```python
import torch

def _softmax(x, axis=-1):
    return torch.softmax(x, dim=axis)

def _gelu(x):
    return torch.nn.functional.gelu(x, approximate='tanh')

def _silu(x):
    return torch.nn.functional.silu(x)

def _sigmoid(x):
    return torch.sigmoid(x)

def _layernorm(x, axis=-1, eps=1e-05):
    m = x.mean(dim=axis, keepdim=True)
    v = x.var(dim=axis, keepdim=True, unbiased=False)
    return (x - m) / torch.sqrt(v + eps)

def _scatter_add(tgt, idx, src, axis=0):
    return tgt.clone().index_add_(axis, idx, src)

def _segment_sum(src, seg, n):
    out = torch.zeros((n,) + src.shape[1:], dtype=src.dtype)
    return out.index_add_(0, seg, src)

def _pad(x, pw):
    flat = tuple((v for pair in reversed(pw) for v in pair))
    return torch.nn.functional.pad(x, flat)
kernel_name = 'gated_mix__memory_aug_recurrent_mem_tr__sliding_local_dilated__prompt'

def setup_inputs():

    _w = lambda a: (lambda t: t.to(torch.bfloat16) if t.is_floating_point() else t)(torch.as_tensor(a))

    def _A_setup():
        B, S, Dm = (1, 2048, 640)
        H, Dh = (32, 192)
        M, seg = (8, 32)
        seg = min(seg, S)
        S = S // seg * seg
        return {'x': _w((lambda *s: torch.randn(*s, dtype=torch.bfloat16) * 0.05)(B, S, Dm)), 'mem0': _w((lambda *s: torch.randn(*s, dtype=torch.bfloat16) * 1.6)(B, M, Dm)), 'Wq': _w((lambda *s: torch.randn(*s, dtype=torch.bfloat16) * 0.8)(Dm, H, Dh) * Dm ** (-0.5)), 'Wk': _w((lambda *s: torch.randn(*s, dtype=torch.bfloat16) * 0.8)(Dm, H, Dh) * Dm ** (-0.5)), 'Wv': _w((lambda *s: torch.randn(*s, dtype=torch.bfloat16) * 1.6)(Dm, H, Dh) * Dm ** (-0.5)), 'Wo': _w((lambda *s: torch.randn(*s, dtype=torch.bfloat16) * 1.6)(H, Dh, Dm) * (H * Dh) ** (-0.5)), 'seg_len': seg}
    _A_in = _A_setup()

    def _B_setup():
        B, S, D = (1, 2048, 640)
        return {'x': _w((lambda *s: torch.randn(*s, dtype=torch.bfloat16) * 0.05)(B, S, D)), 'wqkv': _w((lambda *s: torch.randn(*s, dtype=torch.bfloat16) * 0.8)(D, 3 * D)), 'wo': _w((lambda *s: torch.randn(*s, dtype=torch.bfloat16) * 0.05)(D, D))}
    _B_in = _B_setup()
    return {'A_x': _A_in['x'], 'A_mem0': _A_in['mem0'], 'A_Wq': _A_in['Wq'], 'A_Wk': _A_in['Wk'], 'A_Wv': _A_in['Wv'], 'A_Wo': _A_in['Wo'], 'A_seg_len': _A_in['seg_len'], 'B_x': _B_in['x'], 'B_wqkv': _B_in['wqkv'], 'B_wo': _B_in['wo'], 'gate_w': _w((lambda *s: torch.randn(*s, dtype=torch.bfloat16) * 0.05)(640) * 16.0)}

def reference(A_x, A_mem0, A_Wq, A_Wk, A_Wv, A_Wo, A_seg_len, B_x, B_wqkv, B_wo, gate_w):

    def _A_ref(x, mem0, Wq, Wk, Wv, Wo, seg_len):
        B, S, Dm = x.shape
        H, Dh = (Wq.shape[1], Wq.shape[2])
        M = mem0.shape[1]
        scale = Dh ** (-0.5)
        n_seg = S // seg_len
        L = M + seg_len
        idx = torch.arange(L)
        mask = (idx[:, None] < M) | (idx[:, None] >= idx[None, :])
        mem = mem0
        outs = []
        for s in range(n_seg):
            xs = x[:, s * seg_len:(s + 1) * seg_len, :].clone()
            h = torch.concatenate([mem, xs], axis=1)
            q = torch.einsum('btd,dhe->bhte', h, Wq)
            k = torch.einsum('btd,dhe->bhte', h, Wk)
            v = torch.einsum('btd,dhe->bhte', h, Wv)
            scores = torch.einsum('bhqe,bhke->bhqk', q, k) * scale
            scores = torch.where(mask[None, None], scores, -1000000000.0)
            p = _softmax(scores, axis=-1)
            o = torch.einsum('bhqk,bhke->bhqe', p, v)
            o = torch.einsum('bhte,hed->btd', o, Wo)
            mem = o[:, :M, :].clone()
            outs.append(o[:, M:, :])
        return torch.concatenate(outs, axis=1)

    def _B_ref(x, wqkv, wo):
        B, S, D = x.shape
        H = 32
        Dh = D // H
        W, dil = (8, 2)
        qkv = (lambda x, *d: x.permute(*d))((x @ wqkv).reshape(B, S, 3, H, Dh), 2, 0, 3, 1, 4)
        q, k, v = (qkv[0], qkv[1], qkv[2])
        scale = Dh ** (-0.5)
        pos = torch.arange(S)
        off = torch.arange(W) * dil
        idx = pos[:, None] - off[None, :]
        mask = idx >= 0
        idx_c = torch.where(mask, idx, 0).reshape(-1)
        kg = k[:, :, idx_c, :].reshape(B, H, S, W, Dh)
        vg = v[:, :, idx_c, :].reshape(B, H, S, W, Dh)
        logits = torch.einsum('bhsd,bhswd->bhsw', q, kg) * scale
        logits = torch.where(mask[None, None, :, :], logits, -1000000000.0)
        attn = _softmax(logits, axis=-1)
        o = torch.einsum('bhsw,bhswd->bhsd', attn, vg)
        return (lambda x, *d: x.permute(*d))(o, 0, 2, 1, 3).reshape(B, S, D) @ wo
    x = A_x
    g = _sigmoid((x * gate_w).sum(-1, keepdims=True))
    a = _A_ref(x, A_mem0, A_Wq, A_Wk, A_Wv, A_Wo, A_seg_len)
    b = _B_ref(x, B_wqkv, B_wo)
    return g * a + (1 - g) * b
```

```asm
; @launch kernel=gated_mix__memory_aug_recurrent_mem_tr__sliding_local_dilated__prompt_kernel grid=(256,1,1) block=(256,1,1) lds=161792
.amdgcn_target "amdgcn-amd-amdhsa--gfx950"
.text
.globl gated_mix__memory_aug_recurrent_mem_tr__sliding_local_dilated__prompt_kernel
.p2align 8
.type gated_mix__memory_aug_recurrent_mem_tr__sliding_local_dilated__prompt_kernel,@function
gated_mix__memory_aug_recurrent_mem_tr__sliding_local_dilated__prompt_kernel:
  s_cmp_ge_u32 s2, 256
  s_cbranch_scc1 end0
  s_load_dwordx2 s[4:5], s[0:1], 96
  s_load_dwordx2 s[38:39], s[0:1], 104
  v_lshrrev_b32 v1, 6, v0
  v_and_b32 v2, 15, v0
  v_readfirstlane_b32 s20, v1
  v_and_b32 v1, 63, v0
  v_lshrrev_b32 v3, 4, v1
  s_getreg_b32 s50, hwreg(HW_REG_XCC_ID)
  s_and_b32 s50, s50, 7
  s_waitcnt lgkmcnt(0)
  s_mov_b32 s32, s4
  s_mov_b32 s33, s5
  s_mov_b32 s34, 256
  s_mov_b32 s35, 0x00020000
  v_mov_b32 v21, 0
  s_cmp_lg_u32 s20, 0
  s_cbranch_scc1 rk_1
  s_and_b32 s21, s50, 1
  s_lshl_b32 s21, s21, 7
  s_lshl_b32 s22, s50, 1
  s_and_b32 s22, s22, 12
  s_add_u32 s21, s21, s22
  v_mov_b32 v22, s21
  v_mov_b32 v23, 1
  s_mov_b64 exec, 1
  buffer_atomic_add v23, v22, s[32:35], 0 offen sc0 sc1
  s_waitcnt vmcnt(0)
  v_readfirstlane_b32 s51, v23
  s_lshl_b32 s22, s50, 5
  s_add_u32 s22, s22, s51
  s_cmp_lt_u32 s51, 32
  s_cbranch_scc1 rk_2
  v_mov_b32 v24, 72
  v_mov_b32 v25, 1
  buffer_atomic_add v25, v24, s[32:35], 0 offen sc0 sc1
  s_waitcnt vmcnt(0)
  v_readfirstlane_b32 s23, v25
  s_mov_b32 s101, 0
  s_mov_b64 exec, -1
  v_lshlrev_b32 v24, 2, v1
rk_3:
  s_sleep 8
  buffer_load_dword v25, v24, s[32:35], 0 offen sc1
  s_add_u32 s101, s101, 1
  s_cmp_gt_u32 s101, 131072
  s_cbranch_scc1 end0
  s_waitcnt vmcnt(0)
  v_readlane_b32 s21, v25, 0
  v_readlane_b32 s22, v25, 32
  s_add_u32 s21, s21, s22
  v_readlane_b32 s22, v25, 1
  s_add_u32 s21, s21, s22
  v_readlane_b32 s22, v25, 33
  s_add_u32 s21, s21, s22
  v_readlane_b32 s22, v25, 2
  s_add_u32 s21, s21, s22
  v_readlane_b32 s22, v25, 34
  s_add_u32 s21, s21, s22
  v_readlane_b32 s22, v25, 3
  s_add_u32 s21, s21, s22
  v_readlane_b32 s22, v25, 35
  s_add_u32 s21, s21, s22
  s_cmp_lt_u32 s21, 256
  s_cbranch_scc1 rk_3
  s_mov_b64 exec, 1
  s_mov_b32 s24, 0
rk_5:
  s_and_b32 s21, s24, 1
  s_lshl_b32 s21, s21, 5
  s_lshr_b32 s22, s24, 1
  s_add_u32 s21, s21, s22
  v_readlane_b32 s21, v25, s21
  s_min_u32 s21, s21, 32
  s_sub_u32 s25, 32, s21
  s_cmp_lt_u32 s23, s25
  s_cbranch_scc1 rk_4
  s_sub_u32 s23, s23, s25
  s_add_u32 s24, s24, 1
  s_cmp_lt_u32 s24, 8
  s_cbranch_scc1 rk_5
  s_branch end0
rk_4:
  s_lshl_b32 s22, s24, 5
  s_add_u32 s22, s22, s21
  s_add_u32 s22, s22, s23
  s_or_b32 s22, s22, 0x100
rk_2:
  v_mov_b32 v23, s22
  ds_write_b32 v21, v23
  s_waitcnt lgkmcnt(0)
  s_mov_b64 exec, -1
rk_1:
  s_barrier
  ds_read_b32 v23, v21
  s_waitcnt lgkmcnt(0)
  v_readfirstlane_b32 s22, v23
  s_barrier
  s_mov_b32 s84, 0
  s_mov_b32 s85, -1

  s_lshr_b32 s53, s22, 8
  s_and_b32 s22, s22, 255
  s_cmp_ge_u32 s22, 128
  s_cbranch_scc1 gemm_side
  s_lshr_b32 s50, s22, 4
  s_and_b32 s51, s22, 15
  s_mov_b32 s86, 0x3dd53b95
  s_load_dwordx2 s[4:5], s[0:1], 8
  s_load_dwordx4 s[36:39], s[0:1], 16
  s_load_dwordx4 s[40:43], s[0:1], 32
  s_load_dwordx2 s[44:45], s[0:1], 104
  s_lshr_b32 s55, s51, 2
  s_and_b32 s56, s51, 3
  s_lshl_b32 s57, s50, 2
  s_add_u32 s58, s57, s55
  s_add_u32 s59, s57, s20
  s_lshr_b32 s21, s51, 1
  s_xor_b32 s21, s21, s55
  s_andn2_b32 s21, 1, s21
  s_xor_b32 s85, s51, s21
  s_xor_b32 s84, s56, 1
  s_mul_i32 s87, s85, 5
  s_lshr_b32 s87, s87, 1
  s_and_b32 s79, s85, 1
  s_waitcnt lgkmcnt(0)
  s_add_u32 s8, s44, 78643200
  s_addc_u32 s9, s45, 0
  s_mov_b32 s10, 2162688
  s_mov_b32 s11, 0x00020000
  s_mov_b32 s16, s44
  s_mov_b32 s17, s45
  s_mov_b32 s18, 50331648
  s_mov_b32 s19, 0x00020000
  s_add_u32 s24, s44, 50331648
  s_addc_u32 s25, s45, 0
  s_mov_b32 s26, 12582912
  s_mov_b32 s27, 0x00020000
  s_mov_b32 s28, s4
  s_mov_b32 s29, s5
  s_mov_b32 s30, 10240
  s_mov_b32 s31, 0x00020000
  s_add_u32 s4, s44, 83886079
  s_addc_u32 s5, s45, 0
  s_and_b32 s4, s4, 0xffe00000
  s_mov_b32 s6, 2097152
  s_mov_b32 s7, 0x00020000
  v_mov_b32 v27, 10923
  v_add_u32 v103, 0, v1
  v_mul_u32_u24 v102, v103, v27
  v_lshrrev_b32 v102, 16, v102
  v_mul_u32_u24 v101, 6, v102
  v_sub_u32 v103, v103, v101
  v_bfe_u32 v101, v102, 1, 1
  v_mul_u32_u24 v101, 20, v101
  v_and_b32 v100, 1, v102
  v_add_u32 v101, v101, v100
  v_lshrrev_b32 v100, 3, v102
  v_mul_u32_u24 v100, 40, v100
  v_bfe_u32 v99, v102, 2, 1
  v_lshl_add_u32 v100, v99, 1, v100
  v_add_u32 v100, v100, v101
  v_mul_u32_u24 v100, 12288, v100
  v_lshl_add_u32 v46, v103, 4, v100
  v_lshrrev_b32 v100, 4, v102
  v_mul_u32_u24 v100, 40, v100
  v_bfe_u32 v99, v102, 2, 2
  v_lshl_add_u32 v100, v99, 1, v100
  v_add_u32 v100, v100, v101
  v_mul_u32_u24 v100, 12288, v100
  v_lshl_add_u32 v96, v103, 4, v100
  v_add_u32 v103, 64, v1
  v_mul_u32_u24 v102, v103, v27
  v_lshrrev_b32 v102, 16, v102
  v_mul_u32_u24 v101, 6, v102
  v_sub_u32 v103, v103, v101
  v_bfe_u32 v101, v102, 1, 1
  v_mul_u32_u24 v101, 20, v101
  v_and_b32 v100, 1, v102
  v_add_u32 v101, v101, v100
  v_lshrrev_b32 v100, 3, v102
  v_mul_u32_u24 v100, 40, v100
  v_bfe_u32 v99, v102, 2, 1
  v_lshl_add_u32 v100, v99, 1, v100
  v_add_u32 v100, v100, v101
  v_mul_u32_u24 v100, 12288, v100
  v_lshl_add_u32 v47, v103, 4, v100
  v_lshrrev_b32 v100, 4, v102
  v_mul_u32_u24 v100, 40, v100
  v_bfe_u32 v99, v102, 2, 2
  v_lshl_add_u32 v100, v99, 1, v100
  v_add_u32 v100, v100, v101
  v_mul_u32_u24 v100, 12288, v100
  v_lshl_add_u32 v97, v103, 4, v100
  v_add_u32 v103, 128, v1
  v_mul_u32_u24 v102, v103, v27
  v_lshrrev_b32 v102, 16, v102
  v_mul_u32_u24 v101, 6, v102
  v_sub_u32 v103, v103, v101
  v_bfe_u32 v101, v102, 1, 1
  v_mul_u32_u24 v101, 20, v101
  v_and_b32 v100, 1, v102
  v_add_u32 v101, v101, v100
  v_lshrrev_b32 v100, 3, v102
  v_mul_u32_u24 v100, 40, v100
  v_bfe_u32 v99, v102, 2, 1
  v_lshl_add_u32 v100, v99, 1, v100
  v_add_u32 v100, v100, v101
  v_mul_u32_u24 v100, 12288, v100
  v_lshl_add_u32 v48, v103, 4, v100
  v_lshrrev_b32 v100, 4, v102
  v_mul_u32_u24 v100, 40, v100
  v_bfe_u32 v99, v102, 2, 2
  v_lshl_add_u32 v100, v99, 1, v100
  v_add_u32 v100, v100, v101
  v_mul_u32_u24 v100, 12288, v100
  v_lshl_add_u32 v98, v103, 4, v100
  s_mul_i32 s80, s58, 384
  s_mul_i32 s22, s56, 96
  s_add_u32 s80, s80, s22
  s_mul_i32 s22, s20, 1966080
  s_add_u32 s80, s80, s22
  s_mul_i32 s88, s84, 96
  s_mul_i32 s21, s56, 96
  s_sub_u32 s88, s88, s21
  s_add_u32 s88, s88, s80
  s_mul_i32 s81, s20, 40448

  s_mul_i32 s82, s59, 245760
  s_lshl_b32 s22, s87, 5
  s_add_u32 s82, s82, s22
  s_mov_b32 s12, s38
  s_mov_b32 s13, s39
  s_mov_b32 s14, 7864320
  s_mov_b32 s15, 0x00020000
  s_add_u32 s21, s80, 0
  s_add_u32 s22, s81, 0
  s_add_u32 m0, s22, 0
  s_nop 0
  buffer_load_dwordx4 v96, s[12:15], s21 offen lds
  s_add_u32 m0, s22, 1024
  s_nop 0
  buffer_load_dwordx4 v97, s[12:15], s21 offen lds
  s_add_u32 m0, s22, 2048
  s_nop 0
  buffer_load_dwordx4 v98, s[12:15], s21 offen lds
  s_add_u32 s21, s80, 983040
  s_add_u32 s22, s81, 3072
  s_add_u32 m0, s22, 0
  s_nop 0
  buffer_load_dwordx4 v96, s[12:15], s21 offen lds
  s_add_u32 m0, s22, 1024
  s_nop 0
  buffer_load_dwordx4 v97, s[12:15], s21 offen lds
  s_add_u32 m0, s22, 2048
  s_nop 0
  buffer_load_dwordx4 v98, s[12:15], s21 offen lds
  s_add_u32 s21, s80, 98304
  s_add_u32 s22, s81, 6144
  s_add_u32 m0, s22, 0
  s_nop 0
  buffer_load_dwordx4 v96, s[12:15], s21 offen lds
  s_add_u32 m0, s22, 1024
  s_nop 0
  buffer_load_dwordx4 v97, s[12:15], s21 offen lds
  s_add_u32 m0, s22, 2048
  s_nop 0
  buffer_load_dwordx4 v98, s[12:15], s21 offen lds
  s_add_u32 s21, s80, 1081344
  s_add_u32 s22, s81, 9216
  s_add_u32 m0, s22, 0
  s_nop 0
  buffer_load_dwordx4 v96, s[12:15], s21 offen lds
  s_add_u32 m0, s22, 1024
  s_nop 0
  buffer_load_dwordx4 v97, s[12:15], s21 offen lds
  s_add_u32 m0, s22, 2048
  s_nop 0
  buffer_load_dwordx4 v98, s[12:15], s21 offen lds
  s_add_u32 s21, s80, 196608
  s_add_u32 s22, s81, 12288
  s_add_u32 m0, s22, 0
  s_nop 0
  buffer_load_dwordx4 v46, s[12:15], s21 offen lds
  s_add_u32 m0, s22, 1024
  s_nop 0
  buffer_load_dwordx4 v47, s[12:15], s21 offen lds
  s_add_u32 m0, s22, 2048
  s_nop 0
  buffer_load_dwordx4 v48, s[12:15], s21 offen lds
  v_lshrrev_b32 v99, 2, v2
  v_lshl_add_u32 v99, v3, 3, v99
  v_mul_u32_u24 v99, 96, v99
  v_and_b32 v100, 3, v2
  v_lshlrev_b32 v100, 3, v100
  v_add3_u32 v99, v99, v100, s81
  v_lshlrev_b32 v100, 4, v1
  v_add_u32 v100, s81, v100
  v_and_b32 v236, 7, v2
  v_lshrrev_b32 v237, 3, v2
  v_lshlrev_b32 v238, 7, v3
  v_lshl_add_u32 v238, v236, 4, v238
  v_lshlrev_b32 v16, 4, v1
  v_mul_u32_u24 v244, 1280, v236
  s_mul_i32 s21, s20, 320
  v_add_u32 v244, s21, v244
  v_lshrrev_b32 v245, 3, v1
  v_mul_u32_u24 v245, 40, v245
  v_add_u32 v244, v244, v245
  s_lshr_b32 s21, s20, 1
  s_lshl_b32 s21, s21, 14
  s_and_b32 s22, s20, 1
  s_mul_i32 s22, s22, 3072
  s_add_u32 s21, s21, s22
  v_add_u32 v4, s21, v16
  v_mov_b32 v239, 0x4444
  v_mov_b32 v240, 0xeeee
  v_cmp_eq_u32 vcc, 1, v237
  s_nop 1
  v_cndmask_b32 v44, v239, v240, vcc
  v_cmp_gt_u32 vcc, 2, v3
  s_nop 1
  v_cndmask_b32 v89, 0, 1.0, vcc
  v_lshrrev_b32 v239, 2, v2
  v_mul_u32_u24 v239, 272, v239
  v_lshl_add_u32 v239, v3, 6, v239
  v_and_b32 v240, 3, v2
  v_lshl_add_u32 v239, v240, 2, v239
  s_mul_i32 s21, s20, 5440
  v_add_u32 v5, s21, v239
  v_mul_u32_u24 v239, 272, v3
  v_lshl_add_u32 v6, v2, 4, v239
  v_lshl_add_u32 v239, v236, 4, v239
  v_mul_u32_u24 v240, 10880, v237
  v_add_u32 v45, v239, v240
  s_lshl_b32 s21, s50, 4
  s_add_u32 s21, s21, s51
  s_lshl_b32 s21, s21, 9
  s_lshl_b32 s22, s20, 7
  s_add_u32 s21, s21, s22
  s_add_u32 s21, s21, 81920
  v_and_b32 v239, 1, v3
  v_lshlrev_b32 v239, 8, v239
  v_lshl_add_u32 v239, v236, 4, v239
  v_lshrrev_b32 v240, 1, v3
  v_lshl_add_u32 v239, v240, 3, v239
  v_add_u32 v7, s21, v239
  s_lshl_b32 s22, s58, 9
  s_lshl_b32 s23, s56, 7
  s_add_u32 s22, s22, s23
  s_add_u32 s22, s22, 376704
  v_lshlrev_b32 v239, 6, v3
  v_lshl_add_u32 v239, v236, 3, v239
  v_add_u32 v239, s22, v239
  s_cmp_eq_u32 s20, 2
  s_cselect_b64 vcc, -1, 0
  v_cndmask_b32 v7, v7, v239, vcc
  s_lshl_b32 s21, s59, 11
  s_add_u32 s21, s21, 81920
  v_add_u32 v8, s21, v16
  s_lshl_b32 s21, s59, 9
  s_add_u32 s21, s21, 376832
  v_lshl_add_u32 v9, v1, 3, s21
  s_mul_i32 s21, s59, 3072
  s_add_u32 s21, s21, 278528
  v_and_b32 v239, 0x39, v1
  v_bfe_u32 v240, v1, 1, 1
  v_lshl_or_b32 v239, v240, 2, v239
  v_bfe_u32 v240, v1, 2, 1
  v_lshl_or_b32 v239, v240, 1, v239
  v_lshl_add_u32 v10, v239, 4, s21
  s_cmp_eq_u32 s20, 3
  s_cselect_b32 s22, s84, s56
  s_mul_i32 s22, s22, 12
  v_mul_u32_u24 v239, 3, v3
  v_add_u32 v239, s22, v239
  v_add_u32 v240, 0, v239
  v_lshrrev_b32 v241, 1, v240
  v_and_b32 v240, 1, v240
  v_lshlrev_b32 v240, 3, v240
  v_lshl_add_u32 v242, v241, 7, v240
  v_lshl_add_u32 v242, v236, 4, v242
  s_mul_i32 s21, s58, 3072
  v_add_u32 v21, s21, v242
  v_lshl_add_u32 v242, v241, 8, v240
  v_lshl_add_u32 v242, v2, 4, v242
  s_mul_i32 s21, s58, 12288
  s_and_b32 s22, s20, 1
  s_mul_i32 s22, s22, 6144
  s_add_u32 s21, s21, s22
  v_add_u32 v18, s21, v242
  v_add_u32 v240, 1, v239
  v_lshrrev_b32 v241, 1, v240
  v_and_b32 v240, 1, v240
  v_lshlrev_b32 v240, 3, v240
  v_lshl_add_u32 v242, v241, 7, v240
  v_lshl_add_u32 v242, v236, 4, v242
  s_mul_i32 s21, s58, 3072
  v_add_u32 v22, s21, v242
  v_lshl_add_u32 v242, v241, 8, v240
  v_lshl_add_u32 v242, v2, 4, v242
  s_mul_i32 s21, s58, 12288
  s_and_b32 s22, s20, 1
  s_mul_i32 s22, s22, 6144
  s_add_u32 s21, s21, s22
  v_add_u32 v19, s21, v242
  v_add_u32 v240, 2, v239
  v_lshrrev_b32 v241, 1, v240
  v_and_b32 v240, 1, v240
  v_lshlrev_b32 v240, 3, v240
  v_lshl_add_u32 v242, v241, 7, v240
  v_lshl_add_u32 v242, v236, 4, v242
  s_mul_i32 s21, s58, 3072
  v_add_u32 v23, s21, v242
  v_lshl_add_u32 v242, v241, 8, v240
  v_lshl_add_u32 v242, v2, 4, v242
  s_mul_i32 s21, s58, 12288
  s_and_b32 s22, s20, 1
  s_mul_i32 s22, s22, 6144
  s_add_u32 s21, s21, s22
  v_add_u32 v20, s21, v242
  v_cmp_eq_u32 vcc, 1, v237
  s_nop 1
  v_cndmask_b32 v25, v21, v22, vcc
  v_add_u32 v24, 278528, v25
  s_mul_i32 s21, s20, 3072
  s_add_u32 s21, s21, 22528
  v_add_u32 v11, s21, v16
  v_and_b32 v239, 3, v1
  s_mul_i32 s21, s20, 3
  v_add_u32 v240, s21, v239
  v_cmp_eq_u32 vcc, 3, v239
  v_lshrrev_b32 v241, 5, v1
  v_mul_u32_u24 v241, 10, v241
  v_cndmask_b32 v240, v240, 9, vcc
  s_lshl_b32 s21, s79, 2
  v_add3_u32 v240, v240, v241, s21
  v_lshrrev_b32 v241, 1, v240
  v_lshlrev_b32 v241, 8, v241
  v_and_b32 v240, 1, v240
  v_lshl_add_u32 v241, v240, 3, v241
  v_bfe_u32 v240, v1, 2, 3
  v_lshl_add_u32 v241, v240, 4, v241
  v_add_u32 v12, 22528, v241
  s_mov_b32 s21, 0x07060100
  s_cmp_eq_u32 s20, 1
  s_cselect_b32 s21, 0x07060302, s21
  s_cmp_eq_u32 s20, 2
  s_cselect_b32 s21, 0x07060c0c, s21
  v_mov_b32 v240, s21
  v_mov_b32 v241, 0x03020100
  v_cndmask_b32 v14, v241, v240, vcc
  s_lshr_b32 s21, s85, 3
  s_lshl_b32 s21, s21, 14
  s_bfe_u32 s22, s85, 0x10002
  s_mul_i32 s22, s22, 3072
  s_add_u32 s21, s21, s22
  s_and_b32 s22, s85, 3
  s_lshl_b32 s22, s22, 8
  s_add_u32 s21, s21, s22
  s_lshl_b32 s22, s20, 10
  s_add_u32 s22, s22, s21
  v_lshl_add_u32 v13, v1, 2, s22
  v_lshlrev_b32 v240, 10, v3
  v_lshl_add_u32 v240, v2, 4, v240
  v_add_u32 v240, s21, v240
  s_cmp_eq_u32 s20, 3
  s_cselect_b64 vcc, -1, 0
  v_cndmask_b32 v13, v13, v240, vcc
  s_mov_b32 s91, 0x3c000000
  v_mov_b32 v243, 0
  s_mul_i32 s89, s59, 12288
  s_add_u32 s89, s89, 25165824
  v_cmp_gt_u32 s[60:61], 8, v2
  v_cmp_le_u32 s[62:63], 8, v2
  v_cmp_le_u32 s[72:73], 2, v3
  v_cmp_gt_u32 s[70:71], 48, v1
  s_nop 1
  s_and_b64 s[64:65], s[60:61], s[72:73]
  s_cmp_eq_u32 s20, 2
  s_cselect_b64 s[74:75], s[64:65], s[60:61]
  s_mul_i32 s89, s59, 12288
  s_add_u32 s89, s89, 25165824
  s_not_b64 s[48:49], s[72:73]
  s_mov_b32 s83, 0
  v_mov_b32 v28, -1
  v_mov_b32 v29, -1
  v_mov_b32 v30, -1
  v_mov_b32 v31, -1
  s_cmp_eq_u32 s20, 3
  s_cbranch_scc1 ra_7
  s_mov_b64 exec, s[74:75]
  buffer_store_dwordx2 v[28:29], v7, s[8:11], s83 offen
ra_7:
  s_cmp_lt_u32 s20, 3
  s_cbranch_scc1 ra_8
  s_mov_b64 exec, -1
  buffer_store_dwordx2 v[28:29], v24, s[8:11], s83 offen
  s_mov_b64 exec, s[60:61]
  s_add_u32 s21, s83, 278528
  buffer_store_dwordx2 v[28:29], v23, s[8:11], s21 offen
ra_8:
  s_mov_b64 exec, -1
  s_nop 1
  s_mov_b32 s83, 540672
  v_mov_b32 v28, -1
  v_mov_b32 v29, -1
  v_mov_b32 v30, -1
  v_mov_b32 v31, -1
  s_cmp_eq_u32 s20, 3
  s_cbranch_scc1 ra_9
  s_mov_b64 exec, s[74:75]
  buffer_store_dwordx2 v[28:29], v7, s[8:11], s83 offen
ra_9:
  s_cmp_lt_u32 s20, 3
  s_cbranch_scc1 ra_10
  s_mov_b64 exec, -1
  buffer_store_dwordx2 v[28:29], v24, s[8:11], s83 offen
  s_mov_b64 exec, s[60:61]
  s_add_u32 s21, s83, 278528
  buffer_store_dwordx2 v[28:29], v23, s[8:11], s21 offen
ra_10:
  s_mov_b64 exec, -1
  s_nop 1
  s_mov_b32 s83, 1081344
  v_mov_b32 v28, -1
  v_mov_b32 v29, -1
  v_mov_b32 v30, -1
  v_mov_b32 v31, -1
  s_cmp_eq_u32 s20, 3
  s_cbranch_scc1 ra_11
  s_mov_b64 exec, s[74:75]
  buffer_store_dwordx2 v[28:29], v7, s[8:11], s83 offen
ra_11:
  s_cmp_lt_u32 s20, 3
  s_cbranch_scc1 ra_12
  s_mov_b64 exec, -1
  buffer_store_dwordx2 v[28:29], v24, s[8:11], s83 offen
  s_mov_b64 exec, s[60:61]
  s_add_u32 s21, s83, 278528
  buffer_store_dwordx2 v[28:29], v23, s[8:11], s21 offen
ra_12:
  s_mov_b64 exec, -1
  s_nop 1
  s_mov_b32 s83, 1622016
  v_mov_b32 v28, -1
  v_mov_b32 v29, -1
  v_mov_b32 v30, -1
  v_mov_b32 v31, -1
  s_cmp_eq_u32 s20, 3
  s_cbranch_scc1 ra_13
  s_mov_b64 exec, s[74:75]
  buffer_store_dwordx2 v[28:29], v7, s[8:11], s83 offen
ra_13:
  s_cmp_lt_u32 s20, 3
  s_cbranch_scc1 ra_14
  s_mov_b64 exec, -1
  buffer_store_dwordx2 v[28:29], v24, s[8:11], s83 offen
  s_mov_b64 exec, s[60:61]
  s_add_u32 s21, s83, 278528
  buffer_store_dwordx2 v[28:29], v23, s[8:11], s21 offen
ra_14:
  s_mov_b64 exec, -1
  s_nop 1
  s_cmp_lg_u32 s20, 3
  s_cbranch_scc1 rz_15
  s_and_b32 s21, s50, 3
  s_lshl_b32 s21, s21, 15
  s_lshr_b32 s22, s50, 2
  s_lshl_b32 s22, s22, 13
  s_add_u32 s21, s21, s22
  v_mov_b32 v156, 0
  v_mov_b32 v157, 0
  v_mov_b32 v158, 0
  v_mov_b32 v159, 0
  s_mov_b64 exec, s[70:71]
  buffer_store_dwordx4 v[156:159], v13, s[4:7], s21 offen sc1
  s_mov_b64 exec, -1
rz_15:
  s_mov_b32 s12, s40
  s_mov_b32 s13, s41
  s_mov_b32 s14, 7864320
  s_mov_b32 s15, 0x00020000
  s_add_u32 s21, s88, 0
  s_add_u32 s22, s81, 15360
  s_add_u32 m0, s22, 0
  s_nop 0
  buffer_load_dwordx4 v96, s[12:15], s21 offen lds
  s_add_u32 m0, s22, 1024
  s_nop 0
  buffer_load_dwordx4 v97, s[12:15], s21 offen lds
  s_add_u32 m0, s22, 2048
  s_nop 0
  buffer_load_dwordx4 v98, s[12:15], s21 offen lds
  s_add_u32 s21, s88, 983040
  s_add_u32 s22, s81, 18432
  s_add_u32 m0, s22, 0
  s_nop 0
  buffer_load_dwordx4 v96, s[12:15], s21 offen lds
  s_add_u32 m0, s22, 1024
  s_nop 0
  buffer_load_dwordx4 v97, s[12:15], s21 offen lds
  s_add_u32 m0, s22, 2048
  s_nop 0
  buffer_load_dwordx4 v98, s[12:15], s21 offen lds
  s_add_u32 s21, s88, 98304
  s_add_u32 s22, s81, 21504
  s_add_u32 m0, s22, 0
  s_nop 0
  buffer_load_dwordx4 v96, s[12:15], s21 offen lds
  s_add_u32 m0, s22, 1024
  s_nop 0
  buffer_load_dwordx4 v97, s[12:15], s21 offen lds
  s_add_u32 m0, s22, 2048
  s_nop 0
  buffer_load_dwordx4 v98, s[12:15], s21 offen lds
  s_add_u32 s21, s88, 1081344
  s_add_u32 s22, s81, 24576
  s_add_u32 m0, s22, 0
  s_nop 0
  buffer_load_dwordx4 v96, s[12:15], s21 offen lds
  s_add_u32 m0, s22, 1024
  s_nop 0
  buffer_load_dwordx4 v97, s[12:15], s21 offen lds
  s_add_u32 m0, s22, 2048
  s_nop 0
  buffer_load_dwordx4 v98, s[12:15], s21 offen lds
  s_add_u32 s21, s88, 196608
  s_add_u32 s22, s81, 27648
  s_add_u32 m0, s22, 0
  s_nop 0
  buffer_load_dwordx4 v46, s[12:15], s21 offen lds
  s_add_u32 m0, s22, 1024
  s_nop 0
  buffer_load_dwordx4 v47, s[12:15], s21 offen lds
  s_add_u32 m0, s22, 2048
  s_nop 0
  buffer_load_dwordx4 v48, s[12:15], s21 offen lds
  v_mov_b32 v27, 10923
  v_mov_b32 v49, v100
  v_add_u32 v104, 0, v1
  v_mul_u32_u24 v103, v104, v27
  v_lshrrev_b32 v103, 16, v103
  v_mul_u32_u24 v102, 6, v103
  v_sub_u32 v104, v104, v102
  v_bfe_u32 v102, v103, 1, 1
  v_lshlrev_b32 v102, 3, v102
  v_and_b32 v127, 12, v103
  v_lshrrev_b32 v127, 1, v127
  v_and_b32 v103, 0xfffffff1, v103
  v_or3_b32 v103, v103, v102, v127
  v_mul_u32_u24 v102, 1366, v103
  v_lshrrev_b32 v102, 16, v102
  v_mul_u32_u24 v100, 48, v102
  v_sub_u32 v103, v103, v100
  v_mul_u32_u24 v101, 5462, v103
  v_lshrrev_b32 v101, 16, v101
  v_mul_u32_u24 v126, 12, v101
  v_sub_u32 v103, v103, v126
  v_lshrrev_b32 v126, 2, v103
  v_and_b32 v103, 3, v103
  v_lshl_add_u32 v100, v126, 4, v100
  v_lshl_add_u32 v100, v101, 2, v100
  v_add_u32 v100, v100, v103
  v_mul_u32_u24 v100, 1280, v100
  v_lshl_add_u32 v104, v104, 4, v100
  v_add_u32 v105, 64, v1
  v_mul_u32_u24 v103, v105, v27
  v_lshrrev_b32 v103, 16, v103
  v_mul_u32_u24 v102, 6, v103
  v_sub_u32 v105, v105, v102
  v_bfe_u32 v102, v103, 1, 1
  v_lshlrev_b32 v102, 3, v102
  v_and_b32 v127, 12, v103
  v_lshrrev_b32 v127, 1, v127
  v_and_b32 v103, 0xfffffff1, v103
  v_or3_b32 v103, v103, v102, v127
  v_mul_u32_u24 v102, 1366, v103
  v_lshrrev_b32 v102, 16, v102
  v_mul_u32_u24 v100, 48, v102
  v_sub_u32 v103, v103, v100
  v_mul_u32_u24 v101, 5462, v103
  v_lshrrev_b32 v101, 16, v101
  v_mul_u32_u24 v126, 12, v101
  v_sub_u32 v103, v103, v126
  v_lshrrev_b32 v126, 2, v103
  v_and_b32 v103, 3, v103
  v_lshl_add_u32 v100, v126, 4, v100
  v_lshl_add_u32 v100, v101, 2, v100
  v_add_u32 v100, v100, v103
  v_mul_u32_u24 v100, 1280, v100
  v_lshl_add_u32 v105, v105, 4, v100
  v_add_u32 v106, 128, v1
  v_mul_u32_u24 v103, v106, v27
  v_lshrrev_b32 v103, 16, v103
  v_mul_u32_u24 v102, 6, v103
  v_sub_u32 v106, v106, v102
  v_bfe_u32 v102, v103, 1, 1
  v_lshlrev_b32 v102, 3, v102
  v_and_b32 v127, 12, v103
  v_lshrrev_b32 v127, 1, v127
  v_and_b32 v103, 0xfffffff1, v103
  v_or3_b32 v103, v103, v102, v127
  v_mul_u32_u24 v102, 1366, v103
  v_lshrrev_b32 v102, 16, v102
  v_mul_u32_u24 v100, 48, v102
  v_sub_u32 v103, v103, v100
  v_mul_u32_u24 v101, 5462, v103
  v_lshrrev_b32 v101, 16, v101
  v_mul_u32_u24 v126, 12, v101
  v_sub_u32 v103, v103, v126
  v_lshrrev_b32 v126, 2, v103
  v_and_b32 v103, 3, v103
  v_lshl_add_u32 v100, v126, 4, v100
  v_lshl_add_u32 v100, v101, 2, v100
  v_add_u32 v100, v100, v103
  v_mul_u32_u24 v100, 1280, v100
  v_lshl_add_u32 v106, v106, 4, v100
  v_add_u32 v107, 192, v1
  v_mul_u32_u24 v103, v107, v27
  v_lshrrev_b32 v103, 16, v103
  v_mul_u32_u24 v102, 6, v103
  v_sub_u32 v107, v107, v102
  v_bfe_u32 v102, v103, 1, 1
  v_lshlrev_b32 v102, 3, v102
  v_and_b32 v127, 12, v103
  v_lshrrev_b32 v127, 1, v127
  v_and_b32 v103, 0xfffffff1, v103
  v_or3_b32 v103, v103, v102, v127
  v_mul_u32_u24 v102, 1366, v103
  v_lshrrev_b32 v102, 16, v102
  v_mul_u32_u24 v100, 48, v102
  v_sub_u32 v103, v103, v100
  v_mul_u32_u24 v101, 5462, v103
  v_lshrrev_b32 v101, 16, v101
  v_mul_u32_u24 v126, 12, v101
  v_sub_u32 v103, v103, v126
  v_lshrrev_b32 v126, 2, v103
  v_and_b32 v103, 3, v103
  v_lshl_add_u32 v100, v126, 4, v100
  v_lshl_add_u32 v100, v101, 2, v100
  v_add_u32 v100, v100, v103
  v_mul_u32_u24 v100, 1280, v100
  v_lshl_add_u32 v107, v107, 4, v100
  v_add_u32 v108, 256, v1
  v_mul_u32_u24 v103, v108, v27
  v_lshrrev_b32 v103, 16, v103
  v_mul_u32_u24 v102, 6, v103
  v_sub_u32 v108, v108, v102
  v_bfe_u32 v102, v103, 1, 1
  v_lshlrev_b32 v102, 3, v102
  v_and_b32 v127, 12, v103
  v_lshrrev_b32 v127, 1, v127
  v_and_b32 v103, 0xfffffff1, v103
  v_or3_b32 v103, v103, v102, v127
  v_mul_u32_u24 v102, 1366, v103
  v_lshrrev_b32 v102, 16, v102
  v_mul_u32_u24 v100, 48, v102
  v_sub_u32 v103, v103, v100
  v_mul_u32_u24 v101, 5462, v103
  v_lshrrev_b32 v101, 16, v101
  v_mul_u32_u24 v126, 12, v101
  v_sub_u32 v103, v103, v126
  v_lshrrev_b32 v126, 2, v103
  v_and_b32 v103, 3, v103
  v_lshl_add_u32 v100, v126, 4, v100
  v_lshl_add_u32 v100, v101, 2, v100
  v_add_u32 v100, v100, v103
  v_mul_u32_u24 v100, 1280, v100
  v_lshl_add_u32 v108, v108, 4, v100
  v_add_u32 v109, 320, v1
  v_mul_u32_u24 v103, v109, v27
  v_lshrrev_b32 v103, 16, v103
  v_mul_u32_u24 v102, 6, v103
  v_sub_u32 v109, v109, v102
  v_bfe_u32 v102, v103, 1, 1
  v_lshlrev_b32 v102, 3, v102
  v_and_b32 v127, 12, v103
  v_lshrrev_b32 v127, 1, v127
  v_and_b32 v103, 0xfffffff1, v103
  v_or3_b32 v103, v103, v102, v127
  v_mul_u32_u24 v102, 1366, v103
  v_lshrrev_b32 v102, 16, v102
  v_mul_u32_u24 v100, 48, v102
  v_sub_u32 v103, v103, v100
  v_mul_u32_u24 v101, 5462, v103
  v_lshrrev_b32 v101, 16, v101
  v_mul_u32_u24 v126, 12, v101
  v_sub_u32 v103, v103, v126
  v_lshrrev_b32 v126, 2, v103
  v_and_b32 v103, 3, v103
  v_lshl_add_u32 v100, v126, 4, v100
  v_lshl_add_u32 v100, v101, 2, v100
  v_add_u32 v100, v100, v103
  v_mul_u32_u24 v100, 1280, v100
  v_lshl_add_u32 v109, v109, 4, v100
  v_add_u32 v110, 384, v1
  v_mul_u32_u24 v103, v110, v27
  v_lshrrev_b32 v103, 16, v103
  v_mul_u32_u24 v102, 6, v103
  v_sub_u32 v110, v110, v102
  v_bfe_u32 v102, v103, 1, 1
  v_lshlrev_b32 v102, 3, v102
  v_and_b32 v127, 12, v103
  v_lshrrev_b32 v127, 1, v127
  v_and_b32 v103, 0xfffffff1, v103
  v_or3_b32 v103, v103, v102, v127
  v_mul_u32_u24 v102, 1366, v103
  v_lshrrev_b32 v102, 16, v102
  v_mul_u32_u24 v100, 48, v102
  v_sub_u32 v103, v103, v100
  v_mul_u32_u24 v101, 5462, v103
  v_lshrrev_b32 v101, 16, v101
  v_mul_u32_u24 v126, 12, v101
  v_sub_u32 v103, v103, v126
  v_lshrrev_b32 v126, 2, v103
  v_and_b32 v103, 3, v103
  v_lshl_add_u32 v100, v126, 4, v100
  v_lshl_add_u32 v100, v101, 2, v100
  v_add_u32 v100, v100, v103
  v_mul_u32_u24 v100, 1280, v100
  v_lshl_add_u32 v110, v110, 4, v100
  v_add_u32 v111, 448, v1
  v_mul_u32_u24 v103, v111, v27
  v_lshrrev_b32 v103, 16, v103
  v_mul_u32_u24 v102, 6, v103
  v_sub_u32 v111, v111, v102
  v_bfe_u32 v102, v103, 1, 1
  v_lshlrev_b32 v102, 3, v102
  v_and_b32 v127, 12, v103
  v_lshrrev_b32 v127, 1, v127
  v_and_b32 v103, 0xfffffff1, v103
  v_or3_b32 v103, v103, v102, v127
  v_mul_u32_u24 v102, 1366, v103
  v_lshrrev_b32 v102, 16, v102
  v_mul_u32_u24 v100, 48, v102
  v_sub_u32 v103, v103, v100
  v_mul_u32_u24 v101, 5462, v103
  v_lshrrev_b32 v101, 16, v101
  v_mul_u32_u24 v126, 12, v101
  v_sub_u32 v103, v103, v126
  v_lshrrev_b32 v126, 2, v103
  v_and_b32 v103, 3, v103
  v_lshl_add_u32 v100, v126, 4, v100
  v_lshl_add_u32 v100, v101, 2, v100
  v_add_u32 v100, v100, v103
  v_mul_u32_u24 v100, 1280, v100
  v_lshl_add_u32 v111, v111, 4, v100
  v_add_u32 v112, 512, v1
  v_mul_u32_u24 v103, v112, v27
  v_lshrrev_b32 v103, 16, v103
  v_mul_u32_u24 v102, 6, v103
  v_sub_u32 v112, v112, v102
  v_bfe_u32 v102, v103, 1, 1
  v_lshlrev_b32 v102, 3, v102
  v_and_b32 v127, 12, v103
  v_lshrrev_b32 v127, 1, v127
  v_and_b32 v103, 0xfffffff1, v103
  v_or3_b32 v103, v103, v102, v127
  v_mul_u32_u24 v102, 1366, v103
  v_lshrrev_b32 v102, 16, v102
  v_mul_u32_u24 v100, 48, v102
  v_sub_u32 v103, v103, v100
  v_mul_u32_u24 v101, 5462, v103
  v_lshrrev_b32 v101, 16, v101
  v_mul_u32_u24 v126, 12, v101
  v_sub_u32 v103, v103, v126
  v_lshrrev_b32 v126, 2, v103
  v_and_b32 v103, 3, v103
  v_lshl_add_u32 v100, v126, 4, v100
  v_lshl_add_u32 v100, v101, 2, v100
  v_add_u32 v100, v100, v103
  v_mul_u32_u24 v100, 1280, v100
  v_lshl_add_u32 v112, v112, 4, v100
  s_mov_b32 s12, s42
  s_mov_b32 s13, s43
  s_mov_b32 s14, 7864320
  s_mov_b32 s15, 0x00020000
  s_add_u32 m0, s81, 30720
  s_nop 0
  buffer_load_dwordx4 v104, s[12:15], s82 offen lds
  s_add_u32 m0, s81, 31744
  s_nop 0
  buffer_load_dwordx4 v105, s[12:15], s82 offen lds
  s_add_u32 m0, s81, 32768
  s_nop 0
  buffer_load_dwordx4 v106, s[12:15], s82 offen lds
  s_add_u32 m0, s81, 33792
  s_nop 0
  buffer_load_dwordx4 v107, s[12:15], s82 offen lds
  s_add_u32 m0, s81, 34816
  s_nop 0
  buffer_load_dwordx4 v108, s[12:15], s82 offen lds
  s_add_u32 m0, s81, 35840
  s_nop 0
  buffer_load_dwordx4 v109, s[12:15], s82 offen lds
  s_add_u32 m0, s81, 36864
  s_nop 0
  buffer_load_dwordx4 v110, s[12:15], s82 offen lds
  s_add_u32 m0, s81, 37888
  s_nop 0
  buffer_load_dwordx4 v111, s[12:15], s82 offen lds
  s_add_u32 m0, s81, 38912
  s_nop 0
  buffer_load_dwordx4 v112, s[12:15], s82 offen lds
  s_mov_b32 s12, s36
  s_mov_b32 s13, s37
  s_mov_b32 s14, 7864320
  s_mov_b32 s15, 0x00020000
  s_add_u32 s21, s80, 0
  s_add_u32 s22, s81, 0
  buffer_load_dwordx4 v[128:131], v96, s[12:15], s21 offen
  buffer_load_dwordx4 v[132:135], v97, s[12:15], s21 offen
  buffer_load_dwordx4 v[136:139], v98, s[12:15], s21 offen
  s_add_u32 s21, s80, 983040
  s_add_u32 s22, s81, 3072
  buffer_load_dwordx4 v[140:143], v96, s[12:15], s21 offen
  buffer_load_dwordx4 v[144:147], v97, s[12:15], s21 offen
  buffer_load_dwordx4 v[148:151], v98, s[12:15], s21 offen
  s_add_u32 s21, s80, 98304
  s_add_u32 s22, s81, 6144
  buffer_load_dwordx4 v[152:155], v96, s[12:15], s21 offen
  buffer_load_dwordx4 v[156:159], v97, s[12:15], s21 offen
  buffer_load_dwordx4 v[160:163], v98, s[12:15], s21 offen
  v_add_u32 v113, 576, v1
  v_mul_u32_u24 v103, v113, v27
  v_lshrrev_b32 v103, 16, v103
  v_mul_u32_u24 v102, 6, v103
  v_sub_u32 v113, v113, v102
  v_bfe_u32 v102, v103, 1, 1
  v_lshlrev_b32 v102, 3, v102
  v_and_b32 v127, 12, v103
  v_lshrrev_b32 v127, 1, v127
  v_and_b32 v103, 0xfffffff1, v103
  v_or3_b32 v103, v103, v102, v127
  v_mul_u32_u24 v102, 1366, v103
  v_lshrrev_b32 v102, 16, v102
  v_mul_u32_u24 v100, 48, v102
  v_sub_u32 v103, v103, v100
  v_mul_u32_u24 v101, 5462, v103
  v_lshrrev_b32 v101, 16, v101
  v_mul_u32_u24 v126, 12, v101
  v_sub_u32 v103, v103, v126
  v_lshrrev_b32 v126, 2, v103
  v_and_b32 v103, 3, v103
  v_lshl_add_u32 v100, v126, 4, v100
  v_lshl_add_u32 v100, v101, 2, v100
  v_add_u32 v100, v100, v103
  v_mul_u32_u24 v100, 1280, v100
  v_lshl_add_u32 v113, v113, 4, v100
  v_add_u32 v114, 640, v1
  v_mul_u32_u24 v103, v114, v27
  v_lshrrev_b32 v103, 16, v103
  v_mul_u32_u24 v102, 6, v103
  v_sub_u32 v114, v114, v102
  v_bfe_u32 v102, v103, 1, 1
  v_lshlrev_b32 v102, 3, v102
  v_and_b32 v127, 12, v103
  v_lshrrev_b32 v127, 1, v127
  v_and_b32 v103, 0xfffffff1, v103
  v_or3_b32 v103, v103, v102, v127
  v_mul_u32_u24 v102, 1366, v103
  v_lshrrev_b32 v102, 16, v102
  v_mul_u32_u24 v100, 48, v102
  v_sub_u32 v103, v103, v100
  v_mul_u32_u24 v101, 5462, v103
  v_lshrrev_b32 v101, 16, v101
  v_mul_u32_u24 v126, 12, v101
  v_sub_u32 v103, v103, v126
  v_lshrrev_b32 v126, 2, v103
  v_and_b32 v103, 3, v103
  v_lshl_add_u32 v100, v126, 4, v100
  v_lshl_add_u32 v100, v101, 2, v100
  v_add_u32 v100, v100, v103
  v_mul_u32_u24 v100, 1280, v100
  v_lshl_add_u32 v114, v114, 4, v100
  v_add_u32 v115, 704, v1
  v_mul_u32_u24 v103, v115, v27
  v_lshrrev_b32 v103, 16, v103
  v_mul_u32_u24 v102, 6, v103
  v_sub_u32 v115, v115, v102
  v_bfe_u32 v102, v103, 1, 1
  v_lshlrev_b32 v102, 3, v102
  v_and_b32 v127, 12, v103
  v_lshrrev_b32 v127, 1, v127
  v_and_b32 v103, 0xfffffff1, v103
  v_or3_b32 v103, v103, v102, v127
  v_mul_u32_u24 v102, 1366, v103
  v_lshrrev_b32 v102, 16, v102
  v_mul_u32_u24 v100, 48, v102
  v_sub_u32 v103, v103, v100
  v_mul_u32_u24 v101, 5462, v103
  v_lshrrev_b32 v101, 16, v101
  v_mul_u32_u24 v126, 12, v101
  v_sub_u32 v103, v103, v126
  v_lshrrev_b32 v126, 2, v103
  v_and_b32 v103, 3, v103
  v_lshl_add_u32 v100, v126, 4, v100
  v_lshl_add_u32 v100, v101, 2, v100
  v_add_u32 v100, v100, v103
  v_mul_u32_u24 v100, 1280, v100
  v_lshl_add_u32 v115, v115, 4, v100
  v_add_u32 v116, 768, v1
  v_mul_u32_u24 v103, v116, v27
  v_lshrrev_b32 v103, 16, v103
  v_mul_u32_u24 v102, 6, v103
  v_sub_u32 v116, v116, v102
  v_bfe_u32 v102, v103, 1, 1
  v_lshlrev_b32 v102, 3, v102
  v_and_b32 v127, 12, v103
  v_lshrrev_b32 v127, 1, v127
  v_and_b32 v103, 0xfffffff1, v103
  v_or3_b32 v103, v103, v102, v127
  v_mul_u32_u24 v102, 1366, v103
  v_lshrrev_b32 v102, 16, v102
  v_mul_u32_u24 v100, 48, v102
  v_sub_u32 v103, v103, v100
  v_mul_u32_u24 v101, 5462, v103
  v_lshrrev_b32 v101, 16, v101
  v_mul_u32_u24 v126, 12, v101
  v_sub_u32 v103, v103, v126
  v_lshrrev_b32 v126, 2, v103
  v_and_b32 v103, 3, v103
  v_lshl_add_u32 v100, v126, 4, v100
  v_lshl_add_u32 v100, v101, 2, v100
  v_add_u32 v100, v100, v103
  v_mul_u32_u24 v100, 1280, v100
  v_lshl_add_u32 v116, v116, 4, v100
  v_add_u32 v117, 832, v1
  v_mul_u32_u24 v103, v117, v27
  v_lshrrev_b32 v103, 16, v103
  v_mul_u32_u24 v102, 6, v103
  v_sub_u32 v117, v117, v102
  v_bfe_u32 v102, v103, 1, 1
  v_lshlrev_b32 v102, 3, v102
  v_and_b32 v127, 12, v103
  v_lshrrev_b32 v127, 1, v127
  v_and_b32 v103, 0xfffffff1, v103
  v_or3_b32 v103, v103, v102, v127
  v_mul_u32_u24 v102, 1366, v103
  v_lshrrev_b32 v102, 16, v102
  v_mul_u32_u24 v100, 48, v102
  v_sub_u32 v103, v103, v100
  v_mul_u32_u24 v101, 5462, v103
  v_lshrrev_b32 v101, 16, v101
  v_mul_u32_u24 v126, 12, v101
  v_sub_u32 v103, v103, v126
  v_lshrrev_b32 v126, 2, v103
  v_and_b32 v103, 3, v103
  v_lshl_add_u32 v100, v126, 4, v100
  v_lshl_add_u32 v100, v101, 2, v100
  v_add_u32 v100, v100, v103
  v_mul_u32_u24 v100, 1280, v100
  v_lshl_add_u32 v117, v117, 4, v100
  v_add_u32 v118, 896, v1
  v_mul_u32_u24 v103, v118, v27
  v_lshrrev_b32 v103, 16, v103
  v_mul_u32_u24 v102, 6, v103
  v_sub_u32 v118, v118, v102
  v_bfe_u32 v102, v103, 1, 1
  v_lshlrev_b32 v102, 3, v102
  v_and_b32 v127, 12, v103
  v_lshrrev_b32 v127, 1, v127
  v_and_b32 v103, 0xfffffff1, v103
  v_or3_b32 v103, v103, v102, v127
  v_mul_u32_u24 v102, 1366, v103
  v_lshrrev_b32 v102, 16, v102
  v_mul_u32_u24 v100, 48, v102
  v_sub_u32 v103, v103, v100
  v_mul_u32_u24 v101, 5462, v103
  v_lshrrev_b32 v101, 16, v101
  v_mul_u32_u24 v126, 12, v101
  v_sub_u32 v103, v103, v126
  v_lshrrev_b32 v126, 2, v103
  v_and_b32 v103, 3, v103
  v_lshl_add_u32 v100, v126, 4, v100
  v_lshl_add_u32 v100, v101, 2, v100
  v_add_u32 v100, v100, v103
  v_mul_u32_u24 v100, 1280, v100
  v_lshl_add_u32 v118, v118, 4, v100
  v_add_u32 v119, 960, v1
  v_mul_u32_u24 v103, v119, v27
  v_lshrrev_b32 v103, 16, v103
  v_mul_u32_u24 v102, 6, v103
  v_sub_u32 v119, v119, v102
  v_bfe_u32 v102, v103, 1, 1
  v_lshlrev_b32 v102, 3, v102
  v_and_b32 v127, 12, v103
  v_lshrrev_b32 v127, 1, v127
  v_and_b32 v103, 0xfffffff1, v103
  v_or3_b32 v103, v103, v102, v127
  v_mul_u32_u24 v102, 1366, v103
  v_lshrrev_b32 v102, 16, v102
  v_mul_u32_u24 v100, 48, v102
  v_sub_u32 v103, v103, v100
  v_mul_u32_u24 v101, 5462, v103
  v_lshrrev_b32 v101, 16, v101
  v_mul_u32_u24 v126, 12, v101
  v_sub_u32 v103, v103, v126
  v_lshrrev_b32 v126, 2, v103
  v_and_b32 v103, 3, v103
  v_lshl_add_u32 v100, v126, 4, v100
  v_lshl_add_u32 v100, v101, 2, v100
  v_add_u32 v100, v100, v103
  v_mul_u32_u24 v100, 1280, v100
  v_lshl_add_u32 v119, v119, 4, v100
  v_add_u32 v120, 1024, v1
  v_mul_u32_u24 v103, v120, v27
  v_lshrrev_b32 v103, 16, v103
  v_mul_u32_u24 v102, 6, v103
  v_sub_u32 v120, v120, v102
  v_bfe_u32 v102, v103, 1, 1
  v_lshlrev_b32 v102, 3, v102
  v_and_b32 v127, 12, v103
  v_lshrrev_b32 v127, 1, v127
  v_and_b32 v103, 0xfffffff1, v103
  v_or3_b32 v103, v103, v102, v127
  v_mul_u32_u24 v102, 1366, v103
  v_lshrrev_b32 v102, 16, v102
  v_mul_u32_u24 v100, 48, v102
  v_sub_u32 v103, v103, v100
  v_mul_u32_u24 v101, 5462, v103
  v_lshrrev_b32 v101, 16, v101
  v_mul_u32_u24 v126, 12, v101
  v_sub_u32 v103, v103, v126
  v_lshrrev_b32 v126, 2, v103
  v_and_b32 v103, 3, v103
  v_lshl_add_u32 v100, v126, 4, v100
  v_lshl_add_u32 v100, v101, 2, v100
  v_add_u32 v100, v100, v103
  v_mul_u32_u24 v100, 1280, v100
  v_lshl_add_u32 v120, v120, 4, v100
  v_add_u32 v121, 1088, v1
  v_mul_u32_u24 v103, v121, v27
  v_lshrrev_b32 v103, 16, v103
  v_mul_u32_u24 v102, 6, v103
  v_sub_u32 v121, v121, v102
  v_bfe_u32 v102, v103, 1, 1
  v_lshlrev_b32 v102, 3, v102
  v_and_b32 v127, 12, v103
  v_lshrrev_b32 v127, 1, v127
  v_and_b32 v103, 0xfffffff1, v103
  v_or3_b32 v103, v103, v102, v127
  v_mul_u32_u24 v102, 1366, v103
  v_lshrrev_b32 v102, 16, v102
  v_mul_u32_u24 v100, 48, v102
  v_sub_u32 v103, v103, v100
  v_mul_u32_u24 v101, 5462, v103
  v_lshrrev_b32 v101, 16, v101
  v_mul_u32_u24 v126, 12, v101
  v_sub_u32 v103, v103, v126
  v_lshrrev_b32 v126, 2, v103
  v_and_b32 v103, 3, v103
  v_lshl_add_u32 v100, v126, 4, v100
  v_lshl_add_u32 v100, v101, 2, v100
  v_add_u32 v100, v100, v103
  v_mul_u32_u24 v100, 1280, v100
  v_lshl_add_u32 v121, v121, 4, v100
  v_mov_b32 v100, v49
  v_lshlrev_b32 v239, 2, v1
  s_waitcnt vmcnt(33)
  ds_read_b64_tr_b16 a[60:61], v99 offset:0
  ds_read_b64_tr_b16 a[62:63], v99 offset:384
  ds_read_b64_tr_b16 a[80:81], v99 offset:32
  ds_read_b64_tr_b16 a[82:83], v99 offset:416
  ds_read_b64_tr_b16 a[100:101], v99 offset:64
  ds_read_b64_tr_b16 a[102:103], v99 offset:448
  ds_read_b64_tr_b16 a[64:65], v99 offset:3072
  ds_read_b64_tr_b16 a[66:67], v99 offset:3456
  ds_read_b64_tr_b16 a[84:85], v99 offset:3104
  ds_read_b64_tr_b16 a[86:87], v99 offset:3488
  ds_read_b64_tr_b16 a[104:105], v99 offset:3136
  ds_read_b64_tr_b16 a[106:107], v99 offset:3520
  ds_read_b64_tr_b16 a[68:69], v99 offset:6144
  ds_read_b64_tr_b16 a[70:71], v99 offset:6528
  ds_read_b64_tr_b16 a[88:89], v99 offset:6176
  ds_read_b64_tr_b16 a[90:91], v99 offset:6560
  ds_read_b64_tr_b16 a[108:109], v99 offset:6208
  ds_read_b64_tr_b16 a[110:111], v99 offset:6592
  ds_read_b64_tr_b16 a[72:73], v99 offset:9216
  ds_read_b64_tr_b16 a[74:75], v99 offset:9600
  ds_read_b64_tr_b16 a[92:93], v99 offset:9248
  ds_read_b64_tr_b16 a[94:95], v99 offset:9632
  ds_read_b64_tr_b16 a[112:113], v99 offset:9280
  ds_read_b64_tr_b16 a[114:115], v99 offset:9664
  ds_read_b64_tr_b16 a[76:77], v99 offset:12288
  ds_read_b64_tr_b16 a[78:79], v99 offset:12672
  ds_read_b64_tr_b16 a[96:97], v99 offset:12320
  ds_read_b64_tr_b16 a[98:99], v99 offset:12704
  ds_read_b64_tr_b16 a[116:117], v99 offset:12352
  ds_read_b64_tr_b16 a[118:119], v99 offset:12736
  s_waitcnt lgkmcnt(0)
  s_barrier
  s_cmp_lg_u32 s20, 0
  s_cbranch_scc1 ic_16
  v_mov_b32 v236, 64
  v_mov_b32 v237, 1
  s_mov_b64 exec, 1
  buffer_atomic_add v237, v236, s[32:35], 0 offen sc1
  s_mov_b64 exec, -1
  buffer_load_dword v238, v239, s[32:35], 0 offen sc1
ic_16:
  s_mov_b32 s12, s36
  s_mov_b32 s13, s37
  s_mov_b32 s14, 7864320
  s_mov_b32 s15, 0x00020000
  s_add_u32 s21, s80, 1081344
  s_add_u32 s22, s81, 9216
  buffer_load_dwordx4 v[164:167], v96, s[12:15], s21 offen
  buffer_load_dwordx4 v[168:171], v97, s[12:15], s21 offen
  buffer_load_dwordx4 v[172:175], v98, s[12:15], s21 offen
  s_add_u32 s21, s80, 196608
  s_add_u32 s22, s81, 12288
  buffer_load_dwordx4 v[176:179], v46, s[12:15], s21 offen
  buffer_load_dwordx4 v[180:183], v47, s[12:15], s21 offen
  buffer_load_dwordx4 v[184:187], v48, s[12:15], s21 offen
  s_mov_b32 s12, s42
  s_mov_b32 s13, s43
  s_mov_b32 s14, 7864320
  s_mov_b32 s15, 0x00020000
  buffer_load_dwordx4 v[188:191], v113, s[12:15], s82 offen
  buffer_load_dwordx4 v[192:195], v114, s[12:15], s82 offen
  buffer_load_dwordx4 v[196:199], v115, s[12:15], s82 offen
  buffer_load_dwordx4 v[200:203], v116, s[12:15], s82 offen
  buffer_load_dwordx4 v[204:207], v117, s[12:15], s82 offen
  buffer_load_dwordx4 v[208:211], v118, s[12:15], s82 offen
  buffer_load_dwordx4 v[212:215], v119, s[12:15], s82 offen
  buffer_load_dwordx4 v[216:219], v120, s[12:15], s82 offen
  buffer_load_dwordx4 v[220:223], v121, s[12:15], s82 offen
  buffer_load_dwordx4 v[32:35], v244, s[28:31], 0 offen offset:0
  buffer_load_dwordx4 v[36:39], v244, s[28:31], 0 offen offset:16
  buffer_load_dwordx2 v[40:41], v244, s[28:31], 0 offen offset:32
  s_waitcnt vmcnt(36)
  ds_read_b64_tr_b16 a[120:121], v99 offset:15360
  ds_read_b64_tr_b16 a[122:123], v99 offset:15744
  ds_read_b64_tr_b16 a[140:141], v99 offset:15392
  ds_read_b64_tr_b16 a[142:143], v99 offset:15776
  ds_read_b64_tr_b16 a[160:161], v99 offset:15424
  ds_read_b64_tr_b16 a[162:163], v99 offset:15808
  ds_read_b64_tr_b16 a[124:125], v99 offset:18432
  ds_read_b64_tr_b16 a[126:127], v99 offset:18816
  ds_read_b64_tr_b16 a[144:145], v99 offset:18464
  ds_read_b64_tr_b16 a[146:147], v99 offset:18848
  ds_read_b64_tr_b16 a[164:165], v99 offset:18496
  ds_read_b64_tr_b16 a[166:167], v99 offset:18880
  ds_read_b64_tr_b16 a[128:129], v99 offset:21504
  ds_read_b64_tr_b16 a[130:131], v99 offset:21888
  ds_read_b64_tr_b16 a[148:149], v99 offset:21536
  ds_read_b64_tr_b16 a[150:151], v99 offset:21920
  ds_read_b64_tr_b16 a[168:169], v99 offset:21568
  ds_read_b64_tr_b16 a[170:171], v99 offset:21952
  ds_read_b64_tr_b16 a[132:133], v99 offset:24576
  ds_read_b64_tr_b16 a[134:135], v99 offset:24960
  ds_read_b64_tr_b16 a[152:153], v99 offset:24608
  ds_read_b64_tr_b16 a[154:155], v99 offset:24992
  ds_read_b64_tr_b16 a[172:173], v99 offset:24640
  ds_read_b64_tr_b16 a[174:175], v99 offset:25024
  ds_read_b64_tr_b16 a[136:137], v99 offset:27648
  ds_read_b64_tr_b16 a[138:139], v99 offset:28032
  ds_read_b64_tr_b16 a[156:157], v99 offset:27680
  ds_read_b64_tr_b16 a[158:159], v99 offset:28064
  ds_read_b64_tr_b16 a[176:177], v99 offset:27712
  ds_read_b64_tr_b16 a[178:179], v99 offset:28096
  s_waitcnt lgkmcnt(0)
  s_waitcnt vmcnt(27)
  ds_read_b64_tr_b16 a[180:181], v99 offset:30720
  ds_read_b64_tr_b16 a[182:183], v99 offset:31104
  ds_read_b64_tr_b16 a[204:205], v99 offset:30752
  ds_read_b64_tr_b16 a[206:207], v99 offset:31136
  ds_read_b64_tr_b16 a[228:229], v99 offset:30784
  ds_read_b64_tr_b16 a[230:231], v99 offset:31168
  ds_read_b64_tr_b16 a[184:185], v99 offset:33792
  ds_read_b64_tr_b16 a[186:187], v99 offset:34176
  ds_read_b64_tr_b16 a[208:209], v99 offset:33824
  ds_read_b64_tr_b16 a[210:211], v99 offset:34208
  ds_read_b64_tr_b16 a[232:233], v99 offset:33856
  ds_read_b64_tr_b16 a[234:235], v99 offset:34240
  ds_read_b64_tr_b16 a[188:189], v99 offset:36864
  ds_read_b64_tr_b16 a[190:191], v99 offset:37248
  ds_read_b64_tr_b16 a[212:213], v99 offset:36896
  ds_read_b64_tr_b16 a[214:215], v99 offset:37280
  ds_read_b64_tr_b16 a[236:237], v99 offset:36928
  ds_read_b64_tr_b16 a[238:239], v99 offset:37312
  s_waitcnt lgkmcnt(0)
  s_waitcnt vmcnt(12)
  ds_write_b128 v100, v[128:131] offset:0
  ds_write_b128 v100, v[132:135] offset:1024
  ds_write_b128 v100, v[136:139] offset:2048
  ds_write_b128 v100, v[140:143] offset:3072
  ds_write_b128 v100, v[144:147] offset:4096
  ds_write_b128 v100, v[148:151] offset:5120
  ds_write_b128 v100, v[152:155] offset:6144
  ds_write_b128 v100, v[156:159] offset:7168
  ds_write_b128 v100, v[160:163] offset:8192
  ds_write_b128 v100, v[164:167] offset:9216
  ds_write_b128 v100, v[168:171] offset:10240
  ds_write_b128 v100, v[172:175] offset:11264
  ds_write_b128 v100, v[176:179] offset:12288
  ds_write_b128 v100, v[180:183] offset:13312
  ds_write_b128 v100, v[184:187] offset:14336
  s_waitcnt lgkmcnt(0)
  ds_read_b64_tr_b16 a[0:1], v99 offset:0
  ds_read_b64_tr_b16 a[2:3], v99 offset:384
  ds_read_b64_tr_b16 a[20:21], v99 offset:32
  ds_read_b64_tr_b16 a[22:23], v99 offset:416
  ds_read_b64_tr_b16 a[40:41], v99 offset:64
  ds_read_b64_tr_b16 a[42:43], v99 offset:448
  ds_read_b64_tr_b16 a[4:5], v99 offset:3072
  ds_read_b64_tr_b16 a[6:7], v99 offset:3456
  ds_read_b64_tr_b16 a[24:25], v99 offset:3104
  ds_read_b64_tr_b16 a[26:27], v99 offset:3488
  ds_read_b64_tr_b16 a[44:45], v99 offset:3136
  ds_read_b64_tr_b16 a[46:47], v99 offset:3520
  ds_read_b64_tr_b16 a[8:9], v99 offset:6144
  ds_read_b64_tr_b16 a[10:11], v99 offset:6528
  ds_read_b64_tr_b16 a[28:29], v99 offset:6176
  ds_read_b64_tr_b16 a[30:31], v99 offset:6560
  ds_read_b64_tr_b16 a[48:49], v99 offset:6208
  ds_read_b64_tr_b16 a[50:51], v99 offset:6592
  ds_read_b64_tr_b16 a[12:13], v99 offset:9216
  ds_read_b64_tr_b16 a[14:15], v99 offset:9600
  ds_read_b64_tr_b16 a[32:33], v99 offset:9248
  ds_read_b64_tr_b16 a[34:35], v99 offset:9632
  ds_read_b64_tr_b16 a[52:53], v99 offset:9280
  ds_read_b64_tr_b16 a[54:55], v99 offset:9664
  ds_read_b64_tr_b16 a[16:17], v99 offset:12288
  ds_read_b64_tr_b16 a[18:19], v99 offset:12672
  ds_read_b64_tr_b16 a[36:37], v99 offset:12320
  ds_read_b64_tr_b16 a[38:39], v99 offset:12704
  ds_read_b64_tr_b16 a[56:57], v99 offset:12352
  ds_read_b64_tr_b16 a[58:59], v99 offset:12736
  s_waitcnt lgkmcnt(0)
  s_add_u32 s64, s44, 81068032
  s_addc_u32 s65, s45, 0
  s_mov_b32 s66, 115712
  s_mov_b32 s67, 0x00020000
  s_mov_b32 s83, 0
  s_cmp_lg_u32 s20, 0
  s_cbranch_scc1 sp_17
  v_and_b32 v243, 3, v1
  v_lshlrev_b32 v243, 7, v243
  s_lshl_b32 s78, s50, 9
  s_and_b32 s21, s51, 12
  s_add_u32 s78, s78, s21
  s_add_u32 s78, s78, 94208
  v_readlane_b32 s83, v238, 19
  s_cmp_eq_u32 s83, 0
  s_cbranch_scc1 sp_17
  buffer_load_dword v238, v239, s[32:35], 0 offen sc1
  buffer_load_dword v242, v243, s[64:67], s78 offen sc1
sp_17:
  s_waitcnt vmcnt(3)
  ds_write_b128 v100, v[188:191] offset:15360
  ds_write_b128 v100, v[192:195] offset:16384
  ds_write_b128 v100, v[196:199] offset:17408
  ds_write_b128 v100, v[200:203] offset:18432
  ds_write_b128 v100, v[204:207] offset:19456
  ds_write_b128 v100, v[208:211] offset:20480
  ds_write_b128 v100, v[212:215] offset:21504
  ds_write_b128 v100, v[216:219] offset:22528
  ds_write_b128 v100, v[220:223] offset:23552
  s_waitcnt lgkmcnt(0)
  ds_read_b64_tr_b16 a[192:193], v99 offset:15360
  ds_read_b64_tr_b16 a[194:195], v99 offset:15744
  ds_read_b64_tr_b16 a[216:217], v99 offset:15392
  ds_read_b64_tr_b16 a[218:219], v99 offset:15776
  ds_read_b64_tr_b16 a[240:241], v99 offset:15424
  ds_read_b64_tr_b16 a[242:243], v99 offset:15808
  ds_read_b64_tr_b16 a[196:197], v99 offset:18432
  ds_read_b64_tr_b16 a[198:199], v99 offset:18816
  ds_read_b64_tr_b16 a[220:221], v99 offset:18464
  ds_read_b64_tr_b16 a[222:223], v99 offset:18848
  ds_read_b64_tr_b16 a[244:245], v99 offset:18496
  ds_read_b64_tr_b16 a[246:247], v99 offset:18880
  ds_read_b64_tr_b16 a[200:201], v99 offset:21504
  ds_read_b64_tr_b16 a[202:203], v99 offset:21888
  ds_read_b64_tr_b16 a[224:225], v99 offset:21536
  ds_read_b64_tr_b16 a[226:227], v99 offset:21920
  ds_read_b64_tr_b16 a[248:249], v99 offset:21568
  ds_read_b64_tr_b16 a[250:251], v99 offset:21952
  s_waitcnt lgkmcnt(0)
  v_mov_b32 v174, 0
  v_mov_b32 v175, 0
  v_mov_b32 v218, 0
  v_mov_b32 v219, 0
  v_mov_b32 v234, 0
  v_mov_b32 v235, 0
  v_mov_b32 v220, 0
  v_mov_b32 v221, 0
  v_mov_b32 v222, 0
  v_mov_b32 v223, 0
  v_mov_b32 v224, 0
  v_mov_b32 v225, 0
  v_mov_b32 v226, 0
  v_mov_b32 v227, 0
  s_waitcnt vmcnt(0)
  s_barrier
  s_add_u32 s12, s44, 81068032
  s_addc_u32 s13, s45, 0
  s_mov_b32 s14, 115712
  s_mov_b32 s15, 0x00020000
  s_add_u32 s28, s44, 114294784
  s_addc_u32 s29, s45, 0
  s_mov_b32 s30, 83886080
  s_mov_b32 s31, 0x00020000
  s_mul_i32 s89, s59, 5
  s_lshr_b32 s21, s87, 3
  s_add_u32 s89, s89, s21
  s_and_b32 s87, s87, 7
  s_lshl_b32 s79, s59, 7
  s_and_b32 s21, s51, 12
  s_add_u32 s79, s79, s21
  s_add_u32 s79, s79, 94208
  v_mov_b32 v94, 0
  v_mov_b32 v95, 0
  s_lshl_b32 s90, s58, 7
  s_lshl_b32 s21, s56, 3
  s_add_u32 s90, s90, s21
  s_add_u32 s90, s90, 18432
  s_cmp_lg_u32 s20, 0
  s_cbranch_scc1 fm_19
  s_bfe_u32 s82, s50, 0x10001
  s_lshl_b32 s82, s82, 5
  s_lshr_b32 s21, s50, 2
  s_add_u32 s82, s82, s21
  s_and_b32 s80, s50, 1
  s_lshl_b32 s80, s80, 4
  s_add_u32 s80, s80, 16
  s_mov_b32 s101, 0
  s_branch fm_20
fm_18:
  s_sleep 8
fm_22:
  buffer_load_dword v238, v239, s[32:35], 0 offen sc1
  s_cmp_eq_u32 s83, 0
  s_cbranch_scc1 fm_20
  buffer_load_dword v242, v243, s[12:15], s78 offen sc1
fm_20:
  s_add_u32 s101, s101, 1
  s_cmp_gt_u32 s101, 131072
  s_cbranch_scc1 end0
  s_waitcnt vmcnt(0)
  s_mov_b32 s81, s83
  v_readlane_b32 s83, v238, 19
  s_cmp_eq_u32 s83, 0
  s_cbranch_scc1 fm_18
  s_cmp_eq_u32 s81, 0
  s_cbranch_scc1 fm_22
  v_readlane_b32 s22, v238, 0
  v_readlane_b32 s23, v238, 32
  s_add_u32 s22, s22, s23
  v_readlane_b32 s23, v238, 1
  s_add_u32 s22, s22, s23
  v_readlane_b32 s23, v238, 33
  s_add_u32 s22, s22, s23
  v_readlane_b32 s23, v238, 2
  s_add_u32 s22, s22, s23
  v_readlane_b32 s23, v238, 34
  s_add_u32 s22, s22, s23
  v_readlane_b32 s23, v238, 3
  s_add_u32 s22, s22, s23
  v_readlane_b32 s23, v238, 35
  s_add_u32 s22, s22, s23
  v_readlane_b32 s21, v238, 16
  v_readlane_b32 s23, v238, 21
  v_cmp_gt_u32 vcc, 1, v242
  s_cmp_ge_u32 s22, 256
  s_cselect_b32 s23, s23, 0
  s_cmp_ge_u32 s21, 128
  s_cselect_b32 s23, s23, 0
  s_cbranch_vccnz fm_18
  s_cmp_eq_u32 s23, 0
  s_cbranch_scc1 fm_18
  v_readlane_b32 s21, v238, s82
  v_cmp_ne_u32 vcc, 32, v238
  s_cmp_ge_u32 s21, s80
  s_cselect_b32 s81, 1, 0
  s_andn2_b32 s53, s81, s53
  s_and_b32 s21, vcc_lo, 15
  s_and_b32 s22, vcc_hi, 15
  s_or_b32 s21, s21, s22
  v_mov_b32 v244, s23
  v_mov_b32 v245, s53
  v_mov_b32 v246, s21
  v_mov_b32 v236, 0
  ds_write_b96 v236, v[244:246]
  s_waitcnt lgkmcnt(0)
fm_19:
  s_barrier
  v_mov_b32 v236, 0
  ds_read_b96 v[244:246], v236
  s_mov_b32 s23, 0
  s_mov_b32 s67, 0
  s_mov_b32 s68, 0
  s_sub_u32 s21, s23, 64
  s_mul_i32 s21, s21, 160
  s_add_u32 s21, s21, s89
  s_lshl_b32 s21, s21, 14
  s_add_u32 s64, s21, s67
  s_lshr_b32 s22, s64, 8
  s_xor_b32 s64, s64, s22
  s_xor_b32 s64, s64, s68
  s_and_b32 s64, s64, 8192
  s_add_u32 s64, s64, s21
  s_add_u32 s64, s64, 83886080
  s_mul_i32 s21, s23, 160
  s_add_u32 s21, s21, s89
  s_lshl_b32 s21, s21, 13
  s_cmp_lt_u32 s23, 64
  s_cselect_b32 s64, s21, s64
  s_add_u32 s69, s89, 1
  s_sub_u32 s21, s23, 64
  s_mul_i32 s21, s21, 160
  s_add_u32 s21, s21, s69
  s_lshl_b32 s21, s21, 14
  s_add_u32 s66, s21, s67
  s_lshr_b32 s22, s66, 8
  s_xor_b32 s66, s66, s22
  s_xor_b32 s66, s66, s68
  s_and_b32 s66, s66, 8192
  s_add_u32 s66, s66, s21
  s_add_u32 s66, s66, 83886080
  s_mul_i32 s21, s23, 160
  s_add_u32 s21, s21, s69
  s_lshl_b32 s21, s21, 13
  s_cmp_lt_u32 s23, 64
  s_cselect_b32 s66, s21, s66
  s_lshl_b32 s21, s87, 10
  s_add_u32 s64, s64, s21
  s_add_u32 s66, s66, s21
  s_sub_u32 s66, s66, 8192
  s_cmp_lt_u32 s87, 7
  s_cselect_b32 s65, s64, s66
  s_cmp_lt_u32 s87, 6
  s_cselect_b32 s66, s64, s66
  buffer_load_dwordx4 v[176:179], v16, s[28:31], s64 offen offset:0 sc1
  buffer_load_dwordx4 v[180:183], v16, s[28:31], s65 offen offset:1024 sc1
  buffer_load_dwordx4 v[184:187], v16, s[28:31], s66 offen offset:2048 sc1
  s_cmp_ge_u32 s20, 2
  s_cbranch_scc1 pf_23
  buffer_load_dwordx2 v[168:169], v18, s[16:19], 0 offen sc1
  buffer_load_dwordx2 v[170:171], v19, s[16:19], 0 offen sc1
  buffer_load_dwordx2 v[172:173], v20, s[16:19], 0 offen sc1
pf_23:
  s_waitcnt lgkmcnt(0)
  v_readfirstlane_b32 s53, v245
  v_readfirstlane_b32 s69, v244
  v_readfirstlane_b32 s21, v246
  v_mov_b32 v237, v244
  s_cmp_eq_u32 s21, 0
  s_cbranch_scc1 fm_21
  s_mov_b32 s83, 0
  v_mov_b32 v28, -1
  v_mov_b32 v29, -1
  v_mov_b32 v30, -1
  v_mov_b32 v31, -1
  s_cmp_eq_u32 s20, 3
  s_cbranch_scc1 ra_24
  s_mov_b64 exec, s[74:75]
  buffer_store_dwordx2 v[28:29], v7, s[8:11], s83 offen sc1
ra_24:
  s_cmp_lt_u32 s20, 3
  s_cbranch_scc1 ra_25
  s_mov_b64 exec, -1
  buffer_store_dwordx2 v[28:29], v24, s[8:11], s83 offen sc1
  s_mov_b64 exec, s[60:61]
  s_add_u32 s21, s83, 278528
  buffer_store_dwordx2 v[28:29], v23, s[8:11], s21 offen sc1
ra_25:
  s_mov_b64 exec, -1
  s_nop 1
  s_mov_b32 s83, 540672
  v_mov_b32 v28, -1
  v_mov_b32 v29, -1
  v_mov_b32 v30, -1
  v_mov_b32 v31, -1
  s_cmp_eq_u32 s20, 3
  s_cbranch_scc1 ra_26
  s_mov_b64 exec, s[74:75]
  buffer_store_dwordx2 v[28:29], v7, s[8:11], s83 offen sc1
ra_26:
  s_cmp_lt_u32 s20, 3
  s_cbranch_scc1 ra_27
  s_mov_b64 exec, -1
  buffer_store_dwordx2 v[28:29], v24, s[8:11], s83 offen sc1
  s_mov_b64 exec, s[60:61]
  s_add_u32 s21, s83, 278528
  buffer_store_dwordx2 v[28:29], v23, s[8:11], s21 offen sc1
ra_27:
  s_mov_b64 exec, -1
  s_nop 1
  s_mov_b32 s83, 1081344
  v_mov_b32 v28, -1
  v_mov_b32 v29, -1
  v_mov_b32 v30, -1
  v_mov_b32 v31, -1
  s_cmp_eq_u32 s20, 3
  s_cbranch_scc1 ra_28
  s_mov_b64 exec, s[74:75]
  buffer_store_dwordx2 v[28:29], v7, s[8:11], s83 offen sc1
ra_28:
  s_cmp_lt_u32 s20, 3
  s_cbranch_scc1 ra_29
  s_mov_b64 exec, -1
  buffer_store_dwordx2 v[28:29], v24, s[8:11], s83 offen sc1
  s_mov_b64 exec, s[60:61]
  s_add_u32 s21, s83, 278528
  buffer_store_dwordx2 v[28:29], v23, s[8:11], s21 offen sc1
ra_29:
  s_mov_b64 exec, -1
  s_nop 1
  s_mov_b32 s83, 1622016
  v_mov_b32 v28, -1
  v_mov_b32 v29, -1
  v_mov_b32 v30, -1
  v_mov_b32 v31, -1
  s_cmp_eq_u32 s20, 3
  s_cbranch_scc1 ra_30
  s_mov_b64 exec, s[74:75]
  buffer_store_dwordx2 v[28:29], v7, s[8:11], s83 offen sc1
ra_30:
  s_cmp_lt_u32 s20, 3
  s_cbranch_scc1 ra_31
  s_mov_b64 exec, -1
  buffer_store_dwordx2 v[28:29], v24, s[8:11], s83 offen sc1
  s_mov_b64 exec, s[60:61]
  s_add_u32 s21, s83, 278528
  buffer_store_dwordx2 v[28:29], v23, s[8:11], s21 offen sc1
ra_31:
  s_mov_b64 exec, -1
  s_nop 1
  s_waitcnt vmcnt(0)
  s_barrier
  s_mov_b32 s21, 100
  s_cmp_lg_u32 s20, 0
  s_cbranch_scc1 af_32
  v_mov_b32 v240, 0
  v_mov_b32 v241, 1
  s_mov_b64 exec, 1
  buffer_atomic_add v241, v240, s[32:35], s21 offen sc1
  s_mov_b64 exec, -1
  s_nop 1
af_32:
  s_cmp_lg_u32 s20, 0
  s_cbranch_scc1 wf_34
  v_mov_b32 v240, 0
  s_mov_b32 s101, 0
wf_33:
  buffer_load_dword v241, v240, s[32:35], s21 offen sc1
  s_add_u32 s101, s101, 1
  s_cmp_gt_u32 s101, 131072
  s_cbranch_scc1 end0
  s_waitcnt vmcnt(0)
  v_readfirstlane_b32 s100, v241
  s_cmp_ge_u32 s100, 128
  s_cbranch_scc1 wf_34
  s_sleep 8
  s_branch wf_33
wf_34:
  s_barrier
fm_21:
  s_add_u32 s67, s44, 83886079
  s_lshr_b32 s67, s67, 21
  s_xor_b32 s68, s67, s69
  s_xor_b32 s68, s68, 0
  s_and_b32 s68, s68, 1
  s_lshl_b32 s68, s68, 13
  s_add_u32 s67, s44, 198180864
  s_mov_b32 s23, 1
  s_sub_u32 s21, s23, 64
  s_mul_i32 s21, s21, 160
  s_add_u32 s21, s21, s89
  s_lshl_b32 s21, s21, 14
  s_add_u32 s64, s21, s67
  s_lshr_b32 s22, s64, 8
  s_xor_b32 s64, s64, s22
  s_xor_b32 s64, s64, s68
  s_and_b32 s64, s64, 8192
  s_add_u32 s64, s64, s21
  s_add_u32 s64, s64, 83886080
  s_mul_i32 s21, s23, 160
  s_add_u32 s21, s21, s89
  s_lshl_b32 s21, s21, 13
  s_cmp_lt_u32 s23, 64
  s_cselect_b32 s64, s21, s64
  s_add_u32 s69, s89, 1
  s_sub_u32 s21, s23, 64
  s_mul_i32 s21, s21, 160
  s_add_u32 s21, s21, s69
  s_lshl_b32 s21, s21, 14
  s_add_u32 s66, s21, s67
  s_lshr_b32 s22, s66, 8
  s_xor_b32 s66, s66, s22
  s_xor_b32 s66, s66, s68
  s_and_b32 s66, s66, 8192
  s_add_u32 s66, s66, s21
  s_add_u32 s66, s66, 83886080
  s_mul_i32 s21, s23, 160
  s_add_u32 s21, s21, s69
  s_lshl_b32 s21, s21, 13
  s_cmp_lt_u32 s23, 64
  s_cselect_b32 s66, s21, s66
  s_lshl_b32 s21, s87, 10
  s_add_u32 s64, s64, s21
  s_add_u32 s66, s66, s21
  s_sub_u32 s66, s66, 8192
  s_cmp_lt_u32 s87, 7
  s_cselect_b32 s65, s64, s66
  s_cmp_lt_u32 s87, 6
  s_cselect_b32 s66, s64, s66
  v_add_u32 v237, -1, v237
  v_lshlrev_b32 v237, 13, v237
  v_xor_b32 v237, 0, v237
  v_add_u32 v13, v13, v237
  v_add_u32 v4, v4, v237
  s_barrier
  v_add_u32 v242, 1088, v5
  v_add_u32 v243, 2176, v5
  v_add_u32 v244, 3264, v5
  v_add_u32 v245, 4352, v5
  s_mov_b32 s52, 0
  v_mov_b32 v52, 0
  v_mov_b32 v53, 0
  v_mov_b32 v54, 0
  v_mov_b32 v55, 0
  v_mov_b32 v56, 0
  v_mov_b32 v57, 0
  v_mov_b32 v58, 0
  v_mov_b32 v59, 0
  v_mov_b32 v60, 0
  v_mov_b32 v61, 0
  v_mov_b32 v62, 0
  v_mov_b32 v63, 0
  v_mov_b32 v64, 0
  v_mov_b32 v65, 0
  v_mov_b32 v66, 0
  v_mov_b32 v67, 0
  v_mov_b32 v68, 0
  v_mov_b32 v69, 0
  v_mov_b32 v70, 0
  v_mov_b32 v71, 0
  v_mov_b32 v72, 0
  v_mov_b32 v73, 0
  v_mov_b32 v74, 0
  v_mov_b32 v75, 0
  v_mov_b32 v76, 0
  v_mov_b32 v77, 0
  v_mov_b32 v78, 0
  v_mov_b32 v79, 0
  v_mov_b32 v80, 0
  v_mov_b32 v81, 0
  v_mov_b32 v82, 0
  v_mov_b32 v83, 0
  v_mov_b32 v84, 0
  v_mov_b32 v85, 0
  v_mov_b32 v86, 0
  v_mov_b32 v87, 0
  v_mov_b32 v156, 0
  v_mov_b32 v157, 0
  v_mov_b32 v158, 0
  v_mov_b32 v159, 0
  s_and_b32 s21, s52, 3
  s_mul_i32 s81, s21, 540672
  s_lshl_b32 s84, s21, 15
  s_add_u32 s21, s52, 2
  s_and_b32 s21, s21, 3
  s_mul_i32 s82, s21, 540672
  s_add_u32 s21, s52, 3
  s_and_b32 s21, s21, 3
  s_lshl_b32 s83, s21, 15
  s_add_u32 s21, s52, 1
  s_and_b32 s22, s21, 3
  s_lshl_b32 s3, s22, 15
  s_mul_i32 s80, s21, 393216
  s_add_u32 s46, s21, 1
  s_min_u32 s46, s46, 64
  s_mul_i32 s85, s52, 98304
  s_add_u32 s57, s85, 6291456
  s_bfe_u32 s88, s52, 0x10002
  s_add_u32 s78, s81, 278528
  s_cmp_eq_u32 s53, 0
  s_cbranch_scc1 A1_39
  s_cmp_eq_u32 s20, 0
  s_cbranch_scc1 A1_35
  s_cmp_eq_u32 s20, 1
  s_cbranch_scc1 A1_36
  s_cmp_eq_u32 s20, 2
  s_cbranch_scc1 A1_37
  s_cmp_eq_u32 s20, 3
  s_cbranch_scc1 A1_38
  s_branch A1_39
step_40:
  s_add_u32 s21, s52, 2
  s_and_b32 s21, s21, 3
  s_mul_i32 s82, s21, 540672
  s_add_u32 s21, s52, 3
  s_and_b32 s21, s21, 3
  s_lshl_b32 s83, s21, 15
  s_add_u32 s21, s52, 1
  s_and_b32 s22, s21, 3
  s_lshl_b32 s3, s22, 15
  s_mul_i32 s80, s21, 393216
  s_add_u32 s46, s21, 1
  s_min_u32 s46, s46, 64
  s_mul_i32 s85, s52, 98304
  s_add_u32 s57, s85, 6291456
  s_bfe_u32 s88, s52, 0x10002
  s_add_u32 s78, s81, 278528
  v_mov_b32 v52, 0
  v_mov_b32 v53, 0
  v_mov_b32 v54, 0
  v_mov_b32 v55, 0
  v_mov_b32 v56, 0
  v_mov_b32 v57, 0
  v_mov_b32 v58, 0
  v_mov_b32 v59, 0
  v_mov_b32 v60, 0
  v_mov_b32 v61, 0
  v_mov_b32 v62, 0
  v_mov_b32 v63, 0
  v_mov_b32 v64, 0
  v_mov_b32 v65, 0
  v_mov_b32 v66, 0
  v_mov_b32 v67, 0
  v_mov_b32 v68, 0
  v_mov_b32 v69, 0
  v_mov_b32 v70, 0
  v_mov_b32 v71, 0
  v_mov_b32 v72, 0
  v_mov_b32 v73, 0
  v_mov_b32 v74, 0
  v_mov_b32 v75, 0
  v_mov_b32 v76, 0
  v_mov_b32 v77, 0
  v_mov_b32 v78, 0
  v_mov_b32 v79, 0
  v_mov_b32 v80, 0
  v_mov_b32 v81, 0
  v_mov_b32 v82, 0
  v_mov_b32 v83, 0
  v_mov_b32 v84, 0
  v_mov_b32 v85, 0
  v_mov_b32 v86, 0
  v_mov_b32 v87, 0
  s_sleep 6
  s_mov_b32 s54, 0
  buffer_load_dwordx4 v[96:99], v4, s[4:7], s84 offen offset:0 sc1
  buffer_load_dwordx4 v[100:103], v4, s[4:7], s84 offen offset:1024 sc1
  buffer_load_dwordx4 v[104:107], v4, s[4:7], s84 offen offset:2048 sc1
  s_waitcnt vmcnt(3)
  v_mov_b32 v176, v160
  v_mov_b32 v177, v161
  v_mov_b32 v178, v162
  v_mov_b32 v179, v163
  v_mov_b32 v180, v164
  v_mov_b32 v181, v165
  v_mov_b32 v182, v166
  v_mov_b32 v183, v167
  v_mov_b32 v184, v48
  v_mov_b32 v185, v49
  v_mov_b32 v186, v50
  v_mov_b32 v187, v51
  s_waitcnt vmcnt(0)
  v_bitop3_b32 v27, v99, v103, v107 bitop3:0x80
  v_cvt_f32_f16 v108, v99
  v_and_b32 v27, 0x48000000, v27
  v_cvt_f32_f16 v109, v103
  v_cmp_ne_u32 vcc, 0x48000000, v27
  v_cvt_f32_f16 v110, v106
  v_cvt_f32_f16_sdwa v111, v106 dst_sel:DWORD dst_unused:UNUSED_PAD src0_sel:WORD_1
  v_cvt_pk_bf16_f32 v40, v110, v111
  s_cbranch_vccnz pm_42
pm_43:
  v_cvt_pk_bf16_f32 v41, v108, v109
  v_cvt_f32_f16 v110, v96
  v_cvt_f32_f16_sdwa v111, v96 dst_sel:DWORD dst_unused:UNUSED_PAD src0_sel:WORD_1
  v_smfmac_f32_16x16x32_bf16 v[52:55], v[40:41], a[16:19], v44
  v_cvt_f32_f16 v112, v97
  v_cvt_f32_f16_sdwa v113, v97 dst_sel:DWORD dst_unused:UNUSED_PAD src0_sel:WORD_1
  v_cvt_pk_bf16_f32 v32, v110, v111
  v_smfmac_f32_16x16x32_bf16 v[64:67], v[40:41], a[76:79], v44
  v_cvt_pk_bf16_f32 v33, v112, v113
  v_cvt_f32_f16 v114, v98
  v_cvt_f32_f16_sdwa v115, v98 dst_sel:DWORD dst_unused:UNUSED_PAD src0_sel:WORD_1
  v_smfmac_f32_16x16x32_bf16 v[56:59], v[40:41], a[36:39], v44
  v_cvt_f32_f16 v116, v100
  v_cvt_f32_f16_sdwa v117, v100 dst_sel:DWORD dst_unused:UNUSED_PAD src0_sel:WORD_1
  v_cvt_pk_bf16_f32 v34, v114, v115
  v_smfmac_f32_16x16x32_bf16 v[68:71], v[40:41], a[96:99], v44
  v_cvt_pk_bf16_f32 v35, v116, v117
  v_cvt_f32_f16 v110, v101
  v_cvt_f32_f16_sdwa v111, v101 dst_sel:DWORD dst_unused:UNUSED_PAD src0_sel:WORD_1
  v_smfmac_f32_16x16x32_bf16 v[60:63], v[40:41], a[56:59], v44
  v_cvt_f32_f16 v112, v102
  v_cvt_f32_f16_sdwa v113, v102 dst_sel:DWORD dst_unused:UNUSED_PAD src0_sel:WORD_1
  v_smfmac_f32_16x16x32_bf16 v[72:75], v[40:41], a[116:119], v44
  v_cvt_pk_bf16_f32 v36, v110, v111
  v_cvt_pk_bf16_f32 v37, v112, v113
  v_smfmac_f32_16x16x32_bf16 v[76:79], v[40:41], a[136:139], v44
  v_cvt_f32_f16 v114, v104
  v_cvt_f32_f16_sdwa v115, v104 dst_sel:DWORD dst_unused:UNUSED_PAD src0_sel:WORD_1
  v_smfmac_f32_16x16x32_bf16 v[80:83], v[40:41], a[156:159], v44
  v_cvt_f32_f16 v116, v105
  v_cvt_f32_f16_sdwa v117, v105 dst_sel:DWORD dst_unused:UNUSED_PAD src0_sel:WORD_1
  v_smfmac_f32_16x16x32_bf16 v[84:87], v[40:41], a[176:179], v44
  v_cvt_pk_bf16_f32 v38, v114, v115
  v_cvt_pk_bf16_f32 v39, v116, v117
A2_44:
  v_smfmac_f32_16x16x64_bf16 v[52:55], v[32:35], a[0:7], v44
  v_smfmac_f32_16x16x64_bf16 v[52:55], v[36:39], a[8:15], v44
  v_smfmac_f32_16x16x64_bf16 v[64:67], v[32:35], a[60:67], v44
  v_smfmac_f32_16x16x64_bf16 v[64:67], v[36:39], a[68:75], v44
  v_smfmac_f32_16x16x64_bf16 v[56:59], v[32:35], a[20:27], v44
  v_smfmac_f32_16x16x64_bf16 v[56:59], v[36:39], a[28:35], v44
  v_smfmac_f32_16x16x64_bf16 v[68:71], v[32:35], a[80:87], v44
  v_permlane32_swap_b32 v52, v64
  v_permlane32_swap_b32 v53, v65
  v_permlane32_swap_b32 v54, v66
  v_smfmac_f32_16x16x64_bf16 v[68:71], v[36:39], a[88:95], v44
  v_permlane32_swap_b32 v55, v67
  v_pk_add_f32 v[52:53], v[52:53], v[64:65]
  v_pk_add_f32 v[54:55], v[54:55], v[66:67]
  v_smfmac_f32_16x16x64_bf16 v[60:63], v[32:35], a[40:47], v44
  ds_write2_b32 v5, v52, v53 offset0:0 offset1:4
  ds_write2_b32 v5, v54, v55 offset0:8 offset1:12
  v_smfmac_f32_16x16x64_bf16 v[60:63], v[36:39], a[48:55], v44
  v_smfmac_f32_16x16x64_bf16 v[72:75], v[32:35], a[100:107], v44
  v_permlane32_swap_b32 v56, v68
  v_permlane32_swap_b32 v57, v69
  v_permlane32_swap_b32 v58, v70
  v_smfmac_f32_16x16x64_bf16 v[72:75], v[36:39], a[108:115], v44
  v_permlane32_swap_b32 v59, v71
  v_pk_add_f32 v[56:57], v[56:57], v[68:69]
  v_pk_add_f32 v[58:59], v[58:59], v[70:71]
  v_smfmac_f32_16x16x64_bf16 v[76:79], v[32:35], a[120:127], v44
  ds_write2_b32 v242, v56, v57 offset0:0 offset1:4
  ds_write2_b32 v242, v58, v59 offset0:8 offset1:12
  v_smfmac_f32_16x16x64_bf16 v[76:79], v[36:39], a[128:135], v44
  v_smfmac_f32_16x16x64_bf16 v[80:83], v[32:35], a[140:147], v44
  v_permlane32_swap_b32 v60, v72
  v_permlane32_swap_b32 v61, v73
  v_permlane32_swap_b32 v62, v74
  v_smfmac_f32_16x16x64_bf16 v[80:83], v[36:39], a[148:155], v44
  v_permlane32_swap_b32 v63, v75
  v_pk_add_f32 v[60:61], v[60:61], v[72:73]
  v_pk_add_f32 v[62:63], v[62:63], v[74:75]
  v_smfmac_f32_16x16x64_bf16 v[84:87], v[32:35], a[160:167], v44
  ds_write2_b32 v243, v60, v61 offset0:0 offset1:4
  ds_write2_b32 v243, v62, v63 offset0:8 offset1:12
  v_smfmac_f32_16x16x64_bf16 v[84:87], v[36:39], a[168:175], v44
  v_permlane32_swap_b32 v76, v80
  v_permlane32_swap_b32 v77, v81
  v_permlane32_swap_b32 v78, v82
  v_permlane32_swap_b32 v79, v83
  v_pk_add_f32 v[76:77], v[76:77], v[80:81]
  v_pk_add_f32 v[78:79], v[78:79], v[82:83]
  ds_write2_b32 v244, v76, v77 offset0:0 offset1:4
  ds_write2_b32 v244, v78, v79 offset0:8 offset1:12
  ds_write2_b32 v245, v84, v85 offset0:0 offset1:4
  ds_write2_b32 v245, v86, v87 offset0:8 offset1:12
  s_waitcnt lgkmcnt(0) vmcnt(0)
  s_barrier
  ds_read_b128 v[96:99], v45 offset:0
  ds_read_b128 v[108:111], v45 offset:5440
  ds_read_b128 v[100:103], v45 offset:1088
  ds_read_b128 v[112:115], v45 offset:6528
  ds_read_b128 v[104:107], v45 offset:2176
  ds_read_b128 v[116:119], v45 offset:7616
  s_waitcnt lgkmcnt(4)
  v_pk_add_f32 v[96:97], v[96:97], v[108:109]
  v_pk_add_f32 v[98:99], v[98:99], v[110:111]
  s_nop 0
  v_add_f32_dpp v108, v96, v96 row_ror:8 row_mask:0xf bank_mask:0xf
  v_add_f32_dpp v109, v97, v97 row_ror:8 row_mask:0xf bank_mask:0xf
  v_add_f32_dpp v110, v98, v98 row_ror:8 row_mask:0xf bank_mask:0xf
  v_add_f32_dpp v111, v99, v99 row_ror:8 row_mask:0xf bank_mask:0xf
  v_cvt_pk_bf16_f32 v212, v108, v109
  v_cvt_pk_bf16_f32 v213, v110, v111
  s_waitcnt lgkmcnt(2)
  v_pk_add_f32 v[100:101], v[100:101], v[112:113]
  v_pk_add_f32 v[102:103], v[102:103], v[114:115]
  s_nop 0
  v_add_f32_dpp v112, v100, v100 row_ror:8 row_mask:0xf bank_mask:0xf
  v_add_f32_dpp v113, v101, v101 row_ror:8 row_mask:0xf bank_mask:0xf
  v_add_f32_dpp v114, v102, v102 row_ror:8 row_mask:0xf bank_mask:0xf
  v_add_f32_dpp v115, v103, v103 row_ror:8 row_mask:0xf bank_mask:0xf
  v_cvt_pk_bf16_f32 v214, v112, v113
  v_cvt_pk_bf16_f32 v215, v114, v115
  s_waitcnt lgkmcnt(0)
  v_pk_add_f32 v[104:105], v[104:105], v[116:117]
  v_pk_add_f32 v[106:107], v[106:107], v[118:119]
  v_mfma_f32_16x16x32_bf16 v[96:99], v[168:171], v[212:215], 0
  v_add_f32_dpp v116, v104, v104 row_ror:8 row_mask:0xf bank_mask:0xf
  v_add_f32_dpp v117, v105, v105 row_ror:8 row_mask:0xf bank_mask:0xf
  v_add_f32_dpp v118, v106, v106 row_ror:8 row_mask:0xf bank_mask:0xf
  v_add_f32_dpp v119, v107, v107 row_ror:8 row_mask:0xf bank_mask:0xf
  v_cvt_pk_bf16_f32 v216, v116, v117
  v_cvt_pk_bf16_f32 v217, v118, v119
  s_nop 1
  v_mfma_f32_16x16x32_bf16 v[96:99], v[172:175], v[216:219], v[96:99]
  s_mov_b64 exec, s[74:75]
  s_nop 6
  v_cvt_pk_f16_f32 v100, v96, v97
  v_cvt_pk_f16_f32 v101, v98, v99
  v_and_or_b32 v100, v100, -2, s88
  buffer_store_dwordx2 v[100:101], v7, s[8:11], s81 offen
  s_mov_b64 exec, -1
  s_cmp_eq_u32 s52, 63
  s_cbranch_scc1 last_41
  s_sleep 5
  s_mov_b32 s54, 0
  buffer_load_dwordx2 v[248:249], v9, s[8:11], s81 offen sc1
  buffer_load_dwordx4 v[112:115], v8, s[8:11], s81 offen offset:0 sc1
  buffer_load_dwordx4 v[116:119], v8, s[8:11], s81 offen offset:1024 sc1
  s_sleep 2
  buffer_load_dwordx4 v[144:147], v10, s[8:11], s81 offen offset:0 sc1
  buffer_load_dwordx4 v[148:151], v10, s[8:11], s81 offen offset:1024 sc1
  buffer_load_dwordx4 v[152:155], v10, s[8:11], s81 offen offset:2048 sc1
  v_mov_b32 v188, 0
  v_mov_b32 v189, 0
  v_mov_b32 v190, 0
  v_mov_b32 v191, 0
  v_mov_b32 v192, 0
  v_mov_b32 v193, 0
  v_mov_b32 v194, 0
  v_mov_b32 v195, 0
  v_mov_b32 v196, 0
  v_mov_b32 v197, 0
  v_mov_b32 v198, 0
  v_mov_b32 v199, 0
  v_readfirstlane_b32 s21, v94
  s_add_u32 s22, s46, 8
  s_min_u32 s22, s22, 64
  s_sub_u32 s55, s21, s22
  s_sub_u32 s56, s21, s46
  s_waitcnt vmcnt(5)
  v_xor_b32 v96, s88, v248
  s_nop 0
  v_permlane16_swap_b32 v248, v249
  v_fma_mix_f32 v250, v248, 1.0, v249 op_sel:[0,0,0] op_sel_hi:[1,0,1]
  v_fma_mix_f32 v251, v248, 1.0, v249 op_sel:[1,0,1] op_sel_hi:[1,0,1]
  v_mov_b32 v248, v250
  v_mov_b32 v249, v251
  s_nop 0
  v_permlane32_swap_b32 v248, v250
  v_permlane32_swap_b32 v249, v251
  s_waitcnt vmcnt(3)
  v_bitop3_b32 v97, v112, v114, s88 bitop3:0x7e
  v_bitop3_b32 v98, v116, v118, s88 bitop3:0x7e
  v_fma_mix_f32 v120, v112, 1.0, v116 op_sel:[0,0,0] op_sel_hi:[1,0,1]
  v_or3_b32 v27, v96, v97, v98
  v_fma_mix_f32 v124, v114, 1.0, v118 op_sel:[0,0,0] op_sel_hi:[1,0,1]
  v_and_b32 v27, 1, v27
  v_fma_mix_f32 v121, v112, 1.0, v116 op_sel:[1,0,1] op_sel_hi:[1,0,1]
  v_cmp_ne_u32 vcc, 0, v27
  v_fma_mix_f32 v125, v114, 1.0, v118 op_sel:[1,0,1] op_sel_hi:[1,0,1]
  v_fma_mix_f32 v122, v113, 1.0, v117 op_sel:[0,0,0] op_sel_hi:[1,0,1]
  v_fma_mix_f32 v126, v115, 1.0, v119 op_sel:[0,0,0] op_sel_hi:[1,0,1]
  s_cbranch_vccnz psr_46
psj_47:
  s_cmp_lt_i32 s56, 0
  s_cbranch_scc1 kvw_49
kvok_50:
  v_fma_mix_f32 v123, v113, 1.0, v117 op_sel:[1,0,1] op_sel_hi:[1,0,1]
  v_fma_mix_f32 v127, v115, 1.0, v119 op_sel:[1,0,1] op_sel_hi:[1,0,1]
  v_permlane32_swap_b32 v120, v124
  v_permlane32_swap_b32 v121, v125
  v_permlane32_swap_b32 v122, v126
  v_permlane32_swap_b32 v123, v127
  v_pk_add_f32 v[120:121], v[120:121], v[124:125]
  v_pk_add_f32 v[122:123], v[122:123], v[126:127]
  v_pk_add_f32 v[124:125], v[248:249], v[250:251]
  v_max3_f32 v236, v120, v121, v122
  v_max3_f32 v237, v123, v124, v125
  v_max_f32 v236, v236, v237
  s_nop 1
  v_max_f32_dpp v236, v236, v236 row_ror:8 row_mask:0xf bank_mask:0xf
  v_mov_b32 v237, v236
  s_nop 1
  v_permlane32_swap_b32 v236, v237
  v_max_f32 v236, v236, v237
  v_mov_b32 v237, v236
  s_nop 1
  v_permlane16_swap_b32 v236, v237
  v_max_f32 v236, v236, v237
  s_waitcnt vmcnt(0)
  v_max3_u32 v27, v144, v146, v148
  v_max3_u32 v27, v27, v150, v152
  v_max3_u32 v27, v27, v154, v154
  v_cmp_eq_u32 vcc, -1, v27
  s_nop 1
  s_cbranch_vccnz pv_45
pvj_48:
  v_mul_f32 v236, s86, v236
  v_smfmac_f32_16x16x64_bf16 v[188:191], v[144:147], a[180:187], v44
  v_fma_f32 v120, v120, s86, -v236
  v_smfmac_f32_16x16x64_bf16 v[188:191], v[148:151], a[188:195], v44
  v_fma_f32 v121, v121, s86, -v236
  v_smfmac_f32_16x16x64_bf16 v[188:191], v[152:155], a[196:203], v44
  buffer_load_dwordx4 v[160:163], v16, s[28:31], s64 offen offset:0 sc1
  v_fma_f32 v122, v122, s86, -v236
  v_smfmac_f32_16x16x64_bf16 v[192:195], v[144:147], a[204:211], v44
  v_fma_f32 v123, v123, s86, -v236
  v_smfmac_f32_16x16x64_bf16 v[192:195], v[148:151], a[212:219], v44
  buffer_load_dwordx4 v[164:167], v16, s[28:31], s65 offen offset:1024 sc1
  v_fma_f32 v124, v124, s86, -v236
  v_smfmac_f32_16x16x64_bf16 v[192:195], v[152:155], a[220:227], v44
  v_fma_f32 v125, v125, s86, -v236
  v_smfmac_f32_16x16x64_bf16 v[196:199], v[144:147], a[228:235], v44
  buffer_load_dwordx4 v[48:51], v16, s[28:31], s66 offen offset:2048 sc1
  v_exp_f32 v120, v120
  v_smfmac_f32_16x16x64_bf16 v[196:199], v[148:151], a[236:243], v44
  v_exp_f32 v121, v121
  v_smfmac_f32_16x16x64_bf16 v[196:199], v[152:155], a[244:251], v44
  buffer_load_dwordx2 v[168:169], v18, s[16:19], s80 offen sc1
  v_exp_f32 v122, v122
  buffer_load_dwordx2 v[170:171], v19, s[16:19], s80 offen sc1
  v_exp_f32 v123, v123
  buffer_load_dwordx2 v[172:173], v20, s[16:19], s80 offen sc1
  v_exp_f32 v124, v124
  s_cmp_lt_i32 s55, 0
  s_cbranch_scc1 fl_51
fl_52:
  v_exp_f32 v125, v125
  s_mov_b64 exec, s[60:61]
  v_cvt_pk_bf16_f32 v220, v120, v121
  v_cvt_pk_bf16_f32 v221, v122, v123
  v_cvt_pk_bf16_f32 v224, v124, v125
  s_mov_b64 exec, s[62:63]
  v_cvt_pk_bf16_f32 v222, v120, v121
  v_cvt_pk_bf16_f32 v223, v122, v123
  v_cvt_pk_bf16_f32 v225, v124, v125
  s_mov_b64 exec, -1
  v_pk_add_f32 v[126:127], v[120:121], v[122:123]
  v_add_f32 v128, v124, v125
  v_mfma_f32_16x16x32_bf16 v[200:203], v[176:179], v[220:223], 0
  v_add_f32 v236, v126, v127
  v_fmac_f32 v236, v128, v89
  v_cvt_pk_bf16_f32 v228, v188, v189
  v_cvt_pk_bf16_f32 v229, v190, v191
  v_mfma_f32_16x16x32_bf16 v[204:207], v[180:183], v[220:223], 0
  v_cvt_pk_bf16_f32 v230, v192, v193
  v_cvt_pk_bf16_f32 v231, v194, v195
  v_mfma_f32_16x16x32_bf16 v[208:211], v[184:187], v[220:223], 0
  v_cvt_pk_bf16_f32 v232, v196, v197
  v_cvt_pk_bf16_f32 v233, v198, v199
  v_add_f32_dpp v236, v236, v236 row_ror:8 row_mask:0xf bank_mask:0xf
  v_mov_b32 v237, v236
  s_nop 0
  v_mfma_f32_16x16x32_bf16 v[200:203], v[228:231], v[224:227], v[200:203]
  v_mfma_f32_16x16x32_bf16 v[204:207], v[230:233], v[224:227], v[204:207]
  v_permlane32_swap_b32 v236, v237
  v_add_f32 v236, v236, v237
  v_mov_b32 v237, v236
  v_mfma_f32_16x16x32_bf16 v[208:211], v[232:235], v[224:227], v[208:211]
  s_nop 0
  v_permlane16_swap_b32 v236, v237
  v_add_f32 v236, v236, v237
  v_rcp_f32 v236, v236
  s_nop 2
  v_pk_mul_f32 v[200:201], v[200:201], v[236:237] op_sel_hi:[1,0]
  v_pk_mul_f32 v[202:203], v[202:203], v[236:237] op_sel_hi:[1,0]
  ds_write_b128 v11, v[200:203] offset:0
  v_pk_mul_f32 v[204:205], v[204:205], v[236:237] op_sel_hi:[1,0]
  v_pk_mul_f32 v[206:207], v[206:207], v[236:237] op_sel_hi:[1,0]
  ds_write_b128 v11, v[204:207] offset:1024
  v_pk_mul_f32 v[208:209], v[208:209], v[236:237] op_sel_hi:[1,0]
  v_pk_mul_f32 v[210:211], v[210:211], v[236:237] op_sel_hi:[1,0]
  ds_write_b128 v11, v[208:211] offset:2048
  s_waitcnt lgkmcnt(0)
  s_barrier
  ds_read_b64 v[96:97], v12 offset:0
  ds_read_b64 v[98:99], v12 offset:128
  ds_read_b64 v[100:101], v12 offset:3072
  ds_read_b64 v[102:103], v12 offset:3200
  ds_read_b64 v[104:105], v12 offset:6144
  ds_read_b64 v[106:107], v12 offset:6272
  ds_read_b64 v[108:109], v12 offset:9216
  ds_read_b64 v[110:111], v12 offset:9344
  s_waitcnt lgkmcnt(6)
  v_pk_add_f32 v[96:97], v[96:97], v[98:99]
  s_waitcnt lgkmcnt(4)
  v_pk_add_f32 v[100:101], v[100:101], v[102:103]
  s_waitcnt lgkmcnt(2)
  v_pk_add_f32 v[104:105], v[104:105], v[106:107]
  v_pk_add_f32 v[96:97], v[96:97], v[100:101]
  s_waitcnt lgkmcnt(0)
  v_pk_add_f32 v[108:109], v[108:109], v[110:111]
  v_pk_add_f32 v[96:97], v[96:97], v[104:105]
  v_pk_add_f32 v[96:97], v[96:97], v[108:109]
  v_cvt_pk_f16_f32 v100, v96, v97
  v_perm_b32 v100, s91, v100, v14
  buffer_atomic_pk_add_f16 v100, v13, s[4:7], s3 offen
  s_add_u32 s23, s52, 2
  s_min_u32 s23, s23, 63
  s_sub_u32 s21, s23, 64
  s_mul_i32 s21, s21, 160
  s_add_u32 s21, s21, s89
  s_lshl_b32 s21, s21, 14
  s_add_u32 s64, s21, s67
  s_lshr_b32 s22, s64, 8
  s_xor_b32 s64, s64, s22
  s_xor_b32 s64, s64, s68
  s_and_b32 s64, s64, 8192
  s_add_u32 s64, s64, s21
  s_add_u32 s64, s64, 83886080
  s_mul_i32 s21, s23, 160
  s_add_u32 s21, s21, s89
  s_lshl_b32 s21, s21, 13
  s_cmp_lt_u32 s23, 64
  s_cselect_b32 s64, s21, s64
  s_add_u32 s69, s89, 1
  s_sub_u32 s21, s23, 64
  s_mul_i32 s21, s21, 160
  s_add_u32 s21, s21, s69
  s_lshl_b32 s21, s21, 14
  s_add_u32 s66, s21, s67
  s_lshr_b32 s22, s66, 8
  s_xor_b32 s66, s66, s22
  s_xor_b32 s66, s66, s68
  s_and_b32 s66, s66, 8192
  s_add_u32 s66, s66, s21
  s_add_u32 s66, s66, 83886080
  s_mul_i32 s21, s23, 160
  s_add_u32 s21, s21, s69
  s_lshl_b32 s21, s21, 13
  s_cmp_lt_u32 s23, 64
  s_cselect_b32 s66, s21, s66
  s_lshl_b32 s21, s87, 10
  s_add_u32 s64, s64, s21
  s_add_u32 s66, s66, s21
  s_sub_u32 s66, s66, 8192
  s_cmp_lt_u32 s87, 7
  s_cselect_b32 s65, s64, s66
  s_cmp_lt_u32 s87, 6
  s_cselect_b32 s66, s64, s66
  s_add_u32 s52, s52, 1
  s_and_b32 s21, s52, 3
  s_mul_i32 s81, s21, 540672
  s_lshl_b32 s84, s21, 15
  s_branch step_40
pm_42:
  s_sleep 2
  buffer_load_dwordx4 v[96:99], v4, s[4:7], s84 offen offset:0 sc1
  buffer_load_dwordx4 v[100:103], v4, s[4:7], s84 offen offset:1024 sc1
  buffer_load_dwordx4 v[104:107], v4, s[4:7], s84 offen offset:2048 sc1
  s_add_u32 s54, s54, 1
  s_cmp_gt_u32 s54, 131072
  s_cbranch_scc1 end0
  s_waitcnt vmcnt(0)
  v_bitop3_b32 v27, v99, v103, v107 bitop3:0x80
  v_cvt_f32_f16 v108, v99
  v_and_b32 v27, 0x48000000, v27
  v_cvt_f32_f16 v109, v103
  v_cmp_ne_u32 vcc, 0x48000000, v27
  v_cvt_f32_f16 v110, v106
  v_cvt_f32_f16_sdwa v111, v106 dst_sel:DWORD dst_unused:UNUSED_PAD src0_sel:WORD_1
  v_cvt_pk_bf16_f32 v40, v110, v111
  s_cbranch_vccnz pm_42
  s_branch pm_43
A1_35:
  v_smfmac_f32_16x16x32_bf16 v[52:55], v[40:41], a[16:19], v44
  v_smfmac_f32_16x16x32_bf16 v[64:67], v[40:41], a[76:79], v44
  v_smfmac_f32_16x16x32_bf16 v[56:59], v[40:41], a[36:39], v44
  v_smfmac_f32_16x16x32_bf16 v[68:71], v[40:41], a[96:99], v44
  v_smfmac_f32_16x16x32_bf16 v[60:63], v[40:41], a[56:59], v44
  v_smfmac_f32_16x16x32_bf16 v[72:75], v[40:41], a[116:119], v44
  v_smfmac_f32_16x16x32_bf16 v[76:79], v[40:41], a[136:139], v44
  v_smfmac_f32_16x16x32_bf16 v[80:83], v[40:41], a[156:159], v44
  v_smfmac_f32_16x16x32_bf16 v[84:87], v[40:41], a[176:179], v44
  s_branch A2_44
pv_45:
  buffer_load_dwordx4 v[144:147], v10, s[8:11], s81 offen offset:0 sc1
  buffer_load_dwordx4 v[148:151], v10, s[8:11], s81 offen offset:1024 sc1
  buffer_load_dwordx4 v[152:155], v10, s[8:11], s81 offen offset:2048 sc1
  s_add_u32 s54, s54, 1
  s_cmp_gt_u32 s54, 131072
  s_cbranch_scc1 end0
  s_waitcnt vmcnt(0)
  v_max3_u32 v27, v144, v146, v148
  v_max3_u32 v27, v27, v150, v152
  v_max3_u32 v27, v27, v154, v154
  v_cmp_eq_u32 vcc, -1, v27
  s_nop 1
  s_cbranch_vccnz pv_45
  s_branch pvj_48
psr_46:
  buffer_load_dwordx2 v[248:249], v9, s[8:11], s81 offen sc1
  buffer_load_dwordx4 v[112:115], v8, s[8:11], s81 offen offset:0 sc1
  buffer_load_dwordx4 v[116:119], v8, s[8:11], s81 offen offset:1024 sc1
  s_add_u32 s54, s54, 1
  s_cmp_gt_u32 s54, 131072
  s_cbranch_scc1 end0
  s_waitcnt vmcnt(2)
  v_xor_b32 v96, s88, v248
  s_nop 0
  v_permlane16_swap_b32 v248, v249
  v_fma_mix_f32 v250, v248, 1.0, v249 op_sel:[0,0,0] op_sel_hi:[1,0,1]
  v_fma_mix_f32 v251, v248, 1.0, v249 op_sel:[1,0,1] op_sel_hi:[1,0,1]
  v_mov_b32 v248, v250
  v_mov_b32 v249, v251
  s_nop 0
  v_permlane32_swap_b32 v248, v250
  v_permlane32_swap_b32 v249, v251
  s_waitcnt vmcnt(0)
  v_bitop3_b32 v97, v112, v114, s88 bitop3:0x7e
  v_bitop3_b32 v98, v116, v118, s88 bitop3:0x7e
  v_fma_mix_f32 v120, v112, 1.0, v116 op_sel:[0,0,0] op_sel_hi:[1,0,1]
  v_or3_b32 v27, v96, v97, v98
  v_fma_mix_f32 v124, v114, 1.0, v118 op_sel:[0,0,0] op_sel_hi:[1,0,1]
  v_and_b32 v27, 1, v27
  v_fma_mix_f32 v121, v112, 1.0, v116 op_sel:[1,0,1] op_sel_hi:[1,0,1]
  v_cmp_ne_u32 vcc, 0, v27
  v_fma_mix_f32 v125, v114, 1.0, v118 op_sel:[1,0,1] op_sel_hi:[1,0,1]
  v_fma_mix_f32 v122, v113, 1.0, v117 op_sel:[0,0,0] op_sel_hi:[1,0,1]
  v_fma_mix_f32 v126, v115, 1.0, v119 op_sel:[0,0,0] op_sel_hi:[1,0,1]
  s_cbranch_vccnz psr_46
  s_branch psj_47
kvw_49:
  v_mov_b32 v236, 0
  s_mov_b32 s101, 0
wf_53:
  buffer_load_dword v237, v236, s[12:15], s79 offen sc1
  s_add_u32 s101, s101, 1
  s_cmp_gt_u32 s101, 131072
  s_cbranch_scc1 end0
  s_waitcnt vmcnt(0)
  v_readfirstlane_b32 s100, v237
  s_cmp_ge_u32 s100, s46
  s_cbranch_scc1 wf_54
  s_sleep 1
  s_branch wf_53
wf_54:
  s_branch kvok_50
fl_51:
  buffer_load_dword v94, v95, s[12:15], s79 offen sc1
  s_branch fl_52
last_41:
  v_mov_b32 v246, 80
  v_mov_b32 v247, 1
  s_mov_b64 exec, 1
  buffer_atomic_add v247, v246, s[32:35], 0 offen sc0 sc1
  s_mov_b64 exec, -1
clm_55:
  s_branch chain_done
step_56:
  s_add_u32 s21, s52, 2
  s_and_b32 s21, s21, 3
  s_mul_i32 s82, s21, 540672
  s_add_u32 s21, s52, 3
  s_and_b32 s21, s21, 3
  s_lshl_b32 s83, s21, 15
  s_add_u32 s21, s52, 1
  s_and_b32 s22, s21, 3
  s_lshl_b32 s3, s22, 15
  s_mul_i32 s80, s21, 393216
  s_add_u32 s46, s21, 1
  s_min_u32 s46, s46, 64
  s_mul_i32 s85, s52, 98304
  s_add_u32 s57, s85, 6291456
  s_bfe_u32 s88, s52, 0x10002
  s_add_u32 s78, s81, 278528
  v_mov_b32 v52, 0
  v_mov_b32 v53, 0
  v_mov_b32 v54, 0
  v_mov_b32 v55, 0
  v_mov_b32 v56, 0
  v_mov_b32 v57, 0
  v_mov_b32 v58, 0
  v_mov_b32 v59, 0
  v_mov_b32 v60, 0
  v_mov_b32 v61, 0
  v_mov_b32 v62, 0
  v_mov_b32 v63, 0
  v_mov_b32 v64, 0
  v_mov_b32 v65, 0
  v_mov_b32 v66, 0
  v_mov_b32 v67, 0
  v_mov_b32 v68, 0
  v_mov_b32 v69, 0
  v_mov_b32 v70, 0
  v_mov_b32 v71, 0
  v_mov_b32 v72, 0
  v_mov_b32 v73, 0
  v_mov_b32 v74, 0
  v_mov_b32 v75, 0
  v_mov_b32 v76, 0
  v_mov_b32 v77, 0
  v_mov_b32 v78, 0
  v_mov_b32 v79, 0
  v_mov_b32 v80, 0
  v_mov_b32 v81, 0
  v_mov_b32 v82, 0
  v_mov_b32 v83, 0
  v_mov_b32 v84, 0
  v_mov_b32 v85, 0
  v_mov_b32 v86, 0
  v_mov_b32 v87, 0
  s_sleep 6
  s_mov_b32 s54, 0
  buffer_load_dwordx4 v[96:99], v4, s[4:7], s84 offen offset:0 sc1
  buffer_load_dwordx4 v[100:103], v4, s[4:7], s84 offen offset:1024 sc1
  buffer_load_dwordx4 v[104:107], v4, s[4:7], s84 offen offset:2048 sc1
  s_waitcnt vmcnt(3)
  v_mov_b32 v176, v160
  v_mov_b32 v177, v161
  v_mov_b32 v178, v162
  v_mov_b32 v179, v163
  v_mov_b32 v180, v164
  v_mov_b32 v181, v165
  v_mov_b32 v182, v166
  v_mov_b32 v183, v167
  v_mov_b32 v184, v48
  v_mov_b32 v185, v49
  v_mov_b32 v186, v50
  v_mov_b32 v187, v51
  s_waitcnt vmcnt(0)
  v_bitop3_b32 v27, v99, v103, v107 bitop3:0x80
  v_cvt_f32_f16 v108, v99
  v_and_b32 v27, 0x48000000, v27
  v_cvt_f32_f16 v109, v103
  v_cmp_ne_u32 vcc, 0x48000000, v27
  v_cvt_f32_f16 v110, v106
  v_cvt_f32_f16_sdwa v111, v106 dst_sel:DWORD dst_unused:UNUSED_PAD src0_sel:WORD_1
  v_cvt_pk_bf16_f32 v40, v110, v111
  s_cbranch_vccnz pm_58
pm_59:
  v_cvt_pk_bf16_f32 v41, v108, v109
  v_cvt_f32_f16 v110, v96
  v_cvt_f32_f16_sdwa v111, v96 dst_sel:DWORD dst_unused:UNUSED_PAD src0_sel:WORD_1
  v_smfmac_f32_16x16x32_bf16 v[52:55], v[40:41], a[16:19], v44
  v_cvt_f32_f16 v112, v97
  v_cvt_f32_f16_sdwa v113, v97 dst_sel:DWORD dst_unused:UNUSED_PAD src0_sel:WORD_1
  v_cvt_pk_bf16_f32 v32, v110, v111
  v_smfmac_f32_16x16x32_bf16 v[64:67], v[40:41], a[76:79], v44
  v_cvt_pk_bf16_f32 v33, v112, v113
  v_cvt_f32_f16 v114, v98
  v_cvt_f32_f16_sdwa v115, v98 dst_sel:DWORD dst_unused:UNUSED_PAD src0_sel:WORD_1
  v_smfmac_f32_16x16x32_bf16 v[56:59], v[40:41], a[36:39], v44
  v_cvt_f32_f16 v116, v100
  v_cvt_f32_f16_sdwa v117, v100 dst_sel:DWORD dst_unused:UNUSED_PAD src0_sel:WORD_1
  v_cvt_pk_bf16_f32 v34, v114, v115
  v_smfmac_f32_16x16x32_bf16 v[68:71], v[40:41], a[96:99], v44
  v_cvt_pk_bf16_f32 v35, v116, v117
  v_cvt_f32_f16 v110, v101
  v_cvt_f32_f16_sdwa v111, v101 dst_sel:DWORD dst_unused:UNUSED_PAD src0_sel:WORD_1
  v_smfmac_f32_16x16x32_bf16 v[60:63], v[40:41], a[56:59], v44
  v_cvt_f32_f16 v112, v102
  v_cvt_f32_f16_sdwa v113, v102 dst_sel:DWORD dst_unused:UNUSED_PAD src0_sel:WORD_1
  v_smfmac_f32_16x16x32_bf16 v[72:75], v[40:41], a[116:119], v44
  v_cvt_pk_bf16_f32 v36, v110, v111
  v_cvt_pk_bf16_f32 v37, v112, v113
  v_smfmac_f32_16x16x32_bf16 v[76:79], v[40:41], a[136:139], v44
  v_cvt_f32_f16 v114, v104
  v_cvt_f32_f16_sdwa v115, v104 dst_sel:DWORD dst_unused:UNUSED_PAD src0_sel:WORD_1
  v_smfmac_f32_16x16x32_bf16 v[80:83], v[40:41], a[156:159], v44
  v_cvt_f32_f16 v116, v105
  v_cvt_f32_f16_sdwa v117, v105 dst_sel:DWORD dst_unused:UNUSED_PAD src0_sel:WORD_1
  v_smfmac_f32_16x16x32_bf16 v[84:87], v[40:41], a[176:179], v44
  v_cvt_pk_bf16_f32 v38, v114, v115
  v_cvt_pk_bf16_f32 v39, v116, v117
A2_60:
  v_smfmac_f32_16x16x64_bf16 v[52:55], v[32:35], a[0:7], v44
  v_smfmac_f32_16x16x64_bf16 v[52:55], v[36:39], a[8:15], v44
  v_smfmac_f32_16x16x64_bf16 v[64:67], v[32:35], a[60:67], v44
  v_smfmac_f32_16x16x64_bf16 v[64:67], v[36:39], a[68:75], v44
  v_smfmac_f32_16x16x64_bf16 v[56:59], v[32:35], a[20:27], v44
  v_smfmac_f32_16x16x64_bf16 v[56:59], v[36:39], a[28:35], v44
  v_smfmac_f32_16x16x64_bf16 v[68:71], v[32:35], a[80:87], v44
  v_permlane32_swap_b32 v52, v64
  v_permlane32_swap_b32 v53, v65
  v_permlane32_swap_b32 v54, v66
  v_smfmac_f32_16x16x64_bf16 v[68:71], v[36:39], a[88:95], v44
  v_permlane32_swap_b32 v55, v67
  v_pk_add_f32 v[52:53], v[52:53], v[64:65]
  v_pk_add_f32 v[54:55], v[54:55], v[66:67]
  v_smfmac_f32_16x16x64_bf16 v[60:63], v[32:35], a[40:47], v44
  ds_write2_b32 v5, v52, v53 offset0:0 offset1:4
  ds_write2_b32 v5, v54, v55 offset0:8 offset1:12
  v_smfmac_f32_16x16x64_bf16 v[60:63], v[36:39], a[48:55], v44
  v_smfmac_f32_16x16x64_bf16 v[72:75], v[32:35], a[100:107], v44
  v_permlane32_swap_b32 v56, v68
  v_permlane32_swap_b32 v57, v69
  v_permlane32_swap_b32 v58, v70
  v_smfmac_f32_16x16x64_bf16 v[72:75], v[36:39], a[108:115], v44
  v_permlane32_swap_b32 v59, v71
  v_pk_add_f32 v[56:57], v[56:57], v[68:69]
  v_pk_add_f32 v[58:59], v[58:59], v[70:71]
  v_smfmac_f32_16x16x64_bf16 v[76:79], v[32:35], a[120:127], v44
  ds_write2_b32 v242, v56, v57 offset0:0 offset1:4
  ds_write2_b32 v242, v58, v59 offset0:8 offset1:12
  v_smfmac_f32_16x16x64_bf16 v[76:79], v[36:39], a[128:135], v44
  v_smfmac_f32_16x16x64_bf16 v[80:83], v[32:35], a[140:147], v44
  v_permlane32_swap_b32 v60, v72
  v_permlane32_swap_b32 v61, v73
  v_permlane32_swap_b32 v62, v74
  v_smfmac_f32_16x16x64_bf16 v[80:83], v[36:39], a[148:155], v44
  v_permlane32_swap_b32 v63, v75
  v_pk_add_f32 v[60:61], v[60:61], v[72:73]
  v_pk_add_f32 v[62:63], v[62:63], v[74:75]
  v_smfmac_f32_16x16x64_bf16 v[84:87], v[32:35], a[160:167], v44
  ds_write2_b32 v243, v60, v61 offset0:0 offset1:4
  ds_write2_b32 v243, v62, v63 offset0:8 offset1:12
  v_smfmac_f32_16x16x64_bf16 v[84:87], v[36:39], a[168:175], v44
  v_permlane32_swap_b32 v76, v80
  v_permlane32_swap_b32 v77, v81
  v_permlane32_swap_b32 v78, v82
  v_permlane32_swap_b32 v79, v83
  v_pk_add_f32 v[76:77], v[76:77], v[80:81]
  v_pk_add_f32 v[78:79], v[78:79], v[82:83]
  ds_write2_b32 v244, v76, v77 offset0:0 offset1:4
  ds_write2_b32 v244, v78, v79 offset0:8 offset1:12
  ds_write2_b32 v245, v84, v85 offset0:0 offset1:4
  ds_write2_b32 v245, v86, v87 offset0:8 offset1:12
  s_waitcnt lgkmcnt(0) vmcnt(0)
  s_barrier
  ds_read_b128 v[96:99], v45 offset:0
  ds_read_b128 v[108:111], v45 offset:5440
  ds_read_b128 v[100:103], v45 offset:1088
  ds_read_b128 v[112:115], v45 offset:6528
  ds_read_b128 v[104:107], v45 offset:2176
  ds_read_b128 v[116:119], v45 offset:7616
  s_waitcnt lgkmcnt(4)
  v_pk_add_f32 v[96:97], v[96:97], v[108:109]
  v_pk_add_f32 v[98:99], v[98:99], v[110:111]
  s_nop 0
  v_add_f32_dpp v108, v96, v96 row_ror:8 row_mask:0xf bank_mask:0xf
  v_add_f32_dpp v109, v97, v97 row_ror:8 row_mask:0xf bank_mask:0xf
  v_add_f32_dpp v110, v98, v98 row_ror:8 row_mask:0xf bank_mask:0xf
  v_add_f32_dpp v111, v99, v99 row_ror:8 row_mask:0xf bank_mask:0xf
  v_cvt_pk_bf16_f32 v212, v108, v109
  v_cvt_pk_bf16_f32 v213, v110, v111
  s_waitcnt lgkmcnt(2)
  v_pk_add_f32 v[100:101], v[100:101], v[112:113]
  v_pk_add_f32 v[102:103], v[102:103], v[114:115]
  s_nop 0
  v_add_f32_dpp v112, v100, v100 row_ror:8 row_mask:0xf bank_mask:0xf
  v_add_f32_dpp v113, v101, v101 row_ror:8 row_mask:0xf bank_mask:0xf
  v_add_f32_dpp v114, v102, v102 row_ror:8 row_mask:0xf bank_mask:0xf
  v_add_f32_dpp v115, v103, v103 row_ror:8 row_mask:0xf bank_mask:0xf
  v_cvt_pk_bf16_f32 v214, v112, v113
  v_cvt_pk_bf16_f32 v215, v114, v115
  s_waitcnt lgkmcnt(0)
  v_pk_add_f32 v[104:105], v[104:105], v[116:117]
  v_pk_add_f32 v[106:107], v[106:107], v[118:119]
  v_mfma_f32_16x16x32_bf16 v[96:99], v[168:171], v[212:215], 0
  v_add_f32_dpp v116, v104, v104 row_ror:8 row_mask:0xf bank_mask:0xf
  v_add_f32_dpp v117, v105, v105 row_ror:8 row_mask:0xf bank_mask:0xf
  v_add_f32_dpp v118, v106, v106 row_ror:8 row_mask:0xf bank_mask:0xf
  v_add_f32_dpp v119, v107, v107 row_ror:8 row_mask:0xf bank_mask:0xf
  v_cvt_pk_bf16_f32 v216, v116, v117
  v_cvt_pk_bf16_f32 v217, v118, v119
  s_nop 1
  v_mfma_f32_16x16x32_bf16 v[96:99], v[172:175], v[216:219], v[96:99]
  s_mov_b64 exec, s[74:75]
  s_nop 6
  v_cvt_pk_f16_f32 v100, v96, v97
  v_cvt_pk_f16_f32 v101, v98, v99
  v_and_or_b32 v100, v100, -2, s88
  buffer_store_dwordx2 v[100:101], v7, s[8:11], s81 offen
  s_mov_b64 exec, -1
  s_cmp_eq_u32 s52, 63
  s_cbranch_scc1 last_57
  s_sleep 5
  s_mov_b32 s54, 0
  buffer_load_dwordx2 v[248:249], v9, s[8:11], s81 offen sc1
  buffer_load_dwordx4 v[112:115], v8, s[8:11], s81 offen offset:0 sc1
  buffer_load_dwordx4 v[116:119], v8, s[8:11], s81 offen offset:1024 sc1
  s_sleep 2
  buffer_load_dwordx4 v[144:147], v10, s[8:11], s81 offen offset:0 sc1
  buffer_load_dwordx4 v[148:151], v10, s[8:11], s81 offen offset:1024 sc1
  buffer_load_dwordx4 v[152:155], v10, s[8:11], s81 offen offset:2048 sc1
  v_mov_b32 v188, 0
  v_mov_b32 v189, 0
  v_mov_b32 v190, 0
  v_mov_b32 v191, 0
  v_mov_b32 v192, 0
  v_mov_b32 v193, 0
  v_mov_b32 v194, 0
  v_mov_b32 v195, 0
  v_mov_b32 v196, 0
  v_mov_b32 v197, 0
  v_mov_b32 v198, 0
  v_mov_b32 v199, 0
  v_readfirstlane_b32 s21, v94
  s_add_u32 s22, s46, 8
  s_min_u32 s22, s22, 64
  s_sub_u32 s55, s21, s22
  s_sub_u32 s56, s21, s46
  s_waitcnt vmcnt(5)
  v_xor_b32 v96, s88, v248
  s_nop 0
  v_permlane16_swap_b32 v248, v249
  v_fma_mix_f32 v250, v248, 1.0, v249 op_sel:[0,0,0] op_sel_hi:[1,0,1]
  v_fma_mix_f32 v251, v248, 1.0, v249 op_sel:[1,0,1] op_sel_hi:[1,0,1]
  v_mov_b32 v248, v250
  v_mov_b32 v249, v251
  s_nop 0
  v_permlane32_swap_b32 v248, v250
  v_permlane32_swap_b32 v249, v251
  s_waitcnt vmcnt(3)
  v_bitop3_b32 v97, v112, v114, s88 bitop3:0x7e
  v_bitop3_b32 v98, v116, v118, s88 bitop3:0x7e
  v_fma_mix_f32 v120, v112, 1.0, v116 op_sel:[0,0,0] op_sel_hi:[1,0,1]
  v_or3_b32 v27, v96, v97, v98
  v_fma_mix_f32 v124, v114, 1.0, v118 op_sel:[0,0,0] op_sel_hi:[1,0,1]
  v_and_b32 v27, 1, v27
  v_fma_mix_f32 v121, v112, 1.0, v116 op_sel:[1,0,1] op_sel_hi:[1,0,1]
  v_cmp_ne_u32 vcc, 0, v27
  v_fma_mix_f32 v125, v114, 1.0, v118 op_sel:[1,0,1] op_sel_hi:[1,0,1]
  v_fma_mix_f32 v122, v113, 1.0, v117 op_sel:[0,0,0] op_sel_hi:[1,0,1]
  v_fma_mix_f32 v126, v115, 1.0, v119 op_sel:[0,0,0] op_sel_hi:[1,0,1]
  s_cbranch_vccnz psr_62
psj_63:
  s_cmp_lt_i32 s56, 0
  s_cbranch_scc1 kvw_65
kvok_66:
  v_fma_mix_f32 v123, v113, 1.0, v117 op_sel:[1,0,1] op_sel_hi:[1,0,1]
  v_fma_mix_f32 v127, v115, 1.0, v119 op_sel:[1,0,1] op_sel_hi:[1,0,1]
  v_permlane32_swap_b32 v120, v124
  v_permlane32_swap_b32 v121, v125
  v_permlane32_swap_b32 v122, v126
  v_permlane32_swap_b32 v123, v127
  v_pk_add_f32 v[120:121], v[120:121], v[124:125]
  v_pk_add_f32 v[122:123], v[122:123], v[126:127]
  v_pk_add_f32 v[124:125], v[248:249], v[250:251]
  v_max3_f32 v236, v120, v121, v122
  v_max3_f32 v237, v123, v124, v125
  v_max_f32 v236, v236, v237
  s_nop 1
  v_max_f32_dpp v236, v236, v236 row_ror:8 row_mask:0xf bank_mask:0xf
  v_mov_b32 v237, v236
  s_nop 1
  v_permlane32_swap_b32 v236, v237
  v_max_f32 v236, v236, v237
  v_mov_b32 v237, v236
  s_nop 1
  v_permlane16_swap_b32 v236, v237
  v_max_f32 v236, v236, v237
  s_waitcnt vmcnt(0)
  v_max3_u32 v27, v144, v146, v148
  v_max3_u32 v27, v27, v150, v152
  v_max3_u32 v27, v27, v154, v154
  v_cmp_eq_u32 vcc, -1, v27
  s_nop 1
  s_cbranch_vccnz pv_61
pvj_64:
  v_mul_f32 v236, s86, v236
  v_smfmac_f32_16x16x64_bf16 v[188:191], v[144:147], a[180:187], v44
  v_fma_f32 v120, v120, s86, -v236
  v_smfmac_f32_16x16x64_bf16 v[188:191], v[148:151], a[188:195], v44
  v_fma_f32 v121, v121, s86, -v236
  v_smfmac_f32_16x16x64_bf16 v[188:191], v[152:155], a[196:203], v44
  buffer_load_dwordx4 v[160:163], v16, s[28:31], s64 offen offset:0 sc1
  v_fma_f32 v122, v122, s86, -v236
  v_smfmac_f32_16x16x64_bf16 v[192:195], v[144:147], a[204:211], v44
  v_fma_f32 v123, v123, s86, -v236
  v_smfmac_f32_16x16x64_bf16 v[192:195], v[148:151], a[212:219], v44
  buffer_load_dwordx4 v[164:167], v16, s[28:31], s65 offen offset:1024 sc1
  v_fma_f32 v124, v124, s86, -v236
  v_smfmac_f32_16x16x64_bf16 v[192:195], v[152:155], a[220:227], v44
  v_fma_f32 v125, v125, s86, -v236
  v_smfmac_f32_16x16x64_bf16 v[196:199], v[144:147], a[228:235], v44
  buffer_load_dwordx4 v[48:51], v16, s[28:31], s66 offen offset:2048 sc1
  v_exp_f32 v120, v120
  v_smfmac_f32_16x16x64_bf16 v[196:199], v[148:151], a[236:243], v44
  v_exp_f32 v121, v121
  v_smfmac_f32_16x16x64_bf16 v[196:199], v[152:155], a[244:251], v44
  buffer_load_dwordx2 v[168:169], v18, s[16:19], s80 offen sc1
  v_exp_f32 v122, v122
  buffer_load_dwordx2 v[170:171], v19, s[16:19], s80 offen sc1
  v_exp_f32 v123, v123
  buffer_load_dwordx2 v[172:173], v20, s[16:19], s80 offen sc1
  v_exp_f32 v124, v124
  s_cmp_lt_i32 s55, 0
  s_cbranch_scc1 fl_67
fl_68:
  v_exp_f32 v125, v125
  s_mov_b64 exec, s[60:61]
  v_cvt_pk_bf16_f32 v220, v120, v121
  v_cvt_pk_bf16_f32 v221, v122, v123
  v_cvt_pk_bf16_f32 v224, v124, v125
  s_mov_b64 exec, s[62:63]
  v_cvt_pk_bf16_f32 v222, v120, v121
  v_cvt_pk_bf16_f32 v223, v122, v123
  v_cvt_pk_bf16_f32 v225, v124, v125
  s_mov_b64 exec, -1
  v_pk_add_f32 v[126:127], v[120:121], v[122:123]
  v_add_f32 v128, v124, v125
  v_mfma_f32_16x16x32_bf16 v[200:203], v[176:179], v[220:223], 0
  v_add_f32 v236, v126, v127
  v_fmac_f32 v236, v128, v89
  v_cvt_pk_bf16_f32 v228, v188, v189
  v_cvt_pk_bf16_f32 v229, v190, v191
  v_mfma_f32_16x16x32_bf16 v[204:207], v[180:183], v[220:223], 0
  v_cvt_pk_bf16_f32 v230, v192, v193
  v_cvt_pk_bf16_f32 v231, v194, v195
  v_mfma_f32_16x16x32_bf16 v[208:211], v[184:187], v[220:223], 0
  v_cvt_pk_bf16_f32 v232, v196, v197
  v_cvt_pk_bf16_f32 v233, v198, v199
  v_add_f32_dpp v236, v236, v236 row_ror:8 row_mask:0xf bank_mask:0xf
  v_mov_b32 v237, v236
  s_nop 0
  v_mfma_f32_16x16x32_bf16 v[200:203], v[228:231], v[224:227], v[200:203]
  v_mfma_f32_16x16x32_bf16 v[204:207], v[230:233], v[224:227], v[204:207]
  v_permlane32_swap_b32 v236, v237
  v_add_f32 v236, v236, v237
  v_mov_b32 v237, v236
  v_mfma_f32_16x16x32_bf16 v[208:211], v[232:235], v[224:227], v[208:211]
  s_nop 0
  v_permlane16_swap_b32 v236, v237
  v_add_f32 v236, v236, v237
  v_rcp_f32 v236, v236
  s_nop 2
  v_pk_mul_f32 v[200:201], v[200:201], v[236:237] op_sel_hi:[1,0]
  v_pk_mul_f32 v[202:203], v[202:203], v[236:237] op_sel_hi:[1,0]
  ds_write_b128 v11, v[200:203] offset:0
  v_pk_mul_f32 v[204:205], v[204:205], v[236:237] op_sel_hi:[1,0]
  v_pk_mul_f32 v[206:207], v[206:207], v[236:237] op_sel_hi:[1,0]
  ds_write_b128 v11, v[204:207] offset:1024
  v_pk_mul_f32 v[208:209], v[208:209], v[236:237] op_sel_hi:[1,0]
  v_pk_mul_f32 v[210:211], v[210:211], v[236:237] op_sel_hi:[1,0]
  ds_write_b128 v11, v[208:211] offset:2048
  s_waitcnt lgkmcnt(0)
  s_barrier
  ds_read_b64 v[96:97], v12 offset:0
  ds_read_b64 v[98:99], v12 offset:128
  ds_read_b64 v[100:101], v12 offset:3072
  ds_read_b64 v[102:103], v12 offset:3200
  ds_read_b64 v[104:105], v12 offset:6144
  ds_read_b64 v[106:107], v12 offset:6272
  ds_read_b64 v[108:109], v12 offset:9216
  ds_read_b64 v[110:111], v12 offset:9344
  s_waitcnt lgkmcnt(6)
  v_pk_add_f32 v[96:97], v[96:97], v[98:99]
  s_waitcnt lgkmcnt(4)
  v_pk_add_f32 v[100:101], v[100:101], v[102:103]
  s_waitcnt lgkmcnt(2)
  v_pk_add_f32 v[104:105], v[104:105], v[106:107]
  v_pk_add_f32 v[96:97], v[96:97], v[100:101]
  s_waitcnt lgkmcnt(0)
  v_pk_add_f32 v[108:109], v[108:109], v[110:111]
  v_pk_add_f32 v[96:97], v[96:97], v[104:105]
  v_pk_add_f32 v[96:97], v[96:97], v[108:109]
  v_cvt_pk_f16_f32 v100, v96, v97
  v_perm_b32 v100, s91, v100, v14
  buffer_atomic_pk_add_f16 v100, v13, s[4:7], s3 offen
  s_add_u32 s23, s52, 2
  s_min_u32 s23, s23, 63
  s_sub_u32 s21, s23, 64
  s_mul_i32 s21, s21, 160
  s_add_u32 s21, s21, s89
  s_lshl_b32 s21, s21, 14
  s_add_u32 s64, s21, s67
  s_lshr_b32 s22, s64, 8
  s_xor_b32 s64, s64, s22
  s_xor_b32 s64, s64, s68
  s_and_b32 s64, s64, 8192
  s_add_u32 s64, s64, s21
  s_add_u32 s64, s64, 83886080
  s_mul_i32 s21, s23, 160
  s_add_u32 s21, s21, s89
  s_lshl_b32 s21, s21, 13
  s_cmp_lt_u32 s23, 64
  s_cselect_b32 s64, s21, s64
  s_add_u32 s69, s89, 1
  s_sub_u32 s21, s23, 64
  s_mul_i32 s21, s21, 160
  s_add_u32 s21, s21, s69
  s_lshl_b32 s21, s21, 14
  s_add_u32 s66, s21, s67
  s_lshr_b32 s22, s66, 8
  s_xor_b32 s66, s66, s22
  s_xor_b32 s66, s66, s68
  s_and_b32 s66, s66, 8192
  s_add_u32 s66, s66, s21
  s_add_u32 s66, s66, 83886080
  s_mul_i32 s21, s23, 160
  s_add_u32 s21, s21, s69
  s_lshl_b32 s21, s21, 13
  s_cmp_lt_u32 s23, 64
  s_cselect_b32 s66, s21, s66
  s_lshl_b32 s21, s87, 10
  s_add_u32 s64, s64, s21
  s_add_u32 s66, s66, s21
  s_sub_u32 s66, s66, 8192
  s_cmp_lt_u32 s87, 7
  s_cselect_b32 s65, s64, s66
  s_cmp_lt_u32 s87, 6
  s_cselect_b32 s66, s64, s66
  s_add_u32 s52, s52, 1
  s_and_b32 s21, s52, 3
  s_mul_i32 s81, s21, 540672
  s_lshl_b32 s84, s21, 15
  s_branch step_56
pm_58:
  s_sleep 2
  buffer_load_dwordx4 v[96:99], v4, s[4:7], s84 offen offset:0 sc1
  buffer_load_dwordx4 v[100:103], v4, s[4:7], s84 offen offset:1024 sc1
  buffer_load_dwordx4 v[104:107], v4, s[4:7], s84 offen offset:2048 sc1
  s_add_u32 s54, s54, 1
  s_cmp_gt_u32 s54, 131072
  s_cbranch_scc1 end0
  s_waitcnt vmcnt(0)
  v_bitop3_b32 v27, v99, v103, v107 bitop3:0x80
  v_cvt_f32_f16 v108, v99
  v_and_b32 v27, 0x48000000, v27
  v_cvt_f32_f16 v109, v103
  v_cmp_ne_u32 vcc, 0x48000000, v27
  v_cvt_f32_f16 v110, v106
  v_cvt_f32_f16_sdwa v111, v106 dst_sel:DWORD dst_unused:UNUSED_PAD src0_sel:WORD_1
  v_cvt_pk_bf16_f32 v40, v110, v111
  s_cbranch_vccnz pm_58
  s_branch pm_59
A1_36:
  v_smfmac_f32_16x16x32_bf16 v[52:55], v[40:41], a[16:19], v44
  v_smfmac_f32_16x16x32_bf16 v[64:67], v[40:41], a[76:79], v44
  v_smfmac_f32_16x16x32_bf16 v[56:59], v[40:41], a[36:39], v44
  v_smfmac_f32_16x16x32_bf16 v[68:71], v[40:41], a[96:99], v44
  v_smfmac_f32_16x16x32_bf16 v[60:63], v[40:41], a[56:59], v44
  v_smfmac_f32_16x16x32_bf16 v[72:75], v[40:41], a[116:119], v44
  v_smfmac_f32_16x16x32_bf16 v[76:79], v[40:41], a[136:139], v44
  v_smfmac_f32_16x16x32_bf16 v[80:83], v[40:41], a[156:159], v44
  v_smfmac_f32_16x16x32_bf16 v[84:87], v[40:41], a[176:179], v44
  s_branch A2_60
pv_61:
  buffer_load_dwordx4 v[144:147], v10, s[8:11], s81 offen offset:0 sc1
  buffer_load_dwordx4 v[148:151], v10, s[8:11], s81 offen offset:1024 sc1
  buffer_load_dwordx4 v[152:155], v10, s[8:11], s81 offen offset:2048 sc1
  s_add_u32 s54, s54, 1
  s_cmp_gt_u32 s54, 131072
  s_cbranch_scc1 end0
  s_waitcnt vmcnt(0)
  v_max3_u32 v27, v144, v146, v148
  v_max3_u32 v27, v27, v150, v152
  v_max3_u32 v27, v27, v154, v154
  v_cmp_eq_u32 vcc, -1, v27
  s_nop 1
  s_cbranch_vccnz pv_61
  s_branch pvj_64
psr_62:
  buffer_load_dwordx2 v[248:249], v9, s[8:11], s81 offen sc1
  buffer_load_dwordx4 v[112:115], v8, s[8:11], s81 offen offset:0 sc1
  buffer_load_dwordx4 v[116:119], v8, s[8:11], s81 offen offset:1024 sc1
  s_add_u32 s54, s54, 1
  s_cmp_gt_u32 s54, 131072
  s_cbranch_scc1 end0
  s_waitcnt vmcnt(2)
  v_xor_b32 v96, s88, v248
  s_nop 0
  v_permlane16_swap_b32 v248, v249
  v_fma_mix_f32 v250, v248, 1.0, v249 op_sel:[0,0,0] op_sel_hi:[1,0,1]
  v_fma_mix_f32 v251, v248, 1.0, v249 op_sel:[1,0,1] op_sel_hi:[1,0,1]
  v_mov_b32 v248, v250
  v_mov_b32 v249, v251
  s_nop 0
  v_permlane32_swap_b32 v248, v250
  v_permlane32_swap_b32 v249, v251
  s_waitcnt vmcnt(0)
  v_bitop3_b32 v97, v112, v114, s88 bitop3:0x7e
  v_bitop3_b32 v98, v116, v118, s88 bitop3:0x7e
  v_fma_mix_f32 v120, v112, 1.0, v116 op_sel:[0,0,0] op_sel_hi:[1,0,1]
  v_or3_b32 v27, v96, v97, v98
  v_fma_mix_f32 v124, v114, 1.0, v118 op_sel:[0,0,0] op_sel_hi:[1,0,1]
  v_and_b32 v27, 1, v27
  v_fma_mix_f32 v121, v112, 1.0, v116 op_sel:[1,0,1] op_sel_hi:[1,0,1]
  v_cmp_ne_u32 vcc, 0, v27
  v_fma_mix_f32 v125, v114, 1.0, v118 op_sel:[1,0,1] op_sel_hi:[1,0,1]
  v_fma_mix_f32 v122, v113, 1.0, v117 op_sel:[0,0,0] op_sel_hi:[1,0,1]
  v_fma_mix_f32 v126, v115, 1.0, v119 op_sel:[0,0,0] op_sel_hi:[1,0,1]
  s_cbranch_vccnz psr_62
  s_branch psj_63
kvw_65:
  v_mov_b32 v236, 0
  s_mov_b32 s101, 0
wf_69:
  buffer_load_dword v237, v236, s[12:15], s79 offen sc1
  s_add_u32 s101, s101, 1
  s_cmp_gt_u32 s101, 131072
  s_cbranch_scc1 end0
  s_waitcnt vmcnt(0)
  v_readfirstlane_b32 s100, v237
  s_cmp_ge_u32 s100, s46
  s_cbranch_scc1 wf_70
  s_sleep 1
  s_branch wf_69
wf_70:
  s_branch kvok_66
fl_67:
  buffer_load_dword v94, v95, s[12:15], s79 offen sc1
  s_branch fl_68
last_57:
  s_branch chain_done
step_71:
  s_add_u32 s21, s52, 2
  s_and_b32 s21, s21, 3
  s_mul_i32 s82, s21, 540672
  s_add_u32 s21, s52, 3
  s_and_b32 s21, s21, 3
  s_lshl_b32 s83, s21, 15
  s_add_u32 s21, s52, 1
  s_and_b32 s22, s21, 3
  s_lshl_b32 s3, s22, 15
  s_mul_i32 s80, s21, 393216
  s_add_u32 s46, s21, 1
  s_min_u32 s46, s46, 64
  s_mul_i32 s85, s52, 98304
  s_add_u32 s57, s85, 6291456
  s_bfe_u32 s88, s52, 0x10002
  s_add_u32 s78, s81, 278528
  v_mov_b32 v52, 0
  v_mov_b32 v53, 0
  v_mov_b32 v54, 0
  v_mov_b32 v55, 0
  v_mov_b32 v56, 0
  v_mov_b32 v57, 0
  v_mov_b32 v58, 0
  v_mov_b32 v59, 0
  v_mov_b32 v60, 0
  v_mov_b32 v61, 0
  v_mov_b32 v62, 0
  v_mov_b32 v63, 0
  v_mov_b32 v64, 0
  v_mov_b32 v65, 0
  v_mov_b32 v66, 0
  v_mov_b32 v67, 0
  v_mov_b32 v68, 0
  v_mov_b32 v69, 0
  v_mov_b32 v70, 0
  v_mov_b32 v71, 0
  v_mov_b32 v72, 0
  v_mov_b32 v73, 0
  v_mov_b32 v74, 0
  v_mov_b32 v75, 0
  v_mov_b32 v76, 0
  v_mov_b32 v77, 0
  v_mov_b32 v78, 0
  v_mov_b32 v79, 0
  v_mov_b32 v80, 0
  v_mov_b32 v81, 0
  v_mov_b32 v82, 0
  v_mov_b32 v83, 0
  v_mov_b32 v84, 0
  v_mov_b32 v85, 0
  v_mov_b32 v86, 0
  v_mov_b32 v87, 0
  s_sleep 6
  s_mov_b32 s54, 0
  buffer_load_dwordx4 v[96:99], v4, s[4:7], s84 offen offset:0 sc1
  buffer_load_dwordx4 v[100:103], v4, s[4:7], s84 offen offset:1024 sc1
  buffer_load_dwordx4 v[104:107], v4, s[4:7], s84 offen offset:2048 sc1
  s_waitcnt vmcnt(3)
  v_mov_b32 v176, v160
  v_mov_b32 v177, v161
  v_mov_b32 v178, v162
  v_mov_b32 v179, v163
  v_mov_b32 v180, v164
  v_mov_b32 v181, v165
  v_mov_b32 v182, v166
  v_mov_b32 v183, v167
  v_mov_b32 v184, v48
  v_mov_b32 v185, v49
  v_mov_b32 v186, v50
  v_mov_b32 v187, v51
  s_waitcnt vmcnt(0)
  v_bitop3_b32 v27, v99, v103, v107 bitop3:0x80
  v_cvt_f32_f16 v108, v99
  v_and_b32 v27, 0x48000000, v27
  v_cvt_f32_f16 v109, v103
  v_cmp_ne_u32 vcc, 0x48000000, v27
  v_cvt_f32_f16 v110, v106
  v_cvt_f32_f16_sdwa v111, v106 dst_sel:DWORD dst_unused:UNUSED_PAD src0_sel:WORD_1
  v_cvt_pk_bf16_f32 v40, v110, v111
  s_cbranch_vccnz pm_73
pm_74:
  v_cvt_pk_bf16_f32 v41, v108, v109
  v_cvt_f32_f16 v110, v96
  v_cvt_f32_f16_sdwa v111, v96 dst_sel:DWORD dst_unused:UNUSED_PAD src0_sel:WORD_1
  v_smfmac_f32_16x16x32_bf16 v[52:55], v[40:41], a[16:19], v44
  v_cvt_f32_f16 v112, v97
  v_cvt_f32_f16_sdwa v113, v97 dst_sel:DWORD dst_unused:UNUSED_PAD src0_sel:WORD_1
  v_cvt_pk_bf16_f32 v32, v110, v111
  v_smfmac_f32_16x16x32_bf16 v[64:67], v[40:41], a[76:79], v44
  v_cvt_pk_bf16_f32 v33, v112, v113
  v_cvt_f32_f16 v114, v98
  v_cvt_f32_f16_sdwa v115, v98 dst_sel:DWORD dst_unused:UNUSED_PAD src0_sel:WORD_1
  v_smfmac_f32_16x16x32_bf16 v[56:59], v[40:41], a[36:39], v44
  v_cvt_f32_f16 v116, v100
  v_cvt_f32_f16_sdwa v117, v100 dst_sel:DWORD dst_unused:UNUSED_PAD src0_sel:WORD_1
  v_cvt_pk_bf16_f32 v34, v114, v115
  v_smfmac_f32_16x16x32_bf16 v[68:71], v[40:41], a[96:99], v44
  v_cvt_pk_bf16_f32 v35, v116, v117
  v_cvt_f32_f16 v110, v101
  v_cvt_f32_f16_sdwa v111, v101 dst_sel:DWORD dst_unused:UNUSED_PAD src0_sel:WORD_1
  v_smfmac_f32_16x16x32_bf16 v[60:63], v[40:41], a[56:59], v44
  v_cvt_f32_f16 v112, v102
  v_cvt_f32_f16_sdwa v113, v102 dst_sel:DWORD dst_unused:UNUSED_PAD src0_sel:WORD_1
  v_smfmac_f32_16x16x32_bf16 v[72:75], v[40:41], a[116:119], v44
  v_cvt_pk_bf16_f32 v36, v110, v111
  v_cvt_pk_bf16_f32 v37, v112, v113
  v_smfmac_f32_16x16x32_bf16 v[76:79], v[40:41], a[136:139], v44
  v_cvt_f32_f16 v114, v104
  v_cvt_f32_f16_sdwa v115, v104 dst_sel:DWORD dst_unused:UNUSED_PAD src0_sel:WORD_1
  v_smfmac_f32_16x16x32_bf16 v[80:83], v[40:41], a[156:159], v44
  v_cvt_f32_f16 v116, v105
  v_cvt_f32_f16_sdwa v117, v105 dst_sel:DWORD dst_unused:UNUSED_PAD src0_sel:WORD_1
  v_smfmac_f32_16x16x32_bf16 v[84:87], v[40:41], a[176:179], v44
  v_cvt_pk_bf16_f32 v38, v114, v115
  v_cvt_pk_bf16_f32 v39, v116, v117
A2_75:
  v_smfmac_f32_16x16x64_bf16 v[52:55], v[32:35], a[0:7], v44
  v_smfmac_f32_16x16x64_bf16 v[52:55], v[36:39], a[8:15], v44
  v_smfmac_f32_16x16x64_bf16 v[64:67], v[32:35], a[60:67], v44
  v_smfmac_f32_16x16x64_bf16 v[64:67], v[36:39], a[68:75], v44
  v_smfmac_f32_16x16x64_bf16 v[56:59], v[32:35], a[20:27], v44
  v_smfmac_f32_16x16x64_bf16 v[56:59], v[36:39], a[28:35], v44
  v_smfmac_f32_16x16x64_bf16 v[68:71], v[32:35], a[80:87], v44
  v_permlane32_swap_b32 v52, v64
  v_permlane32_swap_b32 v53, v65
  v_permlane32_swap_b32 v54, v66
  v_smfmac_f32_16x16x64_bf16 v[68:71], v[36:39], a[88:95], v44
  v_permlane32_swap_b32 v55, v67
  v_pk_add_f32 v[52:53], v[52:53], v[64:65]
  v_pk_add_f32 v[54:55], v[54:55], v[66:67]
  v_smfmac_f32_16x16x64_bf16 v[60:63], v[32:35], a[40:47], v44
  ds_write2_b32 v5, v52, v53 offset0:0 offset1:4
  ds_write2_b32 v5, v54, v55 offset0:8 offset1:12
  v_smfmac_f32_16x16x64_bf16 v[60:63], v[36:39], a[48:55], v44
  v_smfmac_f32_16x16x64_bf16 v[72:75], v[32:35], a[100:107], v44
  v_permlane32_swap_b32 v56, v68
  v_permlane32_swap_b32 v57, v69
  v_permlane32_swap_b32 v58, v70
  v_smfmac_f32_16x16x64_bf16 v[72:75], v[36:39], a[108:115], v44
  v_permlane32_swap_b32 v59, v71
  v_pk_add_f32 v[56:57], v[56:57], v[68:69]
  v_pk_add_f32 v[58:59], v[58:59], v[70:71]
  v_smfmac_f32_16x16x64_bf16 v[76:79], v[32:35], a[120:127], v44
  ds_write2_b32 v242, v56, v57 offset0:0 offset1:4
  ds_write2_b32 v242, v58, v59 offset0:8 offset1:12
  v_smfmac_f32_16x16x64_bf16 v[76:79], v[36:39], a[128:135], v44
  v_smfmac_f32_16x16x64_bf16 v[80:83], v[32:35], a[140:147], v44
  v_permlane32_swap_b32 v60, v72
  v_permlane32_swap_b32 v61, v73
  v_permlane32_swap_b32 v62, v74
  v_smfmac_f32_16x16x64_bf16 v[80:83], v[36:39], a[148:155], v44
  v_permlane32_swap_b32 v63, v75
  v_pk_add_f32 v[60:61], v[60:61], v[72:73]
  v_pk_add_f32 v[62:63], v[62:63], v[74:75]
  v_smfmac_f32_16x16x64_bf16 v[84:87], v[32:35], a[160:167], v44
  ds_write2_b32 v243, v60, v61 offset0:0 offset1:4
  ds_write2_b32 v243, v62, v63 offset0:8 offset1:12
  v_smfmac_f32_16x16x64_bf16 v[84:87], v[36:39], a[168:175], v44
  v_permlane32_swap_b32 v76, v80
  v_permlane32_swap_b32 v77, v81
  v_permlane32_swap_b32 v78, v82
  v_permlane32_swap_b32 v79, v83
  v_pk_add_f32 v[76:77], v[76:77], v[80:81]
  v_pk_add_f32 v[78:79], v[78:79], v[82:83]
  ds_write2_b32 v244, v76, v77 offset0:0 offset1:4
  ds_write2_b32 v244, v78, v79 offset0:8 offset1:12
  ds_write2_b32 v245, v84, v85 offset0:0 offset1:4
  ds_write2_b32 v245, v86, v87 offset0:8 offset1:12
  s_waitcnt lgkmcnt(0) vmcnt(0)
  s_barrier
  ds_read_b128 v[96:99], v6 offset:0
  ds_read_b128 v[108:111], v6 offset:5440
  ds_read_b128 v[120:123], v6 offset:10880
  ds_read_b128 v[132:135], v6 offset:16320
  ds_read_b128 v[100:103], v6 offset:1088
  ds_read_b128 v[112:115], v6 offset:6528
  ds_read_b128 v[124:127], v6 offset:11968
  ds_read_b128 v[136:139], v6 offset:17408
  ds_read_b128 v[104:107], v6 offset:2176
  ds_read_b128 v[116:119], v6 offset:7616
  ds_read_b128 v[128:131], v6 offset:13056
  ds_read_b128 v[140:143], v6 offset:18496
  s_waitcnt lgkmcnt(8)
  v_pk_add_f32 v[96:97], v[96:97], v[108:109]
  v_pk_add_f32 v[120:121], v[120:121], v[132:133]
  v_pk_add_f32 v[98:99], v[98:99], v[110:111]
  v_pk_add_f32 v[122:123], v[122:123], v[134:135]
  v_pk_add_f32 v[96:97], v[96:97], v[120:121]
  v_pk_add_f32 v[98:99], v[98:99], v[122:123]
  v_cvt_pk_bf16_f32 v212, v96, v97
  v_cvt_pk_bf16_f32 v213, v98, v99
  s_waitcnt lgkmcnt(4)
  v_pk_add_f32 v[100:101], v[100:101], v[112:113]
  v_pk_add_f32 v[124:125], v[124:125], v[136:137]
  v_pk_add_f32 v[102:103], v[102:103], v[114:115]
  v_pk_add_f32 v[126:127], v[126:127], v[138:139]
  v_pk_add_f32 v[100:101], v[100:101], v[124:125]
  v_pk_add_f32 v[102:103], v[102:103], v[126:127]
  v_cvt_pk_bf16_f32 v214, v100, v101
  v_cvt_pk_bf16_f32 v215, v102, v103
  s_waitcnt lgkmcnt(0)
  v_pk_add_f32 v[104:105], v[104:105], v[116:117]
  v_pk_add_f32 v[128:129], v[128:129], v[140:141]
  v_pk_add_f32 v[106:107], v[106:107], v[118:119]
  v_pk_add_f32 v[130:131], v[130:131], v[142:143]
  v_mfma_f32_16x16x32_bf16 v[96:99], v[212:215], v[212:215], 0
  v_pk_add_f32 v[104:105], v[104:105], v[128:129]
  v_pk_add_f32 v[106:107], v[106:107], v[130:131]
  v_cvt_pk_bf16_f32 v216, v104, v105
  v_cvt_pk_bf16_f32 v217, v106, v107
  s_nop 1
  v_mfma_f32_16x16x32_bf16 v[96:99], v[216:219], v[216:219], v[96:99]
  s_mov_b64 exec, s[74:75]
  s_nop 6
  v_cvt_pk_f16_f32 v100, v96, v97
  v_cvt_pk_f16_f32 v101, v98, v99
  v_and_or_b32 v100, v100, -2, s88
  buffer_store_dwordx2 v[100:101], v7, s[8:11], s81 offen
  s_mov_b64 exec, -1
  s_cmp_eq_u32 s52, 63
  s_cbranch_scc1 last_72
  s_sleep 4
  s_mov_b32 s54, 0
  buffer_load_dwordx2 v[248:249], v9, s[8:11], s81 offen sc1
  buffer_load_dwordx4 v[112:115], v8, s[8:11], s81 offen offset:0 sc1
  buffer_load_dwordx4 v[116:119], v8, s[8:11], s81 offen offset:1024 sc1
  s_sleep 2
  buffer_load_dwordx4 v[144:147], v10, s[8:11], s81 offen offset:0 sc1
  buffer_load_dwordx4 v[148:151], v10, s[8:11], s81 offen offset:1024 sc1
  buffer_load_dwordx4 v[152:155], v10, s[8:11], s81 offen offset:2048 sc1
  v_mov_b32 v188, 0
  v_mov_b32 v189, 0
  v_mov_b32 v190, 0
  v_mov_b32 v191, 0
  v_mov_b32 v192, 0
  v_mov_b32 v193, 0
  v_mov_b32 v194, 0
  v_mov_b32 v195, 0
  v_mov_b32 v196, 0
  v_mov_b32 v197, 0
  v_mov_b32 v198, 0
  v_mov_b32 v199, 0
  v_readfirstlane_b32 s21, v94
  s_add_u32 s22, s46, 8
  s_min_u32 s22, s22, 64
  s_sub_u32 s55, s21, s22
  s_sub_u32 s56, s21, s46
  s_waitcnt vmcnt(5)
  v_xor_b32 v96, s88, v248
  s_nop 0
  v_permlane16_swap_b32 v248, v249
  v_fma_mix_f32 v250, v248, 1.0, v249 op_sel:[0,0,0] op_sel_hi:[1,0,1]
  v_fma_mix_f32 v251, v248, 1.0, v249 op_sel:[1,0,1] op_sel_hi:[1,0,1]
  v_mov_b32 v248, v250
  v_mov_b32 v249, v251
  s_nop 0
  v_permlane32_swap_b32 v248, v250
  v_permlane32_swap_b32 v249, v251
  s_waitcnt vmcnt(3)
  v_bitop3_b32 v97, v112, v114, s88 bitop3:0x7e
  v_bitop3_b32 v98, v116, v118, s88 bitop3:0x7e
  v_fma_mix_f32 v120, v112, 1.0, v116 op_sel:[0,0,0] op_sel_hi:[1,0,1]
  v_or3_b32 v27, v96, v97, v98
  v_fma_mix_f32 v124, v114, 1.0, v118 op_sel:[0,0,0] op_sel_hi:[1,0,1]
  v_and_b32 v27, 1, v27
  v_fma_mix_f32 v121, v112, 1.0, v116 op_sel:[1,0,1] op_sel_hi:[1,0,1]
  v_cmp_ne_u32 vcc, 0, v27
  v_fma_mix_f32 v125, v114, 1.0, v118 op_sel:[1,0,1] op_sel_hi:[1,0,1]
  v_fma_mix_f32 v122, v113, 1.0, v117 op_sel:[0,0,0] op_sel_hi:[1,0,1]
  v_fma_mix_f32 v126, v115, 1.0, v119 op_sel:[0,0,0] op_sel_hi:[1,0,1]
  s_cbranch_vccnz psr_77
psj_78:
  s_cmp_lt_i32 s56, 0
  s_cbranch_scc1 kvw_80
kvok_81:
  v_fma_mix_f32 v123, v113, 1.0, v117 op_sel:[1,0,1] op_sel_hi:[1,0,1]
  v_fma_mix_f32 v127, v115, 1.0, v119 op_sel:[1,0,1] op_sel_hi:[1,0,1]
  v_permlane32_swap_b32 v120, v124
  v_permlane32_swap_b32 v121, v125
  v_permlane32_swap_b32 v122, v126
  v_permlane32_swap_b32 v123, v127
  v_pk_add_f32 v[120:121], v[120:121], v[124:125]
  v_pk_add_f32 v[122:123], v[122:123], v[126:127]
  v_pk_add_f32 v[124:125], v[248:249], v[250:251]
  v_max3_f32 v236, v120, v121, v122
  v_max3_f32 v237, v123, v124, v125
  v_max_f32 v236, v236, v237
  s_nop 1
  v_max_f32_dpp v236, v236, v236 row_ror:8 row_mask:0xf bank_mask:0xf
  v_mov_b32 v237, v236
  s_nop 1
  v_permlane32_swap_b32 v236, v237
  v_max_f32 v236, v236, v237
  v_mov_b32 v237, v236
  s_nop 1
  v_permlane16_swap_b32 v236, v237
  v_max_f32 v236, v236, v237
  s_waitcnt vmcnt(0)
  v_max3_u32 v27, v144, v146, v148
  v_max3_u32 v27, v27, v150, v152
  v_max3_u32 v27, v27, v154, v154
  v_cmp_eq_u32 vcc, -1, v27
  s_nop 1
  s_cbranch_vccnz pv_76
pvj_79:
  v_mul_f32 v236, s86, v236
  v_smfmac_f32_16x16x64_bf16 v[188:191], v[144:147], a[180:187], v44
  v_fma_f32 v120, v120, s86, -v236
  v_smfmac_f32_16x16x64_bf16 v[188:191], v[148:151], a[188:195], v44
  v_fma_f32 v121, v121, s86, -v236
  v_smfmac_f32_16x16x64_bf16 v[188:191], v[152:155], a[196:203], v44
  buffer_load_dwordx4 v[160:163], v16, s[28:31], s64 offen offset:0 sc1
  v_fma_f32 v122, v122, s86, -v236
  v_smfmac_f32_16x16x64_bf16 v[192:195], v[144:147], a[204:211], v44
  v_fma_f32 v123, v123, s86, -v236
  v_smfmac_f32_16x16x64_bf16 v[192:195], v[148:151], a[212:219], v44
  buffer_load_dwordx4 v[164:167], v16, s[28:31], s65 offen offset:1024 sc1
  v_fma_f32 v124, v124, s86, -v236
  v_smfmac_f32_16x16x64_bf16 v[192:195], v[152:155], a[220:227], v44
  v_fma_f32 v125, v125, s86, -v236
  v_smfmac_f32_16x16x64_bf16 v[196:199], v[144:147], a[228:235], v44
  buffer_load_dwordx4 v[48:51], v16, s[28:31], s66 offen offset:2048 sc1
  v_exp_f32 v120, v120
  v_smfmac_f32_16x16x64_bf16 v[196:199], v[148:151], a[236:243], v44
  v_exp_f32 v121, v121
  v_smfmac_f32_16x16x64_bf16 v[196:199], v[152:155], a[244:251], v44
  s_mov_b64 exec, s[62:63]
  buffer_store_dwordx2 v[212:213], v21, s[24:27], s85 offen sc1
  s_mov_b64 exec, -1
  v_exp_f32 v122, v122
  s_mov_b64 exec, s[62:63]
  buffer_store_dwordx2 v[214:215], v22, s[24:27], s85 offen sc1
  s_mov_b64 exec, -1
  v_exp_f32 v123, v123
  s_mov_b64 exec, s[62:63]
  buffer_store_dwordx2 v[216:217], v23, s[24:27], s85 offen sc1
  s_mov_b64 exec, -1
  v_exp_f32 v124, v124
  s_cmp_lt_i32 s55, 0
  s_cbranch_scc1 fl_82
fl_83:
  v_exp_f32 v125, v125
  s_mov_b64 exec, s[60:61]
  v_cvt_pk_bf16_f32 v220, v120, v121
  v_cvt_pk_bf16_f32 v221, v122, v123
  v_cvt_pk_bf16_f32 v224, v124, v125
  s_mov_b64 exec, s[62:63]
  v_cvt_pk_bf16_f32 v222, v120, v121
  v_cvt_pk_bf16_f32 v223, v122, v123
  v_cvt_pk_bf16_f32 v225, v124, v125
  s_mov_b64 exec, -1
  v_pk_add_f32 v[126:127], v[120:121], v[122:123]
  v_add_f32 v128, v124, v125
  v_mfma_f32_16x16x32_bf16 v[200:203], v[176:179], v[220:223], 0
  v_add_f32 v236, v126, v127
  v_fmac_f32 v236, v128, v89
  v_cvt_pk_bf16_f32 v228, v188, v189
  v_cvt_pk_bf16_f32 v229, v190, v191
  v_mfma_f32_16x16x32_bf16 v[204:207], v[180:183], v[220:223], 0
  v_cvt_pk_bf16_f32 v230, v192, v193
  v_cvt_pk_bf16_f32 v231, v194, v195
  v_mfma_f32_16x16x32_bf16 v[208:211], v[184:187], v[220:223], 0
  v_cvt_pk_bf16_f32 v232, v196, v197
  v_cvt_pk_bf16_f32 v233, v198, v199
  v_add_f32_dpp v236, v236, v236 row_ror:8 row_mask:0xf bank_mask:0xf
  v_mov_b32 v237, v236
  s_nop 0
  v_mfma_f32_16x16x32_bf16 v[200:203], v[228:231], v[224:227], v[200:203]
  v_mfma_f32_16x16x32_bf16 v[204:207], v[230:233], v[224:227], v[204:207]
  v_permlane32_swap_b32 v236, v237
  v_add_f32 v236, v236, v237
  v_mov_b32 v237, v236
  v_mfma_f32_16x16x32_bf16 v[208:211], v[232:235], v[224:227], v[208:211]
  s_nop 0
  v_permlane16_swap_b32 v236, v237
  v_add_f32 v236, v236, v237
  v_rcp_f32 v236, v236
  s_nop 2
  v_pk_mul_f32 v[200:201], v[200:201], v[236:237] op_sel_hi:[1,0]
  v_pk_mul_f32 v[202:203], v[202:203], v[236:237] op_sel_hi:[1,0]
  ds_write_b128 v11, v[200:203] offset:0
  v_pk_mul_f32 v[204:205], v[204:205], v[236:237] op_sel_hi:[1,0]
  v_pk_mul_f32 v[206:207], v[206:207], v[236:237] op_sel_hi:[1,0]
  ds_write_b128 v11, v[204:207] offset:1024
  v_pk_mul_f32 v[208:209], v[208:209], v[236:237] op_sel_hi:[1,0]
  v_pk_mul_f32 v[210:211], v[210:211], v[236:237] op_sel_hi:[1,0]
  ds_write_b128 v11, v[208:211] offset:2048
  s_waitcnt lgkmcnt(0)
  s_barrier
  ds_read_b64 v[96:97], v12 offset:0
  ds_read_b64 v[98:99], v12 offset:128
  ds_read_b64 v[100:101], v12 offset:3072
  ds_read_b64 v[102:103], v12 offset:3200
  ds_read_b64 v[104:105], v12 offset:6144
  ds_read_b64 v[106:107], v12 offset:6272
  ds_read_b64 v[108:109], v12 offset:9216
  ds_read_b64 v[110:111], v12 offset:9344
  s_waitcnt lgkmcnt(6)
  v_pk_add_f32 v[96:97], v[96:97], v[98:99]
  s_waitcnt lgkmcnt(4)
  v_pk_add_f32 v[100:101], v[100:101], v[102:103]
  s_waitcnt lgkmcnt(2)
  v_pk_add_f32 v[104:105], v[104:105], v[106:107]
  v_pk_add_f32 v[96:97], v[96:97], v[100:101]
  s_waitcnt lgkmcnt(0)
  v_pk_add_f32 v[108:109], v[108:109], v[110:111]
  v_pk_add_f32 v[96:97], v[96:97], v[104:105]
  v_pk_add_f32 v[96:97], v[96:97], v[108:109]
  v_cvt_pk_f16_f32 v100, v96, v97
  v_perm_b32 v100, s91, v100, v14
  buffer_atomic_pk_add_f16 v100, v13, s[4:7], s3 offen
  s_add_u32 s23, s52, 2
  s_min_u32 s23, s23, 63
  s_sub_u32 s21, s23, 64
  s_mul_i32 s21, s21, 160
  s_add_u32 s21, s21, s89
  s_lshl_b32 s21, s21, 14
  s_add_u32 s64, s21, s67
  s_lshr_b32 s22, s64, 8
  s_xor_b32 s64, s64, s22
  s_xor_b32 s64, s64, s68
  s_and_b32 s64, s64, 8192
  s_add_u32 s64, s64, s21
  s_add_u32 s64, s64, 83886080
  s_mul_i32 s21, s23, 160
  s_add_u32 s21, s21, s89
  s_lshl_b32 s21, s21, 13
  s_cmp_lt_u32 s23, 64
  s_cselect_b32 s64, s21, s64
  s_add_u32 s69, s89, 1
  s_sub_u32 s21, s23, 64
  s_mul_i32 s21, s21, 160
  s_add_u32 s21, s21, s69
  s_lshl_b32 s21, s21, 14
  s_add_u32 s66, s21, s67
  s_lshr_b32 s22, s66, 8
  s_xor_b32 s66, s66, s22
  s_xor_b32 s66, s66, s68
  s_and_b32 s66, s66, 8192
  s_add_u32 s66, s66, s21
  s_add_u32 s66, s66, 83886080
  s_mul_i32 s21, s23, 160
  s_add_u32 s21, s21, s69
  s_lshl_b32 s21, s21, 13
  s_cmp_lt_u32 s23, 64
  s_cselect_b32 s66, s21, s66
  s_lshl_b32 s21, s87, 10
  s_add_u32 s64, s64, s21
  s_add_u32 s66, s66, s21
  s_sub_u32 s66, s66, 8192
  s_cmp_lt_u32 s87, 7
  s_cselect_b32 s65, s64, s66
  s_cmp_lt_u32 s87, 6
  s_cselect_b32 s66, s64, s66
  s_add_u32 s52, s52, 1
  s_and_b32 s21, s52, 3
  s_mul_i32 s81, s21, 540672
  s_lshl_b32 s84, s21, 15
  s_branch step_71
pm_73:
  s_sleep 2
  buffer_load_dwordx4 v[96:99], v4, s[4:7], s84 offen offset:0 sc1
  buffer_load_dwordx4 v[100:103], v4, s[4:7], s84 offen offset:1024 sc1
  buffer_load_dwordx4 v[104:107], v4, s[4:7], s84 offen offset:2048 sc1
  s_add_u32 s54, s54, 1
  s_cmp_gt_u32 s54, 131072
  s_cbranch_scc1 end0
  s_waitcnt vmcnt(0)
  v_bitop3_b32 v27, v99, v103, v107 bitop3:0x80
  v_cvt_f32_f16 v108, v99
  v_and_b32 v27, 0x48000000, v27
  v_cvt_f32_f16 v109, v103
  v_cmp_ne_u32 vcc, 0x48000000, v27
  v_cvt_f32_f16 v110, v106
  v_cvt_f32_f16_sdwa v111, v106 dst_sel:DWORD dst_unused:UNUSED_PAD src0_sel:WORD_1
  v_cvt_pk_bf16_f32 v40, v110, v111
  s_cbranch_vccnz pm_73
  s_branch pm_74
A1_37:
  v_smfmac_f32_16x16x32_bf16 v[52:55], v[40:41], a[16:19], v44
  v_smfmac_f32_16x16x32_bf16 v[64:67], v[40:41], a[76:79], v44
  v_smfmac_f32_16x16x32_bf16 v[56:59], v[40:41], a[36:39], v44
  v_smfmac_f32_16x16x32_bf16 v[68:71], v[40:41], a[96:99], v44
  v_smfmac_f32_16x16x32_bf16 v[60:63], v[40:41], a[56:59], v44
  v_smfmac_f32_16x16x32_bf16 v[72:75], v[40:41], a[116:119], v44
  v_smfmac_f32_16x16x32_bf16 v[76:79], v[40:41], a[136:139], v44
  v_smfmac_f32_16x16x32_bf16 v[80:83], v[40:41], a[156:159], v44
  v_smfmac_f32_16x16x32_bf16 v[84:87], v[40:41], a[176:179], v44
  s_branch A2_75
pv_76:
  buffer_load_dwordx4 v[144:147], v10, s[8:11], s81 offen offset:0 sc1
  buffer_load_dwordx4 v[148:151], v10, s[8:11], s81 offen offset:1024 sc1
  buffer_load_dwordx4 v[152:155], v10, s[8:11], s81 offen offset:2048 sc1
  s_add_u32 s54, s54, 1
  s_cmp_gt_u32 s54, 131072
  s_cbranch_scc1 end0
  s_waitcnt vmcnt(0)
  v_max3_u32 v27, v144, v146, v148
  v_max3_u32 v27, v27, v150, v152
  v_max3_u32 v27, v27, v154, v154
  v_cmp_eq_u32 vcc, -1, v27
  s_nop 1
  s_cbranch_vccnz pv_76
  s_branch pvj_79
psr_77:
  buffer_load_dwordx2 v[248:249], v9, s[8:11], s81 offen sc1
  buffer_load_dwordx4 v[112:115], v8, s[8:11], s81 offen offset:0 sc1
  buffer_load_dwordx4 v[116:119], v8, s[8:11], s81 offen offset:1024 sc1
  s_add_u32 s54, s54, 1
  s_cmp_gt_u32 s54, 131072
  s_cbranch_scc1 end0
  s_waitcnt vmcnt(2)
  v_xor_b32 v96, s88, v248
  s_nop 0
  v_permlane16_swap_b32 v248, v249
  v_fma_mix_f32 v250, v248, 1.0, v249 op_sel:[0,0,0] op_sel_hi:[1,0,1]
  v_fma_mix_f32 v251, v248, 1.0, v249 op_sel:[1,0,1] op_sel_hi:[1,0,1]
  v_mov_b32 v248, v250
  v_mov_b32 v249, v251
  s_nop 0
  v_permlane32_swap_b32 v248, v250
  v_permlane32_swap_b32 v249, v251
  s_waitcnt vmcnt(0)
  v_bitop3_b32 v97, v112, v114, s88 bitop3:0x7e
  v_bitop3_b32 v98, v116, v118, s88 bitop3:0x7e
  v_fma_mix_f32 v120, v112, 1.0, v116 op_sel:[0,0,0] op_sel_hi:[1,0,1]
  v_or3_b32 v27, v96, v97, v98
  v_fma_mix_f32 v124, v114, 1.0, v118 op_sel:[0,0,0] op_sel_hi:[1,0,1]
  v_and_b32 v27, 1, v27
  v_fma_mix_f32 v121, v112, 1.0, v116 op_sel:[1,0,1] op_sel_hi:[1,0,1]
  v_cmp_ne_u32 vcc, 0, v27
  v_fma_mix_f32 v125, v114, 1.0, v118 op_sel:[1,0,1] op_sel_hi:[1,0,1]
  v_fma_mix_f32 v122, v113, 1.0, v117 op_sel:[0,0,0] op_sel_hi:[1,0,1]
  v_fma_mix_f32 v126, v115, 1.0, v119 op_sel:[0,0,0] op_sel_hi:[1,0,1]
  s_cbranch_vccnz psr_77
  s_branch psj_78
kvw_80:
  v_mov_b32 v236, 0
  s_mov_b32 s101, 0
wf_84:
  buffer_load_dword v237, v236, s[12:15], s79 offen sc1
  s_add_u32 s101, s101, 1
  s_cmp_gt_u32 s101, 131072
  s_cbranch_scc1 end0
  s_waitcnt vmcnt(0)
  v_readfirstlane_b32 s100, v237
  s_cmp_ge_u32 s100, s46
  s_cbranch_scc1 wf_85
  s_sleep 1
  s_branch wf_84
wf_85:
  s_branch kvok_81
fl_82:
  buffer_load_dword v94, v95, s[12:15], s79 offen sc1
  s_branch fl_83
last_72:
  s_mov_b64 exec, s[62:63]
  buffer_store_dwordx2 v[212:213], v21, s[24:27], s85 offen sc1
  buffer_store_dwordx2 v[214:215], v22, s[24:27], s85 offen sc1
  buffer_store_dwordx2 v[216:217], v23, s[24:27], s85 offen sc1
  s_mov_b64 exec, 1
  s_waitcnt vmcnt(0)
  v_mov_b32 v236, 64
  buffer_store_dword v236, v95, s[12:15], s90 offen sc1
  s_mov_b64 exec, -1
  s_branch chain_done
step_86:
  s_add_u32 s21, s52, 2
  s_and_b32 s21, s21, 3
  s_mul_i32 s82, s21, 540672
  s_add_u32 s21, s52, 3
  s_and_b32 s21, s21, 3
  s_lshl_b32 s83, s21, 15
  s_add_u32 s21, s52, 1
  s_and_b32 s22, s21, 3
  s_lshl_b32 s3, s22, 15
  s_mul_i32 s80, s21, 393216
  s_add_u32 s46, s21, 1
  s_min_u32 s46, s46, 64
  s_mul_i32 s85, s52, 98304
  s_add_u32 s57, s85, 6291456
  s_bfe_u32 s88, s52, 0x10002
  s_add_u32 s78, s81, 278528
  v_mov_b32 v52, 0
  v_mov_b32 v53, 0
  v_mov_b32 v54, 0
  v_mov_b32 v55, 0
  v_mov_b32 v56, 0
  v_mov_b32 v57, 0
  v_mov_b32 v58, 0
  v_mov_b32 v59, 0
  v_mov_b32 v60, 0
  v_mov_b32 v61, 0
  v_mov_b32 v62, 0
  v_mov_b32 v63, 0
  v_mov_b32 v64, 0
  v_mov_b32 v65, 0
  v_mov_b32 v66, 0
  v_mov_b32 v67, 0
  v_mov_b32 v68, 0
  v_mov_b32 v69, 0
  v_mov_b32 v70, 0
  v_mov_b32 v71, 0
  v_mov_b32 v72, 0
  v_mov_b32 v73, 0
  v_mov_b32 v74, 0
  v_mov_b32 v75, 0
  v_mov_b32 v76, 0
  v_mov_b32 v77, 0
  v_mov_b32 v78, 0
  v_mov_b32 v79, 0
  v_mov_b32 v80, 0
  v_mov_b32 v81, 0
  v_mov_b32 v82, 0
  v_mov_b32 v83, 0
  v_mov_b32 v84, 0
  v_mov_b32 v85, 0
  v_mov_b32 v86, 0
  v_mov_b32 v87, 0
  s_sleep 8
  s_mov_b32 s54, 0
  buffer_load_dwordx4 v[96:99], v4, s[4:7], s84 offen offset:0 sc1
  buffer_load_dwordx4 v[100:103], v4, s[4:7], s84 offen offset:1024 sc1
  buffer_load_dwordx4 v[104:107], v4, s[4:7], s84 offen offset:2048 sc1
  s_waitcnt vmcnt(3)
  v_mov_b32 v176, v160
  v_mov_b32 v177, v161
  v_mov_b32 v178, v162
  v_mov_b32 v179, v163
  v_mov_b32 v180, v164
  v_mov_b32 v181, v165
  v_mov_b32 v182, v166
  v_mov_b32 v183, v167
  v_mov_b32 v184, v48
  v_mov_b32 v185, v49
  v_mov_b32 v186, v50
  v_mov_b32 v187, v51
  s_waitcnt vmcnt(0)
  v_bitop3_b32 v27, v99, v103, v107 bitop3:0x80
  v_cvt_f32_f16 v108, v99
  v_and_b32 v27, 0x48000000, v27
  v_cvt_f32_f16 v109, v103
  v_cmp_ne_u32 vcc, 0x48000000, v27
  v_cvt_f32_f16 v110, v106
  v_cvt_f32_f16_sdwa v111, v106 dst_sel:DWORD dst_unused:UNUSED_PAD src0_sel:WORD_1
  v_cvt_pk_bf16_f32 v40, v110, v111
  s_cbranch_vccnz pm_88
pm_89:
  v_cvt_pk_bf16_f32 v41, v108, v109
  v_cvt_f32_f16 v110, v96
  v_cvt_f32_f16_sdwa v111, v96 dst_sel:DWORD dst_unused:UNUSED_PAD src0_sel:WORD_1
  v_smfmac_f32_16x16x32_bf16 v[52:55], v[40:41], a[16:19], v44
  v_cvt_f32_f16 v112, v97
  v_cvt_f32_f16_sdwa v113, v97 dst_sel:DWORD dst_unused:UNUSED_PAD src0_sel:WORD_1
  v_cvt_pk_bf16_f32 v32, v110, v111
  v_smfmac_f32_16x16x32_bf16 v[64:67], v[40:41], a[76:79], v44
  v_cvt_pk_bf16_f32 v33, v112, v113
  v_cvt_f32_f16 v114, v98
  v_cvt_f32_f16_sdwa v115, v98 dst_sel:DWORD dst_unused:UNUSED_PAD src0_sel:WORD_1
  v_smfmac_f32_16x16x32_bf16 v[56:59], v[40:41], a[36:39], v44
  v_cvt_f32_f16 v116, v100
  v_cvt_f32_f16_sdwa v117, v100 dst_sel:DWORD dst_unused:UNUSED_PAD src0_sel:WORD_1
  v_cvt_pk_bf16_f32 v34, v114, v115
  v_smfmac_f32_16x16x32_bf16 v[68:71], v[40:41], a[96:99], v44
  v_cvt_pk_bf16_f32 v35, v116, v117
  v_cvt_f32_f16 v110, v101
  v_cvt_f32_f16_sdwa v111, v101 dst_sel:DWORD dst_unused:UNUSED_PAD src0_sel:WORD_1
  v_smfmac_f32_16x16x32_bf16 v[60:63], v[40:41], a[56:59], v44
  v_cvt_f32_f16 v112, v102
  v_cvt_f32_f16_sdwa v113, v102 dst_sel:DWORD dst_unused:UNUSED_PAD src0_sel:WORD_1
  v_smfmac_f32_16x16x32_bf16 v[72:75], v[40:41], a[116:119], v44
  v_cvt_pk_bf16_f32 v36, v110, v111
  v_cvt_pk_bf16_f32 v37, v112, v113
  v_smfmac_f32_16x16x32_bf16 v[76:79], v[40:41], a[136:139], v44
  v_cvt_f32_f16 v114, v104
  v_cvt_f32_f16_sdwa v115, v104 dst_sel:DWORD dst_unused:UNUSED_PAD src0_sel:WORD_1
  v_smfmac_f32_16x16x32_bf16 v[80:83], v[40:41], a[156:159], v44
  v_cvt_f32_f16 v116, v105
  v_cvt_f32_f16_sdwa v117, v105 dst_sel:DWORD dst_unused:UNUSED_PAD src0_sel:WORD_1
  v_smfmac_f32_16x16x32_bf16 v[84:87], v[40:41], a[176:179], v44
  v_cvt_pk_bf16_f32 v38, v114, v115
  v_cvt_pk_bf16_f32 v39, v116, v117
A2_90:
  v_smfmac_f32_16x16x64_bf16 v[52:55], v[32:35], a[0:7], v44
  v_smfmac_f32_16x16x64_bf16 v[52:55], v[36:39], a[8:15], v44
  v_smfmac_f32_16x16x64_bf16 v[64:67], v[32:35], a[60:67], v44
  v_smfmac_f32_16x16x64_bf16 v[64:67], v[36:39], a[68:75], v44
  v_smfmac_f32_16x16x64_bf16 v[56:59], v[32:35], a[20:27], v44
  v_smfmac_f32_16x16x64_bf16 v[56:59], v[36:39], a[28:35], v44
  v_smfmac_f32_16x16x64_bf16 v[68:71], v[32:35], a[80:87], v44
  v_permlane32_swap_b32 v52, v64
  v_permlane32_swap_b32 v53, v65
  v_permlane32_swap_b32 v54, v66
  v_smfmac_f32_16x16x64_bf16 v[68:71], v[36:39], a[88:95], v44
  v_permlane32_swap_b32 v55, v67
  v_pk_add_f32 v[52:53], v[52:53], v[64:65]
  v_pk_add_f32 v[54:55], v[54:55], v[66:67]
  v_smfmac_f32_16x16x64_bf16 v[60:63], v[32:35], a[40:47], v44
  ds_write2_b32 v5, v52, v53 offset0:0 offset1:4
  ds_write2_b32 v5, v54, v55 offset0:8 offset1:12
  v_smfmac_f32_16x16x64_bf16 v[60:63], v[36:39], a[48:55], v44
  v_smfmac_f32_16x16x64_bf16 v[72:75], v[32:35], a[100:107], v44
  v_permlane32_swap_b32 v56, v68
  v_permlane32_swap_b32 v57, v69
  v_permlane32_swap_b32 v58, v70
  v_smfmac_f32_16x16x64_bf16 v[72:75], v[36:39], a[108:115], v44
  v_permlane32_swap_b32 v59, v71
  v_pk_add_f32 v[56:57], v[56:57], v[68:69]
  v_pk_add_f32 v[58:59], v[58:59], v[70:71]
  v_smfmac_f32_16x16x64_bf16 v[76:79], v[32:35], a[120:127], v44
  ds_write2_b32 v242, v56, v57 offset0:0 offset1:4
  ds_write2_b32 v242, v58, v59 offset0:8 offset1:12
  v_smfmac_f32_16x16x64_bf16 v[76:79], v[36:39], a[128:135], v44
  v_smfmac_f32_16x16x64_bf16 v[80:83], v[32:35], a[140:147], v44
  v_permlane32_swap_b32 v60, v72
  v_permlane32_swap_b32 v61, v73
  v_permlane32_swap_b32 v62, v74
  v_smfmac_f32_16x16x64_bf16 v[80:83], v[36:39], a[148:155], v44
  v_permlane32_swap_b32 v63, v75
  v_pk_add_f32 v[60:61], v[60:61], v[72:73]
  v_pk_add_f32 v[62:63], v[62:63], v[74:75]
  v_smfmac_f32_16x16x64_bf16 v[84:87], v[32:35], a[160:167], v44
  ds_write2_b32 v243, v60, v61 offset0:0 offset1:4
  ds_write2_b32 v243, v62, v63 offset0:8 offset1:12
  v_smfmac_f32_16x16x64_bf16 v[84:87], v[36:39], a[168:175], v44
  v_permlane32_swap_b32 v76, v80
  v_permlane32_swap_b32 v77, v81
  v_permlane32_swap_b32 v78, v82
  v_permlane32_swap_b32 v79, v83
  v_pk_add_f32 v[76:77], v[76:77], v[80:81]
  v_pk_add_f32 v[78:79], v[78:79], v[82:83]
  ds_write2_b32 v244, v76, v77 offset0:0 offset1:4
  ds_write2_b32 v244, v78, v79 offset0:8 offset1:12
  ds_write2_b32 v245, v84, v85 offset0:0 offset1:4
  ds_write2_b32 v245, v86, v87 offset0:8 offset1:12
  s_waitcnt lgkmcnt(0) vmcnt(0)
  s_barrier
  ds_read_b128 v[96:99], v6 offset:3264
  ds_read_b128 v[100:103], v6 offset:8704
  ds_read_b128 v[104:107], v6 offset:14144
  ds_read_b128 v[108:111], v6 offset:19584
  ds_read_b128 v[112:115], v6 offset:4352
  ds_read_b128 v[116:119], v6 offset:9792
  ds_read_b128 v[120:123], v6 offset:15232
  ds_read_b128 v[124:127], v6 offset:20672
  s_waitcnt lgkmcnt(4)
  v_pk_add_f32 v[96:97], v[96:97], v[100:101]
  v_pk_add_f32 v[98:99], v[98:99], v[102:103]
  v_pk_add_f32 v[104:105], v[104:105], v[108:109]
  v_pk_add_f32 v[106:107], v[106:107], v[110:111]
  v_pk_add_f32 v[96:97], v[96:97], v[104:105]
  v_pk_add_f32 v[98:99], v[98:99], v[106:107]
  v_cvt_pk_bf16_f32 v90, v96, v97
  v_cvt_pk_bf16_f32 v91, v98, v99
  v_min_u32 v90, -2, v90
  v_min_u32 v91, -2, v91
  buffer_store_dwordx2 v[90:91], v24, s[8:11], s81 offen
  s_waitcnt lgkmcnt(0)
  v_pk_add_f32 v[112:113], v[112:113], v[116:117]
  v_pk_add_f32 v[114:115], v[114:115], v[118:119]
  v_pk_add_f32 v[120:121], v[120:121], v[124:125]
  v_pk_add_f32 v[122:123], v[122:123], v[126:127]
  v_pk_add_f32 v[112:113], v[112:113], v[120:121]
  v_pk_add_f32 v[114:115], v[114:115], v[122:123]
  s_nop 1
  v_add_f32_dpp v116, v112, v112 row_ror:8 row_mask:0xf bank_mask:0xf
  v_add_f32_dpp v117, v113, v113 row_ror:8 row_mask:0xf bank_mask:0xf
  v_add_f32_dpp v118, v114, v114 row_ror:8 row_mask:0xf bank_mask:0xf
  v_add_f32_dpp v119, v115, v115 row_ror:8 row_mask:0xf bank_mask:0xf
  v_cvt_pk_bf16_f32 v92, v116, v117
  v_cvt_pk_bf16_f32 v93, v118, v119
  v_min_u32 v92, -2, v92
  v_min_u32 v93, -2, v93
  s_mov_b64 exec, s[60:61]
  buffer_store_dwordx2 v[92:93], v23, s[8:11], s78 offen
  s_mov_b64 exec, -1
  s_cmp_eq_u32 s52, 63
  s_cbranch_scc1 last_87
  s_sleep 5
  s_mov_b32 s54, 0
  buffer_load_dwordx2 v[248:249], v9, s[8:11], s81 offen sc1
  buffer_load_dwordx4 v[112:115], v8, s[8:11], s81 offen offset:0 sc1
  buffer_load_dwordx4 v[116:119], v8, s[8:11], s81 offen offset:1024 sc1
  s_sleep 2
  buffer_load_dwordx4 v[144:147], v10, s[8:11], s81 offen offset:0 sc1
  buffer_load_dwordx4 v[148:151], v10, s[8:11], s81 offen offset:1024 sc1
  buffer_load_dwordx4 v[152:155], v10, s[8:11], s81 offen offset:2048 sc1
  v_mov_b32 v188, 0
  v_mov_b32 v189, 0
  v_mov_b32 v190, 0
  v_mov_b32 v191, 0
  v_mov_b32 v192, 0
  v_mov_b32 v193, 0
  v_mov_b32 v194, 0
  v_mov_b32 v195, 0
  v_mov_b32 v196, 0
  v_mov_b32 v197, 0
  v_mov_b32 v198, 0
  v_mov_b32 v199, 0
  v_readfirstlane_b32 s21, v94
  s_add_u32 s22, s46, 8
  s_min_u32 s22, s22, 64
  s_sub_u32 s55, s21, s22
  s_sub_u32 s56, s21, s46
  s_waitcnt vmcnt(5)
  v_xor_b32 v96, s88, v248
  s_nop 0
  v_permlane16_swap_b32 v248, v249
  v_fma_mix_f32 v250, v248, 1.0, v249 op_sel:[0,0,0] op_sel_hi:[1,0,1]
  v_fma_mix_f32 v251, v248, 1.0, v249 op_sel:[1,0,1] op_sel_hi:[1,0,1]
  v_mov_b32 v248, v250
  v_mov_b32 v249, v251
  s_nop 0
  v_permlane32_swap_b32 v248, v250
  v_permlane32_swap_b32 v249, v251
  s_waitcnt vmcnt(3)
  v_bitop3_b32 v97, v112, v114, s88 bitop3:0x7e
  v_bitop3_b32 v98, v116, v118, s88 bitop3:0x7e
  v_fma_mix_f32 v120, v112, 1.0, v116 op_sel:[0,0,0] op_sel_hi:[1,0,1]
  v_or3_b32 v27, v96, v97, v98
  v_fma_mix_f32 v124, v114, 1.0, v118 op_sel:[0,0,0] op_sel_hi:[1,0,1]
  v_and_b32 v27, 1, v27
  v_fma_mix_f32 v121, v112, 1.0, v116 op_sel:[1,0,1] op_sel_hi:[1,0,1]
  v_cmp_ne_u32 vcc, 0, v27
  v_fma_mix_f32 v125, v114, 1.0, v118 op_sel:[1,0,1] op_sel_hi:[1,0,1]
  v_fma_mix_f32 v122, v113, 1.0, v117 op_sel:[0,0,0] op_sel_hi:[1,0,1]
  v_fma_mix_f32 v126, v115, 1.0, v119 op_sel:[0,0,0] op_sel_hi:[1,0,1]
  s_cbranch_vccnz psr_92
psj_93:
  s_cmp_lt_i32 s56, 0
  s_cbranch_scc1 kvw_95
kvok_96:
  v_fma_mix_f32 v123, v113, 1.0, v117 op_sel:[1,0,1] op_sel_hi:[1,0,1]
  v_fma_mix_f32 v127, v115, 1.0, v119 op_sel:[1,0,1] op_sel_hi:[1,0,1]
  v_permlane32_swap_b32 v120, v124
  v_permlane32_swap_b32 v121, v125
  v_permlane32_swap_b32 v122, v126
  v_permlane32_swap_b32 v123, v127
  v_pk_add_f32 v[120:121], v[120:121], v[124:125]
  v_pk_add_f32 v[122:123], v[122:123], v[126:127]
  v_pk_add_f32 v[124:125], v[248:249], v[250:251]
  v_max3_f32 v236, v120, v121, v122
  v_max3_f32 v237, v123, v124, v125
  v_max_f32 v236, v236, v237
  s_nop 1
  v_max_f32_dpp v236, v236, v236 row_ror:8 row_mask:0xf bank_mask:0xf
  v_mov_b32 v237, v236
  s_nop 1
  v_permlane32_swap_b32 v236, v237
  v_max_f32 v236, v236, v237
  v_mov_b32 v237, v236
  s_nop 1
  v_permlane16_swap_b32 v236, v237
  v_max_f32 v236, v236, v237
  s_waitcnt vmcnt(0)
  v_max3_u32 v27, v144, v146, v148
  v_max3_u32 v27, v27, v150, v152
  v_max3_u32 v27, v27, v154, v154
  v_cmp_eq_u32 vcc, -1, v27
  s_nop 1
  s_cbranch_vccnz pv_91
pvj_94:
  v_mul_f32 v236, s86, v236
  v_smfmac_f32_16x16x64_bf16 v[188:191], v[144:147], a[180:187], v44
  v_fma_f32 v120, v120, s86, -v236
  v_smfmac_f32_16x16x64_bf16 v[188:191], v[148:151], a[188:195], v44
  v_fma_f32 v121, v121, s86, -v236
  v_smfmac_f32_16x16x64_bf16 v[188:191], v[152:155], a[196:203], v44
  buffer_load_dwordx4 v[160:163], v16, s[28:31], s64 offen offset:0 sc1
  v_fma_f32 v122, v122, s86, -v236
  v_smfmac_f32_16x16x64_bf16 v[192:195], v[144:147], a[204:211], v44
  v_fma_f32 v123, v123, s86, -v236
  v_smfmac_f32_16x16x64_bf16 v[192:195], v[148:151], a[212:219], v44
  buffer_load_dwordx4 v[164:167], v16, s[28:31], s65 offen offset:1024 sc1
  v_fma_f32 v124, v124, s86, -v236
  v_smfmac_f32_16x16x64_bf16 v[192:195], v[152:155], a[220:227], v44
  v_fma_f32 v125, v125, s86, -v236
  v_smfmac_f32_16x16x64_bf16 v[196:199], v[144:147], a[228:235], v44
  buffer_load_dwordx4 v[48:51], v16, s[28:31], s66 offen offset:2048 sc1
  v_exp_f32 v120, v120
  v_smfmac_f32_16x16x64_bf16 v[196:199], v[148:151], a[236:243], v44
  v_exp_f32 v121, v121
  v_smfmac_f32_16x16x64_bf16 v[196:199], v[152:155], a[244:251], v44
  buffer_store_dwordx2 v[90:91], v25, s[24:27], s57 offen sc1
  v_exp_f32 v122, v122
  s_mov_b64 exec, s[60:61]
  buffer_store_dwordx2 v[92:93], v23, s[24:27], s57 offen sc1
  s_mov_b64 exec, -1
  v_exp_f32 v123, v123
  v_mov_b32 v240, s52
  v_mov_b32 v241, s52
  s_mov_b64 exec, 1
  buffer_store_dwordx2 v[240:241], v95, s[12:15], s90 offen sc1
  s_mov_b64 exec, -1
  v_exp_f32 v124, v124
  s_cmp_lt_i32 s55, 0
  s_cbranch_scc1 fl_97
fl_98:
  v_exp_f32 v125, v125
  s_mov_b64 exec, s[60:61]
  v_cvt_pk_bf16_f32 v220, v120, v121
  v_cvt_pk_bf16_f32 v221, v122, v123
  v_cvt_pk_bf16_f32 v224, v124, v125
  s_mov_b64 exec, s[62:63]
  v_cvt_pk_bf16_f32 v222, v120, v121
  v_cvt_pk_bf16_f32 v223, v122, v123
  v_cvt_pk_bf16_f32 v225, v124, v125
  s_mov_b64 exec, -1
  v_pk_add_f32 v[126:127], v[120:121], v[122:123]
  v_add_f32 v128, v124, v125
  v_mfma_f32_16x16x32_bf16 v[200:203], v[176:179], v[220:223], 0
  v_add_f32 v236, v126, v127
  v_fmac_f32 v236, v128, v89
  v_cvt_pk_bf16_f32 v228, v188, v189
  v_cvt_pk_bf16_f32 v229, v190, v191
  v_mfma_f32_16x16x32_bf16 v[204:207], v[180:183], v[220:223], 0
  v_cvt_pk_bf16_f32 v230, v192, v193
  v_cvt_pk_bf16_f32 v231, v194, v195
  v_mfma_f32_16x16x32_bf16 v[208:211], v[184:187], v[220:223], 0
  v_cvt_pk_bf16_f32 v232, v196, v197
  v_cvt_pk_bf16_f32 v233, v198, v199
  v_add_f32_dpp v236, v236, v236 row_ror:8 row_mask:0xf bank_mask:0xf
  v_mov_b32 v237, v236
  s_nop 0
  v_mfma_f32_16x16x32_bf16 v[200:203], v[228:231], v[224:227], v[200:203]
  v_mfma_f32_16x16x32_bf16 v[204:207], v[230:233], v[224:227], v[204:207]
  v_permlane32_swap_b32 v236, v237
  v_add_f32 v236, v236, v237
  v_mov_b32 v237, v236
  v_mfma_f32_16x16x32_bf16 v[208:211], v[232:235], v[224:227], v[208:211]
  s_nop 0
  v_permlane16_swap_b32 v236, v237
  v_add_f32 v236, v236, v237
  v_rcp_f32 v236, v236
  s_nop 2
  v_pk_mul_f32 v[200:201], v[200:201], v[236:237] op_sel_hi:[1,0]
  v_pk_mul_f32 v[202:203], v[202:203], v[236:237] op_sel_hi:[1,0]
  ds_write_b128 v11, v[200:203] offset:0
  v_pk_mul_f32 v[204:205], v[204:205], v[236:237] op_sel_hi:[1,0]
  v_pk_mul_f32 v[206:207], v[206:207], v[236:237] op_sel_hi:[1,0]
  ds_write_b128 v11, v[204:207] offset:1024
  v_pk_mul_f32 v[208:209], v[208:209], v[236:237] op_sel_hi:[1,0]
  v_pk_mul_f32 v[210:211], v[210:211], v[236:237] op_sel_hi:[1,0]
  ds_write_b128 v11, v[208:211] offset:2048
  s_waitcnt lgkmcnt(0)
  s_barrier
  v_mov_b32 v28, -1
  v_mov_b32 v29, -1
  buffer_store_dwordx2 v[28:29], v24, s[8:11], s82 offen
  s_mov_b64 exec, s[60:61]
  s_add_u32 s22, s82, 278528
  buffer_store_dwordx2 v[28:29], v23, s[8:11], s22 offen
  s_and_b32 s21, s52, 7
  s_cmp_lg_u32 s21, s50
  s_cbranch_scc1 zm_99
  s_mov_b64 exec, s[70:71]
  buffer_store_dwordx4 v[156:159], v13, s[4:7], s83 offen sc1
zm_99:
  s_mov_b64 exec, -1
  s_add_u32 s23, s52, 2
  s_min_u32 s23, s23, 63
  s_sub_u32 s21, s23, 64
  s_mul_i32 s21, s21, 160
  s_add_u32 s21, s21, s89
  s_lshl_b32 s21, s21, 14
  s_add_u32 s64, s21, s67
  s_lshr_b32 s22, s64, 8
  s_xor_b32 s64, s64, s22
  s_xor_b32 s64, s64, s68
  s_and_b32 s64, s64, 8192
  s_add_u32 s64, s64, s21
  s_add_u32 s64, s64, 83886080
  s_mul_i32 s21, s23, 160
  s_add_u32 s21, s21, s89
  s_lshl_b32 s21, s21, 13
  s_cmp_lt_u32 s23, 64
  s_cselect_b32 s64, s21, s64
  s_add_u32 s69, s89, 1
  s_sub_u32 s21, s23, 64
  s_mul_i32 s21, s21, 160
  s_add_u32 s21, s21, s69
  s_lshl_b32 s21, s21, 14
  s_add_u32 s66, s21, s67
  s_lshr_b32 s22, s66, 8
  s_xor_b32 s66, s66, s22
  s_xor_b32 s66, s66, s68
  s_and_b32 s66, s66, 8192
  s_add_u32 s66, s66, s21
  s_add_u32 s66, s66, 83886080
  s_mul_i32 s21, s23, 160
  s_add_u32 s21, s21, s69
  s_lshl_b32 s21, s21, 13
  s_cmp_lt_u32 s23, 64
  s_cselect_b32 s66, s21, s66
  s_lshl_b32 s21, s87, 10
  s_add_u32 s64, s64, s21
  s_add_u32 s66, s66, s21
  s_sub_u32 s66, s66, 8192
  s_cmp_lt_u32 s87, 7
  s_cselect_b32 s65, s64, s66
  s_cmp_lt_u32 s87, 6
  s_cselect_b32 s66, s64, s66
  s_add_u32 s52, s52, 1
  s_and_b32 s21, s52, 3
  s_mul_i32 s81, s21, 540672
  s_lshl_b32 s84, s21, 15
  s_branch step_86
pm_88:
  s_sleep 2
  buffer_load_dwordx4 v[96:99], v4, s[4:7], s84 offen offset:0 sc1
  buffer_load_dwordx4 v[100:103], v4, s[4:7], s84 offen offset:1024 sc1
  buffer_load_dwordx4 v[104:107], v4, s[4:7], s84 offen offset:2048 sc1
  s_add_u32 s54, s54, 1
  s_cmp_gt_u32 s54, 131072
  s_cbranch_scc1 end0
  s_waitcnt vmcnt(0)
  v_bitop3_b32 v27, v99, v103, v107 bitop3:0x80
  v_cvt_f32_f16 v108, v99
  v_and_b32 v27, 0x48000000, v27
  v_cvt_f32_f16 v109, v103
  v_cmp_ne_u32 vcc, 0x48000000, v27
  v_cvt_f32_f16 v110, v106
  v_cvt_f32_f16_sdwa v111, v106 dst_sel:DWORD dst_unused:UNUSED_PAD src0_sel:WORD_1
  v_cvt_pk_bf16_f32 v40, v110, v111
  s_cbranch_vccnz pm_88
  s_branch pm_89
A1_38:
  v_smfmac_f32_16x16x32_bf16 v[52:55], v[40:41], a[16:19], v44
  v_smfmac_f32_16x16x32_bf16 v[64:67], v[40:41], a[76:79], v44
  v_smfmac_f32_16x16x32_bf16 v[56:59], v[40:41], a[36:39], v44
  v_smfmac_f32_16x16x32_bf16 v[68:71], v[40:41], a[96:99], v44
  v_smfmac_f32_16x16x32_bf16 v[60:63], v[40:41], a[56:59], v44
  v_smfmac_f32_16x16x32_bf16 v[72:75], v[40:41], a[116:119], v44
  v_smfmac_f32_16x16x32_bf16 v[76:79], v[40:41], a[136:139], v44
  v_smfmac_f32_16x16x32_bf16 v[80:83], v[40:41], a[156:159], v44
  v_smfmac_f32_16x16x32_bf16 v[84:87], v[40:41], a[176:179], v44
  s_branch A2_90
pv_91:
  buffer_load_dwordx4 v[144:147], v10, s[8:11], s81 offen offset:0 sc1
  buffer_load_dwordx4 v[148:151], v10, s[8:11], s81 offen offset:1024 sc1
  buffer_load_dwordx4 v[152:155], v10, s[8:11], s81 offen offset:2048 sc1
  s_add_u32 s54, s54, 1
  s_cmp_gt_u32 s54, 131072
  s_cbranch_scc1 end0
  s_waitcnt vmcnt(0)
  v_max3_u32 v27, v144, v146, v148
  v_max3_u32 v27, v27, v150, v152
  v_max3_u32 v27, v27, v154, v154
  v_cmp_eq_u32 vcc, -1, v27
  s_nop 1
  s_cbranch_vccnz pv_91
  s_branch pvj_94
psr_92:
  buffer_load_dwordx2 v[248:249], v9, s[8:11], s81 offen sc1
  buffer_load_dwordx4 v[112:115], v8, s[8:11], s81 offen offset:0 sc1
  buffer_load_dwordx4 v[116:119], v8, s[8:11], s81 offen offset:1024 sc1
  s_add_u32 s54, s54, 1
  s_cmp_gt_u32 s54, 131072
  s_cbranch_scc1 end0
  s_waitcnt vmcnt(2)
  v_xor_b32 v96, s88, v248
  s_nop 0
  v_permlane16_swap_b32 v248, v249
  v_fma_mix_f32 v250, v248, 1.0, v249 op_sel:[0,0,0] op_sel_hi:[1,0,1]
  v_fma_mix_f32 v251, v248, 1.0, v249 op_sel:[1,0,1] op_sel_hi:[1,0,1]
  v_mov_b32 v248, v250
  v_mov_b32 v249, v251
  s_nop 0
  v_permlane32_swap_b32 v248, v250
  v_permlane32_swap_b32 v249, v251
  s_waitcnt vmcnt(0)
  v_bitop3_b32 v97, v112, v114, s88 bitop3:0x7e
  v_bitop3_b32 v98, v116, v118, s88 bitop3:0x7e
  v_fma_mix_f32 v120, v112, 1.0, v116 op_sel:[0,0,0] op_sel_hi:[1,0,1]
  v_or3_b32 v27, v96, v97, v98
  v_fma_mix_f32 v124, v114, 1.0, v118 op_sel:[0,0,0] op_sel_hi:[1,0,1]
  v_and_b32 v27, 1, v27
  v_fma_mix_f32 v121, v112, 1.0, v116 op_sel:[1,0,1] op_sel_hi:[1,0,1]
  v_cmp_ne_u32 vcc, 0, v27
  v_fma_mix_f32 v125, v114, 1.0, v118 op_sel:[1,0,1] op_sel_hi:[1,0,1]
  v_fma_mix_f32 v122, v113, 1.0, v117 op_sel:[0,0,0] op_sel_hi:[1,0,1]
  v_fma_mix_f32 v126, v115, 1.0, v119 op_sel:[0,0,0] op_sel_hi:[1,0,1]
  s_cbranch_vccnz psr_92
  s_branch psj_93
kvw_95:
  v_mov_b32 v236, 0
  s_mov_b32 s101, 0
wf_100:
  buffer_load_dword v237, v236, s[12:15], s79 offen sc1
  s_add_u32 s101, s101, 1
  s_cmp_gt_u32 s101, 131072
  s_cbranch_scc1 end0
  s_waitcnt vmcnt(0)
  v_readfirstlane_b32 s100, v237
  s_cmp_ge_u32 s100, s46
  s_cbranch_scc1 wf_101
  s_sleep 1
  s_branch wf_100
wf_101:
  s_branch kvok_96
fl_97:
  buffer_load_dword v94, v95, s[12:15], s79 offen sc1
  s_branch fl_98
last_87:
  buffer_store_dwordx2 v[90:91], v25, s[24:27], s57 offen sc1
  s_mov_b64 exec, s[60:61]
  buffer_store_dwordx2 v[92:93], v23, s[24:27], s57 offen sc1
  s_mov_b64 exec, 1
  s_waitcnt vmcnt(0)
  v_mov_b32 v236, 64
  buffer_store_dword v236, v95, s[12:15], s90 offen offset:4 sc1
  s_mov_b64 exec, -1
  s_branch chain_done
step_102:
  s_add_u32 s21, s52, 2
  s_and_b32 s21, s21, 3
  s_mul_i32 s82, s21, 540672
  s_add_u32 s21, s52, 3
  s_and_b32 s21, s21, 3
  s_lshl_b32 s83, s21, 15
  s_add_u32 s21, s52, 1
  s_and_b32 s22, s21, 3
  s_lshl_b32 s3, s22, 15
  s_mul_i32 s80, s21, 393216
  s_add_u32 s46, s21, 1
  s_min_u32 s46, s46, 64
  s_mul_i32 s85, s52, 98304
  s_add_u32 s57, s85, 6291456
  s_bfe_u32 s88, s52, 0x10002
  s_add_u32 s78, s81, 278528
  v_mov_b32 v52, 0
  v_mov_b32 v53, 0
  v_mov_b32 v54, 0
  v_mov_b32 v55, 0
  v_mov_b32 v56, 0
  v_mov_b32 v57, 0
  v_mov_b32 v58, 0
  v_mov_b32 v59, 0
  v_mov_b32 v60, 0
  v_mov_b32 v61, 0
  v_mov_b32 v62, 0
  v_mov_b32 v63, 0
  v_mov_b32 v64, 0
  v_mov_b32 v65, 0
  v_mov_b32 v66, 0
  v_mov_b32 v67, 0
  v_mov_b32 v68, 0
  v_mov_b32 v69, 0
  v_mov_b32 v70, 0
  v_mov_b32 v71, 0
  v_mov_b32 v72, 0
  v_mov_b32 v73, 0
  v_mov_b32 v74, 0
  v_mov_b32 v75, 0
  v_mov_b32 v76, 0
  v_mov_b32 v77, 0
  v_mov_b32 v78, 0
  v_mov_b32 v79, 0
  v_mov_b32 v80, 0
  v_mov_b32 v81, 0
  v_mov_b32 v82, 0
  v_mov_b32 v83, 0
  v_mov_b32 v84, 0
  v_mov_b32 v85, 0
  v_mov_b32 v86, 0
  v_mov_b32 v87, 0
  s_sleep 8
  s_mov_b32 s54, 0
  buffer_load_dwordx4 v[96:99], v4, s[4:7], s84 offen offset:0 sc1
  buffer_load_dwordx4 v[100:103], v4, s[4:7], s84 offen offset:1024 sc1
  buffer_load_dwordx4 v[104:107], v4, s[4:7], s84 offen offset:2048 sc1
  s_waitcnt vmcnt(3)
  v_mov_b32 v176, v160
  v_mov_b32 v177, v161
  v_mov_b32 v178, v162
  v_mov_b32 v179, v163
  v_mov_b32 v180, v164
  v_mov_b32 v181, v165
  v_mov_b32 v182, v166
  v_mov_b32 v183, v167
  v_mov_b32 v184, v48
  v_mov_b32 v185, v49
  v_mov_b32 v186, v50
  v_mov_b32 v187, v51
  s_waitcnt vmcnt(0)
  v_bitop3_b32 v27, v99, v103, v107 bitop3:0x80
  v_cvt_f32_f16 v108, v99
  v_and_b32 v27, 0x48000000, v27
  v_cvt_f32_f16 v109, v103
  v_cmp_ne_u32 vcc, 0x48000000, v27
  v_cvt_f32_f16 v110, v106
  v_cvt_f32_f16_sdwa v111, v106 dst_sel:DWORD dst_unused:UNUSED_PAD src0_sel:WORD_1
  v_cvt_pk_bf16_f32 v40, v110, v111
  s_cbranch_vccnz pm_104
pm_105:
  v_cvt_pk_bf16_f32 v41, v108, v109
  v_cvt_f32_f16 v110, v96
  v_cvt_f32_f16_sdwa v111, v96 dst_sel:DWORD dst_unused:UNUSED_PAD src0_sel:WORD_1
  v_smfmac_f32_16x16x32_bf16 v[52:55], v[40:41], a[16:19], v44
  v_cvt_f32_f16 v112, v97
  v_cvt_f32_f16_sdwa v113, v97 dst_sel:DWORD dst_unused:UNUSED_PAD src0_sel:WORD_1
  v_cvt_pk_bf16_f32 v32, v110, v111
  v_smfmac_f32_16x16x32_bf16 v[64:67], v[40:41], a[76:79], v44
  v_cvt_pk_bf16_f32 v33, v112, v113
  v_cvt_f32_f16 v114, v98
  v_cvt_f32_f16_sdwa v115, v98 dst_sel:DWORD dst_unused:UNUSED_PAD src0_sel:WORD_1
  v_smfmac_f32_16x16x32_bf16 v[56:59], v[40:41], a[36:39], v44
  v_cvt_f32_f16 v116, v100
  v_cvt_f32_f16_sdwa v117, v100 dst_sel:DWORD dst_unused:UNUSED_PAD src0_sel:WORD_1
  v_cvt_pk_bf16_f32 v34, v114, v115
  v_smfmac_f32_16x16x32_bf16 v[68:71], v[40:41], a[96:99], v44
  v_cvt_pk_bf16_f32 v35, v116, v117
  v_cvt_f32_f16 v110, v101
  v_cvt_f32_f16_sdwa v111, v101 dst_sel:DWORD dst_unused:UNUSED_PAD src0_sel:WORD_1
  v_smfmac_f32_16x16x32_bf16 v[60:63], v[40:41], a[56:59], v44
  v_cvt_f32_f16 v112, v102
  v_cvt_f32_f16_sdwa v113, v102 dst_sel:DWORD dst_unused:UNUSED_PAD src0_sel:WORD_1
  v_smfmac_f32_16x16x32_bf16 v[72:75], v[40:41], a[116:119], v44
  v_cvt_pk_bf16_f32 v36, v110, v111
  v_cvt_pk_bf16_f32 v37, v112, v113
  v_smfmac_f32_16x16x32_bf16 v[76:79], v[40:41], a[136:139], v44
  v_cvt_f32_f16 v114, v104
  v_cvt_f32_f16_sdwa v115, v104 dst_sel:DWORD dst_unused:UNUSED_PAD src0_sel:WORD_1
  v_smfmac_f32_16x16x32_bf16 v[80:83], v[40:41], a[156:159], v44
  v_cvt_f32_f16 v116, v105
  v_cvt_f32_f16_sdwa v117, v105 dst_sel:DWORD dst_unused:UNUSED_PAD src0_sel:WORD_1
  v_smfmac_f32_16x16x32_bf16 v[84:87], v[40:41], a[176:179], v44
  v_cvt_pk_bf16_f32 v38, v114, v115
  v_cvt_pk_bf16_f32 v39, v116, v117
A2_106:
  v_smfmac_f32_16x16x64_bf16 v[52:55], v[32:35], a[0:7], v44
  v_smfmac_f32_16x16x64_bf16 v[52:55], v[36:39], a[8:15], v44
  v_smfmac_f32_16x16x64_bf16 v[64:67], v[32:35], a[60:67], v44
  v_smfmac_f32_16x16x64_bf16 v[64:67], v[36:39], a[68:75], v44
  v_smfmac_f32_16x16x64_bf16 v[56:59], v[32:35], a[20:27], v44
  v_smfmac_f32_16x16x64_bf16 v[56:59], v[36:39], a[28:35], v44
  v_smfmac_f32_16x16x64_bf16 v[68:71], v[32:35], a[80:87], v44
  v_permlane32_swap_b32 v52, v64
  v_permlane32_swap_b32 v53, v65
  v_permlane32_swap_b32 v54, v66
  v_smfmac_f32_16x16x64_bf16 v[68:71], v[36:39], a[88:95], v44
  v_permlane32_swap_b32 v55, v67
  v_pk_add_f32 v[52:53], v[52:53], v[64:65]
  v_pk_add_f32 v[54:55], v[54:55], v[66:67]
  v_smfmac_f32_16x16x64_bf16 v[60:63], v[32:35], a[40:47], v44
  ds_write2_b32 v5, v52, v53 offset0:0 offset1:4
  ds_write2_b32 v5, v54, v55 offset0:8 offset1:12
  v_smfmac_f32_16x16x64_bf16 v[60:63], v[36:39], a[48:55], v44
  v_smfmac_f32_16x16x64_bf16 v[72:75], v[32:35], a[100:107], v44
  v_permlane32_swap_b32 v56, v68
  v_permlane32_swap_b32 v57, v69
  v_permlane32_swap_b32 v58, v70
  v_smfmac_f32_16x16x64_bf16 v[72:75], v[36:39], a[108:115], v44
  v_permlane32_swap_b32 v59, v71
  v_pk_add_f32 v[56:57], v[56:57], v[68:69]
  v_pk_add_f32 v[58:59], v[58:59], v[70:71]
  v_smfmac_f32_16x16x64_bf16 v[76:79], v[32:35], a[120:127], v44
  ds_write2_b32 v242, v56, v57 offset0:0 offset1:4
  ds_write2_b32 v242, v58, v59 offset0:8 offset1:12
  v_smfmac_f32_16x16x64_bf16 v[76:79], v[36:39], a[128:135], v44
  v_smfmac_f32_16x16x64_bf16 v[80:83], v[32:35], a[140:147], v44
  v_permlane32_swap_b32 v60, v72
  v_permlane32_swap_b32 v61, v73
  v_permlane32_swap_b32 v62, v74
  v_smfmac_f32_16x16x64_bf16 v[80:83], v[36:39], a[148:155], v44
  v_permlane32_swap_b32 v63, v75
  v_pk_add_f32 v[60:61], v[60:61], v[72:73]
  v_pk_add_f32 v[62:63], v[62:63], v[74:75]
  v_smfmac_f32_16x16x64_bf16 v[84:87], v[32:35], a[160:167], v44
  ds_write2_b32 v243, v60, v61 offset0:0 offset1:4
  ds_write2_b32 v243, v62, v63 offset0:8 offset1:12
  v_smfmac_f32_16x16x64_bf16 v[84:87], v[36:39], a[168:175], v44
  v_permlane32_swap_b32 v76, v80
  v_permlane32_swap_b32 v77, v81
  v_permlane32_swap_b32 v78, v82
  v_permlane32_swap_b32 v79, v83
  v_pk_add_f32 v[76:77], v[76:77], v[80:81]
  v_pk_add_f32 v[78:79], v[78:79], v[82:83]
  ds_write2_b32 v244, v76, v77 offset0:0 offset1:4
  ds_write2_b32 v244, v78, v79 offset0:8 offset1:12
  ds_write2_b32 v245, v84, v85 offset0:0 offset1:4
  ds_write2_b32 v245, v86, v87 offset0:8 offset1:12
  s_waitcnt lgkmcnt(0) vmcnt(0)
  s_barrier
  s_lshr_b32 s21, 3, s20
  s_bitcmp1_b32 s21, 0
  s_cbranch_scc0 bw_108
  ds_read_b128 v[96:99], v45 offset:0
  ds_read_b128 v[108:111], v45 offset:5440
  ds_read_b128 v[100:103], v45 offset:1088
  ds_read_b128 v[112:115], v45 offset:6528
  ds_read_b128 v[104:107], v45 offset:2176
  ds_read_b128 v[116:119], v45 offset:7616
  s_waitcnt lgkmcnt(4)
  v_pk_add_f32 v[96:97], v[96:97], v[108:109]
  v_pk_add_f32 v[98:99], v[98:99], v[110:111]
  s_nop 0
  v_add_f32_dpp v108, v96, v96 row_ror:8 row_mask:0xf bank_mask:0xf
  v_add_f32_dpp v109, v97, v97 row_ror:8 row_mask:0xf bank_mask:0xf
  v_add_f32_dpp v110, v98, v98 row_ror:8 row_mask:0xf bank_mask:0xf
  v_add_f32_dpp v111, v99, v99 row_ror:8 row_mask:0xf bank_mask:0xf
  v_cvt_pk_bf16_f32 v212, v108, v109
  v_cvt_pk_bf16_f32 v213, v110, v111
  s_waitcnt lgkmcnt(2)
  v_pk_add_f32 v[100:101], v[100:101], v[112:113]
  v_pk_add_f32 v[102:103], v[102:103], v[114:115]
  s_nop 0
  v_add_f32_dpp v112, v100, v100 row_ror:8 row_mask:0xf bank_mask:0xf
  v_add_f32_dpp v113, v101, v101 row_ror:8 row_mask:0xf bank_mask:0xf
  v_add_f32_dpp v114, v102, v102 row_ror:8 row_mask:0xf bank_mask:0xf
  v_add_f32_dpp v115, v103, v103 row_ror:8 row_mask:0xf bank_mask:0xf
  v_cvt_pk_bf16_f32 v214, v112, v113
  v_cvt_pk_bf16_f32 v215, v114, v115
  s_waitcnt lgkmcnt(0)
  v_pk_add_f32 v[104:105], v[104:105], v[116:117]
  v_pk_add_f32 v[106:107], v[106:107], v[118:119]
  v_mfma_f32_16x16x32_bf16 v[96:99], v[168:171], v[212:215], 0
  v_add_f32_dpp v116, v104, v104 row_ror:8 row_mask:0xf bank_mask:0xf
  v_add_f32_dpp v117, v105, v105 row_ror:8 row_mask:0xf bank_mask:0xf
  v_add_f32_dpp v118, v106, v106 row_ror:8 row_mask:0xf bank_mask:0xf
  v_add_f32_dpp v119, v107, v107 row_ror:8 row_mask:0xf bank_mask:0xf
  v_cvt_pk_bf16_f32 v216, v116, v117
  v_cvt_pk_bf16_f32 v217, v118, v119
  s_nop 1
  v_mfma_f32_16x16x32_bf16 v[96:99], v[172:175], v[216:219], v[96:99]
  s_mov_b64 exec, s[74:75]
  s_nop 6
  v_cvt_pk_f16_f32 v100, v96, v97
  v_cvt_pk_f16_f32 v101, v98, v99
  v_and_or_b32 v100, v100, -2, s88
  s_cmp_eq_u32 s53, 1
  s_cbranch_scc1 si_109
  buffer_store_dwordx2 v[100:101], v7, s[8:11], s81 offen sc1
  s_branch si_110
si_109:
  buffer_store_dwordx2 v[100:101], v7, s[8:11], s81 offen
si_110:
  s_mov_b64 exec, -1
  s_branch bw_107
bw_108:
  s_lshr_b32 s21, 4, s20
  s_bitcmp1_b32 s21, 0
  s_cbranch_scc0 bw_111
  ds_read_b128 v[96:99], v6 offset:0
  ds_read_b128 v[108:111], v6 offset:5440
  ds_read_b128 v[120:123], v6 offset:10880
  ds_read_b128 v[132:135], v6 offset:16320
  ds_read_b128 v[100:103], v6 offset:1088
  ds_read_b128 v[112:115], v6 offset:6528
  ds_read_b128 v[124:127], v6 offset:11968
  ds_read_b128 v[136:139], v6 offset:17408
  ds_read_b128 v[104:107], v6 offset:2176
  ds_read_b128 v[116:119], v6 offset:7616
  ds_read_b128 v[128:131], v6 offset:13056
  ds_read_b128 v[140:143], v6 offset:18496
  s_waitcnt lgkmcnt(8)
  v_pk_add_f32 v[96:97], v[96:97], v[108:109]
  v_pk_add_f32 v[120:121], v[120:121], v[132:133]
  v_pk_add_f32 v[98:99], v[98:99], v[110:111]
  v_pk_add_f32 v[122:123], v[122:123], v[134:135]
  v_pk_add_f32 v[96:97], v[96:97], v[120:121]
  v_pk_add_f32 v[98:99], v[98:99], v[122:123]
  v_cvt_pk_bf16_f32 v212, v96, v97
  v_cvt_pk_bf16_f32 v213, v98, v99
  s_waitcnt lgkmcnt(4)
  v_pk_add_f32 v[100:101], v[100:101], v[112:113]
  v_pk_add_f32 v[124:125], v[124:125], v[136:137]
  v_pk_add_f32 v[102:103], v[102:103], v[114:115]
  v_pk_add_f32 v[126:127], v[126:127], v[138:139]
  v_pk_add_f32 v[100:101], v[100:101], v[124:125]
  v_pk_add_f32 v[102:103], v[102:103], v[126:127]
  v_cvt_pk_bf16_f32 v214, v100, v101
  v_cvt_pk_bf16_f32 v215, v102, v103
  s_waitcnt lgkmcnt(0)
  v_pk_add_f32 v[104:105], v[104:105], v[116:117]
  v_pk_add_f32 v[128:129], v[128:129], v[140:141]
  v_pk_add_f32 v[106:107], v[106:107], v[118:119]
  v_pk_add_f32 v[130:131], v[130:131], v[142:143]
  v_mfma_f32_16x16x32_bf16 v[96:99], v[212:215], v[212:215], 0
  v_pk_add_f32 v[104:105], v[104:105], v[128:129]
  v_pk_add_f32 v[106:107], v[106:107], v[130:131]
  v_cvt_pk_bf16_f32 v216, v104, v105
  v_cvt_pk_bf16_f32 v217, v106, v107
  s_nop 1
  v_mfma_f32_16x16x32_bf16 v[96:99], v[216:219], v[216:219], v[96:99]
  s_mov_b64 exec, s[74:75]
  s_nop 6
  v_cvt_pk_f16_f32 v100, v96, v97
  v_cvt_pk_f16_f32 v101, v98, v99
  v_and_or_b32 v100, v100, -2, s88
  s_cmp_eq_u32 s53, 1
  s_cbranch_scc1 si_112
  buffer_store_dwordx2 v[100:101], v7, s[8:11], s81 offen sc1
  s_branch si_113
si_112:
  buffer_store_dwordx2 v[100:101], v7, s[8:11], s81 offen
si_113:
  s_mov_b64 exec, -1
  s_branch bw_107
bw_111:
  s_lshr_b32 s21, 8, s20
  s_bitcmp1_b32 s21, 0
  s_cbranch_scc0 bw_114
  ds_read_b128 v[96:99], v6 offset:3264
  ds_read_b128 v[100:103], v6 offset:8704
  ds_read_b128 v[104:107], v6 offset:14144
  ds_read_b128 v[108:111], v6 offset:19584
  ds_read_b128 v[112:115], v6 offset:4352
  ds_read_b128 v[116:119], v6 offset:9792
  ds_read_b128 v[120:123], v6 offset:15232
  ds_read_b128 v[124:127], v6 offset:20672
  s_waitcnt lgkmcnt(4)
  v_pk_add_f32 v[96:97], v[96:97], v[100:101]
  v_pk_add_f32 v[98:99], v[98:99], v[102:103]
  v_pk_add_f32 v[104:105], v[104:105], v[108:109]
  v_pk_add_f32 v[106:107], v[106:107], v[110:111]
  v_pk_add_f32 v[96:97], v[96:97], v[104:105]
  v_pk_add_f32 v[98:99], v[98:99], v[106:107]
  v_cvt_pk_bf16_f32 v90, v96, v97
  v_cvt_pk_bf16_f32 v91, v98, v99
  v_min_u32 v90, -2, v90
  v_min_u32 v91, -2, v91
  s_cmp_eq_u32 s53, 1
  s_cbranch_scc1 si_115
  buffer_store_dwordx2 v[90:91], v24, s[8:11], s81 offen sc1
  s_branch si_116
si_115:
  buffer_store_dwordx2 v[90:91], v24, s[8:11], s81 offen
si_116:
  s_waitcnt lgkmcnt(0)
  v_pk_add_f32 v[112:113], v[112:113], v[116:117]
  v_pk_add_f32 v[114:115], v[114:115], v[118:119]
  v_pk_add_f32 v[120:121], v[120:121], v[124:125]
  v_pk_add_f32 v[122:123], v[122:123], v[126:127]
  v_pk_add_f32 v[112:113], v[112:113], v[120:121]
  v_pk_add_f32 v[114:115], v[114:115], v[122:123]
  s_nop 1
  v_add_f32_dpp v116, v112, v112 row_ror:8 row_mask:0xf bank_mask:0xf
  v_add_f32_dpp v117, v113, v113 row_ror:8 row_mask:0xf bank_mask:0xf
  v_add_f32_dpp v118, v114, v114 row_ror:8 row_mask:0xf bank_mask:0xf
  v_add_f32_dpp v119, v115, v115 row_ror:8 row_mask:0xf bank_mask:0xf
  v_cvt_pk_bf16_f32 v92, v116, v117
  v_cvt_pk_bf16_f32 v93, v118, v119
  v_min_u32 v92, -2, v92
  v_min_u32 v93, -2, v93
  s_mov_b64 exec, s[60:61]
  s_cmp_eq_u32 s53, 1
  s_cbranch_scc1 si_117
  buffer_store_dwordx2 v[92:93], v23, s[8:11], s78 offen sc1
  s_branch si_118
si_117:
  buffer_store_dwordx2 v[92:93], v23, s[8:11], s78 offen
si_118:
  s_mov_b64 exec, -1
  s_branch bw_107
bw_114:
bw_107:
  s_cmp_eq_u32 s52, 63
  s_cbranch_scc1 last_103
  s_mov_b32 s54, 0
pv_119:
  buffer_load_dwordx4 v[144:147], v10, s[8:11], s81 offen offset:0 sc1
  buffer_load_dwordx4 v[148:151], v10, s[8:11], s81 offen offset:1024 sc1
  buffer_load_dwordx4 v[152:155], v10, s[8:11], s81 offen offset:2048 sc1
  v_mov_b32 v188, 0
  v_mov_b32 v189, 0
  v_mov_b32 v190, 0
  v_mov_b32 v191, 0
  v_mov_b32 v192, 0
  v_mov_b32 v193, 0
  v_mov_b32 v194, 0
  v_mov_b32 v195, 0
  v_mov_b32 v196, 0
  v_mov_b32 v197, 0
  v_mov_b32 v198, 0
  v_mov_b32 v199, 0
  s_add_u32 s54, s54, 1
  s_cmp_gt_u32 s54, 131072
  s_cbranch_scc1 end0
  s_waitcnt vmcnt(0)
  v_max3_u32 v27, v144, v146, v148
  v_max3_u32 v27, v27, v150, v152
  v_max3_u32 v27, v27, v154, v154
  v_cmp_eq_u32 vcc, -1, v27
  s_nop 1
  s_cbranch_vccnz pv_119
  buffer_load_dwordx2 v[248:249], v9, s[8:11], s81 offen sc1
  buffer_load_dwordx4 v[112:115], v8, s[8:11], s81 offen offset:0 sc1
  buffer_load_dwordx4 v[116:119], v8, s[8:11], s81 offen offset:1024 sc1
  v_smfmac_f32_16x16x64_bf16 v[188:191], v[144:147], a[180:187], v44
  v_smfmac_f32_16x16x64_bf16 v[192:195], v[144:147], a[204:211], v44
  v_smfmac_f32_16x16x64_bf16 v[196:199], v[144:147], a[228:235], v44
  v_smfmac_f32_16x16x64_bf16 v[188:191], v[148:151], a[188:195], v44
  v_smfmac_f32_16x16x64_bf16 v[192:195], v[148:151], a[212:219], v44
  v_smfmac_f32_16x16x64_bf16 v[196:199], v[148:151], a[236:243], v44
  v_smfmac_f32_16x16x64_bf16 v[188:191], v[152:155], a[196:203], v44
  v_smfmac_f32_16x16x64_bf16 v[192:195], v[152:155], a[220:227], v44
  v_smfmac_f32_16x16x64_bf16 v[196:199], v[152:155], a[244:251], v44
  v_readfirstlane_b32 s21, v94
  s_add_u32 s22, s46, 8
  s_min_u32 s22, s22, 64
  s_sub_u32 s55, s21, s22
  s_sub_u32 s56, s21, s46
  s_waitcnt vmcnt(2)
  v_xor_b32 v96, s88, v248
  s_nop 0
  v_permlane16_swap_b32 v248, v249
  v_fma_mix_f32 v250, v248, 1.0, v249 op_sel:[0,0,0] op_sel_hi:[1,0,1]
  v_fma_mix_f32 v251, v248, 1.0, v249 op_sel:[1,0,1] op_sel_hi:[1,0,1]
  v_mov_b32 v248, v250
  v_mov_b32 v249, v251
  s_nop 0
  v_permlane32_swap_b32 v248, v250
  v_permlane32_swap_b32 v249, v251
  s_waitcnt vmcnt(0)
  v_bitop3_b32 v97, v112, v114, s88 bitop3:0x7e
  v_bitop3_b32 v98, v116, v118, s88 bitop3:0x7e
  v_fma_mix_f32 v120, v112, 1.0, v116 op_sel:[0,0,0] op_sel_hi:[1,0,1]
  v_or3_b32 v27, v96, v97, v98
  v_fma_mix_f32 v124, v114, 1.0, v118 op_sel:[0,0,0] op_sel_hi:[1,0,1]
  v_and_b32 v27, 1, v27
  v_fma_mix_f32 v121, v112, 1.0, v116 op_sel:[1,0,1] op_sel_hi:[1,0,1]
  v_cmp_ne_u32 vcc, 0, v27
  v_fma_mix_f32 v125, v114, 1.0, v118 op_sel:[1,0,1] op_sel_hi:[1,0,1]
  v_fma_mix_f32 v122, v113, 1.0, v117 op_sel:[0,0,0] op_sel_hi:[1,0,1]
  v_fma_mix_f32 v126, v115, 1.0, v119 op_sel:[0,0,0] op_sel_hi:[1,0,1]
  s_cbranch_vccnz psr_120
psj_121:
  s_cmp_lt_i32 s56, 0
  s_cbranch_scc1 kvw_122
kvok_123:
  buffer_load_dwordx4 v[160:163], v16, s[28:31], s64 offen offset:0 sc1
  v_fma_mix_f32 v123, v113, 1.0, v117 op_sel:[1,0,1] op_sel_hi:[1,0,1]
  buffer_load_dwordx4 v[164:167], v16, s[28:31], s65 offen offset:1024 sc1
  v_fma_mix_f32 v127, v115, 1.0, v119 op_sel:[1,0,1] op_sel_hi:[1,0,1]
  buffer_load_dwordx4 v[48:51], v16, s[28:31], s66 offen offset:2048 sc1
  v_permlane32_swap_b32 v120, v124
  v_permlane32_swap_b32 v121, v125
  v_permlane32_swap_b32 v122, v126
  s_lshr_b32 s21, 3, s20
  s_bitcmp1_b32 s21, 0
  s_cbranch_scc0 bw_125
  buffer_load_dwordx2 v[168:169], v18, s[16:19], s80 offen sc1
  s_branch bw_124
bw_125:
  s_lshr_b32 s21, 4, s20
  s_bitcmp1_b32 s21, 0
  s_cbranch_scc0 bw_126
  s_mov_b64 exec, s[62:63]
  buffer_store_dwordx2 v[212:213], v21, s[24:27], s85 offen sc1
  s_mov_b64 exec, -1
  s_branch bw_124
bw_126:
  s_lshr_b32 s21, 8, s20
  s_bitcmp1_b32 s21, 0
  s_cbranch_scc0 bw_127
  buffer_store_dwordx2 v[90:91], v25, s[24:27], s57 offen sc1
  s_branch bw_124
bw_127:
bw_124:
  v_permlane32_swap_b32 v123, v127
  v_pk_add_f32 v[120:121], v[120:121], v[124:125]
  v_pk_add_f32 v[122:123], v[122:123], v[126:127]
  s_lshr_b32 s21, 3, s20
  s_bitcmp1_b32 s21, 0
  s_cbranch_scc0 bw_129
  buffer_load_dwordx2 v[170:171], v19, s[16:19], s80 offen sc1
  s_branch bw_128
bw_129:
  s_lshr_b32 s21, 4, s20
  s_bitcmp1_b32 s21, 0
  s_cbranch_scc0 bw_130
  s_mov_b64 exec, s[62:63]
  buffer_store_dwordx2 v[214:215], v22, s[24:27], s85 offen sc1
  s_mov_b64 exec, -1
  s_branch bw_128
bw_130:
  s_lshr_b32 s21, 8, s20
  s_bitcmp1_b32 s21, 0
  s_cbranch_scc0 bw_131
  s_mov_b64 exec, s[60:61]
  buffer_store_dwordx2 v[92:93], v23, s[24:27], s57 offen sc1
  s_mov_b64 exec, -1
  s_branch bw_128
bw_131:
bw_128:
  v_pk_add_f32 v[124:125], v[248:249], v[250:251]
  v_max3_f32 v236, v120, v121, v122
  v_max3_f32 v237, v123, v124, v125
  s_lshr_b32 s21, 3, s20
  s_bitcmp1_b32 s21, 0
  s_cbranch_scc0 bw_133
  buffer_load_dwordx2 v[172:173], v20, s[16:19], s80 offen sc1
  s_branch bw_132
bw_133:
  s_lshr_b32 s21, 4, s20
  s_bitcmp1_b32 s21, 0
  s_cbranch_scc0 bw_134
  s_mov_b64 exec, s[62:63]
  buffer_store_dwordx2 v[216:217], v23, s[24:27], s85 offen sc1
  s_mov_b64 exec, -1
  s_branch bw_132
bw_134:
  s_lshr_b32 s21, 8, s20
  s_bitcmp1_b32 s21, 0
  s_cbranch_scc0 bw_135
  v_mov_b32 v240, s52
  v_mov_b32 v241, s52
  s_mov_b64 exec, 1
  buffer_store_dwordx2 v[240:241], v95, s[12:15], s90 offen sc1
  s_mov_b64 exec, -1
  s_branch bw_132
bw_135:
bw_132:
  v_max_f32 v236, v236, v237
  v_cvt_pk_bf16_f32 v228, v188, v189
  v_cvt_pk_bf16_f32 v229, v190, v191
  v_max_f32_dpp v236, v236, v236 row_ror:8 row_mask:0xf bank_mask:0xf
  v_mov_b32 v237, v236
  s_cmp_lt_i32 s55, 0
  s_cbranch_scc1 fl_136
fl_137:
  v_cvt_pk_bf16_f32 v230, v192, v193
  v_cvt_pk_bf16_f32 v231, v194, v195
  v_permlane32_swap_b32 v236, v237
  v_max_f32 v236, v236, v237
  v_mov_b32 v237, v236
  v_cvt_pk_bf16_f32 v232, v196, v197
  v_cvt_pk_bf16_f32 v233, v198, v199
  v_permlane16_swap_b32 v236, v237
  v_max_f32 v236, v236, v237
  v_mul_f32 v236, s86, v236
  v_fma_f32 v120, v120, s86, -v236
  v_fma_f32 v121, v121, s86, -v236
  v_fma_f32 v122, v122, s86, -v236
  v_fma_f32 v123, v123, s86, -v236
  v_fma_f32 v124, v124, s86, -v236
  v_fma_f32 v125, v125, s86, -v236
  v_exp_f32 v120, v120
  v_exp_f32 v121, v121
  v_exp_f32 v122, v122
  v_exp_f32 v123, v123
  v_exp_f32 v124, v124
  v_exp_f32 v125, v125
  s_mov_b64 exec, s[60:61]
  v_cvt_pk_bf16_f32 v220, v120, v121
  v_cvt_pk_bf16_f32 v221, v122, v123
  v_cvt_pk_bf16_f32 v224, v124, v125
  s_mov_b64 exec, s[62:63]
  v_cvt_pk_bf16_f32 v222, v120, v121
  v_cvt_pk_bf16_f32 v223, v122, v123
  v_cvt_pk_bf16_f32 v225, v124, v125
  s_mov_b64 exec, -1
  v_pk_add_f32 v[126:127], v[120:121], v[122:123]
  v_add_f32 v128, v124, v125
  v_mfma_f32_16x16x32_bf16 v[200:203], v[176:179], v[220:223], 0
  v_add_f32 v236, v126, v127
  v_fmac_f32 v236, v128, v89
  v_mfma_f32_16x16x32_bf16 v[204:207], v[180:183], v[220:223], 0
  v_mfma_f32_16x16x32_bf16 v[208:211], v[184:187], v[220:223], 0
  v_add_f32_dpp v236, v236, v236 row_ror:8 row_mask:0xf bank_mask:0xf
  v_mov_b32 v237, v236
  s_nop 0
  v_mfma_f32_16x16x32_bf16 v[200:203], v[228:231], v[224:227], v[200:203]
  v_mfma_f32_16x16x32_bf16 v[204:207], v[230:233], v[224:227], v[204:207]
  v_permlane32_swap_b32 v236, v237
  v_add_f32 v236, v236, v237
  v_mov_b32 v237, v236
  v_mfma_f32_16x16x32_bf16 v[208:211], v[232:235], v[224:227], v[208:211]
  s_nop 0
  v_permlane16_swap_b32 v236, v237
  v_add_f32 v236, v236, v237
  v_rcp_f32 v236, v236
  s_nop 2
  v_pk_mul_f32 v[200:201], v[200:201], v[236:237] op_sel_hi:[1,0]
  v_pk_mul_f32 v[202:203], v[202:203], v[236:237] op_sel_hi:[1,0]
  ds_write_b128 v11, v[200:203] offset:0
  v_pk_mul_f32 v[204:205], v[204:205], v[236:237] op_sel_hi:[1,0]
  v_pk_mul_f32 v[206:207], v[206:207], v[236:237] op_sel_hi:[1,0]
  ds_write_b128 v11, v[204:207] offset:1024
  v_pk_mul_f32 v[208:209], v[208:209], v[236:237] op_sel_hi:[1,0]
  v_pk_mul_f32 v[210:211], v[210:211], v[236:237] op_sel_hi:[1,0]
  ds_write_b128 v11, v[208:211] offset:2048
  s_waitcnt lgkmcnt(0)
  s_barrier
  s_lshr_b32 s21, 7, s20
  s_bitcmp1_b32 s21, 0
  s_cbranch_scc0 bw_139
  ds_read_b64 v[96:97], v12 offset:0
  ds_read_b64 v[98:99], v12 offset:128
  ds_read_b64 v[100:101], v12 offset:3072
  ds_read_b64 v[102:103], v12 offset:3200
  ds_read_b64 v[104:105], v12 offset:6144
  ds_read_b64 v[106:107], v12 offset:6272
  ds_read_b64 v[108:109], v12 offset:9216
  ds_read_b64 v[110:111], v12 offset:9344
  s_waitcnt lgkmcnt(6)
  v_pk_add_f32 v[96:97], v[96:97], v[98:99]
  s_waitcnt lgkmcnt(4)
  v_pk_add_f32 v[100:101], v[100:101], v[102:103]
  s_waitcnt lgkmcnt(2)
  v_pk_add_f32 v[104:105], v[104:105], v[106:107]
  v_pk_add_f32 v[96:97], v[96:97], v[100:101]
  s_waitcnt lgkmcnt(0)
  v_pk_add_f32 v[108:109], v[108:109], v[110:111]
  v_pk_add_f32 v[96:97], v[96:97], v[104:105]
  v_pk_add_f32 v[96:97], v[96:97], v[108:109]
  v_cvt_pk_f16_f32 v100, v96, v97
  v_perm_b32 v100, s91, v100, v14
  buffer_atomic_pk_add_f16 v100, v13, s[4:7], s3 offen
  s_branch bw_138
bw_139:
  s_lshr_b32 s21, 8, s20
  s_bitcmp1_b32 s21, 0
  s_cbranch_scc0 bw_140
  v_mov_b32 v28, -1
  v_mov_b32 v29, -1
  s_cmp_eq_u32 s53, 1
  s_cbranch_scc1 si_141
  buffer_store_dwordx2 v[28:29], v24, s[8:11], s82 offen sc1
  s_branch si_142
si_141:
  buffer_store_dwordx2 v[28:29], v24, s[8:11], s82 offen
si_142:
  s_mov_b64 exec, s[60:61]
  s_add_u32 s22, s82, 278528
  s_cmp_eq_u32 s53, 1
  s_cbranch_scc1 si_143
  buffer_store_dwordx2 v[28:29], v23, s[8:11], s22 offen sc1
  s_branch si_144
si_143:
  buffer_store_dwordx2 v[28:29], v23, s[8:11], s22 offen
si_144:
  s_and_b32 s21, s52, 7
  s_cmp_lg_u32 s21, s50
  s_cbranch_scc1 zm_145
  s_mov_b64 exec, s[70:71]
  buffer_store_dwordx4 v[156:159], v13, s[4:7], s83 offen sc1
zm_145:
  s_mov_b64 exec, -1
  s_branch bw_138
bw_140:
bw_138:
  s_add_u32 s23, s52, 2
  s_min_u32 s23, s23, 63
  s_sub_u32 s21, s23, 64
  s_mul_i32 s21, s21, 160
  s_add_u32 s21, s21, s89
  s_lshl_b32 s21, s21, 14
  s_add_u32 s64, s21, s67
  s_lshr_b32 s22, s64, 8
  s_xor_b32 s64, s64, s22
  s_xor_b32 s64, s64, s68
  s_and_b32 s64, s64, 8192
  s_add_u32 s64, s64, s21
  s_add_u32 s64, s64, 83886080
  s_mul_i32 s21, s23, 160
  s_add_u32 s21, s21, s89
  s_lshl_b32 s21, s21, 13
  s_cmp_lt_u32 s23, 64
  s_cselect_b32 s64, s21, s64
  s_add_u32 s69, s89, 1
  s_sub_u32 s21, s23, 64
  s_mul_i32 s21, s21, 160
  s_add_u32 s21, s21, s69
  s_lshl_b32 s21, s21, 14
  s_add_u32 s66, s21, s67
  s_lshr_b32 s22, s66, 8
  s_xor_b32 s66, s66, s22
  s_xor_b32 s66, s66, s68
  s_and_b32 s66, s66, 8192
  s_add_u32 s66, s66, s21
  s_add_u32 s66, s66, 83886080
  s_mul_i32 s21, s23, 160
  s_add_u32 s21, s21, s69
  s_lshl_b32 s21, s21, 13
  s_cmp_lt_u32 s23, 64
  s_cselect_b32 s66, s21, s66
  s_lshl_b32 s21, s87, 10
  s_add_u32 s64, s64, s21
  s_add_u32 s66, s66, s21
  s_sub_u32 s66, s66, 8192
  s_cmp_lt_u32 s87, 7
  s_cselect_b32 s65, s64, s66
  s_cmp_lt_u32 s87, 6
  s_cselect_b32 s66, s64, s66
  s_add_u32 s52, s52, 1
  s_and_b32 s21, s52, 3
  s_mul_i32 s81, s21, 540672
  s_lshl_b32 s84, s21, 15
  s_branch step_102
pm_104:
  s_sleep 2
  buffer_load_dwordx4 v[96:99], v4, s[4:7], s84 offen offset:0 sc1
  buffer_load_dwordx4 v[100:103], v4, s[4:7], s84 offen offset:1024 sc1
  buffer_load_dwordx4 v[104:107], v4, s[4:7], s84 offen offset:2048 sc1
  s_add_u32 s54, s54, 1
  s_cmp_gt_u32 s54, 131072
  s_cbranch_scc1 end0
  s_waitcnt vmcnt(0)
  v_bitop3_b32 v27, v99, v103, v107 bitop3:0x80
  v_cvt_f32_f16 v108, v99
  v_and_b32 v27, 0x48000000, v27
  v_cvt_f32_f16 v109, v103
  v_cmp_ne_u32 vcc, 0x48000000, v27
  v_cvt_f32_f16 v110, v106
  v_cvt_f32_f16_sdwa v111, v106 dst_sel:DWORD dst_unused:UNUSED_PAD src0_sel:WORD_1
  v_cvt_pk_bf16_f32 v40, v110, v111
  s_cbranch_vccnz pm_104
  s_branch pm_105
A1_39:
  v_smfmac_f32_16x16x32_bf16 v[52:55], v[40:41], a[16:19], v44
  v_smfmac_f32_16x16x32_bf16 v[64:67], v[40:41], a[76:79], v44
  v_smfmac_f32_16x16x32_bf16 v[56:59], v[40:41], a[36:39], v44
  v_smfmac_f32_16x16x32_bf16 v[68:71], v[40:41], a[96:99], v44
  v_smfmac_f32_16x16x32_bf16 v[60:63], v[40:41], a[56:59], v44
  v_smfmac_f32_16x16x32_bf16 v[72:75], v[40:41], a[116:119], v44
  v_smfmac_f32_16x16x32_bf16 v[76:79], v[40:41], a[136:139], v44
  v_smfmac_f32_16x16x32_bf16 v[80:83], v[40:41], a[156:159], v44
  v_smfmac_f32_16x16x32_bf16 v[84:87], v[40:41], a[176:179], v44
  s_branch A2_106
psr_120:
  buffer_load_dwordx2 v[248:249], v9, s[8:11], s81 offen sc1
  buffer_load_dwordx4 v[112:115], v8, s[8:11], s81 offen offset:0 sc1
  buffer_load_dwordx4 v[116:119], v8, s[8:11], s81 offen offset:1024 sc1
  s_add_u32 s54, s54, 1
  s_cmp_gt_u32 s54, 131072
  s_cbranch_scc1 end0
  s_waitcnt vmcnt(2)
  v_xor_b32 v96, s88, v248
  s_nop 0
  v_permlane16_swap_b32 v248, v249
  v_fma_mix_f32 v250, v248, 1.0, v249 op_sel:[0,0,0] op_sel_hi:[1,0,1]
  v_fma_mix_f32 v251, v248, 1.0, v249 op_sel:[1,0,1] op_sel_hi:[1,0,1]
  v_mov_b32 v248, v250
  v_mov_b32 v249, v251
  s_nop 0
  v_permlane32_swap_b32 v248, v250
  v_permlane32_swap_b32 v249, v251
  s_waitcnt vmcnt(0)
  v_bitop3_b32 v97, v112, v114, s88 bitop3:0x7e
  v_bitop3_b32 v98, v116, v118, s88 bitop3:0x7e
  v_fma_mix_f32 v120, v112, 1.0, v116 op_sel:[0,0,0] op_sel_hi:[1,0,1]
  v_or3_b32 v27, v96, v97, v98
  v_fma_mix_f32 v124, v114, 1.0, v118 op_sel:[0,0,0] op_sel_hi:[1,0,1]
  v_and_b32 v27, 1, v27
  v_fma_mix_f32 v121, v112, 1.0, v116 op_sel:[1,0,1] op_sel_hi:[1,0,1]
  v_cmp_ne_u32 vcc, 0, v27
  v_fma_mix_f32 v125, v114, 1.0, v118 op_sel:[1,0,1] op_sel_hi:[1,0,1]
  v_fma_mix_f32 v122, v113, 1.0, v117 op_sel:[0,0,0] op_sel_hi:[1,0,1]
  v_fma_mix_f32 v126, v115, 1.0, v119 op_sel:[0,0,0] op_sel_hi:[1,0,1]
  s_cbranch_vccnz psr_120
  s_branch psj_121
kvw_122:
  v_mov_b32 v236, 0
  s_mov_b32 s101, 0
wf_146:
  buffer_load_dword v237, v236, s[12:15], s79 offen sc1
  s_add_u32 s101, s101, 1
  s_cmp_gt_u32 s101, 131072
  s_cbranch_scc1 end0
  s_waitcnt vmcnt(0)
  v_readfirstlane_b32 s100, v237
  s_cmp_ge_u32 s100, s46
  s_cbranch_scc1 wf_147
  s_sleep 1
  s_branch wf_146
wf_147:
  s_branch kvok_123
fl_136:
  buffer_load_dword v94, v95, s[12:15], s79 offen sc1
  s_branch fl_137
last_103:
  s_lshr_b32 s21, 1, s20
  s_bitcmp1_b32 s21, 0
  s_cbranch_scc0 bw_149
  v_mov_b32 v246, 80
  v_mov_b32 v247, 1
  s_mov_b64 exec, 1
  buffer_atomic_add v247, v246, s[32:35], 0 offen sc0 sc1
  s_mov_b64 exec, -1
clm_150:
  s_branch bw_148
bw_149:
bw_148:
  s_lshr_b32 s21, 4, s20
  s_bitcmp1_b32 s21, 0
  s_cbranch_scc0 bw_152
  s_mov_b64 exec, s[62:63]
  buffer_store_dwordx2 v[212:213], v21, s[24:27], s85 offen sc1
  buffer_store_dwordx2 v[214:215], v22, s[24:27], s85 offen sc1
  buffer_store_dwordx2 v[216:217], v23, s[24:27], s85 offen sc1
  s_mov_b64 exec, 1
  s_waitcnt vmcnt(0)
  v_mov_b32 v236, 64
  buffer_store_dword v236, v95, s[12:15], s90 offen sc1
  s_mov_b64 exec, -1
  s_branch bw_151
bw_152:
  s_lshr_b32 s21, 8, s20
  s_bitcmp1_b32 s21, 0
  s_cbranch_scc0 bw_153
  buffer_store_dwordx2 v[90:91], v25, s[24:27], s57 offen sc1
  s_mov_b64 exec, s[60:61]
  buffer_store_dwordx2 v[92:93], v23, s[24:27], s57 offen sc1
  s_mov_b64 exec, 1
  s_waitcnt vmcnt(0)
  v_mov_b32 v236, 64
  buffer_store_dword v236, v95, s[12:15], s90 offen offset:4 sc1
  s_mov_b64 exec, -1
  s_branch bw_151
bw_153:
bw_151:
  s_branch chain_done
chain_done:
  s_waitcnt vmcnt(0) lgkmcnt(0)
  s_barrier
  s_mov_b32 s84, 0
  s_mov_b32 s85, -1
  s_mov_b32 s86, 0
  v_mov_b32 v21, 0
  v_mov_b32 v23, v247
  s_cmp_lg_u32 s20, 0
  s_cbranch_scc1 queue_b
  s_mov_b64 exec, 1
  s_branch queue_a
end0:
  s_endpgm
gemm_side:
  s_bfe_u32 s23, s22, 0x20005
  s_add_u32 s22, s22, 31
  s_and_b32 s22, s22, 31
  s_lshl_b32 s21, s23, 3
  s_add_u32 s2, s21, s22
  s_add_u32 s3, s2, 72
  s_add_u32 s24, s2, 48
  s_add_u32 s2, s2, s21
  s_cmp_lt_u32 s22, 24
  s_cselect_b32 s3, s24, s3
  s_cmp_lt_u32 s22, 16
  s_cselect_b32 s3, s2, s3
  s_mov_b32 s2, s3
  s_cmp_ge_u32 s3, 64
  s_cbranch_scc1 not_kv
  s_load_dwordx2 s[4:5], s[0:1], 0
  s_load_dwordx2 s[6:7], s[0:1], 24
  s_load_dwordx2 s[36:37], s[0:1], 32
  s_load_dwordx2 s[38:39], s[0:1], 104
  s_and_b32 s43, s3, 1
  s_bfe_u32 s42, s3, 0x50001
  s_lshr_b32 s40, s42, 2
  s_waitcnt lgkmcnt(0)
  s_cmp_eq_u32 s43, 1
  s_cselect_b32 s6, s36, s6
  s_cselect_b32 s7, s37, s7
  s_mov_b32 s8, s4
  s_mov_b32 s9, s5
  s_mov_b32 s10, 2621440
  s_mov_b32 s11, 0x00020000
  s_mov_b32 s12, s6
  s_mov_b32 s13, s7
  s_mov_b32 s14, 7864320
  s_mov_b32 s15, 0x00020000
  s_mov_b32 s16, s38
  s_mov_b32 s17, s39
  s_mov_b32 s18, 50331648
  s_mov_b32 s19, 0x00020000
  s_mul_i32 s44, s42, 384
  s_mov_b32 s24, 0
  s_mov_b32 s25, 81920
  s_mov_b32 s64, s32
  s_mov_b32 s65, s33
  s_mov_b32 s66, s34
  s_mov_b32 s67, s35
  s_load_dwordx2 s[72:73], s[0:1], 104
  s_waitcnt lgkmcnt(0)
  s_add_u32 s72, s72, 81068032
  s_addc_u32 s73, s73, 0
  s_mov_b32 s74, 115712
  s_mov_b32 s75, 0x00020000
  v_mov_b32 v9, 2731
  v_add_u32 v8, 0, v1
  v_mul_u32_u24 v7, v8, v9
  v_lshrrev_b32 v7, 16, v7
  v_mul_u32_u24 v4, 24, v7
  v_sub_u32 v8, v8, v4
  s_mov_b32 s21, 12288
  v_mul_lo_u32 v7, v7, s21
  v_lshl_add_u32 v4, v8, 4, v7
  v_add_u32 v8, 64, v1
  v_mul_u32_u24 v7, v8, v9
  v_lshrrev_b32 v7, 16, v7
  v_mul_u32_u24 v5, 24, v7
  v_sub_u32 v8, v8, v5
  s_mov_b32 s21, 12288
  v_mul_lo_u32 v7, v7, s21
  v_lshl_add_u32 v5, v8, 4, v7
  v_add_u32 v8, 128, v1
  v_mul_u32_u24 v7, v8, v9
  v_lshrrev_b32 v7, 16, v7
  v_mul_u32_u24 v6, 24, v7
  v_sub_u32 v8, v8, v6
  s_mov_b32 s21, 12288
  v_mul_lo_u32 v7, v7, s21
  v_lshl_add_u32 v6, v8, 4, v7
  v_lshrrev_b32 v7, 2, v2
  v_lshl_add_u32 v7, v3, 3, v7
  v_mul_u32_u24 v7, 384, v7
  v_and_b32 v8, 3, v2
  v_lshlrev_b32 v8, 3, v8
  s_mul_i32 s21, s20, 96
  v_add3_u32 v7, v7, v8, s21
  v_add_u32 v8, 49152, v7
  s_mul_i32 s21, s20, 393216
  s_add_u32 s21, s21, 0
  s_add_u32 s21, s21, s44
  s_mul_i32 s22, s20, 12288
  s_add_u32 s22, s22, 0
  s_add_u32 m0, s22, 0
  s_nop 0
  buffer_load_dwordx4 v4, s[12:15], s21 offen lds
  s_add_u32 m0, s22, 1024
  s_nop 0
  buffer_load_dwordx4 v5, s[12:15], s21 offen lds
  s_add_u32 m0, s22, 2048
  s_nop 0
  buffer_load_dwordx4 v6, s[12:15], s21 offen lds
  s_mul_i32 s21, s20, 393216
  s_add_u32 s21, s21, 98304
  s_add_u32 s21, s21, s44
  s_mul_i32 s22, s20, 12288
  s_add_u32 s22, s22, 3072
  s_add_u32 m0, s22, 0
  s_nop 0
  buffer_load_dwordx4 v4, s[12:15], s21 offen lds
  s_add_u32 m0, s22, 1024
  s_nop 0
  buffer_load_dwordx4 v5, s[12:15], s21 offen lds
  s_add_u32 m0, s22, 2048
  s_nop 0
  buffer_load_dwordx4 v6, s[12:15], s21 offen lds
  s_mul_i32 s21, s20, 393216
  s_add_u32 s21, s21, 196608
  s_add_u32 s21, s21, s44
  s_mul_i32 s22, s20, 12288
  s_add_u32 s22, s22, 6144
  s_add_u32 m0, s22, 0
  s_nop 0
  buffer_load_dwordx4 v4, s[12:15], s21 offen lds
  s_add_u32 m0, s22, 1024
  s_nop 0
  buffer_load_dwordx4 v5, s[12:15], s21 offen lds
  s_add_u32 m0, s22, 2048
  s_nop 0
  buffer_load_dwordx4 v6, s[12:15], s21 offen lds
  s_mul_i32 s21, s20, 393216
  s_add_u32 s21, s21, 294912
  s_add_u32 s21, s21, s44
  s_mul_i32 s22, s20, 12288
  s_add_u32 s22, s22, 9216
  s_add_u32 m0, s22, 0
  s_nop 0
  buffer_load_dwordx4 v4, s[12:15], s21 offen lds
  s_add_u32 m0, s22, 1024
  s_nop 0
  buffer_load_dwordx4 v5, s[12:15], s21 offen lds
  s_add_u32 m0, s22, 2048
  s_nop 0
  buffer_load_dwordx4 v6, s[12:15], s21 offen lds
  v_lshrrev_b32 v11, 3, v1
  v_and_b32 v12, 7, v1
  v_xor_b32 v12, v12, v11
  v_mul_u32_u24 v11, 1280, v11
  v_lshl_add_u32 v10, v12, 4, v11
  s_mov_b32 s30, s24
  s_mov_b32 s31, 0
  s_mov_b32 s32, 98304
  s_mul_i32 s46, s20, 20480
  s_add_u32 s46, s46, s30
  s_lshl_b32 s47, s20, 11
  s_add_u32 s47, s47, s32
  s_add_u32 m0, s47, 0
  s_nop 0
  buffer_load_dwordx4 v10, s[8:11], s46 offen lds
  s_add_u32 s46, s46, 10240
  s_add_u32 m0, s47, 1024
  s_nop 0
  buffer_load_dwordx4 v10, s[8:11], s46 offen lds
  s_add_u32 s30, s30, 128
  s_add_u32 s31, s31, 1
  s_cmp_lt_u32 s31, 10
  s_cbranch_scc1 kvm_154
  s_mov_b32 s31, 0
  s_add_u32 s30, s30, s25
  s_sub_u32 s30, s30, 1280

kvm_154:
  s_add_u32 s32, s32, 8192
  s_cmp_lt_u32 s32, 155648
  s_cselect_b32 s32, s32, 98304
  s_mul_i32 s46, s20, 20480
  s_add_u32 s46, s46, s30
  s_lshl_b32 s47, s20, 11
  s_add_u32 s47, s47, s32
  s_add_u32 m0, s47, 0
  s_nop 0
  buffer_load_dwordx4 v10, s[8:11], s46 offen lds
  s_add_u32 s46, s46, 10240
  s_add_u32 m0, s47, 1024
  s_nop 0
  buffer_load_dwordx4 v10, s[8:11], s46 offen lds
  s_add_u32 s30, s30, 128
  s_add_u32 s31, s31, 1
  s_cmp_lt_u32 s31, 10
  s_cbranch_scc1 kvm_155
  s_mov_b32 s31, 0
  s_add_u32 s30, s30, s25
  s_sub_u32 s30, s30, 1280

kvm_155:
  s_add_u32 s32, s32, 8192
  s_cmp_lt_u32 s32, 155648
  s_cselect_b32 s32, s32, 98304
  s_mul_i32 s46, s20, 20480
  s_add_u32 s46, s46, s30
  s_lshl_b32 s47, s20, 11
  s_add_u32 s47, s47, s32
  s_add_u32 m0, s47, 0
  s_nop 0
  buffer_load_dwordx4 v10, s[8:11], s46 offen lds
  s_add_u32 s46, s46, 10240
  s_add_u32 m0, s47, 1024
  s_nop 0
  buffer_load_dwordx4 v10, s[8:11], s46 offen lds
  s_add_u32 s30, s30, 128
  s_add_u32 s31, s31, 1
  s_cmp_lt_u32 s31, 10
  s_cbranch_scc1 kvm_156
  s_mov_b32 s31, 0
  s_add_u32 s30, s30, s25
  s_sub_u32 s30, s30, 1280

kvm_156:
  s_add_u32 s32, s32, 8192
  s_cmp_lt_u32 s32, 155648
  s_cselect_b32 s32, s32, 98304
  s_mul_i32 s46, s20, 20480
  s_add_u32 s46, s46, s30
  s_lshl_b32 s47, s20, 11
  s_add_u32 s47, s47, s32
  s_add_u32 m0, s47, 0
  s_nop 0
  buffer_load_dwordx4 v10, s[8:11], s46 offen lds
  s_add_u32 s46, s46, 10240
  s_add_u32 m0, s47, 1024
  s_nop 0
  buffer_load_dwordx4 v10, s[8:11], s46 offen lds
  s_add_u32 s30, s30, 128
  s_add_u32 s31, s31, 1
  s_cmp_lt_u32 s31, 10
  s_cbranch_scc1 kvm_157
  s_mov_b32 s31, 0
  s_add_u32 s30, s30, s25
  s_sub_u32 s30, s30, 1280

kvm_157:
  s_add_u32 s32, s32, 8192
  s_cmp_lt_u32 s32, 155648
  s_cselect_b32 s32, s32, 98304
  s_mul_i32 s46, s20, 20480
  s_add_u32 s46, s46, s30
  s_lshl_b32 s47, s20, 11
  s_add_u32 s47, s47, s32
  s_add_u32 m0, s47, 0
  s_nop 0
  buffer_load_dwordx4 v10, s[8:11], s46 offen lds
  s_add_u32 s46, s46, 10240
  s_add_u32 m0, s47, 1024
  s_nop 0
  buffer_load_dwordx4 v10, s[8:11], s46 offen lds
  s_add_u32 s30, s30, 128
  s_add_u32 s31, s31, 1
  s_cmp_lt_u32 s31, 10
  s_cbranch_scc1 kvm_158
  s_mov_b32 s31, 0
  s_add_u32 s30, s30, s25
  s_sub_u32 s30, s30, 1280

kvm_158:
  s_add_u32 s32, s32, 8192
  s_cmp_lt_u32 s32, 155648
  s_cselect_b32 s32, s32, 98304
  s_mul_i32 s21, s20, 393216
  s_add_u32 s21, s21, 1572864
  s_add_u32 s21, s21, s44
  s_mul_i32 s22, s20, 12288
  s_add_u32 s22, s22, 49152
  s_add_u32 m0, s22, 0
  s_nop 0
  buffer_load_dwordx4 v4, s[12:15], s21 offen lds
  s_add_u32 m0, s22, 1024
  s_nop 0
  buffer_load_dwordx4 v5, s[12:15], s21 offen lds
  s_add_u32 m0, s22, 2048
  s_nop 0
  buffer_load_dwordx4 v6, s[12:15], s21 offen lds
  s_mul_i32 s21, s20, 393216
  s_add_u32 s21, s21, 1671168
  s_add_u32 s21, s21, s44
  s_mul_i32 s22, s20, 12288
  s_add_u32 s22, s22, 52224
  s_add_u32 m0, s22, 0
  s_nop 0
  buffer_load_dwordx4 v4, s[12:15], s21 offen lds
  s_add_u32 m0, s22, 1024
  s_nop 0
  buffer_load_dwordx4 v5, s[12:15], s21 offen lds
  s_add_u32 m0, s22, 2048
  s_nop 0
  buffer_load_dwordx4 v6, s[12:15], s21 offen lds
  s_mul_i32 s21, s20, 393216
  s_add_u32 s21, s21, 1769472
  s_add_u32 s21, s21, s44
  s_mul_i32 s22, s20, 12288
  s_add_u32 s22, s22, 55296
  s_add_u32 m0, s22, 0
  s_nop 0
  buffer_load_dwordx4 v4, s[12:15], s21 offen lds
  s_add_u32 m0, s22, 1024
  s_nop 0
  buffer_load_dwordx4 v5, s[12:15], s21 offen lds
  s_add_u32 m0, s22, 2048
  s_nop 0
  buffer_load_dwordx4 v6, s[12:15], s21 offen lds
  s_mul_i32 s21, s20, 393216
  s_add_u32 s21, s21, 1867776
  s_add_u32 s21, s21, s44
  s_mul_i32 s22, s20, 12288
  s_add_u32 s22, s22, 58368
  s_add_u32 m0, s22, 0
  s_nop 0
  buffer_load_dwordx4 v4, s[12:15], s21 offen lds
  s_add_u32 m0, s22, 1024
  s_nop 0
  buffer_load_dwordx4 v5, s[12:15], s21 offen lds
  s_add_u32 m0, s22, 2048
  s_nop 0
  buffer_load_dwordx4 v6, s[12:15], s21 offen lds
  s_waitcnt vmcnt(12)
  s_barrier
  ds_read_b64_tr_b16 a[0:1], v7 offset:0
  ds_read_b64_tr_b16 a[2:3], v7 offset:1536
  ds_read_b64_tr_b16 a[4:5], v7 offset:32
  ds_read_b64_tr_b16 a[6:7], v7 offset:1568
  ds_read_b64_tr_b16 a[8:9], v7 offset:64
  ds_read_b64_tr_b16 a[10:11], v7 offset:1600
  ds_read_b64_tr_b16 a[12:13], v7 offset:12288
  ds_read_b64_tr_b16 a[14:15], v7 offset:13824
  ds_read_b64_tr_b16 a[16:17], v7 offset:12320
  ds_read_b64_tr_b16 a[18:19], v7 offset:13856
  ds_read_b64_tr_b16 a[20:21], v7 offset:12352
  ds_read_b64_tr_b16 a[22:23], v7 offset:13888
  ds_read_b64_tr_b16 a[24:25], v7 offset:24576
  ds_read_b64_tr_b16 a[26:27], v7 offset:26112
  ds_read_b64_tr_b16 a[28:29], v7 offset:24608
  ds_read_b64_tr_b16 a[30:31], v7 offset:26144
  ds_read_b64_tr_b16 a[32:33], v7 offset:24640
  ds_read_b64_tr_b16 a[34:35], v7 offset:26176
  ds_read_b64_tr_b16 a[36:37], v7 offset:36864
  ds_read_b64_tr_b16 a[38:39], v7 offset:38400
  ds_read_b64_tr_b16 a[40:41], v7 offset:36896
  ds_read_b64_tr_b16 a[42:43], v7 offset:38432
  ds_read_b64_tr_b16 a[44:45], v7 offset:36928
  ds_read_b64_tr_b16 a[46:47], v7 offset:38464
  s_waitcnt lgkmcnt(0)
  s_barrier
  s_mul_i32 s21, s20, 393216
  s_add_u32 s21, s21, 3145728
  s_add_u32 s21, s21, s44
  s_mul_i32 s22, s20, 12288
  s_add_u32 s22, s22, 0
  s_add_u32 m0, s22, 0
  s_nop 0
  buffer_load_dwordx4 v4, s[12:15], s21 offen lds
  s_add_u32 m0, s22, 1024
  s_nop 0
  buffer_load_dwordx4 v5, s[12:15], s21 offen lds
  s_add_u32 m0, s22, 2048
  s_nop 0
  buffer_load_dwordx4 v6, s[12:15], s21 offen lds
  s_mul_i32 s21, s20, 393216
  s_add_u32 s21, s21, 3244032
  s_add_u32 s21, s21, s44
  s_mul_i32 s22, s20, 12288
  s_add_u32 s22, s22, 3072
  s_add_u32 m0, s22, 0
  s_nop 0
  buffer_load_dwordx4 v4, s[12:15], s21 offen lds
  s_add_u32 m0, s22, 1024
  s_nop 0
  buffer_load_dwordx4 v5, s[12:15], s21 offen lds
  s_add_u32 m0, s22, 2048
  s_nop 0
  buffer_load_dwordx4 v6, s[12:15], s21 offen lds
  s_mul_i32 s21, s20, 393216
  s_add_u32 s21, s21, 3342336
  s_add_u32 s21, s21, s44
  s_mul_i32 s22, s20, 12288
  s_add_u32 s22, s22, 6144
  s_add_u32 m0, s22, 0
  s_nop 0
  buffer_load_dwordx4 v4, s[12:15], s21 offen lds
  s_add_u32 m0, s22, 1024
  s_nop 0
  buffer_load_dwordx4 v5, s[12:15], s21 offen lds
  s_add_u32 m0, s22, 2048
  s_nop 0
  buffer_load_dwordx4 v6, s[12:15], s21 offen lds
  s_mul_i32 s21, s20, 393216
  s_add_u32 s21, s21, 3440640
  s_add_u32 s21, s21, s44
  s_mul_i32 s22, s20, 12288
  s_add_u32 s22, s22, 9216
  s_add_u32 m0, s22, 0
  s_nop 0
  buffer_load_dwordx4 v4, s[12:15], s21 offen lds
  s_add_u32 m0, s22, 1024
  s_nop 0
  buffer_load_dwordx4 v5, s[12:15], s21 offen lds
  s_add_u32 m0, s22, 2048
  s_nop 0
  buffer_load_dwordx4 v6, s[12:15], s21 offen lds
  s_waitcnt vmcnt(12)
  s_barrier
  ds_read_b64_tr_b16 a[48:49], v8 offset:0
  ds_read_b64_tr_b16 a[50:51], v8 offset:1536
  ds_read_b64_tr_b16 a[52:53], v8 offset:32
  ds_read_b64_tr_b16 a[54:55], v8 offset:1568
  ds_read_b64_tr_b16 a[56:57], v8 offset:64
  ds_read_b64_tr_b16 a[58:59], v8 offset:1600
  ds_read_b64_tr_b16 a[60:61], v8 offset:12288
  ds_read_b64_tr_b16 a[62:63], v8 offset:13824
  ds_read_b64_tr_b16 a[64:65], v8 offset:12320
  ds_read_b64_tr_b16 a[66:67], v8 offset:13856
  ds_read_b64_tr_b16 a[68:69], v8 offset:12352
  ds_read_b64_tr_b16 a[70:71], v8 offset:13888
  ds_read_b64_tr_b16 a[72:73], v8 offset:24576
  ds_read_b64_tr_b16 a[74:75], v8 offset:26112
  ds_read_b64_tr_b16 a[76:77], v8 offset:24608
  ds_read_b64_tr_b16 a[78:79], v8 offset:26144
  ds_read_b64_tr_b16 a[80:81], v8 offset:24640
  ds_read_b64_tr_b16 a[82:83], v8 offset:26176
  ds_read_b64_tr_b16 a[84:85], v8 offset:36864
  ds_read_b64_tr_b16 a[86:87], v8 offset:38400
  ds_read_b64_tr_b16 a[88:89], v8 offset:36896
  ds_read_b64_tr_b16 a[90:91], v8 offset:38432
  ds_read_b64_tr_b16 a[92:93], v8 offset:36928
  ds_read_b64_tr_b16 a[94:95], v8 offset:38464
  s_waitcnt lgkmcnt(0)
  s_barrier
  s_mul_i32 s21, s20, 393216
  s_add_u32 s21, s21, 4718592
  s_add_u32 s21, s21, s44
  s_mul_i32 s22, s20, 12288
  s_add_u32 s22, s22, 49152
  s_add_u32 m0, s22, 0
  s_nop 0
  buffer_load_dwordx4 v4, s[12:15], s21 offen lds
  s_add_u32 m0, s22, 1024
  s_nop 0
  buffer_load_dwordx4 v5, s[12:15], s21 offen lds
  s_add_u32 m0, s22, 2048
  s_nop 0
  buffer_load_dwordx4 v6, s[12:15], s21 offen lds
  s_mul_i32 s21, s20, 393216
  s_add_u32 s21, s21, 4816896
  s_add_u32 s21, s21, s44
  s_mul_i32 s22, s20, 12288
  s_add_u32 s22, s22, 52224
  s_add_u32 m0, s22, 0
  s_nop 0
  buffer_load_dwordx4 v4, s[12:15], s21 offen lds
  s_add_u32 m0, s22, 1024
  s_nop 0
  buffer_load_dwordx4 v5, s[12:15], s21 offen lds
  s_add_u32 m0, s22, 2048
  s_nop 0
  buffer_load_dwordx4 v6, s[12:15], s21 offen lds
  s_mul_i32 s21, s20, 393216
  s_add_u32 s21, s21, 4915200
  s_add_u32 s21, s21, s44
  s_mul_i32 s22, s20, 12288
  s_add_u32 s22, s22, 55296
  s_add_u32 m0, s22, 0
  s_nop 0
  buffer_load_dwordx4 v4, s[12:15], s21 offen lds
  s_add_u32 m0, s22, 1024
  s_nop 0
  buffer_load_dwordx4 v5, s[12:15], s21 offen lds
  s_add_u32 m0, s22, 2048
  s_nop 0
  buffer_load_dwordx4 v6, s[12:15], s21 offen lds
  s_mul_i32 s21, s20, 393216
  s_add_u32 s21, s21, 5013504
  s_add_u32 s21, s21, s44
  s_mul_i32 s22, s20, 12288
  s_add_u32 s22, s22, 58368
  s_add_u32 m0, s22, 0
  s_nop 0
  buffer_load_dwordx4 v4, s[12:15], s21 offen lds
  s_add_u32 m0, s22, 1024
  s_nop 0
  buffer_load_dwordx4 v5, s[12:15], s21 offen lds
  s_add_u32 m0, s22, 2048
  s_nop 0
  buffer_load_dwordx4 v6, s[12:15], s21 offen lds
  v_mov_b32 v29, 76
  buffer_load_dword v29, v29, s[64:67], 0 offen sc1
  s_waitcnt vmcnt(12)
  s_barrier
  ds_read_b64_tr_b16 a[96:97], v7 offset:0
  ds_read_b64_tr_b16 a[98:99], v7 offset:1536
  ds_read_b64_tr_b16 a[100:101], v7 offset:32
  ds_read_b64_tr_b16 a[102:103], v7 offset:1568
  ds_read_b64_tr_b16 a[104:105], v7 offset:64
  ds_read_b64_tr_b16 a[106:107], v7 offset:1600
  ds_read_b64_tr_b16 a[108:109], v7 offset:12288
  ds_read_b64_tr_b16 a[110:111], v7 offset:13824
  ds_read_b64_tr_b16 a[112:113], v7 offset:12320
  ds_read_b64_tr_b16 a[114:115], v7 offset:13856
  ds_read_b64_tr_b16 a[116:117], v7 offset:12352
  ds_read_b64_tr_b16 a[118:119], v7 offset:13888
  ds_read_b64_tr_b16 a[120:121], v7 offset:24576
  ds_read_b64_tr_b16 a[122:123], v7 offset:26112
  ds_read_b64_tr_b16 a[124:125], v7 offset:24608
  ds_read_b64_tr_b16 a[126:127], v7 offset:26144
  ds_read_b64_tr_b16 a[128:129], v7 offset:24640
  ds_read_b64_tr_b16 a[130:131], v7 offset:26176
  ds_read_b64_tr_b16 a[132:133], v7 offset:36864
  ds_read_b64_tr_b16 a[134:135], v7 offset:38400
  ds_read_b64_tr_b16 a[136:137], v7 offset:36896
  ds_read_b64_tr_b16 a[138:139], v7 offset:38432
  ds_read_b64_tr_b16 a[140:141], v7 offset:36928
  ds_read_b64_tr_b16 a[142:143], v7 offset:38464
  s_waitcnt lgkmcnt(0)
  s_barrier
  s_mul_i32 s21, s20, 393216
  s_add_u32 s21, s21, 6291456
  s_add_u32 s21, s21, s44
  s_mul_i32 s22, s20, 12288
  s_add_u32 s22, s22, 0
  s_add_u32 m0, s22, 0
  s_nop 0
  buffer_load_dwordx4 v4, s[12:15], s21 offen lds
  s_add_u32 m0, s22, 1024
  s_nop 0
  buffer_load_dwordx4 v5, s[12:15], s21 offen lds
  s_add_u32 m0, s22, 2048
  s_nop 0
  buffer_load_dwordx4 v6, s[12:15], s21 offen lds
  s_mul_i32 s21, s20, 393216
  s_add_u32 s21, s21, 6389760
  s_add_u32 s21, s21, s44
  s_mul_i32 s22, s20, 12288
  s_add_u32 s22, s22, 3072
  s_add_u32 m0, s22, 0
  s_nop 0
  buffer_load_dwordx4 v4, s[12:15], s21 offen lds
  s_add_u32 m0, s22, 1024
  s_nop 0
  buffer_load_dwordx4 v5, s[12:15], s21 offen lds
  s_add_u32 m0, s22, 2048
  s_nop 0
  buffer_load_dwordx4 v6, s[12:15], s21 offen lds
  s_mul_i32 s21, s20, 393216
  s_add_u32 s21, s21, 6488064
  s_add_u32 s21, s21, s44
  s_mul_i32 s22, s20, 12288
  s_add_u32 s22, s22, 6144
  s_add_u32 m0, s22, 0
  s_nop 0
  buffer_load_dwordx4 v4, s[12:15], s21 offen lds
  s_add_u32 m0, s22, 1024
  s_nop 0
  buffer_load_dwordx4 v5, s[12:15], s21 offen lds
  s_add_u32 m0, s22, 2048
  s_nop 0
  buffer_load_dwordx4 v6, s[12:15], s21 offen lds
  s_mul_i32 s21, s20, 393216
  s_add_u32 s21, s21, 6586368
  s_add_u32 s21, s21, s44
  s_mul_i32 s22, s20, 12288
  s_add_u32 s22, s22, 9216
  s_add_u32 m0, s22, 0
  s_nop 0
  buffer_load_dwordx4 v4, s[12:15], s21 offen lds
  s_add_u32 m0, s22, 1024
  s_nop 0
  buffer_load_dwordx4 v5, s[12:15], s21 offen lds
  s_add_u32 m0, s22, 2048
  s_nop 0
  buffer_load_dwordx4 v6, s[12:15], s21 offen lds
  s_waitcnt vmcnt(12)
  s_barrier
  ds_read_b64_tr_b16 a[144:145], v8 offset:0
  ds_read_b64_tr_b16 a[146:147], v8 offset:1536
  ds_read_b64_tr_b16 a[148:149], v8 offset:32
  ds_read_b64_tr_b16 a[150:151], v8 offset:1568
  ds_read_b64_tr_b16 a[152:153], v8 offset:64
  ds_read_b64_tr_b16 a[154:155], v8 offset:1600
  ds_read_b64_tr_b16 a[156:157], v8 offset:12288
  ds_read_b64_tr_b16 a[158:159], v8 offset:13824
  ds_read_b64_tr_b16 a[160:161], v8 offset:12320
  ds_read_b64_tr_b16 a[162:163], v8 offset:13856
  ds_read_b64_tr_b16 a[164:165], v8 offset:12352
  ds_read_b64_tr_b16 a[166:167], v8 offset:13888
  ds_read_b64_tr_b16 a[168:169], v8 offset:24576
  ds_read_b64_tr_b16 a[170:171], v8 offset:26112
  ds_read_b64_tr_b16 a[172:173], v8 offset:24608
  ds_read_b64_tr_b16 a[174:175], v8 offset:26144
  ds_read_b64_tr_b16 a[176:177], v8 offset:24640
  ds_read_b64_tr_b16 a[178:179], v8 offset:26176
  ds_read_b64_tr_b16 a[180:181], v8 offset:36864
  ds_read_b64_tr_b16 a[182:183], v8 offset:38400
  ds_read_b64_tr_b16 a[184:185], v8 offset:36896
  ds_read_b64_tr_b16 a[186:187], v8 offset:38432
  ds_read_b64_tr_b16 a[188:189], v8 offset:36928
  ds_read_b64_tr_b16 a[190:191], v8 offset:38464
  s_waitcnt lgkmcnt(0)
  s_barrier
  s_waitcnt vmcnt(0)
  s_barrier
  ds_read_b64_tr_b16 a[192:193], v7 offset:0
  ds_read_b64_tr_b16 a[194:195], v7 offset:1536
  ds_read_b64_tr_b16 a[196:197], v7 offset:32
  ds_read_b64_tr_b16 a[198:199], v7 offset:1568
  ds_read_b64_tr_b16 a[200:201], v7 offset:64
  ds_read_b64_tr_b16 a[202:203], v7 offset:1600
  ds_read_b64_tr_b16 a[204:205], v7 offset:12288
  ds_read_b64_tr_b16 a[206:207], v7 offset:13824
  ds_read_b64_tr_b16 a[208:209], v7 offset:12320
  ds_read_b64_tr_b16 a[210:211], v7 offset:13856
  ds_read_b64_tr_b16 a[212:213], v7 offset:12352
  ds_read_b64_tr_b16 a[214:215], v7 offset:13888
  ds_read_b64_tr_b16 a[216:217], v7 offset:24576
  ds_read_b64_tr_b16 a[218:219], v7 offset:26112
  ds_read_b64_tr_b16 a[220:221], v7 offset:24608
  ds_read_b64_tr_b16 a[222:223], v7 offset:26144
  ds_read_b64_tr_b16 a[224:225], v7 offset:24640
  ds_read_b64_tr_b16 a[226:227], v7 offset:26176
  ds_read_b64_tr_b16 a[228:229], v7 offset:36864
  ds_read_b64_tr_b16 a[230:231], v7 offset:38400
  ds_read_b64_tr_b16 a[232:233], v7 offset:36896
  ds_read_b64_tr_b16 a[234:235], v7 offset:38432
  ds_read_b64_tr_b16 a[236:237], v7 offset:36928
  ds_read_b64_tr_b16 a[238:239], v7 offset:38464
  s_waitcnt lgkmcnt(0)
  s_barrier
  s_mov_b32 s26, 4
  s_mul_i32 s27, s42, 12288
  s_mul_i32 s21, s43, 25165824
  s_add_u32 s27, s27, s21
  s_mov_b32 s28, 786432
  v_readfirstlane_b32 s21, v29
  s_cmp_lg_u32 s21, 0
  s_cbranch_scc1 kvz_159
  s_mov_b32 s21, 76
  v_mov_b32 v4, 0
  s_mov_b32 s101, 0
wf_160:
  buffer_load_dword v5, v4, s[64:67], s21 offen sc1
  s_add_u32 s101, s101, 1
  s_cmp_gt_u32 s101, 131072
  s_cbranch_scc1 main_end
  s_waitcnt vmcnt(0)
  v_readfirstlane_b32 s100, v5
  s_cmp_ge_u32 s100, 1
  s_cbranch_scc1 wf_161
  s_sleep 8
  s_branch wf_160
wf_161:
kvz_159:
  s_lshl_b32 s60, s40, 7
  s_add_u32 s60, s60, 0
  s_mov_b32 s61, 0
  v_and_b32 v6, 7, v2
  v_add_u32 v4, 0, v3
  v_xor_b32 v4, v4, v6
  v_lshlrev_b32 v4, 4, v4
  v_lshl_add_u32 v14, v2, 7, v4
  v_add_u32 v4, 4, v3
  v_xor_b32 v4, v4, v6
  v_lshlrev_b32 v4, 4, v4
  v_lshl_add_u32 v15, v2, 7, v4
  v_mul_u32_u24 v22, 400, v2
  v_mul_u32_u24 v4, 24, v3
  s_mul_i32 s21, s20, 96
  s_add_u32 s21, s21, 0
  v_add3_u32 v22, v22, v4, s21
  v_mov_b32 v9, 2731
  s_mul_i32 s21, s20, 6400
  s_add_u32 s21, s21, 0
  v_mul_u32_u24 v4, 400, v2
  v_lshlrev_b32 v5, 4, v3
  v_add3_u32 v23, v4, v5, s21
  v_lshlrev_b32 v26, 4, v1
  s_mov_b32 s33, 98304
  s_mov_b32 s48, 0x80000000
  s_mul_i32 s46, s20, 20480
  s_add_u32 s46, s46, s30
  s_lshl_b32 s47, s20, 11
  s_add_u32 s47, s47, s32
  s_add_u32 m0, s47, 0
  s_nop 0
  buffer_load_dwordx4 v10, s[8:11], s46 offen lds
  s_waitcnt vmcnt(9)
  s_barrier
  v_add_u32 v18, s33, v14
  v_add_u32 v19, s33, v15
  s_add_u32 s33, s33, 8192
  s_cmp_lt_u32 s33, 155648
  s_cselect_b32 s33, s33, 98304
  ds_read_b128 v[160:163], v18 offset:0
  ds_read_b128 v[164:167], v18 offset:2048
  ds_read_b128 v[168:171], v18 offset:4096
  ds_read_b128 v[172:175], v18 offset:6144
kvm_blk_162:
  ds_read_b128 v[192:195], v19 offset:0
  s_waitcnt lgkmcnt(4)
  v_mfma_f32_16x16x32_bf16 v[64:67], a[0:3], v[160:163], 0
  v_mfma_f32_16x16x32_bf16 v[68:71], a[4:7], v[160:163], 0
  v_mfma_f32_16x16x32_bf16 v[72:75], a[8:11], v[160:163], 0
  ds_read_b128 v[196:199], v19 offset:2048
  s_waitcnt lgkmcnt(4)
  v_mfma_f32_16x16x32_bf16 v[76:79], a[0:3], v[164:167], 0
  v_mfma_f32_16x16x32_bf16 v[80:83], a[4:7], v[164:167], 0
  v_mfma_f32_16x16x32_bf16 v[84:87], a[8:11], v[164:167], 0
  s_add_u32 s46, s46, 10240
  s_add_u32 m0, s47, 1024
  s_nop 0
  buffer_load_dwordx4 v10, s[8:11], s46 offen lds
  ds_read_b128 v[200:203], v19 offset:4096
  s_waitcnt lgkmcnt(4)
  v_mfma_f32_16x16x32_bf16 v[88:91], a[0:3], v[168:171], 0
  v_mfma_f32_16x16x32_bf16 v[92:95], a[4:7], v[168:171], 0
  v_mfma_f32_16x16x32_bf16 v[96:99], a[8:11], v[168:171], 0
  ds_read_b128 v[204:207], v19 offset:6144
  s_waitcnt lgkmcnt(4)
  v_mfma_f32_16x16x32_bf16 v[100:103], a[0:3], v[172:175], 0
  v_mfma_f32_16x16x32_bf16 v[104:107], a[4:7], v[172:175], 0
  v_mfma_f32_16x16x32_bf16 v[108:111], a[8:11], v[172:175], 0
  s_waitcnt vmcnt(8)
  s_barrier
  s_add_u32 s30, s30, 128
  s_add_u32 s31, s31, 1
  s_cmp_lt_u32 s31, 10
  s_cbranch_scc1 kvm_163
  s_mov_b32 s31, 0
  s_add_u32 s30, s30, s25
  s_sub_u32 s30, s30, 1280

kvm_163:
  s_add_u32 s32, s32, 8192
  s_cmp_lt_u32 s32, 155648
  s_cselect_b32 s32, s32, 98304
  s_mul_i32 s46, s20, 20480
  s_add_u32 s46, s46, s30
  s_lshl_b32 s47, s20, 11
  s_add_u32 s47, s47, s32
  v_add_u32 v18, s33, v14
  v_add_u32 v19, s33, v15
  s_add_u32 s33, s33, 8192
  s_cmp_lt_u32 s33, 155648
  s_cselect_b32 s33, s33, 98304
  ds_read_b128 v[160:163], v18 offset:0
  s_waitcnt lgkmcnt(4)
  v_mfma_f32_16x16x32_bf16 v[64:67], a[12:15], v[192:195], v[64:67]
  v_mfma_f32_16x16x32_bf16 v[68:71], a[16:19], v[192:195], v[68:71]
  v_mfma_f32_16x16x32_bf16 v[72:75], a[20:23], v[192:195], v[72:75]
  ds_read_b128 v[224:227], v23 offset:0
  ds_read_b128 v[164:167], v18 offset:2048
  s_waitcnt lgkmcnt(4)
  v_mfma_f32_16x16x32_bf16 v[76:79], a[12:15], v[196:199], v[76:79]
  v_mfma_f32_16x16x32_bf16 v[80:83], a[16:19], v[196:199], v[80:83]
  v_mfma_f32_16x16x32_bf16 v[84:87], a[20:23], v[196:199], v[84:87]
  s_add_u32 m0, s47, 0
  s_nop 0
  buffer_load_dwordx4 v10, s[8:11], s46 offen lds
  ds_read_b128 v[228:231], v23 offset:64
  ds_read_b128 v[168:171], v18 offset:4096
  s_waitcnt lgkmcnt(4)
  v_mfma_f32_16x16x32_bf16 v[88:91], a[12:15], v[200:203], v[88:91]
  v_mfma_f32_16x16x32_bf16 v[92:95], a[16:19], v[200:203], v[92:95]
  v_mfma_f32_16x16x32_bf16 v[96:99], a[20:23], v[200:203], v[96:99]
  ds_read_b128 v[172:175], v18 offset:6144
  s_waitcnt lgkmcnt(4)
  v_mfma_f32_16x16x32_bf16 v[100:103], a[12:15], v[204:207], v[100:103]
  v_mfma_f32_16x16x32_bf16 v[104:107], a[16:19], v[204:207], v[104:107]
  v_mfma_f32_16x16x32_bf16 v[108:111], a[20:23], v[204:207], v[108:111]
  ds_read_b128 v[192:195], v19 offset:0
  s_waitcnt lgkmcnt(4)
  v_mfma_f32_16x16x32_bf16 v[64:67], a[24:27], v[160:163], v[64:67]
  v_mfma_f32_16x16x32_bf16 v[68:71], a[28:31], v[160:163], v[68:71]
  v_mfma_f32_16x16x32_bf16 v[72:75], a[32:35], v[160:163], v[72:75]
  ds_read_b128 v[232:235], v23 offset:128
  ds_read_b128 v[196:199], v19 offset:2048
  s_waitcnt lgkmcnt(4)
  v_mfma_f32_16x16x32_bf16 v[76:79], a[24:27], v[164:167], v[76:79]
  v_mfma_f32_16x16x32_bf16 v[80:83], a[28:31], v[164:167], v[80:83]
  v_mfma_f32_16x16x32_bf16 v[84:87], a[32:35], v[164:167], v[84:87]
  s_add_u32 s46, s46, 10240
  s_add_u32 m0, s47, 1024
  s_nop 0
  buffer_load_dwordx4 v10, s[8:11], s46 offen lds
  ds_read_b128 v[236:239], v23 offset:192
  ds_read_b128 v[200:203], v19 offset:4096
  s_waitcnt lgkmcnt(4)
  v_mfma_f32_16x16x32_bf16 v[88:91], a[24:27], v[168:171], v[88:91]
  v_mfma_f32_16x16x32_bf16 v[92:95], a[28:31], v[168:171], v[92:95]
  v_mfma_f32_16x16x32_bf16 v[96:99], a[32:35], v[168:171], v[96:99]
  s_add_u32 s21, s48, 0
  buffer_store_dwordx4 v[224:227], v26, s[16:19], s21 offen offset:0 sc1
  ds_read_b128 v[204:207], v19 offset:6144
  s_waitcnt lgkmcnt(4)
  v_mfma_f32_16x16x32_bf16 v[100:103], a[24:27], v[172:175], v[100:103]
  v_mfma_f32_16x16x32_bf16 v[104:107], a[28:31], v[172:175], v[104:107]
  v_mfma_f32_16x16x32_bf16 v[108:111], a[32:35], v[172:175], v[108:111]
  s_add_u32 s21, s48, 0
  buffer_store_dwordx4 v[228:231], v26, s[16:19], s21 offen offset:1024 sc1
  s_waitcnt vmcnt(10)
  s_barrier
  s_add_u32 s30, s30, 128
  s_add_u32 s31, s31, 1
  s_cmp_lt_u32 s31, 10
  s_cbranch_scc1 kvm_164
  s_mov_b32 s31, 0
  s_add_u32 s30, s30, s25
  s_sub_u32 s30, s30, 1280

kvm_164:
  s_add_u32 s32, s32, 8192
  s_cmp_lt_u32 s32, 155648
  s_cselect_b32 s32, s32, 98304
  s_mul_i32 s46, s20, 20480
  s_add_u32 s46, s46, s30
  s_lshl_b32 s47, s20, 11
  s_add_u32 s47, s47, s32
  v_add_u32 v18, s33, v14
  v_add_u32 v19, s33, v15
  s_add_u32 s33, s33, 8192
  s_cmp_lt_u32 s33, 155648
  s_cselect_b32 s33, s33, 98304
  ds_read_b128 v[160:163], v18 offset:0
  s_waitcnt lgkmcnt(4)
  v_mfma_f32_16x16x32_bf16 v[64:67], a[36:39], v[192:195], v[64:67]
  v_mfma_f32_16x16x32_bf16 v[68:71], a[40:43], v[192:195], v[68:71]
  v_mfma_f32_16x16x32_bf16 v[72:75], a[44:47], v[192:195], v[72:75]
  ds_read_b128 v[240:243], v23 offset:256
  ds_read_b128 v[164:167], v18 offset:2048
  s_waitcnt lgkmcnt(4)
  v_mfma_f32_16x16x32_bf16 v[76:79], a[36:39], v[196:199], v[76:79]
  v_mfma_f32_16x16x32_bf16 v[80:83], a[40:43], v[196:199], v[80:83]
  v_mfma_f32_16x16x32_bf16 v[84:87], a[44:47], v[196:199], v[84:87]
  s_add_u32 m0, s47, 0
  s_nop 0
  buffer_load_dwordx4 v10, s[8:11], s46 offen lds
  ds_read_b128 v[244:247], v23 offset:320
  ds_read_b128 v[168:171], v18 offset:4096
  s_waitcnt lgkmcnt(4)
  v_mfma_f32_16x16x32_bf16 v[88:91], a[36:39], v[200:203], v[88:91]
  v_mfma_f32_16x16x32_bf16 v[92:95], a[40:43], v[200:203], v[92:95]
  v_mfma_f32_16x16x32_bf16 v[96:99], a[44:47], v[200:203], v[96:99]
  s_add_u32 s21, s48, 0
  buffer_store_dwordx4 v[232:235], v26, s[16:19], s21 offen offset:2048 sc1
  ds_read_b128 v[172:175], v18 offset:6144
  s_waitcnt lgkmcnt(4)
  v_mfma_f32_16x16x32_bf16 v[100:103], a[36:39], v[204:207], v[100:103]
  v_mfma_f32_16x16x32_bf16 v[104:107], a[40:43], v[204:207], v[104:107]
  v_mfma_f32_16x16x32_bf16 v[108:111], a[44:47], v[204:207], v[108:111]
  s_add_u32 s21, s48, 0
  buffer_store_dwordx4 v[236:239], v26, s[16:19], s21 offen offset:3072 sc1
  ds_read_b128 v[192:195], v19 offset:0
  s_waitcnt lgkmcnt(4)
  v_mfma_f32_16x16x32_bf16 v[64:67], a[48:51], v[160:163], v[64:67]
  v_mfma_f32_16x16x32_bf16 v[68:71], a[52:55], v[160:163], v[68:71]
  v_mfma_f32_16x16x32_bf16 v[72:75], a[56:59], v[160:163], v[72:75]
  ds_read_b128 v[196:199], v19 offset:2048
  s_waitcnt lgkmcnt(4)
  v_mfma_f32_16x16x32_bf16 v[76:79], a[48:51], v[164:167], v[76:79]
  v_mfma_f32_16x16x32_bf16 v[80:83], a[52:55], v[164:167], v[80:83]
  v_mfma_f32_16x16x32_bf16 v[84:87], a[56:59], v[164:167], v[84:87]
  s_add_u32 s46, s46, 10240
  s_add_u32 m0, s47, 1024
  s_nop 0
  buffer_load_dwordx4 v10, s[8:11], s46 offen lds
  ds_read_b128 v[200:203], v19 offset:4096
  s_waitcnt lgkmcnt(4)
  v_mfma_f32_16x16x32_bf16 v[88:91], a[48:51], v[168:171], v[88:91]
  v_mfma_f32_16x16x32_bf16 v[92:95], a[52:55], v[168:171], v[92:95]
  v_mfma_f32_16x16x32_bf16 v[96:99], a[56:59], v[168:171], v[96:99]
  s_add_u32 s21, s48, 4096
  buffer_store_dwordx4 v[240:243], v26, s[16:19], s21 offen offset:0 sc1
  ds_read_b128 v[204:207], v19 offset:6144
  s_waitcnt lgkmcnt(4)
  v_mfma_f32_16x16x32_bf16 v[100:103], a[48:51], v[172:175], v[100:103]
  v_mfma_f32_16x16x32_bf16 v[104:107], a[52:55], v[172:175], v[104:107]
  v_mfma_f32_16x16x32_bf16 v[108:111], a[56:59], v[172:175], v[108:111]
  s_add_u32 s21, s48, 4096
  buffer_store_dwordx4 v[244:247], v26, s[16:19], s21 offen offset:1024 sc1
  s_waitcnt vmcnt(14)
  s_barrier
  s_add_u32 s30, s30, 128
  s_add_u32 s31, s31, 1
  s_cmp_lt_u32 s31, 10
  s_cbranch_scc1 kvm_165
  s_mov_b32 s31, 0
  s_add_u32 s30, s30, s25
  s_sub_u32 s30, s30, 1280

kvm_165:
  s_add_u32 s32, s32, 8192
  s_cmp_lt_u32 s32, 155648
  s_cselect_b32 s32, s32, 98304
  s_mul_i32 s46, s20, 20480
  s_add_u32 s46, s46, s30
  s_lshl_b32 s47, s20, 11
  s_add_u32 s47, s47, s32
  v_add_u32 v18, s33, v14
  v_add_u32 v19, s33, v15
  s_add_u32 s33, s33, 8192
  s_cmp_lt_u32 s33, 155648
  s_cselect_b32 s33, s33, 98304
  ds_read_b128 v[160:163], v18 offset:0
  s_waitcnt lgkmcnt(4)
  v_mfma_f32_16x16x32_bf16 v[64:67], a[60:63], v[192:195], v[64:67]
  v_mfma_f32_16x16x32_bf16 v[68:71], a[64:67], v[192:195], v[68:71]
  v_mfma_f32_16x16x32_bf16 v[72:75], a[68:71], v[192:195], v[72:75]
  ds_read_b128 v[164:167], v18 offset:2048
  s_waitcnt lgkmcnt(4)
  v_mfma_f32_16x16x32_bf16 v[76:79], a[60:63], v[196:199], v[76:79]
  v_mfma_f32_16x16x32_bf16 v[80:83], a[64:67], v[196:199], v[80:83]
  v_mfma_f32_16x16x32_bf16 v[84:87], a[68:71], v[196:199], v[84:87]
  s_add_u32 m0, s47, 0
  s_nop 0
  buffer_load_dwordx4 v10, s[8:11], s46 offen lds
  ds_read_b128 v[168:171], v18 offset:4096
  s_waitcnt lgkmcnt(4)
  v_mfma_f32_16x16x32_bf16 v[88:91], a[60:63], v[200:203], v[88:91]
  v_mfma_f32_16x16x32_bf16 v[92:95], a[64:67], v[200:203], v[92:95]
  v_mfma_f32_16x16x32_bf16 v[96:99], a[68:71], v[200:203], v[96:99]
  ds_read_b128 v[172:175], v18 offset:6144
  s_waitcnt lgkmcnt(4)
  v_mfma_f32_16x16x32_bf16 v[100:103], a[60:63], v[204:207], v[100:103]
  v_mfma_f32_16x16x32_bf16 v[104:107], a[64:67], v[204:207], v[104:107]
  v_mfma_f32_16x16x32_bf16 v[108:111], a[68:71], v[204:207], v[108:111]
  ds_read_b128 v[192:195], v19 offset:0
  s_waitcnt lgkmcnt(4)
  v_mfma_f32_16x16x32_bf16 v[64:67], a[72:75], v[160:163], v[64:67]
  v_mfma_f32_16x16x32_bf16 v[68:71], a[76:79], v[160:163], v[68:71]
  v_mfma_f32_16x16x32_bf16 v[72:75], a[80:83], v[160:163], v[72:75]
  ds_read_b128 v[196:199], v19 offset:2048
  s_waitcnt lgkmcnt(4)
  v_mfma_f32_16x16x32_bf16 v[76:79], a[72:75], v[164:167], v[76:79]
  v_mfma_f32_16x16x32_bf16 v[80:83], a[76:79], v[164:167], v[80:83]
  v_mfma_f32_16x16x32_bf16 v[84:87], a[80:83], v[164:167], v[84:87]
  s_add_u32 s46, s46, 10240
  s_add_u32 m0, s47, 1024
  s_nop 0
  buffer_load_dwordx4 v10, s[8:11], s46 offen lds
  ds_read_b128 v[200:203], v19 offset:4096
  s_waitcnt lgkmcnt(4)
  v_mfma_f32_16x16x32_bf16 v[88:91], a[72:75], v[168:171], v[88:91]
  v_mfma_f32_16x16x32_bf16 v[92:95], a[76:79], v[168:171], v[92:95]
  v_mfma_f32_16x16x32_bf16 v[96:99], a[80:83], v[168:171], v[96:99]
  ds_read_b128 v[204:207], v19 offset:6144
  s_waitcnt lgkmcnt(4)
  v_mfma_f32_16x16x32_bf16 v[100:103], a[72:75], v[172:175], v[100:103]
  v_mfma_f32_16x16x32_bf16 v[104:107], a[76:79], v[172:175], v[104:107]
  v_mfma_f32_16x16x32_bf16 v[108:111], a[80:83], v[172:175], v[108:111]
  s_waitcnt vmcnt(14)
  s_barrier
  s_add_u32 s30, s30, 128
  s_add_u32 s31, s31, 1
  s_cmp_lt_u32 s31, 10
  s_cbranch_scc1 kvm_166
  s_mov_b32 s31, 0
  s_add_u32 s30, s30, s25
  s_sub_u32 s30, s30, 1280

kvm_166:
  s_add_u32 s32, s32, 8192
  s_cmp_lt_u32 s32, 155648
  s_cselect_b32 s32, s32, 98304
  s_mul_i32 s46, s20, 20480
  s_add_u32 s46, s46, s30
  s_lshl_b32 s47, s20, 11
  s_add_u32 s47, s47, s32
  v_add_u32 v18, s33, v14
  v_add_u32 v19, s33, v15
  s_add_u32 s33, s33, 8192
  s_cmp_lt_u32 s33, 155648
  s_cselect_b32 s33, s33, 98304
  ds_read_b128 v[160:163], v18 offset:0
  s_waitcnt lgkmcnt(4)
  v_mfma_f32_16x16x32_bf16 v[64:67], a[84:87], v[192:195], v[64:67]
  v_mfma_f32_16x16x32_bf16 v[68:71], a[88:91], v[192:195], v[68:71]
  v_mfma_f32_16x16x32_bf16 v[72:75], a[92:95], v[192:195], v[72:75]
  ds_read_b128 v[164:167], v18 offset:2048
  s_waitcnt lgkmcnt(4)
  v_mfma_f32_16x16x32_bf16 v[76:79], a[84:87], v[196:199], v[76:79]
  v_mfma_f32_16x16x32_bf16 v[80:83], a[88:91], v[196:199], v[80:83]
  v_mfma_f32_16x16x32_bf16 v[84:87], a[92:95], v[196:199], v[84:87]
  s_add_u32 m0, s47, 0
  s_nop 0
  buffer_load_dwordx4 v10, s[8:11], s46 offen lds
  ds_read_b128 v[168:171], v18 offset:4096
  s_waitcnt lgkmcnt(4)
  v_mfma_f32_16x16x32_bf16 v[88:91], a[84:87], v[200:203], v[88:91]
  v_mfma_f32_16x16x32_bf16 v[92:95], a[88:91], v[200:203], v[92:95]
  v_mfma_f32_16x16x32_bf16 v[96:99], a[92:95], v[200:203], v[96:99]
  ds_read_b128 v[172:175], v18 offset:6144
  s_waitcnt lgkmcnt(4)
  v_mfma_f32_16x16x32_bf16 v[100:103], a[84:87], v[204:207], v[100:103]
  v_mfma_f32_16x16x32_bf16 v[104:107], a[88:91], v[204:207], v[104:107]
  v_mfma_f32_16x16x32_bf16 v[108:111], a[92:95], v[204:207], v[108:111]
  ds_read_b128 v[192:195], v19 offset:0
  s_waitcnt lgkmcnt(4)
  v_mfma_f32_16x16x32_bf16 v[64:67], a[96:99], v[160:163], v[64:67]
  v_mfma_f32_16x16x32_bf16 v[68:71], a[100:103], v[160:163], v[68:71]
  v_mfma_f32_16x16x32_bf16 v[72:75], a[104:107], v[160:163], v[72:75]
  ds_read_b128 v[196:199], v19 offset:2048
  s_waitcnt lgkmcnt(4)
  v_mfma_f32_16x16x32_bf16 v[76:79], a[96:99], v[164:167], v[76:79]
  v_mfma_f32_16x16x32_bf16 v[80:83], a[100:103], v[164:167], v[80:83]
  v_mfma_f32_16x16x32_bf16 v[84:87], a[104:107], v[164:167], v[84:87]
  s_add_u32 s46, s46, 10240
  s_add_u32 m0, s47, 1024
  s_nop 0
  buffer_load_dwordx4 v10, s[8:11], s46 offen lds
  ds_read_b128 v[200:203], v19 offset:4096
  s_waitcnt lgkmcnt(4)
  v_mfma_f32_16x16x32_bf16 v[88:91], a[96:99], v[168:171], v[88:91]
  v_mfma_f32_16x16x32_bf16 v[92:95], a[100:103], v[168:171], v[92:95]
  v_mfma_f32_16x16x32_bf16 v[96:99], a[104:107], v[168:171], v[96:99]
  ds_read_b128 v[204:207], v19 offset:6144
  s_waitcnt lgkmcnt(4)
  v_mfma_f32_16x16x32_bf16 v[100:103], a[96:99], v[172:175], v[100:103]
  v_mfma_f32_16x16x32_bf16 v[104:107], a[100:103], v[172:175], v[104:107]
  v_mfma_f32_16x16x32_bf16 v[108:111], a[104:107], v[172:175], v[108:111]
  s_waitcnt vmcnt(4)
  s_barrier
  s_cmp_eq_u32 s48, 0x80000000
  s_cbranch_scc1 kvm_167
  s_cmp_lg_u32 s20, 0
  s_cbranch_scc1 af_168
  v_mov_b32 v4, 0
  v_mov_b32 v5, 1
  s_mov_b64 exec, 1
  buffer_atomic_add v5, v4, s[72:75], s61 offen sc1
  s_mov_b64 exec, -1
  s_nop 1
af_168:
kvm_167:
  s_add_u32 s30, s30, 128
  s_add_u32 s31, s31, 1
  s_cmp_lt_u32 s31, 10
  s_cbranch_scc1 kvm_169
  s_mov_b32 s31, 0
  s_add_u32 s30, s30, s25
  s_sub_u32 s30, s30, 1280

kvm_169:
  s_add_u32 s32, s32, 8192
  s_cmp_lt_u32 s32, 155648
  s_cselect_b32 s32, s32, 98304
  s_mul_i32 s46, s20, 20480
  s_add_u32 s46, s46, s30
  s_lshl_b32 s47, s20, 11
  s_add_u32 s47, s47, s32
  v_add_u32 v18, s33, v14
  v_add_u32 v19, s33, v15
  s_add_u32 s33, s33, 8192
  s_cmp_lt_u32 s33, 155648
  s_cselect_b32 s33, s33, 98304
  ds_read_b128 v[160:163], v18 offset:0
  s_waitcnt lgkmcnt(4)
  v_mfma_f32_16x16x32_bf16 v[64:67], a[108:111], v[192:195], v[64:67]
  v_mfma_f32_16x16x32_bf16 v[68:71], a[112:115], v[192:195], v[68:71]
  v_mfma_f32_16x16x32_bf16 v[72:75], a[116:119], v[192:195], v[72:75]
  ds_read_b128 v[164:167], v18 offset:2048
  s_waitcnt lgkmcnt(4)
  v_mfma_f32_16x16x32_bf16 v[76:79], a[108:111], v[196:199], v[76:79]
  v_mfma_f32_16x16x32_bf16 v[80:83], a[112:115], v[196:199], v[80:83]
  v_mfma_f32_16x16x32_bf16 v[84:87], a[116:119], v[196:199], v[84:87]
  s_add_u32 m0, s47, 0
  s_nop 0
  buffer_load_dwordx4 v10, s[8:11], s46 offen lds
  ds_read_b128 v[168:171], v18 offset:4096
  s_waitcnt lgkmcnt(4)
  v_mfma_f32_16x16x32_bf16 v[88:91], a[108:111], v[200:203], v[88:91]
  v_mfma_f32_16x16x32_bf16 v[92:95], a[112:115], v[200:203], v[92:95]
  v_mfma_f32_16x16x32_bf16 v[96:99], a[116:119], v[200:203], v[96:99]
  ds_read_b128 v[172:175], v18 offset:6144
  s_waitcnt lgkmcnt(4)
  v_mfma_f32_16x16x32_bf16 v[100:103], a[108:111], v[204:207], v[100:103]
  v_mfma_f32_16x16x32_bf16 v[104:107], a[112:115], v[204:207], v[104:107]
  v_mfma_f32_16x16x32_bf16 v[108:111], a[116:119], v[204:207], v[108:111]
  ds_read_b128 v[192:195], v19 offset:0
  s_waitcnt lgkmcnt(4)
  v_mfma_f32_16x16x32_bf16 v[64:67], a[120:123], v[160:163], v[64:67]
  v_mfma_f32_16x16x32_bf16 v[68:71], a[124:127], v[160:163], v[68:71]
  v_mfma_f32_16x16x32_bf16 v[72:75], a[128:131], v[160:163], v[72:75]
  ds_read_b128 v[196:199], v19 offset:2048
  s_waitcnt lgkmcnt(4)
  v_mfma_f32_16x16x32_bf16 v[76:79], a[120:123], v[164:167], v[76:79]
  v_mfma_f32_16x16x32_bf16 v[80:83], a[124:127], v[164:167], v[80:83]
  v_mfma_f32_16x16x32_bf16 v[84:87], a[128:131], v[164:167], v[84:87]
  s_add_u32 s46, s46, 10240
  s_add_u32 m0, s47, 1024
  s_nop 0
  buffer_load_dwordx4 v10, s[8:11], s46 offen lds
  ds_read_b128 v[200:203], v19 offset:4096
  s_waitcnt lgkmcnt(4)
  v_mfma_f32_16x16x32_bf16 v[88:91], a[120:123], v[168:171], v[88:91]
  v_mfma_f32_16x16x32_bf16 v[92:95], a[124:127], v[168:171], v[92:95]
  v_mfma_f32_16x16x32_bf16 v[96:99], a[128:131], v[168:171], v[96:99]
  ds_read_b128 v[204:207], v19 offset:6144
  s_waitcnt lgkmcnt(4)
  v_mfma_f32_16x16x32_bf16 v[100:103], a[120:123], v[172:175], v[100:103]
  v_mfma_f32_16x16x32_bf16 v[104:107], a[124:127], v[172:175], v[104:107]
  v_mfma_f32_16x16x32_bf16 v[108:111], a[128:131], v[172:175], v[108:111]
  s_waitcnt vmcnt(14)
  s_barrier
  s_add_u32 s30, s30, 128
  s_add_u32 s31, s31, 1
  s_cmp_lt_u32 s31, 10
  s_cbranch_scc1 kvm_170
  s_mov_b32 s31, 0
  s_add_u32 s30, s30, s25
  s_sub_u32 s30, s30, 1280

kvm_170:
  s_add_u32 s32, s32, 8192
  s_cmp_lt_u32 s32, 155648
  s_cselect_b32 s32, s32, 98304
  s_mul_i32 s46, s20, 20480
  s_add_u32 s46, s46, s30
  s_lshl_b32 s47, s20, 11
  s_add_u32 s47, s47, s32
  v_add_u32 v18, s33, v14
  v_add_u32 v19, s33, v15
  s_add_u32 s33, s33, 8192
  s_cmp_lt_u32 s33, 155648
  s_cselect_b32 s33, s33, 98304
  ds_read_b128 v[160:163], v18 offset:0
  s_waitcnt lgkmcnt(4)
  v_mfma_f32_16x16x32_bf16 v[64:67], a[132:135], v[192:195], v[64:67]
  v_mfma_f32_16x16x32_bf16 v[68:71], a[136:139], v[192:195], v[68:71]
  v_mfma_f32_16x16x32_bf16 v[72:75], a[140:143], v[192:195], v[72:75]
  ds_read_b128 v[164:167], v18 offset:2048
  s_waitcnt lgkmcnt(4)
  v_mfma_f32_16x16x32_bf16 v[76:79], a[132:135], v[196:199], v[76:79]
  v_mfma_f32_16x16x32_bf16 v[80:83], a[136:139], v[196:199], v[80:83]
  v_mfma_f32_16x16x32_bf16 v[84:87], a[140:143], v[196:199], v[84:87]
  s_add_u32 m0, s47, 0
  s_nop 0
  buffer_load_dwordx4 v10, s[8:11], s46 offen lds
  ds_read_b128 v[168:171], v18 offset:4096
  s_waitcnt lgkmcnt(4)
  v_mfma_f32_16x16x32_bf16 v[88:91], a[132:135], v[200:203], v[88:91]
  v_mfma_f32_16x16x32_bf16 v[92:95], a[136:139], v[200:203], v[92:95]
  v_mfma_f32_16x16x32_bf16 v[96:99], a[140:143], v[200:203], v[96:99]
  ds_read_b128 v[172:175], v18 offset:6144
  s_waitcnt lgkmcnt(4)
  v_mfma_f32_16x16x32_bf16 v[100:103], a[132:135], v[204:207], v[100:103]
  v_mfma_f32_16x16x32_bf16 v[104:107], a[136:139], v[204:207], v[104:107]
  v_mfma_f32_16x16x32_bf16 v[108:111], a[140:143], v[204:207], v[108:111]
  ds_read_b128 v[192:195], v19 offset:0
  s_waitcnt lgkmcnt(4)
  v_mfma_f32_16x16x32_bf16 v[64:67], a[144:147], v[160:163], v[64:67]
  v_mfma_f32_16x16x32_bf16 v[68:71], a[148:151], v[160:163], v[68:71]
  v_mfma_f32_16x16x32_bf16 v[72:75], a[152:155], v[160:163], v[72:75]
  ds_read_b128 v[196:199], v19 offset:2048
  s_waitcnt lgkmcnt(4)
  v_mfma_f32_16x16x32_bf16 v[76:79], a[144:147], v[164:167], v[76:79]
  v_mfma_f32_16x16x32_bf16 v[80:83], a[148:151], v[164:167], v[80:83]
  v_mfma_f32_16x16x32_bf16 v[84:87], a[152:155], v[164:167], v[84:87]
  s_add_u32 s46, s46, 10240
  s_add_u32 m0, s47, 1024
  s_nop 0
  buffer_load_dwordx4 v10, s[8:11], s46 offen lds
  ds_read_b128 v[200:203], v19 offset:4096
  s_waitcnt lgkmcnt(4)
  v_mfma_f32_16x16x32_bf16 v[88:91], a[144:147], v[168:171], v[88:91]
  v_mfma_f32_16x16x32_bf16 v[92:95], a[148:151], v[168:171], v[92:95]
  v_mfma_f32_16x16x32_bf16 v[96:99], a[152:155], v[168:171], v[96:99]
  ds_read_b128 v[204:207], v19 offset:6144
  s_waitcnt lgkmcnt(4)
  v_mfma_f32_16x16x32_bf16 v[100:103], a[144:147], v[172:175], v[100:103]
  v_mfma_f32_16x16x32_bf16 v[104:107], a[148:151], v[172:175], v[104:107]
  v_mfma_f32_16x16x32_bf16 v[108:111], a[152:155], v[172:175], v[108:111]
  s_waitcnt vmcnt(10)
  s_barrier
  s_add_u32 s30, s30, 128
  s_add_u32 s31, s31, 1
  s_cmp_lt_u32 s31, 10
  s_cbranch_scc1 kvm_171
  s_mov_b32 s31, 0
  s_add_u32 s30, s30, s25
  s_sub_u32 s30, s30, 1280

kvm_171:
  s_add_u32 s32, s32, 8192
  s_cmp_lt_u32 s32, 155648
  s_cselect_b32 s32, s32, 98304
  s_mul_i32 s46, s20, 20480
  s_add_u32 s46, s46, s30
  s_lshl_b32 s47, s20, 11
  s_add_u32 s47, s47, s32
  v_add_u32 v18, s33, v14
  v_add_u32 v19, s33, v15
  s_add_u32 s33, s33, 8192
  s_cmp_lt_u32 s33, 155648
  s_cselect_b32 s33, s33, 98304
  ds_read_b128 v[160:163], v18 offset:0
  s_waitcnt lgkmcnt(4)
  v_mfma_f32_16x16x32_bf16 v[64:67], a[156:159], v[192:195], v[64:67]
  v_mfma_f32_16x16x32_bf16 v[68:71], a[160:163], v[192:195], v[68:71]
  v_mfma_f32_16x16x32_bf16 v[72:75], a[164:167], v[192:195], v[72:75]
  ds_read_b128 v[164:167], v18 offset:2048
  s_waitcnt lgkmcnt(4)
  v_mfma_f32_16x16x32_bf16 v[76:79], a[156:159], v[196:199], v[76:79]
  v_mfma_f32_16x16x32_bf16 v[80:83], a[160:163], v[196:199], v[80:83]
  v_mfma_f32_16x16x32_bf16 v[84:87], a[164:167], v[196:199], v[84:87]
  s_add_u32 m0, s47, 0
  s_nop 0
  buffer_load_dwordx4 v10, s[8:11], s46 offen lds
  ds_read_b128 v[168:171], v18 offset:4096
  s_waitcnt lgkmcnt(4)
  v_mfma_f32_16x16x32_bf16 v[88:91], a[156:159], v[200:203], v[88:91]
  v_mfma_f32_16x16x32_bf16 v[92:95], a[160:163], v[200:203], v[92:95]
  v_mfma_f32_16x16x32_bf16 v[96:99], a[164:167], v[200:203], v[96:99]
  ds_read_b128 v[172:175], v18 offset:6144
  s_waitcnt lgkmcnt(4)
  v_mfma_f32_16x16x32_bf16 v[100:103], a[156:159], v[204:207], v[100:103]
  v_mfma_f32_16x16x32_bf16 v[104:107], a[160:163], v[204:207], v[104:107]
  v_mfma_f32_16x16x32_bf16 v[108:111], a[164:167], v[204:207], v[108:111]
  ds_read_b128 v[192:195], v19 offset:0
  s_waitcnt lgkmcnt(4)
  v_mfma_f32_16x16x32_bf16 v[64:67], a[168:171], v[160:163], v[64:67]
  v_mfma_f32_16x16x32_bf16 v[68:71], a[172:175], v[160:163], v[68:71]
  v_mfma_f32_16x16x32_bf16 v[72:75], a[176:179], v[160:163], v[72:75]
  ds_read_b128 v[196:199], v19 offset:2048
  s_waitcnt lgkmcnt(4)
  v_mfma_f32_16x16x32_bf16 v[76:79], a[168:171], v[164:167], v[76:79]
  v_mfma_f32_16x16x32_bf16 v[80:83], a[172:175], v[164:167], v[80:83]
  v_mfma_f32_16x16x32_bf16 v[84:87], a[176:179], v[164:167], v[84:87]
  s_add_u32 s46, s46, 10240
  s_add_u32 m0, s47, 1024
  s_nop 0
  buffer_load_dwordx4 v10, s[8:11], s46 offen lds
  ds_read_b128 v[200:203], v19 offset:4096
  s_waitcnt lgkmcnt(4)
  v_mfma_f32_16x16x32_bf16 v[88:91], a[168:171], v[168:171], v[88:91]
  v_mfma_f32_16x16x32_bf16 v[92:95], a[172:175], v[168:171], v[92:95]
  v_mfma_f32_16x16x32_bf16 v[96:99], a[176:179], v[168:171], v[96:99]
  ds_read_b128 v[204:207], v19 offset:6144
  s_waitcnt lgkmcnt(4)
  v_mfma_f32_16x16x32_bf16 v[100:103], a[168:171], v[172:175], v[100:103]
  v_mfma_f32_16x16x32_bf16 v[104:107], a[172:175], v[172:175], v[104:107]
  v_mfma_f32_16x16x32_bf16 v[108:111], a[176:179], v[172:175], v[108:111]
  s_waitcnt vmcnt(8)
  s_barrier
  s_add_u32 s30, s30, 128
  s_add_u32 s31, s31, 1
  s_cmp_lt_u32 s31, 10
  s_cbranch_scc1 kvm_172
  s_mov_b32 s31, 0
  s_add_u32 s30, s30, s25
  s_sub_u32 s30, s30, 1280

kvm_172:
  s_add_u32 s32, s32, 8192
  s_cmp_lt_u32 s32, 155648
  s_cselect_b32 s32, s32, 98304
  s_mul_i32 s46, s20, 20480
  s_add_u32 s46, s46, s30
  s_lshl_b32 s47, s20, 11
  s_add_u32 s47, s47, s32
  v_add_u32 v18, s33, v14
  v_add_u32 v19, s33, v15
  s_add_u32 s33, s33, 8192
  s_cmp_lt_u32 s33, 155648
  s_cselect_b32 s33, s33, 98304
  ds_read_b128 v[160:163], v18 offset:0
  s_waitcnt lgkmcnt(4)
  v_mfma_f32_16x16x32_bf16 v[64:67], a[180:183], v[192:195], v[64:67]
  v_mfma_f32_16x16x32_bf16 v[68:71], a[184:187], v[192:195], v[68:71]
  v_mfma_f32_16x16x32_bf16 v[72:75], a[188:191], v[192:195], v[72:75]
  ds_read_b128 v[164:167], v18 offset:2048
  s_waitcnt lgkmcnt(4)
  v_mfma_f32_16x16x32_bf16 v[76:79], a[180:183], v[196:199], v[76:79]
  v_mfma_f32_16x16x32_bf16 v[80:83], a[184:187], v[196:199], v[80:83]
  v_mfma_f32_16x16x32_bf16 v[84:87], a[188:191], v[196:199], v[84:87]
  s_add_u32 m0, s47, 0
  s_nop 0
  buffer_load_dwordx4 v10, s[8:11], s46 offen lds
  ds_read_b128 v[168:171], v18 offset:4096
  s_waitcnt lgkmcnt(4)
  v_mfma_f32_16x16x32_bf16 v[88:91], a[180:183], v[200:203], v[88:91]
  v_mfma_f32_16x16x32_bf16 v[92:95], a[184:187], v[200:203], v[92:95]
  v_mfma_f32_16x16x32_bf16 v[96:99], a[188:191], v[200:203], v[96:99]
  ds_read_b128 v[172:175], v18 offset:6144
  s_waitcnt lgkmcnt(4)
  v_mfma_f32_16x16x32_bf16 v[100:103], a[180:183], v[204:207], v[100:103]
  v_mfma_f32_16x16x32_bf16 v[104:107], a[184:187], v[204:207], v[104:107]
  v_mfma_f32_16x16x32_bf16 v[108:111], a[188:191], v[204:207], v[108:111]
  ds_read_b128 v[192:195], v19 offset:0
  s_waitcnt lgkmcnt(4)
  v_mfma_f32_16x16x32_bf16 v[64:67], a[192:195], v[160:163], v[64:67]
  v_mfma_f32_16x16x32_bf16 v[68:71], a[196:199], v[160:163], v[68:71]
  v_mfma_f32_16x16x32_bf16 v[72:75], a[200:203], v[160:163], v[72:75]
  ds_read_b128 v[196:199], v19 offset:2048
  s_waitcnt lgkmcnt(4)
  v_mfma_f32_16x16x32_bf16 v[76:79], a[192:195], v[164:167], v[76:79]
  v_mfma_f32_16x16x32_bf16 v[80:83], a[196:199], v[164:167], v[80:83]
  v_mfma_f32_16x16x32_bf16 v[84:87], a[200:203], v[164:167], v[84:87]
  s_add_u32 s46, s46, 10240
  s_add_u32 m0, s47, 1024
  s_nop 0
  buffer_load_dwordx4 v10, s[8:11], s46 offen lds
  ds_read_b128 v[200:203], v19 offset:4096
  s_waitcnt lgkmcnt(4)
  v_mfma_f32_16x16x32_bf16 v[88:91], a[192:195], v[168:171], v[88:91]
  v_mfma_f32_16x16x32_bf16 v[92:95], a[196:199], v[168:171], v[92:95]
  v_mfma_f32_16x16x32_bf16 v[96:99], a[200:203], v[168:171], v[96:99]
  ds_read_b128 v[204:207], v19 offset:6144
  s_waitcnt lgkmcnt(4)
  v_mfma_f32_16x16x32_bf16 v[100:103], a[192:195], v[172:175], v[100:103]
  v_mfma_f32_16x16x32_bf16 v[104:107], a[196:199], v[172:175], v[104:107]
  v_mfma_f32_16x16x32_bf16 v[108:111], a[200:203], v[172:175], v[108:111]
  s_waitcnt vmcnt(8)
  s_barrier
  s_add_u32 s30, s30, 128
  s_add_u32 s31, s31, 1
  s_cmp_lt_u32 s31, 10
  s_cbranch_scc1 kvm_173
  s_mov_b32 s31, 0
  s_add_u32 s30, s30, s25
  s_sub_u32 s30, s30, 1280

kvm_173:
  s_add_u32 s32, s32, 8192
  s_cmp_lt_u32 s32, 155648
  s_cselect_b32 s32, s32, 98304
  s_mul_i32 s46, s20, 20480
  s_add_u32 s46, s46, s30
  s_lshl_b32 s47, s20, 11
  s_add_u32 s47, s47, s32
  v_add_u32 v18, s33, v14
  v_add_u32 v19, s33, v15
  s_add_u32 s33, s33, 8192
  s_cmp_lt_u32 s33, 155648
  s_cselect_b32 s33, s33, 98304
  ds_read_b128 v[160:163], v18 offset:0
  s_waitcnt lgkmcnt(4)
  v_mfma_f32_16x16x32_bf16 v[64:67], a[204:207], v[192:195], v[64:67]
  v_mfma_f32_16x16x32_bf16 v[68:71], a[208:211], v[192:195], v[68:71]
  v_mfma_f32_16x16x32_bf16 v[72:75], a[212:215], v[192:195], v[72:75]
  ds_read_b128 v[164:167], v18 offset:2048
  s_waitcnt lgkmcnt(4)
  v_mfma_f32_16x16x32_bf16 v[76:79], a[204:207], v[196:199], v[76:79]
  v_mfma_f32_16x16x32_bf16 v[80:83], a[208:211], v[196:199], v[80:83]
  v_mfma_f32_16x16x32_bf16 v[84:87], a[212:215], v[196:199], v[84:87]
  s_add_u32 m0, s47, 0
  s_nop 0
  buffer_load_dwordx4 v10, s[8:11], s46 offen lds
  ds_read_b128 v[168:171], v18 offset:4096
  s_waitcnt lgkmcnt(4)
  v_mfma_f32_16x16x32_bf16 v[88:91], a[204:207], v[200:203], v[88:91]
  v_mfma_f32_16x16x32_bf16 v[92:95], a[208:211], v[200:203], v[92:95]
  v_mfma_f32_16x16x32_bf16 v[96:99], a[212:215], v[200:203], v[96:99]
  ds_read_b128 v[172:175], v18 offset:6144
  s_waitcnt lgkmcnt(4)
  v_mfma_f32_16x16x32_bf16 v[100:103], a[204:207], v[204:207], v[100:103]
  v_mfma_f32_16x16x32_bf16 v[104:107], a[208:211], v[204:207], v[104:107]
  v_mfma_f32_16x16x32_bf16 v[108:111], a[212:215], v[204:207], v[108:111]
  ds_read_b128 v[192:195], v19 offset:0
  s_waitcnt lgkmcnt(4)
  v_mfma_f32_16x16x32_bf16 v[64:67], a[216:219], v[160:163], v[64:67]
  v_mfma_f32_16x16x32_bf16 v[68:71], a[220:223], v[160:163], v[68:71]
  v_mfma_f32_16x16x32_bf16 v[72:75], a[224:227], v[160:163], v[72:75]
  ds_read_b128 v[196:199], v19 offset:2048
  s_waitcnt lgkmcnt(4)
  v_mfma_f32_16x16x32_bf16 v[76:79], a[216:219], v[164:167], v[76:79]
  v_mfma_f32_16x16x32_bf16 v[80:83], a[220:223], v[164:167], v[80:83]
  v_mfma_f32_16x16x32_bf16 v[84:87], a[224:227], v[164:167], v[84:87]
  s_add_u32 s46, s46, 10240
  s_add_u32 m0, s47, 1024
  s_nop 0
  buffer_load_dwordx4 v10, s[8:11], s46 offen lds
  ds_read_b128 v[200:203], v19 offset:4096
  s_waitcnt lgkmcnt(4)
  v_mfma_f32_16x16x32_bf16 v[88:91], a[216:219], v[168:171], v[88:91]
  v_mfma_f32_16x16x32_bf16 v[92:95], a[220:223], v[168:171], v[92:95]
  v_mfma_f32_16x16x32_bf16 v[96:99], a[224:227], v[168:171], v[96:99]
  ds_read_b128 v[204:207], v19 offset:6144
  s_waitcnt lgkmcnt(4)
  v_mfma_f32_16x16x32_bf16 v[100:103], a[216:219], v[172:175], v[100:103]
  v_mfma_f32_16x16x32_bf16 v[104:107], a[220:223], v[172:175], v[104:107]
  v_mfma_f32_16x16x32_bf16 v[108:111], a[224:227], v[172:175], v[108:111]
  s_waitcnt vmcnt(8)
  s_barrier
  s_add_u32 s30, s30, 128
  s_add_u32 s31, s31, 1
  s_cmp_lt_u32 s31, 10
  s_cbranch_scc1 kvm_174
  s_mov_b32 s31, 0
  s_add_u32 s30, s30, s25
  s_sub_u32 s30, s30, 1280

kvm_174:
  s_add_u32 s32, s32, 8192
  s_cmp_lt_u32 s32, 155648
  s_cselect_b32 s32, s32, 98304
  s_mul_i32 s46, s20, 20480
  s_add_u32 s46, s46, s30
  s_lshl_b32 s47, s20, 11
  s_add_u32 s47, s47, s32
  v_add_u32 v18, s33, v14
  v_add_u32 v19, s33, v15
  s_add_u32 s33, s33, 8192
  s_cmp_lt_u32 s33, 155648
  s_cselect_b32 s33, s33, 98304
  ds_read_b128 v[160:163], v18 offset:0
  s_waitcnt lgkmcnt(4)
  v_mfma_f32_16x16x32_bf16 v[64:67], a[228:231], v[192:195], v[64:67]
  v_mfma_f32_16x16x32_bf16 v[68:71], a[232:235], v[192:195], v[68:71]
  v_mfma_f32_16x16x32_bf16 v[72:75], a[236:239], v[192:195], v[72:75]
  ds_read_b128 v[164:167], v18 offset:2048
  s_waitcnt lgkmcnt(4)
  v_mfma_f32_16x16x32_bf16 v[76:79], a[228:231], v[196:199], v[76:79]
  v_mfma_f32_16x16x32_bf16 v[80:83], a[232:235], v[196:199], v[80:83]
  v_mfma_f32_16x16x32_bf16 v[84:87], a[236:239], v[196:199], v[84:87]
  s_add_u32 m0, s47, 0
  s_nop 0
  buffer_load_dwordx4 v10, s[8:11], s46 offen lds
  ds_read_b128 v[168:171], v18 offset:4096
  s_waitcnt lgkmcnt(4)
  v_mfma_f32_16x16x32_bf16 v[88:91], a[228:231], v[200:203], v[88:91]
  v_mfma_f32_16x16x32_bf16 v[92:95], a[232:235], v[200:203], v[92:95]
  v_mfma_f32_16x16x32_bf16 v[96:99], a[236:239], v[200:203], v[96:99]
  ds_read_b128 v[172:175], v18 offset:6144
  s_waitcnt lgkmcnt(4)
  v_mfma_f32_16x16x32_bf16 v[100:103], a[228:231], v[204:207], v[100:103]
  v_mfma_f32_16x16x32_bf16 v[104:107], a[232:235], v[204:207], v[104:107]
  v_mfma_f32_16x16x32_bf16 v[108:111], a[236:239], v[204:207], v[108:111]
  v_cvt_pk_bf16_f32 v224, v64, v65
  v_cvt_pk_bf16_f32 v225, v66, v67
  v_cvt_pk_bf16_f32 v226, v68, v69
  v_cvt_pk_bf16_f32 v227, v70, v71
  v_cvt_pk_bf16_f32 v228, v72, v73
  v_cvt_pk_bf16_f32 v229, v74, v75
  ds_write_b64 v22, v[224:225] offset:0
  ds_write_b64 v22, v[226:227] offset:8
  ds_write_b64 v22, v[228:229] offset:16
  s_nop 4
  v_cvt_pk_bf16_f32 v230, v76, v77
  v_cvt_pk_bf16_f32 v231, v78, v79
  v_cvt_pk_bf16_f32 v232, v80, v81
  v_cvt_pk_bf16_f32 v233, v82, v83
  v_cvt_pk_bf16_f32 v234, v84, v85
  v_cvt_pk_bf16_f32 v235, v86, v87
  ds_write_b64 v22, v[230:231] offset:6400
  ds_write_b64 v22, v[232:233] offset:6408
  ds_write_b64 v22, v[234:235] offset:6416
  v_cvt_pk_bf16_f32 v224, v88, v89
  v_cvt_pk_bf16_f32 v225, v90, v91
  v_cvt_pk_bf16_f32 v226, v92, v93
  v_cvt_pk_bf16_f32 v227, v94, v95
  v_cvt_pk_bf16_f32 v228, v96, v97
  v_cvt_pk_bf16_f32 v229, v98, v99
  ds_write_b64 v22, v[224:225] offset:12800
  ds_write_b64 v22, v[226:227] offset:12808
  ds_write_b64 v22, v[228:229] offset:12816
  v_cvt_pk_bf16_f32 v230, v100, v101
  v_cvt_pk_bf16_f32 v231, v102, v103
  v_cvt_pk_bf16_f32 v232, v104, v105
  v_cvt_pk_bf16_f32 v233, v106, v107
  v_cvt_pk_bf16_f32 v234, v108, v109
  v_cvt_pk_bf16_f32 v235, v110, v111
  ds_write_b64 v22, v[230:231] offset:19200
  ds_write_b64 v22, v[232:233] offset:19208
  ds_write_b64 v22, v[234:235] offset:19216
  s_mov_b32 s61, s60
  s_add_u32 s60, s60, 1024
  s_lshr_b32 s48, s20, 1
  s_mul_i32 s48, s48, 393216
  s_and_b32 s21, s20, 1
  s_mul_i32 s21, s21, 6144
  s_add_u32 s48, s48, s21
  s_add_u32 s48, s48, s27
  s_add_u32 s27, s27, s28
  s_sub_u32 s26, s26, 1
  s_cmp_gt_u32 s26, 0
  s_cbranch_scc1 kvm_blk_162
  s_waitcnt vmcnt(0) lgkmcnt(0)
  s_barrier
  ds_read_b128 v[224:227], v23 offset:0
  ds_read_b128 v[228:231], v23 offset:64
  ds_read_b128 v[232:235], v23 offset:128
  ds_read_b128 v[236:239], v23 offset:192
  ds_read_b128 v[240:243], v23 offset:256
  ds_read_b128 v[244:247], v23 offset:320
  s_waitcnt lgkmcnt(0)
  s_add_u32 s21, s48, 0
  buffer_store_dwordx4 v[224:227], v26, s[16:19], s21 offen offset:0 sc1
  s_add_u32 s21, s48, 0
  buffer_store_dwordx4 v[228:231], v26, s[16:19], s21 offen offset:1024 sc1
  s_add_u32 s21, s48, 0
  buffer_store_dwordx4 v[232:235], v26, s[16:19], s21 offen offset:2048 sc1
  s_add_u32 s21, s48, 0
  buffer_store_dwordx4 v[236:239], v26, s[16:19], s21 offen offset:3072 sc1
  s_add_u32 s21, s48, 4096
  buffer_store_dwordx4 v[240:243], v26, s[16:19], s21 offen offset:0 sc1
  s_add_u32 s21, s48, 4096
  buffer_store_dwordx4 v[244:247], v26, s[16:19], s21 offen offset:1024 sc1
  s_nop 1
  s_mov_b32 s24, 327680
  s_mov_b32 s25, 163840
  v_lshrrev_b32 v11, 3, v1
  v_and_b32 v12, 7, v1
  v_xor_b32 v12, v12, v11
  v_mul_u32_u24 v11, 1280, v11
  v_lshl_add_u32 v10, v12, 4, v11
  s_mov_b32 s30, s24
  s_mov_b32 s31, 0
  s_mov_b32 s32, 32768
  s_mul_i32 s46, s20, 40960
  s_add_u32 s46, s46, s30
  s_lshl_b32 s47, s20, 12
  s_add_u32 s47, s47, s32
  s_add_u32 m0, s47, 0
  s_nop 0
  buffer_load_dwordx4 v10, s[8:11], s46 offen lds
  s_add_u32 s46, s46, 10240
  s_add_u32 m0, s47, 1024
  s_nop 0
  buffer_load_dwordx4 v10, s[8:11], s46 offen lds
  s_add_u32 s46, s46, 10240
  s_add_u32 m0, s47, 2048
  s_nop 0
  buffer_load_dwordx4 v10, s[8:11], s46 offen lds
  s_add_u32 s46, s46, 10240
  s_add_u32 m0, s47, 3072
  s_nop 0
  buffer_load_dwordx4 v10, s[8:11], s46 offen lds
  s_add_u32 s30, s30, 128
  s_add_u32 s31, s31, 1
  s_cmp_lt_u32 s31, 10
  s_cbranch_scc1 kv_175
  s_mov_b32 s31, 0
  s_add_u32 s30, s30, s25
  s_sub_u32 s30, s30, 1280

kv_175:
  s_add_u32 s32, s32, 16384
  s_cmp_lt_u32 s32, 98304
  s_cselect_b32 s32, s32, 0
  s_mul_i32 s46, s20, 40960
  s_add_u32 s46, s46, s30
  s_lshl_b32 s47, s20, 12
  s_add_u32 s47, s47, s32
  s_add_u32 m0, s47, 0
  s_nop 0
  buffer_load_dwordx4 v10, s[8:11], s46 offen lds
  s_add_u32 s46, s46, 10240
  s_add_u32 m0, s47, 1024
  s_nop 0
  buffer_load_dwordx4 v10, s[8:11], s46 offen lds
  s_add_u32 s46, s46, 10240
  s_add_u32 m0, s47, 2048
  s_nop 0
  buffer_load_dwordx4 v10, s[8:11], s46 offen lds
  s_add_u32 s46, s46, 10240
  s_add_u32 m0, s47, 3072
  s_nop 0
  buffer_load_dwordx4 v10, s[8:11], s46 offen lds
  s_add_u32 s30, s30, 128
  s_add_u32 s31, s31, 1
  s_cmp_lt_u32 s31, 10
  s_cbranch_scc1 kv_176
  s_mov_b32 s31, 0
  s_add_u32 s30, s30, s25
  s_sub_u32 s30, s30, 1280

kv_176:
  s_add_u32 s32, s32, 16384
  s_cmp_lt_u32 s32, 98304
  s_cselect_b32 s32, s32, 0
  s_mul_i32 s46, s20, 40960
  s_add_u32 s46, s46, s30
  s_lshl_b32 s47, s20, 12
  s_add_u32 s47, s47, s32
  s_add_u32 m0, s47, 0
  s_nop 0
  buffer_load_dwordx4 v10, s[8:11], s46 offen lds
  s_add_u32 s46, s46, 10240
  s_add_u32 m0, s47, 1024
  s_nop 0
  buffer_load_dwordx4 v10, s[8:11], s46 offen lds
  s_add_u32 s46, s46, 10240
  s_add_u32 m0, s47, 2048
  s_nop 0
  buffer_load_dwordx4 v10, s[8:11], s46 offen lds
  s_add_u32 s46, s46, 10240
  s_add_u32 m0, s47, 3072
  s_nop 0
  buffer_load_dwordx4 v10, s[8:11], s46 offen lds
  s_add_u32 s30, s30, 128
  s_add_u32 s31, s31, 1
  s_cmp_lt_u32 s31, 10
  s_cbranch_scc1 kv_177
  s_mov_b32 s31, 0
  s_add_u32 s30, s30, s25
  s_sub_u32 s30, s30, 1280

kv_177:
  s_add_u32 s32, s32, 16384
  s_cmp_lt_u32 s32, 98304
  s_cselect_b32 s32, s32, 0
  s_mul_i32 s46, s20, 40960
  s_add_u32 s46, s46, s30
  s_lshl_b32 s47, s20, 12
  s_add_u32 s47, s47, s32
  s_add_u32 m0, s47, 0
  s_nop 0
  buffer_load_dwordx4 v10, s[8:11], s46 offen lds
  s_add_u32 s46, s46, 10240
  s_add_u32 m0, s47, 1024
  s_nop 0
  buffer_load_dwordx4 v10, s[8:11], s46 offen lds
  s_add_u32 s46, s46, 10240
  s_add_u32 m0, s47, 2048
  s_nop 0
  buffer_load_dwordx4 v10, s[8:11], s46 offen lds
  s_add_u32 s46, s46, 10240
  s_add_u32 m0, s47, 3072
  s_nop 0
  buffer_load_dwordx4 v10, s[8:11], s46 offen lds
  s_add_u32 s30, s30, 128
  s_add_u32 s31, s31, 1
  s_cmp_lt_u32 s31, 10
  s_cbranch_scc1 kv_178
  s_mov_b32 s31, 0
  s_add_u32 s30, s30, s25
  s_sub_u32 s30, s30, 1280

kv_178:
  s_add_u32 s32, s32, 16384
  s_cmp_lt_u32 s32, 98304
  s_cselect_b32 s32, s32, 0
  s_waitcnt vmcnt(16)
  s_barrier
  s_cmp_lg_u32 s20, 0
  s_cbranch_scc1 af_179
  v_mov_b32 v4, 0
  v_mov_b32 v5, 1
  s_mov_b64 exec, 1
  buffer_atomic_add v5, v4, s[72:75], s61 offen sc1
  s_mov_b64 exec, -1
  s_nop 1
af_179:
  s_mov_b32 s26, 14
  s_mov_b32 s28, 1572864
  v_and_b32 v6, 7, v2
  v_add_u32 v4, 0, v3
  v_xor_b32 v4, v4, v6
  v_lshlrev_b32 v4, 4, v4
  v_lshl_add_u32 v14, v2, 7, v4
  v_add_u32 v4, 4, v3
  v_xor_b32 v4, v4, v6
  v_lshlrev_b32 v4, 4, v4
  v_lshl_add_u32 v15, v2, 7, v4
  v_mul_u32_u24 v22, 400, v2
  v_mul_u32_u24 v4, 24, v3
  s_mul_i32 s21, s20, 96
  s_add_u32 s21, s21, 98304
  v_add3_u32 v22, v22, v4, s21
  v_mov_b32 v9, 2731
  s_mul_i32 s21, s20, 12800
  s_add_u32 s21, s21, 98304
  v_mul_u32_u24 v4, 400, v2
  v_lshlrev_b32 v5, 4, v3
  v_add3_u32 v23, v4, v5, s21
  v_lshlrev_b32 v26, 4, v1
  s_mov_b32 s33, 32768
  s_mov_b32 s48, 0x80000000
  s_mul_i32 s46, s20, 40960
  s_add_u32 s46, s46, s30
  s_lshl_b32 s47, s20, 12
  s_add_u32 s47, s47, s32
  s_add_u32 m0, s47, 0
  s_nop 0
  buffer_load_dwordx4 v10, s[8:11], s46 offen lds
  s_add_u32 s46, s46, 10240
  s_add_u32 m0, s47, 1024
  s_nop 0
  buffer_load_dwordx4 v10, s[8:11], s46 offen lds
  s_waitcnt vmcnt(14)
  s_barrier
  v_add_u32 v18, s33, v14
  v_add_u32 v19, s33, v15
  s_add_u32 s33, s33, 16384
  s_cmp_lt_u32 s33, 98304
  s_cselect_b32 s33, s33, 0
  ds_read_b128 v[160:163], v18 offset:0
  ds_read_b128 v[164:167], v18 offset:2048
  ds_read_b128 v[168:171], v18 offset:4096
  ds_read_b128 v[172:175], v18 offset:6144
  ds_read_b128 v[176:179], v18 offset:8192
  ds_read_b128 v[180:183], v18 offset:10240
  ds_read_b128 v[184:187], v18 offset:12288
  ds_read_b128 v[188:191], v18 offset:14336
kv_blk_180:
  ds_read_b128 v[192:195], v19 offset:0
  s_waitcnt lgkmcnt(8)
  v_mfma_f32_16x16x32_bf16 v[64:67], a[0:3], v[160:163], 0
  v_mfma_f32_16x16x32_bf16 v[68:71], a[4:7], v[160:163], 0
  v_mfma_f32_16x16x32_bf16 v[72:75], a[8:11], v[160:163], 0
  ds_read_b128 v[196:199], v19 offset:2048
  s_waitcnt lgkmcnt(8)
  v_mfma_f32_16x16x32_bf16 v[76:79], a[0:3], v[164:167], 0
  v_mfma_f32_16x16x32_bf16 v[80:83], a[4:7], v[164:167], 0
  v_mfma_f32_16x16x32_bf16 v[84:87], a[8:11], v[164:167], 0
  s_add_u32 s46, s46, 10240
  s_add_u32 m0, s47, 2048
  s_nop 0
  buffer_load_dwordx4 v10, s[8:11], s46 offen lds
  ds_read_b128 v[200:203], v19 offset:4096
  s_waitcnt lgkmcnt(8)
  v_mfma_f32_16x16x32_bf16 v[88:91], a[0:3], v[168:171], 0
  v_mfma_f32_16x16x32_bf16 v[92:95], a[4:7], v[168:171], 0
  v_mfma_f32_16x16x32_bf16 v[96:99], a[8:11], v[168:171], 0
  ds_read_b128 v[204:207], v19 offset:6144
  s_waitcnt lgkmcnt(8)
  v_mfma_f32_16x16x32_bf16 v[100:103], a[0:3], v[172:175], 0
  v_mfma_f32_16x16x32_bf16 v[104:107], a[4:7], v[172:175], 0
  v_mfma_f32_16x16x32_bf16 v[108:111], a[8:11], v[172:175], 0
  ds_read_b128 v[208:211], v19 offset:8192
  s_waitcnt lgkmcnt(8)
  v_mfma_f32_16x16x32_bf16 v[112:115], a[0:3], v[176:179], 0
  v_mfma_f32_16x16x32_bf16 v[116:119], a[4:7], v[176:179], 0
  v_mfma_f32_16x16x32_bf16 v[120:123], a[8:11], v[176:179], 0
  ds_read_b128 v[212:215], v19 offset:10240
  s_waitcnt lgkmcnt(8)
  v_mfma_f32_16x16x32_bf16 v[124:127], a[0:3], v[180:183], 0
  v_mfma_f32_16x16x32_bf16 v[128:131], a[4:7], v[180:183], 0
  v_mfma_f32_16x16x32_bf16 v[132:135], a[8:11], v[180:183], 0
  s_add_u32 s46, s46, 10240
  s_add_u32 m0, s47, 3072
  s_nop 0
  buffer_load_dwordx4 v10, s[8:11], s46 offen lds
  ds_read_b128 v[216:219], v19 offset:12288
  s_waitcnt lgkmcnt(8)
  v_mfma_f32_16x16x32_bf16 v[136:139], a[0:3], v[184:187], 0
  v_mfma_f32_16x16x32_bf16 v[140:143], a[4:7], v[184:187], 0
  v_mfma_f32_16x16x32_bf16 v[144:147], a[8:11], v[184:187], 0
  ds_read_b128 v[220:223], v19 offset:14336
  s_waitcnt lgkmcnt(8)
  v_mfma_f32_16x16x32_bf16 v[148:151], a[0:3], v[188:191], 0
  v_mfma_f32_16x16x32_bf16 v[152:155], a[4:7], v[188:191], 0
  v_mfma_f32_16x16x32_bf16 v[156:159], a[8:11], v[188:191], 0
  s_waitcnt vmcnt(12)
  s_barrier
  s_add_u32 s30, s30, 128
  s_add_u32 s31, s31, 1
  s_cmp_lt_u32 s31, 10
  s_cbranch_scc1 kv_181
  s_mov_b32 s31, 0
  s_add_u32 s30, s30, s25
  s_sub_u32 s30, s30, 1280

kv_181:
  s_add_u32 s32, s32, 16384
  s_cmp_lt_u32 s32, 98304
  s_cselect_b32 s32, s32, 0
  s_mul_i32 s46, s20, 40960
  s_add_u32 s46, s46, s30
  s_lshl_b32 s47, s20, 12
  s_add_u32 s47, s47, s32
  v_add_u32 v18, s33, v14
  v_add_u32 v19, s33, v15
  s_add_u32 s33, s33, 16384
  s_cmp_lt_u32 s33, 98304
  s_cselect_b32 s33, s33, 0
  ds_read_b128 v[160:163], v18 offset:0
  s_waitcnt lgkmcnt(8)
  v_mfma_f32_16x16x32_bf16 v[64:67], a[12:15], v[192:195], v[64:67]
  v_mfma_f32_16x16x32_bf16 v[68:71], a[16:19], v[192:195], v[68:71]
  v_mfma_f32_16x16x32_bf16 v[72:75], a[20:23], v[192:195], v[72:75]
  ds_read_b128 v[224:227], v23 offset:0
  ds_read_b128 v[164:167], v18 offset:2048
  s_waitcnt lgkmcnt(8)
  v_mfma_f32_16x16x32_bf16 v[76:79], a[12:15], v[196:199], v[76:79]
  v_mfma_f32_16x16x32_bf16 v[80:83], a[16:19], v[196:199], v[80:83]
  v_mfma_f32_16x16x32_bf16 v[84:87], a[20:23], v[196:199], v[84:87]
  s_add_u32 m0, s47, 0
  s_nop 0
  buffer_load_dwordx4 v10, s[8:11], s46 offen lds
  ds_read_b128 v[168:171], v18 offset:4096
  s_waitcnt lgkmcnt(8)
  v_mfma_f32_16x16x32_bf16 v[88:91], a[12:15], v[200:203], v[88:91]
  v_mfma_f32_16x16x32_bf16 v[92:95], a[16:19], v[200:203], v[92:95]
  v_mfma_f32_16x16x32_bf16 v[96:99], a[20:23], v[200:203], v[96:99]
  ds_read_b128 v[172:175], v18 offset:6144
  s_waitcnt lgkmcnt(8)
  v_mfma_f32_16x16x32_bf16 v[100:103], a[12:15], v[204:207], v[100:103]
  v_mfma_f32_16x16x32_bf16 v[104:107], a[16:19], v[204:207], v[104:107]
  v_mfma_f32_16x16x32_bf16 v[108:111], a[20:23], v[204:207], v[108:111]
  ds_read_b128 v[176:179], v18 offset:8192
  s_waitcnt lgkmcnt(8)
  v_mfma_f32_16x16x32_bf16 v[112:115], a[12:15], v[208:211], v[112:115]
  v_mfma_f32_16x16x32_bf16 v[116:119], a[16:19], v[208:211], v[116:119]
  v_mfma_f32_16x16x32_bf16 v[120:123], a[20:23], v[208:211], v[120:123]
  ds_read_b128 v[228:231], v23 offset:64
  ds_read_b128 v[180:183], v18 offset:10240
  s_waitcnt lgkmcnt(8)
  v_mfma_f32_16x16x32_bf16 v[124:127], a[12:15], v[212:215], v[124:127]
  v_mfma_f32_16x16x32_bf16 v[128:131], a[16:19], v[212:215], v[128:131]
  v_mfma_f32_16x16x32_bf16 v[132:135], a[20:23], v[212:215], v[132:135]
  s_add_u32 s46, s46, 10240
  s_add_u32 m0, s47, 1024
  s_nop 0
  buffer_load_dwordx4 v10, s[8:11], s46 offen lds
  ds_read_b128 v[184:187], v18 offset:12288
  s_waitcnt lgkmcnt(8)
  v_mfma_f32_16x16x32_bf16 v[136:139], a[12:15], v[216:219], v[136:139]
  v_mfma_f32_16x16x32_bf16 v[140:143], a[16:19], v[216:219], v[140:143]
  v_mfma_f32_16x16x32_bf16 v[144:147], a[20:23], v[216:219], v[144:147]
  ds_read_b128 v[188:191], v18 offset:14336
  s_waitcnt lgkmcnt(8)
  v_mfma_f32_16x16x32_bf16 v[148:151], a[12:15], v[220:223], v[148:151]
  v_mfma_f32_16x16x32_bf16 v[152:155], a[16:19], v[220:223], v[152:155]
  v_mfma_f32_16x16x32_bf16 v[156:159], a[20:23], v[220:223], v[156:159]
  ds_read_b128 v[192:195], v19 offset:0
  s_waitcnt lgkmcnt(8)
  v_mfma_f32_16x16x32_bf16 v[64:67], a[24:27], v[160:163], v[64:67]
  v_mfma_f32_16x16x32_bf16 v[68:71], a[28:31], v[160:163], v[68:71]
  v_mfma_f32_16x16x32_bf16 v[72:75], a[32:35], v[160:163], v[72:75]
  ds_read_b128 v[232:235], v23 offset:128
  ds_read_b128 v[196:199], v19 offset:2048
  s_waitcnt lgkmcnt(8)
  v_mfma_f32_16x16x32_bf16 v[76:79], a[24:27], v[164:167], v[76:79]
  v_mfma_f32_16x16x32_bf16 v[80:83], a[28:31], v[164:167], v[80:83]
  v_mfma_f32_16x16x32_bf16 v[84:87], a[32:35], v[164:167], v[84:87]
  s_add_u32 s46, s46, 10240
  s_add_u32 m0, s47, 2048
  s_nop 0
  buffer_load_dwordx4 v10, s[8:11], s46 offen lds
  ds_read_b128 v[200:203], v19 offset:4096
  s_waitcnt lgkmcnt(8)
  v_mfma_f32_16x16x32_bf16 v[88:91], a[24:27], v[168:171], v[88:91]
  v_mfma_f32_16x16x32_bf16 v[92:95], a[28:31], v[168:171], v[92:95]
  v_mfma_f32_16x16x32_bf16 v[96:99], a[32:35], v[168:171], v[96:99]
  ds_read_b128 v[204:207], v19 offset:6144
  s_waitcnt lgkmcnt(8)
  v_mfma_f32_16x16x32_bf16 v[100:103], a[24:27], v[172:175], v[100:103]
  v_mfma_f32_16x16x32_bf16 v[104:107], a[28:31], v[172:175], v[104:107]
  v_mfma_f32_16x16x32_bf16 v[108:111], a[32:35], v[172:175], v[108:111]
  s_add_u32 s21, s48, 0
  buffer_store_dwordx4 v[224:227], v26, s[16:19], s21 offen offset:0 sc1
  ds_read_b128 v[208:211], v19 offset:8192
  s_waitcnt lgkmcnt(8)
  v_mfma_f32_16x16x32_bf16 v[112:115], a[24:27], v[176:179], v[112:115]
  v_mfma_f32_16x16x32_bf16 v[116:119], a[28:31], v[176:179], v[116:119]
  v_mfma_f32_16x16x32_bf16 v[120:123], a[32:35], v[176:179], v[120:123]
  ds_read_b128 v[236:239], v23 offset:192
  ds_read_b128 v[212:215], v19 offset:10240
  s_waitcnt lgkmcnt(8)
  v_mfma_f32_16x16x32_bf16 v[124:127], a[24:27], v[180:183], v[124:127]
  v_mfma_f32_16x16x32_bf16 v[128:131], a[28:31], v[180:183], v[128:131]
  v_mfma_f32_16x16x32_bf16 v[132:135], a[32:35], v[180:183], v[132:135]
  s_add_u32 s46, s46, 10240
  s_add_u32 m0, s47, 3072
  s_nop 0
  buffer_load_dwordx4 v10, s[8:11], s46 offen lds
  ds_read_b128 v[216:219], v19 offset:12288
  s_waitcnt lgkmcnt(8)
  v_mfma_f32_16x16x32_bf16 v[136:139], a[24:27], v[184:187], v[136:139]
  v_mfma_f32_16x16x32_bf16 v[140:143], a[28:31], v[184:187], v[140:143]
  v_mfma_f32_16x16x32_bf16 v[144:147], a[32:35], v[184:187], v[144:147]
  s_add_u32 s21, s48, 0
  buffer_store_dwordx4 v[228:231], v26, s[16:19], s21 offen offset:1024 sc1
  ds_read_b128 v[220:223], v19 offset:14336
  s_waitcnt lgkmcnt(8)
  v_mfma_f32_16x16x32_bf16 v[148:151], a[24:27], v[188:191], v[148:151]
  v_mfma_f32_16x16x32_bf16 v[152:155], a[28:31], v[188:191], v[152:155]
  v_mfma_f32_16x16x32_bf16 v[156:159], a[32:35], v[188:191], v[156:159]
  s_waitcnt vmcnt(14)
  s_barrier
  s_add_u32 s30, s30, 128
  s_add_u32 s31, s31, 1
  s_cmp_lt_u32 s31, 10
  s_cbranch_scc1 kv_182
  s_mov_b32 s31, 0
  s_add_u32 s30, s30, s25
  s_sub_u32 s30, s30, 1280

kv_182:
  s_add_u32 s32, s32, 16384
  s_cmp_lt_u32 s32, 98304
  s_cselect_b32 s32, s32, 0
  s_mul_i32 s46, s20, 40960
  s_add_u32 s46, s46, s30
  s_lshl_b32 s47, s20, 12
  s_add_u32 s47, s47, s32
  v_add_u32 v18, s33, v14
  v_add_u32 v19, s33, v15
  s_add_u32 s33, s33, 16384
  s_cmp_lt_u32 s33, 98304
  s_cselect_b32 s33, s33, 0
  ds_read_b128 v[160:163], v18 offset:0
  s_waitcnt lgkmcnt(8)
  v_mfma_f32_16x16x32_bf16 v[64:67], a[36:39], v[192:195], v[64:67]
  v_mfma_f32_16x16x32_bf16 v[68:71], a[40:43], v[192:195], v[68:71]
  v_mfma_f32_16x16x32_bf16 v[72:75], a[44:47], v[192:195], v[72:75]
  ds_read_b128 v[240:243], v23 offset:256
  ds_read_b128 v[164:167], v18 offset:2048
  s_waitcnt lgkmcnt(8)
  v_mfma_f32_16x16x32_bf16 v[76:79], a[36:39], v[196:199], v[76:79]
  v_mfma_f32_16x16x32_bf16 v[80:83], a[40:43], v[196:199], v[80:83]
  v_mfma_f32_16x16x32_bf16 v[84:87], a[44:47], v[196:199], v[84:87]
  s_add_u32 m0, s47, 0
  s_nop 0
  buffer_load_dwordx4 v10, s[8:11], s46 offen lds
  ds_read_b128 v[168:171], v18 offset:4096
  s_waitcnt lgkmcnt(8)
  v_mfma_f32_16x16x32_bf16 v[88:91], a[36:39], v[200:203], v[88:91]
  v_mfma_f32_16x16x32_bf16 v[92:95], a[40:43], v[200:203], v[92:95]
  v_mfma_f32_16x16x32_bf16 v[96:99], a[44:47], v[200:203], v[96:99]
  ds_read_b128 v[172:175], v18 offset:6144
  s_waitcnt lgkmcnt(8)
  v_mfma_f32_16x16x32_bf16 v[100:103], a[36:39], v[204:207], v[100:103]
  v_mfma_f32_16x16x32_bf16 v[104:107], a[40:43], v[204:207], v[104:107]
  v_mfma_f32_16x16x32_bf16 v[108:111], a[44:47], v[204:207], v[108:111]
  s_add_u32 s21, s48, 0
  buffer_store_dwordx4 v[232:235], v26, s[16:19], s21 offen offset:2048 sc1
  ds_read_b128 v[176:179], v18 offset:8192
  s_waitcnt lgkmcnt(8)
  v_mfma_f32_16x16x32_bf16 v[112:115], a[36:39], v[208:211], v[112:115]
  v_mfma_f32_16x16x32_bf16 v[116:119], a[40:43], v[208:211], v[116:119]
  v_mfma_f32_16x16x32_bf16 v[120:123], a[44:47], v[208:211], v[120:123]
  ds_read_b128 v[244:247], v23 offset:320
  ds_read_b128 v[180:183], v18 offset:10240
  s_waitcnt lgkmcnt(8)
  v_mfma_f32_16x16x32_bf16 v[124:127], a[36:39], v[212:215], v[124:127]
  v_mfma_f32_16x16x32_bf16 v[128:131], a[40:43], v[212:215], v[128:131]
  v_mfma_f32_16x16x32_bf16 v[132:135], a[44:47], v[212:215], v[132:135]
  s_add_u32 s46, s46, 10240
  s_add_u32 m0, s47, 1024
  s_nop 0
  buffer_load_dwordx4 v10, s[8:11], s46 offen lds
  ds_read_b128 v[184:187], v18 offset:12288
  s_waitcnt lgkmcnt(8)
  v_mfma_f32_16x16x32_bf16 v[136:139], a[36:39], v[216:219], v[136:139]
  v_mfma_f32_16x16x32_bf16 v[140:143], a[40:43], v[216:219], v[140:143]
  v_mfma_f32_16x16x32_bf16 v[144:147], a[44:47], v[216:219], v[144:147]
  s_add_u32 s21, s48, 0
  buffer_store_dwordx4 v[236:239], v26, s[16:19], s21 offen offset:3072 sc1
  ds_read_b128 v[188:191], v18 offset:14336
  s_waitcnt lgkmcnt(8)
  v_mfma_f32_16x16x32_bf16 v[148:151], a[36:39], v[220:223], v[148:151]
  v_mfma_f32_16x16x32_bf16 v[152:155], a[40:43], v[220:223], v[152:155]
  v_mfma_f32_16x16x32_bf16 v[156:159], a[44:47], v[220:223], v[156:159]
  ds_read_b128 v[192:195], v19 offset:0
  s_waitcnt lgkmcnt(8)
  v_mfma_f32_16x16x32_bf16 v[64:67], a[48:51], v[160:163], v[64:67]
  v_mfma_f32_16x16x32_bf16 v[68:71], a[52:55], v[160:163], v[68:71]
  v_mfma_f32_16x16x32_bf16 v[72:75], a[56:59], v[160:163], v[72:75]
  ds_read_b128 v[224:227], v23 offset:6400
  ds_read_b128 v[196:199], v19 offset:2048
  s_waitcnt lgkmcnt(8)
  v_mfma_f32_16x16x32_bf16 v[76:79], a[48:51], v[164:167], v[76:79]
  v_mfma_f32_16x16x32_bf16 v[80:83], a[52:55], v[164:167], v[80:83]
  v_mfma_f32_16x16x32_bf16 v[84:87], a[56:59], v[164:167], v[84:87]
  s_add_u32 s46, s46, 10240
  s_add_u32 m0, s47, 2048
  s_nop 0
  buffer_load_dwordx4 v10, s[8:11], s46 offen lds
  ds_read_b128 v[200:203], v19 offset:4096
  s_waitcnt lgkmcnt(8)
  v_mfma_f32_16x16x32_bf16 v[88:91], a[48:51], v[168:171], v[88:91]
  v_mfma_f32_16x16x32_bf16 v[92:95], a[52:55], v[168:171], v[92:95]
  v_mfma_f32_16x16x32_bf16 v[96:99], a[56:59], v[168:171], v[96:99]
  ds_read_b128 v[204:207], v19 offset:6144
  s_waitcnt lgkmcnt(8)
  v_mfma_f32_16x16x32_bf16 v[100:103], a[48:51], v[172:175], v[100:103]
  v_mfma_f32_16x16x32_bf16 v[104:107], a[52:55], v[172:175], v[104:107]
  v_mfma_f32_16x16x32_bf16 v[108:111], a[56:59], v[172:175], v[108:111]
  s_add_u32 s21, s48, 4096
  buffer_store_dwordx4 v[240:243], v26, s[16:19], s21 offen offset:0 sc1
  ds_read_b128 v[208:211], v19 offset:8192
  s_waitcnt lgkmcnt(8)
  v_mfma_f32_16x16x32_bf16 v[112:115], a[48:51], v[176:179], v[112:115]
  v_mfma_f32_16x16x32_bf16 v[116:119], a[52:55], v[176:179], v[116:119]
  v_mfma_f32_16x16x32_bf16 v[120:123], a[56:59], v[176:179], v[120:123]
  ds_read_b128 v[228:231], v23 offset:6464
  ds_read_b128 v[212:215], v19 offset:10240
  s_waitcnt lgkmcnt(8)
  v_mfma_f32_16x16x32_bf16 v[124:127], a[48:51], v[180:183], v[124:127]
  v_mfma_f32_16x16x32_bf16 v[128:131], a[52:55], v[180:183], v[128:131]
  v_mfma_f32_16x16x32_bf16 v[132:135], a[56:59], v[180:183], v[132:135]
  s_add_u32 s46, s46, 10240
  s_add_u32 m0, s47, 3072
  s_nop 0
  buffer_load_dwordx4 v10, s[8:11], s46 offen lds
  ds_read_b128 v[216:219], v19 offset:12288
  s_waitcnt lgkmcnt(8)
  v_mfma_f32_16x16x32_bf16 v[136:139], a[48:51], v[184:187], v[136:139]
  v_mfma_f32_16x16x32_bf16 v[140:143], a[52:55], v[184:187], v[140:143]
  v_mfma_f32_16x16x32_bf16 v[144:147], a[56:59], v[184:187], v[144:147]
  s_add_u32 s21, s48, 4096
  buffer_store_dwordx4 v[244:247], v26, s[16:19], s21 offen offset:1024 sc1
  ds_read_b128 v[220:223], v19 offset:14336
  s_waitcnt lgkmcnt(8)
  v_mfma_f32_16x16x32_bf16 v[148:151], a[48:51], v[188:191], v[148:151]
  v_mfma_f32_16x16x32_bf16 v[152:155], a[52:55], v[188:191], v[152:155]
  v_mfma_f32_16x16x32_bf16 v[156:159], a[56:59], v[188:191], v[156:159]
  s_waitcnt vmcnt(18)
  s_barrier
  s_add_u32 s30, s30, 128
  s_add_u32 s31, s31, 1
  s_cmp_lt_u32 s31, 10
  s_cbranch_scc1 kv_183
  s_mov_b32 s31, 0
  s_add_u32 s30, s30, s25
  s_sub_u32 s30, s30, 1280

kv_183:
  s_add_u32 s32, s32, 16384
  s_cmp_lt_u32 s32, 98304
  s_cselect_b32 s32, s32, 0
  s_mul_i32 s46, s20, 40960
  s_add_u32 s46, s46, s30
  s_lshl_b32 s47, s20, 12
  s_add_u32 s47, s47, s32
  v_add_u32 v18, s33, v14
  v_add_u32 v19, s33, v15
  s_add_u32 s33, s33, 16384
  s_cmp_lt_u32 s33, 98304
  s_cselect_b32 s33, s33, 0
  ds_read_b128 v[160:163], v18 offset:0
  s_waitcnt lgkmcnt(8)
  v_mfma_f32_16x16x32_bf16 v[64:67], a[60:63], v[192:195], v[64:67]
  v_mfma_f32_16x16x32_bf16 v[68:71], a[64:67], v[192:195], v[68:71]
  v_mfma_f32_16x16x32_bf16 v[72:75], a[68:71], v[192:195], v[72:75]
  ds_read_b128 v[232:235], v23 offset:6528
  ds_read_b128 v[164:167], v18 offset:2048
  s_waitcnt lgkmcnt(8)
  v_mfma_f32_16x16x32_bf16 v[76:79], a[60:63], v[196:199], v[76:79]
  v_mfma_f32_16x16x32_bf16 v[80:83], a[64:67], v[196:199], v[80:83]
  v_mfma_f32_16x16x32_bf16 v[84:87], a[68:71], v[196:199], v[84:87]
  s_add_u32 m0, s47, 0
  s_nop 0
  buffer_load_dwordx4 v10, s[8:11], s46 offen lds
  ds_read_b128 v[168:171], v18 offset:4096
  s_waitcnt lgkmcnt(8)
  v_mfma_f32_16x16x32_bf16 v[88:91], a[60:63], v[200:203], v[88:91]
  v_mfma_f32_16x16x32_bf16 v[92:95], a[64:67], v[200:203], v[92:95]
  v_mfma_f32_16x16x32_bf16 v[96:99], a[68:71], v[200:203], v[96:99]
  ds_read_b128 v[172:175], v18 offset:6144
  s_waitcnt lgkmcnt(8)
  v_mfma_f32_16x16x32_bf16 v[100:103], a[60:63], v[204:207], v[100:103]
  v_mfma_f32_16x16x32_bf16 v[104:107], a[64:67], v[204:207], v[104:107]
  v_mfma_f32_16x16x32_bf16 v[108:111], a[68:71], v[204:207], v[108:111]
  s_add_u32 s21, s48, 4096
  buffer_store_dwordx4 v[224:227], v26, s[16:19], s21 offen offset:2048 sc1
  ds_read_b128 v[176:179], v18 offset:8192
  s_waitcnt lgkmcnt(8)
  v_mfma_f32_16x16x32_bf16 v[112:115], a[60:63], v[208:211], v[112:115]
  v_mfma_f32_16x16x32_bf16 v[116:119], a[64:67], v[208:211], v[116:119]
  v_mfma_f32_16x16x32_bf16 v[120:123], a[68:71], v[208:211], v[120:123]
  ds_read_b128 v[236:239], v23 offset:6592
  ds_read_b128 v[180:183], v18 offset:10240
  s_waitcnt lgkmcnt(8)
  v_mfma_f32_16x16x32_bf16 v[124:127], a[60:63], v[212:215], v[124:127]
  v_mfma_f32_16x16x32_bf16 v[128:131], a[64:67], v[212:215], v[128:131]
  v_mfma_f32_16x16x32_bf16 v[132:135], a[68:71], v[212:215], v[132:135]
  s_add_u32 s46, s46, 10240
  s_add_u32 m0, s47, 1024
  s_nop 0
  buffer_load_dwordx4 v10, s[8:11], s46 offen lds
  ds_read_b128 v[184:187], v18 offset:12288
  s_waitcnt lgkmcnt(8)
  v_mfma_f32_16x16x32_bf16 v[136:139], a[60:63], v[216:219], v[136:139]
  v_mfma_f32_16x16x32_bf16 v[140:143], a[64:67], v[216:219], v[140:143]
  v_mfma_f32_16x16x32_bf16 v[144:147], a[68:71], v[216:219], v[144:147]
  s_add_u32 s21, s48, 4096
  buffer_store_dwordx4 v[228:231], v26, s[16:19], s21 offen offset:3072 sc1
  ds_read_b128 v[188:191], v18 offset:14336
  s_waitcnt lgkmcnt(8)
  v_mfma_f32_16x16x32_bf16 v[148:151], a[60:63], v[220:223], v[148:151]
  v_mfma_f32_16x16x32_bf16 v[152:155], a[64:67], v[220:223], v[152:155]
  v_mfma_f32_16x16x32_bf16 v[156:159], a[68:71], v[220:223], v[156:159]
  ds_read_b128 v[192:195], v19 offset:0
  s_waitcnt lgkmcnt(8)
  v_mfma_f32_16x16x32_bf16 v[64:67], a[72:75], v[160:163], v[64:67]
  v_mfma_f32_16x16x32_bf16 v[68:71], a[76:79], v[160:163], v[68:71]
  v_mfma_f32_16x16x32_bf16 v[72:75], a[80:83], v[160:163], v[72:75]
  ds_read_b128 v[240:243], v23 offset:6656
  ds_read_b128 v[196:199], v19 offset:2048
  s_waitcnt lgkmcnt(8)
  v_mfma_f32_16x16x32_bf16 v[76:79], a[72:75], v[164:167], v[76:79]
  v_mfma_f32_16x16x32_bf16 v[80:83], a[76:79], v[164:167], v[80:83]
  v_mfma_f32_16x16x32_bf16 v[84:87], a[80:83], v[164:167], v[84:87]
  s_add_u32 s46, s46, 10240
  s_add_u32 m0, s47, 2048
  s_nop 0
  buffer_load_dwordx4 v10, s[8:11], s46 offen lds
  ds_read_b128 v[200:203], v19 offset:4096
  s_waitcnt lgkmcnt(8)
  v_mfma_f32_16x16x32_bf16 v[88:91], a[72:75], v[168:171], v[88:91]
  v_mfma_f32_16x16x32_bf16 v[92:95], a[76:79], v[168:171], v[92:95]
  v_mfma_f32_16x16x32_bf16 v[96:99], a[80:83], v[168:171], v[96:99]
  ds_read_b128 v[204:207], v19 offset:6144
  s_waitcnt lgkmcnt(8)
  v_mfma_f32_16x16x32_bf16 v[100:103], a[72:75], v[172:175], v[100:103]
  v_mfma_f32_16x16x32_bf16 v[104:107], a[76:79], v[172:175], v[104:107]
  v_mfma_f32_16x16x32_bf16 v[108:111], a[80:83], v[172:175], v[108:111]
  s_add_u32 s21, s48, 8192
  buffer_store_dwordx4 v[232:235], v26, s[16:19], s21 offen offset:0 sc1
  ds_read_b128 v[208:211], v19 offset:8192
  s_waitcnt lgkmcnt(8)
  v_mfma_f32_16x16x32_bf16 v[112:115], a[72:75], v[176:179], v[112:115]
  v_mfma_f32_16x16x32_bf16 v[116:119], a[76:79], v[176:179], v[116:119]
  v_mfma_f32_16x16x32_bf16 v[120:123], a[80:83], v[176:179], v[120:123]
  ds_read_b128 v[244:247], v23 offset:6720
  ds_read_b128 v[212:215], v19 offset:10240
  s_waitcnt lgkmcnt(8)
  v_mfma_f32_16x16x32_bf16 v[124:127], a[72:75], v[180:183], v[124:127]
  v_mfma_f32_16x16x32_bf16 v[128:131], a[76:79], v[180:183], v[128:131]
  v_mfma_f32_16x16x32_bf16 v[132:135], a[80:83], v[180:183], v[132:135]
  s_add_u32 s46, s46, 10240
  s_add_u32 m0, s47, 3072
  s_nop 0
  buffer_load_dwordx4 v10, s[8:11], s46 offen lds
  ds_read_b128 v[216:219], v19 offset:12288
  s_waitcnt lgkmcnt(8)
  v_mfma_f32_16x16x32_bf16 v[136:139], a[72:75], v[184:187], v[136:139]
  v_mfma_f32_16x16x32_bf16 v[140:143], a[76:79], v[184:187], v[140:143]
  v_mfma_f32_16x16x32_bf16 v[144:147], a[80:83], v[184:187], v[144:147]
  s_add_u32 s21, s48, 8192
  buffer_store_dwordx4 v[236:239], v26, s[16:19], s21 offen offset:1024 sc1
  ds_read_b128 v[220:223], v19 offset:14336
  s_waitcnt lgkmcnt(8)
  v_mfma_f32_16x16x32_bf16 v[148:151], a[72:75], v[188:191], v[148:151]
  v_mfma_f32_16x16x32_bf16 v[152:155], a[76:79], v[188:191], v[152:155]
  v_mfma_f32_16x16x32_bf16 v[156:159], a[80:83], v[188:191], v[156:159]
  s_waitcnt vmcnt(22)
  s_barrier
  s_add_u32 s30, s30, 128
  s_add_u32 s31, s31, 1
  s_cmp_lt_u32 s31, 10
  s_cbranch_scc1 kv_184
  s_mov_b32 s31, 0
  s_add_u32 s30, s30, s25
  s_sub_u32 s30, s30, 1280

kv_184:
  s_add_u32 s32, s32, 16384
  s_cmp_lt_u32 s32, 98304
  s_cselect_b32 s32, s32, 0
  s_mul_i32 s46, s20, 40960
  s_add_u32 s46, s46, s30
  s_lshl_b32 s47, s20, 12
  s_add_u32 s47, s47, s32
  v_add_u32 v18, s33, v14
  v_add_u32 v19, s33, v15
  s_add_u32 s33, s33, 16384
  s_cmp_lt_u32 s33, 98304
  s_cselect_b32 s33, s33, 0
  ds_read_b128 v[160:163], v18 offset:0
  s_waitcnt lgkmcnt(8)
  v_mfma_f32_16x16x32_bf16 v[64:67], a[84:87], v[192:195], v[64:67]
  v_mfma_f32_16x16x32_bf16 v[68:71], a[88:91], v[192:195], v[68:71]
  v_mfma_f32_16x16x32_bf16 v[72:75], a[92:95], v[192:195], v[72:75]
  ds_read_b128 v[164:167], v18 offset:2048
  s_waitcnt lgkmcnt(8)
  v_mfma_f32_16x16x32_bf16 v[76:79], a[84:87], v[196:199], v[76:79]
  v_mfma_f32_16x16x32_bf16 v[80:83], a[88:91], v[196:199], v[80:83]
  v_mfma_f32_16x16x32_bf16 v[84:87], a[92:95], v[196:199], v[84:87]
  s_add_u32 m0, s47, 0
  s_nop 0
  buffer_load_dwordx4 v10, s[8:11], s46 offen lds
  ds_read_b128 v[168:171], v18 offset:4096
  s_waitcnt lgkmcnt(8)
  v_mfma_f32_16x16x32_bf16 v[88:91], a[84:87], v[200:203], v[88:91]
  v_mfma_f32_16x16x32_bf16 v[92:95], a[88:91], v[200:203], v[92:95]
  v_mfma_f32_16x16x32_bf16 v[96:99], a[92:95], v[200:203], v[96:99]
  ds_read_b128 v[172:175], v18 offset:6144
  s_waitcnt lgkmcnt(8)
  v_mfma_f32_16x16x32_bf16 v[100:103], a[84:87], v[204:207], v[100:103]
  v_mfma_f32_16x16x32_bf16 v[104:107], a[88:91], v[204:207], v[104:107]
  v_mfma_f32_16x16x32_bf16 v[108:111], a[92:95], v[204:207], v[108:111]
  s_add_u32 s21, s48, 8192
  buffer_store_dwordx4 v[240:243], v26, s[16:19], s21 offen offset:2048 sc1
  ds_read_b128 v[176:179], v18 offset:8192
  s_waitcnt lgkmcnt(8)
  v_mfma_f32_16x16x32_bf16 v[112:115], a[84:87], v[208:211], v[112:115]
  v_mfma_f32_16x16x32_bf16 v[116:119], a[88:91], v[208:211], v[116:119]
  v_mfma_f32_16x16x32_bf16 v[120:123], a[92:95], v[208:211], v[120:123]
  ds_read_b128 v[180:183], v18 offset:10240
  s_waitcnt lgkmcnt(8)
  v_mfma_f32_16x16x32_bf16 v[124:127], a[84:87], v[212:215], v[124:127]
  v_mfma_f32_16x16x32_bf16 v[128:131], a[88:91], v[212:215], v[128:131]
  v_mfma_f32_16x16x32_bf16 v[132:135], a[92:95], v[212:215], v[132:135]
  s_add_u32 s46, s46, 10240
  s_add_u32 m0, s47, 1024
  s_nop 0
  buffer_load_dwordx4 v10, s[8:11], s46 offen lds
  ds_read_b128 v[184:187], v18 offset:12288
  s_waitcnt lgkmcnt(8)
  v_mfma_f32_16x16x32_bf16 v[136:139], a[84:87], v[216:219], v[136:139]
  v_mfma_f32_16x16x32_bf16 v[140:143], a[88:91], v[216:219], v[140:143]
  v_mfma_f32_16x16x32_bf16 v[144:147], a[92:95], v[216:219], v[144:147]
  s_add_u32 s21, s48, 8192
  buffer_store_dwordx4 v[244:247], v26, s[16:19], s21 offen offset:3072 sc1
  ds_read_b128 v[188:191], v18 offset:14336
  s_waitcnt lgkmcnt(8)
  v_mfma_f32_16x16x32_bf16 v[148:151], a[84:87], v[220:223], v[148:151]
  v_mfma_f32_16x16x32_bf16 v[152:155], a[88:91], v[220:223], v[152:155]
  v_mfma_f32_16x16x32_bf16 v[156:159], a[92:95], v[220:223], v[156:159]
  ds_read_b128 v[192:195], v19 offset:0
  s_waitcnt lgkmcnt(8)
  v_mfma_f32_16x16x32_bf16 v[64:67], a[96:99], v[160:163], v[64:67]
  v_mfma_f32_16x16x32_bf16 v[68:71], a[100:103], v[160:163], v[68:71]
  v_mfma_f32_16x16x32_bf16 v[72:75], a[104:107], v[160:163], v[72:75]
  ds_read_b128 v[196:199], v19 offset:2048
  s_waitcnt lgkmcnt(8)
  v_mfma_f32_16x16x32_bf16 v[76:79], a[96:99], v[164:167], v[76:79]
  v_mfma_f32_16x16x32_bf16 v[80:83], a[100:103], v[164:167], v[80:83]
  v_mfma_f32_16x16x32_bf16 v[84:87], a[104:107], v[164:167], v[84:87]
  s_add_u32 s46, s46, 10240
  s_add_u32 m0, s47, 2048
  s_nop 0
  buffer_load_dwordx4 v10, s[8:11], s46 offen lds
  ds_read_b128 v[200:203], v19 offset:4096
  s_waitcnt lgkmcnt(8)
  v_mfma_f32_16x16x32_bf16 v[88:91], a[96:99], v[168:171], v[88:91]
  v_mfma_f32_16x16x32_bf16 v[92:95], a[100:103], v[168:171], v[92:95]
  v_mfma_f32_16x16x32_bf16 v[96:99], a[104:107], v[168:171], v[96:99]
  ds_read_b128 v[204:207], v19 offset:6144
  s_waitcnt lgkmcnt(8)
  v_mfma_f32_16x16x32_bf16 v[100:103], a[96:99], v[172:175], v[100:103]
  v_mfma_f32_16x16x32_bf16 v[104:107], a[100:103], v[172:175], v[104:107]
  v_mfma_f32_16x16x32_bf16 v[108:111], a[104:107], v[172:175], v[108:111]
  ds_read_b128 v[208:211], v19 offset:8192
  s_waitcnt lgkmcnt(8)
  v_mfma_f32_16x16x32_bf16 v[112:115], a[96:99], v[176:179], v[112:115]
  v_mfma_f32_16x16x32_bf16 v[116:119], a[100:103], v[176:179], v[116:119]
  v_mfma_f32_16x16x32_bf16 v[120:123], a[104:107], v[176:179], v[120:123]
  ds_read_b128 v[212:215], v19 offset:10240
  s_waitcnt lgkmcnt(8)
  v_mfma_f32_16x16x32_bf16 v[124:127], a[96:99], v[180:183], v[124:127]
  v_mfma_f32_16x16x32_bf16 v[128:131], a[100:103], v[180:183], v[128:131]
  v_mfma_f32_16x16x32_bf16 v[132:135], a[104:107], v[180:183], v[132:135]
  s_add_u32 s46, s46, 10240
  s_add_u32 m0, s47, 3072
  s_nop 0
  buffer_load_dwordx4 v10, s[8:11], s46 offen lds
  ds_read_b128 v[216:219], v19 offset:12288
  s_waitcnt lgkmcnt(8)
  v_mfma_f32_16x16x32_bf16 v[136:139], a[96:99], v[184:187], v[136:139]
  v_mfma_f32_16x16x32_bf16 v[140:143], a[100:103], v[184:187], v[140:143]
  v_mfma_f32_16x16x32_bf16 v[144:147], a[104:107], v[184:187], v[144:147]
  ds_read_b128 v[220:223], v19 offset:14336
  s_waitcnt lgkmcnt(8)
  v_mfma_f32_16x16x32_bf16 v[148:151], a[96:99], v[188:191], v[148:151]
  v_mfma_f32_16x16x32_bf16 v[152:155], a[100:103], v[188:191], v[152:155]
  v_mfma_f32_16x16x32_bf16 v[156:159], a[104:107], v[188:191], v[156:159]
  s_waitcnt vmcnt(23)
  s_barrier
  s_add_u32 s30, s30, 128
  s_add_u32 s31, s31, 1
  s_cmp_lt_u32 s31, 10
  s_cbranch_scc1 kv_185
  s_mov_b32 s31, 0
  s_add_u32 s30, s30, s25
  s_sub_u32 s30, s30, 1280

kv_185:
  s_add_u32 s32, s32, 16384
  s_cmp_lt_u32 s32, 98304
  s_cselect_b32 s32, s32, 0
  s_mul_i32 s46, s20, 40960
  s_add_u32 s46, s46, s30
  s_lshl_b32 s47, s20, 12
  s_add_u32 s47, s47, s32
  v_add_u32 v18, s33, v14
  v_add_u32 v19, s33, v15
  s_add_u32 s33, s33, 16384
  s_cmp_lt_u32 s33, 98304
  s_cselect_b32 s33, s33, 0
  ds_read_b128 v[160:163], v18 offset:0
  s_waitcnt lgkmcnt(8)
  v_mfma_f32_16x16x32_bf16 v[64:67], a[108:111], v[192:195], v[64:67]
  v_mfma_f32_16x16x32_bf16 v[68:71], a[112:115], v[192:195], v[68:71]
  v_mfma_f32_16x16x32_bf16 v[72:75], a[116:119], v[192:195], v[72:75]
  ds_read_b128 v[164:167], v18 offset:2048
  s_waitcnt lgkmcnt(8)
  v_mfma_f32_16x16x32_bf16 v[76:79], a[108:111], v[196:199], v[76:79]
  v_mfma_f32_16x16x32_bf16 v[80:83], a[112:115], v[196:199], v[80:83]
  v_mfma_f32_16x16x32_bf16 v[84:87], a[116:119], v[196:199], v[84:87]
  s_add_u32 m0, s47, 0
  s_nop 0
  buffer_load_dwordx4 v10, s[8:11], s46 offen lds
  ds_read_b128 v[168:171], v18 offset:4096
  s_waitcnt lgkmcnt(8)
  v_mfma_f32_16x16x32_bf16 v[88:91], a[108:111], v[200:203], v[88:91]
  v_mfma_f32_16x16x32_bf16 v[92:95], a[112:115], v[200:203], v[92:95]
  v_mfma_f32_16x16x32_bf16 v[96:99], a[116:119], v[200:203], v[96:99]
  ds_read_b128 v[172:175], v18 offset:6144
  s_waitcnt lgkmcnt(8)
  v_mfma_f32_16x16x32_bf16 v[100:103], a[108:111], v[204:207], v[100:103]
  v_mfma_f32_16x16x32_bf16 v[104:107], a[112:115], v[204:207], v[104:107]
  v_mfma_f32_16x16x32_bf16 v[108:111], a[116:119], v[204:207], v[108:111]
  ds_read_b128 v[176:179], v18 offset:8192
  s_waitcnt lgkmcnt(8)
  v_mfma_f32_16x16x32_bf16 v[112:115], a[108:111], v[208:211], v[112:115]
  v_mfma_f32_16x16x32_bf16 v[116:119], a[112:115], v[208:211], v[116:119]
  v_mfma_f32_16x16x32_bf16 v[120:123], a[116:119], v[208:211], v[120:123]
  ds_read_b128 v[180:183], v18 offset:10240
  s_waitcnt lgkmcnt(8)
  v_mfma_f32_16x16x32_bf16 v[124:127], a[108:111], v[212:215], v[124:127]
  v_mfma_f32_16x16x32_bf16 v[128:131], a[112:115], v[212:215], v[128:131]
  v_mfma_f32_16x16x32_bf16 v[132:135], a[116:119], v[212:215], v[132:135]
  s_add_u32 s46, s46, 10240
  s_add_u32 m0, s47, 1024
  s_nop 0
  buffer_load_dwordx4 v10, s[8:11], s46 offen lds
  ds_read_b128 v[184:187], v18 offset:12288
  s_waitcnt lgkmcnt(8)
  v_mfma_f32_16x16x32_bf16 v[136:139], a[108:111], v[216:219], v[136:139]
  v_mfma_f32_16x16x32_bf16 v[140:143], a[112:115], v[216:219], v[140:143]
  v_mfma_f32_16x16x32_bf16 v[144:147], a[116:119], v[216:219], v[144:147]
  ds_read_b128 v[188:191], v18 offset:14336
  s_waitcnt lgkmcnt(8)
  v_mfma_f32_16x16x32_bf16 v[148:151], a[108:111], v[220:223], v[148:151]
  v_mfma_f32_16x16x32_bf16 v[152:155], a[112:115], v[220:223], v[152:155]
  v_mfma_f32_16x16x32_bf16 v[156:159], a[116:119], v[220:223], v[156:159]
  ds_read_b128 v[192:195], v19 offset:0
  s_waitcnt lgkmcnt(8)
  v_mfma_f32_16x16x32_bf16 v[64:67], a[120:123], v[160:163], v[64:67]
  v_mfma_f32_16x16x32_bf16 v[68:71], a[124:127], v[160:163], v[68:71]
  v_mfma_f32_16x16x32_bf16 v[72:75], a[128:131], v[160:163], v[72:75]
  ds_read_b128 v[196:199], v19 offset:2048
  s_waitcnt lgkmcnt(8)
  v_mfma_f32_16x16x32_bf16 v[76:79], a[120:123], v[164:167], v[76:79]
  v_mfma_f32_16x16x32_bf16 v[80:83], a[124:127], v[164:167], v[80:83]
  v_mfma_f32_16x16x32_bf16 v[84:87], a[128:131], v[164:167], v[84:87]
  s_add_u32 s46, s46, 10240
  s_add_u32 m0, s47, 2048
  s_nop 0
  buffer_load_dwordx4 v10, s[8:11], s46 offen lds
  ds_read_b128 v[200:203], v19 offset:4096
  s_waitcnt lgkmcnt(8)
  v_mfma_f32_16x16x32_bf16 v[88:91], a[120:123], v[168:171], v[88:91]
  v_mfma_f32_16x16x32_bf16 v[92:95], a[124:127], v[168:171], v[92:95]
  v_mfma_f32_16x16x32_bf16 v[96:99], a[128:131], v[168:171], v[96:99]
  ds_read_b128 v[204:207], v19 offset:6144
  s_waitcnt lgkmcnt(8)
  v_mfma_f32_16x16x32_bf16 v[100:103], a[120:123], v[172:175], v[100:103]
  v_mfma_f32_16x16x32_bf16 v[104:107], a[124:127], v[172:175], v[104:107]
  v_mfma_f32_16x16x32_bf16 v[108:111], a[128:131], v[172:175], v[108:111]
  ds_read_b128 v[208:211], v19 offset:8192
  s_waitcnt lgkmcnt(8)
  v_mfma_f32_16x16x32_bf16 v[112:115], a[120:123], v[176:179], v[112:115]
  v_mfma_f32_16x16x32_bf16 v[116:119], a[124:127], v[176:179], v[116:119]
  v_mfma_f32_16x16x32_bf16 v[120:123], a[128:131], v[176:179], v[120:123]
  ds_read_b128 v[212:215], v19 offset:10240
  s_waitcnt lgkmcnt(8)
  v_mfma_f32_16x16x32_bf16 v[124:127], a[120:123], v[180:183], v[124:127]
  v_mfma_f32_16x16x32_bf16 v[128:131], a[124:127], v[180:183], v[128:131]
  v_mfma_f32_16x16x32_bf16 v[132:135], a[128:131], v[180:183], v[132:135]
  s_add_u32 s46, s46, 10240
  s_add_u32 m0, s47, 3072
  s_nop 0
  buffer_load_dwordx4 v10, s[8:11], s46 offen lds
  ds_read_b128 v[216:219], v19 offset:12288
  s_waitcnt lgkmcnt(8)
  v_mfma_f32_16x16x32_bf16 v[136:139], a[120:123], v[184:187], v[136:139]
  v_mfma_f32_16x16x32_bf16 v[140:143], a[124:127], v[184:187], v[140:143]
  v_mfma_f32_16x16x32_bf16 v[144:147], a[128:131], v[184:187], v[144:147]
  ds_read_b128 v[220:223], v19 offset:14336
  s_waitcnt lgkmcnt(8)
  v_mfma_f32_16x16x32_bf16 v[148:151], a[120:123], v[188:191], v[148:151]
  v_mfma_f32_16x16x32_bf16 v[152:155], a[124:127], v[188:191], v[152:155]
  v_mfma_f32_16x16x32_bf16 v[156:159], a[128:131], v[188:191], v[156:159]
  s_waitcnt vmcnt(6)
  s_barrier
  s_cmp_eq_u32 s48, 0x80000000
  s_cbranch_scc1 kv_186
  s_cmp_lg_u32 s20, 0
  s_cbranch_scc1 af_187
  v_mov_b32 v4, 0
  v_mov_b32 v5, 1
  s_mov_b64 exec, 1
  buffer_atomic_add v5, v4, s[72:75], s61 offen sc1
  s_mov_b64 exec, -1
  s_nop 1
af_187:
kv_186:
  s_add_u32 s30, s30, 128
  s_add_u32 s31, s31, 1
  s_cmp_lt_u32 s31, 10
  s_cbranch_scc1 kv_188
  s_mov_b32 s31, 0
  s_add_u32 s30, s30, s25
  s_sub_u32 s30, s30, 1280

kv_188:
  s_add_u32 s32, s32, 16384
  s_cmp_lt_u32 s32, 98304
  s_cselect_b32 s32, s32, 0
  s_mul_i32 s46, s20, 40960
  s_add_u32 s46, s46, s30
  s_lshl_b32 s47, s20, 12
  s_add_u32 s47, s47, s32
  v_add_u32 v18, s33, v14
  v_add_u32 v19, s33, v15
  s_add_u32 s33, s33, 16384
  s_cmp_lt_u32 s33, 98304
  s_cselect_b32 s33, s33, 0
  ds_read_b128 v[160:163], v18 offset:0
  s_waitcnt lgkmcnt(8)
  v_mfma_f32_16x16x32_bf16 v[64:67], a[132:135], v[192:195], v[64:67]
  v_mfma_f32_16x16x32_bf16 v[68:71], a[136:139], v[192:195], v[68:71]
  v_mfma_f32_16x16x32_bf16 v[72:75], a[140:143], v[192:195], v[72:75]
  ds_read_b128 v[164:167], v18 offset:2048
  s_waitcnt lgkmcnt(8)
  v_mfma_f32_16x16x32_bf16 v[76:79], a[132:135], v[196:199], v[76:79]
  v_mfma_f32_16x16x32_bf16 v[80:83], a[136:139], v[196:199], v[80:83]
  v_mfma_f32_16x16x32_bf16 v[84:87], a[140:143], v[196:199], v[84:87]
  s_add_u32 m0, s47, 0
  s_nop 0
  buffer_load_dwordx4 v10, s[8:11], s46 offen lds
  ds_read_b128 v[168:171], v18 offset:4096
  s_waitcnt lgkmcnt(8)
  v_mfma_f32_16x16x32_bf16 v[88:91], a[132:135], v[200:203], v[88:91]
  v_mfma_f32_16x16x32_bf16 v[92:95], a[136:139], v[200:203], v[92:95]
  v_mfma_f32_16x16x32_bf16 v[96:99], a[140:143], v[200:203], v[96:99]
  ds_read_b128 v[172:175], v18 offset:6144
  s_waitcnt lgkmcnt(8)
  v_mfma_f32_16x16x32_bf16 v[100:103], a[132:135], v[204:207], v[100:103]
  v_mfma_f32_16x16x32_bf16 v[104:107], a[136:139], v[204:207], v[104:107]
  v_mfma_f32_16x16x32_bf16 v[108:111], a[140:143], v[204:207], v[108:111]
  ds_read_b128 v[176:179], v18 offset:8192
  s_waitcnt lgkmcnt(8)
  v_mfma_f32_16x16x32_bf16 v[112:115], a[132:135], v[208:211], v[112:115]
  v_mfma_f32_16x16x32_bf16 v[116:119], a[136:139], v[208:211], v[116:119]
  v_mfma_f32_16x16x32_bf16 v[120:123], a[140:143], v[208:211], v[120:123]
  ds_read_b128 v[180:183], v18 offset:10240
  s_waitcnt lgkmcnt(8)
  v_mfma_f32_16x16x32_bf16 v[124:127], a[132:135], v[212:215], v[124:127]
  v_mfma_f32_16x16x32_bf16 v[128:131], a[136:139], v[212:215], v[128:131]
  v_mfma_f32_16x16x32_bf16 v[132:135], a[140:143], v[212:215], v[132:135]
  s_add_u32 s46, s46, 10240
  s_add_u32 m0, s47, 1024
  s_nop 0
  buffer_load_dwordx4 v10, s[8:11], s46 offen lds
  ds_read_b128 v[184:187], v18 offset:12288
  s_waitcnt lgkmcnt(8)
  v_mfma_f32_16x16x32_bf16 v[136:139], a[132:135], v[216:219], v[136:139]
  v_mfma_f32_16x16x32_bf16 v[140:143], a[136:139], v[216:219], v[140:143]
  v_mfma_f32_16x16x32_bf16 v[144:147], a[140:143], v[216:219], v[144:147]
  ds_read_b128 v[188:191], v18 offset:14336
  s_waitcnt lgkmcnt(8)
  v_mfma_f32_16x16x32_bf16 v[148:151], a[132:135], v[220:223], v[148:151]
  v_mfma_f32_16x16x32_bf16 v[152:155], a[136:139], v[220:223], v[152:155]
  v_mfma_f32_16x16x32_bf16 v[156:159], a[140:143], v[220:223], v[156:159]
  ds_read_b128 v[192:195], v19 offset:0
  s_waitcnt lgkmcnt(8)
  v_mfma_f32_16x16x32_bf16 v[64:67], a[144:147], v[160:163], v[64:67]
  v_mfma_f32_16x16x32_bf16 v[68:71], a[148:151], v[160:163], v[68:71]
  v_mfma_f32_16x16x32_bf16 v[72:75], a[152:155], v[160:163], v[72:75]
  ds_read_b128 v[196:199], v19 offset:2048
  s_waitcnt lgkmcnt(8)
  v_mfma_f32_16x16x32_bf16 v[76:79], a[144:147], v[164:167], v[76:79]
  v_mfma_f32_16x16x32_bf16 v[80:83], a[148:151], v[164:167], v[80:83]
  v_mfma_f32_16x16x32_bf16 v[84:87], a[152:155], v[164:167], v[84:87]
  s_add_u32 s46, s46, 10240
  s_add_u32 m0, s47, 2048
  s_nop 0
  buffer_load_dwordx4 v10, s[8:11], s46 offen lds
  ds_read_b128 v[200:203], v19 offset:4096
  s_waitcnt lgkmcnt(8)
  v_mfma_f32_16x16x32_bf16 v[88:91], a[144:147], v[168:171], v[88:91]
  v_mfma_f32_16x16x32_bf16 v[92:95], a[148:151], v[168:171], v[92:95]
  v_mfma_f32_16x16x32_bf16 v[96:99], a[152:155], v[168:171], v[96:99]
  ds_read_b128 v[204:207], v19 offset:6144
  s_waitcnt lgkmcnt(8)
  v_mfma_f32_16x16x32_bf16 v[100:103], a[144:147], v[172:175], v[100:103]
  v_mfma_f32_16x16x32_bf16 v[104:107], a[148:151], v[172:175], v[104:107]
  v_mfma_f32_16x16x32_bf16 v[108:111], a[152:155], v[172:175], v[108:111]
  ds_read_b128 v[208:211], v19 offset:8192
  s_waitcnt lgkmcnt(8)
  v_mfma_f32_16x16x32_bf16 v[112:115], a[144:147], v[176:179], v[112:115]
  v_mfma_f32_16x16x32_bf16 v[116:119], a[148:151], v[176:179], v[116:119]
  v_mfma_f32_16x16x32_bf16 v[120:123], a[152:155], v[176:179], v[120:123]
  ds_read_b128 v[212:215], v19 offset:10240
  s_waitcnt lgkmcnt(8)
  v_mfma_f32_16x16x32_bf16 v[124:127], a[144:147], v[180:183], v[124:127]
  v_mfma_f32_16x16x32_bf16 v[128:131], a[148:151], v[180:183], v[128:131]
  v_mfma_f32_16x16x32_bf16 v[132:135], a[152:155], v[180:183], v[132:135]
  s_add_u32 s46, s46, 10240
  s_add_u32 m0, s47, 3072
  s_nop 0
  buffer_load_dwordx4 v10, s[8:11], s46 offen lds
  ds_read_b128 v[216:219], v19 offset:12288
  s_waitcnt lgkmcnt(8)
  v_mfma_f32_16x16x32_bf16 v[136:139], a[144:147], v[184:187], v[136:139]
  v_mfma_f32_16x16x32_bf16 v[140:143], a[148:151], v[184:187], v[140:143]
  v_mfma_f32_16x16x32_bf16 v[144:147], a[152:155], v[184:187], v[144:147]
  ds_read_b128 v[220:223], v19 offset:14336
  s_waitcnt lgkmcnt(8)
  v_mfma_f32_16x16x32_bf16 v[148:151], a[144:147], v[188:191], v[148:151]
  v_mfma_f32_16x16x32_bf16 v[152:155], a[148:151], v[188:191], v[152:155]
  v_mfma_f32_16x16x32_bf16 v[156:159], a[152:155], v[188:191], v[156:159]
  s_waitcnt vmcnt(15)
  s_barrier
  s_add_u32 s30, s30, 128
  s_add_u32 s31, s31, 1
  s_cmp_lt_u32 s31, 10
  s_cbranch_scc1 kv_189
  s_mov_b32 s31, 0
  s_add_u32 s30, s30, s25
  s_sub_u32 s30, s30, 1280

kv_189:
  s_add_u32 s32, s32, 16384
  s_cmp_lt_u32 s32, 98304
  s_cselect_b32 s32, s32, 0
  s_mul_i32 s46, s20, 40960
  s_add_u32 s46, s46, s30
  s_lshl_b32 s47, s20, 12
  s_add_u32 s47, s47, s32
  v_add_u32 v18, s33, v14
  v_add_u32 v19, s33, v15
  s_add_u32 s33, s33, 16384
  s_cmp_lt_u32 s33, 98304
  s_cselect_b32 s33, s33, 0
  ds_read_b128 v[160:163], v18 offset:0
  s_waitcnt lgkmcnt(8)
  v_mfma_f32_16x16x32_bf16 v[64:67], a[156:159], v[192:195], v[64:67]
  v_mfma_f32_16x16x32_bf16 v[68:71], a[160:163], v[192:195], v[68:71]
  v_mfma_f32_16x16x32_bf16 v[72:75], a[164:167], v[192:195], v[72:75]
  ds_read_b128 v[164:167], v18 offset:2048
  s_waitcnt lgkmcnt(8)
  v_mfma_f32_16x16x32_bf16 v[76:79], a[156:159], v[196:199], v[76:79]
  v_mfma_f32_16x16x32_bf16 v[80:83], a[160:163], v[196:199], v[80:83]
  v_mfma_f32_16x16x32_bf16 v[84:87], a[164:167], v[196:199], v[84:87]
  s_add_u32 m0, s47, 0
  s_nop 0
  buffer_load_dwordx4 v10, s[8:11], s46 offen lds
  ds_read_b128 v[168:171], v18 offset:4096
  s_waitcnt lgkmcnt(8)
  v_mfma_f32_16x16x32_bf16 v[88:91], a[156:159], v[200:203], v[88:91]
  v_mfma_f32_16x16x32_bf16 v[92:95], a[160:163], v[200:203], v[92:95]
  v_mfma_f32_16x16x32_bf16 v[96:99], a[164:167], v[200:203], v[96:99]
  ds_read_b128 v[172:175], v18 offset:6144
  s_waitcnt lgkmcnt(8)
  v_mfma_f32_16x16x32_bf16 v[100:103], a[156:159], v[204:207], v[100:103]
  v_mfma_f32_16x16x32_bf16 v[104:107], a[160:163], v[204:207], v[104:107]
  v_mfma_f32_16x16x32_bf16 v[108:111], a[164:167], v[204:207], v[108:111]
  ds_read_b128 v[176:179], v18 offset:8192
  s_waitcnt lgkmcnt(8)
  v_mfma_f32_16x16x32_bf16 v[112:115], a[156:159], v[208:211], v[112:115]
  v_mfma_f32_16x16x32_bf16 v[116:119], a[160:163], v[208:211], v[116:119]
  v_mfma_f32_16x16x32_bf16 v[120:123], a[164:167], v[208:211], v[120:123]
  ds_read_b128 v[180:183], v18 offset:10240
  s_waitcnt lgkmcnt(8)
  v_mfma_f32_16x16x32_bf16 v[124:127], a[156:159], v[212:215], v[124:127]
  v_mfma_f32_16x16x32_bf16 v[128:131], a[160:163], v[212:215], v[128:131]
  v_mfma_f32_16x16x32_bf16 v[132:135], a[164:167], v[212:215], v[132:135]
  s_add_u32 s46, s46, 10240
  s_add_u32 m0, s47, 1024
  s_nop 0
  buffer_load_dwordx4 v10, s[8:11], s46 offen lds
  ds_read_b128 v[184:187], v18 offset:12288
  s_waitcnt lgkmcnt(8)
  v_mfma_f32_16x16x32_bf16 v[136:139], a[156:159], v[216:219], v[136:139]
  v_mfma_f32_16x16x32_bf16 v[140:143], a[160:163], v[216:219], v[140:143]
  v_mfma_f32_16x16x32_bf16 v[144:147], a[164:167], v[216:219], v[144:147]
  ds_read_b128 v[188:191], v18 offset:14336
  s_waitcnt lgkmcnt(8)
  v_mfma_f32_16x16x32_bf16 v[148:151], a[156:159], v[220:223], v[148:151]
  v_mfma_f32_16x16x32_bf16 v[152:155], a[160:163], v[220:223], v[152:155]
  v_mfma_f32_16x16x32_bf16 v[156:159], a[164:167], v[220:223], v[156:159]
  ds_read_b128 v[192:195], v19 offset:0
  s_waitcnt lgkmcnt(8)
  v_mfma_f32_16x16x32_bf16 v[64:67], a[168:171], v[160:163], v[64:67]
  v_mfma_f32_16x16x32_bf16 v[68:71], a[172:175], v[160:163], v[68:71]
  v_mfma_f32_16x16x32_bf16 v[72:75], a[176:179], v[160:163], v[72:75]
  ds_read_b128 v[196:199], v19 offset:2048
  s_waitcnt lgkmcnt(8)
  v_mfma_f32_16x16x32_bf16 v[76:79], a[168:171], v[164:167], v[76:79]
  v_mfma_f32_16x16x32_bf16 v[80:83], a[172:175], v[164:167], v[80:83]
  v_mfma_f32_16x16x32_bf16 v[84:87], a[176:179], v[164:167], v[84:87]
  s_add_u32 s46, s46, 10240
  s_add_u32 m0, s47, 2048
  s_nop 0
  buffer_load_dwordx4 v10, s[8:11], s46 offen lds
  ds_read_b128 v[200:203], v19 offset:4096
  s_waitcnt lgkmcnt(8)
  v_mfma_f32_16x16x32_bf16 v[88:91], a[168:171], v[168:171], v[88:91]
  v_mfma_f32_16x16x32_bf16 v[92:95], a[172:175], v[168:171], v[92:95]
  v_mfma_f32_16x16x32_bf16 v[96:99], a[176:179], v[168:171], v[96:99]
  ds_read_b128 v[204:207], v19 offset:6144
  s_waitcnt lgkmcnt(8)
  v_mfma_f32_16x16x32_bf16 v[100:103], a[168:171], v[172:175], v[100:103]
  v_mfma_f32_16x16x32_bf16 v[104:107], a[172:175], v[172:175], v[104:107]
  v_mfma_f32_16x16x32_bf16 v[108:111], a[176:179], v[172:175], v[108:111]
  ds_read_b128 v[208:211], v19 offset:8192
  s_waitcnt lgkmcnt(8)
  v_mfma_f32_16x16x32_bf16 v[112:115], a[168:171], v[176:179], v[112:115]
  v_mfma_f32_16x16x32_bf16 v[116:119], a[172:175], v[176:179], v[116:119]
  v_mfma_f32_16x16x32_bf16 v[120:123], a[176:179], v[176:179], v[120:123]
  ds_read_b128 v[212:215], v19 offset:10240
  s_waitcnt lgkmcnt(8)
  v_mfma_f32_16x16x32_bf16 v[124:127], a[168:171], v[180:183], v[124:127]
  v_mfma_f32_16x16x32_bf16 v[128:131], a[172:175], v[180:183], v[128:131]
  v_mfma_f32_16x16x32_bf16 v[132:135], a[176:179], v[180:183], v[132:135]
  s_add_u32 s46, s46, 10240
  s_add_u32 m0, s47, 3072
  s_nop 0
  buffer_load_dwordx4 v10, s[8:11], s46 offen lds
  ds_read_b128 v[216:219], v19 offset:12288
  s_waitcnt lgkmcnt(8)
  v_mfma_f32_16x16x32_bf16 v[136:139], a[168:171], v[184:187], v[136:139]
  v_mfma_f32_16x16x32_bf16 v[140:143], a[172:175], v[184:187], v[140:143]
  v_mfma_f32_16x16x32_bf16 v[144:147], a[176:179], v[184:187], v[144:147]
  ds_read_b128 v[220:223], v19 offset:14336
  s_waitcnt lgkmcnt(8)
  v_mfma_f32_16x16x32_bf16 v[148:151], a[168:171], v[188:191], v[148:151]
  v_mfma_f32_16x16x32_bf16 v[152:155], a[172:175], v[188:191], v[152:155]
  v_mfma_f32_16x16x32_bf16 v[156:159], a[176:179], v[188:191], v[156:159]
  s_waitcnt vmcnt(12)
  s_barrier
  s_add_u32 s30, s30, 128
  s_add_u32 s31, s31, 1
  s_cmp_lt_u32 s31, 10
  s_cbranch_scc1 kv_190
  s_mov_b32 s31, 0
  s_add_u32 s30, s30, s25
  s_sub_u32 s30, s30, 1280

kv_190:
  s_add_u32 s32, s32, 16384
  s_cmp_lt_u32 s32, 98304
  s_cselect_b32 s32, s32, 0
  s_mul_i32 s46, s20, 40960
  s_add_u32 s46, s46, s30
  s_lshl_b32 s47, s20, 12
  s_add_u32 s47, s47, s32
  v_add_u32 v18, s33, v14
  v_add_u32 v19, s33, v15
  s_add_u32 s33, s33, 16384
  s_cmp_lt_u32 s33, 98304
  s_cselect_b32 s33, s33, 0
  ds_read_b128 v[160:163], v18 offset:0
  s_waitcnt lgkmcnt(8)
  v_mfma_f32_16x16x32_bf16 v[64:67], a[180:183], v[192:195], v[64:67]
  v_mfma_f32_16x16x32_bf16 v[68:71], a[184:187], v[192:195], v[68:71]
  v_mfma_f32_16x16x32_bf16 v[72:75], a[188:191], v[192:195], v[72:75]
  ds_read_b128 v[164:167], v18 offset:2048
  s_waitcnt lgkmcnt(8)
  v_mfma_f32_16x16x32_bf16 v[76:79], a[180:183], v[196:199], v[76:79]
  v_mfma_f32_16x16x32_bf16 v[80:83], a[184:187], v[196:199], v[80:83]
  v_mfma_f32_16x16x32_bf16 v[84:87], a[188:191], v[196:199], v[84:87]
  s_add_u32 m0, s47, 0
  s_nop 0
  buffer_load_dwordx4 v10, s[8:11], s46 offen lds
  ds_read_b128 v[168:171], v18 offset:4096
  s_waitcnt lgkmcnt(8)
  v_mfma_f32_16x16x32_bf16 v[88:91], a[180:183], v[200:203], v[88:91]
  v_mfma_f32_16x16x32_bf16 v[92:95], a[184:187], v[200:203], v[92:95]
  v_mfma_f32_16x16x32_bf16 v[96:99], a[188:191], v[200:203], v[96:99]
  ds_read_b128 v[172:175], v18 offset:6144
  s_waitcnt lgkmcnt(8)
  v_mfma_f32_16x16x32_bf16 v[100:103], a[180:183], v[204:207], v[100:103]
  v_mfma_f32_16x16x32_bf16 v[104:107], a[184:187], v[204:207], v[104:107]
  v_mfma_f32_16x16x32_bf16 v[108:111], a[188:191], v[204:207], v[108:111]
  ds_read_b128 v[176:179], v18 offset:8192
  s_waitcnt lgkmcnt(8)
  v_mfma_f32_16x16x32_bf16 v[112:115], a[180:183], v[208:211], v[112:115]
  v_mfma_f32_16x16x32_bf16 v[116:119], a[184:187], v[208:211], v[116:119]
  v_mfma_f32_16x16x32_bf16 v[120:123], a[188:191], v[208:211], v[120:123]
  ds_read_b128 v[180:183], v18 offset:10240
  s_waitcnt lgkmcnt(8)
  v_mfma_f32_16x16x32_bf16 v[124:127], a[180:183], v[212:215], v[124:127]
  v_mfma_f32_16x16x32_bf16 v[128:131], a[184:187], v[212:215], v[128:131]
  v_mfma_f32_16x16x32_bf16 v[132:135], a[188:191], v[212:215], v[132:135]
  s_add_u32 s46, s46, 10240
  s_add_u32 m0, s47, 1024
  s_nop 0
  buffer_load_dwordx4 v10, s[8:11], s46 offen lds
  ds_read_b128 v[184:187], v18 offset:12288
  s_waitcnt lgkmcnt(8)
  v_mfma_f32_16x16x32_bf16 v[136:139], a[180:183], v[216:219], v[136:139]
  v_mfma_f32_16x16x32_bf16 v[140:143], a[184:187], v[216:219], v[140:143]
  v_mfma_f32_16x16x32_bf16 v[144:147], a[188:191], v[216:219], v[144:147]
  ds_read_b128 v[188:191], v18 offset:14336
  s_waitcnt lgkmcnt(8)
  v_mfma_f32_16x16x32_bf16 v[148:151], a[180:183], v[220:223], v[148:151]
  v_mfma_f32_16x16x32_bf16 v[152:155], a[184:187], v[220:223], v[152:155]
  v_mfma_f32_16x16x32_bf16 v[156:159], a[188:191], v[220:223], v[156:159]
  ds_read_b128 v[192:195], v19 offset:0
  s_waitcnt lgkmcnt(8)
  v_mfma_f32_16x16x32_bf16 v[64:67], a[192:195], v[160:163], v[64:67]
  v_mfma_f32_16x16x32_bf16 v[68:71], a[196:199], v[160:163], v[68:71]
  v_mfma_f32_16x16x32_bf16 v[72:75], a[200:203], v[160:163], v[72:75]
  ds_read_b128 v[196:199], v19 offset:2048
  s_waitcnt lgkmcnt(8)
  v_mfma_f32_16x16x32_bf16 v[76:79], a[192:195], v[164:167], v[76:79]
  v_mfma_f32_16x16x32_bf16 v[80:83], a[196:199], v[164:167], v[80:83]
  v_mfma_f32_16x16x32_bf16 v[84:87], a[200:203], v[164:167], v[84:87]
  s_add_u32 s46, s46, 10240
  s_add_u32 m0, s47, 2048
  s_nop 0
  buffer_load_dwordx4 v10, s[8:11], s46 offen lds
  ds_read_b128 v[200:203], v19 offset:4096
  s_waitcnt lgkmcnt(8)
  v_mfma_f32_16x16x32_bf16 v[88:91], a[192:195], v[168:171], v[88:91]
  v_mfma_f32_16x16x32_bf16 v[92:95], a[196:199], v[168:171], v[92:95]
  v_mfma_f32_16x16x32_bf16 v[96:99], a[200:203], v[168:171], v[96:99]
  ds_read_b128 v[204:207], v19 offset:6144
  s_waitcnt lgkmcnt(8)
  v_mfma_f32_16x16x32_bf16 v[100:103], a[192:195], v[172:175], v[100:103]
  v_mfma_f32_16x16x32_bf16 v[104:107], a[196:199], v[172:175], v[104:107]
  v_mfma_f32_16x16x32_bf16 v[108:111], a[200:203], v[172:175], v[108:111]
  ds_read_b128 v[208:211], v19 offset:8192
  s_waitcnt lgkmcnt(8)
  v_mfma_f32_16x16x32_bf16 v[112:115], a[192:195], v[176:179], v[112:115]
  v_mfma_f32_16x16x32_bf16 v[116:119], a[196:199], v[176:179], v[116:119]
  v_mfma_f32_16x16x32_bf16 v[120:123], a[200:203], v[176:179], v[120:123]
  ds_read_b128 v[212:215], v19 offset:10240
  s_waitcnt lgkmcnt(8)
  v_mfma_f32_16x16x32_bf16 v[124:127], a[192:195], v[180:183], v[124:127]
  v_mfma_f32_16x16x32_bf16 v[128:131], a[196:199], v[180:183], v[128:131]
  v_mfma_f32_16x16x32_bf16 v[132:135], a[200:203], v[180:183], v[132:135]
  s_add_u32 s46, s46, 10240
  s_add_u32 m0, s47, 3072
  s_nop 0
  buffer_load_dwordx4 v10, s[8:11], s46 offen lds
  ds_read_b128 v[216:219], v19 offset:12288
  s_waitcnt lgkmcnt(8)
  v_mfma_f32_16x16x32_bf16 v[136:139], a[192:195], v[184:187], v[136:139]
  v_mfma_f32_16x16x32_bf16 v[140:143], a[196:199], v[184:187], v[140:143]
  v_mfma_f32_16x16x32_bf16 v[144:147], a[200:203], v[184:187], v[144:147]
  ds_read_b128 v[220:223], v19 offset:14336
  s_waitcnt lgkmcnt(8)
  v_mfma_f32_16x16x32_bf16 v[148:151], a[192:195], v[188:191], v[148:151]
  v_mfma_f32_16x16x32_bf16 v[152:155], a[196:199], v[188:191], v[152:155]
  v_mfma_f32_16x16x32_bf16 v[156:159], a[200:203], v[188:191], v[156:159]
  s_waitcnt vmcnt(12)
  s_barrier
  s_add_u32 s30, s30, 128
  s_add_u32 s31, s31, 1
  s_cmp_lt_u32 s31, 10
  s_cbranch_scc1 kv_191
  s_mov_b32 s31, 0
  s_add_u32 s30, s30, s25
  s_sub_u32 s30, s30, 1280

kv_191:
  s_add_u32 s32, s32, 16384
  s_cmp_lt_u32 s32, 98304
  s_cselect_b32 s32, s32, 0
  s_mul_i32 s46, s20, 40960
  s_add_u32 s46, s46, s30
  s_lshl_b32 s47, s20, 12
  s_add_u32 s47, s47, s32
  v_add_u32 v18, s33, v14
  v_add_u32 v19, s33, v15
  s_add_u32 s33, s33, 16384
  s_cmp_lt_u32 s33, 98304
  s_cselect_b32 s33, s33, 0
  ds_read_b128 v[160:163], v18 offset:0
  s_waitcnt lgkmcnt(8)
  v_mfma_f32_16x16x32_bf16 v[64:67], a[204:207], v[192:195], v[64:67]
  v_mfma_f32_16x16x32_bf16 v[68:71], a[208:211], v[192:195], v[68:71]
  v_mfma_f32_16x16x32_bf16 v[72:75], a[212:215], v[192:195], v[72:75]
  ds_read_b128 v[164:167], v18 offset:2048
  s_waitcnt lgkmcnt(8)
  v_mfma_f32_16x16x32_bf16 v[76:79], a[204:207], v[196:199], v[76:79]
  v_mfma_f32_16x16x32_bf16 v[80:83], a[208:211], v[196:199], v[80:83]
  v_mfma_f32_16x16x32_bf16 v[84:87], a[212:215], v[196:199], v[84:87]
  s_add_u32 m0, s47, 0
  s_nop 0
  buffer_load_dwordx4 v10, s[8:11], s46 offen lds
  ds_read_b128 v[168:171], v18 offset:4096
  s_waitcnt lgkmcnt(8)
  v_mfma_f32_16x16x32_bf16 v[88:91], a[204:207], v[200:203], v[88:91]
  v_mfma_f32_16x16x32_bf16 v[92:95], a[208:211], v[200:203], v[92:95]
  v_mfma_f32_16x16x32_bf16 v[96:99], a[212:215], v[200:203], v[96:99]
  ds_read_b128 v[172:175], v18 offset:6144
  s_waitcnt lgkmcnt(8)
  v_mfma_f32_16x16x32_bf16 v[100:103], a[204:207], v[204:207], v[100:103]
  v_mfma_f32_16x16x32_bf16 v[104:107], a[208:211], v[204:207], v[104:107]
  v_mfma_f32_16x16x32_bf16 v[108:111], a[212:215], v[204:207], v[108:111]
  ds_read_b128 v[176:179], v18 offset:8192
  s_waitcnt lgkmcnt(8)
  v_mfma_f32_16x16x32_bf16 v[112:115], a[204:207], v[208:211], v[112:115]
  v_mfma_f32_16x16x32_bf16 v[116:119], a[208:211], v[208:211], v[116:119]
  v_mfma_f32_16x16x32_bf16 v[120:123], a[212:215], v[208:211], v[120:123]
  ds_read_b128 v[180:183], v18 offset:10240
  s_waitcnt lgkmcnt(8)
  v_mfma_f32_16x16x32_bf16 v[124:127], a[204:207], v[212:215], v[124:127]
  v_mfma_f32_16x16x32_bf16 v[128:131], a[208:211], v[212:215], v[128:131]
  v_mfma_f32_16x16x32_bf16 v[132:135], a[212:215], v[212:215], v[132:135]
  s_add_u32 s46, s46, 10240
  s_add_u32 m0, s47, 1024
  s_nop 0
  buffer_load_dwordx4 v10, s[8:11], s46 offen lds
  ds_read_b128 v[184:187], v18 offset:12288
  s_waitcnt lgkmcnt(8)
  v_mfma_f32_16x16x32_bf16 v[136:139], a[204:207], v[216:219], v[136:139]
  v_mfma_f32_16x16x32_bf16 v[140:143], a[208:211], v[216:219], v[140:143]
  v_mfma_f32_16x16x32_bf16 v[144:147], a[212:215], v[216:219], v[144:147]
  ds_read_b128 v[188:191], v18 offset:14336
  s_waitcnt lgkmcnt(8)
  v_mfma_f32_16x16x32_bf16 v[148:151], a[204:207], v[220:223], v[148:151]
  v_mfma_f32_16x16x32_bf16 v[152:155], a[208:211], v[220:223], v[152:155]
  v_mfma_f32_16x16x32_bf16 v[156:159], a[212:215], v[220:223], v[156:159]
  ds_read_b128 v[192:195], v19 offset:0
  s_waitcnt lgkmcnt(8)
  v_mfma_f32_16x16x32_bf16 v[64:67], a[216:219], v[160:163], v[64:67]
  v_mfma_f32_16x16x32_bf16 v[68:71], a[220:223], v[160:163], v[68:71]
  v_mfma_f32_16x16x32_bf16 v[72:75], a[224:227], v[160:163], v[72:75]
  ds_read_b128 v[196:199], v19 offset:2048
  s_waitcnt lgkmcnt(8)
  v_mfma_f32_16x16x32_bf16 v[76:79], a[216:219], v[164:167], v[76:79]
  v_mfma_f32_16x16x32_bf16 v[80:83], a[220:223], v[164:167], v[80:83]
  v_mfma_f32_16x16x32_bf16 v[84:87], a[224:227], v[164:167], v[84:87]
  s_add_u32 s46, s46, 10240
  s_add_u32 m0, s47, 2048
  s_nop 0
  buffer_load_dwordx4 v10, s[8:11], s46 offen lds
  ds_read_b128 v[200:203], v19 offset:4096
  s_waitcnt lgkmcnt(8)
  v_mfma_f32_16x16x32_bf16 v[88:91], a[216:219], v[168:171], v[88:91]
  v_mfma_f32_16x16x32_bf16 v[92:95], a[220:223], v[168:171], v[92:95]
  v_mfma_f32_16x16x32_bf16 v[96:99], a[224:227], v[168:171], v[96:99]
  ds_read_b128 v[204:207], v19 offset:6144
  s_waitcnt lgkmcnt(8)
  v_mfma_f32_16x16x32_bf16 v[100:103], a[216:219], v[172:175], v[100:103]
  v_mfma_f32_16x16x32_bf16 v[104:107], a[220:223], v[172:175], v[104:107]
  v_mfma_f32_16x16x32_bf16 v[108:111], a[224:227], v[172:175], v[108:111]
  ds_read_b128 v[208:211], v19 offset:8192
  s_waitcnt lgkmcnt(8)
  v_mfma_f32_16x16x32_bf16 v[112:115], a[216:219], v[176:179], v[112:115]
  v_mfma_f32_16x16x32_bf16 v[116:119], a[220:223], v[176:179], v[116:119]
  v_mfma_f32_16x16x32_bf16 v[120:123], a[224:227], v[176:179], v[120:123]
  ds_read_b128 v[212:215], v19 offset:10240
  s_waitcnt lgkmcnt(8)
  v_mfma_f32_16x16x32_bf16 v[124:127], a[216:219], v[180:183], v[124:127]
  v_mfma_f32_16x16x32_bf16 v[128:131], a[220:223], v[180:183], v[128:131]
  v_mfma_f32_16x16x32_bf16 v[132:135], a[224:227], v[180:183], v[132:135]
  s_add_u32 s46, s46, 10240
  s_add_u32 m0, s47, 3072
  s_nop 0
  buffer_load_dwordx4 v10, s[8:11], s46 offen lds
  ds_read_b128 v[216:219], v19 offset:12288
  s_waitcnt lgkmcnt(8)
  v_mfma_f32_16x16x32_bf16 v[136:139], a[216:219], v[184:187], v[136:139]
  v_mfma_f32_16x16x32_bf16 v[140:143], a[220:223], v[184:187], v[140:143]
  v_mfma_f32_16x16x32_bf16 v[144:147], a[224:227], v[184:187], v[144:147]
  ds_read_b128 v[220:223], v19 offset:14336
  s_waitcnt lgkmcnt(8)
  v_mfma_f32_16x16x32_bf16 v[148:151], a[216:219], v[188:191], v[148:151]
  v_mfma_f32_16x16x32_bf16 v[152:155], a[220:223], v[188:191], v[152:155]
  v_mfma_f32_16x16x32_bf16 v[156:159], a[224:227], v[188:191], v[156:159]
  s_waitcnt vmcnt(12)
  s_barrier
  s_add_u32 s30, s30, 128
  s_add_u32 s31, s31, 1
  s_cmp_lt_u32 s31, 10
  s_cbranch_scc1 kv_192
  s_mov_b32 s31, 0
  s_add_u32 s30, s30, s25
  s_sub_u32 s30, s30, 1280

kv_192:
  s_add_u32 s32, s32, 16384
  s_cmp_lt_u32 s32, 98304
  s_cselect_b32 s32, s32, 0
  s_mul_i32 s46, s20, 40960
  s_add_u32 s46, s46, s30
  s_lshl_b32 s47, s20, 12
  s_add_u32 s47, s47, s32
  v_add_u32 v18, s33, v14
  v_add_u32 v19, s33, v15
  s_add_u32 s33, s33, 16384
  s_cmp_lt_u32 s33, 98304
  s_cselect_b32 s33, s33, 0
  ds_read_b128 v[160:163], v18 offset:0
  s_waitcnt lgkmcnt(8)
  v_mfma_f32_16x16x32_bf16 v[64:67], a[228:231], v[192:195], v[64:67]
  v_mfma_f32_16x16x32_bf16 v[68:71], a[232:235], v[192:195], v[68:71]
  v_mfma_f32_16x16x32_bf16 v[72:75], a[236:239], v[192:195], v[72:75]
  ds_read_b128 v[164:167], v18 offset:2048
  s_waitcnt lgkmcnt(8)
  v_mfma_f32_16x16x32_bf16 v[76:79], a[228:231], v[196:199], v[76:79]
  v_mfma_f32_16x16x32_bf16 v[80:83], a[232:235], v[196:199], v[80:83]
  v_mfma_f32_16x16x32_bf16 v[84:87], a[236:239], v[196:199], v[84:87]
  s_add_u32 m0, s47, 0
  s_nop 0
  buffer_load_dwordx4 v10, s[8:11], s46 offen lds
  ds_read_b128 v[168:171], v18 offset:4096
  s_waitcnt lgkmcnt(8)
  v_mfma_f32_16x16x32_bf16 v[88:91], a[228:231], v[200:203], v[88:91]
  v_mfma_f32_16x16x32_bf16 v[92:95], a[232:235], v[200:203], v[92:95]
  v_mfma_f32_16x16x32_bf16 v[96:99], a[236:239], v[200:203], v[96:99]
  ds_read_b128 v[172:175], v18 offset:6144
  s_waitcnt lgkmcnt(8)
  v_mfma_f32_16x16x32_bf16 v[100:103], a[228:231], v[204:207], v[100:103]
  v_mfma_f32_16x16x32_bf16 v[104:107], a[232:235], v[204:207], v[104:107]
  v_mfma_f32_16x16x32_bf16 v[108:111], a[236:239], v[204:207], v[108:111]
  v_cvt_pk_bf16_f32 v224, v64, v65
  v_cvt_pk_bf16_f32 v225, v66, v67
  v_cvt_pk_bf16_f32 v226, v68, v69
  v_cvt_pk_bf16_f32 v227, v70, v71
  v_cvt_pk_bf16_f32 v228, v72, v73
  v_cvt_pk_bf16_f32 v229, v74, v75
  ds_write_b64 v22, v[224:225] offset:0
  ds_write_b64 v22, v[226:227] offset:8
  ds_write_b64 v22, v[228:229] offset:16
  ds_read_b128 v[176:179], v18 offset:8192
  s_waitcnt lgkmcnt(8)
  v_mfma_f32_16x16x32_bf16 v[112:115], a[228:231], v[208:211], v[112:115]
  v_mfma_f32_16x16x32_bf16 v[116:119], a[232:235], v[208:211], v[116:119]
  v_mfma_f32_16x16x32_bf16 v[120:123], a[236:239], v[208:211], v[120:123]
  v_cvt_pk_bf16_f32 v230, v76, v77
  v_cvt_pk_bf16_f32 v231, v78, v79
  v_cvt_pk_bf16_f32 v232, v80, v81
  v_cvt_pk_bf16_f32 v233, v82, v83
  v_cvt_pk_bf16_f32 v234, v84, v85
  v_cvt_pk_bf16_f32 v235, v86, v87
  ds_write_b64 v22, v[230:231] offset:6400
  ds_write_b64 v22, v[232:233] offset:6408
  ds_write_b64 v22, v[234:235] offset:6416
  ds_read_b128 v[180:183], v18 offset:10240
  s_waitcnt lgkmcnt(8)
  v_mfma_f32_16x16x32_bf16 v[124:127], a[228:231], v[212:215], v[124:127]
  v_mfma_f32_16x16x32_bf16 v[128:131], a[232:235], v[212:215], v[128:131]
  v_mfma_f32_16x16x32_bf16 v[132:135], a[236:239], v[212:215], v[132:135]
  s_add_u32 s46, s46, 10240
  s_add_u32 m0, s47, 1024
  s_nop 0
  buffer_load_dwordx4 v10, s[8:11], s46 offen lds
  v_cvt_pk_bf16_f32 v224, v88, v89
  v_cvt_pk_bf16_f32 v225, v90, v91
  v_cvt_pk_bf16_f32 v226, v92, v93
  v_cvt_pk_bf16_f32 v227, v94, v95
  v_cvt_pk_bf16_f32 v228, v96, v97
  v_cvt_pk_bf16_f32 v229, v98, v99
  ds_write_b64 v22, v[224:225] offset:12800
  ds_write_b64 v22, v[226:227] offset:12808
  ds_write_b64 v22, v[228:229] offset:12816
  ds_read_b128 v[184:187], v18 offset:12288
  s_waitcnt lgkmcnt(8)
  v_mfma_f32_16x16x32_bf16 v[136:139], a[228:231], v[216:219], v[136:139]
  v_mfma_f32_16x16x32_bf16 v[140:143], a[232:235], v[216:219], v[140:143]
  v_mfma_f32_16x16x32_bf16 v[144:147], a[236:239], v[216:219], v[144:147]
  v_cvt_pk_bf16_f32 v230, v100, v101
  v_cvt_pk_bf16_f32 v231, v102, v103
  v_cvt_pk_bf16_f32 v232, v104, v105
  v_cvt_pk_bf16_f32 v233, v106, v107
  v_cvt_pk_bf16_f32 v234, v108, v109
  v_cvt_pk_bf16_f32 v235, v110, v111
  ds_write_b64 v22, v[230:231] offset:19200
  ds_write_b64 v22, v[232:233] offset:19208
  ds_write_b64 v22, v[234:235] offset:19216
  ds_read_b128 v[188:191], v18 offset:14336
  s_waitcnt lgkmcnt(8)
  v_mfma_f32_16x16x32_bf16 v[148:151], a[228:231], v[220:223], v[148:151]
  v_mfma_f32_16x16x32_bf16 v[152:155], a[232:235], v[220:223], v[152:155]
  v_mfma_f32_16x16x32_bf16 v[156:159], a[236:239], v[220:223], v[156:159]
  v_cvt_pk_bf16_f32 v224, v112, v113
  v_cvt_pk_bf16_f32 v225, v114, v115
  v_cvt_pk_bf16_f32 v226, v116, v117
  v_cvt_pk_bf16_f32 v227, v118, v119
  v_cvt_pk_bf16_f32 v228, v120, v121
  v_cvt_pk_bf16_f32 v229, v122, v123
  ds_write_b64 v22, v[224:225] offset:25600
  ds_write_b64 v22, v[226:227] offset:25608
  ds_write_b64 v22, v[228:229] offset:25616
  v_cvt_pk_bf16_f32 v230, v124, v125
  v_cvt_pk_bf16_f32 v231, v126, v127
  v_cvt_pk_bf16_f32 v232, v128, v129
  v_cvt_pk_bf16_f32 v233, v130, v131
  v_cvt_pk_bf16_f32 v234, v132, v133
  v_cvt_pk_bf16_f32 v235, v134, v135
  ds_write_b64 v22, v[230:231] offset:32000
  ds_write_b64 v22, v[232:233] offset:32008
  ds_write_b64 v22, v[234:235] offset:32016
  v_cvt_pk_bf16_f32 v224, v136, v137
  v_cvt_pk_bf16_f32 v225, v138, v139
  v_cvt_pk_bf16_f32 v226, v140, v141
  v_cvt_pk_bf16_f32 v227, v142, v143
  v_cvt_pk_bf16_f32 v228, v144, v145
  v_cvt_pk_bf16_f32 v229, v146, v147
  ds_write_b64 v22, v[224:225] offset:38400
  ds_write_b64 v22, v[226:227] offset:38408
  ds_write_b64 v22, v[228:229] offset:38416
  v_cvt_pk_bf16_f32 v230, v148, v149
  v_cvt_pk_bf16_f32 v231, v150, v151
  v_cvt_pk_bf16_f32 v232, v152, v153
  v_cvt_pk_bf16_f32 v233, v154, v155
  v_cvt_pk_bf16_f32 v234, v156, v157
  v_cvt_pk_bf16_f32 v235, v158, v159
  ds_write_b64 v22, v[230:231] offset:44800
  ds_write_b64 v22, v[232:233] offset:44808
  ds_write_b64 v22, v[234:235] offset:44816
  s_mov_b32 s61, s60
  s_add_u32 s60, s60, 1024
  s_mul_i32 s48, s20, 393216
  s_add_u32 s48, s48, s27
  s_add_u32 s27, s27, s28
  s_sub_u32 s26, s26, 1
  s_cmp_gt_u32 s26, 0
  s_cbranch_scc1 kv_blk_180
  s_waitcnt vmcnt(0) lgkmcnt(0)
  s_barrier
  ds_read_b128 v[224:227], v23 offset:0
  ds_read_b128 v[228:231], v23 offset:64
  ds_read_b128 v[232:235], v23 offset:128
  ds_read_b128 v[236:239], v23 offset:192
  ds_read_b128 v[240:243], v23 offset:256
  ds_read_b128 v[244:247], v23 offset:320
  s_waitcnt lgkmcnt(0)
  s_add_u32 s21, s48, 0
  buffer_store_dwordx4 v[224:227], v26, s[16:19], s21 offen offset:0 sc1
  s_add_u32 s21, s48, 0
  buffer_store_dwordx4 v[228:231], v26, s[16:19], s21 offen offset:1024 sc1
  s_add_u32 s21, s48, 0
  buffer_store_dwordx4 v[232:235], v26, s[16:19], s21 offen offset:2048 sc1
  s_add_u32 s21, s48, 0
  buffer_store_dwordx4 v[236:239], v26, s[16:19], s21 offen offset:3072 sc1
  s_add_u32 s21, s48, 4096
  buffer_store_dwordx4 v[240:243], v26, s[16:19], s21 offen offset:0 sc1
  s_add_u32 s21, s48, 4096
  buffer_store_dwordx4 v[244:247], v26, s[16:19], s21 offen offset:1024 sc1
  s_nop 1
  ds_read_b128 v[224:227], v23 offset:6400
  ds_read_b128 v[228:231], v23 offset:6464
  ds_read_b128 v[232:235], v23 offset:6528
  ds_read_b128 v[236:239], v23 offset:6592
  ds_read_b128 v[240:243], v23 offset:6656
  ds_read_b128 v[244:247], v23 offset:6720
  s_waitcnt lgkmcnt(0)
  s_add_u32 s21, s48, 4096
  buffer_store_dwordx4 v[224:227], v26, s[16:19], s21 offen offset:2048 sc1
  s_add_u32 s21, s48, 4096
  buffer_store_dwordx4 v[228:231], v26, s[16:19], s21 offen offset:3072 sc1
  s_add_u32 s21, s48, 8192
  buffer_store_dwordx4 v[232:235], v26, s[16:19], s21 offen offset:0 sc1
  s_add_u32 s21, s48, 8192
  buffer_store_dwordx4 v[236:239], v26, s[16:19], s21 offen offset:1024 sc1
  s_add_u32 s21, s48, 8192
  buffer_store_dwordx4 v[240:243], v26, s[16:19], s21 offen offset:2048 sc1
  s_add_u32 s21, s48, 8192
  buffer_store_dwordx4 v[244:247], v26, s[16:19], s21 offen offset:3072 sc1
  s_nop 1
  s_waitcnt vmcnt(0)
  s_barrier
  s_cmp_lg_u32 s20, 0
  s_cbranch_scc1 af_193
  v_mov_b32 v4, 0
  v_mov_b32 v5, 1
  s_mov_b64 exec, 1
  buffer_atomic_add v5, v4, s[72:75], s61 offen sc1
  s_mov_b64 exec, -1
  s_nop 1
af_193:
  s_branch queue
not_kv:
  s_cmp_ge_u32 s3, 96
  s_cbranch_scc1 not_vw
  s_sub_u32 s2, s3, 64
  s_load_dwordx2 s[6:7], s[0:1], 40
  s_load_dwordx2 s[38:39], s[0:1], 104
  s_waitcnt lgkmcnt(0)
  s_mov_b32 s12, s6
  s_mov_b32 s13, s7
  s_mov_b32 s14, 7864320
  s_mov_b32 s15, 0x00020000
  s_mov_b32 s16, s38
  s_mov_b32 s17, s39
  s_mov_b32 s18, 50331648
  s_mov_b32 s19, 0x00020000
  s_add_u32 s24, s38, 114294784
  s_addc_u32 s25, s39, 0
  s_mov_b32 s26, 83886080
  s_mov_b32 s27, 0x00020000
  s_load_dwordx2 s[72:73], s[0:1], 104
  s_waitcnt lgkmcnt(0)
  s_add_u32 s72, s72, 81068032
  s_addc_u32 s73, s73, 0
  s_mov_b32 s74, 115712
  s_mov_b32 s75, 0x00020000
  v_mov_b32 v29, 52429
  s_mul_i32 s21, s20, 960
  s_add_u32 s21, s21, 0
  v_add_u32 v21, s21, v1
  v_mul_u32_u24 v22, v21, v29
  v_lshrrev_b32 v22, 22, v22
  v_mul_u32_u24 v23, 80, v22
  v_sub_u32 v21, v21, v23
  v_mul_u32_u24 v26, 5462, v22
  v_lshrrev_b32 v26, 16, v26
  v_mul_u32_u24 v27, 12, v26
  v_sub_u32 v22, v22, v27
  v_lshrrev_b32 v27, 2, v22
  v_and_b32 v22, 3, v22
  v_lshlrev_b32 v25, 4, v27
  v_lshl_add_u32 v25, v26, 2, v25
  v_add_u32 v25, v25, v22
  v_mul_u32_u24 v25, 1280, v25
  v_lshl_add_u32 v64, v21, 4, v25
  s_mul_i32 s21, s20, 960
  s_add_u32 s21, s21, 64
  v_add_u32 v21, s21, v1
  v_mul_u32_u24 v22, v21, v29
  v_lshrrev_b32 v22, 22, v22
  v_mul_u32_u24 v23, 80, v22
  v_sub_u32 v21, v21, v23
  v_mul_u32_u24 v26, 5462, v22
  v_lshrrev_b32 v26, 16, v26
  v_mul_u32_u24 v27, 12, v26
  v_sub_u32 v22, v22, v27
  v_lshrrev_b32 v27, 2, v22
  v_and_b32 v22, 3, v22
  v_lshlrev_b32 v25, 4, v27
  v_lshl_add_u32 v25, v26, 2, v25
  v_add_u32 v25, v25, v22
  v_mul_u32_u24 v25, 1280, v25
  v_lshl_add_u32 v65, v21, 4, v25
  s_mul_i32 s21, s20, 960
  s_add_u32 s21, s21, 128
  v_add_u32 v21, s21, v1
  v_mul_u32_u24 v22, v21, v29
  v_lshrrev_b32 v22, 22, v22
  v_mul_u32_u24 v23, 80, v22
  v_sub_u32 v21, v21, v23
  v_mul_u32_u24 v26, 5462, v22
  v_lshrrev_b32 v26, 16, v26
  v_mul_u32_u24 v27, 12, v26
  v_sub_u32 v22, v22, v27
  v_lshrrev_b32 v27, 2, v22
  v_and_b32 v22, 3, v22
  v_lshlrev_b32 v25, 4, v27
  v_lshl_add_u32 v25, v26, 2, v25
  v_add_u32 v25, v25, v22
  v_mul_u32_u24 v25, 1280, v25
  v_lshl_add_u32 v66, v21, 4, v25
  s_mul_i32 s21, s20, 960
  s_add_u32 s21, s21, 192
  v_add_u32 v21, s21, v1
  v_mul_u32_u24 v22, v21, v29
  v_lshrrev_b32 v22, 22, v22
  v_mul_u32_u24 v23, 80, v22
  v_sub_u32 v21, v21, v23
  v_mul_u32_u24 v26, 5462, v22
  v_lshrrev_b32 v26, 16, v26
  v_mul_u32_u24 v27, 12, v26
  v_sub_u32 v22, v22, v27
  v_lshrrev_b32 v27, 2, v22
  v_and_b32 v22, 3, v22
  v_lshlrev_b32 v25, 4, v27
  v_lshl_add_u32 v25, v26, 2, v25
  v_add_u32 v25, v25, v22
  v_mul_u32_u24 v25, 1280, v25
  v_lshl_add_u32 v67, v21, 4, v25
  s_mul_i32 s21, s20, 960
  s_add_u32 s21, s21, 256
  v_add_u32 v21, s21, v1
  v_mul_u32_u24 v22, v21, v29
  v_lshrrev_b32 v22, 22, v22
  v_mul_u32_u24 v23, 80, v22
  v_sub_u32 v21, v21, v23
  v_mul_u32_u24 v26, 5462, v22
  v_lshrrev_b32 v26, 16, v26
  v_mul_u32_u24 v27, 12, v26
  v_sub_u32 v22, v22, v27
  v_lshrrev_b32 v27, 2, v22
  v_and_b32 v22, 3, v22
  v_lshlrev_b32 v25, 4, v27
  v_lshl_add_u32 v25, v26, 2, v25
  v_add_u32 v25, v25, v22
  v_mul_u32_u24 v25, 1280, v25
  v_lshl_add_u32 v68, v21, 4, v25
  s_mul_i32 s21, s20, 960
  s_add_u32 s21, s21, 320
  v_add_u32 v21, s21, v1
  v_mul_u32_u24 v22, v21, v29
  v_lshrrev_b32 v22, 22, v22
  v_mul_u32_u24 v23, 80, v22
  v_sub_u32 v21, v21, v23
  v_mul_u32_u24 v26, 5462, v22
  v_lshrrev_b32 v26, 16, v26
  v_mul_u32_u24 v27, 12, v26
  v_sub_u32 v22, v22, v27
  v_lshrrev_b32 v27, 2, v22
  v_and_b32 v22, 3, v22
  v_lshlrev_b32 v25, 4, v27
  v_lshl_add_u32 v25, v26, 2, v25
  v_add_u32 v25, v25, v22
  v_mul_u32_u24 v25, 1280, v25
  v_lshl_add_u32 v69, v21, 4, v25
  s_mul_i32 s21, s20, 960
  s_add_u32 s21, s21, 384
  v_add_u32 v21, s21, v1
  v_mul_u32_u24 v22, v21, v29
  v_lshrrev_b32 v22, 22, v22
  v_mul_u32_u24 v23, 80, v22
  v_sub_u32 v21, v21, v23
  v_mul_u32_u24 v26, 5462, v22
  v_lshrrev_b32 v26, 16, v26
  v_mul_u32_u24 v27, 12, v26
  v_sub_u32 v22, v22, v27
  v_lshrrev_b32 v27, 2, v22
  v_and_b32 v22, 3, v22
  v_lshlrev_b32 v25, 4, v27
  v_lshl_add_u32 v25, v26, 2, v25
  v_add_u32 v25, v25, v22
  v_mul_u32_u24 v25, 1280, v25
  v_lshl_add_u32 v70, v21, 4, v25
  s_mul_i32 s21, s20, 960
  s_add_u32 s21, s21, 448
  v_add_u32 v21, s21, v1
  v_mul_u32_u24 v22, v21, v29
  v_lshrrev_b32 v22, 22, v22
  v_mul_u32_u24 v23, 80, v22
  v_sub_u32 v21, v21, v23
  v_mul_u32_u24 v26, 5462, v22
  v_lshrrev_b32 v26, 16, v26
  v_mul_u32_u24 v27, 12, v26
  v_sub_u32 v22, v22, v27
  v_lshrrev_b32 v27, 2, v22
  v_and_b32 v22, 3, v22
  v_lshlrev_b32 v25, 4, v27
  v_lshl_add_u32 v25, v26, 2, v25
  v_add_u32 v25, v25, v22
  v_mul_u32_u24 v25, 1280, v25
  v_lshl_add_u32 v71, v21, 4, v25
  s_mul_i32 s21, s20, 960
  s_add_u32 s21, s21, 512
  v_add_u32 v21, s21, v1
  v_mul_u32_u24 v22, v21, v29
  v_lshrrev_b32 v22, 22, v22
  v_mul_u32_u24 v23, 80, v22
  v_sub_u32 v21, v21, v23
  v_mul_u32_u24 v26, 5462, v22
  v_lshrrev_b32 v26, 16, v26
  v_mul_u32_u24 v27, 12, v26
  v_sub_u32 v22, v22, v27
  v_lshrrev_b32 v27, 2, v22
  v_and_b32 v22, 3, v22
  v_lshlrev_b32 v25, 4, v27
  v_lshl_add_u32 v25, v26, 2, v25
  v_add_u32 v25, v25, v22
  v_mul_u32_u24 v25, 1280, v25
  v_lshl_add_u32 v72, v21, 4, v25
  s_mul_i32 s21, s20, 960
  s_add_u32 s21, s21, 576
  v_add_u32 v21, s21, v1
  v_mul_u32_u24 v22, v21, v29
  v_lshrrev_b32 v22, 22, v22
  v_mul_u32_u24 v23, 80, v22
  v_sub_u32 v21, v21, v23
  v_mul_u32_u24 v26, 5462, v22
  v_lshrrev_b32 v26, 16, v26
  v_mul_u32_u24 v27, 12, v26
  v_sub_u32 v22, v22, v27
  v_lshrrev_b32 v27, 2, v22
  v_and_b32 v22, 3, v22
  v_lshlrev_b32 v25, 4, v27
  v_lshl_add_u32 v25, v26, 2, v25
  v_add_u32 v25, v25, v22
  v_mul_u32_u24 v25, 1280, v25
  v_lshl_add_u32 v73, v21, 4, v25
  s_mul_i32 s21, s20, 960
  s_add_u32 s21, s21, 640
  v_add_u32 v21, s21, v1
  v_mul_u32_u24 v22, v21, v29
  v_lshrrev_b32 v22, 22, v22
  v_mul_u32_u24 v23, 80, v22
  v_sub_u32 v21, v21, v23
  v_mul_u32_u24 v26, 5462, v22
  v_lshrrev_b32 v26, 16, v26
  v_mul_u32_u24 v27, 12, v26
  v_sub_u32 v22, v22, v27
  v_lshrrev_b32 v27, 2, v22
  v_and_b32 v22, 3, v22
  v_lshlrev_b32 v25, 4, v27
  v_lshl_add_u32 v25, v26, 2, v25
  v_add_u32 v25, v25, v22
  v_mul_u32_u24 v25, 1280, v25
  v_lshl_add_u32 v74, v21, 4, v25
  s_mul_i32 s21, s20, 960
  s_add_u32 s21, s21, 704
  v_add_u32 v21, s21, v1
  v_mul_u32_u24 v22, v21, v29
  v_lshrrev_b32 v22, 22, v22
  v_mul_u32_u24 v23, 80, v22
  v_sub_u32 v21, v21, v23
  v_mul_u32_u24 v26, 5462, v22
  v_lshrrev_b32 v26, 16, v26
  v_mul_u32_u24 v27, 12, v26
  v_sub_u32 v22, v22, v27
  v_lshrrev_b32 v27, 2, v22
  v_and_b32 v22, 3, v22
  v_lshlrev_b32 v25, 4, v27
  v_lshl_add_u32 v25, v26, 2, v25
  v_add_u32 v25, v25, v22
  v_mul_u32_u24 v25, 1280, v25
  v_lshl_add_u32 v75, v21, 4, v25
  s_mul_i32 s21, s20, 960
  s_add_u32 s21, s21, 768
  v_add_u32 v21, s21, v1
  v_mul_u32_u24 v22, v21, v29
  v_lshrrev_b32 v22, 22, v22
  v_mul_u32_u24 v23, 80, v22
  v_sub_u32 v21, v21, v23
  v_mul_u32_u24 v26, 5462, v22
  v_lshrrev_b32 v26, 16, v26
  v_mul_u32_u24 v27, 12, v26
  v_sub_u32 v22, v22, v27
  v_lshrrev_b32 v27, 2, v22
  v_and_b32 v22, 3, v22
  v_lshlrev_b32 v25, 4, v27
  v_lshl_add_u32 v25, v26, 2, v25
  v_add_u32 v25, v25, v22
  v_mul_u32_u24 v25, 1280, v25
  v_lshl_add_u32 v76, v21, 4, v25
  s_mul_i32 s21, s20, 960
  s_add_u32 s21, s21, 832
  v_add_u32 v21, s21, v1
  v_mul_u32_u24 v22, v21, v29
  v_lshrrev_b32 v22, 22, v22
  v_mul_u32_u24 v23, 80, v22
  v_sub_u32 v21, v21, v23
  v_mul_u32_u24 v26, 5462, v22
  v_lshrrev_b32 v26, 16, v26
  v_mul_u32_u24 v27, 12, v26
  v_sub_u32 v22, v22, v27
  v_lshrrev_b32 v27, 2, v22
  v_and_b32 v22, 3, v22
  v_lshlrev_b32 v25, 4, v27
  v_lshl_add_u32 v25, v26, 2, v25
  v_add_u32 v25, v25, v22
  v_mul_u32_u24 v25, 1280, v25
  v_lshl_add_u32 v77, v21, 4, v25
  s_mul_i32 s21, s20, 960
  s_add_u32 s21, s21, 896
  v_add_u32 v21, s21, v1
  v_mul_u32_u24 v22, v21, v29
  v_lshrrev_b32 v22, 22, v22
  v_mul_u32_u24 v23, 80, v22
  v_sub_u32 v21, v21, v23
  v_mul_u32_u24 v26, 5462, v22
  v_lshrrev_b32 v26, 16, v26
  v_mul_u32_u24 v27, 12, v26
  v_sub_u32 v22, v22, v27
  v_lshrrev_b32 v27, 2, v22
  v_and_b32 v22, 3, v22
  v_lshlrev_b32 v25, 4, v27
  v_lshl_add_u32 v25, v26, 2, v25
  v_add_u32 v25, v25, v22
  v_mul_u32_u24 v25, 1280, v25
  v_lshl_add_u32 v78, v21, 4, v25
  v_lshrrev_b32 v6, 2, v2
  v_lshl_add_u32 v6, v3, 3, v6
  v_mul_u32_u24 v6, 1280, v6
  v_and_b32 v7, 3, v2
  v_lshlrev_b32 v7, 3, v7
  s_mul_i32 s21, s20, 320
  v_add3_u32 v6, v6, v7, s21
  v_add_u32 v7, 40960, v6
  v_add_u32 v8, 81920, v6
  s_mul_i32 s40, s2, 245760
  s_add_u32 s21, s40, 0
  s_mul_i32 s22, s20, 15360
  s_add_u32 s22, s22, 0
  s_add_u32 m0, s22, 0
  s_nop 0
  buffer_load_dwordx4 v64, s[12:15], s21 offen lds
  s_add_u32 m0, s22, 1024
  s_nop 0
  buffer_load_dwordx4 v65, s[12:15], s21 offen lds
  s_add_u32 m0, s22, 2048
  s_nop 0
  buffer_load_dwordx4 v66, s[12:15], s21 offen lds
  s_add_u32 m0, s22, 3072
  s_nop 0
  buffer_load_dwordx4 v67, s[12:15], s21 offen lds
  s_add_u32 m0, s22, 4096
  s_nop 0
  buffer_load_dwordx4 v68, s[12:15], s21 offen lds
  s_add_u32 m0, s22, 5120
  s_nop 0
  buffer_load_dwordx4 v69, s[12:15], s21 offen lds
  s_add_u32 m0, s22, 6144
  s_nop 0
  buffer_load_dwordx4 v70, s[12:15], s21 offen lds
  s_add_u32 m0, s22, 7168
  s_nop 0
  buffer_load_dwordx4 v71, s[12:15], s21 offen lds
  s_add_u32 m0, s22, 8192
  s_nop 0
  buffer_load_dwordx4 v72, s[12:15], s21 offen lds
  s_add_u32 m0, s22, 9216
  s_nop 0
  buffer_load_dwordx4 v73, s[12:15], s21 offen lds
  s_add_u32 m0, s22, 10240
  s_nop 0
  buffer_load_dwordx4 v74, s[12:15], s21 offen lds
  s_add_u32 m0, s22, 11264
  s_nop 0
  buffer_load_dwordx4 v75, s[12:15], s21 offen lds
  s_add_u32 m0, s22, 12288
  s_nop 0
  buffer_load_dwordx4 v76, s[12:15], s21 offen lds
  s_add_u32 m0, s22, 13312
  s_nop 0
  buffer_load_dwordx4 v77, s[12:15], s21 offen lds
  s_add_u32 m0, s22, 14336
  s_nop 0
  buffer_load_dwordx4 v78, s[12:15], s21 offen lds
  s_add_u32 s21, s40, 61440
  s_mul_i32 s22, s20, 15360
  s_add_u32 s22, s22, 61440
  s_add_u32 m0, s22, 0
  s_nop 0
  buffer_load_dwordx4 v64, s[12:15], s21 offen lds
  s_add_u32 m0, s22, 1024
  s_nop 0
  buffer_load_dwordx4 v65, s[12:15], s21 offen lds
  s_add_u32 m0, s22, 2048
  s_nop 0
  buffer_load_dwordx4 v66, s[12:15], s21 offen lds
  s_add_u32 m0, s22, 3072
  s_nop 0
  buffer_load_dwordx4 v67, s[12:15], s21 offen lds
  s_add_u32 m0, s22, 4096
  s_nop 0
  buffer_load_dwordx4 v68, s[12:15], s21 offen lds
  s_add_u32 m0, s22, 5120
  s_nop 0
  buffer_load_dwordx4 v69, s[12:15], s21 offen lds
  s_add_u32 m0, s22, 6144
  s_nop 0
  buffer_load_dwordx4 v70, s[12:15], s21 offen lds
  s_add_u32 m0, s22, 7168
  s_nop 0
  buffer_load_dwordx4 v71, s[12:15], s21 offen lds
  s_add_u32 m0, s22, 8192
  s_nop 0
  buffer_load_dwordx4 v72, s[12:15], s21 offen lds
  s_add_u32 m0, s22, 9216
  s_nop 0
  buffer_load_dwordx4 v73, s[12:15], s21 offen lds
  s_add_u32 m0, s22, 10240
  s_nop 0
  buffer_load_dwordx4 v74, s[12:15], s21 offen lds
  s_add_u32 m0, s22, 11264
  s_nop 0
  buffer_load_dwordx4 v75, s[12:15], s21 offen lds
  s_add_u32 m0, s22, 12288
  s_nop 0
  buffer_load_dwordx4 v76, s[12:15], s21 offen lds
  s_add_u32 m0, s22, 13312
  s_nop 0
  buffer_load_dwordx4 v77, s[12:15], s21 offen lds
  s_add_u32 m0, s22, 14336
  s_nop 0
  buffer_load_dwordx4 v78, s[12:15], s21 offen lds
  s_waitcnt vmcnt(0)
  s_barrier
  ds_read_b64_tr_b16 a[0:1], v6 offset:0
  ds_read_b64_tr_b16 a[2:3], v6 offset:5120
  ds_read_b64_tr_b16 a[24:25], v6 offset:32
  ds_read_b64_tr_b16 a[26:27], v6 offset:5152
  ds_read_b64_tr_b16 a[48:49], v6 offset:64
  ds_read_b64_tr_b16 a[50:51], v6 offset:5184
  ds_read_b64_tr_b16 a[72:73], v6 offset:96
  ds_read_b64_tr_b16 a[74:75], v6 offset:5216
  ds_read_b64_tr_b16 a[96:97], v6 offset:128
  ds_read_b64_tr_b16 a[98:99], v6 offset:5248
  ds_read_b64_tr_b16 a[120:121], v6 offset:160
  ds_read_b64_tr_b16 a[122:123], v6 offset:5280
  ds_read_b64_tr_b16 a[144:145], v6 offset:192
  ds_read_b64_tr_b16 a[146:147], v6 offset:5312
  ds_read_b64_tr_b16 a[168:169], v6 offset:224
  ds_read_b64_tr_b16 a[170:171], v6 offset:5344
  ds_read_b64_tr_b16 a[192:193], v6 offset:256
  ds_read_b64_tr_b16 a[194:195], v6 offset:5376
  ds_read_b64_tr_b16 a[216:217], v6 offset:288
  ds_read_b64_tr_b16 a[218:219], v6 offset:5408
  ds_read_b64_tr_b16 a[4:5], v7 offset:0
  ds_read_b64_tr_b16 a[6:7], v7 offset:5120
  ds_read_b64_tr_b16 a[28:29], v7 offset:32
  ds_read_b64_tr_b16 a[30:31], v7 offset:5152
  ds_read_b64_tr_b16 a[52:53], v7 offset:64
  ds_read_b64_tr_b16 a[54:55], v7 offset:5184
  ds_read_b64_tr_b16 a[76:77], v7 offset:96
  ds_read_b64_tr_b16 a[78:79], v7 offset:5216
  ds_read_b64_tr_b16 a[100:101], v7 offset:128
  ds_read_b64_tr_b16 a[102:103], v7 offset:5248
  ds_read_b64_tr_b16 a[124:125], v7 offset:160
  ds_read_b64_tr_b16 a[126:127], v7 offset:5280
  ds_read_b64_tr_b16 a[148:149], v7 offset:192
  ds_read_b64_tr_b16 a[150:151], v7 offset:5312
  ds_read_b64_tr_b16 a[172:173], v7 offset:224
  ds_read_b64_tr_b16 a[174:175], v7 offset:5344
  ds_read_b64_tr_b16 a[196:197], v7 offset:256
  ds_read_b64_tr_b16 a[198:199], v7 offset:5376
  ds_read_b64_tr_b16 a[220:221], v7 offset:288
  ds_read_b64_tr_b16 a[222:223], v7 offset:5408
  ds_read_b64_tr_b16 a[8:9], v8 offset:0
  ds_read_b64_tr_b16 a[10:11], v8 offset:5120
  ds_read_b64_tr_b16 a[32:33], v8 offset:32
  ds_read_b64_tr_b16 a[34:35], v8 offset:5152
  ds_read_b64_tr_b16 a[56:57], v8 offset:64
  ds_read_b64_tr_b16 a[58:59], v8 offset:5184
  ds_read_b64_tr_b16 a[80:81], v8 offset:96
  ds_read_b64_tr_b16 a[82:83], v8 offset:5216
  ds_read_b64_tr_b16 a[104:105], v8 offset:128
  ds_read_b64_tr_b16 a[106:107], v8 offset:5248
  ds_read_b64_tr_b16 a[128:129], v8 offset:160
  ds_read_b64_tr_b16 a[130:131], v8 offset:5280
  ds_read_b64_tr_b16 a[152:153], v8 offset:192
  ds_read_b64_tr_b16 a[154:155], v8 offset:5312
  ds_read_b64_tr_b16 a[176:177], v8 offset:224
  ds_read_b64_tr_b16 a[178:179], v8 offset:5344
  ds_read_b64_tr_b16 a[200:201], v8 offset:256
  ds_read_b64_tr_b16 a[202:203], v8 offset:5376
  ds_read_b64_tr_b16 a[224:225], v8 offset:288
  ds_read_b64_tr_b16 a[226:227], v8 offset:5408
  s_waitcnt lgkmcnt(0)
  s_barrier
  s_add_u32 s21, s40, 122880
  s_mul_i32 s22, s20, 15360
  s_add_u32 s22, s22, 0
  s_add_u32 m0, s22, 0
  s_nop 0
  buffer_load_dwordx4 v64, s[12:15], s21 offen lds
  s_add_u32 m0, s22, 1024
  s_nop 0
  buffer_load_dwordx4 v65, s[12:15], s21 offen lds
  s_add_u32 m0, s22, 2048
  s_nop 0
  buffer_load_dwordx4 v66, s[12:15], s21 offen lds
  s_add_u32 m0, s22, 3072
  s_nop 0
  buffer_load_dwordx4 v67, s[12:15], s21 offen lds
  s_add_u32 m0, s22, 4096
  s_nop 0
  buffer_load_dwordx4 v68, s[12:15], s21 offen lds
  s_add_u32 m0, s22, 5120
  s_nop 0
  buffer_load_dwordx4 v69, s[12:15], s21 offen lds
  s_add_u32 m0, s22, 6144
  s_nop 0
  buffer_load_dwordx4 v70, s[12:15], s21 offen lds
  s_add_u32 m0, s22, 7168
  s_nop 0
  buffer_load_dwordx4 v71, s[12:15], s21 offen lds
  s_add_u32 m0, s22, 8192
  s_nop 0
  buffer_load_dwordx4 v72, s[12:15], s21 offen lds
  s_add_u32 m0, s22, 9216
  s_nop 0
  buffer_load_dwordx4 v73, s[12:15], s21 offen lds
  s_add_u32 m0, s22, 10240
  s_nop 0
  buffer_load_dwordx4 v74, s[12:15], s21 offen lds
  s_add_u32 m0, s22, 11264
  s_nop 0
  buffer_load_dwordx4 v75, s[12:15], s21 offen lds
  s_add_u32 m0, s22, 12288
  s_nop 0
  buffer_load_dwordx4 v76, s[12:15], s21 offen lds
  s_add_u32 m0, s22, 13312
  s_nop 0
  buffer_load_dwordx4 v77, s[12:15], s21 offen lds
  s_add_u32 m0, s22, 14336
  s_nop 0
  buffer_load_dwordx4 v78, s[12:15], s21 offen lds
  s_add_u32 s21, s40, 184320
  s_mul_i32 s22, s20, 15360
  s_add_u32 s22, s22, 61440
  s_add_u32 m0, s22, 0
  s_nop 0
  buffer_load_dwordx4 v64, s[12:15], s21 offen lds
  s_add_u32 m0, s22, 1024
  s_nop 0
  buffer_load_dwordx4 v65, s[12:15], s21 offen lds
  s_add_u32 m0, s22, 2048
  s_nop 0
  buffer_load_dwordx4 v66, s[12:15], s21 offen lds
  s_add_u32 m0, s22, 3072
  s_nop 0
  buffer_load_dwordx4 v67, s[12:15], s21 offen lds
  s_add_u32 m0, s22, 4096
  s_nop 0
  buffer_load_dwordx4 v68, s[12:15], s21 offen lds
  s_add_u32 m0, s22, 5120
  s_nop 0
  buffer_load_dwordx4 v69, s[12:15], s21 offen lds
  s_add_u32 m0, s22, 6144
  s_nop 0
  buffer_load_dwordx4 v70, s[12:15], s21 offen lds
  s_add_u32 m0, s22, 7168
  s_nop 0
  buffer_load_dwordx4 v71, s[12:15], s21 offen lds
  s_add_u32 m0, s22, 8192
  s_nop 0
  buffer_load_dwordx4 v72, s[12:15], s21 offen lds
  s_add_u32 m0, s22, 9216
  s_nop 0
  buffer_load_dwordx4 v73, s[12:15], s21 offen lds
  s_add_u32 m0, s22, 10240
  s_nop 0
  buffer_load_dwordx4 v74, s[12:15], s21 offen lds
  s_add_u32 m0, s22, 11264
  s_nop 0
  buffer_load_dwordx4 v75, s[12:15], s21 offen lds
  s_add_u32 m0, s22, 12288
  s_nop 0
  buffer_load_dwordx4 v76, s[12:15], s21 offen lds
  s_add_u32 m0, s22, 13312
  s_nop 0
  buffer_load_dwordx4 v77, s[12:15], s21 offen lds
  s_add_u32 m0, s22, 14336
  s_nop 0
  buffer_load_dwordx4 v78, s[12:15], s21 offen lds
  s_waitcnt vmcnt(0)
  s_barrier
  ds_read_b64_tr_b16 a[12:13], v6 offset:0
  ds_read_b64_tr_b16 a[14:15], v6 offset:5120
  ds_read_b64_tr_b16 a[36:37], v6 offset:32
  ds_read_b64_tr_b16 a[38:39], v6 offset:5152
  ds_read_b64_tr_b16 a[60:61], v6 offset:64
  ds_read_b64_tr_b16 a[62:63], v6 offset:5184
  ds_read_b64_tr_b16 a[84:85], v6 offset:96
  ds_read_b64_tr_b16 a[86:87], v6 offset:5216
  ds_read_b64_tr_b16 a[108:109], v6 offset:128
  ds_read_b64_tr_b16 a[110:111], v6 offset:5248
  ds_read_b64_tr_b16 a[132:133], v6 offset:160
  ds_read_b64_tr_b16 a[134:135], v6 offset:5280
  ds_read_b64_tr_b16 a[156:157], v6 offset:192
  ds_read_b64_tr_b16 a[158:159], v6 offset:5312
  ds_read_b64_tr_b16 a[180:181], v6 offset:224
  ds_read_b64_tr_b16 a[182:183], v6 offset:5344
  ds_read_b64_tr_b16 a[204:205], v6 offset:256
  ds_read_b64_tr_b16 a[206:207], v6 offset:5376
  ds_read_b64_tr_b16 a[228:229], v6 offset:288
  ds_read_b64_tr_b16 a[230:231], v6 offset:5408
  ds_read_b64_tr_b16 a[16:17], v7 offset:0
  ds_read_b64_tr_b16 a[18:19], v7 offset:5120
  ds_read_b64_tr_b16 a[40:41], v7 offset:32
  ds_read_b64_tr_b16 a[42:43], v7 offset:5152
  ds_read_b64_tr_b16 a[64:65], v7 offset:64
  ds_read_b64_tr_b16 a[66:67], v7 offset:5184
  ds_read_b64_tr_b16 a[88:89], v7 offset:96
  ds_read_b64_tr_b16 a[90:91], v7 offset:5216
  ds_read_b64_tr_b16 a[112:113], v7 offset:128
  ds_read_b64_tr_b16 a[114:115], v7 offset:5248
  ds_read_b64_tr_b16 a[136:137], v7 offset:160
  ds_read_b64_tr_b16 a[138:139], v7 offset:5280
  ds_read_b64_tr_b16 a[160:161], v7 offset:192
  ds_read_b64_tr_b16 a[162:163], v7 offset:5312
  ds_read_b64_tr_b16 a[184:185], v7 offset:224
  ds_read_b64_tr_b16 a[186:187], v7 offset:5344
  ds_read_b64_tr_b16 a[208:209], v7 offset:256
  ds_read_b64_tr_b16 a[210:211], v7 offset:5376
  ds_read_b64_tr_b16 a[232:233], v7 offset:288
  ds_read_b64_tr_b16 a[234:235], v7 offset:5408
  ds_read_b64_tr_b16 a[20:21], v8 offset:0
  ds_read_b64_tr_b16 a[22:23], v8 offset:5120
  ds_read_b64_tr_b16 a[44:45], v8 offset:32
  ds_read_b64_tr_b16 a[46:47], v8 offset:5152
  ds_read_b64_tr_b16 a[68:69], v8 offset:64
  ds_read_b64_tr_b16 a[70:71], v8 offset:5184
  ds_read_b64_tr_b16 a[92:93], v8 offset:96
  ds_read_b64_tr_b16 a[94:95], v8 offset:5216
  ds_read_b64_tr_b16 a[116:117], v8 offset:128
  ds_read_b64_tr_b16 a[118:119], v8 offset:5248
  ds_read_b64_tr_b16 a[140:141], v8 offset:160
  ds_read_b64_tr_b16 a[142:143], v8 offset:5280
  ds_read_b64_tr_b16 a[164:165], v8 offset:192
  ds_read_b64_tr_b16 a[166:167], v8 offset:5312
  ds_read_b64_tr_b16 a[188:189], v8 offset:224
  ds_read_b64_tr_b16 a[190:191], v8 offset:5344
  ds_read_b64_tr_b16 a[212:213], v8 offset:256
  ds_read_b64_tr_b16 a[214:215], v8 offset:5376
  ds_read_b64_tr_b16 a[236:237], v8 offset:288
  ds_read_b64_tr_b16 a[238:239], v8 offset:5408
  s_waitcnt lgkmcnt(0)
  s_barrier
  s_load_dwordx2 s[32:33], s[0:1], 96
  s_waitcnt lgkmcnt(0)
  s_mov_b32 s32, s32
  s_mov_b32 s33, s33
  s_mov_b32 s34, 256
  s_mov_b32 s35, 0x00020000
  s_mov_b32 s21, 76
  s_cmp_lg_u32 s20, 0
  s_cbranch_scc1 wf_195
  v_mov_b32 v4, 0
  s_mov_b32 s101, 0
wf_194:
  buffer_load_dword v5, v4, s[32:35], s21 offen sc1
  s_add_u32 s101, s101, 1
  s_cmp_gt_u32 s101, 131072
  s_cbranch_scc1 main_end
  s_waitcnt vmcnt(0)
  v_readfirstlane_b32 s100, v5
  s_cmp_ge_u32 s100, 1
  s_cbranch_scc1 wf_195
  s_sleep 8
  s_branch wf_194
wf_195:
  s_barrier
  s_mul_i32 s41, s2, 12288
  s_add_u32 s47, s41, 25165824
  s_mov_b32 s41, s47
  s_mul_i32 s21, s20, 10
  s_mul_i32 s47, s2, 5
  s_lshr_b32 s22, s21, 3
  s_add_u32 s47, s47, s22
  s_and_b32 s48, s21, 7
  s_mov_b32 s66, 0
  s_mov_b32 s67, 0
  s_lshr_b32 s43, s2, 2
  s_lshl_b32 s43, s43, 7
  s_add_u32 s43, s43, 0
  s_lshl_b32 s44, s2, 7
  s_lshl_b32 s21, s20, 2
  s_add_u32 s44, s44, s21
  s_add_u32 s44, s44, 94208
  s_mov_b32 s45, 0
  s_mov_b32 s49, 1
  s_mov_b32 s50, 0
  v_mov_b32 v10, 0
  v_mov_b32 v11, 1
  v_lshlrev_b32 v4, 4, v1
  s_add_u32 s76, s38, 56623104
  s_addc_u32 s77, s39, 0
  s_mov_b32 s78, 6291456
  s_mov_b32 s79, 0x00020000
  s_add_u32 s80, s38, 93323264
  s_addc_u32 s81, s39, 0
  s_mov_b32 s82, 20971520
  s_mov_b32 s83, 0x00020000
  v_and_b32 v12, 3, v1
  v_lshlrev_b32 v12, 3, v12
  v_add_u32 v12, 4, v12
  v_and_b32 v13, 7, v2
  v_lshlrev_b32 v13, 4, v13
  v_lshl_add_u32 v13, v3, 7, v13
  v_lshrrev_b32 v14, 3, v2
  v_mul_u32_u24 v14, 98304, v14
  v_add_u32 v14, v14, v13
  v_and_b32 v15, 1, v3
  v_lshlrev_b32 v15, 8, v15
  v_lshl_add_u32 v15, v2, 4, v15
  v_lshrrev_b32 v16, 1, v3
  v_mul_u32_u24 v16, 327680, v16
  v_add_u32 v15, v15, v16
  v_lshlrev_b32 v17, 10, v1
  v_mov_b32 v19, 0
  s_lshl_b32 s53, s2, 7
  s_add_u32 s53, s53, 18432
  s_mov_b32 s55, 0
  s_mov_b32 s56, 0
  s_mov_b32 s58, 0
  s_mov_b32 s59, 0
  s_add_u32 s84, s38, 50331648
  s_addc_u32 s85, s39, 0
  s_mov_b32 s86, 12582912
  s_mov_b32 s87, 0x00020000
  s_and_b32 s21, s2, 3
  s_mul_i32 s51, s2, 3072
  s_cmp_eq_u32 s21, s20
  s_cselect_b32 s51, s51, 6291456
  v_mov_b32 v244, -1
  v_mov_b32 v245, -1
  v_mov_b32 v246, -1
  v_mov_b32 v247, -1
  s_add_u32 s88, s38, 85983232
  s_addc_u32 s89, s39, 0
  s_mov_b32 s90, 5242880
  s_mov_b32 s91, 0x00020000
  s_cmp_ge_u32 s51, 6291456
  s_cbranch_scc1 tch_196
  s_add_u32 s21, s51, 6291456
  buffer_store_dwordx4 v[244:247], v4, s[84:87], s51 offen offset:0 sc1
  buffer_store_dwordx4 v[244:247], v4, s[84:87], s21 offen offset:0 sc1
  buffer_store_dwordx4 v[244:247], v4, s[84:87], s51 offen offset:1024 sc1
  buffer_store_dwordx4 v[244:247], v4, s[84:87], s21 offen offset:1024 sc1
  buffer_store_dwordx4 v[244:247], v4, s[84:87], s51 offen offset:2048 sc1
  buffer_store_dwordx4 v[244:247], v4, s[84:87], s21 offen offset:2048 sc1
  s_add_u32 s51, s51, 98304
tch_196:
  s_cmp_ge_u32 s51, 6291456
  s_cbranch_scc1 tch_197
  s_add_u32 s21, s51, 6291456
  buffer_store_dwordx4 v[244:247], v4, s[84:87], s51 offen offset:0 sc1
  buffer_store_dwordx4 v[244:247], v4, s[84:87], s21 offen offset:0 sc1
  buffer_store_dwordx4 v[244:247], v4, s[84:87], s51 offen offset:1024 sc1
  buffer_store_dwordx4 v[244:247], v4, s[84:87], s21 offen offset:1024 sc1
  buffer_store_dwordx4 v[244:247], v4, s[84:87], s51 offen offset:2048 sc1
  buffer_store_dwordx4 v[244:247], v4, s[84:87], s21 offen offset:2048 sc1
  s_add_u32 s51, s51, 98304
tch_197:
  s_cmp_ge_u32 s51, 6291456
  s_cbranch_scc1 tch_198
  s_add_u32 s21, s51, 6291456
  buffer_store_dwordx4 v[244:247], v4, s[84:87], s51 offen offset:0 sc1
  buffer_store_dwordx4 v[244:247], v4, s[84:87], s21 offen offset:0 sc1
  buffer_store_dwordx4 v[244:247], v4, s[84:87], s51 offen offset:1024 sc1
  buffer_store_dwordx4 v[244:247], v4, s[84:87], s21 offen offset:1024 sc1
  buffer_store_dwordx4 v[244:247], v4, s[84:87], s51 offen offset:2048 sc1
  buffer_store_dwordx4 v[244:247], v4, s[84:87], s21 offen offset:2048 sc1
  s_add_u32 s51, s51, 98304
tch_198:
  s_cmp_ge_u32 s51, 6291456
  s_cbranch_scc1 tch_199
  s_add_u32 s21, s51, 6291456
  buffer_store_dwordx4 v[244:247], v4, s[84:87], s51 offen offset:0 sc1
  buffer_store_dwordx4 v[244:247], v4, s[84:87], s21 offen offset:0 sc1
  buffer_store_dwordx4 v[244:247], v4, s[84:87], s51 offen offset:1024 sc1
  buffer_store_dwordx4 v[244:247], v4, s[84:87], s21 offen offset:1024 sc1
  buffer_store_dwordx4 v[244:247], v4, s[84:87], s51 offen offset:2048 sc1
  buffer_store_dwordx4 v[244:247], v4, s[84:87], s21 offen offset:2048 sc1
  s_add_u32 s51, s51, 98304
tch_199:
  s_cmp_ge_u32 s51, 6291456
  s_cbranch_scc1 tch_200
  s_add_u32 s21, s51, 6291456
  buffer_store_dwordx4 v[244:247], v4, s[84:87], s51 offen offset:0 sc1
  buffer_store_dwordx4 v[244:247], v4, s[84:87], s21 offen offset:0 sc1
  buffer_store_dwordx4 v[244:247], v4, s[84:87], s51 offen offset:1024 sc1
  buffer_store_dwordx4 v[244:247], v4, s[84:87], s21 offen offset:1024 sc1
  buffer_store_dwordx4 v[244:247], v4, s[84:87], s51 offen offset:2048 sc1
  buffer_store_dwordx4 v[244:247], v4, s[84:87], s21 offen offset:2048 sc1
  s_add_u32 s51, s51, 98304
tch_200:
  s_cmp_ge_u32 s51, 6291456
  s_cbranch_scc1 tch_201
  s_add_u32 s21, s51, 6291456
  buffer_store_dwordx4 v[244:247], v4, s[84:87], s51 offen offset:0 sc1
  buffer_store_dwordx4 v[244:247], v4, s[84:87], s21 offen offset:0 sc1
  buffer_store_dwordx4 v[244:247], v4, s[84:87], s51 offen offset:1024 sc1
  buffer_store_dwordx4 v[244:247], v4, s[84:87], s21 offen offset:1024 sc1
  buffer_store_dwordx4 v[244:247], v4, s[84:87], s51 offen offset:2048 sc1
  buffer_store_dwordx4 v[244:247], v4, s[84:87], s21 offen offset:2048 sc1
  s_add_u32 s51, s51, 98304
tch_201:
  s_cmp_ge_u32 s51, 6291456
  s_cbranch_scc1 tch_202
  s_add_u32 s21, s51, 6291456
  buffer_store_dwordx4 v[244:247], v4, s[84:87], s51 offen offset:0 sc1
  buffer_store_dwordx4 v[244:247], v4, s[84:87], s21 offen offset:0 sc1
  buffer_store_dwordx4 v[244:247], v4, s[84:87], s51 offen offset:1024 sc1
  buffer_store_dwordx4 v[244:247], v4, s[84:87], s21 offen offset:1024 sc1
  buffer_store_dwordx4 v[244:247], v4, s[84:87], s51 offen offset:2048 sc1
  buffer_store_dwordx4 v[244:247], v4, s[84:87], s21 offen offset:2048 sc1
  s_add_u32 s51, s51, 98304
tch_202:
  s_cmp_ge_u32 s51, 6291456
  s_cbranch_scc1 tch_203
  s_add_u32 s21, s51, 6291456
  buffer_store_dwordx4 v[244:247], v4, s[84:87], s51 offen offset:0 sc1
  buffer_store_dwordx4 v[244:247], v4, s[84:87], s21 offen offset:0 sc1
  buffer_store_dwordx4 v[244:247], v4, s[84:87], s51 offen offset:1024 sc1
  buffer_store_dwordx4 v[244:247], v4, s[84:87], s21 offen offset:1024 sc1
  buffer_store_dwordx4 v[244:247], v4, s[84:87], s51 offen offset:2048 sc1
  buffer_store_dwordx4 v[244:247], v4, s[84:87], s21 offen offset:2048 sc1
  s_add_u32 s51, s51, 98304
tch_203:
  s_cmp_ge_u32 s51, 6291456
  s_cbranch_scc1 tch_204
  s_add_u32 s21, s51, 6291456
  buffer_store_dwordx4 v[244:247], v4, s[84:87], s51 offen offset:0 sc1
  buffer_store_dwordx4 v[244:247], v4, s[84:87], s21 offen offset:0 sc1
  buffer_store_dwordx4 v[244:247], v4, s[84:87], s51 offen offset:1024 sc1
  buffer_store_dwordx4 v[244:247], v4, s[84:87], s21 offen offset:1024 sc1
  buffer_store_dwordx4 v[244:247], v4, s[84:87], s51 offen offset:2048 sc1
  buffer_store_dwordx4 v[244:247], v4, s[84:87], s21 offen offset:2048 sc1
  s_add_u32 s51, s51, 98304
tch_204:
  s_cmp_ge_u32 s51, 6291456
  s_cbranch_scc1 tch_205
  s_add_u32 s21, s51, 6291456
  buffer_store_dwordx4 v[244:247], v4, s[84:87], s51 offen offset:0 sc1
  buffer_store_dwordx4 v[244:247], v4, s[84:87], s21 offen offset:0 sc1
  buffer_store_dwordx4 v[244:247], v4, s[84:87], s51 offen offset:1024 sc1
  buffer_store_dwordx4 v[244:247], v4, s[84:87], s21 offen offset:1024 sc1
  buffer_store_dwordx4 v[244:247], v4, s[84:87], s51 offen offset:2048 sc1
  buffer_store_dwordx4 v[244:247], v4, s[84:87], s21 offen offset:2048 sc1
  s_add_u32 s51, s51, 98304
tch_205:
  s_cmp_ge_u32 s51, 6291456
  s_cbranch_scc1 tch_206
  s_add_u32 s21, s51, 6291456
  buffer_store_dwordx4 v[244:247], v4, s[84:87], s51 offen offset:0 sc1
  buffer_store_dwordx4 v[244:247], v4, s[84:87], s21 offen offset:0 sc1
  buffer_store_dwordx4 v[244:247], v4, s[84:87], s51 offen offset:1024 sc1
  buffer_store_dwordx4 v[244:247], v4, s[84:87], s21 offen offset:1024 sc1
  buffer_store_dwordx4 v[244:247], v4, s[84:87], s51 offen offset:2048 sc1
  buffer_store_dwordx4 v[244:247], v4, s[84:87], s21 offen offset:2048 sc1
  s_add_u32 s51, s51, 98304
tch_206:
  s_cmp_ge_u32 s51, 6291456
  s_cbranch_scc1 tch_207
  s_add_u32 s21, s51, 6291456
  buffer_store_dwordx4 v[244:247], v4, s[84:87], s51 offen offset:0 sc1
  buffer_store_dwordx4 v[244:247], v4, s[84:87], s21 offen offset:0 sc1
  buffer_store_dwordx4 v[244:247], v4, s[84:87], s51 offen offset:1024 sc1
  buffer_store_dwordx4 v[244:247], v4, s[84:87], s21 offen offset:1024 sc1
  buffer_store_dwordx4 v[244:247], v4, s[84:87], s51 offen offset:2048 sc1
  buffer_store_dwordx4 v[244:247], v4, s[84:87], s21 offen offset:2048 sc1
  s_add_u32 s51, s51, 98304
tch_207:
  s_cmp_ge_u32 s51, 6291456
  s_cbranch_scc1 tch_208
  s_add_u32 s21, s51, 6291456
  buffer_store_dwordx4 v[244:247], v4, s[84:87], s51 offen offset:0 sc1
  buffer_store_dwordx4 v[244:247], v4, s[84:87], s21 offen offset:0 sc1
  buffer_store_dwordx4 v[244:247], v4, s[84:87], s51 offen offset:1024 sc1
  buffer_store_dwordx4 v[244:247], v4, s[84:87], s21 offen offset:1024 sc1
  buffer_store_dwordx4 v[244:247], v4, s[84:87], s51 offen offset:2048 sc1
  buffer_store_dwordx4 v[244:247], v4, s[84:87], s21 offen offset:2048 sc1
  s_add_u32 s51, s51, 98304
tch_208:
  s_cmp_ge_u32 s51, 6291456
  s_cbranch_scc1 tch_209
  s_add_u32 s21, s51, 6291456
  buffer_store_dwordx4 v[244:247], v4, s[84:87], s51 offen offset:0 sc1
  buffer_store_dwordx4 v[244:247], v4, s[84:87], s21 offen offset:0 sc1
  buffer_store_dwordx4 v[244:247], v4, s[84:87], s51 offen offset:1024 sc1
  buffer_store_dwordx4 v[244:247], v4, s[84:87], s21 offen offset:1024 sc1
  buffer_store_dwordx4 v[244:247], v4, s[84:87], s51 offen offset:2048 sc1
  buffer_store_dwordx4 v[244:247], v4, s[84:87], s21 offen offset:2048 sc1
  s_add_u32 s51, s51, 98304
tch_209:
  s_cmp_ge_u32 s51, 6291456
  s_cbranch_scc1 tch_210
  s_add_u32 s21, s51, 6291456
  buffer_store_dwordx4 v[244:247], v4, s[84:87], s51 offen offset:0 sc1
  buffer_store_dwordx4 v[244:247], v4, s[84:87], s21 offen offset:0 sc1
  buffer_store_dwordx4 v[244:247], v4, s[84:87], s51 offen offset:1024 sc1
  buffer_store_dwordx4 v[244:247], v4, s[84:87], s21 offen offset:1024 sc1
  buffer_store_dwordx4 v[244:247], v4, s[84:87], s51 offen offset:2048 sc1
  buffer_store_dwordx4 v[244:247], v4, s[84:87], s21 offen offset:2048 sc1
  s_add_u32 s51, s51, 98304
tch_210:
  s_cmp_ge_u32 s51, 6291456
  s_cbranch_scc1 tch_211
  s_add_u32 s21, s51, 6291456
  buffer_store_dwordx4 v[244:247], v4, s[84:87], s51 offen offset:0 sc1
  buffer_store_dwordx4 v[244:247], v4, s[84:87], s21 offen offset:0 sc1
  buffer_store_dwordx4 v[244:247], v4, s[84:87], s51 offen offset:1024 sc1
  buffer_store_dwordx4 v[244:247], v4, s[84:87], s21 offen offset:1024 sc1
  buffer_store_dwordx4 v[244:247], v4, s[84:87], s51 offen offset:2048 sc1
  buffer_store_dwordx4 v[244:247], v4, s[84:87], s21 offen offset:2048 sc1
  s_add_u32 s51, s51, 98304
tch_211:
  s_cmp_lg_u32 s20, 0
  s_cbranch_scc1 wf_213
  v_mov_b32 v8, 0
  s_mov_b32 s101, 0
wf_212:
  buffer_load_dword v9, v8, s[72:75], s43 offen sc1
  s_add_u32 s101, s101, 1
  s_cmp_gt_u32 s101, 131072
  s_cbranch_scc1 main_end
  s_waitcnt vmcnt(0)
  v_readfirstlane_b32 s100, v9
  s_cmp_ge_u32 s100, 8
  s_cbranch_scc1 wf_213
  s_sleep 6
  s_branch wf_212
wf_213:
  s_barrier
  s_add_u32 s21, s41, 0
  buffer_load_dwordx4 v[144:147], v4, s[16:19], s21 offen offset:0 sc1
  buffer_load_dwordx4 v[148:151], v4, s[16:19], s21 offen offset:1024 sc1
  buffer_load_dwordx4 v[152:155], v4, s[16:19], s21 offen offset:2048 sc1
  buffer_load_dwordx4 v[156:159], v4, s[16:19], s21 offen offset:3072 sc1
  s_add_u32 s21, s41, 4096
  buffer_load_dwordx4 v[160:163], v4, s[16:19], s21 offen offset:0 sc1
  buffer_load_dwordx4 v[164:167], v4, s[16:19], s21 offen offset:1024 sc1
  buffer_load_dwordx4 v[168:171], v4, s[16:19], s21 offen offset:2048 sc1
  buffer_load_dwordx4 v[172:175], v4, s[16:19], s21 offen offset:3072 sc1
  s_add_u32 s21, s41, 8192
  buffer_load_dwordx4 v[176:179], v4, s[16:19], s21 offen offset:0 sc1
  buffer_load_dwordx4 v[180:183], v4, s[16:19], s21 offen offset:1024 sc1
  buffer_load_dwordx4 v[184:187], v4, s[16:19], s21 offen offset:2048 sc1
  buffer_load_dwordx4 v[188:191], v4, s[16:19], s21 offen offset:3072 sc1
  s_add_u32 s41, s41, 393216
  v_mov_b32 v9, 0
  s_waitcnt vmcnt(0)
vwl_214:
  s_add_u32 s46, s45, 1
  s_cmp_ge_u32 s46, 64
  s_cbranch_scc1 vwn_216
  s_cmp_lt_u32 s46, 8
  s_cselect_b32 s21, 1, 3
  s_and_b32 s21, s46, s21
  s_cmp_lg_u32 s21, 0
  s_cbranch_scc1 vwn_215
  s_add_u32 s43, s43, 1024
  v_readfirstlane_b32 s21, v9
  v_mov_b32 v9, 0
  s_cmp_lt_u32 s21, 8
  s_cselect_b32 s50, 1, 0
  s_cbranch_scc1 vwn_216
vwn_215:
  s_add_u32 s21, s41, 0
  buffer_load_dwordx4 v[192:195], v4, s[16:19], s21 offen offset:0 sc1
  buffer_load_dwordx4 v[196:199], v4, s[16:19], s21 offen offset:1024 sc1
  buffer_load_dwordx4 v[200:203], v4, s[16:19], s21 offen offset:2048 sc1
  buffer_load_dwordx4 v[204:207], v4, s[16:19], s21 offen offset:3072 sc1
  s_add_u32 s21, s41, 4096
  buffer_load_dwordx4 v[208:211], v4, s[16:19], s21 offen offset:0 sc1
  buffer_load_dwordx4 v[212:215], v4, s[16:19], s21 offen offset:1024 sc1
  buffer_load_dwordx4 v[216:219], v4, s[16:19], s21 offen offset:2048 sc1
  buffer_load_dwordx4 v[220:223], v4, s[16:19], s21 offen offset:3072 sc1
  s_add_u32 s21, s41, 8192
  buffer_load_dwordx4 v[224:227], v4, s[16:19], s21 offen offset:0 sc1
  buffer_load_dwordx4 v[228:231], v4, s[16:19], s21 offen offset:1024 sc1
  buffer_load_dwordx4 v[232:235], v4, s[16:19], s21 offen offset:2048 sc1
  buffer_load_dwordx4 v[236:239], v4, s[16:19], s21 offen offset:3072 sc1
  s_add_u32 s41, s41, 393216
vwn_216:
  v_readlane_b32 s56, v19, 0
  v_readlane_b32 s21, v19, 1
  v_readlane_b32 s22, v19, 2
  v_readlane_b32 s23, v19, 3
  s_min_u32 s56, s56, s21
  s_min_u32 s22, s22, s23
  s_min_u32 s56, s56, s22
  s_min_u32 s56, s56, 64
  s_add_u32 s21, s55, 2
  s_add_u32 s22, s56, 64
  s_cmp_le_u32 s22, s45
  s_cselect_b32 s21, s21, 99
  s_cmp_le_u32 s21, s56
  s_cselect_b32 s49, 1, 0
  s_cbranch_scc0 vwn_217
  s_sub_u32 s21, s56, s55
  s_cmp_ge_u32 s21, 2
  s_cselect_b64 vcc, -1, 0
  s_cselect_b32 s54, 2, 1
  v_cndmask_b32 v18, v13, v14, vcc
  s_lshl_b32 s21, s55, 5
  s_add_u32 s21, s21, s2
  s_mul_i32 s62, s21, 3072
  s_mul_i32 s63, s21, 10240
  s_mul_i32 s22, s20, 2560
  s_add_u32 s63, s63, s22
  buffer_load_dwordx4 a[240:243], v18, s[76:79], s62 offen offset:0 sc1
  buffer_load_dwordx4 a[244:247], v18, s[76:79], s62 offen offset:512 sc1
  buffer_load_dwordx4 a[248:251], v18, s[76:79], s62 offen offset:1024 sc1
  buffer_load_dwordx4 a[252:255], v18, s[76:79], s62 offen offset:1536 sc1
  buffer_load_dwordx4 v[248:251], v18, s[76:79], s62 offen offset:2048 sc1
  buffer_load_dwordx4 v[252:255], v18, s[76:79], s62 offen offset:2560 sc1
vwn_217:
  s_cmp_lg_u32 s45, 62
  s_cbranch_scc1 vwp_218
  s_mov_b32 s21, 84
  v_mov_b32 v7, 0
  s_mov_b32 s101, 0
wf_219:
  buffer_load_dword v8, v7, s[32:35], s21 offen sc1
  s_add_u32 s101, s101, 1
  s_cmp_gt_u32 s101, 131072
  s_cbranch_scc1 main_end
  s_waitcnt vmcnt(0)
  v_readfirstlane_b32 s100, v8
  s_cmp_ge_u32 s100, 1
  s_cbranch_scc1 wf_220
  s_sleep 8
  s_branch wf_219
wf_220:
  s_mov_b32 s65, s100
  s_add_u32 s66, s38, 83886079
  s_lshr_b32 s66, s66, 21
  s_xor_b32 s67, s66, s65
  s_xor_b32 s67, s67, 0
  s_and_b32 s67, s67, 1
  s_lshl_b32 s67, s67, 13
  s_add_u32 s66, s38, 198180864
vwp_218:
  s_sub_u32 s21, s45, 64
  s_mul_i32 s21, s21, 160
  s_add_u32 s21, s21, s47
  s_lshl_b32 s21, s21, 14
  s_add_u32 s42, s21, s66
  s_lshr_b32 s22, s42, 8
  s_xor_b32 s42, s42, s22
  s_xor_b32 s42, s42, s67
  s_and_b32 s42, s42, 8192
  s_add_u32 s42, s42, s21
  s_add_u32 s42, s42, 83886080
  s_mul_i32 s21, s45, 160
  s_add_u32 s21, s21, s47
  s_lshl_b32 s21, s21, 13
  s_cmp_lt_u32 s45, 64
  s_cselect_b32 s42, s21, s42
  s_add_u32 s65, s47, 1
  s_sub_u32 s21, s45, 64
  s_mul_i32 s21, s21, 160
  s_add_u32 s21, s21, s65
  s_lshl_b32 s21, s21, 14
  s_add_u32 s64, s21, s66
  s_lshr_b32 s22, s64, 8
  s_xor_b32 s64, s64, s22
  s_xor_b32 s64, s64, s67
  s_and_b32 s64, s64, 8192
  s_add_u32 s64, s64, s21
  s_add_u32 s64, s64, 83886080
  s_mul_i32 s21, s45, 160
  s_add_u32 s21, s21, s65
  s_lshl_b32 s21, s21, 13
  s_cmp_lt_u32 s45, 64
  s_cselect_b32 s64, s21, s64
  s_lshl_b32 s21, s48, 10
  s_add_u32 s42, s42, s21
  s_add_u32 s64, s64, s21
  s_sub_u32 s64, s64, 8192
  s_cmp_ge_u32 s51, 6291456
  s_cbranch_scc1 tch_221
  s_add_u32 s21, s51, 6291456
  buffer_store_dwordx4 v[244:247], v4, s[84:87], s51 offen offset:0 sc1
  buffer_store_dwordx4 v[244:247], v4, s[84:87], s21 offen offset:0 sc1
  buffer_store_dwordx4 v[244:247], v4, s[84:87], s51 offen offset:1024 sc1
  buffer_store_dwordx4 v[244:247], v4, s[84:87], s21 offen offset:1024 sc1
  buffer_store_dwordx4 v[244:247], v4, s[84:87], s51 offen offset:2048 sc1
  buffer_store_dwordx4 v[244:247], v4, s[84:87], s21 offen offset:2048 sc1
  s_add_u32 s51, s51, 98304
tch_221:
  s_cmp_lg_u32 s45, 24
  s_cbranch_scc1 arm_222
  s_mul_i32 s21, s2, 10240
  s_mul_i32 s22, s20, 2560
  s_add_u32 s21, s21, s22
  s_add_u32 s21, s21, 18350080
  buffer_store_dwordx4 v[244:247], v15, s[80:83], s21 offen offset:0 sc1
  buffer_store_dwordx4 v[244:247], v15, s[80:83], s21 offen offset:512 sc1
  buffer_store_dwordx4 v[244:247], v15, s[80:83], s21 offen offset:1024 sc1
  buffer_store_dwordx4 v[244:247], v15, s[80:83], s21 offen offset:1536 sc1
  buffer_store_dwordx4 v[244:247], v15, s[80:83], s21 offen offset:2048 sc1
  s_add_u32 s21, s21, 655360
  buffer_store_dwordx4 v[244:247], v15, s[80:83], s21 offen offset:0 sc1
  buffer_store_dwordx4 v[244:247], v15, s[80:83], s21 offen offset:512 sc1
  buffer_store_dwordx4 v[244:247], v15, s[80:83], s21 offen offset:1024 sc1
  buffer_store_dwordx4 v[244:247], v15, s[80:83], s21 offen offset:1536 sc1
  buffer_store_dwordx4 v[244:247], v15, s[80:83], s21 offen offset:2048 sc1
  s_add_u32 s21, s21, 655360
  buffer_store_dwordx4 v[244:247], v15, s[80:83], s21 offen offset:0 sc1
  buffer_store_dwordx4 v[244:247], v15, s[80:83], s21 offen offset:512 sc1
  buffer_store_dwordx4 v[244:247], v15, s[80:83], s21 offen offset:1024 sc1
  buffer_store_dwordx4 v[244:247], v15, s[80:83], s21 offen offset:1536 sc1
  buffer_store_dwordx4 v[244:247], v15, s[80:83], s21 offen offset:2048 sc1
  s_add_u32 s21, s21, 655360
  buffer_store_dwordx4 v[244:247], v15, s[80:83], s21 offen offset:0 sc1
  buffer_store_dwordx4 v[244:247], v15, s[80:83], s21 offen offset:512 sc1
  buffer_store_dwordx4 v[244:247], v15, s[80:83], s21 offen offset:1024 sc1
  buffer_store_dwordx4 v[244:247], v15, s[80:83], s21 offen offset:1536 sc1
  buffer_store_dwordx4 v[244:247], v15, s[80:83], s21 offen offset:2048 sc1
  s_add_u32 s21, s21, 655360
  s_and_b32 s21, s2, 3
  s_cmp_lg_u32 s21, s20
  s_cbranch_scc1 arm_222
  s_mul_i32 s21, s2, 2560
  s_add_u32 s21, s21, 4587520
  v_lshlrev_b32 v21, 3, v1
  buffer_store_dwordx4 v[244:247], v4, s[88:91], s21 offen sc1
  buffer_store_dwordx4 v[244:247], v4, s[88:91], s21 offen offset:1024 sc1
  buffer_store_dwordx2 v[244:245], v21, s[88:91], s21 offen offset:2048 sc1
  s_add_u32 s21, s21, 81920
  buffer_store_dwordx4 v[244:247], v4, s[88:91], s21 offen sc1
  buffer_store_dwordx4 v[244:247], v4, s[88:91], s21 offen offset:1024 sc1
  buffer_store_dwordx2 v[244:245], v21, s[88:91], s21 offen offset:2048 sc1
  s_add_u32 s21, s21, 81920
  buffer_store_dwordx4 v[244:247], v4, s[88:91], s21 offen sc1
  buffer_store_dwordx4 v[244:247], v4, s[88:91], s21 offen offset:1024 sc1
  buffer_store_dwordx2 v[244:245], v21, s[88:91], s21 offen offset:2048 sc1
  s_add_u32 s21, s21, 81920
  buffer_store_dwordx4 v[244:247], v4, s[88:91], s21 offen sc1
  buffer_store_dwordx4 v[244:247], v4, s[88:91], s21 offen offset:1024 sc1
  buffer_store_dwordx2 v[244:245], v21, s[88:91], s21 offen offset:2048 sc1
  s_add_u32 s21, s21, 81920
  buffer_store_dwordx4 v[244:247], v4, s[88:91], s21 offen sc1
  buffer_store_dwordx4 v[244:247], v4, s[88:91], s21 offen offset:1024 sc1
  buffer_store_dwordx2 v[244:245], v21, s[88:91], s21 offen offset:2048 sc1
  s_add_u32 s21, s21, 81920
  buffer_store_dwordx4 v[244:247], v4, s[88:91], s21 offen sc1
  buffer_store_dwordx4 v[244:247], v4, s[88:91], s21 offen offset:1024 sc1
  buffer_store_dwordx2 v[244:245], v21, s[88:91], s21 offen offset:2048 sc1
  s_add_u32 s21, s21, 81920
  buffer_store_dwordx4 v[244:247], v4, s[88:91], s21 offen sc1
  buffer_store_dwordx4 v[244:247], v4, s[88:91], s21 offen offset:1024 sc1
  buffer_store_dwordx2 v[244:245], v21, s[88:91], s21 offen offset:2048 sc1
  s_add_u32 s21, s21, 81920
  buffer_store_dwordx4 v[244:247], v4, s[88:91], s21 offen sc1
  buffer_store_dwordx4 v[244:247], v4, s[88:91], s21 offen offset:1024 sc1
  buffer_store_dwordx2 v[244:245], v21, s[88:91], s21 offen offset:2048 sc1
  s_add_u32 s21, s21, 81920
arm_222:
  buffer_load_dword v19, v12, s[72:75], s53 offen sc1
  v_mfma_f32_16x16x32_bf16 v[64:67], v[144:147], a[0:3], 0
  v_mfma_f32_16x16x32_bf16 v[72:75], v[144:147], a[24:27], 0
  v_mfma_f32_16x16x32_bf16 v[80:83], v[144:147], a[48:51], 0
  v_mfma_f32_16x16x32_bf16 v[88:91], v[144:147], a[72:75], 0
  v_mfma_f32_16x16x32_bf16 v[96:99], v[144:147], a[96:99], 0
  v_mfma_f32_16x16x32_bf16 v[104:107], v[144:147], a[120:123], 0
  v_mfma_f32_16x16x32_bf16 v[112:115], v[144:147], a[144:147], 0
  v_mfma_f32_16x16x32_bf16 v[120:123], v[144:147], a[168:171], 0
  v_mfma_f32_16x16x32_bf16 v[128:131], v[144:147], a[192:195], 0
  v_mfma_f32_16x16x32_bf16 v[136:139], v[144:147], a[216:219], 0
  v_mfma_f32_16x16x32_bf16 v[68:71], v[168:171], a[0:3], 0
  v_mfma_f32_16x16x32_bf16 v[76:79], v[168:171], a[24:27], 0
  v_mfma_f32_16x16x32_bf16 v[84:87], v[168:171], a[48:51], 0
  v_mfma_f32_16x16x32_bf16 v[92:95], v[168:171], a[72:75], 0
  v_mfma_f32_16x16x32_bf16 v[100:103], v[168:171], a[96:99], 0
  v_mfma_f32_16x16x32_bf16 v[108:111], v[168:171], a[120:123], 0
  v_mfma_f32_16x16x32_bf16 v[116:119], v[168:171], a[144:147], 0
  v_mfma_f32_16x16x32_bf16 v[124:127], v[168:171], a[168:171], 0
  v_mfma_f32_16x16x32_bf16 v[132:135], v[168:171], a[192:195], 0
  v_mfma_f32_16x16x32_bf16 v[140:143], v[168:171], a[216:219], 0
  v_mfma_f32_16x16x32_bf16 v[64:67], v[148:151], a[4:7], v[64:67]
  v_mfma_f32_16x16x32_bf16 v[72:75], v[148:151], a[28:31], v[72:75]
  v_mfma_f32_16x16x32_bf16 v[80:83], v[148:151], a[52:55], v[80:83]
  v_mfma_f32_16x16x32_bf16 v[88:91], v[148:151], a[76:79], v[88:91]
  v_mfma_f32_16x16x32_bf16 v[96:99], v[148:151], a[100:103], v[96:99]
  v_mfma_f32_16x16x32_bf16 v[104:107], v[148:151], a[124:127], v[104:107]
  v_mfma_f32_16x16x32_bf16 v[112:115], v[148:151], a[148:151], v[112:115]
  v_mfma_f32_16x16x32_bf16 v[120:123], v[148:151], a[172:175], v[120:123]
  v_mfma_f32_16x16x32_bf16 v[128:131], v[148:151], a[196:199], v[128:131]
  v_mfma_f32_16x16x32_bf16 v[136:139], v[148:151], a[220:223], v[136:139]
  v_mfma_f32_16x16x32_bf16 v[68:71], v[172:175], a[4:7], v[68:71]
  v_mfma_f32_16x16x32_bf16 v[76:79], v[172:175], a[28:31], v[76:79]
  v_mfma_f32_16x16x32_bf16 v[84:87], v[172:175], a[52:55], v[84:87]
  v_mfma_f32_16x16x32_bf16 v[92:95], v[172:175], a[76:79], v[92:95]
  v_mfma_f32_16x16x32_bf16 v[100:103], v[172:175], a[100:103], v[100:103]
  v_mfma_f32_16x16x32_bf16 v[108:111], v[172:175], a[124:127], v[108:111]
  v_mfma_f32_16x16x32_bf16 v[116:119], v[172:175], a[148:151], v[116:119]
  v_mfma_f32_16x16x32_bf16 v[124:127], v[172:175], a[172:175], v[124:127]
  v_mfma_f32_16x16x32_bf16 v[132:135], v[172:175], a[196:199], v[132:135]
  v_mfma_f32_16x16x32_bf16 v[140:143], v[172:175], a[220:223], v[140:143]
  v_mfma_f32_16x16x32_bf16 v[64:67], v[152:155], a[8:11], v[64:67]
  v_mfma_f32_16x16x32_bf16 v[72:75], v[152:155], a[32:35], v[72:75]
  v_mfma_f32_16x16x32_bf16 v[80:83], v[152:155], a[56:59], v[80:83]
  v_mfma_f32_16x16x32_bf16 v[88:91], v[152:155], a[80:83], v[88:91]
  v_mfma_f32_16x16x32_bf16 v[96:99], v[152:155], a[104:107], v[96:99]
  v_mfma_f32_16x16x32_bf16 v[104:107], v[152:155], a[128:131], v[104:107]
  v_mfma_f32_16x16x32_bf16 v[112:115], v[152:155], a[152:155], v[112:115]
  v_mfma_f32_16x16x32_bf16 v[120:123], v[152:155], a[176:179], v[120:123]
  v_mfma_f32_16x16x32_bf16 v[128:131], v[152:155], a[200:203], v[128:131]
  v_mfma_f32_16x16x32_bf16 v[136:139], v[152:155], a[224:227], v[136:139]
  v_mfma_f32_16x16x32_bf16 v[68:71], v[176:179], a[8:11], v[68:71]
  v_mfma_f32_16x16x32_bf16 v[76:79], v[176:179], a[32:35], v[76:79]
  v_mfma_f32_16x16x32_bf16 v[84:87], v[176:179], a[56:59], v[84:87]
  v_mfma_f32_16x16x32_bf16 v[92:95], v[176:179], a[80:83], v[92:95]
  v_mfma_f32_16x16x32_bf16 v[100:103], v[176:179], a[104:107], v[100:103]
  v_mfma_f32_16x16x32_bf16 v[108:111], v[176:179], a[128:131], v[108:111]
  v_mfma_f32_16x16x32_bf16 v[116:119], v[176:179], a[152:155], v[116:119]
  v_mfma_f32_16x16x32_bf16 v[124:127], v[176:179], a[176:179], v[124:127]
  v_mfma_f32_16x16x32_bf16 v[132:135], v[176:179], a[200:203], v[132:135]
  v_mfma_f32_16x16x32_bf16 v[140:143], v[176:179], a[224:227], v[140:143]
  s_add_u32 s21, s43, 1024
  buffer_load_dword v9, v10, s[72:75], s21 offen sc1
  v_mfma_f32_16x16x32_bf16 v[64:67], v[156:159], a[12:15], v[64:67]
  v_mfma_f32_16x16x32_bf16 v[72:75], v[156:159], a[36:39], v[72:75]
  v_mfma_f32_16x16x32_bf16 v[80:83], v[156:159], a[60:63], v[80:83]
  v_mfma_f32_16x16x32_bf16 v[88:91], v[156:159], a[84:87], v[88:91]
  v_mfma_f32_16x16x32_bf16 v[96:99], v[156:159], a[108:111], v[96:99]
  v_mfma_f32_16x16x32_bf16 v[104:107], v[156:159], a[132:135], v[104:107]
  v_mfma_f32_16x16x32_bf16 v[112:115], v[156:159], a[156:159], v[112:115]
  v_mfma_f32_16x16x32_bf16 v[120:123], v[156:159], a[180:183], v[120:123]
  v_mfma_f32_16x16x32_bf16 v[128:131], v[156:159], a[204:207], v[128:131]
  v_mfma_f32_16x16x32_bf16 v[136:139], v[156:159], a[228:231], v[136:139]
  v_mfma_f32_16x16x32_bf16 v[68:71], v[180:183], a[12:15], v[68:71]
  v_mfma_f32_16x16x32_bf16 v[76:79], v[180:183], a[36:39], v[76:79]
  v_mfma_f32_16x16x32_bf16 v[84:87], v[180:183], a[60:63], v[84:87]
  v_mfma_f32_16x16x32_bf16 v[92:95], v[180:183], a[84:87], v[92:95]
  v_mfma_f32_16x16x32_bf16 v[100:103], v[180:183], a[108:111], v[100:103]
  v_mfma_f32_16x16x32_bf16 v[108:111], v[180:183], a[132:135], v[108:111]
  v_mfma_f32_16x16x32_bf16 v[116:119], v[180:183], a[156:159], v[116:119]
  v_mfma_f32_16x16x32_bf16 v[124:127], v[180:183], a[180:183], v[124:127]
  v_mfma_f32_16x16x32_bf16 v[132:135], v[180:183], a[204:207], v[132:135]
  v_mfma_f32_16x16x32_bf16 v[140:143], v[180:183], a[228:231], v[140:143]
  v_mfma_f32_16x16x32_bf16 v[64:67], v[160:163], a[16:19], v[64:67]
  v_mfma_f32_16x16x32_bf16 v[72:75], v[160:163], a[40:43], v[72:75]
  v_mfma_f32_16x16x32_bf16 v[80:83], v[160:163], a[64:67], v[80:83]
  v_mfma_f32_16x16x32_bf16 v[88:91], v[160:163], a[88:91], v[88:91]
  v_mfma_f32_16x16x32_bf16 v[96:99], v[160:163], a[112:115], v[96:99]
  v_mfma_f32_16x16x32_bf16 v[104:107], v[160:163], a[136:139], v[104:107]
  v_mfma_f32_16x16x32_bf16 v[112:115], v[160:163], a[160:163], v[112:115]
  v_mfma_f32_16x16x32_bf16 v[120:123], v[160:163], a[184:187], v[120:123]
  v_mfma_f32_16x16x32_bf16 v[128:131], v[160:163], a[208:211], v[128:131]
  v_mfma_f32_16x16x32_bf16 v[136:139], v[160:163], a[232:235], v[136:139]
  v_mfma_f32_16x16x32_bf16 v[68:71], v[184:187], a[16:19], v[68:71]
  v_mfma_f32_16x16x32_bf16 v[76:79], v[184:187], a[40:43], v[76:79]
  v_mfma_f32_16x16x32_bf16 v[84:87], v[184:187], a[64:67], v[84:87]
  v_mfma_f32_16x16x32_bf16 v[92:95], v[184:187], a[88:91], v[92:95]
  v_mfma_f32_16x16x32_bf16 v[100:103], v[184:187], a[112:115], v[100:103]
  v_mfma_f32_16x16x32_bf16 v[108:111], v[184:187], a[136:139], v[108:111]
  v_mfma_f32_16x16x32_bf16 v[116:119], v[184:187], a[160:163], v[116:119]
  v_mfma_f32_16x16x32_bf16 v[124:127], v[184:187], a[184:187], v[124:127]
  v_mfma_f32_16x16x32_bf16 v[132:135], v[184:187], a[208:211], v[132:135]
  v_mfma_f32_16x16x32_bf16 v[140:143], v[184:187], a[232:235], v[140:143]
  v_mfma_f32_16x16x32_bf16 v[64:67], v[164:167], a[20:23], v[64:67]
  v_mfma_f32_16x16x32_bf16 v[72:75], v[164:167], a[44:47], v[72:75]
  v_mfma_f32_16x16x32_bf16 v[80:83], v[164:167], a[68:71], v[80:83]
  v_mfma_f32_16x16x32_bf16 v[88:91], v[164:167], a[92:95], v[88:91]
  v_mfma_f32_16x16x32_bf16 v[96:99], v[164:167], a[116:119], v[96:99]
  v_mfma_f32_16x16x32_bf16 v[104:107], v[164:167], a[140:143], v[104:107]
  v_mfma_f32_16x16x32_bf16 v[112:115], v[164:167], a[164:167], v[112:115]
  v_mfma_f32_16x16x32_bf16 v[120:123], v[164:167], a[188:191], v[120:123]
  v_mfma_f32_16x16x32_bf16 v[128:131], v[164:167], a[212:215], v[128:131]
  v_mfma_f32_16x16x32_bf16 v[136:139], v[164:167], a[236:239], v[136:139]
  v_mfma_f32_16x16x32_bf16 v[68:71], v[188:191], a[20:23], v[68:71]
  v_mfma_f32_16x16x32_bf16 v[76:79], v[188:191], a[44:47], v[76:79]
  v_mfma_f32_16x16x32_bf16 v[84:87], v[188:191], a[68:71], v[84:87]
  v_mfma_f32_16x16x32_bf16 v[92:95], v[188:191], a[92:95], v[92:95]
  v_mfma_f32_16x16x32_bf16 v[100:103], v[188:191], a[116:119], v[100:103]
  v_mfma_f32_16x16x32_bf16 v[108:111], v[188:191], a[140:143], v[108:111]
  v_mfma_f32_16x16x32_bf16 v[116:119], v[188:191], a[164:167], v[116:119]
  v_mfma_f32_16x16x32_bf16 v[124:127], v[188:191], a[188:191], v[124:127]
  v_mfma_f32_16x16x32_bf16 v[132:135], v[188:191], a[212:215], v[132:135]
  v_mfma_f32_16x16x32_bf16 v[140:143], v[188:191], a[236:239], v[140:143]
  s_waitcnt vmcnt(0)
  s_mov_b64 exec, 1
  v_mov_b32 v20, s45
  buffer_store_dword v20, v10, s[72:75], s44 offen sc1

  s_mov_b64 exec, -1
  s_cmp_eq_u32 s58, 0
  s_cbranch_scc1 uf_224
  s_mov_b64 exec, s[58:59]
  buffer_atomic_add v11, v17, s[72:75], s57 offen sc1
  s_mov_b64 exec, -1
  s_mov_b32 s58, 0
uf_224:
  v_cvt_pk_bf16_f32 v24, v64, v65
  v_cvt_pk_bf16_f32 v25, v66, v67
  v_cvt_pk_bf16_f32 v26, v68, v69
  v_cvt_pk_bf16_f32 v27, v70, v71
  s_cmp_lt_u32 s48, 8
  s_cselect_b32 s21, s42, s64
  buffer_store_dwordx4 v[24:27], v4, s[24:27], s21 offen offset:0 sc1
  v_cvt_pk_bf16_f32 v28, v72, v73
  v_cvt_pk_bf16_f32 v29, v74, v75
  v_cvt_pk_bf16_f32 v30, v76, v77
  v_cvt_pk_bf16_f32 v31, v78, v79
  s_cmp_lt_u32 s48, 7
  s_cselect_b32 s21, s42, s64
  buffer_store_dwordx4 v[28:31], v4, s[24:27], s21 offen offset:1024 sc1
  v_cvt_pk_bf16_f32 v32, v80, v81
  v_cvt_pk_bf16_f32 v33, v82, v83
  v_cvt_pk_bf16_f32 v34, v84, v85
  v_cvt_pk_bf16_f32 v35, v86, v87
  s_cmp_lt_u32 s48, 6
  s_cselect_b32 s21, s42, s64
  buffer_store_dwordx4 v[32:35], v4, s[24:27], s21 offen offset:2048 sc1
  v_cvt_pk_bf16_f32 v36, v88, v89
  v_cvt_pk_bf16_f32 v37, v90, v91
  v_cvt_pk_bf16_f32 v38, v92, v93
  v_cvt_pk_bf16_f32 v39, v94, v95
  s_cmp_lt_u32 s48, 5
  s_cselect_b32 s21, s42, s64
  buffer_store_dwordx4 v[36:39], v4, s[24:27], s21 offen offset:3072 sc1
  v_cvt_pk_bf16_f32 v40, v96, v97
  v_cvt_pk_bf16_f32 v41, v98, v99
  v_cvt_pk_bf16_f32 v42, v100, v101
  v_cvt_pk_bf16_f32 v43, v102, v103
  s_cmp_lt_u32 s48, 4
  s_cselect_b32 s21, s42, s64
  s_add_u32 s21, s21, 4096
  buffer_store_dwordx4 v[40:43], v4, s[24:27], s21 offen offset:0 sc1
  v_cvt_pk_bf16_f32 v44, v104, v105
  v_cvt_pk_bf16_f32 v45, v106, v107
  v_cvt_pk_bf16_f32 v46, v108, v109
  v_cvt_pk_bf16_f32 v47, v110, v111
  s_cmp_lt_u32 s48, 3
  s_cselect_b32 s21, s42, s64
  s_add_u32 s21, s21, 4096
  buffer_store_dwordx4 v[44:47], v4, s[24:27], s21 offen offset:1024 sc1
  v_cvt_pk_bf16_f32 v48, v112, v113
  v_cvt_pk_bf16_f32 v49, v114, v115
  v_cvt_pk_bf16_f32 v50, v116, v117
  v_cvt_pk_bf16_f32 v51, v118, v119
  s_cmp_lt_u32 s48, 2
  s_cselect_b32 s21, s42, s64
  s_add_u32 s21, s21, 4096
  buffer_store_dwordx4 v[48:51], v4, s[24:27], s21 offen offset:2048 sc1
  v_cvt_pk_bf16_f32 v52, v120, v121
  v_cvt_pk_bf16_f32 v53, v122, v123
  v_cvt_pk_bf16_f32 v54, v124, v125
  v_cvt_pk_bf16_f32 v55, v126, v127
  s_cmp_lt_u32 s48, 1
  s_cselect_b32 s21, s42, s64
  s_add_u32 s21, s21, 4096
  buffer_store_dwordx4 v[52:55], v4, s[24:27], s21 offen offset:3072 sc1
  v_cvt_pk_bf16_f32 v56, v128, v129
  v_cvt_pk_bf16_f32 v57, v130, v131
  v_cvt_pk_bf16_f32 v58, v132, v133
  v_cvt_pk_bf16_f32 v59, v134, v135
  s_cmp_lt_u32 s48, 0
  s_cselect_b32 s21, s42, s64
  s_add_u32 s21, s21, 8192
  buffer_store_dwordx4 v[56:59], v4, s[24:27], s21 offen offset:0 sc1
  v_cvt_pk_bf16_f32 v60, v136, v137
  v_cvt_pk_bf16_f32 v61, v138, v139
  v_cvt_pk_bf16_f32 v62, v140, v141
  v_cvt_pk_bf16_f32 v63, v142, v143
  s_cmp_lt_u32 s48, 0
  s_cselect_b32 s21, s42, s64
  s_add_u32 s21, s21, 8192
  buffer_store_dwordx4 v[60:63], v4, s[24:27], s21 offen offset:1024 sc1
  s_add_u32 s45, s45, 1
  s_cmp_eq_u32 s49, 0
  s_cbranch_scc1 vwu_225
  v_mfma_f32_16x16x32_bf16 v[64:67], a[240:243], a[0:3], 0
  v_mfma_f32_16x16x32_bf16 v[68:71], a[240:243], a[24:27], 0
  v_mfma_f32_16x16x32_bf16 v[72:75], a[240:243], a[48:51], 0
  v_mfma_f32_16x16x32_bf16 v[76:79], a[240:243], a[72:75], 0
  v_mfma_f32_16x16x32_bf16 v[80:83], a[240:243], a[96:99], 0
  v_mfma_f32_16x16x32_bf16 v[84:87], a[240:243], a[120:123], 0
  v_mfma_f32_16x16x32_bf16 v[88:91], a[240:243], a[144:147], 0
  v_mfma_f32_16x16x32_bf16 v[92:95], a[240:243], a[168:171], 0
  v_mfma_f32_16x16x32_bf16 v[96:99], a[240:243], a[192:195], 0
  v_mfma_f32_16x16x32_bf16 v[100:103], a[240:243], a[216:219], 0
  v_mfma_f32_16x16x32_bf16 v[64:67], a[244:247], a[4:7], v[64:67]
  v_mfma_f32_16x16x32_bf16 v[68:71], a[244:247], a[28:31], v[68:71]
  v_mfma_f32_16x16x32_bf16 v[72:75], a[244:247], a[52:55], v[72:75]
  v_mfma_f32_16x16x32_bf16 v[76:79], a[244:247], a[76:79], v[76:79]
  v_mfma_f32_16x16x32_bf16 v[80:83], a[244:247], a[100:103], v[80:83]
  v_mfma_f32_16x16x32_bf16 v[84:87], a[244:247], a[124:127], v[84:87]
  v_mfma_f32_16x16x32_bf16 v[88:91], a[244:247], a[148:151], v[88:91]
  v_mfma_f32_16x16x32_bf16 v[92:95], a[244:247], a[172:175], v[92:95]
  v_mfma_f32_16x16x32_bf16 v[96:99], a[244:247], a[196:199], v[96:99]
  v_mfma_f32_16x16x32_bf16 v[100:103], a[244:247], a[220:223], v[100:103]
  v_mfma_f32_16x16x32_bf16 v[64:67], a[248:251], a[8:11], v[64:67]
  v_mfma_f32_16x16x32_bf16 v[68:71], a[248:251], a[32:35], v[68:71]
  v_mfma_f32_16x16x32_bf16 v[72:75], a[248:251], a[56:59], v[72:75]
  v_mfma_f32_16x16x32_bf16 v[76:79], a[248:251], a[80:83], v[76:79]
  v_mfma_f32_16x16x32_bf16 v[80:83], a[248:251], a[104:107], v[80:83]
  v_mfma_f32_16x16x32_bf16 v[84:87], a[248:251], a[128:131], v[84:87]
  v_mfma_f32_16x16x32_bf16 v[88:91], a[248:251], a[152:155], v[88:91]
  v_mfma_f32_16x16x32_bf16 v[92:95], a[248:251], a[176:179], v[92:95]
  v_mfma_f32_16x16x32_bf16 v[96:99], a[248:251], a[200:203], v[96:99]
  v_mfma_f32_16x16x32_bf16 v[100:103], a[248:251], a[224:227], v[100:103]
  v_mfma_f32_16x16x32_bf16 v[64:67], a[252:255], a[12:15], v[64:67]
  v_mfma_f32_16x16x32_bf16 v[68:71], a[252:255], a[36:39], v[68:71]
  v_mfma_f32_16x16x32_bf16 v[72:75], a[252:255], a[60:63], v[72:75]
  v_mfma_f32_16x16x32_bf16 v[76:79], a[252:255], a[84:87], v[76:79]
  v_mfma_f32_16x16x32_bf16 v[80:83], a[252:255], a[108:111], v[80:83]
  v_mfma_f32_16x16x32_bf16 v[84:87], a[252:255], a[132:135], v[84:87]
  v_mfma_f32_16x16x32_bf16 v[88:91], a[252:255], a[156:159], v[88:91]
  v_mfma_f32_16x16x32_bf16 v[92:95], a[252:255], a[180:183], v[92:95]
  v_mfma_f32_16x16x32_bf16 v[96:99], a[252:255], a[204:207], v[96:99]
  v_mfma_f32_16x16x32_bf16 v[100:103], a[252:255], a[228:231], v[100:103]
  v_mfma_f32_16x16x32_bf16 v[64:67], v[248:251], a[16:19], v[64:67]
  v_mfma_f32_16x16x32_bf16 v[68:71], v[248:251], a[40:43], v[68:71]
  v_mfma_f32_16x16x32_bf16 v[72:75], v[248:251], a[64:67], v[72:75]
  v_mfma_f32_16x16x32_bf16 v[76:79], v[248:251], a[88:91], v[76:79]
  v_mfma_f32_16x16x32_bf16 v[80:83], v[248:251], a[112:115], v[80:83]
  v_mfma_f32_16x16x32_bf16 v[84:87], v[248:251], a[136:139], v[84:87]
  v_mfma_f32_16x16x32_bf16 v[88:91], v[248:251], a[160:163], v[88:91]
  v_mfma_f32_16x16x32_bf16 v[92:95], v[248:251], a[184:187], v[92:95]
  v_mfma_f32_16x16x32_bf16 v[96:99], v[248:251], a[208:211], v[96:99]
  v_mfma_f32_16x16x32_bf16 v[100:103], v[248:251], a[232:235], v[100:103]
  v_mfma_f32_16x16x32_bf16 v[64:67], v[252:255], a[20:23], v[64:67]
  v_mfma_f32_16x16x32_bf16 v[68:71], v[252:255], a[44:47], v[68:71]
  v_mfma_f32_16x16x32_bf16 v[72:75], v[252:255], a[68:71], v[72:75]
  v_mfma_f32_16x16x32_bf16 v[76:79], v[252:255], a[92:95], v[76:79]
  v_mfma_f32_16x16x32_bf16 v[80:83], v[252:255], a[116:119], v[80:83]
  v_mfma_f32_16x16x32_bf16 v[84:87], v[252:255], a[140:143], v[84:87]
  v_mfma_f32_16x16x32_bf16 v[88:91], v[252:255], a[164:167], v[88:91]
  v_mfma_f32_16x16x32_bf16 v[92:95], v[252:255], a[188:191], v[92:95]
  v_mfma_f32_16x16x32_bf16 v[96:99], v[252:255], a[212:215], v[96:99]
  v_mfma_f32_16x16x32_bf16 v[100:103], v[252:255], a[236:239], v[100:103]
  s_cmp_eq_u32 s54, 2
  s_cselect_b32 s61, -1, 0
  s_mov_b32 s60, -1
  s_cselect_b32 s58, 3, 1
  s_lshl_b32 s57, s55, 3
  s_and_b32 s21, s2, 7
  s_add_u32 s57, s57, s21
  s_lshl_b32 s57, s57, 7
  s_add_u32 s57, s57, 22528
  s_add_u32 s55, s55, s54
  v_cvt_pk_bf16_f32 v48, v64, v65
  v_cvt_pk_bf16_f32 v49, v66, v67
  v_cvt_pk_bf16_f32 v50, v68, v69
  v_cvt_pk_bf16_f32 v51, v70, v71
  v_cvt_pk_bf16_f32 v52, v72, v73
  v_cvt_pk_bf16_f32 v53, v74, v75
  v_cvt_pk_bf16_f32 v54, v76, v77
  v_cvt_pk_bf16_f32 v55, v78, v79
  v_cvt_pk_bf16_f32 v56, v80, v81
  v_cvt_pk_bf16_f32 v57, v82, v83
  v_cvt_pk_bf16_f32 v58, v84, v85
  v_cvt_pk_bf16_f32 v59, v86, v87
  v_cvt_pk_bf16_f32 v60, v88, v89
  v_cvt_pk_bf16_f32 v61, v90, v91
  v_cvt_pk_bf16_f32 v62, v92, v93
  v_cvt_pk_bf16_f32 v63, v94, v95
  v_cvt_pk_bf16_f32 v240, v96, v97
  v_cvt_pk_bf16_f32 v241, v98, v99
  v_cvt_pk_bf16_f32 v242, v100, v101
  v_cvt_pk_bf16_f32 v243, v102, v103
  v_min_u32 v48, -2, v48
  v_min_u32 v52, -2, v52
  v_min_u32 v56, -2, v56
  v_min_u32 v60, -2, v60
  v_min_u32 v240, -2, v240
  s_mov_b64 exec, s[60:61]
  buffer_store_dwordx4 v[48:51], v15, s[80:83], s63 offen offset:0 sc1
  buffer_store_dwordx4 v[52:55], v15, s[80:83], s63 offen offset:512 sc1
  buffer_store_dwordx4 v[56:59], v15, s[80:83], s63 offen offset:1024 sc1
  buffer_store_dwordx4 v[60:63], v15, s[80:83], s63 offen offset:1536 sc1
  buffer_store_dwordx4 v[240:243], v15, s[80:83], s63 offen offset:2048 sc1
  s_mov_b64 exec, -1
vwu_225:
  s_cmp_eq_u32 s50, 0
  s_cbranch_scc1 vwt_226
  s_waitcnt vmcnt(0)
  s_mov_b64 exec, 1
  v_mov_b32 v20, s45
  buffer_store_dword v20, v10, s[72:75], s44 offen sc1

  s_mov_b64 exec, -1
  s_mov_b32 s50, 0
  s_mov_b32 s70, s45
  s_cmp_eq_u32 s58, 0
  s_cbranch_scc1 uf_227
  s_mov_b64 exec, s[58:59]
  buffer_atomic_add v11, v17, s[72:75], s57 offen sc1
  s_mov_b64 exec, -1
  s_mov_b32 s58, 0
uf_227:
  v_mov_b32 v7, 0
  s_mov_b32 s101, 0
wf_228:
  buffer_load_dword v8, v7, s[72:75], s43 offen sc1
  s_add_u32 s101, s101, 1
  s_cmp_gt_u32 s101, 131072
  s_cbranch_scc1 main_end
  s_waitcnt vmcnt(0)
  v_readfirstlane_b32 s100, v8
  s_cmp_ge_u32 s100, 8
  s_cbranch_scc1 wf_229
  s_sleep 4
  s_branch wf_228
wf_229:
  s_add_u32 s21, s41, 0
  buffer_load_dwordx4 v[192:195], v4, s[16:19], s21 offen offset:0 sc1
  buffer_load_dwordx4 v[196:199], v4, s[16:19], s21 offen offset:1024 sc1
  buffer_load_dwordx4 v[200:203], v4, s[16:19], s21 offen offset:2048 sc1
  buffer_load_dwordx4 v[204:207], v4, s[16:19], s21 offen offset:3072 sc1
  s_add_u32 s21, s41, 4096
  buffer_load_dwordx4 v[208:211], v4, s[16:19], s21 offen offset:0 sc1
  buffer_load_dwordx4 v[212:215], v4, s[16:19], s21 offen offset:1024 sc1
  buffer_load_dwordx4 v[216:219], v4, s[16:19], s21 offen offset:2048 sc1
  buffer_load_dwordx4 v[220:223], v4, s[16:19], s21 offen offset:3072 sc1
  s_add_u32 s21, s41, 8192
  buffer_load_dwordx4 v[224:227], v4, s[16:19], s21 offen offset:0 sc1
  buffer_load_dwordx4 v[228:231], v4, s[16:19], s21 offen offset:1024 sc1
  buffer_load_dwordx4 v[232:235], v4, s[16:19], s21 offen offset:2048 sc1
  buffer_load_dwordx4 v[236:239], v4, s[16:19], s21 offen offset:3072 sc1
  s_add_u32 s41, s41, 393216
  s_waitcnt vmcnt(0)
vwt_226:
  s_add_u32 s46, s45, 1
  s_cmp_ge_u32 s46, 64
  s_cbranch_scc1 vwn_231
  s_cmp_lt_u32 s46, 8
  s_cselect_b32 s21, 1, 3
  s_and_b32 s21, s46, s21
  s_cmp_lg_u32 s21, 0
  s_cbranch_scc1 vwn_230
  s_add_u32 s43, s43, 1024
  v_readfirstlane_b32 s21, v9
  v_mov_b32 v9, 0
  s_cmp_lt_u32 s21, 8
  s_cselect_b32 s50, 1, 0
  s_cbranch_scc1 vwn_231
vwn_230:
  s_add_u32 s21, s41, 0
  buffer_load_dwordx4 v[144:147], v4, s[16:19], s21 offen offset:0 sc1
  buffer_load_dwordx4 v[148:151], v4, s[16:19], s21 offen offset:1024 sc1
  buffer_load_dwordx4 v[152:155], v4, s[16:19], s21 offen offset:2048 sc1
  buffer_load_dwordx4 v[156:159], v4, s[16:19], s21 offen offset:3072 sc1
  s_add_u32 s21, s41, 4096
  buffer_load_dwordx4 v[160:163], v4, s[16:19], s21 offen offset:0 sc1
  buffer_load_dwordx4 v[164:167], v4, s[16:19], s21 offen offset:1024 sc1
  buffer_load_dwordx4 v[168:171], v4, s[16:19], s21 offen offset:2048 sc1
  buffer_load_dwordx4 v[172:175], v4, s[16:19], s21 offen offset:3072 sc1
  s_add_u32 s21, s41, 8192
  buffer_load_dwordx4 v[176:179], v4, s[16:19], s21 offen offset:0 sc1
  buffer_load_dwordx4 v[180:183], v4, s[16:19], s21 offen offset:1024 sc1
  buffer_load_dwordx4 v[184:187], v4, s[16:19], s21 offen offset:2048 sc1
  buffer_load_dwordx4 v[188:191], v4, s[16:19], s21 offen offset:3072 sc1
  s_add_u32 s41, s41, 393216
vwn_231:
  v_readlane_b32 s56, v19, 0
  v_readlane_b32 s21, v19, 1
  v_readlane_b32 s22, v19, 2
  v_readlane_b32 s23, v19, 3
  s_min_u32 s56, s56, s21
  s_min_u32 s22, s22, s23
  s_min_u32 s56, s56, s22
  s_min_u32 s56, s56, 64
  s_add_u32 s21, s55, 2
  s_add_u32 s22, s56, 64
  s_cmp_le_u32 s22, s45
  s_cselect_b32 s21, s21, 99
  s_cmp_le_u32 s21, s56
  s_cselect_b32 s49, 1, 0
  s_cbranch_scc0 vwn_232
  s_sub_u32 s21, s56, s55
  s_cmp_ge_u32 s21, 2
  s_cselect_b64 vcc, -1, 0
  s_cselect_b32 s54, 2, 1
  v_cndmask_b32 v18, v13, v14, vcc
  s_lshl_b32 s21, s55, 5
  s_add_u32 s21, s21, s2
  s_mul_i32 s62, s21, 3072
  s_mul_i32 s63, s21, 10240
  s_mul_i32 s22, s20, 2560
  s_add_u32 s63, s63, s22
  buffer_load_dwordx4 a[240:243], v18, s[76:79], s62 offen offset:0 sc1
  buffer_load_dwordx4 a[244:247], v18, s[76:79], s62 offen offset:512 sc1
  buffer_load_dwordx4 a[248:251], v18, s[76:79], s62 offen offset:1024 sc1
  buffer_load_dwordx4 a[252:255], v18, s[76:79], s62 offen offset:1536 sc1
  buffer_load_dwordx4 v[248:251], v18, s[76:79], s62 offen offset:2048 sc1
  buffer_load_dwordx4 v[252:255], v18, s[76:79], s62 offen offset:2560 sc1
vwn_232:
  s_sub_u32 s21, s45, 64
  s_mul_i32 s21, s21, 160
  s_add_u32 s21, s21, s47
  s_lshl_b32 s21, s21, 14
  s_add_u32 s42, s21, s66
  s_lshr_b32 s22, s42, 8
  s_xor_b32 s42, s42, s22
  s_xor_b32 s42, s42, s67
  s_and_b32 s42, s42, 8192
  s_add_u32 s42, s42, s21
  s_add_u32 s42, s42, 83886080
  s_mul_i32 s21, s45, 160
  s_add_u32 s21, s21, s47
  s_lshl_b32 s21, s21, 13
  s_cmp_lt_u32 s45, 64
  s_cselect_b32 s42, s21, s42
  s_add_u32 s65, s47, 1
  s_sub_u32 s21, s45, 64
  s_mul_i32 s21, s21, 160
  s_add_u32 s21, s21, s65
  s_lshl_b32 s21, s21, 14
  s_add_u32 s64, s21, s66
  s_lshr_b32 s22, s64, 8
  s_xor_b32 s64, s64, s22
  s_xor_b32 s64, s64, s67
  s_and_b32 s64, s64, 8192
  s_add_u32 s64, s64, s21
  s_add_u32 s64, s64, 83886080
  s_mul_i32 s21, s45, 160
  s_add_u32 s21, s21, s65
  s_lshl_b32 s21, s21, 13
  s_cmp_lt_u32 s45, 64
  s_cselect_b32 s64, s21, s64
  s_lshl_b32 s21, s48, 10
  s_add_u32 s42, s42, s21
  s_add_u32 s64, s64, s21
  s_sub_u32 s64, s64, 8192
  s_cmp_ge_u32 s51, 6291456
  s_cbranch_scc1 tch_233
  s_add_u32 s21, s51, 6291456
  buffer_store_dwordx4 v[244:247], v4, s[84:87], s51 offen offset:0 sc1
  buffer_store_dwordx4 v[244:247], v4, s[84:87], s21 offen offset:0 sc1
  buffer_store_dwordx4 v[244:247], v4, s[84:87], s51 offen offset:1024 sc1
  buffer_store_dwordx4 v[244:247], v4, s[84:87], s21 offen offset:1024 sc1
  buffer_store_dwordx4 v[244:247], v4, s[84:87], s51 offen offset:2048 sc1
  buffer_store_dwordx4 v[244:247], v4, s[84:87], s21 offen offset:2048 sc1
  s_add_u32 s51, s51, 98304
tch_233:
  buffer_load_dword v19, v12, s[72:75], s53 offen sc1
  v_mfma_f32_16x16x32_bf16 v[64:67], v[192:195], a[0:3], 0
  v_mfma_f32_16x16x32_bf16 v[72:75], v[192:195], a[24:27], 0
  v_mfma_f32_16x16x32_bf16 v[80:83], v[192:195], a[48:51], 0
  v_mfma_f32_16x16x32_bf16 v[88:91], v[192:195], a[72:75], 0
  v_mfma_f32_16x16x32_bf16 v[96:99], v[192:195], a[96:99], 0
  v_mfma_f32_16x16x32_bf16 v[104:107], v[192:195], a[120:123], 0
  v_mfma_f32_16x16x32_bf16 v[112:115], v[192:195], a[144:147], 0
  v_mfma_f32_16x16x32_bf16 v[120:123], v[192:195], a[168:171], 0
  v_mfma_f32_16x16x32_bf16 v[128:131], v[192:195], a[192:195], 0
  v_mfma_f32_16x16x32_bf16 v[136:139], v[192:195], a[216:219], 0
  v_mfma_f32_16x16x32_bf16 v[68:71], v[216:219], a[0:3], 0
  v_mfma_f32_16x16x32_bf16 v[76:79], v[216:219], a[24:27], 0
  v_mfma_f32_16x16x32_bf16 v[84:87], v[216:219], a[48:51], 0
  v_mfma_f32_16x16x32_bf16 v[92:95], v[216:219], a[72:75], 0
  v_mfma_f32_16x16x32_bf16 v[100:103], v[216:219], a[96:99], 0
  v_mfma_f32_16x16x32_bf16 v[108:111], v[216:219], a[120:123], 0
  v_mfma_f32_16x16x32_bf16 v[116:119], v[216:219], a[144:147], 0
  v_mfma_f32_16x16x32_bf16 v[124:127], v[216:219], a[168:171], 0
  v_mfma_f32_16x16x32_bf16 v[132:135], v[216:219], a[192:195], 0
  v_mfma_f32_16x16x32_bf16 v[140:143], v[216:219], a[216:219], 0
  v_mfma_f32_16x16x32_bf16 v[64:67], v[196:199], a[4:7], v[64:67]
  v_mfma_f32_16x16x32_bf16 v[72:75], v[196:199], a[28:31], v[72:75]
  v_mfma_f32_16x16x32_bf16 v[80:83], v[196:199], a[52:55], v[80:83]
  v_mfma_f32_16x16x32_bf16 v[88:91], v[196:199], a[76:79], v[88:91]
  v_mfma_f32_16x16x32_bf16 v[96:99], v[196:199], a[100:103], v[96:99]
  v_mfma_f32_16x16x32_bf16 v[104:107], v[196:199], a[124:127], v[104:107]
  v_mfma_f32_16x16x32_bf16 v[112:115], v[196:199], a[148:151], v[112:115]
  v_mfma_f32_16x16x32_bf16 v[120:123], v[196:199], a[172:175], v[120:123]
  v_mfma_f32_16x16x32_bf16 v[128:131], v[196:199], a[196:199], v[128:131]
  v_mfma_f32_16x16x32_bf16 v[136:139], v[196:199], a[220:223], v[136:139]
  v_mfma_f32_16x16x32_bf16 v[68:71], v[220:223], a[4:7], v[68:71]
  v_mfma_f32_16x16x32_bf16 v[76:79], v[220:223], a[28:31], v[76:79]
  v_mfma_f32_16x16x32_bf16 v[84:87], v[220:223], a[52:55], v[84:87]
  v_mfma_f32_16x16x32_bf16 v[92:95], v[220:223], a[76:79], v[92:95]
  v_mfma_f32_16x16x32_bf16 v[100:103], v[220:223], a[100:103], v[100:103]
  v_mfma_f32_16x16x32_bf16 v[108:111], v[220:223], a[124:127], v[108:111]
  v_mfma_f32_16x16x32_bf16 v[116:119], v[220:223], a[148:151], v[116:119]
  v_mfma_f32_16x16x32_bf16 v[124:127], v[220:223], a[172:175], v[124:127]
  v_mfma_f32_16x16x32_bf16 v[132:135], v[220:223], a[196:199], v[132:135]
  v_mfma_f32_16x16x32_bf16 v[140:143], v[220:223], a[220:223], v[140:143]
  v_mfma_f32_16x16x32_bf16 v[64:67], v[200:203], a[8:11], v[64:67]
  v_mfma_f32_16x16x32_bf16 v[72:75], v[200:203], a[32:35], v[72:75]
  v_mfma_f32_16x16x32_bf16 v[80:83], v[200:203], a[56:59], v[80:83]
  v_mfma_f32_16x16x32_bf16 v[88:91], v[200:203], a[80:83], v[88:91]
  v_mfma_f32_16x16x32_bf16 v[96:99], v[200:203], a[104:107], v[96:99]
  v_mfma_f32_16x16x32_bf16 v[104:107], v[200:203], a[128:131], v[104:107]
  v_mfma_f32_16x16x32_bf16 v[112:115], v[200:203], a[152:155], v[112:115]
  v_mfma_f32_16x16x32_bf16 v[120:123], v[200:203], a[176:179], v[120:123]
  v_mfma_f32_16x16x32_bf16 v[128:131], v[200:203], a[200:203], v[128:131]
  v_mfma_f32_16x16x32_bf16 v[136:139], v[200:203], a[224:227], v[136:139]
  v_mfma_f32_16x16x32_bf16 v[68:71], v[224:227], a[8:11], v[68:71]
  v_mfma_f32_16x16x32_bf16 v[76:79], v[224:227], a[32:35], v[76:79]
  v_mfma_f32_16x16x32_bf16 v[84:87], v[224:227], a[56:59], v[84:87]
  v_mfma_f32_16x16x32_bf16 v[92:95], v[224:227], a[80:83], v[92:95]
  v_mfma_f32_16x16x32_bf16 v[100:103], v[224:227], a[104:107], v[100:103]
  v_mfma_f32_16x16x32_bf16 v[108:111], v[224:227], a[128:131], v[108:111]
  v_mfma_f32_16x16x32_bf16 v[116:119], v[224:227], a[152:155], v[116:119]
  v_mfma_f32_16x16x32_bf16 v[124:127], v[224:227], a[176:179], v[124:127]
  v_mfma_f32_16x16x32_bf16 v[132:135], v[224:227], a[200:203], v[132:135]
  v_mfma_f32_16x16x32_bf16 v[140:143], v[224:227], a[224:227], v[140:143]
  s_add_u32 s21, s43, 1024
  buffer_load_dword v9, v10, s[72:75], s21 offen sc1
  v_mfma_f32_16x16x32_bf16 v[64:67], v[204:207], a[12:15], v[64:67]
  v_mfma_f32_16x16x32_bf16 v[72:75], v[204:207], a[36:39], v[72:75]
  v_mfma_f32_16x16x32_bf16 v[80:83], v[204:207], a[60:63], v[80:83]
  v_mfma_f32_16x16x32_bf16 v[88:91], v[204:207], a[84:87], v[88:91]
  v_mfma_f32_16x16x32_bf16 v[96:99], v[204:207], a[108:111], v[96:99]
  v_mfma_f32_16x16x32_bf16 v[104:107], v[204:207], a[132:135], v[104:107]
  v_mfma_f32_16x16x32_bf16 v[112:115], v[204:207], a[156:159], v[112:115]
  v_mfma_f32_16x16x32_bf16 v[120:123], v[204:207], a[180:183], v[120:123]
  v_mfma_f32_16x16x32_bf16 v[128:131], v[204:207], a[204:207], v[128:131]
  v_mfma_f32_16x16x32_bf16 v[136:139], v[204:207], a[228:231], v[136:139]
  v_mfma_f32_16x16x32_bf16 v[68:71], v[228:231], a[12:15], v[68:71]
  v_mfma_f32_16x16x32_bf16 v[76:79], v[228:231], a[36:39], v[76:79]
  v_mfma_f32_16x16x32_bf16 v[84:87], v[228:231], a[60:63], v[84:87]
  v_mfma_f32_16x16x32_bf16 v[92:95], v[228:231], a[84:87], v[92:95]
  v_mfma_f32_16x16x32_bf16 v[100:103], v[228:231], a[108:111], v[100:103]
  v_mfma_f32_16x16x32_bf16 v[108:111], v[228:231], a[132:135], v[108:111]
  v_mfma_f32_16x16x32_bf16 v[116:119], v[228:231], a[156:159], v[116:119]
  v_mfma_f32_16x16x32_bf16 v[124:127], v[228:231], a[180:183], v[124:127]
  v_mfma_f32_16x16x32_bf16 v[132:135], v[228:231], a[204:207], v[132:135]
  v_mfma_f32_16x16x32_bf16 v[140:143], v[228:231], a[228:231], v[140:143]
  v_mfma_f32_16x16x32_bf16 v[64:67], v[208:211], a[16:19], v[64:67]
  v_mfma_f32_16x16x32_bf16 v[72:75], v[208:211], a[40:43], v[72:75]
  v_mfma_f32_16x16x32_bf16 v[80:83], v[208:211], a[64:67], v[80:83]
  v_mfma_f32_16x16x32_bf16 v[88:91], v[208:211], a[88:91], v[88:91]
  v_mfma_f32_16x16x32_bf16 v[96:99], v[208:211], a[112:115], v[96:99]
  v_mfma_f32_16x16x32_bf16 v[104:107], v[208:211], a[136:139], v[104:107]
  v_mfma_f32_16x16x32_bf16 v[112:115], v[208:211], a[160:163], v[112:115]
  v_mfma_f32_16x16x32_bf16 v[120:123], v[208:211], a[184:187], v[120:123]
  v_mfma_f32_16x16x32_bf16 v[128:131], v[208:211], a[208:211], v[128:131]
  v_mfma_f32_16x16x32_bf16 v[136:139], v[208:211], a[232:235], v[136:139]
  v_mfma_f32_16x16x32_bf16 v[68:71], v[232:235], a[16:19], v[68:71]
  v_mfma_f32_16x16x32_bf16 v[76:79], v[232:235], a[40:43], v[76:79]
  v_mfma_f32_16x16x32_bf16 v[84:87], v[232:235], a[64:67], v[84:87]
  v_mfma_f32_16x16x32_bf16 v[92:95], v[232:235], a[88:91], v[92:95]
  v_mfma_f32_16x16x32_bf16 v[100:103], v[232:235], a[112:115], v[100:103]
  v_mfma_f32_16x16x32_bf16 v[108:111], v[232:235], a[136:139], v[108:111]
  v_mfma_f32_16x16x32_bf16 v[116:119], v[232:235], a[160:163], v[116:119]
  v_mfma_f32_16x16x32_bf16 v[124:127], v[232:235], a[184:187], v[124:127]
  v_mfma_f32_16x16x32_bf16 v[132:135], v[232:235], a[208:211], v[132:135]
  v_mfma_f32_16x16x32_bf16 v[140:143], v[232:235], a[232:235], v[140:143]
  v_mfma_f32_16x16x32_bf16 v[64:67], v[212:215], a[20:23], v[64:67]
  v_mfma_f32_16x16x32_bf16 v[72:75], v[212:215], a[44:47], v[72:75]
  v_mfma_f32_16x16x32_bf16 v[80:83], v[212:215], a[68:71], v[80:83]
  v_mfma_f32_16x16x32_bf16 v[88:91], v[212:215], a[92:95], v[88:91]
  v_mfma_f32_16x16x32_bf16 v[96:99], v[212:215], a[116:119], v[96:99]
  v_mfma_f32_16x16x32_bf16 v[104:107], v[212:215], a[140:143], v[104:107]
  v_mfma_f32_16x16x32_bf16 v[112:115], v[212:215], a[164:167], v[112:115]
  v_mfma_f32_16x16x32_bf16 v[120:123], v[212:215], a[188:191], v[120:123]
  v_mfma_f32_16x16x32_bf16 v[128:131], v[212:215], a[212:215], v[128:131]
  v_mfma_f32_16x16x32_bf16 v[136:139], v[212:215], a[236:239], v[136:139]
  v_mfma_f32_16x16x32_bf16 v[68:71], v[236:239], a[20:23], v[68:71]
  v_mfma_f32_16x16x32_bf16 v[76:79], v[236:239], a[44:47], v[76:79]
  v_mfma_f32_16x16x32_bf16 v[84:87], v[236:239], a[68:71], v[84:87]
  v_mfma_f32_16x16x32_bf16 v[92:95], v[236:239], a[92:95], v[92:95]
  v_mfma_f32_16x16x32_bf16 v[100:103], v[236:239], a[116:119], v[100:103]
  v_mfma_f32_16x16x32_bf16 v[108:111], v[236:239], a[140:143], v[108:111]
  v_mfma_f32_16x16x32_bf16 v[116:119], v[236:239], a[164:167], v[116:119]
  v_mfma_f32_16x16x32_bf16 v[124:127], v[236:239], a[188:191], v[124:127]
  v_mfma_f32_16x16x32_bf16 v[132:135], v[236:239], a[212:215], v[132:135]
  v_mfma_f32_16x16x32_bf16 v[140:143], v[236:239], a[236:239], v[140:143]
  s_waitcnt vmcnt(0)
  s_mov_b64 exec, 1
  v_mov_b32 v20, s45
  buffer_store_dword v20, v10, s[72:75], s44 offen sc1

  s_mov_b64 exec, -1
  s_cmp_eq_u32 s58, 0
  s_cbranch_scc1 uf_234
  s_mov_b64 exec, s[58:59]
  buffer_atomic_add v11, v17, s[72:75], s57 offen sc1
  s_mov_b64 exec, -1
  s_mov_b32 s58, 0
uf_234:
  v_cvt_pk_bf16_f32 v24, v64, v65
  v_cvt_pk_bf16_f32 v25, v66, v67
  v_cvt_pk_bf16_f32 v26, v68, v69
  v_cvt_pk_bf16_f32 v27, v70, v71
  s_cmp_lt_u32 s48, 8
  s_cselect_b32 s21, s42, s64
  buffer_store_dwordx4 v[24:27], v4, s[24:27], s21 offen offset:0 sc1
  v_cvt_pk_bf16_f32 v28, v72, v73
  v_cvt_pk_bf16_f32 v29, v74, v75
  v_cvt_pk_bf16_f32 v30, v76, v77
  v_cvt_pk_bf16_f32 v31, v78, v79
  s_cmp_lt_u32 s48, 7
  s_cselect_b32 s21, s42, s64
  buffer_store_dwordx4 v[28:31], v4, s[24:27], s21 offen offset:1024 sc1
  v_cvt_pk_bf16_f32 v32, v80, v81
  v_cvt_pk_bf16_f32 v33, v82, v83
  v_cvt_pk_bf16_f32 v34, v84, v85
  v_cvt_pk_bf16_f32 v35, v86, v87
  s_cmp_lt_u32 s48, 6
  s_cselect_b32 s21, s42, s64
  buffer_store_dwordx4 v[32:35], v4, s[24:27], s21 offen offset:2048 sc1
  v_cvt_pk_bf16_f32 v36, v88, v89
  v_cvt_pk_bf16_f32 v37, v90, v91
  v_cvt_pk_bf16_f32 v38, v92, v93
  v_cvt_pk_bf16_f32 v39, v94, v95
  s_cmp_lt_u32 s48, 5
  s_cselect_b32 s21, s42, s64
  buffer_store_dwordx4 v[36:39], v4, s[24:27], s21 offen offset:3072 sc1
  v_cvt_pk_bf16_f32 v40, v96, v97
  v_cvt_pk_bf16_f32 v41, v98, v99
  v_cvt_pk_bf16_f32 v42, v100, v101
  v_cvt_pk_bf16_f32 v43, v102, v103
  s_cmp_lt_u32 s48, 4
  s_cselect_b32 s21, s42, s64
  s_add_u32 s21, s21, 4096
  buffer_store_dwordx4 v[40:43], v4, s[24:27], s21 offen offset:0 sc1
  v_cvt_pk_bf16_f32 v44, v104, v105
  v_cvt_pk_bf16_f32 v45, v106, v107
  v_cvt_pk_bf16_f32 v46, v108, v109
  v_cvt_pk_bf16_f32 v47, v110, v111
  s_cmp_lt_u32 s48, 3
  s_cselect_b32 s21, s42, s64
  s_add_u32 s21, s21, 4096
  buffer_store_dwordx4 v[44:47], v4, s[24:27], s21 offen offset:1024 sc1
  v_cvt_pk_bf16_f32 v48, v112, v113
  v_cvt_pk_bf16_f32 v49, v114, v115
  v_cvt_pk_bf16_f32 v50, v116, v117
  v_cvt_pk_bf16_f32 v51, v118, v119
  s_cmp_lt_u32 s48, 2
  s_cselect_b32 s21, s42, s64
  s_add_u32 s21, s21, 4096
  buffer_store_dwordx4 v[48:51], v4, s[24:27], s21 offen offset:2048 sc1
  v_cvt_pk_bf16_f32 v52, v120, v121
  v_cvt_pk_bf16_f32 v53, v122, v123
  v_cvt_pk_bf16_f32 v54, v124, v125
  v_cvt_pk_bf16_f32 v55, v126, v127
  s_cmp_lt_u32 s48, 1
  s_cselect_b32 s21, s42, s64
  s_add_u32 s21, s21, 4096
  buffer_store_dwordx4 v[52:55], v4, s[24:27], s21 offen offset:3072 sc1
  v_cvt_pk_bf16_f32 v56, v128, v129
  v_cvt_pk_bf16_f32 v57, v130, v131
  v_cvt_pk_bf16_f32 v58, v132, v133
  v_cvt_pk_bf16_f32 v59, v134, v135
  s_cmp_lt_u32 s48, 0
  s_cselect_b32 s21, s42, s64
  s_add_u32 s21, s21, 8192
  buffer_store_dwordx4 v[56:59], v4, s[24:27], s21 offen offset:0 sc1
  v_cvt_pk_bf16_f32 v60, v136, v137
  v_cvt_pk_bf16_f32 v61, v138, v139
  v_cvt_pk_bf16_f32 v62, v140, v141
  v_cvt_pk_bf16_f32 v63, v142, v143
  s_cmp_lt_u32 s48, 0
  s_cselect_b32 s21, s42, s64
  s_add_u32 s21, s21, 8192
  buffer_store_dwordx4 v[60:63], v4, s[24:27], s21 offen offset:1024 sc1
  s_add_u32 s45, s45, 1
  s_cmp_eq_u32 s49, 0
  s_cbranch_scc1 vwu_235
  v_mfma_f32_16x16x32_bf16 v[64:67], a[240:243], a[0:3], 0
  v_mfma_f32_16x16x32_bf16 v[68:71], a[240:243], a[24:27], 0
  v_mfma_f32_16x16x32_bf16 v[72:75], a[240:243], a[48:51], 0
  v_mfma_f32_16x16x32_bf16 v[76:79], a[240:243], a[72:75], 0
  v_mfma_f32_16x16x32_bf16 v[80:83], a[240:243], a[96:99], 0
  v_mfma_f32_16x16x32_bf16 v[84:87], a[240:243], a[120:123], 0
  v_mfma_f32_16x16x32_bf16 v[88:91], a[240:243], a[144:147], 0
  v_mfma_f32_16x16x32_bf16 v[92:95], a[240:243], a[168:171], 0
  v_mfma_f32_16x16x32_bf16 v[96:99], a[240:243], a[192:195], 0
  v_mfma_f32_16x16x32_bf16 v[100:103], a[240:243], a[216:219], 0
  v_mfma_f32_16x16x32_bf16 v[64:67], a[244:247], a[4:7], v[64:67]
  v_mfma_f32_16x16x32_bf16 v[68:71], a[244:247], a[28:31], v[68:71]
  v_mfma_f32_16x16x32_bf16 v[72:75], a[244:247], a[52:55], v[72:75]
  v_mfma_f32_16x16x32_bf16 v[76:79], a[244:247], a[76:79], v[76:79]
  v_mfma_f32_16x16x32_bf16 v[80:83], a[244:247], a[100:103], v[80:83]
  v_mfma_f32_16x16x32_bf16 v[84:87], a[244:247], a[124:127], v[84:87]
  v_mfma_f32_16x16x32_bf16 v[88:91], a[244:247], a[148:151], v[88:91]
  v_mfma_f32_16x16x32_bf16 v[92:95], a[244:247], a[172:175], v[92:95]
  v_mfma_f32_16x16x32_bf16 v[96:99], a[244:247], a[196:199], v[96:99]
  v_mfma_f32_16x16x32_bf16 v[100:103], a[244:247], a[220:223], v[100:103]
  v_mfma_f32_16x16x32_bf16 v[64:67], a[248:251], a[8:11], v[64:67]
  v_mfma_f32_16x16x32_bf16 v[68:71], a[248:251], a[32:35], v[68:71]
  v_mfma_f32_16x16x32_bf16 v[72:75], a[248:251], a[56:59], v[72:75]
  v_mfma_f32_16x16x32_bf16 v[76:79], a[248:251], a[80:83], v[76:79]
  v_mfma_f32_16x16x32_bf16 v[80:83], a[248:251], a[104:107], v[80:83]
  v_mfma_f32_16x16x32_bf16 v[84:87], a[248:251], a[128:131], v[84:87]
  v_mfma_f32_16x16x32_bf16 v[88:91], a[248:251], a[152:155], v[88:91]
  v_mfma_f32_16x16x32_bf16 v[92:95], a[248:251], a[176:179], v[92:95]
  v_mfma_f32_16x16x32_bf16 v[96:99], a[248:251], a[200:203], v[96:99]
  v_mfma_f32_16x16x32_bf16 v[100:103], a[248:251], a[224:227], v[100:103]
  v_mfma_f32_16x16x32_bf16 v[64:67], a[252:255], a[12:15], v[64:67]
  v_mfma_f32_16x16x32_bf16 v[68:71], a[252:255], a[36:39], v[68:71]
  v_mfma_f32_16x16x32_bf16 v[72:75], a[252:255], a[60:63], v[72:75]
  v_mfma_f32_16x16x32_bf16 v[76:79], a[252:255], a[84:87], v[76:79]
  v_mfma_f32_16x16x32_bf16 v[80:83], a[252:255], a[108:111], v[80:83]
  v_mfma_f32_16x16x32_bf16 v[84:87], a[252:255], a[132:135], v[84:87]
  v_mfma_f32_16x16x32_bf16 v[88:91], a[252:255], a[156:159], v[88:91]
  v_mfma_f32_16x16x32_bf16 v[92:95], a[252:255], a[180:183], v[92:95]
  v_mfma_f32_16x16x32_bf16 v[96:99], a[252:255], a[204:207], v[96:99]
  v_mfma_f32_16x16x32_bf16 v[100:103], a[252:255], a[228:231], v[100:103]
  v_mfma_f32_16x16x32_bf16 v[64:67], v[248:251], a[16:19], v[64:67]
  v_mfma_f32_16x16x32_bf16 v[68:71], v[248:251], a[40:43], v[68:71]
  v_mfma_f32_16x16x32_bf16 v[72:75], v[248:251], a[64:67], v[72:75]
  v_mfma_f32_16x16x32_bf16 v[76:79], v[248:251], a[88:91], v[76:79]
  v_mfma_f32_16x16x32_bf16 v[80:83], v[248:251], a[112:115], v[80:83]
  v_mfma_f32_16x16x32_bf16 v[84:87], v[248:251], a[136:139], v[84:87]
  v_mfma_f32_16x16x32_bf16 v[88:91], v[248:251], a[160:163], v[88:91]
  v_mfma_f32_16x16x32_bf16 v[92:95], v[248:251], a[184:187], v[92:95]
  v_mfma_f32_16x16x32_bf16 v[96:99], v[248:251], a[208:211], v[96:99]
  v_mfma_f32_16x16x32_bf16 v[100:103], v[248:251], a[232:235], v[100:103]
  v_mfma_f32_16x16x32_bf16 v[64:67], v[252:255], a[20:23], v[64:67]
  v_mfma_f32_16x16x32_bf16 v[68:71], v[252:255], a[44:47], v[68:71]
  v_mfma_f32_16x16x32_bf16 v[72:75], v[252:255], a[68:71], v[72:75]
  v_mfma_f32_16x16x32_bf16 v[76:79], v[252:255], a[92:95], v[76:79]
  v_mfma_f32_16x16x32_bf16 v[80:83], v[252:255], a[116:119], v[80:83]
  v_mfma_f32_16x16x32_bf16 v[84:87], v[252:255], a[140:143], v[84:87]
  v_mfma_f32_16x16x32_bf16 v[88:91], v[252:255], a[164:167], v[88:91]
  v_mfma_f32_16x16x32_bf16 v[92:95], v[252:255], a[188:191], v[92:95]
  v_mfma_f32_16x16x32_bf16 v[96:99], v[252:255], a[212:215], v[96:99]
  v_mfma_f32_16x16x32_bf16 v[100:103], v[252:255], a[236:239], v[100:103]
  s_cmp_eq_u32 s54, 2
  s_cselect_b32 s61, -1, 0
  s_mov_b32 s60, -1
  s_cselect_b32 s58, 3, 1
  s_lshl_b32 s57, s55, 3
  s_and_b32 s21, s2, 7
  s_add_u32 s57, s57, s21
  s_lshl_b32 s57, s57, 7
  s_add_u32 s57, s57, 22528
  s_add_u32 s55, s55, s54
  v_cvt_pk_bf16_f32 v48, v64, v65
  v_cvt_pk_bf16_f32 v49, v66, v67
  v_cvt_pk_bf16_f32 v50, v68, v69
  v_cvt_pk_bf16_f32 v51, v70, v71
  v_cvt_pk_bf16_f32 v52, v72, v73
  v_cvt_pk_bf16_f32 v53, v74, v75
  v_cvt_pk_bf16_f32 v54, v76, v77
  v_cvt_pk_bf16_f32 v55, v78, v79
  v_cvt_pk_bf16_f32 v56, v80, v81
  v_cvt_pk_bf16_f32 v57, v82, v83
  v_cvt_pk_bf16_f32 v58, v84, v85
  v_cvt_pk_bf16_f32 v59, v86, v87
  v_cvt_pk_bf16_f32 v60, v88, v89
  v_cvt_pk_bf16_f32 v61, v90, v91
  v_cvt_pk_bf16_f32 v62, v92, v93
  v_cvt_pk_bf16_f32 v63, v94, v95
  v_cvt_pk_bf16_f32 v240, v96, v97
  v_cvt_pk_bf16_f32 v241, v98, v99
  v_cvt_pk_bf16_f32 v242, v100, v101
  v_cvt_pk_bf16_f32 v243, v102, v103
  v_min_u32 v48, -2, v48
  v_min_u32 v52, -2, v52
  v_min_u32 v56, -2, v56
  v_min_u32 v60, -2, v60
  v_min_u32 v240, -2, v240
  s_mov_b64 exec, s[60:61]
  buffer_store_dwordx4 v[48:51], v15, s[80:83], s63 offen offset:0 sc1
  buffer_store_dwordx4 v[52:55], v15, s[80:83], s63 offen offset:512 sc1
  buffer_store_dwordx4 v[56:59], v15, s[80:83], s63 offen offset:1024 sc1
  buffer_store_dwordx4 v[60:63], v15, s[80:83], s63 offen offset:1536 sc1
  buffer_store_dwordx4 v[240:243], v15, s[80:83], s63 offen offset:2048 sc1
  s_mov_b64 exec, -1
vwu_235:
  s_cmp_eq_u32 s50, 0
  s_cbranch_scc1 vwt_236
  s_waitcnt vmcnt(0)
  s_mov_b64 exec, 1
  v_mov_b32 v20, s45
  buffer_store_dword v20, v10, s[72:75], s44 offen sc1

  s_mov_b64 exec, -1
  s_mov_b32 s50, 0
  s_mov_b32 s70, s45
  s_cmp_eq_u32 s58, 0
  s_cbranch_scc1 uf_237
  s_mov_b64 exec, s[58:59]
  buffer_atomic_add v11, v17, s[72:75], s57 offen sc1
  s_mov_b64 exec, -1
  s_mov_b32 s58, 0
uf_237:
  v_mov_b32 v7, 0
  s_mov_b32 s101, 0
wf_238:
  buffer_load_dword v8, v7, s[72:75], s43 offen sc1
  s_add_u32 s101, s101, 1
  s_cmp_gt_u32 s101, 131072
  s_cbranch_scc1 main_end
  s_waitcnt vmcnt(0)
  v_readfirstlane_b32 s100, v8
  s_cmp_ge_u32 s100, 8
  s_cbranch_scc1 wf_239
  s_sleep 4
  s_branch wf_238
wf_239:
  s_add_u32 s21, s41, 0
  buffer_load_dwordx4 v[144:147], v4, s[16:19], s21 offen offset:0 sc1
  buffer_load_dwordx4 v[148:151], v4, s[16:19], s21 offen offset:1024 sc1
  buffer_load_dwordx4 v[152:155], v4, s[16:19], s21 offen offset:2048 sc1
  buffer_load_dwordx4 v[156:159], v4, s[16:19], s21 offen offset:3072 sc1
  s_add_u32 s21, s41, 4096
  buffer_load_dwordx4 v[160:163], v4, s[16:19], s21 offen offset:0 sc1
  buffer_load_dwordx4 v[164:167], v4, s[16:19], s21 offen offset:1024 sc1
  buffer_load_dwordx4 v[168:171], v4, s[16:19], s21 offen offset:2048 sc1
  buffer_load_dwordx4 v[172:175], v4, s[16:19], s21 offen offset:3072 sc1
  s_add_u32 s21, s41, 8192
  buffer_load_dwordx4 v[176:179], v4, s[16:19], s21 offen offset:0 sc1
  buffer_load_dwordx4 v[180:183], v4, s[16:19], s21 offen offset:1024 sc1
  buffer_load_dwordx4 v[184:187], v4, s[16:19], s21 offen offset:2048 sc1
  buffer_load_dwordx4 v[188:191], v4, s[16:19], s21 offen offset:3072 sc1
  s_add_u32 s41, s41, 393216
  s_waitcnt vmcnt(0)
vwt_236:
  s_cmp_lt_u32 s45, 64
  s_cbranch_scc1 vwl_214
  s_waitcnt vmcnt(0)
  s_mov_b64 exec, 1
  v_mov_b32 v20, s45
  buffer_store_dword v20, v10, s[72:75], s44 offen sc1

  s_mov_b64 exec, -1
ul_240:
  s_cmp_lt_u32 s55, s56
  s_cbranch_scc1 uh_241
  s_sub_u32 s21, s55, 60
  s_cmp_lt_u32 s21, 4
  s_cbranch_scc1 ut_243
  s_waitcnt vmcnt(0)
  s_cmp_eq_u32 s58, 0
  s_cbranch_scc1 uf_244
  s_mov_b64 exec, s[58:59]
  buffer_atomic_add v11, v17, s[72:75], s57 offen sc1
  s_mov_b64 exec, -1
  s_mov_b32 s58, 0
uf_244:
  s_cmp_ge_u32 s55, 64
  s_cbranch_scc1 ud_242
  s_cmp_ge_u32 s55, 60
  s_cbranch_scc1 ut_243
  s_add_u32 s23, s55, 1
  s_mov_b32 s101, 0
wm_245:
  buffer_load_dword v8, v12, s[72:75], s53 offen sc1
  s_add_u32 s101, s101, 1
  s_cmp_gt_u32 s101, 131072
  s_cbranch_scc1 main_end
  s_waitcnt vmcnt(0)
  v_cmp_gt_u32 vcc, s23, v8
  v_readfirstlane_b32 s100, v8
  s_nop 0
  s_cbranch_vccz wm_246
  s_sleep 4
  s_add_u32 s100, s100, 1
  s_cmp_ge_u32 s100, s23
  s_cbranch_scc1 wm_245
  s_sleep 90
  s_branch wm_245
wm_246:
  v_readlane_b32 s56, v8, 0
  v_readlane_b32 s21, v8, 1
  v_readlane_b32 s22, v8, 2
  v_readlane_b32 s23, v8, 3
  s_min_u32 s56, s56, s21
  s_min_u32 s22, s22, s23
  s_min_u32 s56, s56, s22
  s_min_u32 s56, s56, 64
uh_241:
  s_sub_u32 s21, s56, s55
  s_cmp_lt_u32 s21, 4
  s_cbranch_scc1 uo_247
  s_sub_u32 s21, s56, s55
  s_cmp_ge_u32 s21, 2
  s_cselect_b64 vcc, -1, 0
  s_cselect_b32 s54, 2, 1
  v_cndmask_b32 v18, v13, v14, vcc
  s_lshl_b32 s21, s55, 5
  s_add_u32 s21, s21, s2
  s_mul_i32 s62, s21, 3072
  s_mul_i32 s63, s21, 10240
  s_mul_i32 s22, s20, 2560
  s_add_u32 s63, s63, s22
  buffer_load_dwordx4 a[240:243], v18, s[76:79], s62 offen offset:0 sc1
  buffer_load_dwordx4 a[244:247], v18, s[76:79], s62 offen offset:512 sc1
  buffer_load_dwordx4 a[248:251], v18, s[76:79], s62 offen offset:1024 sc1
  buffer_load_dwordx4 a[252:255], v18, s[76:79], s62 offen offset:1536 sc1
  buffer_load_dwordx4 v[248:251], v18, s[76:79], s62 offen offset:2048 sc1
  buffer_load_dwordx4 v[252:255], v18, s[76:79], s62 offen offset:2560 sc1
  s_mov_b32 s66, 0
  s_mov_b32 s67, 0
  s_add_u32 s62, s62, 196608
  buffer_load_dwordx4 v[24:27], v18, s[76:79], s62 offen offset:0 sc1
  buffer_load_dwordx4 v[28:31], v18, s[76:79], s62 offen offset:512 sc1
  buffer_load_dwordx4 v[32:35], v18, s[76:79], s62 offen offset:1024 sc1
  buffer_load_dwordx4 v[36:39], v18, s[76:79], s62 offen offset:1536 sc1
  buffer_load_dwordx4 v[40:43], v18, s[76:79], s62 offen offset:2048 sc1
  buffer_load_dwordx4 v[44:47], v18, s[76:79], s62 offen offset:2560 sc1
  s_waitcnt vmcnt(6)
  s_cmp_eq_u32 s58, 0
  s_cbranch_scc1 uf_251
  s_mov_b64 exec, s[58:59]
  buffer_atomic_add v11, v17, s[72:75], s57 offen sc1
  s_mov_b64 exec, -1
  s_mov_b32 s58, 0
uf_251:
  v_mfma_f32_16x16x32_bf16 v[64:67], a[240:243], a[0:3], 0
  v_mfma_f32_16x16x32_bf16 v[68:71], a[240:243], a[24:27], 0
  v_mfma_f32_16x16x32_bf16 v[72:75], a[240:243], a[48:51], 0
  v_mfma_f32_16x16x32_bf16 v[76:79], a[240:243], a[72:75], 0
  v_mfma_f32_16x16x32_bf16 v[80:83], a[240:243], a[96:99], 0
  v_mfma_f32_16x16x32_bf16 v[84:87], a[240:243], a[120:123], 0
  v_mfma_f32_16x16x32_bf16 v[88:91], a[240:243], a[144:147], 0
  v_mfma_f32_16x16x32_bf16 v[92:95], a[240:243], a[168:171], 0
  v_mfma_f32_16x16x32_bf16 v[96:99], a[240:243], a[192:195], 0
  v_mfma_f32_16x16x32_bf16 v[100:103], a[240:243], a[216:219], 0
  v_mfma_f32_16x16x32_bf16 v[64:67], a[244:247], a[4:7], v[64:67]
  v_mfma_f32_16x16x32_bf16 v[68:71], a[244:247], a[28:31], v[68:71]
  v_mfma_f32_16x16x32_bf16 v[72:75], a[244:247], a[52:55], v[72:75]
  v_mfma_f32_16x16x32_bf16 v[76:79], a[244:247], a[76:79], v[76:79]
  v_mfma_f32_16x16x32_bf16 v[80:83], a[244:247], a[100:103], v[80:83]
  v_mfma_f32_16x16x32_bf16 v[84:87], a[244:247], a[124:127], v[84:87]
  v_mfma_f32_16x16x32_bf16 v[88:91], a[244:247], a[148:151], v[88:91]
  v_mfma_f32_16x16x32_bf16 v[92:95], a[244:247], a[172:175], v[92:95]
  v_mfma_f32_16x16x32_bf16 v[96:99], a[244:247], a[196:199], v[96:99]
  v_mfma_f32_16x16x32_bf16 v[100:103], a[244:247], a[220:223], v[100:103]
  v_mfma_f32_16x16x32_bf16 v[64:67], a[248:251], a[8:11], v[64:67]
  v_mfma_f32_16x16x32_bf16 v[68:71], a[248:251], a[32:35], v[68:71]
  v_mfma_f32_16x16x32_bf16 v[72:75], a[248:251], a[56:59], v[72:75]
  v_mfma_f32_16x16x32_bf16 v[76:79], a[248:251], a[80:83], v[76:79]
  v_mfma_f32_16x16x32_bf16 v[80:83], a[248:251], a[104:107], v[80:83]
  v_mfma_f32_16x16x32_bf16 v[84:87], a[248:251], a[128:131], v[84:87]
  v_mfma_f32_16x16x32_bf16 v[88:91], a[248:251], a[152:155], v[88:91]
  v_mfma_f32_16x16x32_bf16 v[92:95], a[248:251], a[176:179], v[92:95]
  v_mfma_f32_16x16x32_bf16 v[96:99], a[248:251], a[200:203], v[96:99]
  v_mfma_f32_16x16x32_bf16 v[100:103], a[248:251], a[224:227], v[100:103]
  v_mfma_f32_16x16x32_bf16 v[64:67], a[252:255], a[12:15], v[64:67]
  v_mfma_f32_16x16x32_bf16 v[68:71], a[252:255], a[36:39], v[68:71]
  v_mfma_f32_16x16x32_bf16 v[72:75], a[252:255], a[60:63], v[72:75]
  v_mfma_f32_16x16x32_bf16 v[76:79], a[252:255], a[84:87], v[76:79]
  v_mfma_f32_16x16x32_bf16 v[80:83], a[252:255], a[108:111], v[80:83]
  v_mfma_f32_16x16x32_bf16 v[84:87], a[252:255], a[132:135], v[84:87]
  v_mfma_f32_16x16x32_bf16 v[88:91], a[252:255], a[156:159], v[88:91]
  v_mfma_f32_16x16x32_bf16 v[92:95], a[252:255], a[180:183], v[92:95]
  v_mfma_f32_16x16x32_bf16 v[96:99], a[252:255], a[204:207], v[96:99]
  v_mfma_f32_16x16x32_bf16 v[100:103], a[252:255], a[228:231], v[100:103]
  v_mfma_f32_16x16x32_bf16 v[64:67], v[248:251], a[16:19], v[64:67]
  v_mfma_f32_16x16x32_bf16 v[68:71], v[248:251], a[40:43], v[68:71]
  v_mfma_f32_16x16x32_bf16 v[72:75], v[248:251], a[64:67], v[72:75]
  v_mfma_f32_16x16x32_bf16 v[76:79], v[248:251], a[88:91], v[76:79]
  v_mfma_f32_16x16x32_bf16 v[80:83], v[248:251], a[112:115], v[80:83]
  v_mfma_f32_16x16x32_bf16 v[84:87], v[248:251], a[136:139], v[84:87]
  v_mfma_f32_16x16x32_bf16 v[88:91], v[248:251], a[160:163], v[88:91]
  v_mfma_f32_16x16x32_bf16 v[92:95], v[248:251], a[184:187], v[92:95]
  v_mfma_f32_16x16x32_bf16 v[96:99], v[248:251], a[208:211], v[96:99]
  v_mfma_f32_16x16x32_bf16 v[100:103], v[248:251], a[232:235], v[100:103]
  v_mfma_f32_16x16x32_bf16 v[64:67], v[252:255], a[20:23], v[64:67]
  v_mfma_f32_16x16x32_bf16 v[68:71], v[252:255], a[44:47], v[68:71]
  v_mfma_f32_16x16x32_bf16 v[72:75], v[252:255], a[68:71], v[72:75]
  v_mfma_f32_16x16x32_bf16 v[76:79], v[252:255], a[92:95], v[76:79]
  v_mfma_f32_16x16x32_bf16 v[80:83], v[252:255], a[116:119], v[80:83]
  v_mfma_f32_16x16x32_bf16 v[84:87], v[252:255], a[140:143], v[84:87]
  v_mfma_f32_16x16x32_bf16 v[88:91], v[252:255], a[164:167], v[88:91]
  v_mfma_f32_16x16x32_bf16 v[92:95], v[252:255], a[188:191], v[92:95]
  v_mfma_f32_16x16x32_bf16 v[96:99], v[252:255], a[212:215], v[96:99]
  v_mfma_f32_16x16x32_bf16 v[100:103], v[252:255], a[236:239], v[100:103]
  s_cmp_eq_u32 s54, 2
  s_cselect_b32 s61, -1, 0
  s_mov_b32 s60, -1
  s_cselect_b32 s58, 3, 1
  s_lshl_b32 s57, s55, 3
  s_and_b32 s21, s2, 7
  s_add_u32 s57, s57, s21
  s_lshl_b32 s57, s57, 7
  s_add_u32 s57, s57, 22528
  s_add_u32 s55, s55, s54
  v_cvt_pk_bf16_f32 v48, v64, v65
  v_cvt_pk_bf16_f32 v49, v66, v67
  v_cvt_pk_bf16_f32 v50, v68, v69
  v_cvt_pk_bf16_f32 v51, v70, v71
  v_cvt_pk_bf16_f32 v52, v72, v73
  v_cvt_pk_bf16_f32 v53, v74, v75
  v_cvt_pk_bf16_f32 v54, v76, v77
  v_cvt_pk_bf16_f32 v55, v78, v79
  v_cvt_pk_bf16_f32 v56, v80, v81
  v_cvt_pk_bf16_f32 v57, v82, v83
  v_cvt_pk_bf16_f32 v58, v84, v85
  v_cvt_pk_bf16_f32 v59, v86, v87
  v_cvt_pk_bf16_f32 v60, v88, v89
  v_cvt_pk_bf16_f32 v61, v90, v91
  v_cvt_pk_bf16_f32 v62, v92, v93
  v_cvt_pk_bf16_f32 v63, v94, v95
  v_cvt_pk_bf16_f32 v240, v96, v97
  v_cvt_pk_bf16_f32 v241, v98, v99
  v_cvt_pk_bf16_f32 v242, v100, v101
  v_cvt_pk_bf16_f32 v243, v102, v103
  v_min_u32 v48, -2, v48
  v_min_u32 v52, -2, v52
  v_min_u32 v56, -2, v56
  v_min_u32 v60, -2, v60
  v_min_u32 v240, -2, v240
  s_mov_b64 exec, s[60:61]
  buffer_store_dwordx4 v[48:51], v15, s[80:83], s63 offen offset:0 sc1
  buffer_store_dwordx4 v[52:55], v15, s[80:83], s63 offen offset:512 sc1
  buffer_store_dwordx4 v[56:59], v15, s[80:83], s63 offen offset:1024 sc1
  buffer_store_dwordx4 v[60:63], v15, s[80:83], s63 offen offset:1536 sc1
  buffer_store_dwordx4 v[240:243], v15, s[80:83], s63 offen offset:2048 sc1
  s_mov_b64 exec, -1
  s_add_u32 s63, s63, 655360
uf_248:
  s_add_u32 s21, s55, 4
  s_cmp_gt_u32 s21, s56
  s_cbranch_scc1 ux_250
  s_add_u32 s62, s62, 196608
  buffer_load_dwordx4 a[240:243], v18, s[76:79], s62 offen offset:0 sc1
  buffer_load_dwordx4 a[244:247], v18, s[76:79], s62 offen offset:512 sc1
  buffer_load_dwordx4 a[248:251], v18, s[76:79], s62 offen offset:1024 sc1
  buffer_load_dwordx4 a[252:255], v18, s[76:79], s62 offen offset:1536 sc1
  buffer_load_dwordx4 v[248:251], v18, s[76:79], s62 offen offset:2048 sc1
  buffer_load_dwordx4 v[252:255], v18, s[76:79], s62 offen offset:2560 sc1
  s_waitcnt vmcnt(11)
  s_cmp_eq_u32 s66, 0
  s_cbranch_scc1 uf_252
  s_mov_b64 exec, s[66:67]
  buffer_atomic_add v11, v17, s[72:75], s65 offen sc1
  s_mov_b64 exec, -1
  s_mov_b32 s66, 0
uf_252:
  s_mov_b32 s65, s57
  s_mov_b32 s66, s58
  s_mov_b32 s58, 0
  v_mfma_f32_16x16x32_bf16 v[64:67], v[24:27], a[0:3], 0
  v_mfma_f32_16x16x32_bf16 v[68:71], v[24:27], a[24:27], 0
  v_mfma_f32_16x16x32_bf16 v[72:75], v[24:27], a[48:51], 0
  v_mfma_f32_16x16x32_bf16 v[76:79], v[24:27], a[72:75], 0
  v_mfma_f32_16x16x32_bf16 v[80:83], v[24:27], a[96:99], 0
  v_mfma_f32_16x16x32_bf16 v[84:87], v[24:27], a[120:123], 0
  v_mfma_f32_16x16x32_bf16 v[88:91], v[24:27], a[144:147], 0
  v_mfma_f32_16x16x32_bf16 v[92:95], v[24:27], a[168:171], 0
  v_mfma_f32_16x16x32_bf16 v[96:99], v[24:27], a[192:195], 0
  v_mfma_f32_16x16x32_bf16 v[100:103], v[24:27], a[216:219], 0
  v_mfma_f32_16x16x32_bf16 v[64:67], v[28:31], a[4:7], v[64:67]
  v_mfma_f32_16x16x32_bf16 v[68:71], v[28:31], a[28:31], v[68:71]
  v_mfma_f32_16x16x32_bf16 v[72:75], v[28:31], a[52:55], v[72:75]
  v_mfma_f32_16x16x32_bf16 v[76:79], v[28:31], a[76:79], v[76:79]
  v_mfma_f32_16x16x32_bf16 v[80:83], v[28:31], a[100:103], v[80:83]
  v_mfma_f32_16x16x32_bf16 v[84:87], v[28:31], a[124:127], v[84:87]
  v_mfma_f32_16x16x32_bf16 v[88:91], v[28:31], a[148:151], v[88:91]
  v_mfma_f32_16x16x32_bf16 v[92:95], v[28:31], a[172:175], v[92:95]
  v_mfma_f32_16x16x32_bf16 v[96:99], v[28:31], a[196:199], v[96:99]
  v_mfma_f32_16x16x32_bf16 v[100:103], v[28:31], a[220:223], v[100:103]
  v_mfma_f32_16x16x32_bf16 v[64:67], v[32:35], a[8:11], v[64:67]
  v_mfma_f32_16x16x32_bf16 v[68:71], v[32:35], a[32:35], v[68:71]
  v_mfma_f32_16x16x32_bf16 v[72:75], v[32:35], a[56:59], v[72:75]
  v_mfma_f32_16x16x32_bf16 v[76:79], v[32:35], a[80:83], v[76:79]
  v_mfma_f32_16x16x32_bf16 v[80:83], v[32:35], a[104:107], v[80:83]
  v_mfma_f32_16x16x32_bf16 v[84:87], v[32:35], a[128:131], v[84:87]
  v_mfma_f32_16x16x32_bf16 v[88:91], v[32:35], a[152:155], v[88:91]
  v_mfma_f32_16x16x32_bf16 v[92:95], v[32:35], a[176:179], v[92:95]
  v_mfma_f32_16x16x32_bf16 v[96:99], v[32:35], a[200:203], v[96:99]
  v_mfma_f32_16x16x32_bf16 v[100:103], v[32:35], a[224:227], v[100:103]
  v_mfma_f32_16x16x32_bf16 v[64:67], v[36:39], a[12:15], v[64:67]
  v_mfma_f32_16x16x32_bf16 v[68:71], v[36:39], a[36:39], v[68:71]
  v_mfma_f32_16x16x32_bf16 v[72:75], v[36:39], a[60:63], v[72:75]
  v_mfma_f32_16x16x32_bf16 v[76:79], v[36:39], a[84:87], v[76:79]
  v_mfma_f32_16x16x32_bf16 v[80:83], v[36:39], a[108:111], v[80:83]
  v_mfma_f32_16x16x32_bf16 v[84:87], v[36:39], a[132:135], v[84:87]
  v_mfma_f32_16x16x32_bf16 v[88:91], v[36:39], a[156:159], v[88:91]
  v_mfma_f32_16x16x32_bf16 v[92:95], v[36:39], a[180:183], v[92:95]
  v_mfma_f32_16x16x32_bf16 v[96:99], v[36:39], a[204:207], v[96:99]
  v_mfma_f32_16x16x32_bf16 v[100:103], v[36:39], a[228:231], v[100:103]
  v_mfma_f32_16x16x32_bf16 v[64:67], v[40:43], a[16:19], v[64:67]
  v_mfma_f32_16x16x32_bf16 v[68:71], v[40:43], a[40:43], v[68:71]
  v_mfma_f32_16x16x32_bf16 v[72:75], v[40:43], a[64:67], v[72:75]
  v_mfma_f32_16x16x32_bf16 v[76:79], v[40:43], a[88:91], v[76:79]
  v_mfma_f32_16x16x32_bf16 v[80:83], v[40:43], a[112:115], v[80:83]
  v_mfma_f32_16x16x32_bf16 v[84:87], v[40:43], a[136:139], v[84:87]
  v_mfma_f32_16x16x32_bf16 v[88:91], v[40:43], a[160:163], v[88:91]
  v_mfma_f32_16x16x32_bf16 v[92:95], v[40:43], a[184:187], v[92:95]
  v_mfma_f32_16x16x32_bf16 v[96:99], v[40:43], a[208:211], v[96:99]
  v_mfma_f32_16x16x32_bf16 v[100:103], v[40:43], a[232:235], v[100:103]
  v_mfma_f32_16x16x32_bf16 v[64:67], v[44:47], a[20:23], v[64:67]
  v_mfma_f32_16x16x32_bf16 v[68:71], v[44:47], a[44:47], v[68:71]
  v_mfma_f32_16x16x32_bf16 v[72:75], v[44:47], a[68:71], v[72:75]
  v_mfma_f32_16x16x32_bf16 v[76:79], v[44:47], a[92:95], v[76:79]
  v_mfma_f32_16x16x32_bf16 v[80:83], v[44:47], a[116:119], v[80:83]
  v_mfma_f32_16x16x32_bf16 v[84:87], v[44:47], a[140:143], v[84:87]
  v_mfma_f32_16x16x32_bf16 v[88:91], v[44:47], a[164:167], v[88:91]
  v_mfma_f32_16x16x32_bf16 v[92:95], v[44:47], a[188:191], v[92:95]
  v_mfma_f32_16x16x32_bf16 v[96:99], v[44:47], a[212:215], v[96:99]
  v_mfma_f32_16x16x32_bf16 v[100:103], v[44:47], a[236:239], v[100:103]
  s_cmp_eq_u32 s54, 2
  s_cselect_b32 s61, -1, 0
  s_mov_b32 s60, -1
  s_cselect_b32 s58, 3, 1
  s_lshl_b32 s57, s55, 3
  s_and_b32 s21, s2, 7
  s_add_u32 s57, s57, s21
  s_lshl_b32 s57, s57, 7
  s_add_u32 s57, s57, 22528
  s_add_u32 s55, s55, s54
  v_cvt_pk_bf16_f32 v48, v64, v65
  v_cvt_pk_bf16_f32 v49, v66, v67
  v_cvt_pk_bf16_f32 v50, v68, v69
  v_cvt_pk_bf16_f32 v51, v70, v71
  v_cvt_pk_bf16_f32 v52, v72, v73
  v_cvt_pk_bf16_f32 v53, v74, v75
  v_cvt_pk_bf16_f32 v54, v76, v77
  v_cvt_pk_bf16_f32 v55, v78, v79
  v_cvt_pk_bf16_f32 v56, v80, v81
  v_cvt_pk_bf16_f32 v57, v82, v83
  v_cvt_pk_bf16_f32 v58, v84, v85
  v_cvt_pk_bf16_f32 v59, v86, v87
  v_cvt_pk_bf16_f32 v60, v88, v89
  v_cvt_pk_bf16_f32 v61, v90, v91
  v_cvt_pk_bf16_f32 v62, v92, v93
  v_cvt_pk_bf16_f32 v63, v94, v95
  v_cvt_pk_bf16_f32 v240, v96, v97
  v_cvt_pk_bf16_f32 v241, v98, v99
  v_cvt_pk_bf16_f32 v242, v100, v101
  v_cvt_pk_bf16_f32 v243, v102, v103
  v_min_u32 v48, -2, v48
  v_min_u32 v52, -2, v52
  v_min_u32 v56, -2, v56
  v_min_u32 v60, -2, v60
  v_min_u32 v240, -2, v240
  s_mov_b64 exec, s[60:61]
  buffer_store_dwordx4 v[48:51], v15, s[80:83], s63 offen offset:0 sc1
  buffer_store_dwordx4 v[52:55], v15, s[80:83], s63 offen offset:512 sc1
  buffer_store_dwordx4 v[56:59], v15, s[80:83], s63 offen offset:1024 sc1
  buffer_store_dwordx4 v[60:63], v15, s[80:83], s63 offen offset:1536 sc1
  buffer_store_dwordx4 v[240:243], v15, s[80:83], s63 offen offset:2048 sc1
  s_mov_b64 exec, -1
  s_add_u32 s63, s63, 655360
  s_add_u32 s21, s55, 4
  s_cmp_gt_u32 s21, s56
  s_cbranch_scc1 ux_249
  s_add_u32 s62, s62, 196608
  buffer_load_dwordx4 v[24:27], v18, s[76:79], s62 offen offset:0 sc1
  buffer_load_dwordx4 v[28:31], v18, s[76:79], s62 offen offset:512 sc1
  buffer_load_dwordx4 v[32:35], v18, s[76:79], s62 offen offset:1024 sc1
  buffer_load_dwordx4 v[36:39], v18, s[76:79], s62 offen offset:1536 sc1
  buffer_load_dwordx4 v[40:43], v18, s[76:79], s62 offen offset:2048 sc1
  buffer_load_dwordx4 v[44:47], v18, s[76:79], s62 offen offset:2560 sc1
  s_waitcnt vmcnt(11)
  s_cmp_eq_u32 s66, 0
  s_cbranch_scc1 uf_253
  s_mov_b64 exec, s[66:67]
  buffer_atomic_add v11, v17, s[72:75], s65 offen sc1
  s_mov_b64 exec, -1
  s_mov_b32 s66, 0
uf_253:
  s_mov_b32 s65, s57
  s_mov_b32 s66, s58
  s_mov_b32 s58, 0
  v_mfma_f32_16x16x32_bf16 v[64:67], a[240:243], a[0:3], 0
  v_mfma_f32_16x16x32_bf16 v[68:71], a[240:243], a[24:27], 0
  v_mfma_f32_16x16x32_bf16 v[72:75], a[240:243], a[48:51], 0
  v_mfma_f32_16x16x32_bf16 v[76:79], a[240:243], a[72:75], 0
  v_mfma_f32_16x16x32_bf16 v[80:83], a[240:243], a[96:99], 0
  v_mfma_f32_16x16x32_bf16 v[84:87], a[240:243], a[120:123], 0
  v_mfma_f32_16x16x32_bf16 v[88:91], a[240:243], a[144:147], 0
  v_mfma_f32_16x16x32_bf16 v[92:95], a[240:243], a[168:171], 0
  v_mfma_f32_16x16x32_bf16 v[96:99], a[240:243], a[192:195], 0
  v_mfma_f32_16x16x32_bf16 v[100:103], a[240:243], a[216:219], 0
  v_mfma_f32_16x16x32_bf16 v[64:67], a[244:247], a[4:7], v[64:67]
  v_mfma_f32_16x16x32_bf16 v[68:71], a[244:247], a[28:31], v[68:71]
  v_mfma_f32_16x16x32_bf16 v[72:75], a[244:247], a[52:55], v[72:75]
  v_mfma_f32_16x16x32_bf16 v[76:79], a[244:247], a[76:79], v[76:79]
  v_mfma_f32_16x16x32_bf16 v[80:83], a[244:247], a[100:103], v[80:83]
  v_mfma_f32_16x16x32_bf16 v[84:87], a[244:247], a[124:127], v[84:87]
  v_mfma_f32_16x16x32_bf16 v[88:91], a[244:247], a[148:151], v[88:91]
  v_mfma_f32_16x16x32_bf16 v[92:95], a[244:247], a[172:175], v[92:95]
  v_mfma_f32_16x16x32_bf16 v[96:99], a[244:247], a[196:199], v[96:99]
  v_mfma_f32_16x16x32_bf16 v[100:103], a[244:247], a[220:223], v[100:103]
  v_mfma_f32_16x16x32_bf16 v[64:67], a[248:251], a[8:11], v[64:67]
  v_mfma_f32_16x16x32_bf16 v[68:71], a[248:251], a[32:35], v[68:71]
  v_mfma_f32_16x16x32_bf16 v[72:75], a[248:251], a[56:59], v[72:75]
  v_mfma_f32_16x16x32_bf16 v[76:79], a[248:251], a[80:83], v[76:79]
  v_mfma_f32_16x16x32_bf16 v[80:83], a[248:251], a[104:107], v[80:83]
  v_mfma_f32_16x16x32_bf16 v[84:87], a[248:251], a[128:131], v[84:87]
  v_mfma_f32_16x16x32_bf16 v[88:91], a[248:251], a[152:155], v[88:91]
  v_mfma_f32_16x16x32_bf16 v[92:95], a[248:251], a[176:179], v[92:95]
  v_mfma_f32_16x16x32_bf16 v[96:99], a[248:251], a[200:203], v[96:99]
  v_mfma_f32_16x16x32_bf16 v[100:103], a[248:251], a[224:227], v[100:103]
  v_mfma_f32_16x16x32_bf16 v[64:67], a[252:255], a[12:15], v[64:67]
  v_mfma_f32_16x16x32_bf16 v[68:71], a[252:255], a[36:39], v[68:71]
  v_mfma_f32_16x16x32_bf16 v[72:75], a[252:255], a[60:63], v[72:75]
  v_mfma_f32_16x16x32_bf16 v[76:79], a[252:255], a[84:87], v[76:79]
  v_mfma_f32_16x16x32_bf16 v[80:83], a[252:255], a[108:111], v[80:83]
  v_mfma_f32_16x16x32_bf16 v[84:87], a[252:255], a[132:135], v[84:87]
  v_mfma_f32_16x16x32_bf16 v[88:91], a[252:255], a[156:159], v[88:91]
  v_mfma_f32_16x16x32_bf16 v[92:95], a[252:255], a[180:183], v[92:95]
  v_mfma_f32_16x16x32_bf16 v[96:99], a[252:255], a[204:207], v[96:99]
  v_mfma_f32_16x16x32_bf16 v[100:103], a[252:255], a[228:231], v[100:103]
  v_mfma_f32_16x16x32_bf16 v[64:67], v[248:251], a[16:19], v[64:67]
  v_mfma_f32_16x16x32_bf16 v[68:71], v[248:251], a[40:43], v[68:71]
  v_mfma_f32_16x16x32_bf16 v[72:75], v[248:251], a[64:67], v[72:75]
  v_mfma_f32_16x16x32_bf16 v[76:79], v[248:251], a[88:91], v[76:79]
  v_mfma_f32_16x16x32_bf16 v[80:83], v[248:251], a[112:115], v[80:83]
  v_mfma_f32_16x16x32_bf16 v[84:87], v[248:251], a[136:139], v[84:87]
  v_mfma_f32_16x16x32_bf16 v[88:91], v[248:251], a[160:163], v[88:91]
  v_mfma_f32_16x16x32_bf16 v[92:95], v[248:251], a[184:187], v[92:95]
  v_mfma_f32_16x16x32_bf16 v[96:99], v[248:251], a[208:211], v[96:99]
  v_mfma_f32_16x16x32_bf16 v[100:103], v[248:251], a[232:235], v[100:103]
  v_mfma_f32_16x16x32_bf16 v[64:67], v[252:255], a[20:23], v[64:67]
  v_mfma_f32_16x16x32_bf16 v[68:71], v[252:255], a[44:47], v[68:71]
  v_mfma_f32_16x16x32_bf16 v[72:75], v[252:255], a[68:71], v[72:75]
  v_mfma_f32_16x16x32_bf16 v[76:79], v[252:255], a[92:95], v[76:79]
  v_mfma_f32_16x16x32_bf16 v[80:83], v[252:255], a[116:119], v[80:83]
  v_mfma_f32_16x16x32_bf16 v[84:87], v[252:255], a[140:143], v[84:87]
  v_mfma_f32_16x16x32_bf16 v[88:91], v[252:255], a[164:167], v[88:91]
  v_mfma_f32_16x16x32_bf16 v[92:95], v[252:255], a[188:191], v[92:95]
  v_mfma_f32_16x16x32_bf16 v[96:99], v[252:255], a[212:215], v[96:99]
  v_mfma_f32_16x16x32_bf16 v[100:103], v[252:255], a[236:239], v[100:103]
  s_cmp_eq_u32 s54, 2
  s_cselect_b32 s61, -1, 0
  s_mov_b32 s60, -1
  s_cselect_b32 s58, 3, 1
  s_lshl_b32 s57, s55, 3
  s_and_b32 s21, s2, 7
  s_add_u32 s57, s57, s21
  s_lshl_b32 s57, s57, 7
  s_add_u32 s57, s57, 22528
  s_add_u32 s55, s55, s54
  v_cvt_pk_bf16_f32 v48, v64, v65
  v_cvt_pk_bf16_f32 v49, v66, v67
  v_cvt_pk_bf16_f32 v50, v68, v69
  v_cvt_pk_bf16_f32 v51, v70, v71
  v_cvt_pk_bf16_f32 v52, v72, v73
  v_cvt_pk_bf16_f32 v53, v74, v75
  v_cvt_pk_bf16_f32 v54, v76, v77
  v_cvt_pk_bf16_f32 v55, v78, v79
  v_cvt_pk_bf16_f32 v56, v80, v81
  v_cvt_pk_bf16_f32 v57, v82, v83
  v_cvt_pk_bf16_f32 v58, v84, v85
  v_cvt_pk_bf16_f32 v59, v86, v87
  v_cvt_pk_bf16_f32 v60, v88, v89
  v_cvt_pk_bf16_f32 v61, v90, v91
  v_cvt_pk_bf16_f32 v62, v92, v93
  v_cvt_pk_bf16_f32 v63, v94, v95
  v_cvt_pk_bf16_f32 v240, v96, v97
  v_cvt_pk_bf16_f32 v241, v98, v99
  v_cvt_pk_bf16_f32 v242, v100, v101
  v_cvt_pk_bf16_f32 v243, v102, v103
  v_min_u32 v48, -2, v48
  v_min_u32 v52, -2, v52
  v_min_u32 v56, -2, v56
  v_min_u32 v60, -2, v60
  v_min_u32 v240, -2, v240
  s_mov_b64 exec, s[60:61]
  buffer_store_dwordx4 v[48:51], v15, s[80:83], s63 offen offset:0 sc1
  buffer_store_dwordx4 v[52:55], v15, s[80:83], s63 offen offset:512 sc1
  buffer_store_dwordx4 v[56:59], v15, s[80:83], s63 offen offset:1024 sc1
  buffer_store_dwordx4 v[60:63], v15, s[80:83], s63 offen offset:1536 sc1
  buffer_store_dwordx4 v[240:243], v15, s[80:83], s63 offen offset:2048 sc1
  s_mov_b64 exec, -1
  s_add_u32 s63, s63, 655360
  s_branch uf_248
ux_250:
  s_waitcnt vmcnt(0)
  s_cmp_eq_u32 s66, 0
  s_cbranch_scc1 uf_254
  s_mov_b64 exec, s[66:67]
  buffer_atomic_add v11, v17, s[72:75], s65 offen sc1
  s_mov_b64 exec, -1
  s_mov_b32 s66, 0
uf_254:
  s_cmp_eq_u32 s58, 0
  s_cbranch_scc1 uf_255
  s_mov_b64 exec, s[58:59]
  buffer_atomic_add v11, v17, s[72:75], s57 offen sc1
  s_mov_b64 exec, -1
  s_mov_b32 s58, 0
uf_255:
  v_mfma_f32_16x16x32_bf16 v[64:67], v[24:27], a[0:3], 0
  v_mfma_f32_16x16x32_bf16 v[68:71], v[24:27], a[24:27], 0
  v_mfma_f32_16x16x32_bf16 v[72:75], v[24:27], a[48:51], 0
  v_mfma_f32_16x16x32_bf16 v[76:79], v[24:27], a[72:75], 0
  v_mfma_f32_16x16x32_bf16 v[80:83], v[24:27], a[96:99], 0
  v_mfma_f32_16x16x32_bf16 v[84:87], v[24:27], a[120:123], 0
  v_mfma_f32_16x16x32_bf16 v[88:91], v[24:27], a[144:147], 0
  v_mfma_f32_16x16x32_bf16 v[92:95], v[24:27], a[168:171], 0
  v_mfma_f32_16x16x32_bf16 v[96:99], v[24:27], a[192:195], 0
  v_mfma_f32_16x16x32_bf16 v[100:103], v[24:27], a[216:219], 0
  v_mfma_f32_16x16x32_bf16 v[64:67], v[28:31], a[4:7], v[64:67]
  v_mfma_f32_16x16x32_bf16 v[68:71], v[28:31], a[28:31], v[68:71]
  v_mfma_f32_16x16x32_bf16 v[72:75], v[28:31], a[52:55], v[72:75]
  v_mfma_f32_16x16x32_bf16 v[76:79], v[28:31], a[76:79], v[76:79]
  v_mfma_f32_16x16x32_bf16 v[80:83], v[28:31], a[100:103], v[80:83]
  v_mfma_f32_16x16x32_bf16 v[84:87], v[28:31], a[124:127], v[84:87]
  v_mfma_f32_16x16x32_bf16 v[88:91], v[28:31], a[148:151], v[88:91]
  v_mfma_f32_16x16x32_bf16 v[92:95], v[28:31], a[172:175], v[92:95]
  v_mfma_f32_16x16x32_bf16 v[96:99], v[28:31], a[196:199], v[96:99]
  v_mfma_f32_16x16x32_bf16 v[100:103], v[28:31], a[220:223], v[100:103]
  v_mfma_f32_16x16x32_bf16 v[64:67], v[32:35], a[8:11], v[64:67]
  v_mfma_f32_16x16x32_bf16 v[68:71], v[32:35], a[32:35], v[68:71]
  v_mfma_f32_16x16x32_bf16 v[72:75], v[32:35], a[56:59], v[72:75]
  v_mfma_f32_16x16x32_bf16 v[76:79], v[32:35], a[80:83], v[76:79]
  v_mfma_f32_16x16x32_bf16 v[80:83], v[32:35], a[104:107], v[80:83]
  v_mfma_f32_16x16x32_bf16 v[84:87], v[32:35], a[128:131], v[84:87]
  v_mfma_f32_16x16x32_bf16 v[88:91], v[32:35], a[152:155], v[88:91]
  v_mfma_f32_16x16x32_bf16 v[92:95], v[32:35], a[176:179], v[92:95]
  v_mfma_f32_16x16x32_bf16 v[96:99], v[32:35], a[200:203], v[96:99]
  v_mfma_f32_16x16x32_bf16 v[100:103], v[32:35], a[224:227], v[100:103]
  v_mfma_f32_16x16x32_bf16 v[64:67], v[36:39], a[12:15], v[64:67]
  v_mfma_f32_16x16x32_bf16 v[68:71], v[36:39], a[36:39], v[68:71]
  v_mfma_f32_16x16x32_bf16 v[72:75], v[36:39], a[60:63], v[72:75]
  v_mfma_f32_16x16x32_bf16 v[76:79], v[36:39], a[84:87], v[76:79]
  v_mfma_f32_16x16x32_bf16 v[80:83], v[36:39], a[108:111], v[80:83]
  v_mfma_f32_16x16x32_bf16 v[84:87], v[36:39], a[132:135], v[84:87]
  v_mfma_f32_16x16x32_bf16 v[88:91], v[36:39], a[156:159], v[88:91]
  v_mfma_f32_16x16x32_bf16 v[92:95], v[36:39], a[180:183], v[92:95]
  v_mfma_f32_16x16x32_bf16 v[96:99], v[36:39], a[204:207], v[96:99]
  v_mfma_f32_16x16x32_bf16 v[100:103], v[36:39], a[228:231], v[100:103]
  v_mfma_f32_16x16x32_bf16 v[64:67], v[40:43], a[16:19], v[64:67]
  v_mfma_f32_16x16x32_bf16 v[68:71], v[40:43], a[40:43], v[68:71]
  v_mfma_f32_16x16x32_bf16 v[72:75], v[40:43], a[64:67], v[72:75]
  v_mfma_f32_16x16x32_bf16 v[76:79], v[40:43], a[88:91], v[76:79]
  v_mfma_f32_16x16x32_bf16 v[80:83], v[40:43], a[112:115], v[80:83]
  v_mfma_f32_16x16x32_bf16 v[84:87], v[40:43], a[136:139], v[84:87]
  v_mfma_f32_16x16x32_bf16 v[88:91], v[40:43], a[160:163], v[88:91]
  v_mfma_f32_16x16x32_bf16 v[92:95], v[40:43], a[184:187], v[92:95]
  v_mfma_f32_16x16x32_bf16 v[96:99], v[40:43], a[208:211], v[96:99]
  v_mfma_f32_16x16x32_bf16 v[100:103], v[40:43], a[232:235], v[100:103]
  v_mfma_f32_16x16x32_bf16 v[64:67], v[44:47], a[20:23], v[64:67]
  v_mfma_f32_16x16x32_bf16 v[68:71], v[44:47], a[44:47], v[68:71]
  v_mfma_f32_16x16x32_bf16 v[72:75], v[44:47], a[68:71], v[72:75]
  v_mfma_f32_16x16x32_bf16 v[76:79], v[44:47], a[92:95], v[76:79]
  v_mfma_f32_16x16x32_bf16 v[80:83], v[44:47], a[116:119], v[80:83]
  v_mfma_f32_16x16x32_bf16 v[84:87], v[44:47], a[140:143], v[84:87]
  v_mfma_f32_16x16x32_bf16 v[88:91], v[44:47], a[164:167], v[88:91]
  v_mfma_f32_16x16x32_bf16 v[92:95], v[44:47], a[188:191], v[92:95]
  v_mfma_f32_16x16x32_bf16 v[96:99], v[44:47], a[212:215], v[96:99]
  v_mfma_f32_16x16x32_bf16 v[100:103], v[44:47], a[236:239], v[100:103]
  s_cmp_eq_u32 s54, 2
  s_cselect_b32 s61, -1, 0
  s_mov_b32 s60, -1
  s_cselect_b32 s58, 3, 1
  s_lshl_b32 s57, s55, 3
  s_and_b32 s21, s2, 7
  s_add_u32 s57, s57, s21
  s_lshl_b32 s57, s57, 7
  s_add_u32 s57, s57, 22528
  s_add_u32 s55, s55, s54
  v_cvt_pk_bf16_f32 v48, v64, v65
  v_cvt_pk_bf16_f32 v49, v66, v67
  v_cvt_pk_bf16_f32 v50, v68, v69
  v_cvt_pk_bf16_f32 v51, v70, v71
  v_cvt_pk_bf16_f32 v52, v72, v73
  v_cvt_pk_bf16_f32 v53, v74, v75
  v_cvt_pk_bf16_f32 v54, v76, v77
  v_cvt_pk_bf16_f32 v55, v78, v79
  v_cvt_pk_bf16_f32 v56, v80, v81
  v_cvt_pk_bf16_f32 v57, v82, v83
  v_cvt_pk_bf16_f32 v58, v84, v85
  v_cvt_pk_bf16_f32 v59, v86, v87
  v_cvt_pk_bf16_f32 v60, v88, v89
  v_cvt_pk_bf16_f32 v61, v90, v91
  v_cvt_pk_bf16_f32 v62, v92, v93
  v_cvt_pk_bf16_f32 v63, v94, v95
  v_cvt_pk_bf16_f32 v240, v96, v97
  v_cvt_pk_bf16_f32 v241, v98, v99
  v_cvt_pk_bf16_f32 v242, v100, v101
  v_cvt_pk_bf16_f32 v243, v102, v103
  v_min_u32 v48, -2, v48
  v_min_u32 v52, -2, v52
  v_min_u32 v56, -2, v56
  v_min_u32 v60, -2, v60
  v_min_u32 v240, -2, v240
  s_mov_b64 exec, s[60:61]
  buffer_store_dwordx4 v[48:51], v15, s[80:83], s63 offen offset:0 sc1
  buffer_store_dwordx4 v[52:55], v15, s[80:83], s63 offen offset:512 sc1
  buffer_store_dwordx4 v[56:59], v15, s[80:83], s63 offen offset:1024 sc1
  buffer_store_dwordx4 v[60:63], v15, s[80:83], s63 offen offset:1536 sc1
  buffer_store_dwordx4 v[240:243], v15, s[80:83], s63 offen offset:2048 sc1
  s_mov_b64 exec, -1
  s_add_u32 s63, s63, 655360
  s_branch ul_240
ux_249:
  s_waitcnt vmcnt(0)
  s_cmp_eq_u32 s66, 0
  s_cbranch_scc1 uf_256
  s_mov_b64 exec, s[66:67]
  buffer_atomic_add v11, v17, s[72:75], s65 offen sc1
  s_mov_b64 exec, -1
  s_mov_b32 s66, 0
uf_256:
  s_cmp_eq_u32 s58, 0
  s_cbranch_scc1 uf_257
  s_mov_b64 exec, s[58:59]
  buffer_atomic_add v11, v17, s[72:75], s57 offen sc1
  s_mov_b64 exec, -1
  s_mov_b32 s58, 0
uf_257:
  v_mfma_f32_16x16x32_bf16 v[64:67], a[240:243], a[0:3], 0
  v_mfma_f32_16x16x32_bf16 v[68:71], a[240:243], a[24:27], 0
  v_mfma_f32_16x16x32_bf16 v[72:75], a[240:243], a[48:51], 0
  v_mfma_f32_16x16x32_bf16 v[76:79], a[240:243], a[72:75], 0
  v_mfma_f32_16x16x32_bf16 v[80:83], a[240:243], a[96:99], 0
  v_mfma_f32_16x16x32_bf16 v[84:87], a[240:243], a[120:123], 0
  v_mfma_f32_16x16x32_bf16 v[88:91], a[240:243], a[144:147], 0
  v_mfma_f32_16x16x32_bf16 v[92:95], a[240:243], a[168:171], 0
  v_mfma_f32_16x16x32_bf16 v[96:99], a[240:243], a[192:195], 0
  v_mfma_f32_16x16x32_bf16 v[100:103], a[240:243], a[216:219], 0
  v_mfma_f32_16x16x32_bf16 v[64:67], a[244:247], a[4:7], v[64:67]
  v_mfma_f32_16x16x32_bf16 v[68:71], a[244:247], a[28:31], v[68:71]
  v_mfma_f32_16x16x32_bf16 v[72:75], a[244:247], a[52:55], v[72:75]
  v_mfma_f32_16x16x32_bf16 v[76:79], a[244:247], a[76:79], v[76:79]
  v_mfma_f32_16x16x32_bf16 v[80:83], a[244:247], a[100:103], v[80:83]
  v_mfma_f32_16x16x32_bf16 v[84:87], a[244:247], a[124:127], v[84:87]
  v_mfma_f32_16x16x32_bf16 v[88:91], a[244:247], a[148:151], v[88:91]
  v_mfma_f32_16x16x32_bf16 v[92:95], a[244:247], a[172:175], v[92:95]
  v_mfma_f32_16x16x32_bf16 v[96:99], a[244:247], a[196:199], v[96:99]
  v_mfma_f32_16x16x32_bf16 v[100:103], a[244:247], a[220:223], v[100:103]
  v_mfma_f32_16x16x32_bf16 v[64:67], a[248:251], a[8:11], v[64:67]
  v_mfma_f32_16x16x32_bf16 v[68:71], a[248:251], a[32:35], v[68:71]
  v_mfma_f32_16x16x32_bf16 v[72:75], a[248:251], a[56:59], v[72:75]
  v_mfma_f32_16x16x32_bf16 v[76:79], a[248:251], a[80:83], v[76:79]
  v_mfma_f32_16x16x32_bf16 v[80:83], a[248:251], a[104:107], v[80:83]
  v_mfma_f32_16x16x32_bf16 v[84:87], a[248:251], a[128:131], v[84:87]
  v_mfma_f32_16x16x32_bf16 v[88:91], a[248:251], a[152:155], v[88:91]
  v_mfma_f32_16x16x32_bf16 v[92:95], a[248:251], a[176:179], v[92:95]
  v_mfma_f32_16x16x32_bf16 v[96:99], a[248:251], a[200:203], v[96:99]
  v_mfma_f32_16x16x32_bf16 v[100:103], a[248:251], a[224:227], v[100:103]
  v_mfma_f32_16x16x32_bf16 v[64:67], a[252:255], a[12:15], v[64:67]
  v_mfma_f32_16x16x32_bf16 v[68:71], a[252:255], a[36:39], v[68:71]
  v_mfma_f32_16x16x32_bf16 v[72:75], a[252:255], a[60:63], v[72:75]
  v_mfma_f32_16x16x32_bf16 v[76:79], a[252:255], a[84:87], v[76:79]
  v_mfma_f32_16x16x32_bf16 v[80:83], a[252:255], a[108:111], v[80:83]
  v_mfma_f32_16x16x32_bf16 v[84:87], a[252:255], a[132:135], v[84:87]
  v_mfma_f32_16x16x32_bf16 v[88:91], a[252:255], a[156:159], v[88:91]
  v_mfma_f32_16x16x32_bf16 v[92:95], a[252:255], a[180:183], v[92:95]
  v_mfma_f32_16x16x32_bf16 v[96:99], a[252:255], a[204:207], v[96:99]
  v_mfma_f32_16x16x32_bf16 v[100:103], a[252:255], a[228:231], v[100:103]
  v_mfma_f32_16x16x32_bf16 v[64:67], v[248:251], a[16:19], v[64:67]
  v_mfma_f32_16x16x32_bf16 v[68:71], v[248:251], a[40:43], v[68:71]
  v_mfma_f32_16x16x32_bf16 v[72:75], v[248:251], a[64:67], v[72:75]
  v_mfma_f32_16x16x32_bf16 v[76:79], v[248:251], a[88:91], v[76:79]
  v_mfma_f32_16x16x32_bf16 v[80:83], v[248:251], a[112:115], v[80:83]
  v_mfma_f32_16x16x32_bf16 v[84:87], v[248:251], a[136:139], v[84:87]
  v_mfma_f32_16x16x32_bf16 v[88:91], v[248:251], a[160:163], v[88:91]
  v_mfma_f32_16x16x32_bf16 v[92:95], v[248:251], a[184:187], v[92:95]
  v_mfma_f32_16x16x32_bf16 v[96:99], v[248:251], a[208:211], v[96:99]
  v_mfma_f32_16x16x32_bf16 v[100:103], v[248:251], a[232:235], v[100:103]
  v_mfma_f32_16x16x32_bf16 v[64:67], v[252:255], a[20:23], v[64:67]
  v_mfma_f32_16x16x32_bf16 v[68:71], v[252:255], a[44:47], v[68:71]
  v_mfma_f32_16x16x32_bf16 v[72:75], v[252:255], a[68:71], v[72:75]
  v_mfma_f32_16x16x32_bf16 v[76:79], v[252:255], a[92:95], v[76:79]
  v_mfma_f32_16x16x32_bf16 v[80:83], v[252:255], a[116:119], v[80:83]
  v_mfma_f32_16x16x32_bf16 v[84:87], v[252:255], a[140:143], v[84:87]
  v_mfma_f32_16x16x32_bf16 v[88:91], v[252:255], a[164:167], v[88:91]
  v_mfma_f32_16x16x32_bf16 v[92:95], v[252:255], a[188:191], v[92:95]
  v_mfma_f32_16x16x32_bf16 v[96:99], v[252:255], a[212:215], v[96:99]
  v_mfma_f32_16x16x32_bf16 v[100:103], v[252:255], a[236:239], v[100:103]
  s_cmp_eq_u32 s54, 2
  s_cselect_b32 s61, -1, 0
  s_mov_b32 s60, -1
  s_cselect_b32 s58, 3, 1
  s_lshl_b32 s57, s55, 3
  s_and_b32 s21, s2, 7
  s_add_u32 s57, s57, s21
  s_lshl_b32 s57, s57, 7
  s_add_u32 s57, s57, 22528
  s_add_u32 s55, s55, s54
  v_cvt_pk_bf16_f32 v48, v64, v65
  v_cvt_pk_bf16_f32 v49, v66, v67
  v_cvt_pk_bf16_f32 v50, v68, v69
  v_cvt_pk_bf16_f32 v51, v70, v71
  v_cvt_pk_bf16_f32 v52, v72, v73
  v_cvt_pk_bf16_f32 v53, v74, v75
  v_cvt_pk_bf16_f32 v54, v76, v77
  v_cvt_pk_bf16_f32 v55, v78, v79
  v_cvt_pk_bf16_f32 v56, v80, v81
  v_cvt_pk_bf16_f32 v57, v82, v83
  v_cvt_pk_bf16_f32 v58, v84, v85
  v_cvt_pk_bf16_f32 v59, v86, v87
  v_cvt_pk_bf16_f32 v60, v88, v89
  v_cvt_pk_bf16_f32 v61, v90, v91
  v_cvt_pk_bf16_f32 v62, v92, v93
  v_cvt_pk_bf16_f32 v63, v94, v95
  v_cvt_pk_bf16_f32 v240, v96, v97
  v_cvt_pk_bf16_f32 v241, v98, v99
  v_cvt_pk_bf16_f32 v242, v100, v101
  v_cvt_pk_bf16_f32 v243, v102, v103
  v_min_u32 v48, -2, v48
  v_min_u32 v52, -2, v52
  v_min_u32 v56, -2, v56
  v_min_u32 v60, -2, v60
  v_min_u32 v240, -2, v240
  s_mov_b64 exec, s[60:61]
  buffer_store_dwordx4 v[48:51], v15, s[80:83], s63 offen offset:0 sc1
  buffer_store_dwordx4 v[52:55], v15, s[80:83], s63 offen offset:512 sc1
  buffer_store_dwordx4 v[56:59], v15, s[80:83], s63 offen offset:1024 sc1
  buffer_store_dwordx4 v[60:63], v15, s[80:83], s63 offen offset:1536 sc1
  buffer_store_dwordx4 v[240:243], v15, s[80:83], s63 offen offset:2048 sc1
  s_mov_b64 exec, -1
  s_add_u32 s63, s63, 655360
  s_branch ul_240
uo_247:
  s_sub_u32 s21, s56, s55
  s_cmp_ge_u32 s21, 2
  s_cselect_b64 vcc, -1, 0
  s_cselect_b32 s54, 2, 1
  v_cndmask_b32 v18, v13, v14, vcc
  s_lshl_b32 s21, s55, 5
  s_add_u32 s21, s21, s2
  s_mul_i32 s62, s21, 3072
  s_mul_i32 s63, s21, 10240
  s_mul_i32 s22, s20, 2560
  s_add_u32 s63, s63, s22
  buffer_load_dwordx4 a[240:243], v18, s[76:79], s62 offen offset:0 sc1
  buffer_load_dwordx4 a[244:247], v18, s[76:79], s62 offen offset:512 sc1
  buffer_load_dwordx4 a[248:251], v18, s[76:79], s62 offen offset:1024 sc1
  buffer_load_dwordx4 a[252:255], v18, s[76:79], s62 offen offset:1536 sc1
  buffer_load_dwordx4 v[248:251], v18, s[76:79], s62 offen offset:2048 sc1
  buffer_load_dwordx4 v[252:255], v18, s[76:79], s62 offen offset:2560 sc1
  s_waitcnt vmcnt(0)
  s_cmp_eq_u32 s58, 0
  s_cbranch_scc1 uf_258
  s_mov_b64 exec, s[58:59]
  buffer_atomic_add v11, v17, s[72:75], s57 offen sc1
  s_mov_b64 exec, -1
  s_mov_b32 s58, 0
uf_258:
  v_mfma_f32_16x16x32_bf16 v[64:67], a[240:243], a[0:3], 0
  v_mfma_f32_16x16x32_bf16 v[68:71], a[240:243], a[24:27], 0
  v_mfma_f32_16x16x32_bf16 v[72:75], a[240:243], a[48:51], 0
  v_mfma_f32_16x16x32_bf16 v[76:79], a[240:243], a[72:75], 0
  v_mfma_f32_16x16x32_bf16 v[80:83], a[240:243], a[96:99], 0
  v_mfma_f32_16x16x32_bf16 v[84:87], a[240:243], a[120:123], 0
  v_mfma_f32_16x16x32_bf16 v[88:91], a[240:243], a[144:147], 0
  v_mfma_f32_16x16x32_bf16 v[92:95], a[240:243], a[168:171], 0
  v_mfma_f32_16x16x32_bf16 v[96:99], a[240:243], a[192:195], 0
  v_mfma_f32_16x16x32_bf16 v[100:103], a[240:243], a[216:219], 0
  v_mfma_f32_16x16x32_bf16 v[64:67], a[244:247], a[4:7], v[64:67]
  v_mfma_f32_16x16x32_bf16 v[68:71], a[244:247], a[28:31], v[68:71]
  v_mfma_f32_16x16x32_bf16 v[72:75], a[244:247], a[52:55], v[72:75]
  v_mfma_f32_16x16x32_bf16 v[76:79], a[244:247], a[76:79], v[76:79]
  v_mfma_f32_16x16x32_bf16 v[80:83], a[244:247], a[100:103], v[80:83]
  v_mfma_f32_16x16x32_bf16 v[84:87], a[244:247], a[124:127], v[84:87]
  v_mfma_f32_16x16x32_bf16 v[88:91], a[244:247], a[148:151], v[88:91]
  v_mfma_f32_16x16x32_bf16 v[92:95], a[244:247], a[172:175], v[92:95]
  v_mfma_f32_16x16x32_bf16 v[96:99], a[244:247], a[196:199], v[96:99]
  v_mfma_f32_16x16x32_bf16 v[100:103], a[244:247], a[220:223], v[100:103]
  v_mfma_f32_16x16x32_bf16 v[64:67], a[248:251], a[8:11], v[64:67]
  v_mfma_f32_16x16x32_bf16 v[68:71], a[248:251], a[32:35], v[68:71]
  v_mfma_f32_16x16x32_bf16 v[72:75], a[248:251], a[56:59], v[72:75]
  v_mfma_f32_16x16x32_bf16 v[76:79], a[248:251], a[80:83], v[76:79]
  v_mfma_f32_16x16x32_bf16 v[80:83], a[248:251], a[104:107], v[80:83]
  v_mfma_f32_16x16x32_bf16 v[84:87], a[248:251], a[128:131], v[84:87]
  v_mfma_f32_16x16x32_bf16 v[88:91], a[248:251], a[152:155], v[88:91]
  v_mfma_f32_16x16x32_bf16 v[92:95], a[248:251], a[176:179], v[92:95]
  v_mfma_f32_16x16x32_bf16 v[96:99], a[248:251], a[200:203], v[96:99]
  v_mfma_f32_16x16x32_bf16 v[100:103], a[248:251], a[224:227], v[100:103]
  v_mfma_f32_16x16x32_bf16 v[64:67], a[252:255], a[12:15], v[64:67]
  v_mfma_f32_16x16x32_bf16 v[68:71], a[252:255], a[36:39], v[68:71]
  v_mfma_f32_16x16x32_bf16 v[72:75], a[252:255], a[60:63], v[72:75]
  v_mfma_f32_16x16x32_bf16 v[76:79], a[252:255], a[84:87], v[76:79]
  v_mfma_f32_16x16x32_bf16 v[80:83], a[252:255], a[108:111], v[80:83]
  v_mfma_f32_16x16x32_bf16 v[84:87], a[252:255], a[132:135], v[84:87]
  v_mfma_f32_16x16x32_bf16 v[88:91], a[252:255], a[156:159], v[88:91]
  v_mfma_f32_16x16x32_bf16 v[92:95], a[252:255], a[180:183], v[92:95]
  v_mfma_f32_16x16x32_bf16 v[96:99], a[252:255], a[204:207], v[96:99]
  v_mfma_f32_16x16x32_bf16 v[100:103], a[252:255], a[228:231], v[100:103]
  v_mfma_f32_16x16x32_bf16 v[64:67], v[248:251], a[16:19], v[64:67]
  v_mfma_f32_16x16x32_bf16 v[68:71], v[248:251], a[40:43], v[68:71]
  v_mfma_f32_16x16x32_bf16 v[72:75], v[248:251], a[64:67], v[72:75]
  v_mfma_f32_16x16x32_bf16 v[76:79], v[248:251], a[88:91], v[76:79]
  v_mfma_f32_16x16x32_bf16 v[80:83], v[248:251], a[112:115], v[80:83]
  v_mfma_f32_16x16x32_bf16 v[84:87], v[248:251], a[136:139], v[84:87]
  v_mfma_f32_16x16x32_bf16 v[88:91], v[248:251], a[160:163], v[88:91]
  v_mfma_f32_16x16x32_bf16 v[92:95], v[248:251], a[184:187], v[92:95]
  v_mfma_f32_16x16x32_bf16 v[96:99], v[248:251], a[208:211], v[96:99]
  v_mfma_f32_16x16x32_bf16 v[100:103], v[248:251], a[232:235], v[100:103]
  v_mfma_f32_16x16x32_bf16 v[64:67], v[252:255], a[20:23], v[64:67]
  v_mfma_f32_16x16x32_bf16 v[68:71], v[252:255], a[44:47], v[68:71]
  v_mfma_f32_16x16x32_bf16 v[72:75], v[252:255], a[68:71], v[72:75]
  v_mfma_f32_16x16x32_bf16 v[76:79], v[252:255], a[92:95], v[76:79]
  v_mfma_f32_16x16x32_bf16 v[80:83], v[252:255], a[116:119], v[80:83]
  v_mfma_f32_16x16x32_bf16 v[84:87], v[252:255], a[140:143], v[84:87]
  v_mfma_f32_16x16x32_bf16 v[88:91], v[252:255], a[164:167], v[88:91]
  v_mfma_f32_16x16x32_bf16 v[92:95], v[252:255], a[188:191], v[92:95]
  v_mfma_f32_16x16x32_bf16 v[96:99], v[252:255], a[212:215], v[96:99]
  v_mfma_f32_16x16x32_bf16 v[100:103], v[252:255], a[236:239], v[100:103]
  s_cmp_eq_u32 s54, 2
  s_cselect_b32 s61, -1, 0
  s_mov_b32 s60, -1
  s_cselect_b32 s58, 3, 1
  s_lshl_b32 s57, s55, 3
  s_and_b32 s21, s2, 7
  s_add_u32 s57, s57, s21
  s_lshl_b32 s57, s57, 7
  s_add_u32 s57, s57, 22528
  s_add_u32 s55, s55, s54
  v_cvt_pk_bf16_f32 v48, v64, v65
  v_cvt_pk_bf16_f32 v49, v66, v67
  v_cvt_pk_bf16_f32 v50, v68, v69
  v_cvt_pk_bf16_f32 v51, v70, v71
  v_cvt_pk_bf16_f32 v52, v72, v73
  v_cvt_pk_bf16_f32 v53, v74, v75
  v_cvt_pk_bf16_f32 v54, v76, v77
  v_cvt_pk_bf16_f32 v55, v78, v79
  v_cvt_pk_bf16_f32 v56, v80, v81
  v_cvt_pk_bf16_f32 v57, v82, v83
  v_cvt_pk_bf16_f32 v58, v84, v85
  v_cvt_pk_bf16_f32 v59, v86, v87
  v_cvt_pk_bf16_f32 v60, v88, v89
  v_cvt_pk_bf16_f32 v61, v90, v91
  v_cvt_pk_bf16_f32 v62, v92, v93
  v_cvt_pk_bf16_f32 v63, v94, v95
  v_cvt_pk_bf16_f32 v240, v96, v97
  v_cvt_pk_bf16_f32 v241, v98, v99
  v_cvt_pk_bf16_f32 v242, v100, v101
  v_cvt_pk_bf16_f32 v243, v102, v103
  v_min_u32 v48, -2, v48
  v_min_u32 v52, -2, v52
  v_min_u32 v56, -2, v56
  v_min_u32 v60, -2, v60
  v_min_u32 v240, -2, v240
  s_mov_b64 exec, s[60:61]
  buffer_store_dwordx4 v[48:51], v15, s[80:83], s63 offen offset:0 sc1
  buffer_store_dwordx4 v[52:55], v15, s[80:83], s63 offen offset:512 sc1
  buffer_store_dwordx4 v[56:59], v15, s[80:83], s63 offen offset:1024 sc1
  buffer_store_dwordx4 v[60:63], v15, s[80:83], s63 offen offset:1536 sc1
  buffer_store_dwordx4 v[240:243], v15, s[80:83], s63 offen offset:2048 sc1
  s_mov_b64 exec, -1
  s_branch ul_240
ut_243:
  s_min_u32 s23, s55, 62
  s_add_u32 s56, s55, 1
  s_mov_b32 s54, 1
  s_lshl_b32 s21, s55, 5
  s_add_u32 s21, s21, s2
  s_mul_i32 s62, s21, 3072
  s_mul_i32 s63, s21, 10240
  s_mul_i32 s22, s20, 2560
  s_add_u32 s63, s63, s22
  s_mov_b32 s101, 0
  s_branch utp_260
utp_259:
  s_sleep 3
utp_260:
  buffer_load_dwordx4 v[24:27], v13, s[76:79], s62 offen offset:0 sc1
  buffer_load_dwordx4 v[28:31], v13, s[76:79], s62 offen offset:512 sc1
  buffer_load_dwordx4 v[32:35], v13, s[76:79], s62 offen offset:1024 sc1
  buffer_load_dwordx4 v[36:39], v13, s[76:79], s62 offen offset:1536 sc1
  buffer_load_dwordx4 v[40:43], v13, s[76:79], s62 offen offset:2048 sc1
  buffer_load_dwordx4 v[44:47], v13, s[76:79], s62 offen offset:2560 sc1
  s_add_u32 s101, s101, 1
  s_cmp_gt_u32 s101, 131072
  s_cbranch_scc1 main_end
  s_waitcnt vmcnt(0)
  s_cmp_eq_u32 s58, 0
  s_cbranch_scc1 uf_261
  s_mov_b64 exec, s[58:59]
  buffer_atomic_add v11, v17, s[72:75], s57 offen sc1
  s_mov_b64 exec, -1
  s_mov_b32 s58, 0
uf_261:
  v_max3_u32 v8, v24, v26, v28
  v_max3_u32 v8, v8, v30, v32
  v_max3_u32 v8, v8, v34, v36
  v_max3_u32 v8, v8, v38, v40
  v_max3_u32 v8, v8, v42, v44
  v_max3_u32 v8, v8, v46, v46
  v_cmp_eq_u32 vcc, -1, v8
  s_nop 1
  s_cbranch_vccnz utp_259
  v_mfma_f32_16x16x32_bf16 v[64:67], v[24:27], a[0:3], 0
  v_mfma_f32_16x16x32_bf16 v[68:71], v[24:27], a[24:27], 0
  v_mfma_f32_16x16x32_bf16 v[72:75], v[24:27], a[48:51], 0
  v_mfma_f32_16x16x32_bf16 v[76:79], v[24:27], a[72:75], 0
  v_mfma_f32_16x16x32_bf16 v[80:83], v[24:27], a[96:99], 0
  v_mfma_f32_16x16x32_bf16 v[84:87], v[24:27], a[120:123], 0
  v_mfma_f32_16x16x32_bf16 v[88:91], v[24:27], a[144:147], 0
  v_mfma_f32_16x16x32_bf16 v[92:95], v[24:27], a[168:171], 0
  v_mfma_f32_16x16x32_bf16 v[96:99], v[24:27], a[192:195], 0
  v_mfma_f32_16x16x32_bf16 v[100:103], v[24:27], a[216:219], 0
  v_mfma_f32_16x16x32_bf16 v[64:67], v[28:31], a[4:7], v[64:67]
  v_mfma_f32_16x16x32_bf16 v[68:71], v[28:31], a[28:31], v[68:71]
  v_mfma_f32_16x16x32_bf16 v[72:75], v[28:31], a[52:55], v[72:75]
  v_mfma_f32_16x16x32_bf16 v[76:79], v[28:31], a[76:79], v[76:79]
  v_mfma_f32_16x16x32_bf16 v[80:83], v[28:31], a[100:103], v[80:83]
  v_mfma_f32_16x16x32_bf16 v[84:87], v[28:31], a[124:127], v[84:87]
  v_mfma_f32_16x16x32_bf16 v[88:91], v[28:31], a[148:151], v[88:91]
  v_mfma_f32_16x16x32_bf16 v[92:95], v[28:31], a[172:175], v[92:95]
  v_mfma_f32_16x16x32_bf16 v[96:99], v[28:31], a[196:199], v[96:99]
  v_mfma_f32_16x16x32_bf16 v[100:103], v[28:31], a[220:223], v[100:103]
  v_mfma_f32_16x16x32_bf16 v[64:67], v[32:35], a[8:11], v[64:67]
  v_mfma_f32_16x16x32_bf16 v[68:71], v[32:35], a[32:35], v[68:71]
  v_mfma_f32_16x16x32_bf16 v[72:75], v[32:35], a[56:59], v[72:75]
  v_mfma_f32_16x16x32_bf16 v[76:79], v[32:35], a[80:83], v[76:79]
  v_mfma_f32_16x16x32_bf16 v[80:83], v[32:35], a[104:107], v[80:83]
  v_mfma_f32_16x16x32_bf16 v[84:87], v[32:35], a[128:131], v[84:87]
  v_mfma_f32_16x16x32_bf16 v[88:91], v[32:35], a[152:155], v[88:91]
  v_mfma_f32_16x16x32_bf16 v[92:95], v[32:35], a[176:179], v[92:95]
  v_mfma_f32_16x16x32_bf16 v[96:99], v[32:35], a[200:203], v[96:99]
  v_mfma_f32_16x16x32_bf16 v[100:103], v[32:35], a[224:227], v[100:103]
  v_mfma_f32_16x16x32_bf16 v[64:67], v[36:39], a[12:15], v[64:67]
  v_mfma_f32_16x16x32_bf16 v[68:71], v[36:39], a[36:39], v[68:71]
  v_mfma_f32_16x16x32_bf16 v[72:75], v[36:39], a[60:63], v[72:75]
  v_mfma_f32_16x16x32_bf16 v[76:79], v[36:39], a[84:87], v[76:79]
  v_mfma_f32_16x16x32_bf16 v[80:83], v[36:39], a[108:111], v[80:83]
  v_mfma_f32_16x16x32_bf16 v[84:87], v[36:39], a[132:135], v[84:87]
  v_mfma_f32_16x16x32_bf16 v[88:91], v[36:39], a[156:159], v[88:91]
  v_mfma_f32_16x16x32_bf16 v[92:95], v[36:39], a[180:183], v[92:95]
  v_mfma_f32_16x16x32_bf16 v[96:99], v[36:39], a[204:207], v[96:99]
  v_mfma_f32_16x16x32_bf16 v[100:103], v[36:39], a[228:231], v[100:103]
  v_mfma_f32_16x16x32_bf16 v[64:67], v[40:43], a[16:19], v[64:67]
  v_mfma_f32_16x16x32_bf16 v[68:71], v[40:43], a[40:43], v[68:71]
  v_mfma_f32_16x16x32_bf16 v[72:75], v[40:43], a[64:67], v[72:75]
  v_mfma_f32_16x16x32_bf16 v[76:79], v[40:43], a[88:91], v[76:79]
  v_mfma_f32_16x16x32_bf16 v[80:83], v[40:43], a[112:115], v[80:83]
  v_mfma_f32_16x16x32_bf16 v[84:87], v[40:43], a[136:139], v[84:87]
  v_mfma_f32_16x16x32_bf16 v[88:91], v[40:43], a[160:163], v[88:91]
  v_mfma_f32_16x16x32_bf16 v[92:95], v[40:43], a[184:187], v[92:95]
  v_mfma_f32_16x16x32_bf16 v[96:99], v[40:43], a[208:211], v[96:99]
  v_mfma_f32_16x16x32_bf16 v[100:103], v[40:43], a[232:235], v[100:103]
  v_mfma_f32_16x16x32_bf16 v[64:67], v[44:47], a[20:23], v[64:67]
  v_mfma_f32_16x16x32_bf16 v[68:71], v[44:47], a[44:47], v[68:71]
  v_mfma_f32_16x16x32_bf16 v[72:75], v[44:47], a[68:71], v[72:75]
  v_mfma_f32_16x16x32_bf16 v[76:79], v[44:47], a[92:95], v[76:79]
  v_mfma_f32_16x16x32_bf16 v[80:83], v[44:47], a[116:119], v[80:83]
  v_mfma_f32_16x16x32_bf16 v[84:87], v[44:47], a[140:143], v[84:87]
  v_mfma_f32_16x16x32_bf16 v[88:91], v[44:47], a[164:167], v[88:91]
  v_mfma_f32_16x16x32_bf16 v[92:95], v[44:47], a[188:191], v[92:95]
  v_mfma_f32_16x16x32_bf16 v[96:99], v[44:47], a[212:215], v[96:99]
  v_mfma_f32_16x16x32_bf16 v[100:103], v[44:47], a[236:239], v[100:103]
  s_cmp_eq_u32 s54, 2
  s_cselect_b32 s61, -1, 0
  s_mov_b32 s60, -1
  s_cselect_b32 s58, 3, 1
  s_lshl_b32 s57, s55, 3
  s_and_b32 s21, s2, 7
  s_add_u32 s57, s57, s21
  s_lshl_b32 s57, s57, 7
  s_add_u32 s57, s57, 22528
  s_add_u32 s55, s55, s54
  v_cvt_pk_bf16_f32 v48, v64, v65
  v_cvt_pk_bf16_f32 v49, v66, v67
  v_cvt_pk_bf16_f32 v50, v68, v69
  v_cvt_pk_bf16_f32 v51, v70, v71
  v_cvt_pk_bf16_f32 v52, v72, v73
  v_cvt_pk_bf16_f32 v53, v74, v75
  v_cvt_pk_bf16_f32 v54, v76, v77
  v_cvt_pk_bf16_f32 v55, v78, v79
  v_cvt_pk_bf16_f32 v56, v80, v81
  v_cvt_pk_bf16_f32 v57, v82, v83
  v_cvt_pk_bf16_f32 v58, v84, v85
  v_cvt_pk_bf16_f32 v59, v86, v87
  v_cvt_pk_bf16_f32 v60, v88, v89
  v_cvt_pk_bf16_f32 v61, v90, v91
  v_cvt_pk_bf16_f32 v62, v92, v93
  v_cvt_pk_bf16_f32 v63, v94, v95
  v_cvt_pk_bf16_f32 v240, v96, v97
  v_cvt_pk_bf16_f32 v241, v98, v99
  v_cvt_pk_bf16_f32 v242, v100, v101
  v_cvt_pk_bf16_f32 v243, v102, v103
  v_min_u32 v48, -2, v48
  v_min_u32 v52, -2, v52
  v_min_u32 v56, -2, v56
  v_min_u32 v60, -2, v60
  v_min_u32 v240, -2, v240
  s_mov_b64 exec, s[60:61]
  buffer_store_dwordx4 v[48:51], v15, s[80:83], s63 offen offset:0 sc1
  buffer_store_dwordx4 v[52:55], v15, s[80:83], s63 offen offset:512 sc1
  buffer_store_dwordx4 v[56:59], v15, s[80:83], s63 offen offset:1024 sc1
  buffer_store_dwordx4 v[60:63], v15, s[80:83], s63 offen offset:1536 sc1
  buffer_store_dwordx4 v[240:243], v15, s[80:83], s63 offen offset:2048 sc1
  s_mov_b64 exec, -1
  s_branch ul_240
ud_242:
  s_mov_b32 s84, 0
  s_mov_b32 s85, -1
  s_mov_b32 s86, 0
  s_branch queue
not_vw:
  s_sub_u32 s2, s3, 96
  s_cmp_lg_u32 s2, 31
  s_cbranch_scc1 not_cal
  s_load_dwordx2 s[72:73], s[0:1], 104
  s_waitcnt lgkmcnt(0)
  s_add_u32 s72, s72, 81068032
  s_addc_u32 s73, s73, 0
  s_mov_b32 s74, 115712
  s_mov_b32 s75, 0x00020000
  v_lshlrev_b32 v8, 4, v0
  v_mov_b32 v4, 0
  v_mov_b32 v5, 0
  v_mov_b32 v6, 0
  v_mov_b32 v7, 0
  s_mov_b32 s21, 0
  buffer_store_dwordx4 v[4:7], v8, s[72:75], s21 offen sc1
  s_mov_b32 s21, 4096
  buffer_store_dwordx4 v[4:7], v8, s[72:75], s21 offen sc1
  s_mov_b32 s21, 8192
  buffer_store_dwordx4 v[4:7], v8, s[72:75], s21 offen sc1
  s_mov_b32 s21, 12288
  buffer_store_dwordx4 v[4:7], v8, s[72:75], s21 offen sc1
  s_mov_b32 s21, 16384
  buffer_store_dwordx4 v[4:7], v8, s[72:75], s21 offen sc1
  s_mov_b32 s21, 20480
  buffer_store_dwordx4 v[4:7], v8, s[72:75], s21 offen sc1
  s_mov_b32 s21, 24576
  buffer_store_dwordx4 v[4:7], v8, s[72:75], s21 offen sc1
  s_mov_b32 s21, 28672
  buffer_store_dwordx4 v[4:7], v8, s[72:75], s21 offen sc1
  s_mov_b32 s21, 32768
  buffer_store_dwordx4 v[4:7], v8, s[72:75], s21 offen sc1
  s_mov_b32 s21, 36864
  buffer_store_dwordx4 v[4:7], v8, s[72:75], s21 offen sc1
  s_mov_b32 s21, 40960
  buffer_store_dwordx4 v[4:7], v8, s[72:75], s21 offen sc1
  s_mov_b32 s21, 45056
  buffer_store_dwordx4 v[4:7], v8, s[72:75], s21 offen sc1
  s_mov_b32 s21, 49152
  buffer_store_dwordx4 v[4:7], v8, s[72:75], s21 offen sc1
  s_mov_b32 s21, 53248
  buffer_store_dwordx4 v[4:7], v8, s[72:75], s21 offen sc1
  s_mov_b32 s21, 57344
  buffer_store_dwordx4 v[4:7], v8, s[72:75], s21 offen sc1
  s_mov_b32 s21, 61440
  buffer_store_dwordx4 v[4:7], v8, s[72:75], s21 offen sc1
  s_mov_b32 s21, 65536
  buffer_store_dwordx4 v[4:7], v8, s[72:75], s21 offen sc1
  s_mov_b32 s21, 69632
  buffer_store_dwordx4 v[4:7], v8, s[72:75], s21 offen sc1
  s_mov_b32 s21, 73728
  buffer_store_dwordx4 v[4:7], v8, s[72:75], s21 offen sc1
  s_mov_b32 s21, 77824
  buffer_store_dwordx4 v[4:7], v8, s[72:75], s21 offen sc1
  s_mov_b32 s21, 81920
  buffer_store_dwordx4 v[4:7], v8, s[72:75], s21 offen sc1
  s_mov_b32 s21, 86016
  buffer_store_dwordx4 v[4:7], v8, s[72:75], s21 offen sc1
  s_mov_b32 s21, 90112
  buffer_store_dwordx4 v[4:7], v8, s[72:75], s21 offen sc1
  s_mov_b32 s21, 94208
  buffer_store_dwordx4 v[4:7], v8, s[72:75], s21 offen sc1
  s_mov_b32 s21, 98304
  buffer_store_dwordx4 v[4:7], v8, s[72:75], s21 offen sc1
  s_mov_b32 s21, 102400
  buffer_store_dwordx4 v[4:7], v8, s[72:75], s21 offen sc1
  s_mov_b32 s21, 106496
  buffer_store_dwordx4 v[4:7], v8, s[72:75], s21 offen sc1
  s_mov_b32 s21, 110592
  buffer_store_dwordx4 v[4:7], v8, s[72:75], s21 offen sc1
  s_mov_b32 s21, 114688
  buffer_store_dwordx4 v[4:7], v8, s[72:75], s21 offen sc1
  s_waitcnt vmcnt(0)
  s_barrier
  s_cmp_lg_u32 s20, 0
  s_cbranch_scc1 cal_262
  s_mov_b64 exec, 1
  v_mov_b32 v4, 76
  v_mov_b32 v5, 1
  buffer_store_dword v5, v4, s[32:35], 0 offen sc1
  s_add_u32 s8, s38, 83886079
  s_addc_u32 s9, s39, 0
  s_and_b32 s8, s8, 0xffe00000
  s_mov_b32 s10, 2097152
  s_mov_b32 s11, 0x00020000
  v_mov_b32 v4, 0
  s_mov_b32 s40, -1
  s_mov_b32 s41, -1
  s_mov_b32 s42, 1048576
  s_mov_b32 s43, 0
  s_waitcnt vmcnt(0)
cal_263:
  s_add_u32 s21, s42, 0
  s_memtime s[98:99]
  s_waitcnt lgkmcnt(0)
  buffer_load_dword v5, v4, s[8:11], s21 offen sc1
  s_waitcnt vmcnt(0)
  s_memtime s[100:101]
  s_waitcnt lgkmcnt(0)
  s_sub_u32 s21, s100, s98
  s_min_u32 s40, s40, s21
  s_add_u32 s21, s42, 8192
  s_memtime s[98:99]
  s_waitcnt lgkmcnt(0)
  buffer_load_dword v5, v4, s[8:11], s21 offen sc1
  s_waitcnt vmcnt(0)
  s_memtime s[100:101]
  s_waitcnt lgkmcnt(0)
  s_sub_u32 s21, s100, s98
  s_min_u32 s41, s41, s21
  s_add_u32 s42, s42, 16640
  s_add_u32 s43, s43, 1
  s_cmp_lt_u32 s43, 8
  s_cbranch_scc1 cal_263
  s_cmp_lt_u32 s41, s40
  s_cselect_b32 s21, 1, 2
  v_mov_b32 v4, s21
  v_mov_b32 v5, s40
  v_mov_b32 v6, s41
  v_mov_b32 v8, 84
  buffer_store_dwordx3 v[4:6], v8, s[32:35], 0 offen sc1
  s_waitcnt vmcnt(0)
  s_mov_b64 exec, -1
cal_262:
not_cal:
  s_sleep 127
  s_sleep 127
  s_load_dwordx2 s[32:33], s[0:1], 96
  s_waitcnt lgkmcnt(0)
  s_mov_b32 s32, s32
  s_mov_b32 s33, s33
  s_mov_b32 s34, 256
  s_mov_b32 s35, 0x00020000
  s_mov_b32 s21, 76
  s_cmp_lg_u32 s20, 0
  s_cbranch_scc1 wf_265
  v_mov_b32 v4, 0
  s_mov_b32 s101, 0
wf_264:
  buffer_load_dword v5, v4, s[32:35], s21 offen sc1
  s_add_u32 s101, s101, 1
  s_cmp_gt_u32 s101, 131072
  s_cbranch_scc1 main_end
  s_waitcnt vmcnt(0)
  v_readfirstlane_b32 s100, v5
  s_cmp_ge_u32 s100, 1
  s_cbranch_scc1 wf_265
  s_sleep 8
  s_branch wf_264
wf_265:
  s_barrier
  s_load_dwordx2 s[72:73], s[0:1], 104
  s_waitcnt lgkmcnt(0)
  s_add_u32 s72, s72, 81068032
  s_addc_u32 s73, s73, 0
  s_mov_b32 s74, 115712
  s_mov_b32 s75, 0x00020000
  s_cmp_ge_u32 s2, 30
  s_cbranch_scc1 skip_qb
  s_mul_hi_u32 s42, s2, 0x1999999a
  s_mul_i32 s21, s42, 10
  s_sub_u32 s41, s2, s21
  s_sub_u32 s26, 17, s42
  s_mul_hi_u32 s26, s26, 0x55555556
  s_mov_b32 s63, 3
  s_mov_b32 s64, 0
qkvb_entry:
  s_load_dwordx2 s[4:5], s[0:1], 0
  s_load_dwordx2 s[6:7], s[0:1], 64
  s_load_dwordx2 s[38:39], s[0:1], 104
  s_waitcnt lgkmcnt(0)
  s_mov_b32 s8, s4
  s_mov_b32 s9, s5
  s_mov_b32 s10, 2621440
  s_mov_b32 s11, 0x00020000
  s_mov_b32 s12, s6
  s_mov_b32 s13, s7
  s_mov_b32 s14, 2457600
  s_mov_b32 s15, 0x00020000
  s_add_u32 s16, s38, 62914560
  s_addc_u32 s17, s39, 0
  s_mov_b32 s18, 7864320
  s_mov_b32 s19, 0x00020000
  s_mul_i32 s44, s41, 384
  v_mov_b32 v9, 2731
  v_add_u32 v8, 0, v1
  v_mul_u32_u24 v7, v8, v9
  v_lshrrev_b32 v7, 16, v7
  v_mul_u32_u24 v4, 24, v7
  v_sub_u32 v8, v8, v4
  s_mov_b32 s21, 3840
  v_mul_lo_u32 v7, v7, s21
  v_lshl_add_u32 v4, v8, 4, v7
  v_add_u32 v8, 64, v1
  v_mul_u32_u24 v7, v8, v9
  v_lshrrev_b32 v7, 16, v7
  v_mul_u32_u24 v5, 24, v7
  v_sub_u32 v8, v8, v5
  s_mov_b32 s21, 3840
  v_mul_lo_u32 v7, v7, s21
  v_lshl_add_u32 v5, v8, 4, v7
  v_add_u32 v8, 128, v1
  v_mul_u32_u24 v7, v8, v9
  v_lshrrev_b32 v7, 16, v7
  v_mul_u32_u24 v6, 24, v7
  v_sub_u32 v8, v8, v6
  s_mov_b32 s21, 3840
  v_mul_lo_u32 v7, v7, s21
  v_lshl_add_u32 v6, v8, 4, v7
  v_lshrrev_b32 v7, 2, v2
  v_lshl_add_u32 v7, v3, 3, v7
  v_mul_u32_u24 v7, 384, v7
  v_and_b32 v8, 3, v2
  v_lshlrev_b32 v8, 3, v8
  s_mul_i32 s21, s20, 96
  v_add3_u32 v7, v7, v8, s21
  v_add_u32 v8, 61440, v7
  s_mul_i32 s21, s20, 153600
  s_add_u32 s21, s21, 0
  s_add_u32 s21, s21, s44
  s_mul_i32 s22, s20, 15360
  s_add_u32 s22, s22, 0
  s_add_u32 m0, s22, 0
  s_nop 0
  buffer_load_dwordx4 v4, s[12:15], s21 offen lds
  s_add_u32 m0, s22, 1024
  s_nop 0
  buffer_load_dwordx4 v5, s[12:15], s21 offen lds
  s_add_u32 m0, s22, 2048
  s_nop 0
  buffer_load_dwordx4 v6, s[12:15], s21 offen lds
  s_mul_i32 s21, s20, 153600
  s_add_u32 s21, s21, 30720
  s_add_u32 s21, s21, s44
  s_mul_i32 s22, s20, 15360
  s_add_u32 s22, s22, 3072
  s_add_u32 m0, s22, 0
  s_nop 0
  buffer_load_dwordx4 v4, s[12:15], s21 offen lds
  s_add_u32 m0, s22, 1024
  s_nop 0
  buffer_load_dwordx4 v5, s[12:15], s21 offen lds
  s_add_u32 m0, s22, 2048
  s_nop 0
  buffer_load_dwordx4 v6, s[12:15], s21 offen lds
  s_mul_i32 s21, s20, 153600
  s_add_u32 s21, s21, 61440
  s_add_u32 s21, s21, s44
  s_mul_i32 s22, s20, 15360
  s_add_u32 s22, s22, 6144
  s_add_u32 m0, s22, 0
  s_nop 0
  buffer_load_dwordx4 v4, s[12:15], s21 offen lds
  s_add_u32 m0, s22, 1024
  s_nop 0
  buffer_load_dwordx4 v5, s[12:15], s21 offen lds
  s_add_u32 m0, s22, 2048
  s_nop 0
  buffer_load_dwordx4 v6, s[12:15], s21 offen lds
  s_mul_i32 s21, s20, 153600
  s_add_u32 s21, s21, 92160
  s_add_u32 s21, s21, s44
  s_mul_i32 s22, s20, 15360
  s_add_u32 s22, s22, 9216
  s_add_u32 m0, s22, 0
  s_nop 0
  buffer_load_dwordx4 v4, s[12:15], s21 offen lds
  s_add_u32 m0, s22, 1024
  s_nop 0
  buffer_load_dwordx4 v5, s[12:15], s21 offen lds
  s_add_u32 m0, s22, 2048
  s_nop 0
  buffer_load_dwordx4 v6, s[12:15], s21 offen lds
  s_mul_i32 s21, s20, 153600
  s_add_u32 s21, s21, 122880
  s_add_u32 s21, s21, s44
  s_mul_i32 s22, s20, 15360
  s_add_u32 s22, s22, 12288
  s_add_u32 m0, s22, 0
  s_nop 0
  buffer_load_dwordx4 v4, s[12:15], s21 offen lds
  s_add_u32 m0, s22, 1024
  s_nop 0
  buffer_load_dwordx4 v5, s[12:15], s21 offen lds
  s_add_u32 m0, s22, 2048
  s_nop 0
  buffer_load_dwordx4 v6, s[12:15], s21 offen lds
  s_mul_i32 s21, s20, 153600
  s_add_u32 s21, s21, 614400
  s_add_u32 s21, s21, s44
  s_mul_i32 s22, s20, 15360
  s_add_u32 s22, s22, 61440
  s_add_u32 m0, s22, 0
  s_nop 0
  buffer_load_dwordx4 v4, s[12:15], s21 offen lds
  s_add_u32 m0, s22, 1024
  s_nop 0
  buffer_load_dwordx4 v5, s[12:15], s21 offen lds
  s_add_u32 m0, s22, 2048
  s_nop 0
  buffer_load_dwordx4 v6, s[12:15], s21 offen lds
  s_mul_i32 s21, s20, 153600
  s_add_u32 s21, s21, 645120
  s_add_u32 s21, s21, s44
  s_mul_i32 s22, s20, 15360
  s_add_u32 s22, s22, 64512
  s_add_u32 m0, s22, 0
  s_nop 0
  buffer_load_dwordx4 v4, s[12:15], s21 offen lds
  s_add_u32 m0, s22, 1024
  s_nop 0
  buffer_load_dwordx4 v5, s[12:15], s21 offen lds
  s_add_u32 m0, s22, 2048
  s_nop 0
  buffer_load_dwordx4 v6, s[12:15], s21 offen lds
  s_mul_i32 s21, s20, 153600
  s_add_u32 s21, s21, 675840
  s_add_u32 s21, s21, s44
  s_mul_i32 s22, s20, 15360
  s_add_u32 s22, s22, 67584
  s_add_u32 m0, s22, 0
  s_nop 0
  buffer_load_dwordx4 v4, s[12:15], s21 offen lds
  s_add_u32 m0, s22, 1024
  s_nop 0
  buffer_load_dwordx4 v5, s[12:15], s21 offen lds
  s_add_u32 m0, s22, 2048
  s_nop 0
  buffer_load_dwordx4 v6, s[12:15], s21 offen lds
  s_mul_i32 s21, s20, 153600
  s_add_u32 s21, s21, 706560
  s_add_u32 s21, s21, s44
  s_mul_i32 s22, s20, 15360
  s_add_u32 s22, s22, 70656
  s_add_u32 m0, s22, 0
  s_nop 0
  buffer_load_dwordx4 v4, s[12:15], s21 offen lds
  s_add_u32 m0, s22, 1024
  s_nop 0
  buffer_load_dwordx4 v5, s[12:15], s21 offen lds
  s_add_u32 m0, s22, 2048
  s_nop 0
  buffer_load_dwordx4 v6, s[12:15], s21 offen lds
  s_mul_i32 s21, s20, 153600
  s_add_u32 s21, s21, 737280
  s_add_u32 s21, s21, s44
  s_mul_i32 s22, s20, 15360
  s_add_u32 s22, s22, 73728
  s_add_u32 m0, s22, 0
  s_nop 0
  buffer_load_dwordx4 v4, s[12:15], s21 offen lds
  s_add_u32 m0, s22, 1024
  s_nop 0
  buffer_load_dwordx4 v5, s[12:15], s21 offen lds
  s_add_u32 m0, s22, 2048
  s_nop 0
  buffer_load_dwordx4 v6, s[12:15], s21 offen lds
  s_mul_i32 s21, s20, 153600
  s_add_u32 s21, s21, 1228800
  s_add_u32 s21, s21, s44
  buffer_load_dwordx4 v[64:67], v4, s[12:15], s21 offen
  buffer_load_dwordx4 v[68:71], v5, s[12:15], s21 offen
  buffer_load_dwordx4 v[72:75], v6, s[12:15], s21 offen
  s_mul_i32 s21, s20, 153600
  s_add_u32 s21, s21, 1259520
  s_add_u32 s21, s21, s44
  buffer_load_dwordx4 v[76:79], v4, s[12:15], s21 offen
  buffer_load_dwordx4 v[80:83], v5, s[12:15], s21 offen
  buffer_load_dwordx4 v[84:87], v6, s[12:15], s21 offen
  s_mul_i32 s21, s20, 153600
  s_add_u32 s21, s21, 1290240
  s_add_u32 s21, s21, s44
  buffer_load_dwordx4 v[88:91], v4, s[12:15], s21 offen
  buffer_load_dwordx4 v[92:95], v5, s[12:15], s21 offen
  buffer_load_dwordx4 v[96:99], v6, s[12:15], s21 offen
  s_mul_i32 s21, s20, 153600
  s_add_u32 s21, s21, 1320960
  s_add_u32 s21, s21, s44
  buffer_load_dwordx4 v[100:103], v4, s[12:15], s21 offen
  buffer_load_dwordx4 v[104:107], v5, s[12:15], s21 offen
  buffer_load_dwordx4 v[108:111], v6, s[12:15], s21 offen
  s_mul_i32 s21, s20, 153600
  s_add_u32 s21, s21, 1351680
  s_add_u32 s21, s21, s44
  buffer_load_dwordx4 v[112:115], v4, s[12:15], s21 offen
  buffer_load_dwordx4 v[116:119], v5, s[12:15], s21 offen
  buffer_load_dwordx4 v[120:123], v6, s[12:15], s21 offen
  s_mul_i32 s21, s20, 153600
  s_add_u32 s21, s21, 1843200
  s_add_u32 s21, s21, s44
  buffer_load_dwordx4 v[124:127], v4, s[12:15], s21 offen
  buffer_load_dwordx4 v[128:131], v5, s[12:15], s21 offen
  buffer_load_dwordx4 v[132:135], v6, s[12:15], s21 offen
  s_mul_i32 s21, s20, 153600
  s_add_u32 s21, s21, 1873920
  s_add_u32 s21, s21, s44
  buffer_load_dwordx4 v[136:139], v4, s[12:15], s21 offen
  buffer_load_dwordx4 v[140:143], v5, s[12:15], s21 offen
  buffer_load_dwordx4 v[144:147], v6, s[12:15], s21 offen
  s_mul_i32 s21, s20, 153600
  s_add_u32 s21, s21, 1904640
  s_add_u32 s21, s21, s44
  buffer_load_dwordx4 v[148:151], v4, s[12:15], s21 offen
  buffer_load_dwordx4 v[152:155], v5, s[12:15], s21 offen
  buffer_load_dwordx4 v[156:159], v6, s[12:15], s21 offen
  s_mul_i32 s21, s20, 153600
  s_add_u32 s21, s21, 1935360
  s_add_u32 s21, s21, s44
  buffer_load_dwordx4 v[160:163], v4, s[12:15], s21 offen
  buffer_load_dwordx4 v[164:167], v5, s[12:15], s21 offen
  buffer_load_dwordx4 v[168:171], v6, s[12:15], s21 offen
  s_mul_i32 s21, s20, 153600
  s_add_u32 s21, s21, 1966080
  s_add_u32 s21, s21, s44
  buffer_load_dwordx4 v[172:175], v4, s[12:15], s21 offen
  buffer_load_dwordx4 v[176:179], v5, s[12:15], s21 offen
  buffer_load_dwordx4 v[180:183], v6, s[12:15], s21 offen
  s_mul_i32 s22, s20, 15360
  v_lshl_add_u32 v30, v1, 4, s22
  v_add_u32 v31, 61440, v30
  s_waitcnt vmcnt(45)
  s_barrier
  ds_read_b64_tr_b16 a[0:1], v7 offset:0
  ds_read_b64_tr_b16 a[2:3], v7 offset:1536
  ds_read_b64_tr_b16 a[4:5], v7 offset:32
  ds_read_b64_tr_b16 a[6:7], v7 offset:1568
  ds_read_b64_tr_b16 a[8:9], v7 offset:64
  ds_read_b64_tr_b16 a[10:11], v7 offset:1600
  ds_read_b64_tr_b16 a[12:13], v7 offset:12288
  ds_read_b64_tr_b16 a[14:15], v7 offset:13824
  ds_read_b64_tr_b16 a[16:17], v7 offset:12320
  ds_read_b64_tr_b16 a[18:19], v7 offset:13856
  ds_read_b64_tr_b16 a[20:21], v7 offset:12352
  ds_read_b64_tr_b16 a[22:23], v7 offset:13888
  ds_read_b64_tr_b16 a[24:25], v7 offset:24576
  ds_read_b64_tr_b16 a[26:27], v7 offset:26112
  ds_read_b64_tr_b16 a[28:29], v7 offset:24608
  ds_read_b64_tr_b16 a[30:31], v7 offset:26144
  ds_read_b64_tr_b16 a[32:33], v7 offset:24640
  ds_read_b64_tr_b16 a[34:35], v7 offset:26176
  ds_read_b64_tr_b16 a[36:37], v7 offset:36864
  ds_read_b64_tr_b16 a[38:39], v7 offset:38400
  ds_read_b64_tr_b16 a[40:41], v7 offset:36896
  ds_read_b64_tr_b16 a[42:43], v7 offset:38432
  ds_read_b64_tr_b16 a[44:45], v7 offset:36928
  ds_read_b64_tr_b16 a[46:47], v7 offset:38464
  ds_read_b64_tr_b16 a[48:49], v7 offset:49152
  ds_read_b64_tr_b16 a[50:51], v7 offset:50688
  ds_read_b64_tr_b16 a[52:53], v7 offset:49184
  ds_read_b64_tr_b16 a[54:55], v7 offset:50720
  ds_read_b64_tr_b16 a[56:57], v7 offset:49216
  ds_read_b64_tr_b16 a[58:59], v7 offset:50752
  s_waitcnt lgkmcnt(0)
  s_barrier
  s_waitcnt vmcnt(30)
  s_barrier
  ds_read_b64_tr_b16 a[60:61], v8 offset:0
  ds_read_b64_tr_b16 a[62:63], v8 offset:1536
  ds_read_b64_tr_b16 a[64:65], v8 offset:32
  ds_read_b64_tr_b16 a[66:67], v8 offset:1568
  ds_read_b64_tr_b16 a[68:69], v8 offset:64
  ds_read_b64_tr_b16 a[70:71], v8 offset:1600
  ds_read_b64_tr_b16 a[72:73], v8 offset:12288
  ds_read_b64_tr_b16 a[74:75], v8 offset:13824
  ds_read_b64_tr_b16 a[76:77], v8 offset:12320
  ds_read_b64_tr_b16 a[78:79], v8 offset:13856
  ds_read_b64_tr_b16 a[80:81], v8 offset:12352
  ds_read_b64_tr_b16 a[82:83], v8 offset:13888
  ds_read_b64_tr_b16 a[84:85], v8 offset:24576
  ds_read_b64_tr_b16 a[86:87], v8 offset:26112
  ds_read_b64_tr_b16 a[88:89], v8 offset:24608
  ds_read_b64_tr_b16 a[90:91], v8 offset:26144
  ds_read_b64_tr_b16 a[92:93], v8 offset:24640
  ds_read_b64_tr_b16 a[94:95], v8 offset:26176
  ds_read_b64_tr_b16 a[96:97], v8 offset:36864
  ds_read_b64_tr_b16 a[98:99], v8 offset:38400
  ds_read_b64_tr_b16 a[100:101], v8 offset:36896
  ds_read_b64_tr_b16 a[102:103], v8 offset:38432
  ds_read_b64_tr_b16 a[104:105], v8 offset:36928
  ds_read_b64_tr_b16 a[106:107], v8 offset:38464
  ds_read_b64_tr_b16 a[108:109], v8 offset:49152
  ds_read_b64_tr_b16 a[110:111], v8 offset:50688
  ds_read_b64_tr_b16 a[112:113], v8 offset:49184
  ds_read_b64_tr_b16 a[114:115], v8 offset:50720
  ds_read_b64_tr_b16 a[116:117], v8 offset:49216
  ds_read_b64_tr_b16 a[118:119], v8 offset:50752
  s_waitcnt lgkmcnt(0)
  s_barrier
  s_waitcnt vmcnt(15)
  ds_write_b128 v30, v[64:67] offset:0
  ds_write_b128 v30, v[68:71] offset:1024
  ds_write_b128 v30, v[72:75] offset:2048
  ds_write_b128 v30, v[76:79] offset:3072
  ds_write_b128 v30, v[80:83] offset:4096
  ds_write_b128 v30, v[84:87] offset:5120
  ds_write_b128 v30, v[88:91] offset:6144
  ds_write_b128 v30, v[92:95] offset:7168
  ds_write_b128 v30, v[96:99] offset:8192
  ds_write_b128 v30, v[100:103] offset:9216
  ds_write_b128 v30, v[104:107] offset:10240
  ds_write_b128 v30, v[108:111] offset:11264
  ds_write_b128 v30, v[112:115] offset:12288
  ds_write_b128 v30, v[116:119] offset:13312
  ds_write_b128 v30, v[120:123] offset:14336
  s_waitcnt lgkmcnt(0)
  s_barrier
  ds_read_b64_tr_b16 a[120:121], v7 offset:0
  ds_read_b64_tr_b16 a[122:123], v7 offset:1536
  ds_read_b64_tr_b16 a[124:125], v7 offset:32
  ds_read_b64_tr_b16 a[126:127], v7 offset:1568
  ds_read_b64_tr_b16 a[128:129], v7 offset:64
  ds_read_b64_tr_b16 a[130:131], v7 offset:1600
  ds_read_b64_tr_b16 a[132:133], v7 offset:12288
  ds_read_b64_tr_b16 a[134:135], v7 offset:13824
  ds_read_b64_tr_b16 a[136:137], v7 offset:12320
  ds_read_b64_tr_b16 a[138:139], v7 offset:13856
  ds_read_b64_tr_b16 a[140:141], v7 offset:12352
  ds_read_b64_tr_b16 a[142:143], v7 offset:13888
  ds_read_b64_tr_b16 a[144:145], v7 offset:24576
  ds_read_b64_tr_b16 a[146:147], v7 offset:26112
  ds_read_b64_tr_b16 a[148:149], v7 offset:24608
  ds_read_b64_tr_b16 a[150:151], v7 offset:26144
  ds_read_b64_tr_b16 a[152:153], v7 offset:24640
  ds_read_b64_tr_b16 a[154:155], v7 offset:26176
  ds_read_b64_tr_b16 a[156:157], v7 offset:36864
  ds_read_b64_tr_b16 a[158:159], v7 offset:38400
  ds_read_b64_tr_b16 a[160:161], v7 offset:36896
  ds_read_b64_tr_b16 a[162:163], v7 offset:38432
  ds_read_b64_tr_b16 a[164:165], v7 offset:36928
  ds_read_b64_tr_b16 a[166:167], v7 offset:38464
  ds_read_b64_tr_b16 a[168:169], v7 offset:49152
  ds_read_b64_tr_b16 a[170:171], v7 offset:50688
  ds_read_b64_tr_b16 a[172:173], v7 offset:49184
  ds_read_b64_tr_b16 a[174:175], v7 offset:50720
  ds_read_b64_tr_b16 a[176:177], v7 offset:49216
  ds_read_b64_tr_b16 a[178:179], v7 offset:50752
  s_waitcnt lgkmcnt(0)
  s_barrier
  s_waitcnt vmcnt(0)
  ds_write_b128 v31, v[124:127] offset:0
  ds_write_b128 v31, v[128:131] offset:1024
  ds_write_b128 v31, v[132:135] offset:2048
  ds_write_b128 v31, v[136:139] offset:3072
  ds_write_b128 v31, v[140:143] offset:4096
  ds_write_b128 v31, v[144:147] offset:5120
  ds_write_b128 v31, v[148:151] offset:6144
  ds_write_b128 v31, v[152:155] offset:7168
  ds_write_b128 v31, v[156:159] offset:8192
  ds_write_b128 v31, v[160:163] offset:9216
  ds_write_b128 v31, v[164:167] offset:10240
  ds_write_b128 v31, v[168:171] offset:11264
  ds_write_b128 v31, v[172:175] offset:12288
  ds_write_b128 v31, v[176:179] offset:13312
  ds_write_b128 v31, v[180:183] offset:14336
  s_waitcnt lgkmcnt(0)
  s_barrier
  ds_read_b64_tr_b16 a[180:181], v8 offset:0
  ds_read_b64_tr_b16 a[182:183], v8 offset:1536
  ds_read_b64_tr_b16 a[184:185], v8 offset:32
  ds_read_b64_tr_b16 a[186:187], v8 offset:1568
  ds_read_b64_tr_b16 a[188:189], v8 offset:64
  ds_read_b64_tr_b16 a[190:191], v8 offset:1600
  ds_read_b64_tr_b16 a[192:193], v8 offset:12288
  ds_read_b64_tr_b16 a[194:195], v8 offset:13824
  ds_read_b64_tr_b16 a[196:197], v8 offset:12320
  ds_read_b64_tr_b16 a[198:199], v8 offset:13856
  ds_read_b64_tr_b16 a[200:201], v8 offset:12352
  ds_read_b64_tr_b16 a[202:203], v8 offset:13888
  ds_read_b64_tr_b16 a[204:205], v8 offset:24576
  ds_read_b64_tr_b16 a[206:207], v8 offset:26112
  ds_read_b64_tr_b16 a[208:209], v8 offset:24608
  ds_read_b64_tr_b16 a[210:211], v8 offset:26144
  ds_read_b64_tr_b16 a[212:213], v8 offset:24640
  ds_read_b64_tr_b16 a[214:215], v8 offset:26176
  ds_read_b64_tr_b16 a[216:217], v8 offset:36864
  ds_read_b64_tr_b16 a[218:219], v8 offset:38400
  ds_read_b64_tr_b16 a[220:221], v8 offset:36896
  ds_read_b64_tr_b16 a[222:223], v8 offset:38432
  ds_read_b64_tr_b16 a[224:225], v8 offset:36928
  ds_read_b64_tr_b16 a[226:227], v8 offset:38464
  ds_read_b64_tr_b16 a[228:229], v8 offset:49152
  ds_read_b64_tr_b16 a[230:231], v8 offset:50688
  ds_read_b64_tr_b16 a[232:233], v8 offset:49184
  ds_read_b64_tr_b16 a[234:235], v8 offset:50720
  ds_read_b64_tr_b16 a[236:237], v8 offset:49216
  ds_read_b64_tr_b16 a[238:239], v8 offset:50752
  s_waitcnt lgkmcnt(0)
  s_barrier
  s_mul_i32 s24, s42, 163840
  s_mul_i32 s25, s63, 163840
  s_mul_i32 s27, s42, 491520
  s_add_u32 s27, s27, s44
  s_mul_i32 s28, s63, 491520
  s_lshl_b32 s63, s63, 7
  s_load_dwordx2 s[72:73], s[0:1], 104
  s_waitcnt lgkmcnt(0)
  s_add_u32 s72, s72, 81068032
  s_addc_u32 s73, s73, 0
  s_mov_b32 s74, 115712
  s_mov_b32 s75, 0x00020000
  s_lshl_b32 s60, s42, 7
  s_add_u32 s60, s60, 88064
  s_mov_b32 s61, 0
  v_lshrrev_b32 v11, 3, v1
  v_and_b32 v12, 7, v1
  v_xor_b32 v12, v12, v11
  v_mul_u32_u24 v11, 1280, v11
  v_lshl_add_u32 v10, v12, 4, v11
  s_mov_b32 s30, s24
  s_mov_b32 s31, 0
  s_mov_b32 s32, 0
  s_mul_i32 s46, s20, 40960
  s_add_u32 s46, s46, s30
  s_lshl_b32 s47, s20, 12
  s_add_u32 s47, s47, s32
  s_add_u32 m0, s47, 0
  s_nop 0
  buffer_load_dwordx4 v10, s[8:11], s46 offen lds
  s_add_u32 s46, s46, 10240
  s_add_u32 m0, s47, 1024
  s_nop 0
  buffer_load_dwordx4 v10, s[8:11], s46 offen lds
  s_add_u32 s46, s46, 10240
  s_add_u32 m0, s47, 2048
  s_nop 0
  buffer_load_dwordx4 v10, s[8:11], s46 offen lds
  s_add_u32 s46, s46, 10240
  s_add_u32 m0, s47, 3072
  s_nop 0
  buffer_load_dwordx4 v10, s[8:11], s46 offen lds
  s_add_u32 s30, s30, 128
  s_add_u32 s31, s31, 1
  s_cmp_lt_u32 s31, 10
  s_cbranch_scc1 qb_266
  s_mov_b32 s31, 0
  s_add_u32 s30, s30, s25
  s_sub_u32 s30, s30, 1280

qb_266:
  s_add_u32 s32, s32, 16384
  s_cmp_lt_u32 s32, 98304
  s_cselect_b32 s32, s32, 0
  s_mul_i32 s46, s20, 40960
  s_add_u32 s46, s46, s30
  s_lshl_b32 s47, s20, 12
  s_add_u32 s47, s47, s32
  s_add_u32 m0, s47, 0
  s_nop 0
  buffer_load_dwordx4 v10, s[8:11], s46 offen lds
  s_add_u32 s46, s46, 10240
  s_add_u32 m0, s47, 1024
  s_nop 0
  buffer_load_dwordx4 v10, s[8:11], s46 offen lds
  s_add_u32 s46, s46, 10240
  s_add_u32 m0, s47, 2048
  s_nop 0
  buffer_load_dwordx4 v10, s[8:11], s46 offen lds
  s_add_u32 s46, s46, 10240
  s_add_u32 m0, s47, 3072
  s_nop 0
  buffer_load_dwordx4 v10, s[8:11], s46 offen lds
  s_add_u32 s30, s30, 128
  s_add_u32 s31, s31, 1
  s_cmp_lt_u32 s31, 10
  s_cbranch_scc1 qb_267
  s_mov_b32 s31, 0
  s_add_u32 s30, s30, s25
  s_sub_u32 s30, s30, 1280

qb_267:
  s_add_u32 s32, s32, 16384
  s_cmp_lt_u32 s32, 98304
  s_cselect_b32 s32, s32, 0
  s_mul_i32 s46, s20, 40960
  s_add_u32 s46, s46, s30
  s_lshl_b32 s47, s20, 12
  s_add_u32 s47, s47, s32
  s_add_u32 m0, s47, 0
  s_nop 0
  buffer_load_dwordx4 v10, s[8:11], s46 offen lds
  s_add_u32 s46, s46, 10240
  s_add_u32 m0, s47, 1024
  s_nop 0
  buffer_load_dwordx4 v10, s[8:11], s46 offen lds
  s_add_u32 s46, s46, 10240
  s_add_u32 m0, s47, 2048
  s_nop 0
  buffer_load_dwordx4 v10, s[8:11], s46 offen lds
  s_add_u32 s46, s46, 10240
  s_add_u32 m0, s47, 3072
  s_nop 0
  buffer_load_dwordx4 v10, s[8:11], s46 offen lds
  s_add_u32 s30, s30, 128
  s_add_u32 s31, s31, 1
  s_cmp_lt_u32 s31, 10
  s_cbranch_scc1 qb_268
  s_mov_b32 s31, 0
  s_add_u32 s30, s30, s25
  s_sub_u32 s30, s30, 1280

qb_268:
  s_add_u32 s32, s32, 16384
  s_cmp_lt_u32 s32, 98304
  s_cselect_b32 s32, s32, 0
  s_mul_i32 s46, s20, 40960
  s_add_u32 s46, s46, s30
  s_lshl_b32 s47, s20, 12
  s_add_u32 s47, s47, s32
  s_add_u32 m0, s47, 0
  s_nop 0
  buffer_load_dwordx4 v10, s[8:11], s46 offen lds
  s_add_u32 s46, s46, 10240
  s_add_u32 m0, s47, 1024
  s_nop 0
  buffer_load_dwordx4 v10, s[8:11], s46 offen lds
  s_add_u32 s46, s46, 10240
  s_add_u32 m0, s47, 2048
  s_nop 0
  buffer_load_dwordx4 v10, s[8:11], s46 offen lds
  s_add_u32 s46, s46, 10240
  s_add_u32 m0, s47, 3072
  s_nop 0
  buffer_load_dwordx4 v10, s[8:11], s46 offen lds
  s_add_u32 s30, s30, 128
  s_add_u32 s31, s31, 1
  s_cmp_lt_u32 s31, 10
  s_cbranch_scc1 qb_269
  s_mov_b32 s31, 0
  s_add_u32 s30, s30, s25
  s_sub_u32 s30, s30, 1280

qb_269:
  s_add_u32 s32, s32, 16384
  s_cmp_lt_u32 s32, 98304
  s_cselect_b32 s32, s32, 0
  v_and_b32 v6, 7, v2
  v_add_u32 v4, 0, v3
  v_xor_b32 v4, v4, v6
  v_lshlrev_b32 v4, 4, v4
  v_lshl_add_u32 v14, v2, 7, v4
  v_add_u32 v4, 4, v3
  v_xor_b32 v4, v4, v6
  v_lshlrev_b32 v4, 4, v4
  v_lshl_add_u32 v15, v2, 7, v4
  v_mul_u32_u24 v22, 400, v2
  v_mul_u32_u24 v4, 8, v3
  s_mul_i32 s21, s20, 96
  s_add_u32 s21, s21, 98304
  v_add3_u32 v22, v22, v4, s21
  v_mov_b32 v9, 2731
  v_add_u32 v8, 0, v1
  v_mul_u32_u24 v7, v8, v9
  v_lshrrev_b32 v7, 16, v7
  v_mul_u32_u24 v4, 24, v7
  v_sub_u32 v8, v8, v4
  v_lshlrev_b32 v8, 4, v8
  s_mov_b32 s21, 3840
  v_mul_lo_u32 v4, v7, s21
  v_add_u32 v26, v4, v8
  v_mul_u32_u24 v4, 400, v7
  s_mul_i32 s21, s20, 12800
  s_add_u32 s21, s21, 98304
  v_add3_u32 v23, v4, v8, s21
  v_add_u32 v8, 64, v1
  v_mul_u32_u24 v7, v8, v9
  v_lshrrev_b32 v7, 16, v7
  v_mul_u32_u24 v4, 24, v7
  v_sub_u32 v8, v8, v4
  v_lshlrev_b32 v8, 4, v8
  s_mov_b32 s21, 3840
  v_mul_lo_u32 v4, v7, s21
  v_add_u32 v27, v4, v8
  v_mul_u32_u24 v4, 400, v7
  s_mul_i32 s21, s20, 12800
  s_add_u32 s21, s21, 98304
  v_add3_u32 v24, v4, v8, s21
  v_add_u32 v8, 128, v1
  v_mul_u32_u24 v7, v8, v9
  v_lshrrev_b32 v7, 16, v7
  v_mul_u32_u24 v4, 24, v7
  v_sub_u32 v8, v8, v4
  v_lshlrev_b32 v8, 4, v8
  s_mov_b32 s21, 3840
  v_mul_lo_u32 v4, v7, s21
  v_add_u32 v28, v4, v8
  v_mul_u32_u24 v4, 400, v7
  s_mul_i32 s21, s20, 12800
  s_add_u32 s21, s21, 98304
  v_add3_u32 v25, v4, v8, s21
  s_mov_b32 s33, 0
  s_mov_b32 s48, 0x80000000
  s_mul_i32 s46, s20, 40960
  s_add_u32 s46, s46, s30
  s_lshl_b32 s47, s20, 12
  s_add_u32 s47, s47, s32
  s_add_u32 m0, s47, 0
  s_nop 0
  buffer_load_dwordx4 v10, s[8:11], s46 offen lds
  s_add_u32 s46, s46, 10240
  s_add_u32 m0, s47, 1024
  s_nop 0
  buffer_load_dwordx4 v10, s[8:11], s46 offen lds
  s_waitcnt vmcnt(14)
  s_barrier
  v_add_u32 v18, s33, v14
  v_add_u32 v19, s33, v15
  s_add_u32 s33, s33, 16384
  s_cmp_lt_u32 s33, 98304
  s_cselect_b32 s33, s33, 0
  ds_read_b128 v[160:163], v18 offset:0
  ds_read_b128 v[164:167], v18 offset:2048
  ds_read_b128 v[168:171], v18 offset:4096
  ds_read_b128 v[172:175], v18 offset:6144
  ds_read_b128 v[176:179], v18 offset:8192
  ds_read_b128 v[180:183], v18 offset:10240
  ds_read_b128 v[184:187], v18 offset:12288
  ds_read_b128 v[188:191], v18 offset:14336
qb_blk_270:
  ds_read_b128 v[192:195], v19 offset:0
  s_waitcnt lgkmcnt(8)
  v_mfma_f32_16x16x32_bf16 v[64:67], a[0:3], v[160:163], 0
  v_mfma_f32_16x16x32_bf16 v[68:71], a[4:7], v[160:163], 0
  v_mfma_f32_16x16x32_bf16 v[72:75], a[8:11], v[160:163], 0
  ds_read_b128 v[196:199], v19 offset:2048
  s_waitcnt lgkmcnt(8)
  v_mfma_f32_16x16x32_bf16 v[76:79], a[0:3], v[164:167], 0
  v_mfma_f32_16x16x32_bf16 v[80:83], a[4:7], v[164:167], 0
  v_mfma_f32_16x16x32_bf16 v[84:87], a[8:11], v[164:167], 0
  s_add_u32 s46, s46, 10240
  s_add_u32 m0, s47, 2048
  s_nop 0
  buffer_load_dwordx4 v10, s[8:11], s46 offen lds
  ds_read_b128 v[200:203], v19 offset:4096
  s_waitcnt lgkmcnt(8)
  v_mfma_f32_16x16x32_bf16 v[88:91], a[0:3], v[168:171], 0
  v_mfma_f32_16x16x32_bf16 v[92:95], a[4:7], v[168:171], 0
  v_mfma_f32_16x16x32_bf16 v[96:99], a[8:11], v[168:171], 0
  ds_read_b128 v[204:207], v19 offset:6144
  s_waitcnt lgkmcnt(8)
  v_mfma_f32_16x16x32_bf16 v[100:103], a[0:3], v[172:175], 0
  v_mfma_f32_16x16x32_bf16 v[104:107], a[4:7], v[172:175], 0
  v_mfma_f32_16x16x32_bf16 v[108:111], a[8:11], v[172:175], 0
  ds_read_b128 v[208:211], v19 offset:8192
  s_waitcnt lgkmcnt(8)
  v_mfma_f32_16x16x32_bf16 v[112:115], a[0:3], v[176:179], 0
  v_mfma_f32_16x16x32_bf16 v[116:119], a[4:7], v[176:179], 0
  v_mfma_f32_16x16x32_bf16 v[120:123], a[8:11], v[176:179], 0
  ds_read_b128 v[212:215], v19 offset:10240
  s_waitcnt lgkmcnt(8)
  v_mfma_f32_16x16x32_bf16 v[124:127], a[0:3], v[180:183], 0
  v_mfma_f32_16x16x32_bf16 v[128:131], a[4:7], v[180:183], 0
  v_mfma_f32_16x16x32_bf16 v[132:135], a[8:11], v[180:183], 0
  s_add_u32 s46, s46, 10240
  s_add_u32 m0, s47, 3072
  s_nop 0
  buffer_load_dwordx4 v10, s[8:11], s46 offen lds
  ds_read_b128 v[216:219], v19 offset:12288
  s_waitcnt lgkmcnt(8)
  v_mfma_f32_16x16x32_bf16 v[136:139], a[0:3], v[184:187], 0
  v_mfma_f32_16x16x32_bf16 v[140:143], a[4:7], v[184:187], 0
  v_mfma_f32_16x16x32_bf16 v[144:147], a[8:11], v[184:187], 0
  ds_read_b128 v[220:223], v19 offset:14336
  s_waitcnt lgkmcnt(8)
  v_mfma_f32_16x16x32_bf16 v[148:151], a[0:3], v[188:191], 0
  v_mfma_f32_16x16x32_bf16 v[152:155], a[4:7], v[188:191], 0
  v_mfma_f32_16x16x32_bf16 v[156:159], a[8:11], v[188:191], 0
  s_waitcnt vmcnt(12)
  s_barrier
  s_add_u32 s30, s30, 128
  s_add_u32 s31, s31, 1
  s_cmp_lt_u32 s31, 10
  s_cbranch_scc1 qb_271
  s_mov_b32 s31, 0
  s_add_u32 s30, s30, s25
  s_sub_u32 s30, s30, 1280

qb_271:
  s_add_u32 s32, s32, 16384
  s_cmp_lt_u32 s32, 98304
  s_cselect_b32 s32, s32, 0
  s_mul_i32 s46, s20, 40960
  s_add_u32 s46, s46, s30
  s_lshl_b32 s47, s20, 12
  s_add_u32 s47, s47, s32
  v_add_u32 v18, s33, v14
  v_add_u32 v19, s33, v15
  s_add_u32 s33, s33, 16384
  s_cmp_lt_u32 s33, 98304
  s_cselect_b32 s33, s33, 0
  ds_read_b128 v[160:163], v18 offset:0
  s_waitcnt lgkmcnt(8)
  v_mfma_f32_16x16x32_bf16 v[64:67], a[12:15], v[192:195], v[64:67]
  v_mfma_f32_16x16x32_bf16 v[68:71], a[16:19], v[192:195], v[68:71]
  v_mfma_f32_16x16x32_bf16 v[72:75], a[20:23], v[192:195], v[72:75]
  ds_read_b128 v[224:227], v23 offset:0
  ds_read_b128 v[164:167], v18 offset:2048
  s_waitcnt lgkmcnt(8)
  v_mfma_f32_16x16x32_bf16 v[76:79], a[12:15], v[196:199], v[76:79]
  v_mfma_f32_16x16x32_bf16 v[80:83], a[16:19], v[196:199], v[80:83]
  v_mfma_f32_16x16x32_bf16 v[84:87], a[20:23], v[196:199], v[84:87]
  s_add_u32 m0, s47, 0
  s_nop 0
  buffer_load_dwordx4 v10, s[8:11], s46 offen lds
  ds_read_b128 v[168:171], v18 offset:4096
  s_waitcnt lgkmcnt(8)
  v_mfma_f32_16x16x32_bf16 v[88:91], a[12:15], v[200:203], v[88:91]
  v_mfma_f32_16x16x32_bf16 v[92:95], a[16:19], v[200:203], v[92:95]
  v_mfma_f32_16x16x32_bf16 v[96:99], a[20:23], v[200:203], v[96:99]
  ds_read_b128 v[172:175], v18 offset:6144
  s_waitcnt lgkmcnt(8)
  v_mfma_f32_16x16x32_bf16 v[100:103], a[12:15], v[204:207], v[100:103]
  v_mfma_f32_16x16x32_bf16 v[104:107], a[16:19], v[204:207], v[104:107]
  v_mfma_f32_16x16x32_bf16 v[108:111], a[20:23], v[204:207], v[108:111]
  ds_read_b128 v[176:179], v18 offset:8192
  s_waitcnt lgkmcnt(8)
  v_mfma_f32_16x16x32_bf16 v[112:115], a[12:15], v[208:211], v[112:115]
  v_mfma_f32_16x16x32_bf16 v[116:119], a[16:19], v[208:211], v[116:119]
  v_mfma_f32_16x16x32_bf16 v[120:123], a[20:23], v[208:211], v[120:123]
  ds_read_b128 v[228:231], v24 offset:0
  ds_read_b128 v[180:183], v18 offset:10240
  s_waitcnt lgkmcnt(8)
  v_mfma_f32_16x16x32_bf16 v[124:127], a[12:15], v[212:215], v[124:127]
  v_mfma_f32_16x16x32_bf16 v[128:131], a[16:19], v[212:215], v[128:131]
  v_mfma_f32_16x16x32_bf16 v[132:135], a[20:23], v[212:215], v[132:135]
  s_add_u32 s46, s46, 10240
  s_add_u32 m0, s47, 1024
  s_nop 0
  buffer_load_dwordx4 v10, s[8:11], s46 offen lds
  ds_read_b128 v[184:187], v18 offset:12288
  s_waitcnt lgkmcnt(8)
  v_mfma_f32_16x16x32_bf16 v[136:139], a[12:15], v[216:219], v[136:139]
  v_mfma_f32_16x16x32_bf16 v[140:143], a[16:19], v[216:219], v[140:143]
  v_mfma_f32_16x16x32_bf16 v[144:147], a[20:23], v[216:219], v[144:147]
  ds_read_b128 v[188:191], v18 offset:14336
  s_waitcnt lgkmcnt(8)
  v_mfma_f32_16x16x32_bf16 v[148:151], a[12:15], v[220:223], v[148:151]
  v_mfma_f32_16x16x32_bf16 v[152:155], a[16:19], v[220:223], v[152:155]
  v_mfma_f32_16x16x32_bf16 v[156:159], a[20:23], v[220:223], v[156:159]
  ds_read_b128 v[192:195], v19 offset:0
  s_waitcnt lgkmcnt(8)
  v_mfma_f32_16x16x32_bf16 v[64:67], a[24:27], v[160:163], v[64:67]
  v_mfma_f32_16x16x32_bf16 v[68:71], a[28:31], v[160:163], v[68:71]
  v_mfma_f32_16x16x32_bf16 v[72:75], a[32:35], v[160:163], v[72:75]
  ds_read_b128 v[232:235], v25 offset:0
  ds_read_b128 v[196:199], v19 offset:2048
  s_waitcnt lgkmcnt(8)
  v_mfma_f32_16x16x32_bf16 v[76:79], a[24:27], v[164:167], v[76:79]
  v_mfma_f32_16x16x32_bf16 v[80:83], a[28:31], v[164:167], v[80:83]
  v_mfma_f32_16x16x32_bf16 v[84:87], a[32:35], v[164:167], v[84:87]
  s_add_u32 s46, s46, 10240
  s_add_u32 m0, s47, 2048
  s_nop 0
  buffer_load_dwordx4 v10, s[8:11], s46 offen lds
  ds_read_b128 v[200:203], v19 offset:4096
  s_waitcnt lgkmcnt(8)
  v_mfma_f32_16x16x32_bf16 v[88:91], a[24:27], v[168:171], v[88:91]
  v_mfma_f32_16x16x32_bf16 v[92:95], a[28:31], v[168:171], v[92:95]
  v_mfma_f32_16x16x32_bf16 v[96:99], a[32:35], v[168:171], v[96:99]
  ds_read_b128 v[204:207], v19 offset:6144
  s_waitcnt lgkmcnt(8)
  v_mfma_f32_16x16x32_bf16 v[100:103], a[24:27], v[172:175], v[100:103]
  v_mfma_f32_16x16x32_bf16 v[104:107], a[28:31], v[172:175], v[104:107]
  v_mfma_f32_16x16x32_bf16 v[108:111], a[32:35], v[172:175], v[108:111]
  s_add_u32 s21, s48, 0
  buffer_store_dwordx4 v[224:227], v26, s[16:19], s21 offen sc1
  ds_read_b128 v[208:211], v19 offset:8192
  s_waitcnt lgkmcnt(8)
  v_mfma_f32_16x16x32_bf16 v[112:115], a[24:27], v[176:179], v[112:115]
  v_mfma_f32_16x16x32_bf16 v[116:119], a[28:31], v[176:179], v[116:119]
  v_mfma_f32_16x16x32_bf16 v[120:123], a[32:35], v[176:179], v[120:123]
  ds_read_b128 v[236:239], v23 offset:3200
  ds_read_b128 v[212:215], v19 offset:10240
  s_waitcnt lgkmcnt(8)
  v_mfma_f32_16x16x32_bf16 v[124:127], a[24:27], v[180:183], v[124:127]
  v_mfma_f32_16x16x32_bf16 v[128:131], a[28:31], v[180:183], v[128:131]
  v_mfma_f32_16x16x32_bf16 v[132:135], a[32:35], v[180:183], v[132:135]
  s_add_u32 s46, s46, 10240
  s_add_u32 m0, s47, 3072
  s_nop 0
  buffer_load_dwordx4 v10, s[8:11], s46 offen lds
  ds_read_b128 v[216:219], v19 offset:12288
  s_waitcnt lgkmcnt(8)
  v_mfma_f32_16x16x32_bf16 v[136:139], a[24:27], v[184:187], v[136:139]
  v_mfma_f32_16x16x32_bf16 v[140:143], a[28:31], v[184:187], v[140:143]
  v_mfma_f32_16x16x32_bf16 v[144:147], a[32:35], v[184:187], v[144:147]
  s_add_u32 s21, s48, 0
  buffer_store_dwordx4 v[228:231], v27, s[16:19], s21 offen sc1
  ds_read_b128 v[220:223], v19 offset:14336
  s_waitcnt lgkmcnt(8)
  v_mfma_f32_16x16x32_bf16 v[148:151], a[24:27], v[188:191], v[148:151]
  v_mfma_f32_16x16x32_bf16 v[152:155], a[28:31], v[188:191], v[152:155]
  v_mfma_f32_16x16x32_bf16 v[156:159], a[32:35], v[188:191], v[156:159]
  s_waitcnt vmcnt(14)
  s_barrier
  s_add_u32 s30, s30, 128
  s_add_u32 s31, s31, 1
  s_cmp_lt_u32 s31, 10
  s_cbranch_scc1 qb_272
  s_mov_b32 s31, 0
  s_add_u32 s30, s30, s25
  s_sub_u32 s30, s30, 1280

qb_272:
  s_add_u32 s32, s32, 16384
  s_cmp_lt_u32 s32, 98304
  s_cselect_b32 s32, s32, 0
  s_mul_i32 s46, s20, 40960
  s_add_u32 s46, s46, s30
  s_lshl_b32 s47, s20, 12
  s_add_u32 s47, s47, s32
  v_add_u32 v18, s33, v14
  v_add_u32 v19, s33, v15
  s_add_u32 s33, s33, 16384
  s_cmp_lt_u32 s33, 98304
  s_cselect_b32 s33, s33, 0
  ds_read_b128 v[160:163], v18 offset:0
  s_waitcnt lgkmcnt(8)
  v_mfma_f32_16x16x32_bf16 v[64:67], a[36:39], v[192:195], v[64:67]
  v_mfma_f32_16x16x32_bf16 v[68:71], a[40:43], v[192:195], v[68:71]
  v_mfma_f32_16x16x32_bf16 v[72:75], a[44:47], v[192:195], v[72:75]
  ds_read_b128 v[240:243], v24 offset:3200
  ds_read_b128 v[164:167], v18 offset:2048
  s_waitcnt lgkmcnt(8)
  v_mfma_f32_16x16x32_bf16 v[76:79], a[36:39], v[196:199], v[76:79]
  v_mfma_f32_16x16x32_bf16 v[80:83], a[40:43], v[196:199], v[80:83]
  v_mfma_f32_16x16x32_bf16 v[84:87], a[44:47], v[196:199], v[84:87]
  s_add_u32 m0, s47, 0
  s_nop 0
  buffer_load_dwordx4 v10, s[8:11], s46 offen lds
  ds_read_b128 v[168:171], v18 offset:4096
  s_waitcnt lgkmcnt(8)
  v_mfma_f32_16x16x32_bf16 v[88:91], a[36:39], v[200:203], v[88:91]
  v_mfma_f32_16x16x32_bf16 v[92:95], a[40:43], v[200:203], v[92:95]
  v_mfma_f32_16x16x32_bf16 v[96:99], a[44:47], v[200:203], v[96:99]
  ds_read_b128 v[172:175], v18 offset:6144
  s_waitcnt lgkmcnt(8)
  v_mfma_f32_16x16x32_bf16 v[100:103], a[36:39], v[204:207], v[100:103]
  v_mfma_f32_16x16x32_bf16 v[104:107], a[40:43], v[204:207], v[104:107]
  v_mfma_f32_16x16x32_bf16 v[108:111], a[44:47], v[204:207], v[108:111]
  s_add_u32 s21, s48, 0
  buffer_store_dwordx4 v[232:235], v28, s[16:19], s21 offen sc1
  ds_read_b128 v[176:179], v18 offset:8192
  s_waitcnt lgkmcnt(8)
  v_mfma_f32_16x16x32_bf16 v[112:115], a[36:39], v[208:211], v[112:115]
  v_mfma_f32_16x16x32_bf16 v[116:119], a[40:43], v[208:211], v[116:119]
  v_mfma_f32_16x16x32_bf16 v[120:123], a[44:47], v[208:211], v[120:123]
  ds_read_b128 v[244:247], v25 offset:3200
  ds_read_b128 v[180:183], v18 offset:10240
  s_waitcnt lgkmcnt(8)
  v_mfma_f32_16x16x32_bf16 v[124:127], a[36:39], v[212:215], v[124:127]
  v_mfma_f32_16x16x32_bf16 v[128:131], a[40:43], v[212:215], v[128:131]
  v_mfma_f32_16x16x32_bf16 v[132:135], a[44:47], v[212:215], v[132:135]
  s_add_u32 s46, s46, 10240
  s_add_u32 m0, s47, 1024
  s_nop 0
  buffer_load_dwordx4 v10, s[8:11], s46 offen lds
  ds_read_b128 v[184:187], v18 offset:12288
  s_waitcnt lgkmcnt(8)
  v_mfma_f32_16x16x32_bf16 v[136:139], a[36:39], v[216:219], v[136:139]
  v_mfma_f32_16x16x32_bf16 v[140:143], a[40:43], v[216:219], v[140:143]
  v_mfma_f32_16x16x32_bf16 v[144:147], a[44:47], v[216:219], v[144:147]
  s_add_u32 s21, s48, 30720
  buffer_store_dwordx4 v[236:239], v26, s[16:19], s21 offen sc1
  ds_read_b128 v[188:191], v18 offset:14336
  s_waitcnt lgkmcnt(8)
  v_mfma_f32_16x16x32_bf16 v[148:151], a[36:39], v[220:223], v[148:151]
  v_mfma_f32_16x16x32_bf16 v[152:155], a[40:43], v[220:223], v[152:155]
  v_mfma_f32_16x16x32_bf16 v[156:159], a[44:47], v[220:223], v[156:159]
  ds_read_b128 v[192:195], v19 offset:0
  s_waitcnt lgkmcnt(8)
  v_mfma_f32_16x16x32_bf16 v[64:67], a[48:51], v[160:163], v[64:67]
  v_mfma_f32_16x16x32_bf16 v[68:71], a[52:55], v[160:163], v[68:71]
  v_mfma_f32_16x16x32_bf16 v[72:75], a[56:59], v[160:163], v[72:75]
  ds_read_b128 v[224:227], v23 offset:6400
  ds_read_b128 v[196:199], v19 offset:2048
  s_waitcnt lgkmcnt(8)
  v_mfma_f32_16x16x32_bf16 v[76:79], a[48:51], v[164:167], v[76:79]
  v_mfma_f32_16x16x32_bf16 v[80:83], a[52:55], v[164:167], v[80:83]
  v_mfma_f32_16x16x32_bf16 v[84:87], a[56:59], v[164:167], v[84:87]
  s_add_u32 s46, s46, 10240
  s_add_u32 m0, s47, 2048
  s_nop 0
  buffer_load_dwordx4 v10, s[8:11], s46 offen lds
  ds_read_b128 v[200:203], v19 offset:4096
  s_waitcnt lgkmcnt(8)
  v_mfma_f32_16x16x32_bf16 v[88:91], a[48:51], v[168:171], v[88:91]
  v_mfma_f32_16x16x32_bf16 v[92:95], a[52:55], v[168:171], v[92:95]
  v_mfma_f32_16x16x32_bf16 v[96:99], a[56:59], v[168:171], v[96:99]
  ds_read_b128 v[204:207], v19 offset:6144
  s_waitcnt lgkmcnt(8)
  v_mfma_f32_16x16x32_bf16 v[100:103], a[48:51], v[172:175], v[100:103]
  v_mfma_f32_16x16x32_bf16 v[104:107], a[52:55], v[172:175], v[104:107]
  v_mfma_f32_16x16x32_bf16 v[108:111], a[56:59], v[172:175], v[108:111]
  s_add_u32 s21, s48, 30720
  buffer_store_dwordx4 v[240:243], v27, s[16:19], s21 offen sc1
  ds_read_b128 v[208:211], v19 offset:8192
  s_waitcnt lgkmcnt(8)
  v_mfma_f32_16x16x32_bf16 v[112:115], a[48:51], v[176:179], v[112:115]
  v_mfma_f32_16x16x32_bf16 v[116:119], a[52:55], v[176:179], v[116:119]
  v_mfma_f32_16x16x32_bf16 v[120:123], a[56:59], v[176:179], v[120:123]
  ds_read_b128 v[228:231], v24 offset:6400
  ds_read_b128 v[212:215], v19 offset:10240
  s_waitcnt lgkmcnt(8)
  v_mfma_f32_16x16x32_bf16 v[124:127], a[48:51], v[180:183], v[124:127]
  v_mfma_f32_16x16x32_bf16 v[128:131], a[52:55], v[180:183], v[128:131]
  v_mfma_f32_16x16x32_bf16 v[132:135], a[56:59], v[180:183], v[132:135]
  s_add_u32 s46, s46, 10240
  s_add_u32 m0, s47, 3072
  s_nop 0
  buffer_load_dwordx4 v10, s[8:11], s46 offen lds
  ds_read_b128 v[216:219], v19 offset:12288
  s_waitcnt lgkmcnt(8)
  v_mfma_f32_16x16x32_bf16 v[136:139], a[48:51], v[184:187], v[136:139]
  v_mfma_f32_16x16x32_bf16 v[140:143], a[52:55], v[184:187], v[140:143]
  v_mfma_f32_16x16x32_bf16 v[144:147], a[56:59], v[184:187], v[144:147]
  s_add_u32 s21, s48, 30720
  buffer_store_dwordx4 v[244:247], v28, s[16:19], s21 offen sc1
  ds_read_b128 v[220:223], v19 offset:14336
  s_waitcnt lgkmcnt(8)
  v_mfma_f32_16x16x32_bf16 v[148:151], a[48:51], v[188:191], v[148:151]
  v_mfma_f32_16x16x32_bf16 v[152:155], a[52:55], v[188:191], v[152:155]
  v_mfma_f32_16x16x32_bf16 v[156:159], a[56:59], v[188:191], v[156:159]
  s_waitcnt vmcnt(18)
  s_barrier
  s_add_u32 s30, s30, 128
  s_add_u32 s31, s31, 1
  s_cmp_lt_u32 s31, 10
  s_cbranch_scc1 qb_273
  s_mov_b32 s31, 0
  s_add_u32 s30, s30, s25
  s_sub_u32 s30, s30, 1280

qb_273:
  s_add_u32 s32, s32, 16384
  s_cmp_lt_u32 s32, 98304
  s_cselect_b32 s32, s32, 0
  s_mul_i32 s46, s20, 40960
  s_add_u32 s46, s46, s30
  s_lshl_b32 s47, s20, 12
  s_add_u32 s47, s47, s32
  v_add_u32 v18, s33, v14
  v_add_u32 v19, s33, v15
  s_add_u32 s33, s33, 16384
  s_cmp_lt_u32 s33, 98304
  s_cselect_b32 s33, s33, 0
  ds_read_b128 v[160:163], v18 offset:0
  s_waitcnt lgkmcnt(8)
  v_mfma_f32_16x16x32_bf16 v[64:67], a[60:63], v[192:195], v[64:67]
  v_mfma_f32_16x16x32_bf16 v[68:71], a[64:67], v[192:195], v[68:71]
  v_mfma_f32_16x16x32_bf16 v[72:75], a[68:71], v[192:195], v[72:75]
  ds_read_b128 v[232:235], v25 offset:6400
  ds_read_b128 v[164:167], v18 offset:2048
  s_waitcnt lgkmcnt(8)
  v_mfma_f32_16x16x32_bf16 v[76:79], a[60:63], v[196:199], v[76:79]
  v_mfma_f32_16x16x32_bf16 v[80:83], a[64:67], v[196:199], v[80:83]
  v_mfma_f32_16x16x32_bf16 v[84:87], a[68:71], v[196:199], v[84:87]
  s_add_u32 m0, s47, 0
  s_nop 0
  buffer_load_dwordx4 v10, s[8:11], s46 offen lds
  ds_read_b128 v[168:171], v18 offset:4096
  s_waitcnt lgkmcnt(8)
  v_mfma_f32_16x16x32_bf16 v[88:91], a[60:63], v[200:203], v[88:91]
  v_mfma_f32_16x16x32_bf16 v[92:95], a[64:67], v[200:203], v[92:95]
  v_mfma_f32_16x16x32_bf16 v[96:99], a[68:71], v[200:203], v[96:99]
  ds_read_b128 v[172:175], v18 offset:6144
  s_waitcnt lgkmcnt(8)
  v_mfma_f32_16x16x32_bf16 v[100:103], a[60:63], v[204:207], v[100:103]
  v_mfma_f32_16x16x32_bf16 v[104:107], a[64:67], v[204:207], v[104:107]
  v_mfma_f32_16x16x32_bf16 v[108:111], a[68:71], v[204:207], v[108:111]
  s_add_u32 s21, s48, 61440
  buffer_store_dwordx4 v[224:227], v26, s[16:19], s21 offen sc1
  ds_read_b128 v[176:179], v18 offset:8192
  s_waitcnt lgkmcnt(8)
  v_mfma_f32_16x16x32_bf16 v[112:115], a[60:63], v[208:211], v[112:115]
  v_mfma_f32_16x16x32_bf16 v[116:119], a[64:67], v[208:211], v[116:119]
  v_mfma_f32_16x16x32_bf16 v[120:123], a[68:71], v[208:211], v[120:123]
  ds_read_b128 v[236:239], v23 offset:9600
  ds_read_b128 v[180:183], v18 offset:10240
  s_waitcnt lgkmcnt(8)
  v_mfma_f32_16x16x32_bf16 v[124:127], a[60:63], v[212:215], v[124:127]
  v_mfma_f32_16x16x32_bf16 v[128:131], a[64:67], v[212:215], v[128:131]
  v_mfma_f32_16x16x32_bf16 v[132:135], a[68:71], v[212:215], v[132:135]
  s_add_u32 s46, s46, 10240
  s_add_u32 m0, s47, 1024
  s_nop 0
  buffer_load_dwordx4 v10, s[8:11], s46 offen lds
  ds_read_b128 v[184:187], v18 offset:12288
  s_waitcnt lgkmcnt(8)
  v_mfma_f32_16x16x32_bf16 v[136:139], a[60:63], v[216:219], v[136:139]
  v_mfma_f32_16x16x32_bf16 v[140:143], a[64:67], v[216:219], v[140:143]
  v_mfma_f32_16x16x32_bf16 v[144:147], a[68:71], v[216:219], v[144:147]
  s_add_u32 s21, s48, 61440
  buffer_store_dwordx4 v[228:231], v27, s[16:19], s21 offen sc1
  ds_read_b128 v[188:191], v18 offset:14336
  s_waitcnt lgkmcnt(8)
  v_mfma_f32_16x16x32_bf16 v[148:151], a[60:63], v[220:223], v[148:151]
  v_mfma_f32_16x16x32_bf16 v[152:155], a[64:67], v[220:223], v[152:155]
  v_mfma_f32_16x16x32_bf16 v[156:159], a[68:71], v[220:223], v[156:159]
  ds_read_b128 v[192:195], v19 offset:0
  s_waitcnt lgkmcnt(8)
  v_mfma_f32_16x16x32_bf16 v[64:67], a[72:75], v[160:163], v[64:67]
  v_mfma_f32_16x16x32_bf16 v[68:71], a[76:79], v[160:163], v[68:71]
  v_mfma_f32_16x16x32_bf16 v[72:75], a[80:83], v[160:163], v[72:75]
  ds_read_b128 v[240:243], v24 offset:9600
  ds_read_b128 v[196:199], v19 offset:2048
  s_waitcnt lgkmcnt(8)
  v_mfma_f32_16x16x32_bf16 v[76:79], a[72:75], v[164:167], v[76:79]
  v_mfma_f32_16x16x32_bf16 v[80:83], a[76:79], v[164:167], v[80:83]
  v_mfma_f32_16x16x32_bf16 v[84:87], a[80:83], v[164:167], v[84:87]
  s_add_u32 s46, s46, 10240
  s_add_u32 m0, s47, 2048
  s_nop 0
  buffer_load_dwordx4 v10, s[8:11], s46 offen lds
  ds_read_b128 v[200:203], v19 offset:4096
  s_waitcnt lgkmcnt(8)
  v_mfma_f32_16x16x32_bf16 v[88:91], a[72:75], v[168:171], v[88:91]
  v_mfma_f32_16x16x32_bf16 v[92:95], a[76:79], v[168:171], v[92:95]
  v_mfma_f32_16x16x32_bf16 v[96:99], a[80:83], v[168:171], v[96:99]
  ds_read_b128 v[204:207], v19 offset:6144
  s_waitcnt lgkmcnt(8)
  v_mfma_f32_16x16x32_bf16 v[100:103], a[72:75], v[172:175], v[100:103]
  v_mfma_f32_16x16x32_bf16 v[104:107], a[76:79], v[172:175], v[104:107]
  v_mfma_f32_16x16x32_bf16 v[108:111], a[80:83], v[172:175], v[108:111]
  s_add_u32 s21, s48, 61440
  buffer_store_dwordx4 v[232:235], v28, s[16:19], s21 offen sc1
  ds_read_b128 v[208:211], v19 offset:8192
  s_waitcnt lgkmcnt(8)
  v_mfma_f32_16x16x32_bf16 v[112:115], a[72:75], v[176:179], v[112:115]
  v_mfma_f32_16x16x32_bf16 v[116:119], a[76:79], v[176:179], v[116:119]
  v_mfma_f32_16x16x32_bf16 v[120:123], a[80:83], v[176:179], v[120:123]
  ds_read_b128 v[244:247], v25 offset:9600
  ds_read_b128 v[212:215], v19 offset:10240
  s_waitcnt lgkmcnt(8)
  v_mfma_f32_16x16x32_bf16 v[124:127], a[72:75], v[180:183], v[124:127]
  v_mfma_f32_16x16x32_bf16 v[128:131], a[76:79], v[180:183], v[128:131]
  v_mfma_f32_16x16x32_bf16 v[132:135], a[80:83], v[180:183], v[132:135]
  s_add_u32 s46, s46, 10240
  s_add_u32 m0, s47, 3072
  s_nop 0
  buffer_load_dwordx4 v10, s[8:11], s46 offen lds
  ds_read_b128 v[216:219], v19 offset:12288
  s_waitcnt lgkmcnt(8)
  v_mfma_f32_16x16x32_bf16 v[136:139], a[72:75], v[184:187], v[136:139]
  v_mfma_f32_16x16x32_bf16 v[140:143], a[76:79], v[184:187], v[140:143]
  v_mfma_f32_16x16x32_bf16 v[144:147], a[80:83], v[184:187], v[144:147]
  s_add_u32 s21, s48, 92160
  buffer_store_dwordx4 v[236:239], v26, s[16:19], s21 offen sc1
  ds_read_b128 v[220:223], v19 offset:14336
  s_waitcnt lgkmcnt(8)
  v_mfma_f32_16x16x32_bf16 v[148:151], a[72:75], v[188:191], v[148:151]
  v_mfma_f32_16x16x32_bf16 v[152:155], a[76:79], v[188:191], v[152:155]
  v_mfma_f32_16x16x32_bf16 v[156:159], a[80:83], v[188:191], v[156:159]
  s_waitcnt vmcnt(22)
  s_barrier
  s_add_u32 s30, s30, 128
  s_add_u32 s31, s31, 1
  s_cmp_lt_u32 s31, 10
  s_cbranch_scc1 qb_274
  s_mov_b32 s31, 0
  s_add_u32 s30, s30, s25
  s_sub_u32 s30, s30, 1280

qb_274:
  s_add_u32 s32, s32, 16384
  s_cmp_lt_u32 s32, 98304
  s_cselect_b32 s32, s32, 0
  s_mul_i32 s46, s20, 40960
  s_add_u32 s46, s46, s30
  s_lshl_b32 s47, s20, 12
  s_add_u32 s47, s47, s32
  v_add_u32 v18, s33, v14
  v_add_u32 v19, s33, v15
  s_add_u32 s33, s33, 16384
  s_cmp_lt_u32 s33, 98304
  s_cselect_b32 s33, s33, 0
  ds_read_b128 v[160:163], v18 offset:0
  s_waitcnt lgkmcnt(8)
  v_mfma_f32_16x16x32_bf16 v[64:67], a[84:87], v[192:195], v[64:67]
  v_mfma_f32_16x16x32_bf16 v[68:71], a[88:91], v[192:195], v[68:71]
  v_mfma_f32_16x16x32_bf16 v[72:75], a[92:95], v[192:195], v[72:75]
  ds_read_b128 v[164:167], v18 offset:2048
  s_waitcnt lgkmcnt(8)
  v_mfma_f32_16x16x32_bf16 v[76:79], a[84:87], v[196:199], v[76:79]
  v_mfma_f32_16x16x32_bf16 v[80:83], a[88:91], v[196:199], v[80:83]
  v_mfma_f32_16x16x32_bf16 v[84:87], a[92:95], v[196:199], v[84:87]
  s_add_u32 m0, s47, 0
  s_nop 0
  buffer_load_dwordx4 v10, s[8:11], s46 offen lds
  ds_read_b128 v[168:171], v18 offset:4096
  s_waitcnt lgkmcnt(8)
  v_mfma_f32_16x16x32_bf16 v[88:91], a[84:87], v[200:203], v[88:91]
  v_mfma_f32_16x16x32_bf16 v[92:95], a[88:91], v[200:203], v[92:95]
  v_mfma_f32_16x16x32_bf16 v[96:99], a[92:95], v[200:203], v[96:99]
  ds_read_b128 v[172:175], v18 offset:6144
  s_waitcnt lgkmcnt(8)
  v_mfma_f32_16x16x32_bf16 v[100:103], a[84:87], v[204:207], v[100:103]
  v_mfma_f32_16x16x32_bf16 v[104:107], a[88:91], v[204:207], v[104:107]
  v_mfma_f32_16x16x32_bf16 v[108:111], a[92:95], v[204:207], v[108:111]
  s_add_u32 s21, s48, 92160
  buffer_store_dwordx4 v[240:243], v27, s[16:19], s21 offen sc1
  ds_read_b128 v[176:179], v18 offset:8192
  s_waitcnt lgkmcnt(8)
  v_mfma_f32_16x16x32_bf16 v[112:115], a[84:87], v[208:211], v[112:115]
  v_mfma_f32_16x16x32_bf16 v[116:119], a[88:91], v[208:211], v[116:119]
  v_mfma_f32_16x16x32_bf16 v[120:123], a[92:95], v[208:211], v[120:123]
  ds_read_b128 v[180:183], v18 offset:10240
  s_waitcnt lgkmcnt(8)
  v_mfma_f32_16x16x32_bf16 v[124:127], a[84:87], v[212:215], v[124:127]
  v_mfma_f32_16x16x32_bf16 v[128:131], a[88:91], v[212:215], v[128:131]
  v_mfma_f32_16x16x32_bf16 v[132:135], a[92:95], v[212:215], v[132:135]
  s_add_u32 s46, s46, 10240
  s_add_u32 m0, s47, 1024
  s_nop 0
  buffer_load_dwordx4 v10, s[8:11], s46 offen lds
  ds_read_b128 v[184:187], v18 offset:12288
  s_waitcnt lgkmcnt(8)
  v_mfma_f32_16x16x32_bf16 v[136:139], a[84:87], v[216:219], v[136:139]
  v_mfma_f32_16x16x32_bf16 v[140:143], a[88:91], v[216:219], v[140:143]
  v_mfma_f32_16x16x32_bf16 v[144:147], a[92:95], v[216:219], v[144:147]
  s_add_u32 s21, s48, 92160
  buffer_store_dwordx4 v[244:247], v28, s[16:19], s21 offen sc1
  ds_read_b128 v[188:191], v18 offset:14336
  s_waitcnt lgkmcnt(8)
  v_mfma_f32_16x16x32_bf16 v[148:151], a[84:87], v[220:223], v[148:151]
  v_mfma_f32_16x16x32_bf16 v[152:155], a[88:91], v[220:223], v[152:155]
  v_mfma_f32_16x16x32_bf16 v[156:159], a[92:95], v[220:223], v[156:159]
  ds_read_b128 v[192:195], v19 offset:0
  s_waitcnt lgkmcnt(8)
  v_mfma_f32_16x16x32_bf16 v[64:67], a[96:99], v[160:163], v[64:67]
  v_mfma_f32_16x16x32_bf16 v[68:71], a[100:103], v[160:163], v[68:71]
  v_mfma_f32_16x16x32_bf16 v[72:75], a[104:107], v[160:163], v[72:75]
  ds_read_b128 v[196:199], v19 offset:2048
  s_waitcnt lgkmcnt(8)
  v_mfma_f32_16x16x32_bf16 v[76:79], a[96:99], v[164:167], v[76:79]
  v_mfma_f32_16x16x32_bf16 v[80:83], a[100:103], v[164:167], v[80:83]
  v_mfma_f32_16x16x32_bf16 v[84:87], a[104:107], v[164:167], v[84:87]
  s_add_u32 s46, s46, 10240
  s_add_u32 m0, s47, 2048
  s_nop 0
  buffer_load_dwordx4 v10, s[8:11], s46 offen lds
  ds_read_b128 v[200:203], v19 offset:4096
  s_waitcnt lgkmcnt(8)
  v_mfma_f32_16x16x32_bf16 v[88:91], a[96:99], v[168:171], v[88:91]
  v_mfma_f32_16x16x32_bf16 v[92:95], a[100:103], v[168:171], v[92:95]
  v_mfma_f32_16x16x32_bf16 v[96:99], a[104:107], v[168:171], v[96:99]
  ds_read_b128 v[204:207], v19 offset:6144
  s_waitcnt lgkmcnt(8)
  v_mfma_f32_16x16x32_bf16 v[100:103], a[96:99], v[172:175], v[100:103]
  v_mfma_f32_16x16x32_bf16 v[104:107], a[100:103], v[172:175], v[104:107]
  v_mfma_f32_16x16x32_bf16 v[108:111], a[104:107], v[172:175], v[108:111]
  ds_read_b128 v[208:211], v19 offset:8192
  s_waitcnt lgkmcnt(8)
  v_mfma_f32_16x16x32_bf16 v[112:115], a[96:99], v[176:179], v[112:115]
  v_mfma_f32_16x16x32_bf16 v[116:119], a[100:103], v[176:179], v[116:119]
  v_mfma_f32_16x16x32_bf16 v[120:123], a[104:107], v[176:179], v[120:123]
  ds_read_b128 v[212:215], v19 offset:10240
  s_waitcnt lgkmcnt(8)
  v_mfma_f32_16x16x32_bf16 v[124:127], a[96:99], v[180:183], v[124:127]
  v_mfma_f32_16x16x32_bf16 v[128:131], a[100:103], v[180:183], v[128:131]
  v_mfma_f32_16x16x32_bf16 v[132:135], a[104:107], v[180:183], v[132:135]
  s_add_u32 s46, s46, 10240
  s_add_u32 m0, s47, 3072
  s_nop 0
  buffer_load_dwordx4 v10, s[8:11], s46 offen lds
  ds_read_b128 v[216:219], v19 offset:12288
  s_waitcnt lgkmcnt(8)
  v_mfma_f32_16x16x32_bf16 v[136:139], a[96:99], v[184:187], v[136:139]
  v_mfma_f32_16x16x32_bf16 v[140:143], a[100:103], v[184:187], v[140:143]
  v_mfma_f32_16x16x32_bf16 v[144:147], a[104:107], v[184:187], v[144:147]
  ds_read_b128 v[220:223], v19 offset:14336
  s_waitcnt lgkmcnt(8)
  v_mfma_f32_16x16x32_bf16 v[148:151], a[96:99], v[188:191], v[148:151]
  v_mfma_f32_16x16x32_bf16 v[152:155], a[100:103], v[188:191], v[152:155]
  v_mfma_f32_16x16x32_bf16 v[156:159], a[104:107], v[188:191], v[156:159]
  s_waitcnt vmcnt(23)
  s_barrier
  s_add_u32 s30, s30, 128
  s_add_u32 s31, s31, 1
  s_cmp_lt_u32 s31, 10
  s_cbranch_scc1 qb_275
  s_mov_b32 s31, 0
  s_add_u32 s30, s30, s25
  s_sub_u32 s30, s30, 1280

qb_275:
  s_add_u32 s32, s32, 16384
  s_cmp_lt_u32 s32, 98304
  s_cselect_b32 s32, s32, 0
  s_mul_i32 s46, s20, 40960
  s_add_u32 s46, s46, s30
  s_lshl_b32 s47, s20, 12
  s_add_u32 s47, s47, s32
  v_add_u32 v18, s33, v14
  v_add_u32 v19, s33, v15
  s_add_u32 s33, s33, 16384
  s_cmp_lt_u32 s33, 98304
  s_cselect_b32 s33, s33, 0
  ds_read_b128 v[160:163], v18 offset:0
  s_waitcnt lgkmcnt(8)
  v_mfma_f32_16x16x32_bf16 v[64:67], a[108:111], v[192:195], v[64:67]
  v_mfma_f32_16x16x32_bf16 v[68:71], a[112:115], v[192:195], v[68:71]
  v_mfma_f32_16x16x32_bf16 v[72:75], a[116:119], v[192:195], v[72:75]
  ds_read_b128 v[164:167], v18 offset:2048
  s_waitcnt lgkmcnt(8)
  v_mfma_f32_16x16x32_bf16 v[76:79], a[108:111], v[196:199], v[76:79]
  v_mfma_f32_16x16x32_bf16 v[80:83], a[112:115], v[196:199], v[80:83]
  v_mfma_f32_16x16x32_bf16 v[84:87], a[116:119], v[196:199], v[84:87]
  s_add_u32 m0, s47, 0
  s_nop 0
  buffer_load_dwordx4 v10, s[8:11], s46 offen lds
  ds_read_b128 v[168:171], v18 offset:4096
  s_waitcnt lgkmcnt(8)
  v_mfma_f32_16x16x32_bf16 v[88:91], a[108:111], v[200:203], v[88:91]
  v_mfma_f32_16x16x32_bf16 v[92:95], a[112:115], v[200:203], v[92:95]
  v_mfma_f32_16x16x32_bf16 v[96:99], a[116:119], v[200:203], v[96:99]
  ds_read_b128 v[172:175], v18 offset:6144
  s_waitcnt lgkmcnt(8)
  v_mfma_f32_16x16x32_bf16 v[100:103], a[108:111], v[204:207], v[100:103]
  v_mfma_f32_16x16x32_bf16 v[104:107], a[112:115], v[204:207], v[104:107]
  v_mfma_f32_16x16x32_bf16 v[108:111], a[116:119], v[204:207], v[108:111]
  ds_read_b128 v[176:179], v18 offset:8192
  s_waitcnt lgkmcnt(8)
  v_mfma_f32_16x16x32_bf16 v[112:115], a[108:111], v[208:211], v[112:115]
  v_mfma_f32_16x16x32_bf16 v[116:119], a[112:115], v[208:211], v[116:119]
  v_mfma_f32_16x16x32_bf16 v[120:123], a[116:119], v[208:211], v[120:123]
  ds_read_b128 v[180:183], v18 offset:10240
  s_waitcnt lgkmcnt(8)
  v_mfma_f32_16x16x32_bf16 v[124:127], a[108:111], v[212:215], v[124:127]
  v_mfma_f32_16x16x32_bf16 v[128:131], a[112:115], v[212:215], v[128:131]
  v_mfma_f32_16x16x32_bf16 v[132:135], a[116:119], v[212:215], v[132:135]
  s_add_u32 s46, s46, 10240
  s_add_u32 m0, s47, 1024
  s_nop 0
  buffer_load_dwordx4 v10, s[8:11], s46 offen lds
  ds_read_b128 v[184:187], v18 offset:12288
  s_waitcnt lgkmcnt(8)
  v_mfma_f32_16x16x32_bf16 v[136:139], a[108:111], v[216:219], v[136:139]
  v_mfma_f32_16x16x32_bf16 v[140:143], a[112:115], v[216:219], v[140:143]
  v_mfma_f32_16x16x32_bf16 v[144:147], a[116:119], v[216:219], v[144:147]
  ds_read_b128 v[188:191], v18 offset:14336
  s_waitcnt lgkmcnt(8)
  v_mfma_f32_16x16x32_bf16 v[148:151], a[108:111], v[220:223], v[148:151]
  v_mfma_f32_16x16x32_bf16 v[152:155], a[112:115], v[220:223], v[152:155]
  v_mfma_f32_16x16x32_bf16 v[156:159], a[116:119], v[220:223], v[156:159]
  ds_read_b128 v[192:195], v19 offset:0
  s_waitcnt lgkmcnt(8)
  v_mfma_f32_16x16x32_bf16 v[64:67], a[120:123], v[160:163], v[64:67]
  v_mfma_f32_16x16x32_bf16 v[68:71], a[124:127], v[160:163], v[68:71]
  v_mfma_f32_16x16x32_bf16 v[72:75], a[128:131], v[160:163], v[72:75]
  ds_read_b128 v[196:199], v19 offset:2048
  s_waitcnt lgkmcnt(8)
  v_mfma_f32_16x16x32_bf16 v[76:79], a[120:123], v[164:167], v[76:79]
  v_mfma_f32_16x16x32_bf16 v[80:83], a[124:127], v[164:167], v[80:83]
  v_mfma_f32_16x16x32_bf16 v[84:87], a[128:131], v[164:167], v[84:87]
  s_add_u32 s46, s46, 10240
  s_add_u32 m0, s47, 2048
  s_nop 0
  buffer_load_dwordx4 v10, s[8:11], s46 offen lds
  ds_read_b128 v[200:203], v19 offset:4096
  s_waitcnt lgkmcnt(8)
  v_mfma_f32_16x16x32_bf16 v[88:91], a[120:123], v[168:171], v[88:91]
  v_mfma_f32_16x16x32_bf16 v[92:95], a[124:127], v[168:171], v[92:95]
  v_mfma_f32_16x16x32_bf16 v[96:99], a[128:131], v[168:171], v[96:99]
  ds_read_b128 v[204:207], v19 offset:6144
  s_waitcnt lgkmcnt(8)
  v_mfma_f32_16x16x32_bf16 v[100:103], a[120:123], v[172:175], v[100:103]
  v_mfma_f32_16x16x32_bf16 v[104:107], a[124:127], v[172:175], v[104:107]
  v_mfma_f32_16x16x32_bf16 v[108:111], a[128:131], v[172:175], v[108:111]
  ds_read_b128 v[208:211], v19 offset:8192
  s_waitcnt lgkmcnt(8)
  v_mfma_f32_16x16x32_bf16 v[112:115], a[120:123], v[176:179], v[112:115]
  v_mfma_f32_16x16x32_bf16 v[116:119], a[124:127], v[176:179], v[116:119]
  v_mfma_f32_16x16x32_bf16 v[120:123], a[128:131], v[176:179], v[120:123]
  ds_read_b128 v[212:215], v19 offset:10240
  s_waitcnt lgkmcnt(8)
  v_mfma_f32_16x16x32_bf16 v[124:127], a[120:123], v[180:183], v[124:127]
  v_mfma_f32_16x16x32_bf16 v[128:131], a[124:127], v[180:183], v[128:131]
  v_mfma_f32_16x16x32_bf16 v[132:135], a[128:131], v[180:183], v[132:135]
  s_add_u32 s46, s46, 10240
  s_add_u32 m0, s47, 3072
  s_nop 0
  buffer_load_dwordx4 v10, s[8:11], s46 offen lds
  ds_read_b128 v[216:219], v19 offset:12288
  s_waitcnt lgkmcnt(8)
  v_mfma_f32_16x16x32_bf16 v[136:139], a[120:123], v[184:187], v[136:139]
  v_mfma_f32_16x16x32_bf16 v[140:143], a[124:127], v[184:187], v[140:143]
  v_mfma_f32_16x16x32_bf16 v[144:147], a[128:131], v[184:187], v[144:147]
  ds_read_b128 v[220:223], v19 offset:14336
  s_waitcnt lgkmcnt(8)
  v_mfma_f32_16x16x32_bf16 v[148:151], a[120:123], v[188:191], v[148:151]
  v_mfma_f32_16x16x32_bf16 v[152:155], a[124:127], v[188:191], v[152:155]
  v_mfma_f32_16x16x32_bf16 v[156:159], a[128:131], v[188:191], v[156:159]
  s_waitcnt vmcnt(6)
  s_barrier
  s_cmp_eq_u32 s48, 0x80000000
  s_cbranch_scc1 qb_276
  s_cmp_lg_u32 s20, 0
  s_cbranch_scc1 af_277
  v_mov_b32 v4, 0
  v_mov_b32 v5, 1
  s_mov_b64 exec, 1
  buffer_atomic_add v5, v4, s[72:75], s61 offen sc1
  s_mov_b64 exec, -1
  s_nop 1
af_277:
qb_276:
  s_add_u32 s30, s30, 128
  s_add_u32 s31, s31, 1
  s_cmp_lt_u32 s31, 10
  s_cbranch_scc1 qb_278
  s_mov_b32 s31, 0
  s_add_u32 s30, s30, s25
  s_sub_u32 s30, s30, 1280

qb_278:
  s_add_u32 s32, s32, 16384
  s_cmp_lt_u32 s32, 98304
  s_cselect_b32 s32, s32, 0
  s_mul_i32 s46, s20, 40960
  s_add_u32 s46, s46, s30
  s_lshl_b32 s47, s20, 12
  s_add_u32 s47, s47, s32
  v_add_u32 v18, s33, v14
  v_add_u32 v19, s33, v15
  s_add_u32 s33, s33, 16384
  s_cmp_lt_u32 s33, 98304
  s_cselect_b32 s33, s33, 0
  ds_read_b128 v[160:163], v18 offset:0
  s_waitcnt lgkmcnt(8)
  v_mfma_f32_16x16x32_bf16 v[64:67], a[132:135], v[192:195], v[64:67]
  v_mfma_f32_16x16x32_bf16 v[68:71], a[136:139], v[192:195], v[68:71]
  v_mfma_f32_16x16x32_bf16 v[72:75], a[140:143], v[192:195], v[72:75]
  ds_read_b128 v[164:167], v18 offset:2048
  s_waitcnt lgkmcnt(8)
  v_mfma_f32_16x16x32_bf16 v[76:79], a[132:135], v[196:199], v[76:79]
  v_mfma_f32_16x16x32_bf16 v[80:83], a[136:139], v[196:199], v[80:83]
  v_mfma_f32_16x16x32_bf16 v[84:87], a[140:143], v[196:199], v[84:87]
  s_add_u32 m0, s47, 0
  s_nop 0
  buffer_load_dwordx4 v10, s[8:11], s46 offen lds
  ds_read_b128 v[168:171], v18 offset:4096
  s_waitcnt lgkmcnt(8)
  v_mfma_f32_16x16x32_bf16 v[88:91], a[132:135], v[200:203], v[88:91]
  v_mfma_f32_16x16x32_bf16 v[92:95], a[136:139], v[200:203], v[92:95]
  v_mfma_f32_16x16x32_bf16 v[96:99], a[140:143], v[200:203], v[96:99]
  ds_read_b128 v[172:175], v18 offset:6144
  s_waitcnt lgkmcnt(8)
  v_mfma_f32_16x16x32_bf16 v[100:103], a[132:135], v[204:207], v[100:103]
  v_mfma_f32_16x16x32_bf16 v[104:107], a[136:139], v[204:207], v[104:107]
  v_mfma_f32_16x16x32_bf16 v[108:111], a[140:143], v[204:207], v[108:111]
  ds_read_b128 v[176:179], v18 offset:8192
  s_waitcnt lgkmcnt(8)
  v_mfma_f32_16x16x32_bf16 v[112:115], a[132:135], v[208:211], v[112:115]
  v_mfma_f32_16x16x32_bf16 v[116:119], a[136:139], v[208:211], v[116:119]
  v_mfma_f32_16x16x32_bf16 v[120:123], a[140:143], v[208:211], v[120:123]
  ds_read_b128 v[180:183], v18 offset:10240
  s_waitcnt lgkmcnt(8)
  v_mfma_f32_16x16x32_bf16 v[124:127], a[132:135], v[212:215], v[124:127]
  v_mfma_f32_16x16x32_bf16 v[128:131], a[136:139], v[212:215], v[128:131]
  v_mfma_f32_16x16x32_bf16 v[132:135], a[140:143], v[212:215], v[132:135]
  s_add_u32 s46, s46, 10240
  s_add_u32 m0, s47, 1024
  s_nop 0
  buffer_load_dwordx4 v10, s[8:11], s46 offen lds
  ds_read_b128 v[184:187], v18 offset:12288
  s_waitcnt lgkmcnt(8)
  v_mfma_f32_16x16x32_bf16 v[136:139], a[132:135], v[216:219], v[136:139]
  v_mfma_f32_16x16x32_bf16 v[140:143], a[136:139], v[216:219], v[140:143]
  v_mfma_f32_16x16x32_bf16 v[144:147], a[140:143], v[216:219], v[144:147]
  ds_read_b128 v[188:191], v18 offset:14336
  s_waitcnt lgkmcnt(8)
  v_mfma_f32_16x16x32_bf16 v[148:151], a[132:135], v[220:223], v[148:151]
  v_mfma_f32_16x16x32_bf16 v[152:155], a[136:139], v[220:223], v[152:155]
  v_mfma_f32_16x16x32_bf16 v[156:159], a[140:143], v[220:223], v[156:159]
  ds_read_b128 v[192:195], v19 offset:0
  s_waitcnt lgkmcnt(8)
  v_mfma_f32_16x16x32_bf16 v[64:67], a[144:147], v[160:163], v[64:67]
  v_mfma_f32_16x16x32_bf16 v[68:71], a[148:151], v[160:163], v[68:71]
  v_mfma_f32_16x16x32_bf16 v[72:75], a[152:155], v[160:163], v[72:75]
  ds_read_b128 v[196:199], v19 offset:2048
  s_waitcnt lgkmcnt(8)
  v_mfma_f32_16x16x32_bf16 v[76:79], a[144:147], v[164:167], v[76:79]
  v_mfma_f32_16x16x32_bf16 v[80:83], a[148:151], v[164:167], v[80:83]
  v_mfma_f32_16x16x32_bf16 v[84:87], a[152:155], v[164:167], v[84:87]
  s_add_u32 s46, s46, 10240
  s_add_u32 m0, s47, 2048
  s_nop 0
  buffer_load_dwordx4 v10, s[8:11], s46 offen lds
  ds_read_b128 v[200:203], v19 offset:4096
  s_waitcnt lgkmcnt(8)
  v_mfma_f32_16x16x32_bf16 v[88:91], a[144:147], v[168:171], v[88:91]
  v_mfma_f32_16x16x32_bf16 v[92:95], a[148:151], v[168:171], v[92:95]
  v_mfma_f32_16x16x32_bf16 v[96:99], a[152:155], v[168:171], v[96:99]
  ds_read_b128 v[204:207], v19 offset:6144
  s_waitcnt lgkmcnt(8)
  v_mfma_f32_16x16x32_bf16 v[100:103], a[144:147], v[172:175], v[100:103]
  v_mfma_f32_16x16x32_bf16 v[104:107], a[148:151], v[172:175], v[104:107]
  v_mfma_f32_16x16x32_bf16 v[108:111], a[152:155], v[172:175], v[108:111]
  ds_read_b128 v[208:211], v19 offset:8192
  s_waitcnt lgkmcnt(8)
  v_mfma_f32_16x16x32_bf16 v[112:115], a[144:147], v[176:179], v[112:115]
  v_mfma_f32_16x16x32_bf16 v[116:119], a[148:151], v[176:179], v[116:119]
  v_mfma_f32_16x16x32_bf16 v[120:123], a[152:155], v[176:179], v[120:123]
  ds_read_b128 v[212:215], v19 offset:10240
  s_waitcnt lgkmcnt(8)
  v_mfma_f32_16x16x32_bf16 v[124:127], a[144:147], v[180:183], v[124:127]
  v_mfma_f32_16x16x32_bf16 v[128:131], a[148:151], v[180:183], v[128:131]
  v_mfma_f32_16x16x32_bf16 v[132:135], a[152:155], v[180:183], v[132:135]
  s_add_u32 s46, s46, 10240
  s_add_u32 m0, s47, 3072
  s_nop 0
  buffer_load_dwordx4 v10, s[8:11], s46 offen lds
  ds_read_b128 v[216:219], v19 offset:12288
  s_waitcnt lgkmcnt(8)
  v_mfma_f32_16x16x32_bf16 v[136:139], a[144:147], v[184:187], v[136:139]
  v_mfma_f32_16x16x32_bf16 v[140:143], a[148:151], v[184:187], v[140:143]
  v_mfma_f32_16x16x32_bf16 v[144:147], a[152:155], v[184:187], v[144:147]
  ds_read_b128 v[220:223], v19 offset:14336
  s_waitcnt lgkmcnt(8)
  v_mfma_f32_16x16x32_bf16 v[148:151], a[144:147], v[188:191], v[148:151]
  v_mfma_f32_16x16x32_bf16 v[152:155], a[148:151], v[188:191], v[152:155]
  v_mfma_f32_16x16x32_bf16 v[156:159], a[152:155], v[188:191], v[156:159]
  s_waitcnt vmcnt(15)
  s_barrier
  s_add_u32 s30, s30, 128
  s_add_u32 s31, s31, 1
  s_cmp_lt_u32 s31, 10
  s_cbranch_scc1 qb_279
  s_mov_b32 s31, 0
  s_add_u32 s30, s30, s25
  s_sub_u32 s30, s30, 1280

qb_279:
  s_add_u32 s32, s32, 16384
  s_cmp_lt_u32 s32, 98304
  s_cselect_b32 s32, s32, 0
  s_mul_i32 s46, s20, 40960
  s_add_u32 s46, s46, s30
  s_lshl_b32 s47, s20, 12
  s_add_u32 s47, s47, s32
  v_add_u32 v18, s33, v14
  v_add_u32 v19, s33, v15
  s_add_u32 s33, s33, 16384
  s_cmp_lt_u32 s33, 98304
  s_cselect_b32 s33, s33, 0
  ds_read_b128 v[160:163], v18 offset:0
  s_waitcnt lgkmcnt(8)
  v_mfma_f32_16x16x32_bf16 v[64:67], a[156:159], v[192:195], v[64:67]
  v_mfma_f32_16x16x32_bf16 v[68:71], a[160:163], v[192:195], v[68:71]
  v_mfma_f32_16x16x32_bf16 v[72:75], a[164:167], v[192:195], v[72:75]
  ds_read_b128 v[164:167], v18 offset:2048
  s_waitcnt lgkmcnt(8)
  v_mfma_f32_16x16x32_bf16 v[76:79], a[156:159], v[196:199], v[76:79]
  v_mfma_f32_16x16x32_bf16 v[80:83], a[160:163], v[196:199], v[80:83]
  v_mfma_f32_16x16x32_bf16 v[84:87], a[164:167], v[196:199], v[84:87]
  s_add_u32 m0, s47, 0
  s_nop 0
  buffer_load_dwordx4 v10, s[8:11], s46 offen lds
  ds_read_b128 v[168:171], v18 offset:4096
  s_waitcnt lgkmcnt(8)
  v_mfma_f32_16x16x32_bf16 v[88:91], a[156:159], v[200:203], v[88:91]
  v_mfma_f32_16x16x32_bf16 v[92:95], a[160:163], v[200:203], v[92:95]
  v_mfma_f32_16x16x32_bf16 v[96:99], a[164:167], v[200:203], v[96:99]
  ds_read_b128 v[172:175], v18 offset:6144
  s_waitcnt lgkmcnt(8)
  v_mfma_f32_16x16x32_bf16 v[100:103], a[156:159], v[204:207], v[100:103]
  v_mfma_f32_16x16x32_bf16 v[104:107], a[160:163], v[204:207], v[104:107]
  v_mfma_f32_16x16x32_bf16 v[108:111], a[164:167], v[204:207], v[108:111]
  ds_read_b128 v[176:179], v18 offset:8192
  s_waitcnt lgkmcnt(8)
  v_mfma_f32_16x16x32_bf16 v[112:115], a[156:159], v[208:211], v[112:115]
  v_mfma_f32_16x16x32_bf16 v[116:119], a[160:163], v[208:211], v[116:119]
  v_mfma_f32_16x16x32_bf16 v[120:123], a[164:167], v[208:211], v[120:123]
  ds_read_b128 v[180:183], v18 offset:10240
  s_waitcnt lgkmcnt(8)
  v_mfma_f32_16x16x32_bf16 v[124:127], a[156:159], v[212:215], v[124:127]
  v_mfma_f32_16x16x32_bf16 v[128:131], a[160:163], v[212:215], v[128:131]
  v_mfma_f32_16x16x32_bf16 v[132:135], a[164:167], v[212:215], v[132:135]
  s_add_u32 s46, s46, 10240
  s_add_u32 m0, s47, 1024
  s_nop 0
  buffer_load_dwordx4 v10, s[8:11], s46 offen lds
  ds_read_b128 v[184:187], v18 offset:12288
  s_waitcnt lgkmcnt(8)
  v_mfma_f32_16x16x32_bf16 v[136:139], a[156:159], v[216:219], v[136:139]
  v_mfma_f32_16x16x32_bf16 v[140:143], a[160:163], v[216:219], v[140:143]
  v_mfma_f32_16x16x32_bf16 v[144:147], a[164:167], v[216:219], v[144:147]
  ds_read_b128 v[188:191], v18 offset:14336
  s_waitcnt lgkmcnt(8)
  v_mfma_f32_16x16x32_bf16 v[148:151], a[156:159], v[220:223], v[148:151]
  v_mfma_f32_16x16x32_bf16 v[152:155], a[160:163], v[220:223], v[152:155]
  v_mfma_f32_16x16x32_bf16 v[156:159], a[164:167], v[220:223], v[156:159]
  ds_read_b128 v[192:195], v19 offset:0
  s_waitcnt lgkmcnt(8)
  v_mfma_f32_16x16x32_bf16 v[64:67], a[168:171], v[160:163], v[64:67]
  v_mfma_f32_16x16x32_bf16 v[68:71], a[172:175], v[160:163], v[68:71]
  v_mfma_f32_16x16x32_bf16 v[72:75], a[176:179], v[160:163], v[72:75]
  ds_read_b128 v[196:199], v19 offset:2048
  s_waitcnt lgkmcnt(8)
  v_mfma_f32_16x16x32_bf16 v[76:79], a[168:171], v[164:167], v[76:79]
  v_mfma_f32_16x16x32_bf16 v[80:83], a[172:175], v[164:167], v[80:83]
  v_mfma_f32_16x16x32_bf16 v[84:87], a[176:179], v[164:167], v[84:87]
  s_add_u32 s46, s46, 10240
  s_add_u32 m0, s47, 2048
  s_nop 0
  buffer_load_dwordx4 v10, s[8:11], s46 offen lds
  ds_read_b128 v[200:203], v19 offset:4096
  s_waitcnt lgkmcnt(8)
  v_mfma_f32_16x16x32_bf16 v[88:91], a[168:171], v[168:171], v[88:91]
  v_mfma_f32_16x16x32_bf16 v[92:95], a[172:175], v[168:171], v[92:95]
  v_mfma_f32_16x16x32_bf16 v[96:99], a[176:179], v[168:171], v[96:99]
  ds_read_b128 v[204:207], v19 offset:6144
  s_waitcnt lgkmcnt(8)
  v_mfma_f32_16x16x32_bf16 v[100:103], a[168:171], v[172:175], v[100:103]
  v_mfma_f32_16x16x32_bf16 v[104:107], a[172:175], v[172:175], v[104:107]
  v_mfma_f32_16x16x32_bf16 v[108:111], a[176:179], v[172:175], v[108:111]
  ds_read_b128 v[208:211], v19 offset:8192
  s_waitcnt lgkmcnt(8)
  v_mfma_f32_16x16x32_bf16 v[112:115], a[168:171], v[176:179], v[112:115]
  v_mfma_f32_16x16x32_bf16 v[116:119], a[172:175], v[176:179], v[116:119]
  v_mfma_f32_16x16x32_bf16 v[120:123], a[176:179], v[176:179], v[120:123]
  ds_read_b128 v[212:215], v19 offset:10240
  s_waitcnt lgkmcnt(8)
  v_mfma_f32_16x16x32_bf16 v[124:127], a[168:171], v[180:183], v[124:127]
  v_mfma_f32_16x16x32_bf16 v[128:131], a[172:175], v[180:183], v[128:131]
  v_mfma_f32_16x16x32_bf16 v[132:135], a[176:179], v[180:183], v[132:135]
  s_add_u32 s46, s46, 10240
  s_add_u32 m0, s47, 3072
  s_nop 0
  buffer_load_dwordx4 v10, s[8:11], s46 offen lds
  ds_read_b128 v[216:219], v19 offset:12288
  s_waitcnt lgkmcnt(8)
  v_mfma_f32_16x16x32_bf16 v[136:139], a[168:171], v[184:187], v[136:139]
  v_mfma_f32_16x16x32_bf16 v[140:143], a[172:175], v[184:187], v[140:143]
  v_mfma_f32_16x16x32_bf16 v[144:147], a[176:179], v[184:187], v[144:147]
  ds_read_b128 v[220:223], v19 offset:14336
  s_waitcnt lgkmcnt(8)
  v_mfma_f32_16x16x32_bf16 v[148:151], a[168:171], v[188:191], v[148:151]
  v_mfma_f32_16x16x32_bf16 v[152:155], a[172:175], v[188:191], v[152:155]
  v_mfma_f32_16x16x32_bf16 v[156:159], a[176:179], v[188:191], v[156:159]
  s_waitcnt vmcnt(12)
  s_barrier
  s_add_u32 s30, s30, 128
  s_add_u32 s31, s31, 1
  s_cmp_lt_u32 s31, 10
  s_cbranch_scc1 qb_280
  s_mov_b32 s31, 0
  s_add_u32 s30, s30, s25
  s_sub_u32 s30, s30, 1280

qb_280:
  s_add_u32 s32, s32, 16384
  s_cmp_lt_u32 s32, 98304
  s_cselect_b32 s32, s32, 0
  s_mul_i32 s46, s20, 40960
  s_add_u32 s46, s46, s30
  s_lshl_b32 s47, s20, 12
  s_add_u32 s47, s47, s32
  v_add_u32 v18, s33, v14
  v_add_u32 v19, s33, v15
  s_add_u32 s33, s33, 16384
  s_cmp_lt_u32 s33, 98304
  s_cselect_b32 s33, s33, 0
  ds_read_b128 v[160:163], v18 offset:0
  s_waitcnt lgkmcnt(8)
  v_mfma_f32_16x16x32_bf16 v[64:67], a[180:183], v[192:195], v[64:67]
  v_mfma_f32_16x16x32_bf16 v[68:71], a[184:187], v[192:195], v[68:71]
  v_mfma_f32_16x16x32_bf16 v[72:75], a[188:191], v[192:195], v[72:75]
  ds_read_b128 v[164:167], v18 offset:2048
  s_waitcnt lgkmcnt(8)
  v_mfma_f32_16x16x32_bf16 v[76:79], a[180:183], v[196:199], v[76:79]
  v_mfma_f32_16x16x32_bf16 v[80:83], a[184:187], v[196:199], v[80:83]
  v_mfma_f32_16x16x32_bf16 v[84:87], a[188:191], v[196:199], v[84:87]
  s_add_u32 m0, s47, 0
  s_nop 0
  buffer_load_dwordx4 v10, s[8:11], s46 offen lds
  ds_read_b128 v[168:171], v18 offset:4096
  s_waitcnt lgkmcnt(8)
  v_mfma_f32_16x16x32_bf16 v[88:91], a[180:183], v[200:203], v[88:91]
  v_mfma_f32_16x16x32_bf16 v[92:95], a[184:187], v[200:203], v[92:95]
  v_mfma_f32_16x16x32_bf16 v[96:99], a[188:191], v[200:203], v[96:99]
  ds_read_b128 v[172:175], v18 offset:6144
  s_waitcnt lgkmcnt(8)
  v_mfma_f32_16x16x32_bf16 v[100:103], a[180:183], v[204:207], v[100:103]
  v_mfma_f32_16x16x32_bf16 v[104:107], a[184:187], v[204:207], v[104:107]
  v_mfma_f32_16x16x32_bf16 v[108:111], a[188:191], v[204:207], v[108:111]
  ds_read_b128 v[176:179], v18 offset:8192
  s_waitcnt lgkmcnt(8)
  v_mfma_f32_16x16x32_bf16 v[112:115], a[180:183], v[208:211], v[112:115]
  v_mfma_f32_16x16x32_bf16 v[116:119], a[184:187], v[208:211], v[116:119]
  v_mfma_f32_16x16x32_bf16 v[120:123], a[188:191], v[208:211], v[120:123]
  ds_read_b128 v[180:183], v18 offset:10240
  s_waitcnt lgkmcnt(8)
  v_mfma_f32_16x16x32_bf16 v[124:127], a[180:183], v[212:215], v[124:127]
  v_mfma_f32_16x16x32_bf16 v[128:131], a[184:187], v[212:215], v[128:131]
  v_mfma_f32_16x16x32_bf16 v[132:135], a[188:191], v[212:215], v[132:135]
  s_add_u32 s46, s46, 10240
  s_add_u32 m0, s47, 1024
  s_nop 0
  buffer_load_dwordx4 v10, s[8:11], s46 offen lds
  ds_read_b128 v[184:187], v18 offset:12288
  s_waitcnt lgkmcnt(8)
  v_mfma_f32_16x16x32_bf16 v[136:139], a[180:183], v[216:219], v[136:139]
  v_mfma_f32_16x16x32_bf16 v[140:143], a[184:187], v[216:219], v[140:143]
  v_mfma_f32_16x16x32_bf16 v[144:147], a[188:191], v[216:219], v[144:147]
  ds_read_b128 v[188:191], v18 offset:14336
  s_waitcnt lgkmcnt(8)
  v_mfma_f32_16x16x32_bf16 v[148:151], a[180:183], v[220:223], v[148:151]
  v_mfma_f32_16x16x32_bf16 v[152:155], a[184:187], v[220:223], v[152:155]
  v_mfma_f32_16x16x32_bf16 v[156:159], a[188:191], v[220:223], v[156:159]
  ds_read_b128 v[192:195], v19 offset:0
  s_waitcnt lgkmcnt(8)
  v_mfma_f32_16x16x32_bf16 v[64:67], a[192:195], v[160:163], v[64:67]
  v_mfma_f32_16x16x32_bf16 v[68:71], a[196:199], v[160:163], v[68:71]
  v_mfma_f32_16x16x32_bf16 v[72:75], a[200:203], v[160:163], v[72:75]
  ds_read_b128 v[196:199], v19 offset:2048
  s_waitcnt lgkmcnt(8)
  v_mfma_f32_16x16x32_bf16 v[76:79], a[192:195], v[164:167], v[76:79]
  v_mfma_f32_16x16x32_bf16 v[80:83], a[196:199], v[164:167], v[80:83]
  v_mfma_f32_16x16x32_bf16 v[84:87], a[200:203], v[164:167], v[84:87]
  s_add_u32 s46, s46, 10240
  s_add_u32 m0, s47, 2048
  s_nop 0
  buffer_load_dwordx4 v10, s[8:11], s46 offen lds
  ds_read_b128 v[200:203], v19 offset:4096
  s_waitcnt lgkmcnt(8)
  v_mfma_f32_16x16x32_bf16 v[88:91], a[192:195], v[168:171], v[88:91]
  v_mfma_f32_16x16x32_bf16 v[92:95], a[196:199], v[168:171], v[92:95]
  v_mfma_f32_16x16x32_bf16 v[96:99], a[200:203], v[168:171], v[96:99]
  ds_read_b128 v[204:207], v19 offset:6144
  s_waitcnt lgkmcnt(8)
  v_mfma_f32_16x16x32_bf16 v[100:103], a[192:195], v[172:175], v[100:103]
  v_mfma_f32_16x16x32_bf16 v[104:107], a[196:199], v[172:175], v[104:107]
  v_mfma_f32_16x16x32_bf16 v[108:111], a[200:203], v[172:175], v[108:111]
  ds_read_b128 v[208:211], v19 offset:8192
  s_waitcnt lgkmcnt(8)
  v_mfma_f32_16x16x32_bf16 v[112:115], a[192:195], v[176:179], v[112:115]
  v_mfma_f32_16x16x32_bf16 v[116:119], a[196:199], v[176:179], v[116:119]
  v_mfma_f32_16x16x32_bf16 v[120:123], a[200:203], v[176:179], v[120:123]
  ds_read_b128 v[212:215], v19 offset:10240
  s_waitcnt lgkmcnt(8)
  v_mfma_f32_16x16x32_bf16 v[124:127], a[192:195], v[180:183], v[124:127]
  v_mfma_f32_16x16x32_bf16 v[128:131], a[196:199], v[180:183], v[128:131]
  v_mfma_f32_16x16x32_bf16 v[132:135], a[200:203], v[180:183], v[132:135]
  s_add_u32 s46, s46, 10240
  s_add_u32 m0, s47, 3072
  s_nop 0
  buffer_load_dwordx4 v10, s[8:11], s46 offen lds
  ds_read_b128 v[216:219], v19 offset:12288
  s_waitcnt lgkmcnt(8)
  v_mfma_f32_16x16x32_bf16 v[136:139], a[192:195], v[184:187], v[136:139]
  v_mfma_f32_16x16x32_bf16 v[140:143], a[196:199], v[184:187], v[140:143]
  v_mfma_f32_16x16x32_bf16 v[144:147], a[200:203], v[184:187], v[144:147]
  ds_read_b128 v[220:223], v19 offset:14336
  s_waitcnt lgkmcnt(8)
  v_mfma_f32_16x16x32_bf16 v[148:151], a[192:195], v[188:191], v[148:151]
  v_mfma_f32_16x16x32_bf16 v[152:155], a[196:199], v[188:191], v[152:155]
  v_mfma_f32_16x16x32_bf16 v[156:159], a[200:203], v[188:191], v[156:159]
  s_waitcnt vmcnt(12)
  s_barrier
  s_add_u32 s30, s30, 128
  s_add_u32 s31, s31, 1
  s_cmp_lt_u32 s31, 10
  s_cbranch_scc1 qb_281
  s_mov_b32 s31, 0
  s_add_u32 s30, s30, s25
  s_sub_u32 s30, s30, 1280

qb_281:
  s_add_u32 s32, s32, 16384
  s_cmp_lt_u32 s32, 98304
  s_cselect_b32 s32, s32, 0
  s_mul_i32 s46, s20, 40960
  s_add_u32 s46, s46, s30
  s_lshl_b32 s47, s20, 12
  s_add_u32 s47, s47, s32
  v_add_u32 v18, s33, v14
  v_add_u32 v19, s33, v15
  s_add_u32 s33, s33, 16384
  s_cmp_lt_u32 s33, 98304
  s_cselect_b32 s33, s33, 0
  ds_read_b128 v[160:163], v18 offset:0
  s_waitcnt lgkmcnt(8)
  v_mfma_f32_16x16x32_bf16 v[64:67], a[204:207], v[192:195], v[64:67]
  v_mfma_f32_16x16x32_bf16 v[68:71], a[208:211], v[192:195], v[68:71]
  v_mfma_f32_16x16x32_bf16 v[72:75], a[212:215], v[192:195], v[72:75]
  ds_read_b128 v[164:167], v18 offset:2048
  s_waitcnt lgkmcnt(8)
  v_mfma_f32_16x16x32_bf16 v[76:79], a[204:207], v[196:199], v[76:79]
  v_mfma_f32_16x16x32_bf16 v[80:83], a[208:211], v[196:199], v[80:83]
  v_mfma_f32_16x16x32_bf16 v[84:87], a[212:215], v[196:199], v[84:87]
  s_add_u32 m0, s47, 0
  s_nop 0
  buffer_load_dwordx4 v10, s[8:11], s46 offen lds
  ds_read_b128 v[168:171], v18 offset:4096
  s_waitcnt lgkmcnt(8)
  v_mfma_f32_16x16x32_bf16 v[88:91], a[204:207], v[200:203], v[88:91]
  v_mfma_f32_16x16x32_bf16 v[92:95], a[208:211], v[200:203], v[92:95]
  v_mfma_f32_16x16x32_bf16 v[96:99], a[212:215], v[200:203], v[96:99]
  ds_read_b128 v[172:175], v18 offset:6144
  s_waitcnt lgkmcnt(8)
  v_mfma_f32_16x16x32_bf16 v[100:103], a[204:207], v[204:207], v[100:103]
  v_mfma_f32_16x16x32_bf16 v[104:107], a[208:211], v[204:207], v[104:107]
  v_mfma_f32_16x16x32_bf16 v[108:111], a[212:215], v[204:207], v[108:111]
  ds_read_b128 v[176:179], v18 offset:8192
  s_waitcnt lgkmcnt(8)
  v_mfma_f32_16x16x32_bf16 v[112:115], a[204:207], v[208:211], v[112:115]
  v_mfma_f32_16x16x32_bf16 v[116:119], a[208:211], v[208:211], v[116:119]
  v_mfma_f32_16x16x32_bf16 v[120:123], a[212:215], v[208:211], v[120:123]
  ds_read_b128 v[180:183], v18 offset:10240
  s_waitcnt lgkmcnt(8)
  v_mfma_f32_16x16x32_bf16 v[124:127], a[204:207], v[212:215], v[124:127]
  v_mfma_f32_16x16x32_bf16 v[128:131], a[208:211], v[212:215], v[128:131]
  v_mfma_f32_16x16x32_bf16 v[132:135], a[212:215], v[212:215], v[132:135]
  s_add_u32 s46, s46, 10240
  s_add_u32 m0, s47, 1024
  s_nop 0
  buffer_load_dwordx4 v10, s[8:11], s46 offen lds
  ds_read_b128 v[184:187], v18 offset:12288
  s_waitcnt lgkmcnt(8)
  v_mfma_f32_16x16x32_bf16 v[136:139], a[204:207], v[216:219], v[136:139]
  v_mfma_f32_16x16x32_bf16 v[140:143], a[208:211], v[216:219], v[140:143]
  v_mfma_f32_16x16x32_bf16 v[144:147], a[212:215], v[216:219], v[144:147]
  ds_read_b128 v[188:191], v18 offset:14336
  s_waitcnt lgkmcnt(8)
  v_mfma_f32_16x16x32_bf16 v[148:151], a[204:207], v[220:223], v[148:151]
  v_mfma_f32_16x16x32_bf16 v[152:155], a[208:211], v[220:223], v[152:155]
  v_mfma_f32_16x16x32_bf16 v[156:159], a[212:215], v[220:223], v[156:159]
  ds_read_b128 v[192:195], v19 offset:0
  s_waitcnt lgkmcnt(8)
  v_mfma_f32_16x16x32_bf16 v[64:67], a[216:219], v[160:163], v[64:67]
  v_mfma_f32_16x16x32_bf16 v[68:71], a[220:223], v[160:163], v[68:71]
  v_mfma_f32_16x16x32_bf16 v[72:75], a[224:227], v[160:163], v[72:75]
  ds_read_b128 v[196:199], v19 offset:2048
  s_waitcnt lgkmcnt(8)
  v_mfma_f32_16x16x32_bf16 v[76:79], a[216:219], v[164:167], v[76:79]
  v_mfma_f32_16x16x32_bf16 v[80:83], a[220:223], v[164:167], v[80:83]
  v_mfma_f32_16x16x32_bf16 v[84:87], a[224:227], v[164:167], v[84:87]
  s_add_u32 s46, s46, 10240
  s_add_u32 m0, s47, 2048
  s_nop 0
  buffer_load_dwordx4 v10, s[8:11], s46 offen lds
  ds_read_b128 v[200:203], v19 offset:4096
  s_waitcnt lgkmcnt(8)
  v_mfma_f32_16x16x32_bf16 v[88:91], a[216:219], v[168:171], v[88:91]
  v_mfma_f32_16x16x32_bf16 v[92:95], a[220:223], v[168:171], v[92:95]
  v_mfma_f32_16x16x32_bf16 v[96:99], a[224:227], v[168:171], v[96:99]
  ds_read_b128 v[204:207], v19 offset:6144
  s_waitcnt lgkmcnt(8)
  v_mfma_f32_16x16x32_bf16 v[100:103], a[216:219], v[172:175], v[100:103]
  v_mfma_f32_16x16x32_bf16 v[104:107], a[220:223], v[172:175], v[104:107]
  v_mfma_f32_16x16x32_bf16 v[108:111], a[224:227], v[172:175], v[108:111]
  ds_read_b128 v[208:211], v19 offset:8192
  s_waitcnt lgkmcnt(8)
  v_mfma_f32_16x16x32_bf16 v[112:115], a[216:219], v[176:179], v[112:115]
  v_mfma_f32_16x16x32_bf16 v[116:119], a[220:223], v[176:179], v[116:119]
  v_mfma_f32_16x16x32_bf16 v[120:123], a[224:227], v[176:179], v[120:123]
  ds_read_b128 v[212:215], v19 offset:10240
  s_waitcnt lgkmcnt(8)
  v_mfma_f32_16x16x32_bf16 v[124:127], a[216:219], v[180:183], v[124:127]
  v_mfma_f32_16x16x32_bf16 v[128:131], a[220:223], v[180:183], v[128:131]
  v_mfma_f32_16x16x32_bf16 v[132:135], a[224:227], v[180:183], v[132:135]
  s_add_u32 s46, s46, 10240
  s_add_u32 m0, s47, 3072
  s_nop 0
  buffer_load_dwordx4 v10, s[8:11], s46 offen lds
  ds_read_b128 v[216:219], v19 offset:12288
  s_waitcnt lgkmcnt(8)
  v_mfma_f32_16x16x32_bf16 v[136:139], a[216:219], v[184:187], v[136:139]
  v_mfma_f32_16x16x32_bf16 v[140:143], a[220:223], v[184:187], v[140:143]
  v_mfma_f32_16x16x32_bf16 v[144:147], a[224:227], v[184:187], v[144:147]
  ds_read_b128 v[220:223], v19 offset:14336
  s_waitcnt lgkmcnt(8)
  v_mfma_f32_16x16x32_bf16 v[148:151], a[216:219], v[188:191], v[148:151]
  v_mfma_f32_16x16x32_bf16 v[152:155], a[220:223], v[188:191], v[152:155]
  v_mfma_f32_16x16x32_bf16 v[156:159], a[224:227], v[188:191], v[156:159]
  s_waitcnt vmcnt(12)
  s_barrier
  s_add_u32 s30, s30, 128
  s_add_u32 s31, s31, 1
  s_cmp_lt_u32 s31, 10
  s_cbranch_scc1 qb_282
  s_mov_b32 s31, 0
  s_add_u32 s30, s30, s25
  s_sub_u32 s30, s30, 1280

qb_282:
  s_add_u32 s32, s32, 16384
  s_cmp_lt_u32 s32, 98304
  s_cselect_b32 s32, s32, 0
  s_mul_i32 s46, s20, 40960
  s_add_u32 s46, s46, s30
  s_lshl_b32 s47, s20, 12
  s_add_u32 s47, s47, s32
  v_add_u32 v18, s33, v14
  v_add_u32 v19, s33, v15
  s_add_u32 s33, s33, 16384
  s_cmp_lt_u32 s33, 98304
  s_cselect_b32 s33, s33, 0
  ds_read_b128 v[160:163], v18 offset:0
  s_waitcnt lgkmcnt(8)
  v_mfma_f32_16x16x32_bf16 v[64:67], a[228:231], v[192:195], v[64:67]
  v_mfma_f32_16x16x32_bf16 v[68:71], a[232:235], v[192:195], v[68:71]
  v_mfma_f32_16x16x32_bf16 v[72:75], a[236:239], v[192:195], v[72:75]
  ds_read_b128 v[164:167], v18 offset:2048
  s_waitcnt lgkmcnt(8)
  v_mfma_f32_16x16x32_bf16 v[76:79], a[228:231], v[196:199], v[76:79]
  v_mfma_f32_16x16x32_bf16 v[80:83], a[232:235], v[196:199], v[80:83]
  v_mfma_f32_16x16x32_bf16 v[84:87], a[236:239], v[196:199], v[84:87]
  s_add_u32 m0, s47, 0
  s_nop 0
  buffer_load_dwordx4 v10, s[8:11], s46 offen lds
  ds_read_b128 v[168:171], v18 offset:4096
  s_waitcnt lgkmcnt(8)
  v_mfma_f32_16x16x32_bf16 v[88:91], a[228:231], v[200:203], v[88:91]
  v_mfma_f32_16x16x32_bf16 v[92:95], a[232:235], v[200:203], v[92:95]
  v_mfma_f32_16x16x32_bf16 v[96:99], a[236:239], v[200:203], v[96:99]
  ds_read_b128 v[172:175], v18 offset:6144
  s_waitcnt lgkmcnt(8)
  v_mfma_f32_16x16x32_bf16 v[100:103], a[228:231], v[204:207], v[100:103]
  v_mfma_f32_16x16x32_bf16 v[104:107], a[232:235], v[204:207], v[104:107]
  v_mfma_f32_16x16x32_bf16 v[108:111], a[236:239], v[204:207], v[108:111]
  v_cvt_pk_bf16_f32 v224, v64, v65
  v_cvt_pk_bf16_f32 v225, v66, v67
  v_cvt_pk_bf16_f32 v226, v68, v69
  v_cvt_pk_bf16_f32 v227, v70, v71
  v_cvt_pk_bf16_f32 v228, v72, v73
  v_cvt_pk_bf16_f32 v229, v74, v75
  ds_write_b64 v22, v[224:225] offset:0
  ds_write_b64 v22, v[226:227] offset:32
  ds_write_b64 v22, v[228:229] offset:64
  ds_read_b128 v[176:179], v18 offset:8192
  s_waitcnt lgkmcnt(8)
  v_mfma_f32_16x16x32_bf16 v[112:115], a[228:231], v[208:211], v[112:115]
  v_mfma_f32_16x16x32_bf16 v[116:119], a[232:235], v[208:211], v[116:119]
  v_mfma_f32_16x16x32_bf16 v[120:123], a[236:239], v[208:211], v[120:123]
  v_cvt_pk_bf16_f32 v230, v76, v77
  v_cvt_pk_bf16_f32 v231, v78, v79
  v_cvt_pk_bf16_f32 v232, v80, v81
  v_cvt_pk_bf16_f32 v233, v82, v83
  v_cvt_pk_bf16_f32 v234, v84, v85
  v_cvt_pk_bf16_f32 v235, v86, v87
  ds_write_b64 v22, v[230:231] offset:6400
  ds_write_b64 v22, v[232:233] offset:6432
  ds_write_b64 v22, v[234:235] offset:6464
  ds_read_b128 v[180:183], v18 offset:10240
  s_waitcnt lgkmcnt(8)
  v_mfma_f32_16x16x32_bf16 v[124:127], a[228:231], v[212:215], v[124:127]
  v_mfma_f32_16x16x32_bf16 v[128:131], a[232:235], v[212:215], v[128:131]
  v_mfma_f32_16x16x32_bf16 v[132:135], a[236:239], v[212:215], v[132:135]
  s_add_u32 s46, s46, 10240
  s_add_u32 m0, s47, 1024
  s_nop 0
  buffer_load_dwordx4 v10, s[8:11], s46 offen lds
  v_cvt_pk_bf16_f32 v224, v88, v89
  v_cvt_pk_bf16_f32 v225, v90, v91
  v_cvt_pk_bf16_f32 v226, v92, v93
  v_cvt_pk_bf16_f32 v227, v94, v95
  v_cvt_pk_bf16_f32 v228, v96, v97
  v_cvt_pk_bf16_f32 v229, v98, v99
  ds_write_b64 v22, v[224:225] offset:12800
  ds_write_b64 v22, v[226:227] offset:12832
  ds_write_b64 v22, v[228:229] offset:12864
  ds_read_b128 v[184:187], v18 offset:12288
  s_waitcnt lgkmcnt(8)
  v_mfma_f32_16x16x32_bf16 v[136:139], a[228:231], v[216:219], v[136:139]
  v_mfma_f32_16x16x32_bf16 v[140:143], a[232:235], v[216:219], v[140:143]
  v_mfma_f32_16x16x32_bf16 v[144:147], a[236:239], v[216:219], v[144:147]
  v_cvt_pk_bf16_f32 v230, v100, v101
  v_cvt_pk_bf16_f32 v231, v102, v103
  v_cvt_pk_bf16_f32 v232, v104, v105
  v_cvt_pk_bf16_f32 v233, v106, v107
  v_cvt_pk_bf16_f32 v234, v108, v109
  v_cvt_pk_bf16_f32 v235, v110, v111
  ds_write_b64 v22, v[230:231] offset:19200
  ds_write_b64 v22, v[232:233] offset:19232
  ds_write_b64 v22, v[234:235] offset:19264
  ds_read_b128 v[188:191], v18 offset:14336
  s_waitcnt lgkmcnt(8)
  v_mfma_f32_16x16x32_bf16 v[148:151], a[228:231], v[220:223], v[148:151]
  v_mfma_f32_16x16x32_bf16 v[152:155], a[232:235], v[220:223], v[152:155]
  v_mfma_f32_16x16x32_bf16 v[156:159], a[236:239], v[220:223], v[156:159]
  v_cvt_pk_bf16_f32 v224, v112, v113
  v_cvt_pk_bf16_f32 v225, v114, v115
  v_cvt_pk_bf16_f32 v226, v116, v117
  v_cvt_pk_bf16_f32 v227, v118, v119
  v_cvt_pk_bf16_f32 v228, v120, v121
  v_cvt_pk_bf16_f32 v229, v122, v123
  ds_write_b64 v22, v[224:225] offset:25600
  ds_write_b64 v22, v[226:227] offset:25632
  ds_write_b64 v22, v[228:229] offset:25664
  v_cvt_pk_bf16_f32 v230, v124, v125
  v_cvt_pk_bf16_f32 v231, v126, v127
  v_cvt_pk_bf16_f32 v232, v128, v129
  v_cvt_pk_bf16_f32 v233, v130, v131
  v_cvt_pk_bf16_f32 v234, v132, v133
  v_cvt_pk_bf16_f32 v235, v134, v135
  ds_write_b64 v22, v[230:231] offset:32000
  ds_write_b64 v22, v[232:233] offset:32032
  ds_write_b64 v22, v[234:235] offset:32064
  v_cvt_pk_bf16_f32 v224, v136, v137
  v_cvt_pk_bf16_f32 v225, v138, v139
  v_cvt_pk_bf16_f32 v226, v140, v141
  v_cvt_pk_bf16_f32 v227, v142, v143
  v_cvt_pk_bf16_f32 v228, v144, v145
  v_cvt_pk_bf16_f32 v229, v146, v147
  ds_write_b64 v22, v[224:225] offset:38400
  ds_write_b64 v22, v[226:227] offset:38432
  ds_write_b64 v22, v[228:229] offset:38464
  v_cvt_pk_bf16_f32 v230, v148, v149
  v_cvt_pk_bf16_f32 v231, v150, v151
  v_cvt_pk_bf16_f32 v232, v152, v153
  v_cvt_pk_bf16_f32 v233, v154, v155
  v_cvt_pk_bf16_f32 v234, v156, v157
  v_cvt_pk_bf16_f32 v235, v158, v159
  ds_write_b64 v22, v[230:231] offset:44800
  ds_write_b64 v22, v[232:233] offset:44832
  ds_write_b64 v22, v[234:235] offset:44864
  s_mov_b32 s61, s60
  s_add_u32 s60, s60, s63
  s_mul_i32 s48, s20, 122880
  s_add_u32 s48, s48, s27
  s_add_u32 s27, s27, s28
  s_sub_u32 s26, s26, 1
  s_cmp_gt_u32 s26, 0
  s_cbranch_scc1 qb_blk_270
  s_waitcnt vmcnt(0) lgkmcnt(0)
  s_barrier
  ds_read_b128 v[224:227], v23 offset:0
  ds_read_b128 v[228:231], v24 offset:0
  ds_read_b128 v[232:235], v25 offset:0
  ds_read_b128 v[236:239], v23 offset:3200
  ds_read_b128 v[240:243], v24 offset:3200
  ds_read_b128 v[244:247], v25 offset:3200
  s_waitcnt lgkmcnt(0)
  s_add_u32 s21, s48, 0
  buffer_store_dwordx4 v[224:227], v26, s[16:19], s21 offen sc1
  s_add_u32 s21, s48, 0
  buffer_store_dwordx4 v[228:231], v27, s[16:19], s21 offen sc1
  s_add_u32 s21, s48, 0
  buffer_store_dwordx4 v[232:235], v28, s[16:19], s21 offen sc1
  s_add_u32 s21, s48, 30720
  buffer_store_dwordx4 v[236:239], v26, s[16:19], s21 offen sc1
  s_add_u32 s21, s48, 30720
  buffer_store_dwordx4 v[240:243], v27, s[16:19], s21 offen sc1
  s_add_u32 s21, s48, 30720
  buffer_store_dwordx4 v[244:247], v28, s[16:19], s21 offen sc1
  s_nop 1
  ds_read_b128 v[224:227], v23 offset:6400
  ds_read_b128 v[228:231], v24 offset:6400
  ds_read_b128 v[232:235], v25 offset:6400
  ds_read_b128 v[236:239], v23 offset:9600
  ds_read_b128 v[240:243], v24 offset:9600
  ds_read_b128 v[244:247], v25 offset:9600
  s_waitcnt lgkmcnt(0)
  s_add_u32 s21, s48, 61440
  buffer_store_dwordx4 v[224:227], v26, s[16:19], s21 offen sc1
  s_add_u32 s21, s48, 61440
  buffer_store_dwordx4 v[228:231], v27, s[16:19], s21 offen sc1
  s_add_u32 s21, s48, 61440
  buffer_store_dwordx4 v[232:235], v28, s[16:19], s21 offen sc1
  s_add_u32 s21, s48, 92160
  buffer_store_dwordx4 v[236:239], v26, s[16:19], s21 offen sc1
  s_add_u32 s21, s48, 92160
  buffer_store_dwordx4 v[240:243], v27, s[16:19], s21 offen sc1
  s_add_u32 s21, s48, 92160
  buffer_store_dwordx4 v[244:247], v28, s[16:19], s21 offen sc1
  s_nop 1
  s_waitcnt vmcnt(0)
  s_barrier
  s_cmp_lg_u32 s20, 0
  s_cbranch_scc1 af_283
  v_mov_b32 v4, 0
  v_mov_b32 v5, 1
  s_mov_b64 exec, 1
  buffer_atomic_add v5, v4, s[72:75], s61 offen sc1
  s_mov_b64 exec, -1
  s_nop 1
af_283:
  s_barrier
  s_cmp_eq_u32 s64, 1
  s_cbranch_scc1 queue
skip_qb:
  s_sub_u32 s2, s3, 96
  s_load_dwordx2 s[4:5], s[0:1], 0
  s_load_dwordx2 s[6:7], s[0:1], 16
  s_load_dwordx2 s[38:39], s[0:1], 104
  s_mov_b32 s42, s2
  s_mov_b32 s41, 0
  s_waitcnt lgkmcnt(0)
  s_mov_b32 s8, s4
  s_mov_b32 s9, s5
  s_mov_b32 s10, 2621440
  s_mov_b32 s11, 0x00020000
  s_mov_b32 s12, s6
  s_mov_b32 s13, s7
  s_mov_b32 s14, 7864320
  s_mov_b32 s15, 0x00020000
  s_mov_b32 s16, s38
  s_mov_b32 s17, s39
  s_mov_b32 s18, 50331648
  s_mov_b32 s19, 0x00020000
  s_add_u32 s52, s38, 50331648
  s_addc_u32 s53, s39, 0
  s_mov_b32 s54, 6291456
  s_mov_b32 s55, 0x00020000
  s_add_u32 s56, s38, 85983232
  s_addc_u32 s57, s39, 0
  s_mov_b32 s58, 6815744
  s_mov_b32 s59, 0x00020000
  s_load_dwordx2 s[72:73], s[0:1], 104
  s_waitcnt lgkmcnt(0)
  s_add_u32 s72, s72, 81068032
  s_addc_u32 s73, s73, 0
  s_mov_b32 s74, 115712
  s_mov_b32 s75, 0x00020000
  s_mul_i32 s44, s42, 384
  v_mov_b32 v9, 2731
  v_add_u32 v8, 0, v1
  v_mul_u32_u24 v7, v8, v9
  v_lshrrev_b32 v7, 16, v7
  v_mul_u32_u24 v4, 24, v7
  v_sub_u32 v8, v8, v4
  s_mov_b32 s21, 12288
  v_mul_lo_u32 v7, v7, s21
  v_lshl_add_u32 v4, v8, 4, v7
  v_add_u32 v8, 64, v1
  v_mul_u32_u24 v7, v8, v9
  v_lshrrev_b32 v7, 16, v7
  v_mul_u32_u24 v5, 24, v7
  v_sub_u32 v8, v8, v5
  s_mov_b32 s21, 12288
  v_mul_lo_u32 v7, v7, s21
  v_lshl_add_u32 v5, v8, 4, v7
  v_add_u32 v8, 128, v1
  v_mul_u32_u24 v7, v8, v9
  v_lshrrev_b32 v7, 16, v7
  v_mul_u32_u24 v6, 24, v7
  v_sub_u32 v8, v8, v6
  s_mov_b32 s21, 12288
  v_mul_lo_u32 v7, v7, s21
  v_lshl_add_u32 v6, v8, 4, v7
  v_lshrrev_b32 v7, 2, v2
  v_lshl_add_u32 v7, v3, 3, v7
  v_mul_u32_u24 v7, 384, v7
  v_and_b32 v8, 3, v2
  v_lshlrev_b32 v8, 3, v8
  s_mul_i32 s21, s20, 96
  v_add3_u32 v7, v7, v8, s21
  v_add_u32 v8, 61440, v7
  s_mul_i32 s21, s20, 491520
  s_add_u32 s21, s21, 0
  s_add_u32 s21, s21, s44
  s_mul_i32 s22, s20, 15360
  s_add_u32 s22, s22, 0
  s_add_u32 m0, s22, 0
  s_nop 0
  buffer_load_dwordx4 v4, s[12:15], s21 offen lds
  s_add_u32 m0, s22, 1024
  s_nop 0
  buffer_load_dwordx4 v5, s[12:15], s21 offen lds
  s_add_u32 m0, s22, 2048
  s_nop 0
  buffer_load_dwordx4 v6, s[12:15], s21 offen lds
  s_mul_i32 s21, s20, 491520
  s_add_u32 s21, s21, 98304
  s_add_u32 s21, s21, s44
  s_mul_i32 s22, s20, 15360
  s_add_u32 s22, s22, 3072
  s_add_u32 m0, s22, 0
  s_nop 0
  buffer_load_dwordx4 v4, s[12:15], s21 offen lds
  s_add_u32 m0, s22, 1024
  s_nop 0
  buffer_load_dwordx4 v5, s[12:15], s21 offen lds
  s_add_u32 m0, s22, 2048
  s_nop 0
  buffer_load_dwordx4 v6, s[12:15], s21 offen lds
  s_mul_i32 s21, s20, 491520
  s_add_u32 s21, s21, 196608
  s_add_u32 s21, s21, s44
  s_mul_i32 s22, s20, 15360
  s_add_u32 s22, s22, 6144
  s_add_u32 m0, s22, 0
  s_nop 0
  buffer_load_dwordx4 v4, s[12:15], s21 offen lds
  s_add_u32 m0, s22, 1024
  s_nop 0
  buffer_load_dwordx4 v5, s[12:15], s21 offen lds
  s_add_u32 m0, s22, 2048
  s_nop 0
  buffer_load_dwordx4 v6, s[12:15], s21 offen lds
  s_mul_i32 s21, s20, 491520
  s_add_u32 s21, s21, 294912
  s_add_u32 s21, s21, s44
  s_mul_i32 s22, s20, 15360
  s_add_u32 s22, s22, 9216
  s_add_u32 m0, s22, 0
  s_nop 0
  buffer_load_dwordx4 v4, s[12:15], s21 offen lds
  s_add_u32 m0, s22, 1024
  s_nop 0
  buffer_load_dwordx4 v5, s[12:15], s21 offen lds
  s_add_u32 m0, s22, 2048
  s_nop 0
  buffer_load_dwordx4 v6, s[12:15], s21 offen lds
  s_mul_i32 s21, s20, 491520
  s_add_u32 s21, s21, 393216
  s_add_u32 s21, s21, s44
  s_mul_i32 s22, s20, 15360
  s_add_u32 s22, s22, 12288
  s_add_u32 m0, s22, 0
  s_nop 0
  buffer_load_dwordx4 v4, s[12:15], s21 offen lds
  s_add_u32 m0, s22, 1024
  s_nop 0
  buffer_load_dwordx4 v5, s[12:15], s21 offen lds
  s_add_u32 m0, s22, 2048
  s_nop 0
  buffer_load_dwordx4 v6, s[12:15], s21 offen lds
  s_mul_i32 s21, s20, 491520
  s_add_u32 s21, s21, 1966080
  s_add_u32 s21, s21, s44
  s_mul_i32 s22, s20, 15360
  s_add_u32 s22, s22, 61440
  s_add_u32 m0, s22, 0
  s_nop 0
  buffer_load_dwordx4 v4, s[12:15], s21 offen lds
  s_add_u32 m0, s22, 1024
  s_nop 0
  buffer_load_dwordx4 v5, s[12:15], s21 offen lds
  s_add_u32 m0, s22, 2048
  s_nop 0
  buffer_load_dwordx4 v6, s[12:15], s21 offen lds
  s_mul_i32 s21, s20, 491520
  s_add_u32 s21, s21, 2064384
  s_add_u32 s21, s21, s44
  s_mul_i32 s22, s20, 15360
  s_add_u32 s22, s22, 64512
  s_add_u32 m0, s22, 0
  s_nop 0
  buffer_load_dwordx4 v4, s[12:15], s21 offen lds
  s_add_u32 m0, s22, 1024
  s_nop 0
  buffer_load_dwordx4 v5, s[12:15], s21 offen lds
  s_add_u32 m0, s22, 2048
  s_nop 0
  buffer_load_dwordx4 v6, s[12:15], s21 offen lds
  s_mul_i32 s21, s20, 491520
  s_add_u32 s21, s21, 2162688
  s_add_u32 s21, s21, s44
  s_mul_i32 s22, s20, 15360
  s_add_u32 s22, s22, 67584
  s_add_u32 m0, s22, 0
  s_nop 0
  buffer_load_dwordx4 v4, s[12:15], s21 offen lds
  s_add_u32 m0, s22, 1024
  s_nop 0
  buffer_load_dwordx4 v5, s[12:15], s21 offen lds
  s_add_u32 m0, s22, 2048
  s_nop 0
  buffer_load_dwordx4 v6, s[12:15], s21 offen lds
  s_mul_i32 s21, s20, 491520
  s_add_u32 s21, s21, 2260992
  s_add_u32 s21, s21, s44
  s_mul_i32 s22, s20, 15360
  s_add_u32 s22, s22, 70656
  s_add_u32 m0, s22, 0
  s_nop 0
  buffer_load_dwordx4 v4, s[12:15], s21 offen lds
  s_add_u32 m0, s22, 1024
  s_nop 0
  buffer_load_dwordx4 v5, s[12:15], s21 offen lds
  s_add_u32 m0, s22, 2048
  s_nop 0
  buffer_load_dwordx4 v6, s[12:15], s21 offen lds
  s_mul_i32 s21, s20, 491520
  s_add_u32 s21, s21, 2359296
  s_add_u32 s21, s21, s44
  s_mul_i32 s22, s20, 15360
  s_add_u32 s22, s22, 73728
  s_add_u32 m0, s22, 0
  s_nop 0
  buffer_load_dwordx4 v4, s[12:15], s21 offen lds
  s_add_u32 m0, s22, 1024
  s_nop 0
  buffer_load_dwordx4 v5, s[12:15], s21 offen lds
  s_add_u32 m0, s22, 2048
  s_nop 0
  buffer_load_dwordx4 v6, s[12:15], s21 offen lds
  s_mul_i32 s21, s20, 491520
  s_add_u32 s21, s21, 3932160
  s_add_u32 s21, s21, s44
  buffer_load_dwordx4 v[64:67], v4, s[12:15], s21 offen
  buffer_load_dwordx4 v[68:71], v5, s[12:15], s21 offen
  buffer_load_dwordx4 v[72:75], v6, s[12:15], s21 offen
  s_mul_i32 s21, s20, 491520
  s_add_u32 s21, s21, 4030464
  s_add_u32 s21, s21, s44
  buffer_load_dwordx4 v[76:79], v4, s[12:15], s21 offen
  buffer_load_dwordx4 v[80:83], v5, s[12:15], s21 offen
  buffer_load_dwordx4 v[84:87], v6, s[12:15], s21 offen
  s_mul_i32 s21, s20, 491520
  s_add_u32 s21, s21, 4128768
  s_add_u32 s21, s21, s44
  buffer_load_dwordx4 v[88:91], v4, s[12:15], s21 offen
  buffer_load_dwordx4 v[92:95], v5, s[12:15], s21 offen
  buffer_load_dwordx4 v[96:99], v6, s[12:15], s21 offen
  s_mul_i32 s21, s20, 491520
  s_add_u32 s21, s21, 4227072
  s_add_u32 s21, s21, s44
  buffer_load_dwordx4 v[100:103], v4, s[12:15], s21 offen
  buffer_load_dwordx4 v[104:107], v5, s[12:15], s21 offen
  buffer_load_dwordx4 v[108:111], v6, s[12:15], s21 offen
  s_mul_i32 s21, s20, 491520
  s_add_u32 s21, s21, 4325376
  s_add_u32 s21, s21, s44
  buffer_load_dwordx4 v[112:115], v4, s[12:15], s21 offen
  buffer_load_dwordx4 v[116:119], v5, s[12:15], s21 offen
  buffer_load_dwordx4 v[120:123], v6, s[12:15], s21 offen
  s_mul_i32 s21, s20, 491520
  s_add_u32 s21, s21, 5898240
  s_add_u32 s21, s21, s44
  buffer_load_dwordx4 v[124:127], v4, s[12:15], s21 offen
  buffer_load_dwordx4 v[128:131], v5, s[12:15], s21 offen
  buffer_load_dwordx4 v[132:135], v6, s[12:15], s21 offen
  s_mul_i32 s21, s20, 491520
  s_add_u32 s21, s21, 5996544
  s_add_u32 s21, s21, s44
  buffer_load_dwordx4 v[136:139], v4, s[12:15], s21 offen
  buffer_load_dwordx4 v[140:143], v5, s[12:15], s21 offen
  buffer_load_dwordx4 v[144:147], v6, s[12:15], s21 offen
  s_mul_i32 s21, s20, 491520
  s_add_u32 s21, s21, 6094848
  s_add_u32 s21, s21, s44
  buffer_load_dwordx4 v[148:151], v4, s[12:15], s21 offen
  buffer_load_dwordx4 v[152:155], v5, s[12:15], s21 offen
  buffer_load_dwordx4 v[156:159], v6, s[12:15], s21 offen
  s_mul_i32 s21, s20, 491520
  s_add_u32 s21, s21, 6193152
  s_add_u32 s21, s21, s44
  buffer_load_dwordx4 v[160:163], v4, s[12:15], s21 offen
  buffer_load_dwordx4 v[164:167], v5, s[12:15], s21 offen
  buffer_load_dwordx4 v[168:171], v6, s[12:15], s21 offen
  s_mul_i32 s21, s20, 491520
  s_add_u32 s21, s21, 6291456
  s_add_u32 s21, s21, s44
  buffer_load_dwordx4 v[172:175], v4, s[12:15], s21 offen
  buffer_load_dwordx4 v[176:179], v5, s[12:15], s21 offen
  buffer_load_dwordx4 v[180:183], v6, s[12:15], s21 offen
  s_mul_i32 s22, s20, 15360
  v_lshl_add_u32 v30, v1, 4, s22
  v_add_u32 v31, 61440, v30
  s_waitcnt vmcnt(45)
  s_barrier
  ds_read_b64_tr_b16 a[0:1], v7 offset:0
  ds_read_b64_tr_b16 a[2:3], v7 offset:1536
  ds_read_b64_tr_b16 a[4:5], v7 offset:32
  ds_read_b64_tr_b16 a[6:7], v7 offset:1568
  ds_read_b64_tr_b16 a[8:9], v7 offset:64
  ds_read_b64_tr_b16 a[10:11], v7 offset:1600
  ds_read_b64_tr_b16 a[12:13], v7 offset:12288
  ds_read_b64_tr_b16 a[14:15], v7 offset:13824
  ds_read_b64_tr_b16 a[16:17], v7 offset:12320
  ds_read_b64_tr_b16 a[18:19], v7 offset:13856
  ds_read_b64_tr_b16 a[20:21], v7 offset:12352
  ds_read_b64_tr_b16 a[22:23], v7 offset:13888
  ds_read_b64_tr_b16 a[24:25], v7 offset:24576
  ds_read_b64_tr_b16 a[26:27], v7 offset:26112
  ds_read_b64_tr_b16 a[28:29], v7 offset:24608
  ds_read_b64_tr_b16 a[30:31], v7 offset:26144
  ds_read_b64_tr_b16 a[32:33], v7 offset:24640
  ds_read_b64_tr_b16 a[34:35], v7 offset:26176
  ds_read_b64_tr_b16 a[36:37], v7 offset:36864
  ds_read_b64_tr_b16 a[38:39], v7 offset:38400
  ds_read_b64_tr_b16 a[40:41], v7 offset:36896
  ds_read_b64_tr_b16 a[42:43], v7 offset:38432
  ds_read_b64_tr_b16 a[44:45], v7 offset:36928
  ds_read_b64_tr_b16 a[46:47], v7 offset:38464
  ds_read_b64_tr_b16 a[48:49], v7 offset:49152
  ds_read_b64_tr_b16 a[50:51], v7 offset:50688
  ds_read_b64_tr_b16 a[52:53], v7 offset:49184
  ds_read_b64_tr_b16 a[54:55], v7 offset:50720
  ds_read_b64_tr_b16 a[56:57], v7 offset:49216
  ds_read_b64_tr_b16 a[58:59], v7 offset:50752
  s_waitcnt lgkmcnt(0)
  s_barrier
  s_waitcnt vmcnt(30)
  s_barrier
  ds_read_b64_tr_b16 a[60:61], v8 offset:0
  ds_read_b64_tr_b16 a[62:63], v8 offset:1536
  ds_read_b64_tr_b16 a[64:65], v8 offset:32
  ds_read_b64_tr_b16 a[66:67], v8 offset:1568
  ds_read_b64_tr_b16 a[68:69], v8 offset:64
  ds_read_b64_tr_b16 a[70:71], v8 offset:1600
  ds_read_b64_tr_b16 a[72:73], v8 offset:12288
  ds_read_b64_tr_b16 a[74:75], v8 offset:13824
  ds_read_b64_tr_b16 a[76:77], v8 offset:12320
  ds_read_b64_tr_b16 a[78:79], v8 offset:13856
  ds_read_b64_tr_b16 a[80:81], v8 offset:12352
  ds_read_b64_tr_b16 a[82:83], v8 offset:13888
  ds_read_b64_tr_b16 a[84:85], v8 offset:24576
  ds_read_b64_tr_b16 a[86:87], v8 offset:26112
  ds_read_b64_tr_b16 a[88:89], v8 offset:24608
  ds_read_b64_tr_b16 a[90:91], v8 offset:26144
  ds_read_b64_tr_b16 a[92:93], v8 offset:24640
  ds_read_b64_tr_b16 a[94:95], v8 offset:26176
  ds_read_b64_tr_b16 a[96:97], v8 offset:36864
  ds_read_b64_tr_b16 a[98:99], v8 offset:38400
  ds_read_b64_tr_b16 a[100:101], v8 offset:36896
  ds_read_b64_tr_b16 a[102:103], v8 offset:38432
  ds_read_b64_tr_b16 a[104:105], v8 offset:36928
  ds_read_b64_tr_b16 a[106:107], v8 offset:38464
  ds_read_b64_tr_b16 a[108:109], v8 offset:49152
  ds_read_b64_tr_b16 a[110:111], v8 offset:50688
  ds_read_b64_tr_b16 a[112:113], v8 offset:49184
  ds_read_b64_tr_b16 a[114:115], v8 offset:50720
  ds_read_b64_tr_b16 a[116:117], v8 offset:49216
  ds_read_b64_tr_b16 a[118:119], v8 offset:50752
  s_waitcnt lgkmcnt(0)
  s_barrier
  s_waitcnt vmcnt(15)
  ds_write_b128 v30, v[64:67] offset:0
  ds_write_b128 v30, v[68:71] offset:1024
  ds_write_b128 v30, v[72:75] offset:2048
  ds_write_b128 v30, v[76:79] offset:3072
  ds_write_b128 v30, v[80:83] offset:4096
  ds_write_b128 v30, v[84:87] offset:5120
  ds_write_b128 v30, v[88:91] offset:6144
  ds_write_b128 v30, v[92:95] offset:7168
  ds_write_b128 v30, v[96:99] offset:8192
  ds_write_b128 v30, v[100:103] offset:9216
  ds_write_b128 v30, v[104:107] offset:10240
  ds_write_b128 v30, v[108:111] offset:11264
  ds_write_b128 v30, v[112:115] offset:12288
  ds_write_b128 v30, v[116:119] offset:13312
  ds_write_b128 v30, v[120:123] offset:14336
  s_waitcnt lgkmcnt(0)
  s_barrier
  ds_read_b64_tr_b16 a[120:121], v7 offset:0
  ds_read_b64_tr_b16 a[122:123], v7 offset:1536
  ds_read_b64_tr_b16 a[124:125], v7 offset:32
  ds_read_b64_tr_b16 a[126:127], v7 offset:1568
  ds_read_b64_tr_b16 a[128:129], v7 offset:64
  ds_read_b64_tr_b16 a[130:131], v7 offset:1600
  ds_read_b64_tr_b16 a[132:133], v7 offset:12288
  ds_read_b64_tr_b16 a[134:135], v7 offset:13824
  ds_read_b64_tr_b16 a[136:137], v7 offset:12320
  ds_read_b64_tr_b16 a[138:139], v7 offset:13856
  ds_read_b64_tr_b16 a[140:141], v7 offset:12352
  ds_read_b64_tr_b16 a[142:143], v7 offset:13888
  ds_read_b64_tr_b16 a[144:145], v7 offset:24576
  ds_read_b64_tr_b16 a[146:147], v7 offset:26112
  ds_read_b64_tr_b16 a[148:149], v7 offset:24608
  ds_read_b64_tr_b16 a[150:151], v7 offset:26144
  ds_read_b64_tr_b16 a[152:153], v7 offset:24640
  ds_read_b64_tr_b16 a[154:155], v7 offset:26176
  ds_read_b64_tr_b16 a[156:157], v7 offset:36864
  ds_read_b64_tr_b16 a[158:159], v7 offset:38400
  ds_read_b64_tr_b16 a[160:161], v7 offset:36896
  ds_read_b64_tr_b16 a[162:163], v7 offset:38432
  ds_read_b64_tr_b16 a[164:165], v7 offset:36928
  ds_read_b64_tr_b16 a[166:167], v7 offset:38464
  ds_read_b64_tr_b16 a[168:169], v7 offset:49152
  ds_read_b64_tr_b16 a[170:171], v7 offset:50688
  ds_read_b64_tr_b16 a[172:173], v7 offset:49184
  ds_read_b64_tr_b16 a[174:175], v7 offset:50720
  ds_read_b64_tr_b16 a[176:177], v7 offset:49216
  ds_read_b64_tr_b16 a[178:179], v7 offset:50752
  s_waitcnt lgkmcnt(0)
  s_barrier
  s_waitcnt vmcnt(0)
  ds_write_b128 v31, v[124:127] offset:0
  ds_write_b128 v31, v[128:131] offset:1024
  ds_write_b128 v31, v[132:135] offset:2048
  ds_write_b128 v31, v[136:139] offset:3072
  ds_write_b128 v31, v[140:143] offset:4096
  ds_write_b128 v31, v[144:147] offset:5120
  ds_write_b128 v31, v[148:151] offset:6144
  ds_write_b128 v31, v[152:155] offset:7168
  ds_write_b128 v31, v[156:159] offset:8192
  ds_write_b128 v31, v[160:163] offset:9216
  ds_write_b128 v31, v[164:167] offset:10240
  ds_write_b128 v31, v[168:171] offset:11264
  ds_write_b128 v31, v[172:175] offset:12288
  ds_write_b128 v31, v[176:179] offset:13312
  ds_write_b128 v31, v[180:183] offset:14336
  s_waitcnt lgkmcnt(0)
  s_barrier
  ds_read_b64_tr_b16 a[180:181], v8 offset:0
  ds_read_b64_tr_b16 a[182:183], v8 offset:1536
  ds_read_b64_tr_b16 a[184:185], v8 offset:32
  ds_read_b64_tr_b16 a[186:187], v8 offset:1568
  ds_read_b64_tr_b16 a[188:189], v8 offset:64
  ds_read_b64_tr_b16 a[190:191], v8 offset:1600
  ds_read_b64_tr_b16 a[192:193], v8 offset:12288
  ds_read_b64_tr_b16 a[194:195], v8 offset:13824
  ds_read_b64_tr_b16 a[196:197], v8 offset:12320
  ds_read_b64_tr_b16 a[198:199], v8 offset:13856
  ds_read_b64_tr_b16 a[200:201], v8 offset:12352
  ds_read_b64_tr_b16 a[202:203], v8 offset:13888
  ds_read_b64_tr_b16 a[204:205], v8 offset:24576
  ds_read_b64_tr_b16 a[206:207], v8 offset:26112
  ds_read_b64_tr_b16 a[208:209], v8 offset:24608
  ds_read_b64_tr_b16 a[210:211], v8 offset:26144
  ds_read_b64_tr_b16 a[212:213], v8 offset:24640
  ds_read_b64_tr_b16 a[214:215], v8 offset:26176
  ds_read_b64_tr_b16 a[216:217], v8 offset:36864
  ds_read_b64_tr_b16 a[218:219], v8 offset:38400
  ds_read_b64_tr_b16 a[220:221], v8 offset:36896
  ds_read_b64_tr_b16 a[222:223], v8 offset:38432
  ds_read_b64_tr_b16 a[224:225], v8 offset:36928
  ds_read_b64_tr_b16 a[226:227], v8 offset:38464
  ds_read_b64_tr_b16 a[228:229], v8 offset:49152
  ds_read_b64_tr_b16 a[230:231], v8 offset:50688
  ds_read_b64_tr_b16 a[232:233], v8 offset:49184
  ds_read_b64_tr_b16 a[234:235], v8 offset:50720
  ds_read_b64_tr_b16 a[236:237], v8 offset:49216
  ds_read_b64_tr_b16 a[238:239], v8 offset:50752
  s_waitcnt lgkmcnt(0)
  s_barrier
  s_mul_i32 s21, s20, 12800
  s_add_u32 s21, s21, 98304
  v_mul_u32_u24 v4, 400, v2
  v_lshlrev_b32 v5, 4, v3
  v_add3_u32 v29, v4, v5, s21
  v_lshlrev_b32 v30, 4, v1
  v_and_b32 v4, 7, v2
  v_lshlrev_b32 v4, 4, v4
  v_lshl_add_u32 v31, v3, 7, v4
  v_lshlrev_b32 v32, 3, v1
  v_and_b32 v4, 3, v1
  v_lshlrev_b32 v33, 3, v4
  v_mov_b32 v34, 0xf149f2ca
  v_lshlrev_b32 v4, 2, v3
  v_sub_u32 v35, v2, v4
  v_cmp_gt_u32 s[60:61], 2, v3
  s_mov_b32 s62, 0x3d93cd3a
  s_mov_b32 s63, 0x3fb8aa3b
  s_mov_b32 s83, 0x3dd53b95
  v_cmp_le_i32 s[64:65], 0, v35
  v_cmp_le_i32 s[66:67], 1, v35
  v_cmp_le_i32 s[68:69], 2, v35
  v_cmp_le_i32 s[70:71], 3, v35
  s_mov_b32 s24, 2457600
  s_mov_b32 s25, 4292509696
  s_mov_b32 s26, 16
  s_lshl_b32 s49, s41, 2
  s_add_u32 s49, s49, s20
  s_mov_b32 s29, 4
  s_mov_b32 s78, 0
  s_mov_b32 s81, 0x80000000
  s_mov_b32 s82, 0
  v_lshrrev_b32 v11, 3, v1
  v_and_b32 v12, 7, v1
  v_xor_b32 v12, v12, v11
  v_mul_u32_u24 v11, 1280, v11
  v_lshl_add_u32 v10, v12, 4, v11
  s_mov_b32 s30, s24
  s_mov_b32 s31, 0
  s_mov_b32 s32, 0
  s_mul_i32 s46, s20, 40960
  s_add_u32 s46, s46, s30
  s_lshl_b32 s47, s20, 12
  s_add_u32 s47, s47, s32
  s_add_u32 m0, s47, 0
  s_nop 0
  buffer_load_dwordx4 v10, s[8:11], s46 offen lds
  s_add_u32 s46, s46, 10240
  s_add_u32 m0, s47, 1024
  s_nop 0
  buffer_load_dwordx4 v10, s[8:11], s46 offen lds
  s_add_u32 s46, s46, 10240
  s_add_u32 m0, s47, 2048
  s_nop 0
  buffer_load_dwordx4 v10, s[8:11], s46 offen lds
  s_add_u32 s46, s46, 10240
  s_add_u32 m0, s47, 3072
  s_nop 0
  buffer_load_dwordx4 v10, s[8:11], s46 offen lds
  s_add_u32 s30, s30, 128
  s_add_u32 s31, s31, 1
  s_cmp_lt_u32 s31, 10
  s_cbranch_scc1 qa_284
  s_mov_b32 s31, 0
  s_add_u32 s30, s30, s25
  s_sub_u32 s30, s30, 1280
  s_mov_b32 s25, 163840
qa_284:
  s_add_u32 s32, s32, 16384
  s_cmp_lt_u32 s32, 98304
  s_cselect_b32 s32, s32, 0
  s_mul_i32 s46, s20, 40960
  s_add_u32 s46, s46, s30
  s_lshl_b32 s47, s20, 12
  s_add_u32 s47, s47, s32
  s_add_u32 m0, s47, 0
  s_nop 0
  buffer_load_dwordx4 v10, s[8:11], s46 offen lds
  s_add_u32 s46, s46, 10240
  s_add_u32 m0, s47, 1024
  s_nop 0
  buffer_load_dwordx4 v10, s[8:11], s46 offen lds
  s_add_u32 s46, s46, 10240
  s_add_u32 m0, s47, 2048
  s_nop 0
  buffer_load_dwordx4 v10, s[8:11], s46 offen lds
  s_add_u32 s46, s46, 10240
  s_add_u32 m0, s47, 3072
  s_nop 0
  buffer_load_dwordx4 v10, s[8:11], s46 offen lds
  s_add_u32 s30, s30, 128
  s_add_u32 s31, s31, 1
  s_cmp_lt_u32 s31, 10
  s_cbranch_scc1 qa_285
  s_mov_b32 s31, 0
  s_add_u32 s30, s30, s25
  s_sub_u32 s30, s30, 1280
  s_mov_b32 s25, 163840
qa_285:
  s_add_u32 s32, s32, 16384
  s_cmp_lt_u32 s32, 98304
  s_cselect_b32 s32, s32, 0
  s_mul_i32 s46, s20, 40960
  s_add_u32 s46, s46, s30
  s_lshl_b32 s47, s20, 12
  s_add_u32 s47, s47, s32
  s_add_u32 m0, s47, 0
  s_nop 0
  buffer_load_dwordx4 v10, s[8:11], s46 offen lds
  s_add_u32 s46, s46, 10240
  s_add_u32 m0, s47, 1024
  s_nop 0
  buffer_load_dwordx4 v10, s[8:11], s46 offen lds
  s_add_u32 s46, s46, 10240
  s_add_u32 m0, s47, 2048
  s_nop 0
  buffer_load_dwordx4 v10, s[8:11], s46 offen lds
  s_add_u32 s46, s46, 10240
  s_add_u32 m0, s47, 3072
  s_nop 0
  buffer_load_dwordx4 v10, s[8:11], s46 offen lds
  s_add_u32 s30, s30, 128
  s_add_u32 s31, s31, 1
  s_cmp_lt_u32 s31, 10
  s_cbranch_scc1 qa_286
  s_mov_b32 s31, 0
  s_add_u32 s30, s30, s25
  s_sub_u32 s30, s30, 1280
  s_mov_b32 s25, 163840
qa_286:
  s_add_u32 s32, s32, 16384
  s_cmp_lt_u32 s32, 98304
  s_cselect_b32 s32, s32, 0
  s_mul_i32 s46, s20, 40960
  s_add_u32 s46, s46, s30
  s_lshl_b32 s47, s20, 12
  s_add_u32 s47, s47, s32
  s_add_u32 m0, s47, 0
  s_nop 0
  buffer_load_dwordx4 v10, s[8:11], s46 offen lds
  s_add_u32 s46, s46, 10240
  s_add_u32 m0, s47, 1024
  s_nop 0
  buffer_load_dwordx4 v10, s[8:11], s46 offen lds
  s_add_u32 s46, s46, 10240
  s_add_u32 m0, s47, 2048
  s_nop 0
  buffer_load_dwordx4 v10, s[8:11], s46 offen lds
  s_add_u32 s46, s46, 10240
  s_add_u32 m0, s47, 3072
  s_nop 0
  buffer_load_dwordx4 v10, s[8:11], s46 offen lds
  s_add_u32 s30, s30, 128
  s_add_u32 s31, s31, 1
  s_cmp_lt_u32 s31, 10
  s_cbranch_scc1 qa_287
  s_mov_b32 s31, 0
  s_add_u32 s30, s30, s25
  s_sub_u32 s30, s30, 1280
  s_mov_b32 s25, 163840
qa_287:
  s_add_u32 s32, s32, 16384
  s_cmp_lt_u32 s32, 98304
  s_cselect_b32 s32, s32, 0
  v_and_b32 v6, 7, v2
  v_add_u32 v4, 0, v3
  v_xor_b32 v4, v4, v6
  v_lshlrev_b32 v4, 4, v4
  v_lshl_add_u32 v14, v2, 7, v4
  v_add_u32 v4, 4, v3
  v_xor_b32 v4, v4, v6
  v_lshlrev_b32 v4, 4, v4
  v_lshl_add_u32 v15, v2, 7, v4
  v_mul_u32_u24 v22, 400, v2
  v_mul_u32_u24 v4, 24, v3
  s_mul_i32 s21, s20, 96
  s_add_u32 s21, s21, 98304
  v_add3_u32 v22, v22, v4, s21
  v_mov_b32 v9, 2731
  s_mov_b32 s33, 0
  s_mov_b32 s48, 0x80000000
  s_mul_i32 s46, s20, 40960
  s_add_u32 s46, s46, s30
  s_lshl_b32 s47, s20, 12
  s_add_u32 s47, s47, s32
  s_add_u32 m0, s47, 0
  s_nop 0
  buffer_load_dwordx4 v10, s[8:11], s46 offen lds
  s_add_u32 s46, s46, 10240
  s_add_u32 m0, s47, 1024
  s_nop 0
  buffer_load_dwordx4 v10, s[8:11], s46 offen lds
  s_waitcnt vmcnt(14)
  s_barrier
  v_add_u32 v18, s33, v14
  v_add_u32 v19, s33, v15
  s_add_u32 s33, s33, 16384
  s_cmp_lt_u32 s33, 98304
  s_cselect_b32 s33, s33, 0
  ds_read_b128 v[160:163], v18 offset:0
  ds_read_b128 v[164:167], v18 offset:2048
  ds_read_b128 v[168:171], v18 offset:4096
  ds_read_b128 v[172:175], v18 offset:6144
  ds_read_b128 v[176:179], v18 offset:8192
  ds_read_b128 v[180:183], v18 offset:10240
  ds_read_b128 v[184:187], v18 offset:12288
  ds_read_b128 v[188:191], v18 offset:14336
qa_blk_288:
  ds_read_b128 v[192:195], v19 offset:0
  s_waitcnt lgkmcnt(8)
  v_mfma_f32_16x16x32_bf16 v[64:67], a[0:3], v[160:163], 0
  v_mfma_f32_16x16x32_bf16 v[68:71], a[4:7], v[160:163], 0
  v_mfma_f32_16x16x32_bf16 v[72:75], a[8:11], v[160:163], 0
  ds_read_b128 v[196:199], v19 offset:2048
  s_waitcnt lgkmcnt(8)
  v_mfma_f32_16x16x32_bf16 v[76:79], a[0:3], v[164:167], 0
  v_mfma_f32_16x16x32_bf16 v[80:83], a[4:7], v[164:167], 0
  v_mfma_f32_16x16x32_bf16 v[84:87], a[8:11], v[164:167], 0
  s_add_u32 s46, s46, 10240
  s_add_u32 m0, s47, 2048
  s_nop 0
  buffer_load_dwordx4 v10, s[8:11], s46 offen lds
  ds_read_b128 v[200:203], v19 offset:4096
  s_waitcnt lgkmcnt(8)
  v_mfma_f32_16x16x32_bf16 v[88:91], a[0:3], v[168:171], 0
  v_mfma_f32_16x16x32_bf16 v[92:95], a[4:7], v[168:171], 0
  v_mfma_f32_16x16x32_bf16 v[96:99], a[8:11], v[168:171], 0
  ds_read_b128 v[204:207], v19 offset:6144
  s_waitcnt lgkmcnt(8)
  v_mfma_f32_16x16x32_bf16 v[100:103], a[0:3], v[172:175], 0
  v_mfma_f32_16x16x32_bf16 v[104:107], a[4:7], v[172:175], 0
  v_mfma_f32_16x16x32_bf16 v[108:111], a[8:11], v[172:175], 0
  ds_read_b128 v[208:211], v19 offset:8192
  s_waitcnt lgkmcnt(8)
  v_mfma_f32_16x16x32_bf16 v[112:115], a[0:3], v[176:179], 0
  v_mfma_f32_16x16x32_bf16 v[116:119], a[4:7], v[176:179], 0
  v_mfma_f32_16x16x32_bf16 v[120:123], a[8:11], v[176:179], 0
  ds_read_b128 v[212:215], v19 offset:10240
  s_waitcnt lgkmcnt(8)
  v_mfma_f32_16x16x32_bf16 v[124:127], a[0:3], v[180:183], 0
  v_mfma_f32_16x16x32_bf16 v[128:131], a[4:7], v[180:183], 0
  v_mfma_f32_16x16x32_bf16 v[132:135], a[8:11], v[180:183], 0
  s_add_u32 s46, s46, 10240
  s_add_u32 m0, s47, 3072
  s_nop 0
  buffer_load_dwordx4 v10, s[8:11], s46 offen lds
  ds_read_b128 v[216:219], v19 offset:12288
  s_waitcnt lgkmcnt(8)
  v_mfma_f32_16x16x32_bf16 v[136:139], a[0:3], v[184:187], 0
  v_mfma_f32_16x16x32_bf16 v[140:143], a[4:7], v[184:187], 0
  v_mfma_f32_16x16x32_bf16 v[144:147], a[8:11], v[184:187], 0
  ds_read_b128 v[220:223], v19 offset:14336
  s_waitcnt lgkmcnt(8)
  v_mfma_f32_16x16x32_bf16 v[148:151], a[0:3], v[188:191], 0
  v_mfma_f32_16x16x32_bf16 v[152:155], a[4:7], v[188:191], 0
  v_mfma_f32_16x16x32_bf16 v[156:159], a[8:11], v[188:191], 0
  s_waitcnt vmcnt(12)
  s_barrier
  s_add_u32 s30, s30, 128
  s_add_u32 s31, s31, 1
  s_cmp_lt_u32 s31, 10
  s_cbranch_scc1 qa_289
  s_mov_b32 s31, 0
  s_add_u32 s30, s30, s25
  s_sub_u32 s30, s30, 1280
  s_mov_b32 s25, 163840
qa_289:
  s_add_u32 s32, s32, 16384
  s_cmp_lt_u32 s32, 98304
  s_cselect_b32 s32, s32, 0
  s_mul_i32 s46, s20, 40960
  s_add_u32 s46, s46, s30
  s_lshl_b32 s47, s20, 12
  s_add_u32 s47, s47, s32
  v_add_u32 v18, s33, v14
  v_add_u32 v19, s33, v15
  s_add_u32 s33, s33, 16384
  s_cmp_lt_u32 s33, 98304
  s_cselect_b32 s33, s33, 0
  ds_read_b128 v[160:163], v18 offset:0
  s_waitcnt lgkmcnt(8)
  v_mfma_f32_16x16x32_bf16 v[64:67], a[12:15], v[192:195], v[64:67]
  v_mfma_f32_16x16x32_bf16 v[68:71], a[16:19], v[192:195], v[68:71]
  v_mfma_f32_16x16x32_bf16 v[72:75], a[20:23], v[192:195], v[72:75]
  ds_read_b128 v[164:167], v18 offset:2048
  s_waitcnt lgkmcnt(8)
  v_mfma_f32_16x16x32_bf16 v[76:79], a[12:15], v[196:199], v[76:79]
  v_mfma_f32_16x16x32_bf16 v[80:83], a[16:19], v[196:199], v[80:83]
  v_mfma_f32_16x16x32_bf16 v[84:87], a[20:23], v[196:199], v[84:87]
  s_add_u32 m0, s47, 0
  s_nop 0
  buffer_load_dwordx4 v10, s[8:11], s46 offen lds
  ds_read_b128 v[168:171], v18 offset:4096
  s_waitcnt lgkmcnt(8)
  v_mfma_f32_16x16x32_bf16 v[88:91], a[12:15], v[200:203], v[88:91]
  v_mfma_f32_16x16x32_bf16 v[92:95], a[16:19], v[200:203], v[92:95]
  v_mfma_f32_16x16x32_bf16 v[96:99], a[20:23], v[200:203], v[96:99]
  ds_read_b128 v[172:175], v18 offset:6144
  s_waitcnt lgkmcnt(8)
  v_mfma_f32_16x16x32_bf16 v[100:103], a[12:15], v[204:207], v[100:103]
  v_mfma_f32_16x16x32_bf16 v[104:107], a[16:19], v[204:207], v[104:107]
  v_mfma_f32_16x16x32_bf16 v[108:111], a[20:23], v[204:207], v[108:111]
  ds_read_b128 v[176:179], v18 offset:8192
  s_waitcnt lgkmcnt(8)
  v_mfma_f32_16x16x32_bf16 v[112:115], a[12:15], v[208:211], v[112:115]
  v_mfma_f32_16x16x32_bf16 v[116:119], a[16:19], v[208:211], v[116:119]
  v_mfma_f32_16x16x32_bf16 v[120:123], a[20:23], v[208:211], v[120:123]
  ds_read_b128 v[180:183], v18 offset:10240
  s_waitcnt lgkmcnt(8)
  v_mfma_f32_16x16x32_bf16 v[124:127], a[12:15], v[212:215], v[124:127]
  v_mfma_f32_16x16x32_bf16 v[128:131], a[16:19], v[212:215], v[128:131]
  v_mfma_f32_16x16x32_bf16 v[132:135], a[20:23], v[212:215], v[132:135]
  s_add_u32 s46, s46, 10240
  s_add_u32 m0, s47, 1024
  s_nop 0
  buffer_load_dwordx4 v10, s[8:11], s46 offen lds
  ds_read_b128 v[184:187], v18 offset:12288
  s_waitcnt lgkmcnt(8)
  v_mfma_f32_16x16x32_bf16 v[136:139], a[12:15], v[216:219], v[136:139]
  v_mfma_f32_16x16x32_bf16 v[140:143], a[16:19], v[216:219], v[140:143]
  v_mfma_f32_16x16x32_bf16 v[144:147], a[20:23], v[216:219], v[144:147]
  ds_read_b128 v[188:191], v18 offset:14336
  s_waitcnt lgkmcnt(8)
  v_mfma_f32_16x16x32_bf16 v[148:151], a[12:15], v[220:223], v[148:151]
  v_mfma_f32_16x16x32_bf16 v[152:155], a[16:19], v[220:223], v[152:155]
  v_mfma_f32_16x16x32_bf16 v[156:159], a[20:23], v[220:223], v[156:159]
  ds_read_b128 v[192:195], v19 offset:0
  s_waitcnt lgkmcnt(8)
  v_mfma_f32_16x16x32_bf16 v[64:67], a[24:27], v[160:163], v[64:67]
  v_mfma_f32_16x16x32_bf16 v[68:71], a[28:31], v[160:163], v[68:71]
  v_mfma_f32_16x16x32_bf16 v[72:75], a[32:35], v[160:163], v[72:75]
  ds_read_b128 v[196:199], v19 offset:2048
  s_waitcnt lgkmcnt(8)
  v_mfma_f32_16x16x32_bf16 v[76:79], a[24:27], v[164:167], v[76:79]
  v_mfma_f32_16x16x32_bf16 v[80:83], a[28:31], v[164:167], v[80:83]
  v_mfma_f32_16x16x32_bf16 v[84:87], a[32:35], v[164:167], v[84:87]
  s_add_u32 s46, s46, 10240
  s_add_u32 m0, s47, 2048
  s_nop 0
  buffer_load_dwordx4 v10, s[8:11], s46 offen lds
  ds_read_b128 v[200:203], v19 offset:4096
  s_waitcnt lgkmcnt(8)
  v_mfma_f32_16x16x32_bf16 v[88:91], a[24:27], v[168:171], v[88:91]
  v_mfma_f32_16x16x32_bf16 v[92:95], a[28:31], v[168:171], v[92:95]
  v_mfma_f32_16x16x32_bf16 v[96:99], a[32:35], v[168:171], v[96:99]
  ds_read_b128 v[204:207], v19 offset:6144
  s_waitcnt lgkmcnt(8)
  v_mfma_f32_16x16x32_bf16 v[100:103], a[24:27], v[172:175], v[100:103]
  v_mfma_f32_16x16x32_bf16 v[104:107], a[28:31], v[172:175], v[104:107]
  v_mfma_f32_16x16x32_bf16 v[108:111], a[32:35], v[172:175], v[108:111]
  ds_read_b128 v[208:211], v19 offset:8192
  s_waitcnt lgkmcnt(8)
  v_mfma_f32_16x16x32_bf16 v[112:115], a[24:27], v[176:179], v[112:115]
  v_mfma_f32_16x16x32_bf16 v[116:119], a[28:31], v[176:179], v[116:119]
  v_mfma_f32_16x16x32_bf16 v[120:123], a[32:35], v[176:179], v[120:123]
  ds_read_b128 v[212:215], v19 offset:10240
  s_waitcnt lgkmcnt(8)
  v_mfma_f32_16x16x32_bf16 v[124:127], a[24:27], v[180:183], v[124:127]
  v_mfma_f32_16x16x32_bf16 v[128:131], a[28:31], v[180:183], v[128:131]
  v_mfma_f32_16x16x32_bf16 v[132:135], a[32:35], v[180:183], v[132:135]
  s_add_u32 s46, s46, 10240
  s_add_u32 m0, s47, 3072
  s_nop 0
  buffer_load_dwordx4 v10, s[8:11], s46 offen lds
  ds_read_b128 v[216:219], v19 offset:12288
  s_waitcnt lgkmcnt(8)
  v_mfma_f32_16x16x32_bf16 v[136:139], a[24:27], v[184:187], v[136:139]
  v_mfma_f32_16x16x32_bf16 v[140:143], a[28:31], v[184:187], v[140:143]
  v_mfma_f32_16x16x32_bf16 v[144:147], a[32:35], v[184:187], v[144:147]
  ds_read_b128 v[220:223], v19 offset:14336
  s_waitcnt lgkmcnt(8)
  v_mfma_f32_16x16x32_bf16 v[148:151], a[24:27], v[188:191], v[148:151]
  v_mfma_f32_16x16x32_bf16 v[152:155], a[28:31], v[188:191], v[152:155]
  v_mfma_f32_16x16x32_bf16 v[156:159], a[32:35], v[188:191], v[156:159]
  s_waitcnt vmcnt(12)
  s_barrier
  s_add_u32 s30, s30, 128
  s_add_u32 s31, s31, 1
  s_cmp_lt_u32 s31, 10
  s_cbranch_scc1 qa_290
  s_mov_b32 s31, 0
  s_add_u32 s30, s30, s25
  s_sub_u32 s30, s30, 1280
  s_mov_b32 s25, 163840
qa_290:
  s_add_u32 s32, s32, 16384
  s_cmp_lt_u32 s32, 98304
  s_cselect_b32 s32, s32, 0
  s_mul_i32 s46, s20, 40960
  s_add_u32 s46, s46, s30
  s_lshl_b32 s47, s20, 12
  s_add_u32 s47, s47, s32
  v_add_u32 v18, s33, v14
  v_add_u32 v19, s33, v15
  s_add_u32 s33, s33, 16384
  s_cmp_lt_u32 s33, 98304
  s_cselect_b32 s33, s33, 0
  ds_read_b128 v[160:163], v18 offset:0
  s_waitcnt lgkmcnt(8)
  v_mfma_f32_16x16x32_bf16 v[64:67], a[36:39], v[192:195], v[64:67]
  v_mfma_f32_16x16x32_bf16 v[68:71], a[40:43], v[192:195], v[68:71]
  v_mfma_f32_16x16x32_bf16 v[72:75], a[44:47], v[192:195], v[72:75]
  ds_read_b128 v[164:167], v18 offset:2048
  s_waitcnt lgkmcnt(8)
  v_mfma_f32_16x16x32_bf16 v[76:79], a[36:39], v[196:199], v[76:79]
  v_mfma_f32_16x16x32_bf16 v[80:83], a[40:43], v[196:199], v[80:83]
  v_mfma_f32_16x16x32_bf16 v[84:87], a[44:47], v[196:199], v[84:87]
  s_add_u32 m0, s47, 0
  s_nop 0
  buffer_load_dwordx4 v10, s[8:11], s46 offen lds
  ds_read_b128 v[168:171], v18 offset:4096
  s_waitcnt lgkmcnt(8)
  v_mfma_f32_16x16x32_bf16 v[88:91], a[36:39], v[200:203], v[88:91]
  v_mfma_f32_16x16x32_bf16 v[92:95], a[40:43], v[200:203], v[92:95]
  v_mfma_f32_16x16x32_bf16 v[96:99], a[44:47], v[200:203], v[96:99]
  ds_read_b128 v[172:175], v18 offset:6144
  s_waitcnt lgkmcnt(8)
  v_mfma_f32_16x16x32_bf16 v[100:103], a[36:39], v[204:207], v[100:103]
  v_mfma_f32_16x16x32_bf16 v[104:107], a[40:43], v[204:207], v[104:107]
  v_mfma_f32_16x16x32_bf16 v[108:111], a[44:47], v[204:207], v[108:111]
  ds_read_b128 v[176:179], v18 offset:8192
  s_waitcnt lgkmcnt(8)
  v_mfma_f32_16x16x32_bf16 v[112:115], a[36:39], v[208:211], v[112:115]
  v_mfma_f32_16x16x32_bf16 v[116:119], a[40:43], v[208:211], v[116:119]
  v_mfma_f32_16x16x32_bf16 v[120:123], a[44:47], v[208:211], v[120:123]
  ds_read_b128 v[180:183], v18 offset:10240
  s_waitcnt lgkmcnt(8)
  v_mfma_f32_16x16x32_bf16 v[124:127], a[36:39], v[212:215], v[124:127]
  v_mfma_f32_16x16x32_bf16 v[128:131], a[40:43], v[212:215], v[128:131]
  v_mfma_f32_16x16x32_bf16 v[132:135], a[44:47], v[212:215], v[132:135]
  s_add_u32 s46, s46, 10240
  s_add_u32 m0, s47, 1024
  s_nop 0
  buffer_load_dwordx4 v10, s[8:11], s46 offen lds
  ds_read_b128 v[184:187], v18 offset:12288
  s_waitcnt lgkmcnt(8)
  v_mfma_f32_16x16x32_bf16 v[136:139], a[36:39], v[216:219], v[136:139]
  v_mfma_f32_16x16x32_bf16 v[140:143], a[40:43], v[216:219], v[140:143]
  v_mfma_f32_16x16x32_bf16 v[144:147], a[44:47], v[216:219], v[144:147]
  ds_read_b128 v[188:191], v18 offset:14336
  s_waitcnt lgkmcnt(8)
  v_mfma_f32_16x16x32_bf16 v[148:151], a[36:39], v[220:223], v[148:151]
  v_mfma_f32_16x16x32_bf16 v[152:155], a[40:43], v[220:223], v[152:155]
  v_mfma_f32_16x16x32_bf16 v[156:159], a[44:47], v[220:223], v[156:159]
  ds_read_b128 v[192:195], v19 offset:0
  s_waitcnt lgkmcnt(8)
  v_mfma_f32_16x16x32_bf16 v[64:67], a[48:51], v[160:163], v[64:67]
  v_mfma_f32_16x16x32_bf16 v[68:71], a[52:55], v[160:163], v[68:71]
  v_mfma_f32_16x16x32_bf16 v[72:75], a[56:59], v[160:163], v[72:75]
  ds_read_b128 v[196:199], v19 offset:2048
  s_waitcnt lgkmcnt(8)
  v_mfma_f32_16x16x32_bf16 v[76:79], a[48:51], v[164:167], v[76:79]
  v_mfma_f32_16x16x32_bf16 v[80:83], a[52:55], v[164:167], v[80:83]
  v_mfma_f32_16x16x32_bf16 v[84:87], a[56:59], v[164:167], v[84:87]
  s_add_u32 s46, s46, 10240
  s_add_u32 m0, s47, 2048
  s_nop 0
  buffer_load_dwordx4 v10, s[8:11], s46 offen lds
  ds_read_b128 v[200:203], v19 offset:4096
  s_waitcnt lgkmcnt(8)
  v_mfma_f32_16x16x32_bf16 v[88:91], a[48:51], v[168:171], v[88:91]
  v_mfma_f32_16x16x32_bf16 v[92:95], a[52:55], v[168:171], v[92:95]
  v_mfma_f32_16x16x32_bf16 v[96:99], a[56:59], v[168:171], v[96:99]
  ds_read_b128 v[204:207], v19 offset:6144
  s_waitcnt lgkmcnt(8)
  v_mfma_f32_16x16x32_bf16 v[100:103], a[48:51], v[172:175], v[100:103]
  v_mfma_f32_16x16x32_bf16 v[104:107], a[52:55], v[172:175], v[104:107]
  v_mfma_f32_16x16x32_bf16 v[108:111], a[56:59], v[172:175], v[108:111]
  ds_read_b128 v[208:211], v19 offset:8192
  s_waitcnt lgkmcnt(8)
  v_mfma_f32_16x16x32_bf16 v[112:115], a[48:51], v[176:179], v[112:115]
  v_mfma_f32_16x16x32_bf16 v[116:119], a[52:55], v[176:179], v[116:119]
  v_mfma_f32_16x16x32_bf16 v[120:123], a[56:59], v[176:179], v[120:123]
  ds_read_b128 v[212:215], v19 offset:10240
  s_waitcnt lgkmcnt(8)
  v_mfma_f32_16x16x32_bf16 v[124:127], a[48:51], v[180:183], v[124:127]
  v_mfma_f32_16x16x32_bf16 v[128:131], a[52:55], v[180:183], v[128:131]
  v_mfma_f32_16x16x32_bf16 v[132:135], a[56:59], v[180:183], v[132:135]
  s_add_u32 s46, s46, 10240
  s_add_u32 m0, s47, 3072
  s_nop 0
  buffer_load_dwordx4 v10, s[8:11], s46 offen lds
  ds_read_b128 v[216:219], v19 offset:12288
  s_waitcnt lgkmcnt(8)
  v_mfma_f32_16x16x32_bf16 v[136:139], a[48:51], v[184:187], v[136:139]
  v_mfma_f32_16x16x32_bf16 v[140:143], a[52:55], v[184:187], v[140:143]
  v_mfma_f32_16x16x32_bf16 v[144:147], a[56:59], v[184:187], v[144:147]
  ds_read_b128 v[220:223], v19 offset:14336
  s_waitcnt lgkmcnt(8)
  v_mfma_f32_16x16x32_bf16 v[148:151], a[48:51], v[188:191], v[148:151]
  v_mfma_f32_16x16x32_bf16 v[152:155], a[52:55], v[188:191], v[152:155]
  v_mfma_f32_16x16x32_bf16 v[156:159], a[56:59], v[188:191], v[156:159]
  s_waitcnt vmcnt(12)
  s_barrier
  s_waitcnt vmcnt(10)
  s_cmp_eq_u32 s78, 0
  s_cbranch_scc1 pf_291
  v_mov_b32 v4, 0
  v_mov_b32 v5, 1
  s_mov_b64 exec, 1
  buffer_atomic_add v5, v4, s[72:75], s78 offen sc1
  s_mov_b64 exec, -1
  s_mov_b32 s78, 0
pf_291:
  s_mul_i32 s21, s49, 393216
  s_mul_i32 s22, s42, 12288
  s_add_u32 s50, s21, s22
  s_mul_i32 s21, s49, 98304
  s_mul_i32 s22, s42, 3072
  s_add_u32 s51, s21, s22
  s_lshr_b32 s22, s49, 1
  s_lshr_b32 s21, s49, 2
  s_add_u32 s21, s21, 2
  s_cmp_lt_u32 s49, 8
  s_cselect_b32 s21, s22, s21
  s_lshl_b32 s21, s21, 3
  s_lshr_b32 s22, s42, 2
  s_add_u32 s21, s21, s22
  s_lshl_b32 s21, s21, 7
  s_add_u32 s76, s21, 0
  s_lshl_b32 s77, s42, 7
  s_add_u32 s77, s77, 18432
  v_mov_b32 v4, 0
  buffer_load_dword v20, v4, s[72:75], s76 offen sc1
  s_add_u32 s30, s30, 128
  s_add_u32 s31, s31, 1
  s_cmp_lt_u32 s31, 10
  s_cbranch_scc1 qa_292
  s_mov_b32 s31, 0
  s_add_u32 s30, s30, s25
  s_sub_u32 s30, s30, 1280
  s_mov_b32 s25, 163840
qa_292:
  s_add_u32 s32, s32, 16384
  s_cmp_lt_u32 s32, 98304
  s_cselect_b32 s32, s32, 0
  s_mul_i32 s46, s20, 40960
  s_add_u32 s46, s46, s30
  s_lshl_b32 s47, s20, 12
  s_add_u32 s47, s47, s32
  v_add_u32 v18, s33, v14
  v_add_u32 v19, s33, v15
  s_add_u32 s33, s33, 16384
  s_cmp_lt_u32 s33, 98304
  s_cselect_b32 s33, s33, 0
  ds_read_b128 v[160:163], v18 offset:0
  s_waitcnt lgkmcnt(8)
  v_mfma_f32_16x16x32_bf16 v[64:67], a[60:63], v[192:195], v[64:67]
  v_mfma_f32_16x16x32_bf16 v[68:71], a[64:67], v[192:195], v[68:71]
  v_mfma_f32_16x16x32_bf16 v[72:75], a[68:71], v[192:195], v[72:75]
  ds_read_b128 v[164:167], v18 offset:2048
  s_waitcnt lgkmcnt(8)
  v_mfma_f32_16x16x32_bf16 v[76:79], a[60:63], v[196:199], v[76:79]
  v_mfma_f32_16x16x32_bf16 v[80:83], a[64:67], v[196:199], v[80:83]
  v_mfma_f32_16x16x32_bf16 v[84:87], a[68:71], v[196:199], v[84:87]
  s_add_u32 m0, s47, 0
  s_nop 0
  buffer_load_dwordx4 v10, s[8:11], s46 offen lds
  ds_read_b128 v[168:171], v18 offset:4096
  s_waitcnt lgkmcnt(8)
  v_mfma_f32_16x16x32_bf16 v[88:91], a[60:63], v[200:203], v[88:91]
  v_mfma_f32_16x16x32_bf16 v[92:95], a[64:67], v[200:203], v[92:95]
  v_mfma_f32_16x16x32_bf16 v[96:99], a[68:71], v[200:203], v[96:99]
  ds_read_b128 v[172:175], v18 offset:6144
  s_waitcnt lgkmcnt(8)
  v_mfma_f32_16x16x32_bf16 v[100:103], a[60:63], v[204:207], v[100:103]
  v_mfma_f32_16x16x32_bf16 v[104:107], a[64:67], v[204:207], v[104:107]
  v_mfma_f32_16x16x32_bf16 v[108:111], a[68:71], v[204:207], v[108:111]
  ds_read_b128 v[176:179], v18 offset:8192
  s_waitcnt lgkmcnt(8)
  v_mfma_f32_16x16x32_bf16 v[112:115], a[60:63], v[208:211], v[112:115]
  v_mfma_f32_16x16x32_bf16 v[116:119], a[64:67], v[208:211], v[116:119]
  v_mfma_f32_16x16x32_bf16 v[120:123], a[68:71], v[208:211], v[120:123]
  ds_read_b128 v[180:183], v18 offset:10240
  s_waitcnt lgkmcnt(8)
  v_mfma_f32_16x16x32_bf16 v[124:127], a[60:63], v[212:215], v[124:127]
  v_mfma_f32_16x16x32_bf16 v[128:131], a[64:67], v[212:215], v[128:131]
  v_mfma_f32_16x16x32_bf16 v[132:135], a[68:71], v[212:215], v[132:135]
  s_add_u32 s46, s46, 10240
  s_add_u32 m0, s47, 1024
  s_nop 0
  buffer_load_dwordx4 v10, s[8:11], s46 offen lds
  ds_read_b128 v[184:187], v18 offset:12288
  s_waitcnt lgkmcnt(8)
  v_mfma_f32_16x16x32_bf16 v[136:139], a[60:63], v[216:219], v[136:139]
  v_mfma_f32_16x16x32_bf16 v[140:143], a[64:67], v[216:219], v[140:143]
  v_mfma_f32_16x16x32_bf16 v[144:147], a[68:71], v[216:219], v[144:147]
  ds_read_b128 v[188:191], v18 offset:14336
  s_waitcnt lgkmcnt(8)
  v_mfma_f32_16x16x32_bf16 v[148:151], a[60:63], v[220:223], v[148:151]
  v_mfma_f32_16x16x32_bf16 v[152:155], a[64:67], v[220:223], v[152:155]
  v_mfma_f32_16x16x32_bf16 v[156:159], a[68:71], v[220:223], v[156:159]
  ds_read_b128 v[192:195], v19 offset:0
  s_waitcnt lgkmcnt(8)
  v_mfma_f32_16x16x32_bf16 v[64:67], a[72:75], v[160:163], v[64:67]
  v_mfma_f32_16x16x32_bf16 v[68:71], a[76:79], v[160:163], v[68:71]
  v_mfma_f32_16x16x32_bf16 v[72:75], a[80:83], v[160:163], v[72:75]
  ds_read_b128 v[196:199], v19 offset:2048
  s_waitcnt lgkmcnt(8)
  v_mfma_f32_16x16x32_bf16 v[76:79], a[72:75], v[164:167], v[76:79]
  v_mfma_f32_16x16x32_bf16 v[80:83], a[76:79], v[164:167], v[80:83]
  v_mfma_f32_16x16x32_bf16 v[84:87], a[80:83], v[164:167], v[84:87]
  s_add_u32 s46, s46, 10240
  s_add_u32 m0, s47, 2048
  s_nop 0
  buffer_load_dwordx4 v10, s[8:11], s46 offen lds
  ds_read_b128 v[200:203], v19 offset:4096
  s_waitcnt lgkmcnt(8)
  v_mfma_f32_16x16x32_bf16 v[88:91], a[72:75], v[168:171], v[88:91]
  v_mfma_f32_16x16x32_bf16 v[92:95], a[76:79], v[168:171], v[92:95]
  v_mfma_f32_16x16x32_bf16 v[96:99], a[80:83], v[168:171], v[96:99]
  ds_read_b128 v[204:207], v19 offset:6144
  s_waitcnt lgkmcnt(8)
  v_mfma_f32_16x16x32_bf16 v[100:103], a[72:75], v[172:175], v[100:103]
  v_mfma_f32_16x16x32_bf16 v[104:107], a[76:79], v[172:175], v[104:107]
  v_mfma_f32_16x16x32_bf16 v[108:111], a[80:83], v[172:175], v[108:111]
  ds_read_b128 v[208:211], v19 offset:8192
  s_waitcnt lgkmcnt(8)
  v_mfma_f32_16x16x32_bf16 v[112:115], a[72:75], v[176:179], v[112:115]
  v_mfma_f32_16x16x32_bf16 v[116:119], a[76:79], v[176:179], v[116:119]
  v_mfma_f32_16x16x32_bf16 v[120:123], a[80:83], v[176:179], v[120:123]
  ds_read_b128 v[212:215], v19 offset:10240
  s_waitcnt lgkmcnt(8)
  v_mfma_f32_16x16x32_bf16 v[124:127], a[72:75], v[180:183], v[124:127]
  v_mfma_f32_16x16x32_bf16 v[128:131], a[76:79], v[180:183], v[128:131]
  v_mfma_f32_16x16x32_bf16 v[132:135], a[80:83], v[180:183], v[132:135]
  s_add_u32 s46, s46, 10240
  s_add_u32 m0, s47, 3072
  s_nop 0
  buffer_load_dwordx4 v10, s[8:11], s46 offen lds
  ds_read_b128 v[216:219], v19 offset:12288
  s_waitcnt lgkmcnt(8)
  v_mfma_f32_16x16x32_bf16 v[136:139], a[72:75], v[184:187], v[136:139]
  v_mfma_f32_16x16x32_bf16 v[140:143], a[76:79], v[184:187], v[140:143]
  v_mfma_f32_16x16x32_bf16 v[144:147], a[80:83], v[184:187], v[144:147]
  ds_read_b128 v[220:223], v19 offset:14336
  s_waitcnt lgkmcnt(8)
  v_mfma_f32_16x16x32_bf16 v[148:151], a[72:75], v[188:191], v[148:151]
  v_mfma_f32_16x16x32_bf16 v[152:155], a[76:79], v[188:191], v[152:155]
  v_mfma_f32_16x16x32_bf16 v[156:159], a[80:83], v[188:191], v[156:159]
  s_waitcnt vmcnt(13)
  s_barrier
  s_add_u32 s30, s30, 128
  s_add_u32 s31, s31, 1
  s_cmp_lt_u32 s31, 10
  s_cbranch_scc1 qa_293
  s_mov_b32 s31, 0
  s_add_u32 s30, s30, s25
  s_sub_u32 s30, s30, 1280
  s_mov_b32 s25, 163840
qa_293:
  s_add_u32 s32, s32, 16384
  s_cmp_lt_u32 s32, 98304
  s_cselect_b32 s32, s32, 0
  s_mul_i32 s46, s20, 40960
  s_add_u32 s46, s46, s30
  s_lshl_b32 s47, s20, 12
  s_add_u32 s47, s47, s32
  v_add_u32 v18, s33, v14
  v_add_u32 v19, s33, v15
  s_add_u32 s33, s33, 16384
  s_cmp_lt_u32 s33, 98304
  s_cselect_b32 s33, s33, 0
  ds_read_b128 v[160:163], v18 offset:0
  s_waitcnt lgkmcnt(8)
  v_mfma_f32_16x16x32_bf16 v[64:67], a[84:87], v[192:195], v[64:67]
  v_mfma_f32_16x16x32_bf16 v[68:71], a[88:91], v[192:195], v[68:71]
  v_mfma_f32_16x16x32_bf16 v[72:75], a[92:95], v[192:195], v[72:75]
  ds_read_b128 v[164:167], v18 offset:2048
  s_waitcnt lgkmcnt(8)
  v_mfma_f32_16x16x32_bf16 v[76:79], a[84:87], v[196:199], v[76:79]
  v_mfma_f32_16x16x32_bf16 v[80:83], a[88:91], v[196:199], v[80:83]
  v_mfma_f32_16x16x32_bf16 v[84:87], a[92:95], v[196:199], v[84:87]
  s_add_u32 m0, s47, 0
  s_nop 0
  buffer_load_dwordx4 v10, s[8:11], s46 offen lds
  ds_read_b128 v[168:171], v18 offset:4096
  s_waitcnt lgkmcnt(8)
  v_mfma_f32_16x16x32_bf16 v[88:91], a[84:87], v[200:203], v[88:91]
  v_mfma_f32_16x16x32_bf16 v[92:95], a[88:91], v[200:203], v[92:95]
  v_mfma_f32_16x16x32_bf16 v[96:99], a[92:95], v[200:203], v[96:99]
  ds_read_b128 v[172:175], v18 offset:6144
  s_waitcnt lgkmcnt(8)
  v_mfma_f32_16x16x32_bf16 v[100:103], a[84:87], v[204:207], v[100:103]
  v_mfma_f32_16x16x32_bf16 v[104:107], a[88:91], v[204:207], v[104:107]
  v_mfma_f32_16x16x32_bf16 v[108:111], a[92:95], v[204:207], v[108:111]
  ds_read_b128 v[176:179], v18 offset:8192
  s_waitcnt lgkmcnt(8)
  v_mfma_f32_16x16x32_bf16 v[112:115], a[84:87], v[208:211], v[112:115]
  v_mfma_f32_16x16x32_bf16 v[116:119], a[88:91], v[208:211], v[116:119]
  v_mfma_f32_16x16x32_bf16 v[120:123], a[92:95], v[208:211], v[120:123]
  ds_read_b128 v[180:183], v18 offset:10240
  s_waitcnt lgkmcnt(8)
  v_mfma_f32_16x16x32_bf16 v[124:127], a[84:87], v[212:215], v[124:127]
  v_mfma_f32_16x16x32_bf16 v[128:131], a[88:91], v[212:215], v[128:131]
  v_mfma_f32_16x16x32_bf16 v[132:135], a[92:95], v[212:215], v[132:135]
  s_add_u32 s46, s46, 10240
  s_add_u32 m0, s47, 1024
  s_nop 0
  buffer_load_dwordx4 v10, s[8:11], s46 offen lds
  ds_read_b128 v[184:187], v18 offset:12288
  s_waitcnt lgkmcnt(8)
  v_mfma_f32_16x16x32_bf16 v[136:139], a[84:87], v[216:219], v[136:139]
  v_mfma_f32_16x16x32_bf16 v[140:143], a[88:91], v[216:219], v[140:143]
  v_mfma_f32_16x16x32_bf16 v[144:147], a[92:95], v[216:219], v[144:147]
  ds_read_b128 v[188:191], v18 offset:14336
  s_waitcnt lgkmcnt(8)
  v_mfma_f32_16x16x32_bf16 v[148:151], a[84:87], v[220:223], v[148:151]
  v_mfma_f32_16x16x32_bf16 v[152:155], a[88:91], v[220:223], v[152:155]
  v_mfma_f32_16x16x32_bf16 v[156:159], a[92:95], v[220:223], v[156:159]
  ds_read_b128 v[192:195], v19 offset:0
  s_waitcnt lgkmcnt(8)
  v_mfma_f32_16x16x32_bf16 v[64:67], a[96:99], v[160:163], v[64:67]
  v_mfma_f32_16x16x32_bf16 v[68:71], a[100:103], v[160:163], v[68:71]
  v_mfma_f32_16x16x32_bf16 v[72:75], a[104:107], v[160:163], v[72:75]
  ds_read_b128 v[196:199], v19 offset:2048
  s_waitcnt lgkmcnt(8)
  v_mfma_f32_16x16x32_bf16 v[76:79], a[96:99], v[164:167], v[76:79]
  v_mfma_f32_16x16x32_bf16 v[80:83], a[100:103], v[164:167], v[80:83]
  v_mfma_f32_16x16x32_bf16 v[84:87], a[104:107], v[164:167], v[84:87]
  s_add_u32 s46, s46, 10240
  s_add_u32 m0, s47, 2048
  s_nop 0
  buffer_load_dwordx4 v10, s[8:11], s46 offen lds
  ds_read_b128 v[200:203], v19 offset:4096
  s_waitcnt lgkmcnt(8)
  v_mfma_f32_16x16x32_bf16 v[88:91], a[96:99], v[168:171], v[88:91]
  v_mfma_f32_16x16x32_bf16 v[92:95], a[100:103], v[168:171], v[92:95]
  v_mfma_f32_16x16x32_bf16 v[96:99], a[104:107], v[168:171], v[96:99]
  ds_read_b128 v[204:207], v19 offset:6144
  s_waitcnt lgkmcnt(8)
  v_mfma_f32_16x16x32_bf16 v[100:103], a[96:99], v[172:175], v[100:103]
  v_mfma_f32_16x16x32_bf16 v[104:107], a[100:103], v[172:175], v[104:107]
  v_mfma_f32_16x16x32_bf16 v[108:111], a[104:107], v[172:175], v[108:111]
  ds_read_b128 v[208:211], v19 offset:8192
  s_waitcnt lgkmcnt(8)
  v_mfma_f32_16x16x32_bf16 v[112:115], a[96:99], v[176:179], v[112:115]
  v_mfma_f32_16x16x32_bf16 v[116:119], a[100:103], v[176:179], v[116:119]
  v_mfma_f32_16x16x32_bf16 v[120:123], a[104:107], v[176:179], v[120:123]
  ds_read_b128 v[212:215], v19 offset:10240
  s_waitcnt lgkmcnt(8)
  v_mfma_f32_16x16x32_bf16 v[124:127], a[96:99], v[180:183], v[124:127]
  v_mfma_f32_16x16x32_bf16 v[128:131], a[100:103], v[180:183], v[128:131]
  v_mfma_f32_16x16x32_bf16 v[132:135], a[104:107], v[180:183], v[132:135]
  s_add_u32 s46, s46, 10240
  s_add_u32 m0, s47, 3072
  s_nop 0
  buffer_load_dwordx4 v10, s[8:11], s46 offen lds
  ds_read_b128 v[216:219], v19 offset:12288
  s_waitcnt lgkmcnt(8)
  v_mfma_f32_16x16x32_bf16 v[136:139], a[96:99], v[184:187], v[136:139]
  v_mfma_f32_16x16x32_bf16 v[140:143], a[100:103], v[184:187], v[140:143]
  v_mfma_f32_16x16x32_bf16 v[144:147], a[104:107], v[184:187], v[144:147]
  ds_read_b128 v[220:223], v19 offset:14336
  s_waitcnt lgkmcnt(8)
  v_mfma_f32_16x16x32_bf16 v[148:151], a[96:99], v[188:191], v[148:151]
  v_mfma_f32_16x16x32_bf16 v[152:155], a[100:103], v[188:191], v[152:155]
  v_mfma_f32_16x16x32_bf16 v[156:159], a[104:107], v[188:191], v[156:159]
  s_waitcnt vmcnt(13)
  s_barrier
  s_add_u32 s30, s30, 128
  s_add_u32 s31, s31, 1
  s_cmp_lt_u32 s31, 10
  s_cbranch_scc1 qa_294
  s_mov_b32 s31, 0
  s_add_u32 s30, s30, s25
  s_sub_u32 s30, s30, 1280
  s_mov_b32 s25, 163840
qa_294:
  s_add_u32 s32, s32, 16384
  s_cmp_lt_u32 s32, 98304
  s_cselect_b32 s32, s32, 0
  s_mul_i32 s46, s20, 40960
  s_add_u32 s46, s46, s30
  s_lshl_b32 s47, s20, 12
  s_add_u32 s47, s47, s32
  v_add_u32 v18, s33, v14
  v_add_u32 v19, s33, v15
  s_add_u32 s33, s33, 16384
  s_cmp_lt_u32 s33, 98304
  s_cselect_b32 s33, s33, 0
  ds_read_b128 v[160:163], v18 offset:0
  s_waitcnt lgkmcnt(8)
  v_mfma_f32_16x16x32_bf16 v[64:67], a[108:111], v[192:195], v[64:67]
  v_mfma_f32_16x16x32_bf16 v[68:71], a[112:115], v[192:195], v[68:71]
  v_mfma_f32_16x16x32_bf16 v[72:75], a[116:119], v[192:195], v[72:75]
  ds_read_b128 v[164:167], v18 offset:2048
  s_waitcnt lgkmcnt(8)
  v_mfma_f32_16x16x32_bf16 v[76:79], a[108:111], v[196:199], v[76:79]
  v_mfma_f32_16x16x32_bf16 v[80:83], a[112:115], v[196:199], v[80:83]
  v_mfma_f32_16x16x32_bf16 v[84:87], a[116:119], v[196:199], v[84:87]
  s_add_u32 m0, s47, 0
  s_nop 0
  buffer_load_dwordx4 v10, s[8:11], s46 offen lds
  ds_read_b128 v[168:171], v18 offset:4096
  s_waitcnt lgkmcnt(8)
  v_mfma_f32_16x16x32_bf16 v[88:91], a[108:111], v[200:203], v[88:91]
  v_mfma_f32_16x16x32_bf16 v[92:95], a[112:115], v[200:203], v[92:95]
  v_mfma_f32_16x16x32_bf16 v[96:99], a[116:119], v[200:203], v[96:99]
  ds_read_b128 v[172:175], v18 offset:6144
  s_waitcnt lgkmcnt(8)
  v_mfma_f32_16x16x32_bf16 v[100:103], a[108:111], v[204:207], v[100:103]
  v_mfma_f32_16x16x32_bf16 v[104:107], a[112:115], v[204:207], v[104:107]
  v_mfma_f32_16x16x32_bf16 v[108:111], a[116:119], v[204:207], v[108:111]
  ds_read_b128 v[176:179], v18 offset:8192
  s_waitcnt lgkmcnt(8)
  v_mfma_f32_16x16x32_bf16 v[112:115], a[108:111], v[208:211], v[112:115]
  v_mfma_f32_16x16x32_bf16 v[116:119], a[112:115], v[208:211], v[116:119]
  v_mfma_f32_16x16x32_bf16 v[120:123], a[116:119], v[208:211], v[120:123]
  ds_read_b128 v[180:183], v18 offset:10240
  s_waitcnt lgkmcnt(8)
  v_mfma_f32_16x16x32_bf16 v[124:127], a[108:111], v[212:215], v[124:127]
  v_mfma_f32_16x16x32_bf16 v[128:131], a[112:115], v[212:215], v[128:131]
  v_mfma_f32_16x16x32_bf16 v[132:135], a[116:119], v[212:215], v[132:135]
  s_add_u32 s46, s46, 10240
  s_add_u32 m0, s47, 1024
  s_nop 0
  buffer_load_dwordx4 v10, s[8:11], s46 offen lds
  ds_read_b128 v[184:187], v18 offset:12288
  s_waitcnt lgkmcnt(8)
  v_mfma_f32_16x16x32_bf16 v[136:139], a[108:111], v[216:219], v[136:139]
  v_mfma_f32_16x16x32_bf16 v[140:143], a[112:115], v[216:219], v[140:143]
  v_mfma_f32_16x16x32_bf16 v[144:147], a[116:119], v[216:219], v[144:147]
  ds_read_b128 v[188:191], v18 offset:14336
  s_waitcnt lgkmcnt(8)
  v_mfma_f32_16x16x32_bf16 v[148:151], a[108:111], v[220:223], v[148:151]
  v_mfma_f32_16x16x32_bf16 v[152:155], a[112:115], v[220:223], v[152:155]
  v_mfma_f32_16x16x32_bf16 v[156:159], a[116:119], v[220:223], v[156:159]
  ds_read_b128 v[192:195], v19 offset:0
  s_waitcnt lgkmcnt(8)
  v_mfma_f32_16x16x32_bf16 v[64:67], a[120:123], v[160:163], v[64:67]
  v_mfma_f32_16x16x32_bf16 v[68:71], a[124:127], v[160:163], v[68:71]
  v_mfma_f32_16x16x32_bf16 v[72:75], a[128:131], v[160:163], v[72:75]
  ds_read_b128 v[196:199], v19 offset:2048
  s_waitcnt lgkmcnt(8)
  v_mfma_f32_16x16x32_bf16 v[76:79], a[120:123], v[164:167], v[76:79]
  v_mfma_f32_16x16x32_bf16 v[80:83], a[124:127], v[164:167], v[80:83]
  v_mfma_f32_16x16x32_bf16 v[84:87], a[128:131], v[164:167], v[84:87]
  s_add_u32 s46, s46, 10240
  s_add_u32 m0, s47, 2048
  s_nop 0
  buffer_load_dwordx4 v10, s[8:11], s46 offen lds
  ds_read_b128 v[200:203], v19 offset:4096
  s_waitcnt lgkmcnt(8)
  v_mfma_f32_16x16x32_bf16 v[88:91], a[120:123], v[168:171], v[88:91]
  v_mfma_f32_16x16x32_bf16 v[92:95], a[124:127], v[168:171], v[92:95]
  v_mfma_f32_16x16x32_bf16 v[96:99], a[128:131], v[168:171], v[96:99]
  ds_read_b128 v[204:207], v19 offset:6144
  s_waitcnt lgkmcnt(8)
  v_mfma_f32_16x16x32_bf16 v[100:103], a[120:123], v[172:175], v[100:103]
  v_mfma_f32_16x16x32_bf16 v[104:107], a[124:127], v[172:175], v[104:107]
  v_mfma_f32_16x16x32_bf16 v[108:111], a[128:131], v[172:175], v[108:111]
  ds_read_b128 v[208:211], v19 offset:8192
  s_waitcnt lgkmcnt(8)
  v_mfma_f32_16x16x32_bf16 v[112:115], a[120:123], v[176:179], v[112:115]
  v_mfma_f32_16x16x32_bf16 v[116:119], a[124:127], v[176:179], v[116:119]
  v_mfma_f32_16x16x32_bf16 v[120:123], a[128:131], v[176:179], v[120:123]
  ds_read_b128 v[212:215], v19 offset:10240
  s_waitcnt lgkmcnt(8)
  v_mfma_f32_16x16x32_bf16 v[124:127], a[120:123], v[180:183], v[124:127]
  v_mfma_f32_16x16x32_bf16 v[128:131], a[124:127], v[180:183], v[128:131]
  v_mfma_f32_16x16x32_bf16 v[132:135], a[128:131], v[180:183], v[132:135]
  s_add_u32 s46, s46, 10240
  s_add_u32 m0, s47, 3072
  s_nop 0
  buffer_load_dwordx4 v10, s[8:11], s46 offen lds
  ds_read_b128 v[216:219], v19 offset:12288
  s_waitcnt lgkmcnt(8)
  v_mfma_f32_16x16x32_bf16 v[136:139], a[120:123], v[184:187], v[136:139]
  v_mfma_f32_16x16x32_bf16 v[140:143], a[124:127], v[184:187], v[140:143]
  v_mfma_f32_16x16x32_bf16 v[144:147], a[128:131], v[184:187], v[144:147]
  ds_read_b128 v[220:223], v19 offset:14336
  s_waitcnt lgkmcnt(8)
  v_mfma_f32_16x16x32_bf16 v[148:151], a[120:123], v[188:191], v[148:151]
  v_mfma_f32_16x16x32_bf16 v[152:155], a[124:127], v[188:191], v[152:155]
  v_mfma_f32_16x16x32_bf16 v[156:159], a[128:131], v[188:191], v[156:159]
  s_waitcnt vmcnt(13)
  s_barrier
  s_add_u32 s30, s30, 128
  s_add_u32 s31, s31, 1
  s_cmp_lt_u32 s31, 10
  s_cbranch_scc1 qa_295
  s_mov_b32 s31, 0
  s_add_u32 s30, s30, s25
  s_sub_u32 s30, s30, 1280
  s_mov_b32 s25, 163840
qa_295:
  s_add_u32 s32, s32, 16384
  s_cmp_lt_u32 s32, 98304
  s_cselect_b32 s32, s32, 0
  s_mul_i32 s46, s20, 40960
  s_add_u32 s46, s46, s30
  s_lshl_b32 s47, s20, 12
  s_add_u32 s47, s47, s32
  v_add_u32 v18, s33, v14
  v_add_u32 v19, s33, v15
  s_add_u32 s33, s33, 16384
  s_cmp_lt_u32 s33, 98304
  s_cselect_b32 s33, s33, 0
  ds_read_b128 v[160:163], v18 offset:0
  s_waitcnt lgkmcnt(8)
  v_mfma_f32_16x16x32_bf16 v[64:67], a[132:135], v[192:195], v[64:67]
  v_mfma_f32_16x16x32_bf16 v[68:71], a[136:139], v[192:195], v[68:71]
  v_mfma_f32_16x16x32_bf16 v[72:75], a[140:143], v[192:195], v[72:75]
  ds_read_b128 v[164:167], v18 offset:2048
  s_waitcnt lgkmcnt(8)
  v_mfma_f32_16x16x32_bf16 v[76:79], a[132:135], v[196:199], v[76:79]
  v_mfma_f32_16x16x32_bf16 v[80:83], a[136:139], v[196:199], v[80:83]
  v_mfma_f32_16x16x32_bf16 v[84:87], a[140:143], v[196:199], v[84:87]
  s_add_u32 m0, s47, 0
  s_nop 0
  buffer_load_dwordx4 v10, s[8:11], s46 offen lds
  ds_read_b128 v[168:171], v18 offset:4096
  s_waitcnt lgkmcnt(8)
  v_mfma_f32_16x16x32_bf16 v[88:91], a[132:135], v[200:203], v[88:91]
  v_mfma_f32_16x16x32_bf16 v[92:95], a[136:139], v[200:203], v[92:95]
  v_mfma_f32_16x16x32_bf16 v[96:99], a[140:143], v[200:203], v[96:99]
  ds_read_b128 v[172:175], v18 offset:6144
  s_waitcnt lgkmcnt(8)
  v_mfma_f32_16x16x32_bf16 v[100:103], a[132:135], v[204:207], v[100:103]
  v_mfma_f32_16x16x32_bf16 v[104:107], a[136:139], v[204:207], v[104:107]
  v_mfma_f32_16x16x32_bf16 v[108:111], a[140:143], v[204:207], v[108:111]
  ds_read_b128 v[176:179], v18 offset:8192
  s_waitcnt lgkmcnt(8)
  v_mfma_f32_16x16x32_bf16 v[112:115], a[132:135], v[208:211], v[112:115]
  v_mfma_f32_16x16x32_bf16 v[116:119], a[136:139], v[208:211], v[116:119]
  v_mfma_f32_16x16x32_bf16 v[120:123], a[140:143], v[208:211], v[120:123]
  ds_read_b128 v[180:183], v18 offset:10240
  s_waitcnt lgkmcnt(8)
  v_mfma_f32_16x16x32_bf16 v[124:127], a[132:135], v[212:215], v[124:127]
  v_mfma_f32_16x16x32_bf16 v[128:131], a[136:139], v[212:215], v[128:131]
  v_mfma_f32_16x16x32_bf16 v[132:135], a[140:143], v[212:215], v[132:135]
  s_add_u32 s46, s46, 10240
  s_add_u32 m0, s47, 1024
  s_nop 0
  buffer_load_dwordx4 v10, s[8:11], s46 offen lds
  ds_read_b128 v[184:187], v18 offset:12288
  s_waitcnt lgkmcnt(8)
  v_mfma_f32_16x16x32_bf16 v[136:139], a[132:135], v[216:219], v[136:139]
  v_mfma_f32_16x16x32_bf16 v[140:143], a[136:139], v[216:219], v[140:143]
  v_mfma_f32_16x16x32_bf16 v[144:147], a[140:143], v[216:219], v[144:147]
  ds_read_b128 v[188:191], v18 offset:14336
  s_waitcnt lgkmcnt(8)
  v_mfma_f32_16x16x32_bf16 v[148:151], a[132:135], v[220:223], v[148:151]
  v_mfma_f32_16x16x32_bf16 v[152:155], a[136:139], v[220:223], v[152:155]
  v_mfma_f32_16x16x32_bf16 v[156:159], a[140:143], v[220:223], v[156:159]
  ds_read_b128 v[192:195], v19 offset:0
  s_waitcnt lgkmcnt(8)
  v_mfma_f32_16x16x32_bf16 v[64:67], a[144:147], v[160:163], v[64:67]
  v_mfma_f32_16x16x32_bf16 v[68:71], a[148:151], v[160:163], v[68:71]
  v_mfma_f32_16x16x32_bf16 v[72:75], a[152:155], v[160:163], v[72:75]
  ds_read_b128 v[196:199], v19 offset:2048
  s_waitcnt lgkmcnt(8)
  v_mfma_f32_16x16x32_bf16 v[76:79], a[144:147], v[164:167], v[76:79]
  v_mfma_f32_16x16x32_bf16 v[80:83], a[148:151], v[164:167], v[80:83]
  v_mfma_f32_16x16x32_bf16 v[84:87], a[152:155], v[164:167], v[84:87]
  s_add_u32 s46, s46, 10240
  s_add_u32 m0, s47, 2048
  s_nop 0
  buffer_load_dwordx4 v10, s[8:11], s46 offen lds
  ds_read_b128 v[200:203], v19 offset:4096
  s_waitcnt lgkmcnt(8)
  v_mfma_f32_16x16x32_bf16 v[88:91], a[144:147], v[168:171], v[88:91]
  v_mfma_f32_16x16x32_bf16 v[92:95], a[148:151], v[168:171], v[92:95]
  v_mfma_f32_16x16x32_bf16 v[96:99], a[152:155], v[168:171], v[96:99]
  ds_read_b128 v[204:207], v19 offset:6144
  s_waitcnt lgkmcnt(8)
  v_mfma_f32_16x16x32_bf16 v[100:103], a[144:147], v[172:175], v[100:103]
  v_mfma_f32_16x16x32_bf16 v[104:107], a[148:151], v[172:175], v[104:107]
  v_mfma_f32_16x16x32_bf16 v[108:111], a[152:155], v[172:175], v[108:111]
  ds_read_b128 v[208:211], v19 offset:8192
  s_waitcnt lgkmcnt(8)
  v_mfma_f32_16x16x32_bf16 v[112:115], a[144:147], v[176:179], v[112:115]
  v_mfma_f32_16x16x32_bf16 v[116:119], a[148:151], v[176:179], v[116:119]
  v_mfma_f32_16x16x32_bf16 v[120:123], a[152:155], v[176:179], v[120:123]
  ds_read_b128 v[212:215], v19 offset:10240
  s_waitcnt lgkmcnt(8)
  v_mfma_f32_16x16x32_bf16 v[124:127], a[144:147], v[180:183], v[124:127]
  v_mfma_f32_16x16x32_bf16 v[128:131], a[148:151], v[180:183], v[128:131]
  v_mfma_f32_16x16x32_bf16 v[132:135], a[152:155], v[180:183], v[132:135]
  s_add_u32 s46, s46, 10240
  s_add_u32 m0, s47, 3072
  s_nop 0
  buffer_load_dwordx4 v10, s[8:11], s46 offen lds
  ds_read_b128 v[216:219], v19 offset:12288
  s_waitcnt lgkmcnt(8)
  v_mfma_f32_16x16x32_bf16 v[136:139], a[144:147], v[184:187], v[136:139]
  v_mfma_f32_16x16x32_bf16 v[140:143], a[148:151], v[184:187], v[140:143]
  v_mfma_f32_16x16x32_bf16 v[144:147], a[152:155], v[184:187], v[144:147]
  ds_read_b128 v[220:223], v19 offset:14336
  s_waitcnt lgkmcnt(8)
  v_mfma_f32_16x16x32_bf16 v[148:151], a[144:147], v[188:191], v[148:151]
  v_mfma_f32_16x16x32_bf16 v[152:155], a[148:151], v[188:191], v[152:155]
  v_mfma_f32_16x16x32_bf16 v[156:159], a[152:155], v[188:191], v[156:159]
  s_waitcnt vmcnt(12)
  s_barrier
  v_readfirstlane_b32 s79, v20
  buffer_load_dword v21, v33, s[72:75], s77 offen sc1
  s_add_u32 s21, s50, 0
  buffer_load_dwordx4 v[36:39], v30, s[16:19], s21 offen offset:0 sc1
  buffer_load_dwordx4 v[40:43], v30, s[16:19], s21 offen offset:1024 sc1
  buffer_load_dwordx4 v[44:47], v30, s[16:19], s21 offen offset:2048 sc1
  buffer_load_dwordx4 v[48:51], v30, s[16:19], s21 offen offset:3072 sc1
  s_add_u32 s21, s50, 4096
  buffer_load_dwordx4 v[52:55], v30, s[16:19], s21 offen offset:0 sc1
  buffer_load_dwordx4 v[56:59], v30, s[16:19], s21 offen offset:1024 sc1
  buffer_load_dwordx4 v[60:63], v30, s[16:19], s21 offen offset:2048 sc1
  buffer_load_dwordx4 v[236:239], v30, s[16:19], s21 offen offset:3072 sc1
  s_add_u32 s21, s50, 8192
  buffer_load_dwordx4 v[240:243], v30, s[16:19], s21 offen offset:0 sc1
  buffer_load_dwordx4 v[244:247], v30, s[16:19], s21 offen offset:1024 sc1
  buffer_load_dwordx4 v[248:251], v30, s[16:19], s21 offen offset:2048 sc1
  buffer_load_dwordx4 v[252:255], v30, s[16:19], s21 offen offset:3072 sc1
  s_add_u32 s30, s30, 128
  s_add_u32 s31, s31, 1
  s_cmp_lt_u32 s31, 10
  s_cbranch_scc1 qa_296
  s_mov_b32 s31, 0
  s_add_u32 s30, s30, s25
  s_sub_u32 s30, s30, 1280
  s_mov_b32 s25, 163840
qa_296:
  s_add_u32 s32, s32, 16384
  s_cmp_lt_u32 s32, 98304
  s_cselect_b32 s32, s32, 0
  s_mul_i32 s46, s20, 40960
  s_add_u32 s46, s46, s30
  s_lshl_b32 s47, s20, 12
  s_add_u32 s47, s47, s32
  v_add_u32 v18, s33, v14
  v_add_u32 v19, s33, v15
  s_add_u32 s33, s33, 16384
  s_cmp_lt_u32 s33, 98304
  s_cselect_b32 s33, s33, 0
  ds_read_b128 v[160:163], v18 offset:0
  s_waitcnt lgkmcnt(8)
  v_mfma_f32_16x16x32_bf16 v[64:67], a[156:159], v[192:195], v[64:67]
  v_mfma_f32_16x16x32_bf16 v[68:71], a[160:163], v[192:195], v[68:71]
  v_mfma_f32_16x16x32_bf16 v[72:75], a[164:167], v[192:195], v[72:75]
  ds_read_b128 v[164:167], v18 offset:2048
  s_waitcnt lgkmcnt(8)
  v_mfma_f32_16x16x32_bf16 v[76:79], a[156:159], v[196:199], v[76:79]
  v_mfma_f32_16x16x32_bf16 v[80:83], a[160:163], v[196:199], v[80:83]
  v_mfma_f32_16x16x32_bf16 v[84:87], a[164:167], v[196:199], v[84:87]
  s_add_u32 m0, s47, 0
  s_nop 0
  buffer_load_dwordx4 v10, s[8:11], s46 offen lds
  ds_read_b128 v[168:171], v18 offset:4096
  s_waitcnt lgkmcnt(8)
  v_mfma_f32_16x16x32_bf16 v[88:91], a[156:159], v[200:203], v[88:91]
  v_mfma_f32_16x16x32_bf16 v[92:95], a[160:163], v[200:203], v[92:95]
  v_mfma_f32_16x16x32_bf16 v[96:99], a[164:167], v[200:203], v[96:99]
  ds_read_b128 v[172:175], v18 offset:6144
  s_waitcnt lgkmcnt(8)
  v_mfma_f32_16x16x32_bf16 v[100:103], a[156:159], v[204:207], v[100:103]
  v_mfma_f32_16x16x32_bf16 v[104:107], a[160:163], v[204:207], v[104:107]
  v_mfma_f32_16x16x32_bf16 v[108:111], a[164:167], v[204:207], v[108:111]
  ds_read_b128 v[176:179], v18 offset:8192
  s_waitcnt lgkmcnt(8)
  v_mfma_f32_16x16x32_bf16 v[112:115], a[156:159], v[208:211], v[112:115]
  v_mfma_f32_16x16x32_bf16 v[116:119], a[160:163], v[208:211], v[116:119]
  v_mfma_f32_16x16x32_bf16 v[120:123], a[164:167], v[208:211], v[120:123]
  ds_read_b128 v[180:183], v18 offset:10240
  s_waitcnt lgkmcnt(8)
  v_mfma_f32_16x16x32_bf16 v[124:127], a[156:159], v[212:215], v[124:127]
  v_mfma_f32_16x16x32_bf16 v[128:131], a[160:163], v[212:215], v[128:131]
  v_mfma_f32_16x16x32_bf16 v[132:135], a[164:167], v[212:215], v[132:135]
  s_add_u32 s46, s46, 10240
  s_add_u32 m0, s47, 1024
  s_nop 0
  buffer_load_dwordx4 v10, s[8:11], s46 offen lds
  ds_read_b128 v[184:187], v18 offset:12288
  s_waitcnt lgkmcnt(8)
  v_mfma_f32_16x16x32_bf16 v[136:139], a[156:159], v[216:219], v[136:139]
  v_mfma_f32_16x16x32_bf16 v[140:143], a[160:163], v[216:219], v[140:143]
  v_mfma_f32_16x16x32_bf16 v[144:147], a[164:167], v[216:219], v[144:147]
  ds_read_b128 v[188:191], v18 offset:14336
  s_waitcnt lgkmcnt(8)
  v_mfma_f32_16x16x32_bf16 v[148:151], a[156:159], v[220:223], v[148:151]
  v_mfma_f32_16x16x32_bf16 v[152:155], a[160:163], v[220:223], v[152:155]
  v_mfma_f32_16x16x32_bf16 v[156:159], a[164:167], v[220:223], v[156:159]
  ds_read_b128 v[192:195], v19 offset:0
  s_waitcnt lgkmcnt(8)
  v_mfma_f32_16x16x32_bf16 v[64:67], a[168:171], v[160:163], v[64:67]
  v_mfma_f32_16x16x32_bf16 v[68:71], a[172:175], v[160:163], v[68:71]
  v_mfma_f32_16x16x32_bf16 v[72:75], a[176:179], v[160:163], v[72:75]
  ds_read_b128 v[196:199], v19 offset:2048
  s_waitcnt lgkmcnt(8)
  v_mfma_f32_16x16x32_bf16 v[76:79], a[168:171], v[164:167], v[76:79]
  v_mfma_f32_16x16x32_bf16 v[80:83], a[172:175], v[164:167], v[80:83]
  v_mfma_f32_16x16x32_bf16 v[84:87], a[176:179], v[164:167], v[84:87]
  s_add_u32 s46, s46, 10240
  s_add_u32 m0, s47, 2048
  s_nop 0
  buffer_load_dwordx4 v10, s[8:11], s46 offen lds
  ds_read_b128 v[200:203], v19 offset:4096
  s_waitcnt lgkmcnt(8)
  v_mfma_f32_16x16x32_bf16 v[88:91], a[168:171], v[168:171], v[88:91]
  v_mfma_f32_16x16x32_bf16 v[92:95], a[172:175], v[168:171], v[92:95]
  v_mfma_f32_16x16x32_bf16 v[96:99], a[176:179], v[168:171], v[96:99]
  ds_read_b128 v[204:207], v19 offset:6144
  s_waitcnt lgkmcnt(8)
  v_mfma_f32_16x16x32_bf16 v[100:103], a[168:171], v[172:175], v[100:103]
  v_mfma_f32_16x16x32_bf16 v[104:107], a[172:175], v[172:175], v[104:107]
  v_mfma_f32_16x16x32_bf16 v[108:111], a[176:179], v[172:175], v[108:111]
  ds_read_b128 v[208:211], v19 offset:8192
  s_waitcnt lgkmcnt(8)
  v_mfma_f32_16x16x32_bf16 v[112:115], a[168:171], v[176:179], v[112:115]
  v_mfma_f32_16x16x32_bf16 v[116:119], a[172:175], v[176:179], v[116:119]
  v_mfma_f32_16x16x32_bf16 v[120:123], a[176:179], v[176:179], v[120:123]
  ds_read_b128 v[212:215], v19 offset:10240
  s_waitcnt lgkmcnt(8)
  v_mfma_f32_16x16x32_bf16 v[124:127], a[168:171], v[180:183], v[124:127]
  v_mfma_f32_16x16x32_bf16 v[128:131], a[172:175], v[180:183], v[128:131]
  v_mfma_f32_16x16x32_bf16 v[132:135], a[176:179], v[180:183], v[132:135]
  s_add_u32 s46, s46, 10240
  s_add_u32 m0, s47, 3072
  s_nop 0
  buffer_load_dwordx4 v10, s[8:11], s46 offen lds
  ds_read_b128 v[216:219], v19 offset:12288
  s_waitcnt lgkmcnt(8)
  v_mfma_f32_16x16x32_bf16 v[136:139], a[168:171], v[184:187], v[136:139]
  v_mfma_f32_16x16x32_bf16 v[140:143], a[172:175], v[184:187], v[140:143]
  v_mfma_f32_16x16x32_bf16 v[144:147], a[176:179], v[184:187], v[144:147]
  ds_read_b128 v[220:223], v19 offset:14336
  s_waitcnt lgkmcnt(8)
  v_mfma_f32_16x16x32_bf16 v[148:151], a[168:171], v[188:191], v[148:151]
  v_mfma_f32_16x16x32_bf16 v[152:155], a[172:175], v[188:191], v[152:155]
  v_mfma_f32_16x16x32_bf16 v[156:159], a[176:179], v[188:191], v[156:159]
  s_waitcnt vmcnt(25)
  s_barrier
  s_add_u32 s30, s30, 128
  s_add_u32 s31, s31, 1
  s_cmp_lt_u32 s31, 10
  s_cbranch_scc1 qa_297
  s_mov_b32 s31, 0
  s_add_u32 s30, s30, s25
  s_sub_u32 s30, s30, 1280
  s_mov_b32 s25, 163840
qa_297:
  s_add_u32 s32, s32, 16384
  s_cmp_lt_u32 s32, 98304
  s_cselect_b32 s32, s32, 0
  s_mul_i32 s46, s20, 40960
  s_add_u32 s46, s46, s30
  s_lshl_b32 s47, s20, 12
  s_add_u32 s47, s47, s32
  v_add_u32 v18, s33, v14
  v_add_u32 v19, s33, v15
  s_add_u32 s33, s33, 16384
  s_cmp_lt_u32 s33, 98304
  s_cselect_b32 s33, s33, 0
  ds_read_b128 v[160:163], v18 offset:0
  s_waitcnt lgkmcnt(8)
  v_mfma_f32_16x16x32_bf16 v[64:67], a[180:183], v[192:195], v[64:67]
  v_mfma_f32_16x16x32_bf16 v[68:71], a[184:187], v[192:195], v[68:71]
  v_mfma_f32_16x16x32_bf16 v[72:75], a[188:191], v[192:195], v[72:75]
  ds_read_b128 v[164:167], v18 offset:2048
  s_waitcnt lgkmcnt(8)
  v_mfma_f32_16x16x32_bf16 v[76:79], a[180:183], v[196:199], v[76:79]
  v_mfma_f32_16x16x32_bf16 v[80:83], a[184:187], v[196:199], v[80:83]
  v_mfma_f32_16x16x32_bf16 v[84:87], a[188:191], v[196:199], v[84:87]
  s_add_u32 m0, s47, 0
  s_nop 0
  buffer_load_dwordx4 v10, s[8:11], s46 offen lds
  ds_read_b128 v[168:171], v18 offset:4096
  s_waitcnt lgkmcnt(8)
  v_mfma_f32_16x16x32_bf16 v[88:91], a[180:183], v[200:203], v[88:91]
  v_mfma_f32_16x16x32_bf16 v[92:95], a[184:187], v[200:203], v[92:95]
  v_mfma_f32_16x16x32_bf16 v[96:99], a[188:191], v[200:203], v[96:99]
  ds_read_b128 v[172:175], v18 offset:6144
  s_waitcnt lgkmcnt(8)
  v_mfma_f32_16x16x32_bf16 v[100:103], a[180:183], v[204:207], v[100:103]
  v_mfma_f32_16x16x32_bf16 v[104:107], a[184:187], v[204:207], v[104:107]
  v_mfma_f32_16x16x32_bf16 v[108:111], a[188:191], v[204:207], v[108:111]
  ds_read_b128 v[176:179], v18 offset:8192
  s_waitcnt lgkmcnt(8)
  v_mfma_f32_16x16x32_bf16 v[112:115], a[180:183], v[208:211], v[112:115]
  v_mfma_f32_16x16x32_bf16 v[116:119], a[184:187], v[208:211], v[116:119]
  v_mfma_f32_16x16x32_bf16 v[120:123], a[188:191], v[208:211], v[120:123]
  ds_read_b128 v[180:183], v18 offset:10240
  s_waitcnt lgkmcnt(8)
  v_mfma_f32_16x16x32_bf16 v[124:127], a[180:183], v[212:215], v[124:127]
  v_mfma_f32_16x16x32_bf16 v[128:131], a[184:187], v[212:215], v[128:131]
  v_mfma_f32_16x16x32_bf16 v[132:135], a[188:191], v[212:215], v[132:135]
  s_add_u32 s46, s46, 10240
  s_add_u32 m0, s47, 1024
  s_nop 0
  buffer_load_dwordx4 v10, s[8:11], s46 offen lds
  ds_read_b128 v[184:187], v18 offset:12288
  s_waitcnt lgkmcnt(8)
  v_mfma_f32_16x16x32_bf16 v[136:139], a[180:183], v[216:219], v[136:139]
  v_mfma_f32_16x16x32_bf16 v[140:143], a[184:187], v[216:219], v[140:143]
  v_mfma_f32_16x16x32_bf16 v[144:147], a[188:191], v[216:219], v[144:147]
  ds_read_b128 v[188:191], v18 offset:14336
  s_waitcnt lgkmcnt(8)
  v_mfma_f32_16x16x32_bf16 v[148:151], a[180:183], v[220:223], v[148:151]
  v_mfma_f32_16x16x32_bf16 v[152:155], a[184:187], v[220:223], v[152:155]
  v_mfma_f32_16x16x32_bf16 v[156:159], a[188:191], v[220:223], v[156:159]
  ds_read_b128 v[192:195], v19 offset:0
  s_waitcnt lgkmcnt(8)
  v_mfma_f32_16x16x32_bf16 v[64:67], a[192:195], v[160:163], v[64:67]
  v_mfma_f32_16x16x32_bf16 v[68:71], a[196:199], v[160:163], v[68:71]
  v_mfma_f32_16x16x32_bf16 v[72:75], a[200:203], v[160:163], v[72:75]
  ds_read_b128 v[196:199], v19 offset:2048
  s_waitcnt lgkmcnt(8)
  v_mfma_f32_16x16x32_bf16 v[76:79], a[192:195], v[164:167], v[76:79]
  v_mfma_f32_16x16x32_bf16 v[80:83], a[196:199], v[164:167], v[80:83]
  v_mfma_f32_16x16x32_bf16 v[84:87], a[200:203], v[164:167], v[84:87]
  s_add_u32 s46, s46, 10240
  s_add_u32 m0, s47, 2048
  s_nop 0
  buffer_load_dwordx4 v10, s[8:11], s46 offen lds
  ds_read_b128 v[200:203], v19 offset:4096
  s_waitcnt lgkmcnt(8)
  v_mfma_f32_16x16x32_bf16 v[88:91], a[192:195], v[168:171], v[88:91]
  v_mfma_f32_16x16x32_bf16 v[92:95], a[196:199], v[168:171], v[92:95]
  v_mfma_f32_16x16x32_bf16 v[96:99], a[200:203], v[168:171], v[96:99]
  ds_read_b128 v[204:207], v19 offset:6144
  s_waitcnt lgkmcnt(8)
  v_mfma_f32_16x16x32_bf16 v[100:103], a[192:195], v[172:175], v[100:103]
  v_mfma_f32_16x16x32_bf16 v[104:107], a[196:199], v[172:175], v[104:107]
  v_mfma_f32_16x16x32_bf16 v[108:111], a[200:203], v[172:175], v[108:111]
  ds_read_b128 v[208:211], v19 offset:8192
  s_waitcnt lgkmcnt(8)
  v_mfma_f32_16x16x32_bf16 v[112:115], a[192:195], v[176:179], v[112:115]
  v_mfma_f32_16x16x32_bf16 v[116:119], a[196:199], v[176:179], v[116:119]
  v_mfma_f32_16x16x32_bf16 v[120:123], a[200:203], v[176:179], v[120:123]
  ds_read_b128 v[212:215], v19 offset:10240
  s_waitcnt lgkmcnt(8)
  v_mfma_f32_16x16x32_bf16 v[124:127], a[192:195], v[180:183], v[124:127]
  v_mfma_f32_16x16x32_bf16 v[128:131], a[196:199], v[180:183], v[128:131]
  v_mfma_f32_16x16x32_bf16 v[132:135], a[200:203], v[180:183], v[132:135]
  s_add_u32 s46, s46, 10240
  s_add_u32 m0, s47, 3072
  s_nop 0
  buffer_load_dwordx4 v10, s[8:11], s46 offen lds
  ds_read_b128 v[216:219], v19 offset:12288
  s_waitcnt lgkmcnt(8)
  v_mfma_f32_16x16x32_bf16 v[136:139], a[192:195], v[184:187], v[136:139]
  v_mfma_f32_16x16x32_bf16 v[140:143], a[196:199], v[184:187], v[140:143]
  v_mfma_f32_16x16x32_bf16 v[144:147], a[200:203], v[184:187], v[144:147]
  ds_read_b128 v[220:223], v19 offset:14336
  s_waitcnt lgkmcnt(8)
  v_mfma_f32_16x16x32_bf16 v[148:151], a[192:195], v[188:191], v[148:151]
  v_mfma_f32_16x16x32_bf16 v[152:155], a[196:199], v[188:191], v[152:155]
  v_mfma_f32_16x16x32_bf16 v[156:159], a[200:203], v[188:191], v[156:159]
  s_waitcnt vmcnt(25)
  s_barrier
  s_add_u32 s30, s30, 128
  s_add_u32 s31, s31, 1
  s_cmp_lt_u32 s31, 10
  s_cbranch_scc1 qa_298
  s_mov_b32 s31, 0
  s_add_u32 s30, s30, s25
  s_sub_u32 s30, s30, 1280
  s_mov_b32 s25, 163840
qa_298:
  s_add_u32 s32, s32, 16384
  s_cmp_lt_u32 s32, 98304
  s_cselect_b32 s32, s32, 0
  s_mul_i32 s46, s20, 40960
  s_add_u32 s46, s46, s30
  s_lshl_b32 s47, s20, 12
  s_add_u32 s47, s47, s32
  v_add_u32 v18, s33, v14
  v_add_u32 v19, s33, v15
  s_add_u32 s33, s33, 16384
  s_cmp_lt_u32 s33, 98304
  s_cselect_b32 s33, s33, 0
  ds_read_b128 v[160:163], v18 offset:0
  s_waitcnt lgkmcnt(8)
  v_mfma_f32_16x16x32_bf16 v[64:67], a[204:207], v[192:195], v[64:67]
  v_mfma_f32_16x16x32_bf16 v[68:71], a[208:211], v[192:195], v[68:71]
  v_mfma_f32_16x16x32_bf16 v[72:75], a[212:215], v[192:195], v[72:75]
  ds_read_b128 v[164:167], v18 offset:2048
  s_waitcnt lgkmcnt(8)
  v_mfma_f32_16x16x32_bf16 v[76:79], a[204:207], v[196:199], v[76:79]
  v_mfma_f32_16x16x32_bf16 v[80:83], a[208:211], v[196:199], v[80:83]
  v_mfma_f32_16x16x32_bf16 v[84:87], a[212:215], v[196:199], v[84:87]
  s_add_u32 m0, s47, 0
  s_nop 0
  buffer_load_dwordx4 v10, s[8:11], s46 offen lds
  ds_read_b128 v[168:171], v18 offset:4096
  s_waitcnt lgkmcnt(8)
  v_mfma_f32_16x16x32_bf16 v[88:91], a[204:207], v[200:203], v[88:91]
  v_mfma_f32_16x16x32_bf16 v[92:95], a[208:211], v[200:203], v[92:95]
  v_mfma_f32_16x16x32_bf16 v[96:99], a[212:215], v[200:203], v[96:99]
  ds_read_b128 v[172:175], v18 offset:6144
  s_waitcnt lgkmcnt(8)
  v_mfma_f32_16x16x32_bf16 v[100:103], a[204:207], v[204:207], v[100:103]
  v_mfma_f32_16x16x32_bf16 v[104:107], a[208:211], v[204:207], v[104:107]
  v_mfma_f32_16x16x32_bf16 v[108:111], a[212:215], v[204:207], v[108:111]
  ds_read_b128 v[176:179], v18 offset:8192
  s_waitcnt lgkmcnt(8)
  v_mfma_f32_16x16x32_bf16 v[112:115], a[204:207], v[208:211], v[112:115]
  v_mfma_f32_16x16x32_bf16 v[116:119], a[208:211], v[208:211], v[116:119]
  v_mfma_f32_16x16x32_bf16 v[120:123], a[212:215], v[208:211], v[120:123]
  ds_read_b128 v[180:183], v18 offset:10240
  s_waitcnt lgkmcnt(8)
  v_mfma_f32_16x16x32_bf16 v[124:127], a[204:207], v[212:215], v[124:127]
  v_mfma_f32_16x16x32_bf16 v[128:131], a[208:211], v[212:215], v[128:131]
  v_mfma_f32_16x16x32_bf16 v[132:135], a[212:215], v[212:215], v[132:135]
  s_add_u32 s46, s46, 10240
  s_add_u32 m0, s47, 1024
  s_nop 0
  buffer_load_dwordx4 v10, s[8:11], s46 offen lds
  ds_read_b128 v[184:187], v18 offset:12288
  s_waitcnt lgkmcnt(8)
  v_mfma_f32_16x16x32_bf16 v[136:139], a[204:207], v[216:219], v[136:139]
  v_mfma_f32_16x16x32_bf16 v[140:143], a[208:211], v[216:219], v[140:143]
  v_mfma_f32_16x16x32_bf16 v[144:147], a[212:215], v[216:219], v[144:147]
  ds_read_b128 v[188:191], v18 offset:14336
  s_waitcnt lgkmcnt(8)
  v_mfma_f32_16x16x32_bf16 v[148:151], a[204:207], v[220:223], v[148:151]
  v_mfma_f32_16x16x32_bf16 v[152:155], a[208:211], v[220:223], v[152:155]
  v_mfma_f32_16x16x32_bf16 v[156:159], a[212:215], v[220:223], v[156:159]
  ds_read_b128 v[192:195], v19 offset:0
  s_waitcnt lgkmcnt(8)
  v_mfma_f32_16x16x32_bf16 v[64:67], a[216:219], v[160:163], v[64:67]
  v_mfma_f32_16x16x32_bf16 v[68:71], a[220:223], v[160:163], v[68:71]
  v_mfma_f32_16x16x32_bf16 v[72:75], a[224:227], v[160:163], v[72:75]
  ds_read_b128 v[196:199], v19 offset:2048
  s_waitcnt lgkmcnt(8)
  v_mfma_f32_16x16x32_bf16 v[76:79], a[216:219], v[164:167], v[76:79]
  v_mfma_f32_16x16x32_bf16 v[80:83], a[220:223], v[164:167], v[80:83]
  v_mfma_f32_16x16x32_bf16 v[84:87], a[224:227], v[164:167], v[84:87]
  s_add_u32 s46, s46, 10240
  s_add_u32 m0, s47, 2048
  s_nop 0
  buffer_load_dwordx4 v10, s[8:11], s46 offen lds
  ds_read_b128 v[200:203], v19 offset:4096
  s_waitcnt lgkmcnt(8)
  v_mfma_f32_16x16x32_bf16 v[88:91], a[216:219], v[168:171], v[88:91]
  v_mfma_f32_16x16x32_bf16 v[92:95], a[220:223], v[168:171], v[92:95]
  v_mfma_f32_16x16x32_bf16 v[96:99], a[224:227], v[168:171], v[96:99]
  ds_read_b128 v[204:207], v19 offset:6144
  s_waitcnt lgkmcnt(8)
  v_mfma_f32_16x16x32_bf16 v[100:103], a[216:219], v[172:175], v[100:103]
  v_mfma_f32_16x16x32_bf16 v[104:107], a[220:223], v[172:175], v[104:107]
  v_mfma_f32_16x16x32_bf16 v[108:111], a[224:227], v[172:175], v[108:111]
  ds_read_b128 v[208:211], v19 offset:8192
  s_waitcnt lgkmcnt(8)
  v_mfma_f32_16x16x32_bf16 v[112:115], a[216:219], v[176:179], v[112:115]
  v_mfma_f32_16x16x32_bf16 v[116:119], a[220:223], v[176:179], v[116:119]
  v_mfma_f32_16x16x32_bf16 v[120:123], a[224:227], v[176:179], v[120:123]
  ds_read_b128 v[212:215], v19 offset:10240
  s_waitcnt lgkmcnt(8)
  v_mfma_f32_16x16x32_bf16 v[124:127], a[216:219], v[180:183], v[124:127]
  v_mfma_f32_16x16x32_bf16 v[128:131], a[220:223], v[180:183], v[128:131]
  v_mfma_f32_16x16x32_bf16 v[132:135], a[224:227], v[180:183], v[132:135]
  s_add_u32 s46, s46, 10240
  s_add_u32 m0, s47, 3072
  s_nop 0
  buffer_load_dwordx4 v10, s[8:11], s46 offen lds
  ds_read_b128 v[216:219], v19 offset:12288
  s_waitcnt lgkmcnt(8)
  v_mfma_f32_16x16x32_bf16 v[136:139], a[216:219], v[184:187], v[136:139]
  v_mfma_f32_16x16x32_bf16 v[140:143], a[220:223], v[184:187], v[140:143]
  v_mfma_f32_16x16x32_bf16 v[144:147], a[224:227], v[184:187], v[144:147]
  ds_read_b128 v[220:223], v19 offset:14336
  s_waitcnt lgkmcnt(8)
  v_mfma_f32_16x16x32_bf16 v[148:151], a[216:219], v[188:191], v[148:151]
  v_mfma_f32_16x16x32_bf16 v[152:155], a[220:223], v[188:191], v[152:155]
  v_mfma_f32_16x16x32_bf16 v[156:159], a[224:227], v[188:191], v[156:159]
  s_waitcnt vmcnt(25)
  s_barrier
  s_add_u32 s30, s30, 128
  s_add_u32 s31, s31, 1
  s_cmp_lt_u32 s31, 10
  s_cbranch_scc1 qa_299
  s_mov_b32 s31, 0
  s_add_u32 s30, s30, s25
  s_sub_u32 s30, s30, 1280
  s_mov_b32 s25, 163840
qa_299:
  s_add_u32 s32, s32, 16384
  s_cmp_lt_u32 s32, 98304
  s_cselect_b32 s32, s32, 0
  s_mul_i32 s46, s20, 40960
  s_add_u32 s46, s46, s30
  s_lshl_b32 s47, s20, 12
  s_add_u32 s47, s47, s32
  v_add_u32 v18, s33, v14
  v_add_u32 v19, s33, v15
  s_add_u32 s33, s33, 16384
  s_cmp_lt_u32 s33, 98304
  s_cselect_b32 s33, s33, 0
  ds_read_b128 v[160:163], v18 offset:0
  s_waitcnt lgkmcnt(8)
  v_mfma_f32_16x16x32_bf16 v[64:67], a[228:231], v[192:195], v[64:67]
  v_mfma_f32_16x16x32_bf16 v[68:71], a[232:235], v[192:195], v[68:71]
  v_mfma_f32_16x16x32_bf16 v[72:75], a[236:239], v[192:195], v[72:75]
  ds_read_b128 v[164:167], v18 offset:2048
  s_waitcnt lgkmcnt(8)
  v_mfma_f32_16x16x32_bf16 v[76:79], a[228:231], v[196:199], v[76:79]
  v_mfma_f32_16x16x32_bf16 v[80:83], a[232:235], v[196:199], v[80:83]
  v_mfma_f32_16x16x32_bf16 v[84:87], a[236:239], v[196:199], v[84:87]
  s_add_u32 m0, s47, 0
  s_nop 0
  buffer_load_dwordx4 v10, s[8:11], s46 offen lds
  ds_read_b128 v[168:171], v18 offset:4096
  s_waitcnt lgkmcnt(8)
  v_mfma_f32_16x16x32_bf16 v[88:91], a[228:231], v[200:203], v[88:91]
  v_mfma_f32_16x16x32_bf16 v[92:95], a[232:235], v[200:203], v[92:95]
  v_mfma_f32_16x16x32_bf16 v[96:99], a[236:239], v[200:203], v[96:99]
  ds_read_b128 v[172:175], v18 offset:6144
  s_waitcnt lgkmcnt(8)
  v_mfma_f32_16x16x32_bf16 v[100:103], a[228:231], v[204:207], v[100:103]
  v_mfma_f32_16x16x32_bf16 v[104:107], a[232:235], v[204:207], v[104:107]
  v_mfma_f32_16x16x32_bf16 v[108:111], a[236:239], v[204:207], v[108:111]
  v_cvt_pk_bf16_f32 v224, v64, v65
  v_cvt_pk_bf16_f32 v225, v66, v67
  v_cvt_pk_bf16_f32 v226, v68, v69
  v_cvt_pk_bf16_f32 v227, v70, v71
  v_cvt_pk_bf16_f32 v228, v72, v73
  v_cvt_pk_bf16_f32 v229, v74, v75
  ds_write_b64 v22, v[224:225] offset:0
  ds_write_b64 v22, v[226:227] offset:8
  ds_write_b64 v22, v[228:229] offset:16
  ds_read_b128 v[176:179], v18 offset:8192
  s_waitcnt lgkmcnt(8)
  v_mfma_f32_16x16x32_bf16 v[112:115], a[228:231], v[208:211], v[112:115]
  v_mfma_f32_16x16x32_bf16 v[116:119], a[232:235], v[208:211], v[116:119]
  v_mfma_f32_16x16x32_bf16 v[120:123], a[236:239], v[208:211], v[120:123]
  v_cvt_pk_bf16_f32 v230, v76, v77
  v_cvt_pk_bf16_f32 v231, v78, v79
  v_cvt_pk_bf16_f32 v232, v80, v81
  v_cvt_pk_bf16_f32 v233, v82, v83
  v_cvt_pk_bf16_f32 v234, v84, v85
  v_cvt_pk_bf16_f32 v235, v86, v87
  ds_write_b64 v22, v[230:231] offset:6400
  ds_write_b64 v22, v[232:233] offset:6408
  ds_write_b64 v22, v[234:235] offset:6416
  ds_read_b128 v[180:183], v18 offset:10240
  s_waitcnt lgkmcnt(8)
  v_mfma_f32_16x16x32_bf16 v[124:127], a[228:231], v[212:215], v[124:127]
  v_mfma_f32_16x16x32_bf16 v[128:131], a[232:235], v[212:215], v[128:131]
  v_mfma_f32_16x16x32_bf16 v[132:135], a[236:239], v[212:215], v[132:135]
  s_add_u32 s46, s46, 10240
  s_add_u32 m0, s47, 1024
  s_nop 0
  buffer_load_dwordx4 v10, s[8:11], s46 offen lds
  v_cvt_pk_bf16_f32 v224, v88, v89
  v_cvt_pk_bf16_f32 v225, v90, v91
  v_cvt_pk_bf16_f32 v226, v92, v93
  v_cvt_pk_bf16_f32 v227, v94, v95
  v_cvt_pk_bf16_f32 v228, v96, v97
  v_cvt_pk_bf16_f32 v229, v98, v99
  ds_write_b64 v22, v[224:225] offset:12800
  ds_write_b64 v22, v[226:227] offset:12808
  ds_write_b64 v22, v[228:229] offset:12816
  ds_read_b128 v[184:187], v18 offset:12288
  s_waitcnt lgkmcnt(8)
  v_mfma_f32_16x16x32_bf16 v[136:139], a[228:231], v[216:219], v[136:139]
  v_mfma_f32_16x16x32_bf16 v[140:143], a[232:235], v[216:219], v[140:143]
  v_mfma_f32_16x16x32_bf16 v[144:147], a[236:239], v[216:219], v[144:147]
  v_cvt_pk_bf16_f32 v230, v100, v101
  v_cvt_pk_bf16_f32 v231, v102, v103
  v_cvt_pk_bf16_f32 v232, v104, v105
  v_cvt_pk_bf16_f32 v233, v106, v107
  v_cvt_pk_bf16_f32 v234, v108, v109
  v_cvt_pk_bf16_f32 v235, v110, v111
  ds_write_b64 v22, v[230:231] offset:19200
  ds_write_b64 v22, v[232:233] offset:19208
  ds_write_b64 v22, v[234:235] offset:19216
  ds_read_b128 v[188:191], v18 offset:14336
  s_waitcnt lgkmcnt(8)
  v_mfma_f32_16x16x32_bf16 v[148:151], a[228:231], v[220:223], v[148:151]
  v_mfma_f32_16x16x32_bf16 v[152:155], a[232:235], v[220:223], v[152:155]
  v_mfma_f32_16x16x32_bf16 v[156:159], a[236:239], v[220:223], v[156:159]
  v_cvt_pk_bf16_f32 v224, v112, v113
  v_cvt_pk_bf16_f32 v225, v114, v115
  v_cvt_pk_bf16_f32 v226, v116, v117
  v_cvt_pk_bf16_f32 v227, v118, v119
  v_cvt_pk_bf16_f32 v228, v120, v121
  v_cvt_pk_bf16_f32 v229, v122, v123
  ds_write_b64 v22, v[224:225] offset:25600
  ds_write_b64 v22, v[226:227] offset:25608
  ds_write_b64 v22, v[228:229] offset:25616
  v_cvt_pk_bf16_f32 v230, v124, v125
  v_cvt_pk_bf16_f32 v231, v126, v127
  v_cvt_pk_bf16_f32 v232, v128, v129
  v_cvt_pk_bf16_f32 v233, v130, v131
  v_cvt_pk_bf16_f32 v234, v132, v133
  v_cvt_pk_bf16_f32 v235, v134, v135
  ds_write_b64 v22, v[230:231] offset:32000
  ds_write_b64 v22, v[232:233] offset:32008
  ds_write_b64 v22, v[234:235] offset:32016
  v_cvt_pk_bf16_f32 v224, v136, v137
  v_cvt_pk_bf16_f32 v225, v138, v139
  v_cvt_pk_bf16_f32 v226, v140, v141
  v_cvt_pk_bf16_f32 v227, v142, v143
  v_cvt_pk_bf16_f32 v228, v144, v145
  v_cvt_pk_bf16_f32 v229, v146, v147
  ds_write_b64 v22, v[224:225] offset:38400
  ds_write_b64 v22, v[226:227] offset:38408
  ds_write_b64 v22, v[228:229] offset:38416
  v_cvt_pk_bf16_f32 v230, v148, v149
  v_cvt_pk_bf16_f32 v231, v150, v151
  v_cvt_pk_bf16_f32 v232, v152, v153
  v_cvt_pk_bf16_f32 v233, v154, v155
  v_cvt_pk_bf16_f32 v234, v156, v157
  v_cvt_pk_bf16_f32 v235, v158, v159
  ds_write_b64 v22, v[230:231] offset:44800
  ds_write_b64 v22, v[232:233] offset:44808
  ds_write_b64 v22, v[234:235] offset:44816
  s_lshl_b32 s43, s42, 2
  s_add_u32 s43, s43, s20
  s_mul_i32 s43, s43, 12288
  s_add_u32 s43, s43, 5242880
  s_cmp_lg_u32 s26, 16
  s_cbranch_scc1 qbs_301
  s_waitcnt lgkmcnt(0)
  s_barrier
  ds_read_b128 v[64:67], v29 offset:0
  ds_read_b128 v[68:71], v29 offset:64
  ds_read_b128 v[72:75], v29 offset:128
  ds_read_b128 v[76:79], v29 offset:192
  ds_read_b128 v[80:83], v29 offset:256
  ds_read_b128 v[84:87], v29 offset:320
  ds_read_b128 v[88:91], v29 offset:6400
  ds_read_b128 v[92:95], v29 offset:6464
  ds_read_b128 v[96:99], v29 offset:6528
  ds_read_b128 v[100:103], v29 offset:6592
  ds_read_b128 v[104:107], v29 offset:6656
  ds_read_b128 v[108:111], v29 offset:6720
  s_waitcnt lgkmcnt(0)
  s_add_u32 s21, s43, 0
  buffer_store_dwordx4 v[64:67], v30, s[56:59], s21 offen offset:0 sc1
  buffer_store_dwordx4 v[68:71], v30, s[56:59], s21 offen offset:1024 sc1
  buffer_store_dwordx4 v[72:75], v30, s[56:59], s21 offen offset:2048 sc1
  buffer_store_dwordx4 v[76:79], v30, s[56:59], s21 offen offset:3072 sc1
  s_add_u32 s21, s43, 4096
  buffer_store_dwordx4 v[80:83], v30, s[56:59], s21 offen offset:0 sc1
  buffer_store_dwordx4 v[84:87], v30, s[56:59], s21 offen offset:1024 sc1
  buffer_store_dwordx4 v[88:91], v30, s[56:59], s21 offen offset:2048 sc1
  buffer_store_dwordx4 v[92:95], v30, s[56:59], s21 offen offset:3072 sc1
  s_add_u32 s21, s43, 8192
  buffer_store_dwordx4 v[96:99], v30, s[56:59], s21 offen offset:0 sc1
  buffer_store_dwordx4 v[100:103], v30, s[56:59], s21 offen offset:1024 sc1
  buffer_store_dwordx4 v[104:107], v30, s[56:59], s21 offen offset:2048 sc1
  buffer_store_dwordx4 v[108:111], v30, s[56:59], s21 offen offset:3072 sc1
  s_waitcnt vmcnt(0)
  s_barrier
  s_lshl_b32 s21, s42, 7
  s_add_u32 s21, s21, 111616
  s_cmp_lg_u32 s20, 0
  s_cbranch_scc1 af_302
  v_mov_b32 v4, 0
  v_mov_b32 v5, 1
  s_mov_b64 exec, 1
  buffer_atomic_add v5, v4, s[72:75], s21 offen sc1
  s_mov_b64 exec, -1
  s_nop 1
af_302:
  s_branch qbe_300
qbs_301:
  s_add_u32 s23, s49, 1
  s_waitcnt vmcnt(12)
  v_cmp_gt_u32 vcc, s23, v21
  s_mov_b32 s80, 0
  s_nop 0
  s_cbranch_vccnz qk_304
  s_mov_b32 s80, 1
  buffer_load_dwordx4 v[132:135], v31, s[52:55], s51 offen offset:0 sc1
  buffer_load_dwordx4 v[136:139], v31, s[52:55], s51 offen offset:512 sc1
  buffer_load_dwordx4 v[140:143], v31, s[52:55], s51 offen offset:1024 sc1
  buffer_load_dwordx4 v[144:147], v31, s[52:55], s51 offen offset:1536 sc1
  buffer_load_dwordx4 v[148:151], v31, s[52:55], s51 offen offset:2048 sc1
  buffer_load_dwordx4 v[152:155], v31, s[52:55], s51 offen offset:2560 sc1
qk_304:
  s_cmp_ge_u32 s79, 8
  s_cbranch_scc1 qk_303
  v_mov_b32 v156, 0
  s_mov_b32 s101, 0
wf_305:
  buffer_load_dword v157, v156, s[72:75], s76 offen sc1
  s_add_u32 s101, s101, 1
  s_cmp_gt_u32 s101, 131072
  s_cbranch_scc1 main_end
  s_waitcnt vmcnt(0)
  v_readfirstlane_b32 s100, v157
  s_cmp_ge_u32 s100, 8
  s_cbranch_scc1 wf_306
  s_sleep 2
  s_branch wf_305
wf_306:
  s_add_u32 s21, s50, 0
  buffer_load_dwordx4 v[36:39], v30, s[16:19], s21 offen offset:0 sc1
  buffer_load_dwordx4 v[40:43], v30, s[16:19], s21 offen offset:1024 sc1
  buffer_load_dwordx4 v[44:47], v30, s[16:19], s21 offen offset:2048 sc1
  buffer_load_dwordx4 v[48:51], v30, s[16:19], s21 offen offset:3072 sc1
  s_add_u32 s21, s50, 4096
  buffer_load_dwordx4 v[52:55], v30, s[16:19], s21 offen offset:0 sc1
  buffer_load_dwordx4 v[56:59], v30, s[16:19], s21 offen offset:1024 sc1
  buffer_load_dwordx4 v[60:63], v30, s[16:19], s21 offen offset:2048 sc1
  buffer_load_dwordx4 v[236:239], v30, s[16:19], s21 offen offset:3072 sc1
  s_add_u32 s21, s50, 8192
  buffer_load_dwordx4 v[240:243], v30, s[16:19], s21 offen offset:0 sc1
  buffer_load_dwordx4 v[244:247], v30, s[16:19], s21 offen offset:1024 sc1
  buffer_load_dwordx4 v[248:251], v30, s[16:19], s21 offen offset:2048 sc1
  buffer_load_dwordx4 v[252:255], v30, s[16:19], s21 offen offset:3072 sc1
qk_303:
  s_waitcnt lgkmcnt(0)
  s_barrier
  ds_read_b128 v[64:67], v29 offset:0
  ds_read_b128 v[68:71], v29 offset:64
  ds_read_b128 v[72:75], v29 offset:128
  ds_read_b128 v[76:79], v29 offset:192
  ds_read_b128 v[80:83], v29 offset:256
  ds_read_b128 v[84:87], v29 offset:320
  ds_read_b128 v[88:91], v29 offset:6400
  ds_read_b128 v[92:95], v29 offset:6464
  ds_read_b128 v[96:99], v29 offset:6528
  ds_read_b128 v[100:103], v29 offset:6592
  ds_read_b128 v[104:107], v29 offset:6656
  ds_read_b128 v[108:111], v29 offset:6720
  s_waitcnt lgkmcnt(0) vmcnt(6)
  s_cmp_eq_u32 s80, 1
  s_cselect_b32 s21, s79, 0
  s_cmp_ge_u32 s21, 8
  s_cbranch_scc1 qw_307
  s_waitcnt vmcnt(0)
qw_307:
  v_mfma_f32_16x16x32_bf16 v[112:115], v[36:39], v[64:67], 0
  v_mfma_f32_16x16x32_bf16 v[120:123], v[36:39], v[88:91], 0
  v_mfma_f32_16x16x32_bf16 v[124:127], v[60:63], v[88:91], 0
  v_mfma_f32_16x16x32_bf16 v[112:115], v[40:43], v[68:71], v[112:115]
  v_mfma_f32_16x16x32_bf16 v[120:123], v[40:43], v[92:95], v[120:123]
  v_mfma_f32_16x16x32_bf16 v[124:127], v[236:239], v[92:95], v[124:127]
  v_mfma_f32_16x16x32_bf16 v[112:115], v[44:47], v[72:75], v[112:115]
  v_mfma_f32_16x16x32_bf16 v[120:123], v[44:47], v[96:99], v[120:123]
  v_mfma_f32_16x16x32_bf16 v[124:127], v[240:243], v[96:99], v[124:127]
  v_mfma_f32_16x16x32_bf16 v[112:115], v[48:51], v[76:79], v[112:115]
  v_mfma_f32_16x16x32_bf16 v[120:123], v[48:51], v[100:103], v[120:123]
  v_mfma_f32_16x16x32_bf16 v[124:127], v[244:247], v[100:103], v[124:127]
  v_mfma_f32_16x16x32_bf16 v[112:115], v[52:55], v[80:83], v[112:115]
  v_mfma_f32_16x16x32_bf16 v[120:123], v[52:55], v[104:107], v[120:123]
  v_mfma_f32_16x16x32_bf16 v[124:127], v[248:251], v[104:107], v[124:127]
  v_mfma_f32_16x16x32_bf16 v[112:115], v[56:59], v[84:87], v[112:115]
  v_mfma_f32_16x16x32_bf16 v[120:123], v[56:59], v[108:111], v[120:123]
  v_mfma_f32_16x16x32_bf16 v[124:127], v[252:255], v[108:111], v[124:127]
  s_cmp_eq_u32 s80, 1
  s_cbranch_scc1 qm_308
  s_add_u32 s23, s49, 1
  s_mov_b32 s101, 0
wm_309:
  buffer_load_dword v156, v33, s[72:75], s77 offen sc1
  s_add_u32 s101, s101, 1
  s_cmp_gt_u32 s101, 131072
  s_cbranch_scc1 main_end
  s_waitcnt vmcnt(0)
  v_cmp_gt_u32 vcc, s23, v156
  v_readfirstlane_b32 s100, v156
  s_nop 0
  s_cbranch_vccz wm_310
  s_sleep 4
  s_add_u32 s100, s100, 2
  s_cmp_ge_u32 s100, s23
  s_cbranch_scc1 wm_309
  s_sleep 90
  s_branch wm_309
wm_310:
  buffer_load_dwordx4 v[132:135], v31, s[52:55], s51 offen offset:0 sc1
  buffer_load_dwordx4 v[136:139], v31, s[52:55], s51 offen offset:512 sc1
  buffer_load_dwordx4 v[140:143], v31, s[52:55], s51 offen offset:1024 sc1
  buffer_load_dwordx4 v[144:147], v31, s[52:55], s51 offen offset:1536 sc1
  buffer_load_dwordx4 v[148:151], v31, s[52:55], s51 offen offset:2048 sc1
  buffer_load_dwordx4 v[152:155], v31, s[52:55], s51 offen offset:2560 sc1
qm_308:
  s_waitcnt vmcnt(0)
  v_mfma_f32_16x16x32_bf16 v[116:119], v[132:135], v[64:67], 0
  v_mfma_f32_16x16x32_bf16 v[128:131], v[132:135], v[88:91], 0
  v_mfma_f32_16x16x32_bf16 v[116:119], v[136:139], v[68:71], v[116:119]
  v_mfma_f32_16x16x32_bf16 v[128:131], v[136:139], v[92:95], v[128:131]
  v_mfma_f32_16x16x32_bf16 v[116:119], v[140:143], v[72:75], v[116:119]
  v_mfma_f32_16x16x32_bf16 v[128:131], v[140:143], v[96:99], v[128:131]
  v_mfma_f32_16x16x32_bf16 v[116:119], v[144:147], v[76:79], v[116:119]
  v_mfma_f32_16x16x32_bf16 v[128:131], v[144:147], v[100:103], v[128:131]
  v_mfma_f32_16x16x32_bf16 v[116:119], v[148:151], v[80:83], v[116:119]
  v_mfma_f32_16x16x32_bf16 v[128:131], v[148:151], v[104:107], v[128:131]
  v_mfma_f32_16x16x32_bf16 v[116:119], v[152:155], v[84:87], v[116:119]
  v_mfma_f32_16x16x32_bf16 v[128:131], v[152:155], v[108:111], v[128:131]
  s_lshl_b32 s21, s49, 5
  s_add_u32 s21, s21, s42
  s_mul_i32 s81, s21, 2560
  s_lshl_b32 s82, s49, 3
  s_and_b32 s21, s42, 7
  s_add_u32 s82, s82, s21
  s_lshl_b32 s82, s82, 7
  s_add_u32 s82, s82, 22528
  v_cndmask_b32 v112, v34, v112, s[64:65]
  v_cndmask_b32 v124, v34, v124, s[64:65]
  v_cndmask_b32 v113, v34, v113, s[66:67]
  v_cndmask_b32 v125, v34, v125, s[66:67]
  v_cndmask_b32 v114, v34, v114, s[68:69]
  v_cndmask_b32 v126, v34, v126, s[68:69]
  v_cndmask_b32 v115, v34, v115, s[70:71]
  v_cndmask_b32 v127, v34, v127, s[70:71]
  v_max3_f32 v156, v112, v113, v114
  v_max3_f32 v156, v156, v115, v116
  v_max3_f32 v156, v156, v117, v118
  v_max_f32 v156, v156, v119
  v_mov_b32 v157, v156
  s_nop 1
  v_permlane32_swap_b32 v156, v157
  v_max_f32 v156, v156, v157
  v_mov_b32 v157, v156
  s_nop 1
  v_permlane16_swap_b32 v156, v157
  v_max_f32 v156, v156, v157
  v_mul_f32 v156, s83, v156
  v_fma_f32 v112, v112, s83, -v156
  v_fma_f32 v113, v113, s83, -v156
  v_fma_f32 v114, v114, s83, -v156
  v_fma_f32 v115, v115, s83, -v156
  v_fma_f32 v116, v116, s83, -v156
  v_fma_f32 v117, v117, s83, -v156
  v_fma_f32 v118, v118, s83, -v156
  v_fma_f32 v119, v119, s83, -v156
  v_exp_f32 v112, v112
  v_exp_f32 v113, v113
  v_exp_f32 v114, v114
  v_exp_f32 v115, v115
  v_exp_f32 v116, v116
  v_exp_f32 v117, v117
  v_exp_f32 v118, v118
  v_exp_f32 v119, v119
  s_nop 0
  v_add_f32 v156, v116, v117
  v_add_f32 v156, v156, v118
  v_add_f32 v156, v156, v119
  v_cndmask_b32 v156, 0, v156, s[60:61]
  v_add_f32 v156, v156, v112
  v_add_f32 v156, v156, v113
  v_add_f32 v156, v156, v114
  v_add_f32 v156, v156, v115
  v_mov_b32 v157, v156
  s_nop 1
  v_permlane32_swap_b32 v156, v157
  v_add_f32 v156, v156, v157
  v_mov_b32 v157, v156
  s_nop 1
  v_permlane16_swap_b32 v156, v157
  v_add_f32 v156, v156, v157
  v_rcp_f32 v156, v156
  s_nop 0
  v_mul_f32 v112, v112, v156
  v_mul_f32 v113, v113, v156
  v_mul_f32 v114, v114, v156
  v_mul_f32 v115, v115, v156
  v_mul_f32 v116, v116, v156
  v_mul_f32 v117, v117, v156
  v_mul_f32 v118, v118, v156
  v_mul_f32 v119, v119, v156
  v_max3_f32 v156, v120, v121, v122
  v_max3_f32 v156, v156, v123, v124
  v_max3_f32 v156, v156, v125, v126
  v_max3_f32 v156, v156, v127, v128
  v_max3_f32 v156, v156, v129, v130
  v_max_f32 v156, v156, v131
  v_mov_b32 v157, v156
  s_nop 1
  v_permlane32_swap_b32 v156, v157
  v_max_f32 v156, v156, v157
  v_mov_b32 v157, v156
  s_nop 1
  v_permlane16_swap_b32 v156, v157
  v_max_f32 v156, v156, v157
  v_mul_f32 v156, s83, v156
  v_fma_f32 v120, v120, s83, -v156
  v_fma_f32 v121, v121, s83, -v156
  v_fma_f32 v122, v122, s83, -v156
  v_fma_f32 v123, v123, s83, -v156
  v_fma_f32 v124, v124, s83, -v156
  v_fma_f32 v125, v125, s83, -v156
  v_fma_f32 v126, v126, s83, -v156
  v_fma_f32 v127, v127, s83, -v156
  v_fma_f32 v128, v128, s83, -v156
  v_fma_f32 v129, v129, s83, -v156
  v_fma_f32 v130, v130, s83, -v156
  v_fma_f32 v131, v131, s83, -v156
  v_exp_f32 v120, v120
  v_exp_f32 v121, v121
  v_exp_f32 v122, v122
  v_exp_f32 v123, v123
  v_exp_f32 v124, v124
  v_exp_f32 v125, v125
  v_exp_f32 v126, v126
  v_exp_f32 v127, v127
  v_exp_f32 v128, v128
  v_exp_f32 v129, v129
  v_exp_f32 v130, v130
  v_exp_f32 v131, v131
  s_nop 0
  v_add_f32 v156, v128, v129
  v_add_f32 v156, v156, v130
  v_add_f32 v156, v156, v131
  v_cndmask_b32 v156, 0, v156, s[60:61]
  v_add_f32 v156, v156, v120
  v_add_f32 v156, v156, v121
  v_add_f32 v156, v156, v122
  v_add_f32 v156, v156, v123
  v_add_f32 v156, v156, v124
  v_add_f32 v156, v156, v125
  v_add_f32 v156, v156, v126
  v_add_f32 v156, v156, v127
  v_mov_b32 v157, v156
  s_nop 1
  v_permlane32_swap_b32 v156, v157
  v_add_f32 v156, v156, v157
  v_mov_b32 v157, v156
  s_nop 1
  v_permlane16_swap_b32 v156, v157
  v_add_f32 v156, v156, v157
  v_rcp_f32 v156, v156
  s_nop 0
  v_mul_f32 v120, v120, v156
  v_mul_f32 v121, v121, v156
  v_mul_f32 v122, v122, v156
  v_mul_f32 v123, v123, v156
  v_mul_f32 v124, v124, v156
  v_mul_f32 v125, v125, v156
  v_mul_f32 v126, v126, v156
  v_mul_f32 v127, v127, v156
  v_mul_f32 v128, v128, v156
  v_mul_f32 v129, v129, v156
  v_mul_f32 v130, v130, v156
  v_mul_f32 v131, v131, v156
  v_cvt_pk_bf16_f32 v192, v120, v121
  v_cvt_pk_bf16_f32 v193, v122, v123
  v_cvt_pk_bf16_f32 v194, v124, v125
  v_cvt_pk_bf16_f32 v195, v126, v127
  v_cvt_pk_bf16_f32 v196, v116, v117
  v_cvt_pk_bf16_f32 v197, v118, v119
  v_cvt_pk_bf16_f32 v198, v128, v129
  v_cvt_pk_bf16_f32 v199, v130, v131
  v_cvt_pk_bf16_f32 v200, v112, v113
  v_cvt_pk_bf16_f32 v201, v114, v115
  buffer_store_dwordx4 v[192:195], v30, s[56:59], s81 offen sc1
  buffer_store_dwordx4 v[196:199], v30, s[56:59], s81 offen offset:1024 sc1
  buffer_store_dwordx2 v[200:201], v32, s[56:59], s81 offen offset:2048 sc1
  s_mov_b32 s78, s82
  s_mov_b32 s81, 0x80000000
  s_mov_b32 s82, 0
  s_cmp_eq_u32 s80, 1
  s_cbranch_scc1 qd_311
  s_waitcnt vmcnt(0)
  s_cmp_eq_u32 s78, 0
  s_cbranch_scc1 pf_312
  v_mov_b32 v4, 0
  v_mov_b32 v5, 1
  s_mov_b64 exec, 1
  buffer_atomic_add v5, v4, s[72:75], s78 offen sc1
  s_mov_b64 exec, -1
  s_mov_b32 s78, 0
pf_312:
qd_311:
  s_add_u32 s49, s49, s29
qbe_300:
  s_sub_u32 s26, s26, 1
  s_cmp_gt_u32 s26, 0
  s_cbranch_scc1 qa_blk_288
  s_waitcnt vmcnt(0) lgkmcnt(0)
  s_lshl_b32 s21, s42, 7
  s_add_u32 s21, s21, 18432
  v_mov_b32 v25, 0
  buffer_load_dword v27, v25, s[72:75], s21 offen sc1
  s_waitcnt vmcnt(0)
  s_cmp_eq_u32 s78, 0
  s_cbranch_scc1 pf_313
  v_mov_b32 v4, 0
  v_mov_b32 v5, 1
  s_mov_b64 exec, 1
  buffer_atomic_add v5, v4, s[72:75], s78 offen sc1
  s_mov_b64 exec, -1
  s_mov_b32 s78, 0
pf_313:
  s_add_u32 s84, s42, 1
  v_mov_b32 v26, 32768
  s_waitcnt lgkmcnt(0)
  s_barrier
  s_cmp_lg_u32 s20, 0
  s_cbranch_scc1 a0_314
  ds_write_b32 v26, v27
a0_314:
  s_waitcnt lgkmcnt(0)
  s_barrier
  ds_read_b32 v27, v26
  s_waitcnt lgkmcnt(0)
  v_readfirstlane_b32 s64, v27
  s_barrier
  s_cmp_ge_u32 s64, 59
  s_cbranch_scc1 own_afin
queue:
  s_load_dwordx2 s[4:5], s[0:1], 96
  s_waitcnt lgkmcnt(0)
  s_mov_b32 s32, s4
  s_mov_b32 s33, s5
  s_mov_b32 s34, 256
  s_mov_b32 s35, 0x00020000
  s_waitcnt vmcnt(0) lgkmcnt(0)
  s_barrier
  s_mov_b32 s2, s85
  s_mov_b32 s85, -1
  s_cmp_lg_u32 s2, -1
  s_cbranch_scc1 queue_c
  v_mov_b32 v21, 0
  s_cmp_lg_u32 s20, 0
  s_cbranch_scc1 q_315
  v_mov_b32 v22, 80
  v_mov_b32 v23, 1
  s_mov_b64 exec, 1
  buffer_atomic_add v23, v22, s[32:35], 0 offen sc0 sc1
  s_waitcnt vmcnt(0)
queue_a:
  ds_write_b32 v21, v23
  s_waitcnt lgkmcnt(0)
  s_mov_b64 exec, -1
q_315:
queue_b:
  s_barrier
  ds_read_b32 v23, v21
  s_waitcnt lgkmcnt(0)
  v_readfirstlane_b32 s2, v23
  s_barrier
queue_c:
  s_cmp_eq_u32 s84, 0
  s_cbranch_scc1 od_316
  s_cmp_lt_u32 s2, 738
  s_cbranch_scc1 od_316
  s_mov_b32 s85, s2
  s_branch own_afin
od_316:
  s_add_u32 s21, s2, 0
  s_cmp_lt_u32 s2, 10
  s_cbranch_scc1 do_qbl
  s_sub_u32 s2, s2, 10
  s_add_u32 s21, s2, 0
  s_cmp_lt_u32 s2, 54
  s_cbranch_scc1 do_bat
  s_sub_u32 s2, s2, 54
  s_add_u32 s21, s2, 0
  s_cmp_lt_u32 s2, 56
  s_cbranch_scc1 do_opb
  s_sub_u32 s2, s2, 56
  s_add_u32 s21, s2, 54
  s_cmp_lt_u32 s2, 10
  s_cbranch_scc1 do_bat
  s_sub_u32 s2, s2, 10
  s_add_u32 s21, s2, 0
  s_cmp_lt_u32 s2, 60
  s_cbranch_scc1 do_pv
  s_sub_u32 s2, s2, 60
  s_add_u32 s21, s2, 56
  s_cmp_lt_u32 s2, 8
  s_cbranch_scc1 do_opb
  s_sub_u32 s2, s2, 8
  s_add_u32 s21, s2, 60
  s_cmp_lt_u32 s2, 480
  s_cbranch_scc1 do_pv
  s_sub_u32 s2, s2, 480
  s_add_u32 s21, s2, 540
  s_cmp_lt_u32 s2, 100
  s_cbranch_scc1 do_pv
  s_sub_u32 s2, s2, 100
  s_branch main_fin
do_qbl:
  s_mul_hi_u32 s42, s21, 0x1999999a
  s_mul_i32 s22, s42, 10
  s_sub_u32 s41, s21, s22
  s_add_u32 s42, s42, 15
  s_mov_b32 s26, 1
  s_mov_b32 s63, 1
  s_mov_b32 s64, 1
  s_branch qkvb_entry
do_opb:
  s_mov_b32 s2, s21
  s_lshr_b32 s40, s2, 2
  s_and_b32 s42, s2, 3
  s_mov_b32 s43, 4
  s_load_dwordx2 s[4:5], s[0:1], 40
  s_load_dwordx2 s[6:7], s[0:1], 72
  s_load_dwordx2 s[38:39], s[0:1], 104
  s_waitcnt lgkmcnt(0)
  s_cmp_eq_u32 s43, 4
  s_cselect_b32 s4, s6, s4
  s_cselect_b32 s5, s7, s5
  s_mov_b32 s10, 7864320
  s_cselect_b32 s10, 819200, s10
  s_cselect_b32 s44, 10, 24
  s_mov_b32 s45, 196608
  s_cselect_b32 s45, 20480, s45
  s_mov_b32 s46, 93323264
  s_cselect_b32 s46, 70778880, s46
  s_cselect_b32 s47, 1, 0
  s_mov_b32 s8, s4
  s_mov_b32 s9, s5
  s_mov_b32 s11, 0x00020000
  s_mov_b32 s12, s38
  s_mov_b32 s13, s39
  s_mov_b32 s14, 73400320
  s_mov_b32 s15, 0x00020000
  s_add_u32 s16, s38, 73400320
  s_addc_u32 s17, s39, 0
  s_mov_b32 s18, 5242880
  s_mov_b32 s19, 0x00020000
  s_lshl_b32 s21, s40, 3
  s_lshl_b32 s22, s20, 1
  s_add_u32 s21, s21, s22
  s_mul_i32 s21, s21, s45
  s_add_u32 s48, s46, s21
  s_and_b32 s22, s43, 3
  s_mul_i32 s22, s22, 49152
  s_cmp_eq_u32 s47, 1
  s_cselect_b32 s22, 0, s22
  s_add_u32 s48, s48, s22
  v_lshlrev_b32 v4, 4, v1
  s_and_b32 s22, s43, 3
  s_mul_i32 s49, s22, 1966080
  s_cmp_eq_u32 s47, 1
  s_cselect_b32 s49, 0, s49
  s_mul_i32 s22, s42, 320
  s_add_u32 s49, s49, s22
  v_mov_b32 v29, 3277
  s_mul_i32 s21, s20, 320
  s_add_u32 s21, s21, 0
  v_add_u32 v21, s21, v1
  v_mul_u32_u24 v22, v21, v29
  v_lshrrev_b32 v22, 16, v22
  v_mul_u32_u24 v23, 20, v22
  v_sub_u32 v21, v21, v23
  v_add_u32 v22, 0, v22
  v_mov_b32 v25, v22
  s_cmp_eq_u32 s47, 1
  s_cbranch_scc1 id_317
  v_and_b32 v23, 0xe3, v22
  v_bfe_u32 v24, v22, 2, 1
  v_lshl_add_u32 v23, v24, 4, v23
  v_bfe_u32 v24, v22, 3, 2
  v_lshl_add_u32 v22, v24, 2, v23
  v_mul_u32_u24 v23, 1366, v22
  v_lshrrev_b32 v23, 16, v23
  v_mul_u32_u24 v25, 48, v23
  v_sub_u32 v22, v22, v25
  v_mul_u32_u24 v26, 5462, v22
  v_lshrrev_b32 v26, 16, v26
  v_mul_u32_u24 v27, 12, v26
  v_sub_u32 v22, v22, v27
  v_lshrrev_b32 v27, 2, v22
  v_and_b32 v22, 3, v22
  v_lshl_add_u32 v25, v27, 4, v25
  v_lshl_add_u32 v25, v26, 2, v25
  v_add_u32 v25, v25, v22
id_317:
  v_mul_u32_u24 v25, 1280, v25
  v_lshl_add_u32 v64, v21, 4, v25
  s_mul_i32 s21, s20, 320
  s_add_u32 s21, s21, 64
  v_add_u32 v21, s21, v1
  v_mul_u32_u24 v22, v21, v29
  v_lshrrev_b32 v22, 16, v22
  v_mul_u32_u24 v23, 20, v22
  v_sub_u32 v21, v21, v23
  v_add_u32 v22, 0, v22
  v_mov_b32 v25, v22
  s_cmp_eq_u32 s47, 1
  s_cbranch_scc1 id_318
  v_and_b32 v23, 0xe3, v22
  v_bfe_u32 v24, v22, 2, 1
  v_lshl_add_u32 v23, v24, 4, v23
  v_bfe_u32 v24, v22, 3, 2
  v_lshl_add_u32 v22, v24, 2, v23
  v_mul_u32_u24 v23, 1366, v22
  v_lshrrev_b32 v23, 16, v23
  v_mul_u32_u24 v25, 48, v23
  v_sub_u32 v22, v22, v25
  v_mul_u32_u24 v26, 5462, v22
  v_lshrrev_b32 v26, 16, v26
  v_mul_u32_u24 v27, 12, v26
  v_sub_u32 v22, v22, v27
  v_lshrrev_b32 v27, 2, v22
  v_and_b32 v22, 3, v22
  v_lshl_add_u32 v25, v27, 4, v25
  v_lshl_add_u32 v25, v26, 2, v25
  v_add_u32 v25, v25, v22
id_318:
  v_mul_u32_u24 v25, 1280, v25
  v_lshl_add_u32 v65, v21, 4, v25
  s_mul_i32 s21, s20, 320
  s_add_u32 s21, s21, 128
  v_add_u32 v21, s21, v1
  v_mul_u32_u24 v22, v21, v29
  v_lshrrev_b32 v22, 16, v22
  v_mul_u32_u24 v23, 20, v22
  v_sub_u32 v21, v21, v23
  v_add_u32 v22, 0, v22
  v_mov_b32 v25, v22
  s_cmp_eq_u32 s47, 1
  s_cbranch_scc1 id_319
  v_and_b32 v23, 0xe3, v22
  v_bfe_u32 v24, v22, 2, 1
  v_lshl_add_u32 v23, v24, 4, v23
  v_bfe_u32 v24, v22, 3, 2
  v_lshl_add_u32 v22, v24, 2, v23
  v_mul_u32_u24 v23, 1366, v22
  v_lshrrev_b32 v23, 16, v23
  v_mul_u32_u24 v25, 48, v23
  v_sub_u32 v22, v22, v25
  v_mul_u32_u24 v26, 5462, v22
  v_lshrrev_b32 v26, 16, v26
  v_mul_u32_u24 v27, 12, v26
  v_sub_u32 v22, v22, v27
  v_lshrrev_b32 v27, 2, v22
  v_and_b32 v22, 3, v22
  v_lshl_add_u32 v25, v27, 4, v25
  v_lshl_add_u32 v25, v26, 2, v25
  v_add_u32 v25, v25, v22
id_319:
  v_mul_u32_u24 v25, 1280, v25
  v_lshl_add_u32 v66, v21, 4, v25
  s_mul_i32 s21, s20, 320
  s_add_u32 s21, s21, 192
  v_add_u32 v21, s21, v1
  v_mul_u32_u24 v22, v21, v29
  v_lshrrev_b32 v22, 16, v22
  v_mul_u32_u24 v23, 20, v22
  v_sub_u32 v21, v21, v23
  v_add_u32 v22, 0, v22
  v_mov_b32 v25, v22
  s_cmp_eq_u32 s47, 1
  s_cbranch_scc1 id_320
  v_and_b32 v23, 0xe3, v22
  v_bfe_u32 v24, v22, 2, 1
  v_lshl_add_u32 v23, v24, 4, v23
  v_bfe_u32 v24, v22, 3, 2
  v_lshl_add_u32 v22, v24, 2, v23
  v_mul_u32_u24 v23, 1366, v22
  v_lshrrev_b32 v23, 16, v23
  v_mul_u32_u24 v25, 48, v23
  v_sub_u32 v22, v22, v25
  v_mul_u32_u24 v26, 5462, v22
  v_lshrrev_b32 v26, 16, v26
  v_mul_u32_u24 v27, 12, v26
  v_sub_u32 v22, v22, v27
  v_lshrrev_b32 v27, 2, v22
  v_and_b32 v22, 3, v22
  v_lshl_add_u32 v25, v27, 4, v25
  v_lshl_add_u32 v25, v26, 2, v25
  v_add_u32 v25, v25, v22
id_320:
  v_mul_u32_u24 v25, 1280, v25
  v_lshl_add_u32 v67, v21, 4, v25
  s_mul_i32 s21, s20, 320
  s_add_u32 s21, s21, 256
  v_add_u32 v21, s21, v1
  v_mul_u32_u24 v22, v21, v29
  v_lshrrev_b32 v22, 16, v22
  v_mul_u32_u24 v23, 20, v22
  v_sub_u32 v21, v21, v23
  v_add_u32 v22, 0, v22
  v_mov_b32 v25, v22
  s_cmp_eq_u32 s47, 1
  s_cbranch_scc1 id_321
  v_and_b32 v23, 0xe3, v22
  v_bfe_u32 v24, v22, 2, 1
  v_lshl_add_u32 v23, v24, 4, v23
  v_bfe_u32 v24, v22, 3, 2
  v_lshl_add_u32 v22, v24, 2, v23
  v_mul_u32_u24 v23, 1366, v22
  v_lshrrev_b32 v23, 16, v23
  v_mul_u32_u24 v25, 48, v23
  v_sub_u32 v22, v22, v25
  v_mul_u32_u24 v26, 5462, v22
  v_lshrrev_b32 v26, 16, v26
  v_mul_u32_u24 v27, 12, v26
  v_sub_u32 v22, v22, v27
  v_lshrrev_b32 v27, 2, v22
  v_and_b32 v22, 3, v22
  v_lshl_add_u32 v25, v27, 4, v25
  v_lshl_add_u32 v25, v26, 2, v25
  v_add_u32 v25, v25, v22
id_321:
  v_mul_u32_u24 v25, 1280, v25
  v_lshl_add_u32 v68, v21, 4, v25
  s_mul_i32 s21, s20, 320
  s_add_u32 s21, s21, 0
  v_add_u32 v21, s21, v1
  v_mul_u32_u24 v22, v21, v29
  v_lshrrev_b32 v22, 16, v22
  v_mul_u32_u24 v23, 20, v22
  v_sub_u32 v21, v21, v23
  v_add_u32 v22, 64, v22
  v_mov_b32 v25, v22
  s_cmp_eq_u32 s47, 1
  s_cbranch_scc1 id_322
  v_and_b32 v23, 0xe3, v22
  v_bfe_u32 v24, v22, 2, 1
  v_lshl_add_u32 v23, v24, 4, v23
  v_bfe_u32 v24, v22, 3, 2
  v_lshl_add_u32 v22, v24, 2, v23
  v_mul_u32_u24 v23, 1366, v22
  v_lshrrev_b32 v23, 16, v23
  v_mul_u32_u24 v25, 48, v23
  v_sub_u32 v22, v22, v25
  v_mul_u32_u24 v26, 5462, v22
  v_lshrrev_b32 v26, 16, v26
  v_mul_u32_u24 v27, 12, v26
  v_sub_u32 v22, v22, v27
  v_lshrrev_b32 v27, 2, v22
  v_and_b32 v22, 3, v22
  v_lshl_add_u32 v25, v27, 4, v25
  v_lshl_add_u32 v25, v26, 2, v25
  v_add_u32 v25, v25, v22
id_322:
  v_mul_u32_u24 v25, 1280, v25
  v_lshl_add_u32 v69, v21, 4, v25
  s_mul_i32 s21, s20, 320
  s_add_u32 s21, s21, 64
  v_add_u32 v21, s21, v1
  v_mul_u32_u24 v22, v21, v29
  v_lshrrev_b32 v22, 16, v22
  v_mul_u32_u24 v23, 20, v22
  v_sub_u32 v21, v21, v23
  v_add_u32 v22, 64, v22
  v_mov_b32 v25, v22
  s_cmp_eq_u32 s47, 1
  s_cbranch_scc1 id_323
  v_and_b32 v23, 0xe3, v22
  v_bfe_u32 v24, v22, 2, 1
  v_lshl_add_u32 v23, v24, 4, v23
  v_bfe_u32 v24, v22, 3, 2
  v_lshl_add_u32 v22, v24, 2, v23
  v_mul_u32_u24 v23, 1366, v22
  v_lshrrev_b32 v23, 16, v23
  v_mul_u32_u24 v25, 48, v23
  v_sub_u32 v22, v22, v25
  v_mul_u32_u24 v26, 5462, v22
  v_lshrrev_b32 v26, 16, v26
  v_mul_u32_u24 v27, 12, v26
  v_sub_u32 v22, v22, v27
  v_lshrrev_b32 v27, 2, v22
  v_and_b32 v22, 3, v22
  v_lshl_add_u32 v25, v27, 4, v25
  v_lshl_add_u32 v25, v26, 2, v25
  v_add_u32 v25, v25, v22
id_323:
  v_mul_u32_u24 v25, 1280, v25
  v_lshl_add_u32 v70, v21, 4, v25
  s_mul_i32 s21, s20, 320
  s_add_u32 s21, s21, 128
  v_add_u32 v21, s21, v1
  v_mul_u32_u24 v22, v21, v29
  v_lshrrev_b32 v22, 16, v22
  v_mul_u32_u24 v23, 20, v22
  v_sub_u32 v21, v21, v23
  v_add_u32 v22, 64, v22
  v_mov_b32 v25, v22
  s_cmp_eq_u32 s47, 1
  s_cbranch_scc1 id_324
  v_and_b32 v23, 0xe3, v22
  v_bfe_u32 v24, v22, 2, 1
  v_lshl_add_u32 v23, v24, 4, v23
  v_bfe_u32 v24, v22, 3, 2
  v_lshl_add_u32 v22, v24, 2, v23
  v_mul_u32_u24 v23, 1366, v22
  v_lshrrev_b32 v23, 16, v23
  v_mul_u32_u24 v25, 48, v23
  v_sub_u32 v22, v22, v25
  v_mul_u32_u24 v26, 5462, v22
  v_lshrrev_b32 v26, 16, v26
  v_mul_u32_u24 v27, 12, v26
  v_sub_u32 v22, v22, v27
  v_lshrrev_b32 v27, 2, v22
  v_and_b32 v22, 3, v22
  v_lshl_add_u32 v25, v27, 4, v25
  v_lshl_add_u32 v25, v26, 2, v25
  v_add_u32 v25, v25, v22
id_324:
  v_mul_u32_u24 v25, 1280, v25
  v_lshl_add_u32 v71, v21, 4, v25
  s_mul_i32 s21, s20, 320
  s_add_u32 s21, s21, 192
  v_add_u32 v21, s21, v1
  v_mul_u32_u24 v22, v21, v29
  v_lshrrev_b32 v22, 16, v22
  v_mul_u32_u24 v23, 20, v22
  v_sub_u32 v21, v21, v23
  v_add_u32 v22, 64, v22
  v_mov_b32 v25, v22
  s_cmp_eq_u32 s47, 1
  s_cbranch_scc1 id_325
  v_and_b32 v23, 0xe3, v22
  v_bfe_u32 v24, v22, 2, 1
  v_lshl_add_u32 v23, v24, 4, v23
  v_bfe_u32 v24, v22, 3, 2
  v_lshl_add_u32 v22, v24, 2, v23
  v_mul_u32_u24 v23, 1366, v22
  v_lshrrev_b32 v23, 16, v23
  v_mul_u32_u24 v25, 48, v23
  v_sub_u32 v22, v22, v25
  v_mul_u32_u24 v26, 5462, v22
  v_lshrrev_b32 v26, 16, v26
  v_mul_u32_u24 v27, 12, v26
  v_sub_u32 v22, v22, v27
  v_lshrrev_b32 v27, 2, v22
  v_and_b32 v22, 3, v22
  v_lshl_add_u32 v25, v27, 4, v25
  v_lshl_add_u32 v25, v26, 2, v25
  v_add_u32 v25, v25, v22
id_325:
  v_mul_u32_u24 v25, 1280, v25
  v_lshl_add_u32 v72, v21, 4, v25
  s_mul_i32 s21, s20, 320
  s_add_u32 s21, s21, 256
  v_add_u32 v21, s21, v1
  v_mul_u32_u24 v22, v21, v29
  v_lshrrev_b32 v22, 16, v22
  v_mul_u32_u24 v23, 20, v22
  v_sub_u32 v21, v21, v23
  v_add_u32 v22, 64, v22
  v_mov_b32 v25, v22
  s_cmp_eq_u32 s47, 1
  s_cbranch_scc1 id_326
  v_and_b32 v23, 0xe3, v22
  v_bfe_u32 v24, v22, 2, 1
  v_lshl_add_u32 v23, v24, 4, v23
  v_bfe_u32 v24, v22, 3, 2
  v_lshl_add_u32 v22, v24, 2, v23
  v_mul_u32_u24 v23, 1366, v22
  v_lshrrev_b32 v23, 16, v23
  v_mul_u32_u24 v25, 48, v23
  v_sub_u32 v22, v22, v25
  v_mul_u32_u24 v26, 5462, v22
  v_lshrrev_b32 v26, 16, v26
  v_mul_u32_u24 v27, 12, v26
  v_sub_u32 v22, v22, v27
  v_lshrrev_b32 v27, 2, v22
  v_and_b32 v22, 3, v22
  v_lshl_add_u32 v25, v27, 4, v25
  v_lshl_add_u32 v25, v26, 2, v25
  v_add_u32 v25, v25, v22
id_326:
  v_mul_u32_u24 v25, 1280, v25
  v_lshl_add_u32 v73, v21, 4, v25
  s_mul_i32 s21, s20, 320
  s_add_u32 s21, s21, 0
  v_add_u32 v21, s21, v1
  v_mul_u32_u24 v22, v21, v29
  v_lshrrev_b32 v22, 16, v22
  v_mul_u32_u24 v23, 20, v22
  v_sub_u32 v21, v21, v23
  v_add_u32 v22, 128, v22
  v_mov_b32 v25, v22
  s_cmp_eq_u32 s47, 1
  s_cbranch_scc1 id_327
  v_and_b32 v23, 0xe3, v22
  v_bfe_u32 v24, v22, 2, 1
  v_lshl_add_u32 v23, v24, 4, v23
  v_bfe_u32 v24, v22, 3, 2
  v_lshl_add_u32 v22, v24, 2, v23
  v_mul_u32_u24 v23, 1366, v22
  v_lshrrev_b32 v23, 16, v23
  v_mul_u32_u24 v25, 48, v23
  v_sub_u32 v22, v22, v25
  v_mul_u32_u24 v26, 5462, v22
  v_lshrrev_b32 v26, 16, v26
  v_mul_u32_u24 v27, 12, v26
  v_sub_u32 v22, v22, v27
  v_lshrrev_b32 v27, 2, v22
  v_and_b32 v22, 3, v22
  v_lshl_add_u32 v25, v27, 4, v25
  v_lshl_add_u32 v25, v26, 2, v25
  v_add_u32 v25, v25, v22
id_327:
  v_mul_u32_u24 v25, 1280, v25
  v_lshl_add_u32 v74, v21, 4, v25
  s_mul_i32 s21, s20, 320
  s_add_u32 s21, s21, 64
  v_add_u32 v21, s21, v1
  v_mul_u32_u24 v22, v21, v29
  v_lshrrev_b32 v22, 16, v22
  v_mul_u32_u24 v23, 20, v22
  v_sub_u32 v21, v21, v23
  v_add_u32 v22, 128, v22
  v_mov_b32 v25, v22
  s_cmp_eq_u32 s47, 1
  s_cbranch_scc1 id_328
  v_and_b32 v23, 0xe3, v22
  v_bfe_u32 v24, v22, 2, 1
  v_lshl_add_u32 v23, v24, 4, v23
  v_bfe_u32 v24, v22, 3, 2
  v_lshl_add_u32 v22, v24, 2, v23
  v_mul_u32_u24 v23, 1366, v22
  v_lshrrev_b32 v23, 16, v23
  v_mul_u32_u24 v25, 48, v23
  v_sub_u32 v22, v22, v25
  v_mul_u32_u24 v26, 5462, v22
  v_lshrrev_b32 v26, 16, v26
  v_mul_u32_u24 v27, 12, v26
  v_sub_u32 v22, v22, v27
  v_lshrrev_b32 v27, 2, v22
  v_and_b32 v22, 3, v22
  v_lshl_add_u32 v25, v27, 4, v25
  v_lshl_add_u32 v25, v26, 2, v25
  v_add_u32 v25, v25, v22
id_328:
  v_mul_u32_u24 v25, 1280, v25
  v_lshl_add_u32 v75, v21, 4, v25
  s_mul_i32 s21, s20, 320
  s_add_u32 s21, s21, 128
  v_add_u32 v21, s21, v1
  v_mul_u32_u24 v22, v21, v29
  v_lshrrev_b32 v22, 16, v22
  v_mul_u32_u24 v23, 20, v22
  v_sub_u32 v21, v21, v23
  v_add_u32 v22, 128, v22
  v_mov_b32 v25, v22
  s_cmp_eq_u32 s47, 1
  s_cbranch_scc1 id_329
  v_and_b32 v23, 0xe3, v22
  v_bfe_u32 v24, v22, 2, 1
  v_lshl_add_u32 v23, v24, 4, v23
  v_bfe_u32 v24, v22, 3, 2
  v_lshl_add_u32 v22, v24, 2, v23
  v_mul_u32_u24 v23, 1366, v22
  v_lshrrev_b32 v23, 16, v23
  v_mul_u32_u24 v25, 48, v23
  v_sub_u32 v22, v22, v25
  v_mul_u32_u24 v26, 5462, v22
  v_lshrrev_b32 v26, 16, v26
  v_mul_u32_u24 v27, 12, v26
  v_sub_u32 v22, v22, v27
  v_lshrrev_b32 v27, 2, v22
  v_and_b32 v22, 3, v22
  v_lshl_add_u32 v25, v27, 4, v25
  v_lshl_add_u32 v25, v26, 2, v25
  v_add_u32 v25, v25, v22
id_329:
  v_mul_u32_u24 v25, 1280, v25
  v_lshl_add_u32 v76, v21, 4, v25
  s_mul_i32 s21, s20, 320
  s_add_u32 s21, s21, 192
  v_add_u32 v21, s21, v1
  v_mul_u32_u24 v22, v21, v29
  v_lshrrev_b32 v22, 16, v22
  v_mul_u32_u24 v23, 20, v22
  v_sub_u32 v21, v21, v23
  v_add_u32 v22, 128, v22
  v_mov_b32 v25, v22
  s_cmp_eq_u32 s47, 1
  s_cbranch_scc1 id_330
  v_and_b32 v23, 0xe3, v22
  v_bfe_u32 v24, v22, 2, 1
  v_lshl_add_u32 v23, v24, 4, v23
  v_bfe_u32 v24, v22, 3, 2
  v_lshl_add_u32 v22, v24, 2, v23
  v_mul_u32_u24 v23, 1366, v22
  v_lshrrev_b32 v23, 16, v23
  v_mul_u32_u24 v25, 48, v23
  v_sub_u32 v22, v22, v25
  v_mul_u32_u24 v26, 5462, v22
  v_lshrrev_b32 v26, 16, v26
  v_mul_u32_u24 v27, 12, v26
  v_sub_u32 v22, v22, v27
  v_lshrrev_b32 v27, 2, v22
  v_and_b32 v22, 3, v22
  v_lshl_add_u32 v25, v27, 4, v25
  v_lshl_add_u32 v25, v26, 2, v25
  v_add_u32 v25, v25, v22
id_330:
  v_mul_u32_u24 v25, 1280, v25
  v_lshl_add_u32 v77, v21, 4, v25
  s_mul_i32 s21, s20, 320
  s_add_u32 s21, s21, 256
  v_add_u32 v21, s21, v1
  v_mul_u32_u24 v22, v21, v29
  v_lshrrev_b32 v22, 16, v22
  v_mul_u32_u24 v23, 20, v22
  v_sub_u32 v21, v21, v23
  v_add_u32 v22, 128, v22
  v_mov_b32 v25, v22
  s_cmp_eq_u32 s47, 1
  s_cbranch_scc1 id_331
  v_and_b32 v23, 0xe3, v22
  v_bfe_u32 v24, v22, 2, 1
  v_lshl_add_u32 v23, v24, 4, v23
  v_bfe_u32 v24, v22, 3, 2
  v_lshl_add_u32 v22, v24, 2, v23
  v_mul_u32_u24 v23, 1366, v22
  v_lshrrev_b32 v23, 16, v23
  v_mul_u32_u24 v25, 48, v23
  v_sub_u32 v22, v22, v25
  v_mul_u32_u24 v26, 5462, v22
  v_lshrrev_b32 v26, 16, v26
  v_mul_u32_u24 v27, 12, v26
  v_sub_u32 v22, v22, v27
  v_lshrrev_b32 v27, 2, v22
  v_and_b32 v22, 3, v22
  v_lshl_add_u32 v25, v27, 4, v25
  v_lshl_add_u32 v25, v26, 2, v25
  v_add_u32 v25, v25, v22
id_331:
  v_mul_u32_u24 v25, 1280, v25
  v_lshl_add_u32 v78, v21, 4, v25
  s_lshr_b32 s21, s20, 1
  s_lshl_b32 s21, s21, 13
  v_add_u32 v5, s21, v4
  v_lshrrev_b32 v6, 2, v2
  v_lshl_add_u32 v6, v3, 3, v6
  v_mul_u32_u24 v6, 320, v6
  v_and_b32 v7, 3, v2
  v_lshlrev_b32 v7, 3, v7
  s_and_b32 s21, s20, 1
  s_mul_i32 s21, s21, 160
  s_add_u32 s21, s21, 16384
  v_add3_u32 v6, v6, v7, s21
  s_mov_b32 s50, 0
  s_mov_b32 s51, 0
  v_mov_b32 v80, 0
  v_mov_b32 v81, 0
  v_mov_b32 v82, 0
  v_mov_b32 v83, 0
  v_mov_b32 v84, 0
  v_mov_b32 v85, 0
  v_mov_b32 v86, 0
  v_mov_b32 v87, 0
  v_mov_b32 v88, 0
  v_mov_b32 v89, 0
  v_mov_b32 v90, 0
  v_mov_b32 v91, 0
  v_mov_b32 v92, 0
  v_mov_b32 v93, 0
  v_mov_b32 v94, 0
  v_mov_b32 v95, 0
  v_mov_b32 v96, 0
  v_mov_b32 v97, 0
  v_mov_b32 v98, 0
  v_mov_b32 v99, 0
  v_mov_b32 v100, 0
  v_mov_b32 v101, 0
  v_mov_b32 v102, 0
  v_mov_b32 v103, 0
  v_mov_b32 v104, 0
  v_mov_b32 v105, 0
  v_mov_b32 v106, 0
  v_mov_b32 v107, 0
  v_mov_b32 v108, 0
  v_mov_b32 v109, 0
  v_mov_b32 v110, 0
  v_mov_b32 v111, 0
  v_mov_b32 v112, 0
  v_mov_b32 v113, 0
  v_mov_b32 v114, 0
  v_mov_b32 v115, 0
  v_mov_b32 v116, 0
  v_mov_b32 v117, 0
  v_mov_b32 v118, 0
  v_mov_b32 v119, 0
  v_mov_b32 v120, 0
  v_mov_b32 v121, 0
  v_mov_b32 v122, 0
  v_mov_b32 v123, 0
  v_mov_b32 v124, 0
  v_mov_b32 v125, 0
  v_mov_b32 v126, 0
  v_mov_b32 v127, 0
  v_mov_b32 v128, 0
  v_mov_b32 v129, 0
  v_mov_b32 v130, 0
  v_mov_b32 v131, 0
  v_mov_b32 v132, 0
  v_mov_b32 v133, 0
  v_mov_b32 v134, 0
  v_mov_b32 v135, 0
  v_mov_b32 v136, 0
  v_mov_b32 v137, 0
  v_mov_b32 v138, 0
  v_mov_b32 v139, 0
  v_mov_b32 v140, 0
  v_mov_b32 v141, 0
  v_mov_b32 v142, 0
  v_mov_b32 v143, 0
  v_mov_b32 v144, 0
  v_mov_b32 v145, 0
  v_mov_b32 v146, 0
  v_mov_b32 v147, 0
  v_mov_b32 v148, 0
  v_mov_b32 v149, 0
  v_mov_b32 v150, 0
  v_mov_b32 v151, 0
  v_mov_b32 v152, 0
  v_mov_b32 v153, 0
  v_mov_b32 v154, 0
  v_mov_b32 v155, 0
  v_mov_b32 v156, 0
  v_mov_b32 v157, 0
  v_mov_b32 v158, 0
  v_mov_b32 v159, 0
  s_lshl_b32 s53, s44, 11
  s_add_u32 s53, s53, s48
  s_sub_u32 s53, s53, 2048
  s_load_dwordx2 s[72:73], s[0:1], 104
  s_waitcnt lgkmcnt(0)
  s_add_u32 s72, s72, 81068032
  s_addc_u32 s73, s73, 0
  s_mov_b32 s74, 115712
  s_mov_b32 s75, 0x00020000
  s_lshl_b32 s21, s40, 7
  s_add_u32 s21, s21, 90112
  s_mov_b32 s23, 4
  s_cmp_lg_u32 s20, 0
  s_cbranch_scc1 wf_333
  v_mov_b32 v10, 0
  s_mov_b32 s101, 0
wf_332:
  buffer_load_dword v11, v10, s[72:75], s21 offen sc1
  s_add_u32 s101, s101, 1
  s_cmp_gt_u32 s101, 131072
  s_cbranch_scc1 main_end
  s_waitcnt vmcnt(0)
  v_readfirstlane_b32 s100, v11
  s_cmp_ge_u32 s100, s23
  s_cbranch_scc1 wf_333
  s_sleep 8
  s_add_u32 s100, s100, 8
  s_cmp_ge_u32 s100, s23
  s_cbranch_scc1 wf_332
  s_sleep 60
  s_branch wf_332
wf_333:
  s_barrier
  s_lshl_b32 s22, s20, 12
  s_add_u32 s22, s22, s50
  s_add_u32 s23, s48, s45
  s_add_u32 m0, s22, 0
  s_nop 0
  buffer_load_dwordx4 v4, s[12:15], s48 offen offset:0 sc1 lds
  s_add_u32 m0, s22, 0
  s_nop 0
  buffer_load_dwordx4 v4, s[12:15], s48 offen offset:1024 sc1 lds
  s_add_u32 m0, s22, 2048
  s_nop 0
  buffer_load_dwordx4 v4, s[12:15], s23 offen offset:0 sc1 lds
  s_add_u32 m0, s22, 2048
  s_nop 0
  buffer_load_dwordx4 v4, s[12:15], s23 offen offset:1024 sc1 lds
  s_mul_i32 s22, s20, 5120
  s_add_u32 s22, s22, s50
  s_add_u32 s22, s22, 16384
  s_add_u32 m0, s22, 0
  s_nop 0
  buffer_load_dwordx4 v64, s[8:11], s49 offen lds
  s_add_u32 m0, s22, 1024
  s_nop 0
  buffer_load_dwordx4 v65, s[8:11], s49 offen lds
  s_add_u32 m0, s22, 2048
  s_nop 0
  buffer_load_dwordx4 v66, s[8:11], s49 offen lds
  s_add_u32 m0, s22, 3072
  s_nop 0
  buffer_load_dwordx4 v67, s[8:11], s49 offen lds
  s_add_u32 m0, s22, 4096
  s_nop 0
  buffer_load_dwordx4 v68, s[8:11], s49 offen lds
  s_add_u32 s48, s48, 2048
  s_min_u32 s48, s48, s53
  s_add_u32 s50, s50, 36864
  s_cmp_lt_u32 s50, 147456
  s_cselect_b32 s50, s50, 0
  s_lshl_b32 s22, s20, 12
  s_add_u32 s22, s22, s50
  s_add_u32 s23, s48, s45
  s_add_u32 m0, s22, 0
  s_nop 0
  buffer_load_dwordx4 v4, s[12:15], s48 offen offset:0 sc1 lds
  s_add_u32 m0, s22, 0
  s_nop 0
  buffer_load_dwordx4 v4, s[12:15], s48 offen offset:1024 sc1 lds
  s_add_u32 m0, s22, 2048
  s_nop 0
  buffer_load_dwordx4 v4, s[12:15], s23 offen offset:0 sc1 lds
  s_add_u32 m0, s22, 2048
  s_nop 0
  buffer_load_dwordx4 v4, s[12:15], s23 offen offset:1024 sc1 lds
  s_mul_i32 s22, s20, 5120
  s_add_u32 s22, s22, s50
  s_add_u32 s22, s22, 16384
  s_add_u32 m0, s22, 0
  s_nop 0
  buffer_load_dwordx4 v69, s[8:11], s49 offen lds
  s_add_u32 m0, s22, 1024
  s_nop 0
  buffer_load_dwordx4 v70, s[8:11], s49 offen lds
  s_add_u32 m0, s22, 2048
  s_nop 0
  buffer_load_dwordx4 v71, s[8:11], s49 offen lds
  s_add_u32 m0, s22, 3072
  s_nop 0
  buffer_load_dwordx4 v72, s[8:11], s49 offen lds
  s_add_u32 m0, s22, 4096
  s_nop 0
  buffer_load_dwordx4 v73, s[8:11], s49 offen lds
  s_add_u32 s48, s48, 2048
  s_min_u32 s48, s48, s53
  s_add_u32 s50, s50, 36864
  s_cmp_lt_u32 s50, 147456
  s_cselect_b32 s50, s50, 0
  s_lshl_b32 s22, s20, 12
  s_add_u32 s22, s22, s50
  s_add_u32 s23, s48, s45
  s_add_u32 m0, s22, 0
  s_nop 0
  buffer_load_dwordx4 v4, s[12:15], s48 offen offset:0 sc1 lds
  s_add_u32 m0, s22, 0
  s_nop 0
  buffer_load_dwordx4 v4, s[12:15], s48 offen offset:1024 sc1 lds
  s_add_u32 m0, s22, 2048
  s_nop 0
  buffer_load_dwordx4 v4, s[12:15], s23 offen offset:0 sc1 lds
  s_add_u32 m0, s22, 2048
  s_nop 0
  buffer_load_dwordx4 v4, s[12:15], s23 offen offset:1024 sc1 lds
  s_mul_i32 s22, s20, 5120
  s_add_u32 s22, s22, s50
  s_add_u32 s22, s22, 16384
  s_add_u32 m0, s22, 0
  s_nop 0
  buffer_load_dwordx4 v74, s[8:11], s49 offen lds
  s_add_u32 m0, s22, 1024
  s_nop 0
  buffer_load_dwordx4 v75, s[8:11], s49 offen lds
  s_add_u32 m0, s22, 2048
  s_nop 0
  buffer_load_dwordx4 v76, s[8:11], s49 offen lds
  s_add_u32 m0, s22, 3072
  s_nop 0
  buffer_load_dwordx4 v77, s[8:11], s49 offen lds
  s_add_u32 m0, s22, 4096
  s_nop 0
  buffer_load_dwordx4 v78, s[8:11], s49 offen lds
  s_add_u32 s48, s48, 2048
  s_min_u32 s48, s48, s53
  s_add_u32 s49, s49, 245760
  s_add_u32 s50, s50, 36864
  s_cmp_lt_u32 s50, 147456
  s_cselect_b32 s50, s50, 0
  s_mov_b32 s52, 0
op_334:
  s_waitcnt vmcnt(18)
  s_barrier
  v_add_u32 v8, s51, v5
  v_add_u32 v9, s51, v6
  s_add_u32 s51, s51, 36864
  s_cmp_lt_u32 s51, 147456
  s_cselect_b32 s51, s51, 0
  ds_read_b128 v[160:163], v8 offset:0
  ds_read_b128 v[164:167], v8 offset:2048
  ds_read_b128 v[168:171], v8 offset:4096
  ds_read_b128 v[172:175], v8 offset:6144
  ds_read_b64_tr_b16 v[176:177], v9 offset:0
  ds_read_b64_tr_b16 v[178:179], v9 offset:1280
  ds_read_b64_tr_b16 v[180:181], v9 offset:32
  ds_read_b64_tr_b16 v[182:183], v9 offset:1312
  ds_read_b64_tr_b16 v[184:185], v9 offset:64
  ds_read_b64_tr_b16 v[186:187], v9 offset:1344
  ds_read_b64_tr_b16 v[188:189], v9 offset:96
  ds_read_b64_tr_b16 v[190:191], v9 offset:1376
  ds_read_b64_tr_b16 v[192:193], v9 offset:128
  ds_read_b64_tr_b16 v[194:195], v9 offset:1408
  s_lshl_b32 s22, s20, 12
  s_add_u32 s22, s22, s50
  s_add_u32 s23, s48, s45
  s_add_u32 m0, s22, 0
  s_nop 0
  buffer_load_dwordx4 v4, s[12:15], s48 offen offset:0 sc1 lds
  s_add_u32 m0, s22, 0
  s_nop 0
  buffer_load_dwordx4 v4, s[12:15], s48 offen offset:1024 sc1 lds
  s_add_u32 m0, s22, 2048
  s_nop 0
  buffer_load_dwordx4 v4, s[12:15], s23 offen offset:0 sc1 lds
  s_add_u32 m0, s22, 2048
  s_nop 0
  buffer_load_dwordx4 v4, s[12:15], s23 offen offset:1024 sc1 lds
  ds_read_b128 v[196:199], v8 offset:1024
  ds_read_b128 v[200:203], v8 offset:3072
  ds_read_b128 v[204:207], v8 offset:5120
  ds_read_b128 v[208:211], v8 offset:7168
  ds_read_b64_tr_b16 v[212:213], v9 offset:10240
  ds_read_b64_tr_b16 v[214:215], v9 offset:11520
  ds_read_b64_tr_b16 v[216:217], v9 offset:10272
  ds_read_b64_tr_b16 v[218:219], v9 offset:11552
  ds_read_b64_tr_b16 v[220:221], v9 offset:10304
  ds_read_b64_tr_b16 v[222:223], v9 offset:11584
  ds_read_b64_tr_b16 v[224:225], v9 offset:10336
  ds_read_b64_tr_b16 v[226:227], v9 offset:11616
  ds_read_b64_tr_b16 v[228:229], v9 offset:10368
  ds_read_b64_tr_b16 v[230:231], v9 offset:11648
  s_waitcnt lgkmcnt(14)
  v_mfma_f32_16x16x32_bf16 v[80:83], v[176:179], v[160:163], v[80:83]
  v_mfma_f32_16x16x32_bf16 v[84:87], v[180:183], v[160:163], v[84:87]
  v_mfma_f32_16x16x32_bf16 v[88:91], v[184:187], v[160:163], v[88:91]
  v_mfma_f32_16x16x32_bf16 v[92:95], v[188:191], v[160:163], v[92:95]
  v_mfma_f32_16x16x32_bf16 v[96:99], v[192:195], v[160:163], v[96:99]
  v_mfma_f32_16x16x32_bf16 v[100:103], v[176:179], v[164:167], v[100:103]
  v_mfma_f32_16x16x32_bf16 v[104:107], v[180:183], v[164:167], v[104:107]
  v_mfma_f32_16x16x32_bf16 v[108:111], v[184:187], v[164:167], v[108:111]
  v_mfma_f32_16x16x32_bf16 v[112:115], v[188:191], v[164:167], v[112:115]
  v_mfma_f32_16x16x32_bf16 v[116:119], v[192:195], v[164:167], v[116:119]
  v_mfma_f32_16x16x32_bf16 v[120:123], v[176:179], v[168:171], v[120:123]
  v_mfma_f32_16x16x32_bf16 v[124:127], v[180:183], v[168:171], v[124:127]
  v_mfma_f32_16x16x32_bf16 v[128:131], v[184:187], v[168:171], v[128:131]
  v_mfma_f32_16x16x32_bf16 v[132:135], v[188:191], v[168:171], v[132:135]
  v_mfma_f32_16x16x32_bf16 v[136:139], v[192:195], v[168:171], v[136:139]
  v_mfma_f32_16x16x32_bf16 v[140:143], v[176:179], v[172:175], v[140:143]
  v_mfma_f32_16x16x32_bf16 v[144:147], v[180:183], v[172:175], v[144:147]
  v_mfma_f32_16x16x32_bf16 v[148:151], v[184:187], v[172:175], v[148:151]
  v_mfma_f32_16x16x32_bf16 v[152:155], v[188:191], v[172:175], v[152:155]
  v_mfma_f32_16x16x32_bf16 v[156:159], v[192:195], v[172:175], v[156:159]
  s_mul_i32 s22, s20, 5120
  s_add_u32 s22, s22, s50
  s_add_u32 s22, s22, 16384
  s_add_u32 m0, s22, 0
  s_nop 0
  buffer_load_dwordx4 v64, s[8:11], s49 offen lds
  s_add_u32 m0, s22, 1024
  s_nop 0
  buffer_load_dwordx4 v65, s[8:11], s49 offen lds
  s_add_u32 m0, s22, 2048
  s_nop 0
  buffer_load_dwordx4 v66, s[8:11], s49 offen lds
  s_add_u32 m0, s22, 3072
  s_nop 0
  buffer_load_dwordx4 v67, s[8:11], s49 offen lds
  s_add_u32 m0, s22, 4096
  s_nop 0
  buffer_load_dwordx4 v68, s[8:11], s49 offen lds
  s_add_u32 s48, s48, 2048
  s_min_u32 s48, s48, s53
  s_add_u32 s50, s50, 36864
  s_cmp_lt_u32 s50, 147456
  s_cselect_b32 s50, s50, 0
  s_waitcnt lgkmcnt(0)
  v_mfma_f32_16x16x32_bf16 v[80:83], v[212:215], v[196:199], v[80:83]
  v_mfma_f32_16x16x32_bf16 v[84:87], v[216:219], v[196:199], v[84:87]
  v_mfma_f32_16x16x32_bf16 v[88:91], v[220:223], v[196:199], v[88:91]
  v_mfma_f32_16x16x32_bf16 v[92:95], v[224:227], v[196:199], v[92:95]
  v_mfma_f32_16x16x32_bf16 v[96:99], v[228:231], v[196:199], v[96:99]
  v_mfma_f32_16x16x32_bf16 v[100:103], v[212:215], v[200:203], v[100:103]
  v_mfma_f32_16x16x32_bf16 v[104:107], v[216:219], v[200:203], v[104:107]
  v_mfma_f32_16x16x32_bf16 v[108:111], v[220:223], v[200:203], v[108:111]
  v_mfma_f32_16x16x32_bf16 v[112:115], v[224:227], v[200:203], v[112:115]
  v_mfma_f32_16x16x32_bf16 v[116:119], v[228:231], v[200:203], v[116:119]
  v_mfma_f32_16x16x32_bf16 v[120:123], v[212:215], v[204:207], v[120:123]
  v_mfma_f32_16x16x32_bf16 v[124:127], v[216:219], v[204:207], v[124:127]
  v_mfma_f32_16x16x32_bf16 v[128:131], v[220:223], v[204:207], v[128:131]
  v_mfma_f32_16x16x32_bf16 v[132:135], v[224:227], v[204:207], v[132:135]
  v_mfma_f32_16x16x32_bf16 v[136:139], v[228:231], v[204:207], v[136:139]
  v_mfma_f32_16x16x32_bf16 v[140:143], v[212:215], v[208:211], v[140:143]
  v_mfma_f32_16x16x32_bf16 v[144:147], v[216:219], v[208:211], v[144:147]
  v_mfma_f32_16x16x32_bf16 v[148:151], v[220:223], v[208:211], v[148:151]
  v_mfma_f32_16x16x32_bf16 v[152:155], v[224:227], v[208:211], v[152:155]
  v_mfma_f32_16x16x32_bf16 v[156:159], v[228:231], v[208:211], v[156:159]
  s_add_u32 s52, s52, 1
  s_cmp_ge_u32 s52, s44
  s_cbranch_scc1 opd_335
  s_waitcnt vmcnt(18)
  s_barrier
  v_add_u32 v8, s51, v5
  v_add_u32 v9, s51, v6
  s_add_u32 s51, s51, 36864
  s_cmp_lt_u32 s51, 147456
  s_cselect_b32 s51, s51, 0
  ds_read_b128 v[160:163], v8 offset:0
  ds_read_b128 v[164:167], v8 offset:2048
  ds_read_b128 v[168:171], v8 offset:4096
  ds_read_b128 v[172:175], v8 offset:6144
  ds_read_b64_tr_b16 v[176:177], v9 offset:0
  ds_read_b64_tr_b16 v[178:179], v9 offset:1280
  ds_read_b64_tr_b16 v[180:181], v9 offset:32
  ds_read_b64_tr_b16 v[182:183], v9 offset:1312
  ds_read_b64_tr_b16 v[184:185], v9 offset:64
  ds_read_b64_tr_b16 v[186:187], v9 offset:1344
  ds_read_b64_tr_b16 v[188:189], v9 offset:96
  ds_read_b64_tr_b16 v[190:191], v9 offset:1376
  ds_read_b64_tr_b16 v[192:193], v9 offset:128
  ds_read_b64_tr_b16 v[194:195], v9 offset:1408
  s_lshl_b32 s22, s20, 12
  s_add_u32 s22, s22, s50
  s_add_u32 s23, s48, s45
  s_add_u32 m0, s22, 0
  s_nop 0
  buffer_load_dwordx4 v4, s[12:15], s48 offen offset:0 sc1 lds
  s_add_u32 m0, s22, 0
  s_nop 0
  buffer_load_dwordx4 v4, s[12:15], s48 offen offset:1024 sc1 lds
  s_add_u32 m0, s22, 2048
  s_nop 0
  buffer_load_dwordx4 v4, s[12:15], s23 offen offset:0 sc1 lds
  s_add_u32 m0, s22, 2048
  s_nop 0
  buffer_load_dwordx4 v4, s[12:15], s23 offen offset:1024 sc1 lds
  ds_read_b128 v[196:199], v8 offset:1024
  ds_read_b128 v[200:203], v8 offset:3072
  ds_read_b128 v[204:207], v8 offset:5120
  ds_read_b128 v[208:211], v8 offset:7168
  ds_read_b64_tr_b16 v[212:213], v9 offset:10240
  ds_read_b64_tr_b16 v[214:215], v9 offset:11520
  ds_read_b64_tr_b16 v[216:217], v9 offset:10272
  ds_read_b64_tr_b16 v[218:219], v9 offset:11552
  ds_read_b64_tr_b16 v[220:221], v9 offset:10304
  ds_read_b64_tr_b16 v[222:223], v9 offset:11584
  ds_read_b64_tr_b16 v[224:225], v9 offset:10336
  ds_read_b64_tr_b16 v[226:227], v9 offset:11616
  ds_read_b64_tr_b16 v[228:229], v9 offset:10368
  ds_read_b64_tr_b16 v[230:231], v9 offset:11648
  s_waitcnt lgkmcnt(14)
  v_mfma_f32_16x16x32_bf16 v[80:83], v[176:179], v[160:163], v[80:83]
  v_mfma_f32_16x16x32_bf16 v[84:87], v[180:183], v[160:163], v[84:87]
  v_mfma_f32_16x16x32_bf16 v[88:91], v[184:187], v[160:163], v[88:91]
  v_mfma_f32_16x16x32_bf16 v[92:95], v[188:191], v[160:163], v[92:95]
  v_mfma_f32_16x16x32_bf16 v[96:99], v[192:195], v[160:163], v[96:99]
  v_mfma_f32_16x16x32_bf16 v[100:103], v[176:179], v[164:167], v[100:103]
  v_mfma_f32_16x16x32_bf16 v[104:107], v[180:183], v[164:167], v[104:107]
  v_mfma_f32_16x16x32_bf16 v[108:111], v[184:187], v[164:167], v[108:111]
  v_mfma_f32_16x16x32_bf16 v[112:115], v[188:191], v[164:167], v[112:115]
  v_mfma_f32_16x16x32_bf16 v[116:119], v[192:195], v[164:167], v[116:119]
  v_mfma_f32_16x16x32_bf16 v[120:123], v[176:179], v[168:171], v[120:123]
  v_mfma_f32_16x16x32_bf16 v[124:127], v[180:183], v[168:171], v[124:127]
  v_mfma_f32_16x16x32_bf16 v[128:131], v[184:187], v[168:171], v[128:131]
  v_mfma_f32_16x16x32_bf16 v[132:135], v[188:191], v[168:171], v[132:135]
  v_mfma_f32_16x16x32_bf16 v[136:139], v[192:195], v[168:171], v[136:139]
  v_mfma_f32_16x16x32_bf16 v[140:143], v[176:179], v[172:175], v[140:143]
  v_mfma_f32_16x16x32_bf16 v[144:147], v[180:183], v[172:175], v[144:147]
  v_mfma_f32_16x16x32_bf16 v[148:151], v[184:187], v[172:175], v[148:151]
  v_mfma_f32_16x16x32_bf16 v[152:155], v[188:191], v[172:175], v[152:155]
  v_mfma_f32_16x16x32_bf16 v[156:159], v[192:195], v[172:175], v[156:159]
  s_mul_i32 s22, s20, 5120
  s_add_u32 s22, s22, s50
  s_add_u32 s22, s22, 16384
  s_add_u32 m0, s22, 0
  s_nop 0
  buffer_load_dwordx4 v69, s[8:11], s49 offen lds
  s_add_u32 m0, s22, 1024
  s_nop 0
  buffer_load_dwordx4 v70, s[8:11], s49 offen lds
  s_add_u32 m0, s22, 2048
  s_nop 0
  buffer_load_dwordx4 v71, s[8:11], s49 offen lds
  s_add_u32 m0, s22, 3072
  s_nop 0
  buffer_load_dwordx4 v72, s[8:11], s49 offen lds
  s_add_u32 m0, s22, 4096
  s_nop 0
  buffer_load_dwordx4 v73, s[8:11], s49 offen lds
  s_add_u32 s48, s48, 2048
  s_min_u32 s48, s48, s53
  s_add_u32 s50, s50, 36864
  s_cmp_lt_u32 s50, 147456
  s_cselect_b32 s50, s50, 0
  s_waitcnt lgkmcnt(0)
  v_mfma_f32_16x16x32_bf16 v[80:83], v[212:215], v[196:199], v[80:83]
  v_mfma_f32_16x16x32_bf16 v[84:87], v[216:219], v[196:199], v[84:87]
  v_mfma_f32_16x16x32_bf16 v[88:91], v[220:223], v[196:199], v[88:91]
  v_mfma_f32_16x16x32_bf16 v[92:95], v[224:227], v[196:199], v[92:95]
  v_mfma_f32_16x16x32_bf16 v[96:99], v[228:231], v[196:199], v[96:99]
  v_mfma_f32_16x16x32_bf16 v[100:103], v[212:215], v[200:203], v[100:103]
  v_mfma_f32_16x16x32_bf16 v[104:107], v[216:219], v[200:203], v[104:107]
  v_mfma_f32_16x16x32_bf16 v[108:111], v[220:223], v[200:203], v[108:111]
  v_mfma_f32_16x16x32_bf16 v[112:115], v[224:227], v[200:203], v[112:115]
  v_mfma_f32_16x16x32_bf16 v[116:119], v[228:231], v[200:203], v[116:119]
  v_mfma_f32_16x16x32_bf16 v[120:123], v[212:215], v[204:207], v[120:123]
  v_mfma_f32_16x16x32_bf16 v[124:127], v[216:219], v[204:207], v[124:127]
  v_mfma_f32_16x16x32_bf16 v[128:131], v[220:223], v[204:207], v[128:131]
  v_mfma_f32_16x16x32_bf16 v[132:135], v[224:227], v[204:207], v[132:135]
  v_mfma_f32_16x16x32_bf16 v[136:139], v[228:231], v[204:207], v[136:139]
  v_mfma_f32_16x16x32_bf16 v[140:143], v[212:215], v[208:211], v[140:143]
  v_mfma_f32_16x16x32_bf16 v[144:147], v[216:219], v[208:211], v[144:147]
  v_mfma_f32_16x16x32_bf16 v[148:151], v[220:223], v[208:211], v[148:151]
  v_mfma_f32_16x16x32_bf16 v[152:155], v[224:227], v[208:211], v[152:155]
  v_mfma_f32_16x16x32_bf16 v[156:159], v[228:231], v[208:211], v[156:159]
  s_add_u32 s52, s52, 1
  s_cmp_ge_u32 s52, s44
  s_cbranch_scc1 opd_335
  s_waitcnt vmcnt(18)
  s_barrier
  v_add_u32 v8, s51, v5
  v_add_u32 v9, s51, v6
  s_add_u32 s51, s51, 36864
  s_cmp_lt_u32 s51, 147456
  s_cselect_b32 s51, s51, 0
  ds_read_b128 v[160:163], v8 offset:0
  ds_read_b128 v[164:167], v8 offset:2048
  ds_read_b128 v[168:171], v8 offset:4096
  ds_read_b128 v[172:175], v8 offset:6144
  ds_read_b64_tr_b16 v[176:177], v9 offset:0
  ds_read_b64_tr_b16 v[178:179], v9 offset:1280
  ds_read_b64_tr_b16 v[180:181], v9 offset:32
  ds_read_b64_tr_b16 v[182:183], v9 offset:1312
  ds_read_b64_tr_b16 v[184:185], v9 offset:64
  ds_read_b64_tr_b16 v[186:187], v9 offset:1344
  ds_read_b64_tr_b16 v[188:189], v9 offset:96
  ds_read_b64_tr_b16 v[190:191], v9 offset:1376
  ds_read_b64_tr_b16 v[192:193], v9 offset:128
  ds_read_b64_tr_b16 v[194:195], v9 offset:1408
  s_lshl_b32 s22, s20, 12
  s_add_u32 s22, s22, s50
  s_add_u32 s23, s48, s45
  s_add_u32 m0, s22, 0
  s_nop 0
  buffer_load_dwordx4 v4, s[12:15], s48 offen offset:0 sc1 lds
  s_add_u32 m0, s22, 0
  s_nop 0
  buffer_load_dwordx4 v4, s[12:15], s48 offen offset:1024 sc1 lds
  s_add_u32 m0, s22, 2048
  s_nop 0
  buffer_load_dwordx4 v4, s[12:15], s23 offen offset:0 sc1 lds
  s_add_u32 m0, s22, 2048
  s_nop 0
  buffer_load_dwordx4 v4, s[12:15], s23 offen offset:1024 sc1 lds
  ds_read_b128 v[196:199], v8 offset:1024
  ds_read_b128 v[200:203], v8 offset:3072
  ds_read_b128 v[204:207], v8 offset:5120
  ds_read_b128 v[208:211], v8 offset:7168
  ds_read_b64_tr_b16 v[212:213], v9 offset:10240
  ds_read_b64_tr_b16 v[214:215], v9 offset:11520
  ds_read_b64_tr_b16 v[216:217], v9 offset:10272
  ds_read_b64_tr_b16 v[218:219], v9 offset:11552
  ds_read_b64_tr_b16 v[220:221], v9 offset:10304
  ds_read_b64_tr_b16 v[222:223], v9 offset:11584
  ds_read_b64_tr_b16 v[224:225], v9 offset:10336
  ds_read_b64_tr_b16 v[226:227], v9 offset:11616
  ds_read_b64_tr_b16 v[228:229], v9 offset:10368
  ds_read_b64_tr_b16 v[230:231], v9 offset:11648
  s_waitcnt lgkmcnt(14)
  v_mfma_f32_16x16x32_bf16 v[80:83], v[176:179], v[160:163], v[80:83]
  v_mfma_f32_16x16x32_bf16 v[84:87], v[180:183], v[160:163], v[84:87]
  v_mfma_f32_16x16x32_bf16 v[88:91], v[184:187], v[160:163], v[88:91]
  v_mfma_f32_16x16x32_bf16 v[92:95], v[188:191], v[160:163], v[92:95]
  v_mfma_f32_16x16x32_bf16 v[96:99], v[192:195], v[160:163], v[96:99]
  v_mfma_f32_16x16x32_bf16 v[100:103], v[176:179], v[164:167], v[100:103]
  v_mfma_f32_16x16x32_bf16 v[104:107], v[180:183], v[164:167], v[104:107]
  v_mfma_f32_16x16x32_bf16 v[108:111], v[184:187], v[164:167], v[108:111]
  v_mfma_f32_16x16x32_bf16 v[112:115], v[188:191], v[164:167], v[112:115]
  v_mfma_f32_16x16x32_bf16 v[116:119], v[192:195], v[164:167], v[116:119]
  v_mfma_f32_16x16x32_bf16 v[120:123], v[176:179], v[168:171], v[120:123]
  v_mfma_f32_16x16x32_bf16 v[124:127], v[180:183], v[168:171], v[124:127]
  v_mfma_f32_16x16x32_bf16 v[128:131], v[184:187], v[168:171], v[128:131]
  v_mfma_f32_16x16x32_bf16 v[132:135], v[188:191], v[168:171], v[132:135]
  v_mfma_f32_16x16x32_bf16 v[136:139], v[192:195], v[168:171], v[136:139]
  v_mfma_f32_16x16x32_bf16 v[140:143], v[176:179], v[172:175], v[140:143]
  v_mfma_f32_16x16x32_bf16 v[144:147], v[180:183], v[172:175], v[144:147]
  v_mfma_f32_16x16x32_bf16 v[148:151], v[184:187], v[172:175], v[148:151]
  v_mfma_f32_16x16x32_bf16 v[152:155], v[188:191], v[172:175], v[152:155]
  v_mfma_f32_16x16x32_bf16 v[156:159], v[192:195], v[172:175], v[156:159]
  s_mul_i32 s22, s20, 5120
  s_add_u32 s22, s22, s50
  s_add_u32 s22, s22, 16384
  s_add_u32 m0, s22, 0
  s_nop 0
  buffer_load_dwordx4 v74, s[8:11], s49 offen lds
  s_add_u32 m0, s22, 1024
  s_nop 0
  buffer_load_dwordx4 v75, s[8:11], s49 offen lds
  s_add_u32 m0, s22, 2048
  s_nop 0
  buffer_load_dwordx4 v76, s[8:11], s49 offen lds
  s_add_u32 m0, s22, 3072
  s_nop 0
  buffer_load_dwordx4 v77, s[8:11], s49 offen lds
  s_add_u32 m0, s22, 4096
  s_nop 0
  buffer_load_dwordx4 v78, s[8:11], s49 offen lds
  s_add_u32 s48, s48, 2048
  s_min_u32 s48, s48, s53
  s_add_u32 s49, s49, 245760
  s_add_u32 s50, s50, 36864
  s_cmp_lt_u32 s50, 147456
  s_cselect_b32 s50, s50, 0
  s_waitcnt lgkmcnt(0)
  v_mfma_f32_16x16x32_bf16 v[80:83], v[212:215], v[196:199], v[80:83]
  v_mfma_f32_16x16x32_bf16 v[84:87], v[216:219], v[196:199], v[84:87]
  v_mfma_f32_16x16x32_bf16 v[88:91], v[220:223], v[196:199], v[88:91]
  v_mfma_f32_16x16x32_bf16 v[92:95], v[224:227], v[196:199], v[92:95]
  v_mfma_f32_16x16x32_bf16 v[96:99], v[228:231], v[196:199], v[96:99]
  v_mfma_f32_16x16x32_bf16 v[100:103], v[212:215], v[200:203], v[100:103]
  v_mfma_f32_16x16x32_bf16 v[104:107], v[216:219], v[200:203], v[104:107]
  v_mfma_f32_16x16x32_bf16 v[108:111], v[220:223], v[200:203], v[108:111]
  v_mfma_f32_16x16x32_bf16 v[112:115], v[224:227], v[200:203], v[112:115]
  v_mfma_f32_16x16x32_bf16 v[116:119], v[228:231], v[200:203], v[116:119]
  v_mfma_f32_16x16x32_bf16 v[120:123], v[212:215], v[204:207], v[120:123]
  v_mfma_f32_16x16x32_bf16 v[124:127], v[216:219], v[204:207], v[124:127]
  v_mfma_f32_16x16x32_bf16 v[128:131], v[220:223], v[204:207], v[128:131]
  v_mfma_f32_16x16x32_bf16 v[132:135], v[224:227], v[204:207], v[132:135]
  v_mfma_f32_16x16x32_bf16 v[136:139], v[228:231], v[204:207], v[136:139]
  v_mfma_f32_16x16x32_bf16 v[140:143], v[212:215], v[208:211], v[140:143]
  v_mfma_f32_16x16x32_bf16 v[144:147], v[216:219], v[208:211], v[144:147]
  v_mfma_f32_16x16x32_bf16 v[148:151], v[220:223], v[208:211], v[148:151]
  v_mfma_f32_16x16x32_bf16 v[152:155], v[224:227], v[208:211], v[152:155]
  v_mfma_f32_16x16x32_bf16 v[156:159], v[228:231], v[208:211], v[156:159]
  s_add_u32 s52, s52, 1
  s_cmp_ge_u32 s52, s44
  s_cbranch_scc1 opd_335
  s_branch op_334
opd_335:
  s_nop 7
  s_lshl_b32 s21, s40, 3
  s_lshr_b32 s22, s20, 1
  s_lshl_b32 s22, s22, 2
  s_add_u32 s21, s21, s22
  s_mul_i32 s21, s21, 40960
  s_mul_i32 s22, s42, 10
  s_and_b32 s23, s20, 1
  s_mul_i32 s23, s23, 5
  s_add_u32 s22, s22, s23
  s_lshl_b32 s22, s22, 10
  s_add_u32 s21, s21, s22
  buffer_store_dwordx4 v[80:83], v4, s[16:19], s21 offen offset:0 sc1
  buffer_store_dwordx4 v[84:87], v4, s[16:19], s21 offen offset:1024 sc1
  buffer_store_dwordx4 v[88:91], v4, s[16:19], s21 offen offset:2048 sc1
  buffer_store_dwordx4 v[92:95], v4, s[16:19], s21 offen offset:3072 sc1
  s_add_u32 s22, s21, 4096
  buffer_store_dwordx4 v[96:99], v4, s[16:19], s22 offen offset:0 sc1
  s_add_u32 s21, s21, 40960
  buffer_store_dwordx4 v[100:103], v4, s[16:19], s21 offen offset:0 sc1
  buffer_store_dwordx4 v[104:107], v4, s[16:19], s21 offen offset:1024 sc1
  buffer_store_dwordx4 v[108:111], v4, s[16:19], s21 offen offset:2048 sc1
  buffer_store_dwordx4 v[112:115], v4, s[16:19], s21 offen offset:3072 sc1
  s_add_u32 s22, s21, 4096
  buffer_store_dwordx4 v[116:119], v4, s[16:19], s22 offen offset:0 sc1
  s_add_u32 s21, s21, 40960
  buffer_store_dwordx4 v[120:123], v4, s[16:19], s21 offen offset:0 sc1
  buffer_store_dwordx4 v[124:127], v4, s[16:19], s21 offen offset:1024 sc1
  buffer_store_dwordx4 v[128:131], v4, s[16:19], s21 offen offset:2048 sc1
  buffer_store_dwordx4 v[132:135], v4, s[16:19], s21 offen offset:3072 sc1
  s_add_u32 s22, s21, 4096
  buffer_store_dwordx4 v[136:139], v4, s[16:19], s22 offen offset:0 sc1
  s_add_u32 s21, s21, 40960
  buffer_store_dwordx4 v[140:143], v4, s[16:19], s21 offen offset:0 sc1
  buffer_store_dwordx4 v[144:147], v4, s[16:19], s21 offen offset:1024 sc1
  buffer_store_dwordx4 v[148:151], v4, s[16:19], s21 offen offset:2048 sc1
  buffer_store_dwordx4 v[152:155], v4, s[16:19], s21 offen offset:3072 sc1
  s_add_u32 s22, s21, 4096
  buffer_store_dwordx4 v[156:159], v4, s[16:19], s22 offen offset:0 sc1
  s_add_u32 s21, s21, 40960
  s_waitcnt vmcnt(0)
  s_barrier
  s_lshl_b32 s21, s40, 7
  s_add_u32 s21, s21, 92160
  s_cmp_lg_u32 s20, 0
  s_cbranch_scc1 af_336
  v_mov_b32 v10, 0
  v_mov_b32 v11, 1
  s_mov_b64 exec, 1
  buffer_atomic_add v11, v10, s[72:75], s21 offen sc1
  s_mov_b64 exec, -1
  s_nop 1
af_336:
  s_branch queue
do_pv:
  s_mov_b32 s2, s21
  s_load_dwordx2 s[4:5], s[0:1], 88
  s_load_dwordx2 s[38:39], s[0:1], 104
  s_waitcnt lgkmcnt(0)
  s_mov_b32 s8, s4
  s_mov_b32 s9, s5
  s_mov_b32 s10, 2621440
  s_mov_b32 s11, 0x00020000
  s_add_u32 s12, s38, 114294784
  s_addc_u32 s13, s39, 0
  s_mov_b32 s14, 83886080
  s_mov_b32 s15, 0x00020000
  s_mov_b32 s59, 0
  s_mov_b32 s60, 0
  s_add_u32 s16, s38, 85983232
  s_addc_u32 s17, s39, 0
  s_mov_b32 s18, 28311552
  s_mov_b32 s19, 0x00020000
  s_add_u32 s24, s38, 73400320
  s_addc_u32 s25, s39, 0
  s_mov_b32 s26, 5242880
  s_mov_b32 s27, 0x00020000
  s_add_u32 s28, s38, 81002496
  s_addc_u32 s29, s39, 0
  s_mov_b32 s30, 8192
  s_mov_b32 s31, 0x00020000
  s_add_u32 s72, s38, 81068032
  s_addc_u32 s73, s39, 0
  s_mov_b32 s74, 115712
  s_mov_b32 s75, 0x00020000
  v_lshlrev_b32 v4, 4, v1
  v_lshlrev_b32 v5, 3, v1
  v_lshlrev_b32 v6, 2, v2
  v_and_b32 v7, 7, v1
  v_lshlrev_b32 v7, 7, v7
  v_lshrrev_b32 v31, 3, v1
  v_lshl_add_u32 v208, v31, 10, v7
  v_bfe_u32 v31, v1, 3, 2
  v_lshl_add_u32 v31, v31, 2, v7
  s_lshl_b32 s21, s20, 10
  s_add_u32 s21, s21, 94208
  buffer_load_dword v8, v31, s[72:75], s21 offen sc1
  v_lshlrev_b32 v25, 7, v2
  s_mov_b32 s21, 92160
  buffer_load_dword v26, v25, s[72:75], s21 offen sc1
  s_mov_b32 s63, 1
  v_mul_u32_u24 v9, 1280, v2
  v_lshl_add_u32 v9, v3, 3, v9
  s_lshl_b32 s21, s20, 13
  v_add_u32 v10, s21, v4
  s_lshl_b32 s21, s20, 10
  v_add_u32 v11, s21, v4
  v_lshrrev_b32 v20, 5, v1
  v_mul_u32_u24 v21, 2560, v20
  v_add_u32 v21, v21, v4
  v_and_b32 v22, 31, v1
  v_lshlrev_b32 v22, 4, v22
  v_mul_u32_u24 v20, 10240, v20
  v_add_u32 v22, v22, v20
  v_mov_b32 v28, 80
  v_mov_b32 v30, 32768
  s_mov_b32 s50, 0
  s_mov_b32 s51, 0
  s_and_b32 s43, s20, 1
  s_lshr_b32 s44, s20, 1
  v_mov_b32 v70, 0
  v_mov_b32 v71, 0
  v_mov_b32 v78, 0
  v_mov_b32 v79, 0
  v_mov_b32 v86, 0
  v_mov_b32 v87, 0
  v_mov_b32 v94, 0
  v_mov_b32 v95, 0
  v_mov_b32 v102, 0
  v_mov_b32 v103, 0
  v_mov_b32 v110, 0
  v_mov_b32 v111, 0
  v_mov_b32 v118, 0
  v_mov_b32 v119, 0
  v_mov_b32 v126, 0
  v_mov_b32 v127, 0
  s_mov_b32 s21, s2
pv_loop:
  s_mov_b32 s2, s21
  s_mul_hi_u32 s40, s2, 0x1999999a
  s_mul_i32 s21, s40, 10
  s_sub_u32 s41, s2, s21
  s_lshl_b32 s52, s40, 10
  s_add_u32 s52, s52, 22528
  buffer_load_dword v27, v7, s[72:75], s52 offen sc1
  s_cmp_lg_u32 s20, 0
  s_cbranch_scc1 pv_345

  v_mov_b32 v29, 1
  s_mov_b64 exec, 1
  buffer_atomic_add v29, v28, s[32:35], 0 offen sc0 sc1
  s_mov_b64 exec, -1
pv_345:
  s_lshl_b32 s42, s40, 5
  s_lshl_b32 s21, s20, 3
  s_add_u32 s42, s42, s21
  s_mul_i32 s61, s21, 5
  s_lshr_b32 s22, s41, 1
  s_add_u32 s61, s61, s22
  s_and_b32 s62, s41, 1
  s_lshl_b32 s62, s62, 12
  s_mul_i32 s53, s42, 40960
  s_lshl_b32 s22, s41, 12
  s_add_u32 s53, s53, s22
  s_lshl_b32 s21, s40, 1
  s_add_u32 s21, s21, s43
  s_lshl_b32 s45, s21, 6
  s_mul_i32 s46, s21, 20480
  s_mul_i32 s21, s21, 40
  s_lshl_b32 s22, s41, 2
  s_add_u32 s22, s22, s44
  s_add_u32 s21, s21, s22
  s_lshl_b32 s54, s21, 10
  s_lshl_b32 s22, s22, 5
  s_add_u32 s46, s46, s22
  s_mul_i32 s47, s42, 2560
  s_mul_i32 s48, s42, 10240
  s_lshl_b32 s22, s41, 10
  s_add_u32 s48, s48, s22
  s_add_u32 s48, s48, 7340032
  s_add_u32 s23, s40, 1
  s_cmp_ge_u32 s50, s23
  s_cbranch_scc1 pv_338
  s_cmp_eq_u32 s63, 0
  s_cbranch_scc1 pv_341
  s_mov_b32 s63, 0
  s_waitcnt vmcnt(1)
  v_cmp_le_u32 vcc, 4, v26
  s_mov_b32 s51, vcc_lo
  v_cmp_gt_u32 vcc, s23, v8
  s_nop 1
  s_cbranch_vccz pv_342
pv_341:
  s_lshl_b32 s21, s20, 10
  s_add_u32 s21, s21, 94208
  s_mov_b32 s101, 0
wm_346:
  buffer_load_dword v8, v31, s[72:75], s21 offen sc1
  s_add_u32 s101, s101, 1
  s_cmp_gt_u32 s101, 131072
  s_cbranch_scc1 main_end
  s_waitcnt vmcnt(0)
  v_cmp_gt_u32 vcc, s23, v8
  v_readfirstlane_b32 s100, v8
  s_nop 0
  s_cbranch_vccz wm_347
  s_sleep 8
  s_add_u32 s100, s100, 2
  s_cmp_ge_u32 s100, s23
  s_cbranch_scc1 wm_346
  s_sleep 60
  s_branch wm_346
wm_347:
pv_342:
  v_readlane_b32 s50, v8, 0
  v_readlane_b32 s21, v8, 1
  s_min_u32 s50, s50, s21
  v_readlane_b32 s21, v8, 2
  s_min_u32 s50, s50, s21
  v_readlane_b32 s21, v8, 3
  s_min_u32 s50, s50, s21
  v_readlane_b32 s21, v8, 4
  s_min_u32 s50, s50, s21
  v_readlane_b32 s21, v8, 5
  s_min_u32 s50, s50, s21
  v_readlane_b32 s21, v8, 6
  s_min_u32 s50, s50, s21
  v_readlane_b32 s21, v8, 7
  s_min_u32 s50, s50, s21
  v_readlane_b32 s21, v8, 8
  s_min_u32 s50, s50, s21
  v_readlane_b32 s21, v8, 9
  s_min_u32 s50, s50, s21
  v_readlane_b32 s21, v8, 10
  s_min_u32 s50, s50, s21
  v_readlane_b32 s21, v8, 11
  s_min_u32 s50, s50, s21
  v_readlane_b32 s21, v8, 12
  s_min_u32 s50, s50, s21
  v_readlane_b32 s21, v8, 13
  s_min_u32 s50, s50, s21
  v_readlane_b32 s21, v8, 14
  s_min_u32 s50, s50, s21
  v_readlane_b32 s21, v8, 15
  s_min_u32 s50, s50, s21
  v_readlane_b32 s21, v8, 16
  s_min_u32 s50, s50, s21
  v_readlane_b32 s21, v8, 17
  s_min_u32 s50, s50, s21
  v_readlane_b32 s21, v8, 18
  s_min_u32 s50, s50, s21
  v_readlane_b32 s21, v8, 19
  s_min_u32 s50, s50, s21
  v_readlane_b32 s21, v8, 20
  s_min_u32 s50, s50, s21
  v_readlane_b32 s21, v8, 21
  s_min_u32 s50, s50, s21
  v_readlane_b32 s21, v8, 22
  s_min_u32 s50, s50, s21
  v_readlane_b32 s21, v8, 23
  s_min_u32 s50, s50, s21
  v_readlane_b32 s21, v8, 24
  s_min_u32 s50, s50, s21
  v_readlane_b32 s21, v8, 25
  s_min_u32 s50, s50, s21
  v_readlane_b32 s21, v8, 26
  s_min_u32 s50, s50, s21
  v_readlane_b32 s21, v8, 27
  s_min_u32 s50, s50, s21
  v_readlane_b32 s21, v8, 28
  s_min_u32 s50, s50, s21
  v_readlane_b32 s21, v8, 29
  s_min_u32 s50, s50, s21
  v_readlane_b32 s21, v8, 30
  s_min_u32 s50, s50, s21
  v_readlane_b32 s21, v8, 31
  s_min_u32 s50, s50, s21
pv_338:
  s_lshr_b32 s22, s40, 2
  s_cmp_lt_u32 s40, 0
  s_cbranch_scc1 pv_339
  s_bitcmp1_b32 s51, s22
  s_cbranch_scc1 pv_339
  s_mov_b32 s21, 92160
  v_lshlrev_b32 v25, 7, v2
  s_mov_b32 s101, 0
pv_340:
  buffer_load_dword v26, v25, s[72:75], s21 offen sc1
  s_add_u32 s101, s101, 1
  s_cmp_gt_u32 s101, 131072
  s_cbranch_scc1 main_end
  s_waitcnt vmcnt(0)
  v_cmp_le_u32 vcc, 4, v26
  s_mov_b32 s51, vcc_lo
  s_bitcmp1_b32 s51, s22
  s_cbranch_scc1 pv_339
  s_sleep 8
  s_branch pv_340
pv_339:
  buffer_load_dwordx4 a[0:3], v4, s[12:15], s53 offen offset:0 sc1
  buffer_load_dwordx4 a[4:7], v4, s[12:15], s53 offen offset:1024 sc1
  buffer_load_dwordx4 a[8:11], v4, s[12:15], s53 offen offset:2048 sc1
  buffer_load_dwordx4 a[12:15], v4, s[12:15], s53 offen offset:3072 sc1
  s_add_u32 s53, s53, 40960
  buffer_load_dwordx4 a[16:19], v4, s[12:15], s53 offen offset:0 sc1
  buffer_load_dwordx4 a[20:23], v4, s[12:15], s53 offen offset:1024 sc1
  buffer_load_dwordx4 a[24:27], v4, s[12:15], s53 offen offset:2048 sc1
  buffer_load_dwordx4 a[28:31], v4, s[12:15], s53 offen offset:3072 sc1
  s_add_u32 s53, s53, 40960
  buffer_load_dwordx4 a[32:35], v4, s[12:15], s53 offen offset:0 sc1
  buffer_load_dwordx4 a[36:39], v4, s[12:15], s53 offen offset:1024 sc1
  buffer_load_dwordx4 a[40:43], v4, s[12:15], s53 offen offset:2048 sc1
  buffer_load_dwordx4 a[44:47], v4, s[12:15], s53 offen offset:3072 sc1
  s_add_u32 s53, s53, 40960
  buffer_load_dwordx4 a[48:51], v4, s[12:15], s53 offen offset:0 sc1
  buffer_load_dwordx4 a[52:55], v4, s[12:15], s53 offen offset:1024 sc1
  buffer_load_dwordx4 a[56:59], v4, s[12:15], s53 offen offset:2048 sc1
  buffer_load_dwordx4 a[60:63], v4, s[12:15], s53 offen offset:3072 sc1
  s_add_u32 s53, s53, 40960
  buffer_load_dwordx4 a[64:67], v4, s[12:15], s53 offen offset:0 sc1
  buffer_load_dwordx4 a[68:71], v4, s[12:15], s53 offen offset:1024 sc1
  buffer_load_dwordx4 a[72:75], v4, s[12:15], s53 offen offset:2048 sc1
  buffer_load_dwordx4 a[76:79], v4, s[12:15], s53 offen offset:3072 sc1
  s_add_u32 s53, s53, 40960
  buffer_load_dwordx4 a[80:83], v4, s[12:15], s53 offen offset:0 sc1
  buffer_load_dwordx4 a[84:87], v4, s[12:15], s53 offen offset:1024 sc1
  buffer_load_dwordx4 a[88:91], v4, s[12:15], s53 offen offset:2048 sc1
  buffer_load_dwordx4 a[92:95], v4, s[12:15], s53 offen offset:3072 sc1
  s_add_u32 s53, s53, 40960
  buffer_load_dwordx4 a[96:99], v4, s[12:15], s53 offen offset:0 sc1
  buffer_load_dwordx4 a[100:103], v4, s[12:15], s53 offen offset:1024 sc1
  buffer_load_dwordx4 a[104:107], v4, s[12:15], s53 offen offset:2048 sc1
  buffer_load_dwordx4 a[108:111], v4, s[12:15], s53 offen offset:3072 sc1
  s_add_u32 s53, s53, 40960
  buffer_load_dwordx4 a[112:115], v4, s[12:15], s53 offen offset:0 sc1
  buffer_load_dwordx4 a[116:119], v4, s[12:15], s53 offen offset:1024 sc1
  buffer_load_dwordx4 a[120:123], v4, s[12:15], s53 offen offset:2048 sc1
  buffer_load_dwordx4 a[124:127], v4, s[12:15], s53 offen offset:3072 sc1
  buffer_load_dwordx4 v[12:15], v4, s[24:27], s54 offen sc1
  buffer_load_dwordx4 v[16:19], v4, s[24:27], s54 offen offset:2048 sc1
  buffer_load_dword v24, v6, s[28:31], s45 offen sc1
  s_waitcnt vmcnt(35)
  v_cmp_le_u32 s[68:69], 20, v27
  s_nop 1
  s_and_b32 s21, s68, 255
  s_cmp_lg_u32 s21, 255
  s_cbranch_scc1 pvw_343
  buffer_load_dwordx4 v[64:67], v4, s[16:19], s47 offen sc1
  buffer_load_dwordx2 v[68:69], v5, s[16:19], s47 offen offset:2048 sc1
  buffer_load_dwordx4 v[128:131], v21, s[16:19], s47 offen offset:1024 sc1
  s_add_u32 s47, s47, 2560
  buffer_load_dwordx4 v[72:75], v4, s[16:19], s47 offen sc1
  buffer_load_dwordx2 v[76:77], v5, s[16:19], s47 offen offset:2048 sc1
  s_add_u32 s47, s47, 2560
  buffer_load_dwordx4 v[80:83], v4, s[16:19], s47 offen sc1
  buffer_load_dwordx2 v[84:85], v5, s[16:19], s47 offen offset:2048 sc1
  buffer_load_dwordx4 v[132:135], v21, s[16:19], s47 offen offset:1024 sc1
  s_add_u32 s47, s47, 2560
  buffer_load_dwordx4 v[88:91], v4, s[16:19], s47 offen sc1
  buffer_load_dwordx2 v[92:93], v5, s[16:19], s47 offen offset:2048 sc1
  s_add_u32 s47, s47, 2560
  buffer_load_dwordx4 v[32:35], v22, s[16:19], s48 offen offset:0 sc1
  buffer_load_dwordx4 v[40:43], v22, s[16:19], s48 offen offset:512 sc1
  s_add_u32 s48, s48, 20480
  buffer_load_dwordx4 v[36:39], v22, s[16:19], s48 offen offset:0 sc1
  buffer_load_dwordx4 v[44:47], v22, s[16:19], s48 offen offset:512 sc1
  s_add_u32 s48, s48, 20480
  buffer_load_dwordx4 v[96:99], v4, s[16:19], s47 offen sc1
  buffer_load_dwordx2 v[100:101], v5, s[16:19], s47 offen offset:2048 sc1
  buffer_load_dwordx4 v[136:139], v21, s[16:19], s47 offen offset:1024 sc1
  s_add_u32 s47, s47, 2560
  buffer_load_dwordx4 v[104:107], v4, s[16:19], s47 offen sc1
  buffer_load_dwordx2 v[108:109], v5, s[16:19], s47 offen offset:2048 sc1
  s_add_u32 s47, s47, 2560
  buffer_load_dwordx4 v[112:115], v4, s[16:19], s47 offen sc1
  buffer_load_dwordx2 v[116:117], v5, s[16:19], s47 offen offset:2048 sc1
  buffer_load_dwordx4 v[140:143], v21, s[16:19], s47 offen offset:1024 sc1
  s_add_u32 s47, s47, 2560
  buffer_load_dwordx4 v[120:123], v4, s[16:19], s47 offen sc1
  buffer_load_dwordx2 v[124:125], v5, s[16:19], s47 offen offset:2048 sc1
  s_add_u32 s47, s47, 2560
  buffer_load_dwordx4 v[48:51], v22, s[16:19], s48 offen offset:0 sc1
  buffer_load_dwordx4 v[56:59], v22, s[16:19], s48 offen offset:512 sc1
  s_add_u32 s48, s48, 20480
  buffer_load_dwordx4 v[52:55], v22, s[16:19], s48 offen offset:0 sc1
  buffer_load_dwordx4 v[60:63], v22, s[16:19], s48 offen offset:512 sc1
  s_add_u32 s48, s48, 20480
  s_barrier
  s_waitcnt vmcnt(28)
  v_sub_f32 v25, 1.0, v24
  v_cvt_pk_bf16_f32 v26, v25, v25
  v_lshlrev_b32 v25, 16, v26
  v_cvt_pk_bf16_f32 v26, v12, v12
  v_lshlrev_b32 v12, 16, v26
  v_cvt_pk_bf16_f32 v26, v13, v13
  v_lshlrev_b32 v13, 16, v26
  v_cvt_pk_bf16_f32 v26, v14, v14
  v_lshlrev_b32 v14, 16, v26
  v_cvt_pk_bf16_f32 v26, v15, v15
  v_lshlrev_b32 v15, 16, v26
  v_cvt_pk_bf16_f32 v26, v16, v16
  v_lshlrev_b32 v16, 16, v26
  v_cvt_pk_bf16_f32 v26, v17, v17
  v_lshlrev_b32 v17, 16, v26
  v_cvt_pk_bf16_f32 v26, v18, v18
  v_lshlrev_b32 v18, 16, v26
  v_cvt_pk_bf16_f32 v26, v19, v19
  v_lshlrev_b32 v19, 16, v26
  v_mul_f32 v12, v12, v25
  v_cvt_pk_bf16_f32 v26, v12, v12
  v_lshlrev_b32 v12, 16, v26
  v_mul_f32 v13, v13, v25
  v_cvt_pk_bf16_f32 v26, v13, v13
  v_lshlrev_b32 v13, 16, v26
  v_mul_f32 v14, v14, v25
  v_cvt_pk_bf16_f32 v26, v14, v14
  v_lshlrev_b32 v14, 16, v26
  v_mul_f32 v15, v15, v25
  v_cvt_pk_bf16_f32 v26, v15, v15
  v_lshlrev_b32 v15, 16, v26
  v_mul_f32 v16, v16, v25
  v_cvt_pk_bf16_f32 v26, v16, v16
  v_lshlrev_b32 v16, 16, v26
  v_mul_f32 v17, v17, v25
  v_cvt_pk_bf16_f32 v26, v17, v17
  v_lshlrev_b32 v17, 16, v26
  v_mul_f32 v18, v18, v25
  v_cvt_pk_bf16_f32 v26, v18, v18
  v_lshlrev_b32 v18, 16, v26
  v_mul_f32 v19, v19, v25
  v_cvt_pk_bf16_f32 v26, v19, v19
  v_lshlrev_b32 v19, 16, v26
  s_branch pvg_348
pvw_343:
  s_waitcnt vmcnt(0)
  v_sub_f32 v25, 1.0, v24
  v_cvt_pk_bf16_f32 v26, v25, v25
  v_lshlrev_b32 v25, 16, v26
  v_cvt_pk_bf16_f32 v26, v12, v12
  v_lshlrev_b32 v12, 16, v26
  v_cvt_pk_bf16_f32 v26, v13, v13
  v_lshlrev_b32 v13, 16, v26
  v_cvt_pk_bf16_f32 v26, v14, v14
  v_lshlrev_b32 v14, 16, v26
  v_cvt_pk_bf16_f32 v26, v15, v15
  v_lshlrev_b32 v15, 16, v26
  v_cvt_pk_bf16_f32 v26, v16, v16
  v_lshlrev_b32 v16, 16, v26
  v_cvt_pk_bf16_f32 v26, v17, v17
  v_lshlrev_b32 v17, 16, v26
  v_cvt_pk_bf16_f32 v26, v18, v18
  v_lshlrev_b32 v18, 16, v26
  v_cvt_pk_bf16_f32 v26, v19, v19
  v_lshlrev_b32 v19, 16, v26
  v_mul_f32 v12, v12, v25
  v_cvt_pk_bf16_f32 v26, v12, v12
  v_lshlrev_b32 v12, 16, v26
  v_mul_f32 v13, v13, v25
  v_cvt_pk_bf16_f32 v26, v13, v13
  v_lshlrev_b32 v13, 16, v26
  v_mul_f32 v14, v14, v25
  v_cvt_pk_bf16_f32 v26, v14, v14
  v_lshlrev_b32 v14, 16, v26
  v_mul_f32 v15, v15, v25
  v_cvt_pk_bf16_f32 v26, v15, v15
  v_lshlrev_b32 v15, 16, v26
  v_mul_f32 v16, v16, v25
  v_cvt_pk_bf16_f32 v26, v16, v16
  v_lshlrev_b32 v16, 16, v26
  v_mul_f32 v17, v17, v25
  v_cvt_pk_bf16_f32 v26, v17, v17
  v_lshlrev_b32 v17, 16, v26
  v_mul_f32 v18, v18, v25
  v_cvt_pk_bf16_f32 v26, v18, v18
  v_lshlrev_b32 v18, 16, v26
  v_mul_f32 v19, v19, v25
  v_cvt_pk_bf16_f32 v26, v19, v19
  v_lshlrev_b32 v19, 16, v26
  s_cmp_ge_u32 s40, 56
  s_cbranch_scc1 pvt_349
  s_cmp_lg_u32 s20, 0
  s_cbranch_scc1 wm_351
  s_mov_b32 s101, 0
wm_350:
  buffer_load_dword v26, v7, s[72:75], s52 offen sc1
  s_add_u32 s101, s101, 1
  s_cmp_gt_u32 s101, 131072
  s_cbranch_scc1 main_end
  s_waitcnt vmcnt(0)
  v_cmp_gt_u32 vcc, 20, v26
  v_readfirstlane_b32 s100, v26
  s_nop 0
  s_cbranch_vccz wm_351
  s_sleep 2
  s_add_u32 s100, s100, 19
  s_cmp_ge_u32 s100, 20
  s_cbranch_scc1 wm_350
  s_sleep 24
  s_branch wm_350
wm_351:
  s_barrier
  buffer_load_dwordx4 v[64:67], v4, s[16:19], s47 offen sc1
  buffer_load_dwordx2 v[68:69], v5, s[16:19], s47 offen offset:2048 sc1
  buffer_load_dwordx4 v[128:131], v21, s[16:19], s47 offen offset:1024 sc1
  s_add_u32 s47, s47, 2560
  buffer_load_dwordx4 v[72:75], v4, s[16:19], s47 offen sc1
  buffer_load_dwordx2 v[76:77], v5, s[16:19], s47 offen offset:2048 sc1
  s_add_u32 s47, s47, 2560
  buffer_load_dwordx4 v[80:83], v4, s[16:19], s47 offen sc1
  buffer_load_dwordx2 v[84:85], v5, s[16:19], s47 offen offset:2048 sc1
  buffer_load_dwordx4 v[132:135], v21, s[16:19], s47 offen offset:1024 sc1
  s_add_u32 s47, s47, 2560
  buffer_load_dwordx4 v[88:91], v4, s[16:19], s47 offen sc1
  buffer_load_dwordx2 v[92:93], v5, s[16:19], s47 offen offset:2048 sc1
  s_add_u32 s47, s47, 2560
  buffer_load_dwordx4 v[32:35], v22, s[16:19], s48 offen offset:0 sc1
  buffer_load_dwordx4 v[40:43], v22, s[16:19], s48 offen offset:512 sc1
  s_add_u32 s48, s48, 20480
  buffer_load_dwordx4 v[36:39], v22, s[16:19], s48 offen offset:0 sc1
  buffer_load_dwordx4 v[44:47], v22, s[16:19], s48 offen offset:512 sc1
  s_add_u32 s48, s48, 20480
  buffer_load_dwordx4 v[96:99], v4, s[16:19], s47 offen sc1
  buffer_load_dwordx2 v[100:101], v5, s[16:19], s47 offen offset:2048 sc1
  buffer_load_dwordx4 v[136:139], v21, s[16:19], s47 offen offset:1024 sc1
  s_add_u32 s47, s47, 2560
  buffer_load_dwordx4 v[104:107], v4, s[16:19], s47 offen sc1
  buffer_load_dwordx2 v[108:109], v5, s[16:19], s47 offen offset:2048 sc1
  s_add_u32 s47, s47, 2560
  buffer_load_dwordx4 v[112:115], v4, s[16:19], s47 offen sc1
  buffer_load_dwordx2 v[116:117], v5, s[16:19], s47 offen offset:2048 sc1
  buffer_load_dwordx4 v[140:143], v21, s[16:19], s47 offen offset:1024 sc1
  s_add_u32 s47, s47, 2560
  buffer_load_dwordx4 v[120:123], v4, s[16:19], s47 offen sc1
  buffer_load_dwordx2 v[124:125], v5, s[16:19], s47 offen offset:2048 sc1
  s_add_u32 s47, s47, 2560
  buffer_load_dwordx4 v[48:51], v22, s[16:19], s48 offen offset:0 sc1
  buffer_load_dwordx4 v[56:59], v22, s[16:19], s48 offen offset:512 sc1
  s_add_u32 s48, s48, 20480
  buffer_load_dwordx4 v[52:55], v22, s[16:19], s48 offen offset:0 sc1
  buffer_load_dwordx4 v[60:63], v22, s[16:19], s48 offen offset:512 sc1
  s_add_u32 s48, s48, 20480
pvg_348:
  s_waitcnt vmcnt(26)
  v_mfma_f32_16x16x32_bf16 v[148:151], a[0:3], v[64:67], 0
  v_mfma_f32_16x16x32_bf16 v[144:147], a[0:3], v[68:71], 0
  v_mfma_f32_16x16x32_bf16 v[156:159], a[4:7], v[64:67], 0
  v_mfma_f32_16x16x32_bf16 v[152:155], a[4:7], v[68:71], 0
  v_mfma_f32_16x16x32_bf16 v[164:167], a[8:11], v[64:67], 0
  v_mfma_f32_16x16x32_bf16 v[160:163], a[8:11], v[68:71], 0
  v_mfma_f32_16x16x32_bf16 v[172:175], a[12:15], v[64:67], 0
  v_mfma_f32_16x16x32_bf16 v[168:171], a[12:15], v[68:71], 0
  s_waitcnt vmcnt(23)
  v_mfma_f32_16x16x32_bf16 v[148:151], a[16:19], v[72:75], v[148:151]
  v_mfma_f32_16x16x32_bf16 v[144:147], a[16:19], v[76:79], v[144:147]
  v_mfma_f32_16x16x32_bf16 v[156:159], a[20:23], v[72:75], v[156:159]
  v_mfma_f32_16x16x32_bf16 v[152:155], a[20:23], v[76:79], v[152:155]
  v_mfma_f32_16x16x32_bf16 v[164:167], a[24:27], v[72:75], v[164:167]
  v_mfma_f32_16x16x32_bf16 v[160:163], a[24:27], v[76:79], v[160:163]
  v_mfma_f32_16x16x32_bf16 v[172:175], a[28:31], v[72:75], v[172:175]
  v_mfma_f32_16x16x32_bf16 v[168:171], a[28:31], v[76:79], v[168:171]
  s_waitcnt vmcnt(21)
  v_mfma_f32_16x16x32_bf16 v[148:151], a[32:35], v[80:83], v[148:151]
  v_mfma_f32_16x16x32_bf16 v[144:147], a[32:35], v[84:87], v[144:147]
  v_mfma_f32_16x16x32_bf16 v[156:159], a[36:39], v[80:83], v[156:159]
  v_mfma_f32_16x16x32_bf16 v[152:155], a[36:39], v[84:87], v[152:155]
  v_mfma_f32_16x16x32_bf16 v[164:167], a[40:43], v[80:83], v[164:167]
  v_mfma_f32_16x16x32_bf16 v[160:163], a[40:43], v[84:87], v[160:163]
  v_mfma_f32_16x16x32_bf16 v[172:175], a[44:47], v[80:83], v[172:175]
  v_mfma_f32_16x16x32_bf16 v[168:171], a[44:47], v[84:87], v[168:171]
  s_waitcnt vmcnt(18)
  v_mfma_f32_16x16x32_bf16 v[148:151], a[48:51], v[88:91], v[148:151]
  v_mfma_f32_16x16x32_bf16 v[144:147], a[48:51], v[92:95], v[144:147]
  v_mfma_f32_16x16x32_bf16 v[156:159], a[52:55], v[88:91], v[156:159]
  v_mfma_f32_16x16x32_bf16 v[152:155], a[52:55], v[92:95], v[152:155]
  v_mfma_f32_16x16x32_bf16 v[164:167], a[56:59], v[88:91], v[164:167]
  v_mfma_f32_16x16x32_bf16 v[160:163], a[56:59], v[92:95], v[160:163]
  v_mfma_f32_16x16x32_bf16 v[172:175], a[60:63], v[88:91], v[172:175]
  v_mfma_f32_16x16x32_bf16 v[168:171], a[60:63], v[92:95], v[168:171]
  s_waitcnt vmcnt(14)
  v_swap_b32 v130, v132
  v_swap_b32 v131, v133
  v_swap_b32 v34, v36
  v_swap_b32 v35, v37
  v_swap_b32 v42, v44
  v_swap_b32 v43, v45
  s_nop 1
  v_mfma_f32_16x16x32_bf16 v[144:147], v[32:35], v[128:131], v[144:147]
  v_mfma_f32_16x16x32_bf16 v[148:151], v[32:35], v[132:135], v[148:151]
  v_mfma_f32_16x16x32_bf16 v[152:155], v[36:39], v[128:131], v[152:155]
  v_mfma_f32_16x16x32_bf16 v[156:159], v[36:39], v[132:135], v[156:159]
  v_mfma_f32_16x16x32_bf16 v[160:163], v[40:43], v[128:131], v[160:163]
  v_mfma_f32_16x16x32_bf16 v[164:167], v[40:43], v[132:135], v[164:167]
  v_mfma_f32_16x16x32_bf16 v[168:171], v[44:47], v[128:131], v[168:171]
  v_mfma_f32_16x16x32_bf16 v[172:175], v[44:47], v[132:135], v[172:175]
  s_waitcnt vmcnt(12)
  v_mfma_f32_16x16x32_bf16 v[148:151], a[64:67], v[96:99], v[148:151]
  v_mfma_f32_16x16x32_bf16 v[144:147], a[64:67], v[100:103], v[144:147]
  v_mfma_f32_16x16x32_bf16 v[156:159], a[68:71], v[96:99], v[156:159]
  v_mfma_f32_16x16x32_bf16 v[152:155], a[68:71], v[100:103], v[152:155]
  v_mfma_f32_16x16x32_bf16 v[164:167], a[72:75], v[96:99], v[164:167]
  v_mfma_f32_16x16x32_bf16 v[160:163], a[72:75], v[100:103], v[160:163]
  v_mfma_f32_16x16x32_bf16 v[172:175], a[76:79], v[96:99], v[172:175]
  v_mfma_f32_16x16x32_bf16 v[168:171], a[76:79], v[100:103], v[168:171]
  s_waitcnt vmcnt(9)
  v_mfma_f32_16x16x32_bf16 v[148:151], a[80:83], v[104:107], v[148:151]
  v_mfma_f32_16x16x32_bf16 v[144:147], a[80:83], v[108:111], v[144:147]
  v_mfma_f32_16x16x32_bf16 v[156:159], a[84:87], v[104:107], v[156:159]
  v_mfma_f32_16x16x32_bf16 v[152:155], a[84:87], v[108:111], v[152:155]
  v_mfma_f32_16x16x32_bf16 v[164:167], a[88:91], v[104:107], v[164:167]
  v_mfma_f32_16x16x32_bf16 v[160:163], a[88:91], v[108:111], v[160:163]
  v_mfma_f32_16x16x32_bf16 v[172:175], a[92:95], v[104:107], v[172:175]
  v_mfma_f32_16x16x32_bf16 v[168:171], a[92:95], v[108:111], v[168:171]
  s_waitcnt vmcnt(7)
  v_mfma_f32_16x16x32_bf16 v[148:151], a[96:99], v[112:115], v[148:151]
  v_mfma_f32_16x16x32_bf16 v[144:147], a[96:99], v[116:119], v[144:147]
  v_mfma_f32_16x16x32_bf16 v[156:159], a[100:103], v[112:115], v[156:159]
  v_mfma_f32_16x16x32_bf16 v[152:155], a[100:103], v[116:119], v[152:155]
  v_mfma_f32_16x16x32_bf16 v[164:167], a[104:107], v[112:115], v[164:167]
  v_mfma_f32_16x16x32_bf16 v[160:163], a[104:107], v[116:119], v[160:163]
  v_mfma_f32_16x16x32_bf16 v[172:175], a[108:111], v[112:115], v[172:175]
  v_mfma_f32_16x16x32_bf16 v[168:171], a[108:111], v[116:119], v[168:171]
  s_waitcnt vmcnt(4)
  v_mfma_f32_16x16x32_bf16 v[148:151], a[112:115], v[120:123], v[148:151]
  v_mfma_f32_16x16x32_bf16 v[144:147], a[112:115], v[124:127], v[144:147]
  v_mfma_f32_16x16x32_bf16 v[156:159], a[116:119], v[120:123], v[156:159]
  v_mfma_f32_16x16x32_bf16 v[152:155], a[116:119], v[124:127], v[152:155]
  v_mfma_f32_16x16x32_bf16 v[164:167], a[120:123], v[120:123], v[164:167]
  v_mfma_f32_16x16x32_bf16 v[160:163], a[120:123], v[124:127], v[160:163]
  v_mfma_f32_16x16x32_bf16 v[172:175], a[124:127], v[120:123], v[172:175]
  v_mfma_f32_16x16x32_bf16 v[168:171], a[124:127], v[124:127], v[168:171]
  s_waitcnt vmcnt(0)
  v_swap_b32 v138, v140
  v_swap_b32 v139, v141
  v_swap_b32 v50, v52
  v_swap_b32 v51, v53
  v_swap_b32 v58, v60
  v_swap_b32 v59, v61
  s_nop 1
  v_mfma_f32_16x16x32_bf16 v[144:147], v[48:51], v[136:139], v[144:147]
  v_mfma_f32_16x16x32_bf16 v[148:151], v[48:51], v[140:143], v[148:151]
  v_mfma_f32_16x16x32_bf16 v[152:155], v[52:55], v[136:139], v[152:155]
  v_mfma_f32_16x16x32_bf16 v[156:159], v[52:55], v[140:143], v[156:159]
  v_mfma_f32_16x16x32_bf16 v[160:163], v[56:59], v[136:139], v[160:163]
  v_mfma_f32_16x16x32_bf16 v[164:167], v[56:59], v[140:143], v[164:167]
  v_mfma_f32_16x16x32_bf16 v[168:171], v[60:63], v[136:139], v[168:171]
  v_mfma_f32_16x16x32_bf16 v[172:175], v[60:63], v[140:143], v[172:175]
  s_branch pve_344
pvt_349:
  s_sub_u32 s55, s52, 1024
  s_cmp_lg_u32 s20, 0
  s_cbranch_scc1 wm_353
  s_mov_b32 s101, 0
wm_352:
  buffer_load_dword v26, v7, s[72:75], s55 offen sc1
  s_add_u32 s101, s101, 1
  s_cmp_gt_u32 s101, 131072
  s_cbranch_scc1 main_end
  s_waitcnt vmcnt(0)
  v_cmp_gt_u32 vcc, 20, v26
  v_readfirstlane_b32 s100, v26
  s_nop 0
  s_cbranch_vccz wm_353
  s_sleep 4
  s_add_u32 s100, s100, 19
  s_cmp_ge_u32 s100, 20
  s_cbranch_scc1 wm_352
  s_sleep 24
  s_branch wm_352
wm_353:
  s_barrier
  s_mov_b32 s56, s47
  s_mov_b32 s57, s48
  buffer_load_dwordx4 v[64:67], v4, s[16:19], s56 offen sc1
  buffer_load_dwordx2 v[68:69], v5, s[16:19], s56 offen offset:2048 sc1
  buffer_load_dwordx4 v[128:131], v21, s[16:19], s56 offen offset:1024 sc1
  s_add_u32 s56, s56, 2560
  buffer_load_dwordx4 v[72:75], v4, s[16:19], s56 offen sc1
  buffer_load_dwordx2 v[76:77], v5, s[16:19], s56 offen offset:2048 sc1
  s_add_u32 s56, s56, 2560
  buffer_load_dwordx4 v[80:83], v4, s[16:19], s56 offen sc1
  buffer_load_dwordx2 v[84:85], v5, s[16:19], s56 offen offset:2048 sc1
  buffer_load_dwordx4 v[132:135], v21, s[16:19], s56 offen offset:1024 sc1
  s_add_u32 s56, s56, 2560
  buffer_load_dwordx4 v[88:91], v4, s[16:19], s56 offen sc1
  buffer_load_dwordx2 v[92:93], v5, s[16:19], s56 offen offset:2048 sc1
  s_add_u32 s56, s56, 2560
  buffer_load_dwordx4 v[32:35], v22, s[16:19], s57 offen offset:0 sc1
  buffer_load_dwordx4 v[40:43], v22, s[16:19], s57 offen offset:512 sc1
  s_add_u32 s57, s57, 20480
  buffer_load_dwordx4 v[36:39], v22, s[16:19], s57 offen offset:0 sc1
  buffer_load_dwordx4 v[44:47], v22, s[16:19], s57 offen offset:512 sc1
  s_add_u32 s57, s57, 20480
  buffer_load_dwordx4 v[96:99], v4, s[16:19], s56 offen sc1
  buffer_load_dwordx2 v[100:101], v5, s[16:19], s56 offen offset:2048 sc1
  buffer_load_dwordx4 v[136:139], v21, s[16:19], s56 offen offset:1024 sc1
  s_add_u32 s56, s56, 2560
  buffer_load_dwordx4 v[104:107], v4, s[16:19], s56 offen sc1
  buffer_load_dwordx2 v[108:109], v5, s[16:19], s56 offen offset:2048 sc1
  s_add_u32 s56, s56, 2560
  buffer_load_dwordx4 v[112:115], v4, s[16:19], s56 offen sc1
  buffer_load_dwordx2 v[116:117], v5, s[16:19], s56 offen offset:2048 sc1
  buffer_load_dwordx4 v[140:143], v21, s[16:19], s56 offen offset:1024 sc1
  s_add_u32 s56, s56, 2560
  buffer_load_dwordx4 v[120:123], v4, s[16:19], s56 offen sc1
  buffer_load_dwordx2 v[124:125], v5, s[16:19], s56 offen offset:2048 sc1
  s_add_u32 s56, s56, 2560
  buffer_load_dwordx4 v[48:51], v22, s[16:19], s57 offen offset:0 sc1
  buffer_load_dwordx4 v[56:59], v22, s[16:19], s57 offen offset:512 sc1
  s_add_u32 s57, s57, 20480
  buffer_load_dwordx4 v[52:55], v22, s[16:19], s57 offen offset:0 sc1
  buffer_load_dwordx4 v[60:63], v22, s[16:19], s57 offen offset:512 sc1
  s_add_u32 s57, s57, 20480
  s_mov_b32 s101, 0
  s_waitcnt vmcnt(14)
  s_branch pvr_355
pvr_354:
  s_sleep 2
  s_add_u32 s56, s47, 0
  s_add_u32 s57, s48, 0
  buffer_load_dwordx4 v[64:67], v4, s[16:19], s56 offen sc1
  buffer_load_dwordx2 v[68:69], v5, s[16:19], s56 offen offset:2048 sc1
  buffer_load_dwordx4 v[128:131], v21, s[16:19], s56 offen offset:1024 sc1
  s_add_u32 s56, s56, 2560
  buffer_load_dwordx4 v[72:75], v4, s[16:19], s56 offen sc1
  buffer_load_dwordx2 v[76:77], v5, s[16:19], s56 offen offset:2048 sc1
  s_add_u32 s56, s56, 2560
  buffer_load_dwordx4 v[80:83], v4, s[16:19], s56 offen sc1
  buffer_load_dwordx2 v[84:85], v5, s[16:19], s56 offen offset:2048 sc1
  buffer_load_dwordx4 v[132:135], v21, s[16:19], s56 offen offset:1024 sc1
  s_add_u32 s56, s56, 2560
  buffer_load_dwordx4 v[88:91], v4, s[16:19], s56 offen sc1
  buffer_load_dwordx2 v[92:93], v5, s[16:19], s56 offen offset:2048 sc1
  s_add_u32 s56, s56, 2560
  buffer_load_dwordx4 v[32:35], v22, s[16:19], s57 offen offset:0 sc1
  buffer_load_dwordx4 v[40:43], v22, s[16:19], s57 offen offset:512 sc1
  s_add_u32 s57, s57, 20480
  buffer_load_dwordx4 v[36:39], v22, s[16:19], s57 offen offset:0 sc1
  buffer_load_dwordx4 v[44:47], v22, s[16:19], s57 offen offset:512 sc1
  s_add_u32 s57, s57, 20480
  s_add_u32 s101, s101, 1
  s_cmp_gt_u32 s101, 131072
  s_cbranch_scc1 main_end
  s_waitcnt vmcnt(0)
pvr_355:
  v_max3_u32 v26, v64, v68, v72
  v_max3_u32 v26, v26, v76, v80
  v_max3_u32 v26, v26, v84, v88
  v_max3_u32 v26, v26, v92, v128
  v_max3_u32 v26, v26, v132, v32
  v_max3_u32 v26, v26, v36, v40
  v_max3_u32 v26, v26, v44, v44
  v_cmp_eq_u32 vcc, -1, v26
  s_nop 1
  s_cbranch_vccnz pvr_354
  v_mfma_f32_16x16x32_bf16 v[148:151], a[0:3], v[64:67], 0
  v_mfma_f32_16x16x32_bf16 v[144:147], a[0:3], v[68:71], 0
  v_mfma_f32_16x16x32_bf16 v[156:159], a[4:7], v[64:67], 0
  v_mfma_f32_16x16x32_bf16 v[152:155], a[4:7], v[68:71], 0
  v_mfma_f32_16x16x32_bf16 v[164:167], a[8:11], v[64:67], 0
  v_mfma_f32_16x16x32_bf16 v[160:163], a[8:11], v[68:71], 0
  v_mfma_f32_16x16x32_bf16 v[172:175], a[12:15], v[64:67], 0
  v_mfma_f32_16x16x32_bf16 v[168:171], a[12:15], v[68:71], 0
  v_mfma_f32_16x16x32_bf16 v[148:151], a[16:19], v[72:75], v[148:151]
  v_mfma_f32_16x16x32_bf16 v[144:147], a[16:19], v[76:79], v[144:147]
  v_mfma_f32_16x16x32_bf16 v[156:159], a[20:23], v[72:75], v[156:159]
  v_mfma_f32_16x16x32_bf16 v[152:155], a[20:23], v[76:79], v[152:155]
  v_mfma_f32_16x16x32_bf16 v[164:167], a[24:27], v[72:75], v[164:167]
  v_mfma_f32_16x16x32_bf16 v[160:163], a[24:27], v[76:79], v[160:163]
  v_mfma_f32_16x16x32_bf16 v[172:175], a[28:31], v[72:75], v[172:175]
  v_mfma_f32_16x16x32_bf16 v[168:171], a[28:31], v[76:79], v[168:171]
  v_mfma_f32_16x16x32_bf16 v[148:151], a[32:35], v[80:83], v[148:151]
  v_mfma_f32_16x16x32_bf16 v[144:147], a[32:35], v[84:87], v[144:147]
  v_mfma_f32_16x16x32_bf16 v[156:159], a[36:39], v[80:83], v[156:159]
  v_mfma_f32_16x16x32_bf16 v[152:155], a[36:39], v[84:87], v[152:155]
  v_mfma_f32_16x16x32_bf16 v[164:167], a[40:43], v[80:83], v[164:167]
  v_mfma_f32_16x16x32_bf16 v[160:163], a[40:43], v[84:87], v[160:163]
  v_mfma_f32_16x16x32_bf16 v[172:175], a[44:47], v[80:83], v[172:175]
  v_mfma_f32_16x16x32_bf16 v[168:171], a[44:47], v[84:87], v[168:171]
  v_mfma_f32_16x16x32_bf16 v[148:151], a[48:51], v[88:91], v[148:151]
  v_mfma_f32_16x16x32_bf16 v[144:147], a[48:51], v[92:95], v[144:147]
  v_mfma_f32_16x16x32_bf16 v[156:159], a[52:55], v[88:91], v[156:159]
  v_mfma_f32_16x16x32_bf16 v[152:155], a[52:55], v[92:95], v[152:155]
  v_mfma_f32_16x16x32_bf16 v[164:167], a[56:59], v[88:91], v[164:167]
  v_mfma_f32_16x16x32_bf16 v[160:163], a[56:59], v[92:95], v[160:163]
  v_mfma_f32_16x16x32_bf16 v[172:175], a[60:63], v[88:91], v[172:175]
  v_mfma_f32_16x16x32_bf16 v[168:171], a[60:63], v[92:95], v[168:171]
  v_swap_b32 v130, v132
  v_swap_b32 v131, v133
  v_swap_b32 v34, v36
  v_swap_b32 v35, v37
  v_swap_b32 v42, v44
  v_swap_b32 v43, v45
  s_nop 1
  v_mfma_f32_16x16x32_bf16 v[144:147], v[32:35], v[128:131], v[144:147]
  v_mfma_f32_16x16x32_bf16 v[148:151], v[32:35], v[132:135], v[148:151]
  v_mfma_f32_16x16x32_bf16 v[152:155], v[36:39], v[128:131], v[152:155]
  v_mfma_f32_16x16x32_bf16 v[156:159], v[36:39], v[132:135], v[156:159]
  v_mfma_f32_16x16x32_bf16 v[160:163], v[40:43], v[128:131], v[160:163]
  v_mfma_f32_16x16x32_bf16 v[164:167], v[40:43], v[132:135], v[164:167]
  v_mfma_f32_16x16x32_bf16 v[168:171], v[44:47], v[128:131], v[168:171]
  v_mfma_f32_16x16x32_bf16 v[172:175], v[44:47], v[132:135], v[172:175]
  s_mov_b32 s101, 0
  s_waitcnt vmcnt(0)
  s_branch pvr_357
pvr_356:
  s_sleep 2
  s_add_u32 s56, s47, 10240
  s_add_u32 s57, s48, 40960
  buffer_load_dwordx4 v[96:99], v4, s[16:19], s56 offen sc1
  buffer_load_dwordx2 v[100:101], v5, s[16:19], s56 offen offset:2048 sc1
  buffer_load_dwordx4 v[136:139], v21, s[16:19], s56 offen offset:1024 sc1
  s_add_u32 s56, s56, 2560
  buffer_load_dwordx4 v[104:107], v4, s[16:19], s56 offen sc1
  buffer_load_dwordx2 v[108:109], v5, s[16:19], s56 offen offset:2048 sc1
  s_add_u32 s56, s56, 2560
  buffer_load_dwordx4 v[112:115], v4, s[16:19], s56 offen sc1
  buffer_load_dwordx2 v[116:117], v5, s[16:19], s56 offen offset:2048 sc1
  buffer_load_dwordx4 v[140:143], v21, s[16:19], s56 offen offset:1024 sc1
  s_add_u32 s56, s56, 2560
  buffer_load_dwordx4 v[120:123], v4, s[16:19], s56 offen sc1
  buffer_load_dwordx2 v[124:125], v5, s[16:19], s56 offen offset:2048 sc1
  s_add_u32 s56, s56, 2560
  buffer_load_dwordx4 v[48:51], v22, s[16:19], s57 offen offset:0 sc1
  buffer_load_dwordx4 v[56:59], v22, s[16:19], s57 offen offset:512 sc1
  s_add_u32 s57, s57, 20480
  buffer_load_dwordx4 v[52:55], v22, s[16:19], s57 offen offset:0 sc1
  buffer_load_dwordx4 v[60:63], v22, s[16:19], s57 offen offset:512 sc1
  s_add_u32 s57, s57, 20480
  s_add_u32 s101, s101, 1
  s_cmp_gt_u32 s101, 131072
  s_cbranch_scc1 main_end
  s_waitcnt vmcnt(0)
pvr_357:
  v_max3_u32 v26, v96, v100, v104
  v_max3_u32 v26, v26, v108, v112
  v_max3_u32 v26, v26, v116, v120
  v_max3_u32 v26, v26, v124, v136
  v_max3_u32 v26, v26, v140, v48
  v_max3_u32 v26, v26, v52, v56
  v_max3_u32 v26, v26, v60, v60
  v_cmp_eq_u32 vcc, -1, v26
  s_nop 1
  s_cbranch_vccnz pvr_356
  v_mfma_f32_16x16x32_bf16 v[148:151], a[64:67], v[96:99], v[148:151]
  v_mfma_f32_16x16x32_bf16 v[144:147], a[64:67], v[100:103], v[144:147]
  v_mfma_f32_16x16x32_bf16 v[156:159], a[68:71], v[96:99], v[156:159]
  v_mfma_f32_16x16x32_bf16 v[152:155], a[68:71], v[100:103], v[152:155]
  v_mfma_f32_16x16x32_bf16 v[164:167], a[72:75], v[96:99], v[164:167]
  v_mfma_f32_16x16x32_bf16 v[160:163], a[72:75], v[100:103], v[160:163]
  v_mfma_f32_16x16x32_bf16 v[172:175], a[76:79], v[96:99], v[172:175]
  v_mfma_f32_16x16x32_bf16 v[168:171], a[76:79], v[100:103], v[168:171]
  v_mfma_f32_16x16x32_bf16 v[148:151], a[80:83], v[104:107], v[148:151]
  v_mfma_f32_16x16x32_bf16 v[144:147], a[80:83], v[108:111], v[144:147]
  v_mfma_f32_16x16x32_bf16 v[156:159], a[84:87], v[104:107], v[156:159]
  v_mfma_f32_16x16x32_bf16 v[152:155], a[84:87], v[108:111], v[152:155]
  v_mfma_f32_16x16x32_bf16 v[164:167], a[88:91], v[104:107], v[164:167]
  v_mfma_f32_16x16x32_bf16 v[160:163], a[88:91], v[108:111], v[160:163]
  v_mfma_f32_16x16x32_bf16 v[172:175], a[92:95], v[104:107], v[172:175]
  v_mfma_f32_16x16x32_bf16 v[168:171], a[92:95], v[108:111], v[168:171]
  v_mfma_f32_16x16x32_bf16 v[148:151], a[96:99], v[112:115], v[148:151]
  v_mfma_f32_16x16x32_bf16 v[144:147], a[96:99], v[116:119], v[144:147]
  v_mfma_f32_16x16x32_bf16 v[156:159], a[100:103], v[112:115], v[156:159]
  v_mfma_f32_16x16x32_bf16 v[152:155], a[100:103], v[116:119], v[152:155]
  v_mfma_f32_16x16x32_bf16 v[164:167], a[104:107], v[112:115], v[164:167]
  v_mfma_f32_16x16x32_bf16 v[160:163], a[104:107], v[116:119], v[160:163]
  v_mfma_f32_16x16x32_bf16 v[172:175], a[108:111], v[112:115], v[172:175]
  v_mfma_f32_16x16x32_bf16 v[168:171], a[108:111], v[116:119], v[168:171]
  v_mfma_f32_16x16x32_bf16 v[148:151], a[112:115], v[120:123], v[148:151]
  v_mfma_f32_16x16x32_bf16 v[144:147], a[112:115], v[124:127], v[144:147]
  v_mfma_f32_16x16x32_bf16 v[156:159], a[116:119], v[120:123], v[156:159]
  v_mfma_f32_16x16x32_bf16 v[152:155], a[116:119], v[124:127], v[152:155]
  v_mfma_f32_16x16x32_bf16 v[164:167], a[120:123], v[120:123], v[164:167]
  v_mfma_f32_16x16x32_bf16 v[160:163], a[120:123], v[124:127], v[160:163]
  v_mfma_f32_16x16x32_bf16 v[172:175], a[124:127], v[120:123], v[172:175]
  v_mfma_f32_16x16x32_bf16 v[168:171], a[124:127], v[124:127], v[168:171]
  v_swap_b32 v138, v140
  v_swap_b32 v139, v141
  v_swap_b32 v50, v52
  v_swap_b32 v51, v53
  v_swap_b32 v58, v60
  v_swap_b32 v59, v61
  s_nop 1
  v_mfma_f32_16x16x32_bf16 v[144:147], v[48:51], v[136:139], v[144:147]
  v_mfma_f32_16x16x32_bf16 v[148:151], v[48:51], v[140:143], v[148:151]
  v_mfma_f32_16x16x32_bf16 v[152:155], v[52:55], v[136:139], v[152:155]
  v_mfma_f32_16x16x32_bf16 v[156:159], v[52:55], v[140:143], v[156:159]
  v_mfma_f32_16x16x32_bf16 v[160:163], v[56:59], v[136:139], v[160:163]
  v_mfma_f32_16x16x32_bf16 v[164:167], v[56:59], v[140:143], v[164:167]
  v_mfma_f32_16x16x32_bf16 v[168:171], v[60:63], v[136:139], v[168:171]
  v_mfma_f32_16x16x32_bf16 v[172:175], v[60:63], v[140:143], v[172:175]
pve_344:
  s_nop 0
  s_cmp_eq_u32 s84, 0
  s_cbranch_scc1 ps_358
  s_lshl_b32 s21, s84, 7
  s_add_u32 s21, s21, 18304
  v_mov_b32 v25, 0
  buffer_load_dword v27, v25, s[72:75], s21 offen sc1
ps_358:
  ds_write_b128 v10, v[144:147] offset:0
  ds_write_b128 v10, v[148:151] offset:1024
  ds_write_b128 v10, v[152:155] offset:2048
  ds_write_b128 v10, v[156:159] offset:3072
  ds_write_b128 v10, v[160:163] offset:4096
  ds_write_b128 v10, v[164:167] offset:5120
  ds_write_b128 v10, v[168:171] offset:6144
  ds_write_b128 v10, v[172:175] offset:7168
  s_cmp_lg_u32 s20, 0
  s_cbranch_scc1 pvq_361
  v_readfirstlane_b32 s21, v29
  s_mov_b32 s23, -1
  v_mov_b32 v213, s23
  s_mov_b64 exec, 1
  ds_write_b32 v30, v29
  ds_write_b32 v30, v213 offset:8
  s_mov_b64 exec, -1
pvq_361:
  s_waitcnt lgkmcnt(0)
  s_barrier
  ds_read_b128 v[176:179], v11 offset:0
  ds_read_b128 v[180:183], v11 offset:8192
  ds_read_b128 v[184:187], v11 offset:16384
  ds_read_b128 v[188:191], v11 offset:24576
  ds_read_b128 v[192:195], v11 offset:4096
  ds_read_b128 v[196:199], v11 offset:12288
  ds_read_b128 v[200:203], v11 offset:20480
  ds_read_b128 v[204:207], v11 offset:28672
  ds_read_b32 v23, v30
  ds_read_b32 v213, v30 offset:8
  s_waitcnt lgkmcnt(6)
  v_pk_add_f32 v[176:177], v[176:177], v[180:181]
  v_pk_add_f32 v[184:185], v[184:185], v[188:189]
  v_pk_add_f32 v[178:179], v[178:179], v[182:183]
  v_pk_add_f32 v[186:187], v[186:187], v[190:191]
  v_pk_add_f32 v[176:177], v[176:177], v[184:185]
  v_pk_add_f32 v[178:179], v[178:179], v[186:187]
  v_cvt_pk_bf16_f32 v26, v176, v177
  v_lshlrev_b32 v176, 16, v26
  v_and_b32 v177, 0xffff0000, v26
  v_mul_f32 v176, v176, v24
  v_mul_f32 v177, v177, v24
  v_cvt_pk_bf16_f32 v26, v176, v177
  v_lshlrev_b32 v176, 16, v26
  v_and_b32 v177, 0xffff0000, v26
  v_add_f32 v176, v176, v12
  v_add_f32 v177, v177, v13
  v_cvt_pk_bf16_f32 v180, v176, v177
  v_cvt_pk_bf16_f32 v26, v178, v179
  v_lshlrev_b32 v178, 16, v26
  v_and_b32 v179, 0xffff0000, v26
  v_mul_f32 v178, v178, v24
  v_mul_f32 v179, v179, v24
  v_cvt_pk_bf16_f32 v26, v178, v179
  v_lshlrev_b32 v178, 16, v26
  v_and_b32 v179, 0xffff0000, v26
  v_add_f32 v178, v178, v14
  v_add_f32 v179, v179, v15
  v_cvt_pk_bf16_f32 v181, v178, v179
  buffer_store_dwordx2 v[180:181], v9, s[8:11], s46 offen offset:0
  s_waitcnt lgkmcnt(2)
  v_pk_add_f32 v[192:193], v[192:193], v[196:197]
  v_pk_add_f32 v[200:201], v[200:201], v[204:205]
  v_pk_add_f32 v[194:195], v[194:195], v[198:199]
  v_pk_add_f32 v[202:203], v[202:203], v[206:207]
  v_pk_add_f32 v[192:193], v[192:193], v[200:201]
  v_pk_add_f32 v[194:195], v[194:195], v[202:203]
  v_cvt_pk_bf16_f32 v26, v192, v193
  v_lshlrev_b32 v192, 16, v26
  v_and_b32 v193, 0xffff0000, v26
  v_mul_f32 v192, v192, v24
  v_mul_f32 v193, v193, v24
  v_cvt_pk_bf16_f32 v26, v192, v193
  v_lshlrev_b32 v192, 16, v26
  v_and_b32 v193, 0xffff0000, v26
  v_add_f32 v192, v192, v16
  v_add_f32 v193, v193, v17
  v_cvt_pk_bf16_f32 v196, v192, v193
  v_cvt_pk_bf16_f32 v26, v194, v195
  v_lshlrev_b32 v194, 16, v26
  v_and_b32 v195, 0xffff0000, v26
  v_mul_f32 v194, v194, v24
  v_mul_f32 v195, v195, v24
  v_cvt_pk_bf16_f32 v26, v194, v195
  v_lshlrev_b32 v194, 16, v26
  v_and_b32 v195, 0xffff0000, v26
  v_add_f32 v194, v194, v18
  v_add_f32 v195, v195, v19
  v_cvt_pk_bf16_f32 v197, v194, v195
  buffer_store_dwordx2 v[196:197], v9, s[8:11], s46 offen offset:64
  s_cmp_eq_u32 s84, 0
  s_cbranch_scc1 pz_364
  s_waitcnt vmcnt(2)
  s_cmp_lg_u32 s20, 0
  s_cbranch_scc1 pz_364x
  ds_write_b32 v30, v27 offset:4
pz_364x:
  s_waitcnt lgkmcnt(0)
  s_barrier
  ds_read_b32 v27, v30 offset:4
  s_waitcnt lgkmcnt(0)
  v_readfirstlane_b32 s64, v27
pz_364:
  s_waitcnt lgkmcnt(0)
  v_readfirstlane_b32 s2, v23
  v_readfirstlane_b32 s67, v213
  s_barrier
  s_cmp_eq_u32 s84, 0
  s_cbranch_scc1 oa_365
  s_cmp_lt_u32 s64, 61
  s_cbranch_scc1 oa_365
  s_mov_b32 s85, s2
  s_branch own_afin
oa_365:
  s_cmp_eq_u32 s84, 0
  s_cbranch_scc1 od_366
  s_cmp_lt_u32 s2, 738
  s_cbranch_scc1 od_366
  s_mov_b32 s85, s2
  s_branch own_afin
od_366:
  s_add_u32 s21, s2, 0
  s_cmp_lt_u32 s2, 10
  s_cbranch_scc1 do_qbl
  s_sub_u32 s2, s2, 10
  s_add_u32 s21, s2, 0
  s_cmp_lt_u32 s2, 54
  s_cbranch_scc1 do_bat
  s_sub_u32 s2, s2, 54
  s_add_u32 s21, s2, 0
  s_cmp_lt_u32 s2, 56
  s_cbranch_scc1 do_opb
  s_sub_u32 s2, s2, 56
  s_add_u32 s21, s2, 54
  s_cmp_lt_u32 s2, 10
  s_cbranch_scc1 do_bat
  s_sub_u32 s2, s2, 10
  s_add_u32 s21, s2, 0
  s_cmp_lt_u32 s2, 60
  s_cbranch_scc1 pv_loop
  s_sub_u32 s2, s2, 60
  s_add_u32 s21, s2, 56
  s_cmp_lt_u32 s2, 8
  s_cbranch_scc1 do_opb
  s_sub_u32 s2, s2, 8
  s_add_u32 s21, s2, 60
  s_cmp_lt_u32 s2, 480
  s_cbranch_scc1 pv_loop
  s_sub_u32 s2, s2, 480
  s_add_u32 s21, s2, 540
  s_cmp_lt_u32 s2, 100
  s_cbranch_scc1 pv_loop
  s_sub_u32 s2, s2, 100
  s_branch main_fin
own_afin:
  s_sub_u32 s21, s84, 1
  s_mov_b32 s84, 0
do_afin:
  s_mov_b32 s2, s21
  s_load_dwordx2 s[38:39], s[0:1], 104
  s_mov_b32 s42, s2
  s_waitcnt lgkmcnt(0)
  s_mov_b32 s16, s38
  s_mov_b32 s17, s39
  s_mov_b32 s18, 50331648
  s_mov_b32 s19, 0x00020000
  s_add_u32 s52, s38, 50331648
  s_addc_u32 s53, s39, 0
  s_mov_b32 s54, 6291456
  s_mov_b32 s55, 0x00020000
  s_add_u32 s56, s38, 85983232
  s_addc_u32 s57, s39, 0
  s_mov_b32 s58, 6815744
  s_mov_b32 s59, 0x00020000
  s_add_u32 s72, s38, 81068032
  s_addc_u32 s73, s39, 0
  s_mov_b32 s74, 115712
  s_mov_b32 s75, 0x00020000
  s_mul_i32 s21, s20, 12800
  s_add_u32 s21, s21, 98304
  v_mul_u32_u24 v4, 400, v2
  v_lshlrev_b32 v5, 4, v3
  v_add3_u32 v29, v4, v5, s21
  v_lshlrev_b32 v30, 4, v1
  v_and_b32 v4, 7, v2
  v_lshlrev_b32 v4, 4, v4
  v_lshl_add_u32 v31, v3, 7, v4
  v_lshlrev_b32 v32, 3, v1
  v_and_b32 v4, 3, v1
  v_lshlrev_b32 v33, 3, v4
  v_mov_b32 v34, 0xf149f2ca
  v_lshlrev_b32 v4, 2, v3
  v_sub_u32 v35, v2, v4
  v_cmp_gt_u32 s[60:61], 2, v3
  s_mov_b32 s62, 0x3d93cd3a
  s_mov_b32 s63, 0x3fb8aa3b
  s_mov_b32 s83, 0x3dd53b95
  v_cmp_le_i32 s[64:65], 0, v35
  v_cmp_le_i32 s[66:67], 1, v35
  v_cmp_le_i32 s[68:69], 2, v35
  v_cmp_le_i32 s[70:71], 3, v35
  s_add_u32 s49, s20, 60
  s_mov_b32 s29, 4
  s_mov_b32 s78, 0
  s_lshl_b32 s21, s42, 7
  s_add_u32 s21, s21, 111616
  s_lshl_b32 s43, s42, 2
  s_add_u32 s43, s43, s20
  s_mul_i32 s43, s43, 12288
  s_add_u32 s43, s43, 5242880
  s_waitcnt vmcnt(0)
  s_cmp_eq_u32 s78, 0
  s_cbranch_scc1 pf_368
  v_mov_b32 v4, 0
  v_mov_b32 v5, 1
  s_mov_b64 exec, 1
  buffer_atomic_add v5, v4, s[72:75], s78 offen sc1
  s_mov_b64 exec, -1
  s_mov_b32 s78, 0
pf_368:
  s_mul_i32 s21, s49, 393216
  s_mul_i32 s22, s42, 12288
  s_add_u32 s50, s21, s22
  s_mul_i32 s21, s49, 98304
  s_mul_i32 s22, s42, 3072
  s_add_u32 s51, s21, s22
  s_lshr_b32 s22, s49, 1
  s_lshr_b32 s21, s49, 2
  s_add_u32 s21, s21, 2
  s_cmp_lt_u32 s49, 8
  s_cselect_b32 s21, s22, s21
  s_lshl_b32 s21, s21, 3
  s_lshr_b32 s22, s42, 2
  s_add_u32 s21, s21, s22
  s_lshl_b32 s21, s21, 7
  s_add_u32 s76, s21, 0
  s_lshl_b32 s77, s42, 7
  s_add_u32 s77, s77, 18432
  v_mov_b32 v156, 0
  s_mov_b32 s101, 0
wf_369:
  buffer_load_dword v157, v156, s[72:75], s76 offen sc1
  s_add_u32 s101, s101, 1
  s_cmp_gt_u32 s101, 131072
  s_cbranch_scc1 main_end
  s_waitcnt vmcnt(0)
  v_readfirstlane_b32 s100, v157
  s_cmp_ge_u32 s100, 8
  s_cbranch_scc1 wf_370
  s_sleep 2
  s_branch wf_369
wf_370:
  s_add_u32 s21, s50, 0
  buffer_load_dwordx4 v[36:39], v30, s[16:19], s21 offen offset:0 sc1
  buffer_load_dwordx4 v[40:43], v30, s[16:19], s21 offen offset:1024 sc1
  buffer_load_dwordx4 v[44:47], v30, s[16:19], s21 offen offset:2048 sc1
  buffer_load_dwordx4 v[48:51], v30, s[16:19], s21 offen offset:3072 sc1
  s_add_u32 s21, s50, 4096
  buffer_load_dwordx4 v[52:55], v30, s[16:19], s21 offen offset:0 sc1
  buffer_load_dwordx4 v[56:59], v30, s[16:19], s21 offen offset:1024 sc1
  buffer_load_dwordx4 v[60:63], v30, s[16:19], s21 offen offset:2048 sc1
  buffer_load_dwordx4 v[236:239], v30, s[16:19], s21 offen offset:3072 sc1
  s_add_u32 s21, s50, 8192
  buffer_load_dwordx4 v[240:243], v30, s[16:19], s21 offen offset:0 sc1
  buffer_load_dwordx4 v[244:247], v30, s[16:19], s21 offen offset:1024 sc1
  buffer_load_dwordx4 v[248:251], v30, s[16:19], s21 offen offset:2048 sc1
  buffer_load_dwordx4 v[252:255], v30, s[16:19], s21 offen offset:3072 sc1
  s_add_u32 s21, s43, 0
  buffer_load_dwordx4 v[64:67], v30, s[56:59], s21 offen offset:0 sc1
  buffer_load_dwordx4 v[68:71], v30, s[56:59], s21 offen offset:1024 sc1
  buffer_load_dwordx4 v[72:75], v30, s[56:59], s21 offen offset:2048 sc1
  buffer_load_dwordx4 v[76:79], v30, s[56:59], s21 offen offset:3072 sc1
  s_add_u32 s21, s43, 4096
  buffer_load_dwordx4 v[80:83], v30, s[56:59], s21 offen offset:0 sc1
  buffer_load_dwordx4 v[84:87], v30, s[56:59], s21 offen offset:1024 sc1
  buffer_load_dwordx4 v[88:91], v30, s[56:59], s21 offen offset:2048 sc1
  buffer_load_dwordx4 v[92:95], v30, s[56:59], s21 offen offset:3072 sc1
  s_add_u32 s21, s43, 8192
  buffer_load_dwordx4 v[96:99], v30, s[56:59], s21 offen offset:0 sc1
  buffer_load_dwordx4 v[100:103], v30, s[56:59], s21 offen offset:1024 sc1
  buffer_load_dwordx4 v[104:107], v30, s[56:59], s21 offen offset:2048 sc1
  buffer_load_dwordx4 v[108:111], v30, s[56:59], s21 offen offset:3072 sc1
  s_mov_b32 s80, 0
  s_waitcnt vmcnt(0)
  v_mfma_f32_16x16x32_bf16 v[112:115], v[36:39], v[64:67], 0
  v_mfma_f32_16x16x32_bf16 v[120:123], v[36:39], v[88:91], 0
  v_mfma_f32_16x16x32_bf16 v[124:127], v[60:63], v[88:91], 0
  v_mfma_f32_16x16x32_bf16 v[112:115], v[40:43], v[68:71], v[112:115]
  v_mfma_f32_16x16x32_bf16 v[120:123], v[40:43], v[92:95], v[120:123]
  v_mfma_f32_16x16x32_bf16 v[124:127], v[236:239], v[92:95], v[124:127]
  v_mfma_f32_16x16x32_bf16 v[112:115], v[44:47], v[72:75], v[112:115]
  v_mfma_f32_16x16x32_bf16 v[120:123], v[44:47], v[96:99], v[120:123]
  v_mfma_f32_16x16x32_bf16 v[124:127], v[240:243], v[96:99], v[124:127]
  v_mfma_f32_16x16x32_bf16 v[112:115], v[48:51], v[76:79], v[112:115]
  v_mfma_f32_16x16x32_bf16 v[120:123], v[48:51], v[100:103], v[120:123]
  v_mfma_f32_16x16x32_bf16 v[124:127], v[244:247], v[100:103], v[124:127]
  v_mfma_f32_16x16x32_bf16 v[112:115], v[52:55], v[80:83], v[112:115]
  v_mfma_f32_16x16x32_bf16 v[120:123], v[52:55], v[104:107], v[120:123]
  v_mfma_f32_16x16x32_bf16 v[124:127], v[248:251], v[104:107], v[124:127]
  v_mfma_f32_16x16x32_bf16 v[112:115], v[56:59], v[84:87], v[112:115]
  v_mfma_f32_16x16x32_bf16 v[120:123], v[56:59], v[108:111], v[120:123]
  v_mfma_f32_16x16x32_bf16 v[124:127], v[252:255], v[108:111], v[124:127]
  s_cmp_eq_u32 s80, 1
  s_cbranch_scc1 qm_371
  s_add_u32 s23, s49, 1
  s_min_u32 s23, s49, 62
  s_mov_b32 s101, 0
wm_372:
  buffer_load_dword v156, v33, s[72:75], s77 offen sc1
  s_add_u32 s101, s101, 1
  s_cmp_gt_u32 s101, 131072
  s_cbranch_scc1 main_end
  s_waitcnt vmcnt(0)
  v_cmp_gt_u32 vcc, s23, v156
  v_readfirstlane_b32 s100, v156
  s_nop 0
  s_cbranch_vccz wm_373
  s_sleep 4
  s_add_u32 s100, s100, 2
  s_cmp_ge_u32 s100, s23
  s_cbranch_scc1 wm_372
  s_sleep 90
  s_branch wm_372
wm_373:
  s_mov_b32 s101, 0
  s_branch qtp_375
qtp_374:
  s_sleep 3
qtp_375:
  buffer_load_dwordx4 v[132:135], v31, s[52:55], s51 offen offset:0 sc1
  buffer_load_dwordx4 v[136:139], v31, s[52:55], s51 offen offset:512 sc1
  buffer_load_dwordx4 v[140:143], v31, s[52:55], s51 offen offset:1024 sc1
  buffer_load_dwordx4 v[144:147], v31, s[52:55], s51 offen offset:1536 sc1
  buffer_load_dwordx4 v[148:151], v31, s[52:55], s51 offen offset:2048 sc1
  buffer_load_dwordx4 v[152:155], v31, s[52:55], s51 offen offset:2560 sc1
  s_add_u32 s101, s101, 1
  s_cmp_gt_u32 s101, 131072
  s_cbranch_scc1 main_end
  s_waitcnt vmcnt(0)
  v_max3_u32 v156, v132, v134, v136
  v_max3_u32 v156, v156, v138, v140
  v_max3_u32 v156, v156, v142, v144
  v_max3_u32 v156, v156, v146, v148
  v_max3_u32 v156, v156, v150, v152
  v_max3_u32 v156, v156, v154, v154
  v_cmp_eq_u32 vcc, -1, v156
  s_nop 1
  s_cbranch_vccnz qtp_374
qm_371:
  s_waitcnt vmcnt(0)
  v_mfma_f32_16x16x32_bf16 v[116:119], v[132:135], v[64:67], 0
  v_mfma_f32_16x16x32_bf16 v[128:131], v[132:135], v[88:91], 0
  v_mfma_f32_16x16x32_bf16 v[116:119], v[136:139], v[68:71], v[116:119]
  v_mfma_f32_16x16x32_bf16 v[128:131], v[136:139], v[92:95], v[128:131]
  v_mfma_f32_16x16x32_bf16 v[116:119], v[140:143], v[72:75], v[116:119]
  v_mfma_f32_16x16x32_bf16 v[128:131], v[140:143], v[96:99], v[128:131]
  v_mfma_f32_16x16x32_bf16 v[116:119], v[144:147], v[76:79], v[116:119]
  v_mfma_f32_16x16x32_bf16 v[128:131], v[144:147], v[100:103], v[128:131]
  v_mfma_f32_16x16x32_bf16 v[116:119], v[148:151], v[80:83], v[116:119]
  v_mfma_f32_16x16x32_bf16 v[128:131], v[148:151], v[104:107], v[128:131]
  v_mfma_f32_16x16x32_bf16 v[116:119], v[152:155], v[84:87], v[116:119]
  v_mfma_f32_16x16x32_bf16 v[128:131], v[152:155], v[108:111], v[128:131]
  s_lshl_b32 s21, s49, 5
  s_add_u32 s21, s21, s42
  s_mul_i32 s81, s21, 2560
  s_lshl_b32 s82, s49, 3
  s_and_b32 s21, s42, 7
  s_add_u32 s82, s82, s21
  s_lshl_b32 s82, s82, 7
  s_add_u32 s82, s82, 22528
  v_cndmask_b32 v112, v34, v112, s[64:65]
  v_cndmask_b32 v124, v34, v124, s[64:65]
  v_cndmask_b32 v113, v34, v113, s[66:67]
  v_cndmask_b32 v125, v34, v125, s[66:67]
  v_cndmask_b32 v114, v34, v114, s[68:69]
  v_cndmask_b32 v126, v34, v126, s[68:69]
  v_cndmask_b32 v115, v34, v115, s[70:71]
  v_cndmask_b32 v127, v34, v127, s[70:71]
  v_max3_f32 v156, v112, v113, v114
  v_max3_f32 v156, v156, v115, v116
  v_max3_f32 v156, v156, v117, v118
  v_max_f32 v156, v156, v119
  v_mov_b32 v157, v156
  s_nop 1
  v_permlane32_swap_b32 v156, v157
  v_max_f32 v156, v156, v157
  v_mov_b32 v157, v156
  s_nop 1
  v_permlane16_swap_b32 v156, v157
  v_max_f32 v156, v156, v157
  v_mul_f32 v156, s83, v156
  v_fma_f32 v112, v112, s83, -v156
  v_fma_f32 v113, v113, s83, -v156
  v_fma_f32 v114, v114, s83, -v156
  v_fma_f32 v115, v115, s83, -v156
  v_fma_f32 v116, v116, s83, -v156
  v_fma_f32 v117, v117, s83, -v156
  v_fma_f32 v118, v118, s83, -v156
  v_fma_f32 v119, v119, s83, -v156
  v_exp_f32 v112, v112
  v_exp_f32 v113, v113
  v_exp_f32 v114, v114
  v_exp_f32 v115, v115
  v_exp_f32 v116, v116
  v_exp_f32 v117, v117
  v_exp_f32 v118, v118
  v_exp_f32 v119, v119
  s_nop 0
  v_add_f32 v156, v116, v117
  v_add_f32 v156, v156, v118
  v_add_f32 v156, v156, v119
  v_cndmask_b32 v156, 0, v156, s[60:61]
  v_add_f32 v156, v156, v112
  v_add_f32 v156, v156, v113
  v_add_f32 v156, v156, v114
  v_add_f32 v156, v156, v115
  v_mov_b32 v157, v156
  s_nop 1
  v_permlane32_swap_b32 v156, v157
  v_add_f32 v156, v156, v157
  v_mov_b32 v157, v156
  s_nop 1
  v_permlane16_swap_b32 v156, v157
  v_add_f32 v156, v156, v157
  v_rcp_f32 v156, v156
  s_nop 0
  v_mul_f32 v112, v112, v156
  v_mul_f32 v113, v113, v156
  v_mul_f32 v114, v114, v156
  v_mul_f32 v115, v115, v156
  v_mul_f32 v116, v116, v156
  v_mul_f32 v117, v117, v156
  v_mul_f32 v118, v118, v156
  v_mul_f32 v119, v119, v156
  v_max3_f32 v156, v120, v121, v122
  v_max3_f32 v156, v156, v123, v124
  v_max3_f32 v156, v156, v125, v126
  v_max3_f32 v156, v156, v127, v128
  v_max3_f32 v156, v156, v129, v130
  v_max_f32 v156, v156, v131
  v_mov_b32 v157, v156
  s_nop 1
  v_permlane32_swap_b32 v156, v157
  v_max_f32 v156, v156, v157
  v_mov_b32 v157, v156
  s_nop 1
  v_permlane16_swap_b32 v156, v157
  v_max_f32 v156, v156, v157
  v_mul_f32 v156, s83, v156
  v_fma_f32 v120, v120, s83, -v156
  v_fma_f32 v121, v121, s83, -v156
  v_fma_f32 v122, v122, s83, -v156
  v_fma_f32 v123, v123, s83, -v156
  v_fma_f32 v124, v124, s83, -v156
  v_fma_f32 v125, v125, s83, -v156
  v_fma_f32 v126, v126, s83, -v156
  v_fma_f32 v127, v127, s83, -v156
  v_fma_f32 v128, v128, s83, -v156
  v_fma_f32 v129, v129, s83, -v156
  v_fma_f32 v130, v130, s83, -v156
  v_fma_f32 v131, v131, s83, -v156
  v_exp_f32 v120, v120
  v_exp_f32 v121, v121
  v_exp_f32 v122, v122
  v_exp_f32 v123, v123
  v_exp_f32 v124, v124
  v_exp_f32 v125, v125
  v_exp_f32 v126, v126
  v_exp_f32 v127, v127
  v_exp_f32 v128, v128
  v_exp_f32 v129, v129
  v_exp_f32 v130, v130
  v_exp_f32 v131, v131
  s_nop 0
  v_add_f32 v156, v128, v129
  v_add_f32 v156, v156, v130
  v_add_f32 v156, v156, v131
  v_cndmask_b32 v156, 0, v156, s[60:61]
  v_add_f32 v156, v156, v120
  v_add_f32 v156, v156, v121
  v_add_f32 v156, v156, v122
  v_add_f32 v156, v156, v123
  v_add_f32 v156, v156, v124
  v_add_f32 v156, v156, v125
  v_add_f32 v156, v156, v126
  v_add_f32 v156, v156, v127
  v_mov_b32 v157, v156
  s_nop 1
  v_permlane32_swap_b32 v156, v157
  v_add_f32 v156, v156, v157
  v_mov_b32 v157, v156
  s_nop 1
  v_permlane16_swap_b32 v156, v157
  v_add_f32 v156, v156, v157
  v_rcp_f32 v156, v156
  s_nop 0
  v_mul_f32 v120, v120, v156
  v_mul_f32 v121, v121, v156
  v_mul_f32 v122, v122, v156
  v_mul_f32 v123, v123, v156
  v_mul_f32 v124, v124, v156
  v_mul_f32 v125, v125, v156
  v_mul_f32 v126, v126, v156
  v_mul_f32 v127, v127, v156
  v_mul_f32 v128, v128, v156
  v_mul_f32 v129, v129, v156
  v_mul_f32 v130, v130, v156
  v_mul_f32 v131, v131, v156
  v_cvt_pk_bf16_f32 v192, v120, v121
  v_cvt_pk_bf16_f32 v193, v122, v123
  v_cvt_pk_bf16_f32 v194, v124, v125
  v_cvt_pk_bf16_f32 v195, v126, v127
  v_cvt_pk_bf16_f32 v196, v116, v117
  v_cvt_pk_bf16_f32 v197, v118, v119
  v_cvt_pk_bf16_f32 v198, v128, v129
  v_cvt_pk_bf16_f32 v199, v130, v131
  v_cvt_pk_bf16_f32 v200, v112, v113
  v_cvt_pk_bf16_f32 v201, v114, v115
  buffer_store_dwordx4 v[192:195], v30, s[56:59], s81 offen sc1
  buffer_store_dwordx4 v[196:199], v30, s[56:59], s81 offen offset:1024 sc1
  buffer_store_dwordx2 v[200:201], v32, s[56:59], s81 offen offset:2048 sc1
  s_mov_b32 s78, s82
  s_mov_b32 s81, 0x80000000
  s_mov_b32 s82, 0
  s_cmp_eq_u32 s80, 1
  s_cbranch_scc1 qd_376
  s_waitcnt vmcnt(0)
  s_cmp_eq_u32 s78, 0
  s_cbranch_scc1 pf_377
  v_mov_b32 v4, 0
  v_mov_b32 v5, 1
  s_mov_b64 exec, 1
  buffer_atomic_add v5, v4, s[72:75], s78 offen sc1
  s_mov_b64 exec, -1
  s_mov_b32 s78, 0
pf_377:
qd_376:
  s_add_u32 s49, s49, s29
qbe_367:
  s_branch queue
do_bat:
  s_mov_b32 s2, s21
  s_load_dwordx2 s[4:5], s[0:1], 0
  s_load_dwordx2 s[6:7], s[0:1], 80
  s_load_dwordx2 s[38:39], s[0:1], 104
  s_waitcnt lgkmcnt(0)
  s_mov_b32 s8, s4
  s_mov_b32 s9, s5
  s_mov_b32 s10, 2621440
  s_mov_b32 s11, 0x00020000
  s_mov_b32 s12, s6
  s_mov_b32 s13, s7
  s_mov_b32 s14, 1280
  s_mov_b32 s15, 0x00020000
  s_add_u32 s16, s38, 62914560
  s_addc_u32 s17, s39, 0
  s_mov_b32 s18, 7864320
  s_mov_b32 s19, 0x00020000
  s_add_u32 s24, s38, 70778880
  s_addc_u32 s25, s39, 0
  s_mov_b32 s26, 2621440
  s_mov_b32 s27, 0x00020000
  s_add_u32 s28, s38, 81002496
  s_addc_u32 s29, s39, 0
  s_mov_b32 s30, 8192
  s_mov_b32 s31, 0x00020000
  s_add_u32 s72, s38, 81068032
  s_addc_u32 s73, s39, 0
  s_mov_b32 s74, 115712
  s_mov_b32 s75, 0x00020000
  v_mov_b32 v7, 52429
  v_add_u32 v5, 0, v1
  v_mul_u32_u24 v6, v5, v7
  v_lshrrev_b32 v18, 23, v6
  v_mul_u32_u24 v19, 1280, v18
  v_lshl_add_u32 v8, v5, 4, v19
  v_add_u32 v8, 1280, v8
  v_lshrrev_b32 v18, 22, v6
  v_mul_u32_u24 v19, 2560, v18
  v_lshl_add_u32 v13, v5, 4, v19
  v_add_u32 v5, 64, v1
  v_mul_u32_u24 v6, v5, v7
  v_lshrrev_b32 v18, 23, v6
  v_mul_u32_u24 v19, 1280, v18
  v_lshl_add_u32 v9, v5, 4, v19
  v_add_u32 v9, 1280, v9
  v_lshrrev_b32 v18, 22, v6
  v_mul_u32_u24 v19, 2560, v18
  v_lshl_add_u32 v14, v5, 4, v19
  v_add_u32 v5, 128, v1
  v_mul_u32_u24 v6, v5, v7
  v_lshrrev_b32 v18, 23, v6
  v_mul_u32_u24 v19, 1280, v18
  v_lshl_add_u32 v10, v5, 4, v19
  v_add_u32 v10, 1280, v10
  v_lshrrev_b32 v18, 22, v6
  v_mul_u32_u24 v19, 2560, v18
  v_lshl_add_u32 v15, v5, 4, v19
  v_add_u32 v5, 192, v1
  v_mul_u32_u24 v6, v5, v7
  v_lshrrev_b32 v18, 23, v6
  v_mul_u32_u24 v19, 1280, v18
  v_lshl_add_u32 v11, v5, 4, v19
  v_add_u32 v11, 1280, v11
  v_lshrrev_b32 v18, 22, v6
  v_mul_u32_u24 v19, 2560, v18
  v_lshl_add_u32 v16, v5, 4, v19
  v_add_u32 v5, 256, v1
  v_mul_u32_u24 v6, v5, v7
  v_lshrrev_b32 v18, 23, v6
  v_mul_u32_u24 v19, 1280, v18
  v_lshl_add_u32 v12, v5, 4, v19
  v_add_u32 v12, 1280, v12
  v_lshrrev_b32 v18, 22, v6
  v_mul_u32_u24 v19, 2560, v18
  v_lshl_add_u32 v17, v5, 4, v19
  s_lshr_b32 s21, s2, 2
  s_lshl_b32 s21, s21, 7
  s_add_u32 s21, s21, 88064
  s_cmp_lg_u32 s20, 0
  s_cbranch_scc1 wf_379
  v_mov_b32 v18, 0
  s_mov_b32 s101, 0
wf_378:
  buffer_load_dword v19, v18, s[72:75], s21 offen sc1
  s_add_u32 s101, s101, 1
  s_cmp_gt_u32 s101, 131072
  s_cbranch_scc1 main_end
  s_waitcnt vmcnt(0)
  v_readfirstlane_b32 s100, v19
  s_cmp_ge_u32 s100, 10
  s_cbranch_scc1 wf_379
  s_sleep 16
  s_branch wf_378
wf_379:
  s_barrier
  s_max_u32 s21, s2, 1
  s_sub_u32 s21, s21, 1
  s_lshr_b32 s21, s21, 2
  s_lshl_b32 s21, s21, 7
  s_add_u32 s21, s21, 88064
  s_cmp_lg_u32 s20, 0
  s_cbranch_scc1 wf_381
  v_mov_b32 v18, 0
  s_mov_b32 s101, 0
wf_380:
  buffer_load_dword v19, v18, s[72:75], s21 offen sc1
  s_add_u32 s101, s101, 1
  s_cmp_gt_u32 s101, 131072
  s_cbranch_scc1 main_end
  s_waitcnt vmcnt(0)
  v_readfirstlane_b32 s100, v19
  s_cmp_ge_u32 s100, 10
  s_cbranch_scc1 wf_381
  s_sleep 16
  s_branch wf_380
wf_381:
  s_barrier
  s_lshl_b32 s58, s2, 5
  s_add_u32 s22, s20, 0
  s_cmp_ge_u32 s22, 23
  s_cbranch_scc1 bd_382
  s_lshl_b32 s23, s22, 1
  s_add_u32 s23, s23, s58
  s_sub_i32 s23, s23, 14
  s_max_i32 s23, s23, 0
  s_mul_i32 s23, s23, 3840
  s_mul_i32 s22, s22, 5120
  s_add_u32 m0, s22, 0
  s_nop 0
  buffer_load_dwordx4 v8, s[16:19], s23 offen sc1 lds
  s_add_u32 m0, s22, 1024
  s_nop 0
  buffer_load_dwordx4 v9, s[16:19], s23 offen sc1 lds
  s_add_u32 m0, s22, 2048
  s_nop 0
  buffer_load_dwordx4 v10, s[16:19], s23 offen sc1 lds
  s_add_u32 m0, s22, 3072
  s_nop 0
  buffer_load_dwordx4 v11, s[16:19], s23 offen sc1 lds
  s_add_u32 m0, s22, 4096
  s_nop 0
  buffer_load_dwordx4 v12, s[16:19], s23 offen sc1 lds
bd_382:
  s_add_u32 s22, s20, 4
  s_cmp_ge_u32 s22, 23
  s_cbranch_scc1 bd_383
  s_lshl_b32 s23, s22, 1
  s_add_u32 s23, s23, s58
  s_sub_i32 s23, s23, 14
  s_max_i32 s23, s23, 0
  s_mul_i32 s23, s23, 3840
  s_mul_i32 s22, s22, 5120
  s_add_u32 m0, s22, 0
  s_nop 0
  buffer_load_dwordx4 v8, s[16:19], s23 offen sc1 lds
  s_add_u32 m0, s22, 1024
  s_nop 0
  buffer_load_dwordx4 v9, s[16:19], s23 offen sc1 lds
  s_add_u32 m0, s22, 2048
  s_nop 0
  buffer_load_dwordx4 v10, s[16:19], s23 offen sc1 lds
  s_add_u32 m0, s22, 3072
  s_nop 0
  buffer_load_dwordx4 v11, s[16:19], s23 offen sc1 lds
  s_add_u32 m0, s22, 4096
  s_nop 0
  buffer_load_dwordx4 v12, s[16:19], s23 offen sc1 lds
bd_383:
  s_add_u32 s22, s20, 8
  s_cmp_ge_u32 s22, 23
  s_cbranch_scc1 bd_384
  s_lshl_b32 s23, s22, 1
  s_add_u32 s23, s23, s58
  s_sub_i32 s23, s23, 14
  s_max_i32 s23, s23, 0
  s_mul_i32 s23, s23, 3840
  s_mul_i32 s22, s22, 5120
  s_add_u32 m0, s22, 0
  s_nop 0
  buffer_load_dwordx4 v8, s[16:19], s23 offen sc1 lds
  s_add_u32 m0, s22, 1024
  s_nop 0
  buffer_load_dwordx4 v9, s[16:19], s23 offen sc1 lds
  s_add_u32 m0, s22, 2048
  s_nop 0
  buffer_load_dwordx4 v10, s[16:19], s23 offen sc1 lds
  s_add_u32 m0, s22, 3072
  s_nop 0
  buffer_load_dwordx4 v11, s[16:19], s23 offen sc1 lds
  s_add_u32 m0, s22, 4096
  s_nop 0
  buffer_load_dwordx4 v12, s[16:19], s23 offen sc1 lds
bd_384:
  s_add_u32 s22, s20, 12
  s_cmp_ge_u32 s22, 23
  s_cbranch_scc1 bd_385
  s_lshl_b32 s23, s22, 1
  s_add_u32 s23, s23, s58
  s_sub_i32 s23, s23, 14
  s_max_i32 s23, s23, 0
  s_mul_i32 s23, s23, 3840
  s_mul_i32 s22, s22, 5120
  s_add_u32 m0, s22, 0
  s_nop 0
  buffer_load_dwordx4 v8, s[16:19], s23 offen sc1 lds
  s_add_u32 m0, s22, 1024
  s_nop 0
  buffer_load_dwordx4 v9, s[16:19], s23 offen sc1 lds
  s_add_u32 m0, s22, 2048
  s_nop 0
  buffer_load_dwordx4 v10, s[16:19], s23 offen sc1 lds
  s_add_u32 m0, s22, 3072
  s_nop 0
  buffer_load_dwordx4 v11, s[16:19], s23 offen sc1 lds
  s_add_u32 m0, s22, 4096
  s_nop 0
  buffer_load_dwordx4 v12, s[16:19], s23 offen sc1 lds
bd_385:
  s_add_u32 s22, s20, 16
  s_cmp_ge_u32 s22, 23
  s_cbranch_scc1 bd_386
  s_lshl_b32 s23, s22, 1
  s_add_u32 s23, s23, s58
  s_sub_i32 s23, s23, 14
  s_max_i32 s23, s23, 0
  s_mul_i32 s23, s23, 3840
  s_mul_i32 s22, s22, 5120
  s_add_u32 m0, s22, 0
  s_nop 0
  buffer_load_dwordx4 v8, s[16:19], s23 offen sc1 lds
  s_add_u32 m0, s22, 1024
  s_nop 0
  buffer_load_dwordx4 v9, s[16:19], s23 offen sc1 lds
  s_add_u32 m0, s22, 2048
  s_nop 0
  buffer_load_dwordx4 v10, s[16:19], s23 offen sc1 lds
  s_add_u32 m0, s22, 3072
  s_nop 0
  buffer_load_dwordx4 v11, s[16:19], s23 offen sc1 lds
  s_add_u32 m0, s22, 4096
  s_nop 0
  buffer_load_dwordx4 v12, s[16:19], s23 offen sc1 lds
bd_386:
  s_add_u32 s22, s20, 20
  s_cmp_ge_u32 s22, 23
  s_cbranch_scc1 bd_387
  s_lshl_b32 s23, s22, 1
  s_add_u32 s23, s23, s58
  s_sub_i32 s23, s23, 14
  s_max_i32 s23, s23, 0
  s_mul_i32 s23, s23, 3840
  s_mul_i32 s22, s22, 5120
  s_add_u32 m0, s22, 0
  s_nop 0
  buffer_load_dwordx4 v8, s[16:19], s23 offen sc1 lds
  s_add_u32 m0, s22, 1024
  s_nop 0
  buffer_load_dwordx4 v9, s[16:19], s23 offen sc1 lds
  s_add_u32 m0, s22, 2048
  s_nop 0
  buffer_load_dwordx4 v10, s[16:19], s23 offen sc1 lds
  s_add_u32 m0, s22, 3072
  s_nop 0
  buffer_load_dwordx4 v11, s[16:19], s23 offen sc1 lds
  s_add_u32 m0, s22, 4096
  s_nop 0
  buffer_load_dwordx4 v12, s[16:19], s23 offen sc1 lds
bd_387:
  s_add_u32 s22, s20, 0
  s_lshl_b32 s23, s22, 2
  s_add_u32 s23, s23, s58
  s_mul_i32 s23, s23, 3840
  s_mul_i32 s22, s22, 5120
  s_add_u32 s22, s22, 117760
  s_add_u32 m0, s22, 0
  s_nop 0
  buffer_load_dwordx4 v13, s[16:19], s23 offen sc1 lds
  s_add_u32 m0, s22, 1024
  s_nop 0
  buffer_load_dwordx4 v14, s[16:19], s23 offen sc1 lds
  s_add_u32 m0, s22, 2048
  s_nop 0
  buffer_load_dwordx4 v15, s[16:19], s23 offen sc1 lds
  s_add_u32 m0, s22, 3072
  s_nop 0
  buffer_load_dwordx4 v16, s[16:19], s23 offen sc1 lds
  s_add_u32 m0, s22, 4096
  s_nop 0
  buffer_load_dwordx4 v17, s[16:19], s23 offen sc1 lds
  s_add_u32 s22, s20, 4
  s_lshl_b32 s23, s22, 2
  s_add_u32 s23, s23, s58
  s_mul_i32 s23, s23, 3840
  s_mul_i32 s22, s22, 5120
  s_add_u32 s22, s22, 117760
  s_add_u32 m0, s22, 0
  s_nop 0
  buffer_load_dwordx4 v13, s[16:19], s23 offen sc1 lds
  s_add_u32 m0, s22, 1024
  s_nop 0
  buffer_load_dwordx4 v14, s[16:19], s23 offen sc1 lds
  s_add_u32 m0, s22, 2048
  s_nop 0
  buffer_load_dwordx4 v15, s[16:19], s23 offen sc1 lds
  s_add_u32 m0, s22, 3072
  s_nop 0
  buffer_load_dwordx4 v16, s[16:19], s23 offen sc1 lds
  s_add_u32 m0, s22, 4096
  s_nop 0
  buffer_load_dwordx4 v17, s[16:19], s23 offen sc1 lds
  s_lshl_b32 s21, s20, 3
  s_add_u32 s59, s58, s21
  v_lshlrev_b32 v4, 2, v1
  buffer_load_dword v16, v4, s[12:15], 0 offen offset:0
  buffer_load_dword v17, v4, s[12:15], 0 offen offset:256
  buffer_load_dword v18, v4, s[12:15], 0 offen offset:512
  buffer_load_dword v19, v4, s[12:15], 0 offen offset:768
  buffer_load_dword v20, v4, s[12:15], 0 offen offset:1024
  s_mul_i32 s22, s59, 1280
  buffer_load_dword v32, v4, s[8:11], s22 offen offset:0
  buffer_load_dword v33, v4, s[8:11], s22 offen offset:256
  buffer_load_dword v34, v4, s[8:11], s22 offen offset:512
  buffer_load_dword v35, v4, s[8:11], s22 offen offset:768
  buffer_load_dword v36, v4, s[8:11], s22 offen offset:1024
  s_add_u32 s22, s22, 1280
  buffer_load_dword v37, v4, s[8:11], s22 offen offset:0
  buffer_load_dword v38, v4, s[8:11], s22 offen offset:256
  buffer_load_dword v39, v4, s[8:11], s22 offen offset:512
  buffer_load_dword v40, v4, s[8:11], s22 offen offset:768
  buffer_load_dword v41, v4, s[8:11], s22 offen offset:1024
  s_add_u32 s22, s22, 1280
  buffer_load_dword v42, v4, s[8:11], s22 offen offset:0
  buffer_load_dword v43, v4, s[8:11], s22 offen offset:256
  buffer_load_dword v44, v4, s[8:11], s22 offen offset:512
  buffer_load_dword v45, v4, s[8:11], s22 offen offset:768
  buffer_load_dword v46, v4, s[8:11], s22 offen offset:1024
  s_add_u32 s22, s22, 1280
  buffer_load_dword v47, v4, s[8:11], s22 offen offset:0
  buffer_load_dword v48, v4, s[8:11], s22 offen offset:256
  buffer_load_dword v49, v4, s[8:11], s22 offen offset:512
  buffer_load_dword v50, v4, s[8:11], s22 offen offset:768
  buffer_load_dword v51, v4, s[8:11], s22 offen offset:1024
  s_add_u32 s22, s22, 1280
  buffer_load_dword v52, v4, s[8:11], s22 offen offset:0
  buffer_load_dword v53, v4, s[8:11], s22 offen offset:256
  buffer_load_dword v54, v4, s[8:11], s22 offen offset:512
  buffer_load_dword v55, v4, s[8:11], s22 offen offset:768
  buffer_load_dword v56, v4, s[8:11], s22 offen offset:1024
  s_add_u32 s22, s22, 1280
  buffer_load_dword v57, v4, s[8:11], s22 offen offset:0
  buffer_load_dword v58, v4, s[8:11], s22 offen offset:256
  buffer_load_dword v59, v4, s[8:11], s22 offen offset:512
  buffer_load_dword v60, v4, s[8:11], s22 offen offset:768
  buffer_load_dword v61, v4, s[8:11], s22 offen offset:1024
  s_add_u32 s22, s22, 1280
  buffer_load_dword v62, v4, s[8:11], s22 offen offset:0
  buffer_load_dword v63, v4, s[8:11], s22 offen offset:256
  buffer_load_dword v64, v4, s[8:11], s22 offen offset:512
  buffer_load_dword v65, v4, s[8:11], s22 offen offset:768
  buffer_load_dword v66, v4, s[8:11], s22 offen offset:1024
  s_add_u32 s22, s22, 1280
  buffer_load_dword v67, v4, s[8:11], s22 offen offset:0
  buffer_load_dword v68, v4, s[8:11], s22 offen offset:256
  buffer_load_dword v69, v4, s[8:11], s22 offen offset:512
  buffer_load_dword v70, v4, s[8:11], s22 offen offset:768
  buffer_load_dword v71, v4, s[8:11], s22 offen offset:1024
  s_add_u32 s22, s22, 1280
  s_waitcnt vmcnt(40)
  v_lshlrev_b32 v8, 16, v16
  v_and_b32 v16, 0xffff0000, v16
  v_lshlrev_b32 v9, 16, v17
  v_and_b32 v17, 0xffff0000, v17
  v_lshlrev_b32 v10, 16, v18
  v_and_b32 v18, 0xffff0000, v18
  v_lshlrev_b32 v11, 16, v19
  v_and_b32 v19, 0xffff0000, v19
  v_lshlrev_b32 v12, 16, v20
  v_and_b32 v20, 0xffff0000, v20
  s_waitcnt vmcnt(35)
  v_mov_b32 v80, 0
  v_lshlrev_b32 v25, 16, v32
  v_and_b32 v26, 0xffff0000, v32
  v_mul_f32 v25, v25, v8
  v_mul_f32 v26, v26, v16
  v_cvt_pk_bf16_f32 v25, v25, v26
  v_lshlrev_b32 v26, 16, v25
  v_and_b32 v25, 0xffff0000, v25
  v_add_f32 v80, v80, v26
  v_add_f32 v80, v80, v25
  v_lshlrev_b32 v25, 16, v33
  v_and_b32 v26, 0xffff0000, v33
  v_mul_f32 v25, v25, v9
  v_mul_f32 v26, v26, v17
  v_cvt_pk_bf16_f32 v25, v25, v26
  v_lshlrev_b32 v26, 16, v25
  v_and_b32 v25, 0xffff0000, v25
  v_add_f32 v80, v80, v26
  v_add_f32 v80, v80, v25
  v_lshlrev_b32 v25, 16, v34
  v_and_b32 v26, 0xffff0000, v34
  v_mul_f32 v25, v25, v10
  v_mul_f32 v26, v26, v18
  v_cvt_pk_bf16_f32 v25, v25, v26
  v_lshlrev_b32 v26, 16, v25
  v_and_b32 v25, 0xffff0000, v25
  v_add_f32 v80, v80, v26
  v_add_f32 v80, v80, v25
  v_lshlrev_b32 v25, 16, v35
  v_and_b32 v26, 0xffff0000, v35
  v_mul_f32 v25, v25, v11
  v_mul_f32 v26, v26, v19
  v_cvt_pk_bf16_f32 v25, v25, v26
  v_lshlrev_b32 v26, 16, v25
  v_and_b32 v25, 0xffff0000, v25
  v_add_f32 v80, v80, v26
  v_add_f32 v80, v80, v25
  v_lshlrev_b32 v25, 16, v36
  v_and_b32 v26, 0xffff0000, v36
  v_mul_f32 v25, v25, v12
  v_mul_f32 v26, v26, v20
  v_cvt_pk_bf16_f32 v25, v25, v26
  v_lshlrev_b32 v26, 16, v25
  v_and_b32 v25, 0xffff0000, v25
  v_add_f32 v80, v80, v26
  v_add_f32 v80, v80, v25
  s_waitcnt vmcnt(30)
  v_mov_b32 v81, 0
  v_lshlrev_b32 v25, 16, v37
  v_and_b32 v26, 0xffff0000, v37
  v_mul_f32 v25, v25, v8
  v_mul_f32 v26, v26, v16
  v_cvt_pk_bf16_f32 v25, v25, v26
  v_lshlrev_b32 v26, 16, v25
  v_and_b32 v25, 0xffff0000, v25
  v_add_f32 v81, v81, v26
  v_add_f32 v81, v81, v25
  v_lshlrev_b32 v25, 16, v38
  v_and_b32 v26, 0xffff0000, v38
  v_mul_f32 v25, v25, v9
  v_mul_f32 v26, v26, v17
  v_cvt_pk_bf16_f32 v25, v25, v26
  v_lshlrev_b32 v26, 16, v25
  v_and_b32 v25, 0xffff0000, v25
  v_add_f32 v81, v81, v26
  v_add_f32 v81, v81, v25
  v_lshlrev_b32 v25, 16, v39
  v_and_b32 v26, 0xffff0000, v39
  v_mul_f32 v25, v25, v10
  v_mul_f32 v26, v26, v18
  v_cvt_pk_bf16_f32 v25, v25, v26
  v_lshlrev_b32 v26, 16, v25
  v_and_b32 v25, 0xffff0000, v25
  v_add_f32 v81, v81, v26
  v_add_f32 v81, v81, v25
  v_lshlrev_b32 v25, 16, v40
  v_and_b32 v26, 0xffff0000, v40
  v_mul_f32 v25, v25, v11
  v_mul_f32 v26, v26, v19
  v_cvt_pk_bf16_f32 v25, v25, v26
  v_lshlrev_b32 v26, 16, v25
  v_and_b32 v25, 0xffff0000, v25
  v_add_f32 v81, v81, v26
  v_add_f32 v81, v81, v25
  v_lshlrev_b32 v25, 16, v41
  v_and_b32 v26, 0xffff0000, v41
  v_mul_f32 v25, v25, v12
  v_mul_f32 v26, v26, v20
  v_cvt_pk_bf16_f32 v25, v25, v26
  v_lshlrev_b32 v26, 16, v25
  v_and_b32 v25, 0xffff0000, v25
  v_add_f32 v81, v81, v26
  v_add_f32 v81, v81, v25
  s_waitcnt vmcnt(25)
  v_mov_b32 v82, 0
  v_lshlrev_b32 v25, 16, v42
  v_and_b32 v26, 0xffff0000, v42
  v_mul_f32 v25, v25, v8
  v_mul_f32 v26, v26, v16
  v_cvt_pk_bf16_f32 v25, v25, v26
  v_lshlrev_b32 v26, 16, v25
  v_and_b32 v25, 0xffff0000, v25
  v_add_f32 v82, v82, v26
  v_add_f32 v82, v82, v25
  v_lshlrev_b32 v25, 16, v43
  v_and_b32 v26, 0xffff0000, v43
  v_mul_f32 v25, v25, v9
  v_mul_f32 v26, v26, v17
  v_cvt_pk_bf16_f32 v25, v25, v26
  v_lshlrev_b32 v26, 16, v25
  v_and_b32 v25, 0xffff0000, v25
  v_add_f32 v82, v82, v26
  v_add_f32 v82, v82, v25
  v_lshlrev_b32 v25, 16, v44
  v_and_b32 v26, 0xffff0000, v44
  v_mul_f32 v25, v25, v10
  v_mul_f32 v26, v26, v18
  v_cvt_pk_bf16_f32 v25, v25, v26
  v_lshlrev_b32 v26, 16, v25
  v_and_b32 v25, 0xffff0000, v25
  v_add_f32 v82, v82, v26
  v_add_f32 v82, v82, v25
  v_lshlrev_b32 v25, 16, v45
  v_and_b32 v26, 0xffff0000, v45
  v_mul_f32 v25, v25, v11
  v_mul_f32 v26, v26, v19
  v_cvt_pk_bf16_f32 v25, v25, v26
  v_lshlrev_b32 v26, 16, v25
  v_and_b32 v25, 0xffff0000, v25
  v_add_f32 v82, v82, v26
  v_add_f32 v82, v82, v25
  v_lshlrev_b32 v25, 16, v46
  v_and_b32 v26, 0xffff0000, v46
  v_mul_f32 v25, v25, v12
  v_mul_f32 v26, v26, v20
  v_cvt_pk_bf16_f32 v25, v25, v26
  v_lshlrev_b32 v26, 16, v25
  v_and_b32 v25, 0xffff0000, v25
  v_add_f32 v82, v82, v26
  v_add_f32 v82, v82, v25
  s_waitcnt vmcnt(20)
  v_mov_b32 v83, 0
  v_lshlrev_b32 v25, 16, v47
  v_and_b32 v26, 0xffff0000, v47
  v_mul_f32 v25, v25, v8
  v_mul_f32 v26, v26, v16
  v_cvt_pk_bf16_f32 v25, v25, v26
  v_lshlrev_b32 v26, 16, v25
  v_and_b32 v25, 0xffff0000, v25
  v_add_f32 v83, v83, v26
  v_add_f32 v83, v83, v25
  v_lshlrev_b32 v25, 16, v48
  v_and_b32 v26, 0xffff0000, v48
  v_mul_f32 v25, v25, v9
  v_mul_f32 v26, v26, v17
  v_cvt_pk_bf16_f32 v25, v25, v26
  v_lshlrev_b32 v26, 16, v25
  v_and_b32 v25, 0xffff0000, v25
  v_add_f32 v83, v83, v26
  v_add_f32 v83, v83, v25
  v_lshlrev_b32 v25, 16, v49
  v_and_b32 v26, 0xffff0000, v49
  v_mul_f32 v25, v25, v10
  v_mul_f32 v26, v26, v18
  v_cvt_pk_bf16_f32 v25, v25, v26
  v_lshlrev_b32 v26, 16, v25
  v_and_b32 v25, 0xffff0000, v25
  v_add_f32 v83, v83, v26
  v_add_f32 v83, v83, v25
  v_lshlrev_b32 v25, 16, v50
  v_and_b32 v26, 0xffff0000, v50
  v_mul_f32 v25, v25, v11
  v_mul_f32 v26, v26, v19
  v_cvt_pk_bf16_f32 v25, v25, v26
  v_lshlrev_b32 v26, 16, v25
  v_and_b32 v25, 0xffff0000, v25
  v_add_f32 v83, v83, v26
  v_add_f32 v83, v83, v25
  v_lshlrev_b32 v25, 16, v51
  v_and_b32 v26, 0xffff0000, v51
  v_mul_f32 v25, v25, v12
  v_mul_f32 v26, v26, v20
  v_cvt_pk_bf16_f32 v25, v25, v26
  v_lshlrev_b32 v26, 16, v25
  v_and_b32 v25, 0xffff0000, v25
  v_add_f32 v83, v83, v26
  v_add_f32 v83, v83, v25
  s_waitcnt vmcnt(15)
  v_mov_b32 v84, 0
  v_lshlrev_b32 v25, 16, v52
  v_and_b32 v26, 0xffff0000, v52
  v_mul_f32 v25, v25, v8
  v_mul_f32 v26, v26, v16
  v_cvt_pk_bf16_f32 v25, v25, v26
  v_lshlrev_b32 v26, 16, v25
  v_and_b32 v25, 0xffff0000, v25
  v_add_f32 v84, v84, v26
  v_add_f32 v84, v84, v25
  v_lshlrev_b32 v25, 16, v53
  v_and_b32 v26, 0xffff0000, v53
  v_mul_f32 v25, v25, v9
  v_mul_f32 v26, v26, v17
  v_cvt_pk_bf16_f32 v25, v25, v26
  v_lshlrev_b32 v26, 16, v25
  v_and_b32 v25, 0xffff0000, v25
  v_add_f32 v84, v84, v26
  v_add_f32 v84, v84, v25
  v_lshlrev_b32 v25, 16, v54
  v_and_b32 v26, 0xffff0000, v54
  v_mul_f32 v25, v25, v10
  v_mul_f32 v26, v26, v18
  v_cvt_pk_bf16_f32 v25, v25, v26
  v_lshlrev_b32 v26, 16, v25
  v_and_b32 v25, 0xffff0000, v25
  v_add_f32 v84, v84, v26
  v_add_f32 v84, v84, v25
  v_lshlrev_b32 v25, 16, v55
  v_and_b32 v26, 0xffff0000, v55
  v_mul_f32 v25, v25, v11
  v_mul_f32 v26, v26, v19
  v_cvt_pk_bf16_f32 v25, v25, v26
  v_lshlrev_b32 v26, 16, v25
  v_and_b32 v25, 0xffff0000, v25
  v_add_f32 v84, v84, v26
  v_add_f32 v84, v84, v25
  v_lshlrev_b32 v25, 16, v56
  v_and_b32 v26, 0xffff0000, v56
  v_mul_f32 v25, v25, v12
  v_mul_f32 v26, v26, v20
  v_cvt_pk_bf16_f32 v25, v25, v26
  v_lshlrev_b32 v26, 16, v25
  v_and_b32 v25, 0xffff0000, v25
  v_add_f32 v84, v84, v26
  v_add_f32 v84, v84, v25
  s_waitcnt vmcnt(10)
  v_mov_b32 v85, 0
  v_lshlrev_b32 v25, 16, v57
  v_and_b32 v26, 0xffff0000, v57
  v_mul_f32 v25, v25, v8
  v_mul_f32 v26, v26, v16
  v_cvt_pk_bf16_f32 v25, v25, v26
  v_lshlrev_b32 v26, 16, v25
  v_and_b32 v25, 0xffff0000, v25
  v_add_f32 v85, v85, v26
  v_add_f32 v85, v85, v25
  v_lshlrev_b32 v25, 16, v58
  v_and_b32 v26, 0xffff0000, v58
  v_mul_f32 v25, v25, v9
  v_mul_f32 v26, v26, v17
  v_cvt_pk_bf16_f32 v25, v25, v26
  v_lshlrev_b32 v26, 16, v25
  v_and_b32 v25, 0xffff0000, v25
  v_add_f32 v85, v85, v26
  v_add_f32 v85, v85, v25
  v_lshlrev_b32 v25, 16, v59
  v_and_b32 v26, 0xffff0000, v59
  v_mul_f32 v25, v25, v10
  v_mul_f32 v26, v26, v18
  v_cvt_pk_bf16_f32 v25, v25, v26
  v_lshlrev_b32 v26, 16, v25
  v_and_b32 v25, 0xffff0000, v25
  v_add_f32 v85, v85, v26
  v_add_f32 v85, v85, v25
  v_lshlrev_b32 v25, 16, v60
  v_and_b32 v26, 0xffff0000, v60
  v_mul_f32 v25, v25, v11
  v_mul_f32 v26, v26, v19
  v_cvt_pk_bf16_f32 v25, v25, v26
  v_lshlrev_b32 v26, 16, v25
  v_and_b32 v25, 0xffff0000, v25
  v_add_f32 v85, v85, v26
  v_add_f32 v85, v85, v25
  v_lshlrev_b32 v25, 16, v61
  v_and_b32 v26, 0xffff0000, v61
  v_mul_f32 v25, v25, v12
  v_mul_f32 v26, v26, v20
  v_cvt_pk_bf16_f32 v25, v25, v26
  v_lshlrev_b32 v26, 16, v25
  v_and_b32 v25, 0xffff0000, v25
  v_add_f32 v85, v85, v26
  v_add_f32 v85, v85, v25
  s_waitcnt vmcnt(5)
  v_mov_b32 v86, 0
  v_lshlrev_b32 v25, 16, v62
  v_and_b32 v26, 0xffff0000, v62
  v_mul_f32 v25, v25, v8
  v_mul_f32 v26, v26, v16
  v_cvt_pk_bf16_f32 v25, v25, v26
  v_lshlrev_b32 v26, 16, v25
  v_and_b32 v25, 0xffff0000, v25
  v_add_f32 v86, v86, v26
  v_add_f32 v86, v86, v25
  v_lshlrev_b32 v25, 16, v63
  v_and_b32 v26, 0xffff0000, v63
  v_mul_f32 v25, v25, v9
  v_mul_f32 v26, v26, v17
  v_cvt_pk_bf16_f32 v25, v25, v26
  v_lshlrev_b32 v26, 16, v25
  v_and_b32 v25, 0xffff0000, v25
  v_add_f32 v86, v86, v26
  v_add_f32 v86, v86, v25
  v_lshlrev_b32 v25, 16, v64
  v_and_b32 v26, 0xffff0000, v64
  v_mul_f32 v25, v25, v10
  v_mul_f32 v26, v26, v18
  v_cvt_pk_bf16_f32 v25, v25, v26
  v_lshlrev_b32 v26, 16, v25
  v_and_b32 v25, 0xffff0000, v25
  v_add_f32 v86, v86, v26
  v_add_f32 v86, v86, v25
  v_lshlrev_b32 v25, 16, v65
  v_and_b32 v26, 0xffff0000, v65
  v_mul_f32 v25, v25, v11
  v_mul_f32 v26, v26, v19
  v_cvt_pk_bf16_f32 v25, v25, v26
  v_lshlrev_b32 v26, 16, v25
  v_and_b32 v25, 0xffff0000, v25
  v_add_f32 v86, v86, v26
  v_add_f32 v86, v86, v25
  v_lshlrev_b32 v25, 16, v66
  v_and_b32 v26, 0xffff0000, v66
  v_mul_f32 v25, v25, v12
  v_mul_f32 v26, v26, v20
  v_cvt_pk_bf16_f32 v25, v25, v26
  v_lshlrev_b32 v26, 16, v25
  v_and_b32 v25, 0xffff0000, v25
  v_add_f32 v86, v86, v26
  v_add_f32 v86, v86, v25
  s_waitcnt vmcnt(0)
  v_mov_b32 v87, 0
  v_lshlrev_b32 v25, 16, v67
  v_and_b32 v26, 0xffff0000, v67
  v_mul_f32 v25, v25, v8
  v_mul_f32 v26, v26, v16
  v_cvt_pk_bf16_f32 v25, v25, v26
  v_lshlrev_b32 v26, 16, v25
  v_and_b32 v25, 0xffff0000, v25
  v_add_f32 v87, v87, v26
  v_add_f32 v87, v87, v25
  v_lshlrev_b32 v25, 16, v68
  v_and_b32 v26, 0xffff0000, v68
  v_mul_f32 v25, v25, v9
  v_mul_f32 v26, v26, v17
  v_cvt_pk_bf16_f32 v25, v25, v26
  v_lshlrev_b32 v26, 16, v25
  v_and_b32 v25, 0xffff0000, v25
  v_add_f32 v87, v87, v26
  v_add_f32 v87, v87, v25
  v_lshlrev_b32 v25, 16, v69
  v_and_b32 v26, 0xffff0000, v69
  v_mul_f32 v25, v25, v10
  v_mul_f32 v26, v26, v18
  v_cvt_pk_bf16_f32 v25, v25, v26
  v_lshlrev_b32 v26, 16, v25
  v_and_b32 v25, 0xffff0000, v25
  v_add_f32 v87, v87, v26
  v_add_f32 v87, v87, v25
  v_lshlrev_b32 v25, 16, v70
  v_and_b32 v26, 0xffff0000, v70
  v_mul_f32 v25, v25, v11
  v_mul_f32 v26, v26, v19
  v_cvt_pk_bf16_f32 v25, v25, v26
  v_lshlrev_b32 v26, 16, v25
  v_and_b32 v25, 0xffff0000, v25
  v_add_f32 v87, v87, v26
  v_add_f32 v87, v87, v25
  v_lshlrev_b32 v25, 16, v71
  v_and_b32 v26, 0xffff0000, v71
  v_mul_f32 v25, v25, v12
  v_mul_f32 v26, v26, v20
  v_cvt_pk_bf16_f32 v25, v25, v26
  v_lshlrev_b32 v26, 16, v25
  v_and_b32 v25, 0xffff0000, v25
  v_add_f32 v87, v87, v26
  v_add_f32 v87, v87, v25
  v_add_f32_dpp v80, v80, v80 row_ror:8 row_mask:0xf bank_mask:0xf
  v_add_f32_dpp v81, v81, v81 row_ror:8 row_mask:0xf bank_mask:0xf
  v_add_f32_dpp v82, v82, v82 row_ror:8 row_mask:0xf bank_mask:0xf
  v_add_f32_dpp v83, v83, v83 row_ror:8 row_mask:0xf bank_mask:0xf
  v_add_f32_dpp v84, v84, v84 row_ror:8 row_mask:0xf bank_mask:0xf
  v_add_f32_dpp v85, v85, v85 row_ror:8 row_mask:0xf bank_mask:0xf
  v_add_f32_dpp v86, v86, v86 row_ror:8 row_mask:0xf bank_mask:0xf
  v_add_f32_dpp v87, v87, v87 row_ror:8 row_mask:0xf bank_mask:0xf
  v_add_f32_dpp v80, v80, v80 row_ror:4 row_mask:0xf bank_mask:0xf
  v_add_f32_dpp v81, v81, v81 row_ror:4 row_mask:0xf bank_mask:0xf
  v_add_f32_dpp v82, v82, v82 row_ror:4 row_mask:0xf bank_mask:0xf
  v_add_f32_dpp v83, v83, v83 row_ror:4 row_mask:0xf bank_mask:0xf
  v_add_f32_dpp v84, v84, v84 row_ror:4 row_mask:0xf bank_mask:0xf
  v_add_f32_dpp v85, v85, v85 row_ror:4 row_mask:0xf bank_mask:0xf
  v_add_f32_dpp v86, v86, v86 row_ror:4 row_mask:0xf bank_mask:0xf
  v_add_f32_dpp v87, v87, v87 row_ror:4 row_mask:0xf bank_mask:0xf
  v_add_f32_dpp v80, v80, v80 row_ror:2 row_mask:0xf bank_mask:0xf
  v_add_f32_dpp v81, v81, v81 row_ror:2 row_mask:0xf bank_mask:0xf
  v_add_f32_dpp v82, v82, v82 row_ror:2 row_mask:0xf bank_mask:0xf
  v_add_f32_dpp v83, v83, v83 row_ror:2 row_mask:0xf bank_mask:0xf
  v_add_f32_dpp v84, v84, v84 row_ror:2 row_mask:0xf bank_mask:0xf
  v_add_f32_dpp v85, v85, v85 row_ror:2 row_mask:0xf bank_mask:0xf
  v_add_f32_dpp v86, v86, v86 row_ror:2 row_mask:0xf bank_mask:0xf
  v_add_f32_dpp v87, v87, v87 row_ror:2 row_mask:0xf bank_mask:0xf
  v_add_f32_dpp v80, v80, v80 row_ror:1 row_mask:0xf bank_mask:0xf
  v_add_f32_dpp v81, v81, v81 row_ror:1 row_mask:0xf bank_mask:0xf
  v_add_f32_dpp v82, v82, v82 row_ror:1 row_mask:0xf bank_mask:0xf
  v_add_f32_dpp v83, v83, v83 row_ror:1 row_mask:0xf bank_mask:0xf
  v_add_f32_dpp v84, v84, v84 row_ror:1 row_mask:0xf bank_mask:0xf
  v_add_f32_dpp v85, v85, v85 row_ror:1 row_mask:0xf bank_mask:0xf
  v_add_f32_dpp v86, v86, v86 row_ror:1 row_mask:0xf bank_mask:0xf
  v_add_f32_dpp v87, v87, v87 row_ror:1 row_mask:0xf bank_mask:0xf
  v_mov_b32 v88, v80
  v_mov_b32 v89, v81
  v_mov_b32 v90, v82
  v_mov_b32 v91, v83
  v_mov_b32 v92, v84
  v_mov_b32 v93, v85
  v_mov_b32 v94, v86
  v_mov_b32 v95, v87
  v_permlane32_swap_b32 v80, v88
  v_permlane32_swap_b32 v81, v89
  v_permlane32_swap_b32 v82, v90
  v_permlane32_swap_b32 v83, v91
  v_permlane32_swap_b32 v84, v92
  v_permlane32_swap_b32 v85, v93
  v_permlane32_swap_b32 v86, v94
  v_permlane32_swap_b32 v87, v95
  v_add_f32 v80, v80, v88
  v_add_f32 v81, v81, v89
  v_add_f32 v82, v82, v90
  v_add_f32 v83, v83, v91
  v_add_f32 v84, v84, v92
  v_add_f32 v85, v85, v93
  v_add_f32 v86, v86, v94
  v_add_f32 v87, v87, v95
  v_mov_b32 v88, v80
  v_mov_b32 v89, v81
  v_mov_b32 v90, v82
  v_mov_b32 v91, v83
  v_mov_b32 v92, v84
  v_mov_b32 v93, v85
  v_mov_b32 v94, v86
  v_mov_b32 v95, v87
  v_permlane16_swap_b32 v80, v88
  v_permlane16_swap_b32 v81, v89
  v_permlane16_swap_b32 v82, v90
  v_permlane16_swap_b32 v83, v91
  v_permlane16_swap_b32 v84, v92
  v_permlane16_swap_b32 v85, v93
  v_permlane16_swap_b32 v86, v94
  v_permlane16_swap_b32 v87, v95
  v_add_f32 v80, v80, v88
  v_add_f32 v81, v81, v89
  v_add_f32 v82, v82, v90
  v_add_f32 v83, v83, v91
  v_add_f32 v84, v84, v92
  v_add_f32 v85, v85, v93
  v_add_f32 v86, v86, v94
  v_add_f32 v87, v87, v95
  v_mov_b32 v24, v80
  v_cmp_eq_u32 vcc, 1, v1
  s_nop 1
  v_cndmask_b32 v24, v24, v81, vcc
  v_cmp_eq_u32 vcc, 2, v1
  s_nop 1
  v_cndmask_b32 v24, v24, v82, vcc
  v_cmp_eq_u32 vcc, 3, v1
  s_nop 1
  v_cndmask_b32 v24, v24, v83, vcc
  v_cmp_eq_u32 vcc, 4, v1
  s_nop 1
  v_cndmask_b32 v24, v24, v84, vcc
  v_cmp_eq_u32 vcc, 5, v1
  s_nop 1
  v_cndmask_b32 v24, v24, v85, vcc
  v_cmp_eq_u32 vcc, 6, v1
  s_nop 1
  v_cndmask_b32 v24, v24, v86, vcc
  v_cmp_eq_u32 vcc, 7, v1
  s_nop 1
  v_cndmask_b32 v24, v24, v87, vcc
  v_cvt_pk_bf16_f32 v25, v24, v24
  v_lshlrev_b32 v24, 16, v25
  v_mul_f32 v24, 0xbfb8aa3b, v24
  v_exp_f32 v24, v24
  s_nop 0
  v_add_f32 v24, 1.0, v24
  v_rcp_f32 v24, v24
  s_nop 0
  v_cvt_pk_bf16_f32 v25, v24, v24
  v_lshlrev_b32 v24, 16, v25
  s_lshl_b32 s21, s59, 2
  s_mov_b64 exec, 0xff
  buffer_store_dword v24, v4, s[28:31], s21 offen sc1
  s_mov_b64 exec, -1
  s_barrier
  v_and_b32 v4, 31, v1
  v_lshrrev_b32 v5, 5, v1
  s_lshl_b32 s22, s20, 1
  v_add_u32 v5, s22, v5
  v_mul_u32_u24 v6, 40, v4
  v_mul_u32_u24 v7, 2560, v5
  v_add_u32 v7, v7, v6
  v_mul_u32_u24 v8, 1280, v5
  s_mov_b32 s22, 117760
  v_add3_u32 v8, v8, v6, s22
  v_add_u32 v5, s58, v5
  s_mov_b32 s59, 0
  s_mov_b32 s60, 0x3e64f92e
  s_mov_b32 s61, 0x3fb8aa3b
  s_mov_b32 s62, 0x05040100
  s_mov_b32 s63, 0x07060302
  v_mov_b32 v9, 0xf149f2ca
ba_388:
  ds_read_b64 v[16:17], v8 offset:0
  ds_read_b64 v[18:19], v8 offset:8
  ds_read_b64 v[20:21], v8 offset:16
  ds_read_b64 v[22:23], v8 offset:24
  ds_read_b64 v[24:25], v8 offset:32
  ds_read_b64 v[32:33], v7 offset:35840
  ds_read_b64 v[34:35], v7 offset:35848
  ds_read_b64 v[36:37], v7 offset:35856
  ds_read_b64 v[38:39], v7 offset:35864
  ds_read_b64 v[40:41], v7 offset:35872
  ds_read_b64 v[42:43], v7 offset:30720
  ds_read_b64 v[44:45], v7 offset:30728
  ds_read_b64 v[46:47], v7 offset:30736
  ds_read_b64 v[48:49], v7 offset:30744
  ds_read_b64 v[50:51], v7 offset:30752
  ds_read_b64 v[52:53], v7 offset:25600
  ds_read_b64 v[54:55], v7 offset:25608
  ds_read_b64 v[56:57], v7 offset:25616
  ds_read_b64 v[58:59], v7 offset:25624
  ds_read_b64 v[60:61], v7 offset:25632
  ds_read_b64 v[62:63], v7 offset:20480
  ds_read_b64 v[64:65], v7 offset:20488
  ds_read_b64 v[66:67], v7 offset:20496
  ds_read_b64 v[68:69], v7 offset:20504
  ds_read_b64 v[70:71], v7 offset:20512
  ds_read_b64 v[72:73], v7 offset:15360
  ds_read_b64 v[74:75], v7 offset:15368
  ds_read_b64 v[76:77], v7 offset:15376
  ds_read_b64 v[78:79], v7 offset:15384
  ds_read_b64 v[80:81], v7 offset:15392
  ds_read_b64 v[82:83], v7 offset:10240
  ds_read_b64 v[84:85], v7 offset:10248
  ds_read_b64 v[86:87], v7 offset:10256
  ds_read_b64 v[88:89], v7 offset:10264
  ds_read_b64 v[90:91], v7 offset:10272
  ds_read_b64 v[92:93], v7 offset:5120
  ds_read_b64 v[94:95], v7 offset:5128
  ds_read_b64 v[96:97], v7 offset:5136
  ds_read_b64 v[98:99], v7 offset:5144
  ds_read_b64 v[100:101], v7 offset:5152
  ds_read_b64 v[102:103], v7 offset:0
  ds_read_b64 v[104:105], v7 offset:8
  ds_read_b64 v[106:107], v7 offset:16
  ds_read_b64 v[108:109], v7 offset:24
  ds_read_b64 v[110:111], v7 offset:32
  v_cmp_le_u32 s[40:41], 0, v5
  v_mov_b32 v224, 0
  v_cmp_le_u32 s[42:43], 2, v5
  v_mov_b32 v225, 0
  v_cmp_le_u32 s[44:45], 4, v5
  v_mov_b32 v226, 0
  v_cmp_le_u32 s[46:47], 6, v5
  v_mov_b32 v227, 0
  v_cmp_le_u32 s[48:49], 8, v5
  v_mov_b32 v228, 0
  v_cmp_le_u32 s[50:51], 10, v5
  v_mov_b32 v229, 0
  v_cmp_le_u32 s[52:53], 12, v5
  v_mov_b32 v230, 0
  v_cmp_le_u32 s[54:55], 14, v5
  v_mov_b32 v231, 0
  v_mov_b32 v200, 0
  v_mov_b32 v201, 0
  v_mov_b32 v202, 0
  v_mov_b32 v203, 0
  v_mov_b32 v204, 0
  v_mov_b32 v205, 0
  v_mov_b32 v206, 0
  v_mov_b32 v207, 0
  v_mov_b32 v208, 0
  v_mov_b32 v209, 0
  v_mov_b32 v210, 0
  v_mov_b32 v211, 0
  v_mov_b32 v212, 0
  v_mov_b32 v213, 0
  v_mov_b32 v214, 0
  v_mov_b32 v215, 0
  v_mov_b32 v216, 0
  v_mov_b32 v217, 0
  v_mov_b32 v218, 0
  v_mov_b32 v219, 0
  s_waitcnt lgkmcnt(15)
  v_dot2c_f32_bf16 v224, v32, v16
  v_dot2c_f32_bf16 v225, v42, v16
  v_dot2c_f32_bf16 v226, v52, v16
  v_dot2c_f32_bf16 v227, v62, v16
  v_dot2c_f32_bf16 v228, v72, v16
  v_dot2c_f32_bf16 v224, v33, v17
  v_dot2c_f32_bf16 v225, v43, v17
  v_dot2c_f32_bf16 v226, v53, v17
  v_dot2c_f32_bf16 v227, v63, v17
  v_dot2c_f32_bf16 v228, v73, v17
  v_dot2c_f32_bf16 v224, v34, v18
  v_dot2c_f32_bf16 v225, v44, v18
  v_dot2c_f32_bf16 v226, v54, v18
  v_dot2c_f32_bf16 v227, v64, v18
  v_dot2c_f32_bf16 v228, v74, v18
  v_dot2c_f32_bf16 v224, v35, v19
  v_dot2c_f32_bf16 v225, v45, v19
  v_dot2c_f32_bf16 v226, v55, v19
  v_dot2c_f32_bf16 v227, v65, v19
  v_dot2c_f32_bf16 v228, v75, v19
  v_dot2c_f32_bf16 v224, v36, v20
  v_dot2c_f32_bf16 v225, v46, v20
  v_dot2c_f32_bf16 v226, v56, v20
  v_dot2c_f32_bf16 v227, v66, v20
  v_dot2c_f32_bf16 v228, v76, v20
  v_dot2c_f32_bf16 v224, v37, v21
  v_dot2c_f32_bf16 v225, v47, v21
  v_dot2c_f32_bf16 v226, v57, v21
  v_dot2c_f32_bf16 v227, v67, v21
  v_dot2c_f32_bf16 v228, v77, v21
  v_dot2c_f32_bf16 v224, v38, v22
  v_dot2c_f32_bf16 v225, v48, v22
  v_dot2c_f32_bf16 v226, v58, v22
  v_dot2c_f32_bf16 v227, v68, v22
  v_dot2c_f32_bf16 v228, v78, v22
  v_dot2c_f32_bf16 v224, v39, v23
  v_dot2c_f32_bf16 v225, v49, v23
  v_dot2c_f32_bf16 v226, v59, v23
  v_dot2c_f32_bf16 v227, v69, v23
  v_dot2c_f32_bf16 v228, v79, v23
  v_dot2c_f32_bf16 v224, v40, v24
  v_dot2c_f32_bf16 v225, v50, v24
  v_dot2c_f32_bf16 v226, v60, v24
  v_dot2c_f32_bf16 v227, v70, v24
  v_dot2c_f32_bf16 v228, v80, v24
  v_dot2c_f32_bf16 v224, v41, v25
  v_dot2c_f32_bf16 v225, v51, v25
  v_dot2c_f32_bf16 v226, v61, v25
  v_dot2c_f32_bf16 v227, v71, v25
  v_dot2c_f32_bf16 v228, v81, v25
  s_waitcnt lgkmcnt(0)
  v_dot2c_f32_bf16 v229, v82, v16
  v_dot2c_f32_bf16 v230, v92, v16
  v_dot2c_f32_bf16 v231, v102, v16
  v_dot2c_f32_bf16 v229, v83, v17
  v_dot2c_f32_bf16 v230, v93, v17
  v_dot2c_f32_bf16 v231, v103, v17
  v_dot2c_f32_bf16 v229, v84, v18
  v_dot2c_f32_bf16 v230, v94, v18
  v_dot2c_f32_bf16 v231, v104, v18
  v_dot2c_f32_bf16 v229, v85, v19
  v_dot2c_f32_bf16 v230, v95, v19
  v_dot2c_f32_bf16 v231, v105, v19
  v_dot2c_f32_bf16 v229, v86, v20
  v_dot2c_f32_bf16 v230, v96, v20
  v_dot2c_f32_bf16 v231, v106, v20
  v_dot2c_f32_bf16 v229, v87, v21
  v_dot2c_f32_bf16 v230, v97, v21
  v_dot2c_f32_bf16 v231, v107, v21
  v_dot2c_f32_bf16 v229, v88, v22
  v_dot2c_f32_bf16 v230, v98, v22
  v_dot2c_f32_bf16 v231, v108, v22
  v_dot2c_f32_bf16 v229, v89, v23
  v_dot2c_f32_bf16 v230, v99, v23
  v_dot2c_f32_bf16 v231, v109, v23
  v_dot2c_f32_bf16 v229, v90, v24
  v_dot2c_f32_bf16 v230, v100, v24
  v_dot2c_f32_bf16 v231, v110, v24
  v_dot2c_f32_bf16 v229, v91, v25
  v_dot2c_f32_bf16 v230, v101, v25
  v_dot2c_f32_bf16 v231, v111, v25
  ds_read_b64 v[112:113], v7 offset:37120
  ds_read_b64 v[114:115], v7 offset:37128
  ds_read_b64 v[116:117], v7 offset:37136
  ds_read_b64 v[118:119], v7 offset:37144
  ds_read_b64 v[120:121], v7 offset:37152
  ds_read_b64 v[122:123], v7 offset:32000
  ds_read_b64 v[124:125], v7 offset:32008
  ds_read_b64 v[126:127], v7 offset:32016
  ds_read_b64 v[128:129], v7 offset:32024
  ds_read_b64 v[130:131], v7 offset:32032
  ds_read_b64 v[132:133], v7 offset:26880
  ds_read_b64 v[134:135], v7 offset:26888
  ds_read_b64 v[136:137], v7 offset:26896
  ds_read_b64 v[138:139], v7 offset:26904
  ds_read_b64 v[140:141], v7 offset:26912
  ds_read_b64 v[142:143], v7 offset:21760
  ds_read_b64 v[144:145], v7 offset:21768
  ds_read_b64 v[146:147], v7 offset:21776
  ds_read_b64 v[148:149], v7 offset:21784
  ds_read_b64 v[150:151], v7 offset:21792
  ds_read_b64 v[152:153], v7 offset:16640
  ds_read_b64 v[154:155], v7 offset:16648
  ds_read_b64 v[156:157], v7 offset:16656
  ds_read_b64 v[158:159], v7 offset:16664
  ds_read_b64 v[160:161], v7 offset:16672
  ds_read_b64 v[162:163], v7 offset:11520
  ds_read_b64 v[164:165], v7 offset:11528
  ds_read_b64 v[166:167], v7 offset:11536
  ds_read_b64 v[168:169], v7 offset:11544
  ds_read_b64 v[170:171], v7 offset:11552
  ds_read_b64 v[172:173], v7 offset:6400
  ds_read_b64 v[174:175], v7 offset:6408
  ds_read_b64 v[176:177], v7 offset:6416
  ds_read_b64 v[178:179], v7 offset:6424
  ds_read_b64 v[180:181], v7 offset:6432
  ds_read_b64 v[182:183], v7 offset:1280
  ds_read_b64 v[184:185], v7 offset:1288
  ds_read_b64 v[186:187], v7 offset:1296
  ds_read_b64 v[188:189], v7 offset:1304
  ds_read_b64 v[190:191], v7 offset:1312
  v_cvt_pk_bf16_f32 v10, v224, v225
  v_lshlrev_b32 v224, 16, v10
  v_and_b32 v225, 0xffff0000, v10
  v_mul_f32 v224, s60, v224
  v_mul_f32 v225, s60, v225
  v_cvt_pk_bf16_f32 v10, v224, v225
  v_lshlrev_b32 v224, 16, v10
  v_and_b32 v225, 0xffff0000, v10
  v_cndmask_b32 v224, v9, v224, s[40:41]
  v_cndmask_b32 v225, v9, v225, s[42:43]
  v_cvt_pk_bf16_f32 v10, v226, v227
  v_lshlrev_b32 v226, 16, v10
  v_and_b32 v227, 0xffff0000, v10
  v_mul_f32 v226, s60, v226
  v_mul_f32 v227, s60, v227
  v_cvt_pk_bf16_f32 v10, v226, v227
  v_lshlrev_b32 v226, 16, v10
  v_and_b32 v227, 0xffff0000, v10
  v_cndmask_b32 v226, v9, v226, s[44:45]
  v_cndmask_b32 v227, v9, v227, s[46:47]
  v_cvt_pk_bf16_f32 v10, v228, v229
  v_lshlrev_b32 v228, 16, v10
  v_and_b32 v229, 0xffff0000, v10
  v_mul_f32 v228, s60, v228
  v_mul_f32 v229, s60, v229
  v_cvt_pk_bf16_f32 v10, v228, v229
  v_lshlrev_b32 v228, 16, v10
  v_and_b32 v229, 0xffff0000, v10
  v_cndmask_b32 v228, v9, v228, s[48:49]
  v_cndmask_b32 v229, v9, v229, s[50:51]
  v_cvt_pk_bf16_f32 v10, v230, v231
  v_lshlrev_b32 v230, 16, v10
  v_and_b32 v231, 0xffff0000, v10
  v_mul_f32 v230, s60, v230
  v_mul_f32 v231, s60, v231
  v_cvt_pk_bf16_f32 v10, v230, v231
  v_lshlrev_b32 v230, 16, v10
  v_and_b32 v231, 0xffff0000, v10
  v_cndmask_b32 v230, v9, v230, s[52:53]
  v_cndmask_b32 v231, v9, v231, s[54:55]
  v_max3_f32 v12, v224, v225, v226
  v_max3_f32 v12, v12, v227, v228
  v_max3_f32 v12, v12, v229, v230
  v_max_f32 v12, v12, v231
  v_sub_f32 v224, v224, v12
  v_mul_f32 v224, s61, v224
  v_exp_f32 v224, v224
  v_sub_f32 v225, v225, v12
  v_mul_f32 v225, s61, v225
  v_exp_f32 v225, v225
  v_sub_f32 v226, v226, v12
  v_mul_f32 v226, s61, v226
  v_exp_f32 v226, v226
  v_sub_f32 v227, v227, v12
  v_mul_f32 v227, s61, v227
  v_exp_f32 v227, v227
  v_sub_f32 v228, v228, v12
  v_mul_f32 v228, s61, v228
  v_exp_f32 v228, v228
  v_sub_f32 v229, v229, v12
  v_mul_f32 v229, s61, v229
  v_exp_f32 v229, v229
  v_sub_f32 v230, v230, v12
  v_mul_f32 v230, s61, v230
  v_exp_f32 v230, v230
  v_sub_f32 v231, v231, v12
  v_mul_f32 v231, s61, v231
  v_exp_f32 v231, v231
  s_nop 0
  v_add_f32 v12, v224, v225
  v_add_f32 v12, v12, v226
  v_add_f32 v12, v12, v227
  v_add_f32 v12, v12, v228
  v_add_f32 v12, v12, v229
  v_add_f32 v12, v12, v230
  v_add_f32 v12, v12, v231
  v_rcp_f32 v12, v12
  s_nop 0
  v_mul_f32 v224, v224, v12
  v_mul_f32 v225, v225, v12
  v_mul_f32 v226, v226, v12
  v_mul_f32 v227, v227, v12
  v_mul_f32 v228, v228, v12
  v_mul_f32 v229, v229, v12
  v_mul_f32 v230, v230, v12
  v_mul_f32 v231, v231, v12
  v_cvt_pk_bf16_f32 v232, v224, v225
  v_cvt_pk_bf16_f32 v233, v226, v227
  v_cvt_pk_bf16_f32 v234, v228, v229
  v_cvt_pk_bf16_f32 v235, v230, v231
  s_waitcnt lgkmcnt(15)
  v_perm_b32 v236, v122, v112, s62
  v_perm_b32 v237, v122, v112, s63
  v_dot2c_f32_bf16 v200, v236, v232
  v_dot2c_f32_bf16 v201, v237, v232
  v_perm_b32 v238, v123, v113, s62
  v_perm_b32 v239, v123, v113, s63
  v_dot2c_f32_bf16 v202, v238, v232
  v_dot2c_f32_bf16 v203, v239, v232
  v_perm_b32 v240, v124, v114, s62
  v_perm_b32 v241, v124, v114, s63
  v_dot2c_f32_bf16 v204, v240, v232
  v_dot2c_f32_bf16 v205, v241, v232
  v_perm_b32 v242, v125, v115, s62
  v_perm_b32 v243, v125, v115, s63
  v_dot2c_f32_bf16 v206, v242, v232
  v_dot2c_f32_bf16 v207, v243, v232
  v_perm_b32 v236, v126, v116, s62
  v_perm_b32 v237, v126, v116, s63
  v_dot2c_f32_bf16 v208, v236, v232
  v_dot2c_f32_bf16 v209, v237, v232
  v_perm_b32 v238, v127, v117, s62
  v_perm_b32 v239, v127, v117, s63
  v_dot2c_f32_bf16 v210, v238, v232
  v_dot2c_f32_bf16 v211, v239, v232
  v_perm_b32 v240, v128, v118, s62
  v_perm_b32 v241, v128, v118, s63
  v_dot2c_f32_bf16 v212, v240, v232
  v_dot2c_f32_bf16 v213, v241, v232
  v_perm_b32 v242, v129, v119, s62
  v_perm_b32 v243, v129, v119, s63
  v_dot2c_f32_bf16 v214, v242, v232
  v_dot2c_f32_bf16 v215, v243, v232
  v_perm_b32 v236, v130, v120, s62
  v_perm_b32 v237, v130, v120, s63
  v_dot2c_f32_bf16 v216, v236, v232
  v_dot2c_f32_bf16 v217, v237, v232
  v_perm_b32 v238, v131, v121, s62
  v_perm_b32 v239, v131, v121, s63
  v_dot2c_f32_bf16 v218, v238, v232
  v_dot2c_f32_bf16 v219, v239, v232
  s_waitcnt lgkmcnt(15)
  v_perm_b32 v236, v142, v132, s62
  v_perm_b32 v237, v142, v132, s63
  v_dot2c_f32_bf16 v200, v236, v233
  v_dot2c_f32_bf16 v201, v237, v233
  v_perm_b32 v238, v143, v133, s62
  v_perm_b32 v239, v143, v133, s63
  v_dot2c_f32_bf16 v202, v238, v233
  v_dot2c_f32_bf16 v203, v239, v233
  v_perm_b32 v240, v144, v134, s62
  v_perm_b32 v241, v144, v134, s63
  v_dot2c_f32_bf16 v204, v240, v233
  v_dot2c_f32_bf16 v205, v241, v233
  v_perm_b32 v242, v145, v135, s62
  v_perm_b32 v243, v145, v135, s63
  v_dot2c_f32_bf16 v206, v242, v233
  v_dot2c_f32_bf16 v207, v243, v233
  v_perm_b32 v236, v146, v136, s62
  v_perm_b32 v237, v146, v136, s63
  v_dot2c_f32_bf16 v208, v236, v233
  v_dot2c_f32_bf16 v209, v237, v233
  v_perm_b32 v238, v147, v137, s62
  v_perm_b32 v239, v147, v137, s63
  v_dot2c_f32_bf16 v210, v238, v233
  v_dot2c_f32_bf16 v211, v239, v233
  v_perm_b32 v240, v148, v138, s62
  v_perm_b32 v241, v148, v138, s63
  v_dot2c_f32_bf16 v212, v240, v233
  v_dot2c_f32_bf16 v213, v241, v233
  v_perm_b32 v242, v149, v139, s62
  v_perm_b32 v243, v149, v139, s63
  v_dot2c_f32_bf16 v214, v242, v233
  v_dot2c_f32_bf16 v215, v243, v233
  v_perm_b32 v236, v150, v140, s62
  v_perm_b32 v237, v150, v140, s63
  v_dot2c_f32_bf16 v216, v236, v233
  v_dot2c_f32_bf16 v217, v237, v233
  v_perm_b32 v238, v151, v141, s62
  v_perm_b32 v239, v151, v141, s63
  v_dot2c_f32_bf16 v218, v238, v233
  v_dot2c_f32_bf16 v219, v239, v233
  s_waitcnt lgkmcnt(10)
  v_perm_b32 v236, v162, v152, s62
  v_perm_b32 v237, v162, v152, s63
  v_dot2c_f32_bf16 v200, v236, v234
  v_dot2c_f32_bf16 v201, v237, v234
  v_perm_b32 v238, v163, v153, s62
  v_perm_b32 v239, v163, v153, s63
  v_dot2c_f32_bf16 v202, v238, v234
  v_dot2c_f32_bf16 v203, v239, v234
  v_perm_b32 v240, v164, v154, s62
  v_perm_b32 v241, v164, v154, s63
  v_dot2c_f32_bf16 v204, v240, v234
  v_dot2c_f32_bf16 v205, v241, v234
  v_perm_b32 v242, v165, v155, s62
  v_perm_b32 v243, v165, v155, s63
  v_dot2c_f32_bf16 v206, v242, v234
  v_dot2c_f32_bf16 v207, v243, v234
  v_perm_b32 v236, v166, v156, s62
  v_perm_b32 v237, v166, v156, s63
  v_dot2c_f32_bf16 v208, v236, v234
  v_dot2c_f32_bf16 v209, v237, v234
  v_perm_b32 v238, v167, v157, s62
  v_perm_b32 v239, v167, v157, s63
  v_dot2c_f32_bf16 v210, v238, v234
  v_dot2c_f32_bf16 v211, v239, v234
  v_perm_b32 v240, v168, v158, s62
  v_perm_b32 v241, v168, v158, s63
  v_dot2c_f32_bf16 v212, v240, v234
  v_dot2c_f32_bf16 v213, v241, v234
  v_perm_b32 v242, v169, v159, s62
  v_perm_b32 v243, v169, v159, s63
  v_dot2c_f32_bf16 v214, v242, v234
  v_dot2c_f32_bf16 v215, v243, v234
  v_perm_b32 v236, v170, v160, s62
  v_perm_b32 v237, v170, v160, s63
  v_dot2c_f32_bf16 v216, v236, v234
  v_dot2c_f32_bf16 v217, v237, v234
  v_perm_b32 v238, v171, v161, s62
  v_perm_b32 v239, v171, v161, s63
  v_dot2c_f32_bf16 v218, v238, v234
  v_dot2c_f32_bf16 v219, v239, v234
  s_waitcnt lgkmcnt(0)
  v_perm_b32 v236, v182, v172, s62
  v_perm_b32 v237, v182, v172, s63
  v_dot2c_f32_bf16 v200, v236, v235
  v_dot2c_f32_bf16 v201, v237, v235
  v_perm_b32 v238, v183, v173, s62
  v_perm_b32 v239, v183, v173, s63
  v_dot2c_f32_bf16 v202, v238, v235
  v_dot2c_f32_bf16 v203, v239, v235
  v_perm_b32 v240, v184, v174, s62
  v_perm_b32 v241, v184, v174, s63
  v_dot2c_f32_bf16 v204, v240, v235
  v_dot2c_f32_bf16 v205, v241, v235
  v_perm_b32 v242, v185, v175, s62
  v_perm_b32 v243, v185, v175, s63
  v_dot2c_f32_bf16 v206, v242, v235
  v_dot2c_f32_bf16 v207, v243, v235
  v_perm_b32 v236, v186, v176, s62
  v_perm_b32 v237, v186, v176, s63
  v_dot2c_f32_bf16 v208, v236, v235
  v_dot2c_f32_bf16 v209, v237, v235
  v_perm_b32 v238, v187, v177, s62
  v_perm_b32 v239, v187, v177, s63
  v_dot2c_f32_bf16 v210, v238, v235
  v_dot2c_f32_bf16 v211, v239, v235
  v_perm_b32 v240, v188, v178, s62
  v_perm_b32 v241, v188, v178, s63
  v_dot2c_f32_bf16 v212, v240, v235
  v_dot2c_f32_bf16 v213, v241, v235
  v_perm_b32 v242, v189, v179, s62
  v_perm_b32 v243, v189, v179, s63
  v_dot2c_f32_bf16 v214, v242, v235
  v_dot2c_f32_bf16 v215, v243, v235
  v_perm_b32 v236, v190, v180, s62
  v_perm_b32 v237, v190, v180, s63
  v_dot2c_f32_bf16 v216, v236, v235
  v_dot2c_f32_bf16 v217, v237, v235
  v_perm_b32 v238, v191, v181, s62
  v_perm_b32 v239, v191, v181, s63
  v_dot2c_f32_bf16 v218, v238, v235
  v_dot2c_f32_bf16 v219, v239, v235
  v_cvt_pk_bf16_f32 v244, v200, v201
  v_cvt_pk_bf16_f32 v245, v202, v203
  v_cvt_pk_bf16_f32 v246, v204, v205
  v_cvt_pk_bf16_f32 v247, v206, v207
  v_cvt_pk_bf16_f32 v248, v208, v209
  v_cvt_pk_bf16_f32 v249, v210, v211
  v_cvt_pk_bf16_f32 v250, v212, v213
  v_cvt_pk_bf16_f32 v251, v214, v215
  v_cvt_pk_bf16_f32 v252, v216, v217
  v_cvt_pk_bf16_f32 v253, v218, v219
  v_lshrrev_b32 v10, 4, v5
  v_mul_u32_u24 v10, 20480, v10
  v_and_b32 v11, 15, v5
  v_lshl_add_u32 v10, v11, 4, v10
  v_mul_u32_u24 v11, 5, v4
  v_add_u32 v12, 0, v11
  v_lshrrev_b32 v13, 1, v12
  v_and_b32 v12, 1, v12
  v_lshl_add_u32 v13, v13, 8, v10
  v_lshl_add_u32 v13, v12, 3, v13
  buffer_store_dwordx2 v[244:245], v13, s[24:27], 0 offen sc1
  v_add_u32 v12, 1, v11
  v_lshrrev_b32 v13, 1, v12
  v_and_b32 v12, 1, v12
  v_lshl_add_u32 v13, v13, 8, v10
  v_lshl_add_u32 v13, v12, 3, v13
  buffer_store_dwordx2 v[246:247], v13, s[24:27], 0 offen sc1
  v_add_u32 v12, 2, v11
  v_lshrrev_b32 v13, 1, v12
  v_and_b32 v12, 1, v12
  v_lshl_add_u32 v13, v13, 8, v10
  v_lshl_add_u32 v13, v12, 3, v13
  buffer_store_dwordx2 v[248:249], v13, s[24:27], 0 offen sc1
  v_add_u32 v12, 3, v11
  v_lshrrev_b32 v13, 1, v12
  v_and_b32 v12, 1, v12
  v_lshl_add_u32 v13, v13, 8, v10
  v_lshl_add_u32 v13, v12, 3, v13
  buffer_store_dwordx2 v[250:251], v13, s[24:27], 0 offen sc1
  v_add_u32 v12, 4, v11
  v_lshrrev_b32 v13, 1, v12
  v_and_b32 v12, 1, v12
  v_lshl_add_u32 v13, v13, 8, v10
  v_lshl_add_u32 v13, v12, 3, v13
  buffer_store_dwordx2 v[252:253], v13, s[24:27], 0 offen sc1
  v_add_u32 v5, 8, v5
  v_add_u32 v7, 20480, v7
  v_add_u32 v8, 10240, v8
  s_add_u32 s59, s59, 1
  s_cmp_lt_u32 s59, 4
  s_cbranch_scc1 ba_388
  s_waitcnt vmcnt(0)
  s_barrier
  s_lshr_b32 s21, s2, 2
  s_lshl_b32 s21, s21, 7
  s_add_u32 s21, s21, 90112
  s_cmp_lg_u32 s20, 0
  s_cbranch_scc1 af_389
  v_mov_b32 v8, 0
  v_mov_b32 v9, 1
  s_mov_b64 exec, 1
  buffer_atomic_add v9, v8, s[72:75], s21 offen sc1
  s_mov_b64 exec, -1
  s_nop 1
af_389:
  s_branch queue
main_fin:
  s_waitcnt vmcnt(0)
main_end:
  s_endpgm
.section .rodata,"a"
.p2align 6
.amdhsa_kernel gated_mix__memory_aug_recurrent_mem_tr__sliding_local_dilated__prompt_kernel
  .amdhsa_next_free_vgpr 512
  .amdhsa_next_free_sgpr 102
  .amdhsa_accum_offset 256
  .amdhsa_group_segment_fixed_size 0
  .amdhsa_kernarg_size 112
  .amdhsa_user_sgpr_count 2
  .amdhsa_user_sgpr_kernarg_segment_ptr 1
  .amdhsa_system_sgpr_workgroup_id_x 1
.end_amdhsa_kernel
.text
```

```asm
; @launch kernel=gated_mix__memory_aug_recurrent_mem_tr__sliding_local_dilated__prompt_kernel grid=(256,1,1) block=(256,1,1) lds=161792
.amdgcn_target "amdgcn-amd-amdhsa--gfx950"
.text
.globl gated_mix__memory_aug_recurrent_mem_tr__sliding_local_dilated__prompt_kernel
.p2align 8
.type gated_mix__memory_aug_recurrent_mem_tr__sliding_local_dilated__prompt_kernel,@function
gated_mix__memory_aug_recurrent_mem_tr__sliding_local_dilated__prompt_kernel:
  s_cmp_ge_u32 s2, 256
  s_cbranch_scc1 end0
  s_load_dwordx2 s[4:5], s[0:1], 96
  s_load_dwordx2 s[38:39], s[0:1], 104
  v_lshrrev_b32 v1, 6, v0
  v_and_b32 v2, 15, v0
  v_readfirstlane_b32 s20, v1
  v_and_b32 v1, 63, v0
  v_lshrrev_b32 v3, 4, v1
  s_getreg_b32 s50, hwreg(HW_REG_XCC_ID)
  s_and_b32 s50, s50, 7
  s_waitcnt lgkmcnt(0)
  s_mov_b32 s32, s4
  s_mov_b32 s33, s5
  s_mov_b32 s34, 256
  s_mov_b32 s35, 0x00020000
  v_mov_b32 v21, 0
  s_cmp_lg_u32 s20, 0
  s_cbranch_scc1 rk_1
  s_and_b32 s21, s50, 1
  s_lshl_b32 s21, s21, 7
  s_lshl_b32 s22, s50, 1
  s_and_b32 s22, s22, 12
  s_add_u32 s21, s21, s22
  v_mov_b32 v22, s21
  v_mov_b32 v23, 1
  s_mov_b64 exec, 1
  buffer_atomic_add v23, v22, s[32:35], 0 offen sc0 sc1
  s_waitcnt vmcnt(0)
  v_readfirstlane_b32 s51, v23
  s_lshl_b32 s22, s50, 5
  s_add_u32 s22, s22, s51
  s_cmp_lt_u32 s51, 32
  s_cbranch_scc1 rk_2
  v_mov_b32 v24, 72
  v_mov_b32 v25, 1
  buffer_atomic_add v25, v24, s[32:35], 0 offen sc0 sc1
  s_waitcnt vmcnt(0)
  v_readfirstlane_b32 s23, v25
  s_mov_b32 s101, 0
  s_mov_b64 exec, -1
  v_lshlrev_b32 v24, 2, v1
rk_3:
  s_sleep 8
  buffer_load_dword v25, v24, s[32:35], 0 offen sc1
  s_add_u32 s101, s101, 1
  s_cmp_gt_u32 s101, 131072
  s_cbranch_scc1 end0
  s_waitcnt vmcnt(0)
  v_readlane_b32 s21, v25, 0
  v_readlane_b32 s22, v25, 32
  s_add_u32 s21, s21, s22
  v_readlane_b32 s22, v25, 1
  s_add_u32 s21, s21, s22
  v_readlane_b32 s22, v25, 33
  s_add_u32 s21, s21, s22
  v_readlane_b32 s22, v25, 2
  s_add_u32 s21, s21, s22
  v_readlane_b32 s22, v25, 34
  s_add_u32 s21, s21, s22
  v_readlane_b32 s22, v25, 3
  s_add_u32 s21, s21, s22
  v_readlane_b32 s22, v25, 35
  s_add_u32 s21, s21, s22
  s_cmp_lt_u32 s21, 256
  s_cbranch_scc1 rk_3
  s_mov_b64 exec, 1
  s_mov_b32 s24, 0
rk_5:
  s_and_b32 s21, s24, 1
  s_lshl_b32 s21, s21, 5
  s_lshr_b32 s22, s24, 1
  s_add_u32 s21, s21, s22
  v_readlane_b32 s21, v25, s21
  s_min_u32 s21, s21, 32
  s_sub_u32 s25, 32, s21
  s_cmp_lt_u32 s23, s25
  s_cbranch_scc1 rk_4
  s_sub_u32 s23, s23, s25
  s_add_u32 s24, s24, 1
  s_cmp_lt_u32 s24, 8
  s_cbranch_scc1 rk_5
  s_branch end0
rk_4:
  s_lshl_b32 s22, s24, 5
  s_add_u32 s22, s22, s21
  s_add_u32 s22, s22, s23
  s_or_b32 s22, s22, 0x100
rk_2:
  v_mov_b32 v23, s22
  ds_write_b32 v21, v23
  s_waitcnt lgkmcnt(0)
  s_mov_b64 exec, -1
rk_1:
  s_barrier
  ds_read_b32 v23, v21
  s_waitcnt lgkmcnt(0)
  v_readfirstlane_b32 s22, v23
  s_barrier
  s_mov_b32 s84, 0
  s_mov_b32 s85, -1

  s_lshr_b32 s53, s22, 8
  s_and_b32 s22, s22, 255
  s_cmp_ge_u32 s22, 128
  s_cbranch_scc1 gemm_side
  s_lshr_b32 s50, s22, 4
  s_and_b32 s51, s22, 15
  s_mov_b32 s86, 0x3dd53b95
  s_load_dwordx2 s[4:5], s[0:1], 8
  s_load_dwordx4 s[36:39], s[0:1], 16
  s_load_dwordx4 s[40:43], s[0:1], 32
  s_load_dwordx2 s[44:45], s[0:1], 104
  s_lshr_b32 s55, s51, 2
  s_and_b32 s56, s51, 3
  s_lshl_b32 s57, s50, 2
  s_add_u32 s58, s57, s55
  s_add_u32 s59, s57, s20
  s_lshr_b32 s21, s51, 1
  s_xor_b32 s21, s21, s55
  s_andn2_b32 s21, 1, s21
  s_xor_b32 s85, s51, s21
  s_xor_b32 s84, s56, 1
  s_mul_i32 s87, s85, 5
  s_lshr_b32 s87, s87, 1
  s_and_b32 s79, s85, 1
  s_waitcnt lgkmcnt(0)
  s_add_u32 s8, s44, 78643200
  s_addc_u32 s9, s45, 0
  s_mov_b32 s10, 2162688
  s_mov_b32 s11, 0x00020000
  s_mov_b32 s16, s44
  s_mov_b32 s17, s45
  s_mov_b32 s18, 50331648
  s_mov_b32 s19, 0x00020000
  s_add_u32 s24, s44, 50331648
  s_addc_u32 s25, s45, 0
  s_mov_b32 s26, 12582912
  s_mov_b32 s27, 0x00020000
  s_mov_b32 s28, s4
  s_mov_b32 s29, s5
  s_mov_b32 s30, 10240
  s_mov_b32 s31, 0x00020000
  s_add_u32 s4, s44, 83886079
  s_addc_u32 s5, s45, 0
  s_and_b32 s4, s4, 0xffe00000
  s_mov_b32 s6, 2097152
  s_mov_b32 s7, 0x00020000
  v_mov_b32 v27, 10923
  v_add_u32 v103, 0, v1
  v_mul_u32_u24 v102, v103, v27
  v_lshrrev_b32 v102, 16, v102
  v_mul_u32_u24 v101, 6, v102
  v_sub_u32 v103, v103, v101
  v_bfe_u32 v101, v102, 1, 1
  v_mul_u32_u24 v101, 20, v101
  v_and_b32 v100, 1, v102
  v_add_u32 v101, v101, v100
  v_lshrrev_b32 v100, 3, v102
  v_mul_u32_u24 v100, 40, v100
  v_bfe_u32 v99, v102, 2, 1
  v_lshl_add_u32 v100, v99, 1, v100
  v_add_u32 v100, v100, v101
  v_mul_u32_u24 v100, 12288, v100
  v_lshl_add_u32 v46, v103, 4, v100
  v_lshrrev_b32 v100, 4, v102
  v_mul_u32_u24 v100, 40, v100
  v_bfe_u32 v99, v102, 2, 2
  v_lshl_add_u32 v100, v99, 1, v100
  v_add_u32 v100, v100, v101
  v_mul_u32_u24 v100, 12288, v100
  v_lshl_add_u32 v96, v103, 4, v100
  v_add_u32 v103, 64, v1
  v_mul_u32_u24 v102, v103, v27
  v_lshrrev_b32 v102, 16, v102
  v_mul_u32_u24 v101, 6, v102
  v_sub_u32 v103, v103, v101
  v_bfe_u32 v101, v102, 1, 1
  v_mul_u32_u24 v101, 20, v101
  v_and_b32 v100, 1, v102
  v_add_u32 v101, v101, v100
  v_lshrrev_b32 v100, 3, v102
  v_mul_u32_u24 v100, 40, v100
  v_bfe_u32 v99, v102, 2, 1
  v_lshl_add_u32 v100, v99, 1, v100
  v_add_u32 v100, v100, v101
  v_mul_u32_u24 v100, 12288, v100
  v_lshl_add_u32 v47, v103, 4, v100
  v_lshrrev_b32 v100, 4, v102
  v_mul_u32_u24 v100, 40, v100
  v_bfe_u32 v99, v102, 2, 2
  v_lshl_add_u32 v100, v99, 1, v100
  v_add_u32 v100, v100, v101
  v_mul_u32_u24 v100, 12288, v100
  v_lshl_add_u32 v97, v103, 4, v100
  v_add_u32 v103, 128, v1
  v_mul_u32_u24 v102, v103, v27
  v_lshrrev_b32 v102, 16, v102
  v_mul_u32_u24 v101, 6, v102
  v_sub_u32 v103, v103, v101
  v_bfe_u32 v101, v102, 1, 1
  v_mul_u32_u24 v101, 20, v101
  v_and_b32 v100, 1, v102
  v_add_u32 v101, v101, v100
  v_lshrrev_b32 v100, 3, v102
  v_mul_u32_u24 v100, 40, v100
  v_bfe_u32 v99, v102, 2, 1
  v_lshl_add_u32 v100, v99, 1, v100
  v_add_u32 v100, v100, v101
  v_mul_u32_u24 v100, 12288, v100
  v_lshl_add_u32 v48, v103, 4, v100
  v_lshrrev_b32 v100, 4, v102
  v_mul_u32_u24 v100, 40, v100
  v_bfe_u32 v99, v102, 2, 2
  v_lshl_add_u32 v100, v99, 1, v100
  v_add_u32 v100, v100, v101
  v_mul_u32_u24 v100, 12288, v100
  v_lshl_add_u32 v98, v103, 4, v100
  s_mul_i32 s80, s58, 384
  s_mul_i32 s22, s56, 96
  s_add_u32 s80, s80, s22
  s_mul_i32 s22, s20, 1966080
  s_add_u32 s80, s80, s22
  s_mul_i32 s88, s84, 96
  s_mul_i32 s21, s56, 96
  s_sub_u32 s88, s88, s21
  s_add_u32 s88, s88, s80
  s_mul_i32 s81, s20, 40448

  s_mul_i32 s82, s59, 245760
  s_lshl_b32 s22, s87, 5
  s_add_u32 s82, s82, s22
  s_mov_b32 s12, s38
  s_mov_b32 s13, s39
  s_mov_b32 s14, 7864320
  s_mov_b32 s15, 0x00020000
  s_add_u32 s21, s80, 0
  s_add_u32 s22, s81, 0
  s_add_u32 m0, s22, 0
  s_nop 0
  buffer_load_dwordx4 v96, s[12:15], s21 offen lds
  s_add_u32 m0, s22, 1024
  s_nop 0
  buffer_load_dwordx4 v97, s[12:15], s21 offen lds
  s_add_u32 m0, s22, 2048
  s_nop 0
  buffer_load_dwordx4 v98, s[12:15], s21 offen lds
  s_add_u32 s21, s80, 983040
  s_add_u32 s22, s81, 3072
  s_add_u32 m0, s22, 0
  s_nop 0
  buffer_load_dwordx4 v96, s[12:15], s21 offen lds
  s_add_u32 m0, s22, 1024
  s_nop 0
  buffer_load_dwordx4 v97, s[12:15], s21 offen lds
  s_add_u32 m0, s22, 2048
  s_nop 0
  buffer_load_dwordx4 v98, s[12:15], s21 offen lds
  s_add_u32 s21, s80, 98304
  s_add_u32 s22, s81, 6144
  s_add_u32 m0, s22, 0
  s_nop 0
  buffer_load_dwordx4 v96, s[12:15], s21 offen lds
  s_add_u32 m0, s22, 1024
  s_nop 0
  buffer_load_dwordx4 v97, s[12:15], s21 offen lds
  s_add_u32 m0, s22, 2048
  s_nop 0
  buffer_load_dwordx4 v98, s[12:15], s21 offen lds
  s_add_u32 s21, s80, 1081344
  s_add_u32 s22, s81, 9216
  s_add_u32 m0, s22, 0
  s_nop 0
  buffer_load_dwordx4 v96, s[12:15], s21 offen lds
  s_add_u32 m0, s22, 1024
  s_nop 0
  buffer_load_dwordx4 v97, s[12:15], s21 offen lds
  s_add_u32 m0, s22, 2048
  s_nop 0
  buffer_load_dwordx4 v98, s[12:15], s21 offen lds
  s_add_u32 s21, s80, 196608
  s_add_u32 s22, s81, 12288
  s_add_u32 m0, s22, 0
  s_nop 0
  buffer_load_dwordx4 v46, s[12:15], s21 offen lds
  s_add_u32 m0, s22, 1024
  s_nop 0
  buffer_load_dwordx4 v47, s[12:15], s21 offen lds
  s_add_u32 m0, s22, 2048
  s_nop 0
  buffer_load_dwordx4 v48, s[12:15], s21 offen lds
  v_lshrrev_b32 v99, 2, v2
  v_lshl_add_u32 v99, v3, 3, v99
  v_mul_u32_u24 v99, 96, v99
  v_and_b32 v100, 3, v2
  v_lshlrev_b32 v100, 3, v100
  v_add3_u32 v99, v99, v100, s81
  v_lshlrev_b32 v100, 4, v1
  v_add_u32 v100, s81, v100
  v_and_b32 v236, 7, v2
  v_lshrrev_b32 v237, 3, v2
  v_lshlrev_b32 v238, 7, v3
  v_lshl_add_u32 v238, v236, 4, v238
  v_lshlrev_b32 v16, 4, v1
  v_mul_u32_u24 v244, 1280, v236
  s_mul_i32 s21, s20, 320
  v_add_u32 v244, s21, v244
  v_lshrrev_b32 v245, 3, v1
  v_mul_u32_u24 v245, 40, v245
  v_add_u32 v244, v244, v245
  s_lshr_b32 s21, s20, 1
  s_lshl_b32 s21, s21, 14
  s_and_b32 s22, s20, 1
  s_mul_i32 s22, s22, 3072
  s_add_u32 s21, s21, s22
  v_add_u32 v4, s21, v16
  v_mov_b32 v239, 0x4444
  v_mov_b32 v240, 0xeeee
  v_cmp_eq_u32 vcc, 1, v237
  s_nop 1
  v_cndmask_b32 v44, v239, v240, vcc
  v_cmp_gt_u32 vcc, 2, v3
  s_nop 1
  v_cndmask_b32 v89, 0, 1.0, vcc
  v_lshrrev_b32 v239, 2, v2
  v_mul_u32_u24 v239, 272, v239
  v_lshl_add_u32 v239, v3, 6, v239
  v_and_b32 v240, 3, v2
  v_lshl_add_u32 v239, v240, 2, v239
  s_mul_i32 s21, s20, 5440
  v_add_u32 v5, s21, v239
  v_mul_u32_u24 v239, 272, v3
  v_lshl_add_u32 v6, v2, 4, v239
  v_lshl_add_u32 v239, v236, 4, v239
  v_mul_u32_u24 v240, 10880, v237
  v_add_u32 v45, v239, v240
  s_lshl_b32 s21, s50, 4
  s_add_u32 s21, s21, s51
  s_lshl_b32 s21, s21, 9
  s_lshl_b32 s22, s20, 7
  s_add_u32 s21, s21, s22
  s_add_u32 s21, s21, 81920
  v_and_b32 v239, 1, v3
  v_lshlrev_b32 v239, 8, v239
  v_lshl_add_u32 v239, v236, 4, v239
  v_lshrrev_b32 v240, 1, v3
  v_lshl_add_u32 v239, v240, 3, v239
  v_add_u32 v7, s21, v239
  s_lshl_b32 s22, s58, 9
  s_lshl_b32 s23, s56, 7
  s_add_u32 s22, s22, s23
  s_add_u32 s22, s22, 376704
  v_lshlrev_b32 v239, 6, v3
  v_lshl_add_u32 v239, v236, 3, v239
  v_add_u32 v239, s22, v239
  s_cmp_eq_u32 s20, 2
  s_cselect_b64 vcc, -1, 0
  v_cndmask_b32 v7, v7, v239, vcc
  s_lshl_b32 s21, s59, 11
  s_add_u32 s21, s21, 81920
  v_add_u32 v8, s21, v16
  s_lshl_b32 s21, s59, 9
  s_add_u32 s21, s21, 376832
  v_lshl_add_u32 v9, v1, 3, s21
  s_mul_i32 s21, s59, 3072
  s_add_u32 s21, s21, 278528
  v_and_b32 v239, 0x39, v1
  v_bfe_u32 v240, v1, 1, 1
  v_lshl_or_b32 v239, v240, 2, v239
  v_bfe_u32 v240, v1, 2, 1
  v_lshl_or_b32 v239, v240, 1, v239
  v_lshl_add_u32 v10, v239, 4, s21
  s_cmp_eq_u32 s20, 3
  s_cselect_b32 s22, s84, s56
  s_mul_i32 s22, s22, 12
  v_mul_u32_u24 v239, 3, v3
  v_add_u32 v239, s22, v239
  v_add_u32 v240, 0, v239
  v_lshrrev_b32 v241, 1, v240
  v_and_b32 v240, 1, v240
  v_lshlrev_b32 v240, 3, v240
  v_lshl_add_u32 v242, v241, 7, v240
  v_lshl_add_u32 v242, v236, 4, v242
  s_mul_i32 s21, s58, 3072
  v_add_u32 v21, s21, v242
  v_lshl_add_u32 v242, v241, 8, v240
  v_lshl_add_u32 v242, v2, 4, v242
  s_mul_i32 s21, s58, 12288
  s_and_b32 s22, s20, 1
  s_mul_i32 s22, s22, 6144
  s_add_u32 s21, s21, s22
  v_add_u32 v18, s21, v242
  v_add_u32 v240, 1, v239
  v_lshrrev_b32 v241, 1, v240
  v_and_b32 v240, 1, v240
  v_lshlrev_b32 v240, 3, v240
  v_lshl_add_u32 v242, v241, 7, v240
  v_lshl_add_u32 v242, v236, 4, v242
  s_mul_i32 s21, s58, 3072
  v_add_u32 v22, s21, v242
  v_lshl_add_u32 v242, v241, 8, v240
  v_lshl_add_u32 v242, v2, 4, v242
  s_mul_i32 s21, s58, 12288
  s_and_b32 s22, s20, 1
  s_mul_i32 s22, s22, 6144
  s_add_u32 s21, s21, s22
  v_add_u32 v19, s21, v242
  v_add_u32 v240, 2, v239
  v_lshrrev_b32 v241, 1, v240
  v_and_b32 v240, 1, v240
  v_lshlrev_b32 v240, 3, v240
  v_lshl_add_u32 v242, v241, 7, v240
  v_lshl_add_u32 v242, v236, 4, v242
  s_mul_i32 s21, s58, 3072
  v_add_u32 v23, s21, v242
  v_lshl_add_u32 v242, v241, 8, v240
  v_lshl_add_u32 v242, v2, 4, v242
  s_mul_i32 s21, s58, 12288
  s_and_b32 s22, s20, 1
  s_mul_i32 s22, s22, 6144
  s_add_u32 s21, s21, s22
  v_add_u32 v20, s21, v242
  v_cmp_eq_u32 vcc, 1, v237
  s_nop 1
  v_cndmask_b32 v25, v21, v22, vcc
  v_add_u32 v24, 278528, v25
  s_mul_i32 s21, s20, 3072
  s_add_u32 s21, s21, 22528
  v_add_u32 v11, s21, v16
  v_and_b32 v239, 3, v1
  s_mul_i32 s21, s20, 3
  v_add_u32 v240, s21, v239
  v_cmp_eq_u32 vcc, 3, v239
  v_lshrrev_b32 v241, 5, v1
  v_mul_u32_u24 v241, 10, v241
  v_cndmask_b32 v240, v240, 9, vcc
  s_lshl_b32 s21, s79, 2
  v_add3_u32 v240, v240, v241, s21
  v_lshrrev_b32 v241, 1, v240
  v_lshlrev_b32 v241, 8, v241
  v_and_b32 v240, 1, v240
  v_lshl_add_u32 v241, v240, 3, v241
  v_bfe_u32 v240, v1, 2, 3
  v_lshl_add_u32 v241, v240, 4, v241
  v_add_u32 v12, 22528, v241
  s_mov_b32 s21, 0x07060100
  s_cmp_eq_u32 s20, 1
  s_cselect_b32 s21, 0x07060302, s21
  s_cmp_eq_u32 s20, 2
  s_cselect_b32 s21, 0x07060c0c, s21
  v_mov_b32 v240, s21
  v_mov_b32 v241, 0x03020100
  v_cndmask_b32 v14, v241, v240, vcc
  s_lshr_b32 s21, s85, 3
  s_lshl_b32 s21, s21, 14
  s_bfe_u32 s22, s85, 0x10002
  s_mul_i32 s22, s22, 3072
  s_add_u32 s21, s21, s22
  s_and_b32 s22, s85, 3
  s_lshl_b32 s22, s22, 8
  s_add_u32 s21, s21, s22
  s_lshl_b32 s22, s20, 10
  s_add_u32 s22, s22, s21
  v_lshl_add_u32 v13, v1, 2, s22
  v_lshlrev_b32 v240, 10, v3
  v_lshl_add_u32 v240, v2, 4, v240
  v_add_u32 v240, s21, v240
  s_cmp_eq_u32 s20, 3
  s_cselect_b64 vcc, -1, 0
  v_cndmask_b32 v13, v13, v240, vcc
  s_mov_b32 s91, 0x3c000000
  v_mov_b32 v243, 0
  s_mul_i32 s89, s59, 12288
  s_add_u32 s89, s89, 25165824
  v_cmp_gt_u32 s[60:61], 8, v2
  v_cmp_le_u32 s[62:63], 8, v2
  v_cmp_le_u32 s[72:73], 2, v3
  v_cmp_gt_u32 s[70:71], 48, v1
  s_nop 1
  s_and_b64 s[64:65], s[60:61], s[72:73]
  s_cmp_eq_u32 s20, 2
  s_cselect_b64 s[74:75], s[64:65], s[60:61]
  s_mul_i32 s89, s59, 12288
  s_add_u32 s89, s89, 25165824
  s_not_b64 s[48:49], s[72:73]
  s_mov_b32 s83, 0
  v_mov_b32 v28, -1
  v_mov_b32 v29, -1
  v_mov_b32 v30, -1
  v_mov_b32 v31, -1
  s_cmp_eq_u32 s20, 3
  s_cbranch_scc1 ra_7
  s_mov_b64 exec, s[74:75]
  buffer_store_dwordx2 v[28:29], v7, s[8:11], s83 offen
ra_7:
  s_cmp_lt_u32 s20, 3
  s_cbranch_scc1 ra_8
  s_mov_b64 exec, -1
  buffer_store_dwordx2 v[28:29], v24, s[8:11], s83 offen
  s_mov_b64 exec, s[60:61]
  s_add_u32 s21, s83, 278528
  buffer_store_dwordx2 v[28:29], v23, s[8:11], s21 offen
ra_8:
  s_mov_b64 exec, -1
  s_nop 1
  s_mov_b32 s83, 540672
  v_mov_b32 v28, -1
  v_mov_b32 v29, -1
  v_mov_b32 v30, -1
  v_mov_b32 v31, -1
  s_cmp_eq_u32 s20, 3
  s_cbranch_scc1 ra_9
  s_mov_b64 exec, s[74:75]
  buffer_store_dwordx2 v[28:29], v7, s[8:11], s83 offen
ra_9:
  s_cmp_lt_u32 s20, 3
  s_cbranch_scc1 ra_10
  s_mov_b64 exec, -1
  buffer_store_dwordx2 v[28:29], v24, s[8:11], s83 offen
  s_mov_b64 exec, s[60:61]
  s_add_u32 s21, s83, 278528
  buffer_store_dwordx2 v[28:29], v23, s[8:11], s21 offen
ra_10:
  s_mov_b64 exec, -1
  s_nop 1
  s_mov_b32 s83, 1081344
  v_mov_b32 v28, -1
  v_mov_b32 v29, -1
  v_mov_b32 v30, -1
  v_mov_b32 v31, -1
  s_cmp_eq_u32 s20, 3
  s_cbranch_scc1 ra_11
  s_mov_b64 exec, s[74:75]
  buffer_store_dwordx2 v[28:29], v7, s[8:11], s83 offen
ra_11:
  s_cmp_lt_u32 s20, 3
  s_cbranch_scc1 ra_12
  s_mov_b64 exec, -1
  buffer_store_dwordx2 v[28:29], v24, s[8:11], s83 offen
  s_mov_b64 exec, s[60:61]
  s_add_u32 s21, s83, 278528
  buffer_store_dwordx2 v[28:29], v23, s[8:11], s21 offen
ra_12:
  s_mov_b64 exec, -1
  s_nop 1
  s_mov_b32 s83, 1622016
  v_mov_b32 v28, -1
  v_mov_b32 v29, -1
  v_mov_b32 v30, -1
  v_mov_b32 v31, -1
  s_cmp_eq_u32 s20, 3
  s_cbranch_scc1 ra_13
  s_mov_b64 exec, s[74:75]
  buffer_store_dwordx2 v[28:29], v7, s[8:11], s83 offen
ra_13:
  s_cmp_lt_u32 s20, 3
  s_cbranch_scc1 ra_14
  s_mov_b64 exec, -1
  buffer_store_dwordx2 v[28:29], v24, s[8:11], s83 offen
  s_mov_b64 exec, s[60:61]
  s_add_u32 s21, s83, 278528
  buffer_store_dwordx2 v[28:29], v23, s[8:11], s21 offen
ra_14:
  s_mov_b64 exec, -1
  s_nop 1
  s_cmp_lg_u32 s20, 3
  s_cbranch_scc1 rz_15
  s_and_b32 s21, s50, 3
  s_lshl_b32 s21, s21, 15
  s_lshr_b32 s22, s50, 2
  s_lshl_b32 s22, s22, 13
  s_add_u32 s21, s21, s22
  v_mov_b32 v156, 0
  v_mov_b32 v157, 0
  v_mov_b32 v158, 0
  v_mov_b32 v159, 0
  s_mov_b64 exec, s[70:71]
  buffer_store_dwordx4 v[156:159], v13, s[4:7], s21 offen sc1
  s_mov_b64 exec, -1
rz_15:
  s_mov_b32 s12, s40
  s_mov_b32 s13, s41
  s_mov_b32 s14, 7864320
  s_mov_b32 s15, 0x00020000
  s_add_u32 s21, s88, 0
  s_add_u32 s22, s81, 15360
  s_add_u32 m0, s22, 0
  s_nop 0
  buffer_load_dwordx4 v96, s[12:15], s21 offen lds
  s_add_u32 m0, s22, 1024
  s_nop 0
  buffer_load_dwordx4 v97, s[12:15], s21 offen lds
  s_add_u32 m0, s22, 2048
  s_nop 0
  buffer_load_dwordx4 v98, s[12:15], s21 offen lds
  s_add_u32 s21, s88, 983040
  s_add_u32 s22, s81, 18432
  s_add_u32 m0, s22, 0
  s_nop 0
  buffer_load_dwordx4 v96, s[12:15], s21 offen lds
  s_add_u32 m0, s22, 1024
  s_nop 0
  buffer_load_dwordx4 v97, s[12:15], s21 offen lds
  s_add_u32 m0, s22, 2048
  s_nop 0
  buffer_load_dwordx4 v98, s[12:15], s21 offen lds
  s_add_u32 s21, s88, 98304
  s_add_u32 s22, s81, 21504
  s_add_u32 m0, s22, 0
  s_nop 0
  buffer_load_dwordx4 v96, s[12:15], s21 offen lds
  s_add_u32 m0, s22, 1024
  s_nop 0
  buffer_load_dwordx4 v97, s[12:15], s21 offen lds
  s_add_u32 m0, s22, 2048
  s_nop 0
  buffer_load_dwordx4 v98, s[12:15], s21 offen lds
  s_add_u32 s21, s88, 1081344
  s_add_u32 s22, s81, 24576
  s_add_u32 m0, s22, 0
  s_nop 0
  buffer_load_dwordx4 v96, s[12:15], s21 offen lds
  s_add_u32 m0, s22, 1024
  s_nop 0
  buffer_load_dwordx4 v97, s[12:15], s21 offen lds
  s_add_u32 m0, s22, 2048
  s_nop 0
  buffer_load_dwordx4 v98, s[12:15], s21 offen lds
  s_add_u32 s21, s88, 196608
  s_add_u32 s22, s81, 27648
  s_add_u32 m0, s22, 0
  s_nop 0
  buffer_load_dwordx4 v46, s[12:15], s21 offen lds
  s_add_u32 m0, s22, 1024
  s_nop 0
  buffer_load_dwordx4 v47, s[12:15], s21 offen lds
  s_add_u32 m0, s22, 2048
  s_nop 0
  buffer_load_dwordx4 v48, s[12:15], s21 offen lds
  v_mov_b32 v27, 10923
  v_mov_b32 v49, v100
  v_add_u32 v104, 0, v1
  v_mul_u32_u24 v103, v104, v27
  v_lshrrev_b32 v103, 16, v103
  v_mul_u32_u24 v102, 6, v103
  v_sub_u32 v104, v104, v102
  v_bfe_u32 v102, v103, 1, 1
  v_lshlrev_b32 v102, 3, v102
  v_and_b32 v127, 12, v103
  v_lshrrev_b32 v127, 1, v127
  v_and_b32 v103, 0xfffffff1, v103
  v_or3_b32 v103, v103, v102, v127
  v_mul_u32_u24 v102, 1366, v103
  v_lshrrev_b32 v102, 16, v102
  v_mul_u32_u24 v100, 48, v102
  v_sub_u32 v103, v103, v100
  v_mul_u32_u24 v101, 5462, v103
  v_lshrrev_b32 v101, 16, v101
  v_mul_u32_u24 v126, 12, v101
  v_sub_u32 v103, v103, v126
  v_lshrrev_b32 v126, 2, v103
  v_and_b32 v103, 3, v103
  v_lshl_add_u32 v100, v126, 4, v100
  v_lshl_add_u32 v100, v101, 2, v100
  v_add_u32 v100, v100, v103
  v_mul_u32_u24 v100, 1280, v100
  v_lshl_add_u32 v104, v104, 4, v100
  v_add_u32 v105, 64, v1
  v_mul_u32_u24 v103, v105, v27
  v_lshrrev_b32 v103, 16, v103
  v_mul_u32_u24 v102, 6, v103
  v_sub_u32 v105, v105, v102
  v_bfe_u32 v102, v103, 1, 1
  v_lshlrev_b32 v102, 3, v102
  v_and_b32 v127, 12, v103
  v_lshrrev_b32 v127, 1, v127
  v_and_b32 v103, 0xfffffff1, v103
  v_or3_b32 v103, v103, v102, v127
  v_mul_u32_u24 v102, 1366, v103
  v_lshrrev_b32 v102, 16, v102
  v_mul_u32_u24 v100, 48, v102
  v_sub_u32 v103, v103, v100
  v_mul_u32_u24 v101, 5462, v103
  v_lshrrev_b32 v101, 16, v101
  v_mul_u32_u24 v126, 12, v101
  v_sub_u32 v103, v103, v126
  v_lshrrev_b32 v126, 2, v103
  v_and_b32 v103, 3, v103
  v_lshl_add_u32 v100, v126, 4, v100
  v_lshl_add_u32 v100, v101, 2, v100
  v_add_u32 v100, v100, v103
  v_mul_u32_u24 v100, 1280, v100
  v_lshl_add_u32 v105, v105, 4, v100
  v_add_u32 v106, 128, v1
  v_mul_u32_u24 v103, v106, v27
  v_lshrrev_b32 v103, 16, v103
  v_mul_u32_u24 v102, 6, v103
  v_sub_u32 v106, v106, v102
  v_bfe_u32 v102, v103, 1, 1
  v_lshlrev_b32 v102, 3, v102
  v_and_b32 v127, 12, v103
  v_lshrrev_b32 v127, 1, v127
  v_and_b32 v103, 0xfffffff1, v103
  v_or3_b32 v103, v103, v102, v127
  v_mul_u32_u24 v102, 1366, v103
  v_lshrrev_b32 v102, 16, v102
  v_mul_u32_u24 v100, 48, v102
  v_sub_u32 v103, v103, v100
  v_mul_u32_u24 v101, 5462, v103
  v_lshrrev_b32 v101, 16, v101
  v_mul_u32_u24 v126, 12, v101
  v_sub_u32 v103, v103, v126
  v_lshrrev_b32 v126, 2, v103
  v_and_b32 v103, 3, v103
  v_lshl_add_u32 v100, v126, 4, v100
  v_lshl_add_u32 v100, v101, 2, v100
  v_add_u32 v100, v100, v103
  v_mul_u32_u24 v100, 1280, v100
  v_lshl_add_u32 v106, v106, 4, v100
  v_add_u32 v107, 192, v1
  v_mul_u32_u24 v103, v107, v27
  v_lshrrev_b32 v103, 16, v103
  v_mul_u32_u24 v102, 6, v103
  v_sub_u32 v107, v107, v102
  v_bfe_u32 v102, v103, 1, 1
  v_lshlrev_b32 v102, 3, v102
  v_and_b32 v127, 12, v103
  v_lshrrev_b32 v127, 1, v127
  v_and_b32 v103, 0xfffffff1, v103
  v_or3_b32 v103, v103, v102, v127
  v_mul_u32_u24 v102, 1366, v103
  v_lshrrev_b32 v102, 16, v102
  v_mul_u32_u24 v100, 48, v102
  v_sub_u32 v103, v103, v100
  v_mul_u32_u24 v101, 5462, v103
  v_lshrrev_b32 v101, 16, v101
  v_mul_u32_u24 v126, 12, v101
  v_sub_u32 v103, v103, v126
  v_lshrrev_b32 v126, 2, v103
  v_and_b32 v103, 3, v103
  v_lshl_add_u32 v100, v126, 4, v100
  v_lshl_add_u32 v100, v101, 2, v100
  v_add_u32 v100, v100, v103
  v_mul_u32_u24 v100, 1280, v100
  v_lshl_add_u32 v107, v107, 4, v100
  v_add_u32 v108, 256, v1
  v_mul_u32_u24 v103, v108, v27
  v_lshrrev_b32 v103, 16, v103
  v_mul_u32_u24 v102, 6, v103
  v_sub_u32 v108, v108, v102
  v_bfe_u32 v102, v103, 1, 1
  v_lshlrev_b32 v102, 3, v102
  v_and_b32 v127, 12, v103
  v_lshrrev_b32 v127, 1, v127
  v_and_b32 v103, 0xfffffff1, v103
  v_or3_b32 v103, v103, v102, v127
  v_mul_u32_u24 v102, 1366, v103
  v_lshrrev_b32 v102, 16, v102
  v_mul_u32_u24 v100, 48, v102
  v_sub_u32 v103, v103, v100
  v_mul_u32_u24 v101, 5462, v103
  v_lshrrev_b32 v101, 16, v101
  v_mul_u32_u24 v126, 12, v101
  v_sub_u32 v103, v103, v126
  v_lshrrev_b32 v126, 2, v103
  v_and_b32 v103, 3, v103
  v_lshl_add_u32 v100, v126, 4, v100
  v_lshl_add_u32 v100, v101, 2, v100
  v_add_u32 v100, v100, v103
  v_mul_u32_u24 v100, 1280, v100
  v_lshl_add_u32 v108, v108, 4, v100
  v_add_u32 v109, 320, v1
  v_mul_u32_u24 v103, v109, v27
  v_lshrrev_b32 v103, 16, v103
  v_mul_u32_u24 v102, 6, v103
  v_sub_u32 v109, v109, v102
  v_bfe_u32 v102, v103, 1, 1
  v_lshlrev_b32 v102, 3, v102
  v_and_b32 v127, 12, v103
  v_lshrrev_b32 v127, 1, v127
  v_and_b32 v103, 0xfffffff1, v103
  v_or3_b32 v103, v103, v102, v127
  v_mul_u32_u24 v102, 1366, v103
  v_lshrrev_b32 v102, 16, v102
  v_mul_u32_u24 v100, 48, v102
  v_sub_u32 v103, v103, v100
  v_mul_u32_u24 v101, 5462, v103
  v_lshrrev_b32 v101, 16, v101
  v_mul_u32_u24 v126, 12, v101
  v_sub_u32 v103, v103, v126
  v_lshrrev_b32 v126, 2, v103
  v_and_b32 v103, 3, v103
  v_lshl_add_u32 v100, v126, 4, v100
  v_lshl_add_u32 v100, v101, 2, v100
  v_add_u32 v100, v100, v103
  v_mul_u32_u24 v100, 1280, v100
  v_lshl_add_u32 v109, v109, 4, v100
  v_add_u32 v110, 384, v1
  v_mul_u32_u24 v103, v110, v27
  v_lshrrev_b32 v103, 16, v103
  v_mul_u32_u24 v102, 6, v103
  v_sub_u32 v110, v110, v102
  v_bfe_u32 v102, v103, 1, 1
  v_lshlrev_b32 v102, 3, v102
  v_and_b32 v127, 12, v103
  v_lshrrev_b32 v127, 1, v127
  v_and_b32 v103, 0xfffffff1, v103
  v_or3_b32 v103, v103, v102, v127
  v_mul_u32_u24 v102, 1366, v103
  v_lshrrev_b32 v102, 16, v102
  v_mul_u32_u24 v100, 48, v102
  v_sub_u32 v103, v103, v100
  v_mul_u32_u24 v101, 5462, v103
  v_lshrrev_b32 v101, 16, v101
  v_mul_u32_u24 v126, 12, v101
  v_sub_u32 v103, v103, v126
  v_lshrrev_b32 v126, 2, v103
  v_and_b32 v103, 3, v103
  v_lshl_add_u32 v100, v126, 4, v100
  v_lshl_add_u32 v100, v101, 2, v100
  v_add_u32 v100, v100, v103
  v_mul_u32_u24 v100, 1280, v100
  v_lshl_add_u32 v110, v110, 4, v100
  v_add_u32 v111, 448, v1
  v_mul_u32_u24 v103, v111, v27
  v_lshrrev_b32 v103, 16, v103
  v_mul_u32_u24 v102, 6, v103
  v_sub_u32 v111, v111, v102
  v_bfe_u32 v102, v103, 1, 1
  v_lshlrev_b32 v102, 3, v102
  v_and_b32 v127, 12, v103
  v_lshrrev_b32 v127, 1, v127
  v_and_b32 v103, 0xfffffff1, v103
  v_or3_b32 v103, v103, v102, v127
  v_mul_u32_u24 v102, 1366, v103
  v_lshrrev_b32 v102, 16, v102
  v_mul_u32_u24 v100, 48, v102
  v_sub_u32 v103, v103, v100
  v_mul_u32_u24 v101, 5462, v103
  v_lshrrev_b32 v101, 16, v101
  v_mul_u32_u24 v126, 12, v101
  v_sub_u32 v103, v103, v126
  v_lshrrev_b32 v126, 2, v103
  v_and_b32 v103, 3, v103
  v_lshl_add_u32 v100, v126, 4, v100
  v_lshl_add_u32 v100, v101, 2, v100
  v_add_u32 v100, v100, v103
  v_mul_u32_u24 v100, 1280, v100
  v_lshl_add_u32 v111, v111, 4, v100
  v_add_u32 v112, 512, v1
  v_mul_u32_u24 v103, v112, v27
  v_lshrrev_b32 v103, 16, v103
  v_mul_u32_u24 v102, 6, v103
  v_sub_u32 v112, v112, v102
  v_bfe_u32 v102, v103, 1, 1
  v_lshlrev_b32 v102, 3, v102
  v_and_b32 v127, 12, v103
  v_lshrrev_b32 v127, 1, v127
  v_and_b32 v103, 0xfffffff1, v103
  v_or3_b32 v103, v103, v102, v127
  v_mul_u32_u24 v102, 1366, v103
  v_lshrrev_b32 v102, 16, v102
  v_mul_u32_u24 v100, 48, v102
  v_sub_u32 v103, v103, v100
  v_mul_u32_u24 v101, 5462, v103
  v_lshrrev_b32 v101, 16, v101
  v_mul_u32_u24 v126, 12, v101
  v_sub_u32 v103, v103, v126
  v_lshrrev_b32 v126, 2, v103
  v_and_b32 v103, 3, v103
  v_lshl_add_u32 v100, v126, 4, v100
  v_lshl_add_u32 v100, v101, 2, v100
  v_add_u32 v100, v100, v103
  v_mul_u32_u24 v100, 1280, v100
  v_lshl_add_u32 v112, v112, 4, v100
  s_mov_b32 s12, s42
  s_mov_b32 s13, s43
  s_mov_b32 s14, 7864320
  s_mov_b32 s15, 0x00020000
  s_add_u32 m0, s81, 30720
  s_nop 0
  buffer_load_dwordx4 v104, s[12:15], s82 offen lds
  s_add_u32 m0, s81, 31744
  s_nop 0
  buffer_load_dwordx4 v105, s[12:15], s82 offen lds
  s_add_u32 m0, s81, 32768
  s_nop 0
  buffer_load_dwordx4 v106, s[12:15], s82 offen lds
  s_add_u32 m0, s81, 33792
  s_nop 0
  buffer_load_dwordx4 v107, s[12:15], s82 offen lds
  s_add_u32 m0, s81, 34816
  s_nop 0
  buffer_load_dwordx4 v108, s[12:15], s82 offen lds
  s_add_u32 m0, s81, 35840
  s_nop 0
  buffer_load_dwordx4 v109, s[12:15], s82 offen lds
  s_add_u32 m0, s81, 36864
  s_nop 0
  buffer_load_dwordx4 v110, s[12:15], s82 offen lds
  s_add_u32 m0, s81, 37888
  s_nop 0
  buffer_load_dwordx4 v111, s[12:15], s82 offen lds
  s_add_u32 m0, s81, 38912
  s_nop 0
  buffer_load_dwordx4 v112, s[12:15], s82 offen lds
  s_mov_b32 s12, s36
  s_mov_b32 s13, s37
  s_mov_b32 s14, 7864320
  s_mov_b32 s15, 0x00020000
  s_add_u32 s21, s80, 0
  s_add_u32 s22, s81, 0
  buffer_load_dwordx4 v[128:131], v96, s[12:15], s21 offen
  buffer_load_dwordx4 v[132:135], v97, s[12:15], s21 offen
  buffer_load_dwordx4 v[136:139], v98, s[12:15], s21 offen
  s_add_u32 s21, s80, 983040
  s_add_u32 s22, s81, 3072
  buffer_load_dwordx4 v[140:143], v96, s[12:15], s21 offen
  buffer_load_dwordx4 v[144:147], v97, s[12:15], s21 offen
  buffer_load_dwordx4 v[148:151], v98, s[12:15], s21 offen
  s_add_u32 s21, s80, 98304
  s_add_u32 s22, s81, 6144
  buffer_load_dwordx4 v[152:155], v96, s[12:15], s21 offen
  buffer_load_dwordx4 v[156:159], v97, s[12:15], s21 offen
  buffer_load_dwordx4 v[160:163], v98, s[12:15], s21 offen
  v_add_u32 v113, 576, v1
  v_mul_u32_u24 v103, v113, v27
  v_lshrrev_b32 v103, 16, v103
  v_mul_u32_u24 v102, 6, v103
  v_sub_u32 v113, v113, v102
  v_bfe_u32 v102, v103, 1, 1
  v_lshlrev_b32 v102, 3, v102
  v_and_b32 v127, 12, v103
  v_lshrrev_b32 v127, 1, v127
  v_and_b32 v103, 0xfffffff1, v103
  v_or3_b32 v103, v103, v102, v127
  v_mul_u32_u24 v102, 1366, v103
  v_lshrrev_b32 v102, 16, v102
  v_mul_u32_u24 v100, 48, v102
  v_sub_u32 v103, v103, v100
  v_mul_u32_u24 v101, 5462, v103
  v_lshrrev_b32 v101, 16, v101
  v_mul_u32_u24 v126, 12, v101
  v_sub_u32 v103, v103, v126
  v_lshrrev_b32 v126, 2, v103
  v_and_b32 v103, 3, v103
  v_lshl_add_u32 v100, v126, 4, v100
  v_lshl_add_u32 v100, v101, 2, v100
  v_add_u32 v100, v100, v103
  v_mul_u32_u24 v100, 1280, v100
  v_lshl_add_u32 v113, v113, 4, v100
  v_add_u32 v114, 640, v1
  v_mul_u32_u24 v103, v114, v27
  v_lshrrev_b32 v103, 16, v103
  v_mul_u32_u24 v102, 6, v103
  v_sub_u32 v114, v114, v102
  v_bfe_u32 v102, v103, 1, 1
  v_lshlrev_b32 v102, 3, v102
  v_and_b32 v127, 12, v103
  v_lshrrev_b32 v127, 1, v127
  v_and_b32 v103, 0xfffffff1, v103
  v_or3_b32 v103, v103, v102, v127
  v_mul_u32_u24 v102, 1366, v103
  v_lshrrev_b32 v102, 16, v102
  v_mul_u32_u24 v100, 48, v102
  v_sub_u32 v103, v103, v100
  v_mul_u32_u24 v101, 5462, v103
  v_lshrrev_b32 v101, 16, v101
  v_mul_u32_u24 v126, 12, v101
  v_sub_u32 v103, v103, v126
  v_lshrrev_b32 v126, 2, v103
  v_and_b32 v103, 3, v103
  v_lshl_add_u32 v100, v126, 4, v100
  v_lshl_add_u32 v100, v101, 2, v100
  v_add_u32 v100, v100, v103
  v_mul_u32_u24 v100, 1280, v100
  v_lshl_add_u32 v114, v114, 4, v100
  v_add_u32 v115, 704, v1
  v_mul_u32_u24 v103, v115, v27
  v_lshrrev_b32 v103, 16, v103
  v_mul_u32_u24 v102, 6, v103
  v_sub_u32 v115, v115, v102
  v_bfe_u32 v102, v103, 1, 1
  v_lshlrev_b32 v102, 3, v102
  v_and_b32 v127, 12, v103
  v_lshrrev_b32 v127, 1, v127
  v_and_b32 v103, 0xfffffff1, v103
  v_or3_b32 v103, v103, v102, v127
  v_mul_u32_u24 v102, 1366, v103
  v_lshrrev_b32 v102, 16, v102
  v_mul_u32_u24 v100, 48, v102
  v_sub_u32 v103, v103, v100
  v_mul_u32_u24 v101, 5462, v103
  v_lshrrev_b32 v101, 16, v101
  v_mul_u32_u24 v126, 12, v101
  v_sub_u32 v103, v103, v126
  v_lshrrev_b32 v126, 2, v103
  v_and_b32 v103, 3, v103
  v_lshl_add_u32 v100, v126, 4, v100
  v_lshl_add_u32 v100, v101, 2, v100
  v_add_u32 v100, v100, v103
  v_mul_u32_u24 v100, 1280, v100
  v_lshl_add_u32 v115, v115, 4, v100
  v_add_u32 v116, 768, v1
  v_mul_u32_u24 v103, v116, v27
  v_lshrrev_b32 v103, 16, v103
  v_mul_u32_u24 v102, 6, v103
  v_sub_u32 v116, v116, v102
  v_bfe_u32 v102, v103, 1, 1
  v_lshlrev_b32 v102, 3, v102
  v_and_b32 v127, 12, v103
  v_lshrrev_b32 v127, 1, v127
  v_and_b32 v103, 0xfffffff1, v103
  v_or3_b32 v103, v103, v102, v127
  v_mul_u32_u24 v102, 1366, v103
  v_lshrrev_b32 v102, 16, v102
  v_mul_u32_u24 v100, 48, v102
  v_sub_u32 v103, v103, v100
  v_mul_u32_u24 v101, 5462, v103
  v_lshrrev_b32 v101, 16, v101
  v_mul_u32_u24 v126, 12, v101
  v_sub_u32 v103, v103, v126
  v_lshrrev_b32 v126, 2, v103
  v_and_b32 v103, 3, v103
  v_lshl_add_u32 v100, v126, 4, v100
  v_lshl_add_u32 v100, v101, 2, v100
  v_add_u32 v100, v100, v103
  v_mul_u32_u24 v100, 1280, v100
  v_lshl_add_u32 v116, v116, 4, v100
  v_add_u32 v117, 832, v1
  v_mul_u32_u24 v103, v117, v27
  v_lshrrev_b32 v103, 16, v103
  v_mul_u32_u24 v102, 6, v103
  v_sub_u32 v117, v117, v102
  v_bfe_u32 v102, v103, 1, 1
  v_lshlrev_b32 v102, 3, v102
  v_and_b32 v127, 12, v103
  v_lshrrev_b32 v127, 1, v127
  v_and_b32 v103, 0xfffffff1, v103
  v_or3_b32 v103, v103, v102, v127
  v_mul_u32_u24 v102, 1366, v103
  v_lshrrev_b32 v102, 16, v102
  v_mul_u32_u24 v100, 48, v102
  v_sub_u32 v103, v103, v100
  v_mul_u32_u24 v101, 5462, v103
  v_lshrrev_b32 v101, 16, v101
  v_mul_u32_u24 v126, 12, v101
  v_sub_u32 v103, v103, v126
  v_lshrrev_b32 v126, 2, v103
  v_and_b32 v103, 3, v103
  v_lshl_add_u32 v100, v126, 4, v100
  v_lshl_add_u32 v100, v101, 2, v100
  v_add_u32 v100, v100, v103
  v_mul_u32_u24 v100, 1280, v100
  v_lshl_add_u32 v117, v117, 4, v100
  v_add_u32 v118, 896, v1
  v_mul_u32_u24 v103, v118, v27
  v_lshrrev_b32 v103, 16, v103
  v_mul_u32_u24 v102, 6, v103
  v_sub_u32 v118, v118, v102
  v_bfe_u32 v102, v103, 1, 1
  v_lshlrev_b32 v102, 3, v102
  v_and_b32 v127, 12, v103
  v_lshrrev_b32 v127, 1, v127
  v_and_b32 v103, 0xfffffff1, v103
  v_or3_b32 v103, v103, v102, v127
  v_mul_u32_u24 v102, 1366, v103
  v_lshrrev_b32 v102, 16, v102
  v_mul_u32_u24 v100, 48, v102
  v_sub_u32 v103, v103, v100
  v_mul_u32_u24 v101, 5462, v103
  v_lshrrev_b32 v101, 16, v101
  v_mul_u32_u24 v126, 12, v101
  v_sub_u32 v103, v103, v126
  v_lshrrev_b32 v126, 2, v103
  v_and_b32 v103, 3, v103
  v_lshl_add_u32 v100, v126, 4, v100
  v_lshl_add_u32 v100, v101, 2, v100
  v_add_u32 v100, v100, v103
  v_mul_u32_u24 v100, 1280, v100
  v_lshl_add_u32 v118, v118, 4, v100
  v_add_u32 v119, 960, v1
  v_mul_u32_u24 v103, v119, v27
  v_lshrrev_b32 v103, 16, v103
  v_mul_u32_u24 v102, 6, v103
  v_sub_u32 v119, v119, v102
  v_bfe_u32 v102, v103, 1, 1
  v_lshlrev_b32 v102, 3, v102
  v_and_b32 v127, 12, v103
  v_lshrrev_b32 v127, 1, v127
  v_and_b32 v103, 0xfffffff1, v103
  v_or3_b32 v103, v103, v102, v127
  v_mul_u32_u24 v102, 1366, v103
  v_lshrrev_b32 v102, 16, v102
  v_mul_u32_u24 v100, 48, v102
  v_sub_u32 v103, v103, v100
  v_mul_u32_u24 v101, 5462, v103
  v_lshrrev_b32 v101, 16, v101
  v_mul_u32_u24 v126, 12, v101
  v_sub_u32 v103, v103, v126
  v_lshrrev_b32 v126, 2, v103
  v_and_b32 v103, 3, v103
  v_lshl_add_u32 v100, v126, 4, v100
  v_lshl_add_u32 v100, v101, 2, v100
  v_add_u32 v100, v100, v103
  v_mul_u32_u24 v100, 1280, v100
  v_lshl_add_u32 v119, v119, 4, v100
  v_add_u32 v120, 1024, v1
  v_mul_u32_u24 v103, v120, v27
  v_lshrrev_b32 v103, 16, v103
  v_mul_u32_u24 v102, 6, v103
  v_sub_u32 v120, v120, v102
  v_bfe_u32 v102, v103, 1, 1
  v_lshlrev_b32 v102, 3, v102
  v_and_b32 v127, 12, v103
  v_lshrrev_b32 v127, 1, v127
  v_and_b32 v103, 0xfffffff1, v103
  v_or3_b32 v103, v103, v102, v127
  v_mul_u32_u24 v102, 1366, v103
  v_lshrrev_b32 v102, 16, v102
  v_mul_u32_u24 v100, 48, v102
  v_sub_u32 v103, v103, v100
  v_mul_u32_u24 v101, 5462, v103
  v_lshrrev_b32 v101, 16, v101
  v_mul_u32_u24 v126, 12, v101
  v_sub_u32 v103, v103, v126
  v_lshrrev_b32 v126, 2, v103
  v_and_b32 v103, 3, v103
  v_lshl_add_u32 v100, v126, 4, v100
  v_lshl_add_u32 v100, v101, 2, v100
  v_add_u32 v100, v100, v103
  v_mul_u32_u24 v100, 1280, v100
  v_lshl_add_u32 v120, v120, 4, v100
  v_add_u32 v121, 1088, v1
  v_mul_u32_u24 v103, v121, v27
  v_lshrrev_b32 v103, 16, v103
  v_mul_u32_u24 v102, 6, v103
  v_sub_u32 v121, v121, v102
  v_bfe_u32 v102, v103, 1, 1
  v_lshlrev_b32 v102, 3, v102
  v_and_b32 v127, 12, v103
  v_lshrrev_b32 v127, 1, v127
  v_and_b32 v103, 0xfffffff1, v103
  v_or3_b32 v103, v103, v102, v127
  v_mul_u32_u24 v102, 1366, v103
  v_lshrrev_b32 v102, 16, v102
  v_mul_u32_u24 v100, 48, v102
  v_sub_u32 v103, v103, v100
  v_mul_u32_u24 v101, 5462, v103
  v_lshrrev_b32 v101, 16, v101
  v_mul_u32_u24 v126, 12, v101
  v_sub_u32 v103, v103, v126
  v_lshrrev_b32 v126, 2, v103
  v_and_b32 v103, 3, v103
  v_lshl_add_u32 v100, v126, 4, v100
  v_lshl_add_u32 v100, v101, 2, v100
  v_add_u32 v100, v100, v103
  v_mul_u32_u24 v100, 1280, v100
  v_lshl_add_u32 v121, v121, 4, v100
  v_mov_b32 v100, v49
  v_lshlrev_b32 v239, 2, v1
  s_waitcnt vmcnt(33)
  ds_read_b64_tr_b16 a[60:61], v99 offset:0
  ds_read_b64_tr_b16 a[62:63], v99 offset:384
  ds_read_b64_tr_b16 a[80:81], v99 offset:32
  ds_read_b64_tr_b16 a[82:83], v99 offset:416
  ds_read_b64_tr_b16 a[100:101], v99 offset:64
  ds_read_b64_tr_b16 a[102:103], v99 offset:448
  ds_read_b64_tr_b16 a[64:65], v99 offset:3072
  ds_read_b64_tr_b16 a[66:67], v99 offset:3456
  ds_read_b64_tr_b16 a[84:85], v99 offset:3104
  ds_read_b64_tr_b16 a[86:87], v99 offset:3488
  ds_read_b64_tr_b16 a[104:105], v99 offset:3136
  ds_read_b64_tr_b16 a[106:107], v99 offset:3520
  ds_read_b64_tr_b16 a[68:69], v99 offset:6144
  ds_read_b64_tr_b16 a[70:71], v99 offset:6528
  ds_read_b64_tr_b16 a[88:89], v99 offset:6176
  ds_read_b64_tr_b16 a[90:91], v99 offset:6560
  ds_read_b64_tr_b16 a[108:109], v99 offset:6208
  ds_read_b64_tr_b16 a[110:111], v99 offset:6592
  ds_read_b64_tr_b16 a[72:73], v99 offset:9216
  ds_read_b64_tr_b16 a[74:75], v99 offset:9600
  ds_read_b64_tr_b16 a[92:93], v99 offset:9248
  ds_read_b64_tr_b16 a[94:95], v99 offset:9632
  ds_read_b64_tr_b16 a[112:113], v99 offset:9280
  ds_read_b64_tr_b16 a[114:115], v99 offset:9664
  ds_read_b64_tr_b16 a[76:77], v99 offset:12288
  ds_read_b64_tr_b16 a[78:79], v99 offset:12672
  ds_read_b64_tr_b16 a[96:97], v99 offset:12320
  ds_read_b64_tr_b16 a[98:99], v99 offset:12704
  ds_read_b64_tr_b16 a[116:117], v99 offset:12352
  ds_read_b64_tr_b16 a[118:119], v99 offset:12736
  s_waitcnt lgkmcnt(0)
  s_barrier
  s_cmp_lg_u32 s20, 0
  s_cbranch_scc1 ic_16
  v_mov_b32 v236, 64
  v_mov_b32 v237, 1
  s_mov_b64 exec, 1
  buffer_atomic_add v237, v236, s[32:35], 0 offen sc1
  s_mov_b64 exec, -1
  buffer_load_dword v238, v239, s[32:35], 0 offen sc1
ic_16:
  s_mov_b32 s12, s36
  s_mov_b32 s13, s37
  s_mov_b32 s14, 7864320
  s_mov_b32 s15, 0x00020000
  s_add_u32 s21, s80, 1081344
  s_add_u32 s22, s81, 9216
  buffer_load_dwordx4 v[164:167], v96, s[12:15], s21 offen
  buffer_load_dwordx4 v[168:171], v97, s[12:15], s21 offen
  buffer_load_dwordx4 v[172:175], v98, s[12:15], s21 offen
  s_add_u32 s21, s80, 196608
  s_add_u32 s22, s81, 12288
  buffer_load_dwordx4 v[176:179], v46, s[12:15], s21 offen
  buffer_load_dwordx4 v[180:183], v47, s[12:15], s21 offen
  buffer_load_dwordx4 v[184:187], v48, s[12:15], s21 offen
  s_mov_b32 s12, s42
  s_mov_b32 s13, s43
  s_mov_b32 s14, 7864320
  s_mov_b32 s15, 0x00020000
  buffer_load_dwordx4 v[188:191], v113, s[12:15], s82 offen
  buffer_load_dwordx4 v[192:195], v114, s[12:15], s82 offen
  buffer_load_dwordx4 v[196:199], v115, s[12:15], s82 offen
  buffer_load_dwordx4 v[200:203], v116, s[12:15], s82 offen
  buffer_load_dwordx4 v[204:207], v117, s[12:15], s82 offen
  buffer_load_dwordx4 v[208:211], v118, s[12:15], s82 offen
  buffer_load_dwordx4 v[212:215], v119, s[12:15], s82 offen
  buffer_load_dwordx4 v[216:219], v120, s[12:15], s82 offen
  buffer_load_dwordx4 v[220:223], v121, s[12:15], s82 offen
  buffer_load_dwordx4 v[32:35], v244, s[28:31], 0 offen offset:0
  buffer_load_dwordx4 v[36:39], v244, s[28:31], 0 offen offset:16
  buffer_load_dwordx2 v[40:41], v244, s[28:31], 0 offen offset:32
  s_waitcnt vmcnt(36)
  ds_read_b64_tr_b16 a[120:121], v99 offset:15360
  ds_read_b64_tr_b16 a[122:123], v99 offset:15744
  ds_read_b64_tr_b16 a[140:141], v99 offset:15392
  ds_read_b64_tr_b16 a[142:143], v99 offset:15776
  ds_read_b64_tr_b16 a[160:161], v99 offset:15424
  ds_read_b64_tr_b16 a[162:163], v99 offset:15808
  ds_read_b64_tr_b16 a[124:125], v99 offset:18432
  ds_read_b64_tr_b16 a[126:127], v99 offset:18816
  ds_read_b64_tr_b16 a[144:145], v99 offset:18464
  ds_read_b64_tr_b16 a[146:147], v99 offset:18848
  ds_read_b64_tr_b16 a[164:165], v99 offset:18496
  ds_read_b64_tr_b16 a[166:167], v99 offset:18880
  ds_read_b64_tr_b16 a[128:129], v99 offset:21504
  ds_read_b64_tr_b16 a[130:131], v99 offset:21888
  ds_read_b64_tr_b16 a[148:149], v99 offset:21536
  ds_read_b64_tr_b16 a[150:151], v99 offset:21920
  ds_read_b64_tr_b16 a[168:169], v99 offset:21568
  ds_read_b64_tr_b16 a[170:171], v99 offset:21952
  ds_read_b64_tr_b16 a[132:133], v99 offset:24576
  ds_read_b64_tr_b16 a[134:135], v99 offset:24960
  ds_read_b64_tr_b16 a[152:153], v99 offset:24608
  ds_read_b64_tr_b16 a[154:155], v99 offset:24992
  ds_read_b64_tr_b16 a[172:173], v99 offset:24640
  ds_read_b64_tr_b16 a[174:175], v99 offset:25024
  ds_read_b64_tr_b16 a[136:137], v99 offset:27648
  ds_read_b64_tr_b16 a[138:139], v99 offset:28032
  ds_read_b64_tr_b16 a[156:157], v99 offset:27680
  ds_read_b64_tr_b16 a[158:159], v99 offset:28064
  ds_read_b64_tr_b16 a[176:177], v99 offset:27712
  ds_read_b64_tr_b16 a[178:179], v99 offset:28096
  s_waitcnt lgkmcnt(0)
  s_waitcnt vmcnt(27)
  ds_read_b64_tr_b16 a[180:181], v99 offset:30720
  ds_read_b64_tr_b16 a[182:183], v99 offset:31104
  ds_read_b64_tr_b16 a[204:205], v99 offset:30752
  ds_read_b64_tr_b16 a[206:207], v99 offset:31136
  ds_read_b64_tr_b16 a[228:229], v99 offset:30784
  ds_read_b64_tr_b16 a[230:231], v99 offset:31168
  ds_read_b64_tr_b16 a[184:185], v99 offset:33792
  ds_read_b64_tr_b16 a[186:187], v99 offset:34176
  ds_read_b64_tr_b16 a[208:209], v99 offset:33824
  ds_read_b64_tr_b16 a[210:211], v99 offset:34208
  ds_read_b64_tr_b16 a[232:233], v99 offset:33856
  ds_read_b64_tr_b16 a[234:235], v99 offset:34240
  ds_read_b64_tr_b16 a[188:189], v99 offset:36864
  ds_read_b64_tr_b16 a[190:191], v99 offset:37248
  ds_read_b64_tr_b16 a[212:213], v99 offset:36896
  ds_read_b64_tr_b16 a[214:215], v99 offset:37280
  ds_read_b64_tr_b16 a[236:237], v99 offset:36928
  ds_read_b64_tr_b16 a[238:239], v99 offset:37312
  s_waitcnt lgkmcnt(0)
  s_waitcnt vmcnt(12)
  ds_write_b128 v100, v[128:131] offset:0
  ds_write_b128 v100, v[132:135] offset:1024
  ds_write_b128 v100, v[136:139] offset:2048
  ds_write_b128 v100, v[140:143] offset:3072
  ds_write_b128 v100, v[144:147] offset:4096
  ds_write_b128 v100, v[148:151] offset:5120
  ds_write_b128 v100, v[152:155] offset:6144
  ds_write_b128 v100, v[156:159] offset:7168
  ds_write_b128 v100, v[160:163] offset:8192
  ds_write_b128 v100, v[164:167] offset:9216
  ds_write_b128 v100, v[168:171] offset:10240
  ds_write_b128 v100, v[172:175] offset:11264
  ds_write_b128 v100, v[176:179] offset:12288
  ds_write_b128 v100, v[180:183] offset:13312
  ds_write_b128 v100, v[184:187] offset:14336
  s_waitcnt lgkmcnt(0)
  ds_read_b64_tr_b16 a[0:1], v99 offset:0
  ds_read_b64_tr_b16 a[2:3], v99 offset:384
  ds_read_b64_tr_b16 a[20:21], v99 offset:32
  ds_read_b64_tr_b16 a[22:23], v99 offset:416
  ds_read_b64_tr_b16 a[40:41], v99 offset:64
  ds_read_b64_tr_b16 a[42:43], v99 offset:448
  ds_read_b64_tr_b16 a[4:5], v99 offset:3072
  ds_read_b64_tr_b16 a[6:7], v99 offset:3456
  ds_read_b64_tr_b16 a[24:25], v99 offset:3104
  ds_read_b64_tr_b16 a[26:27], v99 offset:3488
  ds_read_b64_tr_b16 a[44:45], v99 offset:3136
  ds_read_b64_tr_b16 a[46:47], v99 offset:3520
  ds_read_b64_tr_b16 a[8:9], v99 offset:6144
  ds_read_b64_tr_b16 a[10:11], v99 offset:6528
  ds_read_b64_tr_b16 a[28:29], v99 offset:6176
  ds_read_b64_tr_b16 a[30:31], v99 offset:6560
  ds_read_b64_tr_b16 a[48:49], v99 offset:6208
  ds_read_b64_tr_b16 a[50:51], v99 offset:6592
  ds_read_b64_tr_b16 a[12:13], v99 offset:9216
  ds_read_b64_tr_b16 a[14:15], v99 offset:9600
  ds_read_b64_tr_b16 a[32:33], v99 offset:9248
  ds_read_b64_tr_b16 a[34:35], v99 offset:9632
  ds_read_b64_tr_b16 a[52:53], v99 offset:9280
  ds_read_b64_tr_b16 a[54:55], v99 offset:9664
  ds_read_b64_tr_b16 a[16:17], v99 offset:12288
  ds_read_b64_tr_b16 a[18:19], v99 offset:12672
  ds_read_b64_tr_b16 a[36:37], v99 offset:12320
  ds_read_b64_tr_b16 a[38:39], v99 offset:12704
  ds_read_b64_tr_b16 a[56:57], v99 offset:12352
  ds_read_b64_tr_b16 a[58:59], v99 offset:12736
  s_waitcnt lgkmcnt(0)
  s_add_u32 s64, s44, 81068032
  s_addc_u32 s65, s45, 0
  s_mov_b32 s66, 115712
  s_mov_b32 s67, 0x00020000
  s_mov_b32 s83, 0
  s_cmp_lg_u32 s20, 0
  s_cbranch_scc1 sp_17
  v_and_b32 v243, 3, v1
  v_lshlrev_b32 v243, 7, v243
  s_lshl_b32 s78, s50, 9
  s_and_b32 s21, s51, 12
  s_add_u32 s78, s78, s21
  s_add_u32 s78, s78, 94208
  v_readlane_b32 s83, v238, 19
  s_cmp_eq_u32 s83, 0
  s_cbranch_scc1 sp_17
  buffer_load_dword v238, v239, s[32:35], 0 offen sc1
  buffer_load_dword v242, v243, s[64:67], s78 offen sc1
sp_17:
  s_waitcnt vmcnt(3)
  ds_write_b128 v100, v[188:191] offset:15360
  ds_write_b128 v100, v[192:195] offset:16384
  ds_write_b128 v100, v[196:199] offset:17408
  ds_write_b128 v100, v[200:203] offset:18432
  ds_write_b128 v100, v[204:207] offset:19456
  ds_write_b128 v100, v[208:211] offset:20480
  ds_write_b128 v100, v[212:215] offset:21504
  ds_write_b128 v100, v[216:219] offset:22528
  ds_write_b128 v100, v[220:223] offset:23552
  s_waitcnt lgkmcnt(0)
  ds_read_b64_tr_b16 a[192:193], v99 offset:15360
  ds_read_b64_tr_b16 a[194:195], v99 offset:15744
  ds_read_b64_tr_b16 a[216:217], v99 offset:15392
  ds_read_b64_tr_b16 a[218:219], v99 offset:15776
  ds_read_b64_tr_b16 a[240:241], v99 offset:15424
  ds_read_b64_tr_b16 a[242:243], v99 offset:15808
  ds_read_b64_tr_b16 a[196:197], v99 offset:18432
  ds_read_b64_tr_b16 a[198:199], v99 offset:18816
  ds_read_b64_tr_b16 a[220:221], v99 offset:18464
  ds_read_b64_tr_b16 a[222:223], v99 offset:18848
  ds_read_b64_tr_b16 a[244:245], v99 offset:18496
  ds_read_b64_tr_b16 a[246:247], v99 offset:18880
  ds_read_b64_tr_b16 a[200:201], v99 offset:21504
  ds_read_b64_tr_b16 a[202:203], v99 offset:21888
  ds_read_b64_tr_b16 a[224:225], v99 offset:21536
  ds_read_b64_tr_b16 a[226:227], v99 offset:21920
  ds_read_b64_tr_b16 a[248:249], v99 offset:21568
  ds_read_b64_tr_b16 a[250:251], v99 offset:21952
  s_waitcnt lgkmcnt(0)
  v_mov_b32 v174, 0
  v_mov_b32 v175, 0
  v_mov_b32 v218, 0
  v_mov_b32 v219, 0
  v_mov_b32 v234, 0
  v_mov_b32 v235, 0
  v_mov_b32 v220, 0
  v_mov_b32 v221, 0
  v_mov_b32 v222, 0
  v_mov_b32 v223, 0
  v_mov_b32 v224, 0
  v_mov_b32 v225, 0
  v_mov_b32 v226, 0
  v_mov_b32 v227, 0
  s_waitcnt vmcnt(0)
  s_barrier
  s_add_u32 s12, s44, 81068032
  s_addc_u32 s13, s45, 0
  s_mov_b32 s14, 115712
  s_mov_b32 s15, 0x00020000
  s_add_u32 s28, s44, 114294784
  s_addc_u32 s29, s45, 0
  s_mov_b32 s30, 83886080
  s_mov_b32 s31, 0x00020000
  s_mul_i32 s89, s59, 5
  s_lshr_b32 s21, s87, 3
  s_add_u32 s89, s89, s21
  s_and_b32 s87, s87, 7
  s_lshl_b32 s79, s59, 7
  s_and_b32 s21, s51, 12
  s_add_u32 s79, s79, s21
  s_add_u32 s79, s79, 94208
  v_mov_b32 v94, 0
  v_mov_b32 v95, 0
  s_lshl_b32 s90, s58, 7
  s_lshl_b32 s21, s56, 3
  s_add_u32 s90, s90, s21
  s_add_u32 s90, s90, 18432
  s_cmp_lg_u32 s20, 0
  s_cbranch_scc1 fm_19
  s_bfe_u32 s82, s50, 0x10001
  s_lshl_b32 s82, s82, 5
  s_lshr_b32 s21, s50, 2
  s_add_u32 s82, s82, s21
  s_and_b32 s80, s50, 1
  s_lshl_b32 s80, s80, 4
  s_add_u32 s80, s80, 16
  s_mov_b32 s101, 0
  s_branch fm_20
fm_18:
  s_sleep 8
fm_22:
  buffer_load_dword v238, v239, s[32:35], 0 offen sc1
  s_cmp_eq_u32 s83, 0
  s_cbranch_scc1 fm_20
  buffer_load_dword v242, v243, s[12:15], s78 offen sc1
fm_20:
  s_add_u32 s101, s101, 1
  s_cmp_gt_u32 s101, 131072
  s_cbranch_scc1 end0
  s_waitcnt vmcnt(0)
  s_mov_b32 s81, s83
  v_readlane_b32 s83, v238, 19
  s_cmp_eq_u32 s83, 0
  s_cbranch_scc1 fm_18
  s_cmp_eq_u32 s81, 0
  s_cbranch_scc1 fm_22
  v_readlane_b32 s22, v238, 0
  v_readlane_b32 s23, v238, 32
  s_add_u32 s22, s22, s23
  v_readlane_b32 s23, v238, 1
  s_add_u32 s22, s22, s23
  v_readlane_b32 s23, v238, 33
  s_add_u32 s22, s22, s23
  v_readlane_b32 s23, v238, 2
  s_add_u32 s22, s22, s23
  v_readlane_b32 s23, v238, 34
  s_add_u32 s22, s22, s23
  v_readlane_b32 s23, v238, 3
  s_add_u32 s22, s22, s23
  v_readlane_b32 s23, v238, 35
  s_add_u32 s22, s22, s23
  v_readlane_b32 s21, v238, 16
  v_readlane_b32 s23, v238, 21
  v_cmp_gt_u32 vcc, 1, v242
  s_cmp_ge_u32 s22, 256
  s_cselect_b32 s23, s23, 0
  s_cmp_ge_u32 s21, 128
  s_cselect_b32 s23, s23, 0
  s_cbranch_vccnz fm_18
  s_cmp_eq_u32 s23, 0
  s_cbranch_scc1 fm_18
  v_readlane_b32 s21, v238, s82
  v_cmp_ne_u32 vcc, 32, v238
  s_cmp_ge_u32 s21, s80
  s_cselect_b32 s81, 1, 0
  s_andn2_b32 s53, s81, s53
  s_and_b32 s21, vcc_lo, 15
  s_and_b32 s22, vcc_hi, 15
  s_or_b32 s21, s21, s22
  v_mov_b32 v244, s23
  v_mov_b32 v245, s53
  v_mov_b32 v246, s21
  v_mov_b32 v236, 0
  ds_write_b96 v236, v[244:246]
  s_waitcnt lgkmcnt(0)
fm_19:
  s_barrier
  v_mov_b32 v236, 0
  ds_read_b96 v[244:246], v236
  s_mov_b32 s23, 0
  s_mov_b32 s67, 0
  s_mov_b32 s68, 0
  s_sub_u32 s21, s23, 64
  s_mul_i32 s21, s21, 160
  s_add_u32 s21, s21, s89
  s_lshl_b32 s21, s21, 14
  s_add_u32 s64, s21, s67
  s_lshr_b32 s22, s64, 8
  s_xor_b32 s64, s64, s22
  s_xor_b32 s64, s64, s68
  s_and_b32 s64, s64, 8192
  s_add_u32 s64, s64, s21
  s_add_u32 s64, s64, 83886080
  s_mul_i32 s21, s23, 160
  s_add_u32 s21, s21, s89
  s_lshl_b32 s21, s21, 13
  s_cmp_lt_u32 s23, 64
  s_cselect_b32 s64, s21, s64
  s_add_u32 s69, s89, 1
  s_sub_u32 s21, s23, 64
  s_mul_i32 s21, s21, 160
  s_add_u32 s21, s21, s69
  s_lshl_b32 s21, s21, 14
  s_add_u32 s66, s21, s67
  s_lshr_b32 s22, s66, 8
  s_xor_b32 s66, s66, s22
  s_xor_b32 s66, s66, s68
  s_and_b32 s66, s66, 8192
  s_add_u32 s66, s66, s21
  s_add_u32 s66, s66, 83886080
  s_mul_i32 s21, s23, 160
  s_add_u32 s21, s21, s69
  s_lshl_b32 s21, s21, 13
  s_cmp_lt_u32 s23, 64
  s_cselect_b32 s66, s21, s66
  s_lshl_b32 s21, s87, 10
  s_add_u32 s64, s64, s21
  s_add_u32 s66, s66, s21
  s_sub_u32 s66, s66, 8192
  s_cmp_lt_u32 s87, 7
  s_cselect_b32 s65, s64, s66
  s_cmp_lt_u32 s87, 6
  s_cselect_b32 s66, s64, s66
  buffer_load_dwordx4 v[176:179], v16, s[28:31], s64 offen offset:0 sc1
  buffer_load_dwordx4 v[180:183], v16, s[28:31], s65 offen offset:1024 sc1
  buffer_load_dwordx4 v[184:187], v16, s[28:31], s66 offen offset:2048 sc1
  s_cmp_ge_u32 s20, 2
  s_cbranch_scc1 pf_23
  buffer_load_dwordx2 v[168:169], v18, s[16:19], 0 offen sc1
  buffer_load_dwordx2 v[170:171], v19, s[16:19], 0 offen sc1
  buffer_load_dwordx2 v[172:173], v20, s[16:19], 0 offen sc1
pf_23:
  s_waitcnt lgkmcnt(0)
  v_readfirstlane_b32 s53, v245
  v_readfirstlane_b32 s69, v244
  v_readfirstlane_b32 s21, v246
  v_mov_b32 v237, v244
  s_cmp_eq_u32 s21, 0
  s_cbranch_scc1 fm_21
  s_mov_b32 s83, 0
  v_mov_b32 v28, -1
  v_mov_b32 v29, -1
  v_mov_b32 v30, -1
  v_mov_b32 v31, -1
  s_cmp_eq_u32 s20, 3
  s_cbranch_scc1 ra_24
  s_mov_b64 exec, s[74:75]
  buffer_store_dwordx2 v[28:29], v7, s[8:11], s83 offen sc1
ra_24:
  s_cmp_lt_u32 s20, 3
  s_cbranch_scc1 ra_25
  s_mov_b64 exec, -1
  buffer_store_dwordx2 v[28:29], v24, s[8:11], s83 offen sc1
  s_mov_b64 exec, s[60:61]
  s_add_u32 s21, s83, 278528
  buffer_store_dwordx2 v[28:29], v23, s[8:11], s21 offen sc1
ra_25:
  s_mov_b64 exec, -1
  s_nop 1
  s_mov_b32 s83, 540672
  v_mov_b32 v28, -1
  v_mov_b32 v29, -1
  v_mov_b32 v30, -1
  v_mov_b32 v31, -1
  s_cmp_eq_u32 s20, 3
  s_cbranch_scc1 ra_26
  s_mov_b64 exec, s[74:75]
  buffer_store_dwordx2 v[28:29], v7, s[8:11], s83 offen sc1
ra_26:
  s_cmp_lt_u32 s20, 3
  s_cbranch_scc1 ra_27
  s_mov_b64 exec, -1
  buffer_store_dwordx2 v[28:29], v24, s[8:11], s83 offen sc1
  s_mov_b64 exec, s[60:61]
  s_add_u32 s21, s83, 278528
  buffer_store_dwordx2 v[28:29], v23, s[8:11], s21 offen sc1
ra_27:
  s_mov_b64 exec, -1
  s_nop 1
  s_mov_b32 s83, 1081344
  v_mov_b32 v28, -1
  v_mov_b32 v29, -1
  v_mov_b32 v30, -1
  v_mov_b32 v31, -1
  s_cmp_eq_u32 s20, 3
  s_cbranch_scc1 ra_28
  s_mov_b64 exec, s[74:75]
  buffer_store_dwordx2 v[28:29], v7, s[8:11], s83 offen sc1
ra_28:
  s_cmp_lt_u32 s20, 3
  s_cbranch_scc1 ra_29
  s_mov_b64 exec, -1
  buffer_store_dwordx2 v[28:29], v24, s[8:11], s83 offen sc1
  s_mov_b64 exec, s[60:61]
  s_add_u32 s21, s83, 278528
  buffer_store_dwordx2 v[28:29], v23, s[8:11], s21 offen sc1
ra_29:
  s_mov_b64 exec, -1
  s_nop 1
  s_mov_b32 s83, 1622016
  v_mov_b32 v28, -1
  v_mov_b32 v29, -1
  v_mov_b32 v30, -1
  v_mov_b32 v31, -1
  s_cmp_eq_u32 s20, 3
  s_cbranch_scc1 ra_30
  s_mov_b64 exec, s[74:75]
  buffer_store_dwordx2 v[28:29], v7, s[8:11], s83 offen sc1
ra_30:
  s_cmp_lt_u32 s20, 3
  s_cbranch_scc1 ra_31
  s_mov_b64 exec, -1
  buffer_store_dwordx2 v[28:29], v24, s[8:11], s83 offen sc1
  s_mov_b64 exec, s[60:61]
  s_add_u32 s21, s83, 278528
  buffer_store_dwordx2 v[28:29], v23, s[8:11], s21 offen sc1
ra_31:
  s_mov_b64 exec, -1
  s_nop 1
  s_waitcnt vmcnt(0)
  s_barrier
  s_mov_b32 s21, 100
  s_cmp_lg_u32 s20, 0
  s_cbranch_scc1 af_32
  v_mov_b32 v240, 0
  v_mov_b32 v241, 1
  s_mov_b64 exec, 1
  buffer_atomic_add v241, v240, s[32:35], s21 offen sc1
  s_mov_b64 exec, -1
  s_nop 1
af_32:
  s_cmp_lg_u32 s20, 0
  s_cbranch_scc1 wf_34
  v_mov_b32 v240, 0
  s_mov_b32 s101, 0
wf_33:
  buffer_load_dword v241, v240, s[32:35], s21 offen sc1
  s_add_u32 s101, s101, 1
  s_cmp_gt_u32 s101, 131072
  s_cbranch_scc1 end0
  s_waitcnt vmcnt(0)
  v_readfirstlane_b32 s100, v241
  s_cmp_ge_u32 s100, 128
  s_cbranch_scc1 wf_34
  s_sleep 8
  s_branch wf_33
wf_34:
  s_barrier
fm_21:
  s_add_u32 s67, s44, 83886079
  s_lshr_b32 s67, s67, 21
  s_xor_b32 s68, s67, s69
  s_xor_b32 s68, s68, 0
  s_and_b32 s68, s68, 1
  s_lshl_b32 s68, s68, 13
  s_add_u32 s67, s44, 198180864
  s_mov_b32 s23, 1
  s_sub_u32 s21, s23, 64
  s_mul_i32 s21, s21, 160
  s_add_u32 s21, s21, s89
  s_lshl_b32 s21, s21, 14
  s_add_u32 s64, s21, s67
  s_lshr_b32 s22, s64, 8
  s_xor_b32 s64, s64, s22
  s_xor_b32 s64, s64, s68
  s_and_b32 s64, s64, 8192
  s_add_u32 s64, s64, s21
  s_add_u32 s64, s64, 83886080
  s_mul_i32 s21, s23, 160
  s_add_u32 s21, s21, s89
  s_lshl_b32 s21, s21, 13
  s_cmp_lt_u32 s23, 64
  s_cselect_b32 s64, s21, s64
  s_add_u32 s69, s89, 1
  s_sub_u32 s21, s23, 64
  s_mul_i32 s21, s21, 160
  s_add_u32 s21, s21, s69
  s_lshl_b32 s21, s21, 14
  s_add_u32 s66, s21, s67
  s_lshr_b32 s22, s66, 8
  s_xor_b32 s66, s66, s22
  s_xor_b32 s66, s66, s68
  s_and_b32 s66, s66, 8192
  s_add_u32 s66, s66, s21
  s_add_u32 s66, s66, 83886080
  s_mul_i32 s21, s23, 160
  s_add_u32 s21, s21, s69
  s_lshl_b32 s21, s21, 13
  s_cmp_lt_u32 s23, 64
  s_cselect_b32 s66, s21, s66
  s_lshl_b32 s21, s87, 10
  s_add_u32 s64, s64, s21
  s_add_u32 s66, s66, s21
  s_sub_u32 s66, s66, 8192
  s_cmp_lt_u32 s87, 7
  s_cselect_b32 s65, s64, s66
  s_cmp_lt_u32 s87, 6
  s_cselect_b32 s66, s64, s66
  v_add_u32 v237, -1, v237
  v_lshlrev_b32 v237, 13, v237
  v_xor_b32 v237, 0, v237
  v_add_u32 v13, v13, v237
  v_add_u32 v4, v4, v237
  s_barrier
  v_add_u32 v242, 1088, v5
  v_add_u32 v243, 2176, v5
  v_add_u32 v244, 3264, v5
  v_add_u32 v245, 4352, v5
  s_mov_b32 s52, 0
  s_mov_b32 s47, 0
  v_mov_b32 v52, 0
  v_mov_b32 v53, 0
  v_mov_b32 v54, 0
  v_mov_b32 v55, 0
  v_mov_b32 v56, 0
  v_mov_b32 v57, 0
  v_mov_b32 v58, 0
  v_mov_b32 v59, 0
  v_mov_b32 v60, 0
  v_mov_b32 v61, 0
  v_mov_b32 v62, 0
  v_mov_b32 v63, 0
  v_mov_b32 v64, 0
  v_mov_b32 v65, 0
  v_mov_b32 v66, 0
  v_mov_b32 v67, 0
  v_mov_b32 v68, 0
  v_mov_b32 v69, 0
  v_mov_b32 v70, 0
  v_mov_b32 v71, 0
  v_mov_b32 v72, 0
  v_mov_b32 v73, 0
  v_mov_b32 v74, 0
  v_mov_b32 v75, 0
  v_mov_b32 v76, 0
  v_mov_b32 v77, 0
  v_mov_b32 v78, 0
  v_mov_b32 v79, 0
  v_mov_b32 v80, 0
  v_mov_b32 v81, 0
  v_mov_b32 v82, 0
  v_mov_b32 v83, 0
  v_mov_b32 v84, 0
  v_mov_b32 v85, 0
  v_mov_b32 v86, 0
  v_mov_b32 v87, 0
  v_mov_b32 v156, 0
  v_mov_b32 v157, 0
  v_mov_b32 v158, 0
  v_mov_b32 v159, 0
  s_and_b32 s21, s52, 3
  s_mul_i32 s81, s21, 540672
  s_lshl_b32 s84, s21, 15
  s_add_u32 s21, s52, 2
  s_and_b32 s21, s21, 3
  s_mul_i32 s82, s21, 540672
  s_add_u32 s21, s52, 3
  s_and_b32 s21, s21, 3
  s_lshl_b32 s83, s21, 15
  s_add_u32 s21, s52, 1
  s_and_b32 s22, s21, 3
  s_lshl_b32 s3, s22, 15
  s_mul_i32 s80, s21, 393216
  s_add_u32 s46, s21, 1
  s_min_u32 s46, s46, 64
  s_mul_i32 s85, s52, 98304
  s_add_u32 s57, s85, 6291456
  s_bfe_u32 s88, s52, 0x10002
  s_add_u32 s78, s81, 278528
  s_cmp_eq_u32 s53, 0
  s_cbranch_scc1 A1_39
  s_cmp_eq_u32 s20, 0
  s_cbranch_scc1 A1_35
  s_cmp_eq_u32 s20, 1
  s_cbranch_scc1 A1_36
  s_cmp_eq_u32 s20, 2
  s_cbranch_scc1 A1_37
  s_cmp_eq_u32 s20, 3
  s_cbranch_scc1 A1_38
  s_branch A1_39
step_40:
  s_add_u32 s21, s52, 2
  s_and_b32 s21, s21, 3
  s_mul_i32 s82, s21, 540672
  s_add_u32 s21, s52, 3
  s_and_b32 s21, s21, 3
  s_lshl_b32 s83, s21, 15
  s_add_u32 s21, s52, 1
  s_and_b32 s22, s21, 3
  s_lshl_b32 s3, s22, 15
  s_mul_i32 s80, s21, 393216
  s_add_u32 s46, s21, 1
  s_min_u32 s46, s46, 64
  s_mul_i32 s85, s52, 98304
  s_add_u32 s57, s85, 6291456
  s_bfe_u32 s88, s52, 0x10002
  s_add_u32 s78, s81, 278528
  v_mov_b32 v52, 0
  v_mov_b32 v53, 0
  v_mov_b32 v54, 0
  v_mov_b32 v55, 0
  v_mov_b32 v56, 0
  v_mov_b32 v57, 0
  v_mov_b32 v58, 0
  v_mov_b32 v59, 0
  v_mov_b32 v60, 0
  v_mov_b32 v61, 0
  v_mov_b32 v62, 0
  v_mov_b32 v63, 0
  v_mov_b32 v64, 0
  v_mov_b32 v65, 0
  v_mov_b32 v66, 0
  v_mov_b32 v67, 0
  v_mov_b32 v68, 0
  v_mov_b32 v69, 0
  v_mov_b32 v70, 0
  v_mov_b32 v71, 0
  v_mov_b32 v72, 0
  v_mov_b32 v73, 0
  v_mov_b32 v74, 0
  v_mov_b32 v75, 0
  v_mov_b32 v76, 0
  v_mov_b32 v77, 0
  v_mov_b32 v78, 0
  v_mov_b32 v79, 0
  v_mov_b32 v80, 0
  v_mov_b32 v81, 0
  v_mov_b32 v82, 0
  v_mov_b32 v83, 0
  v_mov_b32 v84, 0
  v_mov_b32 v85, 0
  v_mov_b32 v86, 0
  v_mov_b32 v87, 0
  s_sleep 6
  s_mov_b32 s54, 0
  buffer_load_dwordx4 v[96:99], v4, s[4:7], s84 offen offset:0 sc1
  buffer_load_dwordx4 v[100:103], v4, s[4:7], s84 offen offset:1024 sc1
  buffer_load_dwordx4 v[104:107], v4, s[4:7], s84 offen offset:2048 sc1
  s_waitcnt vmcnt(3)
  v_mov_b32 v176, v160
  v_mov_b32 v177, v161
  v_mov_b32 v178, v162
  v_mov_b32 v179, v163
  v_mov_b32 v180, v164
  v_mov_b32 v181, v165
  v_mov_b32 v182, v166
  v_mov_b32 v183, v167
  v_mov_b32 v184, v48
  v_mov_b32 v185, v49
  v_mov_b32 v186, v50
  v_mov_b32 v187, v51
  s_waitcnt vmcnt(0)
  v_bitop3_b32 v27, v99, v103, v107 bitop3:0x80
  v_cvt_f32_f16 v108, v99
  v_and_b32 v27, 0x48000000, v27
  v_cvt_f32_f16 v109, v103
  v_cmp_ne_u32 vcc, 0x48000000, v27
  v_cvt_f32_f16 v110, v106
  v_cvt_f32_f16_sdwa v111, v106 dst_sel:DWORD dst_unused:UNUSED_PAD src0_sel:WORD_1
  v_cvt_pk_bf16_f32 v40, v110, v111
  s_cbranch_vccnz pm_42
pm_43:
  v_cvt_pk_bf16_f32 v41, v108, v109
  v_cvt_f32_f16 v110, v96
  v_cvt_f32_f16_sdwa v111, v96 dst_sel:DWORD dst_unused:UNUSED_PAD src0_sel:WORD_1
  v_smfmac_f32_16x16x32_bf16 v[52:55], v[40:41], a[16:19], v44
  v_cvt_f32_f16 v112, v97
  v_cvt_f32_f16_sdwa v113, v97 dst_sel:DWORD dst_unused:UNUSED_PAD src0_sel:WORD_1
  v_cvt_pk_bf16_f32 v32, v110, v111
  v_smfmac_f32_16x16x32_bf16 v[64:67], v[40:41], a[76:79], v44
  v_cvt_pk_bf16_f32 v33, v112, v113
  v_cvt_f32_f16 v114, v98
  v_cvt_f32_f16_sdwa v115, v98 dst_sel:DWORD dst_unused:UNUSED_PAD src0_sel:WORD_1
  v_smfmac_f32_16x16x32_bf16 v[56:59], v[40:41], a[36:39], v44
  v_cvt_f32_f16 v116, v100
  v_cvt_f32_f16_sdwa v117, v100 dst_sel:DWORD dst_unused:UNUSED_PAD src0_sel:WORD_1
  v_cvt_pk_bf16_f32 v34, v114, v115
  v_smfmac_f32_16x16x32_bf16 v[68:71], v[40:41], a[96:99], v44
  v_cvt_pk_bf16_f32 v35, v116, v117
  v_cvt_f32_f16 v110, v101
  v_cvt_f32_f16_sdwa v111, v101 dst_sel:DWORD dst_unused:UNUSED_PAD src0_sel:WORD_1
  v_smfmac_f32_16x16x32_bf16 v[60:63], v[40:41], a[56:59], v44
  v_cvt_f32_f16 v112, v102
  v_cvt_f32_f16_sdwa v113, v102 dst_sel:DWORD dst_unused:UNUSED_PAD src0_sel:WORD_1
  v_smfmac_f32_16x16x32_bf16 v[72:75], v[40:41], a[116:119], v44
  v_cvt_pk_bf16_f32 v36, v110, v111
  v_cvt_pk_bf16_f32 v37, v112, v113
  v_smfmac_f32_16x16x32_bf16 v[76:79], v[40:41], a[136:139], v44
  v_cvt_f32_f16 v114, v104
  v_cvt_f32_f16_sdwa v115, v104 dst_sel:DWORD dst_unused:UNUSED_PAD src0_sel:WORD_1
  v_smfmac_f32_16x16x32_bf16 v[80:83], v[40:41], a[156:159], v44
  v_cvt_f32_f16 v116, v105
  v_cvt_f32_f16_sdwa v117, v105 dst_sel:DWORD dst_unused:UNUSED_PAD src0_sel:WORD_1
  v_smfmac_f32_16x16x32_bf16 v[84:87], v[40:41], a[176:179], v44
  v_cvt_pk_bf16_f32 v38, v114, v115
  v_cvt_pk_bf16_f32 v39, v116, v117
A2_44:
  v_smfmac_f32_16x16x64_bf16 v[52:55], v[32:35], a[0:7], v44
  v_smfmac_f32_16x16x64_bf16 v[52:55], v[36:39], a[8:15], v44
  v_smfmac_f32_16x16x64_bf16 v[64:67], v[32:35], a[60:67], v44
  v_smfmac_f32_16x16x64_bf16 v[64:67], v[36:39], a[68:75], v44
  v_smfmac_f32_16x16x64_bf16 v[56:59], v[32:35], a[20:27], v44
  v_smfmac_f32_16x16x64_bf16 v[56:59], v[36:39], a[28:35], v44
  v_smfmac_f32_16x16x64_bf16 v[68:71], v[32:35], a[80:87], v44
  v_permlane32_swap_b32 v52, v64
  v_permlane32_swap_b32 v53, v65
  v_permlane32_swap_b32 v54, v66
  v_smfmac_f32_16x16x64_bf16 v[68:71], v[36:39], a[88:95], v44
  v_permlane32_swap_b32 v55, v67
  v_pk_add_f32 v[52:53], v[52:53], v[64:65]
  v_pk_add_f32 v[54:55], v[54:55], v[66:67]
  v_smfmac_f32_16x16x64_bf16 v[60:63], v[32:35], a[40:47], v44
  ds_write2_b32 v5, v52, v53 offset0:0 offset1:4
  ds_write2_b32 v5, v54, v55 offset0:8 offset1:12
  v_smfmac_f32_16x16x64_bf16 v[60:63], v[36:39], a[48:55], v44
  v_smfmac_f32_16x16x64_bf16 v[72:75], v[32:35], a[100:107], v44
  v_permlane32_swap_b32 v56, v68
  v_permlane32_swap_b32 v57, v69
  v_permlane32_swap_b32 v58, v70
  v_smfmac_f32_16x16x64_bf16 v[72:75], v[36:39], a[108:115], v44
  v_permlane32_swap_b32 v59, v71
  v_pk_add_f32 v[56:57], v[56:57], v[68:69]
  v_pk_add_f32 v[58:59], v[58:59], v[70:71]
  v_smfmac_f32_16x16x64_bf16 v[76:79], v[32:35], a[120:127], v44
  ds_write2_b32 v242, v56, v57 offset0:0 offset1:4
  ds_write2_b32 v242, v58, v59 offset0:8 offset1:12
  v_smfmac_f32_16x16x64_bf16 v[76:79], v[36:39], a[128:135], v44
  v_smfmac_f32_16x16x64_bf16 v[80:83], v[32:35], a[140:147], v44
  v_permlane32_swap_b32 v60, v72
  v_permlane32_swap_b32 v61, v73
  v_permlane32_swap_b32 v62, v74
  v_smfmac_f32_16x16x64_bf16 v[80:83], v[36:39], a[148:155], v44
  v_permlane32_swap_b32 v63, v75
  v_pk_add_f32 v[60:61], v[60:61], v[72:73]
  v_pk_add_f32 v[62:63], v[62:63], v[74:75]
  v_smfmac_f32_16x16x64_bf16 v[84:87], v[32:35], a[160:167], v44
  ds_write2_b32 v243, v60, v61 offset0:0 offset1:4
  ds_write2_b32 v243, v62, v63 offset0:8 offset1:12
  v_smfmac_f32_16x16x64_bf16 v[84:87], v[36:39], a[168:175], v44
  v_permlane32_swap_b32 v76, v80
  v_permlane32_swap_b32 v77, v81
  v_permlane32_swap_b32 v78, v82
  v_permlane32_swap_b32 v79, v83
  v_pk_add_f32 v[76:77], v[76:77], v[80:81]
  v_pk_add_f32 v[78:79], v[78:79], v[82:83]
  ds_write2_b32 v244, v76, v77 offset0:0 offset1:4
  ds_write2_b32 v244, v78, v79 offset0:8 offset1:12
  ds_write2_b32 v245, v84, v85 offset0:0 offset1:4
  ds_write2_b32 v245, v86, v87 offset0:8 offset1:12
  s_waitcnt lgkmcnt(0) vmcnt(0)
  s_barrier
  ds_read_b128 v[96:99], v45 offset:0
  ds_read_b128 v[108:111], v45 offset:5440
  ds_read_b128 v[100:103], v45 offset:1088
  ds_read_b128 v[112:115], v45 offset:6528
  ds_read_b128 v[104:107], v45 offset:2176
  ds_read_b128 v[116:119], v45 offset:7616
  s_waitcnt lgkmcnt(4)
  v_pk_add_f32 v[96:97], v[96:97], v[108:109]
  v_pk_add_f32 v[98:99], v[98:99], v[110:111]
  s_nop 0
  v_add_f32_dpp v108, v96, v96 row_ror:8 row_mask:0xf bank_mask:0xf
  v_add_f32_dpp v109, v97, v97 row_ror:8 row_mask:0xf bank_mask:0xf
  v_add_f32_dpp v110, v98, v98 row_ror:8 row_mask:0xf bank_mask:0xf
  v_add_f32_dpp v111, v99, v99 row_ror:8 row_mask:0xf bank_mask:0xf
  v_cvt_pk_bf16_f32 v212, v108, v109
  v_cvt_pk_bf16_f32 v213, v110, v111
  s_waitcnt lgkmcnt(2)
  v_pk_add_f32 v[100:101], v[100:101], v[112:113]
  v_pk_add_f32 v[102:103], v[102:103], v[114:115]
  s_nop 0
  v_add_f32_dpp v112, v100, v100 row_ror:8 row_mask:0xf bank_mask:0xf
  v_add_f32_dpp v113, v101, v101 row_ror:8 row_mask:0xf bank_mask:0xf
  v_add_f32_dpp v114, v102, v102 row_ror:8 row_mask:0xf bank_mask:0xf
  v_add_f32_dpp v115, v103, v103 row_ror:8 row_mask:0xf bank_mask:0xf
  v_cvt_pk_bf16_f32 v214, v112, v113
  v_cvt_pk_bf16_f32 v215, v114, v115
  s_waitcnt lgkmcnt(0)
  v_pk_add_f32 v[104:105], v[104:105], v[116:117]
  v_pk_add_f32 v[106:107], v[106:107], v[118:119]
  v_mfma_f32_16x16x32_bf16 v[96:99], v[168:171], v[212:215], 0
  v_add_f32_dpp v116, v104, v104 row_ror:8 row_mask:0xf bank_mask:0xf
  v_add_f32_dpp v117, v105, v105 row_ror:8 row_mask:0xf bank_mask:0xf
  v_add_f32_dpp v118, v106, v106 row_ror:8 row_mask:0xf bank_mask:0xf
  v_add_f32_dpp v119, v107, v107 row_ror:8 row_mask:0xf bank_mask:0xf
  v_cvt_pk_bf16_f32 v216, v116, v117
  v_cvt_pk_bf16_f32 v217, v118, v119
  s_nop 1
  v_mfma_f32_16x16x32_bf16 v[96:99], v[172:175], v[216:219], v[96:99]
  s_mov_b64 exec, s[74:75]
  s_nop 6
  v_cvt_pk_f16_f32 v100, v96, v97
  v_cvt_pk_f16_f32 v101, v98, v99
  v_and_or_b32 v100, v100, -2, s88
  buffer_store_dwordx2 v[100:101], v7, s[8:11], s81 offen
  s_mov_b64 exec, -1
  s_cmp_eq_u32 s52, 63
  s_cbranch_scc1 last_41
  s_sleep 5
  s_mov_b32 s54, 0
  buffer_load_dwordx2 v[248:249], v9, s[8:11], s81 offen sc1
  buffer_load_dwordx4 v[112:115], v8, s[8:11], s81 offen offset:0 sc1
  buffer_load_dwordx4 v[116:119], v8, s[8:11], s81 offen offset:1024 sc1
  s_sleep 2
  buffer_load_dwordx4 v[144:147], v10, s[8:11], s81 offen offset:0 sc1
  buffer_load_dwordx4 v[148:151], v10, s[8:11], s81 offen offset:1024 sc1
  buffer_load_dwordx4 v[152:155], v10, s[8:11], s81 offen offset:2048 sc1
  v_mov_b32 v188, 0
  v_mov_b32 v189, 0
  v_mov_b32 v190, 0
  v_mov_b32 v191, 0
  v_mov_b32 v192, 0
  v_mov_b32 v193, 0
  v_mov_b32 v194, 0
  v_mov_b32 v195, 0
  v_mov_b32 v196, 0
  v_mov_b32 v197, 0
  v_mov_b32 v198, 0
  v_mov_b32 v199, 0
  v_readfirstlane_b32 s21, v94
  s_add_u32 s22, s46, 8
  s_min_u32 s22, s22, 64
  s_sub_u32 s55, s21, s22
  s_sub_u32 s56, s21, s46
  s_waitcnt vmcnt(5)
  v_xor_b32 v96, s88, v248
  s_nop 0
  v_permlane16_swap_b32 v248, v249
  v_fma_mix_f32 v250, v248, 1.0, v249 op_sel:[0,0,0] op_sel_hi:[1,0,1]
  v_fma_mix_f32 v251, v248, 1.0, v249 op_sel:[1,0,1] op_sel_hi:[1,0,1]
  v_mov_b32 v248, v250
  v_mov_b32 v249, v251
  s_nop 0
  v_permlane32_swap_b32 v248, v250
  v_permlane32_swap_b32 v249, v251
  s_waitcnt vmcnt(3)
  v_bitop3_b32 v97, v112, v114, s88 bitop3:0x7e
  v_bitop3_b32 v98, v116, v118, s88 bitop3:0x7e
  v_fma_mix_f32 v120, v112, 1.0, v116 op_sel:[0,0,0] op_sel_hi:[1,0,1]
  v_or3_b32 v27, v96, v97, v98
  v_fma_mix_f32 v124, v114, 1.0, v118 op_sel:[0,0,0] op_sel_hi:[1,0,1]
  v_and_b32 v27, 1, v27
  v_fma_mix_f32 v121, v112, 1.0, v116 op_sel:[1,0,1] op_sel_hi:[1,0,1]
  v_cmp_ne_u32 vcc, 0, v27
  v_fma_mix_f32 v125, v114, 1.0, v118 op_sel:[1,0,1] op_sel_hi:[1,0,1]
  v_fma_mix_f32 v122, v113, 1.0, v117 op_sel:[0,0,0] op_sel_hi:[1,0,1]
  v_fma_mix_f32 v126, v115, 1.0, v119 op_sel:[0,0,0] op_sel_hi:[1,0,1]
  s_cbranch_vccnz psr_46
psj_47:
  s_cmp_lt_i32 s56, 0
  s_cbranch_scc1 kvw_49
kvok_50:
  v_fma_mix_f32 v123, v113, 1.0, v117 op_sel:[1,0,1] op_sel_hi:[1,0,1]
  v_fma_mix_f32 v127, v115, 1.0, v119 op_sel:[1,0,1] op_sel_hi:[1,0,1]
  v_permlane32_swap_b32 v120, v124
  v_permlane32_swap_b32 v121, v125
  v_permlane32_swap_b32 v122, v126
  v_permlane32_swap_b32 v123, v127
  v_pk_add_f32 v[120:121], v[120:121], v[124:125]
  v_pk_add_f32 v[122:123], v[122:123], v[126:127]
  v_pk_add_f32 v[124:125], v[248:249], v[250:251]
  v_max3_f32 v236, v120, v121, v122
  v_max3_f32 v237, v123, v124, v125
  v_max_f32 v236, v236, v237
  s_nop 1
  v_max_f32_dpp v236, v236, v236 row_ror:8 row_mask:0xf bank_mask:0xf
  v_mov_b32 v237, v236
  s_nop 1
  v_permlane32_swap_b32 v236, v237
  v_max_f32 v236, v236, v237
  v_mov_b32 v237, v236
  s_nop 1
  v_permlane16_swap_b32 v236, v237
  v_max_f32 v236, v236, v237
  s_waitcnt vmcnt(0)
  v_max3_u32 v27, v144, v146, v148
  v_max3_u32 v27, v27, v150, v152
  v_max3_u32 v27, v27, v154, v154
  v_cmp_eq_u32 vcc, -1, v27
  s_nop 1
  s_cbranch_vccnz pv_45
pvj_48:
  v_mul_f32 v236, s86, v236
  v_smfmac_f32_16x16x64_bf16 v[188:191], v[144:147], a[180:187], v44
  v_fma_f32 v120, v120, s86, -v236
  v_smfmac_f32_16x16x64_bf16 v[188:191], v[148:151], a[188:195], v44
  v_fma_f32 v121, v121, s86, -v236
  v_smfmac_f32_16x16x64_bf16 v[188:191], v[152:155], a[196:203], v44
  buffer_load_dwordx4 v[160:163], v16, s[28:31], s64 offen offset:0 sc1
  v_fma_f32 v122, v122, s86, -v236
  v_smfmac_f32_16x16x64_bf16 v[192:195], v[144:147], a[204:211], v44
  v_fma_f32 v123, v123, s86, -v236
  v_smfmac_f32_16x16x64_bf16 v[192:195], v[148:151], a[212:219], v44
  buffer_load_dwordx4 v[164:167], v16, s[28:31], s65 offen offset:1024 sc1
  v_fma_f32 v124, v124, s86, -v236
  v_smfmac_f32_16x16x64_bf16 v[192:195], v[152:155], a[220:227], v44
  v_fma_f32 v125, v125, s86, -v236
  v_smfmac_f32_16x16x64_bf16 v[196:199], v[144:147], a[228:235], v44
  buffer_load_dwordx4 v[48:51], v16, s[28:31], s66 offen offset:2048 sc1
  v_exp_f32 v120, v120
  v_smfmac_f32_16x16x64_bf16 v[196:199], v[148:151], a[236:243], v44
  v_exp_f32 v121, v121
  v_smfmac_f32_16x16x64_bf16 v[196:199], v[152:155], a[244:251], v44
  buffer_load_dwordx2 v[168:169], v18, s[16:19], s80 offen sc1
  v_exp_f32 v122, v122
  buffer_load_dwordx2 v[170:171], v19, s[16:19], s80 offen sc1
  v_exp_f32 v123, v123
  buffer_load_dwordx2 v[172:173], v20, s[16:19], s80 offen sc1
  v_exp_f32 v124, v124
  s_cmp_lt_i32 s55, 0
  s_cbranch_scc1 fl_51
fl_52:
  v_exp_f32 v125, v125
  s_mov_b64 exec, s[60:61]
  v_cvt_pk_bf16_f32 v220, v120, v121
  v_cvt_pk_bf16_f32 v221, v122, v123
  v_cvt_pk_bf16_f32 v224, v124, v125
  s_mov_b64 exec, s[62:63]
  v_cvt_pk_bf16_f32 v222, v120, v121
  v_cvt_pk_bf16_f32 v223, v122, v123
  v_cvt_pk_bf16_f32 v225, v124, v125
  s_mov_b64 exec, -1
  v_pk_add_f32 v[126:127], v[120:121], v[122:123]
  v_add_f32 v128, v124, v125
  v_mfma_f32_16x16x32_bf16 v[200:203], v[176:179], v[220:223], 0
  v_add_f32 v236, v126, v127
  v_fmac_f32 v236, v128, v89
  v_cvt_pk_bf16_f32 v228, v188, v189
  v_cvt_pk_bf16_f32 v229, v190, v191
  v_mfma_f32_16x16x32_bf16 v[204:207], v[180:183], v[220:223], 0
  v_cvt_pk_bf16_f32 v230, v192, v193
  v_cvt_pk_bf16_f32 v231, v194, v195
  v_mfma_f32_16x16x32_bf16 v[208:211], v[184:187], v[220:223], 0
  v_cvt_pk_bf16_f32 v232, v196, v197
  v_cvt_pk_bf16_f32 v233, v198, v199
  v_add_f32_dpp v236, v236, v236 row_ror:8 row_mask:0xf bank_mask:0xf
  v_mov_b32 v237, v236
  s_nop 0
  v_mfma_f32_16x16x32_bf16 v[200:203], v[228:231], v[224:227], v[200:203]
  v_mfma_f32_16x16x32_bf16 v[204:207], v[230:233], v[224:227], v[204:207]
  v_permlane32_swap_b32 v236, v237
  v_add_f32 v236, v236, v237
  v_mov_b32 v237, v236
  v_mfma_f32_16x16x32_bf16 v[208:211], v[232:235], v[224:227], v[208:211]
  s_nop 0
  v_permlane16_swap_b32 v236, v237
  v_add_f32 v236, v236, v237
  v_rcp_f32 v236, v236
  s_nop 2
  v_pk_mul_f32 v[200:201], v[200:201], v[236:237] op_sel_hi:[1,0]
  v_pk_mul_f32 v[202:203], v[202:203], v[236:237] op_sel_hi:[1,0]
  ds_write_b128 v11, v[200:203] offset:0
  v_pk_mul_f32 v[204:205], v[204:205], v[236:237] op_sel_hi:[1,0]
  v_pk_mul_f32 v[206:207], v[206:207], v[236:237] op_sel_hi:[1,0]
  ds_write_b128 v11, v[204:207] offset:1024
  v_pk_mul_f32 v[208:209], v[208:209], v[236:237] op_sel_hi:[1,0]
  v_pk_mul_f32 v[210:211], v[210:211], v[236:237] op_sel_hi:[1,0]
  ds_write_b128 v11, v[208:211] offset:2048
  s_waitcnt lgkmcnt(0)
  s_barrier
  ds_read_b64 v[96:97], v12 offset:0
  ds_read_b64 v[98:99], v12 offset:128
  ds_read_b64 v[100:101], v12 offset:3072
  ds_read_b64 v[102:103], v12 offset:3200
  ds_read_b64 v[104:105], v12 offset:6144
  ds_read_b64 v[106:107], v12 offset:6272
  ds_read_b64 v[108:109], v12 offset:9216
  ds_read_b64 v[110:111], v12 offset:9344
  s_waitcnt lgkmcnt(6)
  v_pk_add_f32 v[96:97], v[96:97], v[98:99]
  s_waitcnt lgkmcnt(4)
  v_pk_add_f32 v[100:101], v[100:101], v[102:103]
  s_waitcnt lgkmcnt(2)
  v_pk_add_f32 v[104:105], v[104:105], v[106:107]
  v_pk_add_f32 v[96:97], v[96:97], v[100:101]
  s_waitcnt lgkmcnt(0)
  v_pk_add_f32 v[108:109], v[108:109], v[110:111]
  v_pk_add_f32 v[96:97], v[96:97], v[104:105]
  v_pk_add_f32 v[96:97], v[96:97], v[108:109]
  v_cvt_pk_f16_f32 v100, v96, v97
  v_perm_b32 v100, s91, v100, v14
  buffer_atomic_pk_add_f16 v100, v13, s[4:7], s3 offen
  s_add_u32 s23, s52, 2
  s_min_u32 s23, s23, 63
  s_sub_u32 s21, s23, 64
  s_mul_i32 s21, s21, 160
  s_add_u32 s21, s21, s89
  s_lshl_b32 s21, s21, 14
  s_add_u32 s64, s21, s67
  s_lshr_b32 s22, s64, 8
  s_xor_b32 s64, s64, s22
  s_xor_b32 s64, s64, s68
  s_and_b32 s64, s64, 8192
  s_add_u32 s64, s64, s21
  s_add_u32 s64, s64, 83886080
  s_mul_i32 s21, s23, 160
  s_add_u32 s21, s21, s89
  s_lshl_b32 s21, s21, 13
  s_cmp_lt_u32 s23, 64
  s_cselect_b32 s64, s21, s64
  s_add_u32 s69, s89, 1
  s_sub_u32 s21, s23, 64
  s_mul_i32 s21, s21, 160
  s_add_u32 s21, s21, s69
  s_lshl_b32 s21, s21, 14
  s_add_u32 s66, s21, s67
  s_lshr_b32 s22, s66, 8
  s_xor_b32 s66, s66, s22
  s_xor_b32 s66, s66, s68
  s_and_b32 s66, s66, 8192
  s_add_u32 s66, s66, s21
  s_add_u32 s66, s66, 83886080
  s_mul_i32 s21, s23, 160
  s_add_u32 s21, s21, s69
  s_lshl_b32 s21, s21, 13
  s_cmp_lt_u32 s23, 64
  s_cselect_b32 s66, s21, s66
  s_lshl_b32 s21, s87, 10
  s_add_u32 s64, s64, s21
  s_add_u32 s66, s66, s21
  s_sub_u32 s66, s66, 8192
  s_cmp_lt_u32 s87, 7
  s_cselect_b32 s65, s64, s66
  s_cmp_lt_u32 s87, 6
  s_cselect_b32 s66, s64, s66
  s_add_u32 s52, s52, 1
  s_and_b32 s21, s52, 3
  s_mul_i32 s81, s21, 540672
  s_lshl_b32 s84, s21, 15
  s_branch step_40
pm_42:
  s_mov_b32 s47, 1
  buffer_load_dwordx4 v[96:99], v4, s[4:7], s84 offen offset:0 sc1
  buffer_load_dwordx4 v[100:103], v4, s[4:7], s84 offen offset:1024 sc1
  buffer_load_dwordx4 v[104:107], v4, s[4:7], s84 offen offset:2048 sc1
  s_add_u32 s54, s54, 1
  s_cmp_gt_u32 s54, 131072
  s_cbranch_scc1 end0
  s_waitcnt vmcnt(0)
  v_bitop3_b32 v27, v99, v103, v107 bitop3:0x80
  v_cvt_f32_f16 v108, v99
  v_and_b32 v27, 0x48000000, v27
  v_cvt_f32_f16 v109, v103
  v_cmp_ne_u32 vcc, 0x48000000, v27
  v_cvt_f32_f16 v110, v106
  v_cvt_f32_f16_sdwa v111, v106 dst_sel:DWORD dst_unused:UNUSED_PAD src0_sel:WORD_1
  v_cvt_pk_bf16_f32 v40, v110, v111
  s_cbranch_vccnz pm_42
  s_branch pm_43
A1_35:
  v_smfmac_f32_16x16x32_bf16 v[52:55], v[40:41], a[16:19], v44
  v_smfmac_f32_16x16x32_bf16 v[64:67], v[40:41], a[76:79], v44
  v_smfmac_f32_16x16x32_bf16 v[56:59], v[40:41], a[36:39], v44
  v_smfmac_f32_16x16x32_bf16 v[68:71], v[40:41], a[96:99], v44
  v_smfmac_f32_16x16x32_bf16 v[60:63], v[40:41], a[56:59], v44
  v_smfmac_f32_16x16x32_bf16 v[72:75], v[40:41], a[116:119], v44
  v_smfmac_f32_16x16x32_bf16 v[76:79], v[40:41], a[136:139], v44
  v_smfmac_f32_16x16x32_bf16 v[80:83], v[40:41], a[156:159], v44
  v_smfmac_f32_16x16x32_bf16 v[84:87], v[40:41], a[176:179], v44
  s_branch A2_44
pv_45:
  buffer_load_dwordx4 v[144:147], v10, s[8:11], s81 offen offset:0 sc1
  buffer_load_dwordx4 v[148:151], v10, s[8:11], s81 offen offset:1024 sc1
  buffer_load_dwordx4 v[152:155], v10, s[8:11], s81 offen offset:2048 sc1
  s_add_u32 s54, s54, 1
  s_cmp_gt_u32 s54, 131072
  s_cbranch_scc1 end0
  s_waitcnt vmcnt(0)
  v_max3_u32 v27, v144, v146, v148
  v_max3_u32 v27, v27, v150, v152
  v_max3_u32 v27, v27, v154, v154
  v_cmp_eq_u32 vcc, -1, v27
  s_nop 1
  s_cbranch_vccnz pv_45
  s_branch pvj_48
psr_46:
  buffer_load_dwordx2 v[248:249], v9, s[8:11], s81 offen sc1
  buffer_load_dwordx4 v[112:115], v8, s[8:11], s81 offen offset:0 sc1
  buffer_load_dwordx4 v[116:119], v8, s[8:11], s81 offen offset:1024 sc1
  s_add_u32 s54, s54, 1
  s_cmp_gt_u32 s54, 131072
  s_cbranch_scc1 end0
  s_waitcnt vmcnt(2)
  v_xor_b32 v96, s88, v248
  s_nop 0
  v_permlane16_swap_b32 v248, v249
  v_fma_mix_f32 v250, v248, 1.0, v249 op_sel:[0,0,0] op_sel_hi:[1,0,1]
  v_fma_mix_f32 v251, v248, 1.0, v249 op_sel:[1,0,1] op_sel_hi:[1,0,1]
  v_mov_b32 v248, v250
  v_mov_b32 v249, v251
  s_nop 0
  v_permlane32_swap_b32 v248, v250
  v_permlane32_swap_b32 v249, v251
  s_waitcnt vmcnt(0)
  v_bitop3_b32 v97, v112, v114, s88 bitop3:0x7e
  v_bitop3_b32 v98, v116, v118, s88 bitop3:0x7e
  v_fma_mix_f32 v120, v112, 1.0, v116 op_sel:[0,0,0] op_sel_hi:[1,0,1]
  v_or3_b32 v27, v96, v97, v98
  v_fma_mix_f32 v124, v114, 1.0, v118 op_sel:[0,0,0] op_sel_hi:[1,0,1]
  v_and_b32 v27, 1, v27
  v_fma_mix_f32 v121, v112, 1.0, v116 op_sel:[1,0,1] op_sel_hi:[1,0,1]
  v_cmp_ne_u32 vcc, 0, v27
  v_fma_mix_f32 v125, v114, 1.0, v118 op_sel:[1,0,1] op_sel_hi:[1,0,1]
  v_fma_mix_f32 v122, v113, 1.0, v117 op_sel:[0,0,0] op_sel_hi:[1,0,1]
  v_fma_mix_f32 v126, v115, 1.0, v119 op_sel:[0,0,0] op_sel_hi:[1,0,1]
  s_cbranch_vccnz psr_46
  s_branch psj_47
kvw_49:
  v_mov_b32 v236, 0
  s_mov_b32 s101, 0
wf_53:
  buffer_load_dword v237, v236, s[12:15], s79 offen sc1
  s_add_u32 s101, s101, 1
  s_cmp_gt_u32 s101, 131072
  s_cbranch_scc1 end0
  s_waitcnt vmcnt(0)
  v_readfirstlane_b32 s100, v237
  s_cmp_ge_u32 s100, s46
  s_cbranch_scc1 wf_54
  s_sleep 1
  s_branch wf_53
wf_54:
  s_branch kvok_50
fl_51:
  buffer_load_dword v94, v95, s[12:15], s79 offen sc1
  s_branch fl_52
last_41:
  v_mov_b32 v246, 80
  v_mov_b32 v247, 1
  s_mov_b64 exec, 1
  buffer_atomic_add v247, v246, s[32:35], 0 offen sc0 sc1
  s_mov_b64 exec, -1
clm_55:
  s_branch chain_done
step_56:
  s_add_u32 s21, s52, 2
  s_and_b32 s21, s21, 3
  s_mul_i32 s82, s21, 540672
  s_add_u32 s21, s52, 3
  s_and_b32 s21, s21, 3
  s_lshl_b32 s83, s21, 15
  s_add_u32 s21, s52, 1
  s_and_b32 s22, s21, 3
  s_lshl_b32 s3, s22, 15
  s_mul_i32 s80, s21, 393216
  s_add_u32 s46, s21, 1
  s_min_u32 s46, s46, 64
  s_mul_i32 s85, s52, 98304
  s_add_u32 s57, s85, 6291456
  s_bfe_u32 s88, s52, 0x10002
  s_add_u32 s78, s81, 278528
  v_mov_b32 v52, 0
  v_mov_b32 v53, 0
  v_mov_b32 v54, 0
  v_mov_b32 v55, 0
  v_mov_b32 v56, 0
  v_mov_b32 v57, 0
  v_mov_b32 v58, 0
  v_mov_b32 v59, 0
  v_mov_b32 v60, 0
  v_mov_b32 v61, 0
  v_mov_b32 v62, 0
  v_mov_b32 v63, 0
  v_mov_b32 v64, 0
  v_mov_b32 v65, 0
  v_mov_b32 v66, 0
  v_mov_b32 v67, 0
  v_mov_b32 v68, 0
  v_mov_b32 v69, 0
  v_mov_b32 v70, 0
  v_mov_b32 v71, 0
  v_mov_b32 v72, 0
  v_mov_b32 v73, 0
  v_mov_b32 v74, 0
  v_mov_b32 v75, 0
  v_mov_b32 v76, 0
  v_mov_b32 v77, 0
  v_mov_b32 v78, 0
  v_mov_b32 v79, 0
  v_mov_b32 v80, 0
  v_mov_b32 v81, 0
  v_mov_b32 v82, 0
  v_mov_b32 v83, 0
  v_mov_b32 v84, 0
  v_mov_b32 v85, 0
  v_mov_b32 v86, 0
  v_mov_b32 v87, 0
  s_sleep 6
  s_mov_b32 s54, 0
  buffer_load_dwordx4 v[96:99], v4, s[4:7], s84 offen offset:0 sc1
  buffer_load_dwordx4 v[100:103], v4, s[4:7], s84 offen offset:1024 sc1
  buffer_load_dwordx4 v[104:107], v4, s[4:7], s84 offen offset:2048 sc1
  s_waitcnt vmcnt(3)
  v_mov_b32 v176, v160
  v_mov_b32 v177, v161
  v_mov_b32 v178, v162
  v_mov_b32 v179, v163
  v_mov_b32 v180, v164
  v_mov_b32 v181, v165
  v_mov_b32 v182, v166
  v_mov_b32 v183, v167
  v_mov_b32 v184, v48
  v_mov_b32 v185, v49
  v_mov_b32 v186, v50
  v_mov_b32 v187, v51
  s_waitcnt vmcnt(0)
  v_bitop3_b32 v27, v99, v103, v107 bitop3:0x80
  v_cvt_f32_f16 v108, v99
  v_and_b32 v27, 0x48000000, v27
  v_cvt_f32_f16 v109, v103
  v_cmp_ne_u32 vcc, 0x48000000, v27
  v_cvt_f32_f16 v110, v106
  v_cvt_f32_f16_sdwa v111, v106 dst_sel:DWORD dst_unused:UNUSED_PAD src0_sel:WORD_1
  v_cvt_pk_bf16_f32 v40, v110, v111
  s_cbranch_vccnz pm_58
pm_59:
  v_cvt_pk_bf16_f32 v41, v108, v109
  v_cvt_f32_f16 v110, v96
  v_cvt_f32_f16_sdwa v111, v96 dst_sel:DWORD dst_unused:UNUSED_PAD src0_sel:WORD_1
  v_smfmac_f32_16x16x32_bf16 v[52:55], v[40:41], a[16:19], v44
  v_cvt_f32_f16 v112, v97
  v_cvt_f32_f16_sdwa v113, v97 dst_sel:DWORD dst_unused:UNUSED_PAD src0_sel:WORD_1
  v_cvt_pk_bf16_f32 v32, v110, v111
  v_smfmac_f32_16x16x32_bf16 v[64:67], v[40:41], a[76:79], v44
  v_cvt_pk_bf16_f32 v33, v112, v113
  v_cvt_f32_f16 v114, v98
  v_cvt_f32_f16_sdwa v115, v98 dst_sel:DWORD dst_unused:UNUSED_PAD src0_sel:WORD_1
  v_smfmac_f32_16x16x32_bf16 v[56:59], v[40:41], a[36:39], v44
  v_cvt_f32_f16 v116, v100
  v_cvt_f32_f16_sdwa v117, v100 dst_sel:DWORD dst_unused:UNUSED_PAD src0_sel:WORD_1
  v_cvt_pk_bf16_f32 v34, v114, v115
  v_smfmac_f32_16x16x32_bf16 v[68:71], v[40:41], a[96:99], v44
  v_cvt_pk_bf16_f32 v35, v116, v117
  v_cvt_f32_f16 v110, v101
  v_cvt_f32_f16_sdwa v111, v101 dst_sel:DWORD dst_unused:UNUSED_PAD src0_sel:WORD_1
  v_smfmac_f32_16x16x32_bf16 v[60:63], v[40:41], a[56:59], v44
  v_cvt_f32_f16 v112, v102
  v_cvt_f32_f16_sdwa v113, v102 dst_sel:DWORD dst_unused:UNUSED_PAD src0_sel:WORD_1
  v_smfmac_f32_16x16x32_bf16 v[72:75], v[40:41], a[116:119], v44
  v_cvt_pk_bf16_f32 v36, v110, v111
  v_cvt_pk_bf16_f32 v37, v112, v113
  v_smfmac_f32_16x16x32_bf16 v[76:79], v[40:41], a[136:139], v44
  v_cvt_f32_f16 v114, v104
  v_cvt_f32_f16_sdwa v115, v104 dst_sel:DWORD dst_unused:UNUSED_PAD src0_sel:WORD_1
  v_smfmac_f32_16x16x32_bf16 v[80:83], v[40:41], a[156:159], v44
  v_cvt_f32_f16 v116, v105
  v_cvt_f32_f16_sdwa v117, v105 dst_sel:DWORD dst_unused:UNUSED_PAD src0_sel:WORD_1
  v_smfmac_f32_16x16x32_bf16 v[84:87], v[40:41], a[176:179], v44
  v_cvt_pk_bf16_f32 v38, v114, v115
  v_cvt_pk_bf16_f32 v39, v116, v117
A2_60:
  v_smfmac_f32_16x16x64_bf16 v[52:55], v[32:35], a[0:7], v44
  v_smfmac_f32_16x16x64_bf16 v[52:55], v[36:39], a[8:15], v44
  v_smfmac_f32_16x16x64_bf16 v[64:67], v[32:35], a[60:67], v44
  v_smfmac_f32_16x16x64_bf16 v[64:67], v[36:39], a[68:75], v44
  v_smfmac_f32_16x16x64_bf16 v[56:59], v[32:35], a[20:27], v44
  v_smfmac_f32_16x16x64_bf16 v[56:59], v[36:39], a[28:35], v44
  v_smfmac_f32_16x16x64_bf16 v[68:71], v[32:35], a[80:87], v44
  v_permlane32_swap_b32 v52, v64
  v_permlane32_swap_b32 v53, v65
  v_permlane32_swap_b32 v54, v66
  v_smfmac_f32_16x16x64_bf16 v[68:71], v[36:39], a[88:95], v44
  v_permlane32_swap_b32 v55, v67
  v_pk_add_f32 v[52:53], v[52:53], v[64:65]
  v_pk_add_f32 v[54:55], v[54:55], v[66:67]
  v_smfmac_f32_16x16x64_bf16 v[60:63], v[32:35], a[40:47], v44
  ds_write2_b32 v5, v52, v53 offset0:0 offset1:4
  ds_write2_b32 v5, v54, v55 offset0:8 offset1:12
  v_smfmac_f32_16x16x64_bf16 v[60:63], v[36:39], a[48:55], v44
  v_smfmac_f32_16x16x64_bf16 v[72:75], v[32:35], a[100:107], v44
  v_permlane32_swap_b32 v56, v68
  v_permlane32_swap_b32 v57, v69
  v_permlane32_swap_b32 v58, v70
  v_smfmac_f32_16x16x64_bf16 v[72:75], v[36:39], a[108:115], v44
  v_permlane32_swap_b32 v59, v71
  v_pk_add_f32 v[56:57], v[56:57], v[68:69]
  v_pk_add_f32 v[58:59], v[58:59], v[70:71]
  v_smfmac_f32_16x16x64_bf16 v[76:79], v[32:35], a[120:127], v44
  ds_write2_b32 v242, v56, v57 offset0:0 offset1:4
  ds_write2_b32 v242, v58, v59 offset0:8 offset1:12
  v_smfmac_f32_16x16x64_bf16 v[76:79], v[36:39], a[128:135], v44
  v_smfmac_f32_16x16x64_bf16 v[80:83], v[32:35], a[140:147], v44
  v_permlane32_swap_b32 v60, v72
  v_permlane32_swap_b32 v61, v73
  v_permlane32_swap_b32 v62, v74
  v_smfmac_f32_16x16x64_bf16 v[80:83], v[36:39], a[148:155], v44
  v_permlane32_swap_b32 v63, v75
  v_pk_add_f32 v[60:61], v[60:61], v[72:73]
  v_pk_add_f32 v[62:63], v[62:63], v[74:75]
  v_smfmac_f32_16x16x64_bf16 v[84:87], v[32:35], a[160:167], v44
  ds_write2_b32 v243, v60, v61 offset0:0 offset1:4
  ds_write2_b32 v243, v62, v63 offset0:8 offset1:12
  v_smfmac_f32_16x16x64_bf16 v[84:87], v[36:39], a[168:175], v44
  v_permlane32_swap_b32 v76, v80
  v_permlane32_swap_b32 v77, v81
  v_permlane32_swap_b32 v78, v82
  v_permlane32_swap_b32 v79, v83
  v_pk_add_f32 v[76:77], v[76:77], v[80:81]
  v_pk_add_f32 v[78:79], v[78:79], v[82:83]
  ds_write2_b32 v244, v76, v77 offset0:0 offset1:4
  ds_write2_b32 v244, v78, v79 offset0:8 offset1:12
  ds_write2_b32 v245, v84, v85 offset0:0 offset1:4
  ds_write2_b32 v245, v86, v87 offset0:8 offset1:12
  s_waitcnt lgkmcnt(0) vmcnt(0)
  s_barrier
  ds_read_b128 v[96:99], v45 offset:0
  ds_read_b128 v[108:111], v45 offset:5440
  ds_read_b128 v[100:103], v45 offset:1088
  ds_read_b128 v[112:115], v45 offset:6528
  ds_read_b128 v[104:107], v45 offset:2176
  ds_read_b128 v[116:119], v45 offset:7616
  s_waitcnt lgkmcnt(4)
  v_pk_add_f32 v[96:97], v[96:97], v[108:109]
  v_pk_add_f32 v[98:99], v[98:99], v[110:111]
  s_nop 0
  v_add_f32_dpp v108, v96, v96 row_ror:8 row_mask:0xf bank_mask:0xf
  v_add_f32_dpp v109, v97, v97 row_ror:8 row_mask:0xf bank_mask:0xf
  v_add_f32_dpp v110, v98, v98 row_ror:8 row_mask:0xf bank_mask:0xf
  v_add_f32_dpp v111, v99, v99 row_ror:8 row_mask:0xf bank_mask:0xf
  v_cvt_pk_bf16_f32 v212, v108, v109
  v_cvt_pk_bf16_f32 v213, v110, v111
  s_waitcnt lgkmcnt(2)
  v_pk_add_f32 v[100:101], v[100:101], v[112:113]
  v_pk_add_f32 v[102:103], v[102:103], v[114:115]
  s_nop 0
  v_add_f32_dpp v112, v100, v100 row_ror:8 row_mask:0xf bank_mask:0xf
  v_add_f32_dpp v113, v101, v101 row_ror:8 row_mask:0xf bank_mask:0xf
  v_add_f32_dpp v114, v102, v102 row_ror:8 row_mask:0xf bank_mask:0xf
  v_add_f32_dpp v115, v103, v103 row_ror:8 row_mask:0xf bank_mask:0xf
  v_cvt_pk_bf16_f32 v214, v112, v113
  v_cvt_pk_bf16_f32 v215, v114, v115
  s_waitcnt lgkmcnt(0)
  v_pk_add_f32 v[104:105], v[104:105], v[116:117]
  v_pk_add_f32 v[106:107], v[106:107], v[118:119]
  v_mfma_f32_16x16x32_bf16 v[96:99], v[168:171], v[212:215], 0
  v_add_f32_dpp v116, v104, v104 row_ror:8 row_mask:0xf bank_mask:0xf
  v_add_f32_dpp v117, v105, v105 row_ror:8 row_mask:0xf bank_mask:0xf
  v_add_f32_dpp v118, v106, v106 row_ror:8 row_mask:0xf bank_mask:0xf
  v_add_f32_dpp v119, v107, v107 row_ror:8 row_mask:0xf bank_mask:0xf
  v_cvt_pk_bf16_f32 v216, v116, v117
  v_cvt_pk_bf16_f32 v217, v118, v119
  s_nop 1
  v_mfma_f32_16x16x32_bf16 v[96:99], v[172:175], v[216:219], v[96:99]
  s_mov_b64 exec, s[74:75]
  s_nop 6
  v_cvt_pk_f16_f32 v100, v96, v97
  v_cvt_pk_f16_f32 v101, v98, v99
  v_and_or_b32 v100, v100, -2, s88
  buffer_store_dwordx2 v[100:101], v7, s[8:11], s81 offen
  s_mov_b64 exec, -1
  s_cmp_eq_u32 s52, 63
  s_cbranch_scc1 last_57
  s_sleep 5
  s_mov_b32 s54, 0
  buffer_load_dwordx2 v[248:249], v9, s[8:11], s81 offen sc1
  buffer_load_dwordx4 v[112:115], v8, s[8:11], s81 offen offset:0 sc1
  buffer_load_dwordx4 v[116:119], v8, s[8:11], s81 offen offset:1024 sc1
  s_sleep 2
  buffer_load_dwordx4 v[144:147], v10, s[8:11], s81 offen offset:0 sc1
  buffer_load_dwordx4 v[148:151], v10, s[8:11], s81 offen offset:1024 sc1
  buffer_load_dwordx4 v[152:155], v10, s[8:11], s81 offen offset:2048 sc1
  v_mov_b32 v188, 0
  v_mov_b32 v189, 0
  v_mov_b32 v190, 0
  v_mov_b32 v191, 0
  v_mov_b32 v192, 0
  v_mov_b32 v193, 0
  v_mov_b32 v194, 0
  v_mov_b32 v195, 0
  v_mov_b32 v196, 0
  v_mov_b32 v197, 0
  v_mov_b32 v198, 0
  v_mov_b32 v199, 0
  v_readfirstlane_b32 s21, v94
  s_add_u32 s22, s46, 8
  s_min_u32 s22, s22, 64
  s_sub_u32 s55, s21, s22
  s_sub_u32 s56, s21, s46
  s_waitcnt vmcnt(5)
  v_xor_b32 v96, s88, v248
  s_nop 0
  v_permlane16_swap_b32 v248, v249
  v_fma_mix_f32 v250, v248, 1.0, v249 op_sel:[0,0,0] op_sel_hi:[1,0,1]
  v_fma_mix_f32 v251, v248, 1.0, v249 op_sel:[1,0,1] op_sel_hi:[1,0,1]
  v_mov_b32 v248, v250
  v_mov_b32 v249, v251
  s_nop 0
  v_permlane32_swap_b32 v248, v250
  v_permlane32_swap_b32 v249, v251
  s_waitcnt vmcnt(3)
  v_bitop3_b32 v97, v112, v114, s88 bitop3:0x7e
  v_bitop3_b32 v98, v116, v118, s88 bitop3:0x7e
  v_fma_mix_f32 v120, v112, 1.0, v116 op_sel:[0,0,0] op_sel_hi:[1,0,1]
  v_or3_b32 v27, v96, v97, v98
  v_fma_mix_f32 v124, v114, 1.0, v118 op_sel:[0,0,0] op_sel_hi:[1,0,1]
  v_and_b32 v27, 1, v27
  v_fma_mix_f32 v121, v112, 1.0, v116 op_sel:[1,0,1] op_sel_hi:[1,0,1]
  v_cmp_ne_u32 vcc, 0, v27
  v_fma_mix_f32 v125, v114, 1.0, v118 op_sel:[1,0,1] op_sel_hi:[1,0,1]
  v_fma_mix_f32 v122, v113, 1.0, v117 op_sel:[0,0,0] op_sel_hi:[1,0,1]
  v_fma_mix_f32 v126, v115, 1.0, v119 op_sel:[0,0,0] op_sel_hi:[1,0,1]
  s_cbranch_vccnz psr_62
psj_63:
  s_cmp_lt_i32 s56, 0
  s_cbranch_scc1 kvw_65
kvok_66:
  v_fma_mix_f32 v123, v113, 1.0, v117 op_sel:[1,0,1] op_sel_hi:[1,0,1]
  v_fma_mix_f32 v127, v115, 1.0, v119 op_sel:[1,0,1] op_sel_hi:[1,0,1]
  v_permlane32_swap_b32 v120, v124
  v_permlane32_swap_b32 v121, v125
  v_permlane32_swap_b32 v122, v126
  v_permlane32_swap_b32 v123, v127
  v_pk_add_f32 v[120:121], v[120:121], v[124:125]
  v_pk_add_f32 v[122:123], v[122:123], v[126:127]
  v_pk_add_f32 v[124:125], v[248:249], v[250:251]
  v_max3_f32 v236, v120, v121, v122
  v_max3_f32 v237, v123, v124, v125
  v_max_f32 v236, v236, v237
  s_nop 1
  v_max_f32_dpp v236, v236, v236 row_ror:8 row_mask:0xf bank_mask:0xf
  v_mov_b32 v237, v236
  s_nop 1
  v_permlane32_swap_b32 v236, v237
  v_max_f32 v236, v236, v237
  v_mov_b32 v237, v236
  s_nop 1
  v_permlane16_swap_b32 v236, v237
  v_max_f32 v236, v236, v237
  s_waitcnt vmcnt(0)
  v_max3_u32 v27, v144, v146, v148
  v_max3_u32 v27, v27, v150, v152
  v_max3_u32 v27, v27, v154, v154
  v_cmp_eq_u32 vcc, -1, v27
  s_nop 1
  s_cbranch_vccnz pv_61
pvj_64:
  v_mul_f32 v236, s86, v236
  v_smfmac_f32_16x16x64_bf16 v[188:191], v[144:147], a[180:187], v44
  v_fma_f32 v120, v120, s86, -v236
  v_smfmac_f32_16x16x64_bf16 v[188:191], v[148:151], a[188:195], v44
  v_fma_f32 v121, v121, s86, -v236
  v_smfmac_f32_16x16x64_bf16 v[188:191], v[152:155], a[196:203], v44
  buffer_load_dwordx4 v[160:163], v16, s[28:31], s64 offen offset:0 sc1
  v_fma_f32 v122, v122, s86, -v236
  v_smfmac_f32_16x16x64_bf16 v[192:195], v[144:147], a[204:211], v44
  v_fma_f32 v123, v123, s86, -v236
  v_smfmac_f32_16x16x64_bf16 v[192:195], v[148:151], a[212:219], v44
  buffer_load_dwordx4 v[164:167], v16, s[28:31], s65 offen offset:1024 sc1
  v_fma_f32 v124, v124, s86, -v236
  v_smfmac_f32_16x16x64_bf16 v[192:195], v[152:155], a[220:227], v44
  v_fma_f32 v125, v125, s86, -v236
  v_smfmac_f32_16x16x64_bf16 v[196:199], v[144:147], a[228:235], v44
  buffer_load_dwordx4 v[48:51], v16, s[28:31], s66 offen offset:2048 sc1
  v_exp_f32 v120, v120
  v_smfmac_f32_16x16x64_bf16 v[196:199], v[148:151], a[236:243], v44
  v_exp_f32 v121, v121
  v_smfmac_f32_16x16x64_bf16 v[196:199], v[152:155], a[244:251], v44
  buffer_load_dwordx2 v[168:169], v18, s[16:19], s80 offen sc1
  v_exp_f32 v122, v122
  buffer_load_dwordx2 v[170:171], v19, s[16:19], s80 offen sc1
  v_exp_f32 v123, v123
  buffer_load_dwordx2 v[172:173], v20, s[16:19], s80 offen sc1
  v_exp_f32 v124, v124
  s_cmp_lt_i32 s55, 0
  s_cbranch_scc1 fl_67
fl_68:
  v_exp_f32 v125, v125
  s_mov_b64 exec, s[60:61]
  v_cvt_pk_bf16_f32 v220, v120, v121
  v_cvt_pk_bf16_f32 v221, v122, v123
  v_cvt_pk_bf16_f32 v224, v124, v125
  s_mov_b64 exec, s[62:63]
  v_cvt_pk_bf16_f32 v222, v120, v121
  v_cvt_pk_bf16_f32 v223, v122, v123
  v_cvt_pk_bf16_f32 v225, v124, v125
  s_mov_b64 exec, -1
  v_pk_add_f32 v[126:127], v[120:121], v[122:123]
  v_add_f32 v128, v124, v125
  v_mfma_f32_16x16x32_bf16 v[200:203], v[176:179], v[220:223], 0
  v_add_f32 v236, v126, v127
  v_fmac_f32 v236, v128, v89
  v_cvt_pk_bf16_f32 v228, v188, v189
  v_cvt_pk_bf16_f32 v229, v190, v191
  v_mfma_f32_16x16x32_bf16 v[204:207], v[180:183], v[220:223], 0
  v_cvt_pk_bf16_f32 v230, v192, v193
  v_cvt_pk_bf16_f32 v231, v194, v195
  v_mfma_f32_16x16x32_bf16 v[208:211], v[184:187], v[220:223], 0
  v_cvt_pk_bf16_f32 v232, v196, v197
  v_cvt_pk_bf16_f32 v233, v198, v199
  v_add_f32_dpp v236, v236, v236 row_ror:8 row_mask:0xf bank_mask:0xf
  v_mov_b32 v237, v236
  s_nop 0
  v_mfma_f32_16x16x32_bf16 v[200:203], v[228:231], v[224:227], v[200:203]
  v_mfma_f32_16x16x32_bf16 v[204:207], v[230:233], v[224:227], v[204:207]
  v_permlane32_swap_b32 v236, v237
  v_add_f32 v236, v236, v237
  v_mov_b32 v237, v236
  v_mfma_f32_16x16x32_bf16 v[208:211], v[232:235], v[224:227], v[208:211]
  s_nop 0
  v_permlane16_swap_b32 v236, v237
  v_add_f32 v236, v236, v237
  v_rcp_f32 v236, v236
  s_nop 2
  v_pk_mul_f32 v[200:201], v[200:201], v[236:237] op_sel_hi:[1,0]
  v_pk_mul_f32 v[202:203], v[202:203], v[236:237] op_sel_hi:[1,0]
  ds_write_b128 v11, v[200:203] offset:0
  v_pk_mul_f32 v[204:205], v[204:205], v[236:237] op_sel_hi:[1,0]
  v_pk_mul_f32 v[206:207], v[206:207], v[236:237] op_sel_hi:[1,0]
  ds_write_b128 v11, v[204:207] offset:1024
  v_pk_mul_f32 v[208:209], v[208:209], v[236:237] op_sel_hi:[1,0]
  v_pk_mul_f32 v[210:211], v[210:211], v[236:237] op_sel_hi:[1,0]
  ds_write_b128 v11, v[208:211] offset:2048
  s_waitcnt lgkmcnt(0)
  s_barrier
  ds_read_b64 v[96:97], v12 offset:0
  ds_read_b64 v[98:99], v12 offset:128
  ds_read_b64 v[100:101], v12 offset:3072
  ds_read_b64 v[102:103], v12 offset:3200
  ds_read_b64 v[104:105], v12 offset:6144
  ds_read_b64 v[106:107], v12 offset:6272
  ds_read_b64 v[108:109], v12 offset:9216
  ds_read_b64 v[110:111], v12 offset:9344
  s_waitcnt lgkmcnt(6)
  v_pk_add_f32 v[96:97], v[96:97], v[98:99]
  s_waitcnt lgkmcnt(4)
  v_pk_add_f32 v[100:101], v[100:101], v[102:103]
  s_waitcnt lgkmcnt(2)
  v_pk_add_f32 v[104:105], v[104:105], v[106:107]
  v_pk_add_f32 v[96:97], v[96:97], v[100:101]
  s_waitcnt lgkmcnt(0)
  v_pk_add_f32 v[108:109], v[108:109], v[110:111]
  v_pk_add_f32 v[96:97], v[96:97], v[104:105]
  v_pk_add_f32 v[96:97], v[96:97], v[108:109]
  v_cvt_pk_f16_f32 v100, v96, v97
  v_perm_b32 v100, s91, v100, v14
  buffer_atomic_pk_add_f16 v100, v13, s[4:7], s3 offen
  s_add_u32 s23, s52, 2
  s_min_u32 s23, s23, 63
  s_sub_u32 s21, s23, 64
  s_mul_i32 s21, s21, 160
  s_add_u32 s21, s21, s89
  s_lshl_b32 s21, s21, 14
  s_add_u32 s64, s21, s67
  s_lshr_b32 s22, s64, 8
  s_xor_b32 s64, s64, s22
  s_xor_b32 s64, s64, s68
  s_and_b32 s64, s64, 8192
  s_add_u32 s64, s64, s21
  s_add_u32 s64, s64, 83886080
  s_mul_i32 s21, s23, 160
  s_add_u32 s21, s21, s89
  s_lshl_b32 s21, s21, 13
  s_cmp_lt_u32 s23, 64
  s_cselect_b32 s64, s21, s64
  s_add_u32 s69, s89, 1
  s_sub_u32 s21, s23, 64
  s_mul_i32 s21, s21, 160
  s_add_u32 s21, s21, s69
  s_lshl_b32 s21, s21, 14
  s_add_u32 s66, s21, s67
  s_lshr_b32 s22, s66, 8
  s_xor_b32 s66, s66, s22
  s_xor_b32 s66, s66, s68
  s_and_b32 s66, s66, 8192
  s_add_u32 s66, s66, s21
  s_add_u32 s66, s66, 83886080
  s_mul_i32 s21, s23, 160
  s_add_u32 s21, s21, s69
  s_lshl_b32 s21, s21, 13
  s_cmp_lt_u32 s23, 64
  s_cselect_b32 s66, s21, s66
  s_lshl_b32 s21, s87, 10
  s_add_u32 s64, s64, s21
  s_add_u32 s66, s66, s21
  s_sub_u32 s66, s66, 8192
  s_cmp_lt_u32 s87, 7
  s_cselect_b32 s65, s64, s66
  s_cmp_lt_u32 s87, 6
  s_cselect_b32 s66, s64, s66
  s_add_u32 s52, s52, 1
  s_and_b32 s21, s52, 3
  s_mul_i32 s81, s21, 540672
  s_lshl_b32 s84, s21, 15
  s_branch step_56
pm_58:
  s_mov_b32 s47, 1
  buffer_load_dwordx4 v[96:99], v4, s[4:7], s84 offen offset:0 sc1
  buffer_load_dwordx4 v[100:103], v4, s[4:7], s84 offen offset:1024 sc1
  buffer_load_dwordx4 v[104:107], v4, s[4:7], s84 offen offset:2048 sc1
  s_add_u32 s54, s54, 1
  s_cmp_gt_u32 s54, 131072
  s_cbranch_scc1 end0
  s_waitcnt vmcnt(0)
  v_bitop3_b32 v27, v99, v103, v107 bitop3:0x80
  v_cvt_f32_f16 v108, v99
  v_and_b32 v27, 0x48000000, v27
  v_cvt_f32_f16 v109, v103
  v_cmp_ne_u32 vcc, 0x48000000, v27
  v_cvt_f32_f16 v110, v106
  v_cvt_f32_f16_sdwa v111, v106 dst_sel:DWORD dst_unused:UNUSED_PAD src0_sel:WORD_1
  v_cvt_pk_bf16_f32 v40, v110, v111
  s_cbranch_vccnz pm_58
  s_branch pm_59
A1_36:
  v_smfmac_f32_16x16x32_bf16 v[52:55], v[40:41], a[16:19], v44
  v_smfmac_f32_16x16x32_bf16 v[64:67], v[40:41], a[76:79], v44
  v_smfmac_f32_16x16x32_bf16 v[56:59], v[40:41], a[36:39], v44
  v_smfmac_f32_16x16x32_bf16 v[68:71], v[40:41], a[96:99], v44
  v_smfmac_f32_16x16x32_bf16 v[60:63], v[40:41], a[56:59], v44
  v_smfmac_f32_16x16x32_bf16 v[72:75], v[40:41], a[116:119], v44
  v_smfmac_f32_16x16x32_bf16 v[76:79], v[40:41], a[136:139], v44
  v_smfmac_f32_16x16x32_bf16 v[80:83], v[40:41], a[156:159], v44
  v_smfmac_f32_16x16x32_bf16 v[84:87], v[40:41], a[176:179], v44
  s_branch A2_60
pv_61:
  buffer_load_dwordx4 v[144:147], v10, s[8:11], s81 offen offset:0 sc1
  buffer_load_dwordx4 v[148:151], v10, s[8:11], s81 offen offset:1024 sc1
  buffer_load_dwordx4 v[152:155], v10, s[8:11], s81 offen offset:2048 sc1
  s_add_u32 s54, s54, 1
  s_cmp_gt_u32 s54, 131072
  s_cbranch_scc1 end0
  s_waitcnt vmcnt(0)
  v_max3_u32 v27, v144, v146, v148
  v_max3_u32 v27, v27, v150, v152
  v_max3_u32 v27, v27, v154, v154
  v_cmp_eq_u32 vcc, -1, v27
  s_nop 1
  s_cbranch_vccnz pv_61
  s_branch pvj_64
psr_62:
  buffer_load_dwordx2 v[248:249], v9, s[8:11], s81 offen sc1
  buffer_load_dwordx4 v[112:115], v8, s[8:11], s81 offen offset:0 sc1
  buffer_load_dwordx4 v[116:119], v8, s[8:11], s81 offen offset:1024 sc1
  s_add_u32 s54, s54, 1
  s_cmp_gt_u32 s54, 131072
  s_cbranch_scc1 end0
  s_waitcnt vmcnt(2)
  v_xor_b32 v96, s88, v248
  s_nop 0
  v_permlane16_swap_b32 v248, v249
  v_fma_mix_f32 v250, v248, 1.0, v249 op_sel:[0,0,0] op_sel_hi:[1,0,1]
  v_fma_mix_f32 v251, v248, 1.0, v249 op_sel:[1,0,1] op_sel_hi:[1,0,1]
  v_mov_b32 v248, v250
  v_mov_b32 v249, v251
  s_nop 0
  v_permlane32_swap_b32 v248, v250
  v_permlane32_swap_b32 v249, v251
  s_waitcnt vmcnt(0)
  v_bitop3_b32 v97, v112, v114, s88 bitop3:0x7e
  v_bitop3_b32 v98, v116, v118, s88 bitop3:0x7e
  v_fma_mix_f32 v120, v112, 1.0, v116 op_sel:[0,0,0] op_sel_hi:[1,0,1]
  v_or3_b32 v27, v96, v97, v98
  v_fma_mix_f32 v124, v114, 1.0, v118 op_sel:[0,0,0] op_sel_hi:[1,0,1]
  v_and_b32 v27, 1, v27
  v_fma_mix_f32 v121, v112, 1.0, v116 op_sel:[1,0,1] op_sel_hi:[1,0,1]
  v_cmp_ne_u32 vcc, 0, v27
  v_fma_mix_f32 v125, v114, 1.0, v118 op_sel:[1,0,1] op_sel_hi:[1,0,1]
  v_fma_mix_f32 v122, v113, 1.0, v117 op_sel:[0,0,0] op_sel_hi:[1,0,1]
  v_fma_mix_f32 v126, v115, 1.0, v119 op_sel:[0,0,0] op_sel_hi:[1,0,1]
  s_cbranch_vccnz psr_62
  s_branch psj_63
kvw_65:
  v_mov_b32 v236, 0
  s_mov_b32 s101, 0
wf_69:
  buffer_load_dword v237, v236, s[12:15], s79 offen sc1
  s_add_u32 s101, s101, 1
  s_cmp_gt_u32 s101, 131072
  s_cbranch_scc1 end0
  s_waitcnt vmcnt(0)
  v_readfirstlane_b32 s100, v237
  s_cmp_ge_u32 s100, s46
  s_cbranch_scc1 wf_70
  s_sleep 1
  s_branch wf_69
wf_70:
  s_branch kvok_66
fl_67:
  buffer_load_dword v94, v95, s[12:15], s79 offen sc1
  s_branch fl_68
last_57:
  s_branch chain_done
step_71:
  s_add_u32 s21, s52, 2
  s_and_b32 s21, s21, 3
  s_mul_i32 s82, s21, 540672
  s_add_u32 s21, s52, 3
  s_and_b32 s21, s21, 3
  s_lshl_b32 s83, s21, 15
  s_add_u32 s21, s52, 1
  s_and_b32 s22, s21, 3
  s_lshl_b32 s3, s22, 15
  s_mul_i32 s80, s21, 393216
  s_add_u32 s46, s21, 1
  s_min_u32 s46, s46, 64
  s_mul_i32 s85, s52, 98304
  s_add_u32 s57, s85, 6291456
  s_bfe_u32 s88, s52, 0x10002
  s_add_u32 s78, s81, 278528
  v_mov_b32 v52, 0
  v_mov_b32 v53, 0
  v_mov_b32 v54, 0
  v_mov_b32 v55, 0
  v_mov_b32 v56, 0
  v_mov_b32 v57, 0
  v_mov_b32 v58, 0
  v_mov_b32 v59, 0
  v_mov_b32 v60, 0
  v_mov_b32 v61, 0
  v_mov_b32 v62, 0
  v_mov_b32 v63, 0
  v_mov_b32 v64, 0
  v_mov_b32 v65, 0
  v_mov_b32 v66, 0
  v_mov_b32 v67, 0
  v_mov_b32 v68, 0
  v_mov_b32 v69, 0
  v_mov_b32 v70, 0
  v_mov_b32 v71, 0
  v_mov_b32 v72, 0
  v_mov_b32 v73, 0
  v_mov_b32 v74, 0
  v_mov_b32 v75, 0
  v_mov_b32 v76, 0
  v_mov_b32 v77, 0
  v_mov_b32 v78, 0
  v_mov_b32 v79, 0
  v_mov_b32 v80, 0
  v_mov_b32 v81, 0
  v_mov_b32 v82, 0
  v_mov_b32 v83, 0
  v_mov_b32 v84, 0
  v_mov_b32 v85, 0
  v_mov_b32 v86, 0
  v_mov_b32 v87, 0
  s_sleep 6
  s_mov_b32 s54, 0
  buffer_load_dwordx4 v[96:99], v4, s[4:7], s84 offen offset:0 sc1
  buffer_load_dwordx4 v[100:103], v4, s[4:7], s84 offen offset:1024 sc1
  buffer_load_dwordx4 v[104:107], v4, s[4:7], s84 offen offset:2048 sc1
  s_waitcnt vmcnt(3)
  v_mov_b32 v176, v160
  v_mov_b32 v177, v161
  v_mov_b32 v178, v162
  v_mov_b32 v179, v163
  v_mov_b32 v180, v164
  v_mov_b32 v181, v165
  v_mov_b32 v182, v166
  v_mov_b32 v183, v167
  v_mov_b32 v184, v48
  v_mov_b32 v185, v49
  v_mov_b32 v186, v50
  v_mov_b32 v187, v51
  s_waitcnt vmcnt(0)
  v_bitop3_b32 v27, v99, v103, v107 bitop3:0x80
  v_cvt_f32_f16 v108, v99
  v_and_b32 v27, 0x48000000, v27
  v_cvt_f32_f16 v109, v103
  v_cmp_ne_u32 vcc, 0x48000000, v27
  v_cvt_f32_f16 v110, v106
  v_cvt_f32_f16_sdwa v111, v106 dst_sel:DWORD dst_unused:UNUSED_PAD src0_sel:WORD_1
  v_cvt_pk_bf16_f32 v40, v110, v111
  s_cbranch_vccnz pm_73
pm_74:
  v_cvt_pk_bf16_f32 v41, v108, v109
  v_cvt_f32_f16 v110, v96
  v_cvt_f32_f16_sdwa v111, v96 dst_sel:DWORD dst_unused:UNUSED_PAD src0_sel:WORD_1
  v_smfmac_f32_16x16x32_bf16 v[52:55], v[40:41], a[16:19], v44
  v_cvt_f32_f16 v112, v97
  v_cvt_f32_f16_sdwa v113, v97 dst_sel:DWORD dst_unused:UNUSED_PAD src0_sel:WORD_1
  v_cvt_pk_bf16_f32 v32, v110, v111
  v_smfmac_f32_16x16x32_bf16 v[64:67], v[40:41], a[76:79], v44
  v_cvt_pk_bf16_f32 v33, v112, v113
  v_cvt_f32_f16 v114, v98
  v_cvt_f32_f16_sdwa v115, v98 dst_sel:DWORD dst_unused:UNUSED_PAD src0_sel:WORD_1
  v_smfmac_f32_16x16x32_bf16 v[56:59], v[40:41], a[36:39], v44
  v_cvt_f32_f16 v116, v100
  v_cvt_f32_f16_sdwa v117, v100 dst_sel:DWORD dst_unused:UNUSED_PAD src0_sel:WORD_1
  v_cvt_pk_bf16_f32 v34, v114, v115
  v_smfmac_f32_16x16x32_bf16 v[68:71], v[40:41], a[96:99], v44
  v_cvt_pk_bf16_f32 v35, v116, v117
  v_cvt_f32_f16 v110, v101
  v_cvt_f32_f16_sdwa v111, v101 dst_sel:DWORD dst_unused:UNUSED_PAD src0_sel:WORD_1
  v_smfmac_f32_16x16x32_bf16 v[60:63], v[40:41], a[56:59], v44
  v_cvt_f32_f16 v112, v102
  v_cvt_f32_f16_sdwa v113, v102 dst_sel:DWORD dst_unused:UNUSED_PAD src0_sel:WORD_1
  v_smfmac_f32_16x16x32_bf16 v[72:75], v[40:41], a[116:119], v44
  v_cvt_pk_bf16_f32 v36, v110, v111
  v_cvt_pk_bf16_f32 v37, v112, v113
  v_smfmac_f32_16x16x32_bf16 v[76:79], v[40:41], a[136:139], v44
  v_cvt_f32_f16 v114, v104
  v_cvt_f32_f16_sdwa v115, v104 dst_sel:DWORD dst_unused:UNUSED_PAD src0_sel:WORD_1
  v_smfmac_f32_16x16x32_bf16 v[80:83], v[40:41], a[156:159], v44
  v_cvt_f32_f16 v116, v105
  v_cvt_f32_f16_sdwa v117, v105 dst_sel:DWORD dst_unused:UNUSED_PAD src0_sel:WORD_1
  v_smfmac_f32_16x16x32_bf16 v[84:87], v[40:41], a[176:179], v44
  v_cvt_pk_bf16_f32 v38, v114, v115
  v_cvt_pk_bf16_f32 v39, v116, v117
A2_75:
  v_smfmac_f32_16x16x64_bf16 v[52:55], v[32:35], a[0:7], v44
  v_smfmac_f32_16x16x64_bf16 v[52:55], v[36:39], a[8:15], v44
  v_smfmac_f32_16x16x64_bf16 v[64:67], v[32:35], a[60:67], v44
  v_smfmac_f32_16x16x64_bf16 v[64:67], v[36:39], a[68:75], v44
  v_smfmac_f32_16x16x64_bf16 v[56:59], v[32:35], a[20:27], v44
  v_smfmac_f32_16x16x64_bf16 v[56:59], v[36:39], a[28:35], v44
  v_smfmac_f32_16x16x64_bf16 v[68:71], v[32:35], a[80:87], v44
  v_permlane32_swap_b32 v52, v64
  v_permlane32_swap_b32 v53, v65
  v_permlane32_swap_b32 v54, v66
  v_smfmac_f32_16x16x64_bf16 v[68:71], v[36:39], a[88:95], v44
  v_permlane32_swap_b32 v55, v67
  v_pk_add_f32 v[52:53], v[52:53], v[64:65]
  v_pk_add_f32 v[54:55], v[54:55], v[66:67]
  v_smfmac_f32_16x16x64_bf16 v[60:63], v[32:35], a[40:47], v44
  ds_write2_b32 v5, v52, v53 offset0:0 offset1:4
  ds_write2_b32 v5, v54, v55 offset0:8 offset1:12
  v_smfmac_f32_16x16x64_bf16 v[60:63], v[36:39], a[48:55], v44
  v_smfmac_f32_16x16x64_bf16 v[72:75], v[32:35], a[100:107], v44
  v_permlane32_swap_b32 v56, v68
  v_permlane32_swap_b32 v57, v69
  v_permlane32_swap_b32 v58, v70
  v_smfmac_f32_16x16x64_bf16 v[72:75], v[36:39], a[108:115], v44
  v_permlane32_swap_b32 v59, v71
  v_pk_add_f32 v[56:57], v[56:57], v[68:69]
  v_pk_add_f32 v[58:59], v[58:59], v[70:71]
  v_smfmac_f32_16x16x64_bf16 v[76:79], v[32:35], a[120:127], v44
  ds_write2_b32 v242, v56, v57 offset0:0 offset1:4
  ds_write2_b32 v242, v58, v59 offset0:8 offset1:12
  v_smfmac_f32_16x16x64_bf16 v[76:79], v[36:39], a[128:135], v44
  v_smfmac_f32_16x16x64_bf16 v[80:83], v[32:35], a[140:147], v44
  v_permlane32_swap_b32 v60, v72
  v_permlane32_swap_b32 v61, v73
  v_permlane32_swap_b32 v62, v74
  v_smfmac_f32_16x16x64_bf16 v[80:83], v[36:39], a[148:155], v44
  v_permlane32_swap_b32 v63, v75
  v_pk_add_f32 v[60:61], v[60:61], v[72:73]
  v_pk_add_f32 v[62:63], v[62:63], v[74:75]
  v_smfmac_f32_16x16x64_bf16 v[84:87], v[32:35], a[160:167], v44
  ds_write2_b32 v243, v60, v61 offset0:0 offset1:4
  ds_write2_b32 v243, v62, v63 offset0:8 offset1:12
  v_smfmac_f32_16x16x64_bf16 v[84:87], v[36:39], a[168:175], v44
  v_permlane32_swap_b32 v76, v80
  v_permlane32_swap_b32 v77, v81
  v_permlane32_swap_b32 v78, v82
  v_permlane32_swap_b32 v79, v83
  v_pk_add_f32 v[76:77], v[76:77], v[80:81]
  v_pk_add_f32 v[78:79], v[78:79], v[82:83]
  ds_write2_b32 v244, v76, v77 offset0:0 offset1:4
  ds_write2_b32 v244, v78, v79 offset0:8 offset1:12
  ds_write2_b32 v245, v84, v85 offset0:0 offset1:4
  ds_write2_b32 v245, v86, v87 offset0:8 offset1:12
  s_waitcnt lgkmcnt(0) vmcnt(0)
  s_barrier
  ds_read_b128 v[96:99], v6 offset:0
  ds_read_b128 v[108:111], v6 offset:5440
  ds_read_b128 v[120:123], v6 offset:10880
  ds_read_b128 v[132:135], v6 offset:16320
  ds_read_b128 v[100:103], v6 offset:1088
  ds_read_b128 v[112:115], v6 offset:6528
  ds_read_b128 v[124:127], v6 offset:11968
  ds_read_b128 v[136:139], v6 offset:17408
  ds_read_b128 v[104:107], v6 offset:2176
  ds_read_b128 v[116:119], v6 offset:7616
  ds_read_b128 v[128:131], v6 offset:13056
  ds_read_b128 v[140:143], v6 offset:18496
  s_waitcnt lgkmcnt(8)
  v_pk_add_f32 v[96:97], v[96:97], v[108:109]
  v_pk_add_f32 v[120:121], v[120:121], v[132:133]
  v_pk_add_f32 v[98:99], v[98:99], v[110:111]
  v_pk_add_f32 v[122:123], v[122:123], v[134:135]
  v_pk_add_f32 v[96:97], v[96:97], v[120:121]
  v_pk_add_f32 v[98:99], v[98:99], v[122:123]
  v_cvt_pk_bf16_f32 v212, v96, v97
  v_cvt_pk_bf16_f32 v213, v98, v99
  s_waitcnt lgkmcnt(4)
  v_pk_add_f32 v[100:101], v[100:101], v[112:113]
  v_pk_add_f32 v[124:125], v[124:125], v[136:137]
  v_pk_add_f32 v[102:103], v[102:103], v[114:115]
  v_pk_add_f32 v[126:127], v[126:127], v[138:139]
  v_pk_add_f32 v[100:101], v[100:101], v[124:125]
  v_pk_add_f32 v[102:103], v[102:103], v[126:127]
  v_cvt_pk_bf16_f32 v214, v100, v101
  v_cvt_pk_bf16_f32 v215, v102, v103
  s_waitcnt lgkmcnt(0)
  v_pk_add_f32 v[104:105], v[104:105], v[116:117]
  v_pk_add_f32 v[128:129], v[128:129], v[140:141]
  v_pk_add_f32 v[106:107], v[106:107], v[118:119]
  v_pk_add_f32 v[130:131], v[130:131], v[142:143]
  v_mfma_f32_16x16x32_bf16 v[96:99], v[212:215], v[212:215], 0
  v_pk_add_f32 v[104:105], v[104:105], v[128:129]
  v_pk_add_f32 v[106:107], v[106:107], v[130:131]
  v_cvt_pk_bf16_f32 v216, v104, v105
  v_cvt_pk_bf16_f32 v217, v106, v107
  s_nop 1
  v_mfma_f32_16x16x32_bf16 v[96:99], v[216:219], v[216:219], v[96:99]
  s_mov_b64 exec, s[74:75]
  s_nop 6
  v_cvt_pk_f16_f32 v100, v96, v97
  v_cvt_pk_f16_f32 v101, v98, v99
  v_and_or_b32 v100, v100, -2, s88
  buffer_store_dwordx2 v[100:101], v7, s[8:11], s81 offen
  s_mov_b64 exec, -1
  s_cmp_eq_u32 s52, 63
  s_cbranch_scc1 last_72
  s_sleep 4
  s_mov_b32 s54, 0
  buffer_load_dwordx2 v[248:249], v9, s[8:11], s81 offen sc1
  buffer_load_dwordx4 v[112:115], v8, s[8:11], s81 offen offset:0 sc1
  buffer_load_dwordx4 v[116:119], v8, s[8:11], s81 offen offset:1024 sc1
  s_sleep 2
  buffer_load_dwordx4 v[144:147], v10, s[8:11], s81 offen offset:0 sc1
  buffer_load_dwordx4 v[148:151], v10, s[8:11], s81 offen offset:1024 sc1
  buffer_load_dwordx4 v[152:155], v10, s[8:11], s81 offen offset:2048 sc1
  v_mov_b32 v188, 0
  v_mov_b32 v189, 0
  v_mov_b32 v190, 0
  v_mov_b32 v191, 0
  v_mov_b32 v192, 0
  v_mov_b32 v193, 0
  v_mov_b32 v194, 0
  v_mov_b32 v195, 0
  v_mov_b32 v196, 0
  v_mov_b32 v197, 0
  v_mov_b32 v198, 0
  v_mov_b32 v199, 0
  v_readfirstlane_b32 s21, v94
  s_add_u32 s22, s46, 8
  s_min_u32 s22, s22, 64
  s_sub_u32 s55, s21, s22
  s_sub_u32 s56, s21, s46
  s_waitcnt vmcnt(5)
  v_xor_b32 v96, s88, v248
  s_nop 0
  v_permlane16_swap_b32 v248, v249
  v_fma_mix_f32 v250, v248, 1.0, v249 op_sel:[0,0,0] op_sel_hi:[1,0,1]
  v_fma_mix_f32 v251, v248, 1.0, v249 op_sel:[1,0,1] op_sel_hi:[1,0,1]
  v_mov_b32 v248, v250
  v_mov_b32 v249, v251
  s_nop 0
  v_permlane32_swap_b32 v248, v250
  v_permlane32_swap_b32 v249, v251
  s_waitcnt vmcnt(3)
  v_bitop3_b32 v97, v112, v114, s88 bitop3:0x7e
  v_bitop3_b32 v98, v116, v118, s88 bitop3:0x7e
  v_fma_mix_f32 v120, v112, 1.0, v116 op_sel:[0,0,0] op_sel_hi:[1,0,1]
  v_or3_b32 v27, v96, v97, v98
  v_fma_mix_f32 v124, v114, 1.0, v118 op_sel:[0,0,0] op_sel_hi:[1,0,1]
  v_and_b32 v27, 1, v27
  v_fma_mix_f32 v121, v112, 1.0, v116 op_sel:[1,0,1] op_sel_hi:[1,0,1]
  v_cmp_ne_u32 vcc, 0, v27
  v_fma_mix_f32 v125, v114, 1.0, v118 op_sel:[1,0,1] op_sel_hi:[1,0,1]
  v_fma_mix_f32 v122, v113, 1.0, v117 op_sel:[0,0,0] op_sel_hi:[1,0,1]
  v_fma_mix_f32 v126, v115, 1.0, v119 op_sel:[0,0,0] op_sel_hi:[1,0,1]
  s_cbranch_vccnz psr_77
psj_78:
  s_cmp_lt_i32 s56, 0
  s_cbranch_scc1 kvw_80
kvok_81:
  v_fma_mix_f32 v123, v113, 1.0, v117 op_sel:[1,0,1] op_sel_hi:[1,0,1]
  v_fma_mix_f32 v127, v115, 1.0, v119 op_sel:[1,0,1] op_sel_hi:[1,0,1]
  v_permlane32_swap_b32 v120, v124
  v_permlane32_swap_b32 v121, v125
  v_permlane32_swap_b32 v122, v126
  v_permlane32_swap_b32 v123, v127
  v_pk_add_f32 v[120:121], v[120:121], v[124:125]
  v_pk_add_f32 v[122:123], v[122:123], v[126:127]
  v_pk_add_f32 v[124:125], v[248:249], v[250:251]
  v_max3_f32 v236, v120, v121, v122
  v_max3_f32 v237, v123, v124, v125
  v_max_f32 v236, v236, v237
  s_nop 1
  v_max_f32_dpp v236, v236, v236 row_ror:8 row_mask:0xf bank_mask:0xf
  v_mov_b32 v237, v236
  s_nop 1
  v_permlane32_swap_b32 v236, v237
  v_max_f32 v236, v236, v237
  v_mov_b32 v237, v236
  s_nop 1
  v_permlane16_swap_b32 v236, v237
  v_max_f32 v236, v236, v237
  s_waitcnt vmcnt(0)
  v_max3_u32 v27, v144, v146, v148
  v_max3_u32 v27, v27, v150, v152
  v_max3_u32 v27, v27, v154, v154
  v_cmp_eq_u32 vcc, -1, v27
  s_nop 1
  s_cbranch_vccnz pv_76
pvj_79:
  v_mul_f32 v236, s86, v236
  v_smfmac_f32_16x16x64_bf16 v[188:191], v[144:147], a[180:187], v44
  v_fma_f32 v120, v120, s86, -v236
  v_smfmac_f32_16x16x64_bf16 v[188:191], v[148:151], a[188:195], v44
  v_fma_f32 v121, v121, s86, -v236
  v_smfmac_f32_16x16x64_bf16 v[188:191], v[152:155], a[196:203], v44
  buffer_load_dwordx4 v[160:163], v16, s[28:31], s64 offen offset:0 sc1
  v_fma_f32 v122, v122, s86, -v236
  v_smfmac_f32_16x16x64_bf16 v[192:195], v[144:147], a[204:211], v44
  v_fma_f32 v123, v123, s86, -v236
  v_smfmac_f32_16x16x64_bf16 v[192:195], v[148:151], a[212:219], v44
  buffer_load_dwordx4 v[164:167], v16, s[28:31], s65 offen offset:1024 sc1
  v_fma_f32 v124, v124, s86, -v236
  v_smfmac_f32_16x16x64_bf16 v[192:195], v[152:155], a[220:227], v44
  v_fma_f32 v125, v125, s86, -v236
  v_smfmac_f32_16x16x64_bf16 v[196:199], v[144:147], a[228:235], v44
  buffer_load_dwordx4 v[48:51], v16, s[28:31], s66 offen offset:2048 sc1
  v_exp_f32 v120, v120
  v_smfmac_f32_16x16x64_bf16 v[196:199], v[148:151], a[236:243], v44
  v_exp_f32 v121, v121
  v_smfmac_f32_16x16x64_bf16 v[196:199], v[152:155], a[244:251], v44
  s_mov_b64 exec, s[62:63]
  buffer_store_dwordx2 v[212:213], v21, s[24:27], s85 offen sc1
  s_mov_b64 exec, -1
  v_exp_f32 v122, v122
  s_mov_b64 exec, s[62:63]
  buffer_store_dwordx2 v[214:215], v22, s[24:27], s85 offen sc1
  s_mov_b64 exec, -1
  v_exp_f32 v123, v123
  s_mov_b64 exec, s[62:63]
  buffer_store_dwordx2 v[216:217], v23, s[24:27], s85 offen sc1
  s_mov_b64 exec, -1
  v_exp_f32 v124, v124
  s_cmp_lt_i32 s55, 0
  s_cbranch_scc1 fl_82
fl_83:
  v_exp_f32 v125, v125
  s_mov_b64 exec, s[60:61]
  v_cvt_pk_bf16_f32 v220, v120, v121
  v_cvt_pk_bf16_f32 v221, v122, v123
  v_cvt_pk_bf16_f32 v224, v124, v125
  s_mov_b64 exec, s[62:63]
  v_cvt_pk_bf16_f32 v222, v120, v121
  v_cvt_pk_bf16_f32 v223, v122, v123
  v_cvt_pk_bf16_f32 v225, v124, v125
  s_mov_b64 exec, -1
  v_pk_add_f32 v[126:127], v[120:121], v[122:123]
  v_add_f32 v128, v124, v125
  v_mfma_f32_16x16x32_bf16 v[200:203], v[176:179], v[220:223], 0
  v_add_f32 v236, v126, v127
  v_fmac_f32 v236, v128, v89
  v_cvt_pk_bf16_f32 v228, v188, v189
  v_cvt_pk_bf16_f32 v229, v190, v191
  v_mfma_f32_16x16x32_bf16 v[204:207], v[180:183], v[220:223], 0
  v_cvt_pk_bf16_f32 v230, v192, v193
  v_cvt_pk_bf16_f32 v231, v194, v195
  v_mfma_f32_16x16x32_bf16 v[208:211], v[184:187], v[220:223], 0
  v_cvt_pk_bf16_f32 v232, v196, v197
  v_cvt_pk_bf16_f32 v233, v198, v199
  v_add_f32_dpp v236, v236, v236 row_ror:8 row_mask:0xf bank_mask:0xf
  v_mov_b32 v237, v236
  s_nop 0
  v_mfma_f32_16x16x32_bf16 v[200:203], v[228:231], v[224:227], v[200:203]
  v_mfma_f32_16x16x32_bf16 v[204:207], v[230:233], v[224:227], v[204:207]
  v_permlane32_swap_b32 v236, v237
  v_add_f32 v236, v236, v237
  v_mov_b32 v237, v236
  v_mfma_f32_16x16x32_bf16 v[208:211], v[232:235], v[224:227], v[208:211]
  s_nop 0
  v_permlane16_swap_b32 v236, v237
  v_add_f32 v236, v236, v237
  v_rcp_f32 v236, v236
  s_nop 2
  v_pk_mul_f32 v[200:201], v[200:201], v[236:237] op_sel_hi:[1,0]
  v_pk_mul_f32 v[202:203], v[202:203], v[236:237] op_sel_hi:[1,0]
  ds_write_b128 v11, v[200:203] offset:0
  v_pk_mul_f32 v[204:205], v[204:205], v[236:237] op_sel_hi:[1,0]
  v_pk_mul_f32 v[206:207], v[206:207], v[236:237] op_sel_hi:[1,0]
  ds_write_b128 v11, v[204:207] offset:1024
  v_pk_mul_f32 v[208:209], v[208:209], v[236:237] op_sel_hi:[1,0]
  v_pk_mul_f32 v[210:211], v[210:211], v[236:237] op_sel_hi:[1,0]
  ds_write_b128 v11, v[208:211] offset:2048
  s_waitcnt lgkmcnt(0)
  s_barrier
  ds_read_b64 v[96:97], v12 offset:0
  ds_read_b64 v[98:99], v12 offset:128
  ds_read_b64 v[100:101], v12 offset:3072
  ds_read_b64 v[102:103], v12 offset:3200
  ds_read_b64 v[104:105], v12 offset:6144
  ds_read_b64 v[106:107], v12 offset:6272
  ds_read_b64 v[108:109], v12 offset:9216
  ds_read_b64 v[110:111], v12 offset:9344
  s_waitcnt lgkmcnt(6)
  v_pk_add_f32 v[96:97], v[96:97], v[98:99]
  s_waitcnt lgkmcnt(4)
  v_pk_add_f32 v[100:101], v[100:101], v[102:103]
  s_waitcnt lgkmcnt(2)
  v_pk_add_f32 v[104:105], v[104:105], v[106:107]
  v_pk_add_f32 v[96:97], v[96:97], v[100:101]
  s_waitcnt lgkmcnt(0)
  v_pk_add_f32 v[108:109], v[108:109], v[110:111]
  v_pk_add_f32 v[96:97], v[96:97], v[104:105]
  v_pk_add_f32 v[96:97], v[96:97], v[108:109]
  v_cvt_pk_f16_f32 v100, v96, v97
  v_perm_b32 v100, s91, v100, v14
  buffer_atomic_pk_add_f16 v100, v13, s[4:7], s3 offen
  s_add_u32 s23, s52, 2
  s_min_u32 s23, s23, 63
  s_sub_u32 s21, s23, 64
  s_mul_i32 s21, s21, 160
  s_add_u32 s21, s21, s89
  s_lshl_b32 s21, s21, 14
  s_add_u32 s64, s21, s67
  s_lshr_b32 s22, s64, 8
  s_xor_b32 s64, s64, s22
  s_xor_b32 s64, s64, s68
  s_and_b32 s64, s64, 8192
  s_add_u32 s64, s64, s21
  s_add_u32 s64, s64, 83886080
  s_mul_i32 s21, s23, 160
  s_add_u32 s21, s21, s89
  s_lshl_b32 s21, s21, 13
  s_cmp_lt_u32 s23, 64
  s_cselect_b32 s64, s21, s64
  s_add_u32 s69, s89, 1
  s_sub_u32 s21, s23, 64
  s_mul_i32 s21, s21, 160
  s_add_u32 s21, s21, s69
  s_lshl_b32 s21, s21, 14
  s_add_u32 s66, s21, s67
  s_lshr_b32 s22, s66, 8
  s_xor_b32 s66, s66, s22
  s_xor_b32 s66, s66, s68
  s_and_b32 s66, s66, 8192
  s_add_u32 s66, s66, s21
  s_add_u32 s66, s66, 83886080
  s_mul_i32 s21, s23, 160
  s_add_u32 s21, s21, s69
  s_lshl_b32 s21, s21, 13
  s_cmp_lt_u32 s23, 64
  s_cselect_b32 s66, s21, s66
  s_lshl_b32 s21, s87, 10
  s_add_u32 s64, s64, s21
  s_add_u32 s66, s66, s21
  s_sub_u32 s66, s66, 8192
  s_cmp_lt_u32 s87, 7
  s_cselect_b32 s65, s64, s66
  s_cmp_lt_u32 s87, 6
  s_cselect_b32 s66, s64, s66
  s_add_u32 s52, s52, 1
  s_and_b32 s21, s52, 3
  s_mul_i32 s81, s21, 540672
  s_lshl_b32 s84, s21, 15
  s_branch step_71
pm_73:
  s_mov_b32 s47, 1
  buffer_load_dwordx4 v[96:99], v4, s[4:7], s84 offen offset:0 sc1
  buffer_load_dwordx4 v[100:103], v4, s[4:7], s84 offen offset:1024 sc1
  buffer_load_dwordx4 v[104:107], v4, s[4:7], s84 offen offset:2048 sc1
  s_add_u32 s54, s54, 1
  s_cmp_gt_u32 s54, 131072
  s_cbranch_scc1 end0
  s_waitcnt vmcnt(0)
  v_bitop3_b32 v27, v99, v103, v107 bitop3:0x80
  v_cvt_f32_f16 v108, v99
  v_and_b32 v27, 0x48000000, v27
  v_cvt_f32_f16 v109, v103
  v_cmp_ne_u32 vcc, 0x48000000, v27
  v_cvt_f32_f16 v110, v106
  v_cvt_f32_f16_sdwa v111, v106 dst_sel:DWORD dst_unused:UNUSED_PAD src0_sel:WORD_1
  v_cvt_pk_bf16_f32 v40, v110, v111
  s_cbranch_vccnz pm_73
  s_branch pm_74
A1_37:
  v_smfmac_f32_16x16x32_bf16 v[52:55], v[40:41], a[16:19], v44
  v_smfmac_f32_16x16x32_bf16 v[64:67], v[40:41], a[76:79], v44
  v_smfmac_f32_16x16x32_bf16 v[56:59], v[40:41], a[36:39], v44
  v_smfmac_f32_16x16x32_bf16 v[68:71], v[40:41], a[96:99], v44
  v_smfmac_f32_16x16x32_bf16 v[60:63], v[40:41], a[56:59], v44
  v_smfmac_f32_16x16x32_bf16 v[72:75], v[40:41], a[116:119], v44
  v_smfmac_f32_16x16x32_bf16 v[76:79], v[40:41], a[136:139], v44
  v_smfmac_f32_16x16x32_bf16 v[80:83], v[40:41], a[156:159], v44
  v_smfmac_f32_16x16x32_bf16 v[84:87], v[40:41], a[176:179], v44
  s_branch A2_75
pv_76:
  buffer_load_dwordx4 v[144:147], v10, s[8:11], s81 offen offset:0 sc1
  buffer_load_dwordx4 v[148:151], v10, s[8:11], s81 offen offset:1024 sc1
  buffer_load_dwordx4 v[152:155], v10, s[8:11], s81 offen offset:2048 sc1
  s_add_u32 s54, s54, 1
  s_cmp_gt_u32 s54, 131072
  s_cbranch_scc1 end0
  s_waitcnt vmcnt(0)
  v_max3_u32 v27, v144, v146, v148
  v_max3_u32 v27, v27, v150, v152
  v_max3_u32 v27, v27, v154, v154
  v_cmp_eq_u32 vcc, -1, v27
  s_nop 1
  s_cbranch_vccnz pv_76
  s_branch pvj_79
psr_77:
  buffer_load_dwordx2 v[248:249], v9, s[8:11], s81 offen sc1
  buffer_load_dwordx4 v[112:115], v8, s[8:11], s81 offen offset:0 sc1
  buffer_load_dwordx4 v[116:119], v8, s[8:11], s81 offen offset:1024 sc1
  s_add_u32 s54, s54, 1
  s_cmp_gt_u32 s54, 131072
  s_cbranch_scc1 end0
  s_waitcnt vmcnt(2)
  v_xor_b32 v96, s88, v248
  s_nop 0
  v_permlane16_swap_b32 v248, v249
  v_fma_mix_f32 v250, v248, 1.0, v249 op_sel:[0,0,0] op_sel_hi:[1,0,1]
  v_fma_mix_f32 v251, v248, 1.0, v249 op_sel:[1,0,1] op_sel_hi:[1,0,1]
  v_mov_b32 v248, v250
  v_mov_b32 v249, v251
  s_nop 0
  v_permlane32_swap_b32 v248, v250
  v_permlane32_swap_b32 v249, v251
  s_waitcnt vmcnt(0)
  v_bitop3_b32 v97, v112, v114, s88 bitop3:0x7e
  v_bitop3_b32 v98, v116, v118, s88 bitop3:0x7e
  v_fma_mix_f32 v120, v112, 1.0, v116 op_sel:[0,0,0] op_sel_hi:[1,0,1]
  v_or3_b32 v27, v96, v97, v98
  v_fma_mix_f32 v124, v114, 1.0, v118 op_sel:[0,0,0] op_sel_hi:[1,0,1]
  v_and_b32 v27, 1, v27
  v_fma_mix_f32 v121, v112, 1.0, v116 op_sel:[1,0,1] op_sel_hi:[1,0,1]
  v_cmp_ne_u32 vcc, 0, v27
  v_fma_mix_f32 v125, v114, 1.0, v118 op_sel:[1,0,1] op_sel_hi:[1,0,1]
  v_fma_mix_f32 v122, v113, 1.0, v117 op_sel:[0,0,0] op_sel_hi:[1,0,1]
  v_fma_mix_f32 v126, v115, 1.0, v119 op_sel:[0,0,0] op_sel_hi:[1,0,1]
  s_cbranch_vccnz psr_77
  s_branch psj_78
kvw_80:
  v_mov_b32 v236, 0
  s_mov_b32 s101, 0
wf_84:
  buffer_load_dword v237, v236, s[12:15], s79 offen sc1
  s_add_u32 s101, s101, 1
  s_cmp_gt_u32 s101, 131072
  s_cbranch_scc1 end0
  s_waitcnt vmcnt(0)
  v_readfirstlane_b32 s100, v237
  s_cmp_ge_u32 s100, s46
  s_cbranch_scc1 wf_85
  s_sleep 1
  s_branch wf_84
wf_85:
  s_branch kvok_81
fl_82:
  buffer_load_dword v94, v95, s[12:15], s79 offen sc1
  s_branch fl_83
last_72:
  s_mov_b64 exec, s[62:63]
  buffer_store_dwordx2 v[212:213], v21, s[24:27], s85 offen sc1
  buffer_store_dwordx2 v[214:215], v22, s[24:27], s85 offen sc1
  buffer_store_dwordx2 v[216:217], v23, s[24:27], s85 offen sc1
  s_mov_b64 exec, 1
  s_waitcnt vmcnt(0)
  v_mov_b32 v236, 64
  buffer_store_dword v236, v95, s[12:15], s90 offen sc1
  s_mov_b64 exec, -1
  s_branch chain_done
step_86:
  s_add_u32 s21, s52, 2
  s_and_b32 s21, s21, 3
  s_mul_i32 s82, s21, 540672
  s_add_u32 s21, s52, 3
  s_and_b32 s21, s21, 3
  s_lshl_b32 s83, s21, 15
  s_add_u32 s21, s52, 1
  s_and_b32 s22, s21, 3
  s_lshl_b32 s3, s22, 15
  s_mul_i32 s80, s21, 393216
  s_add_u32 s46, s21, 1
  s_min_u32 s46, s46, 64
  s_mul_i32 s85, s52, 98304
  s_add_u32 s57, s85, 6291456
  s_bfe_u32 s88, s52, 0x10002
  s_add_u32 s78, s81, 278528
  v_mov_b32 v52, 0
  v_mov_b32 v53, 0
  v_mov_b32 v54, 0
  v_mov_b32 v55, 0
  v_mov_b32 v56, 0
  v_mov_b32 v57, 0
  v_mov_b32 v58, 0
  v_mov_b32 v59, 0
  v_mov_b32 v60, 0
  v_mov_b32 v61, 0
  v_mov_b32 v62, 0
  v_mov_b32 v63, 0
  v_mov_b32 v64, 0
  v_mov_b32 v65, 0
  v_mov_b32 v66, 0
  v_mov_b32 v67, 0
  v_mov_b32 v68, 0
  v_mov_b32 v69, 0
  v_mov_b32 v70, 0
  v_mov_b32 v71, 0
  v_mov_b32 v72, 0
  v_mov_b32 v73, 0
  v_mov_b32 v74, 0
  v_mov_b32 v75, 0
  v_mov_b32 v76, 0
  v_mov_b32 v77, 0
  v_mov_b32 v78, 0
  v_mov_b32 v79, 0
  v_mov_b32 v80, 0
  v_mov_b32 v81, 0
  v_mov_b32 v82, 0
  v_mov_b32 v83, 0
  v_mov_b32 v84, 0
  v_mov_b32 v85, 0
  v_mov_b32 v86, 0
  v_mov_b32 v87, 0
  s_sleep 8
  s_mov_b32 s54, 0
  buffer_load_dwordx4 v[96:99], v4, s[4:7], s84 offen offset:0 sc1
  buffer_load_dwordx4 v[100:103], v4, s[4:7], s84 offen offset:1024 sc1
  buffer_load_dwordx4 v[104:107], v4, s[4:7], s84 offen offset:2048 sc1
  s_waitcnt vmcnt(3)
  v_mov_b32 v176, v160
  v_mov_b32 v177, v161
  v_mov_b32 v178, v162
  v_mov_b32 v179, v163
  v_mov_b32 v180, v164
  v_mov_b32 v181, v165
  v_mov_b32 v182, v166
  v_mov_b32 v183, v167
  v_mov_b32 v184, v48
  v_mov_b32 v185, v49
  v_mov_b32 v186, v50
  v_mov_b32 v187, v51
  s_waitcnt vmcnt(0)
  v_bitop3_b32 v27, v99, v103, v107 bitop3:0x80
  v_cvt_f32_f16 v108, v99
  v_and_b32 v27, 0x48000000, v27
  v_cvt_f32_f16 v109, v103
  v_cmp_ne_u32 vcc, 0x48000000, v27
  v_cvt_f32_f16 v110, v106
  v_cvt_f32_f16_sdwa v111, v106 dst_sel:DWORD dst_unused:UNUSED_PAD src0_sel:WORD_1
  v_cvt_pk_bf16_f32 v40, v110, v111
  s_cbranch_vccnz pm_88
pm_89:
  v_cvt_pk_bf16_f32 v41, v108, v109
  v_cvt_f32_f16 v110, v96
  v_cvt_f32_f16_sdwa v111, v96 dst_sel:DWORD dst_unused:UNUSED_PAD src0_sel:WORD_1
  v_smfmac_f32_16x16x32_bf16 v[52:55], v[40:41], a[16:19], v44
  v_cvt_f32_f16 v112, v97
  v_cvt_f32_f16_sdwa v113, v97 dst_sel:DWORD dst_unused:UNUSED_PAD src0_sel:WORD_1
  v_cvt_pk_bf16_f32 v32, v110, v111
  v_smfmac_f32_16x16x32_bf16 v[64:67], v[40:41], a[76:79], v44
  v_cvt_pk_bf16_f32 v33, v112, v113
  v_cvt_f32_f16 v114, v98
  v_cvt_f32_f16_sdwa v115, v98 dst_sel:DWORD dst_unused:UNUSED_PAD src0_sel:WORD_1
  v_smfmac_f32_16x16x32_bf16 v[56:59], v[40:41], a[36:39], v44
  v_cvt_f32_f16 v116, v100
  v_cvt_f32_f16_sdwa v117, v100 dst_sel:DWORD dst_unused:UNUSED_PAD src0_sel:WORD_1
  v_cvt_pk_bf16_f32 v34, v114, v115
  v_smfmac_f32_16x16x32_bf16 v[68:71], v[40:41], a[96:99], v44
  v_cvt_pk_bf16_f32 v35, v116, v117
  v_cvt_f32_f16 v110, v101
  v_cvt_f32_f16_sdwa v111, v101 dst_sel:DWORD dst_unused:UNUSED_PAD src0_sel:WORD_1
  v_smfmac_f32_16x16x32_bf16 v[60:63], v[40:41], a[56:59], v44
  v_cvt_f32_f16 v112, v102
  v_cvt_f32_f16_sdwa v113, v102 dst_sel:DWORD dst_unused:UNUSED_PAD src0_sel:WORD_1
  v_smfmac_f32_16x16x32_bf16 v[72:75], v[40:41], a[116:119], v44
  v_cvt_pk_bf16_f32 v36, v110, v111
  v_cvt_pk_bf16_f32 v37, v112, v113
  v_smfmac_f32_16x16x32_bf16 v[76:79], v[40:41], a[136:139], v44
  v_cvt_f32_f16 v114, v104
  v_cvt_f32_f16_sdwa v115, v104 dst_sel:DWORD dst_unused:UNUSED_PAD src0_sel:WORD_1
  v_smfmac_f32_16x16x32_bf16 v[80:83], v[40:41], a[156:159], v44
  v_cvt_f32_f16 v116, v105
  v_cvt_f32_f16_sdwa v117, v105 dst_sel:DWORD dst_unused:UNUSED_PAD src0_sel:WORD_1
  v_smfmac_f32_16x16x32_bf16 v[84:87], v[40:41], a[176:179], v44
  v_cvt_pk_bf16_f32 v38, v114, v115
  v_cvt_pk_bf16_f32 v39, v116, v117
A2_90:
  v_smfmac_f32_16x16x64_bf16 v[52:55], v[32:35], a[0:7], v44
  v_smfmac_f32_16x16x64_bf16 v[52:55], v[36:39], a[8:15], v44
  v_smfmac_f32_16x16x64_bf16 v[64:67], v[32:35], a[60:67], v44
  v_smfmac_f32_16x16x64_bf16 v[64:67], v[36:39], a[68:75], v44
  v_smfmac_f32_16x16x64_bf16 v[56:59], v[32:35], a[20:27], v44
  v_smfmac_f32_16x16x64_bf16 v[56:59], v[36:39], a[28:35], v44
  v_smfmac_f32_16x16x64_bf16 v[68:71], v[32:35], a[80:87], v44
  v_permlane32_swap_b32 v52, v64
  v_permlane32_swap_b32 v53, v65
  v_permlane32_swap_b32 v54, v66
  v_smfmac_f32_16x16x64_bf16 v[68:71], v[36:39], a[88:95], v44
  v_permlane32_swap_b32 v55, v67
  v_pk_add_f32 v[52:53], v[52:53], v[64:65]
  v_pk_add_f32 v[54:55], v[54:55], v[66:67]
  v_smfmac_f32_16x16x64_bf16 v[60:63], v[32:35], a[40:47], v44
  ds_write2_b32 v5, v52, v53 offset0:0 offset1:4
  ds_write2_b32 v5, v54, v55 offset0:8 offset1:12
  v_smfmac_f32_16x16x64_bf16 v[60:63], v[36:39], a[48:55], v44
  v_smfmac_f32_16x16x64_bf16 v[72:75], v[32:35], a[100:107], v44
  v_permlane32_swap_b32 v56, v68
  v_permlane32_swap_b32 v57, v69
  v_permlane32_swap_b32 v58, v70
  v_smfmac_f32_16x16x64_bf16 v[72:75], v[36:39], a[108:115], v44
  v_permlane32_swap_b32 v59, v71
  v_pk_add_f32 v[56:57], v[56:57], v[68:69]
  v_pk_add_f32 v[58:59], v[58:59], v[70:71]
  v_smfmac_f32_16x16x64_bf16 v[76:79], v[32:35], a[120:127], v44
  ds_write2_b32 v242, v56, v57 offset0:0 offset1:4
  ds_write2_b32 v242, v58, v59 offset0:8 offset1:12
  v_smfmac_f32_16x16x64_bf16 v[76:79], v[36:39], a[128:135], v44
  v_smfmac_f32_16x16x64_bf16 v[80:83], v[32:35], a[140:147], v44
  v_permlane32_swap_b32 v60, v72
  v_permlane32_swap_b32 v61, v73
  v_permlane32_swap_b32 v62, v74
  v_smfmac_f32_16x16x64_bf16 v[80:83], v[36:39], a[148:155], v44
  v_permlane32_swap_b32 v63, v75
  v_pk_add_f32 v[60:61], v[60:61], v[72:73]
  v_pk_add_f32 v[62:63], v[62:63], v[74:75]
  v_smfmac_f32_16x16x64_bf16 v[84:87], v[32:35], a[160:167], v44
  ds_write2_b32 v243, v60, v61 offset0:0 offset1:4
  ds_write2_b32 v243, v62, v63 offset0:8 offset1:12
  v_smfmac_f32_16x16x64_bf16 v[84:87], v[36:39], a[168:175], v44
  v_permlane32_swap_b32 v76, v80
  v_permlane32_swap_b32 v77, v81
  v_permlane32_swap_b32 v78, v82
  v_permlane32_swap_b32 v79, v83
  v_pk_add_f32 v[76:77], v[76:77], v[80:81]
  v_pk_add_f32 v[78:79], v[78:79], v[82:83]
  ds_write2_b32 v244, v76, v77 offset0:0 offset1:4
  ds_write2_b32 v244, v78, v79 offset0:8 offset1:12
  ds_write2_b32 v245, v84, v85 offset0:0 offset1:4
  ds_write2_b32 v245, v86, v87 offset0:8 offset1:12
  s_waitcnt lgkmcnt(0) vmcnt(0)
  s_barrier
  ds_read_b128 v[96:99], v6 offset:3264
  ds_read_b128 v[100:103], v6 offset:8704
  ds_read_b128 v[104:107], v6 offset:14144
  ds_read_b128 v[108:111], v6 offset:19584
  ds_read_b128 v[112:115], v6 offset:4352
  ds_read_b128 v[116:119], v6 offset:9792
  ds_read_b128 v[120:123], v6 offset:15232
  ds_read_b128 v[124:127], v6 offset:20672
  s_waitcnt lgkmcnt(4)
  v_pk_add_f32 v[96:97], v[96:97], v[100:101]
  v_pk_add_f32 v[98:99], v[98:99], v[102:103]
  v_pk_add_f32 v[104:105], v[104:105], v[108:109]
  v_pk_add_f32 v[106:107], v[106:107], v[110:111]
  v_pk_add_f32 v[96:97], v[96:97], v[104:105]
  v_pk_add_f32 v[98:99], v[98:99], v[106:107]
  v_cvt_pk_bf16_f32 v90, v96, v97
  v_cvt_pk_bf16_f32 v91, v98, v99
  v_min_u32 v90, -2, v90
  v_min_u32 v91, -2, v91
  buffer_store_dwordx2 v[90:91], v24, s[8:11], s81 offen
  s_waitcnt lgkmcnt(0)
  v_pk_add_f32 v[112:113], v[112:113], v[116:117]
  v_pk_add_f32 v[114:115], v[114:115], v[118:119]
  v_pk_add_f32 v[120:121], v[120:121], v[124:125]
  v_pk_add_f32 v[122:123], v[122:123], v[126:127]
  v_pk_add_f32 v[112:113], v[112:113], v[120:121]
  v_pk_add_f32 v[114:115], v[114:115], v[122:123]
  s_nop 1
  v_add_f32_dpp v116, v112, v112 row_ror:8 row_mask:0xf bank_mask:0xf
  v_add_f32_dpp v117, v113, v113 row_ror:8 row_mask:0xf bank_mask:0xf
  v_add_f32_dpp v118, v114, v114 row_ror:8 row_mask:0xf bank_mask:0xf
  v_add_f32_dpp v119, v115, v115 row_ror:8 row_mask:0xf bank_mask:0xf
  v_cvt_pk_bf16_f32 v92, v116, v117
  v_cvt_pk_bf16_f32 v93, v118, v119
  v_min_u32 v92, -2, v92
  v_min_u32 v93, -2, v93
  s_mov_b64 exec, s[60:61]
  buffer_store_dwordx2 v[92:93], v23, s[8:11], s78 offen
  s_mov_b64 exec, -1
  s_cmp_eq_u32 s52, 63
  s_cbranch_scc1 last_87
  s_sleep 5
  s_mov_b32 s54, 0
  buffer_load_dwordx2 v[248:249], v9, s[8:11], s81 offen sc1
  buffer_load_dwordx4 v[112:115], v8, s[8:11], s81 offen offset:0 sc1
  buffer_load_dwordx4 v[116:119], v8, s[8:11], s81 offen offset:1024 sc1
  s_sleep 2
  buffer_load_dwordx4 v[144:147], v10, s[8:11], s81 offen offset:0 sc1
  buffer_load_dwordx4 v[148:151], v10, s[8:11], s81 offen offset:1024 sc1
  buffer_load_dwordx4 v[152:155], v10, s[8:11], s81 offen offset:2048 sc1
  v_mov_b32 v188, 0
  v_mov_b32 v189, 0
  v_mov_b32 v190, 0
  v_mov_b32 v191, 0
  v_mov_b32 v192, 0
  v_mov_b32 v193, 0
  v_mov_b32 v194, 0
  v_mov_b32 v195, 0
  v_mov_b32 v196, 0
  v_mov_b32 v197, 0
  v_mov_b32 v198, 0
  v_mov_b32 v199, 0
  v_readfirstlane_b32 s21, v94
  s_add_u32 s22, s46, 8
  s_min_u32 s22, s22, 64
  s_sub_u32 s55, s21, s22
  s_sub_u32 s56, s21, s46
  s_waitcnt vmcnt(5)
  v_xor_b32 v96, s88, v248
  s_nop 0
  v_permlane16_swap_b32 v248, v249
  v_fma_mix_f32 v250, v248, 1.0, v249 op_sel:[0,0,0] op_sel_hi:[1,0,1]
  v_fma_mix_f32 v251, v248, 1.0, v249 op_sel:[1,0,1] op_sel_hi:[1,0,1]
  v_mov_b32 v248, v250
  v_mov_b32 v249, v251
  s_nop 0
  v_permlane32_swap_b32 v248, v250
  v_permlane32_swap_b32 v249, v251
  s_waitcnt vmcnt(3)
  v_bitop3_b32 v97, v112, v114, s88 bitop3:0x7e
  v_bitop3_b32 v98, v116, v118, s88 bitop3:0x7e
  v_fma_mix_f32 v120, v112, 1.0, v116 op_sel:[0,0,0] op_sel_hi:[1,0,1]
  v_or3_b32 v27, v96, v97, v98
  v_fma_mix_f32 v124, v114, 1.0, v118 op_sel:[0,0,0] op_sel_hi:[1,0,1]
  v_and_b32 v27, 1, v27
  v_fma_mix_f32 v121, v112, 1.0, v116 op_sel:[1,0,1] op_sel_hi:[1,0,1]
  v_cmp_ne_u32 vcc, 0, v27
  v_fma_mix_f32 v125, v114, 1.0, v118 op_sel:[1,0,1] op_sel_hi:[1,0,1]
  v_fma_mix_f32 v122, v113, 1.0, v117 op_sel:[0,0,0] op_sel_hi:[1,0,1]
  v_fma_mix_f32 v126, v115, 1.0, v119 op_sel:[0,0,0] op_sel_hi:[1,0,1]
  s_cbranch_vccnz psr_92
psj_93:
  s_cmp_lt_i32 s56, 0
  s_cbranch_scc1 kvw_95
kvok_96:
  v_fma_mix_f32 v123, v113, 1.0, v117 op_sel:[1,0,1] op_sel_hi:[1,0,1]
  v_fma_mix_f32 v127, v115, 1.0, v119 op_sel:[1,0,1] op_sel_hi:[1,0,1]
  v_permlane32_swap_b32 v120, v124
  v_permlane32_swap_b32 v121, v125
  v_permlane32_swap_b32 v122, v126
  v_permlane32_swap_b32 v123, v127
  v_pk_add_f32 v[120:121], v[120:121], v[124:125]
  v_pk_add_f32 v[122:123], v[122:123], v[126:127]
  v_pk_add_f32 v[124:125], v[248:249], v[250:251]
  v_max3_f32 v236, v120, v121, v122
  v_max3_f32 v237, v123, v124, v125
  v_max_f32 v236, v236, v237
  s_nop 1
  v_max_f32_dpp v236, v236, v236 row_ror:8 row_mask:0xf bank_mask:0xf
  v_mov_b32 v237, v236
  s_nop 1
  v_permlane32_swap_b32 v236, v237
  v_max_f32 v236, v236, v237
  v_mov_b32 v237, v236
  s_nop 1
  v_permlane16_swap_b32 v236, v237
  v_max_f32 v236, v236, v237
  s_waitcnt vmcnt(0)
  v_max3_u32 v27, v144, v146, v148
  v_max3_u32 v27, v27, v150, v152
  v_max3_u32 v27, v27, v154, v154
  v_cmp_eq_u32 vcc, -1, v27
  s_nop 1
  s_cbranch_vccnz pv_91
pvj_94:
  v_mul_f32 v236, s86, v236
  v_smfmac_f32_16x16x64_bf16 v[188:191], v[144:147], a[180:187], v44
  v_fma_f32 v120, v120, s86, -v236
  v_smfmac_f32_16x16x64_bf16 v[188:191], v[148:151], a[188:195], v44
  v_fma_f32 v121, v121, s86, -v236
  v_smfmac_f32_16x16x64_bf16 v[188:191], v[152:155], a[196:203], v44
  buffer_load_dwordx4 v[160:163], v16, s[28:31], s64 offen offset:0 sc1
  v_fma_f32 v122, v122, s86, -v236
  v_smfmac_f32_16x16x64_bf16 v[192:195], v[144:147], a[204:211], v44
  v_fma_f32 v123, v123, s86, -v236
  v_smfmac_f32_16x16x64_bf16 v[192:195], v[148:151], a[212:219], v44
  buffer_load_dwordx4 v[164:167], v16, s[28:31], s65 offen offset:1024 sc1
  v_fma_f32 v124, v124, s86, -v236
  v_smfmac_f32_16x16x64_bf16 v[192:195], v[152:155], a[220:227], v44
  v_fma_f32 v125, v125, s86, -v236
  v_smfmac_f32_16x16x64_bf16 v[196:199], v[144:147], a[228:235], v44
  buffer_load_dwordx4 v[48:51], v16, s[28:31], s66 offen offset:2048 sc1
  v_exp_f32 v120, v120
  v_smfmac_f32_16x16x64_bf16 v[196:199], v[148:151], a[236:243], v44
  v_exp_f32 v121, v121
  v_smfmac_f32_16x16x64_bf16 v[196:199], v[152:155], a[244:251], v44
  buffer_store_dwordx2 v[90:91], v25, s[24:27], s57 offen sc1
  v_exp_f32 v122, v122
  s_mov_b64 exec, s[60:61]
  buffer_store_dwordx2 v[92:93], v23, s[24:27], s57 offen sc1
  s_mov_b64 exec, -1
  v_exp_f32 v123, v123
  v_mov_b32 v240, s52
  v_mov_b32 v241, s52
  s_mov_b64 exec, 1
  buffer_store_dwordx2 v[240:241], v95, s[12:15], s90 offen sc1
  s_mov_b64 exec, -1
  v_exp_f32 v124, v124
  s_cmp_lt_i32 s55, 0
  s_cbranch_scc1 fl_97
fl_98:
  v_exp_f32 v125, v125
  s_mov_b64 exec, s[60:61]
  v_cvt_pk_bf16_f32 v220, v120, v121
  v_cvt_pk_bf16_f32 v221, v122, v123
  v_cvt_pk_bf16_f32 v224, v124, v125
  s_mov_b64 exec, s[62:63]
  v_cvt_pk_bf16_f32 v222, v120, v121
  v_cvt_pk_bf16_f32 v223, v122, v123
  v_cvt_pk_bf16_f32 v225, v124, v125
  s_mov_b64 exec, -1
  v_pk_add_f32 v[126:127], v[120:121], v[122:123]
  v_add_f32 v128, v124, v125
  v_mfma_f32_16x16x32_bf16 v[200:203], v[176:179], v[220:223], 0
  v_add_f32 v236, v126, v127
  v_fmac_f32 v236, v128, v89
  v_cvt_pk_bf16_f32 v228, v188, v189
  v_cvt_pk_bf16_f32 v229, v190, v191
  v_mfma_f32_16x16x32_bf16 v[204:207], v[180:183], v[220:223], 0
  v_cvt_pk_bf16_f32 v230, v192, v193
  v_cvt_pk_bf16_f32 v231, v194, v195
  v_mfma_f32_16x16x32_bf16 v[208:211], v[184:187], v[220:223], 0
  v_cvt_pk_bf16_f32 v232, v196, v197
  v_cvt_pk_bf16_f32 v233, v198, v199
  v_add_f32_dpp v236, v236, v236 row_ror:8 row_mask:0xf bank_mask:0xf
  v_mov_b32 v237, v236
  s_nop 0
  v_mfma_f32_16x16x32_bf16 v[200:203], v[228:231], v[224:227], v[200:203]
  v_mfma_f32_16x16x32_bf16 v[204:207], v[230:233], v[224:227], v[204:207]
  v_permlane32_swap_b32 v236, v237
  v_add_f32 v236, v236, v237
  v_mov_b32 v237, v236
  v_mfma_f32_16x16x32_bf16 v[208:211], v[232:235], v[224:227], v[208:211]
  s_nop 0
  v_permlane16_swap_b32 v236, v237
  v_add_f32 v236, v236, v237
  v_rcp_f32 v236, v236
  s_nop 2
  v_pk_mul_f32 v[200:201], v[200:201], v[236:237] op_sel_hi:[1,0]
  v_pk_mul_f32 v[202:203], v[202:203], v[236:237] op_sel_hi:[1,0]
  ds_write_b128 v11, v[200:203] offset:0
  v_pk_mul_f32 v[204:205], v[204:205], v[236:237] op_sel_hi:[1,0]
  v_pk_mul_f32 v[206:207], v[206:207], v[236:237] op_sel_hi:[1,0]
  ds_write_b128 v11, v[204:207] offset:1024
  v_pk_mul_f32 v[208:209], v[208:209], v[236:237] op_sel_hi:[1,0]
  v_pk_mul_f32 v[210:211], v[210:211], v[236:237] op_sel_hi:[1,0]
  ds_write_b128 v11, v[208:211] offset:2048
  s_waitcnt lgkmcnt(0)
  s_barrier
  v_mov_b32 v28, -1
  v_mov_b32 v29, -1
  buffer_store_dwordx2 v[28:29], v24, s[8:11], s82 offen
  s_mov_b64 exec, s[60:61]
  s_add_u32 s22, s82, 278528
  buffer_store_dwordx2 v[28:29], v23, s[8:11], s22 offen
  s_and_b32 s21, s52, 7
  s_cmp_lg_u32 s21, s50
  s_cbranch_scc1 zm_99
  s_mov_b64 exec, s[70:71]
  buffer_store_dwordx4 v[156:159], v13, s[4:7], s83 offen sc1
zm_99:
  s_mov_b64 exec, -1
  s_add_u32 s23, s52, 2
  s_min_u32 s23, s23, 63
  s_sub_u32 s21, s23, 64
  s_mul_i32 s21, s21, 160
  s_add_u32 s21, s21, s89
  s_lshl_b32 s21, s21, 14
  s_add_u32 s64, s21, s67
  s_lshr_b32 s22, s64, 8
  s_xor_b32 s64, s64, s22
  s_xor_b32 s64, s64, s68
  s_and_b32 s64, s64, 8192
  s_add_u32 s64, s64, s21
  s_add_u32 s64, s64, 83886080
  s_mul_i32 s21, s23, 160
  s_add_u32 s21, s21, s89
  s_lshl_b32 s21, s21, 13
  s_cmp_lt_u32 s23, 64
  s_cselect_b32 s64, s21, s64
  s_add_u32 s69, s89, 1
  s_sub_u32 s21, s23, 64
  s_mul_i32 s21, s21, 160
  s_add_u32 s21, s21, s69
  s_lshl_b32 s21, s21, 14
  s_add_u32 s66, s21, s67
  s_lshr_b32 s22, s66, 8
  s_xor_b32 s66, s66, s22
  s_xor_b32 s66, s66, s68
  s_and_b32 s66, s66, 8192
  s_add_u32 s66, s66, s21
  s_add_u32 s66, s66, 83886080
  s_mul_i32 s21, s23, 160
  s_add_u32 s21, s21, s69
  s_lshl_b32 s21, s21, 13
  s_cmp_lt_u32 s23, 64
  s_cselect_b32 s66, s21, s66
  s_lshl_b32 s21, s87, 10
  s_add_u32 s64, s64, s21
  s_add_u32 s66, s66, s21
  s_sub_u32 s66, s66, 8192
  s_cmp_lt_u32 s87, 7
  s_cselect_b32 s65, s64, s66
  s_cmp_lt_u32 s87, 6
  s_cselect_b32 s66, s64, s66
  s_add_u32 s52, s52, 1
  s_and_b32 s21, s52, 3
  s_mul_i32 s81, s21, 540672
  s_lshl_b32 s84, s21, 15
  s_branch step_86
pm_88:
  s_mov_b32 s47, 1
  buffer_load_dwordx4 v[96:99], v4, s[4:7], s84 offen offset:0 sc1
  buffer_load_dwordx4 v[100:103], v4, s[4:7], s84 offen offset:1024 sc1
  buffer_load_dwordx4 v[104:107], v4, s[4:7], s84 offen offset:2048 sc1
  s_add_u32 s54, s54, 1
  s_cmp_gt_u32 s54, 131072
  s_cbranch_scc1 end0
  s_waitcnt vmcnt(0)
  v_bitop3_b32 v27, v99, v103, v107 bitop3:0x80
  v_cvt_f32_f16 v108, v99
  v_and_b32 v27, 0x48000000, v27
  v_cvt_f32_f16 v109, v103
  v_cmp_ne_u32 vcc, 0x48000000, v27
  v_cvt_f32_f16 v110, v106
  v_cvt_f32_f16_sdwa v111, v106 dst_sel:DWORD dst_unused:UNUSED_PAD src0_sel:WORD_1
  v_cvt_pk_bf16_f32 v40, v110, v111
  s_cbranch_vccnz pm_88
  s_branch pm_89
A1_38:
  v_smfmac_f32_16x16x32_bf16 v[52:55], v[40:41], a[16:19], v44
  v_smfmac_f32_16x16x32_bf16 v[64:67], v[40:41], a[76:79], v44
  v_smfmac_f32_16x16x32_bf16 v[56:59], v[40:41], a[36:39], v44
  v_smfmac_f32_16x16x32_bf16 v[68:71], v[40:41], a[96:99], v44
  v_smfmac_f32_16x16x32_bf16 v[60:63], v[40:41], a[56:59], v44
  v_smfmac_f32_16x16x32_bf16 v[72:75], v[40:41], a[116:119], v44
  v_smfmac_f32_16x16x32_bf16 v[76:79], v[40:41], a[136:139], v44
  v_smfmac_f32_16x16x32_bf16 v[80:83], v[40:41], a[156:159], v44
  v_smfmac_f32_16x16x32_bf16 v[84:87], v[40:41], a[176:179], v44
  s_branch A2_90
pv_91:
  buffer_load_dwordx4 v[144:147], v10, s[8:11], s81 offen offset:0 sc1
  buffer_load_dwordx4 v[148:151], v10, s[8:11], s81 offen offset:1024 sc1
  buffer_load_dwordx4 v[152:155], v10, s[8:11], s81 offen offset:2048 sc1
  s_add_u32 s54, s54, 1
  s_cmp_gt_u32 s54, 131072
  s_cbranch_scc1 end0
  s_waitcnt vmcnt(0)
  v_max3_u32 v27, v144, v146, v148
  v_max3_u32 v27, v27, v150, v152
  v_max3_u32 v27, v27, v154, v154
  v_cmp_eq_u32 vcc, -1, v27
  s_nop 1
  s_cbranch_vccnz pv_91
  s_branch pvj_94
psr_92:
  buffer_load_dwordx2 v[248:249], v9, s[8:11], s81 offen sc1
  buffer_load_dwordx4 v[112:115], v8, s[8:11], s81 offen offset:0 sc1
  buffer_load_dwordx4 v[116:119], v8, s[8:11], s81 offen offset:1024 sc1
  s_add_u32 s54, s54, 1
  s_cmp_gt_u32 s54, 131072
  s_cbranch_scc1 end0
  s_waitcnt vmcnt(2)
  v_xor_b32 v96, s88, v248
  s_nop 0
  v_permlane16_swap_b32 v248, v249
  v_fma_mix_f32 v250, v248, 1.0, v249 op_sel:[0,0,0] op_sel_hi:[1,0,1]
  v_fma_mix_f32 v251, v248, 1.0, v249 op_sel:[1,0,1] op_sel_hi:[1,0,1]
  v_mov_b32 v248, v250
  v_mov_b32 v249, v251
  s_nop 0
  v_permlane32_swap_b32 v248, v250
  v_permlane32_swap_b32 v249, v251
  s_waitcnt vmcnt(0)
  v_bitop3_b32 v97, v112, v114, s88 bitop3:0x7e
  v_bitop3_b32 v98, v116, v118, s88 bitop3:0x7e
  v_fma_mix_f32 v120, v112, 1.0, v116 op_sel:[0,0,0] op_sel_hi:[1,0,1]
  v_or3_b32 v27, v96, v97, v98
  v_fma_mix_f32 v124, v114, 1.0, v118 op_sel:[0,0,0] op_sel_hi:[1,0,1]
  v_and_b32 v27, 1, v27
  v_fma_mix_f32 v121, v112, 1.0, v116 op_sel:[1,0,1] op_sel_hi:[1,0,1]
  v_cmp_ne_u32 vcc, 0, v27
  v_fma_mix_f32 v125, v114, 1.0, v118 op_sel:[1,0,1] op_sel_hi:[1,0,1]
  v_fma_mix_f32 v122, v113, 1.0, v117 op_sel:[0,0,0] op_sel_hi:[1,0,1]
  v_fma_mix_f32 v126, v115, 1.0, v119 op_sel:[0,0,0] op_sel_hi:[1,0,1]
  s_cbranch_vccnz psr_92
  s_branch psj_93
kvw_95:
  v_mov_b32 v236, 0
  s_mov_b32 s101, 0
wf_100:
  buffer_load_dword v237, v236, s[12:15], s79 offen sc1
  s_add_u32 s101, s101, 1
  s_cmp_gt_u32 s101, 131072
  s_cbranch_scc1 end0
  s_waitcnt vmcnt(0)
  v_readfirstlane_b32 s100, v237
  s_cmp_ge_u32 s100, s46
  s_cbranch_scc1 wf_101
  s_sleep 1
  s_branch wf_100
wf_101:
  s_branch kvok_96
fl_97:
  buffer_load_dword v94, v95, s[12:15], s79 offen sc1
  s_branch fl_98
last_87:
  buffer_store_dwordx2 v[90:91], v25, s[24:27], s57 offen sc1
  s_mov_b64 exec, s[60:61]
  buffer_store_dwordx2 v[92:93], v23, s[24:27], s57 offen sc1
  s_mov_b64 exec, 1
  s_waitcnt vmcnt(0)
  v_mov_b32 v236, 64
  buffer_store_dword v236, v95, s[12:15], s90 offen offset:4 sc1
  s_mov_b64 exec, -1
  s_branch chain_done
step_102:
  s_add_u32 s21, s52, 2
  s_and_b32 s21, s21, 3
  s_mul_i32 s82, s21, 540672
  s_add_u32 s21, s52, 3
  s_and_b32 s21, s21, 3
  s_lshl_b32 s83, s21, 15
  s_add_u32 s21, s52, 1
  s_and_b32 s22, s21, 3
  s_lshl_b32 s3, s22, 15
  s_mul_i32 s80, s21, 393216
  s_add_u32 s46, s21, 1
  s_min_u32 s46, s46, 64
  s_mul_i32 s85, s52, 98304
  s_add_u32 s57, s85, 6291456
  s_bfe_u32 s88, s52, 0x10002
  s_add_u32 s78, s81, 278528
  v_mov_b32 v52, 0
  v_mov_b32 v53, 0
  v_mov_b32 v54, 0
  v_mov_b32 v55, 0
  v_mov_b32 v56, 0
  v_mov_b32 v57, 0
  v_mov_b32 v58, 0
  v_mov_b32 v59, 0
  v_mov_b32 v60, 0
  v_mov_b32 v61, 0
  v_mov_b32 v62, 0
  v_mov_b32 v63, 0
  v_mov_b32 v64, 0
  v_mov_b32 v65, 0
  v_mov_b32 v66, 0
  v_mov_b32 v67, 0
  v_mov_b32 v68, 0
  v_mov_b32 v69, 0
  v_mov_b32 v70, 0
  v_mov_b32 v71, 0
  v_mov_b32 v72, 0
  v_mov_b32 v73, 0
  v_mov_b32 v74, 0
  v_mov_b32 v75, 0
  v_mov_b32 v76, 0
  v_mov_b32 v77, 0
  v_mov_b32 v78, 0
  v_mov_b32 v79, 0
  v_mov_b32 v80, 0
  v_mov_b32 v81, 0
  v_mov_b32 v82, 0
  v_mov_b32 v83, 0
  v_mov_b32 v84, 0
  v_mov_b32 v85, 0
  v_mov_b32 v86, 0
  v_mov_b32 v87, 0
  s_sleep 8
  s_mov_b32 s54, 0
  buffer_load_dwordx4 v[96:99], v4, s[4:7], s84 offen offset:0 sc1
  buffer_load_dwordx4 v[100:103], v4, s[4:7], s84 offen offset:1024 sc1
  buffer_load_dwordx4 v[104:107], v4, s[4:7], s84 offen offset:2048 sc1
  s_waitcnt vmcnt(3)
  v_mov_b32 v176, v160
  v_mov_b32 v177, v161
  v_mov_b32 v178, v162
  v_mov_b32 v179, v163
  v_mov_b32 v180, v164
  v_mov_b32 v181, v165
  v_mov_b32 v182, v166
  v_mov_b32 v183, v167
  v_mov_b32 v184, v48
  v_mov_b32 v185, v49
  v_mov_b32 v186, v50
  v_mov_b32 v187, v51
  s_waitcnt vmcnt(0)
  v_bitop3_b32 v27, v99, v103, v107 bitop3:0x80
  v_cvt_f32_f16 v108, v99
  v_and_b32 v27, 0x48000000, v27
  v_cvt_f32_f16 v109, v103
  v_cmp_ne_u32 vcc, 0x48000000, v27
  v_cvt_f32_f16 v110, v106
  v_cvt_f32_f16_sdwa v111, v106 dst_sel:DWORD dst_unused:UNUSED_PAD src0_sel:WORD_1
  v_cvt_pk_bf16_f32 v40, v110, v111
  s_cbranch_vccnz pm_104
pm_105:
  v_cvt_pk_bf16_f32 v41, v108, v109
  v_cvt_f32_f16 v110, v96
  v_cvt_f32_f16_sdwa v111, v96 dst_sel:DWORD dst_unused:UNUSED_PAD src0_sel:WORD_1
  v_smfmac_f32_16x16x32_bf16 v[52:55], v[40:41], a[16:19], v44
  v_cvt_f32_f16 v112, v97
  v_cvt_f32_f16_sdwa v113, v97 dst_sel:DWORD dst_unused:UNUSED_PAD src0_sel:WORD_1
  v_cvt_pk_bf16_f32 v32, v110, v111
  v_smfmac_f32_16x16x32_bf16 v[64:67], v[40:41], a[76:79], v44
  v_cvt_pk_bf16_f32 v33, v112, v113
  v_cvt_f32_f16 v114, v98
  v_cvt_f32_f16_sdwa v115, v98 dst_sel:DWORD dst_unused:UNUSED_PAD src0_sel:WORD_1
  v_smfmac_f32_16x16x32_bf16 v[56:59], v[40:41], a[36:39], v44
  v_cvt_f32_f16 v116, v100
  v_cvt_f32_f16_sdwa v117, v100 dst_sel:DWORD dst_unused:UNUSED_PAD src0_sel:WORD_1
  v_cvt_pk_bf16_f32 v34, v114, v115
  v_smfmac_f32_16x16x32_bf16 v[68:71], v[40:41], a[96:99], v44
  v_cvt_pk_bf16_f32 v35, v116, v117
  v_cvt_f32_f16 v110, v101
  v_cvt_f32_f16_sdwa v111, v101 dst_sel:DWORD dst_unused:UNUSED_PAD src0_sel:WORD_1
  v_smfmac_f32_16x16x32_bf16 v[60:63], v[40:41], a[56:59], v44
  v_cvt_f32_f16 v112, v102
  v_cvt_f32_f16_sdwa v113, v102 dst_sel:DWORD dst_unused:UNUSED_PAD src0_sel:WORD_1
  v_smfmac_f32_16x16x32_bf16 v[72:75], v[40:41], a[116:119], v44
  v_cvt_pk_bf16_f32 v36, v110, v111
  v_cvt_pk_bf16_f32 v37, v112, v113
  v_smfmac_f32_16x16x32_bf16 v[76:79], v[40:41], a[136:139], v44
  v_cvt_f32_f16 v114, v104
  v_cvt_f32_f16_sdwa v115, v104 dst_sel:DWORD dst_unused:UNUSED_PAD src0_sel:WORD_1
  v_smfmac_f32_16x16x32_bf16 v[80:83], v[40:41], a[156:159], v44
  v_cvt_f32_f16 v116, v105
  v_cvt_f32_f16_sdwa v117, v105 dst_sel:DWORD dst_unused:UNUSED_PAD src0_sel:WORD_1
  v_smfmac_f32_16x16x32_bf16 v[84:87], v[40:41], a[176:179], v44
  v_cvt_pk_bf16_f32 v38, v114, v115
  v_cvt_pk_bf16_f32 v39, v116, v117
A2_106:
  v_smfmac_f32_16x16x64_bf16 v[52:55], v[32:35], a[0:7], v44
  v_smfmac_f32_16x16x64_bf16 v[52:55], v[36:39], a[8:15], v44
  v_smfmac_f32_16x16x64_bf16 v[64:67], v[32:35], a[60:67], v44
  v_smfmac_f32_16x16x64_bf16 v[64:67], v[36:39], a[68:75], v44
  v_smfmac_f32_16x16x64_bf16 v[56:59], v[32:35], a[20:27], v44
  v_smfmac_f32_16x16x64_bf16 v[56:59], v[36:39], a[28:35], v44
  v_smfmac_f32_16x16x64_bf16 v[68:71], v[32:35], a[80:87], v44
  v_permlane32_swap_b32 v52, v64
  v_permlane32_swap_b32 v53, v65
  v_permlane32_swap_b32 v54, v66
  v_smfmac_f32_16x16x64_bf16 v[68:71], v[36:39], a[88:95], v44
  v_permlane32_swap_b32 v55, v67
  v_pk_add_f32 v[52:53], v[52:53], v[64:65]
  v_pk_add_f32 v[54:55], v[54:55], v[66:67]
  v_smfmac_f32_16x16x64_bf16 v[60:63], v[32:35], a[40:47], v44
  ds_write2_b32 v5, v52, v53 offset0:0 offset1:4
  ds_write2_b32 v5, v54, v55 offset0:8 offset1:12
  v_smfmac_f32_16x16x64_bf16 v[60:63], v[36:39], a[48:55], v44
  v_smfmac_f32_16x16x64_bf16 v[72:75], v[32:35], a[100:107], v44
  v_permlane32_swap_b32 v56, v68
  v_permlane32_swap_b32 v57, v69
  v_permlane32_swap_b32 v58, v70
  v_smfmac_f32_16x16x64_bf16 v[72:75], v[36:39], a[108:115], v44
  v_permlane32_swap_b32 v59, v71
  v_pk_add_f32 v[56:57], v[56:57], v[68:69]
  v_pk_add_f32 v[58:59], v[58:59], v[70:71]
  v_smfmac_f32_16x16x64_bf16 v[76:79], v[32:35], a[120:127], v44
  ds_write2_b32 v242, v56, v57 offset0:0 offset1:4
  ds_write2_b32 v242, v58, v59 offset0:8 offset1:12
  v_smfmac_f32_16x16x64_bf16 v[76:79], v[36:39], a[128:135], v44
  v_smfmac_f32_16x16x64_bf16 v[80:83], v[32:35], a[140:147], v44
  v_permlane32_swap_b32 v60, v72
  v_permlane32_swap_b32 v61, v73
  v_permlane32_swap_b32 v62, v74
  v_smfmac_f32_16x16x64_bf16 v[80:83], v[36:39], a[148:155], v44
  v_permlane32_swap_b32 v63, v75
  v_pk_add_f32 v[60:61], v[60:61], v[72:73]
  v_pk_add_f32 v[62:63], v[62:63], v[74:75]
  v_smfmac_f32_16x16x64_bf16 v[84:87], v[32:35], a[160:167], v44
  ds_write2_b32 v243, v60, v61 offset0:0 offset1:4
  ds_write2_b32 v243, v62, v63 offset0:8 offset1:12
  v_smfmac_f32_16x16x64_bf16 v[84:87], v[36:39], a[168:175], v44
  v_permlane32_swap_b32 v76, v80
  v_permlane32_swap_b32 v77, v81
  v_permlane32_swap_b32 v78, v82
  v_permlane32_swap_b32 v79, v83
  v_pk_add_f32 v[76:77], v[76:77], v[80:81]
  v_pk_add_f32 v[78:79], v[78:79], v[82:83]
  ds_write2_b32 v244, v76, v77 offset0:0 offset1:4
  ds_write2_b32 v244, v78, v79 offset0:8 offset1:12
  ds_write2_b32 v245, v84, v85 offset0:0 offset1:4
  ds_write2_b32 v245, v86, v87 offset0:8 offset1:12
  s_waitcnt lgkmcnt(0) vmcnt(0)
  s_barrier
  s_lshr_b32 s21, 3, s20
  s_bitcmp1_b32 s21, 0
  s_cbranch_scc0 bw_108
  ds_read_b128 v[96:99], v45 offset:0
  ds_read_b128 v[108:111], v45 offset:5440
  ds_read_b128 v[100:103], v45 offset:1088
  ds_read_b128 v[112:115], v45 offset:6528
  ds_read_b128 v[104:107], v45 offset:2176
  ds_read_b128 v[116:119], v45 offset:7616
  s_waitcnt lgkmcnt(4)
  v_pk_add_f32 v[96:97], v[96:97], v[108:109]
  v_pk_add_f32 v[98:99], v[98:99], v[110:111]
  s_nop 0
  v_add_f32_dpp v108, v96, v96 row_ror:8 row_mask:0xf bank_mask:0xf
  v_add_f32_dpp v109, v97, v97 row_ror:8 row_mask:0xf bank_mask:0xf
  v_add_f32_dpp v110, v98, v98 row_ror:8 row_mask:0xf bank_mask:0xf
  v_add_f32_dpp v111, v99, v99 row_ror:8 row_mask:0xf bank_mask:0xf
  v_cvt_pk_bf16_f32 v212, v108, v109
  v_cvt_pk_bf16_f32 v213, v110, v111
  s_waitcnt lgkmcnt(2)
  v_pk_add_f32 v[100:101], v[100:101], v[112:113]
  v_pk_add_f32 v[102:103], v[102:103], v[114:115]
  s_nop 0
  v_add_f32_dpp v112, v100, v100 row_ror:8 row_mask:0xf bank_mask:0xf
  v_add_f32_dpp v113, v101, v101 row_ror:8 row_mask:0xf bank_mask:0xf
  v_add_f32_dpp v114, v102, v102 row_ror:8 row_mask:0xf bank_mask:0xf
  v_add_f32_dpp v115, v103, v103 row_ror:8 row_mask:0xf bank_mask:0xf
  v_cvt_pk_bf16_f32 v214, v112, v113
  v_cvt_pk_bf16_f32 v215, v114, v115
  s_waitcnt lgkmcnt(0)
  v_pk_add_f32 v[104:105], v[104:105], v[116:117]
  v_pk_add_f32 v[106:107], v[106:107], v[118:119]
  v_mfma_f32_16x16x32_bf16 v[96:99], v[168:171], v[212:215], 0
  v_add_f32_dpp v116, v104, v104 row_ror:8 row_mask:0xf bank_mask:0xf
  v_add_f32_dpp v117, v105, v105 row_ror:8 row_mask:0xf bank_mask:0xf
  v_add_f32_dpp v118, v106, v106 row_ror:8 row_mask:0xf bank_mask:0xf
  v_add_f32_dpp v119, v107, v107 row_ror:8 row_mask:0xf bank_mask:0xf
  v_cvt_pk_bf16_f32 v216, v116, v117
  v_cvt_pk_bf16_f32 v217, v118, v119
  s_nop 1
  v_mfma_f32_16x16x32_bf16 v[96:99], v[172:175], v[216:219], v[96:99]
  s_mov_b64 exec, s[74:75]
  s_nop 6
  v_cvt_pk_f16_f32 v100, v96, v97
  v_cvt_pk_f16_f32 v101, v98, v99
  v_and_or_b32 v100, v100, -2, s88
  s_cmp_eq_u32 s53, 1
  s_cbranch_scc1 si_109
  buffer_store_dwordx2 v[100:101], v7, s[8:11], s81 offen sc1
  s_branch si_110
si_109:
  buffer_store_dwordx2 v[100:101], v7, s[8:11], s81 offen
si_110:
  s_mov_b64 exec, -1
  s_branch bw_107
bw_108:
  s_lshr_b32 s21, 4, s20
  s_bitcmp1_b32 s21, 0
  s_cbranch_scc0 bw_111
  ds_read_b128 v[96:99], v6 offset:0
  ds_read_b128 v[108:111], v6 offset:5440
  ds_read_b128 v[120:123], v6 offset:10880
  ds_read_b128 v[132:135], v6 offset:16320
  ds_read_b128 v[100:103], v6 offset:1088
  ds_read_b128 v[112:115], v6 offset:6528
  ds_read_b128 v[124:127], v6 offset:11968
  ds_read_b128 v[136:139], v6 offset:17408
  ds_read_b128 v[104:107], v6 offset:2176
  ds_read_b128 v[116:119], v6 offset:7616
  ds_read_b128 v[128:131], v6 offset:13056
  ds_read_b128 v[140:143], v6 offset:18496
  s_waitcnt lgkmcnt(8)
  v_pk_add_f32 v[96:97], v[96:97], v[108:109]
  v_pk_add_f32 v[120:121], v[120:121], v[132:133]
  v_pk_add_f32 v[98:99], v[98:99], v[110:111]
  v_pk_add_f32 v[122:123], v[122:123], v[134:135]
  v_pk_add_f32 v[96:97], v[96:97], v[120:121]
  v_pk_add_f32 v[98:99], v[98:99], v[122:123]
  v_cvt_pk_bf16_f32 v212, v96, v97
  v_cvt_pk_bf16_f32 v213, v98, v99
  s_waitcnt lgkmcnt(4)
  v_pk_add_f32 v[100:101], v[100:101], v[112:113]
  v_pk_add_f32 v[124:125], v[124:125], v[136:137]
  v_pk_add_f32 v[102:103], v[102:103], v[114:115]
  v_pk_add_f32 v[126:127], v[126:127], v[138:139]
  v_pk_add_f32 v[100:101], v[100:101], v[124:125]
  v_pk_add_f32 v[102:103], v[102:103], v[126:127]
  v_cvt_pk_bf16_f32 v214, v100, v101
  v_cvt_pk_bf16_f32 v215, v102, v103
  s_waitcnt lgkmcnt(0)
  v_pk_add_f32 v[104:105], v[104:105], v[116:117]
  v_pk_add_f32 v[128:129], v[128:129], v[140:141]
  v_pk_add_f32 v[106:107], v[106:107], v[118:119]
  v_pk_add_f32 v[130:131], v[130:131], v[142:143]
  v_mfma_f32_16x16x32_bf16 v[96:99], v[212:215], v[212:215], 0
  v_pk_add_f32 v[104:105], v[104:105], v[128:129]
  v_pk_add_f32 v[106:107], v[106:107], v[130:131]
  v_cvt_pk_bf16_f32 v216, v104, v105
  v_cvt_pk_bf16_f32 v217, v106, v107
  s_nop 1
  v_mfma_f32_16x16x32_bf16 v[96:99], v[216:219], v[216:219], v[96:99]
  s_mov_b64 exec, s[74:75]
  s_nop 6
  v_cvt_pk_f16_f32 v100, v96, v97
  v_cvt_pk_f16_f32 v101, v98, v99
  v_and_or_b32 v100, v100, -2, s88
  s_cmp_eq_u32 s53, 1
  s_cbranch_scc1 si_112
  buffer_store_dwordx2 v[100:101], v7, s[8:11], s81 offen sc1
  s_branch si_113
si_112:
  buffer_store_dwordx2 v[100:101], v7, s[8:11], s81 offen
si_113:
  s_mov_b64 exec, -1
  s_branch bw_107
bw_111:
  s_lshr_b32 s21, 8, s20
  s_bitcmp1_b32 s21, 0
  s_cbranch_scc0 bw_114
  ds_read_b128 v[96:99], v6 offset:3264
  ds_read_b128 v[100:103], v6 offset:8704
  ds_read_b128 v[104:107], v6 offset:14144
  ds_read_b128 v[108:111], v6 offset:19584
  ds_read_b128 v[112:115], v6 offset:4352
  ds_read_b128 v[116:119], v6 offset:9792
  ds_read_b128 v[120:123], v6 offset:15232
  ds_read_b128 v[124:127], v6 offset:20672
  s_waitcnt lgkmcnt(4)
  v_pk_add_f32 v[96:97], v[96:97], v[100:101]
  v_pk_add_f32 v[98:99], v[98:99], v[102:103]
  v_pk_add_f32 v[104:105], v[104:105], v[108:109]
  v_pk_add_f32 v[106:107], v[106:107], v[110:111]
  v_pk_add_f32 v[96:97], v[96:97], v[104:105]
  v_pk_add_f32 v[98:99], v[98:99], v[106:107]
  v_cvt_pk_bf16_f32 v90, v96, v97
  v_cvt_pk_bf16_f32 v91, v98, v99
  v_min_u32 v90, -2, v90
  v_min_u32 v91, -2, v91
  s_cmp_eq_u32 s53, 1
  s_cbranch_scc1 si_115
  buffer_store_dwordx2 v[90:91], v24, s[8:11], s81 offen sc1
  s_branch si_116
si_115:
  buffer_store_dwordx2 v[90:91], v24, s[8:11], s81 offen
si_116:
  s_waitcnt lgkmcnt(0)
  v_pk_add_f32 v[112:113], v[112:113], v[116:117]
  v_pk_add_f32 v[114:115], v[114:115], v[118:119]
  v_pk_add_f32 v[120:121], v[120:121], v[124:125]
  v_pk_add_f32 v[122:123], v[122:123], v[126:127]
  v_pk_add_f32 v[112:113], v[112:113], v[120:121]
  v_pk_add_f32 v[114:115], v[114:115], v[122:123]
  s_nop 1
  v_add_f32_dpp v116, v112, v112 row_ror:8 row_mask:0xf bank_mask:0xf
  v_add_f32_dpp v117, v113, v113 row_ror:8 row_mask:0xf bank_mask:0xf
  v_add_f32_dpp v118, v114, v114 row_ror:8 row_mask:0xf bank_mask:0xf
  v_add_f32_dpp v119, v115, v115 row_ror:8 row_mask:0xf bank_mask:0xf
  v_cvt_pk_bf16_f32 v92, v116, v117
  v_cvt_pk_bf16_f32 v93, v118, v119
  v_min_u32 v92, -2, v92
  v_min_u32 v93, -2, v93
  s_mov_b64 exec, s[60:61]
  s_cmp_eq_u32 s53, 1
  s_cbranch_scc1 si_117
  buffer_store_dwordx2 v[92:93], v23, s[8:11], s78 offen sc1
  s_branch si_118
si_117:
  buffer_store_dwordx2 v[92:93], v23, s[8:11], s78 offen
si_118:
  s_mov_b64 exec, -1
  s_branch bw_107
bw_114:
bw_107:
  s_cmp_eq_u32 s52, 63
  s_cbranch_scc1 last_103
  s_mov_b32 s54, 0
pv_119:
  buffer_load_dwordx4 v[144:147], v10, s[8:11], s81 offen offset:0 sc1
  buffer_load_dwordx4 v[148:151], v10, s[8:11], s81 offen offset:1024 sc1
  buffer_load_dwordx4 v[152:155], v10, s[8:11], s81 offen offset:2048 sc1
  v_mov_b32 v188, 0
  v_mov_b32 v189, 0
  v_mov_b32 v190, 0
  v_mov_b32 v191, 0
  v_mov_b32 v192, 0
  v_mov_b32 v193, 0
  v_mov_b32 v194, 0
  v_mov_b32 v195, 0
  v_mov_b32 v196, 0
  v_mov_b32 v197, 0
  v_mov_b32 v198, 0
  v_mov_b32 v199, 0
  s_add_u32 s54, s54, 1
  s_cmp_gt_u32 s54, 131072
  s_cbranch_scc1 end0
  s_waitcnt vmcnt(0)
  v_max3_u32 v27, v144, v146, v148
  v_max3_u32 v27, v27, v150, v152
  v_max3_u32 v27, v27, v154, v154
  v_cmp_eq_u32 vcc, -1, v27
  s_nop 1
  s_cbranch_vccnz pv_119
  buffer_load_dwordx2 v[248:249], v9, s[8:11], s81 offen sc1
  buffer_load_dwordx4 v[112:115], v8, s[8:11], s81 offen offset:0 sc1
  buffer_load_dwordx4 v[116:119], v8, s[8:11], s81 offen offset:1024 sc1
  v_smfmac_f32_16x16x64_bf16 v[188:191], v[144:147], a[180:187], v44
  v_smfmac_f32_16x16x64_bf16 v[192:195], v[144:147], a[204:211], v44
  v_smfmac_f32_16x16x64_bf16 v[196:199], v[144:147], a[228:235], v44
  v_smfmac_f32_16x16x64_bf16 v[188:191], v[148:151], a[188:195], v44
  v_smfmac_f32_16x16x64_bf16 v[192:195], v[148:151], a[212:219], v44
  v_smfmac_f32_16x16x64_bf16 v[196:199], v[148:151], a[236:243], v44
  v_smfmac_f32_16x16x64_bf16 v[188:191], v[152:155], a[196:203], v44
  v_smfmac_f32_16x16x64_bf16 v[192:195], v[152:155], a[220:227], v44
  v_smfmac_f32_16x16x64_bf16 v[196:199], v[152:155], a[244:251], v44
  v_readfirstlane_b32 s21, v94
  s_add_u32 s22, s46, 8
  s_min_u32 s22, s22, 64
  s_sub_u32 s55, s21, s22
  s_sub_u32 s56, s21, s46
  s_waitcnt vmcnt(2)
  v_xor_b32 v96, s88, v248
  s_nop 0
  v_permlane16_swap_b32 v248, v249
  v_fma_mix_f32 v250, v248, 1.0, v249 op_sel:[0,0,0] op_sel_hi:[1,0,1]
  v_fma_mix_f32 v251, v248, 1.0, v249 op_sel:[1,0,1] op_sel_hi:[1,0,1]
  v_mov_b32 v248, v250
  v_mov_b32 v249, v251
  s_nop 0
  v_permlane32_swap_b32 v248, v250
  v_permlane32_swap_b32 v249, v251
  s_waitcnt vmcnt(0)
  v_bitop3_b32 v97, v112, v114, s88 bitop3:0x7e
  v_bitop3_b32 v98, v116, v118, s88 bitop3:0x7e
  v_fma_mix_f32 v120, v112, 1.0, v116 op_sel:[0,0,0] op_sel_hi:[1,0,1]
  v_or3_b32 v27, v96, v97, v98
  v_fma_mix_f32 v124, v114, 1.0, v118 op_sel:[0,0,0] op_sel_hi:[1,0,1]
  v_and_b32 v27, 1, v27
  v_fma_mix_f32 v121, v112, 1.0, v116 op_sel:[1,0,1] op_sel_hi:[1,0,1]
  v_cmp_ne_u32 vcc, 0, v27
  v_fma_mix_f32 v125, v114, 1.0, v118 op_sel:[1,0,1] op_sel_hi:[1,0,1]
  v_fma_mix_f32 v122, v113, 1.0, v117 op_sel:[0,0,0] op_sel_hi:[1,0,1]
  v_fma_mix_f32 v126, v115, 1.0, v119 op_sel:[0,0,0] op_sel_hi:[1,0,1]
  s_cbranch_vccnz psr_120
psj_121:
  s_cmp_lt_i32 s56, 0
  s_cbranch_scc1 kvw_122
kvok_123:
  buffer_load_dwordx4 v[160:163], v16, s[28:31], s64 offen offset:0 sc1
  v_fma_mix_f32 v123, v113, 1.0, v117 op_sel:[1,0,1] op_sel_hi:[1,0,1]
  buffer_load_dwordx4 v[164:167], v16, s[28:31], s65 offen offset:1024 sc1
  v_fma_mix_f32 v127, v115, 1.0, v119 op_sel:[1,0,1] op_sel_hi:[1,0,1]
  buffer_load_dwordx4 v[48:51], v16, s[28:31], s66 offen offset:2048 sc1
  v_permlane32_swap_b32 v120, v124
  v_permlane32_swap_b32 v121, v125
  v_permlane32_swap_b32 v122, v126
  s_lshr_b32 s21, 3, s20
  s_bitcmp1_b32 s21, 0
  s_cbranch_scc0 bw_125
  buffer_load_dwordx2 v[168:169], v18, s[16:19], s80 offen sc1
  s_branch bw_124
bw_125:
  s_lshr_b32 s21, 4, s20
  s_bitcmp1_b32 s21, 0
  s_cbranch_scc0 bw_126
  s_mov_b64 exec, s[62:63]
  buffer_store_dwordx2 v[212:213], v21, s[24:27], s85 offen sc1
  s_mov_b64 exec, -1
  s_branch bw_124
bw_126:
  s_lshr_b32 s21, 8, s20
  s_bitcmp1_b32 s21, 0
  s_cbranch_scc0 bw_127
  buffer_store_dwordx2 v[90:91], v25, s[24:27], s57 offen sc1
  s_branch bw_124
bw_127:
bw_124:
  v_permlane32_swap_b32 v123, v127
  v_pk_add_f32 v[120:121], v[120:121], v[124:125]
  v_pk_add_f32 v[122:123], v[122:123], v[126:127]
  s_lshr_b32 s21, 3, s20
  s_bitcmp1_b32 s21, 0
  s_cbranch_scc0 bw_129
  buffer_load_dwordx2 v[170:171], v19, s[16:19], s80 offen sc1
  s_branch bw_128
bw_129:
  s_lshr_b32 s21, 4, s20
  s_bitcmp1_b32 s21, 0
  s_cbranch_scc0 bw_130
  s_mov_b64 exec, s[62:63]
  buffer_store_dwordx2 v[214:215], v22, s[24:27], s85 offen sc1
  s_mov_b64 exec, -1
  s_branch bw_128
bw_130:
  s_lshr_b32 s21, 8, s20
  s_bitcmp1_b32 s21, 0
  s_cbranch_scc0 bw_131
  s_mov_b64 exec, s[60:61]
  buffer_store_dwordx2 v[92:93], v23, s[24:27], s57 offen sc1
  s_mov_b64 exec, -1
  s_branch bw_128
bw_131:
bw_128:
  v_pk_add_f32 v[124:125], v[248:249], v[250:251]
  v_max3_f32 v236, v120, v121, v122
  v_max3_f32 v237, v123, v124, v125
  s_lshr_b32 s21, 3, s20
  s_bitcmp1_b32 s21, 0
  s_cbranch_scc0 bw_133
  buffer_load_dwordx2 v[172:173], v20, s[16:19], s80 offen sc1
  s_branch bw_132
bw_133:
  s_lshr_b32 s21, 4, s20
  s_bitcmp1_b32 s21, 0
  s_cbranch_scc0 bw_134
  s_mov_b64 exec, s[62:63]
  buffer_store_dwordx2 v[216:217], v23, s[24:27], s85 offen sc1
  s_mov_b64 exec, -1
  s_branch bw_132
bw_134:
  s_lshr_b32 s21, 8, s20
  s_bitcmp1_b32 s21, 0
  s_cbranch_scc0 bw_135
  v_mov_b32 v240, s52
  v_mov_b32 v241, s52
  s_mov_b64 exec, 1
  buffer_store_dwordx2 v[240:241], v95, s[12:15], s90 offen sc1
  s_mov_b64 exec, -1
  s_branch bw_132
bw_135:
bw_132:
  v_max_f32 v236, v236, v237
  v_cvt_pk_bf16_f32 v228, v188, v189
  v_cvt_pk_bf16_f32 v229, v190, v191
  v_max_f32_dpp v236, v236, v236 row_ror:8 row_mask:0xf bank_mask:0xf
  v_mov_b32 v237, v236
  s_cmp_lt_i32 s55, 0
  s_cbranch_scc1 fl_136
fl_137:
  v_cvt_pk_bf16_f32 v230, v192, v193
  v_cvt_pk_bf16_f32 v231, v194, v195
  v_permlane32_swap_b32 v236, v237
  v_max_f32 v236, v236, v237
  v_mov_b32 v237, v236
  v_cvt_pk_bf16_f32 v232, v196, v197
  v_cvt_pk_bf16_f32 v233, v198, v199
  v_permlane16_swap_b32 v236, v237
  v_max_f32 v236, v236, v237
  v_mul_f32 v236, s86, v236
  v_fma_f32 v120, v120, s86, -v236
  v_fma_f32 v121, v121, s86, -v236
  v_fma_f32 v122, v122, s86, -v236
  v_fma_f32 v123, v123, s86, -v236
  v_fma_f32 v124, v124, s86, -v236
  v_fma_f32 v125, v125, s86, -v236
  v_exp_f32 v120, v120
  v_exp_f32 v121, v121
  v_exp_f32 v122, v122
  v_exp_f32 v123, v123
  v_exp_f32 v124, v124
  v_exp_f32 v125, v125
  s_mov_b64 exec, s[60:61]
  v_cvt_pk_bf16_f32 v220, v120, v121
  v_cvt_pk_bf16_f32 v221, v122, v123
  v_cvt_pk_bf16_f32 v224, v124, v125
  s_mov_b64 exec, s[62:63]
  v_cvt_pk_bf16_f32 v222, v120, v121
  v_cvt_pk_bf16_f32 v223, v122, v123
  v_cvt_pk_bf16_f32 v225, v124, v125
  s_mov_b64 exec, -1
  v_pk_add_f32 v[126:127], v[120:121], v[122:123]
  v_add_f32 v128, v124, v125
  v_mfma_f32_16x16x32_bf16 v[200:203], v[176:179], v[220:223], 0
  v_add_f32 v236, v126, v127
  v_fmac_f32 v236, v128, v89
  v_mfma_f32_16x16x32_bf16 v[204:207], v[180:183], v[220:223], 0
  v_mfma_f32_16x16x32_bf16 v[208:211], v[184:187], v[220:223], 0
  v_add_f32_dpp v236, v236, v236 row_ror:8 row_mask:0xf bank_mask:0xf
  v_mov_b32 v237, v236
  s_nop 0
  v_mfma_f32_16x16x32_bf16 v[200:203], v[228:231], v[224:227], v[200:203]
  v_mfma_f32_16x16x32_bf16 v[204:207], v[230:233], v[224:227], v[204:207]
  v_permlane32_swap_b32 v236, v237
  v_add_f32 v236, v236, v237
  v_mov_b32 v237, v236
  v_mfma_f32_16x16x32_bf16 v[208:211], v[232:235], v[224:227], v[208:211]
  s_nop 0
  v_permlane16_swap_b32 v236, v237
  v_add_f32 v236, v236, v237
  v_rcp_f32 v236, v236
  s_nop 2
  v_pk_mul_f32 v[200:201], v[200:201], v[236:237] op_sel_hi:[1,0]
  v_pk_mul_f32 v[202:203], v[202:203], v[236:237] op_sel_hi:[1,0]
  ds_write_b128 v11, v[200:203] offset:0
  v_pk_mul_f32 v[204:205], v[204:205], v[236:237] op_sel_hi:[1,0]
  v_pk_mul_f32 v[206:207], v[206:207], v[236:237] op_sel_hi:[1,0]
  ds_write_b128 v11, v[204:207] offset:1024
  v_pk_mul_f32 v[208:209], v[208:209], v[236:237] op_sel_hi:[1,0]
  v_pk_mul_f32 v[210:211], v[210:211], v[236:237] op_sel_hi:[1,0]
  ds_write_b128 v11, v[208:211] offset:2048
  s_waitcnt lgkmcnt(0)
  s_barrier
  s_lshr_b32 s21, 7, s20
  s_bitcmp1_b32 s21, 0
  s_cbranch_scc0 bw_139
  ds_read_b64 v[96:97], v12 offset:0
  ds_read_b64 v[98:99], v12 offset:128
  ds_read_b64 v[100:101], v12 offset:3072
  ds_read_b64 v[102:103], v12 offset:3200
  ds_read_b64 v[104:105], v12 offset:6144
  ds_read_b64 v[106:107], v12 offset:6272
  ds_read_b64 v[108:109], v12 offset:9216
  ds_read_b64 v[110:111], v12 offset:9344
  s_waitcnt lgkmcnt(6)
  v_pk_add_f32 v[96:97], v[96:97], v[98:99]
  s_waitcnt lgkmcnt(4)
  v_pk_add_f32 v[100:101], v[100:101], v[102:103]
  s_waitcnt lgkmcnt(2)
  v_pk_add_f32 v[104:105], v[104:105], v[106:107]
  v_pk_add_f32 v[96:97], v[96:97], v[100:101]
  s_waitcnt lgkmcnt(0)
  v_pk_add_f32 v[108:109], v[108:109], v[110:111]
  v_pk_add_f32 v[96:97], v[96:97], v[104:105]
  v_pk_add_f32 v[96:97], v[96:97], v[108:109]
  v_cvt_pk_f16_f32 v100, v96, v97
  v_perm_b32 v100, s91, v100, v14
  buffer_atomic_pk_add_f16 v100, v13, s[4:7], s3 offen
  s_branch bw_138
bw_139:
  s_lshr_b32 s21, 8, s20
  s_bitcmp1_b32 s21, 0
  s_cbranch_scc0 bw_140
  v_mov_b32 v28, -1
  v_mov_b32 v29, -1
  s_cmp_eq_u32 s53, 1
  s_cbranch_scc1 si_141
  buffer_store_dwordx2 v[28:29], v24, s[8:11], s82 offen sc1
  s_branch si_142
si_141:
  buffer_store_dwordx2 v[28:29], v24, s[8:11], s82 offen
si_142:
  s_mov_b64 exec, s[60:61]
  s_add_u32 s22, s82, 278528
  s_cmp_eq_u32 s53, 1
  s_cbranch_scc1 si_143
  buffer_store_dwordx2 v[28:29], v23, s[8:11], s22 offen sc1
  s_branch si_144
si_143:
  buffer_store_dwordx2 v[28:29], v23, s[8:11], s22 offen
si_144:
  s_and_b32 s21, s52, 7
  s_cmp_lg_u32 s21, s50
  s_cbranch_scc1 zm_145
  s_mov_b64 exec, s[70:71]
  buffer_store_dwordx4 v[156:159], v13, s[4:7], s83 offen sc1
zm_145:
  s_mov_b64 exec, -1
  s_branch bw_138
bw_140:
bw_138:
  s_add_u32 s23, s52, 2
  s_min_u32 s23, s23, 63
  s_sub_u32 s21, s23, 64
  s_mul_i32 s21, s21, 160
  s_add_u32 s21, s21, s89
  s_lshl_b32 s21, s21, 14
  s_add_u32 s64, s21, s67
  s_lshr_b32 s22, s64, 8
  s_xor_b32 s64, s64, s22
  s_xor_b32 s64, s64, s68
  s_and_b32 s64, s64, 8192
  s_add_u32 s64, s64, s21
  s_add_u32 s64, s64, 83886080
  s_mul_i32 s21, s23, 160
  s_add_u32 s21, s21, s89
  s_lshl_b32 s21, s21, 13
  s_cmp_lt_u32 s23, 64
  s_cselect_b32 s64, s21, s64
  s_add_u32 s69, s89, 1
  s_sub_u32 s21, s23, 64
  s_mul_i32 s21, s21, 160
  s_add_u32 s21, s21, s69
  s_lshl_b32 s21, s21, 14
  s_add_u32 s66, s21, s67
  s_lshr_b32 s22, s66, 8
  s_xor_b32 s66, s66, s22
  s_xor_b32 s66, s66, s68
  s_and_b32 s66, s66, 8192
  s_add_u32 s66, s66, s21
  s_add_u32 s66, s66, 83886080
  s_mul_i32 s21, s23, 160
  s_add_u32 s21, s21, s69
  s_lshl_b32 s21, s21, 13
  s_cmp_lt_u32 s23, 64
  s_cselect_b32 s66, s21, s66
  s_lshl_b32 s21, s87, 10
  s_add_u32 s64, s64, s21
  s_add_u32 s66, s66, s21
  s_sub_u32 s66, s66, 8192
  s_cmp_lt_u32 s87, 7
  s_cselect_b32 s65, s64, s66
  s_cmp_lt_u32 s87, 6
  s_cselect_b32 s66, s64, s66
  s_add_u32 s52, s52, 1
  s_and_b32 s21, s52, 3
  s_mul_i32 s81, s21, 540672
  s_lshl_b32 s84, s21, 15
  s_branch step_102
pm_104:
  s_mov_b32 s47, 1
  buffer_load_dwordx4 v[96:99], v4, s[4:7], s84 offen offset:0 sc1
  buffer_load_dwordx4 v[100:103], v4, s[4:7], s84 offen offset:1024 sc1
  buffer_load_dwordx4 v[104:107], v4, s[4:7], s84 offen offset:2048 sc1
  s_add_u32 s54, s54, 1
  s_cmp_gt_u32 s54, 131072
  s_cbranch_scc1 end0
  s_waitcnt vmcnt(0)
  v_bitop3_b32 v27, v99, v103, v107 bitop3:0x80
  v_cvt_f32_f16 v108, v99
  v_and_b32 v27, 0x48000000, v27
  v_cvt_f32_f16 v109, v103
  v_cmp_ne_u32 vcc, 0x48000000, v27
  v_cvt_f32_f16 v110, v106
  v_cvt_f32_f16_sdwa v111, v106 dst_sel:DWORD dst_unused:UNUSED_PAD src0_sel:WORD_1
  v_cvt_pk_bf16_f32 v40, v110, v111
  s_cbranch_vccnz pm_104
  s_branch pm_105
A1_39:
  v_smfmac_f32_16x16x32_bf16 v[52:55], v[40:41], a[16:19], v44
  v_smfmac_f32_16x16x32_bf16 v[64:67], v[40:41], a[76:79], v44
  v_smfmac_f32_16x16x32_bf16 v[56:59], v[40:41], a[36:39], v44
  v_smfmac_f32_16x16x32_bf16 v[68:71], v[40:41], a[96:99], v44
  v_smfmac_f32_16x16x32_bf16 v[60:63], v[40:41], a[56:59], v44
  v_smfmac_f32_16x16x32_bf16 v[72:75], v[40:41], a[116:119], v44
  v_smfmac_f32_16x16x32_bf16 v[76:79], v[40:41], a[136:139], v44
  v_smfmac_f32_16x16x32_bf16 v[80:83], v[40:41], a[156:159], v44
  v_smfmac_f32_16x16x32_bf16 v[84:87], v[40:41], a[176:179], v44
  s_branch A2_106
psr_120:
  buffer_load_dwordx2 v[248:249], v9, s[8:11], s81 offen sc1
  buffer_load_dwordx4 v[112:115], v8, s[8:11], s81 offen offset:0 sc1
  buffer_load_dwordx4 v[116:119], v8, s[8:11], s81 offen offset:1024 sc1
  s_add_u32 s54, s54, 1
  s_cmp_gt_u32 s54, 131072
  s_cbranch_scc1 end0
  s_waitcnt vmcnt(2)
  v_xor_b32 v96, s88, v248
  s_nop 0
  v_permlane16_swap_b32 v248, v249
  v_fma_mix_f32 v250, v248, 1.0, v249 op_sel:[0,0,0] op_sel_hi:[1,0,1]
  v_fma_mix_f32 v251, v248, 1.0, v249 op_sel:[1,0,1] op_sel_hi:[1,0,1]
  v_mov_b32 v248, v250
  v_mov_b32 v249, v251
  s_nop 0
  v_permlane32_swap_b32 v248, v250
  v_permlane32_swap_b32 v249, v251
  s_waitcnt vmcnt(0)
  v_bitop3_b32 v97, v112, v114, s88 bitop3:0x7e
  v_bitop3_b32 v98, v116, v118, s88 bitop3:0x7e
  v_fma_mix_f32 v120, v112, 1.0, v116 op_sel:[0,0,0] op_sel_hi:[1,0,1]
  v_or3_b32 v27, v96, v97, v98
  v_fma_mix_f32 v124, v114, 1.0, v118 op_sel:[0,0,0] op_sel_hi:[1,0,1]
  v_and_b32 v27, 1, v27
  v_fma_mix_f32 v121, v112, 1.0, v116 op_sel:[1,0,1] op_sel_hi:[1,0,1]
  v_cmp_ne_u32 vcc, 0, v27
  v_fma_mix_f32 v125, v114, 1.0, v118 op_sel:[1,0,1] op_sel_hi:[1,0,1]
  v_fma_mix_f32 v122, v113, 1.0, v117 op_sel:[0,0,0] op_sel_hi:[1,0,1]
  v_fma_mix_f32 v126, v115, 1.0, v119 op_sel:[0,0,0] op_sel_hi:[1,0,1]
  s_cbranch_vccnz psr_120
  s_branch psj_121
kvw_122:
  v_mov_b32 v236, 0
  s_mov_b32 s101, 0
wf_146:
  buffer_load_dword v237, v236, s[12:15], s79 offen sc1
  s_add_u32 s101, s101, 1
  s_cmp_gt_u32 s101, 131072
  s_cbranch_scc1 end0
  s_waitcnt vmcnt(0)
  v_readfirstlane_b32 s100, v237
  s_cmp_ge_u32 s100, s46
  s_cbranch_scc1 wf_147
  s_sleep 1
  s_branch wf_146
wf_147:
  s_branch kvok_123
fl_136:
  buffer_load_dword v94, v95, s[12:15], s79 offen sc1
  s_branch fl_137
last_103:
  s_lshr_b32 s21, 1, s20
  s_bitcmp1_b32 s21, 0
  s_cbranch_scc0 bw_149
  v_mov_b32 v246, 80
  v_mov_b32 v247, 1
  s_mov_b64 exec, 1
  buffer_atomic_add v247, v246, s[32:35], 0 offen sc0 sc1
  s_mov_b64 exec, -1
clm_150:
  s_branch bw_148
bw_149:
bw_148:
  s_lshr_b32 s21, 4, s20
  s_bitcmp1_b32 s21, 0
  s_cbranch_scc0 bw_152
  s_mov_b64 exec, s[62:63]
  buffer_store_dwordx2 v[212:213], v21, s[24:27], s85 offen sc1
  buffer_store_dwordx2 v[214:215], v22, s[24:27], s85 offen sc1
  buffer_store_dwordx2 v[216:217], v23, s[24:27], s85 offen sc1
  s_mov_b64 exec, 1
  s_waitcnt vmcnt(0)
  v_mov_b32 v236, 64
  buffer_store_dword v236, v95, s[12:15], s90 offen sc1
  s_mov_b64 exec, -1
  s_branch bw_151
bw_152:
  s_lshr_b32 s21, 8, s20
  s_bitcmp1_b32 s21, 0
  s_cbranch_scc0 bw_153
  buffer_store_dwordx2 v[90:91], v25, s[24:27], s57 offen sc1
  s_mov_b64 exec, s[60:61]
  buffer_store_dwordx2 v[92:93], v23, s[24:27], s57 offen sc1
  s_mov_b64 exec, 1
  s_waitcnt vmcnt(0)
  v_mov_b32 v236, 64
  buffer_store_dword v236, v95, s[12:15], s90 offen offset:4 sc1
  s_mov_b64 exec, -1
  s_branch bw_151
bw_153:
bw_151:
  s_branch chain_done
chain_done:
  s_waitcnt vmcnt(0) lgkmcnt(0)
  s_barrier
  s_mov_b32 s84, 0
  s_mov_b32 s85, -1
  s_mov_b32 s86, 0
  v_mov_b32 v21, 0
  v_mov_b32 v23, v247
  s_cmp_lg_u32 s20, 0
  s_cbranch_scc1 queue_b
  s_mov_b64 exec, 1
  s_branch queue_a
end0:
  s_endpgm
gemm_side:
  s_bfe_u32 s23, s22, 0x20005
  s_add_u32 s22, s22, 31
  s_and_b32 s22, s22, 31
  s_lshl_b32 s21, s23, 3
  s_add_u32 s2, s21, s22
  s_add_u32 s3, s2, 72
  s_add_u32 s24, s2, 48
  s_add_u32 s2, s2, s21
  s_cmp_lt_u32 s22, 24
  s_cselect_b32 s3, s24, s3
  s_cmp_lt_u32 s22, 16
  s_cselect_b32 s3, s2, s3
  s_mov_b32 s2, s3
  s_cmp_ge_u32 s3, 64
  s_cbranch_scc1 not_kv
  s_load_dwordx2 s[4:5], s[0:1], 0
  s_load_dwordx2 s[6:7], s[0:1], 24
  s_load_dwordx2 s[36:37], s[0:1], 32
  s_load_dwordx2 s[38:39], s[0:1], 104
  s_and_b32 s43, s3, 1
  s_bfe_u32 s42, s3, 0x50001
  s_lshr_b32 s40, s42, 2
  s_waitcnt lgkmcnt(0)
  s_cmp_eq_u32 s43, 1
  s_cselect_b32 s6, s36, s6
  s_cselect_b32 s7, s37, s7
  s_mov_b32 s8, s4
  s_mov_b32 s9, s5
  s_mov_b32 s10, 2621440
  s_mov_b32 s11, 0x00020000
  s_mov_b32 s12, s6
  s_mov_b32 s13, s7
  s_mov_b32 s14, 7864320
  s_mov_b32 s15, 0x00020000
  s_mov_b32 s16, s38
  s_mov_b32 s17, s39
  s_mov_b32 s18, 50331648
  s_mov_b32 s19, 0x00020000
  s_mul_i32 s44, s42, 384
  s_mov_b32 s24, 0
  s_mov_b32 s25, 81920
  s_mov_b32 s64, s32
  s_mov_b32 s65, s33
  s_mov_b32 s66, s34
  s_mov_b32 s67, s35
  s_load_dwordx2 s[72:73], s[0:1], 104
  s_waitcnt lgkmcnt(0)
  s_add_u32 s72, s72, 81068032
  s_addc_u32 s73, s73, 0
  s_mov_b32 s74, 115712
  s_mov_b32 s75, 0x00020000
  v_mov_b32 v9, 2731
  v_add_u32 v8, 0, v1
  v_mul_u32_u24 v7, v8, v9
  v_lshrrev_b32 v7, 16, v7
  v_mul_u32_u24 v4, 24, v7
  v_sub_u32 v8, v8, v4
  s_mov_b32 s21, 12288
  v_mul_lo_u32 v7, v7, s21
  v_lshl_add_u32 v4, v8, 4, v7
  v_add_u32 v8, 64, v1
  v_mul_u32_u24 v7, v8, v9
  v_lshrrev_b32 v7, 16, v7
  v_mul_u32_u24 v5, 24, v7
  v_sub_u32 v8, v8, v5
  s_mov_b32 s21, 12288
  v_mul_lo_u32 v7, v7, s21
  v_lshl_add_u32 v5, v8, 4, v7
  v_add_u32 v8, 128, v1
  v_mul_u32_u24 v7, v8, v9
  v_lshrrev_b32 v7, 16, v7
  v_mul_u32_u24 v6, 24, v7
  v_sub_u32 v8, v8, v6
  s_mov_b32 s21, 12288
  v_mul_lo_u32 v7, v7, s21
  v_lshl_add_u32 v6, v8, 4, v7
  v_lshrrev_b32 v7, 2, v2
  v_lshl_add_u32 v7, v3, 3, v7
  v_mul_u32_u24 v7, 384, v7
  v_and_b32 v8, 3, v2
  v_lshlrev_b32 v8, 3, v8
  s_mul_i32 s21, s20, 96
  v_add3_u32 v7, v7, v8, s21
  v_add_u32 v8, 49152, v7
  s_mul_i32 s21, s20, 393216
  s_add_u32 s21, s21, 0
  s_add_u32 s21, s21, s44
  s_mul_i32 s22, s20, 12288
  s_add_u32 s22, s22, 0
  s_add_u32 m0, s22, 0
  s_nop 0
  buffer_load_dwordx4 v4, s[12:15], s21 offen lds
  s_add_u32 m0, s22, 1024
  s_nop 0
  buffer_load_dwordx4 v5, s[12:15], s21 offen lds
  s_add_u32 m0, s22, 2048
  s_nop 0
  buffer_load_dwordx4 v6, s[12:15], s21 offen lds
  s_mul_i32 s21, s20, 393216
  s_add_u32 s21, s21, 98304
  s_add_u32 s21, s21, s44
  s_mul_i32 s22, s20, 12288
  s_add_u32 s22, s22, 3072
  s_add_u32 m0, s22, 0
  s_nop 0
  buffer_load_dwordx4 v4, s[12:15], s21 offen lds
  s_add_u32 m0, s22, 1024
  s_nop 0
  buffer_load_dwordx4 v5, s[12:15], s21 offen lds
  s_add_u32 m0, s22, 2048
  s_nop 0
  buffer_load_dwordx4 v6, s[12:15], s21 offen lds
  s_mul_i32 s21, s20, 393216
  s_add_u32 s21, s21, 196608
  s_add_u32 s21, s21, s44
  s_mul_i32 s22, s20, 12288
  s_add_u32 s22, s22, 6144
  s_add_u32 m0, s22, 0
  s_nop 0
  buffer_load_dwordx4 v4, s[12:15], s21 offen lds
  s_add_u32 m0, s22, 1024
  s_nop 0
  buffer_load_dwordx4 v5, s[12:15], s21 offen lds
  s_add_u32 m0, s22, 2048
  s_nop 0
  buffer_load_dwordx4 v6, s[12:15], s21 offen lds
  s_mul_i32 s21, s20, 393216
  s_add_u32 s21, s21, 294912
  s_add_u32 s21, s21, s44
  s_mul_i32 s22, s20, 12288
  s_add_u32 s22, s22, 9216
  s_add_u32 m0, s22, 0
  s_nop 0
  buffer_load_dwordx4 v4, s[12:15], s21 offen lds
  s_add_u32 m0, s22, 1024
  s_nop 0
  buffer_load_dwordx4 v5, s[12:15], s21 offen lds
  s_add_u32 m0, s22, 2048
  s_nop 0
  buffer_load_dwordx4 v6, s[12:15], s21 offen lds
  v_lshrrev_b32 v11, 3, v1
  v_and_b32 v12, 7, v1
  v_xor_b32 v12, v12, v11
  v_mul_u32_u24 v11, 1280, v11
  v_lshl_add_u32 v10, v12, 4, v11
  s_mul_i32 s46, s20, 20480
  v_add_u32 v10, s46, v10
  s_lshl_b32 s47, s20, 11
  s_add_u32 s47, s47, 98304
  s_add_u32 s46, s47, 57344
  s_mov_b32 s30, s24
  s_add_u32 s32, s47, 0
  v_add_u32 v11, 9216, v10
  s_mov_b32 m0, s32
  s_nop 0
  buffer_load_dwordx4 v10, s[8:11], s30 offen offset:0 lds
  buffer_load_dwordx4 v11, s[8:11], s30 offen offset:1024 lds
  s_add_u32 s30, s30, 128
  s_add_u32 s32, s32, 8192
  s_cmp_lt_u32 s32, s46
  s_cselect_b32 s32, s32, s47
  s_mov_b32 m0, s32
  s_nop 0
  buffer_load_dwordx4 v10, s[8:11], s30 offen offset:0 lds
  buffer_load_dwordx4 v11, s[8:11], s30 offen offset:1024 lds
  s_add_u32 s30, s30, 128
  s_add_u32 s32, s32, 8192
  s_cmp_lt_u32 s32, s46
  s_cselect_b32 s32, s32, s47
  s_mov_b32 m0, s32
  s_nop 0
  buffer_load_dwordx4 v10, s[8:11], s30 offen offset:0 lds
  buffer_load_dwordx4 v11, s[8:11], s30 offen offset:1024 lds
  s_add_u32 s30, s30, 128
  s_add_u32 s32, s32, 8192
  s_cmp_lt_u32 s32, s46
  s_cselect_b32 s32, s32, s47
  s_mov_b32 m0, s32
  s_nop 0
  buffer_load_dwordx4 v10, s[8:11], s30 offen offset:0 lds
  buffer_load_dwordx4 v11, s[8:11], s30 offen offset:1024 lds
  s_add_u32 s30, s30, 128
  s_add_u32 s32, s32, 8192
  s_cmp_lt_u32 s32, s46
  s_cselect_b32 s32, s32, s47
  s_mov_b32 m0, s32
  s_nop 0
  buffer_load_dwordx4 v10, s[8:11], s30 offen offset:0 lds
  buffer_load_dwordx4 v11, s[8:11], s30 offen offset:1024 lds
  s_add_u32 s30, s30, 128
  s_add_u32 s32, s32, 8192
  s_cmp_lt_u32 s32, s46
  s_cselect_b32 s32, s32, s47
  s_mul_i32 s21, s20, 393216
  s_add_u32 s21, s21, 1572864
  s_add_u32 s21, s21, s44
  s_mul_i32 s22, s20, 12288
  s_add_u32 s22, s22, 49152
  s_add_u32 m0, s22, 0
  s_nop 0
  buffer_load_dwordx4 v4, s[12:15], s21 offen lds
  s_add_u32 m0, s22, 1024
  s_nop 0
  buffer_load_dwordx4 v5, s[12:15], s21 offen lds
  s_add_u32 m0, s22, 2048
  s_nop 0
  buffer_load_dwordx4 v6, s[12:15], s21 offen lds
  s_mul_i32 s21, s20, 393216
  s_add_u32 s21, s21, 1671168
  s_add_u32 s21, s21, s44
  s_mul_i32 s22, s20, 12288
  s_add_u32 s22, s22, 52224
  s_add_u32 m0, s22, 0
  s_nop 0
  buffer_load_dwordx4 v4, s[12:15], s21 offen lds
  s_add_u32 m0, s22, 1024
  s_nop 0
  buffer_load_dwordx4 v5, s[12:15], s21 offen lds
  s_add_u32 m0, s22, 2048
  s_nop 0
  buffer_load_dwordx4 v6, s[12:15], s21 offen lds
  s_mul_i32 s21, s20, 393216
  s_add_u32 s21, s21, 1769472
  s_add_u32 s21, s21, s44
  s_mul_i32 s22, s20, 12288
  s_add_u32 s22, s22, 55296
  s_add_u32 m0, s22, 0
  s_nop 0
  buffer_load_dwordx4 v4, s[12:15], s21 offen lds
  s_add_u32 m0, s22, 1024
  s_nop 0
  buffer_load_dwordx4 v5, s[12:15], s21 offen lds
  s_add_u32 m0, s22, 2048
  s_nop 0
  buffer_load_dwordx4 v6, s[12:15], s21 offen lds
  s_mul_i32 s21, s20, 393216
  s_add_u32 s21, s21, 1867776
  s_add_u32 s21, s21, s44
  s_mul_i32 s22, s20, 12288
  s_add_u32 s22, s22, 58368
  s_add_u32 m0, s22, 0
  s_nop 0
  buffer_load_dwordx4 v4, s[12:15], s21 offen lds
  s_add_u32 m0, s22, 1024
  s_nop 0
  buffer_load_dwordx4 v5, s[12:15], s21 offen lds
  s_add_u32 m0, s22, 2048
  s_nop 0
  buffer_load_dwordx4 v6, s[12:15], s21 offen lds
  s_waitcnt vmcnt(12)
  s_barrier
  ds_read_b64_tr_b16 a[0:1], v7 offset:0
  ds_read_b64_tr_b16 a[2:3], v7 offset:1536
  ds_read_b64_tr_b16 a[4:5], v7 offset:32
  ds_read_b64_tr_b16 a[6:7], v7 offset:1568
  ds_read_b64_tr_b16 a[8:9], v7 offset:64
  ds_read_b64_tr_b16 a[10:11], v7 offset:1600
  ds_read_b64_tr_b16 a[12:13], v7 offset:12288
  ds_read_b64_tr_b16 a[14:15], v7 offset:13824
  ds_read_b64_tr_b16 a[16:17], v7 offset:12320
  ds_read_b64_tr_b16 a[18:19], v7 offset:13856
  ds_read_b64_tr_b16 a[20:21], v7 offset:12352
  ds_read_b64_tr_b16 a[22:23], v7 offset:13888
  ds_read_b64_tr_b16 a[24:25], v7 offset:24576
  ds_read_b64_tr_b16 a[26:27], v7 offset:26112
  ds_read_b64_tr_b16 a[28:29], v7 offset:24608
  ds_read_b64_tr_b16 a[30:31], v7 offset:26144
  ds_read_b64_tr_b16 a[32:33], v7 offset:24640
  ds_read_b64_tr_b16 a[34:35], v7 offset:26176
  ds_read_b64_tr_b16 a[36:37], v7 offset:36864
  ds_read_b64_tr_b16 a[38:39], v7 offset:38400
  ds_read_b64_tr_b16 a[40:41], v7 offset:36896
  ds_read_b64_tr_b16 a[42:43], v7 offset:38432
  ds_read_b64_tr_b16 a[44:45], v7 offset:36928
  ds_read_b64_tr_b16 a[46:47], v7 offset:38464
  s_waitcnt lgkmcnt(0)
  s_barrier
  s_mul_i32 s21, s20, 393216
  s_add_u32 s21, s21, 3145728
  s_add_u32 s21, s21, s44
  s_mul_i32 s22, s20, 12288
  s_add_u32 s22, s22, 0
  s_add_u32 m0, s22, 0
  s_nop 0
  buffer_load_dwordx4 v4, s[12:15], s21 offen lds
  s_add_u32 m0, s22, 1024
  s_nop 0
  buffer_load_dwordx4 v5, s[12:15], s21 offen lds
  s_add_u32 m0, s22, 2048
  s_nop 0
  buffer_load_dwordx4 v6, s[12:15], s21 offen lds
  s_mul_i32 s21, s20, 393216
  s_add_u32 s21, s21, 3244032
  s_add_u32 s21, s21, s44
  s_mul_i32 s22, s20, 12288
  s_add_u32 s22, s22, 3072
  s_add_u32 m0, s22, 0
  s_nop 0
  buffer_load_dwordx4 v4, s[12:15], s21 offen lds
  s_add_u32 m0, s22, 1024
  s_nop 0
  buffer_load_dwordx4 v5, s[12:15], s21 offen lds
  s_add_u32 m0, s22, 2048
  s_nop 0
  buffer_load_dwordx4 v6, s[12:15], s21 offen lds
  s_mul_i32 s21, s20, 393216
  s_add_u32 s21, s21, 3342336
  s_add_u32 s21, s21, s44
  s_mul_i32 s22, s20, 12288
  s_add_u32 s22, s22, 6144
  s_add_u32 m0, s22, 0
  s_nop 0
  buffer_load_dwordx4 v4, s[12:15], s21 offen lds
  s_add_u32 m0, s22, 1024
  s_nop 0
  buffer_load_dwordx4 v5, s[12:15], s21 offen lds
  s_add_u32 m0, s22, 2048
  s_nop 0
  buffer_load_dwordx4 v6, s[12:15], s21 offen lds
  s_mul_i32 s21, s20, 393216
  s_add_u32 s21, s21, 3440640
  s_add_u32 s21, s21, s44
  s_mul_i32 s22, s20, 12288
  s_add_u32 s22, s22, 9216
  s_add_u32 m0, s22, 0
  s_nop 0
  buffer_load_dwordx4 v4, s[12:15], s21 offen lds
  s_add_u32 m0, s22, 1024
  s_nop 0
  buffer_load_dwordx4 v5, s[12:15], s21 offen lds
  s_add_u32 m0, s22, 2048
  s_nop 0
  buffer_load_dwordx4 v6, s[12:15], s21 offen lds
  s_waitcnt vmcnt(12)
  s_barrier
  ds_read_b64_tr_b16 a[48:49], v8 offset:0
  ds_read_b64_tr_b16 a[50:51], v8 offset:1536
  ds_read_b64_tr_b16 a[52:53], v8 offset:32
  ds_read_b64_tr_b16 a[54:55], v8 offset:1568
  ds_read_b64_tr_b16 a[56:57], v8 offset:64
  ds_read_b64_tr_b16 a[58:59], v8 offset:1600
  ds_read_b64_tr_b16 a[60:61], v8 offset:12288
  ds_read_b64_tr_b16 a[62:63], v8 offset:13824
  ds_read_b64_tr_b16 a[64:65], v8 offset:12320
  ds_read_b64_tr_b16 a[66:67], v8 offset:13856
  ds_read_b64_tr_b16 a[68:69], v8 offset:12352
  ds_read_b64_tr_b16 a[70:71], v8 offset:13888
  ds_read_b64_tr_b16 a[72:73], v8 offset:24576
  ds_read_b64_tr_b16 a[74:75], v8 offset:26112
  ds_read_b64_tr_b16 a[76:77], v8 offset:24608
  ds_read_b64_tr_b16 a[78:79], v8 offset:26144
  ds_read_b64_tr_b16 a[80:81], v8 offset:24640
  ds_read_b64_tr_b16 a[82:83], v8 offset:26176
  ds_read_b64_tr_b16 a[84:85], v8 offset:36864
  ds_read_b64_tr_b16 a[86:87], v8 offset:38400
  ds_read_b64_tr_b16 a[88:89], v8 offset:36896
  ds_read_b64_tr_b16 a[90:91], v8 offset:38432
  ds_read_b64_tr_b16 a[92:93], v8 offset:36928
  ds_read_b64_tr_b16 a[94:95], v8 offset:38464
  s_waitcnt lgkmcnt(0)
  s_barrier
  s_mul_i32 s21, s20, 393216
  s_add_u32 s21, s21, 4718592
  s_add_u32 s21, s21, s44
  s_mul_i32 s22, s20, 12288
  s_add_u32 s22, s22, 49152
  s_add_u32 m0, s22, 0
  s_nop 0
  buffer_load_dwordx4 v4, s[12:15], s21 offen lds
  s_add_u32 m0, s22, 1024
  s_nop 0
  buffer_load_dwordx4 v5, s[12:15], s21 offen lds
  s_add_u32 m0, s22, 2048
  s_nop 0
  buffer_load_dwordx4 v6, s[12:15], s21 offen lds
  s_mul_i32 s21, s20, 393216
  s_add_u32 s21, s21, 4816896
  s_add_u32 s21, s21, s44
  s_mul_i32 s22, s20, 12288
  s_add_u32 s22, s22, 52224
  s_add_u32 m0, s22, 0
  s_nop 0
  buffer_load_dwordx4 v4, s[12:15], s21 offen lds
  s_add_u32 m0, s22, 1024
  s_nop 0
  buffer_load_dwordx4 v5, s[12:15], s21 offen lds
  s_add_u32 m0, s22, 2048
  s_nop 0
  buffer_load_dwordx4 v6, s[12:15], s21 offen lds
  s_mul_i32 s21, s20, 393216
  s_add_u32 s21, s21, 4915200
  s_add_u32 s21, s21, s44
  s_mul_i32 s22, s20, 12288
  s_add_u32 s22, s22, 55296
  s_add_u32 m0, s22, 0
  s_nop 0
  buffer_load_dwordx4 v4, s[12:15], s21 offen lds
  s_add_u32 m0, s22, 1024
  s_nop 0
  buffer_load_dwordx4 v5, s[12:15], s21 offen lds
  s_add_u32 m0, s22, 2048
  s_nop 0
  buffer_load_dwordx4 v6, s[12:15], s21 offen lds
  s_mul_i32 s21, s20, 393216
  s_add_u32 s21, s21, 5013504
  s_add_u32 s21, s21, s44
  s_mul_i32 s22, s20, 12288
  s_add_u32 s22, s22, 58368
  s_add_u32 m0, s22, 0
  s_nop 0
  buffer_load_dwordx4 v4, s[12:15], s21 offen lds
  s_add_u32 m0, s22, 1024
  s_nop 0
  buffer_load_dwordx4 v5, s[12:15], s21 offen lds
  s_add_u32 m0, s22, 2048
  s_nop 0
  buffer_load_dwordx4 v6, s[12:15], s21 offen lds
  v_mov_b32 v29, 76
  buffer_load_dword v29, v29, s[64:67], 0 offen sc1
  s_waitcnt vmcnt(12)
  s_barrier
  ds_read_b64_tr_b16 a[96:97], v7 offset:0
  ds_read_b64_tr_b16 a[98:99], v7 offset:1536
  ds_read_b64_tr_b16 a[100:101], v7 offset:32
  ds_read_b64_tr_b16 a[102:103], v7 offset:1568
  ds_read_b64_tr_b16 a[104:105], v7 offset:64
  ds_read_b64_tr_b16 a[106:107], v7 offset:1600
  ds_read_b64_tr_b16 a[108:109], v7 offset:12288
  ds_read_b64_tr_b16 a[110:111], v7 offset:13824
  ds_read_b64_tr_b16 a[112:113], v7 offset:12320
  ds_read_b64_tr_b16 a[114:115], v7 offset:13856
  ds_read_b64_tr_b16 a[116:117], v7 offset:12352
  ds_read_b64_tr_b16 a[118:119], v7 offset:13888
  ds_read_b64_tr_b16 a[120:121], v7 offset:24576
  ds_read_b64_tr_b16 a[122:123], v7 offset:26112
  ds_read_b64_tr_b16 a[124:125], v7 offset:24608
  ds_read_b64_tr_b16 a[126:127], v7 offset:26144
  ds_read_b64_tr_b16 a[128:129], v7 offset:24640
  ds_read_b64_tr_b16 a[130:131], v7 offset:26176
  ds_read_b64_tr_b16 a[132:133], v7 offset:36864
  ds_read_b64_tr_b16 a[134:135], v7 offset:38400
  ds_read_b64_tr_b16 a[136:137], v7 offset:36896
  ds_read_b64_tr_b16 a[138:139], v7 offset:38432
  ds_read_b64_tr_b16 a[140:141], v7 offset:36928
  ds_read_b64_tr_b16 a[142:143], v7 offset:38464
  s_waitcnt lgkmcnt(0)
  s_barrier
  s_mul_i32 s21, s20, 393216
  s_add_u32 s21, s21, 6291456
  s_add_u32 s21, s21, s44
  s_mul_i32 s22, s20, 12288
  s_add_u32 s22, s22, 0
  s_add_u32 m0, s22, 0
  s_nop 0
  buffer_load_dwordx4 v4, s[12:15], s21 offen lds
  s_add_u32 m0, s22, 1024
  s_nop 0
  buffer_load_dwordx4 v5, s[12:15], s21 offen lds
  s_add_u32 m0, s22, 2048
  s_nop 0
  buffer_load_dwordx4 v6, s[12:15], s21 offen lds
  s_mul_i32 s21, s20, 393216
  s_add_u32 s21, s21, 6389760
  s_add_u32 s21, s21, s44
  s_mul_i32 s22, s20, 12288
  s_add_u32 s22, s22, 3072
  s_add_u32 m0, s22, 0
  s_nop 0
  buffer_load_dwordx4 v4, s[12:15], s21 offen lds
  s_add_u32 m0, s22, 1024
  s_nop 0
  buffer_load_dwordx4 v5, s[12:15], s21 offen lds
  s_add_u32 m0, s22, 2048
  s_nop 0
  buffer_load_dwordx4 v6, s[12:15], s21 offen lds
  s_mul_i32 s21, s20, 393216
  s_add_u32 s21, s21, 6488064
  s_add_u32 s21, s21, s44
  s_mul_i32 s22, s20, 12288
  s_add_u32 s22, s22, 6144
  s_add_u32 m0, s22, 0
  s_nop 0
  buffer_load_dwordx4 v4, s[12:15], s21 offen lds
  s_add_u32 m0, s22, 1024
  s_nop 0
  buffer_load_dwordx4 v5, s[12:15], s21 offen lds
  s_add_u32 m0, s22, 2048
  s_nop 0
  buffer_load_dwordx4 v6, s[12:15], s21 offen lds
  s_mul_i32 s21, s20, 393216
  s_add_u32 s21, s21, 6586368
  s_add_u32 s21, s21, s44
  s_mul_i32 s22, s20, 12288
  s_add_u32 s22, s22, 9216
  s_add_u32 m0, s22, 0
  s_nop 0
  buffer_load_dwordx4 v4, s[12:15], s21 offen lds
  s_add_u32 m0, s22, 1024
  s_nop 0
  buffer_load_dwordx4 v5, s[12:15], s21 offen lds
  s_add_u32 m0, s22, 2048
  s_nop 0
  buffer_load_dwordx4 v6, s[12:15], s21 offen lds
  s_waitcnt vmcnt(12)
  s_barrier
  ds_read_b64_tr_b16 a[144:145], v8 offset:0
  ds_read_b64_tr_b16 a[146:147], v8 offset:1536
  ds_read_b64_tr_b16 a[148:149], v8 offset:32
  ds_read_b64_tr_b16 a[150:151], v8 offset:1568
  ds_read_b64_tr_b16 a[152:153], v8 offset:64
  ds_read_b64_tr_b16 a[154:155], v8 offset:1600
  ds_read_b64_tr_b16 a[156:157], v8 offset:12288
  ds_read_b64_tr_b16 a[158:159], v8 offset:13824
  ds_read_b64_tr_b16 a[160:161], v8 offset:12320
  ds_read_b64_tr_b16 a[162:163], v8 offset:13856
  ds_read_b64_tr_b16 a[164:165], v8 offset:12352
  ds_read_b64_tr_b16 a[166:167], v8 offset:13888
  ds_read_b64_tr_b16 a[168:169], v8 offset:24576
  ds_read_b64_tr_b16 a[170:171], v8 offset:26112
  ds_read_b64_tr_b16 a[172:173], v8 offset:24608
  ds_read_b64_tr_b16 a[174:175], v8 offset:26144
  ds_read_b64_tr_b16 a[176:177], v8 offset:24640
  ds_read_b64_tr_b16 a[178:179], v8 offset:26176
  ds_read_b64_tr_b16 a[180:181], v8 offset:36864
  ds_read_b64_tr_b16 a[182:183], v8 offset:38400
  ds_read_b64_tr_b16 a[184:185], v8 offset:36896
  ds_read_b64_tr_b16 a[186:187], v8 offset:38432
  ds_read_b64_tr_b16 a[188:189], v8 offset:36928
  ds_read_b64_tr_b16 a[190:191], v8 offset:38464
  s_waitcnt lgkmcnt(0)
  s_barrier
  s_waitcnt vmcnt(0)
  s_barrier
  ds_read_b64_tr_b16 a[192:193], v7 offset:0
  ds_read_b64_tr_b16 a[194:195], v7 offset:1536
  ds_read_b64_tr_b16 a[196:197], v7 offset:32
  ds_read_b64_tr_b16 a[198:199], v7 offset:1568
  ds_read_b64_tr_b16 a[200:201], v7 offset:64
  ds_read_b64_tr_b16 a[202:203], v7 offset:1600
  ds_read_b64_tr_b16 a[204:205], v7 offset:12288
  ds_read_b64_tr_b16 a[206:207], v7 offset:13824
  ds_read_b64_tr_b16 a[208:209], v7 offset:12320
  ds_read_b64_tr_b16 a[210:211], v7 offset:13856
  ds_read_b64_tr_b16 a[212:213], v7 offset:12352
  ds_read_b64_tr_b16 a[214:215], v7 offset:13888
  ds_read_b64_tr_b16 a[216:217], v7 offset:24576
  ds_read_b64_tr_b16 a[218:219], v7 offset:26112
  ds_read_b64_tr_b16 a[220:221], v7 offset:24608
  ds_read_b64_tr_b16 a[222:223], v7 offset:26144
  ds_read_b64_tr_b16 a[224:225], v7 offset:24640
  ds_read_b64_tr_b16 a[226:227], v7 offset:26176
  ds_read_b64_tr_b16 a[228:229], v7 offset:36864
  ds_read_b64_tr_b16 a[230:231], v7 offset:38400
  ds_read_b64_tr_b16 a[232:233], v7 offset:36896
  ds_read_b64_tr_b16 a[234:235], v7 offset:38432
  ds_read_b64_tr_b16 a[236:237], v7 offset:36928
  ds_read_b64_tr_b16 a[238:239], v7 offset:38464
  s_waitcnt lgkmcnt(0)
  s_barrier
  s_mov_b32 s26, 4
  s_mul_i32 s27, s42, 12288
  s_mul_i32 s21, s43, 25165824
  s_add_u32 s27, s27, s21
  s_mov_b32 s28, 786432
  v_readfirstlane_b32 s21, v29
  s_cmp_lg_u32 s21, 0
  s_cbranch_scc1 kvz_154
  s_mov_b32 s21, 76
  v_mov_b32 v4, 0
  s_mov_b32 s101, 0
wf_155:
  buffer_load_dword v5, v4, s[64:67], s21 offen sc1
  s_add_u32 s101, s101, 1
  s_cmp_gt_u32 s101, 131072
  s_cbranch_scc1 main_end
  s_waitcnt vmcnt(0)
  v_readfirstlane_b32 s100, v5
  s_cmp_ge_u32 s100, 1
  s_cbranch_scc1 wf_156
  s_sleep 8
  s_branch wf_155
wf_156:
kvz_154:
  s_lshl_b32 s60, s40, 7
  s_add_u32 s60, s60, 0
  s_mov_b32 s61, 0
  v_and_b32 v6, 7, v2
  v_add_u32 v4, 0, v3
  v_xor_b32 v4, v4, v6
  v_lshlrev_b32 v4, 4, v4
  v_lshl_add_u32 v14, v2, 7, v4
  v_add_u32 v4, 4, v3
  v_xor_b32 v4, v4, v6
  v_lshlrev_b32 v4, 4, v4
  v_lshl_add_u32 v15, v2, 7, v4
  v_mul_u32_u24 v22, 400, v2
  v_mul_u32_u24 v4, 24, v3
  s_mul_i32 s21, s20, 96
  s_add_u32 s21, s21, 0
  v_add3_u32 v22, v22, v4, s21
  v_mov_b32 v9, 2731
  s_mul_i32 s21, s20, 6400
  s_add_u32 s21, s21, 0
  v_mul_u32_u24 v4, 400, v2
  v_lshlrev_b32 v5, 4, v3
  v_add3_u32 v23, v4, v5, s21
  v_lshlrev_b32 v26, 4, v1
  s_mov_b32 s33, 98304
  s_mov_b32 s48, 0x80000000
  s_mov_b32 m0, s32
  s_nop 0
  buffer_load_dwordx4 v10, s[8:11], s30 offen offset:0 lds
  s_waitcnt vmcnt(9)
  s_barrier
  v_add_u32 v18, s33, v14
  v_add_u32 v19, s33, v15
  s_add_u32 s33, s33, 8192
  s_cmp_lt_u32 s33, 155648
  s_cselect_b32 s33, s33, 98304
  ds_read_b128 v[160:163], v18 offset:0
  ds_read_b128 v[164:167], v18 offset:2048
  ds_read_b128 v[168:171], v18 offset:4096
  ds_read_b128 v[172:175], v18 offset:6144
  s_waitcnt lgkmcnt(0)
kvm_blk_159:
  v_mfma_f32_16x16x32_bf16 v[64:67], a[0:3], v[160:163], 0
  ds_read_b128 v[192:195], v19 offset:0
  v_mfma_f32_16x16x32_bf16 v[68:71], a[4:7], v[160:163], 0
  v_add_u32 v18, s33, v14
  v_mfma_f32_16x16x32_bf16 v[72:75], a[8:11], v[160:163], 0
  v_mfma_f32_16x16x32_bf16 v[76:79], a[0:3], v[164:167], 0
  ds_read_b128 v[196:199], v19 offset:2048
  v_mfma_f32_16x16x32_bf16 v[80:83], a[4:7], v[164:167], 0
  buffer_load_dwordx4 v11, s[8:11], s30 offen offset:1024 lds
  v_mfma_f32_16x16x32_bf16 v[84:87], a[8:11], v[164:167], 0
  s_waitcnt lgkmcnt(10)
  s_add_u32 s30, s30, 128
  v_mfma_f32_16x16x32_bf16 v[88:91], a[0:3], v[168:171], 0
  ds_read_b128 v[200:203], v19 offset:4096
  s_add_u32 m0, m0, 8192
  v_mfma_f32_16x16x32_bf16 v[92:95], a[4:7], v[168:171], 0
  s_cmp_lt_u32 m0, s46
  s_cselect_b32 m0, m0, s47
  v_mfma_f32_16x16x32_bf16 v[96:99], a[8:11], v[168:171], 0
  v_mfma_f32_16x16x32_bf16 v[100:103], a[0:3], v[172:175], 0
  ds_read_b128 v[204:207], v19 offset:6144
  v_mfma_f32_16x16x32_bf16 v[104:107], a[4:7], v[172:175], 0
  v_mfma_f32_16x16x32_bf16 v[108:111], a[8:11], v[172:175], 0
  s_waitcnt vmcnt(8) lgkmcnt(2)
  s_barrier
  v_mfma_f32_16x16x32_bf16 v[64:67], a[12:15], v[192:195], v[64:67]
  ds_read_b128 v[160:163], v18 offset:0
  v_mfma_f32_16x16x32_bf16 v[68:71], a[16:19], v[192:195], v[68:71]
  ds_read_b128 v[224:227], v23 offset:0
  v_mfma_f32_16x16x32_bf16 v[72:75], a[20:23], v[192:195], v[72:75]
  v_add_u32 v19, s33, v15
  s_add_u32 s33, s33, 8192
  v_mfma_f32_16x16x32_bf16 v[76:79], a[12:15], v[196:199], v[76:79]
  ds_read_b128 v[164:167], v18 offset:2048
  v_mfma_f32_16x16x32_bf16 v[80:83], a[16:19], v[196:199], v[80:83]
  buffer_load_dwordx4 v10, s[8:11], s30 offen offset:0 lds
  v_mfma_f32_16x16x32_bf16 v[84:87], a[20:23], v[196:199], v[84:87]
  s_waitcnt lgkmcnt(3)
  ds_read_b128 v[228:231], v23 offset:64
  v_mfma_f32_16x16x32_bf16 v[88:91], a[12:15], v[200:203], v[88:91]
  ds_read_b128 v[168:171], v18 offset:4096
  v_mfma_f32_16x16x32_bf16 v[92:95], a[16:19], v[200:203], v[92:95]
  s_cmp_lt_u32 s33, 155648
  s_cselect_b32 s33, s33, 98304
  v_mfma_f32_16x16x32_bf16 v[96:99], a[20:23], v[200:203], v[96:99]
  v_mfma_f32_16x16x32_bf16 v[100:103], a[12:15], v[204:207], v[100:103]
  ds_read_b128 v[172:175], v18 offset:6144
  v_mfma_f32_16x16x32_bf16 v[104:107], a[16:19], v[204:207], v[104:107]
  v_mfma_f32_16x16x32_bf16 v[108:111], a[20:23], v[204:207], v[108:111]
  s_waitcnt lgkmcnt(3)
  v_mfma_f32_16x16x32_bf16 v[64:67], a[24:27], v[160:163], v[64:67]
  ds_read_b128 v[192:195], v19 offset:0
  v_mfma_f32_16x16x32_bf16 v[68:71], a[28:31], v[160:163], v[68:71]
  v_add_u32 v18, s33, v14
  ds_read_b128 v[232:235], v23 offset:128
  v_mfma_f32_16x16x32_bf16 v[72:75], a[32:35], v[160:163], v[72:75]
  v_mfma_f32_16x16x32_bf16 v[76:79], a[24:27], v[164:167], v[76:79]
  ds_read_b128 v[196:199], v19 offset:2048
  v_mfma_f32_16x16x32_bf16 v[80:83], a[28:31], v[164:167], v[80:83]
  buffer_load_dwordx4 v11, s[8:11], s30 offen offset:1024 lds
  s_add_u32 s21, s48, 0
  v_mfma_f32_16x16x32_bf16 v[84:87], a[32:35], v[164:167], v[84:87]
  s_waitcnt lgkmcnt(3)
  s_add_u32 s30, s30, 128
  v_mfma_f32_16x16x32_bf16 v[88:91], a[24:27], v[168:171], v[88:91]
  ds_read_b128 v[200:203], v19 offset:4096
  s_add_u32 m0, m0, 8192
  v_mfma_f32_16x16x32_bf16 v[92:95], a[28:31], v[168:171], v[92:95]
  s_cmp_lt_u32 m0, s46
  s_cselect_b32 m0, m0, s47
  buffer_store_dwordx4 v[224:227], v26, s[16:19], s21 offen offset:0 sc1
  v_mfma_f32_16x16x32_bf16 v[96:99], a[32:35], v[168:171], v[96:99]
  ds_read_b128 v[236:239], v23 offset:192
  v_mfma_f32_16x16x32_bf16 v[100:103], a[24:27], v[172:175], v[100:103]
  ds_read_b128 v[204:207], v19 offset:6144
  v_mfma_f32_16x16x32_bf16 v[104:107], a[28:31], v[172:175], v[104:107]
  buffer_store_dwordx4 v[228:231], v26, s[16:19], s21 offen offset:1024 sc1
  v_mfma_f32_16x16x32_bf16 v[108:111], a[32:35], v[172:175], v[108:111]
  s_waitcnt vmcnt(10) lgkmcnt(3)
  s_barrier
  v_mfma_f32_16x16x32_bf16 v[64:67], a[36:39], v[192:195], v[64:67]
  ds_read_b128 v[160:163], v18 offset:0
  v_mfma_f32_16x16x32_bf16 v[68:71], a[40:43], v[192:195], v[68:71]
  ds_read_b128 v[240:243], v23 offset:256
  v_mfma_f32_16x16x32_bf16 v[72:75], a[44:47], v[192:195], v[72:75]
  v_add_u32 v19, s33, v15
  s_add_u32 s33, s33, 8192
  v_mfma_f32_16x16x32_bf16 v[76:79], a[36:39], v[196:199], v[76:79]
  ds_read_b128 v[164:167], v18 offset:2048
  v_mfma_f32_16x16x32_bf16 v[80:83], a[40:43], v[196:199], v[80:83]
  buffer_load_dwordx4 v10, s[8:11], s30 offen offset:0 lds
  v_mfma_f32_16x16x32_bf16 v[84:87], a[44:47], v[196:199], v[84:87]
  s_waitcnt lgkmcnt(3)
  ds_read_b128 v[244:247], v23 offset:320
  v_mfma_f32_16x16x32_bf16 v[88:91], a[36:39], v[200:203], v[88:91]
  ds_read_b128 v[168:171], v18 offset:4096
  v_mfma_f32_16x16x32_bf16 v[92:95], a[40:43], v[200:203], v[92:95]
  s_cmp_lt_u32 s33, 155648
  s_cselect_b32 s33, s33, 98304
  buffer_store_dwordx4 v[232:235], v26, s[16:19], s21 offen offset:2048 sc1
  v_mfma_f32_16x16x32_bf16 v[96:99], a[44:47], v[200:203], v[96:99]
  v_mfma_f32_16x16x32_bf16 v[100:103], a[36:39], v[204:207], v[100:103]
  ds_read_b128 v[172:175], v18 offset:6144
  v_mfma_f32_16x16x32_bf16 v[104:107], a[40:43], v[204:207], v[104:107]
  buffer_store_dwordx4 v[236:239], v26, s[16:19], s21 offen offset:3072 sc1
  v_mfma_f32_16x16x32_bf16 v[108:111], a[44:47], v[204:207], v[108:111]
  s_waitcnt lgkmcnt(3)
  v_mfma_f32_16x16x32_bf16 v[64:67], a[48:51], v[160:163], v[64:67]
  ds_read_b128 v[192:195], v19 offset:0
  v_mfma_f32_16x16x32_bf16 v[68:71], a[52:55], v[160:163], v[68:71]
  v_add_u32 v18, s33, v14
  v_mfma_f32_16x16x32_bf16 v[72:75], a[56:59], v[160:163], v[72:75]
  v_mfma_f32_16x16x32_bf16 v[76:79], a[48:51], v[164:167], v[76:79]
  ds_read_b128 v[196:199], v19 offset:2048
  v_mfma_f32_16x16x32_bf16 v[80:83], a[52:55], v[164:167], v[80:83]
  buffer_load_dwordx4 v11, s[8:11], s30 offen offset:1024 lds
  s_add_u32 s21, s48, 4096
  v_mfma_f32_16x16x32_bf16 v[84:87], a[56:59], v[164:167], v[84:87]
  s_waitcnt lgkmcnt(2)
  s_add_u32 s30, s30, 128
  v_mfma_f32_16x16x32_bf16 v[88:91], a[48:51], v[168:171], v[88:91]
  ds_read_b128 v[200:203], v19 offset:4096
  s_add_u32 m0, m0, 8192
  v_mfma_f32_16x16x32_bf16 v[92:95], a[52:55], v[168:171], v[92:95]
  s_cmp_lt_u32 m0, s46
  s_cselect_b32 m0, m0, s47
  buffer_store_dwordx4 v[240:243], v26, s[16:19], s21 offen offset:0 sc1
  v_mfma_f32_16x16x32_bf16 v[96:99], a[56:59], v[168:171], v[96:99]
  v_mfma_f32_16x16x32_bf16 v[100:103], a[48:51], v[172:175], v[100:103]
  ds_read_b128 v[204:207], v19 offset:6144
  v_mfma_f32_16x16x32_bf16 v[104:107], a[52:55], v[172:175], v[104:107]
  buffer_store_dwordx4 v[244:247], v26, s[16:19], s21 offen offset:1024 sc1
  v_mfma_f32_16x16x32_bf16 v[108:111], a[56:59], v[172:175], v[108:111]
  s_waitcnt vmcnt(14) lgkmcnt(2)
  s_barrier
  v_mfma_f32_16x16x32_bf16 v[64:67], a[60:63], v[192:195], v[64:67]
  ds_read_b128 v[160:163], v18 offset:0
  v_mfma_f32_16x16x32_bf16 v[68:71], a[64:67], v[192:195], v[68:71]
  v_mfma_f32_16x16x32_bf16 v[72:75], a[68:71], v[192:195], v[72:75]
  v_add_u32 v19, s33, v15
  s_add_u32 s33, s33, 8192
  v_mfma_f32_16x16x32_bf16 v[76:79], a[60:63], v[196:199], v[76:79]
  ds_read_b128 v[164:167], v18 offset:2048
  v_mfma_f32_16x16x32_bf16 v[80:83], a[64:67], v[196:199], v[80:83]
  buffer_load_dwordx4 v10, s[8:11], s30 offen offset:0 lds
  v_mfma_f32_16x16x32_bf16 v[84:87], a[68:71], v[196:199], v[84:87]
  s_waitcnt lgkmcnt(2)
  v_mfma_f32_16x16x32_bf16 v[88:91], a[60:63], v[200:203], v[88:91]
  ds_read_b128 v[168:171], v18 offset:4096
  v_mfma_f32_16x16x32_bf16 v[92:95], a[64:67], v[200:203], v[92:95]
  s_cmp_lt_u32 s33, 155648
  s_cselect_b32 s33, s33, 98304
  v_mfma_f32_16x16x32_bf16 v[96:99], a[68:71], v[200:203], v[96:99]
  v_mfma_f32_16x16x32_bf16 v[100:103], a[60:63], v[204:207], v[100:103]
  ds_read_b128 v[172:175], v18 offset:6144
  v_mfma_f32_16x16x32_bf16 v[104:107], a[64:67], v[204:207], v[104:107]
  v_mfma_f32_16x16x32_bf16 v[108:111], a[68:71], v[204:207], v[108:111]
  s_waitcnt lgkmcnt(2)
  v_mfma_f32_16x16x32_bf16 v[64:67], a[72:75], v[160:163], v[64:67]
  ds_read_b128 v[192:195], v19 offset:0
  v_mfma_f32_16x16x32_bf16 v[68:71], a[76:79], v[160:163], v[68:71]
  v_add_u32 v18, s33, v14
  v_mfma_f32_16x16x32_bf16 v[72:75], a[80:83], v[160:163], v[72:75]
  v_mfma_f32_16x16x32_bf16 v[76:79], a[72:75], v[164:167], v[76:79]
  ds_read_b128 v[196:199], v19 offset:2048
  v_mfma_f32_16x16x32_bf16 v[80:83], a[76:79], v[164:167], v[80:83]
  buffer_load_dwordx4 v11, s[8:11], s30 offen offset:1024 lds
  v_mfma_f32_16x16x32_bf16 v[84:87], a[80:83], v[164:167], v[84:87]
  s_waitcnt lgkmcnt(2)
  s_add_u32 s30, s30, 128
  v_mfma_f32_16x16x32_bf16 v[88:91], a[72:75], v[168:171], v[88:91]
  ds_read_b128 v[200:203], v19 offset:4096
  s_add_u32 m0, m0, 8192
  v_mfma_f32_16x16x32_bf16 v[92:95], a[76:79], v[168:171], v[92:95]
  s_cmp_lt_u32 m0, s46
  s_cselect_b32 m0, m0, s47
  v_mfma_f32_16x16x32_bf16 v[96:99], a[80:83], v[168:171], v[96:99]
  v_mfma_f32_16x16x32_bf16 v[100:103], a[72:75], v[172:175], v[100:103]
  ds_read_b128 v[204:207], v19 offset:6144
  v_mfma_f32_16x16x32_bf16 v[104:107], a[76:79], v[172:175], v[104:107]
  v_mfma_f32_16x16x32_bf16 v[108:111], a[80:83], v[172:175], v[108:111]
  s_waitcnt vmcnt(14) lgkmcnt(2)
  s_barrier
  v_mfma_f32_16x16x32_bf16 v[64:67], a[84:87], v[192:195], v[64:67]
  ds_read_b128 v[160:163], v18 offset:0
  v_mfma_f32_16x16x32_bf16 v[68:71], a[88:91], v[192:195], v[68:71]
  v_mfma_f32_16x16x32_bf16 v[72:75], a[92:95], v[192:195], v[72:75]
  v_add_u32 v19, s33, v15
  s_add_u32 s33, s33, 8192
  v_mfma_f32_16x16x32_bf16 v[76:79], a[84:87], v[196:199], v[76:79]
  ds_read_b128 v[164:167], v18 offset:2048
  v_mfma_f32_16x16x32_bf16 v[80:83], a[88:91], v[196:199], v[80:83]
  buffer_load_dwordx4 v10, s[8:11], s30 offen offset:0 lds
  v_mfma_f32_16x16x32_bf16 v[84:87], a[92:95], v[196:199], v[84:87]
  s_waitcnt lgkmcnt(2)
  v_mfma_f32_16x16x32_bf16 v[88:91], a[84:87], v[200:203], v[88:91]
  ds_read_b128 v[168:171], v18 offset:4096
  v_mfma_f32_16x16x32_bf16 v[92:95], a[88:91], v[200:203], v[92:95]
  s_cmp_lt_u32 s33, 155648
  s_cselect_b32 s33, s33, 98304
  v_mfma_f32_16x16x32_bf16 v[96:99], a[92:95], v[200:203], v[96:99]
  v_mfma_f32_16x16x32_bf16 v[100:103], a[84:87], v[204:207], v[100:103]
  ds_read_b128 v[172:175], v18 offset:6144
  v_mfma_f32_16x16x32_bf16 v[104:107], a[88:91], v[204:207], v[104:107]
  v_mfma_f32_16x16x32_bf16 v[108:111], a[92:95], v[204:207], v[108:111]
  s_waitcnt lgkmcnt(2)
  v_mfma_f32_16x16x32_bf16 v[64:67], a[96:99], v[160:163], v[64:67]
  ds_read_b128 v[192:195], v19 offset:0
  v_mfma_f32_16x16x32_bf16 v[68:71], a[100:103], v[160:163], v[68:71]
  v_add_u32 v18, s33, v14
  v_mfma_f32_16x16x32_bf16 v[72:75], a[104:107], v[160:163], v[72:75]
  v_mfma_f32_16x16x32_bf16 v[76:79], a[96:99], v[164:167], v[76:79]
  ds_read_b128 v[196:199], v19 offset:2048
  v_mfma_f32_16x16x32_bf16 v[80:83], a[100:103], v[164:167], v[80:83]
  buffer_load_dwordx4 v11, s[8:11], s30 offen offset:1024 lds
  v_mfma_f32_16x16x32_bf16 v[84:87], a[104:107], v[164:167], v[84:87]
  s_waitcnt lgkmcnt(2)
  s_add_u32 s30, s30, s25
  v_mfma_f32_16x16x32_bf16 v[88:91], a[96:99], v[168:171], v[88:91]
  ds_read_b128 v[200:203], v19 offset:4096
  s_sub_u32 s30, s30, 1152
  v_mfma_f32_16x16x32_bf16 v[92:95], a[100:103], v[168:171], v[92:95]
  s_add_u32 m0, m0, 8192
  v_mfma_f32_16x16x32_bf16 v[96:99], a[104:107], v[168:171], v[96:99]
  s_cmp_lt_u32 m0, s46
  s_cselect_b32 m0, m0, s47
  v_mfma_f32_16x16x32_bf16 v[100:103], a[96:99], v[172:175], v[100:103]
  ds_read_b128 v[204:207], v19 offset:6144
  v_mfma_f32_16x16x32_bf16 v[104:107], a[100:103], v[172:175], v[104:107]
  v_mfma_f32_16x16x32_bf16 v[108:111], a[104:107], v[172:175], v[108:111]
  s_waitcnt vmcnt(4) lgkmcnt(2)
  s_barrier
  v_mfma_f32_16x16x32_bf16 v[64:67], a[108:111], v[192:195], v[64:67]
  ds_read_b128 v[160:163], v18 offset:0
  v_mfma_f32_16x16x32_bf16 v[68:71], a[112:115], v[192:195], v[68:71]
  s_cmp_eq_u32 s48, 0x80000000
  s_cbranch_scc1 kvm_157
  s_cmp_lg_u32 s20, 0
  s_cbranch_scc1 af_158
  v_mov_b32 v4, 0
  v_mov_b32 v5, 1
  s_mov_b64 exec, 1
  buffer_atomic_add v5, v4, s[72:75], s61 offen sc1
  s_mov_b64 exec, -1
  s_nop 1
af_158:
kvm_157:
  v_mfma_f32_16x16x32_bf16 v[72:75], a[116:119], v[192:195], v[72:75]
  v_add_u32 v19, s33, v15
  s_add_u32 s33, s33, 8192
  v_mfma_f32_16x16x32_bf16 v[76:79], a[108:111], v[196:199], v[76:79]
  ds_read_b128 v[164:167], v18 offset:2048
  v_mfma_f32_16x16x32_bf16 v[80:83], a[112:115], v[196:199], v[80:83]
  buffer_load_dwordx4 v10, s[8:11], s30 offen offset:0 lds
  v_mfma_f32_16x16x32_bf16 v[84:87], a[116:119], v[196:199], v[84:87]
  s_waitcnt lgkmcnt(2)
  v_mfma_f32_16x16x32_bf16 v[88:91], a[108:111], v[200:203], v[88:91]
  ds_read_b128 v[168:171], v18 offset:4096
  v_mfma_f32_16x16x32_bf16 v[92:95], a[112:115], v[200:203], v[92:95]
  s_cmp_lt_u32 s33, 155648
  s_cselect_b32 s33, s33, 98304
  v_mfma_f32_16x16x32_bf16 v[96:99], a[116:119], v[200:203], v[96:99]
  v_mfma_f32_16x16x32_bf16 v[100:103], a[108:111], v[204:207], v[100:103]
  ds_read_b128 v[172:175], v18 offset:6144
  v_mfma_f32_16x16x32_bf16 v[104:107], a[112:115], v[204:207], v[104:107]
  v_mfma_f32_16x16x32_bf16 v[108:111], a[116:119], v[204:207], v[108:111]
  s_waitcnt lgkmcnt(2)
  v_mfma_f32_16x16x32_bf16 v[64:67], a[120:123], v[160:163], v[64:67]
  ds_read_b128 v[192:195], v19 offset:0
  v_mfma_f32_16x16x32_bf16 v[68:71], a[124:127], v[160:163], v[68:71]
  v_add_u32 v18, s33, v14
  s_mov_b32 s61, s60
  v_mfma_f32_16x16x32_bf16 v[72:75], a[128:131], v[160:163], v[72:75]
  s_add_u32 s60, s60, 1024
  s_lshr_b32 s48, s20, 1
  v_mfma_f32_16x16x32_bf16 v[76:79], a[120:123], v[164:167], v[76:79]
  ds_read_b128 v[196:199], v19 offset:2048
  s_mul_i32 s48, s48, 393216
  v_mfma_f32_16x16x32_bf16 v[80:83], a[124:127], v[164:167], v[80:83]
  buffer_load_dwordx4 v11, s[8:11], s30 offen offset:1024 lds
  v_mfma_f32_16x16x32_bf16 v[84:87], a[128:131], v[164:167], v[84:87]
  s_waitcnt lgkmcnt(2)
  s_add_u32 s30, s30, 128
  v_mfma_f32_16x16x32_bf16 v[88:91], a[120:123], v[168:171], v[88:91]
  ds_read_b128 v[200:203], v19 offset:4096
  s_add_u32 m0, m0, 8192
  v_mfma_f32_16x16x32_bf16 v[92:95], a[124:127], v[168:171], v[92:95]
  s_cmp_lt_u32 m0, s46
  s_cselect_b32 m0, m0, s47
  v_mfma_f32_16x16x32_bf16 v[96:99], a[128:131], v[168:171], v[96:99]
  s_and_b32 s21, s20, 1
  s_mul_i32 s21, s21, 6144
  v_mfma_f32_16x16x32_bf16 v[100:103], a[120:123], v[172:175], v[100:103]
  ds_read_b128 v[204:207], v19 offset:6144
  s_add_u32 s48, s48, s21
  v_mfma_f32_16x16x32_bf16 v[104:107], a[124:127], v[172:175], v[104:107]
  s_add_u32 s48, s48, s27
  s_add_u32 s27, s27, s28
  v_mfma_f32_16x16x32_bf16 v[108:111], a[128:131], v[172:175], v[108:111]
  s_waitcnt vmcnt(14) lgkmcnt(2)
  s_barrier
  v_mfma_f32_16x16x32_bf16 v[64:67], a[132:135], v[192:195], v[64:67]
  ds_read_b128 v[160:163], v18 offset:0
  s_sub_u32 s26, s26, 1
  v_mfma_f32_16x16x32_bf16 v[68:71], a[136:139], v[192:195], v[68:71]
  v_mfma_f32_16x16x32_bf16 v[72:75], a[140:143], v[192:195], v[72:75]
  v_add_u32 v19, s33, v15
  s_add_u32 s33, s33, 8192
  v_mfma_f32_16x16x32_bf16 v[76:79], a[132:135], v[196:199], v[76:79]
  ds_read_b128 v[164:167], v18 offset:2048
  v_mfma_f32_16x16x32_bf16 v[80:83], a[136:139], v[196:199], v[80:83]
  buffer_load_dwordx4 v10, s[8:11], s30 offen offset:0 lds
  v_mfma_f32_16x16x32_bf16 v[84:87], a[140:143], v[196:199], v[84:87]
  s_waitcnt lgkmcnt(2)
  v_mfma_f32_16x16x32_bf16 v[88:91], a[132:135], v[200:203], v[88:91]
  ds_read_b128 v[168:171], v18 offset:4096
  v_mfma_f32_16x16x32_bf16 v[92:95], a[136:139], v[200:203], v[92:95]
  s_cmp_lt_u32 s33, 155648
  s_cselect_b32 s33, s33, 98304
  v_mfma_f32_16x16x32_bf16 v[96:99], a[140:143], v[200:203], v[96:99]
  v_mfma_f32_16x16x32_bf16 v[100:103], a[132:135], v[204:207], v[100:103]
  ds_read_b128 v[172:175], v18 offset:6144
  v_mfma_f32_16x16x32_bf16 v[104:107], a[136:139], v[204:207], v[104:107]
  v_mfma_f32_16x16x32_bf16 v[108:111], a[140:143], v[204:207], v[108:111]
  s_waitcnt lgkmcnt(2)
  v_mfma_f32_16x16x32_bf16 v[64:67], a[144:147], v[160:163], v[64:67]
  ds_read_b128 v[192:195], v19 offset:0
  v_mfma_f32_16x16x32_bf16 v[68:71], a[148:151], v[160:163], v[68:71]
  v_add_u32 v18, s33, v14
  v_mfma_f32_16x16x32_bf16 v[72:75], a[152:155], v[160:163], v[72:75]
  v_mfma_f32_16x16x32_bf16 v[76:79], a[144:147], v[164:167], v[76:79]
  ds_read_b128 v[196:199], v19 offset:2048
  v_mfma_f32_16x16x32_bf16 v[80:83], a[148:151], v[164:167], v[80:83]
  buffer_load_dwordx4 v11, s[8:11], s30 offen offset:1024 lds
  v_mfma_f32_16x16x32_bf16 v[84:87], a[152:155], v[164:167], v[84:87]
  s_waitcnt lgkmcnt(2)
  s_add_u32 s30, s30, 128
  v_mfma_f32_16x16x32_bf16 v[88:91], a[144:147], v[168:171], v[88:91]
  ds_read_b128 v[200:203], v19 offset:4096
  s_add_u32 m0, m0, 8192
  v_mfma_f32_16x16x32_bf16 v[92:95], a[148:151], v[168:171], v[92:95]
  s_cmp_lt_u32 m0, s46
  s_cselect_b32 m0, m0, s47
  v_mfma_f32_16x16x32_bf16 v[96:99], a[152:155], v[168:171], v[96:99]
  v_mfma_f32_16x16x32_bf16 v[100:103], a[144:147], v[172:175], v[100:103]
  ds_read_b128 v[204:207], v19 offset:6144
  v_mfma_f32_16x16x32_bf16 v[104:107], a[148:151], v[172:175], v[104:107]
  v_mfma_f32_16x16x32_bf16 v[108:111], a[152:155], v[172:175], v[108:111]
  s_waitcnt vmcnt(10) lgkmcnt(2)
  s_barrier
  v_mfma_f32_16x16x32_bf16 v[64:67], a[156:159], v[192:195], v[64:67]
  ds_read_b128 v[160:163], v18 offset:0
  v_mfma_f32_16x16x32_bf16 v[68:71], a[160:163], v[192:195], v[68:71]
  v_mfma_f32_16x16x32_bf16 v[72:75], a[164:167], v[192:195], v[72:75]
  v_add_u32 v19, s33, v15
  s_add_u32 s33, s33, 8192
  v_mfma_f32_16x16x32_bf16 v[76:79], a[156:159], v[196:199], v[76:79]
  ds_read_b128 v[164:167], v18 offset:2048
  v_mfma_f32_16x16x32_bf16 v[80:83], a[160:163], v[196:199], v[80:83]
  buffer_load_dwordx4 v10, s[8:11], s30 offen offset:0 lds
  v_mfma_f32_16x16x32_bf16 v[84:87], a[164:167], v[196:199], v[84:87]
  s_waitcnt lgkmcnt(2)
  v_mfma_f32_16x16x32_bf16 v[88:91], a[156:159], v[200:203], v[88:91]
  ds_read_b128 v[168:171], v18 offset:4096
  v_mfma_f32_16x16x32_bf16 v[92:95], a[160:163], v[200:203], v[92:95]
  s_cmp_lt_u32 s33, 155648
  s_cselect_b32 s33, s33, 98304
  v_mfma_f32_16x16x32_bf16 v[96:99], a[164:167], v[200:203], v[96:99]
  v_mfma_f32_16x16x32_bf16 v[100:103], a[156:159], v[204:207], v[100:103]
  ds_read_b128 v[172:175], v18 offset:6144
  v_mfma_f32_16x16x32_bf16 v[104:107], a[160:163], v[204:207], v[104:107]
  v_mfma_f32_16x16x32_bf16 v[108:111], a[164:167], v[204:207], v[108:111]
  s_waitcnt lgkmcnt(2)
  v_mfma_f32_16x16x32_bf16 v[64:67], a[168:171], v[160:163], v[64:67]
  ds_read_b128 v[192:195], v19 offset:0
  v_mfma_f32_16x16x32_bf16 v[68:71], a[172:175], v[160:163], v[68:71]
  v_add_u32 v18, s33, v14
  v_mfma_f32_16x16x32_bf16 v[72:75], a[176:179], v[160:163], v[72:75]
  v_mfma_f32_16x16x32_bf16 v[76:79], a[168:171], v[164:167], v[76:79]
  ds_read_b128 v[196:199], v19 offset:2048
  v_mfma_f32_16x16x32_bf16 v[80:83], a[172:175], v[164:167], v[80:83]
  buffer_load_dwordx4 v11, s[8:11], s30 offen offset:1024 lds
  v_mfma_f32_16x16x32_bf16 v[84:87], a[176:179], v[164:167], v[84:87]
  s_waitcnt lgkmcnt(2)
  s_add_u32 s30, s30, 128
  v_mfma_f32_16x16x32_bf16 v[88:91], a[168:171], v[168:171], v[88:91]
  ds_read_b128 v[200:203], v19 offset:4096
  s_add_u32 m0, m0, 8192
  v_mfma_f32_16x16x32_bf16 v[92:95], a[172:175], v[168:171], v[92:95]
  s_cmp_lt_u32 m0, s46
  s_cselect_b32 m0, m0, s47
  v_mfma_f32_16x16x32_bf16 v[96:99], a[176:179], v[168:171], v[96:99]
  v_mfma_f32_16x16x32_bf16 v[100:103], a[168:171], v[172:175], v[100:103]
  ds_read_b128 v[204:207], v19 offset:6144
  v_mfma_f32_16x16x32_bf16 v[104:107], a[172:175], v[172:175], v[104:107]
  v_mfma_f32_16x16x32_bf16 v[108:111], a[176:179], v[172:175], v[108:111]
  s_waitcnt vmcnt(8) lgkmcnt(2)
  s_barrier
  v_mfma_f32_16x16x32_bf16 v[64:67], a[180:183], v[192:195], v[64:67]
  ds_read_b128 v[160:163], v18 offset:0
  v_mfma_f32_16x16x32_bf16 v[68:71], a[184:187], v[192:195], v[68:71]
  v_mfma_f32_16x16x32_bf16 v[72:75], a[188:191], v[192:195], v[72:75]
  v_add_u32 v19, s33, v15
  s_add_u32 s33, s33, 8192
  v_mfma_f32_16x16x32_bf16 v[76:79], a[180:183], v[196:199], v[76:79]
  ds_read_b128 v[164:167], v18 offset:2048
  v_mfma_f32_16x16x32_bf16 v[80:83], a[184:187], v[196:199], v[80:83]
  buffer_load_dwordx4 v10, s[8:11], s30 offen offset:0 lds
  v_mfma_f32_16x16x32_bf16 v[84:87], a[188:191], v[196:199], v[84:87]
  s_waitcnt lgkmcnt(2)
  v_mfma_f32_16x16x32_bf16 v[88:91], a[180:183], v[200:203], v[88:91]
  ds_read_b128 v[168:171], v18 offset:4096
  v_mfma_f32_16x16x32_bf16 v[92:95], a[184:187], v[200:203], v[92:95]
  s_cmp_lt_u32 s33, 155648
  s_cselect_b32 s33, s33, 98304
  v_mfma_f32_16x16x32_bf16 v[96:99], a[188:191], v[200:203], v[96:99]
  v_mfma_f32_16x16x32_bf16 v[100:103], a[180:183], v[204:207], v[100:103]
  ds_read_b128 v[172:175], v18 offset:6144
  v_mfma_f32_16x16x32_bf16 v[104:107], a[184:187], v[204:207], v[104:107]
  v_mfma_f32_16x16x32_bf16 v[108:111], a[188:191], v[204:207], v[108:111]
  s_waitcnt lgkmcnt(2)
  v_mfma_f32_16x16x32_bf16 v[64:67], a[192:195], v[160:163], v[64:67]
  ds_read_b128 v[192:195], v19 offset:0
  v_mfma_f32_16x16x32_bf16 v[68:71], a[196:199], v[160:163], v[68:71]
  v_add_u32 v18, s33, v14
  v_mfma_f32_16x16x32_bf16 v[72:75], a[200:203], v[160:163], v[72:75]
  v_mfma_f32_16x16x32_bf16 v[76:79], a[192:195], v[164:167], v[76:79]
  ds_read_b128 v[196:199], v19 offset:2048
  v_mfma_f32_16x16x32_bf16 v[80:83], a[196:199], v[164:167], v[80:83]
  buffer_load_dwordx4 v11, s[8:11], s30 offen offset:1024 lds
  v_mfma_f32_16x16x32_bf16 v[84:87], a[200:203], v[164:167], v[84:87]
  s_waitcnt lgkmcnt(2)
  s_add_u32 s30, s30, 128
  v_mfma_f32_16x16x32_bf16 v[88:91], a[192:195], v[168:171], v[88:91]
  ds_read_b128 v[200:203], v19 offset:4096
  s_add_u32 m0, m0, 8192
  v_mfma_f32_16x16x32_bf16 v[92:95], a[196:199], v[168:171], v[92:95]
  s_cmp_lt_u32 m0, s46
  s_cselect_b32 m0, m0, s47
  v_mfma_f32_16x16x32_bf16 v[96:99], a[200:203], v[168:171], v[96:99]
  v_mfma_f32_16x16x32_bf16 v[100:103], a[192:195], v[172:175], v[100:103]
  ds_read_b128 v[204:207], v19 offset:6144
  v_mfma_f32_16x16x32_bf16 v[104:107], a[196:199], v[172:175], v[104:107]
  v_mfma_f32_16x16x32_bf16 v[108:111], a[200:203], v[172:175], v[108:111]
  s_waitcnt vmcnt(8) lgkmcnt(2)
  s_barrier
  v_mfma_f32_16x16x32_bf16 v[64:67], a[204:207], v[192:195], v[64:67]
  ds_read_b128 v[160:163], v18 offset:0
  v_mfma_f32_16x16x32_bf16 v[68:71], a[208:211], v[192:195], v[68:71]
  v_mfma_f32_16x16x32_bf16 v[72:75], a[212:215], v[192:195], v[72:75]
  v_add_u32 v19, s33, v15
  s_add_u32 s33, s33, 8192
  v_mfma_f32_16x16x32_bf16 v[76:79], a[204:207], v[196:199], v[76:79]
  ds_read_b128 v[164:167], v18 offset:2048
  v_mfma_f32_16x16x32_bf16 v[80:83], a[208:211], v[196:199], v[80:83]
  buffer_load_dwordx4 v10, s[8:11], s30 offen offset:0 lds
  v_mfma_f32_16x16x32_bf16 v[84:87], a[212:215], v[196:199], v[84:87]
  s_waitcnt lgkmcnt(2)
  v_mfma_f32_16x16x32_bf16 v[88:91], a[204:207], v[200:203], v[88:91]
  ds_read_b128 v[168:171], v18 offset:4096
  v_mfma_f32_16x16x32_bf16 v[92:95], a[208:211], v[200:203], v[92:95]
  s_cmp_lt_u32 s33, 155648
  s_cselect_b32 s33, s33, 98304
  v_mfma_f32_16x16x32_bf16 v[96:99], a[212:215], v[200:203], v[96:99]
  v_mfma_f32_16x16x32_bf16 v[100:103], a[204:207], v[204:207], v[100:103]
  ds_read_b128 v[172:175], v18 offset:6144
  v_mfma_f32_16x16x32_bf16 v[104:107], a[208:211], v[204:207], v[104:107]
  v_mfma_f32_16x16x32_bf16 v[108:111], a[212:215], v[204:207], v[108:111]
  s_waitcnt lgkmcnt(2)
  v_mfma_f32_16x16x32_bf16 v[64:67], a[216:219], v[160:163], v[64:67]
  ds_read_b128 v[192:195], v19 offset:0
  v_mfma_f32_16x16x32_bf16 v[68:71], a[220:223], v[160:163], v[68:71]
  v_add_u32 v18, s33, v14
  v_mfma_f32_16x16x32_bf16 v[72:75], a[224:227], v[160:163], v[72:75]
  v_mfma_f32_16x16x32_bf16 v[76:79], a[216:219], v[164:167], v[76:79]
  ds_read_b128 v[196:199], v19 offset:2048
  v_mfma_f32_16x16x32_bf16 v[80:83], a[220:223], v[164:167], v[80:83]
  buffer_load_dwordx4 v11, s[8:11], s30 offen offset:1024 lds
  v_mfma_f32_16x16x32_bf16 v[84:87], a[224:227], v[164:167], v[84:87]
  s_waitcnt lgkmcnt(2)
  s_add_u32 s30, s30, 128
  v_mfma_f32_16x16x32_bf16 v[88:91], a[216:219], v[168:171], v[88:91]
  ds_read_b128 v[200:203], v19 offset:4096
  s_add_u32 m0, m0, 8192
  v_mfma_f32_16x16x32_bf16 v[92:95], a[220:223], v[168:171], v[92:95]
  s_cmp_lt_u32 m0, s46
  s_cselect_b32 m0, m0, s47
  v_mfma_f32_16x16x32_bf16 v[96:99], a[224:227], v[168:171], v[96:99]
  v_mfma_f32_16x16x32_bf16 v[100:103], a[216:219], v[172:175], v[100:103]
  ds_read_b128 v[204:207], v19 offset:6144
  v_mfma_f32_16x16x32_bf16 v[104:107], a[220:223], v[172:175], v[104:107]
  v_mfma_f32_16x16x32_bf16 v[108:111], a[224:227], v[172:175], v[108:111]
  s_waitcnt vmcnt(8) lgkmcnt(2)
  s_barrier
  v_mfma_f32_16x16x32_bf16 v[64:67], a[228:231], v[192:195], v[64:67]
  ds_read_b128 v[160:163], v18 offset:0
  v_mfma_f32_16x16x32_bf16 v[68:71], a[232:235], v[192:195], v[68:71]
  v_mfma_f32_16x16x32_bf16 v[72:75], a[236:239], v[192:195], v[72:75]
  v_add_u32 v19, s33, v15
  s_add_u32 s33, s33, 8192
  v_mfma_f32_16x16x32_bf16 v[76:79], a[228:231], v[196:199], v[76:79]
  ds_read_b128 v[164:167], v18 offset:2048
  v_cvt_pk_bf16_f32 v224, v64, v65
  v_cvt_pk_bf16_f32 v225, v66, v67
  v_mfma_f32_16x16x32_bf16 v[80:83], a[232:235], v[196:199], v[80:83]
  buffer_load_dwordx4 v10, s[8:11], s30 offen offset:0 lds
  v_cvt_pk_bf16_f32 v226, v68, v69
  v_cvt_pk_bf16_f32 v227, v70, v71
  v_mfma_f32_16x16x32_bf16 v[84:87], a[236:239], v[196:199], v[84:87]
  s_waitcnt lgkmcnt(2)
  v_cvt_pk_bf16_f32 v228, v72, v73
  v_cvt_pk_bf16_f32 v229, v74, v75
  ds_write_b64 v22, v[224:225] offset:0
  v_mfma_f32_16x16x32_bf16 v[88:91], a[228:231], v[200:203], v[88:91]
  ds_read_b128 v[168:171], v18 offset:4096
  ds_write_b64 v22, v[226:227] offset:8
  ds_write_b64 v22, v[228:229] offset:16
  v_cvt_pk_bf16_f32 v230, v76, v77
  v_mfma_f32_16x16x32_bf16 v[92:95], a[232:235], v[200:203], v[92:95]
  s_cmp_lt_u32 s33, 155648
  s_cselect_b32 s33, s33, 98304
  v_cvt_pk_bf16_f32 v231, v78, v79
  v_cvt_pk_bf16_f32 v232, v80, v81
  v_mfma_f32_16x16x32_bf16 v[96:99], a[236:239], v[200:203], v[96:99]
  v_cvt_pk_bf16_f32 v233, v82, v83
  v_cvt_pk_bf16_f32 v234, v84, v85
  v_cvt_pk_bf16_f32 v235, v86, v87
  ds_write_b64 v22, v[230:231] offset:6400
  v_mfma_f32_16x16x32_bf16 v[100:103], a[228:231], v[204:207], v[100:103]
  ds_read_b128 v[172:175], v18 offset:6144
  ds_write_b64 v22, v[232:233] offset:6408
  ds_write_b64 v22, v[234:235] offset:6416
  v_cvt_pk_bf16_f32 v236, v88, v89
  v_mfma_f32_16x16x32_bf16 v[104:107], a[232:235], v[204:207], v[104:107]
  v_cvt_pk_bf16_f32 v237, v90, v91
  v_cvt_pk_bf16_f32 v238, v92, v93
  v_cvt_pk_bf16_f32 v239, v94, v95
  v_mfma_f32_16x16x32_bf16 v[108:111], a[236:239], v[204:207], v[108:111]
  v_cvt_pk_bf16_f32 v240, v96, v97
  v_cvt_pk_bf16_f32 v241, v98, v99
  ds_write_b64 v22, v[236:237] offset:12800
  ds_write_b64 v22, v[238:239] offset:12808
  ds_write_b64 v22, v[240:241] offset:12816
  s_nop 2
  v_cvt_pk_bf16_f32 v242, v100, v101
  v_cvt_pk_bf16_f32 v243, v102, v103
  v_cvt_pk_bf16_f32 v244, v104, v105
  v_cvt_pk_bf16_f32 v245, v106, v107
  v_cvt_pk_bf16_f32 v246, v108, v109
  v_cvt_pk_bf16_f32 v247, v110, v111
  ds_write_b64 v22, v[242:243] offset:19200
  ds_write_b64 v22, v[244:245] offset:19208
  ds_write_b64 v22, v[246:247] offset:19216
  s_waitcnt lgkmcnt(14)
  s_cmp_gt_u32 s26, 0
  s_cbranch_scc1 kvm_blk_159
  s_waitcnt vmcnt(0) lgkmcnt(0)
  s_barrier
  ds_read_b128 v[224:227], v23 offset:0
  ds_read_b128 v[228:231], v23 offset:64
  ds_read_b128 v[232:235], v23 offset:128
  ds_read_b128 v[236:239], v23 offset:192
  ds_read_b128 v[240:243], v23 offset:256
  ds_read_b128 v[244:247], v23 offset:320
  s_waitcnt lgkmcnt(0)
  s_add_u32 s21, s48, 0
  buffer_store_dwordx4 v[224:227], v26, s[16:19], s21 offen offset:0 sc1
  buffer_store_dwordx4 v[228:231], v26, s[16:19], s21 offen offset:1024 sc1
  buffer_store_dwordx4 v[232:235], v26, s[16:19], s21 offen offset:2048 sc1
  buffer_store_dwordx4 v[236:239], v26, s[16:19], s21 offen offset:3072 sc1
  s_add_u32 s21, s48, 4096
  buffer_store_dwordx4 v[240:243], v26, s[16:19], s21 offen offset:0 sc1
  buffer_store_dwordx4 v[244:247], v26, s[16:19], s21 offen offset:1024 sc1
  s_nop 1
  s_mov_b32 s24, 327680
  s_mov_b32 s25, 163840
  v_lshrrev_b32 v11, 3, v1
  v_and_b32 v12, 7, v1
  v_xor_b32 v12, v12, v11
  v_mul_u32_u24 v11, 1280, v11
  v_lshl_add_u32 v10, v12, 4, v11
  s_mul_i32 s46, s20, 40960
  v_add_u32 v10, s46, v10
  s_lshl_b32 s47, s20, 12
  s_add_u32 s47, s47, 0
  s_add_u32 s46, s47, 98304
  s_mov_b32 s30, s24
  s_add_u32 s32, s47, 32768
  v_add_u32 v11, 9216, v10
  v_add_u32 v12, 18432, v10
  v_add_u32 v13, 27648, v10
  s_mov_b32 m0, s32
  s_nop 0
  buffer_load_dwordx4 v10, s[8:11], s30 offen offset:0 lds
  buffer_load_dwordx4 v11, s[8:11], s30 offen offset:1024 lds
  buffer_load_dwordx4 v12, s[8:11], s30 offen offset:2048 lds
  buffer_load_dwordx4 v13, s[8:11], s30 offen offset:3072 lds
  s_add_u32 s30, s30, 128
  s_add_u32 s32, s32, 16384
  s_cmp_lt_u32 s32, s46
  s_cselect_b32 s32, s32, s47
  s_mov_b32 m0, s32
  s_nop 0
  buffer_load_dwordx4 v10, s[8:11], s30 offen offset:0 lds
  buffer_load_dwordx4 v11, s[8:11], s30 offen offset:1024 lds
  buffer_load_dwordx4 v12, s[8:11], s30 offen offset:2048 lds
  buffer_load_dwordx4 v13, s[8:11], s30 offen offset:3072 lds
  s_add_u32 s30, s30, 128
  s_add_u32 s32, s32, 16384
  s_cmp_lt_u32 s32, s46
  s_cselect_b32 s32, s32, s47
  s_mov_b32 m0, s32
  s_nop 0
  buffer_load_dwordx4 v10, s[8:11], s30 offen offset:0 lds
  buffer_load_dwordx4 v11, s[8:11], s30 offen offset:1024 lds
  buffer_load_dwordx4 v12, s[8:11], s30 offen offset:2048 lds
  buffer_load_dwordx4 v13, s[8:11], s30 offen offset:3072 lds
  s_add_u32 s30, s30, 128
  s_add_u32 s32, s32, 16384
  s_cmp_lt_u32 s32, s46
  s_cselect_b32 s32, s32, s47
  s_mov_b32 m0, s32
  s_nop 0
  buffer_load_dwordx4 v10, s[8:11], s30 offen offset:0 lds
  buffer_load_dwordx4 v11, s[8:11], s30 offen offset:1024 lds
  buffer_load_dwordx4 v12, s[8:11], s30 offen offset:2048 lds
  buffer_load_dwordx4 v13, s[8:11], s30 offen offset:3072 lds
  s_add_u32 s30, s30, 128
  s_add_u32 s32, s32, 16384
  s_cmp_lt_u32 s32, s46
  s_cselect_b32 s32, s32, s47
  s_waitcnt vmcnt(16)
  s_barrier
  s_cmp_lg_u32 s20, 0
  s_cbranch_scc1 af_160
  v_mov_b32 v4, 0
  v_mov_b32 v5, 1
  s_mov_b64 exec, 1
  buffer_atomic_add v5, v4, s[72:75], s61 offen sc1
  s_mov_b64 exec, -1
  s_nop 1
af_160:
  s_mov_b32 s26, 14
  s_mov_b32 s28, 1572864
  v_and_b32 v6, 7, v2
  v_add_u32 v4, 0, v3
  v_xor_b32 v4, v4, v6
  v_lshlrev_b32 v4, 4, v4
  v_lshl_add_u32 v14, v2, 7, v4
  v_add_u32 v4, 4, v3
  v_xor_b32 v4, v4, v6
  v_lshlrev_b32 v4, 4, v4
  v_lshl_add_u32 v15, v2, 7, v4
  v_mul_u32_u24 v22, 400, v2
  v_mul_u32_u24 v4, 24, v3
  s_mul_i32 s21, s20, 96
  s_add_u32 s21, s21, 98304
  v_add3_u32 v22, v22, v4, s21
  v_mov_b32 v9, 2731
  s_mul_i32 s21, s20, 12800
  s_add_u32 s21, s21, 98304
  v_mul_u32_u24 v4, 400, v2
  v_lshlrev_b32 v5, 4, v3
  v_add3_u32 v23, v4, v5, s21
  v_lshlrev_b32 v26, 4, v1
  s_mov_b32 s33, 32768
  s_mov_b32 s48, 0x80000000
  s_mov_b32 m0, s32
  s_nop 0
  buffer_load_dwordx4 v10, s[8:11], s30 offen offset:0 lds
  buffer_load_dwordx4 v11, s[8:11], s30 offen offset:1024 lds
  s_waitcnt vmcnt(14)
  s_barrier
  v_add_u32 v18, s33, v14
  v_add_u32 v19, s33, v15
  s_add_u32 s33, s33, 16384
  s_cmp_lt_u32 s33, 98304
  s_cselect_b32 s33, s33, 0
  ds_read_b128 v[160:163], v18 offset:0
  ds_read_b128 v[164:167], v18 offset:2048
  ds_read_b128 v[168:171], v18 offset:4096
  ds_read_b128 v[172:175], v18 offset:6144
  ds_read_b128 v[176:179], v18 offset:8192
  ds_read_b128 v[180:183], v18 offset:10240
  ds_read_b128 v[184:187], v18 offset:12288
  ds_read_b128 v[188:191], v18 offset:14336
  s_waitcnt lgkmcnt(0)
kv_blk_163:
  v_mfma_f32_16x16x32_bf16 v[64:67], a[0:3], v[160:163], 0
  ds_read_b128 v[192:195], v19 offset:0
  ds_write_b64 v22, v[240:241] offset:12816
  v_mfma_f32_16x16x32_bf16 v[68:71], a[4:7], v[160:163], 0
  v_add_u32 v18, s33, v14
  v_cvt_pk_bf16_f32 v242, v100, v101
  v_mfma_f32_16x16x32_bf16 v[72:75], a[8:11], v[160:163], 0
  v_cvt_pk_bf16_f32 v243, v102, v103
  v_cvt_pk_bf16_f32 v244, v104, v105
  v_mfma_f32_16x16x32_bf16 v[76:79], a[0:3], v[164:167], 0
  ds_read_b128 v[196:199], v19 offset:2048
  v_cvt_pk_bf16_f32 v245, v106, v107
  v_mfma_f32_16x16x32_bf16 v[80:83], a[4:7], v[164:167], 0
  buffer_load_dwordx4 v12, s[8:11], s30 offen offset:2048 lds
  v_mfma_f32_16x16x32_bf16 v[84:87], a[8:11], v[164:167], 0
  v_cvt_pk_bf16_f32 v246, v108, v109
  v_cvt_pk_bf16_f32 v247, v110, v111
  v_mfma_f32_16x16x32_bf16 v[88:91], a[0:3], v[168:171], 0
  ds_read_b128 v[200:203], v19 offset:4096
  ds_write_b64 v22, v[242:243] offset:19200
  v_mfma_f32_16x16x32_bf16 v[92:95], a[4:7], v[168:171], 0
  ds_write_b64 v22, v[244:245] offset:19208
  ds_write_b64 v22, v[246:247] offset:19216
  v_mfma_f32_16x16x32_bf16 v[96:99], a[8:11], v[168:171], 0
  v_cvt_pk_bf16_f32 v224, v112, v113
  v_cvt_pk_bf16_f32 v225, v114, v115
  v_mfma_f32_16x16x32_bf16 v[100:103], a[0:3], v[172:175], 0
  ds_read_b128 v[204:207], v19 offset:6144
  v_cvt_pk_bf16_f32 v226, v116, v117
  v_mfma_f32_16x16x32_bf16 v[104:107], a[4:7], v[172:175], 0
  v_cvt_pk_bf16_f32 v227, v118, v119
  v_cvt_pk_bf16_f32 v228, v120, v121
  v_mfma_f32_16x16x32_bf16 v[108:111], a[8:11], v[172:175], 0
  s_waitcnt lgkmcnt(10)
  v_cvt_pk_bf16_f32 v229, v122, v123
  v_mfma_f32_16x16x32_bf16 v[112:115], a[0:3], v[176:179], 0
  ds_read_b128 v[208:211], v19 offset:8192
  ds_write_b64 v22, v[224:225] offset:25600
  v_mfma_f32_16x16x32_bf16 v[116:119], a[4:7], v[176:179], 0
  ds_write_b64 v22, v[226:227] offset:25608
  ds_write_b64 v22, v[228:229] offset:25616
  v_mfma_f32_16x16x32_bf16 v[120:123], a[8:11], v[176:179], 0
  v_cvt_pk_bf16_f32 v230, v124, v125
  v_cvt_pk_bf16_f32 v231, v126, v127
  v_mfma_f32_16x16x32_bf16 v[124:127], a[0:3], v[180:183], 0
  ds_read_b128 v[212:215], v19 offset:10240
  v_cvt_pk_bf16_f32 v232, v128, v129
  v_cvt_pk_bf16_f32 v233, v130, v131
  v_mfma_f32_16x16x32_bf16 v[128:131], a[4:7], v[180:183], 0
  buffer_load_dwordx4 v13, s[8:11], s30 offen offset:3072 lds
  v_cvt_pk_bf16_f32 v234, v132, v133
  v_cvt_pk_bf16_f32 v235, v134, v135
  v_mfma_f32_16x16x32_bf16 v[132:135], a[8:11], v[180:183], 0
  s_add_u32 s30, s30, 128
  s_add_u32 m0, m0, 16384
  ds_write_b64 v22, v[230:231] offset:32000
  ds_write_b64 v22, v[232:233] offset:32008
  ds_write_b64 v22, v[234:235] offset:32016
  v_cvt_pk_bf16_f32 v236, v136, v137
  v_cvt_pk_bf16_f32 v237, v138, v139
  v_mfma_f32_16x16x32_bf16 v[136:139], a[0:3], v[184:187], 0
  ds_read_b128 v[216:219], v19 offset:12288
  v_cvt_pk_bf16_f32 v238, v140, v141
  v_cvt_pk_bf16_f32 v239, v142, v143
  v_mfma_f32_16x16x32_bf16 v[140:143], a[4:7], v[184:187], 0
  s_cmp_lt_u32 m0, s46
  s_cselect_b32 m0, m0, s47
  v_cvt_pk_bf16_f32 v240, v144, v145
  v_cvt_pk_bf16_f32 v241, v146, v147
  v_mfma_f32_16x16x32_bf16 v[144:147], a[8:11], v[184:187], 0
  ds_write_b64 v22, v[236:237] offset:38400
  ds_write_b64 v22, v[238:239] offset:38408
  ds_write_b64 v22, v[240:241] offset:38416
  v_cvt_pk_bf16_f32 v242, v148, v149
  v_cvt_pk_bf16_f32 v243, v150, v151
  v_mfma_f32_16x16x32_bf16 v[148:151], a[0:3], v[188:191], 0
  ds_read_b128 v[220:223], v19 offset:14336
  v_cvt_pk_bf16_f32 v244, v152, v153
  v_cvt_pk_bf16_f32 v245, v154, v155
  v_mfma_f32_16x16x32_bf16 v[152:155], a[4:7], v[188:191], 0
  v_cvt_pk_bf16_f32 v246, v156, v157
  v_cvt_pk_bf16_f32 v247, v158, v159
  v_mfma_f32_16x16x32_bf16 v[156:159], a[8:11], v[188:191], 0
  s_waitcnt vmcnt(12) lgkmcnt(13)
  s_barrier
  v_mfma_f32_16x16x32_bf16 v[64:67], a[12:15], v[192:195], v[64:67]
  ds_read_b128 v[160:163], v18 offset:0
  ds_write_b64 v22, v[242:243] offset:44800
  v_mfma_f32_16x16x32_bf16 v[68:71], a[16:19], v[192:195], v[68:71]
  ds_write_b64 v22, v[244:245] offset:44808
  ds_write_b64 v22, v[246:247] offset:44816
  v_mfma_f32_16x16x32_bf16 v[72:75], a[20:23], v[192:195], v[72:75]
  v_add_u32 v19, s33, v15
  s_add_u32 s33, s33, 16384
  v_mfma_f32_16x16x32_bf16 v[76:79], a[12:15], v[196:199], v[76:79]
  ds_read_b128 v[164:167], v18 offset:2048
  v_mfma_f32_16x16x32_bf16 v[80:83], a[16:19], v[196:199], v[80:83]
  buffer_load_dwordx4 v10, s[8:11], s30 offen offset:0 lds
  v_mfma_f32_16x16x32_bf16 v[84:87], a[20:23], v[196:199], v[84:87]
  s_cmp_lt_u32 s33, 98304
  s_cselect_b32 s33, s33, 0
  v_mfma_f32_16x16x32_bf16 v[88:91], a[12:15], v[200:203], v[88:91]
  ds_read_b128 v[168:171], v18 offset:4096
  v_mfma_f32_16x16x32_bf16 v[92:95], a[16:19], v[200:203], v[92:95]
  v_mfma_f32_16x16x32_bf16 v[96:99], a[20:23], v[200:203], v[96:99]
  v_mfma_f32_16x16x32_bf16 v[100:103], a[12:15], v[204:207], v[100:103]
  ds_read_b128 v[172:175], v18 offset:6144
  v_mfma_f32_16x16x32_bf16 v[104:107], a[16:19], v[204:207], v[104:107]
  v_mfma_f32_16x16x32_bf16 v[108:111], a[20:23], v[204:207], v[108:111]
  s_waitcnt lgkmcnt(7)
  v_mfma_f32_16x16x32_bf16 v[112:115], a[12:15], v[208:211], v[112:115]
  ds_read_b128 v[176:179], v18 offset:8192
  v_mfma_f32_16x16x32_bf16 v[116:119], a[16:19], v[208:211], v[116:119]
  v_mfma_f32_16x16x32_bf16 v[120:123], a[20:23], v[208:211], v[120:123]
  v_mfma_f32_16x16x32_bf16 v[124:127], a[12:15], v[212:215], v[124:127]
  ds_read_b128 v[180:183], v18 offset:10240
  v_mfma_f32_16x16x32_bf16 v[128:131], a[16:19], v[212:215], v[128:131]
  buffer_load_dwordx4 v11, s[8:11], s30 offen offset:1024 lds
  v_mfma_f32_16x16x32_bf16 v[132:135], a[20:23], v[212:215], v[132:135]
  v_mfma_f32_16x16x32_bf16 v[136:139], a[12:15], v[216:219], v[136:139]
  ds_read_b128 v[184:187], v18 offset:12288
  v_mfma_f32_16x16x32_bf16 v[140:143], a[16:19], v[216:219], v[140:143]
  v_mfma_f32_16x16x32_bf16 v[144:147], a[20:23], v[216:219], v[144:147]
  v_mfma_f32_16x16x32_bf16 v[148:151], a[12:15], v[220:223], v[148:151]
  ds_read_b128 v[188:191], v18 offset:14336
  v_mfma_f32_16x16x32_bf16 v[152:155], a[16:19], v[220:223], v[152:155]
  v_mfma_f32_16x16x32_bf16 v[156:159], a[20:23], v[220:223], v[156:159]
  s_waitcnt lgkmcnt(4)
  v_mfma_f32_16x16x32_bf16 v[64:67], a[24:27], v[160:163], v[64:67]
  ds_read_b128 v[192:195], v19 offset:0
  v_mfma_f32_16x16x32_bf16 v[68:71], a[28:31], v[160:163], v[68:71]
  v_add_u32 v18, s33, v14
  v_mfma_f32_16x16x32_bf16 v[72:75], a[32:35], v[160:163], v[72:75]
  v_mfma_f32_16x16x32_bf16 v[76:79], a[24:27], v[164:167], v[76:79]
  ds_read_b128 v[196:199], v19 offset:2048
  v_mfma_f32_16x16x32_bf16 v[80:83], a[28:31], v[164:167], v[80:83]
  buffer_load_dwordx4 v12, s[8:11], s30 offen offset:2048 lds
  v_mfma_f32_16x16x32_bf16 v[84:87], a[32:35], v[164:167], v[84:87]
  v_mfma_f32_16x16x32_bf16 v[88:91], a[24:27], v[168:171], v[88:91]
  ds_read_b128 v[200:203], v19 offset:4096
  v_mfma_f32_16x16x32_bf16 v[92:95], a[28:31], v[168:171], v[92:95]
  v_mfma_f32_16x16x32_bf16 v[96:99], a[32:35], v[168:171], v[96:99]
  v_mfma_f32_16x16x32_bf16 v[100:103], a[24:27], v[172:175], v[100:103]
  ds_read_b128 v[204:207], v19 offset:6144
  v_mfma_f32_16x16x32_bf16 v[104:107], a[28:31], v[172:175], v[104:107]
  v_mfma_f32_16x16x32_bf16 v[108:111], a[32:35], v[172:175], v[108:111]
  s_waitcnt lgkmcnt(4)
  v_mfma_f32_16x16x32_bf16 v[112:115], a[24:27], v[176:179], v[112:115]
  ds_read_b128 v[208:211], v19 offset:8192
  v_mfma_f32_16x16x32_bf16 v[116:119], a[28:31], v[176:179], v[116:119]
  v_mfma_f32_16x16x32_bf16 v[120:123], a[32:35], v[176:179], v[120:123]
  v_mfma_f32_16x16x32_bf16 v[124:127], a[24:27], v[180:183], v[124:127]
  ds_read_b128 v[212:215], v19 offset:10240
  v_mfma_f32_16x16x32_bf16 v[128:131], a[28:31], v[180:183], v[128:131]
  buffer_load_dwordx4 v13, s[8:11], s30 offen offset:3072 lds
  v_mfma_f32_16x16x32_bf16 v[132:135], a[32:35], v[180:183], v[132:135]
  s_add_u32 s30, s30, 128
  s_add_u32 m0, m0, 16384
  v_mfma_f32_16x16x32_bf16 v[136:139], a[24:27], v[184:187], v[136:139]
  ds_read_b128 v[216:219], v19 offset:12288
  v_mfma_f32_16x16x32_bf16 v[140:143], a[28:31], v[184:187], v[140:143]
  s_cmp_lt_u32 m0, s46
  s_cselect_b32 m0, m0, s47
  v_mfma_f32_16x16x32_bf16 v[144:147], a[32:35], v[184:187], v[144:147]
  v_mfma_f32_16x16x32_bf16 v[148:151], a[24:27], v[188:191], v[148:151]
  ds_read_b128 v[220:223], v19 offset:14336
  v_mfma_f32_16x16x32_bf16 v[152:155], a[28:31], v[188:191], v[152:155]
  v_mfma_f32_16x16x32_bf16 v[156:159], a[32:35], v[188:191], v[156:159]
  s_waitcnt vmcnt(12) lgkmcnt(4)
  s_barrier
  v_mfma_f32_16x16x32_bf16 v[64:67], a[36:39], v[192:195], v[64:67]
  ds_read_b128 v[160:163], v18 offset:0
  v_mfma_f32_16x16x32_bf16 v[68:71], a[40:43], v[192:195], v[68:71]
  v_mfma_f32_16x16x32_bf16 v[72:75], a[44:47], v[192:195], v[72:75]
  v_add_u32 v19, s33, v15
  s_add_u32 s33, s33, 16384
  v_mfma_f32_16x16x32_bf16 v[76:79], a[36:39], v[196:199], v[76:79]
  ds_read_b128 v[164:167], v18 offset:2048
  v_mfma_f32_16x16x32_bf16 v[80:83], a[40:43], v[196:199], v[80:83]
  buffer_load_dwordx4 v10, s[8:11], s30 offen offset:0 lds
  v_mfma_f32_16x16x32_bf16 v[84:87], a[44:47], v[196:199], v[84:87]
  s_cmp_lt_u32 s33, 98304
  s_cselect_b32 s33, s33, 0
  v_mfma_f32_16x16x32_bf16 v[88:91], a[36:39], v[200:203], v[88:91]
  ds_read_b128 v[168:171], v18 offset:4096
  v_mfma_f32_16x16x32_bf16 v[92:95], a[40:43], v[200:203], v[92:95]
  ds_read_b128 v[224:227], v23 offset:0
  v_mfma_f32_16x16x32_bf16 v[96:99], a[44:47], v[200:203], v[96:99]
  v_mfma_f32_16x16x32_bf16 v[100:103], a[36:39], v[204:207], v[100:103]
  ds_read_b128 v[172:175], v18 offset:6144
  v_mfma_f32_16x16x32_bf16 v[104:107], a[40:43], v[204:207], v[104:107]
  v_mfma_f32_16x16x32_bf16 v[108:111], a[44:47], v[204:207], v[108:111]
  s_waitcnt lgkmcnt(5)
  v_mfma_f32_16x16x32_bf16 v[112:115], a[36:39], v[208:211], v[112:115]
  ds_read_b128 v[176:179], v18 offset:8192
  v_mfma_f32_16x16x32_bf16 v[116:119], a[40:43], v[208:211], v[116:119]
  v_mfma_f32_16x16x32_bf16 v[120:123], a[44:47], v[208:211], v[120:123]
  v_mfma_f32_16x16x32_bf16 v[124:127], a[36:39], v[212:215], v[124:127]
  ds_read_b128 v[180:183], v18 offset:10240
  v_mfma_f32_16x16x32_bf16 v[128:131], a[40:43], v[212:215], v[128:131]
  buffer_load_dwordx4 v11, s[8:11], s30 offen offset:1024 lds
  v_mfma_f32_16x16x32_bf16 v[132:135], a[44:47], v[212:215], v[132:135]
  v_mfma_f32_16x16x32_bf16 v[136:139], a[36:39], v[216:219], v[136:139]
  ds_read_b128 v[184:187], v18 offset:12288
  v_mfma_f32_16x16x32_bf16 v[140:143], a[40:43], v[216:219], v[140:143]
  ds_read_b128 v[228:231], v23 offset:64
  v_mfma_f32_16x16x32_bf16 v[144:147], a[44:47], v[216:219], v[144:147]
  v_mfma_f32_16x16x32_bf16 v[148:151], a[36:39], v[220:223], v[148:151]
  ds_read_b128 v[188:191], v18 offset:14336
  v_mfma_f32_16x16x32_bf16 v[152:155], a[40:43], v[220:223], v[152:155]
  v_mfma_f32_16x16x32_bf16 v[156:159], a[44:47], v[220:223], v[156:159]
  s_waitcnt lgkmcnt(5)
  v_mfma_f32_16x16x32_bf16 v[64:67], a[48:51], v[160:163], v[64:67]
  ds_read_b128 v[192:195], v19 offset:0
  v_mfma_f32_16x16x32_bf16 v[68:71], a[52:55], v[160:163], v[68:71]
  v_add_u32 v18, s33, v14
  v_mfma_f32_16x16x32_bf16 v[72:75], a[56:59], v[160:163], v[72:75]
  v_mfma_f32_16x16x32_bf16 v[76:79], a[48:51], v[164:167], v[76:79]
  ds_read_b128 v[196:199], v19 offset:2048
  v_mfma_f32_16x16x32_bf16 v[80:83], a[52:55], v[164:167], v[80:83]
  buffer_load_dwordx4 v12, s[8:11], s30 offen offset:2048 lds
  v_mfma_f32_16x16x32_bf16 v[84:87], a[56:59], v[164:167], v[84:87]
  v_mfma_f32_16x16x32_bf16 v[88:91], a[48:51], v[168:171], v[88:91]
  ds_read_b128 v[200:203], v19 offset:4096
  v_mfma_f32_16x16x32_bf16 v[92:95], a[52:55], v[168:171], v[92:95]
  s_add_u32 s21, s48, 0
  ds_read_b128 v[232:235], v23 offset:128
  v_mfma_f32_16x16x32_bf16 v[96:99], a[56:59], v[168:171], v[96:99]
  v_mfma_f32_16x16x32_bf16 v[100:103], a[48:51], v[172:175], v[100:103]
  ds_read_b128 v[204:207], v19 offset:6144
  v_mfma_f32_16x16x32_bf16 v[104:107], a[52:55], v[172:175], v[104:107]
  buffer_store_dwordx4 v[224:227], v26, s[16:19], s21 offen offset:0 sc1
  v_mfma_f32_16x16x32_bf16 v[108:111], a[56:59], v[172:175], v[108:111]
  s_waitcnt lgkmcnt(5)
  v_mfma_f32_16x16x32_bf16 v[112:115], a[48:51], v[176:179], v[112:115]
  ds_read_b128 v[208:211], v19 offset:8192
  v_mfma_f32_16x16x32_bf16 v[116:119], a[52:55], v[176:179], v[116:119]
  v_mfma_f32_16x16x32_bf16 v[120:123], a[56:59], v[176:179], v[120:123]
  v_mfma_f32_16x16x32_bf16 v[124:127], a[48:51], v[180:183], v[124:127]
  ds_read_b128 v[212:215], v19 offset:10240
  v_mfma_f32_16x16x32_bf16 v[128:131], a[52:55], v[180:183], v[128:131]
  buffer_load_dwordx4 v13, s[8:11], s30 offen offset:3072 lds
  v_mfma_f32_16x16x32_bf16 v[132:135], a[56:59], v[180:183], v[132:135]
  s_add_u32 s30, s30, 128
  s_add_u32 m0, m0, 16384
  v_mfma_f32_16x16x32_bf16 v[136:139], a[48:51], v[184:187], v[136:139]
  ds_read_b128 v[216:219], v19 offset:12288
  v_mfma_f32_16x16x32_bf16 v[140:143], a[52:55], v[184:187], v[140:143]
  s_cmp_lt_u32 m0, s46
  s_cselect_b32 m0, m0, s47
  v_mfma_f32_16x16x32_bf16 v[144:147], a[56:59], v[184:187], v[144:147]
  ds_read_b128 v[236:239], v23 offset:192
  v_mfma_f32_16x16x32_bf16 v[148:151], a[48:51], v[188:191], v[148:151]
  ds_read_b128 v[220:223], v19 offset:14336
  v_mfma_f32_16x16x32_bf16 v[152:155], a[52:55], v[188:191], v[152:155]
  buffer_store_dwordx4 v[228:231], v26, s[16:19], s21 offen offset:1024 sc1
  v_mfma_f32_16x16x32_bf16 v[156:159], a[56:59], v[188:191], v[156:159]
  s_waitcnt vmcnt(14) lgkmcnt(5)
  s_barrier
  v_mfma_f32_16x16x32_bf16 v[64:67], a[60:63], v[192:195], v[64:67]
  ds_read_b128 v[160:163], v18 offset:0
  v_mfma_f32_16x16x32_bf16 v[68:71], a[64:67], v[192:195], v[68:71]
  v_mfma_f32_16x16x32_bf16 v[72:75], a[68:71], v[192:195], v[72:75]
  v_add_u32 v19, s33, v15
  s_add_u32 s33, s33, 16384
  v_mfma_f32_16x16x32_bf16 v[76:79], a[60:63], v[196:199], v[76:79]
  ds_read_b128 v[164:167], v18 offset:2048
  v_mfma_f32_16x16x32_bf16 v[80:83], a[64:67], v[196:199], v[80:83]
  buffer_load_dwordx4 v10, s[8:11], s30 offen offset:0 lds
  v_mfma_f32_16x16x32_bf16 v[84:87], a[68:71], v[196:199], v[84:87]
  s_cmp_lt_u32 s33, 98304
  s_cselect_b32 s33, s33, 0
  v_mfma_f32_16x16x32_bf16 v[88:91], a[60:63], v[200:203], v[88:91]
  ds_read_b128 v[168:171], v18 offset:4096
  v_mfma_f32_16x16x32_bf16 v[92:95], a[64:67], v[200:203], v[92:95]
  ds_read_b128 v[240:243], v23 offset:256
  v_mfma_f32_16x16x32_bf16 v[96:99], a[68:71], v[200:203], v[96:99]
  v_mfma_f32_16x16x32_bf16 v[100:103], a[60:63], v[204:207], v[100:103]
  ds_read_b128 v[172:175], v18 offset:6144
  v_mfma_f32_16x16x32_bf16 v[104:107], a[64:67], v[204:207], v[104:107]
  buffer_store_dwordx4 v[232:235], v26, s[16:19], s21 offen offset:2048 sc1
  v_mfma_f32_16x16x32_bf16 v[108:111], a[68:71], v[204:207], v[108:111]
  s_waitcnt lgkmcnt(5)
  v_mfma_f32_16x16x32_bf16 v[112:115], a[60:63], v[208:211], v[112:115]
  ds_read_b128 v[176:179], v18 offset:8192
  v_mfma_f32_16x16x32_bf16 v[116:119], a[64:67], v[208:211], v[116:119]
  v_mfma_f32_16x16x32_bf16 v[120:123], a[68:71], v[208:211], v[120:123]
  v_mfma_f32_16x16x32_bf16 v[124:127], a[60:63], v[212:215], v[124:127]
  ds_read_b128 v[180:183], v18 offset:10240
  v_mfma_f32_16x16x32_bf16 v[128:131], a[64:67], v[212:215], v[128:131]
  buffer_load_dwordx4 v11, s[8:11], s30 offen offset:1024 lds
  v_mfma_f32_16x16x32_bf16 v[132:135], a[68:71], v[212:215], v[132:135]
  v_mfma_f32_16x16x32_bf16 v[136:139], a[60:63], v[216:219], v[136:139]
  ds_read_b128 v[184:187], v18 offset:12288
  v_mfma_f32_16x16x32_bf16 v[140:143], a[64:67], v[216:219], v[140:143]
  ds_read_b128 v[244:247], v23 offset:320
  v_mfma_f32_16x16x32_bf16 v[144:147], a[68:71], v[216:219], v[144:147]
  v_mfma_f32_16x16x32_bf16 v[148:151], a[60:63], v[220:223], v[148:151]
  ds_read_b128 v[188:191], v18 offset:14336
  v_mfma_f32_16x16x32_bf16 v[152:155], a[64:67], v[220:223], v[152:155]
  buffer_store_dwordx4 v[236:239], v26, s[16:19], s21 offen offset:3072 sc1
  v_mfma_f32_16x16x32_bf16 v[156:159], a[68:71], v[220:223], v[156:159]
  s_waitcnt lgkmcnt(5)
  v_mfma_f32_16x16x32_bf16 v[64:67], a[72:75], v[160:163], v[64:67]
  ds_read_b128 v[192:195], v19 offset:0
  v_mfma_f32_16x16x32_bf16 v[68:71], a[76:79], v[160:163], v[68:71]
  v_add_u32 v18, s33, v14
  v_mfma_f32_16x16x32_bf16 v[72:75], a[80:83], v[160:163], v[72:75]
  v_mfma_f32_16x16x32_bf16 v[76:79], a[72:75], v[164:167], v[76:79]
  ds_read_b128 v[196:199], v19 offset:2048
  v_mfma_f32_16x16x32_bf16 v[80:83], a[76:79], v[164:167], v[80:83]
  buffer_load_dwordx4 v12, s[8:11], s30 offen offset:2048 lds
  v_mfma_f32_16x16x32_bf16 v[84:87], a[80:83], v[164:167], v[84:87]
  v_mfma_f32_16x16x32_bf16 v[88:91], a[72:75], v[168:171], v[88:91]
  ds_read_b128 v[200:203], v19 offset:4096
  v_mfma_f32_16x16x32_bf16 v[92:95], a[76:79], v[168:171], v[92:95]
  s_add_u32 s21, s48, 4096
  ds_read_b128 v[224:227], v23 offset:6400
  v_mfma_f32_16x16x32_bf16 v[96:99], a[80:83], v[168:171], v[96:99]
  v_mfma_f32_16x16x32_bf16 v[100:103], a[72:75], v[172:175], v[100:103]
  ds_read_b128 v[204:207], v19 offset:6144
  v_mfma_f32_16x16x32_bf16 v[104:107], a[76:79], v[172:175], v[104:107]
  buffer_store_dwordx4 v[240:243], v26, s[16:19], s21 offen offset:0 sc1
  v_mfma_f32_16x16x32_bf16 v[108:111], a[80:83], v[172:175], v[108:111]
  s_waitcnt lgkmcnt(5)
  v_mfma_f32_16x16x32_bf16 v[112:115], a[72:75], v[176:179], v[112:115]
  ds_read_b128 v[208:211], v19 offset:8192
  v_mfma_f32_16x16x32_bf16 v[116:119], a[76:79], v[176:179], v[116:119]
  v_mfma_f32_16x16x32_bf16 v[120:123], a[80:83], v[176:179], v[120:123]
  v_mfma_f32_16x16x32_bf16 v[124:127], a[72:75], v[180:183], v[124:127]
  ds_read_b128 v[212:215], v19 offset:10240
  v_mfma_f32_16x16x32_bf16 v[128:131], a[76:79], v[180:183], v[128:131]
  buffer_load_dwordx4 v13, s[8:11], s30 offen offset:3072 lds
  v_mfma_f32_16x16x32_bf16 v[132:135], a[80:83], v[180:183], v[132:135]
  s_add_u32 s30, s30, 128
  s_add_u32 m0, m0, 16384
  v_mfma_f32_16x16x32_bf16 v[136:139], a[72:75], v[184:187], v[136:139]
  ds_read_b128 v[216:219], v19 offset:12288
  v_mfma_f32_16x16x32_bf16 v[140:143], a[76:79], v[184:187], v[140:143]
  s_cmp_lt_u32 m0, s46
  s_cselect_b32 m0, m0, s47
  v_mfma_f32_16x16x32_bf16 v[144:147], a[80:83], v[184:187], v[144:147]
  ds_read_b128 v[228:231], v23 offset:6464
  v_mfma_f32_16x16x32_bf16 v[148:151], a[72:75], v[188:191], v[148:151]
  ds_read_b128 v[220:223], v19 offset:14336
  v_mfma_f32_16x16x32_bf16 v[152:155], a[76:79], v[188:191], v[152:155]
  buffer_store_dwordx4 v[244:247], v26, s[16:19], s21 offen offset:1024 sc1
  v_mfma_f32_16x16x32_bf16 v[156:159], a[80:83], v[188:191], v[156:159]
  s_waitcnt vmcnt(18) lgkmcnt(5)
  s_barrier
  v_mfma_f32_16x16x32_bf16 v[64:67], a[84:87], v[192:195], v[64:67]
  ds_read_b128 v[160:163], v18 offset:0
  v_mfma_f32_16x16x32_bf16 v[68:71], a[88:91], v[192:195], v[68:71]
  v_mfma_f32_16x16x32_bf16 v[72:75], a[92:95], v[192:195], v[72:75]
  v_add_u32 v19, s33, v15
  s_add_u32 s33, s33, 16384
  v_mfma_f32_16x16x32_bf16 v[76:79], a[84:87], v[196:199], v[76:79]
  ds_read_b128 v[164:167], v18 offset:2048
  v_mfma_f32_16x16x32_bf16 v[80:83], a[88:91], v[196:199], v[80:83]
  buffer_load_dwordx4 v10, s[8:11], s30 offen offset:0 lds
  v_mfma_f32_16x16x32_bf16 v[84:87], a[92:95], v[196:199], v[84:87]
  s_cmp_lt_u32 s33, 98304
  s_cselect_b32 s33, s33, 0
  v_mfma_f32_16x16x32_bf16 v[88:91], a[84:87], v[200:203], v[88:91]
  ds_read_b128 v[168:171], v18 offset:4096
  v_mfma_f32_16x16x32_bf16 v[92:95], a[88:91], v[200:203], v[92:95]
  ds_read_b128 v[232:235], v23 offset:6528
  v_mfma_f32_16x16x32_bf16 v[96:99], a[92:95], v[200:203], v[96:99]
  v_mfma_f32_16x16x32_bf16 v[100:103], a[84:87], v[204:207], v[100:103]
  ds_read_b128 v[172:175], v18 offset:6144
  v_mfma_f32_16x16x32_bf16 v[104:107], a[88:91], v[204:207], v[104:107]
  buffer_store_dwordx4 v[224:227], v26, s[16:19], s21 offen offset:2048 sc1
  v_mfma_f32_16x16x32_bf16 v[108:111], a[92:95], v[204:207], v[108:111]
  s_waitcnt lgkmcnt(5)
  v_mfma_f32_16x16x32_bf16 v[112:115], a[84:87], v[208:211], v[112:115]
  ds_read_b128 v[176:179], v18 offset:8192
  v_mfma_f32_16x16x32_bf16 v[116:119], a[88:91], v[208:211], v[116:119]
  v_mfma_f32_16x16x32_bf16 v[120:123], a[92:95], v[208:211], v[120:123]
  v_mfma_f32_16x16x32_bf16 v[124:127], a[84:87], v[212:215], v[124:127]
  ds_read_b128 v[180:183], v18 offset:10240
  v_mfma_f32_16x16x32_bf16 v[128:131], a[88:91], v[212:215], v[128:131]
  buffer_load_dwordx4 v11, s[8:11], s30 offen offset:1024 lds
  v_mfma_f32_16x16x32_bf16 v[132:135], a[92:95], v[212:215], v[132:135]
  v_mfma_f32_16x16x32_bf16 v[136:139], a[84:87], v[216:219], v[136:139]
  ds_read_b128 v[184:187], v18 offset:12288
  v_mfma_f32_16x16x32_bf16 v[140:143], a[88:91], v[216:219], v[140:143]
  ds_read_b128 v[236:239], v23 offset:6592
  v_mfma_f32_16x16x32_bf16 v[144:147], a[92:95], v[216:219], v[144:147]
  v_mfma_f32_16x16x32_bf16 v[148:151], a[84:87], v[220:223], v[148:151]
  ds_read_b128 v[188:191], v18 offset:14336
  v_mfma_f32_16x16x32_bf16 v[152:155], a[88:91], v[220:223], v[152:155]
  buffer_store_dwordx4 v[228:231], v26, s[16:19], s21 offen offset:3072 sc1
  v_mfma_f32_16x16x32_bf16 v[156:159], a[92:95], v[220:223], v[156:159]
  s_waitcnt lgkmcnt(5)
  v_mfma_f32_16x16x32_bf16 v[64:67], a[96:99], v[160:163], v[64:67]
  ds_read_b128 v[192:195], v19 offset:0
  v_mfma_f32_16x16x32_bf16 v[68:71], a[100:103], v[160:163], v[68:71]
  v_add_u32 v18, s33, v14
  v_mfma_f32_16x16x32_bf16 v[72:75], a[104:107], v[160:163], v[72:75]
  v_mfma_f32_16x16x32_bf16 v[76:79], a[96:99], v[164:167], v[76:79]
  ds_read_b128 v[196:199], v19 offset:2048
  v_mfma_f32_16x16x32_bf16 v[80:83], a[100:103], v[164:167], v[80:83]
  buffer_load_dwordx4 v12, s[8:11], s30 offen offset:2048 lds
  v_mfma_f32_16x16x32_bf16 v[84:87], a[104:107], v[164:167], v[84:87]
  v_mfma_f32_16x16x32_bf16 v[88:91], a[96:99], v[168:171], v[88:91]
  ds_read_b128 v[200:203], v19 offset:4096
  v_mfma_f32_16x16x32_bf16 v[92:95], a[100:103], v[168:171], v[92:95]
  s_add_u32 s21, s48, 8192
  ds_read_b128 v[240:243], v23 offset:6656
  v_mfma_f32_16x16x32_bf16 v[96:99], a[104:107], v[168:171], v[96:99]
  v_mfma_f32_16x16x32_bf16 v[100:103], a[96:99], v[172:175], v[100:103]
  ds_read_b128 v[204:207], v19 offset:6144
  v_mfma_f32_16x16x32_bf16 v[104:107], a[100:103], v[172:175], v[104:107]
  buffer_store_dwordx4 v[232:235], v26, s[16:19], s21 offen offset:0 sc1
  v_mfma_f32_16x16x32_bf16 v[108:111], a[104:107], v[172:175], v[108:111]
  s_waitcnt lgkmcnt(5)
  v_mfma_f32_16x16x32_bf16 v[112:115], a[96:99], v[176:179], v[112:115]
  ds_read_b128 v[208:211], v19 offset:8192
  v_mfma_f32_16x16x32_bf16 v[116:119], a[100:103], v[176:179], v[116:119]
  v_mfma_f32_16x16x32_bf16 v[120:123], a[104:107], v[176:179], v[120:123]
  v_mfma_f32_16x16x32_bf16 v[124:127], a[96:99], v[180:183], v[124:127]
  ds_read_b128 v[212:215], v19 offset:10240
  v_mfma_f32_16x16x32_bf16 v[128:131], a[100:103], v[180:183], v[128:131]
  buffer_load_dwordx4 v13, s[8:11], s30 offen offset:3072 lds
  v_mfma_f32_16x16x32_bf16 v[132:135], a[104:107], v[180:183], v[132:135]
  s_add_u32 s30, s30, 128
  s_add_u32 m0, m0, 16384
  v_mfma_f32_16x16x32_bf16 v[136:139], a[96:99], v[184:187], v[136:139]
  ds_read_b128 v[216:219], v19 offset:12288
  v_mfma_f32_16x16x32_bf16 v[140:143], a[100:103], v[184:187], v[140:143]
  s_cmp_lt_u32 m0, s46
  s_cselect_b32 m0, m0, s47
  v_mfma_f32_16x16x32_bf16 v[144:147], a[104:107], v[184:187], v[144:147]
  ds_read_b128 v[244:247], v23 offset:6720
  v_mfma_f32_16x16x32_bf16 v[148:151], a[96:99], v[188:191], v[148:151]
  ds_read_b128 v[220:223], v19 offset:14336
  v_mfma_f32_16x16x32_bf16 v[152:155], a[100:103], v[188:191], v[152:155]
  buffer_store_dwordx4 v[236:239], v26, s[16:19], s21 offen offset:1024 sc1
  v_mfma_f32_16x16x32_bf16 v[156:159], a[104:107], v[188:191], v[156:159]
  s_waitcnt vmcnt(22) lgkmcnt(5)
  s_barrier
  v_mfma_f32_16x16x32_bf16 v[64:67], a[108:111], v[192:195], v[64:67]
  ds_read_b128 v[160:163], v18 offset:0
  v_mfma_f32_16x16x32_bf16 v[68:71], a[112:115], v[192:195], v[68:71]
  v_mfma_f32_16x16x32_bf16 v[72:75], a[116:119], v[192:195], v[72:75]
  v_add_u32 v19, s33, v15
  s_add_u32 s33, s33, 16384
  v_mfma_f32_16x16x32_bf16 v[76:79], a[108:111], v[196:199], v[76:79]
  ds_read_b128 v[164:167], v18 offset:2048
  v_mfma_f32_16x16x32_bf16 v[80:83], a[112:115], v[196:199], v[80:83]
  buffer_load_dwordx4 v10, s[8:11], s30 offen offset:0 lds
  v_mfma_f32_16x16x32_bf16 v[84:87], a[116:119], v[196:199], v[84:87]
  s_cmp_lt_u32 s33, 98304
  s_cselect_b32 s33, s33, 0
  v_mfma_f32_16x16x32_bf16 v[88:91], a[108:111], v[200:203], v[88:91]
  ds_read_b128 v[168:171], v18 offset:4096
  v_mfma_f32_16x16x32_bf16 v[92:95], a[112:115], v[200:203], v[92:95]
  v_mfma_f32_16x16x32_bf16 v[96:99], a[116:119], v[200:203], v[96:99]
  v_mfma_f32_16x16x32_bf16 v[100:103], a[108:111], v[204:207], v[100:103]
  ds_read_b128 v[172:175], v18 offset:6144
  v_mfma_f32_16x16x32_bf16 v[104:107], a[112:115], v[204:207], v[104:107]
  buffer_store_dwordx4 v[240:243], v26, s[16:19], s21 offen offset:2048 sc1
  v_mfma_f32_16x16x32_bf16 v[108:111], a[116:119], v[204:207], v[108:111]
  s_waitcnt lgkmcnt(4)
  v_mfma_f32_16x16x32_bf16 v[112:115], a[108:111], v[208:211], v[112:115]
  ds_read_b128 v[176:179], v18 offset:8192
  v_mfma_f32_16x16x32_bf16 v[116:119], a[112:115], v[208:211], v[116:119]
  v_mfma_f32_16x16x32_bf16 v[120:123], a[116:119], v[208:211], v[120:123]
  v_mfma_f32_16x16x32_bf16 v[124:127], a[108:111], v[212:215], v[124:127]
  ds_read_b128 v[180:183], v18 offset:10240
  v_mfma_f32_16x16x32_bf16 v[128:131], a[112:115], v[212:215], v[128:131]
  buffer_load_dwordx4 v11, s[8:11], s30 offen offset:1024 lds
  v_mfma_f32_16x16x32_bf16 v[132:135], a[116:119], v[212:215], v[132:135]
  v_mfma_f32_16x16x32_bf16 v[136:139], a[108:111], v[216:219], v[136:139]
  ds_read_b128 v[184:187], v18 offset:12288
  v_mfma_f32_16x16x32_bf16 v[140:143], a[112:115], v[216:219], v[140:143]
  v_mfma_f32_16x16x32_bf16 v[144:147], a[116:119], v[216:219], v[144:147]
  v_mfma_f32_16x16x32_bf16 v[148:151], a[108:111], v[220:223], v[148:151]
  ds_read_b128 v[188:191], v18 offset:14336
  v_mfma_f32_16x16x32_bf16 v[152:155], a[112:115], v[220:223], v[152:155]
  buffer_store_dwordx4 v[244:247], v26, s[16:19], s21 offen offset:3072 sc1
  v_mfma_f32_16x16x32_bf16 v[156:159], a[116:119], v[220:223], v[156:159]
  s_waitcnt lgkmcnt(4)
  v_mfma_f32_16x16x32_bf16 v[64:67], a[120:123], v[160:163], v[64:67]
  ds_read_b128 v[192:195], v19 offset:0
  v_mfma_f32_16x16x32_bf16 v[68:71], a[124:127], v[160:163], v[68:71]
  v_add_u32 v18, s33, v14
  v_mfma_f32_16x16x32_bf16 v[72:75], a[128:131], v[160:163], v[72:75]
  v_mfma_f32_16x16x32_bf16 v[76:79], a[120:123], v[164:167], v[76:79]
  ds_read_b128 v[196:199], v19 offset:2048
  v_mfma_f32_16x16x32_bf16 v[80:83], a[124:127], v[164:167], v[80:83]
  buffer_load_dwordx4 v12, s[8:11], s30 offen offset:2048 lds
  v_mfma_f32_16x16x32_bf16 v[84:87], a[128:131], v[164:167], v[84:87]
  v_mfma_f32_16x16x32_bf16 v[88:91], a[120:123], v[168:171], v[88:91]
  ds_read_b128 v[200:203], v19 offset:4096
  v_mfma_f32_16x16x32_bf16 v[92:95], a[124:127], v[168:171], v[92:95]
  v_mfma_f32_16x16x32_bf16 v[96:99], a[128:131], v[168:171], v[96:99]
  v_mfma_f32_16x16x32_bf16 v[100:103], a[120:123], v[172:175], v[100:103]
  ds_read_b128 v[204:207], v19 offset:6144
  v_mfma_f32_16x16x32_bf16 v[104:107], a[124:127], v[172:175], v[104:107]
  v_mfma_f32_16x16x32_bf16 v[108:111], a[128:131], v[172:175], v[108:111]
  s_waitcnt lgkmcnt(4)
  v_mfma_f32_16x16x32_bf16 v[112:115], a[120:123], v[176:179], v[112:115]
  ds_read_b128 v[208:211], v19 offset:8192
  v_mfma_f32_16x16x32_bf16 v[116:119], a[124:127], v[176:179], v[116:119]
  v_mfma_f32_16x16x32_bf16 v[120:123], a[128:131], v[176:179], v[120:123]
  v_mfma_f32_16x16x32_bf16 v[124:127], a[120:123], v[180:183], v[124:127]
  ds_read_b128 v[212:215], v19 offset:10240
  v_mfma_f32_16x16x32_bf16 v[128:131], a[124:127], v[180:183], v[128:131]
  buffer_load_dwordx4 v13, s[8:11], s30 offen offset:3072 lds
  v_mfma_f32_16x16x32_bf16 v[132:135], a[128:131], v[180:183], v[132:135]
  s_add_u32 s30, s30, s25
  s_sub_u32 s30, s30, 1152
  v_mfma_f32_16x16x32_bf16 v[136:139], a[120:123], v[184:187], v[136:139]
  ds_read_b128 v[216:219], v19 offset:12288
  s_add_u32 m0, m0, 16384
  v_mfma_f32_16x16x32_bf16 v[140:143], a[124:127], v[184:187], v[140:143]
  s_cmp_lt_u32 m0, s46
  s_cselect_b32 m0, m0, s47
  v_mfma_f32_16x16x32_bf16 v[144:147], a[128:131], v[184:187], v[144:147]
  v_mfma_f32_16x16x32_bf16 v[148:151], a[120:123], v[188:191], v[148:151]
  ds_read_b128 v[220:223], v19 offset:14336
  v_mfma_f32_16x16x32_bf16 v[152:155], a[124:127], v[188:191], v[152:155]
  v_mfma_f32_16x16x32_bf16 v[156:159], a[128:131], v[188:191], v[156:159]
  s_waitcnt vmcnt(23) lgkmcnt(4)
  s_barrier
  v_mfma_f32_16x16x32_bf16 v[64:67], a[132:135], v[192:195], v[64:67]
  ds_read_b128 v[160:163], v18 offset:0
  v_mfma_f32_16x16x32_bf16 v[68:71], a[136:139], v[192:195], v[68:71]
  v_mfma_f32_16x16x32_bf16 v[72:75], a[140:143], v[192:195], v[72:75]
  v_add_u32 v19, s33, v15
  s_add_u32 s33, s33, 16384
  v_mfma_f32_16x16x32_bf16 v[76:79], a[132:135], v[196:199], v[76:79]
  ds_read_b128 v[164:167], v18 offset:2048
  v_mfma_f32_16x16x32_bf16 v[80:83], a[136:139], v[196:199], v[80:83]
  buffer_load_dwordx4 v10, s[8:11], s30 offen offset:0 lds
  v_mfma_f32_16x16x32_bf16 v[84:87], a[140:143], v[196:199], v[84:87]
  s_cmp_lt_u32 s33, 98304
  s_cselect_b32 s33, s33, 0
  v_mfma_f32_16x16x32_bf16 v[88:91], a[132:135], v[200:203], v[88:91]
  ds_read_b128 v[168:171], v18 offset:4096
  v_mfma_f32_16x16x32_bf16 v[92:95], a[136:139], v[200:203], v[92:95]
  v_mfma_f32_16x16x32_bf16 v[96:99], a[140:143], v[200:203], v[96:99]
  v_mfma_f32_16x16x32_bf16 v[100:103], a[132:135], v[204:207], v[100:103]
  ds_read_b128 v[172:175], v18 offset:6144
  v_mfma_f32_16x16x32_bf16 v[104:107], a[136:139], v[204:207], v[104:107]
  v_mfma_f32_16x16x32_bf16 v[108:111], a[140:143], v[204:207], v[108:111]
  s_waitcnt lgkmcnt(4)
  v_mfma_f32_16x16x32_bf16 v[112:115], a[132:135], v[208:211], v[112:115]
  ds_read_b128 v[176:179], v18 offset:8192
  v_mfma_f32_16x16x32_bf16 v[116:119], a[136:139], v[208:211], v[116:119]
  v_mfma_f32_16x16x32_bf16 v[120:123], a[140:143], v[208:211], v[120:123]
  v_mfma_f32_16x16x32_bf16 v[124:127], a[132:135], v[212:215], v[124:127]
  ds_read_b128 v[180:183], v18 offset:10240
  v_mfma_f32_16x16x32_bf16 v[128:131], a[136:139], v[212:215], v[128:131]
  buffer_load_dwordx4 v11, s[8:11], s30 offen offset:1024 lds
  v_mfma_f32_16x16x32_bf16 v[132:135], a[140:143], v[212:215], v[132:135]
  v_mfma_f32_16x16x32_bf16 v[136:139], a[132:135], v[216:219], v[136:139]
  ds_read_b128 v[184:187], v18 offset:12288
  v_mfma_f32_16x16x32_bf16 v[140:143], a[136:139], v[216:219], v[140:143]
  v_mfma_f32_16x16x32_bf16 v[144:147], a[140:143], v[216:219], v[144:147]
  v_mfma_f32_16x16x32_bf16 v[148:151], a[132:135], v[220:223], v[148:151]
  ds_read_b128 v[188:191], v18 offset:14336
  v_mfma_f32_16x16x32_bf16 v[152:155], a[136:139], v[220:223], v[152:155]
  v_mfma_f32_16x16x32_bf16 v[156:159], a[140:143], v[220:223], v[156:159]
  s_waitcnt lgkmcnt(4)
  v_mfma_f32_16x16x32_bf16 v[64:67], a[144:147], v[160:163], v[64:67]
  ds_read_b128 v[192:195], v19 offset:0
  v_mfma_f32_16x16x32_bf16 v[68:71], a[148:151], v[160:163], v[68:71]
  v_add_u32 v18, s33, v14
  v_mfma_f32_16x16x32_bf16 v[72:75], a[152:155], v[160:163], v[72:75]
  v_mfma_f32_16x16x32_bf16 v[76:79], a[144:147], v[164:167], v[76:79]
  ds_read_b128 v[196:199], v19 offset:2048
  v_mfma_f32_16x16x32_bf16 v[80:83], a[148:151], v[164:167], v[80:83]
  buffer_load_dwordx4 v12, s[8:11], s30 offen offset:2048 lds
  v_mfma_f32_16x16x32_bf16 v[84:87], a[152:155], v[164:167], v[84:87]
  v_mfma_f32_16x16x32_bf16 v[88:91], a[144:147], v[168:171], v[88:91]
  ds_read_b128 v[200:203], v19 offset:4096
  v_mfma_f32_16x16x32_bf16 v[92:95], a[148:151], v[168:171], v[92:95]
  v_mfma_f32_16x16x32_bf16 v[96:99], a[152:155], v[168:171], v[96:99]
  v_mfma_f32_16x16x32_bf16 v[100:103], a[144:147], v[172:175], v[100:103]
  ds_read_b128 v[204:207], v19 offset:6144
  v_mfma_f32_16x16x32_bf16 v[104:107], a[148:151], v[172:175], v[104:107]
  v_mfma_f32_16x16x32_bf16 v[108:111], a[152:155], v[172:175], v[108:111]
  s_waitcnt lgkmcnt(4)
  v_mfma_f32_16x16x32_bf16 v[112:115], a[144:147], v[176:179], v[112:115]
  ds_read_b128 v[208:211], v19 offset:8192
  v_mfma_f32_16x16x32_bf16 v[116:119], a[148:151], v[176:179], v[116:119]
  v_mfma_f32_16x16x32_bf16 v[120:123], a[152:155], v[176:179], v[120:123]
  v_mfma_f32_16x16x32_bf16 v[124:127], a[144:147], v[180:183], v[124:127]
  ds_read_b128 v[212:215], v19 offset:10240
  v_mfma_f32_16x16x32_bf16 v[128:131], a[148:151], v[180:183], v[128:131]
  buffer_load_dwordx4 v13, s[8:11], s30 offen offset:3072 lds
  v_mfma_f32_16x16x32_bf16 v[132:135], a[152:155], v[180:183], v[132:135]
  s_add_u32 s30, s30, 128
  s_add_u32 m0, m0, 16384
  v_mfma_f32_16x16x32_bf16 v[136:139], a[144:147], v[184:187], v[136:139]
  ds_read_b128 v[216:219], v19 offset:12288
  v_mfma_f32_16x16x32_bf16 v[140:143], a[148:151], v[184:187], v[140:143]
  s_cmp_lt_u32 m0, s46
  s_cselect_b32 m0, m0, s47
  v_mfma_f32_16x16x32_bf16 v[144:147], a[152:155], v[184:187], v[144:147]
  v_mfma_f32_16x16x32_bf16 v[148:151], a[144:147], v[188:191], v[148:151]
  ds_read_b128 v[220:223], v19 offset:14336
  v_mfma_f32_16x16x32_bf16 v[152:155], a[148:151], v[188:191], v[152:155]
  v_mfma_f32_16x16x32_bf16 v[156:159], a[152:155], v[188:191], v[156:159]
  s_waitcnt vmcnt(6) lgkmcnt(4)
  s_barrier
  v_mfma_f32_16x16x32_bf16 v[64:67], a[156:159], v[192:195], v[64:67]
  ds_read_b128 v[160:163], v18 offset:0
  v_mfma_f32_16x16x32_bf16 v[68:71], a[160:163], v[192:195], v[68:71]
  s_cmp_eq_u32 s48, 0x80000000
  s_cbranch_scc1 kv_161
  s_cmp_lg_u32 s20, 0
  s_cbranch_scc1 af_162
  v_mov_b32 v4, 0
  v_mov_b32 v5, 1
  s_mov_b64 exec, 1
  buffer_atomic_add v5, v4, s[72:75], s61 offen sc1
  s_mov_b64 exec, -1
  s_nop 1
af_162:
kv_161:
  v_mfma_f32_16x16x32_bf16 v[72:75], a[164:167], v[192:195], v[72:75]
  v_add_u32 v19, s33, v15
  s_add_u32 s33, s33, 16384
  v_mfma_f32_16x16x32_bf16 v[76:79], a[156:159], v[196:199], v[76:79]
  ds_read_b128 v[164:167], v18 offset:2048
  v_mfma_f32_16x16x32_bf16 v[80:83], a[160:163], v[196:199], v[80:83]
  buffer_load_dwordx4 v10, s[8:11], s30 offen offset:0 lds
  v_mfma_f32_16x16x32_bf16 v[84:87], a[164:167], v[196:199], v[84:87]
  s_cmp_lt_u32 s33, 98304
  s_cselect_b32 s33, s33, 0
  v_mfma_f32_16x16x32_bf16 v[88:91], a[156:159], v[200:203], v[88:91]
  ds_read_b128 v[168:171], v18 offset:4096
  v_mfma_f32_16x16x32_bf16 v[92:95], a[160:163], v[200:203], v[92:95]
  v_mfma_f32_16x16x32_bf16 v[96:99], a[164:167], v[200:203], v[96:99]
  v_mfma_f32_16x16x32_bf16 v[100:103], a[156:159], v[204:207], v[100:103]
  ds_read_b128 v[172:175], v18 offset:6144
  v_mfma_f32_16x16x32_bf16 v[104:107], a[160:163], v[204:207], v[104:107]
  v_mfma_f32_16x16x32_bf16 v[108:111], a[164:167], v[204:207], v[108:111]
  s_waitcnt lgkmcnt(4)
  v_mfma_f32_16x16x32_bf16 v[112:115], a[156:159], v[208:211], v[112:115]
  ds_read_b128 v[176:179], v18 offset:8192
  v_mfma_f32_16x16x32_bf16 v[116:119], a[160:163], v[208:211], v[116:119]
  v_mfma_f32_16x16x32_bf16 v[120:123], a[164:167], v[208:211], v[120:123]
  v_mfma_f32_16x16x32_bf16 v[124:127], a[156:159], v[212:215], v[124:127]
  ds_read_b128 v[180:183], v18 offset:10240
  v_mfma_f32_16x16x32_bf16 v[128:131], a[160:163], v[212:215], v[128:131]
  buffer_load_dwordx4 v11, s[8:11], s30 offen offset:1024 lds
  v_mfma_f32_16x16x32_bf16 v[132:135], a[164:167], v[212:215], v[132:135]
  v_mfma_f32_16x16x32_bf16 v[136:139], a[156:159], v[216:219], v[136:139]
  ds_read_b128 v[184:187], v18 offset:12288
  v_mfma_f32_16x16x32_bf16 v[140:143], a[160:163], v[216:219], v[140:143]
  v_mfma_f32_16x16x32_bf16 v[144:147], a[164:167], v[216:219], v[144:147]
  v_mfma_f32_16x16x32_bf16 v[148:151], a[156:159], v[220:223], v[148:151]
  ds_read_b128 v[188:191], v18 offset:14336
  v_mfma_f32_16x16x32_bf16 v[152:155], a[160:163], v[220:223], v[152:155]
  v_mfma_f32_16x16x32_bf16 v[156:159], a[164:167], v[220:223], v[156:159]
  s_waitcnt lgkmcnt(4)
  v_mfma_f32_16x16x32_bf16 v[64:67], a[168:171], v[160:163], v[64:67]
  ds_read_b128 v[192:195], v19 offset:0
  v_mfma_f32_16x16x32_bf16 v[68:71], a[172:175], v[160:163], v[68:71]
  v_add_u32 v18, s33, v14
  s_mov_b32 s61, s60
  v_mfma_f32_16x16x32_bf16 v[72:75], a[176:179], v[160:163], v[72:75]
  s_add_u32 s60, s60, 1024
  s_mul_i32 s48, s20, 393216
  v_mfma_f32_16x16x32_bf16 v[76:79], a[168:171], v[164:167], v[76:79]
  ds_read_b128 v[196:199], v19 offset:2048
  s_add_u32 s48, s48, s27
  v_mfma_f32_16x16x32_bf16 v[80:83], a[172:175], v[164:167], v[80:83]
  buffer_load_dwordx4 v12, s[8:11], s30 offen offset:2048 lds
  v_mfma_f32_16x16x32_bf16 v[84:87], a[176:179], v[164:167], v[84:87]
  s_add_u32 s27, s27, s28
  s_sub_u32 s26, s26, 1
  v_mfma_f32_16x16x32_bf16 v[88:91], a[168:171], v[168:171], v[88:91]
  ds_read_b128 v[200:203], v19 offset:4096
  v_mfma_f32_16x16x32_bf16 v[92:95], a[172:175], v[168:171], v[92:95]
  v_mfma_f32_16x16x32_bf16 v[96:99], a[176:179], v[168:171], v[96:99]
  v_mfma_f32_16x16x32_bf16 v[100:103], a[168:171], v[172:175], v[100:103]
  ds_read_b128 v[204:207], v19 offset:6144
  v_mfma_f32_16x16x32_bf16 v[104:107], a[172:175], v[172:175], v[104:107]
  v_mfma_f32_16x16x32_bf16 v[108:111], a[176:179], v[172:175], v[108:111]
  s_waitcnt lgkmcnt(4)
  v_mfma_f32_16x16x32_bf16 v[112:115], a[168:171], v[176:179], v[112:115]
  ds_read_b128 v[208:211], v19 offset:8192
  v_mfma_f32_16x16x32_bf16 v[116:119], a[172:175], v[176:179], v[116:119]
  v_mfma_f32_16x16x32_bf16 v[120:123], a[176:179], v[176:179], v[120:123]
  v_mfma_f32_16x16x32_bf16 v[124:127], a[168:171], v[180:183], v[124:127]
  ds_read_b128 v[212:215], v19 offset:10240
  v_mfma_f32_16x16x32_bf16 v[128:131], a[172:175], v[180:183], v[128:131]
  buffer_load_dwordx4 v13, s[8:11], s30 offen offset:3072 lds
  v_mfma_f32_16x16x32_bf16 v[132:135], a[176:179], v[180:183], v[132:135]
  s_add_u32 s30, s30, 128
  s_add_u32 m0, m0, 16384
  v_mfma_f32_16x16x32_bf16 v[136:139], a[168:171], v[184:187], v[136:139]
  ds_read_b128 v[216:219], v19 offset:12288
  v_mfma_f32_16x16x32_bf16 v[140:143], a[172:175], v[184:187], v[140:143]
  s_cmp_lt_u32 m0, s46
  s_cselect_b32 m0, m0, s47
  v_mfma_f32_16x16x32_bf16 v[144:147], a[176:179], v[184:187], v[144:147]
  v_mfma_f32_16x16x32_bf16 v[148:151], a[168:171], v[188:191], v[148:151]
  ds_read_b128 v[220:223], v19 offset:14336
  v_mfma_f32_16x16x32_bf16 v[152:155], a[172:175], v[188:191], v[152:155]
  v_mfma_f32_16x16x32_bf16 v[156:159], a[176:179], v[188:191], v[156:159]
  s_waitcnt vmcnt(15) lgkmcnt(4)
  s_barrier
  v_mfma_f32_16x16x32_bf16 v[64:67], a[180:183], v[192:195], v[64:67]
  ds_read_b128 v[160:163], v18 offset:0
  v_mfma_f32_16x16x32_bf16 v[68:71], a[184:187], v[192:195], v[68:71]
  v_mfma_f32_16x16x32_bf16 v[72:75], a[188:191], v[192:195], v[72:75]
  v_add_u32 v19, s33, v15
  s_add_u32 s33, s33, 16384
  v_mfma_f32_16x16x32_bf16 v[76:79], a[180:183], v[196:199], v[76:79]
  ds_read_b128 v[164:167], v18 offset:2048
  v_mfma_f32_16x16x32_bf16 v[80:83], a[184:187], v[196:199], v[80:83]
  buffer_load_dwordx4 v10, s[8:11], s30 offen offset:0 lds
  v_mfma_f32_16x16x32_bf16 v[84:87], a[188:191], v[196:199], v[84:87]
  s_cmp_lt_u32 s33, 98304
  s_cselect_b32 s33, s33, 0
  v_mfma_f32_16x16x32_bf16 v[88:91], a[180:183], v[200:203], v[88:91]
  ds_read_b128 v[168:171], v18 offset:4096
  v_mfma_f32_16x16x32_bf16 v[92:95], a[184:187], v[200:203], v[92:95]
  v_mfma_f32_16x16x32_bf16 v[96:99], a[188:191], v[200:203], v[96:99]
  v_mfma_f32_16x16x32_bf16 v[100:103], a[180:183], v[204:207], v[100:103]
  ds_read_b128 v[172:175], v18 offset:6144
  v_mfma_f32_16x16x32_bf16 v[104:107], a[184:187], v[204:207], v[104:107]
  v_mfma_f32_16x16x32_bf16 v[108:111], a[188:191], v[204:207], v[108:111]
  s_waitcnt lgkmcnt(4)
  v_mfma_f32_16x16x32_bf16 v[112:115], a[180:183], v[208:211], v[112:115]
  ds_read_b128 v[176:179], v18 offset:8192
  v_mfma_f32_16x16x32_bf16 v[116:119], a[184:187], v[208:211], v[116:119]
  v_mfma_f32_16x16x32_bf16 v[120:123], a[188:191], v[208:211], v[120:123]
  v_mfma_f32_16x16x32_bf16 v[124:127], a[180:183], v[212:215], v[124:127]
  ds_read_b128 v[180:183], v18 offset:10240
  v_mfma_f32_16x16x32_bf16 v[128:131], a[184:187], v[212:215], v[128:131]
  buffer_load_dwordx4 v11, s[8:11], s30 offen offset:1024 lds
  v_mfma_f32_16x16x32_bf16 v[132:135], a[188:191], v[212:215], v[132:135]
  v_mfma_f32_16x16x32_bf16 v[136:139], a[180:183], v[216:219], v[136:139]
  ds_read_b128 v[184:187], v18 offset:12288
  v_mfma_f32_16x16x32_bf16 v[140:143], a[184:187], v[216:219], v[140:143]
  v_mfma_f32_16x16x32_bf16 v[144:147], a[188:191], v[216:219], v[144:147]
  v_mfma_f32_16x16x32_bf16 v[148:151], a[180:183], v[220:223], v[148:151]
  ds_read_b128 v[188:191], v18 offset:14336
  v_mfma_f32_16x16x32_bf16 v[152:155], a[184:187], v[220:223], v[152:155]
  v_mfma_f32_16x16x32_bf16 v[156:159], a[188:191], v[220:223], v[156:159]
  s_waitcnt lgkmcnt(4)
  v_mfma_f32_16x16x32_bf16 v[64:67], a[192:195], v[160:163], v[64:67]
  ds_read_b128 v[192:195], v19 offset:0
  v_mfma_f32_16x16x32_bf16 v[68:71], a[196:199], v[160:163], v[68:71]
  v_add_u32 v18, s33, v14
  v_mfma_f32_16x16x32_bf16 v[72:75], a[200:203], v[160:163], v[72:75]
  v_mfma_f32_16x16x32_bf16 v[76:79], a[192:195], v[164:167], v[76:79]
  ds_read_b128 v[196:199], v19 offset:2048
  v_mfma_f32_16x16x32_bf16 v[80:83], a[196:199], v[164:167], v[80:83]
  buffer_load_dwordx4 v12, s[8:11], s30 offen offset:2048 lds
  v_mfma_f32_16x16x32_bf16 v[84:87], a[200:203], v[164:167], v[84:87]
  v_mfma_f32_16x16x32_bf16 v[88:91], a[192:195], v[168:171], v[88:91]
  ds_read_b128 v[200:203], v19 offset:4096
  v_mfma_f32_16x16x32_bf16 v[92:95], a[196:199], v[168:171], v[92:95]
  v_mfma_f32_16x16x32_bf16 v[96:99], a[200:203], v[168:171], v[96:99]
  v_mfma_f32_16x16x32_bf16 v[100:103], a[192:195], v[172:175], v[100:103]
  ds_read_b128 v[204:207], v19 offset:6144
  v_mfma_f32_16x16x32_bf16 v[104:107], a[196:199], v[172:175], v[104:107]
  v_mfma_f32_16x16x32_bf16 v[108:111], a[200:203], v[172:175], v[108:111]
  s_waitcnt lgkmcnt(4)
  v_mfma_f32_16x16x32_bf16 v[112:115], a[192:195], v[176:179], v[112:115]
  ds_read_b128 v[208:211], v19 offset:8192
  v_mfma_f32_16x16x32_bf16 v[116:119], a[196:199], v[176:179], v[116:119]
  v_mfma_f32_16x16x32_bf16 v[120:123], a[200:203], v[176:179], v[120:123]
  v_mfma_f32_16x16x32_bf16 v[124:127], a[192:195], v[180:183], v[124:127]
  ds_read_b128 v[212:215], v19 offset:10240
  v_mfma_f32_16x16x32_bf16 v[128:131], a[196:199], v[180:183], v[128:131]
  buffer_load_dwordx4 v13, s[8:11], s30 offen offset:3072 lds
  v_mfma_f32_16x16x32_bf16 v[132:135], a[200:203], v[180:183], v[132:135]
  s_add_u32 s30, s30, 128
  s_add_u32 m0, m0, 16384
  v_mfma_f32_16x16x32_bf16 v[136:139], a[192:195], v[184:187], v[136:139]
  ds_read_b128 v[216:219], v19 offset:12288
  v_mfma_f32_16x16x32_bf16 v[140:143], a[196:199], v[184:187], v[140:143]
  s_cmp_lt_u32 m0, s46
  s_cselect_b32 m0, m0, s47
  v_mfma_f32_16x16x32_bf16 v[144:147], a[200:203], v[184:187], v[144:147]
  v_mfma_f32_16x16x32_bf16 v[148:151], a[192:195], v[188:191], v[148:151]
  ds_read_b128 v[220:223], v19 offset:14336
  v_mfma_f32_16x16x32_bf16 v[152:155], a[196:199], v[188:191], v[152:155]
  v_mfma_f32_16x16x32_bf16 v[156:159], a[200:203], v[188:191], v[156:159]
  s_waitcnt vmcnt(12) lgkmcnt(4)
  s_barrier
  v_mfma_f32_16x16x32_bf16 v[64:67], a[204:207], v[192:195], v[64:67]
  ds_read_b128 v[160:163], v18 offset:0
  v_mfma_f32_16x16x32_bf16 v[68:71], a[208:211], v[192:195], v[68:71]
  v_mfma_f32_16x16x32_bf16 v[72:75], a[212:215], v[192:195], v[72:75]
  v_add_u32 v19, s33, v15
  s_add_u32 s33, s33, 16384
  v_mfma_f32_16x16x32_bf16 v[76:79], a[204:207], v[196:199], v[76:79]
  ds_read_b128 v[164:167], v18 offset:2048
  v_mfma_f32_16x16x32_bf16 v[80:83], a[208:211], v[196:199], v[80:83]
  buffer_load_dwordx4 v10, s[8:11], s30 offen offset:0 lds
  v_mfma_f32_16x16x32_bf16 v[84:87], a[212:215], v[196:199], v[84:87]
  s_cmp_lt_u32 s33, 98304
  s_cselect_b32 s33, s33, 0
  v_mfma_f32_16x16x32_bf16 v[88:91], a[204:207], v[200:203], v[88:91]
  ds_read_b128 v[168:171], v18 offset:4096
  v_mfma_f32_16x16x32_bf16 v[92:95], a[208:211], v[200:203], v[92:95]
  v_mfma_f32_16x16x32_bf16 v[96:99], a[212:215], v[200:203], v[96:99]
  v_mfma_f32_16x16x32_bf16 v[100:103], a[204:207], v[204:207], v[100:103]
  ds_read_b128 v[172:175], v18 offset:6144
  v_mfma_f32_16x16x32_bf16 v[104:107], a[208:211], v[204:207], v[104:107]
  v_mfma_f32_16x16x32_bf16 v[108:111], a[212:215], v[204:207], v[108:111]
  s_waitcnt lgkmcnt(4)
  v_mfma_f32_16x16x32_bf16 v[112:115], a[204:207], v[208:211], v[112:115]
  ds_read_b128 v[176:179], v18 offset:8192
  v_mfma_f32_16x16x32_bf16 v[116:119], a[208:211], v[208:211], v[116:119]
  v_mfma_f32_16x16x32_bf16 v[120:123], a[212:215], v[208:211], v[120:123]
  v_mfma_f32_16x16x32_bf16 v[124:127], a[204:207], v[212:215], v[124:127]
  ds_read_b128 v[180:183], v18 offset:10240
  v_mfma_f32_16x16x32_bf16 v[128:131], a[208:211], v[212:215], v[128:131]
  buffer_load_dwordx4 v11, s[8:11], s30 offen offset:1024 lds
  v_mfma_f32_16x16x32_bf16 v[132:135], a[212:215], v[212:215], v[132:135]
  v_mfma_f32_16x16x32_bf16 v[136:139], a[204:207], v[216:219], v[136:139]
  ds_read_b128 v[184:187], v18 offset:12288
  v_mfma_f32_16x16x32_bf16 v[140:143], a[208:211], v[216:219], v[140:143]
  v_mfma_f32_16x16x32_bf16 v[144:147], a[212:215], v[216:219], v[144:147]
  v_mfma_f32_16x16x32_bf16 v[148:151], a[204:207], v[220:223], v[148:151]
  ds_read_b128 v[188:191], v18 offset:14336
  v_mfma_f32_16x16x32_bf16 v[152:155], a[208:211], v[220:223], v[152:155]
  v_mfma_f32_16x16x32_bf16 v[156:159], a[212:215], v[220:223], v[156:159]
  s_waitcnt lgkmcnt(4)
  v_mfma_f32_16x16x32_bf16 v[64:67], a[216:219], v[160:163], v[64:67]
  ds_read_b128 v[192:195], v19 offset:0
  v_mfma_f32_16x16x32_bf16 v[68:71], a[220:223], v[160:163], v[68:71]
  v_add_u32 v18, s33, v14
  v_mfma_f32_16x16x32_bf16 v[72:75], a[224:227], v[160:163], v[72:75]
  v_mfma_f32_16x16x32_bf16 v[76:79], a[216:219], v[164:167], v[76:79]
  ds_read_b128 v[196:199], v19 offset:2048
  v_mfma_f32_16x16x32_bf16 v[80:83], a[220:223], v[164:167], v[80:83]
  buffer_load_dwordx4 v12, s[8:11], s30 offen offset:2048 lds
  v_mfma_f32_16x16x32_bf16 v[84:87], a[224:227], v[164:167], v[84:87]
  v_mfma_f32_16x16x32_bf16 v[88:91], a[216:219], v[168:171], v[88:91]
  ds_read_b128 v[200:203], v19 offset:4096
  v_mfma_f32_16x16x32_bf16 v[92:95], a[220:223], v[168:171], v[92:95]
  v_mfma_f32_16x16x32_bf16 v[96:99], a[224:227], v[168:171], v[96:99]
  v_mfma_f32_16x16x32_bf16 v[100:103], a[216:219], v[172:175], v[100:103]
  ds_read_b128 v[204:207], v19 offset:6144
  v_mfma_f32_16x16x32_bf16 v[104:107], a[220:223], v[172:175], v[104:107]
  v_mfma_f32_16x16x32_bf16 v[108:111], a[224:227], v[172:175], v[108:111]
  s_waitcnt lgkmcnt(4)
  v_mfma_f32_16x16x32_bf16 v[112:115], a[216:219], v[176:179], v[112:115]
  ds_read_b128 v[208:211], v19 offset:8192
  v_mfma_f32_16x16x32_bf16 v[116:119], a[220:223], v[176:179], v[116:119]
  v_mfma_f32_16x16x32_bf16 v[120:123], a[224:227], v[176:179], v[120:123]
  v_mfma_f32_16x16x32_bf16 v[124:127], a[216:219], v[180:183], v[124:127]
  ds_read_b128 v[212:215], v19 offset:10240
  v_mfma_f32_16x16x32_bf16 v[128:131], a[220:223], v[180:183], v[128:131]
  buffer_load_dwordx4 v13, s[8:11], s30 offen offset:3072 lds
  v_mfma_f32_16x16x32_bf16 v[132:135], a[224:227], v[180:183], v[132:135]
  s_add_u32 s30, s30, 128
  s_add_u32 m0, m0, 16384
  v_mfma_f32_16x16x32_bf16 v[136:139], a[216:219], v[184:187], v[136:139]
  ds_read_b128 v[216:219], v19 offset:12288
  v_mfma_f32_16x16x32_bf16 v[140:143], a[220:223], v[184:187], v[140:143]
  s_cmp_lt_u32 m0, s46
  s_cselect_b32 m0, m0, s47
  v_mfma_f32_16x16x32_bf16 v[144:147], a[224:227], v[184:187], v[144:147]
  v_mfma_f32_16x16x32_bf16 v[148:151], a[216:219], v[188:191], v[148:151]
  ds_read_b128 v[220:223], v19 offset:14336
  v_mfma_f32_16x16x32_bf16 v[152:155], a[220:223], v[188:191], v[152:155]
  v_mfma_f32_16x16x32_bf16 v[156:159], a[224:227], v[188:191], v[156:159]
  s_waitcnt vmcnt(12) lgkmcnt(4)
  s_barrier
  v_mfma_f32_16x16x32_bf16 v[64:67], a[228:231], v[192:195], v[64:67]
  ds_read_b128 v[160:163], v18 offset:0
  v_mfma_f32_16x16x32_bf16 v[68:71], a[232:235], v[192:195], v[68:71]
  v_mfma_f32_16x16x32_bf16 v[72:75], a[236:239], v[192:195], v[72:75]
  v_add_u32 v19, s33, v15
  s_add_u32 s33, s33, 16384
  v_mfma_f32_16x16x32_bf16 v[76:79], a[228:231], v[196:199], v[76:79]
  ds_read_b128 v[164:167], v18 offset:2048
  v_cvt_pk_bf16_f32 v224, v64, v65
  v_mfma_f32_16x16x32_bf16 v[80:83], a[232:235], v[196:199], v[80:83]
  buffer_load_dwordx4 v10, s[8:11], s30 offen offset:0 lds
  v_mfma_f32_16x16x32_bf16 v[84:87], a[236:239], v[196:199], v[84:87]
  s_cmp_lt_u32 s33, 98304
  s_cselect_b32 s33, s33, 0
  v_mfma_f32_16x16x32_bf16 v[88:91], a[228:231], v[200:203], v[88:91]
  ds_read_b128 v[168:171], v18 offset:4096
  v_cvt_pk_bf16_f32 v225, v66, v67
  v_mfma_f32_16x16x32_bf16 v[92:95], a[232:235], v[200:203], v[92:95]
  v_cvt_pk_bf16_f32 v226, v68, v69
  v_cvt_pk_bf16_f32 v227, v70, v71
  v_mfma_f32_16x16x32_bf16 v[96:99], a[236:239], v[200:203], v[96:99]
  v_cvt_pk_bf16_f32 v228, v72, v73
  v_cvt_pk_bf16_f32 v229, v74, v75
  v_mfma_f32_16x16x32_bf16 v[100:103], a[228:231], v[204:207], v[100:103]
  ds_read_b128 v[172:175], v18 offset:6144
  ds_write_b64 v22, v[224:225] offset:0
  v_mfma_f32_16x16x32_bf16 v[104:107], a[232:235], v[204:207], v[104:107]
  ds_write_b64 v22, v[226:227] offset:8
  ds_write_b64 v22, v[228:229] offset:16
  v_mfma_f32_16x16x32_bf16 v[108:111], a[236:239], v[204:207], v[108:111]
  s_waitcnt lgkmcnt(7)
  v_cvt_pk_bf16_f32 v230, v76, v77
  v_mfma_f32_16x16x32_bf16 v[112:115], a[228:231], v[208:211], v[112:115]
  ds_read_b128 v[176:179], v18 offset:8192
  v_cvt_pk_bf16_f32 v231, v78, v79
  v_mfma_f32_16x16x32_bf16 v[116:119], a[232:235], v[208:211], v[116:119]
  v_cvt_pk_bf16_f32 v232, v80, v81
  v_cvt_pk_bf16_f32 v233, v82, v83
  v_mfma_f32_16x16x32_bf16 v[120:123], a[236:239], v[208:211], v[120:123]
  v_cvt_pk_bf16_f32 v234, v84, v85
  v_cvt_pk_bf16_f32 v235, v86, v87
  v_mfma_f32_16x16x32_bf16 v[124:127], a[228:231], v[212:215], v[124:127]
  ds_read_b128 v[180:183], v18 offset:10240
  ds_write_b64 v22, v[230:231] offset:6400
  v_mfma_f32_16x16x32_bf16 v[128:131], a[232:235], v[212:215], v[128:131]
  buffer_load_dwordx4 v11, s[8:11], s30 offen offset:1024 lds
  v_mfma_f32_16x16x32_bf16 v[132:135], a[236:239], v[212:215], v[132:135]
  ds_write_b64 v22, v[232:233] offset:6408
  ds_write_b64 v22, v[234:235] offset:6416
  v_mfma_f32_16x16x32_bf16 v[136:139], a[228:231], v[216:219], v[136:139]
  ds_read_b128 v[184:187], v18 offset:12288
  v_cvt_pk_bf16_f32 v236, v88, v89
  v_mfma_f32_16x16x32_bf16 v[140:143], a[232:235], v[216:219], v[140:143]
  v_cvt_pk_bf16_f32 v237, v90, v91
  v_cvt_pk_bf16_f32 v238, v92, v93
  v_mfma_f32_16x16x32_bf16 v[144:147], a[236:239], v[216:219], v[144:147]
  v_cvt_pk_bf16_f32 v239, v94, v95
  v_cvt_pk_bf16_f32 v240, v96, v97
  v_mfma_f32_16x16x32_bf16 v[148:151], a[228:231], v[220:223], v[148:151]
  ds_read_b128 v[188:191], v18 offset:14336
  v_cvt_pk_bf16_f32 v241, v98, v99
  v_mfma_f32_16x16x32_bf16 v[152:155], a[232:235], v[220:223], v[152:155]
  ds_write_b64 v22, v[236:237] offset:12800
  ds_write_b64 v22, v[238:239] offset:12808
  v_mfma_f32_16x16x32_bf16 v[156:159], a[236:239], v[220:223], v[156:159]
  s_waitcnt lgkmcnt(12)
  s_cmp_gt_u32 s26, 0
  s_cbranch_scc1 kv_blk_163
  s_nop 7
  ds_write_b64 v22, v[240:241] offset:12816
  v_cvt_pk_bf16_f32 v242, v100, v101
  v_cvt_pk_bf16_f32 v243, v102, v103
  v_cvt_pk_bf16_f32 v244, v104, v105
  v_cvt_pk_bf16_f32 v245, v106, v107
  v_cvt_pk_bf16_f32 v246, v108, v109
  v_cvt_pk_bf16_f32 v247, v110, v111
  ds_write_b64 v22, v[242:243] offset:19200
  ds_write_b64 v22, v[244:245] offset:19208
  ds_write_b64 v22, v[246:247] offset:19216
  v_cvt_pk_bf16_f32 v224, v112, v113
  v_cvt_pk_bf16_f32 v225, v114, v115
  v_cvt_pk_bf16_f32 v226, v116, v117
  v_cvt_pk_bf16_f32 v227, v118, v119
  v_cvt_pk_bf16_f32 v228, v120, v121
  v_cvt_pk_bf16_f32 v229, v122, v123
  ds_write_b64 v22, v[224:225] offset:25600
  ds_write_b64 v22, v[226:227] offset:25608
  ds_write_b64 v22, v[228:229] offset:25616
  v_cvt_pk_bf16_f32 v230, v124, v125
  v_cvt_pk_bf16_f32 v231, v126, v127
  v_cvt_pk_bf16_f32 v232, v128, v129
  v_cvt_pk_bf16_f32 v233, v130, v131
  v_cvt_pk_bf16_f32 v234, v132, v133
  v_cvt_pk_bf16_f32 v235, v134, v135
  ds_write_b64 v22, v[230:231] offset:32000
  ds_write_b64 v22, v[232:233] offset:32008
  ds_write_b64 v22, v[234:235] offset:32016
  v_cvt_pk_bf16_f32 v236, v136, v137
  v_cvt_pk_bf16_f32 v237, v138, v139
  v_cvt_pk_bf16_f32 v238, v140, v141
  v_cvt_pk_bf16_f32 v239, v142, v143
  v_cvt_pk_bf16_f32 v240, v144, v145
  v_cvt_pk_bf16_f32 v241, v146, v147
  ds_write_b64 v22, v[236:237] offset:38400
  ds_write_b64 v22, v[238:239] offset:38408
  ds_write_b64 v22, v[240:241] offset:38416
  v_cvt_pk_bf16_f32 v242, v148, v149
  v_cvt_pk_bf16_f32 v243, v150, v151
  v_cvt_pk_bf16_f32 v244, v152, v153
  v_cvt_pk_bf16_f32 v245, v154, v155
  v_cvt_pk_bf16_f32 v246, v156, v157
  v_cvt_pk_bf16_f32 v247, v158, v159
  ds_write_b64 v22, v[242:243] offset:44800
  ds_write_b64 v22, v[244:245] offset:44808
  ds_write_b64 v22, v[246:247] offset:44816
  s_waitcnt vmcnt(0) lgkmcnt(0)
  s_barrier
  ds_read_b128 v[224:227], v23 offset:0
  ds_read_b128 v[228:231], v23 offset:64
  ds_read_b128 v[232:235], v23 offset:128
  ds_read_b128 v[236:239], v23 offset:192
  ds_read_b128 v[240:243], v23 offset:256
  ds_read_b128 v[244:247], v23 offset:320
  s_waitcnt lgkmcnt(0)
  s_add_u32 s21, s48, 0
  buffer_store_dwordx4 v[224:227], v26, s[16:19], s21 offen offset:0 sc1
  buffer_store_dwordx4 v[228:231], v26, s[16:19], s21 offen offset:1024 sc1
  buffer_store_dwordx4 v[232:235], v26, s[16:19], s21 offen offset:2048 sc1
  buffer_store_dwordx4 v[236:239], v26, s[16:19], s21 offen offset:3072 sc1
  s_add_u32 s21, s48, 4096
  buffer_store_dwordx4 v[240:243], v26, s[16:19], s21 offen offset:0 sc1
  buffer_store_dwordx4 v[244:247], v26, s[16:19], s21 offen offset:1024 sc1
  s_nop 1
  ds_read_b128 v[224:227], v23 offset:6400
  ds_read_b128 v[228:231], v23 offset:6464
  ds_read_b128 v[232:235], v23 offset:6528
  ds_read_b128 v[236:239], v23 offset:6592
  ds_read_b128 v[240:243], v23 offset:6656
  ds_read_b128 v[244:247], v23 offset:6720
  s_waitcnt lgkmcnt(0)
  buffer_store_dwordx4 v[224:227], v26, s[16:19], s21 offen offset:2048 sc1
  buffer_store_dwordx4 v[228:231], v26, s[16:19], s21 offen offset:3072 sc1
  s_add_u32 s21, s48, 8192
  buffer_store_dwordx4 v[232:235], v26, s[16:19], s21 offen offset:0 sc1
  buffer_store_dwordx4 v[236:239], v26, s[16:19], s21 offen offset:1024 sc1
  buffer_store_dwordx4 v[240:243], v26, s[16:19], s21 offen offset:2048 sc1
  buffer_store_dwordx4 v[244:247], v26, s[16:19], s21 offen offset:3072 sc1
  s_nop 1
  s_waitcnt vmcnt(0)
  s_barrier
  s_cmp_lg_u32 s20, 0
  s_cbranch_scc1 af_164
  v_mov_b32 v4, 0
  v_mov_b32 v5, 1
  s_mov_b64 exec, 1
  buffer_atomic_add v5, v4, s[72:75], s61 offen sc1
  s_mov_b64 exec, -1
  s_nop 1
af_164:
  s_branch queue
not_kv:
  s_cmp_ge_u32 s3, 96
  s_cbranch_scc1 not_vw
  s_sub_u32 s2, s3, 64
  s_load_dwordx2 s[6:7], s[0:1], 40
  s_load_dwordx2 s[38:39], s[0:1], 104
  s_waitcnt lgkmcnt(0)
  s_mov_b32 s12, s6
  s_mov_b32 s13, s7
  s_mov_b32 s14, 7864320
  s_mov_b32 s15, 0x00020000
  s_mov_b32 s16, s38
  s_mov_b32 s17, s39
  s_mov_b32 s18, 50331648
  s_mov_b32 s19, 0x00020000
  s_add_u32 s24, s38, 114294784
  s_addc_u32 s25, s39, 0
  s_mov_b32 s26, 83886080
  s_mov_b32 s27, 0x00020000
  s_load_dwordx2 s[72:73], s[0:1], 104
  s_waitcnt lgkmcnt(0)
  s_add_u32 s72, s72, 81068032
  s_addc_u32 s73, s73, 0
  s_mov_b32 s74, 115712
  s_mov_b32 s75, 0x00020000
  v_mov_b32 v29, 52429
  s_mul_i32 s21, s20, 960
  s_add_u32 s21, s21, 0
  v_add_u32 v21, s21, v1
  v_mul_u32_u24 v22, v21, v29
  v_lshrrev_b32 v22, 22, v22
  v_mul_u32_u24 v23, 80, v22
  v_sub_u32 v21, v21, v23
  v_mul_u32_u24 v26, 5462, v22
  v_lshrrev_b32 v26, 16, v26
  v_mul_u32_u24 v27, 12, v26
  v_sub_u32 v22, v22, v27
  v_lshrrev_b32 v27, 2, v22
  v_and_b32 v22, 3, v22
  v_lshlrev_b32 v25, 4, v27
  v_lshl_add_u32 v25, v26, 2, v25
  v_add_u32 v25, v25, v22
  v_mul_u32_u24 v25, 1280, v25
  v_lshl_add_u32 v64, v21, 4, v25
  s_mul_i32 s21, s20, 960
  s_add_u32 s21, s21, 64
  v_add_u32 v21, s21, v1
  v_mul_u32_u24 v22, v21, v29
  v_lshrrev_b32 v22, 22, v22
  v_mul_u32_u24 v23, 80, v22
  v_sub_u32 v21, v21, v23
  v_mul_u32_u24 v26, 5462, v22
  v_lshrrev_b32 v26, 16, v26
  v_mul_u32_u24 v27, 12, v26
  v_sub_u32 v22, v22, v27
  v_lshrrev_b32 v27, 2, v22
  v_and_b32 v22, 3, v22
  v_lshlrev_b32 v25, 4, v27
  v_lshl_add_u32 v25, v26, 2, v25
  v_add_u32 v25, v25, v22
  v_mul_u32_u24 v25, 1280, v25
  v_lshl_add_u32 v65, v21, 4, v25
  s_mul_i32 s21, s20, 960
  s_add_u32 s21, s21, 128
  v_add_u32 v21, s21, v1
  v_mul_u32_u24 v22, v21, v29
  v_lshrrev_b32 v22, 22, v22
  v_mul_u32_u24 v23, 80, v22
  v_sub_u32 v21, v21, v23
  v_mul_u32_u24 v26, 5462, v22
  v_lshrrev_b32 v26, 16, v26
  v_mul_u32_u24 v27, 12, v26
  v_sub_u32 v22, v22, v27
  v_lshrrev_b32 v27, 2, v22
  v_and_b32 v22, 3, v22
  v_lshlrev_b32 v25, 4, v27
  v_lshl_add_u32 v25, v26, 2, v25
  v_add_u32 v25, v25, v22
  v_mul_u32_u24 v25, 1280, v25
  v_lshl_add_u32 v66, v21, 4, v25
  s_mul_i32 s21, s20, 960
  s_add_u32 s21, s21, 192
  v_add_u32 v21, s21, v1
  v_mul_u32_u24 v22, v21, v29
  v_lshrrev_b32 v22, 22, v22
  v_mul_u32_u24 v23, 80, v22
  v_sub_u32 v21, v21, v23
  v_mul_u32_u24 v26, 5462, v22
  v_lshrrev_b32 v26, 16, v26
  v_mul_u32_u24 v27, 12, v26
  v_sub_u32 v22, v22, v27
  v_lshrrev_b32 v27, 2, v22
  v_and_b32 v22, 3, v22
  v_lshlrev_b32 v25, 4, v27
  v_lshl_add_u32 v25, v26, 2, v25
  v_add_u32 v25, v25, v22
  v_mul_u32_u24 v25, 1280, v25
  v_lshl_add_u32 v67, v21, 4, v25
  s_mul_i32 s21, s20, 960
  s_add_u32 s21, s21, 256
  v_add_u32 v21, s21, v1
  v_mul_u32_u24 v22, v21, v29
  v_lshrrev_b32 v22, 22, v22
  v_mul_u32_u24 v23, 80, v22
  v_sub_u32 v21, v21, v23
  v_mul_u32_u24 v26, 5462, v22
  v_lshrrev_b32 v26, 16, v26
  v_mul_u32_u24 v27, 12, v26
  v_sub_u32 v22, v22, v27
  v_lshrrev_b32 v27, 2, v22
  v_and_b32 v22, 3, v22
  v_lshlrev_b32 v25, 4, v27
  v_lshl_add_u32 v25, v26, 2, v25
  v_add_u32 v25, v25, v22
  v_mul_u32_u24 v25, 1280, v25
  v_lshl_add_u32 v68, v21, 4, v25
  s_mul_i32 s21, s20, 960
  s_add_u32 s21, s21, 320
  v_add_u32 v21, s21, v1
  v_mul_u32_u24 v22, v21, v29
  v_lshrrev_b32 v22, 22, v22
  v_mul_u32_u24 v23, 80, v22
  v_sub_u32 v21, v21, v23
  v_mul_u32_u24 v26, 5462, v22
  v_lshrrev_b32 v26, 16, v26
  v_mul_u32_u24 v27, 12, v26
  v_sub_u32 v22, v22, v27
  v_lshrrev_b32 v27, 2, v22
  v_and_b32 v22, 3, v22
  v_lshlrev_b32 v25, 4, v27
  v_lshl_add_u32 v25, v26, 2, v25
  v_add_u32 v25, v25, v22
  v_mul_u32_u24 v25, 1280, v25
  v_lshl_add_u32 v69, v21, 4, v25
  s_mul_i32 s21, s20, 960
  s_add_u32 s21, s21, 384
  v_add_u32 v21, s21, v1
  v_mul_u32_u24 v22, v21, v29
  v_lshrrev_b32 v22, 22, v22
  v_mul_u32_u24 v23, 80, v22
  v_sub_u32 v21, v21, v23
  v_mul_u32_u24 v26, 5462, v22
  v_lshrrev_b32 v26, 16, v26
  v_mul_u32_u24 v27, 12, v26
  v_sub_u32 v22, v22, v27
  v_lshrrev_b32 v27, 2, v22
  v_and_b32 v22, 3, v22
  v_lshlrev_b32 v25, 4, v27
  v_lshl_add_u32 v25, v26, 2, v25
  v_add_u32 v25, v25, v22
  v_mul_u32_u24 v25, 1280, v25
  v_lshl_add_u32 v70, v21, 4, v25
  s_mul_i32 s21, s20, 960
  s_add_u32 s21, s21, 448
  v_add_u32 v21, s21, v1
  v_mul_u32_u24 v22, v21, v29
  v_lshrrev_b32 v22, 22, v22
  v_mul_u32_u24 v23, 80, v22
  v_sub_u32 v21, v21, v23
  v_mul_u32_u24 v26, 5462, v22
  v_lshrrev_b32 v26, 16, v26
  v_mul_u32_u24 v27, 12, v26
  v_sub_u32 v22, v22, v27
  v_lshrrev_b32 v27, 2, v22
  v_and_b32 v22, 3, v22
  v_lshlrev_b32 v25, 4, v27
  v_lshl_add_u32 v25, v26, 2, v25
  v_add_u32 v25, v25, v22
  v_mul_u32_u24 v25, 1280, v25
  v_lshl_add_u32 v71, v21, 4, v25
  s_mul_i32 s21, s20, 960
  s_add_u32 s21, s21, 512
  v_add_u32 v21, s21, v1
  v_mul_u32_u24 v22, v21, v29
  v_lshrrev_b32 v22, 22, v22
  v_mul_u32_u24 v23, 80, v22
  v_sub_u32 v21, v21, v23
  v_mul_u32_u24 v26, 5462, v22
  v_lshrrev_b32 v26, 16, v26
  v_mul_u32_u24 v27, 12, v26
  v_sub_u32 v22, v22, v27
  v_lshrrev_b32 v27, 2, v22
  v_and_b32 v22, 3, v22
  v_lshlrev_b32 v25, 4, v27
  v_lshl_add_u32 v25, v26, 2, v25
  v_add_u32 v25, v25, v22
  v_mul_u32_u24 v25, 1280, v25
  v_lshl_add_u32 v72, v21, 4, v25
  s_mul_i32 s21, s20, 960
  s_add_u32 s21, s21, 576
  v_add_u32 v21, s21, v1
  v_mul_u32_u24 v22, v21, v29
  v_lshrrev_b32 v22, 22, v22
  v_mul_u32_u24 v23, 80, v22
  v_sub_u32 v21, v21, v23
  v_mul_u32_u24 v26, 5462, v22
  v_lshrrev_b32 v26, 16, v26
  v_mul_u32_u24 v27, 12, v26
  v_sub_u32 v22, v22, v27
  v_lshrrev_b32 v27, 2, v22
  v_and_b32 v22, 3, v22
  v_lshlrev_b32 v25, 4, v27
  v_lshl_add_u32 v25, v26, 2, v25
  v_add_u32 v25, v25, v22
  v_mul_u32_u24 v25, 1280, v25
  v_lshl_add_u32 v73, v21, 4, v25
  s_mul_i32 s21, s20, 960
  s_add_u32 s21, s21, 640
  v_add_u32 v21, s21, v1
  v_mul_u32_u24 v22, v21, v29
  v_lshrrev_b32 v22, 22, v22
  v_mul_u32_u24 v23, 80, v22
  v_sub_u32 v21, v21, v23
  v_mul_u32_u24 v26, 5462, v22
  v_lshrrev_b32 v26, 16, v26
  v_mul_u32_u24 v27, 12, v26
  v_sub_u32 v22, v22, v27
  v_lshrrev_b32 v27, 2, v22
  v_and_b32 v22, 3, v22
  v_lshlrev_b32 v25, 4, v27
  v_lshl_add_u32 v25, v26, 2, v25
  v_add_u32 v25, v25, v22
  v_mul_u32_u24 v25, 1280, v25
  v_lshl_add_u32 v74, v21, 4, v25
  s_mul_i32 s21, s20, 960
  s_add_u32 s21, s21, 704
  v_add_u32 v21, s21, v1
  v_mul_u32_u24 v22, v21, v29
  v_lshrrev_b32 v22, 22, v22
  v_mul_u32_u24 v23, 80, v22
  v_sub_u32 v21, v21, v23
  v_mul_u32_u24 v26, 5462, v22
  v_lshrrev_b32 v26, 16, v26
  v_mul_u32_u24 v27, 12, v26
  v_sub_u32 v22, v22, v27
  v_lshrrev_b32 v27, 2, v22
  v_and_b32 v22, 3, v22
  v_lshlrev_b32 v25, 4, v27
  v_lshl_add_u32 v25, v26, 2, v25
  v_add_u32 v25, v25, v22
  v_mul_u32_u24 v25, 1280, v25
  v_lshl_add_u32 v75, v21, 4, v25
  s_mul_i32 s21, s20, 960
  s_add_u32 s21, s21, 768
  v_add_u32 v21, s21, v1
  v_mul_u32_u24 v22, v21, v29
  v_lshrrev_b32 v22, 22, v22
  v_mul_u32_u24 v23, 80, v22
  v_sub_u32 v21, v21, v23
  v_mul_u32_u24 v26, 5462, v22
  v_lshrrev_b32 v26, 16, v26
  v_mul_u32_u24 v27, 12, v26
  v_sub_u32 v22, v22, v27
  v_lshrrev_b32 v27, 2, v22
  v_and_b32 v22, 3, v22
  v_lshlrev_b32 v25, 4, v27
  v_lshl_add_u32 v25, v26, 2, v25
  v_add_u32 v25, v25, v22
  v_mul_u32_u24 v25, 1280, v25
  v_lshl_add_u32 v76, v21, 4, v25
  s_mul_i32 s21, s20, 960
  s_add_u32 s21, s21, 832
  v_add_u32 v21, s21, v1
  v_mul_u32_u24 v22, v21, v29
  v_lshrrev_b32 v22, 22, v22
  v_mul_u32_u24 v23, 80, v22
  v_sub_u32 v21, v21, v23
  v_mul_u32_u24 v26, 5462, v22
  v_lshrrev_b32 v26, 16, v26
  v_mul_u32_u24 v27, 12, v26
  v_sub_u32 v22, v22, v27
  v_lshrrev_b32 v27, 2, v22
  v_and_b32 v22, 3, v22
  v_lshlrev_b32 v25, 4, v27
  v_lshl_add_u32 v25, v26, 2, v25
  v_add_u32 v25, v25, v22
  v_mul_u32_u24 v25, 1280, v25
  v_lshl_add_u32 v77, v21, 4, v25
  s_mul_i32 s21, s20, 960
  s_add_u32 s21, s21, 896
  v_add_u32 v21, s21, v1
  v_mul_u32_u24 v22, v21, v29
  v_lshrrev_b32 v22, 22, v22
  v_mul_u32_u24 v23, 80, v22
  v_sub_u32 v21, v21, v23
  v_mul_u32_u24 v26, 5462, v22
  v_lshrrev_b32 v26, 16, v26
  v_mul_u32_u24 v27, 12, v26
  v_sub_u32 v22, v22, v27
  v_lshrrev_b32 v27, 2, v22
  v_and_b32 v22, 3, v22
  v_lshlrev_b32 v25, 4, v27
  v_lshl_add_u32 v25, v26, 2, v25
  v_add_u32 v25, v25, v22
  v_mul_u32_u24 v25, 1280, v25
  v_lshl_add_u32 v78, v21, 4, v25
  v_lshrrev_b32 v6, 2, v2
  v_lshl_add_u32 v6, v3, 3, v6
  v_mul_u32_u24 v6, 1280, v6
  v_and_b32 v7, 3, v2
  v_lshlrev_b32 v7, 3, v7
  s_mul_i32 s21, s20, 320
  v_add3_u32 v6, v6, v7, s21
  v_add_u32 v7, 40960, v6
  v_add_u32 v8, 81920, v6
  s_mul_i32 s40, s2, 245760
  s_add_u32 s21, s40, 0
  s_mul_i32 s22, s20, 15360
  s_add_u32 s22, s22, 0
  s_add_u32 m0, s22, 0
  s_nop 0
  buffer_load_dwordx4 v64, s[12:15], s21 offen lds
  s_add_u32 m0, s22, 1024
  s_nop 0
  buffer_load_dwordx4 v65, s[12:15], s21 offen lds
  s_add_u32 m0, s22, 2048
  s_nop 0
  buffer_load_dwordx4 v66, s[12:15], s21 offen lds
  s_add_u32 m0, s22, 3072
  s_nop 0
  buffer_load_dwordx4 v67, s[12:15], s21 offen lds
  s_add_u32 m0, s22, 4096
  s_nop 0
  buffer_load_dwordx4 v68, s[12:15], s21 offen lds
  s_add_u32 m0, s22, 5120
  s_nop 0
  buffer_load_dwordx4 v69, s[12:15], s21 offen lds
  s_add_u32 m0, s22, 6144
  s_nop 0
  buffer_load_dwordx4 v70, s[12:15], s21 offen lds
  s_add_u32 m0, s22, 7168
  s_nop 0
  buffer_load_dwordx4 v71, s[12:15], s21 offen lds
  s_add_u32 m0, s22, 8192
  s_nop 0
  buffer_load_dwordx4 v72, s[12:15], s21 offen lds
  s_add_u32 m0, s22, 9216
  s_nop 0
  buffer_load_dwordx4 v73, s[12:15], s21 offen lds
  s_add_u32 m0, s22, 10240
  s_nop 0
  buffer_load_dwordx4 v74, s[12:15], s21 offen lds
  s_add_u32 m0, s22, 11264
  s_nop 0
  buffer_load_dwordx4 v75, s[12:15], s21 offen lds
  s_add_u32 m0, s22, 12288
  s_nop 0
  buffer_load_dwordx4 v76, s[12:15], s21 offen lds
  s_add_u32 m0, s22, 13312
  s_nop 0
  buffer_load_dwordx4 v77, s[12:15], s21 offen lds
  s_add_u32 m0, s22, 14336
  s_nop 0
  buffer_load_dwordx4 v78, s[12:15], s21 offen lds
  s_add_u32 s21, s40, 61440
  s_mul_i32 s22, s20, 15360
  s_add_u32 s22, s22, 61440
  s_add_u32 m0, s22, 0
  s_nop 0
  buffer_load_dwordx4 v64, s[12:15], s21 offen lds
  s_add_u32 m0, s22, 1024
  s_nop 0
  buffer_load_dwordx4 v65, s[12:15], s21 offen lds
  s_add_u32 m0, s22, 2048
  s_nop 0
  buffer_load_dwordx4 v66, s[12:15], s21 offen lds
  s_add_u32 m0, s22, 3072
  s_nop 0
  buffer_load_dwordx4 v67, s[12:15], s21 offen lds
  s_add_u32 m0, s22, 4096
  s_nop 0
  buffer_load_dwordx4 v68, s[12:15], s21 offen lds
  s_add_u32 m0, s22, 5120
  s_nop 0
  buffer_load_dwordx4 v69, s[12:15], s21 offen lds
  s_add_u32 m0, s22, 6144
  s_nop 0
  buffer_load_dwordx4 v70, s[12:15], s21 offen lds
  s_add_u32 m0, s22, 7168
  s_nop 0
  buffer_load_dwordx4 v71, s[12:15], s21 offen lds
  s_add_u32 m0, s22, 8192
  s_nop 0
  buffer_load_dwordx4 v72, s[12:15], s21 offen lds
  s_add_u32 m0, s22, 9216
  s_nop 0
  buffer_load_dwordx4 v73, s[12:15], s21 offen lds
  s_add_u32 m0, s22, 10240
  s_nop 0
  buffer_load_dwordx4 v74, s[12:15], s21 offen lds
  s_add_u32 m0, s22, 11264
  s_nop 0
  buffer_load_dwordx4 v75, s[12:15], s21 offen lds
  s_add_u32 m0, s22, 12288
  s_nop 0
  buffer_load_dwordx4 v76, s[12:15], s21 offen lds
  s_add_u32 m0, s22, 13312
  s_nop 0
  buffer_load_dwordx4 v77, s[12:15], s21 offen lds
  s_add_u32 m0, s22, 14336
  s_nop 0
  buffer_load_dwordx4 v78, s[12:15], s21 offen lds
  s_waitcnt vmcnt(0)
  s_barrier
  ds_read_b64_tr_b16 a[0:1], v6 offset:0
  ds_read_b64_tr_b16 a[2:3], v6 offset:5120
  ds_read_b64_tr_b16 a[24:25], v6 offset:32
  ds_read_b64_tr_b16 a[26:27], v6 offset:5152
  ds_read_b64_tr_b16 a[48:49], v6 offset:64
  ds_read_b64_tr_b16 a[50:51], v6 offset:5184
  ds_read_b64_tr_b16 a[72:73], v6 offset:96
  ds_read_b64_tr_b16 a[74:75], v6 offset:5216
  ds_read_b64_tr_b16 a[96:97], v6 offset:128
  ds_read_b64_tr_b16 a[98:99], v6 offset:5248
  ds_read_b64_tr_b16 a[120:121], v6 offset:160
  ds_read_b64_tr_b16 a[122:123], v6 offset:5280
  ds_read_b64_tr_b16 a[144:145], v6 offset:192
  ds_read_b64_tr_b16 a[146:147], v6 offset:5312
  ds_read_b64_tr_b16 a[168:169], v6 offset:224
  ds_read_b64_tr_b16 a[170:171], v6 offset:5344
  ds_read_b64_tr_b16 a[192:193], v6 offset:256
  ds_read_b64_tr_b16 a[194:195], v6 offset:5376
  ds_read_b64_tr_b16 a[216:217], v6 offset:288
  ds_read_b64_tr_b16 a[218:219], v6 offset:5408
  ds_read_b64_tr_b16 a[4:5], v7 offset:0
  ds_read_b64_tr_b16 a[6:7], v7 offset:5120
  ds_read_b64_tr_b16 a[28:29], v7 offset:32
  ds_read_b64_tr_b16 a[30:31], v7 offset:5152
  ds_read_b64_tr_b16 a[52:53], v7 offset:64
  ds_read_b64_tr_b16 a[54:55], v7 offset:5184
  ds_read_b64_tr_b16 a[76:77], v7 offset:96
  ds_read_b64_tr_b16 a[78:79], v7 offset:5216
  ds_read_b64_tr_b16 a[100:101], v7 offset:128
  ds_read_b64_tr_b16 a[102:103], v7 offset:5248
  ds_read_b64_tr_b16 a[124:125], v7 offset:160
  ds_read_b64_tr_b16 a[126:127], v7 offset:5280
  ds_read_b64_tr_b16 a[148:149], v7 offset:192
  ds_read_b64_tr_b16 a[150:151], v7 offset:5312
  ds_read_b64_tr_b16 a[172:173], v7 offset:224
  ds_read_b64_tr_b16 a[174:175], v7 offset:5344
  ds_read_b64_tr_b16 a[196:197], v7 offset:256
  ds_read_b64_tr_b16 a[198:199], v7 offset:5376
  ds_read_b64_tr_b16 a[220:221], v7 offset:288
  ds_read_b64_tr_b16 a[222:223], v7 offset:5408
  ds_read_b64_tr_b16 a[8:9], v8 offset:0
  ds_read_b64_tr_b16 a[10:11], v8 offset:5120
  ds_read_b64_tr_b16 a[32:33], v8 offset:32
  ds_read_b64_tr_b16 a[34:35], v8 offset:5152
  ds_read_b64_tr_b16 a[56:57], v8 offset:64
  ds_read_b64_tr_b16 a[58:59], v8 offset:5184
  ds_read_b64_tr_b16 a[80:81], v8 offset:96
  ds_read_b64_tr_b16 a[82:83], v8 offset:5216
  ds_read_b64_tr_b16 a[104:105], v8 offset:128
  ds_read_b64_tr_b16 a[106:107], v8 offset:5248
  ds_read_b64_tr_b16 a[128:129], v8 offset:160
  ds_read_b64_tr_b16 a[130:131], v8 offset:5280
  ds_read_b64_tr_b16 a[152:153], v8 offset:192
  ds_read_b64_tr_b16 a[154:155], v8 offset:5312
  ds_read_b64_tr_b16 a[176:177], v8 offset:224
  ds_read_b64_tr_b16 a[178:179], v8 offset:5344
  ds_read_b64_tr_b16 a[200:201], v8 offset:256
  ds_read_b64_tr_b16 a[202:203], v8 offset:5376
  ds_read_b64_tr_b16 a[224:225], v8 offset:288
  ds_read_b64_tr_b16 a[226:227], v8 offset:5408
  s_waitcnt lgkmcnt(0)
  s_barrier
  s_add_u32 s21, s40, 122880
  s_mul_i32 s22, s20, 15360
  s_add_u32 s22, s22, 0
  s_add_u32 m0, s22, 0
  s_nop 0
  buffer_load_dwordx4 v64, s[12:15], s21 offen lds
  s_add_u32 m0, s22, 1024
  s_nop 0
  buffer_load_dwordx4 v65, s[12:15], s21 offen lds
  s_add_u32 m0, s22, 2048
  s_nop 0
  buffer_load_dwordx4 v66, s[12:15], s21 offen lds
  s_add_u32 m0, s22, 3072
  s_nop 0
  buffer_load_dwordx4 v67, s[12:15], s21 offen lds
  s_add_u32 m0, s22, 4096
  s_nop 0
  buffer_load_dwordx4 v68, s[12:15], s21 offen lds
  s_add_u32 m0, s22, 5120
  s_nop 0
  buffer_load_dwordx4 v69, s[12:15], s21 offen lds
  s_add_u32 m0, s22, 6144
  s_nop 0
  buffer_load_dwordx4 v70, s[12:15], s21 offen lds
  s_add_u32 m0, s22, 7168
  s_nop 0
  buffer_load_dwordx4 v71, s[12:15], s21 offen lds
  s_add_u32 m0, s22, 8192
  s_nop 0
  buffer_load_dwordx4 v72, s[12:15], s21 offen lds
  s_add_u32 m0, s22, 9216
  s_nop 0
  buffer_load_dwordx4 v73, s[12:15], s21 offen lds
  s_add_u32 m0, s22, 10240
  s_nop 0
  buffer_load_dwordx4 v74, s[12:15], s21 offen lds
  s_add_u32 m0, s22, 11264
  s_nop 0
  buffer_load_dwordx4 v75, s[12:15], s21 offen lds
  s_add_u32 m0, s22, 12288
  s_nop 0
  buffer_load_dwordx4 v76, s[12:15], s21 offen lds
  s_add_u32 m0, s22, 13312
  s_nop 0
  buffer_load_dwordx4 v77, s[12:15], s21 offen lds
  s_add_u32 m0, s22, 14336
  s_nop 0
  buffer_load_dwordx4 v78, s[12:15], s21 offen lds
  s_add_u32 s21, s40, 184320
  s_mul_i32 s22, s20, 15360
  s_add_u32 s22, s22, 61440
  s_add_u32 m0, s22, 0
  s_nop 0
  buffer_load_dwordx4 v64, s[12:15], s21 offen lds
  s_add_u32 m0, s22, 1024
  s_nop 0
  buffer_load_dwordx4 v65, s[12:15], s21 offen lds
  s_add_u32 m0, s22, 2048
  s_nop 0
  buffer_load_dwordx4 v66, s[12:15], s21 offen lds
  s_add_u32 m0, s22, 3072
  s_nop 0
  buffer_load_dwordx4 v67, s[12:15], s21 offen lds
  s_add_u32 m0, s22, 4096
  s_nop 0
  buffer_load_dwordx4 v68, s[12:15], s21 offen lds
  s_add_u32 m0, s22, 5120
  s_nop 0
  buffer_load_dwordx4 v69, s[12:15], s21 offen lds
  s_add_u32 m0, s22, 6144
  s_nop 0
  buffer_load_dwordx4 v70, s[12:15], s21 offen lds
  s_add_u32 m0, s22, 7168
  s_nop 0
  buffer_load_dwordx4 v71, s[12:15], s21 offen lds
  s_add_u32 m0, s22, 8192
  s_nop 0
  buffer_load_dwordx4 v72, s[12:15], s21 offen lds
  s_add_u32 m0, s22, 9216
  s_nop 0
  buffer_load_dwordx4 v73, s[12:15], s21 offen lds
  s_add_u32 m0, s22, 10240
  s_nop 0
  buffer_load_dwordx4 v74, s[12:15], s21 offen lds
  s_add_u32 m0, s22, 11264
  s_nop 0
  buffer_load_dwordx4 v75, s[12:15], s21 offen lds
  s_add_u32 m0, s22, 12288
  s_nop 0
  buffer_load_dwordx4 v76, s[12:15], s21 offen lds
  s_add_u32 m0, s22, 13312
  s_nop 0
  buffer_load_dwordx4 v77, s[12:15], s21 offen lds
  s_add_u32 m0, s22, 14336
  s_nop 0
  buffer_load_dwordx4 v78, s[12:15], s21 offen lds
  s_waitcnt vmcnt(0)
  s_barrier
  ds_read_b64_tr_b16 a[12:13], v6 offset:0
  ds_read_b64_tr_b16 a[14:15], v6 offset:5120
  ds_read_b64_tr_b16 a[36:37], v6 offset:32
  ds_read_b64_tr_b16 a[38:39], v6 offset:5152
  ds_read_b64_tr_b16 a[60:61], v6 offset:64
  ds_read_b64_tr_b16 a[62:63], v6 offset:5184
  ds_read_b64_tr_b16 a[84:85], v6 offset:96
  ds_read_b64_tr_b16 a[86:87], v6 offset:5216
  ds_read_b64_tr_b16 a[108:109], v6 offset:128
  ds_read_b64_tr_b16 a[110:111], v6 offset:5248
  ds_read_b64_tr_b16 a[132:133], v6 offset:160
  ds_read_b64_tr_b16 a[134:135], v6 offset:5280
  ds_read_b64_tr_b16 a[156:157], v6 offset:192
  ds_read_b64_tr_b16 a[158:159], v6 offset:5312
  ds_read_b64_tr_b16 a[180:181], v6 offset:224
  ds_read_b64_tr_b16 a[182:183], v6 offset:5344
  ds_read_b64_tr_b16 a[204:205], v6 offset:256
  ds_read_b64_tr_b16 a[206:207], v6 offset:5376
  ds_read_b64_tr_b16 a[228:229], v6 offset:288
  ds_read_b64_tr_b16 a[230:231], v6 offset:5408
  ds_read_b64_tr_b16 a[16:17], v7 offset:0
  ds_read_b64_tr_b16 a[18:19], v7 offset:5120
  ds_read_b64_tr_b16 a[40:41], v7 offset:32
  ds_read_b64_tr_b16 a[42:43], v7 offset:5152
  ds_read_b64_tr_b16 a[64:65], v7 offset:64
  ds_read_b64_tr_b16 a[66:67], v7 offset:5184
  ds_read_b64_tr_b16 a[88:89], v7 offset:96
  ds_read_b64_tr_b16 a[90:91], v7 offset:5216
  ds_read_b64_tr_b16 a[112:113], v7 offset:128
  ds_read_b64_tr_b16 a[114:115], v7 offset:5248
  ds_read_b64_tr_b16 a[136:137], v7 offset:160
  ds_read_b64_tr_b16 a[138:139], v7 offset:5280
  ds_read_b64_tr_b16 a[160:161], v7 offset:192
  ds_read_b64_tr_b16 a[162:163], v7 offset:5312
  ds_read_b64_tr_b16 a[184:185], v7 offset:224
  ds_read_b64_tr_b16 a[186:187], v7 offset:5344
  ds_read_b64_tr_b16 a[208:209], v7 offset:256
  ds_read_b64_tr_b16 a[210:211], v7 offset:5376
  ds_read_b64_tr_b16 a[232:233], v7 offset:288
  ds_read_b64_tr_b16 a[234:235], v7 offset:5408
  ds_read_b64_tr_b16 a[20:21], v8 offset:0
  ds_read_b64_tr_b16 a[22:23], v8 offset:5120
  ds_read_b64_tr_b16 a[44:45], v8 offset:32
  ds_read_b64_tr_b16 a[46:47], v8 offset:5152
  ds_read_b64_tr_b16 a[68:69], v8 offset:64
  ds_read_b64_tr_b16 a[70:71], v8 offset:5184
  ds_read_b64_tr_b16 a[92:93], v8 offset:96
  ds_read_b64_tr_b16 a[94:95], v8 offset:5216
  ds_read_b64_tr_b16 a[116:117], v8 offset:128
  ds_read_b64_tr_b16 a[118:119], v8 offset:5248
  ds_read_b64_tr_b16 a[140:141], v8 offset:160
  ds_read_b64_tr_b16 a[142:143], v8 offset:5280
  ds_read_b64_tr_b16 a[164:165], v8 offset:192
  ds_read_b64_tr_b16 a[166:167], v8 offset:5312
  ds_read_b64_tr_b16 a[188:189], v8 offset:224
  ds_read_b64_tr_b16 a[190:191], v8 offset:5344
  ds_read_b64_tr_b16 a[212:213], v8 offset:256
  ds_read_b64_tr_b16 a[214:215], v8 offset:5376
  ds_read_b64_tr_b16 a[236:237], v8 offset:288
  ds_read_b64_tr_b16 a[238:239], v8 offset:5408
  s_waitcnt lgkmcnt(0)
  s_barrier
  s_load_dwordx2 s[32:33], s[0:1], 96
  s_waitcnt lgkmcnt(0)
  s_mov_b32 s32, s32
  s_mov_b32 s33, s33
  s_mov_b32 s34, 256
  s_mov_b32 s35, 0x00020000
  s_mov_b32 s21, 76
  s_cmp_lg_u32 s20, 0
  s_cbranch_scc1 wf_166
  v_mov_b32 v4, 0
  s_mov_b32 s101, 0
wf_165:
  buffer_load_dword v5, v4, s[32:35], s21 offen sc1
  s_add_u32 s101, s101, 1
  s_cmp_gt_u32 s101, 131072
  s_cbranch_scc1 main_end
  s_waitcnt vmcnt(0)
  v_readfirstlane_b32 s100, v5
  s_cmp_ge_u32 s100, 1
  s_cbranch_scc1 wf_166
  s_sleep 8
  s_branch wf_165
wf_166:
  s_barrier
  s_mul_i32 s41, s2, 12288
  s_add_u32 s47, s41, 25165824
  s_mov_b32 s41, s47
  s_mul_i32 s21, s20, 10
  s_mul_i32 s47, s2, 5
  s_lshr_b32 s22, s21, 3
  s_add_u32 s47, s47, s22
  s_and_b32 s48, s21, 7
  s_mov_b32 s66, 0
  s_mov_b32 s67, 0
  s_lshr_b32 s43, s2, 2
  s_lshl_b32 s43, s43, 7
  s_add_u32 s43, s43, 0
  s_lshl_b32 s44, s2, 7
  s_lshl_b32 s21, s20, 2
  s_add_u32 s44, s44, s21
  s_add_u32 s44, s44, 94208
  s_mov_b32 s45, 0
  s_mov_b32 s49, 1
  s_mov_b32 s50, 0
  v_mov_b32 v10, 0
  v_mov_b32 v11, 1
  v_lshlrev_b32 v4, 4, v1
  s_add_u32 s76, s38, 56623104
  s_addc_u32 s77, s39, 0
  s_mov_b32 s78, 6291456
  s_mov_b32 s79, 0x00020000
  s_add_u32 s80, s38, 93323264
  s_addc_u32 s81, s39, 0
  s_mov_b32 s82, 20971520
  s_mov_b32 s83, 0x00020000
  v_and_b32 v12, 3, v1
  v_lshlrev_b32 v12, 3, v12
  v_add_u32 v12, 4, v12
  v_and_b32 v13, 7, v2
  v_lshlrev_b32 v13, 4, v13
  v_lshl_add_u32 v13, v3, 7, v13
  v_lshrrev_b32 v14, 3, v2
  v_mul_u32_u24 v14, 98304, v14
  v_add_u32 v14, v14, v13
  v_and_b32 v15, 1, v3
  v_lshlrev_b32 v15, 8, v15
  v_lshl_add_u32 v15, v2, 4, v15
  v_lshrrev_b32 v16, 1, v3
  v_mul_u32_u24 v16, 327680, v16
  v_add_u32 v15, v15, v16
  v_lshlrev_b32 v17, 10, v1
  v_mov_b32 v19, 0
  s_lshl_b32 s53, s2, 7
  s_add_u32 s53, s53, 18432
  s_mov_b32 s55, 0
  s_mov_b32 s56, 0
  s_mov_b32 s58, 0
  s_mov_b32 s59, 0
  s_add_u32 s84, s38, 50331648
  s_addc_u32 s85, s39, 0
  s_mov_b32 s86, 12582912
  s_mov_b32 s87, 0x00020000
  s_and_b32 s21, s2, 3
  s_mul_i32 s51, s2, 3072
  s_cmp_eq_u32 s21, s20
  s_cselect_b32 s51, s51, 6291456
  v_mov_b32 v244, -1
  v_mov_b32 v245, -1
  v_mov_b32 v246, -1
  v_mov_b32 v247, -1
  s_add_u32 s88, s38, 85983232
  s_addc_u32 s89, s39, 0
  s_mov_b32 s90, 5242880
  s_mov_b32 s91, 0x00020000
  s_mul_i32 s21, s20, 3072
  s_add_u32 s41, s41, s21
  s_mov_b32 s64, s21
  s_add_u32 s67, s21, 98304
  s_mov_b32 s71, s21
  s_mov_b32 s46, 0
  s_mov_b32 s47, 0
  s_mov_b32 s65, 0
  s_mul_i32 s42, s2, 40960
  s_mul_i32 s21, s20, 10240
  s_add_u32 s42, s42, s21
  s_mov_b32 s68, 0x80000000
  s_mov_b32 s70, 0
  v_min_u32 v5, 17, v1
  v_lshlrev_b32 v5, 10, v5
  v_mov_b32 v9, 0
  s_lshl_b32 s21, s20, 2
  s_add_u32 s21, s21, 110592
  v_mov_b32 v6, s21
  v_mov_b32 v7, 110592
  s_mul_i32 s51, s2, 3072
  s_lshl_b32 s21, s20, 10
  s_add_u32 s51, s51, s21
  s_cmp_lt_u32 s20, 3
  s_cselect_b32 s51, s51, 6291456
  s_cmp_lt_u32 s51, 6291456
  s_cselect_b32 s52, s51, 0x80000000
  buffer_store_dwordx4 v[244:247], v4, s[84:87], s52 offen sc1
  s_add_u32 s52, s52, 6291456
  s_add_u32 s51, s51, 98304
  buffer_store_dwordx4 v[244:247], v4, s[84:87], s52 offen sc1
  s_cmp_lt_u32 s51, 6291456
  s_cselect_b32 s52, s51, 0x80000000
  buffer_store_dwordx4 v[244:247], v4, s[84:87], s52 offen sc1
  s_add_u32 s52, s52, 6291456
  s_add_u32 s51, s51, 98304
  buffer_store_dwordx4 v[244:247], v4, s[84:87], s52 offen sc1
  s_cmp_lt_u32 s51, 6291456
  s_cselect_b32 s52, s51, 0x80000000
  buffer_store_dwordx4 v[244:247], v4, s[84:87], s52 offen sc1
  s_add_u32 s52, s52, 6291456
  s_add_u32 s51, s51, 98304
  buffer_store_dwordx4 v[244:247], v4, s[84:87], s52 offen sc1
  s_cmp_lt_u32 s51, 6291456
  s_cselect_b32 s52, s51, 0x80000000
  buffer_store_dwordx4 v[244:247], v4, s[84:87], s52 offen sc1
  s_add_u32 s52, s52, 6291456
  s_add_u32 s51, s51, 98304
  buffer_store_dwordx4 v[244:247], v4, s[84:87], s52 offen sc1
  s_cmp_lt_u32 s51, 6291456
  s_cselect_b32 s52, s51, 0x80000000
  buffer_store_dwordx4 v[244:247], v4, s[84:87], s52 offen sc1
  s_add_u32 s52, s52, 6291456
  s_add_u32 s51, s51, 98304
  buffer_store_dwordx4 v[244:247], v4, s[84:87], s52 offen sc1
  s_cmp_lt_u32 s51, 6291456
  s_cselect_b32 s52, s51, 0x80000000
  buffer_store_dwordx4 v[244:247], v4, s[84:87], s52 offen sc1
  s_add_u32 s52, s52, 6291456
  s_add_u32 s51, s51, 98304
  buffer_store_dwordx4 v[244:247], v4, s[84:87], s52 offen sc1
  s_cmp_lt_u32 s51, 6291456
  s_cselect_b32 s52, s51, 0x80000000
  buffer_store_dwordx4 v[244:247], v4, s[84:87], s52 offen sc1
  s_add_u32 s52, s52, 6291456
  s_add_u32 s51, s51, 98304
  buffer_store_dwordx4 v[244:247], v4, s[84:87], s52 offen sc1
  s_cmp_lt_u32 s51, 6291456
  s_cselect_b32 s52, s51, 0x80000000
  buffer_store_dwordx4 v[244:247], v4, s[84:87], s52 offen sc1
  s_add_u32 s52, s52, 6291456
  s_add_u32 s51, s51, 98304
  buffer_store_dwordx4 v[244:247], v4, s[84:87], s52 offen sc1
  s_cmp_lt_u32 s51, 6291456
  s_cselect_b32 s52, s51, 0x80000000
  buffer_store_dwordx4 v[244:247], v4, s[84:87], s52 offen sc1
  s_add_u32 s52, s52, 6291456
  s_add_u32 s51, s51, 98304
  buffer_store_dwordx4 v[244:247], v4, s[84:87], s52 offen sc1
  s_cmp_lt_u32 s51, 6291456
  s_cselect_b32 s52, s51, 0x80000000
  buffer_store_dwordx4 v[244:247], v4, s[84:87], s52 offen sc1
  s_add_u32 s52, s52, 6291456
  s_add_u32 s51, s51, 98304
  buffer_store_dwordx4 v[244:247], v4, s[84:87], s52 offen sc1
  s_cmp_lt_u32 s51, 6291456
  s_cselect_b32 s52, s51, 0x80000000
  buffer_store_dwordx4 v[244:247], v4, s[84:87], s52 offen sc1
  s_add_u32 s52, s52, 6291456
  s_add_u32 s51, s51, 98304
  buffer_store_dwordx4 v[244:247], v4, s[84:87], s52 offen sc1
  s_cmp_lt_u32 s51, 6291456
  s_cselect_b32 s52, s51, 0x80000000
  buffer_store_dwordx4 v[244:247], v4, s[84:87], s52 offen sc1
  s_add_u32 s52, s52, 6291456
  s_add_u32 s51, s51, 98304
  buffer_store_dwordx4 v[244:247], v4, s[84:87], s52 offen sc1
  s_cmp_lt_u32 s51, 6291456
  s_cselect_b32 s52, s51, 0x80000000
  buffer_store_dwordx4 v[244:247], v4, s[84:87], s52 offen sc1
  s_add_u32 s52, s52, 6291456
  s_add_u32 s51, s51, 98304
  buffer_store_dwordx4 v[244:247], v4, s[84:87], s52 offen sc1
  s_cmp_lt_u32 s51, 6291456
  s_cselect_b32 s52, s51, 0x80000000
  buffer_store_dwordx4 v[244:247], v4, s[84:87], s52 offen sc1
  s_add_u32 s52, s52, 6291456
  s_add_u32 s51, s51, 98304
  buffer_store_dwordx4 v[244:247], v4, s[84:87], s52 offen sc1
  s_cmp_lt_u32 s51, 6291456
  s_cselect_b32 s52, s51, 0x80000000
  buffer_store_dwordx4 v[244:247], v4, s[84:87], s52 offen sc1
  s_add_u32 s52, s52, 6291456
  s_add_u32 s51, s51, 98304
  buffer_store_dwordx4 v[244:247], v4, s[84:87], s52 offen sc1
  s_cmp_lt_u32 s51, 6291456
  s_cselect_b32 s52, s51, 0x80000000
  buffer_store_dwordx4 v[244:247], v4, s[84:87], s52 offen sc1
  s_add_u32 s52, s52, 6291456
  s_add_u32 s51, s51, 98304
  buffer_store_dwordx4 v[244:247], v4, s[84:87], s52 offen sc1
  s_cmp_lg_u32 s20, 0
  s_cbranch_scc1 wf_168
  v_mov_b32 v20, 0
  s_mov_b32 s101, 0
wf_167:
  buffer_load_dword v21, v20, s[72:75], s43 offen sc1
  s_add_u32 s101, s101, 1
  s_cmp_gt_u32 s101, 131072
  s_cbranch_scc1 main_end
  s_waitcnt vmcnt(0)
  v_readfirstlane_b32 s100, v21
  s_cmp_ge_u32 s100, 8
  s_cbranch_scc1 wf_168
  s_sleep 6
  s_branch wf_167
wf_168:
  s_barrier
  v_cmp_gt_u32 vcc, 8, v9
  s_nop 0
  s_or_b32 s21, vcc_lo, 0x40000
  s_ff1_i32_b32 s21, s21
  s_lshl_b32 s22, s21, 1
  s_lshl_b32 s21, s21, 2
  s_sub_i32 s21, s21, 8
  s_max_i32 s47, s21, s22
  s_cmp_gt_u32 s47, s45
  s_cbranch_scc1 va_169
  s_mov_b32 s101, 0
  s_branch va_172
va_170:
  s_sleep 8
va_172:
  buffer_load_dword v9, v5, s[72:75], s43 offen sc1
  s_add_u32 s101, s101, 1
  s_cmp_gt_u32 s101, 131072
  s_cbranch_scc1 main_end
  s_waitcnt vmcnt(0)
  v_cmp_gt_u32 vcc, 8, v9
  s_nop 0
  s_or_b32 s21, vcc_lo, 0x40000
  s_ff1_i32_b32 s21, s21
  s_lshl_b32 s22, s21, 1
  s_lshl_b32 s21, s21, 2
  s_sub_i32 s21, s21, 8
  s_max_i32 s47, s21, s22
  s_cmp_gt_u32 s47, s45
  s_cbranch_scc0 va_170
va_169:
  s_add_u32 s22, s45, 6
  s_min_u32 s22, s22, s47
va_171:
  s_cmp_ge_u32 s46, s22
  s_cbranch_scc1 va_173
  s_mov_b32 m0, s64
  s_mov_b32 s66, s41
  buffer_load_dwordx4 v4, s[16:19], s66 offen offset:0 sc1 lds
  buffer_load_dwordx4 v4, s[16:19], s66 offen offset:1024 sc1 lds
  buffer_load_dwordx4 v4, s[16:19], s66 offen offset:2048 sc1 lds
  s_add_u32 s46, s46, 1
  s_add_u32 s41, s41, 393216
  s_add_u32 s64, s64, 12288
  s_cmp_lt_u32 s64, s67
  s_cselect_b32 s64, s64, s71
  s_branch va_171
va_173:
  s_mov_b32 s48, s46
  s_mov_b32 s49, s46
  s_mov_b32 s50, s46
  s_waitcnt vmcnt(0)
  s_barrier
  v_mov_b32 v8, v4
  s_add_u32 s65, s65, 12288
  s_cmp_lt_u32 s65, 98304
  s_cselect_b32 s65, s65, 0
  ds_read_b128 v[144:147], v8 offset:0
  ds_read_b128 v[148:151], v8 offset:1024
  ds_read_b128 v[152:155], v8 offset:2048
  ds_read_b128 v[156:159], v8 offset:3072
  ds_read_b128 v[160:163], v8 offset:4096
  ds_read_b128 v[164:167], v8 offset:5120
  ds_read_b128 v[168:171], v8 offset:6144
  ds_read_b128 v[172:175], v8 offset:7168
  ds_read_b128 v[176:179], v8 offset:8192
  ds_read_b128 v[180:183], v8 offset:9216
  ds_read_b128 v[184:187], v8 offset:10240
  ds_read_b128 v[188:191], v8 offset:11264
  s_mov_b32 s50, 0
  s_add_u32 s21, s45, 1
  s_min_u32 s21, s21, 63
  s_cmp_lt_u32 s21, s50
  s_cselect_b32 s21, 1, 0
  v_mov_b32 v21, s21
  ds_write_b32 v6, v21 offset:0
vwl_174:
  s_waitcnt lgkmcnt(0)
  s_barrier
  v_mfma_f32_16x16x32_bf16 v[64:67], v[144:147], a[0:3], 0
  v_add_u32 v8, s65, v4
  v_mfma_f32_16x16x32_bf16 v[72:75], v[144:147], a[24:27], 0
  ds_read_b128 v[240:243], v7 offset:0
  v_mfma_f32_16x16x32_bf16 v[80:83], v[144:147], a[48:51], 0
  ds_read_b128 v[192:195], v8 offset:0
  s_add_u32 s65, s65, 12288
  v_mfma_f32_16x16x32_bf16 v[88:91], v[144:147], a[72:75], 0
  v_cvt_pk_bf16_f32 v44, v104, v105
  v_mfma_f32_16x16x32_bf16 v[96:99], v[144:147], a[96:99], 0
  s_cmp_lt_u32 s65, 98304
  s_cselect_b32 s65, s65, 0
  v_mfma_f32_16x16x32_bf16 v[68:71], v[168:171], a[0:3], 0
  v_cvt_pk_bf16_f32 v45, v106, v107
  v_mfma_f32_16x16x32_bf16 v[76:79], v[168:171], a[24:27], 0
  v_cmp_gt_u32 vcc, 8, v9
  s_nop 0
  v_mfma_f32_16x16x32_bf16 v[84:87], v[168:171], a[48:51], 0
  v_cvt_pk_bf16_f32 v46, v108, v109
  s_or_b32 s21, vcc_lo, 0x40000
  v_mfma_f32_16x16x32_bf16 v[92:95], v[168:171], a[72:75], 0
  s_ff1_i32_b32 s21, s21
  s_lshl_b32 s22, s21, 1
  v_mfma_f32_16x16x32_bf16 v[100:103], v[168:171], a[96:99], 0
  ds_read_b128 v[196:199], v8 offset:1024
  v_cvt_pk_bf16_f32 v47, v110, v111
  v_mfma_f32_16x16x32_bf16 v[64:67], v[148:151], a[4:7], v[64:67]
  s_lshl_b32 s21, s21, 2
  s_sub_i32 s21, s21, 8
  v_mfma_f32_16x16x32_bf16 v[72:75], v[148:151], a[28:31], v[72:75]
  s_add_u32 s69, s68, 4096
  s_max_i32 s47, s21, s22
  v_mfma_f32_16x16x32_bf16 v[80:83], v[148:151], a[52:55], v[80:83]
  s_add_u32 s22, s45, 7
  s_min_u32 s22, s22, s47
  v_mfma_f32_16x16x32_bf16 v[88:91], v[148:151], a[76:79], v[88:91]
  buffer_store_dwordx4 v[44:47], v4, s[24:27], s69 offen offset:1024 sc1
  v_mfma_f32_16x16x32_bf16 v[96:99], v[148:151], a[100:103], v[96:99]
  s_cmp_lt_u32 s46, s22
  s_cselect_b32 s66, s41, 0x80000000
  s_cselect_b32 m0, s64, 98304
  s_cselect_b32 s22, 1, 0
  v_mfma_f32_16x16x32_bf16 v[68:71], v[172:175], a[4:7], v[68:71]
  v_cvt_pk_bf16_f32 v48, v112, v113
  v_mfma_f32_16x16x32_bf16 v[76:79], v[172:175], a[28:31], v[76:79]
  ds_read_b128 v[200:203], v8 offset:2048
  v_mfma_f32_16x16x32_bf16 v[84:87], v[172:175], a[52:55], v[84:87]
  v_cvt_pk_bf16_f32 v49, v114, v115
  v_mfma_f32_16x16x32_bf16 v[92:95], v[172:175], a[76:79], v[92:95]
  buffer_load_dword v9, v5, s[72:75], s43 offen sc1
  v_mfma_f32_16x16x32_bf16 v[100:103], v[172:175], a[100:103], v[100:103]
  v_cvt_pk_bf16_f32 v50, v116, v117
  v_mfma_f32_16x16x32_bf16 v[64:67], v[152:155], a[8:11], v[64:67]
  v_mfma_f32_16x16x32_bf16 v[72:75], v[152:155], a[32:35], v[72:75]
  v_cvt_pk_bf16_f32 v51, v118, v119
  v_mfma_f32_16x16x32_bf16 v[80:83], v[152:155], a[56:59], v[80:83]
  buffer_load_dwordx4 v4, s[16:19], s66 offen offset:0 sc1 lds
  v_mfma_f32_16x16x32_bf16 v[88:91], v[152:155], a[80:83], v[88:91]
  ds_read_b128 v[204:207], v8 offset:3072
  v_mfma_f32_16x16x32_bf16 v[96:99], v[152:155], a[104:107], v[96:99]
  buffer_store_dwordx4 v[48:51], v4, s[24:27], s69 offen offset:2048 sc1
  v_mfma_f32_16x16x32_bf16 v[68:71], v[176:179], a[8:11], v[68:71]
  v_cvt_pk_bf16_f32 v52, v120, v121
  v_mfma_f32_16x16x32_bf16 v[76:79], v[176:179], a[32:35], v[76:79]
  v_mfma_f32_16x16x32_bf16 v[84:87], v[176:179], a[56:59], v[84:87]
  v_cvt_pk_bf16_f32 v53, v122, v123
  v_mfma_f32_16x16x32_bf16 v[92:95], v[176:179], a[80:83], v[92:95]
  buffer_load_dwordx4 v4, s[16:19], s66 offen offset:1024 sc1 lds
  v_mfma_f32_16x16x32_bf16 v[100:103], v[176:179], a[104:107], v[100:103]
  v_cvt_pk_bf16_f32 v54, v124, v125
  v_mfma_f32_16x16x32_bf16 v[64:67], v[156:159], a[12:15], v[64:67]
  ds_read_b128 v[208:211], v8 offset:4096
  v_mfma_f32_16x16x32_bf16 v[72:75], v[156:159], a[36:39], v[72:75]
  v_cvt_pk_bf16_f32 v55, v126, v127
  v_mfma_f32_16x16x32_bf16 v[80:83], v[156:159], a[60:63], v[80:83]
  v_mfma_f32_16x16x32_bf16 v[88:91], v[156:159], a[84:87], v[88:91]
  buffer_store_dwordx4 v[52:55], v4, s[24:27], s69 offen offset:3072 sc1
  v_mfma_f32_16x16x32_bf16 v[96:99], v[156:159], a[108:111], v[96:99]
  buffer_load_dwordx4 v4, s[16:19], s66 offen offset:2048 sc1 lds
  v_mfma_f32_16x16x32_bf16 v[68:71], v[180:183], a[12:15], v[68:71]
  v_cvt_pk_bf16_f32 v56, v128, v129
  s_add_u32 s46, s46, s22
  v_mfma_f32_16x16x32_bf16 v[76:79], v[180:183], a[36:39], v[76:79]
  s_mul_i32 s21, s22, 393216
  s_add_u32 s41, s41, s21
  v_mfma_f32_16x16x32_bf16 v[84:87], v[180:183], a[60:63], v[84:87]
  ds_read_b128 v[212:215], v8 offset:5120
  v_cvt_pk_bf16_f32 v57, v130, v131
  v_mfma_f32_16x16x32_bf16 v[92:95], v[180:183], a[84:87], v[92:95]
  s_mul_i32 s21, s22, 12288
  s_add_u32 s64, s64, s21
  v_mfma_f32_16x16x32_bf16 v[100:103], v[180:183], a[108:111], v[100:103]
  v_cvt_pk_bf16_f32 v58, v132, v133
  v_mfma_f32_16x16x32_bf16 v[64:67], v[160:163], a[16:19], v[64:67]
  s_cmp_lt_u32 s64, s67
  s_cselect_b32 s64, s64, s71
  v_mfma_f32_16x16x32_bf16 v[72:75], v[160:163], a[40:43], v[72:75]
  v_cvt_pk_bf16_f32 v59, v134, v135
  v_mfma_f32_16x16x32_bf16 v[80:83], v[160:163], a[64:67], v[80:83]
  v_mfma_f32_16x16x32_bf16 v[88:91], v[160:163], a[88:91], v[88:91]
  s_add_u32 s69, s68, 8192
  v_mfma_f32_16x16x32_bf16 v[96:99], v[160:163], a[112:115], v[96:99]
  ds_read_b128 v[216:219], v8 offset:6144
  v_mfma_f32_16x16x32_bf16 v[68:71], v[184:187], a[16:19], v[68:71]
  buffer_store_dwordx4 v[56:59], v4, s[24:27], s69 offen offset:0 sc1
  v_mfma_f32_16x16x32_bf16 v[76:79], v[184:187], a[40:43], v[76:79]
  v_mfma_f32_16x16x32_bf16 v[84:87], v[184:187], a[64:67], v[84:87]
  v_cvt_pk_bf16_f32 v60, v136, v137
  v_mfma_f32_16x16x32_bf16 v[92:95], v[184:187], a[88:91], v[92:95]
  v_mfma_f32_16x16x32_bf16 v[100:103], v[184:187], a[112:115], v[100:103]
  v_cvt_pk_bf16_f32 v61, v138, v139
  v_mfma_f32_16x16x32_bf16 v[64:67], v[164:167], a[20:23], v[64:67]
  v_mfma_f32_16x16x32_bf16 v[72:75], v[164:167], a[44:47], v[72:75]
  ds_read_b128 v[220:223], v8 offset:7168
  v_cvt_pk_bf16_f32 v62, v140, v141
  v_mfma_f32_16x16x32_bf16 v[80:83], v[164:167], a[68:71], v[80:83]
  v_mfma_f32_16x16x32_bf16 v[88:91], v[164:167], a[92:95], v[88:91]
  v_cvt_pk_bf16_f32 v63, v142, v143
  v_mfma_f32_16x16x32_bf16 v[96:99], v[164:167], a[116:119], v[96:99]
  v_mfma_f32_16x16x32_bf16 v[68:71], v[188:191], a[20:23], v[68:71]
  buffer_store_dwordx4 v[60:63], v4, s[24:27], s69 offen offset:1024 sc1
  v_mfma_f32_16x16x32_bf16 v[76:79], v[188:191], a[44:47], v[76:79]
  v_mfma_f32_16x16x32_bf16 v[84:87], v[188:191], a[68:71], v[84:87]
  v_mfma_f32_16x16x32_bf16 v[92:95], v[188:191], a[92:95], v[92:95]
  ds_read_b128 v[224:227], v8 offset:8192
  v_mfma_f32_16x16x32_bf16 v[100:103], v[188:191], a[116:119], v[100:103]
  v_mfma_f32_16x16x32_bf16 v[104:107], v[144:147], a[120:123], 0
  v_mfma_f32_16x16x32_bf16 v[112:115], v[144:147], a[144:147], 0
  v_mfma_f32_16x16x32_bf16 v[120:123], v[144:147], a[168:171], 0
  v_mfma_f32_16x16x32_bf16 v[128:131], v[144:147], a[192:195], 0
  v_cvt_pk_bf16_f32 v24, v64, v65
  v_mfma_f32_16x16x32_bf16 v[136:139], v[144:147], a[216:219], 0
  v_mfma_f32_16x16x32_bf16 v[108:111], v[168:171], a[120:123], 0
  ds_read_b128 v[228:231], v8 offset:9216
  v_cvt_pk_bf16_f32 v25, v66, v67
  v_mfma_f32_16x16x32_bf16 v[116:119], v[168:171], a[144:147], 0
  s_cmp_lt_u32 s51, 6291456
  s_cselect_b32 s52, s51, 0x80000000
  v_mfma_f32_16x16x32_bf16 v[124:127], v[168:171], a[168:171], 0
  v_cvt_pk_bf16_f32 v26, v68, v69
  v_mfma_f32_16x16x32_bf16 v[132:135], v[168:171], a[192:195], 0
  buffer_store_dwordx4 v[244:247], v4, s[84:87], s52 offen sc1
  v_mfma_f32_16x16x32_bf16 v[140:143], v[168:171], a[216:219], 0
  v_cvt_pk_bf16_f32 v27, v70, v71
  s_add_u32 s52, s52, 6291456
  v_mfma_f32_16x16x32_bf16 v[104:107], v[148:151], a[124:127], v[104:107]
  s_add_u32 s51, s51, 98304
  v_mfma_f32_16x16x32_bf16 v[112:115], v[148:151], a[148:151], v[112:115]
  buffer_store_dwordx4 v[24:27], v4, s[24:27], s42 offen offset:0 sc1
  v_mfma_f32_16x16x32_bf16 v[120:123], v[148:151], a[172:175], v[120:123]
  ds_read_b128 v[232:235], v8 offset:10240
  v_mfma_f32_16x16x32_bf16 v[128:131], v[148:151], a[196:199], v[128:131]
  v_cvt_pk_bf16_f32 v28, v72, v73
  v_mfma_f32_16x16x32_bf16 v[136:139], v[148:151], a[220:223], v[136:139]
  v_cvt_pk_bf16_f32 v29, v74, v75
  v_mfma_f32_16x16x32_bf16 v[108:111], v[172:175], a[124:127], v[108:111]
  v_mfma_f32_16x16x32_bf16 v[116:119], v[172:175], a[148:151], v[116:119]
  v_cvt_pk_bf16_f32 v30, v76, v77
  v_mfma_f32_16x16x32_bf16 v[124:127], v[172:175], a[172:175], v[124:127]
  v_mfma_f32_16x16x32_bf16 v[132:135], v[172:175], a[196:199], v[132:135]
  v_cvt_pk_bf16_f32 v31, v78, v79
  v_mfma_f32_16x16x32_bf16 v[140:143], v[172:175], a[220:223], v[140:143]
  ds_read_b128 v[236:239], v8 offset:11264
  v_mfma_f32_16x16x32_bf16 v[104:107], v[152:155], a[128:131], v[104:107]
  buffer_store_dwordx4 v[28:31], v4, s[24:27], s42 offen offset:1024 sc1
  v_mfma_f32_16x16x32_bf16 v[112:115], v[152:155], a[152:155], v[112:115]
  v_mfma_f32_16x16x32_bf16 v[120:123], v[152:155], a[176:179], v[120:123]
  v_cvt_pk_bf16_f32 v32, v80, v81
  v_mfma_f32_16x16x32_bf16 v[128:131], v[152:155], a[200:203], v[128:131]
  v_mfma_f32_16x16x32_bf16 v[136:139], v[152:155], a[224:227], v[136:139]
  v_cvt_pk_bf16_f32 v33, v82, v83
  v_mfma_f32_16x16x32_bf16 v[108:111], v[176:179], a[128:131], v[108:111]
  v_cvt_pk_bf16_f32 v34, v84, v85
  v_mfma_f32_16x16x32_bf16 v[116:119], v[176:179], a[152:155], v[116:119]
  buffer_store_dwordx4 v[244:247], v4, s[84:87], s52 offen sc1
  v_mfma_f32_16x16x32_bf16 v[124:127], v[176:179], a[176:179], v[124:127]
  v_cvt_pk_bf16_f32 v35, v86, v87
  v_mfma_f32_16x16x32_bf16 v[132:135], v[176:179], a[200:203], v[132:135]
  v_mfma_f32_16x16x32_bf16 v[140:143], v[176:179], a[224:227], v[140:143]
  buffer_store_dwordx4 v[32:35], v4, s[24:27], s42 offen offset:2048 sc1
  v_mfma_f32_16x16x32_bf16 v[104:107], v[156:159], a[132:135], v[104:107]
  v_mfma_f32_16x16x32_bf16 v[112:115], v[156:159], a[156:159], v[112:115]
  v_cvt_pk_bf16_f32 v36, v88, v89
  v_mfma_f32_16x16x32_bf16 v[120:123], v[156:159], a[180:183], v[120:123]
  v_mfma_f32_16x16x32_bf16 v[128:131], v[156:159], a[204:207], v[128:131]
  v_cvt_pk_bf16_f32 v37, v90, v91
  v_mfma_f32_16x16x32_bf16 v[136:139], v[156:159], a[228:231], v[136:139]
  v_mfma_f32_16x16x32_bf16 v[108:111], v[180:183], a[132:135], v[108:111]
  v_cvt_pk_bf16_f32 v38, v92, v93
  v_mfma_f32_16x16x32_bf16 v[116:119], v[180:183], a[156:159], v[116:119]
  v_cvt_pk_bf16_f32 v39, v94, v95
  v_mfma_f32_16x16x32_bf16 v[124:127], v[180:183], a[180:183], v[124:127]
  v_mfma_f32_16x16x32_bf16 v[132:135], v[180:183], a[204:207], v[132:135]
  buffer_store_dwordx4 v[36:39], v4, s[24:27], s42 offen offset:3072 sc1
  v_mfma_f32_16x16x32_bf16 v[140:143], v[180:183], a[228:231], v[140:143]
  v_mfma_f32_16x16x32_bf16 v[104:107], v[160:163], a[136:139], v[104:107]
  v_cvt_pk_bf16_f32 v40, v96, v97
  s_waitcnt lgkmcnt(0)
  v_mfma_f32_16x16x32_bf16 v[112:115], v[160:163], a[160:163], v[112:115]
  v_and_b32 v240, v240, v241
  v_and_b32 v242, v242, v243
  v_mfma_f32_16x16x32_bf16 v[120:123], v[160:163], a[184:187], v[120:123]
  v_cvt_pk_bf16_f32 v41, v98, v99
  v_and_b32 v240, v240, v242
  v_mfma_f32_16x16x32_bf16 v[128:131], v[160:163], a[208:211], v[128:131]
  s_nop 0
  v_readfirstlane_b32 s23, v240
  v_mfma_f32_16x16x32_bf16 v[136:139], v[160:163], a[232:235], v[136:139]
  v_cvt_pk_bf16_f32 v42, v100, v101
  v_mfma_f32_16x16x32_bf16 v[108:111], v[184:187], a[136:139], v[108:111]
  v_mfma_f32_16x16x32_bf16 v[116:119], v[184:187], a[160:163], v[116:119]
  v_cvt_pk_bf16_f32 v43, v102, v103
  v_mfma_f32_16x16x32_bf16 v[124:127], v[184:187], a[184:187], v[124:127]
  s_add_u32 s69, s42, 4096
  v_mfma_f32_16x16x32_bf16 v[132:135], v[184:187], a[208:211], v[132:135]
  v_mfma_f32_16x16x32_bf16 v[140:143], v[184:187], a[232:235], v[140:143]
  buffer_store_dwordx4 v[40:43], v4, s[24:27], s69 offen offset:0 sc1
  v_mfma_f32_16x16x32_bf16 v[104:107], v[164:167], a[140:143], v[104:107]
  v_mfma_f32_16x16x32_bf16 v[112:115], v[164:167], a[164:167], v[112:115]
  v_mfma_f32_16x16x32_bf16 v[120:123], v[164:167], a[188:191], v[120:123]
  s_waitcnt vmcnt(16)
  s_mov_b32 s50, s48
  s_mov_b32 s49, s48
  v_mfma_f32_16x16x32_bf16 v[128:131], v[164:167], a[212:215], v[128:131]
  s_mov_b32 s48, s46
  s_sub_i32 s69, s45, 1
  s_max_i32 s69, s69, s70
  v_mfma_f32_16x16x32_bf16 v[136:139], v[164:167], a[236:239], v[136:139]
  s_add_u32 s45, s45, 1
  s_mov_b32 s68, s42
  s_add_u32 s42, s42, 1310720
  v_mfma_f32_16x16x32_bf16 v[108:111], v[188:191], a[140:143], v[108:111]
  s_add_u32 s21, s45, 1
  s_min_u32 s21, s21, 63
  v_mfma_f32_16x16x32_bf16 v[116:119], v[188:191], a[164:167], v[116:119]
  s_cmp_lt_u32 s21, s50
  s_cselect_b32 s21, 1, 0
  v_mov_b32 v21, s21
  v_mfma_f32_16x16x32_bf16 v[124:127], v[188:191], a[188:191], v[124:127]
  ds_write_b32 v6, v21 offset:16
  v_mfma_f32_16x16x32_bf16 v[132:135], v[188:191], a[212:215], v[132:135]
  v_mfma_f32_16x16x32_bf16 v[140:143], v[188:191], a[236:239], v[140:143]
  s_mov_b64 exec, 1
  v_mov_b32 v20, s69
  buffer_store_dword v20, v10, s[72:75], s44 offen sc1
  s_mov_b64 exec, -1
  s_cmp_eq_u32 s23, 0
  s_cbranch_scc1 vws_176
vwb_177:
  s_waitcnt lgkmcnt(0)
  s_barrier
  v_mfma_f32_16x16x32_bf16 v[64:67], v[192:195], a[0:3], 0
  v_add_u32 v8, s65, v4
  v_mfma_f32_16x16x32_bf16 v[72:75], v[192:195], a[24:27], 0
  ds_read_b128 v[240:243], v7 offset:16
  v_mfma_f32_16x16x32_bf16 v[80:83], v[192:195], a[48:51], 0
  ds_read_b128 v[144:147], v8 offset:0
  s_add_u32 s65, s65, 12288
  v_mfma_f32_16x16x32_bf16 v[88:91], v[192:195], a[72:75], 0
  v_cvt_pk_bf16_f32 v44, v104, v105
  v_mfma_f32_16x16x32_bf16 v[96:99], v[192:195], a[96:99], 0
  s_cmp_lt_u32 s65, 98304
  s_cselect_b32 s65, s65, 0
  v_mfma_f32_16x16x32_bf16 v[68:71], v[216:219], a[0:3], 0
  v_cvt_pk_bf16_f32 v45, v106, v107
  v_mfma_f32_16x16x32_bf16 v[76:79], v[216:219], a[24:27], 0
  v_cmp_gt_u32 vcc, 8, v9
  s_nop 0
  v_mfma_f32_16x16x32_bf16 v[84:87], v[216:219], a[48:51], 0
  v_cvt_pk_bf16_f32 v46, v108, v109
  s_or_b32 s21, vcc_lo, 0x40000
  v_mfma_f32_16x16x32_bf16 v[92:95], v[216:219], a[72:75], 0
  s_ff1_i32_b32 s21, s21
  s_lshl_b32 s22, s21, 1
  v_mfma_f32_16x16x32_bf16 v[100:103], v[216:219], a[96:99], 0
  ds_read_b128 v[148:151], v8 offset:1024
  v_cvt_pk_bf16_f32 v47, v110, v111
  v_mfma_f32_16x16x32_bf16 v[64:67], v[196:199], a[4:7], v[64:67]
  s_lshl_b32 s21, s21, 2
  s_sub_i32 s21, s21, 8
  v_mfma_f32_16x16x32_bf16 v[72:75], v[196:199], a[28:31], v[72:75]
  s_add_u32 s69, s68, 4096
  s_max_i32 s47, s21, s22
  v_mfma_f32_16x16x32_bf16 v[80:83], v[196:199], a[52:55], v[80:83]
  s_add_u32 s22, s45, 7
  s_min_u32 s22, s22, s47
  v_mfma_f32_16x16x32_bf16 v[88:91], v[196:199], a[76:79], v[88:91]
  buffer_store_dwordx4 v[44:47], v4, s[24:27], s69 offen offset:1024 sc1
  v_mfma_f32_16x16x32_bf16 v[96:99], v[196:199], a[100:103], v[96:99]
  s_cmp_lt_u32 s46, s22
  s_cselect_b32 s66, s41, 0x80000000
  s_cselect_b32 m0, s64, 98304
  s_cselect_b32 s22, 1, 0
  v_mfma_f32_16x16x32_bf16 v[68:71], v[220:223], a[4:7], v[68:71]
  v_cvt_pk_bf16_f32 v48, v112, v113
  v_mfma_f32_16x16x32_bf16 v[76:79], v[220:223], a[28:31], v[76:79]
  ds_read_b128 v[152:155], v8 offset:2048
  v_mfma_f32_16x16x32_bf16 v[84:87], v[220:223], a[52:55], v[84:87]
  v_cvt_pk_bf16_f32 v49, v114, v115
  v_mfma_f32_16x16x32_bf16 v[92:95], v[220:223], a[76:79], v[92:95]
  buffer_load_dword v9, v5, s[72:75], s43 offen sc1
  v_mfma_f32_16x16x32_bf16 v[100:103], v[220:223], a[100:103], v[100:103]
  v_cvt_pk_bf16_f32 v50, v116, v117
  v_mfma_f32_16x16x32_bf16 v[64:67], v[200:203], a[8:11], v[64:67]
  v_mfma_f32_16x16x32_bf16 v[72:75], v[200:203], a[32:35], v[72:75]
  v_cvt_pk_bf16_f32 v51, v118, v119
  v_mfma_f32_16x16x32_bf16 v[80:83], v[200:203], a[56:59], v[80:83]
  buffer_load_dwordx4 v4, s[16:19], s66 offen offset:0 sc1 lds
  v_mfma_f32_16x16x32_bf16 v[88:91], v[200:203], a[80:83], v[88:91]
  ds_read_b128 v[156:159], v8 offset:3072
  v_mfma_f32_16x16x32_bf16 v[96:99], v[200:203], a[104:107], v[96:99]
  buffer_store_dwordx4 v[48:51], v4, s[24:27], s69 offen offset:2048 sc1
  v_mfma_f32_16x16x32_bf16 v[68:71], v[224:227], a[8:11], v[68:71]
  v_cvt_pk_bf16_f32 v52, v120, v121
  v_mfma_f32_16x16x32_bf16 v[76:79], v[224:227], a[32:35], v[76:79]
  v_mfma_f32_16x16x32_bf16 v[84:87], v[224:227], a[56:59], v[84:87]
  v_cvt_pk_bf16_f32 v53, v122, v123
  v_mfma_f32_16x16x32_bf16 v[92:95], v[224:227], a[80:83], v[92:95]
  buffer_load_dwordx4 v4, s[16:19], s66 offen offset:1024 sc1 lds
  v_mfma_f32_16x16x32_bf16 v[100:103], v[224:227], a[104:107], v[100:103]
  v_cvt_pk_bf16_f32 v54, v124, v125
  v_mfma_f32_16x16x32_bf16 v[64:67], v[204:207], a[12:15], v[64:67]
  ds_read_b128 v[160:163], v8 offset:4096
  v_mfma_f32_16x16x32_bf16 v[72:75], v[204:207], a[36:39], v[72:75]
  v_cvt_pk_bf16_f32 v55, v126, v127
  v_mfma_f32_16x16x32_bf16 v[80:83], v[204:207], a[60:63], v[80:83]
  v_mfma_f32_16x16x32_bf16 v[88:91], v[204:207], a[84:87], v[88:91]
  buffer_store_dwordx4 v[52:55], v4, s[24:27], s69 offen offset:3072 sc1
  v_mfma_f32_16x16x32_bf16 v[96:99], v[204:207], a[108:111], v[96:99]
  buffer_load_dwordx4 v4, s[16:19], s66 offen offset:2048 sc1 lds
  v_mfma_f32_16x16x32_bf16 v[68:71], v[228:231], a[12:15], v[68:71]
  v_cvt_pk_bf16_f32 v56, v128, v129
  s_add_u32 s46, s46, s22
  v_mfma_f32_16x16x32_bf16 v[76:79], v[228:231], a[36:39], v[76:79]
  s_mul_i32 s21, s22, 393216
  s_add_u32 s41, s41, s21
  v_mfma_f32_16x16x32_bf16 v[84:87], v[228:231], a[60:63], v[84:87]
  ds_read_b128 v[164:167], v8 offset:5120
  v_cvt_pk_bf16_f32 v57, v130, v131
  v_mfma_f32_16x16x32_bf16 v[92:95], v[228:231], a[84:87], v[92:95]
  s_mul_i32 s21, s22, 12288
  s_add_u32 s64, s64, s21
  v_mfma_f32_16x16x32_bf16 v[100:103], v[228:231], a[108:111], v[100:103]
  v_cvt_pk_bf16_f32 v58, v132, v133
  v_mfma_f32_16x16x32_bf16 v[64:67], v[208:211], a[16:19], v[64:67]
  s_cmp_lt_u32 s64, s67
  s_cselect_b32 s64, s64, s71
  v_mfma_f32_16x16x32_bf16 v[72:75], v[208:211], a[40:43], v[72:75]
  v_cvt_pk_bf16_f32 v59, v134, v135
  v_mfma_f32_16x16x32_bf16 v[80:83], v[208:211], a[64:67], v[80:83]
  v_mfma_f32_16x16x32_bf16 v[88:91], v[208:211], a[88:91], v[88:91]
  s_add_u32 s69, s68, 8192
  v_mfma_f32_16x16x32_bf16 v[96:99], v[208:211], a[112:115], v[96:99]
  ds_read_b128 v[168:171], v8 offset:6144
  v_mfma_f32_16x16x32_bf16 v[68:71], v[232:235], a[16:19], v[68:71]
  buffer_store_dwordx4 v[56:59], v4, s[24:27], s69 offen offset:0 sc1
  v_mfma_f32_16x16x32_bf16 v[76:79], v[232:235], a[40:43], v[76:79]
  v_mfma_f32_16x16x32_bf16 v[84:87], v[232:235], a[64:67], v[84:87]
  v_cvt_pk_bf16_f32 v60, v136, v137
  v_mfma_f32_16x16x32_bf16 v[92:95], v[232:235], a[88:91], v[92:95]
  v_mfma_f32_16x16x32_bf16 v[100:103], v[232:235], a[112:115], v[100:103]
  v_cvt_pk_bf16_f32 v61, v138, v139
  v_mfma_f32_16x16x32_bf16 v[64:67], v[212:215], a[20:23], v[64:67]
  v_mfma_f32_16x16x32_bf16 v[72:75], v[212:215], a[44:47], v[72:75]
  ds_read_b128 v[172:175], v8 offset:7168
  v_cvt_pk_bf16_f32 v62, v140, v141
  v_mfma_f32_16x16x32_bf16 v[80:83], v[212:215], a[68:71], v[80:83]
  v_mfma_f32_16x16x32_bf16 v[88:91], v[212:215], a[92:95], v[88:91]
  v_cvt_pk_bf16_f32 v63, v142, v143
  v_mfma_f32_16x16x32_bf16 v[96:99], v[212:215], a[116:119], v[96:99]
  v_mfma_f32_16x16x32_bf16 v[68:71], v[236:239], a[20:23], v[68:71]
  buffer_store_dwordx4 v[60:63], v4, s[24:27], s69 offen offset:1024 sc1
  v_mfma_f32_16x16x32_bf16 v[76:79], v[236:239], a[44:47], v[76:79]
  v_mfma_f32_16x16x32_bf16 v[84:87], v[236:239], a[68:71], v[84:87]
  v_mfma_f32_16x16x32_bf16 v[92:95], v[236:239], a[92:95], v[92:95]
  ds_read_b128 v[176:179], v8 offset:8192
  v_mfma_f32_16x16x32_bf16 v[100:103], v[236:239], a[116:119], v[100:103]
  v_mfma_f32_16x16x32_bf16 v[104:107], v[192:195], a[120:123], 0
  v_mfma_f32_16x16x32_bf16 v[112:115], v[192:195], a[144:147], 0
  v_mfma_f32_16x16x32_bf16 v[120:123], v[192:195], a[168:171], 0
  v_mfma_f32_16x16x32_bf16 v[128:131], v[192:195], a[192:195], 0
  v_cvt_pk_bf16_f32 v24, v64, v65
  v_mfma_f32_16x16x32_bf16 v[136:139], v[192:195], a[216:219], 0
  v_mfma_f32_16x16x32_bf16 v[108:111], v[216:219], a[120:123], 0
  ds_read_b128 v[180:183], v8 offset:9216
  v_cvt_pk_bf16_f32 v25, v66, v67
  v_mfma_f32_16x16x32_bf16 v[116:119], v[216:219], a[144:147], 0
  s_cmp_lt_u32 s51, 6291456
  s_cselect_b32 s52, s51, 0x80000000
  v_mfma_f32_16x16x32_bf16 v[124:127], v[216:219], a[168:171], 0
  v_cvt_pk_bf16_f32 v26, v68, v69
  v_mfma_f32_16x16x32_bf16 v[132:135], v[216:219], a[192:195], 0
  buffer_store_dwordx4 v[244:247], v4, s[84:87], s52 offen sc1
  v_mfma_f32_16x16x32_bf16 v[140:143], v[216:219], a[216:219], 0
  v_cvt_pk_bf16_f32 v27, v70, v71
  s_add_u32 s52, s52, 6291456
  v_mfma_f32_16x16x32_bf16 v[104:107], v[196:199], a[124:127], v[104:107]
  s_add_u32 s51, s51, 98304
  v_mfma_f32_16x16x32_bf16 v[112:115], v[196:199], a[148:151], v[112:115]
  buffer_store_dwordx4 v[24:27], v4, s[24:27], s42 offen offset:0 sc1
  v_mfma_f32_16x16x32_bf16 v[120:123], v[196:199], a[172:175], v[120:123]
  ds_read_b128 v[184:187], v8 offset:10240
  v_mfma_f32_16x16x32_bf16 v[128:131], v[196:199], a[196:199], v[128:131]
  v_cvt_pk_bf16_f32 v28, v72, v73
  v_mfma_f32_16x16x32_bf16 v[136:139], v[196:199], a[220:223], v[136:139]
  v_cvt_pk_bf16_f32 v29, v74, v75
  v_mfma_f32_16x16x32_bf16 v[108:111], v[220:223], a[124:127], v[108:111]
  v_mfma_f32_16x16x32_bf16 v[116:119], v[220:223], a[148:151], v[116:119]
  v_cvt_pk_bf16_f32 v30, v76, v77
  v_mfma_f32_16x16x32_bf16 v[124:127], v[220:223], a[172:175], v[124:127]
  v_mfma_f32_16x16x32_bf16 v[132:135], v[220:223], a[196:199], v[132:135]
  v_cvt_pk_bf16_f32 v31, v78, v79
  v_mfma_f32_16x16x32_bf16 v[140:143], v[220:223], a[220:223], v[140:143]
  ds_read_b128 v[188:191], v8 offset:11264
  v_mfma_f32_16x16x32_bf16 v[104:107], v[200:203], a[128:131], v[104:107]
  buffer_store_dwordx4 v[28:31], v4, s[24:27], s42 offen offset:1024 sc1
  v_mfma_f32_16x16x32_bf16 v[112:115], v[200:203], a[152:155], v[112:115]
  v_mfma_f32_16x16x32_bf16 v[120:123], v[200:203], a[176:179], v[120:123]
  v_cvt_pk_bf16_f32 v32, v80, v81
  v_mfma_f32_16x16x32_bf16 v[128:131], v[200:203], a[200:203], v[128:131]
  v_mfma_f32_16x16x32_bf16 v[136:139], v[200:203], a[224:227], v[136:139]
  v_cvt_pk_bf16_f32 v33, v82, v83
  v_mfma_f32_16x16x32_bf16 v[108:111], v[224:227], a[128:131], v[108:111]
  v_cvt_pk_bf16_f32 v34, v84, v85
  v_mfma_f32_16x16x32_bf16 v[116:119], v[224:227], a[152:155], v[116:119]
  buffer_store_dwordx4 v[244:247], v4, s[84:87], s52 offen sc1
  v_mfma_f32_16x16x32_bf16 v[124:127], v[224:227], a[176:179], v[124:127]
  v_cvt_pk_bf16_f32 v35, v86, v87
  v_mfma_f32_16x16x32_bf16 v[132:135], v[224:227], a[200:203], v[132:135]
  v_mfma_f32_16x16x32_bf16 v[140:143], v[224:227], a[224:227], v[140:143]
  buffer_store_dwordx4 v[32:35], v4, s[24:27], s42 offen offset:2048 sc1
  v_mfma_f32_16x16x32_bf16 v[104:107], v[204:207], a[132:135], v[104:107]
  v_mfma_f32_16x16x32_bf16 v[112:115], v[204:207], a[156:159], v[112:115]
  v_cvt_pk_bf16_f32 v36, v88, v89
  v_mfma_f32_16x16x32_bf16 v[120:123], v[204:207], a[180:183], v[120:123]
  v_mfma_f32_16x16x32_bf16 v[128:131], v[204:207], a[204:207], v[128:131]
  v_cvt_pk_bf16_f32 v37, v90, v91
  v_mfma_f32_16x16x32_bf16 v[136:139], v[204:207], a[228:231], v[136:139]
  v_mfma_f32_16x16x32_bf16 v[108:111], v[228:231], a[132:135], v[108:111]
  v_cvt_pk_bf16_f32 v38, v92, v93
  v_mfma_f32_16x16x32_bf16 v[116:119], v[228:231], a[156:159], v[116:119]
  v_cvt_pk_bf16_f32 v39, v94, v95
  v_mfma_f32_16x16x32_bf16 v[124:127], v[228:231], a[180:183], v[124:127]
  v_mfma_f32_16x16x32_bf16 v[132:135], v[228:231], a[204:207], v[132:135]
  buffer_store_dwordx4 v[36:39], v4, s[24:27], s42 offen offset:3072 sc1
  v_mfma_f32_16x16x32_bf16 v[140:143], v[228:231], a[228:231], v[140:143]
  v_mfma_f32_16x16x32_bf16 v[104:107], v[208:211], a[136:139], v[104:107]
  v_cvt_pk_bf16_f32 v40, v96, v97
  s_waitcnt lgkmcnt(0)
  v_mfma_f32_16x16x32_bf16 v[112:115], v[208:211], a[160:163], v[112:115]
  v_and_b32 v240, v240, v241
  v_and_b32 v242, v242, v243
  v_mfma_f32_16x16x32_bf16 v[120:123], v[208:211], a[184:187], v[120:123]
  v_cvt_pk_bf16_f32 v41, v98, v99
  v_and_b32 v240, v240, v242
  v_mfma_f32_16x16x32_bf16 v[128:131], v[208:211], a[208:211], v[128:131]
  s_nop 0
  v_readfirstlane_b32 s23, v240
  v_mfma_f32_16x16x32_bf16 v[136:139], v[208:211], a[232:235], v[136:139]
  v_cvt_pk_bf16_f32 v42, v100, v101
  v_mfma_f32_16x16x32_bf16 v[108:111], v[232:235], a[136:139], v[108:111]
  v_mfma_f32_16x16x32_bf16 v[116:119], v[232:235], a[160:163], v[116:119]
  v_cvt_pk_bf16_f32 v43, v102, v103
  v_mfma_f32_16x16x32_bf16 v[124:127], v[232:235], a[184:187], v[124:127]
  s_add_u32 s69, s42, 4096
  v_mfma_f32_16x16x32_bf16 v[132:135], v[232:235], a[208:211], v[132:135]
  v_mfma_f32_16x16x32_bf16 v[140:143], v[232:235], a[232:235], v[140:143]
  buffer_store_dwordx4 v[40:43], v4, s[24:27], s69 offen offset:0 sc1
  v_mfma_f32_16x16x32_bf16 v[104:107], v[212:215], a[140:143], v[104:107]
  v_mfma_f32_16x16x32_bf16 v[112:115], v[212:215], a[164:167], v[112:115]
  v_mfma_f32_16x16x32_bf16 v[120:123], v[212:215], a[188:191], v[120:123]
  s_waitcnt vmcnt(16)
  s_mov_b32 s50, s48
  s_mov_b32 s49, s48
  v_mfma_f32_16x16x32_bf16 v[128:131], v[212:215], a[212:215], v[128:131]
  s_mov_b32 s48, s46
  s_sub_i32 s69, s45, 1
  s_max_i32 s69, s69, s70
  v_mfma_f32_16x16x32_bf16 v[136:139], v[212:215], a[236:239], v[136:139]
  s_add_u32 s45, s45, 1
  s_mov_b32 s68, s42
  s_add_u32 s42, s42, 1310720
  v_mfma_f32_16x16x32_bf16 v[108:111], v[236:239], a[140:143], v[108:111]
  s_add_u32 s21, s45, 1
  s_min_u32 s21, s21, 63
  v_mfma_f32_16x16x32_bf16 v[116:119], v[236:239], a[164:167], v[116:119]
  s_cmp_lt_u32 s21, s50
  s_cselect_b32 s21, 1, 0
  v_mov_b32 v21, s21
  v_mfma_f32_16x16x32_bf16 v[124:127], v[236:239], a[188:191], v[124:127]
  ds_write_b32 v6, v21 offset:0
  v_mfma_f32_16x16x32_bf16 v[132:135], v[236:239], a[212:215], v[132:135]
  v_mfma_f32_16x16x32_bf16 v[140:143], v[236:239], a[236:239], v[140:143]
  s_mov_b64 exec, 1
  v_mov_b32 v20, s69
  buffer_store_dword v20, v10, s[72:75], s44 offen sc1
  s_mov_b64 exec, -1
  s_cmp_lg_u32 s45, 24
  s_cbranch_scc1 arm_180
  s_mul_i32 s21, s2, 10240
  s_mul_i32 s22, s20, 2560
  s_add_u32 s21, s21, s22
  s_add_u32 s21, s21, 18350080
  buffer_store_dwordx4 v[244:247], v15, s[80:83], s21 offen offset:0 sc1
  buffer_store_dwordx4 v[244:247], v15, s[80:83], s21 offen offset:512 sc1
  buffer_store_dwordx4 v[244:247], v15, s[80:83], s21 offen offset:1024 sc1
  buffer_store_dwordx4 v[244:247], v15, s[80:83], s21 offen offset:1536 sc1
  buffer_store_dwordx4 v[244:247], v15, s[80:83], s21 offen offset:2048 sc1
  s_add_u32 s21, s21, 655360
  buffer_store_dwordx4 v[244:247], v15, s[80:83], s21 offen offset:0 sc1
  buffer_store_dwordx4 v[244:247], v15, s[80:83], s21 offen offset:512 sc1
  buffer_store_dwordx4 v[244:247], v15, s[80:83], s21 offen offset:1024 sc1
  buffer_store_dwordx4 v[244:247], v15, s[80:83], s21 offen offset:1536 sc1
  buffer_store_dwordx4 v[244:247], v15, s[80:83], s21 offen offset:2048 sc1
  s_add_u32 s21, s21, 655360
  buffer_store_dwordx4 v[244:247], v15, s[80:83], s21 offen offset:0 sc1
  buffer_store_dwordx4 v[244:247], v15, s[80:83], s21 offen offset:512 sc1
  buffer_store_dwordx4 v[244:247], v15, s[80:83], s21 offen offset:1024 sc1
  buffer_store_dwordx4 v[244:247], v15, s[80:83], s21 offen offset:1536 sc1
  buffer_store_dwordx4 v[244:247], v15, s[80:83], s21 offen offset:2048 sc1
  s_add_u32 s21, s21, 655360
  buffer_store_dwordx4 v[244:247], v15, s[80:83], s21 offen offset:0 sc1
  buffer_store_dwordx4 v[244:247], v15, s[80:83], s21 offen offset:512 sc1
  buffer_store_dwordx4 v[244:247], v15, s[80:83], s21 offen offset:1024 sc1
  buffer_store_dwordx4 v[244:247], v15, s[80:83], s21 offen offset:1536 sc1
  buffer_store_dwordx4 v[244:247], v15, s[80:83], s21 offen offset:2048 sc1
  s_add_u32 s21, s21, 655360
  s_and_b32 s21, s2, 3
  s_cmp_lg_u32 s21, s20
  s_cbranch_scc1 arm_180
  s_mul_i32 s21, s2, 2560
  s_add_u32 s21, s21, 4587520
  v_lshlrev_b32 v21, 3, v1
  buffer_store_dwordx4 v[244:247], v4, s[88:91], s21 offen sc1
  buffer_store_dwordx4 v[244:247], v4, s[88:91], s21 offen offset:1024 sc1
  buffer_store_dwordx2 v[244:245], v21, s[88:91], s21 offen offset:2048 sc1
  s_add_u32 s21, s21, 81920
  buffer_store_dwordx4 v[244:247], v4, s[88:91], s21 offen sc1
  buffer_store_dwordx4 v[244:247], v4, s[88:91], s21 offen offset:1024 sc1
  buffer_store_dwordx2 v[244:245], v21, s[88:91], s21 offen offset:2048 sc1
  s_add_u32 s21, s21, 81920
  buffer_store_dwordx4 v[244:247], v4, s[88:91], s21 offen sc1
  buffer_store_dwordx4 v[244:247], v4, s[88:91], s21 offen offset:1024 sc1
  buffer_store_dwordx2 v[244:245], v21, s[88:91], s21 offen offset:2048 sc1
  s_add_u32 s21, s21, 81920
  buffer_store_dwordx4 v[244:247], v4, s[88:91], s21 offen sc1
  buffer_store_dwordx4 v[244:247], v4, s[88:91], s21 offen offset:1024 sc1
  buffer_store_dwordx2 v[244:245], v21, s[88:91], s21 offen offset:2048 sc1
  s_add_u32 s21, s21, 81920
  buffer_store_dwordx4 v[244:247], v4, s[88:91], s21 offen sc1
  buffer_store_dwordx4 v[244:247], v4, s[88:91], s21 offen offset:1024 sc1
  buffer_store_dwordx2 v[244:245], v21, s[88:91], s21 offen offset:2048 sc1
  s_add_u32 s21, s21, 81920
  buffer_store_dwordx4 v[244:247], v4, s[88:91], s21 offen sc1
  buffer_store_dwordx4 v[244:247], v4, s[88:91], s21 offen offset:1024 sc1
  buffer_store_dwordx2 v[244:245], v21, s[88:91], s21 offen offset:2048 sc1
  s_add_u32 s21, s21, 81920
  buffer_store_dwordx4 v[244:247], v4, s[88:91], s21 offen sc1
  buffer_store_dwordx4 v[244:247], v4, s[88:91], s21 offen offset:1024 sc1
  buffer_store_dwordx2 v[244:245], v21, s[88:91], s21 offen offset:2048 sc1
  s_add_u32 s21, s21, 81920
  buffer_store_dwordx4 v[244:247], v4, s[88:91], s21 offen sc1
  buffer_store_dwordx4 v[244:247], v4, s[88:91], s21 offen offset:1024 sc1
  buffer_store_dwordx2 v[244:245], v21, s[88:91], s21 offen offset:2048 sc1
  s_add_u32 s21, s21, 81920
arm_180:
  s_cmp_ge_u32 s45, 64
  s_cbranch_scc1 vwd_175
  s_cmp_lg_u32 s23, 0
  s_cbranch_scc1 vwl_174
  s_branch vws_178
vws_176:
  v_cmp_gt_u32 vcc, 8, v9
  s_nop 0
  s_or_b32 s21, vcc_lo, 0x40000
  s_ff1_i32_b32 s21, s21
  s_lshl_b32 s22, s21, 1
  s_lshl_b32 s21, s21, 2
  s_sub_i32 s21, s21, 8
  s_max_i32 s47, s21, s22
  s_cmp_gt_u32 s47, s45
  s_cselect_b32 s21, s45, 0
  s_cmp_ge_u32 s21, 3
  s_cbranch_scc1 va_182
  s_nop 4
  v_cvt_pk_bf16_f32 v44, v104, v105
  v_cvt_pk_bf16_f32 v45, v106, v107
  v_cvt_pk_bf16_f32 v46, v108, v109
  v_cvt_pk_bf16_f32 v47, v110, v111
  s_add_u32 s69, s68, 4096
  buffer_store_dwordx4 v[44:47], v4, s[24:27], s69 offen offset:1024 sc1
  v_cvt_pk_bf16_f32 v48, v112, v113
  v_cvt_pk_bf16_f32 v49, v114, v115
  v_cvt_pk_bf16_f32 v50, v116, v117
  v_cvt_pk_bf16_f32 v51, v118, v119
  buffer_store_dwordx4 v[48:51], v4, s[24:27], s69 offen offset:2048 sc1
  v_cvt_pk_bf16_f32 v52, v120, v121
  v_cvt_pk_bf16_f32 v53, v122, v123
  v_cvt_pk_bf16_f32 v54, v124, v125
  v_cvt_pk_bf16_f32 v55, v126, v127
  buffer_store_dwordx4 v[52:55], v4, s[24:27], s69 offen offset:3072 sc1
  v_cvt_pk_bf16_f32 v56, v128, v129
  v_cvt_pk_bf16_f32 v57, v130, v131
  v_cvt_pk_bf16_f32 v58, v132, v133
  v_cvt_pk_bf16_f32 v59, v134, v135
  s_add_u32 s69, s68, 8192
  buffer_store_dwordx4 v[56:59], v4, s[24:27], s69 offen offset:0 sc1
  v_cvt_pk_bf16_f32 v60, v136, v137
  v_cvt_pk_bf16_f32 v61, v138, v139
  v_cvt_pk_bf16_f32 v62, v140, v141
  v_cvt_pk_bf16_f32 v63, v142, v143
  buffer_store_dwordx4 v[60:63], v4, s[24:27], s69 offen offset:1024 sc1
  s_mov_b32 s68, 0x80000000
  s_waitcnt vmcnt(0)
  s_mov_b64 exec, 1
  v_mov_b32 v20, s45
  buffer_store_dword v20, v10, s[72:75], s44 offen sc1
  s_mov_b64 exec, -1
  s_mov_b32 s70, s45
  s_mov_b32 s101, 0
  s_branch va_185
va_183:
  s_sleep 8
va_185:
  buffer_load_dword v9, v5, s[72:75], s43 offen sc1
  s_add_u32 s101, s101, 1
  s_cmp_gt_u32 s101, 131072
  s_cbranch_scc1 main_end
  s_waitcnt vmcnt(0)
  v_cmp_gt_u32 vcc, 8, v9
  s_nop 0
  s_or_b32 s21, vcc_lo, 0x40000
  s_ff1_i32_b32 s21, s21
  s_lshl_b32 s22, s21, 1
  s_lshl_b32 s21, s21, 2
  s_sub_i32 s21, s21, 8
  s_max_i32 s47, s21, s22
  s_cmp_gt_u32 s47, s45
  s_cbranch_scc0 va_183
va_182:
  s_add_u32 s22, s45, 6
  s_min_u32 s22, s22, s47
va_184:
  s_cmp_ge_u32 s46, s22
  s_cbranch_scc1 va_186
  s_mov_b32 m0, s64
  s_mov_b32 s66, s41
  buffer_load_dwordx4 v4, s[16:19], s66 offen offset:0 sc1 lds
  buffer_load_dwordx4 v4, s[16:19], s66 offen offset:1024 sc1 lds
  buffer_load_dwordx4 v4, s[16:19], s66 offen offset:2048 sc1 lds
  s_add_u32 s46, s46, 1
  s_add_u32 s41, s41, 393216
  s_add_u32 s64, s64, 12288
  s_cmp_lt_u32 s64, s67
  s_cselect_b32 s64, s64, s71
  s_branch va_184
va_186:
  s_mov_b32 s48, s46
  s_mov_b32 s49, s46
  s_mov_b32 s50, s46
  s_waitcnt vmcnt(0)
  s_barrier
  ds_read_b128 v[192:195], v8 offset:0
  ds_read_b128 v[196:199], v8 offset:1024
  ds_read_b128 v[200:203], v8 offset:2048
  ds_read_b128 v[204:207], v8 offset:3072
  ds_read_b128 v[208:211], v8 offset:4096
  ds_read_b128 v[212:215], v8 offset:5120
  ds_read_b128 v[216:219], v8 offset:6144
  ds_read_b128 v[220:223], v8 offset:7168
  ds_read_b128 v[224:227], v8 offset:8192
  ds_read_b128 v[228:231], v8 offset:9216
  ds_read_b128 v[232:235], v8 offset:10240
  ds_read_b128 v[236:239], v8 offset:11264
  s_add_u32 s21, s45, 1
  s_min_u32 s21, s21, 63
  s_cmp_lt_u32 s21, s50
  s_cselect_b32 s21, 1, 0
  v_mov_b32 v21, s21
  ds_write_b32 v6, v21 offset:16
  s_branch vwb_177
vws_178:
  v_cmp_gt_u32 vcc, 8, v9
  s_nop 0
  s_or_b32 s21, vcc_lo, 0x40000
  s_ff1_i32_b32 s21, s21
  s_lshl_b32 s22, s21, 1
  s_lshl_b32 s21, s21, 2
  s_sub_i32 s21, s21, 8
  s_max_i32 s47, s21, s22
  s_cmp_gt_u32 s47, s45
  s_cselect_b32 s21, s45, 0
  s_cmp_ge_u32 s21, 3
  s_cbranch_scc1 va_187
  s_nop 4
  v_cvt_pk_bf16_f32 v44, v104, v105
  v_cvt_pk_bf16_f32 v45, v106, v107
  v_cvt_pk_bf16_f32 v46, v108, v109
  v_cvt_pk_bf16_f32 v47, v110, v111
  s_add_u32 s69, s68, 4096
  buffer_store_dwordx4 v[44:47], v4, s[24:27], s69 offen offset:1024 sc1
  v_cvt_pk_bf16_f32 v48, v112, v113
  v_cvt_pk_bf16_f32 v49, v114, v115
  v_cvt_pk_bf16_f32 v50, v116, v117
  v_cvt_pk_bf16_f32 v51, v118, v119
  buffer_store_dwordx4 v[48:51], v4, s[24:27], s69 offen offset:2048 sc1
  v_cvt_pk_bf16_f32 v52, v120, v121
  v_cvt_pk_bf16_f32 v53, v122, v123
  v_cvt_pk_bf16_f32 v54, v124, v125
  v_cvt_pk_bf16_f32 v55, v126, v127
  buffer_store_dwordx4 v[52:55], v4, s[24:27], s69 offen offset:3072 sc1
  v_cvt_pk_bf16_f32 v56, v128, v129
  v_cvt_pk_bf16_f32 v57, v130, v131
  v_cvt_pk_bf16_f32 v58, v132, v133
  v_cvt_pk_bf16_f32 v59, v134, v135
  s_add_u32 s69, s68, 8192
  buffer_store_dwordx4 v[56:59], v4, s[24:27], s69 offen offset:0 sc1
  v_cvt_pk_bf16_f32 v60, v136, v137
  v_cvt_pk_bf16_f32 v61, v138, v139
  v_cvt_pk_bf16_f32 v62, v140, v141
  v_cvt_pk_bf16_f32 v63, v142, v143
  buffer_store_dwordx4 v[60:63], v4, s[24:27], s69 offen offset:1024 sc1
  s_mov_b32 s68, 0x80000000
  s_waitcnt vmcnt(0)
  s_mov_b64 exec, 1
  v_mov_b32 v20, s45
  buffer_store_dword v20, v10, s[72:75], s44 offen sc1
  s_mov_b64 exec, -1
  s_mov_b32 s70, s45
  s_mov_b32 s101, 0
  s_branch va_190
va_188:
  s_sleep 8
va_190:
  buffer_load_dword v9, v5, s[72:75], s43 offen sc1
  s_add_u32 s101, s101, 1
  s_cmp_gt_u32 s101, 131072
  s_cbranch_scc1 main_end
  s_waitcnt vmcnt(0)
  v_cmp_gt_u32 vcc, 8, v9
  s_nop 0
  s_or_b32 s21, vcc_lo, 0x40000
  s_ff1_i32_b32 s21, s21
  s_lshl_b32 s22, s21, 1
  s_lshl_b32 s21, s21, 2
  s_sub_i32 s21, s21, 8
  s_max_i32 s47, s21, s22
  s_cmp_gt_u32 s47, s45
  s_cbranch_scc0 va_188
va_187:
  s_add_u32 s22, s45, 6
  s_min_u32 s22, s22, s47
va_189:
  s_cmp_ge_u32 s46, s22
  s_cbranch_scc1 va_191
  s_mov_b32 m0, s64
  s_mov_b32 s66, s41
  buffer_load_dwordx4 v4, s[16:19], s66 offen offset:0 sc1 lds
  buffer_load_dwordx4 v4, s[16:19], s66 offen offset:1024 sc1 lds
  buffer_load_dwordx4 v4, s[16:19], s66 offen offset:2048 sc1 lds
  s_add_u32 s46, s46, 1
  s_add_u32 s41, s41, 393216
  s_add_u32 s64, s64, 12288
  s_cmp_lt_u32 s64, s67
  s_cselect_b32 s64, s64, s71
  s_branch va_189
va_191:
  s_mov_b32 s48, s46
  s_mov_b32 s49, s46
  s_mov_b32 s50, s46
  s_waitcnt vmcnt(0)
  s_barrier
  ds_read_b128 v[144:147], v8 offset:0
  ds_read_b128 v[148:151], v8 offset:1024
  ds_read_b128 v[152:155], v8 offset:2048
  ds_read_b128 v[156:159], v8 offset:3072
  ds_read_b128 v[160:163], v8 offset:4096
  ds_read_b128 v[164:167], v8 offset:5120
  ds_read_b128 v[168:171], v8 offset:6144
  ds_read_b128 v[172:175], v8 offset:7168
  ds_read_b128 v[176:179], v8 offset:8192
  ds_read_b128 v[180:183], v8 offset:9216
  ds_read_b128 v[184:187], v8 offset:10240
  ds_read_b128 v[188:191], v8 offset:11264
  s_add_u32 s21, s45, 1
  s_min_u32 s21, s21, 63
  s_cmp_lt_u32 s21, s50
  s_cselect_b32 s21, 1, 0
  v_mov_b32 v21, s21
  ds_write_b32 v6, v21 offset:0
  s_branch vwl_174
vwd_175:
  s_nop 4
  v_cvt_pk_bf16_f32 v44, v104, v105
  v_cvt_pk_bf16_f32 v45, v106, v107
  v_cvt_pk_bf16_f32 v46, v108, v109
  v_cvt_pk_bf16_f32 v47, v110, v111
  s_add_u32 s69, s68, 4096
  buffer_store_dwordx4 v[44:47], v4, s[24:27], s69 offen offset:1024 sc1
  v_cvt_pk_bf16_f32 v48, v112, v113
  v_cvt_pk_bf16_f32 v49, v114, v115
  v_cvt_pk_bf16_f32 v50, v116, v117
  v_cvt_pk_bf16_f32 v51, v118, v119
  buffer_store_dwordx4 v[48:51], v4, s[24:27], s69 offen offset:2048 sc1
  v_cvt_pk_bf16_f32 v52, v120, v121
  v_cvt_pk_bf16_f32 v53, v122, v123
  v_cvt_pk_bf16_f32 v54, v124, v125
  v_cvt_pk_bf16_f32 v55, v126, v127
  buffer_store_dwordx4 v[52:55], v4, s[24:27], s69 offen offset:3072 sc1
  v_cvt_pk_bf16_f32 v56, v128, v129
  v_cvt_pk_bf16_f32 v57, v130, v131
  v_cvt_pk_bf16_f32 v58, v132, v133
  v_cvt_pk_bf16_f32 v59, v134, v135
  s_add_u32 s69, s68, 8192
  buffer_store_dwordx4 v[56:59], v4, s[24:27], s69 offen offset:0 sc1
  v_cvt_pk_bf16_f32 v60, v136, v137
  v_cvt_pk_bf16_f32 v61, v138, v139
  v_cvt_pk_bf16_f32 v62, v140, v141
  v_cvt_pk_bf16_f32 v63, v142, v143
  buffer_store_dwordx4 v[60:63], v4, s[24:27], s69 offen offset:1024 sc1
  s_waitcnt vmcnt(0)
  s_mov_b64 exec, 1
  v_mov_b32 v20, s45
  buffer_store_dword v20, v10, s[72:75], s44 offen sc1
  s_mov_b64 exec, -1
ul_192:
  s_cmp_lt_u32 s55, s56
  s_cbranch_scc1 uh_193
  s_sub_u32 s21, s55, 60
  s_cmp_lt_u32 s21, 4
  s_cbranch_scc1 ut_195
  s_waitcnt vmcnt(0)
  s_cmp_eq_u32 s58, 0
  s_cbranch_scc1 uf_196
  s_mov_b64 exec, s[58:59]
  buffer_atomic_add v11, v17, s[72:75], s57 offen sc1
  s_mov_b64 exec, -1
  s_mov_b32 s58, 0
uf_196:
  s_cmp_ge_u32 s55, 64
  s_cbranch_scc1 ud_194
  s_cmp_ge_u32 s55, 60
  s_cbranch_scc1 ut_195
  s_add_u32 s23, s55, 1
  s_mov_b32 s101, 0
wm_197:
  buffer_load_dword v8, v12, s[72:75], s53 offen sc1
  s_add_u32 s101, s101, 1
  s_cmp_gt_u32 s101, 131072
  s_cbranch_scc1 main_end
  s_waitcnt vmcnt(0)
  v_cmp_gt_u32 vcc, s23, v8
  v_readfirstlane_b32 s100, v8
  s_nop 0
  s_cbranch_vccz wm_198
  s_sleep 4
  s_add_u32 s100, s100, 1
  s_cmp_ge_u32 s100, s23
  s_cbranch_scc1 wm_197
  s_sleep 90
  s_branch wm_197
wm_198:
  v_readlane_b32 s56, v8, 0
  v_readlane_b32 s21, v8, 1
  v_readlane_b32 s22, v8, 2
  v_readlane_b32 s23, v8, 3
  s_min_u32 s56, s56, s21
  s_min_u32 s22, s22, s23
  s_min_u32 s56, s56, s22
  s_min_u32 s56, s56, 64
uh_193:
  s_sub_u32 s21, s56, s55
  s_cmp_lt_u32 s21, 4
  s_cbranch_scc1 uo_199
  s_sub_u32 s21, s56, s55
  s_cmp_ge_u32 s21, 2
  s_cselect_b64 vcc, -1, 0
  s_cselect_b32 s54, 2, 1
  v_cndmask_b32 v18, v13, v14, vcc
  s_lshl_b32 s21, s55, 5
  s_add_u32 s21, s21, s2
  s_mul_i32 s62, s21, 3072
  s_mul_i32 s63, s21, 10240
  s_mul_i32 s22, s20, 2560
  s_add_u32 s63, s63, s22
  buffer_load_dwordx4 a[240:243], v18, s[76:79], s62 offen offset:0 sc1
  buffer_load_dwordx4 a[244:247], v18, s[76:79], s62 offen offset:512 sc1
  buffer_load_dwordx4 a[248:251], v18, s[76:79], s62 offen offset:1024 sc1
  buffer_load_dwordx4 a[252:255], v18, s[76:79], s62 offen offset:1536 sc1
  buffer_load_dwordx4 v[248:251], v18, s[76:79], s62 offen offset:2048 sc1
  buffer_load_dwordx4 v[252:255], v18, s[76:79], s62 offen offset:2560 sc1
  s_mov_b32 s66, 0
  s_mov_b32 s67, 0
  s_add_u32 s62, s62, 196608
  buffer_load_dwordx4 v[24:27], v18, s[76:79], s62 offen offset:0 sc1
  buffer_load_dwordx4 v[28:31], v18, s[76:79], s62 offen offset:512 sc1
  buffer_load_dwordx4 v[32:35], v18, s[76:79], s62 offen offset:1024 sc1
  buffer_load_dwordx4 v[36:39], v18, s[76:79], s62 offen offset:1536 sc1
  buffer_load_dwordx4 v[40:43], v18, s[76:79], s62 offen offset:2048 sc1
  buffer_load_dwordx4 v[44:47], v18, s[76:79], s62 offen offset:2560 sc1
  s_waitcnt vmcnt(6)
  s_cmp_eq_u32 s58, 0
  s_cbranch_scc1 uf_203
  s_mov_b64 exec, s[58:59]
  buffer_atomic_add v11, v17, s[72:75], s57 offen sc1
  s_mov_b64 exec, -1
  s_mov_b32 s58, 0
uf_203:
  v_mfma_f32_16x16x32_bf16 v[64:67], a[240:243], a[0:3], 0
  v_mfma_f32_16x16x32_bf16 v[68:71], a[240:243], a[24:27], 0
  v_mfma_f32_16x16x32_bf16 v[72:75], a[240:243], a[48:51], 0
  v_mfma_f32_16x16x32_bf16 v[76:79], a[240:243], a[72:75], 0
  v_mfma_f32_16x16x32_bf16 v[80:83], a[240:243], a[96:99], 0
  v_mfma_f32_16x16x32_bf16 v[84:87], a[240:243], a[120:123], 0
  v_mfma_f32_16x16x32_bf16 v[88:91], a[240:243], a[144:147], 0
  v_mfma_f32_16x16x32_bf16 v[92:95], a[240:243], a[168:171], 0
  v_mfma_f32_16x16x32_bf16 v[96:99], a[240:243], a[192:195], 0
  v_mfma_f32_16x16x32_bf16 v[100:103], a[240:243], a[216:219], 0
  v_mfma_f32_16x16x32_bf16 v[64:67], a[244:247], a[4:7], v[64:67]
  v_mfma_f32_16x16x32_bf16 v[68:71], a[244:247], a[28:31], v[68:71]
  v_mfma_f32_16x16x32_bf16 v[72:75], a[244:247], a[52:55], v[72:75]
  v_mfma_f32_16x16x32_bf16 v[76:79], a[244:247], a[76:79], v[76:79]
  v_mfma_f32_16x16x32_bf16 v[80:83], a[244:247], a[100:103], v[80:83]
  v_mfma_f32_16x16x32_bf16 v[84:87], a[244:247], a[124:127], v[84:87]
  v_mfma_f32_16x16x32_bf16 v[88:91], a[244:247], a[148:151], v[88:91]
  v_mfma_f32_16x16x32_bf16 v[92:95], a[244:247], a[172:175], v[92:95]
  v_mfma_f32_16x16x32_bf16 v[96:99], a[244:247], a[196:199], v[96:99]
  v_mfma_f32_16x16x32_bf16 v[100:103], a[244:247], a[220:223], v[100:103]
  v_mfma_f32_16x16x32_bf16 v[64:67], a[248:251], a[8:11], v[64:67]
  v_mfma_f32_16x16x32_bf16 v[68:71], a[248:251], a[32:35], v[68:71]
  v_mfma_f32_16x16x32_bf16 v[72:75], a[248:251], a[56:59], v[72:75]
  v_mfma_f32_16x16x32_bf16 v[76:79], a[248:251], a[80:83], v[76:79]
  v_mfma_f32_16x16x32_bf16 v[80:83], a[248:251], a[104:107], v[80:83]
  v_mfma_f32_16x16x32_bf16 v[84:87], a[248:251], a[128:131], v[84:87]
  v_mfma_f32_16x16x32_bf16 v[88:91], a[248:251], a[152:155], v[88:91]
  v_mfma_f32_16x16x32_bf16 v[92:95], a[248:251], a[176:179], v[92:95]
  v_mfma_f32_16x16x32_bf16 v[96:99], a[248:251], a[200:203], v[96:99]
  v_mfma_f32_16x16x32_bf16 v[100:103], a[248:251], a[224:227], v[100:103]
  v_mfma_f32_16x16x32_bf16 v[64:67], a[252:255], a[12:15], v[64:67]
  v_mfma_f32_16x16x32_bf16 v[68:71], a[252:255], a[36:39], v[68:71]
  v_mfma_f32_16x16x32_bf16 v[72:75], a[252:255], a[60:63], v[72:75]
  v_mfma_f32_16x16x32_bf16 v[76:79], a[252:255], a[84:87], v[76:79]
  v_mfma_f32_16x16x32_bf16 v[80:83], a[252:255], a[108:111], v[80:83]
  v_mfma_f32_16x16x32_bf16 v[84:87], a[252:255], a[132:135], v[84:87]
  v_mfma_f32_16x16x32_bf16 v[88:91], a[252:255], a[156:159], v[88:91]
  v_mfma_f32_16x16x32_bf16 v[92:95], a[252:255], a[180:183], v[92:95]
  v_mfma_f32_16x16x32_bf16 v[96:99], a[252:255], a[204:207], v[96:99]
  v_mfma_f32_16x16x32_bf16 v[100:103], a[252:255], a[228:231], v[100:103]
  v_mfma_f32_16x16x32_bf16 v[64:67], v[248:251], a[16:19], v[64:67]
  v_mfma_f32_16x16x32_bf16 v[68:71], v[248:251], a[40:43], v[68:71]
  v_mfma_f32_16x16x32_bf16 v[72:75], v[248:251], a[64:67], v[72:75]
  v_mfma_f32_16x16x32_bf16 v[76:79], v[248:251], a[88:91], v[76:79]
  v_mfma_f32_16x16x32_bf16 v[80:83], v[248:251], a[112:115], v[80:83]
  v_mfma_f32_16x16x32_bf16 v[84:87], v[248:251], a[136:139], v[84:87]
  v_mfma_f32_16x16x32_bf16 v[88:91], v[248:251], a[160:163], v[88:91]
  v_mfma_f32_16x16x32_bf16 v[92:95], v[248:251], a[184:187], v[92:95]
  v_mfma_f32_16x16x32_bf16 v[96:99], v[248:251], a[208:211], v[96:99]
  v_mfma_f32_16x16x32_bf16 v[100:103], v[248:251], a[232:235], v[100:103]
  v_mfma_f32_16x16x32_bf16 v[64:67], v[252:255], a[20:23], v[64:67]
  v_mfma_f32_16x16x32_bf16 v[68:71], v[252:255], a[44:47], v[68:71]
  v_mfma_f32_16x16x32_bf16 v[72:75], v[252:255], a[68:71], v[72:75]
  v_mfma_f32_16x16x32_bf16 v[76:79], v[252:255], a[92:95], v[76:79]
  v_mfma_f32_16x16x32_bf16 v[80:83], v[252:255], a[116:119], v[80:83]
  v_mfma_f32_16x16x32_bf16 v[84:87], v[252:255], a[140:143], v[84:87]
  v_mfma_f32_16x16x32_bf16 v[88:91], v[252:255], a[164:167], v[88:91]
  v_mfma_f32_16x16x32_bf16 v[92:95], v[252:255], a[188:191], v[92:95]
  v_mfma_f32_16x16x32_bf16 v[96:99], v[252:255], a[212:215], v[96:99]
  v_mfma_f32_16x16x32_bf16 v[100:103], v[252:255], a[236:239], v[100:103]
  s_cmp_eq_u32 s54, 2
  s_cselect_b32 s61, -1, 0
  s_mov_b32 s60, -1
  s_cselect_b32 s58, 3, 1
  s_lshl_b32 s57, s55, 3
  s_and_b32 s21, s2, 7
  s_add_u32 s57, s57, s21
  s_lshl_b32 s57, s57, 7
  s_add_u32 s57, s57, 22528
  s_add_u32 s55, s55, s54
  v_cvt_pk_bf16_f32 v48, v64, v65
  v_cvt_pk_bf16_f32 v49, v66, v67
  v_cvt_pk_bf16_f32 v50, v68, v69
  v_cvt_pk_bf16_f32 v51, v70, v71
  v_cvt_pk_bf16_f32 v52, v72, v73
  v_cvt_pk_bf16_f32 v53, v74, v75
  v_cvt_pk_bf16_f32 v54, v76, v77
  v_cvt_pk_bf16_f32 v55, v78, v79
  v_cvt_pk_bf16_f32 v56, v80, v81
  v_cvt_pk_bf16_f32 v57, v82, v83
  v_cvt_pk_bf16_f32 v58, v84, v85
  v_cvt_pk_bf16_f32 v59, v86, v87
  v_cvt_pk_bf16_f32 v60, v88, v89
  v_cvt_pk_bf16_f32 v61, v90, v91
  v_cvt_pk_bf16_f32 v62, v92, v93
  v_cvt_pk_bf16_f32 v63, v94, v95
  v_cvt_pk_bf16_f32 v240, v96, v97
  v_cvt_pk_bf16_f32 v241, v98, v99
  v_cvt_pk_bf16_f32 v242, v100, v101
  v_cvt_pk_bf16_f32 v243, v102, v103
  v_min_u32 v48, -2, v48
  v_min_u32 v52, -2, v52
  v_min_u32 v56, -2, v56
  v_min_u32 v60, -2, v60
  v_min_u32 v240, -2, v240
  s_mov_b64 exec, s[60:61]
  buffer_store_dwordx4 v[48:51], v15, s[80:83], s63 offen offset:0 sc1
  buffer_store_dwordx4 v[52:55], v15, s[80:83], s63 offen offset:512 sc1
  buffer_store_dwordx4 v[56:59], v15, s[80:83], s63 offen offset:1024 sc1
  buffer_store_dwordx4 v[60:63], v15, s[80:83], s63 offen offset:1536 sc1
  buffer_store_dwordx4 v[240:243], v15, s[80:83], s63 offen offset:2048 sc1
  s_mov_b64 exec, -1
  s_add_u32 s63, s63, 655360
uf_200:
  s_add_u32 s21, s55, 4
  s_cmp_gt_u32 s21, s56
  s_cbranch_scc1 ux_202
  s_add_u32 s62, s62, 196608
  buffer_load_dwordx4 a[240:243], v18, s[76:79], s62 offen offset:0 sc1
  buffer_load_dwordx4 a[244:247], v18, s[76:79], s62 offen offset:512 sc1
  buffer_load_dwordx4 a[248:251], v18, s[76:79], s62 offen offset:1024 sc1
  buffer_load_dwordx4 a[252:255], v18, s[76:79], s62 offen offset:1536 sc1
  buffer_load_dwordx4 v[248:251], v18, s[76:79], s62 offen offset:2048 sc1
  buffer_load_dwordx4 v[252:255], v18, s[76:79], s62 offen offset:2560 sc1
  s_waitcnt vmcnt(11)
  s_cmp_eq_u32 s66, 0
  s_cbranch_scc1 uf_204
  s_mov_b64 exec, s[66:67]
  buffer_atomic_add v11, v17, s[72:75], s65 offen sc1
  s_mov_b64 exec, -1
  s_mov_b32 s66, 0
uf_204:
  s_mov_b32 s65, s57
  s_mov_b32 s66, s58
  s_mov_b32 s58, 0
  v_mfma_f32_16x16x32_bf16 v[64:67], v[24:27], a[0:3], 0
  v_mfma_f32_16x16x32_bf16 v[68:71], v[24:27], a[24:27], 0
  v_mfma_f32_16x16x32_bf16 v[72:75], v[24:27], a[48:51], 0
  v_mfma_f32_16x16x32_bf16 v[76:79], v[24:27], a[72:75], 0
  v_mfma_f32_16x16x32_bf16 v[80:83], v[24:27], a[96:99], 0
  v_mfma_f32_16x16x32_bf16 v[84:87], v[24:27], a[120:123], 0
  v_mfma_f32_16x16x32_bf16 v[88:91], v[24:27], a[144:147], 0
  v_mfma_f32_16x16x32_bf16 v[92:95], v[24:27], a[168:171], 0
  v_mfma_f32_16x16x32_bf16 v[96:99], v[24:27], a[192:195], 0
  v_mfma_f32_16x16x32_bf16 v[100:103], v[24:27], a[216:219], 0
  v_mfma_f32_16x16x32_bf16 v[64:67], v[28:31], a[4:7], v[64:67]
  v_mfma_f32_16x16x32_bf16 v[68:71], v[28:31], a[28:31], v[68:71]
  v_mfma_f32_16x16x32_bf16 v[72:75], v[28:31], a[52:55], v[72:75]
  v_mfma_f32_16x16x32_bf16 v[76:79], v[28:31], a[76:79], v[76:79]
  v_mfma_f32_16x16x32_bf16 v[80:83], v[28:31], a[100:103], v[80:83]
  v_mfma_f32_16x16x32_bf16 v[84:87], v[28:31], a[124:127], v[84:87]
  v_mfma_f32_16x16x32_bf16 v[88:91], v[28:31], a[148:151], v[88:91]
  v_mfma_f32_16x16x32_bf16 v[92:95], v[28:31], a[172:175], v[92:95]
  v_mfma_f32_16x16x32_bf16 v[96:99], v[28:31], a[196:199], v[96:99]
  v_mfma_f32_16x16x32_bf16 v[100:103], v[28:31], a[220:223], v[100:103]
  v_mfma_f32_16x16x32_bf16 v[64:67], v[32:35], a[8:11], v[64:67]
  v_mfma_f32_16x16x32_bf16 v[68:71], v[32:35], a[32:35], v[68:71]
  v_mfma_f32_16x16x32_bf16 v[72:75], v[32:35], a[56:59], v[72:75]
  v_mfma_f32_16x16x32_bf16 v[76:79], v[32:35], a[80:83], v[76:79]
  v_mfma_f32_16x16x32_bf16 v[80:83], v[32:35], a[104:107], v[80:83]
  v_mfma_f32_16x16x32_bf16 v[84:87], v[32:35], a[128:131], v[84:87]
  v_mfma_f32_16x16x32_bf16 v[88:91], v[32:35], a[152:155], v[88:91]
  v_mfma_f32_16x16x32_bf16 v[92:95], v[32:35], a[176:179], v[92:95]
  v_mfma_f32_16x16x32_bf16 v[96:99], v[32:35], a[200:203], v[96:99]
  v_mfma_f32_16x16x32_bf16 v[100:103], v[32:35], a[224:227], v[100:103]
  v_mfma_f32_16x16x32_bf16 v[64:67], v[36:39], a[12:15], v[64:67]
  v_mfma_f32_16x16x32_bf16 v[68:71], v[36:39], a[36:39], v[68:71]
  v_mfma_f32_16x16x32_bf16 v[72:75], v[36:39], a[60:63], v[72:75]
  v_mfma_f32_16x16x32_bf16 v[76:79], v[36:39], a[84:87], v[76:79]
  v_mfma_f32_16x16x32_bf16 v[80:83], v[36:39], a[108:111], v[80:83]
  v_mfma_f32_16x16x32_bf16 v[84:87], v[36:39], a[132:135], v[84:87]
  v_mfma_f32_16x16x32_bf16 v[88:91], v[36:39], a[156:159], v[88:91]
  v_mfma_f32_16x16x32_bf16 v[92:95], v[36:39], a[180:183], v[92:95]
  v_mfma_f32_16x16x32_bf16 v[96:99], v[36:39], a[204:207], v[96:99]
  v_mfma_f32_16x16x32_bf16 v[100:103], v[36:39], a[228:231], v[100:103]
  v_mfma_f32_16x16x32_bf16 v[64:67], v[40:43], a[16:19], v[64:67]
  v_mfma_f32_16x16x32_bf16 v[68:71], v[40:43], a[40:43], v[68:71]
  v_mfma_f32_16x16x32_bf16 v[72:75], v[40:43], a[64:67], v[72:75]
  v_mfma_f32_16x16x32_bf16 v[76:79], v[40:43], a[88:91], v[76:79]
  v_mfma_f32_16x16x32_bf16 v[80:83], v[40:43], a[112:115], v[80:83]
  v_mfma_f32_16x16x32_bf16 v[84:87], v[40:43], a[136:139], v[84:87]
  v_mfma_f32_16x16x32_bf16 v[88:91], v[40:43], a[160:163], v[88:91]
  v_mfma_f32_16x16x32_bf16 v[92:95], v[40:43], a[184:187], v[92:95]
  v_mfma_f32_16x16x32_bf16 v[96:99], v[40:43], a[208:211], v[96:99]
  v_mfma_f32_16x16x32_bf16 v[100:103], v[40:43], a[232:235], v[100:103]
  v_mfma_f32_16x16x32_bf16 v[64:67], v[44:47], a[20:23], v[64:67]
  v_mfma_f32_16x16x32_bf16 v[68:71], v[44:47], a[44:47], v[68:71]
  v_mfma_f32_16x16x32_bf16 v[72:75], v[44:47], a[68:71], v[72:75]
  v_mfma_f32_16x16x32_bf16 v[76:79], v[44:47], a[92:95], v[76:79]
  v_mfma_f32_16x16x32_bf16 v[80:83], v[44:47], a[116:119], v[80:83]
  v_mfma_f32_16x16x32_bf16 v[84:87], v[44:47], a[140:143], v[84:87]
  v_mfma_f32_16x16x32_bf16 v[88:91], v[44:47], a[164:167], v[88:91]
  v_mfma_f32_16x16x32_bf16 v[92:95], v[44:47], a[188:191], v[92:95]
  v_mfma_f32_16x16x32_bf16 v[96:99], v[44:47], a[212:215], v[96:99]
  v_mfma_f32_16x16x32_bf16 v[100:103], v[44:47], a[236:239], v[100:103]
  s_cmp_eq_u32 s54, 2
  s_cselect_b32 s61, -1, 0
  s_mov_b32 s60, -1
  s_cselect_b32 s58, 3, 1
  s_lshl_b32 s57, s55, 3
  s_and_b32 s21, s2, 7
  s_add_u32 s57, s57, s21
  s_lshl_b32 s57, s57, 7
  s_add_u32 s57, s57, 22528
  s_add_u32 s55, s55, s54
  v_cvt_pk_bf16_f32 v48, v64, v65
  v_cvt_pk_bf16_f32 v49, v66, v67
  v_cvt_pk_bf16_f32 v50, v68, v69
  v_cvt_pk_bf16_f32 v51, v70, v71
  v_cvt_pk_bf16_f32 v52, v72, v73
  v_cvt_pk_bf16_f32 v53, v74, v75
  v_cvt_pk_bf16_f32 v54, v76, v77
  v_cvt_pk_bf16_f32 v55, v78, v79
  v_cvt_pk_bf16_f32 v56, v80, v81
  v_cvt_pk_bf16_f32 v57, v82, v83
  v_cvt_pk_bf16_f32 v58, v84, v85
  v_cvt_pk_bf16_f32 v59, v86, v87
  v_cvt_pk_bf16_f32 v60, v88, v89
  v_cvt_pk_bf16_f32 v61, v90, v91
  v_cvt_pk_bf16_f32 v62, v92, v93
  v_cvt_pk_bf16_f32 v63, v94, v95
  v_cvt_pk_bf16_f32 v240, v96, v97
  v_cvt_pk_bf16_f32 v241, v98, v99
  v_cvt_pk_bf16_f32 v242, v100, v101
  v_cvt_pk_bf16_f32 v243, v102, v103
  v_min_u32 v48, -2, v48
  v_min_u32 v52, -2, v52
  v_min_u32 v56, -2, v56
  v_min_u32 v60, -2, v60
  v_min_u32 v240, -2, v240
  s_mov_b64 exec, s[60:61]
  buffer_store_dwordx4 v[48:51], v15, s[80:83], s63 offen offset:0 sc1
  buffer_store_dwordx4 v[52:55], v15, s[80:83], s63 offen offset:512 sc1
  buffer_store_dwordx4 v[56:59], v15, s[80:83], s63 offen offset:1024 sc1
  buffer_store_dwordx4 v[60:63], v15, s[80:83], s63 offen offset:1536 sc1
  buffer_store_dwordx4 v[240:243], v15, s[80:83], s63 offen offset:2048 sc1
  s_mov_b64 exec, -1
  s_add_u32 s63, s63, 655360
  s_add_u32 s21, s55, 4
  s_cmp_gt_u32 s21, s56
  s_cbranch_scc1 ux_201
  s_add_u32 s62, s62, 196608
  buffer_load_dwordx4 v[24:27], v18, s[76:79], s62 offen offset:0 sc1
  buffer_load_dwordx4 v[28:31], v18, s[76:79], s62 offen offset:512 sc1
  buffer_load_dwordx4 v[32:35], v18, s[76:79], s62 offen offset:1024 sc1
  buffer_load_dwordx4 v[36:39], v18, s[76:79], s62 offen offset:1536 sc1
  buffer_load_dwordx4 v[40:43], v18, s[76:79], s62 offen offset:2048 sc1
  buffer_load_dwordx4 v[44:47], v18, s[76:79], s62 offen offset:2560 sc1
  s_waitcnt vmcnt(11)
  s_cmp_eq_u32 s66, 0
  s_cbranch_scc1 uf_205
  s_mov_b64 exec, s[66:67]
  buffer_atomic_add v11, v17, s[72:75], s65 offen sc1
  s_mov_b64 exec, -1
  s_mov_b32 s66, 0
uf_205:
  s_mov_b32 s65, s57
  s_mov_b32 s66, s58
  s_mov_b32 s58, 0
  v_mfma_f32_16x16x32_bf16 v[64:67], a[240:243], a[0:3], 0
  v_mfma_f32_16x16x32_bf16 v[68:71], a[240:243], a[24:27], 0
  v_mfma_f32_16x16x32_bf16 v[72:75], a[240:243], a[48:51], 0
  v_mfma_f32_16x16x32_bf16 v[76:79], a[240:243], a[72:75], 0
  v_mfma_f32_16x16x32_bf16 v[80:83], a[240:243], a[96:99], 0
  v_mfma_f32_16x16x32_bf16 v[84:87], a[240:243], a[120:123], 0
  v_mfma_f32_16x16x32_bf16 v[88:91], a[240:243], a[144:147], 0
  v_mfma_f32_16x16x32_bf16 v[92:95], a[240:243], a[168:171], 0
  v_mfma_f32_16x16x32_bf16 v[96:99], a[240:243], a[192:195], 0
  v_mfma_f32_16x16x32_bf16 v[100:103], a[240:243], a[216:219], 0
  v_mfma_f32_16x16x32_bf16 v[64:67], a[244:247], a[4:7], v[64:67]
  v_mfma_f32_16x16x32_bf16 v[68:71], a[244:247], a[28:31], v[68:71]
  v_mfma_f32_16x16x32_bf16 v[72:75], a[244:247], a[52:55], v[72:75]
  v_mfma_f32_16x16x32_bf16 v[76:79], a[244:247], a[76:79], v[76:79]
  v_mfma_f32_16x16x32_bf16 v[80:83], a[244:247], a[100:103], v[80:83]
  v_mfma_f32_16x16x32_bf16 v[84:87], a[244:247], a[124:127], v[84:87]
  v_mfma_f32_16x16x32_bf16 v[88:91], a[244:247], a[148:151], v[88:91]
  v_mfma_f32_16x16x32_bf16 v[92:95], a[244:247], a[172:175], v[92:95]
  v_mfma_f32_16x16x32_bf16 v[96:99], a[244:247], a[196:199], v[96:99]
  v_mfma_f32_16x16x32_bf16 v[100:103], a[244:247], a[220:223], v[100:103]
  v_mfma_f32_16x16x32_bf16 v[64:67], a[248:251], a[8:11], v[64:67]
  v_mfma_f32_16x16x32_bf16 v[68:71], a[248:251], a[32:35], v[68:71]
  v_mfma_f32_16x16x32_bf16 v[72:75], a[248:251], a[56:59], v[72:75]
  v_mfma_f32_16x16x32_bf16 v[76:79], a[248:251], a[80:83], v[76:79]
  v_mfma_f32_16x16x32_bf16 v[80:83], a[248:251], a[104:107], v[80:83]
  v_mfma_f32_16x16x32_bf16 v[84:87], a[248:251], a[128:131], v[84:87]
  v_mfma_f32_16x16x32_bf16 v[88:91], a[248:251], a[152:155], v[88:91]
  v_mfma_f32_16x16x32_bf16 v[92:95], a[248:251], a[176:179], v[92:95]
  v_mfma_f32_16x16x32_bf16 v[96:99], a[248:251], a[200:203], v[96:99]
  v_mfma_f32_16x16x32_bf16 v[100:103], a[248:251], a[224:227], v[100:103]
  v_mfma_f32_16x16x32_bf16 v[64:67], a[252:255], a[12:15], v[64:67]
  v_mfma_f32_16x16x32_bf16 v[68:71], a[252:255], a[36:39], v[68:71]
  v_mfma_f32_16x16x32_bf16 v[72:75], a[252:255], a[60:63], v[72:75]
  v_mfma_f32_16x16x32_bf16 v[76:79], a[252:255], a[84:87], v[76:79]
  v_mfma_f32_16x16x32_bf16 v[80:83], a[252:255], a[108:111], v[80:83]
  v_mfma_f32_16x16x32_bf16 v[84:87], a[252:255], a[132:135], v[84:87]
  v_mfma_f32_16x16x32_bf16 v[88:91], a[252:255], a[156:159], v[88:91]
  v_mfma_f32_16x16x32_bf16 v[92:95], a[252:255], a[180:183], v[92:95]
  v_mfma_f32_16x16x32_bf16 v[96:99], a[252:255], a[204:207], v[96:99]
  v_mfma_f32_16x16x32_bf16 v[100:103], a[252:255], a[228:231], v[100:103]
  v_mfma_f32_16x16x32_bf16 v[64:67], v[248:251], a[16:19], v[64:67]
  v_mfma_f32_16x16x32_bf16 v[68:71], v[248:251], a[40:43], v[68:71]
  v_mfma_f32_16x16x32_bf16 v[72:75], v[248:251], a[64:67], v[72:75]
  v_mfma_f32_16x16x32_bf16 v[76:79], v[248:251], a[88:91], v[76:79]
  v_mfma_f32_16x16x32_bf16 v[80:83], v[248:251], a[112:115], v[80:83]
  v_mfma_f32_16x16x32_bf16 v[84:87], v[248:251], a[136:139], v[84:87]
  v_mfma_f32_16x16x32_bf16 v[88:91], v[248:251], a[160:163], v[88:91]
  v_mfma_f32_16x16x32_bf16 v[92:95], v[248:251], a[184:187], v[92:95]
  v_mfma_f32_16x16x32_bf16 v[96:99], v[248:251], a[208:211], v[96:99]
  v_mfma_f32_16x16x32_bf16 v[100:103], v[248:251], a[232:235], v[100:103]
  v_mfma_f32_16x16x32_bf16 v[64:67], v[252:255], a[20:23], v[64:67]
  v_mfma_f32_16x16x32_bf16 v[68:71], v[252:255], a[44:47], v[68:71]
  v_mfma_f32_16x16x32_bf16 v[72:75], v[252:255], a[68:71], v[72:75]
  v_mfma_f32_16x16x32_bf16 v[76:79], v[252:255], a[92:95], v[76:79]
  v_mfma_f32_16x16x32_bf16 v[80:83], v[252:255], a[116:119], v[80:83]
  v_mfma_f32_16x16x32_bf16 v[84:87], v[252:255], a[140:143], v[84:87]
  v_mfma_f32_16x16x32_bf16 v[88:91], v[252:255], a[164:167], v[88:91]
  v_mfma_f32_16x16x32_bf16 v[92:95], v[252:255], a[188:191], v[92:95]
  v_mfma_f32_16x16x32_bf16 v[96:99], v[252:255], a[212:215], v[96:99]
  v_mfma_f32_16x16x32_bf16 v[100:103], v[252:255], a[236:239], v[100:103]
  s_cmp_eq_u32 s54, 2
  s_cselect_b32 s61, -1, 0
  s_mov_b32 s60, -1
  s_cselect_b32 s58, 3, 1
  s_lshl_b32 s57, s55, 3
  s_and_b32 s21, s2, 7
  s_add_u32 s57, s57, s21
  s_lshl_b32 s57, s57, 7
  s_add_u32 s57, s57, 22528
  s_add_u32 s55, s55, s54
  v_cvt_pk_bf16_f32 v48, v64, v65
  v_cvt_pk_bf16_f32 v49, v66, v67
  v_cvt_pk_bf16_f32 v50, v68, v69
  v_cvt_pk_bf16_f32 v51, v70, v71
  v_cvt_pk_bf16_f32 v52, v72, v73
  v_cvt_pk_bf16_f32 v53, v74, v75
  v_cvt_pk_bf16_f32 v54, v76, v77
  v_cvt_pk_bf16_f32 v55, v78, v79
  v_cvt_pk_bf16_f32 v56, v80, v81
  v_cvt_pk_bf16_f32 v57, v82, v83
  v_cvt_pk_bf16_f32 v58, v84, v85
  v_cvt_pk_bf16_f32 v59, v86, v87
  v_cvt_pk_bf16_f32 v60, v88, v89
  v_cvt_pk_bf16_f32 v61, v90, v91
  v_cvt_pk_bf16_f32 v62, v92, v93
  v_cvt_pk_bf16_f32 v63, v94, v95
  v_cvt_pk_bf16_f32 v240, v96, v97
  v_cvt_pk_bf16_f32 v241, v98, v99
  v_cvt_pk_bf16_f32 v242, v100, v101
  v_cvt_pk_bf16_f32 v243, v102, v103
  v_min_u32 v48, -2, v48
  v_min_u32 v52, -2, v52
  v_min_u32 v56, -2, v56
  v_min_u32 v60, -2, v60
  v_min_u32 v240, -2, v240
  s_mov_b64 exec, s[60:61]
  buffer_store_dwordx4 v[48:51], v15, s[80:83], s63 offen offset:0 sc1
  buffer_store_dwordx4 v[52:55], v15, s[80:83], s63 offen offset:512 sc1
  buffer_store_dwordx4 v[56:59], v15, s[80:83], s63 offen offset:1024 sc1
  buffer_store_dwordx4 v[60:63], v15, s[80:83], s63 offen offset:1536 sc1
  buffer_store_dwordx4 v[240:243], v15, s[80:83], s63 offen offset:2048 sc1
  s_mov_b64 exec, -1
  s_add_u32 s63, s63, 655360
  s_branch uf_200
ux_202:
  s_waitcnt vmcnt(0)
  s_cmp_eq_u32 s66, 0
  s_cbranch_scc1 uf_206
  s_mov_b64 exec, s[66:67]
  buffer_atomic_add v11, v17, s[72:75], s65 offen sc1
  s_mov_b64 exec, -1
  s_mov_b32 s66, 0
uf_206:
  s_cmp_eq_u32 s58, 0
  s_cbranch_scc1 uf_207
  s_mov_b64 exec, s[58:59]
  buffer_atomic_add v11, v17, s[72:75], s57 offen sc1
  s_mov_b64 exec, -1
  s_mov_b32 s58, 0
uf_207:
  v_mfma_f32_16x16x32_bf16 v[64:67], v[24:27], a[0:3], 0
  v_mfma_f32_16x16x32_bf16 v[68:71], v[24:27], a[24:27], 0
  v_mfma_f32_16x16x32_bf16 v[72:75], v[24:27], a[48:51], 0
  v_mfma_f32_16x16x32_bf16 v[76:79], v[24:27], a[72:75], 0
  v_mfma_f32_16x16x32_bf16 v[80:83], v[24:27], a[96:99], 0
  v_mfma_f32_16x16x32_bf16 v[84:87], v[24:27], a[120:123], 0
  v_mfma_f32_16x16x32_bf16 v[88:91], v[24:27], a[144:147], 0
  v_mfma_f32_16x16x32_bf16 v[92:95], v[24:27], a[168:171], 0
  v_mfma_f32_16x16x32_bf16 v[96:99], v[24:27], a[192:195], 0
  v_mfma_f32_16x16x32_bf16 v[100:103], v[24:27], a[216:219], 0
  v_mfma_f32_16x16x32_bf16 v[64:67], v[28:31], a[4:7], v[64:67]
  v_mfma_f32_16x16x32_bf16 v[68:71], v[28:31], a[28:31], v[68:71]
  v_mfma_f32_16x16x32_bf16 v[72:75], v[28:31], a[52:55], v[72:75]
  v_mfma_f32_16x16x32_bf16 v[76:79], v[28:31], a[76:79], v[76:79]
  v_mfma_f32_16x16x32_bf16 v[80:83], v[28:31], a[100:103], v[80:83]
  v_mfma_f32_16x16x32_bf16 v[84:87], v[28:31], a[124:127], v[84:87]
  v_mfma_f32_16x16x32_bf16 v[88:91], v[28:31], a[148:151], v[88:91]
  v_mfma_f32_16x16x32_bf16 v[92:95], v[28:31], a[172:175], v[92:95]
  v_mfma_f32_16x16x32_bf16 v[96:99], v[28:31], a[196:199], v[96:99]
  v_mfma_f32_16x16x32_bf16 v[100:103], v[28:31], a[220:223], v[100:103]
  v_mfma_f32_16x16x32_bf16 v[64:67], v[32:35], a[8:11], v[64:67]
  v_mfma_f32_16x16x32_bf16 v[68:71], v[32:35], a[32:35], v[68:71]
  v_mfma_f32_16x16x32_bf16 v[72:75], v[32:35], a[56:59], v[72:75]
  v_mfma_f32_16x16x32_bf16 v[76:79], v[32:35], a[80:83], v[76:79]
  v_mfma_f32_16x16x32_bf16 v[80:83], v[32:35], a[104:107], v[80:83]
  v_mfma_f32_16x16x32_bf16 v[84:87], v[32:35], a[128:131], v[84:87]
  v_mfma_f32_16x16x32_bf16 v[88:91], v[32:35], a[152:155], v[88:91]
  v_mfma_f32_16x16x32_bf16 v[92:95], v[32:35], a[176:179], v[92:95]
  v_mfma_f32_16x16x32_bf16 v[96:99], v[32:35], a[200:203], v[96:99]
  v_mfma_f32_16x16x32_bf16 v[100:103], v[32:35], a[224:227], v[100:103]
  v_mfma_f32_16x16x32_bf16 v[64:67], v[36:39], a[12:15], v[64:67]
  v_mfma_f32_16x16x32_bf16 v[68:71], v[36:39], a[36:39], v[68:71]
  v_mfma_f32_16x16x32_bf16 v[72:75], v[36:39], a[60:63], v[72:75]
  v_mfma_f32_16x16x32_bf16 v[76:79], v[36:39], a[84:87], v[76:79]
  v_mfma_f32_16x16x32_bf16 v[80:83], v[36:39], a[108:111], v[80:83]
  v_mfma_f32_16x16x32_bf16 v[84:87], v[36:39], a[132:135], v[84:87]
  v_mfma_f32_16x16x32_bf16 v[88:91], v[36:39], a[156:159], v[88:91]
  v_mfma_f32_16x16x32_bf16 v[92:95], v[36:39], a[180:183], v[92:95]
  v_mfma_f32_16x16x32_bf16 v[96:99], v[36:39], a[204:207], v[96:99]
  v_mfma_f32_16x16x32_bf16 v[100:103], v[36:39], a[228:231], v[100:103]
  v_mfma_f32_16x16x32_bf16 v[64:67], v[40:43], a[16:19], v[64:67]
  v_mfma_f32_16x16x32_bf16 v[68:71], v[40:43], a[40:43], v[68:71]
  v_mfma_f32_16x16x32_bf16 v[72:75], v[40:43], a[64:67], v[72:75]
  v_mfma_f32_16x16x32_bf16 v[76:79], v[40:43], a[88:91], v[76:79]
  v_mfma_f32_16x16x32_bf16 v[80:83], v[40:43], a[112:115], v[80:83]
  v_mfma_f32_16x16x32_bf16 v[84:87], v[40:43], a[136:139], v[84:87]
  v_mfma_f32_16x16x32_bf16 v[88:91], v[40:43], a[160:163], v[88:91]
  v_mfma_f32_16x16x32_bf16 v[92:95], v[40:43], a[184:187], v[92:95]
  v_mfma_f32_16x16x32_bf16 v[96:99], v[40:43], a[208:211], v[96:99]
  v_mfma_f32_16x16x32_bf16 v[100:103], v[40:43], a[232:235], v[100:103]
  v_mfma_f32_16x16x32_bf16 v[64:67], v[44:47], a[20:23], v[64:67]
  v_mfma_f32_16x16x32_bf16 v[68:71], v[44:47], a[44:47], v[68:71]
  v_mfma_f32_16x16x32_bf16 v[72:75], v[44:47], a[68:71], v[72:75]
  v_mfma_f32_16x16x32_bf16 v[76:79], v[44:47], a[92:95], v[76:79]
  v_mfma_f32_16x16x32_bf16 v[80:83], v[44:47], a[116:119], v[80:83]
  v_mfma_f32_16x16x32_bf16 v[84:87], v[44:47], a[140:143], v[84:87]
  v_mfma_f32_16x16x32_bf16 v[88:91], v[44:47], a[164:167], v[88:91]
  v_mfma_f32_16x16x32_bf16 v[92:95], v[44:47], a[188:191], v[92:95]
  v_mfma_f32_16x16x32_bf16 v[96:99], v[44:47], a[212:215], v[96:99]
  v_mfma_f32_16x16x32_bf16 v[100:103], v[44:47], a[236:239], v[100:103]
  s_cmp_eq_u32 s54, 2
  s_cselect_b32 s61, -1, 0
  s_mov_b32 s60, -1
  s_cselect_b32 s58, 3, 1
  s_lshl_b32 s57, s55, 3
  s_and_b32 s21, s2, 7
  s_add_u32 s57, s57, s21
  s_lshl_b32 s57, s57, 7
  s_add_u32 s57, s57, 22528
  s_add_u32 s55, s55, s54
  v_cvt_pk_bf16_f32 v48, v64, v65
  v_cvt_pk_bf16_f32 v49, v66, v67
  v_cvt_pk_bf16_f32 v50, v68, v69
  v_cvt_pk_bf16_f32 v51, v70, v71
  v_cvt_pk_bf16_f32 v52, v72, v73
  v_cvt_pk_bf16_f32 v53, v74, v75
  v_cvt_pk_bf16_f32 v54, v76, v77
  v_cvt_pk_bf16_f32 v55, v78, v79
  v_cvt_pk_bf16_f32 v56, v80, v81
  v_cvt_pk_bf16_f32 v57, v82, v83
  v_cvt_pk_bf16_f32 v58, v84, v85
  v_cvt_pk_bf16_f32 v59, v86, v87
  v_cvt_pk_bf16_f32 v60, v88, v89
  v_cvt_pk_bf16_f32 v61, v90, v91
  v_cvt_pk_bf16_f32 v62, v92, v93
  v_cvt_pk_bf16_f32 v63, v94, v95
  v_cvt_pk_bf16_f32 v240, v96, v97
  v_cvt_pk_bf16_f32 v241, v98, v99
  v_cvt_pk_bf16_f32 v242, v100, v101
  v_cvt_pk_bf16_f32 v243, v102, v103
  v_min_u32 v48, -2, v48
  v_min_u32 v52, -2, v52
  v_min_u32 v56, -2, v56
  v_min_u32 v60, -2, v60
  v_min_u32 v240, -2, v240
  s_mov_b64 exec, s[60:61]
  buffer_store_dwordx4 v[48:51], v15, s[80:83], s63 offen offset:0 sc1
  buffer_store_dwordx4 v[52:55], v15, s[80:83], s63 offen offset:512 sc1
  buffer_store_dwordx4 v[56:59], v15, s[80:83], s63 offen offset:1024 sc1
  buffer_store_dwordx4 v[60:63], v15, s[80:83], s63 offen offset:1536 sc1
  buffer_store_dwordx4 v[240:243], v15, s[80:83], s63 offen offset:2048 sc1
  s_mov_b64 exec, -1
  s_add_u32 s63, s63, 655360
  s_branch ul_192
ux_201:
  s_waitcnt vmcnt(0)
  s_cmp_eq_u32 s66, 0
  s_cbranch_scc1 uf_208
  s_mov_b64 exec, s[66:67]
  buffer_atomic_add v11, v17, s[72:75], s65 offen sc1
  s_mov_b64 exec, -1
  s_mov_b32 s66, 0
uf_208:
  s_cmp_eq_u32 s58, 0
  s_cbranch_scc1 uf_209
  s_mov_b64 exec, s[58:59]
  buffer_atomic_add v11, v17, s[72:75], s57 offen sc1
  s_mov_b64 exec, -1
  s_mov_b32 s58, 0
uf_209:
  v_mfma_f32_16x16x32_bf16 v[64:67], a[240:243], a[0:3], 0
  v_mfma_f32_16x16x32_bf16 v[68:71], a[240:243], a[24:27], 0
  v_mfma_f32_16x16x32_bf16 v[72:75], a[240:243], a[48:51], 0
  v_mfma_f32_16x16x32_bf16 v[76:79], a[240:243], a[72:75], 0
  v_mfma_f32_16x16x32_bf16 v[80:83], a[240:243], a[96:99], 0
  v_mfma_f32_16x16x32_bf16 v[84:87], a[240:243], a[120:123], 0
  v_mfma_f32_16x16x32_bf16 v[88:91], a[240:243], a[144:147], 0
  v_mfma_f32_16x16x32_bf16 v[92:95], a[240:243], a[168:171], 0
  v_mfma_f32_16x16x32_bf16 v[96:99], a[240:243], a[192:195], 0
  v_mfma_f32_16x16x32_bf16 v[100:103], a[240:243], a[216:219], 0
  v_mfma_f32_16x16x32_bf16 v[64:67], a[244:247], a[4:7], v[64:67]
  v_mfma_f32_16x16x32_bf16 v[68:71], a[244:247], a[28:31], v[68:71]
  v_mfma_f32_16x16x32_bf16 v[72:75], a[244:247], a[52:55], v[72:75]
  v_mfma_f32_16x16x32_bf16 v[76:79], a[244:247], a[76:79], v[76:79]
  v_mfma_f32_16x16x32_bf16 v[80:83], a[244:247], a[100:103], v[80:83]
  v_mfma_f32_16x16x32_bf16 v[84:87], a[244:247], a[124:127], v[84:87]
  v_mfma_f32_16x16x32_bf16 v[88:91], a[244:247], a[148:151], v[88:91]
  v_mfma_f32_16x16x32_bf16 v[92:95], a[244:247], a[172:175], v[92:95]
  v_mfma_f32_16x16x32_bf16 v[96:99], a[244:247], a[196:199], v[96:99]
  v_mfma_f32_16x16x32_bf16 v[100:103], a[244:247], a[220:223], v[100:103]
  v_mfma_f32_16x16x32_bf16 v[64:67], a[248:251], a[8:11], v[64:67]
  v_mfma_f32_16x16x32_bf16 v[68:71], a[248:251], a[32:35], v[68:71]
  v_mfma_f32_16x16x32_bf16 v[72:75], a[248:251], a[56:59], v[72:75]
  v_mfma_f32_16x16x32_bf16 v[76:79], a[248:251], a[80:83], v[76:79]
  v_mfma_f32_16x16x32_bf16 v[80:83], a[248:251], a[104:107], v[80:83]
  v_mfma_f32_16x16x32_bf16 v[84:87], a[248:251], a[128:131], v[84:87]
  v_mfma_f32_16x16x32_bf16 v[88:91], a[248:251], a[152:155], v[88:91]
  v_mfma_f32_16x16x32_bf16 v[92:95], a[248:251], a[176:179], v[92:95]
  v_mfma_f32_16x16x32_bf16 v[96:99], a[248:251], a[200:203], v[96:99]
  v_mfma_f32_16x16x32_bf16 v[100:103], a[248:251], a[224:227], v[100:103]
  v_mfma_f32_16x16x32_bf16 v[64:67], a[252:255], a[12:15], v[64:67]
  v_mfma_f32_16x16x32_bf16 v[68:71], a[252:255], a[36:39], v[68:71]
  v_mfma_f32_16x16x32_bf16 v[72:75], a[252:255], a[60:63], v[72:75]
  v_mfma_f32_16x16x32_bf16 v[76:79], a[252:255], a[84:87], v[76:79]
  v_mfma_f32_16x16x32_bf16 v[80:83], a[252:255], a[108:111], v[80:83]
  v_mfma_f32_16x16x32_bf16 v[84:87], a[252:255], a[132:135], v[84:87]
  v_mfma_f32_16x16x32_bf16 v[88:91], a[252:255], a[156:159], v[88:91]
  v_mfma_f32_16x16x32_bf16 v[92:95], a[252:255], a[180:183], v[92:95]
  v_mfma_f32_16x16x32_bf16 v[96:99], a[252:255], a[204:207], v[96:99]
  v_mfma_f32_16x16x32_bf16 v[100:103], a[252:255], a[228:231], v[100:103]
  v_mfma_f32_16x16x32_bf16 v[64:67], v[248:251], a[16:19], v[64:67]
  v_mfma_f32_16x16x32_bf16 v[68:71], v[248:251], a[40:43], v[68:71]
  v_mfma_f32_16x16x32_bf16 v[72:75], v[248:251], a[64:67], v[72:75]
  v_mfma_f32_16x16x32_bf16 v[76:79], v[248:251], a[88:91], v[76:79]
  v_mfma_f32_16x16x32_bf16 v[80:83], v[248:251], a[112:115], v[80:83]
  v_mfma_f32_16x16x32_bf16 v[84:87], v[248:251], a[136:139], v[84:87]
  v_mfma_f32_16x16x32_bf16 v[88:91], v[248:251], a[160:163], v[88:91]
  v_mfma_f32_16x16x32_bf16 v[92:95], v[248:251], a[184:187], v[92:95]
  v_mfma_f32_16x16x32_bf16 v[96:99], v[248:251], a[208:211], v[96:99]
  v_mfma_f32_16x16x32_bf16 v[100:103], v[248:251], a[232:235], v[100:103]
  v_mfma_f32_16x16x32_bf16 v[64:67], v[252:255], a[20:23], v[64:67]
  v_mfma_f32_16x16x32_bf16 v[68:71], v[252:255], a[44:47], v[68:71]
  v_mfma_f32_16x16x32_bf16 v[72:75], v[252:255], a[68:71], v[72:75]
  v_mfma_f32_16x16x32_bf16 v[76:79], v[252:255], a[92:95], v[76:79]
  v_mfma_f32_16x16x32_bf16 v[80:83], v[252:255], a[116:119], v[80:83]
  v_mfma_f32_16x16x32_bf16 v[84:87], v[252:255], a[140:143], v[84:87]
  v_mfma_f32_16x16x32_bf16 v[88:91], v[252:255], a[164:167], v[88:91]
  v_mfma_f32_16x16x32_bf16 v[92:95], v[252:255], a[188:191], v[92:95]
  v_mfma_f32_16x16x32_bf16 v[96:99], v[252:255], a[212:215], v[96:99]
  v_mfma_f32_16x16x32_bf16 v[100:103], v[252:255], a[236:239], v[100:103]
  s_cmp_eq_u32 s54, 2
  s_cselect_b32 s61, -1, 0
  s_mov_b32 s60, -1
  s_cselect_b32 s58, 3, 1
  s_lshl_b32 s57, s55, 3
  s_and_b32 s21, s2, 7
  s_add_u32 s57, s57, s21
  s_lshl_b32 s57, s57, 7
  s_add_u32 s57, s57, 22528
  s_add_u32 s55, s55, s54
  v_cvt_pk_bf16_f32 v48, v64, v65
  v_cvt_pk_bf16_f32 v49, v66, v67
  v_cvt_pk_bf16_f32 v50, v68, v69
  v_cvt_pk_bf16_f32 v51, v70, v71
  v_cvt_pk_bf16_f32 v52, v72, v73
  v_cvt_pk_bf16_f32 v53, v74, v75
  v_cvt_pk_bf16_f32 v54, v76, v77
  v_cvt_pk_bf16_f32 v55, v78, v79
  v_cvt_pk_bf16_f32 v56, v80, v81
  v_cvt_pk_bf16_f32 v57, v82, v83
  v_cvt_pk_bf16_f32 v58, v84, v85
  v_cvt_pk_bf16_f32 v59, v86, v87
  v_cvt_pk_bf16_f32 v60, v88, v89
  v_cvt_pk_bf16_f32 v61, v90, v91
  v_cvt_pk_bf16_f32 v62, v92, v93
  v_cvt_pk_bf16_f32 v63, v94, v95
  v_cvt_pk_bf16_f32 v240, v96, v97
  v_cvt_pk_bf16_f32 v241, v98, v99
  v_cvt_pk_bf16_f32 v242, v100, v101
  v_cvt_pk_bf16_f32 v243, v102, v103
  v_min_u32 v48, -2, v48
  v_min_u32 v52, -2, v52
  v_min_u32 v56, -2, v56
  v_min_u32 v60, -2, v60
  v_min_u32 v240, -2, v240
  s_mov_b64 exec, s[60:61]
  buffer_store_dwordx4 v[48:51], v15, s[80:83], s63 offen offset:0 sc1
  buffer_store_dwordx4 v[52:55], v15, s[80:83], s63 offen offset:512 sc1
  buffer_store_dwordx4 v[56:59], v15, s[80:83], s63 offen offset:1024 sc1
  buffer_store_dwordx4 v[60:63], v15, s[80:83], s63 offen offset:1536 sc1
  buffer_store_dwordx4 v[240:243], v15, s[80:83], s63 offen offset:2048 sc1
  s_mov_b64 exec, -1
  s_add_u32 s63, s63, 655360
  s_branch ul_192
uo_199:
  s_sub_u32 s21, s56, s55
  s_cmp_ge_u32 s21, 2
  s_cselect_b64 vcc, -1, 0
  s_cselect_b32 s54, 2, 1
  v_cndmask_b32 v18, v13, v14, vcc
  s_lshl_b32 s21, s55, 5
  s_add_u32 s21, s21, s2
  s_mul_i32 s62, s21, 3072
  s_mul_i32 s63, s21, 10240
  s_mul_i32 s22, s20, 2560
  s_add_u32 s63, s63, s22
  buffer_load_dwordx4 a[240:243], v18, s[76:79], s62 offen offset:0 sc1
  buffer_load_dwordx4 a[244:247], v18, s[76:79], s62 offen offset:512 sc1
  buffer_load_dwordx4 a[248:251], v18, s[76:79], s62 offen offset:1024 sc1
  buffer_load_dwordx4 a[252:255], v18, s[76:79], s62 offen offset:1536 sc1
  buffer_load_dwordx4 v[248:251], v18, s[76:79], s62 offen offset:2048 sc1
  buffer_load_dwordx4 v[252:255], v18, s[76:79], s62 offen offset:2560 sc1
  s_waitcnt vmcnt(0)
  s_cmp_eq_u32 s58, 0
  s_cbranch_scc1 uf_210
  s_mov_b64 exec, s[58:59]
  buffer_atomic_add v11, v17, s[72:75], s57 offen sc1
  s_mov_b64 exec, -1
  s_mov_b32 s58, 0
uf_210:
  v_mfma_f32_16x16x32_bf16 v[64:67], a[240:243], a[0:3], 0
  v_mfma_f32_16x16x32_bf16 v[68:71], a[240:243], a[24:27], 0
  v_mfma_f32_16x16x32_bf16 v[72:75], a[240:243], a[48:51], 0
  v_mfma_f32_16x16x32_bf16 v[76:79], a[240:243], a[72:75], 0
  v_mfma_f32_16x16x32_bf16 v[80:83], a[240:243], a[96:99], 0
  v_mfma_f32_16x16x32_bf16 v[84:87], a[240:243], a[120:123], 0
  v_mfma_f32_16x16x32_bf16 v[88:91], a[240:243], a[144:147], 0
  v_mfma_f32_16x16x32_bf16 v[92:95], a[240:243], a[168:171], 0
  v_mfma_f32_16x16x32_bf16 v[96:99], a[240:243], a[192:195], 0
  v_mfma_f32_16x16x32_bf16 v[100:103], a[240:243], a[216:219], 0
  v_mfma_f32_16x16x32_bf16 v[64:67], a[244:247], a[4:7], v[64:67]
  v_mfma_f32_16x16x32_bf16 v[68:71], a[244:247], a[28:31], v[68:71]
  v_mfma_f32_16x16x32_bf16 v[72:75], a[244:247], a[52:55], v[72:75]
  v_mfma_f32_16x16x32_bf16 v[76:79], a[244:247], a[76:79], v[76:79]
  v_mfma_f32_16x16x32_bf16 v[80:83], a[244:247], a[100:103], v[80:83]
  v_mfma_f32_16x16x32_bf16 v[84:87], a[244:247], a[124:127], v[84:87]
  v_mfma_f32_16x16x32_bf16 v[88:91], a[244:247], a[148:151], v[88:91]
  v_mfma_f32_16x16x32_bf16 v[92:95], a[244:247], a[172:175], v[92:95]
  v_mfma_f32_16x16x32_bf16 v[96:99], a[244:247], a[196:199], v[96:99]
  v_mfma_f32_16x16x32_bf16 v[100:103], a[244:247], a[220:223], v[100:103]
  v_mfma_f32_16x16x32_bf16 v[64:67], a[248:251], a[8:11], v[64:67]
  v_mfma_f32_16x16x32_bf16 v[68:71], a[248:251], a[32:35], v[68:71]
  v_mfma_f32_16x16x32_bf16 v[72:75], a[248:251], a[56:59], v[72:75]
  v_mfma_f32_16x16x32_bf16 v[76:79], a[248:251], a[80:83], v[76:79]
  v_mfma_f32_16x16x32_bf16 v[80:83], a[248:251], a[104:107], v[80:83]
  v_mfma_f32_16x16x32_bf16 v[84:87], a[248:251], a[128:131], v[84:87]
  v_mfma_f32_16x16x32_bf16 v[88:91], a[248:251], a[152:155], v[88:91]
  v_mfma_f32_16x16x32_bf16 v[92:95], a[248:251], a[176:179], v[92:95]
  v_mfma_f32_16x16x32_bf16 v[96:99], a[248:251], a[200:203], v[96:99]
  v_mfma_f32_16x16x32_bf16 v[100:103], a[248:251], a[224:227], v[100:103]
  v_mfma_f32_16x16x32_bf16 v[64:67], a[252:255], a[12:15], v[64:67]
  v_mfma_f32_16x16x32_bf16 v[68:71], a[252:255], a[36:39], v[68:71]
  v_mfma_f32_16x16x32_bf16 v[72:75], a[252:255], a[60:63], v[72:75]
  v_mfma_f32_16x16x32_bf16 v[76:79], a[252:255], a[84:87], v[76:79]
  v_mfma_f32_16x16x32_bf16 v[80:83], a[252:255], a[108:111], v[80:83]
  v_mfma_f32_16x16x32_bf16 v[84:87], a[252:255], a[132:135], v[84:87]
  v_mfma_f32_16x16x32_bf16 v[88:91], a[252:255], a[156:159], v[88:91]
  v_mfma_f32_16x16x32_bf16 v[92:95], a[252:255], a[180:183], v[92:95]
  v_mfma_f32_16x16x32_bf16 v[96:99], a[252:255], a[204:207], v[96:99]
  v_mfma_f32_16x16x32_bf16 v[100:103], a[252:255], a[228:231], v[100:103]
  v_mfma_f32_16x16x32_bf16 v[64:67], v[248:251], a[16:19], v[64:67]
  v_mfma_f32_16x16x32_bf16 v[68:71], v[248:251], a[40:43], v[68:71]
  v_mfma_f32_16x16x32_bf16 v[72:75], v[248:251], a[64:67], v[72:75]
  v_mfma_f32_16x16x32_bf16 v[76:79], v[248:251], a[88:91], v[76:79]
  v_mfma_f32_16x16x32_bf16 v[80:83], v[248:251], a[112:115], v[80:83]
  v_mfma_f32_16x16x32_bf16 v[84:87], v[248:251], a[136:139], v[84:87]
  v_mfma_f32_16x16x32_bf16 v[88:91], v[248:251], a[160:163], v[88:91]
  v_mfma_f32_16x16x32_bf16 v[92:95], v[248:251], a[184:187], v[92:95]
  v_mfma_f32_16x16x32_bf16 v[96:99], v[248:251], a[208:211], v[96:99]
  v_mfma_f32_16x16x32_bf16 v[100:103], v[248:251], a[232:235], v[100:103]
  v_mfma_f32_16x16x32_bf16 v[64:67], v[252:255], a[20:23], v[64:67]
  v_mfma_f32_16x16x32_bf16 v[68:71], v[252:255], a[44:47], v[68:71]
  v_mfma_f32_16x16x32_bf16 v[72:75], v[252:255], a[68:71], v[72:75]
  v_mfma_f32_16x16x32_bf16 v[76:79], v[252:255], a[92:95], v[76:79]
  v_mfma_f32_16x16x32_bf16 v[80:83], v[252:255], a[116:119], v[80:83]
  v_mfma_f32_16x16x32_bf16 v[84:87], v[252:255], a[140:143], v[84:87]
  v_mfma_f32_16x16x32_bf16 v[88:91], v[252:255], a[164:167], v[88:91]
  v_mfma_f32_16x16x32_bf16 v[92:95], v[252:255], a[188:191], v[92:95]
  v_mfma_f32_16x16x32_bf16 v[96:99], v[252:255], a[212:215], v[96:99]
  v_mfma_f32_16x16x32_bf16 v[100:103], v[252:255], a[236:239], v[100:103]
  s_cmp_eq_u32 s54, 2
  s_cselect_b32 s61, -1, 0
  s_mov_b32 s60, -1
  s_cselect_b32 s58, 3, 1
  s_lshl_b32 s57, s55, 3
  s_and_b32 s21, s2, 7
  s_add_u32 s57, s57, s21
  s_lshl_b32 s57, s57, 7
  s_add_u32 s57, s57, 22528
  s_add_u32 s55, s55, s54
  v_cvt_pk_bf16_f32 v48, v64, v65
  v_cvt_pk_bf16_f32 v49, v66, v67
  v_cvt_pk_bf16_f32 v50, v68, v69
  v_cvt_pk_bf16_f32 v51, v70, v71
  v_cvt_pk_bf16_f32 v52, v72, v73
  v_cvt_pk_bf16_f32 v53, v74, v75
  v_cvt_pk_bf16_f32 v54, v76, v77
  v_cvt_pk_bf16_f32 v55, v78, v79
  v_cvt_pk_bf16_f32 v56, v80, v81
  v_cvt_pk_bf16_f32 v57, v82, v83
  v_cvt_pk_bf16_f32 v58, v84, v85
  v_cvt_pk_bf16_f32 v59, v86, v87
  v_cvt_pk_bf16_f32 v60, v88, v89
  v_cvt_pk_bf16_f32 v61, v90, v91
  v_cvt_pk_bf16_f32 v62, v92, v93
  v_cvt_pk_bf16_f32 v63, v94, v95
  v_cvt_pk_bf16_f32 v240, v96, v97
  v_cvt_pk_bf16_f32 v241, v98, v99
  v_cvt_pk_bf16_f32 v242, v100, v101
  v_cvt_pk_bf16_f32 v243, v102, v103
  v_min_u32 v48, -2, v48
  v_min_u32 v52, -2, v52
  v_min_u32 v56, -2, v56
  v_min_u32 v60, -2, v60
  v_min_u32 v240, -2, v240
  s_mov_b64 exec, s[60:61]
  buffer_store_dwordx4 v[48:51], v15, s[80:83], s63 offen offset:0 sc1
  buffer_store_dwordx4 v[52:55], v15, s[80:83], s63 offen offset:512 sc1
  buffer_store_dwordx4 v[56:59], v15, s[80:83], s63 offen offset:1024 sc1
  buffer_store_dwordx4 v[60:63], v15, s[80:83], s63 offen offset:1536 sc1
  buffer_store_dwordx4 v[240:243], v15, s[80:83], s63 offen offset:2048 sc1
  s_mov_b64 exec, -1
  s_branch ul_192
ut_195:
  s_min_u32 s23, s55, 62
  s_add_u32 s56, s55, 1
  s_mov_b32 s54, 1
  s_lshl_b32 s21, s55, 5
  s_add_u32 s21, s21, s2
  s_mul_i32 s62, s21, 3072
  s_mul_i32 s63, s21, 10240
  s_mul_i32 s22, s20, 2560
  s_add_u32 s63, s63, s22
  s_mov_b32 s101, 0
  s_branch utp_212
utp_211:
  s_sleep 3
utp_212:
  buffer_load_dwordx4 v[24:27], v13, s[76:79], s62 offen offset:0 sc1
  buffer_load_dwordx4 v[28:31], v13, s[76:79], s62 offen offset:512 sc1
  buffer_load_dwordx4 v[32:35], v13, s[76:79], s62 offen offset:1024 sc1
  buffer_load_dwordx4 v[36:39], v13, s[76:79], s62 offen offset:1536 sc1
  buffer_load_dwordx4 v[40:43], v13, s[76:79], s62 offen offset:2048 sc1
  buffer_load_dwordx4 v[44:47], v13, s[76:79], s62 offen offset:2560 sc1
  s_add_u32 s101, s101, 1
  s_cmp_gt_u32 s101, 131072
  s_cbranch_scc1 main_end
  s_waitcnt vmcnt(0)
  s_cmp_eq_u32 s58, 0
  s_cbranch_scc1 uf_213
  s_mov_b64 exec, s[58:59]
  buffer_atomic_add v11, v17, s[72:75], s57 offen sc1
  s_mov_b64 exec, -1
  s_mov_b32 s58, 0
uf_213:
  v_max3_u32 v8, v24, v26, v28
  v_max3_u32 v8, v8, v30, v32
  v_max3_u32 v8, v8, v34, v36
  v_max3_u32 v8, v8, v38, v40
  v_max3_u32 v8, v8, v42, v44
  v_max3_u32 v8, v8, v46, v46
  v_cmp_eq_u32 vcc, -1, v8
  s_nop 1
  s_cbranch_vccnz utp_211
  v_mfma_f32_16x16x32_bf16 v[64:67], v[24:27], a[0:3], 0
  v_mfma_f32_16x16x32_bf16 v[68:71], v[24:27], a[24:27], 0
  v_mfma_f32_16x16x32_bf16 v[72:75], v[24:27], a[48:51], 0
  v_mfma_f32_16x16x32_bf16 v[76:79], v[24:27], a[72:75], 0
  v_mfma_f32_16x16x32_bf16 v[80:83], v[24:27], a[96:99], 0
  v_mfma_f32_16x16x32_bf16 v[84:87], v[24:27], a[120:123], 0
  v_mfma_f32_16x16x32_bf16 v[88:91], v[24:27], a[144:147], 0
  v_mfma_f32_16x16x32_bf16 v[92:95], v[24:27], a[168:171], 0
  v_mfma_f32_16x16x32_bf16 v[96:99], v[24:27], a[192:195], 0
  v_mfma_f32_16x16x32_bf16 v[100:103], v[24:27], a[216:219], 0
  v_mfma_f32_16x16x32_bf16 v[64:67], v[28:31], a[4:7], v[64:67]
  v_mfma_f32_16x16x32_bf16 v[68:71], v[28:31], a[28:31], v[68:71]
  v_mfma_f32_16x16x32_bf16 v[72:75], v[28:31], a[52:55], v[72:75]
  v_mfma_f32_16x16x32_bf16 v[76:79], v[28:31], a[76:79], v[76:79]
  v_mfma_f32_16x16x32_bf16 v[80:83], v[28:31], a[100:103], v[80:83]
  v_mfma_f32_16x16x32_bf16 v[84:87], v[28:31], a[124:127], v[84:87]
  v_mfma_f32_16x16x32_bf16 v[88:91], v[28:31], a[148:151], v[88:91]
  v_mfma_f32_16x16x32_bf16 v[92:95], v[28:31], a[172:175], v[92:95]
  v_mfma_f32_16x16x32_bf16 v[96:99], v[28:31], a[196:199], v[96:99]
  v_mfma_f32_16x16x32_bf16 v[100:103], v[28:31], a[220:223], v[100:103]
  v_mfma_f32_16x16x32_bf16 v[64:67], v[32:35], a[8:11], v[64:67]
  v_mfma_f32_16x16x32_bf16 v[68:71], v[32:35], a[32:35], v[68:71]
  v_mfma_f32_16x16x32_bf16 v[72:75], v[32:35], a[56:59], v[72:75]
  v_mfma_f32_16x16x32_bf16 v[76:79], v[32:35], a[80:83], v[76:79]
  v_mfma_f32_16x16x32_bf16 v[80:83], v[32:35], a[104:107], v[80:83]
  v_mfma_f32_16x16x32_bf16 v[84:87], v[32:35], a[128:131], v[84:87]
  v_mfma_f32_16x16x32_bf16 v[88:91], v[32:35], a[152:155], v[88:91]
  v_mfma_f32_16x16x32_bf16 v[92:95], v[32:35], a[176:179], v[92:95]
  v_mfma_f32_16x16x32_bf16 v[96:99], v[32:35], a[200:203], v[96:99]
  v_mfma_f32_16x16x32_bf16 v[100:103], v[32:35], a[224:227], v[100:103]
  v_mfma_f32_16x16x32_bf16 v[64:67], v[36:39], a[12:15], v[64:67]
  v_mfma_f32_16x16x32_bf16 v[68:71], v[36:39], a[36:39], v[68:71]
  v_mfma_f32_16x16x32_bf16 v[72:75], v[36:39], a[60:63], v[72:75]
  v_mfma_f32_16x16x32_bf16 v[76:79], v[36:39], a[84:87], v[76:79]
  v_mfma_f32_16x16x32_bf16 v[80:83], v[36:39], a[108:111], v[80:83]
  v_mfma_f32_16x16x32_bf16 v[84:87], v[36:39], a[132:135], v[84:87]
  v_mfma_f32_16x16x32_bf16 v[88:91], v[36:39], a[156:159], v[88:91]
  v_mfma_f32_16x16x32_bf16 v[92:95], v[36:39], a[180:183], v[92:95]
  v_mfma_f32_16x16x32_bf16 v[96:99], v[36:39], a[204:207], v[96:99]
  v_mfma_f32_16x16x32_bf16 v[100:103], v[36:39], a[228:231], v[100:103]
  v_mfma_f32_16x16x32_bf16 v[64:67], v[40:43], a[16:19], v[64:67]
  v_mfma_f32_16x16x32_bf16 v[68:71], v[40:43], a[40:43], v[68:71]
  v_mfma_f32_16x16x32_bf16 v[72:75], v[40:43], a[64:67], v[72:75]
  v_mfma_f32_16x16x32_bf16 v[76:79], v[40:43], a[88:91], v[76:79]
  v_mfma_f32_16x16x32_bf16 v[80:83], v[40:43], a[112:115], v[80:83]
  v_mfma_f32_16x16x32_bf16 v[84:87], v[40:43], a[136:139], v[84:87]
  v_mfma_f32_16x16x32_bf16 v[88:91], v[40:43], a[160:163], v[88:91]
  v_mfma_f32_16x16x32_bf16 v[92:95], v[40:43], a[184:187], v[92:95]
  v_mfma_f32_16x16x32_bf16 v[96:99], v[40:43], a[208:211], v[96:99]
  v_mfma_f32_16x16x32_bf16 v[100:103], v[40:43], a[232:235], v[100:103]
  v_mfma_f32_16x16x32_bf16 v[64:67], v[44:47], a[20:23], v[64:67]
  v_mfma_f32_16x16x32_bf16 v[68:71], v[44:47], a[44:47], v[68:71]
  v_mfma_f32_16x16x32_bf16 v[72:75], v[44:47], a[68:71], v[72:75]
  v_mfma_f32_16x16x32_bf16 v[76:79], v[44:47], a[92:95], v[76:79]
  v_mfma_f32_16x16x32_bf16 v[80:83], v[44:47], a[116:119], v[80:83]
  v_mfma_f32_16x16x32_bf16 v[84:87], v[44:47], a[140:143], v[84:87]
  v_mfma_f32_16x16x32_bf16 v[88:91], v[44:47], a[164:167], v[88:91]
  v_mfma_f32_16x16x32_bf16 v[92:95], v[44:47], a[188:191], v[92:95]
  v_mfma_f32_16x16x32_bf16 v[96:99], v[44:47], a[212:215], v[96:99]
  v_mfma_f32_16x16x32_bf16 v[100:103], v[44:47], a[236:239], v[100:103]
  s_cmp_eq_u32 s54, 2
  s_cselect_b32 s61, -1, 0
  s_mov_b32 s60, -1
  s_cselect_b32 s58, 3, 1
  s_lshl_b32 s57, s55, 3
  s_and_b32 s21, s2, 7
  s_add_u32 s57, s57, s21
  s_lshl_b32 s57, s57, 7
  s_add_u32 s57, s57, 22528
  s_add_u32 s55, s55, s54
  v_cvt_pk_bf16_f32 v48, v64, v65
  v_cvt_pk_bf16_f32 v49, v66, v67
  v_cvt_pk_bf16_f32 v50, v68, v69
  v_cvt_pk_bf16_f32 v51, v70, v71
  v_cvt_pk_bf16_f32 v52, v72, v73
  v_cvt_pk_bf16_f32 v53, v74, v75
  v_cvt_pk_bf16_f32 v54, v76, v77
  v_cvt_pk_bf16_f32 v55, v78, v79
  v_cvt_pk_bf16_f32 v56, v80, v81
  v_cvt_pk_bf16_f32 v57, v82, v83
  v_cvt_pk_bf16_f32 v58, v84, v85
  v_cvt_pk_bf16_f32 v59, v86, v87
  v_cvt_pk_bf16_f32 v60, v88, v89
  v_cvt_pk_bf16_f32 v61, v90, v91
  v_cvt_pk_bf16_f32 v62, v92, v93
  v_cvt_pk_bf16_f32 v63, v94, v95
  v_cvt_pk_bf16_f32 v240, v96, v97
  v_cvt_pk_bf16_f32 v241, v98, v99
  v_cvt_pk_bf16_f32 v242, v100, v101
  v_cvt_pk_bf16_f32 v243, v102, v103
  v_min_u32 v48, -2, v48
  v_min_u32 v52, -2, v52
  v_min_u32 v56, -2, v56
  v_min_u32 v60, -2, v60
  v_min_u32 v240, -2, v240
  s_mov_b64 exec, s[60:61]
  buffer_store_dwordx4 v[48:51], v15, s[80:83], s63 offen offset:0 sc1
  buffer_store_dwordx4 v[52:55], v15, s[80:83], s63 offen offset:512 sc1
  buffer_store_dwordx4 v[56:59], v15, s[80:83], s63 offen offset:1024 sc1
  buffer_store_dwordx4 v[60:63], v15, s[80:83], s63 offen offset:1536 sc1
  buffer_store_dwordx4 v[240:243], v15, s[80:83], s63 offen offset:2048 sc1
  s_mov_b64 exec, -1
  s_branch ul_192
ud_194:
  s_mov_b32 s84, 0
  s_mov_b32 s85, -1
  s_mov_b32 s86, 0
  s_branch queue
not_vw:
  s_sub_u32 s2, s3, 96
  s_cmp_lg_u32 s2, 31
  s_cbranch_scc1 not_cal
  s_load_dwordx2 s[72:73], s[0:1], 104
  s_waitcnt lgkmcnt(0)
  s_add_u32 s72, s72, 81068032
  s_addc_u32 s73, s73, 0
  s_mov_b32 s74, 115712
  s_mov_b32 s75, 0x00020000
  v_lshlrev_b32 v8, 4, v0
  v_mov_b32 v4, 0
  v_mov_b32 v5, 0
  v_mov_b32 v6, 0
  v_mov_b32 v7, 0
  s_mov_b32 s21, 0
  buffer_store_dwordx4 v[4:7], v8, s[72:75], s21 offen sc1
  s_mov_b32 s21, 4096
  buffer_store_dwordx4 v[4:7], v8, s[72:75], s21 offen sc1
  s_mov_b32 s21, 8192
  buffer_store_dwordx4 v[4:7], v8, s[72:75], s21 offen sc1
  s_mov_b32 s21, 12288
  buffer_store_dwordx4 v[4:7], v8, s[72:75], s21 offen sc1
  s_mov_b32 s21, 16384
  buffer_store_dwordx4 v[4:7], v8, s[72:75], s21 offen sc1
  s_mov_b32 s21, 20480
  buffer_store_dwordx4 v[4:7], v8, s[72:75], s21 offen sc1
  s_mov_b32 s21, 24576
  buffer_store_dwordx4 v[4:7], v8, s[72:75], s21 offen sc1
  s_mov_b32 s21, 28672
  buffer_store_dwordx4 v[4:7], v8, s[72:75], s21 offen sc1
  s_mov_b32 s21, 32768
  buffer_store_dwordx4 v[4:7], v8, s[72:75], s21 offen sc1
  s_mov_b32 s21, 36864
  buffer_store_dwordx4 v[4:7], v8, s[72:75], s21 offen sc1
  s_mov_b32 s21, 40960
  buffer_store_dwordx4 v[4:7], v8, s[72:75], s21 offen sc1
  s_mov_b32 s21, 45056
  buffer_store_dwordx4 v[4:7], v8, s[72:75], s21 offen sc1
  s_mov_b32 s21, 49152
  buffer_store_dwordx4 v[4:7], v8, s[72:75], s21 offen sc1
  s_mov_b32 s21, 53248
  buffer_store_dwordx4 v[4:7], v8, s[72:75], s21 offen sc1
  s_mov_b32 s21, 57344
  buffer_store_dwordx4 v[4:7], v8, s[72:75], s21 offen sc1
  s_mov_b32 s21, 61440
  buffer_store_dwordx4 v[4:7], v8, s[72:75], s21 offen sc1
  s_mov_b32 s21, 65536
  buffer_store_dwordx4 v[4:7], v8, s[72:75], s21 offen sc1
  s_mov_b32 s21, 69632
  buffer_store_dwordx4 v[4:7], v8, s[72:75], s21 offen sc1
  s_mov_b32 s21, 73728
  buffer_store_dwordx4 v[4:7], v8, s[72:75], s21 offen sc1
  s_mov_b32 s21, 77824
  buffer_store_dwordx4 v[4:7], v8, s[72:75], s21 offen sc1
  s_mov_b32 s21, 81920
  buffer_store_dwordx4 v[4:7], v8, s[72:75], s21 offen sc1
  s_mov_b32 s21, 86016
  buffer_store_dwordx4 v[4:7], v8, s[72:75], s21 offen sc1
  s_mov_b32 s21, 90112
  buffer_store_dwordx4 v[4:7], v8, s[72:75], s21 offen sc1
  s_mov_b32 s21, 94208
  buffer_store_dwordx4 v[4:7], v8, s[72:75], s21 offen sc1
  s_mov_b32 s21, 98304
  buffer_store_dwordx4 v[4:7], v8, s[72:75], s21 offen sc1
  s_mov_b32 s21, 102400
  buffer_store_dwordx4 v[4:7], v8, s[72:75], s21 offen sc1
  s_mov_b32 s21, 106496
  buffer_store_dwordx4 v[4:7], v8, s[72:75], s21 offen sc1
  s_mov_b32 s21, 110592
  buffer_store_dwordx4 v[4:7], v8, s[72:75], s21 offen sc1
  s_mov_b32 s21, 114688
  buffer_store_dwordx4 v[4:7], v8, s[72:75], s21 offen sc1
  s_waitcnt vmcnt(0)
  s_barrier
  s_cmp_lg_u32 s20, 0
  s_cbranch_scc1 cal_214
  s_mov_b64 exec, 1
  v_mov_b32 v4, 76
  v_mov_b32 v5, 1
  buffer_store_dword v5, v4, s[32:35], 0 offen sc1
  s_add_u32 s8, s38, 83886079
  s_addc_u32 s9, s39, 0
  s_and_b32 s8, s8, 0xffe00000
  s_mov_b32 s10, 2097152
  s_mov_b32 s11, 0x00020000
  v_mov_b32 v4, 0
  s_mov_b32 s40, -1
  s_mov_b32 s41, -1
  s_mov_b32 s42, 1048576
  s_mov_b32 s43, 0
  s_waitcnt vmcnt(0)
cal_215:
  s_add_u32 s21, s42, 0
  s_memtime s[98:99]
  s_waitcnt lgkmcnt(0)
  buffer_load_dword v5, v4, s[8:11], s21 offen sc1
  s_waitcnt vmcnt(0)
  s_memtime s[100:101]
  s_waitcnt lgkmcnt(0)
  s_sub_u32 s21, s100, s98
  s_min_u32 s40, s40, s21
  s_add_u32 s21, s42, 8192
  s_memtime s[98:99]
  s_waitcnt lgkmcnt(0)
  buffer_load_dword v5, v4, s[8:11], s21 offen sc1
  s_waitcnt vmcnt(0)
  s_memtime s[100:101]
  s_waitcnt lgkmcnt(0)
  s_sub_u32 s21, s100, s98
  s_min_u32 s41, s41, s21
  s_add_u32 s42, s42, 16640
  s_add_u32 s43, s43, 1
  s_cmp_lt_u32 s43, 8
  s_cbranch_scc1 cal_215
  s_cmp_lt_u32 s41, s40
  s_cselect_b32 s21, 1, 2
  v_mov_b32 v4, s21
  v_mov_b32 v5, s40
  v_mov_b32 v6, s41
  v_mov_b32 v8, 84
  buffer_store_dwordx3 v[4:6], v8, s[32:35], 0 offen sc1
  s_waitcnt vmcnt(0)
  s_mov_b64 exec, -1
cal_214:
not_cal:
  s_sleep 127
  s_sleep 127
  s_load_dwordx2 s[32:33], s[0:1], 96
  s_waitcnt lgkmcnt(0)
  s_mov_b32 s32, s32
  s_mov_b32 s33, s33
  s_mov_b32 s34, 256
  s_mov_b32 s35, 0x00020000
  s_mov_b32 s21, 76
  s_cmp_lg_u32 s20, 0
  s_cbranch_scc1 wf_217
  v_mov_b32 v4, 0
  s_mov_b32 s101, 0
wf_216:
  buffer_load_dword v5, v4, s[32:35], s21 offen sc1
  s_add_u32 s101, s101, 1
  s_cmp_gt_u32 s101, 131072
  s_cbranch_scc1 main_end
  s_waitcnt vmcnt(0)
  v_readfirstlane_b32 s100, v5
  s_cmp_ge_u32 s100, 1
  s_cbranch_scc1 wf_217
  s_sleep 8
  s_branch wf_216
wf_217:
  s_barrier
  s_load_dwordx2 s[72:73], s[0:1], 104
  s_waitcnt lgkmcnt(0)
  s_add_u32 s72, s72, 81068032
  s_addc_u32 s73, s73, 0
  s_mov_b32 s74, 115712
  s_mov_b32 s75, 0x00020000
  s_cmp_ge_u32 s2, 30
  s_cbranch_scc1 skip_qb
  s_mul_hi_u32 s42, s2, 0x1999999a
  s_mul_i32 s21, s42, 10
  s_sub_u32 s41, s2, s21
  s_sub_u32 s26, 17, s42
  s_mul_hi_u32 s26, s26, 0x55555556
  s_mov_b32 s63, 3
  s_mov_b32 s64, 0
qkvb_entry:
  s_load_dwordx2 s[4:5], s[0:1], 0
  s_load_dwordx2 s[6:7], s[0:1], 64
  s_load_dwordx2 s[38:39], s[0:1], 104
  s_waitcnt lgkmcnt(0)
  s_mov_b32 s8, s4
  s_mov_b32 s9, s5
  s_mov_b32 s10, 2621440
  s_mov_b32 s11, 0x00020000
  s_mov_b32 s12, s6
  s_mov_b32 s13, s7
  s_mov_b32 s14, 2457600
  s_mov_b32 s15, 0x00020000
  s_add_u32 s16, s38, 62914560
  s_addc_u32 s17, s39, 0
  s_mov_b32 s18, 7864320
  s_mov_b32 s19, 0x00020000
  s_mul_i32 s44, s41, 384
  v_mov_b32 v9, 2731
  v_add_u32 v8, 0, v1
  v_mul_u32_u24 v7, v8, v9
  v_lshrrev_b32 v7, 16, v7
  v_mul_u32_u24 v4, 24, v7
  v_sub_u32 v8, v8, v4
  s_mov_b32 s21, 3840
  v_mul_lo_u32 v7, v7, s21
  v_lshl_add_u32 v4, v8, 4, v7
  v_add_u32 v8, 64, v1
  v_mul_u32_u24 v7, v8, v9
  v_lshrrev_b32 v7, 16, v7
  v_mul_u32_u24 v5, 24, v7
  v_sub_u32 v8, v8, v5
  s_mov_b32 s21, 3840
  v_mul_lo_u32 v7, v7, s21
  v_lshl_add_u32 v5, v8, 4, v7
  v_add_u32 v8, 128, v1
  v_mul_u32_u24 v7, v8, v9
  v_lshrrev_b32 v7, 16, v7
  v_mul_u32_u24 v6, 24, v7
  v_sub_u32 v8, v8, v6
  s_mov_b32 s21, 3840
  v_mul_lo_u32 v7, v7, s21
  v_lshl_add_u32 v6, v8, 4, v7
  v_lshrrev_b32 v7, 2, v2
  v_lshl_add_u32 v7, v3, 3, v7
  v_mul_u32_u24 v7, 384, v7
  v_and_b32 v8, 3, v2
  v_lshlrev_b32 v8, 3, v8
  s_mul_i32 s21, s20, 96
  v_add3_u32 v7, v7, v8, s21
  v_add_u32 v8, 61440, v7
  s_mul_i32 s21, s20, 153600
  s_add_u32 s21, s21, 0
  s_add_u32 s21, s21, s44
  s_mul_i32 s22, s20, 15360
  s_add_u32 s22, s22, 0
  s_add_u32 m0, s22, 0
  s_nop 0
  buffer_load_dwordx4 v4, s[12:15], s21 offen lds
  s_add_u32 m0, s22, 1024
  s_nop 0
  buffer_load_dwordx4 v5, s[12:15], s21 offen lds
  s_add_u32 m0, s22, 2048
  s_nop 0
  buffer_load_dwordx4 v6, s[12:15], s21 offen lds
  s_mul_i32 s21, s20, 153600
  s_add_u32 s21, s21, 30720
  s_add_u32 s21, s21, s44
  s_mul_i32 s22, s20, 15360
  s_add_u32 s22, s22, 3072
  s_add_u32 m0, s22, 0
  s_nop 0
  buffer_load_dwordx4 v4, s[12:15], s21 offen lds
  s_add_u32 m0, s22, 1024
  s_nop 0
  buffer_load_dwordx4 v5, s[12:15], s21 offen lds
  s_add_u32 m0, s22, 2048
  s_nop 0
  buffer_load_dwordx4 v6, s[12:15], s21 offen lds
  s_mul_i32 s21, s20, 153600
  s_add_u32 s21, s21, 61440
  s_add_u32 s21, s21, s44
  s_mul_i32 s22, s20, 15360
  s_add_u32 s22, s22, 6144
  s_add_u32 m0, s22, 0
  s_nop 0
  buffer_load_dwordx4 v4, s[12:15], s21 offen lds
  s_add_u32 m0, s22, 1024
  s_nop 0
  buffer_load_dwordx4 v5, s[12:15], s21 offen lds
  s_add_u32 m0, s22, 2048
  s_nop 0
  buffer_load_dwordx4 v6, s[12:15], s21 offen lds
  s_mul_i32 s21, s20, 153600
  s_add_u32 s21, s21, 92160
  s_add_u32 s21, s21, s44
  s_mul_i32 s22, s20, 15360
  s_add_u32 s22, s22, 9216
  s_add_u32 m0, s22, 0
  s_nop 0
  buffer_load_dwordx4 v4, s[12:15], s21 offen lds
  s_add_u32 m0, s22, 1024
  s_nop 0
  buffer_load_dwordx4 v5, s[12:15], s21 offen lds
  s_add_u32 m0, s22, 2048
  s_nop 0
  buffer_load_dwordx4 v6, s[12:15], s21 offen lds
  s_mul_i32 s21, s20, 153600
  s_add_u32 s21, s21, 122880
  s_add_u32 s21, s21, s44
  s_mul_i32 s22, s20, 15360
  s_add_u32 s22, s22, 12288
  s_add_u32 m0, s22, 0
  s_nop 0
  buffer_load_dwordx4 v4, s[12:15], s21 offen lds
  s_add_u32 m0, s22, 1024
  s_nop 0
  buffer_load_dwordx4 v5, s[12:15], s21 offen lds
  s_add_u32 m0, s22, 2048
  s_nop 0
  buffer_load_dwordx4 v6, s[12:15], s21 offen lds
  s_mul_i32 s21, s20, 153600
  s_add_u32 s21, s21, 614400
  s_add_u32 s21, s21, s44
  s_mul_i32 s22, s20, 15360
  s_add_u32 s22, s22, 61440
  s_add_u32 m0, s22, 0
  s_nop 0
  buffer_load_dwordx4 v4, s[12:15], s21 offen lds
  s_add_u32 m0, s22, 1024
  s_nop 0
  buffer_load_dwordx4 v5, s[12:15], s21 offen lds
  s_add_u32 m0, s22, 2048
  s_nop 0
  buffer_load_dwordx4 v6, s[12:15], s21 offen lds
  s_mul_i32 s21, s20, 153600
  s_add_u32 s21, s21, 645120
  s_add_u32 s21, s21, s44
  s_mul_i32 s22, s20, 15360
  s_add_u32 s22, s22, 64512
  s_add_u32 m0, s22, 0
  s_nop 0
  buffer_load_dwordx4 v4, s[12:15], s21 offen lds
  s_add_u32 m0, s22, 1024
  s_nop 0
  buffer_load_dwordx4 v5, s[12:15], s21 offen lds
  s_add_u32 m0, s22, 2048
  s_nop 0
  buffer_load_dwordx4 v6, s[12:15], s21 offen lds
  s_mul_i32 s21, s20, 153600
  s_add_u32 s21, s21, 675840
  s_add_u32 s21, s21, s44
  s_mul_i32 s22, s20, 15360
  s_add_u32 s22, s22, 67584
  s_add_u32 m0, s22, 0
  s_nop 0
  buffer_load_dwordx4 v4, s[12:15], s21 offen lds
  s_add_u32 m0, s22, 1024
  s_nop 0
  buffer_load_dwordx4 v5, s[12:15], s21 offen lds
  s_add_u32 m0, s22, 2048
  s_nop 0
  buffer_load_dwordx4 v6, s[12:15], s21 offen lds
  s_mul_i32 s21, s20, 153600
  s_add_u32 s21, s21, 706560
  s_add_u32 s21, s21, s44
  s_mul_i32 s22, s20, 15360
  s_add_u32 s22, s22, 70656
  s_add_u32 m0, s22, 0
  s_nop 0
  buffer_load_dwordx4 v4, s[12:15], s21 offen lds
  s_add_u32 m0, s22, 1024
  s_nop 0
  buffer_load_dwordx4 v5, s[12:15], s21 offen lds
  s_add_u32 m0, s22, 2048
  s_nop 0
  buffer_load_dwordx4 v6, s[12:15], s21 offen lds
  s_mul_i32 s21, s20, 153600
  s_add_u32 s21, s21, 737280
  s_add_u32 s21, s21, s44
  s_mul_i32 s22, s20, 15360
  s_add_u32 s22, s22, 73728
  s_add_u32 m0, s22, 0
  s_nop 0
  buffer_load_dwordx4 v4, s[12:15], s21 offen lds
  s_add_u32 m0, s22, 1024
  s_nop 0
  buffer_load_dwordx4 v5, s[12:15], s21 offen lds
  s_add_u32 m0, s22, 2048
  s_nop 0
  buffer_load_dwordx4 v6, s[12:15], s21 offen lds
  s_mul_i32 s21, s20, 153600
  s_add_u32 s21, s21, 1228800
  s_add_u32 s21, s21, s44
  buffer_load_dwordx4 v[64:67], v4, s[12:15], s21 offen
  buffer_load_dwordx4 v[68:71], v5, s[12:15], s21 offen
  buffer_load_dwordx4 v[72:75], v6, s[12:15], s21 offen
  s_mul_i32 s21, s20, 153600
  s_add_u32 s21, s21, 1259520
  s_add_u32 s21, s21, s44
  buffer_load_dwordx4 v[76:79], v4, s[12:15], s21 offen
  buffer_load_dwordx4 v[80:83], v5, s[12:15], s21 offen
  buffer_load_dwordx4 v[84:87], v6, s[12:15], s21 offen
  s_mul_i32 s21, s20, 153600
  s_add_u32 s21, s21, 1290240
  s_add_u32 s21, s21, s44
  buffer_load_dwordx4 v[88:91], v4, s[12:15], s21 offen
  buffer_load_dwordx4 v[92:95], v5, s[12:15], s21 offen
  buffer_load_dwordx4 v[96:99], v6, s[12:15], s21 offen
  s_mul_i32 s21, s20, 153600
  s_add_u32 s21, s21, 1320960
  s_add_u32 s21, s21, s44
  buffer_load_dwordx4 v[100:103], v4, s[12:15], s21 offen
  buffer_load_dwordx4 v[104:107], v5, s[12:15], s21 offen
  buffer_load_dwordx4 v[108:111], v6, s[12:15], s21 offen
  s_mul_i32 s21, s20, 153600
  s_add_u32 s21, s21, 1351680
  s_add_u32 s21, s21, s44
  buffer_load_dwordx4 v[112:115], v4, s[12:15], s21 offen
  buffer_load_dwordx4 v[116:119], v5, s[12:15], s21 offen
  buffer_load_dwordx4 v[120:123], v6, s[12:15], s21 offen
  s_mul_i32 s21, s20, 153600
  s_add_u32 s21, s21, 1843200
  s_add_u32 s21, s21, s44
  buffer_load_dwordx4 v[124:127], v4, s[12:15], s21 offen
  buffer_load_dwordx4 v[128:131], v5, s[12:15], s21 offen
  buffer_load_dwordx4 v[132:135], v6, s[12:15], s21 offen
  s_mul_i32 s21, s20, 153600
  s_add_u32 s21, s21, 1873920
  s_add_u32 s21, s21, s44
  buffer_load_dwordx4 v[136:139], v4, s[12:15], s21 offen
  buffer_load_dwordx4 v[140:143], v5, s[12:15], s21 offen
  buffer_load_dwordx4 v[144:147], v6, s[12:15], s21 offen
  s_mul_i32 s21, s20, 153600
  s_add_u32 s21, s21, 1904640
  s_add_u32 s21, s21, s44
  buffer_load_dwordx4 v[148:151], v4, s[12:15], s21 offen
  buffer_load_dwordx4 v[152:155], v5, s[12:15], s21 offen
  buffer_load_dwordx4 v[156:159], v6, s[12:15], s21 offen
  s_mul_i32 s21, s20, 153600
  s_add_u32 s21, s21, 1935360
  s_add_u32 s21, s21, s44
  buffer_load_dwordx4 v[160:163], v4, s[12:15], s21 offen
  buffer_load_dwordx4 v[164:167], v5, s[12:15], s21 offen
  buffer_load_dwordx4 v[168:171], v6, s[12:15], s21 offen
  s_mul_i32 s21, s20, 153600
  s_add_u32 s21, s21, 1966080
  s_add_u32 s21, s21, s44
  buffer_load_dwordx4 v[172:175], v4, s[12:15], s21 offen
  buffer_load_dwordx4 v[176:179], v5, s[12:15], s21 offen
  buffer_load_dwordx4 v[180:183], v6, s[12:15], s21 offen
  s_mul_i32 s22, s20, 15360
  v_lshl_add_u32 v30, v1, 4, s22
  v_add_u32 v31, 61440, v30
  s_waitcnt vmcnt(45)
  s_barrier
  ds_read_b64_tr_b16 a[0:1], v7 offset:0
  ds_read_b64_tr_b16 a[2:3], v7 offset:1536
  ds_read_b64_tr_b16 a[4:5], v7 offset:32
  ds_read_b64_tr_b16 a[6:7], v7 offset:1568
  ds_read_b64_tr_b16 a[8:9], v7 offset:64
  ds_read_b64_tr_b16 a[10:11], v7 offset:1600
  ds_read_b64_tr_b16 a[12:13], v7 offset:12288
  ds_read_b64_tr_b16 a[14:15], v7 offset:13824
  ds_read_b64_tr_b16 a[16:17], v7 offset:12320
  ds_read_b64_tr_b16 a[18:19], v7 offset:13856
  ds_read_b64_tr_b16 a[20:21], v7 offset:12352
  ds_read_b64_tr_b16 a[22:23], v7 offset:13888
  ds_read_b64_tr_b16 a[24:25], v7 offset:24576
  ds_read_b64_tr_b16 a[26:27], v7 offset:26112
  ds_read_b64_tr_b16 a[28:29], v7 offset:24608
  ds_read_b64_tr_b16 a[30:31], v7 offset:26144
  ds_read_b64_tr_b16 a[32:33], v7 offset:24640
  ds_read_b64_tr_b16 a[34:35], v7 offset:26176
  ds_read_b64_tr_b16 a[36:37], v7 offset:36864
  ds_read_b64_tr_b16 a[38:39], v7 offset:38400
  ds_read_b64_tr_b16 a[40:41], v7 offset:36896
  ds_read_b64_tr_b16 a[42:43], v7 offset:38432
  ds_read_b64_tr_b16 a[44:45], v7 offset:36928
  ds_read_b64_tr_b16 a[46:47], v7 offset:38464
  ds_read_b64_tr_b16 a[48:49], v7 offset:49152
  ds_read_b64_tr_b16 a[50:51], v7 offset:50688
  ds_read_b64_tr_b16 a[52:53], v7 offset:49184
  ds_read_b64_tr_b16 a[54:55], v7 offset:50720
  ds_read_b64_tr_b16 a[56:57], v7 offset:49216
  ds_read_b64_tr_b16 a[58:59], v7 offset:50752
  s_waitcnt lgkmcnt(0)
  s_barrier
  s_waitcnt vmcnt(30)
  s_barrier
  ds_read_b64_tr_b16 a[60:61], v8 offset:0
  ds_read_b64_tr_b16 a[62:63], v8 offset:1536
  ds_read_b64_tr_b16 a[64:65], v8 offset:32
  ds_read_b64_tr_b16 a[66:67], v8 offset:1568
  ds_read_b64_tr_b16 a[68:69], v8 offset:64
  ds_read_b64_tr_b16 a[70:71], v8 offset:1600
  ds_read_b64_tr_b16 a[72:73], v8 offset:12288
  ds_read_b64_tr_b16 a[74:75], v8 offset:13824
  ds_read_b64_tr_b16 a[76:77], v8 offset:12320
  ds_read_b64_tr_b16 a[78:79], v8 offset:13856
  ds_read_b64_tr_b16 a[80:81], v8 offset:12352
  ds_read_b64_tr_b16 a[82:83], v8 offset:13888
  ds_read_b64_tr_b16 a[84:85], v8 offset:24576
  ds_read_b64_tr_b16 a[86:87], v8 offset:26112
  ds_read_b64_tr_b16 a[88:89], v8 offset:24608
  ds_read_b64_tr_b16 a[90:91], v8 offset:26144
  ds_read_b64_tr_b16 a[92:93], v8 offset:24640
  ds_read_b64_tr_b16 a[94:95], v8 offset:26176
  ds_read_b64_tr_b16 a[96:97], v8 offset:36864
  ds_read_b64_tr_b16 a[98:99], v8 offset:38400
  ds_read_b64_tr_b16 a[100:101], v8 offset:36896
  ds_read_b64_tr_b16 a[102:103], v8 offset:38432
  ds_read_b64_tr_b16 a[104:105], v8 offset:36928
  ds_read_b64_tr_b16 a[106:107], v8 offset:38464
  ds_read_b64_tr_b16 a[108:109], v8 offset:49152
  ds_read_b64_tr_b16 a[110:111], v8 offset:50688
  ds_read_b64_tr_b16 a[112:113], v8 offset:49184
  ds_read_b64_tr_b16 a[114:115], v8 offset:50720
  ds_read_b64_tr_b16 a[116:117], v8 offset:49216
  ds_read_b64_tr_b16 a[118:119], v8 offset:50752
  s_waitcnt lgkmcnt(0)
  s_barrier
  s_waitcnt vmcnt(15)
  ds_write_b128 v30, v[64:67] offset:0
  ds_write_b128 v30, v[68:71] offset:1024
  ds_write_b128 v30, v[72:75] offset:2048
  ds_write_b128 v30, v[76:79] offset:3072
  ds_write_b128 v30, v[80:83] offset:4096
  ds_write_b128 v30, v[84:87] offset:5120
  ds_write_b128 v30, v[88:91] offset:6144
  ds_write_b128 v30, v[92:95] offset:7168
  ds_write_b128 v30, v[96:99] offset:8192
  ds_write_b128 v30, v[100:103] offset:9216
  ds_write_b128 v30, v[104:107] offset:10240
  ds_write_b128 v30, v[108:111] offset:11264
  ds_write_b128 v30, v[112:115] offset:12288
  ds_write_b128 v30, v[116:119] offset:13312
  ds_write_b128 v30, v[120:123] offset:14336
  s_waitcnt lgkmcnt(0)
  s_barrier
  ds_read_b64_tr_b16 a[120:121], v7 offset:0
  ds_read_b64_tr_b16 a[122:123], v7 offset:1536
  ds_read_b64_tr_b16 a[124:125], v7 offset:32
  ds_read_b64_tr_b16 a[126:127], v7 offset:1568
  ds_read_b64_tr_b16 a[128:129], v7 offset:64
  ds_read_b64_tr_b16 a[130:131], v7 offset:1600
  ds_read_b64_tr_b16 a[132:133], v7 offset:12288
  ds_read_b64_tr_b16 a[134:135], v7 offset:13824
  ds_read_b64_tr_b16 a[136:137], v7 offset:12320
  ds_read_b64_tr_b16 a[138:139], v7 offset:13856
  ds_read_b64_tr_b16 a[140:141], v7 offset:12352
  ds_read_b64_tr_b16 a[142:143], v7 offset:13888
  ds_read_b64_tr_b16 a[144:145], v7 offset:24576
  ds_read_b64_tr_b16 a[146:147], v7 offset:26112
  ds_read_b64_tr_b16 a[148:149], v7 offset:24608
  ds_read_b64_tr_b16 a[150:151], v7 offset:26144
  ds_read_b64_tr_b16 a[152:153], v7 offset:24640
  ds_read_b64_tr_b16 a[154:155], v7 offset:26176
  ds_read_b64_tr_b16 a[156:157], v7 offset:36864
  ds_read_b64_tr_b16 a[158:159], v7 offset:38400
  ds_read_b64_tr_b16 a[160:161], v7 offset:36896
  ds_read_b64_tr_b16 a[162:163], v7 offset:38432
  ds_read_b64_tr_b16 a[164:165], v7 offset:36928
  ds_read_b64_tr_b16 a[166:167], v7 offset:38464
  ds_read_b64_tr_b16 a[168:169], v7 offset:49152
  ds_read_b64_tr_b16 a[170:171], v7 offset:50688
  ds_read_b64_tr_b16 a[172:173], v7 offset:49184
  ds_read_b64_tr_b16 a[174:175], v7 offset:50720
  ds_read_b64_tr_b16 a[176:177], v7 offset:49216
  ds_read_b64_tr_b16 a[178:179], v7 offset:50752
  s_waitcnt lgkmcnt(0)
  s_barrier
  s_waitcnt vmcnt(0)
  ds_write_b128 v31, v[124:127] offset:0
  ds_write_b128 v31, v[128:131] offset:1024
  ds_write_b128 v31, v[132:135] offset:2048
  ds_write_b128 v31, v[136:139] offset:3072
  ds_write_b128 v31, v[140:143] offset:4096
  ds_write_b128 v31, v[144:147] offset:5120
  ds_write_b128 v31, v[148:151] offset:6144
  ds_write_b128 v31, v[152:155] offset:7168
  ds_write_b128 v31, v[156:159] offset:8192
  ds_write_b128 v31, v[160:163] offset:9216
  ds_write_b128 v31, v[164:167] offset:10240
  ds_write_b128 v31, v[168:171] offset:11264
  ds_write_b128 v31, v[172:175] offset:12288
  ds_write_b128 v31, v[176:179] offset:13312
  ds_write_b128 v31, v[180:183] offset:14336
  s_waitcnt lgkmcnt(0)
  s_barrier
  ds_read_b64_tr_b16 a[180:181], v8 offset:0
  ds_read_b64_tr_b16 a[182:183], v8 offset:1536
  ds_read_b64_tr_b16 a[184:185], v8 offset:32
  ds_read_b64_tr_b16 a[186:187], v8 offset:1568
  ds_read_b64_tr_b16 a[188:189], v8 offset:64
  ds_read_b64_tr_b16 a[190:191], v8 offset:1600
  ds_read_b64_tr_b16 a[192:193], v8 offset:12288
  ds_read_b64_tr_b16 a[194:195], v8 offset:13824
  ds_read_b64_tr_b16 a[196:197], v8 offset:12320
  ds_read_b64_tr_b16 a[198:199], v8 offset:13856
  ds_read_b64_tr_b16 a[200:201], v8 offset:12352
  ds_read_b64_tr_b16 a[202:203], v8 offset:13888
  ds_read_b64_tr_b16 a[204:205], v8 offset:24576
  ds_read_b64_tr_b16 a[206:207], v8 offset:26112
  ds_read_b64_tr_b16 a[208:209], v8 offset:24608
  ds_read_b64_tr_b16 a[210:211], v8 offset:26144
  ds_read_b64_tr_b16 a[212:213], v8 offset:24640
  ds_read_b64_tr_b16 a[214:215], v8 offset:26176
  ds_read_b64_tr_b16 a[216:217], v8 offset:36864
  ds_read_b64_tr_b16 a[218:219], v8 offset:38400
  ds_read_b64_tr_b16 a[220:221], v8 offset:36896
  ds_read_b64_tr_b16 a[222:223], v8 offset:38432
  ds_read_b64_tr_b16 a[224:225], v8 offset:36928
  ds_read_b64_tr_b16 a[226:227], v8 offset:38464
  ds_read_b64_tr_b16 a[228:229], v8 offset:49152
  ds_read_b64_tr_b16 a[230:231], v8 offset:50688
  ds_read_b64_tr_b16 a[232:233], v8 offset:49184
  ds_read_b64_tr_b16 a[234:235], v8 offset:50720
  ds_read_b64_tr_b16 a[236:237], v8 offset:49216
  ds_read_b64_tr_b16 a[238:239], v8 offset:50752
  s_waitcnt lgkmcnt(0)
  s_barrier
  s_mul_i32 s24, s42, 163840
  s_mul_i32 s25, s63, 163840
  s_mul_i32 s27, s42, 491520
  s_add_u32 s27, s27, s44
  s_mul_i32 s28, s63, 491520
  s_lshl_b32 s63, s63, 7
  s_load_dwordx2 s[72:73], s[0:1], 104
  s_waitcnt lgkmcnt(0)
  s_add_u32 s72, s72, 81068032
  s_addc_u32 s73, s73, 0
  s_mov_b32 s74, 115712
  s_mov_b32 s75, 0x00020000
  s_lshl_b32 s60, s42, 7
  s_add_u32 s60, s60, 88064
  s_mov_b32 s61, 0
  v_lshrrev_b32 v11, 3, v1
  v_and_b32 v12, 7, v1
  v_xor_b32 v12, v12, v11
  v_mul_u32_u24 v11, 1280, v11
  v_lshl_add_u32 v10, v12, 4, v11
  s_mul_i32 s46, s20, 40960
  v_add_u32 v10, s46, v10
  s_lshl_b32 s47, s20, 12
  s_add_u32 s47, s47, 0
  s_add_u32 s46, s47, 98304
  s_mov_b32 s30, s24
  s_add_u32 s32, s47, 0
  v_add_u32 v11, 9216, v10
  v_add_u32 v12, 18432, v10
  v_add_u32 v13, 27648, v10
  s_mov_b32 m0, s32
  s_nop 0
  buffer_load_dwordx4 v10, s[8:11], s30 offen offset:0 lds
  buffer_load_dwordx4 v11, s[8:11], s30 offen offset:1024 lds
  buffer_load_dwordx4 v12, s[8:11], s30 offen offset:2048 lds
  buffer_load_dwordx4 v13, s[8:11], s30 offen offset:3072 lds
  s_add_u32 s30, s30, 128
  s_add_u32 s32, s32, 16384
  s_cmp_lt_u32 s32, s46
  s_cselect_b32 s32, s32, s47
  s_mov_b32 m0, s32
  s_nop 0
  buffer_load_dwordx4 v10, s[8:11], s30 offen offset:0 lds
  buffer_load_dwordx4 v11, s[8:11], s30 offen offset:1024 lds
  buffer_load_dwordx4 v12, s[8:11], s30 offen offset:2048 lds
  buffer_load_dwordx4 v13, s[8:11], s30 offen offset:3072 lds
  s_add_u32 s30, s30, 128
  s_add_u32 s32, s32, 16384
  s_cmp_lt_u32 s32, s46
  s_cselect_b32 s32, s32, s47
  s_mov_b32 m0, s32
  s_nop 0
  buffer_load_dwordx4 v10, s[8:11], s30 offen offset:0 lds
  buffer_load_dwordx4 v11, s[8:11], s30 offen offset:1024 lds
  buffer_load_dwordx4 v12, s[8:11], s30 offen offset:2048 lds
  buffer_load_dwordx4 v13, s[8:11], s30 offen offset:3072 lds
  s_add_u32 s30, s30, 128
  s_add_u32 s32, s32, 16384
  s_cmp_lt_u32 s32, s46
  s_cselect_b32 s32, s32, s47
  s_mov_b32 m0, s32
  s_nop 0
  buffer_load_dwordx4 v10, s[8:11], s30 offen offset:0 lds
  buffer_load_dwordx4 v11, s[8:11], s30 offen offset:1024 lds
  buffer_load_dwordx4 v12, s[8:11], s30 offen offset:2048 lds
  buffer_load_dwordx4 v13, s[8:11], s30 offen offset:3072 lds
  s_add_u32 s30, s30, 128
  s_add_u32 s32, s32, 16384
  s_cmp_lt_u32 s32, s46
  s_cselect_b32 s32, s32, s47
  v_and_b32 v6, 7, v2
  v_add_u32 v4, 0, v3
  v_xor_b32 v4, v4, v6
  v_lshlrev_b32 v4, 4, v4
  v_lshl_add_u32 v14, v2, 7, v4
  v_add_u32 v4, 4, v3
  v_xor_b32 v4, v4, v6
  v_lshlrev_b32 v4, 4, v4
  v_lshl_add_u32 v15, v2, 7, v4
  v_mul_u32_u24 v22, 400, v2
  v_mul_u32_u24 v4, 8, v3
  s_mul_i32 s21, s20, 96
  s_add_u32 s21, s21, 98304
  v_add3_u32 v22, v22, v4, s21
  v_mov_b32 v9, 2731
  v_add_u32 v8, 0, v1
  v_mul_u32_u24 v7, v8, v9
  v_lshrrev_b32 v7, 16, v7
  v_mul_u32_u24 v4, 24, v7
  v_sub_u32 v8, v8, v4
  v_lshlrev_b32 v8, 4, v8
  s_mov_b32 s21, 3840
  v_mul_lo_u32 v4, v7, s21
  v_add_u32 v26, v4, v8
  v_mul_u32_u24 v4, 400, v7
  s_mul_i32 s21, s20, 12800
  s_add_u32 s21, s21, 98304
  v_add3_u32 v23, v4, v8, s21
  v_add_u32 v8, 64, v1
  v_mul_u32_u24 v7, v8, v9
  v_lshrrev_b32 v7, 16, v7
  v_mul_u32_u24 v4, 24, v7
  v_sub_u32 v8, v8, v4
  v_lshlrev_b32 v8, 4, v8
  s_mov_b32 s21, 3840
  v_mul_lo_u32 v4, v7, s21
  v_add_u32 v27, v4, v8
  v_mul_u32_u24 v4, 400, v7
  s_mul_i32 s21, s20, 12800
  s_add_u32 s21, s21, 98304
  v_add3_u32 v24, v4, v8, s21
  v_add_u32 v8, 128, v1
  v_mul_u32_u24 v7, v8, v9
  v_lshrrev_b32 v7, 16, v7
  v_mul_u32_u24 v4, 24, v7
  v_sub_u32 v8, v8, v4
  v_lshlrev_b32 v8, 4, v8
  s_mov_b32 s21, 3840
  v_mul_lo_u32 v4, v7, s21
  v_add_u32 v28, v4, v8
  v_mul_u32_u24 v4, 400, v7
  s_mul_i32 s21, s20, 12800
  s_add_u32 s21, s21, 98304
  v_add3_u32 v25, v4, v8, s21
  s_mov_b32 s33, 0
  s_mov_b32 s48, 0x80000000
  s_mov_b32 m0, s32
  s_nop 0
  buffer_load_dwordx4 v10, s[8:11], s30 offen offset:0 lds
  buffer_load_dwordx4 v11, s[8:11], s30 offen offset:1024 lds
  s_waitcnt vmcnt(14)
  s_barrier
  v_add_u32 v18, s33, v14
  v_add_u32 v19, s33, v15
  s_add_u32 s33, s33, 16384
  s_cmp_lt_u32 s33, 98304
  s_cselect_b32 s33, s33, 0
  ds_read_b128 v[160:163], v18 offset:0
  ds_read_b128 v[164:167], v18 offset:2048
  ds_read_b128 v[168:171], v18 offset:4096
  ds_read_b128 v[172:175], v18 offset:6144
  ds_read_b128 v[176:179], v18 offset:8192
  ds_read_b128 v[180:183], v18 offset:10240
  ds_read_b128 v[184:187], v18 offset:12288
  ds_read_b128 v[188:191], v18 offset:14336
  s_waitcnt lgkmcnt(0)
qb_blk_220:
  v_mfma_f32_16x16x32_bf16 v[64:67], a[0:3], v[160:163], 0
  ds_read_b128 v[192:195], v19 offset:0
  ds_write_b64 v22, v[240:241] offset:12864
  v_mfma_f32_16x16x32_bf16 v[68:71], a[4:7], v[160:163], 0
  v_add_u32 v18, s33, v14
  v_cvt_pk_bf16_f32 v242, v100, v101
  v_mfma_f32_16x16x32_bf16 v[72:75], a[8:11], v[160:163], 0
  v_cvt_pk_bf16_f32 v243, v102, v103
  v_cvt_pk_bf16_f32 v244, v104, v105
  v_mfma_f32_16x16x32_bf16 v[76:79], a[0:3], v[164:167], 0
  ds_read_b128 v[196:199], v19 offset:2048
  v_cvt_pk_bf16_f32 v245, v106, v107
  v_mfma_f32_16x16x32_bf16 v[80:83], a[4:7], v[164:167], 0
  buffer_load_dwordx4 v12, s[8:11], s30 offen offset:2048 lds
  v_mfma_f32_16x16x32_bf16 v[84:87], a[8:11], v[164:167], 0
  v_cvt_pk_bf16_f32 v246, v108, v109
  v_cvt_pk_bf16_f32 v247, v110, v111
  v_mfma_f32_16x16x32_bf16 v[88:91], a[0:3], v[168:171], 0
  ds_read_b128 v[200:203], v19 offset:4096
  ds_write_b64 v22, v[242:243] offset:19200
  v_mfma_f32_16x16x32_bf16 v[92:95], a[4:7], v[168:171], 0
  ds_write_b64 v22, v[244:245] offset:19232
  ds_write_b64 v22, v[246:247] offset:19264
  v_mfma_f32_16x16x32_bf16 v[96:99], a[8:11], v[168:171], 0
  v_cvt_pk_bf16_f32 v224, v112, v113
  v_cvt_pk_bf16_f32 v225, v114, v115
  v_mfma_f32_16x16x32_bf16 v[100:103], a[0:3], v[172:175], 0
  ds_read_b128 v[204:207], v19 offset:6144
  v_cvt_pk_bf16_f32 v226, v116, v117
  v_mfma_f32_16x16x32_bf16 v[104:107], a[4:7], v[172:175], 0
  v_cvt_pk_bf16_f32 v227, v118, v119
  v_cvt_pk_bf16_f32 v228, v120, v121
  v_mfma_f32_16x16x32_bf16 v[108:111], a[8:11], v[172:175], 0
  s_waitcnt lgkmcnt(10)
  v_cvt_pk_bf16_f32 v229, v122, v123
  v_mfma_f32_16x16x32_bf16 v[112:115], a[0:3], v[176:179], 0
  ds_read_b128 v[208:211], v19 offset:8192
  ds_write_b64 v22, v[224:225] offset:25600
  v_mfma_f32_16x16x32_bf16 v[116:119], a[4:7], v[176:179], 0
  ds_write_b64 v22, v[226:227] offset:25632
  ds_write_b64 v22, v[228:229] offset:25664
  v_mfma_f32_16x16x32_bf16 v[120:123], a[8:11], v[176:179], 0
  v_cvt_pk_bf16_f32 v230, v124, v125
  v_cvt_pk_bf16_f32 v231, v126, v127
  v_mfma_f32_16x16x32_bf16 v[124:127], a[0:3], v[180:183], 0
  ds_read_b128 v[212:215], v19 offset:10240
  v_cvt_pk_bf16_f32 v232, v128, v129
  v_cvt_pk_bf16_f32 v233, v130, v131
  v_mfma_f32_16x16x32_bf16 v[128:131], a[4:7], v[180:183], 0
  buffer_load_dwordx4 v13, s[8:11], s30 offen offset:3072 lds
  v_cvt_pk_bf16_f32 v234, v132, v133
  v_cvt_pk_bf16_f32 v235, v134, v135
  v_mfma_f32_16x16x32_bf16 v[132:135], a[8:11], v[180:183], 0
  s_add_u32 s30, s30, 128
  s_add_u32 m0, m0, 16384
  ds_write_b64 v22, v[230:231] offset:32000
  ds_write_b64 v22, v[232:233] offset:32032
  ds_write_b64 v22, v[234:235] offset:32064
  v_cvt_pk_bf16_f32 v236, v136, v137
  v_cvt_pk_bf16_f32 v237, v138, v139
  v_mfma_f32_16x16x32_bf16 v[136:139], a[0:3], v[184:187], 0
  ds_read_b128 v[216:219], v19 offset:12288
  v_cvt_pk_bf16_f32 v238, v140, v141
  v_cvt_pk_bf16_f32 v239, v142, v143
  v_mfma_f32_16x16x32_bf16 v[140:143], a[4:7], v[184:187], 0
  s_cmp_lt_u32 m0, s46
  s_cselect_b32 m0, m0, s47
  v_cvt_pk_bf16_f32 v240, v144, v145
  v_cvt_pk_bf16_f32 v241, v146, v147
  v_mfma_f32_16x16x32_bf16 v[144:147], a[8:11], v[184:187], 0
  ds_write_b64 v22, v[236:237] offset:38400
  ds_write_b64 v22, v[238:239] offset:38432
  ds_write_b64 v22, v[240:241] offset:38464
  v_cvt_pk_bf16_f32 v242, v148, v149
  v_cvt_pk_bf16_f32 v243, v150, v151
  v_mfma_f32_16x16x32_bf16 v[148:151], a[0:3], v[188:191], 0
  ds_read_b128 v[220:223], v19 offset:14336
  v_cvt_pk_bf16_f32 v244, v152, v153
  v_cvt_pk_bf16_f32 v245, v154, v155
  v_mfma_f32_16x16x32_bf16 v[152:155], a[4:7], v[188:191], 0
  v_cvt_pk_bf16_f32 v246, v156, v157
  v_cvt_pk_bf16_f32 v247, v158, v159
  v_mfma_f32_16x16x32_bf16 v[156:159], a[8:11], v[188:191], 0
  s_waitcnt vmcnt(12) lgkmcnt(13)
  s_barrier
  v_mfma_f32_16x16x32_bf16 v[64:67], a[12:15], v[192:195], v[64:67]
  ds_read_b128 v[160:163], v18 offset:0
  ds_write_b64 v22, v[242:243] offset:44800
  v_mfma_f32_16x16x32_bf16 v[68:71], a[16:19], v[192:195], v[68:71]
  ds_write_b64 v22, v[244:245] offset:44832
  ds_write_b64 v22, v[246:247] offset:44864
  v_mfma_f32_16x16x32_bf16 v[72:75], a[20:23], v[192:195], v[72:75]
  v_add_u32 v19, s33, v15
  s_add_u32 s33, s33, 16384
  v_mfma_f32_16x16x32_bf16 v[76:79], a[12:15], v[196:199], v[76:79]
  ds_read_b128 v[164:167], v18 offset:2048
  v_mfma_f32_16x16x32_bf16 v[80:83], a[16:19], v[196:199], v[80:83]
  buffer_load_dwordx4 v10, s[8:11], s30 offen offset:0 lds
  v_mfma_f32_16x16x32_bf16 v[84:87], a[20:23], v[196:199], v[84:87]
  s_cmp_lt_u32 s33, 98304
  s_cselect_b32 s33, s33, 0
  v_mfma_f32_16x16x32_bf16 v[88:91], a[12:15], v[200:203], v[88:91]
  ds_read_b128 v[168:171], v18 offset:4096
  v_mfma_f32_16x16x32_bf16 v[92:95], a[16:19], v[200:203], v[92:95]
  v_mfma_f32_16x16x32_bf16 v[96:99], a[20:23], v[200:203], v[96:99]
  v_mfma_f32_16x16x32_bf16 v[100:103], a[12:15], v[204:207], v[100:103]
  ds_read_b128 v[172:175], v18 offset:6144
  v_mfma_f32_16x16x32_bf16 v[104:107], a[16:19], v[204:207], v[104:107]
  v_mfma_f32_16x16x32_bf16 v[108:111], a[20:23], v[204:207], v[108:111]
  s_waitcnt lgkmcnt(7)
  v_mfma_f32_16x16x32_bf16 v[112:115], a[12:15], v[208:211], v[112:115]
  ds_read_b128 v[176:179], v18 offset:8192
  v_mfma_f32_16x16x32_bf16 v[116:119], a[16:19], v[208:211], v[116:119]
  v_mfma_f32_16x16x32_bf16 v[120:123], a[20:23], v[208:211], v[120:123]
  v_mfma_f32_16x16x32_bf16 v[124:127], a[12:15], v[212:215], v[124:127]
  ds_read_b128 v[180:183], v18 offset:10240
  v_mfma_f32_16x16x32_bf16 v[128:131], a[16:19], v[212:215], v[128:131]
  buffer_load_dwordx4 v11, s[8:11], s30 offen offset:1024 lds
  v_mfma_f32_16x16x32_bf16 v[132:135], a[20:23], v[212:215], v[132:135]
  v_mfma_f32_16x16x32_bf16 v[136:139], a[12:15], v[216:219], v[136:139]
  ds_read_b128 v[184:187], v18 offset:12288
  v_mfma_f32_16x16x32_bf16 v[140:143], a[16:19], v[216:219], v[140:143]
  v_mfma_f32_16x16x32_bf16 v[144:147], a[20:23], v[216:219], v[144:147]
  v_mfma_f32_16x16x32_bf16 v[148:151], a[12:15], v[220:223], v[148:151]
  ds_read_b128 v[188:191], v18 offset:14336
  v_mfma_f32_16x16x32_bf16 v[152:155], a[16:19], v[220:223], v[152:155]
  v_mfma_f32_16x16x32_bf16 v[156:159], a[20:23], v[220:223], v[156:159]
  s_waitcnt lgkmcnt(4)
  v_mfma_f32_16x16x32_bf16 v[64:67], a[24:27], v[160:163], v[64:67]
  ds_read_b128 v[192:195], v19 offset:0
  v_mfma_f32_16x16x32_bf16 v[68:71], a[28:31], v[160:163], v[68:71]
  v_add_u32 v18, s33, v14
  v_mfma_f32_16x16x32_bf16 v[72:75], a[32:35], v[160:163], v[72:75]
  v_mfma_f32_16x16x32_bf16 v[76:79], a[24:27], v[164:167], v[76:79]
  ds_read_b128 v[196:199], v19 offset:2048
  v_mfma_f32_16x16x32_bf16 v[80:83], a[28:31], v[164:167], v[80:83]
  buffer_load_dwordx4 v12, s[8:11], s30 offen offset:2048 lds
  v_mfma_f32_16x16x32_bf16 v[84:87], a[32:35], v[164:167], v[84:87]
  v_mfma_f32_16x16x32_bf16 v[88:91], a[24:27], v[168:171], v[88:91]
  ds_read_b128 v[200:203], v19 offset:4096
  v_mfma_f32_16x16x32_bf16 v[92:95], a[28:31], v[168:171], v[92:95]
  v_mfma_f32_16x16x32_bf16 v[96:99], a[32:35], v[168:171], v[96:99]
  v_mfma_f32_16x16x32_bf16 v[100:103], a[24:27], v[172:175], v[100:103]
  ds_read_b128 v[204:207], v19 offset:6144
  v_mfma_f32_16x16x32_bf16 v[104:107], a[28:31], v[172:175], v[104:107]
  v_mfma_f32_16x16x32_bf16 v[108:111], a[32:35], v[172:175], v[108:111]
  s_waitcnt lgkmcnt(4)
  v_mfma_f32_16x16x32_bf16 v[112:115], a[24:27], v[176:179], v[112:115]
  ds_read_b128 v[208:211], v19 offset:8192
  v_mfma_f32_16x16x32_bf16 v[116:119], a[28:31], v[176:179], v[116:119]
  v_mfma_f32_16x16x32_bf16 v[120:123], a[32:35], v[176:179], v[120:123]
  v_mfma_f32_16x16x32_bf16 v[124:127], a[24:27], v[180:183], v[124:127]
  ds_read_b128 v[212:215], v19 offset:10240
  v_mfma_f32_16x16x32_bf16 v[128:131], a[28:31], v[180:183], v[128:131]
  buffer_load_dwordx4 v13, s[8:11], s30 offen offset:3072 lds
  v_mfma_f32_16x16x32_bf16 v[132:135], a[32:35], v[180:183], v[132:135]
  s_add_u32 s30, s30, 128
  s_add_u32 m0, m0, 16384
  v_mfma_f32_16x16x32_bf16 v[136:139], a[24:27], v[184:187], v[136:139]
  ds_read_b128 v[216:219], v19 offset:12288
  v_mfma_f32_16x16x32_bf16 v[140:143], a[28:31], v[184:187], v[140:143]
  s_cmp_lt_u32 m0, s46
  s_cselect_b32 m0, m0, s47
  v_mfma_f32_16x16x32_bf16 v[144:147], a[32:35], v[184:187], v[144:147]
  v_mfma_f32_16x16x32_bf16 v[148:151], a[24:27], v[188:191], v[148:151]
  ds_read_b128 v[220:223], v19 offset:14336
  v_mfma_f32_16x16x32_bf16 v[152:155], a[28:31], v[188:191], v[152:155]
  v_mfma_f32_16x16x32_bf16 v[156:159], a[32:35], v[188:191], v[156:159]
  s_waitcnt vmcnt(12) lgkmcnt(4)
  s_barrier
  v_mfma_f32_16x16x32_bf16 v[64:67], a[36:39], v[192:195], v[64:67]
  ds_read_b128 v[160:163], v18 offset:0
  v_mfma_f32_16x16x32_bf16 v[68:71], a[40:43], v[192:195], v[68:71]
  v_mfma_f32_16x16x32_bf16 v[72:75], a[44:47], v[192:195], v[72:75]
  v_add_u32 v19, s33, v15
  s_add_u32 s33, s33, 16384
  v_mfma_f32_16x16x32_bf16 v[76:79], a[36:39], v[196:199], v[76:79]
  ds_read_b128 v[164:167], v18 offset:2048
  v_mfma_f32_16x16x32_bf16 v[80:83], a[40:43], v[196:199], v[80:83]
  buffer_load_dwordx4 v10, s[8:11], s30 offen offset:0 lds
  v_mfma_f32_16x16x32_bf16 v[84:87], a[44:47], v[196:199], v[84:87]
  s_cmp_lt_u32 s33, 98304
  s_cselect_b32 s33, s33, 0
  v_mfma_f32_16x16x32_bf16 v[88:91], a[36:39], v[200:203], v[88:91]
  ds_read_b128 v[168:171], v18 offset:4096
  v_mfma_f32_16x16x32_bf16 v[92:95], a[40:43], v[200:203], v[92:95]
  ds_read_b128 v[224:227], v23 offset:0
  v_mfma_f32_16x16x32_bf16 v[96:99], a[44:47], v[200:203], v[96:99]
  v_mfma_f32_16x16x32_bf16 v[100:103], a[36:39], v[204:207], v[100:103]
  ds_read_b128 v[172:175], v18 offset:6144
  v_mfma_f32_16x16x32_bf16 v[104:107], a[40:43], v[204:207], v[104:107]
  v_mfma_f32_16x16x32_bf16 v[108:111], a[44:47], v[204:207], v[108:111]
  s_waitcnt lgkmcnt(5)
  v_mfma_f32_16x16x32_bf16 v[112:115], a[36:39], v[208:211], v[112:115]
  ds_read_b128 v[176:179], v18 offset:8192
  v_mfma_f32_16x16x32_bf16 v[116:119], a[40:43], v[208:211], v[116:119]
  v_mfma_f32_16x16x32_bf16 v[120:123], a[44:47], v[208:211], v[120:123]
  v_mfma_f32_16x16x32_bf16 v[124:127], a[36:39], v[212:215], v[124:127]
  ds_read_b128 v[180:183], v18 offset:10240
  v_mfma_f32_16x16x32_bf16 v[128:131], a[40:43], v[212:215], v[128:131]
  buffer_load_dwordx4 v11, s[8:11], s30 offen offset:1024 lds
  v_mfma_f32_16x16x32_bf16 v[132:135], a[44:47], v[212:215], v[132:135]
  v_mfma_f32_16x16x32_bf16 v[136:139], a[36:39], v[216:219], v[136:139]
  ds_read_b128 v[184:187], v18 offset:12288
  v_mfma_f32_16x16x32_bf16 v[140:143], a[40:43], v[216:219], v[140:143]
  ds_read_b128 v[228:231], v24 offset:0
  v_mfma_f32_16x16x32_bf16 v[144:147], a[44:47], v[216:219], v[144:147]
  v_mfma_f32_16x16x32_bf16 v[148:151], a[36:39], v[220:223], v[148:151]
  ds_read_b128 v[188:191], v18 offset:14336
  v_mfma_f32_16x16x32_bf16 v[152:155], a[40:43], v[220:223], v[152:155]
  v_mfma_f32_16x16x32_bf16 v[156:159], a[44:47], v[220:223], v[156:159]
  s_waitcnt lgkmcnt(5)
  v_mfma_f32_16x16x32_bf16 v[64:67], a[48:51], v[160:163], v[64:67]
  ds_read_b128 v[192:195], v19 offset:0
  v_mfma_f32_16x16x32_bf16 v[68:71], a[52:55], v[160:163], v[68:71]
  v_add_u32 v18, s33, v14
  v_mfma_f32_16x16x32_bf16 v[72:75], a[56:59], v[160:163], v[72:75]
  v_mfma_f32_16x16x32_bf16 v[76:79], a[48:51], v[164:167], v[76:79]
  ds_read_b128 v[196:199], v19 offset:2048
  v_mfma_f32_16x16x32_bf16 v[80:83], a[52:55], v[164:167], v[80:83]
  buffer_load_dwordx4 v12, s[8:11], s30 offen offset:2048 lds
  v_mfma_f32_16x16x32_bf16 v[84:87], a[56:59], v[164:167], v[84:87]
  v_mfma_f32_16x16x32_bf16 v[88:91], a[48:51], v[168:171], v[88:91]
  ds_read_b128 v[200:203], v19 offset:4096
  v_mfma_f32_16x16x32_bf16 v[92:95], a[52:55], v[168:171], v[92:95]
  s_add_u32 s21, s48, 0
  ds_read_b128 v[232:235], v25 offset:0
  v_mfma_f32_16x16x32_bf16 v[96:99], a[56:59], v[168:171], v[96:99]
  v_mfma_f32_16x16x32_bf16 v[100:103], a[48:51], v[172:175], v[100:103]
  ds_read_b128 v[204:207], v19 offset:6144
  v_mfma_f32_16x16x32_bf16 v[104:107], a[52:55], v[172:175], v[104:107]
  buffer_store_dwordx4 v[224:227], v26, s[16:19], s21 offen sc1
  v_mfma_f32_16x16x32_bf16 v[108:111], a[56:59], v[172:175], v[108:111]
  s_waitcnt lgkmcnt(5)
  v_mfma_f32_16x16x32_bf16 v[112:115], a[48:51], v[176:179], v[112:115]
  ds_read_b128 v[208:211], v19 offset:8192
  v_mfma_f32_16x16x32_bf16 v[116:119], a[52:55], v[176:179], v[116:119]
  v_mfma_f32_16x16x32_bf16 v[120:123], a[56:59], v[176:179], v[120:123]
  v_mfma_f32_16x16x32_bf16 v[124:127], a[48:51], v[180:183], v[124:127]
  ds_read_b128 v[212:215], v19 offset:10240
  v_mfma_f32_16x16x32_bf16 v[128:131], a[52:55], v[180:183], v[128:131]
  buffer_load_dwordx4 v13, s[8:11], s30 offen offset:3072 lds
  v_mfma_f32_16x16x32_bf16 v[132:135], a[56:59], v[180:183], v[132:135]
  s_add_u32 s30, s30, 128
  s_add_u32 m0, m0, 16384
  v_mfma_f32_16x16x32_bf16 v[136:139], a[48:51], v[184:187], v[136:139]
  ds_read_b128 v[216:219], v19 offset:12288
  v_mfma_f32_16x16x32_bf16 v[140:143], a[52:55], v[184:187], v[140:143]
  s_cmp_lt_u32 m0, s46
  s_cselect_b32 m0, m0, s47
  v_mfma_f32_16x16x32_bf16 v[144:147], a[56:59], v[184:187], v[144:147]
  ds_read_b128 v[236:239], v23 offset:3200
  v_mfma_f32_16x16x32_bf16 v[148:151], a[48:51], v[188:191], v[148:151]
  ds_read_b128 v[220:223], v19 offset:14336
  v_mfma_f32_16x16x32_bf16 v[152:155], a[52:55], v[188:191], v[152:155]
  buffer_store_dwordx4 v[228:231], v27, s[16:19], s21 offen sc1
  v_mfma_f32_16x16x32_bf16 v[156:159], a[56:59], v[188:191], v[156:159]
  s_waitcnt vmcnt(14) lgkmcnt(5)
  s_barrier
  v_mfma_f32_16x16x32_bf16 v[64:67], a[60:63], v[192:195], v[64:67]
  ds_read_b128 v[160:163], v18 offset:0
  v_mfma_f32_16x16x32_bf16 v[68:71], a[64:67], v[192:195], v[68:71]
  v_mfma_f32_16x16x32_bf16 v[72:75], a[68:71], v[192:195], v[72:75]
  v_add_u32 v19, s33, v15
  s_add_u32 s33, s33, 16384
  v_mfma_f32_16x16x32_bf16 v[76:79], a[60:63], v[196:199], v[76:79]
  ds_read_b128 v[164:167], v18 offset:2048
  v_mfma_f32_16x16x32_bf16 v[80:83], a[64:67], v[196:199], v[80:83]
  buffer_load_dwordx4 v10, s[8:11], s30 offen offset:0 lds
  v_mfma_f32_16x16x32_bf16 v[84:87], a[68:71], v[196:199], v[84:87]
  s_cmp_lt_u32 s33, 98304
  s_cselect_b32 s33, s33, 0
  v_mfma_f32_16x16x32_bf16 v[88:91], a[60:63], v[200:203], v[88:91]
  ds_read_b128 v[168:171], v18 offset:4096
  v_mfma_f32_16x16x32_bf16 v[92:95], a[64:67], v[200:203], v[92:95]
  ds_read_b128 v[240:243], v24 offset:3200
  v_mfma_f32_16x16x32_bf16 v[96:99], a[68:71], v[200:203], v[96:99]
  v_mfma_f32_16x16x32_bf16 v[100:103], a[60:63], v[204:207], v[100:103]
  ds_read_b128 v[172:175], v18 offset:6144
  v_mfma_f32_16x16x32_bf16 v[104:107], a[64:67], v[204:207], v[104:107]
  buffer_store_dwordx4 v[232:235], v28, s[16:19], s21 offen sc1
  v_mfma_f32_16x16x32_bf16 v[108:111], a[68:71], v[204:207], v[108:111]
  s_waitcnt lgkmcnt(5)
  v_mfma_f32_16x16x32_bf16 v[112:115], a[60:63], v[208:211], v[112:115]
  ds_read_b128 v[176:179], v18 offset:8192
  v_mfma_f32_16x16x32_bf16 v[116:119], a[64:67], v[208:211], v[116:119]
  v_mfma_f32_16x16x32_bf16 v[120:123], a[68:71], v[208:211], v[120:123]
  v_mfma_f32_16x16x32_bf16 v[124:127], a[60:63], v[212:215], v[124:127]
  ds_read_b128 v[180:183], v18 offset:10240
  v_mfma_f32_16x16x32_bf16 v[128:131], a[64:67], v[212:215], v[128:131]
  buffer_load_dwordx4 v11, s[8:11], s30 offen offset:1024 lds
  v_mfma_f32_16x16x32_bf16 v[132:135], a[68:71], v[212:215], v[132:135]
  v_mfma_f32_16x16x32_bf16 v[136:139], a[60:63], v[216:219], v[136:139]
  ds_read_b128 v[184:187], v18 offset:12288
  v_mfma_f32_16x16x32_bf16 v[140:143], a[64:67], v[216:219], v[140:143]
  s_add_u32 s21, s48, 30720
  ds_read_b128 v[244:247], v25 offset:3200
  v_mfma_f32_16x16x32_bf16 v[144:147], a[68:71], v[216:219], v[144:147]
  v_mfma_f32_16x16x32_bf16 v[148:151], a[60:63], v[220:223], v[148:151]
  ds_read_b128 v[188:191], v18 offset:14336
  v_mfma_f32_16x16x32_bf16 v[152:155], a[64:67], v[220:223], v[152:155]
  buffer_store_dwordx4 v[236:239], v26, s[16:19], s21 offen sc1
  v_mfma_f32_16x16x32_bf16 v[156:159], a[68:71], v[220:223], v[156:159]
  s_waitcnt lgkmcnt(5)
  v_mfma_f32_16x16x32_bf16 v[64:67], a[72:75], v[160:163], v[64:67]
  ds_read_b128 v[192:195], v19 offset:0
  v_mfma_f32_16x16x32_bf16 v[68:71], a[76:79], v[160:163], v[68:71]
  v_add_u32 v18, s33, v14
  v_mfma_f32_16x16x32_bf16 v[72:75], a[80:83], v[160:163], v[72:75]
  v_mfma_f32_16x16x32_bf16 v[76:79], a[72:75], v[164:167], v[76:79]
  ds_read_b128 v[196:199], v19 offset:2048
  v_mfma_f32_16x16x32_bf16 v[80:83], a[76:79], v[164:167], v[80:83]
  buffer_load_dwordx4 v12, s[8:11], s30 offen offset:2048 lds
  v_mfma_f32_16x16x32_bf16 v[84:87], a[80:83], v[164:167], v[84:87]
  v_mfma_f32_16x16x32_bf16 v[88:91], a[72:75], v[168:171], v[88:91]
  ds_read_b128 v[200:203], v19 offset:4096
  v_mfma_f32_16x16x32_bf16 v[92:95], a[76:79], v[168:171], v[92:95]
  ds_read_b128 v[224:227], v23 offset:6400
  v_mfma_f32_16x16x32_bf16 v[96:99], a[80:83], v[168:171], v[96:99]
  v_mfma_f32_16x16x32_bf16 v[100:103], a[72:75], v[172:175], v[100:103]
  ds_read_b128 v[204:207], v19 offset:6144
  v_mfma_f32_16x16x32_bf16 v[104:107], a[76:79], v[172:175], v[104:107]
  buffer_store_dwordx4 v[240:243], v27, s[16:19], s21 offen sc1
  v_mfma_f32_16x16x32_bf16 v[108:111], a[80:83], v[172:175], v[108:111]
  s_waitcnt lgkmcnt(5)
  v_mfma_f32_16x16x32_bf16 v[112:115], a[72:75], v[176:179], v[112:115]
  ds_read_b128 v[208:211], v19 offset:8192
  v_mfma_f32_16x16x32_bf16 v[116:119], a[76:79], v[176:179], v[116:119]
  v_mfma_f32_16x16x32_bf16 v[120:123], a[80:83], v[176:179], v[120:123]
  v_mfma_f32_16x16x32_bf16 v[124:127], a[72:75], v[180:183], v[124:127]
  ds_read_b128 v[212:215], v19 offset:10240
  v_mfma_f32_16x16x32_bf16 v[128:131], a[76:79], v[180:183], v[128:131]
  buffer_load_dwordx4 v13, s[8:11], s30 offen offset:3072 lds
  v_mfma_f32_16x16x32_bf16 v[132:135], a[80:83], v[180:183], v[132:135]
  s_add_u32 s30, s30, 128
  s_add_u32 m0, m0, 16384
  v_mfma_f32_16x16x32_bf16 v[136:139], a[72:75], v[184:187], v[136:139]
  ds_read_b128 v[216:219], v19 offset:12288
  v_mfma_f32_16x16x32_bf16 v[140:143], a[76:79], v[184:187], v[140:143]
  s_cmp_lt_u32 m0, s46
  s_cselect_b32 m0, m0, s47
  v_mfma_f32_16x16x32_bf16 v[144:147], a[80:83], v[184:187], v[144:147]
  ds_read_b128 v[228:231], v24 offset:6400
  v_mfma_f32_16x16x32_bf16 v[148:151], a[72:75], v[188:191], v[148:151]
  ds_read_b128 v[220:223], v19 offset:14336
  v_mfma_f32_16x16x32_bf16 v[152:155], a[76:79], v[188:191], v[152:155]
  buffer_store_dwordx4 v[244:247], v28, s[16:19], s21 offen sc1
  v_mfma_f32_16x16x32_bf16 v[156:159], a[80:83], v[188:191], v[156:159]
  s_waitcnt vmcnt(18) lgkmcnt(5)
  s_barrier
  v_mfma_f32_16x16x32_bf16 v[64:67], a[84:87], v[192:195], v[64:67]
  ds_read_b128 v[160:163], v18 offset:0
  v_mfma_f32_16x16x32_bf16 v[68:71], a[88:91], v[192:195], v[68:71]
  v_mfma_f32_16x16x32_bf16 v[72:75], a[92:95], v[192:195], v[72:75]
  v_add_u32 v19, s33, v15
  s_add_u32 s33, s33, 16384
  v_mfma_f32_16x16x32_bf16 v[76:79], a[84:87], v[196:199], v[76:79]
  ds_read_b128 v[164:167], v18 offset:2048
  v_mfma_f32_16x16x32_bf16 v[80:83], a[88:91], v[196:199], v[80:83]
  buffer_load_dwordx4 v10, s[8:11], s30 offen offset:0 lds
  v_mfma_f32_16x16x32_bf16 v[84:87], a[92:95], v[196:199], v[84:87]
  s_cmp_lt_u32 s33, 98304
  s_cselect_b32 s33, s33, 0
  v_mfma_f32_16x16x32_bf16 v[88:91], a[84:87], v[200:203], v[88:91]
  ds_read_b128 v[168:171], v18 offset:4096
  v_mfma_f32_16x16x32_bf16 v[92:95], a[88:91], v[200:203], v[92:95]
  s_add_u32 s21, s48, 61440
  ds_read_b128 v[232:235], v25 offset:6400
  v_mfma_f32_16x16x32_bf16 v[96:99], a[92:95], v[200:203], v[96:99]
  v_mfma_f32_16x16x32_bf16 v[100:103], a[84:87], v[204:207], v[100:103]
  ds_read_b128 v[172:175], v18 offset:6144
  v_mfma_f32_16x16x32_bf16 v[104:107], a[88:91], v[204:207], v[104:107]
  buffer_store_dwordx4 v[224:227], v26, s[16:19], s21 offen sc1
  v_mfma_f32_16x16x32_bf16 v[108:111], a[92:95], v[204:207], v[108:111]
  s_waitcnt lgkmcnt(5)
  v_mfma_f32_16x16x32_bf16 v[112:115], a[84:87], v[208:211], v[112:115]
  ds_read_b128 v[176:179], v18 offset:8192
  v_mfma_f32_16x16x32_bf16 v[116:119], a[88:91], v[208:211], v[116:119]
  v_mfma_f32_16x16x32_bf16 v[120:123], a[92:95], v[208:211], v[120:123]
  v_mfma_f32_16x16x32_bf16 v[124:127], a[84:87], v[212:215], v[124:127]
  ds_read_b128 v[180:183], v18 offset:10240
  v_mfma_f32_16x16x32_bf16 v[128:131], a[88:91], v[212:215], v[128:131]
  buffer_load_dwordx4 v11, s[8:11], s30 offen offset:1024 lds
  v_mfma_f32_16x16x32_bf16 v[132:135], a[92:95], v[212:215], v[132:135]
  v_mfma_f32_16x16x32_bf16 v[136:139], a[84:87], v[216:219], v[136:139]
  ds_read_b128 v[184:187], v18 offset:12288
  v_mfma_f32_16x16x32_bf16 v[140:143], a[88:91], v[216:219], v[140:143]
  ds_read_b128 v[236:239], v23 offset:9600
  v_mfma_f32_16x16x32_bf16 v[144:147], a[92:95], v[216:219], v[144:147]
  v_mfma_f32_16x16x32_bf16 v[148:151], a[84:87], v[220:223], v[148:151]
  ds_read_b128 v[188:191], v18 offset:14336
  v_mfma_f32_16x16x32_bf16 v[152:155], a[88:91], v[220:223], v[152:155]
  buffer_store_dwordx4 v[228:231], v27, s[16:19], s21 offen sc1
  v_mfma_f32_16x16x32_bf16 v[156:159], a[92:95], v[220:223], v[156:159]
  s_waitcnt lgkmcnt(5)
  v_mfma_f32_16x16x32_bf16 v[64:67], a[96:99], v[160:163], v[64:67]
  ds_read_b128 v[192:195], v19 offset:0
  v_mfma_f32_16x16x32_bf16 v[68:71], a[100:103], v[160:163], v[68:71]
  v_add_u32 v18, s33, v14
  v_mfma_f32_16x16x32_bf16 v[72:75], a[104:107], v[160:163], v[72:75]
  v_mfma_f32_16x16x32_bf16 v[76:79], a[96:99], v[164:167], v[76:79]
  ds_read_b128 v[196:199], v19 offset:2048
  v_mfma_f32_16x16x32_bf16 v[80:83], a[100:103], v[164:167], v[80:83]
  buffer_load_dwordx4 v12, s[8:11], s30 offen offset:2048 lds
  v_mfma_f32_16x16x32_bf16 v[84:87], a[104:107], v[164:167], v[84:87]
  v_mfma_f32_16x16x32_bf16 v[88:91], a[96:99], v[168:171], v[88:91]
  ds_read_b128 v[200:203], v19 offset:4096
  v_mfma_f32_16x16x32_bf16 v[92:95], a[100:103], v[168:171], v[92:95]
  ds_read_b128 v[240:243], v24 offset:9600
  v_mfma_f32_16x16x32_bf16 v[96:99], a[104:107], v[168:171], v[96:99]
  v_mfma_f32_16x16x32_bf16 v[100:103], a[96:99], v[172:175], v[100:103]
  ds_read_b128 v[204:207], v19 offset:6144
  v_mfma_f32_16x16x32_bf16 v[104:107], a[100:103], v[172:175], v[104:107]
  buffer_store_dwordx4 v[232:235], v28, s[16:19], s21 offen sc1
  v_mfma_f32_16x16x32_bf16 v[108:111], a[104:107], v[172:175], v[108:111]
  s_waitcnt lgkmcnt(5)
  v_mfma_f32_16x16x32_bf16 v[112:115], a[96:99], v[176:179], v[112:115]
  ds_read_b128 v[208:211], v19 offset:8192
  v_mfma_f32_16x16x32_bf16 v[116:119], a[100:103], v[176:179], v[116:119]
  v_mfma_f32_16x16x32_bf16 v[120:123], a[104:107], v[176:179], v[120:123]
  v_mfma_f32_16x16x32_bf16 v[124:127], a[96:99], v[180:183], v[124:127]
  ds_read_b128 v[212:215], v19 offset:10240
  v_mfma_f32_16x16x32_bf16 v[128:131], a[100:103], v[180:183], v[128:131]
  buffer_load_dwordx4 v13, s[8:11], s30 offen offset:3072 lds
  v_mfma_f32_16x16x32_bf16 v[132:135], a[104:107], v[180:183], v[132:135]
  s_add_u32 s30, s30, 128
  s_add_u32 m0, m0, 16384
  v_mfma_f32_16x16x32_bf16 v[136:139], a[96:99], v[184:187], v[136:139]
  ds_read_b128 v[216:219], v19 offset:12288
  v_mfma_f32_16x16x32_bf16 v[140:143], a[100:103], v[184:187], v[140:143]
  s_cmp_lt_u32 m0, s46
  s_cselect_b32 m0, m0, s47
  v_mfma_f32_16x16x32_bf16 v[144:147], a[104:107], v[184:187], v[144:147]
  s_add_u32 s21, s48, 92160
  ds_read_b128 v[244:247], v25 offset:9600
  v_mfma_f32_16x16x32_bf16 v[148:151], a[96:99], v[188:191], v[148:151]
  ds_read_b128 v[220:223], v19 offset:14336
  v_mfma_f32_16x16x32_bf16 v[152:155], a[100:103], v[188:191], v[152:155]
  buffer_store_dwordx4 v[236:239], v26, s[16:19], s21 offen sc1
  v_mfma_f32_16x16x32_bf16 v[156:159], a[104:107], v[188:191], v[156:159]
  s_waitcnt vmcnt(22) lgkmcnt(5)
  s_barrier
  v_mfma_f32_16x16x32_bf16 v[64:67], a[108:111], v[192:195], v[64:67]
  ds_read_b128 v[160:163], v18 offset:0
  v_mfma_f32_16x16x32_bf16 v[68:71], a[112:115], v[192:195], v[68:71]
  v_mfma_f32_16x16x32_bf16 v[72:75], a[116:119], v[192:195], v[72:75]
  v_add_u32 v19, s33, v15
  s_add_u32 s33, s33, 16384
  v_mfma_f32_16x16x32_bf16 v[76:79], a[108:111], v[196:199], v[76:79]
  ds_read_b128 v[164:167], v18 offset:2048
  v_mfma_f32_16x16x32_bf16 v[80:83], a[112:115], v[196:199], v[80:83]
  buffer_load_dwordx4 v10, s[8:11], s30 offen offset:0 lds
  v_mfma_f32_16x16x32_bf16 v[84:87], a[116:119], v[196:199], v[84:87]
  s_cmp_lt_u32 s33, 98304
  s_cselect_b32 s33, s33, 0
  v_mfma_f32_16x16x32_bf16 v[88:91], a[108:111], v[200:203], v[88:91]
  ds_read_b128 v[168:171], v18 offset:4096
  v_mfma_f32_16x16x32_bf16 v[92:95], a[112:115], v[200:203], v[92:95]
  v_mfma_f32_16x16x32_bf16 v[96:99], a[116:119], v[200:203], v[96:99]
  v_mfma_f32_16x16x32_bf16 v[100:103], a[108:111], v[204:207], v[100:103]
  ds_read_b128 v[172:175], v18 offset:6144
  v_mfma_f32_16x16x32_bf16 v[104:107], a[112:115], v[204:207], v[104:107]
  buffer_store_dwordx4 v[240:243], v27, s[16:19], s21 offen sc1
  v_mfma_f32_16x16x32_bf16 v[108:111], a[116:119], v[204:207], v[108:111]
  s_waitcnt lgkmcnt(4)
  v_mfma_f32_16x16x32_bf16 v[112:115], a[108:111], v[208:211], v[112:115]
  ds_read_b128 v[176:179], v18 offset:8192
  v_mfma_f32_16x16x32_bf16 v[116:119], a[112:115], v[208:211], v[116:119]
  v_mfma_f32_16x16x32_bf16 v[120:123], a[116:119], v[208:211], v[120:123]
  v_mfma_f32_16x16x32_bf16 v[124:127], a[108:111], v[212:215], v[124:127]
  ds_read_b128 v[180:183], v18 offset:10240
  v_mfma_f32_16x16x32_bf16 v[128:131], a[112:115], v[212:215], v[128:131]
  buffer_load_dwordx4 v11, s[8:11], s30 offen offset:1024 lds
  v_mfma_f32_16x16x32_bf16 v[132:135], a[116:119], v[212:215], v[132:135]
  v_mfma_f32_16x16x32_bf16 v[136:139], a[108:111], v[216:219], v[136:139]
  ds_read_b128 v[184:187], v18 offset:12288
  v_mfma_f32_16x16x32_bf16 v[140:143], a[112:115], v[216:219], v[140:143]
  v_mfma_f32_16x16x32_bf16 v[144:147], a[116:119], v[216:219], v[144:147]
  v_mfma_f32_16x16x32_bf16 v[148:151], a[108:111], v[220:223], v[148:151]
  ds_read_b128 v[188:191], v18 offset:14336
  v_mfma_f32_16x16x32_bf16 v[152:155], a[112:115], v[220:223], v[152:155]
  buffer_store_dwordx4 v[244:247], v28, s[16:19], s21 offen sc1
  v_mfma_f32_16x16x32_bf16 v[156:159], a[116:119], v[220:223], v[156:159]
  s_waitcnt lgkmcnt(4)
  v_mfma_f32_16x16x32_bf16 v[64:67], a[120:123], v[160:163], v[64:67]
  ds_read_b128 v[192:195], v19 offset:0
  v_mfma_f32_16x16x32_bf16 v[68:71], a[124:127], v[160:163], v[68:71]
  v_add_u32 v18, s33, v14
  v_mfma_f32_16x16x32_bf16 v[72:75], a[128:131], v[160:163], v[72:75]
  v_mfma_f32_16x16x32_bf16 v[76:79], a[120:123], v[164:167], v[76:79]
  ds_read_b128 v[196:199], v19 offset:2048
  v_mfma_f32_16x16x32_bf16 v[80:83], a[124:127], v[164:167], v[80:83]
  buffer_load_dwordx4 v12, s[8:11], s30 offen offset:2048 lds
  v_mfma_f32_16x16x32_bf16 v[84:87], a[128:131], v[164:167], v[84:87]
  v_mfma_f32_16x16x32_bf16 v[88:91], a[120:123], v[168:171], v[88:91]
  ds_read_b128 v[200:203], v19 offset:4096
  v_mfma_f32_16x16x32_bf16 v[92:95], a[124:127], v[168:171], v[92:95]
  v_mfma_f32_16x16x32_bf16 v[96:99], a[128:131], v[168:171], v[96:99]
  v_mfma_f32_16x16x32_bf16 v[100:103], a[120:123], v[172:175], v[100:103]
  ds_read_b128 v[204:207], v19 offset:6144
  v_mfma_f32_16x16x32_bf16 v[104:107], a[124:127], v[172:175], v[104:107]
  v_mfma_f32_16x16x32_bf16 v[108:111], a[128:131], v[172:175], v[108:111]
  s_waitcnt lgkmcnt(4)
  v_mfma_f32_16x16x32_bf16 v[112:115], a[120:123], v[176:179], v[112:115]
  ds_read_b128 v[208:211], v19 offset:8192
  v_mfma_f32_16x16x32_bf16 v[116:119], a[124:127], v[176:179], v[116:119]
  v_mfma_f32_16x16x32_bf16 v[120:123], a[128:131], v[176:179], v[120:123]
  v_mfma_f32_16x16x32_bf16 v[124:127], a[120:123], v[180:183], v[124:127]
  ds_read_b128 v[212:215], v19 offset:10240
  v_mfma_f32_16x16x32_bf16 v[128:131], a[124:127], v[180:183], v[128:131]
  buffer_load_dwordx4 v13, s[8:11], s30 offen offset:3072 lds
  v_mfma_f32_16x16x32_bf16 v[132:135], a[128:131], v[180:183], v[132:135]
  s_add_u32 s30, s30, s25
  s_sub_u32 s30, s30, 1152
  v_mfma_f32_16x16x32_bf16 v[136:139], a[120:123], v[184:187], v[136:139]
  ds_read_b128 v[216:219], v19 offset:12288
  s_add_u32 m0, m0, 16384
  v_mfma_f32_16x16x32_bf16 v[140:143], a[124:127], v[184:187], v[140:143]
  s_cmp_lt_u32 m0, s46
  s_cselect_b32 m0, m0, s47
  v_mfma_f32_16x16x32_bf16 v[144:147], a[128:131], v[184:187], v[144:147]
  v_mfma_f32_16x16x32_bf16 v[148:151], a[120:123], v[188:191], v[148:151]
  ds_read_b128 v[220:223], v19 offset:14336
  v_mfma_f32_16x16x32_bf16 v[152:155], a[124:127], v[188:191], v[152:155]
  v_mfma_f32_16x16x32_bf16 v[156:159], a[128:131], v[188:191], v[156:159]
  s_waitcnt vmcnt(23) lgkmcnt(4)
  s_barrier
  v_mfma_f32_16x16x32_bf16 v[64:67], a[132:135], v[192:195], v[64:67]
  ds_read_b128 v[160:163], v18 offset:0
  v_mfma_f32_16x16x32_bf16 v[68:71], a[136:139], v[192:195], v[68:71]
  v_mfma_f32_16x16x32_bf16 v[72:75], a[140:143], v[192:195], v[72:75]
  v_add_u32 v19, s33, v15
  s_add_u32 s33, s33, 16384
  v_mfma_f32_16x16x32_bf16 v[76:79], a[132:135], v[196:199], v[76:79]
  ds_read_b128 v[164:167], v18 offset:2048
  v_mfma_f32_16x16x32_bf16 v[80:83], a[136:139], v[196:199], v[80:83]
  buffer_load_dwordx4 v10, s[8:11], s30 offen offset:0 lds
  v_mfma_f32_16x16x32_bf16 v[84:87], a[140:143], v[196:199], v[84:87]
  s_cmp_lt_u32 s33, 98304
  s_cselect_b32 s33, s33, 0
  v_mfma_f32_16x16x32_bf16 v[88:91], a[132:135], v[200:203], v[88:91]
  ds_read_b128 v[168:171], v18 offset:4096
  v_mfma_f32_16x16x32_bf16 v[92:95], a[136:139], v[200:203], v[92:95]
  v_mfma_f32_16x16x32_bf16 v[96:99], a[140:143], v[200:203], v[96:99]
  v_mfma_f32_16x16x32_bf16 v[100:103], a[132:135], v[204:207], v[100:103]
  ds_read_b128 v[172:175], v18 offset:6144
  v_mfma_f32_16x16x32_bf16 v[104:107], a[136:139], v[204:207], v[104:107]
  v_mfma_f32_16x16x32_bf16 v[108:111], a[140:143], v[204:207], v[108:111]
  s_waitcnt lgkmcnt(4)
  v_mfma_f32_16x16x32_bf16 v[112:115], a[132:135], v[208:211], v[112:115]
  ds_read_b128 v[176:179], v18 offset:8192
  v_mfma_f32_16x16x32_bf16 v[116:119], a[136:139], v[208:211], v[116:119]
  v_mfma_f32_16x16x32_bf16 v[120:123], a[140:143], v[208:211], v[120:123]
  v_mfma_f32_16x16x32_bf16 v[124:127], a[132:135], v[212:215], v[124:127]
  ds_read_b128 v[180:183], v18 offset:10240
  v_mfma_f32_16x16x32_bf16 v[128:131], a[136:139], v[212:215], v[128:131]
  buffer_load_dwordx4 v11, s[8:11], s30 offen offset:1024 lds
  v_mfma_f32_16x16x32_bf16 v[132:135], a[140:143], v[212:215], v[132:135]
  v_mfma_f32_16x16x32_bf16 v[136:139], a[132:135], v[216:219], v[136:139]
  ds_read_b128 v[184:187], v18 offset:12288
  v_mfma_f32_16x16x32_bf16 v[140:143], a[136:139], v[216:219], v[140:143]
  v_mfma_f32_16x16x32_bf16 v[144:147], a[140:143], v[216:219], v[144:147]
  v_mfma_f32_16x16x32_bf16 v[148:151], a[132:135], v[220:223], v[148:151]
  ds_read_b128 v[188:191], v18 offset:14336
  v_mfma_f32_16x16x32_bf16 v[152:155], a[136:139], v[220:223], v[152:155]
  v_mfma_f32_16x16x32_bf16 v[156:159], a[140:143], v[220:223], v[156:159]
  s_waitcnt lgkmcnt(4)
  v_mfma_f32_16x16x32_bf16 v[64:67], a[144:147], v[160:163], v[64:67]
  ds_read_b128 v[192:195], v19 offset:0
  v_mfma_f32_16x16x32_bf16 v[68:71], a[148:151], v[160:163], v[68:71]
  v_add_u32 v18, s33, v14
  v_mfma_f32_16x16x32_bf16 v[72:75], a[152:155], v[160:163], v[72:75]
  v_mfma_f32_16x16x32_bf16 v[76:79], a[144:147], v[164:167], v[76:79]
  ds_read_b128 v[196:199], v19 offset:2048
  v_mfma_f32_16x16x32_bf16 v[80:83], a[148:151], v[164:167], v[80:83]
  buffer_load_dwordx4 v12, s[8:11], s30 offen offset:2048 lds
  v_mfma_f32_16x16x32_bf16 v[84:87], a[152:155], v[164:167], v[84:87]
  v_mfma_f32_16x16x32_bf16 v[88:91], a[144:147], v[168:171], v[88:91]
  ds_read_b128 v[200:203], v19 offset:4096
  v_mfma_f32_16x16x32_bf16 v[92:95], a[148:151], v[168:171], v[92:95]
  v_mfma_f32_16x16x32_bf16 v[96:99], a[152:155], v[168:171], v[96:99]
  v_mfma_f32_16x16x32_bf16 v[100:103], a[144:147], v[172:175], v[100:103]
  ds_read_b128 v[204:207], v19 offset:6144
  v_mfma_f32_16x16x32_bf16 v[104:107], a[148:151], v[172:175], v[104:107]
  v_mfma_f32_16x16x32_bf16 v[108:111], a[152:155], v[172:175], v[108:111]
  s_waitcnt lgkmcnt(4)
  v_mfma_f32_16x16x32_bf16 v[112:115], a[144:147], v[176:179], v[112:115]
  ds_read_b128 v[208:211], v19 offset:8192
  v_mfma_f32_16x16x32_bf16 v[116:119], a[148:151], v[176:179], v[116:119]
  v_mfma_f32_16x16x32_bf16 v[120:123], a[152:155], v[176:179], v[120:123]
  v_mfma_f32_16x16x32_bf16 v[124:127], a[144:147], v[180:183], v[124:127]
  ds_read_b128 v[212:215], v19 offset:10240
  v_mfma_f32_16x16x32_bf16 v[128:131], a[148:151], v[180:183], v[128:131]
  buffer_load_dwordx4 v13, s[8:11], s30 offen offset:3072 lds
  v_mfma_f32_16x16x32_bf16 v[132:135], a[152:155], v[180:183], v[132:135]
  s_add_u32 s30, s30, 128
  s_add_u32 m0, m0, 16384
  v_mfma_f32_16x16x32_bf16 v[136:139], a[144:147], v[184:187], v[136:139]
  ds_read_b128 v[216:219], v19 offset:12288
  v_mfma_f32_16x16x32_bf16 v[140:143], a[148:151], v[184:187], v[140:143]
  s_cmp_lt_u32 m0, s46
  s_cselect_b32 m0, m0, s47
  v_mfma_f32_16x16x32_bf16 v[144:147], a[152:155], v[184:187], v[144:147]
  v_mfma_f32_16x16x32_bf16 v[148:151], a[144:147], v[188:191], v[148:151]
  ds_read_b128 v[220:223], v19 offset:14336
  v_mfma_f32_16x16x32_bf16 v[152:155], a[148:151], v[188:191], v[152:155]
  v_mfma_f32_16x16x32_bf16 v[156:159], a[152:155], v[188:191], v[156:159]
  s_waitcnt vmcnt(6) lgkmcnt(4)
  s_barrier
  v_mfma_f32_16x16x32_bf16 v[64:67], a[156:159], v[192:195], v[64:67]
  ds_read_b128 v[160:163], v18 offset:0
  v_mfma_f32_16x16x32_bf16 v[68:71], a[160:163], v[192:195], v[68:71]
  s_cmp_eq_u32 s48, 0x80000000
  s_cbranch_scc1 qb_218
  s_cmp_lg_u32 s20, 0
  s_cbranch_scc1 af_219
  v_mov_b32 v4, 0
  v_mov_b32 v5, 1
  s_mov_b64 exec, 1
  buffer_atomic_add v5, v4, s[72:75], s61 offen sc1
  s_mov_b64 exec, -1
  s_nop 1
af_219:
qb_218:
  v_mfma_f32_16x16x32_bf16 v[72:75], a[164:167], v[192:195], v[72:75]
  v_add_u32 v19, s33, v15
  s_add_u32 s33, s33, 16384
  v_mfma_f32_16x16x32_bf16 v[76:79], a[156:159], v[196:199], v[76:79]
  ds_read_b128 v[164:167], v18 offset:2048
  v_mfma_f32_16x16x32_bf16 v[80:83], a[160:163], v[196:199], v[80:83]
  buffer_load_dwordx4 v10, s[8:11], s30 offen offset:0 lds
  v_mfma_f32_16x16x32_bf16 v[84:87], a[164:167], v[196:199], v[84:87]
  s_cmp_lt_u32 s33, 98304
  s_cselect_b32 s33, s33, 0
  v_mfma_f32_16x16x32_bf16 v[88:91], a[156:159], v[200:203], v[88:91]
  ds_read_b128 v[168:171], v18 offset:4096
  v_mfma_f32_16x16x32_bf16 v[92:95], a[160:163], v[200:203], v[92:95]
  v_mfma_f32_16x16x32_bf16 v[96:99], a[164:167], v[200:203], v[96:99]
  v_mfma_f32_16x16x32_bf16 v[100:103], a[156:159], v[204:207], v[100:103]
  ds_read_b128 v[172:175], v18 offset:6144
  v_mfma_f32_16x16x32_bf16 v[104:107], a[160:163], v[204:207], v[104:107]
  v_mfma_f32_16x16x32_bf16 v[108:111], a[164:167], v[204:207], v[108:111]
  s_waitcnt lgkmcnt(4)
  v_mfma_f32_16x16x32_bf16 v[112:115], a[156:159], v[208:211], v[112:115]
  ds_read_b128 v[176:179], v18 offset:8192
  v_mfma_f32_16x16x32_bf16 v[116:119], a[160:163], v[208:211], v[116:119]
  v_mfma_f32_16x16x32_bf16 v[120:123], a[164:167], v[208:211], v[120:123]
  v_mfma_f32_16x16x32_bf16 v[124:127], a[156:159], v[212:215], v[124:127]
  ds_read_b128 v[180:183], v18 offset:10240
  v_mfma_f32_16x16x32_bf16 v[128:131], a[160:163], v[212:215], v[128:131]
  buffer_load_dwordx4 v11, s[8:11], s30 offen offset:1024 lds
  v_mfma_f32_16x16x32_bf16 v[132:135], a[164:167], v[212:215], v[132:135]
  v_mfma_f32_16x16x32_bf16 v[136:139], a[156:159], v[216:219], v[136:139]
  ds_read_b128 v[184:187], v18 offset:12288
  v_mfma_f32_16x16x32_bf16 v[140:143], a[160:163], v[216:219], v[140:143]
  v_mfma_f32_16x16x32_bf16 v[144:147], a[164:167], v[216:219], v[144:147]
  v_mfma_f32_16x16x32_bf16 v[148:151], a[156:159], v[220:223], v[148:151]
  ds_read_b128 v[188:191], v18 offset:14336
  v_mfma_f32_16x16x32_bf16 v[152:155], a[160:163], v[220:223], v[152:155]
  v_mfma_f32_16x16x32_bf16 v[156:159], a[164:167], v[220:223], v[156:159]
  s_waitcnt lgkmcnt(4)
  v_mfma_f32_16x16x32_bf16 v[64:67], a[168:171], v[160:163], v[64:67]
  ds_read_b128 v[192:195], v19 offset:0
  v_mfma_f32_16x16x32_bf16 v[68:71], a[172:175], v[160:163], v[68:71]
  v_add_u32 v18, s33, v14
  s_mov_b32 s61, s60
  v_mfma_f32_16x16x32_bf16 v[72:75], a[176:179], v[160:163], v[72:75]
  s_add_u32 s60, s60, s63
  s_mul_i32 s48, s20, 122880
  v_mfma_f32_16x16x32_bf16 v[76:79], a[168:171], v[164:167], v[76:79]
  ds_read_b128 v[196:199], v19 offset:2048
  s_add_u32 s48, s48, s27
  v_mfma_f32_16x16x32_bf16 v[80:83], a[172:175], v[164:167], v[80:83]
  buffer_load_dwordx4 v12, s[8:11], s30 offen offset:2048 lds
  v_mfma_f32_16x16x32_bf16 v[84:87], a[176:179], v[164:167], v[84:87]
  s_add_u32 s27, s27, s28
  s_sub_u32 s26, s26, 1
  v_mfma_f32_16x16x32_bf16 v[88:91], a[168:171], v[168:171], v[88:91]
  ds_read_b128 v[200:203], v19 offset:4096
  v_mfma_f32_16x16x32_bf16 v[92:95], a[172:175], v[168:171], v[92:95]
  v_mfma_f32_16x16x32_bf16 v[96:99], a[176:179], v[168:171], v[96:99]
  v_mfma_f32_16x16x32_bf16 v[100:103], a[168:171], v[172:175], v[100:103]
  ds_read_b128 v[204:207], v19 offset:6144
  v_mfma_f32_16x16x32_bf16 v[104:107], a[172:175], v[172:175], v[104:107]
  v_mfma_f32_16x16x32_bf16 v[108:111], a[176:179], v[172:175], v[108:111]
  s_waitcnt lgkmcnt(4)
  v_mfma_f32_16x16x32_bf16 v[112:115], a[168:171], v[176:179], v[112:115]
  ds_read_b128 v[208:211], v19 offset:8192
  v_mfma_f32_16x16x32_bf16 v[116:119], a[172:175], v[176:179], v[116:119]
  v_mfma_f32_16x16x32_bf16 v[120:123], a[176:179], v[176:179], v[120:123]
  v_mfma_f32_16x16x32_bf16 v[124:127], a[168:171], v[180:183], v[124:127]
  ds_read_b128 v[212:215], v19 offset:10240
  v_mfma_f32_16x16x32_bf16 v[128:131], a[172:175], v[180:183], v[128:131]
  buffer_load_dwordx4 v13, s[8:11], s30 offen offset:3072 lds
  v_mfma_f32_16x16x32_bf16 v[132:135], a[176:179], v[180:183], v[132:135]
  s_add_u32 s30, s30, 128
  s_add_u32 m0, m0, 16384
  v_mfma_f32_16x16x32_bf16 v[136:139], a[168:171], v[184:187], v[136:139]
  ds_read_b128 v[216:219], v19 offset:12288
  v_mfma_f32_16x16x32_bf16 v[140:143], a[172:175], v[184:187], v[140:143]
  s_cmp_lt_u32 m0, s46
  s_cselect_b32 m0, m0, s47
  v_mfma_f32_16x16x32_bf16 v[144:147], a[176:179], v[184:187], v[144:147]
  v_mfma_f32_16x16x32_bf16 v[148:151], a[168:171], v[188:191], v[148:151]
  ds_read_b128 v[220:223], v19 offset:14336
  v_mfma_f32_16x16x32_bf16 v[152:155], a[172:175], v[188:191], v[152:155]
  v_mfma_f32_16x16x32_bf16 v[156:159], a[176:179], v[188:191], v[156:159]
  s_waitcnt vmcnt(15) lgkmcnt(4)
  s_barrier
  v_mfma_f32_16x16x32_bf16 v[64:67], a[180:183], v[192:195], v[64:67]
  ds_read_b128 v[160:163], v18 offset:0
  v_mfma_f32_16x16x32_bf16 v[68:71], a[184:187], v[192:195], v[68:71]
  v_mfma_f32_16x16x32_bf16 v[72:75], a[188:191], v[192:195], v[72:75]
  v_add_u32 v19, s33, v15
  s_add_u32 s33, s33, 16384
  v_mfma_f32_16x16x32_bf16 v[76:79], a[180:183], v[196:199], v[76:79]
  ds_read_b128 v[164:167], v18 offset:2048
  v_mfma_f32_16x16x32_bf16 v[80:83], a[184:187], v[196:199], v[80:83]
  buffer_load_dwordx4 v10, s[8:11], s30 offen offset:0 lds
  v_mfma_f32_16x16x32_bf16 v[84:87], a[188:191], v[196:199], v[84:87]
  s_cmp_lt_u32 s33, 98304
  s_cselect_b32 s33, s33, 0
  v_mfma_f32_16x16x32_bf16 v[88:91], a[180:183], v[200:203], v[88:91]
  ds_read_b128 v[168:171], v18 offset:4096
  v_mfma_f32_16x16x32_bf16 v[92:95], a[184:187], v[200:203], v[92:95]
  v_mfma_f32_16x16x32_bf16 v[96:99], a[188:191], v[200:203], v[96:99]
  v_mfma_f32_16x16x32_bf16 v[100:103], a[180:183], v[204:207], v[100:103]
  ds_read_b128 v[172:175], v18 offset:6144
  v_mfma_f32_16x16x32_bf16 v[104:107], a[184:187], v[204:207], v[104:107]
  v_mfma_f32_16x16x32_bf16 v[108:111], a[188:191], v[204:207], v[108:111]
  s_waitcnt lgkmcnt(4)
  v_mfma_f32_16x16x32_bf16 v[112:115], a[180:183], v[208:211], v[112:115]
  ds_read_b128 v[176:179], v18 offset:8192
  v_mfma_f32_16x16x32_bf16 v[116:119], a[184:187], v[208:211], v[116:119]
  v_mfma_f32_16x16x32_bf16 v[120:123], a[188:191], v[208:211], v[120:123]
  v_mfma_f32_16x16x32_bf16 v[124:127], a[180:183], v[212:215], v[124:127]
  ds_read_b128 v[180:183], v18 offset:10240
  v_mfma_f32_16x16x32_bf16 v[128:131], a[184:187], v[212:215], v[128:131]
  buffer_load_dwordx4 v11, s[8:11], s30 offen offset:1024 lds
  v_mfma_f32_16x16x32_bf16 v[132:135], a[188:191], v[212:215], v[132:135]
  v_mfma_f32_16x16x32_bf16 v[136:139], a[180:183], v[216:219], v[136:139]
  ds_read_b128 v[184:187], v18 offset:12288
  v_mfma_f32_16x16x32_bf16 v[140:143], a[184:187], v[216:219], v[140:143]
  v_mfma_f32_16x16x32_bf16 v[144:147], a[188:191], v[216:219], v[144:147]
  v_mfma_f32_16x16x32_bf16 v[148:151], a[180:183], v[220:223], v[148:151]
  ds_read_b128 v[188:191], v18 offset:14336
  v_mfma_f32_16x16x32_bf16 v[152:155], a[184:187], v[220:223], v[152:155]
  v_mfma_f32_16x16x32_bf16 v[156:159], a[188:191], v[220:223], v[156:159]
  s_waitcnt lgkmcnt(4)
  v_mfma_f32_16x16x32_bf16 v[64:67], a[192:195], v[160:163], v[64:67]
  ds_read_b128 v[192:195], v19 offset:0
  v_mfma_f32_16x16x32_bf16 v[68:71], a[196:199], v[160:163], v[68:71]
  v_add_u32 v18, s33, v14
  v_mfma_f32_16x16x32_bf16 v[72:75], a[200:203], v[160:163], v[72:75]
  v_mfma_f32_16x16x32_bf16 v[76:79], a[192:195], v[164:167], v[76:79]
  ds_read_b128 v[196:199], v19 offset:2048
  v_mfma_f32_16x16x32_bf16 v[80:83], a[196:199], v[164:167], v[80:83]
  buffer_load_dwordx4 v12, s[8:11], s30 offen offset:2048 lds
  v_mfma_f32_16x16x32_bf16 v[84:87], a[200:203], v[164:167], v[84:87]
  v_mfma_f32_16x16x32_bf16 v[88:91], a[192:195], v[168:171], v[88:91]
  ds_read_b128 v[200:203], v19 offset:4096
  v_mfma_f32_16x16x32_bf16 v[92:95], a[196:199], v[168:171], v[92:95]
  v_mfma_f32_16x16x32_bf16 v[96:99], a[200:203], v[168:171], v[96:99]
  v_mfma_f32_16x16x32_bf16 v[100:103], a[192:195], v[172:175], v[100:103]
  ds_read_b128 v[204:207], v19 offset:6144
  v_mfma_f32_16x16x32_bf16 v[104:107], a[196:199], v[172:175], v[104:107]
  v_mfma_f32_16x16x32_bf16 v[108:111], a[200:203], v[172:175], v[108:111]
  s_waitcnt lgkmcnt(4)
  v_mfma_f32_16x16x32_bf16 v[112:115], a[192:195], v[176:179], v[112:115]
  ds_read_b128 v[208:211], v19 offset:8192
  v_mfma_f32_16x16x32_bf16 v[116:119], a[196:199], v[176:179], v[116:119]
  v_mfma_f32_16x16x32_bf16 v[120:123], a[200:203], v[176:179], v[120:123]
  v_mfma_f32_16x16x32_bf16 v[124:127], a[192:195], v[180:183], v[124:127]
  ds_read_b128 v[212:215], v19 offset:10240
  v_mfma_f32_16x16x32_bf16 v[128:131], a[196:199], v[180:183], v[128:131]
  buffer_load_dwordx4 v13, s[8:11], s30 offen offset:3072 lds
  v_mfma_f32_16x16x32_bf16 v[132:135], a[200:203], v[180:183], v[132:135]
  s_add_u32 s30, s30, 128
  s_add_u32 m0, m0, 16384
  v_mfma_f32_16x16x32_bf16 v[136:139], a[192:195], v[184:187], v[136:139]
  ds_read_b128 v[216:219], v19 offset:12288
  v_mfma_f32_16x16x32_bf16 v[140:143], a[196:199], v[184:187], v[140:143]
  s_cmp_lt_u32 m0, s46
  s_cselect_b32 m0, m0, s47
  v_mfma_f32_16x16x32_bf16 v[144:147], a[200:203], v[184:187], v[144:147]
  v_mfma_f32_16x16x32_bf16 v[148:151], a[192:195], v[188:191], v[148:151]
  ds_read_b128 v[220:223], v19 offset:14336
  v_mfma_f32_16x16x32_bf16 v[152:155], a[196:199], v[188:191], v[152:155]
  v_mfma_f32_16x16x32_bf16 v[156:159], a[200:203], v[188:191], v[156:159]
  s_waitcnt vmcnt(12) lgkmcnt(4)
  s_barrier
  v_mfma_f32_16x16x32_bf16 v[64:67], a[204:207], v[192:195], v[64:67]
  ds_read_b128 v[160:163], v18 offset:0
  v_mfma_f32_16x16x32_bf16 v[68:71], a[208:211], v[192:195], v[68:71]
  v_mfma_f32_16x16x32_bf16 v[72:75], a[212:215], v[192:195], v[72:75]
  v_add_u32 v19, s33, v15
  s_add_u32 s33, s33, 16384
  v_mfma_f32_16x16x32_bf16 v[76:79], a[204:207], v[196:199], v[76:79]
  ds_read_b128 v[164:167], v18 offset:2048
  v_mfma_f32_16x16x32_bf16 v[80:83], a[208:211], v[196:199], v[80:83]
  buffer_load_dwordx4 v10, s[8:11], s30 offen offset:0 lds
  v_mfma_f32_16x16x32_bf16 v[84:87], a[212:215], v[196:199], v[84:87]
  s_cmp_lt_u32 s33, 98304
  s_cselect_b32 s33, s33, 0
  v_mfma_f32_16x16x32_bf16 v[88:91], a[204:207], v[200:203], v[88:91]
  ds_read_b128 v[168:171], v18 offset:4096
  v_mfma_f32_16x16x32_bf16 v[92:95], a[208:211], v[200:203], v[92:95]
  v_mfma_f32_16x16x32_bf16 v[96:99], a[212:215], v[200:203], v[96:99]
  v_mfma_f32_16x16x32_bf16 v[100:103], a[204:207], v[204:207], v[100:103]
  ds_read_b128 v[172:175], v18 offset:6144
  v_mfma_f32_16x16x32_bf16 v[104:107], a[208:211], v[204:207], v[104:107]
  v_mfma_f32_16x16x32_bf16 v[108:111], a[212:215], v[204:207], v[108:111]
  s_waitcnt lgkmcnt(4)
  v_mfma_f32_16x16x32_bf16 v[112:115], a[204:207], v[208:211], v[112:115]
  ds_read_b128 v[176:179], v18 offset:8192
  v_mfma_f32_16x16x32_bf16 v[116:119], a[208:211], v[208:211], v[116:119]
  v_mfma_f32_16x16x32_bf16 v[120:123], a[212:215], v[208:211], v[120:123]
  v_mfma_f32_16x16x32_bf16 v[124:127], a[204:207], v[212:215], v[124:127]
  ds_read_b128 v[180:183], v18 offset:10240
  v_mfma_f32_16x16x32_bf16 v[128:131], a[208:211], v[212:215], v[128:131]
  buffer_load_dwordx4 v11, s[8:11], s30 offen offset:1024 lds
  v_mfma_f32_16x16x32_bf16 v[132:135], a[212:215], v[212:215], v[132:135]
  v_mfma_f32_16x16x32_bf16 v[136:139], a[204:207], v[216:219], v[136:139]
  ds_read_b128 v[184:187], v18 offset:12288
  v_mfma_f32_16x16x32_bf16 v[140:143], a[208:211], v[216:219], v[140:143]
  v_mfma_f32_16x16x32_bf16 v[144:147], a[212:215], v[216:219], v[144:147]
  v_mfma_f32_16x16x32_bf16 v[148:151], a[204:207], v[220:223], v[148:151]
  ds_read_b128 v[188:191], v18 offset:14336
  v_mfma_f32_16x16x32_bf16 v[152:155], a[208:211], v[220:223], v[152:155]
  v_mfma_f32_16x16x32_bf16 v[156:159], a[212:215], v[220:223], v[156:159]
  s_waitcnt lgkmcnt(4)
  v_mfma_f32_16x16x32_bf16 v[64:67], a[216:219], v[160:163], v[64:67]
  ds_read_b128 v[192:195], v19 offset:0
  v_mfma_f32_16x16x32_bf16 v[68:71], a[220:223], v[160:163], v[68:71]
  v_add_u32 v18, s33, v14
  v_mfma_f32_16x16x32_bf16 v[72:75], a[224:227], v[160:163], v[72:75]
  v_mfma_f32_16x16x32_bf16 v[76:79], a[216:219], v[164:167], v[76:79]
  ds_read_b128 v[196:199], v19 offset:2048
  v_mfma_f32_16x16x32_bf16 v[80:83], a[220:223], v[164:167], v[80:83]
  buffer_load_dwordx4 v12, s[8:11], s30 offen offset:2048 lds
  v_mfma_f32_16x16x32_bf16 v[84:87], a[224:227], v[164:167], v[84:87]
  v_mfma_f32_16x16x32_bf16 v[88:91], a[216:219], v[168:171], v[88:91]
  ds_read_b128 v[200:203], v19 offset:4096
  v_mfma_f32_16x16x32_bf16 v[92:95], a[220:223], v[168:171], v[92:95]
  v_mfma_f32_16x16x32_bf16 v[96:99], a[224:227], v[168:171], v[96:99]
  v_mfma_f32_16x16x32_bf16 v[100:103], a[216:219], v[172:175], v[100:103]
  ds_read_b128 v[204:207], v19 offset:6144
  v_mfma_f32_16x16x32_bf16 v[104:107], a[220:223], v[172:175], v[104:107]
  v_mfma_f32_16x16x32_bf16 v[108:111], a[224:227], v[172:175], v[108:111]
  s_waitcnt lgkmcnt(4)
  v_mfma_f32_16x16x32_bf16 v[112:115], a[216:219], v[176:179], v[112:115]
  ds_read_b128 v[208:211], v19 offset:8192
  v_mfma_f32_16x16x32_bf16 v[116:119], a[220:223], v[176:179], v[116:119]
  v_mfma_f32_16x16x32_bf16 v[120:123], a[224:227], v[176:179], v[120:123]
  v_mfma_f32_16x16x32_bf16 v[124:127], a[216:219], v[180:183], v[124:127]
  ds_read_b128 v[212:215], v19 offset:10240
  v_mfma_f32_16x16x32_bf16 v[128:131], a[220:223], v[180:183], v[128:131]
  buffer_load_dwordx4 v13, s[8:11], s30 offen offset:3072 lds
  v_mfma_f32_16x16x32_bf16 v[132:135], a[224:227], v[180:183], v[132:135]
  s_add_u32 s30, s30, 128
  s_add_u32 m0, m0, 16384
  v_mfma_f32_16x16x32_bf16 v[136:139], a[216:219], v[184:187], v[136:139]
  ds_read_b128 v[216:219], v19 offset:12288
  v_mfma_f32_16x16x32_bf16 v[140:143], a[220:223], v[184:187], v[140:143]
  s_cmp_lt_u32 m0, s46
  s_cselect_b32 m0, m0, s47
  v_mfma_f32_16x16x32_bf16 v[144:147], a[224:227], v[184:187], v[144:147]
  v_mfma_f32_16x16x32_bf16 v[148:151], a[216:219], v[188:191], v[148:151]
  ds_read_b128 v[220:223], v19 offset:14336
  v_mfma_f32_16x16x32_bf16 v[152:155], a[220:223], v[188:191], v[152:155]
  v_mfma_f32_16x16x32_bf16 v[156:159], a[224:227], v[188:191], v[156:159]
  s_waitcnt vmcnt(12) lgkmcnt(4)
  s_barrier
  v_mfma_f32_16x16x32_bf16 v[64:67], a[228:231], v[192:195], v[64:67]
  ds_read_b128 v[160:163], v18 offset:0
  v_mfma_f32_16x16x32_bf16 v[68:71], a[232:235], v[192:195], v[68:71]
  v_mfma_f32_16x16x32_bf16 v[72:75], a[236:239], v[192:195], v[72:75]
  v_add_u32 v19, s33, v15
  s_add_u32 s33, s33, 16384
  v_mfma_f32_16x16x32_bf16 v[76:79], a[228:231], v[196:199], v[76:79]
  ds_read_b128 v[164:167], v18 offset:2048
  v_cvt_pk_bf16_f32 v224, v64, v65
  v_mfma_f32_16x16x32_bf16 v[80:83], a[232:235], v[196:199], v[80:83]
  buffer_load_dwordx4 v10, s[8:11], s30 offen offset:0 lds
  v_mfma_f32_16x16x32_bf16 v[84:87], a[236:239], v[196:199], v[84:87]
  s_cmp_lt_u32 s33, 98304
  s_cselect_b32 s33, s33, 0
  v_mfma_f32_16x16x32_bf16 v[88:91], a[228:231], v[200:203], v[88:91]
  ds_read_b128 v[168:171], v18 offset:4096
  v_cvt_pk_bf16_f32 v225, v66, v67
  v_mfma_f32_16x16x32_bf16 v[92:95], a[232:235], v[200:203], v[92:95]
  v_cvt_pk_bf16_f32 v226, v68, v69
  v_cvt_pk_bf16_f32 v227, v70, v71
  v_mfma_f32_16x16x32_bf16 v[96:99], a[236:239], v[200:203], v[96:99]
  v_cvt_pk_bf16_f32 v228, v72, v73
  v_cvt_pk_bf16_f32 v229, v74, v75
  v_mfma_f32_16x16x32_bf16 v[100:103], a[228:231], v[204:207], v[100:103]
  ds_read_b128 v[172:175], v18 offset:6144
  ds_write_b64 v22, v[224:225] offset:0
  v_mfma_f32_16x16x32_bf16 v[104:107], a[232:235], v[204:207], v[104:107]
  ds_write_b64 v22, v[226:227] offset:32
  ds_write_b64 v22, v[228:229] offset:64
  v_mfma_f32_16x16x32_bf16 v[108:111], a[236:239], v[204:207], v[108:111]
  s_waitcnt lgkmcnt(7)
  v_cvt_pk_bf16_f32 v230, v76, v77
  v_mfma_f32_16x16x32_bf16 v[112:115], a[228:231], v[208:211], v[112:115]
  ds_read_b128 v[176:179], v18 offset:8192
  v_cvt_pk_bf16_f32 v231, v78, v79
  v_mfma_f32_16x16x32_bf16 v[116:119], a[232:235], v[208:211], v[116:119]
  v_cvt_pk_bf16_f32 v232, v80, v81
  v_cvt_pk_bf16_f32 v233, v82, v83
  v_mfma_f32_16x16x32_bf16 v[120:123], a[236:239], v[208:211], v[120:123]
  v_cvt_pk_bf16_f32 v234, v84, v85
  v_cvt_pk_bf16_f32 v235, v86, v87
  v_mfma_f32_16x16x32_bf16 v[124:127], a[228:231], v[212:215], v[124:127]
  ds_read_b128 v[180:183], v18 offset:10240
  ds_write_b64 v22, v[230:231] offset:6400
  v_mfma_f32_16x16x32_bf16 v[128:131], a[232:235], v[212:215], v[128:131]
  buffer_load_dwordx4 v11, s[8:11], s30 offen offset:1024 lds
  v_mfma_f32_16x16x32_bf16 v[132:135], a[236:239], v[212:215], v[132:135]
  ds_write_b64 v22, v[232:233] offset:6432
  ds_write_b64 v22, v[234:235] offset:6464
  v_mfma_f32_16x16x32_bf16 v[136:139], a[228:231], v[216:219], v[136:139]
  ds_read_b128 v[184:187], v18 offset:12288
  v_cvt_pk_bf16_f32 v236, v88, v89
  v_mfma_f32_16x16x32_bf16 v[140:143], a[232:235], v[216:219], v[140:143]
  v_cvt_pk_bf16_f32 v237, v90, v91
  v_cvt_pk_bf16_f32 v238, v92, v93
  v_mfma_f32_16x16x32_bf16 v[144:147], a[236:239], v[216:219], v[144:147]
  v_cvt_pk_bf16_f32 v239, v94, v95
  v_cvt_pk_bf16_f32 v240, v96, v97
  v_mfma_f32_16x16x32_bf16 v[148:151], a[228:231], v[220:223], v[148:151]
  ds_read_b128 v[188:191], v18 offset:14336
  v_cvt_pk_bf16_f32 v241, v98, v99
  v_mfma_f32_16x16x32_bf16 v[152:155], a[232:235], v[220:223], v[152:155]
  ds_write_b64 v22, v[236:237] offset:12800
  ds_write_b64 v22, v[238:239] offset:12832
  v_mfma_f32_16x16x32_bf16 v[156:159], a[236:239], v[220:223], v[156:159]
  s_waitcnt lgkmcnt(12)
  s_cmp_gt_u32 s26, 0
  s_cbranch_scc1 qb_blk_220
  s_nop 7
  ds_write_b64 v22, v[240:241] offset:12864
  v_cvt_pk_bf16_f32 v242, v100, v101
  v_cvt_pk_bf16_f32 v243, v102, v103
  v_cvt_pk_bf16_f32 v244, v104, v105
  v_cvt_pk_bf16_f32 v245, v106, v107
  v_cvt_pk_bf16_f32 v246, v108, v109
  v_cvt_pk_bf16_f32 v247, v110, v111
  ds_write_b64 v22, v[242:243] offset:19200
  ds_write_b64 v22, v[244:245] offset:19232
  ds_write_b64 v22, v[246:247] offset:19264
  v_cvt_pk_bf16_f32 v224, v112, v113
  v_cvt_pk_bf16_f32 v225, v114, v115
  v_cvt_pk_bf16_f32 v226, v116, v117
  v_cvt_pk_bf16_f32 v227, v118, v119
  v_cvt_pk_bf16_f32 v228, v120, v121
  v_cvt_pk_bf16_f32 v229, v122, v123
  ds_write_b64 v22, v[224:225] offset:25600
  ds_write_b64 v22, v[226:227] offset:25632
  ds_write_b64 v22, v[228:229] offset:25664
  v_cvt_pk_bf16_f32 v230, v124, v125
  v_cvt_pk_bf16_f32 v231, v126, v127
  v_cvt_pk_bf16_f32 v232, v128, v129
  v_cvt_pk_bf16_f32 v233, v130, v131
  v_cvt_pk_bf16_f32 v234, v132, v133
  v_cvt_pk_bf16_f32 v235, v134, v135
  ds_write_b64 v22, v[230:231] offset:32000
  ds_write_b64 v22, v[232:233] offset:32032
  ds_write_b64 v22, v[234:235] offset:32064
  v_cvt_pk_bf16_f32 v236, v136, v137
  v_cvt_pk_bf16_f32 v237, v138, v139
  v_cvt_pk_bf16_f32 v238, v140, v141
  v_cvt_pk_bf16_f32 v239, v142, v143
  v_cvt_pk_bf16_f32 v240, v144, v145
  v_cvt_pk_bf16_f32 v241, v146, v147
  ds_write_b64 v22, v[236:237] offset:38400
  ds_write_b64 v22, v[238:239] offset:38432
  ds_write_b64 v22, v[240:241] offset:38464
  v_cvt_pk_bf16_f32 v242, v148, v149
  v_cvt_pk_bf16_f32 v243, v150, v151
  v_cvt_pk_bf16_f32 v244, v152, v153
  v_cvt_pk_bf16_f32 v245, v154, v155
  v_cvt_pk_bf16_f32 v246, v156, v157
  v_cvt_pk_bf16_f32 v247, v158, v159
  ds_write_b64 v22, v[242:243] offset:44800
  ds_write_b64 v22, v[244:245] offset:44832
  ds_write_b64 v22, v[246:247] offset:44864
  s_waitcnt vmcnt(0) lgkmcnt(0)
  s_barrier
  ds_read_b128 v[224:227], v23 offset:0
  ds_read_b128 v[228:231], v24 offset:0
  ds_read_b128 v[232:235], v25 offset:0
  ds_read_b128 v[236:239], v23 offset:3200
  ds_read_b128 v[240:243], v24 offset:3200
  ds_read_b128 v[244:247], v25 offset:3200
  s_waitcnt lgkmcnt(0)
  s_add_u32 s21, s48, 0
  buffer_store_dwordx4 v[224:227], v26, s[16:19], s21 offen sc1
  buffer_store_dwordx4 v[228:231], v27, s[16:19], s21 offen sc1
  buffer_store_dwordx4 v[232:235], v28, s[16:19], s21 offen sc1
  s_add_u32 s21, s48, 30720
  buffer_store_dwordx4 v[236:239], v26, s[16:19], s21 offen sc1
  buffer_store_dwordx4 v[240:243], v27, s[16:19], s21 offen sc1
  buffer_store_dwordx4 v[244:247], v28, s[16:19], s21 offen sc1
  s_nop 1
  ds_read_b128 v[224:227], v23 offset:6400
  ds_read_b128 v[228:231], v24 offset:6400
  ds_read_b128 v[232:235], v25 offset:6400
  ds_read_b128 v[236:239], v23 offset:9600
  ds_read_b128 v[240:243], v24 offset:9600
  ds_read_b128 v[244:247], v25 offset:9600
  s_waitcnt lgkmcnt(0)
  s_add_u32 s21, s48, 61440
  buffer_store_dwordx4 v[224:227], v26, s[16:19], s21 offen sc1
  buffer_store_dwordx4 v[228:231], v27, s[16:19], s21 offen sc1
  buffer_store_dwordx4 v[232:235], v28, s[16:19], s21 offen sc1
  s_add_u32 s21, s48, 92160
  buffer_store_dwordx4 v[236:239], v26, s[16:19], s21 offen sc1
  buffer_store_dwordx4 v[240:243], v27, s[16:19], s21 offen sc1
  buffer_store_dwordx4 v[244:247], v28, s[16:19], s21 offen sc1
  s_nop 1
  s_waitcnt vmcnt(0)
  s_barrier
  s_cmp_lg_u32 s20, 0
  s_cbranch_scc1 af_221
  v_mov_b32 v4, 0
  v_mov_b32 v5, 1
  s_mov_b64 exec, 1
  buffer_atomic_add v5, v4, s[72:75], s61 offen sc1
  s_mov_b64 exec, -1
  s_nop 1
af_221:
  s_barrier
  s_cmp_eq_u32 s64, 1
  s_cbranch_scc1 queue
skip_qb:
  s_sub_u32 s2, s3, 96
  s_load_dwordx2 s[4:5], s[0:1], 0
  s_load_dwordx2 s[6:7], s[0:1], 16
  s_load_dwordx2 s[38:39], s[0:1], 104
  s_mov_b32 s42, s2
  s_mov_b32 s41, 0
  s_waitcnt lgkmcnt(0)
  s_mov_b32 s8, s4
  s_mov_b32 s9, s5
  s_mov_b32 s10, 2621440
  s_mov_b32 s11, 0x00020000
  s_mov_b32 s12, s6
  s_mov_b32 s13, s7
  s_mov_b32 s14, 7864320
  s_mov_b32 s15, 0x00020000
  s_mov_b32 s16, s38
  s_mov_b32 s17, s39
  s_mov_b32 s18, 50331648
  s_mov_b32 s19, 0x00020000
  s_add_u32 s52, s38, 50331648
  s_addc_u32 s53, s39, 0
  s_mov_b32 s54, 6291456
  s_mov_b32 s55, 0x00020000
  s_add_u32 s56, s38, 85983232
  s_addc_u32 s57, s39, 0
  s_mov_b32 s58, 6815744
  s_mov_b32 s59, 0x00020000
  s_load_dwordx2 s[72:73], s[0:1], 104
  s_waitcnt lgkmcnt(0)
  s_add_u32 s72, s72, 81068032
  s_addc_u32 s73, s73, 0
  s_mov_b32 s74, 115712
  s_mov_b32 s75, 0x00020000
  s_mul_i32 s44, s42, 384
  v_mov_b32 v9, 2731
  v_add_u32 v8, 0, v1
  v_mul_u32_u24 v7, v8, v9
  v_lshrrev_b32 v7, 16, v7
  v_mul_u32_u24 v4, 24, v7
  v_sub_u32 v8, v8, v4
  s_mov_b32 s21, 12288
  v_mul_lo_u32 v7, v7, s21
  v_lshl_add_u32 v4, v8, 4, v7
  v_add_u32 v8, 64, v1
  v_mul_u32_u24 v7, v8, v9
  v_lshrrev_b32 v7, 16, v7
  v_mul_u32_u24 v5, 24, v7
  v_sub_u32 v8, v8, v5
  s_mov_b32 s21, 12288
  v_mul_lo_u32 v7, v7, s21
  v_lshl_add_u32 v5, v8, 4, v7
  v_add_u32 v8, 128, v1
  v_mul_u32_u24 v7, v8, v9
  v_lshrrev_b32 v7, 16, v7
  v_mul_u32_u24 v6, 24, v7
  v_sub_u32 v8, v8, v6
  s_mov_b32 s21, 12288
  v_mul_lo_u32 v7, v7, s21
  v_lshl_add_u32 v6, v8, 4, v7
  v_lshrrev_b32 v7, 2, v2
  v_lshl_add_u32 v7, v3, 3, v7
  v_mul_u32_u24 v7, 384, v7
  v_and_b32 v8, 3, v2
  v_lshlrev_b32 v8, 3, v8
  s_mul_i32 s21, s20, 96
  v_add3_u32 v7, v7, v8, s21
  v_add_u32 v8, 61440, v7
  s_mul_i32 s21, s20, 491520
  s_add_u32 s21, s21, 0
  s_add_u32 s21, s21, s44
  s_mul_i32 s22, s20, 15360
  s_add_u32 s22, s22, 0
  s_add_u32 m0, s22, 0
  s_nop 0
  buffer_load_dwordx4 v4, s[12:15], s21 offen lds
  s_add_u32 m0, s22, 1024
  s_nop 0
  buffer_load_dwordx4 v5, s[12:15], s21 offen lds
  s_add_u32 m0, s22, 2048
  s_nop 0
  buffer_load_dwordx4 v6, s[12:15], s21 offen lds
  s_mul_i32 s21, s20, 491520
  s_add_u32 s21, s21, 98304
  s_add_u32 s21, s21, s44
  s_mul_i32 s22, s20, 15360
  s_add_u32 s22, s22, 3072
  s_add_u32 m0, s22, 0
  s_nop 0
  buffer_load_dwordx4 v4, s[12:15], s21 offen lds
  s_add_u32 m0, s22, 1024
  s_nop 0
  buffer_load_dwordx4 v5, s[12:15], s21 offen lds
  s_add_u32 m0, s22, 2048
  s_nop 0
  buffer_load_dwordx4 v6, s[12:15], s21 offen lds
  s_mul_i32 s21, s20, 491520
  s_add_u32 s21, s21, 196608
  s_add_u32 s21, s21, s44
  s_mul_i32 s22, s20, 15360
  s_add_u32 s22, s22, 6144
  s_add_u32 m0, s22, 0
  s_nop 0
  buffer_load_dwordx4 v4, s[12:15], s21 offen lds
  s_add_u32 m0, s22, 1024
  s_nop 0
  buffer_load_dwordx4 v5, s[12:15], s21 offen lds
  s_add_u32 m0, s22, 2048
  s_nop 0
  buffer_load_dwordx4 v6, s[12:15], s21 offen lds
  s_mul_i32 s21, s20, 491520
  s_add_u32 s21, s21, 294912
  s_add_u32 s21, s21, s44
  s_mul_i32 s22, s20, 15360
  s_add_u32 s22, s22, 9216
  s_add_u32 m0, s22, 0
  s_nop 0
  buffer_load_dwordx4 v4, s[12:15], s21 offen lds
  s_add_u32 m0, s22, 1024
  s_nop 0
  buffer_load_dwordx4 v5, s[12:15], s21 offen lds
  s_add_u32 m0, s22, 2048
  s_nop 0
  buffer_load_dwordx4 v6, s[12:15], s21 offen lds
  s_mul_i32 s21, s20, 491520
  s_add_u32 s21, s21, 393216
  s_add_u32 s21, s21, s44
  s_mul_i32 s22, s20, 15360
  s_add_u32 s22, s22, 12288
  s_add_u32 m0, s22, 0
  s_nop 0
  buffer_load_dwordx4 v4, s[12:15], s21 offen lds
  s_add_u32 m0, s22, 1024
  s_nop 0
  buffer_load_dwordx4 v5, s[12:15], s21 offen lds
  s_add_u32 m0, s22, 2048
  s_nop 0
  buffer_load_dwordx4 v6, s[12:15], s21 offen lds
  s_mul_i32 s21, s20, 491520
  s_add_u32 s21, s21, 1966080
  s_add_u32 s21, s21, s44
  s_mul_i32 s22, s20, 15360
  s_add_u32 s22, s22, 61440
  s_add_u32 m0, s22, 0
  s_nop 0
  buffer_load_dwordx4 v4, s[12:15], s21 offen lds
  s_add_u32 m0, s22, 1024
  s_nop 0
  buffer_load_dwordx4 v5, s[12:15], s21 offen lds
  s_add_u32 m0, s22, 2048
  s_nop 0
  buffer_load_dwordx4 v6, s[12:15], s21 offen lds
  s_mul_i32 s21, s20, 491520
  s_add_u32 s21, s21, 2064384
  s_add_u32 s21, s21, s44
  s_mul_i32 s22, s20, 15360
  s_add_u32 s22, s22, 64512
  s_add_u32 m0, s22, 0
  s_nop 0
  buffer_load_dwordx4 v4, s[12:15], s21 offen lds
  s_add_u32 m0, s22, 1024
  s_nop 0
  buffer_load_dwordx4 v5, s[12:15], s21 offen lds
  s_add_u32 m0, s22, 2048
  s_nop 0
  buffer_load_dwordx4 v6, s[12:15], s21 offen lds
  s_mul_i32 s21, s20, 491520
  s_add_u32 s21, s21, 2162688
  s_add_u32 s21, s21, s44
  s_mul_i32 s22, s20, 15360
  s_add_u32 s22, s22, 67584
  s_add_u32 m0, s22, 0
  s_nop 0
  buffer_load_dwordx4 v4, s[12:15], s21 offen lds
  s_add_u32 m0, s22, 1024
  s_nop 0
  buffer_load_dwordx4 v5, s[12:15], s21 offen lds
  s_add_u32 m0, s22, 2048
  s_nop 0
  buffer_load_dwordx4 v6, s[12:15], s21 offen lds
  s_mul_i32 s21, s20, 491520
  s_add_u32 s21, s21, 2260992
  s_add_u32 s21, s21, s44
  s_mul_i32 s22, s20, 15360
  s_add_u32 s22, s22, 70656
  s_add_u32 m0, s22, 0
  s_nop 0
  buffer_load_dwordx4 v4, s[12:15], s21 offen lds
  s_add_u32 m0, s22, 1024
  s_nop 0
  buffer_load_dwordx4 v5, s[12:15], s21 offen lds
  s_add_u32 m0, s22, 2048
  s_nop 0
  buffer_load_dwordx4 v6, s[12:15], s21 offen lds
  s_mul_i32 s21, s20, 491520
  s_add_u32 s21, s21, 2359296
  s_add_u32 s21, s21, s44
  s_mul_i32 s22, s20, 15360
  s_add_u32 s22, s22, 73728
  s_add_u32 m0, s22, 0
  s_nop 0
  buffer_load_dwordx4 v4, s[12:15], s21 offen lds
  s_add_u32 m0, s22, 1024
  s_nop 0
  buffer_load_dwordx4 v5, s[12:15], s21 offen lds
  s_add_u32 m0, s22, 2048
  s_nop 0
  buffer_load_dwordx4 v6, s[12:15], s21 offen lds
  s_mul_i32 s21, s20, 491520
  s_add_u32 s21, s21, 3932160
  s_add_u32 s21, s21, s44
  buffer_load_dwordx4 v[64:67], v4, s[12:15], s21 offen
  buffer_load_dwordx4 v[68:71], v5, s[12:15], s21 offen
  buffer_load_dwordx4 v[72:75], v6, s[12:15], s21 offen
  s_mul_i32 s21, s20, 491520
  s_add_u32 s21, s21, 4030464
  s_add_u32 s21, s21, s44
  buffer_load_dwordx4 v[76:79], v4, s[12:15], s21 offen
  buffer_load_dwordx4 v[80:83], v5, s[12:15], s21 offen
  buffer_load_dwordx4 v[84:87], v6, s[12:15], s21 offen
  s_mul_i32 s21, s20, 491520
  s_add_u32 s21, s21, 4128768
  s_add_u32 s21, s21, s44
  buffer_load_dwordx4 v[88:91], v4, s[12:15], s21 offen
  buffer_load_dwordx4 v[92:95], v5, s[12:15], s21 offen
  buffer_load_dwordx4 v[96:99], v6, s[12:15], s21 offen
  s_mul_i32 s21, s20, 491520
  s_add_u32 s21, s21, 4227072
  s_add_u32 s21, s21, s44
  buffer_load_dwordx4 v[100:103], v4, s[12:15], s21 offen
  buffer_load_dwordx4 v[104:107], v5, s[12:15], s21 offen
  buffer_load_dwordx4 v[108:111], v6, s[12:15], s21 offen
  s_mul_i32 s21, s20, 491520
  s_add_u32 s21, s21, 4325376
  s_add_u32 s21, s21, s44
  buffer_load_dwordx4 v[112:115], v4, s[12:15], s21 offen
  buffer_load_dwordx4 v[116:119], v5, s[12:15], s21 offen
  buffer_load_dwordx4 v[120:123], v6, s[12:15], s21 offen
  s_mul_i32 s21, s20, 491520
  s_add_u32 s21, s21, 5898240
  s_add_u32 s21, s21, s44
  buffer_load_dwordx4 v[124:127], v4, s[12:15], s21 offen
  buffer_load_dwordx4 v[128:131], v5, s[12:15], s21 offen
  buffer_load_dwordx4 v[132:135], v6, s[12:15], s21 offen
  s_mul_i32 s21, s20, 491520
  s_add_u32 s21, s21, 5996544
  s_add_u32 s21, s21, s44
  buffer_load_dwordx4 v[136:139], v4, s[12:15], s21 offen
  buffer_load_dwordx4 v[140:143], v5, s[12:15], s21 offen
  buffer_load_dwordx4 v[144:147], v6, s[12:15], s21 offen
  s_mul_i32 s21, s20, 491520
  s_add_u32 s21, s21, 6094848
  s_add_u32 s21, s21, s44
  buffer_load_dwordx4 v[148:151], v4, s[12:15], s21 offen
  buffer_load_dwordx4 v[152:155], v5, s[12:15], s21 offen
  buffer_load_dwordx4 v[156:159], v6, s[12:15], s21 offen
  s_mul_i32 s21, s20, 491520
  s_add_u32 s21, s21, 6193152
  s_add_u32 s21, s21, s44
  buffer_load_dwordx4 v[160:163], v4, s[12:15], s21 offen
  buffer_load_dwordx4 v[164:167], v5, s[12:15], s21 offen
  buffer_load_dwordx4 v[168:171], v6, s[12:15], s21 offen
  s_mul_i32 s21, s20, 491520
  s_add_u32 s21, s21, 6291456
  s_add_u32 s21, s21, s44
  buffer_load_dwordx4 v[172:175], v4, s[12:15], s21 offen
  buffer_load_dwordx4 v[176:179], v5, s[12:15], s21 offen
  buffer_load_dwordx4 v[180:183], v6, s[12:15], s21 offen
  s_mul_i32 s22, s20, 15360
  v_lshl_add_u32 v30, v1, 4, s22
  v_add_u32 v31, 61440, v30
  s_waitcnt vmcnt(45)
  s_barrier
  ds_read_b64_tr_b16 a[0:1], v7 offset:0
  ds_read_b64_tr_b16 a[2:3], v7 offset:1536
  ds_read_b64_tr_b16 a[4:5], v7 offset:32
  ds_read_b64_tr_b16 a[6:7], v7 offset:1568
  ds_read_b64_tr_b16 a[8:9], v7 offset:64
  ds_read_b64_tr_b16 a[10:11], v7 offset:1600
  ds_read_b64_tr_b16 a[12:13], v7 offset:12288
  ds_read_b64_tr_b16 a[14:15], v7 offset:13824
  ds_read_b64_tr_b16 a[16:17], v7 offset:12320
  ds_read_b64_tr_b16 a[18:19], v7 offset:13856
  ds_read_b64_tr_b16 a[20:21], v7 offset:12352
  ds_read_b64_tr_b16 a[22:23], v7 offset:13888
  ds_read_b64_tr_b16 a[24:25], v7 offset:24576
  ds_read_b64_tr_b16 a[26:27], v7 offset:26112
  ds_read_b64_tr_b16 a[28:29], v7 offset:24608
  ds_read_b64_tr_b16 a[30:31], v7 offset:26144
  ds_read_b64_tr_b16 a[32:33], v7 offset:24640
  ds_read_b64_tr_b16 a[34:35], v7 offset:26176
  ds_read_b64_tr_b16 a[36:37], v7 offset:36864
  ds_read_b64_tr_b16 a[38:39], v7 offset:38400
  ds_read_b64_tr_b16 a[40:41], v7 offset:36896
  ds_read_b64_tr_b16 a[42:43], v7 offset:38432
  ds_read_b64_tr_b16 a[44:45], v7 offset:36928
  ds_read_b64_tr_b16 a[46:47], v7 offset:38464
  ds_read_b64_tr_b16 a[48:49], v7 offset:49152
  ds_read_b64_tr_b16 a[50:51], v7 offset:50688
  ds_read_b64_tr_b16 a[52:53], v7 offset:49184
  ds_read_b64_tr_b16 a[54:55], v7 offset:50720
  ds_read_b64_tr_b16 a[56:57], v7 offset:49216
  ds_read_b64_tr_b16 a[58:59], v7 offset:50752
  s_waitcnt lgkmcnt(0)
  s_barrier
  s_waitcnt vmcnt(30)
  s_barrier
  ds_read_b64_tr_b16 a[60:61], v8 offset:0
  ds_read_b64_tr_b16 a[62:63], v8 offset:1536
  ds_read_b64_tr_b16 a[64:65], v8 offset:32
  ds_read_b64_tr_b16 a[66:67], v8 offset:1568
  ds_read_b64_tr_b16 a[68:69], v8 offset:64
  ds_read_b64_tr_b16 a[70:71], v8 offset:1600
  ds_read_b64_tr_b16 a[72:73], v8 offset:12288
  ds_read_b64_tr_b16 a[74:75], v8 offset:13824
  ds_read_b64_tr_b16 a[76:77], v8 offset:12320
  ds_read_b64_tr_b16 a[78:79], v8 offset:13856
  ds_read_b64_tr_b16 a[80:81], v8 offset:12352
  ds_read_b64_tr_b16 a[82:83], v8 offset:13888
  ds_read_b64_tr_b16 a[84:85], v8 offset:24576
  ds_read_b64_tr_b16 a[86:87], v8 offset:26112
  ds_read_b64_tr_b16 a[88:89], v8 offset:24608
  ds_read_b64_tr_b16 a[90:91], v8 offset:26144
  ds_read_b64_tr_b16 a[92:93], v8 offset:24640
  ds_read_b64_tr_b16 a[94:95], v8 offset:26176
  ds_read_b64_tr_b16 a[96:97], v8 offset:36864
  ds_read_b64_tr_b16 a[98:99], v8 offset:38400
  ds_read_b64_tr_b16 a[100:101], v8 offset:36896
  ds_read_b64_tr_b16 a[102:103], v8 offset:38432
  ds_read_b64_tr_b16 a[104:105], v8 offset:36928
  ds_read_b64_tr_b16 a[106:107], v8 offset:38464
  ds_read_b64_tr_b16 a[108:109], v8 offset:49152
  ds_read_b64_tr_b16 a[110:111], v8 offset:50688
  ds_read_b64_tr_b16 a[112:113], v8 offset:49184
  ds_read_b64_tr_b16 a[114:115], v8 offset:50720
  ds_read_b64_tr_b16 a[116:117], v8 offset:49216
  ds_read_b64_tr_b16 a[118:119], v8 offset:50752
  s_waitcnt lgkmcnt(0)
  s_barrier
  s_waitcnt vmcnt(15)
  ds_write_b128 v30, v[64:67] offset:0
  ds_write_b128 v30, v[68:71] offset:1024
  ds_write_b128 v30, v[72:75] offset:2048
  ds_write_b128 v30, v[76:79] offset:3072
  ds_write_b128 v30, v[80:83] offset:4096
  ds_write_b128 v30, v[84:87] offset:5120
  ds_write_b128 v30, v[88:91] offset:6144
  ds_write_b128 v30, v[92:95] offset:7168
  ds_write_b128 v30, v[96:99] offset:8192
  ds_write_b128 v30, v[100:103] offset:9216
  ds_write_b128 v30, v[104:107] offset:10240
  ds_write_b128 v30, v[108:111] offset:11264
  ds_write_b128 v30, v[112:115] offset:12288
  ds_write_b128 v30, v[116:119] offset:13312
  ds_write_b128 v30, v[120:123] offset:14336
  s_waitcnt lgkmcnt(0)
  s_barrier
  ds_read_b64_tr_b16 a[120:121], v7 offset:0
  ds_read_b64_tr_b16 a[122:123], v7 offset:1536
  ds_read_b64_tr_b16 a[124:125], v7 offset:32
  ds_read_b64_tr_b16 a[126:127], v7 offset:1568
  ds_read_b64_tr_b16 a[128:129], v7 offset:64
  ds_read_b64_tr_b16 a[130:131], v7 offset:1600
  ds_read_b64_tr_b16 a[132:133], v7 offset:12288
  ds_read_b64_tr_b16 a[134:135], v7 offset:13824
  ds_read_b64_tr_b16 a[136:137], v7 offset:12320
  ds_read_b64_tr_b16 a[138:139], v7 offset:13856
  ds_read_b64_tr_b16 a[140:141], v7 offset:12352
  ds_read_b64_tr_b16 a[142:143], v7 offset:13888
  ds_read_b64_tr_b16 a[144:145], v7 offset:24576
  ds_read_b64_tr_b16 a[146:147], v7 offset:26112
  ds_read_b64_tr_b16 a[148:149], v7 offset:24608
  ds_read_b64_tr_b16 a[150:151], v7 offset:26144
  ds_read_b64_tr_b16 a[152:153], v7 offset:24640
  ds_read_b64_tr_b16 a[154:155], v7 offset:26176
  ds_read_b64_tr_b16 a[156:157], v7 offset:36864
  ds_read_b64_tr_b16 a[158:159], v7 offset:38400
  ds_read_b64_tr_b16 a[160:161], v7 offset:36896
  ds_read_b64_tr_b16 a[162:163], v7 offset:38432
  ds_read_b64_tr_b16 a[164:165], v7 offset:36928
  ds_read_b64_tr_b16 a[166:167], v7 offset:38464
  ds_read_b64_tr_b16 a[168:169], v7 offset:49152
  ds_read_b64_tr_b16 a[170:171], v7 offset:50688
  ds_read_b64_tr_b16 a[172:173], v7 offset:49184
  ds_read_b64_tr_b16 a[174:175], v7 offset:50720
  ds_read_b64_tr_b16 a[176:177], v7 offset:49216
  ds_read_b64_tr_b16 a[178:179], v7 offset:50752
  s_waitcnt lgkmcnt(0)
  s_barrier
  s_waitcnt vmcnt(0)
  ds_write_b128 v31, v[124:127] offset:0
  ds_write_b128 v31, v[128:131] offset:1024
  ds_write_b128 v31, v[132:135] offset:2048
  ds_write_b128 v31, v[136:139] offset:3072
  ds_write_b128 v31, v[140:143] offset:4096
  ds_write_b128 v31, v[144:147] offset:5120
  ds_write_b128 v31, v[148:151] offset:6144
  ds_write_b128 v31, v[152:155] offset:7168
  ds_write_b128 v31, v[156:159] offset:8192
  ds_write_b128 v31, v[160:163] offset:9216
  ds_write_b128 v31, v[164:167] offset:10240
  ds_write_b128 v31, v[168:171] offset:11264
  ds_write_b128 v31, v[172:175] offset:12288
  ds_write_b128 v31, v[176:179] offset:13312
  ds_write_b128 v31, v[180:183] offset:14336
  s_waitcnt lgkmcnt(0)
  s_barrier
  ds_read_b64_tr_b16 a[180:181], v8 offset:0
  ds_read_b64_tr_b16 a[182:183], v8 offset:1536
  ds_read_b64_tr_b16 a[184:185], v8 offset:32
  ds_read_b64_tr_b16 a[186:187], v8 offset:1568
  ds_read_b64_tr_b16 a[188:189], v8 offset:64
  ds_read_b64_tr_b16 a[190:191], v8 offset:1600
  ds_read_b64_tr_b16 a[192:193], v8 offset:12288
  ds_read_b64_tr_b16 a[194:195], v8 offset:13824
  ds_read_b64_tr_b16 a[196:197], v8 offset:12320
  ds_read_b64_tr_b16 a[198:199], v8 offset:13856
  ds_read_b64_tr_b16 a[200:201], v8 offset:12352
  ds_read_b64_tr_b16 a[202:203], v8 offset:13888
  ds_read_b64_tr_b16 a[204:205], v8 offset:24576
  ds_read_b64_tr_b16 a[206:207], v8 offset:26112
  ds_read_b64_tr_b16 a[208:209], v8 offset:24608
  ds_read_b64_tr_b16 a[210:211], v8 offset:26144
  ds_read_b64_tr_b16 a[212:213], v8 offset:24640
  ds_read_b64_tr_b16 a[214:215], v8 offset:26176
  ds_read_b64_tr_b16 a[216:217], v8 offset:36864
  ds_read_b64_tr_b16 a[218:219], v8 offset:38400
  ds_read_b64_tr_b16 a[220:221], v8 offset:36896
  ds_read_b64_tr_b16 a[222:223], v8 offset:38432
  ds_read_b64_tr_b16 a[224:225], v8 offset:36928
  ds_read_b64_tr_b16 a[226:227], v8 offset:38464
  ds_read_b64_tr_b16 a[228:229], v8 offset:49152
  ds_read_b64_tr_b16 a[230:231], v8 offset:50688
  ds_read_b64_tr_b16 a[232:233], v8 offset:49184
  ds_read_b64_tr_b16 a[234:235], v8 offset:50720
  ds_read_b64_tr_b16 a[236:237], v8 offset:49216
  ds_read_b64_tr_b16 a[238:239], v8 offset:50752
  s_waitcnt lgkmcnt(0)
  s_barrier
  s_mul_i32 s21, s20, 12800
  s_add_u32 s21, s21, 98304
  v_mul_u32_u24 v4, 400, v2
  v_lshlrev_b32 v5, 4, v3
  v_add3_u32 v29, v4, v5, s21
  v_lshlrev_b32 v30, 4, v1
  v_and_b32 v4, 7, v2
  v_lshlrev_b32 v4, 4, v4
  v_lshl_add_u32 v31, v3, 7, v4
  v_lshlrev_b32 v32, 3, v1
  v_and_b32 v4, 3, v1
  v_lshlrev_b32 v33, 3, v4
  v_mov_b32 v34, 0xf149f2ca
  v_lshlrev_b32 v4, 2, v3
  v_sub_u32 v35, v2, v4
  v_cmp_gt_u32 s[60:61], 2, v3
  s_mov_b32 s62, 0x3d93cd3a
  s_mov_b32 s63, 0x3fb8aa3b
  s_mov_b32 s83, 0x3dd53b95
  v_cmp_le_i32 s[64:65], 0, v35
  v_cmp_le_i32 s[66:67], 1, v35
  v_cmp_le_i32 s[68:69], 2, v35
  v_cmp_le_i32 s[70:71], 3, v35
  s_mov_b32 s24, 2457600
  s_mov_b32 s25, 4292509696
  s_mov_b32 s26, 16
  s_lshl_b32 s49, s41, 2
  s_add_u32 s49, s49, s20
  s_mov_b32 s29, 4
  s_mov_b32 s78, 0
  s_mov_b32 s81, 0x80000000
  s_mov_b32 s82, 0
  v_lshrrev_b32 v11, 3, v1
  v_and_b32 v12, 7, v1
  v_xor_b32 v12, v12, v11
  v_mul_u32_u24 v11, 1280, v11
  v_lshl_add_u32 v10, v12, 4, v11
  s_mul_i32 s46, s20, 40960
  v_add_u32 v10, s46, v10
  s_lshl_b32 s47, s20, 12
  s_add_u32 s47, s47, 0
  s_add_u32 s46, s47, 98304
  s_mov_b32 s30, s24
  s_add_u32 s32, s47, 0
  v_add_u32 v11, 9216, v10
  v_add_u32 v12, 18432, v10
  v_add_u32 v13, 27648, v10
  s_mov_b32 m0, s32
  s_nop 0
  buffer_load_dwordx4 v10, s[8:11], s30 offen offset:0 lds
  buffer_load_dwordx4 v11, s[8:11], s30 offen offset:1024 lds
  buffer_load_dwordx4 v12, s[8:11], s30 offen offset:2048 lds
  buffer_load_dwordx4 v13, s[8:11], s30 offen offset:3072 lds
  s_add_u32 s30, s30, 128
  s_add_u32 s32, s32, 16384
  s_cmp_lt_u32 s32, s46
  s_cselect_b32 s32, s32, s47
  s_mov_b32 m0, s32
  s_nop 0
  buffer_load_dwordx4 v10, s[8:11], s30 offen offset:0 lds
  buffer_load_dwordx4 v11, s[8:11], s30 offen offset:1024 lds
  buffer_load_dwordx4 v12, s[8:11], s30 offen offset:2048 lds
  buffer_load_dwordx4 v13, s[8:11], s30 offen offset:3072 lds
  s_add_u32 s30, s30, 128
  s_add_u32 s32, s32, 16384
  s_cmp_lt_u32 s32, s46
  s_cselect_b32 s32, s32, s47
  s_mov_b32 m0, s32
  s_nop 0
  buffer_load_dwordx4 v10, s[8:11], s30 offen offset:0 lds
  buffer_load_dwordx4 v11, s[8:11], s30 offen offset:1024 lds
  buffer_load_dwordx4 v12, s[8:11], s30 offen offset:2048 lds
  buffer_load_dwordx4 v13, s[8:11], s30 offen offset:3072 lds
  s_add_u32 s30, s30, 128
  s_add_u32 s32, s32, 16384
  s_cmp_lt_u32 s32, s46
  s_cselect_b32 s32, s32, s47
  s_mov_b32 m0, s32
  s_nop 0
  buffer_load_dwordx4 v10, s[8:11], s30 offen offset:0 lds
  buffer_load_dwordx4 v11, s[8:11], s30 offen offset:1024 lds
  buffer_load_dwordx4 v12, s[8:11], s30 offen offset:2048 lds
  buffer_load_dwordx4 v13, s[8:11], s30 offen offset:3072 lds
  s_add_u32 s30, s30, 128
  s_add_u32 s32, s32, 16384
  s_cmp_lt_u32 s32, s46
  s_cselect_b32 s32, s32, s47
  v_and_b32 v6, 7, v2
  v_add_u32 v4, 0, v3
  v_xor_b32 v4, v4, v6
  v_lshlrev_b32 v4, 4, v4
  v_lshl_add_u32 v14, v2, 7, v4
  v_add_u32 v4, 4, v3
  v_xor_b32 v4, v4, v6
  v_lshlrev_b32 v4, 4, v4
  v_lshl_add_u32 v15, v2, 7, v4
  v_mul_u32_u24 v22, 400, v2
  v_mul_u32_u24 v4, 24, v3
  s_mul_i32 s21, s20, 96
  s_add_u32 s21, s21, 98304
  v_add3_u32 v22, v22, v4, s21
  v_mov_b32 v9, 2731
  s_mov_b32 s33, 0
  s_mov_b32 s48, 0x80000000
  s_mov_b32 m0, s32
  s_nop 0
  buffer_load_dwordx4 v10, s[8:11], s30 offen offset:0 lds
  buffer_load_dwordx4 v11, s[8:11], s30 offen offset:1024 lds
  s_waitcnt vmcnt(14)
  s_barrier
  v_add_u32 v18, s33, v14
  v_add_u32 v19, s33, v15
  s_add_u32 s33, s33, 16384
  s_cmp_lt_u32 s33, 98304
  s_cselect_b32 s33, s33, 0
  ds_read_b128 v[160:163], v18 offset:0
  ds_read_b128 v[164:167], v18 offset:2048
  ds_read_b128 v[168:171], v18 offset:4096
  ds_read_b128 v[172:175], v18 offset:6144
  ds_read_b128 v[176:179], v18 offset:8192
  ds_read_b128 v[180:183], v18 offset:10240
  ds_read_b128 v[184:187], v18 offset:12288
  ds_read_b128 v[188:191], v18 offset:14336
  s_waitcnt lgkmcnt(0)
qa_blk_223:
  v_mfma_f32_16x16x32_bf16 v[64:67], a[0:3], v[160:163], 0
  ds_read_b128 v[192:195], v19 offset:0
  v_mfma_f32_16x16x32_bf16 v[68:71], a[4:7], v[160:163], 0
  v_add_u32 v18, s33, v14
  v_mfma_f32_16x16x32_bf16 v[72:75], a[8:11], v[160:163], 0
  v_mfma_f32_16x16x32_bf16 v[76:79], a[0:3], v[164:167], 0
  ds_read_b128 v[196:199], v19 offset:2048
  v_mfma_f32_16x16x32_bf16 v[80:83], a[4:7], v[164:167], 0
  buffer_load_dwordx4 v12, s[8:11], s30 offen offset:2048 lds
  v_mfma_f32_16x16x32_bf16 v[84:87], a[8:11], v[164:167], 0
  v_mfma_f32_16x16x32_bf16 v[88:91], a[0:3], v[168:171], 0
  ds_read_b128 v[200:203], v19 offset:4096
  v_mfma_f32_16x16x32_bf16 v[92:95], a[4:7], v[168:171], 0
  v_mfma_f32_16x16x32_bf16 v[96:99], a[8:11], v[168:171], 0
  v_mfma_f32_16x16x32_bf16 v[100:103], a[0:3], v[172:175], 0
  ds_read_b128 v[204:207], v19 offset:6144
  v_mfma_f32_16x16x32_bf16 v[104:107], a[4:7], v[172:175], 0
  v_mfma_f32_16x16x32_bf16 v[108:111], a[8:11], v[172:175], 0
  s_waitcnt lgkmcnt(11)
  v_mfma_f32_16x16x32_bf16 v[112:115], a[0:3], v[176:179], 0
  ds_read_b128 v[208:211], v19 offset:8192
  v_mfma_f32_16x16x32_bf16 v[116:119], a[4:7], v[176:179], 0
  v_mfma_f32_16x16x32_bf16 v[120:123], a[8:11], v[176:179], 0
  v_mfma_f32_16x16x32_bf16 v[124:127], a[0:3], v[180:183], 0
  ds_read_b128 v[212:215], v19 offset:10240
  v_mfma_f32_16x16x32_bf16 v[128:131], a[4:7], v[180:183], 0
  buffer_load_dwordx4 v13, s[8:11], s30 offen offset:3072 lds
  v_mfma_f32_16x16x32_bf16 v[132:135], a[8:11], v[180:183], 0
  s_add_u32 s30, s30, 128
  s_add_u32 m0, m0, 16384
  v_mfma_f32_16x16x32_bf16 v[136:139], a[0:3], v[184:187], 0
  ds_read_b128 v[216:219], v19 offset:12288
  v_mfma_f32_16x16x32_bf16 v[140:143], a[4:7], v[184:187], 0
  s_cmp_lt_u32 m0, s46
  s_cselect_b32 m0, m0, s47
  v_mfma_f32_16x16x32_bf16 v[144:147], a[8:11], v[184:187], 0
  v_mfma_f32_16x16x32_bf16 v[148:151], a[0:3], v[188:191], 0
  ds_read_b128 v[220:223], v19 offset:14336
  v_mfma_f32_16x16x32_bf16 v[152:155], a[4:7], v[188:191], 0
  v_mfma_f32_16x16x32_bf16 v[156:159], a[8:11], v[188:191], 0
  s_waitcnt vmcnt(12) lgkmcnt(4)
  s_barrier
  v_mfma_f32_16x16x32_bf16 v[64:67], a[12:15], v[192:195], v[64:67]
  ds_read_b128 v[160:163], v18 offset:0
  v_mfma_f32_16x16x32_bf16 v[68:71], a[16:19], v[192:195], v[68:71]
  v_mfma_f32_16x16x32_bf16 v[72:75], a[20:23], v[192:195], v[72:75]
  v_add_u32 v19, s33, v15
  s_add_u32 s33, s33, 16384
  v_mfma_f32_16x16x32_bf16 v[76:79], a[12:15], v[196:199], v[76:79]
  ds_read_b128 v[164:167], v18 offset:2048
  v_mfma_f32_16x16x32_bf16 v[80:83], a[16:19], v[196:199], v[80:83]
  buffer_load_dwordx4 v10, s[8:11], s30 offen offset:0 lds
  v_mfma_f32_16x16x32_bf16 v[84:87], a[20:23], v[196:199], v[84:87]
  s_cmp_lt_u32 s33, 98304
  s_cselect_b32 s33, s33, 0
  v_mfma_f32_16x16x32_bf16 v[88:91], a[12:15], v[200:203], v[88:91]
  ds_read_b128 v[168:171], v18 offset:4096
  v_mfma_f32_16x16x32_bf16 v[92:95], a[16:19], v[200:203], v[92:95]
  v_mfma_f32_16x16x32_bf16 v[96:99], a[20:23], v[200:203], v[96:99]
  v_mfma_f32_16x16x32_bf16 v[100:103], a[12:15], v[204:207], v[100:103]
  ds_read_b128 v[172:175], v18 offset:6144
  v_mfma_f32_16x16x32_bf16 v[104:107], a[16:19], v[204:207], v[104:107]
  v_mfma_f32_16x16x32_bf16 v[108:111], a[20:23], v[204:207], v[108:111]
  s_waitcnt lgkmcnt(4)
  v_mfma_f32_16x16x32_bf16 v[112:115], a[12:15], v[208:211], v[112:115]
  ds_read_b128 v[176:179], v18 offset:8192
  v_mfma_f32_16x16x32_bf16 v[116:119], a[16:19], v[208:211], v[116:119]
  v_mfma_f32_16x16x32_bf16 v[120:123], a[20:23], v[208:211], v[120:123]
  v_mfma_f32_16x16x32_bf16 v[124:127], a[12:15], v[212:215], v[124:127]
  ds_read_b128 v[180:183], v18 offset:10240
  v_mfma_f32_16x16x32_bf16 v[128:131], a[16:19], v[212:215], v[128:131]
  buffer_load_dwordx4 v11, s[8:11], s30 offen offset:1024 lds
  v_mfma_f32_16x16x32_bf16 v[132:135], a[20:23], v[212:215], v[132:135]
  v_mfma_f32_16x16x32_bf16 v[136:139], a[12:15], v[216:219], v[136:139]
  ds_read_b128 v[184:187], v18 offset:12288
  v_mfma_f32_16x16x32_bf16 v[140:143], a[16:19], v[216:219], v[140:143]
  v_mfma_f32_16x16x32_bf16 v[144:147], a[20:23], v[216:219], v[144:147]
  v_mfma_f32_16x16x32_bf16 v[148:151], a[12:15], v[220:223], v[148:151]
  ds_read_b128 v[188:191], v18 offset:14336
  v_mfma_f32_16x16x32_bf16 v[152:155], a[16:19], v[220:223], v[152:155]
  v_mfma_f32_16x16x32_bf16 v[156:159], a[20:23], v[220:223], v[156:159]
  s_waitcnt lgkmcnt(4)
  v_mfma_f32_16x16x32_bf16 v[64:67], a[24:27], v[160:163], v[64:67]
  ds_read_b128 v[192:195], v19 offset:0
  v_mfma_f32_16x16x32_bf16 v[68:71], a[28:31], v[160:163], v[68:71]
  v_add_u32 v18, s33, v14
  v_mfma_f32_16x16x32_bf16 v[72:75], a[32:35], v[160:163], v[72:75]
  v_mfma_f32_16x16x32_bf16 v[76:79], a[24:27], v[164:167], v[76:79]
  ds_read_b128 v[196:199], v19 offset:2048
  v_mfma_f32_16x16x32_bf16 v[80:83], a[28:31], v[164:167], v[80:83]
  buffer_load_dwordx4 v12, s[8:11], s30 offen offset:2048 lds
  v_mfma_f32_16x16x32_bf16 v[84:87], a[32:35], v[164:167], v[84:87]
  v_mfma_f32_16x16x32_bf16 v[88:91], a[24:27], v[168:171], v[88:91]
  ds_read_b128 v[200:203], v19 offset:4096
  v_mfma_f32_16x16x32_bf16 v[92:95], a[28:31], v[168:171], v[92:95]
  v_mfma_f32_16x16x32_bf16 v[96:99], a[32:35], v[168:171], v[96:99]
  v_mfma_f32_16x16x32_bf16 v[100:103], a[24:27], v[172:175], v[100:103]
  ds_read_b128 v[204:207], v19 offset:6144
  v_mfma_f32_16x16x32_bf16 v[104:107], a[28:31], v[172:175], v[104:107]
  v_mfma_f32_16x16x32_bf16 v[108:111], a[32:35], v[172:175], v[108:111]
  s_waitcnt lgkmcnt(4)
  v_mfma_f32_16x16x32_bf16 v[112:115], a[24:27], v[176:179], v[112:115]
  ds_read_b128 v[208:211], v19 offset:8192
  v_mfma_f32_16x16x32_bf16 v[116:119], a[28:31], v[176:179], v[116:119]
  v_mfma_f32_16x16x32_bf16 v[120:123], a[32:35], v[176:179], v[120:123]
  v_mfma_f32_16x16x32_bf16 v[124:127], a[24:27], v[180:183], v[124:127]
  ds_read_b128 v[212:215], v19 offset:10240
  v_mfma_f32_16x16x32_bf16 v[128:131], a[28:31], v[180:183], v[128:131]
  buffer_load_dwordx4 v13, s[8:11], s30 offen offset:3072 lds
  v_mfma_f32_16x16x32_bf16 v[132:135], a[32:35], v[180:183], v[132:135]
  s_add_u32 s30, s30, 128
  s_add_u32 m0, m0, 16384
  v_mfma_f32_16x16x32_bf16 v[136:139], a[24:27], v[184:187], v[136:139]
  ds_read_b128 v[216:219], v19 offset:12288
  v_mfma_f32_16x16x32_bf16 v[140:143], a[28:31], v[184:187], v[140:143]
  s_cmp_lt_u32 m0, s46
  s_cselect_b32 m0, m0, s47
  v_mfma_f32_16x16x32_bf16 v[144:147], a[32:35], v[184:187], v[144:147]
  v_mfma_f32_16x16x32_bf16 v[148:151], a[24:27], v[188:191], v[148:151]
  ds_read_b128 v[220:223], v19 offset:14336
  v_mfma_f32_16x16x32_bf16 v[152:155], a[28:31], v[188:191], v[152:155]
  v_mfma_f32_16x16x32_bf16 v[156:159], a[32:35], v[188:191], v[156:159]
  s_waitcnt vmcnt(12) lgkmcnt(4)
  s_barrier
  v_mfma_f32_16x16x32_bf16 v[64:67], a[36:39], v[192:195], v[64:67]
  ds_read_b128 v[160:163], v18 offset:0
  v_mfma_f32_16x16x32_bf16 v[68:71], a[40:43], v[192:195], v[68:71]
  v_mfma_f32_16x16x32_bf16 v[72:75], a[44:47], v[192:195], v[72:75]
  v_add_u32 v19, s33, v15
  s_add_u32 s33, s33, 16384
  v_mfma_f32_16x16x32_bf16 v[76:79], a[36:39], v[196:199], v[76:79]
  ds_read_b128 v[164:167], v18 offset:2048
  v_mfma_f32_16x16x32_bf16 v[80:83], a[40:43], v[196:199], v[80:83]
  buffer_load_dwordx4 v10, s[8:11], s30 offen offset:0 lds
  v_mfma_f32_16x16x32_bf16 v[84:87], a[44:47], v[196:199], v[84:87]
  s_cmp_lt_u32 s33, 98304
  s_cselect_b32 s33, s33, 0
  v_mfma_f32_16x16x32_bf16 v[88:91], a[36:39], v[200:203], v[88:91]
  ds_read_b128 v[168:171], v18 offset:4096
  v_mfma_f32_16x16x32_bf16 v[92:95], a[40:43], v[200:203], v[92:95]
  v_mfma_f32_16x16x32_bf16 v[96:99], a[44:47], v[200:203], v[96:99]
  v_mfma_f32_16x16x32_bf16 v[100:103], a[36:39], v[204:207], v[100:103]
  ds_read_b128 v[172:175], v18 offset:6144
  v_mfma_f32_16x16x32_bf16 v[104:107], a[40:43], v[204:207], v[104:107]
  v_mfma_f32_16x16x32_bf16 v[108:111], a[44:47], v[204:207], v[108:111]
  s_waitcnt lgkmcnt(4)
  v_mfma_f32_16x16x32_bf16 v[112:115], a[36:39], v[208:211], v[112:115]
  ds_read_b128 v[176:179], v18 offset:8192
  v_mfma_f32_16x16x32_bf16 v[116:119], a[40:43], v[208:211], v[116:119]
  v_mfma_f32_16x16x32_bf16 v[120:123], a[44:47], v[208:211], v[120:123]
  v_mfma_f32_16x16x32_bf16 v[124:127], a[36:39], v[212:215], v[124:127]
  ds_read_b128 v[180:183], v18 offset:10240
  v_mfma_f32_16x16x32_bf16 v[128:131], a[40:43], v[212:215], v[128:131]
  buffer_load_dwordx4 v11, s[8:11], s30 offen offset:1024 lds
  v_mfma_f32_16x16x32_bf16 v[132:135], a[44:47], v[212:215], v[132:135]
  v_mfma_f32_16x16x32_bf16 v[136:139], a[36:39], v[216:219], v[136:139]
  ds_read_b128 v[184:187], v18 offset:12288
  v_mfma_f32_16x16x32_bf16 v[140:143], a[40:43], v[216:219], v[140:143]
  v_mfma_f32_16x16x32_bf16 v[144:147], a[44:47], v[216:219], v[144:147]
  v_mfma_f32_16x16x32_bf16 v[148:151], a[36:39], v[220:223], v[148:151]
  ds_read_b128 v[188:191], v18 offset:14336
  v_mfma_f32_16x16x32_bf16 v[152:155], a[40:43], v[220:223], v[152:155]
  v_mfma_f32_16x16x32_bf16 v[156:159], a[44:47], v[220:223], v[156:159]
  s_waitcnt lgkmcnt(4)
  v_mfma_f32_16x16x32_bf16 v[64:67], a[48:51], v[160:163], v[64:67]
  ds_read_b128 v[192:195], v19 offset:0
  v_mfma_f32_16x16x32_bf16 v[68:71], a[52:55], v[160:163], v[68:71]
  v_add_u32 v18, s33, v14
  v_mfma_f32_16x16x32_bf16 v[72:75], a[56:59], v[160:163], v[72:75]
  v_mfma_f32_16x16x32_bf16 v[76:79], a[48:51], v[164:167], v[76:79]
  ds_read_b128 v[196:199], v19 offset:2048
  v_mfma_f32_16x16x32_bf16 v[80:83], a[52:55], v[164:167], v[80:83]
  buffer_load_dwordx4 v12, s[8:11], s30 offen offset:2048 lds
  v_mfma_f32_16x16x32_bf16 v[84:87], a[56:59], v[164:167], v[84:87]
  v_mfma_f32_16x16x32_bf16 v[88:91], a[48:51], v[168:171], v[88:91]
  ds_read_b128 v[200:203], v19 offset:4096
  v_mfma_f32_16x16x32_bf16 v[92:95], a[52:55], v[168:171], v[92:95]
  v_mfma_f32_16x16x32_bf16 v[96:99], a[56:59], v[168:171], v[96:99]
  v_mfma_f32_16x16x32_bf16 v[100:103], a[48:51], v[172:175], v[100:103]
  ds_read_b128 v[204:207], v19 offset:6144
  v_mfma_f32_16x16x32_bf16 v[104:107], a[52:55], v[172:175], v[104:107]
  v_mfma_f32_16x16x32_bf16 v[108:111], a[56:59], v[172:175], v[108:111]
  s_waitcnt lgkmcnt(4)
  v_mfma_f32_16x16x32_bf16 v[112:115], a[48:51], v[176:179], v[112:115]
  ds_read_b128 v[208:211], v19 offset:8192
  v_mfma_f32_16x16x32_bf16 v[116:119], a[52:55], v[176:179], v[116:119]
  v_mfma_f32_16x16x32_bf16 v[120:123], a[56:59], v[176:179], v[120:123]
  v_mfma_f32_16x16x32_bf16 v[124:127], a[48:51], v[180:183], v[124:127]
  ds_read_b128 v[212:215], v19 offset:10240
  v_mfma_f32_16x16x32_bf16 v[128:131], a[52:55], v[180:183], v[128:131]
  buffer_load_dwordx4 v13, s[8:11], s30 offen offset:3072 lds
  v_mfma_f32_16x16x32_bf16 v[132:135], a[56:59], v[180:183], v[132:135]
  s_add_u32 s30, s30, 128
  s_add_u32 m0, m0, 16384
  v_mfma_f32_16x16x32_bf16 v[136:139], a[48:51], v[184:187], v[136:139]
  ds_read_b128 v[216:219], v19 offset:12288
  v_mfma_f32_16x16x32_bf16 v[140:143], a[52:55], v[184:187], v[140:143]
  s_cmp_lt_u32 m0, s46
  s_cselect_b32 m0, m0, s47
  v_mfma_f32_16x16x32_bf16 v[144:147], a[56:59], v[184:187], v[144:147]
  v_mfma_f32_16x16x32_bf16 v[148:151], a[48:51], v[188:191], v[148:151]
  ds_read_b128 v[220:223], v19 offset:14336
  v_mfma_f32_16x16x32_bf16 v[152:155], a[52:55], v[188:191], v[152:155]
  v_mfma_f32_16x16x32_bf16 v[156:159], a[56:59], v[188:191], v[156:159]
  s_waitcnt vmcnt(12) lgkmcnt(4)
  s_barrier
  v_mfma_f32_16x16x32_bf16 v[64:67], a[60:63], v[192:195], v[64:67]
  ds_read_b128 v[160:163], v18 offset:0
  v_mfma_f32_16x16x32_bf16 v[68:71], a[64:67], v[192:195], v[68:71]
  s_waitcnt vmcnt(10)
  s_cmp_eq_u32 s78, 0
  s_cbranch_scc1 pf_222
  v_mov_b32 v4, 0
  v_mov_b32 v5, 1
  s_mov_b64 exec, 1
  buffer_atomic_add v5, v4, s[72:75], s78 offen sc1
  s_mov_b64 exec, -1
  s_mov_b32 s78, 0
pf_222:
  s_mul_i32 s21, s49, 393216
  s_mul_i32 s22, s42, 12288
  s_add_u32 s50, s21, s22
  s_mul_i32 s21, s49, 98304
  s_mul_i32 s22, s42, 3072
  s_add_u32 s51, s21, s22
  s_lshr_b32 s22, s49, 1
  s_lshr_b32 s21, s49, 2
  s_add_u32 s21, s21, 2
  s_cmp_lt_u32 s49, 8
  s_cselect_b32 s21, s22, s21
  s_lshl_b32 s21, s21, 3
  s_lshr_b32 s22, s42, 2
  s_add_u32 s21, s21, s22
  s_lshl_b32 s21, s21, 7
  s_add_u32 s76, s21, 0
  s_lshl_b32 s77, s42, 7
  s_add_u32 s77, s77, 18432
  v_mov_b32 v4, 0
  buffer_load_dword v20, v4, s[72:75], s76 offen sc1
  v_mfma_f32_16x16x32_bf16 v[72:75], a[68:71], v[192:195], v[72:75]
  v_add_u32 v19, s33, v15
  s_add_u32 s33, s33, 16384
  v_mfma_f32_16x16x32_bf16 v[76:79], a[60:63], v[196:199], v[76:79]
  ds_read_b128 v[164:167], v18 offset:2048
  v_mfma_f32_16x16x32_bf16 v[80:83], a[64:67], v[196:199], v[80:83]
  buffer_load_dwordx4 v10, s[8:11], s30 offen offset:0 lds
  v_mfma_f32_16x16x32_bf16 v[84:87], a[68:71], v[196:199], v[84:87]
  s_cmp_lt_u32 s33, 98304
  s_cselect_b32 s33, s33, 0
  v_mfma_f32_16x16x32_bf16 v[88:91], a[60:63], v[200:203], v[88:91]
  ds_read_b128 v[168:171], v18 offset:4096
  v_mfma_f32_16x16x32_bf16 v[92:95], a[64:67], v[200:203], v[92:95]
  v_mfma_f32_16x16x32_bf16 v[96:99], a[68:71], v[200:203], v[96:99]
  v_mfma_f32_16x16x32_bf16 v[100:103], a[60:63], v[204:207], v[100:103]
  ds_read_b128 v[172:175], v18 offset:6144
  v_mfma_f32_16x16x32_bf16 v[104:107], a[64:67], v[204:207], v[104:107]
  v_mfma_f32_16x16x32_bf16 v[108:111], a[68:71], v[204:207], v[108:111]
  s_waitcnt lgkmcnt(4)
  v_mfma_f32_16x16x32_bf16 v[112:115], a[60:63], v[208:211], v[112:115]
  ds_read_b128 v[176:179], v18 offset:8192
  v_mfma_f32_16x16x32_bf16 v[116:119], a[64:67], v[208:211], v[116:119]
  v_mfma_f32_16x16x32_bf16 v[120:123], a[68:71], v[208:211], v[120:123]
  v_mfma_f32_16x16x32_bf16 v[124:127], a[60:63], v[212:215], v[124:127]
  ds_read_b128 v[180:183], v18 offset:10240
  v_mfma_f32_16x16x32_bf16 v[128:131], a[64:67], v[212:215], v[128:131]
  buffer_load_dwordx4 v11, s[8:11], s30 offen offset:1024 lds
  v_mfma_f32_16x16x32_bf16 v[132:135], a[68:71], v[212:215], v[132:135]
  v_mfma_f32_16x16x32_bf16 v[136:139], a[60:63], v[216:219], v[136:139]
  ds_read_b128 v[184:187], v18 offset:12288
  v_mfma_f32_16x16x32_bf16 v[140:143], a[64:67], v[216:219], v[140:143]
  v_mfma_f32_16x16x32_bf16 v[144:147], a[68:71], v[216:219], v[144:147]
  v_mfma_f32_16x16x32_bf16 v[148:151], a[60:63], v[220:223], v[148:151]
  ds_read_b128 v[188:191], v18 offset:14336
  v_mfma_f32_16x16x32_bf16 v[152:155], a[64:67], v[220:223], v[152:155]
  v_mfma_f32_16x16x32_bf16 v[156:159], a[68:71], v[220:223], v[156:159]
  s_waitcnt lgkmcnt(4)
  v_mfma_f32_16x16x32_bf16 v[64:67], a[72:75], v[160:163], v[64:67]
  ds_read_b128 v[192:195], v19 offset:0
  v_mfma_f32_16x16x32_bf16 v[68:71], a[76:79], v[160:163], v[68:71]
  v_add_u32 v18, s33, v14
  v_mfma_f32_16x16x32_bf16 v[72:75], a[80:83], v[160:163], v[72:75]
  v_mfma_f32_16x16x32_bf16 v[76:79], a[72:75], v[164:167], v[76:79]
  ds_read_b128 v[196:199], v19 offset:2048
  v_mfma_f32_16x16x32_bf16 v[80:83], a[76:79], v[164:167], v[80:83]
  buffer_load_dwordx4 v12, s[8:11], s30 offen offset:2048 lds
  v_mfma_f32_16x16x32_bf16 v[84:87], a[80:83], v[164:167], v[84:87]
  v_mfma_f32_16x16x32_bf16 v[88:91], a[72:75], v[168:171], v[88:91]
  ds_read_b128 v[200:203], v19 offset:4096
  v_mfma_f32_16x16x32_bf16 v[92:95], a[76:79], v[168:171], v[92:95]
  v_mfma_f32_16x16x32_bf16 v[96:99], a[80:83], v[168:171], v[96:99]
  v_mfma_f32_16x16x32_bf16 v[100:103], a[72:75], v[172:175], v[100:103]
  ds_read_b128 v[204:207], v19 offset:6144
  v_mfma_f32_16x16x32_bf16 v[104:107], a[76:79], v[172:175], v[104:107]
  v_mfma_f32_16x16x32_bf16 v[108:111], a[80:83], v[172:175], v[108:111]
  s_waitcnt lgkmcnt(4)
  v_mfma_f32_16x16x32_bf16 v[112:115], a[72:75], v[176:179], v[112:115]
  ds_read_b128 v[208:211], v19 offset:8192
  v_mfma_f32_16x16x32_bf16 v[116:119], a[76:79], v[176:179], v[116:119]
  v_mfma_f32_16x16x32_bf16 v[120:123], a[80:83], v[176:179], v[120:123]
  v_mfma_f32_16x16x32_bf16 v[124:127], a[72:75], v[180:183], v[124:127]
  ds_read_b128 v[212:215], v19 offset:10240
  v_mfma_f32_16x16x32_bf16 v[128:131], a[76:79], v[180:183], v[128:131]
  buffer_load_dwordx4 v13, s[8:11], s30 offen offset:3072 lds
  v_mfma_f32_16x16x32_bf16 v[132:135], a[80:83], v[180:183], v[132:135]
  s_add_u32 s30, s30, 128
  s_add_u32 m0, m0, 16384
  v_mfma_f32_16x16x32_bf16 v[136:139], a[72:75], v[184:187], v[136:139]
  ds_read_b128 v[216:219], v19 offset:12288
  v_mfma_f32_16x16x32_bf16 v[140:143], a[76:79], v[184:187], v[140:143]
  s_cmp_lt_u32 m0, s46
  s_cselect_b32 m0, m0, s47
  v_mfma_f32_16x16x32_bf16 v[144:147], a[80:83], v[184:187], v[144:147]
  v_mfma_f32_16x16x32_bf16 v[148:151], a[72:75], v[188:191], v[148:151]
  ds_read_b128 v[220:223], v19 offset:14336
  v_mfma_f32_16x16x32_bf16 v[152:155], a[76:79], v[188:191], v[152:155]
  v_mfma_f32_16x16x32_bf16 v[156:159], a[80:83], v[188:191], v[156:159]
  s_waitcnt vmcnt(13) lgkmcnt(4)
  s_barrier
  v_mfma_f32_16x16x32_bf16 v[64:67], a[84:87], v[192:195], v[64:67]
  ds_read_b128 v[160:163], v18 offset:0
  v_mfma_f32_16x16x32_bf16 v[68:71], a[88:91], v[192:195], v[68:71]
  v_mfma_f32_16x16x32_bf16 v[72:75], a[92:95], v[192:195], v[72:75]
  v_add_u32 v19, s33, v15
  s_add_u32 s33, s33, 16384
  v_mfma_f32_16x16x32_bf16 v[76:79], a[84:87], v[196:199], v[76:79]
  ds_read_b128 v[164:167], v18 offset:2048
  v_mfma_f32_16x16x32_bf16 v[80:83], a[88:91], v[196:199], v[80:83]
  buffer_load_dwordx4 v10, s[8:11], s30 offen offset:0 lds
  v_mfma_f32_16x16x32_bf16 v[84:87], a[92:95], v[196:199], v[84:87]
  s_cmp_lt_u32 s33, 98304
  s_cselect_b32 s33, s33, 0
  v_mfma_f32_16x16x32_bf16 v[88:91], a[84:87], v[200:203], v[88:91]
  ds_read_b128 v[168:171], v18 offset:4096
  v_mfma_f32_16x16x32_bf16 v[92:95], a[88:91], v[200:203], v[92:95]
  v_mfma_f32_16x16x32_bf16 v[96:99], a[92:95], v[200:203], v[96:99]
  v_mfma_f32_16x16x32_bf16 v[100:103], a[84:87], v[204:207], v[100:103]
  ds_read_b128 v[172:175], v18 offset:6144
  v_mfma_f32_16x16x32_bf16 v[104:107], a[88:91], v[204:207], v[104:107]
  v_mfma_f32_16x16x32_bf16 v[108:111], a[92:95], v[204:207], v[108:111]
  s_waitcnt lgkmcnt(4)
  v_mfma_f32_16x16x32_bf16 v[112:115], a[84:87], v[208:211], v[112:115]
  ds_read_b128 v[176:179], v18 offset:8192
  v_mfma_f32_16x16x32_bf16 v[116:119], a[88:91], v[208:211], v[116:119]
  v_mfma_f32_16x16x32_bf16 v[120:123], a[92:95], v[208:211], v[120:123]
  v_mfma_f32_16x16x32_bf16 v[124:127], a[84:87], v[212:215], v[124:127]
  ds_read_b128 v[180:183], v18 offset:10240
  v_mfma_f32_16x16x32_bf16 v[128:131], a[88:91], v[212:215], v[128:131]
  buffer_load_dwordx4 v11, s[8:11], s30 offen offset:1024 lds
  v_mfma_f32_16x16x32_bf16 v[132:135], a[92:95], v[212:215], v[132:135]
  v_mfma_f32_16x16x32_bf16 v[136:139], a[84:87], v[216:219], v[136:139]
  ds_read_b128 v[184:187], v18 offset:12288
  v_mfma_f32_16x16x32_bf16 v[140:143], a[88:91], v[216:219], v[140:143]
  v_mfma_f32_16x16x32_bf16 v[144:147], a[92:95], v[216:219], v[144:147]
  v_mfma_f32_16x16x32_bf16 v[148:151], a[84:87], v[220:223], v[148:151]
  ds_read_b128 v[188:191], v18 offset:14336
  v_mfma_f32_16x16x32_bf16 v[152:155], a[88:91], v[220:223], v[152:155]
  v_mfma_f32_16x16x32_bf16 v[156:159], a[92:95], v[220:223], v[156:159]
  s_waitcnt lgkmcnt(4)
  v_mfma_f32_16x16x32_bf16 v[64:67], a[96:99], v[160:163], v[64:67]
  ds_read_b128 v[192:195], v19 offset:0
  v_mfma_f32_16x16x32_bf16 v[68:71], a[100:103], v[160:163], v[68:71]
  v_add_u32 v18, s33, v14
  v_mfma_f32_16x16x32_bf16 v[72:75], a[104:107], v[160:163], v[72:75]
  v_mfma_f32_16x16x32_bf16 v[76:79], a[96:99], v[164:167], v[76:79]
  ds_read_b128 v[196:199], v19 offset:2048
  v_mfma_f32_16x16x32_bf16 v[80:83], a[100:103], v[164:167], v[80:83]
  buffer_load_dwordx4 v12, s[8:11], s30 offen offset:2048 lds
  v_mfma_f32_16x16x32_bf16 v[84:87], a[104:107], v[164:167], v[84:87]
  v_mfma_f32_16x16x32_bf16 v[88:91], a[96:99], v[168:171], v[88:91]
  ds_read_b128 v[200:203], v19 offset:4096
  v_mfma_f32_16x16x32_bf16 v[92:95], a[100:103], v[168:171], v[92:95]
  v_mfma_f32_16x16x32_bf16 v[96:99], a[104:107], v[168:171], v[96:99]
  v_mfma_f32_16x16x32_bf16 v[100:103], a[96:99], v[172:175], v[100:103]
  ds_read_b128 v[204:207], v19 offset:6144
  v_mfma_f32_16x16x32_bf16 v[104:107], a[100:103], v[172:175], v[104:107]
  v_mfma_f32_16x16x32_bf16 v[108:111], a[104:107], v[172:175], v[108:111]
  s_waitcnt lgkmcnt(4)
  v_mfma_f32_16x16x32_bf16 v[112:115], a[96:99], v[176:179], v[112:115]
  ds_read_b128 v[208:211], v19 offset:8192
  v_mfma_f32_16x16x32_bf16 v[116:119], a[100:103], v[176:179], v[116:119]
  v_mfma_f32_16x16x32_bf16 v[120:123], a[104:107], v[176:179], v[120:123]
  v_mfma_f32_16x16x32_bf16 v[124:127], a[96:99], v[180:183], v[124:127]
  ds_read_b128 v[212:215], v19 offset:10240
  v_mfma_f32_16x16x32_bf16 v[128:131], a[100:103], v[180:183], v[128:131]
  buffer_load_dwordx4 v13, s[8:11], s30 offen offset:3072 lds
  v_mfma_f32_16x16x32_bf16 v[132:135], a[104:107], v[180:183], v[132:135]
  s_add_u32 s30, s30, 128
  s_add_u32 m0, m0, 16384
  v_mfma_f32_16x16x32_bf16 v[136:139], a[96:99], v[184:187], v[136:139]
  ds_read_b128 v[216:219], v19 offset:12288
  v_mfma_f32_16x16x32_bf16 v[140:143], a[100:103], v[184:187], v[140:143]
  s_cmp_lt_u32 m0, s46
  s_cselect_b32 m0, m0, s47
  v_mfma_f32_16x16x32_bf16 v[144:147], a[104:107], v[184:187], v[144:147]
  v_mfma_f32_16x16x32_bf16 v[148:151], a[96:99], v[188:191], v[148:151]
  ds_read_b128 v[220:223], v19 offset:14336
  v_mfma_f32_16x16x32_bf16 v[152:155], a[100:103], v[188:191], v[152:155]
  v_mfma_f32_16x16x32_bf16 v[156:159], a[104:107], v[188:191], v[156:159]
  s_waitcnt vmcnt(13) lgkmcnt(4)
  s_barrier
  v_mfma_f32_16x16x32_bf16 v[64:67], a[108:111], v[192:195], v[64:67]
  ds_read_b128 v[160:163], v18 offset:0
  v_mfma_f32_16x16x32_bf16 v[68:71], a[112:115], v[192:195], v[68:71]
  v_mfma_f32_16x16x32_bf16 v[72:75], a[116:119], v[192:195], v[72:75]
  v_add_u32 v19, s33, v15
  s_add_u32 s33, s33, 16384
  v_mfma_f32_16x16x32_bf16 v[76:79], a[108:111], v[196:199], v[76:79]
  ds_read_b128 v[164:167], v18 offset:2048
  v_mfma_f32_16x16x32_bf16 v[80:83], a[112:115], v[196:199], v[80:83]
  buffer_load_dwordx4 v10, s[8:11], s30 offen offset:0 lds
  v_mfma_f32_16x16x32_bf16 v[84:87], a[116:119], v[196:199], v[84:87]
  s_cmp_lt_u32 s33, 98304
  s_cselect_b32 s33, s33, 0
  v_mfma_f32_16x16x32_bf16 v[88:91], a[108:111], v[200:203], v[88:91]
  ds_read_b128 v[168:171], v18 offset:4096
  v_mfma_f32_16x16x32_bf16 v[92:95], a[112:115], v[200:203], v[92:95]
  v_mfma_f32_16x16x32_bf16 v[96:99], a[116:119], v[200:203], v[96:99]
  v_mfma_f32_16x16x32_bf16 v[100:103], a[108:111], v[204:207], v[100:103]
  ds_read_b128 v[172:175], v18 offset:6144
  v_mfma_f32_16x16x32_bf16 v[104:107], a[112:115], v[204:207], v[104:107]
  v_mfma_f32_16x16x32_bf16 v[108:111], a[116:119], v[204:207], v[108:111]
  s_waitcnt lgkmcnt(4)
  v_mfma_f32_16x16x32_bf16 v[112:115], a[108:111], v[208:211], v[112:115]
  ds_read_b128 v[176:179], v18 offset:8192
  v_mfma_f32_16x16x32_bf16 v[116:119], a[112:115], v[208:211], v[116:119]
  v_mfma_f32_16x16x32_bf16 v[120:123], a[116:119], v[208:211], v[120:123]
  v_mfma_f32_16x16x32_bf16 v[124:127], a[108:111], v[212:215], v[124:127]
  ds_read_b128 v[180:183], v18 offset:10240
  v_mfma_f32_16x16x32_bf16 v[128:131], a[112:115], v[212:215], v[128:131]
  buffer_load_dwordx4 v11, s[8:11], s30 offen offset:1024 lds
  v_mfma_f32_16x16x32_bf16 v[132:135], a[116:119], v[212:215], v[132:135]
  v_mfma_f32_16x16x32_bf16 v[136:139], a[108:111], v[216:219], v[136:139]
  ds_read_b128 v[184:187], v18 offset:12288
  v_mfma_f32_16x16x32_bf16 v[140:143], a[112:115], v[216:219], v[140:143]
  v_mfma_f32_16x16x32_bf16 v[144:147], a[116:119], v[216:219], v[144:147]
  v_mfma_f32_16x16x32_bf16 v[148:151], a[108:111], v[220:223], v[148:151]
  ds_read_b128 v[188:191], v18 offset:14336
  v_mfma_f32_16x16x32_bf16 v[152:155], a[112:115], v[220:223], v[152:155]
  v_mfma_f32_16x16x32_bf16 v[156:159], a[116:119], v[220:223], v[156:159]
  s_waitcnt lgkmcnt(4)
  v_mfma_f32_16x16x32_bf16 v[64:67], a[120:123], v[160:163], v[64:67]
  ds_read_b128 v[192:195], v19 offset:0
  v_mfma_f32_16x16x32_bf16 v[68:71], a[124:127], v[160:163], v[68:71]
  v_add_u32 v18, s33, v14
  v_mfma_f32_16x16x32_bf16 v[72:75], a[128:131], v[160:163], v[72:75]
  v_mfma_f32_16x16x32_bf16 v[76:79], a[120:123], v[164:167], v[76:79]
  ds_read_b128 v[196:199], v19 offset:2048
  v_mfma_f32_16x16x32_bf16 v[80:83], a[124:127], v[164:167], v[80:83]
  buffer_load_dwordx4 v12, s[8:11], s30 offen offset:2048 lds
  v_mfma_f32_16x16x32_bf16 v[84:87], a[128:131], v[164:167], v[84:87]
  v_mfma_f32_16x16x32_bf16 v[88:91], a[120:123], v[168:171], v[88:91]
  ds_read_b128 v[200:203], v19 offset:4096
  v_mfma_f32_16x16x32_bf16 v[92:95], a[124:127], v[168:171], v[92:95]
  v_mfma_f32_16x16x32_bf16 v[96:99], a[128:131], v[168:171], v[96:99]
  v_mfma_f32_16x16x32_bf16 v[100:103], a[120:123], v[172:175], v[100:103]
  ds_read_b128 v[204:207], v19 offset:6144
  v_mfma_f32_16x16x32_bf16 v[104:107], a[124:127], v[172:175], v[104:107]
  v_mfma_f32_16x16x32_bf16 v[108:111], a[128:131], v[172:175], v[108:111]
  s_waitcnt lgkmcnt(4)
  v_mfma_f32_16x16x32_bf16 v[112:115], a[120:123], v[176:179], v[112:115]
  ds_read_b128 v[208:211], v19 offset:8192
  v_mfma_f32_16x16x32_bf16 v[116:119], a[124:127], v[176:179], v[116:119]
  v_mfma_f32_16x16x32_bf16 v[120:123], a[128:131], v[176:179], v[120:123]
  v_mfma_f32_16x16x32_bf16 v[124:127], a[120:123], v[180:183], v[124:127]
  ds_read_b128 v[212:215], v19 offset:10240
  v_mfma_f32_16x16x32_bf16 v[128:131], a[124:127], v[180:183], v[128:131]
  buffer_load_dwordx4 v13, s[8:11], s30 offen offset:3072 lds
  v_mfma_f32_16x16x32_bf16 v[132:135], a[128:131], v[180:183], v[132:135]
  s_add_u32 s30, s30, s25
  s_sub_u32 s30, s30, 1152
  v_mfma_f32_16x16x32_bf16 v[136:139], a[120:123], v[184:187], v[136:139]
  ds_read_b128 v[216:219], v19 offset:12288
  s_mov_b32 s25, 163840
  v_mfma_f32_16x16x32_bf16 v[140:143], a[124:127], v[184:187], v[140:143]
  s_add_u32 m0, m0, 16384
  v_mfma_f32_16x16x32_bf16 v[144:147], a[128:131], v[184:187], v[144:147]
  s_cmp_lt_u32 m0, s46
  s_cselect_b32 m0, m0, s47
  v_mfma_f32_16x16x32_bf16 v[148:151], a[120:123], v[188:191], v[148:151]
  ds_read_b128 v[220:223], v19 offset:14336
  v_mfma_f32_16x16x32_bf16 v[152:155], a[124:127], v[188:191], v[152:155]
  v_mfma_f32_16x16x32_bf16 v[156:159], a[128:131], v[188:191], v[156:159]
  s_waitcnt vmcnt(13) lgkmcnt(4)
  s_barrier
  v_mfma_f32_16x16x32_bf16 v[64:67], a[132:135], v[192:195], v[64:67]
  ds_read_b128 v[160:163], v18 offset:0
  v_mfma_f32_16x16x32_bf16 v[68:71], a[136:139], v[192:195], v[68:71]
  v_mfma_f32_16x16x32_bf16 v[72:75], a[140:143], v[192:195], v[72:75]
  v_add_u32 v19, s33, v15
  s_add_u32 s33, s33, 16384
  v_mfma_f32_16x16x32_bf16 v[76:79], a[132:135], v[196:199], v[76:79]
  ds_read_b128 v[164:167], v18 offset:2048
  v_mfma_f32_16x16x32_bf16 v[80:83], a[136:139], v[196:199], v[80:83]
  buffer_load_dwordx4 v10, s[8:11], s30 offen offset:0 lds
  v_mfma_f32_16x16x32_bf16 v[84:87], a[140:143], v[196:199], v[84:87]
  s_cmp_lt_u32 s33, 98304
  s_cselect_b32 s33, s33, 0
  v_mfma_f32_16x16x32_bf16 v[88:91], a[132:135], v[200:203], v[88:91]
  ds_read_b128 v[168:171], v18 offset:4096
  v_mfma_f32_16x16x32_bf16 v[92:95], a[136:139], v[200:203], v[92:95]
  v_mfma_f32_16x16x32_bf16 v[96:99], a[140:143], v[200:203], v[96:99]
  v_mfma_f32_16x16x32_bf16 v[100:103], a[132:135], v[204:207], v[100:103]
  ds_read_b128 v[172:175], v18 offset:6144
  v_mfma_f32_16x16x32_bf16 v[104:107], a[136:139], v[204:207], v[104:107]
  v_mfma_f32_16x16x32_bf16 v[108:111], a[140:143], v[204:207], v[108:111]
  s_waitcnt lgkmcnt(4)
  v_mfma_f32_16x16x32_bf16 v[112:115], a[132:135], v[208:211], v[112:115]
  ds_read_b128 v[176:179], v18 offset:8192
  v_mfma_f32_16x16x32_bf16 v[116:119], a[136:139], v[208:211], v[116:119]
  v_mfma_f32_16x16x32_bf16 v[120:123], a[140:143], v[208:211], v[120:123]
  v_mfma_f32_16x16x32_bf16 v[124:127], a[132:135], v[212:215], v[124:127]
  ds_read_b128 v[180:183], v18 offset:10240
  v_mfma_f32_16x16x32_bf16 v[128:131], a[136:139], v[212:215], v[128:131]
  buffer_load_dwordx4 v11, s[8:11], s30 offen offset:1024 lds
  v_mfma_f32_16x16x32_bf16 v[132:135], a[140:143], v[212:215], v[132:135]
  v_mfma_f32_16x16x32_bf16 v[136:139], a[132:135], v[216:219], v[136:139]
  ds_read_b128 v[184:187], v18 offset:12288
  v_mfma_f32_16x16x32_bf16 v[140:143], a[136:139], v[216:219], v[140:143]
  v_mfma_f32_16x16x32_bf16 v[144:147], a[140:143], v[216:219], v[144:147]
  v_mfma_f32_16x16x32_bf16 v[148:151], a[132:135], v[220:223], v[148:151]
  ds_read_b128 v[188:191], v18 offset:14336
  v_mfma_f32_16x16x32_bf16 v[152:155], a[136:139], v[220:223], v[152:155]
  v_mfma_f32_16x16x32_bf16 v[156:159], a[140:143], v[220:223], v[156:159]
  s_waitcnt lgkmcnt(4)
  v_mfma_f32_16x16x32_bf16 v[64:67], a[144:147], v[160:163], v[64:67]
  ds_read_b128 v[192:195], v19 offset:0
  v_mfma_f32_16x16x32_bf16 v[68:71], a[148:151], v[160:163], v[68:71]
  v_add_u32 v18, s33, v14
  v_mfma_f32_16x16x32_bf16 v[72:75], a[152:155], v[160:163], v[72:75]
  v_mfma_f32_16x16x32_bf16 v[76:79], a[144:147], v[164:167], v[76:79]
  ds_read_b128 v[196:199], v19 offset:2048
  v_mfma_f32_16x16x32_bf16 v[80:83], a[148:151], v[164:167], v[80:83]
  buffer_load_dwordx4 v12, s[8:11], s30 offen offset:2048 lds
  v_mfma_f32_16x16x32_bf16 v[84:87], a[152:155], v[164:167], v[84:87]
  v_mfma_f32_16x16x32_bf16 v[88:91], a[144:147], v[168:171], v[88:91]
  ds_read_b128 v[200:203], v19 offset:4096
  v_mfma_f32_16x16x32_bf16 v[92:95], a[148:151], v[168:171], v[92:95]
  v_mfma_f32_16x16x32_bf16 v[96:99], a[152:155], v[168:171], v[96:99]
  v_mfma_f32_16x16x32_bf16 v[100:103], a[144:147], v[172:175], v[100:103]
  ds_read_b128 v[204:207], v19 offset:6144
  v_mfma_f32_16x16x32_bf16 v[104:107], a[148:151], v[172:175], v[104:107]
  v_mfma_f32_16x16x32_bf16 v[108:111], a[152:155], v[172:175], v[108:111]
  s_waitcnt lgkmcnt(4)
  v_mfma_f32_16x16x32_bf16 v[112:115], a[144:147], v[176:179], v[112:115]
  ds_read_b128 v[208:211], v19 offset:8192
  v_mfma_f32_16x16x32_bf16 v[116:119], a[148:151], v[176:179], v[116:119]
  v_mfma_f32_16x16x32_bf16 v[120:123], a[152:155], v[176:179], v[120:123]
  v_mfma_f32_16x16x32_bf16 v[124:127], a[144:147], v[180:183], v[124:127]
  ds_read_b128 v[212:215], v19 offset:10240
  v_mfma_f32_16x16x32_bf16 v[128:131], a[148:151], v[180:183], v[128:131]
  buffer_load_dwordx4 v13, s[8:11], s30 offen offset:3072 lds
  v_mfma_f32_16x16x32_bf16 v[132:135], a[152:155], v[180:183], v[132:135]
  s_add_u32 s30, s30, 128
  s_add_u32 m0, m0, 16384
  v_mfma_f32_16x16x32_bf16 v[136:139], a[144:147], v[184:187], v[136:139]
  ds_read_b128 v[216:219], v19 offset:12288
  v_mfma_f32_16x16x32_bf16 v[140:143], a[148:151], v[184:187], v[140:143]
  s_cmp_lt_u32 m0, s46
  s_cselect_b32 m0, m0, s47
  v_mfma_f32_16x16x32_bf16 v[144:147], a[152:155], v[184:187], v[144:147]
  v_mfma_f32_16x16x32_bf16 v[148:151], a[144:147], v[188:191], v[148:151]
  ds_read_b128 v[220:223], v19 offset:14336
  v_mfma_f32_16x16x32_bf16 v[152:155], a[148:151], v[188:191], v[152:155]
  v_mfma_f32_16x16x32_bf16 v[156:159], a[152:155], v[188:191], v[156:159]
  s_waitcnt vmcnt(12) lgkmcnt(4)
  s_barrier
  v_mfma_f32_16x16x32_bf16 v[64:67], a[156:159], v[192:195], v[64:67]
  ds_read_b128 v[160:163], v18 offset:0
  v_mfma_f32_16x16x32_bf16 v[68:71], a[160:163], v[192:195], v[68:71]
  v_readfirstlane_b32 s79, v20
  buffer_load_dword v21, v33, s[72:75], s77 offen sc1
  s_add_u32 s21, s50, 0
  buffer_load_dwordx4 v[36:39], v30, s[16:19], s21 offen offset:0 sc1
  buffer_load_dwordx4 v[40:43], v30, s[16:19], s21 offen offset:1024 sc1
  buffer_load_dwordx4 v[44:47], v30, s[16:19], s21 offen offset:2048 sc1
  buffer_load_dwordx4 v[48:51], v30, s[16:19], s21 offen offset:3072 sc1
  s_add_u32 s21, s50, 4096
  buffer_load_dwordx4 v[52:55], v30, s[16:19], s21 offen offset:0 sc1
  buffer_load_dwordx4 v[56:59], v30, s[16:19], s21 offen offset:1024 sc1
  buffer_load_dwordx4 v[60:63], v30, s[16:19], s21 offen offset:2048 sc1
  buffer_load_dwordx4 v[236:239], v30, s[16:19], s21 offen offset:3072 sc1
  s_add_u32 s21, s50, 8192
  buffer_load_dwordx4 v[240:243], v30, s[16:19], s21 offen offset:0 sc1
  buffer_load_dwordx4 v[244:247], v30, s[16:19], s21 offen offset:1024 sc1
  buffer_load_dwordx4 v[248:251], v30, s[16:19], s21 offen offset:2048 sc1
  buffer_load_dwordx4 v[252:255], v30, s[16:19], s21 offen offset:3072 sc1
  v_mfma_f32_16x16x32_bf16 v[72:75], a[164:167], v[192:195], v[72:75]
  v_add_u32 v19, s33, v15
  s_add_u32 s33, s33, 16384
  v_mfma_f32_16x16x32_bf16 v[76:79], a[156:159], v[196:199], v[76:79]
  ds_read_b128 v[164:167], v18 offset:2048
  v_mfma_f32_16x16x32_bf16 v[80:83], a[160:163], v[196:199], v[80:83]
  buffer_load_dwordx4 v10, s[8:11], s30 offen offset:0 lds
  v_mfma_f32_16x16x32_bf16 v[84:87], a[164:167], v[196:199], v[84:87]
  s_cmp_lt_u32 s33, 98304
  s_cselect_b32 s33, s33, 0
  v_mfma_f32_16x16x32_bf16 v[88:91], a[156:159], v[200:203], v[88:91]
  ds_read_b128 v[168:171], v18 offset:4096
  v_mfma_f32_16x16x32_bf16 v[92:95], a[160:163], v[200:203], v[92:95]
  v_mfma_f32_16x16x32_bf16 v[96:99], a[164:167], v[200:203], v[96:99]
  v_mfma_f32_16x16x32_bf16 v[100:103], a[156:159], v[204:207], v[100:103]
  ds_read_b128 v[172:175], v18 offset:6144
  v_mfma_f32_16x16x32_bf16 v[104:107], a[160:163], v[204:207], v[104:107]
  v_mfma_f32_16x16x32_bf16 v[108:111], a[164:167], v[204:207], v[108:111]
  s_waitcnt lgkmcnt(4)
  v_mfma_f32_16x16x32_bf16 v[112:115], a[156:159], v[208:211], v[112:115]
  ds_read_b128 v[176:179], v18 offset:8192
  v_mfma_f32_16x16x32_bf16 v[116:119], a[160:163], v[208:211], v[116:119]
  v_mfma_f32_16x16x32_bf16 v[120:123], a[164:167], v[208:211], v[120:123]
  v_mfma_f32_16x16x32_bf16 v[124:127], a[156:159], v[212:215], v[124:127]
  ds_read_b128 v[180:183], v18 offset:10240
  v_mfma_f32_16x16x32_bf16 v[128:131], a[160:163], v[212:215], v[128:131]
  buffer_load_dwordx4 v11, s[8:11], s30 offen offset:1024 lds
  v_mfma_f32_16x16x32_bf16 v[132:135], a[164:167], v[212:215], v[132:135]
  v_mfma_f32_16x16x32_bf16 v[136:139], a[156:159], v[216:219], v[136:139]
  ds_read_b128 v[184:187], v18 offset:12288
  v_mfma_f32_16x16x32_bf16 v[140:143], a[160:163], v[216:219], v[140:143]
  v_mfma_f32_16x16x32_bf16 v[144:147], a[164:167], v[216:219], v[144:147]
  v_mfma_f32_16x16x32_bf16 v[148:151], a[156:159], v[220:223], v[148:151]
  ds_read_b128 v[188:191], v18 offset:14336
  v_mfma_f32_16x16x32_bf16 v[152:155], a[160:163], v[220:223], v[152:155]
  v_mfma_f32_16x16x32_bf16 v[156:159], a[164:167], v[220:223], v[156:159]
  s_waitcnt lgkmcnt(4)
  v_mfma_f32_16x16x32_bf16 v[64:67], a[168:171], v[160:163], v[64:67]
  ds_read_b128 v[192:195], v19 offset:0
  v_mfma_f32_16x16x32_bf16 v[68:71], a[172:175], v[160:163], v[68:71]
  v_add_u32 v18, s33, v14
  v_mfma_f32_16x16x32_bf16 v[72:75], a[176:179], v[160:163], v[72:75]
  v_mfma_f32_16x16x32_bf16 v[76:79], a[168:171], v[164:167], v[76:79]
  ds_read_b128 v[196:199], v19 offset:2048
  v_mfma_f32_16x16x32_bf16 v[80:83], a[172:175], v[164:167], v[80:83]
  buffer_load_dwordx4 v12, s[8:11], s30 offen offset:2048 lds
  v_mfma_f32_16x16x32_bf16 v[84:87], a[176:179], v[164:167], v[84:87]
  v_mfma_f32_16x16x32_bf16 v[88:91], a[168:171], v[168:171], v[88:91]
  ds_read_b128 v[200:203], v19 offset:4096
  v_mfma_f32_16x16x32_bf16 v[92:95], a[172:175], v[168:171], v[92:95]
  v_mfma_f32_16x16x32_bf16 v[96:99], a[176:179], v[168:171], v[96:99]
  v_mfma_f32_16x16x32_bf16 v[100:103], a[168:171], v[172:175], v[100:103]
  ds_read_b128 v[204:207], v19 offset:6144
  v_mfma_f32_16x16x32_bf16 v[104:107], a[172:175], v[172:175], v[104:107]
  v_mfma_f32_16x16x32_bf16 v[108:111], a[176:179], v[172:175], v[108:111]
  s_waitcnt lgkmcnt(4)
  v_mfma_f32_16x16x32_bf16 v[112:115], a[168:171], v[176:179], v[112:115]
  ds_read_b128 v[208:211], v19 offset:8192
  v_mfma_f32_16x16x32_bf16 v[116:119], a[172:175], v[176:179], v[116:119]
  v_mfma_f32_16x16x32_bf16 v[120:123], a[176:179], v[176:179], v[120:123]
  v_mfma_f32_16x16x32_bf16 v[124:127], a[168:171], v[180:183], v[124:127]
  ds_read_b128 v[212:215], v19 offset:10240
  v_mfma_f32_16x16x32_bf16 v[128:131], a[172:175], v[180:183], v[128:131]
  buffer_load_dwordx4 v13, s[8:11], s30 offen offset:3072 lds
  v_mfma_f32_16x16x32_bf16 v[132:135], a[176:179], v[180:183], v[132:135]
  s_add_u32 s30, s30, 128
  s_add_u32 m0, m0, 16384
  v_mfma_f32_16x16x32_bf16 v[136:139], a[168:171], v[184:187], v[136:139]
  ds_read_b128 v[216:219], v19 offset:12288
  v_mfma_f32_16x16x32_bf16 v[140:143], a[172:175], v[184:187], v[140:143]
  s_cmp_lt_u32 m0, s46
  s_cselect_b32 m0, m0, s47
  v_mfma_f32_16x16x32_bf16 v[144:147], a[176:179], v[184:187], v[144:147]
  v_mfma_f32_16x16x32_bf16 v[148:151], a[168:171], v[188:191], v[148:151]
  ds_read_b128 v[220:223], v19 offset:14336
  v_mfma_f32_16x16x32_bf16 v[152:155], a[172:175], v[188:191], v[152:155]
  v_mfma_f32_16x16x32_bf16 v[156:159], a[176:179], v[188:191], v[156:159]
  s_waitcnt vmcnt(25) lgkmcnt(4)
  s_barrier
  v_mfma_f32_16x16x32_bf16 v[64:67], a[180:183], v[192:195], v[64:67]
  ds_read_b128 v[160:163], v18 offset:0
  v_mfma_f32_16x16x32_bf16 v[68:71], a[184:187], v[192:195], v[68:71]
  v_mfma_f32_16x16x32_bf16 v[72:75], a[188:191], v[192:195], v[72:75]
  v_add_u32 v19, s33, v15
  s_add_u32 s33, s33, 16384
  v_mfma_f32_16x16x32_bf16 v[76:79], a[180:183], v[196:199], v[76:79]
  ds_read_b128 v[164:167], v18 offset:2048
  v_mfma_f32_16x16x32_bf16 v[80:83], a[184:187], v[196:199], v[80:83]
  buffer_load_dwordx4 v10, s[8:11], s30 offen offset:0 lds
  v_mfma_f32_16x16x32_bf16 v[84:87], a[188:191], v[196:199], v[84:87]
  s_cmp_lt_u32 s33, 98304
  s_cselect_b32 s33, s33, 0
  v_mfma_f32_16x16x32_bf16 v[88:91], a[180:183], v[200:203], v[88:91]
  ds_read_b128 v[168:171], v18 offset:4096
  v_mfma_f32_16x16x32_bf16 v[92:95], a[184:187], v[200:203], v[92:95]
  v_mfma_f32_16x16x32_bf16 v[96:99], a[188:191], v[200:203], v[96:99]
  v_mfma_f32_16x16x32_bf16 v[100:103], a[180:183], v[204:207], v[100:103]
  ds_read_b128 v[172:175], v18 offset:6144
  v_mfma_f32_16x16x32_bf16 v[104:107], a[184:187], v[204:207], v[104:107]
  v_mfma_f32_16x16x32_bf16 v[108:111], a[188:191], v[204:207], v[108:111]
  s_waitcnt lgkmcnt(4)
  v_mfma_f32_16x16x32_bf16 v[112:115], a[180:183], v[208:211], v[112:115]
  ds_read_b128 v[176:179], v18 offset:8192
  v_mfma_f32_16x16x32_bf16 v[116:119], a[184:187], v[208:211], v[116:119]
  v_mfma_f32_16x16x32_bf16 v[120:123], a[188:191], v[208:211], v[120:123]
  v_mfma_f32_16x16x32_bf16 v[124:127], a[180:183], v[212:215], v[124:127]
  ds_read_b128 v[180:183], v18 offset:10240
  v_mfma_f32_16x16x32_bf16 v[128:131], a[184:187], v[212:215], v[128:131]
  buffer_load_dwordx4 v11, s[8:11], s30 offen offset:1024 lds
  v_mfma_f32_16x16x32_bf16 v[132:135], a[188:191], v[212:215], v[132:135]
  v_mfma_f32_16x16x32_bf16 v[136:139], a[180:183], v[216:219], v[136:139]
  ds_read_b128 v[184:187], v18 offset:12288
  v_mfma_f32_16x16x32_bf16 v[140:143], a[184:187], v[216:219], v[140:143]
  v_mfma_f32_16x16x32_bf16 v[144:147], a[188:191], v[216:219], v[144:147]
  v_mfma_f32_16x16x32_bf16 v[148:151], a[180:183], v[220:223], v[148:151]
  ds_read_b128 v[188:191], v18 offset:14336
  v_mfma_f32_16x16x32_bf16 v[152:155], a[184:187], v[220:223], v[152:155]
  v_mfma_f32_16x16x32_bf16 v[156:159], a[188:191], v[220:223], v[156:159]
  s_waitcnt lgkmcnt(4)
  v_mfma_f32_16x16x32_bf16 v[64:67], a[192:195], v[160:163], v[64:67]
  ds_read_b128 v[192:195], v19 offset:0
  v_mfma_f32_16x16x32_bf16 v[68:71], a[196:199], v[160:163], v[68:71]
  v_add_u32 v18, s33, v14
  v_mfma_f32_16x16x32_bf16 v[72:75], a[200:203], v[160:163], v[72:75]
  v_mfma_f32_16x16x32_bf16 v[76:79], a[192:195], v[164:167], v[76:79]
  ds_read_b128 v[196:199], v19 offset:2048
  v_mfma_f32_16x16x32_bf16 v[80:83], a[196:199], v[164:167], v[80:83]
  buffer_load_dwordx4 v12, s[8:11], s30 offen offset:2048 lds
  v_mfma_f32_16x16x32_bf16 v[84:87], a[200:203], v[164:167], v[84:87]
  v_mfma_f32_16x16x32_bf16 v[88:91], a[192:195], v[168:171], v[88:91]
  ds_read_b128 v[200:203], v19 offset:4096
  v_mfma_f32_16x16x32_bf16 v[92:95], a[196:199], v[168:171], v[92:95]
  v_mfma_f32_16x16x32_bf16 v[96:99], a[200:203], v[168:171], v[96:99]
  v_mfma_f32_16x16x32_bf16 v[100:103], a[192:195], v[172:175], v[100:103]
  ds_read_b128 v[204:207], v19 offset:6144
  v_mfma_f32_16x16x32_bf16 v[104:107], a[196:199], v[172:175], v[104:107]
  v_mfma_f32_16x16x32_bf16 v[108:111], a[200:203], v[172:175], v[108:111]
  s_waitcnt lgkmcnt(4)
  v_mfma_f32_16x16x32_bf16 v[112:115], a[192:195], v[176:179], v[112:115]
  ds_read_b128 v[208:211], v19 offset:8192
  v_mfma_f32_16x16x32_bf16 v[116:119], a[196:199], v[176:179], v[116:119]
  v_mfma_f32_16x16x32_bf16 v[120:123], a[200:203], v[176:179], v[120:123]
  v_mfma_f32_16x16x32_bf16 v[124:127], a[192:195], v[180:183], v[124:127]
  ds_read_b128 v[212:215], v19 offset:10240
  v_mfma_f32_16x16x32_bf16 v[128:131], a[196:199], v[180:183], v[128:131]
  buffer_load_dwordx4 v13, s[8:11], s30 offen offset:3072 lds
  v_mfma_f32_16x16x32_bf16 v[132:135], a[200:203], v[180:183], v[132:135]
  s_add_u32 s30, s30, 128
  s_add_u32 m0, m0, 16384
  v_mfma_f32_16x16x32_bf16 v[136:139], a[192:195], v[184:187], v[136:139]
  ds_read_b128 v[216:219], v19 offset:12288
  v_mfma_f32_16x16x32_bf16 v[140:143], a[196:199], v[184:187], v[140:143]
  s_cmp_lt_u32 m0, s46
  s_cselect_b32 m0, m0, s47
  v_mfma_f32_16x16x32_bf16 v[144:147], a[200:203], v[184:187], v[144:147]
  v_mfma_f32_16x16x32_bf16 v[148:151], a[192:195], v[188:191], v[148:151]
  ds_read_b128 v[220:223], v19 offset:14336
  v_mfma_f32_16x16x32_bf16 v[152:155], a[196:199], v[188:191], v[152:155]
  v_mfma_f32_16x16x32_bf16 v[156:159], a[200:203], v[188:191], v[156:159]
  s_waitcnt vmcnt(25) lgkmcnt(4)
  s_barrier
  v_mfma_f32_16x16x32_bf16 v[64:67], a[204:207], v[192:195], v[64:67]
  ds_read_b128 v[160:163], v18 offset:0
  v_mfma_f32_16x16x32_bf16 v[68:71], a[208:211], v[192:195], v[68:71]
  v_mfma_f32_16x16x32_bf16 v[72:75], a[212:215], v[192:195], v[72:75]
  v_add_u32 v19, s33, v15
  s_add_u32 s33, s33, 16384
  v_mfma_f32_16x16x32_bf16 v[76:79], a[204:207], v[196:199], v[76:79]
  ds_read_b128 v[164:167], v18 offset:2048
  v_mfma_f32_16x16x32_bf16 v[80:83], a[208:211], v[196:199], v[80:83]
  buffer_load_dwordx4 v10, s[8:11], s30 offen offset:0 lds
  v_mfma_f32_16x16x32_bf16 v[84:87], a[212:215], v[196:199], v[84:87]
  s_cmp_lt_u32 s33, 98304
  s_cselect_b32 s33, s33, 0
  v_mfma_f32_16x16x32_bf16 v[88:91], a[204:207], v[200:203], v[88:91]
  ds_read_b128 v[168:171], v18 offset:4096
  v_mfma_f32_16x16x32_bf16 v[92:95], a[208:211], v[200:203], v[92:95]
  v_mfma_f32_16x16x32_bf16 v[96:99], a[212:215], v[200:203], v[96:99]
  v_mfma_f32_16x16x32_bf16 v[100:103], a[204:207], v[204:207], v[100:103]
  ds_read_b128 v[172:175], v18 offset:6144
  v_mfma_f32_16x16x32_bf16 v[104:107], a[208:211], v[204:207], v[104:107]
  v_mfma_f32_16x16x32_bf16 v[108:111], a[212:215], v[204:207], v[108:111]
  s_waitcnt lgkmcnt(4)
  v_mfma_f32_16x16x32_bf16 v[112:115], a[204:207], v[208:211], v[112:115]
  ds_read_b128 v[176:179], v18 offset:8192
  v_mfma_f32_16x16x32_bf16 v[116:119], a[208:211], v[208:211], v[116:119]
  v_mfma_f32_16x16x32_bf16 v[120:123], a[212:215], v[208:211], v[120:123]
  v_mfma_f32_16x16x32_bf16 v[124:127], a[204:207], v[212:215], v[124:127]
  ds_read_b128 v[180:183], v18 offset:10240
  v_mfma_f32_16x16x32_bf16 v[128:131], a[208:211], v[212:215], v[128:131]
  buffer_load_dwordx4 v11, s[8:11], s30 offen offset:1024 lds
  v_mfma_f32_16x16x32_bf16 v[132:135], a[212:215], v[212:215], v[132:135]
  v_mfma_f32_16x16x32_bf16 v[136:139], a[204:207], v[216:219], v[136:139]
  ds_read_b128 v[184:187], v18 offset:12288
  v_mfma_f32_16x16x32_bf16 v[140:143], a[208:211], v[216:219], v[140:143]
  v_mfma_f32_16x16x32_bf16 v[144:147], a[212:215], v[216:219], v[144:147]
  v_mfma_f32_16x16x32_bf16 v[148:151], a[204:207], v[220:223], v[148:151]
  ds_read_b128 v[188:191], v18 offset:14336
  v_mfma_f32_16x16x32_bf16 v[152:155], a[208:211], v[220:223], v[152:155]
  v_mfma_f32_16x16x32_bf16 v[156:159], a[212:215], v[220:223], v[156:159]
  s_waitcnt lgkmcnt(4)
  v_mfma_f32_16x16x32_bf16 v[64:67], a[216:219], v[160:163], v[64:67]
  ds_read_b128 v[192:195], v19 offset:0
  v_mfma_f32_16x16x32_bf16 v[68:71], a[220:223], v[160:163], v[68:71]
  v_add_u32 v18, s33, v14
  v_mfma_f32_16x16x32_bf16 v[72:75], a[224:227], v[160:163], v[72:75]
  v_mfma_f32_16x16x32_bf16 v[76:79], a[216:219], v[164:167], v[76:79]
  ds_read_b128 v[196:199], v19 offset:2048
  v_mfma_f32_16x16x32_bf16 v[80:83], a[220:223], v[164:167], v[80:83]
  buffer_load_dwordx4 v12, s[8:11], s30 offen offset:2048 lds
  v_mfma_f32_16x16x32_bf16 v[84:87], a[224:227], v[164:167], v[84:87]
  v_mfma_f32_16x16x32_bf16 v[88:91], a[216:219], v[168:171], v[88:91]
  ds_read_b128 v[200:203], v19 offset:4096
  v_mfma_f32_16x16x32_bf16 v[92:95], a[220:223], v[168:171], v[92:95]
  v_mfma_f32_16x16x32_bf16 v[96:99], a[224:227], v[168:171], v[96:99]
  v_mfma_f32_16x16x32_bf16 v[100:103], a[216:219], v[172:175], v[100:103]
  ds_read_b128 v[204:207], v19 offset:6144
  v_mfma_f32_16x16x32_bf16 v[104:107], a[220:223], v[172:175], v[104:107]
  v_mfma_f32_16x16x32_bf16 v[108:111], a[224:227], v[172:175], v[108:111]
  s_waitcnt lgkmcnt(4)
  v_mfma_f32_16x16x32_bf16 v[112:115], a[216:219], v[176:179], v[112:115]
  ds_read_b128 v[208:211], v19 offset:8192
  v_mfma_f32_16x16x32_bf16 v[116:119], a[220:223], v[176:179], v[116:119]
  v_mfma_f32_16x16x32_bf16 v[120:123], a[224:227], v[176:179], v[120:123]
  v_mfma_f32_16x16x32_bf16 v[124:127], a[216:219], v[180:183], v[124:127]
  ds_read_b128 v[212:215], v19 offset:10240
  v_mfma_f32_16x16x32_bf16 v[128:131], a[220:223], v[180:183], v[128:131]
  buffer_load_dwordx4 v13, s[8:11], s30 offen offset:3072 lds
  v_mfma_f32_16x16x32_bf16 v[132:135], a[224:227], v[180:183], v[132:135]
  s_add_u32 s30, s30, 128
  s_add_u32 m0, m0, 16384
  v_mfma_f32_16x16x32_bf16 v[136:139], a[216:219], v[184:187], v[136:139]
  ds_read_b128 v[216:219], v19 offset:12288
  v_mfma_f32_16x16x32_bf16 v[140:143], a[220:223], v[184:187], v[140:143]
  s_cmp_lt_u32 m0, s46
  s_cselect_b32 m0, m0, s47
  v_mfma_f32_16x16x32_bf16 v[144:147], a[224:227], v[184:187], v[144:147]
  v_mfma_f32_16x16x32_bf16 v[148:151], a[216:219], v[188:191], v[148:151]
  ds_read_b128 v[220:223], v19 offset:14336
  v_mfma_f32_16x16x32_bf16 v[152:155], a[220:223], v[188:191], v[152:155]
  v_mfma_f32_16x16x32_bf16 v[156:159], a[224:227], v[188:191], v[156:159]
  s_waitcnt vmcnt(25) lgkmcnt(4)
  s_barrier
  v_mfma_f32_16x16x32_bf16 v[64:67], a[228:231], v[192:195], v[64:67]
  ds_read_b128 v[160:163], v18 offset:0
  v_mfma_f32_16x16x32_bf16 v[68:71], a[232:235], v[192:195], v[68:71]
  v_mfma_f32_16x16x32_bf16 v[72:75], a[236:239], v[192:195], v[72:75]
  v_add_u32 v19, s33, v15
  s_add_u32 s33, s33, 16384
  v_mfma_f32_16x16x32_bf16 v[76:79], a[228:231], v[196:199], v[76:79]
  ds_read_b128 v[164:167], v18 offset:2048
  v_cvt_pk_bf16_f32 v224, v64, v65
  v_cvt_pk_bf16_f32 v225, v66, v67
  v_mfma_f32_16x16x32_bf16 v[80:83], a[232:235], v[196:199], v[80:83]
  buffer_load_dwordx4 v10, s[8:11], s30 offen offset:0 lds
  v_cvt_pk_bf16_f32 v226, v68, v69
  v_cvt_pk_bf16_f32 v227, v70, v71
  v_mfma_f32_16x16x32_bf16 v[84:87], a[236:239], v[196:199], v[84:87]
  s_cmp_lt_u32 s33, 98304
  s_cselect_b32 s33, s33, 0
  v_cvt_pk_bf16_f32 v228, v72, v73
  v_cvt_pk_bf16_f32 v229, v74, v75
  v_mfma_f32_16x16x32_bf16 v[88:91], a[228:231], v[200:203], v[88:91]
  ds_read_b128 v[168:171], v18 offset:4096
  ds_write_b64 v22, v[224:225] offset:0
  ds_write_b64 v22, v[226:227] offset:8
  ds_write_b64 v22, v[228:229] offset:16
  v_mfma_f32_16x16x32_bf16 v[92:95], a[232:235], v[200:203], v[92:95]
  v_cvt_pk_bf16_f32 v230, v76, v77
  v_cvt_pk_bf16_f32 v231, v78, v79
  v_cvt_pk_bf16_f32 v232, v80, v81
  v_cvt_pk_bf16_f32 v233, v82, v83
  v_mfma_f32_16x16x32_bf16 v[96:99], a[236:239], v[200:203], v[96:99]
  v_cvt_pk_bf16_f32 v234, v84, v85
  v_cvt_pk_bf16_f32 v235, v86, v87
  ds_write_b64 v22, v[230:231] offset:6400
  ds_write_b64 v22, v[232:233] offset:6408
  v_mfma_f32_16x16x32_bf16 v[100:103], a[228:231], v[204:207], v[100:103]
  ds_read_b128 v[172:175], v18 offset:6144
  ds_write_b64 v22, v[234:235] offset:6416
  v_cvt_pk_bf16_f32 v224, v88, v89
  v_cvt_pk_bf16_f32 v225, v90, v91
  v_mfma_f32_16x16x32_bf16 v[104:107], a[232:235], v[204:207], v[104:107]
  v_cvt_pk_bf16_f32 v226, v92, v93
  v_cvt_pk_bf16_f32 v227, v94, v95
  v_mfma_f32_16x16x32_bf16 v[108:111], a[236:239], v[204:207], v[108:111]
  s_waitcnt lgkmcnt(10)
  v_cvt_pk_bf16_f32 v228, v96, v97
  v_cvt_pk_bf16_f32 v229, v98, v99
  ds_write_b64 v22, v[224:225] offset:12800
  v_mfma_f32_16x16x32_bf16 v[112:115], a[228:231], v[208:211], v[112:115]
  ds_read_b128 v[176:179], v18 offset:8192
  ds_write_b64 v22, v[226:227] offset:12808
  ds_write_b64 v22, v[228:229] offset:12816
  v_cvt_pk_bf16_f32 v230, v100, v101
  v_mfma_f32_16x16x32_bf16 v[116:119], a[232:235], v[208:211], v[116:119]
  v_cvt_pk_bf16_f32 v231, v102, v103
  v_cvt_pk_bf16_f32 v232, v104, v105
  v_cvt_pk_bf16_f32 v233, v106, v107
  v_mfma_f32_16x16x32_bf16 v[120:123], a[236:239], v[208:211], v[120:123]
  v_cvt_pk_bf16_f32 v234, v108, v109
  v_cvt_pk_bf16_f32 v235, v110, v111
  ds_write_b64 v22, v[230:231] offset:19200
  ds_write_b64 v22, v[232:233] offset:19208
  v_mfma_f32_16x16x32_bf16 v[124:127], a[228:231], v[212:215], v[124:127]
  ds_read_b128 v[180:183], v18 offset:10240
  ds_write_b64 v22, v[234:235] offset:19216
  v_cvt_pk_bf16_f32 v224, v112, v113
  v_cvt_pk_bf16_f32 v225, v114, v115
  v_mfma_f32_16x16x32_bf16 v[128:131], a[232:235], v[212:215], v[128:131]
  buffer_load_dwordx4 v11, s[8:11], s30 offen offset:1024 lds
  v_cvt_pk_bf16_f32 v226, v116, v117
  v_cvt_pk_bf16_f32 v227, v118, v119
  v_mfma_f32_16x16x32_bf16 v[132:135], a[236:239], v[212:215], v[132:135]
  v_cvt_pk_bf16_f32 v228, v120, v121
  v_cvt_pk_bf16_f32 v229, v122, v123
  ds_write_b64 v22, v[224:225] offset:25600
  ds_write_b64 v22, v[226:227] offset:25608
  v_mfma_f32_16x16x32_bf16 v[136:139], a[228:231], v[216:219], v[136:139]
  ds_read_b128 v[184:187], v18 offset:12288
  ds_write_b64 v22, v[228:229] offset:25616
  v_cvt_pk_bf16_f32 v230, v124, v125
  v_cvt_pk_bf16_f32 v231, v126, v127
  v_mfma_f32_16x16x32_bf16 v[140:143], a[232:235], v[216:219], v[140:143]
  v_cvt_pk_bf16_f32 v232, v128, v129
  v_cvt_pk_bf16_f32 v233, v130, v131
  v_mfma_f32_16x16x32_bf16 v[144:147], a[236:239], v[216:219], v[144:147]
  v_cvt_pk_bf16_f32 v234, v132, v133
  v_cvt_pk_bf16_f32 v235, v134, v135
  ds_write_b64 v22, v[230:231] offset:32000
  ds_write_b64 v22, v[232:233] offset:32008
  v_mfma_f32_16x16x32_bf16 v[148:151], a[228:231], v[220:223], v[148:151]
  ds_read_b128 v[188:191], v18 offset:14336
  ds_write_b64 v22, v[234:235] offset:32016
  v_cvt_pk_bf16_f32 v224, v136, v137
  v_cvt_pk_bf16_f32 v225, v138, v139
  v_mfma_f32_16x16x32_bf16 v[152:155], a[232:235], v[220:223], v[152:155]
  v_cvt_pk_bf16_f32 v226, v140, v141
  v_cvt_pk_bf16_f32 v227, v142, v143
  v_mfma_f32_16x16x32_bf16 v[156:159], a[236:239], v[220:223], v[156:159]
  v_cvt_pk_bf16_f32 v228, v144, v145
  v_cvt_pk_bf16_f32 v229, v146, v147
  ds_write_b64 v22, v[224:225] offset:38400
  ds_write_b64 v22, v[226:227] offset:38408
  ds_write_b64 v22, v[228:229] offset:38416
  s_nop 2
  v_cvt_pk_bf16_f32 v230, v148, v149
  v_cvt_pk_bf16_f32 v231, v150, v151
  v_cvt_pk_bf16_f32 v232, v152, v153
  v_cvt_pk_bf16_f32 v233, v154, v155
  v_cvt_pk_bf16_f32 v234, v156, v157
  v_cvt_pk_bf16_f32 v235, v158, v159
  ds_write_b64 v22, v[230:231] offset:44800
  ds_write_b64 v22, v[232:233] offset:44808
  ds_write_b64 v22, v[234:235] offset:44816
  s_lshl_b32 s43, s42, 2
  s_add_u32 s43, s43, s20
  s_mul_i32 s43, s43, 12288
  s_add_u32 s43, s43, 5242880
  s_cmp_lg_u32 s26, 16
  s_cbranch_scc1 qbs_225
  s_waitcnt lgkmcnt(0)
  s_barrier
  ds_read_b128 v[64:67], v29 offset:0
  ds_read_b128 v[68:71], v29 offset:64
  ds_read_b128 v[72:75], v29 offset:128
  ds_read_b128 v[76:79], v29 offset:192
  ds_read_b128 v[80:83], v29 offset:256
  ds_read_b128 v[84:87], v29 offset:320
  ds_read_b128 v[88:91], v29 offset:6400
  ds_read_b128 v[92:95], v29 offset:6464
  ds_read_b128 v[96:99], v29 offset:6528
  ds_read_b128 v[100:103], v29 offset:6592
  ds_read_b128 v[104:107], v29 offset:6656
  ds_read_b128 v[108:111], v29 offset:6720
  s_waitcnt lgkmcnt(0)
  s_add_u32 s21, s43, 0
  buffer_store_dwordx4 v[64:67], v30, s[56:59], s21 offen offset:0 sc1
  buffer_store_dwordx4 v[68:71], v30, s[56:59], s21 offen offset:1024 sc1
  buffer_store_dwordx4 v[72:75], v30, s[56:59], s21 offen offset:2048 sc1
  buffer_store_dwordx4 v[76:79], v30, s[56:59], s21 offen offset:3072 sc1
  s_add_u32 s21, s43, 4096
  buffer_store_dwordx4 v[80:83], v30, s[56:59], s21 offen offset:0 sc1
  buffer_store_dwordx4 v[84:87], v30, s[56:59], s21 offen offset:1024 sc1
  buffer_store_dwordx4 v[88:91], v30, s[56:59], s21 offen offset:2048 sc1
  buffer_store_dwordx4 v[92:95], v30, s[56:59], s21 offen offset:3072 sc1
  s_add_u32 s21, s43, 8192
  buffer_store_dwordx4 v[96:99], v30, s[56:59], s21 offen offset:0 sc1
  buffer_store_dwordx4 v[100:103], v30, s[56:59], s21 offen offset:1024 sc1
  buffer_store_dwordx4 v[104:107], v30, s[56:59], s21 offen offset:2048 sc1
  buffer_store_dwordx4 v[108:111], v30, s[56:59], s21 offen offset:3072 sc1
  s_waitcnt vmcnt(0)
  s_barrier
  s_lshl_b32 s21, s42, 7
  s_add_u32 s21, s21, 111616
  s_cmp_lg_u32 s20, 0
  s_cbranch_scc1 af_226
  v_mov_b32 v4, 0
  v_mov_b32 v5, 1
  s_mov_b64 exec, 1
  buffer_atomic_add v5, v4, s[72:75], s21 offen sc1
  s_mov_b64 exec, -1
  s_nop 1
af_226:
  s_branch qbe_224
qbs_225:
  s_add_u32 s23, s49, 1
  s_waitcnt vmcnt(12)
  v_cmp_gt_u32 vcc, s23, v21
  s_mov_b32 s80, 0
  s_nop 0
  s_cbranch_vccnz qk_228
  s_mov_b32 s80, 1
  buffer_load_dwordx4 v[132:135], v31, s[52:55], s51 offen offset:0 sc1
  buffer_load_dwordx4 v[136:139], v31, s[52:55], s51 offen offset:512 sc1
  buffer_load_dwordx4 v[140:143], v31, s[52:55], s51 offen offset:1024 sc1
  buffer_load_dwordx4 v[144:147], v31, s[52:55], s51 offen offset:1536 sc1
  buffer_load_dwordx4 v[148:151], v31, s[52:55], s51 offen offset:2048 sc1
  buffer_load_dwordx4 v[152:155], v31, s[52:55], s51 offen offset:2560 sc1
qk_228:
  s_cmp_ge_u32 s79, 8
  s_cbranch_scc1 qk_227
  v_mov_b32 v156, 0
  s_mov_b32 s101, 0
wf_229:
  buffer_load_dword v157, v156, s[72:75], s76 offen sc1
  s_add_u32 s101, s101, 1
  s_cmp_gt_u32 s101, 131072
  s_cbranch_scc1 main_end
  s_waitcnt vmcnt(0)
  v_readfirstlane_b32 s100, v157
  s_cmp_ge_u32 s100, 8
  s_cbranch_scc1 wf_230
  s_sleep 2
  s_branch wf_229
wf_230:
  s_add_u32 s21, s50, 0
  buffer_load_dwordx4 v[36:39], v30, s[16:19], s21 offen offset:0 sc1
  buffer_load_dwordx4 v[40:43], v30, s[16:19], s21 offen offset:1024 sc1
  buffer_load_dwordx4 v[44:47], v30, s[16:19], s21 offen offset:2048 sc1
  buffer_load_dwordx4 v[48:51], v30, s[16:19], s21 offen offset:3072 sc1
  s_add_u32 s21, s50, 4096
  buffer_load_dwordx4 v[52:55], v30, s[16:19], s21 offen offset:0 sc1
  buffer_load_dwordx4 v[56:59], v30, s[16:19], s21 offen offset:1024 sc1
  buffer_load_dwordx4 v[60:63], v30, s[16:19], s21 offen offset:2048 sc1
  buffer_load_dwordx4 v[236:239], v30, s[16:19], s21 offen offset:3072 sc1
  s_add_u32 s21, s50, 8192
  buffer_load_dwordx4 v[240:243], v30, s[16:19], s21 offen offset:0 sc1
  buffer_load_dwordx4 v[244:247], v30, s[16:19], s21 offen offset:1024 sc1
  buffer_load_dwordx4 v[248:251], v30, s[16:19], s21 offen offset:2048 sc1
  buffer_load_dwordx4 v[252:255], v30, s[16:19], s21 offen offset:3072 sc1
qk_227:
  s_waitcnt lgkmcnt(0)
  s_barrier
  ds_read_b128 v[64:67], v29 offset:0
  ds_read_b128 v[68:71], v29 offset:64
  ds_read_b128 v[72:75], v29 offset:128
  ds_read_b128 v[76:79], v29 offset:192
  ds_read_b128 v[80:83], v29 offset:256
  ds_read_b128 v[84:87], v29 offset:320
  ds_read_b128 v[88:91], v29 offset:6400
  ds_read_b128 v[92:95], v29 offset:6464
  ds_read_b128 v[96:99], v29 offset:6528
  ds_read_b128 v[100:103], v29 offset:6592
  ds_read_b128 v[104:107], v29 offset:6656
  ds_read_b128 v[108:111], v29 offset:6720
  s_waitcnt lgkmcnt(0) vmcnt(6)
  s_cmp_eq_u32 s80, 1
  s_cselect_b32 s21, s79, 0
  s_cmp_ge_u32 s21, 8
  s_cbranch_scc1 qw_231
  s_waitcnt vmcnt(0)
qw_231:
  v_mfma_f32_16x16x32_bf16 v[112:115], v[36:39], v[64:67], 0
  v_mfma_f32_16x16x32_bf16 v[120:123], v[36:39], v[88:91], 0
  v_mfma_f32_16x16x32_bf16 v[124:127], v[60:63], v[88:91], 0
  v_mfma_f32_16x16x32_bf16 v[112:115], v[40:43], v[68:71], v[112:115]
  v_mfma_f32_16x16x32_bf16 v[120:123], v[40:43], v[92:95], v[120:123]
  v_mfma_f32_16x16x32_bf16 v[124:127], v[236:239], v[92:95], v[124:127]
  v_mfma_f32_16x16x32_bf16 v[112:115], v[44:47], v[72:75], v[112:115]
  v_mfma_f32_16x16x32_bf16 v[120:123], v[44:47], v[96:99], v[120:123]
  v_mfma_f32_16x16x32_bf16 v[124:127], v[240:243], v[96:99], v[124:127]
  v_mfma_f32_16x16x32_bf16 v[112:115], v[48:51], v[76:79], v[112:115]
  v_mfma_f32_16x16x32_bf16 v[120:123], v[48:51], v[100:103], v[120:123]
  v_mfma_f32_16x16x32_bf16 v[124:127], v[244:247], v[100:103], v[124:127]
  v_mfma_f32_16x16x32_bf16 v[112:115], v[52:55], v[80:83], v[112:115]
  v_mfma_f32_16x16x32_bf16 v[120:123], v[52:55], v[104:107], v[120:123]
  v_mfma_f32_16x16x32_bf16 v[124:127], v[248:251], v[104:107], v[124:127]
  v_mfma_f32_16x16x32_bf16 v[112:115], v[56:59], v[84:87], v[112:115]
  v_mfma_f32_16x16x32_bf16 v[120:123], v[56:59], v[108:111], v[120:123]
  v_mfma_f32_16x16x32_bf16 v[124:127], v[252:255], v[108:111], v[124:127]
  s_cmp_eq_u32 s80, 1
  s_cbranch_scc1 qm_232
  s_add_u32 s23, s49, 1
  s_mov_b32 s101, 0
wm_233:
  buffer_load_dword v156, v33, s[72:75], s77 offen sc1
  s_add_u32 s101, s101, 1
  s_cmp_gt_u32 s101, 131072
  s_cbranch_scc1 main_end
  s_waitcnt vmcnt(0)
  v_cmp_gt_u32 vcc, s23, v156
  v_readfirstlane_b32 s100, v156
  s_nop 0
  s_cbranch_vccz wm_234
  s_sleep 4
  s_add_u32 s100, s100, 2
  s_cmp_ge_u32 s100, s23
  s_cbranch_scc1 wm_233
  s_sleep 90
  s_branch wm_233
wm_234:
  buffer_load_dwordx4 v[132:135], v31, s[52:55], s51 offen offset:0 sc1
  buffer_load_dwordx4 v[136:139], v31, s[52:55], s51 offen offset:512 sc1
  buffer_load_dwordx4 v[140:143], v31, s[52:55], s51 offen offset:1024 sc1
  buffer_load_dwordx4 v[144:147], v31, s[52:55], s51 offen offset:1536 sc1
  buffer_load_dwordx4 v[148:151], v31, s[52:55], s51 offen offset:2048 sc1
  buffer_load_dwordx4 v[152:155], v31, s[52:55], s51 offen offset:2560 sc1
qm_232:
  s_waitcnt vmcnt(0)
  v_mfma_f32_16x16x32_bf16 v[116:119], v[132:135], v[64:67], 0
  v_mfma_f32_16x16x32_bf16 v[128:131], v[132:135], v[88:91], 0
  v_mfma_f32_16x16x32_bf16 v[116:119], v[136:139], v[68:71], v[116:119]
  v_mfma_f32_16x16x32_bf16 v[128:131], v[136:139], v[92:95], v[128:131]
  v_mfma_f32_16x16x32_bf16 v[116:119], v[140:143], v[72:75], v[116:119]
  v_mfma_f32_16x16x32_bf16 v[128:131], v[140:143], v[96:99], v[128:131]
  v_mfma_f32_16x16x32_bf16 v[116:119], v[144:147], v[76:79], v[116:119]
  v_mfma_f32_16x16x32_bf16 v[128:131], v[144:147], v[100:103], v[128:131]
  v_mfma_f32_16x16x32_bf16 v[116:119], v[148:151], v[80:83], v[116:119]
  v_mfma_f32_16x16x32_bf16 v[128:131], v[148:151], v[104:107], v[128:131]
  v_mfma_f32_16x16x32_bf16 v[116:119], v[152:155], v[84:87], v[116:119]
  v_mfma_f32_16x16x32_bf16 v[128:131], v[152:155], v[108:111], v[128:131]
  s_lshl_b32 s21, s49, 5
  s_add_u32 s21, s21, s42
  s_mul_i32 s81, s21, 2560
  s_lshl_b32 s82, s49, 3
  s_and_b32 s21, s42, 7
  s_add_u32 s82, s82, s21
  s_lshl_b32 s82, s82, 7
  s_add_u32 s82, s82, 22528
  v_cndmask_b32 v112, v34, v112, s[64:65]
  v_cndmask_b32 v124, v34, v124, s[64:65]
  v_cndmask_b32 v113, v34, v113, s[66:67]
  v_cndmask_b32 v125, v34, v125, s[66:67]
  v_cndmask_b32 v114, v34, v114, s[68:69]
  v_cndmask_b32 v126, v34, v126, s[68:69]
  v_cndmask_b32 v115, v34, v115, s[70:71]
  v_cndmask_b32 v127, v34, v127, s[70:71]
  v_max3_f32 v156, v112, v113, v114
  v_max3_f32 v156, v156, v115, v116
  v_max3_f32 v156, v156, v117, v118
  v_max_f32 v156, v156, v119
  v_mov_b32 v157, v156
  s_nop 1
  v_permlane32_swap_b32 v156, v157
  v_max_f32 v156, v156, v157
  v_mov_b32 v157, v156
  s_nop 1
  v_permlane16_swap_b32 v156, v157
  v_max_f32 v156, v156, v157
  v_mul_f32 v156, s83, v156
  v_fma_f32 v112, v112, s83, -v156
  v_fma_f32 v113, v113, s83, -v156
  v_fma_f32 v114, v114, s83, -v156
  v_fma_f32 v115, v115, s83, -v156
  v_fma_f32 v116, v116, s83, -v156
  v_fma_f32 v117, v117, s83, -v156
  v_fma_f32 v118, v118, s83, -v156
  v_fma_f32 v119, v119, s83, -v156
  v_exp_f32 v112, v112
  v_exp_f32 v113, v113
  v_exp_f32 v114, v114
  v_exp_f32 v115, v115
  v_exp_f32 v116, v116
  v_exp_f32 v117, v117
  v_exp_f32 v118, v118
  v_exp_f32 v119, v119
  s_nop 0
  v_add_f32 v156, v116, v117
  v_add_f32 v156, v156, v118
  v_add_f32 v156, v156, v119
  v_cndmask_b32 v156, 0, v156, s[60:61]
  v_add_f32 v156, v156, v112
  v_add_f32 v156, v156, v113
  v_add_f32 v156, v156, v114
  v_add_f32 v156, v156, v115
  v_mov_b32 v157, v156
  s_nop 1
  v_permlane32_swap_b32 v156, v157
  v_add_f32 v156, v156, v157
  v_mov_b32 v157, v156
  s_nop 1
  v_permlane16_swap_b32 v156, v157
  v_add_f32 v156, v156, v157
  v_rcp_f32 v156, v156
  s_nop 0
  v_mul_f32 v112, v112, v156
  v_mul_f32 v113, v113, v156
  v_mul_f32 v114, v114, v156
  v_mul_f32 v115, v115, v156
  v_mul_f32 v116, v116, v156
  v_mul_f32 v117, v117, v156
  v_mul_f32 v118, v118, v156
  v_mul_f32 v119, v119, v156
  v_max3_f32 v156, v120, v121, v122
  v_max3_f32 v156, v156, v123, v124
  v_max3_f32 v156, v156, v125, v126
  v_max3_f32 v156, v156, v127, v128
  v_max3_f32 v156, v156, v129, v130
  v_max_f32 v156, v156, v131
  v_mov_b32 v157, v156
  s_nop 1
  v_permlane32_swap_b32 v156, v157
  v_max_f32 v156, v156, v157
  v_mov_b32 v157, v156
  s_nop 1
  v_permlane16_swap_b32 v156, v157
  v_max_f32 v156, v156, v157
  v_mul_f32 v156, s83, v156
  v_fma_f32 v120, v120, s83, -v156
  v_fma_f32 v121, v121, s83, -v156
  v_fma_f32 v122, v122, s83, -v156
  v_fma_f32 v123, v123, s83, -v156
  v_fma_f32 v124, v124, s83, -v156
  v_fma_f32 v125, v125, s83, -v156
  v_fma_f32 v126, v126, s83, -v156
  v_fma_f32 v127, v127, s83, -v156
  v_fma_f32 v128, v128, s83, -v156
  v_fma_f32 v129, v129, s83, -v156
  v_fma_f32 v130, v130, s83, -v156
  v_fma_f32 v131, v131, s83, -v156
  v_exp_f32 v120, v120
  v_exp_f32 v121, v121
  v_exp_f32 v122, v122
  v_exp_f32 v123, v123
  v_exp_f32 v124, v124
  v_exp_f32 v125, v125
  v_exp_f32 v126, v126
  v_exp_f32 v127, v127
  v_exp_f32 v128, v128
  v_exp_f32 v129, v129
  v_exp_f32 v130, v130
  v_exp_f32 v131, v131
  s_nop 0
  v_add_f32 v156, v128, v129
  v_add_f32 v156, v156, v130
  v_add_f32 v156, v156, v131
  v_cndmask_b32 v156, 0, v156, s[60:61]
  v_add_f32 v156, v156, v120
  v_add_f32 v156, v156, v121
  v_add_f32 v156, v156, v122
  v_add_f32 v156, v156, v123
  v_add_f32 v156, v156, v124
  v_add_f32 v156, v156, v125
  v_add_f32 v156, v156, v126
  v_add_f32 v156, v156, v127
  v_mov_b32 v157, v156
  s_nop 1
  v_permlane32_swap_b32 v156, v157
  v_add_f32 v156, v156, v157
  v_mov_b32 v157, v156
  s_nop 1
  v_permlane16_swap_b32 v156, v157
  v_add_f32 v156, v156, v157
  v_rcp_f32 v156, v156
  s_nop 0
  v_mul_f32 v120, v120, v156
  v_mul_f32 v121, v121, v156
  v_mul_f32 v122, v122, v156
  v_mul_f32 v123, v123, v156
  v_mul_f32 v124, v124, v156
  v_mul_f32 v125, v125, v156
  v_mul_f32 v126, v126, v156
  v_mul_f32 v127, v127, v156
  v_mul_f32 v128, v128, v156
  v_mul_f32 v129, v129, v156
  v_mul_f32 v130, v130, v156
  v_mul_f32 v131, v131, v156
  v_cvt_pk_bf16_f32 v192, v120, v121
  v_cvt_pk_bf16_f32 v193, v122, v123
  v_cvt_pk_bf16_f32 v194, v124, v125
  v_cvt_pk_bf16_f32 v195, v126, v127
  v_cvt_pk_bf16_f32 v196, v116, v117
  v_cvt_pk_bf16_f32 v197, v118, v119
  v_cvt_pk_bf16_f32 v198, v128, v129
  v_cvt_pk_bf16_f32 v199, v130, v131
  v_cvt_pk_bf16_f32 v200, v112, v113
  v_cvt_pk_bf16_f32 v201, v114, v115
  buffer_store_dwordx4 v[192:195], v30, s[56:59], s81 offen sc1
  buffer_store_dwordx4 v[196:199], v30, s[56:59], s81 offen offset:1024 sc1
  buffer_store_dwordx2 v[200:201], v32, s[56:59], s81 offen offset:2048 sc1
  s_mov_b32 s78, s82
  s_mov_b32 s81, 0x80000000
  s_mov_b32 s82, 0
  s_cmp_eq_u32 s80, 1
  s_cbranch_scc1 qd_235
  s_waitcnt vmcnt(0)
  s_cmp_eq_u32 s78, 0
  s_cbranch_scc1 pf_236
  v_mov_b32 v4, 0
  v_mov_b32 v5, 1
  s_mov_b64 exec, 1
  buffer_atomic_add v5, v4, s[72:75], s78 offen sc1
  s_mov_b64 exec, -1
  s_mov_b32 s78, 0
pf_236:
qd_235:
  s_add_u32 s49, s49, s29
qbe_224:
  s_sub_u32 s26, s26, 1
  s_cmp_gt_u32 s26, 0
  s_waitcnt lgkmcnt(0)
  s_cbranch_scc1 qa_blk_223
  s_waitcnt vmcnt(0) lgkmcnt(0)
  s_lshl_b32 s21, s42, 7
  s_add_u32 s21, s21, 18432
  v_mov_b32 v25, 0
  buffer_load_dword v27, v25, s[72:75], s21 offen sc1
  s_waitcnt vmcnt(0)
  s_cmp_eq_u32 s78, 0
  s_cbranch_scc1 pf_237
  v_mov_b32 v4, 0
  v_mov_b32 v5, 1
  s_mov_b64 exec, 1
  buffer_atomic_add v5, v4, s[72:75], s78 offen sc1
  s_mov_b64 exec, -1
  s_mov_b32 s78, 0
pf_237:
  s_add_u32 s84, s42, 1
  v_mov_b32 v26, 32768
  s_waitcnt lgkmcnt(0)
  s_barrier
  s_cmp_lg_u32 s20, 0
  s_cbranch_scc1 a0_238
  ds_write_b32 v26, v27
a0_238:
  s_waitcnt lgkmcnt(0)
  s_barrier
  ds_read_b32 v27, v26
  s_waitcnt lgkmcnt(0)
  v_readfirstlane_b32 s64, v27
  s_barrier
  s_cmp_ge_u32 s64, 59
  s_cbranch_scc1 own_afin
queue:
  s_load_dwordx2 s[4:5], s[0:1], 96
  s_waitcnt lgkmcnt(0)
  s_mov_b32 s32, s4
  s_mov_b32 s33, s5
  s_mov_b32 s34, 256
  s_mov_b32 s35, 0x00020000
  s_waitcnt vmcnt(0) lgkmcnt(0)
  s_barrier
  s_mov_b32 s2, s85
  s_mov_b32 s85, -1
  s_cmp_lg_u32 s2, -1
  s_cbranch_scc1 queue_c
  v_mov_b32 v21, 0
  s_cmp_lg_u32 s20, 0
  s_cbranch_scc1 q_239
  v_mov_b32 v22, 80
  v_mov_b32 v23, 1
  s_mov_b64 exec, 1
  buffer_atomic_add v23, v22, s[32:35], 0 offen sc0 sc1
  s_waitcnt vmcnt(0)
queue_a:
  ds_write_b32 v21, v23
  s_waitcnt lgkmcnt(0)
  s_mov_b64 exec, -1
q_239:
queue_b:
  s_barrier
  ds_read_b32 v23, v21
  s_waitcnt lgkmcnt(0)
  v_readfirstlane_b32 s2, v23
  s_barrier
queue_c:
  s_cmp_eq_u32 s84, 0
  s_cbranch_scc1 od_240
  s_cmp_lt_u32 s2, 738
  s_cbranch_scc1 od_240
  s_mov_b32 s85, s2
  s_branch own_afin
od_240:
  s_add_u32 s21, s2, 0
  s_cmp_lt_u32 s2, 10
  s_cbranch_scc1 do_qbl
  s_sub_u32 s2, s2, 10
  s_add_u32 s21, s2, 0
  s_cmp_lt_u32 s2, 54
  s_cbranch_scc1 do_bat
  s_sub_u32 s2, s2, 54
  s_add_u32 s21, s2, 0
  s_cmp_lt_u32 s2, 56
  s_cbranch_scc1 do_opb
  s_sub_u32 s2, s2, 56
  s_add_u32 s21, s2, 54
  s_cmp_lt_u32 s2, 10
  s_cbranch_scc1 do_bat
  s_sub_u32 s2, s2, 10
  s_add_u32 s21, s2, 0
  s_cmp_lt_u32 s2, 60
  s_cbranch_scc1 do_pv
  s_sub_u32 s2, s2, 60
  s_add_u32 s21, s2, 56
  s_cmp_lt_u32 s2, 8
  s_cbranch_scc1 do_opb
  s_sub_u32 s2, s2, 8
  s_add_u32 s21, s2, 60
  s_cmp_lt_u32 s2, 480
  s_cbranch_scc1 do_pv
  s_sub_u32 s2, s2, 480
  s_add_u32 s21, s2, 540
  s_cmp_lt_u32 s2, 100
  s_cbranch_scc1 do_pv
  s_sub_u32 s2, s2, 100
  s_branch main_fin
do_qbl:
  s_mul_hi_u32 s42, s21, 0x1999999a
  s_mul_i32 s22, s42, 10
  s_sub_u32 s41, s21, s22
  s_add_u32 s42, s42, 15
  s_mov_b32 s26, 1
  s_mov_b32 s63, 1
  s_mov_b32 s64, 1
  s_branch qkvb_entry
do_opb:
  s_mov_b32 s2, s21
  s_lshr_b32 s40, s2, 2
  s_and_b32 s42, s2, 3
  s_mov_b32 s43, 4
  s_load_dwordx2 s[4:5], s[0:1], 40
  s_load_dwordx2 s[6:7], s[0:1], 72
  s_load_dwordx2 s[38:39], s[0:1], 104
  s_waitcnt lgkmcnt(0)
  s_cmp_eq_u32 s43, 4
  s_cselect_b32 s4, s6, s4
  s_cselect_b32 s5, s7, s5
  s_mov_b32 s10, 7864320
  s_cselect_b32 s10, 819200, s10
  s_cselect_b32 s44, 10, 24
  s_mov_b32 s45, 196608
  s_cselect_b32 s45, 20480, s45
  s_mov_b32 s46, 93323264
  s_cselect_b32 s46, 70778880, s46
  s_cselect_b32 s47, 1, 0
  s_mov_b32 s8, s4
  s_mov_b32 s9, s5
  s_mov_b32 s11, 0x00020000
  s_mov_b32 s12, s38
  s_mov_b32 s13, s39
  s_mov_b32 s14, 73400320
  s_mov_b32 s15, 0x00020000
  s_add_u32 s16, s38, 73400320
  s_addc_u32 s17, s39, 0
  s_mov_b32 s18, 5242880
  s_mov_b32 s19, 0x00020000
  s_lshl_b32 s21, s40, 3
  s_lshl_b32 s22, s20, 1
  s_add_u32 s21, s21, s22
  s_mul_i32 s21, s21, s45
  s_add_u32 s48, s46, s21
  s_and_b32 s22, s43, 3
  s_mul_i32 s22, s22, 49152
  s_cmp_eq_u32 s47, 1
  s_cselect_b32 s22, 0, s22
  s_add_u32 s48, s48, s22
  v_lshlrev_b32 v4, 4, v1
  s_and_b32 s22, s43, 3
  s_mul_i32 s49, s22, 1966080
  s_cmp_eq_u32 s47, 1
  s_cselect_b32 s49, 0, s49
  s_mul_i32 s22, s42, 320
  s_add_u32 s49, s49, s22
  v_mov_b32 v29, 3277
  s_mul_i32 s21, s20, 320
  s_add_u32 s21, s21, 0
  v_add_u32 v21, s21, v1
  v_mul_u32_u24 v22, v21, v29
  v_lshrrev_b32 v22, 16, v22
  v_mul_u32_u24 v23, 20, v22
  v_sub_u32 v21, v21, v23
  v_add_u32 v22, 0, v22
  v_mov_b32 v25, v22
  s_cmp_eq_u32 s47, 1
  s_cbranch_scc1 id_241
  v_and_b32 v23, 0xe3, v22
  v_bfe_u32 v24, v22, 2, 1
  v_lshl_add_u32 v23, v24, 4, v23
  v_bfe_u32 v24, v22, 3, 2
  v_lshl_add_u32 v22, v24, 2, v23
  v_mul_u32_u24 v23, 1366, v22
  v_lshrrev_b32 v23, 16, v23
  v_mul_u32_u24 v25, 48, v23
  v_sub_u32 v22, v22, v25
  v_mul_u32_u24 v26, 5462, v22
  v_lshrrev_b32 v26, 16, v26
  v_mul_u32_u24 v27, 12, v26
  v_sub_u32 v22, v22, v27
  v_lshrrev_b32 v27, 2, v22
  v_and_b32 v22, 3, v22
  v_lshl_add_u32 v25, v27, 4, v25
  v_lshl_add_u32 v25, v26, 2, v25
  v_add_u32 v25, v25, v22
id_241:
  v_mul_u32_u24 v25, 1280, v25
  v_lshl_add_u32 v64, v21, 4, v25
  s_mul_i32 s21, s20, 320
  s_add_u32 s21, s21, 64
  v_add_u32 v21, s21, v1
  v_mul_u32_u24 v22, v21, v29
  v_lshrrev_b32 v22, 16, v22
  v_mul_u32_u24 v23, 20, v22
  v_sub_u32 v21, v21, v23
  v_add_u32 v22, 0, v22
  v_mov_b32 v25, v22
  s_cmp_eq_u32 s47, 1
  s_cbranch_scc1 id_242
  v_and_b32 v23, 0xe3, v22
  v_bfe_u32 v24, v22, 2, 1
  v_lshl_add_u32 v23, v24, 4, v23
  v_bfe_u32 v24, v22, 3, 2
  v_lshl_add_u32 v22, v24, 2, v23
  v_mul_u32_u24 v23, 1366, v22
  v_lshrrev_b32 v23, 16, v23
  v_mul_u32_u24 v25, 48, v23
  v_sub_u32 v22, v22, v25
  v_mul_u32_u24 v26, 5462, v22
  v_lshrrev_b32 v26, 16, v26
  v_mul_u32_u24 v27, 12, v26
  v_sub_u32 v22, v22, v27
  v_lshrrev_b32 v27, 2, v22
  v_and_b32 v22, 3, v22
  v_lshl_add_u32 v25, v27, 4, v25
  v_lshl_add_u32 v25, v26, 2, v25
  v_add_u32 v25, v25, v22
id_242:
  v_mul_u32_u24 v25, 1280, v25
  v_lshl_add_u32 v65, v21, 4, v25
  s_mul_i32 s21, s20, 320
  s_add_u32 s21, s21, 128
  v_add_u32 v21, s21, v1
  v_mul_u32_u24 v22, v21, v29
  v_lshrrev_b32 v22, 16, v22
  v_mul_u32_u24 v23, 20, v22
  v_sub_u32 v21, v21, v23
  v_add_u32 v22, 0, v22
  v_mov_b32 v25, v22
  s_cmp_eq_u32 s47, 1
  s_cbranch_scc1 id_243
  v_and_b32 v23, 0xe3, v22
  v_bfe_u32 v24, v22, 2, 1
  v_lshl_add_u32 v23, v24, 4, v23
  v_bfe_u32 v24, v22, 3, 2
  v_lshl_add_u32 v22, v24, 2, v23
  v_mul_u32_u24 v23, 1366, v22
  v_lshrrev_b32 v23, 16, v23
  v_mul_u32_u24 v25, 48, v23
  v_sub_u32 v22, v22, v25
  v_mul_u32_u24 v26, 5462, v22
  v_lshrrev_b32 v26, 16, v26
  v_mul_u32_u24 v27, 12, v26
  v_sub_u32 v22, v22, v27
  v_lshrrev_b32 v27, 2, v22
  v_and_b32 v22, 3, v22
  v_lshl_add_u32 v25, v27, 4, v25
  v_lshl_add_u32 v25, v26, 2, v25
  v_add_u32 v25, v25, v22
id_243:
  v_mul_u32_u24 v25, 1280, v25
  v_lshl_add_u32 v66, v21, 4, v25
  s_mul_i32 s21, s20, 320
  s_add_u32 s21, s21, 192
  v_add_u32 v21, s21, v1
  v_mul_u32_u24 v22, v21, v29
  v_lshrrev_b32 v22, 16, v22
  v_mul_u32_u24 v23, 20, v22
  v_sub_u32 v21, v21, v23
  v_add_u32 v22, 0, v22
  v_mov_b32 v25, v22
  s_cmp_eq_u32 s47, 1
  s_cbranch_scc1 id_244
  v_and_b32 v23, 0xe3, v22
  v_bfe_u32 v24, v22, 2, 1
  v_lshl_add_u32 v23, v24, 4, v23
  v_bfe_u32 v24, v22, 3, 2
  v_lshl_add_u32 v22, v24, 2, v23
  v_mul_u32_u24 v23, 1366, v22
  v_lshrrev_b32 v23, 16, v23
  v_mul_u32_u24 v25, 48, v23
  v_sub_u32 v22, v22, v25
  v_mul_u32_u24 v26, 5462, v22
  v_lshrrev_b32 v26, 16, v26
  v_mul_u32_u24 v27, 12, v26
  v_sub_u32 v22, v22, v27
  v_lshrrev_b32 v27, 2, v22
  v_and_b32 v22, 3, v22
  v_lshl_add_u32 v25, v27, 4, v25
  v_lshl_add_u32 v25, v26, 2, v25
  v_add_u32 v25, v25, v22
id_244:
  v_mul_u32_u24 v25, 1280, v25
  v_lshl_add_u32 v67, v21, 4, v25
  s_mul_i32 s21, s20, 320
  s_add_u32 s21, s21, 256
  v_add_u32 v21, s21, v1
  v_mul_u32_u24 v22, v21, v29
  v_lshrrev_b32 v22, 16, v22
  v_mul_u32_u24 v23, 20, v22
  v_sub_u32 v21, v21, v23
  v_add_u32 v22, 0, v22
  v_mov_b32 v25, v22
  s_cmp_eq_u32 s47, 1
  s_cbranch_scc1 id_245
  v_and_b32 v23, 0xe3, v22
  v_bfe_u32 v24, v22, 2, 1
  v_lshl_add_u32 v23, v24, 4, v23
  v_bfe_u32 v24, v22, 3, 2
  v_lshl_add_u32 v22, v24, 2, v23
  v_mul_u32_u24 v23, 1366, v22
  v_lshrrev_b32 v23, 16, v23
  v_mul_u32_u24 v25, 48, v23
  v_sub_u32 v22, v22, v25
  v_mul_u32_u24 v26, 5462, v22
  v_lshrrev_b32 v26, 16, v26
  v_mul_u32_u24 v27, 12, v26
  v_sub_u32 v22, v22, v27
  v_lshrrev_b32 v27, 2, v22
  v_and_b32 v22, 3, v22
  v_lshl_add_u32 v25, v27, 4, v25
  v_lshl_add_u32 v25, v26, 2, v25
  v_add_u32 v25, v25, v22
id_245:
  v_mul_u32_u24 v25, 1280, v25
  v_lshl_add_u32 v68, v21, 4, v25
  s_mul_i32 s21, s20, 320
  s_add_u32 s21, s21, 0
  v_add_u32 v21, s21, v1
  v_mul_u32_u24 v22, v21, v29
  v_lshrrev_b32 v22, 16, v22
  v_mul_u32_u24 v23, 20, v22
  v_sub_u32 v21, v21, v23
  v_add_u32 v22, 64, v22
  v_mov_b32 v25, v22
  s_cmp_eq_u32 s47, 1
  s_cbranch_scc1 id_246
  v_and_b32 v23, 0xe3, v22
  v_bfe_u32 v24, v22, 2, 1
  v_lshl_add_u32 v23, v24, 4, v23
  v_bfe_u32 v24, v22, 3, 2
  v_lshl_add_u32 v22, v24, 2, v23
  v_mul_u32_u24 v23, 1366, v22
  v_lshrrev_b32 v23, 16, v23
  v_mul_u32_u24 v25, 48, v23
  v_sub_u32 v22, v22, v25
  v_mul_u32_u24 v26, 5462, v22
  v_lshrrev_b32 v26, 16, v26
  v_mul_u32_u24 v27, 12, v26
  v_sub_u32 v22, v22, v27
  v_lshrrev_b32 v27, 2, v22
  v_and_b32 v22, 3, v22
  v_lshl_add_u32 v25, v27, 4, v25
  v_lshl_add_u32 v25, v26, 2, v25
  v_add_u32 v25, v25, v22
id_246:
  v_mul_u32_u24 v25, 1280, v25
  v_lshl_add_u32 v69, v21, 4, v25
  s_mul_i32 s21, s20, 320
  s_add_u32 s21, s21, 64
  v_add_u32 v21, s21, v1
  v_mul_u32_u24 v22, v21, v29
  v_lshrrev_b32 v22, 16, v22
  v_mul_u32_u24 v23, 20, v22
  v_sub_u32 v21, v21, v23
  v_add_u32 v22, 64, v22
  v_mov_b32 v25, v22
  s_cmp_eq_u32 s47, 1
  s_cbranch_scc1 id_247
  v_and_b32 v23, 0xe3, v22
  v_bfe_u32 v24, v22, 2, 1
  v_lshl_add_u32 v23, v24, 4, v23
  v_bfe_u32 v24, v22, 3, 2
  v_lshl_add_u32 v22, v24, 2, v23
  v_mul_u32_u24 v23, 1366, v22
  v_lshrrev_b32 v23, 16, v23
  v_mul_u32_u24 v25, 48, v23
  v_sub_u32 v22, v22, v25
  v_mul_u32_u24 v26, 5462, v22
  v_lshrrev_b32 v26, 16, v26
  v_mul_u32_u24 v27, 12, v26
  v_sub_u32 v22, v22, v27
  v_lshrrev_b32 v27, 2, v22
  v_and_b32 v22, 3, v22
  v_lshl_add_u32 v25, v27, 4, v25
  v_lshl_add_u32 v25, v26, 2, v25
  v_add_u32 v25, v25, v22
id_247:
  v_mul_u32_u24 v25, 1280, v25
  v_lshl_add_u32 v70, v21, 4, v25
  s_mul_i32 s21, s20, 320
  s_add_u32 s21, s21, 128
  v_add_u32 v21, s21, v1
  v_mul_u32_u24 v22, v21, v29
  v_lshrrev_b32 v22, 16, v22
  v_mul_u32_u24 v23, 20, v22
  v_sub_u32 v21, v21, v23
  v_add_u32 v22, 64, v22
  v_mov_b32 v25, v22
  s_cmp_eq_u32 s47, 1
  s_cbranch_scc1 id_248
  v_and_b32 v23, 0xe3, v22
  v_bfe_u32 v24, v22, 2, 1
  v_lshl_add_u32 v23, v24, 4, v23
  v_bfe_u32 v24, v22, 3, 2
  v_lshl_add_u32 v22, v24, 2, v23
  v_mul_u32_u24 v23, 1366, v22
  v_lshrrev_b32 v23, 16, v23
  v_mul_u32_u24 v25, 48, v23
  v_sub_u32 v22, v22, v25
  v_mul_u32_u24 v26, 5462, v22
  v_lshrrev_b32 v26, 16, v26
  v_mul_u32_u24 v27, 12, v26
  v_sub_u32 v22, v22, v27
  v_lshrrev_b32 v27, 2, v22
  v_and_b32 v22, 3, v22
  v_lshl_add_u32 v25, v27, 4, v25
  v_lshl_add_u32 v25, v26, 2, v25
  v_add_u32 v25, v25, v22
id_248:
  v_mul_u32_u24 v25, 1280, v25
  v_lshl_add_u32 v71, v21, 4, v25
  s_mul_i32 s21, s20, 320
  s_add_u32 s21, s21, 192
  v_add_u32 v21, s21, v1
  v_mul_u32_u24 v22, v21, v29
  v_lshrrev_b32 v22, 16, v22
  v_mul_u32_u24 v23, 20, v22
  v_sub_u32 v21, v21, v23
  v_add_u32 v22, 64, v22
  v_mov_b32 v25, v22
  s_cmp_eq_u32 s47, 1
  s_cbranch_scc1 id_249
  v_and_b32 v23, 0xe3, v22
  v_bfe_u32 v24, v22, 2, 1
  v_lshl_add_u32 v23, v24, 4, v23
  v_bfe_u32 v24, v22, 3, 2
  v_lshl_add_u32 v22, v24, 2, v23
  v_mul_u32_u24 v23, 1366, v22
  v_lshrrev_b32 v23, 16, v23
  v_mul_u32_u24 v25, 48, v23
  v_sub_u32 v22, v22, v25
  v_mul_u32_u24 v26, 5462, v22
  v_lshrrev_b32 v26, 16, v26
  v_mul_u32_u24 v27, 12, v26
  v_sub_u32 v22, v22, v27
  v_lshrrev_b32 v27, 2, v22
  v_and_b32 v22, 3, v22
  v_lshl_add_u32 v25, v27, 4, v25
  v_lshl_add_u32 v25, v26, 2, v25
  v_add_u32 v25, v25, v22
id_249:
  v_mul_u32_u24 v25, 1280, v25
  v_lshl_add_u32 v72, v21, 4, v25
  s_mul_i32 s21, s20, 320
  s_add_u32 s21, s21, 256
  v_add_u32 v21, s21, v1
  v_mul_u32_u24 v22, v21, v29
  v_lshrrev_b32 v22, 16, v22
  v_mul_u32_u24 v23, 20, v22
  v_sub_u32 v21, v21, v23
  v_add_u32 v22, 64, v22
  v_mov_b32 v25, v22
  s_cmp_eq_u32 s47, 1
  s_cbranch_scc1 id_250
  v_and_b32 v23, 0xe3, v22
  v_bfe_u32 v24, v22, 2, 1
  v_lshl_add_u32 v23, v24, 4, v23
  v_bfe_u32 v24, v22, 3, 2
  v_lshl_add_u32 v22, v24, 2, v23
  v_mul_u32_u24 v23, 1366, v22
  v_lshrrev_b32 v23, 16, v23
  v_mul_u32_u24 v25, 48, v23
  v_sub_u32 v22, v22, v25
  v_mul_u32_u24 v26, 5462, v22
  v_lshrrev_b32 v26, 16, v26
  v_mul_u32_u24 v27, 12, v26
  v_sub_u32 v22, v22, v27
  v_lshrrev_b32 v27, 2, v22
  v_and_b32 v22, 3, v22
  v_lshl_add_u32 v25, v27, 4, v25
  v_lshl_add_u32 v25, v26, 2, v25
  v_add_u32 v25, v25, v22
id_250:
  v_mul_u32_u24 v25, 1280, v25
  v_lshl_add_u32 v73, v21, 4, v25
  s_mul_i32 s21, s20, 320
  s_add_u32 s21, s21, 0
  v_add_u32 v21, s21, v1
  v_mul_u32_u24 v22, v21, v29
  v_lshrrev_b32 v22, 16, v22
  v_mul_u32_u24 v23, 20, v22
  v_sub_u32 v21, v21, v23
  v_add_u32 v22, 128, v22
  v_mov_b32 v25, v22
  s_cmp_eq_u32 s47, 1
  s_cbranch_scc1 id_251
  v_and_b32 v23, 0xe3, v22
  v_bfe_u32 v24, v22, 2, 1
  v_lshl_add_u32 v23, v24, 4, v23
  v_bfe_u32 v24, v22, 3, 2
  v_lshl_add_u32 v22, v24, 2, v23
  v_mul_u32_u24 v23, 1366, v22
  v_lshrrev_b32 v23, 16, v23
  v_mul_u32_u24 v25, 48, v23
  v_sub_u32 v22, v22, v25
  v_mul_u32_u24 v26, 5462, v22
  v_lshrrev_b32 v26, 16, v26
  v_mul_u32_u24 v27, 12, v26
  v_sub_u32 v22, v22, v27
  v_lshrrev_b32 v27, 2, v22
  v_and_b32 v22, 3, v22
  v_lshl_add_u32 v25, v27, 4, v25
  v_lshl_add_u32 v25, v26, 2, v25
  v_add_u32 v25, v25, v22
id_251:
  v_mul_u32_u24 v25, 1280, v25
  v_lshl_add_u32 v74, v21, 4, v25
  s_mul_i32 s21, s20, 320
  s_add_u32 s21, s21, 64
  v_add_u32 v21, s21, v1
  v_mul_u32_u24 v22, v21, v29
  v_lshrrev_b32 v22, 16, v22
  v_mul_u32_u24 v23, 20, v22
  v_sub_u32 v21, v21, v23
  v_add_u32 v22, 128, v22
  v_mov_b32 v25, v22
  s_cmp_eq_u32 s47, 1
  s_cbranch_scc1 id_252
  v_and_b32 v23, 0xe3, v22
  v_bfe_u32 v24, v22, 2, 1
  v_lshl_add_u32 v23, v24, 4, v23
  v_bfe_u32 v24, v22, 3, 2
  v_lshl_add_u32 v22, v24, 2, v23
  v_mul_u32_u24 v23, 1366, v22
  v_lshrrev_b32 v23, 16, v23
  v_mul_u32_u24 v25, 48, v23
  v_sub_u32 v22, v22, v25
  v_mul_u32_u24 v26, 5462, v22
  v_lshrrev_b32 v26, 16, v26
  v_mul_u32_u24 v27, 12, v26
  v_sub_u32 v22, v22, v27
  v_lshrrev_b32 v27, 2, v22
  v_and_b32 v22, 3, v22
  v_lshl_add_u32 v25, v27, 4, v25
  v_lshl_add_u32 v25, v26, 2, v25
  v_add_u32 v25, v25, v22
id_252:
  v_mul_u32_u24 v25, 1280, v25
  v_lshl_add_u32 v75, v21, 4, v25
  s_mul_i32 s21, s20, 320
  s_add_u32 s21, s21, 128
  v_add_u32 v21, s21, v1
  v_mul_u32_u24 v22, v21, v29
  v_lshrrev_b32 v22, 16, v22
  v_mul_u32_u24 v23, 20, v22
  v_sub_u32 v21, v21, v23
  v_add_u32 v22, 128, v22
  v_mov_b32 v25, v22
  s_cmp_eq_u32 s47, 1
  s_cbranch_scc1 id_253
  v_and_b32 v23, 0xe3, v22
  v_bfe_u32 v24, v22, 2, 1
  v_lshl_add_u32 v23, v24, 4, v23
  v_bfe_u32 v24, v22, 3, 2
  v_lshl_add_u32 v22, v24, 2, v23
  v_mul_u32_u24 v23, 1366, v22
  v_lshrrev_b32 v23, 16, v23
  v_mul_u32_u24 v25, 48, v23
  v_sub_u32 v22, v22, v25
  v_mul_u32_u24 v26, 5462, v22
  v_lshrrev_b32 v26, 16, v26
  v_mul_u32_u24 v27, 12, v26
  v_sub_u32 v22, v22, v27
  v_lshrrev_b32 v27, 2, v22
  v_and_b32 v22, 3, v22
  v_lshl_add_u32 v25, v27, 4, v25
  v_lshl_add_u32 v25, v26, 2, v25
  v_add_u32 v25, v25, v22
id_253:
  v_mul_u32_u24 v25, 1280, v25
  v_lshl_add_u32 v76, v21, 4, v25
  s_mul_i32 s21, s20, 320
  s_add_u32 s21, s21, 192
  v_add_u32 v21, s21, v1
  v_mul_u32_u24 v22, v21, v29
  v_lshrrev_b32 v22, 16, v22
  v_mul_u32_u24 v23, 20, v22
  v_sub_u32 v21, v21, v23
  v_add_u32 v22, 128, v22
  v_mov_b32 v25, v22
  s_cmp_eq_u32 s47, 1
  s_cbranch_scc1 id_254
  v_and_b32 v23, 0xe3, v22
  v_bfe_u32 v24, v22, 2, 1
  v_lshl_add_u32 v23, v24, 4, v23
  v_bfe_u32 v24, v22, 3, 2
  v_lshl_add_u32 v22, v24, 2, v23
  v_mul_u32_u24 v23, 1366, v22
  v_lshrrev_b32 v23, 16, v23
  v_mul_u32_u24 v25, 48, v23
  v_sub_u32 v22, v22, v25
  v_mul_u32_u24 v26, 5462, v22
  v_lshrrev_b32 v26, 16, v26
  v_mul_u32_u24 v27, 12, v26
  v_sub_u32 v22, v22, v27
  v_lshrrev_b32 v27, 2, v22
  v_and_b32 v22, 3, v22
  v_lshl_add_u32 v25, v27, 4, v25
  v_lshl_add_u32 v25, v26, 2, v25
  v_add_u32 v25, v25, v22
id_254:
  v_mul_u32_u24 v25, 1280, v25
  v_lshl_add_u32 v77, v21, 4, v25
  s_mul_i32 s21, s20, 320
  s_add_u32 s21, s21, 256
  v_add_u32 v21, s21, v1
  v_mul_u32_u24 v22, v21, v29
  v_lshrrev_b32 v22, 16, v22
  v_mul_u32_u24 v23, 20, v22
  v_sub_u32 v21, v21, v23
  v_add_u32 v22, 128, v22
  v_mov_b32 v25, v22
  s_cmp_eq_u32 s47, 1
  s_cbranch_scc1 id_255
  v_and_b32 v23, 0xe3, v22
  v_bfe_u32 v24, v22, 2, 1
  v_lshl_add_u32 v23, v24, 4, v23
  v_bfe_u32 v24, v22, 3, 2
  v_lshl_add_u32 v22, v24, 2, v23
  v_mul_u32_u24 v23, 1366, v22
  v_lshrrev_b32 v23, 16, v23
  v_mul_u32_u24 v25, 48, v23
  v_sub_u32 v22, v22, v25
  v_mul_u32_u24 v26, 5462, v22
  v_lshrrev_b32 v26, 16, v26
  v_mul_u32_u24 v27, 12, v26
  v_sub_u32 v22, v22, v27
  v_lshrrev_b32 v27, 2, v22
  v_and_b32 v22, 3, v22
  v_lshl_add_u32 v25, v27, 4, v25
  v_lshl_add_u32 v25, v26, 2, v25
  v_add_u32 v25, v25, v22
id_255:
  v_mul_u32_u24 v25, 1280, v25
  v_lshl_add_u32 v78, v21, 4, v25
  s_lshr_b32 s21, s20, 1
  s_lshl_b32 s21, s21, 13
  v_add_u32 v5, s21, v4
  v_lshrrev_b32 v6, 2, v2
  v_lshl_add_u32 v6, v3, 3, v6
  v_mul_u32_u24 v6, 320, v6
  v_and_b32 v7, 3, v2
  v_lshlrev_b32 v7, 3, v7
  s_and_b32 s21, s20, 1
  s_mul_i32 s21, s21, 160
  s_add_u32 s21, s21, 16384
  v_add3_u32 v6, v6, v7, s21
  s_mov_b32 s50, 0
  s_mov_b32 s51, 0
  v_mov_b32 v80, 0
  v_mov_b32 v81, 0
  v_mov_b32 v82, 0
  v_mov_b32 v83, 0
  v_mov_b32 v84, 0
  v_mov_b32 v85, 0
  v_mov_b32 v86, 0
  v_mov_b32 v87, 0
  v_mov_b32 v88, 0
  v_mov_b32 v89, 0
  v_mov_b32 v90, 0
  v_mov_b32 v91, 0
  v_mov_b32 v92, 0
  v_mov_b32 v93, 0
  v_mov_b32 v94, 0
  v_mov_b32 v95, 0
  v_mov_b32 v96, 0
  v_mov_b32 v97, 0
  v_mov_b32 v98, 0
  v_mov_b32 v99, 0
  v_mov_b32 v100, 0
  v_mov_b32 v101, 0
  v_mov_b32 v102, 0
  v_mov_b32 v103, 0
  v_mov_b32 v104, 0
  v_mov_b32 v105, 0
  v_mov_b32 v106, 0
  v_mov_b32 v107, 0
  v_mov_b32 v108, 0
  v_mov_b32 v109, 0
  v_mov_b32 v110, 0
  v_mov_b32 v111, 0
  v_mov_b32 v112, 0
  v_mov_b32 v113, 0
  v_mov_b32 v114, 0
  v_mov_b32 v115, 0
  v_mov_b32 v116, 0
  v_mov_b32 v117, 0
  v_mov_b32 v118, 0
  v_mov_b32 v119, 0
  v_mov_b32 v120, 0
  v_mov_b32 v121, 0
  v_mov_b32 v122, 0
  v_mov_b32 v123, 0
  v_mov_b32 v124, 0
  v_mov_b32 v125, 0
  v_mov_b32 v126, 0
  v_mov_b32 v127, 0
  v_mov_b32 v128, 0
  v_mov_b32 v129, 0
  v_mov_b32 v130, 0
  v_mov_b32 v131, 0
  v_mov_b32 v132, 0
  v_mov_b32 v133, 0
  v_mov_b32 v134, 0
  v_mov_b32 v135, 0
  v_mov_b32 v136, 0
  v_mov_b32 v137, 0
  v_mov_b32 v138, 0
  v_mov_b32 v139, 0
  v_mov_b32 v140, 0
  v_mov_b32 v141, 0
  v_mov_b32 v142, 0
  v_mov_b32 v143, 0
  v_mov_b32 v144, 0
  v_mov_b32 v145, 0
  v_mov_b32 v146, 0
  v_mov_b32 v147, 0
  v_mov_b32 v148, 0
  v_mov_b32 v149, 0
  v_mov_b32 v150, 0
  v_mov_b32 v151, 0
  v_mov_b32 v152, 0
  v_mov_b32 v153, 0
  v_mov_b32 v154, 0
  v_mov_b32 v155, 0
  v_mov_b32 v156, 0
  v_mov_b32 v157, 0
  v_mov_b32 v158, 0
  v_mov_b32 v159, 0
  s_lshl_b32 s53, s44, 11
  s_add_u32 s53, s53, s48
  s_sub_u32 s53, s53, 2048
  s_load_dwordx2 s[72:73], s[0:1], 104
  s_waitcnt lgkmcnt(0)
  s_add_u32 s72, s72, 81068032
  s_addc_u32 s73, s73, 0
  s_mov_b32 s74, 115712
  s_mov_b32 s75, 0x00020000
  s_lshl_b32 s21, s40, 7
  s_add_u32 s21, s21, 90112
  s_mov_b32 s23, 4
  s_cmp_lg_u32 s20, 0
  s_cbranch_scc1 wf_257
  v_mov_b32 v10, 0
  s_mov_b32 s101, 0
wf_256:
  buffer_load_dword v11, v10, s[72:75], s21 offen sc1
  s_add_u32 s101, s101, 1
  s_cmp_gt_u32 s101, 131072
  s_cbranch_scc1 main_end
  s_waitcnt vmcnt(0)
  v_readfirstlane_b32 s100, v11
  s_cmp_ge_u32 s100, s23
  s_cbranch_scc1 wf_257
  s_sleep 8
  s_add_u32 s100, s100, 8
  s_cmp_ge_u32 s100, s23
  s_cbranch_scc1 wf_256
  s_sleep 60
  s_branch wf_256
wf_257:
  s_barrier
  s_lshl_b32 s22, s20, 12
  s_add_u32 s22, s22, s50
  s_add_u32 s23, s48, s45
  s_add_u32 m0, s22, 0
  s_nop 0
  buffer_load_dwordx4 v4, s[12:15], s48 offen offset:0 sc1 lds
  s_add_u32 m0, s22, 0
  s_nop 0
  buffer_load_dwordx4 v4, s[12:15], s48 offen offset:1024 sc1 lds
  s_add_u32 m0, s22, 2048
  s_nop 0
  buffer_load_dwordx4 v4, s[12:15], s23 offen offset:0 sc1 lds
  s_add_u32 m0, s22, 2048
  s_nop 0
  buffer_load_dwordx4 v4, s[12:15], s23 offen offset:1024 sc1 lds
  s_mul_i32 s22, s20, 5120
  s_add_u32 s22, s22, s50
  s_add_u32 s22, s22, 16384
  s_add_u32 m0, s22, 0
  s_nop 0
  buffer_load_dwordx4 v64, s[8:11], s49 offen lds
  s_add_u32 m0, s22, 1024
  s_nop 0
  buffer_load_dwordx4 v65, s[8:11], s49 offen lds
  s_add_u32 m0, s22, 2048
  s_nop 0
  buffer_load_dwordx4 v66, s[8:11], s49 offen lds
  s_add_u32 m0, s22, 3072
  s_nop 0
  buffer_load_dwordx4 v67, s[8:11], s49 offen lds
  s_add_u32 m0, s22, 4096
  s_nop 0
  buffer_load_dwordx4 v68, s[8:11], s49 offen lds
  s_add_u32 s48, s48, 2048
  s_min_u32 s48, s48, s53
  s_add_u32 s50, s50, 36864
  s_cmp_lt_u32 s50, 147456
  s_cselect_b32 s50, s50, 0
  s_lshl_b32 s22, s20, 12
  s_add_u32 s22, s22, s50
  s_add_u32 s23, s48, s45
  s_add_u32 m0, s22, 0
  s_nop 0
  buffer_load_dwordx4 v4, s[12:15], s48 offen offset:0 sc1 lds
  s_add_u32 m0, s22, 0
  s_nop 0
  buffer_load_dwordx4 v4, s[12:15], s48 offen offset:1024 sc1 lds
  s_add_u32 m0, s22, 2048
  s_nop 0
  buffer_load_dwordx4 v4, s[12:15], s23 offen offset:0 sc1 lds
  s_add_u32 m0, s22, 2048
  s_nop 0
  buffer_load_dwordx4 v4, s[12:15], s23 offen offset:1024 sc1 lds
  s_mul_i32 s22, s20, 5120
  s_add_u32 s22, s22, s50
  s_add_u32 s22, s22, 16384
  s_add_u32 m0, s22, 0
  s_nop 0
  buffer_load_dwordx4 v69, s[8:11], s49 offen lds
  s_add_u32 m0, s22, 1024
  s_nop 0
  buffer_load_dwordx4 v70, s[8:11], s49 offen lds
  s_add_u32 m0, s22, 2048
  s_nop 0
  buffer_load_dwordx4 v71, s[8:11], s49 offen lds
  s_add_u32 m0, s22, 3072
  s_nop 0
  buffer_load_dwordx4 v72, s[8:11], s49 offen lds
  s_add_u32 m0, s22, 4096
  s_nop 0
  buffer_load_dwordx4 v73, s[8:11], s49 offen lds
  s_add_u32 s48, s48, 2048
  s_min_u32 s48, s48, s53
  s_add_u32 s50, s50, 36864
  s_cmp_lt_u32 s50, 147456
  s_cselect_b32 s50, s50, 0
  s_lshl_b32 s22, s20, 12
  s_add_u32 s22, s22, s50
  s_add_u32 s23, s48, s45
  s_add_u32 m0, s22, 0
  s_nop 0
  buffer_load_dwordx4 v4, s[12:15], s48 offen offset:0 sc1 lds
  s_add_u32 m0, s22, 0
  s_nop 0
  buffer_load_dwordx4 v4, s[12:15], s48 offen offset:1024 sc1 lds
  s_add_u32 m0, s22, 2048
  s_nop 0
  buffer_load_dwordx4 v4, s[12:15], s23 offen offset:0 sc1 lds
  s_add_u32 m0, s22, 2048
  s_nop 0
  buffer_load_dwordx4 v4, s[12:15], s23 offen offset:1024 sc1 lds
  s_mul_i32 s22, s20, 5120
  s_add_u32 s22, s22, s50
  s_add_u32 s22, s22, 16384
  s_add_u32 m0, s22, 0
  s_nop 0
  buffer_load_dwordx4 v74, s[8:11], s49 offen lds
  s_add_u32 m0, s22, 1024
  s_nop 0
  buffer_load_dwordx4 v75, s[8:11], s49 offen lds
  s_add_u32 m0, s22, 2048
  s_nop 0
  buffer_load_dwordx4 v76, s[8:11], s49 offen lds
  s_add_u32 m0, s22, 3072
  s_nop 0
  buffer_load_dwordx4 v77, s[8:11], s49 offen lds
  s_add_u32 m0, s22, 4096
  s_nop 0
  buffer_load_dwordx4 v78, s[8:11], s49 offen lds
  s_add_u32 s48, s48, 2048
  s_min_u32 s48, s48, s53
  s_add_u32 s49, s49, 245760
  s_add_u32 s50, s50, 36864
  s_cmp_lt_u32 s50, 147456
  s_cselect_b32 s50, s50, 0
  s_mov_b32 s52, 0
op_258:
  s_waitcnt vmcnt(18)
  s_barrier
  v_add_u32 v8, s51, v5
  v_add_u32 v9, s51, v6
  s_add_u32 s51, s51, 36864
  s_cmp_lt_u32 s51, 147456
  s_cselect_b32 s51, s51, 0
  ds_read_b128 v[160:163], v8 offset:0
  ds_read_b128 v[164:167], v8 offset:2048
  ds_read_b128 v[168:171], v8 offset:4096
  ds_read_b128 v[172:175], v8 offset:6144
  ds_read_b64_tr_b16 v[176:177], v9 offset:0
  ds_read_b64_tr_b16 v[178:179], v9 offset:1280
  ds_read_b64_tr_b16 v[180:181], v9 offset:32
  ds_read_b64_tr_b16 v[182:183], v9 offset:1312
  ds_read_b64_tr_b16 v[184:185], v9 offset:64
  ds_read_b64_tr_b16 v[186:187], v9 offset:1344
  ds_read_b64_tr_b16 v[188:189], v9 offset:96
  ds_read_b64_tr_b16 v[190:191], v9 offset:1376
  ds_read_b64_tr_b16 v[192:193], v9 offset:128
  ds_read_b64_tr_b16 v[194:195], v9 offset:1408
  s_lshl_b32 s22, s20, 12
  s_add_u32 s22, s22, s50
  s_add_u32 s23, s48, s45
  s_add_u32 m0, s22, 0
  s_nop 0
  buffer_load_dwordx4 v4, s[12:15], s48 offen offset:0 sc1 lds
  s_add_u32 m0, s22, 0
  s_nop 0
  buffer_load_dwordx4 v4, s[12:15], s48 offen offset:1024 sc1 lds
  s_add_u32 m0, s22, 2048
  s_nop 0
  buffer_load_dwordx4 v4, s[12:15], s23 offen offset:0 sc1 lds
  s_add_u32 m0, s22, 2048
  s_nop 0
  buffer_load_dwordx4 v4, s[12:15], s23 offen offset:1024 sc1 lds
  ds_read_b128 v[196:199], v8 offset:1024
  ds_read_b128 v[200:203], v8 offset:3072
  ds_read_b128 v[204:207], v8 offset:5120
  ds_read_b128 v[208:211], v8 offset:7168
  ds_read_b64_tr_b16 v[212:213], v9 offset:10240
  ds_read_b64_tr_b16 v[214:215], v9 offset:11520
  ds_read_b64_tr_b16 v[216:217], v9 offset:10272
  ds_read_b64_tr_b16 v[218:219], v9 offset:11552
  ds_read_b64_tr_b16 v[220:221], v9 offset:10304
  ds_read_b64_tr_b16 v[222:223], v9 offset:11584
  ds_read_b64_tr_b16 v[224:225], v9 offset:10336
  ds_read_b64_tr_b16 v[226:227], v9 offset:11616
  ds_read_b64_tr_b16 v[228:229], v9 offset:10368
  ds_read_b64_tr_b16 v[230:231], v9 offset:11648
  s_waitcnt lgkmcnt(14)
  v_mfma_f32_16x16x32_bf16 v[80:83], v[176:179], v[160:163], v[80:83]
  v_mfma_f32_16x16x32_bf16 v[84:87], v[180:183], v[160:163], v[84:87]
  v_mfma_f32_16x16x32_bf16 v[88:91], v[184:187], v[160:163], v[88:91]
  v_mfma_f32_16x16x32_bf16 v[92:95], v[188:191], v[160:163], v[92:95]
  v_mfma_f32_16x16x32_bf16 v[96:99], v[192:195], v[160:163], v[96:99]
  v_mfma_f32_16x16x32_bf16 v[100:103], v[176:179], v[164:167], v[100:103]
  v_mfma_f32_16x16x32_bf16 v[104:107], v[180:183], v[164:167], v[104:107]
  v_mfma_f32_16x16x32_bf16 v[108:111], v[184:187], v[164:167], v[108:111]
  v_mfma_f32_16x16x32_bf16 v[112:115], v[188:191], v[164:167], v[112:115]
  v_mfma_f32_16x16x32_bf16 v[116:119], v[192:195], v[164:167], v[116:119]
  v_mfma_f32_16x16x32_bf16 v[120:123], v[176:179], v[168:171], v[120:123]
  v_mfma_f32_16x16x32_bf16 v[124:127], v[180:183], v[168:171], v[124:127]
  v_mfma_f32_16x16x32_bf16 v[128:131], v[184:187], v[168:171], v[128:131]
  v_mfma_f32_16x16x32_bf16 v[132:135], v[188:191], v[168:171], v[132:135]
  v_mfma_f32_16x16x32_bf16 v[136:139], v[192:195], v[168:171], v[136:139]
  v_mfma_f32_16x16x32_bf16 v[140:143], v[176:179], v[172:175], v[140:143]
  v_mfma_f32_16x16x32_bf16 v[144:147], v[180:183], v[172:175], v[144:147]
  v_mfma_f32_16x16x32_bf16 v[148:151], v[184:187], v[172:175], v[148:151]
  v_mfma_f32_16x16x32_bf16 v[152:155], v[188:191], v[172:175], v[152:155]
  v_mfma_f32_16x16x32_bf16 v[156:159], v[192:195], v[172:175], v[156:159]
  s_mul_i32 s22, s20, 5120
  s_add_u32 s22, s22, s50
  s_add_u32 s22, s22, 16384
  s_add_u32 m0, s22, 0
  s_nop 0
  buffer_load_dwordx4 v64, s[8:11], s49 offen lds
  s_add_u32 m0, s22, 1024
  s_nop 0
  buffer_load_dwordx4 v65, s[8:11], s49 offen lds
  s_add_u32 m0, s22, 2048
  s_nop 0
  buffer_load_dwordx4 v66, s[8:11], s49 offen lds
  s_add_u32 m0, s22, 3072
  s_nop 0
  buffer_load_dwordx4 v67, s[8:11], s49 offen lds
  s_add_u32 m0, s22, 4096
  s_nop 0
  buffer_load_dwordx4 v68, s[8:11], s49 offen lds
  s_add_u32 s48, s48, 2048
  s_min_u32 s48, s48, s53
  s_add_u32 s50, s50, 36864
  s_cmp_lt_u32 s50, 147456
  s_cselect_b32 s50, s50, 0
  s_waitcnt lgkmcnt(0)
  v_mfma_f32_16x16x32_bf16 v[80:83], v[212:215], v[196:199], v[80:83]
  v_mfma_f32_16x16x32_bf16 v[84:87], v[216:219], v[196:199], v[84:87]
  v_mfma_f32_16x16x32_bf16 v[88:91], v[220:223], v[196:199], v[88:91]
  v_mfma_f32_16x16x32_bf16 v[92:95], v[224:227], v[196:199], v[92:95]
  v_mfma_f32_16x16x32_bf16 v[96:99], v[228:231], v[196:199], v[96:99]
  v_mfma_f32_16x16x32_bf16 v[100:103], v[212:215], v[200:203], v[100:103]
  v_mfma_f32_16x16x32_bf16 v[104:107], v[216:219], v[200:203], v[104:107]
  v_mfma_f32_16x16x32_bf16 v[108:111], v[220:223], v[200:203], v[108:111]
  v_mfma_f32_16x16x32_bf16 v[112:115], v[224:227], v[200:203], v[112:115]
  v_mfma_f32_16x16x32_bf16 v[116:119], v[228:231], v[200:203], v[116:119]
  v_mfma_f32_16x16x32_bf16 v[120:123], v[212:215], v[204:207], v[120:123]
  v_mfma_f32_16x16x32_bf16 v[124:127], v[216:219], v[204:207], v[124:127]
  v_mfma_f32_16x16x32_bf16 v[128:131], v[220:223], v[204:207], v[128:131]
  v_mfma_f32_16x16x32_bf16 v[132:135], v[224:227], v[204:207], v[132:135]
  v_mfma_f32_16x16x32_bf16 v[136:139], v[228:231], v[204:207], v[136:139]
  v_mfma_f32_16x16x32_bf16 v[140:143], v[212:215], v[208:211], v[140:143]
  v_mfma_f32_16x16x32_bf16 v[144:147], v[216:219], v[208:211], v[144:147]
  v_mfma_f32_16x16x32_bf16 v[148:151], v[220:223], v[208:211], v[148:151]
  v_mfma_f32_16x16x32_bf16 v[152:155], v[224:227], v[208:211], v[152:155]
  v_mfma_f32_16x16x32_bf16 v[156:159], v[228:231], v[208:211], v[156:159]
  s_add_u32 s52, s52, 1
  s_cmp_ge_u32 s52, s44
  s_cbranch_scc1 opd_259
  s_waitcnt vmcnt(18)
  s_barrier
  v_add_u32 v8, s51, v5
  v_add_u32 v9, s51, v6
  s_add_u32 s51, s51, 36864
  s_cmp_lt_u32 s51, 147456
  s_cselect_b32 s51, s51, 0
  ds_read_b128 v[160:163], v8 offset:0
  ds_read_b128 v[164:167], v8 offset:2048
  ds_read_b128 v[168:171], v8 offset:4096
  ds_read_b128 v[172:175], v8 offset:6144
  ds_read_b64_tr_b16 v[176:177], v9 offset:0
  ds_read_b64_tr_b16 v[178:179], v9 offset:1280
  ds_read_b64_tr_b16 v[180:181], v9 offset:32
  ds_read_b64_tr_b16 v[182:183], v9 offset:1312
  ds_read_b64_tr_b16 v[184:185], v9 offset:64
  ds_read_b64_tr_b16 v[186:187], v9 offset:1344
  ds_read_b64_tr_b16 v[188:189], v9 offset:96
  ds_read_b64_tr_b16 v[190:191], v9 offset:1376
  ds_read_b64_tr_b16 v[192:193], v9 offset:128
  ds_read_b64_tr_b16 v[194:195], v9 offset:1408
  s_lshl_b32 s22, s20, 12
  s_add_u32 s22, s22, s50
  s_add_u32 s23, s48, s45
  s_add_u32 m0, s22, 0
  s_nop 0
  buffer_load_dwordx4 v4, s[12:15], s48 offen offset:0 sc1 lds
  s_add_u32 m0, s22, 0
  s_nop 0
  buffer_load_dwordx4 v4, s[12:15], s48 offen offset:1024 sc1 lds
  s_add_u32 m0, s22, 2048
  s_nop 0
  buffer_load_dwordx4 v4, s[12:15], s23 offen offset:0 sc1 lds
  s_add_u32 m0, s22, 2048
  s_nop 0
  buffer_load_dwordx4 v4, s[12:15], s23 offen offset:1024 sc1 lds
  ds_read_b128 v[196:199], v8 offset:1024
  ds_read_b128 v[200:203], v8 offset:3072
  ds_read_b128 v[204:207], v8 offset:5120
  ds_read_b128 v[208:211], v8 offset:7168
  ds_read_b64_tr_b16 v[212:213], v9 offset:10240
  ds_read_b64_tr_b16 v[214:215], v9 offset:11520
  ds_read_b64_tr_b16 v[216:217], v9 offset:10272
  ds_read_b64_tr_b16 v[218:219], v9 offset:11552
  ds_read_b64_tr_b16 v[220:221], v9 offset:10304
  ds_read_b64_tr_b16 v[222:223], v9 offset:11584
  ds_read_b64_tr_b16 v[224:225], v9 offset:10336
  ds_read_b64_tr_b16 v[226:227], v9 offset:11616
  ds_read_b64_tr_b16 v[228:229], v9 offset:10368
  ds_read_b64_tr_b16 v[230:231], v9 offset:11648
  s_waitcnt lgkmcnt(14)
  v_mfma_f32_16x16x32_bf16 v[80:83], v[176:179], v[160:163], v[80:83]
  v_mfma_f32_16x16x32_bf16 v[84:87], v[180:183], v[160:163], v[84:87]
  v_mfma_f32_16x16x32_bf16 v[88:91], v[184:187], v[160:163], v[88:91]
  v_mfma_f32_16x16x32_bf16 v[92:95], v[188:191], v[160:163], v[92:95]
  v_mfma_f32_16x16x32_bf16 v[96:99], v[192:195], v[160:163], v[96:99]
  v_mfma_f32_16x16x32_bf16 v[100:103], v[176:179], v[164:167], v[100:103]
  v_mfma_f32_16x16x32_bf16 v[104:107], v[180:183], v[164:167], v[104:107]
  v_mfma_f32_16x16x32_bf16 v[108:111], v[184:187], v[164:167], v[108:111]
  v_mfma_f32_16x16x32_bf16 v[112:115], v[188:191], v[164:167], v[112:115]
  v_mfma_f32_16x16x32_bf16 v[116:119], v[192:195], v[164:167], v[116:119]
  v_mfma_f32_16x16x32_bf16 v[120:123], v[176:179], v[168:171], v[120:123]
  v_mfma_f32_16x16x32_bf16 v[124:127], v[180:183], v[168:171], v[124:127]
  v_mfma_f32_16x16x32_bf16 v[128:131], v[184:187], v[168:171], v[128:131]
  v_mfma_f32_16x16x32_bf16 v[132:135], v[188:191], v[168:171], v[132:135]
  v_mfma_f32_16x16x32_bf16 v[136:139], v[192:195], v[168:171], v[136:139]
  v_mfma_f32_16x16x32_bf16 v[140:143], v[176:179], v[172:175], v[140:143]
  v_mfma_f32_16x16x32_bf16 v[144:147], v[180:183], v[172:175], v[144:147]
  v_mfma_f32_16x16x32_bf16 v[148:151], v[184:187], v[172:175], v[148:151]
  v_mfma_f32_16x16x32_bf16 v[152:155], v[188:191], v[172:175], v[152:155]
  v_mfma_f32_16x16x32_bf16 v[156:159], v[192:195], v[172:175], v[156:159]
  s_mul_i32 s22, s20, 5120
  s_add_u32 s22, s22, s50
  s_add_u32 s22, s22, 16384
  s_add_u32 m0, s22, 0
  s_nop 0
  buffer_load_dwordx4 v69, s[8:11], s49 offen lds
  s_add_u32 m0, s22, 1024
  s_nop 0
  buffer_load_dwordx4 v70, s[8:11], s49 offen lds
  s_add_u32 m0, s22, 2048
  s_nop 0
  buffer_load_dwordx4 v71, s[8:11], s49 offen lds
  s_add_u32 m0, s22, 3072
  s_nop 0
  buffer_load_dwordx4 v72, s[8:11], s49 offen lds
  s_add_u32 m0, s22, 4096
  s_nop 0
  buffer_load_dwordx4 v73, s[8:11], s49 offen lds
  s_add_u32 s48, s48, 2048
  s_min_u32 s48, s48, s53
  s_add_u32 s50, s50, 36864
  s_cmp_lt_u32 s50, 147456
  s_cselect_b32 s50, s50, 0
  s_waitcnt lgkmcnt(0)
  v_mfma_f32_16x16x32_bf16 v[80:83], v[212:215], v[196:199], v[80:83]
  v_mfma_f32_16x16x32_bf16 v[84:87], v[216:219], v[196:199], v[84:87]
  v_mfma_f32_16x16x32_bf16 v[88:91], v[220:223], v[196:199], v[88:91]
  v_mfma_f32_16x16x32_bf16 v[92:95], v[224:227], v[196:199], v[92:95]
  v_mfma_f32_16x16x32_bf16 v[96:99], v[228:231], v[196:199], v[96:99]
  v_mfma_f32_16x16x32_bf16 v[100:103], v[212:215], v[200:203], v[100:103]
  v_mfma_f32_16x16x32_bf16 v[104:107], v[216:219], v[200:203], v[104:107]
  v_mfma_f32_16x16x32_bf16 v[108:111], v[220:223], v[200:203], v[108:111]
  v_mfma_f32_16x16x32_bf16 v[112:115], v[224:227], v[200:203], v[112:115]
  v_mfma_f32_16x16x32_bf16 v[116:119], v[228:231], v[200:203], v[116:119]
  v_mfma_f32_16x16x32_bf16 v[120:123], v[212:215], v[204:207], v[120:123]
  v_mfma_f32_16x16x32_bf16 v[124:127], v[216:219], v[204:207], v[124:127]
  v_mfma_f32_16x16x32_bf16 v[128:131], v[220:223], v[204:207], v[128:131]
  v_mfma_f32_16x16x32_bf16 v[132:135], v[224:227], v[204:207], v[132:135]
  v_mfma_f32_16x16x32_bf16 v[136:139], v[228:231], v[204:207], v[136:139]
  v_mfma_f32_16x16x32_bf16 v[140:143], v[212:215], v[208:211], v[140:143]
  v_mfma_f32_16x16x32_bf16 v[144:147], v[216:219], v[208:211], v[144:147]
  v_mfma_f32_16x16x32_bf16 v[148:151], v[220:223], v[208:211], v[148:151]
  v_mfma_f32_16x16x32_bf16 v[152:155], v[224:227], v[208:211], v[152:155]
  v_mfma_f32_16x16x32_bf16 v[156:159], v[228:231], v[208:211], v[156:159]
  s_add_u32 s52, s52, 1
  s_cmp_ge_u32 s52, s44
  s_cbranch_scc1 opd_259
  s_waitcnt vmcnt(18)
  s_barrier
  v_add_u32 v8, s51, v5
  v_add_u32 v9, s51, v6
  s_add_u32 s51, s51, 36864
  s_cmp_lt_u32 s51, 147456
  s_cselect_b32 s51, s51, 0
  ds_read_b128 v[160:163], v8 offset:0
  ds_read_b128 v[164:167], v8 offset:2048
  ds_read_b128 v[168:171], v8 offset:4096
  ds_read_b128 v[172:175], v8 offset:6144
  ds_read_b64_tr_b16 v[176:177], v9 offset:0
  ds_read_b64_tr_b16 v[178:179], v9 offset:1280
  ds_read_b64_tr_b16 v[180:181], v9 offset:32
  ds_read_b64_tr_b16 v[182:183], v9 offset:1312
  ds_read_b64_tr_b16 v[184:185], v9 offset:64
  ds_read_b64_tr_b16 v[186:187], v9 offset:1344
  ds_read_b64_tr_b16 v[188:189], v9 offset:96
  ds_read_b64_tr_b16 v[190:191], v9 offset:1376
  ds_read_b64_tr_b16 v[192:193], v9 offset:128
  ds_read_b64_tr_b16 v[194:195], v9 offset:1408
  s_lshl_b32 s22, s20, 12
  s_add_u32 s22, s22, s50
  s_add_u32 s23, s48, s45
  s_add_u32 m0, s22, 0
  s_nop 0
  buffer_load_dwordx4 v4, s[12:15], s48 offen offset:0 sc1 lds
  s_add_u32 m0, s22, 0
  s_nop 0
  buffer_load_dwordx4 v4, s[12:15], s48 offen offset:1024 sc1 lds
  s_add_u32 m0, s22, 2048
  s_nop 0
  buffer_load_dwordx4 v4, s[12:15], s23 offen offset:0 sc1 lds
  s_add_u32 m0, s22, 2048
  s_nop 0
  buffer_load_dwordx4 v4, s[12:15], s23 offen offset:1024 sc1 lds
  ds_read_b128 v[196:199], v8 offset:1024
  ds_read_b128 v[200:203], v8 offset:3072
  ds_read_b128 v[204:207], v8 offset:5120
  ds_read_b128 v[208:211], v8 offset:7168
  ds_read_b64_tr_b16 v[212:213], v9 offset:10240
  ds_read_b64_tr_b16 v[214:215], v9 offset:11520
  ds_read_b64_tr_b16 v[216:217], v9 offset:10272
  ds_read_b64_tr_b16 v[218:219], v9 offset:11552
  ds_read_b64_tr_b16 v[220:221], v9 offset:10304
  ds_read_b64_tr_b16 v[222:223], v9 offset:11584
  ds_read_b64_tr_b16 v[224:225], v9 offset:10336
  ds_read_b64_tr_b16 v[226:227], v9 offset:11616
  ds_read_b64_tr_b16 v[228:229], v9 offset:10368
  ds_read_b64_tr_b16 v[230:231], v9 offset:11648
  s_waitcnt lgkmcnt(14)
  v_mfma_f32_16x16x32_bf16 v[80:83], v[176:179], v[160:163], v[80:83]
  v_mfma_f32_16x16x32_bf16 v[84:87], v[180:183], v[160:163], v[84:87]
  v_mfma_f32_16x16x32_bf16 v[88:91], v[184:187], v[160:163], v[88:91]
  v_mfma_f32_16x16x32_bf16 v[92:95], v[188:191], v[160:163], v[92:95]
  v_mfma_f32_16x16x32_bf16 v[96:99], v[192:195], v[160:163], v[96:99]
  v_mfma_f32_16x16x32_bf16 v[100:103], v[176:179], v[164:167], v[100:103]
  v_mfma_f32_16x16x32_bf16 v[104:107], v[180:183], v[164:167], v[104:107]
  v_mfma_f32_16x16x32_bf16 v[108:111], v[184:187], v[164:167], v[108:111]
  v_mfma_f32_16x16x32_bf16 v[112:115], v[188:191], v[164:167], v[112:115]
  v_mfma_f32_16x16x32_bf16 v[116:119], v[192:195], v[164:167], v[116:119]
  v_mfma_f32_16x16x32_bf16 v[120:123], v[176:179], v[168:171], v[120:123]
  v_mfma_f32_16x16x32_bf16 v[124:127], v[180:183], v[168:171], v[124:127]
  v_mfma_f32_16x16x32_bf16 v[128:131], v[184:187], v[168:171], v[128:131]
  v_mfma_f32_16x16x32_bf16 v[132:135], v[188:191], v[168:171], v[132:135]
  v_mfma_f32_16x16x32_bf16 v[136:139], v[192:195], v[168:171], v[136:139]
  v_mfma_f32_16x16x32_bf16 v[140:143], v[176:179], v[172:175], v[140:143]
  v_mfma_f32_16x16x32_bf16 v[144:147], v[180:183], v[172:175], v[144:147]
  v_mfma_f32_16x16x32_bf16 v[148:151], v[184:187], v[172:175], v[148:151]
  v_mfma_f32_16x16x32_bf16 v[152:155], v[188:191], v[172:175], v[152:155]
  v_mfma_f32_16x16x32_bf16 v[156:159], v[192:195], v[172:175], v[156:159]
  s_mul_i32 s22, s20, 5120
  s_add_u32 s22, s22, s50
  s_add_u32 s22, s22, 16384
  s_add_u32 m0, s22, 0
  s_nop 0
  buffer_load_dwordx4 v74, s[8:11], s49 offen lds
  s_add_u32 m0, s22, 1024
  s_nop 0
  buffer_load_dwordx4 v75, s[8:11], s49 offen lds
  s_add_u32 m0, s22, 2048
  s_nop 0
  buffer_load_dwordx4 v76, s[8:11], s49 offen lds
  s_add_u32 m0, s22, 3072
  s_nop 0
  buffer_load_dwordx4 v77, s[8:11], s49 offen lds
  s_add_u32 m0, s22, 4096
  s_nop 0
  buffer_load_dwordx4 v78, s[8:11], s49 offen lds
  s_add_u32 s48, s48, 2048
  s_min_u32 s48, s48, s53
  s_add_u32 s49, s49, 245760
  s_add_u32 s50, s50, 36864
  s_cmp_lt_u32 s50, 147456
  s_cselect_b32 s50, s50, 0
  s_waitcnt lgkmcnt(0)
  v_mfma_f32_16x16x32_bf16 v[80:83], v[212:215], v[196:199], v[80:83]
  v_mfma_f32_16x16x32_bf16 v[84:87], v[216:219], v[196:199], v[84:87]
  v_mfma_f32_16x16x32_bf16 v[88:91], v[220:223], v[196:199], v[88:91]
  v_mfma_f32_16x16x32_bf16 v[92:95], v[224:227], v[196:199], v[92:95]
  v_mfma_f32_16x16x32_bf16 v[96:99], v[228:231], v[196:199], v[96:99]
  v_mfma_f32_16x16x32_bf16 v[100:103], v[212:215], v[200:203], v[100:103]
  v_mfma_f32_16x16x32_bf16 v[104:107], v[216:219], v[200:203], v[104:107]
  v_mfma_f32_16x16x32_bf16 v[108:111], v[220:223], v[200:203], v[108:111]
  v_mfma_f32_16x16x32_bf16 v[112:115], v[224:227], v[200:203], v[112:115]
  v_mfma_f32_16x16x32_bf16 v[116:119], v[228:231], v[200:203], v[116:119]
  v_mfma_f32_16x16x32_bf16 v[120:123], v[212:215], v[204:207], v[120:123]
  v_mfma_f32_16x16x32_bf16 v[124:127], v[216:219], v[204:207], v[124:127]
  v_mfma_f32_16x16x32_bf16 v[128:131], v[220:223], v[204:207], v[128:131]
  v_mfma_f32_16x16x32_bf16 v[132:135], v[224:227], v[204:207], v[132:135]
  v_mfma_f32_16x16x32_bf16 v[136:139], v[228:231], v[204:207], v[136:139]
  v_mfma_f32_16x16x32_bf16 v[140:143], v[212:215], v[208:211], v[140:143]
  v_mfma_f32_16x16x32_bf16 v[144:147], v[216:219], v[208:211], v[144:147]
  v_mfma_f32_16x16x32_bf16 v[148:151], v[220:223], v[208:211], v[148:151]
  v_mfma_f32_16x16x32_bf16 v[152:155], v[224:227], v[208:211], v[152:155]
  v_mfma_f32_16x16x32_bf16 v[156:159], v[228:231], v[208:211], v[156:159]
  s_add_u32 s52, s52, 1
  s_cmp_ge_u32 s52, s44
  s_cbranch_scc1 opd_259
  s_branch op_258
opd_259:
  s_nop 7
  s_lshl_b32 s21, s40, 3
  s_lshr_b32 s22, s20, 1
  s_lshl_b32 s22, s22, 2
  s_add_u32 s21, s21, s22
  s_mul_i32 s21, s21, 40960
  s_mul_i32 s22, s42, 10
  s_and_b32 s23, s20, 1
  s_mul_i32 s23, s23, 5
  s_add_u32 s22, s22, s23
  s_lshl_b32 s22, s22, 10
  s_add_u32 s21, s21, s22
  buffer_store_dwordx4 v[80:83], v4, s[16:19], s21 offen offset:0 sc1
  buffer_store_dwordx4 v[84:87], v4, s[16:19], s21 offen offset:1024 sc1
  buffer_store_dwordx4 v[88:91], v4, s[16:19], s21 offen offset:2048 sc1
  buffer_store_dwordx4 v[92:95], v4, s[16:19], s21 offen offset:3072 sc1
  s_add_u32 s22, s21, 4096
  buffer_store_dwordx4 v[96:99], v4, s[16:19], s22 offen offset:0 sc1
  s_add_u32 s21, s21, 40960
  buffer_store_dwordx4 v[100:103], v4, s[16:19], s21 offen offset:0 sc1
  buffer_store_dwordx4 v[104:107], v4, s[16:19], s21 offen offset:1024 sc1
  buffer_store_dwordx4 v[108:111], v4, s[16:19], s21 offen offset:2048 sc1
  buffer_store_dwordx4 v[112:115], v4, s[16:19], s21 offen offset:3072 sc1
  s_add_u32 s22, s21, 4096
  buffer_store_dwordx4 v[116:119], v4, s[16:19], s22 offen offset:0 sc1
  s_add_u32 s21, s21, 40960
  buffer_store_dwordx4 v[120:123], v4, s[16:19], s21 offen offset:0 sc1
  buffer_store_dwordx4 v[124:127], v4, s[16:19], s21 offen offset:1024 sc1
  buffer_store_dwordx4 v[128:131], v4, s[16:19], s21 offen offset:2048 sc1
  buffer_store_dwordx4 v[132:135], v4, s[16:19], s21 offen offset:3072 sc1
  s_add_u32 s22, s21, 4096
  buffer_store_dwordx4 v[136:139], v4, s[16:19], s22 offen offset:0 sc1
  s_add_u32 s21, s21, 40960
  buffer_store_dwordx4 v[140:143], v4, s[16:19], s21 offen offset:0 sc1
  buffer_store_dwordx4 v[144:147], v4, s[16:19], s21 offen offset:1024 sc1
  buffer_store_dwordx4 v[148:151], v4, s[16:19], s21 offen offset:2048 sc1
  buffer_store_dwordx4 v[152:155], v4, s[16:19], s21 offen offset:3072 sc1
  s_add_u32 s22, s21, 4096
  buffer_store_dwordx4 v[156:159], v4, s[16:19], s22 offen offset:0 sc1
  s_add_u32 s21, s21, 40960
  s_waitcnt vmcnt(0)
  s_barrier
  s_lshl_b32 s21, s40, 7
  s_add_u32 s21, s21, 92160
  s_cmp_lg_u32 s20, 0
  s_cbranch_scc1 af_260
  v_mov_b32 v10, 0
  v_mov_b32 v11, 1
  s_mov_b64 exec, 1
  buffer_atomic_add v11, v10, s[72:75], s21 offen sc1
  s_mov_b64 exec, -1
  s_nop 1
af_260:
  s_branch queue
do_pv:
  s_mov_b32 s2, s21
  s_load_dwordx2 s[4:5], s[0:1], 88
  s_load_dwordx2 s[38:39], s[0:1], 104
  s_waitcnt lgkmcnt(0)
  s_mov_b32 s8, s4
  s_mov_b32 s9, s5
  s_mov_b32 s10, 2621440
  s_mov_b32 s11, 0x00020000
  s_add_u32 s12, s38, 114294784
  s_addc_u32 s13, s39, 0
  s_mov_b32 s14, 83886080
  s_mov_b32 s15, 0x00020000
  s_mov_b32 s59, 0
  s_mov_b32 s60, 0
  s_add_u32 s16, s38, 85983232
  s_addc_u32 s17, s39, 0
  s_mov_b32 s18, 28311552
  s_mov_b32 s19, 0x00020000
  s_add_u32 s24, s38, 73400320
  s_addc_u32 s25, s39, 0
  s_mov_b32 s26, 5242880
  s_mov_b32 s27, 0x00020000
  s_add_u32 s28, s38, 81002496
  s_addc_u32 s29, s39, 0
  s_mov_b32 s30, 8192
  s_mov_b32 s31, 0x00020000
  s_add_u32 s72, s38, 81068032
  s_addc_u32 s73, s39, 0
  s_mov_b32 s74, 115712
  s_mov_b32 s75, 0x00020000
  v_lshlrev_b32 v4, 4, v1
  v_lshlrev_b32 v5, 3, v1
  v_lshlrev_b32 v6, 2, v2
  v_and_b32 v7, 7, v1
  v_lshlrev_b32 v7, 7, v7
  v_lshrrev_b32 v31, 3, v1
  v_lshl_add_u32 v208, v31, 10, v7
  v_bfe_u32 v31, v1, 3, 2
  v_lshl_add_u32 v31, v31, 2, v7
  s_lshl_b32 s21, s20, 10
  s_add_u32 s21, s21, 94208
  buffer_load_dword v8, v31, s[72:75], s21 offen sc1
  v_lshlrev_b32 v25, 7, v2
  s_mov_b32 s21, 92160
  buffer_load_dword v26, v25, s[72:75], s21 offen sc1
  s_mov_b32 s63, 1
  v_mul_u32_u24 v9, 1280, v2
  v_lshl_add_u32 v9, v3, 3, v9
  s_lshl_b32 s21, s20, 13
  v_add_u32 v10, s21, v4
  s_lshl_b32 s21, s20, 10
  v_add_u32 v11, s21, v4
  v_lshrrev_b32 v20, 5, v1
  v_mul_u32_u24 v21, 2560, v20
  v_add_u32 v21, v21, v4
  v_and_b32 v22, 31, v1
  v_lshlrev_b32 v22, 4, v22
  v_mul_u32_u24 v20, 10240, v20
  v_add_u32 v22, v22, v20
  v_mov_b32 v28, 80
  v_mov_b32 v30, 32768
  s_mov_b32 s50, 0
  s_mov_b32 s51, 0
  s_and_b32 s43, s20, 1
  s_lshr_b32 s44, s20, 1
  v_mov_b32 v70, 0
  v_mov_b32 v71, 0
  v_mov_b32 v78, 0
  v_mov_b32 v79, 0
  v_mov_b32 v86, 0
  v_mov_b32 v87, 0
  v_mov_b32 v94, 0
  v_mov_b32 v95, 0
  v_mov_b32 v102, 0
  v_mov_b32 v103, 0
  v_mov_b32 v110, 0
  v_mov_b32 v111, 0
  v_mov_b32 v118, 0
  v_mov_b32 v119, 0
  v_mov_b32 v126, 0
  v_mov_b32 v127, 0
  s_mov_b32 s21, s2
pv_loop:
  s_mov_b32 s2, s21
  s_mul_hi_u32 s40, s2, 0x1999999a
  s_mul_i32 s21, s40, 10
  s_sub_u32 s41, s2, s21
  s_lshl_b32 s52, s40, 10
  s_add_u32 s52, s52, 22528
  buffer_load_dword v27, v7, s[72:75], s52 offen sc1
  s_cmp_lg_u32 s20, 0
  s_cbranch_scc1 pv_269

  v_mov_b32 v29, 1
  s_mov_b64 exec, 1
  buffer_atomic_add v29, v28, s[32:35], 0 offen sc0 sc1
  s_mov_b64 exec, -1
pv_269:
  s_lshl_b32 s42, s40, 5
  s_lshl_b32 s21, s20, 3
  s_add_u32 s42, s42, s21
  s_mul_i32 s61, s21, 5
  s_lshr_b32 s22, s41, 1
  s_add_u32 s61, s61, s22
  s_and_b32 s62, s41, 1
  s_lshl_b32 s62, s62, 12
  s_mul_i32 s53, s42, 40960
  s_lshl_b32 s22, s41, 12
  s_add_u32 s53, s53, s22
  s_lshl_b32 s21, s40, 1
  s_add_u32 s21, s21, s43
  s_lshl_b32 s45, s21, 6
  s_mul_i32 s46, s21, 20480
  s_mul_i32 s21, s21, 40
  s_lshl_b32 s22, s41, 2
  s_add_u32 s22, s22, s44
  s_add_u32 s21, s21, s22
  s_lshl_b32 s54, s21, 10
  s_lshl_b32 s22, s22, 5
  s_add_u32 s46, s46, s22
  s_mul_i32 s47, s42, 2560
  s_mul_i32 s48, s42, 10240
  s_lshl_b32 s22, s41, 10
  s_add_u32 s48, s48, s22
  s_add_u32 s48, s48, 7340032
  s_add_u32 s23, s40, 1
  s_cmp_ge_u32 s50, s23
  s_cbranch_scc1 pv_262
  s_cmp_eq_u32 s63, 0
  s_cbranch_scc1 pv_265
  s_mov_b32 s63, 0
  s_waitcnt vmcnt(1)
  v_cmp_le_u32 vcc, 4, v26
  s_mov_b32 s51, vcc_lo
  v_cmp_gt_u32 vcc, s23, v8
  s_nop 1
  s_cbranch_vccz pv_266
pv_265:
  s_lshl_b32 s21, s20, 10
  s_add_u32 s21, s21, 94208
  s_mov_b32 s101, 0
wm_270:
  buffer_load_dword v8, v31, s[72:75], s21 offen sc1
  s_add_u32 s101, s101, 1
  s_cmp_gt_u32 s101, 131072
  s_cbranch_scc1 main_end
  s_waitcnt vmcnt(0)
  v_cmp_gt_u32 vcc, s23, v8
  v_readfirstlane_b32 s100, v8
  s_nop 0
  s_cbranch_vccz wm_271
  s_sleep 8
  s_add_u32 s100, s100, 2
  s_cmp_ge_u32 s100, s23
  s_cbranch_scc1 wm_270
  s_sleep 60
  s_branch wm_270
wm_271:
pv_266:
  v_readlane_b32 s50, v8, 0
  v_readlane_b32 s21, v8, 1
  s_min_u32 s50, s50, s21
  v_readlane_b32 s21, v8, 2
  s_min_u32 s50, s50, s21
  v_readlane_b32 s21, v8, 3
  s_min_u32 s50, s50, s21
  v_readlane_b32 s21, v8, 4
  s_min_u32 s50, s50, s21
  v_readlane_b32 s21, v8, 5
  s_min_u32 s50, s50, s21
  v_readlane_b32 s21, v8, 6
  s_min_u32 s50, s50, s21
  v_readlane_b32 s21, v8, 7
  s_min_u32 s50, s50, s21
  v_readlane_b32 s21, v8, 8
  s_min_u32 s50, s50, s21
  v_readlane_b32 s21, v8, 9
  s_min_u32 s50, s50, s21
  v_readlane_b32 s21, v8, 10
  s_min_u32 s50, s50, s21
  v_readlane_b32 s21, v8, 11
  s_min_u32 s50, s50, s21
  v_readlane_b32 s21, v8, 12
  s_min_u32 s50, s50, s21
  v_readlane_b32 s21, v8, 13
  s_min_u32 s50, s50, s21
  v_readlane_b32 s21, v8, 14
  s_min_u32 s50, s50, s21
  v_readlane_b32 s21, v8, 15
  s_min_u32 s50, s50, s21
  v_readlane_b32 s21, v8, 16
  s_min_u32 s50, s50, s21
  v_readlane_b32 s21, v8, 17
  s_min_u32 s50, s50, s21
  v_readlane_b32 s21, v8, 18
  s_min_u32 s50, s50, s21
  v_readlane_b32 s21, v8, 19
  s_min_u32 s50, s50, s21
  v_readlane_b32 s21, v8, 20
  s_min_u32 s50, s50, s21
  v_readlane_b32 s21, v8, 21
  s_min_u32 s50, s50, s21
  v_readlane_b32 s21, v8, 22
  s_min_u32 s50, s50, s21
  v_readlane_b32 s21, v8, 23
  s_min_u32 s50, s50, s21
  v_readlane_b32 s21, v8, 24
  s_min_u32 s50, s50, s21
  v_readlane_b32 s21, v8, 25
  s_min_u32 s50, s50, s21
  v_readlane_b32 s21, v8, 26
  s_min_u32 s50, s50, s21
  v_readlane_b32 s21, v8, 27
  s_min_u32 s50, s50, s21
  v_readlane_b32 s21, v8, 28
  s_min_u32 s50, s50, s21
  v_readlane_b32 s21, v8, 29
  s_min_u32 s50, s50, s21
  v_readlane_b32 s21, v8, 30
  s_min_u32 s50, s50, s21
  v_readlane_b32 s21, v8, 31
  s_min_u32 s50, s50, s21
pv_262:
  s_lshr_b32 s22, s40, 2
  s_cmp_lt_u32 s40, 0
  s_cbranch_scc1 pv_263
  s_bitcmp1_b32 s51, s22
  s_cbranch_scc1 pv_263
  s_mov_b32 s21, 92160
  v_lshlrev_b32 v25, 7, v2
  s_mov_b32 s101, 0
pv_264:
  buffer_load_dword v26, v25, s[72:75], s21 offen sc1
  s_add_u32 s101, s101, 1
  s_cmp_gt_u32 s101, 131072
  s_cbranch_scc1 main_end
  s_waitcnt vmcnt(0)
  v_cmp_le_u32 vcc, 4, v26
  s_mov_b32 s51, vcc_lo
  s_bitcmp1_b32 s51, s22
  s_cbranch_scc1 pv_263
  s_sleep 8
  s_branch pv_264
pv_263:
  buffer_load_dwordx4 a[0:3], v4, s[12:15], s53 offen offset:0 sc1
  buffer_load_dwordx4 a[4:7], v4, s[12:15], s53 offen offset:1024 sc1
  buffer_load_dwordx4 a[8:11], v4, s[12:15], s53 offen offset:2048 sc1
  buffer_load_dwordx4 a[12:15], v4, s[12:15], s53 offen offset:3072 sc1
  s_add_u32 s53, s53, 40960
  buffer_load_dwordx4 a[16:19], v4, s[12:15], s53 offen offset:0 sc1
  buffer_load_dwordx4 a[20:23], v4, s[12:15], s53 offen offset:1024 sc1
  buffer_load_dwordx4 a[24:27], v4, s[12:15], s53 offen offset:2048 sc1
  buffer_load_dwordx4 a[28:31], v4, s[12:15], s53 offen offset:3072 sc1
  s_add_u32 s53, s53, 40960
  buffer_load_dwordx4 a[32:35], v4, s[12:15], s53 offen offset:0 sc1
  buffer_load_dwordx4 a[36:39], v4, s[12:15], s53 offen offset:1024 sc1
  buffer_load_dwordx4 a[40:43], v4, s[12:15], s53 offen offset:2048 sc1
  buffer_load_dwordx4 a[44:47], v4, s[12:15], s53 offen offset:3072 sc1
  s_add_u32 s53, s53, 40960
  buffer_load_dwordx4 a[48:51], v4, s[12:15], s53 offen offset:0 sc1
  buffer_load_dwordx4 a[52:55], v4, s[12:15], s53 offen offset:1024 sc1
  buffer_load_dwordx4 a[56:59], v4, s[12:15], s53 offen offset:2048 sc1
  buffer_load_dwordx4 a[60:63], v4, s[12:15], s53 offen offset:3072 sc1
  s_add_u32 s53, s53, 40960
  buffer_load_dwordx4 a[64:67], v4, s[12:15], s53 offen offset:0 sc1
  buffer_load_dwordx4 a[68:71], v4, s[12:15], s53 offen offset:1024 sc1
  buffer_load_dwordx4 a[72:75], v4, s[12:15], s53 offen offset:2048 sc1
  buffer_load_dwordx4 a[76:79], v4, s[12:15], s53 offen offset:3072 sc1
  s_add_u32 s53, s53, 40960
  buffer_load_dwordx4 a[80:83], v4, s[12:15], s53 offen offset:0 sc1
  buffer_load_dwordx4 a[84:87], v4, s[12:15], s53 offen offset:1024 sc1
  buffer_load_dwordx4 a[88:91], v4, s[12:15], s53 offen offset:2048 sc1
  buffer_load_dwordx4 a[92:95], v4, s[12:15], s53 offen offset:3072 sc1
  s_add_u32 s53, s53, 40960
  buffer_load_dwordx4 a[96:99], v4, s[12:15], s53 offen offset:0 sc1
  buffer_load_dwordx4 a[100:103], v4, s[12:15], s53 offen offset:1024 sc1
  buffer_load_dwordx4 a[104:107], v4, s[12:15], s53 offen offset:2048 sc1
  buffer_load_dwordx4 a[108:111], v4, s[12:15], s53 offen offset:3072 sc1
  s_add_u32 s53, s53, 40960
  buffer_load_dwordx4 a[112:115], v4, s[12:15], s53 offen offset:0 sc1
  buffer_load_dwordx4 a[116:119], v4, s[12:15], s53 offen offset:1024 sc1
  buffer_load_dwordx4 a[120:123], v4, s[12:15], s53 offen offset:2048 sc1
  buffer_load_dwordx4 a[124:127], v4, s[12:15], s53 offen offset:3072 sc1
  buffer_load_dwordx4 v[12:15], v4, s[24:27], s54 offen sc1
  buffer_load_dwordx4 v[16:19], v4, s[24:27], s54 offen offset:2048 sc1
  buffer_load_dword v24, v6, s[28:31], s45 offen sc1
  s_waitcnt vmcnt(35)
  v_cmp_le_u32 s[68:69], 20, v27
  s_nop 1
  s_and_b32 s21, s68, 255
  s_cmp_lg_u32 s21, 255
  s_cbranch_scc1 pvw_267
  buffer_load_dwordx4 v[64:67], v4, s[16:19], s47 offen sc1
  buffer_load_dwordx2 v[68:69], v5, s[16:19], s47 offen offset:2048 sc1
  buffer_load_dwordx4 v[128:131], v21, s[16:19], s47 offen offset:1024 sc1
  s_add_u32 s47, s47, 2560
  buffer_load_dwordx4 v[72:75], v4, s[16:19], s47 offen sc1
  buffer_load_dwordx2 v[76:77], v5, s[16:19], s47 offen offset:2048 sc1
  s_add_u32 s47, s47, 2560
  buffer_load_dwordx4 v[80:83], v4, s[16:19], s47 offen sc1
  buffer_load_dwordx2 v[84:85], v5, s[16:19], s47 offen offset:2048 sc1
  buffer_load_dwordx4 v[132:135], v21, s[16:19], s47 offen offset:1024 sc1
  s_add_u32 s47, s47, 2560
  buffer_load_dwordx4 v[88:91], v4, s[16:19], s47 offen sc1
  buffer_load_dwordx2 v[92:93], v5, s[16:19], s47 offen offset:2048 sc1
  s_add_u32 s47, s47, 2560
  buffer_load_dwordx4 v[32:35], v22, s[16:19], s48 offen offset:0 sc1
  buffer_load_dwordx4 v[40:43], v22, s[16:19], s48 offen offset:512 sc1
  s_add_u32 s48, s48, 20480
  buffer_load_dwordx4 v[36:39], v22, s[16:19], s48 offen offset:0 sc1
  buffer_load_dwordx4 v[44:47], v22, s[16:19], s48 offen offset:512 sc1
  s_add_u32 s48, s48, 20480
  buffer_load_dwordx4 v[96:99], v4, s[16:19], s47 offen sc1
  buffer_load_dwordx2 v[100:101], v5, s[16:19], s47 offen offset:2048 sc1
  buffer_load_dwordx4 v[136:139], v21, s[16:19], s47 offen offset:1024 sc1
  s_add_u32 s47, s47, 2560
  buffer_load_dwordx4 v[104:107], v4, s[16:19], s47 offen sc1
  buffer_load_dwordx2 v[108:109], v5, s[16:19], s47 offen offset:2048 sc1
  s_add_u32 s47, s47, 2560
  buffer_load_dwordx4 v[112:115], v4, s[16:19], s47 offen sc1
  buffer_load_dwordx2 v[116:117], v5, s[16:19], s47 offen offset:2048 sc1
  buffer_load_dwordx4 v[140:143], v21, s[16:19], s47 offen offset:1024 sc1
  s_add_u32 s47, s47, 2560
  buffer_load_dwordx4 v[120:123], v4, s[16:19], s47 offen sc1
  buffer_load_dwordx2 v[124:125], v5, s[16:19], s47 offen offset:2048 sc1
  s_add_u32 s47, s47, 2560
  buffer_load_dwordx4 v[48:51], v22, s[16:19], s48 offen offset:0 sc1
  buffer_load_dwordx4 v[56:59], v22, s[16:19], s48 offen offset:512 sc1
  s_add_u32 s48, s48, 20480
  buffer_load_dwordx4 v[52:55], v22, s[16:19], s48 offen offset:0 sc1
  buffer_load_dwordx4 v[60:63], v22, s[16:19], s48 offen offset:512 sc1
  s_add_u32 s48, s48, 20480
  s_barrier
  s_waitcnt vmcnt(28)
  v_sub_f32 v25, 1.0, v24
  v_cvt_pk_bf16_f32 v26, v25, v25
  v_lshlrev_b32 v25, 16, v26
  v_cvt_pk_bf16_f32 v26, v12, v12
  v_lshlrev_b32 v12, 16, v26
  v_cvt_pk_bf16_f32 v26, v13, v13
  v_lshlrev_b32 v13, 16, v26
  v_cvt_pk_bf16_f32 v26, v14, v14
  v_lshlrev_b32 v14, 16, v26
  v_cvt_pk_bf16_f32 v26, v15, v15
  v_lshlrev_b32 v15, 16, v26
  v_cvt_pk_bf16_f32 v26, v16, v16
  v_lshlrev_b32 v16, 16, v26
  v_cvt_pk_bf16_f32 v26, v17, v17
  v_lshlrev_b32 v17, 16, v26
  v_cvt_pk_bf16_f32 v26, v18, v18
  v_lshlrev_b32 v18, 16, v26
  v_cvt_pk_bf16_f32 v26, v19, v19
  v_lshlrev_b32 v19, 16, v26
  v_mul_f32 v12, v12, v25
  v_cvt_pk_bf16_f32 v26, v12, v12
  v_lshlrev_b32 v12, 16, v26
  v_mul_f32 v13, v13, v25
  v_cvt_pk_bf16_f32 v26, v13, v13
  v_lshlrev_b32 v13, 16, v26
  v_mul_f32 v14, v14, v25
  v_cvt_pk_bf16_f32 v26, v14, v14
  v_lshlrev_b32 v14, 16, v26
  v_mul_f32 v15, v15, v25
  v_cvt_pk_bf16_f32 v26, v15, v15
  v_lshlrev_b32 v15, 16, v26
  v_mul_f32 v16, v16, v25
  v_cvt_pk_bf16_f32 v26, v16, v16
  v_lshlrev_b32 v16, 16, v26
  v_mul_f32 v17, v17, v25
  v_cvt_pk_bf16_f32 v26, v17, v17
  v_lshlrev_b32 v17, 16, v26
  v_mul_f32 v18, v18, v25
  v_cvt_pk_bf16_f32 v26, v18, v18
  v_lshlrev_b32 v18, 16, v26
  v_mul_f32 v19, v19, v25
  v_cvt_pk_bf16_f32 v26, v19, v19
  v_lshlrev_b32 v19, 16, v26
  s_branch pvg_272
pvw_267:
  s_waitcnt vmcnt(0)
  v_sub_f32 v25, 1.0, v24
  v_cvt_pk_bf16_f32 v26, v25, v25
  v_lshlrev_b32 v25, 16, v26
  v_cvt_pk_bf16_f32 v26, v12, v12
  v_lshlrev_b32 v12, 16, v26
  v_cvt_pk_bf16_f32 v26, v13, v13
  v_lshlrev_b32 v13, 16, v26
  v_cvt_pk_bf16_f32 v26, v14, v14
  v_lshlrev_b32 v14, 16, v26
  v_cvt_pk_bf16_f32 v26, v15, v15
  v_lshlrev_b32 v15, 16, v26
  v_cvt_pk_bf16_f32 v26, v16, v16
  v_lshlrev_b32 v16, 16, v26
  v_cvt_pk_bf16_f32 v26, v17, v17
  v_lshlrev_b32 v17, 16, v26
  v_cvt_pk_bf16_f32 v26, v18, v18
  v_lshlrev_b32 v18, 16, v26
  v_cvt_pk_bf16_f32 v26, v19, v19
  v_lshlrev_b32 v19, 16, v26
  v_mul_f32 v12, v12, v25
  v_cvt_pk_bf16_f32 v26, v12, v12
  v_lshlrev_b32 v12, 16, v26
  v_mul_f32 v13, v13, v25
  v_cvt_pk_bf16_f32 v26, v13, v13
  v_lshlrev_b32 v13, 16, v26
  v_mul_f32 v14, v14, v25
  v_cvt_pk_bf16_f32 v26, v14, v14
  v_lshlrev_b32 v14, 16, v26
  v_mul_f32 v15, v15, v25
  v_cvt_pk_bf16_f32 v26, v15, v15
  v_lshlrev_b32 v15, 16, v26
  v_mul_f32 v16, v16, v25
  v_cvt_pk_bf16_f32 v26, v16, v16
  v_lshlrev_b32 v16, 16, v26
  v_mul_f32 v17, v17, v25
  v_cvt_pk_bf16_f32 v26, v17, v17
  v_lshlrev_b32 v17, 16, v26
  v_mul_f32 v18, v18, v25
  v_cvt_pk_bf16_f32 v26, v18, v18
  v_lshlrev_b32 v18, 16, v26
  v_mul_f32 v19, v19, v25
  v_cvt_pk_bf16_f32 v26, v19, v19
  v_lshlrev_b32 v19, 16, v26
  s_cmp_ge_u32 s40, 56
  s_cbranch_scc1 pvt_273
  s_cmp_lg_u32 s20, 0
  s_cbranch_scc1 wm_275
  s_mov_b32 s101, 0
wm_274:
  buffer_load_dword v26, v7, s[72:75], s52 offen sc1
  s_add_u32 s101, s101, 1
  s_cmp_gt_u32 s101, 131072
  s_cbranch_scc1 main_end
  s_waitcnt vmcnt(0)
  v_cmp_gt_u32 vcc, 20, v26
  v_readfirstlane_b32 s100, v26
  s_nop 0
  s_cbranch_vccz wm_275
  s_sleep 2
  s_add_u32 s100, s100, 19
  s_cmp_ge_u32 s100, 20
  s_cbranch_scc1 wm_274
  s_sleep 24
  s_branch wm_274
wm_275:
  s_barrier
  buffer_load_dwordx4 v[64:67], v4, s[16:19], s47 offen sc1
  buffer_load_dwordx2 v[68:69], v5, s[16:19], s47 offen offset:2048 sc1
  buffer_load_dwordx4 v[128:131], v21, s[16:19], s47 offen offset:1024 sc1
  s_add_u32 s47, s47, 2560
  buffer_load_dwordx4 v[72:75], v4, s[16:19], s47 offen sc1
  buffer_load_dwordx2 v[76:77], v5, s[16:19], s47 offen offset:2048 sc1
  s_add_u32 s47, s47, 2560
  buffer_load_dwordx4 v[80:83], v4, s[16:19], s47 offen sc1
  buffer_load_dwordx2 v[84:85], v5, s[16:19], s47 offen offset:2048 sc1
  buffer_load_dwordx4 v[132:135], v21, s[16:19], s47 offen offset:1024 sc1
  s_add_u32 s47, s47, 2560
  buffer_load_dwordx4 v[88:91], v4, s[16:19], s47 offen sc1
  buffer_load_dwordx2 v[92:93], v5, s[16:19], s47 offen offset:2048 sc1
  s_add_u32 s47, s47, 2560
  buffer_load_dwordx4 v[32:35], v22, s[16:19], s48 offen offset:0 sc1
  buffer_load_dwordx4 v[40:43], v22, s[16:19], s48 offen offset:512 sc1
  s_add_u32 s48, s48, 20480
  buffer_load_dwordx4 v[36:39], v22, s[16:19], s48 offen offset:0 sc1
  buffer_load_dwordx4 v[44:47], v22, s[16:19], s48 offen offset:512 sc1
  s_add_u32 s48, s48, 20480
  buffer_load_dwordx4 v[96:99], v4, s[16:19], s47 offen sc1
  buffer_load_dwordx2 v[100:101], v5, s[16:19], s47 offen offset:2048 sc1
  buffer_load_dwordx4 v[136:139], v21, s[16:19], s47 offen offset:1024 sc1
  s_add_u32 s47, s47, 2560
  buffer_load_dwordx4 v[104:107], v4, s[16:19], s47 offen sc1
  buffer_load_dwordx2 v[108:109], v5, s[16:19], s47 offen offset:2048 sc1
  s_add_u32 s47, s47, 2560
  buffer_load_dwordx4 v[112:115], v4, s[16:19], s47 offen sc1
  buffer_load_dwordx2 v[116:117], v5, s[16:19], s47 offen offset:2048 sc1
  buffer_load_dwordx4 v[140:143], v21, s[16:19], s47 offen offset:1024 sc1
  s_add_u32 s47, s47, 2560
  buffer_load_dwordx4 v[120:123], v4, s[16:19], s47 offen sc1
  buffer_load_dwordx2 v[124:125], v5, s[16:19], s47 offen offset:2048 sc1
  s_add_u32 s47, s47, 2560
  buffer_load_dwordx4 v[48:51], v22, s[16:19], s48 offen offset:0 sc1
  buffer_load_dwordx4 v[56:59], v22, s[16:19], s48 offen offset:512 sc1
  s_add_u32 s48, s48, 20480
  buffer_load_dwordx4 v[52:55], v22, s[16:19], s48 offen offset:0 sc1
  buffer_load_dwordx4 v[60:63], v22, s[16:19], s48 offen offset:512 sc1
  s_add_u32 s48, s48, 20480
pvg_272:
  s_waitcnt vmcnt(26)
  v_mfma_f32_16x16x32_bf16 v[148:151], a[0:3], v[64:67], 0
  v_mfma_f32_16x16x32_bf16 v[144:147], a[0:3], v[68:71], 0
  v_mfma_f32_16x16x32_bf16 v[156:159], a[4:7], v[64:67], 0
  v_mfma_f32_16x16x32_bf16 v[152:155], a[4:7], v[68:71], 0
  v_mfma_f32_16x16x32_bf16 v[164:167], a[8:11], v[64:67], 0
  v_mfma_f32_16x16x32_bf16 v[160:163], a[8:11], v[68:71], 0
  v_mfma_f32_16x16x32_bf16 v[172:175], a[12:15], v[64:67], 0
  v_mfma_f32_16x16x32_bf16 v[168:171], a[12:15], v[68:71], 0
  s_waitcnt vmcnt(23)
  v_mfma_f32_16x16x32_bf16 v[148:151], a[16:19], v[72:75], v[148:151]
  v_mfma_f32_16x16x32_bf16 v[144:147], a[16:19], v[76:79], v[144:147]
  v_mfma_f32_16x16x32_bf16 v[156:159], a[20:23], v[72:75], v[156:159]
  v_mfma_f32_16x16x32_bf16 v[152:155], a[20:23], v[76:79], v[152:155]
  v_mfma_f32_16x16x32_bf16 v[164:167], a[24:27], v[72:75], v[164:167]
  v_mfma_f32_16x16x32_bf16 v[160:163], a[24:27], v[76:79], v[160:163]
  v_mfma_f32_16x16x32_bf16 v[172:175], a[28:31], v[72:75], v[172:175]
  v_mfma_f32_16x16x32_bf16 v[168:171], a[28:31], v[76:79], v[168:171]
  s_waitcnt vmcnt(21)
  v_mfma_f32_16x16x32_bf16 v[148:151], a[32:35], v[80:83], v[148:151]
  v_mfma_f32_16x16x32_bf16 v[144:147], a[32:35], v[84:87], v[144:147]
  v_mfma_f32_16x16x32_bf16 v[156:159], a[36:39], v[80:83], v[156:159]
  v_mfma_f32_16x16x32_bf16 v[152:155], a[36:39], v[84:87], v[152:155]
  v_mfma_f32_16x16x32_bf16 v[164:167], a[40:43], v[80:83], v[164:167]
  v_mfma_f32_16x16x32_bf16 v[160:163], a[40:43], v[84:87], v[160:163]
  v_mfma_f32_16x16x32_bf16 v[172:175], a[44:47], v[80:83], v[172:175]
  v_mfma_f32_16x16x32_bf16 v[168:171], a[44:47], v[84:87], v[168:171]
  s_waitcnt vmcnt(18)
  v_mfma_f32_16x16x32_bf16 v[148:151], a[48:51], v[88:91], v[148:151]
  v_mfma_f32_16x16x32_bf16 v[144:147], a[48:51], v[92:95], v[144:147]
  v_mfma_f32_16x16x32_bf16 v[156:159], a[52:55], v[88:91], v[156:159]
  v_mfma_f32_16x16x32_bf16 v[152:155], a[52:55], v[92:95], v[152:155]
  v_mfma_f32_16x16x32_bf16 v[164:167], a[56:59], v[88:91], v[164:167]
  v_mfma_f32_16x16x32_bf16 v[160:163], a[56:59], v[92:95], v[160:163]
  v_mfma_f32_16x16x32_bf16 v[172:175], a[60:63], v[88:91], v[172:175]
  v_mfma_f32_16x16x32_bf16 v[168:171], a[60:63], v[92:95], v[168:171]
  s_waitcnt vmcnt(14)
  v_swap_b32 v130, v132
  v_swap_b32 v131, v133
  v_swap_b32 v34, v36
  v_swap_b32 v35, v37
  v_swap_b32 v42, v44
  v_swap_b32 v43, v45
  s_nop 1
  v_mfma_f32_16x16x32_bf16 v[144:147], v[32:35], v[128:131], v[144:147]
  v_mfma_f32_16x16x32_bf16 v[148:151], v[32:35], v[132:135], v[148:151]
  v_mfma_f32_16x16x32_bf16 v[152:155], v[36:39], v[128:131], v[152:155]
  v_mfma_f32_16x16x32_bf16 v[156:159], v[36:39], v[132:135], v[156:159]
  v_mfma_f32_16x16x32_bf16 v[160:163], v[40:43], v[128:131], v[160:163]
  v_mfma_f32_16x16x32_bf16 v[164:167], v[40:43], v[132:135], v[164:167]
  v_mfma_f32_16x16x32_bf16 v[168:171], v[44:47], v[128:131], v[168:171]
  v_mfma_f32_16x16x32_bf16 v[172:175], v[44:47], v[132:135], v[172:175]
  s_waitcnt vmcnt(12)
  v_mfma_f32_16x16x32_bf16 v[148:151], a[64:67], v[96:99], v[148:151]
  v_mfma_f32_16x16x32_bf16 v[144:147], a[64:67], v[100:103], v[144:147]
  v_mfma_f32_16x16x32_bf16 v[156:159], a[68:71], v[96:99], v[156:159]
  v_mfma_f32_16x16x32_bf16 v[152:155], a[68:71], v[100:103], v[152:155]
  v_mfma_f32_16x16x32_bf16 v[164:167], a[72:75], v[96:99], v[164:167]
  v_mfma_f32_16x16x32_bf16 v[160:163], a[72:75], v[100:103], v[160:163]
  v_mfma_f32_16x16x32_bf16 v[172:175], a[76:79], v[96:99], v[172:175]
  v_mfma_f32_16x16x32_bf16 v[168:171], a[76:79], v[100:103], v[168:171]
  s_waitcnt vmcnt(9)
  v_mfma_f32_16x16x32_bf16 v[148:151], a[80:83], v[104:107], v[148:151]
  v_mfma_f32_16x16x32_bf16 v[144:147], a[80:83], v[108:111], v[144:147]
  v_mfma_f32_16x16x32_bf16 v[156:159], a[84:87], v[104:107], v[156:159]
  v_mfma_f32_16x16x32_bf16 v[152:155], a[84:87], v[108:111], v[152:155]
  v_mfma_f32_16x16x32_bf16 v[164:167], a[88:91], v[104:107], v[164:167]
  v_mfma_f32_16x16x32_bf16 v[160:163], a[88:91], v[108:111], v[160:163]
  v_mfma_f32_16x16x32_bf16 v[172:175], a[92:95], v[104:107], v[172:175]
  v_mfma_f32_16x16x32_bf16 v[168:171], a[92:95], v[108:111], v[168:171]
  s_waitcnt vmcnt(7)
  v_mfma_f32_16x16x32_bf16 v[148:151], a[96:99], v[112:115], v[148:151]
  v_mfma_f32_16x16x32_bf16 v[144:147], a[96:99], v[116:119], v[144:147]
  v_mfma_f32_16x16x32_bf16 v[156:159], a[100:103], v[112:115], v[156:159]
  v_mfma_f32_16x16x32_bf16 v[152:155], a[100:103], v[116:119], v[152:155]
  v_mfma_f32_16x16x32_bf16 v[164:167], a[104:107], v[112:115], v[164:167]
  v_mfma_f32_16x16x32_bf16 v[160:163], a[104:107], v[116:119], v[160:163]
  v_mfma_f32_16x16x32_bf16 v[172:175], a[108:111], v[112:115], v[172:175]
  v_mfma_f32_16x16x32_bf16 v[168:171], a[108:111], v[116:119], v[168:171]
  s_waitcnt vmcnt(4)
  v_mfma_f32_16x16x32_bf16 v[148:151], a[112:115], v[120:123], v[148:151]
  v_mfma_f32_16x16x32_bf16 v[144:147], a[112:115], v[124:127], v[144:147]
  v_mfma_f32_16x16x32_bf16 v[156:159], a[116:119], v[120:123], v[156:159]
  v_mfma_f32_16x16x32_bf16 v[152:155], a[116:119], v[124:127], v[152:155]
  v_mfma_f32_16x16x32_bf16 v[164:167], a[120:123], v[120:123], v[164:167]
  v_mfma_f32_16x16x32_bf16 v[160:163], a[120:123], v[124:127], v[160:163]
  v_mfma_f32_16x16x32_bf16 v[172:175], a[124:127], v[120:123], v[172:175]
  v_mfma_f32_16x16x32_bf16 v[168:171], a[124:127], v[124:127], v[168:171]
  s_waitcnt vmcnt(0)
  v_swap_b32 v138, v140
  v_swap_b32 v139, v141
  v_swap_b32 v50, v52
  v_swap_b32 v51, v53
  v_swap_b32 v58, v60
  v_swap_b32 v59, v61
  s_nop 1
  v_mfma_f32_16x16x32_bf16 v[144:147], v[48:51], v[136:139], v[144:147]
  v_mfma_f32_16x16x32_bf16 v[148:151], v[48:51], v[140:143], v[148:151]
  v_mfma_f32_16x16x32_bf16 v[152:155], v[52:55], v[136:139], v[152:155]
  v_mfma_f32_16x16x32_bf16 v[156:159], v[52:55], v[140:143], v[156:159]
  v_mfma_f32_16x16x32_bf16 v[160:163], v[56:59], v[136:139], v[160:163]
  v_mfma_f32_16x16x32_bf16 v[164:167], v[56:59], v[140:143], v[164:167]
  v_mfma_f32_16x16x32_bf16 v[168:171], v[60:63], v[136:139], v[168:171]
  v_mfma_f32_16x16x32_bf16 v[172:175], v[60:63], v[140:143], v[172:175]
  s_branch pve_268
pvt_273:
  s_sub_u32 s55, s52, 1024
  s_cmp_lg_u32 s20, 0
  s_cbranch_scc1 wm_277
  s_mov_b32 s101, 0
wm_276:
  buffer_load_dword v26, v7, s[72:75], s55 offen sc1
  s_add_u32 s101, s101, 1
  s_cmp_gt_u32 s101, 131072
  s_cbranch_scc1 main_end
  s_waitcnt vmcnt(0)
  v_cmp_gt_u32 vcc, 20, v26
  v_readfirstlane_b32 s100, v26
  s_nop 0
  s_cbranch_vccz wm_277
  s_sleep 4
  s_add_u32 s100, s100, 19
  s_cmp_ge_u32 s100, 20
  s_cbranch_scc1 wm_276
  s_sleep 24
  s_branch wm_276
wm_277:
  s_barrier
  s_mov_b32 s56, s47
  s_mov_b32 s57, s48
  buffer_load_dwordx4 v[64:67], v4, s[16:19], s56 offen sc1
  buffer_load_dwordx2 v[68:69], v5, s[16:19], s56 offen offset:2048 sc1
  buffer_load_dwordx4 v[128:131], v21, s[16:19], s56 offen offset:1024 sc1
  s_add_u32 s56, s56, 2560
  buffer_load_dwordx4 v[72:75], v4, s[16:19], s56 offen sc1
  buffer_load_dwordx2 v[76:77], v5, s[16:19], s56 offen offset:2048 sc1
  s_add_u32 s56, s56, 2560
  buffer_load_dwordx4 v[80:83], v4, s[16:19], s56 offen sc1
  buffer_load_dwordx2 v[84:85], v5, s[16:19], s56 offen offset:2048 sc1
  buffer_load_dwordx4 v[132:135], v21, s[16:19], s56 offen offset:1024 sc1
  s_add_u32 s56, s56, 2560
  buffer_load_dwordx4 v[88:91], v4, s[16:19], s56 offen sc1
  buffer_load_dwordx2 v[92:93], v5, s[16:19], s56 offen offset:2048 sc1
  s_add_u32 s56, s56, 2560
  buffer_load_dwordx4 v[32:35], v22, s[16:19], s57 offen offset:0 sc1
  buffer_load_dwordx4 v[40:43], v22, s[16:19], s57 offen offset:512 sc1
  s_add_u32 s57, s57, 20480
  buffer_load_dwordx4 v[36:39], v22, s[16:19], s57 offen offset:0 sc1
  buffer_load_dwordx4 v[44:47], v22, s[16:19], s57 offen offset:512 sc1
  s_add_u32 s57, s57, 20480
  buffer_load_dwordx4 v[96:99], v4, s[16:19], s56 offen sc1
  buffer_load_dwordx2 v[100:101], v5, s[16:19], s56 offen offset:2048 sc1
  buffer_load_dwordx4 v[136:139], v21, s[16:19], s56 offen offset:1024 sc1
  s_add_u32 s56, s56, 2560
  buffer_load_dwordx4 v[104:107], v4, s[16:19], s56 offen sc1
  buffer_load_dwordx2 v[108:109], v5, s[16:19], s56 offen offset:2048 sc1
  s_add_u32 s56, s56, 2560
  buffer_load_dwordx4 v[112:115], v4, s[16:19], s56 offen sc1
  buffer_load_dwordx2 v[116:117], v5, s[16:19], s56 offen offset:2048 sc1
  buffer_load_dwordx4 v[140:143], v21, s[16:19], s56 offen offset:1024 sc1
  s_add_u32 s56, s56, 2560
  buffer_load_dwordx4 v[120:123], v4, s[16:19], s56 offen sc1
  buffer_load_dwordx2 v[124:125], v5, s[16:19], s56 offen offset:2048 sc1
  s_add_u32 s56, s56, 2560
  buffer_load_dwordx4 v[48:51], v22, s[16:19], s57 offen offset:0 sc1
  buffer_load_dwordx4 v[56:59], v22, s[16:19], s57 offen offset:512 sc1
  s_add_u32 s57, s57, 20480
  buffer_load_dwordx4 v[52:55], v22, s[16:19], s57 offen offset:0 sc1
  buffer_load_dwordx4 v[60:63], v22, s[16:19], s57 offen offset:512 sc1
  s_add_u32 s57, s57, 20480
  s_mov_b32 s101, 0
  s_waitcnt vmcnt(14)
  s_branch pvr_279
pvr_278:
  s_sleep 2
  s_add_u32 s56, s47, 0
  s_add_u32 s57, s48, 0
  buffer_load_dwordx4 v[64:67], v4, s[16:19], s56 offen sc1
  buffer_load_dwordx2 v[68:69], v5, s[16:19], s56 offen offset:2048 sc1
  buffer_load_dwordx4 v[128:131], v21, s[16:19], s56 offen offset:1024 sc1
  s_add_u32 s56, s56, 2560
  buffer_load_dwordx4 v[72:75], v4, s[16:19], s56 offen sc1
  buffer_load_dwordx2 v[76:77], v5, s[16:19], s56 offen offset:2048 sc1
  s_add_u32 s56, s56, 2560
  buffer_load_dwordx4 v[80:83], v4, s[16:19], s56 offen sc1
  buffer_load_dwordx2 v[84:85], v5, s[16:19], s56 offen offset:2048 sc1
  buffer_load_dwordx4 v[132:135], v21, s[16:19], s56 offen offset:1024 sc1
  s_add_u32 s56, s56, 2560
  buffer_load_dwordx4 v[88:91], v4, s[16:19], s56 offen sc1
  buffer_load_dwordx2 v[92:93], v5, s[16:19], s56 offen offset:2048 sc1
  s_add_u32 s56, s56, 2560
  buffer_load_dwordx4 v[32:35], v22, s[16:19], s57 offen offset:0 sc1
  buffer_load_dwordx4 v[40:43], v22, s[16:19], s57 offen offset:512 sc1
  s_add_u32 s57, s57, 20480
  buffer_load_dwordx4 v[36:39], v22, s[16:19], s57 offen offset:0 sc1
  buffer_load_dwordx4 v[44:47], v22, s[16:19], s57 offen offset:512 sc1
  s_add_u32 s57, s57, 20480
  s_add_u32 s101, s101, 1
  s_cmp_gt_u32 s101, 131072
  s_cbranch_scc1 main_end
  s_waitcnt vmcnt(0)
pvr_279:
  v_max3_u32 v26, v64, v68, v72
  v_max3_u32 v26, v26, v76, v80
  v_max3_u32 v26, v26, v84, v88
  v_max3_u32 v26, v26, v92, v128
  v_max3_u32 v26, v26, v132, v32
  v_max3_u32 v26, v26, v36, v40
  v_max3_u32 v26, v26, v44, v44
  v_cmp_eq_u32 vcc, -1, v26
  s_nop 1
  s_cbranch_vccnz pvr_278
  v_mfma_f32_16x16x32_bf16 v[148:151], a[0:3], v[64:67], 0
  v_mfma_f32_16x16x32_bf16 v[144:147], a[0:3], v[68:71], 0
  v_mfma_f32_16x16x32_bf16 v[156:159], a[4:7], v[64:67], 0
  v_mfma_f32_16x16x32_bf16 v[152:155], a[4:7], v[68:71], 0
  v_mfma_f32_16x16x32_bf16 v[164:167], a[8:11], v[64:67], 0
  v_mfma_f32_16x16x32_bf16 v[160:163], a[8:11], v[68:71], 0
  v_mfma_f32_16x16x32_bf16 v[172:175], a[12:15], v[64:67], 0
  v_mfma_f32_16x16x32_bf16 v[168:171], a[12:15], v[68:71], 0
  v_mfma_f32_16x16x32_bf16 v[148:151], a[16:19], v[72:75], v[148:151]
  v_mfma_f32_16x16x32_bf16 v[144:147], a[16:19], v[76:79], v[144:147]
  v_mfma_f32_16x16x32_bf16 v[156:159], a[20:23], v[72:75], v[156:159]
  v_mfma_f32_16x16x32_bf16 v[152:155], a[20:23], v[76:79], v[152:155]
  v_mfma_f32_16x16x32_bf16 v[164:167], a[24:27], v[72:75], v[164:167]
  v_mfma_f32_16x16x32_bf16 v[160:163], a[24:27], v[76:79], v[160:163]
  v_mfma_f32_16x16x32_bf16 v[172:175], a[28:31], v[72:75], v[172:175]
  v_mfma_f32_16x16x32_bf16 v[168:171], a[28:31], v[76:79], v[168:171]
  v_mfma_f32_16x16x32_bf16 v[148:151], a[32:35], v[80:83], v[148:151]
  v_mfma_f32_16x16x32_bf16 v[144:147], a[32:35], v[84:87], v[144:147]
  v_mfma_f32_16x16x32_bf16 v[156:159], a[36:39], v[80:83], v[156:159]
  v_mfma_f32_16x16x32_bf16 v[152:155], a[36:39], v[84:87], v[152:155]
  v_mfma_f32_16x16x32_bf16 v[164:167], a[40:43], v[80:83], v[164:167]
  v_mfma_f32_16x16x32_bf16 v[160:163], a[40:43], v[84:87], v[160:163]
  v_mfma_f32_16x16x32_bf16 v[172:175], a[44:47], v[80:83], v[172:175]
  v_mfma_f32_16x16x32_bf16 v[168:171], a[44:47], v[84:87], v[168:171]
  v_mfma_f32_16x16x32_bf16 v[148:151], a[48:51], v[88:91], v[148:151]
  v_mfma_f32_16x16x32_bf16 v[144:147], a[48:51], v[92:95], v[144:147]
  v_mfma_f32_16x16x32_bf16 v[156:159], a[52:55], v[88:91], v[156:159]
  v_mfma_f32_16x16x32_bf16 v[152:155], a[52:55], v[92:95], v[152:155]
  v_mfma_f32_16x16x32_bf16 v[164:167], a[56:59], v[88:91], v[164:167]
  v_mfma_f32_16x16x32_bf16 v[160:163], a[56:59], v[92:95], v[160:163]
  v_mfma_f32_16x16x32_bf16 v[172:175], a[60:63], v[88:91], v[172:175]
  v_mfma_f32_16x16x32_bf16 v[168:171], a[60:63], v[92:95], v[168:171]
  v_swap_b32 v130, v132
  v_swap_b32 v131, v133
  v_swap_b32 v34, v36
  v_swap_b32 v35, v37
  v_swap_b32 v42, v44
  v_swap_b32 v43, v45
  s_nop 1
  v_mfma_f32_16x16x32_bf16 v[144:147], v[32:35], v[128:131], v[144:147]
  v_mfma_f32_16x16x32_bf16 v[148:151], v[32:35], v[132:135], v[148:151]
  v_mfma_f32_16x16x32_bf16 v[152:155], v[36:39], v[128:131], v[152:155]
  v_mfma_f32_16x16x32_bf16 v[156:159], v[36:39], v[132:135], v[156:159]
  v_mfma_f32_16x16x32_bf16 v[160:163], v[40:43], v[128:131], v[160:163]
  v_mfma_f32_16x16x32_bf16 v[164:167], v[40:43], v[132:135], v[164:167]
  v_mfma_f32_16x16x32_bf16 v[168:171], v[44:47], v[128:131], v[168:171]
  v_mfma_f32_16x16x32_bf16 v[172:175], v[44:47], v[132:135], v[172:175]
  s_mov_b32 s101, 0
  s_waitcnt vmcnt(0)
  s_branch pvr_281
pvr_280:
  s_sleep 2
  s_add_u32 s56, s47, 10240
  s_add_u32 s57, s48, 40960
  buffer_load_dwordx4 v[96:99], v4, s[16:19], s56 offen sc1
  buffer_load_dwordx2 v[100:101], v5, s[16:19], s56 offen offset:2048 sc1
  buffer_load_dwordx4 v[136:139], v21, s[16:19], s56 offen offset:1024 sc1
  s_add_u32 s56, s56, 2560
  buffer_load_dwordx4 v[104:107], v4, s[16:19], s56 offen sc1
  buffer_load_dwordx2 v[108:109], v5, s[16:19], s56 offen offset:2048 sc1
  s_add_u32 s56, s56, 2560
  buffer_load_dwordx4 v[112:115], v4, s[16:19], s56 offen sc1
  buffer_load_dwordx2 v[116:117], v5, s[16:19], s56 offen offset:2048 sc1
  buffer_load_dwordx4 v[140:143], v21, s[16:19], s56 offen offset:1024 sc1
  s_add_u32 s56, s56, 2560
  buffer_load_dwordx4 v[120:123], v4, s[16:19], s56 offen sc1
  buffer_load_dwordx2 v[124:125], v5, s[16:19], s56 offen offset:2048 sc1
  s_add_u32 s56, s56, 2560
  buffer_load_dwordx4 v[48:51], v22, s[16:19], s57 offen offset:0 sc1
  buffer_load_dwordx4 v[56:59], v22, s[16:19], s57 offen offset:512 sc1
  s_add_u32 s57, s57, 20480
  buffer_load_dwordx4 v[52:55], v22, s[16:19], s57 offen offset:0 sc1
  buffer_load_dwordx4 v[60:63], v22, s[16:19], s57 offen offset:512 sc1
  s_add_u32 s57, s57, 20480
  s_add_u32 s101, s101, 1
  s_cmp_gt_u32 s101, 131072
  s_cbranch_scc1 main_end
  s_waitcnt vmcnt(0)
pvr_281:
  v_max3_u32 v26, v96, v100, v104
  v_max3_u32 v26, v26, v108, v112
  v_max3_u32 v26, v26, v116, v120
  v_max3_u32 v26, v26, v124, v136
  v_max3_u32 v26, v26, v140, v48
  v_max3_u32 v26, v26, v52, v56
  v_max3_u32 v26, v26, v60, v60
  v_cmp_eq_u32 vcc, -1, v26
  s_nop 1
  s_cbranch_vccnz pvr_280
  v_mfma_f32_16x16x32_bf16 v[148:151], a[64:67], v[96:99], v[148:151]
  v_mfma_f32_16x16x32_bf16 v[144:147], a[64:67], v[100:103], v[144:147]
  v_mfma_f32_16x16x32_bf16 v[156:159], a[68:71], v[96:99], v[156:159]
  v_mfma_f32_16x16x32_bf16 v[152:155], a[68:71], v[100:103], v[152:155]
  v_mfma_f32_16x16x32_bf16 v[164:167], a[72:75], v[96:99], v[164:167]
  v_mfma_f32_16x16x32_bf16 v[160:163], a[72:75], v[100:103], v[160:163]
  v_mfma_f32_16x16x32_bf16 v[172:175], a[76:79], v[96:99], v[172:175]
  v_mfma_f32_16x16x32_bf16 v[168:171], a[76:79], v[100:103], v[168:171]
  v_mfma_f32_16x16x32_bf16 v[148:151], a[80:83], v[104:107], v[148:151]
  v_mfma_f32_16x16x32_bf16 v[144:147], a[80:83], v[108:111], v[144:147]
  v_mfma_f32_16x16x32_bf16 v[156:159], a[84:87], v[104:107], v[156:159]
  v_mfma_f32_16x16x32_bf16 v[152:155], a[84:87], v[108:111], v[152:155]
  v_mfma_f32_16x16x32_bf16 v[164:167], a[88:91], v[104:107], v[164:167]
  v_mfma_f32_16x16x32_bf16 v[160:163], a[88:91], v[108:111], v[160:163]
  v_mfma_f32_16x16x32_bf16 v[172:175], a[92:95], v[104:107], v[172:175]
  v_mfma_f32_16x16x32_bf16 v[168:171], a[92:95], v[108:111], v[168:171]
  v_mfma_f32_16x16x32_bf16 v[148:151], a[96:99], v[112:115], v[148:151]
  v_mfma_f32_16x16x32_bf16 v[144:147], a[96:99], v[116:119], v[144:147]
  v_mfma_f32_16x16x32_bf16 v[156:159], a[100:103], v[112:115], v[156:159]
  v_mfma_f32_16x16x32_bf16 v[152:155], a[100:103], v[116:119], v[152:155]
  v_mfma_f32_16x16x32_bf16 v[164:167], a[104:107], v[112:115], v[164:167]
  v_mfma_f32_16x16x32_bf16 v[160:163], a[104:107], v[116:119], v[160:163]
  v_mfma_f32_16x16x32_bf16 v[172:175], a[108:111], v[112:115], v[172:175]
  v_mfma_f32_16x16x32_bf16 v[168:171], a[108:111], v[116:119], v[168:171]
  v_mfma_f32_16x16x32_bf16 v[148:151], a[112:115], v[120:123], v[148:151]
  v_mfma_f32_16x16x32_bf16 v[144:147], a[112:115], v[124:127], v[144:147]
  v_mfma_f32_16x16x32_bf16 v[156:159], a[116:119], v[120:123], v[156:159]
  v_mfma_f32_16x16x32_bf16 v[152:155], a[116:119], v[124:127], v[152:155]
  v_mfma_f32_16x16x32_bf16 v[164:167], a[120:123], v[120:123], v[164:167]
  v_mfma_f32_16x16x32_bf16 v[160:163], a[120:123], v[124:127], v[160:163]
  v_mfma_f32_16x16x32_bf16 v[172:175], a[124:127], v[120:123], v[172:175]
  v_mfma_f32_16x16x32_bf16 v[168:171], a[124:127], v[124:127], v[168:171]
  v_swap_b32 v138, v140
  v_swap_b32 v139, v141
  v_swap_b32 v50, v52
  v_swap_b32 v51, v53
  v_swap_b32 v58, v60
  v_swap_b32 v59, v61
  s_nop 1
  v_mfma_f32_16x16x32_bf16 v[144:147], v[48:51], v[136:139], v[144:147]
  v_mfma_f32_16x16x32_bf16 v[148:151], v[48:51], v[140:143], v[148:151]
  v_mfma_f32_16x16x32_bf16 v[152:155], v[52:55], v[136:139], v[152:155]
  v_mfma_f32_16x16x32_bf16 v[156:159], v[52:55], v[140:143], v[156:159]
  v_mfma_f32_16x16x32_bf16 v[160:163], v[56:59], v[136:139], v[160:163]
  v_mfma_f32_16x16x32_bf16 v[164:167], v[56:59], v[140:143], v[164:167]
  v_mfma_f32_16x16x32_bf16 v[168:171], v[60:63], v[136:139], v[168:171]
  v_mfma_f32_16x16x32_bf16 v[172:175], v[60:63], v[140:143], v[172:175]
pve_268:
  s_nop 0
  s_cmp_eq_u32 s84, 0
  s_cbranch_scc1 ps_282
  s_lshl_b32 s21, s84, 7
  s_add_u32 s21, s21, 18304
  v_mov_b32 v25, 0
  buffer_load_dword v27, v25, s[72:75], s21 offen sc1
ps_282:
  ds_write_b128 v10, v[144:147] offset:0
  ds_write_b128 v10, v[148:151] offset:1024
  ds_write_b128 v10, v[152:155] offset:2048
  ds_write_b128 v10, v[156:159] offset:3072
  ds_write_b128 v10, v[160:163] offset:4096
  ds_write_b128 v10, v[164:167] offset:5120
  ds_write_b128 v10, v[168:171] offset:6144
  ds_write_b128 v10, v[172:175] offset:7168
  s_cmp_lg_u32 s20, 0
  s_cbranch_scc1 pvq_285
  v_readfirstlane_b32 s21, v29
  s_mov_b32 s23, -1
  v_mov_b32 v213, s23
  s_mov_b64 exec, 1
  ds_write_b32 v30, v29
  ds_write_b32 v30, v213 offset:8
  s_mov_b64 exec, -1
pvq_285:
  s_waitcnt lgkmcnt(0)
  s_barrier
  ds_read_b128 v[176:179], v11 offset:0
  ds_read_b128 v[180:183], v11 offset:8192
  ds_read_b128 v[184:187], v11 offset:16384
  ds_read_b128 v[188:191], v11 offset:24576
  ds_read_b128 v[192:195], v11 offset:4096
  ds_read_b128 v[196:199], v11 offset:12288
  ds_read_b128 v[200:203], v11 offset:20480
  ds_read_b128 v[204:207], v11 offset:28672
  ds_read_b32 v23, v30
  ds_read_b32 v213, v30 offset:8
  s_waitcnt lgkmcnt(6)
  v_pk_add_f32 v[176:177], v[176:177], v[180:181]
  v_pk_add_f32 v[184:185], v[184:185], v[188:189]
  v_pk_add_f32 v[178:179], v[178:179], v[182:183]
  v_pk_add_f32 v[186:187], v[186:187], v[190:191]
  v_pk_add_f32 v[176:177], v[176:177], v[184:185]
  v_pk_add_f32 v[178:179], v[178:179], v[186:187]
  v_cvt_pk_bf16_f32 v26, v176, v177
  v_lshlrev_b32 v176, 16, v26
  v_and_b32 v177, 0xffff0000, v26
  v_mul_f32 v176, v176, v24
  v_mul_f32 v177, v177, v24
  v_cvt_pk_bf16_f32 v26, v176, v177
  v_lshlrev_b32 v176, 16, v26
  v_and_b32 v177, 0xffff0000, v26
  v_add_f32 v176, v176, v12
  v_add_f32 v177, v177, v13
  v_cvt_pk_bf16_f32 v180, v176, v177
  v_cvt_pk_bf16_f32 v26, v178, v179
  v_lshlrev_b32 v178, 16, v26
  v_and_b32 v179, 0xffff0000, v26
  v_mul_f32 v178, v178, v24
  v_mul_f32 v179, v179, v24
  v_cvt_pk_bf16_f32 v26, v178, v179
  v_lshlrev_b32 v178, 16, v26
  v_and_b32 v179, 0xffff0000, v26
  v_add_f32 v178, v178, v14
  v_add_f32 v179, v179, v15
  v_cvt_pk_bf16_f32 v181, v178, v179
  buffer_store_dwordx2 v[180:181], v9, s[8:11], s46 offen offset:0
  s_waitcnt lgkmcnt(2)
  v_pk_add_f32 v[192:193], v[192:193], v[196:197]
  v_pk_add_f32 v[200:201], v[200:201], v[204:205]
  v_pk_add_f32 v[194:195], v[194:195], v[198:199]
  v_pk_add_f32 v[202:203], v[202:203], v[206:207]
  v_pk_add_f32 v[192:193], v[192:193], v[200:201]
  v_pk_add_f32 v[194:195], v[194:195], v[202:203]
  v_cvt_pk_bf16_f32 v26, v192, v193
  v_lshlrev_b32 v192, 16, v26
  v_and_b32 v193, 0xffff0000, v26
  v_mul_f32 v192, v192, v24
  v_mul_f32 v193, v193, v24
  v_cvt_pk_bf16_f32 v26, v192, v193
  v_lshlrev_b32 v192, 16, v26
  v_and_b32 v193, 0xffff0000, v26
  v_add_f32 v192, v192, v16
  v_add_f32 v193, v193, v17
  v_cvt_pk_bf16_f32 v196, v192, v193
  v_cvt_pk_bf16_f32 v26, v194, v195
  v_lshlrev_b32 v194, 16, v26
  v_and_b32 v195, 0xffff0000, v26
  v_mul_f32 v194, v194, v24
  v_mul_f32 v195, v195, v24
  v_cvt_pk_bf16_f32 v26, v194, v195
  v_lshlrev_b32 v194, 16, v26
  v_and_b32 v195, 0xffff0000, v26
  v_add_f32 v194, v194, v18
  v_add_f32 v195, v195, v19
  v_cvt_pk_bf16_f32 v197, v194, v195
  buffer_store_dwordx2 v[196:197], v9, s[8:11], s46 offen offset:64
  s_cmp_eq_u32 s84, 0
  s_cbranch_scc1 pz_288
  s_waitcnt vmcnt(2)
  s_cmp_lg_u32 s20, 0
  s_cbranch_scc1 pz_288x
  ds_write_b32 v30, v27 offset:4
pz_288x:
  s_waitcnt lgkmcnt(0)
  s_barrier
  ds_read_b32 v27, v30 offset:4
  s_waitcnt lgkmcnt(0)
  v_readfirstlane_b32 s64, v27
pz_288:
  s_waitcnt lgkmcnt(0)
  v_readfirstlane_b32 s2, v23
  v_readfirstlane_b32 s67, v213
  s_barrier
  s_cmp_eq_u32 s84, 0
  s_cbranch_scc1 oa_289
  s_cmp_lt_u32 s64, 61
  s_cbranch_scc1 oa_289
  s_mov_b32 s85, s2
  s_branch own_afin
oa_289:
  s_cmp_eq_u32 s84, 0
  s_cbranch_scc1 od_290
  s_cmp_lt_u32 s2, 738
  s_cbranch_scc1 od_290
  s_mov_b32 s85, s2
  s_branch own_afin
od_290:
  s_add_u32 s21, s2, 0
  s_cmp_lt_u32 s2, 10
  s_cbranch_scc1 do_qbl
  s_sub_u32 s2, s2, 10
  s_add_u32 s21, s2, 0
  s_cmp_lt_u32 s2, 54
  s_cbranch_scc1 do_bat
  s_sub_u32 s2, s2, 54
  s_add_u32 s21, s2, 0
  s_cmp_lt_u32 s2, 56
  s_cbranch_scc1 do_opb
  s_sub_u32 s2, s2, 56
  s_add_u32 s21, s2, 54
  s_cmp_lt_u32 s2, 10
  s_cbranch_scc1 do_bat
  s_sub_u32 s2, s2, 10
  s_add_u32 s21, s2, 0
  s_cmp_lt_u32 s2, 60
  s_cbranch_scc1 pv_loop
  s_sub_u32 s2, s2, 60
  s_add_u32 s21, s2, 56
  s_cmp_lt_u32 s2, 8
  s_cbranch_scc1 do_opb
  s_sub_u32 s2, s2, 8
  s_add_u32 s21, s2, 60
  s_cmp_lt_u32 s2, 480
  s_cbranch_scc1 pv_loop
  s_sub_u32 s2, s2, 480
  s_add_u32 s21, s2, 540
  s_cmp_lt_u32 s2, 100
  s_cbranch_scc1 pv_loop
  s_sub_u32 s2, s2, 100
  s_branch main_fin
own_afin:
  s_sub_u32 s21, s84, 1
  s_mov_b32 s84, 0
do_afin:
  s_mov_b32 s2, s21
  s_load_dwordx2 s[38:39], s[0:1], 104
  s_mov_b32 s42, s2
  s_waitcnt lgkmcnt(0)
  s_mov_b32 s16, s38
  s_mov_b32 s17, s39
  s_mov_b32 s18, 50331648
  s_mov_b32 s19, 0x00020000
  s_add_u32 s52, s38, 50331648
  s_addc_u32 s53, s39, 0
  s_mov_b32 s54, 6291456
  s_mov_b32 s55, 0x00020000
  s_add_u32 s56, s38, 85983232
  s_addc_u32 s57, s39, 0
  s_mov_b32 s58, 6815744
  s_mov_b32 s59, 0x00020000
  s_add_u32 s72, s38, 81068032
  s_addc_u32 s73, s39, 0
  s_mov_b32 s74, 115712
  s_mov_b32 s75, 0x00020000
  s_mul_i32 s21, s20, 12800
  s_add_u32 s21, s21, 98304
  v_mul_u32_u24 v4, 400, v2
  v_lshlrev_b32 v5, 4, v3
  v_add3_u32 v29, v4, v5, s21
  v_lshlrev_b32 v30, 4, v1
  v_and_b32 v4, 7, v2
  v_lshlrev_b32 v4, 4, v4
  v_lshl_add_u32 v31, v3, 7, v4
  v_lshlrev_b32 v32, 3, v1
  v_and_b32 v4, 3, v1
  v_lshlrev_b32 v33, 3, v4
  v_mov_b32 v34, 0xf149f2ca
  v_lshlrev_b32 v4, 2, v3
  v_sub_u32 v35, v2, v4
  v_cmp_gt_u32 s[60:61], 2, v3
  s_mov_b32 s62, 0x3d93cd3a
  s_mov_b32 s63, 0x3fb8aa3b
  s_mov_b32 s83, 0x3dd53b95
  v_cmp_le_i32 s[64:65], 0, v35
  v_cmp_le_i32 s[66:67], 1, v35
  v_cmp_le_i32 s[68:69], 2, v35
  v_cmp_le_i32 s[70:71], 3, v35
  s_add_u32 s49, s20, 60
  s_mov_b32 s29, 4
  s_mov_b32 s78, 0
  s_lshl_b32 s21, s42, 7
  s_add_u32 s21, s21, 111616
  s_lshl_b32 s43, s42, 2
  s_add_u32 s43, s43, s20
  s_mul_i32 s43, s43, 12288
  s_add_u32 s43, s43, 5242880
  s_waitcnt vmcnt(0)
  s_cmp_eq_u32 s78, 0
  s_cbranch_scc1 pf_292
  v_mov_b32 v4, 0
  v_mov_b32 v5, 1
  s_mov_b64 exec, 1
  buffer_atomic_add v5, v4, s[72:75], s78 offen sc1
  s_mov_b64 exec, -1
  s_mov_b32 s78, 0
pf_292:
  s_mul_i32 s21, s49, 393216
  s_mul_i32 s22, s42, 12288
  s_add_u32 s50, s21, s22
  s_mul_i32 s21, s49, 98304
  s_mul_i32 s22, s42, 3072
  s_add_u32 s51, s21, s22
  s_lshr_b32 s22, s49, 1
  s_lshr_b32 s21, s49, 2
  s_add_u32 s21, s21, 2
  s_cmp_lt_u32 s49, 8
  s_cselect_b32 s21, s22, s21
  s_lshl_b32 s21, s21, 3
  s_lshr_b32 s22, s42, 2
  s_add_u32 s21, s21, s22
  s_lshl_b32 s21, s21, 7
  s_add_u32 s76, s21, 0
  s_lshl_b32 s77, s42, 7
  s_add_u32 s77, s77, 18432
  v_mov_b32 v156, 0
  s_mov_b32 s101, 0
wf_293:
  buffer_load_dword v157, v156, s[72:75], s76 offen sc1
  s_add_u32 s101, s101, 1
  s_cmp_gt_u32 s101, 131072
  s_cbranch_scc1 main_end
  s_waitcnt vmcnt(0)
  v_readfirstlane_b32 s100, v157
  s_cmp_ge_u32 s100, 8
  s_cbranch_scc1 wf_294
  s_sleep 2
  s_branch wf_293
wf_294:
  s_add_u32 s21, s50, 0
  buffer_load_dwordx4 v[36:39], v30, s[16:19], s21 offen offset:0 sc1
  buffer_load_dwordx4 v[40:43], v30, s[16:19], s21 offen offset:1024 sc1
  buffer_load_dwordx4 v[44:47], v30, s[16:19], s21 offen offset:2048 sc1
  buffer_load_dwordx4 v[48:51], v30, s[16:19], s21 offen offset:3072 sc1
  s_add_u32 s21, s50, 4096
  buffer_load_dwordx4 v[52:55], v30, s[16:19], s21 offen offset:0 sc1
  buffer_load_dwordx4 v[56:59], v30, s[16:19], s21 offen offset:1024 sc1
  buffer_load_dwordx4 v[60:63], v30, s[16:19], s21 offen offset:2048 sc1
  buffer_load_dwordx4 v[236:239], v30, s[16:19], s21 offen offset:3072 sc1
  s_add_u32 s21, s50, 8192
  buffer_load_dwordx4 v[240:243], v30, s[16:19], s21 offen offset:0 sc1
  buffer_load_dwordx4 v[244:247], v30, s[16:19], s21 offen offset:1024 sc1
  buffer_load_dwordx4 v[248:251], v30, s[16:19], s21 offen offset:2048 sc1
  buffer_load_dwordx4 v[252:255], v30, s[16:19], s21 offen offset:3072 sc1
  s_add_u32 s21, s43, 0
  buffer_load_dwordx4 v[64:67], v30, s[56:59], s21 offen offset:0 sc1
  buffer_load_dwordx4 v[68:71], v30, s[56:59], s21 offen offset:1024 sc1
  buffer_load_dwordx4 v[72:75], v30, s[56:59], s21 offen offset:2048 sc1
  buffer_load_dwordx4 v[76:79], v30, s[56:59], s21 offen offset:3072 sc1
  s_add_u32 s21, s43, 4096
  buffer_load_dwordx4 v[80:83], v30, s[56:59], s21 offen offset:0 sc1
  buffer_load_dwordx4 v[84:87], v30, s[56:59], s21 offen offset:1024 sc1
  buffer_load_dwordx4 v[88:91], v30, s[56:59], s21 offen offset:2048 sc1
  buffer_load_dwordx4 v[92:95], v30, s[56:59], s21 offen offset:3072 sc1
  s_add_u32 s21, s43, 8192
  buffer_load_dwordx4 v[96:99], v30, s[56:59], s21 offen offset:0 sc1
  buffer_load_dwordx4 v[100:103], v30, s[56:59], s21 offen offset:1024 sc1
  buffer_load_dwordx4 v[104:107], v30, s[56:59], s21 offen offset:2048 sc1
  buffer_load_dwordx4 v[108:111], v30, s[56:59], s21 offen offset:3072 sc1
  s_mov_b32 s80, 0
  s_waitcnt vmcnt(0)
  v_mfma_f32_16x16x32_bf16 v[112:115], v[36:39], v[64:67], 0
  v_mfma_f32_16x16x32_bf16 v[120:123], v[36:39], v[88:91], 0
  v_mfma_f32_16x16x32_bf16 v[124:127], v[60:63], v[88:91], 0
  v_mfma_f32_16x16x32_bf16 v[112:115], v[40:43], v[68:71], v[112:115]
  v_mfma_f32_16x16x32_bf16 v[120:123], v[40:43], v[92:95], v[120:123]
  v_mfma_f32_16x16x32_bf16 v[124:127], v[236:239], v[92:95], v[124:127]
  v_mfma_f32_16x16x32_bf16 v[112:115], v[44:47], v[72:75], v[112:115]
  v_mfma_f32_16x16x32_bf16 v[120:123], v[44:47], v[96:99], v[120:123]
  v_mfma_f32_16x16x32_bf16 v[124:127], v[240:243], v[96:99], v[124:127]
  v_mfma_f32_16x16x32_bf16 v[112:115], v[48:51], v[76:79], v[112:115]
  v_mfma_f32_16x16x32_bf16 v[120:123], v[48:51], v[100:103], v[120:123]
  v_mfma_f32_16x16x32_bf16 v[124:127], v[244:247], v[100:103], v[124:127]
  v_mfma_f32_16x16x32_bf16 v[112:115], v[52:55], v[80:83], v[112:115]
  v_mfma_f32_16x16x32_bf16 v[120:123], v[52:55], v[104:107], v[120:123]
  v_mfma_f32_16x16x32_bf16 v[124:127], v[248:251], v[104:107], v[124:127]
  v_mfma_f32_16x16x32_bf16 v[112:115], v[56:59], v[84:87], v[112:115]
  v_mfma_f32_16x16x32_bf16 v[120:123], v[56:59], v[108:111], v[120:123]
  v_mfma_f32_16x16x32_bf16 v[124:127], v[252:255], v[108:111], v[124:127]
  s_cmp_eq_u32 s80, 1
  s_cbranch_scc1 qm_295
  s_add_u32 s23, s49, 1
  s_min_u32 s23, s49, 62
  s_mov_b32 s101, 0
wm_296:
  buffer_load_dword v156, v33, s[72:75], s77 offen sc1
  s_add_u32 s101, s101, 1
  s_cmp_gt_u32 s101, 131072
  s_cbranch_scc1 main_end
  s_waitcnt vmcnt(0)
  v_cmp_gt_u32 vcc, s23, v156
  v_readfirstlane_b32 s100, v156
  s_nop 0
  s_cbranch_vccz wm_297
  s_sleep 4
  s_add_u32 s100, s100, 2
  s_cmp_ge_u32 s100, s23
  s_cbranch_scc1 wm_296
  s_sleep 90
  s_branch wm_296
wm_297:
  s_mov_b32 s101, 0
  s_branch qtp_299
qtp_298:
  s_sleep 3
qtp_299:
  buffer_load_dwordx4 v[132:135], v31, s[52:55], s51 offen offset:0 sc1
  buffer_load_dwordx4 v[136:139], v31, s[52:55], s51 offen offset:512 sc1
  buffer_load_dwordx4 v[140:143], v31, s[52:55], s51 offen offset:1024 sc1
  buffer_load_dwordx4 v[144:147], v31, s[52:55], s51 offen offset:1536 sc1
  buffer_load_dwordx4 v[148:151], v31, s[52:55], s51 offen offset:2048 sc1
  buffer_load_dwordx4 v[152:155], v31, s[52:55], s51 offen offset:2560 sc1
  s_add_u32 s101, s101, 1
  s_cmp_gt_u32 s101, 131072
  s_cbranch_scc1 main_end
  s_waitcnt vmcnt(0)
  v_max3_u32 v156, v132, v134, v136
  v_max3_u32 v156, v156, v138, v140
  v_max3_u32 v156, v156, v142, v144
  v_max3_u32 v156, v156, v146, v148
  v_max3_u32 v156, v156, v150, v152
  v_max3_u32 v156, v156, v154, v154
  v_cmp_eq_u32 vcc, -1, v156
  s_nop 1
  s_cbranch_vccnz qtp_298
qm_295:
  s_waitcnt vmcnt(0)
  v_mfma_f32_16x16x32_bf16 v[116:119], v[132:135], v[64:67], 0
  v_mfma_f32_16x16x32_bf16 v[128:131], v[132:135], v[88:91], 0
  v_mfma_f32_16x16x32_bf16 v[116:119], v[136:139], v[68:71], v[116:119]
  v_mfma_f32_16x16x32_bf16 v[128:131], v[136:139], v[92:95], v[128:131]
  v_mfma_f32_16x16x32_bf16 v[116:119], v[140:143], v[72:75], v[116:119]
  v_mfma_f32_16x16x32_bf16 v[128:131], v[140:143], v[96:99], v[128:131]
  v_mfma_f32_16x16x32_bf16 v[116:119], v[144:147], v[76:79], v[116:119]
  v_mfma_f32_16x16x32_bf16 v[128:131], v[144:147], v[100:103], v[128:131]
  v_mfma_f32_16x16x32_bf16 v[116:119], v[148:151], v[80:83], v[116:119]
  v_mfma_f32_16x16x32_bf16 v[128:131], v[148:151], v[104:107], v[128:131]
  v_mfma_f32_16x16x32_bf16 v[116:119], v[152:155], v[84:87], v[116:119]
  v_mfma_f32_16x16x32_bf16 v[128:131], v[152:155], v[108:111], v[128:131]
  s_lshl_b32 s21, s49, 5
  s_add_u32 s21, s21, s42
  s_mul_i32 s81, s21, 2560
  s_lshl_b32 s82, s49, 3
  s_and_b32 s21, s42, 7
  s_add_u32 s82, s82, s21
  s_lshl_b32 s82, s82, 7
  s_add_u32 s82, s82, 22528
  v_cndmask_b32 v112, v34, v112, s[64:65]
  v_cndmask_b32 v124, v34, v124, s[64:65]
  v_cndmask_b32 v113, v34, v113, s[66:67]
  v_cndmask_b32 v125, v34, v125, s[66:67]
  v_cndmask_b32 v114, v34, v114, s[68:69]
  v_cndmask_b32 v126, v34, v126, s[68:69]
  v_cndmask_b32 v115, v34, v115, s[70:71]
  v_cndmask_b32 v127, v34, v127, s[70:71]
  v_max3_f32 v156, v112, v113, v114
  v_max3_f32 v156, v156, v115, v116
  v_max3_f32 v156, v156, v117, v118
  v_max_f32 v156, v156, v119
  v_mov_b32 v157, v156
  s_nop 1
  v_permlane32_swap_b32 v156, v157
  v_max_f32 v156, v156, v157
  v_mov_b32 v157, v156
  s_nop 1
  v_permlane16_swap_b32 v156, v157
  v_max_f32 v156, v156, v157
  v_mul_f32 v156, s83, v156
  v_fma_f32 v112, v112, s83, -v156
  v_fma_f32 v113, v113, s83, -v156
  v_fma_f32 v114, v114, s83, -v156
  v_fma_f32 v115, v115, s83, -v156
  v_fma_f32 v116, v116, s83, -v156
  v_fma_f32 v117, v117, s83, -v156
  v_fma_f32 v118, v118, s83, -v156
  v_fma_f32 v119, v119, s83, -v156
  v_exp_f32 v112, v112
  v_exp_f32 v113, v113
  v_exp_f32 v114, v114
  v_exp_f32 v115, v115
  v_exp_f32 v116, v116
  v_exp_f32 v117, v117
  v_exp_f32 v118, v118
  v_exp_f32 v119, v119
  s_nop 0
  v_add_f32 v156, v116, v117
  v_add_f32 v156, v156, v118
  v_add_f32 v156, v156, v119
  v_cndmask_b32 v156, 0, v156, s[60:61]
  v_add_f32 v156, v156, v112
  v_add_f32 v156, v156, v113
  v_add_f32 v156, v156, v114
  v_add_f32 v156, v156, v115
  v_mov_b32 v157, v156
  s_nop 1
  v_permlane32_swap_b32 v156, v157
  v_add_f32 v156, v156, v157
  v_mov_b32 v157, v156
  s_nop 1
  v_permlane16_swap_b32 v156, v157
  v_add_f32 v156, v156, v157
  v_rcp_f32 v156, v156
  s_nop 0
  v_mul_f32 v112, v112, v156
  v_mul_f32 v113, v113, v156
  v_mul_f32 v114, v114, v156
  v_mul_f32 v115, v115, v156
  v_mul_f32 v116, v116, v156
  v_mul_f32 v117, v117, v156
  v_mul_f32 v118, v118, v156
  v_mul_f32 v119, v119, v156
  v_max3_f32 v156, v120, v121, v122
  v_max3_f32 v156, v156, v123, v124
  v_max3_f32 v156, v156, v125, v126
  v_max3_f32 v156, v156, v127, v128
  v_max3_f32 v156, v156, v129, v130
  v_max_f32 v156, v156, v131
  v_mov_b32 v157, v156
  s_nop 1
  v_permlane32_swap_b32 v156, v157
  v_max_f32 v156, v156, v157
  v_mov_b32 v157, v156
  s_nop 1
  v_permlane16_swap_b32 v156, v157
  v_max_f32 v156, v156, v157
  v_mul_f32 v156, s83, v156
  v_fma_f32 v120, v120, s83, -v156
  v_fma_f32 v121, v121, s83, -v156
  v_fma_f32 v122, v122, s83, -v156
  v_fma_f32 v123, v123, s83, -v156
  v_fma_f32 v124, v124, s83, -v156
  v_fma_f32 v125, v125, s83, -v156
  v_fma_f32 v126, v126, s83, -v156
  v_fma_f32 v127, v127, s83, -v156
  v_fma_f32 v128, v128, s83, -v156
  v_fma_f32 v129, v129, s83, -v156
  v_fma_f32 v130, v130, s83, -v156
  v_fma_f32 v131, v131, s83, -v156
  v_exp_f32 v120, v120
  v_exp_f32 v121, v121
  v_exp_f32 v122, v122
  v_exp_f32 v123, v123
  v_exp_f32 v124, v124
  v_exp_f32 v125, v125
  v_exp_f32 v126, v126
  v_exp_f32 v127, v127
  v_exp_f32 v128, v128
  v_exp_f32 v129, v129
  v_exp_f32 v130, v130
  v_exp_f32 v131, v131
  s_nop 0
  v_add_f32 v156, v128, v129
  v_add_f32 v156, v156, v130
  v_add_f32 v156, v156, v131
  v_cndmask_b32 v156, 0, v156, s[60:61]
  v_add_f32 v156, v156, v120
  v_add_f32 v156, v156, v121
  v_add_f32 v156, v156, v122
  v_add_f32 v156, v156, v123
  v_add_f32 v156, v156, v124
  v_add_f32 v156, v156, v125
  v_add_f32 v156, v156, v126
  v_add_f32 v156, v156, v127
  v_mov_b32 v157, v156
  s_nop 1
  v_permlane32_swap_b32 v156, v157
  v_add_f32 v156, v156, v157
  v_mov_b32 v157, v156
  s_nop 1
  v_permlane16_swap_b32 v156, v157
  v_add_f32 v156, v156, v157
  v_rcp_f32 v156, v156
  s_nop 0
  v_mul_f32 v120, v120, v156
  v_mul_f32 v121, v121, v156
  v_mul_f32 v122, v122, v156
  v_mul_f32 v123, v123, v156
  v_mul_f32 v124, v124, v156
  v_mul_f32 v125, v125, v156
  v_mul_f32 v126, v126, v156
  v_mul_f32 v127, v127, v156
  v_mul_f32 v128, v128, v156
  v_mul_f32 v129, v129, v156
  v_mul_f32 v130, v130, v156
  v_mul_f32 v131, v131, v156
  v_cvt_pk_bf16_f32 v192, v120, v121
  v_cvt_pk_bf16_f32 v193, v122, v123
  v_cvt_pk_bf16_f32 v194, v124, v125
  v_cvt_pk_bf16_f32 v195, v126, v127
  v_cvt_pk_bf16_f32 v196, v116, v117
  v_cvt_pk_bf16_f32 v197, v118, v119
  v_cvt_pk_bf16_f32 v198, v128, v129
  v_cvt_pk_bf16_f32 v199, v130, v131
  v_cvt_pk_bf16_f32 v200, v112, v113
  v_cvt_pk_bf16_f32 v201, v114, v115
  buffer_store_dwordx4 v[192:195], v30, s[56:59], s81 offen sc1
  buffer_store_dwordx4 v[196:199], v30, s[56:59], s81 offen offset:1024 sc1
  buffer_store_dwordx2 v[200:201], v32, s[56:59], s81 offen offset:2048 sc1
  s_mov_b32 s78, s82
  s_mov_b32 s81, 0x80000000
  s_mov_b32 s82, 0
  s_cmp_eq_u32 s80, 1
  s_cbranch_scc1 qd_300
  s_waitcnt vmcnt(0)
  s_cmp_eq_u32 s78, 0
  s_cbranch_scc1 pf_301
  v_mov_b32 v4, 0
  v_mov_b32 v5, 1
  s_mov_b64 exec, 1
  buffer_atomic_add v5, v4, s[72:75], s78 offen sc1
  s_mov_b64 exec, -1
  s_mov_b32 s78, 0
pf_301:
qd_300:
  s_add_u32 s49, s49, s29
qbe_291:
  s_branch queue
do_bat:
  s_mov_b32 s2, s21
  s_load_dwordx2 s[4:5], s[0:1], 0
  s_load_dwordx2 s[6:7], s[0:1], 80
  s_load_dwordx2 s[38:39], s[0:1], 104
  s_waitcnt lgkmcnt(0)
  s_mov_b32 s8, s4
  s_mov_b32 s9, s5
  s_mov_b32 s10, 2621440
  s_mov_b32 s11, 0x00020000
  s_mov_b32 s12, s6
  s_mov_b32 s13, s7
  s_mov_b32 s14, 1280
  s_mov_b32 s15, 0x00020000
  s_add_u32 s16, s38, 62914560
  s_addc_u32 s17, s39, 0
  s_mov_b32 s18, 7864320
  s_mov_b32 s19, 0x00020000
  s_add_u32 s24, s38, 70778880
  s_addc_u32 s25, s39, 0
  s_mov_b32 s26, 2621440
  s_mov_b32 s27, 0x00020000
  s_add_u32 s28, s38, 81002496
  s_addc_u32 s29, s39, 0
  s_mov_b32 s30, 8192
  s_mov_b32 s31, 0x00020000
  s_add_u32 s72, s38, 81068032
  s_addc_u32 s73, s39, 0
  s_mov_b32 s74, 115712
  s_mov_b32 s75, 0x00020000
  v_mov_b32 v7, 52429
  v_add_u32 v5, 0, v1
  v_mul_u32_u24 v6, v5, v7
  v_lshrrev_b32 v18, 23, v6
  v_mul_u32_u24 v19, 1280, v18
  v_lshl_add_u32 v8, v5, 4, v19
  v_add_u32 v8, 1280, v8
  v_lshrrev_b32 v18, 22, v6
  v_mul_u32_u24 v19, 2560, v18
  v_lshl_add_u32 v13, v5, 4, v19
  v_add_u32 v5, 64, v1
  v_mul_u32_u24 v6, v5, v7
  v_lshrrev_b32 v18, 23, v6
  v_mul_u32_u24 v19, 1280, v18
  v_lshl_add_u32 v9, v5, 4, v19
  v_add_u32 v9, 1280, v9
  v_lshrrev_b32 v18, 22, v6
  v_mul_u32_u24 v19, 2560, v18
  v_lshl_add_u32 v14, v5, 4, v19
  v_add_u32 v5, 128, v1
  v_mul_u32_u24 v6, v5, v7
  v_lshrrev_b32 v18, 23, v6
  v_mul_u32_u24 v19, 1280, v18
  v_lshl_add_u32 v10, v5, 4, v19
  v_add_u32 v10, 1280, v10
  v_lshrrev_b32 v18, 22, v6
  v_mul_u32_u24 v19, 2560, v18
  v_lshl_add_u32 v15, v5, 4, v19
  v_add_u32 v5, 192, v1
  v_mul_u32_u24 v6, v5, v7
  v_lshrrev_b32 v18, 23, v6
  v_mul_u32_u24 v19, 1280, v18
  v_lshl_add_u32 v11, v5, 4, v19
  v_add_u32 v11, 1280, v11
  v_lshrrev_b32 v18, 22, v6
  v_mul_u32_u24 v19, 2560, v18
  v_lshl_add_u32 v16, v5, 4, v19
  v_add_u32 v5, 256, v1
  v_mul_u32_u24 v6, v5, v7
  v_lshrrev_b32 v18, 23, v6
  v_mul_u32_u24 v19, 1280, v18
  v_lshl_add_u32 v12, v5, 4, v19
  v_add_u32 v12, 1280, v12
  v_lshrrev_b32 v18, 22, v6
  v_mul_u32_u24 v19, 2560, v18
  v_lshl_add_u32 v17, v5, 4, v19
  s_lshr_b32 s21, s2, 2
  s_lshl_b32 s21, s21, 7
  s_add_u32 s21, s21, 88064
  s_cmp_lg_u32 s20, 0
  s_cbranch_scc1 wf_303
  v_mov_b32 v18, 0
  s_mov_b32 s101, 0
wf_302:
  buffer_load_dword v19, v18, s[72:75], s21 offen sc1
  s_add_u32 s101, s101, 1
  s_cmp_gt_u32 s101, 131072
  s_cbranch_scc1 main_end
  s_waitcnt vmcnt(0)
  v_readfirstlane_b32 s100, v19
  s_cmp_ge_u32 s100, 10
  s_cbranch_scc1 wf_303
  s_sleep 16
  s_branch wf_302
wf_303:
  s_barrier
  s_max_u32 s21, s2, 1
  s_sub_u32 s21, s21, 1
  s_lshr_b32 s21, s21, 2
  s_lshl_b32 s21, s21, 7
  s_add_u32 s21, s21, 88064
  s_cmp_lg_u32 s20, 0
  s_cbranch_scc1 wf_305
  v_mov_b32 v18, 0
  s_mov_b32 s101, 0
wf_304:
  buffer_load_dword v19, v18, s[72:75], s21 offen sc1
  s_add_u32 s101, s101, 1
  s_cmp_gt_u32 s101, 131072
  s_cbranch_scc1 main_end
  s_waitcnt vmcnt(0)
  v_readfirstlane_b32 s100, v19
  s_cmp_ge_u32 s100, 10
  s_cbranch_scc1 wf_305
  s_sleep 16
  s_branch wf_304
wf_305:
  s_barrier
  s_lshl_b32 s58, s2, 5
  s_add_u32 s22, s20, 0
  s_cmp_ge_u32 s22, 23
  s_cbranch_scc1 bd_306
  s_lshl_b32 s23, s22, 1
  s_add_u32 s23, s23, s58
  s_sub_i32 s23, s23, 14
  s_max_i32 s23, s23, 0
  s_mul_i32 s23, s23, 3840
  s_mul_i32 s22, s22, 5120
  s_add_u32 m0, s22, 0
  s_nop 0
  buffer_load_dwordx4 v8, s[16:19], s23 offen sc1 lds
  s_add_u32 m0, s22, 1024
  s_nop 0
  buffer_load_dwordx4 v9, s[16:19], s23 offen sc1 lds
  s_add_u32 m0, s22, 2048
  s_nop 0
  buffer_load_dwordx4 v10, s[16:19], s23 offen sc1 lds
  s_add_u32 m0, s22, 3072
  s_nop 0
  buffer_load_dwordx4 v11, s[16:19], s23 offen sc1 lds
  s_add_u32 m0, s22, 4096
  s_nop 0
  buffer_load_dwordx4 v12, s[16:19], s23 offen sc1 lds
bd_306:
  s_add_u32 s22, s20, 4
  s_cmp_ge_u32 s22, 23
  s_cbranch_scc1 bd_307
  s_lshl_b32 s23, s22, 1
  s_add_u32 s23, s23, s58
  s_sub_i32 s23, s23, 14
  s_max_i32 s23, s23, 0
  s_mul_i32 s23, s23, 3840
  s_mul_i32 s22, s22, 5120
  s_add_u32 m0, s22, 0
  s_nop 0
  buffer_load_dwordx4 v8, s[16:19], s23 offen sc1 lds
  s_add_u32 m0, s22, 1024
  s_nop 0
  buffer_load_dwordx4 v9, s[16:19], s23 offen sc1 lds
  s_add_u32 m0, s22, 2048
  s_nop 0
  buffer_load_dwordx4 v10, s[16:19], s23 offen sc1 lds
  s_add_u32 m0, s22, 3072
  s_nop 0
  buffer_load_dwordx4 v11, s[16:19], s23 offen sc1 lds
  s_add_u32 m0, s22, 4096
  s_nop 0
  buffer_load_dwordx4 v12, s[16:19], s23 offen sc1 lds
bd_307:
  s_add_u32 s22, s20, 8
  s_cmp_ge_u32 s22, 23
  s_cbranch_scc1 bd_308
  s_lshl_b32 s23, s22, 1
  s_add_u32 s23, s23, s58
  s_sub_i32 s23, s23, 14
  s_max_i32 s23, s23, 0
  s_mul_i32 s23, s23, 3840
  s_mul_i32 s22, s22, 5120
  s_add_u32 m0, s22, 0
  s_nop 0
  buffer_load_dwordx4 v8, s[16:19], s23 offen sc1 lds
  s_add_u32 m0, s22, 1024
  s_nop 0
  buffer_load_dwordx4 v9, s[16:19], s23 offen sc1 lds
  s_add_u32 m0, s22, 2048
  s_nop 0
  buffer_load_dwordx4 v10, s[16:19], s23 offen sc1 lds
  s_add_u32 m0, s22, 3072
  s_nop 0
  buffer_load_dwordx4 v11, s[16:19], s23 offen sc1 lds
  s_add_u32 m0, s22, 4096
  s_nop 0
  buffer_load_dwordx4 v12, s[16:19], s23 offen sc1 lds
bd_308:
  s_add_u32 s22, s20, 12
  s_cmp_ge_u32 s22, 23
  s_cbranch_scc1 bd_309
  s_lshl_b32 s23, s22, 1
  s_add_u32 s23, s23, s58
  s_sub_i32 s23, s23, 14
  s_max_i32 s23, s23, 0
  s_mul_i32 s23, s23, 3840
  s_mul_i32 s22, s22, 5120
  s_add_u32 m0, s22, 0
  s_nop 0
  buffer_load_dwordx4 v8, s[16:19], s23 offen sc1 lds
  s_add_u32 m0, s22, 1024
  s_nop 0
  buffer_load_dwordx4 v9, s[16:19], s23 offen sc1 lds
  s_add_u32 m0, s22, 2048
  s_nop 0
  buffer_load_dwordx4 v10, s[16:19], s23 offen sc1 lds
  s_add_u32 m0, s22, 3072
  s_nop 0
  buffer_load_dwordx4 v11, s[16:19], s23 offen sc1 lds
  s_add_u32 m0, s22, 4096
  s_nop 0
  buffer_load_dwordx4 v12, s[16:19], s23 offen sc1 lds
bd_309:
  s_add_u32 s22, s20, 16
  s_cmp_ge_u32 s22, 23
  s_cbranch_scc1 bd_310
  s_lshl_b32 s23, s22, 1
  s_add_u32 s23, s23, s58
  s_sub_i32 s23, s23, 14
  s_max_i32 s23, s23, 0
  s_mul_i32 s23, s23, 3840
  s_mul_i32 s22, s22, 5120
  s_add_u32 m0, s22, 0
  s_nop 0
  buffer_load_dwordx4 v8, s[16:19], s23 offen sc1 lds
  s_add_u32 m0, s22, 1024
  s_nop 0
  buffer_load_dwordx4 v9, s[16:19], s23 offen sc1 lds
  s_add_u32 m0, s22, 2048
  s_nop 0
  buffer_load_dwordx4 v10, s[16:19], s23 offen sc1 lds
  s_add_u32 m0, s22, 3072
  s_nop 0
  buffer_load_dwordx4 v11, s[16:19], s23 offen sc1 lds
  s_add_u32 m0, s22, 4096
  s_nop 0
  buffer_load_dwordx4 v12, s[16:19], s23 offen sc1 lds
bd_310:
  s_add_u32 s22, s20, 20
  s_cmp_ge_u32 s22, 23
  s_cbranch_scc1 bd_311
  s_lshl_b32 s23, s22, 1
  s_add_u32 s23, s23, s58
  s_sub_i32 s23, s23, 14
  s_max_i32 s23, s23, 0
  s_mul_i32 s23, s23, 3840
  s_mul_i32 s22, s22, 5120
  s_add_u32 m0, s22, 0
  s_nop 0
  buffer_load_dwordx4 v8, s[16:19], s23 offen sc1 lds
  s_add_u32 m0, s22, 1024
  s_nop 0
  buffer_load_dwordx4 v9, s[16:19], s23 offen sc1 lds
  s_add_u32 m0, s22, 2048
  s_nop 0
  buffer_load_dwordx4 v10, s[16:19], s23 offen sc1 lds
  s_add_u32 m0, s22, 3072
  s_nop 0
  buffer_load_dwordx4 v11, s[16:19], s23 offen sc1 lds
  s_add_u32 m0, s22, 4096
  s_nop 0
  buffer_load_dwordx4 v12, s[16:19], s23 offen sc1 lds
bd_311:
  s_add_u32 s22, s20, 0
  s_lshl_b32 s23, s22, 2
  s_add_u32 s23, s23, s58
  s_mul_i32 s23, s23, 3840
  s_mul_i32 s22, s22, 5120
  s_add_u32 s22, s22, 117760
  s_add_u32 m0, s22, 0
  s_nop 0
  buffer_load_dwordx4 v13, s[16:19], s23 offen sc1 lds
  s_add_u32 m0, s22, 1024
  s_nop 0
  buffer_load_dwordx4 v14, s[16:19], s23 offen sc1 lds
  s_add_u32 m0, s22, 2048
  s_nop 0
  buffer_load_dwordx4 v15, s[16:19], s23 offen sc1 lds
  s_add_u32 m0, s22, 3072
  s_nop 0
  buffer_load_dwordx4 v16, s[16:19], s23 offen sc1 lds
  s_add_u32 m0, s22, 4096
  s_nop 0
  buffer_load_dwordx4 v17, s[16:19], s23 offen sc1 lds
  s_add_u32 s22, s20, 4
  s_lshl_b32 s23, s22, 2
  s_add_u32 s23, s23, s58
  s_mul_i32 s23, s23, 3840
  s_mul_i32 s22, s22, 5120
  s_add_u32 s22, s22, 117760
  s_add_u32 m0, s22, 0
  s_nop 0
  buffer_load_dwordx4 v13, s[16:19], s23 offen sc1 lds
  s_add_u32 m0, s22, 1024
  s_nop 0
  buffer_load_dwordx4 v14, s[16:19], s23 offen sc1 lds
  s_add_u32 m0, s22, 2048
  s_nop 0
  buffer_load_dwordx4 v15, s[16:19], s23 offen sc1 lds
  s_add_u32 m0, s22, 3072
  s_nop 0
  buffer_load_dwordx4 v16, s[16:19], s23 offen sc1 lds
  s_add_u32 m0, s22, 4096
  s_nop 0
  buffer_load_dwordx4 v17, s[16:19], s23 offen sc1 lds
  s_lshl_b32 s21, s20, 3
  s_add_u32 s59, s58, s21
  v_lshlrev_b32 v4, 2, v1
  buffer_load_dword v16, v4, s[12:15], 0 offen offset:0
  buffer_load_dword v17, v4, s[12:15], 0 offen offset:256
  buffer_load_dword v18, v4, s[12:15], 0 offen offset:512
  buffer_load_dword v19, v4, s[12:15], 0 offen offset:768
  buffer_load_dword v20, v4, s[12:15], 0 offen offset:1024
  s_mul_i32 s22, s59, 1280
  buffer_load_dword v32, v4, s[8:11], s22 offen offset:0
  buffer_load_dword v33, v4, s[8:11], s22 offen offset:256
  buffer_load_dword v34, v4, s[8:11], s22 offen offset:512
  buffer_load_dword v35, v4, s[8:11], s22 offen offset:768
  buffer_load_dword v36, v4, s[8:11], s22 offen offset:1024
  s_add_u32 s22, s22, 1280
  buffer_load_dword v37, v4, s[8:11], s22 offen offset:0
  buffer_load_dword v38, v4, s[8:11], s22 offen offset:256
  buffer_load_dword v39, v4, s[8:11], s22 offen offset:512
  buffer_load_dword v40, v4, s[8:11], s22 offen offset:768
  buffer_load_dword v41, v4, s[8:11], s22 offen offset:1024
  s_add_u32 s22, s22, 1280
  buffer_load_dword v42, v4, s[8:11], s22 offen offset:0
  buffer_load_dword v43, v4, s[8:11], s22 offen offset:256
  buffer_load_dword v44, v4, s[8:11], s22 offen offset:512
  buffer_load_dword v45, v4, s[8:11], s22 offen offset:768
  buffer_load_dword v46, v4, s[8:11], s22 offen offset:1024
  s_add_u32 s22, s22, 1280
  buffer_load_dword v47, v4, s[8:11], s22 offen offset:0
  buffer_load_dword v48, v4, s[8:11], s22 offen offset:256
  buffer_load_dword v49, v4, s[8:11], s22 offen offset:512
  buffer_load_dword v50, v4, s[8:11], s22 offen offset:768
  buffer_load_dword v51, v4, s[8:11], s22 offen offset:1024
  s_add_u32 s22, s22, 1280
  buffer_load_dword v52, v4, s[8:11], s22 offen offset:0
  buffer_load_dword v53, v4, s[8:11], s22 offen offset:256
  buffer_load_dword v54, v4, s[8:11], s22 offen offset:512
  buffer_load_dword v55, v4, s[8:11], s22 offen offset:768
  buffer_load_dword v56, v4, s[8:11], s22 offen offset:1024
  s_add_u32 s22, s22, 1280
  buffer_load_dword v57, v4, s[8:11], s22 offen offset:0
  buffer_load_dword v58, v4, s[8:11], s22 offen offset:256
  buffer_load_dword v59, v4, s[8:11], s22 offen offset:512
  buffer_load_dword v60, v4, s[8:11], s22 offen offset:768
  buffer_load_dword v61, v4, s[8:11], s22 offen offset:1024
  s_add_u32 s22, s22, 1280
  buffer_load_dword v62, v4, s[8:11], s22 offen offset:0
  buffer_load_dword v63, v4, s[8:11], s22 offen offset:256
  buffer_load_dword v64, v4, s[8:11], s22 offen offset:512
  buffer_load_dword v65, v4, s[8:11], s22 offen offset:768
  buffer_load_dword v66, v4, s[8:11], s22 offen offset:1024
  s_add_u32 s22, s22, 1280
  buffer_load_dword v67, v4, s[8:11], s22 offen offset:0
  buffer_load_dword v68, v4, s[8:11], s22 offen offset:256
  buffer_load_dword v69, v4, s[8:11], s22 offen offset:512
  buffer_load_dword v70, v4, s[8:11], s22 offen offset:768
  buffer_load_dword v71, v4, s[8:11], s22 offen offset:1024
  s_add_u32 s22, s22, 1280
  s_waitcnt vmcnt(40)
  v_lshlrev_b32 v8, 16, v16
  v_and_b32 v16, 0xffff0000, v16
  v_lshlrev_b32 v9, 16, v17
  v_and_b32 v17, 0xffff0000, v17
  v_lshlrev_b32 v10, 16, v18
  v_and_b32 v18, 0xffff0000, v18
  v_lshlrev_b32 v11, 16, v19
  v_and_b32 v19, 0xffff0000, v19
  v_lshlrev_b32 v12, 16, v20
  v_and_b32 v20, 0xffff0000, v20
  s_waitcnt vmcnt(35)
  v_mov_b32 v80, 0
  v_lshlrev_b32 v25, 16, v32
  v_and_b32 v26, 0xffff0000, v32
  v_mul_f32 v25, v25, v8
  v_mul_f32 v26, v26, v16
  v_cvt_pk_bf16_f32 v25, v25, v26
  v_lshlrev_b32 v26, 16, v25
  v_and_b32 v25, 0xffff0000, v25
  v_add_f32 v80, v80, v26
  v_add_f32 v80, v80, v25
  v_lshlrev_b32 v25, 16, v33
  v_and_b32 v26, 0xffff0000, v33
  v_mul_f32 v25, v25, v9
  v_mul_f32 v26, v26, v17
  v_cvt_pk_bf16_f32 v25, v25, v26
  v_lshlrev_b32 v26, 16, v25
  v_and_b32 v25, 0xffff0000, v25
  v_add_f32 v80, v80, v26
  v_add_f32 v80, v80, v25
  v_lshlrev_b32 v25, 16, v34
  v_and_b32 v26, 0xffff0000, v34
  v_mul_f32 v25, v25, v10
  v_mul_f32 v26, v26, v18
  v_cvt_pk_bf16_f32 v25, v25, v26
  v_lshlrev_b32 v26, 16, v25
  v_and_b32 v25, 0xffff0000, v25
  v_add_f32 v80, v80, v26
  v_add_f32 v80, v80, v25
  v_lshlrev_b32 v25, 16, v35
  v_and_b32 v26, 0xffff0000, v35
  v_mul_f32 v25, v25, v11
  v_mul_f32 v26, v26, v19
  v_cvt_pk_bf16_f32 v25, v25, v26
  v_lshlrev_b32 v26, 16, v25
  v_and_b32 v25, 0xffff0000, v25
  v_add_f32 v80, v80, v26
  v_add_f32 v80, v80, v25
  v_lshlrev_b32 v25, 16, v36
  v_and_b32 v26, 0xffff0000, v36
  v_mul_f32 v25, v25, v12
  v_mul_f32 v26, v26, v20
  v_cvt_pk_bf16_f32 v25, v25, v26
  v_lshlrev_b32 v26, 16, v25
  v_and_b32 v25, 0xffff0000, v25
  v_add_f32 v80, v80, v26
  v_add_f32 v80, v80, v25
  s_waitcnt vmcnt(30)
  v_mov_b32 v81, 0
  v_lshlrev_b32 v25, 16, v37
  v_and_b32 v26, 0xffff0000, v37
  v_mul_f32 v25, v25, v8
  v_mul_f32 v26, v26, v16
  v_cvt_pk_bf16_f32 v25, v25, v26
  v_lshlrev_b32 v26, 16, v25
  v_and_b32 v25, 0xffff0000, v25
  v_add_f32 v81, v81, v26
  v_add_f32 v81, v81, v25
  v_lshlrev_b32 v25, 16, v38
  v_and_b32 v26, 0xffff0000, v38
  v_mul_f32 v25, v25, v9
  v_mul_f32 v26, v26, v17
  v_cvt_pk_bf16_f32 v25, v25, v26
  v_lshlrev_b32 v26, 16, v25
  v_and_b32 v25, 0xffff0000, v25
  v_add_f32 v81, v81, v26
  v_add_f32 v81, v81, v25
  v_lshlrev_b32 v25, 16, v39
  v_and_b32 v26, 0xffff0000, v39
  v_mul_f32 v25, v25, v10
  v_mul_f32 v26, v26, v18
  v_cvt_pk_bf16_f32 v25, v25, v26
  v_lshlrev_b32 v26, 16, v25
  v_and_b32 v25, 0xffff0000, v25
  v_add_f32 v81, v81, v26
  v_add_f32 v81, v81, v25
  v_lshlrev_b32 v25, 16, v40
  v_and_b32 v26, 0xffff0000, v40
  v_mul_f32 v25, v25, v11
  v_mul_f32 v26, v26, v19
  v_cvt_pk_bf16_f32 v25, v25, v26
  v_lshlrev_b32 v26, 16, v25
  v_and_b32 v25, 0xffff0000, v25
  v_add_f32 v81, v81, v26
  v_add_f32 v81, v81, v25
  v_lshlrev_b32 v25, 16, v41
  v_and_b32 v26, 0xffff0000, v41
  v_mul_f32 v25, v25, v12
  v_mul_f32 v26, v26, v20
  v_cvt_pk_bf16_f32 v25, v25, v26
  v_lshlrev_b32 v26, 16, v25
  v_and_b32 v25, 0xffff0000, v25
  v_add_f32 v81, v81, v26
  v_add_f32 v81, v81, v25
  s_waitcnt vmcnt(25)
  v_mov_b32 v82, 0
  v_lshlrev_b32 v25, 16, v42
  v_and_b32 v26, 0xffff0000, v42
  v_mul_f32 v25, v25, v8
  v_mul_f32 v26, v26, v16
  v_cvt_pk_bf16_f32 v25, v25, v26
  v_lshlrev_b32 v26, 16, v25
  v_and_b32 v25, 0xffff0000, v25
  v_add_f32 v82, v82, v26
  v_add_f32 v82, v82, v25
  v_lshlrev_b32 v25, 16, v43
  v_and_b32 v26, 0xffff0000, v43
  v_mul_f32 v25, v25, v9
  v_mul_f32 v26, v26, v17
  v_cvt_pk_bf16_f32 v25, v25, v26
  v_lshlrev_b32 v26, 16, v25
  v_and_b32 v25, 0xffff0000, v25
  v_add_f32 v82, v82, v26
  v_add_f32 v82, v82, v25
  v_lshlrev_b32 v25, 16, v44
  v_and_b32 v26, 0xffff0000, v44
  v_mul_f32 v25, v25, v10
  v_mul_f32 v26, v26, v18
  v_cvt_pk_bf16_f32 v25, v25, v26
  v_lshlrev_b32 v26, 16, v25
  v_and_b32 v25, 0xffff0000, v25
  v_add_f32 v82, v82, v26
  v_add_f32 v82, v82, v25
  v_lshlrev_b32 v25, 16, v45
  v_and_b32 v26, 0xffff0000, v45
  v_mul_f32 v25, v25, v11
  v_mul_f32 v26, v26, v19
  v_cvt_pk_bf16_f32 v25, v25, v26
  v_lshlrev_b32 v26, 16, v25
  v_and_b32 v25, 0xffff0000, v25
  v_add_f32 v82, v82, v26
  v_add_f32 v82, v82, v25
  v_lshlrev_b32 v25, 16, v46
  v_and_b32 v26, 0xffff0000, v46
  v_mul_f32 v25, v25, v12
  v_mul_f32 v26, v26, v20
  v_cvt_pk_bf16_f32 v25, v25, v26
  v_lshlrev_b32 v26, 16, v25
  v_and_b32 v25, 0xffff0000, v25
  v_add_f32 v82, v82, v26
  v_add_f32 v82, v82, v25
  s_waitcnt vmcnt(20)
  v_mov_b32 v83, 0
  v_lshlrev_b32 v25, 16, v47
  v_and_b32 v26, 0xffff0000, v47
  v_mul_f32 v25, v25, v8
  v_mul_f32 v26, v26, v16
  v_cvt_pk_bf16_f32 v25, v25, v26
  v_lshlrev_b32 v26, 16, v25
  v_and_b32 v25, 0xffff0000, v25
  v_add_f32 v83, v83, v26
  v_add_f32 v83, v83, v25
  v_lshlrev_b32 v25, 16, v48
  v_and_b32 v26, 0xffff0000, v48
  v_mul_f32 v25, v25, v9
  v_mul_f32 v26, v26, v17
  v_cvt_pk_bf16_f32 v25, v25, v26
  v_lshlrev_b32 v26, 16, v25
  v_and_b32 v25, 0xffff0000, v25
  v_add_f32 v83, v83, v26
  v_add_f32 v83, v83, v25
  v_lshlrev_b32 v25, 16, v49
  v_and_b32 v26, 0xffff0000, v49
  v_mul_f32 v25, v25, v10
  v_mul_f32 v26, v26, v18
  v_cvt_pk_bf16_f32 v25, v25, v26
  v_lshlrev_b32 v26, 16, v25
  v_and_b32 v25, 0xffff0000, v25
  v_add_f32 v83, v83, v26
  v_add_f32 v83, v83, v25
  v_lshlrev_b32 v25, 16, v50
  v_and_b32 v26, 0xffff0000, v50
  v_mul_f32 v25, v25, v11
  v_mul_f32 v26, v26, v19
  v_cvt_pk_bf16_f32 v25, v25, v26
  v_lshlrev_b32 v26, 16, v25
  v_and_b32 v25, 0xffff0000, v25
  v_add_f32 v83, v83, v26
  v_add_f32 v83, v83, v25
  v_lshlrev_b32 v25, 16, v51
  v_and_b32 v26, 0xffff0000, v51
  v_mul_f32 v25, v25, v12
  v_mul_f32 v26, v26, v20
  v_cvt_pk_bf16_f32 v25, v25, v26
  v_lshlrev_b32 v26, 16, v25
  v_and_b32 v25, 0xffff0000, v25
  v_add_f32 v83, v83, v26
  v_add_f32 v83, v83, v25
  s_waitcnt vmcnt(15)
  v_mov_b32 v84, 0
  v_lshlrev_b32 v25, 16, v52
  v_and_b32 v26, 0xffff0000, v52
  v_mul_f32 v25, v25, v8
  v_mul_f32 v26, v26, v16
  v_cvt_pk_bf16_f32 v25, v25, v26
  v_lshlrev_b32 v26, 16, v25
  v_and_b32 v25, 0xffff0000, v25
  v_add_f32 v84, v84, v26
  v_add_f32 v84, v84, v25
  v_lshlrev_b32 v25, 16, v53
  v_and_b32 v26, 0xffff0000, v53
  v_mul_f32 v25, v25, v9
  v_mul_f32 v26, v26, v17
  v_cvt_pk_bf16_f32 v25, v25, v26
  v_lshlrev_b32 v26, 16, v25
  v_and_b32 v25, 0xffff0000, v25
  v_add_f32 v84, v84, v26
  v_add_f32 v84, v84, v25
  v_lshlrev_b32 v25, 16, v54
  v_and_b32 v26, 0xffff0000, v54
  v_mul_f32 v25, v25, v10
  v_mul_f32 v26, v26, v18
  v_cvt_pk_bf16_f32 v25, v25, v26
  v_lshlrev_b32 v26, 16, v25
  v_and_b32 v25, 0xffff0000, v25
  v_add_f32 v84, v84, v26
  v_add_f32 v84, v84, v25
  v_lshlrev_b32 v25, 16, v55
  v_and_b32 v26, 0xffff0000, v55
  v_mul_f32 v25, v25, v11
  v_mul_f32 v26, v26, v19
  v_cvt_pk_bf16_f32 v25, v25, v26
  v_lshlrev_b32 v26, 16, v25
  v_and_b32 v25, 0xffff0000, v25
  v_add_f32 v84, v84, v26
  v_add_f32 v84, v84, v25
  v_lshlrev_b32 v25, 16, v56
  v_and_b32 v26, 0xffff0000, v56
  v_mul_f32 v25, v25, v12
  v_mul_f32 v26, v26, v20
  v_cvt_pk_bf16_f32 v25, v25, v26
  v_lshlrev_b32 v26, 16, v25
  v_and_b32 v25, 0xffff0000, v25
  v_add_f32 v84, v84, v26
  v_add_f32 v84, v84, v25
  s_waitcnt vmcnt(10)
  v_mov_b32 v85, 0
  v_lshlrev_b32 v25, 16, v57
  v_and_b32 v26, 0xffff0000, v57
  v_mul_f32 v25, v25, v8
  v_mul_f32 v26, v26, v16
  v_cvt_pk_bf16_f32 v25, v25, v26
  v_lshlrev_b32 v26, 16, v25
  v_and_b32 v25, 0xffff0000, v25
  v_add_f32 v85, v85, v26
  v_add_f32 v85, v85, v25
  v_lshlrev_b32 v25, 16, v58
  v_and_b32 v26, 0xffff0000, v58
  v_mul_f32 v25, v25, v9
  v_mul_f32 v26, v26, v17
  v_cvt_pk_bf16_f32 v25, v25, v26
  v_lshlrev_b32 v26, 16, v25
  v_and_b32 v25, 0xffff0000, v25
  v_add_f32 v85, v85, v26
  v_add_f32 v85, v85, v25
  v_lshlrev_b32 v25, 16, v59
  v_and_b32 v26, 0xffff0000, v59
  v_mul_f32 v25, v25, v10
  v_mul_f32 v26, v26, v18
  v_cvt_pk_bf16_f32 v25, v25, v26
  v_lshlrev_b32 v26, 16, v25
  v_and_b32 v25, 0xffff0000, v25
  v_add_f32 v85, v85, v26
  v_add_f32 v85, v85, v25
  v_lshlrev_b32 v25, 16, v60
  v_and_b32 v26, 0xffff0000, v60
  v_mul_f32 v25, v25, v11
  v_mul_f32 v26, v26, v19
  v_cvt_pk_bf16_f32 v25, v25, v26
  v_lshlrev_b32 v26, 16, v25
  v_and_b32 v25, 0xffff0000, v25
  v_add_f32 v85, v85, v26
  v_add_f32 v85, v85, v25
  v_lshlrev_b32 v25, 16, v61
  v_and_b32 v26, 0xffff0000, v61
  v_mul_f32 v25, v25, v12
  v_mul_f32 v26, v26, v20
  v_cvt_pk_bf16_f32 v25, v25, v26
  v_lshlrev_b32 v26, 16, v25
  v_and_b32 v25, 0xffff0000, v25
  v_add_f32 v85, v85, v26
  v_add_f32 v85, v85, v25
  s_waitcnt vmcnt(5)
  v_mov_b32 v86, 0
  v_lshlrev_b32 v25, 16, v62
  v_and_b32 v26, 0xffff0000, v62
  v_mul_f32 v25, v25, v8
  v_mul_f32 v26, v26, v16
  v_cvt_pk_bf16_f32 v25, v25, v26
  v_lshlrev_b32 v26, 16, v25
  v_and_b32 v25, 0xffff0000, v25
  v_add_f32 v86, v86, v26
  v_add_f32 v86, v86, v25
  v_lshlrev_b32 v25, 16, v63
  v_and_b32 v26, 0xffff0000, v63
  v_mul_f32 v25, v25, v9
  v_mul_f32 v26, v26, v17
  v_cvt_pk_bf16_f32 v25, v25, v26
  v_lshlrev_b32 v26, 16, v25
  v_and_b32 v25, 0xffff0000, v25
  v_add_f32 v86, v86, v26
  v_add_f32 v86, v86, v25
  v_lshlrev_b32 v25, 16, v64
  v_and_b32 v26, 0xffff0000, v64
  v_mul_f32 v25, v25, v10
  v_mul_f32 v26, v26, v18
  v_cvt_pk_bf16_f32 v25, v25, v26
  v_lshlrev_b32 v26, 16, v25
  v_and_b32 v25, 0xffff0000, v25
  v_add_f32 v86, v86, v26
  v_add_f32 v86, v86, v25
  v_lshlrev_b32 v25, 16, v65
  v_and_b32 v26, 0xffff0000, v65
  v_mul_f32 v25, v25, v11
  v_mul_f32 v26, v26, v19
  v_cvt_pk_bf16_f32 v25, v25, v26
  v_lshlrev_b32 v26, 16, v25
  v_and_b32 v25, 0xffff0000, v25
  v_add_f32 v86, v86, v26
  v_add_f32 v86, v86, v25
  v_lshlrev_b32 v25, 16, v66
  v_and_b32 v26, 0xffff0000, v66
  v_mul_f32 v25, v25, v12
  v_mul_f32 v26, v26, v20
  v_cvt_pk_bf16_f32 v25, v25, v26
  v_lshlrev_b32 v26, 16, v25
  v_and_b32 v25, 0xffff0000, v25
  v_add_f32 v86, v86, v26
  v_add_f32 v86, v86, v25
  s_waitcnt vmcnt(0)
  v_mov_b32 v87, 0
  v_lshlrev_b32 v25, 16, v67
  v_and_b32 v26, 0xffff0000, v67
  v_mul_f32 v25, v25, v8
  v_mul_f32 v26, v26, v16
  v_cvt_pk_bf16_f32 v25, v25, v26
  v_lshlrev_b32 v26, 16, v25
  v_and_b32 v25, 0xffff0000, v25
  v_add_f32 v87, v87, v26
  v_add_f32 v87, v87, v25
  v_lshlrev_b32 v25, 16, v68
  v_and_b32 v26, 0xffff0000, v68
  v_mul_f32 v25, v25, v9
  v_mul_f32 v26, v26, v17
  v_cvt_pk_bf16_f32 v25, v25, v26
  v_lshlrev_b32 v26, 16, v25
  v_and_b32 v25, 0xffff0000, v25
  v_add_f32 v87, v87, v26
  v_add_f32 v87, v87, v25
  v_lshlrev_b32 v25, 16, v69
  v_and_b32 v26, 0xffff0000, v69
  v_mul_f32 v25, v25, v10
  v_mul_f32 v26, v26, v18
  v_cvt_pk_bf16_f32 v25, v25, v26
  v_lshlrev_b32 v26, 16, v25
  v_and_b32 v25, 0xffff0000, v25
  v_add_f32 v87, v87, v26
  v_add_f32 v87, v87, v25
  v_lshlrev_b32 v25, 16, v70
  v_and_b32 v26, 0xffff0000, v70
  v_mul_f32 v25, v25, v11
  v_mul_f32 v26, v26, v19
  v_cvt_pk_bf16_f32 v25, v25, v26
  v_lshlrev_b32 v26, 16, v25
  v_and_b32 v25, 0xffff0000, v25
  v_add_f32 v87, v87, v26
  v_add_f32 v87, v87, v25
  v_lshlrev_b32 v25, 16, v71
  v_and_b32 v26, 0xffff0000, v71
  v_mul_f32 v25, v25, v12
  v_mul_f32 v26, v26, v20
  v_cvt_pk_bf16_f32 v25, v25, v26
  v_lshlrev_b32 v26, 16, v25
  v_and_b32 v25, 0xffff0000, v25
  v_add_f32 v87, v87, v26
  v_add_f32 v87, v87, v25
  v_add_f32_dpp v80, v80, v80 row_ror:8 row_mask:0xf bank_mask:0xf
  v_add_f32_dpp v81, v81, v81 row_ror:8 row_mask:0xf bank_mask:0xf
  v_add_f32_dpp v82, v82, v82 row_ror:8 row_mask:0xf bank_mask:0xf
  v_add_f32_dpp v83, v83, v83 row_ror:8 row_mask:0xf bank_mask:0xf
  v_add_f32_dpp v84, v84, v84 row_ror:8 row_mask:0xf bank_mask:0xf
  v_add_f32_dpp v85, v85, v85 row_ror:8 row_mask:0xf bank_mask:0xf
  v_add_f32_dpp v86, v86, v86 row_ror:8 row_mask:0xf bank_mask:0xf
  v_add_f32_dpp v87, v87, v87 row_ror:8 row_mask:0xf bank_mask:0xf
  v_add_f32_dpp v80, v80, v80 row_ror:4 row_mask:0xf bank_mask:0xf
  v_add_f32_dpp v81, v81, v81 row_ror:4 row_mask:0xf bank_mask:0xf
  v_add_f32_dpp v82, v82, v82 row_ror:4 row_mask:0xf bank_mask:0xf
  v_add_f32_dpp v83, v83, v83 row_ror:4 row_mask:0xf bank_mask:0xf
  v_add_f32_dpp v84, v84, v84 row_ror:4 row_mask:0xf bank_mask:0xf
  v_add_f32_dpp v85, v85, v85 row_ror:4 row_mask:0xf bank_mask:0xf
  v_add_f32_dpp v86, v86, v86 row_ror:4 row_mask:0xf bank_mask:0xf
  v_add_f32_dpp v87, v87, v87 row_ror:4 row_mask:0xf bank_mask:0xf
  v_add_f32_dpp v80, v80, v80 row_ror:2 row_mask:0xf bank_mask:0xf
  v_add_f32_dpp v81, v81, v81 row_ror:2 row_mask:0xf bank_mask:0xf
  v_add_f32_dpp v82, v82, v82 row_ror:2 row_mask:0xf bank_mask:0xf
  v_add_f32_dpp v83, v83, v83 row_ror:2 row_mask:0xf bank_mask:0xf
  v_add_f32_dpp v84, v84, v84 row_ror:2 row_mask:0xf bank_mask:0xf
  v_add_f32_dpp v85, v85, v85 row_ror:2 row_mask:0xf bank_mask:0xf
  v_add_f32_dpp v86, v86, v86 row_ror:2 row_mask:0xf bank_mask:0xf
  v_add_f32_dpp v87, v87, v87 row_ror:2 row_mask:0xf bank_mask:0xf
  v_add_f32_dpp v80, v80, v80 row_ror:1 row_mask:0xf bank_mask:0xf
  v_add_f32_dpp v81, v81, v81 row_ror:1 row_mask:0xf bank_mask:0xf
  v_add_f32_dpp v82, v82, v82 row_ror:1 row_mask:0xf bank_mask:0xf
  v_add_f32_dpp v83, v83, v83 row_ror:1 row_mask:0xf bank_mask:0xf
  v_add_f32_dpp v84, v84, v84 row_ror:1 row_mask:0xf bank_mask:0xf
  v_add_f32_dpp v85, v85, v85 row_ror:1 row_mask:0xf bank_mask:0xf
  v_add_f32_dpp v86, v86, v86 row_ror:1 row_mask:0xf bank_mask:0xf
  v_add_f32_dpp v87, v87, v87 row_ror:1 row_mask:0xf bank_mask:0xf
  v_mov_b32 v88, v80
  v_mov_b32 v89, v81
  v_mov_b32 v90, v82
  v_mov_b32 v91, v83
  v_mov_b32 v92, v84
  v_mov_b32 v93, v85
  v_mov_b32 v94, v86
  v_mov_b32 v95, v87
  v_permlane32_swap_b32 v80, v88
  v_permlane32_swap_b32 v81, v89
  v_permlane32_swap_b32 v82, v90
  v_permlane32_swap_b32 v83, v91
  v_permlane32_swap_b32 v84, v92
  v_permlane32_swap_b32 v85, v93
  v_permlane32_swap_b32 v86, v94
  v_permlane32_swap_b32 v87, v95
  v_add_f32 v80, v80, v88
  v_add_f32 v81, v81, v89
  v_add_f32 v82, v82, v90
  v_add_f32 v83, v83, v91
  v_add_f32 v84, v84, v92
  v_add_f32 v85, v85, v93
  v_add_f32 v86, v86, v94
  v_add_f32 v87, v87, v95
  v_mov_b32 v88, v80
  v_mov_b32 v89, v81
  v_mov_b32 v90, v82
  v_mov_b32 v91, v83
  v_mov_b32 v92, v84
  v_mov_b32 v93, v85
  v_mov_b32 v94, v86
  v_mov_b32 v95, v87
  v_permlane16_swap_b32 v80, v88
  v_permlane16_swap_b32 v81, v89
  v_permlane16_swap_b32 v82, v90
  v_permlane16_swap_b32 v83, v91
  v_permlane16_swap_b32 v84, v92
  v_permlane16_swap_b32 v85, v93
  v_permlane16_swap_b32 v86, v94
  v_permlane16_swap_b32 v87, v95
  v_add_f32 v80, v80, v88
  v_add_f32 v81, v81, v89
  v_add_f32 v82, v82, v90
  v_add_f32 v83, v83, v91
  v_add_f32 v84, v84, v92
  v_add_f32 v85, v85, v93
  v_add_f32 v86, v86, v94
  v_add_f32 v87, v87, v95
  v_mov_b32 v24, v80
  v_cmp_eq_u32 vcc, 1, v1
  s_nop 1
  v_cndmask_b32 v24, v24, v81, vcc
  v_cmp_eq_u32 vcc, 2, v1
  s_nop 1
  v_cndmask_b32 v24, v24, v82, vcc
  v_cmp_eq_u32 vcc, 3, v1
  s_nop 1
  v_cndmask_b32 v24, v24, v83, vcc
  v_cmp_eq_u32 vcc, 4, v1
  s_nop 1
  v_cndmask_b32 v24, v24, v84, vcc
  v_cmp_eq_u32 vcc, 5, v1
  s_nop 1
  v_cndmask_b32 v24, v24, v85, vcc
  v_cmp_eq_u32 vcc, 6, v1
  s_nop 1
  v_cndmask_b32 v24, v24, v86, vcc
  v_cmp_eq_u32 vcc, 7, v1
  s_nop 1
  v_cndmask_b32 v24, v24, v87, vcc
  v_cvt_pk_bf16_f32 v25, v24, v24
  v_lshlrev_b32 v24, 16, v25
  v_mul_f32 v24, 0xbfb8aa3b, v24
  v_exp_f32 v24, v24
  s_nop 0
  v_add_f32 v24, 1.0, v24
  v_rcp_f32 v24, v24
  s_nop 0
  v_cvt_pk_bf16_f32 v25, v24, v24
  v_lshlrev_b32 v24, 16, v25
  s_lshl_b32 s21, s59, 2
  s_mov_b64 exec, 0xff
  buffer_store_dword v24, v4, s[28:31], s21 offen sc1
  s_mov_b64 exec, -1
  s_barrier
  v_and_b32 v4, 31, v1
  v_lshrrev_b32 v5, 5, v1
  s_lshl_b32 s22, s20, 1
  v_add_u32 v5, s22, v5
  v_mul_u32_u24 v6, 40, v4
  v_mul_u32_u24 v7, 2560, v5
  v_add_u32 v7, v7, v6
  v_mul_u32_u24 v8, 1280, v5
  s_mov_b32 s22, 117760
  v_add3_u32 v8, v8, v6, s22
  v_add_u32 v5, s58, v5
  s_mov_b32 s59, 0
  s_mov_b32 s60, 0x3e64f92e
  s_mov_b32 s61, 0x3fb8aa3b
  s_mov_b32 s62, 0x05040100
  s_mov_b32 s63, 0x07060302
  v_mov_b32 v9, 0xf149f2ca
ba_312:
  ds_read_b64 v[16:17], v8 offset:0
  ds_read_b64 v[18:19], v8 offset:8
  ds_read_b64 v[20:21], v8 offset:16
  ds_read_b64 v[22:23], v8 offset:24
  ds_read_b64 v[24:25], v8 offset:32
  ds_read_b64 v[32:33], v7 offset:35840
  ds_read_b64 v[34:35], v7 offset:35848
  ds_read_b64 v[36:37], v7 offset:35856
  ds_read_b64 v[38:39], v7 offset:35864
  ds_read_b64 v[40:41], v7 offset:35872
  ds_read_b64 v[42:43], v7 offset:30720
  ds_read_b64 v[44:45], v7 offset:30728
  ds_read_b64 v[46:47], v7 offset:30736
  ds_read_b64 v[48:49], v7 offset:30744
  ds_read_b64 v[50:51], v7 offset:30752
  ds_read_b64 v[52:53], v7 offset:25600
  ds_read_b64 v[54:55], v7 offset:25608
  ds_read_b64 v[56:57], v7 offset:25616
  ds_read_b64 v[58:59], v7 offset:25624
  ds_read_b64 v[60:61], v7 offset:25632
  ds_read_b64 v[62:63], v7 offset:20480
  ds_read_b64 v[64:65], v7 offset:20488
  ds_read_b64 v[66:67], v7 offset:20496
  ds_read_b64 v[68:69], v7 offset:20504
  ds_read_b64 v[70:71], v7 offset:20512
  ds_read_b64 v[72:73], v7 offset:15360
  ds_read_b64 v[74:75], v7 offset:15368
  ds_read_b64 v[76:77], v7 offset:15376
  ds_read_b64 v[78:79], v7 offset:15384
  ds_read_b64 v[80:81], v7 offset:15392
  ds_read_b64 v[82:83], v7 offset:10240
  ds_read_b64 v[84:85], v7 offset:10248
  ds_read_b64 v[86:87], v7 offset:10256
  ds_read_b64 v[88:89], v7 offset:10264
  ds_read_b64 v[90:91], v7 offset:10272
  ds_read_b64 v[92:93], v7 offset:5120
  ds_read_b64 v[94:95], v7 offset:5128
  ds_read_b64 v[96:97], v7 offset:5136
  ds_read_b64 v[98:99], v7 offset:5144
  ds_read_b64 v[100:101], v7 offset:5152
  ds_read_b64 v[102:103], v7 offset:0
  ds_read_b64 v[104:105], v7 offset:8
  ds_read_b64 v[106:107], v7 offset:16
  ds_read_b64 v[108:109], v7 offset:24
  ds_read_b64 v[110:111], v7 offset:32
  v_cmp_le_u32 s[40:41], 0, v5
  v_mov_b32 v224, 0
  v_cmp_le_u32 s[42:43], 2, v5
  v_mov_b32 v225, 0
  v_cmp_le_u32 s[44:45], 4, v5
  v_mov_b32 v226, 0
  v_cmp_le_u32 s[46:47], 6, v5
  v_mov_b32 v227, 0
  v_cmp_le_u32 s[48:49], 8, v5
  v_mov_b32 v228, 0
  v_cmp_le_u32 s[50:51], 10, v5
  v_mov_b32 v229, 0
  v_cmp_le_u32 s[52:53], 12, v5
  v_mov_b32 v230, 0
  v_cmp_le_u32 s[54:55], 14, v5
  v_mov_b32 v231, 0
  v_mov_b32 v200, 0
  v_mov_b32 v201, 0
  v_mov_b32 v202, 0
  v_mov_b32 v203, 0
  v_mov_b32 v204, 0
  v_mov_b32 v205, 0
  v_mov_b32 v206, 0
  v_mov_b32 v207, 0
  v_mov_b32 v208, 0
  v_mov_b32 v209, 0
  v_mov_b32 v210, 0
  v_mov_b32 v211, 0
  v_mov_b32 v212, 0
  v_mov_b32 v213, 0
  v_mov_b32 v214, 0
  v_mov_b32 v215, 0
  v_mov_b32 v216, 0
  v_mov_b32 v217, 0
  v_mov_b32 v218, 0
  v_mov_b32 v219, 0
  s_waitcnt lgkmcnt(15)
  v_dot2c_f32_bf16 v224, v32, v16
  v_dot2c_f32_bf16 v225, v42, v16
  v_dot2c_f32_bf16 v226, v52, v16
  v_dot2c_f32_bf16 v227, v62, v16
  v_dot2c_f32_bf16 v228, v72, v16
  v_dot2c_f32_bf16 v224, v33, v17
  v_dot2c_f32_bf16 v225, v43, v17
  v_dot2c_f32_bf16 v226, v53, v17
  v_dot2c_f32_bf16 v227, v63, v17
  v_dot2c_f32_bf16 v228, v73, v17
  v_dot2c_f32_bf16 v224, v34, v18
  v_dot2c_f32_bf16 v225, v44, v18
  v_dot2c_f32_bf16 v226, v54, v18
  v_dot2c_f32_bf16 v227, v64, v18
  v_dot2c_f32_bf16 v228, v74, v18
  v_dot2c_f32_bf16 v224, v35, v19
  v_dot2c_f32_bf16 v225, v45, v19
  v_dot2c_f32_bf16 v226, v55, v19
  v_dot2c_f32_bf16 v227, v65, v19
  v_dot2c_f32_bf16 v228, v75, v19
  v_dot2c_f32_bf16 v224, v36, v20
  v_dot2c_f32_bf16 v225, v46, v20
  v_dot2c_f32_bf16 v226, v56, v20
  v_dot2c_f32_bf16 v227, v66, v20
  v_dot2c_f32_bf16 v228, v76, v20
  v_dot2c_f32_bf16 v224, v37, v21
  v_dot2c_f32_bf16 v225, v47, v21
  v_dot2c_f32_bf16 v226, v57, v21
  v_dot2c_f32_bf16 v227, v67, v21
  v_dot2c_f32_bf16 v228, v77, v21
  v_dot2c_f32_bf16 v224, v38, v22
  v_dot2c_f32_bf16 v225, v48, v22
  v_dot2c_f32_bf16 v226, v58, v22
  v_dot2c_f32_bf16 v227, v68, v22
  v_dot2c_f32_bf16 v228, v78, v22
  v_dot2c_f32_bf16 v224, v39, v23
  v_dot2c_f32_bf16 v225, v49, v23
  v_dot2c_f32_bf16 v226, v59, v23
  v_dot2c_f32_bf16 v227, v69, v23
  v_dot2c_f32_bf16 v228, v79, v23
  v_dot2c_f32_bf16 v224, v40, v24
  v_dot2c_f32_bf16 v225, v50, v24
  v_dot2c_f32_bf16 v226, v60, v24
  v_dot2c_f32_bf16 v227, v70, v24
  v_dot2c_f32_bf16 v228, v80, v24
  v_dot2c_f32_bf16 v224, v41, v25
  v_dot2c_f32_bf16 v225, v51, v25
  v_dot2c_f32_bf16 v226, v61, v25
  v_dot2c_f32_bf16 v227, v71, v25
  v_dot2c_f32_bf16 v228, v81, v25
  s_waitcnt lgkmcnt(0)
  v_dot2c_f32_bf16 v229, v82, v16
  v_dot2c_f32_bf16 v230, v92, v16
  v_dot2c_f32_bf16 v231, v102, v16
  v_dot2c_f32_bf16 v229, v83, v17
  v_dot2c_f32_bf16 v230, v93, v17
  v_dot2c_f32_bf16 v231, v103, v17
  v_dot2c_f32_bf16 v229, v84, v18
  v_dot2c_f32_bf16 v230, v94, v18
  v_dot2c_f32_bf16 v231, v104, v18
  v_dot2c_f32_bf16 v229, v85, v19
  v_dot2c_f32_bf16 v230, v95, v19
  v_dot2c_f32_bf16 v231, v105, v19
  v_dot2c_f32_bf16 v229, v86, v20
  v_dot2c_f32_bf16 v230, v96, v20
  v_dot2c_f32_bf16 v231, v106, v20
  v_dot2c_f32_bf16 v229, v87, v21
  v_dot2c_f32_bf16 v230, v97, v21
  v_dot2c_f32_bf16 v231, v107, v21
  v_dot2c_f32_bf16 v229, v88, v22
  v_dot2c_f32_bf16 v230, v98, v22
  v_dot2c_f32_bf16 v231, v108, v22
  v_dot2c_f32_bf16 v229, v89, v23
  v_dot2c_f32_bf16 v230, v99, v23
  v_dot2c_f32_bf16 v231, v109, v23
  v_dot2c_f32_bf16 v229, v90, v24
  v_dot2c_f32_bf16 v230, v100, v24
  v_dot2c_f32_bf16 v231, v110, v24
  v_dot2c_f32_bf16 v229, v91, v25
  v_dot2c_f32_bf16 v230, v101, v25
  v_dot2c_f32_bf16 v231, v111, v25
  ds_read_b64 v[112:113], v7 offset:37120
  ds_read_b64 v[114:115], v7 offset:37128
  ds_read_b64 v[116:117], v7 offset:37136
  ds_read_b64 v[118:119], v7 offset:37144
  ds_read_b64 v[120:121], v7 offset:37152
  ds_read_b64 v[122:123], v7 offset:32000
  ds_read_b64 v[124:125], v7 offset:32008
  ds_read_b64 v[126:127], v7 offset:32016
  ds_read_b64 v[128:129], v7 offset:32024
  ds_read_b64 v[130:131], v7 offset:32032
  ds_read_b64 v[132:133], v7 offset:26880
  ds_read_b64 v[134:135], v7 offset:26888
  ds_read_b64 v[136:137], v7 offset:26896
  ds_read_b64 v[138:139], v7 offset:26904
  ds_read_b64 v[140:141], v7 offset:26912
  ds_read_b64 v[142:143], v7 offset:21760
  ds_read_b64 v[144:145], v7 offset:21768
  ds_read_b64 v[146:147], v7 offset:21776
  ds_read_b64 v[148:149], v7 offset:21784
  ds_read_b64 v[150:151], v7 offset:21792
  ds_read_b64 v[152:153], v7 offset:16640
  ds_read_b64 v[154:155], v7 offset:16648
  ds_read_b64 v[156:157], v7 offset:16656
  ds_read_b64 v[158:159], v7 offset:16664
  ds_read_b64 v[160:161], v7 offset:16672
  ds_read_b64 v[162:163], v7 offset:11520
  ds_read_b64 v[164:165], v7 offset:11528
  ds_read_b64 v[166:167], v7 offset:11536
  ds_read_b64 v[168:169], v7 offset:11544
  ds_read_b64 v[170:171], v7 offset:11552
  ds_read_b64 v[172:173], v7 offset:6400
  ds_read_b64 v[174:175], v7 offset:6408
  ds_read_b64 v[176:177], v7 offset:6416
  ds_read_b64 v[178:179], v7 offset:6424
  ds_read_b64 v[180:181], v7 offset:6432
  ds_read_b64 v[182:183], v7 offset:1280
  ds_read_b64 v[184:185], v7 offset:1288
  ds_read_b64 v[186:187], v7 offset:1296
  ds_read_b64 v[188:189], v7 offset:1304
  ds_read_b64 v[190:191], v7 offset:1312
  v_cvt_pk_bf16_f32 v10, v224, v225
  v_lshlrev_b32 v224, 16, v10
  v_and_b32 v225, 0xffff0000, v10
  v_mul_f32 v224, s60, v224
  v_mul_f32 v225, s60, v225
  v_cvt_pk_bf16_f32 v10, v224, v225
  v_lshlrev_b32 v224, 16, v10
  v_and_b32 v225, 0xffff0000, v10
  v_cndmask_b32 v224, v9, v224, s[40:41]
  v_cndmask_b32 v225, v9, v225, s[42:43]
  v_cvt_pk_bf16_f32 v10, v226, v227
  v_lshlrev_b32 v226, 16, v10
  v_and_b32 v227, 0xffff0000, v10
  v_mul_f32 v226, s60, v226
  v_mul_f32 v227, s60, v227
  v_cvt_pk_bf16_f32 v10, v226, v227
  v_lshlrev_b32 v226, 16, v10
  v_and_b32 v227, 0xffff0000, v10
  v_cndmask_b32 v226, v9, v226, s[44:45]
  v_cndmask_b32 v227, v9, v227, s[46:47]
  v_cvt_pk_bf16_f32 v10, v228, v229
  v_lshlrev_b32 v228, 16, v10
  v_and_b32 v229, 0xffff0000, v10
  v_mul_f32 v228, s60, v228
  v_mul_f32 v229, s60, v229
  v_cvt_pk_bf16_f32 v10, v228, v229
  v_lshlrev_b32 v228, 16, v10
  v_and_b32 v229, 0xffff0000, v10
  v_cndmask_b32 v228, v9, v228, s[48:49]
  v_cndmask_b32 v229, v9, v229, s[50:51]
  v_cvt_pk_bf16_f32 v10, v230, v231
  v_lshlrev_b32 v230, 16, v10
  v_and_b32 v231, 0xffff0000, v10
  v_mul_f32 v230, s60, v230
  v_mul_f32 v231, s60, v231
  v_cvt_pk_bf16_f32 v10, v230, v231
  v_lshlrev_b32 v230, 16, v10
  v_and_b32 v231, 0xffff0000, v10
  v_cndmask_b32 v230, v9, v230, s[52:53]
  v_cndmask_b32 v231, v9, v231, s[54:55]
  v_max3_f32 v12, v224, v225, v226
  v_max3_f32 v12, v12, v227, v228
  v_max3_f32 v12, v12, v229, v230
  v_max_f32 v12, v12, v231
  v_sub_f32 v224, v224, v12
  v_mul_f32 v224, s61, v224
  v_exp_f32 v224, v224
  v_sub_f32 v225, v225, v12
  v_mul_f32 v225, s61, v225
  v_exp_f32 v225, v225
  v_sub_f32 v226, v226, v12
  v_mul_f32 v226, s61, v226
  v_exp_f32 v226, v226
  v_sub_f32 v227, v227, v12
  v_mul_f32 v227, s61, v227
  v_exp_f32 v227, v227
  v_sub_f32 v228, v228, v12
  v_mul_f32 v228, s61, v228
  v_exp_f32 v228, v228
  v_sub_f32 v229, v229, v12
  v_mul_f32 v229, s61, v229
  v_exp_f32 v229, v229
  v_sub_f32 v230, v230, v12
  v_mul_f32 v230, s61, v230
  v_exp_f32 v230, v230
  v_sub_f32 v231, v231, v12
  v_mul_f32 v231, s61, v231
  v_exp_f32 v231, v231
  s_nop 0
  v_add_f32 v12, v224, v225
  v_add_f32 v12, v12, v226
  v_add_f32 v12, v12, v227
  v_add_f32 v12, v12, v228
  v_add_f32 v12, v12, v229
  v_add_f32 v12, v12, v230
  v_add_f32 v12, v12, v231
  v_rcp_f32 v12, v12
  s_nop 0
  v_mul_f32 v224, v224, v12
  v_mul_f32 v225, v225, v12
  v_mul_f32 v226, v226, v12
  v_mul_f32 v227, v227, v12
  v_mul_f32 v228, v228, v12
  v_mul_f32 v229, v229, v12
  v_mul_f32 v230, v230, v12
  v_mul_f32 v231, v231, v12
  v_cvt_pk_bf16_f32 v232, v224, v225
  v_cvt_pk_bf16_f32 v233, v226, v227
  v_cvt_pk_bf16_f32 v234, v228, v229
  v_cvt_pk_bf16_f32 v235, v230, v231
  s_waitcnt lgkmcnt(15)
  v_perm_b32 v236, v122, v112, s62
  v_perm_b32 v237, v122, v112, s63
  v_dot2c_f32_bf16 v200, v236, v232
  v_dot2c_f32_bf16 v201, v237, v232
  v_perm_b32 v238, v123, v113, s62
  v_perm_b32 v239, v123, v113, s63
  v_dot2c_f32_bf16 v202, v238, v232
  v_dot2c_f32_bf16 v203, v239, v232
  v_perm_b32 v240, v124, v114, s62
  v_perm_b32 v241, v124, v114, s63
  v_dot2c_f32_bf16 v204, v240, v232
  v_dot2c_f32_bf16 v205, v241, v232
  v_perm_b32 v242, v125, v115, s62
  v_perm_b32 v243, v125, v115, s63
  v_dot2c_f32_bf16 v206, v242, v232
  v_dot2c_f32_bf16 v207, v243, v232
  v_perm_b32 v236, v126, v116, s62
  v_perm_b32 v237, v126, v116, s63
  v_dot2c_f32_bf16 v208, v236, v232
  v_dot2c_f32_bf16 v209, v237, v232
  v_perm_b32 v238, v127, v117, s62
  v_perm_b32 v239, v127, v117, s63
  v_dot2c_f32_bf16 v210, v238, v232
  v_dot2c_f32_bf16 v211, v239, v232
  v_perm_b32 v240, v128, v118, s62
  v_perm_b32 v241, v128, v118, s63
  v_dot2c_f32_bf16 v212, v240, v232
  v_dot2c_f32_bf16 v213, v241, v232
  v_perm_b32 v242, v129, v119, s62
  v_perm_b32 v243, v129, v119, s63
  v_dot2c_f32_bf16 v214, v242, v232
  v_dot2c_f32_bf16 v215, v243, v232
  v_perm_b32 v236, v130, v120, s62
  v_perm_b32 v237, v130, v120, s63
  v_dot2c_f32_bf16 v216, v236, v232
  v_dot2c_f32_bf16 v217, v237, v232
  v_perm_b32 v238, v131, v121, s62
  v_perm_b32 v239, v131, v121, s63
  v_dot2c_f32_bf16 v218, v238, v232
  v_dot2c_f32_bf16 v219, v239, v232
  s_waitcnt lgkmcnt(15)
  v_perm_b32 v236, v142, v132, s62
  v_perm_b32 v237, v142, v132, s63
  v_dot2c_f32_bf16 v200, v236, v233
  v_dot2c_f32_bf16 v201, v237, v233
  v_perm_b32 v238, v143, v133, s62
  v_perm_b32 v239, v143, v133, s63
  v_dot2c_f32_bf16 v202, v238, v233
  v_dot2c_f32_bf16 v203, v239, v233
  v_perm_b32 v240, v144, v134, s62
  v_perm_b32 v241, v144, v134, s63
  v_dot2c_f32_bf16 v204, v240, v233
  v_dot2c_f32_bf16 v205, v241, v233
  v_perm_b32 v242, v145, v135, s62
  v_perm_b32 v243, v145, v135, s63
  v_dot2c_f32_bf16 v206, v242, v233
  v_dot2c_f32_bf16 v207, v243, v233
  v_perm_b32 v236, v146, v136, s62
  v_perm_b32 v237, v146, v136, s63
  v_dot2c_f32_bf16 v208, v236, v233
  v_dot2c_f32_bf16 v209, v237, v233
  v_perm_b32 v238, v147, v137, s62
  v_perm_b32 v239, v147, v137, s63
  v_dot2c_f32_bf16 v210, v238, v233
  v_dot2c_f32_bf16 v211, v239, v233
  v_perm_b32 v240, v148, v138, s62
  v_perm_b32 v241, v148, v138, s63
  v_dot2c_f32_bf16 v212, v240, v233
  v_dot2c_f32_bf16 v213, v241, v233
  v_perm_b32 v242, v149, v139, s62
  v_perm_b32 v243, v149, v139, s63
  v_dot2c_f32_bf16 v214, v242, v233
  v_dot2c_f32_bf16 v215, v243, v233
  v_perm_b32 v236, v150, v140, s62
  v_perm_b32 v237, v150, v140, s63
  v_dot2c_f32_bf16 v216, v236, v233
  v_dot2c_f32_bf16 v217, v237, v233
  v_perm_b32 v238, v151, v141, s62
  v_perm_b32 v239, v151, v141, s63
  v_dot2c_f32_bf16 v218, v238, v233
  v_dot2c_f32_bf16 v219, v239, v233
  s_waitcnt lgkmcnt(10)
  v_perm_b32 v236, v162, v152, s62
  v_perm_b32 v237, v162, v152, s63
  v_dot2c_f32_bf16 v200, v236, v234
  v_dot2c_f32_bf16 v201, v237, v234
  v_perm_b32 v238, v163, v153, s62
  v_perm_b32 v239, v163, v153, s63
  v_dot2c_f32_bf16 v202, v238, v234
  v_dot2c_f32_bf16 v203, v239, v234
  v_perm_b32 v240, v164, v154, s62
  v_perm_b32 v241, v164, v154, s63
  v_dot2c_f32_bf16 v204, v240, v234
  v_dot2c_f32_bf16 v205, v241, v234
  v_perm_b32 v242, v165, v155, s62
  v_perm_b32 v243, v165, v155, s63
  v_dot2c_f32_bf16 v206, v242, v234
  v_dot2c_f32_bf16 v207, v243, v234
  v_perm_b32 v236, v166, v156, s62
  v_perm_b32 v237, v166, v156, s63
  v_dot2c_f32_bf16 v208, v236, v234
  v_dot2c_f32_bf16 v209, v237, v234
  v_perm_b32 v238, v167, v157, s62
  v_perm_b32 v239, v167, v157, s63
  v_dot2c_f32_bf16 v210, v238, v234
  v_dot2c_f32_bf16 v211, v239, v234
  v_perm_b32 v240, v168, v158, s62
  v_perm_b32 v241, v168, v158, s63
  v_dot2c_f32_bf16 v212, v240, v234
  v_dot2c_f32_bf16 v213, v241, v234
  v_perm_b32 v242, v169, v159, s62
  v_perm_b32 v243, v169, v159, s63
  v_dot2c_f32_bf16 v214, v242, v234
  v_dot2c_f32_bf16 v215, v243, v234
  v_perm_b32 v236, v170, v160, s62
  v_perm_b32 v237, v170, v160, s63
  v_dot2c_f32_bf16 v216, v236, v234
  v_dot2c_f32_bf16 v217, v237, v234
  v_perm_b32 v238, v171, v161, s62
  v_perm_b32 v239, v171, v161, s63
  v_dot2c_f32_bf16 v218, v238, v234
  v_dot2c_f32_bf16 v219, v239, v234
  s_waitcnt lgkmcnt(0)
  v_perm_b32 v236, v182, v172, s62
  v_perm_b32 v237, v182, v172, s63
  v_dot2c_f32_bf16 v200, v236, v235
  v_dot2c_f32_bf16 v201, v237, v235
  v_perm_b32 v238, v183, v173, s62
  v_perm_b32 v239, v183, v173, s63
  v_dot2c_f32_bf16 v202, v238, v235
  v_dot2c_f32_bf16 v203, v239, v235
  v_perm_b32 v240, v184, v174, s62
  v_perm_b32 v241, v184, v174, s63
  v_dot2c_f32_bf16 v204, v240, v235
  v_dot2c_f32_bf16 v205, v241, v235
  v_perm_b32 v242, v185, v175, s62
  v_perm_b32 v243, v185, v175, s63
  v_dot2c_f32_bf16 v206, v242, v235
  v_dot2c_f32_bf16 v207, v243, v235
  v_perm_b32 v236, v186, v176, s62
  v_perm_b32 v237, v186, v176, s63
  v_dot2c_f32_bf16 v208, v236, v235
  v_dot2c_f32_bf16 v209, v237, v235
  v_perm_b32 v238, v187, v177, s62
  v_perm_b32 v239, v187, v177, s63
  v_dot2c_f32_bf16 v210, v238, v235
  v_dot2c_f32_bf16 v211, v239, v235
  v_perm_b32 v240, v188, v178, s62
  v_perm_b32 v241, v188, v178, s63
  v_dot2c_f32_bf16 v212, v240, v235
  v_dot2c_f32_bf16 v213, v241, v235
  v_perm_b32 v242, v189, v179, s62
  v_perm_b32 v243, v189, v179, s63
  v_dot2c_f32_bf16 v214, v242, v235
  v_dot2c_f32_bf16 v215, v243, v235
  v_perm_b32 v236, v190, v180, s62
  v_perm_b32 v237, v190, v180, s63
  v_dot2c_f32_bf16 v216, v236, v235
  v_dot2c_f32_bf16 v217, v237, v235
  v_perm_b32 v238, v191, v181, s62
  v_perm_b32 v239, v191, v181, s63
  v_dot2c_f32_bf16 v218, v238, v235
  v_dot2c_f32_bf16 v219, v239, v235
  v_cvt_pk_bf16_f32 v244, v200, v201
  v_cvt_pk_bf16_f32 v245, v202, v203
  v_cvt_pk_bf16_f32 v246, v204, v205
  v_cvt_pk_bf16_f32 v247, v206, v207
  v_cvt_pk_bf16_f32 v248, v208, v209
  v_cvt_pk_bf16_f32 v249, v210, v211
  v_cvt_pk_bf16_f32 v250, v212, v213
  v_cvt_pk_bf16_f32 v251, v214, v215
  v_cvt_pk_bf16_f32 v252, v216, v217
  v_cvt_pk_bf16_f32 v253, v218, v219
  v_lshrrev_b32 v10, 4, v5
  v_mul_u32_u24 v10, 20480, v10
  v_and_b32 v11, 15, v5
  v_lshl_add_u32 v10, v11, 4, v10
  v_mul_u32_u24 v11, 5, v4
  v_add_u32 v12, 0, v11
  v_lshrrev_b32 v13, 1, v12
  v_and_b32 v12, 1, v12
  v_lshl_add_u32 v13, v13, 8, v10
  v_lshl_add_u32 v13, v12, 3, v13
  buffer_store_dwordx2 v[244:245], v13, s[24:27], 0 offen sc1
  v_add_u32 v12, 1, v11
  v_lshrrev_b32 v13, 1, v12
  v_and_b32 v12, 1, v12
  v_lshl_add_u32 v13, v13, 8, v10
  v_lshl_add_u32 v13, v12, 3, v13
  buffer_store_dwordx2 v[246:247], v13, s[24:27], 0 offen sc1
  v_add_u32 v12, 2, v11
  v_lshrrev_b32 v13, 1, v12
  v_and_b32 v12, 1, v12
  v_lshl_add_u32 v13, v13, 8, v10
  v_lshl_add_u32 v13, v12, 3, v13
  buffer_store_dwordx2 v[248:249], v13, s[24:27], 0 offen sc1
  v_add_u32 v12, 3, v11
  v_lshrrev_b32 v13, 1, v12
  v_and_b32 v12, 1, v12
  v_lshl_add_u32 v13, v13, 8, v10
  v_lshl_add_u32 v13, v12, 3, v13
  buffer_store_dwordx2 v[250:251], v13, s[24:27], 0 offen sc1
  v_add_u32 v12, 4, v11
  v_lshrrev_b32 v13, 1, v12
  v_and_b32 v12, 1, v12
  v_lshl_add_u32 v13, v13, 8, v10
  v_lshl_add_u32 v13, v12, 3, v13
  buffer_store_dwordx2 v[252:253], v13, s[24:27], 0 offen sc1
  v_add_u32 v5, 8, v5
  v_add_u32 v7, 20480, v7
  v_add_u32 v8, 10240, v8
  s_add_u32 s59, s59, 1
  s_cmp_lt_u32 s59, 4
  s_cbranch_scc1 ba_312
  s_waitcnt vmcnt(0)
  s_barrier
  s_lshr_b32 s21, s2, 2
  s_lshl_b32 s21, s21, 7
  s_add_u32 s21, s21, 90112
  s_cmp_lg_u32 s20, 0
  s_cbranch_scc1 af_313
  v_mov_b32 v8, 0
  v_mov_b32 v9, 1
  s_mov_b64 exec, 1
  buffer_atomic_add v9, v8, s[72:75], s21 offen sc1
  s_mov_b64 exec, -1
  s_nop 1
af_313:
  s_branch queue
main_fin:
  s_waitcnt vmcnt(0)
main_end:
  s_endpgm
.section .rodata,"a"
.p2align 6
.amdhsa_kernel gated_mix__memory_aug_recurrent_mem_tr__sliding_local_dilated__prompt_kernel
  .amdhsa_next_free_vgpr 512
  .amdhsa_next_free_sgpr 102
  .amdhsa_accum_offset 256
  .amdhsa_group_segment_fixed_size 0
  .amdhsa_kernarg_size 112
  .amdhsa_user_sgpr_count 2
  .amdhsa_user_sgpr_kernarg_segment_ptr 1
  .amdhsa_system_sgpr_workgroup_id_x 1
.end_amdhsa_kernel
.text
```

```asm
; @launch kernel=gated_mix__memory_aug_recurrent_mem_tr__sliding_local_dilated__prompt_kernel grid=(256,1,1) block=(256,1,1) lds=163840
.amdgcn_target "amdgcn-amd-amdhsa--gfx950"
.text
.globl gated_mix__memory_aug_recurrent_mem_tr__sliding_local_dilated__prompt_kernel
.p2align 8
.type gated_mix__memory_aug_recurrent_mem_tr__sliding_local_dilated__prompt_kernel,@function
gated_mix__memory_aug_recurrent_mem_tr__sliding_local_dilated__prompt_kernel:
  s_cmp_ge_u32 s2, 256
  s_cbranch_scc1 end0
  s_load_dwordx2 s[4:5], s[0:1], 96
  s_load_dwordx2 s[38:39], s[0:1], 104
  v_lshrrev_b32 v1, 6, v0
  v_and_b32 v2, 15, v0
  v_readfirstlane_b32 s20, v1
  v_and_b32 v1, 63, v0
  v_lshrrev_b32 v3, 4, v1
  s_getreg_b32 s50, hwreg(HW_REG_XCC_ID)
  s_and_b32 s50, s50, 7
  s_waitcnt lgkmcnt(0)
  s_mov_b32 s32, s4
  s_mov_b32 s33, s5
  s_mov_b32 s34, 256
  s_mov_b32 s35, 0x00020000
  v_mov_b32 v21, 0
  s_cmp_lg_u32 s20, 0
  s_cbranch_scc1 rk_1
  s_and_b32 s21, s50, 1
  s_lshl_b32 s21, s21, 7
  s_lshl_b32 s22, s50, 1
  s_and_b32 s22, s22, 12
  s_add_u32 s21, s21, s22
  v_mov_b32 v22, s21
  v_mov_b32 v23, 1
  s_mov_b64 exec, 1
  buffer_atomic_add v23, v22, s[32:35], 0 offen sc0 sc1
  s_waitcnt vmcnt(0)
  v_readfirstlane_b32 s51, v23
  s_lshl_b32 s22, s50, 5
  s_add_u32 s22, s22, s51
  s_cmp_lt_u32 s51, 32
  s_cbranch_scc1 rk_2
  v_mov_b32 v24, 72
  v_mov_b32 v25, 1
  buffer_atomic_add v25, v24, s[32:35], 0 offen sc0 sc1
  s_waitcnt vmcnt(0)
  v_readfirstlane_b32 s23, v25
  s_mov_b32 s101, 0
  s_mov_b64 exec, -1
  v_lshlrev_b32 v24, 2, v1
rk_3:
  s_sleep 8
  buffer_load_dword v25, v24, s[32:35], 0 offen sc1
  s_add_u32 s101, s101, 1
  s_cmp_gt_u32 s101, 131072
  s_cbranch_scc1 end0
  s_waitcnt vmcnt(0)
  v_readlane_b32 s21, v25, 0
  v_readlane_b32 s22, v25, 32
  s_add_u32 s21, s21, s22
  v_readlane_b32 s22, v25, 1
  s_add_u32 s21, s21, s22
  v_readlane_b32 s22, v25, 33
  s_add_u32 s21, s21, s22
  v_readlane_b32 s22, v25, 2
  s_add_u32 s21, s21, s22
  v_readlane_b32 s22, v25, 34
  s_add_u32 s21, s21, s22
  v_readlane_b32 s22, v25, 3
  s_add_u32 s21, s21, s22
  v_readlane_b32 s22, v25, 35
  s_add_u32 s21, s21, s22
  s_cmp_lt_u32 s21, 256
  s_cbranch_scc1 rk_3
  s_mov_b64 exec, 1
  s_mov_b32 s24, 0
rk_5:
  s_and_b32 s21, s24, 1
  s_lshl_b32 s21, s21, 5
  s_lshr_b32 s22, s24, 1
  s_add_u32 s21, s21, s22
  v_readlane_b32 s21, v25, s21
  s_min_u32 s21, s21, 32
  s_sub_u32 s25, 32, s21
  s_cmp_lt_u32 s23, s25
  s_cbranch_scc1 rk_4
  s_sub_u32 s23, s23, s25
  s_add_u32 s24, s24, 1
  s_cmp_lt_u32 s24, 8
  s_cbranch_scc1 rk_5
  s_branch end0
rk_4:
  s_lshl_b32 s22, s24, 5
  s_add_u32 s22, s22, s21
  s_add_u32 s22, s22, s23
  s_or_b32 s22, s22, 0x100
rk_2:
  v_mov_b32 v23, s22
  ds_write_b32 v21, v23
  s_waitcnt lgkmcnt(0)
  s_mov_b64 exec, -1
rk_1:
  s_barrier
  ds_read_b32 v23, v21
  s_waitcnt lgkmcnt(0)
  v_readfirstlane_b32 s22, v23
  s_barrier
  s_mov_b32 s84, 0
  s_mov_b32 s85, -1

  s_lshr_b32 s53, s22, 8
  s_and_b32 s22, s22, 255
  s_cmp_ge_u32 s22, 128
  s_cbranch_scc1 gemm_side
  s_lshr_b32 s50, s22, 4
  s_and_b32 s51, s22, 15
  s_mov_b32 s86, 0x3dd53b95
  s_load_dwordx2 s[4:5], s[0:1], 8
  s_load_dwordx4 s[36:39], s[0:1], 16
  s_load_dwordx4 s[40:43], s[0:1], 32
  s_load_dwordx2 s[44:45], s[0:1], 104
  s_lshr_b32 s55, s51, 2
  s_and_b32 s56, s51, 3
  s_lshl_b32 s57, s50, 2
  s_add_u32 s58, s57, s55
  s_add_u32 s59, s57, s20
  s_lshr_b32 s21, s51, 1
  s_xor_b32 s21, s21, s55
  s_andn2_b32 s21, 1, s21
  s_xor_b32 s85, s51, s21
  s_xor_b32 s84, s56, 1
  s_mul_i32 s87, s85, 5
  s_lshr_b32 s87, s87, 1
  s_and_b32 s79, s85, 1
  s_waitcnt lgkmcnt(0)
  s_add_u32 s8, s44, 78643200
  s_addc_u32 s9, s45, 0
  s_mov_b32 s10, 2162688
  s_mov_b32 s11, 0x00020000
  s_mov_b32 s16, s44
  s_mov_b32 s17, s45
  s_mov_b32 s18, 50331648
  s_mov_b32 s19, 0x00020000
  s_add_u32 s24, s44, 50331648
  s_addc_u32 s25, s45, 0
  s_mov_b32 s26, 12582912
  s_mov_b32 s27, 0x00020000
  s_mov_b32 s28, s4
  s_mov_b32 s29, s5
  s_mov_b32 s30, 10240
  s_mov_b32 s31, 0x00020000
  s_add_u32 s4, s44, 83886079
  s_addc_u32 s5, s45, 0
  s_and_b32 s4, s4, 0xffe00000
  s_mov_b32 s6, 2097152
  s_mov_b32 s7, 0x00020000
  v_mov_b32 v27, 10923
  v_add_u32 v103, 0, v1
  v_mul_u32_u24 v102, v103, v27
  v_lshrrev_b32 v102, 16, v102
  v_mul_u32_u24 v101, 6, v102
  v_sub_u32 v103, v103, v101
  v_bfe_u32 v101, v102, 1, 1
  v_mul_u32_u24 v101, 20, v101
  v_and_b32 v100, 1, v102
  v_add_u32 v101, v101, v100
  v_lshrrev_b32 v100, 3, v102
  v_mul_u32_u24 v100, 40, v100
  v_bfe_u32 v99, v102, 2, 1
  v_lshl_add_u32 v100, v99, 1, v100
  v_add_u32 v100, v100, v101
  v_mul_u32_u24 v100, 12288, v100
  v_lshl_add_u32 v46, v103, 4, v100
  v_lshrrev_b32 v100, 4, v102
  v_mul_u32_u24 v100, 40, v100
  v_bfe_u32 v99, v102, 2, 2
  v_lshl_add_u32 v100, v99, 1, v100
  v_add_u32 v100, v100, v101
  v_mul_u32_u24 v100, 12288, v100
  v_lshl_add_u32 v96, v103, 4, v100
  v_add_u32 v103, 64, v1
  v_mul_u32_u24 v102, v103, v27
  v_lshrrev_b32 v102, 16, v102
  v_mul_u32_u24 v101, 6, v102
  v_sub_u32 v103, v103, v101
  v_bfe_u32 v101, v102, 1, 1
  v_mul_u32_u24 v101, 20, v101
  v_and_b32 v100, 1, v102
  v_add_u32 v101, v101, v100
  v_lshrrev_b32 v100, 3, v102
  v_mul_u32_u24 v100, 40, v100
  v_bfe_u32 v99, v102, 2, 1
  v_lshl_add_u32 v100, v99, 1, v100
  v_add_u32 v100, v100, v101
  v_mul_u32_u24 v100, 12288, v100
  v_lshl_add_u32 v47, v103, 4, v100
  v_lshrrev_b32 v100, 4, v102
  v_mul_u32_u24 v100, 40, v100
  v_bfe_u32 v99, v102, 2, 2
  v_lshl_add_u32 v100, v99, 1, v100
  v_add_u32 v100, v100, v101
  v_mul_u32_u24 v100, 12288, v100
  v_lshl_add_u32 v97, v103, 4, v100
  v_add_u32 v103, 128, v1
  v_mul_u32_u24 v102, v103, v27
  v_lshrrev_b32 v102, 16, v102
  v_mul_u32_u24 v101, 6, v102
  v_sub_u32 v103, v103, v101
  v_bfe_u32 v101, v102, 1, 1
  v_mul_u32_u24 v101, 20, v101
  v_and_b32 v100, 1, v102
  v_add_u32 v101, v101, v100
  v_lshrrev_b32 v100, 3, v102
  v_mul_u32_u24 v100, 40, v100
  v_bfe_u32 v99, v102, 2, 1
  v_lshl_add_u32 v100, v99, 1, v100
  v_add_u32 v100, v100, v101
  v_mul_u32_u24 v100, 12288, v100
  v_lshl_add_u32 v48, v103, 4, v100
  v_lshrrev_b32 v100, 4, v102
  v_mul_u32_u24 v100, 40, v100
  v_bfe_u32 v99, v102, 2, 2
  v_lshl_add_u32 v100, v99, 1, v100
  v_add_u32 v100, v100, v101
  v_mul_u32_u24 v100, 12288, v100
  v_lshl_add_u32 v98, v103, 4, v100
  s_mul_i32 s80, s58, 384
  s_mul_i32 s22, s56, 96
  s_add_u32 s80, s80, s22
  s_mul_i32 s22, s20, 1966080
  s_add_u32 s80, s80, s22
  s_mul_i32 s88, s84, 96
  s_mul_i32 s21, s56, 96
  s_sub_u32 s88, s88, s21
  s_add_u32 s88, s88, s80
  s_mul_i32 s81, s20, 40448

  s_mul_i32 s82, s59, 245760
  s_lshl_b32 s22, s87, 5
  s_add_u32 s82, s82, s22
  s_mov_b32 s12, s38
  s_mov_b32 s13, s39
  s_mov_b32 s14, 7864320
  s_mov_b32 s15, 0x00020000
  s_add_u32 s21, s80, 0
  s_add_u32 s22, s81, 0
  s_add_u32 m0, s22, 0
  s_nop 0
  buffer_load_dwordx4 v96, s[12:15], s21 offen lds
  s_add_u32 m0, s22, 1024
  s_nop 0
  buffer_load_dwordx4 v97, s[12:15], s21 offen lds
  s_add_u32 m0, s22, 2048
  s_nop 0
  buffer_load_dwordx4 v98, s[12:15], s21 offen lds
  s_add_u32 s21, s80, 983040
  s_add_u32 s22, s81, 3072
  s_add_u32 m0, s22, 0
  s_nop 0
  buffer_load_dwordx4 v96, s[12:15], s21 offen lds
  s_add_u32 m0, s22, 1024
  s_nop 0
  buffer_load_dwordx4 v97, s[12:15], s21 offen lds
  s_add_u32 m0, s22, 2048
  s_nop 0
  buffer_load_dwordx4 v98, s[12:15], s21 offen lds
  s_add_u32 s21, s80, 98304
  s_add_u32 s22, s81, 6144
  s_add_u32 m0, s22, 0
  s_nop 0
  buffer_load_dwordx4 v96, s[12:15], s21 offen lds
  s_add_u32 m0, s22, 1024
  s_nop 0
  buffer_load_dwordx4 v97, s[12:15], s21 offen lds
  s_add_u32 m0, s22, 2048
  s_nop 0
  buffer_load_dwordx4 v98, s[12:15], s21 offen lds
  s_add_u32 s21, s80, 1081344
  s_add_u32 s22, s81, 9216
  s_add_u32 m0, s22, 0
  s_nop 0
  buffer_load_dwordx4 v96, s[12:15], s21 offen lds
  s_add_u32 m0, s22, 1024
  s_nop 0
  buffer_load_dwordx4 v97, s[12:15], s21 offen lds
  s_add_u32 m0, s22, 2048
  s_nop 0
  buffer_load_dwordx4 v98, s[12:15], s21 offen lds
  s_add_u32 s21, s80, 196608
  s_add_u32 s22, s81, 12288
  s_add_u32 m0, s22, 0
  s_nop 0
  buffer_load_dwordx4 v46, s[12:15], s21 offen lds
  s_add_u32 m0, s22, 1024
  s_nop 0
  buffer_load_dwordx4 v47, s[12:15], s21 offen lds
  s_add_u32 m0, s22, 2048
  s_nop 0
  buffer_load_dwordx4 v48, s[12:15], s21 offen lds
  s_mov_b32 s12, s40
  s_mov_b32 s13, s41
  s_mov_b32 s14, 7864320
  s_mov_b32 s15, 0x00020000
  s_add_u32 s21, s88, 0
  s_add_u32 s22, s81, 0
  buffer_load_dwordx4 v[128:131], v96, s[12:15], s21 offen
  buffer_load_dwordx4 v[132:135], v97, s[12:15], s21 offen
  buffer_load_dwordx4 v[136:139], v98, s[12:15], s21 offen
  s_add_u32 s21, s88, 983040
  s_add_u32 s22, s81, 3072
  buffer_load_dwordx4 v[140:143], v96, s[12:15], s21 offen
  buffer_load_dwordx4 v[144:147], v97, s[12:15], s21 offen
  buffer_load_dwordx4 v[148:151], v98, s[12:15], s21 offen
  s_add_u32 s21, s88, 98304
  s_add_u32 s22, s81, 6144
  buffer_load_dwordx4 v[152:155], v96, s[12:15], s21 offen
  buffer_load_dwordx4 v[156:159], v97, s[12:15], s21 offen
  buffer_load_dwordx4 v[160:163], v98, s[12:15], s21 offen
  s_add_u32 s21, s88, 1081344
  s_add_u32 s22, s81, 9216
  buffer_load_dwordx4 v[164:167], v96, s[12:15], s21 offen
  buffer_load_dwordx4 v[168:171], v97, s[12:15], s21 offen
  buffer_load_dwordx4 v[172:175], v98, s[12:15], s21 offen
  s_add_u32 s21, s88, 196608
  s_add_u32 s22, s81, 12288
  buffer_load_dwordx4 v[176:179], v46, s[12:15], s21 offen
  buffer_load_dwordx4 v[180:183], v47, s[12:15], s21 offen
  buffer_load_dwordx4 v[184:187], v48, s[12:15], s21 offen
  v_lshrrev_b32 v99, 2, v2
  v_lshl_add_u32 v99, v3, 3, v99
  v_mul_u32_u24 v99, 96, v99
  v_and_b32 v100, 3, v2
  v_lshlrev_b32 v100, 3, v100
  v_add3_u32 v99, v99, v100, s81
  v_lshlrev_b32 v100, 4, v1
  v_add_u32 v100, s81, v100
  v_and_b32 v236, 7, v2
  v_lshrrev_b32 v237, 3, v2
  v_lshlrev_b32 v238, 7, v3
  v_lshl_add_u32 v238, v236, 4, v238
  v_lshlrev_b32 v16, 4, v1
  v_mul_u32_u24 v244, 1280, v236
  s_mul_i32 s21, s20, 320
  v_add_u32 v244, s21, v244
  v_lshrrev_b32 v245, 3, v1
  v_mul_u32_u24 v245, 40, v245
  v_add_u32 v244, v244, v245
  s_lshr_b32 s21, s20, 1
  s_lshl_b32 s21, s21, 14
  s_and_b32 s22, s20, 1
  s_mul_i32 s22, s22, 3072
  s_add_u32 s21, s21, s22
  v_add_u32 v4, s21, v16
  v_mov_b32 v239, 0x4444
  v_mov_b32 v240, 0xeeee
  v_cmp_eq_u32 vcc, 1, v237
  s_nop 1
  v_cndmask_b32 v44, v239, v240, vcc
  v_cmp_gt_u32 vcc, 2, v3
  s_nop 1
  v_cndmask_b32 v89, 0, 1.0, vcc
  v_lshrrev_b32 v239, 2, v2
  v_mul_u32_u24 v239, 272, v239
  v_lshl_add_u32 v239, v3, 6, v239
  v_and_b32 v240, 3, v2
  v_lshl_add_u32 v239, v240, 2, v239
  s_mul_i32 s21, s20, 5440
  v_add_u32 v5, s21, v239
  v_mul_u32_u24 v239, 272, v3
  v_lshl_add_u32 v6, v2, 4, v239
  v_lshl_add_u32 v239, v236, 4, v239
  v_mul_u32_u24 v240, 10880, v237
  v_add_u32 v45, v239, v240
  s_lshl_b32 s21, s50, 4
  s_add_u32 s21, s21, s51
  s_lshl_b32 s21, s21, 9
  s_lshl_b32 s22, s20, 7
  s_add_u32 s21, s21, s22
  s_add_u32 s21, s21, 81920
  v_and_b32 v239, 1, v3
  v_lshlrev_b32 v239, 8, v239
  v_lshl_add_u32 v239, v236, 4, v239
  v_lshrrev_b32 v240, 1, v3
  v_lshl_add_u32 v239, v240, 3, v239
  v_add_u32 v7, s21, v239
  s_lshl_b32 s22, s58, 9
  s_lshl_b32 s23, s56, 7
  s_add_u32 s22, s22, s23
  s_add_u32 s22, s22, 376704
  v_lshlrev_b32 v239, 6, v3
  v_lshl_add_u32 v239, v236, 3, v239
  v_add_u32 v239, s22, v239
  s_cmp_eq_u32 s20, 2
  s_cselect_b64 vcc, -1, 0
  v_cndmask_b32 v7, v7, v239, vcc
  s_lshl_b32 s21, s59, 11
  s_add_u32 s21, s21, 81920
  v_add_u32 v8, s21, v16
  s_lshl_b32 s21, s59, 9
  s_add_u32 s21, s21, 376832
  v_lshl_add_u32 v9, v1, 3, s21
  s_mul_i32 s21, s59, 3072
  s_add_u32 s21, s21, 278528
  v_and_b32 v239, 0x39, v1
  v_bfe_u32 v240, v1, 1, 1
  v_lshl_or_b32 v239, v240, 2, v239
  v_bfe_u32 v240, v1, 2, 1
  v_lshl_or_b32 v239, v240, 1, v239
  v_lshl_add_u32 v10, v239, 4, s21
  s_cmp_eq_u32 s20, 3
  s_cselect_b32 s22, s84, s56
  s_mul_i32 s22, s22, 12
  v_mul_u32_u24 v239, 3, v3
  v_add_u32 v239, s22, v239
  v_add_u32 v240, 0, v239
  v_lshrrev_b32 v241, 1, v240
  v_and_b32 v240, 1, v240
  v_lshlrev_b32 v240, 3, v240
  v_lshl_add_u32 v242, v241, 7, v240
  v_lshl_add_u32 v242, v236, 4, v242
  s_mul_i32 s21, s58, 3072
  v_add_u32 v21, s21, v242
  v_lshl_add_u32 v242, v241, 8, v240
  v_lshl_add_u32 v242, v2, 4, v242
  s_mul_i32 s21, s58, 12288
  s_and_b32 s22, s20, 1
  s_mul_i32 s22, s22, 6144
  s_add_u32 s21, s21, s22
  v_add_u32 v18, s21, v242
  v_add_u32 v240, 1, v239
  v_lshrrev_b32 v241, 1, v240
  v_and_b32 v240, 1, v240
  v_lshlrev_b32 v240, 3, v240
  v_lshl_add_u32 v242, v241, 7, v240
  v_lshl_add_u32 v242, v236, 4, v242
  s_mul_i32 s21, s58, 3072
  v_add_u32 v22, s21, v242
  v_lshl_add_u32 v242, v241, 8, v240
  v_lshl_add_u32 v242, v2, 4, v242
  s_mul_i32 s21, s58, 12288
  s_and_b32 s22, s20, 1
  s_mul_i32 s22, s22, 6144
  s_add_u32 s21, s21, s22
  v_add_u32 v19, s21, v242
  v_add_u32 v240, 2, v239
  v_lshrrev_b32 v241, 1, v240
  v_and_b32 v240, 1, v240
  v_lshlrev_b32 v240, 3, v240
  v_lshl_add_u32 v242, v241, 7, v240
  v_lshl_add_u32 v242, v236, 4, v242
  s_mul_i32 s21, s58, 3072
  v_add_u32 v23, s21, v242
  v_lshl_add_u32 v242, v241, 8, v240
  v_lshl_add_u32 v242, v2, 4, v242
  s_mul_i32 s21, s58, 12288
  s_and_b32 s22, s20, 1
  s_mul_i32 s22, s22, 6144
  s_add_u32 s21, s21, s22
  v_add_u32 v20, s21, v242
  v_cmp_eq_u32 vcc, 1, v237
  s_nop 1
  v_cndmask_b32 v25, v21, v22, vcc
  v_add_u32 v24, 278528, v25
  s_mul_i32 s21, s20, 3072
  s_add_u32 s21, s21, 22528
  v_add_u32 v11, s21, v16
  v_and_b32 v239, 3, v1
  s_mul_i32 s21, s20, 3
  v_add_u32 v240, s21, v239
  v_cmp_eq_u32 vcc, 3, v239
  v_lshrrev_b32 v241, 5, v1
  v_mul_u32_u24 v241, 10, v241
  v_cndmask_b32 v240, v240, 9, vcc
  s_lshl_b32 s21, s79, 2
  v_add3_u32 v240, v240, v241, s21
  v_lshrrev_b32 v241, 1, v240
  v_lshlrev_b32 v241, 8, v241
  v_and_b32 v240, 1, v240
  v_lshl_add_u32 v241, v240, 3, v241
  v_bfe_u32 v240, v1, 2, 3
  v_lshl_add_u32 v241, v240, 4, v241
  v_add_u32 v12, 22528, v241
  s_mov_b32 s21, 0x07060100
  s_cmp_eq_u32 s20, 1
  s_cselect_b32 s21, 0x07060302, s21
  s_cmp_eq_u32 s20, 2
  s_cselect_b32 s21, 0x07060c0c, s21
  v_mov_b32 v240, s21
  v_mov_b32 v241, 0x03020100
  v_cndmask_b32 v14, v241, v240, vcc
  s_lshr_b32 s21, s85, 3
  s_lshl_b32 s21, s21, 14
  s_bfe_u32 s22, s85, 0x10002
  s_mul_i32 s22, s22, 3072
  s_add_u32 s21, s21, s22
  s_and_b32 s22, s85, 3
  s_lshl_b32 s22, s22, 8
  s_add_u32 s21, s21, s22
  s_lshl_b32 s22, s20, 10
  s_add_u32 s22, s22, s21
  v_lshl_add_u32 v13, v1, 2, s22
  v_lshlrev_b32 v240, 10, v3
  v_lshl_add_u32 v240, v2, 4, v240
  v_add_u32 v240, s21, v240
  s_cmp_eq_u32 s20, 3
  s_cselect_b64 vcc, -1, 0
  v_cndmask_b32 v13, v13, v240, vcc
  s_mov_b32 s91, 0x3c000000
  v_mov_b32 v243, 0
  s_mul_i32 s89, s59, 12288
  s_add_u32 s89, s89, 25165824
  v_cmp_gt_u32 s[60:61], 8, v2
  v_cmp_le_u32 s[62:63], 8, v2
  v_cmp_le_u32 s[72:73], 2, v3
  v_cmp_gt_u32 s[70:71], 48, v1
  s_nop 1
  s_and_b64 s[64:65], s[60:61], s[72:73]
  s_cmp_eq_u32 s20, 2
  s_cselect_b64 s[74:75], s[64:65], s[60:61]
  s_mul_i32 s89, s59, 12288
  s_add_u32 s89, s89, 25165824
  s_not_b64 s[48:49], s[72:73]
  v_mov_b32 v27, 10923
  v_mov_b32 v49, v100
  v_add_u32 v113, 576, v1
  v_mul_u32_u24 v103, v113, v27
  v_lshrrev_b32 v103, 16, v103
  v_mul_u32_u24 v102, 6, v103
  v_sub_u32 v113, v113, v102
  v_bfe_u32 v102, v103, 1, 1
  v_lshlrev_b32 v102, 3, v102
  v_and_b32 v127, 12, v103
  v_lshrrev_b32 v127, 1, v127
  v_and_b32 v103, 0xfffffff1, v103
  v_or3_b32 v103, v103, v102, v127
  v_mul_u32_u24 v102, 1366, v103
  v_lshrrev_b32 v102, 16, v102
  v_mul_u32_u24 v100, 48, v102
  v_sub_u32 v103, v103, v100
  v_mul_u32_u24 v101, 5462, v103
  v_lshrrev_b32 v101, 16, v101
  v_mul_u32_u24 v126, 12, v101
  v_sub_u32 v103, v103, v126
  v_lshrrev_b32 v126, 2, v103
  v_and_b32 v103, 3, v103
  v_lshl_add_u32 v100, v126, 4, v100
  v_lshl_add_u32 v100, v101, 2, v100
  v_add_u32 v100, v100, v103
  v_mul_u32_u24 v100, 1280, v100
  v_lshl_add_u32 v113, v113, 4, v100
  v_add_u32 v114, 640, v1
  v_mul_u32_u24 v103, v114, v27
  v_lshrrev_b32 v103, 16, v103
  v_mul_u32_u24 v102, 6, v103
  v_sub_u32 v114, v114, v102
  v_bfe_u32 v102, v103, 1, 1
  v_lshlrev_b32 v102, 3, v102
  v_and_b32 v127, 12, v103
  v_lshrrev_b32 v127, 1, v127
  v_and_b32 v103, 0xfffffff1, v103
  v_or3_b32 v103, v103, v102, v127
  v_mul_u32_u24 v102, 1366, v103
  v_lshrrev_b32 v102, 16, v102
  v_mul_u32_u24 v100, 48, v102
  v_sub_u32 v103, v103, v100
  v_mul_u32_u24 v101, 5462, v103
  v_lshrrev_b32 v101, 16, v101
  v_mul_u32_u24 v126, 12, v101
  v_sub_u32 v103, v103, v126
  v_lshrrev_b32 v126, 2, v103
  v_and_b32 v103, 3, v103
  v_lshl_add_u32 v100, v126, 4, v100
  v_lshl_add_u32 v100, v101, 2, v100
  v_add_u32 v100, v100, v103
  v_mul_u32_u24 v100, 1280, v100
  v_lshl_add_u32 v114, v114, 4, v100
  v_add_u32 v115, 704, v1
  v_mul_u32_u24 v103, v115, v27
  v_lshrrev_b32 v103, 16, v103
  v_mul_u32_u24 v102, 6, v103
  v_sub_u32 v115, v115, v102
  v_bfe_u32 v102, v103, 1, 1
  v_lshlrev_b32 v102, 3, v102
  v_and_b32 v127, 12, v103
  v_lshrrev_b32 v127, 1, v127
  v_and_b32 v103, 0xfffffff1, v103
  v_or3_b32 v103, v103, v102, v127
  v_mul_u32_u24 v102, 1366, v103
  v_lshrrev_b32 v102, 16, v102
  v_mul_u32_u24 v100, 48, v102
  v_sub_u32 v103, v103, v100
  v_mul_u32_u24 v101, 5462, v103
  v_lshrrev_b32 v101, 16, v101
  v_mul_u32_u24 v126, 12, v101
  v_sub_u32 v103, v103, v126
  v_lshrrev_b32 v126, 2, v103
  v_and_b32 v103, 3, v103
  v_lshl_add_u32 v100, v126, 4, v100
  v_lshl_add_u32 v100, v101, 2, v100
  v_add_u32 v100, v100, v103
  v_mul_u32_u24 v100, 1280, v100
  v_lshl_add_u32 v115, v115, 4, v100
  v_add_u32 v116, 768, v1
  v_mul_u32_u24 v103, v116, v27
  v_lshrrev_b32 v103, 16, v103
  v_mul_u32_u24 v102, 6, v103
  v_sub_u32 v116, v116, v102
  v_bfe_u32 v102, v103, 1, 1
  v_lshlrev_b32 v102, 3, v102
  v_and_b32 v127, 12, v103
  v_lshrrev_b32 v127, 1, v127
  v_and_b32 v103, 0xfffffff1, v103
  v_or3_b32 v103, v103, v102, v127
  v_mul_u32_u24 v102, 1366, v103
  v_lshrrev_b32 v102, 16, v102
  v_mul_u32_u24 v100, 48, v102
  v_sub_u32 v103, v103, v100
  v_mul_u32_u24 v101, 5462, v103
  v_lshrrev_b32 v101, 16, v101
  v_mul_u32_u24 v126, 12, v101
  v_sub_u32 v103, v103, v126
  v_lshrrev_b32 v126, 2, v103
  v_and_b32 v103, 3, v103
  v_lshl_add_u32 v100, v126, 4, v100
  v_lshl_add_u32 v100, v101, 2, v100
  v_add_u32 v100, v100, v103
  v_mul_u32_u24 v100, 1280, v100
  v_lshl_add_u32 v116, v116, 4, v100
  v_add_u32 v117, 832, v1
  v_mul_u32_u24 v103, v117, v27
  v_lshrrev_b32 v103, 16, v103
  v_mul_u32_u24 v102, 6, v103
  v_sub_u32 v117, v117, v102
  v_bfe_u32 v102, v103, 1, 1
  v_lshlrev_b32 v102, 3, v102
  v_and_b32 v127, 12, v103
  v_lshrrev_b32 v127, 1, v127
  v_and_b32 v103, 0xfffffff1, v103
  v_or3_b32 v103, v103, v102, v127
  v_mul_u32_u24 v102, 1366, v103
  v_lshrrev_b32 v102, 16, v102
  v_mul_u32_u24 v100, 48, v102
  v_sub_u32 v103, v103, v100
  v_mul_u32_u24 v101, 5462, v103
  v_lshrrev_b32 v101, 16, v101
  v_mul_u32_u24 v126, 12, v101
  v_sub_u32 v103, v103, v126
  v_lshrrev_b32 v126, 2, v103
  v_and_b32 v103, 3, v103
  v_lshl_add_u32 v100, v126, 4, v100
  v_lshl_add_u32 v100, v101, 2, v100
  v_add_u32 v100, v100, v103
  v_mul_u32_u24 v100, 1280, v100
  v_lshl_add_u32 v117, v117, 4, v100
  v_add_u32 v118, 896, v1
  v_mul_u32_u24 v103, v118, v27
  v_lshrrev_b32 v103, 16, v103
  v_mul_u32_u24 v102, 6, v103
  v_sub_u32 v118, v118, v102
  v_bfe_u32 v102, v103, 1, 1
  v_lshlrev_b32 v102, 3, v102
  v_and_b32 v127, 12, v103
  v_lshrrev_b32 v127, 1, v127
  v_and_b32 v103, 0xfffffff1, v103
  v_or3_b32 v103, v103, v102, v127
  v_mul_u32_u24 v102, 1366, v103
  v_lshrrev_b32 v102, 16, v102
  v_mul_u32_u24 v100, 48, v102
  v_sub_u32 v103, v103, v100
  v_mul_u32_u24 v101, 5462, v103
  v_lshrrev_b32 v101, 16, v101
  v_mul_u32_u24 v126, 12, v101
  v_sub_u32 v103, v103, v126
  v_lshrrev_b32 v126, 2, v103
  v_and_b32 v103, 3, v103
  v_lshl_add_u32 v100, v126, 4, v100
  v_lshl_add_u32 v100, v101, 2, v100
  v_add_u32 v100, v100, v103
  v_mul_u32_u24 v100, 1280, v100
  v_lshl_add_u32 v118, v118, 4, v100
  v_add_u32 v119, 960, v1
  v_mul_u32_u24 v103, v119, v27
  v_lshrrev_b32 v103, 16, v103
  v_mul_u32_u24 v102, 6, v103
  v_sub_u32 v119, v119, v102
  v_bfe_u32 v102, v103, 1, 1
  v_lshlrev_b32 v102, 3, v102
  v_and_b32 v127, 12, v103
  v_lshrrev_b32 v127, 1, v127
  v_and_b32 v103, 0xfffffff1, v103
  v_or3_b32 v103, v103, v102, v127
  v_mul_u32_u24 v102, 1366, v103
  v_lshrrev_b32 v102, 16, v102
  v_mul_u32_u24 v100, 48, v102
  v_sub_u32 v103, v103, v100
  v_mul_u32_u24 v101, 5462, v103
  v_lshrrev_b32 v101, 16, v101
  v_mul_u32_u24 v126, 12, v101
  v_sub_u32 v103, v103, v126
  v_lshrrev_b32 v126, 2, v103
  v_and_b32 v103, 3, v103
  v_lshl_add_u32 v100, v126, 4, v100
  v_lshl_add_u32 v100, v101, 2, v100
  v_add_u32 v100, v100, v103
  v_mul_u32_u24 v100, 1280, v100
  v_lshl_add_u32 v119, v119, 4, v100
  v_add_u32 v120, 1024, v1
  v_mul_u32_u24 v103, v120, v27
  v_lshrrev_b32 v103, 16, v103
  v_mul_u32_u24 v102, 6, v103
  v_sub_u32 v120, v120, v102
  v_bfe_u32 v102, v103, 1, 1
  v_lshlrev_b32 v102, 3, v102
  v_and_b32 v127, 12, v103
  v_lshrrev_b32 v127, 1, v127
  v_and_b32 v103, 0xfffffff1, v103
  v_or3_b32 v103, v103, v102, v127
  v_mul_u32_u24 v102, 1366, v103
  v_lshrrev_b32 v102, 16, v102
  v_mul_u32_u24 v100, 48, v102
  v_sub_u32 v103, v103, v100
  v_mul_u32_u24 v101, 5462, v103
  v_lshrrev_b32 v101, 16, v101
  v_mul_u32_u24 v126, 12, v101
  v_sub_u32 v103, v103, v126
  v_lshrrev_b32 v126, 2, v103
  v_and_b32 v103, 3, v103
  v_lshl_add_u32 v100, v126, 4, v100
  v_lshl_add_u32 v100, v101, 2, v100
  v_add_u32 v100, v100, v103
  v_mul_u32_u24 v100, 1280, v100
  v_lshl_add_u32 v120, v120, 4, v100
  v_add_u32 v121, 1088, v1
  v_mul_u32_u24 v103, v121, v27
  v_lshrrev_b32 v103, 16, v103
  v_mul_u32_u24 v102, 6, v103
  v_sub_u32 v121, v121, v102
  v_bfe_u32 v102, v103, 1, 1
  v_lshlrev_b32 v102, 3, v102
  v_and_b32 v127, 12, v103
  v_lshrrev_b32 v127, 1, v127
  v_and_b32 v103, 0xfffffff1, v103
  v_or3_b32 v103, v103, v102, v127
  v_mul_u32_u24 v102, 1366, v103
  v_lshrrev_b32 v102, 16, v102
  v_mul_u32_u24 v100, 48, v102
  v_sub_u32 v103, v103, v100
  v_mul_u32_u24 v101, 5462, v103
  v_lshrrev_b32 v101, 16, v101
  v_mul_u32_u24 v126, 12, v101
  v_sub_u32 v103, v103, v126
  v_lshrrev_b32 v126, 2, v103
  v_and_b32 v103, 3, v103
  v_lshl_add_u32 v100, v126, 4, v100
  v_lshl_add_u32 v100, v101, 2, v100
  v_add_u32 v100, v100, v103
  v_mul_u32_u24 v100, 1280, v100
  v_lshl_add_u32 v121, v121, 4, v100
  s_waitcnt vmcnt(63)
  s_mov_b32 s12, s42
  s_mov_b32 s13, s43
  s_mov_b32 s14, 7864320
  s_mov_b32 s15, 0x00020000
  buffer_load_dwordx4 v[188:191], v113, s[12:15], s82 offen
  buffer_load_dwordx4 v[192:195], v114, s[12:15], s82 offen
  buffer_load_dwordx4 v[196:199], v115, s[12:15], s82 offen
  buffer_load_dwordx4 v[200:203], v116, s[12:15], s82 offen
  buffer_load_dwordx4 v[204:207], v117, s[12:15], s82 offen
  buffer_load_dwordx4 v[208:211], v118, s[12:15], s82 offen
  buffer_load_dwordx4 v[212:215], v119, s[12:15], s82 offen
  buffer_load_dwordx4 v[216:219], v120, s[12:15], s82 offen
  buffer_load_dwordx4 v[220:223], v121, s[12:15], s82 offen
  v_add_u32 v104, 0, v1
  v_mul_u32_u24 v103, v104, v27
  v_lshrrev_b32 v103, 16, v103
  v_mul_u32_u24 v102, 6, v103
  v_sub_u32 v104, v104, v102
  v_bfe_u32 v102, v103, 1, 1
  v_lshlrev_b32 v102, 3, v102
  v_and_b32 v127, 12, v103
  v_lshrrev_b32 v127, 1, v127
  v_and_b32 v103, 0xfffffff1, v103
  v_or3_b32 v103, v103, v102, v127
  v_mul_u32_u24 v102, 1366, v103
  v_lshrrev_b32 v102, 16, v102
  v_mul_u32_u24 v100, 48, v102
  v_sub_u32 v103, v103, v100
  v_mul_u32_u24 v101, 5462, v103
  v_lshrrev_b32 v101, 16, v101
  v_mul_u32_u24 v126, 12, v101
  v_sub_u32 v103, v103, v126
  v_lshrrev_b32 v126, 2, v103
  v_and_b32 v103, 3, v103
  v_lshl_add_u32 v100, v126, 4, v100
  v_lshl_add_u32 v100, v101, 2, v100
  v_add_u32 v100, v100, v103
  v_mul_u32_u24 v100, 1280, v100
  v_lshl_add_u32 v104, v104, 4, v100
  v_add_u32 v105, 64, v1
  v_mul_u32_u24 v103, v105, v27
  v_lshrrev_b32 v103, 16, v103
  v_mul_u32_u24 v102, 6, v103
  v_sub_u32 v105, v105, v102
  v_bfe_u32 v102, v103, 1, 1
  v_lshlrev_b32 v102, 3, v102
  v_and_b32 v127, 12, v103
  v_lshrrev_b32 v127, 1, v127
  v_and_b32 v103, 0xfffffff1, v103
  v_or3_b32 v103, v103, v102, v127
  v_mul_u32_u24 v102, 1366, v103
  v_lshrrev_b32 v102, 16, v102
  v_mul_u32_u24 v100, 48, v102
  v_sub_u32 v103, v103, v100
  v_mul_u32_u24 v101, 5462, v103
  v_lshrrev_b32 v101, 16, v101
  v_mul_u32_u24 v126, 12, v101
  v_sub_u32 v103, v103, v126
  v_lshrrev_b32 v126, 2, v103
  v_and_b32 v103, 3, v103
  v_lshl_add_u32 v100, v126, 4, v100
  v_lshl_add_u32 v100, v101, 2, v100
  v_add_u32 v100, v100, v103
  v_mul_u32_u24 v100, 1280, v100
  v_lshl_add_u32 v105, v105, 4, v100
  v_add_u32 v106, 128, v1
  v_mul_u32_u24 v103, v106, v27
  v_lshrrev_b32 v103, 16, v103
  v_mul_u32_u24 v102, 6, v103
  v_sub_u32 v106, v106, v102
  v_bfe_u32 v102, v103, 1, 1
  v_lshlrev_b32 v102, 3, v102
  v_and_b32 v127, 12, v103
  v_lshrrev_b32 v127, 1, v127
  v_and_b32 v103, 0xfffffff1, v103
  v_or3_b32 v103, v103, v102, v127
  v_mul_u32_u24 v102, 1366, v103
  v_lshrrev_b32 v102, 16, v102
  v_mul_u32_u24 v100, 48, v102
  v_sub_u32 v103, v103, v100
  v_mul_u32_u24 v101, 5462, v103
  v_lshrrev_b32 v101, 16, v101
  v_mul_u32_u24 v126, 12, v101
  v_sub_u32 v103, v103, v126
  v_lshrrev_b32 v126, 2, v103
  v_and_b32 v103, 3, v103
  v_lshl_add_u32 v100, v126, 4, v100
  v_lshl_add_u32 v100, v101, 2, v100
  v_add_u32 v100, v100, v103
  v_mul_u32_u24 v100, 1280, v100
  v_lshl_add_u32 v106, v106, 4, v100
  v_add_u32 v107, 192, v1
  v_mul_u32_u24 v103, v107, v27
  v_lshrrev_b32 v103, 16, v103
  v_mul_u32_u24 v102, 6, v103
  v_sub_u32 v107, v107, v102
  v_bfe_u32 v102, v103, 1, 1
  v_lshlrev_b32 v102, 3, v102
  v_and_b32 v127, 12, v103
  v_lshrrev_b32 v127, 1, v127
  v_and_b32 v103, 0xfffffff1, v103
  v_or3_b32 v103, v103, v102, v127
  v_mul_u32_u24 v102, 1366, v103
  v_lshrrev_b32 v102, 16, v102
  v_mul_u32_u24 v100, 48, v102
  v_sub_u32 v103, v103, v100
  v_mul_u32_u24 v101, 5462, v103
  v_lshrrev_b32 v101, 16, v101
  v_mul_u32_u24 v126, 12, v101
  v_sub_u32 v103, v103, v126
  v_lshrrev_b32 v126, 2, v103
  v_and_b32 v103, 3, v103
  v_lshl_add_u32 v100, v126, 4, v100
  v_lshl_add_u32 v100, v101, 2, v100
  v_add_u32 v100, v100, v103
  v_mul_u32_u24 v100, 1280, v100
  v_lshl_add_u32 v107, v107, 4, v100
  v_add_u32 v108, 256, v1
  v_mul_u32_u24 v103, v108, v27
  v_lshrrev_b32 v103, 16, v103
  v_mul_u32_u24 v102, 6, v103
  v_sub_u32 v108, v108, v102
  v_bfe_u32 v102, v103, 1, 1
  v_lshlrev_b32 v102, 3, v102
  v_and_b32 v127, 12, v103
  v_lshrrev_b32 v127, 1, v127
  v_and_b32 v103, 0xfffffff1, v103
  v_or3_b32 v103, v103, v102, v127
  v_mul_u32_u24 v102, 1366, v103
  v_lshrrev_b32 v102, 16, v102
  v_mul_u32_u24 v100, 48, v102
  v_sub_u32 v103, v103, v100
  v_mul_u32_u24 v101, 5462, v103
  v_lshrrev_b32 v101, 16, v101
  v_mul_u32_u24 v126, 12, v101
  v_sub_u32 v103, v103, v126
  v_lshrrev_b32 v126, 2, v103
  v_and_b32 v103, 3, v103
  v_lshl_add_u32 v100, v126, 4, v100
  v_lshl_add_u32 v100, v101, 2, v100
  v_add_u32 v100, v100, v103
  v_mul_u32_u24 v100, 1280, v100
  v_lshl_add_u32 v108, v108, 4, v100
  v_add_u32 v109, 320, v1
  v_mul_u32_u24 v103, v109, v27
  v_lshrrev_b32 v103, 16, v103
  v_mul_u32_u24 v102, 6, v103
  v_sub_u32 v109, v109, v102
  v_bfe_u32 v102, v103, 1, 1
  v_lshlrev_b32 v102, 3, v102
  v_and_b32 v127, 12, v103
  v_lshrrev_b32 v127, 1, v127
  v_and_b32 v103, 0xfffffff1, v103
  v_or3_b32 v103, v103, v102, v127
  v_mul_u32_u24 v102, 1366, v103
  v_lshrrev_b32 v102, 16, v102
  v_mul_u32_u24 v100, 48, v102
  v_sub_u32 v103, v103, v100
  v_mul_u32_u24 v101, 5462, v103
  v_lshrrev_b32 v101, 16, v101
  v_mul_u32_u24 v126, 12, v101
  v_sub_u32 v103, v103, v126
  v_lshrrev_b32 v126, 2, v103
  v_and_b32 v103, 3, v103
  v_lshl_add_u32 v100, v126, 4, v100
  v_lshl_add_u32 v100, v101, 2, v100
  v_add_u32 v100, v100, v103
  v_mul_u32_u24 v100, 1280, v100
  v_lshl_add_u32 v109, v109, 4, v100
  v_add_u32 v110, 384, v1
  v_mul_u32_u24 v103, v110, v27
  v_lshrrev_b32 v103, 16, v103
  v_mul_u32_u24 v102, 6, v103
  v_sub_u32 v110, v110, v102
  v_bfe_u32 v102, v103, 1, 1
  v_lshlrev_b32 v102, 3, v102
  v_and_b32 v127, 12, v103
  v_lshrrev_b32 v127, 1, v127
  v_and_b32 v103, 0xfffffff1, v103
  v_or3_b32 v103, v103, v102, v127
  v_mul_u32_u24 v102, 1366, v103
  v_lshrrev_b32 v102, 16, v102
  v_mul_u32_u24 v100, 48, v102
  v_sub_u32 v103, v103, v100
  v_mul_u32_u24 v101, 5462, v103
  v_lshrrev_b32 v101, 16, v101
  v_mul_u32_u24 v126, 12, v101
  v_sub_u32 v103, v103, v126
  v_lshrrev_b32 v126, 2, v103
  v_and_b32 v103, 3, v103
  v_lshl_add_u32 v100, v126, 4, v100
  v_lshl_add_u32 v100, v101, 2, v100
  v_add_u32 v100, v100, v103
  v_mul_u32_u24 v100, 1280, v100
  v_lshl_add_u32 v110, v110, 4, v100
  v_add_u32 v111, 448, v1
  v_mul_u32_u24 v103, v111, v27
  v_lshrrev_b32 v103, 16, v103
  v_mul_u32_u24 v102, 6, v103
  v_sub_u32 v111, v111, v102
  v_bfe_u32 v102, v103, 1, 1
  v_lshlrev_b32 v102, 3, v102
  v_and_b32 v127, 12, v103
  v_lshrrev_b32 v127, 1, v127
  v_and_b32 v103, 0xfffffff1, v103
  v_or3_b32 v103, v103, v102, v127
  v_mul_u32_u24 v102, 1366, v103
  v_lshrrev_b32 v102, 16, v102
  v_mul_u32_u24 v100, 48, v102
  v_sub_u32 v103, v103, v100
  v_mul_u32_u24 v101, 5462, v103
  v_lshrrev_b32 v101, 16, v101
  v_mul_u32_u24 v126, 12, v101
  v_sub_u32 v103, v103, v126
  v_lshrrev_b32 v126, 2, v103
  v_and_b32 v103, 3, v103
  v_lshl_add_u32 v100, v126, 4, v100
  v_lshl_add_u32 v100, v101, 2, v100
  v_add_u32 v100, v100, v103
  v_mul_u32_u24 v100, 1280, v100
  v_lshl_add_u32 v111, v111, 4, v100
  v_add_u32 v112, 512, v1
  v_mul_u32_u24 v103, v112, v27
  v_lshrrev_b32 v103, 16, v103
  v_mul_u32_u24 v102, 6, v103
  v_sub_u32 v112, v112, v102
  v_bfe_u32 v102, v103, 1, 1
  v_lshlrev_b32 v102, 3, v102
  v_and_b32 v127, 12, v103
  v_lshrrev_b32 v127, 1, v127
  v_and_b32 v103, 0xfffffff1, v103
  v_or3_b32 v103, v103, v102, v127
  v_mul_u32_u24 v102, 1366, v103
  v_lshrrev_b32 v102, 16, v102
  v_mul_u32_u24 v100, 48, v102
  v_sub_u32 v103, v103, v100
  v_mul_u32_u24 v101, 5462, v103
  v_lshrrev_b32 v101, 16, v101
  v_mul_u32_u24 v126, 12, v101
  v_sub_u32 v103, v103, v126
  v_lshrrev_b32 v126, 2, v103
  v_and_b32 v103, 3, v103
  v_lshl_add_u32 v100, v126, 4, v100
  v_lshl_add_u32 v100, v101, 2, v100
  v_add_u32 v100, v100, v103
  v_mul_u32_u24 v100, 1280, v100
  v_lshl_add_u32 v112, v112, 4, v100
  s_waitcnt vmcnt(63)
  s_mov_b32 s12, s42
  s_mov_b32 s13, s43
  s_mov_b32 s14, 7864320
  s_mov_b32 s15, 0x00020000
  s_add_u32 m0, s81, 30720
  s_nop 0
  buffer_load_dwordx4 v104, s[12:15], s82 offen lds
  s_add_u32 m0, s81, 31744
  s_nop 0
  buffer_load_dwordx4 v105, s[12:15], s82 offen lds
  s_add_u32 m0, s81, 32768
  s_nop 0
  buffer_load_dwordx4 v106, s[12:15], s82 offen lds
  s_add_u32 m0, s81, 33792
  s_nop 0
  buffer_load_dwordx4 v107, s[12:15], s82 offen lds
  s_add_u32 m0, s81, 34816
  s_nop 0
  buffer_load_dwordx4 v108, s[12:15], s82 offen lds
  s_add_u32 m0, s81, 35840
  s_nop 0
  buffer_load_dwordx4 v109, s[12:15], s82 offen lds
  s_add_u32 m0, s81, 36864
  s_nop 0
  buffer_load_dwordx4 v110, s[12:15], s82 offen lds
  s_add_u32 m0, s81, 37888
  s_nop 0
  buffer_load_dwordx4 v111, s[12:15], s82 offen lds
  s_add_u32 m0, s81, 38912
  s_nop 0
  buffer_load_dwordx4 v112, s[12:15], s82 offen lds
  s_waitcnt vmcnt(63)
  s_mov_b32 s12, s36
  s_mov_b32 s13, s37
  s_mov_b32 s14, 7864320
  s_mov_b32 s15, 0x00020000
  s_add_u32 s21, s80, 0
  s_add_u32 s22, s81, 15360
  s_add_u32 m0, s22, 0
  s_nop 0
  buffer_load_dwordx4 v96, s[12:15], s21 offen lds
  s_add_u32 m0, s22, 1024
  s_nop 0
  buffer_load_dwordx4 v97, s[12:15], s21 offen lds
  s_add_u32 m0, s22, 2048
  s_nop 0
  buffer_load_dwordx4 v98, s[12:15], s21 offen lds
  s_waitcnt vmcnt(63)
  s_mov_b32 s12, s36
  s_mov_b32 s13, s37
  s_mov_b32 s14, 7864320
  s_mov_b32 s15, 0x00020000
  s_add_u32 s21, s80, 983040
  s_add_u32 s22, s81, 18432
  s_add_u32 m0, s22, 0
  s_nop 0
  buffer_load_dwordx4 v96, s[12:15], s21 offen lds
  s_add_u32 m0, s22, 1024
  s_nop 0
  buffer_load_dwordx4 v97, s[12:15], s21 offen lds
  s_add_u32 m0, s22, 2048
  s_nop 0
  buffer_load_dwordx4 v98, s[12:15], s21 offen lds
  s_waitcnt vmcnt(63)
  s_mov_b32 s12, s36
  s_mov_b32 s13, s37
  s_mov_b32 s14, 7864320
  s_mov_b32 s15, 0x00020000
  s_add_u32 s21, s80, 98304
  s_add_u32 s22, s81, 21504
  s_add_u32 m0, s22, 0
  s_nop 0
  buffer_load_dwordx4 v96, s[12:15], s21 offen lds
  s_add_u32 m0, s22, 1024
  s_nop 0
  buffer_load_dwordx4 v97, s[12:15], s21 offen lds
  s_add_u32 m0, s22, 2048
  s_nop 0
  buffer_load_dwordx4 v98, s[12:15], s21 offen lds
  s_waitcnt vmcnt(63)
  s_mov_b32 s12, s36
  s_mov_b32 s13, s37
  s_mov_b32 s14, 7864320
  s_mov_b32 s15, 0x00020000
  s_add_u32 s21, s80, 1081344
  s_add_u32 s22, s81, 24576
  s_add_u32 m0, s22, 0
  s_nop 0
  buffer_load_dwordx4 v96, s[12:15], s21 offen lds
  s_add_u32 m0, s22, 1024
  s_nop 0
  buffer_load_dwordx4 v97, s[12:15], s21 offen lds
  s_add_u32 m0, s22, 2048
  s_nop 0
  buffer_load_dwordx4 v98, s[12:15], s21 offen lds
  s_waitcnt vmcnt(63)
  s_mov_b32 s12, s36
  s_mov_b32 s13, s37
  s_mov_b32 s14, 7864320
  s_mov_b32 s15, 0x00020000
  s_add_u32 s21, s80, 196608
  s_add_u32 s22, s81, 27648
  s_add_u32 m0, s22, 0
  s_nop 0
  buffer_load_dwordx4 v46, s[12:15], s21 offen lds
  s_add_u32 m0, s22, 1024
  s_nop 0
  buffer_load_dwordx4 v47, s[12:15], s21 offen lds
  s_add_u32 m0, s22, 2048
  s_nop 0
  buffer_load_dwordx4 v48, s[12:15], s21 offen lds
  buffer_load_dwordx4 v[32:35], v244, s[28:31], 0 offen offset:0
  buffer_load_dwordx4 v[36:39], v244, s[28:31], 0 offen offset:16
  buffer_load_dwordx2 v[40:41], v244, s[28:31], 0 offen offset:32
  v_mov_b32 v100, v49
  v_lshlrev_b32 v239, 2, v1
  s_waitcnt vmcnt(51)
  ds_read_b64_tr_b16 a[60:61], v99 offset:0
  ds_read_b64_tr_b16 a[62:63], v99 offset:384
  ds_read_b64_tr_b16 a[80:81], v99 offset:32
  ds_read_b64_tr_b16 a[82:83], v99 offset:416
  ds_read_b64_tr_b16 a[100:101], v99 offset:64
  ds_read_b64_tr_b16 a[102:103], v99 offset:448
  ds_read_b64_tr_b16 a[64:65], v99 offset:3072
  ds_read_b64_tr_b16 a[66:67], v99 offset:3456
  ds_read_b64_tr_b16 a[84:85], v99 offset:3104
  ds_read_b64_tr_b16 a[86:87], v99 offset:3488
  ds_read_b64_tr_b16 a[104:105], v99 offset:3136
  ds_read_b64_tr_b16 a[106:107], v99 offset:3520
  ds_read_b64_tr_b16 a[68:69], v99 offset:6144
  ds_read_b64_tr_b16 a[70:71], v99 offset:6528
  ds_read_b64_tr_b16 a[88:89], v99 offset:6176
  ds_read_b64_tr_b16 a[90:91], v99 offset:6560
  ds_read_b64_tr_b16 a[108:109], v99 offset:6208
  ds_read_b64_tr_b16 a[110:111], v99 offset:6592
  ds_read_b64_tr_b16 a[72:73], v99 offset:9216
  ds_read_b64_tr_b16 a[74:75], v99 offset:9600
  ds_read_b64_tr_b16 a[92:93], v99 offset:9248
  ds_read_b64_tr_b16 a[94:95], v99 offset:9632
  ds_read_b64_tr_b16 a[112:113], v99 offset:9280
  ds_read_b64_tr_b16 a[114:115], v99 offset:9664
  ds_read_b64_tr_b16 a[76:77], v99 offset:12288
  ds_read_b64_tr_b16 a[78:79], v99 offset:12672
  ds_read_b64_tr_b16 a[96:97], v99 offset:12320
  ds_read_b64_tr_b16 a[98:99], v99 offset:12704
  ds_read_b64_tr_b16 a[116:117], v99 offset:12352
  ds_read_b64_tr_b16 a[118:119], v99 offset:12736
  s_waitcnt lgkmcnt(0)
  s_waitcnt vmcnt(36)
  ds_write_b128 v100, v[128:131] offset:0
  ds_write_b128 v100, v[132:135] offset:1024
  ds_write_b128 v100, v[136:139] offset:2048
  ds_write_b128 v100, v[140:143] offset:3072
  ds_write_b128 v100, v[144:147] offset:4096
  ds_write_b128 v100, v[148:151] offset:5120
  ds_write_b128 v100, v[152:155] offset:6144
  ds_write_b128 v100, v[156:159] offset:7168
  ds_write_b128 v100, v[160:163] offset:8192
  ds_write_b128 v100, v[164:167] offset:9216
  ds_write_b128 v100, v[168:171] offset:10240
  ds_write_b128 v100, v[172:175] offset:11264
  ds_write_b128 v100, v[176:179] offset:12288
  ds_write_b128 v100, v[180:183] offset:13312
  ds_write_b128 v100, v[184:187] offset:14336
  s_waitcnt lgkmcnt(0)
  ds_read_b64_tr_b16 a[120:121], v99 offset:0
  ds_read_b64_tr_b16 a[122:123], v99 offset:384
  ds_read_b64_tr_b16 a[140:141], v99 offset:32
  ds_read_b64_tr_b16 a[142:143], v99 offset:416
  ds_read_b64_tr_b16 a[160:161], v99 offset:64
  ds_read_b64_tr_b16 a[162:163], v99 offset:448
  ds_read_b64_tr_b16 a[124:125], v99 offset:3072
  ds_read_b64_tr_b16 a[126:127], v99 offset:3456
  ds_read_b64_tr_b16 a[144:145], v99 offset:3104
  ds_read_b64_tr_b16 a[146:147], v99 offset:3488
  ds_read_b64_tr_b16 a[164:165], v99 offset:3136
  ds_read_b64_tr_b16 a[166:167], v99 offset:3520
  ds_read_b64_tr_b16 a[128:129], v99 offset:6144
  ds_read_b64_tr_b16 a[130:131], v99 offset:6528
  ds_read_b64_tr_b16 a[148:149], v99 offset:6176
  ds_read_b64_tr_b16 a[150:151], v99 offset:6560
  ds_read_b64_tr_b16 a[168:169], v99 offset:6208
  ds_read_b64_tr_b16 a[170:171], v99 offset:6592
  ds_read_b64_tr_b16 a[132:133], v99 offset:9216
  ds_read_b64_tr_b16 a[134:135], v99 offset:9600
  ds_read_b64_tr_b16 a[152:153], v99 offset:9248
  ds_read_b64_tr_b16 a[154:155], v99 offset:9632
  ds_read_b64_tr_b16 a[172:173], v99 offset:9280
  ds_read_b64_tr_b16 a[174:175], v99 offset:9664
  ds_read_b64_tr_b16 a[136:137], v99 offset:12288
  ds_read_b64_tr_b16 a[138:139], v99 offset:12672
  ds_read_b64_tr_b16 a[156:157], v99 offset:12320
  ds_read_b64_tr_b16 a[158:159], v99 offset:12704
  ds_read_b64_tr_b16 a[176:177], v99 offset:12352
  ds_read_b64_tr_b16 a[178:179], v99 offset:12736
  s_waitcnt lgkmcnt(0)
  s_waitcnt vmcnt(27)
  s_cmp_lg_u32 s20, 0
  s_cbranch_scc1 ic_7
  buffer_load_dword v238, v239, s[32:35], 0 offen sc1
ic_7:
  ds_write_b128 v100, v[188:191] offset:0
  ds_write_b128 v100, v[192:195] offset:1024
  ds_write_b128 v100, v[196:199] offset:2048
  ds_write_b128 v100, v[200:203] offset:3072
  ds_write_b128 v100, v[204:207] offset:4096
  ds_write_b128 v100, v[208:211] offset:5120
  ds_write_b128 v100, v[212:215] offset:6144
  ds_write_b128 v100, v[216:219] offset:7168
  ds_write_b128 v100, v[220:223] offset:8192
  s_waitcnt lgkmcnt(0)
  ds_read_b64_tr_b16 a[192:193], v99 offset:0
  ds_read_b64_tr_b16 a[194:195], v99 offset:384
  ds_read_b64_tr_b16 a[216:217], v99 offset:32
  ds_read_b64_tr_b16 a[218:219], v99 offset:416
  ds_read_b64_tr_b16 a[240:241], v99 offset:64
  ds_read_b64_tr_b16 a[242:243], v99 offset:448
  ds_read_b64_tr_b16 a[196:197], v99 offset:3072
  ds_read_b64_tr_b16 a[198:199], v99 offset:3456
  ds_read_b64_tr_b16 a[220:221], v99 offset:3104
  ds_read_b64_tr_b16 a[222:223], v99 offset:3488
  ds_read_b64_tr_b16 a[244:245], v99 offset:3136
  ds_read_b64_tr_b16 a[246:247], v99 offset:3520
  ds_read_b64_tr_b16 a[200:201], v99 offset:6144
  ds_read_b64_tr_b16 a[202:203], v99 offset:6528
  ds_read_b64_tr_b16 a[224:225], v99 offset:6176
  ds_read_b64_tr_b16 a[226:227], v99 offset:6560
  ds_read_b64_tr_b16 a[248:249], v99 offset:6208
  ds_read_b64_tr_b16 a[250:251], v99 offset:6592
  s_waitcnt lgkmcnt(0)
  s_waitcnt vmcnt(18)
  ds_read_b64_tr_b16 a[180:181], v99 offset:30720
  ds_read_b64_tr_b16 a[182:183], v99 offset:31104
  ds_read_b64_tr_b16 a[204:205], v99 offset:30752
  ds_read_b64_tr_b16 a[206:207], v99 offset:31136
  ds_read_b64_tr_b16 a[228:229], v99 offset:30784
  ds_read_b64_tr_b16 a[230:231], v99 offset:31168
  ds_read_b64_tr_b16 a[184:185], v99 offset:33792
  ds_read_b64_tr_b16 a[186:187], v99 offset:34176
  ds_read_b64_tr_b16 a[208:209], v99 offset:33824
  ds_read_b64_tr_b16 a[210:211], v99 offset:34208
  ds_read_b64_tr_b16 a[232:233], v99 offset:33856
  ds_read_b64_tr_b16 a[234:235], v99 offset:34240
  ds_read_b64_tr_b16 a[188:189], v99 offset:36864
  ds_read_b64_tr_b16 a[190:191], v99 offset:37248
  ds_read_b64_tr_b16 a[212:213], v99 offset:36896
  ds_read_b64_tr_b16 a[214:215], v99 offset:37280
  ds_read_b64_tr_b16 a[236:237], v99 offset:36928
  ds_read_b64_tr_b16 a[238:239], v99 offset:37312
  s_waitcnt lgkmcnt(0)
  s_waitcnt vmcnt(3)
  ds_read_b64_tr_b16 a[0:1], v99 offset:15360
  ds_read_b64_tr_b16 a[2:3], v99 offset:15744
  ds_read_b64_tr_b16 a[20:21], v99 offset:15392
  ds_read_b64_tr_b16 a[22:23], v99 offset:15776
  ds_read_b64_tr_b16 a[40:41], v99 offset:15424
  ds_read_b64_tr_b16 a[42:43], v99 offset:15808
  ds_read_b64_tr_b16 a[4:5], v99 offset:18432
  ds_read_b64_tr_b16 a[6:7], v99 offset:18816
  ds_read_b64_tr_b16 a[24:25], v99 offset:18464
  ds_read_b64_tr_b16 a[26:27], v99 offset:18848
  ds_read_b64_tr_b16 a[44:45], v99 offset:18496
  ds_read_b64_tr_b16 a[46:47], v99 offset:18880
  ds_read_b64_tr_b16 a[8:9], v99 offset:21504
  ds_read_b64_tr_b16 a[10:11], v99 offset:21888
  ds_read_b64_tr_b16 a[28:29], v99 offset:21536
  ds_read_b64_tr_b16 a[30:31], v99 offset:21920
  ds_read_b64_tr_b16 a[48:49], v99 offset:21568
  ds_read_b64_tr_b16 a[50:51], v99 offset:21952
  ds_read_b64_tr_b16 a[12:13], v99 offset:24576
  ds_read_b64_tr_b16 a[14:15], v99 offset:24960
  ds_read_b64_tr_b16 a[32:33], v99 offset:24608
  ds_read_b64_tr_b16 a[34:35], v99 offset:24992
  ds_read_b64_tr_b16 a[52:53], v99 offset:24640
  ds_read_b64_tr_b16 a[54:55], v99 offset:25024
  ds_read_b64_tr_b16 a[16:17], v99 offset:27648
  ds_read_b64_tr_b16 a[18:19], v99 offset:28032
  ds_read_b64_tr_b16 a[36:37], v99 offset:27680
  ds_read_b64_tr_b16 a[38:39], v99 offset:28064
  ds_read_b64_tr_b16 a[56:57], v99 offset:27712
  ds_read_b64_tr_b16 a[58:59], v99 offset:28096
  s_waitcnt lgkmcnt(0)
  v_mov_b32 v174, 0
  v_mov_b32 v175, 0
  v_mov_b32 v218, 0
  v_mov_b32 v219, 0
  v_mov_b32 v234, 0
  v_mov_b32 v235, 0
  v_mov_b32 v220, 0
  v_mov_b32 v221, 0
  v_mov_b32 v222, 0
  v_mov_b32 v223, 0
  v_mov_b32 v224, 0
  v_mov_b32 v225, 0
  v_mov_b32 v226, 0
  v_mov_b32 v227, 0
  s_waitcnt vmcnt(0)
  s_barrier
  s_add_u32 s12, s44, 81068032
  s_addc_u32 s13, s45, 0
  s_mov_b32 s14, 117760
  s_mov_b32 s15, 0x00020000
  s_add_u32 s28, s44, 114294784
  s_addc_u32 s29, s45, 0
  s_mov_b32 s30, 83886080
  s_mov_b32 s31, 0x00020000
  s_mul_i32 s64, s59, 40960
  s_lshl_b32 s21, s87, 10
  s_add_u32 s64, s64, s21
  s_add_u32 s64, s64, 1310720
  s_lshl_b32 s79, s59, 7
  s_and_b32 s21, s51, 12
  s_add_u32 s79, s79, s21
  s_add_u32 s79, s79, 96256
  v_mov_b32 v94, 0
  v_mov_b32 v95, 0
  s_lshl_b32 s90, s58, 7
  s_lshl_b32 s21, s56, 3
  s_add_u32 s90, s90, s21
  s_add_u32 s90, s90, 20480
  s_cmp_lg_u32 s20, 0
  s_cbranch_scc1 fm_9
  s_bfe_u32 s82, s50, 0x10001
  s_lshl_b32 s82, s82, 5
  s_lshr_b32 s21, s50, 2
  s_add_u32 s82, s82, s21
  s_and_b32 s80, s50, 1
  s_lshl_b32 s80, s80, 4
  s_add_u32 s80, s80, 16
  s_mov_b32 s101, 0
  s_branch fm_10
fm_8:
  s_sleep 8
  buffer_load_dword v238, v239, s[32:35], 0 offen sc1
  s_add_u32 s101, s101, 1
  s_cmp_gt_u32 s101, 131072
  s_cbranch_scc1 end0
  s_waitcnt vmcnt(0)
fm_10:
  v_readlane_b32 s22, v238, 0
  v_readlane_b32 s23, v238, 32
  s_add_u32 s22, s22, s23
  v_readlane_b32 s23, v238, 1
  s_add_u32 s22, s22, s23
  v_readlane_b32 s23, v238, 33
  s_add_u32 s22, s22, s23
  v_readlane_b32 s23, v238, 2
  s_add_u32 s22, s22, s23
  v_readlane_b32 s23, v238, 34
  s_add_u32 s22, s22, s23
  v_readlane_b32 s23, v238, 3
  s_add_u32 s22, s22, s23
  v_readlane_b32 s23, v238, 35
  s_add_u32 s22, s22, s23
  v_readlane_b32 s21, v238, 19
  v_readlane_b32 s23, v238, 21
  s_cmp_ge_u32 s22, 256
  s_cselect_b32 s23, s23, 0
  s_cmp_ge_u32 s21, 32
  s_cselect_b32 s23, s23, 0
  s_cmp_eq_u32 s23, 0
  s_cbranch_scc1 fm_8
  v_readlane_b32 s21, v238, s82
  s_cmp_ge_u32 s21, s80
  s_cselect_b32 s81, 1, 0
  s_andn2_b32 s53, s81, s53
  v_mov_b32 v244, s23
  v_mov_b32 v245, s53
  v_mov_b32 v236, 0
  ds_write_b64 v236, v[244:245]
  s_waitcnt lgkmcnt(0)
fm_9:
  s_barrier
  v_mov_b32 v236, 0
  ds_read_b64 v[244:245], v236
  s_mov_b32 s21, 0
  buffer_load_dwordx2 v[96:97], v9, s[8:11], s21 offen sc1
  buffer_load_dwordx4 v[96:99], v8, s[8:11], s21 offen offset:0 sc1
  buffer_load_dwordx4 v[96:99], v8, s[8:11], s21 offen offset:1024 sc1
  buffer_load_dwordx4 v[96:99], v10, s[8:11], s21 offen offset:0 sc1
  buffer_load_dwordx4 v[96:99], v10, s[8:11], s21 offen offset:1024 sc1
  buffer_load_dwordx4 v[96:99], v10, s[8:11], s21 offen offset:2048 sc1
  s_mov_b32 s21, 540672
  buffer_load_dwordx2 v[96:97], v9, s[8:11], s21 offen sc1
  buffer_load_dwordx4 v[96:99], v8, s[8:11], s21 offen offset:0 sc1
  buffer_load_dwordx4 v[96:99], v8, s[8:11], s21 offen offset:1024 sc1
  buffer_load_dwordx4 v[96:99], v10, s[8:11], s21 offen offset:0 sc1
  buffer_load_dwordx4 v[96:99], v10, s[8:11], s21 offen offset:1024 sc1
  buffer_load_dwordx4 v[96:99], v10, s[8:11], s21 offen offset:2048 sc1
  s_mov_b32 s21, 1081344
  buffer_load_dwordx2 v[96:97], v9, s[8:11], s21 offen sc1
  buffer_load_dwordx4 v[96:99], v8, s[8:11], s21 offen offset:0 sc1
  buffer_load_dwordx4 v[96:99], v8, s[8:11], s21 offen offset:1024 sc1
  buffer_load_dwordx4 v[96:99], v10, s[8:11], s21 offen offset:0 sc1
  buffer_load_dwordx4 v[96:99], v10, s[8:11], s21 offen offset:1024 sc1
  buffer_load_dwordx4 v[96:99], v10, s[8:11], s21 offen offset:2048 sc1
  s_mov_b32 s21, 1622016
  buffer_load_dwordx2 v[96:97], v9, s[8:11], s21 offen sc1
  buffer_load_dwordx4 v[96:99], v8, s[8:11], s21 offen offset:0 sc1
  buffer_load_dwordx4 v[96:99], v8, s[8:11], s21 offen offset:1024 sc1
  buffer_load_dwordx4 v[96:99], v10, s[8:11], s21 offen offset:0 sc1
  buffer_load_dwordx4 v[96:99], v10, s[8:11], s21 offen offset:1024 sc1
  buffer_load_dwordx4 v[96:99], v10, s[8:11], s21 offen offset:2048 sc1
  s_waitcnt lgkmcnt(0)
  v_readfirstlane_b32 s53, v245
  v_add_u32 v237, -1, v244
  v_lshlrev_b32 v237, 13, v237
  v_xor_b32 v237, 0, v237
  v_add_u32 v13, v13, v237
  v_add_u32 v4, v4, v237
  s_lshl_b32 s21, s50, 7
  s_add_u32 s21, s21, 0
  s_cmp_lg_u32 s20, 0
  s_cbranch_scc1 wf_12
  v_mov_b32 v240, 0
  s_mov_b32 s101, 0
wf_11:
  buffer_load_dword v241, v240, s[12:15], s21 offen sc1
  s_add_u32 s101, s101, 1
  s_cmp_gt_u32 s101, 131072
  s_cbranch_scc1 end0
  s_waitcnt vmcnt(0)
  v_readfirstlane_b32 s100, v241
  s_cmp_ge_u32 s100, 8
  s_cbranch_scc1 wf_12
  s_sleep 6
  s_branch wf_11
wf_12:
  s_barrier
  s_cmp_ge_u32 s20, 2
  s_cbranch_scc1 pf_13
  buffer_load_dwordx2 v[168:169], v18, s[16:19], 0 offen sc1
  buffer_load_dwordx2 v[170:171], v19, s[16:19], 0 offen sc1
  buffer_load_dwordx2 v[172:173], v20, s[16:19], 0 offen sc1
pf_13:
  v_add_u32 v242, 1088, v5
  v_add_u32 v243, 2176, v5
  v_add_u32 v244, 3264, v5
  v_add_u32 v245, 4352, v5
  s_mov_b32 s52, 0
  s_mov_b32 s47, 0
  v_mov_b32 v52, 0
  v_mov_b32 v53, 0
  v_mov_b32 v54, 0
  v_mov_b32 v55, 0
  v_mov_b32 v56, 0
  v_mov_b32 v57, 0
  v_mov_b32 v58, 0
  v_mov_b32 v59, 0
  v_mov_b32 v60, 0
  v_mov_b32 v61, 0
  v_mov_b32 v62, 0
  v_mov_b32 v63, 0
  v_mov_b32 v64, 0
  v_mov_b32 v65, 0
  v_mov_b32 v66, 0
  v_mov_b32 v67, 0
  v_mov_b32 v68, 0
  v_mov_b32 v69, 0
  v_mov_b32 v70, 0
  v_mov_b32 v71, 0
  v_mov_b32 v72, 0
  v_mov_b32 v73, 0
  v_mov_b32 v74, 0
  v_mov_b32 v75, 0
  v_mov_b32 v76, 0
  v_mov_b32 v77, 0
  v_mov_b32 v78, 0
  v_mov_b32 v79, 0
  v_mov_b32 v80, 0
  v_mov_b32 v81, 0
  v_mov_b32 v82, 0
  v_mov_b32 v83, 0
  v_mov_b32 v84, 0
  v_mov_b32 v85, 0
  v_mov_b32 v86, 0
  v_mov_b32 v87, 0
  v_mov_b32 v156, 0
  v_mov_b32 v157, 0
  v_mov_b32 v158, 0
  v_mov_b32 v159, 0
  s_and_b32 s21, s52, 3
  s_mul_i32 s81, s21, 540672
  s_lshl_b32 s84, s21, 15
  s_add_u32 s21, s52, 2
  s_and_b32 s21, s21, 3
  s_mul_i32 s82, s21, 540672
  s_add_u32 s21, s52, 3
  s_and_b32 s21, s21, 3
  s_lshl_b32 s83, s21, 15
  s_add_u32 s21, s52, 1
  s_and_b32 s22, s21, 3
  s_lshl_b32 s3, s22, 15
  s_mul_i32 s80, s21, 393216
  s_add_u32 s46, s21, 1
  s_min_u32 s46, s46, 64
  s_mul_i32 s85, s52, 98304
  s_add_u32 s57, s85, 6291456
  s_bfe_u32 s88, s52, 0x10002
  s_add_u32 s78, s81, 278528
  s_cmp_eq_u32 s53, 0
  s_cbranch_scc1 A1_18
  s_cmp_eq_u32 s20, 0
  s_cbranch_scc1 A1_14
  s_cmp_eq_u32 s20, 1
  s_cbranch_scc1 A1_15
  s_cmp_eq_u32 s20, 2
  s_cbranch_scc1 A1_16
  s_cmp_eq_u32 s20, 3
  s_cbranch_scc1 A1_17
  s_branch A1_18
step_19:
  s_add_u32 s21, s52, 2
  s_and_b32 s21, s21, 3
  s_mul_i32 s82, s21, 540672
  s_add_u32 s21, s52, 3
  s_and_b32 s21, s21, 3
  s_lshl_b32 s83, s21, 15
  s_add_u32 s21, s52, 1
  s_and_b32 s22, s21, 3
  s_lshl_b32 s3, s22, 15
  s_mul_i32 s80, s21, 393216
  s_add_u32 s46, s21, 1
  s_min_u32 s46, s46, 64
  s_mul_i32 s85, s52, 98304
  s_add_u32 s57, s85, 6291456
  s_bfe_u32 s88, s52, 0x10002
  s_add_u32 s78, s81, 278528
  v_mov_b32 v52, 0
  v_mov_b32 v53, 0
  v_mov_b32 v54, 0
  v_mov_b32 v55, 0
  v_mov_b32 v56, 0
  v_mov_b32 v57, 0
  v_mov_b32 v58, 0
  v_mov_b32 v59, 0
  v_mov_b32 v60, 0
  v_mov_b32 v61, 0
  v_mov_b32 v62, 0
  v_mov_b32 v63, 0
  v_mov_b32 v64, 0
  v_mov_b32 v65, 0
  v_mov_b32 v66, 0
  v_mov_b32 v67, 0
  v_mov_b32 v68, 0
  v_mov_b32 v69, 0
  v_mov_b32 v70, 0
  v_mov_b32 v71, 0
  v_mov_b32 v72, 0
  v_mov_b32 v73, 0
  v_mov_b32 v74, 0
  v_mov_b32 v75, 0
  v_mov_b32 v76, 0
  v_mov_b32 v77, 0
  v_mov_b32 v78, 0
  v_mov_b32 v79, 0
  v_mov_b32 v80, 0
  v_mov_b32 v81, 0
  v_mov_b32 v82, 0
  v_mov_b32 v83, 0
  v_mov_b32 v84, 0
  v_mov_b32 v85, 0
  v_mov_b32 v86, 0
  v_mov_b32 v87, 0
  s_sleep 9
  s_mov_b32 s54, 0
  buffer_load_dwordx4 v[96:99], v4, s[4:7], s84 offen offset:0 sc1
  buffer_load_dwordx4 v[100:103], v4, s[4:7], s84 offen offset:1024 sc1
  buffer_load_dwordx4 v[104:107], v4, s[4:7], s84 offen offset:2048 sc1
  s_waitcnt vmcnt(3)
  v_mov_b32 v176, v160
  v_mov_b32 v177, v161
  v_mov_b32 v178, v162
  v_mov_b32 v179, v163
  v_mov_b32 v180, v164
  v_mov_b32 v181, v165
  v_mov_b32 v182, v166
  v_mov_b32 v183, v167
  v_mov_b32 v184, v48
  v_mov_b32 v185, v49
  v_mov_b32 v186, v50
  v_mov_b32 v187, v51
  s_waitcnt vmcnt(0)
  v_bitop3_b32 v27, v99, v103, v107 bitop3:0x80
  v_cvt_f32_f16 v108, v99
  v_and_b32 v27, 0x48000000, v27
  v_cvt_f32_f16 v109, v103
  v_cmp_ne_u32 vcc, 0x48000000, v27
  v_cvt_f32_f16 v110, v106
  v_cvt_f32_f16_sdwa v111, v106 dst_sel:DWORD dst_unused:UNUSED_PAD src0_sel:WORD_1
  v_cvt_pk_bf16_f32 v40, v110, v111
  s_cbranch_vccnz pm_21
pm_22:
  v_cvt_pk_bf16_f32 v41, v108, v109
  v_cvt_f32_f16 v110, v96
  v_cvt_f32_f16_sdwa v111, v96 dst_sel:DWORD dst_unused:UNUSED_PAD src0_sel:WORD_1
  v_smfmac_f32_16x16x32_bf16 v[52:55], v[40:41], a[16:19], v44
  v_cvt_f32_f16 v112, v97
  v_cvt_f32_f16_sdwa v113, v97 dst_sel:DWORD dst_unused:UNUSED_PAD src0_sel:WORD_1
  v_cvt_pk_bf16_f32 v32, v110, v111
  v_smfmac_f32_16x16x32_bf16 v[64:67], v[40:41], a[76:79], v44
  v_cvt_pk_bf16_f32 v33, v112, v113
  v_cvt_f32_f16 v114, v98
  v_cvt_f32_f16_sdwa v115, v98 dst_sel:DWORD dst_unused:UNUSED_PAD src0_sel:WORD_1
  v_smfmac_f32_16x16x32_bf16 v[56:59], v[40:41], a[36:39], v44
  v_cvt_f32_f16 v116, v100
  v_cvt_f32_f16_sdwa v117, v100 dst_sel:DWORD dst_unused:UNUSED_PAD src0_sel:WORD_1
  v_cvt_pk_bf16_f32 v34, v114, v115
  v_smfmac_f32_16x16x32_bf16 v[68:71], v[40:41], a[96:99], v44
  v_cvt_pk_bf16_f32 v35, v116, v117
  v_cvt_f32_f16 v110, v101
  v_cvt_f32_f16_sdwa v111, v101 dst_sel:DWORD dst_unused:UNUSED_PAD src0_sel:WORD_1
  v_smfmac_f32_16x16x32_bf16 v[60:63], v[40:41], a[56:59], v44
  v_cvt_f32_f16 v112, v102
  v_cvt_f32_f16_sdwa v113, v102 dst_sel:DWORD dst_unused:UNUSED_PAD src0_sel:WORD_1
  v_smfmac_f32_16x16x32_bf16 v[72:75], v[40:41], a[116:119], v44
  v_cvt_pk_bf16_f32 v36, v110, v111
  v_cvt_pk_bf16_f32 v37, v112, v113
  v_smfmac_f32_16x16x32_bf16 v[76:79], v[40:41], a[136:139], v44
  v_cvt_f32_f16 v114, v104
  v_cvt_f32_f16_sdwa v115, v104 dst_sel:DWORD dst_unused:UNUSED_PAD src0_sel:WORD_1
  v_smfmac_f32_16x16x32_bf16 v[80:83], v[40:41], a[156:159], v44
  v_cvt_f32_f16 v116, v105
  v_cvt_f32_f16_sdwa v117, v105 dst_sel:DWORD dst_unused:UNUSED_PAD src0_sel:WORD_1
  v_smfmac_f32_16x16x32_bf16 v[84:87], v[40:41], a[176:179], v44
  v_cvt_pk_bf16_f32 v38, v114, v115
  v_cvt_pk_bf16_f32 v39, v116, v117
A2_23:
  v_smfmac_f32_16x16x64_bf16 v[52:55], v[32:35], a[0:7], v44
  v_smfmac_f32_16x16x64_bf16 v[52:55], v[36:39], a[8:15], v44
  v_smfmac_f32_16x16x64_bf16 v[64:67], v[32:35], a[60:67], v44
  v_smfmac_f32_16x16x64_bf16 v[64:67], v[36:39], a[68:75], v44
  v_smfmac_f32_16x16x64_bf16 v[56:59], v[32:35], a[20:27], v44
  v_smfmac_f32_16x16x64_bf16 v[56:59], v[36:39], a[28:35], v44
  v_smfmac_f32_16x16x64_bf16 v[68:71], v[32:35], a[80:87], v44
  v_permlane32_swap_b32 v52, v64
  v_permlane32_swap_b32 v53, v65
  v_permlane32_swap_b32 v54, v66
  v_smfmac_f32_16x16x64_bf16 v[68:71], v[36:39], a[88:95], v44
  v_permlane32_swap_b32 v55, v67
  v_pk_add_f32 v[52:53], v[52:53], v[64:65]
  v_pk_add_f32 v[54:55], v[54:55], v[66:67]
  v_smfmac_f32_16x16x64_bf16 v[60:63], v[32:35], a[40:47], v44
  ds_write2_b32 v5, v52, v53 offset0:0 offset1:4
  ds_write2_b32 v5, v54, v55 offset0:8 offset1:12
  v_smfmac_f32_16x16x64_bf16 v[60:63], v[36:39], a[48:55], v44
  v_smfmac_f32_16x16x64_bf16 v[72:75], v[32:35], a[100:107], v44
  v_permlane32_swap_b32 v56, v68
  v_permlane32_swap_b32 v57, v69
  v_permlane32_swap_b32 v58, v70
  v_smfmac_f32_16x16x64_bf16 v[72:75], v[36:39], a[108:115], v44
  v_permlane32_swap_b32 v59, v71
  v_pk_add_f32 v[56:57], v[56:57], v[68:69]
  v_pk_add_f32 v[58:59], v[58:59], v[70:71]
  v_smfmac_f32_16x16x64_bf16 v[76:79], v[32:35], a[120:127], v44
  ds_write2_b32 v242, v56, v57 offset0:0 offset1:4
  ds_write2_b32 v242, v58, v59 offset0:8 offset1:12
  v_smfmac_f32_16x16x64_bf16 v[76:79], v[36:39], a[128:135], v44
  v_smfmac_f32_16x16x64_bf16 v[80:83], v[32:35], a[140:147], v44
  v_permlane32_swap_b32 v60, v72
  v_permlane32_swap_b32 v61, v73
  v_permlane32_swap_b32 v62, v74
  v_smfmac_f32_16x16x64_bf16 v[80:83], v[36:39], a[148:155], v44
  v_permlane32_swap_b32 v63, v75
  v_pk_add_f32 v[60:61], v[60:61], v[72:73]
  v_pk_add_f32 v[62:63], v[62:63], v[74:75]
  v_smfmac_f32_16x16x64_bf16 v[84:87], v[32:35], a[160:167], v44
  ds_write2_b32 v243, v60, v61 offset0:0 offset1:4
  ds_write2_b32 v243, v62, v63 offset0:8 offset1:12
  v_smfmac_f32_16x16x64_bf16 v[84:87], v[36:39], a[168:175], v44
  v_permlane32_swap_b32 v76, v80
  v_permlane32_swap_b32 v77, v81
  v_permlane32_swap_b32 v78, v82
  v_permlane32_swap_b32 v79, v83
  v_pk_add_f32 v[76:77], v[76:77], v[80:81]
  v_pk_add_f32 v[78:79], v[78:79], v[82:83]
  ds_write2_b32 v244, v76, v77 offset0:0 offset1:4
  ds_write2_b32 v244, v78, v79 offset0:8 offset1:12
  ds_write2_b32 v245, v84, v85 offset0:0 offset1:4
  ds_write2_b32 v245, v86, v87 offset0:8 offset1:12
  s_waitcnt lgkmcnt(0) vmcnt(0)
  s_barrier
  ds_read_b128 v[96:99], v45 offset:0
  ds_read_b128 v[108:111], v45 offset:5440
  ds_read_b128 v[100:103], v45 offset:1088
  ds_read_b128 v[112:115], v45 offset:6528
  ds_read_b128 v[104:107], v45 offset:2176
  ds_read_b128 v[116:119], v45 offset:7616
  s_waitcnt lgkmcnt(4)
  v_pk_add_f32 v[96:97], v[96:97], v[108:109]
  v_pk_add_f32 v[98:99], v[98:99], v[110:111]
  s_nop 0
  v_add_f32_dpp v108, v96, v96 row_ror:8 row_mask:0xf bank_mask:0xf
  v_add_f32_dpp v109, v97, v97 row_ror:8 row_mask:0xf bank_mask:0xf
  v_add_f32_dpp v110, v98, v98 row_ror:8 row_mask:0xf bank_mask:0xf
  v_add_f32_dpp v111, v99, v99 row_ror:8 row_mask:0xf bank_mask:0xf
  v_cvt_pk_bf16_f32 v212, v108, v109
  v_cvt_pk_bf16_f32 v213, v110, v111
  s_waitcnt lgkmcnt(2)
  v_pk_add_f32 v[100:101], v[100:101], v[112:113]
  v_pk_add_f32 v[102:103], v[102:103], v[114:115]
  s_nop 0
  v_add_f32_dpp v112, v100, v100 row_ror:8 row_mask:0xf bank_mask:0xf
  v_add_f32_dpp v113, v101, v101 row_ror:8 row_mask:0xf bank_mask:0xf
  v_add_f32_dpp v114, v102, v102 row_ror:8 row_mask:0xf bank_mask:0xf
  v_add_f32_dpp v115, v103, v103 row_ror:8 row_mask:0xf bank_mask:0xf
  v_cvt_pk_bf16_f32 v214, v112, v113
  v_cvt_pk_bf16_f32 v215, v114, v115
  s_waitcnt lgkmcnt(0)
  v_pk_add_f32 v[104:105], v[104:105], v[116:117]
  v_pk_add_f32 v[106:107], v[106:107], v[118:119]
  v_mfma_f32_16x16x32_bf16 v[96:99], v[168:171], v[212:215], 0
  v_add_f32_dpp v116, v104, v104 row_ror:8 row_mask:0xf bank_mask:0xf
  v_add_f32_dpp v117, v105, v105 row_ror:8 row_mask:0xf bank_mask:0xf
  v_add_f32_dpp v118, v106, v106 row_ror:8 row_mask:0xf bank_mask:0xf
  v_add_f32_dpp v119, v107, v107 row_ror:8 row_mask:0xf bank_mask:0xf
  v_cvt_pk_bf16_f32 v216, v116, v117
  v_cvt_pk_bf16_f32 v217, v118, v119
  s_nop 1
  v_mfma_f32_16x16x32_bf16 v[96:99], v[172:175], v[216:219], v[96:99]
  s_mov_b64 exec, s[74:75]
  s_nop 6
  v_cvt_pk_f16_f32 v100, v96, v97
  v_cvt_pk_f16_f32 v101, v98, v99
  v_and_or_b32 v100, v100, -2, s88
  buffer_store_dwordx2 v[100:101], v7, s[8:11], s81 offen
  s_mov_b64 exec, -1
  s_cmp_eq_u32 s52, 63
  s_cbranch_scc1 last_20
  s_sleep 5
  s_mov_b32 s54, 0
  buffer_load_dwordx2 v[248:249], v9, s[8:11], s81 offen sc1
  buffer_load_dwordx4 v[112:115], v8, s[8:11], s81 offen offset:0 sc1
  buffer_load_dwordx4 v[116:119], v8, s[8:11], s81 offen offset:1024 sc1
  s_sleep 2
  buffer_load_dwordx4 v[144:147], v10, s[8:11], s81 offen offset:0 sc1
  buffer_load_dwordx4 v[148:151], v10, s[8:11], s81 offen offset:1024 sc1
  buffer_load_dwordx4 v[152:155], v10, s[8:11], s81 offen offset:2048 sc1
  v_mov_b32 v188, 0
  v_mov_b32 v189, 0
  v_mov_b32 v190, 0
  v_mov_b32 v191, 0
  v_mov_b32 v192, 0
  v_mov_b32 v193, 0
  v_mov_b32 v194, 0
  v_mov_b32 v195, 0
  v_mov_b32 v196, 0
  v_mov_b32 v197, 0
  v_mov_b32 v198, 0
  v_mov_b32 v199, 0
  v_readfirstlane_b32 s21, v94
  s_add_u32 s22, s46, 8
  s_min_u32 s22, s22, 64
  s_sub_u32 s55, s21, s22
  s_sub_u32 s56, s21, s46
  s_waitcnt vmcnt(5)
  v_xor_b32 v96, s88, v248
  s_nop 0
  v_permlane16_swap_b32 v248, v249
  v_fma_mix_f32 v250, v248, 1.0, v249 op_sel:[0,0,0] op_sel_hi:[1,0,1]
  v_fma_mix_f32 v251, v248, 1.0, v249 op_sel:[1,0,1] op_sel_hi:[1,0,1]
  v_mov_b32 v248, v250
  v_mov_b32 v249, v251
  s_nop 0
  v_permlane32_swap_b32 v248, v250
  v_permlane32_swap_b32 v249, v251
  s_waitcnt vmcnt(3)
  v_bitop3_b32 v97, v112, v114, s88 bitop3:0x7e
  v_bitop3_b32 v98, v116, v118, s88 bitop3:0x7e
  v_fma_mix_f32 v120, v112, 1.0, v116 op_sel:[0,0,0] op_sel_hi:[1,0,1]
  v_or3_b32 v27, v96, v97, v98
  v_fma_mix_f32 v124, v114, 1.0, v118 op_sel:[0,0,0] op_sel_hi:[1,0,1]
  v_and_b32 v27, 1, v27
  v_fma_mix_f32 v121, v112, 1.0, v116 op_sel:[1,0,1] op_sel_hi:[1,0,1]
  v_cmp_ne_u32 vcc, 0, v27
  v_fma_mix_f32 v125, v114, 1.0, v118 op_sel:[1,0,1] op_sel_hi:[1,0,1]
  v_fma_mix_f32 v122, v113, 1.0, v117 op_sel:[0,0,0] op_sel_hi:[1,0,1]
  v_fma_mix_f32 v126, v115, 1.0, v119 op_sel:[0,0,0] op_sel_hi:[1,0,1]
  s_cbranch_vccnz psr_25
psj_26:
  s_cmp_lt_i32 s56, 0
  s_cbranch_scc1 kvw_28
kvok_29:
  v_fma_mix_f32 v123, v113, 1.0, v117 op_sel:[1,0,1] op_sel_hi:[1,0,1]
  v_fma_mix_f32 v127, v115, 1.0, v119 op_sel:[1,0,1] op_sel_hi:[1,0,1]
  v_permlane32_swap_b32 v120, v124
  v_permlane32_swap_b32 v121, v125
  v_permlane32_swap_b32 v122, v126
  v_permlane32_swap_b32 v123, v127
  v_pk_add_f32 v[120:121], v[120:121], v[124:125]
  v_pk_add_f32 v[122:123], v[122:123], v[126:127]
  v_pk_add_f32 v[124:125], v[248:249], v[250:251]
  v_max3_f32 v236, v120, v121, v122
  v_max3_f32 v237, v123, v124, v125
  v_max_f32 v236, v236, v237
  s_nop 1
  v_max_f32_dpp v236, v236, v236 row_ror:8 row_mask:0xf bank_mask:0xf
  v_mov_b32 v237, v236
  s_nop 1
  v_permlane32_swap_b32 v236, v237
  v_max_f32 v236, v236, v237
  v_mov_b32 v237, v236
  s_nop 1
  v_permlane16_swap_b32 v236, v237
  v_max_f32 v236, v236, v237
  s_waitcnt vmcnt(0)
  v_max3_u32 v27, v144, v146, v148
  v_max3_u32 v27, v27, v150, v152
  v_max3_u32 v27, v27, v154, v154
  v_cmp_eq_u32 vcc, -1, v27
  s_nop 1
  s_cbranch_vccnz pv_24
pvj_27:
  v_mul_f32 v236, s86, v236
  v_smfmac_f32_16x16x64_bf16 v[188:191], v[144:147], a[180:187], v44
  v_fma_f32 v120, v120, s86, -v236
  v_smfmac_f32_16x16x64_bf16 v[188:191], v[148:151], a[188:195], v44
  v_fma_f32 v121, v121, s86, -v236
  v_smfmac_f32_16x16x64_bf16 v[188:191], v[152:155], a[196:203], v44
  buffer_load_dwordx4 v[160:163], v16, s[28:31], s64 offen offset:0 sc1
  v_fma_f32 v122, v122, s86, -v236
  v_smfmac_f32_16x16x64_bf16 v[192:195], v[144:147], a[204:211], v44
  v_fma_f32 v123, v123, s86, -v236
  v_smfmac_f32_16x16x64_bf16 v[192:195], v[148:151], a[212:219], v44
  buffer_load_dwordx4 v[164:167], v16, s[28:31], s64 offen offset:1024 sc1
  v_fma_f32 v124, v124, s86, -v236
  v_smfmac_f32_16x16x64_bf16 v[192:195], v[152:155], a[220:227], v44
  v_fma_f32 v125, v125, s86, -v236
  v_smfmac_f32_16x16x64_bf16 v[196:199], v[144:147], a[228:235], v44
  buffer_load_dwordx4 v[48:51], v16, s[28:31], s64 offen offset:2048 sc1
  v_exp_f32 v120, v120
  v_smfmac_f32_16x16x64_bf16 v[196:199], v[148:151], a[236:243], v44
  v_exp_f32 v121, v121
  v_smfmac_f32_16x16x64_bf16 v[196:199], v[152:155], a[244:251], v44
  buffer_load_dwordx2 v[168:169], v18, s[16:19], s80 offen sc1
  v_exp_f32 v122, v122
  buffer_load_dwordx2 v[170:171], v19, s[16:19], s80 offen sc1
  v_exp_f32 v123, v123
  buffer_load_dwordx2 v[172:173], v20, s[16:19], s80 offen sc1
  v_exp_f32 v124, v124
  s_cmp_lt_i32 s55, 0
  s_cbranch_scc1 fl_30
fl_31:
  v_exp_f32 v125, v125
  s_mov_b64 exec, s[60:61]
  v_cvt_pk_bf16_f32 v220, v120, v121
  v_cvt_pk_bf16_f32 v221, v122, v123
  v_cvt_pk_bf16_f32 v224, v124, v125
  s_mov_b64 exec, s[62:63]
  v_cvt_pk_bf16_f32 v222, v120, v121
  v_cvt_pk_bf16_f32 v223, v122, v123
  v_cvt_pk_bf16_f32 v225, v124, v125
  s_mov_b64 exec, -1
  v_pk_add_f32 v[126:127], v[120:121], v[122:123]
  v_add_f32 v128, v124, v125
  v_mfma_f32_16x16x32_bf16 v[200:203], v[176:179], v[220:223], 0
  v_add_f32 v236, v126, v127
  v_fmac_f32 v236, v128, v89
  v_cvt_pk_bf16_f32 v228, v188, v189
  v_cvt_pk_bf16_f32 v229, v190, v191
  v_mfma_f32_16x16x32_bf16 v[204:207], v[180:183], v[220:223], 0
  v_cvt_pk_bf16_f32 v230, v192, v193
  v_cvt_pk_bf16_f32 v231, v194, v195
  v_mfma_f32_16x16x32_bf16 v[208:211], v[184:187], v[220:223], 0
  v_cvt_pk_bf16_f32 v232, v196, v197
  v_cvt_pk_bf16_f32 v233, v198, v199
  v_add_f32_dpp v236, v236, v236 row_ror:8 row_mask:0xf bank_mask:0xf
  v_mov_b32 v237, v236
  s_nop 0
  v_mfma_f32_16x16x32_bf16 v[200:203], v[228:231], v[224:227], v[200:203]
  v_mfma_f32_16x16x32_bf16 v[204:207], v[230:233], v[224:227], v[204:207]
  v_permlane32_swap_b32 v236, v237
  v_add_f32 v236, v236, v237
  v_mov_b32 v237, v236
  v_mfma_f32_16x16x32_bf16 v[208:211], v[232:235], v[224:227], v[208:211]
  s_nop 0
  v_permlane16_swap_b32 v236, v237
  v_add_f32 v236, v236, v237
  v_rcp_f32 v236, v236
  s_nop 2
  v_pk_mul_f32 v[200:201], v[200:201], v[236:237] op_sel_hi:[1,0]
  v_pk_mul_f32 v[202:203], v[202:203], v[236:237] op_sel_hi:[1,0]
  ds_write_b128 v11, v[200:203] offset:0
  v_pk_mul_f32 v[204:205], v[204:205], v[236:237] op_sel_hi:[1,0]
  v_pk_mul_f32 v[206:207], v[206:207], v[236:237] op_sel_hi:[1,0]
  ds_write_b128 v11, v[204:207] offset:1024
  v_pk_mul_f32 v[208:209], v[208:209], v[236:237] op_sel_hi:[1,0]
  v_pk_mul_f32 v[210:211], v[210:211], v[236:237] op_sel_hi:[1,0]
  ds_write_b128 v11, v[208:211] offset:2048
  s_waitcnt lgkmcnt(0)
  s_barrier
  ds_read_b64 v[96:97], v12 offset:0
  ds_read_b64 v[98:99], v12 offset:128
  ds_read_b64 v[100:101], v12 offset:3072
  ds_read_b64 v[102:103], v12 offset:3200
  ds_read_b64 v[104:105], v12 offset:6144
  ds_read_b64 v[106:107], v12 offset:6272
  ds_read_b64 v[108:109], v12 offset:9216
  ds_read_b64 v[110:111], v12 offset:9344
  s_waitcnt lgkmcnt(6)
  v_pk_add_f32 v[96:97], v[96:97], v[98:99]
  s_waitcnt lgkmcnt(4)
  v_pk_add_f32 v[100:101], v[100:101], v[102:103]
  s_waitcnt lgkmcnt(2)
  v_pk_add_f32 v[104:105], v[104:105], v[106:107]
  v_pk_add_f32 v[96:97], v[96:97], v[100:101]
  s_waitcnt lgkmcnt(0)
  v_pk_add_f32 v[108:109], v[108:109], v[110:111]
  v_pk_add_f32 v[96:97], v[96:97], v[104:105]
  v_pk_add_f32 v[96:97], v[96:97], v[108:109]
  v_cvt_pk_f16_f32 v100, v96, v97
  v_perm_b32 v100, s91, v100, v14
  buffer_atomic_pk_add_f16 v100, v13, s[4:7], s3 offen
  s_add_u32 s64, s64, 1310720
  s_add_u32 s52, s52, 1
  s_and_b32 s21, s52, 3
  s_mul_i32 s81, s21, 540672
  s_lshl_b32 s84, s21, 15
  s_branch step_19
pm_21:
  s_mov_b32 s47, 1
  buffer_load_dwordx4 v[96:99], v4, s[4:7], s84 offen offset:0 sc1
  buffer_load_dwordx4 v[100:103], v4, s[4:7], s84 offen offset:1024 sc1
  buffer_load_dwordx4 v[104:107], v4, s[4:7], s84 offen offset:2048 sc1
  s_add_u32 s54, s54, 1
  s_cmp_gt_u32 s54, 131072
  s_cbranch_scc1 end0
  s_waitcnt vmcnt(0)
  v_bitop3_b32 v27, v99, v103, v107 bitop3:0x80
  v_cvt_f32_f16 v108, v99
  v_and_b32 v27, 0x48000000, v27
  v_cvt_f32_f16 v109, v103
  v_cmp_ne_u32 vcc, 0x48000000, v27
  v_cvt_f32_f16 v110, v106
  v_cvt_f32_f16_sdwa v111, v106 dst_sel:DWORD dst_unused:UNUSED_PAD src0_sel:WORD_1
  v_cvt_pk_bf16_f32 v40, v110, v111
  s_cbranch_vccnz pm_21
  s_branch pm_22
A1_14:
  v_smfmac_f32_16x16x32_bf16 v[52:55], v[40:41], a[16:19], v44
  v_smfmac_f32_16x16x32_bf16 v[64:67], v[40:41], a[76:79], v44
  v_smfmac_f32_16x16x32_bf16 v[56:59], v[40:41], a[36:39], v44
  v_smfmac_f32_16x16x32_bf16 v[68:71], v[40:41], a[96:99], v44
  v_smfmac_f32_16x16x32_bf16 v[60:63], v[40:41], a[56:59], v44
  v_smfmac_f32_16x16x32_bf16 v[72:75], v[40:41], a[116:119], v44
  v_smfmac_f32_16x16x32_bf16 v[76:79], v[40:41], a[136:139], v44
  v_smfmac_f32_16x16x32_bf16 v[80:83], v[40:41], a[156:159], v44
  v_smfmac_f32_16x16x32_bf16 v[84:87], v[40:41], a[176:179], v44
  s_branch A2_23
pv_24:
  buffer_load_dwordx4 v[144:147], v10, s[8:11], s81 offen offset:0 sc1
  buffer_load_dwordx4 v[148:151], v10, s[8:11], s81 offen offset:1024 sc1
  buffer_load_dwordx4 v[152:155], v10, s[8:11], s81 offen offset:2048 sc1
  s_add_u32 s54, s54, 1
  s_cmp_gt_u32 s54, 131072
  s_cbranch_scc1 end0
  s_waitcnt vmcnt(0)
  v_max3_u32 v27, v144, v146, v148
  v_max3_u32 v27, v27, v150, v152
  v_max3_u32 v27, v27, v154, v154
  v_cmp_eq_u32 vcc, -1, v27
  s_nop 1
  s_cbranch_vccnz pv_24
  s_branch pvj_27
psr_25:
  buffer_load_dwordx2 v[248:249], v9, s[8:11], s81 offen sc1
  buffer_load_dwordx4 v[112:115], v8, s[8:11], s81 offen offset:0 sc1
  buffer_load_dwordx4 v[116:119], v8, s[8:11], s81 offen offset:1024 sc1
  s_add_u32 s54, s54, 1
  s_cmp_gt_u32 s54, 131072
  s_cbranch_scc1 end0
  s_waitcnt vmcnt(2)
  v_xor_b32 v96, s88, v248
  s_nop 0
  v_permlane16_swap_b32 v248, v249
  v_fma_mix_f32 v250, v248, 1.0, v249 op_sel:[0,0,0] op_sel_hi:[1,0,1]
  v_fma_mix_f32 v251, v248, 1.0, v249 op_sel:[1,0,1] op_sel_hi:[1,0,1]
  v_mov_b32 v248, v250
  v_mov_b32 v249, v251
  s_nop 0
  v_permlane32_swap_b32 v248, v250
  v_permlane32_swap_b32 v249, v251
  s_waitcnt vmcnt(0)
  v_bitop3_b32 v97, v112, v114, s88 bitop3:0x7e
  v_bitop3_b32 v98, v116, v118, s88 bitop3:0x7e
  v_fma_mix_f32 v120, v112, 1.0, v116 op_sel:[0,0,0] op_sel_hi:[1,0,1]
  v_or3_b32 v27, v96, v97, v98
  v_fma_mix_f32 v124, v114, 1.0, v118 op_sel:[0,0,0] op_sel_hi:[1,0,1]
  v_and_b32 v27, 1, v27
  v_fma_mix_f32 v121, v112, 1.0, v116 op_sel:[1,0,1] op_sel_hi:[1,0,1]
  v_cmp_ne_u32 vcc, 0, v27
  v_fma_mix_f32 v125, v114, 1.0, v118 op_sel:[1,0,1] op_sel_hi:[1,0,1]
  v_fma_mix_f32 v122, v113, 1.0, v117 op_sel:[0,0,0] op_sel_hi:[1,0,1]
  v_fma_mix_f32 v126, v115, 1.0, v119 op_sel:[0,0,0] op_sel_hi:[1,0,1]
  s_cbranch_vccnz psr_25
  s_branch psj_26
kvw_28:
  s_cmp_eq_u32 s52, 0
  s_cselect_b32 s23, 1, s46
  s_cselect_b32 s55, 0, s55
  v_mov_b32 v236, 0
  s_mov_b32 s101, 0
wf_32:
  buffer_load_dword v237, v236, s[12:15], s79 offen sc1
  s_add_u32 s101, s101, 1
  s_cmp_gt_u32 s101, 131072
  s_cbranch_scc1 end0
  s_waitcnt vmcnt(0)
  v_readfirstlane_b32 s100, v237
  s_cmp_ge_u32 s100, s23
  s_cbranch_scc1 wf_33
  s_sleep 3
  s_branch wf_32
wf_33:
  s_cmp_gt_u32 s52, 1
  s_cbranch_scc1 kvok_29
  s_sub_u32 s21, s64, 1310720
  buffer_load_dwordx4 v[176:179], v16, s[28:31], s21 offen offset:0 sc1
  buffer_load_dwordx4 v[180:183], v16, s[28:31], s21 offen offset:1024 sc1
  buffer_load_dwordx4 v[184:187], v16, s[28:31], s21 offen offset:2048 sc1
  s_waitcnt vmcnt(0)
  s_branch kvok_29
fl_30:
  buffer_load_dword v94, v95, s[12:15], s79 offen sc1
  s_branch fl_31
last_20:
  v_mov_b32 v246, 80
  v_mov_b32 v247, 1
  s_mov_b64 exec, 1
  buffer_atomic_add v247, v246, s[32:35], 0 offen sc0 sc1
  s_mov_b64 exec, -1
clm_34:
  s_branch chain_done
step_35:
  s_add_u32 s21, s52, 2
  s_and_b32 s21, s21, 3
  s_mul_i32 s82, s21, 540672
  s_add_u32 s21, s52, 3
  s_and_b32 s21, s21, 3
  s_lshl_b32 s83, s21, 15
  s_add_u32 s21, s52, 1
  s_and_b32 s22, s21, 3
  s_lshl_b32 s3, s22, 15
  s_mul_i32 s80, s21, 393216
  s_add_u32 s46, s21, 1
  s_min_u32 s46, s46, 64
  s_mul_i32 s85, s52, 98304
  s_add_u32 s57, s85, 6291456
  s_bfe_u32 s88, s52, 0x10002
  s_add_u32 s78, s81, 278528
  v_mov_b32 v52, 0
  v_mov_b32 v53, 0
  v_mov_b32 v54, 0
  v_mov_b32 v55, 0
  v_mov_b32 v56, 0
  v_mov_b32 v57, 0
  v_mov_b32 v58, 0
  v_mov_b32 v59, 0
  v_mov_b32 v60, 0
  v_mov_b32 v61, 0
  v_mov_b32 v62, 0
  v_mov_b32 v63, 0
  v_mov_b32 v64, 0
  v_mov_b32 v65, 0
  v_mov_b32 v66, 0
  v_mov_b32 v67, 0
  v_mov_b32 v68, 0
  v_mov_b32 v69, 0
  v_mov_b32 v70, 0
  v_mov_b32 v71, 0
  v_mov_b32 v72, 0
  v_mov_b32 v73, 0
  v_mov_b32 v74, 0
  v_mov_b32 v75, 0
  v_mov_b32 v76, 0
  v_mov_b32 v77, 0
  v_mov_b32 v78, 0
  v_mov_b32 v79, 0
  v_mov_b32 v80, 0
  v_mov_b32 v81, 0
  v_mov_b32 v82, 0
  v_mov_b32 v83, 0
  v_mov_b32 v84, 0
  v_mov_b32 v85, 0
  v_mov_b32 v86, 0
  v_mov_b32 v87, 0
  s_sleep 9
  s_mov_b32 s54, 0
  buffer_load_dwordx4 v[96:99], v4, s[4:7], s84 offen offset:0 sc1
  buffer_load_dwordx4 v[100:103], v4, s[4:7], s84 offen offset:1024 sc1
  buffer_load_dwordx4 v[104:107], v4, s[4:7], s84 offen offset:2048 sc1
  s_waitcnt vmcnt(3)
  v_mov_b32 v176, v160
  v_mov_b32 v177, v161
  v_mov_b32 v178, v162
  v_mov_b32 v179, v163
  v_mov_b32 v180, v164
  v_mov_b32 v181, v165
  v_mov_b32 v182, v166
  v_mov_b32 v183, v167
  v_mov_b32 v184, v48
  v_mov_b32 v185, v49
  v_mov_b32 v186, v50
  v_mov_b32 v187, v51
  s_waitcnt vmcnt(0)
  v_bitop3_b32 v27, v99, v103, v107 bitop3:0x80
  v_cvt_f32_f16 v108, v99
  v_and_b32 v27, 0x48000000, v27
  v_cvt_f32_f16 v109, v103
  v_cmp_ne_u32 vcc, 0x48000000, v27
  v_cvt_f32_f16 v110, v106
  v_cvt_f32_f16_sdwa v111, v106 dst_sel:DWORD dst_unused:UNUSED_PAD src0_sel:WORD_1
  v_cvt_pk_bf16_f32 v40, v110, v111
  s_cbranch_vccnz pm_37
pm_38:
  v_cvt_pk_bf16_f32 v41, v108, v109
  v_cvt_f32_f16 v110, v96
  v_cvt_f32_f16_sdwa v111, v96 dst_sel:DWORD dst_unused:UNUSED_PAD src0_sel:WORD_1
  v_smfmac_f32_16x16x32_bf16 v[52:55], v[40:41], a[16:19], v44
  v_cvt_f32_f16 v112, v97
  v_cvt_f32_f16_sdwa v113, v97 dst_sel:DWORD dst_unused:UNUSED_PAD src0_sel:WORD_1
  v_cvt_pk_bf16_f32 v32, v110, v111
  v_smfmac_f32_16x16x32_bf16 v[64:67], v[40:41], a[76:79], v44
  v_cvt_pk_bf16_f32 v33, v112, v113
  v_cvt_f32_f16 v114, v98
  v_cvt_f32_f16_sdwa v115, v98 dst_sel:DWORD dst_unused:UNUSED_PAD src0_sel:WORD_1
  v_smfmac_f32_16x16x32_bf16 v[56:59], v[40:41], a[36:39], v44
  v_cvt_f32_f16 v116, v100
  v_cvt_f32_f16_sdwa v117, v100 dst_sel:DWORD dst_unused:UNUSED_PAD src0_sel:WORD_1
  v_cvt_pk_bf16_f32 v34, v114, v115
  v_smfmac_f32_16x16x32_bf16 v[68:71], v[40:41], a[96:99], v44
  v_cvt_pk_bf16_f32 v35, v116, v117
  v_cvt_f32_f16 v110, v101
  v_cvt_f32_f16_sdwa v111, v101 dst_sel:DWORD dst_unused:UNUSED_PAD src0_sel:WORD_1
  v_smfmac_f32_16x16x32_bf16 v[60:63], v[40:41], a[56:59], v44
  v_cvt_f32_f16 v112, v102
  v_cvt_f32_f16_sdwa v113, v102 dst_sel:DWORD dst_unused:UNUSED_PAD src0_sel:WORD_1
  v_smfmac_f32_16x16x32_bf16 v[72:75], v[40:41], a[116:119], v44
  v_cvt_pk_bf16_f32 v36, v110, v111
  v_cvt_pk_bf16_f32 v37, v112, v113
  v_smfmac_f32_16x16x32_bf16 v[76:79], v[40:41], a[136:139], v44
  v_cvt_f32_f16 v114, v104
  v_cvt_f32_f16_sdwa v115, v104 dst_sel:DWORD dst_unused:UNUSED_PAD src0_sel:WORD_1
  v_smfmac_f32_16x16x32_bf16 v[80:83], v[40:41], a[156:159], v44
  v_cvt_f32_f16 v116, v105
  v_cvt_f32_f16_sdwa v117, v105 dst_sel:DWORD dst_unused:UNUSED_PAD src0_sel:WORD_1
  v_smfmac_f32_16x16x32_bf16 v[84:87], v[40:41], a[176:179], v44
  v_cvt_pk_bf16_f32 v38, v114, v115
  v_cvt_pk_bf16_f32 v39, v116, v117
A2_39:
  v_smfmac_f32_16x16x64_bf16 v[52:55], v[32:35], a[0:7], v44
  v_smfmac_f32_16x16x64_bf16 v[52:55], v[36:39], a[8:15], v44
  v_smfmac_f32_16x16x64_bf16 v[64:67], v[32:35], a[60:67], v44
  v_smfmac_f32_16x16x64_bf16 v[64:67], v[36:39], a[68:75], v44
  v_smfmac_f32_16x16x64_bf16 v[56:59], v[32:35], a[20:27], v44
  v_smfmac_f32_16x16x64_bf16 v[56:59], v[36:39], a[28:35], v44
  v_smfmac_f32_16x16x64_bf16 v[68:71], v[32:35], a[80:87], v44
  v_permlane32_swap_b32 v52, v64
  v_permlane32_swap_b32 v53, v65
  v_permlane32_swap_b32 v54, v66
  v_smfmac_f32_16x16x64_bf16 v[68:71], v[36:39], a[88:95], v44
  v_permlane32_swap_b32 v55, v67
  v_pk_add_f32 v[52:53], v[52:53], v[64:65]
  v_pk_add_f32 v[54:55], v[54:55], v[66:67]
  v_smfmac_f32_16x16x64_bf16 v[60:63], v[32:35], a[40:47], v44
  ds_write2_b32 v5, v52, v53 offset0:0 offset1:4
  ds_write2_b32 v5, v54, v55 offset0:8 offset1:12
  v_smfmac_f32_16x16x64_bf16 v[60:63], v[36:39], a[48:55], v44
  v_smfmac_f32_16x16x64_bf16 v[72:75], v[32:35], a[100:107], v44
  v_permlane32_swap_b32 v56, v68
  v_permlane32_swap_b32 v57, v69
  v_permlane32_swap_b32 v58, v70
  v_smfmac_f32_16x16x64_bf16 v[72:75], v[36:39], a[108:115], v44
  v_permlane32_swap_b32 v59, v71
  v_pk_add_f32 v[56:57], v[56:57], v[68:69]
  v_pk_add_f32 v[58:59], v[58:59], v[70:71]
  v_smfmac_f32_16x16x64_bf16 v[76:79], v[32:35], a[120:127], v44
  ds_write2_b32 v242, v56, v57 offset0:0 offset1:4
  ds_write2_b32 v242, v58, v59 offset0:8 offset1:12
  v_smfmac_f32_16x16x64_bf16 v[76:79], v[36:39], a[128:135], v44
  v_smfmac_f32_16x16x64_bf16 v[80:83], v[32:35], a[140:147], v44
  v_permlane32_swap_b32 v60, v72
  v_permlane32_swap_b32 v61, v73
  v_permlane32_swap_b32 v62, v74
  v_smfmac_f32_16x16x64_bf16 v[80:83], v[36:39], a[148:155], v44
  v_permlane32_swap_b32 v63, v75
  v_pk_add_f32 v[60:61], v[60:61], v[72:73]
  v_pk_add_f32 v[62:63], v[62:63], v[74:75]
  v_smfmac_f32_16x16x64_bf16 v[84:87], v[32:35], a[160:167], v44
  ds_write2_b32 v243, v60, v61 offset0:0 offset1:4
  ds_write2_b32 v243, v62, v63 offset0:8 offset1:12
  v_smfmac_f32_16x16x64_bf16 v[84:87], v[36:39], a[168:175], v44
  v_permlane32_swap_b32 v76, v80
  v_permlane32_swap_b32 v77, v81
  v_permlane32_swap_b32 v78, v82
  v_permlane32_swap_b32 v79, v83
  v_pk_add_f32 v[76:77], v[76:77], v[80:81]
  v_pk_add_f32 v[78:79], v[78:79], v[82:83]
  ds_write2_b32 v244, v76, v77 offset0:0 offset1:4
  ds_write2_b32 v244, v78, v79 offset0:8 offset1:12
  ds_write2_b32 v245, v84, v85 offset0:0 offset1:4
  ds_write2_b32 v245, v86, v87 offset0:8 offset1:12
  s_waitcnt lgkmcnt(0) vmcnt(0)
  s_barrier
  ds_read_b128 v[96:99], v45 offset:0
  ds_read_b128 v[108:111], v45 offset:5440
  ds_read_b128 v[100:103], v45 offset:1088
  ds_read_b128 v[112:115], v45 offset:6528
  ds_read_b128 v[104:107], v45 offset:2176
  ds_read_b128 v[116:119], v45 offset:7616
  s_waitcnt lgkmcnt(4)
  v_pk_add_f32 v[96:97], v[96:97], v[108:109]
  v_pk_add_f32 v[98:99], v[98:99], v[110:111]
  s_nop 0
  v_add_f32_dpp v108, v96, v96 row_ror:8 row_mask:0xf bank_mask:0xf
  v_add_f32_dpp v109, v97, v97 row_ror:8 row_mask:0xf bank_mask:0xf
  v_add_f32_dpp v110, v98, v98 row_ror:8 row_mask:0xf bank_mask:0xf
  v_add_f32_dpp v111, v99, v99 row_ror:8 row_mask:0xf bank_mask:0xf
  v_cvt_pk_bf16_f32 v212, v108, v109
  v_cvt_pk_bf16_f32 v213, v110, v111
  s_waitcnt lgkmcnt(2)
  v_pk_add_f32 v[100:101], v[100:101], v[112:113]
  v_pk_add_f32 v[102:103], v[102:103], v[114:115]
  s_nop 0
  v_add_f32_dpp v112, v100, v100 row_ror:8 row_mask:0xf bank_mask:0xf
  v_add_f32_dpp v113, v101, v101 row_ror:8 row_mask:0xf bank_mask:0xf
  v_add_f32_dpp v114, v102, v102 row_ror:8 row_mask:0xf bank_mask:0xf
  v_add_f32_dpp v115, v103, v103 row_ror:8 row_mask:0xf bank_mask:0xf
  v_cvt_pk_bf16_f32 v214, v112, v113
  v_cvt_pk_bf16_f32 v215, v114, v115
  s_waitcnt lgkmcnt(0)
  v_pk_add_f32 v[104:105], v[104:105], v[116:117]
  v_pk_add_f32 v[106:107], v[106:107], v[118:119]
  v_mfma_f32_16x16x32_bf16 v[96:99], v[168:171], v[212:215], 0
  v_add_f32_dpp v116, v104, v104 row_ror:8 row_mask:0xf bank_mask:0xf
  v_add_f32_dpp v117, v105, v105 row_ror:8 row_mask:0xf bank_mask:0xf
  v_add_f32_dpp v118, v106, v106 row_ror:8 row_mask:0xf bank_mask:0xf
  v_add_f32_dpp v119, v107, v107 row_ror:8 row_mask:0xf bank_mask:0xf
  v_cvt_pk_bf16_f32 v216, v116, v117
  v_cvt_pk_bf16_f32 v217, v118, v119
  s_nop 1
  v_mfma_f32_16x16x32_bf16 v[96:99], v[172:175], v[216:219], v[96:99]
  s_mov_b64 exec, s[74:75]
  s_nop 6
  v_cvt_pk_f16_f32 v100, v96, v97
  v_cvt_pk_f16_f32 v101, v98, v99
  v_and_or_b32 v100, v100, -2, s88
  buffer_store_dwordx2 v[100:101], v7, s[8:11], s81 offen
  s_mov_b64 exec, -1
  s_cmp_eq_u32 s52, 63
  s_cbranch_scc1 last_36
  s_sleep 5
  s_mov_b32 s54, 0
  buffer_load_dwordx2 v[248:249], v9, s[8:11], s81 offen sc1
  buffer_load_dwordx4 v[112:115], v8, s[8:11], s81 offen offset:0 sc1
  buffer_load_dwordx4 v[116:119], v8, s[8:11], s81 offen offset:1024 sc1
  s_sleep 2
  buffer_load_dwordx4 v[144:147], v10, s[8:11], s81 offen offset:0 sc1
  buffer_load_dwordx4 v[148:151], v10, s[8:11], s81 offen offset:1024 sc1
  buffer_load_dwordx4 v[152:155], v10, s[8:11], s81 offen offset:2048 sc1
  v_mov_b32 v188, 0
  v_mov_b32 v189, 0
  v_mov_b32 v190, 0
  v_mov_b32 v191, 0
  v_mov_b32 v192, 0
  v_mov_b32 v193, 0
  v_mov_b32 v194, 0
  v_mov_b32 v195, 0
  v_mov_b32 v196, 0
  v_mov_b32 v197, 0
  v_mov_b32 v198, 0
  v_mov_b32 v199, 0
  v_readfirstlane_b32 s21, v94
  s_add_u32 s22, s46, 8
  s_min_u32 s22, s22, 64
  s_sub_u32 s55, s21, s22
  s_sub_u32 s56, s21, s46
  s_waitcnt vmcnt(5)
  v_xor_b32 v96, s88, v248
  s_nop 0
  v_permlane16_swap_b32 v248, v249
  v_fma_mix_f32 v250, v248, 1.0, v249 op_sel:[0,0,0] op_sel_hi:[1,0,1]
  v_fma_mix_f32 v251, v248, 1.0, v249 op_sel:[1,0,1] op_sel_hi:[1,0,1]
  v_mov_b32 v248, v250
  v_mov_b32 v249, v251
  s_nop 0
  v_permlane32_swap_b32 v248, v250
  v_permlane32_swap_b32 v249, v251
  s_waitcnt vmcnt(3)
  v_bitop3_b32 v97, v112, v114, s88 bitop3:0x7e
  v_bitop3_b32 v98, v116, v118, s88 bitop3:0x7e
  v_fma_mix_f32 v120, v112, 1.0, v116 op_sel:[0,0,0] op_sel_hi:[1,0,1]
  v_or3_b32 v27, v96, v97, v98
  v_fma_mix_f32 v124, v114, 1.0, v118 op_sel:[0,0,0] op_sel_hi:[1,0,1]
  v_and_b32 v27, 1, v27
  v_fma_mix_f32 v121, v112, 1.0, v116 op_sel:[1,0,1] op_sel_hi:[1,0,1]
  v_cmp_ne_u32 vcc, 0, v27
  v_fma_mix_f32 v125, v114, 1.0, v118 op_sel:[1,0,1] op_sel_hi:[1,0,1]
  v_fma_mix_f32 v122, v113, 1.0, v117 op_sel:[0,0,0] op_sel_hi:[1,0,1]
  v_fma_mix_f32 v126, v115, 1.0, v119 op_sel:[0,0,0] op_sel_hi:[1,0,1]
  s_cbranch_vccnz psr_41
psj_42:
  s_cmp_lt_i32 s56, 0
  s_cbranch_scc1 kvw_44
kvok_45:
  v_fma_mix_f32 v123, v113, 1.0, v117 op_sel:[1,0,1] op_sel_hi:[1,0,1]
  v_fma_mix_f32 v127, v115, 1.0, v119 op_sel:[1,0,1] op_sel_hi:[1,0,1]
  v_permlane32_swap_b32 v120, v124
  v_permlane32_swap_b32 v121, v125
  v_permlane32_swap_b32 v122, v126
  v_permlane32_swap_b32 v123, v127
  v_pk_add_f32 v[120:121], v[120:121], v[124:125]
  v_pk_add_f32 v[122:123], v[122:123], v[126:127]
  v_pk_add_f32 v[124:125], v[248:249], v[250:251]
  v_max3_f32 v236, v120, v121, v122
  v_max3_f32 v237, v123, v124, v125
  v_max_f32 v236, v236, v237
  s_nop 1
  v_max_f32_dpp v236, v236, v236 row_ror:8 row_mask:0xf bank_mask:0xf
  v_mov_b32 v237, v236
  s_nop 1
  v_permlane32_swap_b32 v236, v237
  v_max_f32 v236, v236, v237
  v_mov_b32 v237, v236
  s_nop 1
  v_permlane16_swap_b32 v236, v237
  v_max_f32 v236, v236, v237
  s_waitcnt vmcnt(0)
  v_max3_u32 v27, v144, v146, v148
  v_max3_u32 v27, v27, v150, v152
  v_max3_u32 v27, v27, v154, v154
  v_cmp_eq_u32 vcc, -1, v27
  s_nop 1
  s_cbranch_vccnz pv_40
pvj_43:
  v_mul_f32 v236, s86, v236
  v_smfmac_f32_16x16x64_bf16 v[188:191], v[144:147], a[180:187], v44
  v_fma_f32 v120, v120, s86, -v236
  v_smfmac_f32_16x16x64_bf16 v[188:191], v[148:151], a[188:195], v44
  v_fma_f32 v121, v121, s86, -v236
  v_smfmac_f32_16x16x64_bf16 v[188:191], v[152:155], a[196:203], v44
  buffer_load_dwordx4 v[160:163], v16, s[28:31], s64 offen offset:0 sc1
  v_fma_f32 v122, v122, s86, -v236
  v_smfmac_f32_16x16x64_bf16 v[192:195], v[144:147], a[204:211], v44
  v_fma_f32 v123, v123, s86, -v236
  v_smfmac_f32_16x16x64_bf16 v[192:195], v[148:151], a[212:219], v44
  buffer_load_dwordx4 v[164:167], v16, s[28:31], s64 offen offset:1024 sc1
  v_fma_f32 v124, v124, s86, -v236
  v_smfmac_f32_16x16x64_bf16 v[192:195], v[152:155], a[220:227], v44
  v_fma_f32 v125, v125, s86, -v236
  v_smfmac_f32_16x16x64_bf16 v[196:199], v[144:147], a[228:235], v44
  buffer_load_dwordx4 v[48:51], v16, s[28:31], s64 offen offset:2048 sc1
  v_exp_f32 v120, v120
  v_smfmac_f32_16x16x64_bf16 v[196:199], v[148:151], a[236:243], v44
  v_exp_f32 v121, v121
  v_smfmac_f32_16x16x64_bf16 v[196:199], v[152:155], a[244:251], v44
  buffer_load_dwordx2 v[168:169], v18, s[16:19], s80 offen sc1
  v_exp_f32 v122, v122
  buffer_load_dwordx2 v[170:171], v19, s[16:19], s80 offen sc1
  v_exp_f32 v123, v123
  buffer_load_dwordx2 v[172:173], v20, s[16:19], s80 offen sc1
  v_exp_f32 v124, v124
  s_cmp_lt_i32 s55, 0
  s_cbranch_scc1 fl_46
fl_47:
  v_exp_f32 v125, v125
  s_mov_b64 exec, s[60:61]
  v_cvt_pk_bf16_f32 v220, v120, v121
  v_cvt_pk_bf16_f32 v221, v122, v123
  v_cvt_pk_bf16_f32 v224, v124, v125
  s_mov_b64 exec, s[62:63]
  v_cvt_pk_bf16_f32 v222, v120, v121
  v_cvt_pk_bf16_f32 v223, v122, v123
  v_cvt_pk_bf16_f32 v225, v124, v125
  s_mov_b64 exec, -1
  v_pk_add_f32 v[126:127], v[120:121], v[122:123]
  v_add_f32 v128, v124, v125
  v_mfma_f32_16x16x32_bf16 v[200:203], v[176:179], v[220:223], 0
  v_add_f32 v236, v126, v127
  v_fmac_f32 v236, v128, v89
  v_cvt_pk_bf16_f32 v228, v188, v189
  v_cvt_pk_bf16_f32 v229, v190, v191
  v_mfma_f32_16x16x32_bf16 v[204:207], v[180:183], v[220:223], 0
  v_cvt_pk_bf16_f32 v230, v192, v193
  v_cvt_pk_bf16_f32 v231, v194, v195
  v_mfma_f32_16x16x32_bf16 v[208:211], v[184:187], v[220:223], 0
  v_cvt_pk_bf16_f32 v232, v196, v197
  v_cvt_pk_bf16_f32 v233, v198, v199
  v_add_f32_dpp v236, v236, v236 row_ror:8 row_mask:0xf bank_mask:0xf
  v_mov_b32 v237, v236
  s_nop 0
  v_mfma_f32_16x16x32_bf16 v[200:203], v[228:231], v[224:227], v[200:203]
  v_mfma_f32_16x16x32_bf16 v[204:207], v[230:233], v[224:227], v[204:207]
  v_permlane32_swap_b32 v236, v237
  v_add_f32 v236, v236, v237
  v_mov_b32 v237, v236
  v_mfma_f32_16x16x32_bf16 v[208:211], v[232:235], v[224:227], v[208:211]
  s_nop 0
  v_permlane16_swap_b32 v236, v237
  v_add_f32 v236, v236, v237
  v_rcp_f32 v236, v236
  s_nop 2
  v_pk_mul_f32 v[200:201], v[200:201], v[236:237] op_sel_hi:[1,0]
  v_pk_mul_f32 v[202:203], v[202:203], v[236:237] op_sel_hi:[1,0]
  ds_write_b128 v11, v[200:203] offset:0
  v_pk_mul_f32 v[204:205], v[204:205], v[236:237] op_sel_hi:[1,0]
  v_pk_mul_f32 v[206:207], v[206:207], v[236:237] op_sel_hi:[1,0]
  ds_write_b128 v11, v[204:207] offset:1024
  v_pk_mul_f32 v[208:209], v[208:209], v[236:237] op_sel_hi:[1,0]
  v_pk_mul_f32 v[210:211], v[210:211], v[236:237] op_sel_hi:[1,0]
  ds_write_b128 v11, v[208:211] offset:2048
  s_waitcnt lgkmcnt(0)
  s_barrier
  ds_read_b64 v[96:97], v12 offset:0
  ds_read_b64 v[98:99], v12 offset:128
  ds_read_b64 v[100:101], v12 offset:3072
  ds_read_b64 v[102:103], v12 offset:3200
  ds_read_b64 v[104:105], v12 offset:6144
  ds_read_b64 v[106:107], v12 offset:6272
  ds_read_b64 v[108:109], v12 offset:9216
  ds_read_b64 v[110:111], v12 offset:9344
  s_waitcnt lgkmcnt(6)
  v_pk_add_f32 v[96:97], v[96:97], v[98:99]
  s_waitcnt lgkmcnt(4)
  v_pk_add_f32 v[100:101], v[100:101], v[102:103]
  s_waitcnt lgkmcnt(2)
  v_pk_add_f32 v[104:105], v[104:105], v[106:107]
  v_pk_add_f32 v[96:97], v[96:97], v[100:101]
  s_waitcnt lgkmcnt(0)
  v_pk_add_f32 v[108:109], v[108:109], v[110:111]
  v_pk_add_f32 v[96:97], v[96:97], v[104:105]
  v_pk_add_f32 v[96:97], v[96:97], v[108:109]
  v_cvt_pk_f16_f32 v100, v96, v97
  v_perm_b32 v100, s91, v100, v14
  buffer_atomic_pk_add_f16 v100, v13, s[4:7], s3 offen
  s_add_u32 s64, s64, 1310720
  s_add_u32 s52, s52, 1
  s_and_b32 s21, s52, 3
  s_mul_i32 s81, s21, 540672
  s_lshl_b32 s84, s21, 15
  s_branch step_35
pm_37:
  s_mov_b32 s47, 1
  buffer_load_dwordx4 v[96:99], v4, s[4:7], s84 offen offset:0 sc1
  buffer_load_dwordx4 v[100:103], v4, s[4:7], s84 offen offset:1024 sc1
  buffer_load_dwordx4 v[104:107], v4, s[4:7], s84 offen offset:2048 sc1
  s_add_u32 s54, s54, 1
  s_cmp_gt_u32 s54, 131072
  s_cbranch_scc1 end0
  s_waitcnt vmcnt(0)
  v_bitop3_b32 v27, v99, v103, v107 bitop3:0x80
  v_cvt_f32_f16 v108, v99
  v_and_b32 v27, 0x48000000, v27
  v_cvt_f32_f16 v109, v103
  v_cmp_ne_u32 vcc, 0x48000000, v27
  v_cvt_f32_f16 v110, v106
  v_cvt_f32_f16_sdwa v111, v106 dst_sel:DWORD dst_unused:UNUSED_PAD src0_sel:WORD_1
  v_cvt_pk_bf16_f32 v40, v110, v111
  s_cbranch_vccnz pm_37
  s_branch pm_38
A1_15:
  v_smfmac_f32_16x16x32_bf16 v[52:55], v[40:41], a[16:19], v44
  v_smfmac_f32_16x16x32_bf16 v[64:67], v[40:41], a[76:79], v44
  v_smfmac_f32_16x16x32_bf16 v[56:59], v[40:41], a[36:39], v44
  v_smfmac_f32_16x16x32_bf16 v[68:71], v[40:41], a[96:99], v44
  v_smfmac_f32_16x16x32_bf16 v[60:63], v[40:41], a[56:59], v44
  v_smfmac_f32_16x16x32_bf16 v[72:75], v[40:41], a[116:119], v44
  v_smfmac_f32_16x16x32_bf16 v[76:79], v[40:41], a[136:139], v44
  v_smfmac_f32_16x16x32_bf16 v[80:83], v[40:41], a[156:159], v44
  v_smfmac_f32_16x16x32_bf16 v[84:87], v[40:41], a[176:179], v44
  s_branch A2_39
pv_40:
  buffer_load_dwordx4 v[144:147], v10, s[8:11], s81 offen offset:0 sc1
  buffer_load_dwordx4 v[148:151], v10, s[8:11], s81 offen offset:1024 sc1
  buffer_load_dwordx4 v[152:155], v10, s[8:11], s81 offen offset:2048 sc1
  s_add_u32 s54, s54, 1
  s_cmp_gt_u32 s54, 131072
  s_cbranch_scc1 end0
  s_waitcnt vmcnt(0)
  v_max3_u32 v27, v144, v146, v148
  v_max3_u32 v27, v27, v150, v152
  v_max3_u32 v27, v27, v154, v154
  v_cmp_eq_u32 vcc, -1, v27
  s_nop 1
  s_cbranch_vccnz pv_40
  s_branch pvj_43
psr_41:
  buffer_load_dwordx2 v[248:249], v9, s[8:11], s81 offen sc1
  buffer_load_dwordx4 v[112:115], v8, s[8:11], s81 offen offset:0 sc1
  buffer_load_dwordx4 v[116:119], v8, s[8:11], s81 offen offset:1024 sc1
  s_add_u32 s54, s54, 1
  s_cmp_gt_u32 s54, 131072
  s_cbranch_scc1 end0
  s_waitcnt vmcnt(2)
  v_xor_b32 v96, s88, v248
  s_nop 0
  v_permlane16_swap_b32 v248, v249
  v_fma_mix_f32 v250, v248, 1.0, v249 op_sel:[0,0,0] op_sel_hi:[1,0,1]
  v_fma_mix_f32 v251, v248, 1.0, v249 op_sel:[1,0,1] op_sel_hi:[1,0,1]
  v_mov_b32 v248, v250
  v_mov_b32 v249, v251
  s_nop 0
  v_permlane32_swap_b32 v248, v250
  v_permlane32_swap_b32 v249, v251
  s_waitcnt vmcnt(0)
  v_bitop3_b32 v97, v112, v114, s88 bitop3:0x7e
  v_bitop3_b32 v98, v116, v118, s88 bitop3:0x7e
  v_fma_mix_f32 v120, v112, 1.0, v116 op_sel:[0,0,0] op_sel_hi:[1,0,1]
  v_or3_b32 v27, v96, v97, v98
  v_fma_mix_f32 v124, v114, 1.0, v118 op_sel:[0,0,0] op_sel_hi:[1,0,1]
  v_and_b32 v27, 1, v27
  v_fma_mix_f32 v121, v112, 1.0, v116 op_sel:[1,0,1] op_sel_hi:[1,0,1]
  v_cmp_ne_u32 vcc, 0, v27
  v_fma_mix_f32 v125, v114, 1.0, v118 op_sel:[1,0,1] op_sel_hi:[1,0,1]
  v_fma_mix_f32 v122, v113, 1.0, v117 op_sel:[0,0,0] op_sel_hi:[1,0,1]
  v_fma_mix_f32 v126, v115, 1.0, v119 op_sel:[0,0,0] op_sel_hi:[1,0,1]
  s_cbranch_vccnz psr_41
  s_branch psj_42
kvw_44:
  s_cmp_eq_u32 s52, 0
  s_cselect_b32 s23, 1, s46
  s_cselect_b32 s55, 0, s55
  v_mov_b32 v236, 0
  s_mov_b32 s101, 0
wf_48:
  buffer_load_dword v237, v236, s[12:15], s79 offen sc1
  s_add_u32 s101, s101, 1
  s_cmp_gt_u32 s101, 131072
  s_cbranch_scc1 end0
  s_waitcnt vmcnt(0)
  v_readfirstlane_b32 s100, v237
  s_cmp_ge_u32 s100, s23
  s_cbranch_scc1 wf_49
  s_sleep 3
  s_branch wf_48
wf_49:
  s_cmp_gt_u32 s52, 1
  s_cbranch_scc1 kvok_45
  s_sub_u32 s21, s64, 1310720
  buffer_load_dwordx4 v[176:179], v16, s[28:31], s21 offen offset:0 sc1
  buffer_load_dwordx4 v[180:183], v16, s[28:31], s21 offen offset:1024 sc1
  buffer_load_dwordx4 v[184:187], v16, s[28:31], s21 offen offset:2048 sc1
  s_waitcnt vmcnt(0)
  s_branch kvok_45
fl_46:
  buffer_load_dword v94, v95, s[12:15], s79 offen sc1
  s_branch fl_47
last_36:
  s_branch chain_done
step_50:
  s_add_u32 s21, s52, 2
  s_and_b32 s21, s21, 3
  s_mul_i32 s82, s21, 540672
  s_add_u32 s21, s52, 3
  s_and_b32 s21, s21, 3
  s_lshl_b32 s83, s21, 15
  s_add_u32 s21, s52, 1
  s_and_b32 s22, s21, 3
  s_lshl_b32 s3, s22, 15
  s_mul_i32 s80, s21, 393216
  s_add_u32 s46, s21, 1
  s_min_u32 s46, s46, 64
  s_mul_i32 s85, s52, 98304
  s_add_u32 s57, s85, 6291456
  s_bfe_u32 s88, s52, 0x10002
  s_add_u32 s78, s81, 278528
  v_mov_b32 v52, 0
  v_mov_b32 v53, 0
  v_mov_b32 v54, 0
  v_mov_b32 v55, 0
  v_mov_b32 v56, 0
  v_mov_b32 v57, 0
  v_mov_b32 v58, 0
  v_mov_b32 v59, 0
  v_mov_b32 v60, 0
  v_mov_b32 v61, 0
  v_mov_b32 v62, 0
  v_mov_b32 v63, 0
  v_mov_b32 v64, 0
  v_mov_b32 v65, 0
  v_mov_b32 v66, 0
  v_mov_b32 v67, 0
  v_mov_b32 v68, 0
  v_mov_b32 v69, 0
  v_mov_b32 v70, 0
  v_mov_b32 v71, 0
  v_mov_b32 v72, 0
  v_mov_b32 v73, 0
  v_mov_b32 v74, 0
  v_mov_b32 v75, 0
  v_mov_b32 v76, 0
  v_mov_b32 v77, 0
  v_mov_b32 v78, 0
  v_mov_b32 v79, 0
  v_mov_b32 v80, 0
  v_mov_b32 v81, 0
  v_mov_b32 v82, 0
  v_mov_b32 v83, 0
  v_mov_b32 v84, 0
  v_mov_b32 v85, 0
  v_mov_b32 v86, 0
  v_mov_b32 v87, 0
  s_sleep 9
  s_mov_b32 s54, 0
  buffer_load_dwordx4 v[96:99], v4, s[4:7], s84 offen offset:0 sc1
  buffer_load_dwordx4 v[100:103], v4, s[4:7], s84 offen offset:1024 sc1
  buffer_load_dwordx4 v[104:107], v4, s[4:7], s84 offen offset:2048 sc1
  s_waitcnt vmcnt(3)
  v_mov_b32 v176, v160
  v_mov_b32 v177, v161
  v_mov_b32 v178, v162
  v_mov_b32 v179, v163
  v_mov_b32 v180, v164
  v_mov_b32 v181, v165
  v_mov_b32 v182, v166
  v_mov_b32 v183, v167
  v_mov_b32 v184, v48
  v_mov_b32 v185, v49
  v_mov_b32 v186, v50
  v_mov_b32 v187, v51
  s_waitcnt vmcnt(0)
  v_bitop3_b32 v27, v99, v103, v107 bitop3:0x80
  v_cvt_f32_f16 v108, v99
  v_and_b32 v27, 0x48000000, v27
  v_cvt_f32_f16 v109, v103
  v_cmp_ne_u32 vcc, 0x48000000, v27
  v_cvt_f32_f16 v110, v106
  v_cvt_f32_f16_sdwa v111, v106 dst_sel:DWORD dst_unused:UNUSED_PAD src0_sel:WORD_1
  v_cvt_pk_bf16_f32 v40, v110, v111
  s_cbranch_vccnz pm_52
pm_53:
  v_cvt_pk_bf16_f32 v41, v108, v109
  v_cvt_f32_f16 v110, v96
  v_cvt_f32_f16_sdwa v111, v96 dst_sel:DWORD dst_unused:UNUSED_PAD src0_sel:WORD_1
  v_smfmac_f32_16x16x32_bf16 v[52:55], v[40:41], a[16:19], v44
  v_cvt_f32_f16 v112, v97
  v_cvt_f32_f16_sdwa v113, v97 dst_sel:DWORD dst_unused:UNUSED_PAD src0_sel:WORD_1
  v_cvt_pk_bf16_f32 v32, v110, v111
  v_smfmac_f32_16x16x32_bf16 v[64:67], v[40:41], a[76:79], v44
  v_cvt_pk_bf16_f32 v33, v112, v113
  v_cvt_f32_f16 v114, v98
  v_cvt_f32_f16_sdwa v115, v98 dst_sel:DWORD dst_unused:UNUSED_PAD src0_sel:WORD_1
  v_smfmac_f32_16x16x32_bf16 v[56:59], v[40:41], a[36:39], v44
  v_cvt_f32_f16 v116, v100
  v_cvt_f32_f16_sdwa v117, v100 dst_sel:DWORD dst_unused:UNUSED_PAD src0_sel:WORD_1
  v_cvt_pk_bf16_f32 v34, v114, v115
  v_smfmac_f32_16x16x32_bf16 v[68:71], v[40:41], a[96:99], v44
  v_cvt_pk_bf16_f32 v35, v116, v117
  v_cvt_f32_f16 v110, v101
  v_cvt_f32_f16_sdwa v111, v101 dst_sel:DWORD dst_unused:UNUSED_PAD src0_sel:WORD_1
  v_smfmac_f32_16x16x32_bf16 v[60:63], v[40:41], a[56:59], v44
  v_cvt_f32_f16 v112, v102
  v_cvt_f32_f16_sdwa v113, v102 dst_sel:DWORD dst_unused:UNUSED_PAD src0_sel:WORD_1
  v_smfmac_f32_16x16x32_bf16 v[72:75], v[40:41], a[116:119], v44
  v_cvt_pk_bf16_f32 v36, v110, v111
  v_cvt_pk_bf16_f32 v37, v112, v113
  v_smfmac_f32_16x16x32_bf16 v[76:79], v[40:41], a[136:139], v44
  v_cvt_f32_f16 v114, v104
  v_cvt_f32_f16_sdwa v115, v104 dst_sel:DWORD dst_unused:UNUSED_PAD src0_sel:WORD_1
  v_smfmac_f32_16x16x32_bf16 v[80:83], v[40:41], a[156:159], v44
  v_cvt_f32_f16 v116, v105
  v_cvt_f32_f16_sdwa v117, v105 dst_sel:DWORD dst_unused:UNUSED_PAD src0_sel:WORD_1
  v_smfmac_f32_16x16x32_bf16 v[84:87], v[40:41], a[176:179], v44
  v_cvt_pk_bf16_f32 v38, v114, v115
  v_cvt_pk_bf16_f32 v39, v116, v117
A2_54:
  v_smfmac_f32_16x16x64_bf16 v[52:55], v[32:35], a[0:7], v44
  v_smfmac_f32_16x16x64_bf16 v[52:55], v[36:39], a[8:15], v44
  v_smfmac_f32_16x16x64_bf16 v[64:67], v[32:35], a[60:67], v44
  v_smfmac_f32_16x16x64_bf16 v[64:67], v[36:39], a[68:75], v44
  v_smfmac_f32_16x16x64_bf16 v[56:59], v[32:35], a[20:27], v44
  v_smfmac_f32_16x16x64_bf16 v[56:59], v[36:39], a[28:35], v44
  v_smfmac_f32_16x16x64_bf16 v[68:71], v[32:35], a[80:87], v44
  v_permlane32_swap_b32 v52, v64
  v_permlane32_swap_b32 v53, v65
  v_permlane32_swap_b32 v54, v66
  v_smfmac_f32_16x16x64_bf16 v[68:71], v[36:39], a[88:95], v44
  v_permlane32_swap_b32 v55, v67
  v_pk_add_f32 v[52:53], v[52:53], v[64:65]
  v_pk_add_f32 v[54:55], v[54:55], v[66:67]
  v_smfmac_f32_16x16x64_bf16 v[60:63], v[32:35], a[40:47], v44
  ds_write2_b32 v5, v52, v53 offset0:0 offset1:4
  ds_write2_b32 v5, v54, v55 offset0:8 offset1:12
  v_smfmac_f32_16x16x64_bf16 v[60:63], v[36:39], a[48:55], v44
  v_smfmac_f32_16x16x64_bf16 v[72:75], v[32:35], a[100:107], v44
  v_permlane32_swap_b32 v56, v68
  v_permlane32_swap_b32 v57, v69
  v_permlane32_swap_b32 v58, v70
  v_smfmac_f32_16x16x64_bf16 v[72:75], v[36:39], a[108:115], v44
  v_permlane32_swap_b32 v59, v71
  v_pk_add_f32 v[56:57], v[56:57], v[68:69]
  v_pk_add_f32 v[58:59], v[58:59], v[70:71]
  v_smfmac_f32_16x16x64_bf16 v[76:79], v[32:35], a[120:127], v44
  ds_write2_b32 v242, v56, v57 offset0:0 offset1:4
  ds_write2_b32 v242, v58, v59 offset0:8 offset1:12
  v_smfmac_f32_16x16x64_bf16 v[76:79], v[36:39], a[128:135], v44
  v_smfmac_f32_16x16x64_bf16 v[80:83], v[32:35], a[140:147], v44
  v_permlane32_swap_b32 v60, v72
  v_permlane32_swap_b32 v61, v73
  v_permlane32_swap_b32 v62, v74
  v_smfmac_f32_16x16x64_bf16 v[80:83], v[36:39], a[148:155], v44
  v_permlane32_swap_b32 v63, v75
  v_pk_add_f32 v[60:61], v[60:61], v[72:73]
  v_pk_add_f32 v[62:63], v[62:63], v[74:75]
  v_smfmac_f32_16x16x64_bf16 v[84:87], v[32:35], a[160:167], v44
  ds_write2_b32 v243, v60, v61 offset0:0 offset1:4
  ds_write2_b32 v243, v62, v63 offset0:8 offset1:12
  v_smfmac_f32_16x16x64_bf16 v[84:87], v[36:39], a[168:175], v44
  v_permlane32_swap_b32 v76, v80
  v_permlane32_swap_b32 v77, v81
  v_permlane32_swap_b32 v78, v82
  v_permlane32_swap_b32 v79, v83
  v_pk_add_f32 v[76:77], v[76:77], v[80:81]
  v_pk_add_f32 v[78:79], v[78:79], v[82:83]
  ds_write2_b32 v244, v76, v77 offset0:0 offset1:4
  ds_write2_b32 v244, v78, v79 offset0:8 offset1:12
  ds_write2_b32 v245, v84, v85 offset0:0 offset1:4
  ds_write2_b32 v245, v86, v87 offset0:8 offset1:12
  s_waitcnt lgkmcnt(0) vmcnt(0)
  s_barrier
  ds_read_b128 v[96:99], v6 offset:0
  ds_read_b128 v[108:111], v6 offset:5440
  ds_read_b128 v[120:123], v6 offset:10880
  ds_read_b128 v[132:135], v6 offset:16320
  ds_read_b128 v[100:103], v6 offset:1088
  ds_read_b128 v[112:115], v6 offset:6528
  ds_read_b128 v[124:127], v6 offset:11968
  ds_read_b128 v[136:139], v6 offset:17408
  ds_read_b128 v[104:107], v6 offset:2176
  ds_read_b128 v[116:119], v6 offset:7616
  ds_read_b128 v[128:131], v6 offset:13056
  ds_read_b128 v[140:143], v6 offset:18496
  s_waitcnt lgkmcnt(8)
  v_pk_add_f32 v[96:97], v[96:97], v[108:109]
  v_pk_add_f32 v[120:121], v[120:121], v[132:133]
  v_pk_add_f32 v[98:99], v[98:99], v[110:111]
  v_pk_add_f32 v[122:123], v[122:123], v[134:135]
  v_pk_add_f32 v[96:97], v[96:97], v[120:121]
  v_pk_add_f32 v[98:99], v[98:99], v[122:123]
  v_cvt_pk_bf16_f32 v212, v96, v97
  v_cvt_pk_bf16_f32 v213, v98, v99
  s_waitcnt lgkmcnt(4)
  v_pk_add_f32 v[100:101], v[100:101], v[112:113]
  v_pk_add_f32 v[124:125], v[124:125], v[136:137]
  v_pk_add_f32 v[102:103], v[102:103], v[114:115]
  v_pk_add_f32 v[126:127], v[126:127], v[138:139]
  v_pk_add_f32 v[100:101], v[100:101], v[124:125]
  v_pk_add_f32 v[102:103], v[102:103], v[126:127]
  v_cvt_pk_bf16_f32 v214, v100, v101
  v_cvt_pk_bf16_f32 v215, v102, v103
  s_waitcnt lgkmcnt(0)
  v_pk_add_f32 v[104:105], v[104:105], v[116:117]
  v_pk_add_f32 v[128:129], v[128:129], v[140:141]
  v_pk_add_f32 v[106:107], v[106:107], v[118:119]
  v_pk_add_f32 v[130:131], v[130:131], v[142:143]
  v_mfma_f32_16x16x32_bf16 v[96:99], v[212:215], v[212:215], 0
  v_pk_add_f32 v[104:105], v[104:105], v[128:129]
  v_pk_add_f32 v[106:107], v[106:107], v[130:131]
  v_cvt_pk_bf16_f32 v216, v104, v105
  v_cvt_pk_bf16_f32 v217, v106, v107
  s_nop 1
  v_mfma_f32_16x16x32_bf16 v[96:99], v[216:219], v[216:219], v[96:99]
  s_mov_b64 exec, s[74:75]
  s_nop 6
  v_cvt_pk_f16_f32 v100, v96, v97
  v_cvt_pk_f16_f32 v101, v98, v99
  v_and_or_b32 v100, v100, -2, s88
  buffer_store_dwordx2 v[100:101], v7, s[8:11], s81 offen
  s_mov_b64 exec, -1
  s_cmp_eq_u32 s52, 63
  s_cbranch_scc1 last_51
  s_sleep 4
  s_mov_b32 s54, 0
  buffer_load_dwordx2 v[248:249], v9, s[8:11], s81 offen sc1
  buffer_load_dwordx4 v[112:115], v8, s[8:11], s81 offen offset:0 sc1
  buffer_load_dwordx4 v[116:119], v8, s[8:11], s81 offen offset:1024 sc1
  s_sleep 2
  buffer_load_dwordx4 v[144:147], v10, s[8:11], s81 offen offset:0 sc1
  buffer_load_dwordx4 v[148:151], v10, s[8:11], s81 offen offset:1024 sc1
  buffer_load_dwordx4 v[152:155], v10, s[8:11], s81 offen offset:2048 sc1
  v_mov_b32 v188, 0
  v_mov_b32 v189, 0
  v_mov_b32 v190, 0
  v_mov_b32 v191, 0
  v_mov_b32 v192, 0
  v_mov_b32 v193, 0
  v_mov_b32 v194, 0
  v_mov_b32 v195, 0
  v_mov_b32 v196, 0
  v_mov_b32 v197, 0
  v_mov_b32 v198, 0
  v_mov_b32 v199, 0
  v_readfirstlane_b32 s21, v94
  s_add_u32 s22, s46, 8
  s_min_u32 s22, s22, 64
  s_sub_u32 s55, s21, s22
  s_sub_u32 s56, s21, s46
  s_waitcnt vmcnt(5)
  v_xor_b32 v96, s88, v248
  s_nop 0
  v_permlane16_swap_b32 v248, v249
  v_fma_mix_f32 v250, v248, 1.0, v249 op_sel:[0,0,0] op_sel_hi:[1,0,1]
  v_fma_mix_f32 v251, v248, 1.0, v249 op_sel:[1,0,1] op_sel_hi:[1,0,1]
  v_mov_b32 v248, v250
  v_mov_b32 v249, v251
  s_nop 0
  v_permlane32_swap_b32 v248, v250
  v_permlane32_swap_b32 v249, v251
  s_waitcnt vmcnt(3)
  v_bitop3_b32 v97, v112, v114, s88 bitop3:0x7e
  v_bitop3_b32 v98, v116, v118, s88 bitop3:0x7e
  v_fma_mix_f32 v120, v112, 1.0, v116 op_sel:[0,0,0] op_sel_hi:[1,0,1]
  v_or3_b32 v27, v96, v97, v98
  v_fma_mix_f32 v124, v114, 1.0, v118 op_sel:[0,0,0] op_sel_hi:[1,0,1]
  v_and_b32 v27, 1, v27
  v_fma_mix_f32 v121, v112, 1.0, v116 op_sel:[1,0,1] op_sel_hi:[1,0,1]
  v_cmp_ne_u32 vcc, 0, v27
  v_fma_mix_f32 v125, v114, 1.0, v118 op_sel:[1,0,1] op_sel_hi:[1,0,1]
  v_fma_mix_f32 v122, v113, 1.0, v117 op_sel:[0,0,0] op_sel_hi:[1,0,1]
  v_fma_mix_f32 v126, v115, 1.0, v119 op_sel:[0,0,0] op_sel_hi:[1,0,1]
  s_cbranch_vccnz psr_56
psj_57:
  s_cmp_lt_i32 s56, 0
  s_cbranch_scc1 kvw_59
kvok_60:
  v_fma_mix_f32 v123, v113, 1.0, v117 op_sel:[1,0,1] op_sel_hi:[1,0,1]
  v_fma_mix_f32 v127, v115, 1.0, v119 op_sel:[1,0,1] op_sel_hi:[1,0,1]
  v_permlane32_swap_b32 v120, v124
  v_permlane32_swap_b32 v121, v125
  v_permlane32_swap_b32 v122, v126
  v_permlane32_swap_b32 v123, v127
  v_pk_add_f32 v[120:121], v[120:121], v[124:125]
  v_pk_add_f32 v[122:123], v[122:123], v[126:127]
  v_pk_add_f32 v[124:125], v[248:249], v[250:251]
  v_max3_f32 v236, v120, v121, v122
  v_max3_f32 v237, v123, v124, v125
  v_max_f32 v236, v236, v237
  s_nop 1
  v_max_f32_dpp v236, v236, v236 row_ror:8 row_mask:0xf bank_mask:0xf
  v_mov_b32 v237, v236
  s_nop 1
  v_permlane32_swap_b32 v236, v237
  v_max_f32 v236, v236, v237
  v_mov_b32 v237, v236
  s_nop 1
  v_permlane16_swap_b32 v236, v237
  v_max_f32 v236, v236, v237
  s_waitcnt vmcnt(0)
  v_max3_u32 v27, v144, v146, v148
  v_max3_u32 v27, v27, v150, v152
  v_max3_u32 v27, v27, v154, v154
  v_cmp_eq_u32 vcc, -1, v27
  s_nop 1
  s_cbranch_vccnz pv_55
pvj_58:
  v_mul_f32 v236, s86, v236
  v_smfmac_f32_16x16x64_bf16 v[188:191], v[144:147], a[180:187], v44
  v_fma_f32 v120, v120, s86, -v236
  v_smfmac_f32_16x16x64_bf16 v[188:191], v[148:151], a[188:195], v44
  v_fma_f32 v121, v121, s86, -v236
  v_smfmac_f32_16x16x64_bf16 v[188:191], v[152:155], a[196:203], v44
  buffer_load_dwordx4 v[160:163], v16, s[28:31], s64 offen offset:0 sc1
  v_fma_f32 v122, v122, s86, -v236
  v_smfmac_f32_16x16x64_bf16 v[192:195], v[144:147], a[204:211], v44
  v_fma_f32 v123, v123, s86, -v236
  v_smfmac_f32_16x16x64_bf16 v[192:195], v[148:151], a[212:219], v44
  buffer_load_dwordx4 v[164:167], v16, s[28:31], s64 offen offset:1024 sc1
  v_fma_f32 v124, v124, s86, -v236
  v_smfmac_f32_16x16x64_bf16 v[192:195], v[152:155], a[220:227], v44
  v_fma_f32 v125, v125, s86, -v236
  v_smfmac_f32_16x16x64_bf16 v[196:199], v[144:147], a[228:235], v44
  buffer_load_dwordx4 v[48:51], v16, s[28:31], s64 offen offset:2048 sc1
  v_exp_f32 v120, v120
  v_smfmac_f32_16x16x64_bf16 v[196:199], v[148:151], a[236:243], v44
  v_exp_f32 v121, v121
  v_smfmac_f32_16x16x64_bf16 v[196:199], v[152:155], a[244:251], v44
  s_mov_b64 exec, s[62:63]
  buffer_store_dwordx2 v[212:213], v21, s[24:27], s85 offen sc1
  s_mov_b64 exec, -1
  v_exp_f32 v122, v122
  s_mov_b64 exec, s[62:63]
  buffer_store_dwordx2 v[214:215], v22, s[24:27], s85 offen sc1
  s_mov_b64 exec, -1
  v_exp_f32 v123, v123
  s_mov_b64 exec, s[62:63]
  buffer_store_dwordx2 v[216:217], v23, s[24:27], s85 offen sc1
  s_mov_b64 exec, -1
  v_exp_f32 v124, v124
  s_cmp_lt_i32 s55, 0
  s_cbranch_scc1 fl_61
fl_62:
  v_exp_f32 v125, v125
  s_mov_b64 exec, s[60:61]
  v_cvt_pk_bf16_f32 v220, v120, v121
  v_cvt_pk_bf16_f32 v221, v122, v123
  v_cvt_pk_bf16_f32 v224, v124, v125
  s_mov_b64 exec, s[62:63]
  v_cvt_pk_bf16_f32 v222, v120, v121
  v_cvt_pk_bf16_f32 v223, v122, v123
  v_cvt_pk_bf16_f32 v225, v124, v125
  s_mov_b64 exec, -1
  v_pk_add_f32 v[126:127], v[120:121], v[122:123]
  v_add_f32 v128, v124, v125
  v_mfma_f32_16x16x32_bf16 v[200:203], v[176:179], v[220:223], 0
  v_add_f32 v236, v126, v127
  v_fmac_f32 v236, v128, v89
  v_cvt_pk_bf16_f32 v228, v188, v189
  v_cvt_pk_bf16_f32 v229, v190, v191
  v_mfma_f32_16x16x32_bf16 v[204:207], v[180:183], v[220:223], 0
  v_cvt_pk_bf16_f32 v230, v192, v193
  v_cvt_pk_bf16_f32 v231, v194, v195
  v_mfma_f32_16x16x32_bf16 v[208:211], v[184:187], v[220:223], 0
  v_cvt_pk_bf16_f32 v232, v196, v197
  v_cvt_pk_bf16_f32 v233, v198, v199
  v_add_f32_dpp v236, v236, v236 row_ror:8 row_mask:0xf bank_mask:0xf
  v_mov_b32 v237, v236
  s_nop 0
  v_mfma_f32_16x16x32_bf16 v[200:203], v[228:231], v[224:227], v[200:203]
  v_mfma_f32_16x16x32_bf16 v[204:207], v[230:233], v[224:227], v[204:207]
  v_permlane32_swap_b32 v236, v237
  v_add_f32 v236, v236, v237
  v_mov_b32 v237, v236
  v_mfma_f32_16x16x32_bf16 v[208:211], v[232:235], v[224:227], v[208:211]
  s_nop 0
  v_permlane16_swap_b32 v236, v237
  v_add_f32 v236, v236, v237
  v_rcp_f32 v236, v236
  s_nop 2
  v_pk_mul_f32 v[200:201], v[200:201], v[236:237] op_sel_hi:[1,0]
  v_pk_mul_f32 v[202:203], v[202:203], v[236:237] op_sel_hi:[1,0]
  ds_write_b128 v11, v[200:203] offset:0
  v_pk_mul_f32 v[204:205], v[204:205], v[236:237] op_sel_hi:[1,0]
  v_pk_mul_f32 v[206:207], v[206:207], v[236:237] op_sel_hi:[1,0]
  ds_write_b128 v11, v[204:207] offset:1024
  v_pk_mul_f32 v[208:209], v[208:209], v[236:237] op_sel_hi:[1,0]
  v_pk_mul_f32 v[210:211], v[210:211], v[236:237] op_sel_hi:[1,0]
  ds_write_b128 v11, v[208:211] offset:2048
  s_waitcnt lgkmcnt(0)
  s_barrier
  ds_read_b64 v[96:97], v12 offset:0
  ds_read_b64 v[98:99], v12 offset:128
  ds_read_b64 v[100:101], v12 offset:3072
  ds_read_b64 v[102:103], v12 offset:3200
  ds_read_b64 v[104:105], v12 offset:6144
  ds_read_b64 v[106:107], v12 offset:6272
  ds_read_b64 v[108:109], v12 offset:9216
  ds_read_b64 v[110:111], v12 offset:9344
  s_waitcnt lgkmcnt(6)
  v_pk_add_f32 v[96:97], v[96:97], v[98:99]
  s_waitcnt lgkmcnt(4)
  v_pk_add_f32 v[100:101], v[100:101], v[102:103]
  s_waitcnt lgkmcnt(2)
  v_pk_add_f32 v[104:105], v[104:105], v[106:107]
  v_pk_add_f32 v[96:97], v[96:97], v[100:101]
  s_waitcnt lgkmcnt(0)
  v_pk_add_f32 v[108:109], v[108:109], v[110:111]
  v_pk_add_f32 v[96:97], v[96:97], v[104:105]
  v_pk_add_f32 v[96:97], v[96:97], v[108:109]
  v_cvt_pk_f16_f32 v100, v96, v97
  v_perm_b32 v100, s91, v100, v14
  buffer_atomic_pk_add_f16 v100, v13, s[4:7], s3 offen
  s_add_u32 s64, s64, 1310720
  s_add_u32 s52, s52, 1
  s_and_b32 s21, s52, 3
  s_mul_i32 s81, s21, 540672
  s_lshl_b32 s84, s21, 15
  s_branch step_50
pm_52:
  s_mov_b32 s47, 1
  buffer_load_dwordx4 v[96:99], v4, s[4:7], s84 offen offset:0 sc1
  buffer_load_dwordx4 v[100:103], v4, s[4:7], s84 offen offset:1024 sc1
  buffer_load_dwordx4 v[104:107], v4, s[4:7], s84 offen offset:2048 sc1
  s_add_u32 s54, s54, 1
  s_cmp_gt_u32 s54, 131072
  s_cbranch_scc1 end0
  s_waitcnt vmcnt(0)
  v_bitop3_b32 v27, v99, v103, v107 bitop3:0x80
  v_cvt_f32_f16 v108, v99
  v_and_b32 v27, 0x48000000, v27
  v_cvt_f32_f16 v109, v103
  v_cmp_ne_u32 vcc, 0x48000000, v27
  v_cvt_f32_f16 v110, v106
  v_cvt_f32_f16_sdwa v111, v106 dst_sel:DWORD dst_unused:UNUSED_PAD src0_sel:WORD_1
  v_cvt_pk_bf16_f32 v40, v110, v111
  s_cbranch_vccnz pm_52
  s_branch pm_53
A1_16:
  v_smfmac_f32_16x16x32_bf16 v[52:55], v[40:41], a[16:19], v44
  v_smfmac_f32_16x16x32_bf16 v[64:67], v[40:41], a[76:79], v44
  v_smfmac_f32_16x16x32_bf16 v[56:59], v[40:41], a[36:39], v44
  v_smfmac_f32_16x16x32_bf16 v[68:71], v[40:41], a[96:99], v44
  v_smfmac_f32_16x16x32_bf16 v[60:63], v[40:41], a[56:59], v44
  v_smfmac_f32_16x16x32_bf16 v[72:75], v[40:41], a[116:119], v44
  v_smfmac_f32_16x16x32_bf16 v[76:79], v[40:41], a[136:139], v44
  v_smfmac_f32_16x16x32_bf16 v[80:83], v[40:41], a[156:159], v44
  v_smfmac_f32_16x16x32_bf16 v[84:87], v[40:41], a[176:179], v44
  s_branch A2_54
pv_55:
  buffer_load_dwordx4 v[144:147], v10, s[8:11], s81 offen offset:0 sc1
  buffer_load_dwordx4 v[148:151], v10, s[8:11], s81 offen offset:1024 sc1
  buffer_load_dwordx4 v[152:155], v10, s[8:11], s81 offen offset:2048 sc1
  s_add_u32 s54, s54, 1
  s_cmp_gt_u32 s54, 131072
  s_cbranch_scc1 end0
  s_waitcnt vmcnt(0)
  v_max3_u32 v27, v144, v146, v148
  v_max3_u32 v27, v27, v150, v152
  v_max3_u32 v27, v27, v154, v154
  v_cmp_eq_u32 vcc, -1, v27
  s_nop 1
  s_cbranch_vccnz pv_55
  s_branch pvj_58
psr_56:
  buffer_load_dwordx2 v[248:249], v9, s[8:11], s81 offen sc1
  buffer_load_dwordx4 v[112:115], v8, s[8:11], s81 offen offset:0 sc1
  buffer_load_dwordx4 v[116:119], v8, s[8:11], s81 offen offset:1024 sc1
  s_add_u32 s54, s54, 1
  s_cmp_gt_u32 s54, 131072
  s_cbranch_scc1 end0
  s_waitcnt vmcnt(2)
  v_xor_b32 v96, s88, v248
  s_nop 0
  v_permlane16_swap_b32 v248, v249
  v_fma_mix_f32 v250, v248, 1.0, v249 op_sel:[0,0,0] op_sel_hi:[1,0,1]
  v_fma_mix_f32 v251, v248, 1.0, v249 op_sel:[1,0,1] op_sel_hi:[1,0,1]
  v_mov_b32 v248, v250
  v_mov_b32 v249, v251
  s_nop 0
  v_permlane32_swap_b32 v248, v250
  v_permlane32_swap_b32 v249, v251
  s_waitcnt vmcnt(0)
  v_bitop3_b32 v97, v112, v114, s88 bitop3:0x7e
  v_bitop3_b32 v98, v116, v118, s88 bitop3:0x7e
  v_fma_mix_f32 v120, v112, 1.0, v116 op_sel:[0,0,0] op_sel_hi:[1,0,1]
  v_or3_b32 v27, v96, v97, v98
  v_fma_mix_f32 v124, v114, 1.0, v118 op_sel:[0,0,0] op_sel_hi:[1,0,1]
  v_and_b32 v27, 1, v27
  v_fma_mix_f32 v121, v112, 1.0, v116 op_sel:[1,0,1] op_sel_hi:[1,0,1]
  v_cmp_ne_u32 vcc, 0, v27
  v_fma_mix_f32 v125, v114, 1.0, v118 op_sel:[1,0,1] op_sel_hi:[1,0,1]
  v_fma_mix_f32 v122, v113, 1.0, v117 op_sel:[0,0,0] op_sel_hi:[1,0,1]
  v_fma_mix_f32 v126, v115, 1.0, v119 op_sel:[0,0,0] op_sel_hi:[1,0,1]
  s_cbranch_vccnz psr_56
  s_branch psj_57
kvw_59:
  s_cmp_eq_u32 s52, 0
  s_cselect_b32 s23, 1, s46
  s_cselect_b32 s55, 0, s55
  v_mov_b32 v236, 0
  s_mov_b32 s101, 0
wf_63:
  buffer_load_dword v237, v236, s[12:15], s79 offen sc1
  s_add_u32 s101, s101, 1
  s_cmp_gt_u32 s101, 131072
  s_cbranch_scc1 end0
  s_waitcnt vmcnt(0)
  v_readfirstlane_b32 s100, v237
  s_cmp_ge_u32 s100, s23
  s_cbranch_scc1 wf_64
  s_sleep 3
  s_branch wf_63
wf_64:
  s_cmp_gt_u32 s52, 1
  s_cbranch_scc1 kvok_60
  s_sub_u32 s21, s64, 1310720
  buffer_load_dwordx4 v[176:179], v16, s[28:31], s21 offen offset:0 sc1
  buffer_load_dwordx4 v[180:183], v16, s[28:31], s21 offen offset:1024 sc1
  buffer_load_dwordx4 v[184:187], v16, s[28:31], s21 offen offset:2048 sc1
  s_waitcnt vmcnt(0)
  s_branch kvok_60
fl_61:
  buffer_load_dword v94, v95, s[12:15], s79 offen sc1
  s_branch fl_62
last_51:
  s_mov_b64 exec, s[62:63]
  buffer_store_dwordx2 v[212:213], v21, s[24:27], s85 offen sc1
  buffer_store_dwordx2 v[214:215], v22, s[24:27], s85 offen sc1
  buffer_store_dwordx2 v[216:217], v23, s[24:27], s85 offen sc1
  s_mov_b64 exec, 1
  s_waitcnt vmcnt(0)
  v_mov_b32 v236, 64
  buffer_store_dword v236, v95, s[12:15], s90 offen sc1
  s_mov_b64 exec, -1
  s_branch chain_done
step_65:
  s_add_u32 s21, s52, 2
  s_and_b32 s21, s21, 3
  s_mul_i32 s82, s21, 540672
  s_add_u32 s21, s52, 3
  s_and_b32 s21, s21, 3
  s_lshl_b32 s83, s21, 15
  s_add_u32 s21, s52, 1
  s_and_b32 s22, s21, 3
  s_lshl_b32 s3, s22, 15
  s_mul_i32 s80, s21, 393216
  s_add_u32 s46, s21, 1
  s_min_u32 s46, s46, 64
  s_mul_i32 s85, s52, 98304
  s_add_u32 s57, s85, 6291456
  s_bfe_u32 s88, s52, 0x10002
  s_add_u32 s78, s81, 278528
  v_mov_b32 v52, 0
  v_mov_b32 v53, 0
  v_mov_b32 v54, 0
  v_mov_b32 v55, 0
  v_mov_b32 v56, 0
  v_mov_b32 v57, 0
  v_mov_b32 v58, 0
  v_mov_b32 v59, 0
  v_mov_b32 v60, 0
  v_mov_b32 v61, 0
  v_mov_b32 v62, 0
  v_mov_b32 v63, 0
  v_mov_b32 v64, 0
  v_mov_b32 v65, 0
  v_mov_b32 v66, 0
  v_mov_b32 v67, 0
  v_mov_b32 v68, 0
  v_mov_b32 v69, 0
  v_mov_b32 v70, 0
  v_mov_b32 v71, 0
  v_mov_b32 v72, 0
  v_mov_b32 v73, 0
  v_mov_b32 v74, 0
  v_mov_b32 v75, 0
  v_mov_b32 v76, 0
  v_mov_b32 v77, 0
  v_mov_b32 v78, 0
  v_mov_b32 v79, 0
  v_mov_b32 v80, 0
  v_mov_b32 v81, 0
  v_mov_b32 v82, 0
  v_mov_b32 v83, 0
  v_mov_b32 v84, 0
  v_mov_b32 v85, 0
  v_mov_b32 v86, 0
  v_mov_b32 v87, 0
  s_sleep 11
  s_mov_b32 s54, 0
  buffer_load_dwordx4 v[96:99], v4, s[4:7], s84 offen offset:0 sc1
  buffer_load_dwordx4 v[100:103], v4, s[4:7], s84 offen offset:1024 sc1
  buffer_load_dwordx4 v[104:107], v4, s[4:7], s84 offen offset:2048 sc1
  s_waitcnt vmcnt(3)
  v_mov_b32 v176, v160
  v_mov_b32 v177, v161
  v_mov_b32 v178, v162
  v_mov_b32 v179, v163
  v_mov_b32 v180, v164
  v_mov_b32 v181, v165
  v_mov_b32 v182, v166
  v_mov_b32 v183, v167
  v_mov_b32 v184, v48
  v_mov_b32 v185, v49
  v_mov_b32 v186, v50
  v_mov_b32 v187, v51
  s_waitcnt vmcnt(0)
  v_bitop3_b32 v27, v99, v103, v107 bitop3:0x80
  v_cvt_f32_f16 v108, v99
  v_and_b32 v27, 0x48000000, v27
  v_cvt_f32_f16 v109, v103
  v_cmp_ne_u32 vcc, 0x48000000, v27
  v_cvt_f32_f16 v110, v106
  v_cvt_f32_f16_sdwa v111, v106 dst_sel:DWORD dst_unused:UNUSED_PAD src0_sel:WORD_1
  v_cvt_pk_bf16_f32 v40, v110, v111
  s_cbranch_vccnz pm_67
pm_68:
  v_cvt_pk_bf16_f32 v41, v108, v109
  v_cvt_f32_f16 v110, v96
  v_cvt_f32_f16_sdwa v111, v96 dst_sel:DWORD dst_unused:UNUSED_PAD src0_sel:WORD_1
  v_smfmac_f32_16x16x32_bf16 v[52:55], v[40:41], a[16:19], v44
  v_cvt_f32_f16 v112, v97
  v_cvt_f32_f16_sdwa v113, v97 dst_sel:DWORD dst_unused:UNUSED_PAD src0_sel:WORD_1
  v_cvt_pk_bf16_f32 v32, v110, v111
  v_smfmac_f32_16x16x32_bf16 v[64:67], v[40:41], a[76:79], v44
  v_cvt_pk_bf16_f32 v33, v112, v113
  v_cvt_f32_f16 v114, v98
  v_cvt_f32_f16_sdwa v115, v98 dst_sel:DWORD dst_unused:UNUSED_PAD src0_sel:WORD_1
  v_smfmac_f32_16x16x32_bf16 v[56:59], v[40:41], a[36:39], v44
  v_cvt_f32_f16 v116, v100
  v_cvt_f32_f16_sdwa v117, v100 dst_sel:DWORD dst_unused:UNUSED_PAD src0_sel:WORD_1
  v_cvt_pk_bf16_f32 v34, v114, v115
  v_smfmac_f32_16x16x32_bf16 v[68:71], v[40:41], a[96:99], v44
  v_cvt_pk_bf16_f32 v35, v116, v117
  v_cvt_f32_f16 v110, v101
  v_cvt_f32_f16_sdwa v111, v101 dst_sel:DWORD dst_unused:UNUSED_PAD src0_sel:WORD_1
  v_smfmac_f32_16x16x32_bf16 v[60:63], v[40:41], a[56:59], v44
  v_cvt_f32_f16 v112, v102
  v_cvt_f32_f16_sdwa v113, v102 dst_sel:DWORD dst_unused:UNUSED_PAD src0_sel:WORD_1
  v_smfmac_f32_16x16x32_bf16 v[72:75], v[40:41], a[116:119], v44
  v_cvt_pk_bf16_f32 v36, v110, v111
  v_cvt_pk_bf16_f32 v37, v112, v113
  v_smfmac_f32_16x16x32_bf16 v[76:79], v[40:41], a[136:139], v44
  v_cvt_f32_f16 v114, v104
  v_cvt_f32_f16_sdwa v115, v104 dst_sel:DWORD dst_unused:UNUSED_PAD src0_sel:WORD_1
  v_smfmac_f32_16x16x32_bf16 v[80:83], v[40:41], a[156:159], v44
  v_cvt_f32_f16 v116, v105
  v_cvt_f32_f16_sdwa v117, v105 dst_sel:DWORD dst_unused:UNUSED_PAD src0_sel:WORD_1
  v_smfmac_f32_16x16x32_bf16 v[84:87], v[40:41], a[176:179], v44
  v_cvt_pk_bf16_f32 v38, v114, v115
  v_cvt_pk_bf16_f32 v39, v116, v117
A2_69:
  v_smfmac_f32_16x16x64_bf16 v[52:55], v[32:35], a[0:7], v44
  v_smfmac_f32_16x16x64_bf16 v[52:55], v[36:39], a[8:15], v44
  v_smfmac_f32_16x16x64_bf16 v[64:67], v[32:35], a[60:67], v44
  v_smfmac_f32_16x16x64_bf16 v[64:67], v[36:39], a[68:75], v44
  v_smfmac_f32_16x16x64_bf16 v[56:59], v[32:35], a[20:27], v44
  v_smfmac_f32_16x16x64_bf16 v[56:59], v[36:39], a[28:35], v44
  v_smfmac_f32_16x16x64_bf16 v[68:71], v[32:35], a[80:87], v44
  v_permlane32_swap_b32 v52, v64
  v_permlane32_swap_b32 v53, v65
  v_permlane32_swap_b32 v54, v66
  v_smfmac_f32_16x16x64_bf16 v[68:71], v[36:39], a[88:95], v44
  v_permlane32_swap_b32 v55, v67
  v_pk_add_f32 v[52:53], v[52:53], v[64:65]
  v_pk_add_f32 v[54:55], v[54:55], v[66:67]
  v_smfmac_f32_16x16x64_bf16 v[60:63], v[32:35], a[40:47], v44
  ds_write2_b32 v5, v52, v53 offset0:0 offset1:4
  ds_write2_b32 v5, v54, v55 offset0:8 offset1:12
  v_smfmac_f32_16x16x64_bf16 v[60:63], v[36:39], a[48:55], v44
  v_smfmac_f32_16x16x64_bf16 v[72:75], v[32:35], a[100:107], v44
  v_permlane32_swap_b32 v56, v68
  v_permlane32_swap_b32 v57, v69
  v_permlane32_swap_b32 v58, v70
  v_smfmac_f32_16x16x64_bf16 v[72:75], v[36:39], a[108:115], v44
  v_permlane32_swap_b32 v59, v71
  v_pk_add_f32 v[56:57], v[56:57], v[68:69]
  v_pk_add_f32 v[58:59], v[58:59], v[70:71]
  v_smfmac_f32_16x16x64_bf16 v[76:79], v[32:35], a[120:127], v44
  ds_write2_b32 v242, v56, v57 offset0:0 offset1:4
  ds_write2_b32 v242, v58, v59 offset0:8 offset1:12
  v_smfmac_f32_16x16x64_bf16 v[76:79], v[36:39], a[128:135], v44
  v_smfmac_f32_16x16x64_bf16 v[80:83], v[32:35], a[140:147], v44
  v_permlane32_swap_b32 v60, v72
  v_permlane32_swap_b32 v61, v73
  v_permlane32_swap_b32 v62, v74
  v_smfmac_f32_16x16x64_bf16 v[80:83], v[36:39], a[148:155], v44
  v_permlane32_swap_b32 v63, v75
  v_pk_add_f32 v[60:61], v[60:61], v[72:73]
  v_pk_add_f32 v[62:63], v[62:63], v[74:75]
  v_smfmac_f32_16x16x64_bf16 v[84:87], v[32:35], a[160:167], v44
  ds_write2_b32 v243, v60, v61 offset0:0 offset1:4
  ds_write2_b32 v243, v62, v63 offset0:8 offset1:12
  v_smfmac_f32_16x16x64_bf16 v[84:87], v[36:39], a[168:175], v44
  v_permlane32_swap_b32 v76, v80
  v_permlane32_swap_b32 v77, v81
  v_permlane32_swap_b32 v78, v82
  v_permlane32_swap_b32 v79, v83
  v_pk_add_f32 v[76:77], v[76:77], v[80:81]
  v_pk_add_f32 v[78:79], v[78:79], v[82:83]
  ds_write2_b32 v244, v76, v77 offset0:0 offset1:4
  ds_write2_b32 v244, v78, v79 offset0:8 offset1:12
  ds_write2_b32 v245, v84, v85 offset0:0 offset1:4
  ds_write2_b32 v245, v86, v87 offset0:8 offset1:12
  s_waitcnt lgkmcnt(0) vmcnt(0)
  s_barrier
  ds_read_b128 v[96:99], v6 offset:3264
  ds_read_b128 v[100:103], v6 offset:8704
  ds_read_b128 v[104:107], v6 offset:14144
  ds_read_b128 v[108:111], v6 offset:19584
  ds_read_b128 v[112:115], v6 offset:4352
  ds_read_b128 v[116:119], v6 offset:9792
  ds_read_b128 v[120:123], v6 offset:15232
  ds_read_b128 v[124:127], v6 offset:20672
  s_waitcnt lgkmcnt(4)
  v_pk_add_f32 v[96:97], v[96:97], v[100:101]
  v_pk_add_f32 v[98:99], v[98:99], v[102:103]
  v_pk_add_f32 v[104:105], v[104:105], v[108:109]
  v_pk_add_f32 v[106:107], v[106:107], v[110:111]
  v_pk_add_f32 v[96:97], v[96:97], v[104:105]
  v_pk_add_f32 v[98:99], v[98:99], v[106:107]
  v_cvt_pk_bf16_f32 v90, v96, v97
  v_cvt_pk_bf16_f32 v91, v98, v99
  v_min_u32 v90, -2, v90
  v_min_u32 v91, -2, v91
  buffer_store_dwordx2 v[90:91], v24, s[8:11], s81 offen
  s_waitcnt lgkmcnt(0)
  v_pk_add_f32 v[112:113], v[112:113], v[116:117]
  v_pk_add_f32 v[114:115], v[114:115], v[118:119]
  v_pk_add_f32 v[120:121], v[120:121], v[124:125]
  v_pk_add_f32 v[122:123], v[122:123], v[126:127]
  v_pk_add_f32 v[112:113], v[112:113], v[120:121]
  v_pk_add_f32 v[114:115], v[114:115], v[122:123]
  s_nop 1
  v_add_f32_dpp v116, v112, v112 row_ror:8 row_mask:0xf bank_mask:0xf
  v_add_f32_dpp v117, v113, v113 row_ror:8 row_mask:0xf bank_mask:0xf
  v_add_f32_dpp v118, v114, v114 row_ror:8 row_mask:0xf bank_mask:0xf
  v_add_f32_dpp v119, v115, v115 row_ror:8 row_mask:0xf bank_mask:0xf
  v_cvt_pk_bf16_f32 v92, v116, v117
  v_cvt_pk_bf16_f32 v93, v118, v119
  v_min_u32 v92, -2, v92
  v_min_u32 v93, -2, v93
  s_mov_b64 exec, s[60:61]
  buffer_store_dwordx2 v[92:93], v23, s[8:11], s78 offen
  s_mov_b64 exec, -1
  s_cmp_eq_u32 s52, 63
  s_cbranch_scc1 last_66
  s_sleep 5
  s_mov_b32 s54, 0
  buffer_load_dwordx2 v[248:249], v9, s[8:11], s81 offen sc1
  buffer_load_dwordx4 v[112:115], v8, s[8:11], s81 offen offset:0 sc1
  buffer_load_dwordx4 v[116:119], v8, s[8:11], s81 offen offset:1024 sc1
  s_sleep 2
  buffer_load_dwordx4 v[144:147], v10, s[8:11], s81 offen offset:0 sc1
  buffer_load_dwordx4 v[148:151], v10, s[8:11], s81 offen offset:1024 sc1
  buffer_load_dwordx4 v[152:155], v10, s[8:11], s81 offen offset:2048 sc1
  v_mov_b32 v188, 0
  v_mov_b32 v189, 0
  v_mov_b32 v190, 0
  v_mov_b32 v191, 0
  v_mov_b32 v192, 0
  v_mov_b32 v193, 0
  v_mov_b32 v194, 0
  v_mov_b32 v195, 0
  v_mov_b32 v196, 0
  v_mov_b32 v197, 0
  v_mov_b32 v198, 0
  v_mov_b32 v199, 0
  v_readfirstlane_b32 s21, v94
  s_add_u32 s22, s46, 8
  s_min_u32 s22, s22, 64
  s_sub_u32 s55, s21, s22
  s_sub_u32 s56, s21, s46
  s_waitcnt vmcnt(5)
  v_xor_b32 v96, s88, v248
  s_nop 0
  v_permlane16_swap_b32 v248, v249
  v_fma_mix_f32 v250, v248, 1.0, v249 op_sel:[0,0,0] op_sel_hi:[1,0,1]
  v_fma_mix_f32 v251, v248, 1.0, v249 op_sel:[1,0,1] op_sel_hi:[1,0,1]
  v_mov_b32 v248, v250
  v_mov_b32 v249, v251
  s_nop 0
  v_permlane32_swap_b32 v248, v250
  v_permlane32_swap_b32 v249, v251
  s_waitcnt vmcnt(3)
  v_bitop3_b32 v97, v112, v114, s88 bitop3:0x7e
  v_bitop3_b32 v98, v116, v118, s88 bitop3:0x7e
  v_fma_mix_f32 v120, v112, 1.0, v116 op_sel:[0,0,0] op_sel_hi:[1,0,1]
  v_or3_b32 v27, v96, v97, v98
  v_fma_mix_f32 v124, v114, 1.0, v118 op_sel:[0,0,0] op_sel_hi:[1,0,1]
  v_and_b32 v27, 1, v27
  v_fma_mix_f32 v121, v112, 1.0, v116 op_sel:[1,0,1] op_sel_hi:[1,0,1]
  v_cmp_ne_u32 vcc, 0, v27
  v_fma_mix_f32 v125, v114, 1.0, v118 op_sel:[1,0,1] op_sel_hi:[1,0,1]
  v_fma_mix_f32 v122, v113, 1.0, v117 op_sel:[0,0,0] op_sel_hi:[1,0,1]
  v_fma_mix_f32 v126, v115, 1.0, v119 op_sel:[0,0,0] op_sel_hi:[1,0,1]
  s_cbranch_vccnz psr_71
psj_72:
  s_cmp_lt_i32 s56, 0
  s_cbranch_scc1 kvw_74
kvok_75:
  v_fma_mix_f32 v123, v113, 1.0, v117 op_sel:[1,0,1] op_sel_hi:[1,0,1]
  v_fma_mix_f32 v127, v115, 1.0, v119 op_sel:[1,0,1] op_sel_hi:[1,0,1]
  v_permlane32_swap_b32 v120, v124
  v_permlane32_swap_b32 v121, v125
  v_permlane32_swap_b32 v122, v126
  v_permlane32_swap_b32 v123, v127
  v_pk_add_f32 v[120:121], v[120:121], v[124:125]
  v_pk_add_f32 v[122:123], v[122:123], v[126:127]
  v_pk_add_f32 v[124:125], v[248:249], v[250:251]
  v_max3_f32 v236, v120, v121, v122
  v_max3_f32 v237, v123, v124, v125
  v_max_f32 v236, v236, v237
  s_nop 1
  v_max_f32_dpp v236, v236, v236 row_ror:8 row_mask:0xf bank_mask:0xf
  v_mov_b32 v237, v236
  s_nop 1
  v_permlane32_swap_b32 v236, v237
  v_max_f32 v236, v236, v237
  v_mov_b32 v237, v236
  s_nop 1
  v_permlane16_swap_b32 v236, v237
  v_max_f32 v236, v236, v237
  s_waitcnt vmcnt(0)
  v_max3_u32 v27, v144, v146, v148
  v_max3_u32 v27, v27, v150, v152
  v_max3_u32 v27, v27, v154, v154
  v_cmp_eq_u32 vcc, -1, v27
  s_nop 1
  s_cbranch_vccnz pv_70
pvj_73:
  v_mul_f32 v236, s86, v236
  v_smfmac_f32_16x16x64_bf16 v[188:191], v[144:147], a[180:187], v44
  v_fma_f32 v120, v120, s86, -v236
  v_smfmac_f32_16x16x64_bf16 v[188:191], v[148:151], a[188:195], v44
  v_fma_f32 v121, v121, s86, -v236
  v_smfmac_f32_16x16x64_bf16 v[188:191], v[152:155], a[196:203], v44
  buffer_load_dwordx4 v[160:163], v16, s[28:31], s64 offen offset:0 sc1
  v_fma_f32 v122, v122, s86, -v236
  v_smfmac_f32_16x16x64_bf16 v[192:195], v[144:147], a[204:211], v44
  v_fma_f32 v123, v123, s86, -v236
  v_smfmac_f32_16x16x64_bf16 v[192:195], v[148:151], a[212:219], v44
  buffer_load_dwordx4 v[164:167], v16, s[28:31], s64 offen offset:1024 sc1
  v_fma_f32 v124, v124, s86, -v236
  v_smfmac_f32_16x16x64_bf16 v[192:195], v[152:155], a[220:227], v44
  v_fma_f32 v125, v125, s86, -v236
  v_smfmac_f32_16x16x64_bf16 v[196:199], v[144:147], a[228:235], v44
  buffer_load_dwordx4 v[48:51], v16, s[28:31], s64 offen offset:2048 sc1
  v_exp_f32 v120, v120
  v_smfmac_f32_16x16x64_bf16 v[196:199], v[148:151], a[236:243], v44
  v_exp_f32 v121, v121
  v_smfmac_f32_16x16x64_bf16 v[196:199], v[152:155], a[244:251], v44
  buffer_store_dwordx2 v[90:91], v25, s[24:27], s57 offen sc1
  v_exp_f32 v122, v122
  s_mov_b64 exec, s[60:61]
  buffer_store_dwordx2 v[92:93], v23, s[24:27], s57 offen sc1
  s_mov_b64 exec, -1
  v_exp_f32 v123, v123
  v_mov_b32 v240, s52
  v_mov_b32 v241, s52
  s_mov_b64 exec, 1
  buffer_store_dwordx2 v[240:241], v95, s[12:15], s90 offen sc1
  s_mov_b64 exec, -1
  v_exp_f32 v124, v124
  s_cmp_lt_i32 s55, 0
  s_cbranch_scc1 fl_76
fl_77:
  v_exp_f32 v125, v125
  s_mov_b64 exec, s[60:61]
  v_cvt_pk_bf16_f32 v220, v120, v121
  v_cvt_pk_bf16_f32 v221, v122, v123
  v_cvt_pk_bf16_f32 v224, v124, v125
  s_mov_b64 exec, s[62:63]
  v_cvt_pk_bf16_f32 v222, v120, v121
  v_cvt_pk_bf16_f32 v223, v122, v123
  v_cvt_pk_bf16_f32 v225, v124, v125
  s_mov_b64 exec, -1
  v_pk_add_f32 v[126:127], v[120:121], v[122:123]
  v_add_f32 v128, v124, v125
  v_mfma_f32_16x16x32_bf16 v[200:203], v[176:179], v[220:223], 0
  v_add_f32 v236, v126, v127
  v_fmac_f32 v236, v128, v89
  v_cvt_pk_bf16_f32 v228, v188, v189
  v_cvt_pk_bf16_f32 v229, v190, v191
  v_mfma_f32_16x16x32_bf16 v[204:207], v[180:183], v[220:223], 0
  v_cvt_pk_bf16_f32 v230, v192, v193
  v_cvt_pk_bf16_f32 v231, v194, v195
  v_mfma_f32_16x16x32_bf16 v[208:211], v[184:187], v[220:223], 0
  v_cvt_pk_bf16_f32 v232, v196, v197
  v_cvt_pk_bf16_f32 v233, v198, v199
  v_add_f32_dpp v236, v236, v236 row_ror:8 row_mask:0xf bank_mask:0xf
  v_mov_b32 v237, v236
  s_nop 0
  v_mfma_f32_16x16x32_bf16 v[200:203], v[228:231], v[224:227], v[200:203]
  v_mfma_f32_16x16x32_bf16 v[204:207], v[230:233], v[224:227], v[204:207]
  v_permlane32_swap_b32 v236, v237
  v_add_f32 v236, v236, v237
  v_mov_b32 v237, v236
  v_mfma_f32_16x16x32_bf16 v[208:211], v[232:235], v[224:227], v[208:211]
  s_nop 0
  v_permlane16_swap_b32 v236, v237
  v_add_f32 v236, v236, v237
  v_rcp_f32 v236, v236
  s_nop 2
  v_pk_mul_f32 v[200:201], v[200:201], v[236:237] op_sel_hi:[1,0]
  v_pk_mul_f32 v[202:203], v[202:203], v[236:237] op_sel_hi:[1,0]
  ds_write_b128 v11, v[200:203] offset:0
  v_pk_mul_f32 v[204:205], v[204:205], v[236:237] op_sel_hi:[1,0]
  v_pk_mul_f32 v[206:207], v[206:207], v[236:237] op_sel_hi:[1,0]
  ds_write_b128 v11, v[204:207] offset:1024
  v_pk_mul_f32 v[208:209], v[208:209], v[236:237] op_sel_hi:[1,0]
  v_pk_mul_f32 v[210:211], v[210:211], v[236:237] op_sel_hi:[1,0]
  ds_write_b128 v11, v[208:211] offset:2048
  s_waitcnt lgkmcnt(0)
  s_barrier
  v_mov_b32 v28, -1
  v_mov_b32 v29, -1
  buffer_store_dwordx2 v[28:29], v24, s[8:11], s82 offen
  s_mov_b64 exec, s[60:61]
  s_add_u32 s22, s82, 278528
  buffer_store_dwordx2 v[28:29], v23, s[8:11], s22 offen
  s_and_b32 s21, s52, 7
  s_cmp_lg_u32 s21, s50
  s_cbranch_scc1 zm_78
  s_mov_b64 exec, s[70:71]
  buffer_store_dwordx4 v[156:159], v13, s[4:7], s83 offen sc1
zm_78:
  s_mov_b64 exec, -1
  s_add_u32 s64, s64, 1310720
  s_add_u32 s52, s52, 1
  s_and_b32 s21, s52, 3
  s_mul_i32 s81, s21, 540672
  s_lshl_b32 s84, s21, 15
  s_branch step_65
pm_67:
  s_mov_b32 s47, 1
  buffer_load_dwordx4 v[96:99], v4, s[4:7], s84 offen offset:0 sc1
  buffer_load_dwordx4 v[100:103], v4, s[4:7], s84 offen offset:1024 sc1
  buffer_load_dwordx4 v[104:107], v4, s[4:7], s84 offen offset:2048 sc1
  s_add_u32 s54, s54, 1
  s_cmp_gt_u32 s54, 131072
  s_cbranch_scc1 end0
  s_waitcnt vmcnt(0)
  v_bitop3_b32 v27, v99, v103, v107 bitop3:0x80
  v_cvt_f32_f16 v108, v99
  v_and_b32 v27, 0x48000000, v27
  v_cvt_f32_f16 v109, v103
  v_cmp_ne_u32 vcc, 0x48000000, v27
  v_cvt_f32_f16 v110, v106
  v_cvt_f32_f16_sdwa v111, v106 dst_sel:DWORD dst_unused:UNUSED_PAD src0_sel:WORD_1
  v_cvt_pk_bf16_f32 v40, v110, v111
  s_cbranch_vccnz pm_67
  s_branch pm_68
A1_17:
  v_smfmac_f32_16x16x32_bf16 v[52:55], v[40:41], a[16:19], v44
  v_smfmac_f32_16x16x32_bf16 v[64:67], v[40:41], a[76:79], v44
  v_smfmac_f32_16x16x32_bf16 v[56:59], v[40:41], a[36:39], v44
  v_smfmac_f32_16x16x32_bf16 v[68:71], v[40:41], a[96:99], v44
  v_smfmac_f32_16x16x32_bf16 v[60:63], v[40:41], a[56:59], v44
  v_smfmac_f32_16x16x32_bf16 v[72:75], v[40:41], a[116:119], v44
  v_smfmac_f32_16x16x32_bf16 v[76:79], v[40:41], a[136:139], v44
  v_smfmac_f32_16x16x32_bf16 v[80:83], v[40:41], a[156:159], v44
  v_smfmac_f32_16x16x32_bf16 v[84:87], v[40:41], a[176:179], v44
  s_branch A2_69
pv_70:
  buffer_load_dwordx4 v[144:147], v10, s[8:11], s81 offen offset:0 sc1
  buffer_load_dwordx4 v[148:151], v10, s[8:11], s81 offen offset:1024 sc1
  buffer_load_dwordx4 v[152:155], v10, s[8:11], s81 offen offset:2048 sc1
  s_add_u32 s54, s54, 1
  s_cmp_gt_u32 s54, 131072
  s_cbranch_scc1 end0
  s_waitcnt vmcnt(0)
  v_max3_u32 v27, v144, v146, v148
  v_max3_u32 v27, v27, v150, v152
  v_max3_u32 v27, v27, v154, v154
  v_cmp_eq_u32 vcc, -1, v27
  s_nop 1
  s_cbranch_vccnz pv_70
  s_branch pvj_73
psr_71:
  buffer_load_dwordx2 v[248:249], v9, s[8:11], s81 offen sc1
  buffer_load_dwordx4 v[112:115], v8, s[8:11], s81 offen offset:0 sc1
  buffer_load_dwordx4 v[116:119], v8, s[8:11], s81 offen offset:1024 sc1
  s_add_u32 s54, s54, 1
  s_cmp_gt_u32 s54, 131072
  s_cbranch_scc1 end0
  s_waitcnt vmcnt(2)
  v_xor_b32 v96, s88, v248
  s_nop 0
  v_permlane16_swap_b32 v248, v249
  v_fma_mix_f32 v250, v248, 1.0, v249 op_sel:[0,0,0] op_sel_hi:[1,0,1]
  v_fma_mix_f32 v251, v248, 1.0, v249 op_sel:[1,0,1] op_sel_hi:[1,0,1]
  v_mov_b32 v248, v250
  v_mov_b32 v249, v251
  s_nop 0
  v_permlane32_swap_b32 v248, v250
  v_permlane32_swap_b32 v249, v251
  s_waitcnt vmcnt(0)
  v_bitop3_b32 v97, v112, v114, s88 bitop3:0x7e
  v_bitop3_b32 v98, v116, v118, s88 bitop3:0x7e
  v_fma_mix_f32 v120, v112, 1.0, v116 op_sel:[0,0,0] op_sel_hi:[1,0,1]
  v_or3_b32 v27, v96, v97, v98
  v_fma_mix_f32 v124, v114, 1.0, v118 op_sel:[0,0,0] op_sel_hi:[1,0,1]
  v_and_b32 v27, 1, v27
  v_fma_mix_f32 v121, v112, 1.0, v116 op_sel:[1,0,1] op_sel_hi:[1,0,1]
  v_cmp_ne_u32 vcc, 0, v27
  v_fma_mix_f32 v125, v114, 1.0, v118 op_sel:[1,0,1] op_sel_hi:[1,0,1]
  v_fma_mix_f32 v122, v113, 1.0, v117 op_sel:[0,0,0] op_sel_hi:[1,0,1]
  v_fma_mix_f32 v126, v115, 1.0, v119 op_sel:[0,0,0] op_sel_hi:[1,0,1]
  s_cbranch_vccnz psr_71
  s_branch psj_72
kvw_74:
  s_cmp_eq_u32 s52, 0
  s_cselect_b32 s23, 1, s46
  s_cselect_b32 s55, 0, s55
  v_mov_b32 v236, 0
  s_mov_b32 s101, 0
wf_79:
  buffer_load_dword v237, v236, s[12:15], s79 offen sc1
  s_add_u32 s101, s101, 1
  s_cmp_gt_u32 s101, 131072
  s_cbranch_scc1 end0
  s_waitcnt vmcnt(0)
  v_readfirstlane_b32 s100, v237
  s_cmp_ge_u32 s100, s23
  s_cbranch_scc1 wf_80
  s_sleep 3
  s_branch wf_79
wf_80:
  s_cmp_gt_u32 s52, 1
  s_cbranch_scc1 kvok_75
  s_sub_u32 s21, s64, 1310720
  buffer_load_dwordx4 v[176:179], v16, s[28:31], s21 offen offset:0 sc1
  buffer_load_dwordx4 v[180:183], v16, s[28:31], s21 offen offset:1024 sc1
  buffer_load_dwordx4 v[184:187], v16, s[28:31], s21 offen offset:2048 sc1
  s_waitcnt vmcnt(0)
  s_branch kvok_75
fl_76:
  buffer_load_dword v94, v95, s[12:15], s79 offen sc1
  s_branch fl_77
last_66:
  buffer_store_dwordx2 v[90:91], v25, s[24:27], s57 offen sc1
  s_mov_b64 exec, s[60:61]
  buffer_store_dwordx2 v[92:93], v23, s[24:27], s57 offen sc1
  s_mov_b64 exec, 1
  s_waitcnt vmcnt(0)
  v_mov_b32 v236, 64
  buffer_store_dword v236, v95, s[12:15], s90 offen offset:4 sc1
  s_mov_b64 exec, -1
  s_branch chain_done
step_81:
  s_add_u32 s21, s52, 2
  s_and_b32 s21, s21, 3
  s_mul_i32 s82, s21, 540672
  s_add_u32 s21, s52, 3
  s_and_b32 s21, s21, 3
  s_lshl_b32 s83, s21, 15
  s_add_u32 s21, s52, 1
  s_and_b32 s22, s21, 3
  s_lshl_b32 s3, s22, 15
  s_mul_i32 s80, s21, 393216
  s_add_u32 s46, s21, 1
  s_min_u32 s46, s46, 64
  s_mul_i32 s85, s52, 98304
  s_add_u32 s57, s85, 6291456
  s_bfe_u32 s88, s52, 0x10002
  s_add_u32 s78, s81, 278528
  v_mov_b32 v52, 0
  v_mov_b32 v53, 0
  v_mov_b32 v54, 0
  v_mov_b32 v55, 0
  v_mov_b32 v56, 0
  v_mov_b32 v57, 0
  v_mov_b32 v58, 0
  v_mov_b32 v59, 0
  v_mov_b32 v60, 0
  v_mov_b32 v61, 0
  v_mov_b32 v62, 0
  v_mov_b32 v63, 0
  v_mov_b32 v64, 0
  v_mov_b32 v65, 0
  v_mov_b32 v66, 0
  v_mov_b32 v67, 0
  v_mov_b32 v68, 0
  v_mov_b32 v69, 0
  v_mov_b32 v70, 0
  v_mov_b32 v71, 0
  v_mov_b32 v72, 0
  v_mov_b32 v73, 0
  v_mov_b32 v74, 0
  v_mov_b32 v75, 0
  v_mov_b32 v76, 0
  v_mov_b32 v77, 0
  v_mov_b32 v78, 0
  v_mov_b32 v79, 0
  v_mov_b32 v80, 0
  v_mov_b32 v81, 0
  v_mov_b32 v82, 0
  v_mov_b32 v83, 0
  v_mov_b32 v84, 0
  v_mov_b32 v85, 0
  v_mov_b32 v86, 0
  v_mov_b32 v87, 0
  s_sleep 8
  s_mov_b32 s54, 0
  buffer_load_dwordx4 v[96:99], v4, s[4:7], s84 offen offset:0 sc1
  buffer_load_dwordx4 v[100:103], v4, s[4:7], s84 offen offset:1024 sc1
  buffer_load_dwordx4 v[104:107], v4, s[4:7], s84 offen offset:2048 sc1
  s_waitcnt vmcnt(3)
  v_mov_b32 v176, v160
  v_mov_b32 v177, v161
  v_mov_b32 v178, v162
  v_mov_b32 v179, v163
  v_mov_b32 v180, v164
  v_mov_b32 v181, v165
  v_mov_b32 v182, v166
  v_mov_b32 v183, v167
  v_mov_b32 v184, v48
  v_mov_b32 v185, v49
  v_mov_b32 v186, v50
  v_mov_b32 v187, v51
  s_waitcnt vmcnt(0)
  v_bitop3_b32 v27, v99, v103, v107 bitop3:0x80
  v_cvt_f32_f16 v108, v99
  v_and_b32 v27, 0x48000000, v27
  v_cvt_f32_f16 v109, v103
  v_cmp_ne_u32 vcc, 0x48000000, v27
  v_cvt_f32_f16 v110, v106
  v_cvt_f32_f16_sdwa v111, v106 dst_sel:DWORD dst_unused:UNUSED_PAD src0_sel:WORD_1
  v_cvt_pk_bf16_f32 v40, v110, v111
  s_cbranch_vccnz pm_83
pm_84:
  v_cvt_pk_bf16_f32 v41, v108, v109
  v_cvt_f32_f16 v110, v96
  v_cvt_f32_f16_sdwa v111, v96 dst_sel:DWORD dst_unused:UNUSED_PAD src0_sel:WORD_1
  v_smfmac_f32_16x16x32_bf16 v[52:55], v[40:41], a[16:19], v44
  v_cvt_f32_f16 v112, v97
  v_cvt_f32_f16_sdwa v113, v97 dst_sel:DWORD dst_unused:UNUSED_PAD src0_sel:WORD_1
  v_cvt_pk_bf16_f32 v32, v110, v111
  v_smfmac_f32_16x16x32_bf16 v[64:67], v[40:41], a[76:79], v44
  v_cvt_pk_bf16_f32 v33, v112, v113
  v_cvt_f32_f16 v114, v98
  v_cvt_f32_f16_sdwa v115, v98 dst_sel:DWORD dst_unused:UNUSED_PAD src0_sel:WORD_1
  v_smfmac_f32_16x16x32_bf16 v[56:59], v[40:41], a[36:39], v44
  v_cvt_f32_f16 v116, v100
  v_cvt_f32_f16_sdwa v117, v100 dst_sel:DWORD dst_unused:UNUSED_PAD src0_sel:WORD_1
  v_cvt_pk_bf16_f32 v34, v114, v115
  v_smfmac_f32_16x16x32_bf16 v[68:71], v[40:41], a[96:99], v44
  v_cvt_pk_bf16_f32 v35, v116, v117
  v_cvt_f32_f16 v110, v101
  v_cvt_f32_f16_sdwa v111, v101 dst_sel:DWORD dst_unused:UNUSED_PAD src0_sel:WORD_1
  v_smfmac_f32_16x16x32_bf16 v[60:63], v[40:41], a[56:59], v44
  v_cvt_f32_f16 v112, v102
  v_cvt_f32_f16_sdwa v113, v102 dst_sel:DWORD dst_unused:UNUSED_PAD src0_sel:WORD_1
  v_smfmac_f32_16x16x32_bf16 v[72:75], v[40:41], a[116:119], v44
  v_cvt_pk_bf16_f32 v36, v110, v111
  v_cvt_pk_bf16_f32 v37, v112, v113
  v_smfmac_f32_16x16x32_bf16 v[76:79], v[40:41], a[136:139], v44
  v_cvt_f32_f16 v114, v104
  v_cvt_f32_f16_sdwa v115, v104 dst_sel:DWORD dst_unused:UNUSED_PAD src0_sel:WORD_1
  v_smfmac_f32_16x16x32_bf16 v[80:83], v[40:41], a[156:159], v44
  v_cvt_f32_f16 v116, v105
  v_cvt_f32_f16_sdwa v117, v105 dst_sel:DWORD dst_unused:UNUSED_PAD src0_sel:WORD_1
  v_smfmac_f32_16x16x32_bf16 v[84:87], v[40:41], a[176:179], v44
  v_cvt_pk_bf16_f32 v38, v114, v115
  v_cvt_pk_bf16_f32 v39, v116, v117
A2_85:
  v_smfmac_f32_16x16x64_bf16 v[52:55], v[32:35], a[0:7], v44
  v_smfmac_f32_16x16x64_bf16 v[52:55], v[36:39], a[8:15], v44
  v_smfmac_f32_16x16x64_bf16 v[64:67], v[32:35], a[60:67], v44
  v_smfmac_f32_16x16x64_bf16 v[64:67], v[36:39], a[68:75], v44
  v_smfmac_f32_16x16x64_bf16 v[56:59], v[32:35], a[20:27], v44
  v_smfmac_f32_16x16x64_bf16 v[56:59], v[36:39], a[28:35], v44
  v_smfmac_f32_16x16x64_bf16 v[68:71], v[32:35], a[80:87], v44
  v_permlane32_swap_b32 v52, v64
  v_permlane32_swap_b32 v53, v65
  v_permlane32_swap_b32 v54, v66
  v_smfmac_f32_16x16x64_bf16 v[68:71], v[36:39], a[88:95], v44
  v_permlane32_swap_b32 v55, v67
  v_pk_add_f32 v[52:53], v[52:53], v[64:65]
  v_pk_add_f32 v[54:55], v[54:55], v[66:67]
  v_smfmac_f32_16x16x64_bf16 v[60:63], v[32:35], a[40:47], v44
  ds_write2_b32 v5, v52, v53 offset0:0 offset1:4
  ds_write2_b32 v5, v54, v55 offset0:8 offset1:12
  v_smfmac_f32_16x16x64_bf16 v[60:63], v[36:39], a[48:55], v44
  v_smfmac_f32_16x16x64_bf16 v[72:75], v[32:35], a[100:107], v44
  v_permlane32_swap_b32 v56, v68
  v_permlane32_swap_b32 v57, v69
  v_permlane32_swap_b32 v58, v70
  v_smfmac_f32_16x16x64_bf16 v[72:75], v[36:39], a[108:115], v44
  v_permlane32_swap_b32 v59, v71
  v_pk_add_f32 v[56:57], v[56:57], v[68:69]
  v_pk_add_f32 v[58:59], v[58:59], v[70:71]
  v_smfmac_f32_16x16x64_bf16 v[76:79], v[32:35], a[120:127], v44
  ds_write2_b32 v242, v56, v57 offset0:0 offset1:4
  ds_write2_b32 v242, v58, v59 offset0:8 offset1:12
  v_smfmac_f32_16x16x64_bf16 v[76:79], v[36:39], a[128:135], v44
  v_smfmac_f32_16x16x64_bf16 v[80:83], v[32:35], a[140:147], v44
  v_permlane32_swap_b32 v60, v72
  v_permlane32_swap_b32 v61, v73
  v_permlane32_swap_b32 v62, v74
  v_smfmac_f32_16x16x64_bf16 v[80:83], v[36:39], a[148:155], v44
  v_permlane32_swap_b32 v63, v75
  v_pk_add_f32 v[60:61], v[60:61], v[72:73]
  v_pk_add_f32 v[62:63], v[62:63], v[74:75]
  v_smfmac_f32_16x16x64_bf16 v[84:87], v[32:35], a[160:167], v44
  ds_write2_b32 v243, v60, v61 offset0:0 offset1:4
  ds_write2_b32 v243, v62, v63 offset0:8 offset1:12
  v_smfmac_f32_16x16x64_bf16 v[84:87], v[36:39], a[168:175], v44
  v_permlane32_swap_b32 v76, v80
  v_permlane32_swap_b32 v77, v81
  v_permlane32_swap_b32 v78, v82
  v_permlane32_swap_b32 v79, v83
  v_pk_add_f32 v[76:77], v[76:77], v[80:81]
  v_pk_add_f32 v[78:79], v[78:79], v[82:83]
  ds_write2_b32 v244, v76, v77 offset0:0 offset1:4
  ds_write2_b32 v244, v78, v79 offset0:8 offset1:12
  ds_write2_b32 v245, v84, v85 offset0:0 offset1:4
  ds_write2_b32 v245, v86, v87 offset0:8 offset1:12
  s_waitcnt lgkmcnt(0) vmcnt(0)
  s_barrier
  s_lshr_b32 s21, 3, s20
  s_bitcmp1_b32 s21, 0
  s_cbranch_scc0 bw_87
  ds_read_b128 v[96:99], v45 offset:0
  ds_read_b128 v[108:111], v45 offset:5440
  ds_read_b128 v[100:103], v45 offset:1088
  ds_read_b128 v[112:115], v45 offset:6528
  ds_read_b128 v[104:107], v45 offset:2176
  ds_read_b128 v[116:119], v45 offset:7616
  s_waitcnt lgkmcnt(4)
  v_pk_add_f32 v[96:97], v[96:97], v[108:109]
  v_pk_add_f32 v[98:99], v[98:99], v[110:111]
  s_nop 0
  v_add_f32_dpp v108, v96, v96 row_ror:8 row_mask:0xf bank_mask:0xf
  v_add_f32_dpp v109, v97, v97 row_ror:8 row_mask:0xf bank_mask:0xf
  v_add_f32_dpp v110, v98, v98 row_ror:8 row_mask:0xf bank_mask:0xf
  v_add_f32_dpp v111, v99, v99 row_ror:8 row_mask:0xf bank_mask:0xf
  v_cvt_pk_bf16_f32 v212, v108, v109
  v_cvt_pk_bf16_f32 v213, v110, v111
  s_waitcnt lgkmcnt(2)
  v_pk_add_f32 v[100:101], v[100:101], v[112:113]
  v_pk_add_f32 v[102:103], v[102:103], v[114:115]
  s_nop 0
  v_add_f32_dpp v112, v100, v100 row_ror:8 row_mask:0xf bank_mask:0xf
  v_add_f32_dpp v113, v101, v101 row_ror:8 row_mask:0xf bank_mask:0xf
  v_add_f32_dpp v114, v102, v102 row_ror:8 row_mask:0xf bank_mask:0xf
  v_add_f32_dpp v115, v103, v103 row_ror:8 row_mask:0xf bank_mask:0xf
  v_cvt_pk_bf16_f32 v214, v112, v113
  v_cvt_pk_bf16_f32 v215, v114, v115
  s_waitcnt lgkmcnt(0)
  v_pk_add_f32 v[104:105], v[104:105], v[116:117]
  v_pk_add_f32 v[106:107], v[106:107], v[118:119]
  v_mfma_f32_16x16x32_bf16 v[96:99], v[168:171], v[212:215], 0
  v_add_f32_dpp v116, v104, v104 row_ror:8 row_mask:0xf bank_mask:0xf
  v_add_f32_dpp v117, v105, v105 row_ror:8 row_mask:0xf bank_mask:0xf
  v_add_f32_dpp v118, v106, v106 row_ror:8 row_mask:0xf bank_mask:0xf
  v_add_f32_dpp v119, v107, v107 row_ror:8 row_mask:0xf bank_mask:0xf
  v_cvt_pk_bf16_f32 v216, v116, v117
  v_cvt_pk_bf16_f32 v217, v118, v119
  s_nop 1
  v_mfma_f32_16x16x32_bf16 v[96:99], v[172:175], v[216:219], v[96:99]
  s_mov_b64 exec, s[74:75]
  s_nop 6
  v_cvt_pk_f16_f32 v100, v96, v97
  v_cvt_pk_f16_f32 v101, v98, v99
  v_and_or_b32 v100, v100, -2, s88
  s_cmp_eq_u32 s53, 1
  s_cbranch_scc1 si_88
  buffer_store_dwordx2 v[100:101], v7, s[8:11], s81 offen sc1
  s_branch si_89
si_88:
  buffer_store_dwordx2 v[100:101], v7, s[8:11], s81 offen
si_89:
  s_mov_b64 exec, -1
  s_branch bw_86
bw_87:
  s_lshr_b32 s21, 4, s20
  s_bitcmp1_b32 s21, 0
  s_cbranch_scc0 bw_90
  ds_read_b128 v[96:99], v6 offset:0
  ds_read_b128 v[108:111], v6 offset:5440
  ds_read_b128 v[120:123], v6 offset:10880
  ds_read_b128 v[132:135], v6 offset:16320
  ds_read_b128 v[100:103], v6 offset:1088
  ds_read_b128 v[112:115], v6 offset:6528
  ds_read_b128 v[124:127], v6 offset:11968
  ds_read_b128 v[136:139], v6 offset:17408
  ds_read_b128 v[104:107], v6 offset:2176
  ds_read_b128 v[116:119], v6 offset:7616
  ds_read_b128 v[128:131], v6 offset:13056
  ds_read_b128 v[140:143], v6 offset:18496
  s_waitcnt lgkmcnt(8)
  v_pk_add_f32 v[96:97], v[96:97], v[108:109]
  v_pk_add_f32 v[120:121], v[120:121], v[132:133]
  v_pk_add_f32 v[98:99], v[98:99], v[110:111]
  v_pk_add_f32 v[122:123], v[122:123], v[134:135]
  v_pk_add_f32 v[96:97], v[96:97], v[120:121]
  v_pk_add_f32 v[98:99], v[98:99], v[122:123]
  v_cvt_pk_bf16_f32 v212, v96, v97
  v_cvt_pk_bf16_f32 v213, v98, v99
  s_waitcnt lgkmcnt(4)
  v_pk_add_f32 v[100:101], v[100:101], v[112:113]
  v_pk_add_f32 v[124:125], v[124:125], v[136:137]
  v_pk_add_f32 v[102:103], v[102:103], v[114:115]
  v_pk_add_f32 v[126:127], v[126:127], v[138:139]
  v_pk_add_f32 v[100:101], v[100:101], v[124:125]
  v_pk_add_f32 v[102:103], v[102:103], v[126:127]
  v_cvt_pk_bf16_f32 v214, v100, v101
  v_cvt_pk_bf16_f32 v215, v102, v103
  s_waitcnt lgkmcnt(0)
  v_pk_add_f32 v[104:105], v[104:105], v[116:117]
  v_pk_add_f32 v[128:129], v[128:129], v[140:141]
  v_pk_add_f32 v[106:107], v[106:107], v[118:119]
  v_pk_add_f32 v[130:131], v[130:131], v[142:143]
  v_mfma_f32_16x16x32_bf16 v[96:99], v[212:215], v[212:215], 0
  v_pk_add_f32 v[104:105], v[104:105], v[128:129]
  v_pk_add_f32 v[106:107], v[106:107], v[130:131]
  v_cvt_pk_bf16_f32 v216, v104, v105
  v_cvt_pk_bf16_f32 v217, v106, v107
  s_nop 1
  v_mfma_f32_16x16x32_bf16 v[96:99], v[216:219], v[216:219], v[96:99]
  s_mov_b64 exec, s[74:75]
  s_nop 6
  v_cvt_pk_f16_f32 v100, v96, v97
  v_cvt_pk_f16_f32 v101, v98, v99
  v_and_or_b32 v100, v100, -2, s88
  s_cmp_eq_u32 s53, 1
  s_cbranch_scc1 si_91
  buffer_store_dwordx2 v[100:101], v7, s[8:11], s81 offen sc1
  s_branch si_92
si_91:
  buffer_store_dwordx2 v[100:101], v7, s[8:11], s81 offen
si_92:
  s_mov_b64 exec, -1
  s_branch bw_86
bw_90:
  s_lshr_b32 s21, 8, s20
  s_bitcmp1_b32 s21, 0
  s_cbranch_scc0 bw_93
  ds_read_b128 v[96:99], v6 offset:3264
  ds_read_b128 v[100:103], v6 offset:8704
  ds_read_b128 v[104:107], v6 offset:14144
  ds_read_b128 v[108:111], v6 offset:19584
  ds_read_b128 v[112:115], v6 offset:4352
  ds_read_b128 v[116:119], v6 offset:9792
  ds_read_b128 v[120:123], v6 offset:15232
  ds_read_b128 v[124:127], v6 offset:20672
  s_waitcnt lgkmcnt(4)
  v_pk_add_f32 v[96:97], v[96:97], v[100:101]
  v_pk_add_f32 v[98:99], v[98:99], v[102:103]
  v_pk_add_f32 v[104:105], v[104:105], v[108:109]
  v_pk_add_f32 v[106:107], v[106:107], v[110:111]
  v_pk_add_f32 v[96:97], v[96:97], v[104:105]
  v_pk_add_f32 v[98:99], v[98:99], v[106:107]
  v_cvt_pk_bf16_f32 v90, v96, v97
  v_cvt_pk_bf16_f32 v91, v98, v99
  v_min_u32 v90, -2, v90
  v_min_u32 v91, -2, v91
  s_cmp_eq_u32 s53, 1
  s_cbranch_scc1 si_94
  buffer_store_dwordx2 v[90:91], v24, s[8:11], s81 offen sc1
  s_branch si_95
si_94:
  buffer_store_dwordx2 v[90:91], v24, s[8:11], s81 offen
si_95:
  s_waitcnt lgkmcnt(0)
  v_pk_add_f32 v[112:113], v[112:113], v[116:117]
  v_pk_add_f32 v[114:115], v[114:115], v[118:119]
  v_pk_add_f32 v[120:121], v[120:121], v[124:125]
  v_pk_add_f32 v[122:123], v[122:123], v[126:127]
  v_pk_add_f32 v[112:113], v[112:113], v[120:121]
  v_pk_add_f32 v[114:115], v[114:115], v[122:123]
  s_nop 1
  v_add_f32_dpp v116, v112, v112 row_ror:8 row_mask:0xf bank_mask:0xf
  v_add_f32_dpp v117, v113, v113 row_ror:8 row_mask:0xf bank_mask:0xf
  v_add_f32_dpp v118, v114, v114 row_ror:8 row_mask:0xf bank_mask:0xf
  v_add_f32_dpp v119, v115, v115 row_ror:8 row_mask:0xf bank_mask:0xf
  v_cvt_pk_bf16_f32 v92, v116, v117
  v_cvt_pk_bf16_f32 v93, v118, v119
  v_min_u32 v92, -2, v92
  v_min_u32 v93, -2, v93
  s_mov_b64 exec, s[60:61]
  s_cmp_eq_u32 s53, 1
  s_cbranch_scc1 si_96
  buffer_store_dwordx2 v[92:93], v23, s[8:11], s78 offen sc1
  s_branch si_97
si_96:
  buffer_store_dwordx2 v[92:93], v23, s[8:11], s78 offen
si_97:
  s_mov_b64 exec, -1
  s_branch bw_86
bw_93:
bw_86:
  s_cmp_eq_u32 s52, 63
  s_cbranch_scc1 last_82
  s_mov_b32 s54, 0
pv_98:
  buffer_load_dwordx4 v[144:147], v10, s[8:11], s81 offen offset:0 sc1
  buffer_load_dwordx4 v[148:151], v10, s[8:11], s81 offen offset:1024 sc1
  buffer_load_dwordx4 v[152:155], v10, s[8:11], s81 offen offset:2048 sc1
  v_mov_b32 v188, 0
  v_mov_b32 v189, 0
  v_mov_b32 v190, 0
  v_mov_b32 v191, 0
  v_mov_b32 v192, 0
  v_mov_b32 v193, 0
  v_mov_b32 v194, 0
  v_mov_b32 v195, 0
  v_mov_b32 v196, 0
  v_mov_b32 v197, 0
  v_mov_b32 v198, 0
  v_mov_b32 v199, 0
  s_add_u32 s54, s54, 1
  s_cmp_gt_u32 s54, 131072
  s_cbranch_scc1 end0
  s_waitcnt vmcnt(0)
  v_max3_u32 v27, v144, v146, v148
  v_max3_u32 v27, v27, v150, v152
  v_max3_u32 v27, v27, v154, v154
  v_cmp_eq_u32 vcc, -1, v27
  s_nop 1
  s_cbranch_vccnz pv_98
  buffer_load_dwordx2 v[248:249], v9, s[8:11], s81 offen sc1
  buffer_load_dwordx4 v[112:115], v8, s[8:11], s81 offen offset:0 sc1
  buffer_load_dwordx4 v[116:119], v8, s[8:11], s81 offen offset:1024 sc1
  v_smfmac_f32_16x16x64_bf16 v[188:191], v[144:147], a[180:187], v44
  v_smfmac_f32_16x16x64_bf16 v[192:195], v[144:147], a[204:211], v44
  v_smfmac_f32_16x16x64_bf16 v[196:199], v[144:147], a[228:235], v44
  v_smfmac_f32_16x16x64_bf16 v[188:191], v[148:151], a[188:195], v44
  v_smfmac_f32_16x16x64_bf16 v[192:195], v[148:151], a[212:219], v44
  v_smfmac_f32_16x16x64_bf16 v[196:199], v[148:151], a[236:243], v44
  v_smfmac_f32_16x16x64_bf16 v[188:191], v[152:155], a[196:203], v44
  v_smfmac_f32_16x16x64_bf16 v[192:195], v[152:155], a[220:227], v44
  v_smfmac_f32_16x16x64_bf16 v[196:199], v[152:155], a[244:251], v44
  v_readfirstlane_b32 s21, v94
  s_add_u32 s22, s46, 8
  s_min_u32 s22, s22, 64
  s_sub_u32 s55, s21, s22
  s_sub_u32 s56, s21, s46
  s_waitcnt vmcnt(2)
  v_xor_b32 v96, s88, v248
  s_nop 0
  v_permlane16_swap_b32 v248, v249
  v_fma_mix_f32 v250, v248, 1.0, v249 op_sel:[0,0,0] op_sel_hi:[1,0,1]
  v_fma_mix_f32 v251, v248, 1.0, v249 op_sel:[1,0,1] op_sel_hi:[1,0,1]
  v_mov_b32 v248, v250
  v_mov_b32 v249, v251
  s_nop 0
  v_permlane32_swap_b32 v248, v250
  v_permlane32_swap_b32 v249, v251
  s_waitcnt vmcnt(0)
  v_bitop3_b32 v97, v112, v114, s88 bitop3:0x7e
  v_bitop3_b32 v98, v116, v118, s88 bitop3:0x7e
  v_fma_mix_f32 v120, v112, 1.0, v116 op_sel:[0,0,0] op_sel_hi:[1,0,1]
  v_or3_b32 v27, v96, v97, v98
  v_fma_mix_f32 v124, v114, 1.0, v118 op_sel:[0,0,0] op_sel_hi:[1,0,1]
  v_and_b32 v27, 1, v27
  v_fma_mix_f32 v121, v112, 1.0, v116 op_sel:[1,0,1] op_sel_hi:[1,0,1]
  v_cmp_ne_u32 vcc, 0, v27
  v_fma_mix_f32 v125, v114, 1.0, v118 op_sel:[1,0,1] op_sel_hi:[1,0,1]
  v_fma_mix_f32 v122, v113, 1.0, v117 op_sel:[0,0,0] op_sel_hi:[1,0,1]
  v_fma_mix_f32 v126, v115, 1.0, v119 op_sel:[0,0,0] op_sel_hi:[1,0,1]
  s_cbranch_vccnz psr_99
psj_100:
  s_cmp_lt_i32 s56, 0
  s_cbranch_scc1 kvw_101
kvok_102:
  buffer_load_dwordx4 v[160:163], v16, s[28:31], s64 offen offset:0 sc1
  v_fma_mix_f32 v123, v113, 1.0, v117 op_sel:[1,0,1] op_sel_hi:[1,0,1]
  buffer_load_dwordx4 v[164:167], v16, s[28:31], s64 offen offset:1024 sc1
  v_fma_mix_f32 v127, v115, 1.0, v119 op_sel:[1,0,1] op_sel_hi:[1,0,1]
  buffer_load_dwordx4 v[48:51], v16, s[28:31], s64 offen offset:2048 sc1
  v_permlane32_swap_b32 v120, v124
  v_permlane32_swap_b32 v121, v125
  v_permlane32_swap_b32 v122, v126
  s_lshr_b32 s21, 3, s20
  s_bitcmp1_b32 s21, 0
  s_cbranch_scc0 bw_104
  buffer_load_dwordx2 v[168:169], v18, s[16:19], s80 offen sc1
  s_branch bw_103
bw_104:
  s_lshr_b32 s21, 4, s20
  s_bitcmp1_b32 s21, 0
  s_cbranch_scc0 bw_105
  s_mov_b64 exec, s[62:63]
  buffer_store_dwordx2 v[212:213], v21, s[24:27], s85 offen sc1
  s_mov_b64 exec, -1
  s_branch bw_103
bw_105:
  s_lshr_b32 s21, 8, s20
  s_bitcmp1_b32 s21, 0
  s_cbranch_scc0 bw_106
  buffer_store_dwordx2 v[90:91], v25, s[24:27], s57 offen sc1
  s_branch bw_103
bw_106:
bw_103:
  v_permlane32_swap_b32 v123, v127
  v_pk_add_f32 v[120:121], v[120:121], v[124:125]
  v_pk_add_f32 v[122:123], v[122:123], v[126:127]
  s_lshr_b32 s21, 3, s20
  s_bitcmp1_b32 s21, 0
  s_cbranch_scc0 bw_108
  buffer_load_dwordx2 v[170:171], v19, s[16:19], s80 offen sc1
  s_branch bw_107
bw_108:
  s_lshr_b32 s21, 4, s20
  s_bitcmp1_b32 s21, 0
  s_cbranch_scc0 bw_109
  s_mov_b64 exec, s[62:63]
  buffer_store_dwordx2 v[214:215], v22, s[24:27], s85 offen sc1
  s_mov_b64 exec, -1
  s_branch bw_107
bw_109:
  s_lshr_b32 s21, 8, s20
  s_bitcmp1_b32 s21, 0
  s_cbranch_scc0 bw_110
  s_mov_b64 exec, s[60:61]
  buffer_store_dwordx2 v[92:93], v23, s[24:27], s57 offen sc1
  s_mov_b64 exec, -1
  s_branch bw_107
bw_110:
bw_107:
  v_pk_add_f32 v[124:125], v[248:249], v[250:251]
  v_max3_f32 v236, v120, v121, v122
  v_max3_f32 v237, v123, v124, v125
  s_lshr_b32 s21, 3, s20
  s_bitcmp1_b32 s21, 0
  s_cbranch_scc0 bw_112
  buffer_load_dwordx2 v[172:173], v20, s[16:19], s80 offen sc1
  s_branch bw_111
bw_112:
  s_lshr_b32 s21, 4, s20
  s_bitcmp1_b32 s21, 0
  s_cbranch_scc0 bw_113
  s_mov_b64 exec, s[62:63]
  buffer_store_dwordx2 v[216:217], v23, s[24:27], s85 offen sc1
  s_mov_b64 exec, -1
  s_branch bw_111
bw_113:
  s_lshr_b32 s21, 8, s20
  s_bitcmp1_b32 s21, 0
  s_cbranch_scc0 bw_114
  v_mov_b32 v240, s52
  v_mov_b32 v241, s52
  s_mov_b64 exec, 1
  buffer_store_dwordx2 v[240:241], v95, s[12:15], s90 offen sc1
  s_mov_b64 exec, -1
  s_branch bw_111
bw_114:
bw_111:
  v_max_f32 v236, v236, v237
  v_cvt_pk_bf16_f32 v228, v188, v189
  v_cvt_pk_bf16_f32 v229, v190, v191
  v_max_f32_dpp v236, v236, v236 row_ror:8 row_mask:0xf bank_mask:0xf
  v_mov_b32 v237, v236
  s_cmp_lt_i32 s55, 0
  s_cbranch_scc1 fl_115
fl_116:
  v_cvt_pk_bf16_f32 v230, v192, v193
  v_cvt_pk_bf16_f32 v231, v194, v195
  v_permlane32_swap_b32 v236, v237
  v_max_f32 v236, v236, v237
  v_mov_b32 v237, v236
  v_cvt_pk_bf16_f32 v232, v196, v197
  v_cvt_pk_bf16_f32 v233, v198, v199
  v_permlane16_swap_b32 v236, v237
  v_max_f32 v236, v236, v237
  v_mul_f32 v236, s86, v236
  v_fma_f32 v120, v120, s86, -v236
  v_fma_f32 v121, v121, s86, -v236
  v_fma_f32 v122, v122, s86, -v236
  v_fma_f32 v123, v123, s86, -v236
  v_fma_f32 v124, v124, s86, -v236
  v_fma_f32 v125, v125, s86, -v236
  v_exp_f32 v120, v120
  v_exp_f32 v121, v121
  v_exp_f32 v122, v122
  v_exp_f32 v123, v123
  v_exp_f32 v124, v124
  v_exp_f32 v125, v125
  s_mov_b64 exec, s[60:61]
  v_cvt_pk_bf16_f32 v220, v120, v121
  v_cvt_pk_bf16_f32 v221, v122, v123
  v_cvt_pk_bf16_f32 v224, v124, v125
  s_mov_b64 exec, s[62:63]
  v_cvt_pk_bf16_f32 v222, v120, v121
  v_cvt_pk_bf16_f32 v223, v122, v123
  v_cvt_pk_bf16_f32 v225, v124, v125
  s_mov_b64 exec, -1
  v_pk_add_f32 v[126:127], v[120:121], v[122:123]
  v_add_f32 v128, v124, v125
  v_mfma_f32_16x16x32_bf16 v[200:203], v[176:179], v[220:223], 0
  v_add_f32 v236, v126, v127
  v_fmac_f32 v236, v128, v89
  v_mfma_f32_16x16x32_bf16 v[204:207], v[180:183], v[220:223], 0
  v_mfma_f32_16x16x32_bf16 v[208:211], v[184:187], v[220:223], 0
  v_add_f32_dpp v236, v236, v236 row_ror:8 row_mask:0xf bank_mask:0xf
  v_mov_b32 v237, v236
  s_nop 0
  v_mfma_f32_16x16x32_bf16 v[200:203], v[228:231], v[224:227], v[200:203]
  v_mfma_f32_16x16x32_bf16 v[204:207], v[230:233], v[224:227], v[204:207]
  v_permlane32_swap_b32 v236, v237
  v_add_f32 v236, v236, v237
  v_mov_b32 v237, v236
  v_mfma_f32_16x16x32_bf16 v[208:211], v[232:235], v[224:227], v[208:211]
  s_nop 0
  v_permlane16_swap_b32 v236, v237
  v_add_f32 v236, v236, v237
  v_rcp_f32 v236, v236
  s_nop 2
  v_pk_mul_f32 v[200:201], v[200:201], v[236:237] op_sel_hi:[1,0]
  v_pk_mul_f32 v[202:203], v[202:203], v[236:237] op_sel_hi:[1,0]
  ds_write_b128 v11, v[200:203] offset:0
  v_pk_mul_f32 v[204:205], v[204:205], v[236:237] op_sel_hi:[1,0]
  v_pk_mul_f32 v[206:207], v[206:207], v[236:237] op_sel_hi:[1,0]
  ds_write_b128 v11, v[204:207] offset:1024
  v_pk_mul_f32 v[208:209], v[208:209], v[236:237] op_sel_hi:[1,0]
  v_pk_mul_f32 v[210:211], v[210:211], v[236:237] op_sel_hi:[1,0]
  ds_write_b128 v11, v[208:211] offset:2048
  s_waitcnt lgkmcnt(0)
  s_barrier
  s_lshr_b32 s21, 7, s20
  s_bitcmp1_b32 s21, 0
  s_cbranch_scc0 bw_118
  ds_read_b64 v[96:97], v12 offset:0
  ds_read_b64 v[98:99], v12 offset:128
  ds_read_b64 v[100:101], v12 offset:3072
  ds_read_b64 v[102:103], v12 offset:3200
  ds_read_b64 v[104:105], v12 offset:6144
  ds_read_b64 v[106:107], v12 offset:6272
  ds_read_b64 v[108:109], v12 offset:9216
  ds_read_b64 v[110:111], v12 offset:9344
  s_waitcnt lgkmcnt(6)
  v_pk_add_f32 v[96:97], v[96:97], v[98:99]
  s_waitcnt lgkmcnt(4)
  v_pk_add_f32 v[100:101], v[100:101], v[102:103]
  s_waitcnt lgkmcnt(2)
  v_pk_add_f32 v[104:105], v[104:105], v[106:107]
  v_pk_add_f32 v[96:97], v[96:97], v[100:101]
  s_waitcnt lgkmcnt(0)
  v_pk_add_f32 v[108:109], v[108:109], v[110:111]
  v_pk_add_f32 v[96:97], v[96:97], v[104:105]
  v_pk_add_f32 v[96:97], v[96:97], v[108:109]
  v_cvt_pk_f16_f32 v100, v96, v97
  v_perm_b32 v100, s91, v100, v14
  buffer_atomic_pk_add_f16 v100, v13, s[4:7], s3 offen
  s_branch bw_117
bw_118:
  s_lshr_b32 s21, 8, s20
  s_bitcmp1_b32 s21, 0
  s_cbranch_scc0 bw_119
  v_mov_b32 v28, -1
  v_mov_b32 v29, -1
  s_cmp_eq_u32 s53, 1
  s_cbranch_scc1 si_120
  buffer_store_dwordx2 v[28:29], v24, s[8:11], s82 offen sc1
  s_branch si_121
si_120:
  buffer_store_dwordx2 v[28:29], v24, s[8:11], s82 offen
si_121:
  s_mov_b64 exec, s[60:61]
  s_add_u32 s22, s82, 278528
  s_cmp_eq_u32 s53, 1
  s_cbranch_scc1 si_122
  buffer_store_dwordx2 v[28:29], v23, s[8:11], s22 offen sc1
  s_branch si_123
si_122:
  buffer_store_dwordx2 v[28:29], v23, s[8:11], s22 offen
si_123:
  s_and_b32 s21, s52, 7
  s_cmp_lg_u32 s21, s50
  s_cbranch_scc1 zm_124
  s_mov_b64 exec, s[70:71]
  buffer_store_dwordx4 v[156:159], v13, s[4:7], s83 offen sc1
zm_124:
  s_mov_b64 exec, -1
  s_branch bw_117
bw_119:
bw_117:
  s_add_u32 s64, s64, 1310720
  s_add_u32 s52, s52, 1
  s_and_b32 s21, s52, 3
  s_mul_i32 s81, s21, 540672
  s_lshl_b32 s84, s21, 15
  s_branch step_81
pm_83:
  s_mov_b32 s47, 1
  buffer_load_dwordx4 v[96:99], v4, s[4:7], s84 offen offset:0 sc1
  buffer_load_dwordx4 v[100:103], v4, s[4:7], s84 offen offset:1024 sc1
  buffer_load_dwordx4 v[104:107], v4, s[4:7], s84 offen offset:2048 sc1
  s_add_u32 s54, s54, 1
  s_cmp_gt_u32 s54, 131072
  s_cbranch_scc1 end0
  s_waitcnt vmcnt(0)
  v_bitop3_b32 v27, v99, v103, v107 bitop3:0x80
  v_cvt_f32_f16 v108, v99
  v_and_b32 v27, 0x48000000, v27
  v_cvt_f32_f16 v109, v103
  v_cmp_ne_u32 vcc, 0x48000000, v27
  v_cvt_f32_f16 v110, v106
  v_cvt_f32_f16_sdwa v111, v106 dst_sel:DWORD dst_unused:UNUSED_PAD src0_sel:WORD_1
  v_cvt_pk_bf16_f32 v40, v110, v111
  s_cbranch_vccnz pm_83
  s_branch pm_84
A1_18:
  v_smfmac_f32_16x16x32_bf16 v[52:55], v[40:41], a[16:19], v44
  v_smfmac_f32_16x16x32_bf16 v[64:67], v[40:41], a[76:79], v44
  v_smfmac_f32_16x16x32_bf16 v[56:59], v[40:41], a[36:39], v44
  v_smfmac_f32_16x16x32_bf16 v[68:71], v[40:41], a[96:99], v44
  v_smfmac_f32_16x16x32_bf16 v[60:63], v[40:41], a[56:59], v44
  v_smfmac_f32_16x16x32_bf16 v[72:75], v[40:41], a[116:119], v44
  v_smfmac_f32_16x16x32_bf16 v[76:79], v[40:41], a[136:139], v44
  v_smfmac_f32_16x16x32_bf16 v[80:83], v[40:41], a[156:159], v44
  v_smfmac_f32_16x16x32_bf16 v[84:87], v[40:41], a[176:179], v44
  s_branch A2_85
psr_99:
  buffer_load_dwordx2 v[248:249], v9, s[8:11], s81 offen sc1
  buffer_load_dwordx4 v[112:115], v8, s[8:11], s81 offen offset:0 sc1
  buffer_load_dwordx4 v[116:119], v8, s[8:11], s81 offen offset:1024 sc1
  s_add_u32 s54, s54, 1
  s_cmp_gt_u32 s54, 131072
  s_cbranch_scc1 end0
  s_waitcnt vmcnt(2)
  v_xor_b32 v96, s88, v248
  s_nop 0
  v_permlane16_swap_b32 v248, v249
  v_fma_mix_f32 v250, v248, 1.0, v249 op_sel:[0,0,0] op_sel_hi:[1,0,1]
  v_fma_mix_f32 v251, v248, 1.0, v249 op_sel:[1,0,1] op_sel_hi:[1,0,1]
  v_mov_b32 v248, v250
  v_mov_b32 v249, v251
  s_nop 0
  v_permlane32_swap_b32 v248, v250
  v_permlane32_swap_b32 v249, v251
  s_waitcnt vmcnt(0)
  v_bitop3_b32 v97, v112, v114, s88 bitop3:0x7e
  v_bitop3_b32 v98, v116, v118, s88 bitop3:0x7e
  v_fma_mix_f32 v120, v112, 1.0, v116 op_sel:[0,0,0] op_sel_hi:[1,0,1]
  v_or3_b32 v27, v96, v97, v98
  v_fma_mix_f32 v124, v114, 1.0, v118 op_sel:[0,0,0] op_sel_hi:[1,0,1]
  v_and_b32 v27, 1, v27
  v_fma_mix_f32 v121, v112, 1.0, v116 op_sel:[1,0,1] op_sel_hi:[1,0,1]
  v_cmp_ne_u32 vcc, 0, v27
  v_fma_mix_f32 v125, v114, 1.0, v118 op_sel:[1,0,1] op_sel_hi:[1,0,1]
  v_fma_mix_f32 v122, v113, 1.0, v117 op_sel:[0,0,0] op_sel_hi:[1,0,1]
  v_fma_mix_f32 v126, v115, 1.0, v119 op_sel:[0,0,0] op_sel_hi:[1,0,1]
  s_cbranch_vccnz psr_99
  s_branch psj_100
kvw_101:
  s_cmp_eq_u32 s52, 0
  s_cselect_b32 s23, 1, s46
  s_cselect_b32 s55, 0, s55
  v_mov_b32 v236, 0
  s_mov_b32 s101, 0
wf_125:
  buffer_load_dword v237, v236, s[12:15], s79 offen sc1
  s_add_u32 s101, s101, 1
  s_cmp_gt_u32 s101, 131072
  s_cbranch_scc1 end0
  s_waitcnt vmcnt(0)
  v_readfirstlane_b32 s100, v237
  s_cmp_ge_u32 s100, s23
  s_cbranch_scc1 wf_126
  s_sleep 3
  s_branch wf_125
wf_126:
  s_cmp_gt_u32 s52, 1
  s_cbranch_scc1 kvok_102
  s_sub_u32 s21, s64, 1310720
  buffer_load_dwordx4 v[176:179], v16, s[28:31], s21 offen offset:0 sc1
  buffer_load_dwordx4 v[180:183], v16, s[28:31], s21 offen offset:1024 sc1
  buffer_load_dwordx4 v[184:187], v16, s[28:31], s21 offen offset:2048 sc1
  s_waitcnt vmcnt(0)
  s_branch kvok_102
fl_115:
  buffer_load_dword v94, v95, s[12:15], s79 offen sc1
  s_branch fl_116
last_82:
  s_lshr_b32 s21, 1, s20
  s_bitcmp1_b32 s21, 0
  s_cbranch_scc0 bw_128
  v_mov_b32 v246, 80
  v_mov_b32 v247, 1
  s_mov_b64 exec, 1
  buffer_atomic_add v247, v246, s[32:35], 0 offen sc0 sc1
  s_mov_b64 exec, -1
clm_129:
  s_branch bw_127
bw_128:
bw_127:
  s_lshr_b32 s21, 4, s20
  s_bitcmp1_b32 s21, 0
  s_cbranch_scc0 bw_131
  s_mov_b64 exec, s[62:63]
  buffer_store_dwordx2 v[212:213], v21, s[24:27], s85 offen sc1
  buffer_store_dwordx2 v[214:215], v22, s[24:27], s85 offen sc1
  buffer_store_dwordx2 v[216:217], v23, s[24:27], s85 offen sc1
  s_mov_b64 exec, 1
  s_waitcnt vmcnt(0)
  v_mov_b32 v236, 64
  buffer_store_dword v236, v95, s[12:15], s90 offen sc1
  s_mov_b64 exec, -1
  s_branch bw_130
bw_131:
  s_lshr_b32 s21, 8, s20
  s_bitcmp1_b32 s21, 0
  s_cbranch_scc0 bw_132
  buffer_store_dwordx2 v[90:91], v25, s[24:27], s57 offen sc1
  s_mov_b64 exec, s[60:61]
  buffer_store_dwordx2 v[92:93], v23, s[24:27], s57 offen sc1
  s_mov_b64 exec, 1
  s_waitcnt vmcnt(0)
  v_mov_b32 v236, 64
  buffer_store_dword v236, v95, s[12:15], s90 offen offset:4 sc1
  s_mov_b64 exec, -1
  s_branch bw_130
bw_132:
bw_130:
  s_branch chain_done
chain_done:
  s_waitcnt vmcnt(0) lgkmcnt(0)
  s_barrier
  s_mov_b32 s84, 0
  s_mov_b32 s85, -1
  s_mov_b32 s86, 0
  v_mov_b32 v21, 0
  v_mov_b32 v23, v247
  s_cmp_lg_u32 s20, 0
  s_cbranch_scc1 queue_b
  s_mov_b64 exec, 1
  s_branch queue_a
end0:
  s_endpgm
gemm_side:
  s_bfe_u32 s23, s22, 0x20005
  s_add_u32 s22, s22, 31
  s_and_b32 s22, s22, 31
  s_lshl_b32 s21, s23, 3
  s_add_u32 s2, s21, s22
  s_add_u32 s3, s2, 72
  s_add_u32 s24, s2, 48
  s_add_u32 s2, s2, s21
  s_cmp_lt_u32 s22, 24
  s_cselect_b32 s3, s24, s3
  s_cmp_lt_u32 s22, 16
  s_cselect_b32 s3, s2, s3
  s_mov_b32 s2, s3
  s_cmp_ge_u32 s3, 64
  s_cbranch_scc1 not_kv
  s_load_dwordx2 s[4:5], s[0:1], 0
  s_load_dwordx2 s[6:7], s[0:1], 24
  s_load_dwordx2 s[36:37], s[0:1], 32
  s_load_dwordx2 s[38:39], s[0:1], 104
  s_and_b32 s43, s3, 1
  s_bfe_u32 s42, s3, 0x50001
  s_lshr_b32 s40, s42, 2
  s_waitcnt lgkmcnt(0)
  s_cmp_eq_u32 s43, 1
  s_cselect_b32 s6, s36, s6
  s_cselect_b32 s7, s37, s7
  s_mov_b32 s8, s4
  s_mov_b32 s9, s5
  s_mov_b32 s10, 2621440
  s_mov_b32 s11, 0x00020000
  s_mov_b32 s12, s6
  s_mov_b32 s13, s7
  s_mov_b32 s14, 7864320
  s_mov_b32 s15, 0x00020000
  s_mov_b32 s16, s38
  s_mov_b32 s17, s39
  s_mov_b32 s18, 50331648
  s_mov_b32 s19, 0x00020000
  s_mul_i32 s44, s42, 384
  s_mov_b32 s62, 1024
  s_mov_b32 s24, 0
  s_mov_b32 s25, 81920
  s_mov_b32 s64, s32
  s_mov_b32 s65, s33
  s_mov_b32 s66, s34
  s_mov_b32 s67, s35
  s_load_dwordx2 s[72:73], s[0:1], 104
  s_waitcnt lgkmcnt(0)
  s_add_u32 s72, s72, 81068032
  s_addc_u32 s73, s73, 0
  s_mov_b32 s74, 117760
  s_mov_b32 s75, 0x00020000
  v_mov_b32 v9, 2731
  v_add_u32 v8, 0, v1
  v_mul_u32_u24 v7, v8, v9
  v_lshrrev_b32 v7, 16, v7
  v_mul_u32_u24 v4, 24, v7
  v_sub_u32 v8, v8, v4
  s_mov_b32 s21, 12288
  v_mul_lo_u32 v7, v7, s21
  v_lshl_add_u32 v4, v8, 4, v7
  v_add_u32 v8, 64, v1
  v_mul_u32_u24 v7, v8, v9
  v_lshrrev_b32 v7, 16, v7
  v_mul_u32_u24 v5, 24, v7
  v_sub_u32 v8, v8, v5
  s_mov_b32 s21, 12288
  v_mul_lo_u32 v7, v7, s21
  v_lshl_add_u32 v5, v8, 4, v7
  v_add_u32 v8, 128, v1
  v_mul_u32_u24 v7, v8, v9
  v_lshrrev_b32 v7, 16, v7
  v_mul_u32_u24 v6, 24, v7
  v_sub_u32 v8, v8, v6
  s_mov_b32 s21, 12288
  v_mul_lo_u32 v7, v7, s21
  v_lshl_add_u32 v6, v8, 4, v7
  v_lshrrev_b32 v7, 2, v2
  v_lshl_add_u32 v7, v3, 3, v7
  v_mul_u32_u24 v7, 384, v7
  v_and_b32 v8, 3, v2
  v_lshlrev_b32 v8, 3, v8
  s_mul_i32 s21, s20, 96
  v_add3_u32 v7, v7, v8, s21
  v_add_u32 v8, 49152, v7
  s_mul_i32 s21, s20, 393216
  s_add_u32 s21, s21, 0
  s_add_u32 s21, s21, s44
  s_mul_i32 s22, s20, 12288
  s_add_u32 s22, s22, 0
  s_add_u32 m0, s22, 0
  s_nop 0
  buffer_load_dwordx4 v4, s[12:15], s21 offen lds
  s_add_u32 m0, s22, 1024
  s_nop 0
  buffer_load_dwordx4 v5, s[12:15], s21 offen lds
  s_add_u32 m0, s22, 2048
  s_nop 0
  buffer_load_dwordx4 v6, s[12:15], s21 offen lds
  s_mul_i32 s21, s20, 393216
  s_add_u32 s21, s21, 98304
  s_add_u32 s21, s21, s44
  s_mul_i32 s22, s20, 12288
  s_add_u32 s22, s22, 3072
  s_add_u32 m0, s22, 0
  s_nop 0
  buffer_load_dwordx4 v4, s[12:15], s21 offen lds
  s_add_u32 m0, s22, 1024
  s_nop 0
  buffer_load_dwordx4 v5, s[12:15], s21 offen lds
  s_add_u32 m0, s22, 2048
  s_nop 0
  buffer_load_dwordx4 v6, s[12:15], s21 offen lds
  s_mul_i32 s21, s20, 393216
  s_add_u32 s21, s21, 196608
  s_add_u32 s21, s21, s44
  s_mul_i32 s22, s20, 12288
  s_add_u32 s22, s22, 6144
  s_add_u32 m0, s22, 0
  s_nop 0
  buffer_load_dwordx4 v4, s[12:15], s21 offen lds
  s_add_u32 m0, s22, 1024
  s_nop 0
  buffer_load_dwordx4 v5, s[12:15], s21 offen lds
  s_add_u32 m0, s22, 2048
  s_nop 0
  buffer_load_dwordx4 v6, s[12:15], s21 offen lds
  s_mul_i32 s21, s20, 393216
  s_add_u32 s21, s21, 294912
  s_add_u32 s21, s21, s44
  s_mul_i32 s22, s20, 12288
  s_add_u32 s22, s22, 9216
  s_add_u32 m0, s22, 0
  s_nop 0
  buffer_load_dwordx4 v4, s[12:15], s21 offen lds
  s_add_u32 m0, s22, 1024
  s_nop 0
  buffer_load_dwordx4 v5, s[12:15], s21 offen lds
  s_add_u32 m0, s22, 2048
  s_nop 0
  buffer_load_dwordx4 v6, s[12:15], s21 offen lds
  v_lshrrev_b32 v11, 3, v1
  v_and_b32 v12, 7, v1
  v_xor_b32 v12, v12, v11
  v_mul_u32_u24 v11, 1280, v11
  v_lshl_add_u32 v10, v12, 4, v11
  s_mul_i32 s46, s20, 20480
  v_add_u32 v10, s46, v10
  s_lshl_b32 s47, s20, 11
  s_add_u32 s47, s47, 98304
  s_add_u32 s46, s47, 57344
  s_mov_b32 s30, s24
  s_add_u32 s32, s47, 0
  v_add_u32 v11, 9216, v10
  s_mov_b32 m0, s32
  s_nop 0
  buffer_load_dwordx4 v10, s[8:11], s30 offen offset:0 lds
  buffer_load_dwordx4 v11, s[8:11], s30 offen offset:1024 lds
  s_add_u32 s30, s30, 128
  s_add_u32 s32, s32, 8192
  s_cmp_lt_u32 s32, s46
  s_cselect_b32 s32, s32, s47
  s_mov_b32 m0, s32
  s_nop 0
  buffer_load_dwordx4 v10, s[8:11], s30 offen offset:0 lds
  buffer_load_dwordx4 v11, s[8:11], s30 offen offset:1024 lds
  s_add_u32 s30, s30, 128
  s_add_u32 s32, s32, 8192
  s_cmp_lt_u32 s32, s46
  s_cselect_b32 s32, s32, s47
  s_mov_b32 m0, s32
  s_nop 0
  buffer_load_dwordx4 v10, s[8:11], s30 offen offset:0 lds
  buffer_load_dwordx4 v11, s[8:11], s30 offen offset:1024 lds
  s_add_u32 s30, s30, 128
  s_add_u32 s32, s32, 8192
  s_cmp_lt_u32 s32, s46
  s_cselect_b32 s32, s32, s47
  s_mov_b32 m0, s32
  s_nop 0
  buffer_load_dwordx4 v10, s[8:11], s30 offen offset:0 lds
  buffer_load_dwordx4 v11, s[8:11], s30 offen offset:1024 lds
  s_add_u32 s30, s30, 128
  s_add_u32 s32, s32, 8192
  s_cmp_lt_u32 s32, s46
  s_cselect_b32 s32, s32, s47
  s_mov_b32 m0, s32
  s_nop 0
  buffer_load_dwordx4 v10, s[8:11], s30 offen offset:0 lds
  buffer_load_dwordx4 v11, s[8:11], s30 offen offset:1024 lds
  s_add_u32 s30, s30, 128
  s_add_u32 s32, s32, 8192
  s_cmp_lt_u32 s32, s46
  s_cselect_b32 s32, s32, s47
  s_mul_i32 s21, s20, 393216
  s_add_u32 s21, s21, 1572864
  s_add_u32 s21, s21, s44
  s_mul_i32 s22, s20, 12288
  s_add_u32 s22, s22, 49152
  s_add_u32 m0, s22, 0
  s_nop 0
  buffer_load_dwordx4 v4, s[12:15], s21 offen lds
  s_add_u32 m0, s22, 1024
  s_nop 0
  buffer_load_dwordx4 v5, s[12:15], s21 offen lds
  s_add_u32 m0, s22, 2048
  s_nop 0
  buffer_load_dwordx4 v6, s[12:15], s21 offen lds
  s_mul_i32 s21, s20, 393216
  s_add_u32 s21, s21, 1671168
  s_add_u32 s21, s21, s44
  s_mul_i32 s22, s20, 12288
  s_add_u32 s22, s22, 52224
  s_add_u32 m0, s22, 0
  s_nop 0
  buffer_load_dwordx4 v4, s[12:15], s21 offen lds
  s_add_u32 m0, s22, 1024
  s_nop 0
  buffer_load_dwordx4 v5, s[12:15], s21 offen lds
  s_add_u32 m0, s22, 2048
  s_nop 0
  buffer_load_dwordx4 v6, s[12:15], s21 offen lds
  s_mul_i32 s21, s20, 393216
  s_add_u32 s21, s21, 1769472
  s_add_u32 s21, s21, s44
  s_mul_i32 s22, s20, 12288
  s_add_u32 s22, s22, 55296
  s_add_u32 m0, s22, 0
  s_nop 0
  buffer_load_dwordx4 v4, s[12:15], s21 offen lds
  s_add_u32 m0, s22, 1024
  s_nop 0
  buffer_load_dwordx4 v5, s[12:15], s21 offen lds
  s_add_u32 m0, s22, 2048
  s_nop 0
  buffer_load_dwordx4 v6, s[12:15], s21 offen lds
  s_mul_i32 s21, s20, 393216
  s_add_u32 s21, s21, 1867776
  s_add_u32 s21, s21, s44
  s_mul_i32 s22, s20, 12288
  s_add_u32 s22, s22, 58368
  s_add_u32 m0, s22, 0
  s_nop 0
  buffer_load_dwordx4 v4, s[12:15], s21 offen lds
  s_add_u32 m0, s22, 1024
  s_nop 0
  buffer_load_dwordx4 v5, s[12:15], s21 offen lds
  s_add_u32 m0, s22, 2048
  s_nop 0
  buffer_load_dwordx4 v6, s[12:15], s21 offen lds
  s_waitcnt vmcnt(12)
  s_barrier
  ds_read_b64_tr_b16 a[0:1], v7 offset:0
  ds_read_b64_tr_b16 a[2:3], v7 offset:1536
  ds_read_b64_tr_b16 a[4:5], v7 offset:32
  ds_read_b64_tr_b16 a[6:7], v7 offset:1568
  ds_read_b64_tr_b16 a[8:9], v7 offset:64
  ds_read_b64_tr_b16 a[10:11], v7 offset:1600
  ds_read_b64_tr_b16 a[12:13], v7 offset:12288
  ds_read_b64_tr_b16 a[14:15], v7 offset:13824
  ds_read_b64_tr_b16 a[16:17], v7 offset:12320
  ds_read_b64_tr_b16 a[18:19], v7 offset:13856
  ds_read_b64_tr_b16 a[20:21], v7 offset:12352
  ds_read_b64_tr_b16 a[22:23], v7 offset:13888
  ds_read_b64_tr_b16 a[24:25], v7 offset:24576
  ds_read_b64_tr_b16 a[26:27], v7 offset:26112
  ds_read_b64_tr_b16 a[28:29], v7 offset:24608
  ds_read_b64_tr_b16 a[30:31], v7 offset:26144
  ds_read_b64_tr_b16 a[32:33], v7 offset:24640
  ds_read_b64_tr_b16 a[34:35], v7 offset:26176
  ds_read_b64_tr_b16 a[36:37], v7 offset:36864
  ds_read_b64_tr_b16 a[38:39], v7 offset:38400
  ds_read_b64_tr_b16 a[40:41], v7 offset:36896
  ds_read_b64_tr_b16 a[42:43], v7 offset:38432
  ds_read_b64_tr_b16 a[44:45], v7 offset:36928
  ds_read_b64_tr_b16 a[46:47], v7 offset:38464
  s_waitcnt lgkmcnt(0)
  s_barrier
  s_mul_i32 s21, s20, 393216
  s_add_u32 s21, s21, 3145728
  s_add_u32 s21, s21, s44
  s_mul_i32 s22, s20, 12288
  s_add_u32 s22, s22, 0
  s_add_u32 m0, s22, 0
  s_nop 0
  buffer_load_dwordx4 v4, s[12:15], s21 offen lds
  s_add_u32 m0, s22, 1024
  s_nop 0
  buffer_load_dwordx4 v5, s[12:15], s21 offen lds
  s_add_u32 m0, s22, 2048
  s_nop 0
  buffer_load_dwordx4 v6, s[12:15], s21 offen lds
  s_mul_i32 s21, s20, 393216
  s_add_u32 s21, s21, 3244032
  s_add_u32 s21, s21, s44
  s_mul_i32 s22, s20, 12288
  s_add_u32 s22, s22, 3072
  s_add_u32 m0, s22, 0
  s_nop 0
  buffer_load_dwordx4 v4, s[12:15], s21 offen lds
  s_add_u32 m0, s22, 1024
  s_nop 0
  buffer_load_dwordx4 v5, s[12:15], s21 offen lds
  s_add_u32 m0, s22, 2048
  s_nop 0
  buffer_load_dwordx4 v6, s[12:15], s21 offen lds
  s_mul_i32 s21, s20, 393216
  s_add_u32 s21, s21, 3342336
  s_add_u32 s21, s21, s44
  s_mul_i32 s22, s20, 12288
  s_add_u32 s22, s22, 6144
  s_add_u32 m0, s22, 0
  s_nop 0
  buffer_load_dwordx4 v4, s[12:15], s21 offen lds
  s_add_u32 m0, s22, 1024
  s_nop 0
  buffer_load_dwordx4 v5, s[12:15], s21 offen lds
  s_add_u32 m0, s22, 2048
  s_nop 0
  buffer_load_dwordx4 v6, s[12:15], s21 offen lds
  s_mul_i32 s21, s20, 393216
  s_add_u32 s21, s21, 3440640
  s_add_u32 s21, s21, s44
  s_mul_i32 s22, s20, 12288
  s_add_u32 s22, s22, 9216
  s_add_u32 m0, s22, 0
  s_nop 0
  buffer_load_dwordx4 v4, s[12:15], s21 offen lds
  s_add_u32 m0, s22, 1024
  s_nop 0
  buffer_load_dwordx4 v5, s[12:15], s21 offen lds
  s_add_u32 m0, s22, 2048
  s_nop 0
  buffer_load_dwordx4 v6, s[12:15], s21 offen lds
  s_waitcnt vmcnt(12)
  s_barrier
  ds_read_b64_tr_b16 a[48:49], v8 offset:0
  ds_read_b64_tr_b16 a[50:51], v8 offset:1536
  ds_read_b64_tr_b16 a[52:53], v8 offset:32
  ds_read_b64_tr_b16 a[54:55], v8 offset:1568
  ds_read_b64_tr_b16 a[56:57], v8 offset:64
  ds_read_b64_tr_b16 a[58:59], v8 offset:1600
  ds_read_b64_tr_b16 a[60:61], v8 offset:12288
  ds_read_b64_tr_b16 a[62:63], v8 offset:13824
  ds_read_b64_tr_b16 a[64:65], v8 offset:12320
  ds_read_b64_tr_b16 a[66:67], v8 offset:13856
  ds_read_b64_tr_b16 a[68:69], v8 offset:12352
  ds_read_b64_tr_b16 a[70:71], v8 offset:13888
  ds_read_b64_tr_b16 a[72:73], v8 offset:24576
  ds_read_b64_tr_b16 a[74:75], v8 offset:26112
  ds_read_b64_tr_b16 a[76:77], v8 offset:24608
  ds_read_b64_tr_b16 a[78:79], v8 offset:26144
  ds_read_b64_tr_b16 a[80:81], v8 offset:24640
  ds_read_b64_tr_b16 a[82:83], v8 offset:26176
  ds_read_b64_tr_b16 a[84:85], v8 offset:36864
  ds_read_b64_tr_b16 a[86:87], v8 offset:38400
  ds_read_b64_tr_b16 a[88:89], v8 offset:36896
  ds_read_b64_tr_b16 a[90:91], v8 offset:38432
  ds_read_b64_tr_b16 a[92:93], v8 offset:36928
  ds_read_b64_tr_b16 a[94:95], v8 offset:38464
  s_waitcnt lgkmcnt(0)
  s_barrier
  s_mul_i32 s21, s20, 393216
  s_add_u32 s21, s21, 4718592
  s_add_u32 s21, s21, s44
  s_mul_i32 s22, s20, 12288
  s_add_u32 s22, s22, 49152
  s_add_u32 m0, s22, 0
  s_nop 0
  buffer_load_dwordx4 v4, s[12:15], s21 offen lds
  s_add_u32 m0, s22, 1024
  s_nop 0
  buffer_load_dwordx4 v5, s[12:15], s21 offen lds
  s_add_u32 m0, s22, 2048
  s_nop 0
  buffer_load_dwordx4 v6, s[12:15], s21 offen lds
  s_mul_i32 s21, s20, 393216
  s_add_u32 s21, s21, 4816896
  s_add_u32 s21, s21, s44
  s_mul_i32 s22, s20, 12288
  s_add_u32 s22, s22, 52224
  s_add_u32 m0, s22, 0
  s_nop 0
  buffer_load_dwordx4 v4, s[12:15], s21 offen lds
  s_add_u32 m0, s22, 1024
  s_nop 0
  buffer_load_dwordx4 v5, s[12:15], s21 offen lds
  s_add_u32 m0, s22, 2048
  s_nop 0
  buffer_load_dwordx4 v6, s[12:15], s21 offen lds
  s_mul_i32 s21, s20, 393216
  s_add_u32 s21, s21, 4915200
  s_add_u32 s21, s21, s44
  s_mul_i32 s22, s20, 12288
  s_add_u32 s22, s22, 55296
  s_add_u32 m0, s22, 0
  s_nop 0
  buffer_load_dwordx4 v4, s[12:15], s21 offen lds
  s_add_u32 m0, s22, 1024
  s_nop 0
  buffer_load_dwordx4 v5, s[12:15], s21 offen lds
  s_add_u32 m0, s22, 2048
  s_nop 0
  buffer_load_dwordx4 v6, s[12:15], s21 offen lds
  s_mul_i32 s21, s20, 393216
  s_add_u32 s21, s21, 5013504
  s_add_u32 s21, s21, s44
  s_mul_i32 s22, s20, 12288
  s_add_u32 s22, s22, 58368
  s_add_u32 m0, s22, 0
  s_nop 0
  buffer_load_dwordx4 v4, s[12:15], s21 offen lds
  s_add_u32 m0, s22, 1024
  s_nop 0
  buffer_load_dwordx4 v5, s[12:15], s21 offen lds
  s_add_u32 m0, s22, 2048
  s_nop 0
  buffer_load_dwordx4 v6, s[12:15], s21 offen lds
  v_mov_b32 v29, 76
  buffer_load_dword v29, v29, s[64:67], 0 offen sc1
  s_waitcnt vmcnt(12)
  s_barrier
  ds_read_b64_tr_b16 a[96:97], v7 offset:0
  ds_read_b64_tr_b16 a[98:99], v7 offset:1536
  ds_read_b64_tr_b16 a[100:101], v7 offset:32
  ds_read_b64_tr_b16 a[102:103], v7 offset:1568
  ds_read_b64_tr_b16 a[104:105], v7 offset:64
  ds_read_b64_tr_b16 a[106:107], v7 offset:1600
  ds_read_b64_tr_b16 a[108:109], v7 offset:12288
  ds_read_b64_tr_b16 a[110:111], v7 offset:13824
  ds_read_b64_tr_b16 a[112:113], v7 offset:12320
  ds_read_b64_tr_b16 a[114:115], v7 offset:13856
  ds_read_b64_tr_b16 a[116:117], v7 offset:12352
  ds_read_b64_tr_b16 a[118:119], v7 offset:13888
  ds_read_b64_tr_b16 a[120:121], v7 offset:24576
  ds_read_b64_tr_b16 a[122:123], v7 offset:26112
  ds_read_b64_tr_b16 a[124:125], v7 offset:24608
  ds_read_b64_tr_b16 a[126:127], v7 offset:26144
  ds_read_b64_tr_b16 a[128:129], v7 offset:24640
  ds_read_b64_tr_b16 a[130:131], v7 offset:26176
  ds_read_b64_tr_b16 a[132:133], v7 offset:36864
  ds_read_b64_tr_b16 a[134:135], v7 offset:38400
  ds_read_b64_tr_b16 a[136:137], v7 offset:36896
  ds_read_b64_tr_b16 a[138:139], v7 offset:38432
  ds_read_b64_tr_b16 a[140:141], v7 offset:36928
  ds_read_b64_tr_b16 a[142:143], v7 offset:38464
  s_waitcnt lgkmcnt(0)
  s_barrier
  s_mul_i32 s21, s20, 393216
  s_add_u32 s21, s21, 6291456
  s_add_u32 s21, s21, s44
  s_mul_i32 s22, s20, 12288
  s_add_u32 s22, s22, 0
  s_add_u32 m0, s22, 0
  s_nop 0
  buffer_load_dwordx4 v4, s[12:15], s21 offen lds
  s_add_u32 m0, s22, 1024
  s_nop 0
  buffer_load_dwordx4 v5, s[12:15], s21 offen lds
  s_add_u32 m0, s22, 2048
  s_nop 0
  buffer_load_dwordx4 v6, s[12:15], s21 offen lds
  s_mul_i32 s21, s20, 393216
  s_add_u32 s21, s21, 6389760
  s_add_u32 s21, s21, s44
  s_mul_i32 s22, s20, 12288
  s_add_u32 s22, s22, 3072
  s_add_u32 m0, s22, 0
  s_nop 0
  buffer_load_dwordx4 v4, s[12:15], s21 offen lds
  s_add_u32 m0, s22, 1024
  s_nop 0
  buffer_load_dwordx4 v5, s[12:15], s21 offen lds
  s_add_u32 m0, s22, 2048
  s_nop 0
  buffer_load_dwordx4 v6, s[12:15], s21 offen lds
  s_mul_i32 s21, s20, 393216
  s_add_u32 s21, s21, 6488064
  s_add_u32 s21, s21, s44
  s_mul_i32 s22, s20, 12288
  s_add_u32 s22, s22, 6144
  s_add_u32 m0, s22, 0
  s_nop 0
  buffer_load_dwordx4 v4, s[12:15], s21 offen lds
  s_add_u32 m0, s22, 1024
  s_nop 0
  buffer_load_dwordx4 v5, s[12:15], s21 offen lds
  s_add_u32 m0, s22, 2048
  s_nop 0
  buffer_load_dwordx4 v6, s[12:15], s21 offen lds
  s_mul_i32 s21, s20, 393216
  s_add_u32 s21, s21, 6586368
  s_add_u32 s21, s21, s44
  s_mul_i32 s22, s20, 12288
  s_add_u32 s22, s22, 9216
  s_add_u32 m0, s22, 0
  s_nop 0
  buffer_load_dwordx4 v4, s[12:15], s21 offen lds
  s_add_u32 m0, s22, 1024
  s_nop 0
  buffer_load_dwordx4 v5, s[12:15], s21 offen lds
  s_add_u32 m0, s22, 2048
  s_nop 0
  buffer_load_dwordx4 v6, s[12:15], s21 offen lds
  s_waitcnt vmcnt(12)
  s_barrier
  ds_read_b64_tr_b16 a[144:145], v8 offset:0
  ds_read_b64_tr_b16 a[146:147], v8 offset:1536
  ds_read_b64_tr_b16 a[148:149], v8 offset:32
  ds_read_b64_tr_b16 a[150:151], v8 offset:1568
  ds_read_b64_tr_b16 a[152:153], v8 offset:64
  ds_read_b64_tr_b16 a[154:155], v8 offset:1600
  ds_read_b64_tr_b16 a[156:157], v8 offset:12288
  ds_read_b64_tr_b16 a[158:159], v8 offset:13824
  ds_read_b64_tr_b16 a[160:161], v8 offset:12320
  ds_read_b64_tr_b16 a[162:163], v8 offset:13856
  ds_read_b64_tr_b16 a[164:165], v8 offset:12352
  ds_read_b64_tr_b16 a[166:167], v8 offset:13888
  ds_read_b64_tr_b16 a[168:169], v8 offset:24576
  ds_read_b64_tr_b16 a[170:171], v8 offset:26112
  ds_read_b64_tr_b16 a[172:173], v8 offset:24608
  ds_read_b64_tr_b16 a[174:175], v8 offset:26144
  ds_read_b64_tr_b16 a[176:177], v8 offset:24640
  ds_read_b64_tr_b16 a[178:179], v8 offset:26176
  ds_read_b64_tr_b16 a[180:181], v8 offset:36864
  ds_read_b64_tr_b16 a[182:183], v8 offset:38400
  ds_read_b64_tr_b16 a[184:185], v8 offset:36896
  ds_read_b64_tr_b16 a[186:187], v8 offset:38432
  ds_read_b64_tr_b16 a[188:189], v8 offset:36928
  ds_read_b64_tr_b16 a[190:191], v8 offset:38464
  s_waitcnt lgkmcnt(0)
  s_barrier
  s_waitcnt vmcnt(0)
  s_barrier
  ds_read_b64_tr_b16 a[192:193], v7 offset:0
  ds_read_b64_tr_b16 a[194:195], v7 offset:1536
  ds_read_b64_tr_b16 a[196:197], v7 offset:32
  ds_read_b64_tr_b16 a[198:199], v7 offset:1568
  ds_read_b64_tr_b16 a[200:201], v7 offset:64
  ds_read_b64_tr_b16 a[202:203], v7 offset:1600
  ds_read_b64_tr_b16 a[204:205], v7 offset:12288
  ds_read_b64_tr_b16 a[206:207], v7 offset:13824
  ds_read_b64_tr_b16 a[208:209], v7 offset:12320
  ds_read_b64_tr_b16 a[210:211], v7 offset:13856
  ds_read_b64_tr_b16 a[212:213], v7 offset:12352
  ds_read_b64_tr_b16 a[214:215], v7 offset:13888
  ds_read_b64_tr_b16 a[216:217], v7 offset:24576
  ds_read_b64_tr_b16 a[218:219], v7 offset:26112
  ds_read_b64_tr_b16 a[220:221], v7 offset:24608
  ds_read_b64_tr_b16 a[222:223], v7 offset:26144
  ds_read_b64_tr_b16 a[224:225], v7 offset:24640
  ds_read_b64_tr_b16 a[226:227], v7 offset:26176
  ds_read_b64_tr_b16 a[228:229], v7 offset:36864
  ds_read_b64_tr_b16 a[230:231], v7 offset:38400
  ds_read_b64_tr_b16 a[232:233], v7 offset:36896
  ds_read_b64_tr_b16 a[234:235], v7 offset:38432
  ds_read_b64_tr_b16 a[236:237], v7 offset:36928
  ds_read_b64_tr_b16 a[238:239], v7 offset:38464
  s_waitcnt lgkmcnt(0)
  s_barrier
  s_mov_b32 s26, 8
  s_mul_i32 s27, s42, 12288
  s_mul_i32 s21, s43, 25165824
  s_add_u32 s27, s27, s21
  s_mov_b32 s28, 786432
  v_readfirstlane_b32 s21, v29
  s_cmp_ge_u32 s21, 32
  s_cbranch_scc1 kvz_133
  s_mov_b32 s21, 76
  v_mov_b32 v4, 0
  s_mov_b32 s101, 0
wf_134:
  buffer_load_dword v5, v4, s[64:67], s21 offen sc1
  s_add_u32 s101, s101, 1
  s_cmp_gt_u32 s101, 131072
  s_cbranch_scc1 main_end
  s_waitcnt vmcnt(0)
  v_readfirstlane_b32 s100, v5
  s_cmp_ge_u32 s100, 32
  s_cbranch_scc1 wf_135
  s_sleep 8
  s_branch wf_134
wf_135:
kvz_133:
  s_lshl_b32 s60, s40, 7
  s_add_u32 s60, s60, 0
  s_mov_b32 s61, 0
  v_and_b32 v6, 7, v2
  v_add_u32 v4, 0, v3
  v_xor_b32 v4, v4, v6
  v_lshlrev_b32 v4, 4, v4
  v_lshl_add_u32 v14, v2, 7, v4
  v_add_u32 v4, 4, v3
  v_xor_b32 v4, v4, v6
  v_lshlrev_b32 v4, 4, v4
  v_lshl_add_u32 v15, v2, 7, v4
  v_mul_u32_u24 v22, 400, v2
  v_mul_u32_u24 v4, 24, v3
  s_mul_i32 s21, s20, 96
  s_add_u32 s21, s21, 0
  v_add3_u32 v22, v22, v4, s21
  v_mov_b32 v9, 2731
  s_mul_i32 s21, s20, 6400
  s_add_u32 s21, s21, 0
  v_mul_u32_u24 v4, 400, v2
  v_lshlrev_b32 v5, 4, v3
  v_add3_u32 v23, v4, v5, s21
  v_lshlrev_b32 v26, 4, v1
  s_mov_b32 s33, 98304
  s_mov_b32 s48, 0x80000000
  s_mov_b32 m0, s32
  s_nop 0
  buffer_load_dwordx4 v10, s[8:11], s30 offen offset:0 lds
  s_waitcnt vmcnt(9)
  s_barrier
  v_add_u32 v18, s33, v14
  v_add_u32 v19, s33, v15
  s_add_u32 s33, s33, 8192
  s_cmp_lt_u32 s33, 155648
  s_cselect_b32 s33, s33, 98304
  ds_read_b128 v[160:163], v18 offset:0
  ds_read_b128 v[164:167], v18 offset:2048
  ds_read_b128 v[168:171], v18 offset:4096
  ds_read_b128 v[172:175], v18 offset:6144
  s_waitcnt lgkmcnt(0)
kvm_blk_138:
  v_mfma_f32_16x16x32_bf16 v[64:67], a[0:3], v[160:163], 0
  ds_read_b128 v[192:195], v19 offset:0
  v_mfma_f32_16x16x32_bf16 v[68:71], a[4:7], v[160:163], 0
  v_add_u32 v18, s33, v14
  v_mfma_f32_16x16x32_bf16 v[72:75], a[8:11], v[160:163], 0
  v_mfma_f32_16x16x32_bf16 v[76:79], a[0:3], v[164:167], 0
  ds_read_b128 v[196:199], v19 offset:2048
  v_mfma_f32_16x16x32_bf16 v[80:83], a[4:7], v[164:167], 0
  buffer_load_dwordx4 v11, s[8:11], s30 offen offset:1024 lds
  v_mfma_f32_16x16x32_bf16 v[84:87], a[8:11], v[164:167], 0
  s_waitcnt lgkmcnt(10)
  s_add_u32 s30, s30, 128
  v_mfma_f32_16x16x32_bf16 v[88:91], a[0:3], v[168:171], 0
  ds_read_b128 v[200:203], v19 offset:4096
  s_add_u32 m0, m0, 8192
  v_mfma_f32_16x16x32_bf16 v[92:95], a[4:7], v[168:171], 0
  s_cmp_lt_u32 m0, s46
  s_cselect_b32 m0, m0, s47
  v_mfma_f32_16x16x32_bf16 v[96:99], a[8:11], v[168:171], 0
  v_mfma_f32_16x16x32_bf16 v[100:103], a[0:3], v[172:175], 0
  ds_read_b128 v[204:207], v19 offset:6144
  v_mfma_f32_16x16x32_bf16 v[104:107], a[4:7], v[172:175], 0
  v_mfma_f32_16x16x32_bf16 v[108:111], a[8:11], v[172:175], 0
  s_waitcnt vmcnt(8) lgkmcnt(2)
  s_barrier
  v_mfma_f32_16x16x32_bf16 v[64:67], a[12:15], v[192:195], v[64:67]
  ds_read_b128 v[160:163], v18 offset:0
  v_mfma_f32_16x16x32_bf16 v[68:71], a[16:19], v[192:195], v[68:71]
  ds_read_b128 v[224:227], v23 offset:0
  v_mfma_f32_16x16x32_bf16 v[72:75], a[20:23], v[192:195], v[72:75]
  v_add_u32 v19, s33, v15
  s_add_u32 s33, s33, 8192
  v_mfma_f32_16x16x32_bf16 v[76:79], a[12:15], v[196:199], v[76:79]
  ds_read_b128 v[164:167], v18 offset:2048
  v_mfma_f32_16x16x32_bf16 v[80:83], a[16:19], v[196:199], v[80:83]
  buffer_load_dwordx4 v10, s[8:11], s30 offen offset:0 lds
  v_mfma_f32_16x16x32_bf16 v[84:87], a[20:23], v[196:199], v[84:87]
  s_waitcnt lgkmcnt(3)
  ds_read_b128 v[228:231], v23 offset:64
  v_mfma_f32_16x16x32_bf16 v[88:91], a[12:15], v[200:203], v[88:91]
  ds_read_b128 v[168:171], v18 offset:4096
  v_mfma_f32_16x16x32_bf16 v[92:95], a[16:19], v[200:203], v[92:95]
  s_cmp_lt_u32 s33, 155648
  s_cselect_b32 s33, s33, 98304
  v_mfma_f32_16x16x32_bf16 v[96:99], a[20:23], v[200:203], v[96:99]
  v_mfma_f32_16x16x32_bf16 v[100:103], a[12:15], v[204:207], v[100:103]
  ds_read_b128 v[172:175], v18 offset:6144
  v_mfma_f32_16x16x32_bf16 v[104:107], a[16:19], v[204:207], v[104:107]
  v_mfma_f32_16x16x32_bf16 v[108:111], a[20:23], v[204:207], v[108:111]
  s_waitcnt lgkmcnt(3)
  v_mfma_f32_16x16x32_bf16 v[64:67], a[24:27], v[160:163], v[64:67]
  ds_read_b128 v[192:195], v19 offset:0
  v_mfma_f32_16x16x32_bf16 v[68:71], a[28:31], v[160:163], v[68:71]
  v_add_u32 v18, s33, v14
  ds_read_b128 v[232:235], v23 offset:128
  v_mfma_f32_16x16x32_bf16 v[72:75], a[32:35], v[160:163], v[72:75]
  v_mfma_f32_16x16x32_bf16 v[76:79], a[24:27], v[164:167], v[76:79]
  ds_read_b128 v[196:199], v19 offset:2048
  v_mfma_f32_16x16x32_bf16 v[80:83], a[28:31], v[164:167], v[80:83]
  buffer_load_dwordx4 v11, s[8:11], s30 offen offset:1024 lds
  s_add_u32 s21, s48, 0
  v_mfma_f32_16x16x32_bf16 v[84:87], a[32:35], v[164:167], v[84:87]
  s_waitcnt lgkmcnt(3)
  s_add_u32 s30, s30, 128
  v_mfma_f32_16x16x32_bf16 v[88:91], a[24:27], v[168:171], v[88:91]
  ds_read_b128 v[200:203], v19 offset:4096
  s_add_u32 m0, m0, 8192
  v_mfma_f32_16x16x32_bf16 v[92:95], a[28:31], v[168:171], v[92:95]
  s_cmp_lt_u32 m0, s46
  s_cselect_b32 m0, m0, s47
  buffer_store_dwordx4 v[224:227], v26, s[16:19], s21 offen offset:0 sc1
  v_mfma_f32_16x16x32_bf16 v[96:99], a[32:35], v[168:171], v[96:99]
  ds_read_b128 v[236:239], v23 offset:192
  v_mfma_f32_16x16x32_bf16 v[100:103], a[24:27], v[172:175], v[100:103]
  ds_read_b128 v[204:207], v19 offset:6144
  v_mfma_f32_16x16x32_bf16 v[104:107], a[28:31], v[172:175], v[104:107]
  buffer_store_dwordx4 v[228:231], v26, s[16:19], s21 offen offset:1024 sc1
  v_mfma_f32_16x16x32_bf16 v[108:111], a[32:35], v[172:175], v[108:111]
  s_waitcnt vmcnt(10) lgkmcnt(3)
  s_barrier
  v_mfma_f32_16x16x32_bf16 v[64:67], a[36:39], v[192:195], v[64:67]
  ds_read_b128 v[160:163], v18 offset:0
  v_mfma_f32_16x16x32_bf16 v[68:71], a[40:43], v[192:195], v[68:71]
  ds_read_b128 v[240:243], v23 offset:256
  v_mfma_f32_16x16x32_bf16 v[72:75], a[44:47], v[192:195], v[72:75]
  v_add_u32 v19, s33, v15
  s_add_u32 s33, s33, 8192
  v_mfma_f32_16x16x32_bf16 v[76:79], a[36:39], v[196:199], v[76:79]
  ds_read_b128 v[164:167], v18 offset:2048
  v_mfma_f32_16x16x32_bf16 v[80:83], a[40:43], v[196:199], v[80:83]
  buffer_load_dwordx4 v10, s[8:11], s30 offen offset:0 lds
  v_mfma_f32_16x16x32_bf16 v[84:87], a[44:47], v[196:199], v[84:87]
  s_waitcnt lgkmcnt(3)
  ds_read_b128 v[244:247], v23 offset:320
  v_mfma_f32_16x16x32_bf16 v[88:91], a[36:39], v[200:203], v[88:91]
  ds_read_b128 v[168:171], v18 offset:4096
  v_mfma_f32_16x16x32_bf16 v[92:95], a[40:43], v[200:203], v[92:95]
  s_cmp_lt_u32 s33, 155648
  s_cselect_b32 s33, s33, 98304
  buffer_store_dwordx4 v[232:235], v26, s[16:19], s21 offen offset:2048 sc1
  v_mfma_f32_16x16x32_bf16 v[96:99], a[44:47], v[200:203], v[96:99]
  v_mfma_f32_16x16x32_bf16 v[100:103], a[36:39], v[204:207], v[100:103]
  ds_read_b128 v[172:175], v18 offset:6144
  v_mfma_f32_16x16x32_bf16 v[104:107], a[40:43], v[204:207], v[104:107]
  buffer_store_dwordx4 v[236:239], v26, s[16:19], s21 offen offset:3072 sc1
  v_mfma_f32_16x16x32_bf16 v[108:111], a[44:47], v[204:207], v[108:111]
  s_waitcnt lgkmcnt(3)
  v_mfma_f32_16x16x32_bf16 v[64:67], a[48:51], v[160:163], v[64:67]
  ds_read_b128 v[192:195], v19 offset:0
  v_mfma_f32_16x16x32_bf16 v[68:71], a[52:55], v[160:163], v[68:71]
  v_add_u32 v18, s33, v14
  v_mfma_f32_16x16x32_bf16 v[72:75], a[56:59], v[160:163], v[72:75]
  v_mfma_f32_16x16x32_bf16 v[76:79], a[48:51], v[164:167], v[76:79]
  ds_read_b128 v[196:199], v19 offset:2048
  v_mfma_f32_16x16x32_bf16 v[80:83], a[52:55], v[164:167], v[80:83]
  buffer_load_dwordx4 v11, s[8:11], s30 offen offset:1024 lds
  s_add_u32 s21, s48, 4096
  v_mfma_f32_16x16x32_bf16 v[84:87], a[56:59], v[164:167], v[84:87]
  s_waitcnt lgkmcnt(2)
  s_add_u32 s30, s30, 128
  v_mfma_f32_16x16x32_bf16 v[88:91], a[48:51], v[168:171], v[88:91]
  ds_read_b128 v[200:203], v19 offset:4096
  s_add_u32 m0, m0, 8192
  v_mfma_f32_16x16x32_bf16 v[92:95], a[52:55], v[168:171], v[92:95]
  s_cmp_lt_u32 m0, s46
  s_cselect_b32 m0, m0, s47
  buffer_store_dwordx4 v[240:243], v26, s[16:19], s21 offen offset:0 sc1
  v_mfma_f32_16x16x32_bf16 v[96:99], a[56:59], v[168:171], v[96:99]
  v_mfma_f32_16x16x32_bf16 v[100:103], a[48:51], v[172:175], v[100:103]
  ds_read_b128 v[204:207], v19 offset:6144
  v_mfma_f32_16x16x32_bf16 v[104:107], a[52:55], v[172:175], v[104:107]
  buffer_store_dwordx4 v[244:247], v26, s[16:19], s21 offen offset:1024 sc1
  v_mfma_f32_16x16x32_bf16 v[108:111], a[56:59], v[172:175], v[108:111]
  s_waitcnt vmcnt(14) lgkmcnt(2)
  s_barrier
  v_mfma_f32_16x16x32_bf16 v[64:67], a[60:63], v[192:195], v[64:67]
  ds_read_b128 v[160:163], v18 offset:0
  v_mfma_f32_16x16x32_bf16 v[68:71], a[64:67], v[192:195], v[68:71]
  v_mfma_f32_16x16x32_bf16 v[72:75], a[68:71], v[192:195], v[72:75]
  v_add_u32 v19, s33, v15
  s_add_u32 s33, s33, 8192
  v_mfma_f32_16x16x32_bf16 v[76:79], a[60:63], v[196:199], v[76:79]
  ds_read_b128 v[164:167], v18 offset:2048
  v_mfma_f32_16x16x32_bf16 v[80:83], a[64:67], v[196:199], v[80:83]
  buffer_load_dwordx4 v10, s[8:11], s30 offen offset:0 lds
  v_mfma_f32_16x16x32_bf16 v[84:87], a[68:71], v[196:199], v[84:87]
  s_waitcnt lgkmcnt(2)
  v_mfma_f32_16x16x32_bf16 v[88:91], a[60:63], v[200:203], v[88:91]
  ds_read_b128 v[168:171], v18 offset:4096
  v_mfma_f32_16x16x32_bf16 v[92:95], a[64:67], v[200:203], v[92:95]
  s_cmp_lt_u32 s33, 155648
  s_cselect_b32 s33, s33, 98304
  v_mfma_f32_16x16x32_bf16 v[96:99], a[68:71], v[200:203], v[96:99]
  v_mfma_f32_16x16x32_bf16 v[100:103], a[60:63], v[204:207], v[100:103]
  ds_read_b128 v[172:175], v18 offset:6144
  v_mfma_f32_16x16x32_bf16 v[104:107], a[64:67], v[204:207], v[104:107]
  v_mfma_f32_16x16x32_bf16 v[108:111], a[68:71], v[204:207], v[108:111]
  s_waitcnt lgkmcnt(2)
  v_mfma_f32_16x16x32_bf16 v[64:67], a[72:75], v[160:163], v[64:67]
  ds_read_b128 v[192:195], v19 offset:0
  v_mfma_f32_16x16x32_bf16 v[68:71], a[76:79], v[160:163], v[68:71]
  v_add_u32 v18, s33, v14
  v_mfma_f32_16x16x32_bf16 v[72:75], a[80:83], v[160:163], v[72:75]
  v_mfma_f32_16x16x32_bf16 v[76:79], a[72:75], v[164:167], v[76:79]
  ds_read_b128 v[196:199], v19 offset:2048
  v_mfma_f32_16x16x32_bf16 v[80:83], a[76:79], v[164:167], v[80:83]
  buffer_load_dwordx4 v11, s[8:11], s30 offen offset:1024 lds
  v_mfma_f32_16x16x32_bf16 v[84:87], a[80:83], v[164:167], v[84:87]
  s_waitcnt lgkmcnt(2)
  s_add_u32 s30, s30, 128
  v_mfma_f32_16x16x32_bf16 v[88:91], a[72:75], v[168:171], v[88:91]
  ds_read_b128 v[200:203], v19 offset:4096
  s_add_u32 m0, m0, 8192
  v_mfma_f32_16x16x32_bf16 v[92:95], a[76:79], v[168:171], v[92:95]
  s_cmp_lt_u32 m0, s46
  s_cselect_b32 m0, m0, s47
  v_mfma_f32_16x16x32_bf16 v[96:99], a[80:83], v[168:171], v[96:99]
  v_mfma_f32_16x16x32_bf16 v[100:103], a[72:75], v[172:175], v[100:103]
  ds_read_b128 v[204:207], v19 offset:6144
  v_mfma_f32_16x16x32_bf16 v[104:107], a[76:79], v[172:175], v[104:107]
  v_mfma_f32_16x16x32_bf16 v[108:111], a[80:83], v[172:175], v[108:111]
  s_waitcnt vmcnt(14) lgkmcnt(2)
  s_barrier
  v_mfma_f32_16x16x32_bf16 v[64:67], a[84:87], v[192:195], v[64:67]
  ds_read_b128 v[160:163], v18 offset:0
  v_mfma_f32_16x16x32_bf16 v[68:71], a[88:91], v[192:195], v[68:71]
  v_mfma_f32_16x16x32_bf16 v[72:75], a[92:95], v[192:195], v[72:75]
  v_add_u32 v19, s33, v15
  s_add_u32 s33, s33, 8192
  v_mfma_f32_16x16x32_bf16 v[76:79], a[84:87], v[196:199], v[76:79]
  ds_read_b128 v[164:167], v18 offset:2048
  v_mfma_f32_16x16x32_bf16 v[80:83], a[88:91], v[196:199], v[80:83]
  buffer_load_dwordx4 v10, s[8:11], s30 offen offset:0 lds
  v_mfma_f32_16x16x32_bf16 v[84:87], a[92:95], v[196:199], v[84:87]
  s_waitcnt lgkmcnt(2)
  v_mfma_f32_16x16x32_bf16 v[88:91], a[84:87], v[200:203], v[88:91]
  ds_read_b128 v[168:171], v18 offset:4096
  v_mfma_f32_16x16x32_bf16 v[92:95], a[88:91], v[200:203], v[92:95]
  s_cmp_lt_u32 s33, 155648
  s_cselect_b32 s33, s33, 98304
  v_mfma_f32_16x16x32_bf16 v[96:99], a[92:95], v[200:203], v[96:99]
  v_mfma_f32_16x16x32_bf16 v[100:103], a[84:87], v[204:207], v[100:103]
  ds_read_b128 v[172:175], v18 offset:6144
  v_mfma_f32_16x16x32_bf16 v[104:107], a[88:91], v[204:207], v[104:107]
  v_mfma_f32_16x16x32_bf16 v[108:111], a[92:95], v[204:207], v[108:111]
  s_waitcnt lgkmcnt(2)
  v_mfma_f32_16x16x32_bf16 v[64:67], a[96:99], v[160:163], v[64:67]
  ds_read_b128 v[192:195], v19 offset:0
  v_mfma_f32_16x16x32_bf16 v[68:71], a[100:103], v[160:163], v[68:71]
  v_add_u32 v18, s33, v14
  v_mfma_f32_16x16x32_bf16 v[72:75], a[104:107], v[160:163], v[72:75]
  v_mfma_f32_16x16x32_bf16 v[76:79], a[96:99], v[164:167], v[76:79]
  ds_read_b128 v[196:199], v19 offset:2048
  v_mfma_f32_16x16x32_bf16 v[80:83], a[100:103], v[164:167], v[80:83]
  buffer_load_dwordx4 v11, s[8:11], s30 offen offset:1024 lds
  v_mfma_f32_16x16x32_bf16 v[84:87], a[104:107], v[164:167], v[84:87]
  s_waitcnt lgkmcnt(2)
  s_add_u32 s30, s30, s25
  v_mfma_f32_16x16x32_bf16 v[88:91], a[96:99], v[168:171], v[88:91]
  ds_read_b128 v[200:203], v19 offset:4096
  s_sub_u32 s30, s30, 1152
  v_mfma_f32_16x16x32_bf16 v[92:95], a[100:103], v[168:171], v[92:95]
  s_add_u32 m0, m0, 8192
  v_mfma_f32_16x16x32_bf16 v[96:99], a[104:107], v[168:171], v[96:99]
  s_cmp_lt_u32 m0, s46
  s_cselect_b32 m0, m0, s47
  v_mfma_f32_16x16x32_bf16 v[100:103], a[96:99], v[172:175], v[100:103]
  ds_read_b128 v[204:207], v19 offset:6144
  v_mfma_f32_16x16x32_bf16 v[104:107], a[100:103], v[172:175], v[104:107]
  v_mfma_f32_16x16x32_bf16 v[108:111], a[104:107], v[172:175], v[108:111]
  s_waitcnt vmcnt(4) lgkmcnt(2)
  s_barrier
  v_mfma_f32_16x16x32_bf16 v[64:67], a[108:111], v[192:195], v[64:67]
  ds_read_b128 v[160:163], v18 offset:0
  v_mfma_f32_16x16x32_bf16 v[68:71], a[112:115], v[192:195], v[68:71]
  s_cmp_eq_u32 s48, 0x80000000
  s_cbranch_scc1 kvm_136
  s_cmp_lg_u32 s20, 0
  s_cbranch_scc1 af_137
  v_mov_b32 v4, 0
  v_mov_b32 v5, 1
  s_mov_b64 exec, 1
  buffer_atomic_add v5, v4, s[72:75], s61 offen sc1
  s_mov_b64 exec, -1
  s_nop 1
af_137:
kvm_136:
  v_mfma_f32_16x16x32_bf16 v[72:75], a[116:119], v[192:195], v[72:75]
  v_add_u32 v19, s33, v15
  s_add_u32 s33, s33, 8192
  v_mfma_f32_16x16x32_bf16 v[76:79], a[108:111], v[196:199], v[76:79]
  ds_read_b128 v[164:167], v18 offset:2048
  v_mfma_f32_16x16x32_bf16 v[80:83], a[112:115], v[196:199], v[80:83]
  buffer_load_dwordx4 v10, s[8:11], s30 offen offset:0 lds
  v_mfma_f32_16x16x32_bf16 v[84:87], a[116:119], v[196:199], v[84:87]
  s_waitcnt lgkmcnt(2)
  v_mfma_f32_16x16x32_bf16 v[88:91], a[108:111], v[200:203], v[88:91]
  ds_read_b128 v[168:171], v18 offset:4096
  v_mfma_f32_16x16x32_bf16 v[92:95], a[112:115], v[200:203], v[92:95]
  s_cmp_lt_u32 s33, 155648
  s_cselect_b32 s33, s33, 98304
  v_mfma_f32_16x16x32_bf16 v[96:99], a[116:119], v[200:203], v[96:99]
  v_mfma_f32_16x16x32_bf16 v[100:103], a[108:111], v[204:207], v[100:103]
  ds_read_b128 v[172:175], v18 offset:6144
  v_mfma_f32_16x16x32_bf16 v[104:107], a[112:115], v[204:207], v[104:107]
  v_mfma_f32_16x16x32_bf16 v[108:111], a[116:119], v[204:207], v[108:111]
  s_waitcnt lgkmcnt(2)
  v_mfma_f32_16x16x32_bf16 v[64:67], a[120:123], v[160:163], v[64:67]
  ds_read_b128 v[192:195], v19 offset:0
  v_mfma_f32_16x16x32_bf16 v[68:71], a[124:127], v[160:163], v[68:71]
  v_add_u32 v18, s33, v14
  s_mov_b32 s61, s60
  v_mfma_f32_16x16x32_bf16 v[72:75], a[128:131], v[160:163], v[72:75]
  s_add_u32 s60, s60, s62
  s_lshr_b32 s48, s20, 1
  v_mfma_f32_16x16x32_bf16 v[76:79], a[120:123], v[164:167], v[76:79]
  ds_read_b128 v[196:199], v19 offset:2048
  s_mul_i32 s48, s48, 393216
  v_mfma_f32_16x16x32_bf16 v[80:83], a[124:127], v[164:167], v[80:83]
  buffer_load_dwordx4 v11, s[8:11], s30 offen offset:1024 lds
  v_mfma_f32_16x16x32_bf16 v[84:87], a[128:131], v[164:167], v[84:87]
  s_waitcnt lgkmcnt(2)
  s_add_u32 s30, s30, 128
  v_mfma_f32_16x16x32_bf16 v[88:91], a[120:123], v[168:171], v[88:91]
  ds_read_b128 v[200:203], v19 offset:4096
  s_add_u32 m0, m0, 8192
  v_mfma_f32_16x16x32_bf16 v[92:95], a[124:127], v[168:171], v[92:95]
  s_cmp_lt_u32 m0, s46
  s_cselect_b32 m0, m0, s47
  v_mfma_f32_16x16x32_bf16 v[96:99], a[128:131], v[168:171], v[96:99]
  s_and_b32 s21, s20, 1
  s_mul_i32 s21, s21, 6144
  v_mfma_f32_16x16x32_bf16 v[100:103], a[120:123], v[172:175], v[100:103]
  ds_read_b128 v[204:207], v19 offset:6144
  s_add_u32 s48, s48, s21
  v_mfma_f32_16x16x32_bf16 v[104:107], a[124:127], v[172:175], v[104:107]
  s_add_u32 s48, s48, s27
  s_add_u32 s27, s27, s28
  v_mfma_f32_16x16x32_bf16 v[108:111], a[128:131], v[172:175], v[108:111]
  s_waitcnt vmcnt(14) lgkmcnt(2)
  s_barrier
  v_mfma_f32_16x16x32_bf16 v[64:67], a[132:135], v[192:195], v[64:67]
  ds_read_b128 v[160:163], v18 offset:0
  s_sub_u32 s26, s26, 1
  v_mfma_f32_16x16x32_bf16 v[68:71], a[136:139], v[192:195], v[68:71]
  v_mfma_f32_16x16x32_bf16 v[72:75], a[140:143], v[192:195], v[72:75]
  v_add_u32 v19, s33, v15
  s_add_u32 s33, s33, 8192
  v_mfma_f32_16x16x32_bf16 v[76:79], a[132:135], v[196:199], v[76:79]
  ds_read_b128 v[164:167], v18 offset:2048
  v_mfma_f32_16x16x32_bf16 v[80:83], a[136:139], v[196:199], v[80:83]
  buffer_load_dwordx4 v10, s[8:11], s30 offen offset:0 lds
  v_mfma_f32_16x16x32_bf16 v[84:87], a[140:143], v[196:199], v[84:87]
  s_waitcnt lgkmcnt(2)
  v_mfma_f32_16x16x32_bf16 v[88:91], a[132:135], v[200:203], v[88:91]
  ds_read_b128 v[168:171], v18 offset:4096
  v_mfma_f32_16x16x32_bf16 v[92:95], a[136:139], v[200:203], v[92:95]
  s_cmp_lt_u32 s33, 155648
  s_cselect_b32 s33, s33, 98304
  v_mfma_f32_16x16x32_bf16 v[96:99], a[140:143], v[200:203], v[96:99]
  v_mfma_f32_16x16x32_bf16 v[100:103], a[132:135], v[204:207], v[100:103]
  ds_read_b128 v[172:175], v18 offset:6144
  v_mfma_f32_16x16x32_bf16 v[104:107], a[136:139], v[204:207], v[104:107]
  v_mfma_f32_16x16x32_bf16 v[108:111], a[140:143], v[204:207], v[108:111]
  s_waitcnt lgkmcnt(2)
  v_mfma_f32_16x16x32_bf16 v[64:67], a[144:147], v[160:163], v[64:67]
  ds_read_b128 v[192:195], v19 offset:0
  v_mfma_f32_16x16x32_bf16 v[68:71], a[148:151], v[160:163], v[68:71]
  v_add_u32 v18, s33, v14
  v_mfma_f32_16x16x32_bf16 v[72:75], a[152:155], v[160:163], v[72:75]
  v_mfma_f32_16x16x32_bf16 v[76:79], a[144:147], v[164:167], v[76:79]
  ds_read_b128 v[196:199], v19 offset:2048
  v_mfma_f32_16x16x32_bf16 v[80:83], a[148:151], v[164:167], v[80:83]
  buffer_load_dwordx4 v11, s[8:11], s30 offen offset:1024 lds
  v_mfma_f32_16x16x32_bf16 v[84:87], a[152:155], v[164:167], v[84:87]
  s_waitcnt lgkmcnt(2)
  s_add_u32 s30, s30, 128
  v_mfma_f32_16x16x32_bf16 v[88:91], a[144:147], v[168:171], v[88:91]
  ds_read_b128 v[200:203], v19 offset:4096
  s_add_u32 m0, m0, 8192
  v_mfma_f32_16x16x32_bf16 v[92:95], a[148:151], v[168:171], v[92:95]
  s_cmp_lt_u32 m0, s46
  s_cselect_b32 m0, m0, s47
  v_mfma_f32_16x16x32_bf16 v[96:99], a[152:155], v[168:171], v[96:99]
  v_mfma_f32_16x16x32_bf16 v[100:103], a[144:147], v[172:175], v[100:103]
  ds_read_b128 v[204:207], v19 offset:6144
  v_mfma_f32_16x16x32_bf16 v[104:107], a[148:151], v[172:175], v[104:107]
  v_mfma_f32_16x16x32_bf16 v[108:111], a[152:155], v[172:175], v[108:111]
  s_waitcnt vmcnt(10) lgkmcnt(2)
  s_barrier
  v_mfma_f32_16x16x32_bf16 v[64:67], a[156:159], v[192:195], v[64:67]
  ds_read_b128 v[160:163], v18 offset:0
  v_mfma_f32_16x16x32_bf16 v[68:71], a[160:163], v[192:195], v[68:71]
  v_mfma_f32_16x16x32_bf16 v[72:75], a[164:167], v[192:195], v[72:75]
  v_add_u32 v19, s33, v15
  s_add_u32 s33, s33, 8192
  v_mfma_f32_16x16x32_bf16 v[76:79], a[156:159], v[196:199], v[76:79]
  ds_read_b128 v[164:167], v18 offset:2048
  v_mfma_f32_16x16x32_bf16 v[80:83], a[160:163], v[196:199], v[80:83]
  buffer_load_dwordx4 v10, s[8:11], s30 offen offset:0 lds
  v_mfma_f32_16x16x32_bf16 v[84:87], a[164:167], v[196:199], v[84:87]
  s_waitcnt lgkmcnt(2)
  v_mfma_f32_16x16x32_bf16 v[88:91], a[156:159], v[200:203], v[88:91]
  ds_read_b128 v[168:171], v18 offset:4096
  v_mfma_f32_16x16x32_bf16 v[92:95], a[160:163], v[200:203], v[92:95]
  s_cmp_lt_u32 s33, 155648
  s_cselect_b32 s33, s33, 98304
  v_mfma_f32_16x16x32_bf16 v[96:99], a[164:167], v[200:203], v[96:99]
  v_mfma_f32_16x16x32_bf16 v[100:103], a[156:159], v[204:207], v[100:103]
  ds_read_b128 v[172:175], v18 offset:6144
  v_mfma_f32_16x16x32_bf16 v[104:107], a[160:163], v[204:207], v[104:107]
  v_mfma_f32_16x16x32_bf16 v[108:111], a[164:167], v[204:207], v[108:111]
  s_waitcnt lgkmcnt(2)
  v_mfma_f32_16x16x32_bf16 v[64:67], a[168:171], v[160:163], v[64:67]
  ds_read_b128 v[192:195], v19 offset:0
  v_mfma_f32_16x16x32_bf16 v[68:71], a[172:175], v[160:163], v[68:71]
  v_add_u32 v18, s33, v14
  v_mfma_f32_16x16x32_bf16 v[72:75], a[176:179], v[160:163], v[72:75]
  v_mfma_f32_16x16x32_bf16 v[76:79], a[168:171], v[164:167], v[76:79]
  ds_read_b128 v[196:199], v19 offset:2048
  v_mfma_f32_16x16x32_bf16 v[80:83], a[172:175], v[164:167], v[80:83]
  buffer_load_dwordx4 v11, s[8:11], s30 offen offset:1024 lds
  v_mfma_f32_16x16x32_bf16 v[84:87], a[176:179], v[164:167], v[84:87]
  s_waitcnt lgkmcnt(2)
  s_add_u32 s30, s30, 128
  v_mfma_f32_16x16x32_bf16 v[88:91], a[168:171], v[168:171], v[88:91]
  ds_read_b128 v[200:203], v19 offset:4096
  s_add_u32 m0, m0, 8192
  v_mfma_f32_16x16x32_bf16 v[92:95], a[172:175], v[168:171], v[92:95]
  s_cmp_lt_u32 m0, s46
  s_cselect_b32 m0, m0, s47
  v_mfma_f32_16x16x32_bf16 v[96:99], a[176:179], v[168:171], v[96:99]
  v_mfma_f32_16x16x32_bf16 v[100:103], a[168:171], v[172:175], v[100:103]
  ds_read_b128 v[204:207], v19 offset:6144
  v_mfma_f32_16x16x32_bf16 v[104:107], a[172:175], v[172:175], v[104:107]
  v_mfma_f32_16x16x32_bf16 v[108:111], a[176:179], v[172:175], v[108:111]
  s_waitcnt vmcnt(8) lgkmcnt(2)
  s_barrier
  v_mfma_f32_16x16x32_bf16 v[64:67], a[180:183], v[192:195], v[64:67]
  ds_read_b128 v[160:163], v18 offset:0
  v_mfma_f32_16x16x32_bf16 v[68:71], a[184:187], v[192:195], v[68:71]
  v_mfma_f32_16x16x32_bf16 v[72:75], a[188:191], v[192:195], v[72:75]
  v_add_u32 v19, s33, v15
  s_add_u32 s33, s33, 8192
  v_mfma_f32_16x16x32_bf16 v[76:79], a[180:183], v[196:199], v[76:79]
  ds_read_b128 v[164:167], v18 offset:2048
  v_mfma_f32_16x16x32_bf16 v[80:83], a[184:187], v[196:199], v[80:83]
  buffer_load_dwordx4 v10, s[8:11], s30 offen offset:0 lds
  v_mfma_f32_16x16x32_bf16 v[84:87], a[188:191], v[196:199], v[84:87]
  s_waitcnt lgkmcnt(2)
  v_mfma_f32_16x16x32_bf16 v[88:91], a[180:183], v[200:203], v[88:91]
  ds_read_b128 v[168:171], v18 offset:4096
  v_mfma_f32_16x16x32_bf16 v[92:95], a[184:187], v[200:203], v[92:95]
  s_cmp_lt_u32 s33, 155648
  s_cselect_b32 s33, s33, 98304
  v_mfma_f32_16x16x32_bf16 v[96:99], a[188:191], v[200:203], v[96:99]
  v_mfma_f32_16x16x32_bf16 v[100:103], a[180:183], v[204:207], v[100:103]
  ds_read_b128 v[172:175], v18 offset:6144
  v_mfma_f32_16x16x32_bf16 v[104:107], a[184:187], v[204:207], v[104:107]
  v_mfma_f32_16x16x32_bf16 v[108:111], a[188:191], v[204:207], v[108:111]
  s_waitcnt lgkmcnt(2)
  v_mfma_f32_16x16x32_bf16 v[64:67], a[192:195], v[160:163], v[64:67]
  ds_read_b128 v[192:195], v19 offset:0
  v_mfma_f32_16x16x32_bf16 v[68:71], a[196:199], v[160:163], v[68:71]
  v_add_u32 v18, s33, v14
  v_mfma_f32_16x16x32_bf16 v[72:75], a[200:203], v[160:163], v[72:75]
  v_mfma_f32_16x16x32_bf16 v[76:79], a[192:195], v[164:167], v[76:79]
  ds_read_b128 v[196:199], v19 offset:2048
  v_mfma_f32_16x16x32_bf16 v[80:83], a[196:199], v[164:167], v[80:83]
  buffer_load_dwordx4 v11, s[8:11], s30 offen offset:1024 lds
  v_mfma_f32_16x16x32_bf16 v[84:87], a[200:203], v[164:167], v[84:87]
  s_waitcnt lgkmcnt(2)
  s_add_u32 s30, s30, 128
  v_mfma_f32_16x16x32_bf16 v[88:91], a[192:195], v[168:171], v[88:91]
  ds_read_b128 v[200:203], v19 offset:4096
  s_add_u32 m0, m0, 8192
  v_mfma_f32_16x16x32_bf16 v[92:95], a[196:199], v[168:171], v[92:95]
  s_cmp_lt_u32 m0, s46
  s_cselect_b32 m0, m0, s47
  v_mfma_f32_16x16x32_bf16 v[96:99], a[200:203], v[168:171], v[96:99]
  v_mfma_f32_16x16x32_bf16 v[100:103], a[192:195], v[172:175], v[100:103]
  ds_read_b128 v[204:207], v19 offset:6144
  v_mfma_f32_16x16x32_bf16 v[104:107], a[196:199], v[172:175], v[104:107]
  v_mfma_f32_16x16x32_bf16 v[108:111], a[200:203], v[172:175], v[108:111]
  s_waitcnt vmcnt(8) lgkmcnt(2)
  s_barrier
  v_mfma_f32_16x16x32_bf16 v[64:67], a[204:207], v[192:195], v[64:67]
  ds_read_b128 v[160:163], v18 offset:0
  v_mfma_f32_16x16x32_bf16 v[68:71], a[208:211], v[192:195], v[68:71]
  v_mfma_f32_16x16x32_bf16 v[72:75], a[212:215], v[192:195], v[72:75]
  v_add_u32 v19, s33, v15
  s_add_u32 s33, s33, 8192
  v_mfma_f32_16x16x32_bf16 v[76:79], a[204:207], v[196:199], v[76:79]
  ds_read_b128 v[164:167], v18 offset:2048
  v_mfma_f32_16x16x32_bf16 v[80:83], a[208:211], v[196:199], v[80:83]
  buffer_load_dwordx4 v10, s[8:11], s30 offen offset:0 lds
  v_mfma_f32_16x16x32_bf16 v[84:87], a[212:215], v[196:199], v[84:87]
  s_waitcnt lgkmcnt(2)
  v_mfma_f32_16x16x32_bf16 v[88:91], a[204:207], v[200:203], v[88:91]
  ds_read_b128 v[168:171], v18 offset:4096
  v_mfma_f32_16x16x32_bf16 v[92:95], a[208:211], v[200:203], v[92:95]
  s_cmp_lt_u32 s33, 155648
  s_cselect_b32 s33, s33, 98304
  v_mfma_f32_16x16x32_bf16 v[96:99], a[212:215], v[200:203], v[96:99]
  v_mfma_f32_16x16x32_bf16 v[100:103], a[204:207], v[204:207], v[100:103]
  ds_read_b128 v[172:175], v18 offset:6144
  v_mfma_f32_16x16x32_bf16 v[104:107], a[208:211], v[204:207], v[104:107]
  v_mfma_f32_16x16x32_bf16 v[108:111], a[212:215], v[204:207], v[108:111]
  s_waitcnt lgkmcnt(2)
  v_mfma_f32_16x16x32_bf16 v[64:67], a[216:219], v[160:163], v[64:67]
  ds_read_b128 v[192:195], v19 offset:0
  v_mfma_f32_16x16x32_bf16 v[68:71], a[220:223], v[160:163], v[68:71]
  v_add_u32 v18, s33, v14
  v_mfma_f32_16x16x32_bf16 v[72:75], a[224:227], v[160:163], v[72:75]
  v_mfma_f32_16x16x32_bf16 v[76:79], a[216:219], v[164:167], v[76:79]
  ds_read_b128 v[196:199], v19 offset:2048
  v_mfma_f32_16x16x32_bf16 v[80:83], a[220:223], v[164:167], v[80:83]
  buffer_load_dwordx4 v11, s[8:11], s30 offen offset:1024 lds
  v_mfma_f32_16x16x32_bf16 v[84:87], a[224:227], v[164:167], v[84:87]
  s_waitcnt lgkmcnt(2)
  s_add_u32 s30, s30, 128
  v_mfma_f32_16x16x32_bf16 v[88:91], a[216:219], v[168:171], v[88:91]
  ds_read_b128 v[200:203], v19 offset:4096
  s_add_u32 m0, m0, 8192
  v_mfma_f32_16x16x32_bf16 v[92:95], a[220:223], v[168:171], v[92:95]
  s_cmp_lt_u32 m0, s46
  s_cselect_b32 m0, m0, s47
  v_mfma_f32_16x16x32_bf16 v[96:99], a[224:227], v[168:171], v[96:99]
  v_mfma_f32_16x16x32_bf16 v[100:103], a[216:219], v[172:175], v[100:103]
  ds_read_b128 v[204:207], v19 offset:6144
  v_mfma_f32_16x16x32_bf16 v[104:107], a[220:223], v[172:175], v[104:107]
  v_mfma_f32_16x16x32_bf16 v[108:111], a[224:227], v[172:175], v[108:111]
  s_waitcnt vmcnt(8) lgkmcnt(2)
  s_barrier
  v_mfma_f32_16x16x32_bf16 v[64:67], a[228:231], v[192:195], v[64:67]
  ds_read_b128 v[160:163], v18 offset:0
  v_mfma_f32_16x16x32_bf16 v[68:71], a[232:235], v[192:195], v[68:71]
  v_mfma_f32_16x16x32_bf16 v[72:75], a[236:239], v[192:195], v[72:75]
  v_add_u32 v19, s33, v15
  s_add_u32 s33, s33, 8192
  v_mfma_f32_16x16x32_bf16 v[76:79], a[228:231], v[196:199], v[76:79]
  ds_read_b128 v[164:167], v18 offset:2048
  v_cvt_pk_bf16_f32 v224, v64, v65
  v_cvt_pk_bf16_f32 v225, v66, v67
  v_mfma_f32_16x16x32_bf16 v[80:83], a[232:235], v[196:199], v[80:83]
  buffer_load_dwordx4 v10, s[8:11], s30 offen offset:0 lds
  v_cvt_pk_bf16_f32 v226, v68, v69
  v_cvt_pk_bf16_f32 v227, v70, v71
  v_mfma_f32_16x16x32_bf16 v[84:87], a[236:239], v[196:199], v[84:87]
  s_waitcnt lgkmcnt(2)
  v_cvt_pk_bf16_f32 v228, v72, v73
  v_cvt_pk_bf16_f32 v229, v74, v75
  ds_write_b64 v22, v[224:225] offset:0
  v_mfma_f32_16x16x32_bf16 v[88:91], a[228:231], v[200:203], v[88:91]
  ds_read_b128 v[168:171], v18 offset:4096
  ds_write_b64 v22, v[226:227] offset:8
  ds_write_b64 v22, v[228:229] offset:16
  v_cvt_pk_bf16_f32 v230, v76, v77
  v_mfma_f32_16x16x32_bf16 v[92:95], a[232:235], v[200:203], v[92:95]
  s_cmp_lt_u32 s33, 155648
  s_cselect_b32 s33, s33, 98304
  v_cvt_pk_bf16_f32 v231, v78, v79
  v_cvt_pk_bf16_f32 v232, v80, v81
  v_mfma_f32_16x16x32_bf16 v[96:99], a[236:239], v[200:203], v[96:99]
  v_cvt_pk_bf16_f32 v233, v82, v83
  v_cvt_pk_bf16_f32 v234, v84, v85
  v_cvt_pk_bf16_f32 v235, v86, v87
  ds_write_b64 v22, v[230:231] offset:6400
  v_mfma_f32_16x16x32_bf16 v[100:103], a[228:231], v[204:207], v[100:103]
  ds_read_b128 v[172:175], v18 offset:6144
  ds_write_b64 v22, v[232:233] offset:6408
  ds_write_b64 v22, v[234:235] offset:6416
  v_cvt_pk_bf16_f32 v236, v88, v89
  v_mfma_f32_16x16x32_bf16 v[104:107], a[232:235], v[204:207], v[104:107]
  v_cvt_pk_bf16_f32 v237, v90, v91
  v_cvt_pk_bf16_f32 v238, v92, v93
  v_cvt_pk_bf16_f32 v239, v94, v95
  v_mfma_f32_16x16x32_bf16 v[108:111], a[236:239], v[204:207], v[108:111]
  v_cvt_pk_bf16_f32 v240, v96, v97
  v_cvt_pk_bf16_f32 v241, v98, v99
  ds_write_b64 v22, v[236:237] offset:12800
  ds_write_b64 v22, v[238:239] offset:12808
  ds_write_b64 v22, v[240:241] offset:12816
  s_nop 2
  v_cvt_pk_bf16_f32 v242, v100, v101
  v_cvt_pk_bf16_f32 v243, v102, v103
  v_cvt_pk_bf16_f32 v244, v104, v105
  v_cvt_pk_bf16_f32 v245, v106, v107
  v_cvt_pk_bf16_f32 v246, v108, v109
  v_cvt_pk_bf16_f32 v247, v110, v111
  ds_write_b64 v22, v[242:243] offset:19200
  ds_write_b64 v22, v[244:245] offset:19208
  ds_write_b64 v22, v[246:247] offset:19216
  s_waitcnt lgkmcnt(14)
  s_sub_u32 s21, s26, 1
  s_cmp_lt_u32 s21, 5
  s_cbranch_scc1 kvm_blk_138
  s_waitcnt lgkmcnt(0)
  s_barrier
  ds_read_b128 v[224:227], v23 offset:0
  ds_read_b128 v[228:231], v23 offset:64
  ds_read_b128 v[232:235], v23 offset:128
  ds_read_b128 v[236:239], v23 offset:192
  ds_read_b128 v[240:243], v23 offset:256
  ds_read_b128 v[244:247], v23 offset:320
  s_waitcnt lgkmcnt(0)
  s_add_u32 s21, s48, 0
  buffer_store_dwordx4 v[224:227], v26, s[16:19], s21 offen offset:0 sc1
  buffer_store_dwordx4 v[228:231], v26, s[16:19], s21 offen offset:1024 sc1
  buffer_store_dwordx4 v[232:235], v26, s[16:19], s21 offen offset:2048 sc1
  buffer_store_dwordx4 v[236:239], v26, s[16:19], s21 offen offset:3072 sc1
  s_add_u32 s21, s48, 4096
  buffer_store_dwordx4 v[240:243], v26, s[16:19], s21 offen offset:0 sc1
  buffer_store_dwordx4 v[244:247], v26, s[16:19], s21 offen offset:1024 sc1
  s_nop 1
  s_cmp_eq_u32 s26, 0
  s_cbranch_scc1 kvm_139
  s_waitcnt vmcnt(0)
  s_barrier
  s_cmp_lg_u32 s20, 0
  s_cbranch_scc1 af_140
  v_mov_b32 v4, 0
  v_mov_b32 v5, 1
  s_mov_b64 exec, 1
  buffer_atomic_add v5, v4, s[72:75], s61 offen sc1
  s_mov_b64 exec, -1
  s_nop 1
af_140:
  s_mov_b32 s48, 0x80000000
  s_branch kvm_blk_138
kvm_139:
  s_waitcnt vmcnt(6)
  s_barrier
  s_mov_b32 s24, 655360
  s_mov_b32 s25, 163840
  v_lshrrev_b32 v11, 3, v1
  v_and_b32 v12, 7, v1
  v_xor_b32 v12, v12, v11
  v_mul_u32_u24 v11, 1280, v11
  v_lshl_add_u32 v10, v12, 4, v11
  s_mul_i32 s46, s20, 40960
  v_add_u32 v10, s46, v10
  s_lshl_b32 s47, s20, 12
  s_add_u32 s47, s47, 0
  s_add_u32 s46, s47, 98304
  s_mov_b32 s30, s24
  s_add_u32 s32, s47, 32768
  v_add_u32 v11, 9216, v10
  v_add_u32 v12, 18432, v10
  v_add_u32 v13, 27648, v10
  s_mov_b32 m0, s32
  s_nop 0
  buffer_load_dwordx4 v10, s[8:11], s30 offen offset:0 lds
  buffer_load_dwordx4 v11, s[8:11], s30 offen offset:1024 lds
  buffer_load_dwordx4 v12, s[8:11], s30 offen offset:2048 lds
  buffer_load_dwordx4 v13, s[8:11], s30 offen offset:3072 lds
  s_add_u32 s30, s30, 128
  s_add_u32 s32, s32, 16384
  s_cmp_lt_u32 s32, s46
  s_cselect_b32 s32, s32, s47
  s_mov_b32 m0, s32
  s_nop 0
  buffer_load_dwordx4 v10, s[8:11], s30 offen offset:0 lds
  buffer_load_dwordx4 v11, s[8:11], s30 offen offset:1024 lds
  buffer_load_dwordx4 v12, s[8:11], s30 offen offset:2048 lds
  buffer_load_dwordx4 v13, s[8:11], s30 offen offset:3072 lds
  s_add_u32 s30, s30, 128
  s_add_u32 s32, s32, 16384
  s_cmp_lt_u32 s32, s46
  s_cselect_b32 s32, s32, s47
  s_mov_b32 m0, s32
  s_nop 0
  buffer_load_dwordx4 v10, s[8:11], s30 offen offset:0 lds
  buffer_load_dwordx4 v11, s[8:11], s30 offen offset:1024 lds
  buffer_load_dwordx4 v12, s[8:11], s30 offen offset:2048 lds
  buffer_load_dwordx4 v13, s[8:11], s30 offen offset:3072 lds
  s_add_u32 s30, s30, 128
  s_add_u32 s32, s32, 16384
  s_cmp_lt_u32 s32, s46
  s_cselect_b32 s32, s32, s47
  s_mov_b32 m0, s32
  s_nop 0
  buffer_load_dwordx4 v10, s[8:11], s30 offen offset:0 lds
  buffer_load_dwordx4 v11, s[8:11], s30 offen offset:1024 lds
  buffer_load_dwordx4 v12, s[8:11], s30 offen offset:2048 lds
  buffer_load_dwordx4 v13, s[8:11], s30 offen offset:3072 lds
  s_add_u32 s30, s30, 128
  s_add_u32 s32, s32, 16384
  s_cmp_lt_u32 s32, s46
  s_cselect_b32 s32, s32, s47
  s_waitcnt vmcnt(16)
  s_barrier
  s_cmp_lg_u32 s20, 0
  s_cbranch_scc1 af_141
  v_mov_b32 v4, 0
  v_mov_b32 v5, 1
  s_mov_b64 exec, 1
  buffer_atomic_add v5, v4, s[72:75], s61 offen sc1
  s_mov_b64 exec, -1
  s_nop 1
af_141:
  s_mov_b32 s26, 12
  s_mov_b32 s28, 1572864
kv_main:
  v_and_b32 v6, 7, v2
  v_add_u32 v4, 0, v3
  v_xor_b32 v4, v4, v6
  v_lshlrev_b32 v4, 4, v4
  v_lshl_add_u32 v14, v2, 7, v4
  v_add_u32 v4, 4, v3
  v_xor_b32 v4, v4, v6
  v_lshlrev_b32 v4, 4, v4
  v_lshl_add_u32 v15, v2, 7, v4
  v_mul_u32_u24 v22, 400, v2
  v_mul_u32_u24 v4, 24, v3
  s_mul_i32 s21, s20, 96
  s_add_u32 s21, s21, 98304
  v_add3_u32 v22, v22, v4, s21
  v_mov_b32 v9, 2731
  s_mul_i32 s21, s20, 12800
  s_add_u32 s21, s21, 98304
  v_mul_u32_u24 v4, 400, v2
  v_lshlrev_b32 v5, 4, v3
  v_add3_u32 v23, v4, v5, s21
  v_lshlrev_b32 v26, 4, v1
  s_mov_b32 s33, 32768
  s_mov_b32 s48, 0x80000000
  s_mov_b32 m0, s32
  s_nop 0
  buffer_load_dwordx4 v10, s[8:11], s30 offen offset:0 lds
  buffer_load_dwordx4 v11, s[8:11], s30 offen offset:1024 lds
  s_waitcnt vmcnt(14)
  s_barrier
  v_add_u32 v18, s33, v14
  v_add_u32 v19, s33, v15
  s_add_u32 s33, s33, 16384
  s_cmp_lt_u32 s33, 98304
  s_cselect_b32 s33, s33, 0
  ds_read_b128 v[160:163], v18 offset:0
  ds_read_b128 v[164:167], v18 offset:2048
  ds_read_b128 v[168:171], v18 offset:4096
  ds_read_b128 v[172:175], v18 offset:6144
  ds_read_b128 v[176:179], v18 offset:8192
  ds_read_b128 v[180:183], v18 offset:10240
  ds_read_b128 v[184:187], v18 offset:12288
  ds_read_b128 v[188:191], v18 offset:14336
  s_waitcnt lgkmcnt(0)
kv_blk_144:
  v_mfma_f32_16x16x32_bf16 v[64:67], a[0:3], v[160:163], 0
  ds_read_b128 v[192:195], v19 offset:0
  ds_write_b64 v22, v[240:241] offset:12816
  v_mfma_f32_16x16x32_bf16 v[68:71], a[4:7], v[160:163], 0
  v_add_u32 v18, s33, v14
  v_cvt_pk_bf16_f32 v242, v100, v101
  v_mfma_f32_16x16x32_bf16 v[72:75], a[8:11], v[160:163], 0
  v_cvt_pk_bf16_f32 v243, v102, v103
  v_cvt_pk_bf16_f32 v244, v104, v105
  v_mfma_f32_16x16x32_bf16 v[76:79], a[0:3], v[164:167], 0
  ds_read_b128 v[196:199], v19 offset:2048
  v_cvt_pk_bf16_f32 v245, v106, v107
  v_mfma_f32_16x16x32_bf16 v[80:83], a[4:7], v[164:167], 0
  buffer_load_dwordx4 v12, s[8:11], s30 offen offset:2048 lds
  v_mfma_f32_16x16x32_bf16 v[84:87], a[8:11], v[164:167], 0
  v_cvt_pk_bf16_f32 v246, v108, v109
  v_cvt_pk_bf16_f32 v247, v110, v111
  v_mfma_f32_16x16x32_bf16 v[88:91], a[0:3], v[168:171], 0
  ds_read_b128 v[200:203], v19 offset:4096
  ds_write_b64 v22, v[242:243] offset:19200
  v_mfma_f32_16x16x32_bf16 v[92:95], a[4:7], v[168:171], 0
  ds_write_b64 v22, v[244:245] offset:19208
  ds_write_b64 v22, v[246:247] offset:19216
  v_mfma_f32_16x16x32_bf16 v[96:99], a[8:11], v[168:171], 0
  v_cvt_pk_bf16_f32 v224, v112, v113
  v_cvt_pk_bf16_f32 v225, v114, v115
  v_mfma_f32_16x16x32_bf16 v[100:103], a[0:3], v[172:175], 0
  ds_read_b128 v[204:207], v19 offset:6144
  v_cvt_pk_bf16_f32 v226, v116, v117
  v_mfma_f32_16x16x32_bf16 v[104:107], a[4:7], v[172:175], 0
  v_cvt_pk_bf16_f32 v227, v118, v119
  v_cvt_pk_bf16_f32 v228, v120, v121
  v_mfma_f32_16x16x32_bf16 v[108:111], a[8:11], v[172:175], 0
  s_waitcnt lgkmcnt(10)
  v_cvt_pk_bf16_f32 v229, v122, v123
  v_mfma_f32_16x16x32_bf16 v[112:115], a[0:3], v[176:179], 0
  ds_read_b128 v[208:211], v19 offset:8192
  ds_write_b64 v22, v[224:225] offset:25600
  v_mfma_f32_16x16x32_bf16 v[116:119], a[4:7], v[176:179], 0
  ds_write_b64 v22, v[226:227] offset:25608
  ds_write_b64 v22, v[228:229] offset:25616
  v_mfma_f32_16x16x32_bf16 v[120:123], a[8:11], v[176:179], 0
  v_cvt_pk_bf16_f32 v230, v124, v125
  v_cvt_pk_bf16_f32 v231, v126, v127
  v_mfma_f32_16x16x32_bf16 v[124:127], a[0:3], v[180:183], 0
  ds_read_b128 v[212:215], v19 offset:10240
  v_cvt_pk_bf16_f32 v232, v128, v129
  v_cvt_pk_bf16_f32 v233, v130, v131
  v_mfma_f32_16x16x32_bf16 v[128:131], a[4:7], v[180:183], 0
  buffer_load_dwordx4 v13, s[8:11], s30 offen offset:3072 lds
  v_cvt_pk_bf16_f32 v234, v132, v133
  v_cvt_pk_bf16_f32 v235, v134, v135
  v_mfma_f32_16x16x32_bf16 v[132:135], a[8:11], v[180:183], 0
  s_add_u32 s30, s30, 128
  s_add_u32 m0, m0, 16384
  ds_write_b64 v22, v[230:231] offset:32000
  ds_write_b64 v22, v[232:233] offset:32008
  ds_write_b64 v22, v[234:235] offset:32016
  v_cvt_pk_bf16_f32 v236, v136, v137
  v_cvt_pk_bf16_f32 v237, v138, v139
  v_mfma_f32_16x16x32_bf16 v[136:139], a[0:3], v[184:187], 0
  ds_read_b128 v[216:219], v19 offset:12288
  v_cvt_pk_bf16_f32 v238, v140, v141
  v_cvt_pk_bf16_f32 v239, v142, v143
  v_mfma_f32_16x16x32_bf16 v[140:143], a[4:7], v[184:187], 0
  s_cmp_lt_u32 m0, s46
  s_cselect_b32 m0, m0, s47
  v_cvt_pk_bf16_f32 v240, v144, v145
  v_cvt_pk_bf16_f32 v241, v146, v147
  v_mfma_f32_16x16x32_bf16 v[144:147], a[8:11], v[184:187], 0
  ds_write_b64 v22, v[236:237] offset:38400
  ds_write_b64 v22, v[238:239] offset:38408
  ds_write_b64 v22, v[240:241] offset:38416
  v_cvt_pk_bf16_f32 v242, v148, v149
  v_cvt_pk_bf16_f32 v243, v150, v151
  v_mfma_f32_16x16x32_bf16 v[148:151], a[0:3], v[188:191], 0
  ds_read_b128 v[220:223], v19 offset:14336
  v_cvt_pk_bf16_f32 v244, v152, v153
  v_cvt_pk_bf16_f32 v245, v154, v155
  v_mfma_f32_16x16x32_bf16 v[152:155], a[4:7], v[188:191], 0
  v_cvt_pk_bf16_f32 v246, v156, v157
  v_cvt_pk_bf16_f32 v247, v158, v159
  v_mfma_f32_16x16x32_bf16 v[156:159], a[8:11], v[188:191], 0
  s_waitcnt vmcnt(12) lgkmcnt(13)
  s_barrier
  v_mfma_f32_16x16x32_bf16 v[64:67], a[12:15], v[192:195], v[64:67]
  ds_read_b128 v[160:163], v18 offset:0
  ds_write_b64 v22, v[242:243] offset:44800
  v_mfma_f32_16x16x32_bf16 v[68:71], a[16:19], v[192:195], v[68:71]
  ds_write_b64 v22, v[244:245] offset:44808
  ds_write_b64 v22, v[246:247] offset:44816
  v_mfma_f32_16x16x32_bf16 v[72:75], a[20:23], v[192:195], v[72:75]
  v_add_u32 v19, s33, v15
  s_add_u32 s33, s33, 16384
  v_mfma_f32_16x16x32_bf16 v[76:79], a[12:15], v[196:199], v[76:79]
  ds_read_b128 v[164:167], v18 offset:2048
  v_mfma_f32_16x16x32_bf16 v[80:83], a[16:19], v[196:199], v[80:83]
  buffer_load_dwordx4 v10, s[8:11], s30 offen offset:0 lds
  v_mfma_f32_16x16x32_bf16 v[84:87], a[20:23], v[196:199], v[84:87]
  s_cmp_lt_u32 s33, 98304
  s_cselect_b32 s33, s33, 0
  v_mfma_f32_16x16x32_bf16 v[88:91], a[12:15], v[200:203], v[88:91]
  ds_read_b128 v[168:171], v18 offset:4096
  v_mfma_f32_16x16x32_bf16 v[92:95], a[16:19], v[200:203], v[92:95]
  v_mfma_f32_16x16x32_bf16 v[96:99], a[20:23], v[200:203], v[96:99]
  v_mfma_f32_16x16x32_bf16 v[100:103], a[12:15], v[204:207], v[100:103]
  ds_read_b128 v[172:175], v18 offset:6144
  v_mfma_f32_16x16x32_bf16 v[104:107], a[16:19], v[204:207], v[104:107]
  v_mfma_f32_16x16x32_bf16 v[108:111], a[20:23], v[204:207], v[108:111]
  s_waitcnt lgkmcnt(7)
  v_mfma_f32_16x16x32_bf16 v[112:115], a[12:15], v[208:211], v[112:115]
  ds_read_b128 v[176:179], v18 offset:8192
  v_mfma_f32_16x16x32_bf16 v[116:119], a[16:19], v[208:211], v[116:119]
  v_mfma_f32_16x16x32_bf16 v[120:123], a[20:23], v[208:211], v[120:123]
  v_mfma_f32_16x16x32_bf16 v[124:127], a[12:15], v[212:215], v[124:127]
  ds_read_b128 v[180:183], v18 offset:10240
  v_mfma_f32_16x16x32_bf16 v[128:131], a[16:19], v[212:215], v[128:131]
  buffer_load_dwordx4 v11, s[8:11], s30 offen offset:1024 lds
  v_mfma_f32_16x16x32_bf16 v[132:135], a[20:23], v[212:215], v[132:135]
  v_mfma_f32_16x16x32_bf16 v[136:139], a[12:15], v[216:219], v[136:139]
  ds_read_b128 v[184:187], v18 offset:12288
  v_mfma_f32_16x16x32_bf16 v[140:143], a[16:19], v[216:219], v[140:143]
  v_mfma_f32_16x16x32_bf16 v[144:147], a[20:23], v[216:219], v[144:147]
  v_mfma_f32_16x16x32_bf16 v[148:151], a[12:15], v[220:223], v[148:151]
  ds_read_b128 v[188:191], v18 offset:14336
  v_mfma_f32_16x16x32_bf16 v[152:155], a[16:19], v[220:223], v[152:155]
  v_mfma_f32_16x16x32_bf16 v[156:159], a[20:23], v[220:223], v[156:159]
  s_waitcnt lgkmcnt(4)
  v_mfma_f32_16x16x32_bf16 v[64:67], a[24:27], v[160:163], v[64:67]
  ds_read_b128 v[192:195], v19 offset:0
  v_mfma_f32_16x16x32_bf16 v[68:71], a[28:31], v[160:163], v[68:71]
  v_add_u32 v18, s33, v14
  v_mfma_f32_16x16x32_bf16 v[72:75], a[32:35], v[160:163], v[72:75]
  v_mfma_f32_16x16x32_bf16 v[76:79], a[24:27], v[164:167], v[76:79]
  ds_read_b128 v[196:199], v19 offset:2048
  v_mfma_f32_16x16x32_bf16 v[80:83], a[28:31], v[164:167], v[80:83]
  buffer_load_dwordx4 v12, s[8:11], s30 offen offset:2048 lds
  v_mfma_f32_16x16x32_bf16 v[84:87], a[32:35], v[164:167], v[84:87]
  v_mfma_f32_16x16x32_bf16 v[88:91], a[24:27], v[168:171], v[88:91]
  ds_read_b128 v[200:203], v19 offset:4096
  v_mfma_f32_16x16x32_bf16 v[92:95], a[28:31], v[168:171], v[92:95]
  v_mfma_f32_16x16x32_bf16 v[96:99], a[32:35], v[168:171], v[96:99]
  v_mfma_f32_16x16x32_bf16 v[100:103], a[24:27], v[172:175], v[100:103]
  ds_read_b128 v[204:207], v19 offset:6144
  v_mfma_f32_16x16x32_bf16 v[104:107], a[28:31], v[172:175], v[104:107]
  v_mfma_f32_16x16x32_bf16 v[108:111], a[32:35], v[172:175], v[108:111]
  s_waitcnt lgkmcnt(4)
  v_mfma_f32_16x16x32_bf16 v[112:115], a[24:27], v[176:179], v[112:115]
  ds_read_b128 v[208:211], v19 offset:8192
  v_mfma_f32_16x16x32_bf16 v[116:119], a[28:31], v[176:179], v[116:119]
  v_mfma_f32_16x16x32_bf16 v[120:123], a[32:35], v[176:179], v[120:123]
  v_mfma_f32_16x16x32_bf16 v[124:127], a[24:27], v[180:183], v[124:127]
  ds_read_b128 v[212:215], v19 offset:10240
  v_mfma_f32_16x16x32_bf16 v[128:131], a[28:31], v[180:183], v[128:131]
  buffer_load_dwordx4 v13, s[8:11], s30 offen offset:3072 lds
  v_mfma_f32_16x16x32_bf16 v[132:135], a[32:35], v[180:183], v[132:135]
  s_add_u32 s30, s30, 128
  s_add_u32 m0, m0, 16384
  v_mfma_f32_16x16x32_bf16 v[136:139], a[24:27], v[184:187], v[136:139]
  ds_read_b128 v[216:219], v19 offset:12288
  v_mfma_f32_16x16x32_bf16 v[140:143], a[28:31], v[184:187], v[140:143]
  s_cmp_lt_u32 m0, s46
  s_cselect_b32 m0, m0, s47
  v_mfma_f32_16x16x32_bf16 v[144:147], a[32:35], v[184:187], v[144:147]
  v_mfma_f32_16x16x32_bf16 v[148:151], a[24:27], v[188:191], v[148:151]
  ds_read_b128 v[220:223], v19 offset:14336
  v_mfma_f32_16x16x32_bf16 v[152:155], a[28:31], v[188:191], v[152:155]
  v_mfma_f32_16x16x32_bf16 v[156:159], a[32:35], v[188:191], v[156:159]
  s_waitcnt vmcnt(12) lgkmcnt(4)
  s_barrier
  v_mfma_f32_16x16x32_bf16 v[64:67], a[36:39], v[192:195], v[64:67]
  ds_read_b128 v[160:163], v18 offset:0
  v_mfma_f32_16x16x32_bf16 v[68:71], a[40:43], v[192:195], v[68:71]
  v_mfma_f32_16x16x32_bf16 v[72:75], a[44:47], v[192:195], v[72:75]
  v_add_u32 v19, s33, v15
  s_add_u32 s33, s33, 16384
  v_mfma_f32_16x16x32_bf16 v[76:79], a[36:39], v[196:199], v[76:79]
  ds_read_b128 v[164:167], v18 offset:2048
  v_mfma_f32_16x16x32_bf16 v[80:83], a[40:43], v[196:199], v[80:83]
  buffer_load_dwordx4 v10, s[8:11], s30 offen offset:0 lds
  v_mfma_f32_16x16x32_bf16 v[84:87], a[44:47], v[196:199], v[84:87]
  s_cmp_lt_u32 s33, 98304
  s_cselect_b32 s33, s33, 0
  v_mfma_f32_16x16x32_bf16 v[88:91], a[36:39], v[200:203], v[88:91]
  ds_read_b128 v[168:171], v18 offset:4096
  v_mfma_f32_16x16x32_bf16 v[92:95], a[40:43], v[200:203], v[92:95]
  ds_read_b128 v[224:227], v23 offset:0
  v_mfma_f32_16x16x32_bf16 v[96:99], a[44:47], v[200:203], v[96:99]
  v_mfma_f32_16x16x32_bf16 v[100:103], a[36:39], v[204:207], v[100:103]
  ds_read_b128 v[172:175], v18 offset:6144
  v_mfma_f32_16x16x32_bf16 v[104:107], a[40:43], v[204:207], v[104:107]
  v_mfma_f32_16x16x32_bf16 v[108:111], a[44:47], v[204:207], v[108:111]
  s_waitcnt lgkmcnt(5)
  v_mfma_f32_16x16x32_bf16 v[112:115], a[36:39], v[208:211], v[112:115]
  ds_read_b128 v[176:179], v18 offset:8192
  v_mfma_f32_16x16x32_bf16 v[116:119], a[40:43], v[208:211], v[116:119]
  v_mfma_f32_16x16x32_bf16 v[120:123], a[44:47], v[208:211], v[120:123]
  v_mfma_f32_16x16x32_bf16 v[124:127], a[36:39], v[212:215], v[124:127]
  ds_read_b128 v[180:183], v18 offset:10240
  v_mfma_f32_16x16x32_bf16 v[128:131], a[40:43], v[212:215], v[128:131]
  buffer_load_dwordx4 v11, s[8:11], s30 offen offset:1024 lds
  v_mfma_f32_16x16x32_bf16 v[132:135], a[44:47], v[212:215], v[132:135]
  v_mfma_f32_16x16x32_bf16 v[136:139], a[36:39], v[216:219], v[136:139]
  ds_read_b128 v[184:187], v18 offset:12288
  v_mfma_f32_16x16x32_bf16 v[140:143], a[40:43], v[216:219], v[140:143]
  ds_read_b128 v[228:231], v23 offset:64
  v_mfma_f32_16x16x32_bf16 v[144:147], a[44:47], v[216:219], v[144:147]
  v_mfma_f32_16x16x32_bf16 v[148:151], a[36:39], v[220:223], v[148:151]
  ds_read_b128 v[188:191], v18 offset:14336
  v_mfma_f32_16x16x32_bf16 v[152:155], a[40:43], v[220:223], v[152:155]
  v_mfma_f32_16x16x32_bf16 v[156:159], a[44:47], v[220:223], v[156:159]
  s_waitcnt lgkmcnt(5)
  v_mfma_f32_16x16x32_bf16 v[64:67], a[48:51], v[160:163], v[64:67]
  ds_read_b128 v[192:195], v19 offset:0
  v_mfma_f32_16x16x32_bf16 v[68:71], a[52:55], v[160:163], v[68:71]
  v_add_u32 v18, s33, v14
  v_mfma_f32_16x16x32_bf16 v[72:75], a[56:59], v[160:163], v[72:75]
  v_mfma_f32_16x16x32_bf16 v[76:79], a[48:51], v[164:167], v[76:79]
  ds_read_b128 v[196:199], v19 offset:2048
  v_mfma_f32_16x16x32_bf16 v[80:83], a[52:55], v[164:167], v[80:83]
  buffer_load_dwordx4 v12, s[8:11], s30 offen offset:2048 lds
  v_mfma_f32_16x16x32_bf16 v[84:87], a[56:59], v[164:167], v[84:87]
  v_mfma_f32_16x16x32_bf16 v[88:91], a[48:51], v[168:171], v[88:91]
  ds_read_b128 v[200:203], v19 offset:4096
  v_mfma_f32_16x16x32_bf16 v[92:95], a[52:55], v[168:171], v[92:95]
  s_add_u32 s21, s48, 0
  ds_read_b128 v[232:235], v23 offset:128
  v_mfma_f32_16x16x32_bf16 v[96:99], a[56:59], v[168:171], v[96:99]
  v_mfma_f32_16x16x32_bf16 v[100:103], a[48:51], v[172:175], v[100:103]
  ds_read_b128 v[204:207], v19 offset:6144
  v_mfma_f32_16x16x32_bf16 v[104:107], a[52:55], v[172:175], v[104:107]
  buffer_store_dwordx4 v[224:227], v26, s[16:19], s21 offen offset:0 sc1
  v_mfma_f32_16x16x32_bf16 v[108:111], a[56:59], v[172:175], v[108:111]
  s_waitcnt lgkmcnt(5)
  v_mfma_f32_16x16x32_bf16 v[112:115], a[48:51], v[176:179], v[112:115]
  ds_read_b128 v[208:211], v19 offset:8192
  v_mfma_f32_16x16x32_bf16 v[116:119], a[52:55], v[176:179], v[116:119]
  v_mfma_f32_16x16x32_bf16 v[120:123], a[56:59], v[176:179], v[120:123]
  v_mfma_f32_16x16x32_bf16 v[124:127], a[48:51], v[180:183], v[124:127]
  ds_read_b128 v[212:215], v19 offset:10240
  v_mfma_f32_16x16x32_bf16 v[128:131], a[52:55], v[180:183], v[128:131]
  buffer_load_dwordx4 v13, s[8:11], s30 offen offset:3072 lds
  v_mfma_f32_16x16x32_bf16 v[132:135], a[56:59], v[180:183], v[132:135]
  s_add_u32 s30, s30, 128
  s_add_u32 m0, m0, 16384
  v_mfma_f32_16x16x32_bf16 v[136:139], a[48:51], v[184:187], v[136:139]
  ds_read_b128 v[216:219], v19 offset:12288
  v_mfma_f32_16x16x32_bf16 v[140:143], a[52:55], v[184:187], v[140:143]
  s_cmp_lt_u32 m0, s46
  s_cselect_b32 m0, m0, s47
  v_mfma_f32_16x16x32_bf16 v[144:147], a[56:59], v[184:187], v[144:147]
  ds_read_b128 v[236:239], v23 offset:192
  v_mfma_f32_16x16x32_bf16 v[148:151], a[48:51], v[188:191], v[148:151]
  ds_read_b128 v[220:223], v19 offset:14336
  v_mfma_f32_16x16x32_bf16 v[152:155], a[52:55], v[188:191], v[152:155]
  buffer_store_dwordx4 v[228:231], v26, s[16:19], s21 offen offset:1024 sc1
  v_mfma_f32_16x16x32_bf16 v[156:159], a[56:59], v[188:191], v[156:159]
  s_waitcnt vmcnt(14) lgkmcnt(5)
  s_barrier
  v_mfma_f32_16x16x32_bf16 v[64:67], a[60:63], v[192:195], v[64:67]
  ds_read_b128 v[160:163], v18 offset:0
  v_mfma_f32_16x16x32_bf16 v[68:71], a[64:67], v[192:195], v[68:71]
  v_mfma_f32_16x16x32_bf16 v[72:75], a[68:71], v[192:195], v[72:75]
  v_add_u32 v19, s33, v15
  s_add_u32 s33, s33, 16384
  v_mfma_f32_16x16x32_bf16 v[76:79], a[60:63], v[196:199], v[76:79]
  ds_read_b128 v[164:167], v18 offset:2048
  v_mfma_f32_16x16x32_bf16 v[80:83], a[64:67], v[196:199], v[80:83]
  buffer_load_dwordx4 v10, s[8:11], s30 offen offset:0 lds
  v_mfma_f32_16x16x32_bf16 v[84:87], a[68:71], v[196:199], v[84:87]
  s_cmp_lt_u32 s33, 98304
  s_cselect_b32 s33, s33, 0
  v_mfma_f32_16x16x32_bf16 v[88:91], a[60:63], v[200:203], v[88:91]
  ds_read_b128 v[168:171], v18 offset:4096
  v_mfma_f32_16x16x32_bf16 v[92:95], a[64:67], v[200:203], v[92:95]
  ds_read_b128 v[240:243], v23 offset:256
  v_mfma_f32_16x16x32_bf16 v[96:99], a[68:71], v[200:203], v[96:99]
  v_mfma_f32_16x16x32_bf16 v[100:103], a[60:63], v[204:207], v[100:103]
  ds_read_b128 v[172:175], v18 offset:6144
  v_mfma_f32_16x16x32_bf16 v[104:107], a[64:67], v[204:207], v[104:107]
  buffer_store_dwordx4 v[232:235], v26, s[16:19], s21 offen offset:2048 sc1
  v_mfma_f32_16x16x32_bf16 v[108:111], a[68:71], v[204:207], v[108:111]
  s_waitcnt lgkmcnt(5)
  v_mfma_f32_16x16x32_bf16 v[112:115], a[60:63], v[208:211], v[112:115]
  ds_read_b128 v[176:179], v18 offset:8192
  v_mfma_f32_16x16x32_bf16 v[116:119], a[64:67], v[208:211], v[116:119]
  v_mfma_f32_16x16x32_bf16 v[120:123], a[68:71], v[208:211], v[120:123]
  v_mfma_f32_16x16x32_bf16 v[124:127], a[60:63], v[212:215], v[124:127]
  ds_read_b128 v[180:183], v18 offset:10240
  v_mfma_f32_16x16x32_bf16 v[128:131], a[64:67], v[212:215], v[128:131]
  buffer_load_dwordx4 v11, s[8:11], s30 offen offset:1024 lds
  v_mfma_f32_16x16x32_bf16 v[132:135], a[68:71], v[212:215], v[132:135]
  v_mfma_f32_16x16x32_bf16 v[136:139], a[60:63], v[216:219], v[136:139]
  ds_read_b128 v[184:187], v18 offset:12288
  v_mfma_f32_16x16x32_bf16 v[140:143], a[64:67], v[216:219], v[140:143]
  ds_read_b128 v[244:247], v23 offset:320
  v_mfma_f32_16x16x32_bf16 v[144:147], a[68:71], v[216:219], v[144:147]
  v_mfma_f32_16x16x32_bf16 v[148:151], a[60:63], v[220:223], v[148:151]
  ds_read_b128 v[188:191], v18 offset:14336
  v_mfma_f32_16x16x32_bf16 v[152:155], a[64:67], v[220:223], v[152:155]
  buffer_store_dwordx4 v[236:239], v26, s[16:19], s21 offen offset:3072 sc1
  v_mfma_f32_16x16x32_bf16 v[156:159], a[68:71], v[220:223], v[156:159]
  s_waitcnt lgkmcnt(5)
  v_mfma_f32_16x16x32_bf16 v[64:67], a[72:75], v[160:163], v[64:67]
  ds_read_b128 v[192:195], v19 offset:0
  v_mfma_f32_16x16x32_bf16 v[68:71], a[76:79], v[160:163], v[68:71]
  v_add_u32 v18, s33, v14
  v_mfma_f32_16x16x32_bf16 v[72:75], a[80:83], v[160:163], v[72:75]
  v_mfma_f32_16x16x32_bf16 v[76:79], a[72:75], v[164:167], v[76:79]
  ds_read_b128 v[196:199], v19 offset:2048
  v_mfma_f32_16x16x32_bf16 v[80:83], a[76:79], v[164:167], v[80:83]
  buffer_load_dwordx4 v12, s[8:11], s30 offen offset:2048 lds
  v_mfma_f32_16x16x32_bf16 v[84:87], a[80:83], v[164:167], v[84:87]
  v_mfma_f32_16x16x32_bf16 v[88:91], a[72:75], v[168:171], v[88:91]
  ds_read_b128 v[200:203], v19 offset:4096
  v_mfma_f32_16x16x32_bf16 v[92:95], a[76:79], v[168:171], v[92:95]
  s_add_u32 s21, s48, 4096
  ds_read_b128 v[224:227], v23 offset:6400
  v_mfma_f32_16x16x32_bf16 v[96:99], a[80:83], v[168:171], v[96:99]
  v_mfma_f32_16x16x32_bf16 v[100:103], a[72:75], v[172:175], v[100:103]
  ds_read_b128 v[204:207], v19 offset:6144
  v_mfma_f32_16x16x32_bf16 v[104:107], a[76:79], v[172:175], v[104:107]
  buffer_store_dwordx4 v[240:243], v26, s[16:19], s21 offen offset:0 sc1
  v_mfma_f32_16x16x32_bf16 v[108:111], a[80:83], v[172:175], v[108:111]
  s_waitcnt lgkmcnt(5)
  v_mfma_f32_16x16x32_bf16 v[112:115], a[72:75], v[176:179], v[112:115]
  ds_read_b128 v[208:211], v19 offset:8192
  v_mfma_f32_16x16x32_bf16 v[116:119], a[76:79], v[176:179], v[116:119]
  v_mfma_f32_16x16x32_bf16 v[120:123], a[80:83], v[176:179], v[120:123]
  v_mfma_f32_16x16x32_bf16 v[124:127], a[72:75], v[180:183], v[124:127]
  ds_read_b128 v[212:215], v19 offset:10240
  v_mfma_f32_16x16x32_bf16 v[128:131], a[76:79], v[180:183], v[128:131]
  buffer_load_dwordx4 v13, s[8:11], s30 offen offset:3072 lds
  v_mfma_f32_16x16x32_bf16 v[132:135], a[80:83], v[180:183], v[132:135]
  s_add_u32 s30, s30, 128
  s_add_u32 m0, m0, 16384
  v_mfma_f32_16x16x32_bf16 v[136:139], a[72:75], v[184:187], v[136:139]
  ds_read_b128 v[216:219], v19 offset:12288
  v_mfma_f32_16x16x32_bf16 v[140:143], a[76:79], v[184:187], v[140:143]
  s_cmp_lt_u32 m0, s46
  s_cselect_b32 m0, m0, s47
  v_mfma_f32_16x16x32_bf16 v[144:147], a[80:83], v[184:187], v[144:147]
  ds_read_b128 v[228:231], v23 offset:6464
  v_mfma_f32_16x16x32_bf16 v[148:151], a[72:75], v[188:191], v[148:151]
  ds_read_b128 v[220:223], v19 offset:14336
  v_mfma_f32_16x16x32_bf16 v[152:155], a[76:79], v[188:191], v[152:155]
  buffer_store_dwordx4 v[244:247], v26, s[16:19], s21 offen offset:1024 sc1
  v_mfma_f32_16x16x32_bf16 v[156:159], a[80:83], v[188:191], v[156:159]
  s_waitcnt vmcnt(18) lgkmcnt(5)
  s_barrier
  v_mfma_f32_16x16x32_bf16 v[64:67], a[84:87], v[192:195], v[64:67]
  ds_read_b128 v[160:163], v18 offset:0
  v_mfma_f32_16x16x32_bf16 v[68:71], a[88:91], v[192:195], v[68:71]
  v_mfma_f32_16x16x32_bf16 v[72:75], a[92:95], v[192:195], v[72:75]
  v_add_u32 v19, s33, v15
  s_add_u32 s33, s33, 16384
  v_mfma_f32_16x16x32_bf16 v[76:79], a[84:87], v[196:199], v[76:79]
  ds_read_b128 v[164:167], v18 offset:2048
  v_mfma_f32_16x16x32_bf16 v[80:83], a[88:91], v[196:199], v[80:83]
  buffer_load_dwordx4 v10, s[8:11], s30 offen offset:0 lds
  v_mfma_f32_16x16x32_bf16 v[84:87], a[92:95], v[196:199], v[84:87]
  s_cmp_lt_u32 s33, 98304
  s_cselect_b32 s33, s33, 0
  v_mfma_f32_16x16x32_bf16 v[88:91], a[84:87], v[200:203], v[88:91]
  ds_read_b128 v[168:171], v18 offset:4096
  v_mfma_f32_16x16x32_bf16 v[92:95], a[88:91], v[200:203], v[92:95]
  ds_read_b128 v[232:235], v23 offset:6528
  v_mfma_f32_16x16x32_bf16 v[96:99], a[92:95], v[200:203], v[96:99]
  v_mfma_f32_16x16x32_bf16 v[100:103], a[84:87], v[204:207], v[100:103]
  ds_read_b128 v[172:175], v18 offset:6144
  v_mfma_f32_16x16x32_bf16 v[104:107], a[88:91], v[204:207], v[104:107]
  buffer_store_dwordx4 v[224:227], v26, s[16:19], s21 offen offset:2048 sc1
  v_mfma_f32_16x16x32_bf16 v[108:111], a[92:95], v[204:207], v[108:111]
  s_waitcnt lgkmcnt(5)
  v_mfma_f32_16x16x32_bf16 v[112:115], a[84:87], v[208:211], v[112:115]
  ds_read_b128 v[176:179], v18 offset:8192
  v_mfma_f32_16x16x32_bf16 v[116:119], a[88:91], v[208:211], v[116:119]
  v_mfma_f32_16x16x32_bf16 v[120:123], a[92:95], v[208:211], v[120:123]
  v_mfma_f32_16x16x32_bf16 v[124:127], a[84:87], v[212:215], v[124:127]
  ds_read_b128 v[180:183], v18 offset:10240
  v_mfma_f32_16x16x32_bf16 v[128:131], a[88:91], v[212:215], v[128:131]
  buffer_load_dwordx4 v11, s[8:11], s30 offen offset:1024 lds
  v_mfma_f32_16x16x32_bf16 v[132:135], a[92:95], v[212:215], v[132:135]
  v_mfma_f32_16x16x32_bf16 v[136:139], a[84:87], v[216:219], v[136:139]
  ds_read_b128 v[184:187], v18 offset:12288
  v_mfma_f32_16x16x32_bf16 v[140:143], a[88:91], v[216:219], v[140:143]
  ds_read_b128 v[236:239], v23 offset:6592
  v_mfma_f32_16x16x32_bf16 v[144:147], a[92:95], v[216:219], v[144:147]
  v_mfma_f32_16x16x32_bf16 v[148:151], a[84:87], v[220:223], v[148:151]
  ds_read_b128 v[188:191], v18 offset:14336
  v_mfma_f32_16x16x32_bf16 v[152:155], a[88:91], v[220:223], v[152:155]
  buffer_store_dwordx4 v[228:231], v26, s[16:19], s21 offen offset:3072 sc1
  v_mfma_f32_16x16x32_bf16 v[156:159], a[92:95], v[220:223], v[156:159]
  s_waitcnt lgkmcnt(5)
  v_mfma_f32_16x16x32_bf16 v[64:67], a[96:99], v[160:163], v[64:67]
  ds_read_b128 v[192:195], v19 offset:0
  v_mfma_f32_16x16x32_bf16 v[68:71], a[100:103], v[160:163], v[68:71]
  v_add_u32 v18, s33, v14
  v_mfma_f32_16x16x32_bf16 v[72:75], a[104:107], v[160:163], v[72:75]
  v_mfma_f32_16x16x32_bf16 v[76:79], a[96:99], v[164:167], v[76:79]
  ds_read_b128 v[196:199], v19 offset:2048
  v_mfma_f32_16x16x32_bf16 v[80:83], a[100:103], v[164:167], v[80:83]
  buffer_load_dwordx4 v12, s[8:11], s30 offen offset:2048 lds
  v_mfma_f32_16x16x32_bf16 v[84:87], a[104:107], v[164:167], v[84:87]
  v_mfma_f32_16x16x32_bf16 v[88:91], a[96:99], v[168:171], v[88:91]
  ds_read_b128 v[200:203], v19 offset:4096
  v_mfma_f32_16x16x32_bf16 v[92:95], a[100:103], v[168:171], v[92:95]
  s_add_u32 s21, s48, 8192
  ds_read_b128 v[240:243], v23 offset:6656
  v_mfma_f32_16x16x32_bf16 v[96:99], a[104:107], v[168:171], v[96:99]
  v_mfma_f32_16x16x32_bf16 v[100:103], a[96:99], v[172:175], v[100:103]
  ds_read_b128 v[204:207], v19 offset:6144
  v_mfma_f32_16x16x32_bf16 v[104:107], a[100:103], v[172:175], v[104:107]
  buffer_store_dwordx4 v[232:235], v26, s[16:19], s21 offen offset:0 sc1
  v_mfma_f32_16x16x32_bf16 v[108:111], a[104:107], v[172:175], v[108:111]
  s_waitcnt lgkmcnt(5)
  v_mfma_f32_16x16x32_bf16 v[112:115], a[96:99], v[176:179], v[112:115]
  ds_read_b128 v[208:211], v19 offset:8192
  v_mfma_f32_16x16x32_bf16 v[116:119], a[100:103], v[176:179], v[116:119]
  v_mfma_f32_16x16x32_bf16 v[120:123], a[104:107], v[176:179], v[120:123]
  v_mfma_f32_16x16x32_bf16 v[124:127], a[96:99], v[180:183], v[124:127]
  ds_read_b128 v[212:215], v19 offset:10240
  v_mfma_f32_16x16x32_bf16 v[128:131], a[100:103], v[180:183], v[128:131]
  buffer_load_dwordx4 v13, s[8:11], s30 offen offset:3072 lds
  v_mfma_f32_16x16x32_bf16 v[132:135], a[104:107], v[180:183], v[132:135]
  s_add_u32 s30, s30, 128
  s_add_u32 m0, m0, 16384
  v_mfma_f32_16x16x32_bf16 v[136:139], a[96:99], v[184:187], v[136:139]
  ds_read_b128 v[216:219], v19 offset:12288
  v_mfma_f32_16x16x32_bf16 v[140:143], a[100:103], v[184:187], v[140:143]
  s_cmp_lt_u32 m0, s46
  s_cselect_b32 m0, m0, s47
  v_mfma_f32_16x16x32_bf16 v[144:147], a[104:107], v[184:187], v[144:147]
  ds_read_b128 v[244:247], v23 offset:6720
  v_mfma_f32_16x16x32_bf16 v[148:151], a[96:99], v[188:191], v[148:151]
  ds_read_b128 v[220:223], v19 offset:14336
  v_mfma_f32_16x16x32_bf16 v[152:155], a[100:103], v[188:191], v[152:155]
  buffer_store_dwordx4 v[236:239], v26, s[16:19], s21 offen offset:1024 sc1
  v_mfma_f32_16x16x32_bf16 v[156:159], a[104:107], v[188:191], v[156:159]
  s_waitcnt vmcnt(22) lgkmcnt(5)
  s_barrier
  v_mfma_f32_16x16x32_bf16 v[64:67], a[108:111], v[192:195], v[64:67]
  ds_read_b128 v[160:163], v18 offset:0
  v_mfma_f32_16x16x32_bf16 v[68:71], a[112:115], v[192:195], v[68:71]
  v_mfma_f32_16x16x32_bf16 v[72:75], a[116:119], v[192:195], v[72:75]
  v_add_u32 v19, s33, v15
  s_add_u32 s33, s33, 16384
  v_mfma_f32_16x16x32_bf16 v[76:79], a[108:111], v[196:199], v[76:79]
  ds_read_b128 v[164:167], v18 offset:2048
  v_mfma_f32_16x16x32_bf16 v[80:83], a[112:115], v[196:199], v[80:83]
  buffer_load_dwordx4 v10, s[8:11], s30 offen offset:0 lds
  v_mfma_f32_16x16x32_bf16 v[84:87], a[116:119], v[196:199], v[84:87]
  s_cmp_lt_u32 s33, 98304
  s_cselect_b32 s33, s33, 0
  v_mfma_f32_16x16x32_bf16 v[88:91], a[108:111], v[200:203], v[88:91]
  ds_read_b128 v[168:171], v18 offset:4096
  v_mfma_f32_16x16x32_bf16 v[92:95], a[112:115], v[200:203], v[92:95]
  v_mfma_f32_16x16x32_bf16 v[96:99], a[116:119], v[200:203], v[96:99]
  v_mfma_f32_16x16x32_bf16 v[100:103], a[108:111], v[204:207], v[100:103]
  ds_read_b128 v[172:175], v18 offset:6144
  v_mfma_f32_16x16x32_bf16 v[104:107], a[112:115], v[204:207], v[104:107]
  buffer_store_dwordx4 v[240:243], v26, s[16:19], s21 offen offset:2048 sc1
  v_mfma_f32_16x16x32_bf16 v[108:111], a[116:119], v[204:207], v[108:111]
  s_waitcnt lgkmcnt(4)
  v_mfma_f32_16x16x32_bf16 v[112:115], a[108:111], v[208:211], v[112:115]
  ds_read_b128 v[176:179], v18 offset:8192
  v_mfma_f32_16x16x32_bf16 v[116:119], a[112:115], v[208:211], v[116:119]
  v_mfma_f32_16x16x32_bf16 v[120:123], a[116:119], v[208:211], v[120:123]
  v_mfma_f32_16x16x32_bf16 v[124:127], a[108:111], v[212:215], v[124:127]
  ds_read_b128 v[180:183], v18 offset:10240
  v_mfma_f32_16x16x32_bf16 v[128:131], a[112:115], v[212:215], v[128:131]
  buffer_load_dwordx4 v11, s[8:11], s30 offen offset:1024 lds
  v_mfma_f32_16x16x32_bf16 v[132:135], a[116:119], v[212:215], v[132:135]
  v_mfma_f32_16x16x32_bf16 v[136:139], a[108:111], v[216:219], v[136:139]
  ds_read_b128 v[184:187], v18 offset:12288
  v_mfma_f32_16x16x32_bf16 v[140:143], a[112:115], v[216:219], v[140:143]
  v_mfma_f32_16x16x32_bf16 v[144:147], a[116:119], v[216:219], v[144:147]
  v_mfma_f32_16x16x32_bf16 v[148:151], a[108:111], v[220:223], v[148:151]
  ds_read_b128 v[188:191], v18 offset:14336
  v_mfma_f32_16x16x32_bf16 v[152:155], a[112:115], v[220:223], v[152:155]
  buffer_store_dwordx4 v[244:247], v26, s[16:19], s21 offen offset:3072 sc1
  v_mfma_f32_16x16x32_bf16 v[156:159], a[116:119], v[220:223], v[156:159]
  s_waitcnt lgkmcnt(4)
  v_mfma_f32_16x16x32_bf16 v[64:67], a[120:123], v[160:163], v[64:67]
  ds_read_b128 v[192:195], v19 offset:0
  v_mfma_f32_16x16x32_bf16 v[68:71], a[124:127], v[160:163], v[68:71]
  v_add_u32 v18, s33, v14
  v_mfma_f32_16x16x32_bf16 v[72:75], a[128:131], v[160:163], v[72:75]
  v_mfma_f32_16x16x32_bf16 v[76:79], a[120:123], v[164:167], v[76:79]
  ds_read_b128 v[196:199], v19 offset:2048
  v_mfma_f32_16x16x32_bf16 v[80:83], a[124:127], v[164:167], v[80:83]
  buffer_load_dwordx4 v12, s[8:11], s30 offen offset:2048 lds
  v_mfma_f32_16x16x32_bf16 v[84:87], a[128:131], v[164:167], v[84:87]
  v_mfma_f32_16x16x32_bf16 v[88:91], a[120:123], v[168:171], v[88:91]
  ds_read_b128 v[200:203], v19 offset:4096
  v_mfma_f32_16x16x32_bf16 v[92:95], a[124:127], v[168:171], v[92:95]
  v_mfma_f32_16x16x32_bf16 v[96:99], a[128:131], v[168:171], v[96:99]
  v_mfma_f32_16x16x32_bf16 v[100:103], a[120:123], v[172:175], v[100:103]
  ds_read_b128 v[204:207], v19 offset:6144
  v_mfma_f32_16x16x32_bf16 v[104:107], a[124:127], v[172:175], v[104:107]
  v_mfma_f32_16x16x32_bf16 v[108:111], a[128:131], v[172:175], v[108:111]
  s_waitcnt lgkmcnt(4)
  v_mfma_f32_16x16x32_bf16 v[112:115], a[120:123], v[176:179], v[112:115]
  ds_read_b128 v[208:211], v19 offset:8192
  v_mfma_f32_16x16x32_bf16 v[116:119], a[124:127], v[176:179], v[116:119]
  v_mfma_f32_16x16x32_bf16 v[120:123], a[128:131], v[176:179], v[120:123]
  v_mfma_f32_16x16x32_bf16 v[124:127], a[120:123], v[180:183], v[124:127]
  ds_read_b128 v[212:215], v19 offset:10240
  v_mfma_f32_16x16x32_bf16 v[128:131], a[124:127], v[180:183], v[128:131]
  buffer_load_dwordx4 v13, s[8:11], s30 offen offset:3072 lds
  v_mfma_f32_16x16x32_bf16 v[132:135], a[128:131], v[180:183], v[132:135]
  s_add_u32 s30, s30, s25
  s_sub_u32 s30, s30, 1152
  v_mfma_f32_16x16x32_bf16 v[136:139], a[120:123], v[184:187], v[136:139]
  ds_read_b128 v[216:219], v19 offset:12288
  s_add_u32 m0, m0, 16384
  v_mfma_f32_16x16x32_bf16 v[140:143], a[124:127], v[184:187], v[140:143]
  s_cmp_lt_u32 m0, s46
  s_cselect_b32 m0, m0, s47
  v_mfma_f32_16x16x32_bf16 v[144:147], a[128:131], v[184:187], v[144:147]
  v_mfma_f32_16x16x32_bf16 v[148:151], a[120:123], v[188:191], v[148:151]
  ds_read_b128 v[220:223], v19 offset:14336
  v_mfma_f32_16x16x32_bf16 v[152:155], a[124:127], v[188:191], v[152:155]
  v_mfma_f32_16x16x32_bf16 v[156:159], a[128:131], v[188:191], v[156:159]
  s_waitcnt vmcnt(23) lgkmcnt(4)
  s_barrier
  v_mfma_f32_16x16x32_bf16 v[64:67], a[132:135], v[192:195], v[64:67]
  ds_read_b128 v[160:163], v18 offset:0
  v_mfma_f32_16x16x32_bf16 v[68:71], a[136:139], v[192:195], v[68:71]
  v_mfma_f32_16x16x32_bf16 v[72:75], a[140:143], v[192:195], v[72:75]
  v_add_u32 v19, s33, v15
  s_add_u32 s33, s33, 16384
  v_mfma_f32_16x16x32_bf16 v[76:79], a[132:135], v[196:199], v[76:79]
  ds_read_b128 v[164:167], v18 offset:2048
  v_mfma_f32_16x16x32_bf16 v[80:83], a[136:139], v[196:199], v[80:83]
  buffer_load_dwordx4 v10, s[8:11], s30 offen offset:0 lds
  v_mfma_f32_16x16x32_bf16 v[84:87], a[140:143], v[196:199], v[84:87]
  s_cmp_lt_u32 s33, 98304
  s_cselect_b32 s33, s33, 0
  v_mfma_f32_16x16x32_bf16 v[88:91], a[132:135], v[200:203], v[88:91]
  ds_read_b128 v[168:171], v18 offset:4096
  v_mfma_f32_16x16x32_bf16 v[92:95], a[136:139], v[200:203], v[92:95]
  v_mfma_f32_16x16x32_bf16 v[96:99], a[140:143], v[200:203], v[96:99]
  v_mfma_f32_16x16x32_bf16 v[100:103], a[132:135], v[204:207], v[100:103]
  ds_read_b128 v[172:175], v18 offset:6144
  v_mfma_f32_16x16x32_bf16 v[104:107], a[136:139], v[204:207], v[104:107]
  v_mfma_f32_16x16x32_bf16 v[108:111], a[140:143], v[204:207], v[108:111]
  s_waitcnt lgkmcnt(4)
  v_mfma_f32_16x16x32_bf16 v[112:115], a[132:135], v[208:211], v[112:115]
  ds_read_b128 v[176:179], v18 offset:8192
  v_mfma_f32_16x16x32_bf16 v[116:119], a[136:139], v[208:211], v[116:119]
  v_mfma_f32_16x16x32_bf16 v[120:123], a[140:143], v[208:211], v[120:123]
  v_mfma_f32_16x16x32_bf16 v[124:127], a[132:135], v[212:215], v[124:127]
  ds_read_b128 v[180:183], v18 offset:10240
  v_mfma_f32_16x16x32_bf16 v[128:131], a[136:139], v[212:215], v[128:131]
  buffer_load_dwordx4 v11, s[8:11], s30 offen offset:1024 lds
  v_mfma_f32_16x16x32_bf16 v[132:135], a[140:143], v[212:215], v[132:135]
  v_mfma_f32_16x16x32_bf16 v[136:139], a[132:135], v[216:219], v[136:139]
  ds_read_b128 v[184:187], v18 offset:12288
  v_mfma_f32_16x16x32_bf16 v[140:143], a[136:139], v[216:219], v[140:143]
  v_mfma_f32_16x16x32_bf16 v[144:147], a[140:143], v[216:219], v[144:147]
  v_mfma_f32_16x16x32_bf16 v[148:151], a[132:135], v[220:223], v[148:151]
  ds_read_b128 v[188:191], v18 offset:14336
  v_mfma_f32_16x16x32_bf16 v[152:155], a[136:139], v[220:223], v[152:155]
  v_mfma_f32_16x16x32_bf16 v[156:159], a[140:143], v[220:223], v[156:159]
  s_waitcnt lgkmcnt(4)
  v_mfma_f32_16x16x32_bf16 v[64:67], a[144:147], v[160:163], v[64:67]
  ds_read_b128 v[192:195], v19 offset:0
  v_mfma_f32_16x16x32_bf16 v[68:71], a[148:151], v[160:163], v[68:71]
  v_add_u32 v18, s33, v14
  v_mfma_f32_16x16x32_bf16 v[72:75], a[152:155], v[160:163], v[72:75]
  v_mfma_f32_16x16x32_bf16 v[76:79], a[144:147], v[164:167], v[76:79]
  ds_read_b128 v[196:199], v19 offset:2048
  v_mfma_f32_16x16x32_bf16 v[80:83], a[148:151], v[164:167], v[80:83]
  buffer_load_dwordx4 v12, s[8:11], s30 offen offset:2048 lds
  v_mfma_f32_16x16x32_bf16 v[84:87], a[152:155], v[164:167], v[84:87]
  v_mfma_f32_16x16x32_bf16 v[88:91], a[144:147], v[168:171], v[88:91]
  ds_read_b128 v[200:203], v19 offset:4096
  v_mfma_f32_16x16x32_bf16 v[92:95], a[148:151], v[168:171], v[92:95]
  v_mfma_f32_16x16x32_bf16 v[96:99], a[152:155], v[168:171], v[96:99]
  v_mfma_f32_16x16x32_bf16 v[100:103], a[144:147], v[172:175], v[100:103]
  ds_read_b128 v[204:207], v19 offset:6144
  v_mfma_f32_16x16x32_bf16 v[104:107], a[148:151], v[172:175], v[104:107]
  v_mfma_f32_16x16x32_bf16 v[108:111], a[152:155], v[172:175], v[108:111]
  s_waitcnt lgkmcnt(4)
  v_mfma_f32_16x16x32_bf16 v[112:115], a[144:147], v[176:179], v[112:115]
  ds_read_b128 v[208:211], v19 offset:8192
  v_mfma_f32_16x16x32_bf16 v[116:119], a[148:151], v[176:179], v[116:119]
  v_mfma_f32_16x16x32_bf16 v[120:123], a[152:155], v[176:179], v[120:123]
  v_mfma_f32_16x16x32_bf16 v[124:127], a[144:147], v[180:183], v[124:127]
  ds_read_b128 v[212:215], v19 offset:10240
  v_mfma_f32_16x16x32_bf16 v[128:131], a[148:151], v[180:183], v[128:131]
  buffer_load_dwordx4 v13, s[8:11], s30 offen offset:3072 lds
  v_mfma_f32_16x16x32_bf16 v[132:135], a[152:155], v[180:183], v[132:135]
  s_add_u32 s30, s30, 128
  s_add_u32 m0, m0, 16384
  v_mfma_f32_16x16x32_bf16 v[136:139], a[144:147], v[184:187], v[136:139]
  ds_read_b128 v[216:219], v19 offset:12288
  v_mfma_f32_16x16x32_bf16 v[140:143], a[148:151], v[184:187], v[140:143]
  s_cmp_lt_u32 m0, s46
  s_cselect_b32 m0, m0, s47
  v_mfma_f32_16x16x32_bf16 v[144:147], a[152:155], v[184:187], v[144:147]
  v_mfma_f32_16x16x32_bf16 v[148:151], a[144:147], v[188:191], v[148:151]
  ds_read_b128 v[220:223], v19 offset:14336
  v_mfma_f32_16x16x32_bf16 v[152:155], a[148:151], v[188:191], v[152:155]
  v_mfma_f32_16x16x32_bf16 v[156:159], a[152:155], v[188:191], v[156:159]
  s_waitcnt vmcnt(6) lgkmcnt(4)
  s_barrier
  v_mfma_f32_16x16x32_bf16 v[64:67], a[156:159], v[192:195], v[64:67]
  ds_read_b128 v[160:163], v18 offset:0
  v_mfma_f32_16x16x32_bf16 v[68:71], a[160:163], v[192:195], v[68:71]
  s_cmp_eq_u32 s48, 0x80000000
  s_cbranch_scc1 kv_142
  s_cmp_lg_u32 s20, 0
  s_cbranch_scc1 af_143
  v_mov_b32 v4, 0
  v_mov_b32 v5, 1
  s_mov_b64 exec, 1
  buffer_atomic_add v5, v4, s[72:75], s61 offen sc1
  s_mov_b64 exec, -1
  s_nop 1
af_143:
kv_142:
  v_mfma_f32_16x16x32_bf16 v[72:75], a[164:167], v[192:195], v[72:75]
  v_add_u32 v19, s33, v15
  s_add_u32 s33, s33, 16384
  v_mfma_f32_16x16x32_bf16 v[76:79], a[156:159], v[196:199], v[76:79]
  ds_read_b128 v[164:167], v18 offset:2048
  v_mfma_f32_16x16x32_bf16 v[80:83], a[160:163], v[196:199], v[80:83]
  buffer_load_dwordx4 v10, s[8:11], s30 offen offset:0 lds
  v_mfma_f32_16x16x32_bf16 v[84:87], a[164:167], v[196:199], v[84:87]
  s_cmp_lt_u32 s33, 98304
  s_cselect_b32 s33, s33, 0
  v_mfma_f32_16x16x32_bf16 v[88:91], a[156:159], v[200:203], v[88:91]
  ds_read_b128 v[168:171], v18 offset:4096
  v_mfma_f32_16x16x32_bf16 v[92:95], a[160:163], v[200:203], v[92:95]
  v_mfma_f32_16x16x32_bf16 v[96:99], a[164:167], v[200:203], v[96:99]
  v_mfma_f32_16x16x32_bf16 v[100:103], a[156:159], v[204:207], v[100:103]
  ds_read_b128 v[172:175], v18 offset:6144
  v_mfma_f32_16x16x32_bf16 v[104:107], a[160:163], v[204:207], v[104:107]
  v_mfma_f32_16x16x32_bf16 v[108:111], a[164:167], v[204:207], v[108:111]
  s_waitcnt lgkmcnt(4)
  v_mfma_f32_16x16x32_bf16 v[112:115], a[156:159], v[208:211], v[112:115]
  ds_read_b128 v[176:179], v18 offset:8192
  v_mfma_f32_16x16x32_bf16 v[116:119], a[160:163], v[208:211], v[116:119]
  v_mfma_f32_16x16x32_bf16 v[120:123], a[164:167], v[208:211], v[120:123]
  v_mfma_f32_16x16x32_bf16 v[124:127], a[156:159], v[212:215], v[124:127]
  ds_read_b128 v[180:183], v18 offset:10240
  v_mfma_f32_16x16x32_bf16 v[128:131], a[160:163], v[212:215], v[128:131]
  buffer_load_dwordx4 v11, s[8:11], s30 offen offset:1024 lds
  v_mfma_f32_16x16x32_bf16 v[132:135], a[164:167], v[212:215], v[132:135]
  v_mfma_f32_16x16x32_bf16 v[136:139], a[156:159], v[216:219], v[136:139]
  ds_read_b128 v[184:187], v18 offset:12288
  v_mfma_f32_16x16x32_bf16 v[140:143], a[160:163], v[216:219], v[140:143]
  v_mfma_f32_16x16x32_bf16 v[144:147], a[164:167], v[216:219], v[144:147]
  v_mfma_f32_16x16x32_bf16 v[148:151], a[156:159], v[220:223], v[148:151]
  ds_read_b128 v[188:191], v18 offset:14336
  v_mfma_f32_16x16x32_bf16 v[152:155], a[160:163], v[220:223], v[152:155]
  v_mfma_f32_16x16x32_bf16 v[156:159], a[164:167], v[220:223], v[156:159]
  s_waitcnt lgkmcnt(4)
  v_mfma_f32_16x16x32_bf16 v[64:67], a[168:171], v[160:163], v[64:67]
  ds_read_b128 v[192:195], v19 offset:0
  v_mfma_f32_16x16x32_bf16 v[68:71], a[172:175], v[160:163], v[68:71]
  v_add_u32 v18, s33, v14
  s_mov_b32 s61, s60
  v_mfma_f32_16x16x32_bf16 v[72:75], a[176:179], v[160:163], v[72:75]
  s_add_u32 s60, s60, s62
  s_mul_i32 s48, s20, 393216
  v_mfma_f32_16x16x32_bf16 v[76:79], a[168:171], v[164:167], v[76:79]
  ds_read_b128 v[196:199], v19 offset:2048
  s_add_u32 s48, s48, s27
  v_mfma_f32_16x16x32_bf16 v[80:83], a[172:175], v[164:167], v[80:83]
  buffer_load_dwordx4 v12, s[8:11], s30 offen offset:2048 lds
  v_mfma_f32_16x16x32_bf16 v[84:87], a[176:179], v[164:167], v[84:87]
  s_add_u32 s27, s27, s28
  s_sub_u32 s26, s26, 1
  v_mfma_f32_16x16x32_bf16 v[88:91], a[168:171], v[168:171], v[88:91]
  ds_read_b128 v[200:203], v19 offset:4096
  v_mfma_f32_16x16x32_bf16 v[92:95], a[172:175], v[168:171], v[92:95]
  v_mfma_f32_16x16x32_bf16 v[96:99], a[176:179], v[168:171], v[96:99]
  v_mfma_f32_16x16x32_bf16 v[100:103], a[168:171], v[172:175], v[100:103]
  ds_read_b128 v[204:207], v19 offset:6144
  v_mfma_f32_16x16x32_bf16 v[104:107], a[172:175], v[172:175], v[104:107]
  v_mfma_f32_16x16x32_bf16 v[108:111], a[176:179], v[172:175], v[108:111]
  s_waitcnt lgkmcnt(4)
  v_mfma_f32_16x16x32_bf16 v[112:115], a[168:171], v[176:179], v[112:115]
  ds_read_b128 v[208:211], v19 offset:8192
  v_mfma_f32_16x16x32_bf16 v[116:119], a[172:175], v[176:179], v[116:119]
  v_mfma_f32_16x16x32_bf16 v[120:123], a[176:179], v[176:179], v[120:123]
  v_mfma_f32_16x16x32_bf16 v[124:127], a[168:171], v[180:183], v[124:127]
  ds_read_b128 v[212:215], v19 offset:10240
  v_mfma_f32_16x16x32_bf16 v[128:131], a[172:175], v[180:183], v[128:131]
  buffer_load_dwordx4 v13, s[8:11], s30 offen offset:3072 lds
  v_mfma_f32_16x16x32_bf16 v[132:135], a[176:179], v[180:183], v[132:135]
  s_add_u32 s30, s30, 128
  s_add_u32 m0, m0, 16384
  v_mfma_f32_16x16x32_bf16 v[136:139], a[168:171], v[184:187], v[136:139]
  ds_read_b128 v[216:219], v19 offset:12288
  v_mfma_f32_16x16x32_bf16 v[140:143], a[172:175], v[184:187], v[140:143]
  s_cmp_lt_u32 m0, s46
  s_cselect_b32 m0, m0, s47
  v_mfma_f32_16x16x32_bf16 v[144:147], a[176:179], v[184:187], v[144:147]
  v_mfma_f32_16x16x32_bf16 v[148:151], a[168:171], v[188:191], v[148:151]
  ds_read_b128 v[220:223], v19 offset:14336
  v_mfma_f32_16x16x32_bf16 v[152:155], a[172:175], v[188:191], v[152:155]
  v_mfma_f32_16x16x32_bf16 v[156:159], a[176:179], v[188:191], v[156:159]
  s_waitcnt vmcnt(15) lgkmcnt(4)
  s_barrier
  v_mfma_f32_16x16x32_bf16 v[64:67], a[180:183], v[192:195], v[64:67]
  ds_read_b128 v[160:163], v18 offset:0
  v_mfma_f32_16x16x32_bf16 v[68:71], a[184:187], v[192:195], v[68:71]
  v_mfma_f32_16x16x32_bf16 v[72:75], a[188:191], v[192:195], v[72:75]
  v_add_u32 v19, s33, v15
  s_add_u32 s33, s33, 16384
  v_mfma_f32_16x16x32_bf16 v[76:79], a[180:183], v[196:199], v[76:79]
  ds_read_b128 v[164:167], v18 offset:2048
  v_mfma_f32_16x16x32_bf16 v[80:83], a[184:187], v[196:199], v[80:83]
  buffer_load_dwordx4 v10, s[8:11], s30 offen offset:0 lds
  v_mfma_f32_16x16x32_bf16 v[84:87], a[188:191], v[196:199], v[84:87]
  s_cmp_lt_u32 s33, 98304
  s_cselect_b32 s33, s33, 0
  v_mfma_f32_16x16x32_bf16 v[88:91], a[180:183], v[200:203], v[88:91]
  ds_read_b128 v[168:171], v18 offset:4096
  v_mfma_f32_16x16x32_bf16 v[92:95], a[184:187], v[200:203], v[92:95]
  v_mfma_f32_16x16x32_bf16 v[96:99], a[188:191], v[200:203], v[96:99]
  v_mfma_f32_16x16x32_bf16 v[100:103], a[180:183], v[204:207], v[100:103]
  ds_read_b128 v[172:175], v18 offset:6144
  v_mfma_f32_16x16x32_bf16 v[104:107], a[184:187], v[204:207], v[104:107]
  v_mfma_f32_16x16x32_bf16 v[108:111], a[188:191], v[204:207], v[108:111]
  s_waitcnt lgkmcnt(4)
  v_mfma_f32_16x16x32_bf16 v[112:115], a[180:183], v[208:211], v[112:115]
  ds_read_b128 v[176:179], v18 offset:8192
  v_mfma_f32_16x16x32_bf16 v[116:119], a[184:187], v[208:211], v[116:119]
  v_mfma_f32_16x16x32_bf16 v[120:123], a[188:191], v[208:211], v[120:123]
  v_mfma_f32_16x16x32_bf16 v[124:127], a[180:183], v[212:215], v[124:127]
  ds_read_b128 v[180:183], v18 offset:10240
  v_mfma_f32_16x16x32_bf16 v[128:131], a[184:187], v[212:215], v[128:131]
  buffer_load_dwordx4 v11, s[8:11], s30 offen offset:1024 lds
  v_mfma_f32_16x16x32_bf16 v[132:135], a[188:191], v[212:215], v[132:135]
  v_mfma_f32_16x16x32_bf16 v[136:139], a[180:183], v[216:219], v[136:139]
  ds_read_b128 v[184:187], v18 offset:12288
  v_mfma_f32_16x16x32_bf16 v[140:143], a[184:187], v[216:219], v[140:143]
  v_mfma_f32_16x16x32_bf16 v[144:147], a[188:191], v[216:219], v[144:147]
  v_mfma_f32_16x16x32_bf16 v[148:151], a[180:183], v[220:223], v[148:151]
  ds_read_b128 v[188:191], v18 offset:14336
  v_mfma_f32_16x16x32_bf16 v[152:155], a[184:187], v[220:223], v[152:155]
  v_mfma_f32_16x16x32_bf16 v[156:159], a[188:191], v[220:223], v[156:159]
  s_waitcnt lgkmcnt(4)
  v_mfma_f32_16x16x32_bf16 v[64:67], a[192:195], v[160:163], v[64:67]
  ds_read_b128 v[192:195], v19 offset:0
  v_mfma_f32_16x16x32_bf16 v[68:71], a[196:199], v[160:163], v[68:71]
  v_add_u32 v18, s33, v14
  v_mfma_f32_16x16x32_bf16 v[72:75], a[200:203], v[160:163], v[72:75]
  v_mfma_f32_16x16x32_bf16 v[76:79], a[192:195], v[164:167], v[76:79]
  ds_read_b128 v[196:199], v19 offset:2048
  v_mfma_f32_16x16x32_bf16 v[80:83], a[196:199], v[164:167], v[80:83]
  buffer_load_dwordx4 v12, s[8:11], s30 offen offset:2048 lds
  v_mfma_f32_16x16x32_bf16 v[84:87], a[200:203], v[164:167], v[84:87]
  v_mfma_f32_16x16x32_bf16 v[88:91], a[192:195], v[168:171], v[88:91]
  ds_read_b128 v[200:203], v19 offset:4096
  v_mfma_f32_16x16x32_bf16 v[92:95], a[196:199], v[168:171], v[92:95]
  v_mfma_f32_16x16x32_bf16 v[96:99], a[200:203], v[168:171], v[96:99]
  v_mfma_f32_16x16x32_bf16 v[100:103], a[192:195], v[172:175], v[100:103]
  ds_read_b128 v[204:207], v19 offset:6144
  v_mfma_f32_16x16x32_bf16 v[104:107], a[196:199], v[172:175], v[104:107]
  v_mfma_f32_16x16x32_bf16 v[108:111], a[200:203], v[172:175], v[108:111]
  s_waitcnt lgkmcnt(4)
  v_mfma_f32_16x16x32_bf16 v[112:115], a[192:195], v[176:179], v[112:115]
  ds_read_b128 v[208:211], v19 offset:8192
  v_mfma_f32_16x16x32_bf16 v[116:119], a[196:199], v[176:179], v[116:119]
  v_mfma_f32_16x16x32_bf16 v[120:123], a[200:203], v[176:179], v[120:123]
  v_mfma_f32_16x16x32_bf16 v[124:127], a[192:195], v[180:183], v[124:127]
  ds_read_b128 v[212:215], v19 offset:10240
  v_mfma_f32_16x16x32_bf16 v[128:131], a[196:199], v[180:183], v[128:131]
  buffer_load_dwordx4 v13, s[8:11], s30 offen offset:3072 lds
  v_mfma_f32_16x16x32_bf16 v[132:135], a[200:203], v[180:183], v[132:135]
  s_add_u32 s30, s30, 128
  s_add_u32 m0, m0, 16384
  v_mfma_f32_16x16x32_bf16 v[136:139], a[192:195], v[184:187], v[136:139]
  ds_read_b128 v[216:219], v19 offset:12288
  v_mfma_f32_16x16x32_bf16 v[140:143], a[196:199], v[184:187], v[140:143]
  s_cmp_lt_u32 m0, s46
  s_cselect_b32 m0, m0, s47
  v_mfma_f32_16x16x32_bf16 v[144:147], a[200:203], v[184:187], v[144:147]
  v_mfma_f32_16x16x32_bf16 v[148:151], a[192:195], v[188:191], v[148:151]
  ds_read_b128 v[220:223], v19 offset:14336
  v_mfma_f32_16x16x32_bf16 v[152:155], a[196:199], v[188:191], v[152:155]
  v_mfma_f32_16x16x32_bf16 v[156:159], a[200:203], v[188:191], v[156:159]
  s_waitcnt vmcnt(12) lgkmcnt(4)
  s_barrier
  v_mfma_f32_16x16x32_bf16 v[64:67], a[204:207], v[192:195], v[64:67]
  ds_read_b128 v[160:163], v18 offset:0
  v_mfma_f32_16x16x32_bf16 v[68:71], a[208:211], v[192:195], v[68:71]
  v_mfma_f32_16x16x32_bf16 v[72:75], a[212:215], v[192:195], v[72:75]
  v_add_u32 v19, s33, v15
  s_add_u32 s33, s33, 16384
  v_mfma_f32_16x16x32_bf16 v[76:79], a[204:207], v[196:199], v[76:79]
  ds_read_b128 v[164:167], v18 offset:2048
  v_mfma_f32_16x16x32_bf16 v[80:83], a[208:211], v[196:199], v[80:83]
  buffer_load_dwordx4 v10, s[8:11], s30 offen offset:0 lds
  v_mfma_f32_16x16x32_bf16 v[84:87], a[212:215], v[196:199], v[84:87]
  s_cmp_lt_u32 s33, 98304
  s_cselect_b32 s33, s33, 0
  v_mfma_f32_16x16x32_bf16 v[88:91], a[204:207], v[200:203], v[88:91]
  ds_read_b128 v[168:171], v18 offset:4096
  v_mfma_f32_16x16x32_bf16 v[92:95], a[208:211], v[200:203], v[92:95]
  v_mfma_f32_16x16x32_bf16 v[96:99], a[212:215], v[200:203], v[96:99]
  v_mfma_f32_16x16x32_bf16 v[100:103], a[204:207], v[204:207], v[100:103]
  ds_read_b128 v[172:175], v18 offset:6144
  v_mfma_f32_16x16x32_bf16 v[104:107], a[208:211], v[204:207], v[104:107]
  v_mfma_f32_16x16x32_bf16 v[108:111], a[212:215], v[204:207], v[108:111]
  s_waitcnt lgkmcnt(4)
  v_mfma_f32_16x16x32_bf16 v[112:115], a[204:207], v[208:211], v[112:115]
  ds_read_b128 v[176:179], v18 offset:8192
  v_mfma_f32_16x16x32_bf16 v[116:119], a[208:211], v[208:211], v[116:119]
  v_mfma_f32_16x16x32_bf16 v[120:123], a[212:215], v[208:211], v[120:123]
  v_mfma_f32_16x16x32_bf16 v[124:127], a[204:207], v[212:215], v[124:127]
  ds_read_b128 v[180:183], v18 offset:10240
  v_mfma_f32_16x16x32_bf16 v[128:131], a[208:211], v[212:215], v[128:131]
  buffer_load_dwordx4 v11, s[8:11], s30 offen offset:1024 lds
  v_mfma_f32_16x16x32_bf16 v[132:135], a[212:215], v[212:215], v[132:135]
  v_mfma_f32_16x16x32_bf16 v[136:139], a[204:207], v[216:219], v[136:139]
  ds_read_b128 v[184:187], v18 offset:12288
  v_mfma_f32_16x16x32_bf16 v[140:143], a[208:211], v[216:219], v[140:143]
  v_mfma_f32_16x16x32_bf16 v[144:147], a[212:215], v[216:219], v[144:147]
  v_mfma_f32_16x16x32_bf16 v[148:151], a[204:207], v[220:223], v[148:151]
  ds_read_b128 v[188:191], v18 offset:14336
  v_mfma_f32_16x16x32_bf16 v[152:155], a[208:211], v[220:223], v[152:155]
  v_mfma_f32_16x16x32_bf16 v[156:159], a[212:215], v[220:223], v[156:159]
  s_waitcnt lgkmcnt(4)
  v_mfma_f32_16x16x32_bf16 v[64:67], a[216:219], v[160:163], v[64:67]
  ds_read_b128 v[192:195], v19 offset:0
  v_mfma_f32_16x16x32_bf16 v[68:71], a[220:223], v[160:163], v[68:71]
  v_add_u32 v18, s33, v14
  v_mfma_f32_16x16x32_bf16 v[72:75], a[224:227], v[160:163], v[72:75]
  v_mfma_f32_16x16x32_bf16 v[76:79], a[216:219], v[164:167], v[76:79]
  ds_read_b128 v[196:199], v19 offset:2048
  v_mfma_f32_16x16x32_bf16 v[80:83], a[220:223], v[164:167], v[80:83]
  buffer_load_dwordx4 v12, s[8:11], s30 offen offset:2048 lds
  v_mfma_f32_16x16x32_bf16 v[84:87], a[224:227], v[164:167], v[84:87]
  v_mfma_f32_16x16x32_bf16 v[88:91], a[216:219], v[168:171], v[88:91]
  ds_read_b128 v[200:203], v19 offset:4096
  v_mfma_f32_16x16x32_bf16 v[92:95], a[220:223], v[168:171], v[92:95]
  v_mfma_f32_16x16x32_bf16 v[96:99], a[224:227], v[168:171], v[96:99]
  v_mfma_f32_16x16x32_bf16 v[100:103], a[216:219], v[172:175], v[100:103]
  ds_read_b128 v[204:207], v19 offset:6144
  v_mfma_f32_16x16x32_bf16 v[104:107], a[220:223], v[172:175], v[104:107]
  v_mfma_f32_16x16x32_bf16 v[108:111], a[224:227], v[172:175], v[108:111]
  s_waitcnt lgkmcnt(4)
  v_mfma_f32_16x16x32_bf16 v[112:115], a[216:219], v[176:179], v[112:115]
  ds_read_b128 v[208:211], v19 offset:8192
  v_mfma_f32_16x16x32_bf16 v[116:119], a[220:223], v[176:179], v[116:119]
  v_mfma_f32_16x16x32_bf16 v[120:123], a[224:227], v[176:179], v[120:123]
  v_mfma_f32_16x16x32_bf16 v[124:127], a[216:219], v[180:183], v[124:127]
  ds_read_b128 v[212:215], v19 offset:10240
  v_mfma_f32_16x16x32_bf16 v[128:131], a[220:223], v[180:183], v[128:131]
  buffer_load_dwordx4 v13, s[8:11], s30 offen offset:3072 lds
  v_mfma_f32_16x16x32_bf16 v[132:135], a[224:227], v[180:183], v[132:135]
  s_add_u32 s30, s30, 128
  s_add_u32 m0, m0, 16384
  v_mfma_f32_16x16x32_bf16 v[136:139], a[216:219], v[184:187], v[136:139]
  ds_read_b128 v[216:219], v19 offset:12288
  v_mfma_f32_16x16x32_bf16 v[140:143], a[220:223], v[184:187], v[140:143]
  s_cmp_lt_u32 m0, s46
  s_cselect_b32 m0, m0, s47
  v_mfma_f32_16x16x32_bf16 v[144:147], a[224:227], v[184:187], v[144:147]
  v_mfma_f32_16x16x32_bf16 v[148:151], a[216:219], v[188:191], v[148:151]
  ds_read_b128 v[220:223], v19 offset:14336
  v_mfma_f32_16x16x32_bf16 v[152:155], a[220:223], v[188:191], v[152:155]
  v_mfma_f32_16x16x32_bf16 v[156:159], a[224:227], v[188:191], v[156:159]
  s_waitcnt vmcnt(12) lgkmcnt(4)
  s_barrier
  v_mfma_f32_16x16x32_bf16 v[64:67], a[228:231], v[192:195], v[64:67]
  ds_read_b128 v[160:163], v18 offset:0
  v_mfma_f32_16x16x32_bf16 v[68:71], a[232:235], v[192:195], v[68:71]
  v_mfma_f32_16x16x32_bf16 v[72:75], a[236:239], v[192:195], v[72:75]
  v_add_u32 v19, s33, v15
  s_add_u32 s33, s33, 16384
  v_mfma_f32_16x16x32_bf16 v[76:79], a[228:231], v[196:199], v[76:79]
  ds_read_b128 v[164:167], v18 offset:2048
  v_cvt_pk_bf16_f32 v224, v64, v65
  v_mfma_f32_16x16x32_bf16 v[80:83], a[232:235], v[196:199], v[80:83]
  buffer_load_dwordx4 v10, s[8:11], s30 offen offset:0 lds
  v_mfma_f32_16x16x32_bf16 v[84:87], a[236:239], v[196:199], v[84:87]
  s_cmp_lt_u32 s33, 98304
  s_cselect_b32 s33, s33, 0
  v_mfma_f32_16x16x32_bf16 v[88:91], a[228:231], v[200:203], v[88:91]
  ds_read_b128 v[168:171], v18 offset:4096
  v_cvt_pk_bf16_f32 v225, v66, v67
  v_mfma_f32_16x16x32_bf16 v[92:95], a[232:235], v[200:203], v[92:95]
  v_cvt_pk_bf16_f32 v226, v68, v69
  v_cvt_pk_bf16_f32 v227, v70, v71
  v_mfma_f32_16x16x32_bf16 v[96:99], a[236:239], v[200:203], v[96:99]
  v_cvt_pk_bf16_f32 v228, v72, v73
  v_cvt_pk_bf16_f32 v229, v74, v75
  v_mfma_f32_16x16x32_bf16 v[100:103], a[228:231], v[204:207], v[100:103]
  ds_read_b128 v[172:175], v18 offset:6144
  ds_write_b64 v22, v[224:225] offset:0
  v_mfma_f32_16x16x32_bf16 v[104:107], a[232:235], v[204:207], v[104:107]
  ds_write_b64 v22, v[226:227] offset:8
  ds_write_b64 v22, v[228:229] offset:16
  v_mfma_f32_16x16x32_bf16 v[108:111], a[236:239], v[204:207], v[108:111]
  s_waitcnt lgkmcnt(7)
  v_cvt_pk_bf16_f32 v230, v76, v77
  v_mfma_f32_16x16x32_bf16 v[112:115], a[228:231], v[208:211], v[112:115]
  ds_read_b128 v[176:179], v18 offset:8192
  v_cvt_pk_bf16_f32 v231, v78, v79
  v_mfma_f32_16x16x32_bf16 v[116:119], a[232:235], v[208:211], v[116:119]
  v_cvt_pk_bf16_f32 v232, v80, v81
  v_cvt_pk_bf16_f32 v233, v82, v83
  v_mfma_f32_16x16x32_bf16 v[120:123], a[236:239], v[208:211], v[120:123]
  v_cvt_pk_bf16_f32 v234, v84, v85
  v_cvt_pk_bf16_f32 v235, v86, v87
  v_mfma_f32_16x16x32_bf16 v[124:127], a[228:231], v[212:215], v[124:127]
  ds_read_b128 v[180:183], v18 offset:10240
  ds_write_b64 v22, v[230:231] offset:6400
  v_mfma_f32_16x16x32_bf16 v[128:131], a[232:235], v[212:215], v[128:131]
  buffer_load_dwordx4 v11, s[8:11], s30 offen offset:1024 lds
  v_mfma_f32_16x16x32_bf16 v[132:135], a[236:239], v[212:215], v[132:135]
  ds_write_b64 v22, v[232:233] offset:6408
  ds_write_b64 v22, v[234:235] offset:6416
  v_mfma_f32_16x16x32_bf16 v[136:139], a[228:231], v[216:219], v[136:139]
  ds_read_b128 v[184:187], v18 offset:12288
  v_cvt_pk_bf16_f32 v236, v88, v89
  v_mfma_f32_16x16x32_bf16 v[140:143], a[232:235], v[216:219], v[140:143]
  v_cvt_pk_bf16_f32 v237, v90, v91
  v_cvt_pk_bf16_f32 v238, v92, v93
  v_mfma_f32_16x16x32_bf16 v[144:147], a[236:239], v[216:219], v[144:147]
  v_cvt_pk_bf16_f32 v239, v94, v95
  v_cvt_pk_bf16_f32 v240, v96, v97
  v_mfma_f32_16x16x32_bf16 v[148:151], a[228:231], v[220:223], v[148:151]
  ds_read_b128 v[188:191], v18 offset:14336
  v_cvt_pk_bf16_f32 v241, v98, v99
  v_mfma_f32_16x16x32_bf16 v[152:155], a[232:235], v[220:223], v[152:155]
  ds_write_b64 v22, v[236:237] offset:12800
  ds_write_b64 v22, v[238:239] offset:12808
  v_mfma_f32_16x16x32_bf16 v[156:159], a[236:239], v[220:223], v[156:159]
  s_waitcnt lgkmcnt(12)
  s_cmp_gt_u32 s26, 0
  s_cbranch_scc1 kv_blk_144
  s_nop 7
  ds_write_b64 v22, v[240:241] offset:12816
  v_cvt_pk_bf16_f32 v242, v100, v101
  v_cvt_pk_bf16_f32 v243, v102, v103
  v_cvt_pk_bf16_f32 v244, v104, v105
  v_cvt_pk_bf16_f32 v245, v106, v107
  v_cvt_pk_bf16_f32 v246, v108, v109
  v_cvt_pk_bf16_f32 v247, v110, v111
  ds_write_b64 v22, v[242:243] offset:19200
  ds_write_b64 v22, v[244:245] offset:19208
  ds_write_b64 v22, v[246:247] offset:19216
  v_cvt_pk_bf16_f32 v224, v112, v113
  v_cvt_pk_bf16_f32 v225, v114, v115
  v_cvt_pk_bf16_f32 v226, v116, v117
  v_cvt_pk_bf16_f32 v227, v118, v119
  v_cvt_pk_bf16_f32 v228, v120, v121
  v_cvt_pk_bf16_f32 v229, v122, v123
  ds_write_b64 v22, v[224:225] offset:25600
  ds_write_b64 v22, v[226:227] offset:25608
  ds_write_b64 v22, v[228:229] offset:25616
  v_cvt_pk_bf16_f32 v230, v124, v125
  v_cvt_pk_bf16_f32 v231, v126, v127
  v_cvt_pk_bf16_f32 v232, v128, v129
  v_cvt_pk_bf16_f32 v233, v130, v131
  v_cvt_pk_bf16_f32 v234, v132, v133
  v_cvt_pk_bf16_f32 v235, v134, v135
  ds_write_b64 v22, v[230:231] offset:32000
  ds_write_b64 v22, v[232:233] offset:32008
  ds_write_b64 v22, v[234:235] offset:32016
  v_cvt_pk_bf16_f32 v236, v136, v137
  v_cvt_pk_bf16_f32 v237, v138, v139
  v_cvt_pk_bf16_f32 v238, v140, v141
  v_cvt_pk_bf16_f32 v239, v142, v143
  v_cvt_pk_bf16_f32 v240, v144, v145
  v_cvt_pk_bf16_f32 v241, v146, v147
  ds_write_b64 v22, v[236:237] offset:38400
  ds_write_b64 v22, v[238:239] offset:38408
  ds_write_b64 v22, v[240:241] offset:38416
  v_cvt_pk_bf16_f32 v242, v148, v149
  v_cvt_pk_bf16_f32 v243, v150, v151
  v_cvt_pk_bf16_f32 v244, v152, v153
  v_cvt_pk_bf16_f32 v245, v154, v155
  v_cvt_pk_bf16_f32 v246, v156, v157
  v_cvt_pk_bf16_f32 v247, v158, v159
  ds_write_b64 v22, v[242:243] offset:44800
  ds_write_b64 v22, v[244:245] offset:44808
  ds_write_b64 v22, v[246:247] offset:44816
  s_waitcnt vmcnt(0) lgkmcnt(0)
  s_barrier
  ds_read_b128 v[224:227], v23 offset:0
  ds_read_b128 v[228:231], v23 offset:64
  ds_read_b128 v[232:235], v23 offset:128
  ds_read_b128 v[236:239], v23 offset:192
  ds_read_b128 v[240:243], v23 offset:256
  ds_read_b128 v[244:247], v23 offset:320
  s_waitcnt lgkmcnt(0)
  s_add_u32 s21, s48, 0
  buffer_store_dwordx4 v[224:227], v26, s[16:19], s21 offen offset:0 sc1
  buffer_store_dwordx4 v[228:231], v26, s[16:19], s21 offen offset:1024 sc1
  buffer_store_dwordx4 v[232:235], v26, s[16:19], s21 offen offset:2048 sc1
  buffer_store_dwordx4 v[236:239], v26, s[16:19], s21 offen offset:3072 sc1
  s_add_u32 s21, s48, 4096
  buffer_store_dwordx4 v[240:243], v26, s[16:19], s21 offen offset:0 sc1
  buffer_store_dwordx4 v[244:247], v26, s[16:19], s21 offen offset:1024 sc1
  s_nop 1
  ds_read_b128 v[224:227], v23 offset:6400
  ds_read_b128 v[228:231], v23 offset:6464
  ds_read_b128 v[232:235], v23 offset:6528
  ds_read_b128 v[236:239], v23 offset:6592
  ds_read_b128 v[240:243], v23 offset:6656
  ds_read_b128 v[244:247], v23 offset:6720
  s_waitcnt lgkmcnt(0)
  buffer_store_dwordx4 v[224:227], v26, s[16:19], s21 offen offset:2048 sc1
  buffer_store_dwordx4 v[228:231], v26, s[16:19], s21 offen offset:3072 sc1
  s_add_u32 s21, s48, 8192
  buffer_store_dwordx4 v[232:235], v26, s[16:19], s21 offen offset:0 sc1
  buffer_store_dwordx4 v[236:239], v26, s[16:19], s21 offen offset:1024 sc1
  buffer_store_dwordx4 v[240:243], v26, s[16:19], s21 offen offset:2048 sc1
  buffer_store_dwordx4 v[244:247], v26, s[16:19], s21 offen offset:3072 sc1
  s_nop 1
  s_waitcnt vmcnt(0)
  s_barrier
  s_cmp_lg_u32 s20, 0
  s_cbranch_scc1 af_145
  v_mov_b32 v4, 0
  v_mov_b32 v5, 1
  s_mov_b64 exec, 1
  buffer_atomic_add v5, v4, s[72:75], s61 offen sc1
  s_mov_b64 exec, -1
  s_nop 1
af_145:
  s_cmp_lg_u32 s43, 0
  s_cbranch_scc1 kv_fin
  s_mov_b32 s43, 2
  s_load_dwordx2 s[6:7], s[0:1], 16
  s_waitcnt lgkmcnt(0)
  s_mov_b32 s12, s6
  s_mov_b32 s13, s7
  s_mov_b32 s14, 7864320
  s_mov_b32 s15, 0x00020000
  s_add_u32 s16, s38, 62914560
  s_addc_u32 s17, s39, 0
  s_mov_b32 s18, 4718592
  s_mov_b32 s19, 0x00020000
  v_mov_b32 v9, 2731
  v_add_u32 v8, 0, v1
  v_mul_u32_u24 v7, v8, v9
  v_lshrrev_b32 v7, 16, v7
  v_mul_u32_u24 v4, 24, v7
  v_sub_u32 v8, v8, v4
  s_mov_b32 s21, 12288
  v_mul_lo_u32 v7, v7, s21
  v_lshl_add_u32 v4, v8, 4, v7
  v_add_u32 v8, 64, v1
  v_mul_u32_u24 v7, v8, v9
  v_lshrrev_b32 v7, 16, v7
  v_mul_u32_u24 v5, 24, v7
  v_sub_u32 v8, v8, v5
  s_mov_b32 s21, 12288
  v_mul_lo_u32 v7, v7, s21
  v_lshl_add_u32 v5, v8, 4, v7
  v_add_u32 v8, 128, v1
  v_mul_u32_u24 v7, v8, v9
  v_lshrrev_b32 v7, 16, v7
  v_mul_u32_u24 v6, 24, v7
  v_sub_u32 v8, v8, v6
  s_mov_b32 s21, 12288
  v_mul_lo_u32 v7, v7, s21
  v_lshl_add_u32 v6, v8, 4, v7
  v_lshrrev_b32 v7, 2, v2
  v_lshl_add_u32 v7, v3, 3, v7
  v_mul_u32_u24 v7, 384, v7
  v_and_b32 v8, 3, v2
  v_lshlrev_b32 v8, 3, v8
  s_mul_i32 s21, s20, 96
  v_add3_u32 v7, v7, v8, s21
  v_add_u32 v8, 61440, v7
  s_mul_i32 s21, s20, 491520
  s_add_u32 s21, s21, 0
  s_add_u32 s21, s21, s44
  s_mul_i32 s22, s20, 15360
  s_add_u32 s22, s22, 0
  s_add_u32 m0, s22, 0
  s_nop 0
  buffer_load_dwordx4 v4, s[12:15], s21 offen lds
  s_add_u32 m0, s22, 1024
  s_nop 0
  buffer_load_dwordx4 v5, s[12:15], s21 offen lds
  s_add_u32 m0, s22, 2048
  s_nop 0
  buffer_load_dwordx4 v6, s[12:15], s21 offen lds
  s_mul_i32 s21, s20, 491520
  s_add_u32 s21, s21, 98304
  s_add_u32 s21, s21, s44
  s_mul_i32 s22, s20, 15360
  s_add_u32 s22, s22, 3072
  s_add_u32 m0, s22, 0
  s_nop 0
  buffer_load_dwordx4 v4, s[12:15], s21 offen lds
  s_add_u32 m0, s22, 1024
  s_nop 0
  buffer_load_dwordx4 v5, s[12:15], s21 offen lds
  s_add_u32 m0, s22, 2048
  s_nop 0
  buffer_load_dwordx4 v6, s[12:15], s21 offen lds
  s_mul_i32 s21, s20, 491520
  s_add_u32 s21, s21, 196608
  s_add_u32 s21, s21, s44
  s_mul_i32 s22, s20, 15360
  s_add_u32 s22, s22, 6144
  s_add_u32 m0, s22, 0
  s_nop 0
  buffer_load_dwordx4 v4, s[12:15], s21 offen lds
  s_add_u32 m0, s22, 1024
  s_nop 0
  buffer_load_dwordx4 v5, s[12:15], s21 offen lds
  s_add_u32 m0, s22, 2048
  s_nop 0
  buffer_load_dwordx4 v6, s[12:15], s21 offen lds
  s_mul_i32 s21, s20, 491520
  s_add_u32 s21, s21, 294912
  s_add_u32 s21, s21, s44
  s_mul_i32 s22, s20, 15360
  s_add_u32 s22, s22, 9216
  s_add_u32 m0, s22, 0
  s_nop 0
  buffer_load_dwordx4 v4, s[12:15], s21 offen lds
  s_add_u32 m0, s22, 1024
  s_nop 0
  buffer_load_dwordx4 v5, s[12:15], s21 offen lds
  s_add_u32 m0, s22, 2048
  s_nop 0
  buffer_load_dwordx4 v6, s[12:15], s21 offen lds
  s_mul_i32 s21, s20, 491520
  s_add_u32 s21, s21, 393216
  s_add_u32 s21, s21, s44
  s_mul_i32 s22, s20, 15360
  s_add_u32 s22, s22, 12288
  s_add_u32 m0, s22, 0
  s_nop 0
  buffer_load_dwordx4 v4, s[12:15], s21 offen lds
  s_add_u32 m0, s22, 1024
  s_nop 0
  buffer_load_dwordx4 v5, s[12:15], s21 offen lds
  s_add_u32 m0, s22, 2048
  s_nop 0
  buffer_load_dwordx4 v6, s[12:15], s21 offen lds
  s_mul_i32 s21, s20, 491520
  s_add_u32 s21, s21, 1966080
  s_add_u32 s21, s21, s44
  s_mul_i32 s22, s20, 15360
  s_add_u32 s22, s22, 61440
  s_add_u32 m0, s22, 0
  s_nop 0
  buffer_load_dwordx4 v4, s[12:15], s21 offen lds
  s_add_u32 m0, s22, 1024
  s_nop 0
  buffer_load_dwordx4 v5, s[12:15], s21 offen lds
  s_add_u32 m0, s22, 2048
  s_nop 0
  buffer_load_dwordx4 v6, s[12:15], s21 offen lds
  s_mul_i32 s21, s20, 491520
  s_add_u32 s21, s21, 2064384
  s_add_u32 s21, s21, s44
  s_mul_i32 s22, s20, 15360
  s_add_u32 s22, s22, 64512
  s_add_u32 m0, s22, 0
  s_nop 0
  buffer_load_dwordx4 v4, s[12:15], s21 offen lds
  s_add_u32 m0, s22, 1024
  s_nop 0
  buffer_load_dwordx4 v5, s[12:15], s21 offen lds
  s_add_u32 m0, s22, 2048
  s_nop 0
  buffer_load_dwordx4 v6, s[12:15], s21 offen lds
  s_mul_i32 s21, s20, 491520
  s_add_u32 s21, s21, 2162688
  s_add_u32 s21, s21, s44
  s_mul_i32 s22, s20, 15360
  s_add_u32 s22, s22, 67584
  s_add_u32 m0, s22, 0
  s_nop 0
  buffer_load_dwordx4 v4, s[12:15], s21 offen lds
  s_add_u32 m0, s22, 1024
  s_nop 0
  buffer_load_dwordx4 v5, s[12:15], s21 offen lds
  s_add_u32 m0, s22, 2048
  s_nop 0
  buffer_load_dwordx4 v6, s[12:15], s21 offen lds
  s_mul_i32 s21, s20, 491520
  s_add_u32 s21, s21, 2260992
  s_add_u32 s21, s21, s44
  s_mul_i32 s22, s20, 15360
  s_add_u32 s22, s22, 70656
  s_add_u32 m0, s22, 0
  s_nop 0
  buffer_load_dwordx4 v4, s[12:15], s21 offen lds
  s_add_u32 m0, s22, 1024
  s_nop 0
  buffer_load_dwordx4 v5, s[12:15], s21 offen lds
  s_add_u32 m0, s22, 2048
  s_nop 0
  buffer_load_dwordx4 v6, s[12:15], s21 offen lds
  s_mul_i32 s21, s20, 491520
  s_add_u32 s21, s21, 2359296
  s_add_u32 s21, s21, s44
  s_mul_i32 s22, s20, 15360
  s_add_u32 s22, s22, 73728
  s_add_u32 m0, s22, 0
  s_nop 0
  buffer_load_dwordx4 v4, s[12:15], s21 offen lds
  s_add_u32 m0, s22, 1024
  s_nop 0
  buffer_load_dwordx4 v5, s[12:15], s21 offen lds
  s_add_u32 m0, s22, 2048
  s_nop 0
  buffer_load_dwordx4 v6, s[12:15], s21 offen lds
  s_mul_i32 s21, s20, 491520
  s_add_u32 s21, s21, 3932160
  s_add_u32 s21, s21, s44
  buffer_load_dwordx4 v[64:67], v4, s[12:15], s21 offen
  buffer_load_dwordx4 v[68:71], v5, s[12:15], s21 offen
  buffer_load_dwordx4 v[72:75], v6, s[12:15], s21 offen
  s_mul_i32 s21, s20, 491520
  s_add_u32 s21, s21, 4030464
  s_add_u32 s21, s21, s44
  buffer_load_dwordx4 v[76:79], v4, s[12:15], s21 offen
  buffer_load_dwordx4 v[80:83], v5, s[12:15], s21 offen
  buffer_load_dwordx4 v[84:87], v6, s[12:15], s21 offen
  s_mul_i32 s21, s20, 491520
  s_add_u32 s21, s21, 4128768
  s_add_u32 s21, s21, s44
  buffer_load_dwordx4 v[88:91], v4, s[12:15], s21 offen
  buffer_load_dwordx4 v[92:95], v5, s[12:15], s21 offen
  buffer_load_dwordx4 v[96:99], v6, s[12:15], s21 offen
  s_mul_i32 s21, s20, 491520
  s_add_u32 s21, s21, 4227072
  s_add_u32 s21, s21, s44
  buffer_load_dwordx4 v[100:103], v4, s[12:15], s21 offen
  buffer_load_dwordx4 v[104:107], v5, s[12:15], s21 offen
  buffer_load_dwordx4 v[108:111], v6, s[12:15], s21 offen
  s_mul_i32 s21, s20, 491520
  s_add_u32 s21, s21, 4325376
  s_add_u32 s21, s21, s44
  buffer_load_dwordx4 v[112:115], v4, s[12:15], s21 offen
  buffer_load_dwordx4 v[116:119], v5, s[12:15], s21 offen
  buffer_load_dwordx4 v[120:123], v6, s[12:15], s21 offen
  s_mul_i32 s21, s20, 491520
  s_add_u32 s21, s21, 5898240
  s_add_u32 s21, s21, s44
  buffer_load_dwordx4 v[124:127], v4, s[12:15], s21 offen
  buffer_load_dwordx4 v[128:131], v5, s[12:15], s21 offen
  buffer_load_dwordx4 v[132:135], v6, s[12:15], s21 offen
  s_mul_i32 s21, s20, 491520
  s_add_u32 s21, s21, 5996544
  s_add_u32 s21, s21, s44
  buffer_load_dwordx4 v[136:139], v4, s[12:15], s21 offen
  buffer_load_dwordx4 v[140:143], v5, s[12:15], s21 offen
  buffer_load_dwordx4 v[144:147], v6, s[12:15], s21 offen
  s_mul_i32 s21, s20, 491520
  s_add_u32 s21, s21, 6094848
  s_add_u32 s21, s21, s44
  buffer_load_dwordx4 v[148:151], v4, s[12:15], s21 offen
  buffer_load_dwordx4 v[152:155], v5, s[12:15], s21 offen
  buffer_load_dwordx4 v[156:159], v6, s[12:15], s21 offen
  s_mul_i32 s21, s20, 491520
  s_add_u32 s21, s21, 6193152
  s_add_u32 s21, s21, s44
  buffer_load_dwordx4 v[160:163], v4, s[12:15], s21 offen
  buffer_load_dwordx4 v[164:167], v5, s[12:15], s21 offen
  buffer_load_dwordx4 v[168:171], v6, s[12:15], s21 offen
  s_mul_i32 s21, s20, 491520
  s_add_u32 s21, s21, 6291456
  s_add_u32 s21, s21, s44
  buffer_load_dwordx4 v[172:175], v4, s[12:15], s21 offen
  buffer_load_dwordx4 v[176:179], v5, s[12:15], s21 offen
  buffer_load_dwordx4 v[180:183], v6, s[12:15], s21 offen
  s_mul_i32 s22, s20, 15360
  v_lshl_add_u32 v30, v1, 4, s22
  v_add_u32 v31, 61440, v30
  s_waitcnt vmcnt(45)
  s_barrier
  ds_read_b64_tr_b16 a[0:1], v7 offset:0
  ds_read_b64_tr_b16 a[2:3], v7 offset:1536
  ds_read_b64_tr_b16 a[4:5], v7 offset:32
  ds_read_b64_tr_b16 a[6:7], v7 offset:1568
  ds_read_b64_tr_b16 a[8:9], v7 offset:64
  ds_read_b64_tr_b16 a[10:11], v7 offset:1600
  ds_read_b64_tr_b16 a[12:13], v7 offset:12288
  ds_read_b64_tr_b16 a[14:15], v7 offset:13824
  ds_read_b64_tr_b16 a[16:17], v7 offset:12320
  ds_read_b64_tr_b16 a[18:19], v7 offset:13856
  ds_read_b64_tr_b16 a[20:21], v7 offset:12352
  ds_read_b64_tr_b16 a[22:23], v7 offset:13888
  ds_read_b64_tr_b16 a[24:25], v7 offset:24576
  ds_read_b64_tr_b16 a[26:27], v7 offset:26112
  ds_read_b64_tr_b16 a[28:29], v7 offset:24608
  ds_read_b64_tr_b16 a[30:31], v7 offset:26144
  ds_read_b64_tr_b16 a[32:33], v7 offset:24640
  ds_read_b64_tr_b16 a[34:35], v7 offset:26176
  ds_read_b64_tr_b16 a[36:37], v7 offset:36864
  ds_read_b64_tr_b16 a[38:39], v7 offset:38400
  ds_read_b64_tr_b16 a[40:41], v7 offset:36896
  ds_read_b64_tr_b16 a[42:43], v7 offset:38432
  ds_read_b64_tr_b16 a[44:45], v7 offset:36928
  ds_read_b64_tr_b16 a[46:47], v7 offset:38464
  ds_read_b64_tr_b16 a[48:49], v7 offset:49152
  ds_read_b64_tr_b16 a[50:51], v7 offset:50688
  ds_read_b64_tr_b16 a[52:53], v7 offset:49184
  ds_read_b64_tr_b16 a[54:55], v7 offset:50720
  ds_read_b64_tr_b16 a[56:57], v7 offset:49216
  ds_read_b64_tr_b16 a[58:59], v7 offset:50752
  s_waitcnt lgkmcnt(0)
  s_barrier
  s_waitcnt vmcnt(30)
  s_barrier
  ds_read_b64_tr_b16 a[60:61], v8 offset:0
  ds_read_b64_tr_b16 a[62:63], v8 offset:1536
  ds_read_b64_tr_b16 a[64:65], v8 offset:32
  ds_read_b64_tr_b16 a[66:67], v8 offset:1568
  ds_read_b64_tr_b16 a[68:69], v8 offset:64
  ds_read_b64_tr_b16 a[70:71], v8 offset:1600
  ds_read_b64_tr_b16 a[72:73], v8 offset:12288
  ds_read_b64_tr_b16 a[74:75], v8 offset:13824
  ds_read_b64_tr_b16 a[76:77], v8 offset:12320
  ds_read_b64_tr_b16 a[78:79], v8 offset:13856
  ds_read_b64_tr_b16 a[80:81], v8 offset:12352
  ds_read_b64_tr_b16 a[82:83], v8 offset:13888
  ds_read_b64_tr_b16 a[84:85], v8 offset:24576
  ds_read_b64_tr_b16 a[86:87], v8 offset:26112
  ds_read_b64_tr_b16 a[88:89], v8 offset:24608
  ds_read_b64_tr_b16 a[90:91], v8 offset:26144
  ds_read_b64_tr_b16 a[92:93], v8 offset:24640
  ds_read_b64_tr_b16 a[94:95], v8 offset:26176
  ds_read_b64_tr_b16 a[96:97], v8 offset:36864
  ds_read_b64_tr_b16 a[98:99], v8 offset:38400
  ds_read_b64_tr_b16 a[100:101], v8 offset:36896
  ds_read_b64_tr_b16 a[102:103], v8 offset:38432
  ds_read_b64_tr_b16 a[104:105], v8 offset:36928
  ds_read_b64_tr_b16 a[106:107], v8 offset:38464
  ds_read_b64_tr_b16 a[108:109], v8 offset:49152
  ds_read_b64_tr_b16 a[110:111], v8 offset:50688
  ds_read_b64_tr_b16 a[112:113], v8 offset:49184
  ds_read_b64_tr_b16 a[114:115], v8 offset:50720
  ds_read_b64_tr_b16 a[116:117], v8 offset:49216
  ds_read_b64_tr_b16 a[118:119], v8 offset:50752
  s_waitcnt lgkmcnt(0)
  s_barrier
  s_waitcnt vmcnt(15)
  ds_write_b128 v30, v[64:67] offset:0
  ds_write_b128 v30, v[68:71] offset:1024
  ds_write_b128 v30, v[72:75] offset:2048
  ds_write_b128 v30, v[76:79] offset:3072
  ds_write_b128 v30, v[80:83] offset:4096
  ds_write_b128 v30, v[84:87] offset:5120
  ds_write_b128 v30, v[88:91] offset:6144
  ds_write_b128 v30, v[92:95] offset:7168
  ds_write_b128 v30, v[96:99] offset:8192
  ds_write_b128 v30, v[100:103] offset:9216
  ds_write_b128 v30, v[104:107] offset:10240
  ds_write_b128 v30, v[108:111] offset:11264
  ds_write_b128 v30, v[112:115] offset:12288
  ds_write_b128 v30, v[116:119] offset:13312
  ds_write_b128 v30, v[120:123] offset:14336
  s_waitcnt lgkmcnt(0)
  s_barrier
  ds_read_b64_tr_b16 a[120:121], v7 offset:0
  ds_read_b64_tr_b16 a[122:123], v7 offset:1536
  ds_read_b64_tr_b16 a[124:125], v7 offset:32
  ds_read_b64_tr_b16 a[126:127], v7 offset:1568
  ds_read_b64_tr_b16 a[128:129], v7 offset:64
  ds_read_b64_tr_b16 a[130:131], v7 offset:1600
  ds_read_b64_tr_b16 a[132:133], v7 offset:12288
  ds_read_b64_tr_b16 a[134:135], v7 offset:13824
  ds_read_b64_tr_b16 a[136:137], v7 offset:12320
  ds_read_b64_tr_b16 a[138:139], v7 offset:13856
  ds_read_b64_tr_b16 a[140:141], v7 offset:12352
  ds_read_b64_tr_b16 a[142:143], v7 offset:13888
  ds_read_b64_tr_b16 a[144:145], v7 offset:24576
  ds_read_b64_tr_b16 a[146:147], v7 offset:26112
  ds_read_b64_tr_b16 a[148:149], v7 offset:24608
  ds_read_b64_tr_b16 a[150:151], v7 offset:26144
  ds_read_b64_tr_b16 a[152:153], v7 offset:24640
  ds_read_b64_tr_b16 a[154:155], v7 offset:26176
  ds_read_b64_tr_b16 a[156:157], v7 offset:36864
  ds_read_b64_tr_b16 a[158:159], v7 offset:38400
  ds_read_b64_tr_b16 a[160:161], v7 offset:36896
  ds_read_b64_tr_b16 a[162:163], v7 offset:38432
  ds_read_b64_tr_b16 a[164:165], v7 offset:36928
  ds_read_b64_tr_b16 a[166:167], v7 offset:38464
  ds_read_b64_tr_b16 a[168:169], v7 offset:49152
  ds_read_b64_tr_b16 a[170:171], v7 offset:50688
  ds_read_b64_tr_b16 a[172:173], v7 offset:49184
  ds_read_b64_tr_b16 a[174:175], v7 offset:50720
  ds_read_b64_tr_b16 a[176:177], v7 offset:49216
  ds_read_b64_tr_b16 a[178:179], v7 offset:50752
  s_waitcnt lgkmcnt(0)
  s_barrier
  s_waitcnt vmcnt(0)
  ds_write_b128 v31, v[124:127] offset:0
  ds_write_b128 v31, v[128:131] offset:1024
  ds_write_b128 v31, v[132:135] offset:2048
  ds_write_b128 v31, v[136:139] offset:3072
  ds_write_b128 v31, v[140:143] offset:4096
  ds_write_b128 v31, v[144:147] offset:5120
  ds_write_b128 v31, v[148:151] offset:6144
  ds_write_b128 v31, v[152:155] offset:7168
  ds_write_b128 v31, v[156:159] offset:8192
  ds_write_b128 v31, v[160:163] offset:9216
  ds_write_b128 v31, v[164:167] offset:10240
  ds_write_b128 v31, v[168:171] offset:11264
  ds_write_b128 v31, v[172:175] offset:12288
  ds_write_b128 v31, v[176:179] offset:13312
  ds_write_b128 v31, v[180:183] offset:14336
  s_waitcnt lgkmcnt(0)
  s_barrier
  ds_read_b64_tr_b16 a[180:181], v8 offset:0
  ds_read_b64_tr_b16 a[182:183], v8 offset:1536
  ds_read_b64_tr_b16 a[184:185], v8 offset:32
  ds_read_b64_tr_b16 a[186:187], v8 offset:1568
  ds_read_b64_tr_b16 a[188:189], v8 offset:64
  ds_read_b64_tr_b16 a[190:191], v8 offset:1600
  ds_read_b64_tr_b16 a[192:193], v8 offset:12288
  ds_read_b64_tr_b16 a[194:195], v8 offset:13824
  ds_read_b64_tr_b16 a[196:197], v8 offset:12320
  ds_read_b64_tr_b16 a[198:199], v8 offset:13856
  ds_read_b64_tr_b16 a[200:201], v8 offset:12352
  ds_read_b64_tr_b16 a[202:203], v8 offset:13888
  ds_read_b64_tr_b16 a[204:205], v8 offset:24576
  ds_read_b64_tr_b16 a[206:207], v8 offset:26112
  ds_read_b64_tr_b16 a[208:209], v8 offset:24608
  ds_read_b64_tr_b16 a[210:211], v8 offset:26144
  ds_read_b64_tr_b16 a[212:213], v8 offset:24640
  ds_read_b64_tr_b16 a[214:215], v8 offset:26176
  ds_read_b64_tr_b16 a[216:217], v8 offset:36864
  ds_read_b64_tr_b16 a[218:219], v8 offset:38400
  ds_read_b64_tr_b16 a[220:221], v8 offset:36896
  ds_read_b64_tr_b16 a[222:223], v8 offset:38432
  ds_read_b64_tr_b16 a[224:225], v8 offset:36928
  ds_read_b64_tr_b16 a[226:227], v8 offset:38464
  ds_read_b64_tr_b16 a[228:229], v8 offset:49152
  ds_read_b64_tr_b16 a[230:231], v8 offset:50688
  ds_read_b64_tr_b16 a[232:233], v8 offset:49184
  ds_read_b64_tr_b16 a[234:235], v8 offset:50720
  ds_read_b64_tr_b16 a[236:237], v8 offset:49216
  ds_read_b64_tr_b16 a[238:239], v8 offset:50752
  s_waitcnt lgkmcnt(0)
  s_barrier
  s_mov_b32 s24, 2129920
  s_mov_b32 s25, 163840
  v_lshrrev_b32 v11, 3, v1
  v_and_b32 v12, 7, v1
  v_xor_b32 v12, v12, v11
  v_mul_u32_u24 v11, 1280, v11
  v_lshl_add_u32 v10, v12, 4, v11
  s_mul_i32 s46, s20, 40960
  v_add_u32 v10, s46, v10
  s_lshl_b32 s47, s20, 12
  s_add_u32 s47, s47, 0
  s_add_u32 s46, s47, 98304
  s_mov_b32 s30, s24
  s_add_u32 s32, s47, 32768
  v_add_u32 v11, 9216, v10
  v_add_u32 v12, 18432, v10
  v_add_u32 v13, 27648, v10
  s_mov_b32 m0, s32
  s_nop 0
  buffer_load_dwordx4 v10, s[8:11], s30 offen offset:0 lds
  buffer_load_dwordx4 v11, s[8:11], s30 offen offset:1024 lds
  buffer_load_dwordx4 v12, s[8:11], s30 offen offset:2048 lds
  buffer_load_dwordx4 v13, s[8:11], s30 offen offset:3072 lds
  s_add_u32 s30, s30, 128
  s_add_u32 s32, s32, 16384
  s_cmp_lt_u32 s32, s46
  s_cselect_b32 s32, s32, s47
  s_mov_b32 m0, s32
  s_nop 0
  buffer_load_dwordx4 v10, s[8:11], s30 offen offset:0 lds
  buffer_load_dwordx4 v11, s[8:11], s30 offen offset:1024 lds
  buffer_load_dwordx4 v12, s[8:11], s30 offen offset:2048 lds
  buffer_load_dwordx4 v13, s[8:11], s30 offen offset:3072 lds
  s_add_u32 s30, s30, 128
  s_add_u32 s32, s32, 16384
  s_cmp_lt_u32 s32, s46
  s_cselect_b32 s32, s32, s47
  s_mov_b32 m0, s32
  s_nop 0
  buffer_load_dwordx4 v10, s[8:11], s30 offen offset:0 lds
  buffer_load_dwordx4 v11, s[8:11], s30 offen offset:1024 lds
  buffer_load_dwordx4 v12, s[8:11], s30 offen offset:2048 lds
  buffer_load_dwordx4 v13, s[8:11], s30 offen offset:3072 lds
  s_add_u32 s30, s30, 128
  s_add_u32 s32, s32, 16384
  s_cmp_lt_u32 s32, s46
  s_cselect_b32 s32, s32, s47
  s_mov_b32 m0, s32
  s_nop 0
  buffer_load_dwordx4 v10, s[8:11], s30 offen offset:0 lds
  buffer_load_dwordx4 v11, s[8:11], s30 offen offset:1024 lds
  buffer_load_dwordx4 v12, s[8:11], s30 offen offset:2048 lds
  buffer_load_dwordx4 v13, s[8:11], s30 offen offset:3072 lds
  s_add_u32 s30, s30, 128
  s_add_u32 s32, s32, 16384
  s_cmp_lt_u32 s32, s46
  s_cselect_b32 s32, s32, s47
  s_mov_b32 s26, 3
  s_mul_i32 s27, s42, 12288
  s_lshl_b32 s60, s42, 7
  s_add_u32 s60, s60, 113664
  s_mov_b32 s62, 0
  s_branch kv_main
kv_fin:
  s_branch queue
not_kv:
  s_cmp_ge_u32 s3, 96
  s_cbranch_scc1 not_vw
  s_sub_u32 s2, s3, 64
  s_load_dwordx2 s[72:73], s[0:1], 104
  s_waitcnt lgkmcnt(0)
  s_add_u32 s72, s72, 81068032
  s_addc_u32 s73, s73, 0
  s_mov_b32 s74, 117760
  s_mov_b32 s75, 0x00020000
  s_add_u32 s8, s38, 78643200
  s_addc_u32 s9, s39, 0
  s_mov_b32 s10, 2162688
  s_mov_b32 s11, 0x00020000
  s_add_u32 s12, s38, 50331648
  s_addc_u32 s13, s39, 0
  s_mov_b32 s14, 12582912
  s_mov_b32 s15, 0x00020000
  s_add_u32 s16, s38, 83886079
  s_addc_u32 s17, s39, 0
  s_and_b32 s16, s16, 0xffe00000
  s_mov_b32 s18, 2097152
  s_mov_b32 s19, 0x00020000
  v_lshlrev_b32 v8, 4, v0
  v_lshlrev_b32 v9, 4, v1
  v_mov_b32 v4, 0
  v_mov_b32 v12, -1
  v_mov_b32 v5, 0
  v_mov_b32 v13, -1
  v_mov_b32 v6, 0
  v_mov_b32 v14, -1
  v_mov_b32 v7, 0
  v_mov_b32 v15, -1
  s_lshl_b32 s21, s2, 12
  buffer_store_dwordx4 v[4:7], v8, s[72:75], s21 offen sc1
  s_lshr_b32 s21, s2, 3
  s_lshl_b32 s21, s21, 15
  s_bfe_u32 s22, s2, 0x10002
  s_lshl_b32 s22, s22, 13
  s_add_u32 s21, s21, s22
  s_bfe_u32 s22, s2, 0x10001
  s_lshl_b32 s22, s22, 14
  s_add_u32 s21, s21, s22
  s_and_b32 s22, s2, 1
  s_mul_i32 s22, s22, 3
  s_add_u32 s22, s22, s20
  s_lshl_b32 s22, s22, 10
  s_add_u32 s21, s21, s22
  s_cmp_lt_u32 s20, 3
  s_cselect_b32 s21, s21, 0x80000000
  buffer_store_dwordx4 v[4:7], v9, s[16:19], s21 offen sc1
  s_mul_i32 s23, s20, 540672
  s_lshl_b32 s21, s2, 11
  s_add_u32 s21, s21, s23
  s_add_u32 s21, s21, 81920
  buffer_store_dwordx4 v[12:15], v9, s[8:11], s21 offen sc1
  buffer_store_dwordx4 v[12:15], v9, s[8:11], s21 offen offset:1024 sc1
  s_mul_i32 s21, s2, 3072
  s_add_u32 s21, s21, s23
  s_add_u32 s21, s21, 278528
  buffer_store_dwordx4 v[12:15], v9, s[8:11], s21 offen sc1
  buffer_store_dwordx4 v[12:15], v9, s[8:11], s21 offen offset:1024 sc1
  buffer_store_dwordx4 v[12:15], v9, s[8:11], s21 offen offset:2048 sc1
  s_lshl_b32 s21, s2, 9
  s_add_u32 s21, s21, s23
  s_add_u32 s21, s21, 376832
  s_mov_b64 exec, 0xffffffff
  buffer_store_dwordx4 v[12:15], v9, s[8:11], s21 offen sc1
  s_mov_b64 exec, -1
  s_lshl_b32 s21, s20, 5
  s_add_u32 s21, s21, s2
  s_mul_i32 s21, s21, 3072
  s_cmp_lt_u32 s20, 3
  s_cselect_b32 s21, s21, 0x80000000
  s_add_u32 s22, s21, 6291456
  buffer_store_dwordx4 v[12:15], v9, s[12:15], s21 offen offset:0 sc1
  buffer_store_dwordx4 v[12:15], v9, s[12:15], s22 offen offset:0 sc1
  buffer_store_dwordx4 v[12:15], v9, s[12:15], s21 offen offset:1024 sc1
  buffer_store_dwordx4 v[12:15], v9, s[12:15], s22 offen offset:1024 sc1
  buffer_store_dwordx4 v[12:15], v9, s[12:15], s21 offen offset:2048 sc1
  buffer_store_dwordx4 v[12:15], v9, s[12:15], s22 offen offset:2048 sc1
  s_waitcnt vmcnt(0)
  s_barrier
  s_mov_b32 s21, 76
  s_cmp_lg_u32 s20, 0
  s_cbranch_scc1 af_146
  v_mov_b32 v10, 0
  v_mov_b32 v11, 1
  s_mov_b64 exec, 1
  buffer_atomic_add v11, v10, s[32:35], s21 offen sc1
  s_mov_b64 exec, -1
  s_nop 1
af_146:
  s_load_dwordx2 s[6:7], s[0:1], 40
  s_load_dwordx2 s[38:39], s[0:1], 104
  s_waitcnt lgkmcnt(0)
  s_mov_b32 s12, s6
  s_mov_b32 s13, s7
  s_mov_b32 s14, 7864320
  s_mov_b32 s15, 0x00020000
  s_mov_b32 s16, s38
  s_mov_b32 s17, s39
  s_mov_b32 s18, 50331648
  s_mov_b32 s19, 0x00020000
  s_add_u32 s24, s38, 114294784
  s_addc_u32 s25, s39, 0
  s_mov_b32 s26, 83886080
  s_mov_b32 s27, 0x00020000
  s_load_dwordx2 s[72:73], s[0:1], 104
  s_waitcnt lgkmcnt(0)
  s_add_u32 s72, s72, 81068032
  s_addc_u32 s73, s73, 0
  s_mov_b32 s74, 117760
  s_mov_b32 s75, 0x00020000
  v_mov_b32 v29, 52429
  s_mul_i32 s21, s20, 960
  s_add_u32 s21, s21, 0
  v_add_u32 v21, s21, v1
  v_mul_u32_u24 v22, v21, v29
  v_lshrrev_b32 v22, 22, v22
  v_mul_u32_u24 v23, 80, v22
  v_sub_u32 v21, v21, v23
  v_bfe_u32 v23, v22, 3, 1
  v_and_b32 v24, 3, v22
  v_lshl_add_u32 v23, v23, 2, v24
  v_lshlrev_b32 v23, 1, v23
  v_xor_b32 v21, v21, v23
  v_mul_u32_u24 v26, 5462, v22
  v_lshrrev_b32 v26, 16, v26
  v_mul_u32_u24 v27, 12, v26
  v_sub_u32 v22, v22, v27
  v_lshrrev_b32 v27, 2, v22
  v_and_b32 v22, 3, v22
  v_lshlrev_b32 v25, 4, v27
  v_lshl_add_u32 v25, v26, 2, v25
  v_add_u32 v25, v25, v22
  v_mul_u32_u24 v25, 1280, v25
  v_lshl_add_u32 v64, v21, 4, v25
  s_mul_i32 s21, s20, 960
  s_add_u32 s21, s21, 64
  v_add_u32 v21, s21, v1
  v_mul_u32_u24 v22, v21, v29
  v_lshrrev_b32 v22, 22, v22
  v_mul_u32_u24 v23, 80, v22
  v_sub_u32 v21, v21, v23
  v_bfe_u32 v23, v22, 3, 1
  v_and_b32 v24, 3, v22
  v_lshl_add_u32 v23, v23, 2, v24
  v_lshlrev_b32 v23, 1, v23
  v_xor_b32 v21, v21, v23
  v_mul_u32_u24 v26, 5462, v22
  v_lshrrev_b32 v26, 16, v26
  v_mul_u32_u24 v27, 12, v26
  v_sub_u32 v22, v22, v27
  v_lshrrev_b32 v27, 2, v22
  v_and_b32 v22, 3, v22
  v_lshlrev_b32 v25, 4, v27
  v_lshl_add_u32 v25, v26, 2, v25
  v_add_u32 v25, v25, v22
  v_mul_u32_u24 v25, 1280, v25
  v_lshl_add_u32 v65, v21, 4, v25
  s_mul_i32 s21, s20, 960
  s_add_u32 s21, s21, 128
  v_add_u32 v21, s21, v1
  v_mul_u32_u24 v22, v21, v29
  v_lshrrev_b32 v22, 22, v22
  v_mul_u32_u24 v23, 80, v22
  v_sub_u32 v21, v21, v23
  v_bfe_u32 v23, v22, 3, 1
  v_and_b32 v24, 3, v22
  v_lshl_add_u32 v23, v23, 2, v24
  v_lshlrev_b32 v23, 1, v23
  v_xor_b32 v21, v21, v23
  v_mul_u32_u24 v26, 5462, v22
  v_lshrrev_b32 v26, 16, v26
  v_mul_u32_u24 v27, 12, v26
  v_sub_u32 v22, v22, v27
  v_lshrrev_b32 v27, 2, v22
  v_and_b32 v22, 3, v22
  v_lshlrev_b32 v25, 4, v27
  v_lshl_add_u32 v25, v26, 2, v25
  v_add_u32 v25, v25, v22
  v_mul_u32_u24 v25, 1280, v25
  v_lshl_add_u32 v66, v21, 4, v25
  s_mul_i32 s21, s20, 960
  s_add_u32 s21, s21, 192
  v_add_u32 v21, s21, v1
  v_mul_u32_u24 v22, v21, v29
  v_lshrrev_b32 v22, 22, v22
  v_mul_u32_u24 v23, 80, v22
  v_sub_u32 v21, v21, v23
  v_bfe_u32 v23, v22, 3, 1
  v_and_b32 v24, 3, v22
  v_lshl_add_u32 v23, v23, 2, v24
  v_lshlrev_b32 v23, 1, v23
  v_xor_b32 v21, v21, v23
  v_mul_u32_u24 v26, 5462, v22
  v_lshrrev_b32 v26, 16, v26
  v_mul_u32_u24 v27, 12, v26
  v_sub_u32 v22, v22, v27
  v_lshrrev_b32 v27, 2, v22
  v_and_b32 v22, 3, v22
  v_lshlrev_b32 v25, 4, v27
  v_lshl_add_u32 v25, v26, 2, v25
  v_add_u32 v25, v25, v22
  v_mul_u32_u24 v25, 1280, v25
  v_lshl_add_u32 v67, v21, 4, v25
  s_mul_i32 s21, s20, 960
  s_add_u32 s21, s21, 256
  v_add_u32 v21, s21, v1
  v_mul_u32_u24 v22, v21, v29
  v_lshrrev_b32 v22, 22, v22
  v_mul_u32_u24 v23, 80, v22
  v_sub_u32 v21, v21, v23
  v_bfe_u32 v23, v22, 3, 1
  v_and_b32 v24, 3, v22
  v_lshl_add_u32 v23, v23, 2, v24
  v_lshlrev_b32 v23, 1, v23
  v_xor_b32 v21, v21, v23
  v_mul_u32_u24 v26, 5462, v22
  v_lshrrev_b32 v26, 16, v26
  v_mul_u32_u24 v27, 12, v26
  v_sub_u32 v22, v22, v27
  v_lshrrev_b32 v27, 2, v22
  v_and_b32 v22, 3, v22
  v_lshlrev_b32 v25, 4, v27
  v_lshl_add_u32 v25, v26, 2, v25
  v_add_u32 v25, v25, v22
  v_mul_u32_u24 v25, 1280, v25
  v_lshl_add_u32 v68, v21, 4, v25
  s_mul_i32 s21, s20, 960
  s_add_u32 s21, s21, 320
  v_add_u32 v21, s21, v1
  v_mul_u32_u24 v22, v21, v29
  v_lshrrev_b32 v22, 22, v22
  v_mul_u32_u24 v23, 80, v22
  v_sub_u32 v21, v21, v23
  v_bfe_u32 v23, v22, 3, 1
  v_and_b32 v24, 3, v22
  v_lshl_add_u32 v23, v23, 2, v24
  v_lshlrev_b32 v23, 1, v23
  v_xor_b32 v21, v21, v23
  v_mul_u32_u24 v26, 5462, v22
  v_lshrrev_b32 v26, 16, v26
  v_mul_u32_u24 v27, 12, v26
  v_sub_u32 v22, v22, v27
  v_lshrrev_b32 v27, 2, v22
  v_and_b32 v22, 3, v22
  v_lshlrev_b32 v25, 4, v27
  v_lshl_add_u32 v25, v26, 2, v25
  v_add_u32 v25, v25, v22
  v_mul_u32_u24 v25, 1280, v25
  v_lshl_add_u32 v69, v21, 4, v25
  s_mul_i32 s21, s20, 960
  s_add_u32 s21, s21, 384
  v_add_u32 v21, s21, v1
  v_mul_u32_u24 v22, v21, v29
  v_lshrrev_b32 v22, 22, v22
  v_mul_u32_u24 v23, 80, v22
  v_sub_u32 v21, v21, v23
  v_bfe_u32 v23, v22, 3, 1
  v_and_b32 v24, 3, v22
  v_lshl_add_u32 v23, v23, 2, v24
  v_lshlrev_b32 v23, 1, v23
  v_xor_b32 v21, v21, v23
  v_mul_u32_u24 v26, 5462, v22
  v_lshrrev_b32 v26, 16, v26
  v_mul_u32_u24 v27, 12, v26
  v_sub_u32 v22, v22, v27
  v_lshrrev_b32 v27, 2, v22
  v_and_b32 v22, 3, v22
  v_lshlrev_b32 v25, 4, v27
  v_lshl_add_u32 v25, v26, 2, v25
  v_add_u32 v25, v25, v22
  v_mul_u32_u24 v25, 1280, v25
  v_lshl_add_u32 v70, v21, 4, v25
  s_mul_i32 s21, s20, 960
  s_add_u32 s21, s21, 448
  v_add_u32 v21, s21, v1
  v_mul_u32_u24 v22, v21, v29
  v_lshrrev_b32 v22, 22, v22
  v_mul_u32_u24 v23, 80, v22
  v_sub_u32 v21, v21, v23
  v_bfe_u32 v23, v22, 3, 1
  v_and_b32 v24, 3, v22
  v_lshl_add_u32 v23, v23, 2, v24
  v_lshlrev_b32 v23, 1, v23
  v_xor_b32 v21, v21, v23
  v_mul_u32_u24 v26, 5462, v22
  v_lshrrev_b32 v26, 16, v26
  v_mul_u32_u24 v27, 12, v26
  v_sub_u32 v22, v22, v27
  v_lshrrev_b32 v27, 2, v22
  v_and_b32 v22, 3, v22
  v_lshlrev_b32 v25, 4, v27
  v_lshl_add_u32 v25, v26, 2, v25
  v_add_u32 v25, v25, v22
  v_mul_u32_u24 v25, 1280, v25
  v_lshl_add_u32 v71, v21, 4, v25
  s_mul_i32 s21, s20, 960
  s_add_u32 s21, s21, 512
  v_add_u32 v21, s21, v1
  v_mul_u32_u24 v22, v21, v29
  v_lshrrev_b32 v22, 22, v22
  v_mul_u32_u24 v23, 80, v22
  v_sub_u32 v21, v21, v23
  v_bfe_u32 v23, v22, 3, 1
  v_and_b32 v24, 3, v22
  v_lshl_add_u32 v23, v23, 2, v24
  v_lshlrev_b32 v23, 1, v23
  v_xor_b32 v21, v21, v23
  v_mul_u32_u24 v26, 5462, v22
  v_lshrrev_b32 v26, 16, v26
  v_mul_u32_u24 v27, 12, v26
  v_sub_u32 v22, v22, v27
  v_lshrrev_b32 v27, 2, v22
  v_and_b32 v22, 3, v22
  v_lshlrev_b32 v25, 4, v27
  v_lshl_add_u32 v25, v26, 2, v25
  v_add_u32 v25, v25, v22
  v_mul_u32_u24 v25, 1280, v25
  v_lshl_add_u32 v72, v21, 4, v25
  s_mul_i32 s21, s20, 960
  s_add_u32 s21, s21, 576
  v_add_u32 v21, s21, v1
  v_mul_u32_u24 v22, v21, v29
  v_lshrrev_b32 v22, 22, v22
  v_mul_u32_u24 v23, 80, v22
  v_sub_u32 v21, v21, v23
  v_bfe_u32 v23, v22, 3, 1
  v_and_b32 v24, 3, v22
  v_lshl_add_u32 v23, v23, 2, v24
  v_lshlrev_b32 v23, 1, v23
  v_xor_b32 v21, v21, v23
  v_mul_u32_u24 v26, 5462, v22
  v_lshrrev_b32 v26, 16, v26
  v_mul_u32_u24 v27, 12, v26
  v_sub_u32 v22, v22, v27
  v_lshrrev_b32 v27, 2, v22
  v_and_b32 v22, 3, v22
  v_lshlrev_b32 v25, 4, v27
  v_lshl_add_u32 v25, v26, 2, v25
  v_add_u32 v25, v25, v22
  v_mul_u32_u24 v25, 1280, v25
  v_lshl_add_u32 v73, v21, 4, v25
  s_mul_i32 s21, s20, 960
  s_add_u32 s21, s21, 640
  v_add_u32 v21, s21, v1
  v_mul_u32_u24 v22, v21, v29
  v_lshrrev_b32 v22, 22, v22
  v_mul_u32_u24 v23, 80, v22
  v_sub_u32 v21, v21, v23
  v_bfe_u32 v23, v22, 3, 1
  v_and_b32 v24, 3, v22
  v_lshl_add_u32 v23, v23, 2, v24
  v_lshlrev_b32 v23, 1, v23
  v_xor_b32 v21, v21, v23
  v_mul_u32_u24 v26, 5462, v22
  v_lshrrev_b32 v26, 16, v26
  v_mul_u32_u24 v27, 12, v26
  v_sub_u32 v22, v22, v27
  v_lshrrev_b32 v27, 2, v22
  v_and_b32 v22, 3, v22
  v_lshlrev_b32 v25, 4, v27
  v_lshl_add_u32 v25, v26, 2, v25
  v_add_u32 v25, v25, v22
  v_mul_u32_u24 v25, 1280, v25
  v_lshl_add_u32 v74, v21, 4, v25
  s_mul_i32 s21, s20, 960
  s_add_u32 s21, s21, 704
  v_add_u32 v21, s21, v1
  v_mul_u32_u24 v22, v21, v29
  v_lshrrev_b32 v22, 22, v22
  v_mul_u32_u24 v23, 80, v22
  v_sub_u32 v21, v21, v23
  v_bfe_u32 v23, v22, 3, 1
  v_and_b32 v24, 3, v22
  v_lshl_add_u32 v23, v23, 2, v24
  v_lshlrev_b32 v23, 1, v23
  v_xor_b32 v21, v21, v23
  v_mul_u32_u24 v26, 5462, v22
  v_lshrrev_b32 v26, 16, v26
  v_mul_u32_u24 v27, 12, v26
  v_sub_u32 v22, v22, v27
  v_lshrrev_b32 v27, 2, v22
  v_and_b32 v22, 3, v22
  v_lshlrev_b32 v25, 4, v27
  v_lshl_add_u32 v25, v26, 2, v25
  v_add_u32 v25, v25, v22
  v_mul_u32_u24 v25, 1280, v25
  v_lshl_add_u32 v75, v21, 4, v25
  s_mul_i32 s21, s20, 960
  s_add_u32 s21, s21, 768
  v_add_u32 v21, s21, v1
  v_mul_u32_u24 v22, v21, v29
  v_lshrrev_b32 v22, 22, v22
  v_mul_u32_u24 v23, 80, v22
  v_sub_u32 v21, v21, v23
  v_bfe_u32 v23, v22, 3, 1
  v_and_b32 v24, 3, v22
  v_lshl_add_u32 v23, v23, 2, v24
  v_lshlrev_b32 v23, 1, v23
  v_xor_b32 v21, v21, v23
  v_mul_u32_u24 v26, 5462, v22
  v_lshrrev_b32 v26, 16, v26
  v_mul_u32_u24 v27, 12, v26
  v_sub_u32 v22, v22, v27
  v_lshrrev_b32 v27, 2, v22
  v_and_b32 v22, 3, v22
  v_lshlrev_b32 v25, 4, v27
  v_lshl_add_u32 v25, v26, 2, v25
  v_add_u32 v25, v25, v22
  v_mul_u32_u24 v25, 1280, v25
  v_lshl_add_u32 v76, v21, 4, v25
  s_mul_i32 s21, s20, 960
  s_add_u32 s21, s21, 832
  v_add_u32 v21, s21, v1
  v_mul_u32_u24 v22, v21, v29
  v_lshrrev_b32 v22, 22, v22
  v_mul_u32_u24 v23, 80, v22
  v_sub_u32 v21, v21, v23
  v_bfe_u32 v23, v22, 3, 1
  v_and_b32 v24, 3, v22
  v_lshl_add_u32 v23, v23, 2, v24
  v_lshlrev_b32 v23, 1, v23
  v_xor_b32 v21, v21, v23
  v_mul_u32_u24 v26, 5462, v22
  v_lshrrev_b32 v26, 16, v26
  v_mul_u32_u24 v27, 12, v26
  v_sub_u32 v22, v22, v27
  v_lshrrev_b32 v27, 2, v22
  v_and_b32 v22, 3, v22
  v_lshlrev_b32 v25, 4, v27
  v_lshl_add_u32 v25, v26, 2, v25
  v_add_u32 v25, v25, v22
  v_mul_u32_u24 v25, 1280, v25
  v_lshl_add_u32 v77, v21, 4, v25
  s_mul_i32 s21, s20, 960
  s_add_u32 s21, s21, 896
  v_add_u32 v21, s21, v1
  v_mul_u32_u24 v22, v21, v29
  v_lshrrev_b32 v22, 22, v22
  v_mul_u32_u24 v23, 80, v22
  v_sub_u32 v21, v21, v23
  v_bfe_u32 v23, v22, 3, 1
  v_and_b32 v24, 3, v22
  v_lshl_add_u32 v23, v23, 2, v24
  v_lshlrev_b32 v23, 1, v23
  v_xor_b32 v21, v21, v23
  v_mul_u32_u24 v26, 5462, v22
  v_lshrrev_b32 v26, 16, v26
  v_mul_u32_u24 v27, 12, v26
  v_sub_u32 v22, v22, v27
  v_lshrrev_b32 v27, 2, v22
  v_and_b32 v22, 3, v22
  v_lshlrev_b32 v25, 4, v27
  v_lshl_add_u32 v25, v26, 2, v25
  v_add_u32 v25, v25, v22
  v_mul_u32_u24 v25, 1280, v25
  v_lshl_add_u32 v78, v21, 4, v25
  s_mul_i32 s40, s2, 245760
  s_sleep 32
  s_sleep 32
  s_add_u32 s21, s40, 0
  s_mul_i32 s22, s20, 15360
  s_add_u32 s22, s22, 0
  s_add_u32 m0, s22, 0
  s_nop 0
  buffer_load_dwordx4 v64, s[12:15], s21 offen lds
  s_add_u32 m0, s22, 1024
  s_nop 0
  buffer_load_dwordx4 v65, s[12:15], s21 offen lds
  s_add_u32 m0, s22, 2048
  s_nop 0
  buffer_load_dwordx4 v66, s[12:15], s21 offen lds
  s_add_u32 m0, s22, 3072
  s_nop 0
  buffer_load_dwordx4 v67, s[12:15], s21 offen lds
  s_add_u32 m0, s22, 4096
  s_nop 0
  buffer_load_dwordx4 v68, s[12:15], s21 offen lds
  s_add_u32 m0, s22, 5120
  s_nop 0
  buffer_load_dwordx4 v69, s[12:15], s21 offen lds
  s_add_u32 m0, s22, 6144
  s_nop 0
  buffer_load_dwordx4 v70, s[12:15], s21 offen lds
  s_add_u32 m0, s22, 7168
  s_nop 0
  buffer_load_dwordx4 v71, s[12:15], s21 offen lds
  s_add_u32 m0, s22, 8192
  s_nop 0
  buffer_load_dwordx4 v72, s[12:15], s21 offen lds
  s_add_u32 m0, s22, 9216
  s_nop 0
  buffer_load_dwordx4 v73, s[12:15], s21 offen lds
  s_add_u32 m0, s22, 10240
  s_nop 0
  buffer_load_dwordx4 v74, s[12:15], s21 offen lds
  s_add_u32 m0, s22, 11264
  s_nop 0
  buffer_load_dwordx4 v75, s[12:15], s21 offen lds
  s_add_u32 m0, s22, 12288
  s_nop 0
  buffer_load_dwordx4 v76, s[12:15], s21 offen lds
  s_add_u32 m0, s22, 13312
  s_nop 0
  buffer_load_dwordx4 v77, s[12:15], s21 offen lds
  s_add_u32 m0, s22, 14336
  s_nop 0
  buffer_load_dwordx4 v78, s[12:15], s21 offen lds
  s_add_u32 s21, s40, 61440
  s_mul_i32 s22, s20, 15360
  s_add_u32 s22, s22, 61440
  s_add_u32 m0, s22, 0
  s_nop 0
  buffer_load_dwordx4 v64, s[12:15], s21 offen lds
  s_add_u32 m0, s22, 1024
  s_nop 0
  buffer_load_dwordx4 v65, s[12:15], s21 offen lds
  s_add_u32 m0, s22, 2048
  s_nop 0
  buffer_load_dwordx4 v66, s[12:15], s21 offen lds
  s_add_u32 m0, s22, 3072
  s_nop 0
  buffer_load_dwordx4 v67, s[12:15], s21 offen lds
  s_add_u32 m0, s22, 4096
  s_nop 0
  buffer_load_dwordx4 v68, s[12:15], s21 offen lds
  s_add_u32 m0, s22, 5120
  s_nop 0
  buffer_load_dwordx4 v69, s[12:15], s21 offen lds
  s_add_u32 m0, s22, 6144
  s_nop 0
  buffer_load_dwordx4 v70, s[12:15], s21 offen lds
  s_add_u32 m0, s22, 7168
  s_nop 0
  buffer_load_dwordx4 v71, s[12:15], s21 offen lds
  s_add_u32 m0, s22, 8192
  s_nop 0
  buffer_load_dwordx4 v72, s[12:15], s21 offen lds
  s_add_u32 m0, s22, 9216
  s_nop 0
  buffer_load_dwordx4 v73, s[12:15], s21 offen lds
  s_add_u32 m0, s22, 10240
  s_nop 0
  buffer_load_dwordx4 v74, s[12:15], s21 offen lds
  s_add_u32 m0, s22, 11264
  s_nop 0
  buffer_load_dwordx4 v75, s[12:15], s21 offen lds
  s_add_u32 m0, s22, 12288
  s_nop 0
  buffer_load_dwordx4 v76, s[12:15], s21 offen lds
  s_add_u32 m0, s22, 13312
  s_nop 0
  buffer_load_dwordx4 v77, s[12:15], s21 offen lds
  s_add_u32 m0, s22, 14336
  s_nop 0
  buffer_load_dwordx4 v78, s[12:15], s21 offen lds
  s_add_u32 s21, s40, 122880
  s_mul_i32 s22, s20, 15360
  s_add_u32 s22, s22, 0
  buffer_load_dwordx4 v[80:83], v64, s[12:15], s21 offen
  buffer_load_dwordx4 v[84:87], v65, s[12:15], s21 offen
  buffer_load_dwordx4 v[88:91], v66, s[12:15], s21 offen
  buffer_load_dwordx4 v[92:95], v67, s[12:15], s21 offen
  buffer_load_dwordx4 v[96:99], v68, s[12:15], s21 offen
  buffer_load_dwordx4 v[100:103], v69, s[12:15], s21 offen
  buffer_load_dwordx4 v[104:107], v70, s[12:15], s21 offen
  buffer_load_dwordx4 v[108:111], v71, s[12:15], s21 offen
  buffer_load_dwordx4 v[112:115], v72, s[12:15], s21 offen
  buffer_load_dwordx4 v[116:119], v73, s[12:15], s21 offen
  buffer_load_dwordx4 v[120:123], v74, s[12:15], s21 offen
  buffer_load_dwordx4 v[124:127], v75, s[12:15], s21 offen
  buffer_load_dwordx4 v[128:131], v76, s[12:15], s21 offen
  buffer_load_dwordx4 v[132:135], v77, s[12:15], s21 offen
  buffer_load_dwordx4 v[136:139], v78, s[12:15], s21 offen
  s_add_u32 s21, s40, 184320
  s_mul_i32 s22, s20, 15360
  s_add_u32 s22, s22, 61440
  buffer_load_dwordx4 v[140:143], v64, s[12:15], s21 offen
  buffer_load_dwordx4 v[144:147], v65, s[12:15], s21 offen
  buffer_load_dwordx4 v[148:151], v66, s[12:15], s21 offen
  buffer_load_dwordx4 v[152:155], v67, s[12:15], s21 offen
  buffer_load_dwordx4 v[156:159], v68, s[12:15], s21 offen
  buffer_load_dwordx4 v[160:163], v69, s[12:15], s21 offen
  buffer_load_dwordx4 v[164:167], v70, s[12:15], s21 offen
  buffer_load_dwordx4 v[168:171], v71, s[12:15], s21 offen
  buffer_load_dwordx4 v[172:175], v72, s[12:15], s21 offen
  buffer_load_dwordx4 v[176:179], v73, s[12:15], s21 offen
  buffer_load_dwordx4 v[180:183], v74, s[12:15], s21 offen
  buffer_load_dwordx4 v[184:187], v75, s[12:15], s21 offen
  buffer_load_dwordx4 v[188:191], v76, s[12:15], s21 offen
  buffer_load_dwordx4 v[192:195], v77, s[12:15], s21 offen
  buffer_load_dwordx4 v[196:199], v78, s[12:15], s21 offen
  v_lshrrev_b32 v6, 2, v2
  v_lshl_add_u32 v7, v3, 3, v6
  v_mul_u32_u24 v7, 1280, v7
  v_and_b32 v8, 1, v2
  v_lshl_add_u32 v7, v8, 3, v7
  v_and_b32 v8, 1, v3
  v_lshl_add_u32 v6, v8, 2, v6
  v_lshlrev_b32 v6, 1, v6
  v_bfe_u32 v8, v2, 1, 1
  s_mul_i32 s21, s20, 20
  v_add_u32 v8, s21, v8
  v_add_u32 v5, 0, v8
  v_xor_b32 v5, v5, v6
  v_lshl_add_u32 v200, v5, 4, v7
  v_add_u32 v210, 81920, v200
  v_add_u32 v5, 2, v8
  v_xor_b32 v5, v5, v6
  v_lshl_add_u32 v201, v5, 4, v7
  v_add_u32 v211, 81920, v201
  v_add_u32 v5, 4, v8
  v_xor_b32 v5, v5, v6
  v_lshl_add_u32 v202, v5, 4, v7
  v_add_u32 v212, 81920, v202
  v_add_u32 v5, 6, v8
  v_xor_b32 v5, v5, v6
  v_lshl_add_u32 v203, v5, 4, v7
  v_add_u32 v213, 81920, v203
  v_add_u32 v5, 8, v8
  v_xor_b32 v5, v5, v6
  v_lshl_add_u32 v204, v5, 4, v7
  v_add_u32 v214, 81920, v204
  v_add_u32 v5, 10, v8
  v_xor_b32 v5, v5, v6
  v_lshl_add_u32 v205, v5, 4, v7
  v_add_u32 v215, 81920, v205
  v_add_u32 v5, 12, v8
  v_xor_b32 v5, v5, v6
  v_lshl_add_u32 v206, v5, 4, v7
  v_add_u32 v216, 81920, v206
  v_add_u32 v5, 14, v8
  v_xor_b32 v5, v5, v6
  v_lshl_add_u32 v207, v5, 4, v7
  v_add_u32 v217, 81920, v207
  v_add_u32 v5, 16, v8
  v_xor_b32 v5, v5, v6
  v_lshl_add_u32 v208, v5, 4, v7
  v_add_u32 v218, 81920, v208
  v_add_u32 v5, 18, v8
  v_xor_b32 v5, v5, v6
  v_lshl_add_u32 v209, v5, 4, v7
  v_add_u32 v219, 81920, v209
  s_mul_i32 s22, s20, 15360
  v_lshl_add_u32 v30, v1, 4, s22
  v_add_u32 v31, 61440, v30
  s_waitcnt vmcnt(30)
  s_barrier
  ds_read_b64_tr_b16 a[0:1], v200 offset:0
  ds_read_b64_tr_b16 a[2:3], v200 offset:5120
  ds_read_b64_tr_b16 a[24:25], v201 offset:0
  ds_read_b64_tr_b16 a[26:27], v201 offset:5120
  ds_read_b64_tr_b16 a[48:49], v202 offset:0
  ds_read_b64_tr_b16 a[50:51], v202 offset:5120
  ds_read_b64_tr_b16 a[72:73], v203 offset:0
  ds_read_b64_tr_b16 a[74:75], v203 offset:5120
  ds_read_b64_tr_b16 a[96:97], v204 offset:0
  ds_read_b64_tr_b16 a[98:99], v204 offset:5120
  ds_read_b64_tr_b16 a[120:121], v205 offset:0
  ds_read_b64_tr_b16 a[122:123], v205 offset:5120
  ds_read_b64_tr_b16 a[144:145], v206 offset:0
  ds_read_b64_tr_b16 a[146:147], v206 offset:5120
  ds_read_b64_tr_b16 a[168:169], v207 offset:0
  ds_read_b64_tr_b16 a[170:171], v207 offset:5120
  ds_read_b64_tr_b16 a[192:193], v208 offset:0
  ds_read_b64_tr_b16 a[194:195], v208 offset:5120
  ds_read_b64_tr_b16 a[216:217], v209 offset:0
  ds_read_b64_tr_b16 a[218:219], v209 offset:5120
  ds_read_b64_tr_b16 a[4:5], v200 offset:40960
  ds_read_b64_tr_b16 a[6:7], v200 offset:46080
  ds_read_b64_tr_b16 a[28:29], v201 offset:40960
  ds_read_b64_tr_b16 a[30:31], v201 offset:46080
  ds_read_b64_tr_b16 a[52:53], v202 offset:40960
  ds_read_b64_tr_b16 a[54:55], v202 offset:46080
  ds_read_b64_tr_b16 a[76:77], v203 offset:40960
  ds_read_b64_tr_b16 a[78:79], v203 offset:46080
  ds_read_b64_tr_b16 a[100:101], v204 offset:40960
  ds_read_b64_tr_b16 a[102:103], v204 offset:46080
  ds_read_b64_tr_b16 a[124:125], v205 offset:40960
  ds_read_b64_tr_b16 a[126:127], v205 offset:46080
  ds_read_b64_tr_b16 a[148:149], v206 offset:40960
  ds_read_b64_tr_b16 a[150:151], v206 offset:46080
  ds_read_b64_tr_b16 a[172:173], v207 offset:40960
  ds_read_b64_tr_b16 a[174:175], v207 offset:46080
  ds_read_b64_tr_b16 a[196:197], v208 offset:40960
  ds_read_b64_tr_b16 a[198:199], v208 offset:46080
  ds_read_b64_tr_b16 a[220:221], v209 offset:40960
  ds_read_b64_tr_b16 a[222:223], v209 offset:46080
  ds_read_b64_tr_b16 a[8:9], v210 offset:0
  ds_read_b64_tr_b16 a[10:11], v210 offset:5120
  ds_read_b64_tr_b16 a[32:33], v211 offset:0
  ds_read_b64_tr_b16 a[34:35], v211 offset:5120
  ds_read_b64_tr_b16 a[56:57], v212 offset:0
  ds_read_b64_tr_b16 a[58:59], v212 offset:5120
  ds_read_b64_tr_b16 a[80:81], v213 offset:0
  ds_read_b64_tr_b16 a[82:83], v213 offset:5120
  ds_read_b64_tr_b16 a[104:105], v214 offset:0
  ds_read_b64_tr_b16 a[106:107], v214 offset:5120
  ds_read_b64_tr_b16 a[128:129], v215 offset:0
  ds_read_b64_tr_b16 a[130:131], v215 offset:5120
  ds_read_b64_tr_b16 a[152:153], v216 offset:0
  ds_read_b64_tr_b16 a[154:155], v216 offset:5120
  ds_read_b64_tr_b16 a[176:177], v217 offset:0
  ds_read_b64_tr_b16 a[178:179], v217 offset:5120
  ds_read_b64_tr_b16 a[200:201], v218 offset:0
  ds_read_b64_tr_b16 a[202:203], v218 offset:5120
  ds_read_b64_tr_b16 a[224:225], v219 offset:0
  ds_read_b64_tr_b16 a[226:227], v219 offset:5120
  s_waitcnt lgkmcnt(0)
  s_barrier
  s_waitcnt vmcnt(15)
  ds_write_b128 v30, v[80:83] offset:0
  ds_write_b128 v30, v[84:87] offset:1024
  ds_write_b128 v30, v[88:91] offset:2048
  ds_write_b128 v30, v[92:95] offset:3072
  ds_write_b128 v30, v[96:99] offset:4096
  ds_write_b128 v30, v[100:103] offset:5120
  ds_write_b128 v30, v[104:107] offset:6144
  ds_write_b128 v30, v[108:111] offset:7168
  ds_write_b128 v30, v[112:115] offset:8192
  ds_write_b128 v30, v[116:119] offset:9216
  ds_write_b128 v30, v[120:123] offset:10240
  ds_write_b128 v30, v[124:127] offset:11264
  ds_write_b128 v30, v[128:131] offset:12288
  ds_write_b128 v30, v[132:135] offset:13312
  ds_write_b128 v30, v[136:139] offset:14336
  s_waitcnt vmcnt(0)
  ds_write_b128 v31, v[140:143] offset:0
  ds_write_b128 v31, v[144:147] offset:1024
  ds_write_b128 v31, v[148:151] offset:2048
  ds_write_b128 v31, v[152:155] offset:3072
  ds_write_b128 v31, v[156:159] offset:4096
  ds_write_b128 v31, v[160:163] offset:5120
  ds_write_b128 v31, v[164:167] offset:6144
  ds_write_b128 v31, v[168:171] offset:7168
  ds_write_b128 v31, v[172:175] offset:8192
  ds_write_b128 v31, v[176:179] offset:9216
  ds_write_b128 v31, v[180:183] offset:10240
  ds_write_b128 v31, v[184:187] offset:11264
  ds_write_b128 v31, v[188:191] offset:12288
  ds_write_b128 v31, v[192:195] offset:13312
  ds_write_b128 v31, v[196:199] offset:14336
  s_waitcnt lgkmcnt(0)
  s_barrier
  ds_read_b64_tr_b16 a[12:13], v200 offset:0
  ds_read_b64_tr_b16 a[14:15], v200 offset:5120
  ds_read_b64_tr_b16 a[36:37], v201 offset:0
  ds_read_b64_tr_b16 a[38:39], v201 offset:5120
  ds_read_b64_tr_b16 a[60:61], v202 offset:0
  ds_read_b64_tr_b16 a[62:63], v202 offset:5120
  ds_read_b64_tr_b16 a[84:85], v203 offset:0
  ds_read_b64_tr_b16 a[86:87], v203 offset:5120
  ds_read_b64_tr_b16 a[108:109], v204 offset:0
  ds_read_b64_tr_b16 a[110:111], v204 offset:5120
  ds_read_b64_tr_b16 a[132:133], v205 offset:0
  ds_read_b64_tr_b16 a[134:135], v205 offset:5120
  ds_read_b64_tr_b16 a[156:157], v206 offset:0
  ds_read_b64_tr_b16 a[158:159], v206 offset:5120
  ds_read_b64_tr_b16 a[180:181], v207 offset:0
  ds_read_b64_tr_b16 a[182:183], v207 offset:5120
  ds_read_b64_tr_b16 a[204:205], v208 offset:0
  ds_read_b64_tr_b16 a[206:207], v208 offset:5120
  ds_read_b64_tr_b16 a[228:229], v209 offset:0
  ds_read_b64_tr_b16 a[230:231], v209 offset:5120
  ds_read_b64_tr_b16 a[16:17], v200 offset:40960
  ds_read_b64_tr_b16 a[18:19], v200 offset:46080
  ds_read_b64_tr_b16 a[40:41], v201 offset:40960
  ds_read_b64_tr_b16 a[42:43], v201 offset:46080
  ds_read_b64_tr_b16 a[64:65], v202 offset:40960
  ds_read_b64_tr_b16 a[66:67], v202 offset:46080
  ds_read_b64_tr_b16 a[88:89], v203 offset:40960
  ds_read_b64_tr_b16 a[90:91], v203 offset:46080
  ds_read_b64_tr_b16 a[112:113], v204 offset:40960
  ds_read_b64_tr_b16 a[114:115], v204 offset:46080
  ds_read_b64_tr_b16 a[136:137], v205 offset:40960
  ds_read_b64_tr_b16 a[138:139], v205 offset:46080
  ds_read_b64_tr_b16 a[160:161], v206 offset:40960
  ds_read_b64_tr_b16 a[162:163], v206 offset:46080
  ds_read_b64_tr_b16 a[184:185], v207 offset:40960
  ds_read_b64_tr_b16 a[186:187], v207 offset:46080
  ds_read_b64_tr_b16 a[208:209], v208 offset:40960
  ds_read_b64_tr_b16 a[210:211], v208 offset:46080
  ds_read_b64_tr_b16 a[232:233], v209 offset:40960
  ds_read_b64_tr_b16 a[234:235], v209 offset:46080
  ds_read_b64_tr_b16 a[20:21], v210 offset:0
  ds_read_b64_tr_b16 a[22:23], v210 offset:5120
  ds_read_b64_tr_b16 a[44:45], v211 offset:0
  ds_read_b64_tr_b16 a[46:47], v211 offset:5120
  ds_read_b64_tr_b16 a[68:69], v212 offset:0
  ds_read_b64_tr_b16 a[70:71], v212 offset:5120
  ds_read_b64_tr_b16 a[92:93], v213 offset:0
  ds_read_b64_tr_b16 a[94:95], v213 offset:5120
  ds_read_b64_tr_b16 a[116:117], v214 offset:0
  ds_read_b64_tr_b16 a[118:119], v214 offset:5120
  ds_read_b64_tr_b16 a[140:141], v215 offset:0
  ds_read_b64_tr_b16 a[142:143], v215 offset:5120
  ds_read_b64_tr_b16 a[164:165], v216 offset:0
  ds_read_b64_tr_b16 a[166:167], v216 offset:5120
  ds_read_b64_tr_b16 a[188:189], v217 offset:0
  ds_read_b64_tr_b16 a[190:191], v217 offset:5120
  ds_read_b64_tr_b16 a[212:213], v218 offset:0
  ds_read_b64_tr_b16 a[214:215], v218 offset:5120
  ds_read_b64_tr_b16 a[236:237], v219 offset:0
  ds_read_b64_tr_b16 a[238:239], v219 offset:5120
  s_waitcnt lgkmcnt(0)
  s_barrier
  s_load_dwordx2 s[32:33], s[0:1], 96
  s_waitcnt lgkmcnt(0)
  s_mov_b32 s32, s32
  s_mov_b32 s33, s33
  s_mov_b32 s34, 256
  s_mov_b32 s35, 0x00020000
  s_mov_b32 s21, 76
  s_cmp_lg_u32 s20, 0
  s_cbranch_scc1 wf_148
  v_mov_b32 v4, 0
  s_mov_b32 s101, 0
wf_147:
  buffer_load_dword v5, v4, s[32:35], s21 offen sc1
  s_add_u32 s101, s101, 1
  s_cmp_gt_u32 s101, 131072
  s_cbranch_scc1 main_end
  s_waitcnt vmcnt(0)
  v_readfirstlane_b32 s100, v5
  s_cmp_ge_u32 s100, 32
  s_cbranch_scc1 wf_148
  s_sleep 8
  s_branch wf_147
wf_148:
  s_barrier
  s_mul_i32 s41, s2, 12288
  s_add_u32 s47, s41, 25165824
  s_mov_b32 s41, s47
  s_mul_i32 s21, s20, 10
  s_mul_i32 s47, s2, 5
  s_lshr_b32 s22, s21, 3
  s_add_u32 s47, s47, s22
  s_and_b32 s48, s21, 7
  s_mov_b32 s66, 0
  s_mov_b32 s67, 0
  s_lshr_b32 s43, s2, 2
  s_lshl_b32 s43, s43, 7
  s_add_u32 s43, s43, 0
  s_lshl_b32 s44, s2, 7
  s_lshl_b32 s21, s20, 2
  s_add_u32 s44, s44, s21
  s_add_u32 s44, s44, 96256
  s_mov_b32 s45, 0
  s_mov_b32 s49, 1
  s_mov_b32 s50, 0
  v_mov_b32 v10, 0
  v_mov_b32 v11, 1
  v_lshlrev_b32 v4, 4, v1
  s_add_u32 s76, s38, 56623104
  s_addc_u32 s77, s39, 0
  s_mov_b32 s78, 6291456
  s_mov_b32 s79, 0x00020000
  s_add_u32 s80, s38, 93323264
  s_addc_u32 s81, s39, 0
  s_mov_b32 s82, 20971520
  s_mov_b32 s83, 0x00020000
  v_and_b32 v12, 3, v1
  v_lshlrev_b32 v12, 3, v12
  v_add_u32 v12, 4, v12
  v_and_b32 v13, 7, v2
  v_lshlrev_b32 v13, 4, v13
  v_lshl_add_u32 v13, v3, 7, v13
  v_lshrrev_b32 v14, 3, v2
  v_mul_u32_u24 v14, 98304, v14
  v_add_u32 v14, v14, v13
  v_and_b32 v15, 1, v3
  v_lshlrev_b32 v15, 8, v15
  v_lshl_add_u32 v15, v2, 4, v15
  v_lshrrev_b32 v16, 1, v3
  v_mul_u32_u24 v16, 327680, v16
  v_add_u32 v15, v15, v16
  v_lshlrev_b32 v17, 10, v1
  v_mov_b32 v19, 0
  s_lshl_b32 s53, s2, 7
  s_add_u32 s53, s53, 20480
  s_mov_b32 s55, 0
  s_mov_b32 s56, 0
  s_mov_b32 s58, 0
  s_mov_b32 s59, 0
  s_add_u32 s84, s38, 50331648
  s_addc_u32 s85, s39, 0
  s_mov_b32 s86, 12582912
  s_mov_b32 s87, 0x00020000
  s_and_b32 s21, s2, 3
  s_mul_i32 s51, s2, 3072
  s_cmp_eq_u32 s21, s20
  s_cselect_b32 s51, s51, 6291456
  v_mov_b32 v244, -1
  v_mov_b32 v245, -1
  v_mov_b32 v246, -1
  v_mov_b32 v247, -1
  s_add_u32 s88, s38, 85983232
  s_addc_u32 s89, s39, 0
  s_mov_b32 s90, 5242880
  s_mov_b32 s91, 0x00020000
  s_mul_i32 s21, s20, 3072
  s_add_u32 s41, s41, s21
  s_mov_b32 s64, s21
  s_add_u32 s67, s21, 98304
  s_mov_b32 s71, s21
  s_mov_b32 s46, 0
  s_mov_b32 s47, 0
  s_mov_b32 s65, 0
  s_mul_i32 s42, s2, 40960
  s_mul_i32 s21, s20, 10240
  s_add_u32 s42, s42, s21
  s_mov_b32 s68, 0x80000000
  s_mov_b32 s70, 0
  s_mov_b32 s40, 0
  v_min_u32 v5, 19, v1
  v_lshlrev_b32 v5, 10, v5
  v_mov_b32 v9, 0
  s_lshl_b32 s21, s20, 2
  s_add_u32 s21, s21, 110592
  v_mov_b32 v6, s21
  v_mov_b32 v7, 110592
  s_mul_i32 s51, s2, 3072
  s_lshl_b32 s21, s20, 10
  s_add_u32 s51, s51, s21
  s_cmp_lt_u32 s20, 3
  s_cselect_b32 s51, s51, 6291456
  s_add_u32 s51, s51, 294912
  s_cmp_lg_u32 s20, 0
  s_cbranch_scc1 wf_150
  v_mov_b32 v20, 0
  s_mov_b32 s101, 0
wf_149:
  buffer_load_dword v21, v20, s[72:75], s43 offen sc1
  s_add_u32 s101, s101, 1
  s_cmp_gt_u32 s101, 131072
  s_cbranch_scc1 main_end
  s_waitcnt vmcnt(0)
  v_readfirstlane_b32 s100, v21
  s_cmp_ge_u32 s100, 8
  s_cbranch_scc1 wf_150
  s_sleep 4
  s_branch wf_149
wf_150:
  s_barrier
  v_writelane_b32 v9, 8, 0
  v_cmp_gt_u32 vcc, 8, v9
  s_nop 0
  s_bitset1_b64 vcc, 20
  s_ff1_i32_b64 s21, vcc
  s_lshl_b32 s22, s21, 1
  s_lshl_b32 s21, s21, 2
  s_sub_i32 s21, s21, 16
  s_max_i32 s47, s21, s22
  s_cmp_gt_u32 s47, s45
  s_cbranch_scc1 va_151
  s_mov_b32 s101, 0
  s_branch va_154
va_152:
  s_sleep 8
va_154:
  buffer_load_dword v9, v5, s[72:75], s43 offen sc1
  s_add_u32 s101, s101, 1
  s_cmp_gt_u32 s101, 131072
  s_cbranch_scc1 main_end
  s_waitcnt vmcnt(0)
  v_cmp_gt_u32 vcc, 8, v9
  s_nop 0
  s_bitset1_b64 vcc, 20
  s_ff1_i32_b64 s21, vcc
  s_lshl_b32 s22, s21, 1
  s_lshl_b32 s21, s21, 2
  s_sub_i32 s21, s21, 16
  s_max_i32 s47, s21, s22
  s_cmp_gt_u32 s47, s45
  s_cbranch_scc0 va_152
va_151:
  s_add_u32 s22, s45, 6
  s_min_u32 s22, s22, s47
va_153:
  s_cmp_ge_u32 s46, s22
  s_cbranch_scc1 va_155
  s_mov_b32 m0, s64
  s_mov_b32 s66, s41
  buffer_load_dwordx4 v4, s[16:19], s66 offen offset:0 sc1 lds
  buffer_load_dwordx4 v4, s[16:19], s66 offen offset:1024 sc1 lds
  buffer_load_dwordx4 v4, s[16:19], s66 offen offset:2048 sc1 lds
  s_add_u32 s46, s46, 1
  s_add_u32 s41, s41, 393216
  s_add_u32 s64, s64, 12288
  s_cmp_lt_u32 s64, s67
  s_cselect_b32 s64, s64, s71
  s_branch va_153
va_155:
  s_mov_b32 s48, s46
  s_mov_b32 s49, s46
  s_mov_b32 s50, s46
  s_waitcnt vmcnt(0)
  s_barrier
  v_mov_b32 v8, v4
  s_add_u32 s65, s65, 12288
  s_cmp_lt_u32 s65, 98304
  s_cselect_b32 s65, s65, 0
  ds_read_b128 v[144:147], v8 offset:0
  ds_read_b128 v[148:151], v8 offset:1024
  ds_read_b128 v[152:155], v8 offset:2048
  ds_read_b128 v[156:159], v8 offset:3072
  ds_read_b128 v[160:163], v8 offset:4096
  ds_read_b128 v[164:167], v8 offset:5120
  ds_read_b128 v[168:171], v8 offset:6144
  ds_read_b128 v[172:175], v8 offset:7168
  ds_read_b128 v[176:179], v8 offset:8192
  ds_read_b128 v[180:183], v8 offset:9216
  ds_read_b128 v[184:187], v8 offset:10240
  ds_read_b128 v[188:191], v8 offset:11264
  s_add_u32 s21, s45, 1
  s_min_u32 s21, s21, 63
  s_cmp_lt_u32 s21, s50
  s_cselect_b32 s21, 1, 0
  v_mov_b32 v21, s21
  ds_write_b32 v6, v21 offset:0
vwl_156:
  s_waitcnt lgkmcnt(0)
  s_barrier
  v_mfma_f32_16x16x32_bf16 v[64:67], v[144:147], a[0:3], 0
  v_add_u32 v8, s65, v4
  v_mfma_f32_16x16x32_bf16 v[72:75], v[144:147], a[24:27], 0
  ds_read_b128 v[240:243], v7 offset:0
  v_mfma_f32_16x16x32_bf16 v[80:83], v[144:147], a[48:51], 0
  ds_read_b128 v[192:195], v8 offset:0
  s_add_u32 s65, s65, 12288
  v_mfma_f32_16x16x32_bf16 v[88:91], v[144:147], a[72:75], 0
  v_cvt_pk_bf16_f32 v44, v104, v105
  v_mfma_f32_16x16x32_bf16 v[96:99], v[144:147], a[96:99], 0
  s_cmp_lt_u32 s65, 98304
  s_cselect_b32 s65, s65, 0
  v_mfma_f32_16x16x32_bf16 v[68:71], v[168:171], a[0:3], 0
  v_cvt_pk_bf16_f32 v45, v106, v107
  v_mfma_f32_16x16x32_bf16 v[76:79], v[168:171], a[24:27], 0
  v_cmp_gt_u32 vcc, 8, v9
  s_nop 0
  v_mfma_f32_16x16x32_bf16 v[84:87], v[168:171], a[48:51], 0
  v_cvt_pk_bf16_f32 v46, v108, v109
  s_bitset1_b64 vcc, 20
  v_mfma_f32_16x16x32_bf16 v[92:95], v[168:171], a[72:75], 0
  s_ff1_i32_b64 s21, vcc
  s_lshl_b32 s22, s21, 1
  v_mfma_f32_16x16x32_bf16 v[100:103], v[168:171], a[96:99], 0
  ds_read_b128 v[196:199], v8 offset:1024
  v_cvt_pk_bf16_f32 v47, v110, v111
  v_mfma_f32_16x16x32_bf16 v[64:67], v[148:151], a[4:7], v[64:67]
  s_lshl_b32 s21, s21, 2
  s_sub_i32 s21, s21, 16
  v_mfma_f32_16x16x32_bf16 v[72:75], v[148:151], a[28:31], v[72:75]
  s_add_u32 s69, s68, 4096
  s_max_i32 s47, s21, s22
  v_mfma_f32_16x16x32_bf16 v[80:83], v[148:151], a[52:55], v[80:83]
  s_add_u32 s22, s45, 7
  s_min_u32 s22, s22, s47
  v_mfma_f32_16x16x32_bf16 v[88:91], v[148:151], a[76:79], v[88:91]
  buffer_store_dwordx4 v[44:47], v4, s[24:27], s69 offen offset:1024 sc1
  v_mfma_f32_16x16x32_bf16 v[96:99], v[148:151], a[100:103], v[96:99]
  s_cmp_lt_u32 s46, s22
  s_cselect_b32 s66, s41, 0x80000000
  s_cselect_b32 m0, s64, 98304
  s_cselect_b32 s22, 1, 0
  v_mfma_f32_16x16x32_bf16 v[68:71], v[172:175], a[4:7], v[68:71]
  v_cvt_pk_bf16_f32 v48, v112, v113
  v_mfma_f32_16x16x32_bf16 v[76:79], v[172:175], a[28:31], v[76:79]
  ds_read_b128 v[200:203], v8 offset:2048
  v_mfma_f32_16x16x32_bf16 v[84:87], v[172:175], a[52:55], v[84:87]
  v_cvt_pk_bf16_f32 v49, v114, v115
  v_mfma_f32_16x16x32_bf16 v[92:95], v[172:175], a[76:79], v[92:95]
  buffer_load_dword v9, v5, s[72:75], s43 offen sc1
  v_mfma_f32_16x16x32_bf16 v[100:103], v[172:175], a[100:103], v[100:103]
  v_cvt_pk_bf16_f32 v50, v116, v117
  v_mfma_f32_16x16x32_bf16 v[64:67], v[152:155], a[8:11], v[64:67]
  v_mfma_f32_16x16x32_bf16 v[72:75], v[152:155], a[32:35], v[72:75]
  v_cvt_pk_bf16_f32 v51, v118, v119
  v_mfma_f32_16x16x32_bf16 v[80:83], v[152:155], a[56:59], v[80:83]
  buffer_load_dwordx4 v4, s[16:19], s66 offen offset:0 sc1 lds
  v_mfma_f32_16x16x32_bf16 v[88:91], v[152:155], a[80:83], v[88:91]
  ds_read_b128 v[204:207], v8 offset:3072
  v_mfma_f32_16x16x32_bf16 v[96:99], v[152:155], a[104:107], v[96:99]
  buffer_store_dwordx4 v[48:51], v4, s[24:27], s69 offen offset:2048 sc1
  v_mfma_f32_16x16x32_bf16 v[68:71], v[176:179], a[8:11], v[68:71]
  v_cvt_pk_bf16_f32 v52, v120, v121
  v_mfma_f32_16x16x32_bf16 v[76:79], v[176:179], a[32:35], v[76:79]
  v_mfma_f32_16x16x32_bf16 v[84:87], v[176:179], a[56:59], v[84:87]
  v_cvt_pk_bf16_f32 v53, v122, v123
  v_mfma_f32_16x16x32_bf16 v[92:95], v[176:179], a[80:83], v[92:95]
  buffer_load_dwordx4 v4, s[16:19], s66 offen offset:1024 sc1 lds
  v_mfma_f32_16x16x32_bf16 v[100:103], v[176:179], a[104:107], v[100:103]
  v_cvt_pk_bf16_f32 v54, v124, v125
  v_mfma_f32_16x16x32_bf16 v[64:67], v[156:159], a[12:15], v[64:67]
  ds_read_b128 v[208:211], v8 offset:4096
  v_mfma_f32_16x16x32_bf16 v[72:75], v[156:159], a[36:39], v[72:75]
  v_cvt_pk_bf16_f32 v55, v126, v127
  v_mfma_f32_16x16x32_bf16 v[80:83], v[156:159], a[60:63], v[80:83]
  v_mfma_f32_16x16x32_bf16 v[88:91], v[156:159], a[84:87], v[88:91]
  buffer_store_dwordx4 v[52:55], v4, s[24:27], s69 offen offset:3072 sc1
  v_mfma_f32_16x16x32_bf16 v[96:99], v[156:159], a[108:111], v[96:99]
  buffer_load_dwordx4 v4, s[16:19], s66 offen offset:2048 sc1 lds
  v_mfma_f32_16x16x32_bf16 v[68:71], v[180:183], a[12:15], v[68:71]
  v_cvt_pk_bf16_f32 v56, v128, v129
  s_add_u32 s46, s46, s22
  v_mfma_f32_16x16x32_bf16 v[76:79], v[180:183], a[36:39], v[76:79]
  s_mul_i32 s21, s22, 393216
  s_add_u32 s41, s41, s21
  v_mfma_f32_16x16x32_bf16 v[84:87], v[180:183], a[60:63], v[84:87]
  ds_read_b128 v[212:215], v8 offset:5120
  v_cvt_pk_bf16_f32 v57, v130, v131
  v_mfma_f32_16x16x32_bf16 v[92:95], v[180:183], a[84:87], v[92:95]
  s_mul_i32 s21, s22, 12288
  s_add_u32 s64, s64, s21
  v_mfma_f32_16x16x32_bf16 v[100:103], v[180:183], a[108:111], v[100:103]
  v_cvt_pk_bf16_f32 v58, v132, v133
  v_mfma_f32_16x16x32_bf16 v[64:67], v[160:163], a[16:19], v[64:67]
  s_cmp_lt_u32 s64, s67
  s_cselect_b32 s64, s64, s71
  v_mfma_f32_16x16x32_bf16 v[72:75], v[160:163], a[40:43], v[72:75]
  v_cvt_pk_bf16_f32 v59, v134, v135
  v_mfma_f32_16x16x32_bf16 v[80:83], v[160:163], a[64:67], v[80:83]
  v_mfma_f32_16x16x32_bf16 v[88:91], v[160:163], a[88:91], v[88:91]
  s_add_u32 s69, s68, 8192
  v_mfma_f32_16x16x32_bf16 v[96:99], v[160:163], a[112:115], v[96:99]
  ds_read_b128 v[216:219], v8 offset:6144
  v_mfma_f32_16x16x32_bf16 v[68:71], v[184:187], a[16:19], v[68:71]
  buffer_store_dwordx4 v[56:59], v4, s[24:27], s69 offen offset:0 sc1
  v_mfma_f32_16x16x32_bf16 v[76:79], v[184:187], a[40:43], v[76:79]
  v_mfma_f32_16x16x32_bf16 v[84:87], v[184:187], a[64:67], v[84:87]
  v_cvt_pk_bf16_f32 v60, v136, v137
  v_mfma_f32_16x16x32_bf16 v[92:95], v[184:187], a[88:91], v[92:95]
  v_mfma_f32_16x16x32_bf16 v[100:103], v[184:187], a[112:115], v[100:103]
  v_cvt_pk_bf16_f32 v61, v138, v139
  v_mfma_f32_16x16x32_bf16 v[64:67], v[164:167], a[20:23], v[64:67]
  v_mfma_f32_16x16x32_bf16 v[72:75], v[164:167], a[44:47], v[72:75]
  ds_read_b128 v[220:223], v8 offset:7168
  v_cvt_pk_bf16_f32 v62, v140, v141
  v_mfma_f32_16x16x32_bf16 v[80:83], v[164:167], a[68:71], v[80:83]
  v_mfma_f32_16x16x32_bf16 v[88:91], v[164:167], a[92:95], v[88:91]
  v_cvt_pk_bf16_f32 v63, v142, v143
  v_mfma_f32_16x16x32_bf16 v[96:99], v[164:167], a[116:119], v[96:99]
  v_mfma_f32_16x16x32_bf16 v[68:71], v[188:191], a[20:23], v[68:71]
  buffer_store_dwordx4 v[60:63], v4, s[24:27], s69 offen offset:1024 sc1
  v_mfma_f32_16x16x32_bf16 v[76:79], v[188:191], a[44:47], v[76:79]
  v_mfma_f32_16x16x32_bf16 v[84:87], v[188:191], a[68:71], v[84:87]
  v_mfma_f32_16x16x32_bf16 v[92:95], v[188:191], a[92:95], v[92:95]
  ds_read_b128 v[224:227], v8 offset:8192
  v_mfma_f32_16x16x32_bf16 v[100:103], v[188:191], a[116:119], v[100:103]
  v_mfma_f32_16x16x32_bf16 v[104:107], v[144:147], a[120:123], 0
  v_mfma_f32_16x16x32_bf16 v[112:115], v[144:147], a[144:147], 0
  v_mfma_f32_16x16x32_bf16 v[120:123], v[144:147], a[168:171], 0
  v_mfma_f32_16x16x32_bf16 v[128:131], v[144:147], a[192:195], 0
  v_cvt_pk_bf16_f32 v24, v64, v65
  v_mfma_f32_16x16x32_bf16 v[136:139], v[144:147], a[216:219], 0
  v_mfma_f32_16x16x32_bf16 v[108:111], v[168:171], a[120:123], 0
  ds_read_b128 v[228:231], v8 offset:9216
  v_cvt_pk_bf16_f32 v25, v66, v67
  v_mfma_f32_16x16x32_bf16 v[116:119], v[168:171], a[144:147], 0
  s_cmp_lt_u32 s51, 6291456
  s_cselect_b32 s52, s51, 0x80000000
  v_mfma_f32_16x16x32_bf16 v[124:127], v[168:171], a[168:171], 0
  v_cvt_pk_bf16_f32 v26, v68, v69
  v_mfma_f32_16x16x32_bf16 v[132:135], v[168:171], a[192:195], 0
  buffer_store_dwordx4 v[244:247], v4, s[84:87], s52 offen sc1
  v_mfma_f32_16x16x32_bf16 v[140:143], v[168:171], a[216:219], 0
  v_cvt_pk_bf16_f32 v27, v70, v71
  s_add_u32 s52, s52, 6291456
  v_mfma_f32_16x16x32_bf16 v[104:107], v[148:151], a[124:127], v[104:107]
  s_add_u32 s51, s51, 98304
  v_mfma_f32_16x16x32_bf16 v[112:115], v[148:151], a[148:151], v[112:115]
  buffer_store_dwordx4 v[24:27], v4, s[24:27], s42 offen offset:0 sc1
  v_mfma_f32_16x16x32_bf16 v[120:123], v[148:151], a[172:175], v[120:123]
  ds_read_b128 v[232:235], v8 offset:10240
  v_mfma_f32_16x16x32_bf16 v[128:131], v[148:151], a[196:199], v[128:131]
  v_cvt_pk_bf16_f32 v28, v72, v73
  v_mfma_f32_16x16x32_bf16 v[136:139], v[148:151], a[220:223], v[136:139]
  v_cvt_pk_bf16_f32 v29, v74, v75
  v_mfma_f32_16x16x32_bf16 v[108:111], v[172:175], a[124:127], v[108:111]
  s_cmp_lg_u32 s40, 0
  s_cbranch_scc1 vwm_158
vwm_159:
  v_mfma_f32_16x16x32_bf16 v[116:119], v[172:175], a[148:151], v[116:119]
  v_cvt_pk_bf16_f32 v30, v76, v77
  v_mfma_f32_16x16x32_bf16 v[124:127], v[172:175], a[172:175], v[124:127]
  v_mfma_f32_16x16x32_bf16 v[132:135], v[172:175], a[196:199], v[132:135]
  v_cvt_pk_bf16_f32 v31, v78, v79
  v_mfma_f32_16x16x32_bf16 v[140:143], v[172:175], a[220:223], v[140:143]
  ds_read_b128 v[236:239], v8 offset:11264
  v_mfma_f32_16x16x32_bf16 v[104:107], v[152:155], a[128:131], v[104:107]
  buffer_store_dwordx4 v[28:31], v4, s[24:27], s42 offen offset:1024 sc1
  v_mfma_f32_16x16x32_bf16 v[112:115], v[152:155], a[152:155], v[112:115]
  v_mfma_f32_16x16x32_bf16 v[120:123], v[152:155], a[176:179], v[120:123]
  v_cvt_pk_bf16_f32 v32, v80, v81
  v_mfma_f32_16x16x32_bf16 v[128:131], v[152:155], a[200:203], v[128:131]
  v_mfma_f32_16x16x32_bf16 v[136:139], v[152:155], a[224:227], v[136:139]
  v_cvt_pk_bf16_f32 v33, v82, v83
  v_mfma_f32_16x16x32_bf16 v[108:111], v[176:179], a[128:131], v[108:111]
  v_cvt_pk_bf16_f32 v34, v84, v85
  v_mfma_f32_16x16x32_bf16 v[116:119], v[176:179], a[152:155], v[116:119]
  buffer_store_dwordx4 v[244:247], v4, s[84:87], s52 offen sc1
  v_mfma_f32_16x16x32_bf16 v[124:127], v[176:179], a[176:179], v[124:127]
  v_cvt_pk_bf16_f32 v35, v86, v87
  v_mfma_f32_16x16x32_bf16 v[132:135], v[176:179], a[200:203], v[132:135]
  v_mfma_f32_16x16x32_bf16 v[140:143], v[176:179], a[224:227], v[140:143]
  buffer_store_dwordx4 v[32:35], v4, s[24:27], s42 offen offset:2048 sc1
  v_mfma_f32_16x16x32_bf16 v[104:107], v[156:159], a[132:135], v[104:107]
  v_mfma_f32_16x16x32_bf16 v[112:115], v[156:159], a[156:159], v[112:115]
  v_cvt_pk_bf16_f32 v36, v88, v89
  v_mfma_f32_16x16x32_bf16 v[120:123], v[156:159], a[180:183], v[120:123]
  v_mfma_f32_16x16x32_bf16 v[128:131], v[156:159], a[204:207], v[128:131]
  v_cvt_pk_bf16_f32 v37, v90, v91
  v_mfma_f32_16x16x32_bf16 v[136:139], v[156:159], a[228:231], v[136:139]
  v_mfma_f32_16x16x32_bf16 v[108:111], v[180:183], a[132:135], v[108:111]
  v_cvt_pk_bf16_f32 v38, v92, v93
  v_mfma_f32_16x16x32_bf16 v[116:119], v[180:183], a[156:159], v[116:119]
  v_cvt_pk_bf16_f32 v39, v94, v95
  v_mfma_f32_16x16x32_bf16 v[124:127], v[180:183], a[180:183], v[124:127]
  v_mfma_f32_16x16x32_bf16 v[132:135], v[180:183], a[204:207], v[132:135]
  buffer_store_dwordx4 v[36:39], v4, s[24:27], s42 offen offset:3072 sc1
  v_mfma_f32_16x16x32_bf16 v[140:143], v[180:183], a[228:231], v[140:143]
  v_mfma_f32_16x16x32_bf16 v[104:107], v[160:163], a[136:139], v[104:107]
  v_cvt_pk_bf16_f32 v40, v96, v97
  s_waitcnt lgkmcnt(0)
  v_mfma_f32_16x16x32_bf16 v[112:115], v[160:163], a[160:163], v[112:115]
  v_and_b32 v240, v240, v241
  v_and_b32 v242, v242, v243
  v_mfma_f32_16x16x32_bf16 v[120:123], v[160:163], a[184:187], v[120:123]
  v_cvt_pk_bf16_f32 v41, v98, v99
  v_and_b32 v240, v240, v242
  v_mfma_f32_16x16x32_bf16 v[128:131], v[160:163], a[208:211], v[128:131]
  s_nop 0
  v_readfirstlane_b32 s23, v240
  v_mfma_f32_16x16x32_bf16 v[136:139], v[160:163], a[232:235], v[136:139]
  v_cvt_pk_bf16_f32 v42, v100, v101
  v_mfma_f32_16x16x32_bf16 v[108:111], v[184:187], a[136:139], v[108:111]
  v_mfma_f32_16x16x32_bf16 v[116:119], v[184:187], a[160:163], v[116:119]
  v_cvt_pk_bf16_f32 v43, v102, v103
  v_mfma_f32_16x16x32_bf16 v[124:127], v[184:187], a[184:187], v[124:127]
  s_add_u32 s69, s42, 4096
  v_mfma_f32_16x16x32_bf16 v[132:135], v[184:187], a[208:211], v[132:135]
  v_mfma_f32_16x16x32_bf16 v[140:143], v[184:187], a[232:235], v[140:143]
  buffer_store_dwordx4 v[40:43], v4, s[24:27], s69 offen offset:0 sc1
  v_mfma_f32_16x16x32_bf16 v[104:107], v[164:167], a[140:143], v[104:107]
  v_mfma_f32_16x16x32_bf16 v[112:115], v[164:167], a[164:167], v[112:115]
  v_mfma_f32_16x16x32_bf16 v[120:123], v[164:167], a[188:191], v[120:123]
  s_waitcnt vmcnt(16)
  s_mov_b32 s50, s48
  s_mov_b32 s49, s48
  v_mfma_f32_16x16x32_bf16 v[128:131], v[164:167], a[212:215], v[128:131]
  s_mov_b32 s48, s46
  s_sub_i32 s69, s45, 1
  s_max_i32 s69, s69, s70
  v_mfma_f32_16x16x32_bf16 v[136:139], v[164:167], a[236:239], v[136:139]
  s_add_u32 s45, s45, 1
  s_mov_b32 s68, s42
  s_add_u32 s42, s42, 1310720
  v_mfma_f32_16x16x32_bf16 v[108:111], v[188:191], a[140:143], v[108:111]
  s_add_u32 s21, s45, 1
  s_min_u32 s21, s21, 63
  v_mfma_f32_16x16x32_bf16 v[116:119], v[188:191], a[164:167], v[116:119]
  s_cmp_lt_u32 s21, s50
  s_cselect_b32 s21, 1, 0
  v_mov_b32 v21, s21
  v_mfma_f32_16x16x32_bf16 v[124:127], v[188:191], a[188:191], v[124:127]
  ds_write_b32 v6, v21 offset:16
  v_mfma_f32_16x16x32_bf16 v[132:135], v[188:191], a[212:215], v[132:135]
  v_mfma_f32_16x16x32_bf16 v[140:143], v[188:191], a[236:239], v[140:143]
  s_mov_b64 exec, 1
  v_mov_b32 v20, s69
  buffer_store_dword v20, v10, s[72:75], s44 offen sc1
  s_mov_b64 exec, -1
  s_cmp_le_u32 s45, 8
  s_cbranch_scc1 vwe_162
vwe_163:
  s_cmp_eq_u32 s23, 0
  s_cbranch_scc1 vws_160
vwb_161:
  s_waitcnt lgkmcnt(0)
  s_barrier
  v_mfma_f32_16x16x32_bf16 v[64:67], v[192:195], a[0:3], 0
  v_add_u32 v8, s65, v4
  v_mfma_f32_16x16x32_bf16 v[72:75], v[192:195], a[24:27], 0
  ds_read_b128 v[240:243], v7 offset:16
  v_mfma_f32_16x16x32_bf16 v[80:83], v[192:195], a[48:51], 0
  ds_read_b128 v[144:147], v8 offset:0
  s_add_u32 s65, s65, 12288
  v_mfma_f32_16x16x32_bf16 v[88:91], v[192:195], a[72:75], 0
  v_cvt_pk_bf16_f32 v44, v104, v105
  v_mfma_f32_16x16x32_bf16 v[96:99], v[192:195], a[96:99], 0
  s_cmp_lt_u32 s65, 98304
  s_cselect_b32 s65, s65, 0
  v_mfma_f32_16x16x32_bf16 v[68:71], v[216:219], a[0:3], 0
  v_cvt_pk_bf16_f32 v45, v106, v107
  v_mfma_f32_16x16x32_bf16 v[76:79], v[216:219], a[24:27], 0
  v_cmp_gt_u32 vcc, 8, v9
  s_nop 0
  v_mfma_f32_16x16x32_bf16 v[84:87], v[216:219], a[48:51], 0
  v_cvt_pk_bf16_f32 v46, v108, v109
  s_bitset1_b64 vcc, 20
  v_mfma_f32_16x16x32_bf16 v[92:95], v[216:219], a[72:75], 0
  s_ff1_i32_b64 s21, vcc
  s_lshl_b32 s22, s21, 1
  v_mfma_f32_16x16x32_bf16 v[100:103], v[216:219], a[96:99], 0
  ds_read_b128 v[148:151], v8 offset:1024
  v_cvt_pk_bf16_f32 v47, v110, v111
  v_mfma_f32_16x16x32_bf16 v[64:67], v[196:199], a[4:7], v[64:67]
  s_lshl_b32 s21, s21, 2
  s_sub_i32 s21, s21, 16
  v_mfma_f32_16x16x32_bf16 v[72:75], v[196:199], a[28:31], v[72:75]
  s_add_u32 s69, s68, 4096
  s_max_i32 s47, s21, s22
  v_mfma_f32_16x16x32_bf16 v[80:83], v[196:199], a[52:55], v[80:83]
  s_add_u32 s22, s45, 7
  s_min_u32 s22, s22, s47
  v_mfma_f32_16x16x32_bf16 v[88:91], v[196:199], a[76:79], v[88:91]
  buffer_store_dwordx4 v[44:47], v4, s[24:27], s69 offen offset:1024 sc1
  v_mfma_f32_16x16x32_bf16 v[96:99], v[196:199], a[100:103], v[96:99]
  s_cmp_lt_u32 s46, s22
  s_cselect_b32 s66, s41, 0x80000000
  s_cselect_b32 m0, s64, 98304
  s_cselect_b32 s22, 1, 0
  v_mfma_f32_16x16x32_bf16 v[68:71], v[220:223], a[4:7], v[68:71]
  v_cvt_pk_bf16_f32 v48, v112, v113
  v_mfma_f32_16x16x32_bf16 v[76:79], v[220:223], a[28:31], v[76:79]
  ds_read_b128 v[152:155], v8 offset:2048
  v_mfma_f32_16x16x32_bf16 v[84:87], v[220:223], a[52:55], v[84:87]
  v_cvt_pk_bf16_f32 v49, v114, v115
  v_mfma_f32_16x16x32_bf16 v[92:95], v[220:223], a[76:79], v[92:95]
  buffer_load_dword v9, v5, s[72:75], s43 offen sc1
  v_mfma_f32_16x16x32_bf16 v[100:103], v[220:223], a[100:103], v[100:103]
  v_cvt_pk_bf16_f32 v50, v116, v117
  v_mfma_f32_16x16x32_bf16 v[64:67], v[200:203], a[8:11], v[64:67]
  v_mfma_f32_16x16x32_bf16 v[72:75], v[200:203], a[32:35], v[72:75]
  v_cvt_pk_bf16_f32 v51, v118, v119
  v_mfma_f32_16x16x32_bf16 v[80:83], v[200:203], a[56:59], v[80:83]
  buffer_load_dwordx4 v4, s[16:19], s66 offen offset:0 sc1 lds
  v_mfma_f32_16x16x32_bf16 v[88:91], v[200:203], a[80:83], v[88:91]
  ds_read_b128 v[156:159], v8 offset:3072
  v_mfma_f32_16x16x32_bf16 v[96:99], v[200:203], a[104:107], v[96:99]
  buffer_store_dwordx4 v[48:51], v4, s[24:27], s69 offen offset:2048 sc1
  v_mfma_f32_16x16x32_bf16 v[68:71], v[224:227], a[8:11], v[68:71]
  v_cvt_pk_bf16_f32 v52, v120, v121
  v_mfma_f32_16x16x32_bf16 v[76:79], v[224:227], a[32:35], v[76:79]
  v_mfma_f32_16x16x32_bf16 v[84:87], v[224:227], a[56:59], v[84:87]
  v_cvt_pk_bf16_f32 v53, v122, v123
  v_mfma_f32_16x16x32_bf16 v[92:95], v[224:227], a[80:83], v[92:95]
  buffer_load_dwordx4 v4, s[16:19], s66 offen offset:1024 sc1 lds
  v_mfma_f32_16x16x32_bf16 v[100:103], v[224:227], a[104:107], v[100:103]
  v_cvt_pk_bf16_f32 v54, v124, v125
  v_mfma_f32_16x16x32_bf16 v[64:67], v[204:207], a[12:15], v[64:67]
  ds_read_b128 v[160:163], v8 offset:4096
  v_mfma_f32_16x16x32_bf16 v[72:75], v[204:207], a[36:39], v[72:75]
  v_cvt_pk_bf16_f32 v55, v126, v127
  v_mfma_f32_16x16x32_bf16 v[80:83], v[204:207], a[60:63], v[80:83]
  v_mfma_f32_16x16x32_bf16 v[88:91], v[204:207], a[84:87], v[88:91]
  buffer_store_dwordx4 v[52:55], v4, s[24:27], s69 offen offset:3072 sc1
  v_mfma_f32_16x16x32_bf16 v[96:99], v[204:207], a[108:111], v[96:99]
  buffer_load_dwordx4 v4, s[16:19], s66 offen offset:2048 sc1 lds
  v_mfma_f32_16x16x32_bf16 v[68:71], v[228:231], a[12:15], v[68:71]
  v_cvt_pk_bf16_f32 v56, v128, v129
  s_add_u32 s46, s46, s22
  v_mfma_f32_16x16x32_bf16 v[76:79], v[228:231], a[36:39], v[76:79]
  s_mul_i32 s21, s22, 393216
  s_add_u32 s41, s41, s21
  v_mfma_f32_16x16x32_bf16 v[84:87], v[228:231], a[60:63], v[84:87]
  ds_read_b128 v[164:167], v8 offset:5120
  v_cvt_pk_bf16_f32 v57, v130, v131
  v_mfma_f32_16x16x32_bf16 v[92:95], v[228:231], a[84:87], v[92:95]
  s_mul_i32 s21, s22, 12288
  s_add_u32 s64, s64, s21
  v_mfma_f32_16x16x32_bf16 v[100:103], v[228:231], a[108:111], v[100:103]
  v_cvt_pk_bf16_f32 v58, v132, v133
  v_mfma_f32_16x16x32_bf16 v[64:67], v[208:211], a[16:19], v[64:67]
  s_cmp_lt_u32 s64, s67
  s_cselect_b32 s64, s64, s71
  v_mfma_f32_16x16x32_bf16 v[72:75], v[208:211], a[40:43], v[72:75]
  v_cvt_pk_bf16_f32 v59, v134, v135
  v_mfma_f32_16x16x32_bf16 v[80:83], v[208:211], a[64:67], v[80:83]
  v_mfma_f32_16x16x32_bf16 v[88:91], v[208:211], a[88:91], v[88:91]
  s_add_u32 s69, s68, 8192
  v_mfma_f32_16x16x32_bf16 v[96:99], v[208:211], a[112:115], v[96:99]
  ds_read_b128 v[168:171], v8 offset:6144
  v_mfma_f32_16x16x32_bf16 v[68:71], v[232:235], a[16:19], v[68:71]
  buffer_store_dwordx4 v[56:59], v4, s[24:27], s69 offen offset:0 sc1
  v_mfma_f32_16x16x32_bf16 v[76:79], v[232:235], a[40:43], v[76:79]
  v_mfma_f32_16x16x32_bf16 v[84:87], v[232:235], a[64:67], v[84:87]
  v_cvt_pk_bf16_f32 v60, v136, v137
  v_mfma_f32_16x16x32_bf16 v[92:95], v[232:235], a[88:91], v[92:95]
  v_mfma_f32_16x16x32_bf16 v[100:103], v[232:235], a[112:115], v[100:103]
  v_cvt_pk_bf16_f32 v61, v138, v139
  v_mfma_f32_16x16x32_bf16 v[64:67], v[212:215], a[20:23], v[64:67]
  v_mfma_f32_16x16x32_bf16 v[72:75], v[212:215], a[44:47], v[72:75]
  ds_read_b128 v[172:175], v8 offset:7168
  v_cvt_pk_bf16_f32 v62, v140, v141
  v_mfma_f32_16x16x32_bf16 v[80:83], v[212:215], a[68:71], v[80:83]
  v_mfma_f32_16x16x32_bf16 v[88:91], v[212:215], a[92:95], v[88:91]
  v_cvt_pk_bf16_f32 v63, v142, v143
  v_mfma_f32_16x16x32_bf16 v[96:99], v[212:215], a[116:119], v[96:99]
  v_mfma_f32_16x16x32_bf16 v[68:71], v[236:239], a[20:23], v[68:71]
  buffer_store_dwordx4 v[60:63], v4, s[24:27], s69 offen offset:1024 sc1
  v_mfma_f32_16x16x32_bf16 v[76:79], v[236:239], a[44:47], v[76:79]
  v_mfma_f32_16x16x32_bf16 v[84:87], v[236:239], a[68:71], v[84:87]
  v_mfma_f32_16x16x32_bf16 v[92:95], v[236:239], a[92:95], v[92:95]
  ds_read_b128 v[176:179], v8 offset:8192
  v_mfma_f32_16x16x32_bf16 v[100:103], v[236:239], a[116:119], v[100:103]
  v_mfma_f32_16x16x32_bf16 v[104:107], v[192:195], a[120:123], 0
  v_mfma_f32_16x16x32_bf16 v[112:115], v[192:195], a[144:147], 0
  v_mfma_f32_16x16x32_bf16 v[120:123], v[192:195], a[168:171], 0
  v_mfma_f32_16x16x32_bf16 v[128:131], v[192:195], a[192:195], 0
  v_cvt_pk_bf16_f32 v24, v64, v65
  v_mfma_f32_16x16x32_bf16 v[136:139], v[192:195], a[216:219], 0
  v_mfma_f32_16x16x32_bf16 v[108:111], v[216:219], a[120:123], 0
  ds_read_b128 v[180:183], v8 offset:9216
  v_cvt_pk_bf16_f32 v25, v66, v67
  v_mfma_f32_16x16x32_bf16 v[116:119], v[216:219], a[144:147], 0
  s_cmp_lt_u32 s51, 6291456
  s_cselect_b32 s52, s51, 0x80000000
  v_mfma_f32_16x16x32_bf16 v[124:127], v[216:219], a[168:171], 0
  v_cvt_pk_bf16_f32 v26, v68, v69
  v_mfma_f32_16x16x32_bf16 v[132:135], v[216:219], a[192:195], 0
  buffer_store_dwordx4 v[244:247], v4, s[84:87], s52 offen sc1
  v_mfma_f32_16x16x32_bf16 v[140:143], v[216:219], a[216:219], 0
  v_cvt_pk_bf16_f32 v27, v70, v71
  s_add_u32 s52, s52, 6291456
  v_mfma_f32_16x16x32_bf16 v[104:107], v[196:199], a[124:127], v[104:107]
  s_add_u32 s51, s51, 98304
  v_mfma_f32_16x16x32_bf16 v[112:115], v[196:199], a[148:151], v[112:115]
  buffer_store_dwordx4 v[24:27], v4, s[24:27], s42 offen offset:0 sc1
  v_mfma_f32_16x16x32_bf16 v[120:123], v[196:199], a[172:175], v[120:123]
  ds_read_b128 v[184:187], v8 offset:10240
  v_mfma_f32_16x16x32_bf16 v[128:131], v[196:199], a[196:199], v[128:131]
  v_cvt_pk_bf16_f32 v28, v72, v73
  v_mfma_f32_16x16x32_bf16 v[136:139], v[196:199], a[220:223], v[136:139]
  v_cvt_pk_bf16_f32 v29, v74, v75
  v_mfma_f32_16x16x32_bf16 v[108:111], v[220:223], a[124:127], v[108:111]
  s_cmp_lg_u32 s40, 0
  s_cbranch_scc1 vwm_164
vwm_165:
  v_mfma_f32_16x16x32_bf16 v[116:119], v[220:223], a[148:151], v[116:119]
  v_cvt_pk_bf16_f32 v30, v76, v77
  v_mfma_f32_16x16x32_bf16 v[124:127], v[220:223], a[172:175], v[124:127]
  v_mfma_f32_16x16x32_bf16 v[132:135], v[220:223], a[196:199], v[132:135]
  v_cvt_pk_bf16_f32 v31, v78, v79
  v_mfma_f32_16x16x32_bf16 v[140:143], v[220:223], a[220:223], v[140:143]
  ds_read_b128 v[188:191], v8 offset:11264
  v_mfma_f32_16x16x32_bf16 v[104:107], v[200:203], a[128:131], v[104:107]
  buffer_store_dwordx4 v[28:31], v4, s[24:27], s42 offen offset:1024 sc1
  v_mfma_f32_16x16x32_bf16 v[112:115], v[200:203], a[152:155], v[112:115]
  v_mfma_f32_16x16x32_bf16 v[120:123], v[200:203], a[176:179], v[120:123]
  v_cvt_pk_bf16_f32 v32, v80, v81
  v_mfma_f32_16x16x32_bf16 v[128:131], v[200:203], a[200:203], v[128:131]
  v_mfma_f32_16x16x32_bf16 v[136:139], v[200:203], a[224:227], v[136:139]
  v_cvt_pk_bf16_f32 v33, v82, v83
  v_mfma_f32_16x16x32_bf16 v[108:111], v[224:227], a[128:131], v[108:111]
  v_cvt_pk_bf16_f32 v34, v84, v85
  v_mfma_f32_16x16x32_bf16 v[116:119], v[224:227], a[152:155], v[116:119]
  buffer_store_dwordx4 v[244:247], v4, s[84:87], s52 offen sc1
  v_mfma_f32_16x16x32_bf16 v[124:127], v[224:227], a[176:179], v[124:127]
  v_cvt_pk_bf16_f32 v35, v86, v87
  v_mfma_f32_16x16x32_bf16 v[132:135], v[224:227], a[200:203], v[132:135]
  v_mfma_f32_16x16x32_bf16 v[140:143], v[224:227], a[224:227], v[140:143]
  buffer_store_dwordx4 v[32:35], v4, s[24:27], s42 offen offset:2048 sc1
  v_mfma_f32_16x16x32_bf16 v[104:107], v[204:207], a[132:135], v[104:107]
  v_mfma_f32_16x16x32_bf16 v[112:115], v[204:207], a[156:159], v[112:115]
  v_cvt_pk_bf16_f32 v36, v88, v89
  v_mfma_f32_16x16x32_bf16 v[120:123], v[204:207], a[180:183], v[120:123]
  v_mfma_f32_16x16x32_bf16 v[128:131], v[204:207], a[204:207], v[128:131]
  v_cvt_pk_bf16_f32 v37, v90, v91
  v_mfma_f32_16x16x32_bf16 v[136:139], v[204:207], a[228:231], v[136:139]
  v_mfma_f32_16x16x32_bf16 v[108:111], v[228:231], a[132:135], v[108:111]
  v_cvt_pk_bf16_f32 v38, v92, v93
  v_mfma_f32_16x16x32_bf16 v[116:119], v[228:231], a[156:159], v[116:119]
  v_cvt_pk_bf16_f32 v39, v94, v95
  v_mfma_f32_16x16x32_bf16 v[124:127], v[228:231], a[180:183], v[124:127]
  v_mfma_f32_16x16x32_bf16 v[132:135], v[228:231], a[204:207], v[132:135]
  buffer_store_dwordx4 v[36:39], v4, s[24:27], s42 offen offset:3072 sc1
  v_mfma_f32_16x16x32_bf16 v[140:143], v[228:231], a[228:231], v[140:143]
  v_mfma_f32_16x16x32_bf16 v[104:107], v[208:211], a[136:139], v[104:107]
  v_cvt_pk_bf16_f32 v40, v96, v97
  s_waitcnt lgkmcnt(0)
  v_mfma_f32_16x16x32_bf16 v[112:115], v[208:211], a[160:163], v[112:115]
  v_and_b32 v240, v240, v241
  v_and_b32 v242, v242, v243
  v_mfma_f32_16x16x32_bf16 v[120:123], v[208:211], a[184:187], v[120:123]
  v_cvt_pk_bf16_f32 v41, v98, v99
  v_and_b32 v240, v240, v242
  v_mfma_f32_16x16x32_bf16 v[128:131], v[208:211], a[208:211], v[128:131]
  s_nop 0
  v_readfirstlane_b32 s23, v240
  v_mfma_f32_16x16x32_bf16 v[136:139], v[208:211], a[232:235], v[136:139]
  v_cvt_pk_bf16_f32 v42, v100, v101
  v_mfma_f32_16x16x32_bf16 v[108:111], v[232:235], a[136:139], v[108:111]
  v_mfma_f32_16x16x32_bf16 v[116:119], v[232:235], a[160:163], v[116:119]
  v_cvt_pk_bf16_f32 v43, v102, v103
  v_mfma_f32_16x16x32_bf16 v[124:127], v[232:235], a[184:187], v[124:127]
  s_add_u32 s69, s42, 4096
  v_mfma_f32_16x16x32_bf16 v[132:135], v[232:235], a[208:211], v[132:135]
  v_mfma_f32_16x16x32_bf16 v[140:143], v[232:235], a[232:235], v[140:143]
  buffer_store_dwordx4 v[40:43], v4, s[24:27], s69 offen offset:0 sc1
  v_mfma_f32_16x16x32_bf16 v[104:107], v[212:215], a[140:143], v[104:107]
  v_mfma_f32_16x16x32_bf16 v[112:115], v[212:215], a[164:167], v[112:115]
  v_mfma_f32_16x16x32_bf16 v[120:123], v[212:215], a[188:191], v[120:123]
  s_waitcnt vmcnt(16)
  s_mov_b32 s50, s48
  s_mov_b32 s49, s48
  v_mfma_f32_16x16x32_bf16 v[128:131], v[212:215], a[212:215], v[128:131]
  s_mov_b32 s48, s46
  s_sub_i32 s69, s45, 1
  s_max_i32 s69, s69, s70
  v_mfma_f32_16x16x32_bf16 v[136:139], v[212:215], a[236:239], v[136:139]
  s_add_u32 s45, s45, 1
  s_mov_b32 s68, s42
  s_add_u32 s42, s42, 1310720
  v_mfma_f32_16x16x32_bf16 v[108:111], v[236:239], a[140:143], v[108:111]
  s_add_u32 s21, s45, 1
  s_min_u32 s21, s21, 63
  v_mfma_f32_16x16x32_bf16 v[116:119], v[236:239], a[164:167], v[116:119]
  s_cmp_lt_u32 s21, s50
  s_cselect_b32 s21, 1, 0
  v_mov_b32 v21, s21
  v_mfma_f32_16x16x32_bf16 v[124:127], v[236:239], a[188:191], v[124:127]
  ds_write_b32 v6, v21 offset:0
  v_mfma_f32_16x16x32_bf16 v[132:135], v[236:239], a[212:215], v[132:135]
  v_mfma_f32_16x16x32_bf16 v[140:143], v[236:239], a[236:239], v[140:143]
  s_mov_b64 exec, 1
  v_mov_b32 v20, s69
  buffer_store_dword v20, v10, s[72:75], s44 offen sc1
  s_mov_b64 exec, -1
  s_cmp_le_u32 s45, 8
  s_cbranch_scc1 vwe_168
vwe_169:
  s_cmp_lg_u32 s45, 24
  s_cbranch_scc1 arm_170
  s_mul_i32 s21, s2, 10240
  s_mul_i32 s22, s20, 2560
  s_add_u32 s21, s21, s22
  s_add_u32 s21, s21, 18350080
  buffer_store_dwordx4 v[244:247], v15, s[80:83], s21 offen offset:0 sc1
  buffer_store_dwordx4 v[244:247], v15, s[80:83], s21 offen offset:512 sc1
  buffer_store_dwordx4 v[244:247], v15, s[80:83], s21 offen offset:1024 sc1
  buffer_store_dwordx4 v[244:247], v15, s[80:83], s21 offen offset:1536 sc1
  buffer_store_dwordx4 v[244:247], v15, s[80:83], s21 offen offset:2048 sc1
  s_add_u32 s21, s21, 655360
  buffer_store_dwordx4 v[244:247], v15, s[80:83], s21 offen offset:0 sc1
  buffer_store_dwordx4 v[244:247], v15, s[80:83], s21 offen offset:512 sc1
  buffer_store_dwordx4 v[244:247], v15, s[80:83], s21 offen offset:1024 sc1
  buffer_store_dwordx4 v[244:247], v15, s[80:83], s21 offen offset:1536 sc1
  buffer_store_dwordx4 v[244:247], v15, s[80:83], s21 offen offset:2048 sc1
  s_add_u32 s21, s21, 655360
  buffer_store_dwordx4 v[244:247], v15, s[80:83], s21 offen offset:0 sc1
  buffer_store_dwordx4 v[244:247], v15, s[80:83], s21 offen offset:512 sc1
  buffer_store_dwordx4 v[244:247], v15, s[80:83], s21 offen offset:1024 sc1
  buffer_store_dwordx4 v[244:247], v15, s[80:83], s21 offen offset:1536 sc1
  buffer_store_dwordx4 v[244:247], v15, s[80:83], s21 offen offset:2048 sc1
  s_add_u32 s21, s21, 655360
  buffer_store_dwordx4 v[244:247], v15, s[80:83], s21 offen offset:0 sc1
  buffer_store_dwordx4 v[244:247], v15, s[80:83], s21 offen offset:512 sc1
  buffer_store_dwordx4 v[244:247], v15, s[80:83], s21 offen offset:1024 sc1
  buffer_store_dwordx4 v[244:247], v15, s[80:83], s21 offen offset:1536 sc1
  buffer_store_dwordx4 v[244:247], v15, s[80:83], s21 offen offset:2048 sc1
  s_add_u32 s21, s21, 655360
  s_and_b32 s21, s2, 3
  s_cmp_lg_u32 s21, s20
  s_cbranch_scc1 arm_170
  s_mul_i32 s21, s2, 2560
  s_add_u32 s21, s21, 4587520
  v_lshlrev_b32 v21, 3, v1
  buffer_store_dwordx4 v[244:247], v4, s[88:91], s21 offen sc1
  buffer_store_dwordx4 v[244:247], v4, s[88:91], s21 offen offset:1024 sc1
  buffer_store_dwordx2 v[244:245], v21, s[88:91], s21 offen offset:2048 sc1
  s_add_u32 s21, s21, 81920
  buffer_store_dwordx4 v[244:247], v4, s[88:91], s21 offen sc1
  buffer_store_dwordx4 v[244:247], v4, s[88:91], s21 offen offset:1024 sc1
  buffer_store_dwordx2 v[244:245], v21, s[88:91], s21 offen offset:2048 sc1
  s_add_u32 s21, s21, 81920
  buffer_store_dwordx4 v[244:247], v4, s[88:91], s21 offen sc1
  buffer_store_dwordx4 v[244:247], v4, s[88:91], s21 offen offset:1024 sc1
  buffer_store_dwordx2 v[244:245], v21, s[88:91], s21 offen offset:2048 sc1
  s_add_u32 s21, s21, 81920
  buffer_store_dwordx4 v[244:247], v4, s[88:91], s21 offen sc1
  buffer_store_dwordx4 v[244:247], v4, s[88:91], s21 offen offset:1024 sc1
  buffer_store_dwordx2 v[244:245], v21, s[88:91], s21 offen offset:2048 sc1
  s_add_u32 s21, s21, 81920
  buffer_store_dwordx4 v[244:247], v4, s[88:91], s21 offen sc1
  buffer_store_dwordx4 v[244:247], v4, s[88:91], s21 offen offset:1024 sc1
  buffer_store_dwordx2 v[244:245], v21, s[88:91], s21 offen offset:2048 sc1
  s_add_u32 s21, s21, 81920
  buffer_store_dwordx4 v[244:247], v4, s[88:91], s21 offen sc1
  buffer_store_dwordx4 v[244:247], v4, s[88:91], s21 offen offset:1024 sc1
  buffer_store_dwordx2 v[244:245], v21, s[88:91], s21 offen offset:2048 sc1
  s_add_u32 s21, s21, 81920
  buffer_store_dwordx4 v[244:247], v4, s[88:91], s21 offen sc1
  buffer_store_dwordx4 v[244:247], v4, s[88:91], s21 offen offset:1024 sc1
  buffer_store_dwordx2 v[244:245], v21, s[88:91], s21 offen offset:2048 sc1
  s_add_u32 s21, s21, 81920
  buffer_store_dwordx4 v[244:247], v4, s[88:91], s21 offen sc1
  buffer_store_dwordx4 v[244:247], v4, s[88:91], s21 offen offset:1024 sc1
  buffer_store_dwordx2 v[244:245], v21, s[88:91], s21 offen offset:2048 sc1
  s_add_u32 s21, s21, 81920
arm_170:
  s_cmp_ge_u32 s45, 64
  s_cbranch_scc1 vwd_157
  s_cmp_lg_u32 s23, 0
  s_cbranch_scc1 vwl_156
  s_branch vws_166
vws_160:
  v_cmp_gt_u32 vcc, 8, v9
  s_nop 0
  s_bitset1_b64 vcc, 20
  s_ff1_i32_b64 s21, vcc
  s_lshl_b32 s22, s21, 1
  s_lshl_b32 s21, s21, 2
  s_sub_i32 s21, s21, 16
  s_max_i32 s47, s21, s22
  s_cmp_gt_u32 s47, s45
  s_cbranch_scc1 va_172
  s_cmp_eq_u32 s70, s45
  s_cbranch_scc1 va_177
  s_nop 4
  v_cvt_pk_bf16_f32 v44, v104, v105
  v_cvt_pk_bf16_f32 v45, v106, v107
  v_cvt_pk_bf16_f32 v46, v108, v109
  v_cvt_pk_bf16_f32 v47, v110, v111
  s_add_u32 s69, s68, 4096
  buffer_store_dwordx4 v[44:47], v4, s[24:27], s69 offen offset:1024 sc1
  v_cvt_pk_bf16_f32 v48, v112, v113
  v_cvt_pk_bf16_f32 v49, v114, v115
  v_cvt_pk_bf16_f32 v50, v116, v117
  v_cvt_pk_bf16_f32 v51, v118, v119
  buffer_store_dwordx4 v[48:51], v4, s[24:27], s69 offen offset:2048 sc1
  v_cvt_pk_bf16_f32 v52, v120, v121
  v_cvt_pk_bf16_f32 v53, v122, v123
  v_cvt_pk_bf16_f32 v54, v124, v125
  v_cvt_pk_bf16_f32 v55, v126, v127
  buffer_store_dwordx4 v[52:55], v4, s[24:27], s69 offen offset:3072 sc1
  v_cvt_pk_bf16_f32 v56, v128, v129
  v_cvt_pk_bf16_f32 v57, v130, v131
  v_cvt_pk_bf16_f32 v58, v132, v133
  v_cvt_pk_bf16_f32 v59, v134, v135
  s_add_u32 s69, s68, 8192
  buffer_store_dwordx4 v[56:59], v4, s[24:27], s69 offen offset:0 sc1
  v_cvt_pk_bf16_f32 v60, v136, v137
  v_cvt_pk_bf16_f32 v61, v138, v139
  v_cvt_pk_bf16_f32 v62, v140, v141
  v_cvt_pk_bf16_f32 v63, v142, v143
  buffer_store_dwordx4 v[60:63], v4, s[24:27], s69 offen offset:1024 sc1
  s_mov_b32 s68, 0x80000000
  s_waitcnt vmcnt(0)
  s_mov_b64 exec, 1
  v_mov_b32 v20, s45
  buffer_store_dword v20, v10, s[72:75], s44 offen sc1
  s_mov_b64 exec, -1
  s_mov_b32 s70, s45
  s_mov_b32 s40, 0
va_177:
  s_mov_b32 s101, 0
  s_branch va_175
va_173:
  s_sleep 8
va_175:
  buffer_load_dword v9, v5, s[72:75], s43 offen sc1
  s_add_u32 s101, s101, 1
  s_cmp_gt_u32 s101, 131072
  s_cbranch_scc1 main_end
  s_waitcnt vmcnt(0)
  v_cmp_gt_u32 vcc, 8, v9
  s_nop 0
  s_bitset1_b64 vcc, 20
  s_ff1_i32_b64 s21, vcc
  s_lshl_b32 s22, s21, 1
  s_lshl_b32 s21, s21, 2
  s_sub_i32 s21, s21, 16
  s_max_i32 s47, s21, s22
  s_cmp_gt_u32 s47, s45
  s_cbranch_scc0 va_173
va_172:
  s_add_u32 s22, s45, 6
  s_min_u32 s22, s22, s47
va_174:
  s_cmp_ge_u32 s46, s22
  s_cbranch_scc1 va_176
  s_mov_b32 m0, s64
  s_mov_b32 s66, s41
  buffer_load_dwordx4 v4, s[16:19], s66 offen offset:0 sc1 lds
  buffer_load_dwordx4 v4, s[16:19], s66 offen offset:1024 sc1 lds
  buffer_load_dwordx4 v4, s[16:19], s66 offen offset:2048 sc1 lds
  s_add_u32 s46, s46, 1
  s_add_u32 s41, s41, 393216
  s_add_u32 s64, s64, 12288
  s_cmp_lt_u32 s64, s67
  s_cselect_b32 s64, s64, s71
  s_branch va_174
va_176:
  s_mov_b32 s48, s46
  s_mov_b32 s49, s46
  s_mov_b32 s50, s46
  s_waitcnt vmcnt(0)
  s_barrier
  ds_read_b128 v[192:195], v8 offset:0
  ds_read_b128 v[196:199], v8 offset:1024
  ds_read_b128 v[200:203], v8 offset:2048
  ds_read_b128 v[204:207], v8 offset:3072
  ds_read_b128 v[208:211], v8 offset:4096
  ds_read_b128 v[212:215], v8 offset:5120
  ds_read_b128 v[216:219], v8 offset:6144
  ds_read_b128 v[220:223], v8 offset:7168
  ds_read_b128 v[224:227], v8 offset:8192
  ds_read_b128 v[228:231], v8 offset:9216
  ds_read_b128 v[232:235], v8 offset:10240
  ds_read_b128 v[236:239], v8 offset:11264
  s_add_u32 s21, s45, 1
  s_min_u32 s21, s21, 63
  s_cmp_lt_u32 s21, s50
  s_cselect_b32 s21, 1, 0
  v_mov_b32 v21, s21
  ds_write_b32 v6, v21 offset:16
  s_branch vwb_161
vws_166:
  v_cmp_gt_u32 vcc, 8, v9
  s_nop 0
  s_bitset1_b64 vcc, 20
  s_ff1_i32_b64 s21, vcc
  s_lshl_b32 s22, s21, 1
  s_lshl_b32 s21, s21, 2
  s_sub_i32 s21, s21, 16
  s_max_i32 s47, s21, s22
  s_cmp_gt_u32 s47, s45
  s_cbranch_scc1 va_178
  s_cmp_eq_u32 s70, s45
  s_cbranch_scc1 va_183
  s_nop 4
  v_cvt_pk_bf16_f32 v44, v104, v105
  v_cvt_pk_bf16_f32 v45, v106, v107
  v_cvt_pk_bf16_f32 v46, v108, v109
  v_cvt_pk_bf16_f32 v47, v110, v111
  s_add_u32 s69, s68, 4096
  buffer_store_dwordx4 v[44:47], v4, s[24:27], s69 offen offset:1024 sc1
  v_cvt_pk_bf16_f32 v48, v112, v113
  v_cvt_pk_bf16_f32 v49, v114, v115
  v_cvt_pk_bf16_f32 v50, v116, v117
  v_cvt_pk_bf16_f32 v51, v118, v119
  buffer_store_dwordx4 v[48:51], v4, s[24:27], s69 offen offset:2048 sc1
  v_cvt_pk_bf16_f32 v52, v120, v121
  v_cvt_pk_bf16_f32 v53, v122, v123
  v_cvt_pk_bf16_f32 v54, v124, v125
  v_cvt_pk_bf16_f32 v55, v126, v127
  buffer_store_dwordx4 v[52:55], v4, s[24:27], s69 offen offset:3072 sc1
  v_cvt_pk_bf16_f32 v56, v128, v129
  v_cvt_pk_bf16_f32 v57, v130, v131
  v_cvt_pk_bf16_f32 v58, v132, v133
  v_cvt_pk_bf16_f32 v59, v134, v135
  s_add_u32 s69, s68, 8192
  buffer_store_dwordx4 v[56:59], v4, s[24:27], s69 offen offset:0 sc1
  v_cvt_pk_bf16_f32 v60, v136, v137
  v_cvt_pk_bf16_f32 v61, v138, v139
  v_cvt_pk_bf16_f32 v62, v140, v141
  v_cvt_pk_bf16_f32 v63, v142, v143
  buffer_store_dwordx4 v[60:63], v4, s[24:27], s69 offen offset:1024 sc1
  s_mov_b32 s68, 0x80000000
  s_waitcnt vmcnt(0)
  s_mov_b64 exec, 1
  v_mov_b32 v20, s45
  buffer_store_dword v20, v10, s[72:75], s44 offen sc1
  s_mov_b64 exec, -1
  s_mov_b32 s70, s45
  s_mov_b32 s40, 0
va_183:
  s_mov_b32 s101, 0
  s_branch va_181
va_179:
  s_sleep 8
va_181:
  buffer_load_dword v9, v5, s[72:75], s43 offen sc1
  s_add_u32 s101, s101, 1
  s_cmp_gt_u32 s101, 131072
  s_cbranch_scc1 main_end
  s_waitcnt vmcnt(0)
  v_cmp_gt_u32 vcc, 8, v9
  s_nop 0
  s_bitset1_b64 vcc, 20
  s_ff1_i32_b64 s21, vcc
  s_lshl_b32 s22, s21, 1
  s_lshl_b32 s21, s21, 2
  s_sub_i32 s21, s21, 16
  s_max_i32 s47, s21, s22
  s_cmp_gt_u32 s47, s45
  s_cbranch_scc0 va_179
va_178:
  s_add_u32 s22, s45, 6
  s_min_u32 s22, s22, s47
va_180:
  s_cmp_ge_u32 s46, s22
  s_cbranch_scc1 va_182
  s_mov_b32 m0, s64
  s_mov_b32 s66, s41
  buffer_load_dwordx4 v4, s[16:19], s66 offen offset:0 sc1 lds
  buffer_load_dwordx4 v4, s[16:19], s66 offen offset:1024 sc1 lds
  buffer_load_dwordx4 v4, s[16:19], s66 offen offset:2048 sc1 lds
  s_add_u32 s46, s46, 1
  s_add_u32 s41, s41, 393216
  s_add_u32 s64, s64, 12288
  s_cmp_lt_u32 s64, s67
  s_cselect_b32 s64, s64, s71
  s_branch va_180
va_182:
  s_mov_b32 s48, s46
  s_mov_b32 s49, s46
  s_mov_b32 s50, s46
  s_waitcnt vmcnt(0)
  s_barrier
  ds_read_b128 v[144:147], v8 offset:0
  ds_read_b128 v[148:151], v8 offset:1024
  ds_read_b128 v[152:155], v8 offset:2048
  ds_read_b128 v[156:159], v8 offset:3072
  ds_read_b128 v[160:163], v8 offset:4096
  ds_read_b128 v[164:167], v8 offset:5120
  ds_read_b128 v[168:171], v8 offset:6144
  ds_read_b128 v[172:175], v8 offset:7168
  ds_read_b128 v[176:179], v8 offset:8192
  ds_read_b128 v[180:183], v8 offset:9216
  ds_read_b128 v[184:187], v8 offset:10240
  ds_read_b128 v[188:191], v8 offset:11264
  s_add_u32 s21, s45, 1
  s_min_u32 s21, s21, 63
  s_cmp_lt_u32 s21, s50
  s_cselect_b32 s21, 1, 0
  v_mov_b32 v21, s21
  ds_write_b32 v6, v21 offset:0
  s_branch vwl_156
vwe_162:
  s_nop 4
  v_cvt_pk_bf16_f32 v44, v104, v105
  v_cvt_pk_bf16_f32 v45, v106, v107
  v_cvt_pk_bf16_f32 v46, v108, v109
  v_cvt_pk_bf16_f32 v47, v110, v111
  s_add_u32 s69, s68, 4096
  buffer_store_dwordx4 v[44:47], v4, s[24:27], s69 offen offset:1024 sc1
  v_cvt_pk_bf16_f32 v48, v112, v113
  v_cvt_pk_bf16_f32 v49, v114, v115
  v_cvt_pk_bf16_f32 v50, v116, v117
  v_cvt_pk_bf16_f32 v51, v118, v119
  buffer_store_dwordx4 v[48:51], v4, s[24:27], s69 offen offset:2048 sc1
  v_cvt_pk_bf16_f32 v52, v120, v121
  v_cvt_pk_bf16_f32 v53, v122, v123
  v_cvt_pk_bf16_f32 v54, v124, v125
  v_cvt_pk_bf16_f32 v55, v126, v127
  buffer_store_dwordx4 v[52:55], v4, s[24:27], s69 offen offset:3072 sc1
  v_cvt_pk_bf16_f32 v56, v128, v129
  v_cvt_pk_bf16_f32 v57, v130, v131
  v_cvt_pk_bf16_f32 v58, v132, v133
  v_cvt_pk_bf16_f32 v59, v134, v135
  s_add_u32 s69, s68, 8192
  buffer_store_dwordx4 v[56:59], v4, s[24:27], s69 offen offset:0 sc1
  v_cvt_pk_bf16_f32 v60, v136, v137
  v_cvt_pk_bf16_f32 v61, v138, v139
  v_cvt_pk_bf16_f32 v62, v140, v141
  v_cvt_pk_bf16_f32 v63, v142, v143
  buffer_store_dwordx4 v[60:63], v4, s[24:27], s69 offen offset:1024 sc1
  s_mov_b32 s68, 0x80000000
  s_mov_b32 s40, 1
  s_branch vwe_163
vwe_168:
  s_nop 4
  v_cvt_pk_bf16_f32 v44, v104, v105
  v_cvt_pk_bf16_f32 v45, v106, v107
  v_cvt_pk_bf16_f32 v46, v108, v109
  v_cvt_pk_bf16_f32 v47, v110, v111
  s_add_u32 s69, s68, 4096
  buffer_store_dwordx4 v[44:47], v4, s[24:27], s69 offen offset:1024 sc1
  v_cvt_pk_bf16_f32 v48, v112, v113
  v_cvt_pk_bf16_f32 v49, v114, v115
  v_cvt_pk_bf16_f32 v50, v116, v117
  v_cvt_pk_bf16_f32 v51, v118, v119
  buffer_store_dwordx4 v[48:51], v4, s[24:27], s69 offen offset:2048 sc1
  v_cvt_pk_bf16_f32 v52, v120, v121
  v_cvt_pk_bf16_f32 v53, v122, v123
  v_cvt_pk_bf16_f32 v54, v124, v125
  v_cvt_pk_bf16_f32 v55, v126, v127
  buffer_store_dwordx4 v[52:55], v4, s[24:27], s69 offen offset:3072 sc1
  v_cvt_pk_bf16_f32 v56, v128, v129
  v_cvt_pk_bf16_f32 v57, v130, v131
  v_cvt_pk_bf16_f32 v58, v132, v133
  v_cvt_pk_bf16_f32 v59, v134, v135
  s_add_u32 s69, s68, 8192
  buffer_store_dwordx4 v[56:59], v4, s[24:27], s69 offen offset:0 sc1
  v_cvt_pk_bf16_f32 v60, v136, v137
  v_cvt_pk_bf16_f32 v61, v138, v139
  v_cvt_pk_bf16_f32 v62, v140, v141
  v_cvt_pk_bf16_f32 v63, v142, v143
  buffer_store_dwordx4 v[60:63], v4, s[24:27], s69 offen offset:1024 sc1
  s_mov_b32 s68, 0x80000000
  s_mov_b32 s40, 1
  s_branch vwe_169
vwm_158:
  s_mov_b32 s40, 0
  s_waitcnt vmcnt(11)
  s_mov_b64 exec, 1
  v_mov_b32 v20, s45
  buffer_store_dword v20, v10, s[72:75], s44 offen sc1
  s_mov_b64 exec, -1
  s_mov_b32 s70, s45
  s_branch vwm_159
vwm_164:
  s_mov_b32 s40, 0
  s_waitcnt vmcnt(11)
  s_mov_b64 exec, 1
  v_mov_b32 v20, s45
  buffer_store_dword v20, v10, s[72:75], s44 offen sc1
  s_mov_b64 exec, -1
  s_mov_b32 s70, s45
  s_branch vwm_165
vwd_157:
  s_nop 4
  v_cvt_pk_bf16_f32 v44, v104, v105
  v_cvt_pk_bf16_f32 v45, v106, v107
  v_cvt_pk_bf16_f32 v46, v108, v109
  v_cvt_pk_bf16_f32 v47, v110, v111
  s_add_u32 s69, s68, 4096
  buffer_store_dwordx4 v[44:47], v4, s[24:27], s69 offen offset:1024 sc1
  v_cvt_pk_bf16_f32 v48, v112, v113
  v_cvt_pk_bf16_f32 v49, v114, v115
  v_cvt_pk_bf16_f32 v50, v116, v117
  v_cvt_pk_bf16_f32 v51, v118, v119
  buffer_store_dwordx4 v[48:51], v4, s[24:27], s69 offen offset:2048 sc1
  v_cvt_pk_bf16_f32 v52, v120, v121
  v_cvt_pk_bf16_f32 v53, v122, v123
  v_cvt_pk_bf16_f32 v54, v124, v125
  v_cvt_pk_bf16_f32 v55, v126, v127
  buffer_store_dwordx4 v[52:55], v4, s[24:27], s69 offen offset:3072 sc1
  v_cvt_pk_bf16_f32 v56, v128, v129
  v_cvt_pk_bf16_f32 v57, v130, v131
  v_cvt_pk_bf16_f32 v58, v132, v133
  v_cvt_pk_bf16_f32 v59, v134, v135
  s_add_u32 s69, s68, 8192
  buffer_store_dwordx4 v[56:59], v4, s[24:27], s69 offen offset:0 sc1
  v_cvt_pk_bf16_f32 v60, v136, v137
  v_cvt_pk_bf16_f32 v61, v138, v139
  v_cvt_pk_bf16_f32 v62, v140, v141
  v_cvt_pk_bf16_f32 v63, v142, v143
  buffer_store_dwordx4 v[60:63], v4, s[24:27], s69 offen offset:1024 sc1
  s_waitcnt vmcnt(0)
  s_mov_b64 exec, 1
  v_mov_b32 v20, s45
  buffer_store_dword v20, v10, s[72:75], s44 offen sc1
  s_mov_b64 exec, -1
ul_184:
  s_cmp_lt_u32 s55, s56
  s_cbranch_scc1 uh_185
  s_sub_u32 s21, s55, 60
  s_cmp_lt_u32 s21, 4
  s_cbranch_scc1 ut_187
  s_waitcnt vmcnt(0)
  s_cmp_eq_u32 s58, 0
  s_cbranch_scc1 uf_188
  s_mov_b64 exec, s[58:59]
  buffer_atomic_add v11, v17, s[72:75], s57 offen sc1
  s_mov_b64 exec, -1
  s_mov_b32 s58, 0
uf_188:
  s_cmp_ge_u32 s55, 64
  s_cbranch_scc1 ud_186
  s_cmp_ge_u32 s55, 60
  s_cbranch_scc1 ut_187
  s_add_u32 s23, s55, 1
  s_mov_b32 s101, 0
wm_189:
  buffer_load_dword v8, v12, s[72:75], s53 offen sc1
  s_add_u32 s101, s101, 1
  s_cmp_gt_u32 s101, 131072
  s_cbranch_scc1 main_end
  s_waitcnt vmcnt(0)
  v_cmp_gt_u32 vcc, s23, v8
  v_readfirstlane_b32 s100, v8
  s_nop 0
  s_cbranch_vccz wm_190
  s_sleep 4
  s_add_u32 s100, s100, 1
  s_cmp_ge_u32 s100, s23
  s_cbranch_scc1 wm_189
  s_sleep 90
  s_branch wm_189
wm_190:
  v_readlane_b32 s56, v8, 0
  v_readlane_b32 s21, v8, 1
  v_readlane_b32 s22, v8, 2
  v_readlane_b32 s23, v8, 3
  s_min_u32 s56, s56, s21
  s_min_u32 s22, s22, s23
  s_min_u32 s56, s56, s22
  s_min_u32 s56, s56, 64
uh_185:
  s_sub_u32 s21, s56, s55
  s_cmp_lt_u32 s21, 4
  s_cbranch_scc1 uo_191
  s_sub_u32 s21, s56, s55
  s_cmp_ge_u32 s21, 2
  s_cselect_b64 vcc, -1, 0
  s_cselect_b32 s54, 2, 1
  v_cndmask_b32 v18, v13, v14, vcc
  s_lshl_b32 s21, s55, 5
  s_add_u32 s21, s21, s2
  s_mul_i32 s62, s21, 3072
  s_mul_i32 s63, s21, 10240
  s_mul_i32 s22, s20, 2560
  s_add_u32 s63, s63, s22
  buffer_load_dwordx4 a[240:243], v18, s[76:79], s62 offen offset:0 sc1
  buffer_load_dwordx4 a[244:247], v18, s[76:79], s62 offen offset:512 sc1
  buffer_load_dwordx4 a[248:251], v18, s[76:79], s62 offen offset:1024 sc1
  buffer_load_dwordx4 a[252:255], v18, s[76:79], s62 offen offset:1536 sc1
  buffer_load_dwordx4 v[248:251], v18, s[76:79], s62 offen offset:2048 sc1
  buffer_load_dwordx4 v[252:255], v18, s[76:79], s62 offen offset:2560 sc1
  s_mov_b32 s66, 0
  s_mov_b32 s67, 0
  s_add_u32 s62, s62, 196608
  buffer_load_dwordx4 v[24:27], v18, s[76:79], s62 offen offset:0 sc1
  buffer_load_dwordx4 v[28:31], v18, s[76:79], s62 offen offset:512 sc1
  buffer_load_dwordx4 v[32:35], v18, s[76:79], s62 offen offset:1024 sc1
  buffer_load_dwordx4 v[36:39], v18, s[76:79], s62 offen offset:1536 sc1
  buffer_load_dwordx4 v[40:43], v18, s[76:79], s62 offen offset:2048 sc1
  buffer_load_dwordx4 v[44:47], v18, s[76:79], s62 offen offset:2560 sc1
  s_waitcnt vmcnt(6)
  s_cmp_eq_u32 s58, 0
  s_cbranch_scc1 uf_195
  s_mov_b64 exec, s[58:59]
  buffer_atomic_add v11, v17, s[72:75], s57 offen sc1
  s_mov_b64 exec, -1
  s_mov_b32 s58, 0
uf_195:
  v_mfma_f32_16x16x32_bf16 v[64:67], a[240:243], a[0:3], 0
  v_mfma_f32_16x16x32_bf16 v[68:71], a[240:243], a[24:27], 0
  v_mfma_f32_16x16x32_bf16 v[72:75], a[240:243], a[48:51], 0
  v_mfma_f32_16x16x32_bf16 v[76:79], a[240:243], a[72:75], 0
  v_mfma_f32_16x16x32_bf16 v[80:83], a[240:243], a[96:99], 0
  v_mfma_f32_16x16x32_bf16 v[84:87], a[240:243], a[120:123], 0
  v_mfma_f32_16x16x32_bf16 v[88:91], a[240:243], a[144:147], 0
  v_mfma_f32_16x16x32_bf16 v[92:95], a[240:243], a[168:171], 0
  v_mfma_f32_16x16x32_bf16 v[96:99], a[240:243], a[192:195], 0
  v_mfma_f32_16x16x32_bf16 v[100:103], a[240:243], a[216:219], 0
  v_mfma_f32_16x16x32_bf16 v[64:67], a[244:247], a[4:7], v[64:67]
  v_mfma_f32_16x16x32_bf16 v[68:71], a[244:247], a[28:31], v[68:71]
  v_mfma_f32_16x16x32_bf16 v[72:75], a[244:247], a[52:55], v[72:75]
  v_mfma_f32_16x16x32_bf16 v[76:79], a[244:247], a[76:79], v[76:79]
  v_mfma_f32_16x16x32_bf16 v[80:83], a[244:247], a[100:103], v[80:83]
  v_mfma_f32_16x16x32_bf16 v[84:87], a[244:247], a[124:127], v[84:87]
  v_mfma_f32_16x16x32_bf16 v[88:91], a[244:247], a[148:151], v[88:91]
  v_mfma_f32_16x16x32_bf16 v[92:95], a[244:247], a[172:175], v[92:95]
  v_mfma_f32_16x16x32_bf16 v[96:99], a[244:247], a[196:199], v[96:99]
  v_mfma_f32_16x16x32_bf16 v[100:103], a[244:247], a[220:223], v[100:103]
  v_mfma_f32_16x16x32_bf16 v[64:67], a[248:251], a[8:11], v[64:67]
  v_mfma_f32_16x16x32_bf16 v[68:71], a[248:251], a[32:35], v[68:71]
  v_mfma_f32_16x16x32_bf16 v[72:75], a[248:251], a[56:59], v[72:75]
  v_mfma_f32_16x16x32_bf16 v[76:79], a[248:251], a[80:83], v[76:79]
  v_mfma_f32_16x16x32_bf16 v[80:83], a[248:251], a[104:107], v[80:83]
  v_mfma_f32_16x16x32_bf16 v[84:87], a[248:251], a[128:131], v[84:87]
  v_mfma_f32_16x16x32_bf16 v[88:91], a[248:251], a[152:155], v[88:91]
  v_mfma_f32_16x16x32_bf16 v[92:95], a[248:251], a[176:179], v[92:95]
  v_mfma_f32_16x16x32_bf16 v[96:99], a[248:251], a[200:203], v[96:99]
  v_mfma_f32_16x16x32_bf16 v[100:103], a[248:251], a[224:227], v[100:103]
  v_mfma_f32_16x16x32_bf16 v[64:67], a[252:255], a[12:15], v[64:67]
  v_mfma_f32_16x16x32_bf16 v[68:71], a[252:255], a[36:39], v[68:71]
  v_mfma_f32_16x16x32_bf16 v[72:75], a[252:255], a[60:63], v[72:75]
  v_mfma_f32_16x16x32_bf16 v[76:79], a[252:255], a[84:87], v[76:79]
  v_mfma_f32_16x16x32_bf16 v[80:83], a[252:255], a[108:111], v[80:83]
  v_mfma_f32_16x16x32_bf16 v[84:87], a[252:255], a[132:135], v[84:87]
  v_mfma_f32_16x16x32_bf16 v[88:91], a[252:255], a[156:159], v[88:91]
  v_mfma_f32_16x16x32_bf16 v[92:95], a[252:255], a[180:183], v[92:95]
  v_mfma_f32_16x16x32_bf16 v[96:99], a[252:255], a[204:207], v[96:99]
  v_mfma_f32_16x16x32_bf16 v[100:103], a[252:255], a[228:231], v[100:103]
  v_mfma_f32_16x16x32_bf16 v[64:67], v[248:251], a[16:19], v[64:67]
  v_mfma_f32_16x16x32_bf16 v[68:71], v[248:251], a[40:43], v[68:71]
  v_mfma_f32_16x16x32_bf16 v[72:75], v[248:251], a[64:67], v[72:75]
  v_mfma_f32_16x16x32_bf16 v[76:79], v[248:251], a[88:91], v[76:79]
  v_mfma_f32_16x16x32_bf16 v[80:83], v[248:251], a[112:115], v[80:83]
  v_mfma_f32_16x16x32_bf16 v[84:87], v[248:251], a[136:139], v[84:87]
  v_mfma_f32_16x16x32_bf16 v[88:91], v[248:251], a[160:163], v[88:91]
  v_mfma_f32_16x16x32_bf16 v[92:95], v[248:251], a[184:187], v[92:95]
  v_mfma_f32_16x16x32_bf16 v[96:99], v[248:251], a[208:211], v[96:99]
  v_mfma_f32_16x16x32_bf16 v[100:103], v[248:251], a[232:235], v[100:103]
  v_mfma_f32_16x16x32_bf16 v[64:67], v[252:255], a[20:23], v[64:67]
  v_mfma_f32_16x16x32_bf16 v[68:71], v[252:255], a[44:47], v[68:71]
  v_mfma_f32_16x16x32_bf16 v[72:75], v[252:255], a[68:71], v[72:75]
  v_mfma_f32_16x16x32_bf16 v[76:79], v[252:255], a[92:95], v[76:79]
  v_mfma_f32_16x16x32_bf16 v[80:83], v[252:255], a[116:119], v[80:83]
  v_mfma_f32_16x16x32_bf16 v[84:87], v[252:255], a[140:143], v[84:87]
  v_mfma_f32_16x16x32_bf16 v[88:91], v[252:255], a[164:167], v[88:91]
  v_mfma_f32_16x16x32_bf16 v[92:95], v[252:255], a[188:191], v[92:95]
  v_mfma_f32_16x16x32_bf16 v[96:99], v[252:255], a[212:215], v[96:99]
  v_mfma_f32_16x16x32_bf16 v[100:103], v[252:255], a[236:239], v[100:103]
  s_cmp_eq_u32 s54, 2
  s_cselect_b32 s61, -1, 0
  s_mov_b32 s60, -1
  s_cselect_b32 s58, 3, 1
  s_lshl_b32 s57, s55, 3
  s_and_b32 s21, s2, 7
  s_add_u32 s57, s57, s21
  s_lshl_b32 s57, s57, 7
  s_add_u32 s57, s57, 24576
  s_add_u32 s55, s55, s54
  v_cvt_pk_bf16_f32 v48, v64, v65
  v_cvt_pk_bf16_f32 v49, v66, v67
  v_cvt_pk_bf16_f32 v50, v68, v69
  v_cvt_pk_bf16_f32 v51, v70, v71
  v_cvt_pk_bf16_f32 v52, v72, v73
  v_cvt_pk_bf16_f32 v53, v74, v75
  v_cvt_pk_bf16_f32 v54, v76, v77
  v_cvt_pk_bf16_f32 v55, v78, v79
  v_cvt_pk_bf16_f32 v56, v80, v81
  v_cvt_pk_bf16_f32 v57, v82, v83
  v_cvt_pk_bf16_f32 v58, v84, v85
  v_cvt_pk_bf16_f32 v59, v86, v87
  v_cvt_pk_bf16_f32 v60, v88, v89
  v_cvt_pk_bf16_f32 v61, v90, v91
  v_cvt_pk_bf16_f32 v62, v92, v93
  v_cvt_pk_bf16_f32 v63, v94, v95
  v_cvt_pk_bf16_f32 v240, v96, v97
  v_cvt_pk_bf16_f32 v241, v98, v99
  v_cvt_pk_bf16_f32 v242, v100, v101
  v_cvt_pk_bf16_f32 v243, v102, v103
  v_min_u32 v48, -2, v48
  v_min_u32 v52, -2, v52
  v_min_u32 v56, -2, v56
  v_min_u32 v60, -2, v60
  v_min_u32 v240, -2, v240
  s_mov_b64 exec, s[60:61]
  buffer_store_dwordx4 v[48:51], v15, s[80:83], s63 offen offset:0 sc1
  buffer_store_dwordx4 v[52:55], v15, s[80:83], s63 offen offset:512 sc1
  buffer_store_dwordx4 v[56:59], v15, s[80:83], s63 offen offset:1024 sc1
  buffer_store_dwordx4 v[60:63], v15, s[80:83], s63 offen offset:1536 sc1
  buffer_store_dwordx4 v[240:243], v15, s[80:83], s63 offen offset:2048 sc1
  s_mov_b64 exec, -1
  s_add_u32 s63, s63, 655360
uf_192:
  s_add_u32 s21, s55, 4
  s_cmp_gt_u32 s21, s56
  s_cbranch_scc1 ux_194
  s_add_u32 s62, s62, 196608
  buffer_load_dwordx4 a[240:243], v18, s[76:79], s62 offen offset:0 sc1
  buffer_load_dwordx4 a[244:247], v18, s[76:79], s62 offen offset:512 sc1
  buffer_load_dwordx4 a[248:251], v18, s[76:79], s62 offen offset:1024 sc1
  buffer_load_dwordx4 a[252:255], v18, s[76:79], s62 offen offset:1536 sc1
  buffer_load_dwordx4 v[248:251], v18, s[76:79], s62 offen offset:2048 sc1
  buffer_load_dwordx4 v[252:255], v18, s[76:79], s62 offen offset:2560 sc1
  s_waitcnt vmcnt(11)
  s_cmp_eq_u32 s66, 0
  s_cbranch_scc1 uf_196
  s_mov_b64 exec, s[66:67]
  buffer_atomic_add v11, v17, s[72:75], s65 offen sc1
  s_mov_b64 exec, -1
  s_mov_b32 s66, 0
uf_196:
  s_mov_b32 s65, s57
  s_mov_b32 s66, s58
  s_mov_b32 s58, 0
  v_mfma_f32_16x16x32_bf16 v[64:67], v[24:27], a[0:3], 0
  v_mfma_f32_16x16x32_bf16 v[68:71], v[24:27], a[24:27], 0
  v_mfma_f32_16x16x32_bf16 v[72:75], v[24:27], a[48:51], 0
  v_mfma_f32_16x16x32_bf16 v[76:79], v[24:27], a[72:75], 0
  v_mfma_f32_16x16x32_bf16 v[80:83], v[24:27], a[96:99], 0
  v_mfma_f32_16x16x32_bf16 v[84:87], v[24:27], a[120:123], 0
  v_mfma_f32_16x16x32_bf16 v[88:91], v[24:27], a[144:147], 0
  v_mfma_f32_16x16x32_bf16 v[92:95], v[24:27], a[168:171], 0
  v_mfma_f32_16x16x32_bf16 v[96:99], v[24:27], a[192:195], 0
  v_mfma_f32_16x16x32_bf16 v[100:103], v[24:27], a[216:219], 0
  v_mfma_f32_16x16x32_bf16 v[64:67], v[28:31], a[4:7], v[64:67]
  v_mfma_f32_16x16x32_bf16 v[68:71], v[28:31], a[28:31], v[68:71]
  v_mfma_f32_16x16x32_bf16 v[72:75], v[28:31], a[52:55], v[72:75]
  v_mfma_f32_16x16x32_bf16 v[76:79], v[28:31], a[76:79], v[76:79]
  v_mfma_f32_16x16x32_bf16 v[80:83], v[28:31], a[100:103], v[80:83]
  v_mfma_f32_16x16x32_bf16 v[84:87], v[28:31], a[124:127], v[84:87]
  v_mfma_f32_16x16x32_bf16 v[88:91], v[28:31], a[148:151], v[88:91]
  v_mfma_f32_16x16x32_bf16 v[92:95], v[28:31], a[172:175], v[92:95]
  v_mfma_f32_16x16x32_bf16 v[96:99], v[28:31], a[196:199], v[96:99]
  v_mfma_f32_16x16x32_bf16 v[100:103], v[28:31], a[220:223], v[100:103]
  v_mfma_f32_16x16x32_bf16 v[64:67], v[32:35], a[8:11], v[64:67]
  v_mfma_f32_16x16x32_bf16 v[68:71], v[32:35], a[32:35], v[68:71]
  v_mfma_f32_16x16x32_bf16 v[72:75], v[32:35], a[56:59], v[72:75]
  v_mfma_f32_16x16x32_bf16 v[76:79], v[32:35], a[80:83], v[76:79]
  v_mfma_f32_16x16x32_bf16 v[80:83], v[32:35], a[104:107], v[80:83]
  v_mfma_f32_16x16x32_bf16 v[84:87], v[32:35], a[128:131], v[84:87]
  v_mfma_f32_16x16x32_bf16 v[88:91], v[32:35], a[152:155], v[88:91]
  v_mfma_f32_16x16x32_bf16 v[92:95], v[32:35], a[176:179], v[92:95]
  v_mfma_f32_16x16x32_bf16 v[96:99], v[32:35], a[200:203], v[96:99]
  v_mfma_f32_16x16x32_bf16 v[100:103], v[32:35], a[224:227], v[100:103]
  v_mfma_f32_16x16x32_bf16 v[64:67], v[36:39], a[12:15], v[64:67]
  v_mfma_f32_16x16x32_bf16 v[68:71], v[36:39], a[36:39], v[68:71]
  v_mfma_f32_16x16x32_bf16 v[72:75], v[36:39], a[60:63], v[72:75]
  v_mfma_f32_16x16x32_bf16 v[76:79], v[36:39], a[84:87], v[76:79]
  v_mfma_f32_16x16x32_bf16 v[80:83], v[36:39], a[108:111], v[80:83]
  v_mfma_f32_16x16x32_bf16 v[84:87], v[36:39], a[132:135], v[84:87]
  v_mfma_f32_16x16x32_bf16 v[88:91], v[36:39], a[156:159], v[88:91]
  v_mfma_f32_16x16x32_bf16 v[92:95], v[36:39], a[180:183], v[92:95]
  v_mfma_f32_16x16x32_bf16 v[96:99], v[36:39], a[204:207], v[96:99]
  v_mfma_f32_16x16x32_bf16 v[100:103], v[36:39], a[228:231], v[100:103]
  v_mfma_f32_16x16x32_bf16 v[64:67], v[40:43], a[16:19], v[64:67]
  v_mfma_f32_16x16x32_bf16 v[68:71], v[40:43], a[40:43], v[68:71]
  v_mfma_f32_16x16x32_bf16 v[72:75], v[40:43], a[64:67], v[72:75]
  v_mfma_f32_16x16x32_bf16 v[76:79], v[40:43], a[88:91], v[76:79]
  v_mfma_f32_16x16x32_bf16 v[80:83], v[40:43], a[112:115], v[80:83]
  v_mfma_f32_16x16x32_bf16 v[84:87], v[40:43], a[136:139], v[84:87]
  v_mfma_f32_16x16x32_bf16 v[88:91], v[40:43], a[160:163], v[88:91]
  v_mfma_f32_16x16x32_bf16 v[92:95], v[40:43], a[184:187], v[92:95]
  v_mfma_f32_16x16x32_bf16 v[96:99], v[40:43], a[208:211], v[96:99]
  v_mfma_f32_16x16x32_bf16 v[100:103], v[40:43], a[232:235], v[100:103]
  v_mfma_f32_16x16x32_bf16 v[64:67], v[44:47], a[20:23], v[64:67]
  v_mfma_f32_16x16x32_bf16 v[68:71], v[44:47], a[44:47], v[68:71]
  v_mfma_f32_16x16x32_bf16 v[72:75], v[44:47], a[68:71], v[72:75]
  v_mfma_f32_16x16x32_bf16 v[76:79], v[44:47], a[92:95], v[76:79]
  v_mfma_f32_16x16x32_bf16 v[80:83], v[44:47], a[116:119], v[80:83]
  v_mfma_f32_16x16x32_bf16 v[84:87], v[44:47], a[140:143], v[84:87]
  v_mfma_f32_16x16x32_bf16 v[88:91], v[44:47], a[164:167], v[88:91]
  v_mfma_f32_16x16x32_bf16 v[92:95], v[44:47], a[188:191], v[92:95]
  v_mfma_f32_16x16x32_bf16 v[96:99], v[44:47], a[212:215], v[96:99]
  v_mfma_f32_16x16x32_bf16 v[100:103], v[44:47], a[236:239], v[100:103]
  s_cmp_eq_u32 s54, 2
  s_cselect_b32 s61, -1, 0
  s_mov_b32 s60, -1
  s_cselect_b32 s58, 3, 1
  s_lshl_b32 s57, s55, 3
  s_and_b32 s21, s2, 7
  s_add_u32 s57, s57, s21
  s_lshl_b32 s57, s57, 7
  s_add_u32 s57, s57, 24576
  s_add_u32 s55, s55, s54
  v_cvt_pk_bf16_f32 v48, v64, v65
  v_cvt_pk_bf16_f32 v49, v66, v67
  v_cvt_pk_bf16_f32 v50, v68, v69
  v_cvt_pk_bf16_f32 v51, v70, v71
  v_cvt_pk_bf16_f32 v52, v72, v73
  v_cvt_pk_bf16_f32 v53, v74, v75
  v_cvt_pk_bf16_f32 v54, v76, v77
  v_cvt_pk_bf16_f32 v55, v78, v79
  v_cvt_pk_bf16_f32 v56, v80, v81
  v_cvt_pk_bf16_f32 v57, v82, v83
  v_cvt_pk_bf16_f32 v58, v84, v85
  v_cvt_pk_bf16_f32 v59, v86, v87
  v_cvt_pk_bf16_f32 v60, v88, v89
  v_cvt_pk_bf16_f32 v61, v90, v91
  v_cvt_pk_bf16_f32 v62, v92, v93
  v_cvt_pk_bf16_f32 v63, v94, v95
  v_cvt_pk_bf16_f32 v240, v96, v97
  v_cvt_pk_bf16_f32 v241, v98, v99
  v_cvt_pk_bf16_f32 v242, v100, v101
  v_cvt_pk_bf16_f32 v243, v102, v103
  v_min_u32 v48, -2, v48
  v_min_u32 v52, -2, v52
  v_min_u32 v56, -2, v56
  v_min_u32 v60, -2, v60
  v_min_u32 v240, -2, v240
  s_mov_b64 exec, s[60:61]
  buffer_store_dwordx4 v[48:51], v15, s[80:83], s63 offen offset:0 sc1
  buffer_store_dwordx4 v[52:55], v15, s[80:83], s63 offen offset:512 sc1
  buffer_store_dwordx4 v[56:59], v15, s[80:83], s63 offen offset:1024 sc1
  buffer_store_dwordx4 v[60:63], v15, s[80:83], s63 offen offset:1536 sc1
  buffer_store_dwordx4 v[240:243], v15, s[80:83], s63 offen offset:2048 sc1
  s_mov_b64 exec, -1
  s_add_u32 s63, s63, 655360
  s_add_u32 s21, s55, 4
  s_cmp_gt_u32 s21, s56
  s_cbranch_scc1 ux_193
  s_add_u32 s62, s62, 196608
  buffer_load_dwordx4 v[24:27], v18, s[76:79], s62 offen offset:0 sc1
  buffer_load_dwordx4 v[28:31], v18, s[76:79], s62 offen offset:512 sc1
  buffer_load_dwordx4 v[32:35], v18, s[76:79], s62 offen offset:1024 sc1
  buffer_load_dwordx4 v[36:39], v18, s[76:79], s62 offen offset:1536 sc1
  buffer_load_dwordx4 v[40:43], v18, s[76:79], s62 offen offset:2048 sc1
  buffer_load_dwordx4 v[44:47], v18, s[76:79], s62 offen offset:2560 sc1
  s_waitcnt vmcnt(11)
  s_cmp_eq_u32 s66, 0
  s_cbranch_scc1 uf_197
  s_mov_b64 exec, s[66:67]
  buffer_atomic_add v11, v17, s[72:75], s65 offen sc1
  s_mov_b64 exec, -1
  s_mov_b32 s66, 0
uf_197:
  s_mov_b32 s65, s57
  s_mov_b32 s66, s58
  s_mov_b32 s58, 0
  v_mfma_f32_16x16x32_bf16 v[64:67], a[240:243], a[0:3], 0
  v_mfma_f32_16x16x32_bf16 v[68:71], a[240:243], a[24:27], 0
  v_mfma_f32_16x16x32_bf16 v[72:75], a[240:243], a[48:51], 0
  v_mfma_f32_16x16x32_bf16 v[76:79], a[240:243], a[72:75], 0
  v_mfma_f32_16x16x32_bf16 v[80:83], a[240:243], a[96:99], 0
  v_mfma_f32_16x16x32_bf16 v[84:87], a[240:243], a[120:123], 0
  v_mfma_f32_16x16x32_bf16 v[88:91], a[240:243], a[144:147], 0
  v_mfma_f32_16x16x32_bf16 v[92:95], a[240:243], a[168:171], 0
  v_mfma_f32_16x16x32_bf16 v[96:99], a[240:243], a[192:195], 0
  v_mfma_f32_16x16x32_bf16 v[100:103], a[240:243], a[216:219], 0
  v_mfma_f32_16x16x32_bf16 v[64:67], a[244:247], a[4:7], v[64:67]
  v_mfma_f32_16x16x32_bf16 v[68:71], a[244:247], a[28:31], v[68:71]
  v_mfma_f32_16x16x32_bf16 v[72:75], a[244:247], a[52:55], v[72:75]
  v_mfma_f32_16x16x32_bf16 v[76:79], a[244:247], a[76:79], v[76:79]
  v_mfma_f32_16x16x32_bf16 v[80:83], a[244:247], a[100:103], v[80:83]
  v_mfma_f32_16x16x32_bf16 v[84:87], a[244:247], a[124:127], v[84:87]
  v_mfma_f32_16x16x32_bf16 v[88:91], a[244:247], a[148:151], v[88:91]
  v_mfma_f32_16x16x32_bf16 v[92:95], a[244:247], a[172:175], v[92:95]
  v_mfma_f32_16x16x32_bf16 v[96:99], a[244:247], a[196:199], v[96:99]
  v_mfma_f32_16x16x32_bf16 v[100:103], a[244:247], a[220:223], v[100:103]
  v_mfma_f32_16x16x32_bf16 v[64:67], a[248:251], a[8:11], v[64:67]
  v_mfma_f32_16x16x32_bf16 v[68:71], a[248:251], a[32:35], v[68:71]
  v_mfma_f32_16x16x32_bf16 v[72:75], a[248:251], a[56:59], v[72:75]
  v_mfma_f32_16x16x32_bf16 v[76:79], a[248:251], a[80:83], v[76:79]
  v_mfma_f32_16x16x32_bf16 v[80:83], a[248:251], a[104:107], v[80:83]
  v_mfma_f32_16x16x32_bf16 v[84:87], a[248:251], a[128:131], v[84:87]
  v_mfma_f32_16x16x32_bf16 v[88:91], a[248:251], a[152:155], v[88:91]
  v_mfma_f32_16x16x32_bf16 v[92:95], a[248:251], a[176:179], v[92:95]
  v_mfma_f32_16x16x32_bf16 v[96:99], a[248:251], a[200:203], v[96:99]
  v_mfma_f32_16x16x32_bf16 v[100:103], a[248:251], a[224:227], v[100:103]
  v_mfma_f32_16x16x32_bf16 v[64:67], a[252:255], a[12:15], v[64:67]
  v_mfma_f32_16x16x32_bf16 v[68:71], a[252:255], a[36:39], v[68:71]
  v_mfma_f32_16x16x32_bf16 v[72:75], a[252:255], a[60:63], v[72:75]
  v_mfma_f32_16x16x32_bf16 v[76:79], a[252:255], a[84:87], v[76:79]
  v_mfma_f32_16x16x32_bf16 v[80:83], a[252:255], a[108:111], v[80:83]
  v_mfma_f32_16x16x32_bf16 v[84:87], a[252:255], a[132:135], v[84:87]
  v_mfma_f32_16x16x32_bf16 v[88:91], a[252:255], a[156:159], v[88:91]
  v_mfma_f32_16x16x32_bf16 v[92:95], a[252:255], a[180:183], v[92:95]
  v_mfma_f32_16x16x32_bf16 v[96:99], a[252:255], a[204:207], v[96:99]
  v_mfma_f32_16x16x32_bf16 v[100:103], a[252:255], a[228:231], v[100:103]
  v_mfma_f32_16x16x32_bf16 v[64:67], v[248:251], a[16:19], v[64:67]
  v_mfma_f32_16x16x32_bf16 v[68:71], v[248:251], a[40:43], v[68:71]
  v_mfma_f32_16x16x32_bf16 v[72:75], v[248:251], a[64:67], v[72:75]
  v_mfma_f32_16x16x32_bf16 v[76:79], v[248:251], a[88:91], v[76:79]
  v_mfma_f32_16x16x32_bf16 v[80:83], v[248:251], a[112:115], v[80:83]
  v_mfma_f32_16x16x32_bf16 v[84:87], v[248:251], a[136:139], v[84:87]
  v_mfma_f32_16x16x32_bf16 v[88:91], v[248:251], a[160:163], v[88:91]
  v_mfma_f32_16x16x32_bf16 v[92:95], v[248:251], a[184:187], v[92:95]
  v_mfma_f32_16x16x32_bf16 v[96:99], v[248:251], a[208:211], v[96:99]
  v_mfma_f32_16x16x32_bf16 v[100:103], v[248:251], a[232:235], v[100:103]
  v_mfma_f32_16x16x32_bf16 v[64:67], v[252:255], a[20:23], v[64:67]
  v_mfma_f32_16x16x32_bf16 v[68:71], v[252:255], a[44:47], v[68:71]
  v_mfma_f32_16x16x32_bf16 v[72:75], v[252:255], a[68:71], v[72:75]
  v_mfma_f32_16x16x32_bf16 v[76:79], v[252:255], a[92:95], v[76:79]
  v_mfma_f32_16x16x32_bf16 v[80:83], v[252:255], a[116:119], v[80:83]
  v_mfma_f32_16x16x32_bf16 v[84:87], v[252:255], a[140:143], v[84:87]
  v_mfma_f32_16x16x32_bf16 v[88:91], v[252:255], a[164:167], v[88:91]
  v_mfma_f32_16x16x32_bf16 v[92:95], v[252:255], a[188:191], v[92:95]
  v_mfma_f32_16x16x32_bf16 v[96:99], v[252:255], a[212:215], v[96:99]
  v_mfma_f32_16x16x32_bf16 v[100:103], v[252:255], a[236:239], v[100:103]
  s_cmp_eq_u32 s54, 2
  s_cselect_b32 s61, -1, 0
  s_mov_b32 s60, -1
  s_cselect_b32 s58, 3, 1
  s_lshl_b32 s57, s55, 3
  s_and_b32 s21, s2, 7
  s_add_u32 s57, s57, s21
  s_lshl_b32 s57, s57, 7
  s_add_u32 s57, s57, 24576
  s_add_u32 s55, s55, s54
  v_cvt_pk_bf16_f32 v48, v64, v65
  v_cvt_pk_bf16_f32 v49, v66, v67
  v_cvt_pk_bf16_f32 v50, v68, v69
  v_cvt_pk_bf16_f32 v51, v70, v71
  v_cvt_pk_bf16_f32 v52, v72, v73
  v_cvt_pk_bf16_f32 v53, v74, v75
  v_cvt_pk_bf16_f32 v54, v76, v77
  v_cvt_pk_bf16_f32 v55, v78, v79
  v_cvt_pk_bf16_f32 v56, v80, v81
  v_cvt_pk_bf16_f32 v57, v82, v83
  v_cvt_pk_bf16_f32 v58, v84, v85
  v_cvt_pk_bf16_f32 v59, v86, v87
  v_cvt_pk_bf16_f32 v60, v88, v89
  v_cvt_pk_bf16_f32 v61, v90, v91
  v_cvt_pk_bf16_f32 v62, v92, v93
  v_cvt_pk_bf16_f32 v63, v94, v95
  v_cvt_pk_bf16_f32 v240, v96, v97
  v_cvt_pk_bf16_f32 v241, v98, v99
  v_cvt_pk_bf16_f32 v242, v100, v101
  v_cvt_pk_bf16_f32 v243, v102, v103
  v_min_u32 v48, -2, v48
  v_min_u32 v52, -2, v52
  v_min_u32 v56, -2, v56
  v_min_u32 v60, -2, v60
  v_min_u32 v240, -2, v240
  s_mov_b64 exec, s[60:61]
  buffer_store_dwordx4 v[48:51], v15, s[80:83], s63 offen offset:0 sc1
  buffer_store_dwordx4 v[52:55], v15, s[80:83], s63 offen offset:512 sc1
  buffer_store_dwordx4 v[56:59], v15, s[80:83], s63 offen offset:1024 sc1
  buffer_store_dwordx4 v[60:63], v15, s[80:83], s63 offen offset:1536 sc1
  buffer_store_dwordx4 v[240:243], v15, s[80:83], s63 offen offset:2048 sc1
  s_mov_b64 exec, -1
  s_add_u32 s63, s63, 655360
  s_branch uf_192
ux_194:
  s_waitcnt vmcnt(0)
  s_cmp_eq_u32 s66, 0
  s_cbranch_scc1 uf_198
  s_mov_b64 exec, s[66:67]
  buffer_atomic_add v11, v17, s[72:75], s65 offen sc1
  s_mov_b64 exec, -1
  s_mov_b32 s66, 0
uf_198:
  s_cmp_eq_u32 s58, 0
  s_cbranch_scc1 uf_199
  s_mov_b64 exec, s[58:59]
  buffer_atomic_add v11, v17, s[72:75], s57 offen sc1
  s_mov_b64 exec, -1
  s_mov_b32 s58, 0
uf_199:
  v_mfma_f32_16x16x32_bf16 v[64:67], v[24:27], a[0:3], 0
  v_mfma_f32_16x16x32_bf16 v[68:71], v[24:27], a[24:27], 0
  v_mfma_f32_16x16x32_bf16 v[72:75], v[24:27], a[48:51], 0
  v_mfma_f32_16x16x32_bf16 v[76:79], v[24:27], a[72:75], 0
  v_mfma_f32_16x16x32_bf16 v[80:83], v[24:27], a[96:99], 0
  v_mfma_f32_16x16x32_bf16 v[84:87], v[24:27], a[120:123], 0
  v_mfma_f32_16x16x32_bf16 v[88:91], v[24:27], a[144:147], 0
  v_mfma_f32_16x16x32_bf16 v[92:95], v[24:27], a[168:171], 0
  v_mfma_f32_16x16x32_bf16 v[96:99], v[24:27], a[192:195], 0
  v_mfma_f32_16x16x32_bf16 v[100:103], v[24:27], a[216:219], 0
  v_mfma_f32_16x16x32_bf16 v[64:67], v[28:31], a[4:7], v[64:67]
  v_mfma_f32_16x16x32_bf16 v[68:71], v[28:31], a[28:31], v[68:71]
  v_mfma_f32_16x16x32_bf16 v[72:75], v[28:31], a[52:55], v[72:75]
  v_mfma_f32_16x16x32_bf16 v[76:79], v[28:31], a[76:79], v[76:79]
  v_mfma_f32_16x16x32_bf16 v[80:83], v[28:31], a[100:103], v[80:83]
  v_mfma_f32_16x16x32_bf16 v[84:87], v[28:31], a[124:127], v[84:87]
  v_mfma_f32_16x16x32_bf16 v[88:91], v[28:31], a[148:151], v[88:91]
  v_mfma_f32_16x16x32_bf16 v[92:95], v[28:31], a[172:175], v[92:95]
  v_mfma_f32_16x16x32_bf16 v[96:99], v[28:31], a[196:199], v[96:99]
  v_mfma_f32_16x16x32_bf16 v[100:103], v[28:31], a[220:223], v[100:103]
  v_mfma_f32_16x16x32_bf16 v[64:67], v[32:35], a[8:11], v[64:67]
  v_mfma_f32_16x16x32_bf16 v[68:71], v[32:35], a[32:35], v[68:71]
  v_mfma_f32_16x16x32_bf16 v[72:75], v[32:35], a[56:59], v[72:75]
  v_mfma_f32_16x16x32_bf16 v[76:79], v[32:35], a[80:83], v[76:79]
  v_mfma_f32_16x16x32_bf16 v[80:83], v[32:35], a[104:107], v[80:83]
  v_mfma_f32_16x16x32_bf16 v[84:87], v[32:35], a[128:131], v[84:87]
  v_mfma_f32_16x16x32_bf16 v[88:91], v[32:35], a[152:155], v[88:91]
  v_mfma_f32_16x16x32_bf16 v[92:95], v[32:35], a[176:179], v[92:95]
  v_mfma_f32_16x16x32_bf16 v[96:99], v[32:35], a[200:203], v[96:99]
  v_mfma_f32_16x16x32_bf16 v[100:103], v[32:35], a[224:227], v[100:103]
  v_mfma_f32_16x16x32_bf16 v[64:67], v[36:39], a[12:15], v[64:67]
  v_mfma_f32_16x16x32_bf16 v[68:71], v[36:39], a[36:39], v[68:71]
  v_mfma_f32_16x16x32_bf16 v[72:75], v[36:39], a[60:63], v[72:75]
  v_mfma_f32_16x16x32_bf16 v[76:79], v[36:39], a[84:87], v[76:79]
  v_mfma_f32_16x16x32_bf16 v[80:83], v[36:39], a[108:111], v[80:83]
  v_mfma_f32_16x16x32_bf16 v[84:87], v[36:39], a[132:135], v[84:87]
  v_mfma_f32_16x16x32_bf16 v[88:91], v[36:39], a[156:159], v[88:91]
  v_mfma_f32_16x16x32_bf16 v[92:95], v[36:39], a[180:183], v[92:95]
  v_mfma_f32_16x16x32_bf16 v[96:99], v[36:39], a[204:207], v[96:99]
  v_mfma_f32_16x16x32_bf16 v[100:103], v[36:39], a[228:231], v[100:103]
  v_mfma_f32_16x16x32_bf16 v[64:67], v[40:43], a[16:19], v[64:67]
  v_mfma_f32_16x16x32_bf16 v[68:71], v[40:43], a[40:43], v[68:71]
  v_mfma_f32_16x16x32_bf16 v[72:75], v[40:43], a[64:67], v[72:75]
  v_mfma_f32_16x16x32_bf16 v[76:79], v[40:43], a[88:91], v[76:79]
  v_mfma_f32_16x16x32_bf16 v[80:83], v[40:43], a[112:115], v[80:83]
  v_mfma_f32_16x16x32_bf16 v[84:87], v[40:43], a[136:139], v[84:87]
  v_mfma_f32_16x16x32_bf16 v[88:91], v[40:43], a[160:163], v[88:91]
  v_mfma_f32_16x16x32_bf16 v[92:95], v[40:43], a[184:187], v[92:95]
  v_mfma_f32_16x16x32_bf16 v[96:99], v[40:43], a[208:211], v[96:99]
  v_mfma_f32_16x16x32_bf16 v[100:103], v[40:43], a[232:235], v[100:103]
  v_mfma_f32_16x16x32_bf16 v[64:67], v[44:47], a[20:23], v[64:67]
  v_mfma_f32_16x16x32_bf16 v[68:71], v[44:47], a[44:47], v[68:71]
  v_mfma_f32_16x16x32_bf16 v[72:75], v[44:47], a[68:71], v[72:75]
  v_mfma_f32_16x16x32_bf16 v[76:79], v[44:47], a[92:95], v[76:79]
  v_mfma_f32_16x16x32_bf16 v[80:83], v[44:47], a[116:119], v[80:83]
  v_mfma_f32_16x16x32_bf16 v[84:87], v[44:47], a[140:143], v[84:87]
  v_mfma_f32_16x16x32_bf16 v[88:91], v[44:47], a[164:167], v[88:91]
  v_mfma_f32_16x16x32_bf16 v[92:95], v[44:47], a[188:191], v[92:95]
  v_mfma_f32_16x16x32_bf16 v[96:99], v[44:47], a[212:215], v[96:99]
  v_mfma_f32_16x16x32_bf16 v[100:103], v[44:47], a[236:239], v[100:103]
  s_cmp_eq_u32 s54, 2
  s_cselect_b32 s61, -1, 0
  s_mov_b32 s60, -1
  s_cselect_b32 s58, 3, 1
  s_lshl_b32 s57, s55, 3
  s_and_b32 s21, s2, 7
  s_add_u32 s57, s57, s21
  s_lshl_b32 s57, s57, 7
  s_add_u32 s57, s57, 24576
  s_add_u32 s55, s55, s54
  v_cvt_pk_bf16_f32 v48, v64, v65
  v_cvt_pk_bf16_f32 v49, v66, v67
  v_cvt_pk_bf16_f32 v50, v68, v69
  v_cvt_pk_bf16_f32 v51, v70, v71
  v_cvt_pk_bf16_f32 v52, v72, v73
  v_cvt_pk_bf16_f32 v53, v74, v75
  v_cvt_pk_bf16_f32 v54, v76, v77
  v_cvt_pk_bf16_f32 v55, v78, v79
  v_cvt_pk_bf16_f32 v56, v80, v81
  v_cvt_pk_bf16_f32 v57, v82, v83
  v_cvt_pk_bf16_f32 v58, v84, v85
  v_cvt_pk_bf16_f32 v59, v86, v87
  v_cvt_pk_bf16_f32 v60, v88, v89
  v_cvt_pk_bf16_f32 v61, v90, v91
  v_cvt_pk_bf16_f32 v62, v92, v93
  v_cvt_pk_bf16_f32 v63, v94, v95
  v_cvt_pk_bf16_f32 v240, v96, v97
  v_cvt_pk_bf16_f32 v241, v98, v99
  v_cvt_pk_bf16_f32 v242, v100, v101
  v_cvt_pk_bf16_f32 v243, v102, v103
  v_min_u32 v48, -2, v48
  v_min_u32 v52, -2, v52
  v_min_u32 v56, -2, v56
  v_min_u32 v60, -2, v60
  v_min_u32 v240, -2, v240
  s_mov_b64 exec, s[60:61]
  buffer_store_dwordx4 v[48:51], v15, s[80:83], s63 offen offset:0 sc1
  buffer_store_dwordx4 v[52:55], v15, s[80:83], s63 offen offset:512 sc1
  buffer_store_dwordx4 v[56:59], v15, s[80:83], s63 offen offset:1024 sc1
  buffer_store_dwordx4 v[60:63], v15, s[80:83], s63 offen offset:1536 sc1
  buffer_store_dwordx4 v[240:243], v15, s[80:83], s63 offen offset:2048 sc1
  s_mov_b64 exec, -1
  s_add_u32 s63, s63, 655360
  s_branch ul_184
ux_193:
  s_waitcnt vmcnt(0)
  s_cmp_eq_u32 s66, 0
  s_cbranch_scc1 uf_200
  s_mov_b64 exec, s[66:67]
  buffer_atomic_add v11, v17, s[72:75], s65 offen sc1
  s_mov_b64 exec, -1
  s_mov_b32 s66, 0
uf_200:
  s_cmp_eq_u32 s58, 0
  s_cbranch_scc1 uf_201
  s_mov_b64 exec, s[58:59]
  buffer_atomic_add v11, v17, s[72:75], s57 offen sc1
  s_mov_b64 exec, -1
  s_mov_b32 s58, 0
uf_201:
  v_mfma_f32_16x16x32_bf16 v[64:67], a[240:243], a[0:3], 0
  v_mfma_f32_16x16x32_bf16 v[68:71], a[240:243], a[24:27], 0
  v_mfma_f32_16x16x32_bf16 v[72:75], a[240:243], a[48:51], 0
  v_mfma_f32_16x16x32_bf16 v[76:79], a[240:243], a[72:75], 0
  v_mfma_f32_16x16x32_bf16 v[80:83], a[240:243], a[96:99], 0
  v_mfma_f32_16x16x32_bf16 v[84:87], a[240:243], a[120:123], 0
  v_mfma_f32_16x16x32_bf16 v[88:91], a[240:243], a[144:147], 0
  v_mfma_f32_16x16x32_bf16 v[92:95], a[240:243], a[168:171], 0
  v_mfma_f32_16x16x32_bf16 v[96:99], a[240:243], a[192:195], 0
  v_mfma_f32_16x16x32_bf16 v[100:103], a[240:243], a[216:219], 0
  v_mfma_f32_16x16x32_bf16 v[64:67], a[244:247], a[4:7], v[64:67]
  v_mfma_f32_16x16x32_bf16 v[68:71], a[244:247], a[28:31], v[68:71]
  v_mfma_f32_16x16x32_bf16 v[72:75], a[244:247], a[52:55], v[72:75]
  v_mfma_f32_16x16x32_bf16 v[76:79], a[244:247], a[76:79], v[76:79]
  v_mfma_f32_16x16x32_bf16 v[80:83], a[244:247], a[100:103], v[80:83]
  v_mfma_f32_16x16x32_bf16 v[84:87], a[244:247], a[124:127], v[84:87]
  v_mfma_f32_16x16x32_bf16 v[88:91], a[244:247], a[148:151], v[88:91]
  v_mfma_f32_16x16x32_bf16 v[92:95], a[244:247], a[172:175], v[92:95]
  v_mfma_f32_16x16x32_bf16 v[96:99], a[244:247], a[196:199], v[96:99]
  v_mfma_f32_16x16x32_bf16 v[100:103], a[244:247], a[220:223], v[100:103]
  v_mfma_f32_16x16x32_bf16 v[64:67], a[248:251], a[8:11], v[64:67]
  v_mfma_f32_16x16x32_bf16 v[68:71], a[248:251], a[32:35], v[68:71]
  v_mfma_f32_16x16x32_bf16 v[72:75], a[248:251], a[56:59], v[72:75]
  v_mfma_f32_16x16x32_bf16 v[76:79], a[248:251], a[80:83], v[76:79]
  v_mfma_f32_16x16x32_bf16 v[80:83], a[248:251], a[104:107], v[80:83]
  v_mfma_f32_16x16x32_bf16 v[84:87], a[248:251], a[128:131], v[84:87]
  v_mfma_f32_16x16x32_bf16 v[88:91], a[248:251], a[152:155], v[88:91]
  v_mfma_f32_16x16x32_bf16 v[92:95], a[248:251], a[176:179], v[92:95]
  v_mfma_f32_16x16x32_bf16 v[96:99], a[248:251], a[200:203], v[96:99]
  v_mfma_f32_16x16x32_bf16 v[100:103], a[248:251], a[224:227], v[100:103]
  v_mfma_f32_16x16x32_bf16 v[64:67], a[252:255], a[12:15], v[64:67]
  v_mfma_f32_16x16x32_bf16 v[68:71], a[252:255], a[36:39], v[68:71]
  v_mfma_f32_16x16x32_bf16 v[72:75], a[252:255], a[60:63], v[72:75]
  v_mfma_f32_16x16x32_bf16 v[76:79], a[252:255], a[84:87], v[76:79]
  v_mfma_f32_16x16x32_bf16 v[80:83], a[252:255], a[108:111], v[80:83]
  v_mfma_f32_16x16x32_bf16 v[84:87], a[252:255], a[132:135], v[84:87]
  v_mfma_f32_16x16x32_bf16 v[88:91], a[252:255], a[156:159], v[88:91]
  v_mfma_f32_16x16x32_bf16 v[92:95], a[252:255], a[180:183], v[92:95]
  v_mfma_f32_16x16x32_bf16 v[96:99], a[252:255], a[204:207], v[96:99]
  v_mfma_f32_16x16x32_bf16 v[100:103], a[252:255], a[228:231], v[100:103]
  v_mfma_f32_16x16x32_bf16 v[64:67], v[248:251], a[16:19], v[64:67]
  v_mfma_f32_16x16x32_bf16 v[68:71], v[248:251], a[40:43], v[68:71]
  v_mfma_f32_16x16x32_bf16 v[72:75], v[248:251], a[64:67], v[72:75]
  v_mfma_f32_16x16x32_bf16 v[76:79], v[248:251], a[88:91], v[76:79]
  v_mfma_f32_16x16x32_bf16 v[80:83], v[248:251], a[112:115], v[80:83]
  v_mfma_f32_16x16x32_bf16 v[84:87], v[248:251], a[136:139], v[84:87]
  v_mfma_f32_16x16x32_bf16 v[88:91], v[248:251], a[160:163], v[88:91]
  v_mfma_f32_16x16x32_bf16 v[92:95], v[248:251], a[184:187], v[92:95]
  v_mfma_f32_16x16x32_bf16 v[96:99], v[248:251], a[208:211], v[96:99]
  v_mfma_f32_16x16x32_bf16 v[100:103], v[248:251], a[232:235], v[100:103]
  v_mfma_f32_16x16x32_bf16 v[64:67], v[252:255], a[20:23], v[64:67]
  v_mfma_f32_16x16x32_bf16 v[68:71], v[252:255], a[44:47], v[68:71]
  v_mfma_f32_16x16x32_bf16 v[72:75], v[252:255], a[68:71], v[72:75]
  v_mfma_f32_16x16x32_bf16 v[76:79], v[252:255], a[92:95], v[76:79]
  v_mfma_f32_16x16x32_bf16 v[80:83], v[252:255], a[116:119], v[80:83]
  v_mfma_f32_16x16x32_bf16 v[84:87], v[252:255], a[140:143], v[84:87]
  v_mfma_f32_16x16x32_bf16 v[88:91], v[252:255], a[164:167], v[88:91]
  v_mfma_f32_16x16x32_bf16 v[92:95], v[252:255], a[188:191], v[92:95]
  v_mfma_f32_16x16x32_bf16 v[96:99], v[252:255], a[212:215], v[96:99]
  v_mfma_f32_16x16x32_bf16 v[100:103], v[252:255], a[236:239], v[100:103]
  s_cmp_eq_u32 s54, 2
  s_cselect_b32 s61, -1, 0
  s_mov_b32 s60, -1
  s_cselect_b32 s58, 3, 1
  s_lshl_b32 s57, s55, 3
  s_and_b32 s21, s2, 7
  s_add_u32 s57, s57, s21
  s_lshl_b32 s57, s57, 7
  s_add_u32 s57, s57, 24576
  s_add_u32 s55, s55, s54
  v_cvt_pk_bf16_f32 v48, v64, v65
  v_cvt_pk_bf16_f32 v49, v66, v67
  v_cvt_pk_bf16_f32 v50, v68, v69
  v_cvt_pk_bf16_f32 v51, v70, v71
  v_cvt_pk_bf16_f32 v52, v72, v73
  v_cvt_pk_bf16_f32 v53, v74, v75
  v_cvt_pk_bf16_f32 v54, v76, v77
  v_cvt_pk_bf16_f32 v55, v78, v79
  v_cvt_pk_bf16_f32 v56, v80, v81
  v_cvt_pk_bf16_f32 v57, v82, v83
  v_cvt_pk_bf16_f32 v58, v84, v85
  v_cvt_pk_bf16_f32 v59, v86, v87
  v_cvt_pk_bf16_f32 v60, v88, v89
  v_cvt_pk_bf16_f32 v61, v90, v91
  v_cvt_pk_bf16_f32 v62, v92, v93
  v_cvt_pk_bf16_f32 v63, v94, v95
  v_cvt_pk_bf16_f32 v240, v96, v97
  v_cvt_pk_bf16_f32 v241, v98, v99
  v_cvt_pk_bf16_f32 v242, v100, v101
  v_cvt_pk_bf16_f32 v243, v102, v103
  v_min_u32 v48, -2, v48
  v_min_u32 v52, -2, v52
  v_min_u32 v56, -2, v56
  v_min_u32 v60, -2, v60
  v_min_u32 v240, -2, v240
  s_mov_b64 exec, s[60:61]
  buffer_store_dwordx4 v[48:51], v15, s[80:83], s63 offen offset:0 sc1
  buffer_store_dwordx4 v[52:55], v15, s[80:83], s63 offen offset:512 sc1
  buffer_store_dwordx4 v[56:59], v15, s[80:83], s63 offen offset:1024 sc1
  buffer_store_dwordx4 v[60:63], v15, s[80:83], s63 offen offset:1536 sc1
  buffer_store_dwordx4 v[240:243], v15, s[80:83], s63 offen offset:2048 sc1
  s_mov_b64 exec, -1
  s_add_u32 s63, s63, 655360
  s_branch ul_184
uo_191:
  s_sub_u32 s21, s56, s55
  s_cmp_ge_u32 s21, 2
  s_cselect_b64 vcc, -1, 0
  s_cselect_b32 s54, 2, 1
  v_cndmask_b32 v18, v13, v14, vcc
  s_lshl_b32 s21, s55, 5
  s_add_u32 s21, s21, s2
  s_mul_i32 s62, s21, 3072
  s_mul_i32 s63, s21, 10240
  s_mul_i32 s22, s20, 2560
  s_add_u32 s63, s63, s22
  buffer_load_dwordx4 a[240:243], v18, s[76:79], s62 offen offset:0 sc1
  buffer_load_dwordx4 a[244:247], v18, s[76:79], s62 offen offset:512 sc1
  buffer_load_dwordx4 a[248:251], v18, s[76:79], s62 offen offset:1024 sc1
  buffer_load_dwordx4 a[252:255], v18, s[76:79], s62 offen offset:1536 sc1
  buffer_load_dwordx4 v[248:251], v18, s[76:79], s62 offen offset:2048 sc1
  buffer_load_dwordx4 v[252:255], v18, s[76:79], s62 offen offset:2560 sc1
  s_waitcnt vmcnt(0)
  s_cmp_eq_u32 s58, 0
  s_cbranch_scc1 uf_202
  s_mov_b64 exec, s[58:59]
  buffer_atomic_add v11, v17, s[72:75], s57 offen sc1
  s_mov_b64 exec, -1
  s_mov_b32 s58, 0
uf_202:
  v_mfma_f32_16x16x32_bf16 v[64:67], a[240:243], a[0:3], 0
  v_mfma_f32_16x16x32_bf16 v[68:71], a[240:243], a[24:27], 0
  v_mfma_f32_16x16x32_bf16 v[72:75], a[240:243], a[48:51], 0
  v_mfma_f32_16x16x32_bf16 v[76:79], a[240:243], a[72:75], 0
  v_mfma_f32_16x16x32_bf16 v[80:83], a[240:243], a[96:99], 0
  v_mfma_f32_16x16x32_bf16 v[84:87], a[240:243], a[120:123], 0
  v_mfma_f32_16x16x32_bf16 v[88:91], a[240:243], a[144:147], 0
  v_mfma_f32_16x16x32_bf16 v[92:95], a[240:243], a[168:171], 0
  v_mfma_f32_16x16x32_bf16 v[96:99], a[240:243], a[192:195], 0
  v_mfma_f32_16x16x32_bf16 v[100:103], a[240:243], a[216:219], 0
  v_mfma_f32_16x16x32_bf16 v[64:67], a[244:247], a[4:7], v[64:67]
  v_mfma_f32_16x16x32_bf16 v[68:71], a[244:247], a[28:31], v[68:71]
  v_mfma_f32_16x16x32_bf16 v[72:75], a[244:247], a[52:55], v[72:75]
  v_mfma_f32_16x16x32_bf16 v[76:79], a[244:247], a[76:79], v[76:79]
  v_mfma_f32_16x16x32_bf16 v[80:83], a[244:247], a[100:103], v[80:83]
  v_mfma_f32_16x16x32_bf16 v[84:87], a[244:247], a[124:127], v[84:87]
  v_mfma_f32_16x16x32_bf16 v[88:91], a[244:247], a[148:151], v[88:91]
  v_mfma_f32_16x16x32_bf16 v[92:95], a[244:247], a[172:175], v[92:95]
  v_mfma_f32_16x16x32_bf16 v[96:99], a[244:247], a[196:199], v[96:99]
  v_mfma_f32_16x16x32_bf16 v[100:103], a[244:247], a[220:223], v[100:103]
  v_mfma_f32_16x16x32_bf16 v[64:67], a[248:251], a[8:11], v[64:67]
  v_mfma_f32_16x16x32_bf16 v[68:71], a[248:251], a[32:35], v[68:71]
  v_mfma_f32_16x16x32_bf16 v[72:75], a[248:251], a[56:59], v[72:75]
  v_mfma_f32_16x16x32_bf16 v[76:79], a[248:251], a[80:83], v[76:79]
  v_mfma_f32_16x16x32_bf16 v[80:83], a[248:251], a[104:107], v[80:83]
  v_mfma_f32_16x16x32_bf16 v[84:87], a[248:251], a[128:131], v[84:87]
  v_mfma_f32_16x16x32_bf16 v[88:91], a[248:251], a[152:155], v[88:91]
  v_mfma_f32_16x16x32_bf16 v[92:95], a[248:251], a[176:179], v[92:95]
  v_mfma_f32_16x16x32_bf16 v[96:99], a[248:251], a[200:203], v[96:99]
  v_mfma_f32_16x16x32_bf16 v[100:103], a[248:251], a[224:227], v[100:103]
  v_mfma_f32_16x16x32_bf16 v[64:67], a[252:255], a[12:15], v[64:67]
  v_mfma_f32_16x16x32_bf16 v[68:71], a[252:255], a[36:39], v[68:71]
  v_mfma_f32_16x16x32_bf16 v[72:75], a[252:255], a[60:63], v[72:75]
  v_mfma_f32_16x16x32_bf16 v[76:79], a[252:255], a[84:87], v[76:79]
  v_mfma_f32_16x16x32_bf16 v[80:83], a[252:255], a[108:111], v[80:83]
  v_mfma_f32_16x16x32_bf16 v[84:87], a[252:255], a[132:135], v[84:87]
  v_mfma_f32_16x16x32_bf16 v[88:91], a[252:255], a[156:159], v[88:91]
  v_mfma_f32_16x16x32_bf16 v[92:95], a[252:255], a[180:183], v[92:95]
  v_mfma_f32_16x16x32_bf16 v[96:99], a[252:255], a[204:207], v[96:99]
  v_mfma_f32_16x16x32_bf16 v[100:103], a[252:255], a[228:231], v[100:103]
  v_mfma_f32_16x16x32_bf16 v[64:67], v[248:251], a[16:19], v[64:67]
  v_mfma_f32_16x16x32_bf16 v[68:71], v[248:251], a[40:43], v[68:71]
  v_mfma_f32_16x16x32_bf16 v[72:75], v[248:251], a[64:67], v[72:75]
  v_mfma_f32_16x16x32_bf16 v[76:79], v[248:251], a[88:91], v[76:79]
  v_mfma_f32_16x16x32_bf16 v[80:83], v[248:251], a[112:115], v[80:83]
  v_mfma_f32_16x16x32_bf16 v[84:87], v[248:251], a[136:139], v[84:87]
  v_mfma_f32_16x16x32_bf16 v[88:91], v[248:251], a[160:163], v[88:91]
  v_mfma_f32_16x16x32_bf16 v[92:95], v[248:251], a[184:187], v[92:95]
  v_mfma_f32_16x16x32_bf16 v[96:99], v[248:251], a[208:211], v[96:99]
  v_mfma_f32_16x16x32_bf16 v[100:103], v[248:251], a[232:235], v[100:103]
  v_mfma_f32_16x16x32_bf16 v[64:67], v[252:255], a[20:23], v[64:67]
  v_mfma_f32_16x16x32_bf16 v[68:71], v[252:255], a[44:47], v[68:71]
  v_mfma_f32_16x16x32_bf16 v[72:75], v[252:255], a[68:71], v[72:75]
  v_mfma_f32_16x16x32_bf16 v[76:79], v[252:255], a[92:95], v[76:79]
  v_mfma_f32_16x16x32_bf16 v[80:83], v[252:255], a[116:119], v[80:83]
  v_mfma_f32_16x16x32_bf16 v[84:87], v[252:255], a[140:143], v[84:87]
  v_mfma_f32_16x16x32_bf16 v[88:91], v[252:255], a[164:167], v[88:91]
  v_mfma_f32_16x16x32_bf16 v[92:95], v[252:255], a[188:191], v[92:95]
  v_mfma_f32_16x16x32_bf16 v[96:99], v[252:255], a[212:215], v[96:99]
  v_mfma_f32_16x16x32_bf16 v[100:103], v[252:255], a[236:239], v[100:103]
  s_cmp_eq_u32 s54, 2
  s_cselect_b32 s61, -1, 0
  s_mov_b32 s60, -1
  s_cselect_b32 s58, 3, 1
  s_lshl_b32 s57, s55, 3
  s_and_b32 s21, s2, 7
  s_add_u32 s57, s57, s21
  s_lshl_b32 s57, s57, 7
  s_add_u32 s57, s57, 24576
  s_add_u32 s55, s55, s54
  v_cvt_pk_bf16_f32 v48, v64, v65
  v_cvt_pk_bf16_f32 v49, v66, v67
  v_cvt_pk_bf16_f32 v50, v68, v69
  v_cvt_pk_bf16_f32 v51, v70, v71
  v_cvt_pk_bf16_f32 v52, v72, v73
  v_cvt_pk_bf16_f32 v53, v74, v75
  v_cvt_pk_bf16_f32 v54, v76, v77
  v_cvt_pk_bf16_f32 v55, v78, v79
  v_cvt_pk_bf16_f32 v56, v80, v81
  v_cvt_pk_bf16_f32 v57, v82, v83
  v_cvt_pk_bf16_f32 v58, v84, v85
  v_cvt_pk_bf16_f32 v59, v86, v87
  v_cvt_pk_bf16_f32 v60, v88, v89
  v_cvt_pk_bf16_f32 v61, v90, v91
  v_cvt_pk_bf16_f32 v62, v92, v93
  v_cvt_pk_bf16_f32 v63, v94, v95
  v_cvt_pk_bf16_f32 v240, v96, v97
  v_cvt_pk_bf16_f32 v241, v98, v99
  v_cvt_pk_bf16_f32 v242, v100, v101
  v_cvt_pk_bf16_f32 v243, v102, v103
  v_min_u32 v48, -2, v48
  v_min_u32 v52, -2, v52
  v_min_u32 v56, -2, v56
  v_min_u32 v60, -2, v60
  v_min_u32 v240, -2, v240
  s_mov_b64 exec, s[60:61]
  buffer_store_dwordx4 v[48:51], v15, s[80:83], s63 offen offset:0 sc1
  buffer_store_dwordx4 v[52:55], v15, s[80:83], s63 offen offset:512 sc1
  buffer_store_dwordx4 v[56:59], v15, s[80:83], s63 offen offset:1024 sc1
  buffer_store_dwordx4 v[60:63], v15, s[80:83], s63 offen offset:1536 sc1
  buffer_store_dwordx4 v[240:243], v15, s[80:83], s63 offen offset:2048 sc1
  s_mov_b64 exec, -1
  s_branch ul_184
ut_187:
  s_min_u32 s23, s55, 62
  s_add_u32 s56, s55, 1
  s_mov_b32 s54, 1
  s_lshl_b32 s21, s55, 5
  s_add_u32 s21, s21, s2
  s_mul_i32 s62, s21, 3072
  s_mul_i32 s63, s21, 10240
  s_mul_i32 s22, s20, 2560
  s_add_u32 s63, s63, s22
  s_mov_b32 s101, 0
  s_branch utp_204
utp_203:
  s_sleep 3
utp_204:
  buffer_load_dwordx4 v[24:27], v13, s[76:79], s62 offen offset:0 sc1
  buffer_load_dwordx4 v[28:31], v13, s[76:79], s62 offen offset:512 sc1
  buffer_load_dwordx4 v[32:35], v13, s[76:79], s62 offen offset:1024 sc1
  buffer_load_dwordx4 v[36:39], v13, s[76:79], s62 offen offset:1536 sc1
  buffer_load_dwordx4 v[40:43], v13, s[76:79], s62 offen offset:2048 sc1
  buffer_load_dwordx4 v[44:47], v13, s[76:79], s62 offen offset:2560 sc1
  s_add_u32 s101, s101, 1
  s_cmp_gt_u32 s101, 131072
  s_cbranch_scc1 main_end
  s_waitcnt vmcnt(0)
  s_cmp_eq_u32 s58, 0
  s_cbranch_scc1 uf_205
  s_mov_b64 exec, s[58:59]
  buffer_atomic_add v11, v17, s[72:75], s57 offen sc1
  s_mov_b64 exec, -1
  s_mov_b32 s58, 0
uf_205:
  v_max3_u32 v8, v24, v26, v28
  v_max3_u32 v8, v8, v30, v32
  v_max3_u32 v8, v8, v34, v36
  v_max3_u32 v8, v8, v38, v40
  v_max3_u32 v8, v8, v42, v44
  v_max3_u32 v8, v8, v46, v46
  v_cmp_eq_u32 vcc, -1, v8
  s_nop 1
  s_cbranch_vccnz utp_203
  v_mfma_f32_16x16x32_bf16 v[64:67], v[24:27], a[0:3], 0
  v_mfma_f32_16x16x32_bf16 v[68:71], v[24:27], a[24:27], 0
  v_mfma_f32_16x16x32_bf16 v[72:75], v[24:27], a[48:51], 0
  v_mfma_f32_16x16x32_bf16 v[76:79], v[24:27], a[72:75], 0
  v_mfma_f32_16x16x32_bf16 v[80:83], v[24:27], a[96:99], 0
  v_mfma_f32_16x16x32_bf16 v[84:87], v[24:27], a[120:123], 0
  v_mfma_f32_16x16x32_bf16 v[88:91], v[24:27], a[144:147], 0
  v_mfma_f32_16x16x32_bf16 v[92:95], v[24:27], a[168:171], 0
  v_mfma_f32_16x16x32_bf16 v[96:99], v[24:27], a[192:195], 0
  v_mfma_f32_16x16x32_bf16 v[100:103], v[24:27], a[216:219], 0
  v_mfma_f32_16x16x32_bf16 v[64:67], v[28:31], a[4:7], v[64:67]
  v_mfma_f32_16x16x32_bf16 v[68:71], v[28:31], a[28:31], v[68:71]
  v_mfma_f32_16x16x32_bf16 v[72:75], v[28:31], a[52:55], v[72:75]
  v_mfma_f32_16x16x32_bf16 v[76:79], v[28:31], a[76:79], v[76:79]
  v_mfma_f32_16x16x32_bf16 v[80:83], v[28:31], a[100:103], v[80:83]
  v_mfma_f32_16x16x32_bf16 v[84:87], v[28:31], a[124:127], v[84:87]
  v_mfma_f32_16x16x32_bf16 v[88:91], v[28:31], a[148:151], v[88:91]
  v_mfma_f32_16x16x32_bf16 v[92:95], v[28:31], a[172:175], v[92:95]
  v_mfma_f32_16x16x32_bf16 v[96:99], v[28:31], a[196:199], v[96:99]
  v_mfma_f32_16x16x32_bf16 v[100:103], v[28:31], a[220:223], v[100:103]
  v_mfma_f32_16x16x32_bf16 v[64:67], v[32:35], a[8:11], v[64:67]
  v_mfma_f32_16x16x32_bf16 v[68:71], v[32:35], a[32:35], v[68:71]
  v_mfma_f32_16x16x32_bf16 v[72:75], v[32:35], a[56:59], v[72:75]
  v_mfma_f32_16x16x32_bf16 v[76:79], v[32:35], a[80:83], v[76:79]
  v_mfma_f32_16x16x32_bf16 v[80:83], v[32:35], a[104:107], v[80:83]
  v_mfma_f32_16x16x32_bf16 v[84:87], v[32:35], a[128:131], v[84:87]
  v_mfma_f32_16x16x32_bf16 v[88:91], v[32:35], a[152:155], v[88:91]
  v_mfma_f32_16x16x32_bf16 v[92:95], v[32:35], a[176:179], v[92:95]
  v_mfma_f32_16x16x32_bf16 v[96:99], v[32:35], a[200:203], v[96:99]
  v_mfma_f32_16x16x32_bf16 v[100:103], v[32:35], a[224:227], v[100:103]
  v_mfma_f32_16x16x32_bf16 v[64:67], v[36:39], a[12:15], v[64:67]
  v_mfma_f32_16x16x32_bf16 v[68:71], v[36:39], a[36:39], v[68:71]
  v_mfma_f32_16x16x32_bf16 v[72:75], v[36:39], a[60:63], v[72:75]
  v_mfma_f32_16x16x32_bf16 v[76:79], v[36:39], a[84:87], v[76:79]
  v_mfma_f32_16x16x32_bf16 v[80:83], v[36:39], a[108:111], v[80:83]
  v_mfma_f32_16x16x32_bf16 v[84:87], v[36:39], a[132:135], v[84:87]
  v_mfma_f32_16x16x32_bf16 v[88:91], v[36:39], a[156:159], v[88:91]
  v_mfma_f32_16x16x32_bf16 v[92:95], v[36:39], a[180:183], v[92:95]
  v_mfma_f32_16x16x32_bf16 v[96:99], v[36:39], a[204:207], v[96:99]
  v_mfma_f32_16x16x32_bf16 v[100:103], v[36:39], a[228:231], v[100:103]
  v_mfma_f32_16x16x32_bf16 v[64:67], v[40:43], a[16:19], v[64:67]
  v_mfma_f32_16x16x32_bf16 v[68:71], v[40:43], a[40:43], v[68:71]
  v_mfma_f32_16x16x32_bf16 v[72:75], v[40:43], a[64:67], v[72:75]
  v_mfma_f32_16x16x32_bf16 v[76:79], v[40:43], a[88:91], v[76:79]
  v_mfma_f32_16x16x32_bf16 v[80:83], v[40:43], a[112:115], v[80:83]
  v_mfma_f32_16x16x32_bf16 v[84:87], v[40:43], a[136:139], v[84:87]
  v_mfma_f32_16x16x32_bf16 v[88:91], v[40:43], a[160:163], v[88:91]
  v_mfma_f32_16x16x32_bf16 v[92:95], v[40:43], a[184:187], v[92:95]
  v_mfma_f32_16x16x32_bf16 v[96:99], v[40:43], a[208:211], v[96:99]
  v_mfma_f32_16x16x32_bf16 v[100:103], v[40:43], a[232:235], v[100:103]
  v_mfma_f32_16x16x32_bf16 v[64:67], v[44:47], a[20:23], v[64:67]
  v_mfma_f32_16x16x32_bf16 v[68:71], v[44:47], a[44:47], v[68:71]
  v_mfma_f32_16x16x32_bf16 v[72:75], v[44:47], a[68:71], v[72:75]
  v_mfma_f32_16x16x32_bf16 v[76:79], v[44:47], a[92:95], v[76:79]
  v_mfma_f32_16x16x32_bf16 v[80:83], v[44:47], a[116:119], v[80:83]
  v_mfma_f32_16x16x32_bf16 v[84:87], v[44:47], a[140:143], v[84:87]
  v_mfma_f32_16x16x32_bf16 v[88:91], v[44:47], a[164:167], v[88:91]
  v_mfma_f32_16x16x32_bf16 v[92:95], v[44:47], a[188:191], v[92:95]
  v_mfma_f32_16x16x32_bf16 v[96:99], v[44:47], a[212:215], v[96:99]
  v_mfma_f32_16x16x32_bf16 v[100:103], v[44:47], a[236:239], v[100:103]
  s_cmp_eq_u32 s54, 2
  s_cselect_b32 s61, -1, 0
  s_mov_b32 s60, -1
  s_cselect_b32 s58, 3, 1
  s_lshl_b32 s57, s55, 3
  s_and_b32 s21, s2, 7
  s_add_u32 s57, s57, s21
  s_lshl_b32 s57, s57, 7
  s_add_u32 s57, s57, 24576
  s_add_u32 s55, s55, s54
  v_cvt_pk_bf16_f32 v48, v64, v65
  v_cvt_pk_bf16_f32 v49, v66, v67
  v_cvt_pk_bf16_f32 v50, v68, v69
  v_cvt_pk_bf16_f32 v51, v70, v71
  v_cvt_pk_bf16_f32 v52, v72, v73
  v_cvt_pk_bf16_f32 v53, v74, v75
  v_cvt_pk_bf16_f32 v54, v76, v77
  v_cvt_pk_bf16_f32 v55, v78, v79
  v_cvt_pk_bf16_f32 v56, v80, v81
  v_cvt_pk_bf16_f32 v57, v82, v83
  v_cvt_pk_bf16_f32 v58, v84, v85
  v_cvt_pk_bf16_f32 v59, v86, v87
  v_cvt_pk_bf16_f32 v60, v88, v89
  v_cvt_pk_bf16_f32 v61, v90, v91
  v_cvt_pk_bf16_f32 v62, v92, v93
  v_cvt_pk_bf16_f32 v63, v94, v95
  v_cvt_pk_bf16_f32 v240, v96, v97
  v_cvt_pk_bf16_f32 v241, v98, v99
  v_cvt_pk_bf16_f32 v242, v100, v101
  v_cvt_pk_bf16_f32 v243, v102, v103
  v_min_u32 v48, -2, v48
  v_min_u32 v52, -2, v52
  v_min_u32 v56, -2, v56
  v_min_u32 v60, -2, v60
  v_min_u32 v240, -2, v240
  s_mov_b64 exec, s[60:61]
  buffer_store_dwordx4 v[48:51], v15, s[80:83], s63 offen offset:0 sc1
  buffer_store_dwordx4 v[52:55], v15, s[80:83], s63 offen offset:512 sc1
  buffer_store_dwordx4 v[56:59], v15, s[80:83], s63 offen offset:1024 sc1
  buffer_store_dwordx4 v[60:63], v15, s[80:83], s63 offen offset:1536 sc1
  buffer_store_dwordx4 v[240:243], v15, s[80:83], s63 offen offset:2048 sc1
  s_mov_b64 exec, -1
  s_branch ul_184
ud_186:
  s_mov_b32 s84, 0
  s_mov_b32 s85, -1
  s_mov_b32 s86, 0
  s_branch queue
not_vw:
  s_sub_u32 s2, s3, 96
  s_cmp_lg_u32 s2, 31
  s_cbranch_scc1 not_cal
  s_add_u32 s8, s38, 83886079
  s_addc_u32 s9, s39, 0
  s_and_b32 s8, s8, 0xffe00000
  s_mov_b32 s10, 2097152
  s_mov_b32 s11, 0x00020000
  v_lshrrev_b32 v9, 4, v0
  v_mul_u32_u24 v9, 16640, v9
  v_bfe_u32 v10, v0, 3, 1
  v_lshl_add_u32 v9, v10, 13, v9
  v_and_b32 v10, 7, v0
  v_lshl_add_u32 v9, v10, 4, v9
  s_mov_b32 s21, 1048576
  buffer_store_dwordx4 v[4:7], v9, s[8:11], s21 offen sc1
  s_waitcnt vmcnt(0)
  s_barrier
  s_cmp_lg_u32 s20, 3
  s_cbranch_scc1 cal_206
  s_mov_b64 exec, 1
  v_mov_b32 v4, 0
  s_mov_b32 s40, -1
  s_mov_b32 s41, -1
  s_mov_b32 s42, 1048576
  s_mov_b32 s43, 0
  s_waitcnt vmcnt(0)
cal_207:
  s_add_u32 s21, s42, 0
  s_memtime s[98:99]
  s_waitcnt lgkmcnt(0)
  buffer_load_dword v5, v4, s[8:11], s21 offen sc1
  s_waitcnt vmcnt(0)
  s_memtime s[100:101]
  s_waitcnt lgkmcnt(0)
  s_sub_u32 s21, s100, s98
  s_min_u32 s40, s40, s21
  s_add_u32 s21, s42, 8192
  s_memtime s[98:99]
  s_waitcnt lgkmcnt(0)
  buffer_load_dword v5, v4, s[8:11], s21 offen sc1
  s_waitcnt vmcnt(0)
  s_memtime s[100:101]
  s_waitcnt lgkmcnt(0)
  s_sub_u32 s21, s100, s98
  s_min_u32 s41, s41, s21
  s_add_u32 s42, s42, 16640
  s_add_u32 s43, s43, 1
  s_cmp_lt_u32 s43, 4
  s_cbranch_scc1 cal_207
  s_cmp_lt_u32 s41, s40
  s_cselect_b32 s21, 1, 2
  v_mov_b32 v4, s21
  v_mov_b32 v5, s40
  v_mov_b32 v6, s41
  v_mov_b32 v8, 84
  buffer_store_dwordx3 v[4:6], v8, s[32:35], 0 offen sc1
  s_waitcnt vmcnt(0)
  s_mov_b64 exec, -1
cal_206:
  s_barrier
  s_branch armed
not_cal:
  s_sleep 32
  s_sleep 32
  s_sleep 32
  s_sleep 32
  s_sleep 32
  s_sleep 32
armed:
  s_load_dwordx2 s[72:73], s[0:1], 104
  s_waitcnt lgkmcnt(0)
  s_add_u32 s72, s72, 81068032
  s_addc_u32 s73, s73, 0
  s_mov_b32 s74, 117760
  s_mov_b32 s75, 0x00020000
  s_load_dwordx2 s[4:5], s[0:1], 0
  s_load_dwordx2 s[6:7], s[0:1], 64
  s_load_dwordx2 s[38:39], s[0:1], 104
  s_lshr_b32 s41, s2, 1
  s_and_b32 s42, s2, 1
  s_waitcnt lgkmcnt(0)
  s_mov_b32 s8, s4
  s_mov_b32 s9, s5
  s_mov_b32 s10, 2621440
  s_mov_b32 s11, 0x00020000
  s_mov_b32 s12, s6
  s_mov_b32 s13, s7
  s_mov_b32 s14, 2457600
  s_mov_b32 s15, 0x00020000
  s_add_u32 s16, s38, 70778880
  s_addc_u32 s17, s39, 0
  s_mov_b32 s18, 2621440
  s_mov_b32 s19, 0x00020000
  s_add_u32 s72, s38, 81068032
  s_addc_u32 s73, s39, 0
  s_mov_b32 s74, 117760
  s_mov_b32 s75, 0x00020000
  v_lshlrev_b32 v6, 1, v3
  v_add_u32 v6, 0, v6
  v_xor_b32 v6, v6, v2
  v_min_u32 v6, 14, v6
  v_mul_u32_u24 v7, 52, v6
  v_lshrrev_b32 v7, 8, v7
  v_mul_u32_u24 v7, 1200, v7
  v_lshl_add_u32 v7, v6, 4, v7
  v_mul_u32_u24 v6, 3840, v3
  v_add_u32 v4, v6, v7
  v_lshlrev_b32 v6, 1, v3
  v_add_u32 v6, 8, v6
  v_xor_b32 v6, v6, v2
  v_min_u32 v6, 14, v6
  v_mul_u32_u24 v7, 52, v6
  v_lshrrev_b32 v7, 8, v7
  v_mul_u32_u24 v7, 1200, v7
  v_lshl_add_u32 v7, v6, 4, v7
  v_mul_u32_u24 v6, 3840, v3
  v_add_u32 v5, v6, v7
  s_mul_i32 s21, s41, 80
  s_mul_i32 s22, s20, 15360
  s_add_u32 s21, s21, s22
  s_lshl_b32 s22, s20, 10
  s_cmp_ge_u32 s20, 2
  s_cselect_b64 vcc, -1, 0
  v_cndmask_b32 v4, v4, v5, vcc
  s_add_u32 m0, s22, 0
  s_nop 0
  buffer_load_dwordx4 v4, s[12:15], s21 offen lds
  s_add_u32 s21, s21, 61440
  s_add_u32 m0, s22, 4096
  s_nop 0
  buffer_load_dwordx4 v4, s[12:15], s21 offen lds
  s_add_u32 s21, s21, 61440
  s_add_u32 m0, s22, 8192
  s_nop 0
  buffer_load_dwordx4 v4, s[12:15], s21 offen lds
  s_add_u32 s21, s21, 61440
  s_add_u32 m0, s22, 12288
  s_nop 0
  buffer_load_dwordx4 v4, s[12:15], s21 offen lds
  s_add_u32 s21, s21, 61440
  s_add_u32 m0, s22, 16384
  s_nop 0
  buffer_load_dwordx4 v4, s[12:15], s21 offen lds
  s_add_u32 s21, s21, 61440
  s_add_u32 m0, s22, 20480
  s_nop 0
  buffer_load_dwordx4 v4, s[12:15], s21 offen lds
  s_add_u32 s21, s21, 61440
  s_add_u32 m0, s22, 24576
  s_nop 0
  buffer_load_dwordx4 v4, s[12:15], s21 offen lds
  s_add_u32 s21, s21, 61440
  s_add_u32 m0, s22, 28672
  s_nop 0
  buffer_load_dwordx4 v4, s[12:15], s21 offen lds
  s_add_u32 s21, s21, 61440
  s_add_u32 m0, s22, 32768
  s_nop 0
  buffer_load_dwordx4 v4, s[12:15], s21 offen lds
  s_add_u32 s21, s21, 61440
  s_add_u32 m0, s22, 36864
  s_nop 0
  buffer_load_dwordx4 v4, s[12:15], s21 offen lds
  s_add_u32 s21, s21, 61440
  s_add_u32 m0, s22, 40960
  s_nop 0
  buffer_load_dwordx4 v4, s[12:15], s21 offen lds
  s_add_u32 s21, s21, 61440
  s_add_u32 m0, s22, 45056
  s_nop 0
  buffer_load_dwordx4 v4, s[12:15], s21 offen lds
  s_add_u32 s21, s21, 61440
  s_add_u32 m0, s22, 49152
  s_nop 0
  buffer_load_dwordx4 v4, s[12:15], s21 offen lds
  s_add_u32 s21, s21, 61440
  s_add_u32 m0, s22, 53248
  s_nop 0
  buffer_load_dwordx4 v4, s[12:15], s21 offen lds
  s_add_u32 s21, s21, 61440
  s_add_u32 m0, s22, 57344
  s_nop 0
  buffer_load_dwordx4 v4, s[12:15], s21 offen lds
  s_add_u32 s21, s21, 61440
  s_add_u32 m0, s22, 61440
  s_nop 0
  buffer_load_dwordx4 v4, s[12:15], s21 offen lds
  s_add_u32 s21, s21, 61440
  s_add_u32 m0, s22, 65536
  s_nop 0
  buffer_load_dwordx4 v4, s[12:15], s21 offen lds
  s_add_u32 s21, s21, 61440
  s_add_u32 m0, s22, 69632
  s_nop 0
  buffer_load_dwordx4 v4, s[12:15], s21 offen lds
  s_add_u32 s21, s21, 61440
  s_add_u32 m0, s22, 73728
  s_nop 0
  buffer_load_dwordx4 v4, s[12:15], s21 offen lds
  s_add_u32 s21, s21, 61440
  s_add_u32 m0, s22, 77824
  s_nop 0
  buffer_load_dwordx4 v4, s[12:15], s21 offen lds
  s_add_u32 s21, s21, 61440
  s_add_u32 m0, s22, 81920
  s_nop 0
  buffer_load_dwordx4 v4, s[12:15], s21 offen lds
  s_add_u32 s21, s21, 61440
  s_add_u32 m0, s22, 86016
  s_nop 0
  buffer_load_dwordx4 v4, s[12:15], s21 offen lds
  s_add_u32 s21, s21, 61440
  s_add_u32 m0, s22, 90112
  s_nop 0
  buffer_load_dwordx4 v4, s[12:15], s21 offen lds
  s_add_u32 s21, s21, 61440
  s_add_u32 m0, s22, 94208
  s_nop 0
  buffer_load_dwordx4 v4, s[12:15], s21 offen lds
  s_add_u32 s21, s21, 61440
  s_add_u32 m0, s22, 98304
  s_nop 0
  buffer_load_dwordx4 v4, s[12:15], s21 offen lds
  s_add_u32 s21, s21, 61440
  s_add_u32 m0, s22, 102400
  s_nop 0
  buffer_load_dwordx4 v4, s[12:15], s21 offen lds
  s_add_u32 s21, s21, 61440
  s_add_u32 m0, s22, 106496
  s_nop 0
  buffer_load_dwordx4 v4, s[12:15], s21 offen lds
  s_add_u32 s21, s21, 61440
  s_add_u32 m0, s22, 110592
  s_nop 0
  buffer_load_dwordx4 v4, s[12:15], s21 offen lds
  s_add_u32 s21, s21, 61440
  s_add_u32 m0, s22, 114688
  s_nop 0
  buffer_load_dwordx4 v4, s[12:15], s21 offen lds
  s_add_u32 s21, s21, 61440
  s_add_u32 m0, s22, 118784
  s_nop 0
  buffer_load_dwordx4 v4, s[12:15], s21 offen lds
  s_add_u32 s21, s21, 61440
  s_add_u32 m0, s22, 122880
  s_nop 0
  buffer_load_dwordx4 v4, s[12:15], s21 offen lds
  s_add_u32 s21, s21, 61440
  s_add_u32 m0, s22, 126976
  s_nop 0
  buffer_load_dwordx4 v4, s[12:15], s21 offen lds
  s_add_u32 s21, s21, 61440
  s_add_u32 m0, s22, 131072
  s_nop 0
  buffer_load_dwordx4 v4, s[12:15], s21 offen lds
  s_add_u32 s21, s21, 61440
  s_add_u32 m0, s22, 135168
  s_nop 0
  buffer_load_dwordx4 v4, s[12:15], s21 offen lds
  s_add_u32 s21, s21, 61440
  s_add_u32 m0, s22, 139264
  s_nop 0
  buffer_load_dwordx4 v4, s[12:15], s21 offen lds
  s_add_u32 s21, s21, 61440
  s_add_u32 m0, s22, 143360
  s_nop 0
  buffer_load_dwordx4 v4, s[12:15], s21 offen lds
  s_add_u32 s21, s21, 61440
  s_add_u32 m0, s22, 147456
  s_nop 0
  buffer_load_dwordx4 v4, s[12:15], s21 offen lds
  s_add_u32 s21, s21, 61440
  s_add_u32 m0, s22, 151552
  s_nop 0
  buffer_load_dwordx4 v4, s[12:15], s21 offen lds
  s_add_u32 s21, s21, 61440
  s_add_u32 m0, s22, 155648
  s_nop 0
  buffer_load_dwordx4 v4, s[12:15], s21 offen lds
  s_add_u32 s21, s21, 61440
  s_add_u32 m0, s22, 159744
  s_nop 0
  buffer_load_dwordx4 v4, s[12:15], s21 offen lds
  s_add_u32 s21, s21, 61440
  s_lshl_b32 s21, s2, 2
  s_add_u32 s21, s21, s20
  s_mul_i32 s21, s21, 20480
  v_lshlrev_b32 v5, 4, v1
  buffer_load_dwordx4 v[64:67], v5, s[8:11], s21 offen offset:0
  buffer_load_dwordx4 v[64:67], v5, s[8:11], s21 offen offset:1024
  buffer_load_dwordx4 v[64:67], v5, s[8:11], s21 offen offset:2048
  buffer_load_dwordx4 v[64:67], v5, s[8:11], s21 offen offset:3072
  s_add_u32 s21, s21, 4096
  buffer_load_dwordx4 v[64:67], v5, s[8:11], s21 offen offset:0
  buffer_load_dwordx4 v[64:67], v5, s[8:11], s21 offen offset:1024
  buffer_load_dwordx4 v[64:67], v5, s[8:11], s21 offen offset:2048
  buffer_load_dwordx4 v[64:67], v5, s[8:11], s21 offen offset:3072
  s_add_u32 s21, s21, 4096
  buffer_load_dwordx4 v[64:67], v5, s[8:11], s21 offen offset:0
  buffer_load_dwordx4 v[64:67], v5, s[8:11], s21 offen offset:1024
  buffer_load_dwordx4 v[64:67], v5, s[8:11], s21 offen offset:2048
  buffer_load_dwordx4 v[64:67], v5, s[8:11], s21 offen offset:3072
  s_add_u32 s21, s21, 4096
  buffer_load_dwordx4 v[64:67], v5, s[8:11], s21 offen offset:0
  buffer_load_dwordx4 v[64:67], v5, s[8:11], s21 offen offset:1024
  buffer_load_dwordx4 v[64:67], v5, s[8:11], s21 offen offset:2048
  buffer_load_dwordx4 v[64:67], v5, s[8:11], s21 offen offset:3072
  s_add_u32 s21, s21, 4096
  buffer_load_dwordx4 v[64:67], v5, s[8:11], s21 offen offset:0
  buffer_load_dwordx4 v[64:67], v5, s[8:11], s21 offen offset:1024
  buffer_load_dwordx4 v[64:67], v5, s[8:11], s21 offen offset:2048
  buffer_load_dwordx4 v[64:67], v5, s[8:11], s21 offen offset:3072
  v_lshrrev_b32 v6, 2, v2
  v_lshl_add_u32 v7, v3, 3, v6
  v_and_b32 v8, 1, v3
  v_lshl_add_u32 v6, v8, 2, v6
  v_lshlrev_b32 v6, 1, v6
  v_bfe_u32 v8, v2, 1, 1
  s_lshl_b32 s21, s20, 2
  v_add_u32 v8, s21, v8
  v_and_b32 v9, 1, v2
  v_lshlrev_b32 v9, 3, v9
  v_lshl_add_u32 v9, v7, 8, v9
  v_add_u32 v5, 0, v8
  v_xor_b32 v5, v5, v6
  v_lshl_add_u32 v10, v5, 4, v9
  v_add_u32 v11, 65536, v10
  v_add_u32 v12, 131072, v10
  v_add_u32 v5, 2, v8
  v_xor_b32 v5, v5, v6
  v_lshl_add_u32 v13, v5, 4, v9
  v_add_u32 v14, 65536, v13
  v_add_u32 v15, 131072, v13
  s_waitcnt vmcnt(50)
  s_barrier
  ds_read_b64_tr_b16 a[0:1], v10 offset:0
  ds_read_b64_tr_b16 a[2:3], v10 offset:1024
  ds_read_b64_tr_b16 a[4:5], v13 offset:0
  ds_read_b64_tr_b16 a[6:7], v13 offset:1024
  ds_read_b64_tr_b16 a[8:9], v10 offset:8192
  ds_read_b64_tr_b16 a[10:11], v10 offset:9216
  ds_read_b64_tr_b16 a[12:13], v13 offset:8192
  ds_read_b64_tr_b16 a[14:15], v13 offset:9216
  ds_read_b64_tr_b16 a[16:17], v10 offset:16384
  ds_read_b64_tr_b16 a[18:19], v10 offset:17408
  ds_read_b64_tr_b16 a[20:21], v13 offset:16384
  ds_read_b64_tr_b16 a[22:23], v13 offset:17408
  ds_read_b64_tr_b16 a[24:25], v10 offset:24576
  ds_read_b64_tr_b16 a[26:27], v10 offset:25600
  ds_read_b64_tr_b16 a[28:29], v13 offset:24576
  ds_read_b64_tr_b16 a[30:31], v13 offset:25600
  ds_read_b64_tr_b16 a[32:33], v10 offset:32768
  ds_read_b64_tr_b16 a[34:35], v10 offset:33792
  ds_read_b64_tr_b16 a[36:37], v13 offset:32768
  ds_read_b64_tr_b16 a[38:39], v13 offset:33792
  s_waitcnt vmcnt(40)
  s_barrier
  ds_read_b64_tr_b16 a[40:41], v10 offset:40960
  ds_read_b64_tr_b16 a[42:43], v10 offset:41984
  ds_read_b64_tr_b16 a[44:45], v13 offset:40960
  ds_read_b64_tr_b16 a[46:47], v13 offset:41984
  ds_read_b64_tr_b16 a[48:49], v10 offset:49152
  ds_read_b64_tr_b16 a[50:51], v10 offset:50176
  ds_read_b64_tr_b16 a[52:53], v13 offset:49152
  ds_read_b64_tr_b16 a[54:55], v13 offset:50176
  ds_read_b64_tr_b16 a[56:57], v10 offset:57344
  ds_read_b64_tr_b16 a[58:59], v10 offset:58368
  ds_read_b64_tr_b16 a[60:61], v13 offset:57344
  ds_read_b64_tr_b16 a[62:63], v13 offset:58368
  ds_read_b64_tr_b16 a[64:65], v11 offset:0
  ds_read_b64_tr_b16 a[66:67], v11 offset:1024
  ds_read_b64_tr_b16 a[68:69], v14 offset:0
  ds_read_b64_tr_b16 a[70:71], v14 offset:1024
  ds_read_b64_tr_b16 a[72:73], v11 offset:8192
  ds_read_b64_tr_b16 a[74:75], v11 offset:9216
  ds_read_b64_tr_b16 a[76:77], v14 offset:8192
  ds_read_b64_tr_b16 a[78:79], v14 offset:9216
  s_waitcnt vmcnt(30)
  s_barrier
  ds_read_b64_tr_b16 a[80:81], v11 offset:16384
  ds_read_b64_tr_b16 a[82:83], v11 offset:17408
  ds_read_b64_tr_b16 a[84:85], v14 offset:16384
  ds_read_b64_tr_b16 a[86:87], v14 offset:17408
  ds_read_b64_tr_b16 a[88:89], v11 offset:24576
  ds_read_b64_tr_b16 a[90:91], v11 offset:25600
  ds_read_b64_tr_b16 a[92:93], v14 offset:24576
  ds_read_b64_tr_b16 a[94:95], v14 offset:25600
  ds_read_b64_tr_b16 a[96:97], v11 offset:32768
  ds_read_b64_tr_b16 a[98:99], v11 offset:33792
  ds_read_b64_tr_b16 a[100:101], v14 offset:32768
  ds_read_b64_tr_b16 a[102:103], v14 offset:33792
  ds_read_b64_tr_b16 a[104:105], v11 offset:40960
  ds_read_b64_tr_b16 a[106:107], v11 offset:41984
  ds_read_b64_tr_b16 a[108:109], v14 offset:40960
  ds_read_b64_tr_b16 a[110:111], v14 offset:41984
  ds_read_b64_tr_b16 a[112:113], v11 offset:49152
  ds_read_b64_tr_b16 a[114:115], v11 offset:50176
  ds_read_b64_tr_b16 a[116:117], v14 offset:49152
  ds_read_b64_tr_b16 a[118:119], v14 offset:50176
  s_waitcnt vmcnt(20)
  s_barrier
  ds_read_b64_tr_b16 a[120:121], v11 offset:57344
  ds_read_b64_tr_b16 a[122:123], v11 offset:58368
  ds_read_b64_tr_b16 a[124:125], v14 offset:57344
  ds_read_b64_tr_b16 a[126:127], v14 offset:58368
  ds_read_b64_tr_b16 a[128:129], v12 offset:0
  ds_read_b64_tr_b16 a[130:131], v12 offset:1024
  ds_read_b64_tr_b16 a[132:133], v15 offset:0
  ds_read_b64_tr_b16 a[134:135], v15 offset:1024
  ds_read_b64_tr_b16 a[136:137], v12 offset:8192
  ds_read_b64_tr_b16 a[138:139], v12 offset:9216
  ds_read_b64_tr_b16 a[140:141], v15 offset:8192
  ds_read_b64_tr_b16 a[142:143], v15 offset:9216
  ds_read_b64_tr_b16 a[144:145], v12 offset:16384
  ds_read_b64_tr_b16 a[146:147], v12 offset:17408
  ds_read_b64_tr_b16 a[148:149], v15 offset:16384
  ds_read_b64_tr_b16 a[150:151], v15 offset:17408
  ds_read_b64_tr_b16 a[152:153], v12 offset:24576
  ds_read_b64_tr_b16 a[154:155], v12 offset:25600
  ds_read_b64_tr_b16 a[156:157], v15 offset:24576
  ds_read_b64_tr_b16 a[158:159], v15 offset:25600
  s_waitcnt lgkmcnt(0)
  s_barrier
  v_and_b32 v4, 31, v1
  s_lshl_b32 s21, s20, 5
  v_add_u32 v36, s21, v4
  v_lshrrev_b32 v5, 5, v1
  v_mul_u32_u24 v6, 264, v36
  v_mul_u32_u24 v7, 40, v5
  s_mov_b32 s21, 114952
  v_add3_u32 v34, v6, v7, s21
  v_lshl_add_u32 v38, v5, 3, v34
  v_lshlrev_b32 v6, 5, v5
  v_sub_u32 v39, v34, v6
  v_lshlrev_b32 v35, 3, v1
  v_add_u32 v35, 114688, v35
  v_mov_b32 v37, 0xf149f2ca
  s_mul_i32 s21, s41, 163840
  s_lshl_b32 s22, s42, 14
  s_add_u32 s21, s21, s22
  v_lshl_add_u32 v7, v36, 4, s21
  v_mul_u32_u24 v6, 98304, v5
  v_add_u32 v29, v6, v7
  v_add_u32 v30, 32768, v29
  v_lshl_add_u32 v31, v5, 3, v7
  v_add_u32 v31, 65536, v31
  v_mov_b32 v8, 0
  v_mov_b32 v9, 0
  ds_write_b64 v35, v[8:9] offset:0
  ds_write_b64 v35, v[8:9] offset:512
  ds_write_b64 v35, v[8:9] offset:1024
  ds_write_b64 v35, v[8:9] offset:1536
  ds_write_b64 v35, v[8:9] offset:2048
  s_mul_i32 s24, s42, 1280
  s_mov_b32 s25, 327680
  s_mov_b32 s26, 8
  s_mov_b32 s27, 0
  s_mov_b32 s60, 0x3e64f92e
  s_mov_b32 s61, 0x3fb8aa3b
  s_mov_b32 s62, 0x05040100
  s_mov_b32 s63, 0x07060302
  v_cmp_le_u32 s[76:77], 0, v36
  v_cmp_le_u32 s[78:79], 1, v36
  v_cmp_le_u32 s[80:81], 2, v36
  v_cmp_le_u32 s[82:83], 3, v36
  v_cmp_le_u32 s[84:85], 4, v36
  v_cmp_le_u32 s[86:87], 5, v36
  v_cmp_le_u32 s[88:89], 6, v36
  v_cmp_le_u32 s[90:91], 7, v36
  v_lshrrev_b32 v11, 3, v1
  v_and_b32 v12, 7, v1
  v_xor_b32 v12, v12, v11
  v_mul_u32_u24 v11, 2560, v11
  v_lshl_add_u32 v10, v12, 4, v11
  s_mul_i32 s46, s20, 81920
  v_add_u32 v10, s46, v10
  s_lshl_b32 s47, s20, 12
  s_add_u32 s47, s47, 0
  s_add_u32 s46, s47, 114688
  s_mov_b32 s30, s24
  s_add_u32 s32, s47, 0
  v_add_u32 v11, 19456, v10
  v_add_u32 v12, 38912, v10
  v_add_u32 v13, 58368, v10
  s_mov_b32 m0, s32
  s_nop 0
  buffer_load_dwordx4 v10, s[8:11], s30 offen offset:0 lds
  buffer_load_dwordx4 v11, s[8:11], s30 offen offset:1024 lds
  buffer_load_dwordx4 v12, s[8:11], s30 offen offset:2048 lds
  buffer_load_dwordx4 v13, s[8:11], s30 offen offset:3072 lds
  s_add_u32 s30, s30, 128
  s_add_u32 s32, s32, 16384
  s_cmp_lt_u32 s32, s46
  s_cselect_b32 s32, s32, s47
  s_mov_b32 m0, s32
  s_nop 0
  buffer_load_dwordx4 v10, s[8:11], s30 offen offset:0 lds
  buffer_load_dwordx4 v11, s[8:11], s30 offen offset:1024 lds
  buffer_load_dwordx4 v12, s[8:11], s30 offen offset:2048 lds
  buffer_load_dwordx4 v13, s[8:11], s30 offen offset:3072 lds
  s_add_u32 s30, s30, 128
  s_add_u32 s32, s32, 16384
  s_cmp_lt_u32 s32, s46
  s_cselect_b32 s32, s32, s47
  s_mov_b32 m0, s32
  s_nop 0
  buffer_load_dwordx4 v10, s[8:11], s30 offen offset:0 lds
  buffer_load_dwordx4 v11, s[8:11], s30 offen offset:1024 lds
  buffer_load_dwordx4 v12, s[8:11], s30 offen offset:2048 lds
  buffer_load_dwordx4 v13, s[8:11], s30 offen offset:3072 lds
  s_add_u32 s30, s30, 128
  s_add_u32 s32, s32, 16384
  s_cmp_lt_u32 s32, s46
  s_cselect_b32 s32, s32, s47
  s_mov_b32 m0, s32
  s_nop 0
  buffer_load_dwordx4 v10, s[8:11], s30 offen offset:0 lds
  buffer_load_dwordx4 v11, s[8:11], s30 offen offset:1024 lds
  buffer_load_dwordx4 v12, s[8:11], s30 offen offset:2048 lds
  buffer_load_dwordx4 v13, s[8:11], s30 offen offset:3072 lds
  s_add_u32 s30, s30, 128
  s_add_u32 s32, s32, 16384
  s_cmp_lt_u32 s32, s46
  s_cselect_b32 s32, s32, s47
  s_mov_b32 m0, s32
  s_nop 0
  buffer_load_dwordx4 v10, s[8:11], s30 offen offset:0 lds
  buffer_load_dwordx4 v11, s[8:11], s30 offen offset:1024 lds
  buffer_load_dwordx4 v12, s[8:11], s30 offen offset:2048 lds
  buffer_load_dwordx4 v13, s[8:11], s30 offen offset:3072 lds
  s_add_u32 s30, s30, 128
  s_add_u32 s32, s32, 16384
  s_cmp_lt_u32 s32, s46
  s_cselect_b32 s32, s32, s47
  v_and_b32 v6, 7, v2
  v_add_u32 v4, 0, v3
  v_xor_b32 v4, v4, v6
  v_lshlrev_b32 v4, 4, v4
  v_lshl_add_u32 v14, v2, 7, v4
  v_add_u32 v4, 4, v3
  v_xor_b32 v4, v4, v6
  v_lshlrev_b32 v4, 4, v4
  v_lshl_add_u32 v15, v2, 7, v4
  v_mul_u32_u24 v22, 264, v2
  v_mul_u32_u24 v4, 8, v3
  s_mul_i32 s21, s20, 64
  s_add_u32 s21, s21, 116800
  v_add3_u32 v22, v22, v4, s21
  v_mov_b32 v9, 2731
  s_mov_b32 s33, 0
  s_mov_b32 s48, 0x80000000
  s_mov_b32 m0, s32
  s_nop 0
  buffer_load_dwordx4 v10, s[8:11], s30 offen offset:0 lds
  buffer_load_dwordx4 v11, s[8:11], s30 offen offset:1024 lds
  s_waitcnt vmcnt(18)
  s_barrier
  v_add_u32 v18, s33, v14
  v_add_u32 v19, s33, v15
  s_add_u32 s33, s33, 16384
  s_cmp_lt_u32 s33, 114688
  s_cselect_b32 s33, s33, 0
  ds_read_b128 v[160:163], v18 offset:0
  ds_read_b128 v[164:167], v18 offset:2048
  ds_read_b128 v[168:171], v18 offset:4096
  ds_read_b128 v[172:175], v18 offset:6144
  ds_read_b128 v[176:179], v18 offset:8192
  ds_read_b128 v[180:183], v18 offset:10240
  ds_read_b128 v[184:187], v18 offset:12288
  ds_read_b128 v[188:191], v18 offset:14336
  s_waitcnt lgkmcnt(0)
bf_blk_208:
  v_mfma_f32_16x16x32_bf16 v[64:67], a[0:3], v[160:163], 0
  ds_read_b128 v[192:195], v19 offset:0
  v_mfma_f32_16x16x32_bf16 v[68:71], a[4:7], v[160:163], 0
  v_add_u32 v18, s33, v14
  v_mfma_f32_16x16x32_bf16 v[72:75], a[0:3], v[164:167], 0
  ds_read_b128 v[196:199], v19 offset:2048
  v_mfma_f32_16x16x32_bf16 v[76:79], a[4:7], v[164:167], 0
  buffer_load_dwordx4 v12, s[8:11], s30 offen offset:2048 lds
  v_mfma_f32_16x16x32_bf16 v[80:83], a[0:3], v[168:171], 0
  ds_read_b128 v[200:203], v19 offset:4096
  v_mfma_f32_16x16x32_bf16 v[84:87], a[4:7], v[168:171], 0
  v_mfma_f32_16x16x32_bf16 v[88:91], a[0:3], v[172:175], 0
  ds_read_b128 v[204:207], v19 offset:6144
  v_mfma_f32_16x16x32_bf16 v[92:95], a[4:7], v[172:175], 0
  s_waitcnt lgkmcnt(10)
  v_mfma_f32_16x16x32_bf16 v[96:99], a[0:3], v[176:179], 0
  ds_read_b128 v[208:211], v19 offset:8192
  v_mfma_f32_16x16x32_bf16 v[100:103], a[4:7], v[176:179], 0
  v_mfma_f32_16x16x32_bf16 v[104:107], a[0:3], v[180:183], 0
  ds_read_b128 v[212:215], v19 offset:10240
  v_mfma_f32_16x16x32_bf16 v[108:111], a[4:7], v[180:183], 0
  buffer_load_dwordx4 v13, s[8:11], s30 offen offset:3072 lds
  v_mfma_f32_16x16x32_bf16 v[112:115], a[0:3], v[184:187], 0
  ds_read_b128 v[216:219], v19 offset:12288
  s_add_u32 s30, s30, 128
  v_mfma_f32_16x16x32_bf16 v[116:119], a[4:7], v[184:187], 0
  s_add_u32 m0, m0, 16384
  v_mfma_f32_16x16x32_bf16 v[120:123], a[0:3], v[188:191], 0
  ds_read_b128 v[220:223], v19 offset:14336
  v_mfma_f32_16x16x32_bf16 v[124:127], a[4:7], v[188:191], 0
  s_waitcnt vmcnt(16) lgkmcnt(4)
  s_barrier
  v_mfma_f32_16x16x32_bf16 v[64:67], a[8:11], v[192:195], v[64:67]
  ds_read_b128 v[160:163], v18 offset:0
  v_mfma_f32_16x16x32_bf16 v[68:71], a[12:15], v[192:195], v[68:71]
  s_cmp_lt_u32 m0, s46
  s_cselect_b32 m0, m0, s47
  v_mfma_f32_16x16x32_bf16 v[72:75], a[8:11], v[196:199], v[72:75]
  ds_read_b128 v[164:167], v18 offset:2048
  v_add_u32 v19, s33, v15
  v_mfma_f32_16x16x32_bf16 v[76:79], a[12:15], v[196:199], v[76:79]
  buffer_load_dwordx4 v10, s[8:11], s30 offen offset:0 lds
  v_mfma_f32_16x16x32_bf16 v[80:83], a[8:11], v[200:203], v[80:83]
  ds_read_b128 v[168:171], v18 offset:4096
  s_add_u32 s33, s33, 16384
  v_mfma_f32_16x16x32_bf16 v[84:87], a[12:15], v[200:203], v[84:87]
  s_cmp_lt_u32 s33, 114688
  s_cselect_b32 s33, s33, 0
  v_mfma_f32_16x16x32_bf16 v[88:91], a[8:11], v[204:207], v[88:91]
  ds_read_b128 v[172:175], v18 offset:6144
  v_mfma_f32_16x16x32_bf16 v[92:95], a[12:15], v[204:207], v[92:95]
  s_waitcnt lgkmcnt(4)
  v_mfma_f32_16x16x32_bf16 v[96:99], a[8:11], v[208:211], v[96:99]
  ds_read_b128 v[176:179], v18 offset:8192
  v_mfma_f32_16x16x32_bf16 v[100:103], a[12:15], v[208:211], v[100:103]
  v_mfma_f32_16x16x32_bf16 v[104:107], a[8:11], v[212:215], v[104:107]
  ds_read_b128 v[180:183], v18 offset:10240
  v_mfma_f32_16x16x32_bf16 v[108:111], a[12:15], v[212:215], v[108:111]
  buffer_load_dwordx4 v11, s[8:11], s30 offen offset:1024 lds
  v_mfma_f32_16x16x32_bf16 v[112:115], a[8:11], v[216:219], v[112:115]
  ds_read_b128 v[184:187], v18 offset:12288
  v_mfma_f32_16x16x32_bf16 v[116:119], a[12:15], v[216:219], v[116:119]
  v_mfma_f32_16x16x32_bf16 v[120:123], a[8:11], v[220:223], v[120:123]
  ds_read_b128 v[188:191], v18 offset:14336
  v_mfma_f32_16x16x32_bf16 v[124:127], a[12:15], v[220:223], v[124:127]
  s_waitcnt lgkmcnt(4)
  v_mfma_f32_16x16x32_bf16 v[64:67], a[16:19], v[160:163], v[64:67]
  ds_read_b128 v[192:195], v19 offset:0
  v_mfma_f32_16x16x32_bf16 v[68:71], a[20:23], v[160:163], v[68:71]
  v_add_u32 v18, s33, v14
  v_mfma_f32_16x16x32_bf16 v[72:75], a[16:19], v[164:167], v[72:75]
  ds_read_b128 v[196:199], v19 offset:2048
  v_mfma_f32_16x16x32_bf16 v[76:79], a[20:23], v[164:167], v[76:79]
  buffer_load_dwordx4 v12, s[8:11], s30 offen offset:2048 lds
  v_mfma_f32_16x16x32_bf16 v[80:83], a[16:19], v[168:171], v[80:83]
  ds_read_b128 v[200:203], v19 offset:4096
  v_mfma_f32_16x16x32_bf16 v[84:87], a[20:23], v[168:171], v[84:87]
  v_mfma_f32_16x16x32_bf16 v[88:91], a[16:19], v[172:175], v[88:91]
  ds_read_b128 v[204:207], v19 offset:6144
  v_mfma_f32_16x16x32_bf16 v[92:95], a[20:23], v[172:175], v[92:95]
  s_waitcnt lgkmcnt(4)
  v_mfma_f32_16x16x32_bf16 v[96:99], a[16:19], v[176:179], v[96:99]
  ds_read_b128 v[208:211], v19 offset:8192
  v_mfma_f32_16x16x32_bf16 v[100:103], a[20:23], v[176:179], v[100:103]
  v_mfma_f32_16x16x32_bf16 v[104:107], a[16:19], v[180:183], v[104:107]
  ds_read_b128 v[212:215], v19 offset:10240
  v_mfma_f32_16x16x32_bf16 v[108:111], a[20:23], v[180:183], v[108:111]
  buffer_load_dwordx4 v13, s[8:11], s30 offen offset:3072 lds
  v_mfma_f32_16x16x32_bf16 v[112:115], a[16:19], v[184:187], v[112:115]
  ds_read_b128 v[216:219], v19 offset:12288
  s_add_u32 s30, s30, 128
  v_mfma_f32_16x16x32_bf16 v[116:119], a[20:23], v[184:187], v[116:119]
  s_add_u32 m0, m0, 16384
  v_mfma_f32_16x16x32_bf16 v[120:123], a[16:19], v[188:191], v[120:123]
  ds_read_b128 v[220:223], v19 offset:14336
  v_mfma_f32_16x16x32_bf16 v[124:127], a[20:23], v[188:191], v[124:127]
  s_waitcnt vmcnt(16) lgkmcnt(4)
  s_barrier
  v_mfma_f32_16x16x32_bf16 v[64:67], a[24:27], v[192:195], v[64:67]
  ds_read_b128 v[160:163], v18 offset:0
  v_mfma_f32_16x16x32_bf16 v[68:71], a[28:31], v[192:195], v[68:71]
  s_cmp_lt_u32 m0, s46
  s_cselect_b32 m0, m0, s47
  v_mfma_f32_16x16x32_bf16 v[72:75], a[24:27], v[196:199], v[72:75]
  ds_read_b128 v[164:167], v18 offset:2048
  v_add_u32 v19, s33, v15
  v_mfma_f32_16x16x32_bf16 v[76:79], a[28:31], v[196:199], v[76:79]
  buffer_load_dwordx4 v10, s[8:11], s30 offen offset:0 lds
  v_mfma_f32_16x16x32_bf16 v[80:83], a[24:27], v[200:203], v[80:83]
  ds_read_b128 v[168:171], v18 offset:4096
  s_add_u32 s33, s33, 16384
  v_mfma_f32_16x16x32_bf16 v[84:87], a[28:31], v[200:203], v[84:87]
  s_cmp_lt_u32 s33, 114688
  s_cselect_b32 s33, s33, 0
  v_mfma_f32_16x16x32_bf16 v[88:91], a[24:27], v[204:207], v[88:91]
  ds_read_b128 v[172:175], v18 offset:6144
  v_mfma_f32_16x16x32_bf16 v[92:95], a[28:31], v[204:207], v[92:95]
  s_waitcnt lgkmcnt(4)
  v_mfma_f32_16x16x32_bf16 v[96:99], a[24:27], v[208:211], v[96:99]
  ds_read_b128 v[176:179], v18 offset:8192
  v_mfma_f32_16x16x32_bf16 v[100:103], a[28:31], v[208:211], v[100:103]
  v_mfma_f32_16x16x32_bf16 v[104:107], a[24:27], v[212:215], v[104:107]
  ds_read_b128 v[180:183], v18 offset:10240
  v_mfma_f32_16x16x32_bf16 v[108:111], a[28:31], v[212:215], v[108:111]
  buffer_load_dwordx4 v11, s[8:11], s30 offen offset:1024 lds
  v_mfma_f32_16x16x32_bf16 v[112:115], a[24:27], v[216:219], v[112:115]
  ds_read_b128 v[184:187], v18 offset:12288
  v_mfma_f32_16x16x32_bf16 v[116:119], a[28:31], v[216:219], v[116:119]
  v_mfma_f32_16x16x32_bf16 v[120:123], a[24:27], v[220:223], v[120:123]
  ds_read_b128 v[188:191], v18 offset:14336
  v_mfma_f32_16x16x32_bf16 v[124:127], a[28:31], v[220:223], v[124:127]
  s_waitcnt lgkmcnt(4)
  v_mfma_f32_16x16x32_bf16 v[64:67], a[32:35], v[160:163], v[64:67]
  ds_read_b128 v[192:195], v19 offset:0
  v_mfma_f32_16x16x32_bf16 v[68:71], a[36:39], v[160:163], v[68:71]
  v_add_u32 v18, s33, v14
  v_mfma_f32_16x16x32_bf16 v[72:75], a[32:35], v[164:167], v[72:75]
  ds_read_b128 v[196:199], v19 offset:2048
  v_mfma_f32_16x16x32_bf16 v[76:79], a[36:39], v[164:167], v[76:79]
  buffer_load_dwordx4 v12, s[8:11], s30 offen offset:2048 lds
  v_mfma_f32_16x16x32_bf16 v[80:83], a[32:35], v[168:171], v[80:83]
  ds_read_b128 v[200:203], v19 offset:4096
  v_mfma_f32_16x16x32_bf16 v[84:87], a[36:39], v[168:171], v[84:87]
  v_mfma_f32_16x16x32_bf16 v[88:91], a[32:35], v[172:175], v[88:91]
  ds_read_b128 v[204:207], v19 offset:6144
  v_mfma_f32_16x16x32_bf16 v[92:95], a[36:39], v[172:175], v[92:95]
  s_waitcnt lgkmcnt(4)
  v_mfma_f32_16x16x32_bf16 v[96:99], a[32:35], v[176:179], v[96:99]
  ds_read_b128 v[208:211], v19 offset:8192
  v_mfma_f32_16x16x32_bf16 v[100:103], a[36:39], v[176:179], v[100:103]
  v_mfma_f32_16x16x32_bf16 v[104:107], a[32:35], v[180:183], v[104:107]
  ds_read_b128 v[212:215], v19 offset:10240
  v_mfma_f32_16x16x32_bf16 v[108:111], a[36:39], v[180:183], v[108:111]
  buffer_load_dwordx4 v13, s[8:11], s30 offen offset:3072 lds
  v_mfma_f32_16x16x32_bf16 v[112:115], a[32:35], v[184:187], v[112:115]
  ds_read_b128 v[216:219], v19 offset:12288
  s_add_u32 s30, s30, 128
  v_mfma_f32_16x16x32_bf16 v[116:119], a[36:39], v[184:187], v[116:119]
  s_add_u32 m0, m0, 16384
  v_mfma_f32_16x16x32_bf16 v[120:123], a[32:35], v[188:191], v[120:123]
  ds_read_b128 v[220:223], v19 offset:14336
  v_mfma_f32_16x16x32_bf16 v[124:127], a[36:39], v[188:191], v[124:127]
  s_waitcnt vmcnt(16) lgkmcnt(4)
  s_barrier
  v_mfma_f32_16x16x32_bf16 v[64:67], a[40:43], v[192:195], v[64:67]
  ds_read_b128 v[160:163], v18 offset:0
  v_mfma_f32_16x16x32_bf16 v[68:71], a[44:47], v[192:195], v[68:71]
  s_cmp_lt_u32 m0, s46
  s_cselect_b32 m0, m0, s47
  v_mfma_f32_16x16x32_bf16 v[72:75], a[40:43], v[196:199], v[72:75]
  ds_read_b128 v[164:167], v18 offset:2048
  v_add_u32 v19, s33, v15
  v_mfma_f32_16x16x32_bf16 v[76:79], a[44:47], v[196:199], v[76:79]
  buffer_load_dwordx4 v10, s[8:11], s30 offen offset:0 lds
  v_mfma_f32_16x16x32_bf16 v[80:83], a[40:43], v[200:203], v[80:83]
  ds_read_b128 v[168:171], v18 offset:4096
  s_add_u32 s33, s33, 16384
  v_mfma_f32_16x16x32_bf16 v[84:87], a[44:47], v[200:203], v[84:87]
  s_cmp_lt_u32 s33, 114688
  s_cselect_b32 s33, s33, 0
  v_mfma_f32_16x16x32_bf16 v[88:91], a[40:43], v[204:207], v[88:91]
  ds_read_b128 v[172:175], v18 offset:6144
  v_mfma_f32_16x16x32_bf16 v[92:95], a[44:47], v[204:207], v[92:95]
  s_waitcnt lgkmcnt(4)
  v_mfma_f32_16x16x32_bf16 v[96:99], a[40:43], v[208:211], v[96:99]
  ds_read_b128 v[176:179], v18 offset:8192
  v_mfma_f32_16x16x32_bf16 v[100:103], a[44:47], v[208:211], v[100:103]
  v_mfma_f32_16x16x32_bf16 v[104:107], a[40:43], v[212:215], v[104:107]
  ds_read_b128 v[180:183], v18 offset:10240
  v_mfma_f32_16x16x32_bf16 v[108:111], a[44:47], v[212:215], v[108:111]
  buffer_load_dwordx4 v11, s[8:11], s30 offen offset:1024 lds
  v_mfma_f32_16x16x32_bf16 v[112:115], a[40:43], v[216:219], v[112:115]
  ds_read_b128 v[184:187], v18 offset:12288
  v_mfma_f32_16x16x32_bf16 v[116:119], a[44:47], v[216:219], v[116:119]
  v_mfma_f32_16x16x32_bf16 v[120:123], a[40:43], v[220:223], v[120:123]
  ds_read_b128 v[188:191], v18 offset:14336
  v_mfma_f32_16x16x32_bf16 v[124:127], a[44:47], v[220:223], v[124:127]
  s_waitcnt lgkmcnt(4)
  v_mfma_f32_16x16x32_bf16 v[64:67], a[48:51], v[160:163], v[64:67]
  ds_read_b128 v[192:195], v19 offset:0
  v_mfma_f32_16x16x32_bf16 v[68:71], a[52:55], v[160:163], v[68:71]
  v_add_u32 v18, s33, v14
  v_mfma_f32_16x16x32_bf16 v[72:75], a[48:51], v[164:167], v[72:75]
  ds_read_b128 v[196:199], v19 offset:2048
  v_mfma_f32_16x16x32_bf16 v[76:79], a[52:55], v[164:167], v[76:79]
  buffer_load_dwordx4 v12, s[8:11], s30 offen offset:2048 lds
  v_mfma_f32_16x16x32_bf16 v[80:83], a[48:51], v[168:171], v[80:83]
  ds_read_b128 v[200:203], v19 offset:4096
  v_mfma_f32_16x16x32_bf16 v[84:87], a[52:55], v[168:171], v[84:87]
  v_mfma_f32_16x16x32_bf16 v[88:91], a[48:51], v[172:175], v[88:91]
  ds_read_b128 v[204:207], v19 offset:6144
  v_mfma_f32_16x16x32_bf16 v[92:95], a[52:55], v[172:175], v[92:95]
  s_waitcnt lgkmcnt(4)
  v_mfma_f32_16x16x32_bf16 v[96:99], a[48:51], v[176:179], v[96:99]
  ds_read_b128 v[208:211], v19 offset:8192
  v_mfma_f32_16x16x32_bf16 v[100:103], a[52:55], v[176:179], v[100:103]
  v_mfma_f32_16x16x32_bf16 v[104:107], a[48:51], v[180:183], v[104:107]
  ds_read_b128 v[212:215], v19 offset:10240
  v_mfma_f32_16x16x32_bf16 v[108:111], a[52:55], v[180:183], v[108:111]
  buffer_load_dwordx4 v13, s[8:11], s30 offen offset:3072 lds
  v_mfma_f32_16x16x32_bf16 v[112:115], a[48:51], v[184:187], v[112:115]
  ds_read_b128 v[216:219], v19 offset:12288
  s_add_u32 s30, s30, 128
  v_mfma_f32_16x16x32_bf16 v[116:119], a[52:55], v[184:187], v[116:119]
  s_add_u32 m0, m0, 16384
  v_mfma_f32_16x16x32_bf16 v[120:123], a[48:51], v[188:191], v[120:123]
  ds_read_b128 v[220:223], v19 offset:14336
  v_mfma_f32_16x16x32_bf16 v[124:127], a[52:55], v[188:191], v[124:127]
  s_waitcnt vmcnt(16) lgkmcnt(4)
  s_barrier
  v_mfma_f32_16x16x32_bf16 v[64:67], a[56:59], v[192:195], v[64:67]
  ds_read_b128 v[160:163], v18 offset:0
  v_mfma_f32_16x16x32_bf16 v[68:71], a[60:63], v[192:195], v[68:71]
  s_cmp_lt_u32 m0, s46
  s_cselect_b32 m0, m0, s47
  v_mfma_f32_16x16x32_bf16 v[72:75], a[56:59], v[196:199], v[72:75]
  ds_read_b128 v[164:167], v18 offset:2048
  v_add_u32 v19, s33, v15
  v_mfma_f32_16x16x32_bf16 v[76:79], a[60:63], v[196:199], v[76:79]
  buffer_load_dwordx4 v10, s[8:11], s30 offen offset:0 lds
  v_mfma_f32_16x16x32_bf16 v[80:83], a[56:59], v[200:203], v[80:83]
  ds_read_b128 v[168:171], v18 offset:4096
  s_add_u32 s33, s33, 16384
  v_mfma_f32_16x16x32_bf16 v[84:87], a[60:63], v[200:203], v[84:87]
  s_cmp_lt_u32 s33, 114688
  s_cselect_b32 s33, s33, 0
  v_mfma_f32_16x16x32_bf16 v[88:91], a[56:59], v[204:207], v[88:91]
  ds_read_b128 v[172:175], v18 offset:6144
  v_mfma_f32_16x16x32_bf16 v[92:95], a[60:63], v[204:207], v[92:95]
  s_waitcnt lgkmcnt(4)
  v_mfma_f32_16x16x32_bf16 v[96:99], a[56:59], v[208:211], v[96:99]
  ds_read_b128 v[176:179], v18 offset:8192
  v_mfma_f32_16x16x32_bf16 v[100:103], a[60:63], v[208:211], v[100:103]
  v_mfma_f32_16x16x32_bf16 v[104:107], a[56:59], v[212:215], v[104:107]
  ds_read_b128 v[180:183], v18 offset:10240
  v_mfma_f32_16x16x32_bf16 v[108:111], a[60:63], v[212:215], v[108:111]
  buffer_load_dwordx4 v11, s[8:11], s30 offen offset:1024 lds
  v_mfma_f32_16x16x32_bf16 v[112:115], a[56:59], v[216:219], v[112:115]
  ds_read_b128 v[184:187], v18 offset:12288
  v_mfma_f32_16x16x32_bf16 v[116:119], a[60:63], v[216:219], v[116:119]
  v_mfma_f32_16x16x32_bf16 v[120:123], a[56:59], v[220:223], v[120:123]
  ds_read_b128 v[188:191], v18 offset:14336
  v_mfma_f32_16x16x32_bf16 v[124:127], a[60:63], v[220:223], v[124:127]
  s_waitcnt lgkmcnt(4)
  v_mfma_f32_16x16x32_bf16 v[64:67], a[64:67], v[160:163], v[64:67]
  ds_read_b128 v[192:195], v19 offset:0
  v_mfma_f32_16x16x32_bf16 v[68:71], a[68:71], v[160:163], v[68:71]
  v_add_u32 v18, s33, v14
  v_mfma_f32_16x16x32_bf16 v[72:75], a[64:67], v[164:167], v[72:75]
  ds_read_b128 v[196:199], v19 offset:2048
  v_mfma_f32_16x16x32_bf16 v[76:79], a[68:71], v[164:167], v[76:79]
  buffer_load_dwordx4 v12, s[8:11], s30 offen offset:2048 lds
  v_mfma_f32_16x16x32_bf16 v[80:83], a[64:67], v[168:171], v[80:83]
  ds_read_b128 v[200:203], v19 offset:4096
  v_mfma_f32_16x16x32_bf16 v[84:87], a[68:71], v[168:171], v[84:87]
  v_mfma_f32_16x16x32_bf16 v[88:91], a[64:67], v[172:175], v[88:91]
  ds_read_b128 v[204:207], v19 offset:6144
  v_mfma_f32_16x16x32_bf16 v[92:95], a[68:71], v[172:175], v[92:95]
  s_waitcnt lgkmcnt(4)
  v_mfma_f32_16x16x32_bf16 v[96:99], a[64:67], v[176:179], v[96:99]
  ds_read_b128 v[208:211], v19 offset:8192
  v_mfma_f32_16x16x32_bf16 v[100:103], a[68:71], v[176:179], v[100:103]
  v_mfma_f32_16x16x32_bf16 v[104:107], a[64:67], v[180:183], v[104:107]
  ds_read_b128 v[212:215], v19 offset:10240
  v_mfma_f32_16x16x32_bf16 v[108:111], a[68:71], v[180:183], v[108:111]
  buffer_load_dwordx4 v13, s[8:11], s30 offen offset:3072 lds
  v_mfma_f32_16x16x32_bf16 v[112:115], a[64:67], v[184:187], v[112:115]
  ds_read_b128 v[216:219], v19 offset:12288
  s_add_u32 s30, s30, s25
  v_mfma_f32_16x16x32_bf16 v[116:119], a[68:71], v[184:187], v[116:119]
  s_sub_u32 s30, s30, 1152
  s_add_u32 m0, m0, 16384
  v_mfma_f32_16x16x32_bf16 v[120:123], a[64:67], v[188:191], v[120:123]
  ds_read_b128 v[220:223], v19 offset:14336
  v_mfma_f32_16x16x32_bf16 v[124:127], a[68:71], v[188:191], v[124:127]
  s_waitcnt vmcnt(16) lgkmcnt(4)
  s_barrier
  v_mfma_f32_16x16x32_bf16 v[64:67], a[72:75], v[192:195], v[64:67]
  ds_read_b128 v[160:163], v18 offset:0
  v_mfma_f32_16x16x32_bf16 v[68:71], a[76:79], v[192:195], v[68:71]
  s_cmp_lt_u32 m0, s46
  s_cselect_b32 m0, m0, s47
  v_mfma_f32_16x16x32_bf16 v[72:75], a[72:75], v[196:199], v[72:75]
  ds_read_b128 v[164:167], v18 offset:2048
  v_add_u32 v19, s33, v15
  v_mfma_f32_16x16x32_bf16 v[76:79], a[76:79], v[196:199], v[76:79]
  buffer_load_dwordx4 v10, s[8:11], s30 offen offset:0 lds
  v_mfma_f32_16x16x32_bf16 v[80:83], a[72:75], v[200:203], v[80:83]
  ds_read_b128 v[168:171], v18 offset:4096
  s_add_u32 s33, s33, 16384
  v_mfma_f32_16x16x32_bf16 v[84:87], a[76:79], v[200:203], v[84:87]
  s_cmp_lt_u32 s33, 114688
  s_cselect_b32 s33, s33, 0
  v_mfma_f32_16x16x32_bf16 v[88:91], a[72:75], v[204:207], v[88:91]
  ds_read_b128 v[172:175], v18 offset:6144
  v_mfma_f32_16x16x32_bf16 v[92:95], a[76:79], v[204:207], v[92:95]
  s_waitcnt lgkmcnt(4)
  v_mfma_f32_16x16x32_bf16 v[96:99], a[72:75], v[208:211], v[96:99]
  ds_read_b128 v[176:179], v18 offset:8192
  v_mfma_f32_16x16x32_bf16 v[100:103], a[76:79], v[208:211], v[100:103]
  v_mfma_f32_16x16x32_bf16 v[104:107], a[72:75], v[212:215], v[104:107]
  ds_read_b128 v[180:183], v18 offset:10240
  v_mfma_f32_16x16x32_bf16 v[108:111], a[76:79], v[212:215], v[108:111]
  buffer_load_dwordx4 v11, s[8:11], s30 offen offset:1024 lds
  v_mfma_f32_16x16x32_bf16 v[112:115], a[72:75], v[216:219], v[112:115]
  ds_read_b128 v[184:187], v18 offset:12288
  v_mfma_f32_16x16x32_bf16 v[116:119], a[76:79], v[216:219], v[116:119]
  v_mfma_f32_16x16x32_bf16 v[120:123], a[72:75], v[220:223], v[120:123]
  ds_read_b128 v[188:191], v18 offset:14336
  v_mfma_f32_16x16x32_bf16 v[124:127], a[76:79], v[220:223], v[124:127]
  s_waitcnt lgkmcnt(4)
  v_mfma_f32_16x16x32_bf16 v[64:67], a[80:83], v[160:163], v[64:67]
  ds_read_b128 v[192:195], v19 offset:0
  v_mfma_f32_16x16x32_bf16 v[68:71], a[84:87], v[160:163], v[68:71]
  v_add_u32 v18, s33, v14
  v_mfma_f32_16x16x32_bf16 v[72:75], a[80:83], v[164:167], v[72:75]
  ds_read_b128 v[196:199], v19 offset:2048
  v_mfma_f32_16x16x32_bf16 v[76:79], a[84:87], v[164:167], v[76:79]
  buffer_load_dwordx4 v12, s[8:11], s30 offen offset:2048 lds
  v_mfma_f32_16x16x32_bf16 v[80:83], a[80:83], v[168:171], v[80:83]
  ds_read_b128 v[200:203], v19 offset:4096
  v_mfma_f32_16x16x32_bf16 v[84:87], a[84:87], v[168:171], v[84:87]
  v_mfma_f32_16x16x32_bf16 v[88:91], a[80:83], v[172:175], v[88:91]
  ds_read_b128 v[204:207], v19 offset:6144
  v_mfma_f32_16x16x32_bf16 v[92:95], a[84:87], v[172:175], v[92:95]
  s_waitcnt lgkmcnt(4)
  v_mfma_f32_16x16x32_bf16 v[96:99], a[80:83], v[176:179], v[96:99]
  ds_read_b128 v[208:211], v19 offset:8192
  v_mfma_f32_16x16x32_bf16 v[100:103], a[84:87], v[176:179], v[100:103]
  v_mfma_f32_16x16x32_bf16 v[104:107], a[80:83], v[180:183], v[104:107]
  ds_read_b128 v[212:215], v19 offset:10240
  v_mfma_f32_16x16x32_bf16 v[108:111], a[84:87], v[180:183], v[108:111]
  buffer_load_dwordx4 v13, s[8:11], s30 offen offset:3072 lds
  v_mfma_f32_16x16x32_bf16 v[112:115], a[80:83], v[184:187], v[112:115]
  ds_read_b128 v[216:219], v19 offset:12288
  s_add_u32 s30, s30, 128
  v_mfma_f32_16x16x32_bf16 v[116:119], a[84:87], v[184:187], v[116:119]
  s_add_u32 m0, m0, 16384
  v_mfma_f32_16x16x32_bf16 v[120:123], a[80:83], v[188:191], v[120:123]
  ds_read_b128 v[220:223], v19 offset:14336
  v_mfma_f32_16x16x32_bf16 v[124:127], a[84:87], v[188:191], v[124:127]
  s_waitcnt vmcnt(16) lgkmcnt(4)
  s_barrier
  v_mfma_f32_16x16x32_bf16 v[64:67], a[88:91], v[192:195], v[64:67]
  ds_read_b128 v[160:163], v18 offset:0
  v_mfma_f32_16x16x32_bf16 v[68:71], a[92:95], v[192:195], v[68:71]
  s_cmp_lt_u32 m0, s46
  s_cselect_b32 m0, m0, s47
  v_mfma_f32_16x16x32_bf16 v[72:75], a[88:91], v[196:199], v[72:75]
  ds_read_b128 v[164:167], v18 offset:2048
  v_add_u32 v19, s33, v15
  v_mfma_f32_16x16x32_bf16 v[76:79], a[92:95], v[196:199], v[76:79]
  buffer_load_dwordx4 v10, s[8:11], s30 offen offset:0 lds
  v_mfma_f32_16x16x32_bf16 v[80:83], a[88:91], v[200:203], v[80:83]
  ds_read_b128 v[168:171], v18 offset:4096
  s_add_u32 s33, s33, 16384
  v_mfma_f32_16x16x32_bf16 v[84:87], a[92:95], v[200:203], v[84:87]
  s_cmp_lt_u32 s33, 114688
  s_cselect_b32 s33, s33, 0
  v_mfma_f32_16x16x32_bf16 v[88:91], a[88:91], v[204:207], v[88:91]
  ds_read_b128 v[172:175], v18 offset:6144
  v_mfma_f32_16x16x32_bf16 v[92:95], a[92:95], v[204:207], v[92:95]
  s_waitcnt lgkmcnt(4)
  v_mfma_f32_16x16x32_bf16 v[96:99], a[88:91], v[208:211], v[96:99]
  ds_read_b128 v[176:179], v18 offset:8192
  v_mfma_f32_16x16x32_bf16 v[100:103], a[92:95], v[208:211], v[100:103]
  v_mfma_f32_16x16x32_bf16 v[104:107], a[88:91], v[212:215], v[104:107]
  ds_read_b128 v[180:183], v18 offset:10240
  v_mfma_f32_16x16x32_bf16 v[108:111], a[92:95], v[212:215], v[108:111]
  buffer_load_dwordx4 v11, s[8:11], s30 offen offset:1024 lds
  v_mfma_f32_16x16x32_bf16 v[112:115], a[88:91], v[216:219], v[112:115]
  ds_read_b128 v[184:187], v18 offset:12288
  v_mfma_f32_16x16x32_bf16 v[116:119], a[92:95], v[216:219], v[116:119]
  v_mfma_f32_16x16x32_bf16 v[120:123], a[88:91], v[220:223], v[120:123]
  ds_read_b128 v[188:191], v18 offset:14336
  v_mfma_f32_16x16x32_bf16 v[124:127], a[92:95], v[220:223], v[124:127]
  s_waitcnt lgkmcnt(4)
  v_mfma_f32_16x16x32_bf16 v[64:67], a[96:99], v[160:163], v[64:67]
  ds_read_b128 v[192:195], v19 offset:0
  v_mfma_f32_16x16x32_bf16 v[68:71], a[100:103], v[160:163], v[68:71]
  v_add_u32 v18, s33, v14
  v_mfma_f32_16x16x32_bf16 v[72:75], a[96:99], v[164:167], v[72:75]
  ds_read_b128 v[196:199], v19 offset:2048
  v_mfma_f32_16x16x32_bf16 v[76:79], a[100:103], v[164:167], v[76:79]
  buffer_load_dwordx4 v12, s[8:11], s30 offen offset:2048 lds
  v_mfma_f32_16x16x32_bf16 v[80:83], a[96:99], v[168:171], v[80:83]
  ds_read_b128 v[200:203], v19 offset:4096
  v_mfma_f32_16x16x32_bf16 v[84:87], a[100:103], v[168:171], v[84:87]
  v_mfma_f32_16x16x32_bf16 v[88:91], a[96:99], v[172:175], v[88:91]
  ds_read_b128 v[204:207], v19 offset:6144
  v_mfma_f32_16x16x32_bf16 v[92:95], a[100:103], v[172:175], v[92:95]
  s_waitcnt lgkmcnt(4)
  v_mfma_f32_16x16x32_bf16 v[96:99], a[96:99], v[176:179], v[96:99]
  ds_read_b128 v[208:211], v19 offset:8192
  v_mfma_f32_16x16x32_bf16 v[100:103], a[100:103], v[176:179], v[100:103]
  v_mfma_f32_16x16x32_bf16 v[104:107], a[96:99], v[180:183], v[104:107]
  ds_read_b128 v[212:215], v19 offset:10240
  v_mfma_f32_16x16x32_bf16 v[108:111], a[100:103], v[180:183], v[108:111]
  buffer_load_dwordx4 v13, s[8:11], s30 offen offset:3072 lds
  v_mfma_f32_16x16x32_bf16 v[112:115], a[96:99], v[184:187], v[112:115]
  ds_read_b128 v[216:219], v19 offset:12288
  s_add_u32 s30, s30, 128
  v_mfma_f32_16x16x32_bf16 v[116:119], a[100:103], v[184:187], v[116:119]
  s_add_u32 m0, m0, 16384
  v_mfma_f32_16x16x32_bf16 v[120:123], a[96:99], v[188:191], v[120:123]
  ds_read_b128 v[220:223], v19 offset:14336
  v_mfma_f32_16x16x32_bf16 v[124:127], a[100:103], v[188:191], v[124:127]
  s_waitcnt vmcnt(16) lgkmcnt(4)
  s_barrier
  v_mfma_f32_16x16x32_bf16 v[64:67], a[104:107], v[192:195], v[64:67]
  ds_read_b128 v[160:163], v18 offset:0
  v_mfma_f32_16x16x32_bf16 v[68:71], a[108:111], v[192:195], v[68:71]
  s_cmp_lt_u32 m0, s46
  s_cselect_b32 m0, m0, s47
  v_mfma_f32_16x16x32_bf16 v[72:75], a[104:107], v[196:199], v[72:75]
  ds_read_b128 v[164:167], v18 offset:2048
  v_add_u32 v19, s33, v15
  v_mfma_f32_16x16x32_bf16 v[76:79], a[108:111], v[196:199], v[76:79]
  buffer_load_dwordx4 v10, s[8:11], s30 offen offset:0 lds
  v_mfma_f32_16x16x32_bf16 v[80:83], a[104:107], v[200:203], v[80:83]
  ds_read_b128 v[168:171], v18 offset:4096
  s_add_u32 s33, s33, 16384
  v_mfma_f32_16x16x32_bf16 v[84:87], a[108:111], v[200:203], v[84:87]
  s_cmp_lt_u32 s33, 114688
  s_cselect_b32 s33, s33, 0
  v_mfma_f32_16x16x32_bf16 v[88:91], a[104:107], v[204:207], v[88:91]
  ds_read_b128 v[172:175], v18 offset:6144
  v_mfma_f32_16x16x32_bf16 v[92:95], a[108:111], v[204:207], v[92:95]
  s_waitcnt lgkmcnt(4)
  v_mfma_f32_16x16x32_bf16 v[96:99], a[104:107], v[208:211], v[96:99]
  ds_read_b128 v[176:179], v18 offset:8192
  v_mfma_f32_16x16x32_bf16 v[100:103], a[108:111], v[208:211], v[100:103]
  v_mfma_f32_16x16x32_bf16 v[104:107], a[104:107], v[212:215], v[104:107]
  ds_read_b128 v[180:183], v18 offset:10240
  v_mfma_f32_16x16x32_bf16 v[108:111], a[108:111], v[212:215], v[108:111]
  buffer_load_dwordx4 v11, s[8:11], s30 offen offset:1024 lds
  v_mfma_f32_16x16x32_bf16 v[112:115], a[104:107], v[216:219], v[112:115]
  ds_read_b128 v[184:187], v18 offset:12288
  v_mfma_f32_16x16x32_bf16 v[116:119], a[108:111], v[216:219], v[116:119]
  v_mfma_f32_16x16x32_bf16 v[120:123], a[104:107], v[220:223], v[120:123]
  ds_read_b128 v[188:191], v18 offset:14336
  v_mfma_f32_16x16x32_bf16 v[124:127], a[108:111], v[220:223], v[124:127]
  s_waitcnt lgkmcnt(4)
  v_mfma_f32_16x16x32_bf16 v[64:67], a[112:115], v[160:163], v[64:67]
  ds_read_b128 v[192:195], v19 offset:0
  v_mfma_f32_16x16x32_bf16 v[68:71], a[116:119], v[160:163], v[68:71]
  v_add_u32 v18, s33, v14
  v_mfma_f32_16x16x32_bf16 v[72:75], a[112:115], v[164:167], v[72:75]
  ds_read_b128 v[196:199], v19 offset:2048
  v_mfma_f32_16x16x32_bf16 v[76:79], a[116:119], v[164:167], v[76:79]
  buffer_load_dwordx4 v12, s[8:11], s30 offen offset:2048 lds
  v_mfma_f32_16x16x32_bf16 v[80:83], a[112:115], v[168:171], v[80:83]
  ds_read_b128 v[200:203], v19 offset:4096
  v_mfma_f32_16x16x32_bf16 v[84:87], a[116:119], v[168:171], v[84:87]
  v_mfma_f32_16x16x32_bf16 v[88:91], a[112:115], v[172:175], v[88:91]
  ds_read_b128 v[204:207], v19 offset:6144
  v_mfma_f32_16x16x32_bf16 v[92:95], a[116:119], v[172:175], v[92:95]
  s_waitcnt lgkmcnt(4)
  v_mfma_f32_16x16x32_bf16 v[96:99], a[112:115], v[176:179], v[96:99]
  ds_read_b128 v[208:211], v19 offset:8192
  v_mfma_f32_16x16x32_bf16 v[100:103], a[116:119], v[176:179], v[100:103]
  v_mfma_f32_16x16x32_bf16 v[104:107], a[112:115], v[180:183], v[104:107]
  ds_read_b128 v[212:215], v19 offset:10240
  v_mfma_f32_16x16x32_bf16 v[108:111], a[116:119], v[180:183], v[108:111]
  buffer_load_dwordx4 v13, s[8:11], s30 offen offset:3072 lds
  v_mfma_f32_16x16x32_bf16 v[112:115], a[112:115], v[184:187], v[112:115]
  ds_read_b128 v[216:219], v19 offset:12288
  s_add_u32 s30, s30, 128
  v_mfma_f32_16x16x32_bf16 v[116:119], a[116:119], v[184:187], v[116:119]
  s_add_u32 m0, m0, 16384
  v_mfma_f32_16x16x32_bf16 v[120:123], a[112:115], v[188:191], v[120:123]
  ds_read_b128 v[220:223], v19 offset:14336
  v_mfma_f32_16x16x32_bf16 v[124:127], a[116:119], v[188:191], v[124:127]
  s_waitcnt vmcnt(16) lgkmcnt(4)
  s_barrier
  v_mfma_f32_16x16x32_bf16 v[64:67], a[120:123], v[192:195], v[64:67]
  ds_read_b128 v[160:163], v18 offset:0
  v_mfma_f32_16x16x32_bf16 v[68:71], a[124:127], v[192:195], v[68:71]
  s_cmp_lt_u32 m0, s46
  s_cselect_b32 m0, m0, s47
  v_mfma_f32_16x16x32_bf16 v[72:75], a[120:123], v[196:199], v[72:75]
  ds_read_b128 v[164:167], v18 offset:2048
  v_add_u32 v19, s33, v15
  v_mfma_f32_16x16x32_bf16 v[76:79], a[124:127], v[196:199], v[76:79]
  buffer_load_dwordx4 v10, s[8:11], s30 offen offset:0 lds
  v_mfma_f32_16x16x32_bf16 v[80:83], a[120:123], v[200:203], v[80:83]
  ds_read_b128 v[168:171], v18 offset:4096
  s_add_u32 s33, s33, 16384
  v_mfma_f32_16x16x32_bf16 v[84:87], a[124:127], v[200:203], v[84:87]
  s_cmp_lt_u32 s33, 114688
  s_cselect_b32 s33, s33, 0
  v_mfma_f32_16x16x32_bf16 v[88:91], a[120:123], v[204:207], v[88:91]
  ds_read_b128 v[172:175], v18 offset:6144
  v_mfma_f32_16x16x32_bf16 v[92:95], a[124:127], v[204:207], v[92:95]
  s_waitcnt lgkmcnt(4)
  v_mfma_f32_16x16x32_bf16 v[96:99], a[120:123], v[208:211], v[96:99]
  ds_read_b128 v[176:179], v18 offset:8192
  v_mfma_f32_16x16x32_bf16 v[100:103], a[124:127], v[208:211], v[100:103]
  v_mfma_f32_16x16x32_bf16 v[104:107], a[120:123], v[212:215], v[104:107]
  ds_read_b128 v[180:183], v18 offset:10240
  v_mfma_f32_16x16x32_bf16 v[108:111], a[124:127], v[212:215], v[108:111]
  buffer_load_dwordx4 v11, s[8:11], s30 offen offset:1024 lds
  v_mfma_f32_16x16x32_bf16 v[112:115], a[120:123], v[216:219], v[112:115]
  ds_read_b128 v[184:187], v18 offset:12288
  v_mfma_f32_16x16x32_bf16 v[116:119], a[124:127], v[216:219], v[116:119]
  v_mfma_f32_16x16x32_bf16 v[120:123], a[120:123], v[220:223], v[120:123]
  ds_read_b128 v[188:191], v18 offset:14336
  v_mfma_f32_16x16x32_bf16 v[124:127], a[124:127], v[220:223], v[124:127]
  s_waitcnt lgkmcnt(4)
  v_mfma_f32_16x16x32_bf16 v[64:67], a[128:131], v[160:163], v[64:67]
  ds_read_b128 v[192:195], v19 offset:0
  v_mfma_f32_16x16x32_bf16 v[68:71], a[132:135], v[160:163], v[68:71]
  v_add_u32 v18, s33, v14
  v_mfma_f32_16x16x32_bf16 v[72:75], a[128:131], v[164:167], v[72:75]
  ds_read_b128 v[196:199], v19 offset:2048
  v_mfma_f32_16x16x32_bf16 v[76:79], a[132:135], v[164:167], v[76:79]
  buffer_load_dwordx4 v12, s[8:11], s30 offen offset:2048 lds
  v_mfma_f32_16x16x32_bf16 v[80:83], a[128:131], v[168:171], v[80:83]
  ds_read_b128 v[200:203], v19 offset:4096
  v_mfma_f32_16x16x32_bf16 v[84:87], a[132:135], v[168:171], v[84:87]
  v_mfma_f32_16x16x32_bf16 v[88:91], a[128:131], v[172:175], v[88:91]
  ds_read_b128 v[204:207], v19 offset:6144
  v_mfma_f32_16x16x32_bf16 v[92:95], a[132:135], v[172:175], v[92:95]
  s_waitcnt lgkmcnt(4)
  v_mfma_f32_16x16x32_bf16 v[96:99], a[128:131], v[176:179], v[96:99]
  ds_read_b128 v[208:211], v19 offset:8192
  v_mfma_f32_16x16x32_bf16 v[100:103], a[132:135], v[176:179], v[100:103]
  v_mfma_f32_16x16x32_bf16 v[104:107], a[128:131], v[180:183], v[104:107]
  ds_read_b128 v[212:215], v19 offset:10240
  v_mfma_f32_16x16x32_bf16 v[108:111], a[132:135], v[180:183], v[108:111]
  buffer_load_dwordx4 v13, s[8:11], s30 offen offset:3072 lds
  v_mfma_f32_16x16x32_bf16 v[112:115], a[128:131], v[184:187], v[112:115]
  ds_read_b128 v[216:219], v19 offset:12288
  s_add_u32 s30, s30, 128
  v_mfma_f32_16x16x32_bf16 v[116:119], a[132:135], v[184:187], v[116:119]
  s_add_u32 m0, m0, 16384
  v_mfma_f32_16x16x32_bf16 v[120:123], a[128:131], v[188:191], v[120:123]
  ds_read_b128 v[220:223], v19 offset:14336
  v_mfma_f32_16x16x32_bf16 v[124:127], a[132:135], v[188:191], v[124:127]
  s_waitcnt vmcnt(16) lgkmcnt(4)
  s_barrier
  v_mfma_f32_16x16x32_bf16 v[64:67], a[136:139], v[192:195], v[64:67]
  ds_read_b128 v[160:163], v18 offset:0
  v_mfma_f32_16x16x32_bf16 v[68:71], a[140:143], v[192:195], v[68:71]
  s_cmp_lt_u32 m0, s46
  s_cselect_b32 m0, m0, s47
  v_mfma_f32_16x16x32_bf16 v[72:75], a[136:139], v[196:199], v[72:75]
  ds_read_b128 v[164:167], v18 offset:2048
  v_add_u32 v19, s33, v15
  v_mfma_f32_16x16x32_bf16 v[76:79], a[140:143], v[196:199], v[76:79]
  buffer_load_dwordx4 v10, s[8:11], s30 offen offset:0 lds
  v_mfma_f32_16x16x32_bf16 v[80:83], a[136:139], v[200:203], v[80:83]
  ds_read_b128 v[168:171], v18 offset:4096
  s_add_u32 s33, s33, 16384
  v_mfma_f32_16x16x32_bf16 v[84:87], a[140:143], v[200:203], v[84:87]
  s_cmp_lt_u32 s33, 114688
  s_cselect_b32 s33, s33, 0
  v_mfma_f32_16x16x32_bf16 v[88:91], a[136:139], v[204:207], v[88:91]
  ds_read_b128 v[172:175], v18 offset:6144
  v_mfma_f32_16x16x32_bf16 v[92:95], a[140:143], v[204:207], v[92:95]
  s_waitcnt lgkmcnt(4)
  v_mfma_f32_16x16x32_bf16 v[96:99], a[136:139], v[208:211], v[96:99]
  ds_read_b128 v[176:179], v18 offset:8192
  v_mfma_f32_16x16x32_bf16 v[100:103], a[140:143], v[208:211], v[100:103]
  v_mfma_f32_16x16x32_bf16 v[104:107], a[136:139], v[212:215], v[104:107]
  ds_read_b128 v[180:183], v18 offset:10240
  v_mfma_f32_16x16x32_bf16 v[108:111], a[140:143], v[212:215], v[108:111]
  buffer_load_dwordx4 v11, s[8:11], s30 offen offset:1024 lds
  v_mfma_f32_16x16x32_bf16 v[112:115], a[136:139], v[216:219], v[112:115]
  ds_read_b128 v[184:187], v18 offset:12288
  v_mfma_f32_16x16x32_bf16 v[116:119], a[140:143], v[216:219], v[116:119]
  v_mfma_f32_16x16x32_bf16 v[120:123], a[136:139], v[220:223], v[120:123]
  ds_read_b128 v[188:191], v18 offset:14336
  v_mfma_f32_16x16x32_bf16 v[124:127], a[140:143], v[220:223], v[124:127]
  s_waitcnt lgkmcnt(4)
  v_mfma_f32_16x16x32_bf16 v[64:67], a[144:147], v[160:163], v[64:67]
  ds_read_b128 v[192:195], v19 offset:0
  v_mfma_f32_16x16x32_bf16 v[68:71], a[148:151], v[160:163], v[68:71]
  v_add_u32 v18, s33, v14
  v_mfma_f32_16x16x32_bf16 v[72:75], a[144:147], v[164:167], v[72:75]
  ds_read_b128 v[196:199], v19 offset:2048
  v_mfma_f32_16x16x32_bf16 v[76:79], a[148:151], v[164:167], v[76:79]
  buffer_load_dwordx4 v12, s[8:11], s30 offen offset:2048 lds
  v_mfma_f32_16x16x32_bf16 v[80:83], a[144:147], v[168:171], v[80:83]
  ds_read_b128 v[200:203], v19 offset:4096
  v_mfma_f32_16x16x32_bf16 v[84:87], a[148:151], v[168:171], v[84:87]
  v_mfma_f32_16x16x32_bf16 v[88:91], a[144:147], v[172:175], v[88:91]
  ds_read_b128 v[204:207], v19 offset:6144
  v_mfma_f32_16x16x32_bf16 v[92:95], a[148:151], v[172:175], v[92:95]
  s_waitcnt lgkmcnt(4)
  v_mfma_f32_16x16x32_bf16 v[96:99], a[144:147], v[176:179], v[96:99]
  ds_read_b128 v[208:211], v19 offset:8192
  v_mfma_f32_16x16x32_bf16 v[100:103], a[148:151], v[176:179], v[100:103]
  v_mfma_f32_16x16x32_bf16 v[104:107], a[144:147], v[180:183], v[104:107]
  ds_read_b128 v[212:215], v19 offset:10240
  v_mfma_f32_16x16x32_bf16 v[108:111], a[148:151], v[180:183], v[108:111]
  buffer_load_dwordx4 v13, s[8:11], s30 offen offset:3072 lds
  v_mfma_f32_16x16x32_bf16 v[112:115], a[144:147], v[184:187], v[112:115]
  ds_read_b128 v[216:219], v19 offset:12288
  s_add_u32 s30, s30, 128
  v_mfma_f32_16x16x32_bf16 v[116:119], a[148:151], v[184:187], v[116:119]
  s_add_u32 m0, m0, 16384
  v_mfma_f32_16x16x32_bf16 v[120:123], a[144:147], v[188:191], v[120:123]
  ds_read_b128 v[220:223], v19 offset:14336
  v_mfma_f32_16x16x32_bf16 v[124:127], a[148:151], v[188:191], v[124:127]
  s_waitcnt vmcnt(16) lgkmcnt(4)
  s_barrier
  v_mfma_f32_16x16x32_bf16 v[64:67], a[152:155], v[192:195], v[64:67]
  ds_read_b128 v[160:163], v18 offset:0
  v_mfma_f32_16x16x32_bf16 v[68:71], a[156:159], v[192:195], v[68:71]
  s_cmp_lt_u32 m0, s46
  s_cselect_b32 m0, m0, s47
  v_mfma_f32_16x16x32_bf16 v[72:75], a[152:155], v[196:199], v[72:75]
  ds_read_b128 v[164:167], v18 offset:2048
  v_add_u32 v19, s33, v15
  v_mfma_f32_16x16x32_bf16 v[76:79], a[156:159], v[196:199], v[76:79]
  buffer_load_dwordx4 v10, s[8:11], s30 offen offset:0 lds
  v_cvt_pk_bf16_f32 v224, v64, v65
  v_cvt_pk_bf16_f32 v225, v66, v67
  v_mfma_f32_16x16x32_bf16 v[80:83], a[152:155], v[200:203], v[80:83]
  ds_read_b128 v[168:171], v18 offset:4096
  s_add_u32 s33, s33, 16384
  v_cvt_pk_bf16_f32 v226, v68, v69
  v_cvt_pk_bf16_f32 v227, v70, v71
  v_mfma_f32_16x16x32_bf16 v[84:87], a[156:159], v[200:203], v[84:87]
  s_cmp_lt_u32 s33, 114688
  s_cselect_b32 s33, s33, 0
  ds_write_b64 v22, v[224:225] offset:0
  ds_write_b64 v22, v[226:227] offset:32
  v_mfma_f32_16x16x32_bf16 v[88:91], a[152:155], v[204:207], v[88:91]
  ds_read_b128 v[172:175], v18 offset:6144
  v_cvt_pk_bf16_f32 v230, v72, v73
  v_cvt_pk_bf16_f32 v231, v74, v75
  v_cvt_pk_bf16_f32 v232, v76, v77
  v_mfma_f32_16x16x32_bf16 v[92:95], a[156:159], v[204:207], v[92:95]
  s_waitcnt lgkmcnt(6)
  v_cvt_pk_bf16_f32 v233, v78, v79
  ds_write_b64 v22, v[230:231] offset:4224
  ds_write_b64 v22, v[232:233] offset:4256
  v_mfma_f32_16x16x32_bf16 v[96:99], a[152:155], v[208:211], v[96:99]
  ds_read_b128 v[176:179], v18 offset:8192
  v_cvt_pk_bf16_f32 v224, v80, v81
  v_cvt_pk_bf16_f32 v225, v82, v83
  v_cvt_pk_bf16_f32 v226, v84, v85
  v_mfma_f32_16x16x32_bf16 v[100:103], a[156:159], v[208:211], v[100:103]
  v_cvt_pk_bf16_f32 v227, v86, v87
  ds_write_b64 v22, v[224:225] offset:8448
  ds_write_b64 v22, v[226:227] offset:8480
  v_cvt_pk_bf16_f32 v230, v88, v89
  v_mfma_f32_16x16x32_bf16 v[104:107], a[152:155], v[212:215], v[104:107]
  ds_read_b128 v[180:183], v18 offset:10240
  v_cvt_pk_bf16_f32 v231, v90, v91
  v_cvt_pk_bf16_f32 v232, v92, v93
  v_cvt_pk_bf16_f32 v233, v94, v95
  v_mfma_f32_16x16x32_bf16 v[108:111], a[156:159], v[212:215], v[108:111]
  buffer_load_dwordx4 v11, s[8:11], s30 offen offset:1024 lds
  ds_write_b64 v22, v[230:231] offset:12672
  ds_write_b64 v22, v[232:233] offset:12704
  v_mfma_f32_16x16x32_bf16 v[112:115], a[152:155], v[216:219], v[112:115]
  ds_read_b128 v[184:187], v18 offset:12288
  v_cvt_pk_bf16_f32 v224, v96, v97
  v_cvt_pk_bf16_f32 v225, v98, v99
  v_cvt_pk_bf16_f32 v226, v100, v101
  v_mfma_f32_16x16x32_bf16 v[116:119], a[156:159], v[216:219], v[116:119]
  v_cvt_pk_bf16_f32 v227, v102, v103
  ds_write_b64 v22, v[224:225] offset:16896
  ds_write_b64 v22, v[226:227] offset:16928
  v_cvt_pk_bf16_f32 v230, v104, v105
  v_mfma_f32_16x16x32_bf16 v[120:123], a[152:155], v[220:223], v[120:123]
  ds_read_b128 v[188:191], v18 offset:14336
  v_cvt_pk_bf16_f32 v231, v106, v107
  v_cvt_pk_bf16_f32 v232, v108, v109
  v_cvt_pk_bf16_f32 v233, v110, v111
  v_mfma_f32_16x16x32_bf16 v[124:127], a[156:159], v[220:223], v[124:127]
  ds_write_b64 v22, v[230:231] offset:21120
  ds_write_b64 v22, v[232:233] offset:21152
  v_cvt_pk_bf16_f32 v224, v112, v113
  v_cvt_pk_bf16_f32 v225, v114, v115
  s_nop 3
  v_cvt_pk_bf16_f32 v226, v116, v117
  v_cvt_pk_bf16_f32 v227, v118, v119
  ds_write_b64 v22, v[224:225] offset:25344
  ds_write_b64 v22, v[226:227] offset:25376
  v_cvt_pk_bf16_f32 v230, v120, v121
  v_cvt_pk_bf16_f32 v231, v122, v123
  v_cvt_pk_bf16_f32 v232, v124, v125
  v_cvt_pk_bf16_f32 v233, v126, v127
  ds_write_b64 v22, v[230:231] offset:29568
  ds_write_b64 v22, v[232:233] offset:29600
  s_waitcnt lgkmcnt(0)
  s_barrier
  ds_read_b64 v[144:145], v34 offset:1848
  ds_read_b64 v[146:147], v34 offset:1856
  ds_read_b64 v[148:149], v34 offset:1864
  ds_read_b64 v[150:151], v34 offset:1872
  ds_read_b64 v[152:153], v34 offset:1880
  ds_read_b64 v[64:65], v34 offset:1928
  ds_read_b64 v[66:67], v34 offset:1936
  ds_read_b64 v[68:69], v34 offset:1944
  ds_read_b64 v[70:71], v34 offset:1952
  ds_read_b64 v[72:73], v34 offset:1960
  ds_read_b64 v[74:75], v34 offset:1664
  ds_read_b64 v[76:77], v34 offset:1672
  ds_read_b64 v[78:79], v34 offset:1680
  ds_read_b64 v[80:81], v34 offset:1688
  ds_read_b64 v[82:83], v34 offset:1696
  ds_read_b64 v[84:85], v34 offset:1400
  ds_read_b64 v[86:87], v34 offset:1408
  ds_read_b64 v[88:89], v34 offset:1416
  ds_read_b64 v[90:91], v34 offset:1424
  ds_read_b64 v[92:93], v34 offset:1432
  ds_read_b64 v[94:95], v34 offset:1136
  ds_read_b64 v[96:97], v34 offset:1144
  ds_read_b64 v[98:99], v34 offset:1152
  ds_read_b64 v[100:101], v34 offset:1160
  ds_read_b64 v[102:103], v34 offset:1168
  ds_read_b64 v[104:105], v34 offset:872
  ds_read_b64 v[106:107], v34 offset:880
  ds_read_b64 v[108:109], v34 offset:888
  ds_read_b64 v[110:111], v34 offset:896
  ds_read_b64 v[112:113], v34 offset:904
  v_mov_b32 v224, 0
  v_mov_b32 v225, 0
  ds_read_b64 v[114:115], v34 offset:608
  ds_read_b64 v[116:117], v34 offset:616
  ds_read_b64 v[118:119], v34 offset:624
  ds_read_b64 v[120:121], v34 offset:632
  ds_read_b64 v[122:123], v34 offset:640
  v_mov_b32 v226, 0
  v_mov_b32 v227, 0
  ds_read_b64 v[124:125], v34 offset:344
  ds_read_b64 v[126:127], v34 offset:352
  ds_read_b64 v[128:129], v34 offset:360
  ds_read_b64 v[130:131], v34 offset:368
  ds_read_b64 v[132:133], v34 offset:376
  v_mov_b32 v228, 0
  v_mov_b32 v229, 0
  ds_read_b64 v[134:135], v34 offset:80
  ds_read_b64 v[136:137], v34 offset:88
  ds_read_b64 v[138:139], v34 offset:96
  ds_read_b64 v[140:141], v34 offset:104
  ds_read_b64 v[142:143], v34 offset:112
  v_mov_b32 v230, 0
  v_mov_b32 v231, 0
  v_mov_b32 v192, 0
  v_mov_b32 v193, 0
  v_mov_b32 v194, 0
  v_mov_b32 v195, 0
  v_mov_b32 v196, 0
  v_mov_b32 v197, 0
  v_mov_b32 v198, 0
  v_mov_b32 v199, 0
  v_mov_b32 v200, 0
  v_mov_b32 v201, 0
  v_mov_b32 v202, 0
  v_mov_b32 v203, 0
  v_mov_b32 v204, 0
  v_mov_b32 v205, 0
  v_mov_b32 v206, 0
  v_mov_b32 v207, 0
  v_mov_b32 v208, 0
  v_mov_b32 v209, 0
  v_mov_b32 v210, 0
  v_mov_b32 v211, 0
  s_waitcnt lgkmcnt(15)
  v_dot2c_f32_bf16 v224, v64, v144
  v_dot2c_f32_bf16 v225, v74, v144
  v_dot2c_f32_bf16 v226, v84, v144
  v_dot2c_f32_bf16 v227, v94, v144
  v_dot2c_f32_bf16 v228, v104, v144
  v_dot2c_f32_bf16 v224, v65, v145
  v_dot2c_f32_bf16 v225, v75, v145
  v_dot2c_f32_bf16 v226, v85, v145
  v_dot2c_f32_bf16 v227, v95, v145
  v_dot2c_f32_bf16 v228, v105, v145
  v_dot2c_f32_bf16 v224, v66, v146
  v_dot2c_f32_bf16 v225, v76, v146
  v_dot2c_f32_bf16 v226, v86, v146
  v_dot2c_f32_bf16 v227, v96, v146
  v_dot2c_f32_bf16 v228, v106, v146
  v_dot2c_f32_bf16 v224, v67, v147
  v_dot2c_f32_bf16 v225, v77, v147
  v_dot2c_f32_bf16 v226, v87, v147
  v_dot2c_f32_bf16 v227, v97, v147
  v_dot2c_f32_bf16 v228, v107, v147
  v_dot2c_f32_bf16 v224, v68, v148
  v_dot2c_f32_bf16 v225, v78, v148
  v_dot2c_f32_bf16 v226, v88, v148
  v_dot2c_f32_bf16 v227, v98, v148
  v_dot2c_f32_bf16 v228, v108, v148
  v_dot2c_f32_bf16 v224, v69, v149
  v_dot2c_f32_bf16 v225, v79, v149
  v_dot2c_f32_bf16 v226, v89, v149
  v_dot2c_f32_bf16 v227, v99, v149
  v_dot2c_f32_bf16 v228, v109, v149
  v_dot2c_f32_bf16 v224, v70, v150
  v_dot2c_f32_bf16 v225, v80, v150
  v_dot2c_f32_bf16 v226, v90, v150
  v_dot2c_f32_bf16 v227, v100, v150
  v_dot2c_f32_bf16 v228, v110, v150
  v_dot2c_f32_bf16 v224, v71, v151
  v_dot2c_f32_bf16 v225, v81, v151
  v_dot2c_f32_bf16 v226, v91, v151
  v_dot2c_f32_bf16 v227, v101, v151
  v_dot2c_f32_bf16 v228, v111, v151
  v_dot2c_f32_bf16 v224, v72, v152
  v_dot2c_f32_bf16 v225, v82, v152
  v_dot2c_f32_bf16 v226, v92, v152
  v_dot2c_f32_bf16 v227, v102, v152
  v_dot2c_f32_bf16 v228, v112, v152
  v_dot2c_f32_bf16 v224, v73, v153
  v_dot2c_f32_bf16 v225, v83, v153
  v_dot2c_f32_bf16 v226, v93, v153
  v_dot2c_f32_bf16 v227, v103, v153
  v_dot2c_f32_bf16 v228, v113, v153
  s_waitcnt lgkmcnt(0)
  v_dot2c_f32_bf16 v229, v114, v144
  v_dot2c_f32_bf16 v230, v124, v144
  v_dot2c_f32_bf16 v231, v134, v144
  v_dot2c_f32_bf16 v229, v115, v145
  v_dot2c_f32_bf16 v230, v125, v145
  v_dot2c_f32_bf16 v231, v135, v145
  v_dot2c_f32_bf16 v229, v116, v146
  v_dot2c_f32_bf16 v230, v126, v146
  v_dot2c_f32_bf16 v231, v136, v146
  v_dot2c_f32_bf16 v229, v117, v147
  v_dot2c_f32_bf16 v230, v127, v147
  v_dot2c_f32_bf16 v231, v137, v147
  v_dot2c_f32_bf16 v229, v118, v148
  v_dot2c_f32_bf16 v230, v128, v148
  v_dot2c_f32_bf16 v231, v138, v148
  v_dot2c_f32_bf16 v229, v119, v149
  v_dot2c_f32_bf16 v230, v129, v149
  v_dot2c_f32_bf16 v231, v139, v149
  v_dot2c_f32_bf16 v229, v120, v150
  v_dot2c_f32_bf16 v230, v130, v150
  v_dot2c_f32_bf16 v231, v140, v150
  v_dot2c_f32_bf16 v229, v121, v151
  v_dot2c_f32_bf16 v230, v131, v151
  v_dot2c_f32_bf16 v231, v141, v151
  v_dot2c_f32_bf16 v229, v122, v152
  v_dot2c_f32_bf16 v230, v132, v152
  v_dot2c_f32_bf16 v231, v142, v152
  v_dot2c_f32_bf16 v229, v123, v153
  v_dot2c_f32_bf16 v230, v133, v153
  v_dot2c_f32_bf16 v231, v143, v153
  ds_read_b64 v[64:65], v38 offset:2008
  ds_read_b64 v[66:67], v38 offset:2016
  ds_read_b64 v[68:69], v38 offset:2024
  ds_read_b64 v[70:71], v38 offset:2032
  ds_read_b64 v[72:73], v39 offset:2040
  ds_read_b64 v[74:75], v38 offset:1744
  ds_read_b64 v[76:77], v38 offset:1752
  ds_read_b64 v[78:79], v38 offset:1760
  ds_read_b64 v[80:81], v38 offset:1768
  ds_read_b64 v[82:83], v39 offset:1776
  ds_read_b64 v[84:85], v38 offset:1480
  ds_read_b64 v[86:87], v38 offset:1488
  ds_read_b64 v[88:89], v38 offset:1496
  ds_read_b64 v[90:91], v38 offset:1504
  ds_read_b64 v[92:93], v39 offset:1512
  ds_read_b64 v[94:95], v38 offset:1216
  ds_read_b64 v[96:97], v38 offset:1224
  ds_read_b64 v[98:99], v38 offset:1232
  ds_read_b64 v[100:101], v38 offset:1240
  ds_read_b64 v[102:103], v39 offset:1248
  ds_read_b64 v[104:105], v38 offset:952
  ds_read_b64 v[106:107], v38 offset:960
  ds_read_b64 v[108:109], v38 offset:968
  ds_read_b64 v[110:111], v38 offset:976
  ds_read_b64 v[112:113], v39 offset:984
  ds_read_b64 v[114:115], v38 offset:688
  ds_read_b64 v[116:117], v38 offset:696
  ds_read_b64 v[118:119], v38 offset:704
  ds_read_b64 v[120:121], v38 offset:712
  ds_read_b64 v[122:123], v39 offset:720
  ds_read_b64 v[124:125], v38 offset:424
  ds_read_b64 v[126:127], v38 offset:432
  ds_read_b64 v[128:129], v38 offset:440
  ds_read_b64 v[130:131], v38 offset:448
  ds_read_b64 v[132:133], v39 offset:456
  ds_read_b64 v[134:135], v38 offset:160
  ds_read_b64 v[136:137], v38 offset:168
  ds_read_b64 v[138:139], v38 offset:176
  ds_read_b64 v[140:141], v38 offset:184
  ds_read_b64 v[142:143], v39 offset:192
  v_cvt_pk_bf16_f32 v4, v224, v225
  v_lshlrev_b32 v224, 16, v4
  v_and_b32 v225, 0xffff0000, v4
  v_mul_f32 v224, s60, v224
  v_mul_f32 v225, s60, v225
  v_cvt_pk_bf16_f32 v4, v224, v225
  v_lshlrev_b32 v224, 16, v4
  v_and_b32 v225, 0xffff0000, v4
  v_cndmask_b32 v224, v37, v224, s[76:77]
  v_cndmask_b32 v225, v37, v225, s[78:79]
  v_cvt_pk_bf16_f32 v4, v226, v227
  v_lshlrev_b32 v226, 16, v4
  v_and_b32 v227, 0xffff0000, v4
  v_mul_f32 v226, s60, v226
  v_mul_f32 v227, s60, v227
  v_cvt_pk_bf16_f32 v4, v226, v227
  v_lshlrev_b32 v226, 16, v4
  v_and_b32 v227, 0xffff0000, v4
  v_cndmask_b32 v226, v37, v226, s[80:81]
  v_cndmask_b32 v227, v37, v227, s[82:83]
  v_cvt_pk_bf16_f32 v4, v228, v229
  v_lshlrev_b32 v228, 16, v4
  v_and_b32 v229, 0xffff0000, v4
  v_mul_f32 v228, s60, v228
  v_mul_f32 v229, s60, v229
  v_cvt_pk_bf16_f32 v4, v228, v229
  v_lshlrev_b32 v228, 16, v4
  v_and_b32 v229, 0xffff0000, v4
  v_cndmask_b32 v228, v37, v228, s[84:85]
  v_cndmask_b32 v229, v37, v229, s[86:87]
  v_cvt_pk_bf16_f32 v4, v230, v231
  v_lshlrev_b32 v230, 16, v4
  v_and_b32 v231, 0xffff0000, v4
  v_mul_f32 v230, s60, v230
  v_mul_f32 v231, s60, v231
  v_cvt_pk_bf16_f32 v4, v230, v231
  v_lshlrev_b32 v230, 16, v4
  v_and_b32 v231, 0xffff0000, v4
  v_cndmask_b32 v230, v37, v230, s[88:89]
  v_cndmask_b32 v231, v37, v231, s[90:91]
  v_max3_f32 v5, v224, v225, v226
  v_max3_f32 v5, v5, v227, v228
  v_max3_f32 v5, v5, v229, v230
  v_max_f32 v5, v5, v231
  v_sub_f32 v224, v224, v5
  v_mul_f32 v224, s61, v224
  v_exp_f32 v224, v224
  v_sub_f32 v225, v225, v5
  v_mul_f32 v225, s61, v225
  v_exp_f32 v225, v225
  v_sub_f32 v226, v226, v5
  v_mul_f32 v226, s61, v226
  v_exp_f32 v226, v226
  v_sub_f32 v227, v227, v5
  v_mul_f32 v227, s61, v227
  v_exp_f32 v227, v227
  v_sub_f32 v228, v228, v5
  v_mul_f32 v228, s61, v228
  v_exp_f32 v228, v228
  v_sub_f32 v229, v229, v5
  v_mul_f32 v229, s61, v229
  v_exp_f32 v229, v229
  v_sub_f32 v230, v230, v5
  v_mul_f32 v230, s61, v230
  v_exp_f32 v230, v230
  v_sub_f32 v231, v231, v5
  v_mul_f32 v231, s61, v231
  v_exp_f32 v231, v231
  s_nop 0
  v_add_f32 v5, v224, v225
  v_add_f32 v5, v5, v226
  v_add_f32 v5, v5, v227
  v_add_f32 v5, v5, v228
  v_add_f32 v5, v5, v229
  v_add_f32 v5, v5, v230
  v_add_f32 v5, v5, v231
  v_rcp_f32 v5, v5
  s_nop 0
  v_mul_f32 v224, v224, v5
  v_mul_f32 v225, v225, v5
  v_mul_f32 v226, v226, v5
  v_mul_f32 v227, v227, v5
  v_mul_f32 v228, v228, v5
  v_mul_f32 v229, v229, v5
  v_mul_f32 v230, v230, v5
  v_mul_f32 v231, v231, v5
  v_cvt_pk_bf16_f32 v232, v224, v225
  v_cvt_pk_bf16_f32 v233, v226, v227
  v_cvt_pk_bf16_f32 v234, v228, v229
  v_cvt_pk_bf16_f32 v235, v230, v231
  s_waitcnt lgkmcnt(15)
  v_perm_b32 v236, v74, v64, s62
  v_perm_b32 v237, v74, v64, s63
  v_dot2c_f32_bf16 v192, v236, v232
  v_dot2c_f32_bf16 v193, v237, v232
  v_perm_b32 v238, v75, v65, s62
  v_perm_b32 v239, v75, v65, s63
  v_dot2c_f32_bf16 v194, v238, v232
  v_dot2c_f32_bf16 v195, v239, v232
  v_perm_b32 v240, v76, v66, s62
  v_perm_b32 v241, v76, v66, s63
  v_dot2c_f32_bf16 v196, v240, v232
  v_dot2c_f32_bf16 v197, v241, v232
  v_perm_b32 v242, v77, v67, s62
  v_perm_b32 v243, v77, v67, s63
  v_dot2c_f32_bf16 v198, v242, v232
  v_dot2c_f32_bf16 v199, v243, v232
  v_perm_b32 v236, v78, v68, s62
  v_perm_b32 v237, v78, v68, s63
  v_dot2c_f32_bf16 v200, v236, v232
  v_dot2c_f32_bf16 v201, v237, v232
  v_perm_b32 v238, v79, v69, s62
  v_perm_b32 v239, v79, v69, s63
  v_dot2c_f32_bf16 v202, v238, v232
  v_dot2c_f32_bf16 v203, v239, v232
  v_perm_b32 v240, v80, v70, s62
  v_perm_b32 v241, v80, v70, s63
  v_dot2c_f32_bf16 v204, v240, v232
  v_dot2c_f32_bf16 v205, v241, v232
  v_perm_b32 v242, v81, v71, s62
  v_perm_b32 v243, v81, v71, s63
  v_dot2c_f32_bf16 v206, v242, v232
  v_dot2c_f32_bf16 v207, v243, v232
  v_perm_b32 v236, v82, v72, s62
  v_perm_b32 v237, v82, v72, s63
  v_dot2c_f32_bf16 v208, v236, v232
  v_dot2c_f32_bf16 v209, v237, v232
  v_perm_b32 v238, v83, v73, s62
  v_perm_b32 v239, v83, v73, s63
  v_dot2c_f32_bf16 v210, v238, v232
  v_dot2c_f32_bf16 v211, v239, v232
  s_waitcnt lgkmcnt(15)
  v_perm_b32 v236, v94, v84, s62
  v_perm_b32 v237, v94, v84, s63
  v_dot2c_f32_bf16 v192, v236, v233
  v_dot2c_f32_bf16 v193, v237, v233
  v_perm_b32 v238, v95, v85, s62
  v_perm_b32 v239, v95, v85, s63
  v_dot2c_f32_bf16 v194, v238, v233
  v_dot2c_f32_bf16 v195, v239, v233
  v_perm_b32 v240, v96, v86, s62
  v_perm_b32 v241, v96, v86, s63
  v_dot2c_f32_bf16 v196, v240, v233
  v_dot2c_f32_bf16 v197, v241, v233
  v_perm_b32 v242, v97, v87, s62
  v_perm_b32 v243, v97, v87, s63
  v_dot2c_f32_bf16 v198, v242, v233
  v_dot2c_f32_bf16 v199, v243, v233
  v_perm_b32 v236, v98, v88, s62
  v_perm_b32 v237, v98, v88, s63
  v_dot2c_f32_bf16 v200, v236, v233
  v_dot2c_f32_bf16 v201, v237, v233
  v_perm_b32 v238, v99, v89, s62
  v_perm_b32 v239, v99, v89, s63
  v_dot2c_f32_bf16 v202, v238, v233
  v_dot2c_f32_bf16 v203, v239, v233
  v_perm_b32 v240, v100, v90, s62
  v_perm_b32 v241, v100, v90, s63
  v_dot2c_f32_bf16 v204, v240, v233
  v_dot2c_f32_bf16 v205, v241, v233
  v_perm_b32 v242, v101, v91, s62
  v_perm_b32 v243, v101, v91, s63
  v_dot2c_f32_bf16 v206, v242, v233
  v_dot2c_f32_bf16 v207, v243, v233
  v_perm_b32 v236, v102, v92, s62
  v_perm_b32 v237, v102, v92, s63
  v_dot2c_f32_bf16 v208, v236, v233
  v_dot2c_f32_bf16 v209, v237, v233
  v_perm_b32 v238, v103, v93, s62
  v_perm_b32 v239, v103, v93, s63
  v_dot2c_f32_bf16 v210, v238, v233
  v_dot2c_f32_bf16 v211, v239, v233
  s_waitcnt lgkmcnt(10)
  v_perm_b32 v236, v114, v104, s62
  v_perm_b32 v237, v114, v104, s63
  v_dot2c_f32_bf16 v192, v236, v234
  v_dot2c_f32_bf16 v193, v237, v234
  v_perm_b32 v238, v115, v105, s62
  v_perm_b32 v239, v115, v105, s63
  v_dot2c_f32_bf16 v194, v238, v234
  v_dot2c_f32_bf16 v195, v239, v234
  v_perm_b32 v240, v116, v106, s62
  v_perm_b32 v241, v116, v106, s63
  v_dot2c_f32_bf16 v196, v240, v234
  v_dot2c_f32_bf16 v197, v241, v234
  v_perm_b32 v242, v117, v107, s62
  v_perm_b32 v243, v117, v107, s63
  v_dot2c_f32_bf16 v198, v242, v234
  v_dot2c_f32_bf16 v199, v243, v234
  v_perm_b32 v236, v118, v108, s62
  v_perm_b32 v237, v118, v108, s63
  v_dot2c_f32_bf16 v200, v236, v234
  v_dot2c_f32_bf16 v201, v237, v234
  v_perm_b32 v238, v119, v109, s62
  v_perm_b32 v239, v119, v109, s63
  v_dot2c_f32_bf16 v202, v238, v234
  v_dot2c_f32_bf16 v203, v239, v234
  v_perm_b32 v240, v120, v110, s62
  v_perm_b32 v241, v120, v110, s63
  v_dot2c_f32_bf16 v204, v240, v234
  v_dot2c_f32_bf16 v205, v241, v234
  v_perm_b32 v242, v121, v111, s62
  v_perm_b32 v243, v121, v111, s63
  v_dot2c_f32_bf16 v206, v242, v234
  v_dot2c_f32_bf16 v207, v243, v234
  v_perm_b32 v236, v122, v112, s62
  v_perm_b32 v237, v122, v112, s63
  v_dot2c_f32_bf16 v208, v236, v234
  v_dot2c_f32_bf16 v209, v237, v234
  v_perm_b32 v238, v123, v113, s62
  v_perm_b32 v239, v123, v113, s63
  v_dot2c_f32_bf16 v210, v238, v234
  v_dot2c_f32_bf16 v211, v239, v234
  s_waitcnt lgkmcnt(0)
  v_perm_b32 v236, v134, v124, s62
  v_perm_b32 v237, v134, v124, s63
  v_dot2c_f32_bf16 v192, v236, v235
  v_dot2c_f32_bf16 v193, v237, v235
  v_perm_b32 v238, v135, v125, s62
  v_perm_b32 v239, v135, v125, s63
  v_dot2c_f32_bf16 v194, v238, v235
  v_dot2c_f32_bf16 v195, v239, v235
  v_perm_b32 v240, v136, v126, s62
  v_perm_b32 v241, v136, v126, s63
  v_dot2c_f32_bf16 v196, v240, v235
  v_dot2c_f32_bf16 v197, v241, v235
  v_perm_b32 v242, v137, v127, s62
  v_perm_b32 v243, v137, v127, s63
  v_dot2c_f32_bf16 v198, v242, v235
  v_dot2c_f32_bf16 v199, v243, v235
  v_perm_b32 v236, v138, v128, s62
  v_perm_b32 v237, v138, v128, s63
  v_dot2c_f32_bf16 v200, v236, v235
  v_dot2c_f32_bf16 v201, v237, v235
  v_perm_b32 v238, v139, v129, s62
  v_perm_b32 v239, v139, v129, s63
  v_dot2c_f32_bf16 v202, v238, v235
  v_dot2c_f32_bf16 v203, v239, v235
  v_perm_b32 v240, v140, v130, s62
  v_perm_b32 v241, v140, v130, s63
  v_dot2c_f32_bf16 v204, v240, v235
  v_dot2c_f32_bf16 v205, v241, v235
  v_perm_b32 v242, v141, v131, s62
  v_perm_b32 v243, v141, v131, s63
  v_dot2c_f32_bf16 v206, v242, v235
  v_dot2c_f32_bf16 v207, v243, v235
  v_perm_b32 v236, v142, v132, s62
  v_perm_b32 v237, v142, v132, s63
  v_dot2c_f32_bf16 v208, v236, v235
  v_dot2c_f32_bf16 v209, v237, v235
  v_perm_b32 v238, v143, v133, s62
  v_perm_b32 v239, v143, v133, s63
  v_dot2c_f32_bf16 v210, v238, v235
  v_dot2c_f32_bf16 v211, v239, v235
  s_cmp_lg_u32 s20, 0
  s_cbranch_scc1 bh_209
  ds_read_b64 v[64:65], v35 offset:33792
  ds_read_b64 v[66:67], v35 offset:34304
  ds_read_b64 v[68:69], v35 offset:34816
  ds_read_b64 v[70:71], v35 offset:35328
  ds_read_b64 v[72:73], v35 offset:35840
  s_waitcnt lgkmcnt(0)
  ds_write_b64 v35, v[64:65] offset:0
  ds_write_b64 v35, v[66:67] offset:512
  ds_write_b64 v35, v[68:69] offset:1024
  ds_write_b64 v35, v[70:71] offset:1536
  ds_write_b64 v35, v[72:73] offset:2048
bh_209:
  s_nop 1
  v_cvt_pk_bf16_f32 v244, v192, v193
  v_cvt_pk_bf16_f32 v245, v194, v195
  v_cvt_pk_bf16_f32 v246, v196, v197
  v_cvt_pk_bf16_f32 v247, v198, v199
  v_cvt_pk_bf16_f32 v248, v200, v201
  v_cvt_pk_bf16_f32 v249, v202, v203
  v_cvt_pk_bf16_f32 v250, v204, v205
  v_cvt_pk_bf16_f32 v251, v206, v207
  v_cvt_pk_bf16_f32 v252, v208, v209
  v_cvt_pk_bf16_f32 v253, v210, v211
  buffer_store_dwordx4 v[244:247], v29, s[16:19], s27 offen sc1
  buffer_store_dwordx4 v[248:251], v30, s[16:19], s27 offen sc1
  buffer_store_dwordx2 v[252:253], v31, s[16:19], s27 offen sc1
  s_add_u32 s27, s27, 2048
  s_mov_b64 s[78:79], -1
  s_mov_b64 s[80:81], -1
  s_mov_b64 s[82:83], -1
  s_mov_b64 s[84:85], -1
  s_mov_b64 s[86:87], -1
  s_mov_b64 s[88:89], -1
  s_mov_b64 s[90:91], -1
  s_sub_u32 s26, s26, 1
  s_cmp_gt_u32 s26, 0
  s_waitcnt lgkmcnt(0)
  s_cbranch_scc1 bf_blk_208
  s_waitcnt vmcnt(0) lgkmcnt(0)
  s_load_dwordx2 s[32:33], s[0:1], 96
  s_waitcnt lgkmcnt(0)
  s_mov_b32 s32, s32
  s_mov_b32 s33, s33
  s_mov_b32 s34, 256
  s_mov_b32 s35, 0x00020000
  s_mov_b32 s21, 76
  s_cmp_lg_u32 s20, 0
  s_cbranch_scc1 wf_211
  v_mov_b32 v4, 0
  s_mov_b32 s101, 0
wf_210:
  buffer_load_dword v5, v4, s[32:35], s21 offen sc1
  s_add_u32 s101, s101, 1
  s_cmp_gt_u32 s101, 131072
  s_cbranch_scc1 main_end
  s_waitcnt vmcnt(0)
  v_readfirstlane_b32 s100, v5
  s_cmp_ge_u32 s100, 32
  s_cbranch_scc1 wf_211
  s_sleep 8
  s_branch wf_210
wf_211:
  s_barrier
  s_mov_b32 s21, 92160
  s_cmp_lg_u32 s20, 0
  s_cbranch_scc1 af_212
  v_mov_b32 v4, 0
  v_mov_b32 v5, 1
  s_mov_b64 exec, 1
  buffer_atomic_add v5, v4, s[72:75], s21 offen sc1
  s_mov_b64 exec, -1
  s_nop 1
af_212:
  s_barrier
  s_mov_b32 s84, 0
  s_mov_b32 s85, -1
  s_load_dwordx2 s[4:5], s[0:1], 0
  s_load_dwordx2 s[6:7], s[0:1], 16
  s_load_dwordx2 s[38:39], s[0:1], 104
  s_mov_b32 s42, s2
  s_mov_b32 s41, 0
  s_waitcnt lgkmcnt(0)
  s_mov_b32 s8, s4
  s_mov_b32 s9, s5
  s_mov_b32 s10, 2621440
  s_mov_b32 s11, 0x00020000
  s_mov_b32 s12, s6
  s_mov_b32 s13, s7
  s_mov_b32 s14, 7864320
  s_mov_b32 s15, 0x00020000
  s_mov_b32 s16, s38
  s_mov_b32 s17, s39
  s_mov_b32 s18, 50331648
  s_mov_b32 s19, 0x00020000
  s_add_u32 s52, s38, 50331648
  s_addc_u32 s53, s39, 0
  s_mov_b32 s54, 6291456
  s_mov_b32 s55, 0x00020000
  s_add_u32 s56, s38, 85983232
  s_addc_u32 s57, s39, 0
  s_mov_b32 s58, 6815744
  s_mov_b32 s59, 0x00020000
  s_load_dwordx2 s[72:73], s[0:1], 104
  s_waitcnt lgkmcnt(0)
  s_add_u32 s72, s72, 81068032
  s_addc_u32 s73, s73, 0
  s_mov_b32 s74, 117760
  s_mov_b32 s75, 0x00020000
  s_mul_i32 s44, s42, 384
  v_mov_b32 v9, 2731
  v_add_u32 v8, 0, v1
  v_mul_u32_u24 v7, v8, v9
  v_lshrrev_b32 v7, 16, v7
  v_mul_u32_u24 v4, 24, v7
  v_sub_u32 v8, v8, v4
  s_mov_b32 s21, 12288
  v_mul_lo_u32 v7, v7, s21
  v_lshl_add_u32 v4, v8, 4, v7
  v_add_u32 v8, 64, v1
  v_mul_u32_u24 v7, v8, v9
  v_lshrrev_b32 v7, 16, v7
  v_mul_u32_u24 v5, 24, v7
  v_sub_u32 v8, v8, v5
  s_mov_b32 s21, 12288
  v_mul_lo_u32 v7, v7, s21
  v_lshl_add_u32 v5, v8, 4, v7
  v_add_u32 v8, 128, v1
  v_mul_u32_u24 v7, v8, v9
  v_lshrrev_b32 v7, 16, v7
  v_mul_u32_u24 v6, 24, v7
  v_sub_u32 v8, v8, v6
  s_mov_b32 s21, 12288
  v_mul_lo_u32 v7, v7, s21
  v_lshl_add_u32 v6, v8, 4, v7
  v_lshrrev_b32 v7, 2, v2
  v_lshl_add_u32 v7, v3, 3, v7
  v_mul_u32_u24 v7, 384, v7
  v_and_b32 v8, 3, v2
  v_lshlrev_b32 v8, 3, v8
  s_mul_i32 s21, s20, 96
  v_add3_u32 v7, v7, v8, s21
  v_add_u32 v8, 61440, v7
  s_mul_i32 s21, s20, 491520
  s_add_u32 s21, s21, 0
  s_add_u32 s21, s21, s44
  s_mul_i32 s22, s20, 15360
  s_add_u32 s22, s22, 0
  s_add_u32 m0, s22, 0
  s_nop 0
  buffer_load_dwordx4 v4, s[12:15], s21 offen lds
  s_add_u32 m0, s22, 1024
  s_nop 0
  buffer_load_dwordx4 v5, s[12:15], s21 offen lds
  s_add_u32 m0, s22, 2048
  s_nop 0
  buffer_load_dwordx4 v6, s[12:15], s21 offen lds
  s_mul_i32 s21, s20, 491520
  s_add_u32 s21, s21, 98304
  s_add_u32 s21, s21, s44
  s_mul_i32 s22, s20, 15360
  s_add_u32 s22, s22, 3072
  s_add_u32 m0, s22, 0
  s_nop 0
  buffer_load_dwordx4 v4, s[12:15], s21 offen lds
  s_add_u32 m0, s22, 1024
  s_nop 0
  buffer_load_dwordx4 v5, s[12:15], s21 offen lds
  s_add_u32 m0, s22, 2048
  s_nop 0
  buffer_load_dwordx4 v6, s[12:15], s21 offen lds
  s_mul_i32 s21, s20, 491520
  s_add_u32 s21, s21, 196608
  s_add_u32 s21, s21, s44
  s_mul_i32 s22, s20, 15360
  s_add_u32 s22, s22, 6144
  s_add_u32 m0, s22, 0
  s_nop 0
  buffer_load_dwordx4 v4, s[12:15], s21 offen lds
  s_add_u32 m0, s22, 1024
  s_nop 0
  buffer_load_dwordx4 v5, s[12:15], s21 offen lds
  s_add_u32 m0, s22, 2048
  s_nop 0
  buffer_load_dwordx4 v6, s[12:15], s21 offen lds
  s_mul_i32 s21, s20, 491520
  s_add_u32 s21, s21, 294912
  s_add_u32 s21, s21, s44
  s_mul_i32 s22, s20, 15360
  s_add_u32 s22, s22, 9216
  s_add_u32 m0, s22, 0
  s_nop 0
  buffer_load_dwordx4 v4, s[12:15], s21 offen lds
  s_add_u32 m0, s22, 1024
  s_nop 0
  buffer_load_dwordx4 v5, s[12:15], s21 offen lds
  s_add_u32 m0, s22, 2048
  s_nop 0
  buffer_load_dwordx4 v6, s[12:15], s21 offen lds
  s_mul_i32 s21, s20, 491520
  s_add_u32 s21, s21, 393216
  s_add_u32 s21, s21, s44
  s_mul_i32 s22, s20, 15360
  s_add_u32 s22, s22, 12288
  s_add_u32 m0, s22, 0
  s_nop 0
  buffer_load_dwordx4 v4, s[12:15], s21 offen lds
  s_add_u32 m0, s22, 1024
  s_nop 0
  buffer_load_dwordx4 v5, s[12:15], s21 offen lds
  s_add_u32 m0, s22, 2048
  s_nop 0
  buffer_load_dwordx4 v6, s[12:15], s21 offen lds
  s_mul_i32 s21, s20, 491520
  s_add_u32 s21, s21, 1966080
  s_add_u32 s21, s21, s44
  s_mul_i32 s22, s20, 15360
  s_add_u32 s22, s22, 61440
  s_add_u32 m0, s22, 0
  s_nop 0
  buffer_load_dwordx4 v4, s[12:15], s21 offen lds
  s_add_u32 m0, s22, 1024
  s_nop 0
  buffer_load_dwordx4 v5, s[12:15], s21 offen lds
  s_add_u32 m0, s22, 2048
  s_nop 0
  buffer_load_dwordx4 v6, s[12:15], s21 offen lds
  s_mul_i32 s21, s20, 491520
  s_add_u32 s21, s21, 2064384
  s_add_u32 s21, s21, s44
  s_mul_i32 s22, s20, 15360
  s_add_u32 s22, s22, 64512
  s_add_u32 m0, s22, 0
  s_nop 0
  buffer_load_dwordx4 v4, s[12:15], s21 offen lds
  s_add_u32 m0, s22, 1024
  s_nop 0
  buffer_load_dwordx4 v5, s[12:15], s21 offen lds
  s_add_u32 m0, s22, 2048
  s_nop 0
  buffer_load_dwordx4 v6, s[12:15], s21 offen lds
  s_mul_i32 s21, s20, 491520
  s_add_u32 s21, s21, 2162688
  s_add_u32 s21, s21, s44
  s_mul_i32 s22, s20, 15360
  s_add_u32 s22, s22, 67584
  s_add_u32 m0, s22, 0
  s_nop 0
  buffer_load_dwordx4 v4, s[12:15], s21 offen lds
  s_add_u32 m0, s22, 1024
  s_nop 0
  buffer_load_dwordx4 v5, s[12:15], s21 offen lds
  s_add_u32 m0, s22, 2048
  s_nop 0
  buffer_load_dwordx4 v6, s[12:15], s21 offen lds
  s_mul_i32 s21, s20, 491520
  s_add_u32 s21, s21, 2260992
  s_add_u32 s21, s21, s44
  s_mul_i32 s22, s20, 15360
  s_add_u32 s22, s22, 70656
  s_add_u32 m0, s22, 0
  s_nop 0
  buffer_load_dwordx4 v4, s[12:15], s21 offen lds
  s_add_u32 m0, s22, 1024
  s_nop 0
  buffer_load_dwordx4 v5, s[12:15], s21 offen lds
  s_add_u32 m0, s22, 2048
  s_nop 0
  buffer_load_dwordx4 v6, s[12:15], s21 offen lds
  s_mul_i32 s21, s20, 491520
  s_add_u32 s21, s21, 2359296
  s_add_u32 s21, s21, s44
  s_mul_i32 s22, s20, 15360
  s_add_u32 s22, s22, 73728
  s_add_u32 m0, s22, 0
  s_nop 0
  buffer_load_dwordx4 v4, s[12:15], s21 offen lds
  s_add_u32 m0, s22, 1024
  s_nop 0
  buffer_load_dwordx4 v5, s[12:15], s21 offen lds
  s_add_u32 m0, s22, 2048
  s_nop 0
  buffer_load_dwordx4 v6, s[12:15], s21 offen lds
  s_mul_i32 s21, s20, 491520
  s_add_u32 s21, s21, 3932160
  s_add_u32 s21, s21, s44
  buffer_load_dwordx4 v[64:67], v4, s[12:15], s21 offen
  buffer_load_dwordx4 v[68:71], v5, s[12:15], s21 offen
  buffer_load_dwordx4 v[72:75], v6, s[12:15], s21 offen
  s_mul_i32 s21, s20, 491520
  s_add_u32 s21, s21, 4030464
  s_add_u32 s21, s21, s44
  buffer_load_dwordx4 v[76:79], v4, s[12:15], s21 offen
  buffer_load_dwordx4 v[80:83], v5, s[12:15], s21 offen
  buffer_load_dwordx4 v[84:87], v6, s[12:15], s21 offen
  s_mul_i32 s21, s20, 491520
  s_add_u32 s21, s21, 4128768
  s_add_u32 s21, s21, s44
  buffer_load_dwordx4 v[88:91], v4, s[12:15], s21 offen
  buffer_load_dwordx4 v[92:95], v5, s[12:15], s21 offen
  buffer_load_dwordx4 v[96:99], v6, s[12:15], s21 offen
  s_mul_i32 s21, s20, 491520
  s_add_u32 s21, s21, 4227072
  s_add_u32 s21, s21, s44
  buffer_load_dwordx4 v[100:103], v4, s[12:15], s21 offen
  buffer_load_dwordx4 v[104:107], v5, s[12:15], s21 offen
  buffer_load_dwordx4 v[108:111], v6, s[12:15], s21 offen
  s_mul_i32 s21, s20, 491520
  s_add_u32 s21, s21, 4325376
  s_add_u32 s21, s21, s44
  buffer_load_dwordx4 v[112:115], v4, s[12:15], s21 offen
  buffer_load_dwordx4 v[116:119], v5, s[12:15], s21 offen
  buffer_load_dwordx4 v[120:123], v6, s[12:15], s21 offen
  s_mul_i32 s21, s20, 491520
  s_add_u32 s21, s21, 5898240
  s_add_u32 s21, s21, s44
  buffer_load_dwordx4 v[124:127], v4, s[12:15], s21 offen
  buffer_load_dwordx4 v[128:131], v5, s[12:15], s21 offen
  buffer_load_dwordx4 v[132:135], v6, s[12:15], s21 offen
  s_mul_i32 s21, s20, 491520
  s_add_u32 s21, s21, 5996544
  s_add_u32 s21, s21, s44
  buffer_load_dwordx4 v[136:139], v4, s[12:15], s21 offen
  buffer_load_dwordx4 v[140:143], v5, s[12:15], s21 offen
  buffer_load_dwordx4 v[144:147], v6, s[12:15], s21 offen
  s_mul_i32 s21, s20, 491520
  s_add_u32 s21, s21, 6094848
  s_add_u32 s21, s21, s44
  buffer_load_dwordx4 v[148:151], v4, s[12:15], s21 offen
  buffer_load_dwordx4 v[152:155], v5, s[12:15], s21 offen
  buffer_load_dwordx4 v[156:159], v6, s[12:15], s21 offen
  s_mul_i32 s21, s20, 491520
  s_add_u32 s21, s21, 6193152
  s_add_u32 s21, s21, s44
  buffer_load_dwordx4 v[160:163], v4, s[12:15], s21 offen
  buffer_load_dwordx4 v[164:167], v5, s[12:15], s21 offen
  buffer_load_dwordx4 v[168:171], v6, s[12:15], s21 offen
  s_mul_i32 s21, s20, 491520
  s_add_u32 s21, s21, 6291456
  s_add_u32 s21, s21, s44
  buffer_load_dwordx4 v[172:175], v4, s[12:15], s21 offen
  buffer_load_dwordx4 v[176:179], v5, s[12:15], s21 offen
  buffer_load_dwordx4 v[180:183], v6, s[12:15], s21 offen
  s_mul_i32 s22, s20, 15360
  v_lshl_add_u32 v30, v1, 4, s22
  v_add_u32 v31, 61440, v30
  s_waitcnt vmcnt(45)
  s_barrier
  ds_read_b64_tr_b16 a[0:1], v7 offset:0
  ds_read_b64_tr_b16 a[2:3], v7 offset:1536
  ds_read_b64_tr_b16 a[4:5], v7 offset:32
  ds_read_b64_tr_b16 a[6:7], v7 offset:1568
  ds_read_b64_tr_b16 a[8:9], v7 offset:64
  ds_read_b64_tr_b16 a[10:11], v7 offset:1600
  ds_read_b64_tr_b16 a[12:13], v7 offset:12288
  ds_read_b64_tr_b16 a[14:15], v7 offset:13824
  ds_read_b64_tr_b16 a[16:17], v7 offset:12320
  ds_read_b64_tr_b16 a[18:19], v7 offset:13856
  ds_read_b64_tr_b16 a[20:21], v7 offset:12352
  ds_read_b64_tr_b16 a[22:23], v7 offset:13888
  ds_read_b64_tr_b16 a[24:25], v7 offset:24576
  ds_read_b64_tr_b16 a[26:27], v7 offset:26112
  ds_read_b64_tr_b16 a[28:29], v7 offset:24608
  ds_read_b64_tr_b16 a[30:31], v7 offset:26144
  ds_read_b64_tr_b16 a[32:33], v7 offset:24640
  ds_read_b64_tr_b16 a[34:35], v7 offset:26176
  ds_read_b64_tr_b16 a[36:37], v7 offset:36864
  ds_read_b64_tr_b16 a[38:39], v7 offset:38400
  ds_read_b64_tr_b16 a[40:41], v7 offset:36896
  ds_read_b64_tr_b16 a[42:43], v7 offset:38432
  ds_read_b64_tr_b16 a[44:45], v7 offset:36928
  ds_read_b64_tr_b16 a[46:47], v7 offset:38464
  ds_read_b64_tr_b16 a[48:49], v7 offset:49152
  ds_read_b64_tr_b16 a[50:51], v7 offset:50688
  ds_read_b64_tr_b16 a[52:53], v7 offset:49184
  ds_read_b64_tr_b16 a[54:55], v7 offset:50720
  ds_read_b64_tr_b16 a[56:57], v7 offset:49216
  ds_read_b64_tr_b16 a[58:59], v7 offset:50752
  s_waitcnt lgkmcnt(0)
  s_barrier
  s_waitcnt vmcnt(30)
  s_barrier
  ds_read_b64_tr_b16 a[60:61], v8 offset:0
  ds_read_b64_tr_b16 a[62:63], v8 offset:1536
  ds_read_b64_tr_b16 a[64:65], v8 offset:32
  ds_read_b64_tr_b16 a[66:67], v8 offset:1568
  ds_read_b64_tr_b16 a[68:69], v8 offset:64
  ds_read_b64_tr_b16 a[70:71], v8 offset:1600
  ds_read_b64_tr_b16 a[72:73], v8 offset:12288
  ds_read_b64_tr_b16 a[74:75], v8 offset:13824
  ds_read_b64_tr_b16 a[76:77], v8 offset:12320
  ds_read_b64_tr_b16 a[78:79], v8 offset:13856
  ds_read_b64_tr_b16 a[80:81], v8 offset:12352
  ds_read_b64_tr_b16 a[82:83], v8 offset:13888
  ds_read_b64_tr_b16 a[84:85], v8 offset:24576
  ds_read_b64_tr_b16 a[86:87], v8 offset:26112
  ds_read_b64_tr_b16 a[88:89], v8 offset:24608
  ds_read_b64_tr_b16 a[90:91], v8 offset:26144
  ds_read_b64_tr_b16 a[92:93], v8 offset:24640
  ds_read_b64_tr_b16 a[94:95], v8 offset:26176
  ds_read_b64_tr_b16 a[96:97], v8 offset:36864
  ds_read_b64_tr_b16 a[98:99], v8 offset:38400
  ds_read_b64_tr_b16 a[100:101], v8 offset:36896
  ds_read_b64_tr_b16 a[102:103], v8 offset:38432
  ds_read_b64_tr_b16 a[104:105], v8 offset:36928
  ds_read_b64_tr_b16 a[106:107], v8 offset:38464
  ds_read_b64_tr_b16 a[108:109], v8 offset:49152
  ds_read_b64_tr_b16 a[110:111], v8 offset:50688
  ds_read_b64_tr_b16 a[112:113], v8 offset:49184
  ds_read_b64_tr_b16 a[114:115], v8 offset:50720
  ds_read_b64_tr_b16 a[116:117], v8 offset:49216
  ds_read_b64_tr_b16 a[118:119], v8 offset:50752
  s_waitcnt lgkmcnt(0)
  s_barrier
  s_waitcnt vmcnt(15)
  ds_write_b128 v30, v[64:67] offset:0
  ds_write_b128 v30, v[68:71] offset:1024
  ds_write_b128 v30, v[72:75] offset:2048
  ds_write_b128 v30, v[76:79] offset:3072
  ds_write_b128 v30, v[80:83] offset:4096
  ds_write_b128 v30, v[84:87] offset:5120
  ds_write_b128 v30, v[88:91] offset:6144
  ds_write_b128 v30, v[92:95] offset:7168
  ds_write_b128 v30, v[96:99] offset:8192
  ds_write_b128 v30, v[100:103] offset:9216
  ds_write_b128 v30, v[104:107] offset:10240
  ds_write_b128 v30, v[108:111] offset:11264
  ds_write_b128 v30, v[112:115] offset:12288
  ds_write_b128 v30, v[116:119] offset:13312
  ds_write_b128 v30, v[120:123] offset:14336
  s_waitcnt lgkmcnt(0)
  s_barrier
  ds_read_b64_tr_b16 a[120:121], v7 offset:0
  ds_read_b64_tr_b16 a[122:123], v7 offset:1536
  ds_read_b64_tr_b16 a[124:125], v7 offset:32
  ds_read_b64_tr_b16 a[126:127], v7 offset:1568
  ds_read_b64_tr_b16 a[128:129], v7 offset:64
  ds_read_b64_tr_b16 a[130:131], v7 offset:1600
  ds_read_b64_tr_b16 a[132:133], v7 offset:12288
  ds_read_b64_tr_b16 a[134:135], v7 offset:13824
  ds_read_b64_tr_b16 a[136:137], v7 offset:12320
  ds_read_b64_tr_b16 a[138:139], v7 offset:13856
  ds_read_b64_tr_b16 a[140:141], v7 offset:12352
  ds_read_b64_tr_b16 a[142:143], v7 offset:13888
  ds_read_b64_tr_b16 a[144:145], v7 offset:24576
  ds_read_b64_tr_b16 a[146:147], v7 offset:26112
  ds_read_b64_tr_b16 a[148:149], v7 offset:24608
  ds_read_b64_tr_b16 a[150:151], v7 offset:26144
  ds_read_b64_tr_b16 a[152:153], v7 offset:24640
  ds_read_b64_tr_b16 a[154:155], v7 offset:26176
  ds_read_b64_tr_b16 a[156:157], v7 offset:36864
  ds_read_b64_tr_b16 a[158:159], v7 offset:38400
  ds_read_b64_tr_b16 a[160:161], v7 offset:36896
  ds_read_b64_tr_b16 a[162:163], v7 offset:38432
  ds_read_b64_tr_b16 a[164:165], v7 offset:36928
  ds_read_b64_tr_b16 a[166:167], v7 offset:38464
  ds_read_b64_tr_b16 a[168:169], v7 offset:49152
  ds_read_b64_tr_b16 a[170:171], v7 offset:50688
  ds_read_b64_tr_b16 a[172:173], v7 offset:49184
  ds_read_b64_tr_b16 a[174:175], v7 offset:50720
  ds_read_b64_tr_b16 a[176:177], v7 offset:49216
  ds_read_b64_tr_b16 a[178:179], v7 offset:50752
  s_waitcnt lgkmcnt(0)
  s_barrier
  s_waitcnt vmcnt(0)
  ds_write_b128 v31, v[124:127] offset:0
  ds_write_b128 v31, v[128:131] offset:1024
  ds_write_b128 v31, v[132:135] offset:2048
  ds_write_b128 v31, v[136:139] offset:3072
  ds_write_b128 v31, v[140:143] offset:4096
  ds_write_b128 v31, v[144:147] offset:5120
  ds_write_b128 v31, v[148:151] offset:6144
  ds_write_b128 v31, v[152:155] offset:7168
  ds_write_b128 v31, v[156:159] offset:8192
  ds_write_b128 v31, v[160:163] offset:9216
  ds_write_b128 v31, v[164:167] offset:10240
  ds_write_b128 v31, v[168:171] offset:11264
  ds_write_b128 v31, v[172:175] offset:12288
  ds_write_b128 v31, v[176:179] offset:13312
  ds_write_b128 v31, v[180:183] offset:14336
  s_waitcnt lgkmcnt(0)
  s_barrier
  ds_read_b64_tr_b16 a[180:181], v8 offset:0
  ds_read_b64_tr_b16 a[182:183], v8 offset:1536
  ds_read_b64_tr_b16 a[184:185], v8 offset:32
  ds_read_b64_tr_b16 a[186:187], v8 offset:1568
  ds_read_b64_tr_b16 a[188:189], v8 offset:64
  ds_read_b64_tr_b16 a[190:191], v8 offset:1600
  ds_read_b64_tr_b16 a[192:193], v8 offset:12288
  ds_read_b64_tr_b16 a[194:195], v8 offset:13824
  ds_read_b64_tr_b16 a[196:197], v8 offset:12320
  ds_read_b64_tr_b16 a[198:199], v8 offset:13856
  ds_read_b64_tr_b16 a[200:201], v8 offset:12352
  ds_read_b64_tr_b16 a[202:203], v8 offset:13888
  ds_read_b64_tr_b16 a[204:205], v8 offset:24576
  ds_read_b64_tr_b16 a[206:207], v8 offset:26112
  ds_read_b64_tr_b16 a[208:209], v8 offset:24608
  ds_read_b64_tr_b16 a[210:211], v8 offset:26144
  ds_read_b64_tr_b16 a[212:213], v8 offset:24640
  ds_read_b64_tr_b16 a[214:215], v8 offset:26176
  ds_read_b64_tr_b16 a[216:217], v8 offset:36864
  ds_read_b64_tr_b16 a[218:219], v8 offset:38400
  ds_read_b64_tr_b16 a[220:221], v8 offset:36896
  ds_read_b64_tr_b16 a[222:223], v8 offset:38432
  ds_read_b64_tr_b16 a[224:225], v8 offset:36928
  ds_read_b64_tr_b16 a[226:227], v8 offset:38464
  ds_read_b64_tr_b16 a[228:229], v8 offset:49152
  ds_read_b64_tr_b16 a[230:231], v8 offset:50688
  ds_read_b64_tr_b16 a[232:233], v8 offset:49184
  ds_read_b64_tr_b16 a[234:235], v8 offset:50720
  ds_read_b64_tr_b16 a[236:237], v8 offset:49216
  ds_read_b64_tr_b16 a[238:239], v8 offset:50752
  s_waitcnt lgkmcnt(0)
  s_barrier
  s_mul_i32 s21, s20, 12800
  s_add_u32 s21, s21, 98304
  v_mul_u32_u24 v4, 400, v2
  v_lshlrev_b32 v5, 4, v3
  v_add3_u32 v29, v4, v5, s21
  v_lshlrev_b32 v30, 4, v1
  v_and_b32 v4, 7, v2
  v_lshlrev_b32 v4, 4, v4
  v_lshl_add_u32 v31, v3, 7, v4
  v_lshlrev_b32 v32, 3, v1
  v_and_b32 v4, 3, v1
  v_lshlrev_b32 v33, 3, v4
  v_mov_b32 v34, 0xf149f2ca
  v_lshlrev_b32 v4, 2, v3
  v_sub_u32 v35, v2, v4
  v_cmp_gt_u32 s[60:61], 2, v3
  s_mov_b32 s62, 0x3d93cd3a
  s_mov_b32 s63, 0x3fb8aa3b
  s_mov_b32 s83, 0x3dd53b95
  v_cmp_le_i32 s[64:65], 0, v35
  v_cmp_le_i32 s[66:67], 1, v35
  v_cmp_le_i32 s[68:69], 2, v35
  v_cmp_le_i32 s[70:71], 3, v35
  s_mov_b32 s24, 0
  s_mov_b32 s25, 163840
  s_mov_b32 s26, 13
  s_lshl_b32 s49, s41, 2
  s_add_u32 s49, s49, s20
  s_mov_b32 s29, 4
  s_mov_b32 s78, 0
  s_mov_b32 s81, 0x80000000
  s_mov_b32 s82, 0
  v_lshrrev_b32 v11, 3, v1
  v_and_b32 v12, 7, v1
  v_xor_b32 v12, v12, v11
  v_mul_u32_u24 v11, 1280, v11
  v_lshl_add_u32 v10, v12, 4, v11
  s_mul_i32 s46, s20, 40960
  v_add_u32 v10, s46, v10
  s_lshl_b32 s47, s20, 12
  s_add_u32 s47, s47, 0
  s_add_u32 s46, s47, 98304
  s_mov_b32 s30, s24
  s_add_u32 s32, s47, 0
  v_add_u32 v11, 9216, v10
  v_add_u32 v12, 18432, v10
  v_add_u32 v13, 27648, v10
  s_mov_b32 m0, s32
  s_nop 0
  buffer_load_dwordx4 v10, s[8:11], s30 offen offset:0 lds
  buffer_load_dwordx4 v11, s[8:11], s30 offen offset:1024 lds
  buffer_load_dwordx4 v12, s[8:11], s30 offen offset:2048 lds
  buffer_load_dwordx4 v13, s[8:11], s30 offen offset:3072 lds
  s_add_u32 s30, s30, 128
  s_add_u32 s32, s32, 16384
  s_cmp_lt_u32 s32, s46
  s_cselect_b32 s32, s32, s47
  s_mov_b32 m0, s32
  s_nop 0
  buffer_load_dwordx4 v10, s[8:11], s30 offen offset:0 lds
  buffer_load_dwordx4 v11, s[8:11], s30 offen offset:1024 lds
  buffer_load_dwordx4 v12, s[8:11], s30 offen offset:2048 lds
  buffer_load_dwordx4 v13, s[8:11], s30 offen offset:3072 lds
  s_add_u32 s30, s30, 128
  s_add_u32 s32, s32, 16384
  s_cmp_lt_u32 s32, s46
  s_cselect_b32 s32, s32, s47
  s_mov_b32 m0, s32
  s_nop 0
  buffer_load_dwordx4 v10, s[8:11], s30 offen offset:0 lds
  buffer_load_dwordx4 v11, s[8:11], s30 offen offset:1024 lds
  buffer_load_dwordx4 v12, s[8:11], s30 offen offset:2048 lds
  buffer_load_dwordx4 v13, s[8:11], s30 offen offset:3072 lds
  s_add_u32 s30, s30, 128
  s_add_u32 s32, s32, 16384
  s_cmp_lt_u32 s32, s46
  s_cselect_b32 s32, s32, s47
  s_mov_b32 m0, s32
  s_nop 0
  buffer_load_dwordx4 v10, s[8:11], s30 offen offset:0 lds
  buffer_load_dwordx4 v11, s[8:11], s30 offen offset:1024 lds
  buffer_load_dwordx4 v12, s[8:11], s30 offen offset:2048 lds
  buffer_load_dwordx4 v13, s[8:11], s30 offen offset:3072 lds
  s_add_u32 s30, s30, 128
  s_add_u32 s32, s32, 16384
  s_cmp_lt_u32 s32, s46
  s_cselect_b32 s32, s32, s47
  v_and_b32 v6, 7, v2
  v_add_u32 v4, 0, v3
  v_xor_b32 v4, v4, v6
  v_lshlrev_b32 v4, 4, v4
  v_lshl_add_u32 v14, v2, 7, v4
  v_add_u32 v4, 4, v3
  v_xor_b32 v4, v4, v6
  v_lshlrev_b32 v4, 4, v4
  v_lshl_add_u32 v15, v2, 7, v4
  v_mul_u32_u24 v22, 400, v2
  v_mul_u32_u24 v4, 24, v3
  s_mul_i32 s21, s20, 96
  s_add_u32 s21, s21, 98304
  v_add3_u32 v22, v22, v4, s21
  v_mov_b32 v9, 2731
  s_mov_b32 s33, 0
  s_mov_b32 s48, 0x80000000
  s_mov_b32 m0, s32
  s_nop 0
  buffer_load_dwordx4 v10, s[8:11], s30 offen offset:0 lds
  buffer_load_dwordx4 v11, s[8:11], s30 offen offset:1024 lds
  s_waitcnt vmcnt(14)
  s_barrier
  v_add_u32 v18, s33, v14
  v_add_u32 v19, s33, v15
  s_add_u32 s33, s33, 16384
  s_cmp_lt_u32 s33, 98304
  s_cselect_b32 s33, s33, 0
  ds_read_b128 v[160:163], v18 offset:0
  ds_read_b128 v[164:167], v18 offset:2048
  ds_read_b128 v[168:171], v18 offset:4096
  ds_read_b128 v[172:175], v18 offset:6144
  ds_read_b128 v[176:179], v18 offset:8192
  ds_read_b128 v[180:183], v18 offset:10240
  ds_read_b128 v[184:187], v18 offset:12288
  ds_read_b128 v[188:191], v18 offset:14336
  s_waitcnt lgkmcnt(0)
qa_blk_215:
  v_mfma_f32_16x16x32_bf16 v[64:67], a[0:3], v[160:163], 0
  ds_read_b128 v[192:195], v19 offset:0
  v_mfma_f32_16x16x32_bf16 v[68:71], a[4:7], v[160:163], 0
  v_add_u32 v18, s33, v14
  v_cndmask_b32 v36, v34, v36, s[64:65]
  v_mfma_f32_16x16x32_bf16 v[72:75], a[8:11], v[160:163], 0
  v_cndmask_b32 v48, v34, v48, s[64:65]
  v_cndmask_b32 v37, v34, v37, s[66:67]
  v_mfma_f32_16x16x32_bf16 v[76:79], a[0:3], v[164:167], 0
  ds_read_b128 v[196:199], v19 offset:2048
  v_cndmask_b32 v49, v34, v49, s[66:67]
  v_mfma_f32_16x16x32_bf16 v[80:83], a[4:7], v[164:167], 0
  buffer_load_dwordx4 v12, s[8:11], s30 offen offset:2048 lds
  v_mfma_f32_16x16x32_bf16 v[84:87], a[8:11], v[164:167], 0
  v_cndmask_b32 v38, v34, v38, s[68:69]
  v_cndmask_b32 v50, v34, v50, s[68:69]
  v_mfma_f32_16x16x32_bf16 v[88:91], a[0:3], v[168:171], 0
  ds_read_b128 v[200:203], v19 offset:4096
  v_cndmask_b32 v39, v34, v39, s[70:71]
  v_mfma_f32_16x16x32_bf16 v[92:95], a[4:7], v[168:171], 0
  v_cndmask_b32 v51, v34, v51, s[70:71]
  v_max3_f32 v56, v36, v37, v38
  v_mfma_f32_16x16x32_bf16 v[96:99], a[8:11], v[168:171], 0
  v_max3_f32 v56, v56, v39, v40
  v_max3_f32 v56, v56, v41, v42
  v_mfma_f32_16x16x32_bf16 v[100:103], a[0:3], v[172:175], 0
  ds_read_b128 v[204:207], v19 offset:6144
  v_max_f32 v56, v56, v43
  v_mfma_f32_16x16x32_bf16 v[104:107], a[4:7], v[172:175], 0
  v_mov_b32 v57, v56
  v_mfma_f32_16x16x32_bf16 v[108:111], a[8:11], v[172:175], 0
  s_waitcnt lgkmcnt(11)
  v_mfma_f32_16x16x32_bf16 v[112:115], a[0:3], v[176:179], 0
  ds_read_b128 v[208:211], v19 offset:8192
  v_mfma_f32_16x16x32_bf16 v[116:119], a[4:7], v[176:179], 0
  s_nop 1
  v_mfma_f32_16x16x32_bf16 v[120:123], a[8:11], v[176:179], 0
  v_permlane32_swap_b32 v56, v57
  v_mfma_f32_16x16x32_bf16 v[124:127], a[0:3], v[180:183], 0
  ds_read_b128 v[212:215], v19 offset:10240
  v_max_f32 v56, v56, v57
  v_mfma_f32_16x16x32_bf16 v[128:131], a[4:7], v[180:183], 0
  buffer_load_dwordx4 v13, s[8:11], s30 offen offset:3072 lds
  v_mfma_f32_16x16x32_bf16 v[132:135], a[8:11], v[180:183], 0
  s_add_u32 s30, s30, 128
  s_add_u32 m0, m0, 16384
  v_mfma_f32_16x16x32_bf16 v[136:139], a[0:3], v[184:187], 0
  ds_read_b128 v[216:219], v19 offset:12288
  v_mov_b32 v57, v56
  v_mfma_f32_16x16x32_bf16 v[140:143], a[4:7], v[184:187], 0
  s_cmp_lt_u32 m0, s46
  s_cselect_b32 m0, m0, s47
  v_mfma_f32_16x16x32_bf16 v[144:147], a[8:11], v[184:187], 0
  s_nop 1
  v_mfma_f32_16x16x32_bf16 v[148:151], a[0:3], v[188:191], 0
  ds_read_b128 v[220:223], v19 offset:14336
  v_mfma_f32_16x16x32_bf16 v[152:155], a[4:7], v[188:191], 0
  v_permlane16_swap_b32 v56, v57
  v_mfma_f32_16x16x32_bf16 v[156:159], a[8:11], v[188:191], 0
  s_waitcnt vmcnt(12) lgkmcnt(4)
  s_barrier
  v_mfma_f32_16x16x32_bf16 v[64:67], a[12:15], v[192:195], v[64:67]
  ds_read_b128 v[160:163], v18 offset:0
  v_max_f32 v56, v56, v57
  v_mfma_f32_16x16x32_bf16 v[68:71], a[16:19], v[192:195], v[68:71]
  v_mul_f32 v56, s83, v56
  v_fma_f32 v36, v36, s83, -v56
  v_mfma_f32_16x16x32_bf16 v[72:75], a[20:23], v[192:195], v[72:75]
  v_add_u32 v19, s33, v15
  s_add_u32 s33, s33, 16384
  v_mfma_f32_16x16x32_bf16 v[76:79], a[12:15], v[196:199], v[76:79]
  ds_read_b128 v[164:167], v18 offset:2048
  v_fma_f32 v37, v37, s83, -v56
  v_mfma_f32_16x16x32_bf16 v[80:83], a[16:19], v[196:199], v[80:83]
  buffer_load_dwordx4 v10, s[8:11], s30 offen offset:0 lds
  v_mfma_f32_16x16x32_bf16 v[84:87], a[20:23], v[196:199], v[84:87]
  s_cmp_lt_u32 s33, 98304
  s_cselect_b32 s33, s33, 0
  v_mfma_f32_16x16x32_bf16 v[88:91], a[12:15], v[200:203], v[88:91]
  ds_read_b128 v[168:171], v18 offset:4096
  v_fma_f32 v38, v38, s83, -v56
  v_mfma_f32_16x16x32_bf16 v[92:95], a[16:19], v[200:203], v[92:95]
  v_fma_f32 v39, v39, s83, -v56
  v_fma_f32 v40, v40, s83, -v56
  v_mfma_f32_16x16x32_bf16 v[96:99], a[20:23], v[200:203], v[96:99]
  v_fma_f32 v41, v41, s83, -v56
  v_fma_f32 v42, v42, s83, -v56
  v_mfma_f32_16x16x32_bf16 v[100:103], a[12:15], v[204:207], v[100:103]
  ds_read_b128 v[172:175], v18 offset:6144
  v_fma_f32 v43, v43, s83, -v56
  v_mfma_f32_16x16x32_bf16 v[104:107], a[16:19], v[204:207], v[104:107]
  v_exp_f32 v36, v36
  v_mfma_f32_16x16x32_bf16 v[108:111], a[20:23], v[204:207], v[108:111]
  s_waitcnt lgkmcnt(4)
  v_mfma_f32_16x16x32_bf16 v[112:115], a[12:15], v[208:211], v[112:115]
  ds_read_b128 v[176:179], v18 offset:8192
  v_mfma_f32_16x16x32_bf16 v[116:119], a[16:19], v[208:211], v[116:119]
  v_exp_f32 v37, v37
  v_mfma_f32_16x16x32_bf16 v[120:123], a[20:23], v[208:211], v[120:123]
  v_exp_f32 v38, v38
  v_mfma_f32_16x16x32_bf16 v[124:127], a[12:15], v[212:215], v[124:127]
  ds_read_b128 v[180:183], v18 offset:10240
  v_mfma_f32_16x16x32_bf16 v[128:131], a[16:19], v[212:215], v[128:131]
  buffer_load_dwordx4 v11, s[8:11], s30 offen offset:1024 lds
  v_mfma_f32_16x16x32_bf16 v[132:135], a[20:23], v[212:215], v[132:135]
  v_exp_f32 v39, v39
  v_mfma_f32_16x16x32_bf16 v[136:139], a[12:15], v[216:219], v[136:139]
  ds_read_b128 v[184:187], v18 offset:12288
  v_mfma_f32_16x16x32_bf16 v[140:143], a[16:19], v[216:219], v[140:143]
  v_exp_f32 v40, v40
  v_mfma_f32_16x16x32_bf16 v[144:147], a[20:23], v[216:219], v[144:147]
  v_exp_f32 v41, v41
  v_mfma_f32_16x16x32_bf16 v[148:151], a[12:15], v[220:223], v[148:151]
  ds_read_b128 v[188:191], v18 offset:14336
  v_mfma_f32_16x16x32_bf16 v[152:155], a[16:19], v[220:223], v[152:155]
  v_exp_f32 v42, v42
  v_mfma_f32_16x16x32_bf16 v[156:159], a[20:23], v[220:223], v[156:159]
  s_waitcnt lgkmcnt(4)
  v_mfma_f32_16x16x32_bf16 v[64:67], a[24:27], v[160:163], v[64:67]
  ds_read_b128 v[192:195], v19 offset:0
  v_mfma_f32_16x16x32_bf16 v[68:71], a[28:31], v[160:163], v[68:71]
  v_add_u32 v18, s33, v14
  v_mfma_f32_16x16x32_bf16 v[72:75], a[32:35], v[160:163], v[72:75]
  v_exp_f32 v43, v43
  v_mfma_f32_16x16x32_bf16 v[76:79], a[24:27], v[164:167], v[76:79]
  ds_read_b128 v[196:199], v19 offset:2048
  s_nop 0
  v_mfma_f32_16x16x32_bf16 v[80:83], a[28:31], v[164:167], v[80:83]
  buffer_load_dwordx4 v12, s[8:11], s30 offen offset:2048 lds
  v_mfma_f32_16x16x32_bf16 v[84:87], a[32:35], v[164:167], v[84:87]
  v_add_f32 v56, v40, v41
  v_add_f32 v56, v56, v42
  v_mfma_f32_16x16x32_bf16 v[88:91], a[24:27], v[168:171], v[88:91]
  ds_read_b128 v[200:203], v19 offset:4096
  v_add_f32 v56, v56, v43
  v_mfma_f32_16x16x32_bf16 v[92:95], a[28:31], v[168:171], v[92:95]
  v_cndmask_b32 v56, 0, v56, s[60:61]
  v_add_f32 v56, v56, v36
  v_mfma_f32_16x16x32_bf16 v[96:99], a[32:35], v[168:171], v[96:99]
  v_add_f32 v56, v56, v37
  v_add_f32 v56, v56, v38
  v_mfma_f32_16x16x32_bf16 v[100:103], a[24:27], v[172:175], v[100:103]
  ds_read_b128 v[204:207], v19 offset:6144
  v_add_f32 v56, v56, v39
  v_mfma_f32_16x16x32_bf16 v[104:107], a[28:31], v[172:175], v[104:107]
  v_mov_b32 v57, v56
  v_mfma_f32_16x16x32_bf16 v[108:111], a[32:35], v[172:175], v[108:111]
  s_waitcnt lgkmcnt(4)
  v_mfma_f32_16x16x32_bf16 v[112:115], a[24:27], v[176:179], v[112:115]
  ds_read_b128 v[208:211], v19 offset:8192
  v_mfma_f32_16x16x32_bf16 v[116:119], a[28:31], v[176:179], v[116:119]
  s_nop 1
  v_mfma_f32_16x16x32_bf16 v[120:123], a[32:35], v[176:179], v[120:123]
  v_permlane32_swap_b32 v56, v57
  v_mfma_f32_16x16x32_bf16 v[124:127], a[24:27], v[180:183], v[124:127]
  ds_read_b128 v[212:215], v19 offset:10240
  v_add_f32 v56, v56, v57
  v_mfma_f32_16x16x32_bf16 v[128:131], a[28:31], v[180:183], v[128:131]
  buffer_load_dwordx4 v13, s[8:11], s30 offen offset:3072 lds
  v_mfma_f32_16x16x32_bf16 v[132:135], a[32:35], v[180:183], v[132:135]
  s_add_u32 s30, s30, 128
  s_add_u32 m0, m0, 16384
  v_mfma_f32_16x16x32_bf16 v[136:139], a[24:27], v[184:187], v[136:139]
  ds_read_b128 v[216:219], v19 offset:12288
  v_mov_b32 v57, v56
  v_mfma_f32_16x16x32_bf16 v[140:143], a[28:31], v[184:187], v[140:143]
  s_cmp_lt_u32 m0, s46
  s_cselect_b32 m0, m0, s47
  v_mfma_f32_16x16x32_bf16 v[144:147], a[32:35], v[184:187], v[144:147]
  s_nop 1
  v_mfma_f32_16x16x32_bf16 v[148:151], a[24:27], v[188:191], v[148:151]
  ds_read_b128 v[220:223], v19 offset:14336
  v_mfma_f32_16x16x32_bf16 v[152:155], a[28:31], v[188:191], v[152:155]
  v_permlane16_swap_b32 v56, v57
  v_mfma_f32_16x16x32_bf16 v[156:159], a[32:35], v[188:191], v[156:159]
  s_waitcnt vmcnt(12) lgkmcnt(4)
  s_barrier
  v_mfma_f32_16x16x32_bf16 v[64:67], a[36:39], v[192:195], v[64:67]
  ds_read_b128 v[160:163], v18 offset:0
  v_add_f32 v56, v56, v57
  v_mfma_f32_16x16x32_bf16 v[68:71], a[40:43], v[192:195], v[68:71]
  v_rcp_f32 v56, v56
  v_mfma_f32_16x16x32_bf16 v[72:75], a[44:47], v[192:195], v[72:75]
  v_add_u32 v19, s33, v15
  s_add_u32 s33, s33, 16384
  v_mfma_f32_16x16x32_bf16 v[76:79], a[36:39], v[196:199], v[76:79]
  ds_read_b128 v[164:167], v18 offset:2048
  s_nop 0
  v_mfma_f32_16x16x32_bf16 v[80:83], a[40:43], v[196:199], v[80:83]
  buffer_load_dwordx4 v10, s[8:11], s30 offen offset:0 lds
  v_mfma_f32_16x16x32_bf16 v[84:87], a[44:47], v[196:199], v[84:87]
  s_cmp_lt_u32 s33, 98304
  s_cselect_b32 s33, s33, 0
  v_mfma_f32_16x16x32_bf16 v[88:91], a[36:39], v[200:203], v[88:91]
  ds_read_b128 v[168:171], v18 offset:4096
  v_mul_f32 v36, v36, v56
  v_mfma_f32_16x16x32_bf16 v[92:95], a[40:43], v[200:203], v[92:95]
  v_mul_f32 v37, v37, v56
  v_mul_f32 v38, v38, v56
  v_mfma_f32_16x16x32_bf16 v[96:99], a[44:47], v[200:203], v[96:99]
  v_mul_f32 v39, v39, v56
  v_mul_f32 v40, v40, v56
  v_mfma_f32_16x16x32_bf16 v[100:103], a[36:39], v[204:207], v[100:103]
  ds_read_b128 v[172:175], v18 offset:6144
  v_mul_f32 v41, v41, v56
  v_mfma_f32_16x16x32_bf16 v[104:107], a[40:43], v[204:207], v[104:107]
  v_mul_f32 v42, v42, v56
  v_mul_f32 v43, v43, v56
  v_mfma_f32_16x16x32_bf16 v[108:111], a[44:47], v[204:207], v[108:111]
  s_waitcnt lgkmcnt(4)
  v_max3_f32 v56, v44, v45, v46
  v_mfma_f32_16x16x32_bf16 v[112:115], a[36:39], v[208:211], v[112:115]
  ds_read_b128 v[176:179], v18 offset:8192
  v_max3_f32 v56, v56, v47, v48
  v_mfma_f32_16x16x32_bf16 v[116:119], a[40:43], v[208:211], v[116:119]
  v_max3_f32 v56, v56, v49, v50
  v_max3_f32 v56, v56, v51, v52
  v_mfma_f32_16x16x32_bf16 v[120:123], a[44:47], v[208:211], v[120:123]
  v_max3_f32 v56, v56, v53, v54
  v_max_f32 v56, v56, v55
  v_mfma_f32_16x16x32_bf16 v[124:127], a[36:39], v[212:215], v[124:127]
  ds_read_b128 v[180:183], v18 offset:10240
  v_mov_b32 v57, v56
  v_mfma_f32_16x16x32_bf16 v[128:131], a[40:43], v[212:215], v[128:131]
  buffer_load_dwordx4 v11, s[8:11], s30 offen offset:1024 lds
  v_mfma_f32_16x16x32_bf16 v[132:135], a[44:47], v[212:215], v[132:135]
  s_nop 1
  v_mfma_f32_16x16x32_bf16 v[136:139], a[36:39], v[216:219], v[136:139]
  ds_read_b128 v[184:187], v18 offset:12288
  v_mfma_f32_16x16x32_bf16 v[140:143], a[40:43], v[216:219], v[140:143]
  v_permlane32_swap_b32 v56, v57
  v_mfma_f32_16x16x32_bf16 v[144:147], a[44:47], v[216:219], v[144:147]
  v_max_f32 v56, v56, v57
  v_mov_b32 v57, v56
  v_mfma_f32_16x16x32_bf16 v[148:151], a[36:39], v[220:223], v[148:151]
  ds_read_b128 v[188:191], v18 offset:14336
  v_mfma_f32_16x16x32_bf16 v[152:155], a[40:43], v[220:223], v[152:155]
  s_nop 1
  v_mfma_f32_16x16x32_bf16 v[156:159], a[44:47], v[220:223], v[156:159]
  s_waitcnt lgkmcnt(4)
  v_mfma_f32_16x16x32_bf16 v[64:67], a[48:51], v[160:163], v[64:67]
  ds_read_b128 v[192:195], v19 offset:0
  v_mfma_f32_16x16x32_bf16 v[68:71], a[52:55], v[160:163], v[68:71]
  v_add_u32 v18, s33, v14
  v_mfma_f32_16x16x32_bf16 v[72:75], a[56:59], v[160:163], v[72:75]
  v_permlane16_swap_b32 v56, v57
  v_mfma_f32_16x16x32_bf16 v[76:79], a[48:51], v[164:167], v[76:79]
  ds_read_b128 v[196:199], v19 offset:2048
  v_max_f32 v56, v56, v57
  v_mfma_f32_16x16x32_bf16 v[80:83], a[52:55], v[164:167], v[80:83]
  buffer_load_dwordx4 v12, s[8:11], s30 offen offset:2048 lds
  v_mfma_f32_16x16x32_bf16 v[84:87], a[56:59], v[164:167], v[84:87]
  v_mul_f32 v56, s83, v56
  v_fma_f32 v44, v44, s83, -v56
  v_mfma_f32_16x16x32_bf16 v[88:91], a[48:51], v[168:171], v[88:91]
  ds_read_b128 v[200:203], v19 offset:4096
  v_fma_f32 v45, v45, s83, -v56
  v_mfma_f32_16x16x32_bf16 v[92:95], a[52:55], v[168:171], v[92:95]
  v_fma_f32 v46, v46, s83, -v56
  v_fma_f32 v47, v47, s83, -v56
  v_mfma_f32_16x16x32_bf16 v[96:99], a[56:59], v[168:171], v[96:99]
  v_fma_f32 v48, v48, s83, -v56
  v_fma_f32 v49, v49, s83, -v56
  v_mfma_f32_16x16x32_bf16 v[100:103], a[48:51], v[172:175], v[100:103]
  ds_read_b128 v[204:207], v19 offset:6144
  v_fma_f32 v50, v50, s83, -v56
  v_mfma_f32_16x16x32_bf16 v[104:107], a[52:55], v[172:175], v[104:107]
  v_fma_f32 v51, v51, s83, -v56
  v_fma_f32 v52, v52, s83, -v56
  v_mfma_f32_16x16x32_bf16 v[108:111], a[56:59], v[172:175], v[108:111]
  s_waitcnt lgkmcnt(4)
  v_fma_f32 v53, v53, s83, -v56
  v_mfma_f32_16x16x32_bf16 v[112:115], a[48:51], v[176:179], v[112:115]
  ds_read_b128 v[208:211], v19 offset:8192
  v_fma_f32 v54, v54, s83, -v56
  v_mfma_f32_16x16x32_bf16 v[116:119], a[52:55], v[176:179], v[116:119]
  v_fma_f32 v55, v55, s83, -v56
  v_mfma_f32_16x16x32_bf16 v[120:123], a[56:59], v[176:179], v[120:123]
  v_exp_f32 v44, v44
  v_mfma_f32_16x16x32_bf16 v[124:127], a[48:51], v[180:183], v[124:127]
  ds_read_b128 v[212:215], v19 offset:10240
  v_mfma_f32_16x16x32_bf16 v[128:131], a[52:55], v[180:183], v[128:131]
  buffer_load_dwordx4 v13, s[8:11], s30 offen offset:3072 lds
  v_mfma_f32_16x16x32_bf16 v[132:135], a[56:59], v[180:183], v[132:135]
  s_add_u32 s30, s30, 128
  s_add_u32 m0, m0, 16384
  v_mfma_f32_16x16x32_bf16 v[136:139], a[48:51], v[184:187], v[136:139]
  ds_read_b128 v[216:219], v19 offset:12288
  v_mfma_f32_16x16x32_bf16 v[140:143], a[52:55], v[184:187], v[140:143]
  s_cmp_lt_u32 m0, s46
  s_cselect_b32 m0, m0, s47
  v_mfma_f32_16x16x32_bf16 v[144:147], a[56:59], v[184:187], v[144:147]
  v_exp_f32 v45, v45
  v_mfma_f32_16x16x32_bf16 v[148:151], a[48:51], v[188:191], v[148:151]
  ds_read_b128 v[220:223], v19 offset:14336
  v_mfma_f32_16x16x32_bf16 v[152:155], a[52:55], v[188:191], v[152:155]
  v_exp_f32 v46, v46
  v_mfma_f32_16x16x32_bf16 v[156:159], a[56:59], v[188:191], v[156:159]
  s_waitcnt vmcnt(12) lgkmcnt(4)
  s_barrier
  v_mfma_f32_16x16x32_bf16 v[64:67], a[60:63], v[192:195], v[64:67]
  ds_read_b128 v[160:163], v18 offset:0
  v_mfma_f32_16x16x32_bf16 v[68:71], a[64:67], v[192:195], v[68:71]
  s_waitcnt vmcnt(10)
  s_cmp_eq_u32 s78, 0
  s_cbranch_scc1 pf_213
  v_mov_b32 v4, 0
  v_mov_b32 v5, 1
  s_mov_b64 exec, 1
  buffer_atomic_add v5, v4, s[72:75], s78 offen sc1
  s_mov_b64 exec, -1
  s_mov_b32 s78, 0
pf_213:
  s_mul_i32 s21, s49, 393216
  s_mul_i32 s22, s42, 12288
  s_add_u32 s50, s21, s22
  s_mul_i32 s21, s49, 98304
  s_mul_i32 s22, s42, 3072
  s_add_u32 s51, s21, s22
  s_lshr_b32 s22, s49, 1
  s_lshr_b32 s21, s49, 2
  s_add_u32 s21, s21, 4
  s_cmp_lt_u32 s49, 16
  s_cselect_b32 s21, s22, s21
  s_lshl_b32 s21, s21, 3
  s_lshr_b32 s22, s42, 2
  s_add_u32 s21, s21, s22
  s_lshl_b32 s21, s21, 7
  s_add_u32 s76, s21, 0
  s_lshl_b32 s77, s42, 7
  s_add_u32 s77, s77, 20480
  v_mov_b32 v4, 0
  buffer_load_dword v20, v4, s[72:75], s76 offen sc1
  v_mfma_f32_16x16x32_bf16 v[72:75], a[68:71], v[192:195], v[72:75]
  v_add_u32 v19, s33, v15
  s_add_u32 s33, s33, 16384
  v_mfma_f32_16x16x32_bf16 v[76:79], a[60:63], v[196:199], v[76:79]
  ds_read_b128 v[164:167], v18 offset:2048
  v_mfma_f32_16x16x32_bf16 v[80:83], a[64:67], v[196:199], v[80:83]
  buffer_load_dwordx4 v10, s[8:11], s30 offen offset:0 lds
  v_mfma_f32_16x16x32_bf16 v[84:87], a[68:71], v[196:199], v[84:87]
  s_cmp_lt_u32 s33, 98304
  s_cselect_b32 s33, s33, 0
  v_mfma_f32_16x16x32_bf16 v[88:91], a[60:63], v[200:203], v[88:91]
  ds_read_b128 v[168:171], v18 offset:4096
  v_mfma_f32_16x16x32_bf16 v[92:95], a[64:67], v[200:203], v[92:95]
  v_exp_f32 v47, v47
  v_mfma_f32_16x16x32_bf16 v[96:99], a[68:71], v[200:203], v[96:99]
  v_exp_f32 v48, v48
  v_mfma_f32_16x16x32_bf16 v[100:103], a[60:63], v[204:207], v[100:103]
  ds_read_b128 v[172:175], v18 offset:6144
  v_mfma_f32_16x16x32_bf16 v[104:107], a[64:67], v[204:207], v[104:107]
  v_exp_f32 v49, v49
  v_mfma_f32_16x16x32_bf16 v[108:111], a[68:71], v[204:207], v[108:111]
  s_waitcnt lgkmcnt(4)
  v_mfma_f32_16x16x32_bf16 v[112:115], a[60:63], v[208:211], v[112:115]
  ds_read_b128 v[176:179], v18 offset:8192
  v_mfma_f32_16x16x32_bf16 v[116:119], a[64:67], v[208:211], v[116:119]
  v_exp_f32 v50, v50
  v_mfma_f32_16x16x32_bf16 v[120:123], a[68:71], v[208:211], v[120:123]
  v_exp_f32 v51, v51
  v_mfma_f32_16x16x32_bf16 v[124:127], a[60:63], v[212:215], v[124:127]
  ds_read_b128 v[180:183], v18 offset:10240
  v_mfma_f32_16x16x32_bf16 v[128:131], a[64:67], v[212:215], v[128:131]
  buffer_load_dwordx4 v11, s[8:11], s30 offen offset:1024 lds
  v_mfma_f32_16x16x32_bf16 v[132:135], a[68:71], v[212:215], v[132:135]
  v_exp_f32 v52, v52
  v_mfma_f32_16x16x32_bf16 v[136:139], a[60:63], v[216:219], v[136:139]
  ds_read_b128 v[184:187], v18 offset:12288
  v_mfma_f32_16x16x32_bf16 v[140:143], a[64:67], v[216:219], v[140:143]
  v_exp_f32 v53, v53
  v_mfma_f32_16x16x32_bf16 v[144:147], a[68:71], v[216:219], v[144:147]
  v_exp_f32 v54, v54
  v_mfma_f32_16x16x32_bf16 v[148:151], a[60:63], v[220:223], v[148:151]
  ds_read_b128 v[188:191], v18 offset:14336
  v_mfma_f32_16x16x32_bf16 v[152:155], a[64:67], v[220:223], v[152:155]
  v_exp_f32 v55, v55
  v_mfma_f32_16x16x32_bf16 v[156:159], a[68:71], v[220:223], v[156:159]
  s_waitcnt lgkmcnt(4)
  s_nop 0
  v_mfma_f32_16x16x32_bf16 v[64:67], a[72:75], v[160:163], v[64:67]
  ds_read_b128 v[192:195], v19 offset:0
  v_add_f32 v56, v52, v53
  v_mfma_f32_16x16x32_bf16 v[68:71], a[76:79], v[160:163], v[68:71]
  v_add_u32 v18, s33, v14
  v_add_f32 v56, v56, v54
  v_mfma_f32_16x16x32_bf16 v[72:75], a[80:83], v[160:163], v[72:75]
  v_add_f32 v56, v56, v55
  v_cndmask_b32 v56, 0, v56, s[60:61]
  v_mfma_f32_16x16x32_bf16 v[76:79], a[72:75], v[164:167], v[76:79]
  ds_read_b128 v[196:199], v19 offset:2048
  v_add_f32 v56, v56, v44
  v_mfma_f32_16x16x32_bf16 v[80:83], a[76:79], v[164:167], v[80:83]
  buffer_load_dwordx4 v12, s[8:11], s30 offen offset:2048 lds
  v_mfma_f32_16x16x32_bf16 v[84:87], a[80:83], v[164:167], v[84:87]
  v_add_f32 v56, v56, v45
  v_add_f32 v56, v56, v46
  v_mfma_f32_16x16x32_bf16 v[88:91], a[72:75], v[168:171], v[88:91]
  ds_read_b128 v[200:203], v19 offset:4096
  v_add_f32 v56, v56, v47
  v_mfma_f32_16x16x32_bf16 v[92:95], a[76:79], v[168:171], v[92:95]
  v_add_f32 v56, v56, v48
  v_add_f32 v56, v56, v49
  v_mfma_f32_16x16x32_bf16 v[96:99], a[80:83], v[168:171], v[96:99]
  v_add_f32 v56, v56, v50
  v_add_f32 v56, v56, v51
  v_mfma_f32_16x16x32_bf16 v[100:103], a[72:75], v[172:175], v[100:103]
  ds_read_b128 v[204:207], v19 offset:6144
  v_mov_b32 v57, v56
  v_mfma_f32_16x16x32_bf16 v[104:107], a[76:79], v[172:175], v[104:107]
  s_nop 1
  v_mfma_f32_16x16x32_bf16 v[108:111], a[80:83], v[172:175], v[108:111]
  s_waitcnt lgkmcnt(4)
  v_mfma_f32_16x16x32_bf16 v[112:115], a[72:75], v[176:179], v[112:115]
  ds_read_b128 v[208:211], v19 offset:8192
  v_mfma_f32_16x16x32_bf16 v[116:119], a[76:79], v[176:179], v[116:119]
  v_permlane32_swap_b32 v56, v57
  v_mfma_f32_16x16x32_bf16 v[120:123], a[80:83], v[176:179], v[120:123]
  v_add_f32 v56, v56, v57
  v_mov_b32 v57, v56
  v_mfma_f32_16x16x32_bf16 v[124:127], a[72:75], v[180:183], v[124:127]
  ds_read_b128 v[212:215], v19 offset:10240
  v_mfma_f32_16x16x32_bf16 v[128:131], a[76:79], v[180:183], v[128:131]
  buffer_load_dwordx4 v13, s[8:11], s30 offen offset:3072 lds
  v_mfma_f32_16x16x32_bf16 v[132:135], a[80:83], v[180:183], v[132:135]
  s_add_u32 s30, s30, 128
  s_add_u32 m0, m0, 16384
  v_mfma_f32_16x16x32_bf16 v[136:139], a[72:75], v[184:187], v[136:139]
  ds_read_b128 v[216:219], v19 offset:12288
  v_mfma_f32_16x16x32_bf16 v[140:143], a[76:79], v[184:187], v[140:143]
  s_cmp_lt_u32 m0, s46
  s_cselect_b32 m0, m0, s47
  v_mfma_f32_16x16x32_bf16 v[144:147], a[80:83], v[184:187], v[144:147]
  s_nop 1
  v_mfma_f32_16x16x32_bf16 v[148:151], a[72:75], v[188:191], v[148:151]
  ds_read_b128 v[220:223], v19 offset:14336
  v_mfma_f32_16x16x32_bf16 v[152:155], a[76:79], v[188:191], v[152:155]
  v_permlane16_swap_b32 v56, v57
  v_mfma_f32_16x16x32_bf16 v[156:159], a[80:83], v[188:191], v[156:159]
  s_waitcnt vmcnt(13) lgkmcnt(4)
  s_barrier
  v_mfma_f32_16x16x32_bf16 v[64:67], a[84:87], v[192:195], v[64:67]
  ds_read_b128 v[160:163], v18 offset:0
  v_add_f32 v56, v56, v57
  v_mfma_f32_16x16x32_bf16 v[68:71], a[88:91], v[192:195], v[68:71]
  v_rcp_f32 v56, v56
  v_mfma_f32_16x16x32_bf16 v[72:75], a[92:95], v[192:195], v[72:75]
  v_add_u32 v19, s33, v15
  s_add_u32 s33, s33, 16384
  v_mfma_f32_16x16x32_bf16 v[76:79], a[84:87], v[196:199], v[76:79]
  ds_read_b128 v[164:167], v18 offset:2048
  s_nop 0
  v_mfma_f32_16x16x32_bf16 v[80:83], a[88:91], v[196:199], v[80:83]
  buffer_load_dwordx4 v10, s[8:11], s30 offen offset:0 lds
  v_mfma_f32_16x16x32_bf16 v[84:87], a[92:95], v[196:199], v[84:87]
  s_cmp_lt_u32 s33, 98304
  s_cselect_b32 s33, s33, 0
  v_mfma_f32_16x16x32_bf16 v[88:91], a[84:87], v[200:203], v[88:91]
  ds_read_b128 v[168:171], v18 offset:4096
  v_mul_f32 v44, v44, v56
  v_mfma_f32_16x16x32_bf16 v[92:95], a[88:91], v[200:203], v[92:95]
  v_mul_f32 v45, v45, v56
  v_mul_f32 v46, v46, v56
  v_mfma_f32_16x16x32_bf16 v[96:99], a[92:95], v[200:203], v[96:99]
  v_mul_f32 v47, v47, v56
  v_mul_f32 v48, v48, v56
  v_mfma_f32_16x16x32_bf16 v[100:103], a[84:87], v[204:207], v[100:103]
  ds_read_b128 v[172:175], v18 offset:6144
  v_mul_f32 v49, v49, v56
  v_mfma_f32_16x16x32_bf16 v[104:107], a[88:91], v[204:207], v[104:107]
  v_mul_f32 v50, v50, v56
  v_mul_f32 v51, v51, v56
  v_mfma_f32_16x16x32_bf16 v[108:111], a[92:95], v[204:207], v[108:111]
  s_waitcnt lgkmcnt(4)
  v_mul_f32 v52, v52, v56
  v_mfma_f32_16x16x32_bf16 v[112:115], a[84:87], v[208:211], v[112:115]
  ds_read_b128 v[176:179], v18 offset:8192
  v_mul_f32 v53, v53, v56
  v_mfma_f32_16x16x32_bf16 v[116:119], a[88:91], v[208:211], v[116:119]
  v_mul_f32 v54, v54, v56
  v_mul_f32 v55, v55, v56
  v_mfma_f32_16x16x32_bf16 v[120:123], a[92:95], v[208:211], v[120:123]
  v_cvt_pk_bf16_f32 v236, v44, v45
  v_cvt_pk_bf16_f32 v237, v46, v47
  v_mfma_f32_16x16x32_bf16 v[124:127], a[84:87], v[212:215], v[124:127]
  ds_read_b128 v[180:183], v18 offset:10240
  v_cvt_pk_bf16_f32 v238, v48, v49
  v_mfma_f32_16x16x32_bf16 v[128:131], a[88:91], v[212:215], v[128:131]
  buffer_load_dwordx4 v11, s[8:11], s30 offen offset:1024 lds
  v_mfma_f32_16x16x32_bf16 v[132:135], a[92:95], v[212:215], v[132:135]
  v_cvt_pk_bf16_f32 v239, v50, v51
  v_cvt_pk_bf16_f32 v240, v40, v41
  v_mfma_f32_16x16x32_bf16 v[136:139], a[84:87], v[216:219], v[136:139]
  ds_read_b128 v[184:187], v18 offset:12288
  v_cvt_pk_bf16_f32 v241, v42, v43
  v_mfma_f32_16x16x32_bf16 v[140:143], a[88:91], v[216:219], v[140:143]
  v_cvt_pk_bf16_f32 v242, v52, v53
  v_cvt_pk_bf16_f32 v243, v54, v55
  v_mfma_f32_16x16x32_bf16 v[144:147], a[92:95], v[216:219], v[144:147]
  v_cvt_pk_bf16_f32 v244, v36, v37
  v_cvt_pk_bf16_f32 v245, v38, v39
  v_mfma_f32_16x16x32_bf16 v[148:151], a[84:87], v[220:223], v[148:151]
  ds_read_b128 v[188:191], v18 offset:14336
  v_mfma_f32_16x16x32_bf16 v[152:155], a[88:91], v[220:223], v[152:155]
  v_mfma_f32_16x16x32_bf16 v[156:159], a[92:95], v[220:223], v[156:159]
  s_waitcnt lgkmcnt(4)
  v_mfma_f32_16x16x32_bf16 v[64:67], a[96:99], v[160:163], v[64:67]
  ds_read_b128 v[192:195], v19 offset:0
  v_mfma_f32_16x16x32_bf16 v[68:71], a[100:103], v[160:163], v[68:71]
  v_add_u32 v18, s33, v14
  v_mfma_f32_16x16x32_bf16 v[72:75], a[104:107], v[160:163], v[72:75]
  v_mfma_f32_16x16x32_bf16 v[76:79], a[96:99], v[164:167], v[76:79]
  ds_read_b128 v[196:199], v19 offset:2048
  v_mfma_f32_16x16x32_bf16 v[80:83], a[100:103], v[164:167], v[80:83]
  buffer_load_dwordx4 v12, s[8:11], s30 offen offset:2048 lds
  v_mfma_f32_16x16x32_bf16 v[84:87], a[104:107], v[164:167], v[84:87]
  v_mfma_f32_16x16x32_bf16 v[88:91], a[96:99], v[168:171], v[88:91]
  ds_read_b128 v[200:203], v19 offset:4096
  v_mfma_f32_16x16x32_bf16 v[92:95], a[100:103], v[168:171], v[92:95]
  v_mfma_f32_16x16x32_bf16 v[96:99], a[104:107], v[168:171], v[96:99]
  v_mfma_f32_16x16x32_bf16 v[100:103], a[96:99], v[172:175], v[100:103]
  ds_read_b128 v[204:207], v19 offset:6144
  v_mfma_f32_16x16x32_bf16 v[104:107], a[100:103], v[172:175], v[104:107]
  v_mfma_f32_16x16x32_bf16 v[108:111], a[104:107], v[172:175], v[108:111]
  s_waitcnt lgkmcnt(4)
  v_mfma_f32_16x16x32_bf16 v[112:115], a[96:99], v[176:179], v[112:115]
  ds_read_b128 v[208:211], v19 offset:8192
  v_mfma_f32_16x16x32_bf16 v[116:119], a[100:103], v[176:179], v[116:119]
  v_mfma_f32_16x16x32_bf16 v[120:123], a[104:107], v[176:179], v[120:123]
  v_mfma_f32_16x16x32_bf16 v[124:127], a[96:99], v[180:183], v[124:127]
  ds_read_b128 v[212:215], v19 offset:10240
  v_mfma_f32_16x16x32_bf16 v[128:131], a[100:103], v[180:183], v[128:131]
  buffer_load_dwordx4 v13, s[8:11], s30 offen offset:3072 lds
  v_mfma_f32_16x16x32_bf16 v[132:135], a[104:107], v[180:183], v[132:135]
  s_add_u32 s30, s30, 128
  s_add_u32 m0, m0, 16384
  v_mfma_f32_16x16x32_bf16 v[136:139], a[96:99], v[184:187], v[136:139]
  ds_read_b128 v[216:219], v19 offset:12288
  v_mfma_f32_16x16x32_bf16 v[140:143], a[100:103], v[184:187], v[140:143]
  s_cmp_lt_u32 m0, s46
  s_cselect_b32 m0, m0, s47
  v_mfma_f32_16x16x32_bf16 v[144:147], a[104:107], v[184:187], v[144:147]
  v_mfma_f32_16x16x32_bf16 v[148:151], a[96:99], v[188:191], v[148:151]
  ds_read_b128 v[220:223], v19 offset:14336
  v_mfma_f32_16x16x32_bf16 v[152:155], a[100:103], v[188:191], v[152:155]
  v_mfma_f32_16x16x32_bf16 v[156:159], a[104:107], v[188:191], v[156:159]
  s_waitcnt vmcnt(13) lgkmcnt(4)
  s_barrier
  v_mfma_f32_16x16x32_bf16 v[64:67], a[108:111], v[192:195], v[64:67]
  ds_read_b128 v[160:163], v18 offset:0
  v_mfma_f32_16x16x32_bf16 v[68:71], a[112:115], v[192:195], v[68:71]
  v_mfma_f32_16x16x32_bf16 v[72:75], a[116:119], v[192:195], v[72:75]
  v_add_u32 v19, s33, v15
  s_add_u32 s33, s33, 16384
  v_mfma_f32_16x16x32_bf16 v[76:79], a[108:111], v[196:199], v[76:79]
  ds_read_b128 v[164:167], v18 offset:2048
  v_mfma_f32_16x16x32_bf16 v[80:83], a[112:115], v[196:199], v[80:83]
  buffer_load_dwordx4 v10, s[8:11], s30 offen offset:0 lds
  v_mfma_f32_16x16x32_bf16 v[84:87], a[116:119], v[196:199], v[84:87]
  s_cmp_lt_u32 s33, 98304
  s_cselect_b32 s33, s33, 0
  v_mfma_f32_16x16x32_bf16 v[88:91], a[108:111], v[200:203], v[88:91]
  ds_read_b128 v[168:171], v18 offset:4096
  v_mfma_f32_16x16x32_bf16 v[92:95], a[112:115], v[200:203], v[92:95]
  v_mfma_f32_16x16x32_bf16 v[96:99], a[116:119], v[200:203], v[96:99]
  v_mfma_f32_16x16x32_bf16 v[100:103], a[108:111], v[204:207], v[100:103]
  ds_read_b128 v[172:175], v18 offset:6144
  v_mfma_f32_16x16x32_bf16 v[104:107], a[112:115], v[204:207], v[104:107]
  v_mfma_f32_16x16x32_bf16 v[108:111], a[116:119], v[204:207], v[108:111]
  s_waitcnt lgkmcnt(4)
  v_mfma_f32_16x16x32_bf16 v[112:115], a[108:111], v[208:211], v[112:115]
  ds_read_b128 v[176:179], v18 offset:8192
  v_mfma_f32_16x16x32_bf16 v[116:119], a[112:115], v[208:211], v[116:119]
  v_mfma_f32_16x16x32_bf16 v[120:123], a[116:119], v[208:211], v[120:123]
  v_mfma_f32_16x16x32_bf16 v[124:127], a[108:111], v[212:215], v[124:127]
  ds_read_b128 v[180:183], v18 offset:10240
  v_mfma_f32_16x16x32_bf16 v[128:131], a[112:115], v[212:215], v[128:131]
  buffer_load_dwordx4 v11, s[8:11], s30 offen offset:1024 lds
  v_mfma_f32_16x16x32_bf16 v[132:135], a[116:119], v[212:215], v[132:135]
  v_mfma_f32_16x16x32_bf16 v[136:139], a[108:111], v[216:219], v[136:139]
  ds_read_b128 v[184:187], v18 offset:12288
  v_mfma_f32_16x16x32_bf16 v[140:143], a[112:115], v[216:219], v[140:143]
  v_mfma_f32_16x16x32_bf16 v[144:147], a[116:119], v[216:219], v[144:147]
  v_mfma_f32_16x16x32_bf16 v[148:151], a[108:111], v[220:223], v[148:151]
  ds_read_b128 v[188:191], v18 offset:14336
  v_mfma_f32_16x16x32_bf16 v[152:155], a[112:115], v[220:223], v[152:155]
  v_mfma_f32_16x16x32_bf16 v[156:159], a[116:119], v[220:223], v[156:159]
  s_waitcnt lgkmcnt(4)
  v_mfma_f32_16x16x32_bf16 v[64:67], a[120:123], v[160:163], v[64:67]
  ds_read_b128 v[192:195], v19 offset:0
  v_mfma_f32_16x16x32_bf16 v[68:71], a[124:127], v[160:163], v[68:71]
  v_add_u32 v18, s33, v14
  v_mfma_f32_16x16x32_bf16 v[72:75], a[128:131], v[160:163], v[72:75]
  v_mfma_f32_16x16x32_bf16 v[76:79], a[120:123], v[164:167], v[76:79]
  ds_read_b128 v[196:199], v19 offset:2048
  v_mfma_f32_16x16x32_bf16 v[80:83], a[124:127], v[164:167], v[80:83]
  buffer_load_dwordx4 v12, s[8:11], s30 offen offset:2048 lds
  v_mfma_f32_16x16x32_bf16 v[84:87], a[128:131], v[164:167], v[84:87]
  v_mfma_f32_16x16x32_bf16 v[88:91], a[120:123], v[168:171], v[88:91]
  ds_read_b128 v[200:203], v19 offset:4096
  v_mfma_f32_16x16x32_bf16 v[92:95], a[124:127], v[168:171], v[92:95]
  v_mfma_f32_16x16x32_bf16 v[96:99], a[128:131], v[168:171], v[96:99]
  v_mfma_f32_16x16x32_bf16 v[100:103], a[120:123], v[172:175], v[100:103]
  ds_read_b128 v[204:207], v19 offset:6144
  v_mfma_f32_16x16x32_bf16 v[104:107], a[124:127], v[172:175], v[104:107]
  v_mfma_f32_16x16x32_bf16 v[108:111], a[128:131], v[172:175], v[108:111]
  s_waitcnt lgkmcnt(4)
  v_mfma_f32_16x16x32_bf16 v[112:115], a[120:123], v[176:179], v[112:115]
  ds_read_b128 v[208:211], v19 offset:8192
  v_mfma_f32_16x16x32_bf16 v[116:119], a[124:127], v[176:179], v[116:119]
  v_mfma_f32_16x16x32_bf16 v[120:123], a[128:131], v[176:179], v[120:123]
  v_mfma_f32_16x16x32_bf16 v[124:127], a[120:123], v[180:183], v[124:127]
  ds_read_b128 v[212:215], v19 offset:10240
  v_mfma_f32_16x16x32_bf16 v[128:131], a[124:127], v[180:183], v[128:131]
  buffer_load_dwordx4 v13, s[8:11], s30 offen offset:3072 lds
  v_mfma_f32_16x16x32_bf16 v[132:135], a[128:131], v[180:183], v[132:135]
  s_add_u32 s30, s30, s25
  s_sub_u32 s30, s30, 1152
  v_mfma_f32_16x16x32_bf16 v[136:139], a[120:123], v[184:187], v[136:139]
  ds_read_b128 v[216:219], v19 offset:12288
  s_mov_b32 s25, 163840
  v_mfma_f32_16x16x32_bf16 v[140:143], a[124:127], v[184:187], v[140:143]
  s_add_u32 m0, m0, 16384
  v_mfma_f32_16x16x32_bf16 v[144:147], a[128:131], v[184:187], v[144:147]
  s_cmp_lt_u32 m0, s46
  s_cselect_b32 m0, m0, s47
  v_mfma_f32_16x16x32_bf16 v[148:151], a[120:123], v[188:191], v[148:151]
  ds_read_b128 v[220:223], v19 offset:14336
  v_mfma_f32_16x16x32_bf16 v[152:155], a[124:127], v[188:191], v[152:155]
  v_mfma_f32_16x16x32_bf16 v[156:159], a[128:131], v[188:191], v[156:159]
  s_waitcnt vmcnt(13) lgkmcnt(4)
  s_barrier
  v_mfma_f32_16x16x32_bf16 v[64:67], a[132:135], v[192:195], v[64:67]
  ds_read_b128 v[160:163], v18 offset:0
  v_mfma_f32_16x16x32_bf16 v[68:71], a[136:139], v[192:195], v[68:71]
  buffer_store_dwordx4 v[236:239], v30, s[56:59], s81 offen sc1
  buffer_store_dwordx4 v[240:243], v30, s[56:59], s81 offen offset:1024 sc1
  buffer_store_dwordx2 v[244:245], v32, s[56:59], s81 offen offset:2048 sc1
  s_mov_b32 s78, s82
  s_mov_b32 s82, 0
  s_mov_b32 s81, 0x80000000
  v_mfma_f32_16x16x32_bf16 v[72:75], a[140:143], v[192:195], v[72:75]
  v_add_u32 v19, s33, v15
  s_add_u32 s33, s33, 16384
  v_mfma_f32_16x16x32_bf16 v[76:79], a[132:135], v[196:199], v[76:79]
  ds_read_b128 v[164:167], v18 offset:2048
  v_mfma_f32_16x16x32_bf16 v[80:83], a[136:139], v[196:199], v[80:83]
  buffer_load_dwordx4 v10, s[8:11], s30 offen offset:0 lds
  v_mfma_f32_16x16x32_bf16 v[84:87], a[140:143], v[196:199], v[84:87]
  s_cmp_lt_u32 s33, 98304
  s_cselect_b32 s33, s33, 0
  v_mfma_f32_16x16x32_bf16 v[88:91], a[132:135], v[200:203], v[88:91]
  ds_read_b128 v[168:171], v18 offset:4096
  v_mfma_f32_16x16x32_bf16 v[92:95], a[136:139], v[200:203], v[92:95]
  v_mfma_f32_16x16x32_bf16 v[96:99], a[140:143], v[200:203], v[96:99]
  v_mfma_f32_16x16x32_bf16 v[100:103], a[132:135], v[204:207], v[100:103]
  ds_read_b128 v[172:175], v18 offset:6144
  v_mfma_f32_16x16x32_bf16 v[104:107], a[136:139], v[204:207], v[104:107]
  v_mfma_f32_16x16x32_bf16 v[108:111], a[140:143], v[204:207], v[108:111]
  s_waitcnt lgkmcnt(4)
  v_mfma_f32_16x16x32_bf16 v[112:115], a[132:135], v[208:211], v[112:115]
  ds_read_b128 v[176:179], v18 offset:8192
  v_mfma_f32_16x16x32_bf16 v[116:119], a[136:139], v[208:211], v[116:119]
  v_mfma_f32_16x16x32_bf16 v[120:123], a[140:143], v[208:211], v[120:123]
  v_mfma_f32_16x16x32_bf16 v[124:127], a[132:135], v[212:215], v[124:127]
  ds_read_b128 v[180:183], v18 offset:10240
  v_mfma_f32_16x16x32_bf16 v[128:131], a[136:139], v[212:215], v[128:131]
  buffer_load_dwordx4 v11, s[8:11], s30 offen offset:1024 lds
  v_mfma_f32_16x16x32_bf16 v[132:135], a[140:143], v[212:215], v[132:135]
  v_mfma_f32_16x16x32_bf16 v[136:139], a[132:135], v[216:219], v[136:139]
  ds_read_b128 v[184:187], v18 offset:12288
  v_mfma_f32_16x16x32_bf16 v[140:143], a[136:139], v[216:219], v[140:143]
  v_mfma_f32_16x16x32_bf16 v[144:147], a[140:143], v[216:219], v[144:147]
  v_mfma_f32_16x16x32_bf16 v[148:151], a[132:135], v[220:223], v[148:151]
  ds_read_b128 v[188:191], v18 offset:14336
  v_mfma_f32_16x16x32_bf16 v[152:155], a[136:139], v[220:223], v[152:155]
  v_mfma_f32_16x16x32_bf16 v[156:159], a[140:143], v[220:223], v[156:159]
  s_waitcnt lgkmcnt(4)
  v_mfma_f32_16x16x32_bf16 v[64:67], a[144:147], v[160:163], v[64:67]
  ds_read_b128 v[192:195], v19 offset:0
  v_mfma_f32_16x16x32_bf16 v[68:71], a[148:151], v[160:163], v[68:71]
  v_add_u32 v18, s33, v14
  v_mfma_f32_16x16x32_bf16 v[72:75], a[152:155], v[160:163], v[72:75]
  v_mfma_f32_16x16x32_bf16 v[76:79], a[144:147], v[164:167], v[76:79]
  ds_read_b128 v[196:199], v19 offset:2048
  v_mfma_f32_16x16x32_bf16 v[80:83], a[148:151], v[164:167], v[80:83]
  buffer_load_dwordx4 v12, s[8:11], s30 offen offset:2048 lds
  v_mfma_f32_16x16x32_bf16 v[84:87], a[152:155], v[164:167], v[84:87]
  v_mfma_f32_16x16x32_bf16 v[88:91], a[144:147], v[168:171], v[88:91]
  ds_read_b128 v[200:203], v19 offset:4096
  v_mfma_f32_16x16x32_bf16 v[92:95], a[148:151], v[168:171], v[92:95]
  v_mfma_f32_16x16x32_bf16 v[96:99], a[152:155], v[168:171], v[96:99]
  v_mfma_f32_16x16x32_bf16 v[100:103], a[144:147], v[172:175], v[100:103]
  ds_read_b128 v[204:207], v19 offset:6144
  v_mfma_f32_16x16x32_bf16 v[104:107], a[148:151], v[172:175], v[104:107]
  v_mfma_f32_16x16x32_bf16 v[108:111], a[152:155], v[172:175], v[108:111]
  s_waitcnt lgkmcnt(4)
  v_mfma_f32_16x16x32_bf16 v[112:115], a[144:147], v[176:179], v[112:115]
  ds_read_b128 v[208:211], v19 offset:8192
  v_mfma_f32_16x16x32_bf16 v[116:119], a[148:151], v[176:179], v[116:119]
  v_mfma_f32_16x16x32_bf16 v[120:123], a[152:155], v[176:179], v[120:123]
  v_mfma_f32_16x16x32_bf16 v[124:127], a[144:147], v[180:183], v[124:127]
  ds_read_b128 v[212:215], v19 offset:10240
  v_mfma_f32_16x16x32_bf16 v[128:131], a[148:151], v[180:183], v[128:131]
  buffer_load_dwordx4 v13, s[8:11], s30 offen offset:3072 lds
  v_mfma_f32_16x16x32_bf16 v[132:135], a[152:155], v[180:183], v[132:135]
  s_add_u32 s30, s30, 128
  s_add_u32 m0, m0, 16384
  v_mfma_f32_16x16x32_bf16 v[136:139], a[144:147], v[184:187], v[136:139]
  ds_read_b128 v[216:219], v19 offset:12288
  v_mfma_f32_16x16x32_bf16 v[140:143], a[148:151], v[184:187], v[140:143]
  s_cmp_lt_u32 m0, s46
  s_cselect_b32 m0, m0, s47
  v_mfma_f32_16x16x32_bf16 v[144:147], a[152:155], v[184:187], v[144:147]
  v_mfma_f32_16x16x32_bf16 v[148:151], a[144:147], v[188:191], v[148:151]
  ds_read_b128 v[220:223], v19 offset:14336
  v_mfma_f32_16x16x32_bf16 v[152:155], a[148:151], v[188:191], v[152:155]
  v_mfma_f32_16x16x32_bf16 v[156:159], a[152:155], v[188:191], v[156:159]
  s_waitcnt vmcnt(15) lgkmcnt(4)
  s_barrier
  v_mfma_f32_16x16x32_bf16 v[64:67], a[156:159], v[192:195], v[64:67]
  ds_read_b128 v[160:163], v18 offset:0
  v_mfma_f32_16x16x32_bf16 v[68:71], a[160:163], v[192:195], v[68:71]
  v_readfirstlane_b32 s79, v20
  v_mfma_f32_16x16x32_bf16 v[72:75], a[164:167], v[192:195], v[72:75]
  v_add_u32 v19, s33, v15
  s_add_u32 s33, s33, 16384
  v_mfma_f32_16x16x32_bf16 v[76:79], a[156:159], v[196:199], v[76:79]
  ds_read_b128 v[164:167], v18 offset:2048
  s_add_u32 s21, s50, 0
  v_mfma_f32_16x16x32_bf16 v[80:83], a[160:163], v[196:199], v[80:83]
  buffer_load_dwordx4 v10, s[8:11], s30 offen offset:0 lds
  v_mfma_f32_16x16x32_bf16 v[84:87], a[164:167], v[196:199], v[84:87]
  s_cmp_lt_u32 s33, 98304
  s_cselect_b32 s33, s33, 0
  v_mfma_f32_16x16x32_bf16 v[88:91], a[156:159], v[200:203], v[88:91]
  ds_read_b128 v[168:171], v18 offset:4096
  v_mfma_f32_16x16x32_bf16 v[92:95], a[160:163], v[200:203], v[92:95]
  buffer_load_dwordx4 v[36:39], v30, s[16:19], s21 offen offset:0 sc1
  v_mfma_f32_16x16x32_bf16 v[96:99], a[164:167], v[200:203], v[96:99]
  v_mfma_f32_16x16x32_bf16 v[100:103], a[156:159], v[204:207], v[100:103]
  ds_read_b128 v[172:175], v18 offset:6144
  v_mfma_f32_16x16x32_bf16 v[104:107], a[160:163], v[204:207], v[104:107]
  v_mfma_f32_16x16x32_bf16 v[108:111], a[164:167], v[204:207], v[108:111]
  s_waitcnt lgkmcnt(4)
  v_mfma_f32_16x16x32_bf16 v[112:115], a[156:159], v[208:211], v[112:115]
  ds_read_b128 v[176:179], v18 offset:8192
  v_mfma_f32_16x16x32_bf16 v[116:119], a[160:163], v[208:211], v[116:119]
  buffer_load_dwordx4 v[40:43], v30, s[16:19], s21 offen offset:1024 sc1
  v_mfma_f32_16x16x32_bf16 v[120:123], a[164:167], v[208:211], v[120:123]
  v_mfma_f32_16x16x32_bf16 v[124:127], a[156:159], v[212:215], v[124:127]
  ds_read_b128 v[180:183], v18 offset:10240
  v_mfma_f32_16x16x32_bf16 v[128:131], a[160:163], v[212:215], v[128:131]
  buffer_load_dwordx4 v11, s[8:11], s30 offen offset:1024 lds
  v_mfma_f32_16x16x32_bf16 v[132:135], a[164:167], v[212:215], v[132:135]
  v_mfma_f32_16x16x32_bf16 v[136:139], a[156:159], v[216:219], v[136:139]
  ds_read_b128 v[184:187], v18 offset:12288
  v_mfma_f32_16x16x32_bf16 v[140:143], a[160:163], v[216:219], v[140:143]
  buffer_load_dwordx4 v[44:47], v30, s[16:19], s21 offen offset:2048 sc1
  v_mfma_f32_16x16x32_bf16 v[144:147], a[164:167], v[216:219], v[144:147]
  v_mfma_f32_16x16x32_bf16 v[148:151], a[156:159], v[220:223], v[148:151]
  ds_read_b128 v[188:191], v18 offset:14336
  v_mfma_f32_16x16x32_bf16 v[152:155], a[160:163], v[220:223], v[152:155]
  v_mfma_f32_16x16x32_bf16 v[156:159], a[164:167], v[220:223], v[156:159]
  s_waitcnt lgkmcnt(4)
  v_mfma_f32_16x16x32_bf16 v[64:67], a[168:171], v[160:163], v[64:67]
  ds_read_b128 v[192:195], v19 offset:0
  v_mfma_f32_16x16x32_bf16 v[68:71], a[172:175], v[160:163], v[68:71]
  v_add_u32 v18, s33, v14
  v_mfma_f32_16x16x32_bf16 v[72:75], a[176:179], v[160:163], v[72:75]
  buffer_load_dwordx4 v[48:51], v30, s[16:19], s21 offen offset:3072 sc1
  v_mfma_f32_16x16x32_bf16 v[76:79], a[168:171], v[164:167], v[76:79]
  ds_read_b128 v[196:199], v19 offset:2048
  v_mfma_f32_16x16x32_bf16 v[80:83], a[172:175], v[164:167], v[80:83]
  buffer_load_dwordx4 v12, s[8:11], s30 offen offset:2048 lds
  v_mfma_f32_16x16x32_bf16 v[84:87], a[176:179], v[164:167], v[84:87]
  v_mfma_f32_16x16x32_bf16 v[88:91], a[168:171], v[168:171], v[88:91]
  ds_read_b128 v[200:203], v19 offset:4096
  v_mfma_f32_16x16x32_bf16 v[92:95], a[172:175], v[168:171], v[92:95]
  s_add_u32 s21, s50, 4096
  v_mfma_f32_16x16x32_bf16 v[96:99], a[176:179], v[168:171], v[96:99]
  buffer_load_dwordx4 v[52:55], v30, s[16:19], s21 offen offset:0 sc1
  v_mfma_f32_16x16x32_bf16 v[100:103], a[168:171], v[172:175], v[100:103]
  ds_read_b128 v[204:207], v19 offset:6144
  v_mfma_f32_16x16x32_bf16 v[104:107], a[172:175], v[172:175], v[104:107]
  v_mfma_f32_16x16x32_bf16 v[108:111], a[176:179], v[172:175], v[108:111]
  s_waitcnt lgkmcnt(4)
  v_mfma_f32_16x16x32_bf16 v[112:115], a[168:171], v[176:179], v[112:115]
  ds_read_b128 v[208:211], v19 offset:8192
  v_mfma_f32_16x16x32_bf16 v[116:119], a[172:175], v[176:179], v[116:119]
  buffer_load_dwordx4 v[56:59], v30, s[16:19], s21 offen offset:1024 sc1
  v_mfma_f32_16x16x32_bf16 v[120:123], a[176:179], v[176:179], v[120:123]
  v_mfma_f32_16x16x32_bf16 v[124:127], a[168:171], v[180:183], v[124:127]
  ds_read_b128 v[212:215], v19 offset:10240
  v_mfma_f32_16x16x32_bf16 v[128:131], a[172:175], v[180:183], v[128:131]
  buffer_load_dwordx4 v13, s[8:11], s30 offen offset:3072 lds
  v_mfma_f32_16x16x32_bf16 v[132:135], a[176:179], v[180:183], v[132:135]
  s_add_u32 s30, s30, 128
  s_add_u32 m0, m0, 16384
  v_mfma_f32_16x16x32_bf16 v[136:139], a[168:171], v[184:187], v[136:139]
  ds_read_b128 v[216:219], v19 offset:12288
  v_mfma_f32_16x16x32_bf16 v[140:143], a[172:175], v[184:187], v[140:143]
  s_cmp_lt_u32 m0, s46
  s_cselect_b32 m0, m0, s47
  v_mfma_f32_16x16x32_bf16 v[144:147], a[176:179], v[184:187], v[144:147]
  buffer_load_dwordx4 v[60:63], v30, s[16:19], s21 offen offset:2048 sc1
  v_mfma_f32_16x16x32_bf16 v[148:151], a[168:171], v[188:191], v[148:151]
  ds_read_b128 v[220:223], v19 offset:14336
  v_mfma_f32_16x16x32_bf16 v[152:155], a[172:175], v[188:191], v[152:155]
  v_mfma_f32_16x16x32_bf16 v[156:159], a[176:179], v[188:191], v[156:159]
  s_waitcnt vmcnt(22) lgkmcnt(4)
  s_barrier
  v_mfma_f32_16x16x32_bf16 v[64:67], a[180:183], v[192:195], v[64:67]
  ds_read_b128 v[160:163], v18 offset:0
  v_mfma_f32_16x16x32_bf16 v[68:71], a[184:187], v[192:195], v[68:71]
  buffer_load_dwordx4 v[236:239], v30, s[16:19], s21 offen offset:3072 sc1
  v_mfma_f32_16x16x32_bf16 v[72:75], a[188:191], v[192:195], v[72:75]
  v_add_u32 v19, s33, v15
  s_add_u32 s33, s33, 16384
  v_mfma_f32_16x16x32_bf16 v[76:79], a[180:183], v[196:199], v[76:79]
  ds_read_b128 v[164:167], v18 offset:2048
  v_mfma_f32_16x16x32_bf16 v[80:83], a[184:187], v[196:199], v[80:83]
  buffer_load_dwordx4 v10, s[8:11], s30 offen offset:0 lds
  v_mfma_f32_16x16x32_bf16 v[84:87], a[188:191], v[196:199], v[84:87]
  s_cmp_lt_u32 s33, 98304
  s_cselect_b32 s33, s33, 0
  v_mfma_f32_16x16x32_bf16 v[88:91], a[180:183], v[200:203], v[88:91]
  ds_read_b128 v[168:171], v18 offset:4096
  s_add_u32 s21, s50, 8192
  v_mfma_f32_16x16x32_bf16 v[92:95], a[184:187], v[200:203], v[92:95]
  buffer_load_dwordx4 v[240:243], v30, s[16:19], s21 offen offset:0 sc1
  v_mfma_f32_16x16x32_bf16 v[96:99], a[188:191], v[200:203], v[96:99]
  v_mfma_f32_16x16x32_bf16 v[100:103], a[180:183], v[204:207], v[100:103]
  ds_read_b128 v[172:175], v18 offset:6144
  v_mfma_f32_16x16x32_bf16 v[104:107], a[184:187], v[204:207], v[104:107]
  v_mfma_f32_16x16x32_bf16 v[108:111], a[188:191], v[204:207], v[108:111]
  s_waitcnt lgkmcnt(4)
  v_mfma_f32_16x16x32_bf16 v[112:115], a[180:183], v[208:211], v[112:115]
  ds_read_b128 v[176:179], v18 offset:8192
  v_mfma_f32_16x16x32_bf16 v[116:119], a[184:187], v[208:211], v[116:119]
  buffer_load_dwordx4 v[244:247], v30, s[16:19], s21 offen offset:1024 sc1
  v_mfma_f32_16x16x32_bf16 v[120:123], a[188:191], v[208:211], v[120:123]
  v_mfma_f32_16x16x32_bf16 v[124:127], a[180:183], v[212:215], v[124:127]
  ds_read_b128 v[180:183], v18 offset:10240
  v_mfma_f32_16x16x32_bf16 v[128:131], a[184:187], v[212:215], v[128:131]
  buffer_load_dwordx4 v11, s[8:11], s30 offen offset:1024 lds
  v_mfma_f32_16x16x32_bf16 v[132:135], a[188:191], v[212:215], v[132:135]
  v_mfma_f32_16x16x32_bf16 v[136:139], a[180:183], v[216:219], v[136:139]
  ds_read_b128 v[184:187], v18 offset:12288
  v_mfma_f32_16x16x32_bf16 v[140:143], a[184:187], v[216:219], v[140:143]
  buffer_load_dwordx4 v[248:251], v30, s[16:19], s21 offen offset:2048 sc1
  v_mfma_f32_16x16x32_bf16 v[144:147], a[188:191], v[216:219], v[144:147]
  v_mfma_f32_16x16x32_bf16 v[148:151], a[180:183], v[220:223], v[148:151]
  ds_read_b128 v[188:191], v18 offset:14336
  v_mfma_f32_16x16x32_bf16 v[152:155], a[184:187], v[220:223], v[152:155]
  v_mfma_f32_16x16x32_bf16 v[156:159], a[188:191], v[220:223], v[156:159]
  s_waitcnt lgkmcnt(4)
  v_mfma_f32_16x16x32_bf16 v[64:67], a[192:195], v[160:163], v[64:67]
  ds_read_b128 v[192:195], v19 offset:0
  v_mfma_f32_16x16x32_bf16 v[68:71], a[196:199], v[160:163], v[68:71]
  v_add_u32 v18, s33, v14
  v_mfma_f32_16x16x32_bf16 v[72:75], a[200:203], v[160:163], v[72:75]
  buffer_load_dwordx4 v[252:255], v30, s[16:19], s21 offen offset:3072 sc1
  v_mfma_f32_16x16x32_bf16 v[76:79], a[192:195], v[164:167], v[76:79]
  ds_read_b128 v[196:199], v19 offset:2048
  v_mfma_f32_16x16x32_bf16 v[80:83], a[196:199], v[164:167], v[80:83]
  buffer_load_dwordx4 v12, s[8:11], s30 offen offset:2048 lds
  v_mfma_f32_16x16x32_bf16 v[84:87], a[200:203], v[164:167], v[84:87]
  v_mfma_f32_16x16x32_bf16 v[88:91], a[192:195], v[168:171], v[88:91]
  ds_read_b128 v[200:203], v19 offset:4096
  v_mfma_f32_16x16x32_bf16 v[92:95], a[196:199], v[168:171], v[92:95]
  buffer_load_dword v21, v33, s[72:75], s77 offen sc1
  v_mfma_f32_16x16x32_bf16 v[96:99], a[200:203], v[168:171], v[96:99]
  v_mfma_f32_16x16x32_bf16 v[100:103], a[192:195], v[172:175], v[100:103]
  ds_read_b128 v[204:207], v19 offset:6144
  v_mfma_f32_16x16x32_bf16 v[104:107], a[196:199], v[172:175], v[104:107]
  v_mfma_f32_16x16x32_bf16 v[108:111], a[200:203], v[172:175], v[108:111]
  s_waitcnt lgkmcnt(4)
  v_mfma_f32_16x16x32_bf16 v[112:115], a[192:195], v[176:179], v[112:115]
  ds_read_b128 v[208:211], v19 offset:8192
  v_mfma_f32_16x16x32_bf16 v[116:119], a[196:199], v[176:179], v[116:119]
  v_mfma_f32_16x16x32_bf16 v[120:123], a[200:203], v[176:179], v[120:123]
  v_mfma_f32_16x16x32_bf16 v[124:127], a[192:195], v[180:183], v[124:127]
  ds_read_b128 v[212:215], v19 offset:10240
  v_mfma_f32_16x16x32_bf16 v[128:131], a[196:199], v[180:183], v[128:131]
  buffer_load_dwordx4 v13, s[8:11], s30 offen offset:3072 lds
  v_mfma_f32_16x16x32_bf16 v[132:135], a[200:203], v[180:183], v[132:135]
  s_add_u32 s30, s30, 128
  s_add_u32 m0, m0, 16384
  v_mfma_f32_16x16x32_bf16 v[136:139], a[192:195], v[184:187], v[136:139]
  ds_read_b128 v[216:219], v19 offset:12288
  v_mfma_f32_16x16x32_bf16 v[140:143], a[196:199], v[184:187], v[140:143]
  s_cmp_lt_u32 m0, s46
  s_cselect_b32 m0, m0, s47
  v_mfma_f32_16x16x32_bf16 v[144:147], a[200:203], v[184:187], v[144:147]
  v_mfma_f32_16x16x32_bf16 v[148:151], a[192:195], v[188:191], v[148:151]
  ds_read_b128 v[220:223], v19 offset:14336
  v_mfma_f32_16x16x32_bf16 v[152:155], a[196:199], v[188:191], v[152:155]
  v_mfma_f32_16x16x32_bf16 v[156:159], a[200:203], v[188:191], v[156:159]
  s_waitcnt vmcnt(28) lgkmcnt(4)
  s_barrier
  v_mfma_f32_16x16x32_bf16 v[64:67], a[204:207], v[192:195], v[64:67]
  ds_read_b128 v[160:163], v18 offset:0
  v_mfma_f32_16x16x32_bf16 v[68:71], a[208:211], v[192:195], v[68:71]
  s_waitcnt vmcnt(25)
  s_cmp_eq_u32 s78, 0
  s_cbranch_scc1 pf_214
  v_mov_b32 v4, 0
  v_mov_b32 v5, 1
  s_mov_b64 exec, 1
  buffer_atomic_add v5, v4, s[72:75], s78 offen sc1
  s_mov_b64 exec, -1
  s_mov_b32 s78, 0
pf_214:
  v_mfma_f32_16x16x32_bf16 v[72:75], a[212:215], v[192:195], v[72:75]
  v_add_u32 v19, s33, v15
  s_add_u32 s33, s33, 16384
  v_mfma_f32_16x16x32_bf16 v[76:79], a[204:207], v[196:199], v[76:79]
  ds_read_b128 v[164:167], v18 offset:2048
  v_mfma_f32_16x16x32_bf16 v[80:83], a[208:211], v[196:199], v[80:83]
  buffer_load_dwordx4 v10, s[8:11], s30 offen offset:0 lds
  v_mfma_f32_16x16x32_bf16 v[84:87], a[212:215], v[196:199], v[84:87]
  s_cmp_lt_u32 s33, 98304
  s_cselect_b32 s33, s33, 0
  v_mfma_f32_16x16x32_bf16 v[88:91], a[204:207], v[200:203], v[88:91]
  ds_read_b128 v[168:171], v18 offset:4096
  v_mfma_f32_16x16x32_bf16 v[92:95], a[208:211], v[200:203], v[92:95]
  v_mfma_f32_16x16x32_bf16 v[96:99], a[212:215], v[200:203], v[96:99]
  v_mfma_f32_16x16x32_bf16 v[100:103], a[204:207], v[204:207], v[100:103]
  ds_read_b128 v[172:175], v18 offset:6144
  v_mfma_f32_16x16x32_bf16 v[104:107], a[208:211], v[204:207], v[104:107]
  v_mfma_f32_16x16x32_bf16 v[108:111], a[212:215], v[204:207], v[108:111]
  s_waitcnt lgkmcnt(4)
  v_mfma_f32_16x16x32_bf16 v[112:115], a[204:207], v[208:211], v[112:115]
  ds_read_b128 v[176:179], v18 offset:8192
  v_mfma_f32_16x16x32_bf16 v[116:119], a[208:211], v[208:211], v[116:119]
  v_mfma_f32_16x16x32_bf16 v[120:123], a[212:215], v[208:211], v[120:123]
  v_mfma_f32_16x16x32_bf16 v[124:127], a[204:207], v[212:215], v[124:127]
  ds_read_b128 v[180:183], v18 offset:10240
  v_mfma_f32_16x16x32_bf16 v[128:131], a[208:211], v[212:215], v[128:131]
  buffer_load_dwordx4 v11, s[8:11], s30 offen offset:1024 lds
  v_mfma_f32_16x16x32_bf16 v[132:135], a[212:215], v[212:215], v[132:135]
  v_mfma_f32_16x16x32_bf16 v[136:139], a[204:207], v[216:219], v[136:139]
  ds_read_b128 v[184:187], v18 offset:12288
  v_mfma_f32_16x16x32_bf16 v[140:143], a[208:211], v[216:219], v[140:143]
  v_mfma_f32_16x16x32_bf16 v[144:147], a[212:215], v[216:219], v[144:147]
  v_mfma_f32_16x16x32_bf16 v[148:151], a[204:207], v[220:223], v[148:151]
  ds_read_b128 v[188:191], v18 offset:14336
  v_mfma_f32_16x16x32_bf16 v[152:155], a[208:211], v[220:223], v[152:155]
  v_mfma_f32_16x16x32_bf16 v[156:159], a[212:215], v[220:223], v[156:159]
  s_waitcnt lgkmcnt(4)
  v_mfma_f32_16x16x32_bf16 v[64:67], a[216:219], v[160:163], v[64:67]
  ds_read_b128 v[192:195], v19 offset:0
  v_mfma_f32_16x16x32_bf16 v[68:71], a[220:223], v[160:163], v[68:71]
  v_add_u32 v18, s33, v14
  v_mfma_f32_16x16x32_bf16 v[72:75], a[224:227], v[160:163], v[72:75]
  v_mfma_f32_16x16x32_bf16 v[76:79], a[216:219], v[164:167], v[76:79]
  ds_read_b128 v[196:199], v19 offset:2048
  v_mfma_f32_16x16x32_bf16 v[80:83], a[220:223], v[164:167], v[80:83]
  buffer_load_dwordx4 v12, s[8:11], s30 offen offset:2048 lds
  v_mfma_f32_16x16x32_bf16 v[84:87], a[224:227], v[164:167], v[84:87]
  v_mfma_f32_16x16x32_bf16 v[88:91], a[216:219], v[168:171], v[88:91]
  ds_read_b128 v[200:203], v19 offset:4096
  v_mfma_f32_16x16x32_bf16 v[92:95], a[220:223], v[168:171], v[92:95]
  v_mfma_f32_16x16x32_bf16 v[96:99], a[224:227], v[168:171], v[96:99]
  v_mfma_f32_16x16x32_bf16 v[100:103], a[216:219], v[172:175], v[100:103]
  ds_read_b128 v[204:207], v19 offset:6144
  v_mfma_f32_16x16x32_bf16 v[104:107], a[220:223], v[172:175], v[104:107]
  v_mfma_f32_16x16x32_bf16 v[108:111], a[224:227], v[172:175], v[108:111]
  s_waitcnt lgkmcnt(4)
  v_mfma_f32_16x16x32_bf16 v[112:115], a[216:219], v[176:179], v[112:115]
  ds_read_b128 v[208:211], v19 offset:8192
  v_mfma_f32_16x16x32_bf16 v[116:119], a[220:223], v[176:179], v[116:119]
  v_mfma_f32_16x16x32_bf16 v[120:123], a[224:227], v[176:179], v[120:123]
  v_mfma_f32_16x16x32_bf16 v[124:127], a[216:219], v[180:183], v[124:127]
  ds_read_b128 v[212:215], v19 offset:10240
  v_mfma_f32_16x16x32_bf16 v[128:131], a[220:223], v[180:183], v[128:131]
  buffer_load_dwordx4 v13, s[8:11], s30 offen offset:3072 lds
  v_mfma_f32_16x16x32_bf16 v[132:135], a[224:227], v[180:183], v[132:135]
  s_add_u32 s30, s30, 128
  s_add_u32 m0, m0, 16384
  v_mfma_f32_16x16x32_bf16 v[136:139], a[216:219], v[184:187], v[136:139]
  ds_read_b128 v[216:219], v19 offset:12288
  v_mfma_f32_16x16x32_bf16 v[140:143], a[220:223], v[184:187], v[140:143]
  s_cmp_lt_u32 m0, s46
  s_cselect_b32 m0, m0, s47
  v_mfma_f32_16x16x32_bf16 v[144:147], a[224:227], v[184:187], v[144:147]
  v_mfma_f32_16x16x32_bf16 v[148:151], a[216:219], v[188:191], v[148:151]
  ds_read_b128 v[220:223], v19 offset:14336
  v_mfma_f32_16x16x32_bf16 v[152:155], a[220:223], v[188:191], v[152:155]
  v_mfma_f32_16x16x32_bf16 v[156:159], a[224:227], v[188:191], v[156:159]
  s_waitcnt vmcnt(25) lgkmcnt(4)
  s_barrier
  v_mfma_f32_16x16x32_bf16 v[64:67], a[228:231], v[192:195], v[64:67]
  ds_read_b128 v[160:163], v18 offset:0
  v_mfma_f32_16x16x32_bf16 v[68:71], a[232:235], v[192:195], v[68:71]
  v_mfma_f32_16x16x32_bf16 v[72:75], a[236:239], v[192:195], v[72:75]
  v_add_u32 v19, s33, v15
  s_add_u32 s33, s33, 16384
  v_mfma_f32_16x16x32_bf16 v[76:79], a[228:231], v[196:199], v[76:79]
  ds_read_b128 v[164:167], v18 offset:2048
  v_cvt_pk_bf16_f32 v224, v64, v65
  v_cvt_pk_bf16_f32 v225, v66, v67
  v_mfma_f32_16x16x32_bf16 v[80:83], a[232:235], v[196:199], v[80:83]
  buffer_load_dwordx4 v10, s[8:11], s30 offen offset:0 lds
  v_cvt_pk_bf16_f32 v226, v68, v69
  v_cvt_pk_bf16_f32 v227, v70, v71
  v_mfma_f32_16x16x32_bf16 v[84:87], a[236:239], v[196:199], v[84:87]
  s_cmp_lt_u32 s33, 98304
  s_cselect_b32 s33, s33, 0
  v_cvt_pk_bf16_f32 v228, v72, v73
  v_cvt_pk_bf16_f32 v229, v74, v75
  v_mfma_f32_16x16x32_bf16 v[88:91], a[228:231], v[200:203], v[88:91]
  ds_read_b128 v[168:171], v18 offset:4096
  ds_write_b64 v22, v[224:225] offset:0
  ds_write_b64 v22, v[226:227] offset:8
  ds_write_b64 v22, v[228:229] offset:16
  v_mfma_f32_16x16x32_bf16 v[92:95], a[232:235], v[200:203], v[92:95]
  v_cvt_pk_bf16_f32 v230, v76, v77
  v_cvt_pk_bf16_f32 v231, v78, v79
  v_cvt_pk_bf16_f32 v232, v80, v81
  v_cvt_pk_bf16_f32 v233, v82, v83
  v_mfma_f32_16x16x32_bf16 v[96:99], a[236:239], v[200:203], v[96:99]
  v_cvt_pk_bf16_f32 v234, v84, v85
  v_cvt_pk_bf16_f32 v235, v86, v87
  ds_write_b64 v22, v[230:231] offset:6400
  ds_write_b64 v22, v[232:233] offset:6408
  v_mfma_f32_16x16x32_bf16 v[100:103], a[228:231], v[204:207], v[100:103]
  ds_read_b128 v[172:175], v18 offset:6144
  ds_write_b64 v22, v[234:235] offset:6416
  v_cvt_pk_bf16_f32 v224, v88, v89
  v_cvt_pk_bf16_f32 v225, v90, v91
  v_mfma_f32_16x16x32_bf16 v[104:107], a[232:235], v[204:207], v[104:107]
  v_cvt_pk_bf16_f32 v226, v92, v93
  v_cvt_pk_bf16_f32 v227, v94, v95
  v_mfma_f32_16x16x32_bf16 v[108:111], a[236:239], v[204:207], v[108:111]
  s_waitcnt lgkmcnt(10)
  v_cvt_pk_bf16_f32 v228, v96, v97
  v_cvt_pk_bf16_f32 v229, v98, v99
  ds_write_b64 v22, v[224:225] offset:12800
  v_mfma_f32_16x16x32_bf16 v[112:115], a[228:231], v[208:211], v[112:115]
  ds_read_b128 v[176:179], v18 offset:8192
  ds_write_b64 v22, v[226:227] offset:12808
  ds_write_b64 v22, v[228:229] offset:12816
  v_cvt_pk_bf16_f32 v230, v100, v101
  v_mfma_f32_16x16x32_bf16 v[116:119], a[232:235], v[208:211], v[116:119]
  v_cvt_pk_bf16_f32 v231, v102, v103
  v_cvt_pk_bf16_f32 v232, v104, v105
  v_cvt_pk_bf16_f32 v233, v106, v107
  v_mfma_f32_16x16x32_bf16 v[120:123], a[236:239], v[208:211], v[120:123]
  v_cvt_pk_bf16_f32 v234, v108, v109
  v_cvt_pk_bf16_f32 v235, v110, v111
  ds_write_b64 v22, v[230:231] offset:19200
  ds_write_b64 v22, v[232:233] offset:19208
  v_mfma_f32_16x16x32_bf16 v[124:127], a[228:231], v[212:215], v[124:127]
  ds_read_b128 v[180:183], v18 offset:10240
  ds_write_b64 v22, v[234:235] offset:19216
  v_cvt_pk_bf16_f32 v224, v112, v113
  v_cvt_pk_bf16_f32 v225, v114, v115
  v_mfma_f32_16x16x32_bf16 v[128:131], a[232:235], v[212:215], v[128:131]
  buffer_load_dwordx4 v11, s[8:11], s30 offen offset:1024 lds
  v_cvt_pk_bf16_f32 v226, v116, v117
  v_cvt_pk_bf16_f32 v227, v118, v119
  v_mfma_f32_16x16x32_bf16 v[132:135], a[236:239], v[212:215], v[132:135]
  v_cvt_pk_bf16_f32 v228, v120, v121
  v_cvt_pk_bf16_f32 v229, v122, v123
  ds_write_b64 v22, v[224:225] offset:25600
  ds_write_b64 v22, v[226:227] offset:25608
  v_mfma_f32_16x16x32_bf16 v[136:139], a[228:231], v[216:219], v[136:139]
  ds_read_b128 v[184:187], v18 offset:12288
  ds_write_b64 v22, v[228:229] offset:25616
  v_cvt_pk_bf16_f32 v230, v124, v125
  v_cvt_pk_bf16_f32 v231, v126, v127
  v_mfma_f32_16x16x32_bf16 v[140:143], a[232:235], v[216:219], v[140:143]
  v_cvt_pk_bf16_f32 v232, v128, v129
  v_cvt_pk_bf16_f32 v233, v130, v131
  v_mfma_f32_16x16x32_bf16 v[144:147], a[236:239], v[216:219], v[144:147]
  v_cvt_pk_bf16_f32 v234, v132, v133
  v_cvt_pk_bf16_f32 v235, v134, v135
  ds_write_b64 v22, v[230:231] offset:32000
  ds_write_b64 v22, v[232:233] offset:32008
  v_mfma_f32_16x16x32_bf16 v[148:151], a[228:231], v[220:223], v[148:151]
  ds_read_b128 v[188:191], v18 offset:14336
  ds_write_b64 v22, v[234:235] offset:32016
  v_cvt_pk_bf16_f32 v224, v136, v137
  v_cvt_pk_bf16_f32 v225, v138, v139
  v_mfma_f32_16x16x32_bf16 v[152:155], a[232:235], v[220:223], v[152:155]
  v_cvt_pk_bf16_f32 v226, v140, v141
  v_cvt_pk_bf16_f32 v227, v142, v143
  v_mfma_f32_16x16x32_bf16 v[156:159], a[236:239], v[220:223], v[156:159]
  v_cvt_pk_bf16_f32 v228, v144, v145
  v_cvt_pk_bf16_f32 v229, v146, v147
  ds_write_b64 v22, v[224:225] offset:38400
  ds_write_b64 v22, v[226:227] offset:38408
  ds_write_b64 v22, v[228:229] offset:38416
  s_nop 2
  v_cvt_pk_bf16_f32 v230, v148, v149
  v_cvt_pk_bf16_f32 v231, v150, v151
  v_cvt_pk_bf16_f32 v232, v152, v153
  v_cvt_pk_bf16_f32 v233, v154, v155
  v_cvt_pk_bf16_f32 v234, v156, v157
  v_cvt_pk_bf16_f32 v235, v158, v159
  ds_write_b64 v22, v[230:231] offset:44800
  ds_write_b64 v22, v[232:233] offset:44808
  ds_write_b64 v22, v[234:235] offset:44816
  s_add_u32 s23, s49, 1
  s_waitcnt vmcnt(6)
  v_cmp_gt_u32 vcc, s23, v21
  s_mov_b32 s80, 0
  s_nop 0
  s_cbranch_vccnz qk_218
  s_mov_b32 s80, 1
  buffer_load_dwordx4 v[132:135], v31, s[52:55], s51 offen offset:0 sc1
  buffer_load_dwordx4 v[136:139], v31, s[52:55], s51 offen offset:512 sc1
  buffer_load_dwordx4 v[140:143], v31, s[52:55], s51 offen offset:1024 sc1
  buffer_load_dwordx4 v[144:147], v31, s[52:55], s51 offen offset:1536 sc1
  buffer_load_dwordx4 v[148:151], v31, s[52:55], s51 offen offset:2048 sc1
  buffer_load_dwordx4 v[152:155], v31, s[52:55], s51 offen offset:2560 sc1
qk_218:
  s_cmp_ge_u32 s79, 8
  s_cbranch_scc1 qk_217
  v_mov_b32 v156, 0
  s_mov_b32 s101, 0
wf_219:
  buffer_load_dword v157, v156, s[72:75], s76 offen sc1
  s_add_u32 s101, s101, 1
  s_cmp_gt_u32 s101, 131072
  s_cbranch_scc1 main_end
  s_waitcnt vmcnt(0)
  v_readfirstlane_b32 s100, v157
  s_cmp_ge_u32 s100, 8
  s_cbranch_scc1 wf_220
  s_sleep 2
  s_branch wf_219
wf_220:
  s_add_u32 s21, s50, 0
  buffer_load_dwordx4 v[36:39], v30, s[16:19], s21 offen offset:0 sc1
  buffer_load_dwordx4 v[40:43], v30, s[16:19], s21 offen offset:1024 sc1
  buffer_load_dwordx4 v[44:47], v30, s[16:19], s21 offen offset:2048 sc1
  buffer_load_dwordx4 v[48:51], v30, s[16:19], s21 offen offset:3072 sc1
  s_add_u32 s21, s50, 4096
  buffer_load_dwordx4 v[52:55], v30, s[16:19], s21 offen offset:0 sc1
  buffer_load_dwordx4 v[56:59], v30, s[16:19], s21 offen offset:1024 sc1
  buffer_load_dwordx4 v[60:63], v30, s[16:19], s21 offen offset:2048 sc1
  buffer_load_dwordx4 v[236:239], v30, s[16:19], s21 offen offset:3072 sc1
  s_add_u32 s21, s50, 8192
  buffer_load_dwordx4 v[240:243], v30, s[16:19], s21 offen offset:0 sc1
  buffer_load_dwordx4 v[244:247], v30, s[16:19], s21 offen offset:1024 sc1
  buffer_load_dwordx4 v[248:251], v30, s[16:19], s21 offen offset:2048 sc1
  buffer_load_dwordx4 v[252:255], v30, s[16:19], s21 offen offset:3072 sc1
qk_217:
  s_waitcnt lgkmcnt(0)
  s_barrier
  ds_read_b128 v[64:67], v29 offset:0
  ds_read_b128 v[68:71], v29 offset:64
  ds_read_b128 v[72:75], v29 offset:128
  ds_read_b128 v[76:79], v29 offset:192
  ds_read_b128 v[80:83], v29 offset:256
  ds_read_b128 v[84:87], v29 offset:320
  ds_read_b128 v[88:91], v29 offset:6400
  ds_read_b128 v[92:95], v29 offset:6464
  ds_read_b128 v[96:99], v29 offset:6528
  ds_read_b128 v[100:103], v29 offset:6592
  ds_read_b128 v[104:107], v29 offset:6656
  ds_read_b128 v[108:111], v29 offset:6720
  s_waitcnt lgkmcnt(0)
  s_cmp_eq_u32 s80, 1
  s_cselect_b32 s21, s79, 0
  s_cmp_ge_u32 s21, 8
  s_cbranch_scc1 qw_221
  s_waitcnt vmcnt(0)
qw_221:
  v_mfma_f32_16x16x32_bf16 v[112:115], v[36:39], v[64:67], 0
  v_mfma_f32_16x16x32_bf16 v[120:123], v[36:39], v[88:91], 0
  v_mfma_f32_16x16x32_bf16 v[124:127], v[60:63], v[88:91], 0
  v_mfma_f32_16x16x32_bf16 v[112:115], v[40:43], v[68:71], v[112:115]
  v_mfma_f32_16x16x32_bf16 v[120:123], v[40:43], v[92:95], v[120:123]
  v_mfma_f32_16x16x32_bf16 v[124:127], v[236:239], v[92:95], v[124:127]
  v_mfma_f32_16x16x32_bf16 v[112:115], v[44:47], v[72:75], v[112:115]
  v_mfma_f32_16x16x32_bf16 v[120:123], v[44:47], v[96:99], v[120:123]
  v_mfma_f32_16x16x32_bf16 v[124:127], v[240:243], v[96:99], v[124:127]
  v_mfma_f32_16x16x32_bf16 v[112:115], v[48:51], v[76:79], v[112:115]
  v_mfma_f32_16x16x32_bf16 v[120:123], v[48:51], v[100:103], v[120:123]
  v_mfma_f32_16x16x32_bf16 v[124:127], v[244:247], v[100:103], v[124:127]
  v_mfma_f32_16x16x32_bf16 v[112:115], v[52:55], v[80:83], v[112:115]
  v_mfma_f32_16x16x32_bf16 v[120:123], v[52:55], v[104:107], v[120:123]
  v_mfma_f32_16x16x32_bf16 v[124:127], v[248:251], v[104:107], v[124:127]
  v_mfma_f32_16x16x32_bf16 v[112:115], v[56:59], v[84:87], v[112:115]
  v_mfma_f32_16x16x32_bf16 v[120:123], v[56:59], v[108:111], v[120:123]
  v_mfma_f32_16x16x32_bf16 v[124:127], v[252:255], v[108:111], v[124:127]
  s_cmp_eq_u32 s80, 1
  s_cbranch_scc1 qm_222
  s_add_u32 s23, s49, 1
  s_mov_b32 s101, 0
wm_223:
  buffer_load_dword v156, v33, s[72:75], s77 offen sc1
  s_add_u32 s101, s101, 1
  s_cmp_gt_u32 s101, 131072
  s_cbranch_scc1 main_end
  s_waitcnt vmcnt(0)
  v_cmp_gt_u32 vcc, s23, v156
  v_readfirstlane_b32 s100, v156
  s_nop 0
  s_cbranch_vccz wm_224
  s_sleep 4
  s_add_u32 s100, s100, 2
  s_cmp_ge_u32 s100, s23
  s_cbranch_scc1 wm_223
  s_sleep 90
  s_branch wm_223
wm_224:
  buffer_load_dwordx4 v[132:135], v31, s[52:55], s51 offen offset:0 sc1
  buffer_load_dwordx4 v[136:139], v31, s[52:55], s51 offen offset:512 sc1
  buffer_load_dwordx4 v[140:143], v31, s[52:55], s51 offen offset:1024 sc1
  buffer_load_dwordx4 v[144:147], v31, s[52:55], s51 offen offset:1536 sc1
  buffer_load_dwordx4 v[148:151], v31, s[52:55], s51 offen offset:2048 sc1
  buffer_load_dwordx4 v[152:155], v31, s[52:55], s51 offen offset:2560 sc1
qm_222:
  s_waitcnt vmcnt(0)
  v_mfma_f32_16x16x32_bf16 v[116:119], v[132:135], v[64:67], 0
  v_mfma_f32_16x16x32_bf16 v[128:131], v[132:135], v[88:91], 0
  v_mfma_f32_16x16x32_bf16 v[116:119], v[136:139], v[68:71], v[116:119]
  v_mfma_f32_16x16x32_bf16 v[128:131], v[136:139], v[92:95], v[128:131]
  v_mfma_f32_16x16x32_bf16 v[116:119], v[140:143], v[72:75], v[116:119]
  v_mfma_f32_16x16x32_bf16 v[128:131], v[140:143], v[96:99], v[128:131]
  v_mfma_f32_16x16x32_bf16 v[116:119], v[144:147], v[76:79], v[116:119]
  v_mfma_f32_16x16x32_bf16 v[128:131], v[144:147], v[100:103], v[128:131]
  v_mfma_f32_16x16x32_bf16 v[116:119], v[148:151], v[80:83], v[116:119]
  v_mfma_f32_16x16x32_bf16 v[128:131], v[148:151], v[104:107], v[128:131]
  v_mfma_f32_16x16x32_bf16 v[116:119], v[152:155], v[84:87], v[116:119]
  v_mfma_f32_16x16x32_bf16 v[128:131], v[152:155], v[108:111], v[128:131]
  s_lshl_b32 s21, s49, 5
  s_add_u32 s21, s21, s42
  s_mul_i32 s81, s21, 2560
  s_lshl_b32 s82, s49, 3
  s_and_b32 s21, s42, 7
  s_add_u32 s82, s82, s21
  s_lshl_b32 s82, s82, 7
  s_add_u32 s82, s82, 24576
  s_cmp_gt_u32 s26, 1
  s_cselect_b32 s21, s80, 0
  s_cmp_eq_u32 s21, 0
  s_cbranch_scc1 qi_226
  v_mov_b32 v36, v112
  v_mov_b32 v37, v113
  v_mov_b32 v38, v114
  v_mov_b32 v39, v115
  v_mov_b32 v40, v116
  v_mov_b32 v41, v117
  v_mov_b32 v42, v118
  v_mov_b32 v43, v119
  v_mov_b32 v44, v120
  v_mov_b32 v45, v121
  v_mov_b32 v46, v122
  v_mov_b32 v47, v123
  v_mov_b32 v48, v124
  v_mov_b32 v49, v125
  v_mov_b32 v50, v126
  v_mov_b32 v51, v127
  v_mov_b32 v52, v128
  v_mov_b32 v53, v129
  v_mov_b32 v54, v130
  v_mov_b32 v55, v131
  s_branch qd_225
qi_226:
  v_cndmask_b32 v112, v34, v112, s[64:65]
  v_cndmask_b32 v124, v34, v124, s[64:65]
  v_cndmask_b32 v113, v34, v113, s[66:67]
  v_cndmask_b32 v125, v34, v125, s[66:67]
  v_cndmask_b32 v114, v34, v114, s[68:69]
  v_cndmask_b32 v126, v34, v126, s[68:69]
  v_cndmask_b32 v115, v34, v115, s[70:71]
  v_cndmask_b32 v127, v34, v127, s[70:71]
  v_max3_f32 v156, v112, v113, v114
  v_max3_f32 v156, v156, v115, v116
  v_max3_f32 v156, v156, v117, v118
  v_max_f32 v156, v156, v119
  v_mov_b32 v157, v156
  s_nop 1
  v_permlane32_swap_b32 v156, v157
  v_max_f32 v156, v156, v157
  v_mov_b32 v157, v156
  s_nop 1
  v_permlane16_swap_b32 v156, v157
  v_max_f32 v156, v156, v157
  v_mul_f32 v156, s83, v156
  v_fma_f32 v112, v112, s83, -v156
  v_fma_f32 v113, v113, s83, -v156
  v_fma_f32 v114, v114, s83, -v156
  v_fma_f32 v115, v115, s83, -v156
  v_fma_f32 v116, v116, s83, -v156
  v_fma_f32 v117, v117, s83, -v156
  v_fma_f32 v118, v118, s83, -v156
  v_fma_f32 v119, v119, s83, -v156
  v_exp_f32 v112, v112
  v_exp_f32 v113, v113
  v_exp_f32 v114, v114
  v_exp_f32 v115, v115
  v_exp_f32 v116, v116
  v_exp_f32 v117, v117
  v_exp_f32 v118, v118
  v_exp_f32 v119, v119
  s_nop 0
  v_add_f32 v156, v116, v117
  v_add_f32 v156, v156, v118
  v_add_f32 v156, v156, v119
  v_cndmask_b32 v156, 0, v156, s[60:61]
  v_add_f32 v156, v156, v112
  v_add_f32 v156, v156, v113
  v_add_f32 v156, v156, v114
  v_add_f32 v156, v156, v115
  v_mov_b32 v157, v156
  s_nop 1
  v_permlane32_swap_b32 v156, v157
  v_add_f32 v156, v156, v157
  v_mov_b32 v157, v156
  s_nop 1
  v_permlane16_swap_b32 v156, v157
  v_add_f32 v156, v156, v157
  v_rcp_f32 v156, v156
  s_nop 0
  v_mul_f32 v112, v112, v156
  v_mul_f32 v113, v113, v156
  v_mul_f32 v114, v114, v156
  v_mul_f32 v115, v115, v156
  v_mul_f32 v116, v116, v156
  v_mul_f32 v117, v117, v156
  v_mul_f32 v118, v118, v156
  v_mul_f32 v119, v119, v156
  v_max3_f32 v156, v120, v121, v122
  v_max3_f32 v156, v156, v123, v124
  v_max3_f32 v156, v156, v125, v126
  v_max3_f32 v156, v156, v127, v128
  v_max3_f32 v156, v156, v129, v130
  v_max_f32 v156, v156, v131
  v_mov_b32 v157, v156
  s_nop 1
  v_permlane32_swap_b32 v156, v157
  v_max_f32 v156, v156, v157
  v_mov_b32 v157, v156
  s_nop 1
  v_permlane16_swap_b32 v156, v157
  v_max_f32 v156, v156, v157
  v_mul_f32 v156, s83, v156
  v_fma_f32 v120, v120, s83, -v156
  v_fma_f32 v121, v121, s83, -v156
  v_fma_f32 v122, v122, s83, -v156
  v_fma_f32 v123, v123, s83, -v156
  v_fma_f32 v124, v124, s83, -v156
  v_fma_f32 v125, v125, s83, -v156
  v_fma_f32 v126, v126, s83, -v156
  v_fma_f32 v127, v127, s83, -v156
  v_fma_f32 v128, v128, s83, -v156
  v_fma_f32 v129, v129, s83, -v156
  v_fma_f32 v130, v130, s83, -v156
  v_fma_f32 v131, v131, s83, -v156
  v_exp_f32 v120, v120
  v_exp_f32 v121, v121
  v_exp_f32 v122, v122
  v_exp_f32 v123, v123
  v_exp_f32 v124, v124
  v_exp_f32 v125, v125
  v_exp_f32 v126, v126
  v_exp_f32 v127, v127
  v_exp_f32 v128, v128
  v_exp_f32 v129, v129
  v_exp_f32 v130, v130
  v_exp_f32 v131, v131
  s_nop 0
  v_add_f32 v156, v128, v129
  v_add_f32 v156, v156, v130
  v_add_f32 v156, v156, v131
  v_cndmask_b32 v156, 0, v156, s[60:61]
  v_add_f32 v156, v156, v120
  v_add_f32 v156, v156, v121
  v_add_f32 v156, v156, v122
  v_add_f32 v156, v156, v123
  v_add_f32 v156, v156, v124
  v_add_f32 v156, v156, v125
  v_add_f32 v156, v156, v126
  v_add_f32 v156, v156, v127
  v_mov_b32 v157, v156
  s_nop 1
  v_permlane32_swap_b32 v156, v157
  v_add_f32 v156, v156, v157
  v_mov_b32 v157, v156
  s_nop 1
  v_permlane16_swap_b32 v156, v157
  v_add_f32 v156, v156, v157
  v_rcp_f32 v156, v156
  s_nop 0
  v_mul_f32 v120, v120, v156
  v_mul_f32 v121, v121, v156
  v_mul_f32 v122, v122, v156
  v_mul_f32 v123, v123, v156
  v_mul_f32 v124, v124, v156
  v_mul_f32 v125, v125, v156
  v_mul_f32 v126, v126, v156
  v_mul_f32 v127, v127, v156
  v_mul_f32 v128, v128, v156
  v_mul_f32 v129, v129, v156
  v_mul_f32 v130, v130, v156
  v_mul_f32 v131, v131, v156
  v_cvt_pk_bf16_f32 v192, v120, v121
  v_cvt_pk_bf16_f32 v193, v122, v123
  v_cvt_pk_bf16_f32 v194, v124, v125
  v_cvt_pk_bf16_f32 v195, v126, v127
  v_cvt_pk_bf16_f32 v196, v116, v117
  v_cvt_pk_bf16_f32 v197, v118, v119
  v_cvt_pk_bf16_f32 v198, v128, v129
  v_cvt_pk_bf16_f32 v199, v130, v131
  v_cvt_pk_bf16_f32 v200, v112, v113
  v_cvt_pk_bf16_f32 v201, v114, v115
  buffer_store_dwordx4 v[192:195], v30, s[56:59], s81 offen sc1
  buffer_store_dwordx4 v[196:199], v30, s[56:59], s81 offen offset:1024 sc1
  buffer_store_dwordx2 v[200:201], v32, s[56:59], s81 offen offset:2048 sc1
  s_mov_b32 s78, s82
  s_mov_b32 s81, 0x80000000
  s_mov_b32 s82, 0
  s_cmp_eq_u32 s80, 1
  s_cbranch_scc1 qd_225
  s_waitcnt vmcnt(0)
  s_cmp_eq_u32 s78, 0
  s_cbranch_scc1 pf_227
  v_mov_b32 v4, 0
  v_mov_b32 v5, 1
  s_mov_b64 exec, 1
  buffer_atomic_add v5, v4, s[72:75], s78 offen sc1
  s_mov_b64 exec, -1
  s_mov_b32 s78, 0
pf_227:
qd_225:
  s_add_u32 s49, s49, s29
qbe_216:
  s_sub_u32 s26, s26, 1
  s_cmp_gt_u32 s26, 0
  s_waitcnt lgkmcnt(0)
  s_cbranch_scc1 qa_blk_215
  s_waitcnt vmcnt(0) lgkmcnt(0)
  s_add_u32 s12, s38, 62914560
  s_addc_u32 s13, s39, 0
  s_mov_b32 s14, 4718592
  s_mov_b32 s15, 0x00020000
qf_228:
  s_waitcnt vmcnt(0)
  s_cmp_eq_u32 s78, 0
  s_cbranch_scc1 pf_230
  v_mov_b32 v4, 0
  v_mov_b32 v5, 1
  s_mov_b64 exec, 1
  buffer_atomic_add v5, v4, s[72:75], s78 offen sc1
  s_mov_b64 exec, -1
  s_mov_b32 s78, 0
pf_230:
  s_mul_i32 s21, s49, 393216
  s_mul_i32 s22, s42, 12288
  s_add_u32 s50, s21, s22
  s_mul_i32 s21, s49, 98304
  s_mul_i32 s22, s42, 3072
  s_add_u32 s51, s21, s22
  s_lshr_b32 s22, s49, 1
  s_lshr_b32 s21, s49, 2
  s_add_u32 s21, s21, 4
  s_cmp_lt_u32 s49, 16
  s_cselect_b32 s21, s22, s21
  s_lshl_b32 s21, s21, 3
  s_lshr_b32 s22, s42, 2
  s_add_u32 s21, s21, s22
  s_lshl_b32 s21, s21, 7
  s_add_u32 s76, s21, 0
  s_lshl_b32 s77, s42, 7
  s_add_u32 s77, s77, 20480
  v_mov_b32 v156, 0
  s_mov_b32 s101, 0
wf_231:
  buffer_load_dword v157, v156, s[72:75], s76 offen sc1
  s_add_u32 s101, s101, 1
  s_cmp_gt_u32 s101, 131072
  s_cbranch_scc1 main_end
  s_waitcnt vmcnt(0)
  v_readfirstlane_b32 s100, v157
  s_cmp_ge_u32 s100, 8
  s_cbranch_scc1 wf_232
  s_sleep 2
  s_branch wf_231
wf_232:
  s_lshr_b32 s23, s49, 2
  s_sub_u32 s23, s23, 12
  s_lshl_b32 s21, s42, 7
  s_add_u32 s21, s21, 113664
  s_sub_u32 s43, s50, 20447232
  v_mov_b32 v156, 0
  s_mov_b32 s101, 0
wf_233:
  buffer_load_dword v157, v156, s[72:75], s21 offen sc1
  s_add_u32 s101, s101, 1
  s_cmp_gt_u32 s101, 131072
  s_cbranch_scc1 main_end
  s_waitcnt vmcnt(0)
  v_readfirstlane_b32 s100, v157
  s_cmp_ge_u32 s100, s23
  s_cbranch_scc1 wf_234
  s_sleep 16
  s_branch wf_233
wf_234:
  s_add_u32 s21, s50, 0
  buffer_load_dwordx4 v[36:39], v30, s[16:19], s21 offen offset:0 sc1
  buffer_load_dwordx4 v[40:43], v30, s[16:19], s21 offen offset:1024 sc1
  buffer_load_dwordx4 v[44:47], v30, s[16:19], s21 offen offset:2048 sc1
  buffer_load_dwordx4 v[48:51], v30, s[16:19], s21 offen offset:3072 sc1
  s_add_u32 s21, s50, 4096
  buffer_load_dwordx4 v[52:55], v30, s[16:19], s21 offen offset:0 sc1
  buffer_load_dwordx4 v[56:59], v30, s[16:19], s21 offen offset:1024 sc1
  buffer_load_dwordx4 v[60:63], v30, s[16:19], s21 offen offset:2048 sc1
  buffer_load_dwordx4 v[236:239], v30, s[16:19], s21 offen offset:3072 sc1
  s_add_u32 s21, s50, 8192
  buffer_load_dwordx4 v[240:243], v30, s[16:19], s21 offen offset:0 sc1
  buffer_load_dwordx4 v[244:247], v30, s[16:19], s21 offen offset:1024 sc1
  buffer_load_dwordx4 v[248:251], v30, s[16:19], s21 offen offset:2048 sc1
  buffer_load_dwordx4 v[252:255], v30, s[16:19], s21 offen offset:3072 sc1
  s_add_u32 s21, s43, 0
  buffer_load_dwordx4 v[64:67], v30, s[12:15], s21 offen offset:0 sc1
  buffer_load_dwordx4 v[68:71], v30, s[12:15], s21 offen offset:1024 sc1
  buffer_load_dwordx4 v[72:75], v30, s[12:15], s21 offen offset:2048 sc1
  buffer_load_dwordx4 v[76:79], v30, s[12:15], s21 offen offset:3072 sc1
  s_add_u32 s21, s43, 4096
  buffer_load_dwordx4 v[80:83], v30, s[12:15], s21 offen offset:0 sc1
  buffer_load_dwordx4 v[84:87], v30, s[12:15], s21 offen offset:1024 sc1
  buffer_load_dwordx4 v[88:91], v30, s[12:15], s21 offen offset:2048 sc1
  buffer_load_dwordx4 v[92:95], v30, s[12:15], s21 offen offset:3072 sc1
  s_add_u32 s21, s43, 8192
  buffer_load_dwordx4 v[96:99], v30, s[12:15], s21 offen offset:0 sc1
  buffer_load_dwordx4 v[100:103], v30, s[12:15], s21 offen offset:1024 sc1
  buffer_load_dwordx4 v[104:107], v30, s[12:15], s21 offen offset:2048 sc1
  buffer_load_dwordx4 v[108:111], v30, s[12:15], s21 offen offset:3072 sc1
  s_mov_b32 s80, 0
  s_waitcnt vmcnt(0)
  v_mfma_f32_16x16x32_bf16 v[112:115], v[36:39], v[64:67], 0
  v_mfma_f32_16x16x32_bf16 v[120:123], v[36:39], v[88:91], 0
  v_mfma_f32_16x16x32_bf16 v[124:127], v[60:63], v[88:91], 0
  v_mfma_f32_16x16x32_bf16 v[112:115], v[40:43], v[68:71], v[112:115]
  v_mfma_f32_16x16x32_bf16 v[120:123], v[40:43], v[92:95], v[120:123]
  v_mfma_f32_16x16x32_bf16 v[124:127], v[236:239], v[92:95], v[124:127]
  v_mfma_f32_16x16x32_bf16 v[112:115], v[44:47], v[72:75], v[112:115]
  v_mfma_f32_16x16x32_bf16 v[120:123], v[44:47], v[96:99], v[120:123]
  v_mfma_f32_16x16x32_bf16 v[124:127], v[240:243], v[96:99], v[124:127]
  v_mfma_f32_16x16x32_bf16 v[112:115], v[48:51], v[76:79], v[112:115]
  v_mfma_f32_16x16x32_bf16 v[120:123], v[48:51], v[100:103], v[120:123]
  v_mfma_f32_16x16x32_bf16 v[124:127], v[244:247], v[100:103], v[124:127]
  v_mfma_f32_16x16x32_bf16 v[112:115], v[52:55], v[80:83], v[112:115]
  v_mfma_f32_16x16x32_bf16 v[120:123], v[52:55], v[104:107], v[120:123]
  v_mfma_f32_16x16x32_bf16 v[124:127], v[248:251], v[104:107], v[124:127]
  v_mfma_f32_16x16x32_bf16 v[112:115], v[56:59], v[84:87], v[112:115]
  v_mfma_f32_16x16x32_bf16 v[120:123], v[56:59], v[108:111], v[120:123]
  v_mfma_f32_16x16x32_bf16 v[124:127], v[252:255], v[108:111], v[124:127]
  s_cmp_eq_u32 s80, 1
  s_cbranch_scc1 qm_235
  s_add_u32 s23, s49, 1
  s_min_u32 s23, s49, 62
  s_mov_b32 s101, 0
wm_236:
  buffer_load_dword v156, v33, s[72:75], s77 offen sc1
  s_add_u32 s101, s101, 1
  s_cmp_gt_u32 s101, 131072
  s_cbranch_scc1 main_end
  s_waitcnt vmcnt(0)
  v_cmp_gt_u32 vcc, s23, v156
  v_readfirstlane_b32 s100, v156
  s_nop 0
  s_cbranch_vccz wm_237
  s_sleep 4
  s_add_u32 s100, s100, 2
  s_cmp_ge_u32 s100, s23
  s_cbranch_scc1 wm_236
  s_sleep 90
  s_branch wm_236
wm_237:
  s_mov_b32 s101, 0
  s_branch qtp_239
qtp_238:
  s_sleep 3
qtp_239:
  buffer_load_dwordx4 v[132:135], v31, s[52:55], s51 offen offset:0 sc1
  buffer_load_dwordx4 v[136:139], v31, s[52:55], s51 offen offset:512 sc1
  buffer_load_dwordx4 v[140:143], v31, s[52:55], s51 offen offset:1024 sc1
  buffer_load_dwordx4 v[144:147], v31, s[52:55], s51 offen offset:1536 sc1
  buffer_load_dwordx4 v[148:151], v31, s[52:55], s51 offen offset:2048 sc1
  buffer_load_dwordx4 v[152:155], v31, s[52:55], s51 offen offset:2560 sc1
  s_add_u32 s101, s101, 1
  s_cmp_gt_u32 s101, 131072
  s_cbranch_scc1 main_end
  s_waitcnt vmcnt(0)
  v_max3_u32 v156, v132, v134, v136
  v_max3_u32 v156, v156, v138, v140
  v_max3_u32 v156, v156, v142, v144
  v_max3_u32 v156, v156, v146, v148
  v_max3_u32 v156, v156, v150, v152
  v_max3_u32 v156, v156, v154, v154
  v_cmp_eq_u32 vcc, -1, v156
  s_nop 1
  s_cbranch_vccnz qtp_238
qm_235:
  s_waitcnt vmcnt(0)
  v_mfma_f32_16x16x32_bf16 v[116:119], v[132:135], v[64:67], 0
  v_mfma_f32_16x16x32_bf16 v[128:131], v[132:135], v[88:91], 0
  v_mfma_f32_16x16x32_bf16 v[116:119], v[136:139], v[68:71], v[116:119]
  v_mfma_f32_16x16x32_bf16 v[128:131], v[136:139], v[92:95], v[128:131]
  v_mfma_f32_16x16x32_bf16 v[116:119], v[140:143], v[72:75], v[116:119]
  v_mfma_f32_16x16x32_bf16 v[128:131], v[140:143], v[96:99], v[128:131]
  v_mfma_f32_16x16x32_bf16 v[116:119], v[144:147], v[76:79], v[116:119]
  v_mfma_f32_16x16x32_bf16 v[128:131], v[144:147], v[100:103], v[128:131]
  v_mfma_f32_16x16x32_bf16 v[116:119], v[148:151], v[80:83], v[116:119]
  v_mfma_f32_16x16x32_bf16 v[128:131], v[148:151], v[104:107], v[128:131]
  v_mfma_f32_16x16x32_bf16 v[116:119], v[152:155], v[84:87], v[116:119]
  v_mfma_f32_16x16x32_bf16 v[128:131], v[152:155], v[108:111], v[128:131]
  s_lshl_b32 s21, s49, 5
  s_add_u32 s21, s21, s42
  s_mul_i32 s81, s21, 2560
  s_lshl_b32 s82, s49, 3
  s_and_b32 s21, s42, 7
  s_add_u32 s82, s82, s21
  s_lshl_b32 s82, s82, 7
  s_add_u32 s82, s82, 24576
  v_cndmask_b32 v112, v34, v112, s[64:65]
  v_cndmask_b32 v124, v34, v124, s[64:65]
  v_cndmask_b32 v113, v34, v113, s[66:67]
  v_cndmask_b32 v125, v34, v125, s[66:67]
  v_cndmask_b32 v114, v34, v114, s[68:69]
  v_cndmask_b32 v126, v34, v126, s[68:69]
  v_cndmask_b32 v115, v34, v115, s[70:71]
  v_cndmask_b32 v127, v34, v127, s[70:71]
  v_max3_f32 v156, v112, v113, v114
  v_max3_f32 v156, v156, v115, v116
  v_max3_f32 v156, v156, v117, v118
  v_max_f32 v156, v156, v119
  v_mov_b32 v157, v156
  s_nop 1
  v_permlane32_swap_b32 v156, v157
  v_max_f32 v156, v156, v157
  v_mov_b32 v157, v156
  s_nop 1
  v_permlane16_swap_b32 v156, v157
  v_max_f32 v156, v156, v157
  v_mul_f32 v156, s83, v156
  v_fma_f32 v112, v112, s83, -v156
  v_fma_f32 v113, v113, s83, -v156
  v_fma_f32 v114, v114, s83, -v156
  v_fma_f32 v115, v115, s83, -v156
  v_fma_f32 v116, v116, s83, -v156
  v_fma_f32 v117, v117, s83, -v156
  v_fma_f32 v118, v118, s83, -v156
  v_fma_f32 v119, v119, s83, -v156
  v_exp_f32 v112, v112
  v_exp_f32 v113, v113
  v_exp_f32 v114, v114
  v_exp_f32 v115, v115
  v_exp_f32 v116, v116
  v_exp_f32 v117, v117
  v_exp_f32 v118, v118
  v_exp_f32 v119, v119
  s_nop 0
  v_add_f32 v156, v116, v117
  v_add_f32 v156, v156, v118
  v_add_f32 v156, v156, v119
  v_cndmask_b32 v156, 0, v156, s[60:61]
  v_add_f32 v156, v156, v112
  v_add_f32 v156, v156, v113
  v_add_f32 v156, v156, v114
  v_add_f32 v156, v156, v115
  v_mov_b32 v157, v156
  s_nop 1
  v_permlane32_swap_b32 v156, v157
  v_add_f32 v156, v156, v157
  v_mov_b32 v157, v156
  s_nop 1
  v_permlane16_swap_b32 v156, v157
  v_add_f32 v156, v156, v157
  v_rcp_f32 v156, v156
  s_nop 0
  v_mul_f32 v112, v112, v156
  v_mul_f32 v113, v113, v156
  v_mul_f32 v114, v114, v156
  v_mul_f32 v115, v115, v156
  v_mul_f32 v116, v116, v156
  v_mul_f32 v117, v117, v156
  v_mul_f32 v118, v118, v156
  v_mul_f32 v119, v119, v156
  v_max3_f32 v156, v120, v121, v122
  v_max3_f32 v156, v156, v123, v124
  v_max3_f32 v156, v156, v125, v126
  v_max3_f32 v156, v156, v127, v128
  v_max3_f32 v156, v156, v129, v130
  v_max_f32 v156, v156, v131
  v_mov_b32 v157, v156
  s_nop 1
  v_permlane32_swap_b32 v156, v157
  v_max_f32 v156, v156, v157
  v_mov_b32 v157, v156
  s_nop 1
  v_permlane16_swap_b32 v156, v157
  v_max_f32 v156, v156, v157
  v_mul_f32 v156, s83, v156
  v_fma_f32 v120, v120, s83, -v156
  v_fma_f32 v121, v121, s83, -v156
  v_fma_f32 v122, v122, s83, -v156
  v_fma_f32 v123, v123, s83, -v156
  v_fma_f32 v124, v124, s83, -v156
  v_fma_f32 v125, v125, s83, -v156
  v_fma_f32 v126, v126, s83, -v156
  v_fma_f32 v127, v127, s83, -v156
  v_fma_f32 v128, v128, s83, -v156
  v_fma_f32 v129, v129, s83, -v156
  v_fma_f32 v130, v130, s83, -v156
  v_fma_f32 v131, v131, s83, -v156
  v_exp_f32 v120, v120
  v_exp_f32 v121, v121
  v_exp_f32 v122, v122
  v_exp_f32 v123, v123
  v_exp_f32 v124, v124
  v_exp_f32 v125, v125
  v_exp_f32 v126, v126
  v_exp_f32 v127, v127
  v_exp_f32 v128, v128
  v_exp_f32 v129, v129
  v_exp_f32 v130, v130
  v_exp_f32 v131, v131
  s_nop 0
  v_add_f32 v156, v128, v129
  v_add_f32 v156, v156, v130
  v_add_f32 v156, v156, v131
  v_cndmask_b32 v156, 0, v156, s[60:61]
  v_add_f32 v156, v156, v120
  v_add_f32 v156, v156, v121
  v_add_f32 v156, v156, v122
  v_add_f32 v156, v156, v123
  v_add_f32 v156, v156, v124
  v_add_f32 v156, v156, v125
  v_add_f32 v156, v156, v126
  v_add_f32 v156, v156, v127
  v_mov_b32 v157, v156
  s_nop 1
  v_permlane32_swap_b32 v156, v157
  v_add_f32 v156, v156, v157
  v_mov_b32 v157, v156
  s_nop 1
  v_permlane16_swap_b32 v156, v157
  v_add_f32 v156, v156, v157
  v_rcp_f32 v156, v156
  s_nop 0
  v_mul_f32 v120, v120, v156
  v_mul_f32 v121, v121, v156
  v_mul_f32 v122, v122, v156
  v_mul_f32 v123, v123, v156
  v_mul_f32 v124, v124, v156
  v_mul_f32 v125, v125, v156
  v_mul_f32 v126, v126, v156
  v_mul_f32 v127, v127, v156
  v_mul_f32 v128, v128, v156
  v_mul_f32 v129, v129, v156
  v_mul_f32 v130, v130, v156
  v_mul_f32 v131, v131, v156
  v_cvt_pk_bf16_f32 v192, v120, v121
  v_cvt_pk_bf16_f32 v193, v122, v123
  v_cvt_pk_bf16_f32 v194, v124, v125
  v_cvt_pk_bf16_f32 v195, v126, v127
  v_cvt_pk_bf16_f32 v196, v116, v117
  v_cvt_pk_bf16_f32 v197, v118, v119
  v_cvt_pk_bf16_f32 v198, v128, v129
  v_cvt_pk_bf16_f32 v199, v130, v131
  v_cvt_pk_bf16_f32 v200, v112, v113
  v_cvt_pk_bf16_f32 v201, v114, v115
  buffer_store_dwordx4 v[192:195], v30, s[56:59], s81 offen sc1
  buffer_store_dwordx4 v[196:199], v30, s[56:59], s81 offen offset:1024 sc1
  buffer_store_dwordx2 v[200:201], v32, s[56:59], s81 offen offset:2048 sc1
  s_mov_b32 s78, s82
  s_mov_b32 s81, 0x80000000
  s_mov_b32 s82, 0
  s_cmp_eq_u32 s80, 1
  s_cbranch_scc1 qd_240
  s_waitcnt vmcnt(0)
  s_cmp_eq_u32 s78, 0
  s_cbranch_scc1 pf_241
  v_mov_b32 v4, 0
  v_mov_b32 v5, 1
  s_mov_b64 exec, 1
  buffer_atomic_add v5, v4, s[72:75], s78 offen sc1
  s_mov_b64 exec, -1
  s_mov_b32 s78, 0
pf_241:
qd_240:
  s_add_u32 s49, s49, s29
qbe_229:
  s_cmp_lt_u32 s49, 64
  s_cbranch_scc1 qf_228
queue:
  s_load_dwordx2 s[4:5], s[0:1], 96
  s_waitcnt lgkmcnt(0)
  s_mov_b32 s32, s4
  s_mov_b32 s33, s5
  s_mov_b32 s34, 256
  s_mov_b32 s35, 0x00020000
  s_waitcnt vmcnt(0) lgkmcnt(0)
  s_barrier
  s_mov_b32 s2, s85
  s_mov_b32 s85, -1
  s_cmp_lg_u32 s2, -1
  s_cbranch_scc1 queue_c
  v_mov_b32 v21, 0
  s_cmp_lg_u32 s20, 0
  s_cbranch_scc1 q_242
  v_mov_b32 v22, 80
  v_mov_b32 v23, 1
  s_mov_b64 exec, 1
  buffer_atomic_add v23, v22, s[32:35], 0 offen sc0 sc1
  s_waitcnt vmcnt(0)
queue_a:
  ds_write_b32 v21, v23
  s_waitcnt lgkmcnt(0)
  s_mov_b64 exec, -1
q_242:
queue_b:
  s_barrier
  ds_read_b32 v23, v21
  s_waitcnt lgkmcnt(0)
  v_readfirstlane_b32 s2, v23
  s_barrier
queue_c:
  s_add_u32 s21, s2, 0
  s_cmp_lt_u32 s2, 64
  s_cbranch_scc1 do_opb
  s_sub_u32 s2, s2, 64
  s_add_u32 s21, s2, 0
  s_cmp_lt_u32 s2, 600
  s_cbranch_scc1 do_pv
  s_sub_u32 s2, s2, 600
  s_add_u32 s21, s2, 600
  s_cmp_lt_u32 s2, 40
  s_cbranch_scc1 do_pv
  s_sub_u32 s2, s2, 40
  s_branch main_fin
do_opb:
  s_mov_b32 s2, s21
  s_load_dwordx2 s[4:5], s[0:1], 0
  s_load_dwordx2 s[6:7], s[0:1], 80
  s_load_dwordx2 s[38:39], s[0:1], 104
  s_lshl_b32 s59, s2, 2
  s_add_u32 s59, s59, s20
  s_lshl_b32 s59, s59, 3
  s_waitcnt lgkmcnt(0)
  s_mov_b32 s8, s4
  s_mov_b32 s9, s5
  s_mov_b32 s10, 2621440
  s_mov_b32 s11, 0x00020000
  s_mov_b32 s12, s6
  s_mov_b32 s13, s7
  s_mov_b32 s14, 1280
  s_mov_b32 s15, 0x00020000
  s_add_u32 s28, s38, 81002496
  s_addc_u32 s29, s39, 0
  s_mov_b32 s30, 8192
  s_mov_b32 s31, 0x00020000
  v_lshlrev_b32 v4, 2, v1
  buffer_load_dword v16, v4, s[12:15], 0 offen offset:0
  buffer_load_dword v17, v4, s[12:15], 0 offen offset:256
  buffer_load_dword v18, v4, s[12:15], 0 offen offset:512
  buffer_load_dword v19, v4, s[12:15], 0 offen offset:768
  buffer_load_dword v20, v4, s[12:15], 0 offen offset:1024
  s_mul_i32 s22, s59, 1280
  buffer_load_dword v64, v4, s[8:11], s22 offen offset:0
  buffer_load_dword v65, v4, s[8:11], s22 offen offset:256
  buffer_load_dword v66, v4, s[8:11], s22 offen offset:512
  buffer_load_dword v67, v4, s[8:11], s22 offen offset:768
  buffer_load_dword v68, v4, s[8:11], s22 offen offset:1024
  s_add_u32 s22, s22, 1280
  buffer_load_dword v69, v4, s[8:11], s22 offen offset:0
  buffer_load_dword v70, v4, s[8:11], s22 offen offset:256
  buffer_load_dword v71, v4, s[8:11], s22 offen offset:512
  buffer_load_dword v72, v4, s[8:11], s22 offen offset:768
  buffer_load_dword v73, v4, s[8:11], s22 offen offset:1024
  s_add_u32 s22, s22, 1280
  buffer_load_dword v74, v4, s[8:11], s22 offen offset:0
  buffer_load_dword v75, v4, s[8:11], s22 offen offset:256
  buffer_load_dword v76, v4, s[8:11], s22 offen offset:512
  buffer_load_dword v77, v4, s[8:11], s22 offen offset:768
  buffer_load_dword v78, v4, s[8:11], s22 offen offset:1024
  s_add_u32 s22, s22, 1280
  buffer_load_dword v79, v4, s[8:11], s22 offen offset:0
  buffer_load_dword v80, v4, s[8:11], s22 offen offset:256
  buffer_load_dword v81, v4, s[8:11], s22 offen offset:512
  buffer_load_dword v82, v4, s[8:11], s22 offen offset:768
  buffer_load_dword v83, v4, s[8:11], s22 offen offset:1024
  s_add_u32 s22, s22, 1280
  buffer_load_dword v84, v4, s[8:11], s22 offen offset:0
  buffer_load_dword v85, v4, s[8:11], s22 offen offset:256
  buffer_load_dword v86, v4, s[8:11], s22 offen offset:512
  buffer_load_dword v87, v4, s[8:11], s22 offen offset:768
  buffer_load_dword v88, v4, s[8:11], s22 offen offset:1024
  s_add_u32 s22, s22, 1280
  buffer_load_dword v89, v4, s[8:11], s22 offen offset:0
  buffer_load_dword v90, v4, s[8:11], s22 offen offset:256
  buffer_load_dword v91, v4, s[8:11], s22 offen offset:512
  buffer_load_dword v92, v4, s[8:11], s22 offen offset:768
  buffer_load_dword v93, v4, s[8:11], s22 offen offset:1024
  s_add_u32 s22, s22, 1280
  buffer_load_dword v94, v4, s[8:11], s22 offen offset:0
  buffer_load_dword v95, v4, s[8:11], s22 offen offset:256
  buffer_load_dword v96, v4, s[8:11], s22 offen offset:512
  buffer_load_dword v97, v4, s[8:11], s22 offen offset:768
  buffer_load_dword v98, v4, s[8:11], s22 offen offset:1024
  s_add_u32 s22, s22, 1280
  buffer_load_dword v99, v4, s[8:11], s22 offen offset:0
  buffer_load_dword v100, v4, s[8:11], s22 offen offset:256
  buffer_load_dword v101, v4, s[8:11], s22 offen offset:512
  buffer_load_dword v102, v4, s[8:11], s22 offen offset:768
  buffer_load_dword v103, v4, s[8:11], s22 offen offset:1024
  s_add_u32 s22, s22, 1280
  s_waitcnt vmcnt(40)
  v_lshlrev_b32 v8, 16, v16
  v_and_b32 v16, 0xffff0000, v16
  v_lshlrev_b32 v9, 16, v17
  v_and_b32 v17, 0xffff0000, v17
  v_lshlrev_b32 v10, 16, v18
  v_and_b32 v18, 0xffff0000, v18
  v_lshlrev_b32 v11, 16, v19
  v_and_b32 v19, 0xffff0000, v19
  v_lshlrev_b32 v12, 16, v20
  v_and_b32 v20, 0xffff0000, v20
  s_waitcnt vmcnt(35)
  v_mov_b32 v160, 0
  v_lshlrev_b32 v25, 16, v64
  v_and_b32 v26, 0xffff0000, v64
  v_mul_f32 v25, v25, v8
  v_mul_f32 v26, v26, v16
  v_cvt_pk_bf16_f32 v25, v25, v26
  v_lshlrev_b32 v26, 16, v25
  v_and_b32 v25, 0xffff0000, v25
  v_add_f32 v160, v160, v26
  v_add_f32 v160, v160, v25
  v_lshlrev_b32 v25, 16, v65
  v_and_b32 v26, 0xffff0000, v65
  v_mul_f32 v25, v25, v9
  v_mul_f32 v26, v26, v17
  v_cvt_pk_bf16_f32 v25, v25, v26
  v_lshlrev_b32 v26, 16, v25
  v_and_b32 v25, 0xffff0000, v25
  v_add_f32 v160, v160, v26
  v_add_f32 v160, v160, v25
  v_lshlrev_b32 v25, 16, v66
  v_and_b32 v26, 0xffff0000, v66
  v_mul_f32 v25, v25, v10
  v_mul_f32 v26, v26, v18
  v_cvt_pk_bf16_f32 v25, v25, v26
  v_lshlrev_b32 v26, 16, v25
  v_and_b32 v25, 0xffff0000, v25
  v_add_f32 v160, v160, v26
  v_add_f32 v160, v160, v25
  v_lshlrev_b32 v25, 16, v67
  v_and_b32 v26, 0xffff0000, v67
  v_mul_f32 v25, v25, v11
  v_mul_f32 v26, v26, v19
  v_cvt_pk_bf16_f32 v25, v25, v26
  v_lshlrev_b32 v26, 16, v25
  v_and_b32 v25, 0xffff0000, v25
  v_add_f32 v160, v160, v26
  v_add_f32 v160, v160, v25
  v_lshlrev_b32 v25, 16, v68
  v_and_b32 v26, 0xffff0000, v68
  v_mul_f32 v25, v25, v12
  v_mul_f32 v26, v26, v20
  v_cvt_pk_bf16_f32 v25, v25, v26
  v_lshlrev_b32 v26, 16, v25
  v_and_b32 v25, 0xffff0000, v25
  v_add_f32 v160, v160, v26
  v_add_f32 v160, v160, v25
  s_waitcnt vmcnt(30)
  v_mov_b32 v161, 0
  v_lshlrev_b32 v25, 16, v69
  v_and_b32 v26, 0xffff0000, v69
  v_mul_f32 v25, v25, v8
  v_mul_f32 v26, v26, v16
  v_cvt_pk_bf16_f32 v25, v25, v26
  v_lshlrev_b32 v26, 16, v25
  v_and_b32 v25, 0xffff0000, v25
  v_add_f32 v161, v161, v26
  v_add_f32 v161, v161, v25
  v_lshlrev_b32 v25, 16, v70
  v_and_b32 v26, 0xffff0000, v70
  v_mul_f32 v25, v25, v9
  v_mul_f32 v26, v26, v17
  v_cvt_pk_bf16_f32 v25, v25, v26
  v_lshlrev_b32 v26, 16, v25
  v_and_b32 v25, 0xffff0000, v25
  v_add_f32 v161, v161, v26
  v_add_f32 v161, v161, v25
  v_lshlrev_b32 v25, 16, v71
  v_and_b32 v26, 0xffff0000, v71
  v_mul_f32 v25, v25, v10
  v_mul_f32 v26, v26, v18
  v_cvt_pk_bf16_f32 v25, v25, v26
  v_lshlrev_b32 v26, 16, v25
  v_and_b32 v25, 0xffff0000, v25
  v_add_f32 v161, v161, v26
  v_add_f32 v161, v161, v25
  v_lshlrev_b32 v25, 16, v72
  v_and_b32 v26, 0xffff0000, v72
  v_mul_f32 v25, v25, v11
  v_mul_f32 v26, v26, v19
  v_cvt_pk_bf16_f32 v25, v25, v26
  v_lshlrev_b32 v26, 16, v25
  v_and_b32 v25, 0xffff0000, v25
  v_add_f32 v161, v161, v26
  v_add_f32 v161, v161, v25
  v_lshlrev_b32 v25, 16, v73
  v_and_b32 v26, 0xffff0000, v73
  v_mul_f32 v25, v25, v12
  v_mul_f32 v26, v26, v20
  v_cvt_pk_bf16_f32 v25, v25, v26
  v_lshlrev_b32 v26, 16, v25
  v_and_b32 v25, 0xffff0000, v25
  v_add_f32 v161, v161, v26
  v_add_f32 v161, v161, v25
  s_waitcnt vmcnt(25)
  v_mov_b32 v162, 0
  v_lshlrev_b32 v25, 16, v74
  v_and_b32 v26, 0xffff0000, v74
  v_mul_f32 v25, v25, v8
  v_mul_f32 v26, v26, v16
  v_cvt_pk_bf16_f32 v25, v25, v26
  v_lshlrev_b32 v26, 16, v25
  v_and_b32 v25, 0xffff0000, v25
  v_add_f32 v162, v162, v26
  v_add_f32 v162, v162, v25
  v_lshlrev_b32 v25, 16, v75
  v_and_b32 v26, 0xffff0000, v75
  v_mul_f32 v25, v25, v9
  v_mul_f32 v26, v26, v17
  v_cvt_pk_bf16_f32 v25, v25, v26
  v_lshlrev_b32 v26, 16, v25
  v_and_b32 v25, 0xffff0000, v25
  v_add_f32 v162, v162, v26
  v_add_f32 v162, v162, v25
  v_lshlrev_b32 v25, 16, v76
  v_and_b32 v26, 0xffff0000, v76
  v_mul_f32 v25, v25, v10
  v_mul_f32 v26, v26, v18
  v_cvt_pk_bf16_f32 v25, v25, v26
  v_lshlrev_b32 v26, 16, v25
  v_and_b32 v25, 0xffff0000, v25
  v_add_f32 v162, v162, v26
  v_add_f32 v162, v162, v25
  v_lshlrev_b32 v25, 16, v77
  v_and_b32 v26, 0xffff0000, v77
  v_mul_f32 v25, v25, v11
  v_mul_f32 v26, v26, v19
  v_cvt_pk_bf16_f32 v25, v25, v26
  v_lshlrev_b32 v26, 16, v25
  v_and_b32 v25, 0xffff0000, v25
  v_add_f32 v162, v162, v26
  v_add_f32 v162, v162, v25
  v_lshlrev_b32 v25, 16, v78
  v_and_b32 v26, 0xffff0000, v78
  v_mul_f32 v25, v25, v12
  v_mul_f32 v26, v26, v20
  v_cvt_pk_bf16_f32 v25, v25, v26
  v_lshlrev_b32 v26, 16, v25
  v_and_b32 v25, 0xffff0000, v25
  v_add_f32 v162, v162, v26
  v_add_f32 v162, v162, v25
  s_waitcnt vmcnt(20)
  v_mov_b32 v163, 0
  v_lshlrev_b32 v25, 16, v79
  v_and_b32 v26, 0xffff0000, v79
  v_mul_f32 v25, v25, v8
  v_mul_f32 v26, v26, v16
  v_cvt_pk_bf16_f32 v25, v25, v26
  v_lshlrev_b32 v26, 16, v25
  v_and_b32 v25, 0xffff0000, v25
  v_add_f32 v163, v163, v26
  v_add_f32 v163, v163, v25
  v_lshlrev_b32 v25, 16, v80
  v_and_b32 v26, 0xffff0000, v80
  v_mul_f32 v25, v25, v9
  v_mul_f32 v26, v26, v17
  v_cvt_pk_bf16_f32 v25, v25, v26
  v_lshlrev_b32 v26, 16, v25
  v_and_b32 v25, 0xffff0000, v25
  v_add_f32 v163, v163, v26
  v_add_f32 v163, v163, v25
  v_lshlrev_b32 v25, 16, v81
  v_and_b32 v26, 0xffff0000, v81
  v_mul_f32 v25, v25, v10
  v_mul_f32 v26, v26, v18
  v_cvt_pk_bf16_f32 v25, v25, v26
  v_lshlrev_b32 v26, 16, v25
  v_and_b32 v25, 0xffff0000, v25
  v_add_f32 v163, v163, v26
  v_add_f32 v163, v163, v25
  v_lshlrev_b32 v25, 16, v82
  v_and_b32 v26, 0xffff0000, v82
  v_mul_f32 v25, v25, v11
  v_mul_f32 v26, v26, v19
  v_cvt_pk_bf16_f32 v25, v25, v26
  v_lshlrev_b32 v26, 16, v25
  v_and_b32 v25, 0xffff0000, v25
  v_add_f32 v163, v163, v26
  v_add_f32 v163, v163, v25
  v_lshlrev_b32 v25, 16, v83
  v_and_b32 v26, 0xffff0000, v83
  v_mul_f32 v25, v25, v12
  v_mul_f32 v26, v26, v20
  v_cvt_pk_bf16_f32 v25, v25, v26
  v_lshlrev_b32 v26, 16, v25
  v_and_b32 v25, 0xffff0000, v25
  v_add_f32 v163, v163, v26
  v_add_f32 v163, v163, v25
  s_waitcnt vmcnt(15)
  v_mov_b32 v164, 0
  v_lshlrev_b32 v25, 16, v84
  v_and_b32 v26, 0xffff0000, v84
  v_mul_f32 v25, v25, v8
  v_mul_f32 v26, v26, v16
  v_cvt_pk_bf16_f32 v25, v25, v26
  v_lshlrev_b32 v26, 16, v25
  v_and_b32 v25, 0xffff0000, v25
  v_add_f32 v164, v164, v26
  v_add_f32 v164, v164, v25
  v_lshlrev_b32 v25, 16, v85
  v_and_b32 v26, 0xffff0000, v85
  v_mul_f32 v25, v25, v9
  v_mul_f32 v26, v26, v17
  v_cvt_pk_bf16_f32 v25, v25, v26
  v_lshlrev_b32 v26, 16, v25
  v_and_b32 v25, 0xffff0000, v25
  v_add_f32 v164, v164, v26
  v_add_f32 v164, v164, v25
  v_lshlrev_b32 v25, 16, v86
  v_and_b32 v26, 0xffff0000, v86
  v_mul_f32 v25, v25, v10
  v_mul_f32 v26, v26, v18
  v_cvt_pk_bf16_f32 v25, v25, v26
  v_lshlrev_b32 v26, 16, v25
  v_and_b32 v25, 0xffff0000, v25
  v_add_f32 v164, v164, v26
  v_add_f32 v164, v164, v25
  v_lshlrev_b32 v25, 16, v87
  v_and_b32 v26, 0xffff0000, v87
  v_mul_f32 v25, v25, v11
  v_mul_f32 v26, v26, v19
  v_cvt_pk_bf16_f32 v25, v25, v26
  v_lshlrev_b32 v26, 16, v25
  v_and_b32 v25, 0xffff0000, v25
  v_add_f32 v164, v164, v26
  v_add_f32 v164, v164, v25
  v_lshlrev_b32 v25, 16, v88
  v_and_b32 v26, 0xffff0000, v88
  v_mul_f32 v25, v25, v12
  v_mul_f32 v26, v26, v20
  v_cvt_pk_bf16_f32 v25, v25, v26
  v_lshlrev_b32 v26, 16, v25
  v_and_b32 v25, 0xffff0000, v25
  v_add_f32 v164, v164, v26
  v_add_f32 v164, v164, v25
  s_waitcnt vmcnt(10)
  v_mov_b32 v165, 0
  v_lshlrev_b32 v25, 16, v89
  v_and_b32 v26, 0xffff0000, v89
  v_mul_f32 v25, v25, v8
  v_mul_f32 v26, v26, v16
  v_cvt_pk_bf16_f32 v25, v25, v26
  v_lshlrev_b32 v26, 16, v25
  v_and_b32 v25, 0xffff0000, v25
  v_add_f32 v165, v165, v26
  v_add_f32 v165, v165, v25
  v_lshlrev_b32 v25, 16, v90
  v_and_b32 v26, 0xffff0000, v90
  v_mul_f32 v25, v25, v9
  v_mul_f32 v26, v26, v17
  v_cvt_pk_bf16_f32 v25, v25, v26
  v_lshlrev_b32 v26, 16, v25
  v_and_b32 v25, 0xffff0000, v25
  v_add_f32 v165, v165, v26
  v_add_f32 v165, v165, v25
  v_lshlrev_b32 v25, 16, v91
  v_and_b32 v26, 0xffff0000, v91
  v_mul_f32 v25, v25, v10
  v_mul_f32 v26, v26, v18
  v_cvt_pk_bf16_f32 v25, v25, v26
  v_lshlrev_b32 v26, 16, v25
  v_and_b32 v25, 0xffff0000, v25
  v_add_f32 v165, v165, v26
  v_add_f32 v165, v165, v25
  v_lshlrev_b32 v25, 16, v92
  v_and_b32 v26, 0xffff0000, v92
  v_mul_f32 v25, v25, v11
  v_mul_f32 v26, v26, v19
  v_cvt_pk_bf16_f32 v25, v25, v26
  v_lshlrev_b32 v26, 16, v25
  v_and_b32 v25, 0xffff0000, v25
  v_add_f32 v165, v165, v26
  v_add_f32 v165, v165, v25
  v_lshlrev_b32 v25, 16, v93
  v_and_b32 v26, 0xffff0000, v93
  v_mul_f32 v25, v25, v12
  v_mul_f32 v26, v26, v20
  v_cvt_pk_bf16_f32 v25, v25, v26
  v_lshlrev_b32 v26, 16, v25
  v_and_b32 v25, 0xffff0000, v25
  v_add_f32 v165, v165, v26
  v_add_f32 v165, v165, v25
  s_waitcnt vmcnt(5)
  v_mov_b32 v166, 0
  v_lshlrev_b32 v25, 16, v94
  v_and_b32 v26, 0xffff0000, v94
  v_mul_f32 v25, v25, v8
  v_mul_f32 v26, v26, v16
  v_cvt_pk_bf16_f32 v25, v25, v26
  v_lshlrev_b32 v26, 16, v25
  v_and_b32 v25, 0xffff0000, v25
  v_add_f32 v166, v166, v26
  v_add_f32 v166, v166, v25
  v_lshlrev_b32 v25, 16, v95
  v_and_b32 v26, 0xffff0000, v95
  v_mul_f32 v25, v25, v9
  v_mul_f32 v26, v26, v17
  v_cvt_pk_bf16_f32 v25, v25, v26
  v_lshlrev_b32 v26, 16, v25
  v_and_b32 v25, 0xffff0000, v25
  v_add_f32 v166, v166, v26
  v_add_f32 v166, v166, v25
  v_lshlrev_b32 v25, 16, v96
  v_and_b32 v26, 0xffff0000, v96
  v_mul_f32 v25, v25, v10
  v_mul_f32 v26, v26, v18
  v_cvt_pk_bf16_f32 v25, v25, v26
  v_lshlrev_b32 v26, 16, v25
  v_and_b32 v25, 0xffff0000, v25
  v_add_f32 v166, v166, v26
  v_add_f32 v166, v166, v25
  v_lshlrev_b32 v25, 16, v97
  v_and_b32 v26, 0xffff0000, v97
  v_mul_f32 v25, v25, v11
  v_mul_f32 v26, v26, v19
  v_cvt_pk_bf16_f32 v25, v25, v26
  v_lshlrev_b32 v26, 16, v25
  v_and_b32 v25, 0xffff0000, v25
  v_add_f32 v166, v166, v26
  v_add_f32 v166, v166, v25
  v_lshlrev_b32 v25, 16, v98
  v_and_b32 v26, 0xffff0000, v98
  v_mul_f32 v25, v25, v12
  v_mul_f32 v26, v26, v20
  v_cvt_pk_bf16_f32 v25, v25, v26
  v_lshlrev_b32 v26, 16, v25
  v_and_b32 v25, 0xffff0000, v25
  v_add_f32 v166, v166, v26
  v_add_f32 v166, v166, v25
  s_waitcnt vmcnt(0)
  v_mov_b32 v167, 0
  v_lshlrev_b32 v25, 16, v99
  v_and_b32 v26, 0xffff0000, v99
  v_mul_f32 v25, v25, v8
  v_mul_f32 v26, v26, v16
  v_cvt_pk_bf16_f32 v25, v25, v26
  v_lshlrev_b32 v26, 16, v25
  v_and_b32 v25, 0xffff0000, v25
  v_add_f32 v167, v167, v26
  v_add_f32 v167, v167, v25
  v_lshlrev_b32 v25, 16, v100
  v_and_b32 v26, 0xffff0000, v100
  v_mul_f32 v25, v25, v9
  v_mul_f32 v26, v26, v17
  v_cvt_pk_bf16_f32 v25, v25, v26
  v_lshlrev_b32 v26, 16, v25
  v_and_b32 v25, 0xffff0000, v25
  v_add_f32 v167, v167, v26
  v_add_f32 v167, v167, v25
  v_lshlrev_b32 v25, 16, v101
  v_and_b32 v26, 0xffff0000, v101
  v_mul_f32 v25, v25, v10
  v_mul_f32 v26, v26, v18
  v_cvt_pk_bf16_f32 v25, v25, v26
  v_lshlrev_b32 v26, 16, v25
  v_and_b32 v25, 0xffff0000, v25
  v_add_f32 v167, v167, v26
  v_add_f32 v167, v167, v25
  v_lshlrev_b32 v25, 16, v102
  v_and_b32 v26, 0xffff0000, v102
  v_mul_f32 v25, v25, v11
  v_mul_f32 v26, v26, v19
  v_cvt_pk_bf16_f32 v25, v25, v26
  v_lshlrev_b32 v26, 16, v25
  v_and_b32 v25, 0xffff0000, v25
  v_add_f32 v167, v167, v26
  v_add_f32 v167, v167, v25
  v_lshlrev_b32 v25, 16, v103
  v_and_b32 v26, 0xffff0000, v103
  v_mul_f32 v25, v25, v12
  v_mul_f32 v26, v26, v20
  v_cvt_pk_bf16_f32 v25, v25, v26
  v_lshlrev_b32 v26, 16, v25
  v_and_b32 v25, 0xffff0000, v25
  v_add_f32 v167, v167, v26
  v_add_f32 v167, v167, v25
  v_add_f32_dpp v160, v160, v160 row_ror:8 row_mask:0xf bank_mask:0xf
  v_add_f32_dpp v161, v161, v161 row_ror:8 row_mask:0xf bank_mask:0xf
  v_add_f32_dpp v162, v162, v162 row_ror:8 row_mask:0xf bank_mask:0xf
  v_add_f32_dpp v163, v163, v163 row_ror:8 row_mask:0xf bank_mask:0xf
  v_add_f32_dpp v164, v164, v164 row_ror:8 row_mask:0xf bank_mask:0xf
  v_add_f32_dpp v165, v165, v165 row_ror:8 row_mask:0xf bank_mask:0xf
  v_add_f32_dpp v166, v166, v166 row_ror:8 row_mask:0xf bank_mask:0xf
  v_add_f32_dpp v167, v167, v167 row_ror:8 row_mask:0xf bank_mask:0xf
  v_add_f32_dpp v160, v160, v160 row_ror:4 row_mask:0xf bank_mask:0xf
  v_add_f32_dpp v161, v161, v161 row_ror:4 row_mask:0xf bank_mask:0xf
  v_add_f32_dpp v162, v162, v162 row_ror:4 row_mask:0xf bank_mask:0xf
  v_add_f32_dpp v163, v163, v163 row_ror:4 row_mask:0xf bank_mask:0xf
  v_add_f32_dpp v164, v164, v164 row_ror:4 row_mask:0xf bank_mask:0xf
  v_add_f32_dpp v165, v165, v165 row_ror:4 row_mask:0xf bank_mask:0xf
  v_add_f32_dpp v166, v166, v166 row_ror:4 row_mask:0xf bank_mask:0xf
  v_add_f32_dpp v167, v167, v167 row_ror:4 row_mask:0xf bank_mask:0xf
  v_add_f32_dpp v160, v160, v160 row_ror:2 row_mask:0xf bank_mask:0xf
  v_add_f32_dpp v161, v161, v161 row_ror:2 row_mask:0xf bank_mask:0xf
  v_add_f32_dpp v162, v162, v162 row_ror:2 row_mask:0xf bank_mask:0xf
  v_add_f32_dpp v163, v163, v163 row_ror:2 row_mask:0xf bank_mask:0xf
  v_add_f32_dpp v164, v164, v164 row_ror:2 row_mask:0xf bank_mask:0xf
  v_add_f32_dpp v165, v165, v165 row_ror:2 row_mask:0xf bank_mask:0xf
  v_add_f32_dpp v166, v166, v166 row_ror:2 row_mask:0xf bank_mask:0xf
  v_add_f32_dpp v167, v167, v167 row_ror:2 row_mask:0xf bank_mask:0xf
  v_add_f32_dpp v160, v160, v160 row_ror:1 row_mask:0xf bank_mask:0xf
  v_add_f32_dpp v161, v161, v161 row_ror:1 row_mask:0xf bank_mask:0xf
  v_add_f32_dpp v162, v162, v162 row_ror:1 row_mask:0xf bank_mask:0xf
  v_add_f32_dpp v163, v163, v163 row_ror:1 row_mask:0xf bank_mask:0xf
  v_add_f32_dpp v164, v164, v164 row_ror:1 row_mask:0xf bank_mask:0xf
  v_add_f32_dpp v165, v165, v165 row_ror:1 row_mask:0xf bank_mask:0xf
  v_add_f32_dpp v166, v166, v166 row_ror:1 row_mask:0xf bank_mask:0xf
  v_add_f32_dpp v167, v167, v167 row_ror:1 row_mask:0xf bank_mask:0xf
  v_mov_b32 v192, v160
  v_mov_b32 v193, v161
  v_mov_b32 v194, v162
  v_mov_b32 v195, v163
  v_mov_b32 v196, v164
  v_mov_b32 v197, v165
  v_mov_b32 v198, v166
  v_mov_b32 v199, v167
  v_permlane32_swap_b32 v160, v192
  v_permlane32_swap_b32 v161, v193
  v_permlane32_swap_b32 v162, v194
  v_permlane32_swap_b32 v163, v195
  v_permlane32_swap_b32 v164, v196
  v_permlane32_swap_b32 v165, v197
  v_permlane32_swap_b32 v166, v198
  v_permlane32_swap_b32 v167, v199
  v_add_f32 v160, v160, v192
  v_add_f32 v161, v161, v193
  v_add_f32 v162, v162, v194
  v_add_f32 v163, v163, v195
  v_add_f32 v164, v164, v196
  v_add_f32 v165, v165, v197
  v_add_f32 v166, v166, v198
  v_add_f32 v167, v167, v199
  v_mov_b32 v192, v160
  v_mov_b32 v193, v161
  v_mov_b32 v194, v162
  v_mov_b32 v195, v163
  v_mov_b32 v196, v164
  v_mov_b32 v197, v165
  v_mov_b32 v198, v166
  v_mov_b32 v199, v167
  v_permlane16_swap_b32 v160, v192
  v_permlane16_swap_b32 v161, v193
  v_permlane16_swap_b32 v162, v194
  v_permlane16_swap_b32 v163, v195
  v_permlane16_swap_b32 v164, v196
  v_permlane16_swap_b32 v165, v197
  v_permlane16_swap_b32 v166, v198
  v_permlane16_swap_b32 v167, v199
  v_add_f32 v160, v160, v192
  v_add_f32 v161, v161, v193
  v_add_f32 v162, v162, v194
  v_add_f32 v163, v163, v195
  v_add_f32 v164, v164, v196
  v_add_f32 v165, v165, v197
  v_add_f32 v166, v166, v198
  v_add_f32 v167, v167, v199
  v_mov_b32 v24, v160
  v_cmp_eq_u32 vcc, 1, v1
  s_nop 1
  v_cndmask_b32 v24, v24, v161, vcc
  v_cmp_eq_u32 vcc, 2, v1
  s_nop 1
  v_cndmask_b32 v24, v24, v162, vcc
  v_cmp_eq_u32 vcc, 3, v1
  s_nop 1
  v_cndmask_b32 v24, v24, v163, vcc
  v_cmp_eq_u32 vcc, 4, v1
  s_nop 1
  v_cndmask_b32 v24, v24, v164, vcc
  v_cmp_eq_u32 vcc, 5, v1
  s_nop 1
  v_cndmask_b32 v24, v24, v165, vcc
  v_cmp_eq_u32 vcc, 6, v1
  s_nop 1
  v_cndmask_b32 v24, v24, v166, vcc
  v_cmp_eq_u32 vcc, 7, v1
  s_nop 1
  v_cndmask_b32 v24, v24, v167, vcc
  v_cvt_pk_bf16_f32 v25, v24, v24
  v_lshlrev_b32 v24, 16, v25
  v_mul_f32 v24, 0xbfb8aa3b, v24
  v_exp_f32 v24, v24
  s_nop 0
  v_add_f32 v24, 1.0, v24
  v_rcp_f32 v24, v24
  s_nop 0
  v_cvt_pk_bf16_f32 v25, v24, v24
  v_lshlrev_b32 v24, 16, v25
  s_lshl_b32 s21, s59, 2
  s_mov_b64 exec, 255
  buffer_store_dword v24, v4, s[28:31], s21 offen sc1
  s_mov_b64 exec, -1
  s_lshr_b32 s40, s2, 2
  s_and_b32 s42, s2, 3
  s_mov_b32 s43, 4
  s_load_dwordx2 s[4:5], s[0:1], 40
  s_load_dwordx2 s[6:7], s[0:1], 72
  s_load_dwordx2 s[38:39], s[0:1], 104
  s_waitcnt lgkmcnt(0)
  s_cmp_eq_u32 s43, 4
  s_cselect_b32 s4, s6, s4
  s_cselect_b32 s5, s7, s5
  s_mov_b32 s10, 7864320
  s_cselect_b32 s10, 819200, s10
  s_cselect_b32 s44, 10, 24
  s_mov_b32 s45, 196608
  s_cselect_b32 s45, 128, s45
  s_mov_b32 s46, 93323264
  s_cselect_b32 s46, 70778880, s46
  s_cselect_b32 s47, 1, 0
  s_mov_b32 s8, s4
  s_mov_b32 s9, s5
  s_mov_b32 s11, 0x00020000
  s_mov_b32 s12, s38
  s_mov_b32 s13, s39
  s_mov_b32 s14, 73400320
  s_mov_b32 s15, 0x00020000
  s_add_u32 s16, s38, 73400320
  s_addc_u32 s17, s39, 0
  s_mov_b32 s18, 5242880
  s_mov_b32 s19, 0x00020000
  s_lshl_b32 s21, s40, 3
  s_lshl_b32 s22, s20, 1
  s_add_u32 s21, s21, s22
  s_mul_i32 s21, s21, s45
  s_add_u32 s48, s46, s21
  s_and_b32 s22, s43, 3
  s_mul_i32 s22, s22, 49152
  s_cmp_eq_u32 s47, 1
  s_cselect_b32 s22, 0, s22
  s_add_u32 s48, s48, s22
  v_lshlrev_b32 v4, 4, v1
  s_and_b32 s22, s43, 3
  s_mul_i32 s49, s22, 1966080
  s_cmp_eq_u32 s47, 1
  s_cselect_b32 s49, 0, s49
  s_mul_i32 s22, s42, 320
  s_add_u32 s49, s49, s22
  v_mov_b32 v29, 3277
  s_mul_i32 s21, s20, 320
  s_add_u32 s21, s21, 0
  v_add_u32 v21, s21, v1
  v_mul_u32_u24 v22, v21, v29
  v_lshrrev_b32 v22, 16, v22
  v_mul_u32_u24 v23, 20, v22
  v_sub_u32 v21, v21, v23
  v_add_u32 v22, 0, v22
  v_mov_b32 v25, v22
  s_cmp_eq_u32 s47, 1
  s_cbranch_scc1 id_243
  v_and_b32 v23, 0xe3, v22
  v_bfe_u32 v24, v22, 2, 1
  v_lshl_add_u32 v23, v24, 4, v23
  v_bfe_u32 v24, v22, 3, 2
  v_lshl_add_u32 v22, v24, 2, v23
  v_mul_u32_u24 v23, 1366, v22
  v_lshrrev_b32 v23, 16, v23
  v_mul_u32_u24 v25, 48, v23
  v_sub_u32 v22, v22, v25
  v_mul_u32_u24 v26, 5462, v22
  v_lshrrev_b32 v26, 16, v26
  v_mul_u32_u24 v27, 12, v26
  v_sub_u32 v22, v22, v27
  v_lshrrev_b32 v27, 2, v22
  v_and_b32 v22, 3, v22
  v_lshl_add_u32 v25, v27, 4, v25
  v_lshl_add_u32 v25, v26, 2, v25
  v_add_u32 v25, v25, v22
id_243:
  v_mul_u32_u24 v25, 1280, v25
  v_lshl_add_u32 v64, v21, 4, v25
  s_mul_i32 s21, s20, 320
  s_add_u32 s21, s21, 64
  v_add_u32 v21, s21, v1
  v_mul_u32_u24 v22, v21, v29
  v_lshrrev_b32 v22, 16, v22
  v_mul_u32_u24 v23, 20, v22
  v_sub_u32 v21, v21, v23
  v_add_u32 v22, 0, v22
  v_mov_b32 v25, v22
  s_cmp_eq_u32 s47, 1
  s_cbranch_scc1 id_244
  v_and_b32 v23, 0xe3, v22
  v_bfe_u32 v24, v22, 2, 1
  v_lshl_add_u32 v23, v24, 4, v23
  v_bfe_u32 v24, v22, 3, 2
  v_lshl_add_u32 v22, v24, 2, v23
  v_mul_u32_u24 v23, 1366, v22
  v_lshrrev_b32 v23, 16, v23
  v_mul_u32_u24 v25, 48, v23
  v_sub_u32 v22, v22, v25
  v_mul_u32_u24 v26, 5462, v22
  v_lshrrev_b32 v26, 16, v26
  v_mul_u32_u24 v27, 12, v26
  v_sub_u32 v22, v22, v27
  v_lshrrev_b32 v27, 2, v22
  v_and_b32 v22, 3, v22
  v_lshl_add_u32 v25, v27, 4, v25
  v_lshl_add_u32 v25, v26, 2, v25
  v_add_u32 v25, v25, v22
id_244:
  v_mul_u32_u24 v25, 1280, v25
  v_lshl_add_u32 v65, v21, 4, v25
  s_mul_i32 s21, s20, 320
  s_add_u32 s21, s21, 128
  v_add_u32 v21, s21, v1
  v_mul_u32_u24 v22, v21, v29
  v_lshrrev_b32 v22, 16, v22
  v_mul_u32_u24 v23, 20, v22
  v_sub_u32 v21, v21, v23
  v_add_u32 v22, 0, v22
  v_mov_b32 v25, v22
  s_cmp_eq_u32 s47, 1
  s_cbranch_scc1 id_245
  v_and_b32 v23, 0xe3, v22
  v_bfe_u32 v24, v22, 2, 1
  v_lshl_add_u32 v23, v24, 4, v23
  v_bfe_u32 v24, v22, 3, 2
  v_lshl_add_u32 v22, v24, 2, v23
  v_mul_u32_u24 v23, 1366, v22
  v_lshrrev_b32 v23, 16, v23
  v_mul_u32_u24 v25, 48, v23
  v_sub_u32 v22, v22, v25
  v_mul_u32_u24 v26, 5462, v22
  v_lshrrev_b32 v26, 16, v26
  v_mul_u32_u24 v27, 12, v26
  v_sub_u32 v22, v22, v27
  v_lshrrev_b32 v27, 2, v22
  v_and_b32 v22, 3, v22
  v_lshl_add_u32 v25, v27, 4, v25
  v_lshl_add_u32 v25, v26, 2, v25
  v_add_u32 v25, v25, v22
id_245:
  v_mul_u32_u24 v25, 1280, v25
  v_lshl_add_u32 v66, v21, 4, v25
  s_mul_i32 s21, s20, 320
  s_add_u32 s21, s21, 192
  v_add_u32 v21, s21, v1
  v_mul_u32_u24 v22, v21, v29
  v_lshrrev_b32 v22, 16, v22
  v_mul_u32_u24 v23, 20, v22
  v_sub_u32 v21, v21, v23
  v_add_u32 v22, 0, v22
  v_mov_b32 v25, v22
  s_cmp_eq_u32 s47, 1
  s_cbranch_scc1 id_246
  v_and_b32 v23, 0xe3, v22
  v_bfe_u32 v24, v22, 2, 1
  v_lshl_add_u32 v23, v24, 4, v23
  v_bfe_u32 v24, v22, 3, 2
  v_lshl_add_u32 v22, v24, 2, v23
  v_mul_u32_u24 v23, 1366, v22
  v_lshrrev_b32 v23, 16, v23
  v_mul_u32_u24 v25, 48, v23
  v_sub_u32 v22, v22, v25
  v_mul_u32_u24 v26, 5462, v22
  v_lshrrev_b32 v26, 16, v26
  v_mul_u32_u24 v27, 12, v26
  v_sub_u32 v22, v22, v27
  v_lshrrev_b32 v27, 2, v22
  v_and_b32 v22, 3, v22
  v_lshl_add_u32 v25, v27, 4, v25
  v_lshl_add_u32 v25, v26, 2, v25
  v_add_u32 v25, v25, v22
id_246:
  v_mul_u32_u24 v25, 1280, v25
  v_lshl_add_u32 v67, v21, 4, v25
  s_mul_i32 s21, s20, 320
  s_add_u32 s21, s21, 256
  v_add_u32 v21, s21, v1
  v_mul_u32_u24 v22, v21, v29
  v_lshrrev_b32 v22, 16, v22
  v_mul_u32_u24 v23, 20, v22
  v_sub_u32 v21, v21, v23
  v_add_u32 v22, 0, v22
  v_mov_b32 v25, v22
  s_cmp_eq_u32 s47, 1
  s_cbranch_scc1 id_247
  v_and_b32 v23, 0xe3, v22
  v_bfe_u32 v24, v22, 2, 1
  v_lshl_add_u32 v23, v24, 4, v23
  v_bfe_u32 v24, v22, 3, 2
  v_lshl_add_u32 v22, v24, 2, v23
  v_mul_u32_u24 v23, 1366, v22
  v_lshrrev_b32 v23, 16, v23
  v_mul_u32_u24 v25, 48, v23
  v_sub_u32 v22, v22, v25
  v_mul_u32_u24 v26, 5462, v22
  v_lshrrev_b32 v26, 16, v26
  v_mul_u32_u24 v27, 12, v26
  v_sub_u32 v22, v22, v27
  v_lshrrev_b32 v27, 2, v22
  v_and_b32 v22, 3, v22
  v_lshl_add_u32 v25, v27, 4, v25
  v_lshl_add_u32 v25, v26, 2, v25
  v_add_u32 v25, v25, v22
id_247:
  v_mul_u32_u24 v25, 1280, v25
  v_lshl_add_u32 v68, v21, 4, v25
  s_mul_i32 s21, s20, 320
  s_add_u32 s21, s21, 0
  v_add_u32 v21, s21, v1
  v_mul_u32_u24 v22, v21, v29
  v_lshrrev_b32 v22, 16, v22
  v_mul_u32_u24 v23, 20, v22
  v_sub_u32 v21, v21, v23
  v_add_u32 v22, 64, v22
  v_mov_b32 v25, v22
  s_cmp_eq_u32 s47, 1
  s_cbranch_scc1 id_248
  v_and_b32 v23, 0xe3, v22
  v_bfe_u32 v24, v22, 2, 1
  v_lshl_add_u32 v23, v24, 4, v23
  v_bfe_u32 v24, v22, 3, 2
  v_lshl_add_u32 v22, v24, 2, v23
  v_mul_u32_u24 v23, 1366, v22
  v_lshrrev_b32 v23, 16, v23
  v_mul_u32_u24 v25, 48, v23
  v_sub_u32 v22, v22, v25
  v_mul_u32_u24 v26, 5462, v22
  v_lshrrev_b32 v26, 16, v26
  v_mul_u32_u24 v27, 12, v26
  v_sub_u32 v22, v22, v27
  v_lshrrev_b32 v27, 2, v22
  v_and_b32 v22, 3, v22
  v_lshl_add_u32 v25, v27, 4, v25
  v_lshl_add_u32 v25, v26, 2, v25
  v_add_u32 v25, v25, v22
id_248:
  v_mul_u32_u24 v25, 1280, v25
  v_lshl_add_u32 v69, v21, 4, v25
  s_mul_i32 s21, s20, 320
  s_add_u32 s21, s21, 64
  v_add_u32 v21, s21, v1
  v_mul_u32_u24 v22, v21, v29
  v_lshrrev_b32 v22, 16, v22
  v_mul_u32_u24 v23, 20, v22
  v_sub_u32 v21, v21, v23
  v_add_u32 v22, 64, v22
  v_mov_b32 v25, v22
  s_cmp_eq_u32 s47, 1
  s_cbranch_scc1 id_249
  v_and_b32 v23, 0xe3, v22
  v_bfe_u32 v24, v22, 2, 1
  v_lshl_add_u32 v23, v24, 4, v23
  v_bfe_u32 v24, v22, 3, 2
  v_lshl_add_u32 v22, v24, 2, v23
  v_mul_u32_u24 v23, 1366, v22
  v_lshrrev_b32 v23, 16, v23
  v_mul_u32_u24 v25, 48, v23
  v_sub_u32 v22, v22, v25
  v_mul_u32_u24 v26, 5462, v22
  v_lshrrev_b32 v26, 16, v26
  v_mul_u32_u24 v27, 12, v26
  v_sub_u32 v22, v22, v27
  v_lshrrev_b32 v27, 2, v22
  v_and_b32 v22, 3, v22
  v_lshl_add_u32 v25, v27, 4, v25
  v_lshl_add_u32 v25, v26, 2, v25
  v_add_u32 v25, v25, v22
id_249:
  v_mul_u32_u24 v25, 1280, v25
  v_lshl_add_u32 v70, v21, 4, v25
  s_mul_i32 s21, s20, 320
  s_add_u32 s21, s21, 128
  v_add_u32 v21, s21, v1
  v_mul_u32_u24 v22, v21, v29
  v_lshrrev_b32 v22, 16, v22
  v_mul_u32_u24 v23, 20, v22
  v_sub_u32 v21, v21, v23
  v_add_u32 v22, 64, v22
  v_mov_b32 v25, v22
  s_cmp_eq_u32 s47, 1
  s_cbranch_scc1 id_250
  v_and_b32 v23, 0xe3, v22
  v_bfe_u32 v24, v22, 2, 1
  v_lshl_add_u32 v23, v24, 4, v23
  v_bfe_u32 v24, v22, 3, 2
  v_lshl_add_u32 v22, v24, 2, v23
  v_mul_u32_u24 v23, 1366, v22
  v_lshrrev_b32 v23, 16, v23
  v_mul_u32_u24 v25, 48, v23
  v_sub_u32 v22, v22, v25
  v_mul_u32_u24 v26, 5462, v22
  v_lshrrev_b32 v26, 16, v26
  v_mul_u32_u24 v27, 12, v26
  v_sub_u32 v22, v22, v27
  v_lshrrev_b32 v27, 2, v22
  v_and_b32 v22, 3, v22
  v_lshl_add_u32 v25, v27, 4, v25
  v_lshl_add_u32 v25, v26, 2, v25
  v_add_u32 v25, v25, v22
id_250:
  v_mul_u32_u24 v25, 1280, v25
  v_lshl_add_u32 v71, v21, 4, v25
  s_mul_i32 s21, s20, 320
  s_add_u32 s21, s21, 192
  v_add_u32 v21, s21, v1
  v_mul_u32_u24 v22, v21, v29
  v_lshrrev_b32 v22, 16, v22
  v_mul_u32_u24 v23, 20, v22
  v_sub_u32 v21, v21, v23
  v_add_u32 v22, 64, v22
  v_mov_b32 v25, v22
  s_cmp_eq_u32 s47, 1
  s_cbranch_scc1 id_251
  v_and_b32 v23, 0xe3, v22
  v_bfe_u32 v24, v22, 2, 1
  v_lshl_add_u32 v23, v24, 4, v23
  v_bfe_u32 v24, v22, 3, 2
  v_lshl_add_u32 v22, v24, 2, v23
  v_mul_u32_u24 v23, 1366, v22
  v_lshrrev_b32 v23, 16, v23
  v_mul_u32_u24 v25, 48, v23
  v_sub_u32 v22, v22, v25
  v_mul_u32_u24 v26, 5462, v22
  v_lshrrev_b32 v26, 16, v26
  v_mul_u32_u24 v27, 12, v26
  v_sub_u32 v22, v22, v27
  v_lshrrev_b32 v27, 2, v22
  v_and_b32 v22, 3, v22
  v_lshl_add_u32 v25, v27, 4, v25
  v_lshl_add_u32 v25, v26, 2, v25
  v_add_u32 v25, v25, v22
id_251:
  v_mul_u32_u24 v25, 1280, v25
  v_lshl_add_u32 v72, v21, 4, v25
  s_mul_i32 s21, s20, 320
  s_add_u32 s21, s21, 256
  v_add_u32 v21, s21, v1
  v_mul_u32_u24 v22, v21, v29
  v_lshrrev_b32 v22, 16, v22
  v_mul_u32_u24 v23, 20, v22
  v_sub_u32 v21, v21, v23
  v_add_u32 v22, 64, v22
  v_mov_b32 v25, v22
  s_cmp_eq_u32 s47, 1
  s_cbranch_scc1 id_252
  v_and_b32 v23, 0xe3, v22
  v_bfe_u32 v24, v22, 2, 1
  v_lshl_add_u32 v23, v24, 4, v23
  v_bfe_u32 v24, v22, 3, 2
  v_lshl_add_u32 v22, v24, 2, v23
  v_mul_u32_u24 v23, 1366, v22
  v_lshrrev_b32 v23, 16, v23
  v_mul_u32_u24 v25, 48, v23
  v_sub_u32 v22, v22, v25
  v_mul_u32_u24 v26, 5462, v22
  v_lshrrev_b32 v26, 16, v26
  v_mul_u32_u24 v27, 12, v26
  v_sub_u32 v22, v22, v27
  v_lshrrev_b32 v27, 2, v22
  v_and_b32 v22, 3, v22
  v_lshl_add_u32 v25, v27, 4, v25
  v_lshl_add_u32 v25, v26, 2, v25
  v_add_u32 v25, v25, v22
id_252:
  v_mul_u32_u24 v25, 1280, v25
  v_lshl_add_u32 v73, v21, 4, v25
  s_mul_i32 s21, s20, 320
  s_add_u32 s21, s21, 0
  v_add_u32 v21, s21, v1
  v_mul_u32_u24 v22, v21, v29
  v_lshrrev_b32 v22, 16, v22
  v_mul_u32_u24 v23, 20, v22
  v_sub_u32 v21, v21, v23
  v_add_u32 v22, 128, v22
  v_mov_b32 v25, v22
  s_cmp_eq_u32 s47, 1
  s_cbranch_scc1 id_253
  v_and_b32 v23, 0xe3, v22
  v_bfe_u32 v24, v22, 2, 1
  v_lshl_add_u32 v23, v24, 4, v23
  v_bfe_u32 v24, v22, 3, 2
  v_lshl_add_u32 v22, v24, 2, v23
  v_mul_u32_u24 v23, 1366, v22
  v_lshrrev_b32 v23, 16, v23
  v_mul_u32_u24 v25, 48, v23
  v_sub_u32 v22, v22, v25
  v_mul_u32_u24 v26, 5462, v22
  v_lshrrev_b32 v26, 16, v26
  v_mul_u32_u24 v27, 12, v26
  v_sub_u32 v22, v22, v27
  v_lshrrev_b32 v27, 2, v22
  v_and_b32 v22, 3, v22
  v_lshl_add_u32 v25, v27, 4, v25
  v_lshl_add_u32 v25, v26, 2, v25
  v_add_u32 v25, v25, v22
id_253:
  v_mul_u32_u24 v25, 1280, v25
  v_lshl_add_u32 v74, v21, 4, v25
  s_mul_i32 s21, s20, 320
  s_add_u32 s21, s21, 64
  v_add_u32 v21, s21, v1
  v_mul_u32_u24 v22, v21, v29
  v_lshrrev_b32 v22, 16, v22
  v_mul_u32_u24 v23, 20, v22
  v_sub_u32 v21, v21, v23
  v_add_u32 v22, 128, v22
  v_mov_b32 v25, v22
  s_cmp_eq_u32 s47, 1
  s_cbranch_scc1 id_254
  v_and_b32 v23, 0xe3, v22
  v_bfe_u32 v24, v22, 2, 1
  v_lshl_add_u32 v23, v24, 4, v23
  v_bfe_u32 v24, v22, 3, 2
  v_lshl_add_u32 v22, v24, 2, v23
  v_mul_u32_u24 v23, 1366, v22
  v_lshrrev_b32 v23, 16, v23
  v_mul_u32_u24 v25, 48, v23
  v_sub_u32 v22, v22, v25
  v_mul_u32_u24 v26, 5462, v22
  v_lshrrev_b32 v26, 16, v26
  v_mul_u32_u24 v27, 12, v26
  v_sub_u32 v22, v22, v27
  v_lshrrev_b32 v27, 2, v22
  v_and_b32 v22, 3, v22
  v_lshl_add_u32 v25, v27, 4, v25
  v_lshl_add_u32 v25, v26, 2, v25
  v_add_u32 v25, v25, v22
id_254:
  v_mul_u32_u24 v25, 1280, v25
  v_lshl_add_u32 v75, v21, 4, v25
  s_mul_i32 s21, s20, 320
  s_add_u32 s21, s21, 128
  v_add_u32 v21, s21, v1
  v_mul_u32_u24 v22, v21, v29
  v_lshrrev_b32 v22, 16, v22
  v_mul_u32_u24 v23, 20, v22
  v_sub_u32 v21, v21, v23
  v_add_u32 v22, 128, v22
  v_mov_b32 v25, v22
  s_cmp_eq_u32 s47, 1
  s_cbranch_scc1 id_255
  v_and_b32 v23, 0xe3, v22
  v_bfe_u32 v24, v22, 2, 1
  v_lshl_add_u32 v23, v24, 4, v23
  v_bfe_u32 v24, v22, 3, 2
  v_lshl_add_u32 v22, v24, 2, v23
  v_mul_u32_u24 v23, 1366, v22
  v_lshrrev_b32 v23, 16, v23
  v_mul_u32_u24 v25, 48, v23
  v_sub_u32 v22, v22, v25
  v_mul_u32_u24 v26, 5462, v22
  v_lshrrev_b32 v26, 16, v26
  v_mul_u32_u24 v27, 12, v26
  v_sub_u32 v22, v22, v27
  v_lshrrev_b32 v27, 2, v22
  v_and_b32 v22, 3, v22
  v_lshl_add_u32 v25, v27, 4, v25
  v_lshl_add_u32 v25, v26, 2, v25
  v_add_u32 v25, v25, v22
id_255:
  v_mul_u32_u24 v25, 1280, v25
  v_lshl_add_u32 v76, v21, 4, v25
  s_mul_i32 s21, s20, 320
  s_add_u32 s21, s21, 192
  v_add_u32 v21, s21, v1
  v_mul_u32_u24 v22, v21, v29
  v_lshrrev_b32 v22, 16, v22
  v_mul_u32_u24 v23, 20, v22
  v_sub_u32 v21, v21, v23
  v_add_u32 v22, 128, v22
  v_mov_b32 v25, v22
  s_cmp_eq_u32 s47, 1
  s_cbranch_scc1 id_256
  v_and_b32 v23, 0xe3, v22
  v_bfe_u32 v24, v22, 2, 1
  v_lshl_add_u32 v23, v24, 4, v23
  v_bfe_u32 v24, v22, 3, 2
  v_lshl_add_u32 v22, v24, 2, v23
  v_mul_u32_u24 v23, 1366, v22
  v_lshrrev_b32 v23, 16, v23
  v_mul_u32_u24 v25, 48, v23
  v_sub_u32 v22, v22, v25
  v_mul_u32_u24 v26, 5462, v22
  v_lshrrev_b32 v26, 16, v26
  v_mul_u32_u24 v27, 12, v26
  v_sub_u32 v22, v22, v27
  v_lshrrev_b32 v27, 2, v22
  v_and_b32 v22, 3, v22
  v_lshl_add_u32 v25, v27, 4, v25
  v_lshl_add_u32 v25, v26, 2, v25
  v_add_u32 v25, v25, v22
id_256:
  v_mul_u32_u24 v25, 1280, v25
  v_lshl_add_u32 v77, v21, 4, v25
  s_mul_i32 s21, s20, 320
  s_add_u32 s21, s21, 256
  v_add_u32 v21, s21, v1
  v_mul_u32_u24 v22, v21, v29
  v_lshrrev_b32 v22, 16, v22
  v_mul_u32_u24 v23, 20, v22
  v_sub_u32 v21, v21, v23
  v_add_u32 v22, 128, v22
  v_mov_b32 v25, v22
  s_cmp_eq_u32 s47, 1
  s_cbranch_scc1 id_257
  v_and_b32 v23, 0xe3, v22
  v_bfe_u32 v24, v22, 2, 1
  v_lshl_add_u32 v23, v24, 4, v23
  v_bfe_u32 v24, v22, 3, 2
  v_lshl_add_u32 v22, v24, 2, v23
  v_mul_u32_u24 v23, 1366, v22
  v_lshrrev_b32 v23, 16, v23
  v_mul_u32_u24 v25, 48, v23
  v_sub_u32 v22, v22, v25
  v_mul_u32_u24 v26, 5462, v22
  v_lshrrev_b32 v26, 16, v26
  v_mul_u32_u24 v27, 12, v26
  v_sub_u32 v22, v22, v27
  v_lshrrev_b32 v27, 2, v22
  v_and_b32 v22, 3, v22
  v_lshl_add_u32 v25, v27, 4, v25
  v_lshl_add_u32 v25, v26, 2, v25
  v_add_u32 v25, v25, v22
id_257:
  v_mul_u32_u24 v25, 1280, v25
  v_lshl_add_u32 v78, v21, 4, v25
  s_lshr_b32 s21, s20, 1
  s_lshl_b32 s21, s21, 13
  v_add_u32 v5, s21, v4
  v_lshrrev_b32 v6, 2, v2
  v_lshl_add_u32 v6, v3, 3, v6
  v_mul_u32_u24 v6, 320, v6
  v_and_b32 v7, 3, v2
  v_lshlrev_b32 v7, 3, v7
  s_and_b32 s21, s20, 1
  s_mul_i32 s21, s21, 160
  s_add_u32 s21, s21, 16384
  v_add3_u32 v6, v6, v7, s21
  s_mov_b32 s50, 0
  s_mov_b32 s51, 0
  v_and_b32 v21, 1, v2
  v_lshlrev_b32 v21, 14, v21
  v_lshl_add_u32 v21, v3, 15, v21
  v_lshrrev_b32 v22, 1, v2
  v_lshl_add_u32 v12, v22, 4, v21
  v_add_u32 v13, 130048, v12
  v_mov_b32 v80, 0
  v_mov_b32 v81, 0
  v_mov_b32 v82, 0
  v_mov_b32 v83, 0
  v_mov_b32 v84, 0
  v_mov_b32 v85, 0
  v_mov_b32 v86, 0
  v_mov_b32 v87, 0
  v_mov_b32 v88, 0
  v_mov_b32 v89, 0
  v_mov_b32 v90, 0
  v_mov_b32 v91, 0
  v_mov_b32 v92, 0
  v_mov_b32 v93, 0
  v_mov_b32 v94, 0
  v_mov_b32 v95, 0
  v_mov_b32 v96, 0
  v_mov_b32 v97, 0
  v_mov_b32 v98, 0
  v_mov_b32 v99, 0
  v_mov_b32 v100, 0
  v_mov_b32 v101, 0
  v_mov_b32 v102, 0
  v_mov_b32 v103, 0
  v_mov_b32 v104, 0
  v_mov_b32 v105, 0
  v_mov_b32 v106, 0
  v_mov_b32 v107, 0
  v_mov_b32 v108, 0
  v_mov_b32 v109, 0
  v_mov_b32 v110, 0
  v_mov_b32 v111, 0
  v_mov_b32 v112, 0
  v_mov_b32 v113, 0
  v_mov_b32 v114, 0
  v_mov_b32 v115, 0
  v_mov_b32 v116, 0
  v_mov_b32 v117, 0
  v_mov_b32 v118, 0
  v_mov_b32 v119, 0
  v_mov_b32 v120, 0
  v_mov_b32 v121, 0
  v_mov_b32 v122, 0
  v_mov_b32 v123, 0
  v_mov_b32 v124, 0
  v_mov_b32 v125, 0
  v_mov_b32 v126, 0
  v_mov_b32 v127, 0
  v_mov_b32 v128, 0
  v_mov_b32 v129, 0
  v_mov_b32 v130, 0
  v_mov_b32 v131, 0
  v_mov_b32 v132, 0
  v_mov_b32 v133, 0
  v_mov_b32 v134, 0
  v_mov_b32 v135, 0
  v_mov_b32 v136, 0
  v_mov_b32 v137, 0
  v_mov_b32 v138, 0
  v_mov_b32 v139, 0
  v_mov_b32 v140, 0
  v_mov_b32 v141, 0
  v_mov_b32 v142, 0
  v_mov_b32 v143, 0
  v_mov_b32 v144, 0
  v_mov_b32 v145, 0
  v_mov_b32 v146, 0
  v_mov_b32 v147, 0
  v_mov_b32 v148, 0
  v_mov_b32 v149, 0
  v_mov_b32 v150, 0
  v_mov_b32 v151, 0
  v_mov_b32 v152, 0
  v_mov_b32 v153, 0
  v_mov_b32 v154, 0
  v_mov_b32 v155, 0
  v_mov_b32 v156, 0
  v_mov_b32 v157, 0
  v_mov_b32 v158, 0
  v_mov_b32 v159, 0
  s_mul_i32 s53, s44, 262144
  s_add_u32 s53, s53, s48
  s_sub_u32 s53, s53, 262144
  s_load_dwordx2 s[72:73], s[0:1], 104
  s_waitcnt lgkmcnt(0)
  s_add_u32 s72, s72, 81068032
  s_addc_u32 s73, s73, 0
  s_mov_b32 s74, 117760
  s_mov_b32 s75, 0x00020000
  s_lshl_b32 s21, s40, 7
  s_add_u32 s21, s21, 92160
  s_mov_b32 s23, 4
  s_mov_b32 s21, 92160
  s_mov_b32 s23, 32
  s_cmp_lg_u32 s20, 0
  s_cbranch_scc1 wf_259
  v_mov_b32 v10, 0
  s_mov_b32 s101, 0
wf_258:
  buffer_load_dword v11, v10, s[72:75], s21 offen sc1
  s_add_u32 s101, s101, 1
  s_cmp_gt_u32 s101, 131072
  s_cbranch_scc1 main_end
  s_waitcnt vmcnt(0)
  v_readfirstlane_b32 s100, v11
  s_cmp_ge_u32 s100, s23
  s_cbranch_scc1 wf_259
  s_sleep 8
  s_add_u32 s100, s100, 8
  s_cmp_ge_u32 s100, s23
  s_cbranch_scc1 wf_258
  s_sleep 60
  s_branch wf_258
wf_259:
  s_barrier
  s_lshl_b32 s22, s20, 12
  s_add_u32 s22, s22, s50
  s_add_u32 s23, s48, s45
  s_add_u32 m0, s22, 0
  s_nop 0
  buffer_load_dwordx4 v12, s[12:15], s48 offen offset:0 sc1 lds
  s_add_u32 m0, s22, 0
  s_nop 0
  buffer_load_dwordx4 v13, s[12:15], s48 offen offset:1024 sc1 lds
  s_add_u32 m0, s22, 2048
  s_nop 0
  buffer_load_dwordx4 v12, s[12:15], s23 offen offset:0 sc1 lds
  s_add_u32 m0, s22, 2048
  s_nop 0
  buffer_load_dwordx4 v13, s[12:15], s23 offen offset:1024 sc1 lds
  s_mul_i32 s22, s20, 5120
  s_add_u32 s22, s22, s50
  s_add_u32 s22, s22, 16384
  s_add_u32 m0, s22, 0
  s_nop 0
  buffer_load_dwordx4 v64, s[8:11], s49 offen lds
  s_add_u32 m0, s22, 1024
  s_nop 0
  buffer_load_dwordx4 v65, s[8:11], s49 offen lds
  s_add_u32 m0, s22, 2048
  s_nop 0
  buffer_load_dwordx4 v66, s[8:11], s49 offen lds
  s_add_u32 m0, s22, 3072
  s_nop 0
  buffer_load_dwordx4 v67, s[8:11], s49 offen lds
  s_add_u32 m0, s22, 4096
  s_nop 0
  buffer_load_dwordx4 v68, s[8:11], s49 offen lds
  s_add_u32 s48, s48, 262144
  s_min_u32 s48, s48, s53
  s_add_u32 s50, s50, 36864
  s_cmp_lt_u32 s50, 147456
  s_cselect_b32 s50, s50, 0
  s_lshl_b32 s22, s20, 12
  s_add_u32 s22, s22, s50
  s_add_u32 s23, s48, s45
  s_add_u32 m0, s22, 0
  s_nop 0
  buffer_load_dwordx4 v12, s[12:15], s48 offen offset:0 sc1 lds
  s_add_u32 m0, s22, 0
  s_nop 0
  buffer_load_dwordx4 v13, s[12:15], s48 offen offset:1024 sc1 lds
  s_add_u32 m0, s22, 2048
  s_nop 0
  buffer_load_dwordx4 v12, s[12:15], s23 offen offset:0 sc1 lds
  s_add_u32 m0, s22, 2048
  s_nop 0
  buffer_load_dwordx4 v13, s[12:15], s23 offen offset:1024 sc1 lds
  s_mul_i32 s22, s20, 5120
  s_add_u32 s22, s22, s50
  s_add_u32 s22, s22, 16384
  s_add_u32 m0, s22, 0
  s_nop 0
  buffer_load_dwordx4 v69, s[8:11], s49 offen lds
  s_add_u32 m0, s22, 1024
  s_nop 0
  buffer_load_dwordx4 v70, s[8:11], s49 offen lds
  s_add_u32 m0, s22, 2048
  s_nop 0
  buffer_load_dwordx4 v71, s[8:11], s49 offen lds
  s_add_u32 m0, s22, 3072
  s_nop 0
  buffer_load_dwordx4 v72, s[8:11], s49 offen lds
  s_add_u32 m0, s22, 4096
  s_nop 0
  buffer_load_dwordx4 v73, s[8:11], s49 offen lds
  s_add_u32 s48, s48, 262144
  s_min_u32 s48, s48, s53
  s_add_u32 s50, s50, 36864
  s_cmp_lt_u32 s50, 147456
  s_cselect_b32 s50, s50, 0
  s_lshl_b32 s22, s20, 12
  s_add_u32 s22, s22, s50
  s_add_u32 s23, s48, s45
  s_add_u32 m0, s22, 0
  s_nop 0
  buffer_load_dwordx4 v12, s[12:15], s48 offen offset:0 sc1 lds
  s_add_u32 m0, s22, 0
  s_nop 0
  buffer_load_dwordx4 v13, s[12:15], s48 offen offset:1024 sc1 lds
  s_add_u32 m0, s22, 2048
  s_nop 0
  buffer_load_dwordx4 v12, s[12:15], s23 offen offset:0 sc1 lds
  s_add_u32 m0, s22, 2048
  s_nop 0
  buffer_load_dwordx4 v13, s[12:15], s23 offen offset:1024 sc1 lds
  s_mul_i32 s22, s20, 5120
  s_add_u32 s22, s22, s50
  s_add_u32 s22, s22, 16384
  s_add_u32 m0, s22, 0
  s_nop 0
  buffer_load_dwordx4 v74, s[8:11], s49 offen lds
  s_add_u32 m0, s22, 1024
  s_nop 0
  buffer_load_dwordx4 v75, s[8:11], s49 offen lds
  s_add_u32 m0, s22, 2048
  s_nop 0
  buffer_load_dwordx4 v76, s[8:11], s49 offen lds
  s_add_u32 m0, s22, 3072
  s_nop 0
  buffer_load_dwordx4 v77, s[8:11], s49 offen lds
  s_add_u32 m0, s22, 4096
  s_nop 0
  buffer_load_dwordx4 v78, s[8:11], s49 offen lds
  s_add_u32 s48, s48, 262144
  s_min_u32 s48, s48, s53
  s_add_u32 s49, s49, 245760
  s_add_u32 s50, s50, 36864
  s_cmp_lt_u32 s50, 147456
  s_cselect_b32 s50, s50, 0
  s_mov_b32 s52, 0
op_260:
  s_waitcnt vmcnt(18)
  s_barrier
  v_add_u32 v8, s51, v5
  v_add_u32 v9, s51, v6
  s_add_u32 s51, s51, 36864
  s_cmp_lt_u32 s51, 147456
  s_cselect_b32 s51, s51, 0
  ds_read_b128 v[160:163], v8 offset:0
  ds_read_b128 v[164:167], v8 offset:2048
  ds_read_b128 v[168:171], v8 offset:4096
  ds_read_b128 v[172:175], v8 offset:6144
  ds_read_b64_tr_b16 v[176:177], v9 offset:0
  ds_read_b64_tr_b16 v[178:179], v9 offset:1280
  ds_read_b64_tr_b16 v[180:181], v9 offset:32
  ds_read_b64_tr_b16 v[182:183], v9 offset:1312
  ds_read_b64_tr_b16 v[184:185], v9 offset:64
  ds_read_b64_tr_b16 v[186:187], v9 offset:1344
  ds_read_b64_tr_b16 v[188:189], v9 offset:96
  ds_read_b64_tr_b16 v[190:191], v9 offset:1376
  ds_read_b64_tr_b16 v[192:193], v9 offset:128
  ds_read_b64_tr_b16 v[194:195], v9 offset:1408
  s_lshl_b32 s22, s20, 12
  s_add_u32 s22, s22, s50
  s_add_u32 s23, s48, s45
  s_add_u32 m0, s22, 0
  s_nop 0
  buffer_load_dwordx4 v12, s[12:15], s48 offen offset:0 sc1 lds
  s_add_u32 m0, s22, 0
  s_nop 0
  buffer_load_dwordx4 v13, s[12:15], s48 offen offset:1024 sc1 lds
  s_add_u32 m0, s22, 2048
  s_nop 0
  buffer_load_dwordx4 v12, s[12:15], s23 offen offset:0 sc1 lds
  s_add_u32 m0, s22, 2048
  s_nop 0
  buffer_load_dwordx4 v13, s[12:15], s23 offen offset:1024 sc1 lds
  ds_read_b128 v[196:199], v8 offset:1024
  ds_read_b128 v[200:203], v8 offset:3072
  ds_read_b128 v[204:207], v8 offset:5120
  ds_read_b128 v[208:211], v8 offset:7168
  ds_read_b64_tr_b16 v[212:213], v9 offset:10240
  ds_read_b64_tr_b16 v[214:215], v9 offset:11520
  ds_read_b64_tr_b16 v[216:217], v9 offset:10272
  ds_read_b64_tr_b16 v[218:219], v9 offset:11552
  ds_read_b64_tr_b16 v[220:221], v9 offset:10304
  ds_read_b64_tr_b16 v[222:223], v9 offset:11584
  ds_read_b64_tr_b16 v[224:225], v9 offset:10336
  ds_read_b64_tr_b16 v[226:227], v9 offset:11616
  ds_read_b64_tr_b16 v[228:229], v9 offset:10368
  ds_read_b64_tr_b16 v[230:231], v9 offset:11648
  s_waitcnt lgkmcnt(14)
  v_mfma_f32_16x16x32_bf16 v[80:83], v[176:179], v[160:163], v[80:83]
  v_mfma_f32_16x16x32_bf16 v[84:87], v[180:183], v[160:163], v[84:87]
  v_mfma_f32_16x16x32_bf16 v[88:91], v[184:187], v[160:163], v[88:91]
  v_mfma_f32_16x16x32_bf16 v[92:95], v[188:191], v[160:163], v[92:95]
  v_mfma_f32_16x16x32_bf16 v[96:99], v[192:195], v[160:163], v[96:99]
  v_mfma_f32_16x16x32_bf16 v[100:103], v[176:179], v[164:167], v[100:103]
  v_mfma_f32_16x16x32_bf16 v[104:107], v[180:183], v[164:167], v[104:107]
  v_mfma_f32_16x16x32_bf16 v[108:111], v[184:187], v[164:167], v[108:111]
  v_mfma_f32_16x16x32_bf16 v[112:115], v[188:191], v[164:167], v[112:115]
  v_mfma_f32_16x16x32_bf16 v[116:119], v[192:195], v[164:167], v[116:119]
  v_mfma_f32_16x16x32_bf16 v[120:123], v[176:179], v[168:171], v[120:123]
  v_mfma_f32_16x16x32_bf16 v[124:127], v[180:183], v[168:171], v[124:127]
  v_mfma_f32_16x16x32_bf16 v[128:131], v[184:187], v[168:171], v[128:131]
  v_mfma_f32_16x16x32_bf16 v[132:135], v[188:191], v[168:171], v[132:135]
  v_mfma_f32_16x16x32_bf16 v[136:139], v[192:195], v[168:171], v[136:139]
  v_mfma_f32_16x16x32_bf16 v[140:143], v[176:179], v[172:175], v[140:143]
  v_mfma_f32_16x16x32_bf16 v[144:147], v[180:183], v[172:175], v[144:147]
  v_mfma_f32_16x16x32_bf16 v[148:151], v[184:187], v[172:175], v[148:151]
  v_mfma_f32_16x16x32_bf16 v[152:155], v[188:191], v[172:175], v[152:155]
  v_mfma_f32_16x16x32_bf16 v[156:159], v[192:195], v[172:175], v[156:159]
  s_mul_i32 s22, s20, 5120
  s_add_u32 s22, s22, s50
  s_add_u32 s22, s22, 16384
  s_add_u32 m0, s22, 0
  s_nop 0
  buffer_load_dwordx4 v64, s[8:11], s49 offen lds
  s_add_u32 m0, s22, 1024
  s_nop 0
  buffer_load_dwordx4 v65, s[8:11], s49 offen lds
  s_add_u32 m0, s22, 2048
  s_nop 0
  buffer_load_dwordx4 v66, s[8:11], s49 offen lds
  s_add_u32 m0, s22, 3072
  s_nop 0
  buffer_load_dwordx4 v67, s[8:11], s49 offen lds
  s_add_u32 m0, s22, 4096
  s_nop 0
  buffer_load_dwordx4 v68, s[8:11], s49 offen lds
  s_add_u32 s48, s48, 262144
  s_min_u32 s48, s48, s53
  s_add_u32 s50, s50, 36864
  s_cmp_lt_u32 s50, 147456
  s_cselect_b32 s50, s50, 0
  s_waitcnt lgkmcnt(0)
  v_mfma_f32_16x16x32_bf16 v[80:83], v[212:215], v[196:199], v[80:83]
  v_mfma_f32_16x16x32_bf16 v[84:87], v[216:219], v[196:199], v[84:87]
  v_mfma_f32_16x16x32_bf16 v[88:91], v[220:223], v[196:199], v[88:91]
  v_mfma_f32_16x16x32_bf16 v[92:95], v[224:227], v[196:199], v[92:95]
  v_mfma_f32_16x16x32_bf16 v[96:99], v[228:231], v[196:199], v[96:99]
  v_mfma_f32_16x16x32_bf16 v[100:103], v[212:215], v[200:203], v[100:103]
  v_mfma_f32_16x16x32_bf16 v[104:107], v[216:219], v[200:203], v[104:107]
  v_mfma_f32_16x16x32_bf16 v[108:111], v[220:223], v[200:203], v[108:111]
  v_mfma_f32_16x16x32_bf16 v[112:115], v[224:227], v[200:203], v[112:115]
  v_mfma_f32_16x16x32_bf16 v[116:119], v[228:231], v[200:203], v[116:119]
  v_mfma_f32_16x16x32_bf16 v[120:123], v[212:215], v[204:207], v[120:123]
  v_mfma_f32_16x16x32_bf16 v[124:127], v[216:219], v[204:207], v[124:127]
  v_mfma_f32_16x16x32_bf16 v[128:131], v[220:223], v[204:207], v[128:131]
  v_mfma_f32_16x16x32_bf16 v[132:135], v[224:227], v[204:207], v[132:135]
  v_mfma_f32_16x16x32_bf16 v[136:139], v[228:231], v[204:207], v[136:139]
  v_mfma_f32_16x16x32_bf16 v[140:143], v[212:215], v[208:211], v[140:143]
  v_mfma_f32_16x16x32_bf16 v[144:147], v[216:219], v[208:211], v[144:147]
  v_mfma_f32_16x16x32_bf16 v[148:151], v[220:223], v[208:211], v[148:151]
  v_mfma_f32_16x16x32_bf16 v[152:155], v[224:227], v[208:211], v[152:155]
  v_mfma_f32_16x16x32_bf16 v[156:159], v[228:231], v[208:211], v[156:159]
  s_add_u32 s52, s52, 1
  s_cmp_ge_u32 s52, s44
  s_cbranch_scc1 opd_261
  s_waitcnt vmcnt(18)
  s_barrier
  v_add_u32 v8, s51, v5
  v_add_u32 v9, s51, v6
  s_add_u32 s51, s51, 36864
  s_cmp_lt_u32 s51, 147456
  s_cselect_b32 s51, s51, 0
  ds_read_b128 v[160:163], v8 offset:0
  ds_read_b128 v[164:167], v8 offset:2048
  ds_read_b128 v[168:171], v8 offset:4096
  ds_read_b128 v[172:175], v8 offset:6144
  ds_read_b64_tr_b16 v[176:177], v9 offset:0
  ds_read_b64_tr_b16 v[178:179], v9 offset:1280
  ds_read_b64_tr_b16 v[180:181], v9 offset:32
  ds_read_b64_tr_b16 v[182:183], v9 offset:1312
  ds_read_b64_tr_b16 v[184:185], v9 offset:64
  ds_read_b64_tr_b16 v[186:187], v9 offset:1344
  ds_read_b64_tr_b16 v[188:189], v9 offset:96
  ds_read_b64_tr_b16 v[190:191], v9 offset:1376
  ds_read_b64_tr_b16 v[192:193], v9 offset:128
  ds_read_b64_tr_b16 v[194:195], v9 offset:1408
  s_lshl_b32 s22, s20, 12
  s_add_u32 s22, s22, s50
  s_add_u32 s23, s48, s45
  s_add_u32 m0, s22, 0
  s_nop 0
  buffer_load_dwordx4 v12, s[12:15], s48 offen offset:0 sc1 lds
  s_add_u32 m0, s22, 0
  s_nop 0
  buffer_load_dwordx4 v13, s[12:15], s48 offen offset:1024 sc1 lds
  s_add_u32 m0, s22, 2048
  s_nop 0
  buffer_load_dwordx4 v12, s[12:15], s23 offen offset:0 sc1 lds
  s_add_u32 m0, s22, 2048
  s_nop 0
  buffer_load_dwordx4 v13, s[12:15], s23 offen offset:1024 sc1 lds
  ds_read_b128 v[196:199], v8 offset:1024
  ds_read_b128 v[200:203], v8 offset:3072
  ds_read_b128 v[204:207], v8 offset:5120
  ds_read_b128 v[208:211], v8 offset:7168
  ds_read_b64_tr_b16 v[212:213], v9 offset:10240
  ds_read_b64_tr_b16 v[214:215], v9 offset:11520
  ds_read_b64_tr_b16 v[216:217], v9 offset:10272
  ds_read_b64_tr_b16 v[218:219], v9 offset:11552
  ds_read_b64_tr_b16 v[220:221], v9 offset:10304
  ds_read_b64_tr_b16 v[222:223], v9 offset:11584
  ds_read_b64_tr_b16 v[224:225], v9 offset:10336
  ds_read_b64_tr_b16 v[226:227], v9 offset:11616
  ds_read_b64_tr_b16 v[228:229], v9 offset:10368
  ds_read_b64_tr_b16 v[230:231], v9 offset:11648
  s_waitcnt lgkmcnt(14)
  v_mfma_f32_16x16x32_bf16 v[80:83], v[176:179], v[160:163], v[80:83]
  v_mfma_f32_16x16x32_bf16 v[84:87], v[180:183], v[160:163], v[84:87]
  v_mfma_f32_16x16x32_bf16 v[88:91], v[184:187], v[160:163], v[88:91]
  v_mfma_f32_16x16x32_bf16 v[92:95], v[188:191], v[160:163], v[92:95]
  v_mfma_f32_16x16x32_bf16 v[96:99], v[192:195], v[160:163], v[96:99]
  v_mfma_f32_16x16x32_bf16 v[100:103], v[176:179], v[164:167], v[100:103]
  v_mfma_f32_16x16x32_bf16 v[104:107], v[180:183], v[164:167], v[104:107]
  v_mfma_f32_16x16x32_bf16 v[108:111], v[184:187], v[164:167], v[108:111]
  v_mfma_f32_16x16x32_bf16 v[112:115], v[188:191], v[164:167], v[112:115]
  v_mfma_f32_16x16x32_bf16 v[116:119], v[192:195], v[164:167], v[116:119]
  v_mfma_f32_16x16x32_bf16 v[120:123], v[176:179], v[168:171], v[120:123]
  v_mfma_f32_16x16x32_bf16 v[124:127], v[180:183], v[168:171], v[124:127]
  v_mfma_f32_16x16x32_bf16 v[128:131], v[184:187], v[168:171], v[128:131]
  v_mfma_f32_16x16x32_bf16 v[132:135], v[188:191], v[168:171], v[132:135]
  v_mfma_f32_16x16x32_bf16 v[136:139], v[192:195], v[168:171], v[136:139]
  v_mfma_f32_16x16x32_bf16 v[140:143], v[176:179], v[172:175], v[140:143]
  v_mfma_f32_16x16x32_bf16 v[144:147], v[180:183], v[172:175], v[144:147]
  v_mfma_f32_16x16x32_bf16 v[148:151], v[184:187], v[172:175], v[148:151]
  v_mfma_f32_16x16x32_bf16 v[152:155], v[188:191], v[172:175], v[152:155]
  v_mfma_f32_16x16x32_bf16 v[156:159], v[192:195], v[172:175], v[156:159]
  s_mul_i32 s22, s20, 5120
  s_add_u32 s22, s22, s50
  s_add_u32 s22, s22, 16384
  s_add_u32 m0, s22, 0
  s_nop 0
  buffer_load_dwordx4 v69, s[8:11], s49 offen lds
  s_add_u32 m0, s22, 1024
  s_nop 0
  buffer_load_dwordx4 v70, s[8:11], s49 offen lds
  s_add_u32 m0, s22, 2048
  s_nop 0
  buffer_load_dwordx4 v71, s[8:11], s49 offen lds
  s_add_u32 m0, s22, 3072
  s_nop 0
  buffer_load_dwordx4 v72, s[8:11], s49 offen lds
  s_add_u32 m0, s22, 4096
  s_nop 0
  buffer_load_dwordx4 v73, s[8:11], s49 offen lds
  s_add_u32 s48, s48, 262144
  s_min_u32 s48, s48, s53
  s_add_u32 s50, s50, 36864
  s_cmp_lt_u32 s50, 147456
  s_cselect_b32 s50, s50, 0
  s_waitcnt lgkmcnt(0)
  v_mfma_f32_16x16x32_bf16 v[80:83], v[212:215], v[196:199], v[80:83]
  v_mfma_f32_16x16x32_bf16 v[84:87], v[216:219], v[196:199], v[84:87]
  v_mfma_f32_16x16x32_bf16 v[88:91], v[220:223], v[196:199], v[88:91]
  v_mfma_f32_16x16x32_bf16 v[92:95], v[224:227], v[196:199], v[92:95]
  v_mfma_f32_16x16x32_bf16 v[96:99], v[228:231], v[196:199], v[96:99]
  v_mfma_f32_16x16x32_bf16 v[100:103], v[212:215], v[200:203], v[100:103]
  v_mfma_f32_16x16x32_bf16 v[104:107], v[216:219], v[200:203], v[104:107]
  v_mfma_f32_16x16x32_bf16 v[108:111], v[220:223], v[200:203], v[108:111]
  v_mfma_f32_16x16x32_bf16 v[112:115], v[224:227], v[200:203], v[112:115]
  v_mfma_f32_16x16x32_bf16 v[116:119], v[228:231], v[200:203], v[116:119]
  v_mfma_f32_16x16x32_bf16 v[120:123], v[212:215], v[204:207], v[120:123]
  v_mfma_f32_16x16x32_bf16 v[124:127], v[216:219], v[204:207], v[124:127]
  v_mfma_f32_16x16x32_bf16 v[128:131], v[220:223], v[204:207], v[128:131]
  v_mfma_f32_16x16x32_bf16 v[132:135], v[224:227], v[204:207], v[132:135]
  v_mfma_f32_16x16x32_bf16 v[136:139], v[228:231], v[204:207], v[136:139]
  v_mfma_f32_16x16x32_bf16 v[140:143], v[212:215], v[208:211], v[140:143]
  v_mfma_f32_16x16x32_bf16 v[144:147], v[216:219], v[208:211], v[144:147]
  v_mfma_f32_16x16x32_bf16 v[148:151], v[220:223], v[208:211], v[148:151]
  v_mfma_f32_16x16x32_bf16 v[152:155], v[224:227], v[208:211], v[152:155]
  v_mfma_f32_16x16x32_bf16 v[156:159], v[228:231], v[208:211], v[156:159]
  s_add_u32 s52, s52, 1
  s_cmp_ge_u32 s52, s44
  s_cbranch_scc1 opd_261
  s_waitcnt vmcnt(18)
  s_barrier
  v_add_u32 v8, s51, v5
  v_add_u32 v9, s51, v6
  s_add_u32 s51, s51, 36864
  s_cmp_lt_u32 s51, 147456
  s_cselect_b32 s51, s51, 0
  ds_read_b128 v[160:163], v8 offset:0
  ds_read_b128 v[164:167], v8 offset:2048
  ds_read_b128 v[168:171], v8 offset:4096
  ds_read_b128 v[172:175], v8 offset:6144
  ds_read_b64_tr_b16 v[176:177], v9 offset:0
  ds_read_b64_tr_b16 v[178:179], v9 offset:1280
  ds_read_b64_tr_b16 v[180:181], v9 offset:32
  ds_read_b64_tr_b16 v[182:183], v9 offset:1312
  ds_read_b64_tr_b16 v[184:185], v9 offset:64
  ds_read_b64_tr_b16 v[186:187], v9 offset:1344
  ds_read_b64_tr_b16 v[188:189], v9 offset:96
  ds_read_b64_tr_b16 v[190:191], v9 offset:1376
  ds_read_b64_tr_b16 v[192:193], v9 offset:128
  ds_read_b64_tr_b16 v[194:195], v9 offset:1408
  s_lshl_b32 s22, s20, 12
  s_add_u32 s22, s22, s50
  s_add_u32 s23, s48, s45
  s_add_u32 m0, s22, 0
  s_nop 0
  buffer_load_dwordx4 v12, s[12:15], s48 offen offset:0 sc1 lds
  s_add_u32 m0, s22, 0
  s_nop 0
  buffer_load_dwordx4 v13, s[12:15], s48 offen offset:1024 sc1 lds
  s_add_u32 m0, s22, 2048
  s_nop 0
  buffer_load_dwordx4 v12, s[12:15], s23 offen offset:0 sc1 lds
  s_add_u32 m0, s22, 2048
  s_nop 0
  buffer_load_dwordx4 v13, s[12:15], s23 offen offset:1024 sc1 lds
  ds_read_b128 v[196:199], v8 offset:1024
  ds_read_b128 v[200:203], v8 offset:3072
  ds_read_b128 v[204:207], v8 offset:5120
  ds_read_b128 v[208:211], v8 offset:7168
  ds_read_b64_tr_b16 v[212:213], v9 offset:10240
  ds_read_b64_tr_b16 v[214:215], v9 offset:11520
  ds_read_b64_tr_b16 v[216:217], v9 offset:10272
  ds_read_b64_tr_b16 v[218:219], v9 offset:11552
  ds_read_b64_tr_b16 v[220:221], v9 offset:10304
  ds_read_b64_tr_b16 v[222:223], v9 offset:11584
  ds_read_b64_tr_b16 v[224:225], v9 offset:10336
  ds_read_b64_tr_b16 v[226:227], v9 offset:11616
  ds_read_b64_tr_b16 v[228:229], v9 offset:10368
  ds_read_b64_tr_b16 v[230:231], v9 offset:11648
  s_waitcnt lgkmcnt(14)
  v_mfma_f32_16x16x32_bf16 v[80:83], v[176:179], v[160:163], v[80:83]
  v_mfma_f32_16x16x32_bf16 v[84:87], v[180:183], v[160:163], v[84:87]
  v_mfma_f32_16x16x32_bf16 v[88:91], v[184:187], v[160:163], v[88:91]
  v_mfma_f32_16x16x32_bf16 v[92:95], v[188:191], v[160:163], v[92:95]
  v_mfma_f32_16x16x32_bf16 v[96:99], v[192:195], v[160:163], v[96:99]
  v_mfma_f32_16x16x32_bf16 v[100:103], v[176:179], v[164:167], v[100:103]
  v_mfma_f32_16x16x32_bf16 v[104:107], v[180:183], v[164:167], v[104:107]
  v_mfma_f32_16x16x32_bf16 v[108:111], v[184:187], v[164:167], v[108:111]
  v_mfma_f32_16x16x32_bf16 v[112:115], v[188:191], v[164:167], v[112:115]
  v_mfma_f32_16x16x32_bf16 v[116:119], v[192:195], v[164:167], v[116:119]
  v_mfma_f32_16x16x32_bf16 v[120:123], v[176:179], v[168:171], v[120:123]
  v_mfma_f32_16x16x32_bf16 v[124:127], v[180:183], v[168:171], v[124:127]
  v_mfma_f32_16x16x32_bf16 v[128:131], v[184:187], v[168:171], v[128:131]
  v_mfma_f32_16x16x32_bf16 v[132:135], v[188:191], v[168:171], v[132:135]
  v_mfma_f32_16x16x32_bf16 v[136:139], v[192:195], v[168:171], v[136:139]
  v_mfma_f32_16x16x32_bf16 v[140:143], v[176:179], v[172:175], v[140:143]
  v_mfma_f32_16x16x32_bf16 v[144:147], v[180:183], v[172:175], v[144:147]
  v_mfma_f32_16x16x32_bf16 v[148:151], v[184:187], v[172:175], v[148:151]
  v_mfma_f32_16x16x32_bf16 v[152:155], v[188:191], v[172:175], v[152:155]
  v_mfma_f32_16x16x32_bf16 v[156:159], v[192:195], v[172:175], v[156:159]
  s_mul_i32 s22, s20, 5120
  s_add_u32 s22, s22, s50
  s_add_u32 s22, s22, 16384
  s_add_u32 m0, s22, 0
  s_nop 0
  buffer_load_dwordx4 v74, s[8:11], s49 offen lds
  s_add_u32 m0, s22, 1024
  s_nop 0
  buffer_load_dwordx4 v75, s[8:11], s49 offen lds
  s_add_u32 m0, s22, 2048
  s_nop 0
  buffer_load_dwordx4 v76, s[8:11], s49 offen lds
  s_add_u32 m0, s22, 3072
  s_nop 0
  buffer_load_dwordx4 v77, s[8:11], s49 offen lds
  s_add_u32 m0, s22, 4096
  s_nop 0
  buffer_load_dwordx4 v78, s[8:11], s49 offen lds
  s_add_u32 s48, s48, 262144
  s_min_u32 s48, s48, s53
  s_add_u32 s49, s49, 245760
  s_add_u32 s50, s50, 36864
  s_cmp_lt_u32 s50, 147456
  s_cselect_b32 s50, s50, 0
  s_waitcnt lgkmcnt(0)
  v_mfma_f32_16x16x32_bf16 v[80:83], v[212:215], v[196:199], v[80:83]
  v_mfma_f32_16x16x32_bf16 v[84:87], v[216:219], v[196:199], v[84:87]
  v_mfma_f32_16x16x32_bf16 v[88:91], v[220:223], v[196:199], v[88:91]
  v_mfma_f32_16x16x32_bf16 v[92:95], v[224:227], v[196:199], v[92:95]
  v_mfma_f32_16x16x32_bf16 v[96:99], v[228:231], v[196:199], v[96:99]
  v_mfma_f32_16x16x32_bf16 v[100:103], v[212:215], v[200:203], v[100:103]
  v_mfma_f32_16x16x32_bf16 v[104:107], v[216:219], v[200:203], v[104:107]
  v_mfma_f32_16x16x32_bf16 v[108:111], v[220:223], v[200:203], v[108:111]
  v_mfma_f32_16x16x32_bf16 v[112:115], v[224:227], v[200:203], v[112:115]
  v_mfma_f32_16x16x32_bf16 v[116:119], v[228:231], v[200:203], v[116:119]
  v_mfma_f32_16x16x32_bf16 v[120:123], v[212:215], v[204:207], v[120:123]
  v_mfma_f32_16x16x32_bf16 v[124:127], v[216:219], v[204:207], v[124:127]
  v_mfma_f32_16x16x32_bf16 v[128:131], v[220:223], v[204:207], v[128:131]
  v_mfma_f32_16x16x32_bf16 v[132:135], v[224:227], v[204:207], v[132:135]
  v_mfma_f32_16x16x32_bf16 v[136:139], v[228:231], v[204:207], v[136:139]
  v_mfma_f32_16x16x32_bf16 v[140:143], v[212:215], v[208:211], v[140:143]
  v_mfma_f32_16x16x32_bf16 v[144:147], v[216:219], v[208:211], v[144:147]
  v_mfma_f32_16x16x32_bf16 v[148:151], v[220:223], v[208:211], v[148:151]
  v_mfma_f32_16x16x32_bf16 v[152:155], v[224:227], v[208:211], v[152:155]
  v_mfma_f32_16x16x32_bf16 v[156:159], v[228:231], v[208:211], v[156:159]
  s_add_u32 s52, s52, 1
  s_cmp_ge_u32 s52, s44
  s_cbranch_scc1 opd_261
  s_branch op_260
opd_261:
  s_nop 7
  s_lshl_b32 s21, s40, 3
  s_lshr_b32 s22, s20, 1
  s_lshl_b32 s22, s22, 2
  s_add_u32 s21, s21, s22
  s_mul_i32 s21, s21, 40960
  s_mul_i32 s22, s42, 10
  s_and_b32 s23, s20, 1
  s_mul_i32 s23, s23, 5
  s_add_u32 s22, s22, s23
  s_lshl_b32 s22, s22, 10
  s_add_u32 s21, s21, s22
  buffer_store_dwordx4 v[80:83], v4, s[16:19], s21 offen offset:0 sc1
  buffer_store_dwordx4 v[84:87], v4, s[16:19], s21 offen offset:1024 sc1
  buffer_store_dwordx4 v[88:91], v4, s[16:19], s21 offen offset:2048 sc1
  buffer_store_dwordx4 v[92:95], v4, s[16:19], s21 offen offset:3072 sc1
  s_add_u32 s22, s21, 4096
  buffer_store_dwordx4 v[96:99], v4, s[16:19], s22 offen offset:0 sc1
  s_add_u32 s21, s21, 40960
  buffer_store_dwordx4 v[100:103], v4, s[16:19], s21 offen offset:0 sc1
  buffer_store_dwordx4 v[104:107], v4, s[16:19], s21 offen offset:1024 sc1
  buffer_store_dwordx4 v[108:111], v4, s[16:19], s21 offen offset:2048 sc1
  buffer_store_dwordx4 v[112:115], v4, s[16:19], s21 offen offset:3072 sc1
  s_add_u32 s22, s21, 4096
  buffer_store_dwordx4 v[116:119], v4, s[16:19], s22 offen offset:0 sc1
  s_add_u32 s21, s21, 40960
  buffer_store_dwordx4 v[120:123], v4, s[16:19], s21 offen offset:0 sc1
  buffer_store_dwordx4 v[124:127], v4, s[16:19], s21 offen offset:1024 sc1
  buffer_store_dwordx4 v[128:131], v4, s[16:19], s21 offen offset:2048 sc1
  buffer_store_dwordx4 v[132:135], v4, s[16:19], s21 offen offset:3072 sc1
  s_add_u32 s22, s21, 4096
  buffer_store_dwordx4 v[136:139], v4, s[16:19], s22 offen offset:0 sc1
  s_add_u32 s21, s21, 40960
  buffer_store_dwordx4 v[140:143], v4, s[16:19], s21 offen offset:0 sc1
  buffer_store_dwordx4 v[144:147], v4, s[16:19], s21 offen offset:1024 sc1
  buffer_store_dwordx4 v[148:151], v4, s[16:19], s21 offen offset:2048 sc1
  buffer_store_dwordx4 v[152:155], v4, s[16:19], s21 offen offset:3072 sc1
  s_add_u32 s22, s21, 4096
  buffer_store_dwordx4 v[156:159], v4, s[16:19], s22 offen offset:0 sc1
  s_add_u32 s21, s21, 40960
  s_waitcnt vmcnt(0)
  s_barrier
  s_lshl_b32 s21, s40, 7
  s_add_u32 s21, s21, 94208
  s_cmp_lg_u32 s20, 0
  s_cbranch_scc1 af_262
  v_mov_b32 v10, 0
  v_mov_b32 v11, 1
  s_mov_b64 exec, 1
  buffer_atomic_add v11, v10, s[72:75], s21 offen sc1
  s_mov_b64 exec, -1
  s_nop 1
af_262:
  s_branch queue
do_pv:
  s_mov_b32 s2, s21
  s_load_dwordx2 s[4:5], s[0:1], 88
  s_load_dwordx2 s[38:39], s[0:1], 104
  s_waitcnt lgkmcnt(0)
  s_mov_b32 s8, s4
  s_mov_b32 s9, s5
  s_mov_b32 s10, 2621440
  s_mov_b32 s11, 0x00020000
  s_add_u32 s12, s38, 114294784
  s_addc_u32 s13, s39, 0
  s_mov_b32 s14, 83886080
  s_mov_b32 s15, 0x00020000
  s_mov_b32 s59, 0
  s_mov_b32 s60, 0
  s_add_u32 s16, s38, 85983232
  s_addc_u32 s17, s39, 0
  s_mov_b32 s18, 28311552
  s_mov_b32 s19, 0x00020000
  s_add_u32 s24, s38, 73400320
  s_addc_u32 s25, s39, 0
  s_mov_b32 s26, 5242880
  s_mov_b32 s27, 0x00020000
  s_add_u32 s28, s38, 81002496
  s_addc_u32 s29, s39, 0
  s_mov_b32 s30, 8192
  s_mov_b32 s31, 0x00020000
  s_add_u32 s72, s38, 81068032
  s_addc_u32 s73, s39, 0
  s_mov_b32 s74, 117760
  s_mov_b32 s75, 0x00020000
  v_lshlrev_b32 v4, 4, v1
  v_lshlrev_b32 v5, 3, v1
  v_lshlrev_b32 v6, 2, v2
  v_and_b32 v7, 7, v1
  v_lshlrev_b32 v7, 7, v7
  v_lshrrev_b32 v31, 3, v1
  v_lshl_add_u32 v208, v31, 10, v7
  v_bfe_u32 v31, v1, 3, 2
  v_lshl_add_u32 v31, v31, 2, v7
  s_lshl_b32 s21, s20, 10
  s_add_u32 s21, s21, 96256
  buffer_load_dword v8, v31, s[72:75], s21 offen sc1
  v_lshlrev_b32 v25, 7, v2
  s_mov_b32 s21, 94208
  buffer_load_dword v26, v25, s[72:75], s21 offen sc1
  s_mov_b32 s63, 1
  v_mul_u32_u24 v9, 1280, v2
  v_lshl_add_u32 v9, v3, 3, v9
  s_lshl_b32 s21, s20, 13
  v_add_u32 v10, s21, v4
  s_lshl_b32 s21, s20, 10
  v_add_u32 v11, s21, v4
  v_lshrrev_b32 v20, 5, v1
  v_mul_u32_u24 v21, 2560, v20
  v_add_u32 v21, v21, v4
  v_and_b32 v22, 31, v1
  v_lshlrev_b32 v22, 4, v22
  v_mul_u32_u24 v20, 10240, v20
  v_add_u32 v22, v22, v20
  v_mov_b32 v28, 80
  v_mov_b32 v30, 32768
  s_mov_b32 s50, 0
  s_mov_b32 s51, 0
  s_and_b32 s43, s20, 1
  s_lshr_b32 s44, s20, 1
  v_mov_b32 v70, 0
  v_mov_b32 v71, 0
  v_mov_b32 v78, 0
  v_mov_b32 v79, 0
  v_mov_b32 v86, 0
  v_mov_b32 v87, 0
  v_mov_b32 v94, 0
  v_mov_b32 v95, 0
  v_mov_b32 v102, 0
  v_mov_b32 v103, 0
  v_mov_b32 v110, 0
  v_mov_b32 v111, 0
  v_mov_b32 v118, 0
  v_mov_b32 v119, 0
  v_mov_b32 v126, 0
  v_mov_b32 v127, 0
  s_mov_b32 s21, s2
pv_loop:
  s_mov_b32 s2, s21
  s_mul_hi_u32 s40, s2, 0x1999999a
  s_mul_i32 s21, s40, 10
  s_sub_u32 s41, s2, s21
  s_lshl_b32 s52, s40, 10
  s_add_u32 s52, s52, 24576
  buffer_load_dword v27, v7, s[72:75], s52 offen sc1
  s_cmp_lg_u32 s20, 0
  s_cbranch_scc1 pv_271

  v_mov_b32 v29, 1
  s_mov_b64 exec, 1
  buffer_atomic_add v29, v28, s[32:35], 0 offen sc0 sc1
  s_mov_b64 exec, -1
pv_271:
  s_lshl_b32 s42, s40, 5
  s_lshl_b32 s21, s20, 3
  s_add_u32 s42, s42, s21
  s_mul_i32 s61, s21, 5
  s_lshr_b32 s22, s41, 1
  s_add_u32 s61, s61, s22
  s_and_b32 s62, s41, 1
  s_lshl_b32 s62, s62, 12
  s_mul_i32 s53, s42, 40960
  s_lshl_b32 s22, s41, 12
  s_add_u32 s53, s53, s22
  s_lshl_b32 s21, s40, 1
  s_add_u32 s21, s21, s43
  s_lshl_b32 s45, s21, 6
  s_mul_i32 s46, s21, 20480
  s_mul_i32 s21, s21, 40
  s_lshl_b32 s22, s41, 2
  s_add_u32 s22, s22, s44
  s_add_u32 s21, s21, s22
  s_lshl_b32 s54, s21, 10
  s_lshl_b32 s22, s22, 5
  s_add_u32 s46, s46, s22
  s_mul_i32 s47, s42, 2560
  s_mul_i32 s48, s42, 10240
  s_lshl_b32 s22, s41, 10
  s_add_u32 s48, s48, s22
  s_add_u32 s48, s48, 7340032
  s_add_u32 s23, s40, 1
  s_cmp_ge_u32 s50, s23
  s_cbranch_scc1 pv_264
  s_cmp_eq_u32 s63, 0
  s_cbranch_scc1 pv_267
  s_mov_b32 s63, 0
  s_waitcnt vmcnt(1)
  v_cmp_le_u32 vcc, 4, v26
  s_mov_b32 s51, vcc_lo
  v_cmp_gt_u32 vcc, s23, v8
  s_nop 1
  s_cbranch_vccz pv_268
pv_267:
  s_lshl_b32 s21, s20, 10
  s_add_u32 s21, s21, 96256
  s_mov_b32 s101, 0
wm_272:
  buffer_load_dword v8, v31, s[72:75], s21 offen sc1
  s_add_u32 s101, s101, 1
  s_cmp_gt_u32 s101, 131072
  s_cbranch_scc1 main_end
  s_waitcnt vmcnt(0)
  v_cmp_gt_u32 vcc, s23, v8
  v_readfirstlane_b32 s100, v8
  s_nop 0
  s_cbranch_vccz wm_273
  s_sleep 8
  s_add_u32 s100, s100, 2
  s_cmp_ge_u32 s100, s23
  s_cbranch_scc1 wm_272
  s_sleep 60
  s_branch wm_272
wm_273:
pv_268:
  v_readlane_b32 s50, v8, 0
  v_readlane_b32 s21, v8, 1
  s_min_u32 s50, s50, s21
  v_readlane_b32 s21, v8, 2
  s_min_u32 s50, s50, s21
  v_readlane_b32 s21, v8, 3
  s_min_u32 s50, s50, s21
  v_readlane_b32 s21, v8, 4
  s_min_u32 s50, s50, s21
  v_readlane_b32 s21, v8, 5
  s_min_u32 s50, s50, s21
  v_readlane_b32 s21, v8, 6
  s_min_u32 s50, s50, s21
  v_readlane_b32 s21, v8, 7
  s_min_u32 s50, s50, s21
  v_readlane_b32 s21, v8, 8
  s_min_u32 s50, s50, s21
  v_readlane_b32 s21, v8, 9
  s_min_u32 s50, s50, s21
  v_readlane_b32 s21, v8, 10
  s_min_u32 s50, s50, s21
  v_readlane_b32 s21, v8, 11
  s_min_u32 s50, s50, s21
  v_readlane_b32 s21, v8, 12
  s_min_u32 s50, s50, s21
  v_readlane_b32 s21, v8, 13
  s_min_u32 s50, s50, s21
  v_readlane_b32 s21, v8, 14
  s_min_u32 s50, s50, s21
  v_readlane_b32 s21, v8, 15
  s_min_u32 s50, s50, s21
  v_readlane_b32 s21, v8, 16
  s_min_u32 s50, s50, s21
  v_readlane_b32 s21, v8, 17
  s_min_u32 s50, s50, s21
  v_readlane_b32 s21, v8, 18
  s_min_u32 s50, s50, s21
  v_readlane_b32 s21, v8, 19
  s_min_u32 s50, s50, s21
  v_readlane_b32 s21, v8, 20
  s_min_u32 s50, s50, s21
  v_readlane_b32 s21, v8, 21
  s_min_u32 s50, s50, s21
  v_readlane_b32 s21, v8, 22
  s_min_u32 s50, s50, s21
  v_readlane_b32 s21, v8, 23
  s_min_u32 s50, s50, s21
  v_readlane_b32 s21, v8, 24
  s_min_u32 s50, s50, s21
  v_readlane_b32 s21, v8, 25
  s_min_u32 s50, s50, s21
  v_readlane_b32 s21, v8, 26
  s_min_u32 s50, s50, s21
  v_readlane_b32 s21, v8, 27
  s_min_u32 s50, s50, s21
  v_readlane_b32 s21, v8, 28
  s_min_u32 s50, s50, s21
  v_readlane_b32 s21, v8, 29
  s_min_u32 s50, s50, s21
  v_readlane_b32 s21, v8, 30
  s_min_u32 s50, s50, s21
  v_readlane_b32 s21, v8, 31
  s_min_u32 s50, s50, s21
pv_264:
  s_lshr_b32 s22, s40, 2
  s_cmp_lt_u32 s40, 0
  s_cbranch_scc1 pv_265
  s_bitcmp1_b32 s51, s22
  s_cbranch_scc1 pv_265
  s_mov_b32 s21, 94208
  v_lshlrev_b32 v25, 7, v2
  s_mov_b32 s101, 0
pv_266:
  buffer_load_dword v26, v25, s[72:75], s21 offen sc1
  s_add_u32 s101, s101, 1
  s_cmp_gt_u32 s101, 131072
  s_cbranch_scc1 main_end
  s_waitcnt vmcnt(0)
  v_cmp_le_u32 vcc, 4, v26
  s_mov_b32 s51, vcc_lo
  s_bitcmp1_b32 s51, s22
  s_cbranch_scc1 pv_265
  s_sleep 8
  s_branch pv_266
pv_265:
  buffer_load_dwordx4 a[0:3], v4, s[12:15], s53 offen offset:0 sc1
  buffer_load_dwordx4 a[4:7], v4, s[12:15], s53 offen offset:1024 sc1
  buffer_load_dwordx4 a[8:11], v4, s[12:15], s53 offen offset:2048 sc1
  buffer_load_dwordx4 a[12:15], v4, s[12:15], s53 offen offset:3072 sc1
  s_add_u32 s53, s53, 40960
  buffer_load_dwordx4 a[16:19], v4, s[12:15], s53 offen offset:0 sc1
  buffer_load_dwordx4 a[20:23], v4, s[12:15], s53 offen offset:1024 sc1
  buffer_load_dwordx4 a[24:27], v4, s[12:15], s53 offen offset:2048 sc1
  buffer_load_dwordx4 a[28:31], v4, s[12:15], s53 offen offset:3072 sc1
  s_add_u32 s53, s53, 40960
  buffer_load_dwordx4 a[32:35], v4, s[12:15], s53 offen offset:0 sc1
  buffer_load_dwordx4 a[36:39], v4, s[12:15], s53 offen offset:1024 sc1
  buffer_load_dwordx4 a[40:43], v4, s[12:15], s53 offen offset:2048 sc1
  buffer_load_dwordx4 a[44:47], v4, s[12:15], s53 offen offset:3072 sc1
  s_add_u32 s53, s53, 40960
  buffer_load_dwordx4 a[48:51], v4, s[12:15], s53 offen offset:0 sc1
  buffer_load_dwordx4 a[52:55], v4, s[12:15], s53 offen offset:1024 sc1
  buffer_load_dwordx4 a[56:59], v4, s[12:15], s53 offen offset:2048 sc1
  buffer_load_dwordx4 a[60:63], v4, s[12:15], s53 offen offset:3072 sc1
  s_add_u32 s53, s53, 40960
  buffer_load_dwordx4 a[64:67], v4, s[12:15], s53 offen offset:0 sc1
  buffer_load_dwordx4 a[68:71], v4, s[12:15], s53 offen offset:1024 sc1
  buffer_load_dwordx4 a[72:75], v4, s[12:15], s53 offen offset:2048 sc1
  buffer_load_dwordx4 a[76:79], v4, s[12:15], s53 offen offset:3072 sc1
  s_add_u32 s53, s53, 40960
  buffer_load_dwordx4 a[80:83], v4, s[12:15], s53 offen offset:0 sc1
  buffer_load_dwordx4 a[84:87], v4, s[12:15], s53 offen offset:1024 sc1
  buffer_load_dwordx4 a[88:91], v4, s[12:15], s53 offen offset:2048 sc1
  buffer_load_dwordx4 a[92:95], v4, s[12:15], s53 offen offset:3072 sc1
  s_add_u32 s53, s53, 40960
  buffer_load_dwordx4 a[96:99], v4, s[12:15], s53 offen offset:0 sc1
  buffer_load_dwordx4 a[100:103], v4, s[12:15], s53 offen offset:1024 sc1
  buffer_load_dwordx4 a[104:107], v4, s[12:15], s53 offen offset:2048 sc1
  buffer_load_dwordx4 a[108:111], v4, s[12:15], s53 offen offset:3072 sc1
  s_add_u32 s53, s53, 40960
  buffer_load_dwordx4 a[112:115], v4, s[12:15], s53 offen offset:0 sc1
  buffer_load_dwordx4 a[116:119], v4, s[12:15], s53 offen offset:1024 sc1
  buffer_load_dwordx4 a[120:123], v4, s[12:15], s53 offen offset:2048 sc1
  buffer_load_dwordx4 a[124:127], v4, s[12:15], s53 offen offset:3072 sc1
  buffer_load_dwordx4 v[12:15], v4, s[24:27], s54 offen sc1
  buffer_load_dwordx4 v[16:19], v4, s[24:27], s54 offen offset:2048 sc1
  buffer_load_dword v24, v6, s[28:31], s45 offen sc1
  s_waitcnt vmcnt(35)
  v_cmp_le_u32 s[68:69], 20, v27
  s_nop 1
  s_and_b32 s21, s68, 255
  s_cmp_lg_u32 s21, 255
  s_cbranch_scc1 pvw_269
  buffer_load_dwordx4 v[64:67], v4, s[16:19], s47 offen sc1
  buffer_load_dwordx2 v[68:69], v5, s[16:19], s47 offen offset:2048 sc1
  buffer_load_dwordx4 v[128:131], v21, s[16:19], s47 offen offset:1024 sc1
  s_add_u32 s47, s47, 2560
  buffer_load_dwordx4 v[72:75], v4, s[16:19], s47 offen sc1
  buffer_load_dwordx2 v[76:77], v5, s[16:19], s47 offen offset:2048 sc1
  s_add_u32 s47, s47, 2560
  buffer_load_dwordx4 v[80:83], v4, s[16:19], s47 offen sc1
  buffer_load_dwordx2 v[84:85], v5, s[16:19], s47 offen offset:2048 sc1
  buffer_load_dwordx4 v[132:135], v21, s[16:19], s47 offen offset:1024 sc1
  s_add_u32 s47, s47, 2560
  buffer_load_dwordx4 v[88:91], v4, s[16:19], s47 offen sc1
  buffer_load_dwordx2 v[92:93], v5, s[16:19], s47 offen offset:2048 sc1
  s_add_u32 s47, s47, 2560
  buffer_load_dwordx4 v[32:35], v22, s[16:19], s48 offen offset:0 sc1
  buffer_load_dwordx4 v[40:43], v22, s[16:19], s48 offen offset:512 sc1
  s_add_u32 s48, s48, 20480
  buffer_load_dwordx4 v[36:39], v22, s[16:19], s48 offen offset:0 sc1
  buffer_load_dwordx4 v[44:47], v22, s[16:19], s48 offen offset:512 sc1
  s_add_u32 s48, s48, 20480
  buffer_load_dwordx4 v[96:99], v4, s[16:19], s47 offen sc1
  buffer_load_dwordx2 v[100:101], v5, s[16:19], s47 offen offset:2048 sc1
  buffer_load_dwordx4 v[136:139], v21, s[16:19], s47 offen offset:1024 sc1
  s_add_u32 s47, s47, 2560
  buffer_load_dwordx4 v[104:107], v4, s[16:19], s47 offen sc1
  buffer_load_dwordx2 v[108:109], v5, s[16:19], s47 offen offset:2048 sc1
  s_add_u32 s47, s47, 2560
  buffer_load_dwordx4 v[112:115], v4, s[16:19], s47 offen sc1
  buffer_load_dwordx2 v[116:117], v5, s[16:19], s47 offen offset:2048 sc1
  buffer_load_dwordx4 v[140:143], v21, s[16:19], s47 offen offset:1024 sc1
  s_add_u32 s47, s47, 2560
  buffer_load_dwordx4 v[120:123], v4, s[16:19], s47 offen sc1
  buffer_load_dwordx2 v[124:125], v5, s[16:19], s47 offen offset:2048 sc1
  s_add_u32 s47, s47, 2560
  buffer_load_dwordx4 v[48:51], v22, s[16:19], s48 offen offset:0 sc1
  buffer_load_dwordx4 v[56:59], v22, s[16:19], s48 offen offset:512 sc1
  s_add_u32 s48, s48, 20480
  buffer_load_dwordx4 v[52:55], v22, s[16:19], s48 offen offset:0 sc1
  buffer_load_dwordx4 v[60:63], v22, s[16:19], s48 offen offset:512 sc1
  s_add_u32 s48, s48, 20480
  s_barrier
  s_waitcnt vmcnt(28)
  v_sub_f32 v25, 1.0, v24
  v_cvt_pk_bf16_f32 v26, v25, v25
  v_lshlrev_b32 v25, 16, v26
  v_cvt_pk_bf16_f32 v26, v12, v12
  v_lshlrev_b32 v12, 16, v26
  v_cvt_pk_bf16_f32 v26, v13, v13
  v_lshlrev_b32 v13, 16, v26
  v_cvt_pk_bf16_f32 v26, v14, v14
  v_lshlrev_b32 v14, 16, v26
  v_cvt_pk_bf16_f32 v26, v15, v15
  v_lshlrev_b32 v15, 16, v26
  v_cvt_pk_bf16_f32 v26, v16, v16
  v_lshlrev_b32 v16, 16, v26
  v_cvt_pk_bf16_f32 v26, v17, v17
  v_lshlrev_b32 v17, 16, v26
  v_cvt_pk_bf16_f32 v26, v18, v18
  v_lshlrev_b32 v18, 16, v26
  v_cvt_pk_bf16_f32 v26, v19, v19
  v_lshlrev_b32 v19, 16, v26
  v_mul_f32 v12, v12, v25
  v_cvt_pk_bf16_f32 v26, v12, v12
  v_lshlrev_b32 v12, 16, v26
  v_mul_f32 v13, v13, v25
  v_cvt_pk_bf16_f32 v26, v13, v13
  v_lshlrev_b32 v13, 16, v26
  v_mul_f32 v14, v14, v25
  v_cvt_pk_bf16_f32 v26, v14, v14
  v_lshlrev_b32 v14, 16, v26
  v_mul_f32 v15, v15, v25
  v_cvt_pk_bf16_f32 v26, v15, v15
  v_lshlrev_b32 v15, 16, v26
  v_mul_f32 v16, v16, v25
  v_cvt_pk_bf16_f32 v26, v16, v16
  v_lshlrev_b32 v16, 16, v26
  v_mul_f32 v17, v17, v25
  v_cvt_pk_bf16_f32 v26, v17, v17
  v_lshlrev_b32 v17, 16, v26
  v_mul_f32 v18, v18, v25
  v_cvt_pk_bf16_f32 v26, v18, v18
  v_lshlrev_b32 v18, 16, v26
  v_mul_f32 v19, v19, v25
  v_cvt_pk_bf16_f32 v26, v19, v19
  v_lshlrev_b32 v19, 16, v26
  s_branch pvg_274
pvw_269:
  s_waitcnt vmcnt(0)
  v_sub_f32 v25, 1.0, v24
  v_cvt_pk_bf16_f32 v26, v25, v25
  v_lshlrev_b32 v25, 16, v26
  v_cvt_pk_bf16_f32 v26, v12, v12
  v_lshlrev_b32 v12, 16, v26
  v_cvt_pk_bf16_f32 v26, v13, v13
  v_lshlrev_b32 v13, 16, v26
  v_cvt_pk_bf16_f32 v26, v14, v14
  v_lshlrev_b32 v14, 16, v26
  v_cvt_pk_bf16_f32 v26, v15, v15
  v_lshlrev_b32 v15, 16, v26
  v_cvt_pk_bf16_f32 v26, v16, v16
  v_lshlrev_b32 v16, 16, v26
  v_cvt_pk_bf16_f32 v26, v17, v17
  v_lshlrev_b32 v17, 16, v26
  v_cvt_pk_bf16_f32 v26, v18, v18
  v_lshlrev_b32 v18, 16, v26
  v_cvt_pk_bf16_f32 v26, v19, v19
  v_lshlrev_b32 v19, 16, v26
  v_mul_f32 v12, v12, v25
  v_cvt_pk_bf16_f32 v26, v12, v12
  v_lshlrev_b32 v12, 16, v26
  v_mul_f32 v13, v13, v25
  v_cvt_pk_bf16_f32 v26, v13, v13
  v_lshlrev_b32 v13, 16, v26
  v_mul_f32 v14, v14, v25
  v_cvt_pk_bf16_f32 v26, v14, v14
  v_lshlrev_b32 v14, 16, v26
  v_mul_f32 v15, v15, v25
  v_cvt_pk_bf16_f32 v26, v15, v15
  v_lshlrev_b32 v15, 16, v26
  v_mul_f32 v16, v16, v25
  v_cvt_pk_bf16_f32 v26, v16, v16
  v_lshlrev_b32 v16, 16, v26
  v_mul_f32 v17, v17, v25
  v_cvt_pk_bf16_f32 v26, v17, v17
  v_lshlrev_b32 v17, 16, v26
  v_mul_f32 v18, v18, v25
  v_cvt_pk_bf16_f32 v26, v18, v18
  v_lshlrev_b32 v18, 16, v26
  v_mul_f32 v19, v19, v25
  v_cvt_pk_bf16_f32 v26, v19, v19
  v_lshlrev_b32 v19, 16, v26
  s_cmp_ge_u32 s40, 56
  s_cbranch_scc1 pvt_275
  s_cmp_lg_u32 s20, 0
  s_cbranch_scc1 wm_277
  s_mov_b32 s101, 0
wm_276:
  buffer_load_dword v26, v7, s[72:75], s52 offen sc1
  s_add_u32 s101, s101, 1
  s_cmp_gt_u32 s101, 131072
  s_cbranch_scc1 main_end
  s_waitcnt vmcnt(0)
  v_cmp_gt_u32 vcc, 20, v26
  v_readfirstlane_b32 s100, v26
  s_nop 0
  s_cbranch_vccz wm_277
  s_sleep 2
  s_add_u32 s100, s100, 19
  s_cmp_ge_u32 s100, 20
  s_cbranch_scc1 wm_276
  s_sleep 24
  s_branch wm_276
wm_277:
  s_barrier
  buffer_load_dwordx4 v[64:67], v4, s[16:19], s47 offen sc1
  buffer_load_dwordx2 v[68:69], v5, s[16:19], s47 offen offset:2048 sc1
  buffer_load_dwordx4 v[128:131], v21, s[16:19], s47 offen offset:1024 sc1
  s_add_u32 s47, s47, 2560
  buffer_load_dwordx4 v[72:75], v4, s[16:19], s47 offen sc1
  buffer_load_dwordx2 v[76:77], v5, s[16:19], s47 offen offset:2048 sc1
  s_add_u32 s47, s47, 2560
  buffer_load_dwordx4 v[80:83], v4, s[16:19], s47 offen sc1
  buffer_load_dwordx2 v[84:85], v5, s[16:19], s47 offen offset:2048 sc1
  buffer_load_dwordx4 v[132:135], v21, s[16:19], s47 offen offset:1024 sc1
  s_add_u32 s47, s47, 2560
  buffer_load_dwordx4 v[88:91], v4, s[16:19], s47 offen sc1
  buffer_load_dwordx2 v[92:93], v5, s[16:19], s47 offen offset:2048 sc1
  s_add_u32 s47, s47, 2560
  buffer_load_dwordx4 v[32:35], v22, s[16:19], s48 offen offset:0 sc1
  buffer_load_dwordx4 v[40:43], v22, s[16:19], s48 offen offset:512 sc1
  s_add_u32 s48, s48, 20480
  buffer_load_dwordx4 v[36:39], v22, s[16:19], s48 offen offset:0 sc1
  buffer_load_dwordx4 v[44:47], v22, s[16:19], s48 offen offset:512 sc1
  s_add_u32 s48, s48, 20480
  buffer_load_dwordx4 v[96:99], v4, s[16:19], s47 offen sc1
  buffer_load_dwordx2 v[100:101], v5, s[16:19], s47 offen offset:2048 sc1
  buffer_load_dwordx4 v[136:139], v21, s[16:19], s47 offen offset:1024 sc1
  s_add_u32 s47, s47, 2560
  buffer_load_dwordx4 v[104:107], v4, s[16:19], s47 offen sc1
  buffer_load_dwordx2 v[108:109], v5, s[16:19], s47 offen offset:2048 sc1
  s_add_u32 s47, s47, 2560
  buffer_load_dwordx4 v[112:115], v4, s[16:19], s47 offen sc1
  buffer_load_dwordx2 v[116:117], v5, s[16:19], s47 offen offset:2048 sc1
  buffer_load_dwordx4 v[140:143], v21, s[16:19], s47 offen offset:1024 sc1
  s_add_u32 s47, s47, 2560
  buffer_load_dwordx4 v[120:123], v4, s[16:19], s47 offen sc1
  buffer_load_dwordx2 v[124:125], v5, s[16:19], s47 offen offset:2048 sc1
  s_add_u32 s47, s47, 2560
  buffer_load_dwordx4 v[48:51], v22, s[16:19], s48 offen offset:0 sc1
  buffer_load_dwordx4 v[56:59], v22, s[16:19], s48 offen offset:512 sc1
  s_add_u32 s48, s48, 20480
  buffer_load_dwordx4 v[52:55], v22, s[16:19], s48 offen offset:0 sc1
  buffer_load_dwordx4 v[60:63], v22, s[16:19], s48 offen offset:512 sc1
  s_add_u32 s48, s48, 20480
pvg_274:
  s_waitcnt vmcnt(26)
  v_mfma_f32_16x16x32_bf16 v[148:151], a[0:3], v[64:67], 0
  v_mfma_f32_16x16x32_bf16 v[144:147], a[0:3], v[68:71], 0
  v_mfma_f32_16x16x32_bf16 v[156:159], a[4:7], v[64:67], 0
  v_mfma_f32_16x16x32_bf16 v[152:155], a[4:7], v[68:71], 0
  v_mfma_f32_16x16x32_bf16 v[164:167], a[8:11], v[64:67], 0
  v_mfma_f32_16x16x32_bf16 v[160:163], a[8:11], v[68:71], 0
  v_mfma_f32_16x16x32_bf16 v[172:175], a[12:15], v[64:67], 0
  v_mfma_f32_16x16x32_bf16 v[168:171], a[12:15], v[68:71], 0
  s_waitcnt vmcnt(23)
  v_mfma_f32_16x16x32_bf16 v[148:151], a[16:19], v[72:75], v[148:151]
  v_mfma_f32_16x16x32_bf16 v[144:147], a[16:19], v[76:79], v[144:147]
  v_mfma_f32_16x16x32_bf16 v[156:159], a[20:23], v[72:75], v[156:159]
  v_mfma_f32_16x16x32_bf16 v[152:155], a[20:23], v[76:79], v[152:155]
  v_mfma_f32_16x16x32_bf16 v[164:167], a[24:27], v[72:75], v[164:167]
  v_mfma_f32_16x16x32_bf16 v[160:163], a[24:27], v[76:79], v[160:163]
  v_mfma_f32_16x16x32_bf16 v[172:175], a[28:31], v[72:75], v[172:175]
  v_mfma_f32_16x16x32_bf16 v[168:171], a[28:31], v[76:79], v[168:171]
  s_waitcnt vmcnt(21)
  v_mfma_f32_16x16x32_bf16 v[148:151], a[32:35], v[80:83], v[148:151]
  v_mfma_f32_16x16x32_bf16 v[144:147], a[32:35], v[84:87], v[144:147]
  v_mfma_f32_16x16x32_bf16 v[156:159], a[36:39], v[80:83], v[156:159]
  v_mfma_f32_16x16x32_bf16 v[152:155], a[36:39], v[84:87], v[152:155]
  v_mfma_f32_16x16x32_bf16 v[164:167], a[40:43], v[80:83], v[164:167]
  v_mfma_f32_16x16x32_bf16 v[160:163], a[40:43], v[84:87], v[160:163]
  v_mfma_f32_16x16x32_bf16 v[172:175], a[44:47], v[80:83], v[172:175]
  v_mfma_f32_16x16x32_bf16 v[168:171], a[44:47], v[84:87], v[168:171]
  s_waitcnt vmcnt(18)
  v_mfma_f32_16x16x32_bf16 v[148:151], a[48:51], v[88:91], v[148:151]
  v_mfma_f32_16x16x32_bf16 v[144:147], a[48:51], v[92:95], v[144:147]
  v_mfma_f32_16x16x32_bf16 v[156:159], a[52:55], v[88:91], v[156:159]
  v_mfma_f32_16x16x32_bf16 v[152:155], a[52:55], v[92:95], v[152:155]
  v_mfma_f32_16x16x32_bf16 v[164:167], a[56:59], v[88:91], v[164:167]
  v_mfma_f32_16x16x32_bf16 v[160:163], a[56:59], v[92:95], v[160:163]
  v_mfma_f32_16x16x32_bf16 v[172:175], a[60:63], v[88:91], v[172:175]
  v_mfma_f32_16x16x32_bf16 v[168:171], a[60:63], v[92:95], v[168:171]
  s_waitcnt vmcnt(14)
  v_swap_b32 v130, v132
  v_swap_b32 v131, v133
  v_swap_b32 v34, v36
  v_swap_b32 v35, v37
  v_swap_b32 v42, v44
  v_swap_b32 v43, v45
  s_nop 1
  v_mfma_f32_16x16x32_bf16 v[144:147], v[32:35], v[128:131], v[144:147]
  v_mfma_f32_16x16x32_bf16 v[148:151], v[32:35], v[132:135], v[148:151]
  v_mfma_f32_16x16x32_bf16 v[152:155], v[36:39], v[128:131], v[152:155]
  v_mfma_f32_16x16x32_bf16 v[156:159], v[36:39], v[132:135], v[156:159]
  v_mfma_f32_16x16x32_bf16 v[160:163], v[40:43], v[128:131], v[160:163]
  v_mfma_f32_16x16x32_bf16 v[164:167], v[40:43], v[132:135], v[164:167]
  v_mfma_f32_16x16x32_bf16 v[168:171], v[44:47], v[128:131], v[168:171]
  v_mfma_f32_16x16x32_bf16 v[172:175], v[44:47], v[132:135], v[172:175]
  s_waitcnt vmcnt(12)
  v_mfma_f32_16x16x32_bf16 v[148:151], a[64:67], v[96:99], v[148:151]
  v_mfma_f32_16x16x32_bf16 v[144:147], a[64:67], v[100:103], v[144:147]
  v_mfma_f32_16x16x32_bf16 v[156:159], a[68:71], v[96:99], v[156:159]
  v_mfma_f32_16x16x32_bf16 v[152:155], a[68:71], v[100:103], v[152:155]
  v_mfma_f32_16x16x32_bf16 v[164:167], a[72:75], v[96:99], v[164:167]
  v_mfma_f32_16x16x32_bf16 v[160:163], a[72:75], v[100:103], v[160:163]
  v_mfma_f32_16x16x32_bf16 v[172:175], a[76:79], v[96:99], v[172:175]
  v_mfma_f32_16x16x32_bf16 v[168:171], a[76:79], v[100:103], v[168:171]
  s_waitcnt vmcnt(9)
  v_mfma_f32_16x16x32_bf16 v[148:151], a[80:83], v[104:107], v[148:151]
  v_mfma_f32_16x16x32_bf16 v[144:147], a[80:83], v[108:111], v[144:147]
  v_mfma_f32_16x16x32_bf16 v[156:159], a[84:87], v[104:107], v[156:159]
  v_mfma_f32_16x16x32_bf16 v[152:155], a[84:87], v[108:111], v[152:155]
  v_mfma_f32_16x16x32_bf16 v[164:167], a[88:91], v[104:107], v[164:167]
  v_mfma_f32_16x16x32_bf16 v[160:163], a[88:91], v[108:111], v[160:163]
  v_mfma_f32_16x16x32_bf16 v[172:175], a[92:95], v[104:107], v[172:175]
  v_mfma_f32_16x16x32_bf16 v[168:171], a[92:95], v[108:111], v[168:171]
  s_waitcnt vmcnt(7)
  v_mfma_f32_16x16x32_bf16 v[148:151], a[96:99], v[112:115], v[148:151]
  v_mfma_f32_16x16x32_bf16 v[144:147], a[96:99], v[116:119], v[144:147]
  v_mfma_f32_16x16x32_bf16 v[156:159], a[100:103], v[112:115], v[156:159]
  v_mfma_f32_16x16x32_bf16 v[152:155], a[100:103], v[116:119], v[152:155]
  v_mfma_f32_16x16x32_bf16 v[164:167], a[104:107], v[112:115], v[164:167]
  v_mfma_f32_16x16x32_bf16 v[160:163], a[104:107], v[116:119], v[160:163]
  v_mfma_f32_16x16x32_bf16 v[172:175], a[108:111], v[112:115], v[172:175]
  v_mfma_f32_16x16x32_bf16 v[168:171], a[108:111], v[116:119], v[168:171]
  s_waitcnt vmcnt(4)
  v_mfma_f32_16x16x32_bf16 v[148:151], a[112:115], v[120:123], v[148:151]
  v_mfma_f32_16x16x32_bf16 v[144:147], a[112:115], v[124:127], v[144:147]
  v_mfma_f32_16x16x32_bf16 v[156:159], a[116:119], v[120:123], v[156:159]
  v_mfma_f32_16x16x32_bf16 v[152:155], a[116:119], v[124:127], v[152:155]
  v_mfma_f32_16x16x32_bf16 v[164:167], a[120:123], v[120:123], v[164:167]
  v_mfma_f32_16x16x32_bf16 v[160:163], a[120:123], v[124:127], v[160:163]
  v_mfma_f32_16x16x32_bf16 v[172:175], a[124:127], v[120:123], v[172:175]
  v_mfma_f32_16x16x32_bf16 v[168:171], a[124:127], v[124:127], v[168:171]
  s_waitcnt vmcnt(0)
  v_swap_b32 v138, v140
  v_swap_b32 v139, v141
  v_swap_b32 v50, v52
  v_swap_b32 v51, v53
  v_swap_b32 v58, v60
  v_swap_b32 v59, v61
  s_nop 1
  v_mfma_f32_16x16x32_bf16 v[144:147], v[48:51], v[136:139], v[144:147]
  v_mfma_f32_16x16x32_bf16 v[148:151], v[48:51], v[140:143], v[148:151]
  v_mfma_f32_16x16x32_bf16 v[152:155], v[52:55], v[136:139], v[152:155]
  v_mfma_f32_16x16x32_bf16 v[156:159], v[52:55], v[140:143], v[156:159]
  v_mfma_f32_16x16x32_bf16 v[160:163], v[56:59], v[136:139], v[160:163]
  v_mfma_f32_16x16x32_bf16 v[164:167], v[56:59], v[140:143], v[164:167]
  v_mfma_f32_16x16x32_bf16 v[168:171], v[60:63], v[136:139], v[168:171]
  v_mfma_f32_16x16x32_bf16 v[172:175], v[60:63], v[140:143], v[172:175]
  s_branch pve_270
pvt_275:
  s_sub_u32 s55, s52, 1024
  s_cmp_lg_u32 s20, 0
  s_cbranch_scc1 wm_279
  s_mov_b32 s101, 0
wm_278:
  buffer_load_dword v26, v7, s[72:75], s55 offen sc1
  s_add_u32 s101, s101, 1
  s_cmp_gt_u32 s101, 131072
  s_cbranch_scc1 main_end
  s_waitcnt vmcnt(0)
  v_cmp_gt_u32 vcc, 20, v26
  v_readfirstlane_b32 s100, v26
  s_nop 0
  s_cbranch_vccz wm_279
  s_sleep 4
  s_add_u32 s100, s100, 19
  s_cmp_ge_u32 s100, 20
  s_cbranch_scc1 wm_278
  s_sleep 24
  s_branch wm_278
wm_279:
  s_barrier
  s_mov_b32 s56, s47
  s_mov_b32 s57, s48
  buffer_load_dwordx4 v[64:67], v4, s[16:19], s56 offen sc1
  buffer_load_dwordx2 v[68:69], v5, s[16:19], s56 offen offset:2048 sc1
  buffer_load_dwordx4 v[128:131], v21, s[16:19], s56 offen offset:1024 sc1
  s_add_u32 s56, s56, 2560
  buffer_load_dwordx4 v[72:75], v4, s[16:19], s56 offen sc1
  buffer_load_dwordx2 v[76:77], v5, s[16:19], s56 offen offset:2048 sc1
  s_add_u32 s56, s56, 2560
  buffer_load_dwordx4 v[80:83], v4, s[16:19], s56 offen sc1
  buffer_load_dwordx2 v[84:85], v5, s[16:19], s56 offen offset:2048 sc1
  buffer_load_dwordx4 v[132:135], v21, s[16:19], s56 offen offset:1024 sc1
  s_add_u32 s56, s56, 2560
  buffer_load_dwordx4 v[88:91], v4, s[16:19], s56 offen sc1
  buffer_load_dwordx2 v[92:93], v5, s[16:19], s56 offen offset:2048 sc1
  s_add_u32 s56, s56, 2560
  buffer_load_dwordx4 v[32:35], v22, s[16:19], s57 offen offset:0 sc1
  buffer_load_dwordx4 v[40:43], v22, s[16:19], s57 offen offset:512 sc1
  s_add_u32 s57, s57, 20480
  buffer_load_dwordx4 v[36:39], v22, s[16:19], s57 offen offset:0 sc1
  buffer_load_dwordx4 v[44:47], v22, s[16:19], s57 offen offset:512 sc1
  s_add_u32 s57, s57, 20480
  buffer_load_dwordx4 v[96:99], v4, s[16:19], s56 offen sc1
  buffer_load_dwordx2 v[100:101], v5, s[16:19], s56 offen offset:2048 sc1
  buffer_load_dwordx4 v[136:139], v21, s[16:19], s56 offen offset:1024 sc1
  s_add_u32 s56, s56, 2560
  buffer_load_dwordx4 v[104:107], v4, s[16:19], s56 offen sc1
  buffer_load_dwordx2 v[108:109], v5, s[16:19], s56 offen offset:2048 sc1
  s_add_u32 s56, s56, 2560
  buffer_load_dwordx4 v[112:115], v4, s[16:19], s56 offen sc1
  buffer_load_dwordx2 v[116:117], v5, s[16:19], s56 offen offset:2048 sc1
  buffer_load_dwordx4 v[140:143], v21, s[16:19], s56 offen offset:1024 sc1
  s_add_u32 s56, s56, 2560
  buffer_load_dwordx4 v[120:123], v4, s[16:19], s56 offen sc1
  buffer_load_dwordx2 v[124:125], v5, s[16:19], s56 offen offset:2048 sc1
  s_add_u32 s56, s56, 2560
  buffer_load_dwordx4 v[48:51], v22, s[16:19], s57 offen offset:0 sc1
  buffer_load_dwordx4 v[56:59], v22, s[16:19], s57 offen offset:512 sc1
  s_add_u32 s57, s57, 20480
  buffer_load_dwordx4 v[52:55], v22, s[16:19], s57 offen offset:0 sc1
  buffer_load_dwordx4 v[60:63], v22, s[16:19], s57 offen offset:512 sc1
  s_add_u32 s57, s57, 20480
  s_mov_b32 s101, 0
  s_waitcnt vmcnt(14)
  s_branch pvr_281
pvr_280:
  s_sleep 2
  s_add_u32 s56, s47, 0
  s_add_u32 s57, s48, 0
  buffer_load_dwordx4 v[64:67], v4, s[16:19], s56 offen sc1
  buffer_load_dwordx2 v[68:69], v5, s[16:19], s56 offen offset:2048 sc1
  buffer_load_dwordx4 v[128:131], v21, s[16:19], s56 offen offset:1024 sc1
  s_add_u32 s56, s56, 2560
  buffer_load_dwordx4 v[72:75], v4, s[16:19], s56 offen sc1
  buffer_load_dwordx2 v[76:77], v5, s[16:19], s56 offen offset:2048 sc1
  s_add_u32 s56, s56, 2560
  buffer_load_dwordx4 v[80:83], v4, s[16:19], s56 offen sc1
  buffer_load_dwordx2 v[84:85], v5, s[16:19], s56 offen offset:2048 sc1
  buffer_load_dwordx4 v[132:135], v21, s[16:19], s56 offen offset:1024 sc1
  s_add_u32 s56, s56, 2560
  buffer_load_dwordx4 v[88:91], v4, s[16:19], s56 offen sc1
  buffer_load_dwordx2 v[92:93], v5, s[16:19], s56 offen offset:2048 sc1
  s_add_u32 s56, s56, 2560
  buffer_load_dwordx4 v[32:35], v22, s[16:19], s57 offen offset:0 sc1
  buffer_load_dwordx4 v[40:43], v22, s[16:19], s57 offen offset:512 sc1
  s_add_u32 s57, s57, 20480
  buffer_load_dwordx4 v[36:39], v22, s[16:19], s57 offen offset:0 sc1
  buffer_load_dwordx4 v[44:47], v22, s[16:19], s57 offen offset:512 sc1
  s_add_u32 s57, s57, 20480
  s_add_u32 s101, s101, 1
  s_cmp_gt_u32 s101, 131072
  s_cbranch_scc1 main_end
  s_waitcnt vmcnt(0)
pvr_281:
  v_max3_u32 v26, v64, v68, v72
  v_max3_u32 v26, v26, v76, v80
  v_max3_u32 v26, v26, v84, v88
  v_max3_u32 v26, v26, v92, v128
  v_max3_u32 v26, v26, v132, v32
  v_max3_u32 v26, v26, v36, v40
  v_max3_u32 v26, v26, v44, v44
  v_cmp_eq_u32 vcc, -1, v26
  s_nop 1
  s_cbranch_vccnz pvr_280
  v_mfma_f32_16x16x32_bf16 v[148:151], a[0:3], v[64:67], 0
  v_mfma_f32_16x16x32_bf16 v[144:147], a[0:3], v[68:71], 0
  v_mfma_f32_16x16x32_bf16 v[156:159], a[4:7], v[64:67], 0
  v_mfma_f32_16x16x32_bf16 v[152:155], a[4:7], v[68:71], 0
  v_mfma_f32_16x16x32_bf16 v[164:167], a[8:11], v[64:67], 0
  v_mfma_f32_16x16x32_bf16 v[160:163], a[8:11], v[68:71], 0
  v_mfma_f32_16x16x32_bf16 v[172:175], a[12:15], v[64:67], 0
  v_mfma_f32_16x16x32_bf16 v[168:171], a[12:15], v[68:71], 0
  v_mfma_f32_16x16x32_bf16 v[148:151], a[16:19], v[72:75], v[148:151]
  v_mfma_f32_16x16x32_bf16 v[144:147], a[16:19], v[76:79], v[144:147]
  v_mfma_f32_16x16x32_bf16 v[156:159], a[20:23], v[72:75], v[156:159]
  v_mfma_f32_16x16x32_bf16 v[152:155], a[20:23], v[76:79], v[152:155]
  v_mfma_f32_16x16x32_bf16 v[164:167], a[24:27], v[72:75], v[164:167]
  v_mfma_f32_16x16x32_bf16 v[160:163], a[24:27], v[76:79], v[160:163]
  v_mfma_f32_16x16x32_bf16 v[172:175], a[28:31], v[72:75], v[172:175]
  v_mfma_f32_16x16x32_bf16 v[168:171], a[28:31], v[76:79], v[168:171]
  v_mfma_f32_16x16x32_bf16 v[148:151], a[32:35], v[80:83], v[148:151]
  v_mfma_f32_16x16x32_bf16 v[144:147], a[32:35], v[84:87], v[144:147]
  v_mfma_f32_16x16x32_bf16 v[156:159], a[36:39], v[80:83], v[156:159]
  v_mfma_f32_16x16x32_bf16 v[152:155], a[36:39], v[84:87], v[152:155]
  v_mfma_f32_16x16x32_bf16 v[164:167], a[40:43], v[80:83], v[164:167]
  v_mfma_f32_16x16x32_bf16 v[160:163], a[40:43], v[84:87], v[160:163]
  v_mfma_f32_16x16x32_bf16 v[172:175], a[44:47], v[80:83], v[172:175]
  v_mfma_f32_16x16x32_bf16 v[168:171], a[44:47], v[84:87], v[168:171]
  v_mfma_f32_16x16x32_bf16 v[148:151], a[48:51], v[88:91], v[148:151]
  v_mfma_f32_16x16x32_bf16 v[144:147], a[48:51], v[92:95], v[144:147]
  v_mfma_f32_16x16x32_bf16 v[156:159], a[52:55], v[88:91], v[156:159]
  v_mfma_f32_16x16x32_bf16 v[152:155], a[52:55], v[92:95], v[152:155]
  v_mfma_f32_16x16x32_bf16 v[164:167], a[56:59], v[88:91], v[164:167]
  v_mfma_f32_16x16x32_bf16 v[160:163], a[56:59], v[92:95], v[160:163]
  v_mfma_f32_16x16x32_bf16 v[172:175], a[60:63], v[88:91], v[172:175]
  v_mfma_f32_16x16x32_bf16 v[168:171], a[60:63], v[92:95], v[168:171]
  v_swap_b32 v130, v132
  v_swap_b32 v131, v133
  v_swap_b32 v34, v36
  v_swap_b32 v35, v37
  v_swap_b32 v42, v44
  v_swap_b32 v43, v45
  s_nop 1
  v_mfma_f32_16x16x32_bf16 v[144:147], v[32:35], v[128:131], v[144:147]
  v_mfma_f32_16x16x32_bf16 v[148:151], v[32:35], v[132:135], v[148:151]
  v_mfma_f32_16x16x32_bf16 v[152:155], v[36:39], v[128:131], v[152:155]
  v_mfma_f32_16x16x32_bf16 v[156:159], v[36:39], v[132:135], v[156:159]
  v_mfma_f32_16x16x32_bf16 v[160:163], v[40:43], v[128:131], v[160:163]
  v_mfma_f32_16x16x32_bf16 v[164:167], v[40:43], v[132:135], v[164:167]
  v_mfma_f32_16x16x32_bf16 v[168:171], v[44:47], v[128:131], v[168:171]
  v_mfma_f32_16x16x32_bf16 v[172:175], v[44:47], v[132:135], v[172:175]
  s_mov_b32 s101, 0
  s_waitcnt vmcnt(0)
  s_branch pvr_283
pvr_282:
  s_sleep 2
  s_add_u32 s56, s47, 10240
  s_add_u32 s57, s48, 40960
  buffer_load_dwordx4 v[96:99], v4, s[16:19], s56 offen sc1
  buffer_load_dwordx2 v[100:101], v5, s[16:19], s56 offen offset:2048 sc1
  buffer_load_dwordx4 v[136:139], v21, s[16:19], s56 offen offset:1024 sc1
  s_add_u32 s56, s56, 2560
  buffer_load_dwordx4 v[104:107], v4, s[16:19], s56 offen sc1
  buffer_load_dwordx2 v[108:109], v5, s[16:19], s56 offen offset:2048 sc1
  s_add_u32 s56, s56, 2560
  buffer_load_dwordx4 v[112:115], v4, s[16:19], s56 offen sc1
  buffer_load_dwordx2 v[116:117], v5, s[16:19], s56 offen offset:2048 sc1
  buffer_load_dwordx4 v[140:143], v21, s[16:19], s56 offen offset:1024 sc1
  s_add_u32 s56, s56, 2560
  buffer_load_dwordx4 v[120:123], v4, s[16:19], s56 offen sc1
  buffer_load_dwordx2 v[124:125], v5, s[16:19], s56 offen offset:2048 sc1
  s_add_u32 s56, s56, 2560
  buffer_load_dwordx4 v[48:51], v22, s[16:19], s57 offen offset:0 sc1
  buffer_load_dwordx4 v[56:59], v22, s[16:19], s57 offen offset:512 sc1
  s_add_u32 s57, s57, 20480
  buffer_load_dwordx4 v[52:55], v22, s[16:19], s57 offen offset:0 sc1
  buffer_load_dwordx4 v[60:63], v22, s[16:19], s57 offen offset:512 sc1
  s_add_u32 s57, s57, 20480
  s_add_u32 s101, s101, 1
  s_cmp_gt_u32 s101, 131072
  s_cbranch_scc1 main_end
  s_waitcnt vmcnt(0)
pvr_283:
  v_max3_u32 v26, v96, v100, v104
  v_max3_u32 v26, v26, v108, v112
  v_max3_u32 v26, v26, v116, v120
  v_max3_u32 v26, v26, v124, v136
  v_max3_u32 v26, v26, v140, v48
  v_max3_u32 v26, v26, v52, v56
  v_max3_u32 v26, v26, v60, v60
  v_cmp_eq_u32 vcc, -1, v26
  s_nop 1
  s_cbranch_vccnz pvr_282
  v_mfma_f32_16x16x32_bf16 v[148:151], a[64:67], v[96:99], v[148:151]
  v_mfma_f32_16x16x32_bf16 v[144:147], a[64:67], v[100:103], v[144:147]
  v_mfma_f32_16x16x32_bf16 v[156:159], a[68:71], v[96:99], v[156:159]
  v_mfma_f32_16x16x32_bf16 v[152:155], a[68:71], v[100:103], v[152:155]
  v_mfma_f32_16x16x32_bf16 v[164:167], a[72:75], v[96:99], v[164:167]
  v_mfma_f32_16x16x32_bf16 v[160:163], a[72:75], v[100:103], v[160:163]
  v_mfma_f32_16x16x32_bf16 v[172:175], a[76:79], v[96:99], v[172:175]
  v_mfma_f32_16x16x32_bf16 v[168:171], a[76:79], v[100:103], v[168:171]
  v_mfma_f32_16x16x32_bf16 v[148:151], a[80:83], v[104:107], v[148:151]
  v_mfma_f32_16x16x32_bf16 v[144:147], a[80:83], v[108:111], v[144:147]
  v_mfma_f32_16x16x32_bf16 v[156:159], a[84:87], v[104:107], v[156:159]
  v_mfma_f32_16x16x32_bf16 v[152:155], a[84:87], v[108:111], v[152:155]
  v_mfma_f32_16x16x32_bf16 v[164:167], a[88:91], v[104:107], v[164:167]
  v_mfma_f32_16x16x32_bf16 v[160:163], a[88:91], v[108:111], v[160:163]
  v_mfma_f32_16x16x32_bf16 v[172:175], a[92:95], v[104:107], v[172:175]
  v_mfma_f32_16x16x32_bf16 v[168:171], a[92:95], v[108:111], v[168:171]
  v_mfma_f32_16x16x32_bf16 v[148:151], a[96:99], v[112:115], v[148:151]
  v_mfma_f32_16x16x32_bf16 v[144:147], a[96:99], v[116:119], v[144:147]
  v_mfma_f32_16x16x32_bf16 v[156:159], a[100:103], v[112:115], v[156:159]
  v_mfma_f32_16x16x32_bf16 v[152:155], a[100:103], v[116:119], v[152:155]
  v_mfma_f32_16x16x32_bf16 v[164:167], a[104:107], v[112:115], v[164:167]
  v_mfma_f32_16x16x32_bf16 v[160:163], a[104:107], v[116:119], v[160:163]
  v_mfma_f32_16x16x32_bf16 v[172:175], a[108:111], v[112:115], v[172:175]
  v_mfma_f32_16x16x32_bf16 v[168:171], a[108:111], v[116:119], v[168:171]
  v_mfma_f32_16x16x32_bf16 v[148:151], a[112:115], v[120:123], v[148:151]
  v_mfma_f32_16x16x32_bf16 v[144:147], a[112:115], v[124:127], v[144:147]
  v_mfma_f32_16x16x32_bf16 v[156:159], a[116:119], v[120:123], v[156:159]
  v_mfma_f32_16x16x32_bf16 v[152:155], a[116:119], v[124:127], v[152:155]
  v_mfma_f32_16x16x32_bf16 v[164:167], a[120:123], v[120:123], v[164:167]
  v_mfma_f32_16x16x32_bf16 v[160:163], a[120:123], v[124:127], v[160:163]
  v_mfma_f32_16x16x32_bf16 v[172:175], a[124:127], v[120:123], v[172:175]
  v_mfma_f32_16x16x32_bf16 v[168:171], a[124:127], v[124:127], v[168:171]
  v_swap_b32 v138, v140
  v_swap_b32 v139, v141
  v_swap_b32 v50, v52
  v_swap_b32 v51, v53
  v_swap_b32 v58, v60
  v_swap_b32 v59, v61
  s_nop 1
  v_mfma_f32_16x16x32_bf16 v[144:147], v[48:51], v[136:139], v[144:147]
  v_mfma_f32_16x16x32_bf16 v[148:151], v[48:51], v[140:143], v[148:151]
  v_mfma_f32_16x16x32_bf16 v[152:155], v[52:55], v[136:139], v[152:155]
  v_mfma_f32_16x16x32_bf16 v[156:159], v[52:55], v[140:143], v[156:159]
  v_mfma_f32_16x16x32_bf16 v[160:163], v[56:59], v[136:139], v[160:163]
  v_mfma_f32_16x16x32_bf16 v[164:167], v[56:59], v[140:143], v[164:167]
  v_mfma_f32_16x16x32_bf16 v[168:171], v[60:63], v[136:139], v[168:171]
  v_mfma_f32_16x16x32_bf16 v[172:175], v[60:63], v[140:143], v[172:175]
pve_270:
  s_nop 0
  ds_write_b128 v10, v[144:147] offset:0
  ds_write_b128 v10, v[148:151] offset:1024
  ds_write_b128 v10, v[152:155] offset:2048
  ds_write_b128 v10, v[156:159] offset:3072
  ds_write_b128 v10, v[160:163] offset:4096
  ds_write_b128 v10, v[164:167] offset:5120
  ds_write_b128 v10, v[168:171] offset:6144
  ds_write_b128 v10, v[172:175] offset:7168
  s_cmp_lg_u32 s20, 0
  s_cbranch_scc1 pvq_286
  v_readfirstlane_b32 s21, v29
  s_mov_b32 s23, -1
  v_mov_b32 v213, s23
  s_mov_b64 exec, 1
  ds_write_b32 v30, v29
  ds_write_b32 v30, v213 offset:8
  s_mov_b64 exec, -1
pvq_286:
  s_waitcnt lgkmcnt(0)
  s_barrier
  ds_read_b128 v[176:179], v11 offset:0
  ds_read_b128 v[180:183], v11 offset:8192
  ds_read_b128 v[184:187], v11 offset:16384
  ds_read_b128 v[188:191], v11 offset:24576
  ds_read_b128 v[192:195], v11 offset:4096
  ds_read_b128 v[196:199], v11 offset:12288
  ds_read_b128 v[200:203], v11 offset:20480
  ds_read_b128 v[204:207], v11 offset:28672
  ds_read_b32 v23, v30
  ds_read_b32 v213, v30 offset:8
  s_waitcnt lgkmcnt(6)
  v_pk_add_f32 v[176:177], v[176:177], v[180:181]
  v_pk_add_f32 v[184:185], v[184:185], v[188:189]
  v_pk_add_f32 v[178:179], v[178:179], v[182:183]
  v_pk_add_f32 v[186:187], v[186:187], v[190:191]
  v_pk_add_f32 v[176:177], v[176:177], v[184:185]
  v_pk_add_f32 v[178:179], v[178:179], v[186:187]
  v_cvt_pk_bf16_f32 v26, v176, v177
  v_lshlrev_b32 v176, 16, v26
  v_and_b32 v177, 0xffff0000, v26
  v_mul_f32 v176, v176, v24
  v_mul_f32 v177, v177, v24
  v_cvt_pk_bf16_f32 v26, v176, v177
  v_lshlrev_b32 v176, 16, v26
  v_and_b32 v177, 0xffff0000, v26
  v_add_f32 v176, v176, v12
  v_add_f32 v177, v177, v13
  v_cvt_pk_bf16_f32 v180, v176, v177
  v_cvt_pk_bf16_f32 v26, v178, v179
  v_lshlrev_b32 v178, 16, v26
  v_and_b32 v179, 0xffff0000, v26
  v_mul_f32 v178, v178, v24
  v_mul_f32 v179, v179, v24
  v_cvt_pk_bf16_f32 v26, v178, v179
  v_lshlrev_b32 v178, 16, v26
  v_and_b32 v179, 0xffff0000, v26
  v_add_f32 v178, v178, v14
  v_add_f32 v179, v179, v15
  v_cvt_pk_bf16_f32 v181, v178, v179
  buffer_store_dwordx2 v[180:181], v9, s[8:11], s46 offen offset:0
  s_waitcnt lgkmcnt(2)
  v_pk_add_f32 v[192:193], v[192:193], v[196:197]
  v_pk_add_f32 v[200:201], v[200:201], v[204:205]
  v_pk_add_f32 v[194:195], v[194:195], v[198:199]
  v_pk_add_f32 v[202:203], v[202:203], v[206:207]
  v_pk_add_f32 v[192:193], v[192:193], v[200:201]
  v_pk_add_f32 v[194:195], v[194:195], v[202:203]
  v_cvt_pk_bf16_f32 v26, v192, v193
  v_lshlrev_b32 v192, 16, v26
  v_and_b32 v193, 0xffff0000, v26
  v_mul_f32 v192, v192, v24
  v_mul_f32 v193, v193, v24
  v_cvt_pk_bf16_f32 v26, v192, v193
  v_lshlrev_b32 v192, 16, v26
  v_and_b32 v193, 0xffff0000, v26
  v_add_f32 v192, v192, v16
  v_add_f32 v193, v193, v17
  v_cvt_pk_bf16_f32 v196, v192, v193
  v_cvt_pk_bf16_f32 v26, v194, v195
  v_lshlrev_b32 v194, 16, v26
  v_and_b32 v195, 0xffff0000, v26
  v_mul_f32 v194, v194, v24
  v_mul_f32 v195, v195, v24
  v_cvt_pk_bf16_f32 v26, v194, v195
  v_lshlrev_b32 v194, 16, v26
  v_and_b32 v195, 0xffff0000, v26
  v_add_f32 v194, v194, v18
  v_add_f32 v195, v195, v19
  v_cvt_pk_bf16_f32 v197, v194, v195
  buffer_store_dwordx2 v[196:197], v9, s[8:11], s46 offen offset:64
  s_waitcnt lgkmcnt(0)
  v_readfirstlane_b32 s2, v23
  v_readfirstlane_b32 s67, v213
  s_barrier
  s_add_u32 s21, s2, 0
  s_cmp_lt_u32 s2, 64
  s_cbranch_scc1 do_opb
  s_sub_u32 s2, s2, 64
  s_add_u32 s21, s2, 0
  s_cmp_lt_u32 s2, 600
  s_cbranch_scc1 pv_loop
  s_sub_u32 s2, s2, 600
  s_add_u32 s21, s2, 600
  s_cmp_lt_u32 s2, 40
  s_cbranch_scc1 pv_loop
  s_sub_u32 s2, s2, 40
  s_branch main_fin
  s_branch queue
main_fin:
  s_waitcnt vmcnt(0)
main_end:
  s_endpgm
.section .rodata,"a"
.p2align 6
.amdhsa_kernel gated_mix__memory_aug_recurrent_mem_tr__sliding_local_dilated__prompt_kernel
  .amdhsa_next_free_vgpr 512
  .amdhsa_next_free_sgpr 102
  .amdhsa_accum_offset 256
  .amdhsa_group_segment_fixed_size 0
  .amdhsa_kernarg_size 112
  .amdhsa_user_sgpr_count 2
  .amdhsa_user_sgpr_kernarg_segment_ptr 1
  .amdhsa_system_sgpr_workgroup_id_x 1
.end_amdhsa_kernel
.text
```

```asm
; @launch kernel=gated_mix__memory_aug_recurrent_mem_tr__sliding_local_dilated__prompt_kernel grid=(256,1,1) block=(256,1,1) lds=163840
.amdgcn_target "amdgcn-amd-amdhsa--gfx950"
.text
.globl gated_mix__memory_aug_recurrent_mem_tr__sliding_local_dilated__prompt_kernel
.p2align 8
.type gated_mix__memory_aug_recurrent_mem_tr__sliding_local_dilated__prompt_kernel,@function
gated_mix__memory_aug_recurrent_mem_tr__sliding_local_dilated__prompt_kernel:
  s_cmp_ge_u32 s2, 256
  s_cbranch_scc1 end0
  s_load_dwordx2 s[4:5], s[0:1], 96
  s_load_dwordx2 s[38:39], s[0:1], 104
  v_lshrrev_b32 v1, 6, v0
  v_and_b32 v2, 15, v0
  v_readfirstlane_b32 s20, v1
  v_and_b32 v1, 63, v0
  v_lshrrev_b32 v3, 4, v1
  s_getreg_b32 s50, hwreg(HW_REG_XCC_ID)
  s_and_b32 s50, s50, 7
  s_waitcnt lgkmcnt(0)
  s_mov_b32 s32, s4
  s_mov_b32 s33, s5
  s_mov_b32 s34, 256
  s_mov_b32 s35, 0x00020000
  v_mov_b32 v21, 0
  s_cmp_lg_u32 s20, 0
  s_cbranch_scc1 rk_1
  s_and_b32 s21, s50, 1
  s_lshl_b32 s21, s21, 7
  s_lshl_b32 s22, s50, 1
  s_and_b32 s22, s22, 12
  s_add_u32 s21, s21, s22
  v_mov_b32 v22, s21
  v_mov_b32 v23, 1
  s_mov_b64 exec, 1
  buffer_atomic_add v23, v22, s[32:35], 0 offen sc0 sc1
  s_waitcnt vmcnt(0)
  v_readfirstlane_b32 s51, v23
  s_lshl_b32 s22, s50, 5
  s_add_u32 s22, s22, s51
  s_cmp_lt_u32 s51, 32
  s_cbranch_scc1 rk_2
  v_mov_b32 v24, 72
  v_mov_b32 v25, 1
  buffer_atomic_add v25, v24, s[32:35], 0 offen sc0 sc1
  s_waitcnt vmcnt(0)
  v_readfirstlane_b32 s23, v25
  s_mov_b32 s101, 0
  s_mov_b64 exec, -1
  v_lshlrev_b32 v24, 2, v1
rk_3:
  s_sleep 8
  buffer_load_dword v25, v24, s[32:35], 0 offen sc1
  s_add_u32 s101, s101, 1
  s_cmp_gt_u32 s101, 131072
  s_cbranch_scc1 end0
  s_waitcnt vmcnt(0)
  v_readlane_b32 s21, v25, 0
  v_readlane_b32 s22, v25, 32
  s_add_u32 s21, s21, s22
  v_readlane_b32 s22, v25, 1
  s_add_u32 s21, s21, s22
  v_readlane_b32 s22, v25, 33
  s_add_u32 s21, s21, s22
  v_readlane_b32 s22, v25, 2
  s_add_u32 s21, s21, s22
  v_readlane_b32 s22, v25, 34
  s_add_u32 s21, s21, s22
  v_readlane_b32 s22, v25, 3
  s_add_u32 s21, s21, s22
  v_readlane_b32 s22, v25, 35
  s_add_u32 s21, s21, s22
  s_cmp_lt_u32 s21, 256
  s_cbranch_scc1 rk_3
  s_mov_b64 exec, 1
  s_mov_b32 s24, 0
rk_5:
  s_and_b32 s21, s24, 1
  s_lshl_b32 s21, s21, 5
  s_lshr_b32 s22, s24, 1
  s_add_u32 s21, s21, s22
  v_readlane_b32 s21, v25, s21
  s_min_u32 s21, s21, 32
  s_sub_u32 s25, 32, s21
  s_cmp_lt_u32 s23, s25
  s_cbranch_scc1 rk_4
  s_sub_u32 s23, s23, s25
  s_add_u32 s24, s24, 1
  s_cmp_lt_u32 s24, 8
  s_cbranch_scc1 rk_5
  s_branch end0
rk_4:
  s_lshl_b32 s22, s24, 5
  s_add_u32 s22, s22, s21
  s_add_u32 s22, s22, s23
  s_or_b32 s22, s22, 0x100
rk_2:
  v_mov_b32 v23, s22
  ds_write_b32 v21, v23
  s_waitcnt lgkmcnt(0)
  s_mov_b64 exec, -1
rk_1:
  s_barrier
  ds_read_b32 v23, v21
  s_waitcnt lgkmcnt(0)
  v_readfirstlane_b32 s22, v23
  s_barrier
  s_mov_b32 s84, 0
  s_mov_b32 s85, -1

  s_lshr_b32 s53, s22, 8
  s_and_b32 s22, s22, 255
  s_cmp_ge_u32 s22, 128
  s_cbranch_scc1 gemm_side
  s_lshr_b32 s50, s22, 4
  s_and_b32 s51, s22, 15
  s_mov_b32 s86, 0x3dd53b95
  s_load_dwordx2 s[4:5], s[0:1], 8
  s_load_dwordx4 s[36:39], s[0:1], 16
  s_load_dwordx4 s[40:43], s[0:1], 32
  s_load_dwordx2 s[44:45], s[0:1], 104
  s_lshr_b32 s55, s51, 2
  s_and_b32 s56, s51, 3
  s_lshl_b32 s57, s50, 2
  s_add_u32 s58, s57, s55
  s_add_u32 s59, s57, s20
  s_lshr_b32 s21, s51, 1
  s_xor_b32 s21, s21, s55
  s_andn2_b32 s21, 1, s21
  s_xor_b32 s85, s51, s21
  s_xor_b32 s84, s56, 1
  s_mul_i32 s87, s85, 5
  s_lshr_b32 s87, s87, 1
  s_and_b32 s79, s85, 1
  s_waitcnt lgkmcnt(0)
  s_add_u32 s8, s44, 78643200
  s_addc_u32 s9, s45, 0
  s_mov_b32 s10, 2162688
  s_mov_b32 s11, 0x00020000
  s_mov_b32 s16, s44
  s_mov_b32 s17, s45
  s_mov_b32 s18, 50331648
  s_mov_b32 s19, 0x00020000
  s_add_u32 s24, s44, 50331648
  s_addc_u32 s25, s45, 0
  s_mov_b32 s26, 63963136
  s_mov_b32 s27, 0x00020000
  s_mov_b32 s28, s4
  s_mov_b32 s29, s5
  s_mov_b32 s30, 10240
  s_mov_b32 s31, 0x00020000
  s_add_u32 s4, s44, 83886079
  s_addc_u32 s5, s45, 0
  s_and_b32 s4, s4, 0xffe00000
  s_mov_b32 s6, 2097152
  s_mov_b32 s7, 0x00020000
  v_mov_b32 v27, 10923
  v_add_u32 v103, 0, v1
  v_mul_u32_u24 v102, v103, v27
  v_lshrrev_b32 v102, 16, v102
  v_mul_u32_u24 v101, 6, v102
  v_sub_u32 v103, v103, v101
  v_bfe_u32 v101, v102, 1, 1
  v_mul_u32_u24 v101, 20, v101
  v_and_b32 v100, 1, v102
  v_add_u32 v101, v101, v100
  v_lshrrev_b32 v100, 3, v102
  v_mul_u32_u24 v100, 40, v100
  v_bfe_u32 v99, v102, 2, 1
  v_lshl_add_u32 v100, v99, 1, v100
  v_add_u32 v100, v100, v101
  v_mul_u32_u24 v100, 12288, v100
  v_lshl_add_u32 v46, v103, 4, v100
  v_lshrrev_b32 v100, 4, v102
  v_mul_u32_u24 v100, 40, v100
  v_bfe_u32 v99, v102, 2, 2
  v_lshl_add_u32 v100, v99, 1, v100
  v_add_u32 v100, v100, v101
  v_mul_u32_u24 v100, 12288, v100
  v_lshl_add_u32 v96, v103, 4, v100
  v_add_u32 v103, 64, v1
  v_mul_u32_u24 v102, v103, v27
  v_lshrrev_b32 v102, 16, v102
  v_mul_u32_u24 v101, 6, v102
  v_sub_u32 v103, v103, v101
  v_bfe_u32 v101, v102, 1, 1
  v_mul_u32_u24 v101, 20, v101
  v_and_b32 v100, 1, v102
  v_add_u32 v101, v101, v100
  v_lshrrev_b32 v100, 3, v102
  v_mul_u32_u24 v100, 40, v100
  v_bfe_u32 v99, v102, 2, 1
  v_lshl_add_u32 v100, v99, 1, v100
  v_add_u32 v100, v100, v101
  v_mul_u32_u24 v100, 12288, v100
  v_lshl_add_u32 v47, v103, 4, v100
  v_lshrrev_b32 v100, 4, v102
  v_mul_u32_u24 v100, 40, v100
  v_bfe_u32 v99, v102, 2, 2
  v_lshl_add_u32 v100, v99, 1, v100
  v_add_u32 v100, v100, v101
  v_mul_u32_u24 v100, 12288, v100
  v_lshl_add_u32 v97, v103, 4, v100
  v_add_u32 v103, 128, v1
  v_mul_u32_u24 v102, v103, v27
  v_lshrrev_b32 v102, 16, v102
  v_mul_u32_u24 v101, 6, v102
  v_sub_u32 v103, v103, v101
  v_bfe_u32 v101, v102, 1, 1
  v_mul_u32_u24 v101, 20, v101
  v_and_b32 v100, 1, v102
  v_add_u32 v101, v101, v100
  v_lshrrev_b32 v100, 3, v102
  v_mul_u32_u24 v100, 40, v100
  v_bfe_u32 v99, v102, 2, 1
  v_lshl_add_u32 v100, v99, 1, v100
  v_add_u32 v100, v100, v101
  v_mul_u32_u24 v100, 12288, v100
  v_lshl_add_u32 v48, v103, 4, v100
  v_lshrrev_b32 v100, 4, v102
  v_mul_u32_u24 v100, 40, v100
  v_bfe_u32 v99, v102, 2, 2
  v_lshl_add_u32 v100, v99, 1, v100
  v_add_u32 v100, v100, v101
  v_mul_u32_u24 v100, 12288, v100
  v_lshl_add_u32 v98, v103, 4, v100
  s_mul_i32 s80, s58, 384
  s_mul_i32 s22, s56, 96
  s_add_u32 s80, s80, s22
  s_mul_i32 s22, s20, 1966080
  s_add_u32 s80, s80, s22
  s_mul_i32 s88, s84, 96
  s_mul_i32 s21, s56, 96
  s_sub_u32 s88, s88, s21
  s_add_u32 s88, s88, s80
  s_mul_i32 s81, s20, 40448

  s_mul_i32 s82, s59, 245760
  s_lshl_b32 s22, s87, 5
  s_add_u32 s82, s82, s22
  s_mov_b32 s12, s38
  s_mov_b32 s13, s39
  s_mov_b32 s14, 7864320
  s_mov_b32 s15, 0x00020000
  s_add_u32 s21, s80, 0
  s_add_u32 s22, s81, 0
  s_add_u32 m0, s22, 0
  s_nop 0
  buffer_load_dwordx4 v96, s[12:15], s21 offen lds
  s_add_u32 m0, s22, 1024
  s_nop 0
  buffer_load_dwordx4 v97, s[12:15], s21 offen lds
  s_add_u32 m0, s22, 2048
  s_nop 0
  buffer_load_dwordx4 v98, s[12:15], s21 offen lds
  s_add_u32 s21, s80, 983040
  s_add_u32 s22, s81, 3072
  s_add_u32 m0, s22, 0
  s_nop 0
  buffer_load_dwordx4 v96, s[12:15], s21 offen lds
  s_add_u32 m0, s22, 1024
  s_nop 0
  buffer_load_dwordx4 v97, s[12:15], s21 offen lds
  s_add_u32 m0, s22, 2048
  s_nop 0
  buffer_load_dwordx4 v98, s[12:15], s21 offen lds
  s_add_u32 s21, s80, 98304
  s_add_u32 s22, s81, 6144
  s_add_u32 m0, s22, 0
  s_nop 0
  buffer_load_dwordx4 v96, s[12:15], s21 offen lds
  s_add_u32 m0, s22, 1024
  s_nop 0
  buffer_load_dwordx4 v97, s[12:15], s21 offen lds
  s_add_u32 m0, s22, 2048
  s_nop 0
  buffer_load_dwordx4 v98, s[12:15], s21 offen lds
  s_add_u32 s21, s80, 1081344
  s_add_u32 s22, s81, 9216
  s_add_u32 m0, s22, 0
  s_nop 0
  buffer_load_dwordx4 v96, s[12:15], s21 offen lds
  s_add_u32 m0, s22, 1024
  s_nop 0
  buffer_load_dwordx4 v97, s[12:15], s21 offen lds
  s_add_u32 m0, s22, 2048
  s_nop 0
  buffer_load_dwordx4 v98, s[12:15], s21 offen lds
  s_add_u32 s21, s80, 196608
  s_add_u32 s22, s81, 12288
  s_add_u32 m0, s22, 0
  s_nop 0
  buffer_load_dwordx4 v46, s[12:15], s21 offen lds
  s_add_u32 m0, s22, 1024
  s_nop 0
  buffer_load_dwordx4 v47, s[12:15], s21 offen lds
  s_add_u32 m0, s22, 2048
  s_nop 0
  buffer_load_dwordx4 v48, s[12:15], s21 offen lds
  s_mov_b32 s12, s40
  s_mov_b32 s13, s41
  s_mov_b32 s14, 7864320
  s_mov_b32 s15, 0x00020000
  s_add_u32 s21, s88, 0
  s_add_u32 s22, s81, 0
  buffer_load_dwordx4 v[128:131], v96, s[12:15], s21 offen
  buffer_load_dwordx4 v[132:135], v97, s[12:15], s21 offen
  buffer_load_dwordx4 v[136:139], v98, s[12:15], s21 offen
  s_add_u32 s21, s88, 983040
  s_add_u32 s22, s81, 3072
  buffer_load_dwordx4 v[140:143], v96, s[12:15], s21 offen
  buffer_load_dwordx4 v[144:147], v97, s[12:15], s21 offen
  buffer_load_dwordx4 v[148:151], v98, s[12:15], s21 offen
  s_add_u32 s21, s88, 98304
  s_add_u32 s22, s81, 6144
  buffer_load_dwordx4 v[152:155], v96, s[12:15], s21 offen
  buffer_load_dwordx4 v[156:159], v97, s[12:15], s21 offen
  buffer_load_dwordx4 v[160:163], v98, s[12:15], s21 offen
  s_add_u32 s21, s88, 1081344
  s_add_u32 s22, s81, 9216
  buffer_load_dwordx4 v[164:167], v96, s[12:15], s21 offen
  buffer_load_dwordx4 v[168:171], v97, s[12:15], s21 offen
  buffer_load_dwordx4 v[172:175], v98, s[12:15], s21 offen
  s_add_u32 s21, s88, 196608
  s_add_u32 s22, s81, 12288
  buffer_load_dwordx4 v[176:179], v46, s[12:15], s21 offen
  buffer_load_dwordx4 v[180:183], v47, s[12:15], s21 offen
  buffer_load_dwordx4 v[184:187], v48, s[12:15], s21 offen
  v_lshrrev_b32 v99, 2, v2
  v_lshl_add_u32 v99, v3, 3, v99
  v_mul_u32_u24 v99, 96, v99
  v_and_b32 v100, 3, v2
  v_lshlrev_b32 v100, 3, v100
  v_add3_u32 v99, v99, v100, s81
  v_lshlrev_b32 v100, 4, v1
  v_add_u32 v100, s81, v100
  v_and_b32 v236, 7, v2
  v_lshrrev_b32 v237, 3, v2
  v_lshlrev_b32 v238, 7, v3
  v_lshl_add_u32 v238, v236, 4, v238
  v_lshlrev_b32 v16, 4, v1
  v_mul_u32_u24 v244, 1280, v236
  s_mul_i32 s21, s20, 320
  v_add_u32 v244, s21, v244
  v_lshrrev_b32 v245, 3, v1
  v_mul_u32_u24 v245, 40, v245
  v_add_u32 v244, v244, v245
  s_lshr_b32 s21, s20, 1
  s_lshl_b32 s21, s21, 14
  s_and_b32 s22, s20, 1
  s_mul_i32 s22, s22, 3072
  s_add_u32 s21, s21, s22
  v_add_u32 v4, s21, v16
  v_mov_b32 v239, 0x4444
  v_mov_b32 v240, 0xeeee
  v_cmp_eq_u32 vcc, 1, v237
  s_nop 1
  v_cndmask_b32 v44, v239, v240, vcc
  v_cmp_gt_u32 vcc, 2, v3
  s_nop 1
  v_cndmask_b32 v89, 0, 1.0, vcc
  v_lshrrev_b32 v239, 2, v2
  v_mul_u32_u24 v239, 272, v239
  v_lshl_add_u32 v239, v3, 6, v239
  v_and_b32 v240, 3, v2
  v_lshl_add_u32 v239, v240, 2, v239
  s_mul_i32 s21, s20, 5440
  v_add_u32 v5, s21, v239
  v_mul_u32_u24 v239, 272, v3
  v_lshl_add_u32 v6, v2, 4, v239
  v_lshl_add_u32 v239, v236, 4, v239
  v_mul_u32_u24 v240, 10880, v237
  v_add_u32 v45, v239, v240
  s_lshl_b32 s21, s50, 4
  s_add_u32 s21, s21, s51
  s_lshl_b32 s21, s21, 9
  s_lshl_b32 s22, s20, 7
  s_add_u32 s21, s21, s22
  s_add_u32 s21, s21, 81920
  v_and_b32 v239, 1, v3
  v_lshlrev_b32 v239, 8, v239
  v_lshl_add_u32 v239, v236, 4, v239
  v_lshrrev_b32 v240, 1, v3
  v_lshl_add_u32 v239, v240, 3, v239
  v_add_u32 v7, s21, v239
  s_lshl_b32 s22, s58, 9
  s_lshl_b32 s23, s56, 7
  s_add_u32 s22, s22, s23
  s_add_u32 s22, s22, 376704
  v_lshlrev_b32 v239, 6, v3
  v_lshl_add_u32 v239, v236, 3, v239
  v_add_u32 v239, s22, v239
  s_cmp_eq_u32 s20, 2
  s_cselect_b64 vcc, -1, 0
  v_cndmask_b32 v7, v7, v239, vcc
  s_lshl_b32 s21, s59, 11
  s_add_u32 s21, s21, 81920
  v_add_u32 v8, s21, v16
  s_lshl_b32 s21, s59, 9
  s_add_u32 s21, s21, 376832
  v_lshl_add_u32 v9, v1, 3, s21
  s_mul_i32 s21, s59, 3072
  s_add_u32 s21, s21, 278528
  v_and_b32 v239, 0x39, v1
  v_bfe_u32 v240, v1, 1, 1
  v_lshl_or_b32 v239, v240, 2, v239
  v_bfe_u32 v240, v1, 2, 1
  v_lshl_or_b32 v239, v240, 1, v239
  v_lshl_add_u32 v10, v239, 4, s21
  s_cmp_eq_u32 s20, 3
  s_cselect_b32 s22, s84, s56
  s_mul_i32 s22, s22, 12
  v_add_u32 v239, s22, v3
  v_add3_u32 v240, 0, v239, v3
  v_lshrrev_b32 v241, 1, v240
  v_and_b32 v240, 1, v240
  v_lshlrev_b32 v240, 3, v240
  v_lshl_add_u32 v242, v241, 7, v240
  v_lshl_add_u32 v242, v236, 4, v242
  s_mul_i32 s21, s58, 3072
  v_add_u32 v21, s21, v242
  v_lshl_add_u32 v242, v241, 8, v240
  v_lshl_add_u32 v242, v2, 4, v242
  s_mul_i32 s21, s58, 12288
  s_and_b32 s22, s20, 1
  s_mul_i32 s22, s22, 6144
  s_add_u32 s21, s21, s22
  v_add_u32 v18, s21, v242
  v_add3_u32 v240, 1, v239, v3
  v_lshrrev_b32 v241, 1, v240
  v_and_b32 v240, 1, v240
  v_lshlrev_b32 v240, 3, v240
  v_lshl_add_u32 v242, v241, 7, v240
  v_lshl_add_u32 v242, v236, 4, v242
  s_mul_i32 s21, s58, 3072
  v_add_u32 v22, s21, v242
  v_lshl_add_u32 v242, v241, 8, v240
  v_lshl_add_u32 v242, v2, 4, v242
  s_mul_i32 s21, s58, 12288
  s_and_b32 s22, s20, 1
  s_mul_i32 s22, s22, 6144
  s_add_u32 s21, s21, s22
  v_add_u32 v19, s21, v242
  v_add_u32 v240, 8, v239
  v_lshrrev_b32 v241, 1, v240
  v_and_b32 v240, 1, v240
  v_lshlrev_b32 v240, 3, v240
  v_lshl_add_u32 v242, v241, 7, v240
  v_lshl_add_u32 v242, v236, 4, v242
  s_mul_i32 s21, s58, 3072
  v_add_u32 v23, s21, v242
  v_lshl_add_u32 v242, v241, 8, v240
  v_lshl_add_u32 v242, v2, 4, v242
  s_mul_i32 s21, s58, 12288
  s_and_b32 s22, s20, 1
  s_mul_i32 s22, s22, 6144
  s_add_u32 s21, s21, s22
  v_add_u32 v20, s21, v242
  v_cmp_eq_u32 vcc, 1, v237
  s_nop 1
  v_cndmask_b32 v25, v21, v22, vcc
  v_add_u32 v24, 278528, v25
  s_mul_i32 s21, s20, 3072
  s_add_u32 s21, s21, 22528
  v_add_u32 v11, s21, v16
  v_and_b32 v239, 3, v1
  s_mul_i32 s21, s20, 3
  v_add_u32 v240, s21, v239
  v_cmp_eq_u32 vcc, 3, v239
  v_lshrrev_b32 v241, 5, v1
  v_mul_u32_u24 v241, 10, v241
  v_cndmask_b32 v240, v240, 9, vcc
  s_lshl_b32 s21, s79, 2
  v_add3_u32 v240, v240, v241, s21
  v_lshrrev_b32 v241, 1, v240
  v_lshlrev_b32 v241, 8, v241
  v_and_b32 v240, 1, v240
  v_lshl_add_u32 v241, v240, 3, v241
  v_bfe_u32 v240, v1, 2, 3
  v_lshl_add_u32 v241, v240, 4, v241
  v_add_u32 v12, 22528, v241
  s_mov_b32 s21, 0x07060100
  s_cmp_eq_u32 s20, 1
  s_cselect_b32 s21, 0x07060302, s21
  s_cmp_eq_u32 s20, 2
  s_cselect_b32 s21, 0x07060c0c, s21
  v_mov_b32 v240, s21
  v_mov_b32 v241, 0x03020100
  v_cndmask_b32 v14, v241, v240, vcc
  s_lshr_b32 s21, s85, 3
  s_lshl_b32 s21, s21, 14
  s_bfe_u32 s22, s85, 0x10002
  s_mul_i32 s22, s22, 3072
  s_add_u32 s21, s21, s22
  s_and_b32 s22, s85, 3
  s_lshl_b32 s22, s22, 8
  s_add_u32 s21, s21, s22
  s_lshl_b32 s22, s20, 10
  s_add_u32 s22, s22, s21
  v_lshl_add_u32 v13, v1, 2, s22
  v_lshlrev_b32 v240, 10, v3
  v_lshl_add_u32 v240, v2, 4, v240
  v_add_u32 v240, s21, v240
  s_cmp_eq_u32 s20, 3
  s_cselect_b64 vcc, -1, 0
  v_cndmask_b32 v13, v13, v240, vcc
  s_mov_b32 s91, 0x3c000000
  v_and_b32 v240, 1, v3
  v_lshrrev_b32 v241, 1, v3
  v_lshl_add_u32 v240, v240, 1, v241
  v_lshlrev_b32 v240, 8, v240
  v_lshl_add_u32 v240, v2, 4, v240
  s_mul_i32 s21, s59, 10240
  s_lshl_b32 s22, s87, 8
  s_add_u32 s21, s21, s22
  v_add_u32 v15, s21, v240
  s_lshl_b32 s21, s79, 4
  s_lshl_b32 s76, -1, s21
  s_mov_b32 s77, 0xffff
  s_lshl_b32 s21, s79, 7
  v_or_b32 v17, s21, v16
  s_or_b32 s21, s21, 0xffffff7f
  v_and_b32 v26, s21, v16
  v_mov_b32 v243, 0
  s_mul_i32 s89, s59, 12288
  s_add_u32 s89, s89, 25165824
  v_cmp_gt_u32 s[60:61], 8, v2
  v_cmp_le_u32 s[62:63], 8, v2
  v_cmp_le_u32 s[72:73], 2, v3
  v_cmp_gt_u32 s[70:71], 48, v1
  s_nop 1
  s_and_b64 s[64:65], s[60:61], s[72:73]
  s_cmp_eq_u32 s20, 2
  s_cselect_b64 s[74:75], s[64:65], s[60:61]
  s_mul_i32 s89, s59, 12288
  s_add_u32 s89, s89, 25165824
  s_not_b64 s[48:49], s[72:73]
  v_mov_b32 v27, 10923
  v_mov_b32 v49, v100
  v_add_u32 v113, 576, v1
  v_mul_u32_u24 v103, v113, v27
  v_lshrrev_b32 v103, 16, v103
  v_mul_u32_u24 v102, 6, v103
  v_sub_u32 v113, v113, v102
  v_bfe_u32 v102, v103, 1, 1
  v_lshlrev_b32 v102, 3, v102
  v_and_b32 v127, 12, v103
  v_lshrrev_b32 v127, 1, v127
  v_and_b32 v103, 0xfffffff1, v103
  v_or3_b32 v103, v103, v102, v127
  v_mul_u32_u24 v102, 1366, v103
  v_lshrrev_b32 v102, 16, v102
  v_mul_u32_u24 v100, 48, v102
  v_sub_u32 v103, v103, v100
  v_cmp_gt_u32 vcc, 32, v103
  v_bfe_u32 v101, v103, 3, 2
  v_and_b32 v126, 3, v103
  v_lshl_add_u32 v126, v101, 2, v126
  v_bfe_u32 v101, v103, 2, 1
  v_lshl_add_u32 v126, v101, 4, v126
  v_cndmask_b32 v103, v103, v126, vcc
  v_add_u32 v100, v100, v103
  v_mul_u32_u24 v100, 1280, v100
  v_lshl_add_u32 v113, v113, 4, v100
  v_add_u32 v114, 640, v1
  v_mul_u32_u24 v103, v114, v27
  v_lshrrev_b32 v103, 16, v103
  v_mul_u32_u24 v102, 6, v103
  v_sub_u32 v114, v114, v102
  v_bfe_u32 v102, v103, 1, 1
  v_lshlrev_b32 v102, 3, v102
  v_and_b32 v127, 12, v103
  v_lshrrev_b32 v127, 1, v127
  v_and_b32 v103, 0xfffffff1, v103
  v_or3_b32 v103, v103, v102, v127
  v_mul_u32_u24 v102, 1366, v103
  v_lshrrev_b32 v102, 16, v102
  v_mul_u32_u24 v100, 48, v102
  v_sub_u32 v103, v103, v100
  v_cmp_gt_u32 vcc, 32, v103
  v_bfe_u32 v101, v103, 3, 2
  v_and_b32 v126, 3, v103
  v_lshl_add_u32 v126, v101, 2, v126
  v_bfe_u32 v101, v103, 2, 1
  v_lshl_add_u32 v126, v101, 4, v126
  v_cndmask_b32 v103, v103, v126, vcc
  v_add_u32 v100, v100, v103
  v_mul_u32_u24 v100, 1280, v100
  v_lshl_add_u32 v114, v114, 4, v100
  v_add_u32 v115, 704, v1
  v_mul_u32_u24 v103, v115, v27
  v_lshrrev_b32 v103, 16, v103
  v_mul_u32_u24 v102, 6, v103
  v_sub_u32 v115, v115, v102
  v_bfe_u32 v102, v103, 1, 1
  v_lshlrev_b32 v102, 3, v102
  v_and_b32 v127, 12, v103
  v_lshrrev_b32 v127, 1, v127
  v_and_b32 v103, 0xfffffff1, v103
  v_or3_b32 v103, v103, v102, v127
  v_mul_u32_u24 v102, 1366, v103
  v_lshrrev_b32 v102, 16, v102
  v_mul_u32_u24 v100, 48, v102
  v_sub_u32 v103, v103, v100
  v_cmp_gt_u32 vcc, 32, v103
  v_bfe_u32 v101, v103, 3, 2
  v_and_b32 v126, 3, v103
  v_lshl_add_u32 v126, v101, 2, v126
  v_bfe_u32 v101, v103, 2, 1
  v_lshl_add_u32 v126, v101, 4, v126
  v_cndmask_b32 v103, v103, v126, vcc
  v_add_u32 v100, v100, v103
  v_mul_u32_u24 v100, 1280, v100
  v_lshl_add_u32 v115, v115, 4, v100
  v_add_u32 v116, 768, v1
  v_mul_u32_u24 v103, v116, v27
  v_lshrrev_b32 v103, 16, v103
  v_mul_u32_u24 v102, 6, v103
  v_sub_u32 v116, v116, v102
  v_bfe_u32 v102, v103, 1, 1
  v_lshlrev_b32 v102, 3, v102
  v_and_b32 v127, 12, v103
  v_lshrrev_b32 v127, 1, v127
  v_and_b32 v103, 0xfffffff1, v103
  v_or3_b32 v103, v103, v102, v127
  v_mul_u32_u24 v102, 1366, v103
  v_lshrrev_b32 v102, 16, v102
  v_mul_u32_u24 v100, 48, v102
  v_sub_u32 v103, v103, v100
  v_cmp_gt_u32 vcc, 32, v103
  v_bfe_u32 v101, v103, 3, 2
  v_and_b32 v126, 3, v103
  v_lshl_add_u32 v126, v101, 2, v126
  v_bfe_u32 v101, v103, 2, 1
  v_lshl_add_u32 v126, v101, 4, v126
  v_cndmask_b32 v103, v103, v126, vcc
  v_add_u32 v100, v100, v103
  v_mul_u32_u24 v100, 1280, v100
  v_lshl_add_u32 v116, v116, 4, v100
  v_add_u32 v117, 832, v1
  v_mul_u32_u24 v103, v117, v27
  v_lshrrev_b32 v103, 16, v103
  v_mul_u32_u24 v102, 6, v103
  v_sub_u32 v117, v117, v102
  v_bfe_u32 v102, v103, 1, 1
  v_lshlrev_b32 v102, 3, v102
  v_and_b32 v127, 12, v103
  v_lshrrev_b32 v127, 1, v127
  v_and_b32 v103, 0xfffffff1, v103
  v_or3_b32 v103, v103, v102, v127
  v_mul_u32_u24 v102, 1366, v103
  v_lshrrev_b32 v102, 16, v102
  v_mul_u32_u24 v100, 48, v102
  v_sub_u32 v103, v103, v100
  v_cmp_gt_u32 vcc, 32, v103
  v_bfe_u32 v101, v103, 3, 2
  v_and_b32 v126, 3, v103
  v_lshl_add_u32 v126, v101, 2, v126
  v_bfe_u32 v101, v103, 2, 1
  v_lshl_add_u32 v126, v101, 4, v126
  v_cndmask_b32 v103, v103, v126, vcc
  v_add_u32 v100, v100, v103
  v_mul_u32_u24 v100, 1280, v100
  v_lshl_add_u32 v117, v117, 4, v100
  v_add_u32 v118, 896, v1
  v_mul_u32_u24 v103, v118, v27
  v_lshrrev_b32 v103, 16, v103
  v_mul_u32_u24 v102, 6, v103
  v_sub_u32 v118, v118, v102
  v_bfe_u32 v102, v103, 1, 1
  v_lshlrev_b32 v102, 3, v102
  v_and_b32 v127, 12, v103
  v_lshrrev_b32 v127, 1, v127
  v_and_b32 v103, 0xfffffff1, v103
  v_or3_b32 v103, v103, v102, v127
  v_mul_u32_u24 v102, 1366, v103
  v_lshrrev_b32 v102, 16, v102
  v_mul_u32_u24 v100, 48, v102
  v_sub_u32 v103, v103, v100
  v_cmp_gt_u32 vcc, 32, v103
  v_bfe_u32 v101, v103, 3, 2
  v_and_b32 v126, 3, v103
  v_lshl_add_u32 v126, v101, 2, v126
  v_bfe_u32 v101, v103, 2, 1
  v_lshl_add_u32 v126, v101, 4, v126
  v_cndmask_b32 v103, v103, v126, vcc
  v_add_u32 v100, v100, v103
  v_mul_u32_u24 v100, 1280, v100
  v_lshl_add_u32 v118, v118, 4, v100
  v_add_u32 v119, 960, v1
  v_mul_u32_u24 v103, v119, v27
  v_lshrrev_b32 v103, 16, v103
  v_mul_u32_u24 v102, 6, v103
  v_sub_u32 v119, v119, v102
  v_bfe_u32 v102, v103, 1, 1
  v_lshlrev_b32 v102, 3, v102
  v_and_b32 v127, 12, v103
  v_lshrrev_b32 v127, 1, v127
  v_and_b32 v103, 0xfffffff1, v103
  v_or3_b32 v103, v103, v102, v127
  v_mul_u32_u24 v102, 1366, v103
  v_lshrrev_b32 v102, 16, v102
  v_mul_u32_u24 v100, 48, v102
  v_sub_u32 v103, v103, v100
  v_cmp_gt_u32 vcc, 32, v103
  v_bfe_u32 v101, v103, 3, 2
  v_and_b32 v126, 3, v103
  v_lshl_add_u32 v126, v101, 2, v126
  v_bfe_u32 v101, v103, 2, 1
  v_lshl_add_u32 v126, v101, 4, v126
  v_cndmask_b32 v103, v103, v126, vcc
  v_add_u32 v100, v100, v103
  v_mul_u32_u24 v100, 1280, v100
  v_lshl_add_u32 v119, v119, 4, v100
  v_add_u32 v120, 1024, v1
  v_mul_u32_u24 v103, v120, v27
  v_lshrrev_b32 v103, 16, v103
  v_mul_u32_u24 v102, 6, v103
  v_sub_u32 v120, v120, v102
  v_bfe_u32 v102, v103, 1, 1
  v_lshlrev_b32 v102, 3, v102
  v_and_b32 v127, 12, v103
  v_lshrrev_b32 v127, 1, v127
  v_and_b32 v103, 0xfffffff1, v103
  v_or3_b32 v103, v103, v102, v127
  v_mul_u32_u24 v102, 1366, v103
  v_lshrrev_b32 v102, 16, v102
  v_mul_u32_u24 v100, 48, v102
  v_sub_u32 v103, v103, v100
  v_cmp_gt_u32 vcc, 32, v103
  v_bfe_u32 v101, v103, 3, 2
  v_and_b32 v126, 3, v103
  v_lshl_add_u32 v126, v101, 2, v126
  v_bfe_u32 v101, v103, 2, 1
  v_lshl_add_u32 v126, v101, 4, v126
  v_cndmask_b32 v103, v103, v126, vcc
  v_add_u32 v100, v100, v103
  v_mul_u32_u24 v100, 1280, v100
  v_lshl_add_u32 v120, v120, 4, v100
  v_add_u32 v121, 1088, v1
  v_mul_u32_u24 v103, v121, v27
  v_lshrrev_b32 v103, 16, v103
  v_mul_u32_u24 v102, 6, v103
  v_sub_u32 v121, v121, v102
  v_bfe_u32 v102, v103, 1, 1
  v_lshlrev_b32 v102, 3, v102
  v_and_b32 v127, 12, v103
  v_lshrrev_b32 v127, 1, v127
  v_and_b32 v103, 0xfffffff1, v103
  v_or3_b32 v103, v103, v102, v127
  v_mul_u32_u24 v102, 1366, v103
  v_lshrrev_b32 v102, 16, v102
  v_mul_u32_u24 v100, 48, v102
  v_sub_u32 v103, v103, v100
  v_cmp_gt_u32 vcc, 32, v103
  v_bfe_u32 v101, v103, 3, 2
  v_and_b32 v126, 3, v103
  v_lshl_add_u32 v126, v101, 2, v126
  v_bfe_u32 v101, v103, 2, 1
  v_lshl_add_u32 v126, v101, 4, v126
  v_cndmask_b32 v103, v103, v126, vcc
  v_add_u32 v100, v100, v103
  v_mul_u32_u24 v100, 1280, v100
  v_lshl_add_u32 v121, v121, 4, v100
  s_waitcnt vmcnt(63)
  s_mov_b32 s12, s42
  s_mov_b32 s13, s43
  s_mov_b32 s14, 7864320
  s_mov_b32 s15, 0x00020000
  buffer_load_dwordx4 v[188:191], v113, s[12:15], s82 offen
  buffer_load_dwordx4 v[192:195], v114, s[12:15], s82 offen
  buffer_load_dwordx4 v[196:199], v115, s[12:15], s82 offen
  buffer_load_dwordx4 v[200:203], v116, s[12:15], s82 offen
  buffer_load_dwordx4 v[204:207], v117, s[12:15], s82 offen
  buffer_load_dwordx4 v[208:211], v118, s[12:15], s82 offen
  buffer_load_dwordx4 v[212:215], v119, s[12:15], s82 offen
  buffer_load_dwordx4 v[216:219], v120, s[12:15], s82 offen
  buffer_load_dwordx4 v[220:223], v121, s[12:15], s82 offen
  v_add_u32 v104, 0, v1
  v_mul_u32_u24 v103, v104, v27
  v_lshrrev_b32 v103, 16, v103
  v_mul_u32_u24 v102, 6, v103
  v_sub_u32 v104, v104, v102
  v_bfe_u32 v102, v103, 1, 1
  v_lshlrev_b32 v102, 3, v102
  v_and_b32 v127, 12, v103
  v_lshrrev_b32 v127, 1, v127
  v_and_b32 v103, 0xfffffff1, v103
  v_or3_b32 v103, v103, v102, v127
  v_mul_u32_u24 v102, 1366, v103
  v_lshrrev_b32 v102, 16, v102
  v_mul_u32_u24 v100, 48, v102
  v_sub_u32 v103, v103, v100
  v_cmp_gt_u32 vcc, 32, v103
  v_bfe_u32 v101, v103, 3, 2
  v_and_b32 v126, 3, v103
  v_lshl_add_u32 v126, v101, 2, v126
  v_bfe_u32 v101, v103, 2, 1
  v_lshl_add_u32 v126, v101, 4, v126
  v_cndmask_b32 v103, v103, v126, vcc
  v_add_u32 v100, v100, v103
  v_mul_u32_u24 v100, 1280, v100
  v_lshl_add_u32 v104, v104, 4, v100
  v_add_u32 v105, 64, v1
  v_mul_u32_u24 v103, v105, v27
  v_lshrrev_b32 v103, 16, v103
  v_mul_u32_u24 v102, 6, v103
  v_sub_u32 v105, v105, v102
  v_bfe_u32 v102, v103, 1, 1
  v_lshlrev_b32 v102, 3, v102
  v_and_b32 v127, 12, v103
  v_lshrrev_b32 v127, 1, v127
  v_and_b32 v103, 0xfffffff1, v103
  v_or3_b32 v103, v103, v102, v127
  v_mul_u32_u24 v102, 1366, v103
  v_lshrrev_b32 v102, 16, v102
  v_mul_u32_u24 v100, 48, v102
  v_sub_u32 v103, v103, v100
  v_cmp_gt_u32 vcc, 32, v103
  v_bfe_u32 v101, v103, 3, 2
  v_and_b32 v126, 3, v103
  v_lshl_add_u32 v126, v101, 2, v126
  v_bfe_u32 v101, v103, 2, 1
  v_lshl_add_u32 v126, v101, 4, v126
  v_cndmask_b32 v103, v103, v126, vcc
  v_add_u32 v100, v100, v103
  v_mul_u32_u24 v100, 1280, v100
  v_lshl_add_u32 v105, v105, 4, v100
  v_add_u32 v106, 128, v1
  v_mul_u32_u24 v103, v106, v27
  v_lshrrev_b32 v103, 16, v103
  v_mul_u32_u24 v102, 6, v103
  v_sub_u32 v106, v106, v102
  v_bfe_u32 v102, v103, 1, 1
  v_lshlrev_b32 v102, 3, v102
  v_and_b32 v127, 12, v103
  v_lshrrev_b32 v127, 1, v127
  v_and_b32 v103, 0xfffffff1, v103
  v_or3_b32 v103, v103, v102, v127
  v_mul_u32_u24 v102, 1366, v103
  v_lshrrev_b32 v102, 16, v102
  v_mul_u32_u24 v100, 48, v102
  v_sub_u32 v103, v103, v100
  v_cmp_gt_u32 vcc, 32, v103
  v_bfe_u32 v101, v103, 3, 2
  v_and_b32 v126, 3, v103
  v_lshl_add_u32 v126, v101, 2, v126
  v_bfe_u32 v101, v103, 2, 1
  v_lshl_add_u32 v126, v101, 4, v126
  v_cndmask_b32 v103, v103, v126, vcc
  v_add_u32 v100, v100, v103
  v_mul_u32_u24 v100, 1280, v100
  v_lshl_add_u32 v106, v106, 4, v100
  v_add_u32 v107, 192, v1
  v_mul_u32_u24 v103, v107, v27
  v_lshrrev_b32 v103, 16, v103
  v_mul_u32_u24 v102, 6, v103
  v_sub_u32 v107, v107, v102
  v_bfe_u32 v102, v103, 1, 1
  v_lshlrev_b32 v102, 3, v102
  v_and_b32 v127, 12, v103
  v_lshrrev_b32 v127, 1, v127
  v_and_b32 v103, 0xfffffff1, v103
  v_or3_b32 v103, v103, v102, v127
  v_mul_u32_u24 v102, 1366, v103
  v_lshrrev_b32 v102, 16, v102
  v_mul_u32_u24 v100, 48, v102
  v_sub_u32 v103, v103, v100
  v_cmp_gt_u32 vcc, 32, v103
  v_bfe_u32 v101, v103, 3, 2
  v_and_b32 v126, 3, v103
  v_lshl_add_u32 v126, v101, 2, v126
  v_bfe_u32 v101, v103, 2, 1
  v_lshl_add_u32 v126, v101, 4, v126
  v_cndmask_b32 v103, v103, v126, vcc
  v_add_u32 v100, v100, v103
  v_mul_u32_u24 v100, 1280, v100
  v_lshl_add_u32 v107, v107, 4, v100
  v_add_u32 v108, 256, v1
  v_mul_u32_u24 v103, v108, v27
  v_lshrrev_b32 v103, 16, v103
  v_mul_u32_u24 v102, 6, v103
  v_sub_u32 v108, v108, v102
  v_bfe_u32 v102, v103, 1, 1
  v_lshlrev_b32 v102, 3, v102
  v_and_b32 v127, 12, v103
  v_lshrrev_b32 v127, 1, v127
  v_and_b32 v103, 0xfffffff1, v103
  v_or3_b32 v103, v103, v102, v127
  v_mul_u32_u24 v102, 1366, v103
  v_lshrrev_b32 v102, 16, v102
  v_mul_u32_u24 v100, 48, v102
  v_sub_u32 v103, v103, v100
  v_cmp_gt_u32 vcc, 32, v103
  v_bfe_u32 v101, v103, 3, 2
  v_and_b32 v126, 3, v103
  v_lshl_add_u32 v126, v101, 2, v126
  v_bfe_u32 v101, v103, 2, 1
  v_lshl_add_u32 v126, v101, 4, v126
  v_cndmask_b32 v103, v103, v126, vcc
  v_add_u32 v100, v100, v103
  v_mul_u32_u24 v100, 1280, v100
  v_lshl_add_u32 v108, v108, 4, v100
  v_add_u32 v109, 320, v1
  v_mul_u32_u24 v103, v109, v27
  v_lshrrev_b32 v103, 16, v103
  v_mul_u32_u24 v102, 6, v103
  v_sub_u32 v109, v109, v102
  v_bfe_u32 v102, v103, 1, 1
  v_lshlrev_b32 v102, 3, v102
  v_and_b32 v127, 12, v103
  v_lshrrev_b32 v127, 1, v127
  v_and_b32 v103, 0xfffffff1, v103
  v_or3_b32 v103, v103, v102, v127
  v_mul_u32_u24 v102, 1366, v103
  v_lshrrev_b32 v102, 16, v102
  v_mul_u32_u24 v100, 48, v102
  v_sub_u32 v103, v103, v100
  v_cmp_gt_u32 vcc, 32, v103
  v_bfe_u32 v101, v103, 3, 2
  v_and_b32 v126, 3, v103
  v_lshl_add_u32 v126, v101, 2, v126
  v_bfe_u32 v101, v103, 2, 1
  v_lshl_add_u32 v126, v101, 4, v126
  v_cndmask_b32 v103, v103, v126, vcc
  v_add_u32 v100, v100, v103
  v_mul_u32_u24 v100, 1280, v100
  v_lshl_add_u32 v109, v109, 4, v100
  v_add_u32 v110, 384, v1
  v_mul_u32_u24 v103, v110, v27
  v_lshrrev_b32 v103, 16, v103
  v_mul_u32_u24 v102, 6, v103
  v_sub_u32 v110, v110, v102
  v_bfe_u32 v102, v103, 1, 1
  v_lshlrev_b32 v102, 3, v102
  v_and_b32 v127, 12, v103
  v_lshrrev_b32 v127, 1, v127
  v_and_b32 v103, 0xfffffff1, v103
  v_or3_b32 v103, v103, v102, v127
  v_mul_u32_u24 v102, 1366, v103
  v_lshrrev_b32 v102, 16, v102
  v_mul_u32_u24 v100, 48, v102
  v_sub_u32 v103, v103, v100
  v_cmp_gt_u32 vcc, 32, v103
  v_bfe_u32 v101, v103, 3, 2
  v_and_b32 v126, 3, v103
  v_lshl_add_u32 v126, v101, 2, v126
  v_bfe_u32 v101, v103, 2, 1
  v_lshl_add_u32 v126, v101, 4, v126
  v_cndmask_b32 v103, v103, v126, vcc
  v_add_u32 v100, v100, v103
  v_mul_u32_u24 v100, 1280, v100
  v_lshl_add_u32 v110, v110, 4, v100
  v_add_u32 v111, 448, v1
  v_mul_u32_u24 v103, v111, v27
  v_lshrrev_b32 v103, 16, v103
  v_mul_u32_u24 v102, 6, v103
  v_sub_u32 v111, v111, v102
  v_bfe_u32 v102, v103, 1, 1
  v_lshlrev_b32 v102, 3, v102
  v_and_b32 v127, 12, v103
  v_lshrrev_b32 v127, 1, v127
  v_and_b32 v103, 0xfffffff1, v103
  v_or3_b32 v103, v103, v102, v127
  v_mul_u32_u24 v102, 1366, v103
  v_lshrrev_b32 v102, 16, v102
  v_mul_u32_u24 v100, 48, v102
  v_sub_u32 v103, v103, v100
  v_cmp_gt_u32 vcc, 32, v103
  v_bfe_u32 v101, v103, 3, 2
  v_and_b32 v126, 3, v103
  v_lshl_add_u32 v126, v101, 2, v126
  v_bfe_u32 v101, v103, 2, 1
  v_lshl_add_u32 v126, v101, 4, v126
  v_cndmask_b32 v103, v103, v126, vcc
  v_add_u32 v100, v100, v103
  v_mul_u32_u24 v100, 1280, v100
  v_lshl_add_u32 v111, v111, 4, v100
  v_add_u32 v112, 512, v1
  v_mul_u32_u24 v103, v112, v27
  v_lshrrev_b32 v103, 16, v103
  v_mul_u32_u24 v102, 6, v103
  v_sub_u32 v112, v112, v102
  v_bfe_u32 v102, v103, 1, 1
  v_lshlrev_b32 v102, 3, v102
  v_and_b32 v127, 12, v103
  v_lshrrev_b32 v127, 1, v127
  v_and_b32 v103, 0xfffffff1, v103
  v_or3_b32 v103, v103, v102, v127
  v_mul_u32_u24 v102, 1366, v103
  v_lshrrev_b32 v102, 16, v102
  v_mul_u32_u24 v100, 48, v102
  v_sub_u32 v103, v103, v100
  v_cmp_gt_u32 vcc, 32, v103
  v_bfe_u32 v101, v103, 3, 2
  v_and_b32 v126, 3, v103
  v_lshl_add_u32 v126, v101, 2, v126
  v_bfe_u32 v101, v103, 2, 1
  v_lshl_add_u32 v126, v101, 4, v126
  v_cndmask_b32 v103, v103, v126, vcc
  v_add_u32 v100, v100, v103
  v_mul_u32_u24 v100, 1280, v100
  v_lshl_add_u32 v112, v112, 4, v100
  s_waitcnt vmcnt(63)
  s_mov_b32 s12, s42
  s_mov_b32 s13, s43
  s_mov_b32 s14, 7864320
  s_mov_b32 s15, 0x00020000
  s_add_u32 m0, s81, 30720
  s_nop 0
  buffer_load_dwordx4 v104, s[12:15], s82 offen lds
  s_add_u32 m0, s81, 31744
  s_nop 0
  buffer_load_dwordx4 v105, s[12:15], s82 offen lds
  s_add_u32 m0, s81, 32768
  s_nop 0
  buffer_load_dwordx4 v106, s[12:15], s82 offen lds
  s_add_u32 m0, s81, 33792
  s_nop 0
  buffer_load_dwordx4 v107, s[12:15], s82 offen lds
  s_add_u32 m0, s81, 34816
  s_nop 0
  buffer_load_dwordx4 v108, s[12:15], s82 offen lds
  s_add_u32 m0, s81, 35840
  s_nop 0
  buffer_load_dwordx4 v109, s[12:15], s82 offen lds
  s_add_u32 m0, s81, 36864
  s_nop 0
  buffer_load_dwordx4 v110, s[12:15], s82 offen lds
  s_add_u32 m0, s81, 37888
  s_nop 0
  buffer_load_dwordx4 v111, s[12:15], s82 offen lds
  s_add_u32 m0, s81, 38912
  s_nop 0
  buffer_load_dwordx4 v112, s[12:15], s82 offen lds
  s_waitcnt vmcnt(63)
  s_mov_b32 s12, s36
  s_mov_b32 s13, s37
  s_mov_b32 s14, 7864320
  s_mov_b32 s15, 0x00020000
  s_add_u32 s21, s80, 0
  s_add_u32 s22, s81, 15360
  s_add_u32 m0, s22, 0
  s_nop 0
  buffer_load_dwordx4 v96, s[12:15], s21 offen lds
  s_add_u32 m0, s22, 1024
  s_nop 0
  buffer_load_dwordx4 v97, s[12:15], s21 offen lds
  s_add_u32 m0, s22, 2048
  s_nop 0
  buffer_load_dwordx4 v98, s[12:15], s21 offen lds
  s_waitcnt vmcnt(63)
  s_mov_b32 s12, s36
  s_mov_b32 s13, s37
  s_mov_b32 s14, 7864320
  s_mov_b32 s15, 0x00020000
  s_add_u32 s21, s80, 983040
  s_add_u32 s22, s81, 18432
  s_add_u32 m0, s22, 0
  s_nop 0
  buffer_load_dwordx4 v96, s[12:15], s21 offen lds
  s_add_u32 m0, s22, 1024
  s_nop 0
  buffer_load_dwordx4 v97, s[12:15], s21 offen lds
  s_add_u32 m0, s22, 2048
  s_nop 0
  buffer_load_dwordx4 v98, s[12:15], s21 offen lds
  s_waitcnt vmcnt(63)
  s_mov_b32 s12, s36
  s_mov_b32 s13, s37
  s_mov_b32 s14, 7864320
  s_mov_b32 s15, 0x00020000
  s_add_u32 s21, s80, 98304
  s_add_u32 s22, s81, 21504
  s_add_u32 m0, s22, 0
  s_nop 0
  buffer_load_dwordx4 v96, s[12:15], s21 offen lds
  s_add_u32 m0, s22, 1024
  s_nop 0
  buffer_load_dwordx4 v97, s[12:15], s21 offen lds
  s_add_u32 m0, s22, 2048
  s_nop 0
  buffer_load_dwordx4 v98, s[12:15], s21 offen lds
  s_waitcnt vmcnt(63)
  s_mov_b32 s12, s36
  s_mov_b32 s13, s37
  s_mov_b32 s14, 7864320
  s_mov_b32 s15, 0x00020000
  s_add_u32 s21, s80, 1081344
  s_add_u32 s22, s81, 24576
  s_add_u32 m0, s22, 0
  s_nop 0
  buffer_load_dwordx4 v96, s[12:15], s21 offen lds
  s_add_u32 m0, s22, 1024
  s_nop 0
  buffer_load_dwordx4 v97, s[12:15], s21 offen lds
  s_add_u32 m0, s22, 2048
  s_nop 0
  buffer_load_dwordx4 v98, s[12:15], s21 offen lds
  s_waitcnt vmcnt(63)
  s_mov_b32 s12, s36
  s_mov_b32 s13, s37
  s_mov_b32 s14, 7864320
  s_mov_b32 s15, 0x00020000
  s_add_u32 s21, s80, 196608
  s_add_u32 s22, s81, 27648
  s_add_u32 m0, s22, 0
  s_nop 0
  buffer_load_dwordx4 v46, s[12:15], s21 offen lds
  s_add_u32 m0, s22, 1024
  s_nop 0
  buffer_load_dwordx4 v47, s[12:15], s21 offen lds
  s_add_u32 m0, s22, 2048
  s_nop 0
  buffer_load_dwordx4 v48, s[12:15], s21 offen lds
  buffer_load_dwordx4 v[32:35], v244, s[28:31], 0 offen offset:0
  buffer_load_dwordx4 v[36:39], v244, s[28:31], 0 offen offset:16
  buffer_load_dwordx2 v[40:41], v244, s[28:31], 0 offen offset:32
  v_mov_b32 v100, v49
  v_lshlrev_b32 v239, 2, v1
  s_waitcnt vmcnt(51)
  ds_read_b64_tr_b16 a[60:61], v99 offset:0
  ds_read_b64_tr_b16 a[62:63], v99 offset:384
  ds_read_b64_tr_b16 a[80:81], v99 offset:32
  ds_read_b64_tr_b16 a[82:83], v99 offset:416
  ds_read_b64_tr_b16 a[100:101], v99 offset:64
  ds_read_b64_tr_b16 a[102:103], v99 offset:448
  ds_read_b64_tr_b16 a[64:65], v99 offset:3072
  ds_read_b64_tr_b16 a[66:67], v99 offset:3456
  ds_read_b64_tr_b16 a[84:85], v99 offset:3104
  ds_read_b64_tr_b16 a[86:87], v99 offset:3488
  ds_read_b64_tr_b16 a[104:105], v99 offset:3136
  ds_read_b64_tr_b16 a[106:107], v99 offset:3520
  ds_read_b64_tr_b16 a[68:69], v99 offset:6144
  ds_read_b64_tr_b16 a[70:71], v99 offset:6528
  ds_read_b64_tr_b16 a[88:89], v99 offset:6176
  ds_read_b64_tr_b16 a[90:91], v99 offset:6560
  ds_read_b64_tr_b16 a[108:109], v99 offset:6208
  ds_read_b64_tr_b16 a[110:111], v99 offset:6592
  ds_read_b64_tr_b16 a[72:73], v99 offset:9216
  ds_read_b64_tr_b16 a[74:75], v99 offset:9600
  ds_read_b64_tr_b16 a[92:93], v99 offset:9248
  ds_read_b64_tr_b16 a[94:95], v99 offset:9632
  ds_read_b64_tr_b16 a[112:113], v99 offset:9280
  ds_read_b64_tr_b16 a[114:115], v99 offset:9664
  ds_read_b64_tr_b16 a[76:77], v99 offset:12288
  ds_read_b64_tr_b16 a[78:79], v99 offset:12672
  ds_read_b64_tr_b16 a[96:97], v99 offset:12320
  ds_read_b64_tr_b16 a[98:99], v99 offset:12704
  ds_read_b64_tr_b16 a[116:117], v99 offset:12352
  ds_read_b64_tr_b16 a[118:119], v99 offset:12736
  s_waitcnt lgkmcnt(0)
  s_waitcnt vmcnt(36)
  ds_write_b128 v100, v[128:131] offset:0
  ds_write_b128 v100, v[132:135] offset:1024
  ds_write_b128 v100, v[136:139] offset:2048
  ds_write_b128 v100, v[140:143] offset:3072
  ds_write_b128 v100, v[144:147] offset:4096
  ds_write_b128 v100, v[148:151] offset:5120
  ds_write_b128 v100, v[152:155] offset:6144
  ds_write_b128 v100, v[156:159] offset:7168
  ds_write_b128 v100, v[160:163] offset:8192
  ds_write_b128 v100, v[164:167] offset:9216
  ds_write_b128 v100, v[168:171] offset:10240
  ds_write_b128 v100, v[172:175] offset:11264
  ds_write_b128 v100, v[176:179] offset:12288
  ds_write_b128 v100, v[180:183] offset:13312
  ds_write_b128 v100, v[184:187] offset:14336
  s_waitcnt lgkmcnt(0)
  ds_read_b64_tr_b16 a[120:121], v99 offset:0
  ds_read_b64_tr_b16 a[122:123], v99 offset:384
  ds_read_b64_tr_b16 a[140:141], v99 offset:32
  ds_read_b64_tr_b16 a[142:143], v99 offset:416
  ds_read_b64_tr_b16 a[160:161], v99 offset:64
  ds_read_b64_tr_b16 a[162:163], v99 offset:448
  ds_read_b64_tr_b16 a[124:125], v99 offset:3072
  ds_read_b64_tr_b16 a[126:127], v99 offset:3456
  ds_read_b64_tr_b16 a[144:145], v99 offset:3104
  ds_read_b64_tr_b16 a[146:147], v99 offset:3488
  ds_read_b64_tr_b16 a[164:165], v99 offset:3136
  ds_read_b64_tr_b16 a[166:167], v99 offset:3520
  ds_read_b64_tr_b16 a[128:129], v99 offset:6144
  ds_read_b64_tr_b16 a[130:131], v99 offset:6528
  ds_read_b64_tr_b16 a[148:149], v99 offset:6176
  ds_read_b64_tr_b16 a[150:151], v99 offset:6560
  ds_read_b64_tr_b16 a[168:169], v99 offset:6208
  ds_read_b64_tr_b16 a[170:171], v99 offset:6592
  ds_read_b64_tr_b16 a[132:133], v99 offset:9216
  ds_read_b64_tr_b16 a[134:135], v99 offset:9600
  ds_read_b64_tr_b16 a[152:153], v99 offset:9248
  ds_read_b64_tr_b16 a[154:155], v99 offset:9632
  ds_read_b64_tr_b16 a[172:173], v99 offset:9280
  ds_read_b64_tr_b16 a[174:175], v99 offset:9664
  ds_read_b64_tr_b16 a[136:137], v99 offset:12288
  ds_read_b64_tr_b16 a[138:139], v99 offset:12672
  ds_read_b64_tr_b16 a[156:157], v99 offset:12320
  ds_read_b64_tr_b16 a[158:159], v99 offset:12704
  ds_read_b64_tr_b16 a[176:177], v99 offset:12352
  ds_read_b64_tr_b16 a[178:179], v99 offset:12736
  s_waitcnt lgkmcnt(0)
  s_waitcnt vmcnt(27)
  s_cmp_lg_u32 s20, 0
  s_cbranch_scc1 ic_7
  buffer_load_dword v238, v239, s[32:35], 0 offen sc1
ic_7:
  ds_write_b128 v100, v[188:191] offset:0
  ds_write_b128 v100, v[192:195] offset:1024
  ds_write_b128 v100, v[196:199] offset:2048
  ds_write_b128 v100, v[200:203] offset:3072
  ds_write_b128 v100, v[204:207] offset:4096
  ds_write_b128 v100, v[208:211] offset:5120
  ds_write_b128 v100, v[212:215] offset:6144
  ds_write_b128 v100, v[216:219] offset:7168
  ds_write_b128 v100, v[220:223] offset:8192
  s_waitcnt lgkmcnt(0)
  ds_read_b64_tr_b16 a[192:193], v99 offset:0
  ds_read_b64_tr_b16 a[194:195], v99 offset:384
  ds_read_b64_tr_b16 a[216:217], v99 offset:32
  ds_read_b64_tr_b16 a[218:219], v99 offset:416
  ds_read_b64_tr_b16 a[240:241], v99 offset:64
  ds_read_b64_tr_b16 a[242:243], v99 offset:448
  ds_read_b64_tr_b16 a[196:197], v99 offset:3072
  ds_read_b64_tr_b16 a[198:199], v99 offset:3456
  ds_read_b64_tr_b16 a[220:221], v99 offset:3104
  ds_read_b64_tr_b16 a[222:223], v99 offset:3488
  ds_read_b64_tr_b16 a[244:245], v99 offset:3136
  ds_read_b64_tr_b16 a[246:247], v99 offset:3520
  ds_read_b64_tr_b16 a[200:201], v99 offset:6144
  ds_read_b64_tr_b16 a[202:203], v99 offset:6528
  ds_read_b64_tr_b16 a[224:225], v99 offset:6176
  ds_read_b64_tr_b16 a[226:227], v99 offset:6560
  ds_read_b64_tr_b16 a[248:249], v99 offset:6208
  ds_read_b64_tr_b16 a[250:251], v99 offset:6592
  s_waitcnt lgkmcnt(0)
  s_waitcnt vmcnt(18)
  ds_read_b64_tr_b16 a[180:181], v99 offset:30720
  ds_read_b64_tr_b16 a[182:183], v99 offset:31104
  ds_read_b64_tr_b16 a[204:205], v99 offset:30752
  ds_read_b64_tr_b16 a[206:207], v99 offset:31136
  ds_read_b64_tr_b16 a[228:229], v99 offset:30784
  ds_read_b64_tr_b16 a[230:231], v99 offset:31168
  ds_read_b64_tr_b16 a[184:185], v99 offset:33792
  ds_read_b64_tr_b16 a[186:187], v99 offset:34176
  ds_read_b64_tr_b16 a[208:209], v99 offset:33824
  ds_read_b64_tr_b16 a[210:211], v99 offset:34208
  ds_read_b64_tr_b16 a[232:233], v99 offset:33856
  ds_read_b64_tr_b16 a[234:235], v99 offset:34240
  ds_read_b64_tr_b16 a[188:189], v99 offset:36864
  ds_read_b64_tr_b16 a[190:191], v99 offset:37248
  ds_read_b64_tr_b16 a[212:213], v99 offset:36896
  ds_read_b64_tr_b16 a[214:215], v99 offset:37280
  ds_read_b64_tr_b16 a[236:237], v99 offset:36928
  ds_read_b64_tr_b16 a[238:239], v99 offset:37312
  s_waitcnt lgkmcnt(0)
  s_waitcnt vmcnt(3)
  ds_read_b64_tr_b16 a[0:1], v99 offset:15360
  ds_read_b64_tr_b16 a[2:3], v99 offset:15744
  ds_read_b64_tr_b16 a[20:21], v99 offset:15392
  ds_read_b64_tr_b16 a[22:23], v99 offset:15776
  ds_read_b64_tr_b16 a[40:41], v99 offset:15424
  ds_read_b64_tr_b16 a[42:43], v99 offset:15808
  ds_read_b64_tr_b16 a[4:5], v99 offset:18432
  ds_read_b64_tr_b16 a[6:7], v99 offset:18816
  ds_read_b64_tr_b16 a[24:25], v99 offset:18464
  ds_read_b64_tr_b16 a[26:27], v99 offset:18848
  ds_read_b64_tr_b16 a[44:45], v99 offset:18496
  ds_read_b64_tr_b16 a[46:47], v99 offset:18880
  ds_read_b64_tr_b16 a[8:9], v99 offset:21504
  ds_read_b64_tr_b16 a[10:11], v99 offset:21888
  ds_read_b64_tr_b16 a[28:29], v99 offset:21536
  ds_read_b64_tr_b16 a[30:31], v99 offset:21920
  ds_read_b64_tr_b16 a[48:49], v99 offset:21568
  ds_read_b64_tr_b16 a[50:51], v99 offset:21952
  ds_read_b64_tr_b16 a[12:13], v99 offset:24576
  ds_read_b64_tr_b16 a[14:15], v99 offset:24960
  ds_read_b64_tr_b16 a[32:33], v99 offset:24608
  ds_read_b64_tr_b16 a[34:35], v99 offset:24992
  ds_read_b64_tr_b16 a[52:53], v99 offset:24640
  ds_read_b64_tr_b16 a[54:55], v99 offset:25024
  ds_read_b64_tr_b16 a[16:17], v99 offset:27648
  ds_read_b64_tr_b16 a[18:19], v99 offset:28032
  ds_read_b64_tr_b16 a[36:37], v99 offset:27680
  ds_read_b64_tr_b16 a[38:39], v99 offset:28064
  ds_read_b64_tr_b16 a[56:57], v99 offset:27712
  ds_read_b64_tr_b16 a[58:59], v99 offset:28096
  s_waitcnt lgkmcnt(0)
  v_mov_b32 v174, 0
  v_mov_b32 v175, 0
  v_mov_b32 v218, 0
  v_mov_b32 v219, 0
  v_mov_b32 v234, 0
  v_mov_b32 v235, 0
  v_mov_b32 v220, 0
  v_mov_b32 v221, 0
  v_mov_b32 v222, 0
  v_mov_b32 v223, 0
  v_mov_b32 v224, 0
  v_mov_b32 v225, 0
  v_mov_b32 v226, 0
  v_mov_b32 v227, 0
  s_waitcnt vmcnt(0)
  s_barrier
  s_add_u32 s12, s44, 81068032
  s_addc_u32 s13, s45, 0
  s_mov_b32 s14, 117760
  s_mov_b32 s15, 0x00020000
  s_add_u32 s28, s44, 114294784
  s_addc_u32 s29, s45, 0
  s_mov_b32 s30, 83886080
  s_mov_b32 s31, 0x00020000
  s_mul_i32 s64, s59, 40960
  s_lshl_b32 s21, s87, 10
  s_add_u32 s64, s64, s21
  s_add_u32 s64, s64, 1310720
  s_lshl_b32 s79, s59, 7
  s_and_b32 s21, s51, 12
  s_add_u32 s79, s79, s21
  s_add_u32 s79, s79, 96256
  v_mov_b32 v94, 0
  v_mov_b32 v95, 0
  s_lshl_b32 s90, s58, 7
  s_lshl_b32 s21, s56, 3
  s_add_u32 s90, s90, s21
  s_add_u32 s90, s90, 20480
  s_cmp_eq_u32 s56, 0
  s_cselect_b32 s65, s90, 0x80000000
  s_mov_b32 s69, 0
  v_lshlrev_b32 v88, 3, v1
  s_cmp_lg_u32 s20, 0
  s_cbranch_scc1 fm_9
  s_bfe_u32 s82, s50, 0x10001
  s_lshl_b32 s82, s82, 5
  s_lshr_b32 s21, s50, 2
  s_add_u32 s82, s82, s21
  s_and_b32 s80, s50, 1
  s_lshl_b32 s80, s80, 4
  s_add_u32 s80, s80, 16
  s_mov_b32 s101, 0
  s_branch fm_10
fm_8:
  s_sleep 8
  buffer_load_dword v238, v239, s[32:35], 0 offen sc1
  s_add_u32 s101, s101, 1
  s_cmp_gt_u32 s101, 131072
  s_cbranch_scc1 end0
  s_waitcnt vmcnt(0)
fm_10:
  v_readlane_b32 s22, v238, 0
  v_readlane_b32 s23, v238, 32
  s_add_u32 s22, s22, s23
  v_readlane_b32 s23, v238, 1
  s_add_u32 s22, s22, s23
  v_readlane_b32 s23, v238, 33
  s_add_u32 s22, s22, s23
  v_readlane_b32 s23, v238, 2
  s_add_u32 s22, s22, s23
  v_readlane_b32 s23, v238, 34
  s_add_u32 s22, s22, s23
  v_readlane_b32 s23, v238, 3
  s_add_u32 s22, s22, s23
  v_readlane_b32 s23, v238, 35
  s_add_u32 s22, s22, s23
  v_readlane_b32 s21, v238, 19
  v_readlane_b32 s23, v238, 21
  s_cmp_ge_u32 s22, 256
  s_cselect_b32 s23, s23, 0
  s_cmp_ge_u32 s21, 32
  s_cselect_b32 s23, s23, 0
  s_cmp_eq_u32 s23, 0
  s_cbranch_scc1 fm_8
  v_readlane_b32 s21, v238, s82
  s_cmp_ge_u32 s21, s80
  s_cselect_b32 s81, 1, 0
  s_andn2_b32 s53, s81, s53
  v_mov_b32 v244, s23
  v_mov_b32 v245, s53
  v_mov_b32 v236, 0
  ds_write_b64 v236, v[244:245]
  s_waitcnt lgkmcnt(0)
fm_9:
  s_barrier
  v_mov_b32 v236, 0
  ds_read_b64 v[244:245], v236
  s_mov_b32 s21, 0
  buffer_load_dwordx2 v[96:97], v9, s[8:11], s21 offen sc1
  buffer_load_dwordx4 v[96:99], v8, s[8:11], s21 offen offset:0 sc1
  buffer_load_dwordx4 v[96:99], v8, s[8:11], s21 offen offset:1024 sc1
  buffer_load_dwordx4 v[96:99], v10, s[8:11], s21 offen offset:0 sc1
  buffer_load_dwordx4 v[96:99], v10, s[8:11], s21 offen offset:1024 sc1
  buffer_load_dwordx4 v[96:99], v10, s[8:11], s21 offen offset:2048 sc1
  s_mov_b32 s21, 540672
  buffer_load_dwordx2 v[96:97], v9, s[8:11], s21 offen sc1
  buffer_load_dwordx4 v[96:99], v8, s[8:11], s21 offen offset:0 sc1
  buffer_load_dwordx4 v[96:99], v8, s[8:11], s21 offen offset:1024 sc1
  buffer_load_dwordx4 v[96:99], v10, s[8:11], s21 offen offset:0 sc1
  buffer_load_dwordx4 v[96:99], v10, s[8:11], s21 offen offset:1024 sc1
  buffer_load_dwordx4 v[96:99], v10, s[8:11], s21 offen offset:2048 sc1
  s_mov_b32 s21, 1081344
  buffer_load_dwordx2 v[96:97], v9, s[8:11], s21 offen sc1
  buffer_load_dwordx4 v[96:99], v8, s[8:11], s21 offen offset:0 sc1
  buffer_load_dwordx4 v[96:99], v8, s[8:11], s21 offen offset:1024 sc1
  buffer_load_dwordx4 v[96:99], v10, s[8:11], s21 offen offset:0 sc1
  buffer_load_dwordx4 v[96:99], v10, s[8:11], s21 offen offset:1024 sc1
  buffer_load_dwordx4 v[96:99], v10, s[8:11], s21 offen offset:2048 sc1
  s_mov_b32 s21, 1622016
  buffer_load_dwordx2 v[96:97], v9, s[8:11], s21 offen sc1
  buffer_load_dwordx4 v[96:99], v8, s[8:11], s21 offen offset:0 sc1
  buffer_load_dwordx4 v[96:99], v8, s[8:11], s21 offen offset:1024 sc1
  buffer_load_dwordx4 v[96:99], v10, s[8:11], s21 offen offset:0 sc1
  buffer_load_dwordx4 v[96:99], v10, s[8:11], s21 offen offset:1024 sc1
  buffer_load_dwordx4 v[96:99], v10, s[8:11], s21 offen offset:2048 sc1
  s_waitcnt lgkmcnt(0)
  v_readfirstlane_b32 s53, v245
  v_add_u32 v237, -1, v244
  v_lshlrev_b32 v237, 13, v237
  v_xor_b32 v237, 0, v237
  v_add_u32 v13, v13, v237
  v_add_u32 v4, v4, v237
  s_lshl_b32 s21, s50, 7
  s_add_u32 s21, s21, 0
  s_cmp_lg_u32 s20, 0
  s_cbranch_scc1 wf_12
  v_mov_b32 v240, 0
  s_mov_b32 s101, 0
wf_11:
  buffer_load_dword v241, v240, s[12:15], s21 offen sc1
  s_add_u32 s101, s101, 1
  s_cmp_gt_u32 s101, 131072
  s_cbranch_scc1 end0
  s_waitcnt vmcnt(0)
  v_readfirstlane_b32 s100, v241
  s_cmp_ge_u32 s100, 8
  s_cbranch_scc1 wf_12
  s_sleep 6
  s_branch wf_11
wf_12:
  s_barrier
  s_cmp_ge_u32 s20, 2
  s_cbranch_scc1 pf_13
  buffer_load_dwordx4 v[168:171], v18, s[16:19], 0 offen sc1
  buffer_load_dwordx2 v[172:173], v20, s[16:19], 0 offen sc1
pf_13:
  v_add_u32 v242, 1088, v5
  v_add_u32 v243, 2176, v5
  v_add_u32 v244, 3264, v5
  v_add_u32 v245, 4352, v5
  s_mov_b32 s52, 0
  s_mov_b32 s47, 0
  v_mov_b32 v52, 0
  v_mov_b32 v53, 0
  v_mov_b32 v54, 0
  v_mov_b32 v55, 0
  v_mov_b32 v56, 0
  v_mov_b32 v57, 0
  v_mov_b32 v58, 0
  v_mov_b32 v59, 0
  v_mov_b32 v60, 0
  v_mov_b32 v61, 0
  v_mov_b32 v62, 0
  v_mov_b32 v63, 0
  v_mov_b32 v64, 0
  v_mov_b32 v65, 0
  v_mov_b32 v66, 0
  v_mov_b32 v67, 0
  v_mov_b32 v68, 0
  v_mov_b32 v69, 0
  v_mov_b32 v70, 0
  v_mov_b32 v71, 0
  v_mov_b32 v72, 0
  v_mov_b32 v73, 0
  v_mov_b32 v74, 0
  v_mov_b32 v75, 0
  v_mov_b32 v76, 0
  v_mov_b32 v77, 0
  v_mov_b32 v78, 0
  v_mov_b32 v79, 0
  v_mov_b32 v80, 0
  v_mov_b32 v81, 0
  v_mov_b32 v82, 0
  v_mov_b32 v83, 0
  v_mov_b32 v84, 0
  v_mov_b32 v85, 0
  v_mov_b32 v86, 0
  v_mov_b32 v87, 0
  v_mov_b32 v156, 0
  v_mov_b32 v157, 0
  v_mov_b32 v158, 0
  v_mov_b32 v159, 0
  s_and_b32 s21, s52, 3
  s_mul_i32 s81, s21, 540672
  s_lshl_b32 s84, s21, 15
  s_add_u32 s21, s52, 2
  s_and_b32 s21, s21, 3
  s_mul_i32 s82, s21, 540672
  s_add_u32 s21, s52, 3
  s_and_b32 s21, s21, 3
  s_lshl_b32 s83, s21, 15
  s_add_u32 s21, s52, 1
  s_and_b32 s22, s21, 3
  s_lshl_b32 s3, s22, 15
  s_mul_i32 s80, s21, 393216
  s_add_u32 s46, s21, 1
  s_min_u32 s46, s46, 64
  s_mul_i32 s85, s52, 98304
  s_mul_i32 s57, s52, 327680
  s_add_u32 s57, s57, 42991616

  s_bfe_u32 s88, s52, 0x10002
  s_add_u32 s78, s81, 278528
  s_max_u32 s21, s52, 1
  s_sub_u32 s21, s21, 1
  s_cmp_lt_u32 s52, 60
  s_cselect_b32 s66, s65, 0x80000000
  s_cselect_b32 s68, 15, 1
  s_cmp_ge_u32 s52, 61
  s_cselect_b32 s66, s90, s66
  s_cselect_b32 s67, s52, s21
  s_cmp_eq_u32 s53, 0
  s_cbranch_scc1 A1_18
  s_cmp_eq_u32 s20, 0
  s_cbranch_scc1 A1_14
  s_cmp_eq_u32 s20, 1
  s_cbranch_scc1 A1_15
  s_cmp_eq_u32 s20, 2
  s_cbranch_scc1 A1_16
  s_cmp_eq_u32 s20, 3
  s_cbranch_scc1 A1_17
  s_branch A1_18
step_19:
  s_add_u32 s21, s52, 2
  s_and_b32 s21, s21, 3
  s_mul_i32 s82, s21, 540672
  s_add_u32 s21, s52, 3
  s_and_b32 s21, s21, 3
  s_lshl_b32 s83, s21, 15
  s_add_u32 s21, s52, 1
  s_and_b32 s22, s21, 3
  s_lshl_b32 s3, s22, 15
  s_mul_i32 s80, s21, 393216
  s_add_u32 s46, s21, 1
  s_min_u32 s46, s46, 64
  s_mul_i32 s85, s52, 98304
  s_mul_i32 s57, s52, 327680
  s_add_u32 s57, s57, 42991616

  s_bfe_u32 s88, s52, 0x10002
  s_add_u32 s78, s81, 278528
  s_max_u32 s21, s52, 1
  s_sub_u32 s21, s21, 1
  s_cmp_lt_u32 s52, 60
  s_cselect_b32 s66, s65, 0x80000000
  s_cselect_b32 s68, 15, 1
  s_cmp_ge_u32 s52, 61
  s_cselect_b32 s66, s90, s66
  s_cselect_b32 s67, s52, s21
  v_mov_b32 v52, 0
  v_mov_b32 v53, 0
  v_mov_b32 v54, 0
  v_mov_b32 v55, 0
  v_mov_b32 v56, 0
  v_mov_b32 v57, 0
  v_mov_b32 v58, 0
  v_mov_b32 v59, 0
  v_mov_b32 v60, 0
  v_mov_b32 v61, 0
  v_mov_b32 v62, 0
  v_mov_b32 v63, 0
  v_mov_b32 v64, 0
  v_mov_b32 v65, 0
  v_mov_b32 v66, 0
  v_mov_b32 v67, 0
  v_mov_b32 v68, 0
  v_mov_b32 v69, 0
  v_mov_b32 v70, 0
  v_mov_b32 v71, 0
  v_mov_b32 v72, 0
  v_mov_b32 v73, 0
  v_mov_b32 v74, 0
  v_mov_b32 v75, 0
  v_mov_b32 v76, 0
  v_mov_b32 v77, 0
  v_mov_b32 v78, 0
  v_mov_b32 v79, 0
  v_mov_b32 v80, 0
  v_mov_b32 v81, 0
  v_mov_b32 v82, 0
  v_mov_b32 v83, 0
  v_mov_b32 v84, 0
  v_mov_b32 v85, 0
  v_mov_b32 v86, 0
  v_mov_b32 v87, 0
  s_sleep 5
  s_mov_b32 s54, 0
  buffer_load_dwordx4 v[96:99], v4, s[4:7], s84 offen offset:0 sc1
  buffer_load_dwordx4 v[100:103], v4, s[4:7], s84 offen offset:1024 sc1
  buffer_load_dwordx4 v[104:107], v4, s[4:7], s84 offen offset:2048 sc1
  s_waitcnt vmcnt(3)
  v_mov_b32 v176, v160
  v_mov_b32 v177, v161
  v_mov_b32 v178, v162
  v_mov_b32 v179, v163
  v_mov_b32 v180, v164
  v_mov_b32 v181, v165
  v_mov_b32 v182, v166
  v_mov_b32 v183, v167
  v_mov_b32 v184, v48
  v_mov_b32 v185, v49
  v_mov_b32 v186, v50
  v_mov_b32 v187, v51
  s_waitcnt vmcnt(0)
  v_bitop3_b32 v27, v99, v103, v107 bitop3:0x80
  v_cvt_f32_f16 v108, v99
  v_and_b32 v27, 0x48000000, v27
  v_cvt_f32_f16 v109, v103
  v_cmp_ne_u32 vcc, 0x48000000, v27
  v_cvt_f32_f16 v110, v106
  v_cvt_f32_f16_sdwa v111, v106 dst_sel:DWORD dst_unused:UNUSED_PAD src0_sel:WORD_1
  v_cvt_pk_bf16_f32 v40, v110, v111
  s_cbranch_vccnz pm_21
pm_22:
  v_cvt_pk_bf16_f32 v41, v108, v109
  v_cvt_f32_f16 v110, v96
  v_cvt_f32_f16_sdwa v111, v96 dst_sel:DWORD dst_unused:UNUSED_PAD src0_sel:WORD_1
  v_smfmac_f32_16x16x32_bf16 v[52:55], v[40:41], a[16:19], v44
  v_cvt_f32_f16 v112, v97
  v_cvt_f32_f16_sdwa v113, v97 dst_sel:DWORD dst_unused:UNUSED_PAD src0_sel:WORD_1
  v_cvt_pk_bf16_f32 v32, v110, v111
  v_smfmac_f32_16x16x32_bf16 v[64:67], v[40:41], a[76:79], v44
  v_cvt_pk_bf16_f32 v33, v112, v113
  v_cvt_f32_f16 v114, v98
  v_cvt_f32_f16_sdwa v115, v98 dst_sel:DWORD dst_unused:UNUSED_PAD src0_sel:WORD_1
  v_smfmac_f32_16x16x32_bf16 v[56:59], v[40:41], a[36:39], v44
  v_cvt_f32_f16 v116, v100
  v_cvt_f32_f16_sdwa v117, v100 dst_sel:DWORD dst_unused:UNUSED_PAD src0_sel:WORD_1
  v_cvt_pk_bf16_f32 v34, v114, v115
  v_smfmac_f32_16x16x32_bf16 v[68:71], v[40:41], a[96:99], v44
  v_cvt_pk_bf16_f32 v35, v116, v117
  v_cvt_f32_f16 v110, v101
  v_cvt_f32_f16_sdwa v111, v101 dst_sel:DWORD dst_unused:UNUSED_PAD src0_sel:WORD_1
  v_smfmac_f32_16x16x32_bf16 v[60:63], v[40:41], a[56:59], v44
  v_cvt_f32_f16 v112, v102
  v_cvt_f32_f16_sdwa v113, v102 dst_sel:DWORD dst_unused:UNUSED_PAD src0_sel:WORD_1
  v_smfmac_f32_16x16x32_bf16 v[72:75], v[40:41], a[116:119], v44
  v_cvt_pk_bf16_f32 v36, v110, v111
  v_cvt_pk_bf16_f32 v37, v112, v113
  v_smfmac_f32_16x16x32_bf16 v[76:79], v[40:41], a[136:139], v44
  v_cvt_f32_f16 v114, v104
  v_cvt_f32_f16_sdwa v115, v104 dst_sel:DWORD dst_unused:UNUSED_PAD src0_sel:WORD_1
  v_smfmac_f32_16x16x32_bf16 v[80:83], v[40:41], a[156:159], v44
  v_cvt_f32_f16 v116, v105
  v_cvt_f32_f16_sdwa v117, v105 dst_sel:DWORD dst_unused:UNUSED_PAD src0_sel:WORD_1
  v_smfmac_f32_16x16x32_bf16 v[84:87], v[40:41], a[176:179], v44
  v_cvt_pk_bf16_f32 v38, v114, v115
  v_cvt_pk_bf16_f32 v39, v116, v117
A2_23:
  v_smfmac_f32_16x16x64_bf16 v[52:55], v[32:35], a[0:7], v44
  v_smfmac_f32_16x16x64_bf16 v[52:55], v[36:39], a[8:15], v44
  v_smfmac_f32_16x16x64_bf16 v[64:67], v[32:35], a[60:67], v44
  v_smfmac_f32_16x16x64_bf16 v[64:67], v[36:39], a[68:75], v44
  v_smfmac_f32_16x16x64_bf16 v[56:59], v[32:35], a[20:27], v44
  v_smfmac_f32_16x16x64_bf16 v[56:59], v[36:39], a[28:35], v44
  v_smfmac_f32_16x16x64_bf16 v[68:71], v[32:35], a[80:87], v44
  v_permlane32_swap_b32 v52, v64
  v_permlane32_swap_b32 v53, v65
  v_permlane32_swap_b32 v54, v66
  v_smfmac_f32_16x16x64_bf16 v[68:71], v[36:39], a[88:95], v44
  v_permlane32_swap_b32 v55, v67
  v_pk_add_f32 v[52:53], v[52:53], v[64:65]
  v_pk_add_f32 v[54:55], v[54:55], v[66:67]
  v_smfmac_f32_16x16x64_bf16 v[60:63], v[32:35], a[40:47], v44
  ds_write2_b32 v5, v52, v53 offset0:0 offset1:4
  ds_write2_b32 v5, v54, v55 offset0:8 offset1:12
  v_smfmac_f32_16x16x64_bf16 v[60:63], v[36:39], a[48:55], v44
  v_smfmac_f32_16x16x64_bf16 v[72:75], v[32:35], a[100:107], v44
  v_permlane32_swap_b32 v56, v68
  v_permlane32_swap_b32 v57, v69
  v_permlane32_swap_b32 v58, v70
  v_smfmac_f32_16x16x64_bf16 v[72:75], v[36:39], a[108:115], v44
  v_permlane32_swap_b32 v59, v71
  v_pk_add_f32 v[56:57], v[56:57], v[68:69]
  v_pk_add_f32 v[58:59], v[58:59], v[70:71]
  v_smfmac_f32_16x16x64_bf16 v[76:79], v[32:35], a[120:127], v44
  ds_write2_b32 v242, v56, v57 offset0:0 offset1:4
  ds_write2_b32 v242, v58, v59 offset0:8 offset1:12
  v_smfmac_f32_16x16x64_bf16 v[76:79], v[36:39], a[128:135], v44
  v_smfmac_f32_16x16x64_bf16 v[80:83], v[32:35], a[140:147], v44
  v_permlane32_swap_b32 v60, v72
  v_permlane32_swap_b32 v61, v73
  v_permlane32_swap_b32 v62, v74
  v_smfmac_f32_16x16x64_bf16 v[80:83], v[36:39], a[148:155], v44
  v_permlane32_swap_b32 v63, v75
  v_pk_add_f32 v[60:61], v[60:61], v[72:73]
  v_pk_add_f32 v[62:63], v[62:63], v[74:75]
  v_smfmac_f32_16x16x64_bf16 v[84:87], v[32:35], a[160:167], v44
  ds_write2_b32 v243, v60, v61 offset0:0 offset1:4
  ds_write2_b32 v243, v62, v63 offset0:8 offset1:12
  v_smfmac_f32_16x16x64_bf16 v[84:87], v[36:39], a[168:175], v44
  v_permlane32_swap_b32 v76, v80
  v_permlane32_swap_b32 v77, v81
  v_permlane32_swap_b32 v78, v82
  v_permlane32_swap_b32 v79, v83
  v_pk_add_f32 v[76:77], v[76:77], v[80:81]
  v_pk_add_f32 v[78:79], v[78:79], v[82:83]
  ds_write2_b32 v244, v76, v77 offset0:0 offset1:4
  ds_write2_b32 v244, v78, v79 offset0:8 offset1:12
  ds_write2_b32 v245, v84, v85 offset0:0 offset1:4
  ds_write2_b32 v245, v86, v87 offset0:8 offset1:12
  s_waitcnt lgkmcnt(0) vmcnt(0)
  s_barrier
  ds_read_b128 v[96:99], v45 offset:0
  ds_read_b128 v[108:111], v45 offset:5440
  ds_read_b128 v[100:103], v45 offset:1088
  ds_read_b128 v[112:115], v45 offset:6528
  ds_read_b128 v[104:107], v45 offset:2176
  ds_read_b128 v[116:119], v45 offset:7616
  s_waitcnt lgkmcnt(4)
  v_pk_add_f32 v[96:97], v[96:97], v[108:109]
  v_pk_add_f32 v[98:99], v[98:99], v[110:111]
  s_nop 0
  v_add_f32_dpp v108, v96, v96 row_ror:8 row_mask:0xf bank_mask:0xf
  v_add_f32_dpp v109, v97, v97 row_ror:8 row_mask:0xf bank_mask:0xf
  v_add_f32_dpp v110, v98, v98 row_ror:8 row_mask:0xf bank_mask:0xf
  v_add_f32_dpp v111, v99, v99 row_ror:8 row_mask:0xf bank_mask:0xf
  v_cvt_pk_bf16_f32 v212, v108, v109
  v_cvt_pk_bf16_f32 v213, v110, v111
  s_waitcnt lgkmcnt(2)
  v_pk_add_f32 v[100:101], v[100:101], v[112:113]
  v_pk_add_f32 v[102:103], v[102:103], v[114:115]
  s_nop 0
  v_add_f32_dpp v112, v100, v100 row_ror:8 row_mask:0xf bank_mask:0xf
  v_add_f32_dpp v113, v101, v101 row_ror:8 row_mask:0xf bank_mask:0xf
  v_add_f32_dpp v114, v102, v102 row_ror:8 row_mask:0xf bank_mask:0xf
  v_add_f32_dpp v115, v103, v103 row_ror:8 row_mask:0xf bank_mask:0xf
  v_cvt_pk_bf16_f32 v214, v112, v113
  v_cvt_pk_bf16_f32 v215, v114, v115
  s_waitcnt lgkmcnt(0)
  v_pk_add_f32 v[104:105], v[104:105], v[116:117]
  v_pk_add_f32 v[106:107], v[106:107], v[118:119]
  v_mfma_f32_16x16x32_bf16 v[96:99], v[168:171], v[212:215], 0
  v_add_f32_dpp v116, v104, v104 row_ror:8 row_mask:0xf bank_mask:0xf
  v_add_f32_dpp v117, v105, v105 row_ror:8 row_mask:0xf bank_mask:0xf
  v_add_f32_dpp v118, v106, v106 row_ror:8 row_mask:0xf bank_mask:0xf
  v_add_f32_dpp v119, v107, v107 row_ror:8 row_mask:0xf bank_mask:0xf
  v_cvt_pk_bf16_f32 v216, v116, v117
  v_cvt_pk_bf16_f32 v217, v118, v119
  s_nop 1
  v_mfma_f32_16x16x32_bf16 v[96:99], v[172:175], v[216:219], v[96:99]
  s_mov_b64 exec, s[74:75]
  s_nop 6
  v_cvt_pk_f16_f32 v100, v96, v97
  v_cvt_pk_f16_f32 v101, v98, v99
  v_and_or_b32 v100, v100, -2, s88
  buffer_store_dwordx2 v[100:101], v7, s[8:11], s81 offen
  s_mov_b64 exec, -1
  s_cmp_eq_u32 s52, 63
  s_cbranch_scc1 last_20
  s_sleep 5
  s_mov_b32 s54, 0
  buffer_load_dwordx2 v[248:249], v9, s[8:11], s81 offen sc1
  buffer_load_dwordx4 v[112:115], v8, s[8:11], s81 offen offset:0 sc1
  buffer_load_dwordx4 v[116:119], v8, s[8:11], s81 offen offset:1024 sc1
  s_sleep 2
  buffer_load_dwordx4 v[144:147], v10, s[8:11], s81 offen offset:0 sc1
  buffer_load_dwordx4 v[148:151], v10, s[8:11], s81 offen offset:1024 sc1
  buffer_load_dwordx4 v[152:155], v10, s[8:11], s81 offen offset:2048 sc1
  v_mov_b32 v188, 0
  v_mov_b32 v189, 0
  v_mov_b32 v190, 0
  v_mov_b32 v191, 0
  v_mov_b32 v192, 0
  v_mov_b32 v193, 0
  v_mov_b32 v194, 0
  v_mov_b32 v195, 0
  v_mov_b32 v196, 0
  v_mov_b32 v197, 0
  v_mov_b32 v198, 0
  v_mov_b32 v199, 0
  v_readfirstlane_b32 s21, v94
  s_add_u32 s22, s46, 2
  s_min_u32 s22, s22, 64
  s_sub_u32 s55, s21, s22
  s_sub_u32 s56, s21, s46
  s_waitcnt vmcnt(5)
  v_xor_b32 v96, s88, v248
  s_nop 0
  v_permlane16_swap_b32 v248, v249
  v_fma_mix_f32 v250, v248, 1.0, v249 op_sel:[0,0,0] op_sel_hi:[1,0,1]
  v_fma_mix_f32 v251, v248, 1.0, v249 op_sel:[1,0,1] op_sel_hi:[1,0,1]
  v_mov_b32 v248, v250
  v_mov_b32 v249, v251
  s_nop 0
  v_permlane32_swap_b32 v248, v250
  v_permlane32_swap_b32 v249, v251
  s_waitcnt vmcnt(3)
  v_bitop3_b32 v97, v112, v114, s88 bitop3:0x7e
  v_bitop3_b32 v98, v116, v118, s88 bitop3:0x7e
  v_fma_mix_f32 v120, v112, 1.0, v116 op_sel:[0,0,0] op_sel_hi:[1,0,1]
  v_or3_b32 v27, v96, v97, v98
  v_fma_mix_f32 v124, v114, 1.0, v118 op_sel:[0,0,0] op_sel_hi:[1,0,1]
  v_and_b32 v27, 1, v27
  v_fma_mix_f32 v121, v112, 1.0, v116 op_sel:[1,0,1] op_sel_hi:[1,0,1]
  v_cmp_ne_u32 vcc, 0, v27
  v_fma_mix_f32 v125, v114, 1.0, v118 op_sel:[1,0,1] op_sel_hi:[1,0,1]
  v_fma_mix_f32 v122, v113, 1.0, v117 op_sel:[0,0,0] op_sel_hi:[1,0,1]
  v_fma_mix_f32 v126, v115, 1.0, v119 op_sel:[0,0,0] op_sel_hi:[1,0,1]
  s_cbranch_vccnz psr_25
psj_26:
  s_cmp_lt_i32 s56, 0
  s_cbranch_scc1 kvw_28
kvok_29:
  v_fma_mix_f32 v123, v113, 1.0, v117 op_sel:[1,0,1] op_sel_hi:[1,0,1]
  v_fma_mix_f32 v127, v115, 1.0, v119 op_sel:[1,0,1] op_sel_hi:[1,0,1]
  v_permlane32_swap_b32 v120, v124
  v_permlane32_swap_b32 v121, v125
  v_permlane32_swap_b32 v122, v126
  v_permlane32_swap_b32 v123, v127
  v_pk_add_f32 v[120:121], v[120:121], v[124:125]
  v_pk_add_f32 v[122:123], v[122:123], v[126:127]
  v_pk_add_f32 v[124:125], v[248:249], v[250:251]
  v_max3_f32 v236, v120, v121, v122
  v_max3_f32 v237, v123, v124, v125
  v_max_f32 v236, v236, v237
  s_nop 1
  v_max_f32_dpp v236, v236, v236 row_ror:8 row_mask:0xf bank_mask:0xf
  v_mov_b32 v237, v236
  s_nop 1
  v_permlane32_swap_b32 v236, v237
  v_max_f32 v236, v236, v237
  v_mov_b32 v237, v236
  s_nop 1
  v_permlane16_swap_b32 v236, v237
  v_max_f32 v236, v236, v237
  s_waitcnt vmcnt(0)
  v_max3_u32 v27, v144, v146, v148
  v_max3_u32 v27, v27, v150, v152
  v_max3_u32 v27, v27, v154, v154
  v_cmp_eq_u32 vcc, -1, v27
  s_nop 1
  s_cbranch_vccnz pv_24
pvj_27:
  v_mul_f32 v236, s86, v236
  v_smfmac_f32_16x16x64_bf16 v[188:191], v[144:147], a[180:187], v44
  v_fma_f32 v120, v120, s86, -v236
  v_smfmac_f32_16x16x64_bf16 v[188:191], v[148:151], a[188:195], v44
  v_fma_f32 v121, v121, s86, -v236
  v_smfmac_f32_16x16x64_bf16 v[188:191], v[152:155], a[196:203], v44
  buffer_load_dwordx4 v[160:163], v17, s[28:31], s64 offen offset:0 sc1
  v_fma_f32 v122, v122, s86, -v236
  v_smfmac_f32_16x16x64_bf16 v[192:195], v[144:147], a[204:211], v44
  v_fma_f32 v123, v123, s86, -v236
  v_smfmac_f32_16x16x64_bf16 v[192:195], v[148:151], a[212:219], v44
  buffer_load_dwordx4 v[164:167], v16, s[28:31], s64 offen offset:1024 sc1
  v_fma_f32 v124, v124, s86, -v236
  v_smfmac_f32_16x16x64_bf16 v[192:195], v[152:155], a[220:227], v44
  v_fma_f32 v125, v125, s86, -v236
  v_smfmac_f32_16x16x64_bf16 v[196:199], v[144:147], a[228:235], v44
  buffer_load_dwordx4 v[48:51], v26, s[28:31], s64 offen offset:2048 sc1
  v_exp_f32 v120, v120
  v_smfmac_f32_16x16x64_bf16 v[196:199], v[148:151], a[236:243], v44
  v_exp_f32 v121, v121
  v_smfmac_f32_16x16x64_bf16 v[196:199], v[152:155], a[244:251], v44
  buffer_load_dwordx4 v[168:171], v18, s[16:19], s80 offen sc1
  v_exp_f32 v122, v122
  buffer_load_dwordx2 v[172:173], v20, s[16:19], s80 offen sc1
  v_exp_f32 v123, v123
  v_exp_f32 v124, v124
  s_cmp_lt_i32 s55, 0
  s_cbranch_scc1 fl_30
fl_31:
  v_exp_f32 v125, v125
  s_mov_b64 exec, s[60:61]
  v_cvt_pk_bf16_f32 v220, v120, v121
  v_cvt_pk_bf16_f32 v221, v122, v123
  v_cvt_pk_bf16_f32 v224, v124, v125
  s_mov_b64 exec, s[62:63]
  v_cvt_pk_bf16_f32 v222, v120, v121
  v_cvt_pk_bf16_f32 v223, v122, v123
  v_cvt_pk_bf16_f32 v225, v124, v125
  s_mov_b64 exec, -1
  v_pk_add_f32 v[126:127], v[120:121], v[122:123]
  v_add_f32 v128, v124, v125
  v_mfma_f32_16x16x32_bf16 v[200:203], v[176:179], v[220:223], 0
  v_add_f32 v236, v126, v127
  v_fmac_f32 v236, v128, v89
  v_cvt_pk_bf16_f32 v228, v188, v189
  v_cvt_pk_bf16_f32 v229, v190, v191
  v_mfma_f32_16x16x32_bf16 v[204:207], v[180:183], v[220:223], 0
  v_cvt_pk_bf16_f32 v230, v192, v193
  v_cvt_pk_bf16_f32 v231, v194, v195
  v_mfma_f32_16x16x32_bf16 v[208:211], v[184:187], v[220:223], 0
  v_cvt_pk_bf16_f32 v232, v196, v197
  v_cvt_pk_bf16_f32 v233, v198, v199
  v_add_f32_dpp v236, v236, v236 row_ror:8 row_mask:0xf bank_mask:0xf
  v_mov_b32 v237, v236
  s_nop 0
  v_mfma_f32_16x16x32_bf16 v[200:203], v[228:231], v[224:227], v[200:203]
  v_mfma_f32_16x16x32_bf16 v[204:207], v[230:233], v[224:227], v[204:207]
  v_permlane32_swap_b32 v236, v237
  v_add_f32 v236, v236, v237
  v_mov_b32 v237, v236
  v_mfma_f32_16x16x32_bf16 v[208:211], v[232:235], v[224:227], v[208:211]
  s_nop 0
  v_permlane16_swap_b32 v236, v237
  v_add_f32 v236, v236, v237
  v_rcp_f32 v236, v236
  s_nop 2
  v_pk_mul_f32 v[200:201], v[200:201], v[236:237] op_sel_hi:[1,0]
  v_pk_mul_f32 v[202:203], v[202:203], v[236:237] op_sel_hi:[1,0]
  ds_write_b128 v11, v[200:203] offset:0
  v_pk_mul_f32 v[204:205], v[204:205], v[236:237] op_sel_hi:[1,0]
  v_pk_mul_f32 v[206:207], v[206:207], v[236:237] op_sel_hi:[1,0]
  ds_write_b128 v11, v[204:207] offset:1024
  v_pk_mul_f32 v[208:209], v[208:209], v[236:237] op_sel_hi:[1,0]
  v_pk_mul_f32 v[210:211], v[210:211], v[236:237] op_sel_hi:[1,0]
  ds_write_b128 v11, v[208:211] offset:2048
  s_waitcnt lgkmcnt(0)
  s_barrier
  ds_read_b64 v[96:97], v12 offset:0
  ds_read_b64 v[98:99], v12 offset:128
  ds_read_b64 v[100:101], v12 offset:3072
  ds_read_b64 v[102:103], v12 offset:3200
  ds_read_b64 v[104:105], v12 offset:6144
  ds_read_b64 v[106:107], v12 offset:6272
  ds_read_b64 v[108:109], v12 offset:9216
  ds_read_b64 v[110:111], v12 offset:9344
  s_waitcnt lgkmcnt(6)
  v_pk_add_f32 v[96:97], v[96:97], v[98:99]
  s_waitcnt lgkmcnt(4)
  v_pk_add_f32 v[100:101], v[100:101], v[102:103]
  s_waitcnt lgkmcnt(2)
  v_pk_add_f32 v[104:105], v[104:105], v[106:107]
  v_pk_add_f32 v[96:97], v[96:97], v[100:101]
  s_waitcnt lgkmcnt(0)
  v_pk_add_f32 v[108:109], v[108:109], v[110:111]
  v_pk_add_f32 v[96:97], v[96:97], v[104:105]
  v_pk_add_f32 v[96:97], v[96:97], v[108:109]
  v_cvt_pk_f16_f32 v100, v96, v97
  v_perm_b32 v100, s91, v100, v14
  buffer_atomic_pk_add_f16 v100, v13, s[4:7], s3 offen
  v_mov_b32 v200, v196
  v_mov_b32 v201, v197
  v_mov_b32 v202, v198
  v_mov_b32 v203, v199
  v_permlane32_swap_b32 v188, v192
  v_permlane32_swap_b32 v189, v193
  v_permlane32_swap_b32 v190, v194
  v_permlane32_swap_b32 v191, v195
  v_permlane32_swap_b32 v196, v200
  v_permlane32_swap_b32 v197, v201
  v_permlane32_swap_b32 v198, v202
  v_permlane32_swap_b32 v199, v203
  v_pk_add_f32 v[188:189], v[188:189], v[192:193]
  v_pk_add_f32 v[190:191], v[190:191], v[194:195]
  v_pk_add_f32 v[196:197], v[196:197], v[200:201]
  v_pk_add_f32 v[198:199], v[198:199], v[202:203]
  v_cvt_pk_bf16_f32 v252, v188, v189
  v_cvt_pk_bf16_f32 v254, v196, v197
  v_cvt_pk_bf16_f32 v253, v190, v191
  v_cvt_pk_bf16_f32 v255, v198, v199
  s_nop 0
  v_permlane16_swap_b32 v252, v254
  v_permlane16_swap_b32 v253, v255
  v_min_u32 v252, -2, v252
  s_mov_b64 exec, s[76:77]
  buffer_store_dwordx4 v[252:255], v15, s[24:27], s57 offen sc1
  s_mov_b64 exec, -1
  s_add_u32 s64, s64, 1310720
  s_add_u32 s52, s52, 1
  s_and_b32 s21, s52, 3
  s_mul_i32 s81, s21, 540672
  s_lshl_b32 s84, s21, 15
  s_branch step_19
pm_21:
  s_mov_b32 s47, 1
  buffer_load_dwordx4 v[96:99], v4, s[4:7], s84 offen offset:0 sc1
  buffer_load_dwordx4 v[100:103], v4, s[4:7], s84 offen offset:1024 sc1
  buffer_load_dwordx4 v[104:107], v4, s[4:7], s84 offen offset:2048 sc1
  s_add_u32 s54, s54, 1
  s_cmp_gt_u32 s54, 131072
  s_cbranch_scc1 end0
  s_waitcnt vmcnt(0)
  v_bitop3_b32 v27, v99, v103, v107 bitop3:0x80
  v_cvt_f32_f16 v108, v99
  v_and_b32 v27, 0x48000000, v27
  v_cvt_f32_f16 v109, v103
  v_cmp_ne_u32 vcc, 0x48000000, v27
  v_cvt_f32_f16 v110, v106
  v_cvt_f32_f16_sdwa v111, v106 dst_sel:DWORD dst_unused:UNUSED_PAD src0_sel:WORD_1
  v_cvt_pk_bf16_f32 v40, v110, v111
  s_cbranch_vccnz pm_21
  s_branch pm_22
A1_14:
  v_smfmac_f32_16x16x32_bf16 v[52:55], v[40:41], a[16:19], v44
  v_smfmac_f32_16x16x32_bf16 v[64:67], v[40:41], a[76:79], v44
  v_smfmac_f32_16x16x32_bf16 v[56:59], v[40:41], a[36:39], v44
  v_smfmac_f32_16x16x32_bf16 v[68:71], v[40:41], a[96:99], v44
  v_smfmac_f32_16x16x32_bf16 v[60:63], v[40:41], a[56:59], v44
  v_smfmac_f32_16x16x32_bf16 v[72:75], v[40:41], a[116:119], v44
  v_smfmac_f32_16x16x32_bf16 v[76:79], v[40:41], a[136:139], v44
  v_smfmac_f32_16x16x32_bf16 v[80:83], v[40:41], a[156:159], v44
  v_smfmac_f32_16x16x32_bf16 v[84:87], v[40:41], a[176:179], v44
  s_branch A2_23
pv_24:
  buffer_load_dwordx4 v[144:147], v10, s[8:11], s81 offen offset:0 sc1
  buffer_load_dwordx4 v[148:151], v10, s[8:11], s81 offen offset:1024 sc1
  buffer_load_dwordx4 v[152:155], v10, s[8:11], s81 offen offset:2048 sc1
  s_add_u32 s54, s54, 1
  s_cmp_gt_u32 s54, 131072
  s_cbranch_scc1 end0
  s_waitcnt vmcnt(0)
  v_max3_u32 v27, v144, v146, v148
  v_max3_u32 v27, v27, v150, v152
  v_max3_u32 v27, v27, v154, v154
  v_cmp_eq_u32 vcc, -1, v27
  s_nop 1
  s_cbranch_vccnz pv_24
  s_branch pvj_27
psr_25:
  buffer_load_dwordx2 v[248:249], v9, s[8:11], s81 offen sc1
  buffer_load_dwordx4 v[112:115], v8, s[8:11], s81 offen offset:0 sc1
  buffer_load_dwordx4 v[116:119], v8, s[8:11], s81 offen offset:1024 sc1
  s_add_u32 s54, s54, 1
  s_cmp_gt_u32 s54, 131072
  s_cbranch_scc1 end0
  s_waitcnt vmcnt(2)
  v_xor_b32 v96, s88, v248
  s_nop 0
  v_permlane16_swap_b32 v248, v249
  v_fma_mix_f32 v250, v248, 1.0, v249 op_sel:[0,0,0] op_sel_hi:[1,0,1]
  v_fma_mix_f32 v251, v248, 1.0, v249 op_sel:[1,0,1] op_sel_hi:[1,0,1]
  v_mov_b32 v248, v250
  v_mov_b32 v249, v251
  s_nop 0
  v_permlane32_swap_b32 v248, v250
  v_permlane32_swap_b32 v249, v251
  s_waitcnt vmcnt(0)
  v_bitop3_b32 v97, v112, v114, s88 bitop3:0x7e
  v_bitop3_b32 v98, v116, v118, s88 bitop3:0x7e
  v_fma_mix_f32 v120, v112, 1.0, v116 op_sel:[0,0,0] op_sel_hi:[1,0,1]
  v_or3_b32 v27, v96, v97, v98
  v_fma_mix_f32 v124, v114, 1.0, v118 op_sel:[0,0,0] op_sel_hi:[1,0,1]
  v_and_b32 v27, 1, v27
  v_fma_mix_f32 v121, v112, 1.0, v116 op_sel:[1,0,1] op_sel_hi:[1,0,1]
  v_cmp_ne_u32 vcc, 0, v27
  v_fma_mix_f32 v125, v114, 1.0, v118 op_sel:[1,0,1] op_sel_hi:[1,0,1]
  v_fma_mix_f32 v122, v113, 1.0, v117 op_sel:[0,0,0] op_sel_hi:[1,0,1]
  v_fma_mix_f32 v126, v115, 1.0, v119 op_sel:[0,0,0] op_sel_hi:[1,0,1]
  s_cbranch_vccnz psr_25
  s_branch psj_26
kvw_28:
  s_cmp_eq_u32 s52, 0
  s_cselect_b32 s23, 1, s46
  s_cselect_b32 s55, 0, s55
  v_mov_b32 v236, 0
  s_mov_b32 s101, 0
wf_32:
  buffer_load_dword v237, v236, s[12:15], s79 offen sc1
  s_add_u32 s101, s101, 1
  s_cmp_gt_u32 s101, 131072
  s_cbranch_scc1 end0
  s_waitcnt vmcnt(0)
  v_readfirstlane_b32 s100, v237
  s_cmp_ge_u32 s100, s23
  s_cbranch_scc1 wf_33
  s_sleep 3
  s_branch wf_32
wf_33:
  s_cmp_gt_u32 s52, 1
  s_cbranch_scc1 kvok_29
  s_sub_u32 s21, s64, 1310720
  buffer_load_dwordx4 v[176:179], v16, s[28:31], s21 offen offset:0 sc1
  buffer_load_dwordx4 v[180:183], v16, s[28:31], s21 offen offset:1024 sc1
  buffer_load_dwordx4 v[184:187], v16, s[28:31], s21 offen offset:2048 sc1
  s_waitcnt vmcnt(0)
  s_branch kvok_29
fl_30:
  buffer_load_dword v94, v95, s[12:15], s79 offen sc1
  s_branch fl_31
last_20:
  v_mov_b32 v188, 0
  v_mov_b32 v189, 0
  v_mov_b32 v190, 0
  v_mov_b32 v191, 0
  v_mov_b32 v192, 0
  v_mov_b32 v193, 0
  v_mov_b32 v194, 0
  v_mov_b32 v195, 0
  v_mov_b32 v196, 0
  v_mov_b32 v197, 0
  v_mov_b32 v198, 0
  v_mov_b32 v199, 0
  s_sleep 4
  s_mov_b32 s54, 0
lv_34:
  buffer_load_dwordx4 v[144:147], v10, s[8:11], s81 offen offset:0 sc1
  buffer_load_dwordx4 v[148:151], v10, s[8:11], s81 offen offset:1024 sc1
  buffer_load_dwordx4 v[152:155], v10, s[8:11], s81 offen offset:2048 sc1
  s_add_u32 s54, s54, 1
  s_cmp_gt_u32 s54, 131072
  s_cbranch_scc1 end0
  s_waitcnt vmcnt(0)
  v_max3_u32 v27, v144, v146, v148
  v_max3_u32 v27, v27, v150, v152
  v_max3_u32 v27, v27, v154, v154
  v_cmp_eq_u32 vcc, -1, v27
  s_nop 1
  s_cbranch_vccnz lv_34
  v_smfmac_f32_16x16x64_bf16 v[188:191], v[144:147], a[180:187], v44
  v_smfmac_f32_16x16x64_bf16 v[192:195], v[144:147], a[204:211], v44
  v_smfmac_f32_16x16x64_bf16 v[196:199], v[144:147], a[228:235], v44
  v_smfmac_f32_16x16x64_bf16 v[188:191], v[148:151], a[188:195], v44
  v_smfmac_f32_16x16x64_bf16 v[192:195], v[148:151], a[212:219], v44
  v_smfmac_f32_16x16x64_bf16 v[196:199], v[148:151], a[236:243], v44
  v_smfmac_f32_16x16x64_bf16 v[188:191], v[152:155], a[196:203], v44
  v_smfmac_f32_16x16x64_bf16 v[192:195], v[152:155], a[220:227], v44
  v_smfmac_f32_16x16x64_bf16 v[196:199], v[152:155], a[244:251], v44
  s_nop 7
  v_mov_b32 v200, v196
  v_mov_b32 v201, v197
  v_mov_b32 v202, v198
  v_mov_b32 v203, v199
  v_permlane32_swap_b32 v188, v192
  v_permlane32_swap_b32 v189, v193
  v_permlane32_swap_b32 v190, v194
  v_permlane32_swap_b32 v191, v195
  v_permlane32_swap_b32 v196, v200
  v_permlane32_swap_b32 v197, v201
  v_permlane32_swap_b32 v198, v202
  v_permlane32_swap_b32 v199, v203
  v_pk_add_f32 v[188:189], v[188:189], v[192:193]
  v_pk_add_f32 v[190:191], v[190:191], v[194:195]
  v_pk_add_f32 v[196:197], v[196:197], v[200:201]
  v_pk_add_f32 v[198:199], v[198:199], v[202:203]
  v_cvt_pk_bf16_f32 v252, v188, v189
  v_cvt_pk_bf16_f32 v254, v196, v197
  v_cvt_pk_bf16_f32 v253, v190, v191
  v_cvt_pk_bf16_f32 v255, v198, v199
  s_nop 0
  v_permlane16_swap_b32 v252, v254
  v_permlane16_swap_b32 v253, v255
  v_min_u32 v252, -2, v252
  s_mov_b64 exec, s[76:77]
  buffer_store_dwordx4 v[252:255], v15, s[24:27], s57 offen sc1
  s_mov_b64 exec, -1
  v_mov_b32 v246, 80
  v_mov_b32 v247, 1
  s_mov_b64 exec, 1
  buffer_atomic_add v247, v246, s[32:35], 0 offen sc0 sc1
  s_mov_b64 exec, -1
clm_35:
  s_branch chain_done
step_36:
  s_add_u32 s21, s52, 2
  s_and_b32 s21, s21, 3
  s_mul_i32 s82, s21, 540672
  s_add_u32 s21, s52, 3
  s_and_b32 s21, s21, 3
  s_lshl_b32 s83, s21, 15
  s_add_u32 s21, s52, 1
  s_and_b32 s22, s21, 3
  s_lshl_b32 s3, s22, 15
  s_mul_i32 s80, s21, 393216
  s_add_u32 s46, s21, 1
  s_min_u32 s46, s46, 64
  s_mul_i32 s85, s52, 98304
  s_mul_i32 s57, s52, 327680
  s_add_u32 s57, s57, 42991616

  s_bfe_u32 s88, s52, 0x10002
  s_add_u32 s78, s81, 278528
  s_max_u32 s21, s52, 1
  s_sub_u32 s21, s21, 1
  s_cmp_lt_u32 s52, 60
  s_cselect_b32 s66, s65, 0x80000000
  s_cselect_b32 s68, 15, 1
  s_cmp_ge_u32 s52, 61
  s_cselect_b32 s66, s90, s66
  s_cselect_b32 s67, s52, s21
  v_mov_b32 v52, 0
  v_mov_b32 v53, 0
  v_mov_b32 v54, 0
  v_mov_b32 v55, 0
  v_mov_b32 v56, 0
  v_mov_b32 v57, 0
  v_mov_b32 v58, 0
  v_mov_b32 v59, 0
  v_mov_b32 v60, 0
  v_mov_b32 v61, 0
  v_mov_b32 v62, 0
  v_mov_b32 v63, 0
  v_mov_b32 v64, 0
  v_mov_b32 v65, 0
  v_mov_b32 v66, 0
  v_mov_b32 v67, 0
  v_mov_b32 v68, 0
  v_mov_b32 v69, 0
  v_mov_b32 v70, 0
  v_mov_b32 v71, 0
  v_mov_b32 v72, 0
  v_mov_b32 v73, 0
  v_mov_b32 v74, 0
  v_mov_b32 v75, 0
  v_mov_b32 v76, 0
  v_mov_b32 v77, 0
  v_mov_b32 v78, 0
  v_mov_b32 v79, 0
  v_mov_b32 v80, 0
  v_mov_b32 v81, 0
  v_mov_b32 v82, 0
  v_mov_b32 v83, 0
  v_mov_b32 v84, 0
  v_mov_b32 v85, 0
  v_mov_b32 v86, 0
  v_mov_b32 v87, 0
  s_sleep 5
  s_mov_b32 s54, 0
  buffer_load_dwordx4 v[96:99], v4, s[4:7], s84 offen offset:0 sc1
  buffer_load_dwordx4 v[100:103], v4, s[4:7], s84 offen offset:1024 sc1
  buffer_load_dwordx4 v[104:107], v4, s[4:7], s84 offen offset:2048 sc1
  s_waitcnt vmcnt(3)
  v_mov_b32 v176, v160
  v_mov_b32 v177, v161
  v_mov_b32 v178, v162
  v_mov_b32 v179, v163
  v_mov_b32 v180, v164
  v_mov_b32 v181, v165
  v_mov_b32 v182, v166
  v_mov_b32 v183, v167
  v_mov_b32 v184, v48
  v_mov_b32 v185, v49
  v_mov_b32 v186, v50
  v_mov_b32 v187, v51
  s_waitcnt vmcnt(0)
  v_bitop3_b32 v27, v99, v103, v107 bitop3:0x80
  v_cvt_f32_f16 v108, v99
  v_and_b32 v27, 0x48000000, v27
  v_cvt_f32_f16 v109, v103
  v_cmp_ne_u32 vcc, 0x48000000, v27
  v_cvt_f32_f16 v110, v106
  v_cvt_f32_f16_sdwa v111, v106 dst_sel:DWORD dst_unused:UNUSED_PAD src0_sel:WORD_1
  v_cvt_pk_bf16_f32 v40, v110, v111
  s_cbranch_vccnz pm_38
pm_39:
  v_cvt_pk_bf16_f32 v41, v108, v109
  v_cvt_f32_f16 v110, v96
  v_cvt_f32_f16_sdwa v111, v96 dst_sel:DWORD dst_unused:UNUSED_PAD src0_sel:WORD_1
  v_smfmac_f32_16x16x32_bf16 v[52:55], v[40:41], a[16:19], v44
  v_cvt_f32_f16 v112, v97
  v_cvt_f32_f16_sdwa v113, v97 dst_sel:DWORD dst_unused:UNUSED_PAD src0_sel:WORD_1
  v_cvt_pk_bf16_f32 v32, v110, v111
  v_smfmac_f32_16x16x32_bf16 v[64:67], v[40:41], a[76:79], v44
  v_cvt_pk_bf16_f32 v33, v112, v113
  v_cvt_f32_f16 v114, v98
  v_cvt_f32_f16_sdwa v115, v98 dst_sel:DWORD dst_unused:UNUSED_PAD src0_sel:WORD_1
  v_smfmac_f32_16x16x32_bf16 v[56:59], v[40:41], a[36:39], v44
  v_cvt_f32_f16 v116, v100
  v_cvt_f32_f16_sdwa v117, v100 dst_sel:DWORD dst_unused:UNUSED_PAD src0_sel:WORD_1
  v_cvt_pk_bf16_f32 v34, v114, v115
  v_smfmac_f32_16x16x32_bf16 v[68:71], v[40:41], a[96:99], v44
  v_cvt_pk_bf16_f32 v35, v116, v117
  v_cvt_f32_f16 v110, v101
  v_cvt_f32_f16_sdwa v111, v101 dst_sel:DWORD dst_unused:UNUSED_PAD src0_sel:WORD_1
  v_smfmac_f32_16x16x32_bf16 v[60:63], v[40:41], a[56:59], v44
  v_cvt_f32_f16 v112, v102
  v_cvt_f32_f16_sdwa v113, v102 dst_sel:DWORD dst_unused:UNUSED_PAD src0_sel:WORD_1
  v_smfmac_f32_16x16x32_bf16 v[72:75], v[40:41], a[116:119], v44
  v_cvt_pk_bf16_f32 v36, v110, v111
  v_cvt_pk_bf16_f32 v37, v112, v113
  v_smfmac_f32_16x16x32_bf16 v[76:79], v[40:41], a[136:139], v44
  v_cvt_f32_f16 v114, v104
  v_cvt_f32_f16_sdwa v115, v104 dst_sel:DWORD dst_unused:UNUSED_PAD src0_sel:WORD_1
  v_smfmac_f32_16x16x32_bf16 v[80:83], v[40:41], a[156:159], v44
  v_cvt_f32_f16 v116, v105
  v_cvt_f32_f16_sdwa v117, v105 dst_sel:DWORD dst_unused:UNUSED_PAD src0_sel:WORD_1
  v_smfmac_f32_16x16x32_bf16 v[84:87], v[40:41], a[176:179], v44
  v_cvt_pk_bf16_f32 v38, v114, v115
  v_cvt_pk_bf16_f32 v39, v116, v117
A2_40:
  v_smfmac_f32_16x16x64_bf16 v[52:55], v[32:35], a[0:7], v44
  v_smfmac_f32_16x16x64_bf16 v[52:55], v[36:39], a[8:15], v44
  v_smfmac_f32_16x16x64_bf16 v[64:67], v[32:35], a[60:67], v44
  v_smfmac_f32_16x16x64_bf16 v[64:67], v[36:39], a[68:75], v44
  v_smfmac_f32_16x16x64_bf16 v[56:59], v[32:35], a[20:27], v44
  v_smfmac_f32_16x16x64_bf16 v[56:59], v[36:39], a[28:35], v44
  v_smfmac_f32_16x16x64_bf16 v[68:71], v[32:35], a[80:87], v44
  v_permlane32_swap_b32 v52, v64
  v_permlane32_swap_b32 v53, v65
  v_permlane32_swap_b32 v54, v66
  v_smfmac_f32_16x16x64_bf16 v[68:71], v[36:39], a[88:95], v44
  v_permlane32_swap_b32 v55, v67
  v_pk_add_f32 v[52:53], v[52:53], v[64:65]
  v_pk_add_f32 v[54:55], v[54:55], v[66:67]
  v_smfmac_f32_16x16x64_bf16 v[60:63], v[32:35], a[40:47], v44
  ds_write2_b32 v5, v52, v53 offset0:0 offset1:4
  ds_write2_b32 v5, v54, v55 offset0:8 offset1:12
  v_smfmac_f32_16x16x64_bf16 v[60:63], v[36:39], a[48:55], v44
  v_smfmac_f32_16x16x64_bf16 v[72:75], v[32:35], a[100:107], v44
  v_permlane32_swap_b32 v56, v68
  v_permlane32_swap_b32 v57, v69
  v_permlane32_swap_b32 v58, v70
  v_smfmac_f32_16x16x64_bf16 v[72:75], v[36:39], a[108:115], v44
  v_permlane32_swap_b32 v59, v71
  v_pk_add_f32 v[56:57], v[56:57], v[68:69]
  v_pk_add_f32 v[58:59], v[58:59], v[70:71]
  v_smfmac_f32_16x16x64_bf16 v[76:79], v[32:35], a[120:127], v44
  ds_write2_b32 v242, v56, v57 offset0:0 offset1:4
  ds_write2_b32 v242, v58, v59 offset0:8 offset1:12
  v_smfmac_f32_16x16x64_bf16 v[76:79], v[36:39], a[128:135], v44
  v_smfmac_f32_16x16x64_bf16 v[80:83], v[32:35], a[140:147], v44
  v_permlane32_swap_b32 v60, v72
  v_permlane32_swap_b32 v61, v73
  v_permlane32_swap_b32 v62, v74
  v_smfmac_f32_16x16x64_bf16 v[80:83], v[36:39], a[148:155], v44
  v_permlane32_swap_b32 v63, v75
  v_pk_add_f32 v[60:61], v[60:61], v[72:73]
  v_pk_add_f32 v[62:63], v[62:63], v[74:75]
  v_smfmac_f32_16x16x64_bf16 v[84:87], v[32:35], a[160:167], v44
  ds_write2_b32 v243, v60, v61 offset0:0 offset1:4
  ds_write2_b32 v243, v62, v63 offset0:8 offset1:12
  v_smfmac_f32_16x16x64_bf16 v[84:87], v[36:39], a[168:175], v44
  v_permlane32_swap_b32 v76, v80
  v_permlane32_swap_b32 v77, v81
  v_permlane32_swap_b32 v78, v82
  v_permlane32_swap_b32 v79, v83
  v_pk_add_f32 v[76:77], v[76:77], v[80:81]
  v_pk_add_f32 v[78:79], v[78:79], v[82:83]
  ds_write2_b32 v244, v76, v77 offset0:0 offset1:4
  ds_write2_b32 v244, v78, v79 offset0:8 offset1:12
  ds_write2_b32 v245, v84, v85 offset0:0 offset1:4
  ds_write2_b32 v245, v86, v87 offset0:8 offset1:12
  s_waitcnt lgkmcnt(0) vmcnt(0)
  s_barrier
  ds_read_b128 v[96:99], v45 offset:0
  ds_read_b128 v[108:111], v45 offset:5440
  ds_read_b128 v[100:103], v45 offset:1088
  ds_read_b128 v[112:115], v45 offset:6528
  ds_read_b128 v[104:107], v45 offset:2176
  ds_read_b128 v[116:119], v45 offset:7616
  s_waitcnt lgkmcnt(4)
  v_pk_add_f32 v[96:97], v[96:97], v[108:109]
  v_pk_add_f32 v[98:99], v[98:99], v[110:111]
  s_nop 0
  v_add_f32_dpp v108, v96, v96 row_ror:8 row_mask:0xf bank_mask:0xf
  v_add_f32_dpp v109, v97, v97 row_ror:8 row_mask:0xf bank_mask:0xf
  v_add_f32_dpp v110, v98, v98 row_ror:8 row_mask:0xf bank_mask:0xf
  v_add_f32_dpp v111, v99, v99 row_ror:8 row_mask:0xf bank_mask:0xf
  v_cvt_pk_bf16_f32 v212, v108, v109
  v_cvt_pk_bf16_f32 v213, v110, v111
  s_waitcnt lgkmcnt(2)
  v_pk_add_f32 v[100:101], v[100:101], v[112:113]
  v_pk_add_f32 v[102:103], v[102:103], v[114:115]
  s_nop 0
  v_add_f32_dpp v112, v100, v100 row_ror:8 row_mask:0xf bank_mask:0xf
  v_add_f32_dpp v113, v101, v101 row_ror:8 row_mask:0xf bank_mask:0xf
  v_add_f32_dpp v114, v102, v102 row_ror:8 row_mask:0xf bank_mask:0xf
  v_add_f32_dpp v115, v103, v103 row_ror:8 row_mask:0xf bank_mask:0xf
  v_cvt_pk_bf16_f32 v214, v112, v113
  v_cvt_pk_bf16_f32 v215, v114, v115
  s_waitcnt lgkmcnt(0)
  v_pk_add_f32 v[104:105], v[104:105], v[116:117]
  v_pk_add_f32 v[106:107], v[106:107], v[118:119]
  v_mfma_f32_16x16x32_bf16 v[96:99], v[168:171], v[212:215], 0
  v_add_f32_dpp v116, v104, v104 row_ror:8 row_mask:0xf bank_mask:0xf
  v_add_f32_dpp v117, v105, v105 row_ror:8 row_mask:0xf bank_mask:0xf
  v_add_f32_dpp v118, v106, v106 row_ror:8 row_mask:0xf bank_mask:0xf
  v_add_f32_dpp v119, v107, v107 row_ror:8 row_mask:0xf bank_mask:0xf
  v_cvt_pk_bf16_f32 v216, v116, v117
  v_cvt_pk_bf16_f32 v217, v118, v119
  s_nop 1
  v_mfma_f32_16x16x32_bf16 v[96:99], v[172:175], v[216:219], v[96:99]
  s_mov_b64 exec, s[74:75]
  s_nop 6
  v_cvt_pk_f16_f32 v100, v96, v97
  v_cvt_pk_f16_f32 v101, v98, v99
  v_and_or_b32 v100, v100, -2, s88
  buffer_store_dwordx2 v[100:101], v7, s[8:11], s81 offen
  s_mov_b64 exec, -1
  s_cmp_eq_u32 s52, 63
  s_cbranch_scc1 last_37
  s_sleep 5
  s_mov_b32 s54, 0
  buffer_load_dwordx2 v[248:249], v9, s[8:11], s81 offen sc1
  buffer_load_dwordx4 v[112:115], v8, s[8:11], s81 offen offset:0 sc1
  buffer_load_dwordx4 v[116:119], v8, s[8:11], s81 offen offset:1024 sc1
  s_sleep 2
  buffer_load_dwordx4 v[144:147], v10, s[8:11], s81 offen offset:0 sc1
  buffer_load_dwordx4 v[148:151], v10, s[8:11], s81 offen offset:1024 sc1
  buffer_load_dwordx4 v[152:155], v10, s[8:11], s81 offen offset:2048 sc1
  v_mov_b32 v188, 0
  v_mov_b32 v189, 0
  v_mov_b32 v190, 0
  v_mov_b32 v191, 0
  v_mov_b32 v192, 0
  v_mov_b32 v193, 0
  v_mov_b32 v194, 0
  v_mov_b32 v195, 0
  v_mov_b32 v196, 0
  v_mov_b32 v197, 0
  v_mov_b32 v198, 0
  v_mov_b32 v199, 0
  v_readfirstlane_b32 s21, v94
  s_add_u32 s22, s46, 2
  s_min_u32 s22, s22, 64
  s_sub_u32 s55, s21, s22
  s_sub_u32 s56, s21, s46
  s_waitcnt vmcnt(5)
  v_xor_b32 v96, s88, v248
  s_nop 0
  v_permlane16_swap_b32 v248, v249
  v_fma_mix_f32 v250, v248, 1.0, v249 op_sel:[0,0,0] op_sel_hi:[1,0,1]
  v_fma_mix_f32 v251, v248, 1.0, v249 op_sel:[1,0,1] op_sel_hi:[1,0,1]
  v_mov_b32 v248, v250
  v_mov_b32 v249, v251
  s_nop 0
  v_permlane32_swap_b32 v248, v250
  v_permlane32_swap_b32 v249, v251
  s_waitcnt vmcnt(3)
  v_bitop3_b32 v97, v112, v114, s88 bitop3:0x7e
  v_bitop3_b32 v98, v116, v118, s88 bitop3:0x7e
  v_fma_mix_f32 v120, v112, 1.0, v116 op_sel:[0,0,0] op_sel_hi:[1,0,1]
  v_or3_b32 v27, v96, v97, v98
  v_fma_mix_f32 v124, v114, 1.0, v118 op_sel:[0,0,0] op_sel_hi:[1,0,1]
  v_and_b32 v27, 1, v27
  v_fma_mix_f32 v121, v112, 1.0, v116 op_sel:[1,0,1] op_sel_hi:[1,0,1]
  v_cmp_ne_u32 vcc, 0, v27
  v_fma_mix_f32 v125, v114, 1.0, v118 op_sel:[1,0,1] op_sel_hi:[1,0,1]
  v_fma_mix_f32 v122, v113, 1.0, v117 op_sel:[0,0,0] op_sel_hi:[1,0,1]
  v_fma_mix_f32 v126, v115, 1.0, v119 op_sel:[0,0,0] op_sel_hi:[1,0,1]
  s_cbranch_vccnz psr_42
psj_43:
  s_cmp_lt_i32 s56, 0
  s_cbranch_scc1 kvw_45
kvok_46:
  v_fma_mix_f32 v123, v113, 1.0, v117 op_sel:[1,0,1] op_sel_hi:[1,0,1]
  v_fma_mix_f32 v127, v115, 1.0, v119 op_sel:[1,0,1] op_sel_hi:[1,0,1]
  v_permlane32_swap_b32 v120, v124
  v_permlane32_swap_b32 v121, v125
  v_permlane32_swap_b32 v122, v126
  v_permlane32_swap_b32 v123, v127
  v_pk_add_f32 v[120:121], v[120:121], v[124:125]
  v_pk_add_f32 v[122:123], v[122:123], v[126:127]
  v_pk_add_f32 v[124:125], v[248:249], v[250:251]
  v_max3_f32 v236, v120, v121, v122
  v_max3_f32 v237, v123, v124, v125
  v_max_f32 v236, v236, v237
  s_nop 1
  v_max_f32_dpp v236, v236, v236 row_ror:8 row_mask:0xf bank_mask:0xf
  v_mov_b32 v237, v236
  s_nop 1
  v_permlane32_swap_b32 v236, v237
  v_max_f32 v236, v236, v237
  v_mov_b32 v237, v236
  s_nop 1
  v_permlane16_swap_b32 v236, v237
  v_max_f32 v236, v236, v237
  s_waitcnt vmcnt(0)
  v_max3_u32 v27, v144, v146, v148
  v_max3_u32 v27, v27, v150, v152
  v_max3_u32 v27, v27, v154, v154
  v_cmp_eq_u32 vcc, -1, v27
  s_nop 1
  s_cbranch_vccnz pv_41
pvj_44:
  v_mul_f32 v236, s86, v236
  v_smfmac_f32_16x16x64_bf16 v[188:191], v[144:147], a[180:187], v44
  v_fma_f32 v120, v120, s86, -v236
  v_smfmac_f32_16x16x64_bf16 v[188:191], v[148:151], a[188:195], v44
  v_fma_f32 v121, v121, s86, -v236
  v_smfmac_f32_16x16x64_bf16 v[188:191], v[152:155], a[196:203], v44
  buffer_load_dwordx4 v[160:163], v17, s[28:31], s64 offen offset:0 sc1
  v_fma_f32 v122, v122, s86, -v236
  v_smfmac_f32_16x16x64_bf16 v[192:195], v[144:147], a[204:211], v44
  v_fma_f32 v123, v123, s86, -v236
  v_smfmac_f32_16x16x64_bf16 v[192:195], v[148:151], a[212:219], v44
  buffer_load_dwordx4 v[164:167], v16, s[28:31], s64 offen offset:1024 sc1
  v_fma_f32 v124, v124, s86, -v236
  v_smfmac_f32_16x16x64_bf16 v[192:195], v[152:155], a[220:227], v44
  v_fma_f32 v125, v125, s86, -v236
  v_smfmac_f32_16x16x64_bf16 v[196:199], v[144:147], a[228:235], v44
  buffer_load_dwordx4 v[48:51], v26, s[28:31], s64 offen offset:2048 sc1
  v_exp_f32 v120, v120
  v_smfmac_f32_16x16x64_bf16 v[196:199], v[148:151], a[236:243], v44
  v_exp_f32 v121, v121
  v_smfmac_f32_16x16x64_bf16 v[196:199], v[152:155], a[244:251], v44
  buffer_load_dwordx4 v[168:171], v18, s[16:19], s80 offen sc1
  v_exp_f32 v122, v122
  buffer_load_dwordx2 v[172:173], v20, s[16:19], s80 offen sc1
  v_exp_f32 v123, v123
  v_exp_f32 v124, v124
  s_cmp_lt_i32 s55, 0
  s_cbranch_scc1 fl_47
fl_48:
  v_exp_f32 v125, v125
  s_mov_b64 exec, s[60:61]
  v_cvt_pk_bf16_f32 v220, v120, v121
  v_cvt_pk_bf16_f32 v221, v122, v123
  v_cvt_pk_bf16_f32 v224, v124, v125
  s_mov_b64 exec, s[62:63]
  v_cvt_pk_bf16_f32 v222, v120, v121
  v_cvt_pk_bf16_f32 v223, v122, v123
  v_cvt_pk_bf16_f32 v225, v124, v125
  s_mov_b64 exec, -1
  v_pk_add_f32 v[126:127], v[120:121], v[122:123]
  v_add_f32 v128, v124, v125
  v_mfma_f32_16x16x32_bf16 v[200:203], v[176:179], v[220:223], 0
  v_add_f32 v236, v126, v127
  v_fmac_f32 v236, v128, v89
  v_cvt_pk_bf16_f32 v228, v188, v189
  v_cvt_pk_bf16_f32 v229, v190, v191
  v_mfma_f32_16x16x32_bf16 v[204:207], v[180:183], v[220:223], 0
  v_cvt_pk_bf16_f32 v230, v192, v193
  v_cvt_pk_bf16_f32 v231, v194, v195
  v_mfma_f32_16x16x32_bf16 v[208:211], v[184:187], v[220:223], 0
  v_cvt_pk_bf16_f32 v232, v196, v197
  v_cvt_pk_bf16_f32 v233, v198, v199
  v_add_f32_dpp v236, v236, v236 row_ror:8 row_mask:0xf bank_mask:0xf
  v_mov_b32 v237, v236
  s_nop 0
  v_mfma_f32_16x16x32_bf16 v[200:203], v[228:231], v[224:227], v[200:203]
  v_mfma_f32_16x16x32_bf16 v[204:207], v[230:233], v[224:227], v[204:207]
  v_permlane32_swap_b32 v236, v237
  v_add_f32 v236, v236, v237
  v_mov_b32 v237, v236
  v_mfma_f32_16x16x32_bf16 v[208:211], v[232:235], v[224:227], v[208:211]
  s_nop 0
  v_permlane16_swap_b32 v236, v237
  v_add_f32 v236, v236, v237
  v_rcp_f32 v236, v236
  s_nop 2
  v_pk_mul_f32 v[200:201], v[200:201], v[236:237] op_sel_hi:[1,0]
  v_pk_mul_f32 v[202:203], v[202:203], v[236:237] op_sel_hi:[1,0]
  ds_write_b128 v11, v[200:203] offset:0
  v_pk_mul_f32 v[204:205], v[204:205], v[236:237] op_sel_hi:[1,0]
  v_pk_mul_f32 v[206:207], v[206:207], v[236:237] op_sel_hi:[1,0]
  ds_write_b128 v11, v[204:207] offset:1024
  v_pk_mul_f32 v[208:209], v[208:209], v[236:237] op_sel_hi:[1,0]
  v_pk_mul_f32 v[210:211], v[210:211], v[236:237] op_sel_hi:[1,0]
  ds_write_b128 v11, v[208:211] offset:2048
  s_waitcnt lgkmcnt(0)
  s_barrier
  ds_read_b64 v[96:97], v12 offset:0
  ds_read_b64 v[98:99], v12 offset:128
  ds_read_b64 v[100:101], v12 offset:3072
  ds_read_b64 v[102:103], v12 offset:3200
  ds_read_b64 v[104:105], v12 offset:6144
  ds_read_b64 v[106:107], v12 offset:6272
  ds_read_b64 v[108:109], v12 offset:9216
  ds_read_b64 v[110:111], v12 offset:9344
  s_waitcnt lgkmcnt(6)
  v_pk_add_f32 v[96:97], v[96:97], v[98:99]
  s_waitcnt lgkmcnt(4)
  v_pk_add_f32 v[100:101], v[100:101], v[102:103]
  s_waitcnt lgkmcnt(2)
  v_pk_add_f32 v[104:105], v[104:105], v[106:107]
  v_pk_add_f32 v[96:97], v[96:97], v[100:101]
  s_waitcnt lgkmcnt(0)
  v_pk_add_f32 v[108:109], v[108:109], v[110:111]
  v_pk_add_f32 v[96:97], v[96:97], v[104:105]
  v_pk_add_f32 v[96:97], v[96:97], v[108:109]
  v_cvt_pk_f16_f32 v100, v96, v97
  v_perm_b32 v100, s91, v100, v14
  buffer_atomic_pk_add_f16 v100, v13, s[4:7], s3 offen
  v_mov_b32 v200, v196
  v_mov_b32 v201, v197
  v_mov_b32 v202, v198
  v_mov_b32 v203, v199
  v_permlane32_swap_b32 v188, v192
  v_permlane32_swap_b32 v189, v193
  v_permlane32_swap_b32 v190, v194
  v_permlane32_swap_b32 v191, v195
  v_permlane32_swap_b32 v196, v200
  v_permlane32_swap_b32 v197, v201
  v_permlane32_swap_b32 v198, v202
  v_permlane32_swap_b32 v199, v203
  v_pk_add_f32 v[188:189], v[188:189], v[192:193]
  v_pk_add_f32 v[190:191], v[190:191], v[194:195]
  v_pk_add_f32 v[196:197], v[196:197], v[200:201]
  v_pk_add_f32 v[198:199], v[198:199], v[202:203]
  v_cvt_pk_bf16_f32 v252, v188, v189
  v_cvt_pk_bf16_f32 v254, v196, v197
  v_cvt_pk_bf16_f32 v253, v190, v191
  v_cvt_pk_bf16_f32 v255, v198, v199
  s_nop 0
  v_permlane16_swap_b32 v252, v254
  v_permlane16_swap_b32 v253, v255
  v_min_u32 v252, -2, v252
  s_mov_b64 exec, s[76:77]
  buffer_store_dwordx4 v[252:255], v15, s[24:27], s57 offen sc1
  s_mov_b64 exec, -1
  s_add_u32 s64, s64, 1310720
  s_add_u32 s52, s52, 1
  s_and_b32 s21, s52, 3
  s_mul_i32 s81, s21, 540672
  s_lshl_b32 s84, s21, 15
  s_branch step_36
pm_38:
  s_mov_b32 s47, 1
  buffer_load_dwordx4 v[96:99], v4, s[4:7], s84 offen offset:0 sc1
  buffer_load_dwordx4 v[100:103], v4, s[4:7], s84 offen offset:1024 sc1
  buffer_load_dwordx4 v[104:107], v4, s[4:7], s84 offen offset:2048 sc1
  s_add_u32 s54, s54, 1
  s_cmp_gt_u32 s54, 131072
  s_cbranch_scc1 end0
  s_waitcnt vmcnt(0)
  v_bitop3_b32 v27, v99, v103, v107 bitop3:0x80
  v_cvt_f32_f16 v108, v99
  v_and_b32 v27, 0x48000000, v27
  v_cvt_f32_f16 v109, v103
  v_cmp_ne_u32 vcc, 0x48000000, v27
  v_cvt_f32_f16 v110, v106
  v_cvt_f32_f16_sdwa v111, v106 dst_sel:DWORD dst_unused:UNUSED_PAD src0_sel:WORD_1
  v_cvt_pk_bf16_f32 v40, v110, v111
  s_cbranch_vccnz pm_38
  s_branch pm_39
A1_15:
  v_smfmac_f32_16x16x32_bf16 v[52:55], v[40:41], a[16:19], v44
  v_smfmac_f32_16x16x32_bf16 v[64:67], v[40:41], a[76:79], v44
  v_smfmac_f32_16x16x32_bf16 v[56:59], v[40:41], a[36:39], v44
  v_smfmac_f32_16x16x32_bf16 v[68:71], v[40:41], a[96:99], v44
  v_smfmac_f32_16x16x32_bf16 v[60:63], v[40:41], a[56:59], v44
  v_smfmac_f32_16x16x32_bf16 v[72:75], v[40:41], a[116:119], v44
  v_smfmac_f32_16x16x32_bf16 v[76:79], v[40:41], a[136:139], v44
  v_smfmac_f32_16x16x32_bf16 v[80:83], v[40:41], a[156:159], v44
  v_smfmac_f32_16x16x32_bf16 v[84:87], v[40:41], a[176:179], v44
  s_branch A2_40
pv_41:
  buffer_load_dwordx4 v[144:147], v10, s[8:11], s81 offen offset:0 sc1
  buffer_load_dwordx4 v[148:151], v10, s[8:11], s81 offen offset:1024 sc1
  buffer_load_dwordx4 v[152:155], v10, s[8:11], s81 offen offset:2048 sc1
  s_add_u32 s54, s54, 1
  s_cmp_gt_u32 s54, 131072
  s_cbranch_scc1 end0
  s_waitcnt vmcnt(0)
  v_max3_u32 v27, v144, v146, v148
  v_max3_u32 v27, v27, v150, v152
  v_max3_u32 v27, v27, v154, v154
  v_cmp_eq_u32 vcc, -1, v27
  s_nop 1
  s_cbranch_vccnz pv_41
  s_branch pvj_44
psr_42:
  buffer_load_dwordx2 v[248:249], v9, s[8:11], s81 offen sc1
  buffer_load_dwordx4 v[112:115], v8, s[8:11], s81 offen offset:0 sc1
  buffer_load_dwordx4 v[116:119], v8, s[8:11], s81 offen offset:1024 sc1
  s_add_u32 s54, s54, 1
  s_cmp_gt_u32 s54, 131072
  s_cbranch_scc1 end0
  s_waitcnt vmcnt(2)
  v_xor_b32 v96, s88, v248
  s_nop 0
  v_permlane16_swap_b32 v248, v249
  v_fma_mix_f32 v250, v248, 1.0, v249 op_sel:[0,0,0] op_sel_hi:[1,0,1]
  v_fma_mix_f32 v251, v248, 1.0, v249 op_sel:[1,0,1] op_sel_hi:[1,0,1]
  v_mov_b32 v248, v250
  v_mov_b32 v249, v251
  s_nop 0
  v_permlane32_swap_b32 v248, v250
  v_permlane32_swap_b32 v249, v251
  s_waitcnt vmcnt(0)
  v_bitop3_b32 v97, v112, v114, s88 bitop3:0x7e
  v_bitop3_b32 v98, v116, v118, s88 bitop3:0x7e
  v_fma_mix_f32 v120, v112, 1.0, v116 op_sel:[0,0,0] op_sel_hi:[1,0,1]
  v_or3_b32 v27, v96, v97, v98
  v_fma_mix_f32 v124, v114, 1.0, v118 op_sel:[0,0,0] op_sel_hi:[1,0,1]
  v_and_b32 v27, 1, v27
  v_fma_mix_f32 v121, v112, 1.0, v116 op_sel:[1,0,1] op_sel_hi:[1,0,1]
  v_cmp_ne_u32 vcc, 0, v27
  v_fma_mix_f32 v125, v114, 1.0, v118 op_sel:[1,0,1] op_sel_hi:[1,0,1]
  v_fma_mix_f32 v122, v113, 1.0, v117 op_sel:[0,0,0] op_sel_hi:[1,0,1]
  v_fma_mix_f32 v126, v115, 1.0, v119 op_sel:[0,0,0] op_sel_hi:[1,0,1]
  s_cbranch_vccnz psr_42
  s_branch psj_43
kvw_45:
  s_cmp_eq_u32 s52, 0
  s_cselect_b32 s23, 1, s46
  s_cselect_b32 s55, 0, s55
  v_mov_b32 v236, 0
  s_mov_b32 s101, 0
wf_49:
  buffer_load_dword v237, v236, s[12:15], s79 offen sc1
  s_add_u32 s101, s101, 1
  s_cmp_gt_u32 s101, 131072
  s_cbranch_scc1 end0
  s_waitcnt vmcnt(0)
  v_readfirstlane_b32 s100, v237
  s_cmp_ge_u32 s100, s23
  s_cbranch_scc1 wf_50
  s_sleep 3
  s_branch wf_49
wf_50:
  s_cmp_gt_u32 s52, 1
  s_cbranch_scc1 kvok_46
  s_sub_u32 s21, s64, 1310720
  buffer_load_dwordx4 v[176:179], v16, s[28:31], s21 offen offset:0 sc1
  buffer_load_dwordx4 v[180:183], v16, s[28:31], s21 offen offset:1024 sc1
  buffer_load_dwordx4 v[184:187], v16, s[28:31], s21 offen offset:2048 sc1
  s_waitcnt vmcnt(0)
  s_branch kvok_46
fl_47:
  buffer_load_dword v94, v95, s[12:15], s79 offen sc1
  s_branch fl_48
last_37:
  v_mov_b32 v188, 0
  v_mov_b32 v189, 0
  v_mov_b32 v190, 0
  v_mov_b32 v191, 0
  v_mov_b32 v192, 0
  v_mov_b32 v193, 0
  v_mov_b32 v194, 0
  v_mov_b32 v195, 0
  v_mov_b32 v196, 0
  v_mov_b32 v197, 0
  v_mov_b32 v198, 0
  v_mov_b32 v199, 0
  s_sleep 4
  s_mov_b32 s54, 0
lv_51:
  buffer_load_dwordx4 v[144:147], v10, s[8:11], s81 offen offset:0 sc1
  buffer_load_dwordx4 v[148:151], v10, s[8:11], s81 offen offset:1024 sc1
  buffer_load_dwordx4 v[152:155], v10, s[8:11], s81 offen offset:2048 sc1
  s_add_u32 s54, s54, 1
  s_cmp_gt_u32 s54, 131072
  s_cbranch_scc1 end0
  s_waitcnt vmcnt(0)
  v_max3_u32 v27, v144, v146, v148
  v_max3_u32 v27, v27, v150, v152
  v_max3_u32 v27, v27, v154, v154
  v_cmp_eq_u32 vcc, -1, v27
  s_nop 1
  s_cbranch_vccnz lv_51
  v_smfmac_f32_16x16x64_bf16 v[188:191], v[144:147], a[180:187], v44
  v_smfmac_f32_16x16x64_bf16 v[192:195], v[144:147], a[204:211], v44
  v_smfmac_f32_16x16x64_bf16 v[196:199], v[144:147], a[228:235], v44
  v_smfmac_f32_16x16x64_bf16 v[188:191], v[148:151], a[188:195], v44
  v_smfmac_f32_16x16x64_bf16 v[192:195], v[148:151], a[212:219], v44
  v_smfmac_f32_16x16x64_bf16 v[196:199], v[148:151], a[236:243], v44
  v_smfmac_f32_16x16x64_bf16 v[188:191], v[152:155], a[196:203], v44
  v_smfmac_f32_16x16x64_bf16 v[192:195], v[152:155], a[220:227], v44
  v_smfmac_f32_16x16x64_bf16 v[196:199], v[152:155], a[244:251], v44
  s_nop 7
  v_mov_b32 v200, v196
  v_mov_b32 v201, v197
  v_mov_b32 v202, v198
  v_mov_b32 v203, v199
  v_permlane32_swap_b32 v188, v192
  v_permlane32_swap_b32 v189, v193
  v_permlane32_swap_b32 v190, v194
  v_permlane32_swap_b32 v191, v195
  v_permlane32_swap_b32 v196, v200
  v_permlane32_swap_b32 v197, v201
  v_permlane32_swap_b32 v198, v202
  v_permlane32_swap_b32 v199, v203
  v_pk_add_f32 v[188:189], v[188:189], v[192:193]
  v_pk_add_f32 v[190:191], v[190:191], v[194:195]
  v_pk_add_f32 v[196:197], v[196:197], v[200:201]
  v_pk_add_f32 v[198:199], v[198:199], v[202:203]
  v_cvt_pk_bf16_f32 v252, v188, v189
  v_cvt_pk_bf16_f32 v254, v196, v197
  v_cvt_pk_bf16_f32 v253, v190, v191
  v_cvt_pk_bf16_f32 v255, v198, v199
  s_nop 0
  v_permlane16_swap_b32 v252, v254
  v_permlane16_swap_b32 v253, v255
  v_min_u32 v252, -2, v252
  s_mov_b64 exec, s[76:77]
  buffer_store_dwordx4 v[252:255], v15, s[24:27], s57 offen sc1
  s_mov_b64 exec, -1
  s_branch chain_done
step_52:
  s_add_u32 s21, s52, 2
  s_and_b32 s21, s21, 3
  s_mul_i32 s82, s21, 540672
  s_add_u32 s21, s52, 3
  s_and_b32 s21, s21, 3
  s_lshl_b32 s83, s21, 15
  s_add_u32 s21, s52, 1
  s_and_b32 s22, s21, 3
  s_lshl_b32 s3, s22, 15
  s_mul_i32 s80, s21, 393216
  s_add_u32 s46, s21, 1
  s_min_u32 s46, s46, 64
  s_mul_i32 s85, s52, 98304
  s_mul_i32 s57, s52, 327680
  s_add_u32 s57, s57, 42991616

  s_bfe_u32 s88, s52, 0x10002
  s_add_u32 s78, s81, 278528
  s_max_u32 s21, s52, 1
  s_sub_u32 s21, s21, 1
  s_cmp_lt_u32 s52, 60
  s_cselect_b32 s66, s65, 0x80000000
  s_cselect_b32 s68, 15, 1
  s_cmp_ge_u32 s52, 61
  s_cselect_b32 s66, s90, s66
  s_cselect_b32 s67, s52, s21
  v_mov_b32 v52, 0
  v_mov_b32 v53, 0
  v_mov_b32 v54, 0
  v_mov_b32 v55, 0
  v_mov_b32 v56, 0
  v_mov_b32 v57, 0
  v_mov_b32 v58, 0
  v_mov_b32 v59, 0
  v_mov_b32 v60, 0
  v_mov_b32 v61, 0
  v_mov_b32 v62, 0
  v_mov_b32 v63, 0
  v_mov_b32 v64, 0
  v_mov_b32 v65, 0
  v_mov_b32 v66, 0
  v_mov_b32 v67, 0
  v_mov_b32 v68, 0
  v_mov_b32 v69, 0
  v_mov_b32 v70, 0
  v_mov_b32 v71, 0
  v_mov_b32 v72, 0
  v_mov_b32 v73, 0
  v_mov_b32 v74, 0
  v_mov_b32 v75, 0
  v_mov_b32 v76, 0
  v_mov_b32 v77, 0
  v_mov_b32 v78, 0
  v_mov_b32 v79, 0
  v_mov_b32 v80, 0
  v_mov_b32 v81, 0
  v_mov_b32 v82, 0
  v_mov_b32 v83, 0
  v_mov_b32 v84, 0
  v_mov_b32 v85, 0
  v_mov_b32 v86, 0
  v_mov_b32 v87, 0
  s_sleep 5
  s_mov_b32 s54, 0
  buffer_load_dwordx4 v[96:99], v4, s[4:7], s84 offen offset:0 sc1
  buffer_load_dwordx4 v[100:103], v4, s[4:7], s84 offen offset:1024 sc1
  buffer_load_dwordx4 v[104:107], v4, s[4:7], s84 offen offset:2048 sc1
  s_waitcnt vmcnt(3)
  v_mov_b32 v176, v160
  v_mov_b32 v177, v161
  v_mov_b32 v178, v162
  v_mov_b32 v179, v163
  v_mov_b32 v180, v164
  v_mov_b32 v181, v165
  v_mov_b32 v182, v166
  v_mov_b32 v183, v167
  v_mov_b32 v184, v48
  v_mov_b32 v185, v49
  v_mov_b32 v186, v50
  v_mov_b32 v187, v51
  s_waitcnt vmcnt(0)
  v_bitop3_b32 v27, v99, v103, v107 bitop3:0x80
  v_cvt_f32_f16 v108, v99
  v_and_b32 v27, 0x48000000, v27
  v_cvt_f32_f16 v109, v103
  v_cmp_ne_u32 vcc, 0x48000000, v27
  v_cvt_f32_f16 v110, v106
  v_cvt_f32_f16_sdwa v111, v106 dst_sel:DWORD dst_unused:UNUSED_PAD src0_sel:WORD_1
  v_cvt_pk_bf16_f32 v40, v110, v111
  s_cbranch_vccnz pm_54
pm_55:
  v_cvt_pk_bf16_f32 v41, v108, v109
  v_cvt_f32_f16 v110, v96
  v_cvt_f32_f16_sdwa v111, v96 dst_sel:DWORD dst_unused:UNUSED_PAD src0_sel:WORD_1
  v_smfmac_f32_16x16x32_bf16 v[52:55], v[40:41], a[16:19], v44
  v_cvt_f32_f16 v112, v97
  v_cvt_f32_f16_sdwa v113, v97 dst_sel:DWORD dst_unused:UNUSED_PAD src0_sel:WORD_1
  v_cvt_pk_bf16_f32 v32, v110, v111
  v_smfmac_f32_16x16x32_bf16 v[64:67], v[40:41], a[76:79], v44
  v_cvt_pk_bf16_f32 v33, v112, v113
  v_cvt_f32_f16 v114, v98
  v_cvt_f32_f16_sdwa v115, v98 dst_sel:DWORD dst_unused:UNUSED_PAD src0_sel:WORD_1
  v_smfmac_f32_16x16x32_bf16 v[56:59], v[40:41], a[36:39], v44
  v_cvt_f32_f16 v116, v100
  v_cvt_f32_f16_sdwa v117, v100 dst_sel:DWORD dst_unused:UNUSED_PAD src0_sel:WORD_1
  v_cvt_pk_bf16_f32 v34, v114, v115
  v_smfmac_f32_16x16x32_bf16 v[68:71], v[40:41], a[96:99], v44
  v_cvt_pk_bf16_f32 v35, v116, v117
  v_cvt_f32_f16 v110, v101
  v_cvt_f32_f16_sdwa v111, v101 dst_sel:DWORD dst_unused:UNUSED_PAD src0_sel:WORD_1
  v_smfmac_f32_16x16x32_bf16 v[60:63], v[40:41], a[56:59], v44
  v_cvt_f32_f16 v112, v102
  v_cvt_f32_f16_sdwa v113, v102 dst_sel:DWORD dst_unused:UNUSED_PAD src0_sel:WORD_1
  v_smfmac_f32_16x16x32_bf16 v[72:75], v[40:41], a[116:119], v44
  v_cvt_pk_bf16_f32 v36, v110, v111
  v_cvt_pk_bf16_f32 v37, v112, v113
  v_smfmac_f32_16x16x32_bf16 v[76:79], v[40:41], a[136:139], v44
  v_cvt_f32_f16 v114, v104
  v_cvt_f32_f16_sdwa v115, v104 dst_sel:DWORD dst_unused:UNUSED_PAD src0_sel:WORD_1
  v_smfmac_f32_16x16x32_bf16 v[80:83], v[40:41], a[156:159], v44
  v_cvt_f32_f16 v116, v105
  v_cvt_f32_f16_sdwa v117, v105 dst_sel:DWORD dst_unused:UNUSED_PAD src0_sel:WORD_1
  v_smfmac_f32_16x16x32_bf16 v[84:87], v[40:41], a[176:179], v44
  v_cvt_pk_bf16_f32 v38, v114, v115
  v_cvt_pk_bf16_f32 v39, v116, v117
A2_56:
  v_smfmac_f32_16x16x64_bf16 v[52:55], v[32:35], a[0:7], v44
  v_smfmac_f32_16x16x64_bf16 v[52:55], v[36:39], a[8:15], v44
  v_smfmac_f32_16x16x64_bf16 v[64:67], v[32:35], a[60:67], v44
  v_smfmac_f32_16x16x64_bf16 v[64:67], v[36:39], a[68:75], v44
  v_smfmac_f32_16x16x64_bf16 v[56:59], v[32:35], a[20:27], v44
  v_smfmac_f32_16x16x64_bf16 v[56:59], v[36:39], a[28:35], v44
  v_smfmac_f32_16x16x64_bf16 v[68:71], v[32:35], a[80:87], v44
  v_permlane32_swap_b32 v52, v64
  v_permlane32_swap_b32 v53, v65
  v_permlane32_swap_b32 v54, v66
  v_smfmac_f32_16x16x64_bf16 v[68:71], v[36:39], a[88:95], v44
  v_permlane32_swap_b32 v55, v67
  v_pk_add_f32 v[52:53], v[52:53], v[64:65]
  v_pk_add_f32 v[54:55], v[54:55], v[66:67]
  v_smfmac_f32_16x16x64_bf16 v[60:63], v[32:35], a[40:47], v44
  ds_write2_b32 v5, v52, v53 offset0:0 offset1:4
  ds_write2_b32 v5, v54, v55 offset0:8 offset1:12
  v_smfmac_f32_16x16x64_bf16 v[60:63], v[36:39], a[48:55], v44
  v_smfmac_f32_16x16x64_bf16 v[72:75], v[32:35], a[100:107], v44
  v_permlane32_swap_b32 v56, v68
  v_permlane32_swap_b32 v57, v69
  v_permlane32_swap_b32 v58, v70
  v_smfmac_f32_16x16x64_bf16 v[72:75], v[36:39], a[108:115], v44
  v_permlane32_swap_b32 v59, v71
  v_pk_add_f32 v[56:57], v[56:57], v[68:69]
  v_pk_add_f32 v[58:59], v[58:59], v[70:71]
  v_smfmac_f32_16x16x64_bf16 v[76:79], v[32:35], a[120:127], v44
  ds_write2_b32 v242, v56, v57 offset0:0 offset1:4
  ds_write2_b32 v242, v58, v59 offset0:8 offset1:12
  v_smfmac_f32_16x16x64_bf16 v[76:79], v[36:39], a[128:135], v44
  v_smfmac_f32_16x16x64_bf16 v[80:83], v[32:35], a[140:147], v44
  v_permlane32_swap_b32 v60, v72
  v_permlane32_swap_b32 v61, v73
  v_permlane32_swap_b32 v62, v74
  v_smfmac_f32_16x16x64_bf16 v[80:83], v[36:39], a[148:155], v44
  v_permlane32_swap_b32 v63, v75
  v_pk_add_f32 v[60:61], v[60:61], v[72:73]
  v_pk_add_f32 v[62:63], v[62:63], v[74:75]
  v_smfmac_f32_16x16x64_bf16 v[84:87], v[32:35], a[160:167], v44
  ds_write2_b32 v243, v60, v61 offset0:0 offset1:4
  ds_write2_b32 v243, v62, v63 offset0:8 offset1:12
  v_smfmac_f32_16x16x64_bf16 v[84:87], v[36:39], a[168:175], v44
  v_permlane32_swap_b32 v76, v80
  v_permlane32_swap_b32 v77, v81
  v_permlane32_swap_b32 v78, v82
  v_permlane32_swap_b32 v79, v83
  v_pk_add_f32 v[76:77], v[76:77], v[80:81]
  v_pk_add_f32 v[78:79], v[78:79], v[82:83]
  ds_write2_b32 v244, v76, v77 offset0:0 offset1:4
  ds_write2_b32 v244, v78, v79 offset0:8 offset1:12
  ds_write2_b32 v245, v84, v85 offset0:0 offset1:4
  ds_write2_b32 v245, v86, v87 offset0:8 offset1:12
  s_waitcnt lgkmcnt(0) vmcnt(0)
  s_barrier
  ds_read_b128 v[96:99], v6 offset:0
  ds_read_b128 v[108:111], v6 offset:5440
  ds_read_b128 v[120:123], v6 offset:10880
  ds_read_b128 v[132:135], v6 offset:16320
  ds_read_b128 v[100:103], v6 offset:1088
  ds_read_b128 v[112:115], v6 offset:6528
  ds_read_b128 v[124:127], v6 offset:11968
  ds_read_b128 v[136:139], v6 offset:17408
  ds_read_b128 v[104:107], v6 offset:2176
  ds_read_b128 v[116:119], v6 offset:7616
  ds_read_b128 v[128:131], v6 offset:13056
  ds_read_b128 v[140:143], v6 offset:18496
  s_waitcnt lgkmcnt(8)
  v_pk_add_f32 v[96:97], v[96:97], v[108:109]
  v_pk_add_f32 v[120:121], v[120:121], v[132:133]
  v_pk_add_f32 v[98:99], v[98:99], v[110:111]
  v_pk_add_f32 v[122:123], v[122:123], v[134:135]
  v_pk_add_f32 v[96:97], v[96:97], v[120:121]
  v_pk_add_f32 v[98:99], v[98:99], v[122:123]
  v_cvt_pk_bf16_f32 v212, v96, v97
  v_cvt_pk_bf16_f32 v213, v98, v99
  s_waitcnt lgkmcnt(4)
  v_pk_add_f32 v[100:101], v[100:101], v[112:113]
  v_pk_add_f32 v[124:125], v[124:125], v[136:137]
  v_pk_add_f32 v[102:103], v[102:103], v[114:115]
  v_pk_add_f32 v[126:127], v[126:127], v[138:139]
  v_pk_add_f32 v[100:101], v[100:101], v[124:125]
  v_pk_add_f32 v[102:103], v[102:103], v[126:127]
  v_cvt_pk_bf16_f32 v214, v100, v101
  v_cvt_pk_bf16_f32 v215, v102, v103
  s_waitcnt lgkmcnt(0)
  v_pk_add_f32 v[104:105], v[104:105], v[116:117]
  v_pk_add_f32 v[128:129], v[128:129], v[140:141]
  v_pk_add_f32 v[106:107], v[106:107], v[118:119]
  v_pk_add_f32 v[130:131], v[130:131], v[142:143]
  v_mfma_f32_16x16x32_bf16 v[96:99], v[212:215], v[212:215], 0
  v_pk_add_f32 v[104:105], v[104:105], v[128:129]
  v_pk_add_f32 v[106:107], v[106:107], v[130:131]
  v_cvt_pk_bf16_f32 v216, v104, v105
  v_cvt_pk_bf16_f32 v217, v106, v107
  s_nop 1
  v_mfma_f32_16x16x32_bf16 v[96:99], v[216:219], v[216:219], v[96:99]
  s_mov_b64 exec, s[74:75]
  s_nop 6
  v_cvt_pk_f16_f32 v100, v96, v97
  v_cvt_pk_f16_f32 v101, v98, v99
  v_and_or_b32 v100, v100, -2, s88
  buffer_store_dwordx2 v[100:101], v7, s[8:11], s81 offen
  s_mov_b64 exec, -1
  s_cmp_eq_u32 s52, 63
  s_cbranch_scc1 last_53
  s_sleep 4
  s_mov_b32 s54, 0
  buffer_load_dwordx2 v[248:249], v9, s[8:11], s81 offen sc1
  buffer_load_dwordx4 v[112:115], v8, s[8:11], s81 offen offset:0 sc1
  buffer_load_dwordx4 v[116:119], v8, s[8:11], s81 offen offset:1024 sc1
  s_sleep 2
  buffer_load_dwordx4 v[144:147], v10, s[8:11], s81 offen offset:0 sc1
  buffer_load_dwordx4 v[148:151], v10, s[8:11], s81 offen offset:1024 sc1
  buffer_load_dwordx4 v[152:155], v10, s[8:11], s81 offen offset:2048 sc1
  v_mov_b32 v188, 0
  v_mov_b32 v189, 0
  v_mov_b32 v190, 0
  v_mov_b32 v191, 0
  v_mov_b32 v192, 0
  v_mov_b32 v193, 0
  v_mov_b32 v194, 0
  v_mov_b32 v195, 0
  v_mov_b32 v196, 0
  v_mov_b32 v197, 0
  v_mov_b32 v198, 0
  v_mov_b32 v199, 0
  v_readfirstlane_b32 s21, v94
  s_add_u32 s22, s46, 2
  s_min_u32 s22, s22, 64
  s_sub_u32 s55, s21, s22
  s_sub_u32 s56, s21, s46
  s_waitcnt vmcnt(5)
  v_xor_b32 v96, s88, v248
  s_nop 0
  v_permlane16_swap_b32 v248, v249
  v_fma_mix_f32 v250, v248, 1.0, v249 op_sel:[0,0,0] op_sel_hi:[1,0,1]
  v_fma_mix_f32 v251, v248, 1.0, v249 op_sel:[1,0,1] op_sel_hi:[1,0,1]
  v_mov_b32 v248, v250
  v_mov_b32 v249, v251
  s_nop 0
  v_permlane32_swap_b32 v248, v250
  v_permlane32_swap_b32 v249, v251
  s_waitcnt vmcnt(3)
  v_bitop3_b32 v97, v112, v114, s88 bitop3:0x7e
  v_bitop3_b32 v98, v116, v118, s88 bitop3:0x7e
  v_fma_mix_f32 v120, v112, 1.0, v116 op_sel:[0,0,0] op_sel_hi:[1,0,1]
  v_or3_b32 v27, v96, v97, v98
  v_fma_mix_f32 v124, v114, 1.0, v118 op_sel:[0,0,0] op_sel_hi:[1,0,1]
  v_and_b32 v27, 1, v27
  v_fma_mix_f32 v121, v112, 1.0, v116 op_sel:[1,0,1] op_sel_hi:[1,0,1]
  v_cmp_ne_u32 vcc, 0, v27
  v_fma_mix_f32 v125, v114, 1.0, v118 op_sel:[1,0,1] op_sel_hi:[1,0,1]
  v_fma_mix_f32 v122, v113, 1.0, v117 op_sel:[0,0,0] op_sel_hi:[1,0,1]
  v_fma_mix_f32 v126, v115, 1.0, v119 op_sel:[0,0,0] op_sel_hi:[1,0,1]
  s_cbranch_vccnz psr_58
psj_59:
  s_cmp_lt_i32 s56, 0
  s_cbranch_scc1 kvw_61
kvok_62:
  v_fma_mix_f32 v123, v113, 1.0, v117 op_sel:[1,0,1] op_sel_hi:[1,0,1]
  v_fma_mix_f32 v127, v115, 1.0, v119 op_sel:[1,0,1] op_sel_hi:[1,0,1]
  v_permlane32_swap_b32 v120, v124
  v_permlane32_swap_b32 v121, v125
  v_permlane32_swap_b32 v122, v126
  v_permlane32_swap_b32 v123, v127
  v_pk_add_f32 v[120:121], v[120:121], v[124:125]
  v_pk_add_f32 v[122:123], v[122:123], v[126:127]
  v_pk_add_f32 v[124:125], v[248:249], v[250:251]
  v_max3_f32 v236, v120, v121, v122
  v_max3_f32 v237, v123, v124, v125
  v_max_f32 v236, v236, v237
  s_nop 1
  v_max_f32_dpp v236, v236, v236 row_ror:8 row_mask:0xf bank_mask:0xf
  v_mov_b32 v237, v236
  s_nop 1
  v_permlane32_swap_b32 v236, v237
  v_max_f32 v236, v236, v237
  v_mov_b32 v237, v236
  s_nop 1
  v_permlane16_swap_b32 v236, v237
  v_max_f32 v236, v236, v237
  s_waitcnt vmcnt(0)
  v_max3_u32 v27, v144, v146, v148
  v_max3_u32 v27, v27, v150, v152
  v_max3_u32 v27, v27, v154, v154
  v_cmp_eq_u32 vcc, -1, v27
  s_nop 1
  s_cbranch_vccnz pv_57
pvj_60:
  v_mul_f32 v236, s86, v236
  v_smfmac_f32_16x16x64_bf16 v[188:191], v[144:147], a[180:187], v44
  v_fma_f32 v120, v120, s86, -v236
  v_smfmac_f32_16x16x64_bf16 v[188:191], v[148:151], a[188:195], v44
  v_fma_f32 v121, v121, s86, -v236
  v_smfmac_f32_16x16x64_bf16 v[188:191], v[152:155], a[196:203], v44
  buffer_load_dwordx4 v[160:163], v17, s[28:31], s64 offen offset:0 sc1
  v_fma_f32 v122, v122, s86, -v236
  v_smfmac_f32_16x16x64_bf16 v[192:195], v[144:147], a[204:211], v44
  v_fma_f32 v123, v123, s86, -v236
  v_smfmac_f32_16x16x64_bf16 v[192:195], v[148:151], a[212:219], v44
  buffer_load_dwordx4 v[164:167], v16, s[28:31], s64 offen offset:1024 sc1
  v_fma_f32 v124, v124, s86, -v236
  v_smfmac_f32_16x16x64_bf16 v[192:195], v[152:155], a[220:227], v44
  v_fma_f32 v125, v125, s86, -v236
  v_smfmac_f32_16x16x64_bf16 v[196:199], v[144:147], a[228:235], v44
  buffer_load_dwordx4 v[48:51], v26, s[28:31], s64 offen offset:2048 sc1
  v_exp_f32 v120, v120
  v_smfmac_f32_16x16x64_bf16 v[196:199], v[148:151], a[236:243], v44
  v_exp_f32 v121, v121
  v_smfmac_f32_16x16x64_bf16 v[196:199], v[152:155], a[244:251], v44
  v_exp_f32 v122, v122
  v_exp_f32 v123, v123
  v_exp_f32 v124, v124
  s_cmp_lt_i32 s55, 0
  s_cbranch_scc1 fl_63
fl_64:
  v_exp_f32 v125, v125
  s_mov_b64 exec, s[60:61]
  v_cvt_pk_bf16_f32 v220, v120, v121
  v_cvt_pk_bf16_f32 v221, v122, v123
  v_cvt_pk_bf16_f32 v224, v124, v125
  s_mov_b64 exec, s[62:63]
  v_cvt_pk_bf16_f32 v222, v120, v121
  v_cvt_pk_bf16_f32 v223, v122, v123
  v_cvt_pk_bf16_f32 v225, v124, v125
  s_mov_b64 exec, -1
  v_pk_add_f32 v[126:127], v[120:121], v[122:123]
  v_add_f32 v128, v124, v125
  v_mfma_f32_16x16x32_bf16 v[200:203], v[176:179], v[220:223], 0
  v_add_f32 v236, v126, v127
  v_fmac_f32 v236, v128, v89
  v_cvt_pk_bf16_f32 v228, v188, v189
  v_cvt_pk_bf16_f32 v229, v190, v191
  v_mfma_f32_16x16x32_bf16 v[204:207], v[180:183], v[220:223], 0
  v_cvt_pk_bf16_f32 v230, v192, v193
  v_cvt_pk_bf16_f32 v231, v194, v195
  v_mfma_f32_16x16x32_bf16 v[208:211], v[184:187], v[220:223], 0
  v_cvt_pk_bf16_f32 v232, v196, v197
  v_cvt_pk_bf16_f32 v233, v198, v199
  v_add_f32_dpp v236, v236, v236 row_ror:8 row_mask:0xf bank_mask:0xf
  v_mov_b32 v237, v236
  s_nop 0
  v_mfma_f32_16x16x32_bf16 v[200:203], v[228:231], v[224:227], v[200:203]
  v_mfma_f32_16x16x32_bf16 v[204:207], v[230:233], v[224:227], v[204:207]
  v_permlane32_swap_b32 v236, v237
  v_add_f32 v236, v236, v237
  v_mov_b32 v237, v236
  v_mfma_f32_16x16x32_bf16 v[208:211], v[232:235], v[224:227], v[208:211]
  s_nop 0
  v_permlane16_swap_b32 v236, v237
  v_add_f32 v236, v236, v237
  v_rcp_f32 v236, v236
  s_nop 2
  v_pk_mul_f32 v[200:201], v[200:201], v[236:237] op_sel_hi:[1,0]
  v_pk_mul_f32 v[202:203], v[202:203], v[236:237] op_sel_hi:[1,0]
  ds_write_b128 v11, v[200:203] offset:0
  v_pk_mul_f32 v[204:205], v[204:205], v[236:237] op_sel_hi:[1,0]
  v_pk_mul_f32 v[206:207], v[206:207], v[236:237] op_sel_hi:[1,0]
  ds_write_b128 v11, v[204:207] offset:1024
  v_pk_mul_f32 v[208:209], v[208:209], v[236:237] op_sel_hi:[1,0]
  v_pk_mul_f32 v[210:211], v[210:211], v[236:237] op_sel_hi:[1,0]
  ds_write_b128 v11, v[208:211] offset:2048
  s_waitcnt lgkmcnt(0)
  s_barrier
  ds_read_b64 v[96:97], v12 offset:0
  ds_read_b64 v[98:99], v12 offset:128
  ds_read_b64 v[100:101], v12 offset:3072
  ds_read_b64 v[102:103], v12 offset:3200
  ds_read_b64 v[104:105], v12 offset:6144
  ds_read_b64 v[106:107], v12 offset:6272
  ds_read_b64 v[108:109], v12 offset:9216
  ds_read_b64 v[110:111], v12 offset:9344
  s_waitcnt lgkmcnt(6)
  v_pk_add_f32 v[96:97], v[96:97], v[98:99]
  s_waitcnt lgkmcnt(4)
  v_pk_add_f32 v[100:101], v[100:101], v[102:103]
  s_waitcnt lgkmcnt(2)
  v_pk_add_f32 v[104:105], v[104:105], v[106:107]
  v_pk_add_f32 v[96:97], v[96:97], v[100:101]
  s_waitcnt lgkmcnt(0)
  v_pk_add_f32 v[108:109], v[108:109], v[110:111]
  v_pk_add_f32 v[96:97], v[96:97], v[104:105]
  v_pk_add_f32 v[96:97], v[96:97], v[108:109]
  v_cvt_pk_f16_f32 v100, v96, v97
  v_perm_b32 v100, s91, v100, v14
  buffer_atomic_pk_add_f16 v100, v13, s[4:7], s3 offen
  s_mov_b64 exec, s[62:63]
  buffer_store_dwordx4 v[212:215], v21, s[24:27], s85 offen sc1
  buffer_store_dwordx2 v[216:217], v23, s[24:27], s85 offen sc1
  s_mov_b64 exec, -1
  v_mov_b32 v200, v196
  v_mov_b32 v201, v197
  v_mov_b32 v202, v198
  v_mov_b32 v203, v199
  v_permlane32_swap_b32 v188, v192
  v_permlane32_swap_b32 v189, v193
  v_permlane32_swap_b32 v190, v194
  v_permlane32_swap_b32 v191, v195
  v_permlane32_swap_b32 v196, v200
  v_permlane32_swap_b32 v197, v201
  v_permlane32_swap_b32 v198, v202
  v_permlane32_swap_b32 v199, v203
  v_pk_add_f32 v[188:189], v[188:189], v[192:193]
  v_pk_add_f32 v[190:191], v[190:191], v[194:195]
  v_pk_add_f32 v[196:197], v[196:197], v[200:201]
  v_pk_add_f32 v[198:199], v[198:199], v[202:203]
  v_cvt_pk_bf16_f32 v252, v188, v189
  v_cvt_pk_bf16_f32 v254, v196, v197
  v_cvt_pk_bf16_f32 v253, v190, v191
  v_cvt_pk_bf16_f32 v255, v198, v199
  s_nop 0
  v_permlane16_swap_b32 v252, v254
  v_permlane16_swap_b32 v253, v255
  v_min_u32 v252, -2, v252
  s_mov_b64 exec, s[76:77]
  buffer_store_dwordx4 v[252:255], v15, s[24:27], s57 offen sc1
  s_mov_b64 exec, -1
  s_add_u32 s64, s64, 1310720
  s_add_u32 s52, s52, 1
  s_and_b32 s21, s52, 3
  s_mul_i32 s81, s21, 540672
  s_lshl_b32 s84, s21, 15
  s_branch step_52
pm_54:
  s_mov_b32 s47, 1
  buffer_load_dwordx4 v[96:99], v4, s[4:7], s84 offen offset:0 sc1
  buffer_load_dwordx4 v[100:103], v4, s[4:7], s84 offen offset:1024 sc1
  buffer_load_dwordx4 v[104:107], v4, s[4:7], s84 offen offset:2048 sc1
  s_add_u32 s54, s54, 1
  s_cmp_gt_u32 s54, 131072
  s_cbranch_scc1 end0
  s_waitcnt vmcnt(0)
  v_bitop3_b32 v27, v99, v103, v107 bitop3:0x80
  v_cvt_f32_f16 v108, v99
  v_and_b32 v27, 0x48000000, v27
  v_cvt_f32_f16 v109, v103
  v_cmp_ne_u32 vcc, 0x48000000, v27
  v_cvt_f32_f16 v110, v106
  v_cvt_f32_f16_sdwa v111, v106 dst_sel:DWORD dst_unused:UNUSED_PAD src0_sel:WORD_1
  v_cvt_pk_bf16_f32 v40, v110, v111
  s_cbranch_vccnz pm_54
  s_branch pm_55
A1_16:
  v_smfmac_f32_16x16x32_bf16 v[52:55], v[40:41], a[16:19], v44
  v_smfmac_f32_16x16x32_bf16 v[64:67], v[40:41], a[76:79], v44
  v_smfmac_f32_16x16x32_bf16 v[56:59], v[40:41], a[36:39], v44
  v_smfmac_f32_16x16x32_bf16 v[68:71], v[40:41], a[96:99], v44
  v_smfmac_f32_16x16x32_bf16 v[60:63], v[40:41], a[56:59], v44
  v_smfmac_f32_16x16x32_bf16 v[72:75], v[40:41], a[116:119], v44
  v_smfmac_f32_16x16x32_bf16 v[76:79], v[40:41], a[136:139], v44
  v_smfmac_f32_16x16x32_bf16 v[80:83], v[40:41], a[156:159], v44
  v_smfmac_f32_16x16x32_bf16 v[84:87], v[40:41], a[176:179], v44
  s_branch A2_56
pv_57:
  buffer_load_dwordx4 v[144:147], v10, s[8:11], s81 offen offset:0 sc1
  buffer_load_dwordx4 v[148:151], v10, s[8:11], s81 offen offset:1024 sc1
  buffer_load_dwordx4 v[152:155], v10, s[8:11], s81 offen offset:2048 sc1
  s_add_u32 s54, s54, 1
  s_cmp_gt_u32 s54, 131072
  s_cbranch_scc1 end0
  s_waitcnt vmcnt(0)
  v_max3_u32 v27, v144, v146, v148
  v_max3_u32 v27, v27, v150, v152
  v_max3_u32 v27, v27, v154, v154
  v_cmp_eq_u32 vcc, -1, v27
  s_nop 1
  s_cbranch_vccnz pv_57
  s_branch pvj_60
psr_58:
  buffer_load_dwordx2 v[248:249], v9, s[8:11], s81 offen sc1
  buffer_load_dwordx4 v[112:115], v8, s[8:11], s81 offen offset:0 sc1
  buffer_load_dwordx4 v[116:119], v8, s[8:11], s81 offen offset:1024 sc1
  s_add_u32 s54, s54, 1
  s_cmp_gt_u32 s54, 131072
  s_cbranch_scc1 end0
  s_waitcnt vmcnt(2)
  v_xor_b32 v96, s88, v248
  s_nop 0
  v_permlane16_swap_b32 v248, v249
  v_fma_mix_f32 v250, v248, 1.0, v249 op_sel:[0,0,0] op_sel_hi:[1,0,1]
  v_fma_mix_f32 v251, v248, 1.0, v249 op_sel:[1,0,1] op_sel_hi:[1,0,1]
  v_mov_b32 v248, v250
  v_mov_b32 v249, v251
  s_nop 0
  v_permlane32_swap_b32 v248, v250
  v_permlane32_swap_b32 v249, v251
  s_waitcnt vmcnt(0)
  v_bitop3_b32 v97, v112, v114, s88 bitop3:0x7e
  v_bitop3_b32 v98, v116, v118, s88 bitop3:0x7e
  v_fma_mix_f32 v120, v112, 1.0, v116 op_sel:[0,0,0] op_sel_hi:[1,0,1]
  v_or3_b32 v27, v96, v97, v98
  v_fma_mix_f32 v124, v114, 1.0, v118 op_sel:[0,0,0] op_sel_hi:[1,0,1]
  v_and_b32 v27, 1, v27
  v_fma_mix_f32 v121, v112, 1.0, v116 op_sel:[1,0,1] op_sel_hi:[1,0,1]
  v_cmp_ne_u32 vcc, 0, v27
  v_fma_mix_f32 v125, v114, 1.0, v118 op_sel:[1,0,1] op_sel_hi:[1,0,1]
  v_fma_mix_f32 v122, v113, 1.0, v117 op_sel:[0,0,0] op_sel_hi:[1,0,1]
  v_fma_mix_f32 v126, v115, 1.0, v119 op_sel:[0,0,0] op_sel_hi:[1,0,1]
  s_cbranch_vccnz psr_58
  s_branch psj_59
kvw_61:
  s_cmp_eq_u32 s52, 0
  s_cselect_b32 s23, 1, s46
  s_cselect_b32 s55, 0, s55
  v_mov_b32 v236, 0
  s_mov_b32 s101, 0
wf_65:
  buffer_load_dword v237, v236, s[12:15], s79 offen sc1
  s_add_u32 s101, s101, 1
  s_cmp_gt_u32 s101, 131072
  s_cbranch_scc1 end0
  s_waitcnt vmcnt(0)
  v_readfirstlane_b32 s100, v237
  s_cmp_ge_u32 s100, s23
  s_cbranch_scc1 wf_66
  s_sleep 3
  s_branch wf_65
wf_66:
  s_cmp_gt_u32 s52, 1
  s_cbranch_scc1 kvok_62
  s_sub_u32 s21, s64, 1310720
  buffer_load_dwordx4 v[176:179], v16, s[28:31], s21 offen offset:0 sc1
  buffer_load_dwordx4 v[180:183], v16, s[28:31], s21 offen offset:1024 sc1
  buffer_load_dwordx4 v[184:187], v16, s[28:31], s21 offen offset:2048 sc1
  s_waitcnt vmcnt(0)
  s_branch kvok_62
fl_63:
  buffer_load_dword v94, v95, s[12:15], s79 offen sc1
  s_branch fl_64
last_53:
  s_mov_b64 exec, s[62:63]
  buffer_store_dwordx4 v[212:215], v21, s[24:27], s85 offen sc1
  buffer_store_dwordx2 v[216:217], v23, s[24:27], s85 offen sc1
  s_mov_b64 exec, -1
  v_mov_b32 v188, 0
  v_mov_b32 v189, 0
  v_mov_b32 v190, 0
  v_mov_b32 v191, 0
  v_mov_b32 v192, 0
  v_mov_b32 v193, 0
  v_mov_b32 v194, 0
  v_mov_b32 v195, 0
  v_mov_b32 v196, 0
  v_mov_b32 v197, 0
  v_mov_b32 v198, 0
  v_mov_b32 v199, 0
  s_sleep 4
  s_mov_b32 s54, 0
lv_67:
  buffer_load_dwordx4 v[144:147], v10, s[8:11], s81 offen offset:0 sc1
  buffer_load_dwordx4 v[148:151], v10, s[8:11], s81 offen offset:1024 sc1
  buffer_load_dwordx4 v[152:155], v10, s[8:11], s81 offen offset:2048 sc1
  s_add_u32 s54, s54, 1
  s_cmp_gt_u32 s54, 131072
  s_cbranch_scc1 end0
  s_waitcnt vmcnt(0)
  v_max3_u32 v27, v144, v146, v148
  v_max3_u32 v27, v27, v150, v152
  v_max3_u32 v27, v27, v154, v154
  v_cmp_eq_u32 vcc, -1, v27
  s_nop 1
  s_cbranch_vccnz lv_67
  v_smfmac_f32_16x16x64_bf16 v[188:191], v[144:147], a[180:187], v44
  v_smfmac_f32_16x16x64_bf16 v[192:195], v[144:147], a[204:211], v44
  v_smfmac_f32_16x16x64_bf16 v[196:199], v[144:147], a[228:235], v44
  v_smfmac_f32_16x16x64_bf16 v[188:191], v[148:151], a[188:195], v44
  v_smfmac_f32_16x16x64_bf16 v[192:195], v[148:151], a[212:219], v44
  v_smfmac_f32_16x16x64_bf16 v[196:199], v[148:151], a[236:243], v44
  v_smfmac_f32_16x16x64_bf16 v[188:191], v[152:155], a[196:203], v44
  v_smfmac_f32_16x16x64_bf16 v[192:195], v[152:155], a[220:227], v44
  v_smfmac_f32_16x16x64_bf16 v[196:199], v[152:155], a[244:251], v44
  v_mov_b32 v236, 64
  s_mov_b64 exec, 1
  buffer_store_dword v236, v95, s[12:15], s90 offen sc1
  s_mov_b64 exec, -1
  s_nop 7
  v_mov_b32 v200, v196
  v_mov_b32 v201, v197
  v_mov_b32 v202, v198
  v_mov_b32 v203, v199
  v_permlane32_swap_b32 v188, v192
  v_permlane32_swap_b32 v189, v193
  v_permlane32_swap_b32 v190, v194
  v_permlane32_swap_b32 v191, v195
  v_permlane32_swap_b32 v196, v200
  v_permlane32_swap_b32 v197, v201
  v_permlane32_swap_b32 v198, v202
  v_permlane32_swap_b32 v199, v203
  v_pk_add_f32 v[188:189], v[188:189], v[192:193]
  v_pk_add_f32 v[190:191], v[190:191], v[194:195]
  v_pk_add_f32 v[196:197], v[196:197], v[200:201]
  v_pk_add_f32 v[198:199], v[198:199], v[202:203]
  v_cvt_pk_bf16_f32 v252, v188, v189
  v_cvt_pk_bf16_f32 v254, v196, v197
  v_cvt_pk_bf16_f32 v253, v190, v191
  v_cvt_pk_bf16_f32 v255, v198, v199
  s_nop 0
  v_permlane16_swap_b32 v252, v254
  v_permlane16_swap_b32 v253, v255
  v_min_u32 v252, -2, v252
  s_mov_b64 exec, s[76:77]
  buffer_store_dwordx4 v[252:255], v15, s[24:27], s57 offen sc1
  s_mov_b64 exec, -1
  s_branch chain_done
step_68:
  s_add_u32 s21, s52, 2
  s_and_b32 s21, s21, 3
  s_mul_i32 s82, s21, 540672
  s_add_u32 s21, s52, 3
  s_and_b32 s21, s21, 3
  s_lshl_b32 s83, s21, 15
  s_add_u32 s21, s52, 1
  s_and_b32 s22, s21, 3
  s_lshl_b32 s3, s22, 15
  s_mul_i32 s80, s21, 393216
  s_add_u32 s46, s21, 1
  s_min_u32 s46, s46, 64
  s_mul_i32 s85, s52, 98304
  s_mul_i32 s57, s52, 327680
  s_add_u32 s57, s57, 42991616

  s_bfe_u32 s88, s52, 0x10002
  s_add_u32 s78, s81, 278528
  s_max_u32 s21, s52, 1
  s_sub_u32 s21, s21, 1
  s_cmp_lt_u32 s52, 60
  s_cselect_b32 s66, s65, 0x80000000
  s_cselect_b32 s68, 15, 1
  s_cmp_ge_u32 s52, 61
  s_cselect_b32 s66, s90, s66
  s_cselect_b32 s67, s52, s21
  v_mov_b32 v52, 0
  v_mov_b32 v53, 0
  v_mov_b32 v54, 0
  v_mov_b32 v55, 0
  v_mov_b32 v56, 0
  v_mov_b32 v57, 0
  v_mov_b32 v58, 0
  v_mov_b32 v59, 0
  v_mov_b32 v60, 0
  v_mov_b32 v61, 0
  v_mov_b32 v62, 0
  v_mov_b32 v63, 0
  v_mov_b32 v64, 0
  v_mov_b32 v65, 0
  v_mov_b32 v66, 0
  v_mov_b32 v67, 0
  v_mov_b32 v68, 0
  v_mov_b32 v69, 0
  v_mov_b32 v70, 0
  v_mov_b32 v71, 0
  v_mov_b32 v72, 0
  v_mov_b32 v73, 0
  v_mov_b32 v74, 0
  v_mov_b32 v75, 0
  v_mov_b32 v76, 0
  v_mov_b32 v77, 0
  v_mov_b32 v78, 0
  v_mov_b32 v79, 0
  v_mov_b32 v80, 0
  v_mov_b32 v81, 0
  v_mov_b32 v82, 0
  v_mov_b32 v83, 0
  v_mov_b32 v84, 0
  v_mov_b32 v85, 0
  v_mov_b32 v86, 0
  v_mov_b32 v87, 0
  s_sleep 7
  s_mov_b32 s54, 0
  buffer_load_dwordx4 v[96:99], v4, s[4:7], s84 offen offset:0 sc1
  buffer_load_dwordx4 v[100:103], v4, s[4:7], s84 offen offset:1024 sc1
  buffer_load_dwordx4 v[104:107], v4, s[4:7], s84 offen offset:2048 sc1
  s_waitcnt vmcnt(3)
  v_mov_b32 v176, v160
  v_mov_b32 v177, v161
  v_mov_b32 v178, v162
  v_mov_b32 v179, v163
  v_mov_b32 v180, v164
  v_mov_b32 v181, v165
  v_mov_b32 v182, v166
  v_mov_b32 v183, v167
  v_mov_b32 v184, v48
  v_mov_b32 v185, v49
  v_mov_b32 v186, v50
  v_mov_b32 v187, v51
  s_waitcnt vmcnt(0)
  v_bitop3_b32 v27, v99, v103, v107 bitop3:0x80
  v_cvt_f32_f16 v108, v99
  v_and_b32 v27, 0x48000000, v27
  v_cvt_f32_f16 v109, v103
  v_cmp_ne_u32 vcc, 0x48000000, v27
  v_cvt_f32_f16 v110, v106
  v_cvt_f32_f16_sdwa v111, v106 dst_sel:DWORD dst_unused:UNUSED_PAD src0_sel:WORD_1
  v_cvt_pk_bf16_f32 v40, v110, v111
  s_cbranch_vccnz pm_70
pm_71:
  v_cvt_pk_bf16_f32 v41, v108, v109
  v_cvt_f32_f16 v110, v96
  v_cvt_f32_f16_sdwa v111, v96 dst_sel:DWORD dst_unused:UNUSED_PAD src0_sel:WORD_1
  v_smfmac_f32_16x16x32_bf16 v[52:55], v[40:41], a[16:19], v44
  v_cvt_f32_f16 v112, v97
  v_cvt_f32_f16_sdwa v113, v97 dst_sel:DWORD dst_unused:UNUSED_PAD src0_sel:WORD_1
  v_cvt_pk_bf16_f32 v32, v110, v111
  v_smfmac_f32_16x16x32_bf16 v[64:67], v[40:41], a[76:79], v44
  v_cvt_pk_bf16_f32 v33, v112, v113
  v_cvt_f32_f16 v114, v98
  v_cvt_f32_f16_sdwa v115, v98 dst_sel:DWORD dst_unused:UNUSED_PAD src0_sel:WORD_1
  v_smfmac_f32_16x16x32_bf16 v[56:59], v[40:41], a[36:39], v44
  v_cvt_f32_f16 v116, v100
  v_cvt_f32_f16_sdwa v117, v100 dst_sel:DWORD dst_unused:UNUSED_PAD src0_sel:WORD_1
  v_cvt_pk_bf16_f32 v34, v114, v115
  v_smfmac_f32_16x16x32_bf16 v[68:71], v[40:41], a[96:99], v44
  v_cvt_pk_bf16_f32 v35, v116, v117
  v_cvt_f32_f16 v110, v101
  v_cvt_f32_f16_sdwa v111, v101 dst_sel:DWORD dst_unused:UNUSED_PAD src0_sel:WORD_1
  v_smfmac_f32_16x16x32_bf16 v[60:63], v[40:41], a[56:59], v44
  v_cvt_f32_f16 v112, v102
  v_cvt_f32_f16_sdwa v113, v102 dst_sel:DWORD dst_unused:UNUSED_PAD src0_sel:WORD_1
  v_smfmac_f32_16x16x32_bf16 v[72:75], v[40:41], a[116:119], v44
  v_cvt_pk_bf16_f32 v36, v110, v111
  v_cvt_pk_bf16_f32 v37, v112, v113
  v_smfmac_f32_16x16x32_bf16 v[76:79], v[40:41], a[136:139], v44
  v_cvt_f32_f16 v114, v104
  v_cvt_f32_f16_sdwa v115, v104 dst_sel:DWORD dst_unused:UNUSED_PAD src0_sel:WORD_1
  v_smfmac_f32_16x16x32_bf16 v[80:83], v[40:41], a[156:159], v44
  v_cvt_f32_f16 v116, v105
  v_cvt_f32_f16_sdwa v117, v105 dst_sel:DWORD dst_unused:UNUSED_PAD src0_sel:WORD_1
  v_smfmac_f32_16x16x32_bf16 v[84:87], v[40:41], a[176:179], v44
  v_cvt_pk_bf16_f32 v38, v114, v115
  v_cvt_pk_bf16_f32 v39, v116, v117
A2_72:
  v_smfmac_f32_16x16x64_bf16 v[52:55], v[32:35], a[0:7], v44
  v_smfmac_f32_16x16x64_bf16 v[52:55], v[36:39], a[8:15], v44
  v_smfmac_f32_16x16x64_bf16 v[64:67], v[32:35], a[60:67], v44
  v_smfmac_f32_16x16x64_bf16 v[64:67], v[36:39], a[68:75], v44
  v_smfmac_f32_16x16x64_bf16 v[56:59], v[32:35], a[20:27], v44
  v_smfmac_f32_16x16x64_bf16 v[56:59], v[36:39], a[28:35], v44
  v_smfmac_f32_16x16x64_bf16 v[68:71], v[32:35], a[80:87], v44
  v_permlane32_swap_b32 v52, v64
  v_permlane32_swap_b32 v53, v65
  v_permlane32_swap_b32 v54, v66
  v_smfmac_f32_16x16x64_bf16 v[68:71], v[36:39], a[88:95], v44
  v_permlane32_swap_b32 v55, v67
  v_pk_add_f32 v[52:53], v[52:53], v[64:65]
  v_pk_add_f32 v[54:55], v[54:55], v[66:67]
  v_smfmac_f32_16x16x64_bf16 v[60:63], v[32:35], a[40:47], v44
  ds_write2_b32 v5, v52, v53 offset0:0 offset1:4
  ds_write2_b32 v5, v54, v55 offset0:8 offset1:12
  v_smfmac_f32_16x16x64_bf16 v[60:63], v[36:39], a[48:55], v44
  v_smfmac_f32_16x16x64_bf16 v[72:75], v[32:35], a[100:107], v44
  v_permlane32_swap_b32 v56, v68
  v_permlane32_swap_b32 v57, v69
  v_permlane32_swap_b32 v58, v70
  v_smfmac_f32_16x16x64_bf16 v[72:75], v[36:39], a[108:115], v44
  v_permlane32_swap_b32 v59, v71
  v_pk_add_f32 v[56:57], v[56:57], v[68:69]
  v_pk_add_f32 v[58:59], v[58:59], v[70:71]
  v_smfmac_f32_16x16x64_bf16 v[76:79], v[32:35], a[120:127], v44
  ds_write2_b32 v242, v56, v57 offset0:0 offset1:4
  ds_write2_b32 v242, v58, v59 offset0:8 offset1:12
  v_smfmac_f32_16x16x64_bf16 v[76:79], v[36:39], a[128:135], v44
  v_smfmac_f32_16x16x64_bf16 v[80:83], v[32:35], a[140:147], v44
  v_permlane32_swap_b32 v60, v72
  v_permlane32_swap_b32 v61, v73
  v_permlane32_swap_b32 v62, v74
  v_smfmac_f32_16x16x64_bf16 v[80:83], v[36:39], a[148:155], v44
  v_permlane32_swap_b32 v63, v75
  v_pk_add_f32 v[60:61], v[60:61], v[72:73]
  v_pk_add_f32 v[62:63], v[62:63], v[74:75]
  v_smfmac_f32_16x16x64_bf16 v[84:87], v[32:35], a[160:167], v44
  ds_write2_b32 v243, v60, v61 offset0:0 offset1:4
  ds_write2_b32 v243, v62, v63 offset0:8 offset1:12
  v_smfmac_f32_16x16x64_bf16 v[84:87], v[36:39], a[168:175], v44
  v_permlane32_swap_b32 v76, v80
  v_permlane32_swap_b32 v77, v81
  v_permlane32_swap_b32 v78, v82
  v_permlane32_swap_b32 v79, v83
  v_pk_add_f32 v[76:77], v[76:77], v[80:81]
  v_pk_add_f32 v[78:79], v[78:79], v[82:83]
  ds_write2_b32 v244, v76, v77 offset0:0 offset1:4
  ds_write2_b32 v244, v78, v79 offset0:8 offset1:12
  ds_write2_b32 v245, v84, v85 offset0:0 offset1:4
  ds_write2_b32 v245, v86, v87 offset0:8 offset1:12
  s_waitcnt lgkmcnt(0) vmcnt(0)
  s_barrier
  ds_read_b128 v[96:99], v6 offset:3264
  ds_read_b128 v[100:103], v6 offset:8704
  ds_read_b128 v[104:107], v6 offset:14144
  ds_read_b128 v[108:111], v6 offset:19584
  ds_read_b128 v[112:115], v6 offset:4352
  ds_read_b128 v[116:119], v6 offset:9792
  ds_read_b128 v[120:123], v6 offset:15232
  ds_read_b128 v[124:127], v6 offset:20672
  s_waitcnt lgkmcnt(4)
  v_pk_add_f32 v[96:97], v[96:97], v[100:101]
  v_pk_add_f32 v[98:99], v[98:99], v[102:103]
  v_pk_add_f32 v[104:105], v[104:105], v[108:109]
  v_pk_add_f32 v[106:107], v[106:107], v[110:111]
  v_pk_add_f32 v[96:97], v[96:97], v[104:105]
  v_pk_add_f32 v[98:99], v[98:99], v[106:107]
  v_cvt_pk_bf16_f32 v90, v96, v97
  v_cvt_pk_bf16_f32 v91, v98, v99
  v_min_u32 v90, -2, v90
  v_min_u32 v91, -2, v91
  buffer_store_dwordx2 v[90:91], v24, s[8:11], s81 offen
  s_waitcnt lgkmcnt(0)
  v_pk_add_f32 v[112:113], v[112:113], v[116:117]
  v_pk_add_f32 v[114:115], v[114:115], v[118:119]
  v_pk_add_f32 v[120:121], v[120:121], v[124:125]
  v_pk_add_f32 v[122:123], v[122:123], v[126:127]
  v_pk_add_f32 v[112:113], v[112:113], v[120:121]
  v_pk_add_f32 v[114:115], v[114:115], v[122:123]
  s_nop 1
  v_add_f32_dpp v116, v112, v112 row_ror:8 row_mask:0xf bank_mask:0xf
  v_add_f32_dpp v117, v113, v113 row_ror:8 row_mask:0xf bank_mask:0xf
  v_add_f32_dpp v118, v114, v114 row_ror:8 row_mask:0xf bank_mask:0xf
  v_add_f32_dpp v119, v115, v115 row_ror:8 row_mask:0xf bank_mask:0xf
  v_cvt_pk_bf16_f32 v92, v116, v117
  v_cvt_pk_bf16_f32 v93, v118, v119
  v_min_u32 v92, -2, v92
  v_min_u32 v93, -2, v93
  s_mov_b64 exec, s[60:61]
  buffer_store_dwordx2 v[92:93], v23, s[8:11], s78 offen
  s_mov_b64 exec, -1
  s_cmp_eq_u32 s52, 63
  s_cbranch_scc1 last_69
  s_sleep 5
  s_mov_b32 s54, 0
  buffer_load_dwordx2 v[248:249], v9, s[8:11], s81 offen sc1
  buffer_load_dwordx4 v[112:115], v8, s[8:11], s81 offen offset:0 sc1
  buffer_load_dwordx4 v[116:119], v8, s[8:11], s81 offen offset:1024 sc1
  s_sleep 2
  buffer_load_dwordx4 v[144:147], v10, s[8:11], s81 offen offset:0 sc1
  buffer_load_dwordx4 v[148:151], v10, s[8:11], s81 offen offset:1024 sc1
  buffer_load_dwordx4 v[152:155], v10, s[8:11], s81 offen offset:2048 sc1
  v_mov_b32 v188, 0
  v_mov_b32 v189, 0
  v_mov_b32 v190, 0
  v_mov_b32 v191, 0
  v_mov_b32 v192, 0
  v_mov_b32 v193, 0
  v_mov_b32 v194, 0
  v_mov_b32 v195, 0
  v_mov_b32 v196, 0
  v_mov_b32 v197, 0
  v_mov_b32 v198, 0
  v_mov_b32 v199, 0
  v_readfirstlane_b32 s21, v94
  s_add_u32 s22, s46, 2
  s_min_u32 s22, s22, 64
  s_sub_u32 s55, s21, s22
  s_sub_u32 s56, s21, s46
  s_waitcnt vmcnt(5)
  v_xor_b32 v96, s88, v248
  s_nop 0
  v_permlane16_swap_b32 v248, v249
  v_fma_mix_f32 v250, v248, 1.0, v249 op_sel:[0,0,0] op_sel_hi:[1,0,1]
  v_fma_mix_f32 v251, v248, 1.0, v249 op_sel:[1,0,1] op_sel_hi:[1,0,1]
  v_mov_b32 v248, v250
  v_mov_b32 v249, v251
  s_nop 0
  v_permlane32_swap_b32 v248, v250
  v_permlane32_swap_b32 v249, v251
  s_waitcnt vmcnt(3)
  v_bitop3_b32 v97, v112, v114, s88 bitop3:0x7e
  v_bitop3_b32 v98, v116, v118, s88 bitop3:0x7e
  v_fma_mix_f32 v120, v112, 1.0, v116 op_sel:[0,0,0] op_sel_hi:[1,0,1]
  v_or3_b32 v27, v96, v97, v98
  v_fma_mix_f32 v124, v114, 1.0, v118 op_sel:[0,0,0] op_sel_hi:[1,0,1]
  v_and_b32 v27, 1, v27
  v_fma_mix_f32 v121, v112, 1.0, v116 op_sel:[1,0,1] op_sel_hi:[1,0,1]
  v_cmp_ne_u32 vcc, 0, v27
  v_fma_mix_f32 v125, v114, 1.0, v118 op_sel:[1,0,1] op_sel_hi:[1,0,1]
  v_fma_mix_f32 v122, v113, 1.0, v117 op_sel:[0,0,0] op_sel_hi:[1,0,1]
  v_fma_mix_f32 v126, v115, 1.0, v119 op_sel:[0,0,0] op_sel_hi:[1,0,1]
  s_cbranch_vccnz psr_74
psj_75:
  s_cmp_lt_i32 s56, 0
  s_cbranch_scc1 kvw_77
kvok_78:
  v_fma_mix_f32 v123, v113, 1.0, v117 op_sel:[1,0,1] op_sel_hi:[1,0,1]
  v_fma_mix_f32 v127, v115, 1.0, v119 op_sel:[1,0,1] op_sel_hi:[1,0,1]
  v_permlane32_swap_b32 v120, v124
  v_permlane32_swap_b32 v121, v125
  v_permlane32_swap_b32 v122, v126
  v_permlane32_swap_b32 v123, v127
  v_pk_add_f32 v[120:121], v[120:121], v[124:125]
  v_pk_add_f32 v[122:123], v[122:123], v[126:127]
  v_pk_add_f32 v[124:125], v[248:249], v[250:251]
  v_max3_f32 v236, v120, v121, v122
  v_max3_f32 v237, v123, v124, v125
  v_max_f32 v236, v236, v237
  s_nop 1
  v_max_f32_dpp v236, v236, v236 row_ror:8 row_mask:0xf bank_mask:0xf
  v_mov_b32 v237, v236
  s_nop 1
  v_permlane32_swap_b32 v236, v237
  v_max_f32 v236, v236, v237
  v_mov_b32 v237, v236
  s_nop 1
  v_permlane16_swap_b32 v236, v237
  v_max_f32 v236, v236, v237
  s_waitcnt vmcnt(0)
  v_max3_u32 v27, v144, v146, v148
  v_max3_u32 v27, v27, v150, v152
  v_max3_u32 v27, v27, v154, v154
  v_cmp_eq_u32 vcc, -1, v27
  s_nop 1
  s_cbranch_vccnz pv_73
pvj_76:
  v_mul_f32 v236, s86, v236
  v_smfmac_f32_16x16x64_bf16 v[188:191], v[144:147], a[180:187], v44
  v_fma_f32 v120, v120, s86, -v236
  v_smfmac_f32_16x16x64_bf16 v[188:191], v[148:151], a[188:195], v44
  v_fma_f32 v121, v121, s86, -v236
  v_smfmac_f32_16x16x64_bf16 v[188:191], v[152:155], a[196:203], v44
  buffer_load_dwordx4 v[160:163], v17, s[28:31], s64 offen offset:0 sc1
  v_fma_f32 v122, v122, s86, -v236
  v_smfmac_f32_16x16x64_bf16 v[192:195], v[144:147], a[204:211], v44
  v_fma_f32 v123, v123, s86, -v236
  v_smfmac_f32_16x16x64_bf16 v[192:195], v[148:151], a[212:219], v44
  buffer_load_dwordx4 v[164:167], v16, s[28:31], s64 offen offset:1024 sc1
  v_fma_f32 v124, v124, s86, -v236
  v_smfmac_f32_16x16x64_bf16 v[192:195], v[152:155], a[220:227], v44
  v_fma_f32 v125, v125, s86, -v236
  v_smfmac_f32_16x16x64_bf16 v[196:199], v[144:147], a[228:235], v44
  buffer_load_dwordx4 v[48:51], v26, s[28:31], s64 offen offset:2048 sc1
  v_exp_f32 v120, v120
  v_smfmac_f32_16x16x64_bf16 v[196:199], v[148:151], a[236:243], v44
  v_exp_f32 v121, v121
  v_smfmac_f32_16x16x64_bf16 v[196:199], v[152:155], a[244:251], v44
  v_exp_f32 v122, v122
  v_exp_f32 v123, v123
  v_mov_b32 v240, s67
  v_mov_b32 v241, s67
  s_mov_b64 exec, s[68:69]
  buffer_store_dwordx2 v[240:241], v88, s[12:15], s66 offen sc1
  s_mov_b64 exec, -1
  v_exp_f32 v124, v124
  s_cmp_lt_i32 s55, 0
  s_cbranch_scc1 fl_79
fl_80:
  v_exp_f32 v125, v125
  s_mov_b64 exec, s[60:61]
  v_cvt_pk_bf16_f32 v220, v120, v121
  v_cvt_pk_bf16_f32 v221, v122, v123
  v_cvt_pk_bf16_f32 v224, v124, v125
  s_mov_b64 exec, s[62:63]
  v_cvt_pk_bf16_f32 v222, v120, v121
  v_cvt_pk_bf16_f32 v223, v122, v123
  v_cvt_pk_bf16_f32 v225, v124, v125
  s_mov_b64 exec, -1
  v_pk_add_f32 v[126:127], v[120:121], v[122:123]
  v_add_f32 v128, v124, v125
  v_mfma_f32_16x16x32_bf16 v[200:203], v[176:179], v[220:223], 0
  v_add_f32 v236, v126, v127
  v_fmac_f32 v236, v128, v89
  v_cvt_pk_bf16_f32 v228, v188, v189
  v_cvt_pk_bf16_f32 v229, v190, v191
  v_mfma_f32_16x16x32_bf16 v[204:207], v[180:183], v[220:223], 0
  v_cvt_pk_bf16_f32 v230, v192, v193
  v_cvt_pk_bf16_f32 v231, v194, v195
  v_mfma_f32_16x16x32_bf16 v[208:211], v[184:187], v[220:223], 0
  v_cvt_pk_bf16_f32 v232, v196, v197
  v_cvt_pk_bf16_f32 v233, v198, v199
  v_add_f32_dpp v236, v236, v236 row_ror:8 row_mask:0xf bank_mask:0xf
  v_mov_b32 v237, v236
  s_nop 0
  v_mfma_f32_16x16x32_bf16 v[200:203], v[228:231], v[224:227], v[200:203]
  v_mfma_f32_16x16x32_bf16 v[204:207], v[230:233], v[224:227], v[204:207]
  v_permlane32_swap_b32 v236, v237
  v_add_f32 v236, v236, v237
  v_mov_b32 v237, v236
  v_mfma_f32_16x16x32_bf16 v[208:211], v[232:235], v[224:227], v[208:211]
  s_nop 0
  v_permlane16_swap_b32 v236, v237
  v_add_f32 v236, v236, v237
  v_rcp_f32 v236, v236
  s_nop 2
  v_pk_mul_f32 v[200:201], v[200:201], v[236:237] op_sel_hi:[1,0]
  v_pk_mul_f32 v[202:203], v[202:203], v[236:237] op_sel_hi:[1,0]
  ds_write_b128 v11, v[200:203] offset:0
  v_pk_mul_f32 v[204:205], v[204:205], v[236:237] op_sel_hi:[1,0]
  v_pk_mul_f32 v[206:207], v[206:207], v[236:237] op_sel_hi:[1,0]
  ds_write_b128 v11, v[204:207] offset:1024
  v_pk_mul_f32 v[208:209], v[208:209], v[236:237] op_sel_hi:[1,0]
  v_pk_mul_f32 v[210:211], v[210:211], v[236:237] op_sel_hi:[1,0]
  ds_write_b128 v11, v[208:211] offset:2048
  s_waitcnt lgkmcnt(0)
  s_barrier
  v_mov_b32 v28, -1
  v_mov_b32 v29, -1
  buffer_store_dwordx2 v[28:29], v24, s[8:11], s82 offen
  s_mov_b64 exec, s[60:61]
  s_add_u32 s22, s82, 278528
  buffer_store_dwordx2 v[28:29], v23, s[8:11], s22 offen
  s_and_b32 s21, s52, 7
  s_cmp_lg_u32 s21, s50
  s_cbranch_scc1 zm_81
  s_mov_b64 exec, s[70:71]
  buffer_store_dwordx4 v[156:159], v13, s[4:7], s83 offen sc1
zm_81:
  s_mov_b64 exec, -1
  v_mov_b32 v200, v196
  v_mov_b32 v201, v197
  v_mov_b32 v202, v198
  v_mov_b32 v203, v199
  v_permlane32_swap_b32 v188, v192
  v_permlane32_swap_b32 v189, v193
  v_permlane32_swap_b32 v190, v194
  v_permlane32_swap_b32 v191, v195
  v_permlane32_swap_b32 v196, v200
  v_permlane32_swap_b32 v197, v201
  v_permlane32_swap_b32 v198, v202
  v_permlane32_swap_b32 v199, v203
  v_pk_add_f32 v[188:189], v[188:189], v[192:193]
  v_pk_add_f32 v[190:191], v[190:191], v[194:195]
  v_pk_add_f32 v[196:197], v[196:197], v[200:201]
  v_pk_add_f32 v[198:199], v[198:199], v[202:203]
  v_cvt_pk_bf16_f32 v252, v188, v189
  v_cvt_pk_bf16_f32 v254, v196, v197
  v_cvt_pk_bf16_f32 v253, v190, v191
  v_cvt_pk_bf16_f32 v255, v198, v199
  s_nop 0
  v_permlane16_swap_b32 v252, v254
  v_permlane16_swap_b32 v253, v255
  v_min_u32 v252, -2, v252
  s_mov_b64 exec, s[76:77]
  buffer_store_dwordx4 v[252:255], v15, s[24:27], s57 offen sc1
  s_mov_b64 exec, -1
  s_add_u32 s64, s64, 1310720
  s_add_u32 s52, s52, 1
  s_and_b32 s21, s52, 3
  s_mul_i32 s81, s21, 540672
  s_lshl_b32 s84, s21, 15
  s_branch step_68
pm_70:
  s_mov_b32 s47, 1
  buffer_load_dwordx4 v[96:99], v4, s[4:7], s84 offen offset:0 sc1
  buffer_load_dwordx4 v[100:103], v4, s[4:7], s84 offen offset:1024 sc1
  buffer_load_dwordx4 v[104:107], v4, s[4:7], s84 offen offset:2048 sc1
  s_add_u32 s54, s54, 1
  s_cmp_gt_u32 s54, 131072
  s_cbranch_scc1 end0
  s_waitcnt vmcnt(0)
  v_bitop3_b32 v27, v99, v103, v107 bitop3:0x80
  v_cvt_f32_f16 v108, v99
  v_and_b32 v27, 0x48000000, v27
  v_cvt_f32_f16 v109, v103
  v_cmp_ne_u32 vcc, 0x48000000, v27
  v_cvt_f32_f16 v110, v106
  v_cvt_f32_f16_sdwa v111, v106 dst_sel:DWORD dst_unused:UNUSED_PAD src0_sel:WORD_1
  v_cvt_pk_bf16_f32 v40, v110, v111
  s_cbranch_vccnz pm_70
  s_branch pm_71
A1_17:
  v_smfmac_f32_16x16x32_bf16 v[52:55], v[40:41], a[16:19], v44
  v_smfmac_f32_16x16x32_bf16 v[64:67], v[40:41], a[76:79], v44
  v_smfmac_f32_16x16x32_bf16 v[56:59], v[40:41], a[36:39], v44
  v_smfmac_f32_16x16x32_bf16 v[68:71], v[40:41], a[96:99], v44
  v_smfmac_f32_16x16x32_bf16 v[60:63], v[40:41], a[56:59], v44
  v_smfmac_f32_16x16x32_bf16 v[72:75], v[40:41], a[116:119], v44
  v_smfmac_f32_16x16x32_bf16 v[76:79], v[40:41], a[136:139], v44
  v_smfmac_f32_16x16x32_bf16 v[80:83], v[40:41], a[156:159], v44
  v_smfmac_f32_16x16x32_bf16 v[84:87], v[40:41], a[176:179], v44
  s_branch A2_72
pv_73:
  buffer_load_dwordx4 v[144:147], v10, s[8:11], s81 offen offset:0 sc1
  buffer_load_dwordx4 v[148:151], v10, s[8:11], s81 offen offset:1024 sc1
  buffer_load_dwordx4 v[152:155], v10, s[8:11], s81 offen offset:2048 sc1
  s_add_u32 s54, s54, 1
  s_cmp_gt_u32 s54, 131072
  s_cbranch_scc1 end0
  s_waitcnt vmcnt(0)
  v_max3_u32 v27, v144, v146, v148
  v_max3_u32 v27, v27, v150, v152
  v_max3_u32 v27, v27, v154, v154
  v_cmp_eq_u32 vcc, -1, v27
  s_nop 1
  s_cbranch_vccnz pv_73
  s_branch pvj_76
psr_74:
  buffer_load_dwordx2 v[248:249], v9, s[8:11], s81 offen sc1
  buffer_load_dwordx4 v[112:115], v8, s[8:11], s81 offen offset:0 sc1
  buffer_load_dwordx4 v[116:119], v8, s[8:11], s81 offen offset:1024 sc1
  s_add_u32 s54, s54, 1
  s_cmp_gt_u32 s54, 131072
  s_cbranch_scc1 end0
  s_waitcnt vmcnt(2)
  v_xor_b32 v96, s88, v248
  s_nop 0
  v_permlane16_swap_b32 v248, v249
  v_fma_mix_f32 v250, v248, 1.0, v249 op_sel:[0,0,0] op_sel_hi:[1,0,1]
  v_fma_mix_f32 v251, v248, 1.0, v249 op_sel:[1,0,1] op_sel_hi:[1,0,1]
  v_mov_b32 v248, v250
  v_mov_b32 v249, v251
  s_nop 0
  v_permlane32_swap_b32 v248, v250
  v_permlane32_swap_b32 v249, v251
  s_waitcnt vmcnt(0)
  v_bitop3_b32 v97, v112, v114, s88 bitop3:0x7e
  v_bitop3_b32 v98, v116, v118, s88 bitop3:0x7e
  v_fma_mix_f32 v120, v112, 1.0, v116 op_sel:[0,0,0] op_sel_hi:[1,0,1]
  v_or3_b32 v27, v96, v97, v98
  v_fma_mix_f32 v124, v114, 1.0, v118 op_sel:[0,0,0] op_sel_hi:[1,0,1]
  v_and_b32 v27, 1, v27
  v_fma_mix_f32 v121, v112, 1.0, v116 op_sel:[1,0,1] op_sel_hi:[1,0,1]
  v_cmp_ne_u32 vcc, 0, v27
  v_fma_mix_f32 v125, v114, 1.0, v118 op_sel:[1,0,1] op_sel_hi:[1,0,1]
  v_fma_mix_f32 v122, v113, 1.0, v117 op_sel:[0,0,0] op_sel_hi:[1,0,1]
  v_fma_mix_f32 v126, v115, 1.0, v119 op_sel:[0,0,0] op_sel_hi:[1,0,1]
  s_cbranch_vccnz psr_74
  s_branch psj_75
kvw_77:
  s_cmp_eq_u32 s52, 0
  s_cselect_b32 s23, 1, s46
  s_cselect_b32 s55, 0, s55
  v_mov_b32 v236, 0
  s_mov_b32 s101, 0
wf_82:
  buffer_load_dword v237, v236, s[12:15], s79 offen sc1
  s_add_u32 s101, s101, 1
  s_cmp_gt_u32 s101, 131072
  s_cbranch_scc1 end0
  s_waitcnt vmcnt(0)
  v_readfirstlane_b32 s100, v237
  s_cmp_ge_u32 s100, s23
  s_cbranch_scc1 wf_83
  s_sleep 3
  s_branch wf_82
wf_83:
  s_cmp_gt_u32 s52, 1
  s_cbranch_scc1 kvok_78
  s_sub_u32 s21, s64, 1310720
  buffer_load_dwordx4 v[176:179], v16, s[28:31], s21 offen offset:0 sc1
  buffer_load_dwordx4 v[180:183], v16, s[28:31], s21 offen offset:1024 sc1
  buffer_load_dwordx4 v[184:187], v16, s[28:31], s21 offen offset:2048 sc1
  s_waitcnt vmcnt(0)
  s_branch kvok_78
fl_79:
  buffer_load_dword v94, v95, s[12:15], s79 offen sc1
  s_branch fl_80
last_69:
  v_mov_b32 v188, 0
  v_mov_b32 v189, 0
  v_mov_b32 v190, 0
  v_mov_b32 v191, 0
  v_mov_b32 v192, 0
  v_mov_b32 v193, 0
  v_mov_b32 v194, 0
  v_mov_b32 v195, 0
  v_mov_b32 v196, 0
  v_mov_b32 v197, 0
  v_mov_b32 v198, 0
  v_mov_b32 v199, 0
  s_sleep 4
  s_mov_b32 s54, 0
lv_84:
  buffer_load_dwordx4 v[144:147], v10, s[8:11], s81 offen offset:0 sc1
  buffer_load_dwordx4 v[148:151], v10, s[8:11], s81 offen offset:1024 sc1
  buffer_load_dwordx4 v[152:155], v10, s[8:11], s81 offen offset:2048 sc1
  s_add_u32 s54, s54, 1
  s_cmp_gt_u32 s54, 131072
  s_cbranch_scc1 end0
  s_waitcnt vmcnt(0)
  v_max3_u32 v27, v144, v146, v148
  v_max3_u32 v27, v27, v150, v152
  v_max3_u32 v27, v27, v154, v154
  v_cmp_eq_u32 vcc, -1, v27
  s_nop 1
  s_cbranch_vccnz lv_84
  v_smfmac_f32_16x16x64_bf16 v[188:191], v[144:147], a[180:187], v44
  v_smfmac_f32_16x16x64_bf16 v[192:195], v[144:147], a[204:211], v44
  v_smfmac_f32_16x16x64_bf16 v[196:199], v[144:147], a[228:235], v44
  v_smfmac_f32_16x16x64_bf16 v[188:191], v[148:151], a[188:195], v44
  v_smfmac_f32_16x16x64_bf16 v[192:195], v[148:151], a[212:219], v44
  v_smfmac_f32_16x16x64_bf16 v[196:199], v[148:151], a[236:243], v44
  v_smfmac_f32_16x16x64_bf16 v[188:191], v[152:155], a[196:203], v44
  v_smfmac_f32_16x16x64_bf16 v[192:195], v[152:155], a[220:227], v44
  v_smfmac_f32_16x16x64_bf16 v[196:199], v[152:155], a[244:251], v44
  s_nop 7
  v_mov_b32 v200, v196
  v_mov_b32 v201, v197
  v_mov_b32 v202, v198
  v_mov_b32 v203, v199
  v_permlane32_swap_b32 v188, v192
  v_permlane32_swap_b32 v189, v193
  v_permlane32_swap_b32 v190, v194
  v_permlane32_swap_b32 v191, v195
  v_permlane32_swap_b32 v196, v200
  v_permlane32_swap_b32 v197, v201
  v_permlane32_swap_b32 v198, v202
  v_permlane32_swap_b32 v199, v203
  v_pk_add_f32 v[188:189], v[188:189], v[192:193]
  v_pk_add_f32 v[190:191], v[190:191], v[194:195]
  v_pk_add_f32 v[196:197], v[196:197], v[200:201]
  v_pk_add_f32 v[198:199], v[198:199], v[202:203]
  v_cvt_pk_bf16_f32 v252, v188, v189
  v_cvt_pk_bf16_f32 v254, v196, v197
  v_cvt_pk_bf16_f32 v253, v190, v191
  v_cvt_pk_bf16_f32 v255, v198, v199
  s_nop 0
  v_permlane16_swap_b32 v252, v254
  v_permlane16_swap_b32 v253, v255
  v_min_u32 v252, -2, v252
  s_mov_b64 exec, s[76:77]
  buffer_store_dwordx4 v[252:255], v15, s[24:27], s57 offen sc1
  s_mov_b64 exec, -1
  s_branch chain_done
step_85:
  s_add_u32 s21, s52, 2
  s_and_b32 s21, s21, 3
  s_mul_i32 s82, s21, 540672
  s_add_u32 s21, s52, 3
  s_and_b32 s21, s21, 3
  s_lshl_b32 s83, s21, 15
  s_add_u32 s21, s52, 1
  s_and_b32 s22, s21, 3
  s_lshl_b32 s3, s22, 15
  s_mul_i32 s80, s21, 393216
  s_add_u32 s46, s21, 1
  s_min_u32 s46, s46, 64
  s_mul_i32 s85, s52, 98304
  s_mul_i32 s57, s52, 327680
  s_add_u32 s57, s57, 42991616

  s_bfe_u32 s88, s52, 0x10002
  s_add_u32 s78, s81, 278528
  s_max_u32 s21, s52, 1
  s_sub_u32 s21, s21, 1
  s_cmp_lt_u32 s52, 60
  s_cselect_b32 s66, s65, 0x80000000
  s_cselect_b32 s68, 15, 1
  s_cmp_ge_u32 s52, 61
  s_cselect_b32 s66, s90, s66
  s_cselect_b32 s67, s52, s21
  v_mov_b32 v52, 0
  v_mov_b32 v53, 0
  v_mov_b32 v54, 0
  v_mov_b32 v55, 0
  v_mov_b32 v56, 0
  v_mov_b32 v57, 0
  v_mov_b32 v58, 0
  v_mov_b32 v59, 0
  v_mov_b32 v60, 0
  v_mov_b32 v61, 0
  v_mov_b32 v62, 0
  v_mov_b32 v63, 0
  v_mov_b32 v64, 0
  v_mov_b32 v65, 0
  v_mov_b32 v66, 0
  v_mov_b32 v67, 0
  v_mov_b32 v68, 0
  v_mov_b32 v69, 0
  v_mov_b32 v70, 0
  v_mov_b32 v71, 0
  v_mov_b32 v72, 0
  v_mov_b32 v73, 0
  v_mov_b32 v74, 0
  v_mov_b32 v75, 0
  v_mov_b32 v76, 0
  v_mov_b32 v77, 0
  v_mov_b32 v78, 0
  v_mov_b32 v79, 0
  v_mov_b32 v80, 0
  v_mov_b32 v81, 0
  v_mov_b32 v82, 0
  v_mov_b32 v83, 0
  v_mov_b32 v84, 0
  v_mov_b32 v85, 0
  v_mov_b32 v86, 0
  v_mov_b32 v87, 0
  s_sleep 8
  s_mov_b32 s54, 0
  buffer_load_dwordx4 v[96:99], v4, s[4:7], s84 offen offset:0 sc1
  buffer_load_dwordx4 v[100:103], v4, s[4:7], s84 offen offset:1024 sc1
  buffer_load_dwordx4 v[104:107], v4, s[4:7], s84 offen offset:2048 sc1
  s_waitcnt vmcnt(3)
  v_mov_b32 v176, v160
  v_mov_b32 v177, v161
  v_mov_b32 v178, v162
  v_mov_b32 v179, v163
  v_mov_b32 v180, v164
  v_mov_b32 v181, v165
  v_mov_b32 v182, v166
  v_mov_b32 v183, v167
  v_mov_b32 v184, v48
  v_mov_b32 v185, v49
  v_mov_b32 v186, v50
  v_mov_b32 v187, v51
  s_waitcnt vmcnt(0)
  v_bitop3_b32 v27, v99, v103, v107 bitop3:0x80
  v_cvt_f32_f16 v108, v99
  v_and_b32 v27, 0x48000000, v27
  v_cvt_f32_f16 v109, v103
  v_cmp_ne_u32 vcc, 0x48000000, v27
  v_cvt_f32_f16 v110, v106
  v_cvt_f32_f16_sdwa v111, v106 dst_sel:DWORD dst_unused:UNUSED_PAD src0_sel:WORD_1
  v_cvt_pk_bf16_f32 v40, v110, v111
  s_cbranch_vccnz pm_87
pm_88:
  v_cvt_pk_bf16_f32 v41, v108, v109
  v_cvt_f32_f16 v110, v96
  v_cvt_f32_f16_sdwa v111, v96 dst_sel:DWORD dst_unused:UNUSED_PAD src0_sel:WORD_1
  v_smfmac_f32_16x16x32_bf16 v[52:55], v[40:41], a[16:19], v44
  v_cvt_f32_f16 v112, v97
  v_cvt_f32_f16_sdwa v113, v97 dst_sel:DWORD dst_unused:UNUSED_PAD src0_sel:WORD_1
  v_cvt_pk_bf16_f32 v32, v110, v111
  v_smfmac_f32_16x16x32_bf16 v[64:67], v[40:41], a[76:79], v44
  v_cvt_pk_bf16_f32 v33, v112, v113
  v_cvt_f32_f16 v114, v98
  v_cvt_f32_f16_sdwa v115, v98 dst_sel:DWORD dst_unused:UNUSED_PAD src0_sel:WORD_1
  v_smfmac_f32_16x16x32_bf16 v[56:59], v[40:41], a[36:39], v44
  v_cvt_f32_f16 v116, v100
  v_cvt_f32_f16_sdwa v117, v100 dst_sel:DWORD dst_unused:UNUSED_PAD src0_sel:WORD_1
  v_cvt_pk_bf16_f32 v34, v114, v115
  v_smfmac_f32_16x16x32_bf16 v[68:71], v[40:41], a[96:99], v44
  v_cvt_pk_bf16_f32 v35, v116, v117
  v_cvt_f32_f16 v110, v101
  v_cvt_f32_f16_sdwa v111, v101 dst_sel:DWORD dst_unused:UNUSED_PAD src0_sel:WORD_1
  v_smfmac_f32_16x16x32_bf16 v[60:63], v[40:41], a[56:59], v44
  v_cvt_f32_f16 v112, v102
  v_cvt_f32_f16_sdwa v113, v102 dst_sel:DWORD dst_unused:UNUSED_PAD src0_sel:WORD_1
  v_smfmac_f32_16x16x32_bf16 v[72:75], v[40:41], a[116:119], v44
  v_cvt_pk_bf16_f32 v36, v110, v111
  v_cvt_pk_bf16_f32 v37, v112, v113
  v_smfmac_f32_16x16x32_bf16 v[76:79], v[40:41], a[136:139], v44
  v_cvt_f32_f16 v114, v104
  v_cvt_f32_f16_sdwa v115, v104 dst_sel:DWORD dst_unused:UNUSED_PAD src0_sel:WORD_1
  v_smfmac_f32_16x16x32_bf16 v[80:83], v[40:41], a[156:159], v44
  v_cvt_f32_f16 v116, v105
  v_cvt_f32_f16_sdwa v117, v105 dst_sel:DWORD dst_unused:UNUSED_PAD src0_sel:WORD_1
  v_smfmac_f32_16x16x32_bf16 v[84:87], v[40:41], a[176:179], v44
  v_cvt_pk_bf16_f32 v38, v114, v115
  v_cvt_pk_bf16_f32 v39, v116, v117
A2_89:
  v_smfmac_f32_16x16x64_bf16 v[52:55], v[32:35], a[0:7], v44
  v_smfmac_f32_16x16x64_bf16 v[52:55], v[36:39], a[8:15], v44
  v_smfmac_f32_16x16x64_bf16 v[64:67], v[32:35], a[60:67], v44
  v_smfmac_f32_16x16x64_bf16 v[64:67], v[36:39], a[68:75], v44
  v_smfmac_f32_16x16x64_bf16 v[56:59], v[32:35], a[20:27], v44
  v_smfmac_f32_16x16x64_bf16 v[56:59], v[36:39], a[28:35], v44
  v_smfmac_f32_16x16x64_bf16 v[68:71], v[32:35], a[80:87], v44
  v_permlane32_swap_b32 v52, v64
  v_permlane32_swap_b32 v53, v65
  v_permlane32_swap_b32 v54, v66
  v_smfmac_f32_16x16x64_bf16 v[68:71], v[36:39], a[88:95], v44
  v_permlane32_swap_b32 v55, v67
  v_pk_add_f32 v[52:53], v[52:53], v[64:65]
  v_pk_add_f32 v[54:55], v[54:55], v[66:67]
  v_smfmac_f32_16x16x64_bf16 v[60:63], v[32:35], a[40:47], v44
  ds_write2_b32 v5, v52, v53 offset0:0 offset1:4
  ds_write2_b32 v5, v54, v55 offset0:8 offset1:12
  v_smfmac_f32_16x16x64_bf16 v[60:63], v[36:39], a[48:55], v44
  v_smfmac_f32_16x16x64_bf16 v[72:75], v[32:35], a[100:107], v44
  v_permlane32_swap_b32 v56, v68
  v_permlane32_swap_b32 v57, v69
  v_permlane32_swap_b32 v58, v70
  v_smfmac_f32_16x16x64_bf16 v[72:75], v[36:39], a[108:115], v44
  v_permlane32_swap_b32 v59, v71
  v_pk_add_f32 v[56:57], v[56:57], v[68:69]
  v_pk_add_f32 v[58:59], v[58:59], v[70:71]
  v_smfmac_f32_16x16x64_bf16 v[76:79], v[32:35], a[120:127], v44
  ds_write2_b32 v242, v56, v57 offset0:0 offset1:4
  ds_write2_b32 v242, v58, v59 offset0:8 offset1:12
  v_smfmac_f32_16x16x64_bf16 v[76:79], v[36:39], a[128:135], v44
  v_smfmac_f32_16x16x64_bf16 v[80:83], v[32:35], a[140:147], v44
  v_permlane32_swap_b32 v60, v72
  v_permlane32_swap_b32 v61, v73
  v_permlane32_swap_b32 v62, v74
  v_smfmac_f32_16x16x64_bf16 v[80:83], v[36:39], a[148:155], v44
  v_permlane32_swap_b32 v63, v75
  v_pk_add_f32 v[60:61], v[60:61], v[72:73]
  v_pk_add_f32 v[62:63], v[62:63], v[74:75]
  v_smfmac_f32_16x16x64_bf16 v[84:87], v[32:35], a[160:167], v44
  ds_write2_b32 v243, v60, v61 offset0:0 offset1:4
  ds_write2_b32 v243, v62, v63 offset0:8 offset1:12
  v_smfmac_f32_16x16x64_bf16 v[84:87], v[36:39], a[168:175], v44
  v_permlane32_swap_b32 v76, v80
  v_permlane32_swap_b32 v77, v81
  v_permlane32_swap_b32 v78, v82
  v_permlane32_swap_b32 v79, v83
  v_pk_add_f32 v[76:77], v[76:77], v[80:81]
  v_pk_add_f32 v[78:79], v[78:79], v[82:83]
  ds_write2_b32 v244, v76, v77 offset0:0 offset1:4
  ds_write2_b32 v244, v78, v79 offset0:8 offset1:12
  ds_write2_b32 v245, v84, v85 offset0:0 offset1:4
  ds_write2_b32 v245, v86, v87 offset0:8 offset1:12
  s_waitcnt lgkmcnt(0) vmcnt(0)
  s_barrier
  s_lshr_b32 s21, 3, s20
  s_bitcmp1_b32 s21, 0
  s_cbranch_scc0 bw_91
  ds_read_b128 v[96:99], v45 offset:0
  ds_read_b128 v[108:111], v45 offset:5440
  ds_read_b128 v[100:103], v45 offset:1088
  ds_read_b128 v[112:115], v45 offset:6528
  ds_read_b128 v[104:107], v45 offset:2176
  ds_read_b128 v[116:119], v45 offset:7616
  s_waitcnt lgkmcnt(4)
  v_pk_add_f32 v[96:97], v[96:97], v[108:109]
  v_pk_add_f32 v[98:99], v[98:99], v[110:111]
  s_nop 0
  v_add_f32_dpp v108, v96, v96 row_ror:8 row_mask:0xf bank_mask:0xf
  v_add_f32_dpp v109, v97, v97 row_ror:8 row_mask:0xf bank_mask:0xf
  v_add_f32_dpp v110, v98, v98 row_ror:8 row_mask:0xf bank_mask:0xf
  v_add_f32_dpp v111, v99, v99 row_ror:8 row_mask:0xf bank_mask:0xf
  v_cvt_pk_bf16_f32 v212, v108, v109
  v_cvt_pk_bf16_f32 v213, v110, v111
  s_waitcnt lgkmcnt(2)
  v_pk_add_f32 v[100:101], v[100:101], v[112:113]
  v_pk_add_f32 v[102:103], v[102:103], v[114:115]
  s_nop 0
  v_add_f32_dpp v112, v100, v100 row_ror:8 row_mask:0xf bank_mask:0xf
  v_add_f32_dpp v113, v101, v101 row_ror:8 row_mask:0xf bank_mask:0xf
  v_add_f32_dpp v114, v102, v102 row_ror:8 row_mask:0xf bank_mask:0xf
  v_add_f32_dpp v115, v103, v103 row_ror:8 row_mask:0xf bank_mask:0xf
  v_cvt_pk_bf16_f32 v214, v112, v113
  v_cvt_pk_bf16_f32 v215, v114, v115
  s_waitcnt lgkmcnt(0)
  v_pk_add_f32 v[104:105], v[104:105], v[116:117]
  v_pk_add_f32 v[106:107], v[106:107], v[118:119]
  v_mfma_f32_16x16x32_bf16 v[96:99], v[168:171], v[212:215], 0
  v_add_f32_dpp v116, v104, v104 row_ror:8 row_mask:0xf bank_mask:0xf
  v_add_f32_dpp v117, v105, v105 row_ror:8 row_mask:0xf bank_mask:0xf
  v_add_f32_dpp v118, v106, v106 row_ror:8 row_mask:0xf bank_mask:0xf
  v_add_f32_dpp v119, v107, v107 row_ror:8 row_mask:0xf bank_mask:0xf
  v_cvt_pk_bf16_f32 v216, v116, v117
  v_cvt_pk_bf16_f32 v217, v118, v119
  s_nop 1
  v_mfma_f32_16x16x32_bf16 v[96:99], v[172:175], v[216:219], v[96:99]
  s_mov_b64 exec, s[74:75]
  s_nop 6
  v_cvt_pk_f16_f32 v100, v96, v97
  v_cvt_pk_f16_f32 v101, v98, v99
  v_and_or_b32 v100, v100, -2, s88
  s_cmp_eq_u32 s53, 1
  s_cbranch_scc1 si_92
  buffer_store_dwordx2 v[100:101], v7, s[8:11], s81 offen sc1
  s_branch si_93
si_92:
  buffer_store_dwordx2 v[100:101], v7, s[8:11], s81 offen
si_93:
  s_mov_b64 exec, -1
  s_branch bw_90
bw_91:
  s_lshr_b32 s21, 4, s20
  s_bitcmp1_b32 s21, 0
  s_cbranch_scc0 bw_94
  ds_read_b128 v[96:99], v6 offset:0
  ds_read_b128 v[108:111], v6 offset:5440
  ds_read_b128 v[120:123], v6 offset:10880
  ds_read_b128 v[132:135], v6 offset:16320
  ds_read_b128 v[100:103], v6 offset:1088
  ds_read_b128 v[112:115], v6 offset:6528
  ds_read_b128 v[124:127], v6 offset:11968
  ds_read_b128 v[136:139], v6 offset:17408
  ds_read_b128 v[104:107], v6 offset:2176
  ds_read_b128 v[116:119], v6 offset:7616
  ds_read_b128 v[128:131], v6 offset:13056
  ds_read_b128 v[140:143], v6 offset:18496
  s_waitcnt lgkmcnt(8)
  v_pk_add_f32 v[96:97], v[96:97], v[108:109]
  v_pk_add_f32 v[120:121], v[120:121], v[132:133]
  v_pk_add_f32 v[98:99], v[98:99], v[110:111]
  v_pk_add_f32 v[122:123], v[122:123], v[134:135]
  v_pk_add_f32 v[96:97], v[96:97], v[120:121]
  v_pk_add_f32 v[98:99], v[98:99], v[122:123]
  v_cvt_pk_bf16_f32 v212, v96, v97
  v_cvt_pk_bf16_f32 v213, v98, v99
  s_waitcnt lgkmcnt(4)
  v_pk_add_f32 v[100:101], v[100:101], v[112:113]
  v_pk_add_f32 v[124:125], v[124:125], v[136:137]
  v_pk_add_f32 v[102:103], v[102:103], v[114:115]
  v_pk_add_f32 v[126:127], v[126:127], v[138:139]
  v_pk_add_f32 v[100:101], v[100:101], v[124:125]
  v_pk_add_f32 v[102:103], v[102:103], v[126:127]
  v_cvt_pk_bf16_f32 v214, v100, v101
  v_cvt_pk_bf16_f32 v215, v102, v103
  s_waitcnt lgkmcnt(0)
  v_pk_add_f32 v[104:105], v[104:105], v[116:117]
  v_pk_add_f32 v[128:129], v[128:129], v[140:141]
  v_pk_add_f32 v[106:107], v[106:107], v[118:119]
  v_pk_add_f32 v[130:131], v[130:131], v[142:143]
  v_mfma_f32_16x16x32_bf16 v[96:99], v[212:215], v[212:215], 0
  v_pk_add_f32 v[104:105], v[104:105], v[128:129]
  v_pk_add_f32 v[106:107], v[106:107], v[130:131]
  v_cvt_pk_bf16_f32 v216, v104, v105
  v_cvt_pk_bf16_f32 v217, v106, v107
  s_nop 1
  v_mfma_f32_16x16x32_bf16 v[96:99], v[216:219], v[216:219], v[96:99]
  s_mov_b64 exec, s[74:75]
  s_nop 6
  v_cvt_pk_f16_f32 v100, v96, v97
  v_cvt_pk_f16_f32 v101, v98, v99
  v_and_or_b32 v100, v100, -2, s88
  s_cmp_eq_u32 s53, 1
  s_cbranch_scc1 si_95
  buffer_store_dwordx2 v[100:101], v7, s[8:11], s81 offen sc1
  s_branch si_96
si_95:
  buffer_store_dwordx2 v[100:101], v7, s[8:11], s81 offen
si_96:
  s_mov_b64 exec, -1
  s_branch bw_90
bw_94:
  s_lshr_b32 s21, 8, s20
  s_bitcmp1_b32 s21, 0
  s_cbranch_scc0 bw_97
  ds_read_b128 v[96:99], v6 offset:3264
  ds_read_b128 v[100:103], v6 offset:8704
  ds_read_b128 v[104:107], v6 offset:14144
  ds_read_b128 v[108:111], v6 offset:19584
  ds_read_b128 v[112:115], v6 offset:4352
  ds_read_b128 v[116:119], v6 offset:9792
  ds_read_b128 v[120:123], v6 offset:15232
  ds_read_b128 v[124:127], v6 offset:20672
  s_waitcnt lgkmcnt(4)
  v_pk_add_f32 v[96:97], v[96:97], v[100:101]
  v_pk_add_f32 v[98:99], v[98:99], v[102:103]
  v_pk_add_f32 v[104:105], v[104:105], v[108:109]
  v_pk_add_f32 v[106:107], v[106:107], v[110:111]
  v_pk_add_f32 v[96:97], v[96:97], v[104:105]
  v_pk_add_f32 v[98:99], v[98:99], v[106:107]
  v_cvt_pk_bf16_f32 v90, v96, v97
  v_cvt_pk_bf16_f32 v91, v98, v99
  v_min_u32 v90, -2, v90
  v_min_u32 v91, -2, v91
  s_cmp_eq_u32 s53, 1
  s_cbranch_scc1 si_98
  buffer_store_dwordx2 v[90:91], v24, s[8:11], s81 offen sc1
  s_branch si_99
si_98:
  buffer_store_dwordx2 v[90:91], v24, s[8:11], s81 offen
si_99:
  s_waitcnt lgkmcnt(0)
  v_pk_add_f32 v[112:113], v[112:113], v[116:117]
  v_pk_add_f32 v[114:115], v[114:115], v[118:119]
  v_pk_add_f32 v[120:121], v[120:121], v[124:125]
  v_pk_add_f32 v[122:123], v[122:123], v[126:127]
  v_pk_add_f32 v[112:113], v[112:113], v[120:121]
  v_pk_add_f32 v[114:115], v[114:115], v[122:123]
  s_nop 1
  v_add_f32_dpp v116, v112, v112 row_ror:8 row_mask:0xf bank_mask:0xf
  v_add_f32_dpp v117, v113, v113 row_ror:8 row_mask:0xf bank_mask:0xf
  v_add_f32_dpp v118, v114, v114 row_ror:8 row_mask:0xf bank_mask:0xf
  v_add_f32_dpp v119, v115, v115 row_ror:8 row_mask:0xf bank_mask:0xf
  v_cvt_pk_bf16_f32 v92, v116, v117
  v_cvt_pk_bf16_f32 v93, v118, v119
  v_min_u32 v92, -2, v92
  v_min_u32 v93, -2, v93
  s_mov_b64 exec, s[60:61]
  s_cmp_eq_u32 s53, 1
  s_cbranch_scc1 si_100
  buffer_store_dwordx2 v[92:93], v23, s[8:11], s78 offen sc1
  s_branch si_101
si_100:
  buffer_store_dwordx2 v[92:93], v23, s[8:11], s78 offen
si_101:
  s_mov_b64 exec, -1
  s_branch bw_90
bw_97:
bw_90:
  s_cmp_eq_u32 s52, 63
  s_cbranch_scc1 last_86
  s_mov_b32 s54, 0
pv_102:
  buffer_load_dwordx4 v[144:147], v10, s[8:11], s81 offen offset:0 sc1
  buffer_load_dwordx4 v[148:151], v10, s[8:11], s81 offen offset:1024 sc1
  buffer_load_dwordx4 v[152:155], v10, s[8:11], s81 offen offset:2048 sc1
  v_mov_b32 v188, 0
  v_mov_b32 v189, 0
  v_mov_b32 v190, 0
  v_mov_b32 v191, 0
  v_mov_b32 v192, 0
  v_mov_b32 v193, 0
  v_mov_b32 v194, 0
  v_mov_b32 v195, 0
  v_mov_b32 v196, 0
  v_mov_b32 v197, 0
  v_mov_b32 v198, 0
  v_mov_b32 v199, 0
  s_add_u32 s54, s54, 1
  s_cmp_gt_u32 s54, 131072
  s_cbranch_scc1 end0
  s_waitcnt vmcnt(0)
  v_max3_u32 v27, v144, v146, v148
  v_max3_u32 v27, v27, v150, v152
  v_max3_u32 v27, v27, v154, v154
  v_cmp_eq_u32 vcc, -1, v27
  s_nop 1
  s_cbranch_vccnz pv_102
  buffer_load_dwordx2 v[248:249], v9, s[8:11], s81 offen sc1
  buffer_load_dwordx4 v[112:115], v8, s[8:11], s81 offen offset:0 sc1
  buffer_load_dwordx4 v[116:119], v8, s[8:11], s81 offen offset:1024 sc1
  v_smfmac_f32_16x16x64_bf16 v[188:191], v[144:147], a[180:187], v44
  v_smfmac_f32_16x16x64_bf16 v[192:195], v[144:147], a[204:211], v44
  v_smfmac_f32_16x16x64_bf16 v[196:199], v[144:147], a[228:235], v44
  v_smfmac_f32_16x16x64_bf16 v[188:191], v[148:151], a[188:195], v44
  v_smfmac_f32_16x16x64_bf16 v[192:195], v[148:151], a[212:219], v44
  v_smfmac_f32_16x16x64_bf16 v[196:199], v[148:151], a[236:243], v44
  v_smfmac_f32_16x16x64_bf16 v[188:191], v[152:155], a[196:203], v44
  v_smfmac_f32_16x16x64_bf16 v[192:195], v[152:155], a[220:227], v44
  v_smfmac_f32_16x16x64_bf16 v[196:199], v[152:155], a[244:251], v44
  v_readfirstlane_b32 s21, v94
  s_add_u32 s22, s46, 2
  s_min_u32 s22, s22, 64
  s_sub_u32 s55, s21, s22
  s_sub_u32 s56, s21, s46
  s_waitcnt vmcnt(2)
  v_xor_b32 v96, s88, v248
  s_nop 0
  v_permlane16_swap_b32 v248, v249
  v_fma_mix_f32 v250, v248, 1.0, v249 op_sel:[0,0,0] op_sel_hi:[1,0,1]
  v_fma_mix_f32 v251, v248, 1.0, v249 op_sel:[1,0,1] op_sel_hi:[1,0,1]
  v_mov_b32 v248, v250
  v_mov_b32 v249, v251
  s_nop 0
  v_permlane32_swap_b32 v248, v250
  v_permlane32_swap_b32 v249, v251
  s_waitcnt vmcnt(0)
  v_bitop3_b32 v97, v112, v114, s88 bitop3:0x7e
  v_bitop3_b32 v98, v116, v118, s88 bitop3:0x7e
  v_fma_mix_f32 v120, v112, 1.0, v116 op_sel:[0,0,0] op_sel_hi:[1,0,1]
  v_or3_b32 v27, v96, v97, v98
  v_fma_mix_f32 v124, v114, 1.0, v118 op_sel:[0,0,0] op_sel_hi:[1,0,1]
  v_and_b32 v27, 1, v27
  v_fma_mix_f32 v121, v112, 1.0, v116 op_sel:[1,0,1] op_sel_hi:[1,0,1]
  v_cmp_ne_u32 vcc, 0, v27
  v_fma_mix_f32 v125, v114, 1.0, v118 op_sel:[1,0,1] op_sel_hi:[1,0,1]
  v_fma_mix_f32 v122, v113, 1.0, v117 op_sel:[0,0,0] op_sel_hi:[1,0,1]
  v_fma_mix_f32 v126, v115, 1.0, v119 op_sel:[0,0,0] op_sel_hi:[1,0,1]
  s_cbranch_vccnz psr_103
psj_104:
  s_cmp_lt_i32 s56, 0
  s_cbranch_scc1 kvw_105
kvok_106:
  buffer_load_dwordx4 v[160:163], v17, s[28:31], s64 offen offset:0 sc1
  v_fma_mix_f32 v123, v113, 1.0, v117 op_sel:[1,0,1] op_sel_hi:[1,0,1]
  buffer_load_dwordx4 v[164:167], v16, s[28:31], s64 offen offset:1024 sc1
  v_fma_mix_f32 v127, v115, 1.0, v119 op_sel:[1,0,1] op_sel_hi:[1,0,1]
  buffer_load_dwordx4 v[48:51], v26, s[28:31], s64 offen offset:2048 sc1
  v_permlane32_swap_b32 v120, v124
  v_permlane32_swap_b32 v121, v125
  v_permlane32_swap_b32 v122, v126
  s_lshr_b32 s21, 3, s20
  s_bitcmp1_b32 s21, 0
  s_cbranch_scc0 bw_108
  buffer_load_dwordx4 v[168:171], v18, s[16:19], s80 offen sc1
  s_branch bw_107
bw_108:
  s_lshr_b32 s21, 4, s20
  s_bitcmp1_b32 s21, 0
  s_cbranch_scc0 bw_109
  s_branch bw_107
bw_109:
  s_lshr_b32 s21, 8, s20
  s_bitcmp1_b32 s21, 0
  s_cbranch_scc0 bw_110
  s_branch bw_107
bw_110:
bw_107:
  v_permlane32_swap_b32 v123, v127
  v_pk_add_f32 v[120:121], v[120:121], v[124:125]
  v_pk_add_f32 v[122:123], v[122:123], v[126:127]
  s_lshr_b32 s21, 3, s20
  s_bitcmp1_b32 s21, 0
  s_cbranch_scc0 bw_112
  buffer_load_dwordx2 v[172:173], v20, s[16:19], s80 offen sc1
  s_branch bw_111
bw_112:
  s_lshr_b32 s21, 4, s20
  s_bitcmp1_b32 s21, 0
  s_cbranch_scc0 bw_113
  s_branch bw_111
bw_113:
  s_lshr_b32 s21, 8, s20
  s_bitcmp1_b32 s21, 0
  s_cbranch_scc0 bw_114
  s_branch bw_111
bw_114:
bw_111:
  v_pk_add_f32 v[124:125], v[248:249], v[250:251]
  v_max3_f32 v236, v120, v121, v122
  v_max3_f32 v237, v123, v124, v125
  s_lshr_b32 s21, 3, s20
  s_bitcmp1_b32 s21, 0
  s_cbranch_scc0 bw_116
  s_branch bw_115
bw_116:
  s_lshr_b32 s21, 4, s20
  s_bitcmp1_b32 s21, 0
  s_cbranch_scc0 bw_117
  s_branch bw_115
bw_117:
  s_lshr_b32 s21, 8, s20
  s_bitcmp1_b32 s21, 0
  s_cbranch_scc0 bw_118
  v_mov_b32 v240, s67
  v_mov_b32 v241, s67
  s_mov_b64 exec, s[68:69]
  buffer_store_dwordx2 v[240:241], v88, s[12:15], s66 offen sc1
  s_mov_b64 exec, -1
  s_branch bw_115
bw_118:
bw_115:
  v_max_f32 v236, v236, v237
  v_cvt_pk_bf16_f32 v228, v188, v189
  v_cvt_pk_bf16_f32 v229, v190, v191
  v_max_f32_dpp v236, v236, v236 row_ror:8 row_mask:0xf bank_mask:0xf
  v_mov_b32 v237, v236
  s_cmp_lt_i32 s55, 0
  s_cbranch_scc1 fl_119
fl_120:
  v_cvt_pk_bf16_f32 v230, v192, v193
  v_cvt_pk_bf16_f32 v231, v194, v195
  v_permlane32_swap_b32 v236, v237
  v_max_f32 v236, v236, v237
  v_mov_b32 v237, v236
  v_cvt_pk_bf16_f32 v232, v196, v197
  v_cvt_pk_bf16_f32 v233, v198, v199
  v_permlane16_swap_b32 v236, v237
  v_max_f32 v236, v236, v237
  v_mul_f32 v236, s86, v236
  v_fma_f32 v120, v120, s86, -v236
  v_fma_f32 v121, v121, s86, -v236
  v_fma_f32 v122, v122, s86, -v236
  v_fma_f32 v123, v123, s86, -v236
  v_fma_f32 v124, v124, s86, -v236
  v_fma_f32 v125, v125, s86, -v236
  v_exp_f32 v120, v120
  v_exp_f32 v121, v121
  v_exp_f32 v122, v122
  v_exp_f32 v123, v123
  v_exp_f32 v124, v124
  v_exp_f32 v125, v125
  s_mov_b64 exec, s[60:61]
  v_cvt_pk_bf16_f32 v220, v120, v121
  v_cvt_pk_bf16_f32 v221, v122, v123
  v_cvt_pk_bf16_f32 v224, v124, v125
  s_mov_b64 exec, s[62:63]
  v_cvt_pk_bf16_f32 v222, v120, v121
  v_cvt_pk_bf16_f32 v223, v122, v123
  v_cvt_pk_bf16_f32 v225, v124, v125
  s_mov_b64 exec, -1
  v_pk_add_f32 v[126:127], v[120:121], v[122:123]
  v_add_f32 v128, v124, v125
  v_mfma_f32_16x16x32_bf16 v[200:203], v[176:179], v[220:223], 0
  v_add_f32 v236, v126, v127
  v_fmac_f32 v236, v128, v89
  v_mfma_f32_16x16x32_bf16 v[204:207], v[180:183], v[220:223], 0
  v_mfma_f32_16x16x32_bf16 v[208:211], v[184:187], v[220:223], 0
  v_add_f32_dpp v236, v236, v236 row_ror:8 row_mask:0xf bank_mask:0xf
  v_mov_b32 v237, v236
  s_nop 0
  v_mfma_f32_16x16x32_bf16 v[200:203], v[228:231], v[224:227], v[200:203]
  v_mfma_f32_16x16x32_bf16 v[204:207], v[230:233], v[224:227], v[204:207]
  v_permlane32_swap_b32 v236, v237
  v_add_f32 v236, v236, v237
  v_mov_b32 v237, v236
  v_mfma_f32_16x16x32_bf16 v[208:211], v[232:235], v[224:227], v[208:211]
  s_nop 0
  v_permlane16_swap_b32 v236, v237
  v_add_f32 v236, v236, v237
  v_rcp_f32 v236, v236
  s_nop 2
  v_pk_mul_f32 v[200:201], v[200:201], v[236:237] op_sel_hi:[1,0]
  v_pk_mul_f32 v[202:203], v[202:203], v[236:237] op_sel_hi:[1,0]
  ds_write_b128 v11, v[200:203] offset:0
  v_pk_mul_f32 v[204:205], v[204:205], v[236:237] op_sel_hi:[1,0]
  v_pk_mul_f32 v[206:207], v[206:207], v[236:237] op_sel_hi:[1,0]
  ds_write_b128 v11, v[204:207] offset:1024
  v_pk_mul_f32 v[208:209], v[208:209], v[236:237] op_sel_hi:[1,0]
  v_pk_mul_f32 v[210:211], v[210:211], v[236:237] op_sel_hi:[1,0]
  ds_write_b128 v11, v[208:211] offset:2048
  s_waitcnt lgkmcnt(0)
  s_barrier
  s_lshr_b32 s21, 7, s20
  s_bitcmp1_b32 s21, 0
  s_cbranch_scc0 bw_122
  ds_read_b64 v[96:97], v12 offset:0
  ds_read_b64 v[98:99], v12 offset:128
  ds_read_b64 v[100:101], v12 offset:3072
  ds_read_b64 v[102:103], v12 offset:3200
  ds_read_b64 v[104:105], v12 offset:6144
  ds_read_b64 v[106:107], v12 offset:6272
  ds_read_b64 v[108:109], v12 offset:9216
  ds_read_b64 v[110:111], v12 offset:9344
  s_waitcnt lgkmcnt(6)
  v_pk_add_f32 v[96:97], v[96:97], v[98:99]
  s_waitcnt lgkmcnt(4)
  v_pk_add_f32 v[100:101], v[100:101], v[102:103]
  s_waitcnt lgkmcnt(2)
  v_pk_add_f32 v[104:105], v[104:105], v[106:107]
  v_pk_add_f32 v[96:97], v[96:97], v[100:101]
  s_waitcnt lgkmcnt(0)
  v_pk_add_f32 v[108:109], v[108:109], v[110:111]
  v_pk_add_f32 v[96:97], v[96:97], v[104:105]
  v_pk_add_f32 v[96:97], v[96:97], v[108:109]
  v_cvt_pk_f16_f32 v100, v96, v97
  v_perm_b32 v100, s91, v100, v14
  buffer_atomic_pk_add_f16 v100, v13, s[4:7], s3 offen
  s_branch bw_121
bw_122:
  s_lshr_b32 s21, 8, s20
  s_bitcmp1_b32 s21, 0
  s_cbranch_scc0 bw_123
  v_mov_b32 v28, -1
  v_mov_b32 v29, -1
  s_cmp_eq_u32 s53, 1
  s_cbranch_scc1 si_124
  buffer_store_dwordx2 v[28:29], v24, s[8:11], s82 offen sc1
  s_branch si_125
si_124:
  buffer_store_dwordx2 v[28:29], v24, s[8:11], s82 offen
si_125:
  s_mov_b64 exec, s[60:61]
  s_add_u32 s22, s82, 278528
  s_cmp_eq_u32 s53, 1
  s_cbranch_scc1 si_126
  buffer_store_dwordx2 v[28:29], v23, s[8:11], s22 offen sc1
  s_branch si_127
si_126:
  buffer_store_dwordx2 v[28:29], v23, s[8:11], s22 offen
si_127:
  s_and_b32 s21, s52, 7
  s_cmp_lg_u32 s21, s50
  s_cbranch_scc1 zm_128
  s_mov_b64 exec, s[70:71]
  buffer_store_dwordx4 v[156:159], v13, s[4:7], s83 offen sc1
zm_128:
  s_mov_b64 exec, -1
  s_branch bw_121
bw_123:
bw_121:
  s_lshr_b32 s21, 4, s20
  s_bitcmp1_b32 s21, 0
  s_cbranch_scc0 bw_130
  s_mov_b64 exec, s[62:63]
  buffer_store_dwordx4 v[212:215], v21, s[24:27], s85 offen sc1
  buffer_store_dwordx2 v[216:217], v23, s[24:27], s85 offen sc1
  s_mov_b64 exec, -1
  s_branch bw_129
bw_130:
bw_129:
  v_mov_b32 v200, v196
  v_mov_b32 v201, v197
  v_mov_b32 v202, v198
  v_mov_b32 v203, v199
  v_permlane32_swap_b32 v188, v192
  v_permlane32_swap_b32 v189, v193
  v_permlane32_swap_b32 v190, v194
  v_permlane32_swap_b32 v191, v195
  v_permlane32_swap_b32 v196, v200
  v_permlane32_swap_b32 v197, v201
  v_permlane32_swap_b32 v198, v202
  v_permlane32_swap_b32 v199, v203
  v_pk_add_f32 v[188:189], v[188:189], v[192:193]
  v_pk_add_f32 v[190:191], v[190:191], v[194:195]
  v_pk_add_f32 v[196:197], v[196:197], v[200:201]
  v_pk_add_f32 v[198:199], v[198:199], v[202:203]
  v_cvt_pk_bf16_f32 v252, v188, v189
  v_cvt_pk_bf16_f32 v254, v196, v197
  v_cvt_pk_bf16_f32 v253, v190, v191
  v_cvt_pk_bf16_f32 v255, v198, v199
  s_nop 0
  v_permlane16_swap_b32 v252, v254
  v_permlane16_swap_b32 v253, v255
  v_min_u32 v252, -2, v252
  s_mov_b64 exec, s[76:77]
  buffer_store_dwordx4 v[252:255], v15, s[24:27], s57 offen sc1
  s_mov_b64 exec, -1
  s_add_u32 s64, s64, 1310720
  s_add_u32 s52, s52, 1
  s_and_b32 s21, s52, 3
  s_mul_i32 s81, s21, 540672
  s_lshl_b32 s84, s21, 15
  s_branch step_85
pm_87:
  s_mov_b32 s47, 1
  buffer_load_dwordx4 v[96:99], v4, s[4:7], s84 offen offset:0 sc1
  buffer_load_dwordx4 v[100:103], v4, s[4:7], s84 offen offset:1024 sc1
  buffer_load_dwordx4 v[104:107], v4, s[4:7], s84 offen offset:2048 sc1
  s_add_u32 s54, s54, 1
  s_cmp_gt_u32 s54, 131072
  s_cbranch_scc1 end0
  s_waitcnt vmcnt(0)
  v_bitop3_b32 v27, v99, v103, v107 bitop3:0x80
  v_cvt_f32_f16 v108, v99
  v_and_b32 v27, 0x48000000, v27
  v_cvt_f32_f16 v109, v103
  v_cmp_ne_u32 vcc, 0x48000000, v27
  v_cvt_f32_f16 v110, v106
  v_cvt_f32_f16_sdwa v111, v106 dst_sel:DWORD dst_unused:UNUSED_PAD src0_sel:WORD_1
  v_cvt_pk_bf16_f32 v40, v110, v111
  s_cbranch_vccnz pm_87
  s_branch pm_88
A1_18:
  v_smfmac_f32_16x16x32_bf16 v[52:55], v[40:41], a[16:19], v44
  v_smfmac_f32_16x16x32_bf16 v[64:67], v[40:41], a[76:79], v44
  v_smfmac_f32_16x16x32_bf16 v[56:59], v[40:41], a[36:39], v44
  v_smfmac_f32_16x16x32_bf16 v[68:71], v[40:41], a[96:99], v44
  v_smfmac_f32_16x16x32_bf16 v[60:63], v[40:41], a[56:59], v44
  v_smfmac_f32_16x16x32_bf16 v[72:75], v[40:41], a[116:119], v44
  v_smfmac_f32_16x16x32_bf16 v[76:79], v[40:41], a[136:139], v44
  v_smfmac_f32_16x16x32_bf16 v[80:83], v[40:41], a[156:159], v44
  v_smfmac_f32_16x16x32_bf16 v[84:87], v[40:41], a[176:179], v44
  s_branch A2_89
psr_103:
  buffer_load_dwordx2 v[248:249], v9, s[8:11], s81 offen sc1
  buffer_load_dwordx4 v[112:115], v8, s[8:11], s81 offen offset:0 sc1
  buffer_load_dwordx4 v[116:119], v8, s[8:11], s81 offen offset:1024 sc1
  s_add_u32 s54, s54, 1
  s_cmp_gt_u32 s54, 131072
  s_cbranch_scc1 end0
  s_waitcnt vmcnt(2)
  v_xor_b32 v96, s88, v248
  s_nop 0
  v_permlane16_swap_b32 v248, v249
  v_fma_mix_f32 v250, v248, 1.0, v249 op_sel:[0,0,0] op_sel_hi:[1,0,1]
  v_fma_mix_f32 v251, v248, 1.0, v249 op_sel:[1,0,1] op_sel_hi:[1,0,1]
  v_mov_b32 v248, v250
  v_mov_b32 v249, v251
  s_nop 0
  v_permlane32_swap_b32 v248, v250
  v_permlane32_swap_b32 v249, v251
  s_waitcnt vmcnt(0)
  v_bitop3_b32 v97, v112, v114, s88 bitop3:0x7e
  v_bitop3_b32 v98, v116, v118, s88 bitop3:0x7e
  v_fma_mix_f32 v120, v112, 1.0, v116 op_sel:[0,0,0] op_sel_hi:[1,0,1]
  v_or3_b32 v27, v96, v97, v98
  v_fma_mix_f32 v124, v114, 1.0, v118 op_sel:[0,0,0] op_sel_hi:[1,0,1]
  v_and_b32 v27, 1, v27
  v_fma_mix_f32 v121, v112, 1.0, v116 op_sel:[1,0,1] op_sel_hi:[1,0,1]
  v_cmp_ne_u32 vcc, 0, v27
  v_fma_mix_f32 v125, v114, 1.0, v118 op_sel:[1,0,1] op_sel_hi:[1,0,1]
  v_fma_mix_f32 v122, v113, 1.0, v117 op_sel:[0,0,0] op_sel_hi:[1,0,1]
  v_fma_mix_f32 v126, v115, 1.0, v119 op_sel:[0,0,0] op_sel_hi:[1,0,1]
  s_cbranch_vccnz psr_103
  s_branch psj_104
kvw_105:
  s_cmp_eq_u32 s52, 0
  s_cselect_b32 s23, 1, s46
  s_cselect_b32 s55, 0, s55
  v_mov_b32 v236, 0
  s_mov_b32 s101, 0
wf_131:
  buffer_load_dword v237, v236, s[12:15], s79 offen sc1
  s_add_u32 s101, s101, 1
  s_cmp_gt_u32 s101, 131072
  s_cbranch_scc1 end0
  s_waitcnt vmcnt(0)
  v_readfirstlane_b32 s100, v237
  s_cmp_ge_u32 s100, s23
  s_cbranch_scc1 wf_132
  s_sleep 3
  s_branch wf_131
wf_132:
  s_cmp_gt_u32 s52, 1
  s_cbranch_scc1 kvok_106
  s_sub_u32 s21, s64, 1310720
  buffer_load_dwordx4 v[176:179], v16, s[28:31], s21 offen offset:0 sc1
  buffer_load_dwordx4 v[180:183], v16, s[28:31], s21 offen offset:1024 sc1
  buffer_load_dwordx4 v[184:187], v16, s[28:31], s21 offen offset:2048 sc1
  s_waitcnt vmcnt(0)
  s_branch kvok_106
fl_119:
  buffer_load_dword v94, v95, s[12:15], s79 offen sc1
  s_branch fl_120
last_86:
  s_lshr_b32 s21, 4, s20
  s_bitcmp1_b32 s21, 0
  s_cbranch_scc0 bw_134
  s_mov_b64 exec, s[62:63]
  buffer_store_dwordx4 v[212:215], v21, s[24:27], s85 offen sc1
  buffer_store_dwordx2 v[216:217], v23, s[24:27], s85 offen sc1
  s_mov_b64 exec, -1
  s_branch bw_133
bw_134:
bw_133:
  v_mov_b32 v188, 0
  v_mov_b32 v189, 0
  v_mov_b32 v190, 0
  v_mov_b32 v191, 0
  v_mov_b32 v192, 0
  v_mov_b32 v193, 0
  v_mov_b32 v194, 0
  v_mov_b32 v195, 0
  v_mov_b32 v196, 0
  v_mov_b32 v197, 0
  v_mov_b32 v198, 0
  v_mov_b32 v199, 0
  s_sleep 4
  s_mov_b32 s54, 0
lv_135:
  buffer_load_dwordx4 v[144:147], v10, s[8:11], s81 offen offset:0 sc1
  buffer_load_dwordx4 v[148:151], v10, s[8:11], s81 offen offset:1024 sc1
  buffer_load_dwordx4 v[152:155], v10, s[8:11], s81 offen offset:2048 sc1
  s_add_u32 s54, s54, 1
  s_cmp_gt_u32 s54, 131072
  s_cbranch_scc1 end0
  s_waitcnt vmcnt(0)
  v_max3_u32 v27, v144, v146, v148
  v_max3_u32 v27, v27, v150, v152
  v_max3_u32 v27, v27, v154, v154
  v_cmp_eq_u32 vcc, -1, v27
  s_nop 1
  s_cbranch_vccnz lv_135
  v_smfmac_f32_16x16x64_bf16 v[188:191], v[144:147], a[180:187], v44
  v_smfmac_f32_16x16x64_bf16 v[192:195], v[144:147], a[204:211], v44
  v_smfmac_f32_16x16x64_bf16 v[196:199], v[144:147], a[228:235], v44
  v_smfmac_f32_16x16x64_bf16 v[188:191], v[148:151], a[188:195], v44
  v_smfmac_f32_16x16x64_bf16 v[192:195], v[148:151], a[212:219], v44
  v_smfmac_f32_16x16x64_bf16 v[196:199], v[148:151], a[236:243], v44
  v_smfmac_f32_16x16x64_bf16 v[188:191], v[152:155], a[196:203], v44
  v_smfmac_f32_16x16x64_bf16 v[192:195], v[152:155], a[220:227], v44
  v_smfmac_f32_16x16x64_bf16 v[196:199], v[152:155], a[244:251], v44
  s_lshr_b32 s21, 4, s20
  s_bitcmp1_b32 s21, 0
  s_cbranch_scc0 bw_137
  v_mov_b32 v236, 64
  s_mov_b64 exec, 1
  buffer_store_dword v236, v95, s[12:15], s90 offen sc1
  s_mov_b64 exec, -1
  s_branch bw_136
bw_137:
bw_136:
  s_nop 7
  v_mov_b32 v200, v196
  v_mov_b32 v201, v197
  v_mov_b32 v202, v198
  v_mov_b32 v203, v199
  v_permlane32_swap_b32 v188, v192
  v_permlane32_swap_b32 v189, v193
  v_permlane32_swap_b32 v190, v194
  v_permlane32_swap_b32 v191, v195
  v_permlane32_swap_b32 v196, v200
  v_permlane32_swap_b32 v197, v201
  v_permlane32_swap_b32 v198, v202
  v_permlane32_swap_b32 v199, v203
  v_pk_add_f32 v[188:189], v[188:189], v[192:193]
  v_pk_add_f32 v[190:191], v[190:191], v[194:195]
  v_pk_add_f32 v[196:197], v[196:197], v[200:201]
  v_pk_add_f32 v[198:199], v[198:199], v[202:203]
  v_cvt_pk_bf16_f32 v252, v188, v189
  v_cvt_pk_bf16_f32 v254, v196, v197
  v_cvt_pk_bf16_f32 v253, v190, v191
  v_cvt_pk_bf16_f32 v255, v198, v199
  s_nop 0
  v_permlane16_swap_b32 v252, v254
  v_permlane16_swap_b32 v253, v255
  v_min_u32 v252, -2, v252
  s_mov_b64 exec, s[76:77]
  buffer_store_dwordx4 v[252:255], v15, s[24:27], s57 offen sc1
  s_mov_b64 exec, -1
  s_lshr_b32 s21, 1, s20
  s_bitcmp1_b32 s21, 0
  s_cbranch_scc0 bw_139
  v_mov_b32 v246, 80
  v_mov_b32 v247, 1
  s_mov_b64 exec, 1
  buffer_atomic_add v247, v246, s[32:35], 0 offen sc0 sc1
  s_mov_b64 exec, -1
clm_140:
  s_branch bw_138
bw_139:
bw_138:
  s_branch chain_done
chain_done:
  s_waitcnt vmcnt(0) lgkmcnt(0)
  s_barrier
  s_mov_b32 s84, 0
  s_mov_b32 s85, -1
  s_mov_b32 s86, 0
  v_mov_b32 v21, 0
  v_mov_b32 v23, v247
  s_cmp_lg_u32 s20, 0
  s_cbranch_scc1 queue_b
  s_mov_b64 exec, 1
  s_branch queue_a
end0:
  s_endpgm
gemm_side:
  s_bfe_u32 s23, s22, 0x20005
  s_add_u32 s22, s22, 31
  s_and_b32 s22, s22, 31
  s_lshl_b32 s21, s23, 3
  s_add_u32 s2, s21, s22
  s_add_u32 s3, s2, 72
  s_add_u32 s24, s2, 48
  s_add_u32 s2, s2, s21
  s_cmp_lt_u32 s22, 24
  s_cselect_b32 s3, s24, s3
  s_cmp_lt_u32 s22, 16
  s_cselect_b32 s3, s2, s3
  s_mov_b32 s2, s3
  s_cmp_ge_u32 s3, 64
  s_cbranch_scc1 not_kv
  s_load_dwordx2 s[4:5], s[0:1], 0
  s_load_dwordx2 s[6:7], s[0:1], 24
  s_load_dwordx2 s[36:37], s[0:1], 32
  s_load_dwordx2 s[38:39], s[0:1], 104
  s_and_b32 s43, s3, 1
  s_bfe_u32 s42, s3, 0x50001
  s_lshr_b32 s40, s42, 2
  s_waitcnt lgkmcnt(0)
  s_cmp_eq_u32 s43, 1
  s_cselect_b32 s6, s36, s6
  s_cselect_b32 s7, s37, s7
  s_mov_b32 s8, s4
  s_mov_b32 s9, s5
  s_mov_b32 s10, 2621440
  s_mov_b32 s11, 0x00020000
  s_mov_b32 s12, s6
  s_mov_b32 s13, s7
  s_mov_b32 s14, 7864320
  s_mov_b32 s15, 0x00020000
  s_mov_b32 s16, s38
  s_mov_b32 s17, s39
  s_mov_b32 s18, 50331648
  s_mov_b32 s19, 0x00020000
  s_mul_i32 s44, s42, 384
  s_mov_b32 s62, 1024
  s_mov_b32 s24, 0
  s_mov_b32 s25, 81920
  s_mov_b32 s64, s32
  s_mov_b32 s65, s33
  s_mov_b32 s66, s34
  s_mov_b32 s67, s35
  s_load_dwordx2 s[72:73], s[0:1], 104
  s_waitcnt lgkmcnt(0)
  s_add_u32 s72, s72, 81068032
  s_addc_u32 s73, s73, 0
  s_mov_b32 s74, 117760
  s_mov_b32 s75, 0x00020000
  v_mov_b32 v9, 2731
  v_add_u32 v8, 0, v1
  v_mul_u32_u24 v7, v8, v9
  v_lshrrev_b32 v7, 16, v7
  v_mul_u32_u24 v4, 24, v7
  v_sub_u32 v8, v8, v4
  s_mov_b32 s21, 12288
  v_mul_lo_u32 v7, v7, s21
  v_lshl_add_u32 v4, v8, 4, v7
  v_add_u32 v8, 64, v1
  v_mul_u32_u24 v7, v8, v9
  v_lshrrev_b32 v7, 16, v7
  v_mul_u32_u24 v5, 24, v7
  v_sub_u32 v8, v8, v5
  s_mov_b32 s21, 12288
  v_mul_lo_u32 v7, v7, s21
  v_lshl_add_u32 v5, v8, 4, v7
  v_add_u32 v8, 128, v1
  v_mul_u32_u24 v7, v8, v9
  v_lshrrev_b32 v7, 16, v7
  v_mul_u32_u24 v6, 24, v7
  v_sub_u32 v8, v8, v6
  s_mov_b32 s21, 12288
  v_mul_lo_u32 v7, v7, s21
  v_lshl_add_u32 v6, v8, 4, v7
  v_lshrrev_b32 v7, 2, v2
  v_lshl_add_u32 v7, v3, 3, v7
  v_mul_u32_u24 v7, 384, v7
  v_and_b32 v8, 3, v2
  v_lshlrev_b32 v8, 3, v8
  s_mul_i32 s21, s20, 96
  v_add3_u32 v7, v7, v8, s21
  v_add_u32 v8, 49152, v7
  s_mul_i32 s21, s20, 393216
  s_add_u32 s21, s21, 0
  s_add_u32 s21, s21, s44
  s_mul_i32 s22, s20, 12288
  s_add_u32 s22, s22, 0
  s_add_u32 m0, s22, 0
  s_nop 0
  buffer_load_dwordx4 v4, s[12:15], s21 offen lds
  s_add_u32 m0, s22, 1024
  s_nop 0
  buffer_load_dwordx4 v5, s[12:15], s21 offen lds
  s_add_u32 m0, s22, 2048
  s_nop 0
  buffer_load_dwordx4 v6, s[12:15], s21 offen lds
  s_mul_i32 s21, s20, 393216
  s_add_u32 s21, s21, 98304
  s_add_u32 s21, s21, s44
  s_mul_i32 s22, s20, 12288
  s_add_u32 s22, s22, 3072
  s_add_u32 m0, s22, 0
  s_nop 0
  buffer_load_dwordx4 v4, s[12:15], s21 offen lds
  s_add_u32 m0, s22, 1024
  s_nop 0
  buffer_load_dwordx4 v5, s[12:15], s21 offen lds
  s_add_u32 m0, s22, 2048
  s_nop 0
  buffer_load_dwordx4 v6, s[12:15], s21 offen lds
  s_mul_i32 s21, s20, 393216
  s_add_u32 s21, s21, 196608
  s_add_u32 s21, s21, s44
  s_mul_i32 s22, s20, 12288
  s_add_u32 s22, s22, 6144
  s_add_u32 m0, s22, 0
  s_nop 0
  buffer_load_dwordx4 v4, s[12:15], s21 offen lds
  s_add_u32 m0, s22, 1024
  s_nop 0
  buffer_load_dwordx4 v5, s[12:15], s21 offen lds
  s_add_u32 m0, s22, 2048
  s_nop 0
  buffer_load_dwordx4 v6, s[12:15], s21 offen lds
  s_mul_i32 s21, s20, 393216
  s_add_u32 s21, s21, 294912
  s_add_u32 s21, s21, s44
  s_mul_i32 s22, s20, 12288
  s_add_u32 s22, s22, 9216
  s_add_u32 m0, s22, 0
  s_nop 0
  buffer_load_dwordx4 v4, s[12:15], s21 offen lds
  s_add_u32 m0, s22, 1024
  s_nop 0
  buffer_load_dwordx4 v5, s[12:15], s21 offen lds
  s_add_u32 m0, s22, 2048
  s_nop 0
  buffer_load_dwordx4 v6, s[12:15], s21 offen lds
  v_lshrrev_b32 v11, 3, v1
  v_and_b32 v12, 7, v1
  v_xor_b32 v12, v12, v11
  v_mul_u32_u24 v11, 1280, v11
  v_lshl_add_u32 v10, v12, 4, v11
  s_mul_i32 s46, s20, 20480
  v_add_u32 v10, s46, v10
  s_lshl_b32 s47, s20, 11
  s_add_u32 s47, s47, 98304
  s_add_u32 s46, s47, 57344
  s_mov_b32 s30, s24
  s_add_u32 s32, s47, 0
  v_add_u32 v11, 9216, v10
  s_mov_b32 m0, s32
  s_nop 0
  buffer_load_dwordx4 v10, s[8:11], s30 offen offset:0 lds
  buffer_load_dwordx4 v11, s[8:11], s30 offen offset:1024 lds
  s_add_u32 s30, s30, 128
  s_add_u32 s32, s32, 8192
  s_cmp_lt_u32 s32, s46
  s_cselect_b32 s32, s32, s47
  s_mov_b32 m0, s32
  s_nop 0
  buffer_load_dwordx4 v10, s[8:11], s30 offen offset:0 lds
  buffer_load_dwordx4 v11, s[8:11], s30 offen offset:1024 lds
  s_add_u32 s30, s30, 128
  s_add_u32 s32, s32, 8192
  s_cmp_lt_u32 s32, s46
  s_cselect_b32 s32, s32, s47
  s_mov_b32 m0, s32
  s_nop 0
  buffer_load_dwordx4 v10, s[8:11], s30 offen offset:0 lds
  buffer_load_dwordx4 v11, s[8:11], s30 offen offset:1024 lds
  s_add_u32 s30, s30, 128
  s_add_u32 s32, s32, 8192
  s_cmp_lt_u32 s32, s46
  s_cselect_b32 s32, s32, s47
  s_mov_b32 m0, s32
  s_nop 0
  buffer_load_dwordx4 v10, s[8:11], s30 offen offset:0 lds
  buffer_load_dwordx4 v11, s[8:11], s30 offen offset:1024 lds
  s_add_u32 s30, s30, 128
  s_add_u32 s32, s32, 8192
  s_cmp_lt_u32 s32, s46
  s_cselect_b32 s32, s32, s47
  s_mov_b32 m0, s32
  s_nop 0
  buffer_load_dwordx4 v10, s[8:11], s30 offen offset:0 lds
  buffer_load_dwordx4 v11, s[8:11], s30 offen offset:1024 lds
  s_add_u32 s30, s30, 128
  s_add_u32 s32, s32, 8192
  s_cmp_lt_u32 s32, s46
  s_cselect_b32 s32, s32, s47
  s_mul_i32 s21, s20, 393216
  s_add_u32 s21, s21, 1572864
  s_add_u32 s21, s21, s44
  s_mul_i32 s22, s20, 12288
  s_add_u32 s22, s22, 49152
  s_add_u32 m0, s22, 0
  s_nop 0
  buffer_load_dwordx4 v4, s[12:15], s21 offen lds
  s_add_u32 m0, s22, 1024
  s_nop 0
  buffer_load_dwordx4 v5, s[12:15], s21 offen lds
  s_add_u32 m0, s22, 2048
  s_nop 0
  buffer_load_dwordx4 v6, s[12:15], s21 offen lds
  s_mul_i32 s21, s20, 393216
  s_add_u32 s21, s21, 1671168
  s_add_u32 s21, s21, s44
  s_mul_i32 s22, s20, 12288
  s_add_u32 s22, s22, 52224
  s_add_u32 m0, s22, 0
  s_nop 0
  buffer_load_dwordx4 v4, s[12:15], s21 offen lds
  s_add_u32 m0, s22, 1024
  s_nop 0
  buffer_load_dwordx4 v5, s[12:15], s21 offen lds
  s_add_u32 m0, s22, 2048
  s_nop 0
  buffer_load_dwordx4 v6, s[12:15], s21 offen lds
  s_mul_i32 s21, s20, 393216
  s_add_u32 s21, s21, 1769472
  s_add_u32 s21, s21, s44
  s_mul_i32 s22, s20, 12288
  s_add_u32 s22, s22, 55296
  s_add_u32 m0, s22, 0
  s_nop 0
  buffer_load_dwordx4 v4, s[12:15], s21 offen lds
  s_add_u32 m0, s22, 1024
  s_nop 0
  buffer_load_dwordx4 v5, s[12:15], s21 offen lds
  s_add_u32 m0, s22, 2048
  s_nop 0
  buffer_load_dwordx4 v6, s[12:15], s21 offen lds
  s_mul_i32 s21, s20, 393216
  s_add_u32 s21, s21, 1867776
  s_add_u32 s21, s21, s44
  s_mul_i32 s22, s20, 12288
  s_add_u32 s22, s22, 58368
  s_add_u32 m0, s22, 0
  s_nop 0
  buffer_load_dwordx4 v4, s[12:15], s21 offen lds
  s_add_u32 m0, s22, 1024
  s_nop 0
  buffer_load_dwordx4 v5, s[12:15], s21 offen lds
  s_add_u32 m0, s22, 2048
  s_nop 0
  buffer_load_dwordx4 v6, s[12:15], s21 offen lds
  s_waitcnt vmcnt(12)
  s_barrier
  ds_read_b64_tr_b16 a[0:1], v7 offset:0
  ds_read_b64_tr_b16 a[2:3], v7 offset:1536
  ds_read_b64_tr_b16 a[4:5], v7 offset:32
  ds_read_b64_tr_b16 a[6:7], v7 offset:1568
  ds_read_b64_tr_b16 a[8:9], v7 offset:64
  ds_read_b64_tr_b16 a[10:11], v7 offset:1600
  ds_read_b64_tr_b16 a[12:13], v7 offset:12288
  ds_read_b64_tr_b16 a[14:15], v7 offset:13824
  ds_read_b64_tr_b16 a[16:17], v7 offset:12320
  ds_read_b64_tr_b16 a[18:19], v7 offset:13856
  ds_read_b64_tr_b16 a[20:21], v7 offset:12352
  ds_read_b64_tr_b16 a[22:23], v7 offset:13888
  ds_read_b64_tr_b16 a[24:25], v7 offset:24576
  ds_read_b64_tr_b16 a[26:27], v7 offset:26112
  ds_read_b64_tr_b16 a[28:29], v7 offset:24608
  ds_read_b64_tr_b16 a[30:31], v7 offset:26144
  ds_read_b64_tr_b16 a[32:33], v7 offset:24640
  ds_read_b64_tr_b16 a[34:35], v7 offset:26176
  ds_read_b64_tr_b16 a[36:37], v7 offset:36864
  ds_read_b64_tr_b16 a[38:39], v7 offset:38400
  ds_read_b64_tr_b16 a[40:41], v7 offset:36896
  ds_read_b64_tr_b16 a[42:43], v7 offset:38432
  ds_read_b64_tr_b16 a[44:45], v7 offset:36928
  ds_read_b64_tr_b16 a[46:47], v7 offset:38464
  s_waitcnt lgkmcnt(0)
  s_barrier
  s_mul_i32 s21, s20, 393216
  s_add_u32 s21, s21, 3145728
  s_add_u32 s21, s21, s44
  s_mul_i32 s22, s20, 12288
  s_add_u32 s22, s22, 0
  s_add_u32 m0, s22, 0
  s_nop 0
  buffer_load_dwordx4 v4, s[12:15], s21 offen lds
  s_add_u32 m0, s22, 1024
  s_nop 0
  buffer_load_dwordx4 v5, s[12:15], s21 offen lds
  s_add_u32 m0, s22, 2048
  s_nop 0
  buffer_load_dwordx4 v6, s[12:15], s21 offen lds
  s_mul_i32 s21, s20, 393216
  s_add_u32 s21, s21, 3244032
  s_add_u32 s21, s21, s44
  s_mul_i32 s22, s20, 12288
  s_add_u32 s22, s22, 3072
  s_add_u32 m0, s22, 0
  s_nop 0
  buffer_load_dwordx4 v4, s[12:15], s21 offen lds
  s_add_u32 m0, s22, 1024
  s_nop 0
  buffer_load_dwordx4 v5, s[12:15], s21 offen lds
  s_add_u32 m0, s22, 2048
  s_nop 0
  buffer_load_dwordx4 v6, s[12:15], s21 offen lds
  s_mul_i32 s21, s20, 393216
  s_add_u32 s21, s21, 3342336
  s_add_u32 s21, s21, s44
  s_mul_i32 s22, s20, 12288
  s_add_u32 s22, s22, 6144
  s_add_u32 m0, s22, 0
  s_nop 0
  buffer_load_dwordx4 v4, s[12:15], s21 offen lds
  s_add_u32 m0, s22, 1024
  s_nop 0
  buffer_load_dwordx4 v5, s[12:15], s21 offen lds
  s_add_u32 m0, s22, 2048
  s_nop 0
  buffer_load_dwordx4 v6, s[12:15], s21 offen lds
  s_mul_i32 s21, s20, 393216
  s_add_u32 s21, s21, 3440640
  s_add_u32 s21, s21, s44
  s_mul_i32 s22, s20, 12288
  s_add_u32 s22, s22, 9216
  s_add_u32 m0, s22, 0
  s_nop 0
  buffer_load_dwordx4 v4, s[12:15], s21 offen lds
  s_add_u32 m0, s22, 1024
  s_nop 0
  buffer_load_dwordx4 v5, s[12:15], s21 offen lds
  s_add_u32 m0, s22, 2048
  s_nop 0
  buffer_load_dwordx4 v6, s[12:15], s21 offen lds
  s_waitcnt vmcnt(12)
  s_barrier
  ds_read_b64_tr_b16 a[48:49], v8 offset:0
  ds_read_b64_tr_b16 a[50:51], v8 offset:1536
  ds_read_b64_tr_b16 a[52:53], v8 offset:32
  ds_read_b64_tr_b16 a[54:55], v8 offset:1568
  ds_read_b64_tr_b16 a[56:57], v8 offset:64
  ds_read_b64_tr_b16 a[58:59], v8 offset:1600
  ds_read_b64_tr_b16 a[60:61], v8 offset:12288
  ds_read_b64_tr_b16 a[62:63], v8 offset:13824
  ds_read_b64_tr_b16 a[64:65], v8 offset:12320
  ds_read_b64_tr_b16 a[66:67], v8 offset:13856
  ds_read_b64_tr_b16 a[68:69], v8 offset:12352
  ds_read_b64_tr_b16 a[70:71], v8 offset:13888
  ds_read_b64_tr_b16 a[72:73], v8 offset:24576
  ds_read_b64_tr_b16 a[74:75], v8 offset:26112
  ds_read_b64_tr_b16 a[76:77], v8 offset:24608
  ds_read_b64_tr_b16 a[78:79], v8 offset:26144
  ds_read_b64_tr_b16 a[80:81], v8 offset:24640
  ds_read_b64_tr_b16 a[82:83], v8 offset:26176
  ds_read_b64_tr_b16 a[84:85], v8 offset:36864
  ds_read_b64_tr_b16 a[86:87], v8 offset:38400
  ds_read_b64_tr_b16 a[88:89], v8 offset:36896
  ds_read_b64_tr_b16 a[90:91], v8 offset:38432
  ds_read_b64_tr_b16 a[92:93], v8 offset:36928
  ds_read_b64_tr_b16 a[94:95], v8 offset:38464
  s_waitcnt lgkmcnt(0)
  s_barrier
  s_mul_i32 s21, s20, 393216
  s_add_u32 s21, s21, 4718592
  s_add_u32 s21, s21, s44
  s_mul_i32 s22, s20, 12288
  s_add_u32 s22, s22, 49152
  s_add_u32 m0, s22, 0
  s_nop 0
  buffer_load_dwordx4 v4, s[12:15], s21 offen lds
  s_add_u32 m0, s22, 1024
  s_nop 0
  buffer_load_dwordx4 v5, s[12:15], s21 offen lds
  s_add_u32 m0, s22, 2048
  s_nop 0
  buffer_load_dwordx4 v6, s[12:15], s21 offen lds
  s_mul_i32 s21, s20, 393216
  s_add_u32 s21, s21, 4816896
  s_add_u32 s21, s21, s44
  s_mul_i32 s22, s20, 12288
  s_add_u32 s22, s22, 52224
  s_add_u32 m0, s22, 0
  s_nop 0
  buffer_load_dwordx4 v4, s[12:15], s21 offen lds
  s_add_u32 m0, s22, 1024
  s_nop 0
  buffer_load_dwordx4 v5, s[12:15], s21 offen lds
  s_add_u32 m0, s22, 2048
  s_nop 0
  buffer_load_dwordx4 v6, s[12:15], s21 offen lds
  s_mul_i32 s21, s20, 393216
  s_add_u32 s21, s21, 4915200
  s_add_u32 s21, s21, s44
  s_mul_i32 s22, s20, 12288
  s_add_u32 s22, s22, 55296
  s_add_u32 m0, s22, 0
  s_nop 0
  buffer_load_dwordx4 v4, s[12:15], s21 offen lds
  s_add_u32 m0, s22, 1024
  s_nop 0
  buffer_load_dwordx4 v5, s[12:15], s21 offen lds
  s_add_u32 m0, s22, 2048
  s_nop 0
  buffer_load_dwordx4 v6, s[12:15], s21 offen lds
  s_mul_i32 s21, s20, 393216
  s_add_u32 s21, s21, 5013504
  s_add_u32 s21, s21, s44
  s_mul_i32 s22, s20, 12288
  s_add_u32 s22, s22, 58368
  s_add_u32 m0, s22, 0
  s_nop 0
  buffer_load_dwordx4 v4, s[12:15], s21 offen lds
  s_add_u32 m0, s22, 1024
  s_nop 0
  buffer_load_dwordx4 v5, s[12:15], s21 offen lds
  s_add_u32 m0, s22, 2048
  s_nop 0
  buffer_load_dwordx4 v6, s[12:15], s21 offen lds
  v_mov_b32 v29, 76
  buffer_load_dword v29, v29, s[64:67], 0 offen sc1
  s_waitcnt vmcnt(12)
  s_barrier
  ds_read_b64_tr_b16 a[96:97], v7 offset:0
  ds_read_b64_tr_b16 a[98:99], v7 offset:1536
  ds_read_b64_tr_b16 a[100:101], v7 offset:32
  ds_read_b64_tr_b16 a[102:103], v7 offset:1568
  ds_read_b64_tr_b16 a[104:105], v7 offset:64
  ds_read_b64_tr_b16 a[106:107], v7 offset:1600
  ds_read_b64_tr_b16 a[108:109], v7 offset:12288
  ds_read_b64_tr_b16 a[110:111], v7 offset:13824
  ds_read_b64_tr_b16 a[112:113], v7 offset:12320
  ds_read_b64_tr_b16 a[114:115], v7 offset:13856
  ds_read_b64_tr_b16 a[116:117], v7 offset:12352
  ds_read_b64_tr_b16 a[118:119], v7 offset:13888
  ds_read_b64_tr_b16 a[120:121], v7 offset:24576
  ds_read_b64_tr_b16 a[122:123], v7 offset:26112
  ds_read_b64_tr_b16 a[124:125], v7 offset:24608
  ds_read_b64_tr_b16 a[126:127], v7 offset:26144
  ds_read_b64_tr_b16 a[128:129], v7 offset:24640
  ds_read_b64_tr_b16 a[130:131], v7 offset:26176
  ds_read_b64_tr_b16 a[132:133], v7 offset:36864
  ds_read_b64_tr_b16 a[134:135], v7 offset:38400
  ds_read_b64_tr_b16 a[136:137], v7 offset:36896
  ds_read_b64_tr_b16 a[138:139], v7 offset:38432
  ds_read_b64_tr_b16 a[140:141], v7 offset:36928
  ds_read_b64_tr_b16 a[142:143], v7 offset:38464
  s_waitcnt lgkmcnt(0)
  s_barrier
  s_mul_i32 s21, s20, 393216
  s_add_u32 s21, s21, 6291456
  s_add_u32 s21, s21, s44
  s_mul_i32 s22, s20, 12288
  s_add_u32 s22, s22, 0
  s_add_u32 m0, s22, 0
  s_nop 0
  buffer_load_dwordx4 v4, s[12:15], s21 offen lds
  s_add_u32 m0, s22, 1024
  s_nop 0
  buffer_load_dwordx4 v5, s[12:15], s21 offen lds
  s_add_u32 m0, s22, 2048
  s_nop 0
  buffer_load_dwordx4 v6, s[12:15], s21 offen lds
  s_mul_i32 s21, s20, 393216
  s_add_u32 s21, s21, 6389760
  s_add_u32 s21, s21, s44
  s_mul_i32 s22, s20, 12288
  s_add_u32 s22, s22, 3072
  s_add_u32 m0, s22, 0
  s_nop 0
  buffer_load_dwordx4 v4, s[12:15], s21 offen lds
  s_add_u32 m0, s22, 1024
  s_nop 0
  buffer_load_dwordx4 v5, s[12:15], s21 offen lds
  s_add_u32 m0, s22, 2048
  s_nop 0
  buffer_load_dwordx4 v6, s[12:15], s21 offen lds
  s_mul_i32 s21, s20, 393216
  s_add_u32 s21, s21, 6488064
  s_add_u32 s21, s21, s44
  s_mul_i32 s22, s20, 12288
  s_add_u32 s22, s22, 6144
  s_add_u32 m0, s22, 0
  s_nop 0
  buffer_load_dwordx4 v4, s[12:15], s21 offen lds
  s_add_u32 m0, s22, 1024
  s_nop 0
  buffer_load_dwordx4 v5, s[12:15], s21 offen lds
  s_add_u32 m0, s22, 2048
  s_nop 0
  buffer_load_dwordx4 v6, s[12:15], s21 offen lds
  s_mul_i32 s21, s20, 393216
  s_add_u32 s21, s21, 6586368
  s_add_u32 s21, s21, s44
  s_mul_i32 s22, s20, 12288
  s_add_u32 s22, s22, 9216
  s_add_u32 m0, s22, 0
  s_nop 0
  buffer_load_dwordx4 v4, s[12:15], s21 offen lds
  s_add_u32 m0, s22, 1024
  s_nop 0
  buffer_load_dwordx4 v5, s[12:15], s21 offen lds
  s_add_u32 m0, s22, 2048
  s_nop 0
  buffer_load_dwordx4 v6, s[12:15], s21 offen lds
  s_waitcnt vmcnt(12)
  s_barrier
  ds_read_b64_tr_b16 a[144:145], v8 offset:0
  ds_read_b64_tr_b16 a[146:147], v8 offset:1536
  ds_read_b64_tr_b16 a[148:149], v8 offset:32
  ds_read_b64_tr_b16 a[150:151], v8 offset:1568
  ds_read_b64_tr_b16 a[152:153], v8 offset:64
  ds_read_b64_tr_b16 a[154:155], v8 offset:1600
  ds_read_b64_tr_b16 a[156:157], v8 offset:12288
  ds_read_b64_tr_b16 a[158:159], v8 offset:13824
  ds_read_b64_tr_b16 a[160:161], v8 offset:12320
  ds_read_b64_tr_b16 a[162:163], v8 offset:13856
  ds_read_b64_tr_b16 a[164:165], v8 offset:12352
  ds_read_b64_tr_b16 a[166:167], v8 offset:13888
  ds_read_b64_tr_b16 a[168:169], v8 offset:24576
  ds_read_b64_tr_b16 a[170:171], v8 offset:26112
  ds_read_b64_tr_b16 a[172:173], v8 offset:24608
  ds_read_b64_tr_b16 a[174:175], v8 offset:26144
  ds_read_b64_tr_b16 a[176:177], v8 offset:24640
  ds_read_b64_tr_b16 a[178:179], v8 offset:26176
  ds_read_b64_tr_b16 a[180:181], v8 offset:36864
  ds_read_b64_tr_b16 a[182:183], v8 offset:38400
  ds_read_b64_tr_b16 a[184:185], v8 offset:36896
  ds_read_b64_tr_b16 a[186:187], v8 offset:38432
  ds_read_b64_tr_b16 a[188:189], v8 offset:36928
  ds_read_b64_tr_b16 a[190:191], v8 offset:38464
  s_waitcnt lgkmcnt(0)
  s_barrier
  s_waitcnt vmcnt(0)
  s_barrier
  ds_read_b64_tr_b16 a[192:193], v7 offset:0
  ds_read_b64_tr_b16 a[194:195], v7 offset:1536
  ds_read_b64_tr_b16 a[196:197], v7 offset:32
  ds_read_b64_tr_b16 a[198:199], v7 offset:1568
  ds_read_b64_tr_b16 a[200:201], v7 offset:64
  ds_read_b64_tr_b16 a[202:203], v7 offset:1600
  ds_read_b64_tr_b16 a[204:205], v7 offset:12288
  ds_read_b64_tr_b16 a[206:207], v7 offset:13824
  ds_read_b64_tr_b16 a[208:209], v7 offset:12320
  ds_read_b64_tr_b16 a[210:211], v7 offset:13856
  ds_read_b64_tr_b16 a[212:213], v7 offset:12352
  ds_read_b64_tr_b16 a[214:215], v7 offset:13888
  ds_read_b64_tr_b16 a[216:217], v7 offset:24576
  ds_read_b64_tr_b16 a[218:219], v7 offset:26112
  ds_read_b64_tr_b16 a[220:221], v7 offset:24608
  ds_read_b64_tr_b16 a[222:223], v7 offset:26144
  ds_read_b64_tr_b16 a[224:225], v7 offset:24640
  ds_read_b64_tr_b16 a[226:227], v7 offset:26176
  ds_read_b64_tr_b16 a[228:229], v7 offset:36864
  ds_read_b64_tr_b16 a[230:231], v7 offset:38400
  ds_read_b64_tr_b16 a[232:233], v7 offset:36896
  ds_read_b64_tr_b16 a[234:235], v7 offset:38432
  ds_read_b64_tr_b16 a[236:237], v7 offset:36928
  ds_read_b64_tr_b16 a[238:239], v7 offset:38464
  s_waitcnt lgkmcnt(0)
  s_barrier
  s_mov_b32 s26, 8
  s_mul_i32 s27, s42, 12288
  s_mul_i32 s21, s43, 25165824
  s_add_u32 s27, s27, s21
  s_mov_b32 s28, 786432
  v_readfirstlane_b32 s21, v29
  s_cmp_ge_u32 s21, 32
  s_cbranch_scc1 kvz_141
  s_mov_b32 s21, 76
  v_mov_b32 v4, 0
  s_mov_b32 s101, 0
wf_142:
  buffer_load_dword v5, v4, s[64:67], s21 offen sc1
  s_add_u32 s101, s101, 1
  s_cmp_gt_u32 s101, 131072
  s_cbranch_scc1 main_end
  s_waitcnt vmcnt(0)
  v_readfirstlane_b32 s100, v5
  s_cmp_ge_u32 s100, 32
  s_cbranch_scc1 wf_143
  s_sleep 8
  s_branch wf_142
wf_143:
kvz_141:
  s_lshl_b32 s60, s40, 7
  s_add_u32 s60, s60, 0
  s_mov_b32 s61, 0
  v_and_b32 v6, 7, v2
  v_add_u32 v4, 0, v3
  v_xor_b32 v4, v4, v6
  v_lshlrev_b32 v4, 4, v4
  v_lshl_add_u32 v14, v2, 7, v4
  v_add_u32 v4, 4, v3
  v_xor_b32 v4, v4, v6
  v_lshlrev_b32 v4, 4, v4
  v_lshl_add_u32 v15, v2, 7, v4
  v_mul_u32_u24 v22, 400, v2
  v_mul_u32_u24 v4, 16, v3
  s_mul_i32 s21, s20, 96
  s_add_u32 s21, s21, 0
  v_add3_u32 v22, v22, v4, s21
  v_lshlrev_b32 v4, 3, v3
  v_sub_u32 v16, v22, v4
  v_mov_b32 v9, 2731
  s_mul_i32 s21, s20, 6400
  s_add_u32 s21, s21, 0
  v_mul_u32_u24 v4, 400, v2
  v_lshlrev_b32 v5, 4, v3
  v_add3_u32 v23, v4, v5, s21
  v_lshlrev_b32 v26, 4, v1
  s_mov_b32 s33, 98304
  s_mov_b32 s48, 0x80000000
  s_mov_b32 m0, s32
  s_nop 0
  buffer_load_dwordx4 v10, s[8:11], s30 offen offset:0 lds
  s_waitcnt vmcnt(9)
  s_barrier
  v_add_u32 v18, s33, v14
  v_add_u32 v19, s33, v15
  s_add_u32 s33, s33, 8192
  s_cmp_lt_u32 s33, 155648
  s_cselect_b32 s33, s33, 98304
  ds_read_b128 v[160:163], v18 offset:0
  ds_read_b128 v[164:167], v18 offset:2048
  ds_read_b128 v[168:171], v18 offset:4096
  ds_read_b128 v[172:175], v18 offset:6144
  s_waitcnt lgkmcnt(0)
kvm_blk_146:
  v_mfma_f32_16x16x32_bf16 v[64:67], a[0:3], v[160:163], 0
  ds_read_b128 v[192:195], v19 offset:0
  v_mfma_f32_16x16x32_bf16 v[68:71], a[4:7], v[160:163], 0
  v_add_u32 v18, s33, v14
  v_mfma_f32_16x16x32_bf16 v[72:75], a[8:11], v[160:163], 0
  v_mfma_f32_16x16x32_bf16 v[76:79], a[0:3], v[164:167], 0
  ds_read_b128 v[196:199], v19 offset:2048
  v_mfma_f32_16x16x32_bf16 v[80:83], a[4:7], v[164:167], 0
  buffer_load_dwordx4 v11, s[8:11], s30 offen offset:1024 lds
  v_mfma_f32_16x16x32_bf16 v[84:87], a[8:11], v[164:167], 0
  s_waitcnt lgkmcnt(11)
  s_add_u32 s30, s30, 128
  v_mfma_f32_16x16x32_bf16 v[88:91], a[0:3], v[168:171], 0
  ds_read_b128 v[200:203], v19 offset:4096
  s_add_u32 m0, m0, 8192
  v_mfma_f32_16x16x32_bf16 v[92:95], a[4:7], v[168:171], 0
  s_cmp_lt_u32 m0, s46
  s_cselect_b32 m0, m0, s47
  v_mfma_f32_16x16x32_bf16 v[96:99], a[8:11], v[168:171], 0
  v_mfma_f32_16x16x32_bf16 v[100:103], a[0:3], v[172:175], 0
  ds_read_b128 v[204:207], v19 offset:6144
  v_mfma_f32_16x16x32_bf16 v[104:107], a[4:7], v[172:175], 0
  v_mfma_f32_16x16x32_bf16 v[108:111], a[8:11], v[172:175], 0
  s_waitcnt vmcnt(8) lgkmcnt(2)
  s_barrier
  v_mfma_f32_16x16x32_bf16 v[64:67], a[12:15], v[192:195], v[64:67]
  ds_read_b128 v[160:163], v18 offset:0
  v_mfma_f32_16x16x32_bf16 v[68:71], a[16:19], v[192:195], v[68:71]
  ds_read_b128 v[224:227], v23 offset:0
  v_mfma_f32_16x16x32_bf16 v[72:75], a[20:23], v[192:195], v[72:75]
  v_add_u32 v19, s33, v15
  s_add_u32 s33, s33, 8192
  v_mfma_f32_16x16x32_bf16 v[76:79], a[12:15], v[196:199], v[76:79]
  ds_read_b128 v[164:167], v18 offset:2048
  v_mfma_f32_16x16x32_bf16 v[80:83], a[16:19], v[196:199], v[80:83]
  buffer_load_dwordx4 v10, s[8:11], s30 offen offset:0 lds
  v_mfma_f32_16x16x32_bf16 v[84:87], a[20:23], v[196:199], v[84:87]
  s_waitcnt lgkmcnt(3)
  ds_read_b128 v[228:231], v23 offset:64
  v_mfma_f32_16x16x32_bf16 v[88:91], a[12:15], v[200:203], v[88:91]
  ds_read_b128 v[168:171], v18 offset:4096
  v_mfma_f32_16x16x32_bf16 v[92:95], a[16:19], v[200:203], v[92:95]
  s_cmp_lt_u32 s33, 155648
  s_cselect_b32 s33, s33, 98304
  v_mfma_f32_16x16x32_bf16 v[96:99], a[20:23], v[200:203], v[96:99]
  v_mfma_f32_16x16x32_bf16 v[100:103], a[12:15], v[204:207], v[100:103]
  ds_read_b128 v[172:175], v18 offset:6144
  v_mfma_f32_16x16x32_bf16 v[104:107], a[16:19], v[204:207], v[104:107]
  v_mfma_f32_16x16x32_bf16 v[108:111], a[20:23], v[204:207], v[108:111]
  s_waitcnt lgkmcnt(3)
  v_mfma_f32_16x16x32_bf16 v[64:67], a[24:27], v[160:163], v[64:67]
  ds_read_b128 v[192:195], v19 offset:0
  v_mfma_f32_16x16x32_bf16 v[68:71], a[28:31], v[160:163], v[68:71]
  v_add_u32 v18, s33, v14
  ds_read_b128 v[232:235], v23 offset:128
  v_mfma_f32_16x16x32_bf16 v[72:75], a[32:35], v[160:163], v[72:75]
  v_mfma_f32_16x16x32_bf16 v[76:79], a[24:27], v[164:167], v[76:79]
  ds_read_b128 v[196:199], v19 offset:2048
  v_mfma_f32_16x16x32_bf16 v[80:83], a[28:31], v[164:167], v[80:83]
  buffer_load_dwordx4 v11, s[8:11], s30 offen offset:1024 lds
  s_add_u32 s21, s48, 0
  v_mfma_f32_16x16x32_bf16 v[84:87], a[32:35], v[164:167], v[84:87]
  s_waitcnt lgkmcnt(3)
  s_add_u32 s30, s30, 128
  v_mfma_f32_16x16x32_bf16 v[88:91], a[24:27], v[168:171], v[88:91]
  ds_read_b128 v[200:203], v19 offset:4096
  s_add_u32 m0, m0, 8192
  v_mfma_f32_16x16x32_bf16 v[92:95], a[28:31], v[168:171], v[92:95]
  s_cmp_lt_u32 m0, s46
  s_cselect_b32 m0, m0, s47
  buffer_store_dwordx4 v[224:227], v26, s[16:19], s21 offen offset:0 sc1
  v_mfma_f32_16x16x32_bf16 v[96:99], a[32:35], v[168:171], v[96:99]
  ds_read_b128 v[236:239], v23 offset:192
  v_mfma_f32_16x16x32_bf16 v[100:103], a[24:27], v[172:175], v[100:103]
  ds_read_b128 v[204:207], v19 offset:6144
  v_mfma_f32_16x16x32_bf16 v[104:107], a[28:31], v[172:175], v[104:107]
  buffer_store_dwordx4 v[228:231], v26, s[16:19], s21 offen offset:1024 sc1
  v_mfma_f32_16x16x32_bf16 v[108:111], a[32:35], v[172:175], v[108:111]
  s_waitcnt vmcnt(10) lgkmcnt(3)
  s_barrier
  v_mfma_f32_16x16x32_bf16 v[64:67], a[36:39], v[192:195], v[64:67]
  ds_read_b128 v[160:163], v18 offset:0
  v_mfma_f32_16x16x32_bf16 v[68:71], a[40:43], v[192:195], v[68:71]
  ds_read_b128 v[240:243], v23 offset:256
  v_mfma_f32_16x16x32_bf16 v[72:75], a[44:47], v[192:195], v[72:75]
  v_add_u32 v19, s33, v15
  s_add_u32 s33, s33, 8192
  v_mfma_f32_16x16x32_bf16 v[76:79], a[36:39], v[196:199], v[76:79]
  ds_read_b128 v[164:167], v18 offset:2048
  v_mfma_f32_16x16x32_bf16 v[80:83], a[40:43], v[196:199], v[80:83]
  buffer_load_dwordx4 v10, s[8:11], s30 offen offset:0 lds
  v_mfma_f32_16x16x32_bf16 v[84:87], a[44:47], v[196:199], v[84:87]
  s_waitcnt lgkmcnt(3)
  ds_read_b128 v[244:247], v23 offset:320
  v_mfma_f32_16x16x32_bf16 v[88:91], a[36:39], v[200:203], v[88:91]
  ds_read_b128 v[168:171], v18 offset:4096
  v_mfma_f32_16x16x32_bf16 v[92:95], a[40:43], v[200:203], v[92:95]
  s_cmp_lt_u32 s33, 155648
  s_cselect_b32 s33, s33, 98304
  buffer_store_dwordx4 v[232:235], v26, s[16:19], s21 offen offset:2048 sc1
  v_mfma_f32_16x16x32_bf16 v[96:99], a[44:47], v[200:203], v[96:99]
  v_mfma_f32_16x16x32_bf16 v[100:103], a[36:39], v[204:207], v[100:103]
  ds_read_b128 v[172:175], v18 offset:6144
  v_mfma_f32_16x16x32_bf16 v[104:107], a[40:43], v[204:207], v[104:107]
  buffer_store_dwordx4 v[236:239], v26, s[16:19], s21 offen offset:3072 sc1
  v_mfma_f32_16x16x32_bf16 v[108:111], a[44:47], v[204:207], v[108:111]
  s_waitcnt lgkmcnt(3)
  v_mfma_f32_16x16x32_bf16 v[64:67], a[48:51], v[160:163], v[64:67]
  ds_read_b128 v[192:195], v19 offset:0
  v_mfma_f32_16x16x32_bf16 v[68:71], a[52:55], v[160:163], v[68:71]
  v_add_u32 v18, s33, v14
  v_mfma_f32_16x16x32_bf16 v[72:75], a[56:59], v[160:163], v[72:75]
  v_mfma_f32_16x16x32_bf16 v[76:79], a[48:51], v[164:167], v[76:79]
  ds_read_b128 v[196:199], v19 offset:2048
  v_mfma_f32_16x16x32_bf16 v[80:83], a[52:55], v[164:167], v[80:83]
  buffer_load_dwordx4 v11, s[8:11], s30 offen offset:1024 lds
  s_add_u32 s21, s48, 4096
  v_mfma_f32_16x16x32_bf16 v[84:87], a[56:59], v[164:167], v[84:87]
  s_waitcnt lgkmcnt(2)
  s_add_u32 s30, s30, 128
  v_mfma_f32_16x16x32_bf16 v[88:91], a[48:51], v[168:171], v[88:91]
  ds_read_b128 v[200:203], v19 offset:4096
  s_add_u32 m0, m0, 8192
  v_mfma_f32_16x16x32_bf16 v[92:95], a[52:55], v[168:171], v[92:95]
  s_cmp_lt_u32 m0, s46
  s_cselect_b32 m0, m0, s47
  buffer_store_dwordx4 v[240:243], v26, s[16:19], s21 offen offset:0 sc1
  v_mfma_f32_16x16x32_bf16 v[96:99], a[56:59], v[168:171], v[96:99]
  v_mfma_f32_16x16x32_bf16 v[100:103], a[48:51], v[172:175], v[100:103]
  ds_read_b128 v[204:207], v19 offset:6144
  v_mfma_f32_16x16x32_bf16 v[104:107], a[52:55], v[172:175], v[104:107]
  buffer_store_dwordx4 v[244:247], v26, s[16:19], s21 offen offset:1024 sc1
  v_mfma_f32_16x16x32_bf16 v[108:111], a[56:59], v[172:175], v[108:111]
  s_waitcnt vmcnt(14) lgkmcnt(2)
  s_barrier
  v_mfma_f32_16x16x32_bf16 v[64:67], a[60:63], v[192:195], v[64:67]
  ds_read_b128 v[160:163], v18 offset:0
  v_mfma_f32_16x16x32_bf16 v[68:71], a[64:67], v[192:195], v[68:71]
  v_mfma_f32_16x16x32_bf16 v[72:75], a[68:71], v[192:195], v[72:75]
  v_add_u32 v19, s33, v15
  s_add_u32 s33, s33, 8192
  v_mfma_f32_16x16x32_bf16 v[76:79], a[60:63], v[196:199], v[76:79]
  ds_read_b128 v[164:167], v18 offset:2048
  v_mfma_f32_16x16x32_bf16 v[80:83], a[64:67], v[196:199], v[80:83]
  buffer_load_dwordx4 v10, s[8:11], s30 offen offset:0 lds
  v_mfma_f32_16x16x32_bf16 v[84:87], a[68:71], v[196:199], v[84:87]
  s_waitcnt lgkmcnt(2)
  v_mfma_f32_16x16x32_bf16 v[88:91], a[60:63], v[200:203], v[88:91]
  ds_read_b128 v[168:171], v18 offset:4096
  v_mfma_f32_16x16x32_bf16 v[92:95], a[64:67], v[200:203], v[92:95]
  s_cmp_lt_u32 s33, 155648
  s_cselect_b32 s33, s33, 98304
  v_mfma_f32_16x16x32_bf16 v[96:99], a[68:71], v[200:203], v[96:99]
  v_mfma_f32_16x16x32_bf16 v[100:103], a[60:63], v[204:207], v[100:103]
  ds_read_b128 v[172:175], v18 offset:6144
  v_mfma_f32_16x16x32_bf16 v[104:107], a[64:67], v[204:207], v[104:107]
  v_mfma_f32_16x16x32_bf16 v[108:111], a[68:71], v[204:207], v[108:111]
  s_waitcnt lgkmcnt(2)
  v_mfma_f32_16x16x32_bf16 v[64:67], a[72:75], v[160:163], v[64:67]
  ds_read_b128 v[192:195], v19 offset:0
  v_mfma_f32_16x16x32_bf16 v[68:71], a[76:79], v[160:163], v[68:71]
  v_add_u32 v18, s33, v14
  v_mfma_f32_16x16x32_bf16 v[72:75], a[80:83], v[160:163], v[72:75]
  v_mfma_f32_16x16x32_bf16 v[76:79], a[72:75], v[164:167], v[76:79]
  ds_read_b128 v[196:199], v19 offset:2048
  v_mfma_f32_16x16x32_bf16 v[80:83], a[76:79], v[164:167], v[80:83]
  buffer_load_dwordx4 v11, s[8:11], s30 offen offset:1024 lds
  v_mfma_f32_16x16x32_bf16 v[84:87], a[80:83], v[164:167], v[84:87]
  s_waitcnt lgkmcnt(2)
  s_add_u32 s30, s30, 128
  v_mfma_f32_16x16x32_bf16 v[88:91], a[72:75], v[168:171], v[88:91]
  ds_read_b128 v[200:203], v19 offset:4096
  s_add_u32 m0, m0, 8192
  v_mfma_f32_16x16x32_bf16 v[92:95], a[76:79], v[168:171], v[92:95]
  s_cmp_lt_u32 m0, s46
  s_cselect_b32 m0, m0, s47
  v_mfma_f32_16x16x32_bf16 v[96:99], a[80:83], v[168:171], v[96:99]
  v_mfma_f32_16x16x32_bf16 v[100:103], a[72:75], v[172:175], v[100:103]
  ds_read_b128 v[204:207], v19 offset:6144
  v_mfma_f32_16x16x32_bf16 v[104:107], a[76:79], v[172:175], v[104:107]
  v_mfma_f32_16x16x32_bf16 v[108:111], a[80:83], v[172:175], v[108:111]
  s_waitcnt vmcnt(14) lgkmcnt(2)
  s_barrier
  v_mfma_f32_16x16x32_bf16 v[64:67], a[84:87], v[192:195], v[64:67]
  ds_read_b128 v[160:163], v18 offset:0
  v_mfma_f32_16x16x32_bf16 v[68:71], a[88:91], v[192:195], v[68:71]
  v_mfma_f32_16x16x32_bf16 v[72:75], a[92:95], v[192:195], v[72:75]
  v_add_u32 v19, s33, v15
  s_add_u32 s33, s33, 8192
  v_mfma_f32_16x16x32_bf16 v[76:79], a[84:87], v[196:199], v[76:79]
  ds_read_b128 v[164:167], v18 offset:2048
  v_mfma_f32_16x16x32_bf16 v[80:83], a[88:91], v[196:199], v[80:83]
  buffer_load_dwordx4 v10, s[8:11], s30 offen offset:0 lds
  v_mfma_f32_16x16x32_bf16 v[84:87], a[92:95], v[196:199], v[84:87]
  s_waitcnt lgkmcnt(2)
  v_mfma_f32_16x16x32_bf16 v[88:91], a[84:87], v[200:203], v[88:91]
  ds_read_b128 v[168:171], v18 offset:4096
  v_mfma_f32_16x16x32_bf16 v[92:95], a[88:91], v[200:203], v[92:95]
  s_cmp_lt_u32 s33, 155648
  s_cselect_b32 s33, s33, 98304
  v_mfma_f32_16x16x32_bf16 v[96:99], a[92:95], v[200:203], v[96:99]
  v_mfma_f32_16x16x32_bf16 v[100:103], a[84:87], v[204:207], v[100:103]
  ds_read_b128 v[172:175], v18 offset:6144
  v_mfma_f32_16x16x32_bf16 v[104:107], a[88:91], v[204:207], v[104:107]
  v_mfma_f32_16x16x32_bf16 v[108:111], a[92:95], v[204:207], v[108:111]
  s_waitcnt lgkmcnt(2)
  v_mfma_f32_16x16x32_bf16 v[64:67], a[96:99], v[160:163], v[64:67]
  ds_read_b128 v[192:195], v19 offset:0
  v_mfma_f32_16x16x32_bf16 v[68:71], a[100:103], v[160:163], v[68:71]
  v_add_u32 v18, s33, v14
  v_mfma_f32_16x16x32_bf16 v[72:75], a[104:107], v[160:163], v[72:75]
  v_mfma_f32_16x16x32_bf16 v[76:79], a[96:99], v[164:167], v[76:79]
  ds_read_b128 v[196:199], v19 offset:2048
  v_mfma_f32_16x16x32_bf16 v[80:83], a[100:103], v[164:167], v[80:83]
  buffer_load_dwordx4 v11, s[8:11], s30 offen offset:1024 lds
  v_mfma_f32_16x16x32_bf16 v[84:87], a[104:107], v[164:167], v[84:87]
  s_waitcnt lgkmcnt(2)
  s_add_u32 s30, s30, s25
  v_mfma_f32_16x16x32_bf16 v[88:91], a[96:99], v[168:171], v[88:91]
  ds_read_b128 v[200:203], v19 offset:4096
  s_sub_u32 s30, s30, 1152
  v_mfma_f32_16x16x32_bf16 v[92:95], a[100:103], v[168:171], v[92:95]
  s_add_u32 m0, m0, 8192
  v_mfma_f32_16x16x32_bf16 v[96:99], a[104:107], v[168:171], v[96:99]
  s_cmp_lt_u32 m0, s46
  s_cselect_b32 m0, m0, s47
  v_mfma_f32_16x16x32_bf16 v[100:103], a[96:99], v[172:175], v[100:103]
  ds_read_b128 v[204:207], v19 offset:6144
  v_mfma_f32_16x16x32_bf16 v[104:107], a[100:103], v[172:175], v[104:107]
  v_mfma_f32_16x16x32_bf16 v[108:111], a[104:107], v[172:175], v[108:111]
  s_waitcnt vmcnt(14) lgkmcnt(2)
  s_barrier
  v_mfma_f32_16x16x32_bf16 v[64:67], a[108:111], v[192:195], v[64:67]
  ds_read_b128 v[160:163], v18 offset:0
  v_mfma_f32_16x16x32_bf16 v[68:71], a[112:115], v[192:195], v[68:71]
  v_mfma_f32_16x16x32_bf16 v[72:75], a[116:119], v[192:195], v[72:75]
  v_add_u32 v19, s33, v15
  s_add_u32 s33, s33, 8192
  v_mfma_f32_16x16x32_bf16 v[76:79], a[108:111], v[196:199], v[76:79]
  ds_read_b128 v[164:167], v18 offset:2048
  v_mfma_f32_16x16x32_bf16 v[80:83], a[112:115], v[196:199], v[80:83]
  buffer_load_dwordx4 v10, s[8:11], s30 offen offset:0 lds
  v_mfma_f32_16x16x32_bf16 v[84:87], a[116:119], v[196:199], v[84:87]
  s_waitcnt lgkmcnt(2)
  v_mfma_f32_16x16x32_bf16 v[88:91], a[108:111], v[200:203], v[88:91]
  ds_read_b128 v[168:171], v18 offset:4096
  v_mfma_f32_16x16x32_bf16 v[92:95], a[112:115], v[200:203], v[92:95]
  s_cmp_lt_u32 s33, 155648
  s_cselect_b32 s33, s33, 98304
  v_mfma_f32_16x16x32_bf16 v[96:99], a[116:119], v[200:203], v[96:99]
  v_mfma_f32_16x16x32_bf16 v[100:103], a[108:111], v[204:207], v[100:103]
  ds_read_b128 v[172:175], v18 offset:6144
  v_mfma_f32_16x16x32_bf16 v[104:107], a[112:115], v[204:207], v[104:107]
  v_mfma_f32_16x16x32_bf16 v[108:111], a[116:119], v[204:207], v[108:111]
  s_waitcnt lgkmcnt(2)
  v_mfma_f32_16x16x32_bf16 v[64:67], a[120:123], v[160:163], v[64:67]
  ds_read_b128 v[192:195], v19 offset:0
  v_mfma_f32_16x16x32_bf16 v[68:71], a[124:127], v[160:163], v[68:71]
  v_add_u32 v18, s33, v14
  v_mfma_f32_16x16x32_bf16 v[72:75], a[128:131], v[160:163], v[72:75]
  v_mfma_f32_16x16x32_bf16 v[76:79], a[120:123], v[164:167], v[76:79]
  ds_read_b128 v[196:199], v19 offset:2048
  v_mfma_f32_16x16x32_bf16 v[80:83], a[124:127], v[164:167], v[80:83]
  buffer_load_dwordx4 v11, s[8:11], s30 offen offset:1024 lds
  v_mfma_f32_16x16x32_bf16 v[84:87], a[128:131], v[164:167], v[84:87]
  s_waitcnt lgkmcnt(2)
  s_add_u32 s30, s30, 128
  v_mfma_f32_16x16x32_bf16 v[88:91], a[120:123], v[168:171], v[88:91]
  ds_read_b128 v[200:203], v19 offset:4096
  s_add_u32 m0, m0, 8192
  v_mfma_f32_16x16x32_bf16 v[92:95], a[124:127], v[168:171], v[92:95]
  s_cmp_lt_u32 m0, s46
  s_cselect_b32 m0, m0, s47
  v_mfma_f32_16x16x32_bf16 v[96:99], a[128:131], v[168:171], v[96:99]
  v_mfma_f32_16x16x32_bf16 v[100:103], a[120:123], v[172:175], v[100:103]
  ds_read_b128 v[204:207], v19 offset:6144
  v_mfma_f32_16x16x32_bf16 v[104:107], a[124:127], v[172:175], v[104:107]
  v_mfma_f32_16x16x32_bf16 v[108:111], a[128:131], v[172:175], v[108:111]
  s_waitcnt vmcnt(14) lgkmcnt(2)
  s_barrier
  v_mfma_f32_16x16x32_bf16 v[64:67], a[132:135], v[192:195], v[64:67]
  ds_read_b128 v[160:163], v18 offset:0
  v_mfma_f32_16x16x32_bf16 v[68:71], a[136:139], v[192:195], v[68:71]
  v_mfma_f32_16x16x32_bf16 v[72:75], a[140:143], v[192:195], v[72:75]
  v_add_u32 v19, s33, v15
  s_add_u32 s33, s33, 8192
  v_mfma_f32_16x16x32_bf16 v[76:79], a[132:135], v[196:199], v[76:79]
  ds_read_b128 v[164:167], v18 offset:2048
  v_mfma_f32_16x16x32_bf16 v[80:83], a[136:139], v[196:199], v[80:83]
  buffer_load_dwordx4 v10, s[8:11], s30 offen offset:0 lds
  v_mfma_f32_16x16x32_bf16 v[84:87], a[140:143], v[196:199], v[84:87]
  s_waitcnt lgkmcnt(2)
  v_mfma_f32_16x16x32_bf16 v[88:91], a[132:135], v[200:203], v[88:91]
  ds_read_b128 v[168:171], v18 offset:4096
  v_mfma_f32_16x16x32_bf16 v[92:95], a[136:139], v[200:203], v[92:95]
  s_cmp_lt_u32 s33, 155648
  s_cselect_b32 s33, s33, 98304
  v_mfma_f32_16x16x32_bf16 v[96:99], a[140:143], v[200:203], v[96:99]
  v_mfma_f32_16x16x32_bf16 v[100:103], a[132:135], v[204:207], v[100:103]
  ds_read_b128 v[172:175], v18 offset:6144
  v_mfma_f32_16x16x32_bf16 v[104:107], a[136:139], v[204:207], v[104:107]
  v_mfma_f32_16x16x32_bf16 v[108:111], a[140:143], v[204:207], v[108:111]
  s_waitcnt lgkmcnt(2)
  v_mfma_f32_16x16x32_bf16 v[64:67], a[144:147], v[160:163], v[64:67]
  ds_read_b128 v[192:195], v19 offset:0
  v_mfma_f32_16x16x32_bf16 v[68:71], a[148:151], v[160:163], v[68:71]
  v_add_u32 v18, s33, v14
  v_mfma_f32_16x16x32_bf16 v[72:75], a[152:155], v[160:163], v[72:75]
  v_mfma_f32_16x16x32_bf16 v[76:79], a[144:147], v[164:167], v[76:79]
  ds_read_b128 v[196:199], v19 offset:2048
  v_mfma_f32_16x16x32_bf16 v[80:83], a[148:151], v[164:167], v[80:83]
  buffer_load_dwordx4 v11, s[8:11], s30 offen offset:1024 lds
  v_mfma_f32_16x16x32_bf16 v[84:87], a[152:155], v[164:167], v[84:87]
  s_waitcnt lgkmcnt(2)
  s_add_u32 s30, s30, 128
  v_mfma_f32_16x16x32_bf16 v[88:91], a[144:147], v[168:171], v[88:91]
  ds_read_b128 v[200:203], v19 offset:4096
  s_add_u32 m0, m0, 8192
  v_mfma_f32_16x16x32_bf16 v[92:95], a[148:151], v[168:171], v[92:95]
  s_cmp_lt_u32 m0, s46
  s_cselect_b32 m0, m0, s47
  v_mfma_f32_16x16x32_bf16 v[96:99], a[152:155], v[168:171], v[96:99]
  v_mfma_f32_16x16x32_bf16 v[100:103], a[144:147], v[172:175], v[100:103]
  ds_read_b128 v[204:207], v19 offset:6144
  v_mfma_f32_16x16x32_bf16 v[104:107], a[148:151], v[172:175], v[104:107]
  v_mfma_f32_16x16x32_bf16 v[108:111], a[152:155], v[172:175], v[108:111]
  s_waitcnt vmcnt(8) lgkmcnt(2)
  s_barrier
  v_mfma_f32_16x16x32_bf16 v[64:67], a[156:159], v[192:195], v[64:67]
  ds_read_b128 v[160:163], v18 offset:0
  v_mfma_f32_16x16x32_bf16 v[68:71], a[160:163], v[192:195], v[68:71]
  s_cmp_eq_u32 s48, 0x80000000
  s_cbranch_scc1 kvm_144
  s_cmp_lg_u32 s20, 0
  s_cbranch_scc1 af_145
  v_mov_b32 v4, 0
  v_mov_b32 v5, 1
  s_mov_b64 exec, 1
  buffer_atomic_add v5, v4, s[72:75], s61 offen sc1
  s_mov_b64 exec, -1
  s_nop 1
af_145:
kvm_144:
  v_mfma_f32_16x16x32_bf16 v[72:75], a[164:167], v[192:195], v[72:75]
  v_add_u32 v19, s33, v15
  s_add_u32 s33, s33, 8192
  v_mfma_f32_16x16x32_bf16 v[76:79], a[156:159], v[196:199], v[76:79]
  ds_read_b128 v[164:167], v18 offset:2048
  v_mfma_f32_16x16x32_bf16 v[80:83], a[160:163], v[196:199], v[80:83]
  buffer_load_dwordx4 v10, s[8:11], s30 offen offset:0 lds
  v_mfma_f32_16x16x32_bf16 v[84:87], a[164:167], v[196:199], v[84:87]
  s_waitcnt lgkmcnt(2)
  v_mfma_f32_16x16x32_bf16 v[88:91], a[156:159], v[200:203], v[88:91]
  ds_read_b128 v[168:171], v18 offset:4096
  v_mfma_f32_16x16x32_bf16 v[92:95], a[160:163], v[200:203], v[92:95]
  s_cmp_lt_u32 s33, 155648
  s_cselect_b32 s33, s33, 98304
  v_mfma_f32_16x16x32_bf16 v[96:99], a[164:167], v[200:203], v[96:99]
  v_mfma_f32_16x16x32_bf16 v[100:103], a[156:159], v[204:207], v[100:103]
  ds_read_b128 v[172:175], v18 offset:6144
  v_mfma_f32_16x16x32_bf16 v[104:107], a[160:163], v[204:207], v[104:107]
  v_mfma_f32_16x16x32_bf16 v[108:111], a[164:167], v[204:207], v[108:111]
  s_waitcnt lgkmcnt(2)
  v_mfma_f32_16x16x32_bf16 v[64:67], a[168:171], v[160:163], v[64:67]
  ds_read_b128 v[192:195], v19 offset:0
  v_mfma_f32_16x16x32_bf16 v[68:71], a[172:175], v[160:163], v[68:71]
  v_add_u32 v18, s33, v14
  s_mov_b32 s61, s60
  v_mfma_f32_16x16x32_bf16 v[72:75], a[176:179], v[160:163], v[72:75]
  s_add_u32 s60, s60, s62
  s_lshr_b32 s48, s20, 1
  v_mfma_f32_16x16x32_bf16 v[76:79], a[168:171], v[164:167], v[76:79]
  ds_read_b128 v[196:199], v19 offset:2048
  s_mul_i32 s48, s48, 393216
  v_mfma_f32_16x16x32_bf16 v[80:83], a[172:175], v[164:167], v[80:83]
  buffer_load_dwordx4 v11, s[8:11], s30 offen offset:1024 lds
  v_mfma_f32_16x16x32_bf16 v[84:87], a[176:179], v[164:167], v[84:87]
  s_waitcnt lgkmcnt(2)
  s_add_u32 s30, s30, 128
  v_mfma_f32_16x16x32_bf16 v[88:91], a[168:171], v[168:171], v[88:91]
  ds_read_b128 v[200:203], v19 offset:4096
  s_add_u32 m0, m0, 8192
  v_mfma_f32_16x16x32_bf16 v[92:95], a[172:175], v[168:171], v[92:95]
  s_cmp_lt_u32 m0, s46
  s_cselect_b32 m0, m0, s47
  v_mfma_f32_16x16x32_bf16 v[96:99], a[176:179], v[168:171], v[96:99]
  s_and_b32 s21, s20, 1
  s_mul_i32 s21, s21, 6144
  v_mfma_f32_16x16x32_bf16 v[100:103], a[168:171], v[172:175], v[100:103]
  ds_read_b128 v[204:207], v19 offset:6144
  s_add_u32 s48, s48, s21
  v_mfma_f32_16x16x32_bf16 v[104:107], a[172:175], v[172:175], v[104:107]
  s_add_u32 s48, s48, s27
  s_add_u32 s27, s27, s28
  v_mfma_f32_16x16x32_bf16 v[108:111], a[176:179], v[172:175], v[108:111]
  s_waitcnt vmcnt(8) lgkmcnt(2)
  s_barrier
  v_mfma_f32_16x16x32_bf16 v[64:67], a[180:183], v[192:195], v[64:67]
  ds_read_b128 v[160:163], v18 offset:0
  s_sub_u32 s26, s26, 1
  v_mfma_f32_16x16x32_bf16 v[68:71], a[184:187], v[192:195], v[68:71]
  v_mfma_f32_16x16x32_bf16 v[72:75], a[188:191], v[192:195], v[72:75]
  v_add_u32 v19, s33, v15
  s_add_u32 s33, s33, 8192
  v_mfma_f32_16x16x32_bf16 v[76:79], a[180:183], v[196:199], v[76:79]
  ds_read_b128 v[164:167], v18 offset:2048
  v_mfma_f32_16x16x32_bf16 v[80:83], a[184:187], v[196:199], v[80:83]
  buffer_load_dwordx4 v10, s[8:11], s30 offen offset:0 lds
  v_mfma_f32_16x16x32_bf16 v[84:87], a[188:191], v[196:199], v[84:87]
  s_waitcnt lgkmcnt(2)
  v_mfma_f32_16x16x32_bf16 v[88:91], a[180:183], v[200:203], v[88:91]
  ds_read_b128 v[168:171], v18 offset:4096
  v_mfma_f32_16x16x32_bf16 v[92:95], a[184:187], v[200:203], v[92:95]
  s_cmp_lt_u32 s33, 155648
  s_cselect_b32 s33, s33, 98304
  v_mfma_f32_16x16x32_bf16 v[96:99], a[188:191], v[200:203], v[96:99]
  v_mfma_f32_16x16x32_bf16 v[100:103], a[180:183], v[204:207], v[100:103]
  ds_read_b128 v[172:175], v18 offset:6144
  v_mfma_f32_16x16x32_bf16 v[104:107], a[184:187], v[204:207], v[104:107]
  v_mfma_f32_16x16x32_bf16 v[108:111], a[188:191], v[204:207], v[108:111]
  s_waitcnt lgkmcnt(2)
  v_mfma_f32_16x16x32_bf16 v[64:67], a[192:195], v[160:163], v[64:67]
  ds_read_b128 v[192:195], v19 offset:0
  v_mfma_f32_16x16x32_bf16 v[68:71], a[196:199], v[160:163], v[68:71]
  v_add_u32 v18, s33, v14
  v_mfma_f32_16x16x32_bf16 v[72:75], a[200:203], v[160:163], v[72:75]
  v_mfma_f32_16x16x32_bf16 v[76:79], a[192:195], v[164:167], v[76:79]
  ds_read_b128 v[196:199], v19 offset:2048
  v_mfma_f32_16x16x32_bf16 v[80:83], a[196:199], v[164:167], v[80:83]
  buffer_load_dwordx4 v11, s[8:11], s30 offen offset:1024 lds
  v_mfma_f32_16x16x32_bf16 v[84:87], a[200:203], v[164:167], v[84:87]
  s_waitcnt lgkmcnt(2)
  s_add_u32 s30, s30, 128
  v_mfma_f32_16x16x32_bf16 v[88:91], a[192:195], v[168:171], v[88:91]
  ds_read_b128 v[200:203], v19 offset:4096
  s_add_u32 m0, m0, 8192
  v_mfma_f32_16x16x32_bf16 v[92:95], a[196:199], v[168:171], v[92:95]
  s_cmp_lt_u32 m0, s46
  s_cselect_b32 m0, m0, s47
  v_mfma_f32_16x16x32_bf16 v[96:99], a[200:203], v[168:171], v[96:99]
  v_mfma_f32_16x16x32_bf16 v[100:103], a[192:195], v[172:175], v[100:103]
  ds_read_b128 v[204:207], v19 offset:6144
  v_mfma_f32_16x16x32_bf16 v[104:107], a[196:199], v[172:175], v[104:107]
  v_mfma_f32_16x16x32_bf16 v[108:111], a[200:203], v[172:175], v[108:111]
  s_waitcnt vmcnt(8) lgkmcnt(2)
  s_barrier
  v_mfma_f32_16x16x32_bf16 v[64:67], a[204:207], v[192:195], v[64:67]
  ds_read_b128 v[160:163], v18 offset:0
  v_mfma_f32_16x16x32_bf16 v[68:71], a[208:211], v[192:195], v[68:71]
  v_mfma_f32_16x16x32_bf16 v[72:75], a[212:215], v[192:195], v[72:75]
  v_add_u32 v19, s33, v15
  s_add_u32 s33, s33, 8192
  v_mfma_f32_16x16x32_bf16 v[76:79], a[204:207], v[196:199], v[76:79]
  ds_read_b128 v[164:167], v18 offset:2048
  v_mfma_f32_16x16x32_bf16 v[80:83], a[208:211], v[196:199], v[80:83]
  buffer_load_dwordx4 v10, s[8:11], s30 offen offset:0 lds
  v_mfma_f32_16x16x32_bf16 v[84:87], a[212:215], v[196:199], v[84:87]
  s_waitcnt lgkmcnt(2)
  v_mfma_f32_16x16x32_bf16 v[88:91], a[204:207], v[200:203], v[88:91]
  ds_read_b128 v[168:171], v18 offset:4096
  v_mfma_f32_16x16x32_bf16 v[92:95], a[208:211], v[200:203], v[92:95]
  s_cmp_lt_u32 s33, 155648
  s_cselect_b32 s33, s33, 98304
  v_mfma_f32_16x16x32_bf16 v[96:99], a[212:215], v[200:203], v[96:99]
  v_mfma_f32_16x16x32_bf16 v[100:103], a[204:207], v[204:207], v[100:103]
  ds_read_b128 v[172:175], v18 offset:6144
  v_mfma_f32_16x16x32_bf16 v[104:107], a[208:211], v[204:207], v[104:107]
  v_mfma_f32_16x16x32_bf16 v[108:111], a[212:215], v[204:207], v[108:111]
  s_waitcnt lgkmcnt(2)
  v_mfma_f32_16x16x32_bf16 v[64:67], a[216:219], v[160:163], v[64:67]
  ds_read_b128 v[192:195], v19 offset:0
  v_mfma_f32_16x16x32_bf16 v[68:71], a[220:223], v[160:163], v[68:71]
  v_add_u32 v18, s33, v14
  v_mfma_f32_16x16x32_bf16 v[72:75], a[224:227], v[160:163], v[72:75]
  v_mfma_f32_16x16x32_bf16 v[76:79], a[216:219], v[164:167], v[76:79]
  ds_read_b128 v[196:199], v19 offset:2048
  v_mfma_f32_16x16x32_bf16 v[80:83], a[220:223], v[164:167], v[80:83]
  buffer_load_dwordx4 v11, s[8:11], s30 offen offset:1024 lds
  v_mfma_f32_16x16x32_bf16 v[84:87], a[224:227], v[164:167], v[84:87]
  s_waitcnt lgkmcnt(2)
  s_add_u32 s30, s30, 128
  v_mfma_f32_16x16x32_bf16 v[88:91], a[216:219], v[168:171], v[88:91]
  ds_read_b128 v[200:203], v19 offset:4096
  s_add_u32 m0, m0, 8192
  v_mfma_f32_16x16x32_bf16 v[92:95], a[220:223], v[168:171], v[92:95]
  s_cmp_lt_u32 m0, s46
  s_cselect_b32 m0, m0, s47
  v_mfma_f32_16x16x32_bf16 v[96:99], a[224:227], v[168:171], v[96:99]
  v_mfma_f32_16x16x32_bf16 v[100:103], a[216:219], v[172:175], v[100:103]
  ds_read_b128 v[204:207], v19 offset:6144
  v_mfma_f32_16x16x32_bf16 v[104:107], a[220:223], v[172:175], v[104:107]
  v_mfma_f32_16x16x32_bf16 v[108:111], a[224:227], v[172:175], v[108:111]
  s_waitcnt vmcnt(8) lgkmcnt(2)
  s_barrier
  v_mfma_f32_16x16x32_bf16 v[64:67], a[228:231], v[192:195], v[64:67]
  ds_read_b128 v[160:163], v18 offset:0
  v_mfma_f32_16x16x32_bf16 v[68:71], a[232:235], v[192:195], v[68:71]
  v_mfma_f32_16x16x32_bf16 v[72:75], a[236:239], v[192:195], v[72:75]
  v_add_u32 v19, s33, v15
  s_add_u32 s33, s33, 8192
  v_mfma_f32_16x16x32_bf16 v[76:79], a[228:231], v[196:199], v[76:79]
  ds_read_b128 v[164:167], v18 offset:2048
  v_cvt_pk_bf16_f32 v224, v64, v65
  v_cvt_pk_bf16_f32 v225, v66, v67
  v_mfma_f32_16x16x32_bf16 v[80:83], a[232:235], v[196:199], v[80:83]
  buffer_load_dwordx4 v10, s[8:11], s30 offen offset:0 lds
  v_cvt_pk_bf16_f32 v226, v68, v69
  v_cvt_pk_bf16_f32 v227, v70, v71
  v_mfma_f32_16x16x32_bf16 v[84:87], a[236:239], v[196:199], v[84:87]
  s_waitcnt lgkmcnt(2)
  v_cvt_pk_bf16_f32 v228, v72, v73
  v_cvt_pk_bf16_f32 v229, v74, v75
  v_mfma_f32_16x16x32_bf16 v[88:91], a[228:231], v[200:203], v[88:91]
  ds_read_b128 v[168:171], v18 offset:4096
  ds_write_b64 v22, v[224:225] offset:0
  v_mfma_f32_16x16x32_bf16 v[92:95], a[232:235], v[200:203], v[92:95]
  s_cmp_lt_u32 s33, 155648
  s_cselect_b32 s33, s33, 98304
  ds_write_b64 v22, v[226:227] offset:8
  v_mfma_f32_16x16x32_bf16 v[96:99], a[236:239], v[200:203], v[96:99]
  ds_write_b64 v16, v[228:229] offset:64
  v_cvt_pk_bf16_f32 v230, v76, v77
  v_cvt_pk_bf16_f32 v231, v78, v79
  v_mfma_f32_16x16x32_bf16 v[100:103], a[228:231], v[204:207], v[100:103]
  ds_read_b128 v[172:175], v18 offset:6144
  v_cvt_pk_bf16_f32 v232, v80, v81
  v_cvt_pk_bf16_f32 v233, v82, v83
  v_cvt_pk_bf16_f32 v234, v84, v85
  v_mfma_f32_16x16x32_bf16 v[104:107], a[232:235], v[204:207], v[104:107]
  v_cvt_pk_bf16_f32 v235, v86, v87
  ds_write_b64 v22, v[230:231] offset:6400
  v_mfma_f32_16x16x32_bf16 v[108:111], a[236:239], v[204:207], v[108:111]
  ds_write_b64 v22, v[232:233] offset:6408
  ds_write_b64 v16, v[234:235] offset:6464
  v_cvt_pk_bf16_f32 v236, v88, v89
  v_cvt_pk_bf16_f32 v237, v90, v91
  v_cvt_pk_bf16_f32 v238, v92, v93
  v_cvt_pk_bf16_f32 v239, v94, v95
  v_cvt_pk_bf16_f32 v240, v96, v97
  v_cvt_pk_bf16_f32 v241, v98, v99
  ds_write_b64 v22, v[236:237] offset:12800
  ds_write_b64 v22, v[238:239] offset:12808
  ds_write_b64 v16, v[240:241] offset:12864
  v_cvt_pk_bf16_f32 v242, v100, v101
  v_cvt_pk_bf16_f32 v243, v102, v103
  v_cvt_pk_bf16_f32 v244, v104, v105
  v_cvt_pk_bf16_f32 v245, v106, v107
  v_cvt_pk_bf16_f32 v246, v108, v109
  v_cvt_pk_bf16_f32 v247, v110, v111
  ds_write_b64 v22, v[242:243] offset:19200
  ds_write_b64 v22, v[244:245] offset:19208
  ds_write_b64 v16, v[246:247] offset:19264
  s_waitcnt lgkmcnt(14)
  s_sub_u32 s21, s26, 1
  s_cmp_lt_u32 s21, 5
  s_cbranch_scc1 kvm_blk_146
  s_waitcnt lgkmcnt(0)
  s_barrier
  ds_read_b128 v[224:227], v23 offset:0
  ds_read_b128 v[228:231], v23 offset:64
  ds_read_b128 v[232:235], v23 offset:128
  ds_read_b128 v[236:239], v23 offset:192
  ds_read_b128 v[240:243], v23 offset:256
  ds_read_b128 v[244:247], v23 offset:320
  s_waitcnt lgkmcnt(0)
  s_add_u32 s21, s48, 0
  buffer_store_dwordx4 v[224:227], v26, s[16:19], s21 offen offset:0 sc1
  buffer_store_dwordx4 v[228:231], v26, s[16:19], s21 offen offset:1024 sc1
  buffer_store_dwordx4 v[232:235], v26, s[16:19], s21 offen offset:2048 sc1
  buffer_store_dwordx4 v[236:239], v26, s[16:19], s21 offen offset:3072 sc1
  s_add_u32 s21, s48, 4096
  buffer_store_dwordx4 v[240:243], v26, s[16:19], s21 offen offset:0 sc1
  buffer_store_dwordx4 v[244:247], v26, s[16:19], s21 offen offset:1024 sc1
  s_nop 1
  s_cmp_eq_u32 s26, 0
  s_cbranch_scc1 kvm_147
  s_waitcnt vmcnt(0)
  s_barrier
  s_cmp_lg_u32 s20, 0
  s_cbranch_scc1 af_148
  v_mov_b32 v4, 0
  v_mov_b32 v5, 1
  s_mov_b64 exec, 1
  buffer_atomic_add v5, v4, s[72:75], s61 offen sc1
  s_mov_b64 exec, -1
  s_nop 1
af_148:
  s_mov_b32 s48, 0x80000000
  s_branch kvm_blk_146
kvm_147:
  s_waitcnt vmcnt(6)
  s_barrier
  s_mov_b32 s24, 655360
  s_mov_b32 s25, 163840
  v_lshrrev_b32 v11, 3, v1
  v_and_b32 v12, 7, v1
  v_xor_b32 v12, v12, v11
  v_mul_u32_u24 v11, 1280, v11
  v_lshl_add_u32 v10, v12, 4, v11
  s_mul_i32 s46, s20, 40960
  v_add_u32 v10, s46, v10
  s_lshl_b32 s47, s20, 12
  s_add_u32 s47, s47, 0
  s_add_u32 s46, s47, 98304
  s_mov_b32 s30, s24
  s_add_u32 s32, s47, 32768
  v_add_u32 v11, 9216, v10
  v_add_u32 v12, 18432, v10
  v_add_u32 v13, 27648, v10
  s_mov_b32 m0, s32
  s_nop 0
  buffer_load_dwordx4 v10, s[8:11], s30 offen offset:0 lds
  buffer_load_dwordx4 v11, s[8:11], s30 offen offset:1024 lds
  buffer_load_dwordx4 v12, s[8:11], s30 offen offset:2048 lds
  buffer_load_dwordx4 v13, s[8:11], s30 offen offset:3072 lds
  s_add_u32 s30, s30, 128
  s_add_u32 s32, s32, 16384
  s_cmp_lt_u32 s32, s46
  s_cselect_b32 s32, s32, s47
  s_mov_b32 m0, s32
  s_nop 0
  buffer_load_dwordx4 v10, s[8:11], s30 offen offset:0 lds
  buffer_load_dwordx4 v11, s[8:11], s30 offen offset:1024 lds
  buffer_load_dwordx4 v12, s[8:11], s30 offen offset:2048 lds
  buffer_load_dwordx4 v13, s[8:11], s30 offen offset:3072 lds
  s_add_u32 s30, s30, 128
  s_add_u32 s32, s32, 16384
  s_cmp_lt_u32 s32, s46
  s_cselect_b32 s32, s32, s47
  s_mov_b32 m0, s32
  s_nop 0
  buffer_load_dwordx4 v10, s[8:11], s30 offen offset:0 lds
  buffer_load_dwordx4 v11, s[8:11], s30 offen offset:1024 lds
  buffer_load_dwordx4 v12, s[8:11], s30 offen offset:2048 lds
  buffer_load_dwordx4 v13, s[8:11], s30 offen offset:3072 lds
  s_add_u32 s30, s30, 128
  s_add_u32 s32, s32, 16384
  s_cmp_lt_u32 s32, s46
  s_cselect_b32 s32, s32, s47
  s_mov_b32 m0, s32
  s_nop 0
  buffer_load_dwordx4 v10, s[8:11], s30 offen offset:0 lds
  buffer_load_dwordx4 v11, s[8:11], s30 offen offset:1024 lds
  buffer_load_dwordx4 v12, s[8:11], s30 offen offset:2048 lds
  buffer_load_dwordx4 v13, s[8:11], s30 offen offset:3072 lds
  s_add_u32 s30, s30, 128
  s_add_u32 s32, s32, 16384
  s_cmp_lt_u32 s32, s46
  s_cselect_b32 s32, s32, s47
  s_waitcnt vmcnt(16)
  s_barrier
  s_cmp_lg_u32 s20, 0
  s_cbranch_scc1 af_149
  v_mov_b32 v4, 0
  v_mov_b32 v5, 1
  s_mov_b64 exec, 1
  buffer_atomic_add v5, v4, s[72:75], s61 offen sc1
  s_mov_b64 exec, -1
  s_nop 1
af_149:
  s_mov_b32 s26, 12
  s_mov_b32 s28, 1572864
kv_main:
  v_and_b32 v6, 7, v2
  v_add_u32 v4, 0, v3
  v_xor_b32 v4, v4, v6
  v_lshlrev_b32 v4, 4, v4
  v_lshl_add_u32 v14, v2, 7, v4
  v_add_u32 v4, 4, v3
  v_xor_b32 v4, v4, v6
  v_lshlrev_b32 v4, 4, v4
  v_lshl_add_u32 v15, v2, 7, v4
  v_mul_u32_u24 v22, 400, v2
  v_mul_u32_u24 v4, 16, v3
  s_mul_i32 s21, s20, 96
  s_add_u32 s21, s21, 98304
  v_add3_u32 v22, v22, v4, s21
  v_lshlrev_b32 v4, 3, v3
  v_sub_u32 v16, v22, v4
  v_mov_b32 v9, 2731
  s_mul_i32 s21, s20, 12800
  s_add_u32 s21, s21, 98304
  v_mul_u32_u24 v4, 400, v2
  v_lshlrev_b32 v5, 4, v3
  v_add3_u32 v23, v4, v5, s21
  v_lshlrev_b32 v26, 4, v1
  s_mov_b32 s33, 32768
  s_mov_b32 s48, 0x80000000
  s_mov_b32 m0, s32
  s_nop 0
  buffer_load_dwordx4 v10, s[8:11], s30 offen offset:0 lds
  buffer_load_dwordx4 v11, s[8:11], s30 offen offset:1024 lds
  s_waitcnt vmcnt(14)
  s_barrier
  v_add_u32 v18, s33, v14
  v_add_u32 v19, s33, v15
  s_add_u32 s33, s33, 16384
  s_cmp_lt_u32 s33, 98304
  s_cselect_b32 s33, s33, 0
  ds_read_b128 v[160:163], v18 offset:0
  ds_read_b128 v[164:167], v18 offset:2048
  ds_read_b128 v[168:171], v18 offset:4096
  ds_read_b128 v[172:175], v18 offset:6144
  ds_read_b128 v[176:179], v18 offset:8192
  ds_read_b128 v[180:183], v18 offset:10240
  ds_read_b128 v[184:187], v18 offset:12288
  ds_read_b128 v[188:191], v18 offset:14336
  s_waitcnt lgkmcnt(0)
kv_blk_152:
  v_mfma_f32_16x16x32_bf16 v[64:67], a[0:3], v[160:163], 0
  ds_read_b128 v[192:195], v19 offset:0
  v_mfma_f32_16x16x32_bf16 v[68:71], a[4:7], v[160:163], 0
  v_add_u32 v18, s33, v14
  v_mfma_f32_16x16x32_bf16 v[72:75], a[8:11], v[160:163], 0
  ds_write_b64 v16, v[234:235] offset:6464
  v_mfma_f32_16x16x32_bf16 v[76:79], a[0:3], v[164:167], 0
  ds_read_b128 v[196:199], v19 offset:2048
  v_cvt_pk_bf16_f32 v236, v88, v89
  v_mfma_f32_16x16x32_bf16 v[80:83], a[4:7], v[164:167], 0
  buffer_load_dwordx4 v12, s[8:11], s30 offen offset:2048 lds
  v_mfma_f32_16x16x32_bf16 v[84:87], a[8:11], v[164:167], 0
  v_cvt_pk_bf16_f32 v237, v90, v91
  v_cvt_pk_bf16_f32 v238, v92, v93
  v_mfma_f32_16x16x32_bf16 v[88:91], a[0:3], v[168:171], 0
  ds_read_b128 v[200:203], v19 offset:4096
  v_cvt_pk_bf16_f32 v239, v94, v95
  v_mfma_f32_16x16x32_bf16 v[92:95], a[4:7], v[168:171], 0
  v_cvt_pk_bf16_f32 v240, v96, v97
  v_cvt_pk_bf16_f32 v241, v98, v99
  v_mfma_f32_16x16x32_bf16 v[96:99], a[8:11], v[168:171], 0
  ds_write_b64 v22, v[236:237] offset:12800
  ds_write_b64 v22, v[238:239] offset:12808
  ds_write_b64 v16, v[240:241] offset:12864
  v_cvt_pk_bf16_f32 v242, v100, v101
  v_cvt_pk_bf16_f32 v243, v102, v103
  v_mfma_f32_16x16x32_bf16 v[100:103], a[0:3], v[172:175], 0
  ds_read_b128 v[204:207], v19 offset:6144
  v_cvt_pk_bf16_f32 v244, v104, v105
  v_cvt_pk_bf16_f32 v245, v106, v107
  v_mfma_f32_16x16x32_bf16 v[104:107], a[4:7], v[172:175], 0
  v_cvt_pk_bf16_f32 v246, v108, v109
  v_cvt_pk_bf16_f32 v247, v110, v111
  v_mfma_f32_16x16x32_bf16 v[108:111], a[8:11], v[172:175], 0
  s_waitcnt lgkmcnt(9)
  ds_write_b64 v22, v[242:243] offset:19200
  ds_write_b64 v22, v[244:245] offset:19208
  ds_write_b64 v16, v[246:247] offset:19264
  v_cvt_pk_bf16_f32 v224, v112, v113
  v_cvt_pk_bf16_f32 v225, v114, v115
  v_mfma_f32_16x16x32_bf16 v[112:115], a[0:3], v[176:179], 0
  ds_read_b128 v[208:211], v19 offset:8192
  v_cvt_pk_bf16_f32 v226, v116, v117
  v_cvt_pk_bf16_f32 v227, v118, v119
  v_mfma_f32_16x16x32_bf16 v[116:119], a[4:7], v[176:179], 0
  v_cvt_pk_bf16_f32 v228, v120, v121
  v_cvt_pk_bf16_f32 v229, v122, v123
  v_mfma_f32_16x16x32_bf16 v[120:123], a[8:11], v[176:179], 0
  ds_write_b64 v22, v[224:225] offset:25600
  ds_write_b64 v22, v[226:227] offset:25608
  ds_write_b64 v16, v[228:229] offset:25664
  v_cvt_pk_bf16_f32 v230, v124, v125
  v_cvt_pk_bf16_f32 v231, v126, v127
  v_mfma_f32_16x16x32_bf16 v[124:127], a[0:3], v[180:183], 0
  ds_read_b128 v[212:215], v19 offset:10240
  v_cvt_pk_bf16_f32 v232, v128, v129
  v_cvt_pk_bf16_f32 v233, v130, v131
  v_mfma_f32_16x16x32_bf16 v[128:131], a[4:7], v[180:183], 0
  buffer_load_dwordx4 v13, s[8:11], s30 offen offset:3072 lds
  v_cvt_pk_bf16_f32 v234, v132, v133
  v_cvt_pk_bf16_f32 v235, v134, v135
  v_mfma_f32_16x16x32_bf16 v[132:135], a[8:11], v[180:183], 0
  s_add_u32 s30, s30, 128
  s_add_u32 m0, m0, 16384
  ds_write_b64 v22, v[230:231] offset:32000
  ds_write_b64 v22, v[232:233] offset:32008
  ds_write_b64 v16, v[234:235] offset:32064
  v_cvt_pk_bf16_f32 v236, v136, v137
  v_cvt_pk_bf16_f32 v237, v138, v139
  v_mfma_f32_16x16x32_bf16 v[136:139], a[0:3], v[184:187], 0
  ds_read_b128 v[216:219], v19 offset:12288
  v_cvt_pk_bf16_f32 v238, v140, v141
  v_cvt_pk_bf16_f32 v239, v142, v143
  v_mfma_f32_16x16x32_bf16 v[140:143], a[4:7], v[184:187], 0
  s_cmp_lt_u32 m0, s46
  s_cselect_b32 m0, m0, s47
  v_cvt_pk_bf16_f32 v240, v144, v145
  v_cvt_pk_bf16_f32 v241, v146, v147
  v_mfma_f32_16x16x32_bf16 v[144:147], a[8:11], v[184:187], 0
  ds_write_b64 v22, v[236:237] offset:38400
  ds_write_b64 v22, v[238:239] offset:38408
  ds_write_b64 v16, v[240:241] offset:38464
  v_cvt_pk_bf16_f32 v242, v148, v149
  v_cvt_pk_bf16_f32 v243, v150, v151
  v_mfma_f32_16x16x32_bf16 v[148:151], a[0:3], v[188:191], 0
  ds_read_b128 v[220:223], v19 offset:14336
  v_cvt_pk_bf16_f32 v244, v152, v153
  v_cvt_pk_bf16_f32 v245, v154, v155
  v_mfma_f32_16x16x32_bf16 v[152:155], a[4:7], v[188:191], 0
  v_cvt_pk_bf16_f32 v246, v156, v157
  v_cvt_pk_bf16_f32 v247, v158, v159
  v_mfma_f32_16x16x32_bf16 v[156:159], a[8:11], v[188:191], 0
  s_waitcnt vmcnt(12) lgkmcnt(15)
  s_barrier
  v_mfma_f32_16x16x32_bf16 v[64:67], a[12:15], v[192:195], v[64:67]
  ds_read_b128 v[160:163], v18 offset:0
  v_mfma_f32_16x16x32_bf16 v[68:71], a[16:19], v[192:195], v[68:71]
  ds_write_b64 v22, v[242:243] offset:44800
  v_mfma_f32_16x16x32_bf16 v[72:75], a[20:23], v[192:195], v[72:75]
  v_add_u32 v19, s33, v15
  s_add_u32 s33, s33, 16384
  v_mfma_f32_16x16x32_bf16 v[76:79], a[12:15], v[196:199], v[76:79]
  ds_read_b128 v[164:167], v18 offset:2048
  v_mfma_f32_16x16x32_bf16 v[80:83], a[16:19], v[196:199], v[80:83]
  buffer_load_dwordx4 v10, s[8:11], s30 offen offset:0 lds
  v_mfma_f32_16x16x32_bf16 v[84:87], a[20:23], v[196:199], v[84:87]
  s_cmp_lt_u32 s33, 98304
  s_cselect_b32 s33, s33, 0
  v_mfma_f32_16x16x32_bf16 v[88:91], a[12:15], v[200:203], v[88:91]
  ds_read_b128 v[168:171], v18 offset:4096
  v_mfma_f32_16x16x32_bf16 v[92:95], a[16:19], v[200:203], v[92:95]
  ds_write_b64 v22, v[244:245] offset:44808
  v_mfma_f32_16x16x32_bf16 v[96:99], a[20:23], v[200:203], v[96:99]
  ds_write_b64 v16, v[246:247] offset:44864
  v_mfma_f32_16x16x32_bf16 v[100:103], a[12:15], v[204:207], v[100:103]
  ds_read_b128 v[172:175], v18 offset:6144
  v_mfma_f32_16x16x32_bf16 v[104:107], a[16:19], v[204:207], v[104:107]
  v_mfma_f32_16x16x32_bf16 v[108:111], a[20:23], v[204:207], v[108:111]
  s_waitcnt lgkmcnt(7)
  v_mfma_f32_16x16x32_bf16 v[112:115], a[12:15], v[208:211], v[112:115]
  ds_read_b128 v[176:179], v18 offset:8192
  v_mfma_f32_16x16x32_bf16 v[116:119], a[16:19], v[208:211], v[116:119]
  v_mfma_f32_16x16x32_bf16 v[120:123], a[20:23], v[208:211], v[120:123]
  v_mfma_f32_16x16x32_bf16 v[124:127], a[12:15], v[212:215], v[124:127]
  ds_read_b128 v[180:183], v18 offset:10240
  v_mfma_f32_16x16x32_bf16 v[128:131], a[16:19], v[212:215], v[128:131]
  buffer_load_dwordx4 v11, s[8:11], s30 offen offset:1024 lds
  v_mfma_f32_16x16x32_bf16 v[132:135], a[20:23], v[212:215], v[132:135]
  v_mfma_f32_16x16x32_bf16 v[136:139], a[12:15], v[216:219], v[136:139]
  ds_read_b128 v[184:187], v18 offset:12288
  v_mfma_f32_16x16x32_bf16 v[140:143], a[16:19], v[216:219], v[140:143]
  v_mfma_f32_16x16x32_bf16 v[144:147], a[20:23], v[216:219], v[144:147]
  v_mfma_f32_16x16x32_bf16 v[148:151], a[12:15], v[220:223], v[148:151]
  ds_read_b128 v[188:191], v18 offset:14336
  v_mfma_f32_16x16x32_bf16 v[152:155], a[16:19], v[220:223], v[152:155]
  v_mfma_f32_16x16x32_bf16 v[156:159], a[20:23], v[220:223], v[156:159]
  s_waitcnt lgkmcnt(4)
  v_mfma_f32_16x16x32_bf16 v[64:67], a[24:27], v[160:163], v[64:67]
  ds_read_b128 v[192:195], v19 offset:0
  v_mfma_f32_16x16x32_bf16 v[68:71], a[28:31], v[160:163], v[68:71]
  v_add_u32 v18, s33, v14
  v_mfma_f32_16x16x32_bf16 v[72:75], a[32:35], v[160:163], v[72:75]
  v_mfma_f32_16x16x32_bf16 v[76:79], a[24:27], v[164:167], v[76:79]
  ds_read_b128 v[196:199], v19 offset:2048
  v_mfma_f32_16x16x32_bf16 v[80:83], a[28:31], v[164:167], v[80:83]
  buffer_load_dwordx4 v12, s[8:11], s30 offen offset:2048 lds
  v_mfma_f32_16x16x32_bf16 v[84:87], a[32:35], v[164:167], v[84:87]
  v_mfma_f32_16x16x32_bf16 v[88:91], a[24:27], v[168:171], v[88:91]
  ds_read_b128 v[200:203], v19 offset:4096
  v_mfma_f32_16x16x32_bf16 v[92:95], a[28:31], v[168:171], v[92:95]
  v_mfma_f32_16x16x32_bf16 v[96:99], a[32:35], v[168:171], v[96:99]
  v_mfma_f32_16x16x32_bf16 v[100:103], a[24:27], v[172:175], v[100:103]
  ds_read_b128 v[204:207], v19 offset:6144
  v_mfma_f32_16x16x32_bf16 v[104:107], a[28:31], v[172:175], v[104:107]
  v_mfma_f32_16x16x32_bf16 v[108:111], a[32:35], v[172:175], v[108:111]
  s_waitcnt lgkmcnt(4)
  v_mfma_f32_16x16x32_bf16 v[112:115], a[24:27], v[176:179], v[112:115]
  ds_read_b128 v[208:211], v19 offset:8192
  v_mfma_f32_16x16x32_bf16 v[116:119], a[28:31], v[176:179], v[116:119]
  v_mfma_f32_16x16x32_bf16 v[120:123], a[32:35], v[176:179], v[120:123]
  v_mfma_f32_16x16x32_bf16 v[124:127], a[24:27], v[180:183], v[124:127]
  ds_read_b128 v[212:215], v19 offset:10240
  v_mfma_f32_16x16x32_bf16 v[128:131], a[28:31], v[180:183], v[128:131]
  buffer_load_dwordx4 v13, s[8:11], s30 offen offset:3072 lds
  v_mfma_f32_16x16x32_bf16 v[132:135], a[32:35], v[180:183], v[132:135]
  s_add_u32 s30, s30, 128
  s_add_u32 m0, m0, 16384
  v_mfma_f32_16x16x32_bf16 v[136:139], a[24:27], v[184:187], v[136:139]
  ds_read_b128 v[216:219], v19 offset:12288
  v_mfma_f32_16x16x32_bf16 v[140:143], a[28:31], v[184:187], v[140:143]
  s_cmp_lt_u32 m0, s46
  s_cselect_b32 m0, m0, s47
  v_mfma_f32_16x16x32_bf16 v[144:147], a[32:35], v[184:187], v[144:147]
  v_mfma_f32_16x16x32_bf16 v[148:151], a[24:27], v[188:191], v[148:151]
  ds_read_b128 v[220:223], v19 offset:14336
  v_mfma_f32_16x16x32_bf16 v[152:155], a[28:31], v[188:191], v[152:155]
  v_mfma_f32_16x16x32_bf16 v[156:159], a[32:35], v[188:191], v[156:159]
  s_waitcnt vmcnt(12) lgkmcnt(4)
  s_barrier
  v_mfma_f32_16x16x32_bf16 v[64:67], a[36:39], v[192:195], v[64:67]
  ds_read_b128 v[160:163], v18 offset:0
  v_mfma_f32_16x16x32_bf16 v[68:71], a[40:43], v[192:195], v[68:71]
  v_mfma_f32_16x16x32_bf16 v[72:75], a[44:47], v[192:195], v[72:75]
  v_add_u32 v19, s33, v15
  s_add_u32 s33, s33, 16384
  v_mfma_f32_16x16x32_bf16 v[76:79], a[36:39], v[196:199], v[76:79]
  ds_read_b128 v[164:167], v18 offset:2048
  v_mfma_f32_16x16x32_bf16 v[80:83], a[40:43], v[196:199], v[80:83]
  buffer_load_dwordx4 v10, s[8:11], s30 offen offset:0 lds
  v_mfma_f32_16x16x32_bf16 v[84:87], a[44:47], v[196:199], v[84:87]
  s_cmp_lt_u32 s33, 98304
  s_cselect_b32 s33, s33, 0
  v_mfma_f32_16x16x32_bf16 v[88:91], a[36:39], v[200:203], v[88:91]
  ds_read_b128 v[168:171], v18 offset:4096
  v_mfma_f32_16x16x32_bf16 v[92:95], a[40:43], v[200:203], v[92:95]
  ds_read_b128 v[224:227], v23 offset:0
  v_mfma_f32_16x16x32_bf16 v[96:99], a[44:47], v[200:203], v[96:99]
  v_mfma_f32_16x16x32_bf16 v[100:103], a[36:39], v[204:207], v[100:103]
  ds_read_b128 v[172:175], v18 offset:6144
  v_mfma_f32_16x16x32_bf16 v[104:107], a[40:43], v[204:207], v[104:107]
  v_mfma_f32_16x16x32_bf16 v[108:111], a[44:47], v[204:207], v[108:111]
  s_waitcnt lgkmcnt(5)
  v_mfma_f32_16x16x32_bf16 v[112:115], a[36:39], v[208:211], v[112:115]
  ds_read_b128 v[176:179], v18 offset:8192
  v_mfma_f32_16x16x32_bf16 v[116:119], a[40:43], v[208:211], v[116:119]
  v_mfma_f32_16x16x32_bf16 v[120:123], a[44:47], v[208:211], v[120:123]
  v_mfma_f32_16x16x32_bf16 v[124:127], a[36:39], v[212:215], v[124:127]
  ds_read_b128 v[180:183], v18 offset:10240
  v_mfma_f32_16x16x32_bf16 v[128:131], a[40:43], v[212:215], v[128:131]
  buffer_load_dwordx4 v11, s[8:11], s30 offen offset:1024 lds
  v_mfma_f32_16x16x32_bf16 v[132:135], a[44:47], v[212:215], v[132:135]
  v_mfma_f32_16x16x32_bf16 v[136:139], a[36:39], v[216:219], v[136:139]
  ds_read_b128 v[184:187], v18 offset:12288
  v_mfma_f32_16x16x32_bf16 v[140:143], a[40:43], v[216:219], v[140:143]
  ds_read_b128 v[228:231], v23 offset:64
  v_mfma_f32_16x16x32_bf16 v[144:147], a[44:47], v[216:219], v[144:147]
  v_mfma_f32_16x16x32_bf16 v[148:151], a[36:39], v[220:223], v[148:151]
  ds_read_b128 v[188:191], v18 offset:14336
  v_mfma_f32_16x16x32_bf16 v[152:155], a[40:43], v[220:223], v[152:155]
  v_mfma_f32_16x16x32_bf16 v[156:159], a[44:47], v[220:223], v[156:159]
  s_waitcnt lgkmcnt(5)
  v_mfma_f32_16x16x32_bf16 v[64:67], a[48:51], v[160:163], v[64:67]
  ds_read_b128 v[192:195], v19 offset:0
  v_mfma_f32_16x16x32_bf16 v[68:71], a[52:55], v[160:163], v[68:71]
  v_add_u32 v18, s33, v14
  v_mfma_f32_16x16x32_bf16 v[72:75], a[56:59], v[160:163], v[72:75]
  v_mfma_f32_16x16x32_bf16 v[76:79], a[48:51], v[164:167], v[76:79]
  ds_read_b128 v[196:199], v19 offset:2048
  v_mfma_f32_16x16x32_bf16 v[80:83], a[52:55], v[164:167], v[80:83]
  buffer_load_dwordx4 v12, s[8:11], s30 offen offset:2048 lds
  v_mfma_f32_16x16x32_bf16 v[84:87], a[56:59], v[164:167], v[84:87]
  v_mfma_f32_16x16x32_bf16 v[88:91], a[48:51], v[168:171], v[88:91]
  ds_read_b128 v[200:203], v19 offset:4096
  v_mfma_f32_16x16x32_bf16 v[92:95], a[52:55], v[168:171], v[92:95]
  s_add_u32 s21, s48, 0
  ds_read_b128 v[232:235], v23 offset:128
  v_mfma_f32_16x16x32_bf16 v[96:99], a[56:59], v[168:171], v[96:99]
  v_mfma_f32_16x16x32_bf16 v[100:103], a[48:51], v[172:175], v[100:103]
  ds_read_b128 v[204:207], v19 offset:6144
  v_mfma_f32_16x16x32_bf16 v[104:107], a[52:55], v[172:175], v[104:107]
  buffer_store_dwordx4 v[224:227], v26, s[16:19], s21 offen offset:0 sc1
  v_mfma_f32_16x16x32_bf16 v[108:111], a[56:59], v[172:175], v[108:111]
  s_waitcnt lgkmcnt(5)
  v_mfma_f32_16x16x32_bf16 v[112:115], a[48:51], v[176:179], v[112:115]
  ds_read_b128 v[208:211], v19 offset:8192
  v_mfma_f32_16x16x32_bf16 v[116:119], a[52:55], v[176:179], v[116:119]
  v_mfma_f32_16x16x32_bf16 v[120:123], a[56:59], v[176:179], v[120:123]
  v_mfma_f32_16x16x32_bf16 v[124:127], a[48:51], v[180:183], v[124:127]
  ds_read_b128 v[212:215], v19 offset:10240
  v_mfma_f32_16x16x32_bf16 v[128:131], a[52:55], v[180:183], v[128:131]
  buffer_load_dwordx4 v13, s[8:11], s30 offen offset:3072 lds
  v_mfma_f32_16x16x32_bf16 v[132:135], a[56:59], v[180:183], v[132:135]
  s_add_u32 s30, s30, 128
  s_add_u32 m0, m0, 16384
  v_mfma_f32_16x16x32_bf16 v[136:139], a[48:51], v[184:187], v[136:139]
  ds_read_b128 v[216:219], v19 offset:12288
  v_mfma_f32_16x16x32_bf16 v[140:143], a[52:55], v[184:187], v[140:143]
  s_cmp_lt_u32 m0, s46
  s_cselect_b32 m0, m0, s47
  v_mfma_f32_16x16x32_bf16 v[144:147], a[56:59], v[184:187], v[144:147]
  ds_read_b128 v[236:239], v23 offset:192
  v_mfma_f32_16x16x32_bf16 v[148:151], a[48:51], v[188:191], v[148:151]
  ds_read_b128 v[220:223], v19 offset:14336
  v_mfma_f32_16x16x32_bf16 v[152:155], a[52:55], v[188:191], v[152:155]
  buffer_store_dwordx4 v[228:231], v26, s[16:19], s21 offen offset:1024 sc1
  v_mfma_f32_16x16x32_bf16 v[156:159], a[56:59], v[188:191], v[156:159]
  s_waitcnt vmcnt(14) lgkmcnt(5)
  s_barrier
  v_mfma_f32_16x16x32_bf16 v[64:67], a[60:63], v[192:195], v[64:67]
  ds_read_b128 v[160:163], v18 offset:0
  v_mfma_f32_16x16x32_bf16 v[68:71], a[64:67], v[192:195], v[68:71]
  v_mfma_f32_16x16x32_bf16 v[72:75], a[68:71], v[192:195], v[72:75]
  v_add_u32 v19, s33, v15
  s_add_u32 s33, s33, 16384
  v_mfma_f32_16x16x32_bf16 v[76:79], a[60:63], v[196:199], v[76:79]
  ds_read_b128 v[164:167], v18 offset:2048
  v_mfma_f32_16x16x32_bf16 v[80:83], a[64:67], v[196:199], v[80:83]
  buffer_load_dwordx4 v10, s[8:11], s30 offen offset:0 lds
  v_mfma_f32_16x16x32_bf16 v[84:87], a[68:71], v[196:199], v[84:87]
  s_cmp_lt_u32 s33, 98304
  s_cselect_b32 s33, s33, 0
  v_mfma_f32_16x16x32_bf16 v[88:91], a[60:63], v[200:203], v[88:91]
  ds_read_b128 v[168:171], v18 offset:4096
  v_mfma_f32_16x16x32_bf16 v[92:95], a[64:67], v[200:203], v[92:95]
  ds_read_b128 v[240:243], v23 offset:256
  v_mfma_f32_16x16x32_bf16 v[96:99], a[68:71], v[200:203], v[96:99]
  v_mfma_f32_16x16x32_bf16 v[100:103], a[60:63], v[204:207], v[100:103]
  ds_read_b128 v[172:175], v18 offset:6144
  v_mfma_f32_16x16x32_bf16 v[104:107], a[64:67], v[204:207], v[104:107]
  buffer_store_dwordx4 v[232:235], v26, s[16:19], s21 offen offset:2048 sc1
  v_mfma_f32_16x16x32_bf16 v[108:111], a[68:71], v[204:207], v[108:111]
  s_waitcnt lgkmcnt(5)
  v_mfma_f32_16x16x32_bf16 v[112:115], a[60:63], v[208:211], v[112:115]
  ds_read_b128 v[176:179], v18 offset:8192
  v_mfma_f32_16x16x32_bf16 v[116:119], a[64:67], v[208:211], v[116:119]
  v_mfma_f32_16x16x32_bf16 v[120:123], a[68:71], v[208:211], v[120:123]
  v_mfma_f32_16x16x32_bf16 v[124:127], a[60:63], v[212:215], v[124:127]
  ds_read_b128 v[180:183], v18 offset:10240
  v_mfma_f32_16x16x32_bf16 v[128:131], a[64:67], v[212:215], v[128:131]
  buffer_load_dwordx4 v11, s[8:11], s30 offen offset:1024 lds
  v_mfma_f32_16x16x32_bf16 v[132:135], a[68:71], v[212:215], v[132:135]
  v_mfma_f32_16x16x32_bf16 v[136:139], a[60:63], v[216:219], v[136:139]
  ds_read_b128 v[184:187], v18 offset:12288
  v_mfma_f32_16x16x32_bf16 v[140:143], a[64:67], v[216:219], v[140:143]
  ds_read_b128 v[244:247], v23 offset:320
  v_mfma_f32_16x16x32_bf16 v[144:147], a[68:71], v[216:219], v[144:147]
  v_mfma_f32_16x16x32_bf16 v[148:151], a[60:63], v[220:223], v[148:151]
  ds_read_b128 v[188:191], v18 offset:14336
  v_mfma_f32_16x16x32_bf16 v[152:155], a[64:67], v[220:223], v[152:155]
  buffer_store_dwordx4 v[236:239], v26, s[16:19], s21 offen offset:3072 sc1
  v_mfma_f32_16x16x32_bf16 v[156:159], a[68:71], v[220:223], v[156:159]
  s_waitcnt lgkmcnt(5)
  v_mfma_f32_16x16x32_bf16 v[64:67], a[72:75], v[160:163], v[64:67]
  ds_read_b128 v[192:195], v19 offset:0
  v_mfma_f32_16x16x32_bf16 v[68:71], a[76:79], v[160:163], v[68:71]
  v_add_u32 v18, s33, v14
  v_mfma_f32_16x16x32_bf16 v[72:75], a[80:83], v[160:163], v[72:75]
  v_mfma_f32_16x16x32_bf16 v[76:79], a[72:75], v[164:167], v[76:79]
  ds_read_b128 v[196:199], v19 offset:2048
  v_mfma_f32_16x16x32_bf16 v[80:83], a[76:79], v[164:167], v[80:83]
  buffer_load_dwordx4 v12, s[8:11], s30 offen offset:2048 lds
  v_mfma_f32_16x16x32_bf16 v[84:87], a[80:83], v[164:167], v[84:87]
  v_mfma_f32_16x16x32_bf16 v[88:91], a[72:75], v[168:171], v[88:91]
  ds_read_b128 v[200:203], v19 offset:4096
  v_mfma_f32_16x16x32_bf16 v[92:95], a[76:79], v[168:171], v[92:95]
  s_add_u32 s21, s48, 4096
  ds_read_b128 v[224:227], v23 offset:6400
  v_mfma_f32_16x16x32_bf16 v[96:99], a[80:83], v[168:171], v[96:99]
  v_mfma_f32_16x16x32_bf16 v[100:103], a[72:75], v[172:175], v[100:103]
  ds_read_b128 v[204:207], v19 offset:6144
  v_mfma_f32_16x16x32_bf16 v[104:107], a[76:79], v[172:175], v[104:107]
  buffer_store_dwordx4 v[240:243], v26, s[16:19], s21 offen offset:0 sc1
  v_mfma_f32_16x16x32_bf16 v[108:111], a[80:83], v[172:175], v[108:111]
  s_waitcnt lgkmcnt(5)
  v_mfma_f32_16x16x32_bf16 v[112:115], a[72:75], v[176:179], v[112:115]
  ds_read_b128 v[208:211], v19 offset:8192
  v_mfma_f32_16x16x32_bf16 v[116:119], a[76:79], v[176:179], v[116:119]
  v_mfma_f32_16x16x32_bf16 v[120:123], a[80:83], v[176:179], v[120:123]
  v_mfma_f32_16x16x32_bf16 v[124:127], a[72:75], v[180:183], v[124:127]
  ds_read_b128 v[212:215], v19 offset:10240
  v_mfma_f32_16x16x32_bf16 v[128:131], a[76:79], v[180:183], v[128:131]
  buffer_load_dwordx4 v13, s[8:11], s30 offen offset:3072 lds
  v_mfma_f32_16x16x32_bf16 v[132:135], a[80:83], v[180:183], v[132:135]
  s_add_u32 s30, s30, 128
  s_add_u32 m0, m0, 16384
  v_mfma_f32_16x16x32_bf16 v[136:139], a[72:75], v[184:187], v[136:139]
  ds_read_b128 v[216:219], v19 offset:12288
  v_mfma_f32_16x16x32_bf16 v[140:143], a[76:79], v[184:187], v[140:143]
  s_cmp_lt_u32 m0, s46
  s_cselect_b32 m0, m0, s47
  v_mfma_f32_16x16x32_bf16 v[144:147], a[80:83], v[184:187], v[144:147]
  ds_read_b128 v[228:231], v23 offset:6464
  v_mfma_f32_16x16x32_bf16 v[148:151], a[72:75], v[188:191], v[148:151]
  ds_read_b128 v[220:223], v19 offset:14336
  v_mfma_f32_16x16x32_bf16 v[152:155], a[76:79], v[188:191], v[152:155]
  buffer_store_dwordx4 v[244:247], v26, s[16:19], s21 offen offset:1024 sc1
  v_mfma_f32_16x16x32_bf16 v[156:159], a[80:83], v[188:191], v[156:159]
  s_waitcnt vmcnt(18) lgkmcnt(5)
  s_barrier
  v_mfma_f32_16x16x32_bf16 v[64:67], a[84:87], v[192:195], v[64:67]
  ds_read_b128 v[160:163], v18 offset:0
  v_mfma_f32_16x16x32_bf16 v[68:71], a[88:91], v[192:195], v[68:71]
  v_mfma_f32_16x16x32_bf16 v[72:75], a[92:95], v[192:195], v[72:75]
  v_add_u32 v19, s33, v15
  s_add_u32 s33, s33, 16384
  v_mfma_f32_16x16x32_bf16 v[76:79], a[84:87], v[196:199], v[76:79]
  ds_read_b128 v[164:167], v18 offset:2048
  v_mfma_f32_16x16x32_bf16 v[80:83], a[88:91], v[196:199], v[80:83]
  buffer_load_dwordx4 v10, s[8:11], s30 offen offset:0 lds
  v_mfma_f32_16x16x32_bf16 v[84:87], a[92:95], v[196:199], v[84:87]
  s_cmp_lt_u32 s33, 98304
  s_cselect_b32 s33, s33, 0
  v_mfma_f32_16x16x32_bf16 v[88:91], a[84:87], v[200:203], v[88:91]
  ds_read_b128 v[168:171], v18 offset:4096
  v_mfma_f32_16x16x32_bf16 v[92:95], a[88:91], v[200:203], v[92:95]
  ds_read_b128 v[232:235], v23 offset:6528
  v_mfma_f32_16x16x32_bf16 v[96:99], a[92:95], v[200:203], v[96:99]
  v_mfma_f32_16x16x32_bf16 v[100:103], a[84:87], v[204:207], v[100:103]
  ds_read_b128 v[172:175], v18 offset:6144
  v_mfma_f32_16x16x32_bf16 v[104:107], a[88:91], v[204:207], v[104:107]
  buffer_store_dwordx4 v[224:227], v26, s[16:19], s21 offen offset:2048 sc1
  v_mfma_f32_16x16x32_bf16 v[108:111], a[92:95], v[204:207], v[108:111]
  s_waitcnt lgkmcnt(5)
  v_mfma_f32_16x16x32_bf16 v[112:115], a[84:87], v[208:211], v[112:115]
  ds_read_b128 v[176:179], v18 offset:8192
  v_mfma_f32_16x16x32_bf16 v[116:119], a[88:91], v[208:211], v[116:119]
  v_mfma_f32_16x16x32_bf16 v[120:123], a[92:95], v[208:211], v[120:123]
  v_mfma_f32_16x16x32_bf16 v[124:127], a[84:87], v[212:215], v[124:127]
  ds_read_b128 v[180:183], v18 offset:10240
  v_mfma_f32_16x16x32_bf16 v[128:131], a[88:91], v[212:215], v[128:131]
  buffer_load_dwordx4 v11, s[8:11], s30 offen offset:1024 lds
  v_mfma_f32_16x16x32_bf16 v[132:135], a[92:95], v[212:215], v[132:135]
  v_mfma_f32_16x16x32_bf16 v[136:139], a[84:87], v[216:219], v[136:139]
  ds_read_b128 v[184:187], v18 offset:12288
  v_mfma_f32_16x16x32_bf16 v[140:143], a[88:91], v[216:219], v[140:143]
  ds_read_b128 v[236:239], v23 offset:6592
  v_mfma_f32_16x16x32_bf16 v[144:147], a[92:95], v[216:219], v[144:147]
  v_mfma_f32_16x16x32_bf16 v[148:151], a[84:87], v[220:223], v[148:151]
  ds_read_b128 v[188:191], v18 offset:14336
  v_mfma_f32_16x16x32_bf16 v[152:155], a[88:91], v[220:223], v[152:155]
  buffer_store_dwordx4 v[228:231], v26, s[16:19], s21 offen offset:3072 sc1
  v_mfma_f32_16x16x32_bf16 v[156:159], a[92:95], v[220:223], v[156:159]
  s_waitcnt lgkmcnt(5)
  v_mfma_f32_16x16x32_bf16 v[64:67], a[96:99], v[160:163], v[64:67]
  ds_read_b128 v[192:195], v19 offset:0
  v_mfma_f32_16x16x32_bf16 v[68:71], a[100:103], v[160:163], v[68:71]
  v_add_u32 v18, s33, v14
  v_mfma_f32_16x16x32_bf16 v[72:75], a[104:107], v[160:163], v[72:75]
  v_mfma_f32_16x16x32_bf16 v[76:79], a[96:99], v[164:167], v[76:79]
  ds_read_b128 v[196:199], v19 offset:2048
  v_mfma_f32_16x16x32_bf16 v[80:83], a[100:103], v[164:167], v[80:83]
  buffer_load_dwordx4 v12, s[8:11], s30 offen offset:2048 lds
  v_mfma_f32_16x16x32_bf16 v[84:87], a[104:107], v[164:167], v[84:87]
  v_mfma_f32_16x16x32_bf16 v[88:91], a[96:99], v[168:171], v[88:91]
  ds_read_b128 v[200:203], v19 offset:4096
  v_mfma_f32_16x16x32_bf16 v[92:95], a[100:103], v[168:171], v[92:95]
  s_add_u32 s21, s48, 8192
  ds_read_b128 v[240:243], v23 offset:6656
  v_mfma_f32_16x16x32_bf16 v[96:99], a[104:107], v[168:171], v[96:99]
  v_mfma_f32_16x16x32_bf16 v[100:103], a[96:99], v[172:175], v[100:103]
  ds_read_b128 v[204:207], v19 offset:6144
  v_mfma_f32_16x16x32_bf16 v[104:107], a[100:103], v[172:175], v[104:107]
  buffer_store_dwordx4 v[232:235], v26, s[16:19], s21 offen offset:0 sc1
  v_mfma_f32_16x16x32_bf16 v[108:111], a[104:107], v[172:175], v[108:111]
  s_waitcnt lgkmcnt(5)
  v_mfma_f32_16x16x32_bf16 v[112:115], a[96:99], v[176:179], v[112:115]
  ds_read_b128 v[208:211], v19 offset:8192
  v_mfma_f32_16x16x32_bf16 v[116:119], a[100:103], v[176:179], v[116:119]
  v_mfma_f32_16x16x32_bf16 v[120:123], a[104:107], v[176:179], v[120:123]
  v_mfma_f32_16x16x32_bf16 v[124:127], a[96:99], v[180:183], v[124:127]
  ds_read_b128 v[212:215], v19 offset:10240
  v_mfma_f32_16x16x32_bf16 v[128:131], a[100:103], v[180:183], v[128:131]
  buffer_load_dwordx4 v13, s[8:11], s30 offen offset:3072 lds
  v_mfma_f32_16x16x32_bf16 v[132:135], a[104:107], v[180:183], v[132:135]
  s_add_u32 s30, s30, 128
  s_add_u32 m0, m0, 16384
  v_mfma_f32_16x16x32_bf16 v[136:139], a[96:99], v[184:187], v[136:139]
  ds_read_b128 v[216:219], v19 offset:12288
  v_mfma_f32_16x16x32_bf16 v[140:143], a[100:103], v[184:187], v[140:143]
  s_cmp_lt_u32 m0, s46
  s_cselect_b32 m0, m0, s47
  v_mfma_f32_16x16x32_bf16 v[144:147], a[104:107], v[184:187], v[144:147]
  ds_read_b128 v[244:247], v23 offset:6720
  v_mfma_f32_16x16x32_bf16 v[148:151], a[96:99], v[188:191], v[148:151]
  ds_read_b128 v[220:223], v19 offset:14336
  v_mfma_f32_16x16x32_bf16 v[152:155], a[100:103], v[188:191], v[152:155]
  buffer_store_dwordx4 v[236:239], v26, s[16:19], s21 offen offset:1024 sc1
  v_mfma_f32_16x16x32_bf16 v[156:159], a[104:107], v[188:191], v[156:159]
  s_waitcnt vmcnt(22) lgkmcnt(5)
  s_barrier
  v_mfma_f32_16x16x32_bf16 v[64:67], a[108:111], v[192:195], v[64:67]
  ds_read_b128 v[160:163], v18 offset:0
  v_mfma_f32_16x16x32_bf16 v[68:71], a[112:115], v[192:195], v[68:71]
  v_mfma_f32_16x16x32_bf16 v[72:75], a[116:119], v[192:195], v[72:75]
  v_add_u32 v19, s33, v15
  s_add_u32 s33, s33, 16384
  v_mfma_f32_16x16x32_bf16 v[76:79], a[108:111], v[196:199], v[76:79]
  ds_read_b128 v[164:167], v18 offset:2048
  v_mfma_f32_16x16x32_bf16 v[80:83], a[112:115], v[196:199], v[80:83]
  buffer_load_dwordx4 v10, s[8:11], s30 offen offset:0 lds
  v_mfma_f32_16x16x32_bf16 v[84:87], a[116:119], v[196:199], v[84:87]
  s_cmp_lt_u32 s33, 98304
  s_cselect_b32 s33, s33, 0
  v_mfma_f32_16x16x32_bf16 v[88:91], a[108:111], v[200:203], v[88:91]
  ds_read_b128 v[168:171], v18 offset:4096
  v_mfma_f32_16x16x32_bf16 v[92:95], a[112:115], v[200:203], v[92:95]
  v_mfma_f32_16x16x32_bf16 v[96:99], a[116:119], v[200:203], v[96:99]
  v_mfma_f32_16x16x32_bf16 v[100:103], a[108:111], v[204:207], v[100:103]
  ds_read_b128 v[172:175], v18 offset:6144
  v_mfma_f32_16x16x32_bf16 v[104:107], a[112:115], v[204:207], v[104:107]
  buffer_store_dwordx4 v[240:243], v26, s[16:19], s21 offen offset:2048 sc1
  v_mfma_f32_16x16x32_bf16 v[108:111], a[116:119], v[204:207], v[108:111]
  s_waitcnt lgkmcnt(4)
  v_mfma_f32_16x16x32_bf16 v[112:115], a[108:111], v[208:211], v[112:115]
  ds_read_b128 v[176:179], v18 offset:8192
  v_mfma_f32_16x16x32_bf16 v[116:119], a[112:115], v[208:211], v[116:119]
  v_mfma_f32_16x16x32_bf16 v[120:123], a[116:119], v[208:211], v[120:123]
  v_mfma_f32_16x16x32_bf16 v[124:127], a[108:111], v[212:215], v[124:127]
  ds_read_b128 v[180:183], v18 offset:10240
  v_mfma_f32_16x16x32_bf16 v[128:131], a[112:115], v[212:215], v[128:131]
  buffer_load_dwordx4 v11, s[8:11], s30 offen offset:1024 lds
  v_mfma_f32_16x16x32_bf16 v[132:135], a[116:119], v[212:215], v[132:135]
  v_mfma_f32_16x16x32_bf16 v[136:139], a[108:111], v[216:219], v[136:139]
  ds_read_b128 v[184:187], v18 offset:12288
  v_mfma_f32_16x16x32_bf16 v[140:143], a[112:115], v[216:219], v[140:143]
  v_mfma_f32_16x16x32_bf16 v[144:147], a[116:119], v[216:219], v[144:147]
  v_mfma_f32_16x16x32_bf16 v[148:151], a[108:111], v[220:223], v[148:151]
  ds_read_b128 v[188:191], v18 offset:14336
  v_mfma_f32_16x16x32_bf16 v[152:155], a[112:115], v[220:223], v[152:155]
  buffer_store_dwordx4 v[244:247], v26, s[16:19], s21 offen offset:3072 sc1
  v_mfma_f32_16x16x32_bf16 v[156:159], a[116:119], v[220:223], v[156:159]
  s_waitcnt lgkmcnt(4)
  v_mfma_f32_16x16x32_bf16 v[64:67], a[120:123], v[160:163], v[64:67]
  ds_read_b128 v[192:195], v19 offset:0
  v_mfma_f32_16x16x32_bf16 v[68:71], a[124:127], v[160:163], v[68:71]
  v_add_u32 v18, s33, v14
  v_mfma_f32_16x16x32_bf16 v[72:75], a[128:131], v[160:163], v[72:75]
  v_mfma_f32_16x16x32_bf16 v[76:79], a[120:123], v[164:167], v[76:79]
  ds_read_b128 v[196:199], v19 offset:2048
  v_mfma_f32_16x16x32_bf16 v[80:83], a[124:127], v[164:167], v[80:83]
  buffer_load_dwordx4 v12, s[8:11], s30 offen offset:2048 lds
  v_mfma_f32_16x16x32_bf16 v[84:87], a[128:131], v[164:167], v[84:87]
  v_mfma_f32_16x16x32_bf16 v[88:91], a[120:123], v[168:171], v[88:91]
  ds_read_b128 v[200:203], v19 offset:4096
  v_mfma_f32_16x16x32_bf16 v[92:95], a[124:127], v[168:171], v[92:95]
  v_mfma_f32_16x16x32_bf16 v[96:99], a[128:131], v[168:171], v[96:99]
  v_mfma_f32_16x16x32_bf16 v[100:103], a[120:123], v[172:175], v[100:103]
  ds_read_b128 v[204:207], v19 offset:6144
  v_mfma_f32_16x16x32_bf16 v[104:107], a[124:127], v[172:175], v[104:107]
  v_mfma_f32_16x16x32_bf16 v[108:111], a[128:131], v[172:175], v[108:111]
  s_waitcnt lgkmcnt(4)
  v_mfma_f32_16x16x32_bf16 v[112:115], a[120:123], v[176:179], v[112:115]
  ds_read_b128 v[208:211], v19 offset:8192
  v_mfma_f32_16x16x32_bf16 v[116:119], a[124:127], v[176:179], v[116:119]
  v_mfma_f32_16x16x32_bf16 v[120:123], a[128:131], v[176:179], v[120:123]
  v_mfma_f32_16x16x32_bf16 v[124:127], a[120:123], v[180:183], v[124:127]
  ds_read_b128 v[212:215], v19 offset:10240
  v_mfma_f32_16x16x32_bf16 v[128:131], a[124:127], v[180:183], v[128:131]
  buffer_load_dwordx4 v13, s[8:11], s30 offen offset:3072 lds
  v_mfma_f32_16x16x32_bf16 v[132:135], a[128:131], v[180:183], v[132:135]
  s_add_u32 s30, s30, s25
  s_sub_u32 s30, s30, 1152
  v_mfma_f32_16x16x32_bf16 v[136:139], a[120:123], v[184:187], v[136:139]
  ds_read_b128 v[216:219], v19 offset:12288
  s_add_u32 m0, m0, 16384
  v_mfma_f32_16x16x32_bf16 v[140:143], a[124:127], v[184:187], v[140:143]
  s_cmp_lt_u32 m0, s46
  s_cselect_b32 m0, m0, s47
  v_mfma_f32_16x16x32_bf16 v[144:147], a[128:131], v[184:187], v[144:147]
  v_mfma_f32_16x16x32_bf16 v[148:151], a[120:123], v[188:191], v[148:151]
  ds_read_b128 v[220:223], v19 offset:14336
  v_mfma_f32_16x16x32_bf16 v[152:155], a[124:127], v[188:191], v[152:155]
  v_mfma_f32_16x16x32_bf16 v[156:159], a[128:131], v[188:191], v[156:159]
  s_waitcnt vmcnt(23) lgkmcnt(4)
  s_barrier
  v_mfma_f32_16x16x32_bf16 v[64:67], a[132:135], v[192:195], v[64:67]
  ds_read_b128 v[160:163], v18 offset:0
  v_mfma_f32_16x16x32_bf16 v[68:71], a[136:139], v[192:195], v[68:71]
  v_mfma_f32_16x16x32_bf16 v[72:75], a[140:143], v[192:195], v[72:75]
  v_add_u32 v19, s33, v15
  s_add_u32 s33, s33, 16384
  v_mfma_f32_16x16x32_bf16 v[76:79], a[132:135], v[196:199], v[76:79]
  ds_read_b128 v[164:167], v18 offset:2048
  v_mfma_f32_16x16x32_bf16 v[80:83], a[136:139], v[196:199], v[80:83]
  buffer_load_dwordx4 v10, s[8:11], s30 offen offset:0 lds
  v_mfma_f32_16x16x32_bf16 v[84:87], a[140:143], v[196:199], v[84:87]
  s_cmp_lt_u32 s33, 98304
  s_cselect_b32 s33, s33, 0
  v_mfma_f32_16x16x32_bf16 v[88:91], a[132:135], v[200:203], v[88:91]
  ds_read_b128 v[168:171], v18 offset:4096
  v_mfma_f32_16x16x32_bf16 v[92:95], a[136:139], v[200:203], v[92:95]
  v_mfma_f32_16x16x32_bf16 v[96:99], a[140:143], v[200:203], v[96:99]
  v_mfma_f32_16x16x32_bf16 v[100:103], a[132:135], v[204:207], v[100:103]
  ds_read_b128 v[172:175], v18 offset:6144
  v_mfma_f32_16x16x32_bf16 v[104:107], a[136:139], v[204:207], v[104:107]
  v_mfma_f32_16x16x32_bf16 v[108:111], a[140:143], v[204:207], v[108:111]
  s_waitcnt lgkmcnt(4)
  v_mfma_f32_16x16x32_bf16 v[112:115], a[132:135], v[208:211], v[112:115]
  ds_read_b128 v[176:179], v18 offset:8192
  v_mfma_f32_16x16x32_bf16 v[116:119], a[136:139], v[208:211], v[116:119]
  v_mfma_f32_16x16x32_bf16 v[120:123], a[140:143], v[208:211], v[120:123]
  v_mfma_f32_16x16x32_bf16 v[124:127], a[132:135], v[212:215], v[124:127]
  ds_read_b128 v[180:183], v18 offset:10240
  v_mfma_f32_16x16x32_bf16 v[128:131], a[136:139], v[212:215], v[128:131]
  buffer_load_dwordx4 v11, s[8:11], s30 offen offset:1024 lds
  v_mfma_f32_16x16x32_bf16 v[132:135], a[140:143], v[212:215], v[132:135]
  v_mfma_f32_16x16x32_bf16 v[136:139], a[132:135], v[216:219], v[136:139]
  ds_read_b128 v[184:187], v18 offset:12288
  v_mfma_f32_16x16x32_bf16 v[140:143], a[136:139], v[216:219], v[140:143]
  v_mfma_f32_16x16x32_bf16 v[144:147], a[140:143], v[216:219], v[144:147]
  v_mfma_f32_16x16x32_bf16 v[148:151], a[132:135], v[220:223], v[148:151]
  ds_read_b128 v[188:191], v18 offset:14336
  v_mfma_f32_16x16x32_bf16 v[152:155], a[136:139], v[220:223], v[152:155]
  v_mfma_f32_16x16x32_bf16 v[156:159], a[140:143], v[220:223], v[156:159]
  s_waitcnt lgkmcnt(4)
  v_mfma_f32_16x16x32_bf16 v[64:67], a[144:147], v[160:163], v[64:67]
  ds_read_b128 v[192:195], v19 offset:0
  v_mfma_f32_16x16x32_bf16 v[68:71], a[148:151], v[160:163], v[68:71]
  v_add_u32 v18, s33, v14
  v_mfma_f32_16x16x32_bf16 v[72:75], a[152:155], v[160:163], v[72:75]
  v_mfma_f32_16x16x32_bf16 v[76:79], a[144:147], v[164:167], v[76:79]
  ds_read_b128 v[196:199], v19 offset:2048
  v_mfma_f32_16x16x32_bf16 v[80:83], a[148:151], v[164:167], v[80:83]
  buffer_load_dwordx4 v12, s[8:11], s30 offen offset:2048 lds
  v_mfma_f32_16x16x32_bf16 v[84:87], a[152:155], v[164:167], v[84:87]
  v_mfma_f32_16x16x32_bf16 v[88:91], a[144:147], v[168:171], v[88:91]
  ds_read_b128 v[200:203], v19 offset:4096
  v_mfma_f32_16x16x32_bf16 v[92:95], a[148:151], v[168:171], v[92:95]
  v_mfma_f32_16x16x32_bf16 v[96:99], a[152:155], v[168:171], v[96:99]
  v_mfma_f32_16x16x32_bf16 v[100:103], a[144:147], v[172:175], v[100:103]
  ds_read_b128 v[204:207], v19 offset:6144
  v_mfma_f32_16x16x32_bf16 v[104:107], a[148:151], v[172:175], v[104:107]
  v_mfma_f32_16x16x32_bf16 v[108:111], a[152:155], v[172:175], v[108:111]
  s_waitcnt lgkmcnt(4)
  v_mfma_f32_16x16x32_bf16 v[112:115], a[144:147], v[176:179], v[112:115]
  ds_read_b128 v[208:211], v19 offset:8192
  v_mfma_f32_16x16x32_bf16 v[116:119], a[148:151], v[176:179], v[116:119]
  v_mfma_f32_16x16x32_bf16 v[120:123], a[152:155], v[176:179], v[120:123]
  v_mfma_f32_16x16x32_bf16 v[124:127], a[144:147], v[180:183], v[124:127]
  ds_read_b128 v[212:215], v19 offset:10240
  v_mfma_f32_16x16x32_bf16 v[128:131], a[148:151], v[180:183], v[128:131]
  buffer_load_dwordx4 v13, s[8:11], s30 offen offset:3072 lds
  v_mfma_f32_16x16x32_bf16 v[132:135], a[152:155], v[180:183], v[132:135]
  s_add_u32 s30, s30, 128
  s_add_u32 m0, m0, 16384
  v_mfma_f32_16x16x32_bf16 v[136:139], a[144:147], v[184:187], v[136:139]
  ds_read_b128 v[216:219], v19 offset:12288
  v_mfma_f32_16x16x32_bf16 v[140:143], a[148:151], v[184:187], v[140:143]
  s_cmp_lt_u32 m0, s46
  s_cselect_b32 m0, m0, s47
  v_mfma_f32_16x16x32_bf16 v[144:147], a[152:155], v[184:187], v[144:147]
  v_mfma_f32_16x16x32_bf16 v[148:151], a[144:147], v[188:191], v[148:151]
  ds_read_b128 v[220:223], v19 offset:14336
  v_mfma_f32_16x16x32_bf16 v[152:155], a[148:151], v[188:191], v[152:155]
  v_mfma_f32_16x16x32_bf16 v[156:159], a[152:155], v[188:191], v[156:159]
  s_waitcnt vmcnt(6) lgkmcnt(4)
  s_barrier
  v_mfma_f32_16x16x32_bf16 v[64:67], a[156:159], v[192:195], v[64:67]
  ds_read_b128 v[160:163], v18 offset:0
  v_mfma_f32_16x16x32_bf16 v[68:71], a[160:163], v[192:195], v[68:71]
  s_cmp_eq_u32 s48, 0x80000000
  s_cbranch_scc1 kv_150
  s_cmp_lg_u32 s20, 0
  s_cbranch_scc1 af_151
  v_mov_b32 v4, 0
  v_mov_b32 v5, 1
  s_mov_b64 exec, 1
  buffer_atomic_add v5, v4, s[72:75], s61 offen sc1
  s_mov_b64 exec, -1
  s_nop 1
af_151:
kv_150:
  v_mfma_f32_16x16x32_bf16 v[72:75], a[164:167], v[192:195], v[72:75]
  v_add_u32 v19, s33, v15
  s_add_u32 s33, s33, 16384
  v_mfma_f32_16x16x32_bf16 v[76:79], a[156:159], v[196:199], v[76:79]
  ds_read_b128 v[164:167], v18 offset:2048
  v_mfma_f32_16x16x32_bf16 v[80:83], a[160:163], v[196:199], v[80:83]
  buffer_load_dwordx4 v10, s[8:11], s30 offen offset:0 lds
  v_mfma_f32_16x16x32_bf16 v[84:87], a[164:167], v[196:199], v[84:87]
  s_cmp_lt_u32 s33, 98304
  s_cselect_b32 s33, s33, 0
  v_mfma_f32_16x16x32_bf16 v[88:91], a[156:159], v[200:203], v[88:91]
  ds_read_b128 v[168:171], v18 offset:4096
  v_mfma_f32_16x16x32_bf16 v[92:95], a[160:163], v[200:203], v[92:95]
  v_mfma_f32_16x16x32_bf16 v[96:99], a[164:167], v[200:203], v[96:99]
  v_mfma_f32_16x16x32_bf16 v[100:103], a[156:159], v[204:207], v[100:103]
  ds_read_b128 v[172:175], v18 offset:6144
  v_mfma_f32_16x16x32_bf16 v[104:107], a[160:163], v[204:207], v[104:107]
  v_mfma_f32_16x16x32_bf16 v[108:111], a[164:167], v[204:207], v[108:111]
  s_waitcnt lgkmcnt(4)
  v_mfma_f32_16x16x32_bf16 v[112:115], a[156:159], v[208:211], v[112:115]
  ds_read_b128 v[176:179], v18 offset:8192
  v_mfma_f32_16x16x32_bf16 v[116:119], a[160:163], v[208:211], v[116:119]
  v_mfma_f32_16x16x32_bf16 v[120:123], a[164:167], v[208:211], v[120:123]
  v_mfma_f32_16x16x32_bf16 v[124:127], a[156:159], v[212:215], v[124:127]
  ds_read_b128 v[180:183], v18 offset:10240
  v_mfma_f32_16x16x32_bf16 v[128:131], a[160:163], v[212:215], v[128:131]
  buffer_load_dwordx4 v11, s[8:11], s30 offen offset:1024 lds
  v_mfma_f32_16x16x32_bf16 v[132:135], a[164:167], v[212:215], v[132:135]
  v_mfma_f32_16x16x32_bf16 v[136:139], a[156:159], v[216:219], v[136:139]
  ds_read_b128 v[184:187], v18 offset:12288
  v_mfma_f32_16x16x32_bf16 v[140:143], a[160:163], v[216:219], v[140:143]
  v_mfma_f32_16x16x32_bf16 v[144:147], a[164:167], v[216:219], v[144:147]
  v_mfma_f32_16x16x32_bf16 v[148:151], a[156:159], v[220:223], v[148:151]
  ds_read_b128 v[188:191], v18 offset:14336
  v_mfma_f32_16x16x32_bf16 v[152:155], a[160:163], v[220:223], v[152:155]
  v_mfma_f32_16x16x32_bf16 v[156:159], a[164:167], v[220:223], v[156:159]
  s_waitcnt lgkmcnt(4)
  v_mfma_f32_16x16x32_bf16 v[64:67], a[168:171], v[160:163], v[64:67]
  ds_read_b128 v[192:195], v19 offset:0
  v_mfma_f32_16x16x32_bf16 v[68:71], a[172:175], v[160:163], v[68:71]
  v_add_u32 v18, s33, v14
  s_mov_b32 s61, s60
  v_mfma_f32_16x16x32_bf16 v[72:75], a[176:179], v[160:163], v[72:75]
  s_add_u32 s60, s60, s62
  s_mul_i32 s48, s20, 393216
  v_mfma_f32_16x16x32_bf16 v[76:79], a[168:171], v[164:167], v[76:79]
  ds_read_b128 v[196:199], v19 offset:2048
  s_add_u32 s48, s48, s27
  v_mfma_f32_16x16x32_bf16 v[80:83], a[172:175], v[164:167], v[80:83]
  buffer_load_dwordx4 v12, s[8:11], s30 offen offset:2048 lds
  v_mfma_f32_16x16x32_bf16 v[84:87], a[176:179], v[164:167], v[84:87]
  s_add_u32 s27, s27, s28
  s_sub_u32 s26, s26, 1
  v_mfma_f32_16x16x32_bf16 v[88:91], a[168:171], v[168:171], v[88:91]
  ds_read_b128 v[200:203], v19 offset:4096
  v_mfma_f32_16x16x32_bf16 v[92:95], a[172:175], v[168:171], v[92:95]
  v_mfma_f32_16x16x32_bf16 v[96:99], a[176:179], v[168:171], v[96:99]
  v_mfma_f32_16x16x32_bf16 v[100:103], a[168:171], v[172:175], v[100:103]
  ds_read_b128 v[204:207], v19 offset:6144
  v_mfma_f32_16x16x32_bf16 v[104:107], a[172:175], v[172:175], v[104:107]
  v_mfma_f32_16x16x32_bf16 v[108:111], a[176:179], v[172:175], v[108:111]
  s_waitcnt lgkmcnt(4)
  v_mfma_f32_16x16x32_bf16 v[112:115], a[168:171], v[176:179], v[112:115]
  ds_read_b128 v[208:211], v19 offset:8192
  v_mfma_f32_16x16x32_bf16 v[116:119], a[172:175], v[176:179], v[116:119]
  v_mfma_f32_16x16x32_bf16 v[120:123], a[176:179], v[176:179], v[120:123]
  v_mfma_f32_16x16x32_bf16 v[124:127], a[168:171], v[180:183], v[124:127]
  ds_read_b128 v[212:215], v19 offset:10240
  v_mfma_f32_16x16x32_bf16 v[128:131], a[172:175], v[180:183], v[128:131]
  buffer_load_dwordx4 v13, s[8:11], s30 offen offset:3072 lds
  v_mfma_f32_16x16x32_bf16 v[132:135], a[176:179], v[180:183], v[132:135]
  s_add_u32 s30, s30, 128
  s_add_u32 m0, m0, 16384
  v_mfma_f32_16x16x32_bf16 v[136:139], a[168:171], v[184:187], v[136:139]
  ds_read_b128 v[216:219], v19 offset:12288
  v_mfma_f32_16x16x32_bf16 v[140:143], a[172:175], v[184:187], v[140:143]
  s_cmp_lt_u32 m0, s46
  s_cselect_b32 m0, m0, s47
  v_mfma_f32_16x16x32_bf16 v[144:147], a[176:179], v[184:187], v[144:147]
  v_mfma_f32_16x16x32_bf16 v[148:151], a[168:171], v[188:191], v[148:151]
  ds_read_b128 v[220:223], v19 offset:14336
  v_mfma_f32_16x16x32_bf16 v[152:155], a[172:175], v[188:191], v[152:155]
  v_mfma_f32_16x16x32_bf16 v[156:159], a[176:179], v[188:191], v[156:159]
  s_waitcnt vmcnt(15) lgkmcnt(4)
  s_barrier
  v_mfma_f32_16x16x32_bf16 v[64:67], a[180:183], v[192:195], v[64:67]
  ds_read_b128 v[160:163], v18 offset:0
  v_mfma_f32_16x16x32_bf16 v[68:71], a[184:187], v[192:195], v[68:71]
  v_mfma_f32_16x16x32_bf16 v[72:75], a[188:191], v[192:195], v[72:75]
  v_add_u32 v19, s33, v15
  s_add_u32 s33, s33, 16384
  v_mfma_f32_16x16x32_bf16 v[76:79], a[180:183], v[196:199], v[76:79]
  ds_read_b128 v[164:167], v18 offset:2048
  v_mfma_f32_16x16x32_bf16 v[80:83], a[184:187], v[196:199], v[80:83]
  buffer_load_dwordx4 v10, s[8:11], s30 offen offset:0 lds
  v_mfma_f32_16x16x32_bf16 v[84:87], a[188:191], v[196:199], v[84:87]
  s_cmp_lt_u32 s33, 98304
  s_cselect_b32 s33, s33, 0
  v_mfma_f32_16x16x32_bf16 v[88:91], a[180:183], v[200:203], v[88:91]
  ds_read_b128 v[168:171], v18 offset:4096
  v_mfma_f32_16x16x32_bf16 v[92:95], a[184:187], v[200:203], v[92:95]
  v_mfma_f32_16x16x32_bf16 v[96:99], a[188:191], v[200:203], v[96:99]
  v_mfma_f32_16x16x32_bf16 v[100:103], a[180:183], v[204:207], v[100:103]
  ds_read_b128 v[172:175], v18 offset:6144
  v_mfma_f32_16x16x32_bf16 v[104:107], a[184:187], v[204:207], v[104:107]
  v_mfma_f32_16x16x32_bf16 v[108:111], a[188:191], v[204:207], v[108:111]
  s_waitcnt lgkmcnt(4)
  v_mfma_f32_16x16x32_bf16 v[112:115], a[180:183], v[208:211], v[112:115]
  ds_read_b128 v[176:179], v18 offset:8192
  v_mfma_f32_16x16x32_bf16 v[116:119], a[184:187], v[208:211], v[116:119]
  v_mfma_f32_16x16x32_bf16 v[120:123], a[188:191], v[208:211], v[120:123]
  v_mfma_f32_16x16x32_bf16 v[124:127], a[180:183], v[212:215], v[124:127]
  ds_read_b128 v[180:183], v18 offset:10240
  v_mfma_f32_16x16x32_bf16 v[128:131], a[184:187], v[212:215], v[128:131]
  buffer_load_dwordx4 v11, s[8:11], s30 offen offset:1024 lds
  v_mfma_f32_16x16x32_bf16 v[132:135], a[188:191], v[212:215], v[132:135]
  v_mfma_f32_16x16x32_bf16 v[136:139], a[180:183], v[216:219], v[136:139]
  ds_read_b128 v[184:187], v18 offset:12288
  v_mfma_f32_16x16x32_bf16 v[140:143], a[184:187], v[216:219], v[140:143]
  v_mfma_f32_16x16x32_bf16 v[144:147], a[188:191], v[216:219], v[144:147]
  v_mfma_f32_16x16x32_bf16 v[148:151], a[180:183], v[220:223], v[148:151]
  ds_read_b128 v[188:191], v18 offset:14336
  v_mfma_f32_16x16x32_bf16 v[152:155], a[184:187], v[220:223], v[152:155]
  v_mfma_f32_16x16x32_bf16 v[156:159], a[188:191], v[220:223], v[156:159]
  s_waitcnt lgkmcnt(4)
  v_mfma_f32_16x16x32_bf16 v[64:67], a[192:195], v[160:163], v[64:67]
  ds_read_b128 v[192:195], v19 offset:0
  v_mfma_f32_16x16x32_bf16 v[68:71], a[196:199], v[160:163], v[68:71]
  v_add_u32 v18, s33, v14
  v_mfma_f32_16x16x32_bf16 v[72:75], a[200:203], v[160:163], v[72:75]
  v_mfma_f32_16x16x32_bf16 v[76:79], a[192:195], v[164:167], v[76:79]
  ds_read_b128 v[196:199], v19 offset:2048
  v_mfma_f32_16x16x32_bf16 v[80:83], a[196:199], v[164:167], v[80:83]
  buffer_load_dwordx4 v12, s[8:11], s30 offen offset:2048 lds
  v_mfma_f32_16x16x32_bf16 v[84:87], a[200:203], v[164:167], v[84:87]
  v_mfma_f32_16x16x32_bf16 v[88:91], a[192:195], v[168:171], v[88:91]
  ds_read_b128 v[200:203], v19 offset:4096
  v_mfma_f32_16x16x32_bf16 v[92:95], a[196:199], v[168:171], v[92:95]
  v_mfma_f32_16x16x32_bf16 v[96:99], a[200:203], v[168:171], v[96:99]
  v_mfma_f32_16x16x32_bf16 v[100:103], a[192:195], v[172:175], v[100:103]
  ds_read_b128 v[204:207], v19 offset:6144
  v_mfma_f32_16x16x32_bf16 v[104:107], a[196:199], v[172:175], v[104:107]
  v_mfma_f32_16x16x32_bf16 v[108:111], a[200:203], v[172:175], v[108:111]
  s_waitcnt lgkmcnt(4)
  v_mfma_f32_16x16x32_bf16 v[112:115], a[192:195], v[176:179], v[112:115]
  ds_read_b128 v[208:211], v19 offset:8192
  v_mfma_f32_16x16x32_bf16 v[116:119], a[196:199], v[176:179], v[116:119]
  v_mfma_f32_16x16x32_bf16 v[120:123], a[200:203], v[176:179], v[120:123]
  v_mfma_f32_16x16x32_bf16 v[124:127], a[192:195], v[180:183], v[124:127]
  ds_read_b128 v[212:215], v19 offset:10240
  v_mfma_f32_16x16x32_bf16 v[128:131], a[196:199], v[180:183], v[128:131]
  buffer_load_dwordx4 v13, s[8:11], s30 offen offset:3072 lds
  v_mfma_f32_16x16x32_bf16 v[132:135], a[200:203], v[180:183], v[132:135]
  s_add_u32 s30, s30, 128
  s_add_u32 m0, m0, 16384
  v_mfma_f32_16x16x32_bf16 v[136:139], a[192:195], v[184:187], v[136:139]
  ds_read_b128 v[216:219], v19 offset:12288
  v_mfma_f32_16x16x32_bf16 v[140:143], a[196:199], v[184:187], v[140:143]
  s_cmp_lt_u32 m0, s46
  s_cselect_b32 m0, m0, s47
  v_mfma_f32_16x16x32_bf16 v[144:147], a[200:203], v[184:187], v[144:147]
  v_mfma_f32_16x16x32_bf16 v[148:151], a[192:195], v[188:191], v[148:151]
  ds_read_b128 v[220:223], v19 offset:14336
  v_mfma_f32_16x16x32_bf16 v[152:155], a[196:199], v[188:191], v[152:155]
  v_mfma_f32_16x16x32_bf16 v[156:159], a[200:203], v[188:191], v[156:159]
  s_waitcnt vmcnt(12) lgkmcnt(4)
  s_barrier
  v_mfma_f32_16x16x32_bf16 v[64:67], a[204:207], v[192:195], v[64:67]
  ds_read_b128 v[160:163], v18 offset:0
  v_mfma_f32_16x16x32_bf16 v[68:71], a[208:211], v[192:195], v[68:71]
  v_mfma_f32_16x16x32_bf16 v[72:75], a[212:215], v[192:195], v[72:75]
  v_add_u32 v19, s33, v15
  s_add_u32 s33, s33, 16384
  v_mfma_f32_16x16x32_bf16 v[76:79], a[204:207], v[196:199], v[76:79]
  ds_read_b128 v[164:167], v18 offset:2048
  v_mfma_f32_16x16x32_bf16 v[80:83], a[208:211], v[196:199], v[80:83]
  buffer_load_dwordx4 v10, s[8:11], s30 offen offset:0 lds
  v_mfma_f32_16x16x32_bf16 v[84:87], a[212:215], v[196:199], v[84:87]
  s_cmp_lt_u32 s33, 98304
  s_cselect_b32 s33, s33, 0
  v_mfma_f32_16x16x32_bf16 v[88:91], a[204:207], v[200:203], v[88:91]
  ds_read_b128 v[168:171], v18 offset:4096
  v_mfma_f32_16x16x32_bf16 v[92:95], a[208:211], v[200:203], v[92:95]
  v_mfma_f32_16x16x32_bf16 v[96:99], a[212:215], v[200:203], v[96:99]
  v_mfma_f32_16x16x32_bf16 v[100:103], a[204:207], v[204:207], v[100:103]
  ds_read_b128 v[172:175], v18 offset:6144
  v_mfma_f32_16x16x32_bf16 v[104:107], a[208:211], v[204:207], v[104:107]
  v_mfma_f32_16x16x32_bf16 v[108:111], a[212:215], v[204:207], v[108:111]
  s_waitcnt lgkmcnt(4)
  v_mfma_f32_16x16x32_bf16 v[112:115], a[204:207], v[208:211], v[112:115]
  ds_read_b128 v[176:179], v18 offset:8192
  v_mfma_f32_16x16x32_bf16 v[116:119], a[208:211], v[208:211], v[116:119]
  v_mfma_f32_16x16x32_bf16 v[120:123], a[212:215], v[208:211], v[120:123]
  v_mfma_f32_16x16x32_bf16 v[124:127], a[204:207], v[212:215], v[124:127]
  ds_read_b128 v[180:183], v18 offset:10240
  v_mfma_f32_16x16x32_bf16 v[128:131], a[208:211], v[212:215], v[128:131]
  buffer_load_dwordx4 v11, s[8:11], s30 offen offset:1024 lds
  v_mfma_f32_16x16x32_bf16 v[132:135], a[212:215], v[212:215], v[132:135]
  v_mfma_f32_16x16x32_bf16 v[136:139], a[204:207], v[216:219], v[136:139]
  ds_read_b128 v[184:187], v18 offset:12288
  v_mfma_f32_16x16x32_bf16 v[140:143], a[208:211], v[216:219], v[140:143]
  v_mfma_f32_16x16x32_bf16 v[144:147], a[212:215], v[216:219], v[144:147]
  v_mfma_f32_16x16x32_bf16 v[148:151], a[204:207], v[220:223], v[148:151]
  ds_read_b128 v[188:191], v18 offset:14336
  v_mfma_f32_16x16x32_bf16 v[152:155], a[208:211], v[220:223], v[152:155]
  v_mfma_f32_16x16x32_bf16 v[156:159], a[212:215], v[220:223], v[156:159]
  s_waitcnt lgkmcnt(4)
  v_mfma_f32_16x16x32_bf16 v[64:67], a[216:219], v[160:163], v[64:67]
  ds_read_b128 v[192:195], v19 offset:0
  v_mfma_f32_16x16x32_bf16 v[68:71], a[220:223], v[160:163], v[68:71]
  v_add_u32 v18, s33, v14
  v_mfma_f32_16x16x32_bf16 v[72:75], a[224:227], v[160:163], v[72:75]
  v_mfma_f32_16x16x32_bf16 v[76:79], a[216:219], v[164:167], v[76:79]
  ds_read_b128 v[196:199], v19 offset:2048
  v_mfma_f32_16x16x32_bf16 v[80:83], a[220:223], v[164:167], v[80:83]
  buffer_load_dwordx4 v12, s[8:11], s30 offen offset:2048 lds
  v_mfma_f32_16x16x32_bf16 v[84:87], a[224:227], v[164:167], v[84:87]
  v_mfma_f32_16x16x32_bf16 v[88:91], a[216:219], v[168:171], v[88:91]
  ds_read_b128 v[200:203], v19 offset:4096
  v_mfma_f32_16x16x32_bf16 v[92:95], a[220:223], v[168:171], v[92:95]
  v_mfma_f32_16x16x32_bf16 v[96:99], a[224:227], v[168:171], v[96:99]
  v_mfma_f32_16x16x32_bf16 v[100:103], a[216:219], v[172:175], v[100:103]
  ds_read_b128 v[204:207], v19 offset:6144
  v_mfma_f32_16x16x32_bf16 v[104:107], a[220:223], v[172:175], v[104:107]
  v_mfma_f32_16x16x32_bf16 v[108:111], a[224:227], v[172:175], v[108:111]
  s_waitcnt lgkmcnt(4)
  v_mfma_f32_16x16x32_bf16 v[112:115], a[216:219], v[176:179], v[112:115]
  ds_read_b128 v[208:211], v19 offset:8192
  v_mfma_f32_16x16x32_bf16 v[116:119], a[220:223], v[176:179], v[116:119]
  v_mfma_f32_16x16x32_bf16 v[120:123], a[224:227], v[176:179], v[120:123]
  v_mfma_f32_16x16x32_bf16 v[124:127], a[216:219], v[180:183], v[124:127]
  ds_read_b128 v[212:215], v19 offset:10240
  v_mfma_f32_16x16x32_bf16 v[128:131], a[220:223], v[180:183], v[128:131]
  buffer_load_dwordx4 v13, s[8:11], s30 offen offset:3072 lds
  v_mfma_f32_16x16x32_bf16 v[132:135], a[224:227], v[180:183], v[132:135]
  s_add_u32 s30, s30, 128
  s_add_u32 m0, m0, 16384
  v_mfma_f32_16x16x32_bf16 v[136:139], a[216:219], v[184:187], v[136:139]
  ds_read_b128 v[216:219], v19 offset:12288
  v_mfma_f32_16x16x32_bf16 v[140:143], a[220:223], v[184:187], v[140:143]
  s_cmp_lt_u32 m0, s46
  s_cselect_b32 m0, m0, s47
  v_mfma_f32_16x16x32_bf16 v[144:147], a[224:227], v[184:187], v[144:147]
  v_mfma_f32_16x16x32_bf16 v[148:151], a[216:219], v[188:191], v[148:151]
  ds_read_b128 v[220:223], v19 offset:14336
  v_mfma_f32_16x16x32_bf16 v[152:155], a[220:223], v[188:191], v[152:155]
  v_mfma_f32_16x16x32_bf16 v[156:159], a[224:227], v[188:191], v[156:159]
  s_waitcnt vmcnt(12) lgkmcnt(4)
  s_barrier
  v_mfma_f32_16x16x32_bf16 v[64:67], a[228:231], v[192:195], v[64:67]
  ds_read_b128 v[160:163], v18 offset:0
  v_mfma_f32_16x16x32_bf16 v[68:71], a[232:235], v[192:195], v[68:71]
  v_mfma_f32_16x16x32_bf16 v[72:75], a[236:239], v[192:195], v[72:75]
  v_add_u32 v19, s33, v15
  s_add_u32 s33, s33, 16384
  v_mfma_f32_16x16x32_bf16 v[76:79], a[228:231], v[196:199], v[76:79]
  ds_read_b128 v[164:167], v18 offset:2048
  v_cvt_pk_bf16_f32 v224, v64, v65
  v_mfma_f32_16x16x32_bf16 v[80:83], a[232:235], v[196:199], v[80:83]
  buffer_load_dwordx4 v10, s[8:11], s30 offen offset:0 lds
  v_mfma_f32_16x16x32_bf16 v[84:87], a[236:239], v[196:199], v[84:87]
  s_cmp_lt_u32 s33, 98304
  s_cselect_b32 s33, s33, 0
  v_mfma_f32_16x16x32_bf16 v[88:91], a[228:231], v[200:203], v[88:91]
  ds_read_b128 v[168:171], v18 offset:4096
  v_cvt_pk_bf16_f32 v225, v66, v67
  v_mfma_f32_16x16x32_bf16 v[92:95], a[232:235], v[200:203], v[92:95]
  v_cvt_pk_bf16_f32 v226, v68, v69
  v_cvt_pk_bf16_f32 v227, v70, v71
  v_mfma_f32_16x16x32_bf16 v[96:99], a[236:239], v[200:203], v[96:99]
  v_cvt_pk_bf16_f32 v228, v72, v73
  v_cvt_pk_bf16_f32 v229, v74, v75
  v_mfma_f32_16x16x32_bf16 v[100:103], a[228:231], v[204:207], v[100:103]
  ds_read_b128 v[172:175], v18 offset:6144
  v_mfma_f32_16x16x32_bf16 v[104:107], a[232:235], v[204:207], v[104:107]
  ds_write_b64 v22, v[224:225] offset:0
  v_mfma_f32_16x16x32_bf16 v[108:111], a[236:239], v[204:207], v[108:111]
  s_waitcnt lgkmcnt(5)
  v_mfma_f32_16x16x32_bf16 v[112:115], a[228:231], v[208:211], v[112:115]
  ds_read_b128 v[176:179], v18 offset:8192
  v_mfma_f32_16x16x32_bf16 v[116:119], a[232:235], v[208:211], v[116:119]
  ds_write_b64 v22, v[226:227] offset:8
  v_mfma_f32_16x16x32_bf16 v[120:123], a[236:239], v[208:211], v[120:123]
  ds_write_b64 v16, v[228:229] offset:64
  v_mfma_f32_16x16x32_bf16 v[124:127], a[228:231], v[212:215], v[124:127]
  ds_read_b128 v[180:183], v18 offset:10240
  v_cvt_pk_bf16_f32 v230, v76, v77
  v_mfma_f32_16x16x32_bf16 v[128:131], a[232:235], v[212:215], v[128:131]
  buffer_load_dwordx4 v11, s[8:11], s30 offen offset:1024 lds
  v_mfma_f32_16x16x32_bf16 v[132:135], a[236:239], v[212:215], v[132:135]
  v_cvt_pk_bf16_f32 v231, v78, v79
  v_cvt_pk_bf16_f32 v232, v80, v81
  v_mfma_f32_16x16x32_bf16 v[136:139], a[228:231], v[216:219], v[136:139]
  ds_read_b128 v[184:187], v18 offset:12288
  v_cvt_pk_bf16_f32 v233, v82, v83
  v_mfma_f32_16x16x32_bf16 v[140:143], a[232:235], v[216:219], v[140:143]
  v_cvt_pk_bf16_f32 v234, v84, v85
  v_cvt_pk_bf16_f32 v235, v86, v87
  v_mfma_f32_16x16x32_bf16 v[144:147], a[236:239], v[216:219], v[144:147]
  ds_write_b64 v22, v[230:231] offset:6400
  v_mfma_f32_16x16x32_bf16 v[148:151], a[228:231], v[220:223], v[148:151]
  ds_read_b128 v[188:191], v18 offset:14336
  v_mfma_f32_16x16x32_bf16 v[152:155], a[232:235], v[220:223], v[152:155]
  ds_write_b64 v22, v[232:233] offset:6408
  v_mfma_f32_16x16x32_bf16 v[156:159], a[236:239], v[220:223], v[156:159]
  s_waitcnt lgkmcnt(9)
  s_cmp_gt_u32 s26, 0
  s_cbranch_scc1 kv_blk_152
  s_nop 7
  ds_write_b64 v16, v[234:235] offset:6464
  v_cvt_pk_bf16_f32 v236, v88, v89
  v_cvt_pk_bf16_f32 v237, v90, v91
  v_cvt_pk_bf16_f32 v238, v92, v93
  v_cvt_pk_bf16_f32 v239, v94, v95
  v_cvt_pk_bf16_f32 v240, v96, v97
  v_cvt_pk_bf16_f32 v241, v98, v99
  ds_write_b64 v22, v[236:237] offset:12800
  ds_write_b64 v22, v[238:239] offset:12808
  ds_write_b64 v16, v[240:241] offset:12864
  v_cvt_pk_bf16_f32 v242, v100, v101
  v_cvt_pk_bf16_f32 v243, v102, v103
  v_cvt_pk_bf16_f32 v244, v104, v105
  v_cvt_pk_bf16_f32 v245, v106, v107
  v_cvt_pk_bf16_f32 v246, v108, v109
  v_cvt_pk_bf16_f32 v247, v110, v111
  ds_write_b64 v22, v[242:243] offset:19200
  ds_write_b64 v22, v[244:245] offset:19208
  ds_write_b64 v16, v[246:247] offset:19264
  v_cvt_pk_bf16_f32 v224, v112, v113
  v_cvt_pk_bf16_f32 v225, v114, v115
  v_cvt_pk_bf16_f32 v226, v116, v117
  v_cvt_pk_bf16_f32 v227, v118, v119
  v_cvt_pk_bf16_f32 v228, v120, v121
  v_cvt_pk_bf16_f32 v229, v122, v123
  ds_write_b64 v22, v[224:225] offset:25600
  ds_write_b64 v22, v[226:227] offset:25608
  ds_write_b64 v16, v[228:229] offset:25664
  v_cvt_pk_bf16_f32 v230, v124, v125
  v_cvt_pk_bf16_f32 v231, v126, v127
  v_cvt_pk_bf16_f32 v232, v128, v129
  v_cvt_pk_bf16_f32 v233, v130, v131
  v_cvt_pk_bf16_f32 v234, v132, v133
  v_cvt_pk_bf16_f32 v235, v134, v135
  ds_write_b64 v22, v[230:231] offset:32000
  ds_write_b64 v22, v[232:233] offset:32008
  ds_write_b64 v16, v[234:235] offset:32064
  v_cvt_pk_bf16_f32 v236, v136, v137
  v_cvt_pk_bf16_f32 v237, v138, v139
  v_cvt_pk_bf16_f32 v238, v140, v141
  v_cvt_pk_bf16_f32 v239, v142, v143
  v_cvt_pk_bf16_f32 v240, v144, v145
  v_cvt_pk_bf16_f32 v241, v146, v147
  ds_write_b64 v22, v[236:237] offset:38400
  ds_write_b64 v22, v[238:239] offset:38408
  ds_write_b64 v16, v[240:241] offset:38464
  v_cvt_pk_bf16_f32 v242, v148, v149
  v_cvt_pk_bf16_f32 v243, v150, v151
  v_cvt_pk_bf16_f32 v244, v152, v153
  v_cvt_pk_bf16_f32 v245, v154, v155
  v_cvt_pk_bf16_f32 v246, v156, v157
  v_cvt_pk_bf16_f32 v247, v158, v159
  ds_write_b64 v22, v[242:243] offset:44800
  ds_write_b64 v22, v[244:245] offset:44808
  ds_write_b64 v16, v[246:247] offset:44864
  s_waitcnt vmcnt(0) lgkmcnt(0)
  s_barrier
  ds_read_b128 v[224:227], v23 offset:0
  ds_read_b128 v[228:231], v23 offset:64
  ds_read_b128 v[232:235], v23 offset:128
  ds_read_b128 v[236:239], v23 offset:192
  ds_read_b128 v[240:243], v23 offset:256
  ds_read_b128 v[244:247], v23 offset:320
  s_waitcnt lgkmcnt(0)
  s_add_u32 s21, s48, 0
  buffer_store_dwordx4 v[224:227], v26, s[16:19], s21 offen offset:0 sc1
  buffer_store_dwordx4 v[228:231], v26, s[16:19], s21 offen offset:1024 sc1
  buffer_store_dwordx4 v[232:235], v26, s[16:19], s21 offen offset:2048 sc1
  buffer_store_dwordx4 v[236:239], v26, s[16:19], s21 offen offset:3072 sc1
  s_add_u32 s21, s48, 4096
  buffer_store_dwordx4 v[240:243], v26, s[16:19], s21 offen offset:0 sc1
  buffer_store_dwordx4 v[244:247], v26, s[16:19], s21 offen offset:1024 sc1
  s_nop 1
  ds_read_b128 v[224:227], v23 offset:6400
  ds_read_b128 v[228:231], v23 offset:6464
  ds_read_b128 v[232:235], v23 offset:6528
  ds_read_b128 v[236:239], v23 offset:6592
  ds_read_b128 v[240:243], v23 offset:6656
  ds_read_b128 v[244:247], v23 offset:6720
  s_waitcnt lgkmcnt(0)
  buffer_store_dwordx4 v[224:227], v26, s[16:19], s21 offen offset:2048 sc1
  buffer_store_dwordx4 v[228:231], v26, s[16:19], s21 offen offset:3072 sc1
  s_add_u32 s21, s48, 8192
  buffer_store_dwordx4 v[232:235], v26, s[16:19], s21 offen offset:0 sc1
  buffer_store_dwordx4 v[236:239], v26, s[16:19], s21 offen offset:1024 sc1
  buffer_store_dwordx4 v[240:243], v26, s[16:19], s21 offen offset:2048 sc1
  buffer_store_dwordx4 v[244:247], v26, s[16:19], s21 offen offset:3072 sc1
  s_nop 1
  s_waitcnt vmcnt(0)
  s_barrier
  s_cmp_lg_u32 s20, 0
  s_cbranch_scc1 af_153
  v_mov_b32 v4, 0
  v_mov_b32 v5, 1
  s_mov_b64 exec, 1
  buffer_atomic_add v5, v4, s[72:75], s61 offen sc1
  s_mov_b64 exec, -1
  s_nop 1
af_153:
  s_cmp_lg_u32 s43, 0
  s_cbranch_scc1 kv_fin
  s_mov_b32 s43, 2
  s_load_dwordx2 s[6:7], s[0:1], 16
  s_waitcnt lgkmcnt(0)
  s_mov_b32 s12, s6
  s_mov_b32 s13, s7
  s_mov_b32 s14, 7864320
  s_mov_b32 s15, 0x00020000
  s_add_u32 s16, s38, 201326592
  s_addc_u32 s17, s39, 0
  s_mov_b32 s18, 4718592
  s_mov_b32 s19, 0x00020000
  v_mov_b32 v9, 2731
  v_add_u32 v8, 0, v1
  v_mul_u32_u24 v7, v8, v9
  v_lshrrev_b32 v7, 16, v7
  v_mul_u32_u24 v4, 24, v7
  v_sub_u32 v8, v8, v4
  s_mov_b32 s21, 12288
  v_mul_lo_u32 v7, v7, s21
  v_lshl_add_u32 v4, v8, 4, v7
  v_add_u32 v8, 64, v1
  v_mul_u32_u24 v7, v8, v9
  v_lshrrev_b32 v7, 16, v7
  v_mul_u32_u24 v5, 24, v7
  v_sub_u32 v8, v8, v5
  s_mov_b32 s21, 12288
  v_mul_lo_u32 v7, v7, s21
  v_lshl_add_u32 v5, v8, 4, v7
  v_add_u32 v8, 128, v1
  v_mul_u32_u24 v7, v8, v9
  v_lshrrev_b32 v7, 16, v7
  v_mul_u32_u24 v6, 24, v7
  v_sub_u32 v8, v8, v6
  s_mov_b32 s21, 12288
  v_mul_lo_u32 v7, v7, s21
  v_lshl_add_u32 v6, v8, 4, v7
  v_lshrrev_b32 v7, 2, v2
  v_lshl_add_u32 v7, v3, 3, v7
  v_mul_u32_u24 v7, 384, v7
  v_and_b32 v8, 3, v2
  v_lshlrev_b32 v8, 3, v8
  s_mul_i32 s21, s20, 96
  v_add3_u32 v7, v7, v8, s21
  v_add_u32 v8, 61440, v7
  s_mul_i32 s21, s20, 491520
  s_add_u32 s21, s21, 0
  s_add_u32 s21, s21, s44
  s_mul_i32 s22, s20, 15360
  s_add_u32 s22, s22, 0
  s_add_u32 m0, s22, 0
  s_nop 0
  buffer_load_dwordx4 v4, s[12:15], s21 offen lds
  s_add_u32 m0, s22, 1024
  s_nop 0
  buffer_load_dwordx4 v5, s[12:15], s21 offen lds
  s_add_u32 m0, s22, 2048
  s_nop 0
  buffer_load_dwordx4 v6, s[12:15], s21 offen lds
  s_mul_i32 s21, s20, 491520
  s_add_u32 s21, s21, 98304
  s_add_u32 s21, s21, s44
  s_mul_i32 s22, s20, 15360
  s_add_u32 s22, s22, 3072
  s_add_u32 m0, s22, 0
  s_nop 0
  buffer_load_dwordx4 v4, s[12:15], s21 offen lds
  s_add_u32 m0, s22, 1024
  s_nop 0
  buffer_load_dwordx4 v5, s[12:15], s21 offen lds
  s_add_u32 m0, s22, 2048
  s_nop 0
  buffer_load_dwordx4 v6, s[12:15], s21 offen lds
  s_mul_i32 s21, s20, 491520
  s_add_u32 s21, s21, 196608
  s_add_u32 s21, s21, s44
  s_mul_i32 s22, s20, 15360
  s_add_u32 s22, s22, 6144
  s_add_u32 m0, s22, 0
  s_nop 0
  buffer_load_dwordx4 v4, s[12:15], s21 offen lds
  s_add_u32 m0, s22, 1024
  s_nop 0
  buffer_load_dwordx4 v5, s[12:15], s21 offen lds
  s_add_u32 m0, s22, 2048
  s_nop 0
  buffer_load_dwordx4 v6, s[12:15], s21 offen lds
  s_mul_i32 s21, s20, 491520
  s_add_u32 s21, s21, 294912
  s_add_u32 s21, s21, s44
  s_mul_i32 s22, s20, 15360
  s_add_u32 s22, s22, 9216
  s_add_u32 m0, s22, 0
  s_nop 0
  buffer_load_dwordx4 v4, s[12:15], s21 offen lds
  s_add_u32 m0, s22, 1024
  s_nop 0
  buffer_load_dwordx4 v5, s[12:15], s21 offen lds
  s_add_u32 m0, s22, 2048
  s_nop 0
  buffer_load_dwordx4 v6, s[12:15], s21 offen lds
  s_mul_i32 s21, s20, 491520
  s_add_u32 s21, s21, 393216
  s_add_u32 s21, s21, s44
  s_mul_i32 s22, s20, 15360
  s_add_u32 s22, s22, 12288
  s_add_u32 m0, s22, 0
  s_nop 0
  buffer_load_dwordx4 v4, s[12:15], s21 offen lds
  s_add_u32 m0, s22, 1024
  s_nop 0
  buffer_load_dwordx4 v5, s[12:15], s21 offen lds
  s_add_u32 m0, s22, 2048
  s_nop 0
  buffer_load_dwordx4 v6, s[12:15], s21 offen lds
  s_mul_i32 s21, s20, 491520
  s_add_u32 s21, s21, 1966080
  s_add_u32 s21, s21, s44
  s_mul_i32 s22, s20, 15360
  s_add_u32 s22, s22, 61440
  s_add_u32 m0, s22, 0
  s_nop 0
  buffer_load_dwordx4 v4, s[12:15], s21 offen lds
  s_add_u32 m0, s22, 1024
  s_nop 0
  buffer_load_dwordx4 v5, s[12:15], s21 offen lds
  s_add_u32 m0, s22, 2048
  s_nop 0
  buffer_load_dwordx4 v6, s[12:15], s21 offen lds
  s_mul_i32 s21, s20, 491520
  s_add_u32 s21, s21, 2064384
  s_add_u32 s21, s21, s44
  s_mul_i32 s22, s20, 15360
  s_add_u32 s22, s22, 64512
  s_add_u32 m0, s22, 0
  s_nop 0
  buffer_load_dwordx4 v4, s[12:15], s21 offen lds
  s_add_u32 m0, s22, 1024
  s_nop 0
  buffer_load_dwordx4 v5, s[12:15], s21 offen lds
  s_add_u32 m0, s22, 2048
  s_nop 0
  buffer_load_dwordx4 v6, s[12:15], s21 offen lds
  s_mul_i32 s21, s20, 491520
  s_add_u32 s21, s21, 2162688
  s_add_u32 s21, s21, s44
  s_mul_i32 s22, s20, 15360
  s_add_u32 s22, s22, 67584
  s_add_u32 m0, s22, 0
  s_nop 0
  buffer_load_dwordx4 v4, s[12:15], s21 offen lds
  s_add_u32 m0, s22, 1024
  s_nop 0
  buffer_load_dwordx4 v5, s[12:15], s21 offen lds
  s_add_u32 m0, s22, 2048
  s_nop 0
  buffer_load_dwordx4 v6, s[12:15], s21 offen lds
  s_mul_i32 s21, s20, 491520
  s_add_u32 s21, s21, 2260992
  s_add_u32 s21, s21, s44
  s_mul_i32 s22, s20, 15360
  s_add_u32 s22, s22, 70656
  s_add_u32 m0, s22, 0
  s_nop 0
  buffer_load_dwordx4 v4, s[12:15], s21 offen lds
  s_add_u32 m0, s22, 1024
  s_nop 0
  buffer_load_dwordx4 v5, s[12:15], s21 offen lds
  s_add_u32 m0, s22, 2048
  s_nop 0
  buffer_load_dwordx4 v6, s[12:15], s21 offen lds
  s_mul_i32 s21, s20, 491520
  s_add_u32 s21, s21, 2359296
  s_add_u32 s21, s21, s44
  s_mul_i32 s22, s20, 15360
  s_add_u32 s22, s22, 73728
  s_add_u32 m0, s22, 0
  s_nop 0
  buffer_load_dwordx4 v4, s[12:15], s21 offen lds
  s_add_u32 m0, s22, 1024
  s_nop 0
  buffer_load_dwordx4 v5, s[12:15], s21 offen lds
  s_add_u32 m0, s22, 2048
  s_nop 0
  buffer_load_dwordx4 v6, s[12:15], s21 offen lds
  s_mul_i32 s21, s20, 491520
  s_add_u32 s21, s21, 3932160
  s_add_u32 s21, s21, s44
  buffer_load_dwordx4 v[64:67], v4, s[12:15], s21 offen
  buffer_load_dwordx4 v[68:71], v5, s[12:15], s21 offen
  buffer_load_dwordx4 v[72:75], v6, s[12:15], s21 offen
  s_mul_i32 s21, s20, 491520
  s_add_u32 s21, s21, 4030464
  s_add_u32 s21, s21, s44
  buffer_load_dwordx4 v[76:79], v4, s[12:15], s21 offen
  buffer_load_dwordx4 v[80:83], v5, s[12:15], s21 offen
  buffer_load_dwordx4 v[84:87], v6, s[12:15], s21 offen
  s_mul_i32 s21, s20, 491520
  s_add_u32 s21, s21, 4128768
  s_add_u32 s21, s21, s44
  buffer_load_dwordx4 v[88:91], v4, s[12:15], s21 offen
  buffer_load_dwordx4 v[92:95], v5, s[12:15], s21 offen
  buffer_load_dwordx4 v[96:99], v6, s[12:15], s21 offen
  s_mul_i32 s21, s20, 491520
  s_add_u32 s21, s21, 4227072
  s_add_u32 s21, s21, s44
  buffer_load_dwordx4 v[100:103], v4, s[12:15], s21 offen
  buffer_load_dwordx4 v[104:107], v5, s[12:15], s21 offen
  buffer_load_dwordx4 v[108:111], v6, s[12:15], s21 offen
  s_mul_i32 s21, s20, 491520
  s_add_u32 s21, s21, 4325376
  s_add_u32 s21, s21, s44
  buffer_load_dwordx4 v[112:115], v4, s[12:15], s21 offen
  buffer_load_dwordx4 v[116:119], v5, s[12:15], s21 offen
  buffer_load_dwordx4 v[120:123], v6, s[12:15], s21 offen
  s_mul_i32 s21, s20, 491520
  s_add_u32 s21, s21, 5898240
  s_add_u32 s21, s21, s44
  buffer_load_dwordx4 v[124:127], v4, s[12:15], s21 offen
  buffer_load_dwordx4 v[128:131], v5, s[12:15], s21 offen
  buffer_load_dwordx4 v[132:135], v6, s[12:15], s21 offen
  s_mul_i32 s21, s20, 491520
  s_add_u32 s21, s21, 5996544
  s_add_u32 s21, s21, s44
  buffer_load_dwordx4 v[136:139], v4, s[12:15], s21 offen
  buffer_load_dwordx4 v[140:143], v5, s[12:15], s21 offen
  buffer_load_dwordx4 v[144:147], v6, s[12:15], s21 offen
  s_mul_i32 s21, s20, 491520
  s_add_u32 s21, s21, 6094848
  s_add_u32 s21, s21, s44
  buffer_load_dwordx4 v[148:151], v4, s[12:15], s21 offen
  buffer_load_dwordx4 v[152:155], v5, s[12:15], s21 offen
  buffer_load_dwordx4 v[156:159], v6, s[12:15], s21 offen
  s_mul_i32 s21, s20, 491520
  s_add_u32 s21, s21, 6193152
  s_add_u32 s21, s21, s44
  buffer_load_dwordx4 v[160:163], v4, s[12:15], s21 offen
  buffer_load_dwordx4 v[164:167], v5, s[12:15], s21 offen
  buffer_load_dwordx4 v[168:171], v6, s[12:15], s21 offen
  s_mul_i32 s21, s20, 491520
  s_add_u32 s21, s21, 6291456
  s_add_u32 s21, s21, s44
  buffer_load_dwordx4 v[172:175], v4, s[12:15], s21 offen
  buffer_load_dwordx4 v[176:179], v5, s[12:15], s21 offen
  buffer_load_dwordx4 v[180:183], v6, s[12:15], s21 offen
  s_mul_i32 s22, s20, 15360
  v_lshl_add_u32 v30, v1, 4, s22
  v_add_u32 v31, 61440, v30
  s_waitcnt vmcnt(45)
  s_barrier
  ds_read_b64_tr_b16 a[0:1], v7 offset:0
  ds_read_b64_tr_b16 a[2:3], v7 offset:1536
  ds_read_b64_tr_b16 a[4:5], v7 offset:32
  ds_read_b64_tr_b16 a[6:7], v7 offset:1568
  ds_read_b64_tr_b16 a[8:9], v7 offset:64
  ds_read_b64_tr_b16 a[10:11], v7 offset:1600
  ds_read_b64_tr_b16 a[12:13], v7 offset:12288
  ds_read_b64_tr_b16 a[14:15], v7 offset:13824
  ds_read_b64_tr_b16 a[16:17], v7 offset:12320
  ds_read_b64_tr_b16 a[18:19], v7 offset:13856
  ds_read_b64_tr_b16 a[20:21], v7 offset:12352
  ds_read_b64_tr_b16 a[22:23], v7 offset:13888
  ds_read_b64_tr_b16 a[24:25], v7 offset:24576
  ds_read_b64_tr_b16 a[26:27], v7 offset:26112
  ds_read_b64_tr_b16 a[28:29], v7 offset:24608
  ds_read_b64_tr_b16 a[30:31], v7 offset:26144
  ds_read_b64_tr_b16 a[32:33], v7 offset:24640
  ds_read_b64_tr_b16 a[34:35], v7 offset:26176
  ds_read_b64_tr_b16 a[36:37], v7 offset:36864
  ds_read_b64_tr_b16 a[38:39], v7 offset:38400
  ds_read_b64_tr_b16 a[40:41], v7 offset:36896
  ds_read_b64_tr_b16 a[42:43], v7 offset:38432
  ds_read_b64_tr_b16 a[44:45], v7 offset:36928
  ds_read_b64_tr_b16 a[46:47], v7 offset:38464
  ds_read_b64_tr_b16 a[48:49], v7 offset:49152
  ds_read_b64_tr_b16 a[50:51], v7 offset:50688
  ds_read_b64_tr_b16 a[52:53], v7 offset:49184
  ds_read_b64_tr_b16 a[54:55], v7 offset:50720
  ds_read_b64_tr_b16 a[56:57], v7 offset:49216
  ds_read_b64_tr_b16 a[58:59], v7 offset:50752
  s_waitcnt lgkmcnt(0)
  s_barrier
  s_waitcnt vmcnt(30)
  s_barrier
  ds_read_b64_tr_b16 a[60:61], v8 offset:0
  ds_read_b64_tr_b16 a[62:63], v8 offset:1536
  ds_read_b64_tr_b16 a[64:65], v8 offset:32
  ds_read_b64_tr_b16 a[66:67], v8 offset:1568
  ds_read_b64_tr_b16 a[68:69], v8 offset:64
  ds_read_b64_tr_b16 a[70:71], v8 offset:1600
  ds_read_b64_tr_b16 a[72:73], v8 offset:12288
  ds_read_b64_tr_b16 a[74:75], v8 offset:13824
  ds_read_b64_tr_b16 a[76:77], v8 offset:12320
  ds_read_b64_tr_b16 a[78:79], v8 offset:13856
  ds_read_b64_tr_b16 a[80:81], v8 offset:12352
  ds_read_b64_tr_b16 a[82:83], v8 offset:13888
  ds_read_b64_tr_b16 a[84:85], v8 offset:24576
  ds_read_b64_tr_b16 a[86:87], v8 offset:26112
  ds_read_b64_tr_b16 a[88:89], v8 offset:24608
  ds_read_b64_tr_b16 a[90:91], v8 offset:26144
  ds_read_b64_tr_b16 a[92:93], v8 offset:24640
  ds_read_b64_tr_b16 a[94:95], v8 offset:26176
  ds_read_b64_tr_b16 a[96:97], v8 offset:36864
  ds_read_b64_tr_b16 a[98:99], v8 offset:38400
  ds_read_b64_tr_b16 a[100:101], v8 offset:36896
  ds_read_b64_tr_b16 a[102:103], v8 offset:38432
  ds_read_b64_tr_b16 a[104:105], v8 offset:36928
  ds_read_b64_tr_b16 a[106:107], v8 offset:38464
  ds_read_b64_tr_b16 a[108:109], v8 offset:49152
  ds_read_b64_tr_b16 a[110:111], v8 offset:50688
  ds_read_b64_tr_b16 a[112:113], v8 offset:49184
  ds_read_b64_tr_b16 a[114:115], v8 offset:50720
  ds_read_b64_tr_b16 a[116:117], v8 offset:49216
  ds_read_b64_tr_b16 a[118:119], v8 offset:50752
  s_waitcnt lgkmcnt(0)
  s_barrier
  s_waitcnt vmcnt(15)
  ds_write_b128 v30, v[64:67] offset:0
  ds_write_b128 v30, v[68:71] offset:1024
  ds_write_b128 v30, v[72:75] offset:2048
  ds_write_b128 v30, v[76:79] offset:3072
  ds_write_b128 v30, v[80:83] offset:4096
  ds_write_b128 v30, v[84:87] offset:5120
  ds_write_b128 v30, v[88:91] offset:6144
  ds_write_b128 v30, v[92:95] offset:7168
  ds_write_b128 v30, v[96:99] offset:8192
  ds_write_b128 v30, v[100:103] offset:9216
  ds_write_b128 v30, v[104:107] offset:10240
  ds_write_b128 v30, v[108:111] offset:11264
  ds_write_b128 v30, v[112:115] offset:12288
  ds_write_b128 v30, v[116:119] offset:13312
  ds_write_b128 v30, v[120:123] offset:14336
  s_waitcnt lgkmcnt(0)
  s_barrier
  ds_read_b64_tr_b16 a[120:121], v7 offset:0
  ds_read_b64_tr_b16 a[122:123], v7 offset:1536
  ds_read_b64_tr_b16 a[124:125], v7 offset:32
  ds_read_b64_tr_b16 a[126:127], v7 offset:1568
  ds_read_b64_tr_b16 a[128:129], v7 offset:64
  ds_read_b64_tr_b16 a[130:131], v7 offset:1600
  ds_read_b64_tr_b16 a[132:133], v7 offset:12288
  ds_read_b64_tr_b16 a[134:135], v7 offset:13824
  ds_read_b64_tr_b16 a[136:137], v7 offset:12320
  ds_read_b64_tr_b16 a[138:139], v7 offset:13856
  ds_read_b64_tr_b16 a[140:141], v7 offset:12352
  ds_read_b64_tr_b16 a[142:143], v7 offset:13888
  ds_read_b64_tr_b16 a[144:145], v7 offset:24576
  ds_read_b64_tr_b16 a[146:147], v7 offset:26112
  ds_read_b64_tr_b16 a[148:149], v7 offset:24608
  ds_read_b64_tr_b16 a[150:151], v7 offset:26144
  ds_read_b64_tr_b16 a[152:153], v7 offset:24640
  ds_read_b64_tr_b16 a[154:155], v7 offset:26176
  ds_read_b64_tr_b16 a[156:157], v7 offset:36864
  ds_read_b64_tr_b16 a[158:159], v7 offset:38400
  ds_read_b64_tr_b16 a[160:161], v7 offset:36896
  ds_read_b64_tr_b16 a[162:163], v7 offset:38432
  ds_read_b64_tr_b16 a[164:165], v7 offset:36928
  ds_read_b64_tr_b16 a[166:167], v7 offset:38464
  ds_read_b64_tr_b16 a[168:169], v7 offset:49152
  ds_read_b64_tr_b16 a[170:171], v7 offset:50688
  ds_read_b64_tr_b16 a[172:173], v7 offset:49184
  ds_read_b64_tr_b16 a[174:175], v7 offset:50720
  ds_read_b64_tr_b16 a[176:177], v7 offset:49216
  ds_read_b64_tr_b16 a[178:179], v7 offset:50752
  s_waitcnt lgkmcnt(0)
  s_barrier
  s_waitcnt vmcnt(0)
  ds_write_b128 v31, v[124:127] offset:0
  ds_write_b128 v31, v[128:131] offset:1024
  ds_write_b128 v31, v[132:135] offset:2048
  ds_write_b128 v31, v[136:139] offset:3072
  ds_write_b128 v31, v[140:143] offset:4096
  ds_write_b128 v31, v[144:147] offset:5120
  ds_write_b128 v31, v[148:151] offset:6144
  ds_write_b128 v31, v[152:155] offset:7168
  ds_write_b128 v31, v[156:159] offset:8192
  ds_write_b128 v31, v[160:163] offset:9216
  ds_write_b128 v31, v[164:167] offset:10240
  ds_write_b128 v31, v[168:171] offset:11264
  ds_write_b128 v31, v[172:175] offset:12288
  ds_write_b128 v31, v[176:179] offset:13312
  ds_write_b128 v31, v[180:183] offset:14336
  s_waitcnt lgkmcnt(0)
  s_barrier
  ds_read_b64_tr_b16 a[180:181], v8 offset:0
  ds_read_b64_tr_b16 a[182:183], v8 offset:1536
  ds_read_b64_tr_b16 a[184:185], v8 offset:32
  ds_read_b64_tr_b16 a[186:187], v8 offset:1568
  ds_read_b64_tr_b16 a[188:189], v8 offset:64
  ds_read_b64_tr_b16 a[190:191], v8 offset:1600
  ds_read_b64_tr_b16 a[192:193], v8 offset:12288
  ds_read_b64_tr_b16 a[194:195], v8 offset:13824
  ds_read_b64_tr_b16 a[196:197], v8 offset:12320
  ds_read_b64_tr_b16 a[198:199], v8 offset:13856
  ds_read_b64_tr_b16 a[200:201], v8 offset:12352
  ds_read_b64_tr_b16 a[202:203], v8 offset:13888
  ds_read_b64_tr_b16 a[204:205], v8 offset:24576
  ds_read_b64_tr_b16 a[206:207], v8 offset:26112
  ds_read_b64_tr_b16 a[208:209], v8 offset:24608
  ds_read_b64_tr_b16 a[210:211], v8 offset:26144
  ds_read_b64_tr_b16 a[212:213], v8 offset:24640
  ds_read_b64_tr_b16 a[214:215], v8 offset:26176
  ds_read_b64_tr_b16 a[216:217], v8 offset:36864
  ds_read_b64_tr_b16 a[218:219], v8 offset:38400
  ds_read_b64_tr_b16 a[220:221], v8 offset:36896
  ds_read_b64_tr_b16 a[222:223], v8 offset:38432
  ds_read_b64_tr_b16 a[224:225], v8 offset:36928
  ds_read_b64_tr_b16 a[226:227], v8 offset:38464
  ds_read_b64_tr_b16 a[228:229], v8 offset:49152
  ds_read_b64_tr_b16 a[230:231], v8 offset:50688
  ds_read_b64_tr_b16 a[232:233], v8 offset:49184
  ds_read_b64_tr_b16 a[234:235], v8 offset:50720
  ds_read_b64_tr_b16 a[236:237], v8 offset:49216
  ds_read_b64_tr_b16 a[238:239], v8 offset:50752
  s_waitcnt lgkmcnt(0)
  s_barrier
  s_mov_b32 s24, 2129920
  s_mov_b32 s25, 163840
  v_lshrrev_b32 v11, 3, v1
  v_and_b32 v12, 7, v1
  v_xor_b32 v12, v12, v11
  v_mul_u32_u24 v11, 1280, v11
  v_lshl_add_u32 v10, v12, 4, v11
  s_mul_i32 s46, s20, 40960
  v_add_u32 v10, s46, v10
  s_lshl_b32 s47, s20, 12
  s_add_u32 s47, s47, 0
  s_add_u32 s46, s47, 98304
  s_mov_b32 s30, s24
  s_add_u32 s32, s47, 32768
  v_add_u32 v11, 9216, v10
  v_add_u32 v12, 18432, v10
  v_add_u32 v13, 27648, v10
  s_mov_b32 m0, s32
  s_nop 0
  buffer_load_dwordx4 v10, s[8:11], s30 offen offset:0 lds
  buffer_load_dwordx4 v11, s[8:11], s30 offen offset:1024 lds
  buffer_load_dwordx4 v12, s[8:11], s30 offen offset:2048 lds
  buffer_load_dwordx4 v13, s[8:11], s30 offen offset:3072 lds
  s_add_u32 s30, s30, 128
  s_add_u32 s32, s32, 16384
  s_cmp_lt_u32 s32, s46
  s_cselect_b32 s32, s32, s47
  s_mov_b32 m0, s32
  s_nop 0
  buffer_load_dwordx4 v10, s[8:11], s30 offen offset:0 lds
  buffer_load_dwordx4 v11, s[8:11], s30 offen offset:1024 lds
  buffer_load_dwordx4 v12, s[8:11], s30 offen offset:2048 lds
  buffer_load_dwordx4 v13, s[8:11], s30 offen offset:3072 lds
  s_add_u32 s30, s30, 128
  s_add_u32 s32, s32, 16384
  s_cmp_lt_u32 s32, s46
  s_cselect_b32 s32, s32, s47
  s_mov_b32 m0, s32
  s_nop 0
  buffer_load_dwordx4 v10, s[8:11], s30 offen offset:0 lds
  buffer_load_dwordx4 v11, s[8:11], s30 offen offset:1024 lds
  buffer_load_dwordx4 v12, s[8:11], s30 offen offset:2048 lds
  buffer_load_dwordx4 v13, s[8:11], s30 offen offset:3072 lds
  s_add_u32 s30, s30, 128
  s_add_u32 s32, s32, 16384
  s_cmp_lt_u32 s32, s46
  s_cselect_b32 s32, s32, s47
  s_mov_b32 m0, s32
  s_nop 0
  buffer_load_dwordx4 v10, s[8:11], s30 offen offset:0 lds
  buffer_load_dwordx4 v11, s[8:11], s30 offen offset:1024 lds
  buffer_load_dwordx4 v12, s[8:11], s30 offen offset:2048 lds
  buffer_load_dwordx4 v13, s[8:11], s30 offen offset:3072 lds
  s_add_u32 s30, s30, 128
  s_add_u32 s32, s32, 16384
  s_cmp_lt_u32 s32, s46
  s_cselect_b32 s32, s32, s47
  s_mov_b32 s26, 3
  s_mul_i32 s27, s42, 12288
  s_lshl_b32 s60, s42, 7
  s_add_u32 s60, s60, 113664
  s_mov_b32 s62, 0
  s_branch kv_main
kv_fin:
  s_cmp_lg_u32 s43, 2
  s_cbranch_scc1 queue
  s_bfe_u32 s21, s3, 0x20001
  s_cmp_lt_u32 s21, 2
  s_cbranch_scc1 queue
  s_sub_u32 s21, s21, 2
  s_lshl_b32 s21, s21, 3
  s_lshr_b32 s22, s3, 3
  s_add_u32 s21, s21, s22
  s_add_u32 s87, s21, 342
  s_branch tail_item
  s_branch queue
not_kv:
  s_cmp_ge_u32 s3, 96
  s_cbranch_scc1 not_vw
  s_sub_u32 s2, s3, 64
  s_load_dwordx2 s[72:73], s[0:1], 104
  s_waitcnt lgkmcnt(0)
  s_add_u32 s72, s72, 81068032
  s_addc_u32 s73, s73, 0
  s_mov_b32 s74, 117760
  s_mov_b32 s75, 0x00020000
  s_add_u32 s8, s38, 78643200
  s_addc_u32 s9, s39, 0
  s_mov_b32 s10, 2162688
  s_mov_b32 s11, 0x00020000
  s_add_u32 s12, s38, 50331648
  s_addc_u32 s13, s39, 0
  s_mov_b32 s14, 12582912
  s_mov_b32 s15, 0x00020000
  s_add_u32 s16, s38, 83886079
  s_addc_u32 s17, s39, 0
  s_and_b32 s16, s16, 0xffe00000
  s_mov_b32 s18, 2097152
  s_mov_b32 s19, 0x00020000
  v_lshlrev_b32 v8, 4, v0
  v_lshlrev_b32 v9, 4, v1
  v_mov_b32 v4, 0
  v_mov_b32 v12, -1
  v_mov_b32 v5, 0
  v_mov_b32 v13, -1
  v_mov_b32 v6, 0
  v_mov_b32 v14, -1
  v_mov_b32 v7, 0
  v_mov_b32 v15, -1
  s_lshl_b32 s21, s2, 12
  buffer_store_dwordx4 v[4:7], v8, s[72:75], s21 offen sc1
  s_lshr_b32 s21, s2, 3
  s_lshl_b32 s21, s21, 15
  s_bfe_u32 s22, s2, 0x10002
  s_lshl_b32 s22, s22, 13
  s_add_u32 s21, s21, s22
  s_bfe_u32 s22, s2, 0x10001
  s_lshl_b32 s22, s22, 14
  s_add_u32 s21, s21, s22
  s_and_b32 s22, s2, 1
  s_mul_i32 s22, s22, 3
  s_add_u32 s22, s22, s20
  s_lshl_b32 s22, s22, 10
  s_add_u32 s21, s21, s22
  s_cmp_lt_u32 s20, 3
  s_cselect_b32 s21, s21, 0x80000000
  buffer_store_dwordx4 v[4:7], v9, s[16:19], s21 offen sc1
  s_mul_i32 s23, s20, 540672
  s_lshl_b32 s21, s2, 11
  s_add_u32 s21, s21, s23
  s_add_u32 s21, s21, 81920
  buffer_store_dwordx4 v[12:15], v9, s[8:11], s21 offen sc1
  buffer_store_dwordx4 v[12:15], v9, s[8:11], s21 offen offset:1024 sc1
  s_mul_i32 s21, s2, 3072
  s_add_u32 s21, s21, s23
  s_add_u32 s21, s21, 278528
  buffer_store_dwordx4 v[12:15], v9, s[8:11], s21 offen sc1
  buffer_store_dwordx4 v[12:15], v9, s[8:11], s21 offen offset:1024 sc1
  buffer_store_dwordx4 v[12:15], v9, s[8:11], s21 offen offset:2048 sc1
  s_lshl_b32 s21, s2, 9
  s_add_u32 s21, s21, s23
  s_add_u32 s21, s21, 376832
  s_mov_b64 exec, 0xffffffff
  buffer_store_dwordx4 v[12:15], v9, s[8:11], s21 offen sc1
  s_mov_b64 exec, -1
  s_lshl_b32 s21, s20, 5
  s_add_u32 s21, s21, s2
  s_mul_i32 s21, s21, 3072
  s_cmp_lt_u32 s20, 3
  s_cselect_b32 s21, s21, 0x80000000
  s_add_u32 s22, s21, 6291456
  buffer_store_dwordx4 v[12:15], v9, s[12:15], s21 offen offset:0 sc1
  buffer_store_dwordx4 v[12:15], v9, s[12:15], s22 offen offset:0 sc1
  buffer_store_dwordx4 v[12:15], v9, s[12:15], s21 offen offset:1024 sc1
  buffer_store_dwordx4 v[12:15], v9, s[12:15], s22 offen offset:1024 sc1
  buffer_store_dwordx4 v[12:15], v9, s[12:15], s21 offen offset:2048 sc1
  buffer_store_dwordx4 v[12:15], v9, s[12:15], s22 offen offset:2048 sc1
  s_waitcnt vmcnt(0)
  s_barrier
  s_mov_b32 s21, 76
  s_cmp_lg_u32 s20, 0
  s_cbranch_scc1 af_154
  v_mov_b32 v10, 0
  v_mov_b32 v11, 1
  s_mov_b64 exec, 1
  buffer_atomic_add v11, v10, s[32:35], s21 offen sc1
  s_mov_b64 exec, -1
  s_nop 1
af_154:
  s_load_dwordx2 s[6:7], s[0:1], 40
  s_load_dwordx2 s[38:39], s[0:1], 104
  s_waitcnt lgkmcnt(0)
  s_mov_b32 s12, s6
  s_mov_b32 s13, s7
  s_mov_b32 s14, 7864320
  s_mov_b32 s15, 0x00020000
  s_mov_b32 s16, s38
  s_mov_b32 s17, s39
  s_mov_b32 s18, 50331648
  s_mov_b32 s19, 0x00020000
  s_add_u32 s24, s38, 114294784
  s_addc_u32 s25, s39, 0
  s_mov_b32 s26, 83886080
  s_mov_b32 s27, 0x00020000
  s_load_dwordx2 s[72:73], s[0:1], 104
  s_waitcnt lgkmcnt(0)
  s_add_u32 s72, s72, 81068032
  s_addc_u32 s73, s73, 0
  s_mov_b32 s74, 117760
  s_mov_b32 s75, 0x00020000
  v_mov_b32 v29, 52429
  s_mul_i32 s21, s20, 960
  s_add_u32 s21, s21, 0
  v_add_u32 v21, s21, v1
  v_mul_u32_u24 v22, v21, v29
  v_lshrrev_b32 v22, 22, v22
  v_mul_u32_u24 v23, 80, v22
  v_sub_u32 v21, v21, v23
  v_bfe_u32 v23, v22, 3, 1
  v_and_b32 v24, 3, v22
  v_lshl_add_u32 v23, v23, 2, v24
  v_lshlrev_b32 v23, 1, v23
  v_xor_b32 v21, v21, v23
  v_cmp_gt_u32 vcc, 32, v22
  v_bfe_u32 v26, v22, 3, 2
  v_lshl_add_u32 v25, v26, 2, v24
  v_bfe_u32 v26, v22, 2, 1
  v_lshl_add_u32 v25, v26, 4, v25
  v_cndmask_b32 v25, v22, v25, vcc
  v_mul_u32_u24 v25, 1280, v25
  v_lshl_add_u32 v64, v21, 4, v25
  s_mul_i32 s21, s20, 960
  s_add_u32 s21, s21, 64
  v_add_u32 v21, s21, v1
  v_mul_u32_u24 v22, v21, v29
  v_lshrrev_b32 v22, 22, v22
  v_mul_u32_u24 v23, 80, v22
  v_sub_u32 v21, v21, v23
  v_bfe_u32 v23, v22, 3, 1
  v_and_b32 v24, 3, v22
  v_lshl_add_u32 v23, v23, 2, v24
  v_lshlrev_b32 v23, 1, v23
  v_xor_b32 v21, v21, v23
  v_cmp_gt_u32 vcc, 32, v22
  v_bfe_u32 v26, v22, 3, 2
  v_lshl_add_u32 v25, v26, 2, v24
  v_bfe_u32 v26, v22, 2, 1
  v_lshl_add_u32 v25, v26, 4, v25
  v_cndmask_b32 v25, v22, v25, vcc
  v_mul_u32_u24 v25, 1280, v25
  v_lshl_add_u32 v65, v21, 4, v25
  s_mul_i32 s21, s20, 960
  s_add_u32 s21, s21, 128
  v_add_u32 v21, s21, v1
  v_mul_u32_u24 v22, v21, v29
  v_lshrrev_b32 v22, 22, v22
  v_mul_u32_u24 v23, 80, v22
  v_sub_u32 v21, v21, v23
  v_bfe_u32 v23, v22, 3, 1
  v_and_b32 v24, 3, v22
  v_lshl_add_u32 v23, v23, 2, v24
  v_lshlrev_b32 v23, 1, v23
  v_xor_b32 v21, v21, v23
  v_cmp_gt_u32 vcc, 32, v22
  v_bfe_u32 v26, v22, 3, 2
  v_lshl_add_u32 v25, v26, 2, v24
  v_bfe_u32 v26, v22, 2, 1
  v_lshl_add_u32 v25, v26, 4, v25
  v_cndmask_b32 v25, v22, v25, vcc
  v_mul_u32_u24 v25, 1280, v25
  v_lshl_add_u32 v66, v21, 4, v25
  s_mul_i32 s21, s20, 960
  s_add_u32 s21, s21, 192
  v_add_u32 v21, s21, v1
  v_mul_u32_u24 v22, v21, v29
  v_lshrrev_b32 v22, 22, v22
  v_mul_u32_u24 v23, 80, v22
  v_sub_u32 v21, v21, v23
  v_bfe_u32 v23, v22, 3, 1
  v_and_b32 v24, 3, v22
  v_lshl_add_u32 v23, v23, 2, v24
  v_lshlrev_b32 v23, 1, v23
  v_xor_b32 v21, v21, v23
  v_cmp_gt_u32 vcc, 32, v22
  v_bfe_u32 v26, v22, 3, 2
  v_lshl_add_u32 v25, v26, 2, v24
  v_bfe_u32 v26, v22, 2, 1
  v_lshl_add_u32 v25, v26, 4, v25
  v_cndmask_b32 v25, v22, v25, vcc
  v_mul_u32_u24 v25, 1280, v25
  v_lshl_add_u32 v67, v21, 4, v25
  s_mul_i32 s21, s20, 960
  s_add_u32 s21, s21, 256
  v_add_u32 v21, s21, v1
  v_mul_u32_u24 v22, v21, v29
  v_lshrrev_b32 v22, 22, v22
  v_mul_u32_u24 v23, 80, v22
  v_sub_u32 v21, v21, v23
  v_bfe_u32 v23, v22, 3, 1
  v_and_b32 v24, 3, v22
  v_lshl_add_u32 v23, v23, 2, v24
  v_lshlrev_b32 v23, 1, v23
  v_xor_b32 v21, v21, v23
  v_cmp_gt_u32 vcc, 32, v22
  v_bfe_u32 v26, v22, 3, 2
  v_lshl_add_u32 v25, v26, 2, v24
  v_bfe_u32 v26, v22, 2, 1
  v_lshl_add_u32 v25, v26, 4, v25
  v_cndmask_b32 v25, v22, v25, vcc
  v_mul_u32_u24 v25, 1280, v25
  v_lshl_add_u32 v68, v21, 4, v25
  s_mul_i32 s21, s20, 960
  s_add_u32 s21, s21, 320
  v_add_u32 v21, s21, v1
  v_mul_u32_u24 v22, v21, v29
  v_lshrrev_b32 v22, 22, v22
  v_mul_u32_u24 v23, 80, v22
  v_sub_u32 v21, v21, v23
  v_bfe_u32 v23, v22, 3, 1
  v_and_b32 v24, 3, v22
  v_lshl_add_u32 v23, v23, 2, v24
  v_lshlrev_b32 v23, 1, v23
  v_xor_b32 v21, v21, v23
  v_cmp_gt_u32 vcc, 32, v22
  v_bfe_u32 v26, v22, 3, 2
  v_lshl_add_u32 v25, v26, 2, v24
  v_bfe_u32 v26, v22, 2, 1
  v_lshl_add_u32 v25, v26, 4, v25
  v_cndmask_b32 v25, v22, v25, vcc
  v_mul_u32_u24 v25, 1280, v25
  v_lshl_add_u32 v69, v21, 4, v25
  s_mul_i32 s21, s20, 960
  s_add_u32 s21, s21, 384
  v_add_u32 v21, s21, v1
  v_mul_u32_u24 v22, v21, v29
  v_lshrrev_b32 v22, 22, v22
  v_mul_u32_u24 v23, 80, v22
  v_sub_u32 v21, v21, v23
  v_bfe_u32 v23, v22, 3, 1
  v_and_b32 v24, 3, v22
  v_lshl_add_u32 v23, v23, 2, v24
  v_lshlrev_b32 v23, 1, v23
  v_xor_b32 v21, v21, v23
  v_cmp_gt_u32 vcc, 32, v22
  v_bfe_u32 v26, v22, 3, 2
  v_lshl_add_u32 v25, v26, 2, v24
  v_bfe_u32 v26, v22, 2, 1
  v_lshl_add_u32 v25, v26, 4, v25
  v_cndmask_b32 v25, v22, v25, vcc
  v_mul_u32_u24 v25, 1280, v25
  v_lshl_add_u32 v70, v21, 4, v25
  s_mul_i32 s21, s20, 960
  s_add_u32 s21, s21, 448
  v_add_u32 v21, s21, v1
  v_mul_u32_u24 v22, v21, v29
  v_lshrrev_b32 v22, 22, v22
  v_mul_u32_u24 v23, 80, v22
  v_sub_u32 v21, v21, v23
  v_bfe_u32 v23, v22, 3, 1
  v_and_b32 v24, 3, v22
  v_lshl_add_u32 v23, v23, 2, v24
  v_lshlrev_b32 v23, 1, v23
  v_xor_b32 v21, v21, v23
  v_cmp_gt_u32 vcc, 32, v22
  v_bfe_u32 v26, v22, 3, 2
  v_lshl_add_u32 v25, v26, 2, v24
  v_bfe_u32 v26, v22, 2, 1
  v_lshl_add_u32 v25, v26, 4, v25
  v_cndmask_b32 v25, v22, v25, vcc
  v_mul_u32_u24 v25, 1280, v25
  v_lshl_add_u32 v71, v21, 4, v25
  s_mul_i32 s21, s20, 960
  s_add_u32 s21, s21, 512
  v_add_u32 v21, s21, v1
  v_mul_u32_u24 v22, v21, v29
  v_lshrrev_b32 v22, 22, v22
  v_mul_u32_u24 v23, 80, v22
  v_sub_u32 v21, v21, v23
  v_bfe_u32 v23, v22, 3, 1
  v_and_b32 v24, 3, v22
  v_lshl_add_u32 v23, v23, 2, v24
  v_lshlrev_b32 v23, 1, v23
  v_xor_b32 v21, v21, v23
  v_cmp_gt_u32 vcc, 32, v22
  v_bfe_u32 v26, v22, 3, 2
  v_lshl_add_u32 v25, v26, 2, v24
  v_bfe_u32 v26, v22, 2, 1
  v_lshl_add_u32 v25, v26, 4, v25
  v_cndmask_b32 v25, v22, v25, vcc
  v_mul_u32_u24 v25, 1280, v25
  v_lshl_add_u32 v72, v21, 4, v25
  s_mul_i32 s21, s20, 960
  s_add_u32 s21, s21, 576
  v_add_u32 v21, s21, v1
  v_mul_u32_u24 v22, v21, v29
  v_lshrrev_b32 v22, 22, v22
  v_mul_u32_u24 v23, 80, v22
  v_sub_u32 v21, v21, v23
  v_bfe_u32 v23, v22, 3, 1
  v_and_b32 v24, 3, v22
  v_lshl_add_u32 v23, v23, 2, v24
  v_lshlrev_b32 v23, 1, v23
  v_xor_b32 v21, v21, v23
  v_cmp_gt_u32 vcc, 32, v22
  v_bfe_u32 v26, v22, 3, 2
  v_lshl_add_u32 v25, v26, 2, v24
  v_bfe_u32 v26, v22, 2, 1
  v_lshl_add_u32 v25, v26, 4, v25
  v_cndmask_b32 v25, v22, v25, vcc
  v_mul_u32_u24 v25, 1280, v25
  v_lshl_add_u32 v73, v21, 4, v25
  s_mul_i32 s21, s20, 960
  s_add_u32 s21, s21, 640
  v_add_u32 v21, s21, v1
  v_mul_u32_u24 v22, v21, v29
  v_lshrrev_b32 v22, 22, v22
  v_mul_u32_u24 v23, 80, v22
  v_sub_u32 v21, v21, v23
  v_bfe_u32 v23, v22, 3, 1
  v_and_b32 v24, 3, v22
  v_lshl_add_u32 v23, v23, 2, v24
  v_lshlrev_b32 v23, 1, v23
  v_xor_b32 v21, v21, v23
  v_cmp_gt_u32 vcc, 32, v22
  v_bfe_u32 v26, v22, 3, 2
  v_lshl_add_u32 v25, v26, 2, v24
  v_bfe_u32 v26, v22, 2, 1
  v_lshl_add_u32 v25, v26, 4, v25
  v_cndmask_b32 v25, v22, v25, vcc
  v_mul_u32_u24 v25, 1280, v25
  v_lshl_add_u32 v74, v21, 4, v25
  s_mul_i32 s21, s20, 960
  s_add_u32 s21, s21, 704
  v_add_u32 v21, s21, v1
  v_mul_u32_u24 v22, v21, v29
  v_lshrrev_b32 v22, 22, v22
  v_mul_u32_u24 v23, 80, v22
  v_sub_u32 v21, v21, v23
  v_bfe_u32 v23, v22, 3, 1
  v_and_b32 v24, 3, v22
  v_lshl_add_u32 v23, v23, 2, v24
  v_lshlrev_b32 v23, 1, v23
  v_xor_b32 v21, v21, v23
  v_cmp_gt_u32 vcc, 32, v22
  v_bfe_u32 v26, v22, 3, 2
  v_lshl_add_u32 v25, v26, 2, v24
  v_bfe_u32 v26, v22, 2, 1
  v_lshl_add_u32 v25, v26, 4, v25
  v_cndmask_b32 v25, v22, v25, vcc
  v_mul_u32_u24 v25, 1280, v25
  v_lshl_add_u32 v75, v21, 4, v25
  s_mul_i32 s21, s20, 960
  s_add_u32 s21, s21, 768
  v_add_u32 v21, s21, v1
  v_mul_u32_u24 v22, v21, v29
  v_lshrrev_b32 v22, 22, v22
  v_mul_u32_u24 v23, 80, v22
  v_sub_u32 v21, v21, v23
  v_bfe_u32 v23, v22, 3, 1
  v_and_b32 v24, 3, v22
  v_lshl_add_u32 v23, v23, 2, v24
  v_lshlrev_b32 v23, 1, v23
  v_xor_b32 v21, v21, v23
  v_cmp_gt_u32 vcc, 32, v22
  v_bfe_u32 v26, v22, 3, 2
  v_lshl_add_u32 v25, v26, 2, v24
  v_bfe_u32 v26, v22, 2, 1
  v_lshl_add_u32 v25, v26, 4, v25
  v_cndmask_b32 v25, v22, v25, vcc
  v_mul_u32_u24 v25, 1280, v25
  v_lshl_add_u32 v76, v21, 4, v25
  s_mul_i32 s21, s20, 960
  s_add_u32 s21, s21, 832
  v_add_u32 v21, s21, v1
  v_mul_u32_u24 v22, v21, v29
  v_lshrrev_b32 v22, 22, v22
  v_mul_u32_u24 v23, 80, v22
  v_sub_u32 v21, v21, v23
  v_bfe_u32 v23, v22, 3, 1
  v_and_b32 v24, 3, v22
  v_lshl_add_u32 v23, v23, 2, v24
  v_lshlrev_b32 v23, 1, v23
  v_xor_b32 v21, v21, v23
  v_cmp_gt_u32 vcc, 32, v22
  v_bfe_u32 v26, v22, 3, 2
  v_lshl_add_u32 v25, v26, 2, v24
  v_bfe_u32 v26, v22, 2, 1
  v_lshl_add_u32 v25, v26, 4, v25
  v_cndmask_b32 v25, v22, v25, vcc
  v_mul_u32_u24 v25, 1280, v25
  v_lshl_add_u32 v77, v21, 4, v25
  s_mul_i32 s21, s20, 960
  s_add_u32 s21, s21, 896
  v_add_u32 v21, s21, v1
  v_mul_u32_u24 v22, v21, v29
  v_lshrrev_b32 v22, 22, v22
  v_mul_u32_u24 v23, 80, v22
  v_sub_u32 v21, v21, v23
  v_bfe_u32 v23, v22, 3, 1
  v_and_b32 v24, 3, v22
  v_lshl_add_u32 v23, v23, 2, v24
  v_lshlrev_b32 v23, 1, v23
  v_xor_b32 v21, v21, v23
  v_cmp_gt_u32 vcc, 32, v22
  v_bfe_u32 v26, v22, 3, 2
  v_lshl_add_u32 v25, v26, 2, v24
  v_bfe_u32 v26, v22, 2, 1
  v_lshl_add_u32 v25, v26, 4, v25
  v_cndmask_b32 v25, v22, v25, vcc
  v_mul_u32_u24 v25, 1280, v25
  v_lshl_add_u32 v78, v21, 4, v25
  s_mul_i32 s40, s2, 245760
  s_sleep 32
  s_sleep 32
  s_add_u32 s21, s40, 0
  s_mul_i32 s22, s20, 15360
  s_add_u32 s22, s22, 0
  s_add_u32 m0, s22, 0
  s_nop 0
  buffer_load_dwordx4 v64, s[12:15], s21 offen lds
  s_add_u32 m0, s22, 1024
  s_nop 0
  buffer_load_dwordx4 v65, s[12:15], s21 offen lds
  s_add_u32 m0, s22, 2048
  s_nop 0
  buffer_load_dwordx4 v66, s[12:15], s21 offen lds
  s_add_u32 m0, s22, 3072
  s_nop 0
  buffer_load_dwordx4 v67, s[12:15], s21 offen lds
  s_add_u32 m0, s22, 4096
  s_nop 0
  buffer_load_dwordx4 v68, s[12:15], s21 offen lds
  s_add_u32 m0, s22, 5120
  s_nop 0
  buffer_load_dwordx4 v69, s[12:15], s21 offen lds
  s_add_u32 m0, s22, 6144
  s_nop 0
  buffer_load_dwordx4 v70, s[12:15], s21 offen lds
  s_add_u32 m0, s22, 7168
  s_nop 0
  buffer_load_dwordx4 v71, s[12:15], s21 offen lds
  s_add_u32 m0, s22, 8192
  s_nop 0
  buffer_load_dwordx4 v72, s[12:15], s21 offen lds
  s_add_u32 m0, s22, 9216
  s_nop 0
  buffer_load_dwordx4 v73, s[12:15], s21 offen lds
  s_add_u32 m0, s22, 10240
  s_nop 0
  buffer_load_dwordx4 v74, s[12:15], s21 offen lds
  s_add_u32 m0, s22, 11264
  s_nop 0
  buffer_load_dwordx4 v75, s[12:15], s21 offen lds
  s_add_u32 m0, s22, 12288
  s_nop 0
  buffer_load_dwordx4 v76, s[12:15], s21 offen lds
  s_add_u32 m0, s22, 13312
  s_nop 0
  buffer_load_dwordx4 v77, s[12:15], s21 offen lds
  s_add_u32 m0, s22, 14336
  s_nop 0
  buffer_load_dwordx4 v78, s[12:15], s21 offen lds
  s_add_u32 s21, s40, 61440
  s_mul_i32 s22, s20, 15360
  s_add_u32 s22, s22, 61440
  s_add_u32 m0, s22, 0
  s_nop 0
  buffer_load_dwordx4 v64, s[12:15], s21 offen lds
  s_add_u32 m0, s22, 1024
  s_nop 0
  buffer_load_dwordx4 v65, s[12:15], s21 offen lds
  s_add_u32 m0, s22, 2048
  s_nop 0
  buffer_load_dwordx4 v66, s[12:15], s21 offen lds
  s_add_u32 m0, s22, 3072
  s_nop 0
  buffer_load_dwordx4 v67, s[12:15], s21 offen lds
  s_add_u32 m0, s22, 4096
  s_nop 0
  buffer_load_dwordx4 v68, s[12:15], s21 offen lds
  s_add_u32 m0, s22, 5120
  s_nop 0
  buffer_load_dwordx4 v69, s[12:15], s21 offen lds
  s_add_u32 m0, s22, 6144
  s_nop 0
  buffer_load_dwordx4 v70, s[12:15], s21 offen lds
  s_add_u32 m0, s22, 7168
  s_nop 0
  buffer_load_dwordx4 v71, s[12:15], s21 offen lds
  s_add_u32 m0, s22, 8192
  s_nop 0
  buffer_load_dwordx4 v72, s[12:15], s21 offen lds
  s_add_u32 m0, s22, 9216
  s_nop 0
  buffer_load_dwordx4 v73, s[12:15], s21 offen lds
  s_add_u32 m0, s22, 10240
  s_nop 0
  buffer_load_dwordx4 v74, s[12:15], s21 offen lds
  s_add_u32 m0, s22, 11264
  s_nop 0
  buffer_load_dwordx4 v75, s[12:15], s21 offen lds
  s_add_u32 m0, s22, 12288
  s_nop 0
  buffer_load_dwordx4 v76, s[12:15], s21 offen lds
  s_add_u32 m0, s22, 13312
  s_nop 0
  buffer_load_dwordx4 v77, s[12:15], s21 offen lds
  s_add_u32 m0, s22, 14336
  s_nop 0
  buffer_load_dwordx4 v78, s[12:15], s21 offen lds
  s_add_u32 s21, s40, 122880
  s_mul_i32 s22, s20, 15360
  s_add_u32 s22, s22, 0
  buffer_load_dwordx4 v[80:83], v64, s[12:15], s21 offen
  buffer_load_dwordx4 v[84:87], v65, s[12:15], s21 offen
  buffer_load_dwordx4 v[88:91], v66, s[12:15], s21 offen
  buffer_load_dwordx4 v[92:95], v67, s[12:15], s21 offen
  buffer_load_dwordx4 v[96:99], v68, s[12:15], s21 offen
  buffer_load_dwordx4 v[100:103], v69, s[12:15], s21 offen
  buffer_load_dwordx4 v[104:107], v70, s[12:15], s21 offen
  buffer_load_dwordx4 v[108:111], v71, s[12:15], s21 offen
  buffer_load_dwordx4 v[112:115], v72, s[12:15], s21 offen
  buffer_load_dwordx4 v[116:119], v73, s[12:15], s21 offen
  buffer_load_dwordx4 v[120:123], v74, s[12:15], s21 offen
  buffer_load_dwordx4 v[124:127], v75, s[12:15], s21 offen
  buffer_load_dwordx4 v[128:131], v76, s[12:15], s21 offen
  buffer_load_dwordx4 v[132:135], v77, s[12:15], s21 offen
  buffer_load_dwordx4 v[136:139], v78, s[12:15], s21 offen
  s_add_u32 s21, s40, 184320
  s_mul_i32 s22, s20, 15360
  s_add_u32 s22, s22, 61440
  buffer_load_dwordx4 v[140:143], v64, s[12:15], s21 offen
  buffer_load_dwordx4 v[144:147], v65, s[12:15], s21 offen
  buffer_load_dwordx4 v[148:151], v66, s[12:15], s21 offen
  buffer_load_dwordx4 v[152:155], v67, s[12:15], s21 offen
  buffer_load_dwordx4 v[156:159], v68, s[12:15], s21 offen
  buffer_load_dwordx4 v[160:163], v69, s[12:15], s21 offen
  buffer_load_dwordx4 v[164:167], v70, s[12:15], s21 offen
  buffer_load_dwordx4 v[168:171], v71, s[12:15], s21 offen
  buffer_load_dwordx4 v[172:175], v72, s[12:15], s21 offen
  buffer_load_dwordx4 v[176:179], v73, s[12:15], s21 offen
  buffer_load_dwordx4 v[180:183], v74, s[12:15], s21 offen
  buffer_load_dwordx4 v[184:187], v75, s[12:15], s21 offen
  buffer_load_dwordx4 v[188:191], v76, s[12:15], s21 offen
  buffer_load_dwordx4 v[192:195], v77, s[12:15], s21 offen
  buffer_load_dwordx4 v[196:199], v78, s[12:15], s21 offen
  v_lshrrev_b32 v6, 2, v2
  v_lshl_add_u32 v7, v3, 3, v6
  v_mul_u32_u24 v7, 1280, v7
  v_and_b32 v8, 1, v2
  v_lshl_add_u32 v7, v8, 3, v7
  v_and_b32 v8, 1, v3
  v_lshl_add_u32 v6, v8, 2, v6
  v_lshlrev_b32 v6, 1, v6
  v_bfe_u32 v8, v2, 1, 1
  s_mul_i32 s21, s20, 20
  v_add_u32 v8, s21, v8
  v_add_u32 v5, 0, v8
  v_xor_b32 v5, v5, v6
  v_lshl_add_u32 v200, v5, 4, v7
  v_add_u32 v210, 81920, v200
  v_add_u32 v5, 2, v8
  v_xor_b32 v5, v5, v6
  v_lshl_add_u32 v201, v5, 4, v7
  v_add_u32 v211, 81920, v201
  v_add_u32 v5, 4, v8
  v_xor_b32 v5, v5, v6
  v_lshl_add_u32 v202, v5, 4, v7
  v_add_u32 v212, 81920, v202
  v_add_u32 v5, 6, v8
  v_xor_b32 v5, v5, v6
  v_lshl_add_u32 v203, v5, 4, v7
  v_add_u32 v213, 81920, v203
  v_add_u32 v5, 8, v8
  v_xor_b32 v5, v5, v6
  v_lshl_add_u32 v204, v5, 4, v7
  v_add_u32 v214, 81920, v204
  v_add_u32 v5, 10, v8
  v_xor_b32 v5, v5, v6
  v_lshl_add_u32 v205, v5, 4, v7
  v_add_u32 v215, 81920, v205
  v_add_u32 v5, 12, v8
  v_xor_b32 v5, v5, v6
  v_lshl_add_u32 v206, v5, 4, v7
  v_add_u32 v216, 81920, v206
  v_add_u32 v5, 14, v8
  v_xor_b32 v5, v5, v6
  v_lshl_add_u32 v207, v5, 4, v7
  v_add_u32 v217, 81920, v207
  v_add_u32 v5, 16, v8
  v_xor_b32 v5, v5, v6
  v_lshl_add_u32 v208, v5, 4, v7
  v_add_u32 v218, 81920, v208
  v_add_u32 v5, 18, v8
  v_xor_b32 v5, v5, v6
  v_lshl_add_u32 v209, v5, 4, v7
  v_add_u32 v219, 81920, v209
  s_mul_i32 s22, s20, 15360
  v_lshl_add_u32 v30, v1, 4, s22
  v_add_u32 v31, 61440, v30
  s_waitcnt vmcnt(30)
  s_barrier
  ds_read_b64_tr_b16 a[0:1], v200 offset:0
  ds_read_b64_tr_b16 a[2:3], v200 offset:5120
  ds_read_b64_tr_b16 a[24:25], v201 offset:0
  ds_read_b64_tr_b16 a[26:27], v201 offset:5120
  ds_read_b64_tr_b16 a[48:49], v202 offset:0
  ds_read_b64_tr_b16 a[50:51], v202 offset:5120
  ds_read_b64_tr_b16 a[72:73], v203 offset:0
  ds_read_b64_tr_b16 a[74:75], v203 offset:5120
  ds_read_b64_tr_b16 a[96:97], v204 offset:0
  ds_read_b64_tr_b16 a[98:99], v204 offset:5120
  ds_read_b64_tr_b16 a[120:121], v205 offset:0
  ds_read_b64_tr_b16 a[122:123], v205 offset:5120
  ds_read_b64_tr_b16 a[144:145], v206 offset:0
  ds_read_b64_tr_b16 a[146:147], v206 offset:5120
  ds_read_b64_tr_b16 a[168:169], v207 offset:0
  ds_read_b64_tr_b16 a[170:171], v207 offset:5120
  ds_read_b64_tr_b16 a[192:193], v208 offset:0
  ds_read_b64_tr_b16 a[194:195], v208 offset:5120
  ds_read_b64_tr_b16 a[216:217], v209 offset:0
  ds_read_b64_tr_b16 a[218:219], v209 offset:5120
  ds_read_b64_tr_b16 a[4:5], v200 offset:40960
  ds_read_b64_tr_b16 a[6:7], v200 offset:46080
  ds_read_b64_tr_b16 a[28:29], v201 offset:40960
  ds_read_b64_tr_b16 a[30:31], v201 offset:46080
  ds_read_b64_tr_b16 a[52:53], v202 offset:40960
  ds_read_b64_tr_b16 a[54:55], v202 offset:46080
  ds_read_b64_tr_b16 a[76:77], v203 offset:40960
  ds_read_b64_tr_b16 a[78:79], v203 offset:46080
  ds_read_b64_tr_b16 a[100:101], v204 offset:40960
  ds_read_b64_tr_b16 a[102:103], v204 offset:46080
  ds_read_b64_tr_b16 a[124:125], v205 offset:40960
  ds_read_b64_tr_b16 a[126:127], v205 offset:46080
  ds_read_b64_tr_b16 a[148:149], v206 offset:40960
  ds_read_b64_tr_b16 a[150:151], v206 offset:46080
  ds_read_b64_tr_b16 a[172:173], v207 offset:40960
  ds_read_b64_tr_b16 a[174:175], v207 offset:46080
  ds_read_b64_tr_b16 a[196:197], v208 offset:40960
  ds_read_b64_tr_b16 a[198:199], v208 offset:46080
  ds_read_b64_tr_b16 a[220:221], v209 offset:40960
  ds_read_b64_tr_b16 a[222:223], v209 offset:46080
  ds_read_b64_tr_b16 a[8:9], v210 offset:0
  ds_read_b64_tr_b16 a[10:11], v210 offset:5120
  ds_read_b64_tr_b16 a[32:33], v211 offset:0
  ds_read_b64_tr_b16 a[34:35], v211 offset:5120
  ds_read_b64_tr_b16 a[56:57], v212 offset:0
  ds_read_b64_tr_b16 a[58:59], v212 offset:5120
  ds_read_b64_tr_b16 a[80:81], v213 offset:0
  ds_read_b64_tr_b16 a[82:83], v213 offset:5120
  ds_read_b64_tr_b16 a[104:105], v214 offset:0
  ds_read_b64_tr_b16 a[106:107], v214 offset:5120
  ds_read_b64_tr_b16 a[128:129], v215 offset:0
  ds_read_b64_tr_b16 a[130:131], v215 offset:5120
  ds_read_b64_tr_b16 a[152:153], v216 offset:0
  ds_read_b64_tr_b16 a[154:155], v216 offset:5120
  ds_read_b64_tr_b16 a[176:177], v217 offset:0
  ds_read_b64_tr_b16 a[178:179], v217 offset:5120
  ds_read_b64_tr_b16 a[200:201], v218 offset:0
  ds_read_b64_tr_b16 a[202:203], v218 offset:5120
  ds_read_b64_tr_b16 a[224:225], v219 offset:0
  ds_read_b64_tr_b16 a[226:227], v219 offset:5120
  s_waitcnt lgkmcnt(0)
  s_barrier
  s_waitcnt vmcnt(15)
  ds_write_b128 v30, v[80:83] offset:0
  ds_write_b128 v30, v[84:87] offset:1024
  ds_write_b128 v30, v[88:91] offset:2048
  ds_write_b128 v30, v[92:95] offset:3072
  ds_write_b128 v30, v[96:99] offset:4096
  ds_write_b128 v30, v[100:103] offset:5120
  ds_write_b128 v30, v[104:107] offset:6144
  ds_write_b128 v30, v[108:111] offset:7168
  ds_write_b128 v30, v[112:115] offset:8192
  ds_write_b128 v30, v[116:119] offset:9216
  ds_write_b128 v30, v[120:123] offset:10240
  ds_write_b128 v30, v[124:127] offset:11264
  ds_write_b128 v30, v[128:131] offset:12288
  ds_write_b128 v30, v[132:135] offset:13312
  ds_write_b128 v30, v[136:139] offset:14336
  s_waitcnt vmcnt(0)
  ds_write_b128 v31, v[140:143] offset:0
  ds_write_b128 v31, v[144:147] offset:1024
  ds_write_b128 v31, v[148:151] offset:2048
  ds_write_b128 v31, v[152:155] offset:3072
  ds_write_b128 v31, v[156:159] offset:4096
  ds_write_b128 v31, v[160:163] offset:5120
  ds_write_b128 v31, v[164:167] offset:6144
  ds_write_b128 v31, v[168:171] offset:7168
  ds_write_b128 v31, v[172:175] offset:8192
  ds_write_b128 v31, v[176:179] offset:9216
  ds_write_b128 v31, v[180:183] offset:10240
  ds_write_b128 v31, v[184:187] offset:11264
  ds_write_b128 v31, v[188:191] offset:12288
  ds_write_b128 v31, v[192:195] offset:13312
  ds_write_b128 v31, v[196:199] offset:14336
  s_waitcnt lgkmcnt(0)
  s_barrier
  ds_read_b64_tr_b16 a[12:13], v200 offset:0
  ds_read_b64_tr_b16 a[14:15], v200 offset:5120
  ds_read_b64_tr_b16 a[36:37], v201 offset:0
  ds_read_b64_tr_b16 a[38:39], v201 offset:5120
  ds_read_b64_tr_b16 a[60:61], v202 offset:0
  ds_read_b64_tr_b16 a[62:63], v202 offset:5120
  ds_read_b64_tr_b16 a[84:85], v203 offset:0
  ds_read_b64_tr_b16 a[86:87], v203 offset:5120
  ds_read_b64_tr_b16 a[108:109], v204 offset:0
  ds_read_b64_tr_b16 a[110:111], v204 offset:5120
  ds_read_b64_tr_b16 a[132:133], v205 offset:0
  ds_read_b64_tr_b16 a[134:135], v205 offset:5120
  ds_read_b64_tr_b16 a[156:157], v206 offset:0
  ds_read_b64_tr_b16 a[158:159], v206 offset:5120
  ds_read_b64_tr_b16 a[180:181], v207 offset:0
  ds_read_b64_tr_b16 a[182:183], v207 offset:5120
  ds_read_b64_tr_b16 a[204:205], v208 offset:0
  ds_read_b64_tr_b16 a[206:207], v208 offset:5120
  ds_read_b64_tr_b16 a[228:229], v209 offset:0
  ds_read_b64_tr_b16 a[230:231], v209 offset:5120
  ds_read_b64_tr_b16 a[16:17], v200 offset:40960
  ds_read_b64_tr_b16 a[18:19], v200 offset:46080
  ds_read_b64_tr_b16 a[40:41], v201 offset:40960
  ds_read_b64_tr_b16 a[42:43], v201 offset:46080
  ds_read_b64_tr_b16 a[64:65], v202 offset:40960
  ds_read_b64_tr_b16 a[66:67], v202 offset:46080
  ds_read_b64_tr_b16 a[88:89], v203 offset:40960
  ds_read_b64_tr_b16 a[90:91], v203 offset:46080
  ds_read_b64_tr_b16 a[112:113], v204 offset:40960
  ds_read_b64_tr_b16 a[114:115], v204 offset:46080
  ds_read_b64_tr_b16 a[136:137], v205 offset:40960
  ds_read_b64_tr_b16 a[138:139], v205 offset:46080
  ds_read_b64_tr_b16 a[160:161], v206 offset:40960
  ds_read_b64_tr_b16 a[162:163], v206 offset:46080
  ds_read_b64_tr_b16 a[184:185], v207 offset:40960
  ds_read_b64_tr_b16 a[186:187], v207 offset:46080
  ds_read_b64_tr_b16 a[208:209], v208 offset:40960
  ds_read_b64_tr_b16 a[210:211], v208 offset:46080
  ds_read_b64_tr_b16 a[232:233], v209 offset:40960
  ds_read_b64_tr_b16 a[234:235], v209 offset:46080
  ds_read_b64_tr_b16 a[20:21], v210 offset:0
  ds_read_b64_tr_b16 a[22:23], v210 offset:5120
  ds_read_b64_tr_b16 a[44:45], v211 offset:0
  ds_read_b64_tr_b16 a[46:47], v211 offset:5120
  ds_read_b64_tr_b16 a[68:69], v212 offset:0
  ds_read_b64_tr_b16 a[70:71], v212 offset:5120
  ds_read_b64_tr_b16 a[92:93], v213 offset:0
  ds_read_b64_tr_b16 a[94:95], v213 offset:5120
  ds_read_b64_tr_b16 a[116:117], v214 offset:0
  ds_read_b64_tr_b16 a[118:119], v214 offset:5120
  ds_read_b64_tr_b16 a[140:141], v215 offset:0
  ds_read_b64_tr_b16 a[142:143], v215 offset:5120
  ds_read_b64_tr_b16 a[164:165], v216 offset:0
  ds_read_b64_tr_b16 a[166:167], v216 offset:5120
  ds_read_b64_tr_b16 a[188:189], v217 offset:0
  ds_read_b64_tr_b16 a[190:191], v217 offset:5120
  ds_read_b64_tr_b16 a[212:213], v218 offset:0
  ds_read_b64_tr_b16 a[214:215], v218 offset:5120
  ds_read_b64_tr_b16 a[236:237], v219 offset:0
  ds_read_b64_tr_b16 a[238:239], v219 offset:5120
  s_waitcnt lgkmcnt(0)
  s_barrier
  s_load_dwordx2 s[32:33], s[0:1], 96
  s_waitcnt lgkmcnt(0)
  s_mov_b32 s32, s32
  s_mov_b32 s33, s33
  s_mov_b32 s34, 256
  s_mov_b32 s35, 0x00020000
  s_mov_b32 s21, 76
  s_cmp_lg_u32 s20, 0
  s_cbranch_scc1 wf_156
  v_mov_b32 v4, 0
  s_mov_b32 s101, 0
wf_155:
  buffer_load_dword v5, v4, s[32:35], s21 offen sc1
  s_add_u32 s101, s101, 1
  s_cmp_gt_u32 s101, 131072
  s_cbranch_scc1 main_end
  s_waitcnt vmcnt(0)
  v_readfirstlane_b32 s100, v5
  s_cmp_ge_u32 s100, 32
  s_cbranch_scc1 wf_156
  s_sleep 8
  s_branch wf_155
wf_156:
  s_barrier
  s_mul_i32 s41, s2, 12288
  s_add_u32 s47, s41, 25165824
  s_mov_b32 s41, s47
  s_mul_i32 s21, s20, 10
  s_mul_i32 s47, s2, 5
  s_lshr_b32 s22, s21, 3
  s_add_u32 s47, s47, s22
  s_and_b32 s48, s21, 7
  s_mov_b32 s66, 0
  s_mov_b32 s67, 0
  s_lshr_b32 s43, s2, 2
  s_lshl_b32 s43, s43, 7
  s_add_u32 s43, s43, 0
  s_lshl_b32 s44, s2, 7
  s_lshl_b32 s21, s20, 2
  s_add_u32 s44, s44, s21
  s_add_u32 s44, s44, 96256
  s_mov_b32 s45, 0
  s_mov_b32 s49, 1
  s_mov_b32 s50, 0
  v_mov_b32 v10, 0
  v_mov_b32 v11, 1
  v_lshlrev_b32 v4, 4, v1
  s_add_u32 s76, s38, 56623104
  s_addc_u32 s77, s39, 0
  s_mov_b32 s78, 6291456
  s_mov_b32 s79, 0x00020000
  s_add_u32 s80, s38, 93323264
  s_addc_u32 s81, s39, 0
  s_mov_b32 s82, 20971520
  s_mov_b32 s83, 0x00020000
  v_and_b32 v12, 3, v1
  v_lshlrev_b32 v12, 3, v12
  v_add_u32 v12, 4, v12
  v_and_b32 v13, 7, v2
  v_lshlrev_b32 v13, 4, v13
  v_lshl_add_u32 v13, v3, 7, v13
  v_lshrrev_b32 v14, 3, v2
  v_mul_u32_u24 v14, 98304, v14
  v_add_u32 v14, v14, v13
  v_and_b32 v15, 1, v3
  v_lshlrev_b32 v15, 8, v15
  v_lshl_add_u32 v15, v2, 4, v15
  v_lshrrev_b32 v16, 1, v3
  v_mul_u32_u24 v16, 327680, v16
  v_add_u32 v15, v15, v16
  v_lshlrev_b32 v17, 10, v1
  v_mov_b32 v19, 0
  s_lshl_b32 s53, s2, 7
  s_add_u32 s53, s53, 20480
  s_mov_b32 s55, 0
  s_mov_b32 s56, 0
  s_mov_b32 s58, 0
  s_mov_b32 s59, 0
  s_add_u32 s84, s38, 50331648
  s_addc_u32 s85, s39, 0
  s_mov_b32 s86, 12582912
  s_mov_b32 s87, 0x00020000
  s_and_b32 s21, s2, 3
  s_mul_i32 s51, s2, 3072
  s_cmp_eq_u32 s21, s20
  s_cselect_b32 s51, s51, 6291456
  v_mov_b32 v244, -1
  v_mov_b32 v245, -1
  v_mov_b32 v246, -1
  v_mov_b32 v247, -1
  s_add_u32 s88, s38, 85983232
  s_addc_u32 s89, s39, 0
  s_mov_b32 s90, 5242880
  s_mov_b32 s91, 0x00020000
  s_mul_i32 s21, s20, 3072
  s_add_u32 s41, s41, s21
  s_mov_b32 s64, s21
  s_add_u32 s67, s21, 98304
  s_mov_b32 s71, s21
  s_mov_b32 s46, 0
  s_mov_b32 s47, 0
  s_mov_b32 s65, 0
  s_mul_i32 s42, s2, 40960
  s_mul_i32 s21, s20, 10240
  s_add_u32 s42, s42, s21
  s_mov_b32 s68, 0x80000000
  s_mov_b32 s70, 0
  s_mov_b32 s40, 0
  s_mov_b32 s30, 0
  s_mov_b32 s31, 0
  v_min_u32 v5, 19, v1
  v_lshlrev_b32 v5, 10, v5
  v_mov_b32 v9, 0
  s_lshl_b32 s21, s20, 2
  s_add_u32 s21, s21, 110592
  v_mov_b32 v6, s21
  v_mov_b32 v7, 110592
  s_mul_i32 s51, s2, 3072
  s_lshl_b32 s21, s20, 10
  s_add_u32 s51, s51, s21
  s_cmp_lt_u32 s20, 3
  s_cselect_b32 s51, s51, 6291456
  s_add_u32 s51, s51, 6094848
  s_cmp_lg_u32 s20, 0
  s_cbranch_scc1 wf_158
  v_mov_b32 v20, 0
  s_mov_b32 s101, 0
wf_157:
  buffer_load_dword v21, v20, s[72:75], s43 offen sc1
  s_add_u32 s101, s101, 1
  s_cmp_gt_u32 s101, 131072
  s_cbranch_scc1 main_end
  s_waitcnt vmcnt(0)
  v_readfirstlane_b32 s100, v21
  s_cmp_ge_u32 s100, 8
  s_cbranch_scc1 wf_158
  s_sleep 4
  s_branch wf_157
wf_158:
  s_barrier
  v_writelane_b32 v9, 8, 0
  v_cmp_gt_u32 vcc, 8, v9
  s_nop 0
  s_bitset1_b64 vcc, 20
  s_ff1_i32_b64 s21, vcc
  s_lshl_b32 s22, s21, 1
  s_lshl_b32 s21, s21, 2
  s_sub_i32 s21, s21, 16
  s_max_i32 s47, s21, s22
  s_cmp_gt_u32 s47, s45
  s_cbranch_scc1 va_159
  s_mov_b32 s101, 0
  s_branch va_162
va_160:
  s_sleep 8
va_162:
  buffer_load_dword v9, v5, s[72:75], s43 offen sc1
  s_add_u32 s101, s101, 1
  s_cmp_gt_u32 s101, 131072
  s_cbranch_scc1 main_end
  s_waitcnt vmcnt(0)
  v_cmp_gt_u32 vcc, 8, v9
  s_nop 0
  s_bitset1_b64 vcc, 20
  s_ff1_i32_b64 s21, vcc
  s_lshl_b32 s22, s21, 1
  s_lshl_b32 s21, s21, 2
  s_sub_i32 s21, s21, 16
  s_max_i32 s47, s21, s22
  s_cmp_gt_u32 s47, s45
  s_cbranch_scc0 va_160
va_159:
  s_add_u32 s22, s45, 6
  s_min_u32 s22, s22, s47
va_161:
  s_cmp_ge_u32 s46, s22
  s_cbranch_scc1 va_163
  s_mov_b32 m0, s64
  s_mov_b32 s66, s41
  buffer_load_dwordx4 v4, s[16:19], s66 offen offset:0 sc1 lds
  buffer_load_dwordx4 v4, s[16:19], s66 offen offset:1024 sc1 lds
  buffer_load_dwordx4 v4, s[16:19], s66 offen offset:2048 sc1 lds
  s_add_u32 s46, s46, 1
  s_add_u32 s41, s41, 393216
  s_add_u32 s64, s64, 12288
  s_cmp_lt_u32 s64, s67
  s_cselect_b32 s64, s64, s71
  s_branch va_161
va_163:
  s_mov_b32 s48, s46
  s_mov_b32 s49, s46
  s_mov_b32 s50, s46
  s_waitcnt vmcnt(0)
  s_barrier
  v_mov_b32 v8, v4
  s_add_u32 s65, s65, 12288
  s_cmp_lt_u32 s65, 98304
  s_cselect_b32 s65, s65, 0
  ds_read_b128 v[144:147], v8 offset:0
  ds_read_b128 v[148:151], v8 offset:1024
  ds_read_b128 v[152:155], v8 offset:2048
  ds_read_b128 v[156:159], v8 offset:3072
  ds_read_b128 v[160:163], v8 offset:4096
  ds_read_b128 v[164:167], v8 offset:5120
  ds_read_b128 v[168:171], v8 offset:6144
  ds_read_b128 v[172:175], v8 offset:7168
  ds_read_b128 v[176:179], v8 offset:8192
  ds_read_b128 v[180:183], v8 offset:9216
  ds_read_b128 v[184:187], v8 offset:10240
  ds_read_b128 v[188:191], v8 offset:11264
  s_add_u32 s21, s45, 1
  s_min_u32 s21, s21, 63
  s_cmp_lt_u32 s21, s50
  s_addc_u32 s21, s31, s31
  v_mov_b32 v21, s21
  ds_write_b32 v6, v21 offset:0
vwl_164:
  s_waitcnt lgkmcnt(0)
  s_barrier
  v_mfma_f32_16x16x32_bf16 v[64:67], v[144:147], a[0:3], 0
  v_add_u32 v8, s65, v4
  v_mfma_f32_16x16x32_bf16 v[72:75], v[144:147], a[24:27], 0
  ds_read_b128 v[240:243], v7 offset:0
  v_mfma_f32_16x16x32_bf16 v[80:83], v[144:147], a[48:51], 0
  ds_read_b128 v[192:195], v8 offset:0
  s_add_u32 s65, s65, 12288
  v_mfma_f32_16x16x32_bf16 v[88:91], v[144:147], a[72:75], 0
  v_cvt_pk_bf16_f32 v44, v104, v105
  v_mfma_f32_16x16x32_bf16 v[96:99], v[144:147], a[96:99], 0
  s_cmp_lt_u32 s65, 98304
  s_cselect_b32 s65, s65, 0
  v_mfma_f32_16x16x32_bf16 v[68:71], v[168:171], a[0:3], 0
  v_cvt_pk_bf16_f32 v45, v106, v107
  v_mfma_f32_16x16x32_bf16 v[76:79], v[168:171], a[24:27], 0
  v_cmp_gt_u32 vcc, 8, v9
  s_nop 0
  v_mfma_f32_16x16x32_bf16 v[84:87], v[168:171], a[48:51], 0
  v_cvt_pk_bf16_f32 v46, v108, v109
  s_bitset1_b64 vcc, 20
  v_mfma_f32_16x16x32_bf16 v[92:95], v[168:171], a[72:75], 0
  s_ff1_i32_b64 s21, vcc
  s_lshl_b32 s22, s21, 1
  v_mfma_f32_16x16x32_bf16 v[100:103], v[168:171], a[96:99], 0
  ds_read_b128 v[196:199], v8 offset:1024
  v_cvt_pk_bf16_f32 v47, v110, v111
  v_mfma_f32_16x16x32_bf16 v[64:67], v[148:151], a[4:7], v[64:67]
  s_lshl_b32 s21, s21, 2
  s_sub_i32 s21, s21, 16
  v_mfma_f32_16x16x32_bf16 v[72:75], v[148:151], a[28:31], v[72:75]
  s_add_u32 s69, s68, 4096
  s_max_i32 s47, s21, s22
  v_mfma_f32_16x16x32_bf16 v[80:83], v[148:151], a[52:55], v[80:83]
  s_add_u32 s22, s45, 7
  s_min_u32 s22, s22, s47
  v_mfma_f32_16x16x32_bf16 v[88:91], v[148:151], a[76:79], v[88:91]
  buffer_store_dwordx4 v[44:47], v4, s[24:27], s69 offen offset:1024 sc1
  v_mfma_f32_16x16x32_bf16 v[96:99], v[148:151], a[100:103], v[96:99]
  s_cmp_lt_u32 s46, s22
  s_cselect_b32 s66, s41, 0x80000000
  s_cselect_b32 m0, s64, 98304
  s_cselect_b32 s22, 1, 0
  v_mfma_f32_16x16x32_bf16 v[68:71], v[172:175], a[4:7], v[68:71]
  v_cvt_pk_bf16_f32 v48, v112, v113
  v_mfma_f32_16x16x32_bf16 v[76:79], v[172:175], a[28:31], v[76:79]
  ds_read_b128 v[200:203], v8 offset:2048
  v_mfma_f32_16x16x32_bf16 v[84:87], v[172:175], a[52:55], v[84:87]
  v_cvt_pk_bf16_f32 v49, v114, v115
  v_mfma_f32_16x16x32_bf16 v[92:95], v[172:175], a[76:79], v[92:95]
  buffer_load_dword v9, v5, s[72:75], s43 offen sc1
  v_mfma_f32_16x16x32_bf16 v[100:103], v[172:175], a[100:103], v[100:103]
  v_cvt_pk_bf16_f32 v50, v116, v117
  v_mfma_f32_16x16x32_bf16 v[64:67], v[152:155], a[8:11], v[64:67]
  v_mfma_f32_16x16x32_bf16 v[72:75], v[152:155], a[32:35], v[72:75]
  v_cvt_pk_bf16_f32 v51, v118, v119
  v_mfma_f32_16x16x32_bf16 v[80:83], v[152:155], a[56:59], v[80:83]
  buffer_load_dwordx4 v4, s[16:19], s66 offen offset:0 sc1 lds
  v_mfma_f32_16x16x32_bf16 v[88:91], v[152:155], a[80:83], v[88:91]
  ds_read_b128 v[204:207], v8 offset:3072
  v_mfma_f32_16x16x32_bf16 v[96:99], v[152:155], a[104:107], v[96:99]
  buffer_store_dwordx4 v[48:51], v4, s[24:27], s69 offen offset:2048 sc1
  v_mfma_f32_16x16x32_bf16 v[68:71], v[176:179], a[8:11], v[68:71]
  v_cvt_pk_bf16_f32 v52, v120, v121
  v_mfma_f32_16x16x32_bf16 v[76:79], v[176:179], a[32:35], v[76:79]
  v_mfma_f32_16x16x32_bf16 v[84:87], v[176:179], a[56:59], v[84:87]
  v_cvt_pk_bf16_f32 v53, v122, v123
  v_mfma_f32_16x16x32_bf16 v[92:95], v[176:179], a[80:83], v[92:95]
  buffer_load_dwordx4 v4, s[16:19], s66 offen offset:1024 sc1 lds
  v_mfma_f32_16x16x32_bf16 v[100:103], v[176:179], a[104:107], v[100:103]
  v_cvt_pk_bf16_f32 v54, v124, v125
  v_mfma_f32_16x16x32_bf16 v[64:67], v[156:159], a[12:15], v[64:67]
  ds_read_b128 v[208:211], v8 offset:4096
  v_mfma_f32_16x16x32_bf16 v[72:75], v[156:159], a[36:39], v[72:75]
  v_cvt_pk_bf16_f32 v55, v126, v127
  v_mfma_f32_16x16x32_bf16 v[80:83], v[156:159], a[60:63], v[80:83]
  v_mfma_f32_16x16x32_bf16 v[88:91], v[156:159], a[84:87], v[88:91]
  buffer_store_dwordx4 v[52:55], v4, s[24:27], s69 offen offset:3072 sc1
  v_mfma_f32_16x16x32_bf16 v[96:99], v[156:159], a[108:111], v[96:99]
  buffer_load_dwordx4 v4, s[16:19], s66 offen offset:2048 sc1 lds
  v_mfma_f32_16x16x32_bf16 v[68:71], v[180:183], a[12:15], v[68:71]
  v_cvt_pk_bf16_f32 v56, v128, v129
  s_add_u32 s46, s46, s22
  v_mfma_f32_16x16x32_bf16 v[76:79], v[180:183], a[36:39], v[76:79]
  s_mul_i32 s21, s22, 393216
  s_add_u32 s41, s41, s21
  v_mfma_f32_16x16x32_bf16 v[84:87], v[180:183], a[60:63], v[84:87]
  ds_read_b128 v[212:215], v8 offset:5120
  v_cvt_pk_bf16_f32 v57, v130, v131
  v_mfma_f32_16x16x32_bf16 v[92:95], v[180:183], a[84:87], v[92:95]
  s_mul_i32 s21, s22, 12288
  s_add_u32 s64, s64, s21
  v_mfma_f32_16x16x32_bf16 v[100:103], v[180:183], a[108:111], v[100:103]
  v_cvt_pk_bf16_f32 v58, v132, v133
  v_mfma_f32_16x16x32_bf16 v[64:67], v[160:163], a[16:19], v[64:67]
  s_cmp_lt_u32 s64, s67
  s_cselect_b32 s64, s64, s71
  v_mfma_f32_16x16x32_bf16 v[72:75], v[160:163], a[40:43], v[72:75]
  v_cvt_pk_bf16_f32 v59, v134, v135
  v_mfma_f32_16x16x32_bf16 v[80:83], v[160:163], a[64:67], v[80:83]
  v_mfma_f32_16x16x32_bf16 v[88:91], v[160:163], a[88:91], v[88:91]
  s_add_u32 s69, s68, 8192
  v_mfma_f32_16x16x32_bf16 v[96:99], v[160:163], a[112:115], v[96:99]
  ds_read_b128 v[216:219], v8 offset:6144
  v_mfma_f32_16x16x32_bf16 v[68:71], v[184:187], a[16:19], v[68:71]
  buffer_store_dwordx4 v[56:59], v4, s[24:27], s69 offen offset:0 sc1
  v_mfma_f32_16x16x32_bf16 v[76:79], v[184:187], a[40:43], v[76:79]
  v_mfma_f32_16x16x32_bf16 v[84:87], v[184:187], a[64:67], v[84:87]
  v_cvt_pk_bf16_f32 v60, v136, v137
  v_mfma_f32_16x16x32_bf16 v[92:95], v[184:187], a[88:91], v[92:95]
  v_readlane_b32 s31, v19, 0
  v_readlane_b32 s21, v19, 1
  v_mfma_f32_16x16x32_bf16 v[100:103], v[184:187], a[112:115], v[100:103]
  v_cvt_pk_bf16_f32 v61, v138, v139
  v_readlane_b32 s22, v19, 2
  v_mfma_f32_16x16x32_bf16 v[64:67], v[164:167], a[20:23], v[64:67]
  s_min_u32 s31, s31, s21
  v_readlane_b32 s21, v19, 3
  v_mfma_f32_16x16x32_bf16 v[72:75], v[164:167], a[44:47], v[72:75]
  ds_read_b128 v[220:223], v8 offset:7168
  v_cvt_pk_bf16_f32 v62, v140, v141
  v_mfma_f32_16x16x32_bf16 v[80:83], v[164:167], a[68:71], v[80:83]
  s_min_u32 s31, s31, s22
  s_min_u32 s31, s31, s21
  v_mfma_f32_16x16x32_bf16 v[88:91], v[164:167], a[92:95], v[88:91]
  v_cvt_pk_bf16_f32 v63, v142, v143
  s_min_u32 s31, s31, 64
  v_mfma_f32_16x16x32_bf16 v[96:99], v[164:167], a[116:119], v[96:99]
  v_mfma_f32_16x16x32_bf16 v[68:71], v[188:191], a[20:23], v[68:71]
  buffer_store_dwordx4 v[60:63], v4, s[24:27], s69 offen offset:1024 sc1
  v_mfma_f32_16x16x32_bf16 v[76:79], v[188:191], a[44:47], v[76:79]
  v_mfma_f32_16x16x32_bf16 v[84:87], v[188:191], a[68:71], v[84:87]
  v_mfma_f32_16x16x32_bf16 v[92:95], v[188:191], a[92:95], v[92:95]
  ds_read_b128 v[224:227], v8 offset:8192
  v_mfma_f32_16x16x32_bf16 v[100:103], v[188:191], a[116:119], v[100:103]
  v_mfma_f32_16x16x32_bf16 v[104:107], v[144:147], a[120:123], 0
  v_mfma_f32_16x16x32_bf16 v[112:115], v[144:147], a[144:147], 0
  v_mfma_f32_16x16x32_bf16 v[120:123], v[144:147], a[168:171], 0
  v_mfma_f32_16x16x32_bf16 v[128:131], v[144:147], a[192:195], 0
  v_cvt_pk_bf16_f32 v24, v64, v65
  v_mfma_f32_16x16x32_bf16 v[136:139], v[144:147], a[216:219], 0
  v_mfma_f32_16x16x32_bf16 v[108:111], v[168:171], a[120:123], 0
  ds_read_b128 v[228:231], v8 offset:9216
  v_cvt_pk_bf16_f32 v25, v66, v67
  v_mfma_f32_16x16x32_bf16 v[116:119], v[168:171], a[144:147], 0
  s_cmp_lt_u32 s51, 6291456
  s_cselect_b32 s52, s51, 0x80000000
  v_mfma_f32_16x16x32_bf16 v[124:127], v[168:171], a[168:171], 0
  v_cvt_pk_bf16_f32 v26, v68, v69
  v_mfma_f32_16x16x32_bf16 v[132:135], v[168:171], a[192:195], 0
  buffer_store_dwordx4 v[244:247], v4, s[84:87], s52 offen sc1
  v_mfma_f32_16x16x32_bf16 v[140:143], v[168:171], a[216:219], 0
  v_cvt_pk_bf16_f32 v27, v70, v71
  s_add_u32 s51, s51, 98304
  v_mfma_f32_16x16x32_bf16 v[104:107], v[148:151], a[124:127], v[104:107]
  v_mfma_f32_16x16x32_bf16 v[112:115], v[148:151], a[148:151], v[112:115]
  buffer_store_dwordx4 v[24:27], v4, s[24:27], s42 offen offset:0 sc1
  v_mfma_f32_16x16x32_bf16 v[120:123], v[148:151], a[172:175], v[120:123]
  ds_read_b128 v[232:235], v8 offset:10240
  v_mfma_f32_16x16x32_bf16 v[128:131], v[148:151], a[196:199], v[128:131]
  v_cvt_pk_bf16_f32 v28, v72, v73
  v_mfma_f32_16x16x32_bf16 v[136:139], v[148:151], a[220:223], v[136:139]
  v_cvt_pk_bf16_f32 v29, v74, v75
  v_mfma_f32_16x16x32_bf16 v[108:111], v[172:175], a[124:127], v[108:111]
  s_cmp_lg_u32 s40, 0
  s_cbranch_scc1 vwm_166
vwm_167:
  v_mfma_f32_16x16x32_bf16 v[116:119], v[172:175], a[148:151], v[116:119]
  v_cvt_pk_bf16_f32 v30, v76, v77
  v_mfma_f32_16x16x32_bf16 v[124:127], v[172:175], a[172:175], v[124:127]
  v_mfma_f32_16x16x32_bf16 v[132:135], v[172:175], a[196:199], v[132:135]
  v_cvt_pk_bf16_f32 v31, v78, v79
  v_mfma_f32_16x16x32_bf16 v[140:143], v[172:175], a[220:223], v[140:143]
  ds_read_b128 v[236:239], v8 offset:11264
  v_mfma_f32_16x16x32_bf16 v[104:107], v[152:155], a[128:131], v[104:107]
  buffer_store_dwordx4 v[28:31], v4, s[24:27], s42 offen offset:1024 sc1
  v_mfma_f32_16x16x32_bf16 v[112:115], v[152:155], a[152:155], v[112:115]
  v_mfma_f32_16x16x32_bf16 v[120:123], v[152:155], a[176:179], v[120:123]
  v_cvt_pk_bf16_f32 v32, v80, v81
  v_mfma_f32_16x16x32_bf16 v[128:131], v[152:155], a[200:203], v[128:131]
  v_mfma_f32_16x16x32_bf16 v[136:139], v[152:155], a[224:227], v[136:139]
  v_cvt_pk_bf16_f32 v33, v82, v83
  v_mfma_f32_16x16x32_bf16 v[108:111], v[176:179], a[128:131], v[108:111]
  v_cvt_pk_bf16_f32 v34, v84, v85
  v_mfma_f32_16x16x32_bf16 v[116:119], v[176:179], a[152:155], v[116:119]
  v_mfma_f32_16x16x32_bf16 v[124:127], v[176:179], a[176:179], v[124:127]
  v_cvt_pk_bf16_f32 v35, v86, v87
  v_mfma_f32_16x16x32_bf16 v[132:135], v[176:179], a[200:203], v[132:135]
  s_waitcnt lgkmcnt(0)
  v_min3_u32 v22, v240, v241, v242
  v_mfma_f32_16x16x32_bf16 v[140:143], v[176:179], a[224:227], v[140:143]
  buffer_store_dwordx4 v[32:35], v4, s[24:27], s42 offen offset:2048 sc1
  v_mfma_f32_16x16x32_bf16 v[104:107], v[156:159], a[132:135], v[104:107]
  v_bitop3_b32 v240, v240, v241, v242 bitop3:0x80
  v_min_u32 v22, v22, v243
  v_mfma_f32_16x16x32_bf16 v[112:115], v[156:159], a[156:159], v[112:115]
  v_cvt_pk_bf16_f32 v36, v88, v89
  v_and_b32 v240, v240, v243
  v_mfma_f32_16x16x32_bf16 v[120:123], v[156:159], a[180:183], v[120:123]
  v_readfirstlane_b32 s56, v22
  v_readfirstlane_b32 s23, v240
  v_mfma_f32_16x16x32_bf16 v[128:131], v[156:159], a[204:207], v[128:131]
  v_cvt_pk_bf16_f32 v37, v90, v91
  s_lshr_b32 s56, s56, 1
  v_mfma_f32_16x16x32_bf16 v[136:139], v[156:159], a[228:231], v[136:139]
  s_and_b32 s23, s23, 1
  s_add_u32 s21, s56, 99
  v_mfma_f32_16x16x32_bf16 v[108:111], v[180:183], a[132:135], v[108:111]
  v_cvt_pk_bf16_f32 v38, v92, v93
  v_mfma_f32_16x16x32_bf16 v[116:119], v[180:183], a[156:159], v[116:119]
  v_cvt_pk_bf16_f32 v39, v94, v95
  v_mfma_f32_16x16x32_bf16 v[124:127], v[180:183], a[180:183], v[124:127]
  s_cmp_le_u32 s21, s45
  s_cselect_b32 s21, s56, 0
  v_mfma_f32_16x16x32_bf16 v[132:135], v[180:183], a[204:207], v[132:135]
  buffer_store_dwordx4 v[36:39], v4, s[24:27], s42 offen offset:3072 sc1
  v_mfma_f32_16x16x32_bf16 v[140:143], v[180:183], a[228:231], v[140:143]
  s_add_u32 s22, s55, s30
  s_add_u32 s22, s22, 2
  v_mfma_f32_16x16x32_bf16 v[104:107], v[160:163], a[136:139], v[104:107]
  v_cvt_pk_bf16_f32 v40, v96, v97
  v_mfma_f32_16x16x32_bf16 v[112:115], v[160:163], a[160:163], v[112:115]
  s_cmp_le_u32 s22, s21
  s_cselect_b32 s29, 4, 0
  v_mfma_f32_16x16x32_bf16 v[120:123], v[160:163], a[184:187], v[120:123]
  v_cvt_pk_bf16_f32 v41, v98, v99
  s_or_b32 s28, s29, s30
  v_mfma_f32_16x16x32_bf16 v[128:131], v[160:163], a[208:211], v[128:131]
  s_or_b32 s28, s28, s58
  v_mfma_f32_16x16x32_bf16 v[136:139], v[160:163], a[232:235], v[136:139]
  v_cvt_pk_bf16_f32 v42, v100, v101
  v_mfma_f32_16x16x32_bf16 v[108:111], v[184:187], a[136:139], v[108:111]
  v_mfma_f32_16x16x32_bf16 v[116:119], v[184:187], a[160:163], v[116:119]
  v_cvt_pk_bf16_f32 v43, v102, v103
  v_mfma_f32_16x16x32_bf16 v[124:127], v[184:187], a[184:187], v[124:127]
  s_add_u32 s69, s42, 4096
  v_mfma_f32_16x16x32_bf16 v[132:135], v[184:187], a[208:211], v[132:135]
  v_mfma_f32_16x16x32_bf16 v[140:143], v[184:187], a[232:235], v[140:143]
  buffer_store_dwordx4 v[40:43], v4, s[24:27], s69 offen offset:0 sc1
  v_mfma_f32_16x16x32_bf16 v[104:107], v[164:167], a[140:143], v[104:107]
  v_mfma_f32_16x16x32_bf16 v[112:115], v[164:167], a[164:167], v[112:115]
  v_mfma_f32_16x16x32_bf16 v[120:123], v[164:167], a[188:191], v[120:123]
  s_waitcnt vmcnt(15)
  s_mov_b32 s50, s48
  s_mov_b32 s49, s48
  v_mfma_f32_16x16x32_bf16 v[128:131], v[164:167], a[212:215], v[128:131]
  s_mov_b32 s48, s46
  s_sub_i32 s69, s45, 1
  s_max_i32 s69, s69, s70
  v_mfma_f32_16x16x32_bf16 v[136:139], v[164:167], a[236:239], v[136:139]
  s_add_u32 s45, s45, 1
  s_mov_b32 s68, s42
  s_add_u32 s42, s42, 1310720
  v_mfma_f32_16x16x32_bf16 v[108:111], v[188:191], a[140:143], v[108:111]
  s_add_u32 s21, s45, 1
  s_min_u32 s21, s21, 63
  v_mfma_f32_16x16x32_bf16 v[116:119], v[188:191], a[164:167], v[116:119]
  s_cmp_lt_u32 s21, s50
  s_addc_u32 s21, s31, s31
  v_mov_b32 v21, s21
  v_mfma_f32_16x16x32_bf16 v[124:127], v[188:191], a[188:191], v[124:127]
  ds_write_b32 v6, v21 offset:16
  v_mfma_f32_16x16x32_bf16 v[132:135], v[188:191], a[212:215], v[132:135]
  v_mfma_f32_16x16x32_bf16 v[140:143], v[188:191], a[236:239], v[140:143]
  s_mov_b64 exec, 1
  v_mov_b32 v20, s69
  buffer_store_dword v20, v10, s[72:75], s44 offen sc1
  s_mov_b64 exec, -1
  s_cmp_le_u32 s45, 8
  s_cbranch_scc1 vwe_170
vwe_171:
  s_cmp_eq_u32 s23, 0
  s_cbranch_scc1 vws_168
vwb_169:
  s_waitcnt lgkmcnt(0)
  s_barrier
  v_mfma_f32_16x16x32_bf16 v[64:67], v[192:195], a[0:3], 0
  v_add_u32 v8, s65, v4
  v_mfma_f32_16x16x32_bf16 v[72:75], v[192:195], a[24:27], 0
  ds_read_b128 v[240:243], v7 offset:16
  v_mfma_f32_16x16x32_bf16 v[80:83], v[192:195], a[48:51], 0
  ds_read_b128 v[144:147], v8 offset:0
  s_add_u32 s65, s65, 12288
  v_mfma_f32_16x16x32_bf16 v[88:91], v[192:195], a[72:75], 0
  v_cvt_pk_bf16_f32 v44, v104, v105
  v_mfma_f32_16x16x32_bf16 v[96:99], v[192:195], a[96:99], 0
  s_cmp_lt_u32 s65, 98304
  s_cselect_b32 s65, s65, 0
  v_mfma_f32_16x16x32_bf16 v[68:71], v[216:219], a[0:3], 0
  v_cvt_pk_bf16_f32 v45, v106, v107
  v_mfma_f32_16x16x32_bf16 v[76:79], v[216:219], a[24:27], 0
  v_cmp_gt_u32 vcc, 8, v9
  s_nop 0
  v_mfma_f32_16x16x32_bf16 v[84:87], v[216:219], a[48:51], 0
  v_cvt_pk_bf16_f32 v46, v108, v109
  s_bitset1_b64 vcc, 20
  v_mfma_f32_16x16x32_bf16 v[92:95], v[216:219], a[72:75], 0
  s_ff1_i32_b64 s21, vcc
  s_lshl_b32 s22, s21, 1
  v_mfma_f32_16x16x32_bf16 v[100:103], v[216:219], a[96:99], 0
  ds_read_b128 v[148:151], v8 offset:1024
  v_cvt_pk_bf16_f32 v47, v110, v111
  v_mfma_f32_16x16x32_bf16 v[64:67], v[196:199], a[4:7], v[64:67]
  s_lshl_b32 s21, s21, 2
  s_sub_i32 s21, s21, 16
  v_mfma_f32_16x16x32_bf16 v[72:75], v[196:199], a[28:31], v[72:75]
  s_add_u32 s69, s68, 4096
  s_max_i32 s47, s21, s22
  v_mfma_f32_16x16x32_bf16 v[80:83], v[196:199], a[52:55], v[80:83]
  s_add_u32 s22, s45, 7
  s_min_u32 s22, s22, s47
  v_mfma_f32_16x16x32_bf16 v[88:91], v[196:199], a[76:79], v[88:91]
  buffer_store_dwordx4 v[44:47], v4, s[24:27], s69 offen offset:1024 sc1
  v_mfma_f32_16x16x32_bf16 v[96:99], v[196:199], a[100:103], v[96:99]
  s_cmp_lt_u32 s46, s22
  s_cselect_b32 s66, s41, 0x80000000
  s_cselect_b32 m0, s64, 98304
  s_cselect_b32 s22, 1, 0
  v_mfma_f32_16x16x32_bf16 v[68:71], v[220:223], a[4:7], v[68:71]
  v_cvt_pk_bf16_f32 v48, v112, v113
  v_mfma_f32_16x16x32_bf16 v[76:79], v[220:223], a[28:31], v[76:79]
  ds_read_b128 v[152:155], v8 offset:2048
  v_mfma_f32_16x16x32_bf16 v[84:87], v[220:223], a[52:55], v[84:87]
  v_cvt_pk_bf16_f32 v49, v114, v115
  v_mfma_f32_16x16x32_bf16 v[92:95], v[220:223], a[76:79], v[92:95]
  buffer_load_dword v9, v5, s[72:75], s43 offen sc1
  v_mfma_f32_16x16x32_bf16 v[100:103], v[220:223], a[100:103], v[100:103]
  v_cvt_pk_bf16_f32 v50, v116, v117
  v_mfma_f32_16x16x32_bf16 v[64:67], v[200:203], a[8:11], v[64:67]
  v_mfma_f32_16x16x32_bf16 v[72:75], v[200:203], a[32:35], v[72:75]
  v_cvt_pk_bf16_f32 v51, v118, v119
  v_mfma_f32_16x16x32_bf16 v[80:83], v[200:203], a[56:59], v[80:83]
  buffer_load_dwordx4 v4, s[16:19], s66 offen offset:0 sc1 lds
  v_mfma_f32_16x16x32_bf16 v[88:91], v[200:203], a[80:83], v[88:91]
  ds_read_b128 v[156:159], v8 offset:3072
  v_mfma_f32_16x16x32_bf16 v[96:99], v[200:203], a[104:107], v[96:99]
  buffer_store_dwordx4 v[48:51], v4, s[24:27], s69 offen offset:2048 sc1
  v_mfma_f32_16x16x32_bf16 v[68:71], v[224:227], a[8:11], v[68:71]
  v_cvt_pk_bf16_f32 v52, v120, v121
  v_mfma_f32_16x16x32_bf16 v[76:79], v[224:227], a[32:35], v[76:79]
  v_mfma_f32_16x16x32_bf16 v[84:87], v[224:227], a[56:59], v[84:87]
  v_cvt_pk_bf16_f32 v53, v122, v123
  v_mfma_f32_16x16x32_bf16 v[92:95], v[224:227], a[80:83], v[92:95]
  buffer_load_dwordx4 v4, s[16:19], s66 offen offset:1024 sc1 lds
  v_mfma_f32_16x16x32_bf16 v[100:103], v[224:227], a[104:107], v[100:103]
  v_cvt_pk_bf16_f32 v54, v124, v125
  v_mfma_f32_16x16x32_bf16 v[64:67], v[204:207], a[12:15], v[64:67]
  ds_read_b128 v[160:163], v8 offset:4096
  v_mfma_f32_16x16x32_bf16 v[72:75], v[204:207], a[36:39], v[72:75]
  v_cvt_pk_bf16_f32 v55, v126, v127
  v_mfma_f32_16x16x32_bf16 v[80:83], v[204:207], a[60:63], v[80:83]
  v_mfma_f32_16x16x32_bf16 v[88:91], v[204:207], a[84:87], v[88:91]
  buffer_store_dwordx4 v[52:55], v4, s[24:27], s69 offen offset:3072 sc1
  v_mfma_f32_16x16x32_bf16 v[96:99], v[204:207], a[108:111], v[96:99]
  buffer_load_dwordx4 v4, s[16:19], s66 offen offset:2048 sc1 lds
  v_mfma_f32_16x16x32_bf16 v[68:71], v[228:231], a[12:15], v[68:71]
  v_cvt_pk_bf16_f32 v56, v128, v129
  s_add_u32 s46, s46, s22
  v_mfma_f32_16x16x32_bf16 v[76:79], v[228:231], a[36:39], v[76:79]
  s_mul_i32 s21, s22, 393216
  s_add_u32 s41, s41, s21
  v_mfma_f32_16x16x32_bf16 v[84:87], v[228:231], a[60:63], v[84:87]
  ds_read_b128 v[164:167], v8 offset:5120
  v_cvt_pk_bf16_f32 v57, v130, v131
  v_mfma_f32_16x16x32_bf16 v[92:95], v[228:231], a[84:87], v[92:95]
  s_mul_i32 s21, s22, 12288
  s_add_u32 s64, s64, s21
  v_mfma_f32_16x16x32_bf16 v[100:103], v[228:231], a[108:111], v[100:103]
  v_cvt_pk_bf16_f32 v58, v132, v133
  v_mfma_f32_16x16x32_bf16 v[64:67], v[208:211], a[16:19], v[64:67]
  s_cmp_lt_u32 s64, s67
  s_cselect_b32 s64, s64, s71
  v_mfma_f32_16x16x32_bf16 v[72:75], v[208:211], a[40:43], v[72:75]
  v_cvt_pk_bf16_f32 v59, v134, v135
  v_mfma_f32_16x16x32_bf16 v[80:83], v[208:211], a[64:67], v[80:83]
  v_mfma_f32_16x16x32_bf16 v[88:91], v[208:211], a[88:91], v[88:91]
  s_add_u32 s69, s68, 8192
  v_mfma_f32_16x16x32_bf16 v[96:99], v[208:211], a[112:115], v[96:99]
  ds_read_b128 v[168:171], v8 offset:6144
  v_mfma_f32_16x16x32_bf16 v[68:71], v[232:235], a[16:19], v[68:71]
  buffer_store_dwordx4 v[56:59], v4, s[24:27], s69 offen offset:0 sc1
  v_mfma_f32_16x16x32_bf16 v[76:79], v[232:235], a[40:43], v[76:79]
  v_mfma_f32_16x16x32_bf16 v[84:87], v[232:235], a[64:67], v[84:87]
  v_cvt_pk_bf16_f32 v60, v136, v137
  v_mfma_f32_16x16x32_bf16 v[92:95], v[232:235], a[88:91], v[92:95]
  v_readlane_b32 s31, v19, 0
  v_readlane_b32 s21, v19, 1
  v_mfma_f32_16x16x32_bf16 v[100:103], v[232:235], a[112:115], v[100:103]
  v_cvt_pk_bf16_f32 v61, v138, v139
  v_readlane_b32 s22, v19, 2
  v_mfma_f32_16x16x32_bf16 v[64:67], v[212:215], a[20:23], v[64:67]
  s_min_u32 s31, s31, s21
  v_readlane_b32 s21, v19, 3
  v_mfma_f32_16x16x32_bf16 v[72:75], v[212:215], a[44:47], v[72:75]
  ds_read_b128 v[172:175], v8 offset:7168
  v_cvt_pk_bf16_f32 v62, v140, v141
  v_mfma_f32_16x16x32_bf16 v[80:83], v[212:215], a[68:71], v[80:83]
  s_min_u32 s31, s31, s22
  s_min_u32 s31, s31, s21
  v_mfma_f32_16x16x32_bf16 v[88:91], v[212:215], a[92:95], v[88:91]
  v_cvt_pk_bf16_f32 v63, v142, v143
  s_min_u32 s31, s31, 64
  v_mfma_f32_16x16x32_bf16 v[96:99], v[212:215], a[116:119], v[96:99]
  v_mfma_f32_16x16x32_bf16 v[68:71], v[236:239], a[20:23], v[68:71]
  buffer_store_dwordx4 v[60:63], v4, s[24:27], s69 offen offset:1024 sc1
  v_mfma_f32_16x16x32_bf16 v[76:79], v[236:239], a[44:47], v[76:79]
  v_mfma_f32_16x16x32_bf16 v[84:87], v[236:239], a[68:71], v[84:87]
  v_mfma_f32_16x16x32_bf16 v[92:95], v[236:239], a[92:95], v[92:95]
  ds_read_b128 v[176:179], v8 offset:8192
  v_mfma_f32_16x16x32_bf16 v[100:103], v[236:239], a[116:119], v[100:103]
  v_mfma_f32_16x16x32_bf16 v[104:107], v[192:195], a[120:123], 0
  v_mfma_f32_16x16x32_bf16 v[112:115], v[192:195], a[144:147], 0
  v_mfma_f32_16x16x32_bf16 v[120:123], v[192:195], a[168:171], 0
  v_mfma_f32_16x16x32_bf16 v[128:131], v[192:195], a[192:195], 0
  v_cvt_pk_bf16_f32 v24, v64, v65
  v_mfma_f32_16x16x32_bf16 v[136:139], v[192:195], a[216:219], 0
  v_mfma_f32_16x16x32_bf16 v[108:111], v[216:219], a[120:123], 0
  ds_read_b128 v[180:183], v8 offset:9216
  v_cvt_pk_bf16_f32 v25, v66, v67
  v_mfma_f32_16x16x32_bf16 v[116:119], v[216:219], a[144:147], 0
  s_cmp_lt_u32 s51, 6291456
  s_cselect_b32 s52, s51, 0x80000000
  v_mfma_f32_16x16x32_bf16 v[124:127], v[216:219], a[168:171], 0
  v_cvt_pk_bf16_f32 v26, v68, v69
  v_mfma_f32_16x16x32_bf16 v[132:135], v[216:219], a[192:195], 0
  buffer_store_dwordx4 v[244:247], v4, s[84:87], s52 offen sc1
  v_mfma_f32_16x16x32_bf16 v[140:143], v[216:219], a[216:219], 0
  v_cvt_pk_bf16_f32 v27, v70, v71
  s_add_u32 s51, s51, 98304
  v_mfma_f32_16x16x32_bf16 v[104:107], v[196:199], a[124:127], v[104:107]
  v_mfma_f32_16x16x32_bf16 v[112:115], v[196:199], a[148:151], v[112:115]
  buffer_store_dwordx4 v[24:27], v4, s[24:27], s42 offen offset:0 sc1
  v_mfma_f32_16x16x32_bf16 v[120:123], v[196:199], a[172:175], v[120:123]
  ds_read_b128 v[184:187], v8 offset:10240
  v_mfma_f32_16x16x32_bf16 v[128:131], v[196:199], a[196:199], v[128:131]
  v_cvt_pk_bf16_f32 v28, v72, v73
  v_mfma_f32_16x16x32_bf16 v[136:139], v[196:199], a[220:223], v[136:139]
  v_cvt_pk_bf16_f32 v29, v74, v75
  v_mfma_f32_16x16x32_bf16 v[108:111], v[220:223], a[124:127], v[108:111]
  s_cmp_lg_u32 s40, 0
  s_cbranch_scc1 vwm_174
vwm_175:
  v_mfma_f32_16x16x32_bf16 v[116:119], v[220:223], a[148:151], v[116:119]
  v_cvt_pk_bf16_f32 v30, v76, v77
  v_mfma_f32_16x16x32_bf16 v[124:127], v[220:223], a[172:175], v[124:127]
  v_mfma_f32_16x16x32_bf16 v[132:135], v[220:223], a[196:199], v[132:135]
  v_cvt_pk_bf16_f32 v31, v78, v79
  v_mfma_f32_16x16x32_bf16 v[140:143], v[220:223], a[220:223], v[140:143]
  ds_read_b128 v[188:191], v8 offset:11264
  v_mfma_f32_16x16x32_bf16 v[104:107], v[200:203], a[128:131], v[104:107]
  buffer_store_dwordx4 v[28:31], v4, s[24:27], s42 offen offset:1024 sc1
  v_mfma_f32_16x16x32_bf16 v[112:115], v[200:203], a[152:155], v[112:115]
  v_mfma_f32_16x16x32_bf16 v[120:123], v[200:203], a[176:179], v[120:123]
  v_cvt_pk_bf16_f32 v32, v80, v81
  v_mfma_f32_16x16x32_bf16 v[128:131], v[200:203], a[200:203], v[128:131]
  v_mfma_f32_16x16x32_bf16 v[136:139], v[200:203], a[224:227], v[136:139]
  v_cvt_pk_bf16_f32 v33, v82, v83
  v_mfma_f32_16x16x32_bf16 v[108:111], v[224:227], a[128:131], v[108:111]
  v_cvt_pk_bf16_f32 v34, v84, v85
  v_mfma_f32_16x16x32_bf16 v[116:119], v[224:227], a[152:155], v[116:119]
  v_mfma_f32_16x16x32_bf16 v[124:127], v[224:227], a[176:179], v[124:127]
  v_cvt_pk_bf16_f32 v35, v86, v87
  v_mfma_f32_16x16x32_bf16 v[132:135], v[224:227], a[200:203], v[132:135]
  s_waitcnt lgkmcnt(0)
  v_min3_u32 v22, v240, v241, v242
  v_mfma_f32_16x16x32_bf16 v[140:143], v[224:227], a[224:227], v[140:143]
  buffer_store_dwordx4 v[32:35], v4, s[24:27], s42 offen offset:2048 sc1
  v_mfma_f32_16x16x32_bf16 v[104:107], v[204:207], a[132:135], v[104:107]
  v_bitop3_b32 v240, v240, v241, v242 bitop3:0x80
  v_min_u32 v22, v22, v243
  v_mfma_f32_16x16x32_bf16 v[112:115], v[204:207], a[156:159], v[112:115]
  v_cvt_pk_bf16_f32 v36, v88, v89
  v_and_b32 v240, v240, v243
  v_mfma_f32_16x16x32_bf16 v[120:123], v[204:207], a[180:183], v[120:123]
  v_readfirstlane_b32 s56, v22
  v_readfirstlane_b32 s23, v240
  v_mfma_f32_16x16x32_bf16 v[128:131], v[204:207], a[204:207], v[128:131]
  v_cvt_pk_bf16_f32 v37, v90, v91
  s_lshr_b32 s56, s56, 1
  v_mfma_f32_16x16x32_bf16 v[136:139], v[204:207], a[228:231], v[136:139]
  s_and_b32 s23, s23, 1
  s_add_u32 s21, s56, 99
  v_mfma_f32_16x16x32_bf16 v[108:111], v[228:231], a[132:135], v[108:111]
  v_cvt_pk_bf16_f32 v38, v92, v93
  v_mfma_f32_16x16x32_bf16 v[116:119], v[228:231], a[156:159], v[116:119]
  v_cvt_pk_bf16_f32 v39, v94, v95
  v_mfma_f32_16x16x32_bf16 v[124:127], v[228:231], a[180:183], v[124:127]
  s_cmp_le_u32 s21, s45
  s_cselect_b32 s21, s56, 0
  v_mfma_f32_16x16x32_bf16 v[132:135], v[228:231], a[204:207], v[132:135]
  buffer_store_dwordx4 v[36:39], v4, s[24:27], s42 offen offset:3072 sc1
  v_mfma_f32_16x16x32_bf16 v[140:143], v[228:231], a[228:231], v[140:143]
  s_add_u32 s22, s55, s30
  s_add_u32 s22, s22, 2
  v_mfma_f32_16x16x32_bf16 v[104:107], v[208:211], a[136:139], v[104:107]
  v_cvt_pk_bf16_f32 v40, v96, v97
  v_mfma_f32_16x16x32_bf16 v[112:115], v[208:211], a[160:163], v[112:115]
  s_cmp_le_u32 s22, s21
  s_cselect_b32 s29, 4, 0
  v_mfma_f32_16x16x32_bf16 v[120:123], v[208:211], a[184:187], v[120:123]
  v_cvt_pk_bf16_f32 v41, v98, v99
  s_or_b32 s28, s29, s30
  v_mfma_f32_16x16x32_bf16 v[128:131], v[208:211], a[208:211], v[128:131]
  s_or_b32 s28, s28, s58
  v_mfma_f32_16x16x32_bf16 v[136:139], v[208:211], a[232:235], v[136:139]
  v_cvt_pk_bf16_f32 v42, v100, v101
  v_mfma_f32_16x16x32_bf16 v[108:111], v[232:235], a[136:139], v[108:111]
  v_mfma_f32_16x16x32_bf16 v[116:119], v[232:235], a[160:163], v[116:119]
  v_cvt_pk_bf16_f32 v43, v102, v103
  v_mfma_f32_16x16x32_bf16 v[124:127], v[232:235], a[184:187], v[124:127]
  s_add_u32 s69, s42, 4096
  v_mfma_f32_16x16x32_bf16 v[132:135], v[232:235], a[208:211], v[132:135]
  v_mfma_f32_16x16x32_bf16 v[140:143], v[232:235], a[232:235], v[140:143]
  buffer_store_dwordx4 v[40:43], v4, s[24:27], s69 offen offset:0 sc1
  v_mfma_f32_16x16x32_bf16 v[104:107], v[212:215], a[140:143], v[104:107]
  v_mfma_f32_16x16x32_bf16 v[112:115], v[212:215], a[164:167], v[112:115]
  v_mfma_f32_16x16x32_bf16 v[120:123], v[212:215], a[188:191], v[120:123]
  s_waitcnt vmcnt(15)
  s_mov_b32 s50, s48
  s_mov_b32 s49, s48
  v_mfma_f32_16x16x32_bf16 v[128:131], v[212:215], a[212:215], v[128:131]
  s_mov_b32 s48, s46
  s_sub_i32 s69, s45, 1
  s_max_i32 s69, s69, s70
  v_mfma_f32_16x16x32_bf16 v[136:139], v[212:215], a[236:239], v[136:139]
  s_add_u32 s45, s45, 1
  s_mov_b32 s68, s42
  s_add_u32 s42, s42, 1310720
  v_mfma_f32_16x16x32_bf16 v[108:111], v[236:239], a[140:143], v[108:111]
  s_add_u32 s21, s45, 1
  s_min_u32 s21, s21, 63
  v_mfma_f32_16x16x32_bf16 v[116:119], v[236:239], a[164:167], v[116:119]
  s_cmp_lt_u32 s21, s50
  s_addc_u32 s21, s31, s31
  v_mov_b32 v21, s21
  v_mfma_f32_16x16x32_bf16 v[124:127], v[236:239], a[188:191], v[124:127]
  ds_write_b32 v6, v21 offset:0
  v_mfma_f32_16x16x32_bf16 v[132:135], v[236:239], a[212:215], v[132:135]
  v_mfma_f32_16x16x32_bf16 v[140:143], v[236:239], a[236:239], v[140:143]
  s_mov_b64 exec, 1
  v_mov_b32 v20, s69
  buffer_store_dword v20, v10, s[72:75], s44 offen sc1
  s_mov_b64 exec, -1
  s_cmp_le_u32 s45, 8
  s_cbranch_scc1 vwe_178
vwe_179:
  s_cmp_lg_u32 s45, 24
  s_cbranch_scc1 arm_182
  s_mul_i32 s21, s2, 10240
  s_mul_i32 s22, s20, 2560
  s_add_u32 s21, s21, s22
  s_add_u32 s21, s21, 18350080
  buffer_store_dwordx4 v[244:247], v15, s[80:83], s21 offen offset:0 sc1
  buffer_store_dwordx4 v[244:247], v15, s[80:83], s21 offen offset:512 sc1
  buffer_store_dwordx4 v[244:247], v15, s[80:83], s21 offen offset:1024 sc1
  buffer_store_dwordx4 v[244:247], v15, s[80:83], s21 offen offset:1536 sc1
  buffer_store_dwordx4 v[244:247], v15, s[80:83], s21 offen offset:2048 sc1
  s_add_u32 s21, s21, 655360
  buffer_store_dwordx4 v[244:247], v15, s[80:83], s21 offen offset:0 sc1
  buffer_store_dwordx4 v[244:247], v15, s[80:83], s21 offen offset:512 sc1
  buffer_store_dwordx4 v[244:247], v15, s[80:83], s21 offen offset:1024 sc1
  buffer_store_dwordx4 v[244:247], v15, s[80:83], s21 offen offset:1536 sc1
  buffer_store_dwordx4 v[244:247], v15, s[80:83], s21 offen offset:2048 sc1
  s_add_u32 s21, s21, 655360
  buffer_store_dwordx4 v[244:247], v15, s[80:83], s21 offen offset:0 sc1
  buffer_store_dwordx4 v[244:247], v15, s[80:83], s21 offen offset:512 sc1
  buffer_store_dwordx4 v[244:247], v15, s[80:83], s21 offen offset:1024 sc1
  buffer_store_dwordx4 v[244:247], v15, s[80:83], s21 offen offset:1536 sc1
  buffer_store_dwordx4 v[244:247], v15, s[80:83], s21 offen offset:2048 sc1
  s_add_u32 s21, s21, 655360
  buffer_store_dwordx4 v[244:247], v15, s[80:83], s21 offen offset:0 sc1
  buffer_store_dwordx4 v[244:247], v15, s[80:83], s21 offen offset:512 sc1
  buffer_store_dwordx4 v[244:247], v15, s[80:83], s21 offen offset:1024 sc1
  buffer_store_dwordx4 v[244:247], v15, s[80:83], s21 offen offset:1536 sc1
  buffer_store_dwordx4 v[244:247], v15, s[80:83], s21 offen offset:2048 sc1
  s_add_u32 s21, s21, 655360
  s_and_b32 s21, s2, 3
  s_cmp_lg_u32 s21, s20
  s_cbranch_scc1 arm_182
  s_mul_i32 s21, s2, 2560
  s_add_u32 s21, s21, 4587520
  v_lshlrev_b32 v21, 3, v1
  buffer_store_dwordx4 v[244:247], v4, s[88:91], s21 offen sc1
  buffer_store_dwordx4 v[244:247], v4, s[88:91], s21 offen offset:1024 sc1
  buffer_store_dwordx2 v[244:245], v21, s[88:91], s21 offen offset:2048 sc1
  s_add_u32 s21, s21, 81920
  buffer_store_dwordx4 v[244:247], v4, s[88:91], s21 offen sc1
  buffer_store_dwordx4 v[244:247], v4, s[88:91], s21 offen offset:1024 sc1
  buffer_store_dwordx2 v[244:245], v21, s[88:91], s21 offen offset:2048 sc1
  s_add_u32 s21, s21, 81920
  buffer_store_dwordx4 v[244:247], v4, s[88:91], s21 offen sc1
  buffer_store_dwordx4 v[244:247], v4, s[88:91], s21 offen offset:1024 sc1
  buffer_store_dwordx2 v[244:245], v21, s[88:91], s21 offen offset:2048 sc1
  s_add_u32 s21, s21, 81920
  buffer_store_dwordx4 v[244:247], v4, s[88:91], s21 offen sc1
  buffer_store_dwordx4 v[244:247], v4, s[88:91], s21 offen offset:1024 sc1
  buffer_store_dwordx2 v[244:245], v21, s[88:91], s21 offen offset:2048 sc1
  s_add_u32 s21, s21, 81920
  buffer_store_dwordx4 v[244:247], v4, s[88:91], s21 offen sc1
  buffer_store_dwordx4 v[244:247], v4, s[88:91], s21 offen offset:1024 sc1
  buffer_store_dwordx2 v[244:245], v21, s[88:91], s21 offen offset:2048 sc1
  s_add_u32 s21, s21, 81920
  buffer_store_dwordx4 v[244:247], v4, s[88:91], s21 offen sc1
  buffer_store_dwordx4 v[244:247], v4, s[88:91], s21 offen offset:1024 sc1
  buffer_store_dwordx2 v[244:245], v21, s[88:91], s21 offen offset:2048 sc1
  s_add_u32 s21, s21, 81920
  buffer_store_dwordx4 v[244:247], v4, s[88:91], s21 offen sc1
  buffer_store_dwordx4 v[244:247], v4, s[88:91], s21 offen offset:1024 sc1
  buffer_store_dwordx2 v[244:245], v21, s[88:91], s21 offen offset:2048 sc1
  s_add_u32 s21, s21, 81920
  buffer_store_dwordx4 v[244:247], v4, s[88:91], s21 offen sc1
  buffer_store_dwordx4 v[244:247], v4, s[88:91], s21 offen offset:1024 sc1
  buffer_store_dwordx2 v[244:245], v21, s[88:91], s21 offen offset:2048 sc1
  s_add_u32 s21, s21, 81920
arm_182:
  s_cmp_ge_u32 s45, 64
  s_cbranch_scc1 vwd_165
  s_cmp_lg_u32 s23, 0
  s_cbranch_scc1 vwl_164
  s_branch vws_176
vws_168:
  v_cmp_gt_u32 vcc, 8, v9
  s_nop 0
  s_bitset1_b64 vcc, 20
  s_ff1_i32_b64 s21, vcc
  s_lshl_b32 s22, s21, 1
  s_lshl_b32 s21, s21, 2
  s_sub_i32 s21, s21, 16
  s_max_i32 s47, s21, s22
  s_cmp_gt_u32 s47, s45
  s_cbranch_scc1 va_184
  s_cmp_eq_u32 s70, s45
  s_cbranch_scc1 va_189
  s_nop 4
  v_cvt_pk_bf16_f32 v44, v104, v105
  v_cvt_pk_bf16_f32 v45, v106, v107
  v_cvt_pk_bf16_f32 v46, v108, v109
  v_cvt_pk_bf16_f32 v47, v110, v111
  s_add_u32 s69, s68, 4096
  buffer_store_dwordx4 v[44:47], v4, s[24:27], s69 offen offset:1024 sc1
  v_cvt_pk_bf16_f32 v48, v112, v113
  v_cvt_pk_bf16_f32 v49, v114, v115
  v_cvt_pk_bf16_f32 v50, v116, v117
  v_cvt_pk_bf16_f32 v51, v118, v119
  buffer_store_dwordx4 v[48:51], v4, s[24:27], s69 offen offset:2048 sc1
  v_cvt_pk_bf16_f32 v52, v120, v121
  v_cvt_pk_bf16_f32 v53, v122, v123
  v_cvt_pk_bf16_f32 v54, v124, v125
  v_cvt_pk_bf16_f32 v55, v126, v127
  buffer_store_dwordx4 v[52:55], v4, s[24:27], s69 offen offset:3072 sc1
  v_cvt_pk_bf16_f32 v56, v128, v129
  v_cvt_pk_bf16_f32 v57, v130, v131
  v_cvt_pk_bf16_f32 v58, v132, v133
  v_cvt_pk_bf16_f32 v59, v134, v135
  s_add_u32 s69, s68, 8192
  buffer_store_dwordx4 v[56:59], v4, s[24:27], s69 offen offset:0 sc1
  v_cvt_pk_bf16_f32 v60, v136, v137
  v_cvt_pk_bf16_f32 v61, v138, v139
  v_cvt_pk_bf16_f32 v62, v140, v141
  v_cvt_pk_bf16_f32 v63, v142, v143
  buffer_store_dwordx4 v[60:63], v4, s[24:27], s69 offen offset:1024 sc1
  s_mov_b32 s68, 0x80000000
  s_waitcnt vmcnt(0)
  s_mov_b64 exec, 1
  v_mov_b32 v20, s45
  buffer_store_dword v20, v10, s[72:75], s44 offen sc1
  s_mov_b64 exec, -1
  s_mov_b32 s70, s45
  s_mov_b32 s40, 0
va_189:
  s_mov_b32 s101, 0
  s_branch va_187
va_185:
  s_sleep 8
va_187:
  buffer_load_dword v9, v5, s[72:75], s43 offen sc1
  s_add_u32 s101, s101, 1
  s_cmp_gt_u32 s101, 131072
  s_cbranch_scc1 main_end
  s_waitcnt vmcnt(0)
  v_cmp_gt_u32 vcc, 8, v9
  s_nop 0
  s_bitset1_b64 vcc, 20
  s_ff1_i32_b64 s21, vcc
  s_lshl_b32 s22, s21, 1
  s_lshl_b32 s21, s21, 2
  s_sub_i32 s21, s21, 16
  s_max_i32 s47, s21, s22
  s_cmp_gt_u32 s47, s45
  s_cbranch_scc0 va_185
va_184:
  s_add_u32 s22, s45, 6
  s_min_u32 s22, s22, s47
va_186:
  s_cmp_ge_u32 s46, s22
  s_cbranch_scc1 va_188
  s_mov_b32 m0, s64
  s_mov_b32 s66, s41
  buffer_load_dwordx4 v4, s[16:19], s66 offen offset:0 sc1 lds
  buffer_load_dwordx4 v4, s[16:19], s66 offen offset:1024 sc1 lds
  buffer_load_dwordx4 v4, s[16:19], s66 offen offset:2048 sc1 lds
  s_add_u32 s46, s46, 1
  s_add_u32 s41, s41, 393216
  s_add_u32 s64, s64, 12288
  s_cmp_lt_u32 s64, s67
  s_cselect_b32 s64, s64, s71
  s_branch va_186
va_188:
  s_mov_b32 s48, s46
  s_mov_b32 s49, s46
  s_mov_b32 s50, s46
  s_waitcnt vmcnt(0)
  s_barrier
  ds_read_b128 v[192:195], v8 offset:0
  ds_read_b128 v[196:199], v8 offset:1024
  ds_read_b128 v[200:203], v8 offset:2048
  ds_read_b128 v[204:207], v8 offset:3072
  ds_read_b128 v[208:211], v8 offset:4096
  ds_read_b128 v[212:215], v8 offset:5120
  ds_read_b128 v[216:219], v8 offset:6144
  ds_read_b128 v[220:223], v8 offset:7168
  ds_read_b128 v[224:227], v8 offset:8192
  ds_read_b128 v[228:231], v8 offset:9216
  ds_read_b128 v[232:235], v8 offset:10240
  ds_read_b128 v[236:239], v8 offset:11264
  s_add_u32 s21, s45, 1
  s_min_u32 s21, s21, 63
  s_cmp_lt_u32 s21, s50
  s_addc_u32 s21, s31, s31
  v_mov_b32 v21, s21
  ds_write_b32 v6, v21 offset:16
  s_branch vwb_169
vws_176:
  v_cmp_gt_u32 vcc, 8, v9
  s_nop 0
  s_bitset1_b64 vcc, 20
  s_ff1_i32_b64 s21, vcc
  s_lshl_b32 s22, s21, 1
  s_lshl_b32 s21, s21, 2
  s_sub_i32 s21, s21, 16
  s_max_i32 s47, s21, s22
  s_cmp_gt_u32 s47, s45
  s_cbranch_scc1 va_190
  s_cmp_eq_u32 s70, s45
  s_cbranch_scc1 va_195
  s_nop 4
  v_cvt_pk_bf16_f32 v44, v104, v105
  v_cvt_pk_bf16_f32 v45, v106, v107
  v_cvt_pk_bf16_f32 v46, v108, v109
  v_cvt_pk_bf16_f32 v47, v110, v111
  s_add_u32 s69, s68, 4096
  buffer_store_dwordx4 v[44:47], v4, s[24:27], s69 offen offset:1024 sc1
  v_cvt_pk_bf16_f32 v48, v112, v113
  v_cvt_pk_bf16_f32 v49, v114, v115
  v_cvt_pk_bf16_f32 v50, v116, v117
  v_cvt_pk_bf16_f32 v51, v118, v119
  buffer_store_dwordx4 v[48:51], v4, s[24:27], s69 offen offset:2048 sc1
  v_cvt_pk_bf16_f32 v52, v120, v121
  v_cvt_pk_bf16_f32 v53, v122, v123
  v_cvt_pk_bf16_f32 v54, v124, v125
  v_cvt_pk_bf16_f32 v55, v126, v127
  buffer_store_dwordx4 v[52:55], v4, s[24:27], s69 offen offset:3072 sc1
  v_cvt_pk_bf16_f32 v56, v128, v129
  v_cvt_pk_bf16_f32 v57, v130, v131
  v_cvt_pk_bf16_f32 v58, v132, v133
  v_cvt_pk_bf16_f32 v59, v134, v135
  s_add_u32 s69, s68, 8192
  buffer_store_dwordx4 v[56:59], v4, s[24:27], s69 offen offset:0 sc1
  v_cvt_pk_bf16_f32 v60, v136, v137
  v_cvt_pk_bf16_f32 v61, v138, v139
  v_cvt_pk_bf16_f32 v62, v140, v141
  v_cvt_pk_bf16_f32 v63, v142, v143
  buffer_store_dwordx4 v[60:63], v4, s[24:27], s69 offen offset:1024 sc1
  s_mov_b32 s68, 0x80000000
  s_waitcnt vmcnt(0)
  s_mov_b64 exec, 1
  v_mov_b32 v20, s45
  buffer_store_dword v20, v10, s[72:75], s44 offen sc1
  s_mov_b64 exec, -1
  s_mov_b32 s70, s45
  s_mov_b32 s40, 0
va_195:
  s_mov_b32 s101, 0
  s_branch va_193
va_191:
  s_sleep 8
va_193:
  buffer_load_dword v9, v5, s[72:75], s43 offen sc1
  s_add_u32 s101, s101, 1
  s_cmp_gt_u32 s101, 131072
  s_cbranch_scc1 main_end
  s_waitcnt vmcnt(0)
  v_cmp_gt_u32 vcc, 8, v9
  s_nop 0
  s_bitset1_b64 vcc, 20
  s_ff1_i32_b64 s21, vcc
  s_lshl_b32 s22, s21, 1
  s_lshl_b32 s21, s21, 2
  s_sub_i32 s21, s21, 16
  s_max_i32 s47, s21, s22
  s_cmp_gt_u32 s47, s45
  s_cbranch_scc0 va_191
va_190:
  s_add_u32 s22, s45, 6
  s_min_u32 s22, s22, s47
va_192:
  s_cmp_ge_u32 s46, s22
  s_cbranch_scc1 va_194
  s_mov_b32 m0, s64
  s_mov_b32 s66, s41
  buffer_load_dwordx4 v4, s[16:19], s66 offen offset:0 sc1 lds
  buffer_load_dwordx4 v4, s[16:19], s66 offen offset:1024 sc1 lds
  buffer_load_dwordx4 v4, s[16:19], s66 offen offset:2048 sc1 lds
  s_add_u32 s46, s46, 1
  s_add_u32 s41, s41, 393216
  s_add_u32 s64, s64, 12288
  s_cmp_lt_u32 s64, s67
  s_cselect_b32 s64, s64, s71
  s_branch va_192
va_194:
  s_mov_b32 s48, s46
  s_mov_b32 s49, s46
  s_mov_b32 s50, s46
  s_waitcnt vmcnt(0)
  s_barrier
  ds_read_b128 v[144:147], v8 offset:0
  ds_read_b128 v[148:151], v8 offset:1024
  ds_read_b128 v[152:155], v8 offset:2048
  ds_read_b128 v[156:159], v8 offset:3072
  ds_read_b128 v[160:163], v8 offset:4096
  ds_read_b128 v[164:167], v8 offset:5120
  ds_read_b128 v[168:171], v8 offset:6144
  ds_read_b128 v[172:175], v8 offset:7168
  ds_read_b128 v[176:179], v8 offset:8192
  ds_read_b128 v[180:183], v8 offset:9216
  ds_read_b128 v[184:187], v8 offset:10240
  ds_read_b128 v[188:191], v8 offset:11264
  s_add_u32 s21, s45, 1
  s_min_u32 s21, s21, 63
  s_cmp_lt_u32 s21, s50
  s_addc_u32 s21, s31, s31
  v_mov_b32 v21, s21
  ds_write_b32 v6, v21 offset:0
  s_branch vwl_164
vwe_170:
  s_nop 4
  v_cvt_pk_bf16_f32 v44, v104, v105
  v_cvt_pk_bf16_f32 v45, v106, v107
  v_cvt_pk_bf16_f32 v46, v108, v109
  v_cvt_pk_bf16_f32 v47, v110, v111
  s_add_u32 s69, s68, 4096
  buffer_store_dwordx4 v[44:47], v4, s[24:27], s69 offen offset:1024 sc1
  v_cvt_pk_bf16_f32 v48, v112, v113
  v_cvt_pk_bf16_f32 v49, v114, v115
  v_cvt_pk_bf16_f32 v50, v116, v117
  v_cvt_pk_bf16_f32 v51, v118, v119
  buffer_store_dwordx4 v[48:51], v4, s[24:27], s69 offen offset:2048 sc1
  v_cvt_pk_bf16_f32 v52, v120, v121
  v_cvt_pk_bf16_f32 v53, v122, v123
  v_cvt_pk_bf16_f32 v54, v124, v125
  v_cvt_pk_bf16_f32 v55, v126, v127
  buffer_store_dwordx4 v[52:55], v4, s[24:27], s69 offen offset:3072 sc1
  v_cvt_pk_bf16_f32 v56, v128, v129
  v_cvt_pk_bf16_f32 v57, v130, v131
  v_cvt_pk_bf16_f32 v58, v132, v133
  v_cvt_pk_bf16_f32 v59, v134, v135
  s_add_u32 s69, s68, 8192
  buffer_store_dwordx4 v[56:59], v4, s[24:27], s69 offen offset:0 sc1
  v_cvt_pk_bf16_f32 v60, v136, v137
  v_cvt_pk_bf16_f32 v61, v138, v139
  v_cvt_pk_bf16_f32 v62, v140, v141
  v_cvt_pk_bf16_f32 v63, v142, v143
  buffer_store_dwordx4 v[60:63], v4, s[24:27], s69 offen offset:1024 sc1
  s_mov_b32 s68, 0x80000000
  s_mov_b32 s40, 1
  s_branch vwe_171
vwe_178:
  s_nop 4
  v_cvt_pk_bf16_f32 v44, v104, v105
  v_cvt_pk_bf16_f32 v45, v106, v107
  v_cvt_pk_bf16_f32 v46, v108, v109
  v_cvt_pk_bf16_f32 v47, v110, v111
  s_add_u32 s69, s68, 4096
  buffer_store_dwordx4 v[44:47], v4, s[24:27], s69 offen offset:1024 sc1
  v_cvt_pk_bf16_f32 v48, v112, v113
  v_cvt_pk_bf16_f32 v49, v114, v115
  v_cvt_pk_bf16_f32 v50, v116, v117
  v_cvt_pk_bf16_f32 v51, v118, v119
  buffer_store_dwordx4 v[48:51], v4, s[24:27], s69 offen offset:2048 sc1
  v_cvt_pk_bf16_f32 v52, v120, v121
  v_cvt_pk_bf16_f32 v53, v122, v123
  v_cvt_pk_bf16_f32 v54, v124, v125
  v_cvt_pk_bf16_f32 v55, v126, v127
  buffer_store_dwordx4 v[52:55], v4, s[24:27], s69 offen offset:3072 sc1
  v_cvt_pk_bf16_f32 v56, v128, v129
  v_cvt_pk_bf16_f32 v57, v130, v131
  v_cvt_pk_bf16_f32 v58, v132, v133
  v_cvt_pk_bf16_f32 v59, v134, v135
  s_add_u32 s69, s68, 8192
  buffer_store_dwordx4 v[56:59], v4, s[24:27], s69 offen offset:0 sc1
  v_cvt_pk_bf16_f32 v60, v136, v137
  v_cvt_pk_bf16_f32 v61, v138, v139
  v_cvt_pk_bf16_f32 v62, v140, v141
  v_cvt_pk_bf16_f32 v63, v142, v143
  buffer_store_dwordx4 v[60:63], v4, s[24:27], s69 offen offset:1024 sc1
  s_mov_b32 s68, 0x80000000
  s_mov_b32 s40, 1
  s_branch vwe_179
vwm_166:
  s_mov_b32 s40, 0
  s_waitcnt vmcnt(11)
  s_mov_b64 exec, 1
  v_mov_b32 v20, s45
  buffer_store_dword v20, v10, s[72:75], s44 offen sc1
  s_mov_b64 exec, -1
  s_mov_b32 s70, s45
  s_branch vwm_167
vwm_174:
  s_mov_b32 s40, 0
  s_waitcnt vmcnt(11)
  s_mov_b64 exec, 1
  v_mov_b32 v20, s45
  buffer_store_dword v20, v10, s[72:75], s44 offen sc1
  s_mov_b64 exec, -1
  s_mov_b32 s70, s45
  s_branch vwm_175
vwd_165:
  s_nop 4
  v_cvt_pk_bf16_f32 v44, v104, v105
  v_cvt_pk_bf16_f32 v45, v106, v107
  v_cvt_pk_bf16_f32 v46, v108, v109
  v_cvt_pk_bf16_f32 v47, v110, v111
  s_add_u32 s69, s68, 4096
  buffer_store_dwordx4 v[44:47], v4, s[24:27], s69 offen offset:1024 sc1
  v_cvt_pk_bf16_f32 v48, v112, v113
  v_cvt_pk_bf16_f32 v49, v114, v115
  v_cvt_pk_bf16_f32 v50, v116, v117
  v_cvt_pk_bf16_f32 v51, v118, v119
  buffer_store_dwordx4 v[48:51], v4, s[24:27], s69 offen offset:2048 sc1
  v_cvt_pk_bf16_f32 v52, v120, v121
  v_cvt_pk_bf16_f32 v53, v122, v123
  v_cvt_pk_bf16_f32 v54, v124, v125
  v_cvt_pk_bf16_f32 v55, v126, v127
  buffer_store_dwordx4 v[52:55], v4, s[24:27], s69 offen offset:3072 sc1
  v_cvt_pk_bf16_f32 v56, v128, v129
  v_cvt_pk_bf16_f32 v57, v130, v131
  v_cvt_pk_bf16_f32 v58, v132, v133
  v_cvt_pk_bf16_f32 v59, v134, v135
  s_add_u32 s69, s68, 8192
  buffer_store_dwordx4 v[56:59], v4, s[24:27], s69 offen offset:0 sc1
  v_cvt_pk_bf16_f32 v60, v136, v137
  v_cvt_pk_bf16_f32 v61, v138, v139
  v_cvt_pk_bf16_f32 v62, v140, v141
  v_cvt_pk_bf16_f32 v63, v142, v143
  buffer_store_dwordx4 v[60:63], v4, s[24:27], s69 offen offset:1024 sc1
  s_waitcnt vmcnt(0)
  s_mov_b64 exec, 1
  v_mov_b32 v20, s45
  buffer_store_dword v20, v10, s[72:75], s44 offen sc1
  s_mov_b64 exec, -1
  s_mov_b32 s84, 0
  s_mov_b32 s85, -1
  s_add_u32 s87, s3, 294
  s_sub_u32 s21, s3, 32
  s_waitcnt vmcnt(0) lgkmcnt(0)
  s_barrier
  s_branch do_opb2
  s_mov_b32 s84, 0
  s_mov_b32 s85, -1
  s_mov_b32 s86, 0
  s_branch queue
not_vw:
  s_sub_u32 s2, s3, 96
  s_cmp_lg_u32 s2, 31
  s_cbranch_scc1 not_cal
  s_add_u32 s8, s38, 83886079
  s_addc_u32 s9, s39, 0
  s_and_b32 s8, s8, 0xffe00000
  s_mov_b32 s10, 2097152
  s_mov_b32 s11, 0x00020000
  v_lshrrev_b32 v9, 4, v0
  v_mul_u32_u24 v9, 16640, v9
  v_bfe_u32 v10, v0, 3, 1
  v_lshl_add_u32 v9, v10, 13, v9
  v_and_b32 v10, 7, v0
  v_lshl_add_u32 v9, v10, 4, v9
  s_mov_b32 s21, 1048576
  buffer_store_dwordx4 v[4:7], v9, s[8:11], s21 offen sc1
  s_waitcnt vmcnt(0)
  s_barrier
  s_cmp_lg_u32 s20, 3
  s_cbranch_scc1 cal_196
  s_mov_b64 exec, 1
  v_mov_b32 v4, 0
  s_mov_b32 s40, -1
  s_mov_b32 s41, -1
  s_mov_b32 s42, 1048576
  s_mov_b32 s43, 0
  s_waitcnt vmcnt(0)
cal_197:
  s_add_u32 s21, s42, 0
  s_memtime s[98:99]
  s_waitcnt lgkmcnt(0)
  buffer_load_dword v5, v4, s[8:11], s21 offen sc1
  s_waitcnt vmcnt(0)
  s_memtime s[100:101]
  s_waitcnt lgkmcnt(0)
  s_sub_u32 s21, s100, s98
  s_min_u32 s40, s40, s21
  s_add_u32 s21, s42, 8192
  s_memtime s[98:99]
  s_waitcnt lgkmcnt(0)
  buffer_load_dword v5, v4, s[8:11], s21 offen sc1
  s_waitcnt vmcnt(0)
  s_memtime s[100:101]
  s_waitcnt lgkmcnt(0)
  s_sub_u32 s21, s100, s98
  s_min_u32 s41, s41, s21
  s_add_u32 s42, s42, 16640
  s_add_u32 s43, s43, 1
  s_cmp_lt_u32 s43, 4
  s_cbranch_scc1 cal_197
  s_cmp_lt_u32 s41, s40
  s_cselect_b32 s21, 1, 2
  v_mov_b32 v4, s21
  v_mov_b32 v5, s40
  v_mov_b32 v6, s41
  v_mov_b32 v8, 84
  buffer_store_dwordx3 v[4:6], v8, s[32:35], 0 offen sc1
  s_waitcnt vmcnt(0)
  s_mov_b64 exec, -1
cal_196:
  s_barrier
  s_branch armed
not_cal:
  s_sleep 32
  s_sleep 32
  s_sleep 32
  s_sleep 32
  s_sleep 32
  s_sleep 32
armed:
  s_load_dwordx2 s[72:73], s[0:1], 104
  s_waitcnt lgkmcnt(0)
  s_add_u32 s72, s72, 81068032
  s_addc_u32 s73, s73, 0
  s_mov_b32 s74, 117760
  s_mov_b32 s75, 0x00020000
  s_load_dwordx2 s[4:5], s[0:1], 0
  s_load_dwordx2 s[6:7], s[0:1], 64
  s_load_dwordx2 s[38:39], s[0:1], 104
  s_lshr_b32 s41, s2, 1
  s_and_b32 s42, s2, 1
  s_waitcnt lgkmcnt(0)
  s_mov_b32 s8, s4
  s_mov_b32 s9, s5
  s_mov_b32 s10, 2621440
  s_mov_b32 s11, 0x00020000
  s_mov_b32 s12, s6
  s_mov_b32 s13, s7
  s_mov_b32 s14, 2457600
  s_mov_b32 s15, 0x00020000
  s_add_u32 s16, s38, 70713344
  s_addc_u32 s17, s39, 0
  s_mov_b32 s18, 2641920
  s_mov_b32 s19, 0x00020000
  s_add_u32 s72, s38, 81068032
  s_addc_u32 s73, s39, 0
  s_mov_b32 s74, 117760
  s_mov_b32 s75, 0x00020000
  v_lshlrev_b32 v6, 1, v3
  v_add_u32 v6, 0, v6
  v_xor_b32 v6, v6, v2
  v_min_u32 v6, 14, v6
  v_mul_u32_u24 v7, 52, v6
  v_lshrrev_b32 v7, 8, v7
  v_mul_u32_u24 v7, 1200, v7
  v_lshl_add_u32 v7, v6, 4, v7
  v_mul_u32_u24 v6, 3840, v3
  v_add_u32 v4, v6, v7
  v_lshlrev_b32 v6, 1, v3
  v_add_u32 v6, 8, v6
  v_xor_b32 v6, v6, v2
  v_min_u32 v6, 14, v6
  v_mul_u32_u24 v7, 52, v6
  v_lshrrev_b32 v7, 8, v7
  v_mul_u32_u24 v7, 1200, v7
  v_lshl_add_u32 v7, v6, 4, v7
  v_mul_u32_u24 v6, 3840, v3
  v_add_u32 v5, v6, v7
  s_mul_i32 s21, s41, 80
  s_mul_i32 s22, s20, 15360
  s_add_u32 s21, s21, s22
  s_lshl_b32 s22, s20, 10
  s_cmp_ge_u32 s20, 2
  s_cselect_b64 vcc, -1, 0
  v_cndmask_b32 v4, v4, v5, vcc
  s_add_u32 m0, s22, 0
  s_nop 0
  buffer_load_dwordx4 v4, s[12:15], s21 offen lds
  s_add_u32 s21, s21, 61440
  s_add_u32 m0, s22, 4096
  s_nop 0
  buffer_load_dwordx4 v4, s[12:15], s21 offen lds
  s_add_u32 s21, s21, 61440
  s_add_u32 m0, s22, 8192
  s_nop 0
  buffer_load_dwordx4 v4, s[12:15], s21 offen lds
  s_add_u32 s21, s21, 61440
  s_add_u32 m0, s22, 12288
  s_nop 0
  buffer_load_dwordx4 v4, s[12:15], s21 offen lds
  s_add_u32 s21, s21, 61440
  s_add_u32 m0, s22, 16384
  s_nop 0
  buffer_load_dwordx4 v4, s[12:15], s21 offen lds
  s_add_u32 s21, s21, 61440
  s_add_u32 m0, s22, 20480
  s_nop 0
  buffer_load_dwordx4 v4, s[12:15], s21 offen lds
  s_add_u32 s21, s21, 61440
  s_add_u32 m0, s22, 24576
  s_nop 0
  buffer_load_dwordx4 v4, s[12:15], s21 offen lds
  s_add_u32 s21, s21, 61440
  s_add_u32 m0, s22, 28672
  s_nop 0
  buffer_load_dwordx4 v4, s[12:15], s21 offen lds
  s_add_u32 s21, s21, 61440
  s_add_u32 m0, s22, 32768
  s_nop 0
  buffer_load_dwordx4 v4, s[12:15], s21 offen lds
  s_add_u32 s21, s21, 61440
  s_add_u32 m0, s22, 36864
  s_nop 0
  buffer_load_dwordx4 v4, s[12:15], s21 offen lds
  s_add_u32 s21, s21, 61440
  s_add_u32 m0, s22, 40960
  s_nop 0
  buffer_load_dwordx4 v4, s[12:15], s21 offen lds
  s_add_u32 s21, s21, 61440
  s_add_u32 m0, s22, 45056
  s_nop 0
  buffer_load_dwordx4 v4, s[12:15], s21 offen lds
  s_add_u32 s21, s21, 61440
  s_add_u32 m0, s22, 49152
  s_nop 0
  buffer_load_dwordx4 v4, s[12:15], s21 offen lds
  s_add_u32 s21, s21, 61440
  s_add_u32 m0, s22, 53248
  s_nop 0
  buffer_load_dwordx4 v4, s[12:15], s21 offen lds
  s_add_u32 s21, s21, 61440
  s_add_u32 m0, s22, 57344
  s_nop 0
  buffer_load_dwordx4 v4, s[12:15], s21 offen lds
  s_add_u32 s21, s21, 61440
  s_add_u32 m0, s22, 61440
  s_nop 0
  buffer_load_dwordx4 v4, s[12:15], s21 offen lds
  s_add_u32 s21, s21, 61440
  s_add_u32 m0, s22, 65536
  s_nop 0
  buffer_load_dwordx4 v4, s[12:15], s21 offen lds
  s_add_u32 s21, s21, 61440
  s_add_u32 m0, s22, 69632
  s_nop 0
  buffer_load_dwordx4 v4, s[12:15], s21 offen lds
  s_add_u32 s21, s21, 61440
  s_add_u32 m0, s22, 73728
  s_nop 0
  buffer_load_dwordx4 v4, s[12:15], s21 offen lds
  s_add_u32 s21, s21, 61440
  s_add_u32 m0, s22, 77824
  s_nop 0
  buffer_load_dwordx4 v4, s[12:15], s21 offen lds
  s_add_u32 s21, s21, 61440
  s_add_u32 m0, s22, 81920
  s_nop 0
  buffer_load_dwordx4 v4, s[12:15], s21 offen lds
  s_add_u32 s21, s21, 61440
  s_add_u32 m0, s22, 86016
  s_nop 0
  buffer_load_dwordx4 v4, s[12:15], s21 offen lds
  s_add_u32 s21, s21, 61440
  s_add_u32 m0, s22, 90112
  s_nop 0
  buffer_load_dwordx4 v4, s[12:15], s21 offen lds
  s_add_u32 s21, s21, 61440
  s_add_u32 m0, s22, 94208
  s_nop 0
  buffer_load_dwordx4 v4, s[12:15], s21 offen lds
  s_add_u32 s21, s21, 61440
  s_add_u32 m0, s22, 98304
  s_nop 0
  buffer_load_dwordx4 v4, s[12:15], s21 offen lds
  s_add_u32 s21, s21, 61440
  s_add_u32 m0, s22, 102400
  s_nop 0
  buffer_load_dwordx4 v4, s[12:15], s21 offen lds
  s_add_u32 s21, s21, 61440
  s_add_u32 m0, s22, 106496
  s_nop 0
  buffer_load_dwordx4 v4, s[12:15], s21 offen lds
  s_add_u32 s21, s21, 61440
  s_add_u32 m0, s22, 110592
  s_nop 0
  buffer_load_dwordx4 v4, s[12:15], s21 offen lds
  s_add_u32 s21, s21, 61440
  s_add_u32 m0, s22, 114688
  s_nop 0
  buffer_load_dwordx4 v4, s[12:15], s21 offen lds
  s_add_u32 s21, s21, 61440
  s_add_u32 m0, s22, 118784
  s_nop 0
  buffer_load_dwordx4 v4, s[12:15], s21 offen lds
  s_add_u32 s21, s21, 61440
  s_add_u32 m0, s22, 122880
  s_nop 0
  buffer_load_dwordx4 v4, s[12:15], s21 offen lds
  s_add_u32 s21, s21, 61440
  s_add_u32 m0, s22, 126976
  s_nop 0
  buffer_load_dwordx4 v4, s[12:15], s21 offen lds
  s_add_u32 s21, s21, 61440
  s_add_u32 m0, s22, 131072
  s_nop 0
  buffer_load_dwordx4 v4, s[12:15], s21 offen lds
  s_add_u32 s21, s21, 61440
  s_add_u32 m0, s22, 135168
  s_nop 0
  buffer_load_dwordx4 v4, s[12:15], s21 offen lds
  s_add_u32 s21, s21, 61440
  s_add_u32 m0, s22, 139264
  s_nop 0
  buffer_load_dwordx4 v4, s[12:15], s21 offen lds
  s_add_u32 s21, s21, 61440
  s_add_u32 m0, s22, 143360
  s_nop 0
  buffer_load_dwordx4 v4, s[12:15], s21 offen lds
  s_add_u32 s21, s21, 61440
  s_add_u32 m0, s22, 147456
  s_nop 0
  buffer_load_dwordx4 v4, s[12:15], s21 offen lds
  s_add_u32 s21, s21, 61440
  s_add_u32 m0, s22, 151552
  s_nop 0
  buffer_load_dwordx4 v4, s[12:15], s21 offen lds
  s_add_u32 s21, s21, 61440
  s_add_u32 m0, s22, 155648
  s_nop 0
  buffer_load_dwordx4 v4, s[12:15], s21 offen lds
  s_add_u32 s21, s21, 61440
  s_add_u32 m0, s22, 159744
  s_nop 0
  buffer_load_dwordx4 v4, s[12:15], s21 offen lds
  s_add_u32 s21, s21, 61440
  s_lshl_b32 s21, s2, 2
  s_add_u32 s21, s21, s20
  s_mul_i32 s21, s21, 20480
  v_lshlrev_b32 v5, 4, v1
  buffer_load_dwordx4 v[64:67], v5, s[8:11], s21 offen offset:0
  buffer_load_dwordx4 v[64:67], v5, s[8:11], s21 offen offset:1024
  buffer_load_dwordx4 v[64:67], v5, s[8:11], s21 offen offset:2048
  buffer_load_dwordx4 v[64:67], v5, s[8:11], s21 offen offset:3072
  s_add_u32 s21, s21, 4096
  buffer_load_dwordx4 v[64:67], v5, s[8:11], s21 offen offset:0
  buffer_load_dwordx4 v[64:67], v5, s[8:11], s21 offen offset:1024
  buffer_load_dwordx4 v[64:67], v5, s[8:11], s21 offen offset:2048
  buffer_load_dwordx4 v[64:67], v5, s[8:11], s21 offen offset:3072
  s_add_u32 s21, s21, 4096
  buffer_load_dwordx4 v[64:67], v5, s[8:11], s21 offen offset:0
  buffer_load_dwordx4 v[64:67], v5, s[8:11], s21 offen offset:1024
  buffer_load_dwordx4 v[64:67], v5, s[8:11], s21 offen offset:2048
  buffer_load_dwordx4 v[64:67], v5, s[8:11], s21 offen offset:3072
  s_add_u32 s21, s21, 4096
  buffer_load_dwordx4 v[64:67], v5, s[8:11], s21 offen offset:0
  buffer_load_dwordx4 v[64:67], v5, s[8:11], s21 offen offset:1024
  buffer_load_dwordx4 v[64:67], v5, s[8:11], s21 offen offset:2048
  buffer_load_dwordx4 v[64:67], v5, s[8:11], s21 offen offset:3072
  s_add_u32 s21, s21, 4096
  buffer_load_dwordx4 v[64:67], v5, s[8:11], s21 offen offset:0
  buffer_load_dwordx4 v[64:67], v5, s[8:11], s21 offen offset:1024
  buffer_load_dwordx4 v[64:67], v5, s[8:11], s21 offen offset:2048
  buffer_load_dwordx4 v[64:67], v5, s[8:11], s21 offen offset:3072
  v_lshrrev_b32 v6, 2, v2
  v_lshl_add_u32 v7, v3, 3, v6
  v_and_b32 v8, 1, v3
  v_lshl_add_u32 v6, v8, 2, v6
  v_lshlrev_b32 v6, 1, v6
  v_bfe_u32 v8, v2, 1, 1
  s_lshl_b32 s21, s20, 2
  v_add_u32 v8, s21, v8
  v_and_b32 v9, 1, v2
  v_lshlrev_b32 v9, 3, v9
  v_lshl_add_u32 v9, v7, 8, v9
  v_add_u32 v5, 0, v8
  v_xor_b32 v5, v5, v6
  v_lshl_add_u32 v10, v5, 4, v9
  v_add_u32 v11, 65536, v10
  v_add_u32 v12, 131072, v10
  v_add_u32 v5, 2, v8
  v_xor_b32 v5, v5, v6
  v_lshl_add_u32 v13, v5, 4, v9
  v_add_u32 v14, 65536, v13
  v_add_u32 v15, 131072, v13
  s_waitcnt vmcnt(50)
  s_barrier
  ds_read_b64_tr_b16 a[0:1], v10 offset:0
  ds_read_b64_tr_b16 a[2:3], v10 offset:1024
  ds_read_b64_tr_b16 a[4:5], v13 offset:0
  ds_read_b64_tr_b16 a[6:7], v13 offset:1024
  ds_read_b64_tr_b16 a[8:9], v10 offset:8192
  ds_read_b64_tr_b16 a[10:11], v10 offset:9216
  ds_read_b64_tr_b16 a[12:13], v13 offset:8192
  ds_read_b64_tr_b16 a[14:15], v13 offset:9216
  ds_read_b64_tr_b16 a[16:17], v10 offset:16384
  ds_read_b64_tr_b16 a[18:19], v10 offset:17408
  ds_read_b64_tr_b16 a[20:21], v13 offset:16384
  ds_read_b64_tr_b16 a[22:23], v13 offset:17408
  ds_read_b64_tr_b16 a[24:25], v10 offset:24576
  ds_read_b64_tr_b16 a[26:27], v10 offset:25600
  ds_read_b64_tr_b16 a[28:29], v13 offset:24576
  ds_read_b64_tr_b16 a[30:31], v13 offset:25600
  ds_read_b64_tr_b16 a[32:33], v10 offset:32768
  ds_read_b64_tr_b16 a[34:35], v10 offset:33792
  ds_read_b64_tr_b16 a[36:37], v13 offset:32768
  ds_read_b64_tr_b16 a[38:39], v13 offset:33792
  s_waitcnt vmcnt(40)
  s_barrier
  ds_read_b64_tr_b16 a[40:41], v10 offset:40960
  ds_read_b64_tr_b16 a[42:43], v10 offset:41984
  ds_read_b64_tr_b16 a[44:45], v13 offset:40960
  ds_read_b64_tr_b16 a[46:47], v13 offset:41984
  ds_read_b64_tr_b16 a[48:49], v10 offset:49152
  ds_read_b64_tr_b16 a[50:51], v10 offset:50176
  ds_read_b64_tr_b16 a[52:53], v13 offset:49152
  ds_read_b64_tr_b16 a[54:55], v13 offset:50176
  ds_read_b64_tr_b16 a[56:57], v10 offset:57344
  ds_read_b64_tr_b16 a[58:59], v10 offset:58368
  ds_read_b64_tr_b16 a[60:61], v13 offset:57344
  ds_read_b64_tr_b16 a[62:63], v13 offset:58368
  ds_read_b64_tr_b16 a[64:65], v11 offset:0
  ds_read_b64_tr_b16 a[66:67], v11 offset:1024
  ds_read_b64_tr_b16 a[68:69], v14 offset:0
  ds_read_b64_tr_b16 a[70:71], v14 offset:1024
  ds_read_b64_tr_b16 a[72:73], v11 offset:8192
  ds_read_b64_tr_b16 a[74:75], v11 offset:9216
  ds_read_b64_tr_b16 a[76:77], v14 offset:8192
  ds_read_b64_tr_b16 a[78:79], v14 offset:9216
  s_waitcnt vmcnt(30)
  s_barrier
  ds_read_b64_tr_b16 a[80:81], v11 offset:16384
  ds_read_b64_tr_b16 a[82:83], v11 offset:17408
  ds_read_b64_tr_b16 a[84:85], v14 offset:16384
  ds_read_b64_tr_b16 a[86:87], v14 offset:17408
  ds_read_b64_tr_b16 a[88:89], v11 offset:24576
  ds_read_b64_tr_b16 a[90:91], v11 offset:25600
  ds_read_b64_tr_b16 a[92:93], v14 offset:24576
  ds_read_b64_tr_b16 a[94:95], v14 offset:25600
  ds_read_b64_tr_b16 a[96:97], v11 offset:32768
  ds_read_b64_tr_b16 a[98:99], v11 offset:33792
  ds_read_b64_tr_b16 a[100:101], v14 offset:32768
  ds_read_b64_tr_b16 a[102:103], v14 offset:33792
  ds_read_b64_tr_b16 a[104:105], v11 offset:40960
  ds_read_b64_tr_b16 a[106:107], v11 offset:41984
  ds_read_b64_tr_b16 a[108:109], v14 offset:40960
  ds_read_b64_tr_b16 a[110:111], v14 offset:41984
  ds_read_b64_tr_b16 a[112:113], v11 offset:49152
  ds_read_b64_tr_b16 a[114:115], v11 offset:50176
  ds_read_b64_tr_b16 a[116:117], v14 offset:49152
  ds_read_b64_tr_b16 a[118:119], v14 offset:50176
  s_waitcnt vmcnt(20)
  s_barrier
  ds_read_b64_tr_b16 a[120:121], v11 offset:57344
  ds_read_b64_tr_b16 a[122:123], v11 offset:58368
  ds_read_b64_tr_b16 a[124:125], v14 offset:57344
  ds_read_b64_tr_b16 a[126:127], v14 offset:58368
  ds_read_b64_tr_b16 a[128:129], v12 offset:0
  ds_read_b64_tr_b16 a[130:131], v12 offset:1024
  ds_read_b64_tr_b16 a[132:133], v15 offset:0
  ds_read_b64_tr_b16 a[134:135], v15 offset:1024
  ds_read_b64_tr_b16 a[136:137], v12 offset:8192
  ds_read_b64_tr_b16 a[138:139], v12 offset:9216
  ds_read_b64_tr_b16 a[140:141], v15 offset:8192
  ds_read_b64_tr_b16 a[142:143], v15 offset:9216
  ds_read_b64_tr_b16 a[144:145], v12 offset:16384
  ds_read_b64_tr_b16 a[146:147], v12 offset:17408
  ds_read_b64_tr_b16 a[148:149], v15 offset:16384
  ds_read_b64_tr_b16 a[150:151], v15 offset:17408
  ds_read_b64_tr_b16 a[152:153], v12 offset:24576
  ds_read_b64_tr_b16 a[154:155], v12 offset:25600
  ds_read_b64_tr_b16 a[156:157], v15 offset:24576
  ds_read_b64_tr_b16 a[158:159], v15 offset:25600
  s_waitcnt lgkmcnt(0)
  s_barrier
  v_and_b32 v4, 31, v1
  s_lshl_b32 s21, s20, 5
  v_add_u32 v36, s21, v4
  v_lshrrev_b32 v5, 5, v1
  v_mul_u32_u24 v6, 264, v36
  v_mul_u32_u24 v7, 40, v5
  s_mov_b32 s21, 114952
  v_add3_u32 v34, v6, v7, s21
  v_lshl_add_u32 v38, v5, 3, v34
  v_lshlrev_b32 v6, 5, v5
  v_sub_u32 v39, v34, v6
  v_lshlrev_b32 v35, 3, v1
  v_add_u32 v35, 114688, v35
  v_mov_b32 v37, 0xf149f2ca
  s_mul_i32 s21, s41, 165120
  s_mul_i32 s22, s42, 16512
  s_add_u32 s21, s21, s22
  v_lshl_add_u32 v7, v36, 4, s21
  v_mul_u32_u24 v6, 99072, v5
  v_add_u32 v29, v6, v7
  v_add_u32 v30, 33024, v29
  v_lshl_add_u32 v31, v5, 3, v7
  v_add_u32 v31, 66048, v31
  v_mov_b32 v8, 0
  v_mov_b32 v9, 0
  ds_write_b64 v35, v[8:9] offset:0
  ds_write_b64 v35, v[8:9] offset:512
  ds_write_b64 v35, v[8:9] offset:1024
  ds_write_b64 v35, v[8:9] offset:1536
  ds_write_b64 v35, v[8:9] offset:2048
  s_mul_i32 s24, s42, 1280
  s_mov_b32 s25, 327680
  s_mov_b32 s26, 8
  s_mov_b32 s27, 0
  s_mov_b32 s60, 0x3e64f92e
  s_mov_b32 s61, 0x3fb8aa3b
  s_mov_b32 s62, 0x05040100
  s_mov_b32 s63, 0x07060302
  v_cmp_le_u32 s[76:77], 0, v36
  v_cmp_le_u32 s[78:79], 1, v36
  v_cmp_le_u32 s[80:81], 2, v36
  v_cmp_le_u32 s[82:83], 3, v36
  v_cmp_le_u32 s[84:85], 4, v36
  v_cmp_le_u32 s[86:87], 5, v36
  v_cmp_le_u32 s[88:89], 6, v36
  v_cmp_le_u32 s[90:91], 7, v36
  v_lshrrev_b32 v11, 3, v1
  v_and_b32 v12, 7, v1
  v_xor_b32 v12, v12, v11
  v_mul_u32_u24 v11, 2560, v11
  v_lshl_add_u32 v10, v12, 4, v11
  s_mul_i32 s46, s20, 81920
  v_add_u32 v10, s46, v10
  s_lshl_b32 s47, s20, 12
  s_add_u32 s47, s47, 0
  s_add_u32 s46, s47, 114688
  s_mov_b32 s30, s24
  s_add_u32 s32, s47, 0
  v_add_u32 v11, 19456, v10
  v_add_u32 v12, 38912, v10
  v_add_u32 v13, 58368, v10
  s_mov_b32 m0, s32
  s_nop 0
  buffer_load_dwordx4 v10, s[8:11], s30 offen offset:0 lds
  buffer_load_dwordx4 v11, s[8:11], s30 offen offset:1024 lds
  buffer_load_dwordx4 v12, s[8:11], s30 offen offset:2048 lds
  buffer_load_dwordx4 v13, s[8:11], s30 offen offset:3072 lds
  s_add_u32 s30, s30, 128
  s_add_u32 s32, s32, 16384
  s_cmp_lt_u32 s32, s46
  s_cselect_b32 s32, s32, s47
  s_mov_b32 m0, s32
  s_nop 0
  buffer_load_dwordx4 v10, s[8:11], s30 offen offset:0 lds
  buffer_load_dwordx4 v11, s[8:11], s30 offen offset:1024 lds
  buffer_load_dwordx4 v12, s[8:11], s30 offen offset:2048 lds
  buffer_load_dwordx4 v13, s[8:11], s30 offen offset:3072 lds
  s_add_u32 s30, s30, 128
  s_add_u32 s32, s32, 16384
  s_cmp_lt_u32 s32, s46
  s_cselect_b32 s32, s32, s47
  s_mov_b32 m0, s32
  s_nop 0
  buffer_load_dwordx4 v10, s[8:11], s30 offen offset:0 lds
  buffer_load_dwordx4 v11, s[8:11], s30 offen offset:1024 lds
  buffer_load_dwordx4 v12, s[8:11], s30 offen offset:2048 lds
  buffer_load_dwordx4 v13, s[8:11], s30 offen offset:3072 lds
  s_add_u32 s30, s30, 128
  s_add_u32 s32, s32, 16384
  s_cmp_lt_u32 s32, s46
  s_cselect_b32 s32, s32, s47
  s_mov_b32 m0, s32
  s_nop 0
  buffer_load_dwordx4 v10, s[8:11], s30 offen offset:0 lds
  buffer_load_dwordx4 v11, s[8:11], s30 offen offset:1024 lds
  buffer_load_dwordx4 v12, s[8:11], s30 offen offset:2048 lds
  buffer_load_dwordx4 v13, s[8:11], s30 offen offset:3072 lds
  s_add_u32 s30, s30, 128
  s_add_u32 s32, s32, 16384
  s_cmp_lt_u32 s32, s46
  s_cselect_b32 s32, s32, s47
  s_mov_b32 m0, s32
  s_nop 0
  buffer_load_dwordx4 v10, s[8:11], s30 offen offset:0 lds
  buffer_load_dwordx4 v11, s[8:11], s30 offen offset:1024 lds
  buffer_load_dwordx4 v12, s[8:11], s30 offen offset:2048 lds
  buffer_load_dwordx4 v13, s[8:11], s30 offen offset:3072 lds
  s_add_u32 s30, s30, 128
  s_add_u32 s32, s32, 16384
  s_cmp_lt_u32 s32, s46
  s_cselect_b32 s32, s32, s47
  v_and_b32 v6, 7, v2
  v_add_u32 v4, 0, v3
  v_xor_b32 v4, v4, v6
  v_lshlrev_b32 v4, 4, v4
  v_lshl_add_u32 v14, v2, 7, v4
  v_add_u32 v4, 4, v3
  v_xor_b32 v4, v4, v6
  v_lshlrev_b32 v4, 4, v4
  v_lshl_add_u32 v15, v2, 7, v4
  v_mul_u32_u24 v22, 264, v2
  v_mul_u32_u24 v4, 8, v3
  s_mul_i32 s21, s20, 64
  s_add_u32 s21, s21, 116800
  v_add3_u32 v22, v22, v4, s21
  v_lshlrev_b32 v4, 3, v3
  v_sub_u32 v16, v22, v4
  v_mov_b32 v9, 2731
  s_mov_b32 s33, 0
  s_mov_b32 s48, 0x80000000
  s_mov_b32 m0, s32
  s_nop 0
  buffer_load_dwordx4 v10, s[8:11], s30 offen offset:0 lds
  buffer_load_dwordx4 v11, s[8:11], s30 offen offset:1024 lds
  s_waitcnt vmcnt(18)
  s_barrier
  v_add_u32 v18, s33, v14
  v_add_u32 v19, s33, v15
  s_add_u32 s33, s33, 16384
  s_cmp_lt_u32 s33, 114688
  s_cselect_b32 s33, s33, 0
  ds_read_b128 v[160:163], v18 offset:0
  ds_read_b128 v[164:167], v18 offset:2048
  ds_read_b128 v[168:171], v18 offset:4096
  ds_read_b128 v[172:175], v18 offset:6144
  ds_read_b128 v[176:179], v18 offset:8192
  ds_read_b128 v[180:183], v18 offset:10240
  ds_read_b128 v[184:187], v18 offset:12288
  ds_read_b128 v[188:191], v18 offset:14336
  s_waitcnt lgkmcnt(0)
bf_blk_198:
  v_mfma_f32_16x16x32_bf16 v[64:67], a[0:3], v[160:163], 0
  ds_read_b128 v[192:195], v19 offset:0
  v_mfma_f32_16x16x32_bf16 v[68:71], a[4:7], v[160:163], 0
  v_add_u32 v18, s33, v14
  v_mfma_f32_16x16x32_bf16 v[72:75], a[0:3], v[164:167], 0
  ds_read_b128 v[196:199], v19 offset:2048
  v_mfma_f32_16x16x32_bf16 v[76:79], a[4:7], v[164:167], 0
  buffer_load_dwordx4 v12, s[8:11], s30 offen offset:2048 lds
  v_mfma_f32_16x16x32_bf16 v[80:83], a[0:3], v[168:171], 0
  ds_read_b128 v[200:203], v19 offset:4096
  v_mfma_f32_16x16x32_bf16 v[84:87], a[4:7], v[168:171], 0
  v_mfma_f32_16x16x32_bf16 v[88:91], a[0:3], v[172:175], 0
  ds_read_b128 v[204:207], v19 offset:6144
  v_mfma_f32_16x16x32_bf16 v[92:95], a[4:7], v[172:175], 0
  s_waitcnt lgkmcnt(14)
  v_mfma_f32_16x16x32_bf16 v[96:99], a[0:3], v[176:179], 0
  ds_read_b128 v[208:211], v19 offset:8192
  v_mfma_f32_16x16x32_bf16 v[100:103], a[4:7], v[176:179], 0
  v_mfma_f32_16x16x32_bf16 v[104:107], a[0:3], v[180:183], 0
  ds_read_b128 v[212:215], v19 offset:10240
  v_mfma_f32_16x16x32_bf16 v[108:111], a[4:7], v[180:183], 0
  buffer_load_dwordx4 v13, s[8:11], s30 offen offset:3072 lds
  v_mfma_f32_16x16x32_bf16 v[112:115], a[0:3], v[184:187], 0
  ds_read_b128 v[216:219], v19 offset:12288
  s_add_u32 s30, s30, 128
  v_mfma_f32_16x16x32_bf16 v[116:119], a[4:7], v[184:187], 0
  s_add_u32 m0, m0, 16384
  v_mfma_f32_16x16x32_bf16 v[120:123], a[0:3], v[188:191], 0
  ds_read_b128 v[220:223], v19 offset:14336
  v_mfma_f32_16x16x32_bf16 v[124:127], a[4:7], v[188:191], 0
  s_waitcnt vmcnt(16) lgkmcnt(4)
  s_barrier
  v_mfma_f32_16x16x32_bf16 v[64:67], a[8:11], v[192:195], v[64:67]
  ds_read_b128 v[160:163], v18 offset:0
  v_mfma_f32_16x16x32_bf16 v[68:71], a[12:15], v[192:195], v[68:71]
  s_cmp_lt_u32 m0, s46
  s_cselect_b32 m0, m0, s47
  v_mfma_f32_16x16x32_bf16 v[72:75], a[8:11], v[196:199], v[72:75]
  ds_read_b128 v[164:167], v18 offset:2048
  v_add_u32 v19, s33, v15
  v_mfma_f32_16x16x32_bf16 v[76:79], a[12:15], v[196:199], v[76:79]
  buffer_load_dwordx4 v10, s[8:11], s30 offen offset:0 lds
  v_mfma_f32_16x16x32_bf16 v[80:83], a[8:11], v[200:203], v[80:83]
  ds_read_b128 v[168:171], v18 offset:4096
  s_add_u32 s33, s33, 16384
  v_mfma_f32_16x16x32_bf16 v[84:87], a[12:15], v[200:203], v[84:87]
  s_cmp_lt_u32 s33, 114688
  s_cselect_b32 s33, s33, 0
  v_mfma_f32_16x16x32_bf16 v[88:91], a[8:11], v[204:207], v[88:91]
  ds_read_b128 v[172:175], v18 offset:6144
  v_mfma_f32_16x16x32_bf16 v[92:95], a[12:15], v[204:207], v[92:95]
  s_waitcnt lgkmcnt(4)
  v_mfma_f32_16x16x32_bf16 v[96:99], a[8:11], v[208:211], v[96:99]
  ds_read_b128 v[176:179], v18 offset:8192
  v_mfma_f32_16x16x32_bf16 v[100:103], a[12:15], v[208:211], v[100:103]
  v_mfma_f32_16x16x32_bf16 v[104:107], a[8:11], v[212:215], v[104:107]
  ds_read_b128 v[180:183], v18 offset:10240
  v_mfma_f32_16x16x32_bf16 v[108:111], a[12:15], v[212:215], v[108:111]
  buffer_load_dwordx4 v11, s[8:11], s30 offen offset:1024 lds
  v_mfma_f32_16x16x32_bf16 v[112:115], a[8:11], v[216:219], v[112:115]
  ds_read_b128 v[184:187], v18 offset:12288
  v_mfma_f32_16x16x32_bf16 v[116:119], a[12:15], v[216:219], v[116:119]
  v_mfma_f32_16x16x32_bf16 v[120:123], a[8:11], v[220:223], v[120:123]
  ds_read_b128 v[188:191], v18 offset:14336
  v_mfma_f32_16x16x32_bf16 v[124:127], a[12:15], v[220:223], v[124:127]
  s_waitcnt lgkmcnt(4)
  v_mfma_f32_16x16x32_bf16 v[64:67], a[16:19], v[160:163], v[64:67]
  ds_read_b128 v[192:195], v19 offset:0
  v_mfma_f32_16x16x32_bf16 v[68:71], a[20:23], v[160:163], v[68:71]
  v_add_u32 v18, s33, v14
  v_mfma_f32_16x16x32_bf16 v[72:75], a[16:19], v[164:167], v[72:75]
  ds_read_b128 v[196:199], v19 offset:2048
  v_mfma_f32_16x16x32_bf16 v[76:79], a[20:23], v[164:167], v[76:79]
  buffer_load_dwordx4 v12, s[8:11], s30 offen offset:2048 lds
  v_mfma_f32_16x16x32_bf16 v[80:83], a[16:19], v[168:171], v[80:83]
  ds_read_b128 v[200:203], v19 offset:4096
  v_mfma_f32_16x16x32_bf16 v[84:87], a[20:23], v[168:171], v[84:87]
  v_mfma_f32_16x16x32_bf16 v[88:91], a[16:19], v[172:175], v[88:91]
  ds_read_b128 v[204:207], v19 offset:6144
  v_mfma_f32_16x16x32_bf16 v[92:95], a[20:23], v[172:175], v[92:95]
  s_waitcnt lgkmcnt(4)
  v_mfma_f32_16x16x32_bf16 v[96:99], a[16:19], v[176:179], v[96:99]
  ds_read_b128 v[208:211], v19 offset:8192
  v_mfma_f32_16x16x32_bf16 v[100:103], a[20:23], v[176:179], v[100:103]
  v_mfma_f32_16x16x32_bf16 v[104:107], a[16:19], v[180:183], v[104:107]
  ds_read_b128 v[212:215], v19 offset:10240
  v_mfma_f32_16x16x32_bf16 v[108:111], a[20:23], v[180:183], v[108:111]
  buffer_load_dwordx4 v13, s[8:11], s30 offen offset:3072 lds
  v_mfma_f32_16x16x32_bf16 v[112:115], a[16:19], v[184:187], v[112:115]
  ds_read_b128 v[216:219], v19 offset:12288
  s_add_u32 s30, s30, 128
  v_mfma_f32_16x16x32_bf16 v[116:119], a[20:23], v[184:187], v[116:119]
  s_add_u32 m0, m0, 16384
  v_mfma_f32_16x16x32_bf16 v[120:123], a[16:19], v[188:191], v[120:123]
  ds_read_b128 v[220:223], v19 offset:14336
  v_mfma_f32_16x16x32_bf16 v[124:127], a[20:23], v[188:191], v[124:127]
  s_waitcnt vmcnt(16) lgkmcnt(4)
  s_barrier
  v_mfma_f32_16x16x32_bf16 v[64:67], a[24:27], v[192:195], v[64:67]
  ds_read_b128 v[160:163], v18 offset:0
  v_mfma_f32_16x16x32_bf16 v[68:71], a[28:31], v[192:195], v[68:71]
  s_cmp_lt_u32 m0, s46
  s_cselect_b32 m0, m0, s47
  v_mfma_f32_16x16x32_bf16 v[72:75], a[24:27], v[196:199], v[72:75]
  ds_read_b128 v[164:167], v18 offset:2048
  v_add_u32 v19, s33, v15
  v_mfma_f32_16x16x32_bf16 v[76:79], a[28:31], v[196:199], v[76:79]
  buffer_load_dwordx4 v10, s[8:11], s30 offen offset:0 lds
  v_mfma_f32_16x16x32_bf16 v[80:83], a[24:27], v[200:203], v[80:83]
  ds_read_b128 v[168:171], v18 offset:4096
  s_add_u32 s33, s33, 16384
  v_mfma_f32_16x16x32_bf16 v[84:87], a[28:31], v[200:203], v[84:87]
  s_cmp_lt_u32 s33, 114688
  s_cselect_b32 s33, s33, 0
  v_mfma_f32_16x16x32_bf16 v[88:91], a[24:27], v[204:207], v[88:91]
  ds_read_b128 v[172:175], v18 offset:6144
  v_mfma_f32_16x16x32_bf16 v[92:95], a[28:31], v[204:207], v[92:95]
  s_waitcnt lgkmcnt(4)
  v_mfma_f32_16x16x32_bf16 v[96:99], a[24:27], v[208:211], v[96:99]
  ds_read_b128 v[176:179], v18 offset:8192
  v_mfma_f32_16x16x32_bf16 v[100:103], a[28:31], v[208:211], v[100:103]
  v_mfma_f32_16x16x32_bf16 v[104:107], a[24:27], v[212:215], v[104:107]
  ds_read_b128 v[180:183], v18 offset:10240
  v_mfma_f32_16x16x32_bf16 v[108:111], a[28:31], v[212:215], v[108:111]
  buffer_load_dwordx4 v11, s[8:11], s30 offen offset:1024 lds
  v_mfma_f32_16x16x32_bf16 v[112:115], a[24:27], v[216:219], v[112:115]
  ds_read_b128 v[184:187], v18 offset:12288
  v_mfma_f32_16x16x32_bf16 v[116:119], a[28:31], v[216:219], v[116:119]
  v_mfma_f32_16x16x32_bf16 v[120:123], a[24:27], v[220:223], v[120:123]
  ds_read_b128 v[188:191], v18 offset:14336
  v_mfma_f32_16x16x32_bf16 v[124:127], a[28:31], v[220:223], v[124:127]
  s_waitcnt lgkmcnt(4)
  v_mfma_f32_16x16x32_bf16 v[64:67], a[32:35], v[160:163], v[64:67]
  ds_read_b128 v[192:195], v19 offset:0
  v_mfma_f32_16x16x32_bf16 v[68:71], a[36:39], v[160:163], v[68:71]
  v_add_u32 v18, s33, v14
  v_mfma_f32_16x16x32_bf16 v[72:75], a[32:35], v[164:167], v[72:75]
  ds_read_b128 v[196:199], v19 offset:2048
  v_mfma_f32_16x16x32_bf16 v[76:79], a[36:39], v[164:167], v[76:79]
  buffer_load_dwordx4 v12, s[8:11], s30 offen offset:2048 lds
  v_mfma_f32_16x16x32_bf16 v[80:83], a[32:35], v[168:171], v[80:83]
  ds_read_b128 v[200:203], v19 offset:4096
  v_mfma_f32_16x16x32_bf16 v[84:87], a[36:39], v[168:171], v[84:87]
  v_mfma_f32_16x16x32_bf16 v[88:91], a[32:35], v[172:175], v[88:91]
  ds_read_b128 v[204:207], v19 offset:6144
  v_mfma_f32_16x16x32_bf16 v[92:95], a[36:39], v[172:175], v[92:95]
  s_waitcnt lgkmcnt(4)
  v_mfma_f32_16x16x32_bf16 v[96:99], a[32:35], v[176:179], v[96:99]
  ds_read_b128 v[208:211], v19 offset:8192
  v_mfma_f32_16x16x32_bf16 v[100:103], a[36:39], v[176:179], v[100:103]
  v_mfma_f32_16x16x32_bf16 v[104:107], a[32:35], v[180:183], v[104:107]
  ds_read_b128 v[212:215], v19 offset:10240
  v_mfma_f32_16x16x32_bf16 v[108:111], a[36:39], v[180:183], v[108:111]
  buffer_load_dwordx4 v13, s[8:11], s30 offen offset:3072 lds
  v_mfma_f32_16x16x32_bf16 v[112:115], a[32:35], v[184:187], v[112:115]
  ds_read_b128 v[216:219], v19 offset:12288
  s_add_u32 s30, s30, 128
  v_mfma_f32_16x16x32_bf16 v[116:119], a[36:39], v[184:187], v[116:119]
  s_add_u32 m0, m0, 16384
  v_mfma_f32_16x16x32_bf16 v[120:123], a[32:35], v[188:191], v[120:123]
  ds_read_b128 v[220:223], v19 offset:14336
  v_mfma_f32_16x16x32_bf16 v[124:127], a[36:39], v[188:191], v[124:127]
  s_waitcnt vmcnt(16) lgkmcnt(4)
  s_barrier
  v_mfma_f32_16x16x32_bf16 v[64:67], a[40:43], v[192:195], v[64:67]
  ds_read_b128 v[160:163], v18 offset:0
  v_mfma_f32_16x16x32_bf16 v[68:71], a[44:47], v[192:195], v[68:71]
  s_cmp_lt_u32 m0, s46
  s_cselect_b32 m0, m0, s47
  v_mfma_f32_16x16x32_bf16 v[72:75], a[40:43], v[196:199], v[72:75]
  ds_read_b128 v[164:167], v18 offset:2048
  v_add_u32 v19, s33, v15
  v_mfma_f32_16x16x32_bf16 v[76:79], a[44:47], v[196:199], v[76:79]
  buffer_load_dwordx4 v10, s[8:11], s30 offen offset:0 lds
  v_mfma_f32_16x16x32_bf16 v[80:83], a[40:43], v[200:203], v[80:83]
  ds_read_b128 v[168:171], v18 offset:4096
  s_add_u32 s33, s33, 16384
  v_mfma_f32_16x16x32_bf16 v[84:87], a[44:47], v[200:203], v[84:87]
  s_cmp_lt_u32 s33, 114688
  s_cselect_b32 s33, s33, 0
  v_mfma_f32_16x16x32_bf16 v[88:91], a[40:43], v[204:207], v[88:91]
  ds_read_b128 v[172:175], v18 offset:6144
  v_mfma_f32_16x16x32_bf16 v[92:95], a[44:47], v[204:207], v[92:95]
  s_waitcnt lgkmcnt(4)
  v_mfma_f32_16x16x32_bf16 v[96:99], a[40:43], v[208:211], v[96:99]
  ds_read_b128 v[176:179], v18 offset:8192
  v_mfma_f32_16x16x32_bf16 v[100:103], a[44:47], v[208:211], v[100:103]
  v_mfma_f32_16x16x32_bf16 v[104:107], a[40:43], v[212:215], v[104:107]
  ds_read_b128 v[180:183], v18 offset:10240
  v_mfma_f32_16x16x32_bf16 v[108:111], a[44:47], v[212:215], v[108:111]
  buffer_load_dwordx4 v11, s[8:11], s30 offen offset:1024 lds
  v_mfma_f32_16x16x32_bf16 v[112:115], a[40:43], v[216:219], v[112:115]
  ds_read_b128 v[184:187], v18 offset:12288
  v_mfma_f32_16x16x32_bf16 v[116:119], a[44:47], v[216:219], v[116:119]
  v_mfma_f32_16x16x32_bf16 v[120:123], a[40:43], v[220:223], v[120:123]
  ds_read_b128 v[188:191], v18 offset:14336
  v_mfma_f32_16x16x32_bf16 v[124:127], a[44:47], v[220:223], v[124:127]
  s_waitcnt lgkmcnt(4)
  v_mfma_f32_16x16x32_bf16 v[64:67], a[48:51], v[160:163], v[64:67]
  ds_read_b128 v[192:195], v19 offset:0
  v_mfma_f32_16x16x32_bf16 v[68:71], a[52:55], v[160:163], v[68:71]
  v_add_u32 v18, s33, v14
  v_mfma_f32_16x16x32_bf16 v[72:75], a[48:51], v[164:167], v[72:75]
  ds_read_b128 v[196:199], v19 offset:2048
  v_mfma_f32_16x16x32_bf16 v[76:79], a[52:55], v[164:167], v[76:79]
  buffer_load_dwordx4 v12, s[8:11], s30 offen offset:2048 lds
  v_mfma_f32_16x16x32_bf16 v[80:83], a[48:51], v[168:171], v[80:83]
  ds_read_b128 v[200:203], v19 offset:4096
  v_mfma_f32_16x16x32_bf16 v[84:87], a[52:55], v[168:171], v[84:87]
  v_mfma_f32_16x16x32_bf16 v[88:91], a[48:51], v[172:175], v[88:91]
  ds_read_b128 v[204:207], v19 offset:6144
  v_mfma_f32_16x16x32_bf16 v[92:95], a[52:55], v[172:175], v[92:95]
  s_waitcnt lgkmcnt(4)
  v_mfma_f32_16x16x32_bf16 v[96:99], a[48:51], v[176:179], v[96:99]
  ds_read_b128 v[208:211], v19 offset:8192
  v_mfma_f32_16x16x32_bf16 v[100:103], a[52:55], v[176:179], v[100:103]
  v_mfma_f32_16x16x32_bf16 v[104:107], a[48:51], v[180:183], v[104:107]
  ds_read_b128 v[212:215], v19 offset:10240
  v_mfma_f32_16x16x32_bf16 v[108:111], a[52:55], v[180:183], v[108:111]
  buffer_load_dwordx4 v13, s[8:11], s30 offen offset:3072 lds
  v_mfma_f32_16x16x32_bf16 v[112:115], a[48:51], v[184:187], v[112:115]
  ds_read_b128 v[216:219], v19 offset:12288
  s_add_u32 s30, s30, 128
  v_mfma_f32_16x16x32_bf16 v[116:119], a[52:55], v[184:187], v[116:119]
  s_add_u32 m0, m0, 16384
  v_mfma_f32_16x16x32_bf16 v[120:123], a[48:51], v[188:191], v[120:123]
  ds_read_b128 v[220:223], v19 offset:14336
  v_mfma_f32_16x16x32_bf16 v[124:127], a[52:55], v[188:191], v[124:127]
  s_waitcnt vmcnt(16) lgkmcnt(4)
  s_barrier
  v_mfma_f32_16x16x32_bf16 v[64:67], a[56:59], v[192:195], v[64:67]
  ds_read_b128 v[160:163], v18 offset:0
  v_mfma_f32_16x16x32_bf16 v[68:71], a[60:63], v[192:195], v[68:71]
  s_cmp_lt_u32 m0, s46
  s_cselect_b32 m0, m0, s47
  v_mfma_f32_16x16x32_bf16 v[72:75], a[56:59], v[196:199], v[72:75]
  ds_read_b128 v[164:167], v18 offset:2048
  v_add_u32 v19, s33, v15
  v_mfma_f32_16x16x32_bf16 v[76:79], a[60:63], v[196:199], v[76:79]
  buffer_load_dwordx4 v10, s[8:11], s30 offen offset:0 lds
  v_mfma_f32_16x16x32_bf16 v[80:83], a[56:59], v[200:203], v[80:83]
  ds_read_b128 v[168:171], v18 offset:4096
  s_add_u32 s33, s33, 16384
  v_mfma_f32_16x16x32_bf16 v[84:87], a[60:63], v[200:203], v[84:87]
  s_cmp_lt_u32 s33, 114688
  s_cselect_b32 s33, s33, 0
  v_mfma_f32_16x16x32_bf16 v[88:91], a[56:59], v[204:207], v[88:91]
  ds_read_b128 v[172:175], v18 offset:6144
  v_mfma_f32_16x16x32_bf16 v[92:95], a[60:63], v[204:207], v[92:95]
  s_waitcnt lgkmcnt(4)
  v_mfma_f32_16x16x32_bf16 v[96:99], a[56:59], v[208:211], v[96:99]
  ds_read_b128 v[176:179], v18 offset:8192
  v_mfma_f32_16x16x32_bf16 v[100:103], a[60:63], v[208:211], v[100:103]
  v_mfma_f32_16x16x32_bf16 v[104:107], a[56:59], v[212:215], v[104:107]
  ds_read_b128 v[180:183], v18 offset:10240
  v_mfma_f32_16x16x32_bf16 v[108:111], a[60:63], v[212:215], v[108:111]
  buffer_load_dwordx4 v11, s[8:11], s30 offen offset:1024 lds
  v_mfma_f32_16x16x32_bf16 v[112:115], a[56:59], v[216:219], v[112:115]
  ds_read_b128 v[184:187], v18 offset:12288
  v_mfma_f32_16x16x32_bf16 v[116:119], a[60:63], v[216:219], v[116:119]
  v_mfma_f32_16x16x32_bf16 v[120:123], a[56:59], v[220:223], v[120:123]
  ds_read_b128 v[188:191], v18 offset:14336
  v_mfma_f32_16x16x32_bf16 v[124:127], a[60:63], v[220:223], v[124:127]
  s_waitcnt lgkmcnt(4)
  v_mfma_f32_16x16x32_bf16 v[64:67], a[64:67], v[160:163], v[64:67]
  ds_read_b128 v[192:195], v19 offset:0
  v_mfma_f32_16x16x32_bf16 v[68:71], a[68:71], v[160:163], v[68:71]
  v_add_u32 v18, s33, v14
  v_mfma_f32_16x16x32_bf16 v[72:75], a[64:67], v[164:167], v[72:75]
  ds_read_b128 v[196:199], v19 offset:2048
  v_mfma_f32_16x16x32_bf16 v[76:79], a[68:71], v[164:167], v[76:79]
  buffer_load_dwordx4 v12, s[8:11], s30 offen offset:2048 lds
  v_mfma_f32_16x16x32_bf16 v[80:83], a[64:67], v[168:171], v[80:83]
  ds_read_b128 v[200:203], v19 offset:4096
  v_mfma_f32_16x16x32_bf16 v[84:87], a[68:71], v[168:171], v[84:87]
  v_mfma_f32_16x16x32_bf16 v[88:91], a[64:67], v[172:175], v[88:91]
  ds_read_b128 v[204:207], v19 offset:6144
  v_mfma_f32_16x16x32_bf16 v[92:95], a[68:71], v[172:175], v[92:95]
  s_waitcnt lgkmcnt(4)
  v_mfma_f32_16x16x32_bf16 v[96:99], a[64:67], v[176:179], v[96:99]
  ds_read_b128 v[208:211], v19 offset:8192
  v_mfma_f32_16x16x32_bf16 v[100:103], a[68:71], v[176:179], v[100:103]
  v_mfma_f32_16x16x32_bf16 v[104:107], a[64:67], v[180:183], v[104:107]
  ds_read_b128 v[212:215], v19 offset:10240
  v_mfma_f32_16x16x32_bf16 v[108:111], a[68:71], v[180:183], v[108:111]
  buffer_load_dwordx4 v13, s[8:11], s30 offen offset:3072 lds
  v_mfma_f32_16x16x32_bf16 v[112:115], a[64:67], v[184:187], v[112:115]
  ds_read_b128 v[216:219], v19 offset:12288
  s_add_u32 s30, s30, s25
  v_mfma_f32_16x16x32_bf16 v[116:119], a[68:71], v[184:187], v[116:119]
  s_sub_u32 s30, s30, 1152
  s_add_u32 m0, m0, 16384
  v_mfma_f32_16x16x32_bf16 v[120:123], a[64:67], v[188:191], v[120:123]
  ds_read_b128 v[220:223], v19 offset:14336
  v_mfma_f32_16x16x32_bf16 v[124:127], a[68:71], v[188:191], v[124:127]
  s_waitcnt vmcnt(16) lgkmcnt(4)
  s_barrier
  v_mfma_f32_16x16x32_bf16 v[64:67], a[72:75], v[192:195], v[64:67]
  ds_read_b128 v[160:163], v18 offset:0
  v_mfma_f32_16x16x32_bf16 v[68:71], a[76:79], v[192:195], v[68:71]
  s_cmp_lt_u32 m0, s46
  s_cselect_b32 m0, m0, s47
  v_mfma_f32_16x16x32_bf16 v[72:75], a[72:75], v[196:199], v[72:75]
  ds_read_b128 v[164:167], v18 offset:2048
  v_add_u32 v19, s33, v15
  v_mfma_f32_16x16x32_bf16 v[76:79], a[76:79], v[196:199], v[76:79]
  buffer_load_dwordx4 v10, s[8:11], s30 offen offset:0 lds
  v_mfma_f32_16x16x32_bf16 v[80:83], a[72:75], v[200:203], v[80:83]
  ds_read_b128 v[168:171], v18 offset:4096
  s_add_u32 s33, s33, 16384
  v_mfma_f32_16x16x32_bf16 v[84:87], a[76:79], v[200:203], v[84:87]
  s_cmp_lt_u32 s33, 114688
  s_cselect_b32 s33, s33, 0
  v_mfma_f32_16x16x32_bf16 v[88:91], a[72:75], v[204:207], v[88:91]
  ds_read_b128 v[172:175], v18 offset:6144
  v_mfma_f32_16x16x32_bf16 v[92:95], a[76:79], v[204:207], v[92:95]
  s_waitcnt lgkmcnt(4)
  v_mfma_f32_16x16x32_bf16 v[96:99], a[72:75], v[208:211], v[96:99]
  ds_read_b128 v[176:179], v18 offset:8192
  v_mfma_f32_16x16x32_bf16 v[100:103], a[76:79], v[208:211], v[100:103]
  v_mfma_f32_16x16x32_bf16 v[104:107], a[72:75], v[212:215], v[104:107]
  ds_read_b128 v[180:183], v18 offset:10240
  v_mfma_f32_16x16x32_bf16 v[108:111], a[76:79], v[212:215], v[108:111]
  buffer_load_dwordx4 v11, s[8:11], s30 offen offset:1024 lds
  v_mfma_f32_16x16x32_bf16 v[112:115], a[72:75], v[216:219], v[112:115]
  ds_read_b128 v[184:187], v18 offset:12288
  v_mfma_f32_16x16x32_bf16 v[116:119], a[76:79], v[216:219], v[116:119]
  v_mfma_f32_16x16x32_bf16 v[120:123], a[72:75], v[220:223], v[120:123]
  ds_read_b128 v[188:191], v18 offset:14336
  v_mfma_f32_16x16x32_bf16 v[124:127], a[76:79], v[220:223], v[124:127]
  s_waitcnt lgkmcnt(4)
  v_mfma_f32_16x16x32_bf16 v[64:67], a[80:83], v[160:163], v[64:67]
  ds_read_b128 v[192:195], v19 offset:0
  v_mfma_f32_16x16x32_bf16 v[68:71], a[84:87], v[160:163], v[68:71]
  v_add_u32 v18, s33, v14
  v_mfma_f32_16x16x32_bf16 v[72:75], a[80:83], v[164:167], v[72:75]
  ds_read_b128 v[196:199], v19 offset:2048
  v_mfma_f32_16x16x32_bf16 v[76:79], a[84:87], v[164:167], v[76:79]
  buffer_load_dwordx4 v12, s[8:11], s30 offen offset:2048 lds
  v_mfma_f32_16x16x32_bf16 v[80:83], a[80:83], v[168:171], v[80:83]
  ds_read_b128 v[200:203], v19 offset:4096
  v_mfma_f32_16x16x32_bf16 v[84:87], a[84:87], v[168:171], v[84:87]
  v_mfma_f32_16x16x32_bf16 v[88:91], a[80:83], v[172:175], v[88:91]
  ds_read_b128 v[204:207], v19 offset:6144
  v_mfma_f32_16x16x32_bf16 v[92:95], a[84:87], v[172:175], v[92:95]
  s_waitcnt lgkmcnt(4)
  v_mfma_f32_16x16x32_bf16 v[96:99], a[80:83], v[176:179], v[96:99]
  ds_read_b128 v[208:211], v19 offset:8192
  v_mfma_f32_16x16x32_bf16 v[100:103], a[84:87], v[176:179], v[100:103]
  v_mfma_f32_16x16x32_bf16 v[104:107], a[80:83], v[180:183], v[104:107]
  ds_read_b128 v[212:215], v19 offset:10240
  v_mfma_f32_16x16x32_bf16 v[108:111], a[84:87], v[180:183], v[108:111]
  buffer_load_dwordx4 v13, s[8:11], s30 offen offset:3072 lds
  v_mfma_f32_16x16x32_bf16 v[112:115], a[80:83], v[184:187], v[112:115]
  ds_read_b128 v[216:219], v19 offset:12288
  s_add_u32 s30, s30, 128
  v_mfma_f32_16x16x32_bf16 v[116:119], a[84:87], v[184:187], v[116:119]
  s_add_u32 m0, m0, 16384
  v_mfma_f32_16x16x32_bf16 v[120:123], a[80:83], v[188:191], v[120:123]
  ds_read_b128 v[220:223], v19 offset:14336
  v_mfma_f32_16x16x32_bf16 v[124:127], a[84:87], v[188:191], v[124:127]
  s_waitcnt vmcnt(16) lgkmcnt(4)
  s_barrier
  v_mfma_f32_16x16x32_bf16 v[64:67], a[88:91], v[192:195], v[64:67]
  ds_read_b128 v[160:163], v18 offset:0
  v_mfma_f32_16x16x32_bf16 v[68:71], a[92:95], v[192:195], v[68:71]
  s_cmp_lt_u32 m0, s46
  s_cselect_b32 m0, m0, s47
  v_mfma_f32_16x16x32_bf16 v[72:75], a[88:91], v[196:199], v[72:75]
  ds_read_b128 v[164:167], v18 offset:2048
  v_add_u32 v19, s33, v15
  v_mfma_f32_16x16x32_bf16 v[76:79], a[92:95], v[196:199], v[76:79]
  buffer_load_dwordx4 v10, s[8:11], s30 offen offset:0 lds
  v_mfma_f32_16x16x32_bf16 v[80:83], a[88:91], v[200:203], v[80:83]
  ds_read_b128 v[168:171], v18 offset:4096
  s_add_u32 s33, s33, 16384
  v_mfma_f32_16x16x32_bf16 v[84:87], a[92:95], v[200:203], v[84:87]
  s_cmp_lt_u32 s33, 114688
  s_cselect_b32 s33, s33, 0
  v_mfma_f32_16x16x32_bf16 v[88:91], a[88:91], v[204:207], v[88:91]
  ds_read_b128 v[172:175], v18 offset:6144
  v_mfma_f32_16x16x32_bf16 v[92:95], a[92:95], v[204:207], v[92:95]
  s_waitcnt lgkmcnt(4)
  v_mfma_f32_16x16x32_bf16 v[96:99], a[88:91], v[208:211], v[96:99]
  ds_read_b128 v[176:179], v18 offset:8192
  v_mfma_f32_16x16x32_bf16 v[100:103], a[92:95], v[208:211], v[100:103]
  v_mfma_f32_16x16x32_bf16 v[104:107], a[88:91], v[212:215], v[104:107]
  ds_read_b128 v[180:183], v18 offset:10240
  v_mfma_f32_16x16x32_bf16 v[108:111], a[92:95], v[212:215], v[108:111]
  buffer_load_dwordx4 v11, s[8:11], s30 offen offset:1024 lds
  v_mfma_f32_16x16x32_bf16 v[112:115], a[88:91], v[216:219], v[112:115]
  ds_read_b128 v[184:187], v18 offset:12288
  v_mfma_f32_16x16x32_bf16 v[116:119], a[92:95], v[216:219], v[116:119]
  v_mfma_f32_16x16x32_bf16 v[120:123], a[88:91], v[220:223], v[120:123]
  ds_read_b128 v[188:191], v18 offset:14336
  v_mfma_f32_16x16x32_bf16 v[124:127], a[92:95], v[220:223], v[124:127]
  s_waitcnt lgkmcnt(4)
  v_mfma_f32_16x16x32_bf16 v[64:67], a[96:99], v[160:163], v[64:67]
  ds_read_b128 v[192:195], v19 offset:0
  v_mfma_f32_16x16x32_bf16 v[68:71], a[100:103], v[160:163], v[68:71]
  v_add_u32 v18, s33, v14
  v_mfma_f32_16x16x32_bf16 v[72:75], a[96:99], v[164:167], v[72:75]
  ds_read_b128 v[196:199], v19 offset:2048
  v_mfma_f32_16x16x32_bf16 v[76:79], a[100:103], v[164:167], v[76:79]
  buffer_load_dwordx4 v12, s[8:11], s30 offen offset:2048 lds
  v_mfma_f32_16x16x32_bf16 v[80:83], a[96:99], v[168:171], v[80:83]
  ds_read_b128 v[200:203], v19 offset:4096
  v_mfma_f32_16x16x32_bf16 v[84:87], a[100:103], v[168:171], v[84:87]
  v_mfma_f32_16x16x32_bf16 v[88:91], a[96:99], v[172:175], v[88:91]
  ds_read_b128 v[204:207], v19 offset:6144
  v_mfma_f32_16x16x32_bf16 v[92:95], a[100:103], v[172:175], v[92:95]
  s_waitcnt lgkmcnt(4)
  v_mfma_f32_16x16x32_bf16 v[96:99], a[96:99], v[176:179], v[96:99]
  ds_read_b128 v[208:211], v19 offset:8192
  v_mfma_f32_16x16x32_bf16 v[100:103], a[100:103], v[176:179], v[100:103]
  v_mfma_f32_16x16x32_bf16 v[104:107], a[96:99], v[180:183], v[104:107]
  ds_read_b128 v[212:215], v19 offset:10240
  v_mfma_f32_16x16x32_bf16 v[108:111], a[100:103], v[180:183], v[108:111]
  buffer_load_dwordx4 v13, s[8:11], s30 offen offset:3072 lds
  v_mfma_f32_16x16x32_bf16 v[112:115], a[96:99], v[184:187], v[112:115]
  ds_read_b128 v[216:219], v19 offset:12288
  s_add_u32 s30, s30, 128
  v_mfma_f32_16x16x32_bf16 v[116:119], a[100:103], v[184:187], v[116:119]
  s_add_u32 m0, m0, 16384
  v_mfma_f32_16x16x32_bf16 v[120:123], a[96:99], v[188:191], v[120:123]
  ds_read_b128 v[220:223], v19 offset:14336
  v_mfma_f32_16x16x32_bf16 v[124:127], a[100:103], v[188:191], v[124:127]
  s_waitcnt vmcnt(16) lgkmcnt(4)
  s_barrier
  v_mfma_f32_16x16x32_bf16 v[64:67], a[104:107], v[192:195], v[64:67]
  ds_read_b128 v[160:163], v18 offset:0
  v_mfma_f32_16x16x32_bf16 v[68:71], a[108:111], v[192:195], v[68:71]
  s_cmp_lt_u32 m0, s46
  s_cselect_b32 m0, m0, s47
  v_mfma_f32_16x16x32_bf16 v[72:75], a[104:107], v[196:199], v[72:75]
  ds_read_b128 v[164:167], v18 offset:2048
  v_add_u32 v19, s33, v15
  v_mfma_f32_16x16x32_bf16 v[76:79], a[108:111], v[196:199], v[76:79]
  buffer_load_dwordx4 v10, s[8:11], s30 offen offset:0 lds
  v_mfma_f32_16x16x32_bf16 v[80:83], a[104:107], v[200:203], v[80:83]
  ds_read_b128 v[168:171], v18 offset:4096
  s_add_u32 s33, s33, 16384
  v_mfma_f32_16x16x32_bf16 v[84:87], a[108:111], v[200:203], v[84:87]
  s_cmp_lt_u32 s33, 114688
  s_cselect_b32 s33, s33, 0
  v_mfma_f32_16x16x32_bf16 v[88:91], a[104:107], v[204:207], v[88:91]
  ds_read_b128 v[172:175], v18 offset:6144
  v_mfma_f32_16x16x32_bf16 v[92:95], a[108:111], v[204:207], v[92:95]
  s_waitcnt lgkmcnt(4)
  v_mfma_f32_16x16x32_bf16 v[96:99], a[104:107], v[208:211], v[96:99]
  ds_read_b128 v[176:179], v18 offset:8192
  v_mfma_f32_16x16x32_bf16 v[100:103], a[108:111], v[208:211], v[100:103]
  v_mfma_f32_16x16x32_bf16 v[104:107], a[104:107], v[212:215], v[104:107]
  ds_read_b128 v[180:183], v18 offset:10240
  v_mfma_f32_16x16x32_bf16 v[108:111], a[108:111], v[212:215], v[108:111]
  buffer_load_dwordx4 v11, s[8:11], s30 offen offset:1024 lds
  v_mfma_f32_16x16x32_bf16 v[112:115], a[104:107], v[216:219], v[112:115]
  ds_read_b128 v[184:187], v18 offset:12288
  v_mfma_f32_16x16x32_bf16 v[116:119], a[108:111], v[216:219], v[116:119]
  v_mfma_f32_16x16x32_bf16 v[120:123], a[104:107], v[220:223], v[120:123]
  ds_read_b128 v[188:191], v18 offset:14336
  v_mfma_f32_16x16x32_bf16 v[124:127], a[108:111], v[220:223], v[124:127]
  s_waitcnt lgkmcnt(4)
  v_mfma_f32_16x16x32_bf16 v[64:67], a[112:115], v[160:163], v[64:67]
  ds_read_b128 v[192:195], v19 offset:0
  v_mfma_f32_16x16x32_bf16 v[68:71], a[116:119], v[160:163], v[68:71]
  v_add_u32 v18, s33, v14
  v_mfma_f32_16x16x32_bf16 v[72:75], a[112:115], v[164:167], v[72:75]
  ds_read_b128 v[196:199], v19 offset:2048
  v_mfma_f32_16x16x32_bf16 v[76:79], a[116:119], v[164:167], v[76:79]
  buffer_load_dwordx4 v12, s[8:11], s30 offen offset:2048 lds
  v_mfma_f32_16x16x32_bf16 v[80:83], a[112:115], v[168:171], v[80:83]
  ds_read_b128 v[200:203], v19 offset:4096
  v_mfma_f32_16x16x32_bf16 v[84:87], a[116:119], v[168:171], v[84:87]
  v_mfma_f32_16x16x32_bf16 v[88:91], a[112:115], v[172:175], v[88:91]
  ds_read_b128 v[204:207], v19 offset:6144
  v_mfma_f32_16x16x32_bf16 v[92:95], a[116:119], v[172:175], v[92:95]
  s_waitcnt lgkmcnt(4)
  v_mfma_f32_16x16x32_bf16 v[96:99], a[112:115], v[176:179], v[96:99]
  ds_read_b128 v[208:211], v19 offset:8192
  v_mfma_f32_16x16x32_bf16 v[100:103], a[116:119], v[176:179], v[100:103]
  v_mfma_f32_16x16x32_bf16 v[104:107], a[112:115], v[180:183], v[104:107]
  ds_read_b128 v[212:215], v19 offset:10240
  v_mfma_f32_16x16x32_bf16 v[108:111], a[116:119], v[180:183], v[108:111]
  buffer_load_dwordx4 v13, s[8:11], s30 offen offset:3072 lds
  v_mfma_f32_16x16x32_bf16 v[112:115], a[112:115], v[184:187], v[112:115]
  ds_read_b128 v[216:219], v19 offset:12288
  s_add_u32 s30, s30, 128
  v_mfma_f32_16x16x32_bf16 v[116:119], a[116:119], v[184:187], v[116:119]
  s_add_u32 m0, m0, 16384
  v_mfma_f32_16x16x32_bf16 v[120:123], a[112:115], v[188:191], v[120:123]
  ds_read_b128 v[220:223], v19 offset:14336
  v_mfma_f32_16x16x32_bf16 v[124:127], a[116:119], v[188:191], v[124:127]
  s_waitcnt vmcnt(16) lgkmcnt(4)
  s_barrier
  v_mfma_f32_16x16x32_bf16 v[64:67], a[120:123], v[192:195], v[64:67]
  ds_read_b128 v[160:163], v18 offset:0
  v_mfma_f32_16x16x32_bf16 v[68:71], a[124:127], v[192:195], v[68:71]
  s_cmp_lt_u32 m0, s46
  s_cselect_b32 m0, m0, s47
  v_mfma_f32_16x16x32_bf16 v[72:75], a[120:123], v[196:199], v[72:75]
  ds_read_b128 v[164:167], v18 offset:2048
  v_add_u32 v19, s33, v15
  v_mfma_f32_16x16x32_bf16 v[76:79], a[124:127], v[196:199], v[76:79]
  buffer_load_dwordx4 v10, s[8:11], s30 offen offset:0 lds
  v_mfma_f32_16x16x32_bf16 v[80:83], a[120:123], v[200:203], v[80:83]
  ds_read_b128 v[168:171], v18 offset:4096
  s_add_u32 s33, s33, 16384
  v_mfma_f32_16x16x32_bf16 v[84:87], a[124:127], v[200:203], v[84:87]
  s_cmp_lt_u32 s33, 114688
  s_cselect_b32 s33, s33, 0
  v_mfma_f32_16x16x32_bf16 v[88:91], a[120:123], v[204:207], v[88:91]
  ds_read_b128 v[172:175], v18 offset:6144
  v_mfma_f32_16x16x32_bf16 v[92:95], a[124:127], v[204:207], v[92:95]
  s_waitcnt lgkmcnt(4)
  v_mfma_f32_16x16x32_bf16 v[96:99], a[120:123], v[208:211], v[96:99]
  ds_read_b128 v[176:179], v18 offset:8192
  v_mfma_f32_16x16x32_bf16 v[100:103], a[124:127], v[208:211], v[100:103]
  v_mfma_f32_16x16x32_bf16 v[104:107], a[120:123], v[212:215], v[104:107]
  ds_read_b128 v[180:183], v18 offset:10240
  v_mfma_f32_16x16x32_bf16 v[108:111], a[124:127], v[212:215], v[108:111]
  buffer_load_dwordx4 v11, s[8:11], s30 offen offset:1024 lds
  v_mfma_f32_16x16x32_bf16 v[112:115], a[120:123], v[216:219], v[112:115]
  ds_read_b128 v[184:187], v18 offset:12288
  v_mfma_f32_16x16x32_bf16 v[116:119], a[124:127], v[216:219], v[116:119]
  v_mfma_f32_16x16x32_bf16 v[120:123], a[120:123], v[220:223], v[120:123]
  ds_read_b128 v[188:191], v18 offset:14336
  v_mfma_f32_16x16x32_bf16 v[124:127], a[124:127], v[220:223], v[124:127]
  s_waitcnt lgkmcnt(4)
  v_mfma_f32_16x16x32_bf16 v[64:67], a[128:131], v[160:163], v[64:67]
  ds_read_b128 v[192:195], v19 offset:0
  v_mfma_f32_16x16x32_bf16 v[68:71], a[132:135], v[160:163], v[68:71]
  v_add_u32 v18, s33, v14
  v_mfma_f32_16x16x32_bf16 v[72:75], a[128:131], v[164:167], v[72:75]
  ds_read_b128 v[196:199], v19 offset:2048
  v_mfma_f32_16x16x32_bf16 v[76:79], a[132:135], v[164:167], v[76:79]
  buffer_load_dwordx4 v12, s[8:11], s30 offen offset:2048 lds
  v_mfma_f32_16x16x32_bf16 v[80:83], a[128:131], v[168:171], v[80:83]
  ds_read_b128 v[200:203], v19 offset:4096
  v_mfma_f32_16x16x32_bf16 v[84:87], a[132:135], v[168:171], v[84:87]
  v_mfma_f32_16x16x32_bf16 v[88:91], a[128:131], v[172:175], v[88:91]
  ds_read_b128 v[204:207], v19 offset:6144
  v_mfma_f32_16x16x32_bf16 v[92:95], a[132:135], v[172:175], v[92:95]
  s_waitcnt lgkmcnt(4)
  v_mfma_f32_16x16x32_bf16 v[96:99], a[128:131], v[176:179], v[96:99]
  ds_read_b128 v[208:211], v19 offset:8192
  v_mfma_f32_16x16x32_bf16 v[100:103], a[132:135], v[176:179], v[100:103]
  v_mfma_f32_16x16x32_bf16 v[104:107], a[128:131], v[180:183], v[104:107]
  ds_read_b128 v[212:215], v19 offset:10240
  v_mfma_f32_16x16x32_bf16 v[108:111], a[132:135], v[180:183], v[108:111]
  buffer_load_dwordx4 v13, s[8:11], s30 offen offset:3072 lds
  v_mfma_f32_16x16x32_bf16 v[112:115], a[128:131], v[184:187], v[112:115]
  ds_read_b128 v[216:219], v19 offset:12288
  s_add_u32 s30, s30, 128
  v_mfma_f32_16x16x32_bf16 v[116:119], a[132:135], v[184:187], v[116:119]
  s_add_u32 m0, m0, 16384
  v_mfma_f32_16x16x32_bf16 v[120:123], a[128:131], v[188:191], v[120:123]
  ds_read_b128 v[220:223], v19 offset:14336
  v_mfma_f32_16x16x32_bf16 v[124:127], a[132:135], v[188:191], v[124:127]
  s_waitcnt vmcnt(16) lgkmcnt(4)
  s_barrier
  v_mfma_f32_16x16x32_bf16 v[64:67], a[136:139], v[192:195], v[64:67]
  ds_read_b128 v[160:163], v18 offset:0
  v_mfma_f32_16x16x32_bf16 v[68:71], a[140:143], v[192:195], v[68:71]
  s_cmp_lt_u32 m0, s46
  s_cselect_b32 m0, m0, s47
  v_mfma_f32_16x16x32_bf16 v[72:75], a[136:139], v[196:199], v[72:75]
  ds_read_b128 v[164:167], v18 offset:2048
  v_add_u32 v19, s33, v15
  v_mfma_f32_16x16x32_bf16 v[76:79], a[140:143], v[196:199], v[76:79]
  buffer_load_dwordx4 v10, s[8:11], s30 offen offset:0 lds
  v_mfma_f32_16x16x32_bf16 v[80:83], a[136:139], v[200:203], v[80:83]
  ds_read_b128 v[168:171], v18 offset:4096
  s_add_u32 s33, s33, 16384
  v_mfma_f32_16x16x32_bf16 v[84:87], a[140:143], v[200:203], v[84:87]
  s_cmp_lt_u32 s33, 114688
  s_cselect_b32 s33, s33, 0
  v_mfma_f32_16x16x32_bf16 v[88:91], a[136:139], v[204:207], v[88:91]
  ds_read_b128 v[172:175], v18 offset:6144
  v_mfma_f32_16x16x32_bf16 v[92:95], a[140:143], v[204:207], v[92:95]
  s_waitcnt lgkmcnt(4)
  v_mfma_f32_16x16x32_bf16 v[96:99], a[136:139], v[208:211], v[96:99]
  ds_read_b128 v[176:179], v18 offset:8192
  v_mfma_f32_16x16x32_bf16 v[100:103], a[140:143], v[208:211], v[100:103]
  v_mfma_f32_16x16x32_bf16 v[104:107], a[136:139], v[212:215], v[104:107]
  ds_read_b128 v[180:183], v18 offset:10240
  v_mfma_f32_16x16x32_bf16 v[108:111], a[140:143], v[212:215], v[108:111]
  buffer_load_dwordx4 v11, s[8:11], s30 offen offset:1024 lds
  v_mfma_f32_16x16x32_bf16 v[112:115], a[136:139], v[216:219], v[112:115]
  ds_read_b128 v[184:187], v18 offset:12288
  v_mfma_f32_16x16x32_bf16 v[116:119], a[140:143], v[216:219], v[116:119]
  v_mfma_f32_16x16x32_bf16 v[120:123], a[136:139], v[220:223], v[120:123]
  ds_read_b128 v[188:191], v18 offset:14336
  v_mfma_f32_16x16x32_bf16 v[124:127], a[140:143], v[220:223], v[124:127]
  s_waitcnt lgkmcnt(4)
  v_mfma_f32_16x16x32_bf16 v[64:67], a[144:147], v[160:163], v[64:67]
  ds_read_b128 v[192:195], v19 offset:0
  v_mfma_f32_16x16x32_bf16 v[68:71], a[148:151], v[160:163], v[68:71]
  v_add_u32 v18, s33, v14
  v_mfma_f32_16x16x32_bf16 v[72:75], a[144:147], v[164:167], v[72:75]
  ds_read_b128 v[196:199], v19 offset:2048
  v_mfma_f32_16x16x32_bf16 v[76:79], a[148:151], v[164:167], v[76:79]
  buffer_load_dwordx4 v12, s[8:11], s30 offen offset:2048 lds
  v_mfma_f32_16x16x32_bf16 v[80:83], a[144:147], v[168:171], v[80:83]
  ds_read_b128 v[200:203], v19 offset:4096
  v_mfma_f32_16x16x32_bf16 v[84:87], a[148:151], v[168:171], v[84:87]
  v_mfma_f32_16x16x32_bf16 v[88:91], a[144:147], v[172:175], v[88:91]
  ds_read_b128 v[204:207], v19 offset:6144
  v_mfma_f32_16x16x32_bf16 v[92:95], a[148:151], v[172:175], v[92:95]
  s_waitcnt lgkmcnt(4)
  v_mfma_f32_16x16x32_bf16 v[96:99], a[144:147], v[176:179], v[96:99]
  ds_read_b128 v[208:211], v19 offset:8192
  v_mfma_f32_16x16x32_bf16 v[100:103], a[148:151], v[176:179], v[100:103]
  v_mfma_f32_16x16x32_bf16 v[104:107], a[144:147], v[180:183], v[104:107]
  ds_read_b128 v[212:215], v19 offset:10240
  v_mfma_f32_16x16x32_bf16 v[108:111], a[148:151], v[180:183], v[108:111]
  buffer_load_dwordx4 v13, s[8:11], s30 offen offset:3072 lds
  v_mfma_f32_16x16x32_bf16 v[112:115], a[144:147], v[184:187], v[112:115]
  ds_read_b128 v[216:219], v19 offset:12288
  s_add_u32 s30, s30, 128
  v_mfma_f32_16x16x32_bf16 v[116:119], a[148:151], v[184:187], v[116:119]
  s_add_u32 m0, m0, 16384
  v_mfma_f32_16x16x32_bf16 v[120:123], a[144:147], v[188:191], v[120:123]
  ds_read_b128 v[220:223], v19 offset:14336
  v_mfma_f32_16x16x32_bf16 v[124:127], a[148:151], v[188:191], v[124:127]
  s_waitcnt vmcnt(16) lgkmcnt(4)
  s_barrier
  v_mfma_f32_16x16x32_bf16 v[64:67], a[152:155], v[192:195], v[64:67]
  ds_read_b128 v[160:163], v18 offset:0
  v_mfma_f32_16x16x32_bf16 v[68:71], a[156:159], v[192:195], v[68:71]
  s_cmp_lt_u32 m0, s46
  s_cselect_b32 m0, m0, s47
  v_mfma_f32_16x16x32_bf16 v[72:75], a[152:155], v[196:199], v[72:75]
  ds_read_b128 v[164:167], v18 offset:2048
  v_add_u32 v19, s33, v15
  v_mfma_f32_16x16x32_bf16 v[76:79], a[156:159], v[196:199], v[76:79]
  buffer_load_dwordx4 v10, s[8:11], s30 offen offset:0 lds
  v_cvt_pk_bf16_f32 v224, v64, v65
  v_cvt_pk_bf16_f32 v225, v66, v67
  v_mfma_f32_16x16x32_bf16 v[80:83], a[152:155], v[200:203], v[80:83]
  ds_read_b128 v[168:171], v18 offset:4096
  s_add_u32 s33, s33, 16384
  v_cvt_pk_bf16_f32 v226, v68, v69
  v_cvt_pk_bf16_f32 v227, v70, v71
  v_mfma_f32_16x16x32_bf16 v[84:87], a[156:159], v[200:203], v[84:87]
  s_cmp_lt_u32 s33, 114688
  s_cselect_b32 s33, s33, 0
  ds_write_b64 v22, v[224:225] offset:0
  v_mfma_f32_16x16x32_bf16 v[88:91], a[152:155], v[204:207], v[88:91]
  ds_read_b128 v[172:175], v18 offset:6144
  ds_write_b64 v22, v[226:227] offset:32
  v_cvt_pk_bf16_f32 v230, v72, v73
  v_mfma_f32_16x16x32_bf16 v[92:95], a[156:159], v[204:207], v[92:95]
  s_waitcnt lgkmcnt(6)
  v_cvt_pk_bf16_f32 v231, v74, v75
  v_cvt_pk_bf16_f32 v232, v76, v77
  v_cvt_pk_bf16_f32 v233, v78, v79
  v_mfma_f32_16x16x32_bf16 v[96:99], a[152:155], v[208:211], v[96:99]
  ds_read_b128 v[176:179], v18 offset:8192
  ds_write_b64 v22, v[230:231] offset:4224
  v_mfma_f32_16x16x32_bf16 v[100:103], a[156:159], v[208:211], v[100:103]
  ds_write_b64 v22, v[232:233] offset:4256
  v_cvt_pk_bf16_f32 v224, v80, v81
  v_cvt_pk_bf16_f32 v225, v82, v83
  v_mfma_f32_16x16x32_bf16 v[104:107], a[152:155], v[212:215], v[104:107]
  ds_read_b128 v[180:183], v18 offset:10240
  v_cvt_pk_bf16_f32 v226, v84, v85
  v_cvt_pk_bf16_f32 v227, v86, v87
  v_mfma_f32_16x16x32_bf16 v[108:111], a[156:159], v[212:215], v[108:111]
  buffer_load_dwordx4 v11, s[8:11], s30 offen offset:1024 lds
  ds_write_b64 v22, v[224:225] offset:8448
  v_mfma_f32_16x16x32_bf16 v[112:115], a[152:155], v[216:219], v[112:115]
  ds_read_b128 v[184:187], v18 offset:12288
  ds_write_b64 v22, v[226:227] offset:8480
  v_cvt_pk_bf16_f32 v230, v88, v89
  v_mfma_f32_16x16x32_bf16 v[116:119], a[156:159], v[216:219], v[116:119]
  v_cvt_pk_bf16_f32 v231, v90, v91
  v_cvt_pk_bf16_f32 v232, v92, v93
  v_cvt_pk_bf16_f32 v233, v94, v95
  v_mfma_f32_16x16x32_bf16 v[120:123], a[152:155], v[220:223], v[120:123]
  ds_read_b128 v[188:191], v18 offset:14336
  ds_write_b64 v22, v[230:231] offset:12672
  v_mfma_f32_16x16x32_bf16 v[124:127], a[156:159], v[220:223], v[124:127]
  ds_write_b64 v22, v[232:233] offset:12704
  v_cvt_pk_bf16_f32 v224, v96, v97
  v_cvt_pk_bf16_f32 v225, v98, v99
  v_cvt_pk_bf16_f32 v226, v100, v101
  v_cvt_pk_bf16_f32 v227, v102, v103
  ds_write_b64 v22, v[224:225] offset:16896
  ds_write_b64 v22, v[226:227] offset:16928
  v_cvt_pk_bf16_f32 v230, v104, v105
  v_cvt_pk_bf16_f32 v231, v106, v107
  v_cvt_pk_bf16_f32 v232, v108, v109
  v_cvt_pk_bf16_f32 v233, v110, v111
  ds_write_b64 v22, v[230:231] offset:21120
  ds_write_b64 v22, v[232:233] offset:21152
  v_cvt_pk_bf16_f32 v224, v112, v113
  v_cvt_pk_bf16_f32 v225, v114, v115
  v_cvt_pk_bf16_f32 v226, v116, v117
  v_cvt_pk_bf16_f32 v227, v118, v119
  ds_write_b64 v22, v[224:225] offset:25344
  ds_write_b64 v22, v[226:227] offset:25376
  v_cvt_pk_bf16_f32 v230, v120, v121
  v_cvt_pk_bf16_f32 v231, v122, v123
  v_cvt_pk_bf16_f32 v232, v124, v125
  v_cvt_pk_bf16_f32 v233, v126, v127
  ds_write_b64 v22, v[230:231] offset:29568
  ds_write_b64 v22, v[232:233] offset:29600
  s_waitcnt lgkmcnt(0)
  s_barrier
  ds_read_b64 v[144:145], v34 offset:1848
  ds_read_b64 v[146:147], v34 offset:1856
  ds_read_b64 v[148:149], v34 offset:1864
  ds_read_b64 v[150:151], v34 offset:1872
  ds_read_b64 v[152:153], v34 offset:1880
  ds_read_b64 v[64:65], v34 offset:1928
  ds_read_b64 v[66:67], v34 offset:1936
  ds_read_b64 v[68:69], v34 offset:1944
  ds_read_b64 v[70:71], v34 offset:1952
  ds_read_b64 v[72:73], v34 offset:1960
  ds_read_b64 v[74:75], v34 offset:1664
  ds_read_b64 v[76:77], v34 offset:1672
  ds_read_b64 v[78:79], v34 offset:1680
  ds_read_b64 v[80:81], v34 offset:1688
  ds_read_b64 v[82:83], v34 offset:1696
  ds_read_b64 v[84:85], v34 offset:1400
  ds_read_b64 v[86:87], v34 offset:1408
  ds_read_b64 v[88:89], v34 offset:1416
  ds_read_b64 v[90:91], v34 offset:1424
  ds_read_b64 v[92:93], v34 offset:1432
  ds_read_b64 v[94:95], v34 offset:1136
  ds_read_b64 v[96:97], v34 offset:1144
  ds_read_b64 v[98:99], v34 offset:1152
  ds_read_b64 v[100:101], v34 offset:1160
  ds_read_b64 v[102:103], v34 offset:1168
  ds_read_b64 v[104:105], v34 offset:872
  ds_read_b64 v[106:107], v34 offset:880
  ds_read_b64 v[108:109], v34 offset:888
  ds_read_b64 v[110:111], v34 offset:896
  ds_read_b64 v[112:113], v34 offset:904
  v_mov_b32 v224, 0
  v_mov_b32 v225, 0
  ds_read_b64 v[114:115], v34 offset:608
  ds_read_b64 v[116:117], v34 offset:616
  ds_read_b64 v[118:119], v34 offset:624
  ds_read_b64 v[120:121], v34 offset:632
  ds_read_b64 v[122:123], v34 offset:640
  v_mov_b32 v226, 0
  v_mov_b32 v227, 0
  ds_read_b64 v[124:125], v34 offset:344
  ds_read_b64 v[126:127], v34 offset:352
  ds_read_b64 v[128:129], v34 offset:360
  ds_read_b64 v[130:131], v34 offset:368
  ds_read_b64 v[132:133], v34 offset:376
  v_mov_b32 v228, 0
  v_mov_b32 v229, 0
  ds_read_b64 v[134:135], v34 offset:80
  ds_read_b64 v[136:137], v34 offset:88
  ds_read_b64 v[138:139], v34 offset:96
  ds_read_b64 v[140:141], v34 offset:104
  ds_read_b64 v[142:143], v34 offset:112
  v_mov_b32 v230, 0
  v_mov_b32 v231, 0
  v_mov_b32 v192, 0
  v_mov_b32 v193, 0
  v_mov_b32 v194, 0
  v_mov_b32 v195, 0
  v_mov_b32 v196, 0
  v_mov_b32 v197, 0
  v_mov_b32 v198, 0
  v_mov_b32 v199, 0
  v_mov_b32 v200, 0
  v_mov_b32 v201, 0
  v_mov_b32 v202, 0
  v_mov_b32 v203, 0
  v_mov_b32 v204, 0
  v_mov_b32 v205, 0
  v_mov_b32 v206, 0
  v_mov_b32 v207, 0
  v_mov_b32 v208, 0
  v_mov_b32 v209, 0
  v_mov_b32 v210, 0
  v_mov_b32 v211, 0
  s_waitcnt lgkmcnt(15)
  v_dot2c_f32_bf16 v224, v64, v144
  v_dot2c_f32_bf16 v225, v74, v144
  v_dot2c_f32_bf16 v226, v84, v144
  v_dot2c_f32_bf16 v227, v94, v144
  v_dot2c_f32_bf16 v228, v104, v144
  v_dot2c_f32_bf16 v224, v65, v145
  v_dot2c_f32_bf16 v225, v75, v145
  v_dot2c_f32_bf16 v226, v85, v145
  v_dot2c_f32_bf16 v227, v95, v145
  v_dot2c_f32_bf16 v228, v105, v145
  v_dot2c_f32_bf16 v224, v66, v146
  v_dot2c_f32_bf16 v225, v76, v146
  v_dot2c_f32_bf16 v226, v86, v146
  v_dot2c_f32_bf16 v227, v96, v146
  v_dot2c_f32_bf16 v228, v106, v146
  v_dot2c_f32_bf16 v224, v67, v147
  v_dot2c_f32_bf16 v225, v77, v147
  v_dot2c_f32_bf16 v226, v87, v147
  v_dot2c_f32_bf16 v227, v97, v147
  v_dot2c_f32_bf16 v228, v107, v147
  v_dot2c_f32_bf16 v224, v68, v148
  v_dot2c_f32_bf16 v225, v78, v148
  v_dot2c_f32_bf16 v226, v88, v148
  v_dot2c_f32_bf16 v227, v98, v148
  v_dot2c_f32_bf16 v228, v108, v148
  v_dot2c_f32_bf16 v224, v69, v149
  v_dot2c_f32_bf16 v225, v79, v149
  v_dot2c_f32_bf16 v226, v89, v149
  v_dot2c_f32_bf16 v227, v99, v149
  v_dot2c_f32_bf16 v228, v109, v149
  v_dot2c_f32_bf16 v224, v70, v150
  v_dot2c_f32_bf16 v225, v80, v150
  v_dot2c_f32_bf16 v226, v90, v150
  v_dot2c_f32_bf16 v227, v100, v150
  v_dot2c_f32_bf16 v228, v110, v150
  v_dot2c_f32_bf16 v224, v71, v151
  v_dot2c_f32_bf16 v225, v81, v151
  v_dot2c_f32_bf16 v226, v91, v151
  v_dot2c_f32_bf16 v227, v101, v151
  v_dot2c_f32_bf16 v228, v111, v151
  v_dot2c_f32_bf16 v224, v72, v152
  v_dot2c_f32_bf16 v225, v82, v152
  v_dot2c_f32_bf16 v226, v92, v152
  v_dot2c_f32_bf16 v227, v102, v152
  v_dot2c_f32_bf16 v228, v112, v152
  v_dot2c_f32_bf16 v224, v73, v153
  v_dot2c_f32_bf16 v225, v83, v153
  v_dot2c_f32_bf16 v226, v93, v153
  v_dot2c_f32_bf16 v227, v103, v153
  v_dot2c_f32_bf16 v228, v113, v153
  s_waitcnt lgkmcnt(0)
  v_dot2c_f32_bf16 v229, v114, v144
  v_dot2c_f32_bf16 v230, v124, v144
  v_dot2c_f32_bf16 v231, v134, v144
  v_dot2c_f32_bf16 v229, v115, v145
  v_dot2c_f32_bf16 v230, v125, v145
  v_dot2c_f32_bf16 v231, v135, v145
  v_dot2c_f32_bf16 v229, v116, v146
  v_dot2c_f32_bf16 v230, v126, v146
  v_dot2c_f32_bf16 v231, v136, v146
  v_dot2c_f32_bf16 v229, v117, v147
  v_dot2c_f32_bf16 v230, v127, v147
  v_dot2c_f32_bf16 v231, v137, v147
  v_dot2c_f32_bf16 v229, v118, v148
  v_dot2c_f32_bf16 v230, v128, v148
  v_dot2c_f32_bf16 v231, v138, v148
  v_dot2c_f32_bf16 v229, v119, v149
  v_dot2c_f32_bf16 v230, v129, v149
  v_dot2c_f32_bf16 v231, v139, v149
  v_dot2c_f32_bf16 v229, v120, v150
  v_dot2c_f32_bf16 v230, v130, v150
  v_dot2c_f32_bf16 v231, v140, v150
  v_dot2c_f32_bf16 v229, v121, v151
  v_dot2c_f32_bf16 v230, v131, v151
  v_dot2c_f32_bf16 v231, v141, v151
  v_dot2c_f32_bf16 v229, v122, v152
  v_dot2c_f32_bf16 v230, v132, v152
  v_dot2c_f32_bf16 v231, v142, v152
  v_dot2c_f32_bf16 v229, v123, v153
  v_dot2c_f32_bf16 v230, v133, v153
  v_dot2c_f32_bf16 v231, v143, v153
  ds_read_b64 v[64:65], v38 offset:2008
  ds_read_b64 v[66:67], v38 offset:2016
  ds_read_b64 v[68:69], v38 offset:2024
  ds_read_b64 v[70:71], v38 offset:2032
  ds_read_b64 v[72:73], v39 offset:2040
  ds_read_b64 v[74:75], v38 offset:1744
  ds_read_b64 v[76:77], v38 offset:1752
  ds_read_b64 v[78:79], v38 offset:1760
  ds_read_b64 v[80:81], v38 offset:1768
  ds_read_b64 v[82:83], v39 offset:1776
  ds_read_b64 v[84:85], v38 offset:1480
  ds_read_b64 v[86:87], v38 offset:1488
  ds_read_b64 v[88:89], v38 offset:1496
  ds_read_b64 v[90:91], v38 offset:1504
  ds_read_b64 v[92:93], v39 offset:1512
  ds_read_b64 v[94:95], v38 offset:1216
  ds_read_b64 v[96:97], v38 offset:1224
  ds_read_b64 v[98:99], v38 offset:1232
  ds_read_b64 v[100:101], v38 offset:1240
  ds_read_b64 v[102:103], v39 offset:1248
  ds_read_b64 v[104:105], v38 offset:952
  ds_read_b64 v[106:107], v38 offset:960
  ds_read_b64 v[108:109], v38 offset:968
  ds_read_b64 v[110:111], v38 offset:976
  ds_read_b64 v[112:113], v39 offset:984
  ds_read_b64 v[114:115], v38 offset:688
  ds_read_b64 v[116:117], v38 offset:696
  ds_read_b64 v[118:119], v38 offset:704
  ds_read_b64 v[120:121], v38 offset:712
  ds_read_b64 v[122:123], v39 offset:720
  ds_read_b64 v[124:125], v38 offset:424
  ds_read_b64 v[126:127], v38 offset:432
  ds_read_b64 v[128:129], v38 offset:440
  ds_read_b64 v[130:131], v38 offset:448
  ds_read_b64 v[132:133], v39 offset:456
  ds_read_b64 v[134:135], v38 offset:160
  ds_read_b64 v[136:137], v38 offset:168
  ds_read_b64 v[138:139], v38 offset:176
  ds_read_b64 v[140:141], v38 offset:184
  ds_read_b64 v[142:143], v39 offset:192
  v_cvt_pk_bf16_f32 v4, v224, v225
  v_lshlrev_b32 v224, 16, v4
  v_and_b32 v225, 0xffff0000, v4
  v_mul_f32 v224, s60, v224
  v_mul_f32 v225, s60, v225
  v_cvt_pk_bf16_f32 v4, v224, v225
  v_lshlrev_b32 v224, 16, v4
  v_and_b32 v225, 0xffff0000, v4
  v_cndmask_b32 v224, v37, v224, s[76:77]
  v_cndmask_b32 v225, v37, v225, s[78:79]
  v_cvt_pk_bf16_f32 v4, v226, v227
  v_lshlrev_b32 v226, 16, v4
  v_and_b32 v227, 0xffff0000, v4
  v_mul_f32 v226, s60, v226
  v_mul_f32 v227, s60, v227
  v_cvt_pk_bf16_f32 v4, v226, v227
  v_lshlrev_b32 v226, 16, v4
  v_and_b32 v227, 0xffff0000, v4
  v_cndmask_b32 v226, v37, v226, s[80:81]
  v_cndmask_b32 v227, v37, v227, s[82:83]
  v_cvt_pk_bf16_f32 v4, v228, v229
  v_lshlrev_b32 v228, 16, v4
  v_and_b32 v229, 0xffff0000, v4
  v_mul_f32 v228, s60, v228
  v_mul_f32 v229, s60, v229
  v_cvt_pk_bf16_f32 v4, v228, v229
  v_lshlrev_b32 v228, 16, v4
  v_and_b32 v229, 0xffff0000, v4
  v_cndmask_b32 v228, v37, v228, s[84:85]
  v_cndmask_b32 v229, v37, v229, s[86:87]
  v_cvt_pk_bf16_f32 v4, v230, v231
  v_lshlrev_b32 v230, 16, v4
  v_and_b32 v231, 0xffff0000, v4
  v_mul_f32 v230, s60, v230
  v_mul_f32 v231, s60, v231
  v_cvt_pk_bf16_f32 v4, v230, v231
  v_lshlrev_b32 v230, 16, v4
  v_and_b32 v231, 0xffff0000, v4
  v_cndmask_b32 v230, v37, v230, s[88:89]
  v_cndmask_b32 v231, v37, v231, s[90:91]
  v_max3_f32 v5, v224, v225, v226
  v_max3_f32 v5, v5, v227, v228
  v_max3_f32 v5, v5, v229, v230
  v_max_f32 v5, v5, v231
  v_sub_f32 v224, v224, v5
  v_mul_f32 v224, s61, v224
  v_exp_f32 v224, v224
  v_sub_f32 v225, v225, v5
  v_mul_f32 v225, s61, v225
  v_exp_f32 v225, v225
  v_sub_f32 v226, v226, v5
  v_mul_f32 v226, s61, v226
  v_exp_f32 v226, v226
  v_sub_f32 v227, v227, v5
  v_mul_f32 v227, s61, v227
  v_exp_f32 v227, v227
  v_sub_f32 v228, v228, v5
  v_mul_f32 v228, s61, v228
  v_exp_f32 v228, v228
  v_sub_f32 v229, v229, v5
  v_mul_f32 v229, s61, v229
  v_exp_f32 v229, v229
  v_sub_f32 v230, v230, v5
  v_mul_f32 v230, s61, v230
  v_exp_f32 v230, v230
  v_sub_f32 v231, v231, v5
  v_mul_f32 v231, s61, v231
  v_exp_f32 v231, v231
  s_nop 0
  v_add_f32 v5, v224, v225
  v_add_f32 v5, v5, v226
  v_add_f32 v5, v5, v227
  v_add_f32 v5, v5, v228
  v_add_f32 v5, v5, v229
  v_add_f32 v5, v5, v230
  v_add_f32 v5, v5, v231
  v_rcp_f32 v5, v5
  s_nop 0
  v_mul_f32 v224, v224, v5
  v_mul_f32 v225, v225, v5
  v_mul_f32 v226, v226, v5
  v_mul_f32 v227, v227, v5
  v_mul_f32 v228, v228, v5
  v_mul_f32 v229, v229, v5
  v_mul_f32 v230, v230, v5
  v_mul_f32 v231, v231, v5
  v_cvt_pk_bf16_f32 v232, v224, v225
  v_cvt_pk_bf16_f32 v233, v226, v227
  v_cvt_pk_bf16_f32 v234, v228, v229
  v_cvt_pk_bf16_f32 v235, v230, v231
  s_waitcnt lgkmcnt(15)
  v_perm_b32 v236, v74, v64, s62
  v_perm_b32 v237, v74, v64, s63
  v_dot2c_f32_bf16 v192, v236, v232
  v_dot2c_f32_bf16 v193, v237, v232
  v_perm_b32 v238, v75, v65, s62
  v_perm_b32 v239, v75, v65, s63
  v_dot2c_f32_bf16 v194, v238, v232
  v_dot2c_f32_bf16 v195, v239, v232
  v_perm_b32 v240, v76, v66, s62
  v_perm_b32 v241, v76, v66, s63
  v_dot2c_f32_bf16 v196, v240, v232
  v_dot2c_f32_bf16 v197, v241, v232
  v_perm_b32 v242, v77, v67, s62
  v_perm_b32 v243, v77, v67, s63
  v_dot2c_f32_bf16 v198, v242, v232
  v_dot2c_f32_bf16 v199, v243, v232
  v_perm_b32 v236, v78, v68, s62
  v_perm_b32 v237, v78, v68, s63
  v_dot2c_f32_bf16 v200, v236, v232
  v_dot2c_f32_bf16 v201, v237, v232
  v_perm_b32 v238, v79, v69, s62
  v_perm_b32 v239, v79, v69, s63
  v_dot2c_f32_bf16 v202, v238, v232
  v_dot2c_f32_bf16 v203, v239, v232
  v_perm_b32 v240, v80, v70, s62
  v_perm_b32 v241, v80, v70, s63
  v_dot2c_f32_bf16 v204, v240, v232
  v_dot2c_f32_bf16 v205, v241, v232
  v_perm_b32 v242, v81, v71, s62
  v_perm_b32 v243, v81, v71, s63
  v_dot2c_f32_bf16 v206, v242, v232
  v_dot2c_f32_bf16 v207, v243, v232
  v_perm_b32 v236, v82, v72, s62
  v_perm_b32 v237, v82, v72, s63
  v_dot2c_f32_bf16 v208, v236, v232
  v_dot2c_f32_bf16 v209, v237, v232
  v_perm_b32 v238, v83, v73, s62
  v_perm_b32 v239, v83, v73, s63
  v_dot2c_f32_bf16 v210, v238, v232
  v_dot2c_f32_bf16 v211, v239, v232
  s_waitcnt lgkmcnt(15)
  v_perm_b32 v236, v94, v84, s62
  v_perm_b32 v237, v94, v84, s63
  v_dot2c_f32_bf16 v192, v236, v233
  v_dot2c_f32_bf16 v193, v237, v233
  v_perm_b32 v238, v95, v85, s62
  v_perm_b32 v239, v95, v85, s63
  v_dot2c_f32_bf16 v194, v238, v233
  v_dot2c_f32_bf16 v195, v239, v233
  v_perm_b32 v240, v96, v86, s62
  v_perm_b32 v241, v96, v86, s63
  v_dot2c_f32_bf16 v196, v240, v233
  v_dot2c_f32_bf16 v197, v241, v233
  v_perm_b32 v242, v97, v87, s62
  v_perm_b32 v243, v97, v87, s63
  v_dot2c_f32_bf16 v198, v242, v233
  v_dot2c_f32_bf16 v199, v243, v233
  v_perm_b32 v236, v98, v88, s62
  v_perm_b32 v237, v98, v88, s63
  v_dot2c_f32_bf16 v200, v236, v233
  v_dot2c_f32_bf16 v201, v237, v233
  v_perm_b32 v238, v99, v89, s62
  v_perm_b32 v239, v99, v89, s63
  v_dot2c_f32_bf16 v202, v238, v233
  v_dot2c_f32_bf16 v203, v239, v233
  v_perm_b32 v240, v100, v90, s62
  v_perm_b32 v241, v100, v90, s63
  v_dot2c_f32_bf16 v204, v240, v233
  v_dot2c_f32_bf16 v205, v241, v233
  v_perm_b32 v242, v101, v91, s62
  v_perm_b32 v243, v101, v91, s63
  v_dot2c_f32_bf16 v206, v242, v233
  v_dot2c_f32_bf16 v207, v243, v233
  v_perm_b32 v236, v102, v92, s62
  v_perm_b32 v237, v102, v92, s63
  v_dot2c_f32_bf16 v208, v236, v233
  v_dot2c_f32_bf16 v209, v237, v233
  v_perm_b32 v238, v103, v93, s62
  v_perm_b32 v239, v103, v93, s63
  v_dot2c_f32_bf16 v210, v238, v233
  v_dot2c_f32_bf16 v211, v239, v233
  s_waitcnt lgkmcnt(10)
  v_perm_b32 v236, v114, v104, s62
  v_perm_b32 v237, v114, v104, s63
  v_dot2c_f32_bf16 v192, v236, v234
  v_dot2c_f32_bf16 v193, v237, v234
  v_perm_b32 v238, v115, v105, s62
  v_perm_b32 v239, v115, v105, s63
  v_dot2c_f32_bf16 v194, v238, v234
  v_dot2c_f32_bf16 v195, v239, v234
  v_perm_b32 v240, v116, v106, s62
  v_perm_b32 v241, v116, v106, s63
  v_dot2c_f32_bf16 v196, v240, v234
  v_dot2c_f32_bf16 v197, v241, v234
  v_perm_b32 v242, v117, v107, s62
  v_perm_b32 v243, v117, v107, s63
  v_dot2c_f32_bf16 v198, v242, v234
  v_dot2c_f32_bf16 v199, v243, v234
  v_perm_b32 v236, v118, v108, s62
  v_perm_b32 v237, v118, v108, s63
  v_dot2c_f32_bf16 v200, v236, v234
  v_dot2c_f32_bf16 v201, v237, v234
  v_perm_b32 v238, v119, v109, s62
  v_perm_b32 v239, v119, v109, s63
  v_dot2c_f32_bf16 v202, v238, v234
  v_dot2c_f32_bf16 v203, v239, v234
  v_perm_b32 v240, v120, v110, s62
  v_perm_b32 v241, v120, v110, s63
  v_dot2c_f32_bf16 v204, v240, v234
  v_dot2c_f32_bf16 v205, v241, v234
  v_perm_b32 v242, v121, v111, s62
  v_perm_b32 v243, v121, v111, s63
  v_dot2c_f32_bf16 v206, v242, v234
  v_dot2c_f32_bf16 v207, v243, v234
  v_perm_b32 v236, v122, v112, s62
  v_perm_b32 v237, v122, v112, s63
  v_dot2c_f32_bf16 v208, v236, v234
  v_dot2c_f32_bf16 v209, v237, v234
  v_perm_b32 v238, v123, v113, s62
  v_perm_b32 v239, v123, v113, s63
  v_dot2c_f32_bf16 v210, v238, v234
  v_dot2c_f32_bf16 v211, v239, v234
  s_waitcnt lgkmcnt(0)
  v_perm_b32 v236, v134, v124, s62
  v_perm_b32 v237, v134, v124, s63
  v_dot2c_f32_bf16 v192, v236, v235
  v_dot2c_f32_bf16 v193, v237, v235
  v_perm_b32 v238, v135, v125, s62
  v_perm_b32 v239, v135, v125, s63
  v_dot2c_f32_bf16 v194, v238, v235
  v_dot2c_f32_bf16 v195, v239, v235
  v_perm_b32 v240, v136, v126, s62
  v_perm_b32 v241, v136, v126, s63
  v_dot2c_f32_bf16 v196, v240, v235
  v_dot2c_f32_bf16 v197, v241, v235
  v_perm_b32 v242, v137, v127, s62
  v_perm_b32 v243, v137, v127, s63
  v_dot2c_f32_bf16 v198, v242, v235
  v_dot2c_f32_bf16 v199, v243, v235
  v_perm_b32 v236, v138, v128, s62
  v_perm_b32 v237, v138, v128, s63
  v_dot2c_f32_bf16 v200, v236, v235
  v_dot2c_f32_bf16 v201, v237, v235
  v_perm_b32 v238, v139, v129, s62
  v_perm_b32 v239, v139, v129, s63
  v_dot2c_f32_bf16 v202, v238, v235
  v_dot2c_f32_bf16 v203, v239, v235
  v_perm_b32 v240, v140, v130, s62
  v_perm_b32 v241, v140, v130, s63
  v_dot2c_f32_bf16 v204, v240, v235
  v_dot2c_f32_bf16 v205, v241, v235
  v_perm_b32 v242, v141, v131, s62
  v_perm_b32 v243, v141, v131, s63
  v_dot2c_f32_bf16 v206, v242, v235
  v_dot2c_f32_bf16 v207, v243, v235
  v_perm_b32 v236, v142, v132, s62
  v_perm_b32 v237, v142, v132, s63
  v_dot2c_f32_bf16 v208, v236, v235
  v_dot2c_f32_bf16 v209, v237, v235
  v_perm_b32 v238, v143, v133, s62
  v_perm_b32 v239, v143, v133, s63
  v_dot2c_f32_bf16 v210, v238, v235
  v_dot2c_f32_bf16 v211, v239, v235
  s_cmp_lg_u32 s20, 0
  s_cbranch_scc1 bh_199
  ds_read_b64 v[64:65], v35 offset:33792
  ds_read_b64 v[66:67], v35 offset:34304
  ds_read_b64 v[68:69], v35 offset:34816
  ds_read_b64 v[70:71], v35 offset:35328
  ds_read_b64 v[72:73], v35 offset:35840
  s_waitcnt lgkmcnt(0)
  ds_write_b64 v35, v[64:65] offset:0
  ds_write_b64 v35, v[66:67] offset:512
  ds_write_b64 v35, v[68:69] offset:1024
  ds_write_b64 v35, v[70:71] offset:1536
  ds_write_b64 v35, v[72:73] offset:2048
bh_199:
  s_nop 1
  v_cvt_pk_bf16_f32 v244, v192, v193
  v_cvt_pk_bf16_f32 v245, v194, v195
  v_cvt_pk_bf16_f32 v246, v196, v197
  v_cvt_pk_bf16_f32 v247, v198, v199
  v_cvt_pk_bf16_f32 v248, v200, v201
  v_cvt_pk_bf16_f32 v249, v202, v203
  v_cvt_pk_bf16_f32 v250, v204, v205
  v_cvt_pk_bf16_f32 v251, v206, v207
  v_cvt_pk_bf16_f32 v252, v208, v209
  v_cvt_pk_bf16_f32 v253, v210, v211
  buffer_store_dwordx4 v[244:247], v29, s[16:19], s27 offen sc1
  buffer_store_dwordx4 v[248:251], v30, s[16:19], s27 offen sc1
  buffer_store_dwordx2 v[252:253], v31, s[16:19], s27 offen sc1
  s_add_u32 s27, s27, 2048
  s_mov_b64 s[78:79], -1
  s_mov_b64 s[80:81], -1
  s_mov_b64 s[82:83], -1
  s_mov_b64 s[84:85], -1
  s_mov_b64 s[86:87], -1
  s_mov_b64 s[88:89], -1
  s_mov_b64 s[90:91], -1
  s_sub_u32 s26, s26, 1
  s_cmp_gt_u32 s26, 0
  s_waitcnt lgkmcnt(0)
  s_cbranch_scc1 bf_blk_198
  s_waitcnt vmcnt(0) lgkmcnt(0)
  s_load_dwordx2 s[32:33], s[0:1], 96
  s_waitcnt lgkmcnt(0)
  s_mov_b32 s32, s32
  s_mov_b32 s33, s33
  s_mov_b32 s34, 256
  s_mov_b32 s35, 0x00020000
  s_mov_b32 s21, 76
  s_cmp_lg_u32 s20, 0
  s_cbranch_scc1 wf_201
  v_mov_b32 v4, 0
  s_mov_b32 s101, 0
wf_200:
  buffer_load_dword v5, v4, s[32:35], s21 offen sc1
  s_add_u32 s101, s101, 1
  s_cmp_gt_u32 s101, 131072
  s_cbranch_scc1 main_end
  s_waitcnt vmcnt(0)
  v_readfirstlane_b32 s100, v5
  s_cmp_ge_u32 s100, 32
  s_cbranch_scc1 wf_201
  s_sleep 8
  s_branch wf_200
wf_201:
  s_barrier
  s_load_dwordx2 s[12:13], s[0:1], 72
  s_lshl_b32 s21, s2, 2
  s_add_u32 s21, s21, s20
  s_mul_i32 s21, s21, 6400
  s_add_u32 s22, s21, 4096
  v_lshlrev_b32 v5, 4, v1
  s_mov_b32 s14, 819200
  s_waitcnt lgkmcnt(0)
  buffer_load_dwordx4 v[40:43], v5, s[12:15], s21 offen offset:0
  buffer_load_dwordx4 v[40:43], v5, s[12:15], s21 offen offset:1024
  buffer_load_dwordx4 v[40:43], v5, s[12:15], s21 offen offset:2048
  buffer_load_dwordx4 v[40:43], v5, s[12:15], s21 offen offset:3072
  buffer_load_dwordx4 v[40:43], v5, s[12:15], s22 offen offset:0
  buffer_load_dwordx4 v[40:43], v5, s[12:15], s22 offen offset:1024
  buffer_load_dwordx4 v[40:43], v5, s[12:15], s22 offen offset:2048
  s_mov_b32 s21, 92160
  s_cmp_lg_u32 s20, 0
  s_cbranch_scc1 af_202
  v_mov_b32 v4, 0
  v_mov_b32 v5, 1
  s_mov_b64 exec, 1
  buffer_atomic_add v5, v4, s[72:75], s21 offen sc1
  s_mov_b64 exec, -1
  s_nop 1
af_202:
  s_barrier
  s_mov_b32 s84, 0
  s_mov_b32 s85, -1
  s_load_dwordx2 s[4:5], s[0:1], 0
  s_load_dwordx2 s[6:7], s[0:1], 16
  s_load_dwordx2 s[38:39], s[0:1], 104
  s_mov_b32 s42, s2
  s_mov_b32 s41, 0
  s_waitcnt lgkmcnt(0)
  s_mov_b32 s8, s4
  s_mov_b32 s9, s5
  s_mov_b32 s10, 2621440
  s_mov_b32 s11, 0x00020000
  s_mov_b32 s12, s6
  s_mov_b32 s13, s7
  s_mov_b32 s14, 7864320
  s_mov_b32 s15, 0x00020000
  s_mov_b32 s16, s38
  s_mov_b32 s17, s39
  s_mov_b32 s18, 50331648
  s_mov_b32 s19, 0x00020000
  s_add_u32 s52, s38, 50331648
  s_addc_u32 s53, s39, 0
  s_mov_b32 s54, 6291456
  s_mov_b32 s55, 0x00020000
  s_add_u32 s56, s38, 85983232
  s_addc_u32 s57, s39, 0
  s_mov_b32 s58, 6815744
  s_mov_b32 s59, 0x00020000
  s_load_dwordx2 s[72:73], s[0:1], 104
  s_waitcnt lgkmcnt(0)
  s_add_u32 s72, s72, 81068032
  s_addc_u32 s73, s73, 0
  s_mov_b32 s74, 117760
  s_mov_b32 s75, 0x00020000
  s_mul_i32 s44, s42, 384
  v_mov_b32 v9, 2731
  v_add_u32 v8, 0, v1
  v_mul_u32_u24 v7, v8, v9
  v_lshrrev_b32 v7, 16, v7
  v_mul_u32_u24 v4, 24, v7
  v_sub_u32 v8, v8, v4
  s_mov_b32 s21, 12288
  v_mul_lo_u32 v7, v7, s21
  v_lshl_add_u32 v4, v8, 4, v7
  v_add_u32 v8, 64, v1
  v_mul_u32_u24 v7, v8, v9
  v_lshrrev_b32 v7, 16, v7
  v_mul_u32_u24 v5, 24, v7
  v_sub_u32 v8, v8, v5
  s_mov_b32 s21, 12288
  v_mul_lo_u32 v7, v7, s21
  v_lshl_add_u32 v5, v8, 4, v7
  v_add_u32 v8, 128, v1
  v_mul_u32_u24 v7, v8, v9
  v_lshrrev_b32 v7, 16, v7
  v_mul_u32_u24 v6, 24, v7
  v_sub_u32 v8, v8, v6
  s_mov_b32 s21, 12288
  v_mul_lo_u32 v7, v7, s21
  v_lshl_add_u32 v6, v8, 4, v7
  v_lshrrev_b32 v7, 2, v2
  v_lshl_add_u32 v7, v3, 3, v7
  v_mul_u32_u24 v7, 384, v7
  v_and_b32 v8, 3, v2
  v_lshlrev_b32 v8, 3, v8
  s_mul_i32 s21, s20, 96
  v_add3_u32 v7, v7, v8, s21
  v_add_u32 v8, 61440, v7
  s_mul_i32 s21, s20, 491520
  s_add_u32 s21, s21, 0
  s_add_u32 s21, s21, s44
  s_mul_i32 s22, s20, 15360
  s_add_u32 s22, s22, 0
  s_add_u32 m0, s22, 0
  s_nop 0
  buffer_load_dwordx4 v4, s[12:15], s21 offen lds
  s_add_u32 m0, s22, 1024
  s_nop 0
  buffer_load_dwordx4 v5, s[12:15], s21 offen lds
  s_add_u32 m0, s22, 2048
  s_nop 0
  buffer_load_dwordx4 v6, s[12:15], s21 offen lds
  s_mul_i32 s21, s20, 491520
  s_add_u32 s21, s21, 98304
  s_add_u32 s21, s21, s44
  s_mul_i32 s22, s20, 15360
  s_add_u32 s22, s22, 3072
  s_add_u32 m0, s22, 0
  s_nop 0
  buffer_load_dwordx4 v4, s[12:15], s21 offen lds
  s_add_u32 m0, s22, 1024
  s_nop 0
  buffer_load_dwordx4 v5, s[12:15], s21 offen lds
  s_add_u32 m0, s22, 2048
  s_nop 0
  buffer_load_dwordx4 v6, s[12:15], s21 offen lds
  s_mul_i32 s21, s20, 491520
  s_add_u32 s21, s21, 196608
  s_add_u32 s21, s21, s44
  s_mul_i32 s22, s20, 15360
  s_add_u32 s22, s22, 6144
  s_add_u32 m0, s22, 0
  s_nop 0
  buffer_load_dwordx4 v4, s[12:15], s21 offen lds
  s_add_u32 m0, s22, 1024
  s_nop 0
  buffer_load_dwordx4 v5, s[12:15], s21 offen lds
  s_add_u32 m0, s22, 2048
  s_nop 0
  buffer_load_dwordx4 v6, s[12:15], s21 offen lds
  s_mul_i32 s21, s20, 491520
  s_add_u32 s21, s21, 294912
  s_add_u32 s21, s21, s44
  s_mul_i32 s22, s20, 15360
  s_add_u32 s22, s22, 9216
  s_add_u32 m0, s22, 0
  s_nop 0
  buffer_load_dwordx4 v4, s[12:15], s21 offen lds
  s_add_u32 m0, s22, 1024
  s_nop 0
  buffer_load_dwordx4 v5, s[12:15], s21 offen lds
  s_add_u32 m0, s22, 2048
  s_nop 0
  buffer_load_dwordx4 v6, s[12:15], s21 offen lds
  s_mul_i32 s21, s20, 491520
  s_add_u32 s21, s21, 393216
  s_add_u32 s21, s21, s44
  s_mul_i32 s22, s20, 15360
  s_add_u32 s22, s22, 12288
  s_add_u32 m0, s22, 0
  s_nop 0
  buffer_load_dwordx4 v4, s[12:15], s21 offen lds
  s_add_u32 m0, s22, 1024
  s_nop 0
  buffer_load_dwordx4 v5, s[12:15], s21 offen lds
  s_add_u32 m0, s22, 2048
  s_nop 0
  buffer_load_dwordx4 v6, s[12:15], s21 offen lds
  s_mul_i32 s21, s20, 491520
  s_add_u32 s21, s21, 1966080
  s_add_u32 s21, s21, s44
  s_mul_i32 s22, s20, 15360
  s_add_u32 s22, s22, 61440
  s_add_u32 m0, s22, 0
  s_nop 0
  buffer_load_dwordx4 v4, s[12:15], s21 offen lds
  s_add_u32 m0, s22, 1024
  s_nop 0
  buffer_load_dwordx4 v5, s[12:15], s21 offen lds
  s_add_u32 m0, s22, 2048
  s_nop 0
  buffer_load_dwordx4 v6, s[12:15], s21 offen lds
  s_mul_i32 s21, s20, 491520
  s_add_u32 s21, s21, 2064384
  s_add_u32 s21, s21, s44
  s_mul_i32 s22, s20, 15360
  s_add_u32 s22, s22, 64512
  s_add_u32 m0, s22, 0
  s_nop 0
  buffer_load_dwordx4 v4, s[12:15], s21 offen lds
  s_add_u32 m0, s22, 1024
  s_nop 0
  buffer_load_dwordx4 v5, s[12:15], s21 offen lds
  s_add_u32 m0, s22, 2048
  s_nop 0
  buffer_load_dwordx4 v6, s[12:15], s21 offen lds
  s_mul_i32 s21, s20, 491520
  s_add_u32 s21, s21, 2162688
  s_add_u32 s21, s21, s44
  s_mul_i32 s22, s20, 15360
  s_add_u32 s22, s22, 67584
  s_add_u32 m0, s22, 0
  s_nop 0
  buffer_load_dwordx4 v4, s[12:15], s21 offen lds
  s_add_u32 m0, s22, 1024
  s_nop 0
  buffer_load_dwordx4 v5, s[12:15], s21 offen lds
  s_add_u32 m0, s22, 2048
  s_nop 0
  buffer_load_dwordx4 v6, s[12:15], s21 offen lds
  s_mul_i32 s21, s20, 491520
  s_add_u32 s21, s21, 2260992
  s_add_u32 s21, s21, s44
  s_mul_i32 s22, s20, 15360
  s_add_u32 s22, s22, 70656
  s_add_u32 m0, s22, 0
  s_nop 0
  buffer_load_dwordx4 v4, s[12:15], s21 offen lds
  s_add_u32 m0, s22, 1024
  s_nop 0
  buffer_load_dwordx4 v5, s[12:15], s21 offen lds
  s_add_u32 m0, s22, 2048
  s_nop 0
  buffer_load_dwordx4 v6, s[12:15], s21 offen lds
  s_mul_i32 s21, s20, 491520
  s_add_u32 s21, s21, 2359296
  s_add_u32 s21, s21, s44
  s_mul_i32 s22, s20, 15360
  s_add_u32 s22, s22, 73728
  s_add_u32 m0, s22, 0
  s_nop 0
  buffer_load_dwordx4 v4, s[12:15], s21 offen lds
  s_add_u32 m0, s22, 1024
  s_nop 0
  buffer_load_dwordx4 v5, s[12:15], s21 offen lds
  s_add_u32 m0, s22, 2048
  s_nop 0
  buffer_load_dwordx4 v6, s[12:15], s21 offen lds
  s_mul_i32 s21, s20, 491520
  s_add_u32 s21, s21, 3932160
  s_add_u32 s21, s21, s44
  buffer_load_dwordx4 v[64:67], v4, s[12:15], s21 offen
  buffer_load_dwordx4 v[68:71], v5, s[12:15], s21 offen
  buffer_load_dwordx4 v[72:75], v6, s[12:15], s21 offen
  s_mul_i32 s21, s20, 491520
  s_add_u32 s21, s21, 4030464
  s_add_u32 s21, s21, s44
  buffer_load_dwordx4 v[76:79], v4, s[12:15], s21 offen
  buffer_load_dwordx4 v[80:83], v5, s[12:15], s21 offen
  buffer_load_dwordx4 v[84:87], v6, s[12:15], s21 offen
  s_mul_i32 s21, s20, 491520
  s_add_u32 s21, s21, 4128768
  s_add_u32 s21, s21, s44
  buffer_load_dwordx4 v[88:91], v4, s[12:15], s21 offen
  buffer_load_dwordx4 v[92:95], v5, s[12:15], s21 offen
  buffer_load_dwordx4 v[96:99], v6, s[12:15], s21 offen
  s_mul_i32 s21, s20, 491520
  s_add_u32 s21, s21, 4227072
  s_add_u32 s21, s21, s44
  buffer_load_dwordx4 v[100:103], v4, s[12:15], s21 offen
  buffer_load_dwordx4 v[104:107], v5, s[12:15], s21 offen
  buffer_load_dwordx4 v[108:111], v6, s[12:15], s21 offen
  s_mul_i32 s21, s20, 491520
  s_add_u32 s21, s21, 4325376
  s_add_u32 s21, s21, s44
  buffer_load_dwordx4 v[112:115], v4, s[12:15], s21 offen
  buffer_load_dwordx4 v[116:119], v5, s[12:15], s21 offen
  buffer_load_dwordx4 v[120:123], v6, s[12:15], s21 offen
  s_mul_i32 s21, s20, 491520
  s_add_u32 s21, s21, 5898240
  s_add_u32 s21, s21, s44
  buffer_load_dwordx4 v[124:127], v4, s[12:15], s21 offen
  buffer_load_dwordx4 v[128:131], v5, s[12:15], s21 offen
  buffer_load_dwordx4 v[132:135], v6, s[12:15], s21 offen
  s_mul_i32 s21, s20, 491520
  s_add_u32 s21, s21, 5996544
  s_add_u32 s21, s21, s44
  buffer_load_dwordx4 v[136:139], v4, s[12:15], s21 offen
  buffer_load_dwordx4 v[140:143], v5, s[12:15], s21 offen
  buffer_load_dwordx4 v[144:147], v6, s[12:15], s21 offen
  s_mul_i32 s21, s20, 491520
  s_add_u32 s21, s21, 6094848
  s_add_u32 s21, s21, s44
  buffer_load_dwordx4 v[148:151], v4, s[12:15], s21 offen
  buffer_load_dwordx4 v[152:155], v5, s[12:15], s21 offen
  buffer_load_dwordx4 v[156:159], v6, s[12:15], s21 offen
  s_mul_i32 s21, s20, 491520
  s_add_u32 s21, s21, 6193152
  s_add_u32 s21, s21, s44
  buffer_load_dwordx4 v[160:163], v4, s[12:15], s21 offen
  buffer_load_dwordx4 v[164:167], v5, s[12:15], s21 offen
  buffer_load_dwordx4 v[168:171], v6, s[12:15], s21 offen
  s_mul_i32 s21, s20, 491520
  s_add_u32 s21, s21, 6291456
  s_add_u32 s21, s21, s44
  buffer_load_dwordx4 v[172:175], v4, s[12:15], s21 offen
  buffer_load_dwordx4 v[176:179], v5, s[12:15], s21 offen
  buffer_load_dwordx4 v[180:183], v6, s[12:15], s21 offen
  s_mul_i32 s22, s20, 15360
  v_lshl_add_u32 v30, v1, 4, s22
  v_add_u32 v31, 61440, v30
  s_waitcnt vmcnt(45)
  s_barrier
  ds_read_b64_tr_b16 a[0:1], v7 offset:0
  ds_read_b64_tr_b16 a[2:3], v7 offset:1536
  ds_read_b64_tr_b16 a[4:5], v7 offset:32
  ds_read_b64_tr_b16 a[6:7], v7 offset:1568
  ds_read_b64_tr_b16 a[8:9], v7 offset:64
  ds_read_b64_tr_b16 a[10:11], v7 offset:1600
  ds_read_b64_tr_b16 a[12:13], v7 offset:12288
  ds_read_b64_tr_b16 a[14:15], v7 offset:13824
  ds_read_b64_tr_b16 a[16:17], v7 offset:12320
  ds_read_b64_tr_b16 a[18:19], v7 offset:13856
  ds_read_b64_tr_b16 a[20:21], v7 offset:12352
  ds_read_b64_tr_b16 a[22:23], v7 offset:13888
  ds_read_b64_tr_b16 a[24:25], v7 offset:24576
  ds_read_b64_tr_b16 a[26:27], v7 offset:26112
  ds_read_b64_tr_b16 a[28:29], v7 offset:24608
  ds_read_b64_tr_b16 a[30:31], v7 offset:26144
  ds_read_b64_tr_b16 a[32:33], v7 offset:24640
  ds_read_b64_tr_b16 a[34:35], v7 offset:26176
  ds_read_b64_tr_b16 a[36:37], v7 offset:36864
  ds_read_b64_tr_b16 a[38:39], v7 offset:38400
  ds_read_b64_tr_b16 a[40:41], v7 offset:36896
  ds_read_b64_tr_b16 a[42:43], v7 offset:38432
  ds_read_b64_tr_b16 a[44:45], v7 offset:36928
  ds_read_b64_tr_b16 a[46:47], v7 offset:38464
  ds_read_b64_tr_b16 a[48:49], v7 offset:49152
  ds_read_b64_tr_b16 a[50:51], v7 offset:50688
  ds_read_b64_tr_b16 a[52:53], v7 offset:49184
  ds_read_b64_tr_b16 a[54:55], v7 offset:50720
  ds_read_b64_tr_b16 a[56:57], v7 offset:49216
  ds_read_b64_tr_b16 a[58:59], v7 offset:50752
  s_waitcnt lgkmcnt(0)
  s_barrier
  s_waitcnt vmcnt(30)
  s_barrier
  ds_read_b64_tr_b16 a[60:61], v8 offset:0
  ds_read_b64_tr_b16 a[62:63], v8 offset:1536
  ds_read_b64_tr_b16 a[64:65], v8 offset:32
  ds_read_b64_tr_b16 a[66:67], v8 offset:1568
  ds_read_b64_tr_b16 a[68:69], v8 offset:64
  ds_read_b64_tr_b16 a[70:71], v8 offset:1600
  ds_read_b64_tr_b16 a[72:73], v8 offset:12288
  ds_read_b64_tr_b16 a[74:75], v8 offset:13824
  ds_read_b64_tr_b16 a[76:77], v8 offset:12320
  ds_read_b64_tr_b16 a[78:79], v8 offset:13856
  ds_read_b64_tr_b16 a[80:81], v8 offset:12352
  ds_read_b64_tr_b16 a[82:83], v8 offset:13888
  ds_read_b64_tr_b16 a[84:85], v8 offset:24576
  ds_read_b64_tr_b16 a[86:87], v8 offset:26112
  ds_read_b64_tr_b16 a[88:89], v8 offset:24608
  ds_read_b64_tr_b16 a[90:91], v8 offset:26144
  ds_read_b64_tr_b16 a[92:93], v8 offset:24640
  ds_read_b64_tr_b16 a[94:95], v8 offset:26176
  ds_read_b64_tr_b16 a[96:97], v8 offset:36864
  ds_read_b64_tr_b16 a[98:99], v8 offset:38400
  ds_read_b64_tr_b16 a[100:101], v8 offset:36896
  ds_read_b64_tr_b16 a[102:103], v8 offset:38432
  ds_read_b64_tr_b16 a[104:105], v8 offset:36928
  ds_read_b64_tr_b16 a[106:107], v8 offset:38464
  ds_read_b64_tr_b16 a[108:109], v8 offset:49152
  ds_read_b64_tr_b16 a[110:111], v8 offset:50688
  ds_read_b64_tr_b16 a[112:113], v8 offset:49184
  ds_read_b64_tr_b16 a[114:115], v8 offset:50720
  ds_read_b64_tr_b16 a[116:117], v8 offset:49216
  ds_read_b64_tr_b16 a[118:119], v8 offset:50752
  s_waitcnt lgkmcnt(0)
  s_barrier
  s_waitcnt vmcnt(15)
  ds_write_b128 v30, v[64:67] offset:0
  ds_write_b128 v30, v[68:71] offset:1024
  ds_write_b128 v30, v[72:75] offset:2048
  ds_write_b128 v30, v[76:79] offset:3072
  ds_write_b128 v30, v[80:83] offset:4096
  ds_write_b128 v30, v[84:87] offset:5120
  ds_write_b128 v30, v[88:91] offset:6144
  ds_write_b128 v30, v[92:95] offset:7168
  ds_write_b128 v30, v[96:99] offset:8192
  ds_write_b128 v30, v[100:103] offset:9216
  ds_write_b128 v30, v[104:107] offset:10240
  ds_write_b128 v30, v[108:111] offset:11264
  ds_write_b128 v30, v[112:115] offset:12288
  ds_write_b128 v30, v[116:119] offset:13312
  ds_write_b128 v30, v[120:123] offset:14336
  s_waitcnt lgkmcnt(0)
  s_barrier
  ds_read_b64_tr_b16 a[120:121], v7 offset:0
  ds_read_b64_tr_b16 a[122:123], v7 offset:1536
  ds_read_b64_tr_b16 a[124:125], v7 offset:32
  ds_read_b64_tr_b16 a[126:127], v7 offset:1568
  ds_read_b64_tr_b16 a[128:129], v7 offset:64
  ds_read_b64_tr_b16 a[130:131], v7 offset:1600
  ds_read_b64_tr_b16 a[132:133], v7 offset:12288
  ds_read_b64_tr_b16 a[134:135], v7 offset:13824
  ds_read_b64_tr_b16 a[136:137], v7 offset:12320
  ds_read_b64_tr_b16 a[138:139], v7 offset:13856
  ds_read_b64_tr_b16 a[140:141], v7 offset:12352
  ds_read_b64_tr_b16 a[142:143], v7 offset:13888
  ds_read_b64_tr_b16 a[144:145], v7 offset:24576
  ds_read_b64_tr_b16 a[146:147], v7 offset:26112
  ds_read_b64_tr_b16 a[148:149], v7 offset:24608
  ds_read_b64_tr_b16 a[150:151], v7 offset:26144
  ds_read_b64_tr_b16 a[152:153], v7 offset:24640
  ds_read_b64_tr_b16 a[154:155], v7 offset:26176
  ds_read_b64_tr_b16 a[156:157], v7 offset:36864
  ds_read_b64_tr_b16 a[158:159], v7 offset:38400
  ds_read_b64_tr_b16 a[160:161], v7 offset:36896
  ds_read_b64_tr_b16 a[162:163], v7 offset:38432
  ds_read_b64_tr_b16 a[164:165], v7 offset:36928
  ds_read_b64_tr_b16 a[166:167], v7 offset:38464
  ds_read_b64_tr_b16 a[168:169], v7 offset:49152
  ds_read_b64_tr_b16 a[170:171], v7 offset:50688
  ds_read_b64_tr_b16 a[172:173], v7 offset:49184
  ds_read_b64_tr_b16 a[174:175], v7 offset:50720
  ds_read_b64_tr_b16 a[176:177], v7 offset:49216
  ds_read_b64_tr_b16 a[178:179], v7 offset:50752
  s_waitcnt lgkmcnt(0)
  s_barrier
  s_waitcnt vmcnt(0)
  ds_write_b128 v31, v[124:127] offset:0
  ds_write_b128 v31, v[128:131] offset:1024
  ds_write_b128 v31, v[132:135] offset:2048
  ds_write_b128 v31, v[136:139] offset:3072
  ds_write_b128 v31, v[140:143] offset:4096
  ds_write_b128 v31, v[144:147] offset:5120
  ds_write_b128 v31, v[148:151] offset:6144
  ds_write_b128 v31, v[152:155] offset:7168
  ds_write_b128 v31, v[156:159] offset:8192
  ds_write_b128 v31, v[160:163] offset:9216
  ds_write_b128 v31, v[164:167] offset:10240
  ds_write_b128 v31, v[168:171] offset:11264
  ds_write_b128 v31, v[172:175] offset:12288
  ds_write_b128 v31, v[176:179] offset:13312
  ds_write_b128 v31, v[180:183] offset:14336
  s_waitcnt lgkmcnt(0)
  s_barrier
  ds_read_b64_tr_b16 a[180:181], v8 offset:0
  ds_read_b64_tr_b16 a[182:183], v8 offset:1536
  ds_read_b64_tr_b16 a[184:185], v8 offset:32
  ds_read_b64_tr_b16 a[186:187], v8 offset:1568
  ds_read_b64_tr_b16 a[188:189], v8 offset:64
  ds_read_b64_tr_b16 a[190:191], v8 offset:1600
  ds_read_b64_tr_b16 a[192:193], v8 offset:12288
  ds_read_b64_tr_b16 a[194:195], v8 offset:13824
  ds_read_b64_tr_b16 a[196:197], v8 offset:12320
  ds_read_b64_tr_b16 a[198:199], v8 offset:13856
  ds_read_b64_tr_b16 a[200:201], v8 offset:12352
  ds_read_b64_tr_b16 a[202:203], v8 offset:13888
  ds_read_b64_tr_b16 a[204:205], v8 offset:24576
  ds_read_b64_tr_b16 a[206:207], v8 offset:26112
  ds_read_b64_tr_b16 a[208:209], v8 offset:24608
  ds_read_b64_tr_b16 a[210:211], v8 offset:26144
  ds_read_b64_tr_b16 a[212:213], v8 offset:24640
  ds_read_b64_tr_b16 a[214:215], v8 offset:26176
  ds_read_b64_tr_b16 a[216:217], v8 offset:36864
  ds_read_b64_tr_b16 a[218:219], v8 offset:38400
  ds_read_b64_tr_b16 a[220:221], v8 offset:36896
  ds_read_b64_tr_b16 a[222:223], v8 offset:38432
  ds_read_b64_tr_b16 a[224:225], v8 offset:36928
  ds_read_b64_tr_b16 a[226:227], v8 offset:38464
  ds_read_b64_tr_b16 a[228:229], v8 offset:49152
  ds_read_b64_tr_b16 a[230:231], v8 offset:50688
  ds_read_b64_tr_b16 a[232:233], v8 offset:49184
  ds_read_b64_tr_b16 a[234:235], v8 offset:50720
  ds_read_b64_tr_b16 a[236:237], v8 offset:49216
  ds_read_b64_tr_b16 a[238:239], v8 offset:50752
  s_waitcnt lgkmcnt(0)
  s_barrier
  s_mul_i32 s21, s20, 12800
  s_add_u32 s21, s21, 98304
  v_mul_u32_u24 v4, 400, v2
  v_lshlrev_b32 v5, 4, v3
  v_add3_u32 v29, v4, v5, s21
  v_lshlrev_b32 v30, 4, v1
  v_and_b32 v4, 1, v2
  v_bfe_u32 v5, v2, 1, 1
  v_lshl_or_b32 v4, v5, 2, v4
  v_bfe_u32 v5, v2, 2, 1
  v_lshl_or_b32 v4, v5, 1, v4
  v_lshlrev_b32 v4, 4, v4
  v_lshl_add_u32 v31, v3, 7, v4
  v_lshlrev_b32 v32, 3, v1
  v_and_b32 v4, 3, v1
  v_lshlrev_b32 v33, 3, v4
  v_mov_b32 v34, 0xf149f2ca
  v_lshlrev_b32 v4, 2, v3
  v_sub_u32 v35, v2, v4
  v_cmp_gt_u32 s[60:61], 2, v3
  s_mov_b32 s62, 0x3d93cd3a
  s_mov_b32 s63, 0x3fb8aa3b
  s_mov_b32 s83, 0x3dd53b95
  v_cmp_le_i32 s[64:65], 0, v35
  v_cmp_le_i32 s[66:67], 1, v35
  v_cmp_le_i32 s[68:69], 2, v35
  v_cmp_le_i32 s[70:71], 3, v35
  s_mov_b32 s24, 0
  s_mov_b32 s25, 163840
  s_mov_b32 s26, 13
  s_lshl_b32 s49, s41, 2
  s_add_u32 s49, s49, s20
  s_mov_b32 s29, 4
  s_mov_b32 s78, 0
  s_mov_b32 s81, 0x80000000
  s_mov_b32 s82, 0
  v_lshrrev_b32 v11, 3, v1
  v_and_b32 v12, 7, v1
  v_xor_b32 v12, v12, v11
  v_mul_u32_u24 v11, 1280, v11
  v_lshl_add_u32 v10, v12, 4, v11
  s_mul_i32 s46, s20, 40960
  v_add_u32 v10, s46, v10
  s_lshl_b32 s47, s20, 12
  s_add_u32 s47, s47, 0
  s_add_u32 s46, s47, 98304
  s_mov_b32 s30, s24
  s_add_u32 s32, s47, 0
  v_add_u32 v11, 9216, v10
  v_add_u32 v12, 18432, v10
  v_add_u32 v13, 27648, v10
  s_mov_b32 m0, s32
  s_nop 0
  buffer_load_dwordx4 v10, s[8:11], s30 offen offset:0 lds
  buffer_load_dwordx4 v11, s[8:11], s30 offen offset:1024 lds
  buffer_load_dwordx4 v12, s[8:11], s30 offen offset:2048 lds
  buffer_load_dwordx4 v13, s[8:11], s30 offen offset:3072 lds
  s_add_u32 s30, s30, 128
  s_add_u32 s32, s32, 16384
  s_cmp_lt_u32 s32, s46
  s_cselect_b32 s32, s32, s47
  s_mov_b32 m0, s32
  s_nop 0
  buffer_load_dwordx4 v10, s[8:11], s30 offen offset:0 lds
  buffer_load_dwordx4 v11, s[8:11], s30 offen offset:1024 lds
  buffer_load_dwordx4 v12, s[8:11], s30 offen offset:2048 lds
  buffer_load_dwordx4 v13, s[8:11], s30 offen offset:3072 lds
  s_add_u32 s30, s30, 128
  s_add_u32 s32, s32, 16384
  s_cmp_lt_u32 s32, s46
  s_cselect_b32 s32, s32, s47
  s_mov_b32 m0, s32
  s_nop 0
  buffer_load_dwordx4 v10, s[8:11], s30 offen offset:0 lds
  buffer_load_dwordx4 v11, s[8:11], s30 offen offset:1024 lds
  buffer_load_dwordx4 v12, s[8:11], s30 offen offset:2048 lds
  buffer_load_dwordx4 v13, s[8:11], s30 offen offset:3072 lds
  s_add_u32 s30, s30, 128
  s_add_u32 s32, s32, 16384
  s_cmp_lt_u32 s32, s46
  s_cselect_b32 s32, s32, s47
  s_mov_b32 m0, s32
  s_nop 0
  buffer_load_dwordx4 v10, s[8:11], s30 offen offset:0 lds
  buffer_load_dwordx4 v11, s[8:11], s30 offen offset:1024 lds
  buffer_load_dwordx4 v12, s[8:11], s30 offen offset:2048 lds
  buffer_load_dwordx4 v13, s[8:11], s30 offen offset:3072 lds
  s_add_u32 s30, s30, 128
  s_add_u32 s32, s32, 16384
  s_cmp_lt_u32 s32, s46
  s_cselect_b32 s32, s32, s47
  v_and_b32 v6, 7, v2
  v_add_u32 v4, 0, v3
  v_xor_b32 v4, v4, v6
  v_lshlrev_b32 v4, 4, v4
  v_lshl_add_u32 v14, v2, 7, v4
  v_add_u32 v4, 4, v3
  v_xor_b32 v4, v4, v6
  v_lshlrev_b32 v4, 4, v4
  v_lshl_add_u32 v15, v2, 7, v4
  v_mul_u32_u24 v22, 400, v2
  v_mul_u32_u24 v4, 16, v3
  s_mul_i32 s21, s20, 96
  s_add_u32 s21, s21, 98304
  v_add3_u32 v22, v22, v4, s21
  v_lshlrev_b32 v4, 3, v3
  v_sub_u32 v16, v22, v4
  v_mov_b32 v9, 2731
  s_mov_b32 s33, 0
  s_mov_b32 s48, 0x80000000
  s_mov_b32 m0, s32
  s_nop 0
  buffer_load_dwordx4 v10, s[8:11], s30 offen offset:0 lds
  buffer_load_dwordx4 v11, s[8:11], s30 offen offset:1024 lds
  s_waitcnt vmcnt(14)
  s_barrier
  v_add_u32 v18, s33, v14
  v_add_u32 v19, s33, v15
  s_add_u32 s33, s33, 16384
  s_cmp_lt_u32 s33, 98304
  s_cselect_b32 s33, s33, 0
  ds_read_b128 v[160:163], v18 offset:0
  ds_read_b128 v[164:167], v18 offset:2048
  ds_read_b128 v[168:171], v18 offset:4096
  ds_read_b128 v[172:175], v18 offset:6144
  ds_read_b128 v[176:179], v18 offset:8192
  ds_read_b128 v[180:183], v18 offset:10240
  ds_read_b128 v[184:187], v18 offset:12288
  ds_read_b128 v[188:191], v18 offset:14336
  s_waitcnt lgkmcnt(0)
qa_blk_205:
  v_mfma_f32_16x16x32_bf16 v[64:67], a[0:3], v[160:163], 0
  ds_read_b128 v[192:195], v19 offset:0
  v_mfma_f32_16x16x32_bf16 v[68:71], a[4:7], v[160:163], 0
  v_add_u32 v18, s33, v14
  v_cndmask_b32 v36, v34, v36, s[64:65]
  v_mfma_f32_16x16x32_bf16 v[72:75], a[8:11], v[160:163], 0
  v_cndmask_b32 v48, v34, v48, s[64:65]
  v_cndmask_b32 v37, v34, v37, s[66:67]
  v_mfma_f32_16x16x32_bf16 v[76:79], a[0:3], v[164:167], 0
  ds_read_b128 v[196:199], v19 offset:2048
  v_cndmask_b32 v49, v34, v49, s[66:67]
  v_mfma_f32_16x16x32_bf16 v[80:83], a[4:7], v[164:167], 0
  buffer_load_dwordx4 v12, s[8:11], s30 offen offset:2048 lds
  v_mfma_f32_16x16x32_bf16 v[84:87], a[8:11], v[164:167], 0
  v_cndmask_b32 v38, v34, v38, s[68:69]
  v_cndmask_b32 v50, v34, v50, s[68:69]
  v_mfma_f32_16x16x32_bf16 v[88:91], a[0:3], v[168:171], 0
  ds_read_b128 v[200:203], v19 offset:4096
  v_cndmask_b32 v39, v34, v39, s[70:71]
  v_mfma_f32_16x16x32_bf16 v[92:95], a[4:7], v[168:171], 0
  v_cndmask_b32 v51, v34, v51, s[70:71]
  v_max3_f32 v56, v36, v37, v38
  v_mfma_f32_16x16x32_bf16 v[96:99], a[8:11], v[168:171], 0
  v_max3_f32 v56, v56, v39, v40
  v_max3_f32 v56, v56, v41, v42
  v_mfma_f32_16x16x32_bf16 v[100:103], a[0:3], v[172:175], 0
  ds_read_b128 v[204:207], v19 offset:6144
  v_max_f32 v56, v56, v43
  v_mfma_f32_16x16x32_bf16 v[104:107], a[4:7], v[172:175], 0
  v_mov_b32 v57, v56
  v_mfma_f32_16x16x32_bf16 v[108:111], a[8:11], v[172:175], 0
  s_waitcnt lgkmcnt(15)
  v_mfma_f32_16x16x32_bf16 v[112:115], a[0:3], v[176:179], 0
  ds_read_b128 v[208:211], v19 offset:8192
  v_mfma_f32_16x16x32_bf16 v[116:119], a[4:7], v[176:179], 0
  s_nop 1
  v_mfma_f32_16x16x32_bf16 v[120:123], a[8:11], v[176:179], 0
  v_permlane32_swap_b32 v56, v57
  v_mfma_f32_16x16x32_bf16 v[124:127], a[0:3], v[180:183], 0
  ds_read_b128 v[212:215], v19 offset:10240
  v_max_f32 v56, v56, v57
  v_mfma_f32_16x16x32_bf16 v[128:131], a[4:7], v[180:183], 0
  buffer_load_dwordx4 v13, s[8:11], s30 offen offset:3072 lds
  v_mfma_f32_16x16x32_bf16 v[132:135], a[8:11], v[180:183], 0
  s_add_u32 s30, s30, 128
  s_add_u32 m0, m0, 16384
  v_mfma_f32_16x16x32_bf16 v[136:139], a[0:3], v[184:187], 0
  ds_read_b128 v[216:219], v19 offset:12288
  v_mov_b32 v57, v56
  v_mfma_f32_16x16x32_bf16 v[140:143], a[4:7], v[184:187], 0
  s_cmp_lt_u32 m0, s46
  s_cselect_b32 m0, m0, s47
  v_mfma_f32_16x16x32_bf16 v[144:147], a[8:11], v[184:187], 0
  s_nop 1
  v_mfma_f32_16x16x32_bf16 v[148:151], a[0:3], v[188:191], 0
  ds_read_b128 v[220:223], v19 offset:14336
  v_mfma_f32_16x16x32_bf16 v[152:155], a[4:7], v[188:191], 0
  v_permlane16_swap_b32 v56, v57
  v_mfma_f32_16x16x32_bf16 v[156:159], a[8:11], v[188:191], 0
  s_waitcnt vmcnt(12) lgkmcnt(4)
  s_barrier
  v_mfma_f32_16x16x32_bf16 v[64:67], a[12:15], v[192:195], v[64:67]
  ds_read_b128 v[160:163], v18 offset:0
  v_max_f32 v56, v56, v57
  v_mfma_f32_16x16x32_bf16 v[68:71], a[16:19], v[192:195], v[68:71]
  v_mul_f32 v56, s83, v56
  v_fma_f32 v36, v36, s83, -v56
  v_mfma_f32_16x16x32_bf16 v[72:75], a[20:23], v[192:195], v[72:75]
  v_add_u32 v19, s33, v15
  s_add_u32 s33, s33, 16384
  v_mfma_f32_16x16x32_bf16 v[76:79], a[12:15], v[196:199], v[76:79]
  ds_read_b128 v[164:167], v18 offset:2048
  v_fma_f32 v37, v37, s83, -v56
  v_mfma_f32_16x16x32_bf16 v[80:83], a[16:19], v[196:199], v[80:83]
  buffer_load_dwordx4 v10, s[8:11], s30 offen offset:0 lds
  v_mfma_f32_16x16x32_bf16 v[84:87], a[20:23], v[196:199], v[84:87]
  s_cmp_lt_u32 s33, 98304
  s_cselect_b32 s33, s33, 0
  v_mfma_f32_16x16x32_bf16 v[88:91], a[12:15], v[200:203], v[88:91]
  ds_read_b128 v[168:171], v18 offset:4096
  v_fma_f32 v38, v38, s83, -v56
  v_mfma_f32_16x16x32_bf16 v[92:95], a[16:19], v[200:203], v[92:95]
  v_fma_f32 v39, v39, s83, -v56
  v_fma_f32 v40, v40, s83, -v56
  v_mfma_f32_16x16x32_bf16 v[96:99], a[20:23], v[200:203], v[96:99]
  v_fma_f32 v41, v41, s83, -v56
  v_fma_f32 v42, v42, s83, -v56
  v_mfma_f32_16x16x32_bf16 v[100:103], a[12:15], v[204:207], v[100:103]
  ds_read_b128 v[172:175], v18 offset:6144
  v_fma_f32 v43, v43, s83, -v56
  v_mfma_f32_16x16x32_bf16 v[104:107], a[16:19], v[204:207], v[104:107]
  v_exp_f32 v36, v36
  v_mfma_f32_16x16x32_bf16 v[108:111], a[20:23], v[204:207], v[108:111]
  s_waitcnt lgkmcnt(4)
  v_mfma_f32_16x16x32_bf16 v[112:115], a[12:15], v[208:211], v[112:115]
  ds_read_b128 v[176:179], v18 offset:8192
  v_mfma_f32_16x16x32_bf16 v[116:119], a[16:19], v[208:211], v[116:119]
  v_exp_f32 v37, v37
  v_mfma_f32_16x16x32_bf16 v[120:123], a[20:23], v[208:211], v[120:123]
  v_exp_f32 v38, v38
  v_mfma_f32_16x16x32_bf16 v[124:127], a[12:15], v[212:215], v[124:127]
  ds_read_b128 v[180:183], v18 offset:10240
  v_mfma_f32_16x16x32_bf16 v[128:131], a[16:19], v[212:215], v[128:131]
  buffer_load_dwordx4 v11, s[8:11], s30 offen offset:1024 lds
  v_mfma_f32_16x16x32_bf16 v[132:135], a[20:23], v[212:215], v[132:135]
  v_exp_f32 v39, v39
  v_mfma_f32_16x16x32_bf16 v[136:139], a[12:15], v[216:219], v[136:139]
  ds_read_b128 v[184:187], v18 offset:12288
  v_mfma_f32_16x16x32_bf16 v[140:143], a[16:19], v[216:219], v[140:143]
  v_exp_f32 v40, v40
  v_mfma_f32_16x16x32_bf16 v[144:147], a[20:23], v[216:219], v[144:147]
  v_exp_f32 v41, v41
  v_mfma_f32_16x16x32_bf16 v[148:151], a[12:15], v[220:223], v[148:151]
  ds_read_b128 v[188:191], v18 offset:14336
  v_mfma_f32_16x16x32_bf16 v[152:155], a[16:19], v[220:223], v[152:155]
  v_exp_f32 v42, v42
  v_mfma_f32_16x16x32_bf16 v[156:159], a[20:23], v[220:223], v[156:159]
  s_waitcnt lgkmcnt(4)
  v_mfma_f32_16x16x32_bf16 v[64:67], a[24:27], v[160:163], v[64:67]
  ds_read_b128 v[192:195], v19 offset:0
  v_mfma_f32_16x16x32_bf16 v[68:71], a[28:31], v[160:163], v[68:71]
  v_add_u32 v18, s33, v14
  v_mfma_f32_16x16x32_bf16 v[72:75], a[32:35], v[160:163], v[72:75]
  v_exp_f32 v43, v43
  v_mfma_f32_16x16x32_bf16 v[76:79], a[24:27], v[164:167], v[76:79]
  ds_read_b128 v[196:199], v19 offset:2048
  s_nop 0
  v_mfma_f32_16x16x32_bf16 v[80:83], a[28:31], v[164:167], v[80:83]
  buffer_load_dwordx4 v12, s[8:11], s30 offen offset:2048 lds
  v_mfma_f32_16x16x32_bf16 v[84:87], a[32:35], v[164:167], v[84:87]
  v_add_f32 v56, v40, v41
  v_add_f32 v56, v56, v42
  v_mfma_f32_16x16x32_bf16 v[88:91], a[24:27], v[168:171], v[88:91]
  ds_read_b128 v[200:203], v19 offset:4096
  v_add_f32 v56, v56, v43
  v_mfma_f32_16x16x32_bf16 v[92:95], a[28:31], v[168:171], v[92:95]
  v_cndmask_b32 v56, 0, v56, s[60:61]
  v_add_f32 v56, v56, v36
  v_mfma_f32_16x16x32_bf16 v[96:99], a[32:35], v[168:171], v[96:99]
  v_add_f32 v56, v56, v37
  v_add_f32 v56, v56, v38
  v_mfma_f32_16x16x32_bf16 v[100:103], a[24:27], v[172:175], v[100:103]
  ds_read_b128 v[204:207], v19 offset:6144
  v_add_f32 v56, v56, v39
  v_mfma_f32_16x16x32_bf16 v[104:107], a[28:31], v[172:175], v[104:107]
  v_mov_b32 v57, v56
  v_mfma_f32_16x16x32_bf16 v[108:111], a[32:35], v[172:175], v[108:111]
  s_waitcnt lgkmcnt(4)
  v_mfma_f32_16x16x32_bf16 v[112:115], a[24:27], v[176:179], v[112:115]
  ds_read_b128 v[208:211], v19 offset:8192
  v_mfma_f32_16x16x32_bf16 v[116:119], a[28:31], v[176:179], v[116:119]
  s_nop 1
  v_mfma_f32_16x16x32_bf16 v[120:123], a[32:35], v[176:179], v[120:123]
  v_permlane32_swap_b32 v56, v57
  v_mfma_f32_16x16x32_bf16 v[124:127], a[24:27], v[180:183], v[124:127]
  ds_read_b128 v[212:215], v19 offset:10240
  v_add_f32 v56, v56, v57
  v_mfma_f32_16x16x32_bf16 v[128:131], a[28:31], v[180:183], v[128:131]
  buffer_load_dwordx4 v13, s[8:11], s30 offen offset:3072 lds
  v_mfma_f32_16x16x32_bf16 v[132:135], a[32:35], v[180:183], v[132:135]
  s_add_u32 s30, s30, 128
  s_add_u32 m0, m0, 16384
  v_mfma_f32_16x16x32_bf16 v[136:139], a[24:27], v[184:187], v[136:139]
  ds_read_b128 v[216:219], v19 offset:12288
  v_mov_b32 v57, v56
  v_mfma_f32_16x16x32_bf16 v[140:143], a[28:31], v[184:187], v[140:143]
  s_cmp_lt_u32 m0, s46
  s_cselect_b32 m0, m0, s47
  v_mfma_f32_16x16x32_bf16 v[144:147], a[32:35], v[184:187], v[144:147]
  s_nop 1
  v_mfma_f32_16x16x32_bf16 v[148:151], a[24:27], v[188:191], v[148:151]
  ds_read_b128 v[220:223], v19 offset:14336
  v_mfma_f32_16x16x32_bf16 v[152:155], a[28:31], v[188:191], v[152:155]
  v_permlane16_swap_b32 v56, v57
  v_mfma_f32_16x16x32_bf16 v[156:159], a[32:35], v[188:191], v[156:159]
  s_waitcnt vmcnt(12) lgkmcnt(4)
  s_barrier
  v_mfma_f32_16x16x32_bf16 v[64:67], a[36:39], v[192:195], v[64:67]
  ds_read_b128 v[160:163], v18 offset:0
  v_add_f32 v56, v56, v57
  v_mfma_f32_16x16x32_bf16 v[68:71], a[40:43], v[192:195], v[68:71]
  v_rcp_f32 v56, v56
  v_mfma_f32_16x16x32_bf16 v[72:75], a[44:47], v[192:195], v[72:75]
  v_add_u32 v19, s33, v15
  s_add_u32 s33, s33, 16384
  v_mfma_f32_16x16x32_bf16 v[76:79], a[36:39], v[196:199], v[76:79]
  ds_read_b128 v[164:167], v18 offset:2048
  s_nop 0
  v_mfma_f32_16x16x32_bf16 v[80:83], a[40:43], v[196:199], v[80:83]
  buffer_load_dwordx4 v10, s[8:11], s30 offen offset:0 lds
  v_mfma_f32_16x16x32_bf16 v[84:87], a[44:47], v[196:199], v[84:87]
  s_cmp_lt_u32 s33, 98304
  s_cselect_b32 s33, s33, 0
  v_mfma_f32_16x16x32_bf16 v[88:91], a[36:39], v[200:203], v[88:91]
  ds_read_b128 v[168:171], v18 offset:4096
  v_mul_f32 v36, v36, v56
  v_mfma_f32_16x16x32_bf16 v[92:95], a[40:43], v[200:203], v[92:95]
  v_mul_f32 v37, v37, v56
  v_mul_f32 v38, v38, v56
  v_mfma_f32_16x16x32_bf16 v[96:99], a[44:47], v[200:203], v[96:99]
  v_mul_f32 v39, v39, v56
  v_mul_f32 v40, v40, v56
  v_mfma_f32_16x16x32_bf16 v[100:103], a[36:39], v[204:207], v[100:103]
  ds_read_b128 v[172:175], v18 offset:6144
  v_mul_f32 v41, v41, v56
  v_mfma_f32_16x16x32_bf16 v[104:107], a[40:43], v[204:207], v[104:107]
  v_mul_f32 v42, v42, v56
  v_mul_f32 v43, v43, v56
  v_mfma_f32_16x16x32_bf16 v[108:111], a[44:47], v[204:207], v[108:111]
  s_waitcnt lgkmcnt(4)
  v_max3_f32 v56, v44, v45, v46
  v_mfma_f32_16x16x32_bf16 v[112:115], a[36:39], v[208:211], v[112:115]
  ds_read_b128 v[176:179], v18 offset:8192
  v_max3_f32 v56, v56, v47, v48
  v_mfma_f32_16x16x32_bf16 v[116:119], a[40:43], v[208:211], v[116:119]
  v_max3_f32 v56, v56, v49, v50
  v_max3_f32 v56, v56, v51, v52
  v_mfma_f32_16x16x32_bf16 v[120:123], a[44:47], v[208:211], v[120:123]
  v_max3_f32 v56, v56, v53, v54
  v_max_f32 v56, v56, v55
  v_mfma_f32_16x16x32_bf16 v[124:127], a[36:39], v[212:215], v[124:127]
  ds_read_b128 v[180:183], v18 offset:10240
  v_mov_b32 v57, v56
  v_mfma_f32_16x16x32_bf16 v[128:131], a[40:43], v[212:215], v[128:131]
  buffer_load_dwordx4 v11, s[8:11], s30 offen offset:1024 lds
  v_mfma_f32_16x16x32_bf16 v[132:135], a[44:47], v[212:215], v[132:135]
  s_nop 1
  v_mfma_f32_16x16x32_bf16 v[136:139], a[36:39], v[216:219], v[136:139]
  ds_read_b128 v[184:187], v18 offset:12288
  v_mfma_f32_16x16x32_bf16 v[140:143], a[40:43], v[216:219], v[140:143]
  v_permlane32_swap_b32 v56, v57
  v_mfma_f32_16x16x32_bf16 v[144:147], a[44:47], v[216:219], v[144:147]
  v_max_f32 v56, v56, v57
  v_mov_b32 v57, v56
  v_mfma_f32_16x16x32_bf16 v[148:151], a[36:39], v[220:223], v[148:151]
  ds_read_b128 v[188:191], v18 offset:14336
  v_mfma_f32_16x16x32_bf16 v[152:155], a[40:43], v[220:223], v[152:155]
  s_nop 1
  v_mfma_f32_16x16x32_bf16 v[156:159], a[44:47], v[220:223], v[156:159]
  s_waitcnt lgkmcnt(4)
  v_mfma_f32_16x16x32_bf16 v[64:67], a[48:51], v[160:163], v[64:67]
  ds_read_b128 v[192:195], v19 offset:0
  v_mfma_f32_16x16x32_bf16 v[68:71], a[52:55], v[160:163], v[68:71]
  v_add_u32 v18, s33, v14
  v_mfma_f32_16x16x32_bf16 v[72:75], a[56:59], v[160:163], v[72:75]
  v_permlane16_swap_b32 v56, v57
  v_mfma_f32_16x16x32_bf16 v[76:79], a[48:51], v[164:167], v[76:79]
  ds_read_b128 v[196:199], v19 offset:2048
  v_max_f32 v56, v56, v57
  v_mfma_f32_16x16x32_bf16 v[80:83], a[52:55], v[164:167], v[80:83]
  buffer_load_dwordx4 v12, s[8:11], s30 offen offset:2048 lds
  v_mfma_f32_16x16x32_bf16 v[84:87], a[56:59], v[164:167], v[84:87]
  v_mul_f32 v56, s83, v56
  v_fma_f32 v44, v44, s83, -v56
  v_mfma_f32_16x16x32_bf16 v[88:91], a[48:51], v[168:171], v[88:91]
  ds_read_b128 v[200:203], v19 offset:4096
  v_fma_f32 v45, v45, s83, -v56
  v_mfma_f32_16x16x32_bf16 v[92:95], a[52:55], v[168:171], v[92:95]
  v_fma_f32 v46, v46, s83, -v56
  v_fma_f32 v47, v47, s83, -v56
  v_mfma_f32_16x16x32_bf16 v[96:99], a[56:59], v[168:171], v[96:99]
  v_fma_f32 v48, v48, s83, -v56
  v_fma_f32 v49, v49, s83, -v56
  v_mfma_f32_16x16x32_bf16 v[100:103], a[48:51], v[172:175], v[100:103]
  ds_read_b128 v[204:207], v19 offset:6144
  v_fma_f32 v50, v50, s83, -v56
  v_mfma_f32_16x16x32_bf16 v[104:107], a[52:55], v[172:175], v[104:107]
  v_fma_f32 v51, v51, s83, -v56
  v_fma_f32 v52, v52, s83, -v56
  v_mfma_f32_16x16x32_bf16 v[108:111], a[56:59], v[172:175], v[108:111]
  s_waitcnt lgkmcnt(4)
  v_fma_f32 v53, v53, s83, -v56
  v_mfma_f32_16x16x32_bf16 v[112:115], a[48:51], v[176:179], v[112:115]
  ds_read_b128 v[208:211], v19 offset:8192
  v_fma_f32 v54, v54, s83, -v56
  v_mfma_f32_16x16x32_bf16 v[116:119], a[52:55], v[176:179], v[116:119]
  v_fma_f32 v55, v55, s83, -v56
  v_mfma_f32_16x16x32_bf16 v[120:123], a[56:59], v[176:179], v[120:123]
  v_exp_f32 v44, v44
  v_mfma_f32_16x16x32_bf16 v[124:127], a[48:51], v[180:183], v[124:127]
  ds_read_b128 v[212:215], v19 offset:10240
  v_mfma_f32_16x16x32_bf16 v[128:131], a[52:55], v[180:183], v[128:131]
  buffer_load_dwordx4 v13, s[8:11], s30 offen offset:3072 lds
  v_mfma_f32_16x16x32_bf16 v[132:135], a[56:59], v[180:183], v[132:135]
  s_add_u32 s30, s30, 128
  s_add_u32 m0, m0, 16384
  v_mfma_f32_16x16x32_bf16 v[136:139], a[48:51], v[184:187], v[136:139]
  ds_read_b128 v[216:219], v19 offset:12288
  v_mfma_f32_16x16x32_bf16 v[140:143], a[52:55], v[184:187], v[140:143]
  s_cmp_lt_u32 m0, s46
  s_cselect_b32 m0, m0, s47
  v_mfma_f32_16x16x32_bf16 v[144:147], a[56:59], v[184:187], v[144:147]
  v_exp_f32 v45, v45
  v_mfma_f32_16x16x32_bf16 v[148:151], a[48:51], v[188:191], v[148:151]
  ds_read_b128 v[220:223], v19 offset:14336
  v_mfma_f32_16x16x32_bf16 v[152:155], a[52:55], v[188:191], v[152:155]
  v_exp_f32 v46, v46
  v_mfma_f32_16x16x32_bf16 v[156:159], a[56:59], v[188:191], v[156:159]
  s_waitcnt vmcnt(12) lgkmcnt(4)
  s_barrier
  v_mfma_f32_16x16x32_bf16 v[64:67], a[60:63], v[192:195], v[64:67]
  ds_read_b128 v[160:163], v18 offset:0
  v_mfma_f32_16x16x32_bf16 v[68:71], a[64:67], v[192:195], v[68:71]
  s_waitcnt vmcnt(10)
  s_cmp_eq_u32 s78, 0
  s_cbranch_scc1 pf_203
  v_mov_b32 v4, 0
  v_mov_b32 v5, 1
  s_mov_b64 exec, 1
  buffer_atomic_add v5, v4, s[72:75], s78 offen sc1
  s_mov_b64 exec, -1
  s_mov_b32 s78, 0
pf_203:
  s_mul_i32 s21, s49, 393216
  s_mul_i32 s22, s42, 12288
  s_add_u32 s50, s21, s22
  s_mul_i32 s21, s49, 98304
  s_mul_i32 s22, s42, 3072
  s_add_u32 s51, s21, s22
  s_lshr_b32 s22, s49, 1
  s_lshr_b32 s21, s49, 2
  s_add_u32 s21, s21, 4
  s_cmp_lt_u32 s49, 16
  s_cselect_b32 s21, s22, s21
  s_lshl_b32 s21, s21, 3
  s_lshr_b32 s22, s42, 2
  s_add_u32 s21, s21, s22
  s_lshl_b32 s21, s21, 7
  s_add_u32 s76, s21, 0
  s_lshl_b32 s77, s42, 7
  s_add_u32 s77, s77, 20480
  v_mov_b32 v4, 0
  buffer_load_dword v20, v4, s[72:75], s76 offen sc1
  v_mfma_f32_16x16x32_bf16 v[72:75], a[68:71], v[192:195], v[72:75]
  v_add_u32 v19, s33, v15
  s_add_u32 s33, s33, 16384
  v_mfma_f32_16x16x32_bf16 v[76:79], a[60:63], v[196:199], v[76:79]
  ds_read_b128 v[164:167], v18 offset:2048
  v_mfma_f32_16x16x32_bf16 v[80:83], a[64:67], v[196:199], v[80:83]
  buffer_load_dwordx4 v10, s[8:11], s30 offen offset:0 lds
  v_mfma_f32_16x16x32_bf16 v[84:87], a[68:71], v[196:199], v[84:87]
  s_cmp_lt_u32 s33, 98304
  s_cselect_b32 s33, s33, 0
  v_mfma_f32_16x16x32_bf16 v[88:91], a[60:63], v[200:203], v[88:91]
  ds_read_b128 v[168:171], v18 offset:4096
  v_mfma_f32_16x16x32_bf16 v[92:95], a[64:67], v[200:203], v[92:95]
  v_exp_f32 v47, v47
  v_mfma_f32_16x16x32_bf16 v[96:99], a[68:71], v[200:203], v[96:99]
  v_exp_f32 v48, v48
  v_mfma_f32_16x16x32_bf16 v[100:103], a[60:63], v[204:207], v[100:103]
  ds_read_b128 v[172:175], v18 offset:6144
  v_mfma_f32_16x16x32_bf16 v[104:107], a[64:67], v[204:207], v[104:107]
  v_exp_f32 v49, v49
  v_mfma_f32_16x16x32_bf16 v[108:111], a[68:71], v[204:207], v[108:111]
  s_waitcnt lgkmcnt(4)
  v_mfma_f32_16x16x32_bf16 v[112:115], a[60:63], v[208:211], v[112:115]
  ds_read_b128 v[176:179], v18 offset:8192
  v_mfma_f32_16x16x32_bf16 v[116:119], a[64:67], v[208:211], v[116:119]
  v_exp_f32 v50, v50
  v_mfma_f32_16x16x32_bf16 v[120:123], a[68:71], v[208:211], v[120:123]
  v_exp_f32 v51, v51
  v_mfma_f32_16x16x32_bf16 v[124:127], a[60:63], v[212:215], v[124:127]
  ds_read_b128 v[180:183], v18 offset:10240
  v_mfma_f32_16x16x32_bf16 v[128:131], a[64:67], v[212:215], v[128:131]
  buffer_load_dwordx4 v11, s[8:11], s30 offen offset:1024 lds
  v_mfma_f32_16x16x32_bf16 v[132:135], a[68:71], v[212:215], v[132:135]
  v_exp_f32 v52, v52
  v_mfma_f32_16x16x32_bf16 v[136:139], a[60:63], v[216:219], v[136:139]
  ds_read_b128 v[184:187], v18 offset:12288
  v_mfma_f32_16x16x32_bf16 v[140:143], a[64:67], v[216:219], v[140:143]
  v_exp_f32 v53, v53
  v_mfma_f32_16x16x32_bf16 v[144:147], a[68:71], v[216:219], v[144:147]
  v_exp_f32 v54, v54
  v_mfma_f32_16x16x32_bf16 v[148:151], a[60:63], v[220:223], v[148:151]
  ds_read_b128 v[188:191], v18 offset:14336
  v_mfma_f32_16x16x32_bf16 v[152:155], a[64:67], v[220:223], v[152:155]
  v_exp_f32 v55, v55
  v_mfma_f32_16x16x32_bf16 v[156:159], a[68:71], v[220:223], v[156:159]
  s_waitcnt lgkmcnt(4)
  s_nop 0
  v_mfma_f32_16x16x32_bf16 v[64:67], a[72:75], v[160:163], v[64:67]
  ds_read_b128 v[192:195], v19 offset:0
  v_add_f32 v56, v52, v53
  v_mfma_f32_16x16x32_bf16 v[68:71], a[76:79], v[160:163], v[68:71]
  v_add_u32 v18, s33, v14
  v_add_f32 v56, v56, v54
  v_mfma_f32_16x16x32_bf16 v[72:75], a[80:83], v[160:163], v[72:75]
  v_add_f32 v56, v56, v55
  v_cndmask_b32 v56, 0, v56, s[60:61]
  v_mfma_f32_16x16x32_bf16 v[76:79], a[72:75], v[164:167], v[76:79]
  ds_read_b128 v[196:199], v19 offset:2048
  v_add_f32 v56, v56, v44
  v_mfma_f32_16x16x32_bf16 v[80:83], a[76:79], v[164:167], v[80:83]
  buffer_load_dwordx4 v12, s[8:11], s30 offen offset:2048 lds
  v_mfma_f32_16x16x32_bf16 v[84:87], a[80:83], v[164:167], v[84:87]
  v_add_f32 v56, v56, v45
  v_add_f32 v56, v56, v46
  v_mfma_f32_16x16x32_bf16 v[88:91], a[72:75], v[168:171], v[88:91]
  ds_read_b128 v[200:203], v19 offset:4096
  v_add_f32 v56, v56, v47
  v_mfma_f32_16x16x32_bf16 v[92:95], a[76:79], v[168:171], v[92:95]
  v_add_f32 v56, v56, v48
  v_add_f32 v56, v56, v49
  v_mfma_f32_16x16x32_bf16 v[96:99], a[80:83], v[168:171], v[96:99]
  v_add_f32 v56, v56, v50
  v_add_f32 v56, v56, v51
  v_mfma_f32_16x16x32_bf16 v[100:103], a[72:75], v[172:175], v[100:103]
  ds_read_b128 v[204:207], v19 offset:6144
  v_mov_b32 v57, v56
  v_mfma_f32_16x16x32_bf16 v[104:107], a[76:79], v[172:175], v[104:107]
  s_nop 1
  v_mfma_f32_16x16x32_bf16 v[108:111], a[80:83], v[172:175], v[108:111]
  s_waitcnt lgkmcnt(4)
  v_mfma_f32_16x16x32_bf16 v[112:115], a[72:75], v[176:179], v[112:115]
  ds_read_b128 v[208:211], v19 offset:8192
  v_mfma_f32_16x16x32_bf16 v[116:119], a[76:79], v[176:179], v[116:119]
  v_permlane32_swap_b32 v56, v57
  v_mfma_f32_16x16x32_bf16 v[120:123], a[80:83], v[176:179], v[120:123]
  v_add_f32 v56, v56, v57
  v_mov_b32 v57, v56
  v_mfma_f32_16x16x32_bf16 v[124:127], a[72:75], v[180:183], v[124:127]
  ds_read_b128 v[212:215], v19 offset:10240
  v_mfma_f32_16x16x32_bf16 v[128:131], a[76:79], v[180:183], v[128:131]
  buffer_load_dwordx4 v13, s[8:11], s30 offen offset:3072 lds
  v_mfma_f32_16x16x32_bf16 v[132:135], a[80:83], v[180:183], v[132:135]
  s_add_u32 s30, s30, 128
  s_add_u32 m0, m0, 16384
  v_mfma_f32_16x16x32_bf16 v[136:139], a[72:75], v[184:187], v[136:139]
  ds_read_b128 v[216:219], v19 offset:12288
  v_mfma_f32_16x16x32_bf16 v[140:143], a[76:79], v[184:187], v[140:143]
  s_cmp_lt_u32 m0, s46
  s_cselect_b32 m0, m0, s47
  v_mfma_f32_16x16x32_bf16 v[144:147], a[80:83], v[184:187], v[144:147]
  s_nop 1
  v_mfma_f32_16x16x32_bf16 v[148:151], a[72:75], v[188:191], v[148:151]
  ds_read_b128 v[220:223], v19 offset:14336
  v_mfma_f32_16x16x32_bf16 v[152:155], a[76:79], v[188:191], v[152:155]
  v_permlane16_swap_b32 v56, v57
  v_mfma_f32_16x16x32_bf16 v[156:159], a[80:83], v[188:191], v[156:159]
  s_waitcnt vmcnt(13) lgkmcnt(4)
  s_barrier
  v_mfma_f32_16x16x32_bf16 v[64:67], a[84:87], v[192:195], v[64:67]
  ds_read_b128 v[160:163], v18 offset:0
  v_add_f32 v56, v56, v57
  v_mfma_f32_16x16x32_bf16 v[68:71], a[88:91], v[192:195], v[68:71]
  v_rcp_f32 v56, v56
  v_mfma_f32_16x16x32_bf16 v[72:75], a[92:95], v[192:195], v[72:75]
  v_add_u32 v19, s33, v15
  s_add_u32 s33, s33, 16384
  v_mfma_f32_16x16x32_bf16 v[76:79], a[84:87], v[196:199], v[76:79]
  ds_read_b128 v[164:167], v18 offset:2048
  s_nop 0
  v_mfma_f32_16x16x32_bf16 v[80:83], a[88:91], v[196:199], v[80:83]
  buffer_load_dwordx4 v10, s[8:11], s30 offen offset:0 lds
  v_mfma_f32_16x16x32_bf16 v[84:87], a[92:95], v[196:199], v[84:87]
  s_cmp_lt_u32 s33, 98304
  s_cselect_b32 s33, s33, 0
  v_mfma_f32_16x16x32_bf16 v[88:91], a[84:87], v[200:203], v[88:91]
  ds_read_b128 v[168:171], v18 offset:4096
  v_mul_f32 v44, v44, v56
  v_mfma_f32_16x16x32_bf16 v[92:95], a[88:91], v[200:203], v[92:95]
  v_mul_f32 v45, v45, v56
  v_mul_f32 v46, v46, v56
  v_mfma_f32_16x16x32_bf16 v[96:99], a[92:95], v[200:203], v[96:99]
  v_mul_f32 v47, v47, v56
  v_mul_f32 v48, v48, v56
  v_mfma_f32_16x16x32_bf16 v[100:103], a[84:87], v[204:207], v[100:103]
  ds_read_b128 v[172:175], v18 offset:6144
  v_mul_f32 v49, v49, v56
  v_mfma_f32_16x16x32_bf16 v[104:107], a[88:91], v[204:207], v[104:107]
  v_mul_f32 v50, v50, v56
  v_mul_f32 v51, v51, v56
  v_mfma_f32_16x16x32_bf16 v[108:111], a[92:95], v[204:207], v[108:111]
  s_waitcnt lgkmcnt(4)
  v_mul_f32 v52, v52, v56
  v_mfma_f32_16x16x32_bf16 v[112:115], a[84:87], v[208:211], v[112:115]
  ds_read_b128 v[176:179], v18 offset:8192
  v_mul_f32 v53, v53, v56
  v_mfma_f32_16x16x32_bf16 v[116:119], a[88:91], v[208:211], v[116:119]
  v_mul_f32 v54, v54, v56
  v_mul_f32 v55, v55, v56
  v_mfma_f32_16x16x32_bf16 v[120:123], a[92:95], v[208:211], v[120:123]
  v_cvt_pk_bf16_f32 v240, v40, v41
  v_cvt_pk_bf16_f32 v241, v42, v43
  v_mfma_f32_16x16x32_bf16 v[124:127], a[84:87], v[212:215], v[124:127]
  ds_read_b128 v[180:183], v18 offset:10240
  v_cvt_pk_bf16_f32 v242, v52, v53
  v_mfma_f32_16x16x32_bf16 v[128:131], a[88:91], v[212:215], v[128:131]
  buffer_load_dwordx4 v11, s[8:11], s30 offen offset:1024 lds
  v_mfma_f32_16x16x32_bf16 v[132:135], a[92:95], v[212:215], v[132:135]
  v_cvt_pk_bf16_f32 v243, v54, v55
  v_cvt_pk_bf16_f32 v236, v44, v45
  v_mfma_f32_16x16x32_bf16 v[136:139], a[84:87], v[216:219], v[136:139]
  ds_read_b128 v[184:187], v18 offset:12288
  v_cvt_pk_bf16_f32 v237, v46, v47
  v_mfma_f32_16x16x32_bf16 v[140:143], a[88:91], v[216:219], v[140:143]
  v_cvt_pk_bf16_f32 v238, v48, v49
  v_cvt_pk_bf16_f32 v239, v50, v51
  v_mfma_f32_16x16x32_bf16 v[144:147], a[92:95], v[216:219], v[144:147]
  v_cvt_pk_bf16_f32 v244, v36, v37
  v_cvt_pk_bf16_f32 v245, v38, v39
  v_mfma_f32_16x16x32_bf16 v[148:151], a[84:87], v[220:223], v[148:151]
  ds_read_b128 v[188:191], v18 offset:14336
  v_mfma_f32_16x16x32_bf16 v[152:155], a[88:91], v[220:223], v[152:155]
  v_permlane16_swap_b32 v240, v242
  v_mfma_f32_16x16x32_bf16 v[156:159], a[92:95], v[220:223], v[156:159]
  s_waitcnt lgkmcnt(4)
  v_mfma_f32_16x16x32_bf16 v[64:67], a[96:99], v[160:163], v[64:67]
  ds_read_b128 v[192:195], v19 offset:0
  v_mfma_f32_16x16x32_bf16 v[68:71], a[100:103], v[160:163], v[68:71]
  v_add_u32 v18, s33, v14
  v_mfma_f32_16x16x32_bf16 v[72:75], a[104:107], v[160:163], v[72:75]
  v_permlane16_swap_b32 v241, v243
  v_mfma_f32_16x16x32_bf16 v[76:79], a[96:99], v[164:167], v[76:79]
  ds_read_b128 v[196:199], v19 offset:2048
  v_mfma_f32_16x16x32_bf16 v[80:83], a[100:103], v[164:167], v[80:83]
  buffer_load_dwordx4 v12, s[8:11], s30 offen offset:2048 lds
  v_mfma_f32_16x16x32_bf16 v[84:87], a[104:107], v[164:167], v[84:87]
  v_mfma_f32_16x16x32_bf16 v[88:91], a[96:99], v[168:171], v[88:91]
  ds_read_b128 v[200:203], v19 offset:4096
  v_mfma_f32_16x16x32_bf16 v[92:95], a[100:103], v[168:171], v[92:95]
  v_mfma_f32_16x16x32_bf16 v[96:99], a[104:107], v[168:171], v[96:99]
  v_mfma_f32_16x16x32_bf16 v[100:103], a[96:99], v[172:175], v[100:103]
  ds_read_b128 v[204:207], v19 offset:6144
  v_mfma_f32_16x16x32_bf16 v[104:107], a[100:103], v[172:175], v[104:107]
  v_mfma_f32_16x16x32_bf16 v[108:111], a[104:107], v[172:175], v[108:111]
  s_waitcnt lgkmcnt(4)
  v_mfma_f32_16x16x32_bf16 v[112:115], a[96:99], v[176:179], v[112:115]
  ds_read_b128 v[208:211], v19 offset:8192
  v_mfma_f32_16x16x32_bf16 v[116:119], a[100:103], v[176:179], v[116:119]
  v_mfma_f32_16x16x32_bf16 v[120:123], a[104:107], v[176:179], v[120:123]
  v_mfma_f32_16x16x32_bf16 v[124:127], a[96:99], v[180:183], v[124:127]
  ds_read_b128 v[212:215], v19 offset:10240
  v_mfma_f32_16x16x32_bf16 v[128:131], a[100:103], v[180:183], v[128:131]
  buffer_load_dwordx4 v13, s[8:11], s30 offen offset:3072 lds
  v_mfma_f32_16x16x32_bf16 v[132:135], a[104:107], v[180:183], v[132:135]
  s_add_u32 s30, s30, 128
  s_add_u32 m0, m0, 16384
  v_mfma_f32_16x16x32_bf16 v[136:139], a[96:99], v[184:187], v[136:139]
  ds_read_b128 v[216:219], v19 offset:12288
  v_mfma_f32_16x16x32_bf16 v[140:143], a[100:103], v[184:187], v[140:143]
  s_cmp_lt_u32 m0, s46
  s_cselect_b32 m0, m0, s47
  v_mfma_f32_16x16x32_bf16 v[144:147], a[104:107], v[184:187], v[144:147]
  v_mfma_f32_16x16x32_bf16 v[148:151], a[96:99], v[188:191], v[148:151]
  ds_read_b128 v[220:223], v19 offset:14336
  v_mfma_f32_16x16x32_bf16 v[152:155], a[100:103], v[188:191], v[152:155]
  v_mfma_f32_16x16x32_bf16 v[156:159], a[104:107], v[188:191], v[156:159]
  s_waitcnt vmcnt(13) lgkmcnt(4)
  s_barrier
  v_mfma_f32_16x16x32_bf16 v[64:67], a[108:111], v[192:195], v[64:67]
  ds_read_b128 v[160:163], v18 offset:0
  v_mfma_f32_16x16x32_bf16 v[68:71], a[112:115], v[192:195], v[68:71]
  v_mfma_f32_16x16x32_bf16 v[72:75], a[116:119], v[192:195], v[72:75]
  v_add_u32 v19, s33, v15
  s_add_u32 s33, s33, 16384
  v_mfma_f32_16x16x32_bf16 v[76:79], a[108:111], v[196:199], v[76:79]
  ds_read_b128 v[164:167], v18 offset:2048
  v_mfma_f32_16x16x32_bf16 v[80:83], a[112:115], v[196:199], v[80:83]
  buffer_load_dwordx4 v10, s[8:11], s30 offen offset:0 lds
  v_mfma_f32_16x16x32_bf16 v[84:87], a[116:119], v[196:199], v[84:87]
  s_cmp_lt_u32 s33, 98304
  s_cselect_b32 s33, s33, 0
  v_mfma_f32_16x16x32_bf16 v[88:91], a[108:111], v[200:203], v[88:91]
  ds_read_b128 v[168:171], v18 offset:4096
  v_mfma_f32_16x16x32_bf16 v[92:95], a[112:115], v[200:203], v[92:95]
  v_mfma_f32_16x16x32_bf16 v[96:99], a[116:119], v[200:203], v[96:99]
  v_mfma_f32_16x16x32_bf16 v[100:103], a[108:111], v[204:207], v[100:103]
  ds_read_b128 v[172:175], v18 offset:6144
  v_mfma_f32_16x16x32_bf16 v[104:107], a[112:115], v[204:207], v[104:107]
  v_mfma_f32_16x16x32_bf16 v[108:111], a[116:119], v[204:207], v[108:111]
  s_waitcnt lgkmcnt(4)
  v_mfma_f32_16x16x32_bf16 v[112:115], a[108:111], v[208:211], v[112:115]
  ds_read_b128 v[176:179], v18 offset:8192
  v_mfma_f32_16x16x32_bf16 v[116:119], a[112:115], v[208:211], v[116:119]
  v_mfma_f32_16x16x32_bf16 v[120:123], a[116:119], v[208:211], v[120:123]
  v_mfma_f32_16x16x32_bf16 v[124:127], a[108:111], v[212:215], v[124:127]
  ds_read_b128 v[180:183], v18 offset:10240
  v_mfma_f32_16x16x32_bf16 v[128:131], a[112:115], v[212:215], v[128:131]
  buffer_load_dwordx4 v11, s[8:11], s30 offen offset:1024 lds
  v_mfma_f32_16x16x32_bf16 v[132:135], a[116:119], v[212:215], v[132:135]
  v_mfma_f32_16x16x32_bf16 v[136:139], a[108:111], v[216:219], v[136:139]
  ds_read_b128 v[184:187], v18 offset:12288
  v_mfma_f32_16x16x32_bf16 v[140:143], a[112:115], v[216:219], v[140:143]
  v_mfma_f32_16x16x32_bf16 v[144:147], a[116:119], v[216:219], v[144:147]
  v_mfma_f32_16x16x32_bf16 v[148:151], a[108:111], v[220:223], v[148:151]
  ds_read_b128 v[188:191], v18 offset:14336
  v_mfma_f32_16x16x32_bf16 v[152:155], a[112:115], v[220:223], v[152:155]
  v_mfma_f32_16x16x32_bf16 v[156:159], a[116:119], v[220:223], v[156:159]
  s_waitcnt lgkmcnt(4)
  v_mfma_f32_16x16x32_bf16 v[64:67], a[120:123], v[160:163], v[64:67]
  ds_read_b128 v[192:195], v19 offset:0
  v_mfma_f32_16x16x32_bf16 v[68:71], a[124:127], v[160:163], v[68:71]
  v_add_u32 v18, s33, v14
  v_mfma_f32_16x16x32_bf16 v[72:75], a[128:131], v[160:163], v[72:75]
  v_mfma_f32_16x16x32_bf16 v[76:79], a[120:123], v[164:167], v[76:79]
  ds_read_b128 v[196:199], v19 offset:2048
  v_mfma_f32_16x16x32_bf16 v[80:83], a[124:127], v[164:167], v[80:83]
  buffer_load_dwordx4 v12, s[8:11], s30 offen offset:2048 lds
  v_mfma_f32_16x16x32_bf16 v[84:87], a[128:131], v[164:167], v[84:87]
  v_mfma_f32_16x16x32_bf16 v[88:91], a[120:123], v[168:171], v[88:91]
  ds_read_b128 v[200:203], v19 offset:4096
  v_mfma_f32_16x16x32_bf16 v[92:95], a[124:127], v[168:171], v[92:95]
  v_mfma_f32_16x16x32_bf16 v[96:99], a[128:131], v[168:171], v[96:99]
  v_mfma_f32_16x16x32_bf16 v[100:103], a[120:123], v[172:175], v[100:103]
  ds_read_b128 v[204:207], v19 offset:6144
  v_mfma_f32_16x16x32_bf16 v[104:107], a[124:127], v[172:175], v[104:107]
  v_mfma_f32_16x16x32_bf16 v[108:111], a[128:131], v[172:175], v[108:111]
  s_waitcnt lgkmcnt(4)
  v_mfma_f32_16x16x32_bf16 v[112:115], a[120:123], v[176:179], v[112:115]
  ds_read_b128 v[208:211], v19 offset:8192
  v_mfma_f32_16x16x32_bf16 v[116:119], a[124:127], v[176:179], v[116:119]
  v_mfma_f32_16x16x32_bf16 v[120:123], a[128:131], v[176:179], v[120:123]
  v_mfma_f32_16x16x32_bf16 v[124:127], a[120:123], v[180:183], v[124:127]
  ds_read_b128 v[212:215], v19 offset:10240
  v_mfma_f32_16x16x32_bf16 v[128:131], a[124:127], v[180:183], v[128:131]
  buffer_load_dwordx4 v13, s[8:11], s30 offen offset:3072 lds
  v_mfma_f32_16x16x32_bf16 v[132:135], a[128:131], v[180:183], v[132:135]
  s_add_u32 s30, s30, s25
  s_sub_u32 s30, s30, 1152
  v_mfma_f32_16x16x32_bf16 v[136:139], a[120:123], v[184:187], v[136:139]
  ds_read_b128 v[216:219], v19 offset:12288
  s_mov_b32 s25, 163840
  v_mfma_f32_16x16x32_bf16 v[140:143], a[124:127], v[184:187], v[140:143]
  s_add_u32 m0, m0, 16384
  v_mfma_f32_16x16x32_bf16 v[144:147], a[128:131], v[184:187], v[144:147]
  s_cmp_lt_u32 m0, s46
  s_cselect_b32 m0, m0, s47
  v_mfma_f32_16x16x32_bf16 v[148:151], a[120:123], v[188:191], v[148:151]
  ds_read_b128 v[220:223], v19 offset:14336
  v_mfma_f32_16x16x32_bf16 v[152:155], a[124:127], v[188:191], v[152:155]
  v_mfma_f32_16x16x32_bf16 v[156:159], a[128:131], v[188:191], v[156:159]
  s_waitcnt vmcnt(13) lgkmcnt(4)
  s_barrier
  v_mfma_f32_16x16x32_bf16 v[64:67], a[132:135], v[192:195], v[64:67]
  ds_read_b128 v[160:163], v18 offset:0
  v_mfma_f32_16x16x32_bf16 v[68:71], a[136:139], v[192:195], v[68:71]
  buffer_store_dwordx4 v[236:239], v30, s[56:59], s81 offen sc1
  s_mov_b64 exec, 0xffffffff
  buffer_store_dwordx4 v[240:243], v30, s[56:59], s81 offen offset:1024 sc1
  s_mov_b64 exec, -1
  buffer_store_dwordx2 v[244:245], v32, s[56:59], s81 offen offset:2048 sc1
  s_mov_b32 s78, s82
  s_mov_b32 s82, 0
  s_mov_b32 s81, 0x80000000
  v_mfma_f32_16x16x32_bf16 v[72:75], a[140:143], v[192:195], v[72:75]
  v_add_u32 v19, s33, v15
  s_add_u32 s33, s33, 16384
  v_mfma_f32_16x16x32_bf16 v[76:79], a[132:135], v[196:199], v[76:79]
  ds_read_b128 v[164:167], v18 offset:2048
  v_mfma_f32_16x16x32_bf16 v[80:83], a[136:139], v[196:199], v[80:83]
  buffer_load_dwordx4 v10, s[8:11], s30 offen offset:0 lds
  v_mfma_f32_16x16x32_bf16 v[84:87], a[140:143], v[196:199], v[84:87]
  s_cmp_lt_u32 s33, 98304
  s_cselect_b32 s33, s33, 0
  v_mfma_f32_16x16x32_bf16 v[88:91], a[132:135], v[200:203], v[88:91]
  ds_read_b128 v[168:171], v18 offset:4096
  v_mfma_f32_16x16x32_bf16 v[92:95], a[136:139], v[200:203], v[92:95]
  v_mfma_f32_16x16x32_bf16 v[96:99], a[140:143], v[200:203], v[96:99]
  v_mfma_f32_16x16x32_bf16 v[100:103], a[132:135], v[204:207], v[100:103]
  ds_read_b128 v[172:175], v18 offset:6144
  v_mfma_f32_16x16x32_bf16 v[104:107], a[136:139], v[204:207], v[104:107]
  v_mfma_f32_16x16x32_bf16 v[108:111], a[140:143], v[204:207], v[108:111]
  s_waitcnt lgkmcnt(4)
  v_mfma_f32_16x16x32_bf16 v[112:115], a[132:135], v[208:211], v[112:115]
  ds_read_b128 v[176:179], v18 offset:8192
  v_mfma_f32_16x16x32_bf16 v[116:119], a[136:139], v[208:211], v[116:119]
  v_mfma_f32_16x16x32_bf16 v[120:123], a[140:143], v[208:211], v[120:123]
  v_mfma_f32_16x16x32_bf16 v[124:127], a[132:135], v[212:215], v[124:127]
  ds_read_b128 v[180:183], v18 offset:10240
  v_mfma_f32_16x16x32_bf16 v[128:131], a[136:139], v[212:215], v[128:131]
  buffer_load_dwordx4 v11, s[8:11], s30 offen offset:1024 lds
  v_mfma_f32_16x16x32_bf16 v[132:135], a[140:143], v[212:215], v[132:135]
  v_mfma_f32_16x16x32_bf16 v[136:139], a[132:135], v[216:219], v[136:139]
  ds_read_b128 v[184:187], v18 offset:12288
  v_mfma_f32_16x16x32_bf16 v[140:143], a[136:139], v[216:219], v[140:143]
  v_mfma_f32_16x16x32_bf16 v[144:147], a[140:143], v[216:219], v[144:147]
  v_mfma_f32_16x16x32_bf16 v[148:151], a[132:135], v[220:223], v[148:151]
  ds_read_b128 v[188:191], v18 offset:14336
  v_mfma_f32_16x16x32_bf16 v[152:155], a[136:139], v[220:223], v[152:155]
  v_mfma_f32_16x16x32_bf16 v[156:159], a[140:143], v[220:223], v[156:159]
  s_waitcnt lgkmcnt(4)
  v_mfma_f32_16x16x32_bf16 v[64:67], a[144:147], v[160:163], v[64:67]
  ds_read_b128 v[192:195], v19 offset:0
  v_mfma_f32_16x16x32_bf16 v[68:71], a[148:151], v[160:163], v[68:71]
  v_add_u32 v18, s33, v14
  v_mfma_f32_16x16x32_bf16 v[72:75], a[152:155], v[160:163], v[72:75]
  v_mfma_f32_16x16x32_bf16 v[76:79], a[144:147], v[164:167], v[76:79]
  ds_read_b128 v[196:199], v19 offset:2048
  v_mfma_f32_16x16x32_bf16 v[80:83], a[148:151], v[164:167], v[80:83]
  buffer_load_dwordx4 v12, s[8:11], s30 offen offset:2048 lds
  v_mfma_f32_16x16x32_bf16 v[84:87], a[152:155], v[164:167], v[84:87]
  v_mfma_f32_16x16x32_bf16 v[88:91], a[144:147], v[168:171], v[88:91]
  ds_read_b128 v[200:203], v19 offset:4096
  v_mfma_f32_16x16x32_bf16 v[92:95], a[148:151], v[168:171], v[92:95]
  v_mfma_f32_16x16x32_bf16 v[96:99], a[152:155], v[168:171], v[96:99]
  v_mfma_f32_16x16x32_bf16 v[100:103], a[144:147], v[172:175], v[100:103]
  ds_read_b128 v[204:207], v19 offset:6144
  v_mfma_f32_16x16x32_bf16 v[104:107], a[148:151], v[172:175], v[104:107]
  v_mfma_f32_16x16x32_bf16 v[108:111], a[152:155], v[172:175], v[108:111]
  s_waitcnt lgkmcnt(4)
  v_mfma_f32_16x16x32_bf16 v[112:115], a[144:147], v[176:179], v[112:115]
  ds_read_b128 v[208:211], v19 offset:8192
  v_mfma_f32_16x16x32_bf16 v[116:119], a[148:151], v[176:179], v[116:119]
  v_mfma_f32_16x16x32_bf16 v[120:123], a[152:155], v[176:179], v[120:123]
  v_mfma_f32_16x16x32_bf16 v[124:127], a[144:147], v[180:183], v[124:127]
  ds_read_b128 v[212:215], v19 offset:10240
  v_mfma_f32_16x16x32_bf16 v[128:131], a[148:151], v[180:183], v[128:131]
  buffer_load_dwordx4 v13, s[8:11], s30 offen offset:3072 lds
  v_mfma_f32_16x16x32_bf16 v[132:135], a[152:155], v[180:183], v[132:135]
  s_add_u32 s30, s30, 128
  s_add_u32 m0, m0, 16384
  v_mfma_f32_16x16x32_bf16 v[136:139], a[144:147], v[184:187], v[136:139]
  ds_read_b128 v[216:219], v19 offset:12288
  v_mfma_f32_16x16x32_bf16 v[140:143], a[148:151], v[184:187], v[140:143]
  s_cmp_lt_u32 m0, s46
  s_cselect_b32 m0, m0, s47
  v_mfma_f32_16x16x32_bf16 v[144:147], a[152:155], v[184:187], v[144:147]
  v_mfma_f32_16x16x32_bf16 v[148:151], a[144:147], v[188:191], v[148:151]
  ds_read_b128 v[220:223], v19 offset:14336
  v_mfma_f32_16x16x32_bf16 v[152:155], a[148:151], v[188:191], v[152:155]
  v_mfma_f32_16x16x32_bf16 v[156:159], a[152:155], v[188:191], v[156:159]
  s_waitcnt vmcnt(15) lgkmcnt(4)
  s_barrier
  v_mfma_f32_16x16x32_bf16 v[64:67], a[156:159], v[192:195], v[64:67]
  ds_read_b128 v[160:163], v18 offset:0
  v_mfma_f32_16x16x32_bf16 v[68:71], a[160:163], v[192:195], v[68:71]
  v_readfirstlane_b32 s79, v20
  v_mfma_f32_16x16x32_bf16 v[72:75], a[164:167], v[192:195], v[72:75]
  v_add_u32 v19, s33, v15
  s_add_u32 s33, s33, 16384
  v_mfma_f32_16x16x32_bf16 v[76:79], a[156:159], v[196:199], v[76:79]
  ds_read_b128 v[164:167], v18 offset:2048
  s_add_u32 s21, s50, 0
  v_mfma_f32_16x16x32_bf16 v[80:83], a[160:163], v[196:199], v[80:83]
  buffer_load_dwordx4 v10, s[8:11], s30 offen offset:0 lds
  v_mfma_f32_16x16x32_bf16 v[84:87], a[164:167], v[196:199], v[84:87]
  s_cmp_lt_u32 s33, 98304
  s_cselect_b32 s33, s33, 0
  v_mfma_f32_16x16x32_bf16 v[88:91], a[156:159], v[200:203], v[88:91]
  ds_read_b128 v[168:171], v18 offset:4096
  v_mfma_f32_16x16x32_bf16 v[92:95], a[160:163], v[200:203], v[92:95]
  buffer_load_dwordx4 v[36:39], v30, s[16:19], s21 offen offset:0 sc1
  v_mfma_f32_16x16x32_bf16 v[96:99], a[164:167], v[200:203], v[96:99]
  v_mfma_f32_16x16x32_bf16 v[100:103], a[156:159], v[204:207], v[100:103]
  ds_read_b128 v[172:175], v18 offset:6144
  v_mfma_f32_16x16x32_bf16 v[104:107], a[160:163], v[204:207], v[104:107]
  v_mfma_f32_16x16x32_bf16 v[108:111], a[164:167], v[204:207], v[108:111]
  s_waitcnt lgkmcnt(4)
  v_mfma_f32_16x16x32_bf16 v[112:115], a[156:159], v[208:211], v[112:115]
  ds_read_b128 v[176:179], v18 offset:8192
  v_mfma_f32_16x16x32_bf16 v[116:119], a[160:163], v[208:211], v[116:119]
  buffer_load_dwordx4 v[40:43], v30, s[16:19], s21 offen offset:1024 sc1
  v_mfma_f32_16x16x32_bf16 v[120:123], a[164:167], v[208:211], v[120:123]
  v_mfma_f32_16x16x32_bf16 v[124:127], a[156:159], v[212:215], v[124:127]
  ds_read_b128 v[180:183], v18 offset:10240
  v_mfma_f32_16x16x32_bf16 v[128:131], a[160:163], v[212:215], v[128:131]
  buffer_load_dwordx4 v11, s[8:11], s30 offen offset:1024 lds
  v_mfma_f32_16x16x32_bf16 v[132:135], a[164:167], v[212:215], v[132:135]
  v_mfma_f32_16x16x32_bf16 v[136:139], a[156:159], v[216:219], v[136:139]
  ds_read_b128 v[184:187], v18 offset:12288
  v_mfma_f32_16x16x32_bf16 v[140:143], a[160:163], v[216:219], v[140:143]
  buffer_load_dwordx4 v[44:47], v30, s[16:19], s21 offen offset:2048 sc1
  v_mfma_f32_16x16x32_bf16 v[144:147], a[164:167], v[216:219], v[144:147]
  v_mfma_f32_16x16x32_bf16 v[148:151], a[156:159], v[220:223], v[148:151]
  ds_read_b128 v[188:191], v18 offset:14336
  v_mfma_f32_16x16x32_bf16 v[152:155], a[160:163], v[220:223], v[152:155]
  v_mfma_f32_16x16x32_bf16 v[156:159], a[164:167], v[220:223], v[156:159]
  s_waitcnt lgkmcnt(4)
  v_mfma_f32_16x16x32_bf16 v[64:67], a[168:171], v[160:163], v[64:67]
  ds_read_b128 v[192:195], v19 offset:0
  v_mfma_f32_16x16x32_bf16 v[68:71], a[172:175], v[160:163], v[68:71]
  v_add_u32 v18, s33, v14
  v_mfma_f32_16x16x32_bf16 v[72:75], a[176:179], v[160:163], v[72:75]
  buffer_load_dwordx4 v[48:51], v30, s[16:19], s21 offen offset:3072 sc1
  v_mfma_f32_16x16x32_bf16 v[76:79], a[168:171], v[164:167], v[76:79]
  ds_read_b128 v[196:199], v19 offset:2048
  v_mfma_f32_16x16x32_bf16 v[80:83], a[172:175], v[164:167], v[80:83]
  buffer_load_dwordx4 v12, s[8:11], s30 offen offset:2048 lds
  v_mfma_f32_16x16x32_bf16 v[84:87], a[176:179], v[164:167], v[84:87]
  v_mfma_f32_16x16x32_bf16 v[88:91], a[168:171], v[168:171], v[88:91]
  ds_read_b128 v[200:203], v19 offset:4096
  v_mfma_f32_16x16x32_bf16 v[92:95], a[172:175], v[168:171], v[92:95]
  s_add_u32 s21, s50, 4096
  v_mfma_f32_16x16x32_bf16 v[96:99], a[176:179], v[168:171], v[96:99]
  buffer_load_dwordx4 v[52:55], v30, s[16:19], s21 offen offset:0 sc1
  v_mfma_f32_16x16x32_bf16 v[100:103], a[168:171], v[172:175], v[100:103]
  ds_read_b128 v[204:207], v19 offset:6144
  v_mfma_f32_16x16x32_bf16 v[104:107], a[172:175], v[172:175], v[104:107]
  v_mfma_f32_16x16x32_bf16 v[108:111], a[176:179], v[172:175], v[108:111]
  s_waitcnt lgkmcnt(4)
  v_mfma_f32_16x16x32_bf16 v[112:115], a[168:171], v[176:179], v[112:115]
  ds_read_b128 v[208:211], v19 offset:8192
  v_mfma_f32_16x16x32_bf16 v[116:119], a[172:175], v[176:179], v[116:119]
  buffer_load_dwordx4 v[56:59], v30, s[16:19], s21 offen offset:1024 sc1
  v_mfma_f32_16x16x32_bf16 v[120:123], a[176:179], v[176:179], v[120:123]
  v_mfma_f32_16x16x32_bf16 v[124:127], a[168:171], v[180:183], v[124:127]
  ds_read_b128 v[212:215], v19 offset:10240
  v_mfma_f32_16x16x32_bf16 v[128:131], a[172:175], v[180:183], v[128:131]
  buffer_load_dwordx4 v13, s[8:11], s30 offen offset:3072 lds
  v_mfma_f32_16x16x32_bf16 v[132:135], a[176:179], v[180:183], v[132:135]
  s_add_u32 s30, s30, 128
  s_add_u32 m0, m0, 16384
  v_mfma_f32_16x16x32_bf16 v[136:139], a[168:171], v[184:187], v[136:139]
  ds_read_b128 v[216:219], v19 offset:12288
  v_mfma_f32_16x16x32_bf16 v[140:143], a[172:175], v[184:187], v[140:143]
  s_cmp_lt_u32 m0, s46
  s_cselect_b32 m0, m0, s47
  v_mfma_f32_16x16x32_bf16 v[144:147], a[176:179], v[184:187], v[144:147]
  buffer_load_dwordx4 v[60:63], v30, s[16:19], s21 offen offset:2048 sc1
  v_mfma_f32_16x16x32_bf16 v[148:151], a[168:171], v[188:191], v[148:151]
  ds_read_b128 v[220:223], v19 offset:14336
  v_mfma_f32_16x16x32_bf16 v[152:155], a[172:175], v[188:191], v[152:155]
  v_mfma_f32_16x16x32_bf16 v[156:159], a[176:179], v[188:191], v[156:159]
  s_waitcnt vmcnt(22) lgkmcnt(4)
  s_barrier
  v_mfma_f32_16x16x32_bf16 v[64:67], a[180:183], v[192:195], v[64:67]
  ds_read_b128 v[160:163], v18 offset:0
  v_mfma_f32_16x16x32_bf16 v[68:71], a[184:187], v[192:195], v[68:71]
  buffer_load_dwordx4 v[236:239], v30, s[16:19], s21 offen offset:3072 sc1
  v_mfma_f32_16x16x32_bf16 v[72:75], a[188:191], v[192:195], v[72:75]
  v_add_u32 v19, s33, v15
  s_add_u32 s33, s33, 16384
  v_mfma_f32_16x16x32_bf16 v[76:79], a[180:183], v[196:199], v[76:79]
  ds_read_b128 v[164:167], v18 offset:2048
  v_mfma_f32_16x16x32_bf16 v[80:83], a[184:187], v[196:199], v[80:83]
  buffer_load_dwordx4 v10, s[8:11], s30 offen offset:0 lds
  v_mfma_f32_16x16x32_bf16 v[84:87], a[188:191], v[196:199], v[84:87]
  s_cmp_lt_u32 s33, 98304
  s_cselect_b32 s33, s33, 0
  v_mfma_f32_16x16x32_bf16 v[88:91], a[180:183], v[200:203], v[88:91]
  ds_read_b128 v[168:171], v18 offset:4096
  s_add_u32 s21, s50, 8192
  v_mfma_f32_16x16x32_bf16 v[92:95], a[184:187], v[200:203], v[92:95]
  buffer_load_dwordx4 v[240:243], v30, s[16:19], s21 offen offset:0 sc1
  v_mfma_f32_16x16x32_bf16 v[96:99], a[188:191], v[200:203], v[96:99]
  v_mfma_f32_16x16x32_bf16 v[100:103], a[180:183], v[204:207], v[100:103]
  ds_read_b128 v[172:175], v18 offset:6144
  v_mfma_f32_16x16x32_bf16 v[104:107], a[184:187], v[204:207], v[104:107]
  v_mfma_f32_16x16x32_bf16 v[108:111], a[188:191], v[204:207], v[108:111]
  s_waitcnt lgkmcnt(4)
  v_mfma_f32_16x16x32_bf16 v[112:115], a[180:183], v[208:211], v[112:115]
  ds_read_b128 v[176:179], v18 offset:8192
  v_mfma_f32_16x16x32_bf16 v[116:119], a[184:187], v[208:211], v[116:119]
  buffer_load_dwordx4 v[244:247], v30, s[16:19], s21 offen offset:1024 sc1
  v_mfma_f32_16x16x32_bf16 v[120:123], a[188:191], v[208:211], v[120:123]
  v_mfma_f32_16x16x32_bf16 v[124:127], a[180:183], v[212:215], v[124:127]
  ds_read_b128 v[180:183], v18 offset:10240
  v_mfma_f32_16x16x32_bf16 v[128:131], a[184:187], v[212:215], v[128:131]
  buffer_load_dwordx4 v11, s[8:11], s30 offen offset:1024 lds
  v_mfma_f32_16x16x32_bf16 v[132:135], a[188:191], v[212:215], v[132:135]
  v_mfma_f32_16x16x32_bf16 v[136:139], a[180:183], v[216:219], v[136:139]
  ds_read_b128 v[184:187], v18 offset:12288
  v_mfma_f32_16x16x32_bf16 v[140:143], a[184:187], v[216:219], v[140:143]
  buffer_load_dwordx4 v[248:251], v30, s[16:19], s21 offen offset:2048 sc1
  v_mfma_f32_16x16x32_bf16 v[144:147], a[188:191], v[216:219], v[144:147]
  v_mfma_f32_16x16x32_bf16 v[148:151], a[180:183], v[220:223], v[148:151]
  ds_read_b128 v[188:191], v18 offset:14336
  v_mfma_f32_16x16x32_bf16 v[152:155], a[184:187], v[220:223], v[152:155]
  v_mfma_f32_16x16x32_bf16 v[156:159], a[188:191], v[220:223], v[156:159]
  s_waitcnt lgkmcnt(4)
  v_mfma_f32_16x16x32_bf16 v[64:67], a[192:195], v[160:163], v[64:67]
  ds_read_b128 v[192:195], v19 offset:0
  v_mfma_f32_16x16x32_bf16 v[68:71], a[196:199], v[160:163], v[68:71]
  v_add_u32 v18, s33, v14
  v_mfma_f32_16x16x32_bf16 v[72:75], a[200:203], v[160:163], v[72:75]
  buffer_load_dwordx4 v[252:255], v30, s[16:19], s21 offen offset:3072 sc1
  v_mfma_f32_16x16x32_bf16 v[76:79], a[192:195], v[164:167], v[76:79]
  ds_read_b128 v[196:199], v19 offset:2048
  v_mfma_f32_16x16x32_bf16 v[80:83], a[196:199], v[164:167], v[80:83]
  buffer_load_dwordx4 v12, s[8:11], s30 offen offset:2048 lds
  v_mfma_f32_16x16x32_bf16 v[84:87], a[200:203], v[164:167], v[84:87]
  v_mfma_f32_16x16x32_bf16 v[88:91], a[192:195], v[168:171], v[88:91]
  ds_read_b128 v[200:203], v19 offset:4096
  v_mfma_f32_16x16x32_bf16 v[92:95], a[196:199], v[168:171], v[92:95]
  buffer_load_dword v21, v33, s[72:75], s77 offen sc1
  v_mfma_f32_16x16x32_bf16 v[96:99], a[200:203], v[168:171], v[96:99]
  v_mfma_f32_16x16x32_bf16 v[100:103], a[192:195], v[172:175], v[100:103]
  ds_read_b128 v[204:207], v19 offset:6144
  v_mfma_f32_16x16x32_bf16 v[104:107], a[196:199], v[172:175], v[104:107]
  v_mfma_f32_16x16x32_bf16 v[108:111], a[200:203], v[172:175], v[108:111]
  s_waitcnt lgkmcnt(4)
  v_mfma_f32_16x16x32_bf16 v[112:115], a[192:195], v[176:179], v[112:115]
  ds_read_b128 v[208:211], v19 offset:8192
  v_mfma_f32_16x16x32_bf16 v[116:119], a[196:199], v[176:179], v[116:119]
  v_mfma_f32_16x16x32_bf16 v[120:123], a[200:203], v[176:179], v[120:123]
  v_mfma_f32_16x16x32_bf16 v[124:127], a[192:195], v[180:183], v[124:127]
  ds_read_b128 v[212:215], v19 offset:10240
  v_mfma_f32_16x16x32_bf16 v[128:131], a[196:199], v[180:183], v[128:131]
  buffer_load_dwordx4 v13, s[8:11], s30 offen offset:3072 lds
  v_mfma_f32_16x16x32_bf16 v[132:135], a[200:203], v[180:183], v[132:135]
  s_add_u32 s30, s30, 128
  s_add_u32 m0, m0, 16384
  v_mfma_f32_16x16x32_bf16 v[136:139], a[192:195], v[184:187], v[136:139]
  ds_read_b128 v[216:219], v19 offset:12288
  v_mfma_f32_16x16x32_bf16 v[140:143], a[196:199], v[184:187], v[140:143]
  s_cmp_lt_u32 m0, s46
  s_cselect_b32 m0, m0, s47
  v_mfma_f32_16x16x32_bf16 v[144:147], a[200:203], v[184:187], v[144:147]
  v_mfma_f32_16x16x32_bf16 v[148:151], a[192:195], v[188:191], v[148:151]
  ds_read_b128 v[220:223], v19 offset:14336
  v_mfma_f32_16x16x32_bf16 v[152:155], a[196:199], v[188:191], v[152:155]
  v_mfma_f32_16x16x32_bf16 v[156:159], a[200:203], v[188:191], v[156:159]
  s_waitcnt vmcnt(28) lgkmcnt(4)
  s_barrier
  v_mfma_f32_16x16x32_bf16 v[64:67], a[204:207], v[192:195], v[64:67]
  ds_read_b128 v[160:163], v18 offset:0
  v_mfma_f32_16x16x32_bf16 v[68:71], a[208:211], v[192:195], v[68:71]
  s_waitcnt vmcnt(25)
  s_cmp_eq_u32 s78, 0
  s_cbranch_scc1 pf_204
  v_mov_b32 v4, 0
  v_mov_b32 v5, 1
  s_mov_b64 exec, 1
  buffer_atomic_add v5, v4, s[72:75], s78 offen sc1
  s_mov_b64 exec, -1
  s_mov_b32 s78, 0
pf_204:
  v_mfma_f32_16x16x32_bf16 v[72:75], a[212:215], v[192:195], v[72:75]
  v_add_u32 v19, s33, v15
  s_add_u32 s33, s33, 16384
  v_mfma_f32_16x16x32_bf16 v[76:79], a[204:207], v[196:199], v[76:79]
  ds_read_b128 v[164:167], v18 offset:2048
  v_mfma_f32_16x16x32_bf16 v[80:83], a[208:211], v[196:199], v[80:83]
  buffer_load_dwordx4 v10, s[8:11], s30 offen offset:0 lds
  v_mfma_f32_16x16x32_bf16 v[84:87], a[212:215], v[196:199], v[84:87]
  s_cmp_lt_u32 s33, 98304
  s_cselect_b32 s33, s33, 0
  v_mfma_f32_16x16x32_bf16 v[88:91], a[204:207], v[200:203], v[88:91]
  ds_read_b128 v[168:171], v18 offset:4096
  v_mfma_f32_16x16x32_bf16 v[92:95], a[208:211], v[200:203], v[92:95]
  v_mfma_f32_16x16x32_bf16 v[96:99], a[212:215], v[200:203], v[96:99]
  v_mfma_f32_16x16x32_bf16 v[100:103], a[204:207], v[204:207], v[100:103]
  ds_read_b128 v[172:175], v18 offset:6144
  v_mfma_f32_16x16x32_bf16 v[104:107], a[208:211], v[204:207], v[104:107]
  v_mfma_f32_16x16x32_bf16 v[108:111], a[212:215], v[204:207], v[108:111]
  s_waitcnt lgkmcnt(4)
  v_mfma_f32_16x16x32_bf16 v[112:115], a[204:207], v[208:211], v[112:115]
  ds_read_b128 v[176:179], v18 offset:8192
  v_mfma_f32_16x16x32_bf16 v[116:119], a[208:211], v[208:211], v[116:119]
  v_mfma_f32_16x16x32_bf16 v[120:123], a[212:215], v[208:211], v[120:123]
  v_mfma_f32_16x16x32_bf16 v[124:127], a[204:207], v[212:215], v[124:127]
  ds_read_b128 v[180:183], v18 offset:10240
  v_mfma_f32_16x16x32_bf16 v[128:131], a[208:211], v[212:215], v[128:131]
  buffer_load_dwordx4 v11, s[8:11], s30 offen offset:1024 lds
  v_mfma_f32_16x16x32_bf16 v[132:135], a[212:215], v[212:215], v[132:135]
  v_mfma_f32_16x16x32_bf16 v[136:139], a[204:207], v[216:219], v[136:139]
  ds_read_b128 v[184:187], v18 offset:12288
  v_mfma_f32_16x16x32_bf16 v[140:143], a[208:211], v[216:219], v[140:143]
  v_mfma_f32_16x16x32_bf16 v[144:147], a[212:215], v[216:219], v[144:147]
  v_mfma_f32_16x16x32_bf16 v[148:151], a[204:207], v[220:223], v[148:151]
  ds_read_b128 v[188:191], v18 offset:14336
  v_mfma_f32_16x16x32_bf16 v[152:155], a[208:211], v[220:223], v[152:155]
  v_mfma_f32_16x16x32_bf16 v[156:159], a[212:215], v[220:223], v[156:159]
  s_waitcnt lgkmcnt(4)
  v_mfma_f32_16x16x32_bf16 v[64:67], a[216:219], v[160:163], v[64:67]
  ds_read_b128 v[192:195], v19 offset:0
  v_mfma_f32_16x16x32_bf16 v[68:71], a[220:223], v[160:163], v[68:71]
  v_add_u32 v18, s33, v14
  v_mfma_f32_16x16x32_bf16 v[72:75], a[224:227], v[160:163], v[72:75]
  v_mfma_f32_16x16x32_bf16 v[76:79], a[216:219], v[164:167], v[76:79]
  ds_read_b128 v[196:199], v19 offset:2048
  v_mfma_f32_16x16x32_bf16 v[80:83], a[220:223], v[164:167], v[80:83]
  buffer_load_dwordx4 v12, s[8:11], s30 offen offset:2048 lds
  v_mfma_f32_16x16x32_bf16 v[84:87], a[224:227], v[164:167], v[84:87]
  v_mfma_f32_16x16x32_bf16 v[88:91], a[216:219], v[168:171], v[88:91]
  ds_read_b128 v[200:203], v19 offset:4096
  v_mfma_f32_16x16x32_bf16 v[92:95], a[220:223], v[168:171], v[92:95]
  v_mfma_f32_16x16x32_bf16 v[96:99], a[224:227], v[168:171], v[96:99]
  v_mfma_f32_16x16x32_bf16 v[100:103], a[216:219], v[172:175], v[100:103]
  ds_read_b128 v[204:207], v19 offset:6144
  v_mfma_f32_16x16x32_bf16 v[104:107], a[220:223], v[172:175], v[104:107]
  v_mfma_f32_16x16x32_bf16 v[108:111], a[224:227], v[172:175], v[108:111]
  s_waitcnt lgkmcnt(4)
  v_mfma_f32_16x16x32_bf16 v[112:115], a[216:219], v[176:179], v[112:115]
  ds_read_b128 v[208:211], v19 offset:8192
  v_mfma_f32_16x16x32_bf16 v[116:119], a[220:223], v[176:179], v[116:119]
  v_mfma_f32_16x16x32_bf16 v[120:123], a[224:227], v[176:179], v[120:123]
  v_mfma_f32_16x16x32_bf16 v[124:127], a[216:219], v[180:183], v[124:127]
  ds_read_b128 v[212:215], v19 offset:10240
  v_mfma_f32_16x16x32_bf16 v[128:131], a[220:223], v[180:183], v[128:131]
  buffer_load_dwordx4 v13, s[8:11], s30 offen offset:3072 lds
  v_mfma_f32_16x16x32_bf16 v[132:135], a[224:227], v[180:183], v[132:135]
  s_add_u32 s30, s30, 128
  s_add_u32 m0, m0, 16384
  v_mfma_f32_16x16x32_bf16 v[136:139], a[216:219], v[184:187], v[136:139]
  ds_read_b128 v[216:219], v19 offset:12288
  v_mfma_f32_16x16x32_bf16 v[140:143], a[220:223], v[184:187], v[140:143]
  s_cmp_lt_u32 m0, s46
  s_cselect_b32 m0, m0, s47
  v_mfma_f32_16x16x32_bf16 v[144:147], a[224:227], v[184:187], v[144:147]
  v_mfma_f32_16x16x32_bf16 v[148:151], a[216:219], v[188:191], v[148:151]
  ds_read_b128 v[220:223], v19 offset:14336
  v_mfma_f32_16x16x32_bf16 v[152:155], a[220:223], v[188:191], v[152:155]
  v_mfma_f32_16x16x32_bf16 v[156:159], a[224:227], v[188:191], v[156:159]
  s_waitcnt vmcnt(25) lgkmcnt(4)
  s_barrier
  v_mfma_f32_16x16x32_bf16 v[64:67], a[228:231], v[192:195], v[64:67]
  ds_read_b128 v[160:163], v18 offset:0
  v_mfma_f32_16x16x32_bf16 v[68:71], a[232:235], v[192:195], v[68:71]
  v_mfma_f32_16x16x32_bf16 v[72:75], a[236:239], v[192:195], v[72:75]
  v_add_u32 v19, s33, v15
  s_add_u32 s33, s33, 16384
  v_mfma_f32_16x16x32_bf16 v[76:79], a[228:231], v[196:199], v[76:79]
  ds_read_b128 v[164:167], v18 offset:2048
  v_cvt_pk_bf16_f32 v224, v64, v65
  v_cvt_pk_bf16_f32 v225, v66, v67
  v_mfma_f32_16x16x32_bf16 v[80:83], a[232:235], v[196:199], v[80:83]
  buffer_load_dwordx4 v10, s[8:11], s30 offen offset:0 lds
  v_cvt_pk_bf16_f32 v226, v68, v69
  v_cvt_pk_bf16_f32 v227, v70, v71
  v_mfma_f32_16x16x32_bf16 v[84:87], a[236:239], v[196:199], v[84:87]
  s_cmp_lt_u32 s33, 98304
  s_cselect_b32 s33, s33, 0
  v_cvt_pk_bf16_f32 v228, v72, v73
  v_cvt_pk_bf16_f32 v229, v74, v75
  v_mfma_f32_16x16x32_bf16 v[88:91], a[228:231], v[200:203], v[88:91]
  ds_read_b128 v[168:171], v18 offset:4096
  ds_write_b64 v22, v[224:225] offset:0
  v_mfma_f32_16x16x32_bf16 v[92:95], a[232:235], v[200:203], v[92:95]
  ds_write_b64 v22, v[226:227] offset:8
  ds_write_b64 v16, v[228:229] offset:64
  v_mfma_f32_16x16x32_bf16 v[96:99], a[236:239], v[200:203], v[96:99]
  v_cvt_pk_bf16_f32 v230, v76, v77
  v_cvt_pk_bf16_f32 v231, v78, v79
  v_cvt_pk_bf16_f32 v232, v80, v81
  v_cvt_pk_bf16_f32 v233, v82, v83
  v_mfma_f32_16x16x32_bf16 v[100:103], a[228:231], v[204:207], v[100:103]
  ds_read_b128 v[172:175], v18 offset:6144
  v_cvt_pk_bf16_f32 v234, v84, v85
  v_cvt_pk_bf16_f32 v235, v86, v87
  v_mfma_f32_16x16x32_bf16 v[104:107], a[232:235], v[204:207], v[104:107]
  ds_write_b64 v22, v[230:231] offset:6400
  ds_write_b64 v22, v[232:233] offset:6408
  v_mfma_f32_16x16x32_bf16 v[108:111], a[236:239], v[204:207], v[108:111]
  s_waitcnt lgkmcnt(9)
  ds_write_b64 v16, v[234:235] offset:6464
  v_cvt_pk_bf16_f32 v224, v88, v89
  v_mfma_f32_16x16x32_bf16 v[112:115], a[228:231], v[208:211], v[112:115]
  ds_read_b128 v[176:179], v18 offset:8192
  v_cvt_pk_bf16_f32 v225, v90, v91
  v_cvt_pk_bf16_f32 v226, v92, v93
  v_cvt_pk_bf16_f32 v227, v94, v95
  v_mfma_f32_16x16x32_bf16 v[116:119], a[232:235], v[208:211], v[116:119]
  v_cvt_pk_bf16_f32 v228, v96, v97
  v_cvt_pk_bf16_f32 v229, v98, v99
  ds_write_b64 v22, v[224:225] offset:12800
  v_mfma_f32_16x16x32_bf16 v[120:123], a[236:239], v[208:211], v[120:123]
  ds_write_b64 v22, v[226:227] offset:12808
  ds_write_b64 v16, v[228:229] offset:12864
  v_mfma_f32_16x16x32_bf16 v[124:127], a[228:231], v[212:215], v[124:127]
  ds_read_b128 v[180:183], v18 offset:10240
  v_cvt_pk_bf16_f32 v230, v100, v101
  v_cvt_pk_bf16_f32 v231, v102, v103
  v_cvt_pk_bf16_f32 v232, v104, v105
  v_mfma_f32_16x16x32_bf16 v[128:131], a[232:235], v[212:215], v[128:131]
  buffer_load_dwordx4 v11, s[8:11], s30 offen offset:1024 lds
  v_cvt_pk_bf16_f32 v233, v106, v107
  v_cvt_pk_bf16_f32 v234, v108, v109
  v_mfma_f32_16x16x32_bf16 v[132:135], a[236:239], v[212:215], v[132:135]
  v_cvt_pk_bf16_f32 v235, v110, v111
  ds_write_b64 v22, v[230:231] offset:19200
  v_mfma_f32_16x16x32_bf16 v[136:139], a[228:231], v[216:219], v[136:139]
  ds_read_b128 v[184:187], v18 offset:12288
  ds_write_b64 v22, v[232:233] offset:19208
  v_mfma_f32_16x16x32_bf16 v[140:143], a[232:235], v[216:219], v[140:143]
  ds_write_b64 v16, v[234:235] offset:19264
  v_cvt_pk_bf16_f32 v224, v112, v113
  v_cvt_pk_bf16_f32 v225, v114, v115
  v_mfma_f32_16x16x32_bf16 v[144:147], a[236:239], v[216:219], v[144:147]
  v_cvt_pk_bf16_f32 v226, v116, v117
  v_cvt_pk_bf16_f32 v227, v118, v119
  v_cvt_pk_bf16_f32 v228, v120, v121
  v_cvt_pk_bf16_f32 v229, v122, v123
  v_mfma_f32_16x16x32_bf16 v[148:151], a[228:231], v[220:223], v[148:151]
  ds_read_b128 v[188:191], v18 offset:14336
  ds_write_b64 v22, v[224:225] offset:25600
  v_mfma_f32_16x16x32_bf16 v[152:155], a[232:235], v[220:223], v[152:155]
  ds_write_b64 v22, v[226:227] offset:25608
  ds_write_b64 v16, v[228:229] offset:25664
  v_mfma_f32_16x16x32_bf16 v[156:159], a[236:239], v[220:223], v[156:159]
  v_cvt_pk_bf16_f32 v230, v124, v125
  v_cvt_pk_bf16_f32 v231, v126, v127
  v_cvt_pk_bf16_f32 v232, v128, v129
  v_cvt_pk_bf16_f32 v233, v130, v131
  v_cvt_pk_bf16_f32 v234, v132, v133
  v_cvt_pk_bf16_f32 v235, v134, v135
  ds_write_b64 v22, v[230:231] offset:32000
  ds_write_b64 v22, v[232:233] offset:32008
  ds_write_b64 v16, v[234:235] offset:32064
  v_cvt_pk_bf16_f32 v224, v136, v137
  v_cvt_pk_bf16_f32 v225, v138, v139
  v_cvt_pk_bf16_f32 v226, v140, v141
  v_cvt_pk_bf16_f32 v227, v142, v143
  v_cvt_pk_bf16_f32 v228, v144, v145
  v_cvt_pk_bf16_f32 v229, v146, v147
  ds_write_b64 v22, v[224:225] offset:38400
  ds_write_b64 v22, v[226:227] offset:38408
  ds_write_b64 v16, v[228:229] offset:38464
  v_cvt_pk_bf16_f32 v230, v148, v149
  v_cvt_pk_bf16_f32 v231, v150, v151
  v_cvt_pk_bf16_f32 v232, v152, v153
  v_cvt_pk_bf16_f32 v233, v154, v155
  v_cvt_pk_bf16_f32 v234, v156, v157
  v_cvt_pk_bf16_f32 v235, v158, v159
  ds_write_b64 v22, v[230:231] offset:44800
  ds_write_b64 v22, v[232:233] offset:44808
  ds_write_b64 v16, v[234:235] offset:44864
  s_add_u32 s23, s49, 1
  s_waitcnt vmcnt(6)
  v_cmp_gt_u32 vcc, s23, v21
  s_mov_b32 s80, 0
  s_nop 0
  s_cbranch_vccnz qk_208
  s_mov_b32 s80, 1
  buffer_load_dwordx4 v[132:135], v31, s[52:55], s51 offen offset:0 sc1
  buffer_load_dwordx4 v[136:139], v31, s[52:55], s51 offen offset:512 sc1
  buffer_load_dwordx4 v[140:143], v31, s[52:55], s51 offen offset:1024 sc1
  buffer_load_dwordx4 v[144:147], v31, s[52:55], s51 offen offset:1536 sc1
  buffer_load_dwordx4 v[148:151], v31, s[52:55], s51 offen offset:2048 sc1
  buffer_load_dwordx4 v[152:155], v31, s[52:55], s51 offen offset:2560 sc1
qk_208:
  s_cmp_ge_u32 s79, 8
  s_cbranch_scc1 qk_207
  v_mov_b32 v156, 0
  s_mov_b32 s101, 0
wf_209:
  buffer_load_dword v157, v156, s[72:75], s76 offen sc1
  s_add_u32 s101, s101, 1
  s_cmp_gt_u32 s101, 131072
  s_cbranch_scc1 main_end
  s_waitcnt vmcnt(0)
  v_readfirstlane_b32 s100, v157
  s_cmp_ge_u32 s100, 8
  s_cbranch_scc1 wf_210
  s_sleep 2
  s_branch wf_209
wf_210:
  s_add_u32 s21, s50, 0
  buffer_load_dwordx4 v[36:39], v30, s[16:19], s21 offen offset:0 sc1
  buffer_load_dwordx4 v[40:43], v30, s[16:19], s21 offen offset:1024 sc1
  buffer_load_dwordx4 v[44:47], v30, s[16:19], s21 offen offset:2048 sc1
  buffer_load_dwordx4 v[48:51], v30, s[16:19], s21 offen offset:3072 sc1
  s_add_u32 s21, s50, 4096
  buffer_load_dwordx4 v[52:55], v30, s[16:19], s21 offen offset:0 sc1
  buffer_load_dwordx4 v[56:59], v30, s[16:19], s21 offen offset:1024 sc1
  buffer_load_dwordx4 v[60:63], v30, s[16:19], s21 offen offset:2048 sc1
  buffer_load_dwordx4 v[236:239], v30, s[16:19], s21 offen offset:3072 sc1
  s_add_u32 s21, s50, 8192
  buffer_load_dwordx4 v[240:243], v30, s[16:19], s21 offen offset:0 sc1
  buffer_load_dwordx4 v[244:247], v30, s[16:19], s21 offen offset:1024 sc1
  buffer_load_dwordx4 v[248:251], v30, s[16:19], s21 offen offset:2048 sc1
  buffer_load_dwordx4 v[252:255], v30, s[16:19], s21 offen offset:3072 sc1
qk_207:
  s_waitcnt lgkmcnt(0)
  s_barrier
  ds_read_b128 v[64:67], v29 offset:0
  ds_read_b128 v[68:71], v29 offset:64
  ds_read_b128 v[72:75], v29 offset:128
  ds_read_b128 v[76:79], v29 offset:192
  ds_read_b128 v[80:83], v29 offset:256
  ds_read_b128 v[84:87], v29 offset:320
  ds_read_b128 v[88:91], v29 offset:6400
  ds_read_b128 v[92:95], v29 offset:6464
  ds_read_b128 v[96:99], v29 offset:6528
  ds_read_b128 v[100:103], v29 offset:6592
  ds_read_b128 v[104:107], v29 offset:6656
  ds_read_b128 v[108:111], v29 offset:6720
  s_waitcnt lgkmcnt(0)
  s_cmp_eq_u32 s80, 1
  s_cselect_b32 s21, s79, 0
  s_cmp_ge_u32 s21, 8
  s_cbranch_scc1 qw_211
  s_waitcnt vmcnt(0)
qw_211:
  v_mfma_f32_16x16x32_bf16 v[112:115], v[36:39], v[64:67], 0
  v_mfma_f32_16x16x32_bf16 v[120:123], v[36:39], v[88:91], 0
  v_mfma_f32_16x16x32_bf16 v[124:127], v[60:63], v[88:91], 0
  v_mfma_f32_16x16x32_bf16 v[112:115], v[40:43], v[68:71], v[112:115]
  v_mfma_f32_16x16x32_bf16 v[120:123], v[40:43], v[92:95], v[120:123]
  v_mfma_f32_16x16x32_bf16 v[124:127], v[236:239], v[92:95], v[124:127]
  v_mfma_f32_16x16x32_bf16 v[112:115], v[44:47], v[72:75], v[112:115]
  v_mfma_f32_16x16x32_bf16 v[120:123], v[44:47], v[96:99], v[120:123]
  v_mfma_f32_16x16x32_bf16 v[124:127], v[240:243], v[96:99], v[124:127]
  v_mfma_f32_16x16x32_bf16 v[112:115], v[48:51], v[76:79], v[112:115]
  v_mfma_f32_16x16x32_bf16 v[120:123], v[48:51], v[100:103], v[120:123]
  v_mfma_f32_16x16x32_bf16 v[124:127], v[244:247], v[100:103], v[124:127]
  v_mfma_f32_16x16x32_bf16 v[112:115], v[52:55], v[80:83], v[112:115]
  v_mfma_f32_16x16x32_bf16 v[120:123], v[52:55], v[104:107], v[120:123]
  v_mfma_f32_16x16x32_bf16 v[124:127], v[248:251], v[104:107], v[124:127]
  v_mfma_f32_16x16x32_bf16 v[112:115], v[56:59], v[84:87], v[112:115]
  v_mfma_f32_16x16x32_bf16 v[120:123], v[56:59], v[108:111], v[120:123]
  v_mfma_f32_16x16x32_bf16 v[124:127], v[252:255], v[108:111], v[124:127]
  s_cmp_eq_u32 s80, 1
  s_cbranch_scc1 qm_212
  s_add_u32 s23, s49, 1
  s_mov_b32 s101, 0
wm_213:
  buffer_load_dword v156, v33, s[72:75], s77 offen sc1
  s_add_u32 s101, s101, 1
  s_cmp_gt_u32 s101, 131072
  s_cbranch_scc1 main_end
  s_waitcnt vmcnt(0)
  v_cmp_gt_u32 vcc, s23, v156
  v_readfirstlane_b32 s100, v156
  s_nop 0
  s_cbranch_vccz wm_214
  s_sleep 4
  s_add_u32 s100, s100, 2
  s_cmp_ge_u32 s100, s23
  s_cbranch_scc1 wm_213
  s_sleep 90
  s_branch wm_213
wm_214:
  buffer_load_dwordx4 v[132:135], v31, s[52:55], s51 offen offset:0 sc1
  buffer_load_dwordx4 v[136:139], v31, s[52:55], s51 offen offset:512 sc1
  buffer_load_dwordx4 v[140:143], v31, s[52:55], s51 offen offset:1024 sc1
  buffer_load_dwordx4 v[144:147], v31, s[52:55], s51 offen offset:1536 sc1
  buffer_load_dwordx4 v[148:151], v31, s[52:55], s51 offen offset:2048 sc1
  buffer_load_dwordx4 v[152:155], v31, s[52:55], s51 offen offset:2560 sc1
qm_212:
  s_waitcnt vmcnt(0)
  v_mfma_f32_16x16x32_bf16 v[116:119], v[132:135], v[64:67], 0
  v_mfma_f32_16x16x32_bf16 v[128:131], v[132:135], v[88:91], 0
  v_mfma_f32_16x16x32_bf16 v[116:119], v[136:139], v[68:71], v[116:119]
  v_mfma_f32_16x16x32_bf16 v[128:131], v[136:139], v[92:95], v[128:131]
  v_mfma_f32_16x16x32_bf16 v[116:119], v[140:143], v[72:75], v[116:119]
  v_mfma_f32_16x16x32_bf16 v[128:131], v[140:143], v[96:99], v[128:131]
  v_mfma_f32_16x16x32_bf16 v[116:119], v[144:147], v[76:79], v[116:119]
  v_mfma_f32_16x16x32_bf16 v[128:131], v[144:147], v[100:103], v[128:131]
  v_mfma_f32_16x16x32_bf16 v[116:119], v[148:151], v[80:83], v[116:119]
  v_mfma_f32_16x16x32_bf16 v[128:131], v[148:151], v[104:107], v[128:131]
  v_mfma_f32_16x16x32_bf16 v[116:119], v[152:155], v[84:87], v[116:119]
  v_mfma_f32_16x16x32_bf16 v[128:131], v[152:155], v[108:111], v[128:131]
  s_lshl_b32 s21, s49, 5
  s_add_u32 s21, s21, s42
  s_mul_i32 s81, s21, 2560
  s_lshl_b32 s82, s49, 3
  s_and_b32 s21, s42, 7
  s_add_u32 s82, s82, s21
  s_lshl_b32 s82, s82, 7
  s_add_u32 s82, s82, 24576
  s_cmp_gt_u32 s26, 1
  s_cselect_b32 s21, s80, 0
  s_cmp_eq_u32 s21, 0
  s_cbranch_scc1 qi_216
  v_mov_b32 v36, v112
  v_mov_b32 v37, v113
  v_mov_b32 v38, v114
  v_mov_b32 v39, v115
  v_mov_b32 v40, v116
  v_mov_b32 v41, v117
  v_mov_b32 v42, v118
  v_mov_b32 v43, v119
  v_mov_b32 v44, v120
  v_mov_b32 v45, v121
  v_mov_b32 v46, v122
  v_mov_b32 v47, v123
  v_mov_b32 v48, v124
  v_mov_b32 v49, v125
  v_mov_b32 v50, v126
  v_mov_b32 v51, v127
  v_mov_b32 v52, v128
  v_mov_b32 v53, v129
  v_mov_b32 v54, v130
  v_mov_b32 v55, v131
  s_branch qd_215
qi_216:
  v_cndmask_b32 v112, v34, v112, s[64:65]
  v_cndmask_b32 v124, v34, v124, s[64:65]
  v_cndmask_b32 v113, v34, v113, s[66:67]
  v_cndmask_b32 v125, v34, v125, s[66:67]
  v_cndmask_b32 v114, v34, v114, s[68:69]
  v_cndmask_b32 v126, v34, v126, s[68:69]
  v_cndmask_b32 v115, v34, v115, s[70:71]
  v_cndmask_b32 v127, v34, v127, s[70:71]
  v_max3_f32 v156, v112, v113, v114
  v_max3_f32 v156, v156, v115, v116
  v_max3_f32 v156, v156, v117, v118
  v_max_f32 v156, v156, v119
  v_mov_b32 v157, v156
  s_nop 1
  v_permlane32_swap_b32 v156, v157
  v_max_f32 v156, v156, v157
  v_mov_b32 v157, v156
  s_nop 1
  v_permlane16_swap_b32 v156, v157
  v_max_f32 v156, v156, v157
  v_mul_f32 v156, s83, v156
  v_fma_f32 v112, v112, s83, -v156
  v_fma_f32 v113, v113, s83, -v156
  v_fma_f32 v114, v114, s83, -v156
  v_fma_f32 v115, v115, s83, -v156
  v_fma_f32 v116, v116, s83, -v156
  v_fma_f32 v117, v117, s83, -v156
  v_fma_f32 v118, v118, s83, -v156
  v_fma_f32 v119, v119, s83, -v156
  v_exp_f32 v112, v112
  v_exp_f32 v113, v113
  v_exp_f32 v114, v114
  v_exp_f32 v115, v115
  v_exp_f32 v116, v116
  v_exp_f32 v117, v117
  v_exp_f32 v118, v118
  v_exp_f32 v119, v119
  s_nop 0
  v_add_f32 v156, v116, v117
  v_add_f32 v156, v156, v118
  v_add_f32 v156, v156, v119
  v_cndmask_b32 v156, 0, v156, s[60:61]
  v_add_f32 v156, v156, v112
  v_add_f32 v156, v156, v113
  v_add_f32 v156, v156, v114
  v_add_f32 v156, v156, v115
  v_mov_b32 v157, v156
  s_nop 1
  v_permlane32_swap_b32 v156, v157
  v_add_f32 v156, v156, v157
  v_mov_b32 v157, v156
  s_nop 1
  v_permlane16_swap_b32 v156, v157
  v_add_f32 v156, v156, v157
  v_rcp_f32 v156, v156
  s_nop 0
  v_mul_f32 v112, v112, v156
  v_mul_f32 v113, v113, v156
  v_mul_f32 v114, v114, v156
  v_mul_f32 v115, v115, v156
  v_mul_f32 v116, v116, v156
  v_mul_f32 v117, v117, v156
  v_mul_f32 v118, v118, v156
  v_mul_f32 v119, v119, v156
  v_max3_f32 v156, v120, v121, v122
  v_max3_f32 v156, v156, v123, v124
  v_max3_f32 v156, v156, v125, v126
  v_max3_f32 v156, v156, v127, v128
  v_max3_f32 v156, v156, v129, v130
  v_max_f32 v156, v156, v131
  v_mov_b32 v157, v156
  s_nop 1
  v_permlane32_swap_b32 v156, v157
  v_max_f32 v156, v156, v157
  v_mov_b32 v157, v156
  s_nop 1
  v_permlane16_swap_b32 v156, v157
  v_max_f32 v156, v156, v157
  v_mul_f32 v156, s83, v156
  v_fma_f32 v120, v120, s83, -v156
  v_fma_f32 v121, v121, s83, -v156
  v_fma_f32 v122, v122, s83, -v156
  v_fma_f32 v123, v123, s83, -v156
  v_fma_f32 v124, v124, s83, -v156
  v_fma_f32 v125, v125, s83, -v156
  v_fma_f32 v126, v126, s83, -v156
  v_fma_f32 v127, v127, s83, -v156
  v_fma_f32 v128, v128, s83, -v156
  v_fma_f32 v129, v129, s83, -v156
  v_fma_f32 v130, v130, s83, -v156
  v_fma_f32 v131, v131, s83, -v156
  v_exp_f32 v120, v120
  v_exp_f32 v121, v121
  v_exp_f32 v122, v122
  v_exp_f32 v123, v123
  v_exp_f32 v124, v124
  v_exp_f32 v125, v125
  v_exp_f32 v126, v126
  v_exp_f32 v127, v127
  v_exp_f32 v128, v128
  v_exp_f32 v129, v129
  v_exp_f32 v130, v130
  v_exp_f32 v131, v131
  s_nop 0
  v_add_f32 v156, v128, v129
  v_add_f32 v156, v156, v130
  v_add_f32 v156, v156, v131
  v_cndmask_b32 v156, 0, v156, s[60:61]
  v_add_f32 v156, v156, v120
  v_add_f32 v156, v156, v121
  v_add_f32 v156, v156, v122
  v_add_f32 v156, v156, v123
  v_add_f32 v156, v156, v124
  v_add_f32 v156, v156, v125
  v_add_f32 v156, v156, v126
  v_add_f32 v156, v156, v127
  v_mov_b32 v157, v156
  s_nop 1
  v_permlane32_swap_b32 v156, v157
  v_add_f32 v156, v156, v157
  v_mov_b32 v157, v156
  s_nop 1
  v_permlane16_swap_b32 v156, v157
  v_add_f32 v156, v156, v157
  v_rcp_f32 v156, v156
  s_nop 0
  v_mul_f32 v120, v120, v156
  v_mul_f32 v121, v121, v156
  v_mul_f32 v122, v122, v156
  v_mul_f32 v123, v123, v156
  v_mul_f32 v124, v124, v156
  v_mul_f32 v125, v125, v156
  v_mul_f32 v126, v126, v156
  v_mul_f32 v127, v127, v156
  v_mul_f32 v128, v128, v156
  v_mul_f32 v129, v129, v156
  v_mul_f32 v130, v130, v156
  v_mul_f32 v131, v131, v156
  v_cvt_pk_bf16_f32 v196, v116, v117
  v_cvt_pk_bf16_f32 v197, v118, v119
  v_cvt_pk_bf16_f32 v198, v128, v129
  v_cvt_pk_bf16_f32 v199, v130, v131
  v_cvt_pk_bf16_f32 v192, v120, v121
  v_cvt_pk_bf16_f32 v193, v122, v123
  v_cvt_pk_bf16_f32 v194, v124, v125
  v_cvt_pk_bf16_f32 v195, v126, v127
  v_cvt_pk_bf16_f32 v200, v112, v113
  v_cvt_pk_bf16_f32 v201, v114, v115
  v_permlane16_swap_b32 v196, v198
  v_permlane16_swap_b32 v197, v199
  buffer_store_dwordx4 v[192:195], v30, s[56:59], s81 offen sc1
  s_mov_b64 exec, 0xffffffff
  buffer_store_dwordx4 v[196:199], v30, s[56:59], s81 offen offset:1024 sc1
  s_mov_b64 exec, -1
  buffer_store_dwordx2 v[200:201], v32, s[56:59], s81 offen offset:2048 sc1
  s_mov_b32 s78, s82
  s_mov_b32 s81, 0x80000000
  s_mov_b32 s82, 0
  s_cmp_eq_u32 s80, 1
  s_cbranch_scc1 qd_215
  s_waitcnt vmcnt(0)
  s_cmp_eq_u32 s78, 0
  s_cbranch_scc1 pf_217
  v_mov_b32 v4, 0
  v_mov_b32 v5, 1
  s_mov_b64 exec, 1
  buffer_atomic_add v5, v4, s[72:75], s78 offen sc1
  s_mov_b64 exec, -1
  s_mov_b32 s78, 0
pf_217:
qd_215:
  s_add_u32 s49, s49, s29
qbe_206:
  s_sub_u32 s26, s26, 1
  s_cmp_gt_u32 s26, 0
  s_waitcnt lgkmcnt(0)
  s_cbranch_scc1 qa_blk_205
  s_waitcnt vmcnt(0) lgkmcnt(0)
  s_add_u32 s12, s38, 201326592
  s_addc_u32 s13, s39, 0
  s_mov_b32 s14, 4718592
  s_mov_b32 s15, 0x00020000
  s_cmp_eq_u32 s78, 0
  s_cbranch_scc1 pf_218
  v_mov_b32 v4, 0
  v_mov_b32 v5, 1
  s_mov_b64 exec, 1
  buffer_atomic_add v5, v4, s[72:75], s78 offen sc1
  s_mov_b64 exec, -1
  s_mov_b32 s78, 0
pf_218:
  s_lshl_b32 s21, s42, 7
  s_add_u32 s21, s21, 113664
  v_mov_b32 v156, 0
  s_mov_b32 s101, 0
wf_219:
  buffer_load_dword v157, v156, s[72:75], s21 offen sc1
  s_add_u32 s101, s101, 1
  s_cmp_gt_u32 s101, 131072
  s_cbranch_scc1 main_end
  s_waitcnt vmcnt(0)
  v_readfirstlane_b32 s100, v157
  s_cmp_ge_u32 s100, 3
  s_cbranch_scc1 wf_220
  s_sleep 16
  s_branch wf_219
wf_220:
qf_221:
  s_mul_i32 s21, s49, 393216
  s_mul_i32 s22, s42, 12288
  s_add_u32 s50, s21, s22
  s_mul_i32 s21, s49, 98304
  s_mul_i32 s22, s42, 3072
  s_add_u32 s51, s21, s22
  s_lshr_b32 s22, s49, 1
  s_lshr_b32 s21, s49, 2
  s_add_u32 s21, s21, 4
  s_cmp_lt_u32 s49, 16
  s_cselect_b32 s21, s22, s21
  s_lshl_b32 s21, s21, 3
  s_lshr_b32 s22, s42, 2
  s_add_u32 s21, s21, s22
  s_lshl_b32 s21, s21, 7
  s_add_u32 s76, s21, 0
  s_lshl_b32 s77, s42, 7
  s_add_u32 s77, s77, 20480
  s_sub_u32 s43, s50, 20447232
  buffer_load_dword v21, v33, s[72:75], s77 offen sc1
  s_add_u32 s21, s50, 0
  buffer_load_dwordx4 v[36:39], v30, s[16:19], s21 offen offset:0 sc1
  buffer_load_dwordx4 v[40:43], v30, s[16:19], s21 offen offset:1024 sc1
  buffer_load_dwordx4 v[44:47], v30, s[16:19], s21 offen offset:2048 sc1
  buffer_load_dwordx4 v[48:51], v30, s[16:19], s21 offen offset:3072 sc1
  s_add_u32 s21, s50, 4096
  buffer_load_dwordx4 v[52:55], v30, s[16:19], s21 offen offset:0 sc1
  buffer_load_dwordx4 v[56:59], v30, s[16:19], s21 offen offset:1024 sc1
  buffer_load_dwordx4 v[60:63], v30, s[16:19], s21 offen offset:2048 sc1
  buffer_load_dwordx4 v[236:239], v30, s[16:19], s21 offen offset:3072 sc1
  s_add_u32 s21, s50, 8192
  buffer_load_dwordx4 v[240:243], v30, s[16:19], s21 offen offset:0 sc1
  buffer_load_dwordx4 v[244:247], v30, s[16:19], s21 offen offset:1024 sc1
  buffer_load_dwordx4 v[248:251], v30, s[16:19], s21 offen offset:2048 sc1
  buffer_load_dwordx4 v[252:255], v30, s[16:19], s21 offen offset:3072 sc1
  s_add_u32 s21, s43, 0
  buffer_load_dwordx4 v[64:67], v30, s[12:15], s21 offen offset:0 sc1
  buffer_load_dwordx4 v[68:71], v30, s[12:15], s21 offen offset:1024 sc1
  buffer_load_dwordx4 v[72:75], v30, s[12:15], s21 offen offset:2048 sc1
  buffer_load_dwordx4 v[76:79], v30, s[12:15], s21 offen offset:3072 sc1
  s_add_u32 s21, s43, 4096
  buffer_load_dwordx4 v[80:83], v30, s[12:15], s21 offen offset:0 sc1
  buffer_load_dwordx4 v[84:87], v30, s[12:15], s21 offen offset:1024 sc1
  buffer_load_dwordx4 v[88:91], v30, s[12:15], s21 offen offset:2048 sc1
  buffer_load_dwordx4 v[92:95], v30, s[12:15], s21 offen offset:3072 sc1
  s_add_u32 s21, s43, 8192
  buffer_load_dwordx4 v[96:99], v30, s[12:15], s21 offen offset:0 sc1
  buffer_load_dwordx4 v[100:103], v30, s[12:15], s21 offen offset:1024 sc1
  buffer_load_dwordx4 v[104:107], v30, s[12:15], s21 offen offset:2048 sc1
  buffer_load_dwordx4 v[108:111], v30, s[12:15], s21 offen offset:3072 sc1
  s_waitcnt vmcnt(24)
  s_cmp_eq_u32 s78, 0
  s_cbranch_scc1 pf_224
  v_mov_b32 v4, 0
  v_mov_b32 v5, 1
  s_mov_b64 exec, 1
  buffer_atomic_add v5, v4, s[72:75], s78 offen sc1
  s_mov_b64 exec, -1
  s_mov_b32 s78, 0
pf_224:
  s_add_u32 s23, s49, 1
  v_cmp_gt_u32 vcc, s23, v21
  s_mov_b32 s80, 0
  s_nop 0
  s_cbranch_vccnz qk_223
  s_mov_b32 s80, 1
  buffer_load_dwordx4 v[132:135], v31, s[52:55], s51 offen offset:0 sc1
  buffer_load_dwordx4 v[136:139], v31, s[52:55], s51 offen offset:512 sc1
  buffer_load_dwordx4 v[140:143], v31, s[52:55], s51 offen offset:1024 sc1
  buffer_load_dwordx4 v[144:147], v31, s[52:55], s51 offen offset:1536 sc1
  buffer_load_dwordx4 v[148:151], v31, s[52:55], s51 offen offset:2048 sc1
  buffer_load_dwordx4 v[152:155], v31, s[52:55], s51 offen offset:2560 sc1
  s_waitcnt vmcnt(6)
  s_branch qk_223x
qk_223:
  s_waitcnt vmcnt(0)
qk_223x:
  v_mfma_f32_16x16x32_bf16 v[112:115], v[36:39], v[64:67], 0
  v_mfma_f32_16x16x32_bf16 v[120:123], v[36:39], v[88:91], 0
  v_mfma_f32_16x16x32_bf16 v[124:127], v[60:63], v[88:91], 0
  v_mfma_f32_16x16x32_bf16 v[112:115], v[40:43], v[68:71], v[112:115]
  v_mfma_f32_16x16x32_bf16 v[120:123], v[40:43], v[92:95], v[120:123]
  v_mfma_f32_16x16x32_bf16 v[124:127], v[236:239], v[92:95], v[124:127]
  v_mfma_f32_16x16x32_bf16 v[112:115], v[44:47], v[72:75], v[112:115]
  v_mfma_f32_16x16x32_bf16 v[120:123], v[44:47], v[96:99], v[120:123]
  v_mfma_f32_16x16x32_bf16 v[124:127], v[240:243], v[96:99], v[124:127]
  v_mfma_f32_16x16x32_bf16 v[112:115], v[48:51], v[76:79], v[112:115]
  v_mfma_f32_16x16x32_bf16 v[120:123], v[48:51], v[100:103], v[120:123]
  v_mfma_f32_16x16x32_bf16 v[124:127], v[244:247], v[100:103], v[124:127]
  v_mfma_f32_16x16x32_bf16 v[112:115], v[52:55], v[80:83], v[112:115]
  v_mfma_f32_16x16x32_bf16 v[120:123], v[52:55], v[104:107], v[120:123]
  v_mfma_f32_16x16x32_bf16 v[124:127], v[248:251], v[104:107], v[124:127]
  v_mfma_f32_16x16x32_bf16 v[112:115], v[56:59], v[84:87], v[112:115]
  v_mfma_f32_16x16x32_bf16 v[120:123], v[56:59], v[108:111], v[120:123]
  v_mfma_f32_16x16x32_bf16 v[124:127], v[252:255], v[108:111], v[124:127]
  s_cmp_eq_u32 s80, 1
  s_cbranch_scc1 qm_225
  s_add_u32 s23, s49, 1
  s_min_u32 s22, s49, 62
  s_cmp_lt_u32 s49, 62
  s_cselect_b32 s23, s23, s22
  s_mov_b32 s101, 0
wm_226:
  buffer_load_dword v156, v33, s[72:75], s77 offen sc1
  s_add_u32 s101, s101, 1
  s_cmp_gt_u32 s101, 131072
  s_cbranch_scc1 main_end
  s_waitcnt vmcnt(0)
  v_cmp_gt_u32 vcc, s23, v156
  v_readfirstlane_b32 s100, v156
  s_nop 0
  s_cbranch_vccz wm_227
  s_sleep 4
  s_add_u32 s100, s100, 2
  s_cmp_ge_u32 s100, s23
  s_cbranch_scc1 wm_226
  s_sleep 90
  s_branch wm_226
wm_227:
  s_mov_b32 s101, 0
  s_branch qtp_229
qtp_228:
  s_sleep 3
qtp_229:
  buffer_load_dwordx4 v[132:135], v31, s[52:55], s51 offen offset:0 sc1
  buffer_load_dwordx4 v[136:139], v31, s[52:55], s51 offen offset:512 sc1
  buffer_load_dwordx4 v[140:143], v31, s[52:55], s51 offen offset:1024 sc1
  buffer_load_dwordx4 v[144:147], v31, s[52:55], s51 offen offset:1536 sc1
  buffer_load_dwordx4 v[148:151], v31, s[52:55], s51 offen offset:2048 sc1
  buffer_load_dwordx4 v[152:155], v31, s[52:55], s51 offen offset:2560 sc1
  s_add_u32 s101, s101, 1
  s_cmp_gt_u32 s101, 131072
  s_cbranch_scc1 main_end
  s_waitcnt vmcnt(0)
  v_max3_u32 v156, v132, v134, v136
  v_max3_u32 v156, v156, v138, v140
  v_max3_u32 v156, v156, v142, v144
  v_max3_u32 v156, v156, v146, v148
  v_max3_u32 v156, v156, v150, v152
  v_max3_u32 v156, v156, v154, v154
  v_cmp_eq_u32 vcc, -1, v156
  s_nop 1
  s_cbranch_vccnz qtp_228
qm_225:
  s_waitcnt vmcnt(0)
  v_mfma_f32_16x16x32_bf16 v[116:119], v[132:135], v[64:67], 0
  v_mfma_f32_16x16x32_bf16 v[128:131], v[132:135], v[88:91], 0
  v_mfma_f32_16x16x32_bf16 v[116:119], v[136:139], v[68:71], v[116:119]
  v_mfma_f32_16x16x32_bf16 v[128:131], v[136:139], v[92:95], v[128:131]
  v_mfma_f32_16x16x32_bf16 v[116:119], v[140:143], v[72:75], v[116:119]
  v_mfma_f32_16x16x32_bf16 v[128:131], v[140:143], v[96:99], v[128:131]
  v_mfma_f32_16x16x32_bf16 v[116:119], v[144:147], v[76:79], v[116:119]
  v_mfma_f32_16x16x32_bf16 v[128:131], v[144:147], v[100:103], v[128:131]
  v_mfma_f32_16x16x32_bf16 v[116:119], v[148:151], v[80:83], v[116:119]
  v_mfma_f32_16x16x32_bf16 v[128:131], v[148:151], v[104:107], v[128:131]
  v_mfma_f32_16x16x32_bf16 v[116:119], v[152:155], v[84:87], v[116:119]
  v_mfma_f32_16x16x32_bf16 v[128:131], v[152:155], v[108:111], v[128:131]
  s_lshl_b32 s21, s49, 5
  s_add_u32 s21, s21, s42
  s_mul_i32 s81, s21, 2560
  s_lshl_b32 s82, s49, 3
  s_and_b32 s21, s42, 7
  s_add_u32 s82, s82, s21
  s_lshl_b32 s82, s82, 7
  s_add_u32 s82, s82, 24576
  v_cndmask_b32 v112, v34, v112, s[64:65]
  v_cndmask_b32 v124, v34, v124, s[64:65]
  v_cndmask_b32 v113, v34, v113, s[66:67]
  v_cndmask_b32 v125, v34, v125, s[66:67]
  v_cndmask_b32 v114, v34, v114, s[68:69]
  v_cndmask_b32 v126, v34, v126, s[68:69]
  v_cndmask_b32 v115, v34, v115, s[70:71]
  v_cndmask_b32 v127, v34, v127, s[70:71]
  v_max3_f32 v156, v112, v113, v114
  v_max3_f32 v156, v156, v115, v116
  v_max3_f32 v156, v156, v117, v118
  v_max_f32 v156, v156, v119
  v_mov_b32 v157, v156
  s_nop 1
  v_permlane32_swap_b32 v156, v157
  v_max_f32 v156, v156, v157
  v_mov_b32 v157, v156
  s_nop 1
  v_permlane16_swap_b32 v156, v157
  v_max_f32 v156, v156, v157
  v_mul_f32 v156, s83, v156
  v_fma_f32 v112, v112, s83, -v156
  v_fma_f32 v113, v113, s83, -v156
  v_fma_f32 v114, v114, s83, -v156
  v_fma_f32 v115, v115, s83, -v156
  v_fma_f32 v116, v116, s83, -v156
  v_fma_f32 v117, v117, s83, -v156
  v_fma_f32 v118, v118, s83, -v156
  v_fma_f32 v119, v119, s83, -v156
  v_exp_f32 v112, v112
  v_exp_f32 v113, v113
  v_exp_f32 v114, v114
  v_exp_f32 v115, v115
  v_exp_f32 v116, v116
  v_exp_f32 v117, v117
  v_exp_f32 v118, v118
  v_exp_f32 v119, v119
  s_nop 0
  v_add_f32 v156, v116, v117
  v_add_f32 v156, v156, v118
  v_add_f32 v156, v156, v119
  v_cndmask_b32 v156, 0, v156, s[60:61]
  v_add_f32 v156, v156, v112
  v_add_f32 v156, v156, v113
  v_add_f32 v156, v156, v114
  v_add_f32 v156, v156, v115
  v_mov_b32 v157, v156
  s_nop 1
  v_permlane32_swap_b32 v156, v157
  v_add_f32 v156, v156, v157
  v_mov_b32 v157, v156
  s_nop 1
  v_permlane16_swap_b32 v156, v157
  v_add_f32 v156, v156, v157
  v_rcp_f32 v156, v156
  s_nop 0
  v_mul_f32 v112, v112, v156
  v_mul_f32 v113, v113, v156
  v_mul_f32 v114, v114, v156
  v_mul_f32 v115, v115, v156
  v_mul_f32 v116, v116, v156
  v_mul_f32 v117, v117, v156
  v_mul_f32 v118, v118, v156
  v_mul_f32 v119, v119, v156
  v_max3_f32 v156, v120, v121, v122
  v_max3_f32 v156, v156, v123, v124
  v_max3_f32 v156, v156, v125, v126
  v_max3_f32 v156, v156, v127, v128
  v_max3_f32 v156, v156, v129, v130
  v_max_f32 v156, v156, v131
  v_mov_b32 v157, v156
  s_nop 1
  v_permlane32_swap_b32 v156, v157
  v_max_f32 v156, v156, v157
  v_mov_b32 v157, v156
  s_nop 1
  v_permlane16_swap_b32 v156, v157
  v_max_f32 v156, v156, v157
  v_mul_f32 v156, s83, v156
  v_fma_f32 v120, v120, s83, -v156
  v_fma_f32 v121, v121, s83, -v156
  v_fma_f32 v122, v122, s83, -v156
  v_fma_f32 v123, v123, s83, -v156
  v_fma_f32 v124, v124, s83, -v156
  v_fma_f32 v125, v125, s83, -v156
  v_fma_f32 v126, v126, s83, -v156
  v_fma_f32 v127, v127, s83, -v156
  v_fma_f32 v128, v128, s83, -v156
  v_fma_f32 v129, v129, s83, -v156
  v_fma_f32 v130, v130, s83, -v156
  v_fma_f32 v131, v131, s83, -v156
  v_exp_f32 v120, v120
  v_exp_f32 v121, v121
  v_exp_f32 v122, v122
  v_exp_f32 v123, v123
  v_exp_f32 v124, v124
  v_exp_f32 v125, v125
  v_exp_f32 v126, v126
  v_exp_f32 v127, v127
  v_exp_f32 v128, v128
  v_exp_f32 v129, v129
  v_exp_f32 v130, v130
  v_exp_f32 v131, v131
  s_nop 0
  v_add_f32 v156, v128, v129
  v_add_f32 v156, v156, v130
  v_add_f32 v156, v156, v131
  v_cndmask_b32 v156, 0, v156, s[60:61]
  v_add_f32 v156, v156, v120
  v_add_f32 v156, v156, v121
  v_add_f32 v156, v156, v122
  v_add_f32 v156, v156, v123
  v_add_f32 v156, v156, v124
  v_add_f32 v156, v156, v125
  v_add_f32 v156, v156, v126
  v_add_f32 v156, v156, v127
  v_mov_b32 v157, v156
  s_nop 1
  v_permlane32_swap_b32 v156, v157
  v_add_f32 v156, v156, v157
  v_mov_b32 v157, v156
  s_nop 1
  v_permlane16_swap_b32 v156, v157
  v_add_f32 v156, v156, v157
  v_rcp_f32 v156, v156
  s_nop 0
  v_mul_f32 v120, v120, v156
  v_mul_f32 v121, v121, v156
  v_mul_f32 v122, v122, v156
  v_mul_f32 v123, v123, v156
  v_mul_f32 v124, v124, v156
  v_mul_f32 v125, v125, v156
  v_mul_f32 v126, v126, v156
  v_mul_f32 v127, v127, v156
  v_mul_f32 v128, v128, v156
  v_mul_f32 v129, v129, v156
  v_mul_f32 v130, v130, v156
  v_mul_f32 v131, v131, v156
  v_cvt_pk_bf16_f32 v196, v116, v117
  v_cvt_pk_bf16_f32 v197, v118, v119
  v_cvt_pk_bf16_f32 v198, v128, v129
  v_cvt_pk_bf16_f32 v199, v130, v131
  v_cvt_pk_bf16_f32 v192, v120, v121
  v_cvt_pk_bf16_f32 v193, v122, v123
  v_cvt_pk_bf16_f32 v194, v124, v125
  v_cvt_pk_bf16_f32 v195, v126, v127
  v_cvt_pk_bf16_f32 v200, v112, v113
  v_cvt_pk_bf16_f32 v201, v114, v115
  v_permlane16_swap_b32 v196, v198
  v_permlane16_swap_b32 v197, v199
  buffer_store_dwordx4 v[192:195], v30, s[56:59], s81 offen sc1
  s_mov_b64 exec, 0xffffffff
  buffer_store_dwordx4 v[196:199], v30, s[56:59], s81 offen offset:1024 sc1
  s_mov_b64 exec, -1
  buffer_store_dwordx2 v[200:201], v32, s[56:59], s81 offen offset:2048 sc1
  s_mov_b32 s78, s82
  s_mov_b32 s81, 0x80000000
  s_mov_b32 s82, 0
  s_cmp_eq_u32 s80, 1
  s_cbranch_scc1 qd_230
  s_waitcnt vmcnt(0)
  s_cmp_eq_u32 s78, 0
  s_cbranch_scc1 pf_231
  v_mov_b32 v4, 0
  v_mov_b32 v5, 1
  s_mov_b64 exec, 1
  buffer_atomic_add v5, v4, s[72:75], s78 offen sc1
  s_mov_b64 exec, -1
  s_mov_b32 s78, 0
pf_231:
qd_230:
  s_add_u32 s49, s49, s29
qbe_222:
  s_cmp_lt_u32 s49, 64
  s_cbranch_scc1 qf_221
  s_waitcnt vmcnt(0)
  s_cmp_eq_u32 s78, 0
  s_cbranch_scc1 pf_232
  v_mov_b32 v4, 0
  v_mov_b32 v5, 1
  s_mov_b64 exec, 1
  buffer_atomic_add v5, v4, s[72:75], s78 offen sc1
  s_mov_b64 exec, -1
  s_mov_b32 s78, 0
pf_232:
queue:
  s_load_dwordx2 s[4:5], s[0:1], 96
  s_waitcnt lgkmcnt(0)
  s_mov_b32 s32, s4
  s_mov_b32 s33, s5
  s_mov_b32 s34, 256
  s_mov_b32 s35, 0x00020000
  s_waitcnt vmcnt(0) lgkmcnt(0)
  s_barrier
  s_mov_b32 s2, s85
  s_mov_b32 s85, -1
  s_cmp_lg_u32 s2, -1
  s_cbranch_scc1 queue_c
  v_mov_b32 v21, 0
  s_cmp_lg_u32 s20, 0
  s_cbranch_scc1 q_233
  v_mov_b32 v22, 80
  v_mov_b32 v23, 1
  s_mov_b64 exec, 1
  buffer_atomic_add v23, v22, s[32:35], 0 offen sc0 sc1
  s_waitcnt vmcnt(0)
queue_a:
  ds_write_b32 v21, v23
  s_waitcnt lgkmcnt(0)
  s_mov_b64 exec, -1
q_233:
queue_b:
  s_barrier
  ds_read_b32 v23, v21
  s_waitcnt lgkmcnt(0)
  v_readfirstlane_b32 s2, v23
  s_barrier
queue_c:
  s_add_u32 s21, s2, 0
  s_cmp_lt_u32 s2, 32
  s_cbranch_scc1 do_opb
  s_sub_u32 s2, s2, 32
  s_add_u32 s21, s2, 0
  s_cmp_lt_u32 s2, 342
  s_cbranch_scc1 do_pv
  s_sub_u32 s2, s2, 342
  s_branch main_fin
do_opb:
  s_mov_b32 s87, -1
do_opb2:
  s_mov_b32 s2, s21
  s_load_dwordx2 s[4:5], s[0:1], 0
  s_load_dwordx4 s[40:43], s[0:1], 72
  s_load_dwordx2 s[38:39], s[0:1], 104
  s_lshl_b32 s59, s2, 2
  s_add_u32 s59, s59, s20
  s_lshl_b32 s59, s59, 3
  v_lshlrev_b32 v4, 4, v1
  v_lshlrev_b32 v5, 2, v1
  s_waitcnt lgkmcnt(0)
  s_mov_b32 s8, s4
  s_mov_b32 s9, s5
  s_mov_b32 s10, 2621440
  s_mov_b32 s11, 0x00020000
  s_mov_b32 s12, s42
  s_mov_b32 s13, s43
  s_mov_b32 s14, 1280
  s_mov_b32 s15, 0x00020000
  s_mov_b32 s24, s40
  s_mov_b32 s25, s41
  s_mov_b32 s26, 819200
  s_mov_b32 s27, 0x00020000
  s_add_u32 s16, s38, 70713344
  s_addc_u32 s17, s39, 0
  s_mov_b32 s18, 2641920
  s_mov_b32 s19, 0x00020000
  s_add_u32 s28, s38, 81002496
  s_addc_u32 s29, s39, 0
  s_mov_b32 s30, 8192
  s_mov_b32 s31, 0x00020000
  s_add_u32 s72, s38, 81068032
  s_addc_u32 s73, s39, 0
  s_mov_b32 s74, 117760
  s_mov_b32 s75, 0x00020000
  s_mov_b32 s21, 92160
  v_mov_b32 v20, 0
  buffer_load_dword v21, v20, s[72:75], s21 offen sc1
  v_mov_b32 v29, 3277
  s_mul_i32 s21, s20, 320
  s_add_u32 s21, s21, 0
  v_add_u32 v22, s21, v1
  v_mul_u32_u24 v23, v22, v29
  v_lshrrev_b32 v23, 16, v23
  v_mul_u32_u24 v24, 20, v23
  v_sub_u32 v22, v22, v24
  v_bfe_u32 v24, v23, 3, 1
  v_lshlrev_b32 v24, 1, v24
  v_xor_b32 v22, v22, v24
  v_mul_u32_u24 v23, 1280, v23
  v_lshl_add_u32 v8, v22, 4, v23
  s_mul_i32 s21, s20, 320
  s_add_u32 s21, s21, 64
  v_add_u32 v22, s21, v1
  v_mul_u32_u24 v23, v22, v29
  v_lshrrev_b32 v23, 16, v23
  v_mul_u32_u24 v24, 20, v23
  v_sub_u32 v22, v22, v24
  v_bfe_u32 v24, v23, 3, 1
  v_lshlrev_b32 v24, 1, v24
  v_xor_b32 v22, v22, v24
  v_mul_u32_u24 v23, 1280, v23
  v_lshl_add_u32 v9, v22, 4, v23
  s_mul_i32 s21, s20, 320
  s_add_u32 s21, s21, 128
  v_add_u32 v22, s21, v1
  v_mul_u32_u24 v23, v22, v29
  v_lshrrev_b32 v23, 16, v23
  v_mul_u32_u24 v24, 20, v23
  v_sub_u32 v22, v22, v24
  v_bfe_u32 v24, v23, 3, 1
  v_lshlrev_b32 v24, 1, v24
  v_xor_b32 v22, v22, v24
  v_mul_u32_u24 v23, 1280, v23
  v_lshl_add_u32 v10, v22, 4, v23
  s_mul_i32 s21, s20, 320
  s_add_u32 s21, s21, 192
  v_add_u32 v22, s21, v1
  v_mul_u32_u24 v23, v22, v29
  v_lshrrev_b32 v23, 16, v23
  v_mul_u32_u24 v24, 20, v23
  v_sub_u32 v22, v22, v24
  v_bfe_u32 v24, v23, 3, 1
  v_lshlrev_b32 v24, 1, v24
  v_xor_b32 v22, v22, v24
  v_mul_u32_u24 v23, 1280, v23
  v_lshl_add_u32 v11, v22, 4, v23
  s_mul_i32 s21, s20, 320
  s_add_u32 s21, s21, 256
  v_add_u32 v22, s21, v1
  v_mul_u32_u24 v23, v22, v29
  v_lshrrev_b32 v23, 16, v23
  v_mul_u32_u24 v24, 20, v23
  v_sub_u32 v22, v22, v24
  v_bfe_u32 v24, v23, 3, 1
  v_lshlrev_b32 v24, 1, v24
  v_xor_b32 v22, v22, v24
  v_mul_u32_u24 v23, 1280, v23
  v_lshl_add_u32 v12, v22, 4, v23
  s_and_b32 s44, s2, 3
  s_mul_i32 s45, s44, 320
  s_mul_i32 s46, s20, 5120
  v_and_b32 v22, 1, v2
  v_mul_u32_u24 v22, 16512, v22
  v_mul_u32_u24 v23, 33024, v3
  v_lshrrev_b32 v24, 1, v2
  v_lshlrev_b32 v24, 4, v24
  v_add3_u32 v6, v22, v23, v24
  s_lshr_b32 s47, s2, 2
  s_lshl_b32 s47, s47, 2
  s_add_u32 s47, s47, s20
  s_lshl_b32 s47, s47, 1
  s_lshl_b32 s48, s47, 7
  v_lshrrev_b32 v22, 2, v2
  v_lshl_add_u32 v22, v3, 3, v22
  v_mul_u32_u24 v22, 320, v22
  v_and_b32 v23, 3, v2
  v_lshl_add_u32 v22, v23, 3, v22
  v_and_b32 v23, 1, v3
  v_lshlrev_b32 v23, 5, v23
  v_add_u32 v14, v22, v23
  v_sub_u32 v15, v22, v23
  v_add_u32 v16, 61440, v14
  v_add_u32 v17, 61440, v15
  v_add_u32 v18, 122880, v14
  v_add_u32 v19, 122880, v15
  s_add_u32 m0, s46, 0
  s_add_u32 s49, s45, 0
  s_nop 0
  buffer_load_dwordx4 v8, s[24:27], s49 offen lds
  s_add_u32 m0, s46, 1024
  s_nop 0
  buffer_load_dwordx4 v9, s[24:27], s49 offen lds
  s_add_u32 m0, s46, 2048
  s_nop 0
  buffer_load_dwordx4 v10, s[24:27], s49 offen lds
  s_add_u32 m0, s46, 3072
  s_nop 0
  buffer_load_dwordx4 v11, s[24:27], s49 offen lds
  s_add_u32 m0, s46, 4096
  s_nop 0
  buffer_load_dwordx4 v12, s[24:27], s49 offen lds
  s_add_u32 m0, s46, 20480
  s_add_u32 s49, s45, 81920
  s_nop 0
  buffer_load_dwordx4 v8, s[24:27], s49 offen lds
  s_add_u32 m0, s46, 21504
  s_nop 0
  buffer_load_dwordx4 v9, s[24:27], s49 offen lds
  s_add_u32 m0, s46, 22528
  s_nop 0
  buffer_load_dwordx4 v10, s[24:27], s49 offen lds
  s_add_u32 m0, s46, 23552
  s_nop 0
  buffer_load_dwordx4 v11, s[24:27], s49 offen lds
  s_add_u32 m0, s46, 24576
  s_nop 0
  buffer_load_dwordx4 v12, s[24:27], s49 offen lds
  s_waitcnt vmcnt(10)
  v_readfirstlane_b32 s21, v21
  s_cmp_ge_u32 s21, 32
  s_cbranch_scc1 o2_234
  s_mov_b32 s21, 92160
  v_mov_b32 v20, 0
  s_mov_b32 s101, 0
wf_235:
  buffer_load_dword v21, v20, s[72:75], s21 offen sc1
  s_add_u32 s101, s101, 1
  s_cmp_gt_u32 s101, 131072
  s_cbranch_scc1 main_end
  s_waitcnt vmcnt(0)
  v_readfirstlane_b32 s100, v21
  s_cmp_ge_u32 s100, 32
  s_cbranch_scc1 wf_236
  s_sleep 32
  s_branch wf_235
wf_236:
o2_234:
  buffer_load_dwordx4 a[0:3], v6, s[16:19], s48 offen offset:0 sc1
  buffer_load_dwordx4 a[4:7], v6, s[16:19], s48 offen offset:128 sc1
  s_add_u32 s48, s48, 132096
  buffer_load_dwordx4 a[8:11], v6, s[16:19], s48 offen offset:0 sc1
  buffer_load_dwordx4 a[12:15], v6, s[16:19], s48 offen offset:128 sc1
  s_add_u32 s48, s48, 132096
  buffer_load_dwordx4 a[16:19], v6, s[16:19], s48 offen offset:0 sc1
  buffer_load_dwordx4 a[20:23], v6, s[16:19], s48 offen offset:128 sc1
  s_add_u32 s48, s48, 132096
  buffer_load_dwordx4 a[24:27], v6, s[16:19], s48 offen offset:0 sc1
  buffer_load_dwordx4 a[28:31], v6, s[16:19], s48 offen offset:128 sc1
  s_add_u32 s48, s48, 132096
  s_add_u32 m0, s46, 40960
  s_add_u32 s49, s45, 163840
  s_nop 0
  buffer_load_dwordx4 v8, s[24:27], s49 offen lds
  s_add_u32 m0, s46, 41984
  s_nop 0
  buffer_load_dwordx4 v9, s[24:27], s49 offen lds
  s_add_u32 m0, s46, 43008
  s_nop 0
  buffer_load_dwordx4 v10, s[24:27], s49 offen lds
  s_add_u32 m0, s46, 44032
  s_nop 0
  buffer_load_dwordx4 v11, s[24:27], s49 offen lds
  s_add_u32 m0, s46, 45056
  s_nop 0
  buffer_load_dwordx4 v12, s[24:27], s49 offen lds
  buffer_load_dwordx4 a[32:35], v6, s[16:19], s48 offen offset:0 sc1
  buffer_load_dwordx4 a[36:39], v6, s[16:19], s48 offen offset:128 sc1
  s_add_u32 s48, s48, 132096
  buffer_load_dwordx4 a[40:43], v6, s[16:19], s48 offen offset:0 sc1
  buffer_load_dwordx4 a[44:47], v6, s[16:19], s48 offen offset:128 sc1
  s_add_u32 s48, s48, 132096
  s_add_u32 m0, s46, 61440
  s_add_u32 s49, s45, 245760
  s_nop 0
  buffer_load_dwordx4 v8, s[24:27], s49 offen lds
  s_add_u32 m0, s46, 62464
  s_nop 0
  buffer_load_dwordx4 v9, s[24:27], s49 offen lds
  s_add_u32 m0, s46, 63488
  s_nop 0
  buffer_load_dwordx4 v10, s[24:27], s49 offen lds
  s_add_u32 m0, s46, 64512
  s_nop 0
  buffer_load_dwordx4 v11, s[24:27], s49 offen lds
  s_add_u32 m0, s46, 65536
  s_nop 0
  buffer_load_dwordx4 v12, s[24:27], s49 offen lds
  buffer_load_dwordx4 a[48:51], v6, s[16:19], s48 offen offset:0 sc1
  buffer_load_dwordx4 a[52:55], v6, s[16:19], s48 offen offset:128 sc1
  s_add_u32 s48, s48, 132096
  buffer_load_dwordx4 a[56:59], v6, s[16:19], s48 offen offset:0 sc1
  buffer_load_dwordx4 a[60:63], v6, s[16:19], s48 offen offset:128 sc1
  s_add_u32 s48, s48, 132096
  s_add_u32 m0, s46, 81920
  s_add_u32 s49, s45, 327680
  s_nop 0
  buffer_load_dwordx4 v8, s[24:27], s49 offen lds
  s_add_u32 m0, s46, 82944
  s_nop 0
  buffer_load_dwordx4 v9, s[24:27], s49 offen lds
  s_add_u32 m0, s46, 83968
  s_nop 0
  buffer_load_dwordx4 v10, s[24:27], s49 offen lds
  s_add_u32 m0, s46, 84992
  s_nop 0
  buffer_load_dwordx4 v11, s[24:27], s49 offen lds
  s_add_u32 m0, s46, 86016
  s_nop 0
  buffer_load_dwordx4 v12, s[24:27], s49 offen lds
  buffer_load_dwordx4 a[64:67], v6, s[16:19], s48 offen offset:0 sc1
  buffer_load_dwordx4 a[68:71], v6, s[16:19], s48 offen offset:128 sc1
  s_add_u32 s48, s48, 132096
  buffer_load_dwordx4 a[72:75], v6, s[16:19], s48 offen offset:0 sc1
  buffer_load_dwordx4 a[76:79], v6, s[16:19], s48 offen offset:128 sc1
  s_add_u32 s48, s48, 132096
  s_add_u32 m0, s46, 102400
  s_add_u32 s49, s45, 409600
  s_nop 0
  buffer_load_dwordx4 v8, s[24:27], s49 offen lds
  s_add_u32 m0, s46, 103424
  s_nop 0
  buffer_load_dwordx4 v9, s[24:27], s49 offen lds
  s_add_u32 m0, s46, 104448
  s_nop 0
  buffer_load_dwordx4 v10, s[24:27], s49 offen lds
  s_add_u32 m0, s46, 105472
  s_nop 0
  buffer_load_dwordx4 v11, s[24:27], s49 offen lds
  s_add_u32 m0, s46, 106496
  s_nop 0
  buffer_load_dwordx4 v12, s[24:27], s49 offen lds
  s_add_u32 m0, s46, 122880
  s_add_u32 s49, s45, 491520
  s_nop 0
  buffer_load_dwordx4 v8, s[24:27], s49 offen lds
  s_add_u32 m0, s46, 123904
  s_nop 0
  buffer_load_dwordx4 v9, s[24:27], s49 offen lds
  s_add_u32 m0, s46, 124928
  s_nop 0
  buffer_load_dwordx4 v10, s[24:27], s49 offen lds
  s_add_u32 m0, s46, 125952
  s_nop 0
  buffer_load_dwordx4 v11, s[24:27], s49 offen lds
  s_add_u32 m0, s46, 126976
  s_nop 0
  buffer_load_dwordx4 v12, s[24:27], s49 offen lds
  s_waitcnt vmcnt(50)
  s_barrier
  ds_read_b64_tr_b16 v[144:145], v14 offset:0
  ds_read_b64_tr_b16 v[146:147], v14 offset:1280
  ds_read_b64_tr_b16 v[148:149], v15 offset:32
  ds_read_b64_tr_b16 v[150:151], v15 offset:1312
  ds_read_b64_tr_b16 v[152:153], v14 offset:64
  ds_read_b64_tr_b16 v[154:155], v14 offset:1344
  ds_read_b64_tr_b16 v[156:157], v15 offset:96
  ds_read_b64_tr_b16 v[158:159], v15 offset:1376
  ds_read_b64_tr_b16 v[160:161], v14 offset:128
  ds_read_b64_tr_b16 v[162:163], v14 offset:1408
  ds_read_b64_tr_b16 v[164:165], v15 offset:160
  ds_read_b64_tr_b16 v[166:167], v15 offset:1440
  ds_read_b64_tr_b16 v[168:169], v14 offset:192
  ds_read_b64_tr_b16 v[170:171], v14 offset:1472
  ds_read_b64_tr_b16 v[172:173], v15 offset:224
  ds_read_b64_tr_b16 v[174:175], v15 offset:1504
  ds_read_b64_tr_b16 v[176:177], v14 offset:256
  ds_read_b64_tr_b16 v[178:179], v14 offset:1536
  ds_read_b64_tr_b16 v[180:181], v15 offset:288
  ds_read_b64_tr_b16 v[182:183], v15 offset:1568
  s_waitcnt lgkmcnt(0) vmcnt(43)
  v_mfma_f32_16x16x32_bf16 v[64:67], v[144:147], a[0:3], 0
  ds_read_b64_tr_b16 v[184:185], v14 offset:10240
  ds_read_b64_tr_b16 v[186:187], v14 offset:11520
  v_mfma_f32_16x16x32_bf16 v[104:107], v[144:147], a[4:7], 0
  ds_read_b64_tr_b16 v[188:189], v15 offset:10272
  v_mfma_f32_16x16x32_bf16 v[68:71], v[148:151], a[0:3], 0
  ds_read_b64_tr_b16 v[190:191], v15 offset:11552
  v_mfma_f32_16x16x32_bf16 v[108:111], v[148:151], a[4:7], 0
  ds_read_b64_tr_b16 v[192:193], v14 offset:10304
  v_mfma_f32_16x16x32_bf16 v[72:75], v[152:155], a[0:3], 0
  ds_read_b64_tr_b16 v[194:195], v14 offset:11584
  v_mfma_f32_16x16x32_bf16 v[112:115], v[152:155], a[4:7], 0
  ds_read_b64_tr_b16 v[196:197], v15 offset:10336
  ds_read_b64_tr_b16 v[198:199], v15 offset:11616
  v_mfma_f32_16x16x32_bf16 v[76:79], v[156:159], a[0:3], 0
  ds_read_b64_tr_b16 v[200:201], v14 offset:10368
  v_mfma_f32_16x16x32_bf16 v[116:119], v[156:159], a[4:7], 0
  ds_read_b64_tr_b16 v[202:203], v14 offset:11648
  v_mfma_f32_16x16x32_bf16 v[80:83], v[160:163], a[0:3], 0
  ds_read_b64_tr_b16 v[204:205], v15 offset:10400
  v_mfma_f32_16x16x32_bf16 v[120:123], v[160:163], a[4:7], 0
  ds_read_b64_tr_b16 v[206:207], v15 offset:11680
  v_mfma_f32_16x16x32_bf16 v[84:87], v[164:167], a[0:3], 0
  ds_read_b64_tr_b16 v[208:209], v14 offset:10432
  v_mfma_f32_16x16x32_bf16 v[124:127], v[164:167], a[4:7], 0
  ds_read_b64_tr_b16 v[210:211], v14 offset:11712
  ds_read_b64_tr_b16 v[212:213], v15 offset:10464
  v_mfma_f32_16x16x32_bf16 v[88:91], v[168:171], a[0:3], 0
  ds_read_b64_tr_b16 v[214:215], v15 offset:11744
  v_mfma_f32_16x16x32_bf16 v[128:131], v[168:171], a[4:7], 0
  buffer_load_dwordx4 a[80:83], v6, s[16:19], s48 offen offset:0 sc1
  ds_read_b64_tr_b16 v[216:217], v14 offset:10496
  v_mfma_f32_16x16x32_bf16 v[92:95], v[172:175], a[0:3], 0
  ds_read_b64_tr_b16 v[218:219], v14 offset:11776
  v_mfma_f32_16x16x32_bf16 v[132:135], v[172:175], a[4:7], 0
  ds_read_b64_tr_b16 v[220:221], v15 offset:10528
  v_mfma_f32_16x16x32_bf16 v[96:99], v[176:179], a[0:3], 0
  ds_read_b64_tr_b16 v[222:223], v15 offset:11808
  v_mfma_f32_16x16x32_bf16 v[136:139], v[176:179], a[4:7], 0
  buffer_load_dwordx4 a[84:87], v6, s[16:19], s48 offen offset:128 sc1
  v_mfma_f32_16x16x32_bf16 v[100:103], v[180:183], a[0:3], 0
  s_add_u32 s48, s48, 132096
  v_mfma_f32_16x16x32_bf16 v[140:143], v[180:183], a[4:7], 0
  s_waitcnt lgkmcnt(0) vmcnt(43)
  s_barrier
  v_mfma_f32_16x16x32_bf16 v[64:67], v[184:187], a[8:11], v[64:67]
  s_add_u32 m0, s46, 0
  ds_read_b64_tr_b16 v[144:145], v14 offset:20480
  ds_read_b64_tr_b16 v[146:147], v14 offset:21760
  v_mfma_f32_16x16x32_bf16 v[104:107], v[184:187], a[12:15], v[104:107]
  s_add_u32 s49, s45, 573440
  ds_read_b64_tr_b16 v[148:149], v15 offset:20512
  v_mfma_f32_16x16x32_bf16 v[68:71], v[188:191], a[8:11], v[68:71]
  buffer_load_dwordx4 v8, s[24:27], s49 offen lds
  ds_read_b64_tr_b16 v[150:151], v15 offset:21792
  v_mfma_f32_16x16x32_bf16 v[108:111], v[188:191], a[12:15], v[108:111]
  s_add_u32 m0, s46, 1024
  ds_read_b64_tr_b16 v[152:153], v14 offset:20544
  v_mfma_f32_16x16x32_bf16 v[72:75], v[192:195], a[8:11], v[72:75]
  buffer_load_dwordx4 v9, s[24:27], s49 offen lds
  ds_read_b64_tr_b16 v[154:155], v14 offset:21824
  v_mfma_f32_16x16x32_bf16 v[112:115], v[192:195], a[12:15], v[112:115]
  s_add_u32 m0, s46, 2048
  ds_read_b64_tr_b16 v[156:157], v15 offset:20576
  ds_read_b64_tr_b16 v[158:159], v15 offset:21856
  v_mfma_f32_16x16x32_bf16 v[76:79], v[196:199], a[8:11], v[76:79]
  buffer_load_dwordx4 v10, s[24:27], s49 offen lds
  ds_read_b64_tr_b16 v[160:161], v14 offset:20608
  v_mfma_f32_16x16x32_bf16 v[116:119], v[196:199], a[12:15], v[116:119]
  s_add_u32 m0, s46, 3072
  ds_read_b64_tr_b16 v[162:163], v14 offset:21888
  v_mfma_f32_16x16x32_bf16 v[80:83], v[200:203], a[8:11], v[80:83]
  buffer_load_dwordx4 v11, s[24:27], s49 offen lds
  ds_read_b64_tr_b16 v[164:165], v15 offset:20640
  v_mfma_f32_16x16x32_bf16 v[120:123], v[200:203], a[12:15], v[120:123]
  s_add_u32 m0, s46, 4096
  ds_read_b64_tr_b16 v[166:167], v15 offset:21920
  v_mfma_f32_16x16x32_bf16 v[84:87], v[204:207], a[8:11], v[84:87]
  buffer_load_dwordx4 v12, s[24:27], s49 offen lds
  ds_read_b64_tr_b16 v[168:169], v14 offset:20672
  v_mfma_f32_16x16x32_bf16 v[124:127], v[204:207], a[12:15], v[124:127]
  ds_read_b64_tr_b16 v[170:171], v14 offset:21952
  ds_read_b64_tr_b16 v[172:173], v15 offset:20704
  v_mfma_f32_16x16x32_bf16 v[88:91], v[208:211], a[8:11], v[88:91]
  ds_read_b64_tr_b16 v[174:175], v15 offset:21984
  v_mfma_f32_16x16x32_bf16 v[128:131], v[208:211], a[12:15], v[128:131]
  buffer_load_dwordx4 a[88:91], v6, s[16:19], s48 offen offset:0 sc1
  ds_read_b64_tr_b16 v[176:177], v14 offset:20736
  v_mfma_f32_16x16x32_bf16 v[92:95], v[212:215], a[8:11], v[92:95]
  ds_read_b64_tr_b16 v[178:179], v14 offset:22016
  v_mfma_f32_16x16x32_bf16 v[132:135], v[212:215], a[12:15], v[132:135]
  ds_read_b64_tr_b16 v[180:181], v15 offset:20768
  v_mfma_f32_16x16x32_bf16 v[96:99], v[216:219], a[8:11], v[96:99]
  ds_read_b64_tr_b16 v[182:183], v15 offset:22048
  v_mfma_f32_16x16x32_bf16 v[136:139], v[216:219], a[12:15], v[136:139]
  buffer_load_dwordx4 a[92:95], v6, s[16:19], s48 offen offset:128 sc1
  v_mfma_f32_16x16x32_bf16 v[100:103], v[220:223], a[8:11], v[100:103]
  s_add_u32 s48, s48, 132096
  v_mfma_f32_16x16x32_bf16 v[140:143], v[220:223], a[12:15], v[140:143]
  s_waitcnt lgkmcnt(0) vmcnt(48)
  v_mfma_f32_16x16x32_bf16 v[64:67], v[144:147], a[16:19], v[64:67]
  ds_read_b64_tr_b16 v[184:185], v14 offset:30720
  ds_read_b64_tr_b16 v[186:187], v14 offset:32000
  v_mfma_f32_16x16x32_bf16 v[104:107], v[144:147], a[20:23], v[104:107]
  ds_read_b64_tr_b16 v[188:189], v15 offset:30752
  v_mfma_f32_16x16x32_bf16 v[68:71], v[148:151], a[16:19], v[68:71]
  ds_read_b64_tr_b16 v[190:191], v15 offset:32032
  v_mfma_f32_16x16x32_bf16 v[108:111], v[148:151], a[20:23], v[108:111]
  ds_read_b64_tr_b16 v[192:193], v14 offset:30784
  v_mfma_f32_16x16x32_bf16 v[72:75], v[152:155], a[16:19], v[72:75]
  ds_read_b64_tr_b16 v[194:195], v14 offset:32064
  v_mfma_f32_16x16x32_bf16 v[112:115], v[152:155], a[20:23], v[112:115]
  ds_read_b64_tr_b16 v[196:197], v15 offset:30816
  ds_read_b64_tr_b16 v[198:199], v15 offset:32096
  v_mfma_f32_16x16x32_bf16 v[76:79], v[156:159], a[16:19], v[76:79]
  ds_read_b64_tr_b16 v[200:201], v14 offset:30848
  v_mfma_f32_16x16x32_bf16 v[116:119], v[156:159], a[20:23], v[116:119]
  ds_read_b64_tr_b16 v[202:203], v14 offset:32128
  v_mfma_f32_16x16x32_bf16 v[80:83], v[160:163], a[16:19], v[80:83]
  ds_read_b64_tr_b16 v[204:205], v15 offset:30880
  v_mfma_f32_16x16x32_bf16 v[120:123], v[160:163], a[20:23], v[120:123]
  ds_read_b64_tr_b16 v[206:207], v15 offset:32160
  v_mfma_f32_16x16x32_bf16 v[84:87], v[164:167], a[16:19], v[84:87]
  ds_read_b64_tr_b16 v[208:209], v14 offset:30912
  v_mfma_f32_16x16x32_bf16 v[124:127], v[164:167], a[20:23], v[124:127]
  ds_read_b64_tr_b16 v[210:211], v14 offset:32192
  ds_read_b64_tr_b16 v[212:213], v15 offset:30944
  v_mfma_f32_16x16x32_bf16 v[88:91], v[168:171], a[16:19], v[88:91]
  ds_read_b64_tr_b16 v[214:215], v15 offset:32224
  v_mfma_f32_16x16x32_bf16 v[128:131], v[168:171], a[20:23], v[128:131]
  buffer_load_dwordx4 a[96:99], v6, s[16:19], s48 offen offset:0 sc1
  ds_read_b64_tr_b16 v[216:217], v14 offset:30976
  v_mfma_f32_16x16x32_bf16 v[92:95], v[172:175], a[16:19], v[92:95]
  ds_read_b64_tr_b16 v[218:219], v14 offset:32256
  v_mfma_f32_16x16x32_bf16 v[132:135], v[172:175], a[20:23], v[132:135]
  ds_read_b64_tr_b16 v[220:221], v15 offset:31008
  v_mfma_f32_16x16x32_bf16 v[96:99], v[176:179], a[16:19], v[96:99]
  ds_read_b64_tr_b16 v[222:223], v15 offset:32288
  v_mfma_f32_16x16x32_bf16 v[136:139], v[176:179], a[20:23], v[136:139]
  buffer_load_dwordx4 a[100:103], v6, s[16:19], s48 offen offset:128 sc1
  v_mfma_f32_16x16x32_bf16 v[100:103], v[180:183], a[16:19], v[100:103]
  s_add_u32 s48, s48, 132096
  v_mfma_f32_16x16x32_bf16 v[140:143], v[180:183], a[20:23], v[140:143]
  s_waitcnt lgkmcnt(0) vmcnt(43)
  s_barrier
  v_mfma_f32_16x16x32_bf16 v[64:67], v[184:187], a[24:27], v[64:67]
  s_add_u32 m0, s46, 20480
  ds_read_b64_tr_b16 v[144:145], v14 offset:40960
  ds_read_b64_tr_b16 v[146:147], v14 offset:42240
  v_mfma_f32_16x16x32_bf16 v[104:107], v[184:187], a[28:31], v[104:107]
  s_add_u32 s49, s45, 655360
  ds_read_b64_tr_b16 v[148:149], v15 offset:40992
  v_mfma_f32_16x16x32_bf16 v[68:71], v[188:191], a[24:27], v[68:71]
  buffer_load_dwordx4 v8, s[24:27], s49 offen lds
  ds_read_b64_tr_b16 v[150:151], v15 offset:42272
  v_mfma_f32_16x16x32_bf16 v[108:111], v[188:191], a[28:31], v[108:111]
  s_add_u32 m0, s46, 21504
  ds_read_b64_tr_b16 v[152:153], v14 offset:41024
  v_mfma_f32_16x16x32_bf16 v[72:75], v[192:195], a[24:27], v[72:75]
  buffer_load_dwordx4 v9, s[24:27], s49 offen lds
  ds_read_b64_tr_b16 v[154:155], v14 offset:42304
  v_mfma_f32_16x16x32_bf16 v[112:115], v[192:195], a[28:31], v[112:115]
  s_add_u32 m0, s46, 22528
  ds_read_b64_tr_b16 v[156:157], v15 offset:41056
  ds_read_b64_tr_b16 v[158:159], v15 offset:42336
  v_mfma_f32_16x16x32_bf16 v[76:79], v[196:199], a[24:27], v[76:79]
  buffer_load_dwordx4 v10, s[24:27], s49 offen lds
  ds_read_b64_tr_b16 v[160:161], v14 offset:41088
  v_mfma_f32_16x16x32_bf16 v[116:119], v[196:199], a[28:31], v[116:119]
  s_add_u32 m0, s46, 23552
  ds_read_b64_tr_b16 v[162:163], v14 offset:42368
  v_mfma_f32_16x16x32_bf16 v[80:83], v[200:203], a[24:27], v[80:83]
  buffer_load_dwordx4 v11, s[24:27], s49 offen lds
  ds_read_b64_tr_b16 v[164:165], v15 offset:41120
  v_mfma_f32_16x16x32_bf16 v[120:123], v[200:203], a[28:31], v[120:123]
  s_add_u32 m0, s46, 24576
  ds_read_b64_tr_b16 v[166:167], v15 offset:42400
  v_mfma_f32_16x16x32_bf16 v[84:87], v[204:207], a[24:27], v[84:87]
  buffer_load_dwordx4 v12, s[24:27], s49 offen lds
  ds_read_b64_tr_b16 v[168:169], v14 offset:41152
  v_mfma_f32_16x16x32_bf16 v[124:127], v[204:207], a[28:31], v[124:127]
  ds_read_b64_tr_b16 v[170:171], v14 offset:42432
  ds_read_b64_tr_b16 v[172:173], v15 offset:41184
  v_mfma_f32_16x16x32_bf16 v[88:91], v[208:211], a[24:27], v[88:91]
  ds_read_b64_tr_b16 v[174:175], v15 offset:42464
  v_mfma_f32_16x16x32_bf16 v[128:131], v[208:211], a[28:31], v[128:131]
  buffer_load_dwordx4 a[104:107], v6, s[16:19], s48 offen offset:0 sc1
  ds_read_b64_tr_b16 v[176:177], v14 offset:41216
  v_mfma_f32_16x16x32_bf16 v[92:95], v[212:215], a[24:27], v[92:95]
  ds_read_b64_tr_b16 v[178:179], v14 offset:42496
  v_mfma_f32_16x16x32_bf16 v[132:135], v[212:215], a[28:31], v[132:135]
  ds_read_b64_tr_b16 v[180:181], v15 offset:41248
  v_mfma_f32_16x16x32_bf16 v[96:99], v[216:219], a[24:27], v[96:99]
  ds_read_b64_tr_b16 v[182:183], v15 offset:42528
  v_mfma_f32_16x16x32_bf16 v[136:139], v[216:219], a[28:31], v[136:139]
  buffer_load_dwordx4 a[108:111], v6, s[16:19], s48 offen offset:128 sc1
  v_mfma_f32_16x16x32_bf16 v[100:103], v[220:223], a[24:27], v[100:103]
  s_add_u32 s48, s48, 132096
  v_mfma_f32_16x16x32_bf16 v[140:143], v[220:223], a[28:31], v[140:143]
  s_waitcnt lgkmcnt(0) vmcnt(48)
  v_mfma_f32_16x16x32_bf16 v[64:67], v[144:147], a[32:35], v[64:67]
  ds_read_b64_tr_b16 v[184:185], v14 offset:51200
  ds_read_b64_tr_b16 v[186:187], v14 offset:52480
  v_mfma_f32_16x16x32_bf16 v[104:107], v[144:147], a[36:39], v[104:107]
  ds_read_b64_tr_b16 v[188:189], v15 offset:51232
  v_mfma_f32_16x16x32_bf16 v[68:71], v[148:151], a[32:35], v[68:71]
  ds_read_b64_tr_b16 v[190:191], v15 offset:52512
  v_mfma_f32_16x16x32_bf16 v[108:111], v[148:151], a[36:39], v[108:111]
  ds_read_b64_tr_b16 v[192:193], v14 offset:51264
  v_mfma_f32_16x16x32_bf16 v[72:75], v[152:155], a[32:35], v[72:75]
  ds_read_b64_tr_b16 v[194:195], v14 offset:52544
  v_mfma_f32_16x16x32_bf16 v[112:115], v[152:155], a[36:39], v[112:115]
  ds_read_b64_tr_b16 v[196:197], v15 offset:51296
  ds_read_b64_tr_b16 v[198:199], v15 offset:52576
  v_mfma_f32_16x16x32_bf16 v[76:79], v[156:159], a[32:35], v[76:79]
  ds_read_b64_tr_b16 v[200:201], v14 offset:51328
  v_mfma_f32_16x16x32_bf16 v[116:119], v[156:159], a[36:39], v[116:119]
  ds_read_b64_tr_b16 v[202:203], v14 offset:52608
  v_mfma_f32_16x16x32_bf16 v[80:83], v[160:163], a[32:35], v[80:83]
  ds_read_b64_tr_b16 v[204:205], v15 offset:51360
  v_mfma_f32_16x16x32_bf16 v[120:123], v[160:163], a[36:39], v[120:123]
  ds_read_b64_tr_b16 v[206:207], v15 offset:52640
  v_mfma_f32_16x16x32_bf16 v[84:87], v[164:167], a[32:35], v[84:87]
  ds_read_b64_tr_b16 v[208:209], v14 offset:51392
  v_mfma_f32_16x16x32_bf16 v[124:127], v[164:167], a[36:39], v[124:127]
  ds_read_b64_tr_b16 v[210:211], v14 offset:52672
  ds_read_b64_tr_b16 v[212:213], v15 offset:51424
  v_mfma_f32_16x16x32_bf16 v[88:91], v[168:171], a[32:35], v[88:91]
  ds_read_b64_tr_b16 v[214:215], v15 offset:52704
  v_mfma_f32_16x16x32_bf16 v[128:131], v[168:171], a[36:39], v[128:131]
  buffer_load_dwordx4 a[112:115], v6, s[16:19], s48 offen offset:0 sc1
  ds_read_b64_tr_b16 v[216:217], v14 offset:51456
  v_mfma_f32_16x16x32_bf16 v[92:95], v[172:175], a[32:35], v[92:95]
  ds_read_b64_tr_b16 v[218:219], v14 offset:52736
  v_mfma_f32_16x16x32_bf16 v[132:135], v[172:175], a[36:39], v[132:135]
  ds_read_b64_tr_b16 v[220:221], v15 offset:51488
  v_mfma_f32_16x16x32_bf16 v[96:99], v[176:179], a[32:35], v[96:99]
  ds_read_b64_tr_b16 v[222:223], v15 offset:52768
  v_mfma_f32_16x16x32_bf16 v[136:139], v[176:179], a[36:39], v[136:139]
  buffer_load_dwordx4 a[116:119], v6, s[16:19], s48 offen offset:128 sc1
  v_mfma_f32_16x16x32_bf16 v[100:103], v[180:183], a[32:35], v[100:103]
  s_add_u32 s48, s48, 132096
  v_mfma_f32_16x16x32_bf16 v[140:143], v[180:183], a[36:39], v[140:143]
  s_waitcnt lgkmcnt(0) vmcnt(43)
  s_barrier
  v_mfma_f32_16x16x32_bf16 v[64:67], v[184:187], a[40:43], v[64:67]
  s_add_u32 m0, s46, 40960
  ds_read_b64_tr_b16 v[144:145], v16 offset:0
  ds_read_b64_tr_b16 v[146:147], v16 offset:1280
  v_mfma_f32_16x16x32_bf16 v[104:107], v[184:187], a[44:47], v[104:107]
  s_add_u32 s49, s45, 737280
  ds_read_b64_tr_b16 v[148:149], v17 offset:32
  v_mfma_f32_16x16x32_bf16 v[68:71], v[188:191], a[40:43], v[68:71]
  buffer_load_dwordx4 v8, s[24:27], s49 offen lds
  ds_read_b64_tr_b16 v[150:151], v17 offset:1312
  v_mfma_f32_16x16x32_bf16 v[108:111], v[188:191], a[44:47], v[108:111]
  s_add_u32 m0, s46, 41984
  ds_read_b64_tr_b16 v[152:153], v16 offset:64
  v_mfma_f32_16x16x32_bf16 v[72:75], v[192:195], a[40:43], v[72:75]
  buffer_load_dwordx4 v9, s[24:27], s49 offen lds
  ds_read_b64_tr_b16 v[154:155], v16 offset:1344
  v_mfma_f32_16x16x32_bf16 v[112:115], v[192:195], a[44:47], v[112:115]
  s_add_u32 m0, s46, 43008
  ds_read_b64_tr_b16 v[156:157], v17 offset:96
  ds_read_b64_tr_b16 v[158:159], v17 offset:1376
  v_mfma_f32_16x16x32_bf16 v[76:79], v[196:199], a[40:43], v[76:79]
  buffer_load_dwordx4 v10, s[24:27], s49 offen lds
  ds_read_b64_tr_b16 v[160:161], v16 offset:128
  v_mfma_f32_16x16x32_bf16 v[116:119], v[196:199], a[44:47], v[116:119]
  s_add_u32 m0, s46, 44032
  ds_read_b64_tr_b16 v[162:163], v16 offset:1408
  v_mfma_f32_16x16x32_bf16 v[80:83], v[200:203], a[40:43], v[80:83]
  buffer_load_dwordx4 v11, s[24:27], s49 offen lds
  ds_read_b64_tr_b16 v[164:165], v17 offset:160
  v_mfma_f32_16x16x32_bf16 v[120:123], v[200:203], a[44:47], v[120:123]
  s_add_u32 m0, s46, 45056
  ds_read_b64_tr_b16 v[166:167], v17 offset:1440
  v_mfma_f32_16x16x32_bf16 v[84:87], v[204:207], a[40:43], v[84:87]
  buffer_load_dwordx4 v12, s[24:27], s49 offen lds
  ds_read_b64_tr_b16 v[168:169], v16 offset:192
  v_mfma_f32_16x16x32_bf16 v[124:127], v[204:207], a[44:47], v[124:127]
  ds_read_b64_tr_b16 v[170:171], v16 offset:1472
  ds_read_b64_tr_b16 v[172:173], v17 offset:224
  v_mfma_f32_16x16x32_bf16 v[88:91], v[208:211], a[40:43], v[88:91]
  ds_read_b64_tr_b16 v[174:175], v17 offset:1504
  v_mfma_f32_16x16x32_bf16 v[128:131], v[208:211], a[44:47], v[128:131]
  buffer_load_dwordx4 a[120:123], v6, s[16:19], s48 offen offset:0 sc1
  ds_read_b64_tr_b16 v[176:177], v16 offset:256
  v_mfma_f32_16x16x32_bf16 v[92:95], v[212:215], a[40:43], v[92:95]
  ds_read_b64_tr_b16 v[178:179], v16 offset:1536
  v_mfma_f32_16x16x32_bf16 v[132:135], v[212:215], a[44:47], v[132:135]
  ds_read_b64_tr_b16 v[180:181], v17 offset:288
  v_mfma_f32_16x16x32_bf16 v[96:99], v[216:219], a[40:43], v[96:99]
  ds_read_b64_tr_b16 v[182:183], v17 offset:1568
  v_mfma_f32_16x16x32_bf16 v[136:139], v[216:219], a[44:47], v[136:139]
  buffer_load_dwordx4 a[124:127], v6, s[16:19], s48 offen offset:128 sc1
  v_mfma_f32_16x16x32_bf16 v[100:103], v[220:223], a[40:43], v[100:103]
  s_add_u32 s48, s48, 132096
  v_mfma_f32_16x16x32_bf16 v[140:143], v[220:223], a[44:47], v[140:143]
  s_waitcnt lgkmcnt(0) vmcnt(48)
  v_mfma_f32_16x16x32_bf16 v[64:67], v[144:147], a[48:51], v[64:67]
  ds_read_b64_tr_b16 v[184:185], v16 offset:10240
  ds_read_b64_tr_b16 v[186:187], v16 offset:11520
  v_mfma_f32_16x16x32_bf16 v[104:107], v[144:147], a[52:55], v[104:107]
  ds_read_b64_tr_b16 v[188:189], v17 offset:10272
  v_mfma_f32_16x16x32_bf16 v[68:71], v[148:151], a[48:51], v[68:71]
  ds_read_b64_tr_b16 v[190:191], v17 offset:11552
  v_mfma_f32_16x16x32_bf16 v[108:111], v[148:151], a[52:55], v[108:111]
  ds_read_b64_tr_b16 v[192:193], v16 offset:10304
  v_mfma_f32_16x16x32_bf16 v[72:75], v[152:155], a[48:51], v[72:75]
  ds_read_b64_tr_b16 v[194:195], v16 offset:11584
  v_mfma_f32_16x16x32_bf16 v[112:115], v[152:155], a[52:55], v[112:115]
  ds_read_b64_tr_b16 v[196:197], v17 offset:10336
  ds_read_b64_tr_b16 v[198:199], v17 offset:11616
  v_mfma_f32_16x16x32_bf16 v[76:79], v[156:159], a[48:51], v[76:79]
  ds_read_b64_tr_b16 v[200:201], v16 offset:10368
  v_mfma_f32_16x16x32_bf16 v[116:119], v[156:159], a[52:55], v[116:119]
  ds_read_b64_tr_b16 v[202:203], v16 offset:11648
  v_mfma_f32_16x16x32_bf16 v[80:83], v[160:163], a[48:51], v[80:83]
  ds_read_b64_tr_b16 v[204:205], v17 offset:10400
  v_mfma_f32_16x16x32_bf16 v[120:123], v[160:163], a[52:55], v[120:123]
  ds_read_b64_tr_b16 v[206:207], v17 offset:11680
  v_mfma_f32_16x16x32_bf16 v[84:87], v[164:167], a[48:51], v[84:87]
  ds_read_b64_tr_b16 v[208:209], v16 offset:10432
  v_mfma_f32_16x16x32_bf16 v[124:127], v[164:167], a[52:55], v[124:127]
  ds_read_b64_tr_b16 v[210:211], v16 offset:11712
  ds_read_b64_tr_b16 v[212:213], v17 offset:10464
  v_mfma_f32_16x16x32_bf16 v[88:91], v[168:171], a[48:51], v[88:91]
  ds_read_b64_tr_b16 v[214:215], v17 offset:11744
  v_mfma_f32_16x16x32_bf16 v[128:131], v[168:171], a[52:55], v[128:131]
  buffer_load_dwordx4 a[128:131], v6, s[16:19], s48 offen offset:0 sc1
  ds_read_b64_tr_b16 v[216:217], v16 offset:10496
  v_mfma_f32_16x16x32_bf16 v[92:95], v[172:175], a[48:51], v[92:95]
  ds_read_b64_tr_b16 v[218:219], v16 offset:11776
  v_mfma_f32_16x16x32_bf16 v[132:135], v[172:175], a[52:55], v[132:135]
  ds_read_b64_tr_b16 v[220:221], v17 offset:10528
  v_mfma_f32_16x16x32_bf16 v[96:99], v[176:179], a[48:51], v[96:99]
  ds_read_b64_tr_b16 v[222:223], v17 offset:11808
  v_mfma_f32_16x16x32_bf16 v[136:139], v[176:179], a[52:55], v[136:139]
  buffer_load_dwordx4 a[132:135], v6, s[16:19], s48 offen offset:128 sc1
  v_mfma_f32_16x16x32_bf16 v[100:103], v[180:183], a[48:51], v[100:103]
  s_add_u32 s48, s48, 132096
  v_mfma_f32_16x16x32_bf16 v[140:143], v[180:183], a[52:55], v[140:143]
  s_waitcnt lgkmcnt(0) vmcnt(43)
  s_barrier
  v_mfma_f32_16x16x32_bf16 v[64:67], v[184:187], a[56:59], v[64:67]
  ds_read_b64_tr_b16 v[144:145], v16 offset:20480
  ds_read_b64_tr_b16 v[146:147], v16 offset:21760
  v_mfma_f32_16x16x32_bf16 v[104:107], v[184:187], a[60:63], v[104:107]
  ds_read_b64_tr_b16 v[148:149], v17 offset:20512
  v_mfma_f32_16x16x32_bf16 v[68:71], v[188:191], a[56:59], v[68:71]
  ds_read_b64_tr_b16 v[150:151], v17 offset:21792
  v_mfma_f32_16x16x32_bf16 v[108:111], v[188:191], a[60:63], v[108:111]
  ds_read_b64_tr_b16 v[152:153], v16 offset:20544
  v_mfma_f32_16x16x32_bf16 v[72:75], v[192:195], a[56:59], v[72:75]
  ds_read_b64_tr_b16 v[154:155], v16 offset:21824
  v_mfma_f32_16x16x32_bf16 v[112:115], v[192:195], a[60:63], v[112:115]
  ds_read_b64_tr_b16 v[156:157], v17 offset:20576
  ds_read_b64_tr_b16 v[158:159], v17 offset:21856
  v_mfma_f32_16x16x32_bf16 v[76:79], v[196:199], a[56:59], v[76:79]
  ds_read_b64_tr_b16 v[160:161], v16 offset:20608
  v_mfma_f32_16x16x32_bf16 v[116:119], v[196:199], a[60:63], v[116:119]
  ds_read_b64_tr_b16 v[162:163], v16 offset:21888
  v_mfma_f32_16x16x32_bf16 v[80:83], v[200:203], a[56:59], v[80:83]
  ds_read_b64_tr_b16 v[164:165], v17 offset:20640
  v_mfma_f32_16x16x32_bf16 v[120:123], v[200:203], a[60:63], v[120:123]
  ds_read_b64_tr_b16 v[166:167], v17 offset:21920
  v_mfma_f32_16x16x32_bf16 v[84:87], v[204:207], a[56:59], v[84:87]
  ds_read_b64_tr_b16 v[168:169], v16 offset:20672
  v_mfma_f32_16x16x32_bf16 v[124:127], v[204:207], a[60:63], v[124:127]
  ds_read_b64_tr_b16 v[170:171], v16 offset:21952
  ds_read_b64_tr_b16 v[172:173], v17 offset:20704
  v_mfma_f32_16x16x32_bf16 v[88:91], v[208:211], a[56:59], v[88:91]
  ds_read_b64_tr_b16 v[174:175], v17 offset:21984
  v_mfma_f32_16x16x32_bf16 v[128:131], v[208:211], a[60:63], v[128:131]
  buffer_load_dwordx4 a[136:139], v6, s[16:19], s48 offen offset:0 sc1
  ds_read_b64_tr_b16 v[176:177], v16 offset:20736
  v_mfma_f32_16x16x32_bf16 v[92:95], v[212:215], a[56:59], v[92:95]
  ds_read_b64_tr_b16 v[178:179], v16 offset:22016
  v_mfma_f32_16x16x32_bf16 v[132:135], v[212:215], a[60:63], v[132:135]
  ds_read_b64_tr_b16 v[180:181], v17 offset:20768
  v_mfma_f32_16x16x32_bf16 v[96:99], v[216:219], a[56:59], v[96:99]
  ds_read_b64_tr_b16 v[182:183], v17 offset:22048
  v_mfma_f32_16x16x32_bf16 v[136:139], v[216:219], a[60:63], v[136:139]
  buffer_load_dwordx4 a[140:143], v6, s[16:19], s48 offen offset:128 sc1
  v_mfma_f32_16x16x32_bf16 v[100:103], v[220:223], a[56:59], v[100:103]
  s_add_u32 s48, s48, 132096
  v_mfma_f32_16x16x32_bf16 v[140:143], v[220:223], a[60:63], v[140:143]
  s_waitcnt lgkmcnt(0) vmcnt(43)
  v_mfma_f32_16x16x32_bf16 v[64:67], v[144:147], a[64:67], v[64:67]
  ds_read_b64_tr_b16 v[184:185], v16 offset:30720
  ds_read_b64_tr_b16 v[186:187], v16 offset:32000
  v_mfma_f32_16x16x32_bf16 v[104:107], v[144:147], a[68:71], v[104:107]
  ds_read_b64_tr_b16 v[188:189], v17 offset:30752
  v_mfma_f32_16x16x32_bf16 v[68:71], v[148:151], a[64:67], v[68:71]
  ds_read_b64_tr_b16 v[190:191], v17 offset:32032
  v_mfma_f32_16x16x32_bf16 v[108:111], v[148:151], a[68:71], v[108:111]
  ds_read_b64_tr_b16 v[192:193], v16 offset:30784
  v_mfma_f32_16x16x32_bf16 v[72:75], v[152:155], a[64:67], v[72:75]
  ds_read_b64_tr_b16 v[194:195], v16 offset:32064
  v_mfma_f32_16x16x32_bf16 v[112:115], v[152:155], a[68:71], v[112:115]
  ds_read_b64_tr_b16 v[196:197], v17 offset:30816
  ds_read_b64_tr_b16 v[198:199], v17 offset:32096
  v_mfma_f32_16x16x32_bf16 v[76:79], v[156:159], a[64:67], v[76:79]
  ds_read_b64_tr_b16 v[200:201], v16 offset:30848
  v_mfma_f32_16x16x32_bf16 v[116:119], v[156:159], a[68:71], v[116:119]
  ds_read_b64_tr_b16 v[202:203], v16 offset:32128
  v_mfma_f32_16x16x32_bf16 v[80:83], v[160:163], a[64:67], v[80:83]
  ds_read_b64_tr_b16 v[204:205], v17 offset:30880
  v_mfma_f32_16x16x32_bf16 v[120:123], v[160:163], a[68:71], v[120:123]
  ds_read_b64_tr_b16 v[206:207], v17 offset:32160
  v_mfma_f32_16x16x32_bf16 v[84:87], v[164:167], a[64:67], v[84:87]
  ds_read_b64_tr_b16 v[208:209], v16 offset:30912
  v_mfma_f32_16x16x32_bf16 v[124:127], v[164:167], a[68:71], v[124:127]
  ds_read_b64_tr_b16 v[210:211], v16 offset:32192
  ds_read_b64_tr_b16 v[212:213], v17 offset:30944
  v_mfma_f32_16x16x32_bf16 v[88:91], v[168:171], a[64:67], v[88:91]
  ds_read_b64_tr_b16 v[214:215], v17 offset:32224
  v_mfma_f32_16x16x32_bf16 v[128:131], v[168:171], a[68:71], v[128:131]
  buffer_load_dwordx4 a[144:147], v6, s[16:19], s48 offen offset:0 sc1
  ds_read_b64_tr_b16 v[216:217], v16 offset:30976
  v_mfma_f32_16x16x32_bf16 v[92:95], v[172:175], a[64:67], v[92:95]
  ds_read_b64_tr_b16 v[218:219], v16 offset:32256
  v_mfma_f32_16x16x32_bf16 v[132:135], v[172:175], a[68:71], v[132:135]
  ds_read_b64_tr_b16 v[220:221], v17 offset:31008
  v_mfma_f32_16x16x32_bf16 v[96:99], v[176:179], a[64:67], v[96:99]
  ds_read_b64_tr_b16 v[222:223], v17 offset:32288
  v_mfma_f32_16x16x32_bf16 v[136:139], v[176:179], a[68:71], v[136:139]
  buffer_load_dwordx4 a[148:151], v6, s[16:19], s48 offen offset:128 sc1
  v_mfma_f32_16x16x32_bf16 v[100:103], v[180:183], a[64:67], v[100:103]
  s_add_u32 s48, s48, 132096
  v_mfma_f32_16x16x32_bf16 v[140:143], v[180:183], a[68:71], v[140:143]
  s_waitcnt lgkmcnt(0) vmcnt(38)
  s_barrier
  v_mfma_f32_16x16x32_bf16 v[64:67], v[184:187], a[72:75], v[64:67]
  ds_read_b64_tr_b16 v[144:145], v16 offset:40960
  ds_read_b64_tr_b16 v[146:147], v16 offset:42240
  v_mfma_f32_16x16x32_bf16 v[104:107], v[184:187], a[76:79], v[104:107]
  ds_read_b64_tr_b16 v[148:149], v17 offset:40992
  v_mfma_f32_16x16x32_bf16 v[68:71], v[188:191], a[72:75], v[68:71]
  ds_read_b64_tr_b16 v[150:151], v17 offset:42272
  v_mfma_f32_16x16x32_bf16 v[108:111], v[188:191], a[76:79], v[108:111]
  ds_read_b64_tr_b16 v[152:153], v16 offset:41024
  v_mfma_f32_16x16x32_bf16 v[72:75], v[192:195], a[72:75], v[72:75]
  ds_read_b64_tr_b16 v[154:155], v16 offset:42304
  v_mfma_f32_16x16x32_bf16 v[112:115], v[192:195], a[76:79], v[112:115]
  ds_read_b64_tr_b16 v[156:157], v17 offset:41056
  ds_read_b64_tr_b16 v[158:159], v17 offset:42336
  v_mfma_f32_16x16x32_bf16 v[76:79], v[196:199], a[72:75], v[76:79]
  ds_read_b64_tr_b16 v[160:161], v16 offset:41088
  v_mfma_f32_16x16x32_bf16 v[116:119], v[196:199], a[76:79], v[116:119]
  ds_read_b64_tr_b16 v[162:163], v16 offset:42368
  v_mfma_f32_16x16x32_bf16 v[80:83], v[200:203], a[72:75], v[80:83]
  ds_read_b64_tr_b16 v[164:165], v17 offset:41120
  v_mfma_f32_16x16x32_bf16 v[120:123], v[200:203], a[76:79], v[120:123]
  ds_read_b64_tr_b16 v[166:167], v17 offset:42400
  v_mfma_f32_16x16x32_bf16 v[84:87], v[204:207], a[72:75], v[84:87]
  ds_read_b64_tr_b16 v[168:169], v16 offset:41152
  v_mfma_f32_16x16x32_bf16 v[124:127], v[204:207], a[76:79], v[124:127]
  ds_read_b64_tr_b16 v[170:171], v16 offset:42432
  ds_read_b64_tr_b16 v[172:173], v17 offset:41184
  v_mfma_f32_16x16x32_bf16 v[88:91], v[208:211], a[72:75], v[88:91]
  ds_read_b64_tr_b16 v[174:175], v17 offset:42464
  v_mfma_f32_16x16x32_bf16 v[128:131], v[208:211], a[76:79], v[128:131]
  buffer_load_dwordx4 a[152:155], v6, s[16:19], s48 offen offset:0 sc1
  ds_read_b64_tr_b16 v[176:177], v16 offset:41216
  v_mfma_f32_16x16x32_bf16 v[92:95], v[212:215], a[72:75], v[92:95]
  ds_read_b64_tr_b16 v[178:179], v16 offset:42496
  v_mfma_f32_16x16x32_bf16 v[132:135], v[212:215], a[76:79], v[132:135]
  ds_read_b64_tr_b16 v[180:181], v17 offset:41248
  v_mfma_f32_16x16x32_bf16 v[96:99], v[216:219], a[72:75], v[96:99]
  ds_read_b64_tr_b16 v[182:183], v17 offset:42528
  v_mfma_f32_16x16x32_bf16 v[136:139], v[216:219], a[76:79], v[136:139]
  buffer_load_dwordx4 a[156:159], v6, s[16:19], s48 offen offset:128 sc1
  v_mfma_f32_16x16x32_bf16 v[100:103], v[220:223], a[72:75], v[100:103]
  s_add_u32 s48, s48, 132096
  v_mfma_f32_16x16x32_bf16 v[140:143], v[220:223], a[76:79], v[140:143]
  s_waitcnt lgkmcnt(0) vmcnt(33)
  v_mfma_f32_16x16x32_bf16 v[64:67], v[144:147], a[80:83], v[64:67]
  ds_read_b64_tr_b16 v[184:185], v16 offset:51200
  ds_read_b64_tr_b16 v[186:187], v16 offset:52480
  v_mfma_f32_16x16x32_bf16 v[104:107], v[144:147], a[84:87], v[104:107]
  ds_read_b64_tr_b16 v[188:189], v17 offset:51232
  v_mfma_f32_16x16x32_bf16 v[68:71], v[148:151], a[80:83], v[68:71]
  ds_read_b64_tr_b16 v[190:191], v17 offset:52512
  v_mfma_f32_16x16x32_bf16 v[108:111], v[148:151], a[84:87], v[108:111]
  ds_read_b64_tr_b16 v[192:193], v16 offset:51264
  v_mfma_f32_16x16x32_bf16 v[72:75], v[152:155], a[80:83], v[72:75]
  ds_read_b64_tr_b16 v[194:195], v16 offset:52544
  v_mfma_f32_16x16x32_bf16 v[112:115], v[152:155], a[84:87], v[112:115]
  ds_read_b64_tr_b16 v[196:197], v17 offset:51296
  ds_read_b64_tr_b16 v[198:199], v17 offset:52576
  v_mfma_f32_16x16x32_bf16 v[76:79], v[156:159], a[80:83], v[76:79]
  ds_read_b64_tr_b16 v[200:201], v16 offset:51328
  v_mfma_f32_16x16x32_bf16 v[116:119], v[156:159], a[84:87], v[116:119]
  ds_read_b64_tr_b16 v[202:203], v16 offset:52608
  v_mfma_f32_16x16x32_bf16 v[80:83], v[160:163], a[80:83], v[80:83]
  ds_read_b64_tr_b16 v[204:205], v17 offset:51360
  v_mfma_f32_16x16x32_bf16 v[120:123], v[160:163], a[84:87], v[120:123]
  ds_read_b64_tr_b16 v[206:207], v17 offset:52640
  v_mfma_f32_16x16x32_bf16 v[84:87], v[164:167], a[80:83], v[84:87]
  ds_read_b64_tr_b16 v[208:209], v16 offset:51392
  v_mfma_f32_16x16x32_bf16 v[124:127], v[164:167], a[84:87], v[124:127]
  ds_read_b64_tr_b16 v[210:211], v16 offset:52672
  ds_read_b64_tr_b16 v[212:213], v17 offset:51424
  v_mfma_f32_16x16x32_bf16 v[88:91], v[168:171], a[80:83], v[88:91]
  ds_read_b64_tr_b16 v[214:215], v17 offset:52704
  v_mfma_f32_16x16x32_bf16 v[128:131], v[168:171], a[84:87], v[128:131]
  buffer_load_dwordx4 v[52:55], v4, s[12:15], 0 offen
  ds_read_b64_tr_b16 v[216:217], v16 offset:51456
  v_mfma_f32_16x16x32_bf16 v[92:95], v[172:175], a[80:83], v[92:95]
  ds_read_b64_tr_b16 v[218:219], v16 offset:52736
  v_mfma_f32_16x16x32_bf16 v[132:135], v[172:175], a[84:87], v[132:135]
  ds_read_b64_tr_b16 v[220:221], v17 offset:51488
  v_mfma_f32_16x16x32_bf16 v[96:99], v[176:179], a[80:83], v[96:99]
  ds_read_b64_tr_b16 v[222:223], v17 offset:52768
  v_mfma_f32_16x16x32_bf16 v[136:139], v[176:179], a[84:87], v[136:139]
  buffer_load_dword v56, v5, s[12:15], 0 offen offset:1024
  v_mfma_f32_16x16x32_bf16 v[100:103], v[180:183], a[80:83], v[100:103]
  s_mul_i32 s50, s59, 1280
  v_mfma_f32_16x16x32_bf16 v[140:143], v[180:183], a[84:87], v[140:143]
  s_waitcnt lgkmcnt(0) vmcnt(28)
  s_barrier
  v_mfma_f32_16x16x32_bf16 v[64:67], v[184:187], a[88:91], v[64:67]
  ds_read_b64_tr_b16 v[144:145], v18 offset:0
  ds_read_b64_tr_b16 v[146:147], v18 offset:1280
  v_mfma_f32_16x16x32_bf16 v[104:107], v[184:187], a[92:95], v[104:107]
  ds_read_b64_tr_b16 v[148:149], v19 offset:32
  v_mfma_f32_16x16x32_bf16 v[68:71], v[188:191], a[88:91], v[68:71]
  ds_read_b64_tr_b16 v[150:151], v19 offset:1312
  v_mfma_f32_16x16x32_bf16 v[108:111], v[188:191], a[92:95], v[108:111]
  ds_read_b64_tr_b16 v[152:153], v18 offset:64
  v_mfma_f32_16x16x32_bf16 v[72:75], v[192:195], a[88:91], v[72:75]
  ds_read_b64_tr_b16 v[154:155], v18 offset:1344
  v_mfma_f32_16x16x32_bf16 v[112:115], v[192:195], a[92:95], v[112:115]
  ds_read_b64_tr_b16 v[156:157], v19 offset:96
  ds_read_b64_tr_b16 v[158:159], v19 offset:1376
  v_mfma_f32_16x16x32_bf16 v[76:79], v[196:199], a[88:91], v[76:79]
  ds_read_b64_tr_b16 v[160:161], v18 offset:128
  v_mfma_f32_16x16x32_bf16 v[116:119], v[196:199], a[92:95], v[116:119]
  ds_read_b64_tr_b16 v[162:163], v18 offset:1408
  v_mfma_f32_16x16x32_bf16 v[80:83], v[200:203], a[88:91], v[80:83]
  ds_read_b64_tr_b16 v[164:165], v19 offset:160
  v_mfma_f32_16x16x32_bf16 v[120:123], v[200:203], a[92:95], v[120:123]
  ds_read_b64_tr_b16 v[166:167], v19 offset:1440
  v_mfma_f32_16x16x32_bf16 v[84:87], v[204:207], a[88:91], v[84:87]
  ds_read_b64_tr_b16 v[168:169], v18 offset:192
  v_mfma_f32_16x16x32_bf16 v[124:127], v[204:207], a[92:95], v[124:127]
  ds_read_b64_tr_b16 v[170:171], v18 offset:1472
  ds_read_b64_tr_b16 v[172:173], v19 offset:224
  v_mfma_f32_16x16x32_bf16 v[88:91], v[208:211], a[88:91], v[88:91]
  ds_read_b64_tr_b16 v[174:175], v19 offset:1504
  v_mfma_f32_16x16x32_bf16 v[128:131], v[208:211], a[92:95], v[128:131]
  buffer_load_dwordx4 v[224:227], v4, s[8:11], s50 offen
  ds_read_b64_tr_b16 v[176:177], v18 offset:256
  v_mfma_f32_16x16x32_bf16 v[92:95], v[212:215], a[88:91], v[92:95]
  ds_read_b64_tr_b16 v[178:179], v18 offset:1536
  v_mfma_f32_16x16x32_bf16 v[132:135], v[212:215], a[92:95], v[132:135]
  ds_read_b64_tr_b16 v[180:181], v19 offset:288
  v_mfma_f32_16x16x32_bf16 v[96:99], v[216:219], a[88:91], v[96:99]
  ds_read_b64_tr_b16 v[182:183], v19 offset:1568
  v_mfma_f32_16x16x32_bf16 v[136:139], v[216:219], a[92:95], v[136:139]
  buffer_load_dword v228, v5, s[8:11], s50 offen offset:1024
  v_mfma_f32_16x16x32_bf16 v[100:103], v[220:223], a[88:91], v[100:103]
  s_add_u32 s50, s50, 1280
  v_mfma_f32_16x16x32_bf16 v[140:143], v[220:223], a[92:95], v[140:143]
  s_waitcnt lgkmcnt(0) vmcnt(28)
  v_mfma_f32_16x16x32_bf16 v[64:67], v[144:147], a[96:99], v[64:67]
  ds_read_b64_tr_b16 v[184:185], v18 offset:10240
  ds_read_b64_tr_b16 v[186:187], v18 offset:11520
  v_mfma_f32_16x16x32_bf16 v[104:107], v[144:147], a[100:103], v[104:107]
  ds_read_b64_tr_b16 v[188:189], v19 offset:10272
  v_mfma_f32_16x16x32_bf16 v[68:71], v[148:151], a[96:99], v[68:71]
  ds_read_b64_tr_b16 v[190:191], v19 offset:11552
  v_mfma_f32_16x16x32_bf16 v[108:111], v[148:151], a[100:103], v[108:111]
  ds_read_b64_tr_b16 v[192:193], v18 offset:10304
  v_mfma_f32_16x16x32_bf16 v[72:75], v[152:155], a[96:99], v[72:75]
  ds_read_b64_tr_b16 v[194:195], v18 offset:11584
  v_mfma_f32_16x16x32_bf16 v[112:115], v[152:155], a[100:103], v[112:115]
  ds_read_b64_tr_b16 v[196:197], v19 offset:10336
  ds_read_b64_tr_b16 v[198:199], v19 offset:11616
  v_mfma_f32_16x16x32_bf16 v[76:79], v[156:159], a[96:99], v[76:79]
  ds_read_b64_tr_b16 v[200:201], v18 offset:10368
  v_mfma_f32_16x16x32_bf16 v[116:119], v[156:159], a[100:103], v[116:119]
  ds_read_b64_tr_b16 v[202:203], v18 offset:11648
  v_mfma_f32_16x16x32_bf16 v[80:83], v[160:163], a[96:99], v[80:83]
  ds_read_b64_tr_b16 v[204:205], v19 offset:10400
  v_mfma_f32_16x16x32_bf16 v[120:123], v[160:163], a[100:103], v[120:123]
  ds_read_b64_tr_b16 v[206:207], v19 offset:11680
  v_mfma_f32_16x16x32_bf16 v[84:87], v[164:167], a[96:99], v[84:87]
  ds_read_b64_tr_b16 v[208:209], v18 offset:10432
  v_mfma_f32_16x16x32_bf16 v[124:127], v[164:167], a[100:103], v[124:127]
  ds_read_b64_tr_b16 v[210:211], v18 offset:11712
  ds_read_b64_tr_b16 v[212:213], v19 offset:10464
  v_mfma_f32_16x16x32_bf16 v[88:91], v[168:171], a[96:99], v[88:91]
  ds_read_b64_tr_b16 v[214:215], v19 offset:11744
  v_mfma_f32_16x16x32_bf16 v[128:131], v[168:171], a[100:103], v[128:131]
  buffer_load_dwordx4 v[230:233], v4, s[8:11], s50 offen
  ds_read_b64_tr_b16 v[216:217], v18 offset:10496
  v_mfma_f32_16x16x32_bf16 v[92:95], v[172:175], a[96:99], v[92:95]
  ds_read_b64_tr_b16 v[218:219], v18 offset:11776
  v_mfma_f32_16x16x32_bf16 v[132:135], v[172:175], a[100:103], v[132:135]
  ds_read_b64_tr_b16 v[220:221], v19 offset:10528
  v_mfma_f32_16x16x32_bf16 v[96:99], v[176:179], a[96:99], v[96:99]
  ds_read_b64_tr_b16 v[222:223], v19 offset:11808
  v_mfma_f32_16x16x32_bf16 v[136:139], v[176:179], a[100:103], v[136:139]
  buffer_load_dword v234, v5, s[8:11], s50 offen offset:1024
  v_mfma_f32_16x16x32_bf16 v[100:103], v[180:183], a[96:99], v[100:103]
  s_add_u32 s50, s50, 1280
  v_mfma_f32_16x16x32_bf16 v[140:143], v[180:183], a[100:103], v[140:143]
  s_waitcnt lgkmcnt(0) vmcnt(23)
  s_barrier
  v_mfma_f32_16x16x32_bf16 v[64:67], v[184:187], a[104:107], v[64:67]
  ds_read_b64_tr_b16 v[144:145], v14 offset:0
  ds_read_b64_tr_b16 v[146:147], v14 offset:1280
  v_mfma_f32_16x16x32_bf16 v[104:107], v[184:187], a[108:111], v[104:107]
  ds_read_b64_tr_b16 v[148:149], v15 offset:32
  v_mfma_f32_16x16x32_bf16 v[68:71], v[188:191], a[104:107], v[68:71]
  ds_read_b64_tr_b16 v[150:151], v15 offset:1312
  v_mfma_f32_16x16x32_bf16 v[108:111], v[188:191], a[108:111], v[108:111]
  ds_read_b64_tr_b16 v[152:153], v14 offset:64
  v_mfma_f32_16x16x32_bf16 v[72:75], v[192:195], a[104:107], v[72:75]
  ds_read_b64_tr_b16 v[154:155], v14 offset:1344
  v_mfma_f32_16x16x32_bf16 v[112:115], v[192:195], a[108:111], v[112:115]
  ds_read_b64_tr_b16 v[156:157], v15 offset:96
  ds_read_b64_tr_b16 v[158:159], v15 offset:1376
  v_mfma_f32_16x16x32_bf16 v[76:79], v[196:199], a[104:107], v[76:79]
  ds_read_b64_tr_b16 v[160:161], v14 offset:128
  v_mfma_f32_16x16x32_bf16 v[116:119], v[196:199], a[108:111], v[116:119]
  ds_read_b64_tr_b16 v[162:163], v14 offset:1408
  v_mfma_f32_16x16x32_bf16 v[80:83], v[200:203], a[104:107], v[80:83]
  ds_read_b64_tr_b16 v[164:165], v15 offset:160
  v_mfma_f32_16x16x32_bf16 v[120:123], v[200:203], a[108:111], v[120:123]
  ds_read_b64_tr_b16 v[166:167], v15 offset:1440
  v_mfma_f32_16x16x32_bf16 v[84:87], v[204:207], a[104:107], v[84:87]
  ds_read_b64_tr_b16 v[168:169], v14 offset:192
  v_mfma_f32_16x16x32_bf16 v[124:127], v[204:207], a[108:111], v[124:127]
  ds_read_b64_tr_b16 v[170:171], v14 offset:1472
  ds_read_b64_tr_b16 v[172:173], v15 offset:224
  v_mfma_f32_16x16x32_bf16 v[88:91], v[208:211], a[104:107], v[88:91]
  ds_read_b64_tr_b16 v[174:175], v15 offset:1504
  v_mfma_f32_16x16x32_bf16 v[128:131], v[208:211], a[108:111], v[128:131]
  buffer_load_dwordx4 v[236:239], v4, s[8:11], s50 offen
  ds_read_b64_tr_b16 v[176:177], v14 offset:256
  v_mfma_f32_16x16x32_bf16 v[92:95], v[212:215], a[104:107], v[92:95]
  ds_read_b64_tr_b16 v[178:179], v14 offset:1536
  v_mfma_f32_16x16x32_bf16 v[132:135], v[212:215], a[108:111], v[132:135]
  ds_read_b64_tr_b16 v[180:181], v15 offset:288
  v_mfma_f32_16x16x32_bf16 v[96:99], v[216:219], a[104:107], v[96:99]
  ds_read_b64_tr_b16 v[182:183], v15 offset:1568
  v_mfma_f32_16x16x32_bf16 v[136:139], v[216:219], a[108:111], v[136:139]
  buffer_load_dword v240, v5, s[8:11], s50 offen offset:1024
  v_mfma_f32_16x16x32_bf16 v[100:103], v[220:223], a[104:107], v[100:103]
  s_add_u32 s50, s50, 1280
  v_mfma_f32_16x16x32_bf16 v[140:143], v[220:223], a[108:111], v[140:143]
  s_waitcnt lgkmcnt(0) vmcnt(23)
  v_mfma_f32_16x16x32_bf16 v[64:67], v[144:147], a[112:115], v[64:67]
  ds_read_b64_tr_b16 v[184:185], v14 offset:10240
  ds_read_b64_tr_b16 v[186:187], v14 offset:11520
  v_mfma_f32_16x16x32_bf16 v[104:107], v[144:147], a[116:119], v[104:107]
  ds_read_b64_tr_b16 v[188:189], v15 offset:10272
  v_mfma_f32_16x16x32_bf16 v[68:71], v[148:151], a[112:115], v[68:71]
  ds_read_b64_tr_b16 v[190:191], v15 offset:11552
  v_mfma_f32_16x16x32_bf16 v[108:111], v[148:151], a[116:119], v[108:111]
  ds_read_b64_tr_b16 v[192:193], v14 offset:10304
  v_mfma_f32_16x16x32_bf16 v[72:75], v[152:155], a[112:115], v[72:75]
  ds_read_b64_tr_b16 v[194:195], v14 offset:11584
  v_mfma_f32_16x16x32_bf16 v[112:115], v[152:155], a[116:119], v[112:115]
  ds_read_b64_tr_b16 v[196:197], v15 offset:10336
  ds_read_b64_tr_b16 v[198:199], v15 offset:11616
  v_mfma_f32_16x16x32_bf16 v[76:79], v[156:159], a[112:115], v[76:79]
  ds_read_b64_tr_b16 v[200:201], v14 offset:10368
  v_mfma_f32_16x16x32_bf16 v[116:119], v[156:159], a[116:119], v[116:119]
  ds_read_b64_tr_b16 v[202:203], v14 offset:11648
  v_mfma_f32_16x16x32_bf16 v[80:83], v[160:163], a[112:115], v[80:83]
  ds_read_b64_tr_b16 v[204:205], v15 offset:10400
  v_mfma_f32_16x16x32_bf16 v[120:123], v[160:163], a[116:119], v[120:123]
  ds_read_b64_tr_b16 v[206:207], v15 offset:11680
  v_mfma_f32_16x16x32_bf16 v[84:87], v[164:167], a[112:115], v[84:87]
  ds_read_b64_tr_b16 v[208:209], v14 offset:10432
  v_mfma_f32_16x16x32_bf16 v[124:127], v[164:167], a[116:119], v[124:127]
  ds_read_b64_tr_b16 v[210:211], v14 offset:11712
  ds_read_b64_tr_b16 v[212:213], v15 offset:10464
  v_mfma_f32_16x16x32_bf16 v[88:91], v[168:171], a[112:115], v[88:91]
  ds_read_b64_tr_b16 v[214:215], v15 offset:11744
  v_mfma_f32_16x16x32_bf16 v[128:131], v[168:171], a[116:119], v[128:131]
  buffer_load_dwordx4 v[242:245], v4, s[8:11], s50 offen
  ds_read_b64_tr_b16 v[216:217], v14 offset:10496
  v_mfma_f32_16x16x32_bf16 v[92:95], v[172:175], a[112:115], v[92:95]
  ds_read_b64_tr_b16 v[218:219], v14 offset:11776
  v_mfma_f32_16x16x32_bf16 v[132:135], v[172:175], a[116:119], v[132:135]
  ds_read_b64_tr_b16 v[220:221], v15 offset:10528
  v_mfma_f32_16x16x32_bf16 v[96:99], v[176:179], a[112:115], v[96:99]
  ds_read_b64_tr_b16 v[222:223], v15 offset:11808
  v_mfma_f32_16x16x32_bf16 v[136:139], v[176:179], a[116:119], v[136:139]
  buffer_load_dword v246, v5, s[8:11], s50 offen offset:1024
  v_mfma_f32_16x16x32_bf16 v[100:103], v[180:183], a[112:115], v[100:103]
  s_add_u32 s50, s50, 1280
  v_mfma_f32_16x16x32_bf16 v[140:143], v[180:183], a[116:119], v[140:143]
  s_waitcnt lgkmcnt(0) vmcnt(18)
  s_barrier
  v_mfma_f32_16x16x32_bf16 v[64:67], v[184:187], a[120:123], v[64:67]
  ds_read_b64_tr_b16 v[144:145], v14 offset:20480
  ds_read_b64_tr_b16 v[146:147], v14 offset:21760
  v_mfma_f32_16x16x32_bf16 v[104:107], v[184:187], a[124:127], v[104:107]
  ds_read_b64_tr_b16 v[148:149], v15 offset:20512
  v_mfma_f32_16x16x32_bf16 v[68:71], v[188:191], a[120:123], v[68:71]
  ds_read_b64_tr_b16 v[150:151], v15 offset:21792
  v_mfma_f32_16x16x32_bf16 v[108:111], v[188:191], a[124:127], v[108:111]
  ds_read_b64_tr_b16 v[152:153], v14 offset:20544
  v_mfma_f32_16x16x32_bf16 v[72:75], v[192:195], a[120:123], v[72:75]
  ds_read_b64_tr_b16 v[154:155], v14 offset:21824
  v_mfma_f32_16x16x32_bf16 v[112:115], v[192:195], a[124:127], v[112:115]
  ds_read_b64_tr_b16 v[156:157], v15 offset:20576
  ds_read_b64_tr_b16 v[158:159], v15 offset:21856
  v_mfma_f32_16x16x32_bf16 v[76:79], v[196:199], a[120:123], v[76:79]
  ds_read_b64_tr_b16 v[160:161], v14 offset:20608
  v_mfma_f32_16x16x32_bf16 v[116:119], v[196:199], a[124:127], v[116:119]
  ds_read_b64_tr_b16 v[162:163], v14 offset:21888
  v_mfma_f32_16x16x32_bf16 v[80:83], v[200:203], a[120:123], v[80:83]
  ds_read_b64_tr_b16 v[164:165], v15 offset:20640
  v_mfma_f32_16x16x32_bf16 v[120:123], v[200:203], a[124:127], v[120:123]
  ds_read_b64_tr_b16 v[166:167], v15 offset:21920
  v_mfma_f32_16x16x32_bf16 v[84:87], v[204:207], a[120:123], v[84:87]
  ds_read_b64_tr_b16 v[168:169], v14 offset:20672
  v_mfma_f32_16x16x32_bf16 v[124:127], v[204:207], a[124:127], v[124:127]
  ds_read_b64_tr_b16 v[170:171], v14 offset:21952
  ds_read_b64_tr_b16 v[172:173], v15 offset:20704
  v_mfma_f32_16x16x32_bf16 v[88:91], v[208:211], a[120:123], v[88:91]
  ds_read_b64_tr_b16 v[174:175], v15 offset:21984
  v_mfma_f32_16x16x32_bf16 v[128:131], v[208:211], a[124:127], v[128:131]
  buffer_load_dwordx4 v[248:251], v4, s[8:11], s50 offen
  ds_read_b64_tr_b16 v[176:177], v14 offset:20736
  v_mfma_f32_16x16x32_bf16 v[92:95], v[212:215], a[120:123], v[92:95]
  ds_read_b64_tr_b16 v[178:179], v14 offset:22016
  v_mfma_f32_16x16x32_bf16 v[132:135], v[212:215], a[124:127], v[132:135]
  ds_read_b64_tr_b16 v[180:181], v15 offset:20768
  v_mfma_f32_16x16x32_bf16 v[96:99], v[216:219], a[120:123], v[96:99]
  ds_read_b64_tr_b16 v[182:183], v15 offset:22048
  v_mfma_f32_16x16x32_bf16 v[136:139], v[216:219], a[124:127], v[136:139]
  buffer_load_dword v252, v5, s[8:11], s50 offen offset:1024
  v_mfma_f32_16x16x32_bf16 v[100:103], v[220:223], a[120:123], v[100:103]
  s_add_u32 s50, s50, 1280
  v_mfma_f32_16x16x32_bf16 v[140:143], v[220:223], a[124:127], v[140:143]
  s_waitcnt lgkmcnt(0) vmcnt(18)
  v_mfma_f32_16x16x32_bf16 v[64:67], v[144:147], a[128:131], v[64:67]
  ds_read_b64_tr_b16 v[184:185], v14 offset:30720
  ds_read_b64_tr_b16 v[186:187], v14 offset:32000
  v_mfma_f32_16x16x32_bf16 v[104:107], v[144:147], a[132:135], v[104:107]
  ds_read_b64_tr_b16 v[188:189], v15 offset:30752
  v_mfma_f32_16x16x32_bf16 v[68:71], v[148:151], a[128:131], v[68:71]
  ds_read_b64_tr_b16 v[190:191], v15 offset:32032
  v_mfma_f32_16x16x32_bf16 v[108:111], v[148:151], a[132:135], v[108:111]
  ds_read_b64_tr_b16 v[192:193], v14 offset:30784
  v_mfma_f32_16x16x32_bf16 v[72:75], v[152:155], a[128:131], v[72:75]
  ds_read_b64_tr_b16 v[194:195], v14 offset:32064
  v_mfma_f32_16x16x32_bf16 v[112:115], v[152:155], a[132:135], v[112:115]
  ds_read_b64_tr_b16 v[196:197], v15 offset:30816
  ds_read_b64_tr_b16 v[198:199], v15 offset:32096
  v_mfma_f32_16x16x32_bf16 v[76:79], v[156:159], a[128:131], v[76:79]
  ds_read_b64_tr_b16 v[200:201], v14 offset:30848
  v_mfma_f32_16x16x32_bf16 v[116:119], v[156:159], a[132:135], v[116:119]
  ds_read_b64_tr_b16 v[202:203], v14 offset:32128
  v_mfma_f32_16x16x32_bf16 v[80:83], v[160:163], a[128:131], v[80:83]
  ds_read_b64_tr_b16 v[204:205], v15 offset:30880
  v_mfma_f32_16x16x32_bf16 v[120:123], v[160:163], a[132:135], v[120:123]
  ds_read_b64_tr_b16 v[206:207], v15 offset:32160
  v_mfma_f32_16x16x32_bf16 v[84:87], v[164:167], a[128:131], v[84:87]
  ds_read_b64_tr_b16 v[208:209], v14 offset:30912
  v_mfma_f32_16x16x32_bf16 v[124:127], v[164:167], a[132:135], v[124:127]
  ds_read_b64_tr_b16 v[210:211], v14 offset:32192
  ds_read_b64_tr_b16 v[212:213], v15 offset:30944
  v_mfma_f32_16x16x32_bf16 v[88:91], v[168:171], a[128:131], v[88:91]
  ds_read_b64_tr_b16 v[214:215], v15 offset:32224
  v_mfma_f32_16x16x32_bf16 v[128:131], v[168:171], a[132:135], v[128:131]
  buffer_load_dwordx4 v[30:33], v4, s[8:11], s50 offen
  ds_read_b64_tr_b16 v[216:217], v14 offset:30976
  v_mfma_f32_16x16x32_bf16 v[92:95], v[172:175], a[128:131], v[92:95]
  ds_read_b64_tr_b16 v[218:219], v14 offset:32256
  v_mfma_f32_16x16x32_bf16 v[132:135], v[172:175], a[132:135], v[132:135]
  ds_read_b64_tr_b16 v[220:221], v15 offset:31008
  v_mfma_f32_16x16x32_bf16 v[96:99], v[176:179], a[128:131], v[96:99]
  ds_read_b64_tr_b16 v[222:223], v15 offset:32288
  v_mfma_f32_16x16x32_bf16 v[136:139], v[176:179], a[132:135], v[136:139]
  buffer_load_dword v34, v5, s[8:11], s50 offen offset:1024
  v_mfma_f32_16x16x32_bf16 v[100:103], v[180:183], a[128:131], v[100:103]
  s_add_u32 s50, s50, 1280
  v_mfma_f32_16x16x32_bf16 v[140:143], v[180:183], a[132:135], v[140:143]
  s_waitcnt lgkmcnt(0) vmcnt(18)
  s_barrier
  v_mfma_f32_16x16x32_bf16 v[64:67], v[184:187], a[136:139], v[64:67]
  ds_read_b64_tr_b16 v[144:145], v14 offset:40960
  ds_read_b64_tr_b16 v[146:147], v14 offset:42240
  v_mfma_f32_16x16x32_bf16 v[104:107], v[184:187], a[140:143], v[104:107]
  ds_read_b64_tr_b16 v[148:149], v15 offset:40992
  v_mfma_f32_16x16x32_bf16 v[68:71], v[188:191], a[136:139], v[68:71]
  ds_read_b64_tr_b16 v[150:151], v15 offset:42272
  v_mfma_f32_16x16x32_bf16 v[108:111], v[188:191], a[140:143], v[108:111]
  ds_read_b64_tr_b16 v[152:153], v14 offset:41024
  v_mfma_f32_16x16x32_bf16 v[72:75], v[192:195], a[136:139], v[72:75]
  ds_read_b64_tr_b16 v[154:155], v14 offset:42304
  v_mfma_f32_16x16x32_bf16 v[112:115], v[192:195], a[140:143], v[112:115]
  ds_read_b64_tr_b16 v[156:157], v15 offset:41056
  ds_read_b64_tr_b16 v[158:159], v15 offset:42336
  v_mfma_f32_16x16x32_bf16 v[76:79], v[196:199], a[136:139], v[76:79]
  ds_read_b64_tr_b16 v[160:161], v14 offset:41088
  v_mfma_f32_16x16x32_bf16 v[116:119], v[196:199], a[140:143], v[116:119]
  ds_read_b64_tr_b16 v[162:163], v14 offset:42368
  v_mfma_f32_16x16x32_bf16 v[80:83], v[200:203], a[136:139], v[80:83]
  ds_read_b64_tr_b16 v[164:165], v15 offset:41120
  v_mfma_f32_16x16x32_bf16 v[120:123], v[200:203], a[140:143], v[120:123]
  ds_read_b64_tr_b16 v[166:167], v15 offset:42400
  v_mfma_f32_16x16x32_bf16 v[84:87], v[204:207], a[136:139], v[84:87]
  ds_read_b64_tr_b16 v[168:169], v14 offset:41152
  v_mfma_f32_16x16x32_bf16 v[124:127], v[204:207], a[140:143], v[124:127]
  ds_read_b64_tr_b16 v[170:171], v14 offset:42432
  ds_read_b64_tr_b16 v[172:173], v15 offset:41184
  v_mfma_f32_16x16x32_bf16 v[88:91], v[208:211], a[136:139], v[88:91]
  ds_read_b64_tr_b16 v[174:175], v15 offset:42464
  v_mfma_f32_16x16x32_bf16 v[128:131], v[208:211], a[140:143], v[128:131]
  buffer_load_dwordx4 v[36:39], v4, s[8:11], s50 offen
  ds_read_b64_tr_b16 v[176:177], v14 offset:41216
  v_mfma_f32_16x16x32_bf16 v[92:95], v[212:215], a[136:139], v[92:95]
  ds_read_b64_tr_b16 v[178:179], v14 offset:42496
  v_mfma_f32_16x16x32_bf16 v[132:135], v[212:215], a[140:143], v[132:135]
  ds_read_b64_tr_b16 v[180:181], v15 offset:41248
  v_mfma_f32_16x16x32_bf16 v[96:99], v[216:219], a[136:139], v[96:99]
  ds_read_b64_tr_b16 v[182:183], v15 offset:42528
  v_mfma_f32_16x16x32_bf16 v[136:139], v[216:219], a[140:143], v[136:139]
  buffer_load_dword v40, v5, s[8:11], s50 offen offset:1024
  v_mfma_f32_16x16x32_bf16 v[100:103], v[220:223], a[136:139], v[100:103]
  s_add_u32 s50, s50, 1280
  v_mfma_f32_16x16x32_bf16 v[140:143], v[220:223], a[140:143], v[140:143]
  s_waitcnt lgkmcnt(0) vmcnt(18)
  v_mfma_f32_16x16x32_bf16 v[64:67], v[144:147], a[144:147], v[64:67]
  ds_read_b64_tr_b16 v[184:185], v14 offset:51200
  ds_read_b64_tr_b16 v[186:187], v14 offset:52480
  v_mfma_f32_16x16x32_bf16 v[104:107], v[144:147], a[148:151], v[104:107]
  ds_read_b64_tr_b16 v[188:189], v15 offset:51232
  v_mfma_f32_16x16x32_bf16 v[68:71], v[148:151], a[144:147], v[68:71]
  ds_read_b64_tr_b16 v[190:191], v15 offset:52512
  v_mfma_f32_16x16x32_bf16 v[108:111], v[148:151], a[148:151], v[108:111]
  ds_read_b64_tr_b16 v[192:193], v14 offset:51264
  v_mfma_f32_16x16x32_bf16 v[72:75], v[152:155], a[144:147], v[72:75]
  ds_read_b64_tr_b16 v[194:195], v14 offset:52544
  v_mfma_f32_16x16x32_bf16 v[112:115], v[152:155], a[148:151], v[112:115]
  ds_read_b64_tr_b16 v[196:197], v15 offset:51296
  ds_read_b64_tr_b16 v[198:199], v15 offset:52576
  v_mfma_f32_16x16x32_bf16 v[76:79], v[156:159], a[144:147], v[76:79]
  ds_read_b64_tr_b16 v[200:201], v14 offset:51328
  v_mfma_f32_16x16x32_bf16 v[116:119], v[156:159], a[148:151], v[116:119]
  ds_read_b64_tr_b16 v[202:203], v14 offset:52608
  v_mfma_f32_16x16x32_bf16 v[80:83], v[160:163], a[144:147], v[80:83]
  ds_read_b64_tr_b16 v[204:205], v15 offset:51360
  v_mfma_f32_16x16x32_bf16 v[120:123], v[160:163], a[148:151], v[120:123]
  ds_read_b64_tr_b16 v[206:207], v15 offset:52640
  v_mfma_f32_16x16x32_bf16 v[84:87], v[164:167], a[144:147], v[84:87]
  ds_read_b64_tr_b16 v[208:209], v14 offset:51392
  v_mfma_f32_16x16x32_bf16 v[124:127], v[164:167], a[148:151], v[124:127]
  ds_read_b64_tr_b16 v[210:211], v14 offset:52672
  ds_read_b64_tr_b16 v[212:213], v15 offset:51424
  v_mfma_f32_16x16x32_bf16 v[88:91], v[168:171], a[144:147], v[88:91]
  ds_read_b64_tr_b16 v[214:215], v15 offset:52704
  v_mfma_f32_16x16x32_bf16 v[128:131], v[168:171], a[148:151], v[128:131]
  buffer_load_dwordx4 v[42:45], v4, s[8:11], s50 offen
  ds_read_b64_tr_b16 v[216:217], v14 offset:51456
  v_mfma_f32_16x16x32_bf16 v[92:95], v[172:175], a[144:147], v[92:95]
  ds_read_b64_tr_b16 v[218:219], v14 offset:52736
  v_mfma_f32_16x16x32_bf16 v[132:135], v[172:175], a[148:151], v[132:135]
  ds_read_b64_tr_b16 v[220:221], v15 offset:51488
  v_mfma_f32_16x16x32_bf16 v[96:99], v[176:179], a[144:147], v[96:99]
  ds_read_b64_tr_b16 v[222:223], v15 offset:52768
  v_mfma_f32_16x16x32_bf16 v[136:139], v[176:179], a[148:151], v[136:139]
  buffer_load_dword v46, v5, s[8:11], s50 offen offset:1024
  v_mfma_f32_16x16x32_bf16 v[100:103], v[180:183], a[144:147], v[100:103]
  s_add_u32 s50, s50, 1280
  v_mfma_f32_16x16x32_bf16 v[140:143], v[180:183], a[148:151], v[140:143]
  s_waitcnt lgkmcnt(0) vmcnt(18)
  v_mfma_f32_16x16x32_bf16 v[64:67], v[184:187], a[152:155], v[64:67]
  v_mfma_f32_16x16x32_bf16 v[104:107], v[184:187], a[156:159], v[104:107]
  v_mfma_f32_16x16x32_bf16 v[68:71], v[188:191], a[152:155], v[68:71]
  v_mfma_f32_16x16x32_bf16 v[108:111], v[188:191], a[156:159], v[108:111]
  v_mfma_f32_16x16x32_bf16 v[72:75], v[192:195], a[152:155], v[72:75]
  v_mfma_f32_16x16x32_bf16 v[112:115], v[192:195], a[156:159], v[112:115]
  v_mfma_f32_16x16x32_bf16 v[76:79], v[196:199], a[152:155], v[76:79]
  v_mfma_f32_16x16x32_bf16 v[116:119], v[196:199], a[156:159], v[116:119]
  v_mfma_f32_16x16x32_bf16 v[80:83], v[200:203], a[152:155], v[80:83]
  v_mfma_f32_16x16x32_bf16 v[120:123], v[200:203], a[156:159], v[120:123]
  v_mfma_f32_16x16x32_bf16 v[84:87], v[204:207], a[152:155], v[84:87]
  v_mfma_f32_16x16x32_bf16 v[124:127], v[204:207], a[156:159], v[124:127]
  v_mfma_f32_16x16x32_bf16 v[88:91], v[208:211], a[152:155], v[88:91]
  v_mfma_f32_16x16x32_bf16 v[128:131], v[208:211], a[156:159], v[128:131]
  v_mfma_f32_16x16x32_bf16 v[92:95], v[212:215], a[152:155], v[92:95]
  v_mfma_f32_16x16x32_bf16 v[132:135], v[212:215], a[156:159], v[132:135]
  v_mfma_f32_16x16x32_bf16 v[96:99], v[216:219], a[152:155], v[96:99]
  v_mfma_f32_16x16x32_bf16 v[136:139], v[216:219], a[156:159], v[136:139]
  v_mfma_f32_16x16x32_bf16 v[100:103], v[220:223], a[152:155], v[100:103]
  v_mfma_f32_16x16x32_bf16 v[140:143], v[220:223], a[156:159], v[140:143]
  s_add_u32 s16, s38, 73400320
  s_addc_u32 s17, s39, 0
  s_mov_b32 s18, 5242880
  s_mov_b32 s19, 0x00020000
  s_nop 3
  s_mul_i32 s21, s47, 40
  s_mul_i32 s22, s44, 10
  s_add_u32 s21, s21, s22
  s_lshl_b32 s21, s21, 10
  s_add_u32 s22, s21, 0
  buffer_store_dwordx4 v[64:67], v4, s[16:19], s22 offen offset:0 sc1
  buffer_store_dwordx4 v[68:71], v4, s[16:19], s22 offen offset:1024 sc1
  buffer_store_dwordx4 v[72:75], v4, s[16:19], s22 offen offset:2048 sc1
  buffer_store_dwordx4 v[76:79], v4, s[16:19], s22 offen offset:3072 sc1
  s_add_u32 s22, s21, 4096
  buffer_store_dwordx4 v[80:83], v4, s[16:19], s22 offen offset:0 sc1
  buffer_store_dwordx4 v[84:87], v4, s[16:19], s22 offen offset:1024 sc1
  buffer_store_dwordx4 v[88:91], v4, s[16:19], s22 offen offset:2048 sc1
  buffer_store_dwordx4 v[92:95], v4, s[16:19], s22 offen offset:3072 sc1
  s_add_u32 s22, s21, 8192
  buffer_store_dwordx4 v[96:99], v4, s[16:19], s22 offen offset:0 sc1
  buffer_store_dwordx4 v[100:103], v4, s[16:19], s22 offen offset:1024 sc1
  s_add_u32 s22, s21, 40960
  buffer_store_dwordx4 v[104:107], v4, s[16:19], s22 offen offset:0 sc1
  buffer_store_dwordx4 v[108:111], v4, s[16:19], s22 offen offset:1024 sc1
  buffer_store_dwordx4 v[112:115], v4, s[16:19], s22 offen offset:2048 sc1
  buffer_store_dwordx4 v[116:119], v4, s[16:19], s22 offen offset:3072 sc1
  s_add_u32 s22, s21, 45056
  buffer_store_dwordx4 v[120:123], v4, s[16:19], s22 offen offset:0 sc1
  buffer_store_dwordx4 v[124:127], v4, s[16:19], s22 offen offset:1024 sc1
  buffer_store_dwordx4 v[128:131], v4, s[16:19], s22 offen offset:2048 sc1
  buffer_store_dwordx4 v[132:135], v4, s[16:19], s22 offen offset:3072 sc1
  s_add_u32 s22, s21, 49152
  buffer_store_dwordx4 v[136:139], v4, s[16:19], s22 offen offset:0 sc1
  buffer_store_dwordx4 v[140:143], v4, s[16:19], s22 offen offset:1024 sc1
  s_waitcnt vmcnt(20)
  v_lshlrev_b32 v57, 16, v52
  v_and_b32 v52, 0xffff0000, v52
  v_lshlrev_b32 v58, 16, v53
  v_and_b32 v53, 0xffff0000, v53
  v_lshlrev_b32 v59, 16, v54
  v_and_b32 v54, 0xffff0000, v54
  v_lshlrev_b32 v60, 16, v55
  v_and_b32 v55, 0xffff0000, v55
  v_lshlrev_b32 v61, 16, v56
  v_and_b32 v56, 0xffff0000, v56
  v_lshlrev_b32 v25, 16, v224
  v_and_b32 v26, 0xffff0000, v224
  v_mul_f32 v25, v25, v57
  v_mul_f32 v26, v26, v52
  v_cvt_pk_bf16_f32 v25, v25, v26
  v_lshlrev_b32 v26, 16, v25
  v_and_b32 v25, 0xffff0000, v25
  v_add_f32 v144, v25, v26
  v_lshlrev_b32 v25, 16, v225
  v_and_b32 v26, 0xffff0000, v225
  v_mul_f32 v25, v25, v58
  v_mul_f32 v26, v26, v53
  v_cvt_pk_bf16_f32 v25, v25, v26
  v_lshlrev_b32 v26, 16, v25
  v_and_b32 v25, 0xffff0000, v25
  v_add_f32 v144, v144, v26
  v_add_f32 v144, v144, v25
  v_lshlrev_b32 v25, 16, v226
  v_and_b32 v26, 0xffff0000, v226
  v_mul_f32 v25, v25, v59
  v_mul_f32 v26, v26, v54
  v_cvt_pk_bf16_f32 v25, v25, v26
  v_lshlrev_b32 v26, 16, v25
  v_and_b32 v25, 0xffff0000, v25
  v_add_f32 v144, v144, v26
  v_add_f32 v144, v144, v25
  v_lshlrev_b32 v25, 16, v227
  v_and_b32 v26, 0xffff0000, v227
  v_mul_f32 v25, v25, v60
  v_mul_f32 v26, v26, v55
  v_cvt_pk_bf16_f32 v25, v25, v26
  v_lshlrev_b32 v26, 16, v25
  v_and_b32 v25, 0xffff0000, v25
  v_add_f32 v144, v144, v26
  v_add_f32 v144, v144, v25
  v_lshlrev_b32 v25, 16, v228
  v_and_b32 v26, 0xffff0000, v228
  v_mul_f32 v25, v25, v61
  v_mul_f32 v26, v26, v56
  v_cvt_pk_bf16_f32 v25, v25, v26
  v_lshlrev_b32 v26, 16, v25
  v_and_b32 v25, 0xffff0000, v25
  v_add_f32 v144, v144, v26
  v_add_f32 v144, v144, v25
  v_lshlrev_b32 v25, 16, v230
  v_and_b32 v26, 0xffff0000, v230
  v_mul_f32 v25, v25, v57
  v_mul_f32 v26, v26, v52
  v_cvt_pk_bf16_f32 v25, v25, v26
  v_lshlrev_b32 v26, 16, v25
  v_and_b32 v25, 0xffff0000, v25
  v_add_f32 v145, v25, v26
  v_lshlrev_b32 v25, 16, v231
  v_and_b32 v26, 0xffff0000, v231
  v_mul_f32 v25, v25, v58
  v_mul_f32 v26, v26, v53
  v_cvt_pk_bf16_f32 v25, v25, v26
  v_lshlrev_b32 v26, 16, v25
  v_and_b32 v25, 0xffff0000, v25
  v_add_f32 v145, v145, v26
  v_add_f32 v145, v145, v25
  v_lshlrev_b32 v25, 16, v232
  v_and_b32 v26, 0xffff0000, v232
  v_mul_f32 v25, v25, v59
  v_mul_f32 v26, v26, v54
  v_cvt_pk_bf16_f32 v25, v25, v26
  v_lshlrev_b32 v26, 16, v25
  v_and_b32 v25, 0xffff0000, v25
  v_add_f32 v145, v145, v26
  v_add_f32 v145, v145, v25
  v_lshlrev_b32 v25, 16, v233
  v_and_b32 v26, 0xffff0000, v233
  v_mul_f32 v25, v25, v60
  v_mul_f32 v26, v26, v55
  v_cvt_pk_bf16_f32 v25, v25, v26
  v_lshlrev_b32 v26, 16, v25
  v_and_b32 v25, 0xffff0000, v25
  v_add_f32 v145, v145, v26
  v_add_f32 v145, v145, v25
  v_lshlrev_b32 v25, 16, v234
  v_and_b32 v26, 0xffff0000, v234
  v_mul_f32 v25, v25, v61
  v_mul_f32 v26, v26, v56
  v_cvt_pk_bf16_f32 v25, v25, v26
  v_lshlrev_b32 v26, 16, v25
  v_and_b32 v25, 0xffff0000, v25
  v_add_f32 v145, v145, v26
  v_add_f32 v145, v145, v25
  v_lshlrev_b32 v25, 16, v236
  v_and_b32 v26, 0xffff0000, v236
  v_mul_f32 v25, v25, v57
  v_mul_f32 v26, v26, v52
  v_cvt_pk_bf16_f32 v25, v25, v26
  v_lshlrev_b32 v26, 16, v25
  v_and_b32 v25, 0xffff0000, v25
  v_add_f32 v146, v25, v26
  v_lshlrev_b32 v25, 16, v237
  v_and_b32 v26, 0xffff0000, v237
  v_mul_f32 v25, v25, v58
  v_mul_f32 v26, v26, v53
  v_cvt_pk_bf16_f32 v25, v25, v26
  v_lshlrev_b32 v26, 16, v25
  v_and_b32 v25, 0xffff0000, v25
  v_add_f32 v146, v146, v26
  v_add_f32 v146, v146, v25
  v_lshlrev_b32 v25, 16, v238
  v_and_b32 v26, 0xffff0000, v238
  v_mul_f32 v25, v25, v59
  v_mul_f32 v26, v26, v54
  v_cvt_pk_bf16_f32 v25, v25, v26
  v_lshlrev_b32 v26, 16, v25
  v_and_b32 v25, 0xffff0000, v25
  v_add_f32 v146, v146, v26
  v_add_f32 v146, v146, v25
  v_lshlrev_b32 v25, 16, v239
  v_and_b32 v26, 0xffff0000, v239
  v_mul_f32 v25, v25, v60
  v_mul_f32 v26, v26, v55
  v_cvt_pk_bf16_f32 v25, v25, v26
  v_lshlrev_b32 v26, 16, v25
  v_and_b32 v25, 0xffff0000, v25
  v_add_f32 v146, v146, v26
  v_add_f32 v146, v146, v25
  v_lshlrev_b32 v25, 16, v240
  v_and_b32 v26, 0xffff0000, v240
  v_mul_f32 v25, v25, v61
  v_mul_f32 v26, v26, v56
  v_cvt_pk_bf16_f32 v25, v25, v26
  v_lshlrev_b32 v26, 16, v25
  v_and_b32 v25, 0xffff0000, v25
  v_add_f32 v146, v146, v26
  v_add_f32 v146, v146, v25
  v_lshlrev_b32 v25, 16, v242
  v_and_b32 v26, 0xffff0000, v242
  v_mul_f32 v25, v25, v57
  v_mul_f32 v26, v26, v52
  v_cvt_pk_bf16_f32 v25, v25, v26
  v_lshlrev_b32 v26, 16, v25
  v_and_b32 v25, 0xffff0000, v25
  v_add_f32 v147, v25, v26
  v_lshlrev_b32 v25, 16, v243
  v_and_b32 v26, 0xffff0000, v243
  v_mul_f32 v25, v25, v58
  v_mul_f32 v26, v26, v53
  v_cvt_pk_bf16_f32 v25, v25, v26
  v_lshlrev_b32 v26, 16, v25
  v_and_b32 v25, 0xffff0000, v25
  v_add_f32 v147, v147, v26
  v_add_f32 v147, v147, v25
  v_lshlrev_b32 v25, 16, v244
  v_and_b32 v26, 0xffff0000, v244
  v_mul_f32 v25, v25, v59
  v_mul_f32 v26, v26, v54
  v_cvt_pk_bf16_f32 v25, v25, v26
  v_lshlrev_b32 v26, 16, v25
  v_and_b32 v25, 0xffff0000, v25
  v_add_f32 v147, v147, v26
  v_add_f32 v147, v147, v25
  v_lshlrev_b32 v25, 16, v245
  v_and_b32 v26, 0xffff0000, v245
  v_mul_f32 v25, v25, v60
  v_mul_f32 v26, v26, v55
  v_cvt_pk_bf16_f32 v25, v25, v26
  v_lshlrev_b32 v26, 16, v25
  v_and_b32 v25, 0xffff0000, v25
  v_add_f32 v147, v147, v26
  v_add_f32 v147, v147, v25
  v_lshlrev_b32 v25, 16, v246
  v_and_b32 v26, 0xffff0000, v246
  v_mul_f32 v25, v25, v61
  v_mul_f32 v26, v26, v56
  v_cvt_pk_bf16_f32 v25, v25, v26
  v_lshlrev_b32 v26, 16, v25
  v_and_b32 v25, 0xffff0000, v25
  v_add_f32 v147, v147, v26
  v_add_f32 v147, v147, v25
  v_lshlrev_b32 v25, 16, v248
  v_and_b32 v26, 0xffff0000, v248
  v_mul_f32 v25, v25, v57
  v_mul_f32 v26, v26, v52
  v_cvt_pk_bf16_f32 v25, v25, v26
  v_lshlrev_b32 v26, 16, v25
  v_and_b32 v25, 0xffff0000, v25
  v_add_f32 v148, v25, v26
  v_lshlrev_b32 v25, 16, v249
  v_and_b32 v26, 0xffff0000, v249
  v_mul_f32 v25, v25, v58
  v_mul_f32 v26, v26, v53
  v_cvt_pk_bf16_f32 v25, v25, v26
  v_lshlrev_b32 v26, 16, v25
  v_and_b32 v25, 0xffff0000, v25
  v_add_f32 v148, v148, v26
  v_add_f32 v148, v148, v25
  v_lshlrev_b32 v25, 16, v250
  v_and_b32 v26, 0xffff0000, v250
  v_mul_f32 v25, v25, v59
  v_mul_f32 v26, v26, v54
  v_cvt_pk_bf16_f32 v25, v25, v26
  v_lshlrev_b32 v26, 16, v25
  v_and_b32 v25, 0xffff0000, v25
  v_add_f32 v148, v148, v26
  v_add_f32 v148, v148, v25
  v_lshlrev_b32 v25, 16, v251
  v_and_b32 v26, 0xffff0000, v251
  v_mul_f32 v25, v25, v60
  v_mul_f32 v26, v26, v55
  v_cvt_pk_bf16_f32 v25, v25, v26
  v_lshlrev_b32 v26, 16, v25
  v_and_b32 v25, 0xffff0000, v25
  v_add_f32 v148, v148, v26
  v_add_f32 v148, v148, v25
  v_lshlrev_b32 v25, 16, v252
  v_and_b32 v26, 0xffff0000, v252
  v_mul_f32 v25, v25, v61
  v_mul_f32 v26, v26, v56
  v_cvt_pk_bf16_f32 v25, v25, v26
  v_lshlrev_b32 v26, 16, v25
  v_and_b32 v25, 0xffff0000, v25
  v_add_f32 v148, v148, v26
  v_add_f32 v148, v148, v25
  v_lshlrev_b32 v25, 16, v30
  v_and_b32 v26, 0xffff0000, v30
  v_mul_f32 v25, v25, v57
  v_mul_f32 v26, v26, v52
  v_cvt_pk_bf16_f32 v25, v25, v26
  v_lshlrev_b32 v26, 16, v25
  v_and_b32 v25, 0xffff0000, v25
  v_add_f32 v149, v25, v26
  v_lshlrev_b32 v25, 16, v31
  v_and_b32 v26, 0xffff0000, v31
  v_mul_f32 v25, v25, v58
  v_mul_f32 v26, v26, v53
  v_cvt_pk_bf16_f32 v25, v25, v26
  v_lshlrev_b32 v26, 16, v25
  v_and_b32 v25, 0xffff0000, v25
  v_add_f32 v149, v149, v26
  v_add_f32 v149, v149, v25
  v_lshlrev_b32 v25, 16, v32
  v_and_b32 v26, 0xffff0000, v32
  v_mul_f32 v25, v25, v59
  v_mul_f32 v26, v26, v54
  v_cvt_pk_bf16_f32 v25, v25, v26
  v_lshlrev_b32 v26, 16, v25
  v_and_b32 v25, 0xffff0000, v25
  v_add_f32 v149, v149, v26
  v_add_f32 v149, v149, v25
  v_lshlrev_b32 v25, 16, v33
  v_and_b32 v26, 0xffff0000, v33
  v_mul_f32 v25, v25, v60
  v_mul_f32 v26, v26, v55
  v_cvt_pk_bf16_f32 v25, v25, v26
  v_lshlrev_b32 v26, 16, v25
  v_and_b32 v25, 0xffff0000, v25
  v_add_f32 v149, v149, v26
  v_add_f32 v149, v149, v25
  v_lshlrev_b32 v25, 16, v34
  v_and_b32 v26, 0xffff0000, v34
  v_mul_f32 v25, v25, v61
  v_mul_f32 v26, v26, v56
  v_cvt_pk_bf16_f32 v25, v25, v26
  v_lshlrev_b32 v26, 16, v25
  v_and_b32 v25, 0xffff0000, v25
  v_add_f32 v149, v149, v26
  v_add_f32 v149, v149, v25
  v_lshlrev_b32 v25, 16, v36
  v_and_b32 v26, 0xffff0000, v36
  v_mul_f32 v25, v25, v57
  v_mul_f32 v26, v26, v52
  v_cvt_pk_bf16_f32 v25, v25, v26
  v_lshlrev_b32 v26, 16, v25
  v_and_b32 v25, 0xffff0000, v25
  v_add_f32 v150, v25, v26
  v_lshlrev_b32 v25, 16, v37
  v_and_b32 v26, 0xffff0000, v37
  v_mul_f32 v25, v25, v58
  v_mul_f32 v26, v26, v53
  v_cvt_pk_bf16_f32 v25, v25, v26
  v_lshlrev_b32 v26, 16, v25
  v_and_b32 v25, 0xffff0000, v25
  v_add_f32 v150, v150, v26
  v_add_f32 v150, v150, v25
  v_lshlrev_b32 v25, 16, v38
  v_and_b32 v26, 0xffff0000, v38
  v_mul_f32 v25, v25, v59
  v_mul_f32 v26, v26, v54
  v_cvt_pk_bf16_f32 v25, v25, v26
  v_lshlrev_b32 v26, 16, v25
  v_and_b32 v25, 0xffff0000, v25
  v_add_f32 v150, v150, v26
  v_add_f32 v150, v150, v25
  v_lshlrev_b32 v25, 16, v39
  v_and_b32 v26, 0xffff0000, v39
  v_mul_f32 v25, v25, v60
  v_mul_f32 v26, v26, v55
  v_cvt_pk_bf16_f32 v25, v25, v26
  v_lshlrev_b32 v26, 16, v25
  v_and_b32 v25, 0xffff0000, v25
  v_add_f32 v150, v150, v26
  v_add_f32 v150, v150, v25
  v_lshlrev_b32 v25, 16, v40
  v_and_b32 v26, 0xffff0000, v40
  v_mul_f32 v25, v25, v61
  v_mul_f32 v26, v26, v56
  v_cvt_pk_bf16_f32 v25, v25, v26
  v_lshlrev_b32 v26, 16, v25
  v_and_b32 v25, 0xffff0000, v25
  v_add_f32 v150, v150, v26
  v_add_f32 v150, v150, v25
  v_lshlrev_b32 v25, 16, v42
  v_and_b32 v26, 0xffff0000, v42
  v_mul_f32 v25, v25, v57
  v_mul_f32 v26, v26, v52
  v_cvt_pk_bf16_f32 v25, v25, v26
  v_lshlrev_b32 v26, 16, v25
  v_and_b32 v25, 0xffff0000, v25
  v_add_f32 v151, v25, v26
  v_lshlrev_b32 v25, 16, v43
  v_and_b32 v26, 0xffff0000, v43
  v_mul_f32 v25, v25, v58
  v_mul_f32 v26, v26, v53
  v_cvt_pk_bf16_f32 v25, v25, v26
  v_lshlrev_b32 v26, 16, v25
  v_and_b32 v25, 0xffff0000, v25
  v_add_f32 v151, v151, v26
  v_add_f32 v151, v151, v25
  v_lshlrev_b32 v25, 16, v44
  v_and_b32 v26, 0xffff0000, v44
  v_mul_f32 v25, v25, v59
  v_mul_f32 v26, v26, v54
  v_cvt_pk_bf16_f32 v25, v25, v26
  v_lshlrev_b32 v26, 16, v25
  v_and_b32 v25, 0xffff0000, v25
  v_add_f32 v151, v151, v26
  v_add_f32 v151, v151, v25
  v_lshlrev_b32 v25, 16, v45
  v_and_b32 v26, 0xffff0000, v45
  v_mul_f32 v25, v25, v60
  v_mul_f32 v26, v26, v55
  v_cvt_pk_bf16_f32 v25, v25, v26
  v_lshlrev_b32 v26, 16, v25
  v_and_b32 v25, 0xffff0000, v25
  v_add_f32 v151, v151, v26
  v_add_f32 v151, v151, v25
  v_lshlrev_b32 v25, 16, v46
  v_and_b32 v26, 0xffff0000, v46
  v_mul_f32 v25, v25, v61
  v_mul_f32 v26, v26, v56
  v_cvt_pk_bf16_f32 v25, v25, v26
  v_lshlrev_b32 v26, 16, v25
  v_and_b32 v25, 0xffff0000, v25
  v_add_f32 v151, v151, v26
  v_add_f32 v151, v151, v25
  v_add_f32_dpp v144, v144, v144 row_ror:8 row_mask:0xf bank_mask:0xf
  v_add_f32_dpp v145, v145, v145 row_ror:8 row_mask:0xf bank_mask:0xf
  v_add_f32_dpp v146, v146, v146 row_ror:8 row_mask:0xf bank_mask:0xf
  v_add_f32_dpp v147, v147, v147 row_ror:8 row_mask:0xf bank_mask:0xf
  v_add_f32_dpp v148, v148, v148 row_ror:8 row_mask:0xf bank_mask:0xf
  v_add_f32_dpp v149, v149, v149 row_ror:8 row_mask:0xf bank_mask:0xf
  v_add_f32_dpp v150, v150, v150 row_ror:8 row_mask:0xf bank_mask:0xf
  v_add_f32_dpp v151, v151, v151 row_ror:8 row_mask:0xf bank_mask:0xf
  v_add_f32_dpp v144, v144, v144 row_ror:4 row_mask:0xf bank_mask:0xf
  v_add_f32_dpp v145, v145, v145 row_ror:4 row_mask:0xf bank_mask:0xf
  v_add_f32_dpp v146, v146, v146 row_ror:4 row_mask:0xf bank_mask:0xf
  v_add_f32_dpp v147, v147, v147 row_ror:4 row_mask:0xf bank_mask:0xf
  v_add_f32_dpp v148, v148, v148 row_ror:4 row_mask:0xf bank_mask:0xf
  v_add_f32_dpp v149, v149, v149 row_ror:4 row_mask:0xf bank_mask:0xf
  v_add_f32_dpp v150, v150, v150 row_ror:4 row_mask:0xf bank_mask:0xf
  v_add_f32_dpp v151, v151, v151 row_ror:4 row_mask:0xf bank_mask:0xf
  v_add_f32_dpp v144, v144, v144 row_ror:2 row_mask:0xf bank_mask:0xf
  v_add_f32_dpp v145, v145, v145 row_ror:2 row_mask:0xf bank_mask:0xf
  v_add_f32_dpp v146, v146, v146 row_ror:2 row_mask:0xf bank_mask:0xf
  v_add_f32_dpp v147, v147, v147 row_ror:2 row_mask:0xf bank_mask:0xf
  v_add_f32_dpp v148, v148, v148 row_ror:2 row_mask:0xf bank_mask:0xf
  v_add_f32_dpp v149, v149, v149 row_ror:2 row_mask:0xf bank_mask:0xf
  v_add_f32_dpp v150, v150, v150 row_ror:2 row_mask:0xf bank_mask:0xf
  v_add_f32_dpp v151, v151, v151 row_ror:2 row_mask:0xf bank_mask:0xf
  v_add_f32_dpp v144, v144, v144 row_ror:1 row_mask:0xf bank_mask:0xf
  v_add_f32_dpp v145, v145, v145 row_ror:1 row_mask:0xf bank_mask:0xf
  v_add_f32_dpp v146, v146, v146 row_ror:1 row_mask:0xf bank_mask:0xf
  v_add_f32_dpp v147, v147, v147 row_ror:1 row_mask:0xf bank_mask:0xf
  v_add_f32_dpp v148, v148, v148 row_ror:1 row_mask:0xf bank_mask:0xf
  v_add_f32_dpp v149, v149, v149 row_ror:1 row_mask:0xf bank_mask:0xf
  v_add_f32_dpp v150, v150, v150 row_ror:1 row_mask:0xf bank_mask:0xf
  v_add_f32_dpp v151, v151, v151 row_ror:1 row_mask:0xf bank_mask:0xf
  v_mov_b32 v152, v144
  v_mov_b32 v153, v145
  v_mov_b32 v154, v146
  v_mov_b32 v155, v147
  v_mov_b32 v156, v148
  v_mov_b32 v157, v149
  v_mov_b32 v158, v150
  v_mov_b32 v159, v151
  v_permlane32_swap_b32 v144, v152
  v_permlane32_swap_b32 v145, v153
  v_permlane32_swap_b32 v146, v154
  v_permlane32_swap_b32 v147, v155
  v_permlane32_swap_b32 v148, v156
  v_permlane32_swap_b32 v149, v157
  v_permlane32_swap_b32 v150, v158
  v_permlane32_swap_b32 v151, v159
  v_add_f32 v144, v144, v152
  v_add_f32 v145, v145, v153
  v_add_f32 v146, v146, v154
  v_add_f32 v147, v147, v155
  v_add_f32 v148, v148, v156
  v_add_f32 v149, v149, v157
  v_add_f32 v150, v150, v158
  v_add_f32 v151, v151, v159
  v_mov_b32 v152, v144
  v_mov_b32 v153, v145
  v_mov_b32 v154, v146
  v_mov_b32 v155, v147
  v_mov_b32 v156, v148
  v_mov_b32 v157, v149
  v_mov_b32 v158, v150
  v_mov_b32 v159, v151
  v_permlane16_swap_b32 v144, v152
  v_permlane16_swap_b32 v145, v153
  v_permlane16_swap_b32 v146, v154
  v_permlane16_swap_b32 v147, v155
  v_permlane16_swap_b32 v148, v156
  v_permlane16_swap_b32 v149, v157
  v_permlane16_swap_b32 v150, v158
  v_permlane16_swap_b32 v151, v159
  v_add_f32 v144, v144, v152
  v_add_f32 v145, v145, v153
  v_add_f32 v146, v146, v154
  v_add_f32 v147, v147, v155
  v_add_f32 v148, v148, v156
  v_add_f32 v149, v149, v157
  v_add_f32 v150, v150, v158
  v_add_f32 v151, v151, v159
  v_mov_b32 v24, v144
  v_cmp_eq_u32 vcc, 1, v1
  s_nop 1
  v_cndmask_b32 v24, v24, v145, vcc
  v_cmp_eq_u32 vcc, 2, v1
  s_nop 1
  v_cndmask_b32 v24, v24, v146, vcc
  v_cmp_eq_u32 vcc, 3, v1
  s_nop 1
  v_cndmask_b32 v24, v24, v147, vcc
  v_cmp_eq_u32 vcc, 4, v1
  s_nop 1
  v_cndmask_b32 v24, v24, v148, vcc
  v_cmp_eq_u32 vcc, 5, v1
  s_nop 1
  v_cndmask_b32 v24, v24, v149, vcc
  v_cmp_eq_u32 vcc, 6, v1
  s_nop 1
  v_cndmask_b32 v24, v24, v150, vcc
  v_cmp_eq_u32 vcc, 7, v1
  s_nop 1
  v_cndmask_b32 v24, v24, v151, vcc
  v_cvt_pk_bf16_f32 v25, v24, v24
  v_lshlrev_b32 v24, 16, v25
  v_mul_f32 v24, 0xbfb8aa3b, v24
  v_exp_f32 v24, v24
  s_nop 0
  v_add_f32 v24, 1.0, v24
  v_rcp_f32 v24, v24
  s_nop 0
  v_cvt_pk_bf16_f32 v25, v24, v24
  v_lshlrev_b32 v24, 16, v25
  s_lshl_b32 s21, s59, 2
  s_mov_b64 exec, 0xff
  buffer_store_dword v24, v5, s[28:31], s21 offen sc1
  s_mov_b64 exec, -1
  s_waitcnt vmcnt(0)
  s_barrier
  s_lshr_b32 s21, s2, 2
  s_lshl_b32 s21, s21, 7
  s_add_u32 s21, s21, 94208
  s_cmp_lg_u32 s20, 0
  s_cbranch_scc1 af_237
  v_mov_b32 v10, 0
  v_mov_b32 v11, 1
  s_mov_b64 exec, 1
  buffer_atomic_add v11, v10, s[72:75], s21 offen sc1
  s_mov_b64 exec, -1
  s_nop 1
af_237:
  s_cmp_eq_u32 s87, -1
  s_cbranch_scc1 queue
tail_item:
  s_load_dwordx2 s[4:5], s[0:1], 96
  s_waitcnt lgkmcnt(0)
  s_mov_b32 s32, s4
  s_mov_b32 s33, s5
  s_mov_b32 s34, 256
  s_mov_b32 s35, 0x00020000
  s_waitcnt vmcnt(0)
  s_barrier
  s_mov_b32 s21, s87
do_pv:
  s_mov_b32 s2, s21
  s_load_dwordx2 s[4:5], s[0:1], 88
  s_load_dwordx2 s[38:39], s[0:1], 104
  s_waitcnt lgkmcnt(0)
  s_mov_b32 s8, s4
  s_mov_b32 s9, s5
  s_mov_b32 s10, 2621440
  s_mov_b32 s11, 0x00020000
  s_add_u32 s12, s38, 114294784
  s_addc_u32 s13, s39, 0
  s_mov_b32 s14, 83886080
  s_mov_b32 s15, 0x00020000
  s_mov_b32 s59, 0
  s_mov_b32 s60, 0
  s_add_u32 s16, s38, 85983232
  s_addc_u32 s17, s39, 0
  s_mov_b32 s18, 28311552
  s_mov_b32 s19, 0x00020000
  s_add_u32 s24, s38, 73400320
  s_addc_u32 s25, s39, 0
  s_mov_b32 s26, 5242880
  s_mov_b32 s27, 0x00020000
  s_add_u32 s28, s38, 81002496
  s_addc_u32 s29, s39, 0
  s_mov_b32 s30, 8192
  s_mov_b32 s31, 0x00020000
  s_add_u32 s72, s38, 81068032
  s_addc_u32 s73, s39, 0
  s_mov_b32 s74, 117760
  s_mov_b32 s75, 0x00020000
  v_lshlrev_b32 v4, 4, v1
  v_lshlrev_b32 v5, 3, v1
  v_lshlrev_b32 v6, 2, v2
  v_and_b32 v7, 7, v1
  v_lshlrev_b32 v7, 7, v7
  v_lshrrev_b32 v31, 3, v1
  v_lshl_add_u32 v208, v31, 10, v7
  v_bfe_u32 v31, v1, 3, 2
  v_lshl_add_u32 v31, v31, 2, v7
  s_lshl_b32 s21, s20, 10
  s_add_u32 s21, s21, 96256
  buffer_load_dword v8, v31, s[72:75], s21 offen sc1
  v_lshlrev_b32 v25, 7, v2
  s_mov_b32 s21, 94208
  buffer_load_dword v26, v25, s[72:75], s21 offen sc1
  s_mov_b32 s63, 1
  v_mul_u32_u24 v9, 1280, v2
  v_lshl_add_u32 v9, v3, 3, v9
  s_lshl_b32 s21, s20, 13
  v_add_u32 v10, s21, v4
  s_lshl_b32 s21, s20, 10
  v_add_u32 v11, s21, v4
  v_lshrrev_b32 v20, 5, v1
  v_mul_u32_u24 v21, 2560, v20
  v_add_u32 v21, v21, v4
  v_and_b32 v22, 31, v1
  v_lshlrev_b32 v22, 4, v22
  v_mul_u32_u24 v20, 10240, v20
  v_add_u32 v22, v22, v20
  v_mul_u32_u24 v21, 2560, v3
  v_lshl_add_u32 v21, v2, 4, v21
  v_mul_u32_u24 v22, 10240, v3
  v_lshl_add_u32 v22, v2, 4, v22
  v_mov_b32 v28, 80
  v_mov_b32 v30, 32768
  s_mov_b32 s50, 0
  s_mov_b32 s51, 0
  s_and_b32 s43, s20, 1
  s_lshr_b32 s44, s20, 1
  v_mov_b32 v70, 0
  v_mov_b32 v71, 0
  v_mov_b32 v78, 0
  v_mov_b32 v79, 0
  v_mov_b32 v86, 0
  v_mov_b32 v87, 0
  v_mov_b32 v94, 0
  v_mov_b32 v95, 0
  v_mov_b32 v102, 0
  v_mov_b32 v103, 0
  v_mov_b32 v110, 0
  v_mov_b32 v111, 0
  v_mov_b32 v118, 0
  v_mov_b32 v119, 0
  v_mov_b32 v126, 0
  v_mov_b32 v127, 0
  s_mov_b32 s21, s2
pv_loop:
  s_mul_i32 s2, s21, 2
  s_add_u32 s22, s21, 250
  s_cmp_lt_u32 s21, 250
  s_cselect_b32 s2, s2, s22
  s_cselect_b32 s65, 1, 0
  s_mul_hi_u32 s40, s2, 0x1999999a
  s_mul_i32 s21, s40, 10
  s_sub_u32 s41, s2, s21
  s_lshl_b32 s52, s40, 10
  s_add_u32 s52, s52, 24576
  buffer_load_dword v27, v7, s[72:75], s52 offen sc1
  s_cmp_lg_u32 s20, 0
  s_cbranch_scc1 pv_246
  s_sub_u32 s21, s2, 450
  s_cmp_lt_u32 s21, 190
  s_cbranch_scc1 pv_246
  v_mov_b32 v29, 1
  s_mov_b64 exec, 1
  buffer_atomic_add v29, v28, s[32:35], 0 offen sc0 sc1
  s_mov_b64 exec, -1
pv_246:
  s_lshl_b32 s42, s40, 5
  s_lshl_b32 s21, s20, 3
  s_add_u32 s42, s42, s21
  s_mul_i32 s61, s21, 5
  s_lshr_b32 s22, s41, 1
  s_add_u32 s61, s61, s22
  s_and_b32 s62, s41, 1
  s_lshl_b32 s62, s62, 12
  s_mul_i32 s53, s42, 40960
  s_lshl_b32 s22, s41, 12
  s_add_u32 s53, s53, s22
  s_lshl_b32 s21, s40, 1
  s_add_u32 s21, s21, s43
  s_lshl_b32 s45, s21, 6
  s_mul_i32 s46, s21, 20480
  s_mul_i32 s21, s21, 40
  s_lshl_b32 s22, s41, 2
  s_add_u32 s22, s22, s44
  s_add_u32 s21, s21, s22
  s_lshl_b32 s54, s21, 10
  s_lshl_b32 s22, s22, 5
  s_add_u32 s46, s46, s22
  s_mul_i32 s47, s42, 2560
  s_mul_i32 s48, s42, 10240
  s_lshl_b32 s22, s41, 10
  s_add_u32 s48, s48, s22
  s_add_u32 s48, s48, 7340032
  s_add_u32 s23, s40, 1
  s_cmp_ge_u32 s50, s23
  s_cbranch_scc1 pv_239
  s_cmp_eq_u32 s63, 0
  s_cbranch_scc1 pv_242
  s_mov_b32 s63, 0
  s_waitcnt vmcnt(1)
  v_cmp_le_u32 vcc, 4, v26
  s_mov_b32 s51, vcc_lo
  v_cmp_gt_u32 vcc, s23, v8
  s_nop 1
  s_cbranch_vccz pv_243
pv_242:
  s_lshl_b32 s21, s20, 10
  s_add_u32 s21, s21, 96256
  s_mov_b32 s101, 0
wm_247:
  buffer_load_dword v8, v31, s[72:75], s21 offen sc1
  s_add_u32 s101, s101, 1
  s_cmp_gt_u32 s101, 131072
  s_cbranch_scc1 main_end
  s_waitcnt vmcnt(0)
  v_cmp_gt_u32 vcc, s23, v8
  v_readfirstlane_b32 s100, v8
  s_nop 0
  s_cbranch_vccz wm_248
  s_sleep 8
  s_add_u32 s100, s100, 2
  s_cmp_ge_u32 s100, s23
  s_cbranch_scc1 wm_247
  s_sleep 60
  s_branch wm_247
wm_248:
pv_243:
  v_readlane_b32 s50, v8, 0
  v_readlane_b32 s21, v8, 1
  s_min_u32 s50, s50, s21
  v_readlane_b32 s21, v8, 2
  s_min_u32 s50, s50, s21
  v_readlane_b32 s21, v8, 3
  s_min_u32 s50, s50, s21
  v_readlane_b32 s21, v8, 4
  s_min_u32 s50, s50, s21
  v_readlane_b32 s21, v8, 5
  s_min_u32 s50, s50, s21
  v_readlane_b32 s21, v8, 6
  s_min_u32 s50, s50, s21
  v_readlane_b32 s21, v8, 7
  s_min_u32 s50, s50, s21
  v_readlane_b32 s21, v8, 8
  s_min_u32 s50, s50, s21
  v_readlane_b32 s21, v8, 9
  s_min_u32 s50, s50, s21
  v_readlane_b32 s21, v8, 10
  s_min_u32 s50, s50, s21
  v_readlane_b32 s21, v8, 11
  s_min_u32 s50, s50, s21
  v_readlane_b32 s21, v8, 12
  s_min_u32 s50, s50, s21
  v_readlane_b32 s21, v8, 13
  s_min_u32 s50, s50, s21
  v_readlane_b32 s21, v8, 14
  s_min_u32 s50, s50, s21
  v_readlane_b32 s21, v8, 15
  s_min_u32 s50, s50, s21
  v_readlane_b32 s21, v8, 16
  s_min_u32 s50, s50, s21
  v_readlane_b32 s21, v8, 17
  s_min_u32 s50, s50, s21
  v_readlane_b32 s21, v8, 18
  s_min_u32 s50, s50, s21
  v_readlane_b32 s21, v8, 19
  s_min_u32 s50, s50, s21
  v_readlane_b32 s21, v8, 20
  s_min_u32 s50, s50, s21
  v_readlane_b32 s21, v8, 21
  s_min_u32 s50, s50, s21
  v_readlane_b32 s21, v8, 22
  s_min_u32 s50, s50, s21
  v_readlane_b32 s21, v8, 23
  s_min_u32 s50, s50, s21
  v_readlane_b32 s21, v8, 24
  s_min_u32 s50, s50, s21
  v_readlane_b32 s21, v8, 25
  s_min_u32 s50, s50, s21
  v_readlane_b32 s21, v8, 26
  s_min_u32 s50, s50, s21
  v_readlane_b32 s21, v8, 27
  s_min_u32 s50, s50, s21
  v_readlane_b32 s21, v8, 28
  s_min_u32 s50, s50, s21
  v_readlane_b32 s21, v8, 29
  s_min_u32 s50, s50, s21
  v_readlane_b32 s21, v8, 30
  s_min_u32 s50, s50, s21
  v_readlane_b32 s21, v8, 31
  s_min_u32 s50, s50, s21
pv_239:
  s_lshr_b32 s22, s40, 2
  s_cmp_lt_u32 s40, 0
  s_cbranch_scc1 pv_240
  s_bitcmp1_b32 s51, s22
  s_cbranch_scc1 pv_240
  s_mov_b32 s21, 94208
  v_lshlrev_b32 v25, 7, v2
  s_mov_b32 s101, 0
pv_241:
  buffer_load_dword v26, v25, s[72:75], s21 offen sc1
  s_add_u32 s101, s101, 1
  s_cmp_gt_u32 s101, 131072
  s_cbranch_scc1 main_end
  s_waitcnt vmcnt(0)
  v_cmp_le_u32 vcc, 4, v26
  s_mov_b32 s51, vcc_lo
  s_bitcmp1_b32 s51, s22
  s_cbranch_scc1 pv_240
  s_sleep 8
  s_branch pv_241
pv_240:
  buffer_load_dwordx4 a[0:3], v4, s[12:15], s53 offen offset:0 sc1
  buffer_load_dwordx4 a[4:7], v4, s[12:15], s53 offen offset:1024 sc1
  buffer_load_dwordx4 a[8:11], v4, s[12:15], s53 offen offset:2048 sc1
  buffer_load_dwordx4 a[12:15], v4, s[12:15], s53 offen offset:3072 sc1
  s_add_u32 s53, s53, 40960
  buffer_load_dwordx4 a[16:19], v4, s[12:15], s53 offen offset:0 sc1
  buffer_load_dwordx4 a[20:23], v4, s[12:15], s53 offen offset:1024 sc1
  buffer_load_dwordx4 a[24:27], v4, s[12:15], s53 offen offset:2048 sc1
  buffer_load_dwordx4 a[28:31], v4, s[12:15], s53 offen offset:3072 sc1
  s_add_u32 s53, s53, 40960
  buffer_load_dwordx4 a[32:35], v4, s[12:15], s53 offen offset:0 sc1
  buffer_load_dwordx4 a[36:39], v4, s[12:15], s53 offen offset:1024 sc1
  buffer_load_dwordx4 a[40:43], v4, s[12:15], s53 offen offset:2048 sc1
  buffer_load_dwordx4 a[44:47], v4, s[12:15], s53 offen offset:3072 sc1
  s_add_u32 s53, s53, 40960
  buffer_load_dwordx4 a[48:51], v4, s[12:15], s53 offen offset:0 sc1
  buffer_load_dwordx4 a[52:55], v4, s[12:15], s53 offen offset:1024 sc1
  buffer_load_dwordx4 a[56:59], v4, s[12:15], s53 offen offset:2048 sc1
  buffer_load_dwordx4 a[60:63], v4, s[12:15], s53 offen offset:3072 sc1
  s_add_u32 s53, s53, 40960
  buffer_load_dwordx4 a[64:67], v4, s[12:15], s53 offen offset:0 sc1
  buffer_load_dwordx4 a[68:71], v4, s[12:15], s53 offen offset:1024 sc1
  buffer_load_dwordx4 a[72:75], v4, s[12:15], s53 offen offset:2048 sc1
  buffer_load_dwordx4 a[76:79], v4, s[12:15], s53 offen offset:3072 sc1
  s_add_u32 s53, s53, 40960
  buffer_load_dwordx4 a[80:83], v4, s[12:15], s53 offen offset:0 sc1
  buffer_load_dwordx4 a[84:87], v4, s[12:15], s53 offen offset:1024 sc1
  buffer_load_dwordx4 a[88:91], v4, s[12:15], s53 offen offset:2048 sc1
  buffer_load_dwordx4 a[92:95], v4, s[12:15], s53 offen offset:3072 sc1
  s_add_u32 s53, s53, 40960
  buffer_load_dwordx4 a[96:99], v4, s[12:15], s53 offen offset:0 sc1
  buffer_load_dwordx4 a[100:103], v4, s[12:15], s53 offen offset:1024 sc1
  buffer_load_dwordx4 a[104:107], v4, s[12:15], s53 offen offset:2048 sc1
  buffer_load_dwordx4 a[108:111], v4, s[12:15], s53 offen offset:3072 sc1
  s_add_u32 s53, s53, 40960
  buffer_load_dwordx4 a[112:115], v4, s[12:15], s53 offen offset:0 sc1
  buffer_load_dwordx4 a[116:119], v4, s[12:15], s53 offen offset:1024 sc1
  buffer_load_dwordx4 a[120:123], v4, s[12:15], s53 offen offset:2048 sc1
  buffer_load_dwordx4 a[124:127], v4, s[12:15], s53 offen offset:3072 sc1
  buffer_load_dwordx4 v[12:15], v4, s[24:27], s54 offen sc1
  buffer_load_dwordx4 v[16:19], v4, s[24:27], s54 offen offset:2048 sc1
  buffer_load_dword v24, v6, s[28:31], s45 offen sc1
  s_waitcnt vmcnt(35)
  v_cmp_le_u32 s[68:69], 4, v27
  s_nop 1
  s_and_b32 s21, s68, 255
  s_cmp_lg_u32 s21, 255
  s_cbranch_scc1 pvw_244
  s_mov_b32 s56, s47
  s_mov_b32 s57, s48
  buffer_load_dwordx4 v[64:67], v4, s[16:19], s56 offen sc1
  buffer_load_dwordx2 v[68:69], v5, s[16:19], s56 offen offset:2048 sc1
  buffer_load_dwordx4 v[128:131], v21, s[16:19], s56 offen offset:1024 sc1
  buffer_load_dwordx4 v[132:135], v21, s[16:19], s56 offen offset:1280 sc1
  s_add_u32 s56, s56, 2560
  buffer_load_dwordx4 v[72:75], v4, s[16:19], s56 offen sc1
  buffer_load_dwordx2 v[76:77], v5, s[16:19], s56 offen offset:2048 sc1
  s_add_u32 s56, s56, 2560
  buffer_load_dwordx4 v[80:83], v4, s[16:19], s56 offen sc1
  buffer_load_dwordx2 v[84:85], v5, s[16:19], s56 offen offset:2048 sc1
  s_add_u32 s56, s56, 2560
  buffer_load_dwordx4 v[88:91], v4, s[16:19], s56 offen sc1
  buffer_load_dwordx2 v[92:93], v5, s[16:19], s56 offen offset:2048 sc1
  s_add_u32 s56, s56, 2560
  buffer_load_dwordx4 v[32:35], v22, s[16:19], s57 offen offset:0 sc1
  buffer_load_dwordx4 v[36:39], v22, s[16:19], s57 offen offset:256 sc1
  buffer_load_dwordx4 v[40:43], v22, s[16:19], s57 offen offset:512 sc1
  buffer_load_dwordx4 v[44:47], v22, s[16:19], s57 offen offset:768 sc1
  s_add_u32 s57, s57, 40960
  buffer_load_dwordx4 v[96:99], v4, s[16:19], s56 offen sc1
  buffer_load_dwordx2 v[100:101], v5, s[16:19], s56 offen offset:2048 sc1
  buffer_load_dwordx4 v[136:139], v21, s[16:19], s56 offen offset:1024 sc1
  buffer_load_dwordx4 v[140:143], v21, s[16:19], s56 offen offset:1280 sc1
  s_add_u32 s56, s56, 2560
  buffer_load_dwordx4 v[104:107], v4, s[16:19], s56 offen sc1
  buffer_load_dwordx2 v[108:109], v5, s[16:19], s56 offen offset:2048 sc1
  s_add_u32 s56, s56, 2560
  buffer_load_dwordx4 v[112:115], v4, s[16:19], s56 offen sc1
  buffer_load_dwordx2 v[116:117], v5, s[16:19], s56 offen offset:2048 sc1
  s_add_u32 s56, s56, 2560
  buffer_load_dwordx4 v[120:123], v4, s[16:19], s56 offen sc1
  buffer_load_dwordx2 v[124:125], v5, s[16:19], s56 offen offset:2048 sc1
  s_add_u32 s56, s56, 2560
  buffer_load_dwordx4 v[48:51], v22, s[16:19], s57 offen offset:0 sc1
  buffer_load_dwordx4 v[52:55], v22, s[16:19], s57 offen offset:256 sc1
  buffer_load_dwordx4 v[56:59], v22, s[16:19], s57 offen offset:512 sc1
  buffer_load_dwordx4 v[60:63], v22, s[16:19], s57 offen offset:768 sc1
  s_add_u32 s57, s57, 40960
  s_barrier
  s_waitcnt vmcnt(28)
  v_sub_f32 v25, 1.0, v24
  v_cvt_pk_bf16_f32 v26, v25, v25
  v_lshlrev_b32 v25, 16, v26
  v_cvt_pk_bf16_f32 v26, v12, v12
  v_lshlrev_b32 v12, 16, v26
  v_cvt_pk_bf16_f32 v26, v13, v13
  v_lshlrev_b32 v13, 16, v26
  v_cvt_pk_bf16_f32 v26, v14, v14
  v_lshlrev_b32 v14, 16, v26
  v_cvt_pk_bf16_f32 v26, v15, v15
  v_lshlrev_b32 v15, 16, v26
  v_cvt_pk_bf16_f32 v26, v16, v16
  v_lshlrev_b32 v16, 16, v26
  v_cvt_pk_bf16_f32 v26, v17, v17
  v_lshlrev_b32 v17, 16, v26
  v_cvt_pk_bf16_f32 v26, v18, v18
  v_lshlrev_b32 v18, 16, v26
  v_cvt_pk_bf16_f32 v26, v19, v19
  v_lshlrev_b32 v19, 16, v26
  v_mul_f32 v12, v12, v25
  v_cvt_pk_bf16_f32 v26, v12, v12
  v_lshlrev_b32 v12, 16, v26
  v_mul_f32 v13, v13, v25
  v_cvt_pk_bf16_f32 v26, v13, v13
  v_lshlrev_b32 v13, 16, v26
  v_mul_f32 v14, v14, v25
  v_cvt_pk_bf16_f32 v26, v14, v14
  v_lshlrev_b32 v14, 16, v26
  v_mul_f32 v15, v15, v25
  v_cvt_pk_bf16_f32 v26, v15, v15
  v_lshlrev_b32 v15, 16, v26
  v_mul_f32 v16, v16, v25
  v_cvt_pk_bf16_f32 v26, v16, v16
  v_lshlrev_b32 v16, 16, v26
  v_mul_f32 v17, v17, v25
  v_cvt_pk_bf16_f32 v26, v17, v17
  v_lshlrev_b32 v17, 16, v26
  v_mul_f32 v18, v18, v25
  v_cvt_pk_bf16_f32 v26, v18, v18
  v_lshlrev_b32 v18, 16, v26
  v_mul_f32 v19, v19, v25
  v_cvt_pk_bf16_f32 v26, v19, v19
  v_lshlrev_b32 v19, 16, v26
  s_cmp_ge_u32 s40, 56
  s_cbranch_scc1 pvc_250
  s_branch pvg_249
pvw_244:
  s_waitcnt vmcnt(0)
  v_sub_f32 v25, 1.0, v24
  v_cvt_pk_bf16_f32 v26, v25, v25
  v_lshlrev_b32 v25, 16, v26
  v_cvt_pk_bf16_f32 v26, v12, v12
  v_lshlrev_b32 v12, 16, v26
  v_cvt_pk_bf16_f32 v26, v13, v13
  v_lshlrev_b32 v13, 16, v26
  v_cvt_pk_bf16_f32 v26, v14, v14
  v_lshlrev_b32 v14, 16, v26
  v_cvt_pk_bf16_f32 v26, v15, v15
  v_lshlrev_b32 v15, 16, v26
  v_cvt_pk_bf16_f32 v26, v16, v16
  v_lshlrev_b32 v16, 16, v26
  v_cvt_pk_bf16_f32 v26, v17, v17
  v_lshlrev_b32 v17, 16, v26
  v_cvt_pk_bf16_f32 v26, v18, v18
  v_lshlrev_b32 v18, 16, v26
  v_cvt_pk_bf16_f32 v26, v19, v19
  v_lshlrev_b32 v19, 16, v26
  v_mul_f32 v12, v12, v25
  v_cvt_pk_bf16_f32 v26, v12, v12
  v_lshlrev_b32 v12, 16, v26
  v_mul_f32 v13, v13, v25
  v_cvt_pk_bf16_f32 v26, v13, v13
  v_lshlrev_b32 v13, 16, v26
  v_mul_f32 v14, v14, v25
  v_cvt_pk_bf16_f32 v26, v14, v14
  v_lshlrev_b32 v14, 16, v26
  v_mul_f32 v15, v15, v25
  v_cvt_pk_bf16_f32 v26, v15, v15
  v_lshlrev_b32 v15, 16, v26
  v_mul_f32 v16, v16, v25
  v_cvt_pk_bf16_f32 v26, v16, v16
  v_lshlrev_b32 v16, 16, v26
  v_mul_f32 v17, v17, v25
  v_cvt_pk_bf16_f32 v26, v17, v17
  v_lshlrev_b32 v17, 16, v26
  v_mul_f32 v18, v18, v25
  v_cvt_pk_bf16_f32 v26, v18, v18
  v_lshlrev_b32 v18, 16, v26
  v_mul_f32 v19, v19, v25
  v_cvt_pk_bf16_f32 v26, v19, v19
  v_lshlrev_b32 v19, 16, v26
  s_cmp_ge_u32 s40, 56
  s_cbranch_scc1 pvt_251
  s_cmp_lg_u32 s20, 0
  s_cbranch_scc1 wm_253
  s_mov_b32 s101, 0
wm_252:
  buffer_load_dword v26, v7, s[72:75], s52 offen sc1
  s_add_u32 s101, s101, 1
  s_cmp_gt_u32 s101, 131072
  s_cbranch_scc1 main_end
  s_waitcnt vmcnt(0)
  v_cmp_gt_u32 vcc, 4, v26
  v_readfirstlane_b32 s100, v26
  s_nop 0
  s_cbranch_vccz wm_253
  s_sleep 2
  s_add_u32 s100, s100, 3
  s_cmp_ge_u32 s100, 4
  s_cbranch_scc1 wm_252
  s_sleep 24
  s_branch wm_252
wm_253:
  s_barrier
  buffer_load_dwordx4 v[64:67], v4, s[16:19], s47 offen sc1
  buffer_load_dwordx2 v[68:69], v5, s[16:19], s47 offen offset:2048 sc1
  buffer_load_dwordx4 v[128:131], v21, s[16:19], s47 offen offset:1024 sc1
  buffer_load_dwordx4 v[132:135], v21, s[16:19], s47 offen offset:1280 sc1
  s_add_u32 s47, s47, 2560
  buffer_load_dwordx4 v[72:75], v4, s[16:19], s47 offen sc1
  buffer_load_dwordx2 v[76:77], v5, s[16:19], s47 offen offset:2048 sc1
  s_add_u32 s47, s47, 2560
  buffer_load_dwordx4 v[80:83], v4, s[16:19], s47 offen sc1
  buffer_load_dwordx2 v[84:85], v5, s[16:19], s47 offen offset:2048 sc1
  s_add_u32 s47, s47, 2560
  buffer_load_dwordx4 v[88:91], v4, s[16:19], s47 offen sc1
  buffer_load_dwordx2 v[92:93], v5, s[16:19], s47 offen offset:2048 sc1
  s_add_u32 s47, s47, 2560
  buffer_load_dwordx4 v[32:35], v22, s[16:19], s48 offen offset:0 sc1
  buffer_load_dwordx4 v[36:39], v22, s[16:19], s48 offen offset:256 sc1
  buffer_load_dwordx4 v[40:43], v22, s[16:19], s48 offen offset:512 sc1
  buffer_load_dwordx4 v[44:47], v22, s[16:19], s48 offen offset:768 sc1
  s_add_u32 s48, s48, 40960
  buffer_load_dwordx4 v[96:99], v4, s[16:19], s47 offen sc1
  buffer_load_dwordx2 v[100:101], v5, s[16:19], s47 offen offset:2048 sc1
  buffer_load_dwordx4 v[136:139], v21, s[16:19], s47 offen offset:1024 sc1
  buffer_load_dwordx4 v[140:143], v21, s[16:19], s47 offen offset:1280 sc1
  s_add_u32 s47, s47, 2560
  buffer_load_dwordx4 v[104:107], v4, s[16:19], s47 offen sc1
  buffer_load_dwordx2 v[108:109], v5, s[16:19], s47 offen offset:2048 sc1
  s_add_u32 s47, s47, 2560
  buffer_load_dwordx4 v[112:115], v4, s[16:19], s47 offen sc1
  buffer_load_dwordx2 v[116:117], v5, s[16:19], s47 offen offset:2048 sc1
  s_add_u32 s47, s47, 2560
  buffer_load_dwordx4 v[120:123], v4, s[16:19], s47 offen sc1
  buffer_load_dwordx2 v[124:125], v5, s[16:19], s47 offen offset:2048 sc1
  s_add_u32 s47, s47, 2560
  buffer_load_dwordx4 v[48:51], v22, s[16:19], s48 offen offset:0 sc1
  buffer_load_dwordx4 v[52:55], v22, s[16:19], s48 offen offset:256 sc1
  buffer_load_dwordx4 v[56:59], v22, s[16:19], s48 offen offset:512 sc1
  buffer_load_dwordx4 v[60:63], v22, s[16:19], s48 offen offset:768 sc1
  s_add_u32 s48, s48, 40960
pvg_249:
  s_waitcnt vmcnt(26)
  v_mfma_f32_16x16x32_bf16 v[148:151], a[0:3], v[64:67], 0
  v_mfma_f32_16x16x32_bf16 v[144:147], a[0:3], v[68:71], 0
  v_mfma_f32_16x16x32_bf16 v[156:159], a[4:7], v[64:67], 0
  v_mfma_f32_16x16x32_bf16 v[152:155], a[4:7], v[68:71], 0
  v_mfma_f32_16x16x32_bf16 v[164:167], a[8:11], v[64:67], 0
  v_mfma_f32_16x16x32_bf16 v[160:163], a[8:11], v[68:71], 0
  v_mfma_f32_16x16x32_bf16 v[172:175], a[12:15], v[64:67], 0
  v_mfma_f32_16x16x32_bf16 v[168:171], a[12:15], v[68:71], 0
  s_waitcnt vmcnt(22)
  v_mfma_f32_16x16x32_bf16 v[148:151], a[16:19], v[72:75], v[148:151]
  v_mfma_f32_16x16x32_bf16 v[144:147], a[16:19], v[76:79], v[144:147]
  v_mfma_f32_16x16x32_bf16 v[156:159], a[20:23], v[72:75], v[156:159]
  v_mfma_f32_16x16x32_bf16 v[152:155], a[20:23], v[76:79], v[152:155]
  v_mfma_f32_16x16x32_bf16 v[164:167], a[24:27], v[72:75], v[164:167]
  v_mfma_f32_16x16x32_bf16 v[160:163], a[24:27], v[76:79], v[160:163]
  v_mfma_f32_16x16x32_bf16 v[172:175], a[28:31], v[72:75], v[172:175]
  v_mfma_f32_16x16x32_bf16 v[168:171], a[28:31], v[76:79], v[168:171]
  s_waitcnt vmcnt(20)
  v_mfma_f32_16x16x32_bf16 v[148:151], a[32:35], v[80:83], v[148:151]
  v_mfma_f32_16x16x32_bf16 v[144:147], a[32:35], v[84:87], v[144:147]
  v_mfma_f32_16x16x32_bf16 v[156:159], a[36:39], v[80:83], v[156:159]
  v_mfma_f32_16x16x32_bf16 v[152:155], a[36:39], v[84:87], v[152:155]
  v_mfma_f32_16x16x32_bf16 v[164:167], a[40:43], v[80:83], v[164:167]
  v_mfma_f32_16x16x32_bf16 v[160:163], a[40:43], v[84:87], v[160:163]
  v_mfma_f32_16x16x32_bf16 v[172:175], a[44:47], v[80:83], v[172:175]
  v_mfma_f32_16x16x32_bf16 v[168:171], a[44:47], v[84:87], v[168:171]
  s_waitcnt vmcnt(18)
  v_mfma_f32_16x16x32_bf16 v[148:151], a[48:51], v[88:91], v[148:151]
  v_mfma_f32_16x16x32_bf16 v[144:147], a[48:51], v[92:95], v[144:147]
  v_mfma_f32_16x16x32_bf16 v[156:159], a[52:55], v[88:91], v[156:159]
  v_mfma_f32_16x16x32_bf16 v[152:155], a[52:55], v[92:95], v[152:155]
  v_mfma_f32_16x16x32_bf16 v[164:167], a[56:59], v[88:91], v[164:167]
  v_mfma_f32_16x16x32_bf16 v[160:163], a[56:59], v[92:95], v[160:163]
  v_mfma_f32_16x16x32_bf16 v[172:175], a[60:63], v[88:91], v[172:175]
  v_mfma_f32_16x16x32_bf16 v[168:171], a[60:63], v[92:95], v[168:171]
  s_waitcnt vmcnt(14)
  s_nop 1
  v_mfma_f32_16x16x32_bf16 v[144:147], v[32:35], v[128:131], v[144:147]
  v_mfma_f32_16x16x32_bf16 v[148:151], v[32:35], v[132:135], v[148:151]
  v_mfma_f32_16x16x32_bf16 v[152:155], v[36:39], v[128:131], v[152:155]
  v_mfma_f32_16x16x32_bf16 v[156:159], v[36:39], v[132:135], v[156:159]
  v_mfma_f32_16x16x32_bf16 v[160:163], v[40:43], v[128:131], v[160:163]
  v_mfma_f32_16x16x32_bf16 v[164:167], v[40:43], v[132:135], v[164:167]
  v_mfma_f32_16x16x32_bf16 v[168:171], v[44:47], v[128:131], v[168:171]
  v_mfma_f32_16x16x32_bf16 v[172:175], v[44:47], v[132:135], v[172:175]
  s_waitcnt vmcnt(12)
  v_mfma_f32_16x16x32_bf16 v[148:151], a[64:67], v[96:99], v[148:151]
  v_mfma_f32_16x16x32_bf16 v[144:147], a[64:67], v[100:103], v[144:147]
  v_mfma_f32_16x16x32_bf16 v[156:159], a[68:71], v[96:99], v[156:159]
  v_mfma_f32_16x16x32_bf16 v[152:155], a[68:71], v[100:103], v[152:155]
  v_mfma_f32_16x16x32_bf16 v[164:167], a[72:75], v[96:99], v[164:167]
  v_mfma_f32_16x16x32_bf16 v[160:163], a[72:75], v[100:103], v[160:163]
  v_mfma_f32_16x16x32_bf16 v[172:175], a[76:79], v[96:99], v[172:175]
  v_mfma_f32_16x16x32_bf16 v[168:171], a[76:79], v[100:103], v[168:171]
  s_waitcnt vmcnt(8)
  v_mfma_f32_16x16x32_bf16 v[148:151], a[80:83], v[104:107], v[148:151]
  v_mfma_f32_16x16x32_bf16 v[144:147], a[80:83], v[108:111], v[144:147]
  v_mfma_f32_16x16x32_bf16 v[156:159], a[84:87], v[104:107], v[156:159]
  v_mfma_f32_16x16x32_bf16 v[152:155], a[84:87], v[108:111], v[152:155]
  v_mfma_f32_16x16x32_bf16 v[164:167], a[88:91], v[104:107], v[164:167]
  v_mfma_f32_16x16x32_bf16 v[160:163], a[88:91], v[108:111], v[160:163]
  v_mfma_f32_16x16x32_bf16 v[172:175], a[92:95], v[104:107], v[172:175]
  v_mfma_f32_16x16x32_bf16 v[168:171], a[92:95], v[108:111], v[168:171]
  s_waitcnt vmcnt(6)
  v_mfma_f32_16x16x32_bf16 v[148:151], a[96:99], v[112:115], v[148:151]
  v_mfma_f32_16x16x32_bf16 v[144:147], a[96:99], v[116:119], v[144:147]
  v_mfma_f32_16x16x32_bf16 v[156:159], a[100:103], v[112:115], v[156:159]
  v_mfma_f32_16x16x32_bf16 v[152:155], a[100:103], v[116:119], v[152:155]
  v_mfma_f32_16x16x32_bf16 v[164:167], a[104:107], v[112:115], v[164:167]
  v_mfma_f32_16x16x32_bf16 v[160:163], a[104:107], v[116:119], v[160:163]
  v_mfma_f32_16x16x32_bf16 v[172:175], a[108:111], v[112:115], v[172:175]
  v_mfma_f32_16x16x32_bf16 v[168:171], a[108:111], v[116:119], v[168:171]
  s_waitcnt vmcnt(4)
  v_mfma_f32_16x16x32_bf16 v[148:151], a[112:115], v[120:123], v[148:151]
  v_mfma_f32_16x16x32_bf16 v[144:147], a[112:115], v[124:127], v[144:147]
  v_mfma_f32_16x16x32_bf16 v[156:159], a[116:119], v[120:123], v[156:159]
  v_mfma_f32_16x16x32_bf16 v[152:155], a[116:119], v[124:127], v[152:155]
  v_mfma_f32_16x16x32_bf16 v[164:167], a[120:123], v[120:123], v[164:167]
  v_mfma_f32_16x16x32_bf16 v[160:163], a[120:123], v[124:127], v[160:163]
  v_mfma_f32_16x16x32_bf16 v[172:175], a[124:127], v[120:123], v[172:175]
  v_mfma_f32_16x16x32_bf16 v[168:171], a[124:127], v[124:127], v[168:171]
  s_waitcnt vmcnt(0)
  s_nop 1
  v_mfma_f32_16x16x32_bf16 v[144:147], v[48:51], v[136:139], v[144:147]
  v_mfma_f32_16x16x32_bf16 v[148:151], v[48:51], v[140:143], v[148:151]
  v_mfma_f32_16x16x32_bf16 v[152:155], v[52:55], v[136:139], v[152:155]
  v_mfma_f32_16x16x32_bf16 v[156:159], v[52:55], v[140:143], v[156:159]
  v_mfma_f32_16x16x32_bf16 v[160:163], v[56:59], v[136:139], v[160:163]
  v_mfma_f32_16x16x32_bf16 v[164:167], v[56:59], v[140:143], v[164:167]
  v_mfma_f32_16x16x32_bf16 v[168:171], v[60:63], v[136:139], v[168:171]
  v_mfma_f32_16x16x32_bf16 v[172:175], v[60:63], v[140:143], v[172:175]
  s_branch pve_245
pvt_251:
  s_sub_u32 s55, s52, 1024
  s_cmp_lg_u32 s20, 0
  s_cbranch_scc1 wm_255
  s_mov_b32 s101, 0
wm_254:
  buffer_load_dword v26, v7, s[72:75], s55 offen sc1
  s_add_u32 s101, s101, 1
  s_cmp_gt_u32 s101, 131072
  s_cbranch_scc1 main_end
  s_waitcnt vmcnt(0)
  v_cmp_gt_u32 vcc, 4, v26
  v_readfirstlane_b32 s100, v26
  s_nop 0
  s_cbranch_vccz wm_255
  s_sleep 4
  s_add_u32 s100, s100, 3
  s_cmp_ge_u32 s100, 4
  s_cbranch_scc1 wm_254
  s_sleep 24
  s_branch wm_254
wm_255:
  s_barrier
  s_mov_b32 s56, s47
  s_mov_b32 s57, s48
  buffer_load_dwordx4 v[64:67], v4, s[16:19], s56 offen sc1
  buffer_load_dwordx2 v[68:69], v5, s[16:19], s56 offen offset:2048 sc1
  buffer_load_dwordx4 v[128:131], v21, s[16:19], s56 offen offset:1024 sc1
  buffer_load_dwordx4 v[132:135], v21, s[16:19], s56 offen offset:1280 sc1
  s_add_u32 s56, s56, 2560
  buffer_load_dwordx4 v[72:75], v4, s[16:19], s56 offen sc1
  buffer_load_dwordx2 v[76:77], v5, s[16:19], s56 offen offset:2048 sc1
  s_add_u32 s56, s56, 2560
  buffer_load_dwordx4 v[80:83], v4, s[16:19], s56 offen sc1
  buffer_load_dwordx2 v[84:85], v5, s[16:19], s56 offen offset:2048 sc1
  s_add_u32 s56, s56, 2560
  buffer_load_dwordx4 v[88:91], v4, s[16:19], s56 offen sc1
  buffer_load_dwordx2 v[92:93], v5, s[16:19], s56 offen offset:2048 sc1
  s_add_u32 s56, s56, 2560
  buffer_load_dwordx4 v[32:35], v22, s[16:19], s57 offen offset:0 sc1
  buffer_load_dwordx4 v[36:39], v22, s[16:19], s57 offen offset:256 sc1
  buffer_load_dwordx4 v[40:43], v22, s[16:19], s57 offen offset:512 sc1
  buffer_load_dwordx4 v[44:47], v22, s[16:19], s57 offen offset:768 sc1
  s_add_u32 s57, s57, 40960
  buffer_load_dwordx4 v[96:99], v4, s[16:19], s56 offen sc1
  buffer_load_dwordx2 v[100:101], v5, s[16:19], s56 offen offset:2048 sc1
  buffer_load_dwordx4 v[136:139], v21, s[16:19], s56 offen offset:1024 sc1
  buffer_load_dwordx4 v[140:143], v21, s[16:19], s56 offen offset:1280 sc1
  s_add_u32 s56, s56, 2560
  buffer_load_dwordx4 v[104:107], v4, s[16:19], s56 offen sc1
  buffer_load_dwordx2 v[108:109], v5, s[16:19], s56 offen offset:2048 sc1
  s_add_u32 s56, s56, 2560
  buffer_load_dwordx4 v[112:115], v4, s[16:19], s56 offen sc1
  buffer_load_dwordx2 v[116:117], v5, s[16:19], s56 offen offset:2048 sc1
  s_add_u32 s56, s56, 2560
  buffer_load_dwordx4 v[120:123], v4, s[16:19], s56 offen sc1
  buffer_load_dwordx2 v[124:125], v5, s[16:19], s56 offen offset:2048 sc1
  s_add_u32 s56, s56, 2560
  buffer_load_dwordx4 v[48:51], v22, s[16:19], s57 offen offset:0 sc1
  buffer_load_dwordx4 v[52:55], v22, s[16:19], s57 offen offset:256 sc1
  buffer_load_dwordx4 v[56:59], v22, s[16:19], s57 offen offset:512 sc1
  buffer_load_dwordx4 v[60:63], v22, s[16:19], s57 offen offset:768 sc1
  s_add_u32 s57, s57, 40960
pvc_250:
  s_mov_b32 s101, 0
  s_waitcnt vmcnt(14)
  s_branch pvr_257
pvr_256:
  s_sleep 2
  s_add_u32 s56, s47, 0
  s_add_u32 s57, s48, 0
  buffer_load_dwordx4 v[64:67], v4, s[16:19], s56 offen sc1
  buffer_load_dwordx2 v[68:69], v5, s[16:19], s56 offen offset:2048 sc1
  buffer_load_dwordx4 v[128:131], v21, s[16:19], s56 offen offset:1024 sc1
  buffer_load_dwordx4 v[132:135], v21, s[16:19], s56 offen offset:1280 sc1
  s_add_u32 s56, s56, 2560
  buffer_load_dwordx4 v[72:75], v4, s[16:19], s56 offen sc1
  buffer_load_dwordx2 v[76:77], v5, s[16:19], s56 offen offset:2048 sc1
  s_add_u32 s56, s56, 2560
  buffer_load_dwordx4 v[80:83], v4, s[16:19], s56 offen sc1
  buffer_load_dwordx2 v[84:85], v5, s[16:19], s56 offen offset:2048 sc1
  s_add_u32 s56, s56, 2560
  buffer_load_dwordx4 v[88:91], v4, s[16:19], s56 offen sc1
  buffer_load_dwordx2 v[92:93], v5, s[16:19], s56 offen offset:2048 sc1
  s_add_u32 s56, s56, 2560
  buffer_load_dwordx4 v[32:35], v22, s[16:19], s57 offen offset:0 sc1
  buffer_load_dwordx4 v[36:39], v22, s[16:19], s57 offen offset:256 sc1
  buffer_load_dwordx4 v[40:43], v22, s[16:19], s57 offen offset:512 sc1
  buffer_load_dwordx4 v[44:47], v22, s[16:19], s57 offen offset:768 sc1
  s_add_u32 s57, s57, 40960
  s_add_u32 s101, s101, 1
  s_cmp_gt_u32 s101, 131072
  s_cbranch_scc1 main_end
  s_waitcnt vmcnt(0)
pvr_257:
  v_max3_u32 v26, v64, v68, v72
  v_max3_u32 v26, v26, v76, v80
  v_max3_u32 v26, v26, v84, v88
  v_max3_u32 v26, v26, v92, v128
  v_max3_u32 v26, v26, v132, v32
  v_max3_u32 v26, v26, v36, v40
  v_max3_u32 v26, v26, v44, v44
  v_cmp_eq_u32 vcc, -1, v26
  s_nop 1
  s_cbranch_vccnz pvr_256
  v_mfma_f32_16x16x32_bf16 v[148:151], a[0:3], v[64:67], 0
  v_mfma_f32_16x16x32_bf16 v[144:147], a[0:3], v[68:71], 0
  v_mfma_f32_16x16x32_bf16 v[156:159], a[4:7], v[64:67], 0
  v_mfma_f32_16x16x32_bf16 v[152:155], a[4:7], v[68:71], 0
  v_mfma_f32_16x16x32_bf16 v[164:167], a[8:11], v[64:67], 0
  v_mfma_f32_16x16x32_bf16 v[160:163], a[8:11], v[68:71], 0
  v_mfma_f32_16x16x32_bf16 v[172:175], a[12:15], v[64:67], 0
  v_mfma_f32_16x16x32_bf16 v[168:171], a[12:15], v[68:71], 0
  v_mfma_f32_16x16x32_bf16 v[148:151], a[16:19], v[72:75], v[148:151]
  v_mfma_f32_16x16x32_bf16 v[144:147], a[16:19], v[76:79], v[144:147]
  v_mfma_f32_16x16x32_bf16 v[156:159], a[20:23], v[72:75], v[156:159]
  v_mfma_f32_16x16x32_bf16 v[152:155], a[20:23], v[76:79], v[152:155]
  v_mfma_f32_16x16x32_bf16 v[164:167], a[24:27], v[72:75], v[164:167]
  v_mfma_f32_16x16x32_bf16 v[160:163], a[24:27], v[76:79], v[160:163]
  v_mfma_f32_16x16x32_bf16 v[172:175], a[28:31], v[72:75], v[172:175]
  v_mfma_f32_16x16x32_bf16 v[168:171], a[28:31], v[76:79], v[168:171]
  v_mfma_f32_16x16x32_bf16 v[148:151], a[32:35], v[80:83], v[148:151]
  v_mfma_f32_16x16x32_bf16 v[144:147], a[32:35], v[84:87], v[144:147]
  v_mfma_f32_16x16x32_bf16 v[156:159], a[36:39], v[80:83], v[156:159]
  v_mfma_f32_16x16x32_bf16 v[152:155], a[36:39], v[84:87], v[152:155]
  v_mfma_f32_16x16x32_bf16 v[164:167], a[40:43], v[80:83], v[164:167]
  v_mfma_f32_16x16x32_bf16 v[160:163], a[40:43], v[84:87], v[160:163]
  v_mfma_f32_16x16x32_bf16 v[172:175], a[44:47], v[80:83], v[172:175]
  v_mfma_f32_16x16x32_bf16 v[168:171], a[44:47], v[84:87], v[168:171]
  v_mfma_f32_16x16x32_bf16 v[148:151], a[48:51], v[88:91], v[148:151]
  v_mfma_f32_16x16x32_bf16 v[144:147], a[48:51], v[92:95], v[144:147]
  v_mfma_f32_16x16x32_bf16 v[156:159], a[52:55], v[88:91], v[156:159]
  v_mfma_f32_16x16x32_bf16 v[152:155], a[52:55], v[92:95], v[152:155]
  v_mfma_f32_16x16x32_bf16 v[164:167], a[56:59], v[88:91], v[164:167]
  v_mfma_f32_16x16x32_bf16 v[160:163], a[56:59], v[92:95], v[160:163]
  v_mfma_f32_16x16x32_bf16 v[172:175], a[60:63], v[88:91], v[172:175]
  v_mfma_f32_16x16x32_bf16 v[168:171], a[60:63], v[92:95], v[168:171]
  s_nop 1
  v_mfma_f32_16x16x32_bf16 v[144:147], v[32:35], v[128:131], v[144:147]
  v_mfma_f32_16x16x32_bf16 v[148:151], v[32:35], v[132:135], v[148:151]
  v_mfma_f32_16x16x32_bf16 v[152:155], v[36:39], v[128:131], v[152:155]
  v_mfma_f32_16x16x32_bf16 v[156:159], v[36:39], v[132:135], v[156:159]
  v_mfma_f32_16x16x32_bf16 v[160:163], v[40:43], v[128:131], v[160:163]
  v_mfma_f32_16x16x32_bf16 v[164:167], v[40:43], v[132:135], v[164:167]
  v_mfma_f32_16x16x32_bf16 v[168:171], v[44:47], v[128:131], v[168:171]
  v_mfma_f32_16x16x32_bf16 v[172:175], v[44:47], v[132:135], v[172:175]
  s_mov_b32 s101, 0
  s_waitcnt vmcnt(0)
  s_branch pvr_259
pvr_258:
  s_sleep 2
  s_add_u32 s56, s47, 10240
  s_add_u32 s57, s48, 40960
  buffer_load_dwordx4 v[96:99], v4, s[16:19], s56 offen sc1
  buffer_load_dwordx2 v[100:101], v5, s[16:19], s56 offen offset:2048 sc1
  buffer_load_dwordx4 v[136:139], v21, s[16:19], s56 offen offset:1024 sc1
  buffer_load_dwordx4 v[140:143], v21, s[16:19], s56 offen offset:1280 sc1
  s_add_u32 s56, s56, 2560
  buffer_load_dwordx4 v[104:107], v4, s[16:19], s56 offen sc1
  buffer_load_dwordx2 v[108:109], v5, s[16:19], s56 offen offset:2048 sc1
  s_add_u32 s56, s56, 2560
  buffer_load_dwordx4 v[112:115], v4, s[16:19], s56 offen sc1
  buffer_load_dwordx2 v[116:117], v5, s[16:19], s56 offen offset:2048 sc1
  s_add_u32 s56, s56, 2560
  buffer_load_dwordx4 v[120:123], v4, s[16:19], s56 offen sc1
  buffer_load_dwordx2 v[124:125], v5, s[16:19], s56 offen offset:2048 sc1
  s_add_u32 s56, s56, 2560
  buffer_load_dwordx4 v[48:51], v22, s[16:19], s57 offen offset:0 sc1
  buffer_load_dwordx4 v[52:55], v22, s[16:19], s57 offen offset:256 sc1
  buffer_load_dwordx4 v[56:59], v22, s[16:19], s57 offen offset:512 sc1
  buffer_load_dwordx4 v[60:63], v22, s[16:19], s57 offen offset:768 sc1
  s_add_u32 s57, s57, 40960
  s_add_u32 s101, s101, 1
  s_cmp_gt_u32 s101, 131072
  s_cbranch_scc1 main_end
  s_waitcnt vmcnt(0)
pvr_259:
  v_max3_u32 v26, v96, v100, v104
  v_max3_u32 v26, v26, v108, v112
  v_max3_u32 v26, v26, v116, v120
  v_max3_u32 v26, v26, v124, v136
  v_max3_u32 v26, v26, v140, v48
  v_max3_u32 v26, v26, v52, v56
  v_max3_u32 v26, v26, v60, v60
  v_cmp_eq_u32 vcc, -1, v26
  s_nop 1
  s_cbranch_vccnz pvr_258
  v_mfma_f32_16x16x32_bf16 v[148:151], a[64:67], v[96:99], v[148:151]
  v_mfma_f32_16x16x32_bf16 v[144:147], a[64:67], v[100:103], v[144:147]
  v_mfma_f32_16x16x32_bf16 v[156:159], a[68:71], v[96:99], v[156:159]
  v_mfma_f32_16x16x32_bf16 v[152:155], a[68:71], v[100:103], v[152:155]
  v_mfma_f32_16x16x32_bf16 v[164:167], a[72:75], v[96:99], v[164:167]
  v_mfma_f32_16x16x32_bf16 v[160:163], a[72:75], v[100:103], v[160:163]
  v_mfma_f32_16x16x32_bf16 v[172:175], a[76:79], v[96:99], v[172:175]
  v_mfma_f32_16x16x32_bf16 v[168:171], a[76:79], v[100:103], v[168:171]
  v_mfma_f32_16x16x32_bf16 v[148:151], a[80:83], v[104:107], v[148:151]
  v_mfma_f32_16x16x32_bf16 v[144:147], a[80:83], v[108:111], v[144:147]
  v_mfma_f32_16x16x32_bf16 v[156:159], a[84:87], v[104:107], v[156:159]
  v_mfma_f32_16x16x32_bf16 v[152:155], a[84:87], v[108:111], v[152:155]
  v_mfma_f32_16x16x32_bf16 v[164:167], a[88:91], v[104:107], v[164:167]
  v_mfma_f32_16x16x32_bf16 v[160:163], a[88:91], v[108:111], v[160:163]
  v_mfma_f32_16x16x32_bf16 v[172:175], a[92:95], v[104:107], v[172:175]
  v_mfma_f32_16x16x32_bf16 v[168:171], a[92:95], v[108:111], v[168:171]
  v_mfma_f32_16x16x32_bf16 v[148:151], a[96:99], v[112:115], v[148:151]
  v_mfma_f32_16x16x32_bf16 v[144:147], a[96:99], v[116:119], v[144:147]
  v_mfma_f32_16x16x32_bf16 v[156:159], a[100:103], v[112:115], v[156:159]
  v_mfma_f32_16x16x32_bf16 v[152:155], a[100:103], v[116:119], v[152:155]
  v_mfma_f32_16x16x32_bf16 v[164:167], a[104:107], v[112:115], v[164:167]
  v_mfma_f32_16x16x32_bf16 v[160:163], a[104:107], v[116:119], v[160:163]
  v_mfma_f32_16x16x32_bf16 v[172:175], a[108:111], v[112:115], v[172:175]
  v_mfma_f32_16x16x32_bf16 v[168:171], a[108:111], v[116:119], v[168:171]
  v_mfma_f32_16x16x32_bf16 v[148:151], a[112:115], v[120:123], v[148:151]
  v_mfma_f32_16x16x32_bf16 v[144:147], a[112:115], v[124:127], v[144:147]
  v_mfma_f32_16x16x32_bf16 v[156:159], a[116:119], v[120:123], v[156:159]
  v_mfma_f32_16x16x32_bf16 v[152:155], a[116:119], v[124:127], v[152:155]
  v_mfma_f32_16x16x32_bf16 v[164:167], a[120:123], v[120:123], v[164:167]
  v_mfma_f32_16x16x32_bf16 v[160:163], a[120:123], v[124:127], v[160:163]
  v_mfma_f32_16x16x32_bf16 v[172:175], a[124:127], v[120:123], v[172:175]
  v_mfma_f32_16x16x32_bf16 v[168:171], a[124:127], v[124:127], v[168:171]
  s_nop 1
  v_mfma_f32_16x16x32_bf16 v[144:147], v[48:51], v[136:139], v[144:147]
  v_mfma_f32_16x16x32_bf16 v[148:151], v[48:51], v[140:143], v[148:151]
  v_mfma_f32_16x16x32_bf16 v[152:155], v[52:55], v[136:139], v[152:155]
  v_mfma_f32_16x16x32_bf16 v[156:159], v[52:55], v[140:143], v[156:159]
  v_mfma_f32_16x16x32_bf16 v[160:163], v[56:59], v[136:139], v[160:163]
  v_mfma_f32_16x16x32_bf16 v[164:167], v[56:59], v[140:143], v[164:167]
  v_mfma_f32_16x16x32_bf16 v[168:171], v[60:63], v[136:139], v[168:171]
  v_mfma_f32_16x16x32_bf16 v[172:175], v[60:63], v[140:143], v[172:175]
pve_245:
  s_nop 0
  s_cmp_eq_u32 s65, 0
  s_cbranch_scc1 pvx_260
  s_add_u32 s41, s41, 1
  s_mul_i32 s53, s42, 40960
  s_lshl_b32 s22, s41, 12
  s_add_u32 s53, s53, s22
  s_mul_i32 s48, s42, 10240
  s_lshl_b32 s22, s41, 10
  s_add_u32 s48, s48, s22
  s_add_u32 s48, s48, 7340032
  buffer_load_dwordx4 v[32:35], v22, s[16:19], s48 offen offset:0 sc1
  buffer_load_dwordx4 v[36:39], v22, s[16:19], s48 offen offset:256 sc1
  buffer_load_dwordx4 v[40:43], v22, s[16:19], s48 offen offset:512 sc1
  buffer_load_dwordx4 v[44:47], v22, s[16:19], s48 offen offset:768 sc1
  s_add_u32 s48, s48, 40960
  buffer_load_dwordx4 v[48:51], v22, s[16:19], s48 offen offset:0 sc1
  buffer_load_dwordx4 v[52:55], v22, s[16:19], s48 offen offset:256 sc1
  buffer_load_dwordx4 v[56:59], v22, s[16:19], s48 offen offset:512 sc1
  buffer_load_dwordx4 v[60:63], v22, s[16:19], s48 offen offset:768 sc1
  s_add_u32 s48, s48, 40960
  buffer_load_dwordx4 a[0:3], v4, s[12:15], s53 offen offset:0 sc1
  buffer_load_dwordx4 a[4:7], v4, s[12:15], s53 offen offset:1024 sc1
  buffer_load_dwordx4 a[8:11], v4, s[12:15], s53 offen offset:2048 sc1
  buffer_load_dwordx4 a[12:15], v4, s[12:15], s53 offen offset:3072 sc1
  s_add_u32 s53, s53, 40960
  buffer_load_dwordx4 a[16:19], v4, s[12:15], s53 offen offset:0 sc1
  buffer_load_dwordx4 a[20:23], v4, s[12:15], s53 offen offset:1024 sc1
  buffer_load_dwordx4 a[24:27], v4, s[12:15], s53 offen offset:2048 sc1
  buffer_load_dwordx4 a[28:31], v4, s[12:15], s53 offen offset:3072 sc1
  s_add_u32 s53, s53, 40960
  buffer_load_dwordx4 a[32:35], v4, s[12:15], s53 offen offset:0 sc1
  buffer_load_dwordx4 a[36:39], v4, s[12:15], s53 offen offset:1024 sc1
  buffer_load_dwordx4 a[40:43], v4, s[12:15], s53 offen offset:2048 sc1
  buffer_load_dwordx4 a[44:47], v4, s[12:15], s53 offen offset:3072 sc1
  s_add_u32 s53, s53, 40960
  buffer_load_dwordx4 a[48:51], v4, s[12:15], s53 offen offset:0 sc1
  buffer_load_dwordx4 a[52:55], v4, s[12:15], s53 offen offset:1024 sc1
  buffer_load_dwordx4 a[56:59], v4, s[12:15], s53 offen offset:2048 sc1
  buffer_load_dwordx4 a[60:63], v4, s[12:15], s53 offen offset:3072 sc1
  s_add_u32 s53, s53, 40960
  buffer_load_dwordx4 a[64:67], v4, s[12:15], s53 offen offset:0 sc1
  buffer_load_dwordx4 a[68:71], v4, s[12:15], s53 offen offset:1024 sc1
  buffer_load_dwordx4 a[72:75], v4, s[12:15], s53 offen offset:2048 sc1
  buffer_load_dwordx4 a[76:79], v4, s[12:15], s53 offen offset:3072 sc1
  s_add_u32 s53, s53, 40960
  buffer_load_dwordx4 a[80:83], v4, s[12:15], s53 offen offset:0 sc1
  buffer_load_dwordx4 a[84:87], v4, s[12:15], s53 offen offset:1024 sc1
  buffer_load_dwordx4 a[88:91], v4, s[12:15], s53 offen offset:2048 sc1
  buffer_load_dwordx4 a[92:95], v4, s[12:15], s53 offen offset:3072 sc1
  s_add_u32 s53, s53, 40960
  buffer_load_dwordx4 a[96:99], v4, s[12:15], s53 offen offset:0 sc1
  buffer_load_dwordx4 a[100:103], v4, s[12:15], s53 offen offset:1024 sc1
  buffer_load_dwordx4 a[104:107], v4, s[12:15], s53 offen offset:2048 sc1
  buffer_load_dwordx4 a[108:111], v4, s[12:15], s53 offen offset:3072 sc1
  s_add_u32 s53, s53, 40960
  buffer_load_dwordx4 a[112:115], v4, s[12:15], s53 offen offset:0 sc1
  buffer_load_dwordx4 a[116:119], v4, s[12:15], s53 offen offset:1024 sc1
  buffer_load_dwordx4 a[120:123], v4, s[12:15], s53 offen offset:2048 sc1
  buffer_load_dwordx4 a[124:127], v4, s[12:15], s53 offen offset:3072 sc1
pvx_260:
  s_cmp_lg_u32 s20, 0
  s_cbranch_scc1 lc_261
  s_sub_u32 s21, s2, 450
  s_cmp_ge_u32 s21, 190
  s_cbranch_scc1 lc_261
  v_mov_b32 v29, 1
  s_mov_b64 exec, 1
  buffer_atomic_add v29, v28, s[32:35], 0 offen sc0 sc1
  s_mov_b64 exec, -1
lc_261:
  ds_write_b128 v10, v[144:147] offset:0
  ds_write_b128 v10, v[148:151] offset:1024
  ds_write_b128 v10, v[152:155] offset:2048
  ds_write_b128 v10, v[156:159] offset:3072
  ds_write_b128 v10, v[160:163] offset:4096
  ds_write_b128 v10, v[164:167] offset:5120
  ds_write_b128 v10, v[168:171] offset:6144
  ds_write_b128 v10, v[172:175] offset:7168
  s_cmp_lg_u32 s20, 0
  s_cbranch_scc1 pvq_264
  v_readfirstlane_b32 s21, v29
  s_mov_b32 s23, -1
  v_mov_b32 v213, s23
  s_mov_b64 exec, 1
  ds_write_b32 v30, v29
  ds_write_b32 v30, v213 offset:8
  s_mov_b64 exec, -1
pvq_264:
  s_waitcnt lgkmcnt(0)
  s_barrier
  ds_read_b128 v[176:179], v11 offset:0
  ds_read_b128 v[180:183], v11 offset:8192
  ds_read_b128 v[184:187], v11 offset:16384
  ds_read_b128 v[188:191], v11 offset:24576
  ds_read_b128 v[192:195], v11 offset:4096
  ds_read_b128 v[196:199], v11 offset:12288
  ds_read_b128 v[200:203], v11 offset:20480
  ds_read_b128 v[204:207], v11 offset:28672
  ds_read_b32 v23, v30
  ds_read_b32 v213, v30 offset:8
  s_waitcnt lgkmcnt(6)
  v_pk_add_f32 v[176:177], v[176:177], v[180:181]
  v_pk_add_f32 v[184:185], v[184:185], v[188:189]
  v_pk_add_f32 v[178:179], v[178:179], v[182:183]
  v_pk_add_f32 v[186:187], v[186:187], v[190:191]
  v_pk_add_f32 v[176:177], v[176:177], v[184:185]
  v_pk_add_f32 v[178:179], v[178:179], v[186:187]
  v_cvt_pk_bf16_f32 v26, v176, v177
  v_lshlrev_b32 v176, 16, v26
  v_and_b32 v177, 0xffff0000, v26
  v_mul_f32 v176, v176, v24
  v_mul_f32 v177, v177, v24
  v_cvt_pk_bf16_f32 v26, v176, v177
  v_lshlrev_b32 v176, 16, v26
  v_and_b32 v177, 0xffff0000, v26
  v_add_f32 v176, v176, v12
  v_add_f32 v177, v177, v13
  v_cvt_pk_bf16_f32 v180, v176, v177
  v_cvt_pk_bf16_f32 v26, v178, v179
  v_lshlrev_b32 v178, 16, v26
  v_and_b32 v179, 0xffff0000, v26
  v_mul_f32 v178, v178, v24
  v_mul_f32 v179, v179, v24
  v_cvt_pk_bf16_f32 v26, v178, v179
  v_lshlrev_b32 v178, 16, v26
  v_and_b32 v179, 0xffff0000, v26
  v_add_f32 v178, v178, v14
  v_add_f32 v179, v179, v15
  v_cvt_pk_bf16_f32 v181, v178, v179
  buffer_store_dwordx2 v[180:181], v9, s[8:11], s46 offen offset:0
  s_waitcnt lgkmcnt(2)
  v_pk_add_f32 v[192:193], v[192:193], v[196:197]
  v_pk_add_f32 v[200:201], v[200:201], v[204:205]
  v_pk_add_f32 v[194:195], v[194:195], v[198:199]
  v_pk_add_f32 v[202:203], v[202:203], v[206:207]
  v_pk_add_f32 v[192:193], v[192:193], v[200:201]
  v_pk_add_f32 v[194:195], v[194:195], v[202:203]
  v_cvt_pk_bf16_f32 v26, v192, v193
  v_lshlrev_b32 v192, 16, v26
  v_and_b32 v193, 0xffff0000, v26
  v_mul_f32 v192, v192, v24
  v_mul_f32 v193, v193, v24
  v_cvt_pk_bf16_f32 v26, v192, v193
  v_lshlrev_b32 v192, 16, v26
  v_and_b32 v193, 0xffff0000, v26
  v_add_f32 v192, v192, v16
  v_add_f32 v193, v193, v17
  v_cvt_pk_bf16_f32 v196, v192, v193
  v_cvt_pk_bf16_f32 v26, v194, v195
  v_lshlrev_b32 v194, 16, v26
  v_and_b32 v195, 0xffff0000, v26
  v_mul_f32 v194, v194, v24
  v_mul_f32 v195, v195, v24
  v_cvt_pk_bf16_f32 v26, v194, v195
  v_lshlrev_b32 v194, 16, v26
  v_and_b32 v195, 0xffff0000, v26
  v_add_f32 v194, v194, v18
  v_add_f32 v195, v195, v19
  v_cvt_pk_bf16_f32 v197, v194, v195
  buffer_store_dwordx2 v[196:197], v9, s[8:11], s46 offen offset:64
pvy_267:
  s_cmp_eq_u32 s65, 0
  s_cbranch_scc1 pvy_268
  s_sub_u32 s65, s65, 1
  s_add_u32 s46, s46, 128
  s_add_u32 s54, s54, 4096
  buffer_load_dwordx4 v[12:15], v4, s[24:27], s54 offen sc1
  buffer_load_dwordx4 v[16:19], v4, s[24:27], s54 offen offset:2048 sc1
  buffer_load_dword v24, v6, s[28:31], s45 offen sc1
  s_waitcnt vmcnt(37) lgkmcnt(0)
  s_barrier
  s_nop 1
  v_mfma_f32_16x16x32_bf16 v[144:147], v[32:35], v[128:131], 0
  v_mfma_f32_16x16x32_bf16 v[148:151], v[32:35], v[132:135], 0
  v_mfma_f32_16x16x32_bf16 v[152:155], v[36:39], v[128:131], 0
  v_mfma_f32_16x16x32_bf16 v[156:159], v[36:39], v[132:135], 0
  v_mfma_f32_16x16x32_bf16 v[160:163], v[40:43], v[128:131], 0
  v_mfma_f32_16x16x32_bf16 v[164:167], v[40:43], v[132:135], 0
  v_mfma_f32_16x16x32_bf16 v[168:171], v[44:47], v[128:131], 0
  v_mfma_f32_16x16x32_bf16 v[172:175], v[44:47], v[132:135], 0
  v_mfma_f32_16x16x32_bf16 v[144:147], v[48:51], v[136:139], v[144:147]
  v_mfma_f32_16x16x32_bf16 v[148:151], v[48:51], v[140:143], v[148:151]
  v_mfma_f32_16x16x32_bf16 v[152:155], v[52:55], v[136:139], v[152:155]
  v_mfma_f32_16x16x32_bf16 v[156:159], v[52:55], v[140:143], v[156:159]
  v_mfma_f32_16x16x32_bf16 v[160:163], v[56:59], v[136:139], v[160:163]
  v_mfma_f32_16x16x32_bf16 v[164:167], v[56:59], v[140:143], v[164:167]
  v_mfma_f32_16x16x32_bf16 v[168:171], v[60:63], v[136:139], v[168:171]
  v_mfma_f32_16x16x32_bf16 v[172:175], v[60:63], v[140:143], v[172:175]
  s_waitcnt vmcnt(33)
  v_mfma_f32_16x16x32_bf16 v[148:151], a[0:3], v[64:67], v[148:151]
  v_mfma_f32_16x16x32_bf16 v[144:147], a[0:3], v[68:71], v[144:147]
  v_mfma_f32_16x16x32_bf16 v[156:159], a[4:7], v[64:67], v[156:159]
  v_mfma_f32_16x16x32_bf16 v[152:155], a[4:7], v[68:71], v[152:155]
  v_mfma_f32_16x16x32_bf16 v[164:167], a[8:11], v[64:67], v[164:167]
  v_mfma_f32_16x16x32_bf16 v[160:163], a[8:11], v[68:71], v[160:163]
  v_mfma_f32_16x16x32_bf16 v[172:175], a[12:15], v[64:67], v[172:175]
  v_mfma_f32_16x16x32_bf16 v[168:171], a[12:15], v[68:71], v[168:171]
  s_waitcnt vmcnt(29)
  v_mfma_f32_16x16x32_bf16 v[148:151], a[16:19], v[72:75], v[148:151]
  v_mfma_f32_16x16x32_bf16 v[144:147], a[16:19], v[76:79], v[144:147]
  v_mfma_f32_16x16x32_bf16 v[156:159], a[20:23], v[72:75], v[156:159]
  v_mfma_f32_16x16x32_bf16 v[152:155], a[20:23], v[76:79], v[152:155]
  v_mfma_f32_16x16x32_bf16 v[164:167], a[24:27], v[72:75], v[164:167]
  v_mfma_f32_16x16x32_bf16 v[160:163], a[24:27], v[76:79], v[160:163]
  v_mfma_f32_16x16x32_bf16 v[172:175], a[28:31], v[72:75], v[172:175]
  v_mfma_f32_16x16x32_bf16 v[168:171], a[28:31], v[76:79], v[168:171]
  s_waitcnt vmcnt(25)
  v_mfma_f32_16x16x32_bf16 v[148:151], a[32:35], v[80:83], v[148:151]
  v_mfma_f32_16x16x32_bf16 v[144:147], a[32:35], v[84:87], v[144:147]
  v_mfma_f32_16x16x32_bf16 v[156:159], a[36:39], v[80:83], v[156:159]
  v_mfma_f32_16x16x32_bf16 v[152:155], a[36:39], v[84:87], v[152:155]
  v_mfma_f32_16x16x32_bf16 v[164:167], a[40:43], v[80:83], v[164:167]
  v_mfma_f32_16x16x32_bf16 v[160:163], a[40:43], v[84:87], v[160:163]
  v_mfma_f32_16x16x32_bf16 v[172:175], a[44:47], v[80:83], v[172:175]
  v_mfma_f32_16x16x32_bf16 v[168:171], a[44:47], v[84:87], v[168:171]
  s_waitcnt vmcnt(21)
  v_mfma_f32_16x16x32_bf16 v[148:151], a[48:51], v[88:91], v[148:151]
  v_mfma_f32_16x16x32_bf16 v[144:147], a[48:51], v[92:95], v[144:147]
  v_mfma_f32_16x16x32_bf16 v[156:159], a[52:55], v[88:91], v[156:159]
  v_mfma_f32_16x16x32_bf16 v[152:155], a[52:55], v[92:95], v[152:155]
  v_mfma_f32_16x16x32_bf16 v[164:167], a[56:59], v[88:91], v[164:167]
  v_mfma_f32_16x16x32_bf16 v[160:163], a[56:59], v[92:95], v[160:163]
  v_mfma_f32_16x16x32_bf16 v[172:175], a[60:63], v[88:91], v[172:175]
  v_mfma_f32_16x16x32_bf16 v[168:171], a[60:63], v[92:95], v[168:171]
  s_waitcnt vmcnt(17)
  v_mfma_f32_16x16x32_bf16 v[148:151], a[64:67], v[96:99], v[148:151]
  v_mfma_f32_16x16x32_bf16 v[144:147], a[64:67], v[100:103], v[144:147]
  v_mfma_f32_16x16x32_bf16 v[156:159], a[68:71], v[96:99], v[156:159]
  v_mfma_f32_16x16x32_bf16 v[152:155], a[68:71], v[100:103], v[152:155]
  v_mfma_f32_16x16x32_bf16 v[164:167], a[72:75], v[96:99], v[164:167]
  v_mfma_f32_16x16x32_bf16 v[160:163], a[72:75], v[100:103], v[160:163]
  v_mfma_f32_16x16x32_bf16 v[172:175], a[76:79], v[96:99], v[172:175]
  v_mfma_f32_16x16x32_bf16 v[168:171], a[76:79], v[100:103], v[168:171]
  s_waitcnt vmcnt(13)
  v_mfma_f32_16x16x32_bf16 v[148:151], a[80:83], v[104:107], v[148:151]
  v_mfma_f32_16x16x32_bf16 v[144:147], a[80:83], v[108:111], v[144:147]
  v_mfma_f32_16x16x32_bf16 v[156:159], a[84:87], v[104:107], v[156:159]
  v_mfma_f32_16x16x32_bf16 v[152:155], a[84:87], v[108:111], v[152:155]
  v_mfma_f32_16x16x32_bf16 v[164:167], a[88:91], v[104:107], v[164:167]
  v_mfma_f32_16x16x32_bf16 v[160:163], a[88:91], v[108:111], v[160:163]
  v_mfma_f32_16x16x32_bf16 v[172:175], a[92:95], v[104:107], v[172:175]
  v_mfma_f32_16x16x32_bf16 v[168:171], a[92:95], v[108:111], v[168:171]
  s_waitcnt vmcnt(9)
  v_mfma_f32_16x16x32_bf16 v[148:151], a[96:99], v[112:115], v[148:151]
  v_mfma_f32_16x16x32_bf16 v[144:147], a[96:99], v[116:119], v[144:147]
  v_mfma_f32_16x16x32_bf16 v[156:159], a[100:103], v[112:115], v[156:159]
  v_mfma_f32_16x16x32_bf16 v[152:155], a[100:103], v[116:119], v[152:155]
  v_mfma_f32_16x16x32_bf16 v[164:167], a[104:107], v[112:115], v[164:167]
  v_mfma_f32_16x16x32_bf16 v[160:163], a[104:107], v[116:119], v[160:163]
  v_mfma_f32_16x16x32_bf16 v[172:175], a[108:111], v[112:115], v[172:175]
  v_mfma_f32_16x16x32_bf16 v[168:171], a[108:111], v[116:119], v[168:171]
  s_waitcnt vmcnt(5)
  v_mfma_f32_16x16x32_bf16 v[148:151], a[112:115], v[120:123], v[148:151]
  v_mfma_f32_16x16x32_bf16 v[144:147], a[112:115], v[124:127], v[144:147]
  v_mfma_f32_16x16x32_bf16 v[156:159], a[116:119], v[120:123], v[156:159]
  v_mfma_f32_16x16x32_bf16 v[152:155], a[116:119], v[124:127], v[152:155]
  v_mfma_f32_16x16x32_bf16 v[164:167], a[120:123], v[120:123], v[164:167]
  v_mfma_f32_16x16x32_bf16 v[160:163], a[120:123], v[124:127], v[160:163]
  v_mfma_f32_16x16x32_bf16 v[172:175], a[124:127], v[120:123], v[172:175]
  v_mfma_f32_16x16x32_bf16 v[168:171], a[124:127], v[124:127], v[168:171]
  s_waitcnt vmcnt(0)
  v_sub_f32 v25, 1.0, v24
  v_cvt_pk_bf16_f32 v26, v25, v25
  v_lshlrev_b32 v25, 16, v26
  v_cvt_pk_bf16_f32 v26, v12, v12
  v_lshlrev_b32 v12, 16, v26
  v_cvt_pk_bf16_f32 v26, v13, v13
  v_lshlrev_b32 v13, 16, v26
  v_cvt_pk_bf16_f32 v26, v14, v14
  v_lshlrev_b32 v14, 16, v26
  v_cvt_pk_bf16_f32 v26, v15, v15
  v_lshlrev_b32 v15, 16, v26
  v_cvt_pk_bf16_f32 v26, v16, v16
  v_lshlrev_b32 v16, 16, v26
  v_cvt_pk_bf16_f32 v26, v17, v17
  v_lshlrev_b32 v17, 16, v26
  v_cvt_pk_bf16_f32 v26, v18, v18
  v_lshlrev_b32 v18, 16, v26
  v_cvt_pk_bf16_f32 v26, v19, v19
  v_lshlrev_b32 v19, 16, v26
  v_mul_f32 v12, v12, v25
  v_cvt_pk_bf16_f32 v26, v12, v12
  v_lshlrev_b32 v12, 16, v26
  v_mul_f32 v13, v13, v25
  v_cvt_pk_bf16_f32 v26, v13, v13
  v_lshlrev_b32 v13, 16, v26
  v_mul_f32 v14, v14, v25
  v_cvt_pk_bf16_f32 v26, v14, v14
  v_lshlrev_b32 v14, 16, v26
  v_mul_f32 v15, v15, v25
  v_cvt_pk_bf16_f32 v26, v15, v15
  v_lshlrev_b32 v15, 16, v26
  v_mul_f32 v16, v16, v25
  v_cvt_pk_bf16_f32 v26, v16, v16
  v_lshlrev_b32 v16, 16, v26
  v_mul_f32 v17, v17, v25
  v_cvt_pk_bf16_f32 v26, v17, v17
  v_lshlrev_b32 v17, 16, v26
  v_mul_f32 v18, v18, v25
  v_cvt_pk_bf16_f32 v26, v18, v18
  v_lshlrev_b32 v18, 16, v26
  v_mul_f32 v19, v19, v25
  v_cvt_pk_bf16_f32 v26, v19, v19
  v_lshlrev_b32 v19, 16, v26
  s_cmp_eq_u32 s65, 0
  s_cbranch_scc1 pvx_269
  s_add_u32 s41, s41, 1
  s_mul_i32 s53, s42, 40960
  s_lshl_b32 s22, s41, 12
  s_add_u32 s53, s53, s22
  s_mul_i32 s48, s42, 10240
  s_lshl_b32 s22, s41, 10
  s_add_u32 s48, s48, s22
  s_add_u32 s48, s48, 7340032
  buffer_load_dwordx4 v[32:35], v22, s[16:19], s48 offen offset:0 sc1
  buffer_load_dwordx4 v[36:39], v22, s[16:19], s48 offen offset:256 sc1
  buffer_load_dwordx4 v[40:43], v22, s[16:19], s48 offen offset:512 sc1
  buffer_load_dwordx4 v[44:47], v22, s[16:19], s48 offen offset:768 sc1
  s_add_u32 s48, s48, 40960
  buffer_load_dwordx4 v[48:51], v22, s[16:19], s48 offen offset:0 sc1
  buffer_load_dwordx4 v[52:55], v22, s[16:19], s48 offen offset:256 sc1
  buffer_load_dwordx4 v[56:59], v22, s[16:19], s48 offen offset:512 sc1
  buffer_load_dwordx4 v[60:63], v22, s[16:19], s48 offen offset:768 sc1
  s_add_u32 s48, s48, 40960
  buffer_load_dwordx4 a[0:3], v4, s[12:15], s53 offen offset:0 sc1
  buffer_load_dwordx4 a[4:7], v4, s[12:15], s53 offen offset:1024 sc1
  buffer_load_dwordx4 a[8:11], v4, s[12:15], s53 offen offset:2048 sc1
  buffer_load_dwordx4 a[12:15], v4, s[12:15], s53 offen offset:3072 sc1
  s_add_u32 s53, s53, 40960
  buffer_load_dwordx4 a[16:19], v4, s[12:15], s53 offen offset:0 sc1
  buffer_load_dwordx4 a[20:23], v4, s[12:15], s53 offen offset:1024 sc1
  buffer_load_dwordx4 a[24:27], v4, s[12:15], s53 offen offset:2048 sc1
  buffer_load_dwordx4 a[28:31], v4, s[12:15], s53 offen offset:3072 sc1
  s_add_u32 s53, s53, 40960
  buffer_load_dwordx4 a[32:35], v4, s[12:15], s53 offen offset:0 sc1
  buffer_load_dwordx4 a[36:39], v4, s[12:15], s53 offen offset:1024 sc1
  buffer_load_dwordx4 a[40:43], v4, s[12:15], s53 offen offset:2048 sc1
  buffer_load_dwordx4 a[44:47], v4, s[12:15], s53 offen offset:3072 sc1
  s_add_u32 s53, s53, 40960
  buffer_load_dwordx4 a[48:51], v4, s[12:15], s53 offen offset:0 sc1
  buffer_load_dwordx4 a[52:55], v4, s[12:15], s53 offen offset:1024 sc1
  buffer_load_dwordx4 a[56:59], v4, s[12:15], s53 offen offset:2048 sc1
  buffer_load_dwordx4 a[60:63], v4, s[12:15], s53 offen offset:3072 sc1
  s_add_u32 s53, s53, 40960
  buffer_load_dwordx4 a[64:67], v4, s[12:15], s53 offen offset:0 sc1
  buffer_load_dwordx4 a[68:71], v4, s[12:15], s53 offen offset:1024 sc1
  buffer_load_dwordx4 a[72:75], v4, s[12:15], s53 offen offset:2048 sc1
  buffer_load_dwordx4 a[76:79], v4, s[12:15], s53 offen offset:3072 sc1
  s_add_u32 s53, s53, 40960
  buffer_load_dwordx4 a[80:83], v4, s[12:15], s53 offen offset:0 sc1
  buffer_load_dwordx4 a[84:87], v4, s[12:15], s53 offen offset:1024 sc1
  buffer_load_dwordx4 a[88:91], v4, s[12:15], s53 offen offset:2048 sc1
  buffer_load_dwordx4 a[92:95], v4, s[12:15], s53 offen offset:3072 sc1
  s_add_u32 s53, s53, 40960
  buffer_load_dwordx4 a[96:99], v4, s[12:15], s53 offen offset:0 sc1
  buffer_load_dwordx4 a[100:103], v4, s[12:15], s53 offen offset:1024 sc1
  buffer_load_dwordx4 a[104:107], v4, s[12:15], s53 offen offset:2048 sc1
  buffer_load_dwordx4 a[108:111], v4, s[12:15], s53 offen offset:3072 sc1
  s_add_u32 s53, s53, 40960
  buffer_load_dwordx4 a[112:115], v4, s[12:15], s53 offen offset:0 sc1
  buffer_load_dwordx4 a[116:119], v4, s[12:15], s53 offen offset:1024 sc1
  buffer_load_dwordx4 a[120:123], v4, s[12:15], s53 offen offset:2048 sc1
  buffer_load_dwordx4 a[124:127], v4, s[12:15], s53 offen offset:3072 sc1
pvx_269:
  ds_write_b128 v10, v[144:147] offset:0
  ds_write_b128 v10, v[148:151] offset:1024
  ds_write_b128 v10, v[152:155] offset:2048
  ds_write_b128 v10, v[156:159] offset:3072
  ds_write_b128 v10, v[160:163] offset:4096
  ds_write_b128 v10, v[164:167] offset:5120
  ds_write_b128 v10, v[168:171] offset:6144
  ds_write_b128 v10, v[172:175] offset:7168
  s_waitcnt lgkmcnt(0)
  s_barrier
  ds_read_b128 v[176:179], v11 offset:0
  ds_read_b128 v[180:183], v11 offset:8192
  ds_read_b128 v[184:187], v11 offset:16384
  ds_read_b128 v[188:191], v11 offset:24576
  ds_read_b128 v[192:195], v11 offset:4096
  ds_read_b128 v[196:199], v11 offset:12288
  ds_read_b128 v[200:203], v11 offset:20480
  ds_read_b128 v[204:207], v11 offset:28672
  s_waitcnt lgkmcnt(4)
  v_pk_add_f32 v[176:177], v[176:177], v[180:181]
  v_pk_add_f32 v[184:185], v[184:185], v[188:189]
  v_pk_add_f32 v[178:179], v[178:179], v[182:183]
  v_pk_add_f32 v[186:187], v[186:187], v[190:191]
  v_pk_add_f32 v[176:177], v[176:177], v[184:185]
  v_pk_add_f32 v[178:179], v[178:179], v[186:187]
  v_cvt_pk_bf16_f32 v26, v176, v177
  v_lshlrev_b32 v176, 16, v26
  v_and_b32 v177, 0xffff0000, v26
  v_mul_f32 v176, v176, v24
  v_mul_f32 v177, v177, v24
  v_cvt_pk_bf16_f32 v26, v176, v177
  v_lshlrev_b32 v176, 16, v26
  v_and_b32 v177, 0xffff0000, v26
  v_add_f32 v176, v176, v12
  v_add_f32 v177, v177, v13
  v_cvt_pk_bf16_f32 v180, v176, v177
  v_cvt_pk_bf16_f32 v26, v178, v179
  v_lshlrev_b32 v178, 16, v26
  v_and_b32 v179, 0xffff0000, v26
  v_mul_f32 v178, v178, v24
  v_mul_f32 v179, v179, v24
  v_cvt_pk_bf16_f32 v26, v178, v179
  v_lshlrev_b32 v178, 16, v26
  v_and_b32 v179, 0xffff0000, v26
  v_add_f32 v178, v178, v14
  v_add_f32 v179, v179, v15
  v_cvt_pk_bf16_f32 v181, v178, v179
  buffer_store_dwordx2 v[180:181], v9, s[8:11], s46 offen offset:0
  s_waitcnt lgkmcnt(0)
  v_pk_add_f32 v[192:193], v[192:193], v[196:197]
  v_pk_add_f32 v[200:201], v[200:201], v[204:205]
  v_pk_add_f32 v[194:195], v[194:195], v[198:199]
  v_pk_add_f32 v[202:203], v[202:203], v[206:207]
  v_pk_add_f32 v[192:193], v[192:193], v[200:201]
  v_pk_add_f32 v[194:195], v[194:195], v[202:203]
  v_cvt_pk_bf16_f32 v26, v192, v193
  v_lshlrev_b32 v192, 16, v26
  v_and_b32 v193, 0xffff0000, v26
  v_mul_f32 v192, v192, v24
  v_mul_f32 v193, v193, v24
  v_cvt_pk_bf16_f32 v26, v192, v193
  v_lshlrev_b32 v192, 16, v26
  v_and_b32 v193, 0xffff0000, v26
  v_add_f32 v192, v192, v16
  v_add_f32 v193, v193, v17
  v_cvt_pk_bf16_f32 v196, v192, v193
  v_cvt_pk_bf16_f32 v26, v194, v195
  v_lshlrev_b32 v194, 16, v26
  v_and_b32 v195, 0xffff0000, v26
  v_mul_f32 v194, v194, v24
  v_mul_f32 v195, v195, v24
  v_cvt_pk_bf16_f32 v26, v194, v195
  v_lshlrev_b32 v194, 16, v26
  v_and_b32 v195, 0xffff0000, v26
  v_add_f32 v194, v194, v18
  v_add_f32 v195, v195, v19
  v_cvt_pk_bf16_f32 v197, v194, v195
  buffer_store_dwordx2 v[196:197], v9, s[8:11], s46 offen offset:64
  s_branch pvy_267
pvy_268:
  s_sub_u32 s21, s2, 450
  s_cmp_ge_u32 s21, 190
  s_cbranch_scc1 lc_270
  s_cmp_lg_u32 s20, 0
  s_cbranch_scc1 lc_270x
  s_waitcnt vmcnt(2)
  s_mov_b64 exec, 1
  ds_write_b32 v30, v29 offset:12
  s_mov_b64 exec, -1
lc_270x:
  s_waitcnt lgkmcnt(0)
  s_barrier
  ds_read_b32 v23, v30 offset:12
lc_270:
  s_waitcnt lgkmcnt(0)
  v_readfirstlane_b32 s2, v23
  v_readfirstlane_b32 s67, v213
  s_barrier
  s_add_u32 s21, s2, 0
  s_cmp_lt_u32 s2, 32
  s_cbranch_scc1 do_opb
  s_sub_u32 s2, s2, 32
  s_add_u32 s21, s2, 0
  s_cmp_lt_u32 s2, 342
  s_cbranch_scc1 pv_loop
  s_sub_u32 s2, s2, 342
  s_branch main_fin
  s_branch queue
main_fin:
  s_waitcnt vmcnt(0)
main_end:
  s_endpgm
.section .rodata,"a"
.p2align 6
.amdhsa_kernel gated_mix__memory_aug_recurrent_mem_tr__sliding_local_dilated__prompt_kernel
  .amdhsa_next_free_vgpr 512
  .amdhsa_next_free_sgpr 102
  .amdhsa_accum_offset 256
  .amdhsa_group_segment_fixed_size 0
  .amdhsa_kernarg_size 112
  .amdhsa_user_sgpr_count 2
  .amdhsa_user_sgpr_kernarg_segment_ptr 1
  .amdhsa_system_sgpr_workgroup_id_x 1
.end_amdhsa_kernel
.text
```

```asm
; @launch kernel=gated_mix__memory_aug_recurrent_mem_tr__sliding_local_dilated__prompt_kernel grid=(256,1,1) block=(256,1,1) lds=163840
.amdgcn_target "amdgcn-amd-amdhsa--gfx950"
.text
.globl gated_mix__memory_aug_recurrent_mem_tr__sliding_local_dilated__prompt_kernel
.p2align 8
.type gated_mix__memory_aug_recurrent_mem_tr__sliding_local_dilated__prompt_kernel,@function
gated_mix__memory_aug_recurrent_mem_tr__sliding_local_dilated__prompt_kernel:
  s_cmp_ge_u32 s2, 256
  s_cbranch_scc1 end0
  s_load_dwordx2 s[4:5], s[0:1], 96
  s_load_dwordx2 s[38:39], s[0:1], 104
  v_lshrrev_b32 v1, 6, v0
  v_and_b32 v2, 15, v0
  v_readfirstlane_b32 s20, v1
  v_and_b32 v1, 63, v0
  v_lshrrev_b32 v3, 4, v1
  s_getreg_b32 s50, hwreg(HW_REG_XCC_ID)
  s_and_b32 s50, s50, 7
  s_waitcnt lgkmcnt(0)
  s_mov_b32 s32, s4
  s_mov_b32 s33, s5
  s_mov_b32 s34, 256
  s_mov_b32 s35, 0x00020000
  v_mov_b32 v21, 0
  s_cmp_lg_u32 s20, 0
  s_cbranch_scc1 rk_1
  s_and_b32 s21, s50, 1
  s_lshl_b32 s21, s21, 7
  s_lshl_b32 s22, s50, 1
  s_and_b32 s22, s22, 12
  s_add_u32 s21, s21, s22
  v_mov_b32 v22, s21
  v_mov_b32 v23, 1
  s_mov_b64 exec, 1
  buffer_atomic_add v23, v22, s[32:35], 0 offen sc0 sc1
  s_waitcnt vmcnt(0)
  v_readfirstlane_b32 s51, v23
  s_lshl_b32 s22, s50, 5
  s_add_u32 s22, s22, s51
  s_cmp_lt_u32 s51, 32
  s_cbranch_scc1 rk_2
  v_mov_b32 v24, 72
  v_mov_b32 v25, 1
  buffer_atomic_add v25, v24, s[32:35], 0 offen sc0 sc1
  s_waitcnt vmcnt(0)
  v_readfirstlane_b32 s23, v25
  s_mov_b32 s101, 0
  s_mov_b64 exec, -1
  v_lshlrev_b32 v24, 2, v1
rk_3:
  s_sleep 8
  buffer_load_dword v25, v24, s[32:35], 0 offen sc1
  s_add_u32 s101, s101, 1
  s_cmp_gt_u32 s101, 131072
  s_cbranch_scc1 end0
  s_waitcnt vmcnt(0)
  v_readlane_b32 s21, v25, 0
  v_readlane_b32 s22, v25, 32
  s_add_u32 s21, s21, s22
  v_readlane_b32 s22, v25, 1
  s_add_u32 s21, s21, s22
  v_readlane_b32 s22, v25, 33
  s_add_u32 s21, s21, s22
  v_readlane_b32 s22, v25, 2
  s_add_u32 s21, s21, s22
  v_readlane_b32 s22, v25, 34
  s_add_u32 s21, s21, s22
  v_readlane_b32 s22, v25, 3
  s_add_u32 s21, s21, s22
  v_readlane_b32 s22, v25, 35
  s_add_u32 s21, s21, s22
  s_cmp_lt_u32 s21, 256
  s_cbranch_scc1 rk_3
  s_mov_b64 exec, 1
  s_mov_b32 s24, 0
rk_5:
  s_and_b32 s21, s24, 1
  s_lshl_b32 s21, s21, 5
  s_lshr_b32 s22, s24, 1
  s_add_u32 s21, s21, s22
  v_readlane_b32 s21, v25, s21
  s_min_u32 s21, s21, 32
  s_sub_u32 s25, 32, s21
  s_cmp_lt_u32 s23, s25
  s_cbranch_scc1 rk_4
  s_sub_u32 s23, s23, s25
  s_add_u32 s24, s24, 1
  s_cmp_lt_u32 s24, 8
  s_cbranch_scc1 rk_5
  s_branch end0
rk_4:
  s_lshl_b32 s22, s24, 5
  s_add_u32 s22, s22, s21
  s_add_u32 s22, s22, s23
  s_or_b32 s22, s22, 0x100
rk_2:
  v_mov_b32 v23, s22
  ds_write_b32 v21, v23
  s_waitcnt lgkmcnt(0)
  s_mov_b64 exec, -1
rk_1:
  s_barrier
  ds_read_b32 v23, v21
  s_waitcnt lgkmcnt(0)
  v_readfirstlane_b32 s22, v23
  s_barrier
  s_mov_b32 s84, 0
  s_mov_b32 s85, -1

  s_lshr_b32 s53, s22, 8
  s_and_b32 s22, s22, 255
  s_cmp_ge_u32 s22, 128
  s_cbranch_scc1 gemm_side
  s_lshr_b32 s50, s22, 4
  s_and_b32 s51, s22, 15
  s_mov_b32 s86, 0x3dd53b95
  s_load_dwordx2 s[4:5], s[0:1], 8
  s_load_dwordx4 s[36:39], s[0:1], 16
  s_load_dwordx4 s[40:43], s[0:1], 32
  s_load_dwordx2 s[44:45], s[0:1], 104
  s_lshr_b32 s55, s51, 2
  s_and_b32 s56, s51, 3
  s_lshl_b32 s57, s50, 2
  s_add_u32 s58, s57, s55
  s_add_u32 s59, s57, s20
  s_lshr_b32 s21, s51, 1
  s_xor_b32 s21, s21, s55
  s_andn2_b32 s21, 1, s21
  s_xor_b32 s85, s51, s21
  s_xor_b32 s84, s56, 1
  s_mul_i32 s87, s85, 5
  s_lshr_b32 s87, s87, 1
  s_and_b32 s79, s85, 1
  s_waitcnt lgkmcnt(0)
  s_add_u32 s8, s44, 78643200
  s_addc_u32 s9, s45, 0
  s_mov_b32 s10, 2162688
  s_mov_b32 s11, 0x00020000
  s_mov_b32 s16, s44
  s_mov_b32 s17, s45
  s_mov_b32 s18, 50331648
  s_mov_b32 s19, 0x00020000
  s_add_u32 s24, s44, 50331648
  s_addc_u32 s25, s45, 0
  s_mov_b32 s26, 63963136
  s_mov_b32 s27, 0x00020000
  s_mov_b32 s28, s4
  s_mov_b32 s29, s5
  s_mov_b32 s30, 10240
  s_mov_b32 s31, 0x00020000
  s_add_u32 s4, s44, 83886079
  s_addc_u32 s5, s45, 0
  s_and_b32 s4, s4, 0xffe00000
  s_mov_b32 s6, 2097152
  s_mov_b32 s7, 0x00020000
  v_mov_b32 v27, 10923
  v_add_u32 v103, 0, v1
  v_mul_u32_u24 v102, v103, v27
  v_lshrrev_b32 v102, 16, v102
  v_mul_u32_u24 v101, 6, v102
  v_sub_u32 v103, v103, v101
  v_bfe_u32 v101, v102, 1, 1
  v_mul_u32_u24 v101, 20, v101
  v_and_b32 v100, 1, v102
  v_add_u32 v101, v101, v100
  v_lshrrev_b32 v100, 3, v102
  v_mul_u32_u24 v100, 40, v100
  v_bfe_u32 v99, v102, 2, 1
  v_lshl_add_u32 v100, v99, 1, v100
  v_add_u32 v100, v100, v101
  v_mul_u32_u24 v100, 12288, v100
  v_lshl_add_u32 v46, v103, 4, v100
  v_lshrrev_b32 v100, 4, v102
  v_mul_u32_u24 v100, 40, v100
  v_bfe_u32 v99, v102, 2, 2
  v_lshl_add_u32 v100, v99, 1, v100
  v_add_u32 v100, v100, v101
  v_mul_u32_u24 v100, 12288, v100
  v_lshl_add_u32 v96, v103, 4, v100
  v_add_u32 v103, 64, v1
  v_mul_u32_u24 v102, v103, v27
  v_lshrrev_b32 v102, 16, v102
  v_mul_u32_u24 v101, 6, v102
  v_sub_u32 v103, v103, v101
  v_bfe_u32 v101, v102, 1, 1
  v_mul_u32_u24 v101, 20, v101
  v_and_b32 v100, 1, v102
  v_add_u32 v101, v101, v100
  v_lshrrev_b32 v100, 3, v102
  v_mul_u32_u24 v100, 40, v100
  v_bfe_u32 v99, v102, 2, 1
  v_lshl_add_u32 v100, v99, 1, v100
  v_add_u32 v100, v100, v101
  v_mul_u32_u24 v100, 12288, v100
  v_lshl_add_u32 v47, v103, 4, v100
  v_lshrrev_b32 v100, 4, v102
  v_mul_u32_u24 v100, 40, v100
  v_bfe_u32 v99, v102, 2, 2
  v_lshl_add_u32 v100, v99, 1, v100
  v_add_u32 v100, v100, v101
  v_mul_u32_u24 v100, 12288, v100
  v_lshl_add_u32 v97, v103, 4, v100
  v_add_u32 v103, 128, v1
  v_mul_u32_u24 v102, v103, v27
  v_lshrrev_b32 v102, 16, v102
  v_mul_u32_u24 v101, 6, v102
  v_sub_u32 v103, v103, v101
  v_bfe_u32 v101, v102, 1, 1
  v_mul_u32_u24 v101, 20, v101
  v_and_b32 v100, 1, v102
  v_add_u32 v101, v101, v100
  v_lshrrev_b32 v100, 3, v102
  v_mul_u32_u24 v100, 40, v100
  v_bfe_u32 v99, v102, 2, 1
  v_lshl_add_u32 v100, v99, 1, v100
  v_add_u32 v100, v100, v101
  v_mul_u32_u24 v100, 12288, v100
  v_lshl_add_u32 v48, v103, 4, v100
  v_lshrrev_b32 v100, 4, v102
  v_mul_u32_u24 v100, 40, v100
  v_bfe_u32 v99, v102, 2, 2
  v_lshl_add_u32 v100, v99, 1, v100
  v_add_u32 v100, v100, v101
  v_mul_u32_u24 v100, 12288, v100
  v_lshl_add_u32 v98, v103, 4, v100
  s_mul_i32 s80, s58, 384
  s_mul_i32 s22, s56, 96
  s_add_u32 s80, s80, s22
  s_mul_i32 s22, s20, 1966080
  s_add_u32 s80, s80, s22
  s_mul_i32 s88, s84, 96
  s_mul_i32 s21, s56, 96
  s_sub_u32 s88, s88, s21
  s_add_u32 s88, s88, s80
  s_mul_i32 s81, s20, 40448

  s_mul_i32 s82, s59, 245760
  s_lshl_b32 s22, s87, 5
  s_add_u32 s82, s82, s22
  s_mov_b32 s12, s38
  s_mov_b32 s13, s39
  s_mov_b32 s14, 7864320
  s_mov_b32 s15, 0x00020000
  s_add_u32 s21, s80, 0
  s_add_u32 s22, s81, 0
  s_add_u32 m0, s22, 0
  s_nop 0
  buffer_load_dwordx4 v96, s[12:15], s21 offen lds
  s_add_u32 m0, s22, 1024
  s_nop 0
  buffer_load_dwordx4 v97, s[12:15], s21 offen lds
  s_add_u32 m0, s22, 2048
  s_nop 0
  buffer_load_dwordx4 v98, s[12:15], s21 offen lds
  s_add_u32 s21, s80, 983040
  s_add_u32 s22, s81, 3072
  s_add_u32 m0, s22, 0
  s_nop 0
  buffer_load_dwordx4 v96, s[12:15], s21 offen lds
  s_add_u32 m0, s22, 1024
  s_nop 0
  buffer_load_dwordx4 v97, s[12:15], s21 offen lds
  s_add_u32 m0, s22, 2048
  s_nop 0
  buffer_load_dwordx4 v98, s[12:15], s21 offen lds
  s_add_u32 s21, s80, 98304
  s_add_u32 s22, s81, 6144
  s_add_u32 m0, s22, 0
  s_nop 0
  buffer_load_dwordx4 v96, s[12:15], s21 offen lds
  s_add_u32 m0, s22, 1024
  s_nop 0
  buffer_load_dwordx4 v97, s[12:15], s21 offen lds
  s_add_u32 m0, s22, 2048
  s_nop 0
  buffer_load_dwordx4 v98, s[12:15], s21 offen lds
  s_add_u32 s21, s80, 1081344
  s_add_u32 s22, s81, 9216
  s_add_u32 m0, s22, 0
  s_nop 0
  buffer_load_dwordx4 v96, s[12:15], s21 offen lds
  s_add_u32 m0, s22, 1024
  s_nop 0
  buffer_load_dwordx4 v97, s[12:15], s21 offen lds
  s_add_u32 m0, s22, 2048
  s_nop 0
  buffer_load_dwordx4 v98, s[12:15], s21 offen lds
  s_add_u32 s21, s80, 196608
  s_add_u32 s22, s81, 12288
  s_add_u32 m0, s22, 0
  s_nop 0
  buffer_load_dwordx4 v46, s[12:15], s21 offen lds
  s_add_u32 m0, s22, 1024
  s_nop 0
  buffer_load_dwordx4 v47, s[12:15], s21 offen lds
  s_add_u32 m0, s22, 2048
  s_nop 0
  buffer_load_dwordx4 v48, s[12:15], s21 offen lds
  s_mov_b32 s12, s40
  s_mov_b32 s13, s41
  s_mov_b32 s14, 7864320
  s_mov_b32 s15, 0x00020000
  s_add_u32 s21, s88, 0
  s_add_u32 s22, s81, 0
  buffer_load_dwordx4 v[128:131], v96, s[12:15], s21 offen
  buffer_load_dwordx4 v[132:135], v97, s[12:15], s21 offen
  buffer_load_dwordx4 v[136:139], v98, s[12:15], s21 offen
  s_add_u32 s21, s88, 983040
  s_add_u32 s22, s81, 3072
  buffer_load_dwordx4 v[140:143], v96, s[12:15], s21 offen
  buffer_load_dwordx4 v[144:147], v97, s[12:15], s21 offen
  buffer_load_dwordx4 v[148:151], v98, s[12:15], s21 offen
  s_add_u32 s21, s88, 98304
  s_add_u32 s22, s81, 6144
  buffer_load_dwordx4 v[152:155], v96, s[12:15], s21 offen
  buffer_load_dwordx4 v[156:159], v97, s[12:15], s21 offen
  buffer_load_dwordx4 v[160:163], v98, s[12:15], s21 offen
  s_add_u32 s21, s88, 1081344
  s_add_u32 s22, s81, 9216
  buffer_load_dwordx4 v[164:167], v96, s[12:15], s21 offen
  buffer_load_dwordx4 v[168:171], v97, s[12:15], s21 offen
  buffer_load_dwordx4 v[172:175], v98, s[12:15], s21 offen
  s_add_u32 s21, s88, 196608
  s_add_u32 s22, s81, 12288
  buffer_load_dwordx4 v[176:179], v46, s[12:15], s21 offen
  buffer_load_dwordx4 v[180:183], v47, s[12:15], s21 offen
  buffer_load_dwordx4 v[184:187], v48, s[12:15], s21 offen
  v_lshrrev_b32 v99, 2, v2
  v_lshl_add_u32 v99, v3, 3, v99
  v_mul_u32_u24 v99, 96, v99
  v_and_b32 v100, 3, v2
  v_lshlrev_b32 v100, 3, v100
  v_add3_u32 v99, v99, v100, s81
  v_lshlrev_b32 v100, 4, v1
  v_add_u32 v100, s81, v100
  v_and_b32 v236, 7, v2
  v_lshrrev_b32 v237, 3, v2
  v_lshlrev_b32 v238, 7, v3
  v_lshl_add_u32 v238, v236, 4, v238
  v_lshlrev_b32 v16, 4, v1
  v_mul_u32_u24 v244, 1280, v236
  s_mul_i32 s21, s20, 320
  v_add_u32 v244, s21, v244
  v_lshrrev_b32 v245, 3, v1
  v_mul_u32_u24 v245, 40, v245
  v_add_u32 v244, v244, v245
  s_lshr_b32 s21, s20, 1
  s_lshl_b32 s21, s21, 14
  s_and_b32 s22, s20, 1
  s_mul_i32 s22, s22, 3072
  s_add_u32 s21, s21, s22
  v_add_u32 v4, s21, v16
  v_mov_b32 v239, 0x4444
  v_mov_b32 v240, 0xeeee
  v_cmp_eq_u32 vcc, 1, v237
  s_nop 1
  v_cndmask_b32 v44, v239, v240, vcc
  v_cmp_gt_u32 vcc, 2, v3
  s_nop 1
  v_cndmask_b32 v89, 0, 1.0, vcc
  v_lshrrev_b32 v239, 2, v2
  v_mul_u32_u24 v239, 272, v239
  v_lshl_add_u32 v239, v3, 6, v239
  v_and_b32 v240, 3, v2
  v_lshl_add_u32 v239, v240, 2, v239
  s_mul_i32 s21, s20, 5440
  v_add_u32 v5, s21, v239
  v_mul_u32_u24 v239, 272, v3
  v_lshl_add_u32 v6, v2, 4, v239
  v_lshl_add_u32 v239, v236, 4, v239
  v_mul_u32_u24 v240, 10880, v237
  v_add_u32 v45, v239, v240
  s_lshl_b32 s21, s50, 4
  s_add_u32 s21, s21, s51
  s_lshl_b32 s21, s21, 9
  s_lshl_b32 s22, s20, 7
  s_add_u32 s21, s21, s22
  s_add_u32 s21, s21, 81920
  v_and_b32 v239, 1, v3
  v_lshlrev_b32 v239, 8, v239
  v_lshl_add_u32 v239, v236, 4, v239
  v_lshrrev_b32 v240, 1, v3
  v_lshl_add_u32 v239, v240, 3, v239
  v_add_u32 v7, s21, v239
  s_lshl_b32 s22, s58, 9
  s_lshl_b32 s23, s56, 7
  s_add_u32 s22, s22, s23
  s_add_u32 s22, s22, 376704
  v_lshlrev_b32 v239, 6, v3
  v_lshl_add_u32 v239, v236, 3, v239
  v_add_u32 v239, s22, v239
  s_cmp_eq_u32 s20, 2
  s_cselect_b64 vcc, -1, 0
  v_cndmask_b32 v7, v7, v239, vcc
  s_lshl_b32 s21, s59, 11
  s_add_u32 s21, s21, 81920
  v_add_u32 v8, s21, v16
  s_lshl_b32 s21, s59, 9
  s_add_u32 s21, s21, 376832
  v_lshl_add_u32 v9, v1, 3, s21
  s_mul_i32 s21, s59, 3072
  s_add_u32 s21, s21, 278528
  v_and_b32 v239, 0x39, v1
  v_bfe_u32 v240, v1, 1, 1
  v_lshl_or_b32 v239, v240, 2, v239
  v_bfe_u32 v240, v1, 2, 1
  v_lshl_or_b32 v239, v240, 1, v239
  v_lshl_add_u32 v10, v239, 4, s21
  s_cmp_eq_u32 s20, 3
  s_cselect_b32 s22, s84, s56
  s_mul_i32 s22, s22, 12
  v_add_u32 v239, s22, v3
  v_add3_u32 v240, 0, v239, v3
  v_lshrrev_b32 v241, 1, v240
  v_and_b32 v240, 1, v240
  v_lshlrev_b32 v240, 3, v240
  v_lshl_add_u32 v242, v241, 7, v240
  v_lshl_add_u32 v242, v236, 4, v242
  s_mul_i32 s21, s58, 3072
  v_add_u32 v21, s21, v242
  v_lshl_add_u32 v242, v241, 8, v240
  v_lshl_add_u32 v242, v2, 4, v242
  s_mul_i32 s21, s58, 12288
  s_and_b32 s22, s20, 1
  s_mul_i32 s22, s22, 6144
  s_add_u32 s21, s21, s22
  v_add_u32 v18, s21, v242
  v_add3_u32 v240, 1, v239, v3
  v_lshrrev_b32 v241, 1, v240
  v_and_b32 v240, 1, v240
  v_lshlrev_b32 v240, 3, v240
  v_lshl_add_u32 v242, v241, 7, v240
  v_lshl_add_u32 v242, v236, 4, v242
  s_mul_i32 s21, s58, 3072
  v_add_u32 v22, s21, v242
  v_lshl_add_u32 v242, v241, 8, v240
  v_lshl_add_u32 v242, v2, 4, v242
  s_mul_i32 s21, s58, 12288
  s_and_b32 s22, s20, 1
  s_mul_i32 s22, s22, 6144
  s_add_u32 s21, s21, s22
  v_add_u32 v19, s21, v242
  v_add_u32 v240, 8, v239
  v_lshrrev_b32 v241, 1, v240
  v_and_b32 v240, 1, v240
  v_lshlrev_b32 v240, 3, v240
  v_lshl_add_u32 v242, v241, 7, v240
  v_lshl_add_u32 v242, v236, 4, v242
  s_mul_i32 s21, s58, 3072
  v_add_u32 v23, s21, v242
  v_lshl_add_u32 v242, v241, 8, v240
  v_lshl_add_u32 v242, v2, 4, v242
  s_mul_i32 s21, s58, 12288
  s_and_b32 s22, s20, 1
  s_mul_i32 s22, s22, 6144
  s_add_u32 s21, s21, s22
  v_add_u32 v20, s21, v242
  v_cmp_eq_u32 vcc, 1, v237
  s_nop 1
  v_cndmask_b32 v25, v21, v22, vcc
  v_add_u32 v24, 278528, v25
  s_mul_i32 s21, s20, 3072
  s_add_u32 s21, s21, 22528
  v_add_u32 v11, s21, v16
  v_and_b32 v239, 3, v1
  s_lshl_b32 s21, s20, 2
  v_add_u32 v240, s21, v239
  v_cmp_eq_u32 vcc, 10, v240
  s_nop 1
  v_cndmask_b32 v240, v240, 7, vcc
  v_cmp_eq_u32 vcc, 3, v239
  v_lshrrev_b32 v241, 5, v1
  v_mul_u32_u24 v241, 10, v241
  v_cndmask_b32 v240, v240, 3, vcc
  s_lshl_b32 s21, s79, 2
  v_add3_u32 v240, v240, v241, s21
  v_lshrrev_b32 v241, 1, v240
  v_lshlrev_b32 v241, 8, v241
  v_and_b32 v240, 1, v240
  v_lshl_add_u32 v241, v240, 3, v241
  v_bfe_u32 v240, v1, 2, 3
  v_lshl_add_u32 v241, v240, 4, v241
  v_add_u32 v12, 22528, v241
  s_mov_b32 s21, 0x07060100
  s_cmp_eq_u32 s20, 1
  s_cselect_b32 s21, 0x07060302, s21
  s_cmp_eq_u32 s20, 2
  s_cselect_b32 s21, 0x07060c0c, s21
  v_mov_b32 v240, s21
  v_mov_b32 v241, 0x03020100
  v_cndmask_b32 v14, v241, v240, vcc
  s_lshr_b32 s21, s85, 3
  s_lshl_b32 s21, s21, 14
  s_bfe_u32 s22, s85, 0x10002
  s_mul_i32 s22, s22, 3072
  s_add_u32 s21, s21, s22
  s_and_b32 s22, s85, 3
  s_lshl_b32 s22, s22, 8
  s_add_u32 s21, s21, s22
  s_lshl_b32 s22, s20, 10
  s_add_u32 s22, s22, s21
  v_lshl_add_u32 v13, v1, 2, s22
  v_lshlrev_b32 v240, 10, v3
  v_lshl_add_u32 v240, v2, 4, v240
  v_add_u32 v240, s21, v240
  s_cmp_eq_u32 s20, 3
  s_cselect_b64 vcc, -1, 0
  v_cndmask_b32 v13, v13, v240, vcc
  s_mov_b32 s91, 0x3c000000
  v_and_b32 v240, 1, v3
  v_lshrrev_b32 v241, 1, v3
  v_lshl_add_u32 v240, v240, 1, v241
  v_lshlrev_b32 v240, 8, v240
  v_lshl_add_u32 v240, v2, 4, v240
  s_mul_i32 s21, s59, 10240
  s_lshl_b32 s22, s87, 8
  s_add_u32 s21, s21, s22
  v_add_u32 v15, s21, v240
  s_lshl_b32 s21, s79, 4
  s_lshl_b32 s76, -1, s21
  s_mov_b32 s77, 0xffff
  s_lshl_b32 s21, s79, 7
  v_or_b32 v17, s21, v16
  s_or_b32 s21, s21, 0xffffff7f
  v_and_b32 v26, s21, v16
  v_mov_b32 v243, 0
  s_mul_i32 s89, s59, 12288
  s_add_u32 s89, s89, 25165824
  v_cmp_gt_u32 s[60:61], 8, v2
  v_cmp_le_u32 s[62:63], 8, v2
  v_cmp_le_u32 s[72:73], 2, v3
  v_cmp_gt_u32 s[70:71], 48, v1
  s_nop 1
  s_and_b64 s[64:65], s[60:61], s[72:73]
  s_cmp_eq_u32 s20, 2
  s_cselect_b64 s[74:75], s[64:65], s[60:61]
  s_mul_i32 s89, s59, 12288
  s_add_u32 s89, s89, 25165824
  s_not_b64 s[48:49], s[72:73]
  v_mov_b32 v27, 10923
  v_mov_b32 v49, v100
  v_add_u32 v113, 576, v1
  v_mul_u32_u24 v103, v113, v27
  v_lshrrev_b32 v103, 16, v103
  v_mul_u32_u24 v102, 6, v103
  v_sub_u32 v113, v113, v102
  v_bfe_u32 v102, v103, 1, 1
  v_lshlrev_b32 v102, 3, v102
  v_and_b32 v127, 12, v103
  v_lshrrev_b32 v127, 1, v127
  v_and_b32 v103, 0xfffffff1, v103
  v_or3_b32 v103, v103, v102, v127
  v_mul_u32_u24 v102, 1366, v103
  v_lshrrev_b32 v102, 16, v102
  v_mul_u32_u24 v100, 48, v102
  v_sub_u32 v103, v103, v100
  v_cmp_gt_u32 vcc, 32, v103
  v_bfe_u32 v101, v103, 3, 2
  v_and_b32 v126, 3, v103
  v_lshl_add_u32 v126, v101, 2, v126
  v_bfe_u32 v101, v103, 2, 1
  v_lshl_add_u32 v126, v101, 4, v126
  v_cndmask_b32 v103, v103, v126, vcc
  v_add_u32 v100, v100, v103
  v_mul_u32_u24 v100, 1280, v100
  v_lshl_add_u32 v113, v113, 4, v100
  v_add_u32 v114, 640, v1
  v_mul_u32_u24 v103, v114, v27
  v_lshrrev_b32 v103, 16, v103
  v_mul_u32_u24 v102, 6, v103
  v_sub_u32 v114, v114, v102
  v_bfe_u32 v102, v103, 1, 1
  v_lshlrev_b32 v102, 3, v102
  v_and_b32 v127, 12, v103
  v_lshrrev_b32 v127, 1, v127
  v_and_b32 v103, 0xfffffff1, v103
  v_or3_b32 v103, v103, v102, v127
  v_mul_u32_u24 v102, 1366, v103
  v_lshrrev_b32 v102, 16, v102
  v_mul_u32_u24 v100, 48, v102
  v_sub_u32 v103, v103, v100
  v_cmp_gt_u32 vcc, 32, v103
  v_bfe_u32 v101, v103, 3, 2
  v_and_b32 v126, 3, v103
  v_lshl_add_u32 v126, v101, 2, v126
  v_bfe_u32 v101, v103, 2, 1
  v_lshl_add_u32 v126, v101, 4, v126
  v_cndmask_b32 v103, v103, v126, vcc
  v_add_u32 v100, v100, v103
  v_mul_u32_u24 v100, 1280, v100
  v_lshl_add_u32 v114, v114, 4, v100
  v_add_u32 v115, 704, v1
  v_mul_u32_u24 v103, v115, v27
  v_lshrrev_b32 v103, 16, v103
  v_mul_u32_u24 v102, 6, v103
  v_sub_u32 v115, v115, v102
  v_bfe_u32 v102, v103, 1, 1
  v_lshlrev_b32 v102, 3, v102
  v_and_b32 v127, 12, v103
  v_lshrrev_b32 v127, 1, v127
  v_and_b32 v103, 0xfffffff1, v103
  v_or3_b32 v103, v103, v102, v127
  v_mul_u32_u24 v102, 1366, v103
  v_lshrrev_b32 v102, 16, v102
  v_mul_u32_u24 v100, 48, v102
  v_sub_u32 v103, v103, v100
  v_cmp_gt_u32 vcc, 32, v103
  v_bfe_u32 v101, v103, 3, 2
  v_and_b32 v126, 3, v103
  v_lshl_add_u32 v126, v101, 2, v126
  v_bfe_u32 v101, v103, 2, 1
  v_lshl_add_u32 v126, v101, 4, v126
  v_cndmask_b32 v103, v103, v126, vcc
  v_add_u32 v100, v100, v103
  v_mul_u32_u24 v100, 1280, v100
  v_lshl_add_u32 v115, v115, 4, v100
  v_add_u32 v116, 768, v1
  v_mul_u32_u24 v103, v116, v27
  v_lshrrev_b32 v103, 16, v103
  v_mul_u32_u24 v102, 6, v103
  v_sub_u32 v116, v116, v102
  v_bfe_u32 v102, v103, 1, 1
  v_lshlrev_b32 v102, 3, v102
  v_and_b32 v127, 12, v103
  v_lshrrev_b32 v127, 1, v127
  v_and_b32 v103, 0xfffffff1, v103
  v_or3_b32 v103, v103, v102, v127
  v_mul_u32_u24 v102, 1366, v103
  v_lshrrev_b32 v102, 16, v102
  v_mul_u32_u24 v100, 48, v102
  v_sub_u32 v103, v103, v100
  v_cmp_gt_u32 vcc, 32, v103
  v_bfe_u32 v101, v103, 3, 2
  v_and_b32 v126, 3, v103
  v_lshl_add_u32 v126, v101, 2, v126
  v_bfe_u32 v101, v103, 2, 1
  v_lshl_add_u32 v126, v101, 4, v126
  v_cndmask_b32 v103, v103, v126, vcc
  v_add_u32 v100, v100, v103
  v_mul_u32_u24 v100, 1280, v100
  v_lshl_add_u32 v116, v116, 4, v100
  v_add_u32 v117, 832, v1
  v_mul_u32_u24 v103, v117, v27
  v_lshrrev_b32 v103, 16, v103
  v_mul_u32_u24 v102, 6, v103
  v_sub_u32 v117, v117, v102
  v_bfe_u32 v102, v103, 1, 1
  v_lshlrev_b32 v102, 3, v102
  v_and_b32 v127, 12, v103
  v_lshrrev_b32 v127, 1, v127
  v_and_b32 v103, 0xfffffff1, v103
  v_or3_b32 v103, v103, v102, v127
  v_mul_u32_u24 v102, 1366, v103
  v_lshrrev_b32 v102, 16, v102
  v_mul_u32_u24 v100, 48, v102
  v_sub_u32 v103, v103, v100
  v_cmp_gt_u32 vcc, 32, v103
  v_bfe_u32 v101, v103, 3, 2
  v_and_b32 v126, 3, v103
  v_lshl_add_u32 v126, v101, 2, v126
  v_bfe_u32 v101, v103, 2, 1
  v_lshl_add_u32 v126, v101, 4, v126
  v_cndmask_b32 v103, v103, v126, vcc
  v_add_u32 v100, v100, v103
  v_mul_u32_u24 v100, 1280, v100
  v_lshl_add_u32 v117, v117, 4, v100
  v_add_u32 v118, 896, v1
  v_mul_u32_u24 v103, v118, v27
  v_lshrrev_b32 v103, 16, v103
  v_mul_u32_u24 v102, 6, v103
  v_sub_u32 v118, v118, v102
  v_bfe_u32 v102, v103, 1, 1
  v_lshlrev_b32 v102, 3, v102
  v_and_b32 v127, 12, v103
  v_lshrrev_b32 v127, 1, v127
  v_and_b32 v103, 0xfffffff1, v103
  v_or3_b32 v103, v103, v102, v127
  v_mul_u32_u24 v102, 1366, v103
  v_lshrrev_b32 v102, 16, v102
  v_mul_u32_u24 v100, 48, v102
  v_sub_u32 v103, v103, v100
  v_cmp_gt_u32 vcc, 32, v103
  v_bfe_u32 v101, v103, 3, 2
  v_and_b32 v126, 3, v103
  v_lshl_add_u32 v126, v101, 2, v126
  v_bfe_u32 v101, v103, 2, 1
  v_lshl_add_u32 v126, v101, 4, v126
  v_cndmask_b32 v103, v103, v126, vcc
  v_add_u32 v100, v100, v103
  v_mul_u32_u24 v100, 1280, v100
  v_lshl_add_u32 v118, v118, 4, v100
  v_add_u32 v119, 960, v1
  v_mul_u32_u24 v103, v119, v27
  v_lshrrev_b32 v103, 16, v103
  v_mul_u32_u24 v102, 6, v103
  v_sub_u32 v119, v119, v102
  v_bfe_u32 v102, v103, 1, 1
  v_lshlrev_b32 v102, 3, v102
  v_and_b32 v127, 12, v103
  v_lshrrev_b32 v127, 1, v127
  v_and_b32 v103, 0xfffffff1, v103
  v_or3_b32 v103, v103, v102, v127
  v_mul_u32_u24 v102, 1366, v103
  v_lshrrev_b32 v102, 16, v102
  v_mul_u32_u24 v100, 48, v102
  v_sub_u32 v103, v103, v100
  v_cmp_gt_u32 vcc, 32, v103
  v_bfe_u32 v101, v103, 3, 2
  v_and_b32 v126, 3, v103
  v_lshl_add_u32 v126, v101, 2, v126
  v_bfe_u32 v101, v103, 2, 1
  v_lshl_add_u32 v126, v101, 4, v126
  v_cndmask_b32 v103, v103, v126, vcc
  v_add_u32 v100, v100, v103
  v_mul_u32_u24 v100, 1280, v100
  v_lshl_add_u32 v119, v119, 4, v100
  v_add_u32 v120, 1024, v1
  v_mul_u32_u24 v103, v120, v27
  v_lshrrev_b32 v103, 16, v103
  v_mul_u32_u24 v102, 6, v103
  v_sub_u32 v120, v120, v102
  v_bfe_u32 v102, v103, 1, 1
  v_lshlrev_b32 v102, 3, v102
  v_and_b32 v127, 12, v103
  v_lshrrev_b32 v127, 1, v127
  v_and_b32 v103, 0xfffffff1, v103
  v_or3_b32 v103, v103, v102, v127
  v_mul_u32_u24 v102, 1366, v103
  v_lshrrev_b32 v102, 16, v102
  v_mul_u32_u24 v100, 48, v102
  v_sub_u32 v103, v103, v100
  v_cmp_gt_u32 vcc, 32, v103
  v_bfe_u32 v101, v103, 3, 2
  v_and_b32 v126, 3, v103
  v_lshl_add_u32 v126, v101, 2, v126
  v_bfe_u32 v101, v103, 2, 1
  v_lshl_add_u32 v126, v101, 4, v126
  v_cndmask_b32 v103, v103, v126, vcc
  v_add_u32 v100, v100, v103
  v_mul_u32_u24 v100, 1280, v100
  v_lshl_add_u32 v120, v120, 4, v100
  v_add_u32 v121, 1088, v1
  v_mul_u32_u24 v103, v121, v27
  v_lshrrev_b32 v103, 16, v103
  v_mul_u32_u24 v102, 6, v103
  v_sub_u32 v121, v121, v102
  v_bfe_u32 v102, v103, 1, 1
  v_lshlrev_b32 v102, 3, v102
  v_and_b32 v127, 12, v103
  v_lshrrev_b32 v127, 1, v127
  v_and_b32 v103, 0xfffffff1, v103
  v_or3_b32 v103, v103, v102, v127
  v_mul_u32_u24 v102, 1366, v103
  v_lshrrev_b32 v102, 16, v102
  v_mul_u32_u24 v100, 48, v102
  v_sub_u32 v103, v103, v100
  v_cmp_gt_u32 vcc, 32, v103
  v_bfe_u32 v101, v103, 3, 2
  v_and_b32 v126, 3, v103
  v_lshl_add_u32 v126, v101, 2, v126
  v_bfe_u32 v101, v103, 2, 1
  v_lshl_add_u32 v126, v101, 4, v126
  v_cndmask_b32 v103, v103, v126, vcc
  v_add_u32 v100, v100, v103
  v_mul_u32_u24 v100, 1280, v100
  v_lshl_add_u32 v121, v121, 4, v100
  s_waitcnt vmcnt(63)
  s_mov_b32 s12, s42
  s_mov_b32 s13, s43
  s_mov_b32 s14, 7864320
  s_mov_b32 s15, 0x00020000
  buffer_load_dwordx4 v[188:191], v113, s[12:15], s82 offen
  buffer_load_dwordx4 v[192:195], v114, s[12:15], s82 offen
  buffer_load_dwordx4 v[196:199], v115, s[12:15], s82 offen
  buffer_load_dwordx4 v[200:203], v116, s[12:15], s82 offen
  buffer_load_dwordx4 v[204:207], v117, s[12:15], s82 offen
  buffer_load_dwordx4 v[208:211], v118, s[12:15], s82 offen
  buffer_load_dwordx4 v[212:215], v119, s[12:15], s82 offen
  buffer_load_dwordx4 v[216:219], v120, s[12:15], s82 offen
  buffer_load_dwordx4 v[220:223], v121, s[12:15], s82 offen
  v_add_u32 v104, 0, v1
  v_mul_u32_u24 v103, v104, v27
  v_lshrrev_b32 v103, 16, v103
  v_mul_u32_u24 v102, 6, v103
  v_sub_u32 v104, v104, v102
  v_bfe_u32 v102, v103, 1, 1
  v_lshlrev_b32 v102, 3, v102
  v_and_b32 v127, 12, v103
  v_lshrrev_b32 v127, 1, v127
  v_and_b32 v103, 0xfffffff1, v103
  v_or3_b32 v103, v103, v102, v127
  v_mul_u32_u24 v102, 1366, v103
  v_lshrrev_b32 v102, 16, v102
  v_mul_u32_u24 v100, 48, v102
  v_sub_u32 v103, v103, v100
  v_cmp_gt_u32 vcc, 32, v103
  v_bfe_u32 v101, v103, 3, 2
  v_and_b32 v126, 3, v103
  v_lshl_add_u32 v126, v101, 2, v126
  v_bfe_u32 v101, v103, 2, 1
  v_lshl_add_u32 v126, v101, 4, v126
  v_cndmask_b32 v103, v103, v126, vcc
  v_add_u32 v100, v100, v103
  v_mul_u32_u24 v100, 1280, v100
  v_lshl_add_u32 v104, v104, 4, v100
  v_add_u32 v105, 64, v1
  v_mul_u32_u24 v103, v105, v27
  v_lshrrev_b32 v103, 16, v103
  v_mul_u32_u24 v102, 6, v103
  v_sub_u32 v105, v105, v102
  v_bfe_u32 v102, v103, 1, 1
  v_lshlrev_b32 v102, 3, v102
  v_and_b32 v127, 12, v103
  v_lshrrev_b32 v127, 1, v127
  v_and_b32 v103, 0xfffffff1, v103
  v_or3_b32 v103, v103, v102, v127
  v_mul_u32_u24 v102, 1366, v103
  v_lshrrev_b32 v102, 16, v102
  v_mul_u32_u24 v100, 48, v102
  v_sub_u32 v103, v103, v100
  v_cmp_gt_u32 vcc, 32, v103
  v_bfe_u32 v101, v103, 3, 2
  v_and_b32 v126, 3, v103
  v_lshl_add_u32 v126, v101, 2, v126
  v_bfe_u32 v101, v103, 2, 1
  v_lshl_add_u32 v126, v101, 4, v126
  v_cndmask_b32 v103, v103, v126, vcc
  v_add_u32 v100, v100, v103
  v_mul_u32_u24 v100, 1280, v100
  v_lshl_add_u32 v105, v105, 4, v100
  v_add_u32 v106, 128, v1
  v_mul_u32_u24 v103, v106, v27
  v_lshrrev_b32 v103, 16, v103
  v_mul_u32_u24 v102, 6, v103
  v_sub_u32 v106, v106, v102
  v_bfe_u32 v102, v103, 1, 1
  v_lshlrev_b32 v102, 3, v102
  v_and_b32 v127, 12, v103
  v_lshrrev_b32 v127, 1, v127
  v_and_b32 v103, 0xfffffff1, v103
  v_or3_b32 v103, v103, v102, v127
  v_mul_u32_u24 v102, 1366, v103
  v_lshrrev_b32 v102, 16, v102
  v_mul_u32_u24 v100, 48, v102
  v_sub_u32 v103, v103, v100
  v_cmp_gt_u32 vcc, 32, v103
  v_bfe_u32 v101, v103, 3, 2
  v_and_b32 v126, 3, v103
  v_lshl_add_u32 v126, v101, 2, v126
  v_bfe_u32 v101, v103, 2, 1
  v_lshl_add_u32 v126, v101, 4, v126
  v_cndmask_b32 v103, v103, v126, vcc
  v_add_u32 v100, v100, v103
  v_mul_u32_u24 v100, 1280, v100
  v_lshl_add_u32 v106, v106, 4, v100
  v_add_u32 v107, 192, v1
  v_mul_u32_u24 v103, v107, v27
  v_lshrrev_b32 v103, 16, v103
  v_mul_u32_u24 v102, 6, v103
  v_sub_u32 v107, v107, v102
  v_bfe_u32 v102, v103, 1, 1
  v_lshlrev_b32 v102, 3, v102
  v_and_b32 v127, 12, v103
  v_lshrrev_b32 v127, 1, v127
  v_and_b32 v103, 0xfffffff1, v103
  v_or3_b32 v103, v103, v102, v127
  v_mul_u32_u24 v102, 1366, v103
  v_lshrrev_b32 v102, 16, v102
  v_mul_u32_u24 v100, 48, v102
  v_sub_u32 v103, v103, v100
  v_cmp_gt_u32 vcc, 32, v103
  v_bfe_u32 v101, v103, 3, 2
  v_and_b32 v126, 3, v103
  v_lshl_add_u32 v126, v101, 2, v126
  v_bfe_u32 v101, v103, 2, 1
  v_lshl_add_u32 v126, v101, 4, v126
  v_cndmask_b32 v103, v103, v126, vcc
  v_add_u32 v100, v100, v103
  v_mul_u32_u24 v100, 1280, v100
  v_lshl_add_u32 v107, v107, 4, v100
  v_add_u32 v108, 256, v1
  v_mul_u32_u24 v103, v108, v27
  v_lshrrev_b32 v103, 16, v103
  v_mul_u32_u24 v102, 6, v103
  v_sub_u32 v108, v108, v102
  v_bfe_u32 v102, v103, 1, 1
  v_lshlrev_b32 v102, 3, v102
  v_and_b32 v127, 12, v103
  v_lshrrev_b32 v127, 1, v127
  v_and_b32 v103, 0xfffffff1, v103
  v_or3_b32 v103, v103, v102, v127
  v_mul_u32_u24 v102, 1366, v103
  v_lshrrev_b32 v102, 16, v102
  v_mul_u32_u24 v100, 48, v102
  v_sub_u32 v103, v103, v100
  v_cmp_gt_u32 vcc, 32, v103
  v_bfe_u32 v101, v103, 3, 2
  v_and_b32 v126, 3, v103
  v_lshl_add_u32 v126, v101, 2, v126
  v_bfe_u32 v101, v103, 2, 1
  v_lshl_add_u32 v126, v101, 4, v126
  v_cndmask_b32 v103, v103, v126, vcc
  v_add_u32 v100, v100, v103
  v_mul_u32_u24 v100, 1280, v100
  v_lshl_add_u32 v108, v108, 4, v100
  v_add_u32 v109, 320, v1
  v_mul_u32_u24 v103, v109, v27
  v_lshrrev_b32 v103, 16, v103
  v_mul_u32_u24 v102, 6, v103
  v_sub_u32 v109, v109, v102
  v_bfe_u32 v102, v103, 1, 1
  v_lshlrev_b32 v102, 3, v102
  v_and_b32 v127, 12, v103
  v_lshrrev_b32 v127, 1, v127
  v_and_b32 v103, 0xfffffff1, v103
  v_or3_b32 v103, v103, v102, v127
  v_mul_u32_u24 v102, 1366, v103
  v_lshrrev_b32 v102, 16, v102
  v_mul_u32_u24 v100, 48, v102
  v_sub_u32 v103, v103, v100
  v_cmp_gt_u32 vcc, 32, v103
  v_bfe_u32 v101, v103, 3, 2
  v_and_b32 v126, 3, v103
  v_lshl_add_u32 v126, v101, 2, v126
  v_bfe_u32 v101, v103, 2, 1
  v_lshl_add_u32 v126, v101, 4, v126
  v_cndmask_b32 v103, v103, v126, vcc
  v_add_u32 v100, v100, v103
  v_mul_u32_u24 v100, 1280, v100
  v_lshl_add_u32 v109, v109, 4, v100
  v_add_u32 v110, 384, v1
  v_mul_u32_u24 v103, v110, v27
  v_lshrrev_b32 v103, 16, v103
  v_mul_u32_u24 v102, 6, v103
  v_sub_u32 v110, v110, v102
  v_bfe_u32 v102, v103, 1, 1
  v_lshlrev_b32 v102, 3, v102
  v_and_b32 v127, 12, v103
  v_lshrrev_b32 v127, 1, v127
  v_and_b32 v103, 0xfffffff1, v103
  v_or3_b32 v103, v103, v102, v127
  v_mul_u32_u24 v102, 1366, v103
  v_lshrrev_b32 v102, 16, v102
  v_mul_u32_u24 v100, 48, v102
  v_sub_u32 v103, v103, v100
  v_cmp_gt_u32 vcc, 32, v103
  v_bfe_u32 v101, v103, 3, 2
  v_and_b32 v126, 3, v103
  v_lshl_add_u32 v126, v101, 2, v126
  v_bfe_u32 v101, v103, 2, 1
  v_lshl_add_u32 v126, v101, 4, v126
  v_cndmask_b32 v103, v103, v126, vcc
  v_add_u32 v100, v100, v103
  v_mul_u32_u24 v100, 1280, v100
  v_lshl_add_u32 v110, v110, 4, v100
  v_add_u32 v111, 448, v1
  v_mul_u32_u24 v103, v111, v27
  v_lshrrev_b32 v103, 16, v103
  v_mul_u32_u24 v102, 6, v103
  v_sub_u32 v111, v111, v102
  v_bfe_u32 v102, v103, 1, 1
  v_lshlrev_b32 v102, 3, v102
  v_and_b32 v127, 12, v103
  v_lshrrev_b32 v127, 1, v127
  v_and_b32 v103, 0xfffffff1, v103
  v_or3_b32 v103, v103, v102, v127
  v_mul_u32_u24 v102, 1366, v103
  v_lshrrev_b32 v102, 16, v102
  v_mul_u32_u24 v100, 48, v102
  v_sub_u32 v103, v103, v100
  v_cmp_gt_u32 vcc, 32, v103
  v_bfe_u32 v101, v103, 3, 2
  v_and_b32 v126, 3, v103
  v_lshl_add_u32 v126, v101, 2, v126
  v_bfe_u32 v101, v103, 2, 1
  v_lshl_add_u32 v126, v101, 4, v126
  v_cndmask_b32 v103, v103, v126, vcc
  v_add_u32 v100, v100, v103
  v_mul_u32_u24 v100, 1280, v100
  v_lshl_add_u32 v111, v111, 4, v100
  v_add_u32 v112, 512, v1
  v_mul_u32_u24 v103, v112, v27
  v_lshrrev_b32 v103, 16, v103
  v_mul_u32_u24 v102, 6, v103
  v_sub_u32 v112, v112, v102
  v_bfe_u32 v102, v103, 1, 1
  v_lshlrev_b32 v102, 3, v102
  v_and_b32 v127, 12, v103
  v_lshrrev_b32 v127, 1, v127
  v_and_b32 v103, 0xfffffff1, v103
  v_or3_b32 v103, v103, v102, v127
  v_mul_u32_u24 v102, 1366, v103
  v_lshrrev_b32 v102, 16, v102
  v_mul_u32_u24 v100, 48, v102
  v_sub_u32 v103, v103, v100
  v_cmp_gt_u32 vcc, 32, v103
  v_bfe_u32 v101, v103, 3, 2
  v_and_b32 v126, 3, v103
  v_lshl_add_u32 v126, v101, 2, v126
  v_bfe_u32 v101, v103, 2, 1
  v_lshl_add_u32 v126, v101, 4, v126
  v_cndmask_b32 v103, v103, v126, vcc
  v_add_u32 v100, v100, v103
  v_mul_u32_u24 v100, 1280, v100
  v_lshl_add_u32 v112, v112, 4, v100
  s_waitcnt vmcnt(63)
  s_mov_b32 s12, s42
  s_mov_b32 s13, s43
  s_mov_b32 s14, 7864320
  s_mov_b32 s15, 0x00020000
  s_add_u32 m0, s81, 30720
  s_nop 0
  buffer_load_dwordx4 v104, s[12:15], s82 offen lds
  s_add_u32 m0, s81, 31744
  s_nop 0
  buffer_load_dwordx4 v105, s[12:15], s82 offen lds
  s_add_u32 m0, s81, 32768
  s_nop 0
  buffer_load_dwordx4 v106, s[12:15], s82 offen lds
  s_add_u32 m0, s81, 33792
  s_nop 0
  buffer_load_dwordx4 v107, s[12:15], s82 offen lds
  s_add_u32 m0, s81, 34816
  s_nop 0
  buffer_load_dwordx4 v108, s[12:15], s82 offen lds
  s_add_u32 m0, s81, 35840
  s_nop 0
  buffer_load_dwordx4 v109, s[12:15], s82 offen lds
  s_add_u32 m0, s81, 36864
  s_nop 0
  buffer_load_dwordx4 v110, s[12:15], s82 offen lds
  s_add_u32 m0, s81, 37888
  s_nop 0
  buffer_load_dwordx4 v111, s[12:15], s82 offen lds
  s_add_u32 m0, s81, 38912
  s_nop 0
  buffer_load_dwordx4 v112, s[12:15], s82 offen lds
  buffer_load_dwordx4 v[32:35], v244, s[28:31], 0 offen offset:0
  buffer_load_dwordx4 v[36:39], v244, s[28:31], 0 offen offset:16
  buffer_load_dwordx2 v[40:41], v244, s[28:31], 0 offen offset:32
  s_waitcnt vmcnt(63)
  s_mov_b32 s12, s36
  s_mov_b32 s13, s37
  s_mov_b32 s14, 7864320
  s_mov_b32 s15, 0x00020000
  s_add_u32 s21, s80, 0
  s_add_u32 s22, s81, 15360
  s_add_u32 m0, s22, 0
  s_nop 0
  buffer_load_dwordx4 v96, s[12:15], s21 offen lds
  s_add_u32 m0, s22, 1024
  s_nop 0
  buffer_load_dwordx4 v97, s[12:15], s21 offen lds
  s_add_u32 m0, s22, 2048
  s_nop 0
  buffer_load_dwordx4 v98, s[12:15], s21 offen lds
  s_waitcnt vmcnt(63)
  s_mov_b32 s12, s36
  s_mov_b32 s13, s37
  s_mov_b32 s14, 7864320
  s_mov_b32 s15, 0x00020000
  s_add_u32 s21, s80, 983040
  s_add_u32 s22, s81, 18432
  s_add_u32 m0, s22, 0
  s_nop 0
  buffer_load_dwordx4 v96, s[12:15], s21 offen lds
  s_add_u32 m0, s22, 1024
  s_nop 0
  buffer_load_dwordx4 v97, s[12:15], s21 offen lds
  s_add_u32 m0, s22, 2048
  s_nop 0
  buffer_load_dwordx4 v98, s[12:15], s21 offen lds
  s_waitcnt vmcnt(63)
  s_mov_b32 s12, s36
  s_mov_b32 s13, s37
  s_mov_b32 s14, 7864320
  s_mov_b32 s15, 0x00020000
  s_add_u32 s21, s80, 98304
  s_add_u32 s22, s81, 21504
  s_add_u32 m0, s22, 0
  s_nop 0
  buffer_load_dwordx4 v96, s[12:15], s21 offen lds
  s_add_u32 m0, s22, 1024
  s_nop 0
  buffer_load_dwordx4 v97, s[12:15], s21 offen lds
  s_add_u32 m0, s22, 2048
  s_nop 0
  buffer_load_dwordx4 v98, s[12:15], s21 offen lds
  s_waitcnt vmcnt(63)
  s_mov_b32 s12, s36
  s_mov_b32 s13, s37
  s_mov_b32 s14, 7864320
  s_mov_b32 s15, 0x00020000
  s_add_u32 s21, s80, 1081344
  s_add_u32 s22, s81, 24576
  s_add_u32 m0, s22, 0
  s_nop 0
  buffer_load_dwordx4 v96, s[12:15], s21 offen lds
  s_add_u32 m0, s22, 1024
  s_nop 0
  buffer_load_dwordx4 v97, s[12:15], s21 offen lds
  s_add_u32 m0, s22, 2048
  s_nop 0
  buffer_load_dwordx4 v98, s[12:15], s21 offen lds
  s_waitcnt vmcnt(63)
  s_mov_b32 s12, s36
  s_mov_b32 s13, s37
  s_mov_b32 s14, 7864320
  s_mov_b32 s15, 0x00020000
  s_add_u32 s21, s80, 196608
  s_add_u32 s22, s81, 27648
  s_add_u32 m0, s22, 0
  s_nop 0
  buffer_load_dwordx4 v46, s[12:15], s21 offen lds
  s_add_u32 m0, s22, 1024
  s_nop 0
  buffer_load_dwordx4 v47, s[12:15], s21 offen lds
  s_add_u32 m0, s22, 2048
  s_nop 0
  buffer_load_dwordx4 v48, s[12:15], s21 offen lds
  v_mov_b32 v100, v49
  v_lshlrev_b32 v239, 2, v1
  s_waitcnt vmcnt(51)
  ds_read_b64_tr_b16 v[52:53], v99 offset:0
  ds_read_b64_tr_b16 v[54:55], v99 offset:384
  ds_read_b64_tr_b16 v[56:57], v99 offset:32
  ds_read_b64_tr_b16 v[58:59], v99 offset:416
  ds_read_b64_tr_b16 v[60:61], v99 offset:64
  ds_read_b64_tr_b16 v[62:63], v99 offset:448
  ds_read_b64_tr_b16 v[64:65], v99 offset:3072
  ds_read_b64_tr_b16 v[66:67], v99 offset:3456
  ds_read_b64_tr_b16 v[68:69], v99 offset:3104
  ds_read_b64_tr_b16 v[70:71], v99 offset:3488
  ds_read_b64_tr_b16 v[72:73], v99 offset:3136
  ds_read_b64_tr_b16 v[74:75], v99 offset:3520
  ds_read_b64_tr_b16 v[76:77], v99 offset:6144
  ds_read_b64_tr_b16 v[78:79], v99 offset:6528
  ds_read_b64_tr_b16 v[80:81], v99 offset:6176
  ds_read_b64_tr_b16 v[82:83], v99 offset:6560
  ds_read_b64_tr_b16 v[84:85], v99 offset:6208
  ds_read_b64_tr_b16 v[86:87], v99 offset:6592
  s_waitcnt lgkmcnt(12)
  v_lshlrev_b32 v50, 16, v52
  v_and_b32 v52, 0xffff0000, v52
  v_cvt_pk_f16_f32 v52, v50, v52
  v_accvgpr_write_b32 a60, v52
  v_lshlrev_b32 v50, 16, v53
  v_and_b32 v53, 0xffff0000, v53
  v_cvt_pk_f16_f32 v53, v50, v53
  v_accvgpr_write_b32 a61, v53
  v_lshlrev_b32 v50, 16, v54
  v_and_b32 v54, 0xffff0000, v54
  v_cvt_pk_f16_f32 v54, v50, v54
  v_accvgpr_write_b32 a62, v54
  v_lshlrev_b32 v50, 16, v55
  v_and_b32 v55, 0xffff0000, v55
  v_cvt_pk_f16_f32 v55, v50, v55
  v_accvgpr_write_b32 a63, v55
  v_lshlrev_b32 v50, 16, v56
  v_and_b32 v56, 0xffff0000, v56
  v_cvt_pk_f16_f32 v56, v50, v56
  v_accvgpr_write_b32 a80, v56
  v_lshlrev_b32 v50, 16, v57
  v_and_b32 v57, 0xffff0000, v57
  v_cvt_pk_f16_f32 v57, v50, v57
  v_accvgpr_write_b32 a81, v57
  v_lshlrev_b32 v50, 16, v58
  v_and_b32 v58, 0xffff0000, v58
  v_cvt_pk_f16_f32 v58, v50, v58
  v_accvgpr_write_b32 a82, v58
  v_lshlrev_b32 v50, 16, v59
  v_and_b32 v59, 0xffff0000, v59
  v_cvt_pk_f16_f32 v59, v50, v59
  v_accvgpr_write_b32 a83, v59
  v_lshlrev_b32 v50, 16, v60
  v_and_b32 v60, 0xffff0000, v60
  v_cvt_pk_f16_f32 v60, v50, v60
  v_accvgpr_write_b32 a100, v60
  v_lshlrev_b32 v50, 16, v61
  v_and_b32 v61, 0xffff0000, v61
  v_cvt_pk_f16_f32 v61, v50, v61
  v_accvgpr_write_b32 a101, v61
  v_lshlrev_b32 v50, 16, v62
  v_and_b32 v62, 0xffff0000, v62
  v_cvt_pk_f16_f32 v62, v50, v62
  v_accvgpr_write_b32 a102, v62
  v_lshlrev_b32 v50, 16, v63
  v_and_b32 v63, 0xffff0000, v63
  v_cvt_pk_f16_f32 v63, v50, v63
  v_accvgpr_write_b32 a103, v63
  ds_read_b64_tr_b16 v[52:53], v99 offset:9216
  ds_read_b64_tr_b16 v[54:55], v99 offset:9600
  ds_read_b64_tr_b16 v[56:57], v99 offset:9248
  ds_read_b64_tr_b16 v[58:59], v99 offset:9632
  ds_read_b64_tr_b16 v[60:61], v99 offset:9280
  ds_read_b64_tr_b16 v[62:63], v99 offset:9664
  s_waitcnt lgkmcnt(12)
  v_lshlrev_b32 v50, 16, v64
  v_and_b32 v64, 0xffff0000, v64
  v_cvt_pk_f16_f32 v64, v50, v64
  v_accvgpr_write_b32 a64, v64
  v_lshlrev_b32 v50, 16, v65
  v_and_b32 v65, 0xffff0000, v65
  v_cvt_pk_f16_f32 v65, v50, v65
  v_accvgpr_write_b32 a65, v65
  v_lshlrev_b32 v50, 16, v66
  v_and_b32 v66, 0xffff0000, v66
  v_cvt_pk_f16_f32 v66, v50, v66
  v_accvgpr_write_b32 a66, v66
  v_lshlrev_b32 v50, 16, v67
  v_and_b32 v67, 0xffff0000, v67
  v_cvt_pk_f16_f32 v67, v50, v67
  v_accvgpr_write_b32 a67, v67
  v_lshlrev_b32 v50, 16, v68
  v_and_b32 v68, 0xffff0000, v68
  v_cvt_pk_f16_f32 v68, v50, v68
  v_accvgpr_write_b32 a84, v68
  v_lshlrev_b32 v50, 16, v69
  v_and_b32 v69, 0xffff0000, v69
  v_cvt_pk_f16_f32 v69, v50, v69
  v_accvgpr_write_b32 a85, v69
  v_lshlrev_b32 v50, 16, v70
  v_and_b32 v70, 0xffff0000, v70
  v_cvt_pk_f16_f32 v70, v50, v70
  v_accvgpr_write_b32 a86, v70
  v_lshlrev_b32 v50, 16, v71
  v_and_b32 v71, 0xffff0000, v71
  v_cvt_pk_f16_f32 v71, v50, v71
  v_accvgpr_write_b32 a87, v71
  v_lshlrev_b32 v50, 16, v72
  v_and_b32 v72, 0xffff0000, v72
  v_cvt_pk_f16_f32 v72, v50, v72
  v_accvgpr_write_b32 a104, v72
  v_lshlrev_b32 v50, 16, v73
  v_and_b32 v73, 0xffff0000, v73
  v_cvt_pk_f16_f32 v73, v50, v73
  v_accvgpr_write_b32 a105, v73
  v_lshlrev_b32 v50, 16, v74
  v_and_b32 v74, 0xffff0000, v74
  v_cvt_pk_f16_f32 v74, v50, v74
  v_accvgpr_write_b32 a106, v74
  v_lshlrev_b32 v50, 16, v75
  v_and_b32 v75, 0xffff0000, v75
  v_cvt_pk_f16_f32 v75, v50, v75
  v_accvgpr_write_b32 a107, v75
  ds_read_b64_tr_b16 v[64:65], v99 offset:12288
  ds_read_b64_tr_b16 v[66:67], v99 offset:12672
  ds_read_b64_tr_b16 v[68:69], v99 offset:12320
  ds_read_b64_tr_b16 v[70:71], v99 offset:12704
  ds_read_b64_tr_b16 v[72:73], v99 offset:12352
  ds_read_b64_tr_b16 v[74:75], v99 offset:12736
  s_waitcnt lgkmcnt(12)
  v_lshlrev_b32 v50, 16, v76
  v_and_b32 v76, 0xffff0000, v76
  v_cvt_pk_f16_f32 v76, v50, v76
  v_accvgpr_write_b32 a68, v76
  v_lshlrev_b32 v50, 16, v77
  v_and_b32 v77, 0xffff0000, v77
  v_cvt_pk_f16_f32 v77, v50, v77
  v_accvgpr_write_b32 a69, v77
  v_lshlrev_b32 v50, 16, v78
  v_and_b32 v78, 0xffff0000, v78
  v_cvt_pk_f16_f32 v78, v50, v78
  v_accvgpr_write_b32 a70, v78
  v_lshlrev_b32 v50, 16, v79
  v_and_b32 v79, 0xffff0000, v79
  v_cvt_pk_f16_f32 v79, v50, v79
  v_accvgpr_write_b32 a71, v79
  v_lshlrev_b32 v50, 16, v80
  v_and_b32 v80, 0xffff0000, v80
  v_cvt_pk_f16_f32 v80, v50, v80
  v_accvgpr_write_b32 a88, v80
  v_lshlrev_b32 v50, 16, v81
  v_and_b32 v81, 0xffff0000, v81
  v_cvt_pk_f16_f32 v81, v50, v81
  v_accvgpr_write_b32 a89, v81
  v_lshlrev_b32 v50, 16, v82
  v_and_b32 v82, 0xffff0000, v82
  v_cvt_pk_f16_f32 v82, v50, v82
  v_accvgpr_write_b32 a90, v82
  v_lshlrev_b32 v50, 16, v83
  v_and_b32 v83, 0xffff0000, v83
  v_cvt_pk_f16_f32 v83, v50, v83
  v_accvgpr_write_b32 a91, v83
  v_lshlrev_b32 v50, 16, v84
  v_and_b32 v84, 0xffff0000, v84
  v_cvt_pk_f16_f32 v84, v50, v84
  v_accvgpr_write_b32 a108, v84
  v_lshlrev_b32 v50, 16, v85
  v_and_b32 v85, 0xffff0000, v85
  v_cvt_pk_f16_f32 v85, v50, v85
  v_accvgpr_write_b32 a109, v85
  v_lshlrev_b32 v50, 16, v86
  v_and_b32 v86, 0xffff0000, v86
  v_cvt_pk_f16_f32 v86, v50, v86
  v_accvgpr_write_b32 a110, v86
  v_lshlrev_b32 v50, 16, v87
  v_and_b32 v87, 0xffff0000, v87
  v_cvt_pk_f16_f32 v87, v50, v87
  v_accvgpr_write_b32 a111, v87
  s_waitcnt lgkmcnt(6)
  v_lshlrev_b32 v50, 16, v52
  v_and_b32 v52, 0xffff0000, v52
  v_cvt_pk_f16_f32 v52, v50, v52
  v_accvgpr_write_b32 a72, v52
  v_lshlrev_b32 v50, 16, v53
  v_and_b32 v53, 0xffff0000, v53
  v_cvt_pk_f16_f32 v53, v50, v53
  v_accvgpr_write_b32 a73, v53
  v_lshlrev_b32 v50, 16, v54
  v_and_b32 v54, 0xffff0000, v54
  v_cvt_pk_f16_f32 v54, v50, v54
  v_accvgpr_write_b32 a74, v54
  v_lshlrev_b32 v50, 16, v55
  v_and_b32 v55, 0xffff0000, v55
  v_cvt_pk_f16_f32 v55, v50, v55
  v_accvgpr_write_b32 a75, v55
  v_lshlrev_b32 v50, 16, v56
  v_and_b32 v56, 0xffff0000, v56
  v_cvt_pk_f16_f32 v56, v50, v56
  v_accvgpr_write_b32 a92, v56
  v_lshlrev_b32 v50, 16, v57
  v_and_b32 v57, 0xffff0000, v57
  v_cvt_pk_f16_f32 v57, v50, v57
  v_accvgpr_write_b32 a93, v57
  v_lshlrev_b32 v50, 16, v58
  v_and_b32 v58, 0xffff0000, v58
  v_cvt_pk_f16_f32 v58, v50, v58
  v_accvgpr_write_b32 a94, v58
  v_lshlrev_b32 v50, 16, v59
  v_and_b32 v59, 0xffff0000, v59
  v_cvt_pk_f16_f32 v59, v50, v59
  v_accvgpr_write_b32 a95, v59
  v_lshlrev_b32 v50, 16, v60
  v_and_b32 v60, 0xffff0000, v60
  v_cvt_pk_f16_f32 v60, v50, v60
  v_accvgpr_write_b32 a112, v60
  v_lshlrev_b32 v50, 16, v61
  v_and_b32 v61, 0xffff0000, v61
  v_cvt_pk_f16_f32 v61, v50, v61
  v_accvgpr_write_b32 a113, v61
  v_lshlrev_b32 v50, 16, v62
  v_and_b32 v62, 0xffff0000, v62
  v_cvt_pk_f16_f32 v62, v50, v62
  v_accvgpr_write_b32 a114, v62
  v_lshlrev_b32 v50, 16, v63
  v_and_b32 v63, 0xffff0000, v63
  v_cvt_pk_f16_f32 v63, v50, v63
  v_accvgpr_write_b32 a115, v63
  s_waitcnt lgkmcnt(0)
  v_lshlrev_b32 v50, 16, v64
  v_and_b32 v64, 0xffff0000, v64
  v_cvt_pk_f16_f32 v64, v50, v64
  v_accvgpr_write_b32 a76, v64
  v_lshlrev_b32 v50, 16, v65
  v_and_b32 v65, 0xffff0000, v65
  v_cvt_pk_f16_f32 v65, v50, v65
  v_accvgpr_write_b32 a77, v65
  v_lshlrev_b32 v50, 16, v66
  v_and_b32 v66, 0xffff0000, v66
  v_cvt_pk_f16_f32 v66, v50, v66
  v_accvgpr_write_b32 a78, v66
  v_lshlrev_b32 v50, 16, v67
  v_and_b32 v67, 0xffff0000, v67
  v_cvt_pk_f16_f32 v67, v50, v67
  v_accvgpr_write_b32 a79, v67
  v_lshlrev_b32 v50, 16, v68
  v_and_b32 v68, 0xffff0000, v68
  v_cvt_pk_f16_f32 v68, v50, v68
  v_accvgpr_write_b32 a96, v68
  v_lshlrev_b32 v50, 16, v69
  v_and_b32 v69, 0xffff0000, v69
  v_cvt_pk_f16_f32 v69, v50, v69
  v_accvgpr_write_b32 a97, v69
  v_lshlrev_b32 v50, 16, v70
  v_and_b32 v70, 0xffff0000, v70
  v_cvt_pk_f16_f32 v70, v50, v70
  v_accvgpr_write_b32 a98, v70
  v_lshlrev_b32 v50, 16, v71
  v_and_b32 v71, 0xffff0000, v71
  v_cvt_pk_f16_f32 v71, v50, v71
  v_accvgpr_write_b32 a99, v71
  v_lshlrev_b32 v50, 16, v72
  v_and_b32 v72, 0xffff0000, v72
  v_cvt_pk_f16_f32 v72, v50, v72
  v_accvgpr_write_b32 a116, v72
  v_lshlrev_b32 v50, 16, v73
  v_and_b32 v73, 0xffff0000, v73
  v_cvt_pk_f16_f32 v73, v50, v73
  v_accvgpr_write_b32 a117, v73
  v_lshlrev_b32 v50, 16, v74
  v_and_b32 v74, 0xffff0000, v74
  v_cvt_pk_f16_f32 v74, v50, v74
  v_accvgpr_write_b32 a118, v74
  v_lshlrev_b32 v50, 16, v75
  v_and_b32 v75, 0xffff0000, v75
  v_cvt_pk_f16_f32 v75, v50, v75
  v_accvgpr_write_b32 a119, v75
  s_waitcnt vmcnt(36)
  ds_write_b128 v100, v[128:131] offset:0
  ds_write_b128 v100, v[132:135] offset:1024
  ds_write_b128 v100, v[136:139] offset:2048
  ds_write_b128 v100, v[140:143] offset:3072
  ds_write_b128 v100, v[144:147] offset:4096
  ds_write_b128 v100, v[148:151] offset:5120
  ds_write_b128 v100, v[152:155] offset:6144
  ds_write_b128 v100, v[156:159] offset:7168
  ds_write_b128 v100, v[160:163] offset:8192
  ds_write_b128 v100, v[164:167] offset:9216
  ds_write_b128 v100, v[168:171] offset:10240
  ds_write_b128 v100, v[172:175] offset:11264
  ds_write_b128 v100, v[176:179] offset:12288
  ds_write_b128 v100, v[180:183] offset:13312
  ds_write_b128 v100, v[184:187] offset:14336
  s_waitcnt lgkmcnt(0)
  ds_read_b64_tr_b16 v[52:53], v99 offset:0
  ds_read_b64_tr_b16 v[54:55], v99 offset:384
  ds_read_b64_tr_b16 v[56:57], v99 offset:32
  ds_read_b64_tr_b16 v[58:59], v99 offset:416
  ds_read_b64_tr_b16 v[60:61], v99 offset:64
  ds_read_b64_tr_b16 v[62:63], v99 offset:448
  ds_read_b64_tr_b16 v[64:65], v99 offset:3072
  ds_read_b64_tr_b16 v[66:67], v99 offset:3456
  ds_read_b64_tr_b16 v[68:69], v99 offset:3104
  ds_read_b64_tr_b16 v[70:71], v99 offset:3488
  ds_read_b64_tr_b16 v[72:73], v99 offset:3136
  ds_read_b64_tr_b16 v[74:75], v99 offset:3520
  ds_read_b64_tr_b16 v[76:77], v99 offset:6144
  ds_read_b64_tr_b16 v[78:79], v99 offset:6528
  ds_read_b64_tr_b16 v[80:81], v99 offset:6176
  ds_read_b64_tr_b16 v[82:83], v99 offset:6560
  ds_read_b64_tr_b16 v[84:85], v99 offset:6208
  ds_read_b64_tr_b16 v[86:87], v99 offset:6592
  s_waitcnt lgkmcnt(12)
  v_lshlrev_b32 v50, 16, v52
  v_and_b32 v52, 0xffff0000, v52
  v_cvt_pk_f16_f32 v52, v50, v52
  v_accvgpr_write_b32 a120, v52
  v_lshlrev_b32 v50, 16, v53
  v_and_b32 v53, 0xffff0000, v53
  v_cvt_pk_f16_f32 v53, v50, v53
  v_accvgpr_write_b32 a121, v53
  v_lshlrev_b32 v50, 16, v54
  v_and_b32 v54, 0xffff0000, v54
  v_cvt_pk_f16_f32 v54, v50, v54
  v_accvgpr_write_b32 a122, v54
  v_lshlrev_b32 v50, 16, v55
  v_and_b32 v55, 0xffff0000, v55
  v_cvt_pk_f16_f32 v55, v50, v55
  v_accvgpr_write_b32 a123, v55
  v_lshlrev_b32 v50, 16, v56
  v_and_b32 v56, 0xffff0000, v56
  v_cvt_pk_f16_f32 v56, v50, v56
  v_accvgpr_write_b32 a140, v56
  v_lshlrev_b32 v50, 16, v57
  v_and_b32 v57, 0xffff0000, v57
  v_cvt_pk_f16_f32 v57, v50, v57
  v_accvgpr_write_b32 a141, v57
  v_lshlrev_b32 v50, 16, v58
  v_and_b32 v58, 0xffff0000, v58
  v_cvt_pk_f16_f32 v58, v50, v58
  v_accvgpr_write_b32 a142, v58
  v_lshlrev_b32 v50, 16, v59
  v_and_b32 v59, 0xffff0000, v59
  v_cvt_pk_f16_f32 v59, v50, v59
  v_accvgpr_write_b32 a143, v59
  v_lshlrev_b32 v50, 16, v60
  v_and_b32 v60, 0xffff0000, v60
  v_cvt_pk_f16_f32 v60, v50, v60
  v_accvgpr_write_b32 a160, v60
  v_lshlrev_b32 v50, 16, v61
  v_and_b32 v61, 0xffff0000, v61
  v_cvt_pk_f16_f32 v61, v50, v61
  v_accvgpr_write_b32 a161, v61
  v_lshlrev_b32 v50, 16, v62
  v_and_b32 v62, 0xffff0000, v62
  v_cvt_pk_f16_f32 v62, v50, v62
  v_accvgpr_write_b32 a162, v62
  v_lshlrev_b32 v50, 16, v63
  v_and_b32 v63, 0xffff0000, v63
  v_cvt_pk_f16_f32 v63, v50, v63
  v_accvgpr_write_b32 a163, v63
  ds_read_b64_tr_b16 v[52:53], v99 offset:9216
  ds_read_b64_tr_b16 v[54:55], v99 offset:9600
  ds_read_b64_tr_b16 v[56:57], v99 offset:9248
  ds_read_b64_tr_b16 v[58:59], v99 offset:9632
  ds_read_b64_tr_b16 v[60:61], v99 offset:9280
  ds_read_b64_tr_b16 v[62:63], v99 offset:9664
  s_waitcnt lgkmcnt(12)
  v_lshlrev_b32 v50, 16, v64
  v_and_b32 v64, 0xffff0000, v64
  v_cvt_pk_f16_f32 v64, v50, v64
  v_accvgpr_write_b32 a124, v64
  v_lshlrev_b32 v50, 16, v65
  v_and_b32 v65, 0xffff0000, v65
  v_cvt_pk_f16_f32 v65, v50, v65
  v_accvgpr_write_b32 a125, v65
  v_lshlrev_b32 v50, 16, v66
  v_and_b32 v66, 0xffff0000, v66
  v_cvt_pk_f16_f32 v66, v50, v66
  v_accvgpr_write_b32 a126, v66
  v_lshlrev_b32 v50, 16, v67
  v_and_b32 v67, 0xffff0000, v67
  v_cvt_pk_f16_f32 v67, v50, v67
  v_accvgpr_write_b32 a127, v67
  v_lshlrev_b32 v50, 16, v68
  v_and_b32 v68, 0xffff0000, v68
  v_cvt_pk_f16_f32 v68, v50, v68
  v_accvgpr_write_b32 a144, v68
  v_lshlrev_b32 v50, 16, v69
  v_and_b32 v69, 0xffff0000, v69
  v_cvt_pk_f16_f32 v69, v50, v69
  v_accvgpr_write_b32 a145, v69
  v_lshlrev_b32 v50, 16, v70
  v_and_b32 v70, 0xffff0000, v70
  v_cvt_pk_f16_f32 v70, v50, v70
  v_accvgpr_write_b32 a146, v70
  v_lshlrev_b32 v50, 16, v71
  v_and_b32 v71, 0xffff0000, v71
  v_cvt_pk_f16_f32 v71, v50, v71
  v_accvgpr_write_b32 a147, v71
  v_lshlrev_b32 v50, 16, v72
  v_and_b32 v72, 0xffff0000, v72
  v_cvt_pk_f16_f32 v72, v50, v72
  v_accvgpr_write_b32 a164, v72
  v_lshlrev_b32 v50, 16, v73
  v_and_b32 v73, 0xffff0000, v73
  v_cvt_pk_f16_f32 v73, v50, v73
  v_accvgpr_write_b32 a165, v73
  v_lshlrev_b32 v50, 16, v74
  v_and_b32 v74, 0xffff0000, v74
  v_cvt_pk_f16_f32 v74, v50, v74
  v_accvgpr_write_b32 a166, v74
  v_lshlrev_b32 v50, 16, v75
  v_and_b32 v75, 0xffff0000, v75
  v_cvt_pk_f16_f32 v75, v50, v75
  v_accvgpr_write_b32 a167, v75
  ds_read_b64_tr_b16 v[64:65], v99 offset:12288
  ds_read_b64_tr_b16 v[66:67], v99 offset:12672
  ds_read_b64_tr_b16 v[68:69], v99 offset:12320
  ds_read_b64_tr_b16 v[70:71], v99 offset:12704
  ds_read_b64_tr_b16 v[72:73], v99 offset:12352
  ds_read_b64_tr_b16 v[74:75], v99 offset:12736
  s_waitcnt lgkmcnt(12)
  v_lshlrev_b32 v50, 16, v76
  v_and_b32 v76, 0xffff0000, v76
  v_cvt_pk_f16_f32 v76, v50, v76
  v_accvgpr_write_b32 a128, v76
  v_lshlrev_b32 v50, 16, v77
  v_and_b32 v77, 0xffff0000, v77
  v_cvt_pk_f16_f32 v77, v50, v77
  v_accvgpr_write_b32 a129, v77
  v_lshlrev_b32 v50, 16, v78
  v_and_b32 v78, 0xffff0000, v78
  v_cvt_pk_f16_f32 v78, v50, v78
  v_accvgpr_write_b32 a130, v78
  v_lshlrev_b32 v50, 16, v79
  v_and_b32 v79, 0xffff0000, v79
  v_cvt_pk_f16_f32 v79, v50, v79
  v_accvgpr_write_b32 a131, v79
  v_lshlrev_b32 v50, 16, v80
  v_and_b32 v80, 0xffff0000, v80
  v_cvt_pk_f16_f32 v80, v50, v80
  v_accvgpr_write_b32 a148, v80
  v_lshlrev_b32 v50, 16, v81
  v_and_b32 v81, 0xffff0000, v81
  v_cvt_pk_f16_f32 v81, v50, v81
  v_accvgpr_write_b32 a149, v81
  v_lshlrev_b32 v50, 16, v82
  v_and_b32 v82, 0xffff0000, v82
  v_cvt_pk_f16_f32 v82, v50, v82
  v_accvgpr_write_b32 a150, v82
  v_lshlrev_b32 v50, 16, v83
  v_and_b32 v83, 0xffff0000, v83
  v_cvt_pk_f16_f32 v83, v50, v83
  v_accvgpr_write_b32 a151, v83
  v_lshlrev_b32 v50, 16, v84
  v_and_b32 v84, 0xffff0000, v84
  v_cvt_pk_f16_f32 v84, v50, v84
  v_accvgpr_write_b32 a168, v84
  v_lshlrev_b32 v50, 16, v85
  v_and_b32 v85, 0xffff0000, v85
  v_cvt_pk_f16_f32 v85, v50, v85
  v_accvgpr_write_b32 a169, v85
  v_lshlrev_b32 v50, 16, v86
  v_and_b32 v86, 0xffff0000, v86
  v_cvt_pk_f16_f32 v86, v50, v86
  v_accvgpr_write_b32 a170, v86
  v_lshlrev_b32 v50, 16, v87
  v_and_b32 v87, 0xffff0000, v87
  v_cvt_pk_f16_f32 v87, v50, v87
  v_accvgpr_write_b32 a171, v87
  s_waitcnt lgkmcnt(6)
  v_lshlrev_b32 v50, 16, v52
  v_and_b32 v52, 0xffff0000, v52
  v_cvt_pk_f16_f32 v52, v50, v52
  v_accvgpr_write_b32 a132, v52
  v_lshlrev_b32 v50, 16, v53
  v_and_b32 v53, 0xffff0000, v53
  v_cvt_pk_f16_f32 v53, v50, v53
  v_accvgpr_write_b32 a133, v53
  v_lshlrev_b32 v50, 16, v54
  v_and_b32 v54, 0xffff0000, v54
  v_cvt_pk_f16_f32 v54, v50, v54
  v_accvgpr_write_b32 a134, v54
  v_lshlrev_b32 v50, 16, v55
  v_and_b32 v55, 0xffff0000, v55
  v_cvt_pk_f16_f32 v55, v50, v55
  v_accvgpr_write_b32 a135, v55
  v_lshlrev_b32 v50, 16, v56
  v_and_b32 v56, 0xffff0000, v56
  v_cvt_pk_f16_f32 v56, v50, v56
  v_accvgpr_write_b32 a152, v56
  v_lshlrev_b32 v50, 16, v57
  v_and_b32 v57, 0xffff0000, v57
  v_cvt_pk_f16_f32 v57, v50, v57
  v_accvgpr_write_b32 a153, v57
  v_lshlrev_b32 v50, 16, v58
  v_and_b32 v58, 0xffff0000, v58
  v_cvt_pk_f16_f32 v58, v50, v58
  v_accvgpr_write_b32 a154, v58
  v_lshlrev_b32 v50, 16, v59
  v_and_b32 v59, 0xffff0000, v59
  v_cvt_pk_f16_f32 v59, v50, v59
  v_accvgpr_write_b32 a155, v59
  v_lshlrev_b32 v50, 16, v60
  v_and_b32 v60, 0xffff0000, v60
  v_cvt_pk_f16_f32 v60, v50, v60
  v_accvgpr_write_b32 a172, v60
  v_lshlrev_b32 v50, 16, v61
  v_and_b32 v61, 0xffff0000, v61
  v_cvt_pk_f16_f32 v61, v50, v61
  v_accvgpr_write_b32 a173, v61
  v_lshlrev_b32 v50, 16, v62
  v_and_b32 v62, 0xffff0000, v62
  v_cvt_pk_f16_f32 v62, v50, v62
  v_accvgpr_write_b32 a174, v62
  v_lshlrev_b32 v50, 16, v63
  v_and_b32 v63, 0xffff0000, v63
  v_cvt_pk_f16_f32 v63, v50, v63
  v_accvgpr_write_b32 a175, v63
  s_waitcnt lgkmcnt(0)
  v_lshlrev_b32 v50, 16, v64
  v_and_b32 v64, 0xffff0000, v64
  v_cvt_pk_f16_f32 v64, v50, v64
  v_accvgpr_write_b32 a136, v64
  v_lshlrev_b32 v50, 16, v65
  v_and_b32 v65, 0xffff0000, v65
  v_cvt_pk_f16_f32 v65, v50, v65
  v_accvgpr_write_b32 a137, v65
  v_lshlrev_b32 v50, 16, v66
  v_and_b32 v66, 0xffff0000, v66
  v_cvt_pk_f16_f32 v66, v50, v66
  v_accvgpr_write_b32 a138, v66
  v_lshlrev_b32 v50, 16, v67
  v_and_b32 v67, 0xffff0000, v67
  v_cvt_pk_f16_f32 v67, v50, v67
  v_accvgpr_write_b32 a139, v67
  v_lshlrev_b32 v50, 16, v68
  v_and_b32 v68, 0xffff0000, v68
  v_cvt_pk_f16_f32 v68, v50, v68
  v_accvgpr_write_b32 a156, v68
  v_lshlrev_b32 v50, 16, v69
  v_and_b32 v69, 0xffff0000, v69
  v_cvt_pk_f16_f32 v69, v50, v69
  v_accvgpr_write_b32 a157, v69
  v_lshlrev_b32 v50, 16, v70
  v_and_b32 v70, 0xffff0000, v70
  v_cvt_pk_f16_f32 v70, v50, v70
  v_accvgpr_write_b32 a158, v70
  v_lshlrev_b32 v50, 16, v71
  v_and_b32 v71, 0xffff0000, v71
  v_cvt_pk_f16_f32 v71, v50, v71
  v_accvgpr_write_b32 a159, v71
  v_lshlrev_b32 v50, 16, v72
  v_and_b32 v72, 0xffff0000, v72
  v_cvt_pk_f16_f32 v72, v50, v72
  v_accvgpr_write_b32 a176, v72
  v_lshlrev_b32 v50, 16, v73
  v_and_b32 v73, 0xffff0000, v73
  v_cvt_pk_f16_f32 v73, v50, v73
  v_accvgpr_write_b32 a177, v73
  v_lshlrev_b32 v50, 16, v74
  v_and_b32 v74, 0xffff0000, v74
  v_cvt_pk_f16_f32 v74, v50, v74
  v_accvgpr_write_b32 a178, v74
  v_lshlrev_b32 v50, 16, v75
  v_and_b32 v75, 0xffff0000, v75
  v_cvt_pk_f16_f32 v75, v50, v75
  v_accvgpr_write_b32 a179, v75
  s_waitcnt vmcnt(27)
  s_cmp_lg_u32 s20, 0
  s_cbranch_scc1 ic_7
  buffer_load_dword v238, v239, s[32:35], 0 offen sc1
ic_7:
  ds_write_b128 v100, v[188:191] offset:0
  ds_write_b128 v100, v[192:195] offset:1024
  ds_write_b128 v100, v[196:199] offset:2048
  ds_write_b128 v100, v[200:203] offset:3072
  ds_write_b128 v100, v[204:207] offset:4096
  ds_write_b128 v100, v[208:211] offset:5120
  ds_write_b128 v100, v[212:215] offset:6144
  ds_write_b128 v100, v[216:219] offset:7168
  ds_write_b128 v100, v[220:223] offset:8192
  s_waitcnt lgkmcnt(0)
  ds_read_b64_tr_b16 a[192:193], v99 offset:0
  ds_read_b64_tr_b16 a[194:195], v99 offset:384
  ds_read_b64_tr_b16 a[216:217], v99 offset:32
  ds_read_b64_tr_b16 a[218:219], v99 offset:416
  ds_read_b64_tr_b16 a[240:241], v99 offset:64
  ds_read_b64_tr_b16 a[242:243], v99 offset:448
  ds_read_b64_tr_b16 a[196:197], v99 offset:3072
  ds_read_b64_tr_b16 a[198:199], v99 offset:3456
  ds_read_b64_tr_b16 a[220:221], v99 offset:3104
  ds_read_b64_tr_b16 a[222:223], v99 offset:3488
  ds_read_b64_tr_b16 a[244:245], v99 offset:3136
  ds_read_b64_tr_b16 a[246:247], v99 offset:3520
  ds_read_b64_tr_b16 a[200:201], v99 offset:6144
  ds_read_b64_tr_b16 a[202:203], v99 offset:6528
  ds_read_b64_tr_b16 a[224:225], v99 offset:6176
  ds_read_b64_tr_b16 a[226:227], v99 offset:6560
  ds_read_b64_tr_b16 a[248:249], v99 offset:6208
  ds_read_b64_tr_b16 a[250:251], v99 offset:6592
  s_waitcnt lgkmcnt(0)
  s_waitcnt vmcnt(15)
  ds_read_b64_tr_b16 a[180:181], v99 offset:30720
  ds_read_b64_tr_b16 a[182:183], v99 offset:31104
  ds_read_b64_tr_b16 a[204:205], v99 offset:30752
  ds_read_b64_tr_b16 a[206:207], v99 offset:31136
  ds_read_b64_tr_b16 a[228:229], v99 offset:30784
  ds_read_b64_tr_b16 a[230:231], v99 offset:31168
  ds_read_b64_tr_b16 a[184:185], v99 offset:33792
  ds_read_b64_tr_b16 a[186:187], v99 offset:34176
  ds_read_b64_tr_b16 a[208:209], v99 offset:33824
  ds_read_b64_tr_b16 a[210:211], v99 offset:34208
  ds_read_b64_tr_b16 a[232:233], v99 offset:33856
  ds_read_b64_tr_b16 a[234:235], v99 offset:34240
  ds_read_b64_tr_b16 a[188:189], v99 offset:36864
  ds_read_b64_tr_b16 a[190:191], v99 offset:37248
  ds_read_b64_tr_b16 a[212:213], v99 offset:36896
  ds_read_b64_tr_b16 a[214:215], v99 offset:37280
  ds_read_b64_tr_b16 a[236:237], v99 offset:36928
  ds_read_b64_tr_b16 a[238:239], v99 offset:37312
  s_waitcnt lgkmcnt(0)
  v_lshlrev_b32 v50, 16, v32
  v_and_b32 v32, 0xffff0000, v32
  v_cvt_pk_f16_f32 v32, v50, v32
  v_lshlrev_b32 v50, 16, v33
  v_and_b32 v33, 0xffff0000, v33
  v_cvt_pk_f16_f32 v33, v50, v33
  v_lshlrev_b32 v50, 16, v34
  v_and_b32 v34, 0xffff0000, v34
  v_cvt_pk_f16_f32 v34, v50, v34
  v_lshlrev_b32 v50, 16, v35
  v_and_b32 v35, 0xffff0000, v35
  v_cvt_pk_f16_f32 v35, v50, v35
  v_lshlrev_b32 v50, 16, v36
  v_and_b32 v36, 0xffff0000, v36
  v_cvt_pk_f16_f32 v36, v50, v36
  v_lshlrev_b32 v50, 16, v37
  v_and_b32 v37, 0xffff0000, v37
  v_cvt_pk_f16_f32 v37, v50, v37
  v_lshlrev_b32 v50, 16, v38
  v_and_b32 v38, 0xffff0000, v38
  v_cvt_pk_f16_f32 v38, v50, v38
  v_lshlrev_b32 v50, 16, v39
  v_and_b32 v39, 0xffff0000, v39
  v_cvt_pk_f16_f32 v39, v50, v39
  v_lshlrev_b32 v50, 16, v40
  v_and_b32 v40, 0xffff0000, v40
  v_cvt_pk_f16_f32 v40, v50, v40
  v_lshlrev_b32 v50, 16, v41
  v_and_b32 v41, 0xffff0000, v41
  v_cvt_pk_f16_f32 v41, v50, v41
  v_mov_b32 v174, 0
  v_mov_b32 v175, 0
  v_mov_b32 v218, 0
  v_mov_b32 v219, 0
  v_mov_b32 v234, 0
  v_mov_b32 v235, 0
  v_mov_b32 v220, 0
  v_mov_b32 v221, 0
  v_mov_b32 v222, 0
  v_mov_b32 v223, 0
  v_mov_b32 v224, 0
  v_mov_b32 v225, 0
  v_mov_b32 v226, 0
  v_mov_b32 v227, 0
  s_waitcnt vmcnt(12)
  ds_read_b64_tr_b16 v[52:53], v99 offset:15360
  ds_read_b64_tr_b16 v[54:55], v99 offset:15744
  ds_read_b64_tr_b16 v[56:57], v99 offset:15392
  ds_read_b64_tr_b16 v[58:59], v99 offset:15776
  ds_read_b64_tr_b16 v[60:61], v99 offset:15424
  ds_read_b64_tr_b16 v[62:63], v99 offset:15808
  s_waitcnt lgkmcnt(0)
  v_lshlrev_b32 v50, 16, v52
  v_and_b32 v52, 0xffff0000, v52
  v_cvt_pk_f16_f32 v52, v50, v52
  v_accvgpr_write_b32 a0, v52
  v_lshlrev_b32 v50, 16, v53
  v_and_b32 v53, 0xffff0000, v53
  v_cvt_pk_f16_f32 v53, v50, v53
  v_accvgpr_write_b32 a1, v53
  v_lshlrev_b32 v50, 16, v54
  v_and_b32 v54, 0xffff0000, v54
  v_cvt_pk_f16_f32 v54, v50, v54
  v_accvgpr_write_b32 a2, v54
  v_lshlrev_b32 v50, 16, v55
  v_and_b32 v55, 0xffff0000, v55
  v_cvt_pk_f16_f32 v55, v50, v55
  v_accvgpr_write_b32 a3, v55
  v_lshlrev_b32 v50, 16, v56
  v_and_b32 v56, 0xffff0000, v56
  v_cvt_pk_f16_f32 v56, v50, v56
  v_accvgpr_write_b32 a20, v56
  v_lshlrev_b32 v50, 16, v57
  v_and_b32 v57, 0xffff0000, v57
  v_cvt_pk_f16_f32 v57, v50, v57
  v_accvgpr_write_b32 a21, v57
  v_lshlrev_b32 v50, 16, v58
  v_and_b32 v58, 0xffff0000, v58
  v_cvt_pk_f16_f32 v58, v50, v58
  v_accvgpr_write_b32 a22, v58
  v_lshlrev_b32 v50, 16, v59
  v_and_b32 v59, 0xffff0000, v59
  v_cvt_pk_f16_f32 v59, v50, v59
  v_accvgpr_write_b32 a23, v59
  v_lshlrev_b32 v50, 16, v60
  v_and_b32 v60, 0xffff0000, v60
  v_cvt_pk_f16_f32 v60, v50, v60
  v_accvgpr_write_b32 a40, v60
  v_lshlrev_b32 v50, 16, v61
  v_and_b32 v61, 0xffff0000, v61
  v_cvt_pk_f16_f32 v61, v50, v61
  v_accvgpr_write_b32 a41, v61
  v_lshlrev_b32 v50, 16, v62
  v_and_b32 v62, 0xffff0000, v62
  v_cvt_pk_f16_f32 v62, v50, v62
  v_accvgpr_write_b32 a42, v62
  v_lshlrev_b32 v50, 16, v63
  v_and_b32 v63, 0xffff0000, v63
  v_cvt_pk_f16_f32 v63, v50, v63
  v_accvgpr_write_b32 a43, v63
  s_waitcnt vmcnt(9)
  ds_read_b64_tr_b16 v[64:65], v99 offset:18432
  ds_read_b64_tr_b16 v[66:67], v99 offset:18816
  ds_read_b64_tr_b16 v[68:69], v99 offset:18464
  ds_read_b64_tr_b16 v[70:71], v99 offset:18848
  ds_read_b64_tr_b16 v[72:73], v99 offset:18496
  ds_read_b64_tr_b16 v[74:75], v99 offset:18880
  s_waitcnt lgkmcnt(0)
  v_lshlrev_b32 v50, 16, v64
  v_and_b32 v64, 0xffff0000, v64
  v_cvt_pk_f16_f32 v64, v50, v64
  v_accvgpr_write_b32 a4, v64
  v_lshlrev_b32 v50, 16, v65
  v_and_b32 v65, 0xffff0000, v65
  v_cvt_pk_f16_f32 v65, v50, v65
  v_accvgpr_write_b32 a5, v65
  v_lshlrev_b32 v50, 16, v66
  v_and_b32 v66, 0xffff0000, v66
  v_cvt_pk_f16_f32 v66, v50, v66
  v_accvgpr_write_b32 a6, v66
  v_lshlrev_b32 v50, 16, v67
  v_and_b32 v67, 0xffff0000, v67
  v_cvt_pk_f16_f32 v67, v50, v67
  v_accvgpr_write_b32 a7, v67
  v_lshlrev_b32 v50, 16, v68
  v_and_b32 v68, 0xffff0000, v68
  v_cvt_pk_f16_f32 v68, v50, v68
  v_accvgpr_write_b32 a24, v68
  v_lshlrev_b32 v50, 16, v69
  v_and_b32 v69, 0xffff0000, v69
  v_cvt_pk_f16_f32 v69, v50, v69
  v_accvgpr_write_b32 a25, v69
  v_lshlrev_b32 v50, 16, v70
  v_and_b32 v70, 0xffff0000, v70
  v_cvt_pk_f16_f32 v70, v50, v70
  v_accvgpr_write_b32 a26, v70
  v_lshlrev_b32 v50, 16, v71
  v_and_b32 v71, 0xffff0000, v71
  v_cvt_pk_f16_f32 v71, v50, v71
  v_accvgpr_write_b32 a27, v71
  v_lshlrev_b32 v50, 16, v72
  v_and_b32 v72, 0xffff0000, v72
  v_cvt_pk_f16_f32 v72, v50, v72
  v_accvgpr_write_b32 a44, v72
  v_lshlrev_b32 v50, 16, v73
  v_and_b32 v73, 0xffff0000, v73
  v_cvt_pk_f16_f32 v73, v50, v73
  v_accvgpr_write_b32 a45, v73
  v_lshlrev_b32 v50, 16, v74
  v_and_b32 v74, 0xffff0000, v74
  v_cvt_pk_f16_f32 v74, v50, v74
  v_accvgpr_write_b32 a46, v74
  v_lshlrev_b32 v50, 16, v75
  v_and_b32 v75, 0xffff0000, v75
  v_cvt_pk_f16_f32 v75, v50, v75
  v_accvgpr_write_b32 a47, v75
  s_waitcnt vmcnt(6)
  ds_read_b64_tr_b16 v[76:77], v99 offset:21504
  ds_read_b64_tr_b16 v[78:79], v99 offset:21888
  ds_read_b64_tr_b16 v[80:81], v99 offset:21536
  ds_read_b64_tr_b16 v[82:83], v99 offset:21920
  ds_read_b64_tr_b16 v[84:85], v99 offset:21568
  ds_read_b64_tr_b16 v[86:87], v99 offset:21952
  s_waitcnt lgkmcnt(0)
  v_lshlrev_b32 v50, 16, v76
  v_and_b32 v76, 0xffff0000, v76
  v_cvt_pk_f16_f32 v76, v50, v76
  v_accvgpr_write_b32 a8, v76
  v_lshlrev_b32 v50, 16, v77
  v_and_b32 v77, 0xffff0000, v77
  v_cvt_pk_f16_f32 v77, v50, v77
  v_accvgpr_write_b32 a9, v77
  v_lshlrev_b32 v50, 16, v78
  v_and_b32 v78, 0xffff0000, v78
  v_cvt_pk_f16_f32 v78, v50, v78
  v_accvgpr_write_b32 a10, v78
  v_lshlrev_b32 v50, 16, v79
  v_and_b32 v79, 0xffff0000, v79
  v_cvt_pk_f16_f32 v79, v50, v79
  v_accvgpr_write_b32 a11, v79
  v_lshlrev_b32 v50, 16, v80
  v_and_b32 v80, 0xffff0000, v80
  v_cvt_pk_f16_f32 v80, v50, v80
  v_accvgpr_write_b32 a28, v80
  v_lshlrev_b32 v50, 16, v81
  v_and_b32 v81, 0xffff0000, v81
  v_cvt_pk_f16_f32 v81, v50, v81
  v_accvgpr_write_b32 a29, v81
  v_lshlrev_b32 v50, 16, v82
  v_and_b32 v82, 0xffff0000, v82
  v_cvt_pk_f16_f32 v82, v50, v82
  v_accvgpr_write_b32 a30, v82
  v_lshlrev_b32 v50, 16, v83
  v_and_b32 v83, 0xffff0000, v83
  v_cvt_pk_f16_f32 v83, v50, v83
  v_accvgpr_write_b32 a31, v83
  v_lshlrev_b32 v50, 16, v84
  v_and_b32 v84, 0xffff0000, v84
  v_cvt_pk_f16_f32 v84, v50, v84
  v_accvgpr_write_b32 a48, v84
  v_lshlrev_b32 v50, 16, v85
  v_and_b32 v85, 0xffff0000, v85
  v_cvt_pk_f16_f32 v85, v50, v85
  v_accvgpr_write_b32 a49, v85
  v_lshlrev_b32 v50, 16, v86
  v_and_b32 v86, 0xffff0000, v86
  v_cvt_pk_f16_f32 v86, v50, v86
  v_accvgpr_write_b32 a50, v86
  v_lshlrev_b32 v50, 16, v87
  v_and_b32 v87, 0xffff0000, v87
  v_cvt_pk_f16_f32 v87, v50, v87
  v_accvgpr_write_b32 a51, v87
  s_waitcnt vmcnt(3)
  ds_read_b64_tr_b16 v[52:53], v99 offset:24576
  ds_read_b64_tr_b16 v[54:55], v99 offset:24960
  ds_read_b64_tr_b16 v[56:57], v99 offset:24608
  ds_read_b64_tr_b16 v[58:59], v99 offset:24992
  ds_read_b64_tr_b16 v[60:61], v99 offset:24640
  ds_read_b64_tr_b16 v[62:63], v99 offset:25024
  s_waitcnt lgkmcnt(0)
  v_lshlrev_b32 v50, 16, v52
  v_and_b32 v52, 0xffff0000, v52
  v_cvt_pk_f16_f32 v52, v50, v52
  v_accvgpr_write_b32 a12, v52
  v_lshlrev_b32 v50, 16, v53
  v_and_b32 v53, 0xffff0000, v53
  v_cvt_pk_f16_f32 v53, v50, v53
  v_accvgpr_write_b32 a13, v53
  v_lshlrev_b32 v50, 16, v54
  v_and_b32 v54, 0xffff0000, v54
  v_cvt_pk_f16_f32 v54, v50, v54
  v_accvgpr_write_b32 a14, v54
  v_lshlrev_b32 v50, 16, v55
  v_and_b32 v55, 0xffff0000, v55
  v_cvt_pk_f16_f32 v55, v50, v55
  v_accvgpr_write_b32 a15, v55
  v_lshlrev_b32 v50, 16, v56
  v_and_b32 v56, 0xffff0000, v56
  v_cvt_pk_f16_f32 v56, v50, v56
  v_accvgpr_write_b32 a32, v56
  v_lshlrev_b32 v50, 16, v57
  v_and_b32 v57, 0xffff0000, v57
  v_cvt_pk_f16_f32 v57, v50, v57
  v_accvgpr_write_b32 a33, v57
  v_lshlrev_b32 v50, 16, v58
  v_and_b32 v58, 0xffff0000, v58
  v_cvt_pk_f16_f32 v58, v50, v58
  v_accvgpr_write_b32 a34, v58
  v_lshlrev_b32 v50, 16, v59
  v_and_b32 v59, 0xffff0000, v59
  v_cvt_pk_f16_f32 v59, v50, v59
  v_accvgpr_write_b32 a35, v59
  v_lshlrev_b32 v50, 16, v60
  v_and_b32 v60, 0xffff0000, v60
  v_cvt_pk_f16_f32 v60, v50, v60
  v_accvgpr_write_b32 a52, v60
  v_lshlrev_b32 v50, 16, v61
  v_and_b32 v61, 0xffff0000, v61
  v_cvt_pk_f16_f32 v61, v50, v61
  v_accvgpr_write_b32 a53, v61
  v_lshlrev_b32 v50, 16, v62
  v_and_b32 v62, 0xffff0000, v62
  v_cvt_pk_f16_f32 v62, v50, v62
  v_accvgpr_write_b32 a54, v62
  v_lshlrev_b32 v50, 16, v63
  v_and_b32 v63, 0xffff0000, v63
  v_cvt_pk_f16_f32 v63, v50, v63
  v_accvgpr_write_b32 a55, v63
  s_waitcnt vmcnt(0)
  ds_read_b64_tr_b16 v[64:65], v99 offset:27648
  ds_read_b64_tr_b16 v[66:67], v99 offset:28032
  ds_read_b64_tr_b16 v[68:69], v99 offset:27680
  ds_read_b64_tr_b16 v[70:71], v99 offset:28064
  ds_read_b64_tr_b16 v[72:73], v99 offset:27712
  ds_read_b64_tr_b16 v[74:75], v99 offset:28096
  s_waitcnt lgkmcnt(0)
  v_lshlrev_b32 v50, 16, v64
  v_and_b32 v64, 0xffff0000, v64
  v_cvt_pk_f16_f32 v64, v50, v64
  v_accvgpr_write_b32 a16, v64
  v_lshlrev_b32 v50, 16, v65
  v_and_b32 v65, 0xffff0000, v65
  v_cvt_pk_f16_f32 v65, v50, v65
  v_accvgpr_write_b32 a17, v65
  v_lshlrev_b32 v50, 16, v66
  v_and_b32 v66, 0xffff0000, v66
  v_cvt_pk_f16_f32 v66, v50, v66
  v_accvgpr_write_b32 a18, v66
  v_lshlrev_b32 v50, 16, v67
  v_and_b32 v67, 0xffff0000, v67
  v_cvt_pk_f16_f32 v67, v50, v67
  v_accvgpr_write_b32 a19, v67
  v_lshlrev_b32 v50, 16, v68
  v_and_b32 v68, 0xffff0000, v68
  v_cvt_pk_f16_f32 v68, v50, v68
  v_accvgpr_write_b32 a36, v68
  v_lshlrev_b32 v50, 16, v69
  v_and_b32 v69, 0xffff0000, v69
  v_cvt_pk_f16_f32 v69, v50, v69
  v_accvgpr_write_b32 a37, v69
  v_lshlrev_b32 v50, 16, v70
  v_and_b32 v70, 0xffff0000, v70
  v_cvt_pk_f16_f32 v70, v50, v70
  v_accvgpr_write_b32 a38, v70
  v_lshlrev_b32 v50, 16, v71
  v_and_b32 v71, 0xffff0000, v71
  v_cvt_pk_f16_f32 v71, v50, v71
  v_accvgpr_write_b32 a39, v71
  v_lshlrev_b32 v50, 16, v72
  v_and_b32 v72, 0xffff0000, v72
  v_cvt_pk_f16_f32 v72, v50, v72
  v_accvgpr_write_b32 a56, v72
  v_lshlrev_b32 v50, 16, v73
  v_and_b32 v73, 0xffff0000, v73
  v_cvt_pk_f16_f32 v73, v50, v73
  v_accvgpr_write_b32 a57, v73
  v_lshlrev_b32 v50, 16, v74
  v_and_b32 v74, 0xffff0000, v74
  v_cvt_pk_f16_f32 v74, v50, v74
  v_accvgpr_write_b32 a58, v74
  v_lshlrev_b32 v50, 16, v75
  v_and_b32 v75, 0xffff0000, v75
  v_cvt_pk_f16_f32 v75, v50, v75
  v_accvgpr_write_b32 a59, v75
  s_waitcnt vmcnt(0)
  s_barrier
  s_add_u32 s12, s44, 81068032
  s_addc_u32 s13, s45, 0
  s_mov_b32 s14, 116736
  s_mov_b32 s15, 0x00020000
  s_add_u32 s28, s44, 114294784
  s_addc_u32 s29, s45, 0
  s_mov_b32 s30, 83886080
  s_mov_b32 s31, 0x00020000
  s_mul_i32 s64, s59, 40960
  s_lshl_b32 s21, s87, 10
  s_add_u32 s64, s64, s21
  s_add_u32 s64, s64, 1310720
  s_lshl_b32 s79, s59, 7
  s_and_b32 s21, s51, 12
  s_add_u32 s79, s79, s21
  s_add_u32 s79, s79, 95232
  v_mov_b32 v94, 0
  v_mov_b32 v95, 0
  s_lshl_b32 s90, s58, 7
  s_lshl_b32 s21, s56, 3
  s_add_u32 s90, s90, s21
  s_add_u32 s90, s90, 19456
  s_cmp_eq_u32 s56, 0
  s_cselect_b32 s65, s90, 0x80000000
  s_mov_b32 s69, 0
  v_lshlrev_b32 v88, 3, v1
  s_cmp_lg_u32 s20, 0
  s_cbranch_scc1 fm_9
  s_bfe_u32 s82, s50, 0x10001
  s_lshl_b32 s82, s82, 5
  s_lshr_b32 s21, s50, 2
  s_add_u32 s82, s82, s21
  s_and_b32 s80, s50, 1
  s_lshl_b32 s80, s80, 4
  s_add_u32 s80, s80, 16
  s_mov_b32 s101, 0
  s_branch fm_10
fm_8:
  s_sleep 8
  buffer_load_dword v238, v239, s[32:35], 0 offen sc1
  s_add_u32 s101, s101, 1
  s_cmp_gt_u32 s101, 131072
  s_cbranch_scc1 end0
  s_waitcnt vmcnt(0)
fm_10:
  v_readlane_b32 s22, v238, 0
  v_readlane_b32 s23, v238, 32
  s_add_u32 s22, s22, s23
  v_readlane_b32 s23, v238, 1
  s_add_u32 s22, s22, s23
  v_readlane_b32 s23, v238, 33
  s_add_u32 s22, s22, s23
  v_readlane_b32 s23, v238, 2
  s_add_u32 s22, s22, s23
  v_readlane_b32 s23, v238, 34
  s_add_u32 s22, s22, s23
  v_readlane_b32 s23, v238, 3
  s_add_u32 s22, s22, s23
  v_readlane_b32 s23, v238, 35
  s_add_u32 s22, s22, s23
  v_readlane_b32 s21, v238, 19
  v_readlane_b32 s23, v238, 21
  s_cmp_ge_u32 s22, 256
  s_cselect_b32 s23, s23, 0
  s_cmp_ge_u32 s21, 32
  s_cselect_b32 s23, s23, 0
  s_cmp_eq_u32 s23, 0
  s_cbranch_scc1 fm_8
  v_readlane_b32 s21, v238, s82
  s_cmp_ge_u32 s21, s80
  s_cselect_b32 s81, 1, 0
  s_andn2_b32 s53, s81, s53
  v_mov_b32 v244, s23
  v_mov_b32 v245, s53
  v_mov_b32 v236, 0
  ds_write_b64 v236, v[244:245]
  s_waitcnt lgkmcnt(0)
fm_9:
  s_barrier
  v_mov_b32 v236, 0
  ds_read_b64 v[244:245], v236
  buffer_load_dword v94, v95, s[12:15], s79 offen sc1
  s_and_b32 s21, s51, 3
  s_mul_i32 s21, s21, 540672
  buffer_load_dwordx2 v[96:97], v9, s[8:11], s21 offen sc1
  buffer_load_dwordx4 v[96:99], v8, s[8:11], s21 offen offset:0 sc1
  buffer_load_dwordx4 v[96:99], v8, s[8:11], s21 offen offset:1024 sc1
  buffer_load_dwordx4 v[96:99], v10, s[8:11], s21 offen offset:0 sc1
  buffer_load_dwordx4 v[96:99], v10, s[8:11], s21 offen offset:1024 sc1
  buffer_load_dwordx4 v[96:99], v10, s[8:11], s21 offen offset:2048 sc1
  s_waitcnt lgkmcnt(0)
  v_readfirstlane_b32 s53, v245
  v_add_u32 v237, -1, v244
  v_lshlrev_b32 v237, 13, v237
  v_xor_b32 v237, 0, v237
  v_add_u32 v13, v13, v237
  v_add_u32 v4, v4, v237
  s_lshl_b32 s21, s50, 7
  s_add_u32 s21, s21, 0
  s_cmp_lg_u32 s20, 0
  s_cbranch_scc1 wf_12
  v_mov_b32 v240, 0
  s_mov_b32 s101, 0
wf_11:
  buffer_load_dword v241, v240, s[12:15], s21 offen sc1
  s_add_u32 s101, s101, 1
  s_cmp_gt_u32 s101, 131072
  s_cbranch_scc1 end0
  s_waitcnt vmcnt(0)
  v_readfirstlane_b32 s100, v241
  s_cmp_ge_u32 s100, 8
  s_cbranch_scc1 wf_12
  s_sleep 6
  s_branch wf_11
wf_12:
  s_barrier
  s_cmp_ge_u32 s20, 2
  s_cbranch_scc1 pf_13
  buffer_load_dwordx4 v[168:171], v18, s[16:19], 0 offen sc1
  buffer_load_dwordx2 v[172:173], v20, s[16:19], 0 offen sc1
pf_13:
  s_waitcnt vmcnt(6)
  v_readfirstlane_b32 s21, v94
  s_mov_b32 s87, 1
  s_cmp_eq_u32 s21, 0
  s_cbranch_scc1 pf_14
  s_mov_b32 s87, 0
  s_sub_u32 s21, s64, 1310720
  buffer_load_dwordx4 v[176:179], v16, s[28:31], s21 offen offset:0 sc1
  buffer_load_dwordx4 v[180:183], v16, s[28:31], s21 offen offset:1024 sc1
  buffer_load_dwordx4 v[184:187], v16, s[28:31], s21 offen offset:2048 sc1
pf_14:
  v_add_u32 v242, 1088, v5
  v_add_u32 v243, 2176, v5
  v_add_u32 v244, 3264, v5
  v_add_u32 v245, 4352, v5
  s_mov_b32 s52, 0
  s_mov_b32 s89, 0x05040100
  v_mov_b32 v52, 0
  v_mov_b32 v53, 0
  v_mov_b32 v54, 0
  v_mov_b32 v55, 0
  v_mov_b32 v56, 0
  v_mov_b32 v57, 0
  v_mov_b32 v58, 0
  v_mov_b32 v59, 0
  v_mov_b32 v60, 0
  v_mov_b32 v61, 0
  v_mov_b32 v62, 0
  v_mov_b32 v63, 0
  v_mov_b32 v64, 0
  v_mov_b32 v65, 0
  v_mov_b32 v66, 0
  v_mov_b32 v67, 0
  v_mov_b32 v68, 0
  v_mov_b32 v69, 0
  v_mov_b32 v70, 0
  v_mov_b32 v71, 0
  v_mov_b32 v72, 0
  v_mov_b32 v73, 0
  v_mov_b32 v74, 0
  v_mov_b32 v75, 0
  v_mov_b32 v76, 0
  v_mov_b32 v77, 0
  v_mov_b32 v78, 0
  v_mov_b32 v79, 0
  v_mov_b32 v80, 0
  v_mov_b32 v81, 0
  v_mov_b32 v82, 0
  v_mov_b32 v83, 0
  v_mov_b32 v84, 0
  v_mov_b32 v85, 0
  v_mov_b32 v86, 0
  v_mov_b32 v87, 0
  v_mov_b32 v156, 0
  v_mov_b32 v157, 0
  v_mov_b32 v158, 0
  v_mov_b32 v159, 0
  s_and_b32 s21, s52, 3
  s_mul_i32 s81, s21, 540672
  s_lshl_b32 s84, s21, 15
  s_add_u32 s21, s52, 2
  s_and_b32 s21, s21, 3
  s_mul_i32 s82, s21, 540672
  s_add_u32 s21, s52, 3
  s_and_b32 s21, s21, 3
  s_lshl_b32 s83, s21, 15
  s_add_u32 s21, s52, 1
  s_and_b32 s22, s21, 3
  s_lshl_b32 s3, s22, 15
  s_mul_i32 s80, s21, 393216
  s_add_u32 s46, s21, 1
  s_min_u32 s46, s46, 64
  s_mul_i32 s85, s52, 98304
  s_mul_i32 s57, s52, 327680
  s_add_u32 s57, s57, 42991616

  s_bfe_u32 s88, s52, 0x10002
  s_add_u32 s78, s81, 278528
  s_max_u32 s21, s52, 1
  s_sub_u32 s21, s21, 1
  s_cmp_lt_u32 s52, 60
  s_cselect_b32 s66, s65, 0x80000000
  s_cselect_b32 s68, 15, 1
  s_cmp_ge_u32 s52, 61
  s_cselect_b32 s66, s90, s66
  s_cselect_b32 s67, s52, s21
  s_cmp_eq_u32 s53, 0
  s_cbranch_scc1 A1_19
  s_cmp_eq_u32 s20, 0
  s_cbranch_scc1 A1_15
  s_cmp_eq_u32 s20, 1
  s_cbranch_scc1 A1_16
  s_cmp_eq_u32 s20, 2
  s_cbranch_scc1 A1_17
  s_cmp_eq_u32 s20, 3
  s_cbranch_scc1 A1_18
  s_branch A1_19
step_20:
  s_add_u32 s21, s52, 2
  s_and_b32 s21, s21, 3
  s_mul_i32 s82, s21, 540672
  s_add_u32 s21, s52, 3
  s_and_b32 s21, s21, 3
  s_lshl_b32 s83, s21, 15
  s_add_u32 s21, s52, 1
  s_and_b32 s22, s21, 3
  s_lshl_b32 s3, s22, 15
  s_mul_i32 s80, s21, 393216
  s_add_u32 s46, s21, 1
  s_min_u32 s46, s46, 64
  s_mul_i32 s85, s52, 98304
  s_mul_i32 s57, s52, 327680
  s_add_u32 s57, s57, 42991616

  s_bfe_u32 s88, s52, 0x10002
  s_add_u32 s78, s81, 278528
  s_max_u32 s21, s52, 1
  s_sub_u32 s21, s21, 1
  s_cmp_lt_u32 s52, 60
  s_cselect_b32 s66, s65, 0x80000000
  s_cselect_b32 s68, 15, 1
  s_cmp_ge_u32 s52, 61
  s_cselect_b32 s66, s90, s66
  s_cselect_b32 s67, s52, s21
  v_mov_b32 v52, 0
  v_mov_b32 v53, 0
  v_mov_b32 v54, 0
  v_mov_b32 v55, 0
  v_mov_b32 v56, 0
  v_mov_b32 v57, 0
  v_mov_b32 v58, 0
  v_mov_b32 v59, 0
  v_mov_b32 v60, 0
  v_mov_b32 v61, 0
  v_mov_b32 v62, 0
  v_mov_b32 v63, 0
  v_mov_b32 v64, 0
  v_mov_b32 v65, 0
  v_mov_b32 v66, 0
  v_mov_b32 v67, 0
  v_mov_b32 v68, 0
  v_mov_b32 v69, 0
  v_mov_b32 v70, 0
  v_mov_b32 v71, 0
  v_mov_b32 v72, 0
  v_mov_b32 v73, 0
  v_mov_b32 v74, 0
  v_mov_b32 v75, 0
  v_mov_b32 v76, 0
  v_mov_b32 v77, 0
  v_mov_b32 v78, 0
  v_mov_b32 v79, 0
  v_mov_b32 v80, 0
  v_mov_b32 v81, 0
  v_mov_b32 v82, 0
  v_mov_b32 v83, 0
  v_mov_b32 v84, 0
  v_mov_b32 v85, 0
  v_mov_b32 v86, 0
  v_mov_b32 v87, 0
  s_sleep 4
  s_cmp_lt_i32 s55, 0
  s_cbranch_scc1 fl_24
fl_25:
  s_mov_b32 s54, 0
  buffer_load_dwordx4 v[32:35], v4, s[4:7], s84 offen offset:0 sc1
  buffer_load_dwordx4 v[36:39], v4, s[4:7], s84 offen offset:1024 sc1
  buffer_load_dwordx4 v[40:43], v4, s[4:7], s84 offen offset:2048 sc1
  s_waitcnt vmcnt(3)
  v_mov_b32 v176, v160
  v_mov_b32 v177, v161
  v_mov_b32 v178, v162
  v_mov_b32 v179, v163
  v_mov_b32 v180, v164
  v_mov_b32 v181, v165
  v_mov_b32 v182, v166
  v_mov_b32 v183, v167
  v_mov_b32 v184, v48
  v_mov_b32 v185, v49
  v_mov_b32 v186, v50
  v_mov_b32 v187, v51
  s_waitcnt vmcnt(0)
  v_bitop3_b32 v27, v35, v39, v43 bitop3:0x80
  v_perm_b32 v35, v39, v35, s89
  v_cmp_gt_u32 vcc, 0x48000000, v27
  v_mov_b32 v39, v42
  s_cbranch_vccnz pm_22
A1_15:
  v_smfmac_f32_16x16x32_f16 v[52:55], v[40:41], a[16:19], v44
  v_smfmac_f32_16x16x32_f16 v[64:67], v[40:41], a[76:79], v44
  v_smfmac_f32_16x16x32_f16 v[56:59], v[40:41], a[36:39], v44
  v_smfmac_f32_16x16x64_f16 v[52:55], v[32:35], a[0:7], v44
  v_smfmac_f32_16x16x64_f16 v[52:55], v[36:39], a[8:15], v44
  v_smfmac_f32_16x16x32_f16 v[68:71], v[40:41], a[96:99], v44
  v_smfmac_f32_16x16x64_f16 v[64:67], v[32:35], a[60:67], v44
  v_smfmac_f32_16x16x64_f16 v[64:67], v[36:39], a[68:75], v44
  v_smfmac_f32_16x16x32_f16 v[60:63], v[40:41], a[56:59], v44
  v_smfmac_f32_16x16x64_f16 v[56:59], v[32:35], a[20:27], v44
  v_smfmac_f32_16x16x64_f16 v[56:59], v[36:39], a[28:35], v44
  v_permlane32_swap_b32 v52, v64
  v_smfmac_f32_16x16x32_f16 v[72:75], v[40:41], a[116:119], v44
  v_permlane32_swap_b32 v53, v65
  v_add_f32 v52, v52, v64
  v_add_f32 v53, v53, v65
  v_smfmac_f32_16x16x64_f16 v[68:71], v[32:35], a[80:87], v44
  ds_write2_b32 v5, v52, v53 offset0:0 offset1:4
  v_smfmac_f32_16x16x64_f16 v[68:71], v[36:39], a[88:95], v44
  v_permlane32_swap_b32 v54, v66
  v_smfmac_f32_16x16x32_f16 v[76:79], v[40:41], a[136:139], v44
  v_permlane32_swap_b32 v55, v67
  v_add_f32 v54, v54, v66
  v_add_f32 v55, v55, v67
  v_smfmac_f32_16x16x64_f16 v[60:63], v[32:35], a[40:47], v44
  ds_write2_b32 v5, v54, v55 offset0:8 offset1:12
  v_smfmac_f32_16x16x64_f16 v[60:63], v[36:39], a[48:55], v44
  v_permlane32_swap_b32 v56, v68
  v_smfmac_f32_16x16x32_f16 v[80:83], v[40:41], a[156:159], v44
  v_permlane32_swap_b32 v57, v69
  v_add_f32 v56, v56, v68
  v_add_f32 v57, v57, v69
  v_smfmac_f32_16x16x64_f16 v[72:75], v[32:35], a[100:107], v44
  ds_write2_b32 v242, v56, v57 offset0:0 offset1:4
  v_smfmac_f32_16x16x64_f16 v[72:75], v[36:39], a[108:115], v44
  v_permlane32_swap_b32 v58, v70
  v_smfmac_f32_16x16x32_f16 v[84:87], v[40:41], a[176:179], v44
  v_permlane32_swap_b32 v59, v71
  v_add_f32 v58, v58, v70
  v_add_f32 v59, v59, v71
  v_smfmac_f32_16x16x64_f16 v[76:79], v[32:35], a[120:127], v44
  ds_write2_b32 v242, v58, v59 offset0:8 offset1:12
  v_smfmac_f32_16x16x64_f16 v[76:79], v[36:39], a[128:135], v44
  v_permlane32_swap_b32 v60, v72
  v_smfmac_f32_16x16x64_f16 v[80:83], v[32:35], a[140:147], v44
  v_permlane32_swap_b32 v61, v73
  v_add_f32 v60, v60, v72
  v_smfmac_f32_16x16x64_f16 v[80:83], v[36:39], a[148:155], v44
  v_add_f32 v61, v61, v73
  ds_write2_b32 v243, v60, v61 offset0:0 offset1:4
  v_smfmac_f32_16x16x64_f16 v[84:87], v[32:35], a[160:167], v44
  v_permlane32_swap_b32 v62, v74
  v_smfmac_f32_16x16x64_f16 v[84:87], v[36:39], a[168:175], v44
  v_permlane32_swap_b32 v63, v75
  v_add_f32 v62, v62, v74
  v_add_f32 v63, v63, v75
  ds_write2_b32 v243, v62, v63 offset0:8 offset1:12
  v_permlane32_swap_b32 v76, v80
  v_permlane32_swap_b32 v77, v81
  v_add_f32 v76, v76, v80
  v_add_f32 v77, v77, v81
  ds_write2_b32 v244, v76, v77 offset0:0 offset1:4
  v_permlane32_swap_b32 v78, v82
  v_permlane32_swap_b32 v79, v83
  v_add_f32 v78, v78, v82
  v_add_f32 v79, v79, v83
  ds_write2_b32 v244, v78, v79 offset0:8 offset1:12
  ds_write2_b32 v245, v84, v85 offset0:0 offset1:4
  ds_write2_b32 v245, v86, v87 offset0:8 offset1:12
  s_waitcnt lgkmcnt(0) vmcnt(0)
  s_barrier
  ds_read_b128 v[96:99], v45 offset:0
  ds_read_b128 v[108:111], v45 offset:5440
  ds_read_b128 v[100:103], v45 offset:1088
  ds_read_b128 v[112:115], v45 offset:6528
  ds_read_b128 v[104:107], v45 offset:2176
  ds_read_b128 v[116:119], v45 offset:7616
  s_waitcnt lgkmcnt(4)
  v_pk_add_f32 v[96:97], v[96:97], v[108:109]
  v_pk_add_f32 v[98:99], v[98:99], v[110:111]
  s_nop 0
  v_add_f32_dpp v108, v96, v96 row_ror:8 row_mask:0xf bank_mask:0xf
  v_add_f32_dpp v109, v97, v97 row_ror:8 row_mask:0xf bank_mask:0xf
  v_add_f32_dpp v110, v98, v98 row_ror:8 row_mask:0xf bank_mask:0xf
  v_add_f32_dpp v111, v99, v99 row_ror:8 row_mask:0xf bank_mask:0xf
  v_cvt_pk_bf16_f32 v212, v108, v109
  v_cvt_pk_bf16_f32 v213, v110, v111
  s_waitcnt lgkmcnt(2)
  v_pk_add_f32 v[100:101], v[100:101], v[112:113]
  v_pk_add_f32 v[102:103], v[102:103], v[114:115]
  s_nop 0
  v_add_f32_dpp v112, v100, v100 row_ror:8 row_mask:0xf bank_mask:0xf
  v_add_f32_dpp v113, v101, v101 row_ror:8 row_mask:0xf bank_mask:0xf
  v_add_f32_dpp v114, v102, v102 row_ror:8 row_mask:0xf bank_mask:0xf
  v_add_f32_dpp v115, v103, v103 row_ror:8 row_mask:0xf bank_mask:0xf
  v_cvt_pk_bf16_f32 v214, v112, v113
  v_cvt_pk_bf16_f32 v215, v114, v115
  s_waitcnt lgkmcnt(0)
  v_pk_add_f32 v[104:105], v[104:105], v[116:117]
  v_pk_add_f32 v[106:107], v[106:107], v[118:119]
  v_mfma_f32_16x16x32_bf16 v[96:99], v[168:171], v[212:215], 0
  v_add_f32_dpp v116, v104, v104 row_ror:8 row_mask:0xf bank_mask:0xf
  v_add_f32_dpp v117, v105, v105 row_ror:8 row_mask:0xf bank_mask:0xf
  v_add_f32_dpp v118, v106, v106 row_ror:8 row_mask:0xf bank_mask:0xf
  v_add_f32_dpp v119, v107, v107 row_ror:8 row_mask:0xf bank_mask:0xf
  v_cvt_pk_bf16_f32 v216, v116, v117
  v_cvt_pk_bf16_f32 v217, v118, v119
  s_nop 1
  v_mfma_f32_16x16x32_bf16 v[96:99], v[172:175], v[216:219], v[96:99]
  s_mov_b64 exec, s[74:75]
  s_nop 6
  v_cvt_pk_f16_f32 v100, v96, v97
  v_cvt_pk_f16_f32 v101, v98, v99
  v_and_or_b32 v100, v100, -2, s88
  buffer_store_dwordx2 v[100:101], v7, s[8:11], s81 offen
  s_mov_b64 exec, -1
  s_cmp_eq_u32 s52, 63
  s_cbranch_scc1 last_21
  s_sleep 5
  s_mov_b32 s54, 0
  buffer_load_dwordx2 v[248:249], v9, s[8:11], s81 offen sc1
  buffer_load_dwordx4 v[112:115], v8, s[8:11], s81 offen offset:0 sc1
  buffer_load_dwordx4 v[116:119], v8, s[8:11], s81 offen offset:1024 sc1
  s_sleep 2
  buffer_load_dwordx4 v[144:147], v10, s[8:11], s81 offen offset:0 sc1
  buffer_load_dwordx4 v[148:151], v10, s[8:11], s81 offen offset:1024 sc1
  buffer_load_dwordx4 v[152:155], v10, s[8:11], s81 offen offset:2048 sc1
  v_mov_b32 v188, 0
  v_mov_b32 v189, 0
  v_mov_b32 v190, 0
  v_mov_b32 v191, 0
  v_mov_b32 v192, 0
  v_mov_b32 v193, 0
  v_mov_b32 v194, 0
  v_mov_b32 v195, 0
  v_mov_b32 v196, 0
  v_mov_b32 v197, 0
  v_mov_b32 v198, 0
  v_mov_b32 v199, 0
  v_readfirstlane_b32 s21, v94
  s_add_u32 s22, s46, 2
  s_min_u32 s22, s22, 64
  s_sub_u32 s55, s21, s22
  s_sub_u32 s56, s21, s46
  s_waitcnt vmcnt(5)
  v_xor_b32 v96, s88, v248
  s_nop 0
  v_permlane16_swap_b32 v248, v249
  v_fma_mix_f32 v250, v248, 1.0, v249 op_sel:[0,0,0] op_sel_hi:[1,0,1]
  v_fma_mix_f32 v251, v248, 1.0, v249 op_sel:[1,0,1] op_sel_hi:[1,0,1]
  v_mov_b32 v248, v250
  v_mov_b32 v249, v251
  s_nop 0
  v_permlane32_swap_b32 v248, v250
  v_permlane32_swap_b32 v249, v251
  s_waitcnt vmcnt(3)
  v_bitop3_b32 v97, v112, v114, s88 bitop3:0x7e
  v_bitop3_b32 v98, v116, v118, s88 bitop3:0x7e
  v_fma_mix_f32 v120, v112, 1.0, v116 op_sel:[0,0,0] op_sel_hi:[1,0,1]
  v_or3_b32 v27, v96, v97, v98
  v_fma_mix_f32 v124, v114, 1.0, v118 op_sel:[0,0,0] op_sel_hi:[1,0,1]
  v_and_b32 v27, 1, v27
  v_fma_mix_f32 v121, v112, 1.0, v116 op_sel:[1,0,1] op_sel_hi:[1,0,1]
  v_cmp_ne_u32 vcc, 0, v27
  v_fma_mix_f32 v125, v114, 1.0, v118 op_sel:[1,0,1] op_sel_hi:[1,0,1]
  v_fma_mix_f32 v122, v113, 1.0, v117 op_sel:[0,0,0] op_sel_hi:[1,0,1]
  v_fma_mix_f32 v126, v115, 1.0, v119 op_sel:[0,0,0] op_sel_hi:[1,0,1]
  s_cbranch_vccnz psr_27
psj_28:
  s_cmp_lt_i32 s56, 0
  s_cbranch_scc1 kvw_30
kvok_31:
  v_fma_mix_f32 v123, v113, 1.0, v117 op_sel:[1,0,1] op_sel_hi:[1,0,1]
  v_fma_mix_f32 v127, v115, 1.0, v119 op_sel:[1,0,1] op_sel_hi:[1,0,1]
  v_permlane32_swap_b32 v120, v124
  v_permlane32_swap_b32 v121, v125
  v_permlane32_swap_b32 v122, v126
  v_permlane32_swap_b32 v123, v127
  v_pk_add_f32 v[120:121], v[120:121], v[124:125]
  v_pk_add_f32 v[122:123], v[122:123], v[126:127]
  v_pk_add_f32 v[124:125], v[248:249], v[250:251]
  v_max3_f32 v236, v120, v121, v122
  v_max3_f32 v237, v123, v124, v125
  v_max_f32 v236, v236, v237
  s_nop 1
  v_max_f32_dpp v236, v236, v236 row_ror:8 row_mask:0xf bank_mask:0xf
  v_mov_b32 v237, v236
  s_nop 1
  v_permlane32_swap_b32 v236, v237
  v_max_f32 v236, v236, v237
  v_mov_b32 v237, v236
  s_nop 1
  v_permlane16_swap_b32 v236, v237
  v_max_f32 v236, v236, v237
  s_waitcnt vmcnt(0)
  v_max3_u32 v27, v144, v146, v148
  v_max3_u32 v27, v27, v150, v152
  v_max3_u32 v27, v27, v154, v154
  v_cmp_eq_u32 vcc, -1, v27
  s_nop 1
  s_cbranch_vccnz pv_26
pvj_29:
  v_mul_f32 v236, s86, v236
  v_smfmac_f32_16x16x64_bf16 v[188:191], v[144:147], a[180:187], v44
  v_fma_f32 v120, v120, s86, -v236
  v_smfmac_f32_16x16x64_bf16 v[188:191], v[148:151], a[188:195], v44
  v_fma_f32 v121, v121, s86, -v236
  v_smfmac_f32_16x16x64_bf16 v[188:191], v[152:155], a[196:203], v44
  buffer_load_dwordx4 v[160:163], v17, s[28:31], s64 offen offset:0 sc1
  v_fma_f32 v122, v122, s86, -v236
  v_smfmac_f32_16x16x64_bf16 v[192:195], v[144:147], a[204:211], v44
  v_fma_f32 v123, v123, s86, -v236
  v_smfmac_f32_16x16x64_bf16 v[192:195], v[148:151], a[212:219], v44
  buffer_load_dwordx4 v[164:167], v16, s[28:31], s64 offen offset:1024 sc1
  v_fma_f32 v124, v124, s86, -v236
  v_smfmac_f32_16x16x64_bf16 v[192:195], v[152:155], a[220:227], v44
  v_fma_f32 v125, v125, s86, -v236
  v_smfmac_f32_16x16x64_bf16 v[196:199], v[144:147], a[228:235], v44
  buffer_load_dwordx4 v[48:51], v26, s[28:31], s64 offen offset:2048 sc1
  v_exp_f32 v120, v120
  v_smfmac_f32_16x16x64_bf16 v[196:199], v[148:151], a[236:243], v44
  v_exp_f32 v121, v121
  v_smfmac_f32_16x16x64_bf16 v[196:199], v[152:155], a[244:251], v44
  buffer_load_dwordx4 v[168:171], v18, s[16:19], s80 offen sc1
  v_exp_f32 v122, v122
  buffer_load_dwordx2 v[172:173], v20, s[16:19], s80 offen sc1
  v_exp_f32 v123, v123
  v_exp_f32 v124, v124
  v_exp_f32 v125, v125
  s_mov_b64 exec, s[60:61]
  v_cvt_pk_bf16_f32 v220, v120, v121
  v_cvt_pk_bf16_f32 v221, v122, v123
  v_cvt_pk_bf16_f32 v224, v124, v125
  s_mov_b64 exec, s[62:63]
  v_cvt_pk_bf16_f32 v222, v120, v121
  v_cvt_pk_bf16_f32 v223, v122, v123
  v_cvt_pk_bf16_f32 v225, v124, v125
  s_mov_b64 exec, -1
  v_pk_add_f32 v[126:127], v[120:121], v[122:123]
  v_add_f32 v128, v124, v125
  v_mfma_f32_16x16x32_bf16 v[200:203], v[176:179], v[220:223], 0
  v_add_f32 v236, v126, v127
  v_fmac_f32 v236, v128, v89
  v_cvt_pk_bf16_f32 v228, v188, v189
  v_cvt_pk_bf16_f32 v229, v190, v191
  v_mfma_f32_16x16x32_bf16 v[204:207], v[180:183], v[220:223], 0
  v_cvt_pk_bf16_f32 v230, v192, v193
  v_cvt_pk_bf16_f32 v231, v194, v195
  v_mfma_f32_16x16x32_bf16 v[208:211], v[184:187], v[220:223], 0
  v_cvt_pk_bf16_f32 v232, v196, v197
  v_cvt_pk_bf16_f32 v233, v198, v199
  v_add_f32_dpp v236, v236, v236 row_ror:8 row_mask:0xf bank_mask:0xf
  v_mov_b32 v237, v236
  s_nop 0
  v_mfma_f32_16x16x32_bf16 v[200:203], v[228:231], v[224:227], v[200:203]
  v_mfma_f32_16x16x32_bf16 v[204:207], v[230:233], v[224:227], v[204:207]
  v_permlane32_swap_b32 v236, v237
  v_add_f32 v236, v236, v237
  v_mov_b32 v237, v236
  v_mfma_f32_16x16x32_bf16 v[208:211], v[232:235], v[224:227], v[208:211]
  s_nop 0
  v_permlane16_swap_b32 v236, v237
  v_add_f32 v236, v236, v237
  v_rcp_f32 v236, v236
  s_nop 2
  v_pk_mul_f32 v[200:201], v[200:201], v[236:237] op_sel_hi:[1,0]
  v_pk_mul_f32 v[202:203], v[202:203], v[236:237] op_sel_hi:[1,0]
  ds_write_b128 v11, v[200:203] offset:0
  v_pk_mul_f32 v[204:205], v[204:205], v[236:237] op_sel_hi:[1,0]
  v_pk_mul_f32 v[206:207], v[206:207], v[236:237] op_sel_hi:[1,0]
  ds_write_b128 v11, v[204:207] offset:1024
  v_pk_mul_f32 v[208:209], v[208:209], v[236:237] op_sel_hi:[1,0]
  v_pk_mul_f32 v[210:211], v[210:211], v[236:237] op_sel_hi:[1,0]
  ds_write_b128 v11, v[208:211] offset:2048
  s_waitcnt lgkmcnt(0)
  s_barrier
  ds_read_b64 v[96:97], v12 offset:0
  ds_read_b64 v[98:99], v12 offset:128
  ds_read_b64 v[100:101], v12 offset:3072
  ds_read_b64 v[102:103], v12 offset:3200
  ds_read_b64 v[104:105], v12 offset:6144
  ds_read_b64 v[106:107], v12 offset:6272
  ds_read_b64 v[108:109], v12 offset:9216
  ds_read_b64 v[110:111], v12 offset:9344
  s_waitcnt lgkmcnt(6)
  v_pk_add_f32 v[96:97], v[96:97], v[98:99]
  s_waitcnt lgkmcnt(4)
  v_pk_add_f32 v[100:101], v[100:101], v[102:103]
  s_waitcnt lgkmcnt(2)
  v_pk_add_f32 v[104:105], v[104:105], v[106:107]
  v_pk_add_f32 v[96:97], v[96:97], v[100:101]
  s_waitcnt lgkmcnt(0)
  v_pk_add_f32 v[108:109], v[108:109], v[110:111]
  v_pk_add_f32 v[96:97], v[96:97], v[104:105]
  v_pk_add_f32 v[96:97], v[96:97], v[108:109]
  v_cvt_pk_f16_f32 v100, v96, v97
  v_perm_b32 v100, s91, v100, v14
  buffer_atomic_pk_add_f16 v100, v13, s[4:7], s3 offen
  v_mov_b32 v200, v196
  v_mov_b32 v201, v197
  v_mov_b32 v202, v198
  v_mov_b32 v203, v199
  v_permlane32_swap_b32 v188, v192
  v_permlane32_swap_b32 v189, v193
  v_permlane32_swap_b32 v190, v194
  v_permlane32_swap_b32 v191, v195
  v_permlane32_swap_b32 v196, v200
  v_permlane32_swap_b32 v197, v201
  v_permlane32_swap_b32 v198, v202
  v_permlane32_swap_b32 v199, v203
  v_pk_add_f32 v[188:189], v[188:189], v[192:193]
  v_pk_add_f32 v[190:191], v[190:191], v[194:195]
  v_pk_add_f32 v[196:197], v[196:197], v[200:201]
  v_pk_add_f32 v[198:199], v[198:199], v[202:203]
  v_cvt_pk_bf16_f32 v252, v188, v189
  v_cvt_pk_bf16_f32 v254, v196, v197
  v_cvt_pk_bf16_f32 v253, v190, v191
  v_cvt_pk_bf16_f32 v255, v198, v199
  s_nop 0
  v_permlane16_swap_b32 v252, v254
  v_permlane16_swap_b32 v253, v255
  v_min_u32 v252, -2, v252
  s_mov_b64 exec, s[76:77]
  buffer_store_dwordx4 v[252:255], v15, s[24:27], s57 offen sc1
  s_mov_b64 exec, -1
  s_add_u32 s64, s64, 1310720
  s_add_u32 s52, s52, 1
  s_and_b32 s21, s52, 3
  s_mul_i32 s81, s21, 540672
  s_lshl_b32 s84, s21, 15
  s_branch step_20
fl_24:
  buffer_load_dword v94, v95, s[12:15], s79 offen sc1
  s_branch fl_25
pm_22:
  s_cmp_gt_u32 s52, 3
  s_cbranch_scc1 op_32
  v_readfirstlane_b32 s21, v94
  s_cmp_ge_u32 s21, s46
  s_cbranch_scc1 op_32
  buffer_load_dword v94, v95, s[12:15], s79 offen sc1
  s_waitcnt vmcnt(0)
  v_readfirstlane_b32 s21, v94
  s_add_u32 s22, s46, 2
  s_min_u32 s22, s22, 64
  s_sub_u32 s55, s21, s22
  s_sub_u32 s56, s21, s46
  s_cmp_gt_u32 s21, s52
  s_cselect_b32 s21, s87, 0
  s_cmp_eq_u32 s21, 0
  s_cbranch_scc1 op_32
  s_mov_b32 s87, 0
  s_sub_u32 s21, s64, 1310720
  buffer_load_dwordx4 v[176:179], v16, s[28:31], s21 offen offset:0 sc1
  buffer_load_dwordx4 v[180:183], v16, s[28:31], s21 offen offset:1024 sc1
  buffer_load_dwordx4 v[184:187], v16, s[28:31], s21 offen offset:2048 sc1
op_32:
  buffer_load_dwordx4 v[32:35], v4, s[4:7], s84 offen offset:0 sc1
  buffer_load_dwordx4 v[36:39], v4, s[4:7], s84 offen offset:1024 sc1
  buffer_load_dwordx4 v[40:43], v4, s[4:7], s84 offen offset:2048 sc1
  s_add_u32 s54, s54, 1
  s_cmp_gt_u32 s54, 131072
  s_cbranch_scc1 end0
  s_waitcnt vmcnt(0)
  v_bitop3_b32 v27, v35, v39, v43 bitop3:0x80
  v_perm_b32 v35, v39, v35, s89
  v_cmp_gt_u32 vcc, 0x48000000, v27
  v_mov_b32 v39, v42
  s_cbranch_vccnz pm_22
  s_branch A1_15
pv_26:
  buffer_load_dwordx4 v[144:147], v10, s[8:11], s81 offen offset:0 sc1
  buffer_load_dwordx4 v[148:151], v10, s[8:11], s81 offen offset:1024 sc1
  buffer_load_dwordx4 v[152:155], v10, s[8:11], s81 offen offset:2048 sc1
  s_add_u32 s54, s54, 1
  s_cmp_gt_u32 s54, 131072
  s_cbranch_scc1 end0
  s_waitcnt vmcnt(0)
  v_max3_u32 v27, v144, v146, v148
  v_max3_u32 v27, v27, v150, v152
  v_max3_u32 v27, v27, v154, v154
  v_cmp_eq_u32 vcc, -1, v27
  s_nop 1
  s_cbranch_vccnz pv_26
  s_branch pvj_29
psr_27:
  s_cmp_gt_u32 s52, 3
  s_cbranch_scc1 op_33
  v_readfirstlane_b32 s21, v94
  s_cmp_ge_u32 s21, s46
  s_cbranch_scc1 op_33
  buffer_load_dword v94, v95, s[12:15], s79 offen sc1
  s_waitcnt vmcnt(0)
  v_readfirstlane_b32 s21, v94
  s_add_u32 s22, s46, 2
  s_min_u32 s22, s22, 64
  s_sub_u32 s55, s21, s22
  s_sub_u32 s56, s21, s46
  s_cmp_gt_u32 s21, s52
  s_cselect_b32 s21, s87, 0
  s_cmp_eq_u32 s21, 0
  s_cbranch_scc1 op_33
  s_mov_b32 s87, 0
  s_sub_u32 s21, s64, 1310720
  buffer_load_dwordx4 v[176:179], v16, s[28:31], s21 offen offset:0 sc1
  buffer_load_dwordx4 v[180:183], v16, s[28:31], s21 offen offset:1024 sc1
  buffer_load_dwordx4 v[184:187], v16, s[28:31], s21 offen offset:2048 sc1
op_33:
  buffer_load_dwordx2 v[248:249], v9, s[8:11], s81 offen sc1
  buffer_load_dwordx4 v[112:115], v8, s[8:11], s81 offen offset:0 sc1
  buffer_load_dwordx4 v[116:119], v8, s[8:11], s81 offen offset:1024 sc1
  s_add_u32 s54, s54, 1
  s_cmp_gt_u32 s54, 131072
  s_cbranch_scc1 end0
  s_waitcnt vmcnt(2)
  v_xor_b32 v96, s88, v248
  s_nop 0
  v_permlane16_swap_b32 v248, v249
  v_fma_mix_f32 v250, v248, 1.0, v249 op_sel:[0,0,0] op_sel_hi:[1,0,1]
  v_fma_mix_f32 v251, v248, 1.0, v249 op_sel:[1,0,1] op_sel_hi:[1,0,1]
  v_mov_b32 v248, v250
  v_mov_b32 v249, v251
  s_nop 0
  v_permlane32_swap_b32 v248, v250
  v_permlane32_swap_b32 v249, v251
  s_waitcnt vmcnt(0)
  v_bitop3_b32 v97, v112, v114, s88 bitop3:0x7e
  v_bitop3_b32 v98, v116, v118, s88 bitop3:0x7e
  v_fma_mix_f32 v120, v112, 1.0, v116 op_sel:[0,0,0] op_sel_hi:[1,0,1]
  v_or3_b32 v27, v96, v97, v98
  v_fma_mix_f32 v124, v114, 1.0, v118 op_sel:[0,0,0] op_sel_hi:[1,0,1]
  v_and_b32 v27, 1, v27
  v_fma_mix_f32 v121, v112, 1.0, v116 op_sel:[1,0,1] op_sel_hi:[1,0,1]
  v_cmp_ne_u32 vcc, 0, v27
  v_fma_mix_f32 v125, v114, 1.0, v118 op_sel:[1,0,1] op_sel_hi:[1,0,1]
  v_fma_mix_f32 v122, v113, 1.0, v117 op_sel:[0,0,0] op_sel_hi:[1,0,1]
  v_fma_mix_f32 v126, v115, 1.0, v119 op_sel:[0,0,0] op_sel_hi:[1,0,1]
  s_cbranch_vccnz psr_27
  s_branch psj_28
kvw_30:
  s_mov_b32 s22, s87
  s_cmp_eq_u32 s52, 0
  s_cselect_b32 s23, s87, s46
  s_cselect_b32 s55, 0, s55
  s_cselect_b32 s87, 1, 0
  s_cmp_eq_u32 s23, 0
  s_cbranch_scc1 kvok_31
  v_mov_b32 v236, 0
  s_mov_b32 s101, 0
wf_34:
  buffer_load_dword v237, v236, s[12:15], s79 offen sc1
  s_add_u32 s101, s101, 1
  s_cmp_gt_u32 s101, 131072
  s_cbranch_scc1 end0
  s_waitcnt vmcnt(0)
  v_readfirstlane_b32 s100, v237
  s_cmp_ge_u32 s100, s23
  s_cbranch_scc1 wf_35
  s_sleep 3
  s_branch wf_34
wf_35:
  s_cmp_eq_u32 s22, 0
  s_cbranch_scc1 kvok_31
  s_sub_u32 s21, s64, 1310720
  buffer_load_dwordx4 v[176:179], v16, s[28:31], s21 offen offset:0 sc1
  buffer_load_dwordx4 v[180:183], v16, s[28:31], s21 offen offset:1024 sc1
  buffer_load_dwordx4 v[184:187], v16, s[28:31], s21 offen offset:2048 sc1
  s_waitcnt vmcnt(0)
  s_branch kvok_31
last_21:
  v_mov_b32 v188, 0
  v_mov_b32 v189, 0
  v_mov_b32 v190, 0
  v_mov_b32 v191, 0
  v_mov_b32 v192, 0
  v_mov_b32 v193, 0
  v_mov_b32 v194, 0
  v_mov_b32 v195, 0
  v_mov_b32 v196, 0
  v_mov_b32 v197, 0
  v_mov_b32 v198, 0
  v_mov_b32 v199, 0
  s_sleep 4
  s_mov_b32 s54, 0
lv_36:
  buffer_load_dwordx4 v[144:147], v10, s[8:11], s81 offen offset:0 sc1
  buffer_load_dwordx4 v[148:151], v10, s[8:11], s81 offen offset:1024 sc1
  buffer_load_dwordx4 v[152:155], v10, s[8:11], s81 offen offset:2048 sc1
  s_add_u32 s54, s54, 1
  s_cmp_gt_u32 s54, 131072
  s_cbranch_scc1 end0
  s_waitcnt vmcnt(0)
  v_max3_u32 v27, v144, v146, v148
  v_max3_u32 v27, v27, v150, v152
  v_max3_u32 v27, v27, v154, v154
  v_cmp_eq_u32 vcc, -1, v27
  s_nop 1
  s_cbranch_vccnz lv_36
  v_smfmac_f32_16x16x64_bf16 v[188:191], v[144:147], a[180:187], v44
  v_smfmac_f32_16x16x64_bf16 v[192:195], v[144:147], a[204:211], v44
  v_smfmac_f32_16x16x64_bf16 v[196:199], v[144:147], a[228:235], v44
  v_smfmac_f32_16x16x64_bf16 v[188:191], v[148:151], a[188:195], v44
  v_smfmac_f32_16x16x64_bf16 v[192:195], v[148:151], a[212:219], v44
  v_smfmac_f32_16x16x64_bf16 v[196:199], v[148:151], a[236:243], v44
  v_smfmac_f32_16x16x64_bf16 v[188:191], v[152:155], a[196:203], v44
  v_smfmac_f32_16x16x64_bf16 v[192:195], v[152:155], a[220:227], v44
  v_smfmac_f32_16x16x64_bf16 v[196:199], v[152:155], a[244:251], v44
  s_nop 7
  v_mov_b32 v200, v196
  v_mov_b32 v201, v197
  v_mov_b32 v202, v198
  v_mov_b32 v203, v199
  v_permlane32_swap_b32 v188, v192
  v_permlane32_swap_b32 v189, v193
  v_permlane32_swap_b32 v190, v194
  v_permlane32_swap_b32 v191, v195
  v_permlane32_swap_b32 v196, v200
  v_permlane32_swap_b32 v197, v201
  v_permlane32_swap_b32 v198, v202
  v_permlane32_swap_b32 v199, v203
  v_pk_add_f32 v[188:189], v[188:189], v[192:193]
  v_pk_add_f32 v[190:191], v[190:191], v[194:195]
  v_pk_add_f32 v[196:197], v[196:197], v[200:201]
  v_pk_add_f32 v[198:199], v[198:199], v[202:203]
  v_cvt_pk_bf16_f32 v252, v188, v189
  v_cvt_pk_bf16_f32 v254, v196, v197
  v_cvt_pk_bf16_f32 v253, v190, v191
  v_cvt_pk_bf16_f32 v255, v198, v199
  s_nop 0
  v_permlane16_swap_b32 v252, v254
  v_permlane16_swap_b32 v253, v255
  v_min_u32 v252, -2, v252
  s_mov_b64 exec, s[76:77]
  buffer_store_dwordx4 v[252:255], v15, s[24:27], s57 offen sc1
  s_mov_b64 exec, -1
  v_mov_b32 v246, 80
  v_mov_b32 v247, 1
  s_mov_b64 exec, 1
  buffer_atomic_add v247, v246, s[32:35], 0 offen sc0 sc1
  s_mov_b64 exec, -1
clm_37:
  s_branch chain_done
step_38:
  s_add_u32 s21, s52, 2
  s_and_b32 s21, s21, 3
  s_mul_i32 s82, s21, 540672
  s_add_u32 s21, s52, 3
  s_and_b32 s21, s21, 3
  s_lshl_b32 s83, s21, 15
  s_add_u32 s21, s52, 1
  s_and_b32 s22, s21, 3
  s_lshl_b32 s3, s22, 15
  s_mul_i32 s80, s21, 393216
  s_add_u32 s46, s21, 1
  s_min_u32 s46, s46, 64
  s_mul_i32 s85, s52, 98304
  s_mul_i32 s57, s52, 327680
  s_add_u32 s57, s57, 42991616

  s_bfe_u32 s88, s52, 0x10002
  s_add_u32 s78, s81, 278528
  s_max_u32 s21, s52, 1
  s_sub_u32 s21, s21, 1
  s_cmp_lt_u32 s52, 60
  s_cselect_b32 s66, s65, 0x80000000
  s_cselect_b32 s68, 15, 1
  s_cmp_ge_u32 s52, 61
  s_cselect_b32 s66, s90, s66
  s_cselect_b32 s67, s52, s21
  v_mov_b32 v52, 0
  v_mov_b32 v53, 0
  v_mov_b32 v54, 0
  v_mov_b32 v55, 0
  v_mov_b32 v56, 0
  v_mov_b32 v57, 0
  v_mov_b32 v58, 0
  v_mov_b32 v59, 0
  v_mov_b32 v60, 0
  v_mov_b32 v61, 0
  v_mov_b32 v62, 0
  v_mov_b32 v63, 0
  v_mov_b32 v64, 0
  v_mov_b32 v65, 0
  v_mov_b32 v66, 0
  v_mov_b32 v67, 0
  v_mov_b32 v68, 0
  v_mov_b32 v69, 0
  v_mov_b32 v70, 0
  v_mov_b32 v71, 0
  v_mov_b32 v72, 0
  v_mov_b32 v73, 0
  v_mov_b32 v74, 0
  v_mov_b32 v75, 0
  v_mov_b32 v76, 0
  v_mov_b32 v77, 0
  v_mov_b32 v78, 0
  v_mov_b32 v79, 0
  v_mov_b32 v80, 0
  v_mov_b32 v81, 0
  v_mov_b32 v82, 0
  v_mov_b32 v83, 0
  v_mov_b32 v84, 0
  v_mov_b32 v85, 0
  v_mov_b32 v86, 0
  v_mov_b32 v87, 0
  s_sleep 4
  s_cmp_lt_i32 s55, 0
  s_cbranch_scc1 fl_42
fl_43:
  s_mov_b32 s54, 0
  buffer_load_dwordx4 v[32:35], v4, s[4:7], s84 offen offset:0 sc1
  buffer_load_dwordx4 v[36:39], v4, s[4:7], s84 offen offset:1024 sc1
  buffer_load_dwordx4 v[40:43], v4, s[4:7], s84 offen offset:2048 sc1
  s_waitcnt vmcnt(3)
  v_mov_b32 v176, v160
  v_mov_b32 v177, v161
  v_mov_b32 v178, v162
  v_mov_b32 v179, v163
  v_mov_b32 v180, v164
  v_mov_b32 v181, v165
  v_mov_b32 v182, v166
  v_mov_b32 v183, v167
  v_mov_b32 v184, v48
  v_mov_b32 v185, v49
  v_mov_b32 v186, v50
  v_mov_b32 v187, v51
  s_waitcnt vmcnt(0)
  v_bitop3_b32 v27, v35, v39, v43 bitop3:0x80
  v_perm_b32 v35, v39, v35, s89
  v_cmp_gt_u32 vcc, 0x48000000, v27
  v_mov_b32 v39, v42
  s_cbranch_vccnz pm_40
A1_16:
  v_smfmac_f32_16x16x32_f16 v[52:55], v[40:41], a[16:19], v44
  v_smfmac_f32_16x16x32_f16 v[64:67], v[40:41], a[76:79], v44
  v_smfmac_f32_16x16x32_f16 v[56:59], v[40:41], a[36:39], v44
  v_smfmac_f32_16x16x64_f16 v[52:55], v[32:35], a[0:7], v44
  v_smfmac_f32_16x16x64_f16 v[52:55], v[36:39], a[8:15], v44
  v_smfmac_f32_16x16x32_f16 v[68:71], v[40:41], a[96:99], v44
  v_smfmac_f32_16x16x64_f16 v[64:67], v[32:35], a[60:67], v44
  v_smfmac_f32_16x16x64_f16 v[64:67], v[36:39], a[68:75], v44
  v_smfmac_f32_16x16x32_f16 v[60:63], v[40:41], a[56:59], v44
  v_smfmac_f32_16x16x64_f16 v[56:59], v[32:35], a[20:27], v44
  v_smfmac_f32_16x16x64_f16 v[56:59], v[36:39], a[28:35], v44
  v_permlane32_swap_b32 v52, v64
  v_smfmac_f32_16x16x32_f16 v[72:75], v[40:41], a[116:119], v44
  v_permlane32_swap_b32 v53, v65
  v_add_f32 v52, v52, v64
  v_add_f32 v53, v53, v65
  v_smfmac_f32_16x16x64_f16 v[68:71], v[32:35], a[80:87], v44
  ds_write2_b32 v5, v52, v53 offset0:0 offset1:4
  v_smfmac_f32_16x16x64_f16 v[68:71], v[36:39], a[88:95], v44
  v_permlane32_swap_b32 v54, v66
  v_smfmac_f32_16x16x32_f16 v[76:79], v[40:41], a[136:139], v44
  v_permlane32_swap_b32 v55, v67
  v_add_f32 v54, v54, v66
  v_add_f32 v55, v55, v67
  v_smfmac_f32_16x16x64_f16 v[60:63], v[32:35], a[40:47], v44
  ds_write2_b32 v5, v54, v55 offset0:8 offset1:12
  v_smfmac_f32_16x16x64_f16 v[60:63], v[36:39], a[48:55], v44
  v_permlane32_swap_b32 v56, v68
  v_smfmac_f32_16x16x32_f16 v[80:83], v[40:41], a[156:159], v44
  v_permlane32_swap_b32 v57, v69
  v_add_f32 v56, v56, v68
  v_add_f32 v57, v57, v69
  v_smfmac_f32_16x16x64_f16 v[72:75], v[32:35], a[100:107], v44
  ds_write2_b32 v242, v56, v57 offset0:0 offset1:4
  v_smfmac_f32_16x16x64_f16 v[72:75], v[36:39], a[108:115], v44
  v_permlane32_swap_b32 v58, v70
  v_smfmac_f32_16x16x32_f16 v[84:87], v[40:41], a[176:179], v44
  v_permlane32_swap_b32 v59, v71
  v_add_f32 v58, v58, v70
  v_add_f32 v59, v59, v71
  v_smfmac_f32_16x16x64_f16 v[76:79], v[32:35], a[120:127], v44
  ds_write2_b32 v242, v58, v59 offset0:8 offset1:12
  v_smfmac_f32_16x16x64_f16 v[76:79], v[36:39], a[128:135], v44
  v_permlane32_swap_b32 v60, v72
  v_smfmac_f32_16x16x64_f16 v[80:83], v[32:35], a[140:147], v44
  v_permlane32_swap_b32 v61, v73
  v_add_f32 v60, v60, v72
  v_smfmac_f32_16x16x64_f16 v[80:83], v[36:39], a[148:155], v44
  v_add_f32 v61, v61, v73
  ds_write2_b32 v243, v60, v61 offset0:0 offset1:4
  v_smfmac_f32_16x16x64_f16 v[84:87], v[32:35], a[160:167], v44
  v_permlane32_swap_b32 v62, v74
  v_smfmac_f32_16x16x64_f16 v[84:87], v[36:39], a[168:175], v44
  v_permlane32_swap_b32 v63, v75
  v_add_f32 v62, v62, v74
  v_add_f32 v63, v63, v75
  ds_write2_b32 v243, v62, v63 offset0:8 offset1:12
  v_permlane32_swap_b32 v76, v80
  v_permlane32_swap_b32 v77, v81
  v_add_f32 v76, v76, v80
  v_add_f32 v77, v77, v81
  ds_write2_b32 v244, v76, v77 offset0:0 offset1:4
  v_permlane32_swap_b32 v78, v82
  v_permlane32_swap_b32 v79, v83
  v_add_f32 v78, v78, v82
  v_add_f32 v79, v79, v83
  ds_write2_b32 v244, v78, v79 offset0:8 offset1:12
  ds_write2_b32 v245, v84, v85 offset0:0 offset1:4
  ds_write2_b32 v245, v86, v87 offset0:8 offset1:12
  s_waitcnt lgkmcnt(0) vmcnt(0)
  s_barrier
  ds_read_b128 v[96:99], v45 offset:0
  ds_read_b128 v[108:111], v45 offset:5440
  ds_read_b128 v[100:103], v45 offset:1088
  ds_read_b128 v[112:115], v45 offset:6528
  ds_read_b128 v[104:107], v45 offset:2176
  ds_read_b128 v[116:119], v45 offset:7616
  s_waitcnt lgkmcnt(4)
  v_pk_add_f32 v[96:97], v[96:97], v[108:109]
  v_pk_add_f32 v[98:99], v[98:99], v[110:111]
  s_nop 0
  v_add_f32_dpp v108, v96, v96 row_ror:8 row_mask:0xf bank_mask:0xf
  v_add_f32_dpp v109, v97, v97 row_ror:8 row_mask:0xf bank_mask:0xf
  v_add_f32_dpp v110, v98, v98 row_ror:8 row_mask:0xf bank_mask:0xf
  v_add_f32_dpp v111, v99, v99 row_ror:8 row_mask:0xf bank_mask:0xf
  v_cvt_pk_bf16_f32 v212, v108, v109
  v_cvt_pk_bf16_f32 v213, v110, v111
  s_waitcnt lgkmcnt(2)
  v_pk_add_f32 v[100:101], v[100:101], v[112:113]
  v_pk_add_f32 v[102:103], v[102:103], v[114:115]
  s_nop 0
  v_add_f32_dpp v112, v100, v100 row_ror:8 row_mask:0xf bank_mask:0xf
  v_add_f32_dpp v113, v101, v101 row_ror:8 row_mask:0xf bank_mask:0xf
  v_add_f32_dpp v114, v102, v102 row_ror:8 row_mask:0xf bank_mask:0xf
  v_add_f32_dpp v115, v103, v103 row_ror:8 row_mask:0xf bank_mask:0xf
  v_cvt_pk_bf16_f32 v214, v112, v113
  v_cvt_pk_bf16_f32 v215, v114, v115
  s_waitcnt lgkmcnt(0)
  v_pk_add_f32 v[104:105], v[104:105], v[116:117]
  v_pk_add_f32 v[106:107], v[106:107], v[118:119]
  v_mfma_f32_16x16x32_bf16 v[96:99], v[168:171], v[212:215], 0
  v_add_f32_dpp v116, v104, v104 row_ror:8 row_mask:0xf bank_mask:0xf
  v_add_f32_dpp v117, v105, v105 row_ror:8 row_mask:0xf bank_mask:0xf
  v_add_f32_dpp v118, v106, v106 row_ror:8 row_mask:0xf bank_mask:0xf
  v_add_f32_dpp v119, v107, v107 row_ror:8 row_mask:0xf bank_mask:0xf
  v_cvt_pk_bf16_f32 v216, v116, v117
  v_cvt_pk_bf16_f32 v217, v118, v119
  s_nop 1
  v_mfma_f32_16x16x32_bf16 v[96:99], v[172:175], v[216:219], v[96:99]
  s_mov_b64 exec, s[74:75]
  s_nop 6
  v_cvt_pk_f16_f32 v100, v96, v97
  v_cvt_pk_f16_f32 v101, v98, v99
  v_and_or_b32 v100, v100, -2, s88
  buffer_store_dwordx2 v[100:101], v7, s[8:11], s81 offen
  s_mov_b64 exec, -1
  s_cmp_eq_u32 s52, 63
  s_cbranch_scc1 last_39
  s_sleep 5
  s_mov_b32 s54, 0
  buffer_load_dwordx2 v[248:249], v9, s[8:11], s81 offen sc1
  buffer_load_dwordx4 v[112:115], v8, s[8:11], s81 offen offset:0 sc1
  buffer_load_dwordx4 v[116:119], v8, s[8:11], s81 offen offset:1024 sc1
  s_sleep 2
  buffer_load_dwordx4 v[144:147], v10, s[8:11], s81 offen offset:0 sc1
  buffer_load_dwordx4 v[148:151], v10, s[8:11], s81 offen offset:1024 sc1
  buffer_load_dwordx4 v[152:155], v10, s[8:11], s81 offen offset:2048 sc1
  v_mov_b32 v188, 0
  v_mov_b32 v189, 0
  v_mov_b32 v190, 0
  v_mov_b32 v191, 0
  v_mov_b32 v192, 0
  v_mov_b32 v193, 0
  v_mov_b32 v194, 0
  v_mov_b32 v195, 0
  v_mov_b32 v196, 0
  v_mov_b32 v197, 0
  v_mov_b32 v198, 0
  v_mov_b32 v199, 0
  v_readfirstlane_b32 s21, v94
  s_add_u32 s22, s46, 2
  s_min_u32 s22, s22, 64
  s_sub_u32 s55, s21, s22
  s_sub_u32 s56, s21, s46
  s_waitcnt vmcnt(5)
  v_xor_b32 v96, s88, v248
  s_nop 0
  v_permlane16_swap_b32 v248, v249
  v_fma_mix_f32 v250, v248, 1.0, v249 op_sel:[0,0,0] op_sel_hi:[1,0,1]
  v_fma_mix_f32 v251, v248, 1.0, v249 op_sel:[1,0,1] op_sel_hi:[1,0,1]
  v_mov_b32 v248, v250
  v_mov_b32 v249, v251
  s_nop 0
  v_permlane32_swap_b32 v248, v250
  v_permlane32_swap_b32 v249, v251
  s_waitcnt vmcnt(3)
  v_bitop3_b32 v97, v112, v114, s88 bitop3:0x7e
  v_bitop3_b32 v98, v116, v118, s88 bitop3:0x7e
  v_fma_mix_f32 v120, v112, 1.0, v116 op_sel:[0,0,0] op_sel_hi:[1,0,1]
  v_or3_b32 v27, v96, v97, v98
  v_fma_mix_f32 v124, v114, 1.0, v118 op_sel:[0,0,0] op_sel_hi:[1,0,1]
  v_and_b32 v27, 1, v27
  v_fma_mix_f32 v121, v112, 1.0, v116 op_sel:[1,0,1] op_sel_hi:[1,0,1]
  v_cmp_ne_u32 vcc, 0, v27
  v_fma_mix_f32 v125, v114, 1.0, v118 op_sel:[1,0,1] op_sel_hi:[1,0,1]
  v_fma_mix_f32 v122, v113, 1.0, v117 op_sel:[0,0,0] op_sel_hi:[1,0,1]
  v_fma_mix_f32 v126, v115, 1.0, v119 op_sel:[0,0,0] op_sel_hi:[1,0,1]
  s_cbranch_vccnz psr_45
psj_46:
  s_cmp_lt_i32 s56, 0
  s_cbranch_scc1 kvw_48
kvok_49:
  v_fma_mix_f32 v123, v113, 1.0, v117 op_sel:[1,0,1] op_sel_hi:[1,0,1]
  v_fma_mix_f32 v127, v115, 1.0, v119 op_sel:[1,0,1] op_sel_hi:[1,0,1]
  v_permlane32_swap_b32 v120, v124
  v_permlane32_swap_b32 v121, v125
  v_permlane32_swap_b32 v122, v126
  v_permlane32_swap_b32 v123, v127
  v_pk_add_f32 v[120:121], v[120:121], v[124:125]
  v_pk_add_f32 v[122:123], v[122:123], v[126:127]
  v_pk_add_f32 v[124:125], v[248:249], v[250:251]
  v_max3_f32 v236, v120, v121, v122
  v_max3_f32 v237, v123, v124, v125
  v_max_f32 v236, v236, v237
  s_nop 1
  v_max_f32_dpp v236, v236, v236 row_ror:8 row_mask:0xf bank_mask:0xf
  v_mov_b32 v237, v236
  s_nop 1
  v_permlane32_swap_b32 v236, v237
  v_max_f32 v236, v236, v237
  v_mov_b32 v237, v236
  s_nop 1
  v_permlane16_swap_b32 v236, v237
  v_max_f32 v236, v236, v237
  s_waitcnt vmcnt(0)
  v_max3_u32 v27, v144, v146, v148
  v_max3_u32 v27, v27, v150, v152
  v_max3_u32 v27, v27, v154, v154
  v_cmp_eq_u32 vcc, -1, v27
  s_nop 1
  s_cbranch_vccnz pv_44
pvj_47:
  v_mul_f32 v236, s86, v236
  v_smfmac_f32_16x16x64_bf16 v[188:191], v[144:147], a[180:187], v44
  v_fma_f32 v120, v120, s86, -v236
  v_smfmac_f32_16x16x64_bf16 v[188:191], v[148:151], a[188:195], v44
  v_fma_f32 v121, v121, s86, -v236
  v_smfmac_f32_16x16x64_bf16 v[188:191], v[152:155], a[196:203], v44
  buffer_load_dwordx4 v[160:163], v17, s[28:31], s64 offen offset:0 sc1
  v_fma_f32 v122, v122, s86, -v236
  v_smfmac_f32_16x16x64_bf16 v[192:195], v[144:147], a[204:211], v44
  v_fma_f32 v123, v123, s86, -v236
  v_smfmac_f32_16x16x64_bf16 v[192:195], v[148:151], a[212:219], v44
  buffer_load_dwordx4 v[164:167], v16, s[28:31], s64 offen offset:1024 sc1
  v_fma_f32 v124, v124, s86, -v236
  v_smfmac_f32_16x16x64_bf16 v[192:195], v[152:155], a[220:227], v44
  v_fma_f32 v125, v125, s86, -v236
  v_smfmac_f32_16x16x64_bf16 v[196:199], v[144:147], a[228:235], v44
  buffer_load_dwordx4 v[48:51], v26, s[28:31], s64 offen offset:2048 sc1
  v_exp_f32 v120, v120
  v_smfmac_f32_16x16x64_bf16 v[196:199], v[148:151], a[236:243], v44
  v_exp_f32 v121, v121
  v_smfmac_f32_16x16x64_bf16 v[196:199], v[152:155], a[244:251], v44
  buffer_load_dwordx4 v[168:171], v18, s[16:19], s80 offen sc1
  v_exp_f32 v122, v122
  buffer_load_dwordx2 v[172:173], v20, s[16:19], s80 offen sc1
  v_exp_f32 v123, v123
  v_exp_f32 v124, v124
  v_exp_f32 v125, v125
  s_mov_b64 exec, s[60:61]
  v_cvt_pk_bf16_f32 v220, v120, v121
  v_cvt_pk_bf16_f32 v221, v122, v123
  v_cvt_pk_bf16_f32 v224, v124, v125
  s_mov_b64 exec, s[62:63]
  v_cvt_pk_bf16_f32 v222, v120, v121
  v_cvt_pk_bf16_f32 v223, v122, v123
  v_cvt_pk_bf16_f32 v225, v124, v125
  s_mov_b64 exec, -1
  v_pk_add_f32 v[126:127], v[120:121], v[122:123]
  v_add_f32 v128, v124, v125
  v_mfma_f32_16x16x32_bf16 v[200:203], v[176:179], v[220:223], 0
  v_add_f32 v236, v126, v127
  v_fmac_f32 v236, v128, v89
  v_cvt_pk_bf16_f32 v228, v188, v189
  v_cvt_pk_bf16_f32 v229, v190, v191
  v_mfma_f32_16x16x32_bf16 v[204:207], v[180:183], v[220:223], 0
  v_cvt_pk_bf16_f32 v230, v192, v193
  v_cvt_pk_bf16_f32 v231, v194, v195
  v_mfma_f32_16x16x32_bf16 v[208:211], v[184:187], v[220:223], 0
  v_cvt_pk_bf16_f32 v232, v196, v197
  v_cvt_pk_bf16_f32 v233, v198, v199
  v_add_f32_dpp v236, v236, v236 row_ror:8 row_mask:0xf bank_mask:0xf
  v_mov_b32 v237, v236
  s_nop 0
  v_mfma_f32_16x16x32_bf16 v[200:203], v[228:231], v[224:227], v[200:203]
  v_mfma_f32_16x16x32_bf16 v[204:207], v[230:233], v[224:227], v[204:207]
  v_permlane32_swap_b32 v236, v237
  v_add_f32 v236, v236, v237
  v_mov_b32 v237, v236
  v_mfma_f32_16x16x32_bf16 v[208:211], v[232:235], v[224:227], v[208:211]
  s_nop 0
  v_permlane16_swap_b32 v236, v237
  v_add_f32 v236, v236, v237
  v_rcp_f32 v236, v236
  s_nop 2
  v_pk_mul_f32 v[200:201], v[200:201], v[236:237] op_sel_hi:[1,0]
  v_pk_mul_f32 v[202:203], v[202:203], v[236:237] op_sel_hi:[1,0]
  ds_write_b128 v11, v[200:203] offset:0
  v_pk_mul_f32 v[204:205], v[204:205], v[236:237] op_sel_hi:[1,0]
  v_pk_mul_f32 v[206:207], v[206:207], v[236:237] op_sel_hi:[1,0]
  ds_write_b128 v11, v[204:207] offset:1024
  v_pk_mul_f32 v[208:209], v[208:209], v[236:237] op_sel_hi:[1,0]
  v_pk_mul_f32 v[210:211], v[210:211], v[236:237] op_sel_hi:[1,0]
  ds_write_b128 v11, v[208:211] offset:2048
  s_waitcnt lgkmcnt(0)
  s_barrier
  ds_read_b64 v[96:97], v12 offset:0
  ds_read_b64 v[98:99], v12 offset:128
  ds_read_b64 v[100:101], v12 offset:3072
  ds_read_b64 v[102:103], v12 offset:3200
  ds_read_b64 v[104:105], v12 offset:6144
  ds_read_b64 v[106:107], v12 offset:6272
  ds_read_b64 v[108:109], v12 offset:9216
  ds_read_b64 v[110:111], v12 offset:9344
  s_waitcnt lgkmcnt(6)
  v_pk_add_f32 v[96:97], v[96:97], v[98:99]
  s_waitcnt lgkmcnt(4)
  v_pk_add_f32 v[100:101], v[100:101], v[102:103]
  s_waitcnt lgkmcnt(2)
  v_pk_add_f32 v[104:105], v[104:105], v[106:107]
  v_pk_add_f32 v[96:97], v[96:97], v[100:101]
  s_waitcnt lgkmcnt(0)
  v_pk_add_f32 v[108:109], v[108:109], v[110:111]
  v_pk_add_f32 v[96:97], v[96:97], v[104:105]
  v_pk_add_f32 v[96:97], v[96:97], v[108:109]
  v_cvt_pk_f16_f32 v100, v96, v97
  v_perm_b32 v100, s91, v100, v14
  buffer_atomic_pk_add_f16 v100, v13, s[4:7], s3 offen
  v_mov_b32 v200, v196
  v_mov_b32 v201, v197
  v_mov_b32 v202, v198
  v_mov_b32 v203, v199
  v_permlane32_swap_b32 v188, v192
  v_permlane32_swap_b32 v189, v193
  v_permlane32_swap_b32 v190, v194
  v_permlane32_swap_b32 v191, v195
  v_permlane32_swap_b32 v196, v200
  v_permlane32_swap_b32 v197, v201
  v_permlane32_swap_b32 v198, v202
  v_permlane32_swap_b32 v199, v203
  v_pk_add_f32 v[188:189], v[188:189], v[192:193]
  v_pk_add_f32 v[190:191], v[190:191], v[194:195]
  v_pk_add_f32 v[196:197], v[196:197], v[200:201]
  v_pk_add_f32 v[198:199], v[198:199], v[202:203]
  v_cvt_pk_bf16_f32 v252, v188, v189
  v_cvt_pk_bf16_f32 v254, v196, v197
  v_cvt_pk_bf16_f32 v253, v190, v191
  v_cvt_pk_bf16_f32 v255, v198, v199
  s_nop 0
  v_permlane16_swap_b32 v252, v254
  v_permlane16_swap_b32 v253, v255
  v_min_u32 v252, -2, v252
  s_mov_b64 exec, s[76:77]
  buffer_store_dwordx4 v[252:255], v15, s[24:27], s57 offen sc1
  s_mov_b64 exec, -1
  s_add_u32 s64, s64, 1310720
  s_add_u32 s52, s52, 1
  s_and_b32 s21, s52, 3
  s_mul_i32 s81, s21, 540672
  s_lshl_b32 s84, s21, 15
  s_branch step_38
fl_42:
  buffer_load_dword v94, v95, s[12:15], s79 offen sc1
  s_branch fl_43
pm_40:
  s_cmp_gt_u32 s52, 3
  s_cbranch_scc1 op_50
  v_readfirstlane_b32 s21, v94
  s_cmp_ge_u32 s21, s46
  s_cbranch_scc1 op_50
  buffer_load_dword v94, v95, s[12:15], s79 offen sc1
  s_waitcnt vmcnt(0)
  v_readfirstlane_b32 s21, v94
  s_add_u32 s22, s46, 2
  s_min_u32 s22, s22, 64
  s_sub_u32 s55, s21, s22
  s_sub_u32 s56, s21, s46
  s_cmp_gt_u32 s21, s52
  s_cselect_b32 s21, s87, 0
  s_cmp_eq_u32 s21, 0
  s_cbranch_scc1 op_50
  s_mov_b32 s87, 0
  s_sub_u32 s21, s64, 1310720
  buffer_load_dwordx4 v[176:179], v16, s[28:31], s21 offen offset:0 sc1
  buffer_load_dwordx4 v[180:183], v16, s[28:31], s21 offen offset:1024 sc1
  buffer_load_dwordx4 v[184:187], v16, s[28:31], s21 offen offset:2048 sc1
op_50:
  buffer_load_dwordx4 v[32:35], v4, s[4:7], s84 offen offset:0 sc1
  buffer_load_dwordx4 v[36:39], v4, s[4:7], s84 offen offset:1024 sc1
  buffer_load_dwordx4 v[40:43], v4, s[4:7], s84 offen offset:2048 sc1
  s_add_u32 s54, s54, 1
  s_cmp_gt_u32 s54, 131072
  s_cbranch_scc1 end0
  s_waitcnt vmcnt(0)
  v_bitop3_b32 v27, v35, v39, v43 bitop3:0x80
  v_perm_b32 v35, v39, v35, s89
  v_cmp_gt_u32 vcc, 0x48000000, v27
  v_mov_b32 v39, v42
  s_cbranch_vccnz pm_40
  s_branch A1_16
pv_44:
  buffer_load_dwordx4 v[144:147], v10, s[8:11], s81 offen offset:0 sc1
  buffer_load_dwordx4 v[148:151], v10, s[8:11], s81 offen offset:1024 sc1
  buffer_load_dwordx4 v[152:155], v10, s[8:11], s81 offen offset:2048 sc1
  s_add_u32 s54, s54, 1
  s_cmp_gt_u32 s54, 131072
  s_cbranch_scc1 end0
  s_waitcnt vmcnt(0)
  v_max3_u32 v27, v144, v146, v148
  v_max3_u32 v27, v27, v150, v152
  v_max3_u32 v27, v27, v154, v154
  v_cmp_eq_u32 vcc, -1, v27
  s_nop 1
  s_cbranch_vccnz pv_44
  s_branch pvj_47
psr_45:
  s_cmp_gt_u32 s52, 3
  s_cbranch_scc1 op_51
  v_readfirstlane_b32 s21, v94
  s_cmp_ge_u32 s21, s46
  s_cbranch_scc1 op_51
  buffer_load_dword v94, v95, s[12:15], s79 offen sc1
  s_waitcnt vmcnt(0)
  v_readfirstlane_b32 s21, v94
  s_add_u32 s22, s46, 2
  s_min_u32 s22, s22, 64
  s_sub_u32 s55, s21, s22
  s_sub_u32 s56, s21, s46
  s_cmp_gt_u32 s21, s52
  s_cselect_b32 s21, s87, 0
  s_cmp_eq_u32 s21, 0
  s_cbranch_scc1 op_51
  s_mov_b32 s87, 0
  s_sub_u32 s21, s64, 1310720
  buffer_load_dwordx4 v[176:179], v16, s[28:31], s21 offen offset:0 sc1
  buffer_load_dwordx4 v[180:183], v16, s[28:31], s21 offen offset:1024 sc1
  buffer_load_dwordx4 v[184:187], v16, s[28:31], s21 offen offset:2048 sc1
op_51:
  buffer_load_dwordx2 v[248:249], v9, s[8:11], s81 offen sc1
  buffer_load_dwordx4 v[112:115], v8, s[8:11], s81 offen offset:0 sc1
  buffer_load_dwordx4 v[116:119], v8, s[8:11], s81 offen offset:1024 sc1
  s_add_u32 s54, s54, 1
  s_cmp_gt_u32 s54, 131072
  s_cbranch_scc1 end0
  s_waitcnt vmcnt(2)
  v_xor_b32 v96, s88, v248
  s_nop 0
  v_permlane16_swap_b32 v248, v249
  v_fma_mix_f32 v250, v248, 1.0, v249 op_sel:[0,0,0] op_sel_hi:[1,0,1]
  v_fma_mix_f32 v251, v248, 1.0, v249 op_sel:[1,0,1] op_sel_hi:[1,0,1]
  v_mov_b32 v248, v250
  v_mov_b32 v249, v251
  s_nop 0
  v_permlane32_swap_b32 v248, v250
  v_permlane32_swap_b32 v249, v251
  s_waitcnt vmcnt(0)
  v_bitop3_b32 v97, v112, v114, s88 bitop3:0x7e
  v_bitop3_b32 v98, v116, v118, s88 bitop3:0x7e
  v_fma_mix_f32 v120, v112, 1.0, v116 op_sel:[0,0,0] op_sel_hi:[1,0,1]
  v_or3_b32 v27, v96, v97, v98
  v_fma_mix_f32 v124, v114, 1.0, v118 op_sel:[0,0,0] op_sel_hi:[1,0,1]
  v_and_b32 v27, 1, v27
  v_fma_mix_f32 v121, v112, 1.0, v116 op_sel:[1,0,1] op_sel_hi:[1,0,1]
  v_cmp_ne_u32 vcc, 0, v27
  v_fma_mix_f32 v125, v114, 1.0, v118 op_sel:[1,0,1] op_sel_hi:[1,0,1]
  v_fma_mix_f32 v122, v113, 1.0, v117 op_sel:[0,0,0] op_sel_hi:[1,0,1]
  v_fma_mix_f32 v126, v115, 1.0, v119 op_sel:[0,0,0] op_sel_hi:[1,0,1]
  s_cbranch_vccnz psr_45
  s_branch psj_46
kvw_48:
  s_mov_b32 s22, s87
  s_cmp_eq_u32 s52, 0
  s_cselect_b32 s23, s87, s46
  s_cselect_b32 s55, 0, s55
  s_cselect_b32 s87, 1, 0
  s_cmp_eq_u32 s23, 0
  s_cbranch_scc1 kvok_49
  v_mov_b32 v236, 0
  s_mov_b32 s101, 0
wf_52:
  buffer_load_dword v237, v236, s[12:15], s79 offen sc1
  s_add_u32 s101, s101, 1
  s_cmp_gt_u32 s101, 131072
  s_cbranch_scc1 end0
  s_waitcnt vmcnt(0)
  v_readfirstlane_b32 s100, v237
  s_cmp_ge_u32 s100, s23
  s_cbranch_scc1 wf_53
  s_sleep 3
  s_branch wf_52
wf_53:
  s_cmp_eq_u32 s22, 0
  s_cbranch_scc1 kvok_49
  s_sub_u32 s21, s64, 1310720
  buffer_load_dwordx4 v[176:179], v16, s[28:31], s21 offen offset:0 sc1
  buffer_load_dwordx4 v[180:183], v16, s[28:31], s21 offen offset:1024 sc1
  buffer_load_dwordx4 v[184:187], v16, s[28:31], s21 offen offset:2048 sc1
  s_waitcnt vmcnt(0)
  s_branch kvok_49
last_39:
  v_mov_b32 v188, 0
  v_mov_b32 v189, 0
  v_mov_b32 v190, 0
  v_mov_b32 v191, 0
  v_mov_b32 v192, 0
  v_mov_b32 v193, 0
  v_mov_b32 v194, 0
  v_mov_b32 v195, 0
  v_mov_b32 v196, 0
  v_mov_b32 v197, 0
  v_mov_b32 v198, 0
  v_mov_b32 v199, 0
  s_sleep 4
  s_mov_b32 s54, 0
lv_54:
  buffer_load_dwordx4 v[144:147], v10, s[8:11], s81 offen offset:0 sc1
  buffer_load_dwordx4 v[148:151], v10, s[8:11], s81 offen offset:1024 sc1
  buffer_load_dwordx4 v[152:155], v10, s[8:11], s81 offen offset:2048 sc1
  s_add_u32 s54, s54, 1
  s_cmp_gt_u32 s54, 131072
  s_cbranch_scc1 end0
  s_waitcnt vmcnt(0)
  v_max3_u32 v27, v144, v146, v148
  v_max3_u32 v27, v27, v150, v152
  v_max3_u32 v27, v27, v154, v154
  v_cmp_eq_u32 vcc, -1, v27
  s_nop 1
  s_cbranch_vccnz lv_54
  v_smfmac_f32_16x16x64_bf16 v[188:191], v[144:147], a[180:187], v44
  v_smfmac_f32_16x16x64_bf16 v[192:195], v[144:147], a[204:211], v44
  v_smfmac_f32_16x16x64_bf16 v[196:199], v[144:147], a[228:235], v44
  v_smfmac_f32_16x16x64_bf16 v[188:191], v[148:151], a[188:195], v44
  v_smfmac_f32_16x16x64_bf16 v[192:195], v[148:151], a[212:219], v44
  v_smfmac_f32_16x16x64_bf16 v[196:199], v[148:151], a[236:243], v44
  v_smfmac_f32_16x16x64_bf16 v[188:191], v[152:155], a[196:203], v44
  v_smfmac_f32_16x16x64_bf16 v[192:195], v[152:155], a[220:227], v44
  v_smfmac_f32_16x16x64_bf16 v[196:199], v[152:155], a[244:251], v44
  s_nop 7
  v_mov_b32 v200, v196
  v_mov_b32 v201, v197
  v_mov_b32 v202, v198
  v_mov_b32 v203, v199
  v_permlane32_swap_b32 v188, v192
  v_permlane32_swap_b32 v189, v193
  v_permlane32_swap_b32 v190, v194
  v_permlane32_swap_b32 v191, v195
  v_permlane32_swap_b32 v196, v200
  v_permlane32_swap_b32 v197, v201
  v_permlane32_swap_b32 v198, v202
  v_permlane32_swap_b32 v199, v203
  v_pk_add_f32 v[188:189], v[188:189], v[192:193]
  v_pk_add_f32 v[190:191], v[190:191], v[194:195]
  v_pk_add_f32 v[196:197], v[196:197], v[200:201]
  v_pk_add_f32 v[198:199], v[198:199], v[202:203]
  v_cvt_pk_bf16_f32 v252, v188, v189
  v_cvt_pk_bf16_f32 v254, v196, v197
  v_cvt_pk_bf16_f32 v253, v190, v191
  v_cvt_pk_bf16_f32 v255, v198, v199
  s_nop 0
  v_permlane16_swap_b32 v252, v254
  v_permlane16_swap_b32 v253, v255
  v_min_u32 v252, -2, v252
  s_mov_b64 exec, s[76:77]
  buffer_store_dwordx4 v[252:255], v15, s[24:27], s57 offen sc1
  s_mov_b64 exec, -1
  s_branch chain_done
step_55:
  s_add_u32 s21, s52, 2
  s_and_b32 s21, s21, 3
  s_mul_i32 s82, s21, 540672
  s_add_u32 s21, s52, 3
  s_and_b32 s21, s21, 3
  s_lshl_b32 s83, s21, 15
  s_add_u32 s21, s52, 1
  s_and_b32 s22, s21, 3
  s_lshl_b32 s3, s22, 15
  s_mul_i32 s80, s21, 393216
  s_add_u32 s46, s21, 1
  s_min_u32 s46, s46, 64
  s_mul_i32 s85, s52, 98304
  s_mul_i32 s57, s52, 327680
  s_add_u32 s57, s57, 42991616

  s_bfe_u32 s88, s52, 0x10002
  s_add_u32 s78, s81, 278528
  s_max_u32 s21, s52, 1
  s_sub_u32 s21, s21, 1
  s_cmp_lt_u32 s52, 60
  s_cselect_b32 s66, s65, 0x80000000
  s_cselect_b32 s68, 15, 1
  s_cmp_ge_u32 s52, 61
  s_cselect_b32 s66, s90, s66
  s_cselect_b32 s67, s52, s21
  v_mov_b32 v52, 0
  v_mov_b32 v53, 0
  v_mov_b32 v54, 0
  v_mov_b32 v55, 0
  v_mov_b32 v56, 0
  v_mov_b32 v57, 0
  v_mov_b32 v58, 0
  v_mov_b32 v59, 0
  v_mov_b32 v60, 0
  v_mov_b32 v61, 0
  v_mov_b32 v62, 0
  v_mov_b32 v63, 0
  v_mov_b32 v64, 0
  v_mov_b32 v65, 0
  v_mov_b32 v66, 0
  v_mov_b32 v67, 0
  v_mov_b32 v68, 0
  v_mov_b32 v69, 0
  v_mov_b32 v70, 0
  v_mov_b32 v71, 0
  v_mov_b32 v72, 0
  v_mov_b32 v73, 0
  v_mov_b32 v74, 0
  v_mov_b32 v75, 0
  v_mov_b32 v76, 0
  v_mov_b32 v77, 0
  v_mov_b32 v78, 0
  v_mov_b32 v79, 0
  v_mov_b32 v80, 0
  v_mov_b32 v81, 0
  v_mov_b32 v82, 0
  v_mov_b32 v83, 0
  v_mov_b32 v84, 0
  v_mov_b32 v85, 0
  v_mov_b32 v86, 0
  v_mov_b32 v87, 0
  s_sleep 3
  s_cmp_lt_i32 s55, 0
  s_cbranch_scc1 fl_59
fl_60:
  s_mov_b32 s54, 0
  buffer_load_dwordx4 v[32:35], v4, s[4:7], s84 offen offset:0 sc1
  buffer_load_dwordx4 v[36:39], v4, s[4:7], s84 offen offset:1024 sc1
  buffer_load_dwordx4 v[40:43], v4, s[4:7], s84 offen offset:2048 sc1
  s_waitcnt vmcnt(3)
  v_mov_b32 v176, v160
  v_mov_b32 v177, v161
  v_mov_b32 v178, v162
  v_mov_b32 v179, v163
  v_mov_b32 v180, v164
  v_mov_b32 v181, v165
  v_mov_b32 v182, v166
  v_mov_b32 v183, v167
  v_mov_b32 v184, v48
  v_mov_b32 v185, v49
  v_mov_b32 v186, v50
  v_mov_b32 v187, v51
  s_waitcnt vmcnt(0)
  v_bitop3_b32 v27, v35, v39, v43 bitop3:0x80
  v_perm_b32 v35, v39, v35, s89
  v_cmp_gt_u32 vcc, 0x48000000, v27
  v_mov_b32 v39, v42
  s_cbranch_vccnz pm_57
A1_17:
  v_smfmac_f32_16x16x32_f16 v[52:55], v[40:41], a[16:19], v44
  v_smfmac_f32_16x16x32_f16 v[64:67], v[40:41], a[76:79], v44
  v_smfmac_f32_16x16x32_f16 v[56:59], v[40:41], a[36:39], v44
  v_smfmac_f32_16x16x64_f16 v[52:55], v[32:35], a[0:7], v44
  v_smfmac_f32_16x16x64_f16 v[52:55], v[36:39], a[8:15], v44
  v_smfmac_f32_16x16x32_f16 v[68:71], v[40:41], a[96:99], v44
  v_smfmac_f32_16x16x64_f16 v[64:67], v[32:35], a[60:67], v44
  v_smfmac_f32_16x16x64_f16 v[64:67], v[36:39], a[68:75], v44
  v_smfmac_f32_16x16x32_f16 v[60:63], v[40:41], a[56:59], v44
  v_smfmac_f32_16x16x64_f16 v[56:59], v[32:35], a[20:27], v44
  v_smfmac_f32_16x16x64_f16 v[56:59], v[36:39], a[28:35], v44
  v_permlane32_swap_b32 v52, v64
  v_smfmac_f32_16x16x32_f16 v[72:75], v[40:41], a[116:119], v44
  v_permlane32_swap_b32 v53, v65
  v_add_f32 v52, v52, v64
  v_add_f32 v53, v53, v65
  v_smfmac_f32_16x16x64_f16 v[68:71], v[32:35], a[80:87], v44
  ds_write2_b32 v5, v52, v53 offset0:0 offset1:4
  v_smfmac_f32_16x16x64_f16 v[68:71], v[36:39], a[88:95], v44
  v_permlane32_swap_b32 v54, v66
  v_smfmac_f32_16x16x32_f16 v[76:79], v[40:41], a[136:139], v44
  v_permlane32_swap_b32 v55, v67
  v_add_f32 v54, v54, v66
  v_add_f32 v55, v55, v67
  v_smfmac_f32_16x16x64_f16 v[60:63], v[32:35], a[40:47], v44
  ds_write2_b32 v5, v54, v55 offset0:8 offset1:12
  v_smfmac_f32_16x16x64_f16 v[60:63], v[36:39], a[48:55], v44
  v_permlane32_swap_b32 v56, v68
  v_smfmac_f32_16x16x32_f16 v[80:83], v[40:41], a[156:159], v44
  v_permlane32_swap_b32 v57, v69
  v_add_f32 v56, v56, v68
  v_add_f32 v57, v57, v69
  v_smfmac_f32_16x16x64_f16 v[72:75], v[32:35], a[100:107], v44
  ds_write2_b32 v242, v56, v57 offset0:0 offset1:4
  v_smfmac_f32_16x16x64_f16 v[72:75], v[36:39], a[108:115], v44
  v_permlane32_swap_b32 v58, v70
  v_smfmac_f32_16x16x32_f16 v[84:87], v[40:41], a[176:179], v44
  v_permlane32_swap_b32 v59, v71
  v_add_f32 v58, v58, v70
  v_add_f32 v59, v59, v71
  v_smfmac_f32_16x16x64_f16 v[76:79], v[32:35], a[120:127], v44
  ds_write2_b32 v242, v58, v59 offset0:8 offset1:12
  v_smfmac_f32_16x16x64_f16 v[76:79], v[36:39], a[128:135], v44
  v_permlane32_swap_b32 v60, v72
  v_smfmac_f32_16x16x64_f16 v[80:83], v[32:35], a[140:147], v44
  v_permlane32_swap_b32 v61, v73
  v_add_f32 v60, v60, v72
  v_smfmac_f32_16x16x64_f16 v[80:83], v[36:39], a[148:155], v44
  v_add_f32 v61, v61, v73
  ds_write2_b32 v243, v60, v61 offset0:0 offset1:4
  v_smfmac_f32_16x16x64_f16 v[84:87], v[32:35], a[160:167], v44
  v_permlane32_swap_b32 v62, v74
  v_smfmac_f32_16x16x64_f16 v[84:87], v[36:39], a[168:175], v44
  v_permlane32_swap_b32 v63, v75
  v_add_f32 v62, v62, v74
  v_add_f32 v63, v63, v75
  ds_write2_b32 v243, v62, v63 offset0:8 offset1:12
  v_permlane32_swap_b32 v76, v80
  v_permlane32_swap_b32 v77, v81
  v_add_f32 v76, v76, v80
  v_add_f32 v77, v77, v81
  ds_write2_b32 v244, v76, v77 offset0:0 offset1:4
  v_permlane32_swap_b32 v78, v82
  v_permlane32_swap_b32 v79, v83
  v_add_f32 v78, v78, v82
  v_add_f32 v79, v79, v83
  ds_write2_b32 v244, v78, v79 offset0:8 offset1:12
  ds_write2_b32 v245, v84, v85 offset0:0 offset1:4
  ds_write2_b32 v245, v86, v87 offset0:8 offset1:12
  s_waitcnt lgkmcnt(0) vmcnt(0)
  s_barrier
  ds_read_b128 v[96:99], v6 offset:0
  ds_read_b128 v[108:111], v6 offset:5440
  ds_read_b128 v[120:123], v6 offset:10880
  ds_read_b128 v[132:135], v6 offset:16320
  ds_read_b128 v[100:103], v6 offset:1088
  ds_read_b128 v[112:115], v6 offset:6528
  ds_read_b128 v[124:127], v6 offset:11968
  ds_read_b128 v[136:139], v6 offset:17408
  ds_read_b128 v[104:107], v6 offset:2176
  ds_read_b128 v[116:119], v6 offset:7616
  ds_read_b128 v[128:131], v6 offset:13056
  ds_read_b128 v[140:143], v6 offset:18496
  s_waitcnt lgkmcnt(8)
  v_pk_add_f32 v[96:97], v[96:97], v[108:109]
  v_pk_add_f32 v[120:121], v[120:121], v[132:133]
  v_pk_add_f32 v[98:99], v[98:99], v[110:111]
  v_pk_add_f32 v[122:123], v[122:123], v[134:135]
  v_pk_add_f32 v[96:97], v[96:97], v[120:121]
  v_pk_add_f32 v[98:99], v[98:99], v[122:123]
  v_cvt_pk_bf16_f32 v212, v96, v97
  v_cvt_pk_bf16_f32 v213, v98, v99
  s_waitcnt lgkmcnt(4)
  v_pk_add_f32 v[100:101], v[100:101], v[112:113]
  v_pk_add_f32 v[124:125], v[124:125], v[136:137]
  v_pk_add_f32 v[102:103], v[102:103], v[114:115]
  v_pk_add_f32 v[126:127], v[126:127], v[138:139]
  v_pk_add_f32 v[100:101], v[100:101], v[124:125]
  v_pk_add_f32 v[102:103], v[102:103], v[126:127]
  v_cvt_pk_bf16_f32 v214, v100, v101
  v_cvt_pk_bf16_f32 v215, v102, v103
  s_waitcnt lgkmcnt(0)
  v_pk_add_f32 v[104:105], v[104:105], v[116:117]
  v_pk_add_f32 v[128:129], v[128:129], v[140:141]
  v_pk_add_f32 v[106:107], v[106:107], v[118:119]
  v_pk_add_f32 v[130:131], v[130:131], v[142:143]
  v_mfma_f32_16x16x32_bf16 v[96:99], v[212:215], v[212:215], 0
  v_pk_add_f32 v[104:105], v[104:105], v[128:129]
  v_pk_add_f32 v[106:107], v[106:107], v[130:131]
  v_cvt_pk_bf16_f32 v216, v104, v105
  v_cvt_pk_bf16_f32 v217, v106, v107
  s_nop 1
  v_mfma_f32_16x16x32_bf16 v[96:99], v[216:219], v[216:219], v[96:99]
  s_mov_b64 exec, s[74:75]
  s_nop 6
  v_cvt_pk_f16_f32 v100, v96, v97
  v_cvt_pk_f16_f32 v101, v98, v99
  v_and_or_b32 v100, v100, -2, s88
  buffer_store_dwordx2 v[100:101], v7, s[8:11], s81 offen
  s_mov_b64 exec, -1
  s_cmp_eq_u32 s52, 63
  s_cbranch_scc1 last_56
  s_sleep 4
  s_mov_b32 s54, 0
  buffer_load_dwordx2 v[248:249], v9, s[8:11], s81 offen sc1
  buffer_load_dwordx4 v[112:115], v8, s[8:11], s81 offen offset:0 sc1
  buffer_load_dwordx4 v[116:119], v8, s[8:11], s81 offen offset:1024 sc1
  s_sleep 2
  buffer_load_dwordx4 v[144:147], v10, s[8:11], s81 offen offset:0 sc1
  buffer_load_dwordx4 v[148:151], v10, s[8:11], s81 offen offset:1024 sc1
  buffer_load_dwordx4 v[152:155], v10, s[8:11], s81 offen offset:2048 sc1
  v_mov_b32 v188, 0
  v_mov_b32 v189, 0
  v_mov_b32 v190, 0
  v_mov_b32 v191, 0
  v_mov_b32 v192, 0
  v_mov_b32 v193, 0
  v_mov_b32 v194, 0
  v_mov_b32 v195, 0
  v_mov_b32 v196, 0
  v_mov_b32 v197, 0
  v_mov_b32 v198, 0
  v_mov_b32 v199, 0
  v_readfirstlane_b32 s21, v94
  s_add_u32 s22, s46, 2
  s_min_u32 s22, s22, 64
  s_sub_u32 s55, s21, s22
  s_sub_u32 s56, s21, s46
  s_waitcnt vmcnt(5)
  v_xor_b32 v96, s88, v248
  s_nop 0
  v_permlane16_swap_b32 v248, v249
  v_fma_mix_f32 v250, v248, 1.0, v249 op_sel:[0,0,0] op_sel_hi:[1,0,1]
  v_fma_mix_f32 v251, v248, 1.0, v249 op_sel:[1,0,1] op_sel_hi:[1,0,1]
  v_mov_b32 v248, v250
  v_mov_b32 v249, v251
  s_nop 0
  v_permlane32_swap_b32 v248, v250
  v_permlane32_swap_b32 v249, v251
  s_waitcnt vmcnt(3)
  v_bitop3_b32 v97, v112, v114, s88 bitop3:0x7e
  v_bitop3_b32 v98, v116, v118, s88 bitop3:0x7e
  v_fma_mix_f32 v120, v112, 1.0, v116 op_sel:[0,0,0] op_sel_hi:[1,0,1]
  v_or3_b32 v27, v96, v97, v98
  v_fma_mix_f32 v124, v114, 1.0, v118 op_sel:[0,0,0] op_sel_hi:[1,0,1]
  v_and_b32 v27, 1, v27
  v_fma_mix_f32 v121, v112, 1.0, v116 op_sel:[1,0,1] op_sel_hi:[1,0,1]
  v_cmp_ne_u32 vcc, 0, v27
  v_fma_mix_f32 v125, v114, 1.0, v118 op_sel:[1,0,1] op_sel_hi:[1,0,1]
  v_fma_mix_f32 v122, v113, 1.0, v117 op_sel:[0,0,0] op_sel_hi:[1,0,1]
  v_fma_mix_f32 v126, v115, 1.0, v119 op_sel:[0,0,0] op_sel_hi:[1,0,1]
  s_cbranch_vccnz psr_62
psj_63:
  s_cmp_lt_i32 s56, 0
  s_cbranch_scc1 kvw_65
kvok_66:
  v_fma_mix_f32 v123, v113, 1.0, v117 op_sel:[1,0,1] op_sel_hi:[1,0,1]
  v_fma_mix_f32 v127, v115, 1.0, v119 op_sel:[1,0,1] op_sel_hi:[1,0,1]
  v_permlane32_swap_b32 v120, v124
  v_permlane32_swap_b32 v121, v125
  v_permlane32_swap_b32 v122, v126
  v_permlane32_swap_b32 v123, v127
  v_pk_add_f32 v[120:121], v[120:121], v[124:125]
  v_pk_add_f32 v[122:123], v[122:123], v[126:127]
  v_pk_add_f32 v[124:125], v[248:249], v[250:251]
  v_max3_f32 v236, v120, v121, v122
  v_max3_f32 v237, v123, v124, v125
  v_max_f32 v236, v236, v237
  s_nop 1
  v_max_f32_dpp v236, v236, v236 row_ror:8 row_mask:0xf bank_mask:0xf
  v_mov_b32 v237, v236
  s_nop 1
  v_permlane32_swap_b32 v236, v237
  v_max_f32 v236, v236, v237
  v_mov_b32 v237, v236
  s_nop 1
  v_permlane16_swap_b32 v236, v237
  v_max_f32 v236, v236, v237
  s_waitcnt vmcnt(0)
  v_max3_u32 v27, v144, v146, v148
  v_max3_u32 v27, v27, v150, v152
  v_max3_u32 v27, v27, v154, v154
  v_cmp_eq_u32 vcc, -1, v27
  s_nop 1
  s_cbranch_vccnz pv_61
pvj_64:
  v_mul_f32 v236, s86, v236
  v_smfmac_f32_16x16x64_bf16 v[188:191], v[144:147], a[180:187], v44
  v_fma_f32 v120, v120, s86, -v236
  v_smfmac_f32_16x16x64_bf16 v[188:191], v[148:151], a[188:195], v44
  v_fma_f32 v121, v121, s86, -v236
  v_smfmac_f32_16x16x64_bf16 v[188:191], v[152:155], a[196:203], v44
  buffer_load_dwordx4 v[160:163], v17, s[28:31], s64 offen offset:0 sc1
  v_fma_f32 v122, v122, s86, -v236
  v_smfmac_f32_16x16x64_bf16 v[192:195], v[144:147], a[204:211], v44
  v_fma_f32 v123, v123, s86, -v236
  v_smfmac_f32_16x16x64_bf16 v[192:195], v[148:151], a[212:219], v44
  buffer_load_dwordx4 v[164:167], v16, s[28:31], s64 offen offset:1024 sc1
  v_fma_f32 v124, v124, s86, -v236
  v_smfmac_f32_16x16x64_bf16 v[192:195], v[152:155], a[220:227], v44
  v_fma_f32 v125, v125, s86, -v236
  v_smfmac_f32_16x16x64_bf16 v[196:199], v[144:147], a[228:235], v44
  buffer_load_dwordx4 v[48:51], v26, s[28:31], s64 offen offset:2048 sc1
  v_exp_f32 v120, v120
  v_smfmac_f32_16x16x64_bf16 v[196:199], v[148:151], a[236:243], v44
  v_exp_f32 v121, v121
  v_smfmac_f32_16x16x64_bf16 v[196:199], v[152:155], a[244:251], v44
  v_exp_f32 v122, v122
  v_exp_f32 v123, v123
  v_exp_f32 v124, v124
  v_exp_f32 v125, v125
  s_mov_b64 exec, s[60:61]
  v_cvt_pk_bf16_f32 v220, v120, v121
  v_cvt_pk_bf16_f32 v221, v122, v123
  v_cvt_pk_bf16_f32 v224, v124, v125
  s_mov_b64 exec, s[62:63]
  v_cvt_pk_bf16_f32 v222, v120, v121
  v_cvt_pk_bf16_f32 v223, v122, v123
  v_cvt_pk_bf16_f32 v225, v124, v125
  s_mov_b64 exec, -1
  v_pk_add_f32 v[126:127], v[120:121], v[122:123]
  v_add_f32 v128, v124, v125
  v_mfma_f32_16x16x32_bf16 v[200:203], v[176:179], v[220:223], 0
  v_add_f32 v236, v126, v127
  v_fmac_f32 v236, v128, v89
  v_cvt_pk_bf16_f32 v228, v188, v189
  v_cvt_pk_bf16_f32 v229, v190, v191
  v_mfma_f32_16x16x32_bf16 v[204:207], v[180:183], v[220:223], 0
  v_cvt_pk_bf16_f32 v230, v192, v193
  v_cvt_pk_bf16_f32 v231, v194, v195
  v_mfma_f32_16x16x32_bf16 v[208:211], v[184:187], v[220:223], 0
  v_cvt_pk_bf16_f32 v232, v196, v197
  v_cvt_pk_bf16_f32 v233, v198, v199
  v_add_f32_dpp v236, v236, v236 row_ror:8 row_mask:0xf bank_mask:0xf
  v_mov_b32 v237, v236
  s_nop 0
  v_mfma_f32_16x16x32_bf16 v[200:203], v[228:231], v[224:227], v[200:203]
  v_mfma_f32_16x16x32_bf16 v[204:207], v[230:233], v[224:227], v[204:207]
  v_permlane32_swap_b32 v236, v237
  v_add_f32 v236, v236, v237
  v_mov_b32 v237, v236
  v_mfma_f32_16x16x32_bf16 v[208:211], v[232:235], v[224:227], v[208:211]
  s_nop 0
  v_permlane16_swap_b32 v236, v237
  v_add_f32 v236, v236, v237
  v_rcp_f32 v236, v236
  s_nop 2
  v_pk_mul_f32 v[200:201], v[200:201], v[236:237] op_sel_hi:[1,0]
  v_pk_mul_f32 v[202:203], v[202:203], v[236:237] op_sel_hi:[1,0]
  ds_write_b128 v11, v[200:203] offset:0
  v_pk_mul_f32 v[204:205], v[204:205], v[236:237] op_sel_hi:[1,0]
  v_pk_mul_f32 v[206:207], v[206:207], v[236:237] op_sel_hi:[1,0]
  ds_write_b128 v11, v[204:207] offset:1024
  v_pk_mul_f32 v[208:209], v[208:209], v[236:237] op_sel_hi:[1,0]
  v_pk_mul_f32 v[210:211], v[210:211], v[236:237] op_sel_hi:[1,0]
  ds_write_b128 v11, v[208:211] offset:2048
  s_waitcnt lgkmcnt(0)
  s_barrier
  ds_read_b64 v[96:97], v12 offset:0
  ds_read_b64 v[98:99], v12 offset:128
  ds_read_b64 v[100:101], v12 offset:3072
  ds_read_b64 v[102:103], v12 offset:3200
  ds_read_b64 v[104:105], v12 offset:6144
  ds_read_b64 v[106:107], v12 offset:6272
  ds_read_b64 v[108:109], v12 offset:9216
  ds_read_b64 v[110:111], v12 offset:9344
  s_waitcnt lgkmcnt(6)
  v_pk_add_f32 v[96:97], v[96:97], v[98:99]
  s_waitcnt lgkmcnt(4)
  v_pk_add_f32 v[100:101], v[100:101], v[102:103]
  s_waitcnt lgkmcnt(2)
  v_pk_add_f32 v[104:105], v[104:105], v[106:107]
  v_pk_add_f32 v[96:97], v[96:97], v[100:101]
  s_waitcnt lgkmcnt(0)
  v_pk_add_f32 v[108:109], v[108:109], v[110:111]
  v_pk_add_f32 v[96:97], v[96:97], v[104:105]
  v_pk_add_f32 v[96:97], v[96:97], v[108:109]
  v_cvt_pk_f16_f32 v100, v96, v97
  v_perm_b32 v100, s91, v100, v14
  buffer_atomic_pk_add_f16 v100, v13, s[4:7], s3 offen
  s_mov_b64 exec, s[62:63]
  buffer_store_dwordx4 v[212:215], v21, s[24:27], s85 offen sc1
  buffer_store_dwordx2 v[216:217], v23, s[24:27], s85 offen sc1
  s_mov_b64 exec, -1
  v_mov_b32 v200, v196
  v_mov_b32 v201, v197
  v_mov_b32 v202, v198
  v_mov_b32 v203, v199
  v_permlane32_swap_b32 v188, v192
  v_permlane32_swap_b32 v189, v193
  v_permlane32_swap_b32 v190, v194
  v_permlane32_swap_b32 v191, v195
  v_permlane32_swap_b32 v196, v200
  v_permlane32_swap_b32 v197, v201
  v_permlane32_swap_b32 v198, v202
  v_permlane32_swap_b32 v199, v203
  v_pk_add_f32 v[188:189], v[188:189], v[192:193]
  v_pk_add_f32 v[190:191], v[190:191], v[194:195]
  v_pk_add_f32 v[196:197], v[196:197], v[200:201]
  v_pk_add_f32 v[198:199], v[198:199], v[202:203]
  v_cvt_pk_bf16_f32 v252, v188, v189
  v_cvt_pk_bf16_f32 v254, v196, v197
  v_cvt_pk_bf16_f32 v253, v190, v191
  v_cvt_pk_bf16_f32 v255, v198, v199
  s_nop 0
  v_permlane16_swap_b32 v252, v254
  v_permlane16_swap_b32 v253, v255
  v_min_u32 v252, -2, v252
  s_mov_b64 exec, s[76:77]
  buffer_store_dwordx4 v[252:255], v15, s[24:27], s57 offen sc1
  s_mov_b64 exec, -1
  s_add_u32 s64, s64, 1310720
  s_add_u32 s52, s52, 1
  s_and_b32 s21, s52, 3
  s_mul_i32 s81, s21, 540672
  s_lshl_b32 s84, s21, 15
  s_branch step_55
fl_59:
  buffer_load_dword v94, v95, s[12:15], s79 offen sc1
  s_branch fl_60
pm_57:
  s_cmp_gt_u32 s52, 3
  s_cbranch_scc1 op_67
  v_readfirstlane_b32 s21, v94
  s_cmp_ge_u32 s21, s46
  s_cbranch_scc1 op_67
  buffer_load_dword v94, v95, s[12:15], s79 offen sc1
  s_waitcnt vmcnt(0)
  v_readfirstlane_b32 s21, v94
  s_add_u32 s22, s46, 2
  s_min_u32 s22, s22, 64
  s_sub_u32 s55, s21, s22
  s_sub_u32 s56, s21, s46
  s_cmp_gt_u32 s21, s52
  s_cselect_b32 s21, s87, 0
  s_cmp_eq_u32 s21, 0
  s_cbranch_scc1 op_67
  s_mov_b32 s87, 0
  s_sub_u32 s21, s64, 1310720
  buffer_load_dwordx4 v[176:179], v16, s[28:31], s21 offen offset:0 sc1
  buffer_load_dwordx4 v[180:183], v16, s[28:31], s21 offen offset:1024 sc1
  buffer_load_dwordx4 v[184:187], v16, s[28:31], s21 offen offset:2048 sc1
op_67:
  buffer_load_dwordx4 v[32:35], v4, s[4:7], s84 offen offset:0 sc1
  buffer_load_dwordx4 v[36:39], v4, s[4:7], s84 offen offset:1024 sc1
  buffer_load_dwordx4 v[40:43], v4, s[4:7], s84 offen offset:2048 sc1
  s_add_u32 s54, s54, 1
  s_cmp_gt_u32 s54, 131072
  s_cbranch_scc1 end0
  s_waitcnt vmcnt(0)
  v_bitop3_b32 v27, v35, v39, v43 bitop3:0x80
  v_perm_b32 v35, v39, v35, s89
  v_cmp_gt_u32 vcc, 0x48000000, v27
  v_mov_b32 v39, v42
  s_cbranch_vccnz pm_57
  s_branch A1_17
pv_61:
  buffer_load_dwordx4 v[144:147], v10, s[8:11], s81 offen offset:0 sc1
  buffer_load_dwordx4 v[148:151], v10, s[8:11], s81 offen offset:1024 sc1
  buffer_load_dwordx4 v[152:155], v10, s[8:11], s81 offen offset:2048 sc1
  s_add_u32 s54, s54, 1
  s_cmp_gt_u32 s54, 131072
  s_cbranch_scc1 end0
  s_waitcnt vmcnt(0)
  v_max3_u32 v27, v144, v146, v148
  v_max3_u32 v27, v27, v150, v152
  v_max3_u32 v27, v27, v154, v154
  v_cmp_eq_u32 vcc, -1, v27
  s_nop 1
  s_cbranch_vccnz pv_61
  s_branch pvj_64
psr_62:
  s_cmp_gt_u32 s52, 3
  s_cbranch_scc1 op_68
  v_readfirstlane_b32 s21, v94
  s_cmp_ge_u32 s21, s46
  s_cbranch_scc1 op_68
  buffer_load_dword v94, v95, s[12:15], s79 offen sc1
  s_waitcnt vmcnt(0)
  v_readfirstlane_b32 s21, v94
  s_add_u32 s22, s46, 2
  s_min_u32 s22, s22, 64
  s_sub_u32 s55, s21, s22
  s_sub_u32 s56, s21, s46
  s_cmp_gt_u32 s21, s52
  s_cselect_b32 s21, s87, 0
  s_cmp_eq_u32 s21, 0
  s_cbranch_scc1 op_68
  s_mov_b32 s87, 0
  s_sub_u32 s21, s64, 1310720
  buffer_load_dwordx4 v[176:179], v16, s[28:31], s21 offen offset:0 sc1
  buffer_load_dwordx4 v[180:183], v16, s[28:31], s21 offen offset:1024 sc1
  buffer_load_dwordx4 v[184:187], v16, s[28:31], s21 offen offset:2048 sc1
op_68:
  buffer_load_dwordx2 v[248:249], v9, s[8:11], s81 offen sc1
  buffer_load_dwordx4 v[112:115], v8, s[8:11], s81 offen offset:0 sc1
  buffer_load_dwordx4 v[116:119], v8, s[8:11], s81 offen offset:1024 sc1
  s_add_u32 s54, s54, 1
  s_cmp_gt_u32 s54, 131072
  s_cbranch_scc1 end0
  s_waitcnt vmcnt(2)
  v_xor_b32 v96, s88, v248
  s_nop 0
  v_permlane16_swap_b32 v248, v249
  v_fma_mix_f32 v250, v248, 1.0, v249 op_sel:[0,0,0] op_sel_hi:[1,0,1]
  v_fma_mix_f32 v251, v248, 1.0, v249 op_sel:[1,0,1] op_sel_hi:[1,0,1]
  v_mov_b32 v248, v250
  v_mov_b32 v249, v251
  s_nop 0
  v_permlane32_swap_b32 v248, v250
  v_permlane32_swap_b32 v249, v251
  s_waitcnt vmcnt(0)
  v_bitop3_b32 v97, v112, v114, s88 bitop3:0x7e
  v_bitop3_b32 v98, v116, v118, s88 bitop3:0x7e
  v_fma_mix_f32 v120, v112, 1.0, v116 op_sel:[0,0,0] op_sel_hi:[1,0,1]
  v_or3_b32 v27, v96, v97, v98
  v_fma_mix_f32 v124, v114, 1.0, v118 op_sel:[0,0,0] op_sel_hi:[1,0,1]
  v_and_b32 v27, 1, v27
  v_fma_mix_f32 v121, v112, 1.0, v116 op_sel:[1,0,1] op_sel_hi:[1,0,1]
  v_cmp_ne_u32 vcc, 0, v27
  v_fma_mix_f32 v125, v114, 1.0, v118 op_sel:[1,0,1] op_sel_hi:[1,0,1]
  v_fma_mix_f32 v122, v113, 1.0, v117 op_sel:[0,0,0] op_sel_hi:[1,0,1]
  v_fma_mix_f32 v126, v115, 1.0, v119 op_sel:[0,0,0] op_sel_hi:[1,0,1]
  s_cbranch_vccnz psr_62
  s_branch psj_63
kvw_65:
  s_mov_b32 s22, s87
  s_cmp_eq_u32 s52, 0
  s_cselect_b32 s23, s87, s46
  s_cselect_b32 s55, 0, s55
  s_cselect_b32 s87, 1, 0
  s_cmp_eq_u32 s23, 0
  s_cbranch_scc1 kvok_66
  v_mov_b32 v236, 0
  s_mov_b32 s101, 0
wf_69:
  buffer_load_dword v237, v236, s[12:15], s79 offen sc1
  s_add_u32 s101, s101, 1
  s_cmp_gt_u32 s101, 131072
  s_cbranch_scc1 end0
  s_waitcnt vmcnt(0)
  v_readfirstlane_b32 s100, v237
  s_cmp_ge_u32 s100, s23
  s_cbranch_scc1 wf_70
  s_sleep 3
  s_branch wf_69
wf_70:
  s_cmp_eq_u32 s22, 0
  s_cbranch_scc1 kvok_66
  s_sub_u32 s21, s64, 1310720
  buffer_load_dwordx4 v[176:179], v16, s[28:31], s21 offen offset:0 sc1
  buffer_load_dwordx4 v[180:183], v16, s[28:31], s21 offen offset:1024 sc1
  buffer_load_dwordx4 v[184:187], v16, s[28:31], s21 offen offset:2048 sc1
  s_waitcnt vmcnt(0)
  s_branch kvok_66
last_56:
  s_mov_b64 exec, s[62:63]
  buffer_store_dwordx4 v[212:215], v21, s[24:27], s85 offen sc1
  buffer_store_dwordx2 v[216:217], v23, s[24:27], s85 offen sc1
  s_mov_b64 exec, -1
  v_mov_b32 v188, 0
  v_mov_b32 v189, 0
  v_mov_b32 v190, 0
  v_mov_b32 v191, 0
  v_mov_b32 v192, 0
  v_mov_b32 v193, 0
  v_mov_b32 v194, 0
  v_mov_b32 v195, 0
  v_mov_b32 v196, 0
  v_mov_b32 v197, 0
  v_mov_b32 v198, 0
  v_mov_b32 v199, 0
  s_sleep 4
  s_mov_b32 s54, 0
lv_71:
  buffer_load_dwordx4 v[144:147], v10, s[8:11], s81 offen offset:0 sc1
  buffer_load_dwordx4 v[148:151], v10, s[8:11], s81 offen offset:1024 sc1
  buffer_load_dwordx4 v[152:155], v10, s[8:11], s81 offen offset:2048 sc1
  s_add_u32 s54, s54, 1
  s_cmp_gt_u32 s54, 131072
  s_cbranch_scc1 end0
  s_waitcnt vmcnt(0)
  v_max3_u32 v27, v144, v146, v148
  v_max3_u32 v27, v27, v150, v152
  v_max3_u32 v27, v27, v154, v154
  v_cmp_eq_u32 vcc, -1, v27
  s_nop 1
  s_cbranch_vccnz lv_71
  v_smfmac_f32_16x16x64_bf16 v[188:191], v[144:147], a[180:187], v44
  v_smfmac_f32_16x16x64_bf16 v[192:195], v[144:147], a[204:211], v44
  v_smfmac_f32_16x16x64_bf16 v[196:199], v[144:147], a[228:235], v44
  v_smfmac_f32_16x16x64_bf16 v[188:191], v[148:151], a[188:195], v44
  v_smfmac_f32_16x16x64_bf16 v[192:195], v[148:151], a[212:219], v44
  v_smfmac_f32_16x16x64_bf16 v[196:199], v[148:151], a[236:243], v44
  v_smfmac_f32_16x16x64_bf16 v[188:191], v[152:155], a[196:203], v44
  v_smfmac_f32_16x16x64_bf16 v[192:195], v[152:155], a[220:227], v44
  v_smfmac_f32_16x16x64_bf16 v[196:199], v[152:155], a[244:251], v44
  v_mov_b32 v236, 64
  s_mov_b64 exec, 1
  buffer_store_dword v236, v95, s[12:15], s90 offen sc1
  s_mov_b64 exec, -1
  s_nop 7
  v_mov_b32 v200, v196
  v_mov_b32 v201, v197
  v_mov_b32 v202, v198
  v_mov_b32 v203, v199
  v_permlane32_swap_b32 v188, v192
  v_permlane32_swap_b32 v189, v193
  v_permlane32_swap_b32 v190, v194
  v_permlane32_swap_b32 v191, v195
  v_permlane32_swap_b32 v196, v200
  v_permlane32_swap_b32 v197, v201
  v_permlane32_swap_b32 v198, v202
  v_permlane32_swap_b32 v199, v203
  v_pk_add_f32 v[188:189], v[188:189], v[192:193]
  v_pk_add_f32 v[190:191], v[190:191], v[194:195]
  v_pk_add_f32 v[196:197], v[196:197], v[200:201]
  v_pk_add_f32 v[198:199], v[198:199], v[202:203]
  v_cvt_pk_bf16_f32 v252, v188, v189
  v_cvt_pk_bf16_f32 v254, v196, v197
  v_cvt_pk_bf16_f32 v253, v190, v191
  v_cvt_pk_bf16_f32 v255, v198, v199
  s_nop 0
  v_permlane16_swap_b32 v252, v254
  v_permlane16_swap_b32 v253, v255
  v_min_u32 v252, -2, v252
  s_mov_b64 exec, s[76:77]
  buffer_store_dwordx4 v[252:255], v15, s[24:27], s57 offen sc1
  s_mov_b64 exec, -1
  s_branch chain_done
step_72:
  s_add_u32 s21, s52, 2
  s_and_b32 s21, s21, 3
  s_mul_i32 s82, s21, 540672
  s_add_u32 s21, s52, 3
  s_and_b32 s21, s21, 3
  s_lshl_b32 s83, s21, 15
  s_add_u32 s21, s52, 1
  s_and_b32 s22, s21, 3
  s_lshl_b32 s3, s22, 15
  s_mul_i32 s80, s21, 393216
  s_add_u32 s46, s21, 1
  s_min_u32 s46, s46, 64
  s_mul_i32 s85, s52, 98304
  s_mul_i32 s57, s52, 327680
  s_add_u32 s57, s57, 42991616

  s_bfe_u32 s88, s52, 0x10002
  s_add_u32 s78, s81, 278528
  s_max_u32 s21, s52, 1
  s_sub_u32 s21, s21, 1
  s_cmp_lt_u32 s52, 60
  s_cselect_b32 s66, s65, 0x80000000
  s_cselect_b32 s68, 15, 1
  s_cmp_ge_u32 s52, 61
  s_cselect_b32 s66, s90, s66
  s_cselect_b32 s67, s52, s21
  v_mov_b32 v52, 0
  v_mov_b32 v53, 0
  v_mov_b32 v54, 0
  v_mov_b32 v55, 0
  v_mov_b32 v56, 0
  v_mov_b32 v57, 0
  v_mov_b32 v58, 0
  v_mov_b32 v59, 0
  v_mov_b32 v60, 0
  v_mov_b32 v61, 0
  v_mov_b32 v62, 0
  v_mov_b32 v63, 0
  v_mov_b32 v64, 0
  v_mov_b32 v65, 0
  v_mov_b32 v66, 0
  v_mov_b32 v67, 0
  v_mov_b32 v68, 0
  v_mov_b32 v69, 0
  v_mov_b32 v70, 0
  v_mov_b32 v71, 0
  v_mov_b32 v72, 0
  v_mov_b32 v73, 0
  v_mov_b32 v74, 0
  v_mov_b32 v75, 0
  v_mov_b32 v76, 0
  v_mov_b32 v77, 0
  v_mov_b32 v78, 0
  v_mov_b32 v79, 0
  v_mov_b32 v80, 0
  v_mov_b32 v81, 0
  v_mov_b32 v82, 0
  v_mov_b32 v83, 0
  v_mov_b32 v84, 0
  v_mov_b32 v85, 0
  v_mov_b32 v86, 0
  v_mov_b32 v87, 0
  s_sleep 5
  s_cmp_lt_i32 s55, 0
  s_cbranch_scc1 fl_76
fl_77:
  s_mov_b32 s54, 0
  buffer_load_dwordx4 v[32:35], v4, s[4:7], s84 offen offset:0 sc1
  buffer_load_dwordx4 v[36:39], v4, s[4:7], s84 offen offset:1024 sc1
  buffer_load_dwordx4 v[40:43], v4, s[4:7], s84 offen offset:2048 sc1
  s_waitcnt vmcnt(3)
  v_mov_b32 v176, v160
  v_mov_b32 v177, v161
  v_mov_b32 v178, v162
  v_mov_b32 v179, v163
  v_mov_b32 v180, v164
  v_mov_b32 v181, v165
  v_mov_b32 v182, v166
  v_mov_b32 v183, v167
  v_mov_b32 v184, v48
  v_mov_b32 v185, v49
  v_mov_b32 v186, v50
  v_mov_b32 v187, v51
  s_waitcnt vmcnt(0)
  v_bitop3_b32 v27, v35, v39, v43 bitop3:0x80
  v_perm_b32 v35, v39, v35, s89
  v_cmp_gt_u32 vcc, 0x48000000, v27
  v_mov_b32 v39, v42
  s_cbranch_vccnz pm_74
A1_18:
  v_smfmac_f32_16x16x32_f16 v[52:55], v[40:41], a[16:19], v44
  v_smfmac_f32_16x16x32_f16 v[64:67], v[40:41], a[76:79], v44
  v_smfmac_f32_16x16x32_f16 v[56:59], v[40:41], a[36:39], v44
  v_smfmac_f32_16x16x64_f16 v[52:55], v[32:35], a[0:7], v44
  v_smfmac_f32_16x16x64_f16 v[52:55], v[36:39], a[8:15], v44
  v_smfmac_f32_16x16x32_f16 v[68:71], v[40:41], a[96:99], v44
  v_smfmac_f32_16x16x64_f16 v[64:67], v[32:35], a[60:67], v44
  v_smfmac_f32_16x16x64_f16 v[64:67], v[36:39], a[68:75], v44
  v_smfmac_f32_16x16x32_f16 v[60:63], v[40:41], a[56:59], v44
  v_smfmac_f32_16x16x64_f16 v[56:59], v[32:35], a[20:27], v44
  v_smfmac_f32_16x16x64_f16 v[56:59], v[36:39], a[28:35], v44
  v_permlane32_swap_b32 v52, v64
  v_smfmac_f32_16x16x32_f16 v[72:75], v[40:41], a[116:119], v44
  v_permlane32_swap_b32 v53, v65
  v_add_f32 v52, v52, v64
  v_add_f32 v53, v53, v65
  v_smfmac_f32_16x16x64_f16 v[68:71], v[32:35], a[80:87], v44
  ds_write2_b32 v5, v52, v53 offset0:0 offset1:4
  v_smfmac_f32_16x16x64_f16 v[68:71], v[36:39], a[88:95], v44
  v_permlane32_swap_b32 v54, v66
  v_smfmac_f32_16x16x32_f16 v[76:79], v[40:41], a[136:139], v44
  v_permlane32_swap_b32 v55, v67
  v_add_f32 v54, v54, v66
  v_add_f32 v55, v55, v67
  v_smfmac_f32_16x16x64_f16 v[60:63], v[32:35], a[40:47], v44
  ds_write2_b32 v5, v54, v55 offset0:8 offset1:12
  v_smfmac_f32_16x16x64_f16 v[60:63], v[36:39], a[48:55], v44
  v_permlane32_swap_b32 v56, v68
  v_smfmac_f32_16x16x32_f16 v[80:83], v[40:41], a[156:159], v44
  v_permlane32_swap_b32 v57, v69
  v_add_f32 v56, v56, v68
  v_add_f32 v57, v57, v69
  v_smfmac_f32_16x16x64_f16 v[72:75], v[32:35], a[100:107], v44
  ds_write2_b32 v242, v56, v57 offset0:0 offset1:4
  v_smfmac_f32_16x16x64_f16 v[72:75], v[36:39], a[108:115], v44
  v_permlane32_swap_b32 v58, v70
  v_smfmac_f32_16x16x32_f16 v[84:87], v[40:41], a[176:179], v44
  v_permlane32_swap_b32 v59, v71
  v_add_f32 v58, v58, v70
  v_add_f32 v59, v59, v71
  v_smfmac_f32_16x16x64_f16 v[76:79], v[32:35], a[120:127], v44
  ds_write2_b32 v242, v58, v59 offset0:8 offset1:12
  v_smfmac_f32_16x16x64_f16 v[76:79], v[36:39], a[128:135], v44
  v_permlane32_swap_b32 v60, v72
  v_smfmac_f32_16x16x64_f16 v[80:83], v[32:35], a[140:147], v44
  v_permlane32_swap_b32 v61, v73
  v_add_f32 v60, v60, v72
  v_smfmac_f32_16x16x64_f16 v[80:83], v[36:39], a[148:155], v44
  v_add_f32 v61, v61, v73
  ds_write2_b32 v243, v60, v61 offset0:0 offset1:4
  v_smfmac_f32_16x16x64_f16 v[84:87], v[32:35], a[160:167], v44
  v_permlane32_swap_b32 v62, v74
  v_smfmac_f32_16x16x64_f16 v[84:87], v[36:39], a[168:175], v44
  v_permlane32_swap_b32 v63, v75
  v_add_f32 v62, v62, v74
  v_add_f32 v63, v63, v75
  ds_write2_b32 v243, v62, v63 offset0:8 offset1:12
  v_permlane32_swap_b32 v76, v80
  v_permlane32_swap_b32 v77, v81
  v_add_f32 v76, v76, v80
  v_add_f32 v77, v77, v81
  ds_write2_b32 v244, v76, v77 offset0:0 offset1:4
  v_permlane32_swap_b32 v78, v82
  v_permlane32_swap_b32 v79, v83
  v_add_f32 v78, v78, v82
  v_add_f32 v79, v79, v83
  ds_write2_b32 v244, v78, v79 offset0:8 offset1:12
  ds_write2_b32 v245, v84, v85 offset0:0 offset1:4
  ds_write2_b32 v245, v86, v87 offset0:8 offset1:12
  s_waitcnt lgkmcnt(0) vmcnt(0)
  s_barrier
  ds_read_b128 v[96:99], v6 offset:3264
  ds_read_b128 v[100:103], v6 offset:8704
  ds_read_b128 v[104:107], v6 offset:14144
  ds_read_b128 v[108:111], v6 offset:19584
  ds_read_b128 v[112:115], v6 offset:4352
  ds_read_b128 v[116:119], v6 offset:9792
  ds_read_b128 v[120:123], v6 offset:15232
  ds_read_b128 v[124:127], v6 offset:20672
  s_waitcnt lgkmcnt(4)
  v_pk_add_f32 v[96:97], v[96:97], v[100:101]
  v_pk_add_f32 v[98:99], v[98:99], v[102:103]
  v_pk_add_f32 v[104:105], v[104:105], v[108:109]
  v_pk_add_f32 v[106:107], v[106:107], v[110:111]
  v_pk_add_f32 v[96:97], v[96:97], v[104:105]
  v_pk_add_f32 v[98:99], v[98:99], v[106:107]
  v_cvt_pk_bf16_f32 v90, v96, v97
  v_cvt_pk_bf16_f32 v91, v98, v99
  v_min_u32 v90, -2, v90
  v_min_u32 v91, -2, v91
  buffer_store_dwordx2 v[90:91], v24, s[8:11], s81 offen
  s_waitcnt lgkmcnt(0)
  v_pk_add_f32 v[112:113], v[112:113], v[116:117]
  v_pk_add_f32 v[114:115], v[114:115], v[118:119]
  v_pk_add_f32 v[120:121], v[120:121], v[124:125]
  v_pk_add_f32 v[122:123], v[122:123], v[126:127]
  v_pk_add_f32 v[112:113], v[112:113], v[120:121]
  v_pk_add_f32 v[114:115], v[114:115], v[122:123]
  s_nop 1
  v_add_f32_dpp v116, v112, v112 row_ror:8 row_mask:0xf bank_mask:0xf
  v_add_f32_dpp v117, v113, v113 row_ror:8 row_mask:0xf bank_mask:0xf
  v_add_f32_dpp v118, v114, v114 row_ror:8 row_mask:0xf bank_mask:0xf
  v_add_f32_dpp v119, v115, v115 row_ror:8 row_mask:0xf bank_mask:0xf
  v_cvt_pk_bf16_f32 v92, v116, v117
  v_cvt_pk_bf16_f32 v93, v118, v119
  v_min_u32 v92, -2, v92
  v_min_u32 v93, -2, v93
  s_mov_b64 exec, s[60:61]
  buffer_store_dwordx2 v[92:93], v23, s[8:11], s78 offen
  s_mov_b64 exec, -1
  s_cmp_eq_u32 s52, 63
  s_cbranch_scc1 last_73
  s_sleep 5
  s_mov_b32 s54, 0
  buffer_load_dwordx2 v[248:249], v9, s[8:11], s81 offen sc1
  buffer_load_dwordx4 v[112:115], v8, s[8:11], s81 offen offset:0 sc1
  buffer_load_dwordx4 v[116:119], v8, s[8:11], s81 offen offset:1024 sc1
  s_sleep 2
  buffer_load_dwordx4 v[144:147], v10, s[8:11], s81 offen offset:0 sc1
  buffer_load_dwordx4 v[148:151], v10, s[8:11], s81 offen offset:1024 sc1
  buffer_load_dwordx4 v[152:155], v10, s[8:11], s81 offen offset:2048 sc1
  v_mov_b32 v188, 0
  v_mov_b32 v189, 0
  v_mov_b32 v190, 0
  v_mov_b32 v191, 0
  v_mov_b32 v192, 0
  v_mov_b32 v193, 0
  v_mov_b32 v194, 0
  v_mov_b32 v195, 0
  v_mov_b32 v196, 0
  v_mov_b32 v197, 0
  v_mov_b32 v198, 0
  v_mov_b32 v199, 0
  v_readfirstlane_b32 s21, v94
  s_add_u32 s22, s46, 2
  s_min_u32 s22, s22, 64
  s_sub_u32 s55, s21, s22
  s_sub_u32 s56, s21, s46
  s_waitcnt vmcnt(5)
  v_xor_b32 v96, s88, v248
  s_nop 0
  v_permlane16_swap_b32 v248, v249
  v_fma_mix_f32 v250, v248, 1.0, v249 op_sel:[0,0,0] op_sel_hi:[1,0,1]
  v_fma_mix_f32 v251, v248, 1.0, v249 op_sel:[1,0,1] op_sel_hi:[1,0,1]
  v_mov_b32 v248, v250
  v_mov_b32 v249, v251
  s_nop 0
  v_permlane32_swap_b32 v248, v250
  v_permlane32_swap_b32 v249, v251
  s_waitcnt vmcnt(3)
  v_bitop3_b32 v97, v112, v114, s88 bitop3:0x7e
  v_bitop3_b32 v98, v116, v118, s88 bitop3:0x7e
  v_fma_mix_f32 v120, v112, 1.0, v116 op_sel:[0,0,0] op_sel_hi:[1,0,1]
  v_or3_b32 v27, v96, v97, v98
  v_fma_mix_f32 v124, v114, 1.0, v118 op_sel:[0,0,0] op_sel_hi:[1,0,1]
  v_and_b32 v27, 1, v27
  v_fma_mix_f32 v121, v112, 1.0, v116 op_sel:[1,0,1] op_sel_hi:[1,0,1]
  v_cmp_ne_u32 vcc, 0, v27
  v_fma_mix_f32 v125, v114, 1.0, v118 op_sel:[1,0,1] op_sel_hi:[1,0,1]
  v_fma_mix_f32 v122, v113, 1.0, v117 op_sel:[0,0,0] op_sel_hi:[1,0,1]
  v_fma_mix_f32 v126, v115, 1.0, v119 op_sel:[0,0,0] op_sel_hi:[1,0,1]
  s_cbranch_vccnz psr_79
psj_80:
  s_cmp_lt_i32 s56, 0
  s_cbranch_scc1 kvw_82
kvok_83:
  v_fma_mix_f32 v123, v113, 1.0, v117 op_sel:[1,0,1] op_sel_hi:[1,0,1]
  v_fma_mix_f32 v127, v115, 1.0, v119 op_sel:[1,0,1] op_sel_hi:[1,0,1]
  v_permlane32_swap_b32 v120, v124
  v_permlane32_swap_b32 v121, v125
  v_permlane32_swap_b32 v122, v126
  v_permlane32_swap_b32 v123, v127
  v_pk_add_f32 v[120:121], v[120:121], v[124:125]
  v_pk_add_f32 v[122:123], v[122:123], v[126:127]
  v_pk_add_f32 v[124:125], v[248:249], v[250:251]
  v_max3_f32 v236, v120, v121, v122
  v_max3_f32 v237, v123, v124, v125
  v_max_f32 v236, v236, v237
  s_nop 1
  v_max_f32_dpp v236, v236, v236 row_ror:8 row_mask:0xf bank_mask:0xf
  v_mov_b32 v237, v236
  s_nop 1
  v_permlane32_swap_b32 v236, v237
  v_max_f32 v236, v236, v237
  v_mov_b32 v237, v236
  s_nop 1
  v_permlane16_swap_b32 v236, v237
  v_max_f32 v236, v236, v237
  s_waitcnt vmcnt(0)
  v_max3_u32 v27, v144, v146, v148
  v_max3_u32 v27, v27, v150, v152
  v_max3_u32 v27, v27, v154, v154
  v_cmp_eq_u32 vcc, -1, v27
  s_nop 1
  s_cbranch_vccnz pv_78
pvj_81:
  v_mul_f32 v236, s86, v236
  v_smfmac_f32_16x16x64_bf16 v[188:191], v[144:147], a[180:187], v44
  v_fma_f32 v120, v120, s86, -v236
  v_smfmac_f32_16x16x64_bf16 v[188:191], v[148:151], a[188:195], v44
  v_fma_f32 v121, v121, s86, -v236
  v_smfmac_f32_16x16x64_bf16 v[188:191], v[152:155], a[196:203], v44
  buffer_load_dwordx4 v[160:163], v17, s[28:31], s64 offen offset:0 sc1
  v_fma_f32 v122, v122, s86, -v236
  v_smfmac_f32_16x16x64_bf16 v[192:195], v[144:147], a[204:211], v44
  v_fma_f32 v123, v123, s86, -v236
  v_smfmac_f32_16x16x64_bf16 v[192:195], v[148:151], a[212:219], v44
  buffer_load_dwordx4 v[164:167], v16, s[28:31], s64 offen offset:1024 sc1
  v_fma_f32 v124, v124, s86, -v236
  v_smfmac_f32_16x16x64_bf16 v[192:195], v[152:155], a[220:227], v44
  v_fma_f32 v125, v125, s86, -v236
  v_smfmac_f32_16x16x64_bf16 v[196:199], v[144:147], a[228:235], v44
  buffer_load_dwordx4 v[48:51], v26, s[28:31], s64 offen offset:2048 sc1
  v_exp_f32 v120, v120
  v_smfmac_f32_16x16x64_bf16 v[196:199], v[148:151], a[236:243], v44
  v_exp_f32 v121, v121
  v_smfmac_f32_16x16x64_bf16 v[196:199], v[152:155], a[244:251], v44
  v_exp_f32 v122, v122
  v_exp_f32 v123, v123
  v_mov_b32 v240, s67
  v_mov_b32 v241, s67
  s_mov_b64 exec, s[68:69]
  buffer_store_dwordx2 v[240:241], v88, s[12:15], s66 offen sc1
  s_mov_b64 exec, -1
  v_exp_f32 v124, v124
  v_exp_f32 v125, v125
  s_mov_b64 exec, s[60:61]
  v_cvt_pk_bf16_f32 v220, v120, v121
  v_cvt_pk_bf16_f32 v221, v122, v123
  v_cvt_pk_bf16_f32 v224, v124, v125
  s_mov_b64 exec, s[62:63]
  v_cvt_pk_bf16_f32 v222, v120, v121
  v_cvt_pk_bf16_f32 v223, v122, v123
  v_cvt_pk_bf16_f32 v225, v124, v125
  s_mov_b64 exec, -1
  v_pk_add_f32 v[126:127], v[120:121], v[122:123]
  v_add_f32 v128, v124, v125
  v_mfma_f32_16x16x32_bf16 v[200:203], v[176:179], v[220:223], 0
  v_add_f32 v236, v126, v127
  v_fmac_f32 v236, v128, v89
  v_cvt_pk_bf16_f32 v228, v188, v189
  v_cvt_pk_bf16_f32 v229, v190, v191
  v_mfma_f32_16x16x32_bf16 v[204:207], v[180:183], v[220:223], 0
  v_cvt_pk_bf16_f32 v230, v192, v193
  v_cvt_pk_bf16_f32 v231, v194, v195
  v_mfma_f32_16x16x32_bf16 v[208:211], v[184:187], v[220:223], 0
  v_cvt_pk_bf16_f32 v232, v196, v197
  v_cvt_pk_bf16_f32 v233, v198, v199
  v_add_f32_dpp v236, v236, v236 row_ror:8 row_mask:0xf bank_mask:0xf
  v_mov_b32 v237, v236
  s_nop 0
  v_mfma_f32_16x16x32_bf16 v[200:203], v[228:231], v[224:227], v[200:203]
  v_mfma_f32_16x16x32_bf16 v[204:207], v[230:233], v[224:227], v[204:207]
  v_permlane32_swap_b32 v236, v237
  v_add_f32 v236, v236, v237
  v_mov_b32 v237, v236
  v_mfma_f32_16x16x32_bf16 v[208:211], v[232:235], v[224:227], v[208:211]
  s_nop 0
  v_permlane16_swap_b32 v236, v237
  v_add_f32 v236, v236, v237
  v_rcp_f32 v236, v236
  s_nop 2
  v_pk_mul_f32 v[200:201], v[200:201], v[236:237] op_sel_hi:[1,0]
  v_pk_mul_f32 v[202:203], v[202:203], v[236:237] op_sel_hi:[1,0]
  ds_write_b128 v11, v[200:203] offset:0
  v_pk_mul_f32 v[204:205], v[204:205], v[236:237] op_sel_hi:[1,0]
  v_pk_mul_f32 v[206:207], v[206:207], v[236:237] op_sel_hi:[1,0]
  ds_write_b128 v11, v[204:207] offset:1024
  v_pk_mul_f32 v[208:209], v[208:209], v[236:237] op_sel_hi:[1,0]
  v_pk_mul_f32 v[210:211], v[210:211], v[236:237] op_sel_hi:[1,0]
  ds_write_b128 v11, v[208:211] offset:2048
  s_waitcnt lgkmcnt(0)
  s_barrier
  v_mov_b32 v28, -1
  v_mov_b32 v29, -1
  buffer_store_dwordx2 v[28:29], v24, s[8:11], s82 offen
  s_mov_b64 exec, s[60:61]
  s_add_u32 s22, s82, 278528
  buffer_store_dwordx2 v[28:29], v23, s[8:11], s22 offen
  s_and_b32 s21, s52, 7
  s_cmp_lg_u32 s21, s50
  s_cbranch_scc1 zm_84
  s_mov_b64 exec, s[70:71]
  buffer_store_dwordx4 v[156:159], v13, s[4:7], s83 offen sc1
zm_84:
  s_mov_b64 exec, -1
  v_mov_b32 v200, v196
  v_mov_b32 v201, v197
  v_mov_b32 v202, v198
  v_mov_b32 v203, v199
  v_permlane32_swap_b32 v188, v192
  v_permlane32_swap_b32 v189, v193
  v_permlane32_swap_b32 v190, v194
  v_permlane32_swap_b32 v191, v195
  v_permlane32_swap_b32 v196, v200
  v_permlane32_swap_b32 v197, v201
  v_permlane32_swap_b32 v198, v202
  v_permlane32_swap_b32 v199, v203
  v_pk_add_f32 v[188:189], v[188:189], v[192:193]
  v_pk_add_f32 v[190:191], v[190:191], v[194:195]
  v_pk_add_f32 v[196:197], v[196:197], v[200:201]
  v_pk_add_f32 v[198:199], v[198:199], v[202:203]
  v_cvt_pk_bf16_f32 v252, v188, v189
  v_cvt_pk_bf16_f32 v254, v196, v197
  v_cvt_pk_bf16_f32 v253, v190, v191
  v_cvt_pk_bf16_f32 v255, v198, v199
  s_nop 0
  v_permlane16_swap_b32 v252, v254
  v_permlane16_swap_b32 v253, v255
  v_min_u32 v252, -2, v252
  s_mov_b64 exec, s[76:77]
  buffer_store_dwordx4 v[252:255], v15, s[24:27], s57 offen sc1
  s_mov_b64 exec, -1
  s_add_u32 s64, s64, 1310720
  s_add_u32 s52, s52, 1
  s_and_b32 s21, s52, 3
  s_mul_i32 s81, s21, 540672
  s_lshl_b32 s84, s21, 15
  s_branch step_72
fl_76:
  buffer_load_dword v94, v95, s[12:15], s79 offen sc1
  s_branch fl_77
pm_74:
  s_cmp_gt_u32 s52, 3
  s_cbranch_scc1 op_85
  v_readfirstlane_b32 s21, v94
  s_cmp_ge_u32 s21, s46
  s_cbranch_scc1 op_85
  buffer_load_dword v94, v95, s[12:15], s79 offen sc1
  s_waitcnt vmcnt(0)
  v_readfirstlane_b32 s21, v94
  s_add_u32 s22, s46, 2
  s_min_u32 s22, s22, 64
  s_sub_u32 s55, s21, s22
  s_sub_u32 s56, s21, s46
  s_cmp_gt_u32 s21, s52
  s_cselect_b32 s21, s87, 0
  s_cmp_eq_u32 s21, 0
  s_cbranch_scc1 op_85
  s_mov_b32 s87, 0
  s_sub_u32 s21, s64, 1310720
  buffer_load_dwordx4 v[176:179], v16, s[28:31], s21 offen offset:0 sc1
  buffer_load_dwordx4 v[180:183], v16, s[28:31], s21 offen offset:1024 sc1
  buffer_load_dwordx4 v[184:187], v16, s[28:31], s21 offen offset:2048 sc1
op_85:
  buffer_load_dwordx4 v[32:35], v4, s[4:7], s84 offen offset:0 sc1
  buffer_load_dwordx4 v[36:39], v4, s[4:7], s84 offen offset:1024 sc1
  buffer_load_dwordx4 v[40:43], v4, s[4:7], s84 offen offset:2048 sc1
  s_add_u32 s54, s54, 1
  s_cmp_gt_u32 s54, 131072
  s_cbranch_scc1 end0
  s_waitcnt vmcnt(0)
  v_bitop3_b32 v27, v35, v39, v43 bitop3:0x80
  v_perm_b32 v35, v39, v35, s89
  v_cmp_gt_u32 vcc, 0x48000000, v27
  v_mov_b32 v39, v42
  s_cbranch_vccnz pm_74
  s_branch A1_18
pv_78:
  buffer_load_dwordx4 v[144:147], v10, s[8:11], s81 offen offset:0 sc1
  buffer_load_dwordx4 v[148:151], v10, s[8:11], s81 offen offset:1024 sc1
  buffer_load_dwordx4 v[152:155], v10, s[8:11], s81 offen offset:2048 sc1
  s_add_u32 s54, s54, 1
  s_cmp_gt_u32 s54, 131072
  s_cbranch_scc1 end0
  s_waitcnt vmcnt(0)
  v_max3_u32 v27, v144, v146, v148
  v_max3_u32 v27, v27, v150, v152
  v_max3_u32 v27, v27, v154, v154
  v_cmp_eq_u32 vcc, -1, v27
  s_nop 1
  s_cbranch_vccnz pv_78
  s_branch pvj_81
psr_79:
  s_cmp_gt_u32 s52, 3
  s_cbranch_scc1 op_86
  v_readfirstlane_b32 s21, v94
  s_cmp_ge_u32 s21, s46
  s_cbranch_scc1 op_86
  buffer_load_dword v94, v95, s[12:15], s79 offen sc1
  s_waitcnt vmcnt(0)
  v_readfirstlane_b32 s21, v94
  s_add_u32 s22, s46, 2
  s_min_u32 s22, s22, 64
  s_sub_u32 s55, s21, s22
  s_sub_u32 s56, s21, s46
  s_cmp_gt_u32 s21, s52
  s_cselect_b32 s21, s87, 0
  s_cmp_eq_u32 s21, 0
  s_cbranch_scc1 op_86
  s_mov_b32 s87, 0
  s_sub_u32 s21, s64, 1310720
  buffer_load_dwordx4 v[176:179], v16, s[28:31], s21 offen offset:0 sc1
  buffer_load_dwordx4 v[180:183], v16, s[28:31], s21 offen offset:1024 sc1
  buffer_load_dwordx4 v[184:187], v16, s[28:31], s21 offen offset:2048 sc1
op_86:
  buffer_load_dwordx2 v[248:249], v9, s[8:11], s81 offen sc1
  buffer_load_dwordx4 v[112:115], v8, s[8:11], s81 offen offset:0 sc1
  buffer_load_dwordx4 v[116:119], v8, s[8:11], s81 offen offset:1024 sc1
  s_add_u32 s54, s54, 1
  s_cmp_gt_u32 s54, 131072
  s_cbranch_scc1 end0
  s_waitcnt vmcnt(2)
  v_xor_b32 v96, s88, v248
  s_nop 0
  v_permlane16_swap_b32 v248, v249
  v_fma_mix_f32 v250, v248, 1.0, v249 op_sel:[0,0,0] op_sel_hi:[1,0,1]
  v_fma_mix_f32 v251, v248, 1.0, v249 op_sel:[1,0,1] op_sel_hi:[1,0,1]
  v_mov_b32 v248, v250
  v_mov_b32 v249, v251
  s_nop 0
  v_permlane32_swap_b32 v248, v250
  v_permlane32_swap_b32 v249, v251
  s_waitcnt vmcnt(0)
  v_bitop3_b32 v97, v112, v114, s88 bitop3:0x7e
  v_bitop3_b32 v98, v116, v118, s88 bitop3:0x7e
  v_fma_mix_f32 v120, v112, 1.0, v116 op_sel:[0,0,0] op_sel_hi:[1,0,1]
  v_or3_b32 v27, v96, v97, v98
  v_fma_mix_f32 v124, v114, 1.0, v118 op_sel:[0,0,0] op_sel_hi:[1,0,1]
  v_and_b32 v27, 1, v27
  v_fma_mix_f32 v121, v112, 1.0, v116 op_sel:[1,0,1] op_sel_hi:[1,0,1]
  v_cmp_ne_u32 vcc, 0, v27
  v_fma_mix_f32 v125, v114, 1.0, v118 op_sel:[1,0,1] op_sel_hi:[1,0,1]
  v_fma_mix_f32 v122, v113, 1.0, v117 op_sel:[0,0,0] op_sel_hi:[1,0,1]
  v_fma_mix_f32 v126, v115, 1.0, v119 op_sel:[0,0,0] op_sel_hi:[1,0,1]
  s_cbranch_vccnz psr_79
  s_branch psj_80
kvw_82:
  s_mov_b32 s22, s87
  s_cmp_eq_u32 s52, 0
  s_cselect_b32 s23, s87, s46
  s_cselect_b32 s55, 0, s55
  s_cselect_b32 s87, 1, 0
  s_cmp_eq_u32 s23, 0
  s_cbranch_scc1 kvok_83
  v_mov_b32 v236, 0
  s_mov_b32 s101, 0
wf_87:
  buffer_load_dword v237, v236, s[12:15], s79 offen sc1
  s_add_u32 s101, s101, 1
  s_cmp_gt_u32 s101, 131072
  s_cbranch_scc1 end0
  s_waitcnt vmcnt(0)
  v_readfirstlane_b32 s100, v237
  s_cmp_ge_u32 s100, s23
  s_cbranch_scc1 wf_88
  s_sleep 3
  s_branch wf_87
wf_88:
  s_cmp_eq_u32 s22, 0
  s_cbranch_scc1 kvok_83
  s_sub_u32 s21, s64, 1310720
  buffer_load_dwordx4 v[176:179], v16, s[28:31], s21 offen offset:0 sc1
  buffer_load_dwordx4 v[180:183], v16, s[28:31], s21 offen offset:1024 sc1
  buffer_load_dwordx4 v[184:187], v16, s[28:31], s21 offen offset:2048 sc1
  s_waitcnt vmcnt(0)
  s_branch kvok_83
last_73:
  v_mov_b32 v188, 0
  v_mov_b32 v189, 0
  v_mov_b32 v190, 0
  v_mov_b32 v191, 0
  v_mov_b32 v192, 0
  v_mov_b32 v193, 0
  v_mov_b32 v194, 0
  v_mov_b32 v195, 0
  v_mov_b32 v196, 0
  v_mov_b32 v197, 0
  v_mov_b32 v198, 0
  v_mov_b32 v199, 0
  s_sleep 4
  s_mov_b32 s54, 0
lv_89:
  buffer_load_dwordx4 v[144:147], v10, s[8:11], s81 offen offset:0 sc1
  buffer_load_dwordx4 v[148:151], v10, s[8:11], s81 offen offset:1024 sc1
  buffer_load_dwordx4 v[152:155], v10, s[8:11], s81 offen offset:2048 sc1
  s_add_u32 s54, s54, 1
  s_cmp_gt_u32 s54, 131072
  s_cbranch_scc1 end0
  s_waitcnt vmcnt(0)
  v_max3_u32 v27, v144, v146, v148
  v_max3_u32 v27, v27, v150, v152
  v_max3_u32 v27, v27, v154, v154
  v_cmp_eq_u32 vcc, -1, v27
  s_nop 1
  s_cbranch_vccnz lv_89
  v_smfmac_f32_16x16x64_bf16 v[188:191], v[144:147], a[180:187], v44
  v_smfmac_f32_16x16x64_bf16 v[192:195], v[144:147], a[204:211], v44
  v_smfmac_f32_16x16x64_bf16 v[196:199], v[144:147], a[228:235], v44
  v_smfmac_f32_16x16x64_bf16 v[188:191], v[148:151], a[188:195], v44
  v_smfmac_f32_16x16x64_bf16 v[192:195], v[148:151], a[212:219], v44
  v_smfmac_f32_16x16x64_bf16 v[196:199], v[148:151], a[236:243], v44
  v_smfmac_f32_16x16x64_bf16 v[188:191], v[152:155], a[196:203], v44
  v_smfmac_f32_16x16x64_bf16 v[192:195], v[152:155], a[220:227], v44
  v_smfmac_f32_16x16x64_bf16 v[196:199], v[152:155], a[244:251], v44
  s_nop 7
  v_mov_b32 v200, v196
  v_mov_b32 v201, v197
  v_mov_b32 v202, v198
  v_mov_b32 v203, v199
  v_permlane32_swap_b32 v188, v192
  v_permlane32_swap_b32 v189, v193
  v_permlane32_swap_b32 v190, v194
  v_permlane32_swap_b32 v191, v195
  v_permlane32_swap_b32 v196, v200
  v_permlane32_swap_b32 v197, v201
  v_permlane32_swap_b32 v198, v202
  v_permlane32_swap_b32 v199, v203
  v_pk_add_f32 v[188:189], v[188:189], v[192:193]
  v_pk_add_f32 v[190:191], v[190:191], v[194:195]
  v_pk_add_f32 v[196:197], v[196:197], v[200:201]
  v_pk_add_f32 v[198:199], v[198:199], v[202:203]
  v_cvt_pk_bf16_f32 v252, v188, v189
  v_cvt_pk_bf16_f32 v254, v196, v197
  v_cvt_pk_bf16_f32 v253, v190, v191
  v_cvt_pk_bf16_f32 v255, v198, v199
  s_nop 0
  v_permlane16_swap_b32 v252, v254
  v_permlane16_swap_b32 v253, v255
  v_min_u32 v252, -2, v252
  s_mov_b64 exec, s[76:77]
  buffer_store_dwordx4 v[252:255], v15, s[24:27], s57 offen sc1
  s_mov_b64 exec, -1
  s_branch chain_done
step_90:
  s_add_u32 s21, s52, 2
  s_and_b32 s21, s21, 3
  s_mul_i32 s82, s21, 540672
  s_add_u32 s21, s52, 3
  s_and_b32 s21, s21, 3
  s_lshl_b32 s83, s21, 15
  s_add_u32 s21, s52, 1
  s_and_b32 s22, s21, 3
  s_lshl_b32 s3, s22, 15
  s_mul_i32 s80, s21, 393216
  s_add_u32 s46, s21, 1
  s_min_u32 s46, s46, 64
  s_mul_i32 s85, s52, 98304
  s_mul_i32 s57, s52, 327680
  s_add_u32 s57, s57, 42991616

  s_bfe_u32 s88, s52, 0x10002
  s_add_u32 s78, s81, 278528
  s_max_u32 s21, s52, 1
  s_sub_u32 s21, s21, 1
  s_cmp_lt_u32 s52, 60
  s_cselect_b32 s66, s65, 0x80000000
  s_cselect_b32 s68, 15, 1
  s_cmp_ge_u32 s52, 61
  s_cselect_b32 s66, s90, s66
  s_cselect_b32 s67, s52, s21
  v_mov_b32 v52, 0
  v_mov_b32 v53, 0
  v_mov_b32 v54, 0
  v_mov_b32 v55, 0
  v_mov_b32 v56, 0
  v_mov_b32 v57, 0
  v_mov_b32 v58, 0
  v_mov_b32 v59, 0
  v_mov_b32 v60, 0
  v_mov_b32 v61, 0
  v_mov_b32 v62, 0
  v_mov_b32 v63, 0
  v_mov_b32 v64, 0
  v_mov_b32 v65, 0
  v_mov_b32 v66, 0
  v_mov_b32 v67, 0
  v_mov_b32 v68, 0
  v_mov_b32 v69, 0
  v_mov_b32 v70, 0
  v_mov_b32 v71, 0
  v_mov_b32 v72, 0
  v_mov_b32 v73, 0
  v_mov_b32 v74, 0
  v_mov_b32 v75, 0
  v_mov_b32 v76, 0
  v_mov_b32 v77, 0
  v_mov_b32 v78, 0
  v_mov_b32 v79, 0
  v_mov_b32 v80, 0
  v_mov_b32 v81, 0
  v_mov_b32 v82, 0
  v_mov_b32 v83, 0
  v_mov_b32 v84, 0
  v_mov_b32 v85, 0
  v_mov_b32 v86, 0
  v_mov_b32 v87, 0
  s_sleep 8
  s_cmp_lt_i32 s55, 0
  s_cbranch_scc1 fl_94
fl_95:
  s_mov_b32 s54, 0
  buffer_load_dwordx4 v[32:35], v4, s[4:7], s84 offen offset:0 sc1
  buffer_load_dwordx4 v[36:39], v4, s[4:7], s84 offen offset:1024 sc1
  buffer_load_dwordx4 v[40:43], v4, s[4:7], s84 offen offset:2048 sc1
  s_waitcnt vmcnt(3)
  v_mov_b32 v176, v160
  v_mov_b32 v177, v161
  v_mov_b32 v178, v162
  v_mov_b32 v179, v163
  v_mov_b32 v180, v164
  v_mov_b32 v181, v165
  v_mov_b32 v182, v166
  v_mov_b32 v183, v167
  v_mov_b32 v184, v48
  v_mov_b32 v185, v49
  v_mov_b32 v186, v50
  v_mov_b32 v187, v51
  s_waitcnt vmcnt(0)
  v_bitop3_b32 v27, v35, v39, v43 bitop3:0x80
  v_perm_b32 v35, v39, v35, s89
  v_cmp_gt_u32 vcc, 0x48000000, v27
  v_mov_b32 v39, v42
  s_cbranch_vccnz pm_92
A1_19:
  v_smfmac_f32_16x16x32_f16 v[52:55], v[40:41], a[16:19], v44
  v_smfmac_f32_16x16x32_f16 v[64:67], v[40:41], a[76:79], v44
  v_smfmac_f32_16x16x32_f16 v[56:59], v[40:41], a[36:39], v44
  v_smfmac_f32_16x16x64_f16 v[52:55], v[32:35], a[0:7], v44
  v_smfmac_f32_16x16x64_f16 v[52:55], v[36:39], a[8:15], v44
  v_smfmac_f32_16x16x32_f16 v[68:71], v[40:41], a[96:99], v44
  v_smfmac_f32_16x16x64_f16 v[64:67], v[32:35], a[60:67], v44
  v_smfmac_f32_16x16x64_f16 v[64:67], v[36:39], a[68:75], v44
  v_smfmac_f32_16x16x32_f16 v[60:63], v[40:41], a[56:59], v44
  v_smfmac_f32_16x16x64_f16 v[56:59], v[32:35], a[20:27], v44
  v_smfmac_f32_16x16x64_f16 v[56:59], v[36:39], a[28:35], v44
  v_permlane32_swap_b32 v52, v64
  v_smfmac_f32_16x16x32_f16 v[72:75], v[40:41], a[116:119], v44
  v_permlane32_swap_b32 v53, v65
  v_add_f32 v52, v52, v64
  v_add_f32 v53, v53, v65
  v_smfmac_f32_16x16x64_f16 v[68:71], v[32:35], a[80:87], v44
  ds_write2_b32 v5, v52, v53 offset0:0 offset1:4
  v_smfmac_f32_16x16x64_f16 v[68:71], v[36:39], a[88:95], v44
  v_permlane32_swap_b32 v54, v66
  v_smfmac_f32_16x16x32_f16 v[76:79], v[40:41], a[136:139], v44
  v_permlane32_swap_b32 v55, v67
  v_add_f32 v54, v54, v66
  v_add_f32 v55, v55, v67
  v_smfmac_f32_16x16x64_f16 v[60:63], v[32:35], a[40:47], v44
  ds_write2_b32 v5, v54, v55 offset0:8 offset1:12
  v_smfmac_f32_16x16x64_f16 v[60:63], v[36:39], a[48:55], v44
  v_permlane32_swap_b32 v56, v68
  v_smfmac_f32_16x16x32_f16 v[80:83], v[40:41], a[156:159], v44
  v_permlane32_swap_b32 v57, v69
  v_add_f32 v56, v56, v68
  v_add_f32 v57, v57, v69
  v_smfmac_f32_16x16x64_f16 v[72:75], v[32:35], a[100:107], v44
  ds_write2_b32 v242, v56, v57 offset0:0 offset1:4
  v_smfmac_f32_16x16x64_f16 v[72:75], v[36:39], a[108:115], v44
  v_permlane32_swap_b32 v58, v70
  v_smfmac_f32_16x16x32_f16 v[84:87], v[40:41], a[176:179], v44
  v_permlane32_swap_b32 v59, v71
  v_add_f32 v58, v58, v70
  v_add_f32 v59, v59, v71
  v_smfmac_f32_16x16x64_f16 v[76:79], v[32:35], a[120:127], v44
  ds_write2_b32 v242, v58, v59 offset0:8 offset1:12
  v_smfmac_f32_16x16x64_f16 v[76:79], v[36:39], a[128:135], v44
  v_permlane32_swap_b32 v60, v72
  v_smfmac_f32_16x16x64_f16 v[80:83], v[32:35], a[140:147], v44
  v_permlane32_swap_b32 v61, v73
  v_add_f32 v60, v60, v72
  v_smfmac_f32_16x16x64_f16 v[80:83], v[36:39], a[148:155], v44
  v_add_f32 v61, v61, v73
  ds_write2_b32 v243, v60, v61 offset0:0 offset1:4
  v_smfmac_f32_16x16x64_f16 v[84:87], v[32:35], a[160:167], v44
  v_permlane32_swap_b32 v62, v74
  v_smfmac_f32_16x16x64_f16 v[84:87], v[36:39], a[168:175], v44
  v_permlane32_swap_b32 v63, v75
  v_add_f32 v62, v62, v74
  v_add_f32 v63, v63, v75
  ds_write2_b32 v243, v62, v63 offset0:8 offset1:12
  v_permlane32_swap_b32 v76, v80
  v_permlane32_swap_b32 v77, v81
  v_add_f32 v76, v76, v80
  v_add_f32 v77, v77, v81
  ds_write2_b32 v244, v76, v77 offset0:0 offset1:4
  v_permlane32_swap_b32 v78, v82
  v_permlane32_swap_b32 v79, v83
  v_add_f32 v78, v78, v82
  v_add_f32 v79, v79, v83
  ds_write2_b32 v244, v78, v79 offset0:8 offset1:12
  ds_write2_b32 v245, v84, v85 offset0:0 offset1:4
  ds_write2_b32 v245, v86, v87 offset0:8 offset1:12
  s_waitcnt lgkmcnt(0) vmcnt(0)
  s_barrier
  s_lshr_b32 s21, 3, s20
  s_bitcmp1_b32 s21, 0
  s_cbranch_scc0 bw_97
  ds_read_b128 v[96:99], v45 offset:0
  ds_read_b128 v[108:111], v45 offset:5440
  ds_read_b128 v[100:103], v45 offset:1088
  ds_read_b128 v[112:115], v45 offset:6528
  ds_read_b128 v[104:107], v45 offset:2176
  ds_read_b128 v[116:119], v45 offset:7616
  s_waitcnt lgkmcnt(4)
  v_pk_add_f32 v[96:97], v[96:97], v[108:109]
  v_pk_add_f32 v[98:99], v[98:99], v[110:111]
  s_nop 0
  v_add_f32_dpp v108, v96, v96 row_ror:8 row_mask:0xf bank_mask:0xf
  v_add_f32_dpp v109, v97, v97 row_ror:8 row_mask:0xf bank_mask:0xf
  v_add_f32_dpp v110, v98, v98 row_ror:8 row_mask:0xf bank_mask:0xf
  v_add_f32_dpp v111, v99, v99 row_ror:8 row_mask:0xf bank_mask:0xf
  v_cvt_pk_bf16_f32 v212, v108, v109
  v_cvt_pk_bf16_f32 v213, v110, v111
  s_waitcnt lgkmcnt(2)
  v_pk_add_f32 v[100:101], v[100:101], v[112:113]
  v_pk_add_f32 v[102:103], v[102:103], v[114:115]
  s_nop 0
  v_add_f32_dpp v112, v100, v100 row_ror:8 row_mask:0xf bank_mask:0xf
  v_add_f32_dpp v113, v101, v101 row_ror:8 row_mask:0xf bank_mask:0xf
  v_add_f32_dpp v114, v102, v102 row_ror:8 row_mask:0xf bank_mask:0xf
  v_add_f32_dpp v115, v103, v103 row_ror:8 row_mask:0xf bank_mask:0xf
  v_cvt_pk_bf16_f32 v214, v112, v113
  v_cvt_pk_bf16_f32 v215, v114, v115
  s_waitcnt lgkmcnt(0)
  v_pk_add_f32 v[104:105], v[104:105], v[116:117]
  v_pk_add_f32 v[106:107], v[106:107], v[118:119]
  v_mfma_f32_16x16x32_bf16 v[96:99], v[168:171], v[212:215], 0
  v_add_f32_dpp v116, v104, v104 row_ror:8 row_mask:0xf bank_mask:0xf
  v_add_f32_dpp v117, v105, v105 row_ror:8 row_mask:0xf bank_mask:0xf
  v_add_f32_dpp v118, v106, v106 row_ror:8 row_mask:0xf bank_mask:0xf
  v_add_f32_dpp v119, v107, v107 row_ror:8 row_mask:0xf bank_mask:0xf
  v_cvt_pk_bf16_f32 v216, v116, v117
  v_cvt_pk_bf16_f32 v217, v118, v119
  s_nop 1
  v_mfma_f32_16x16x32_bf16 v[96:99], v[172:175], v[216:219], v[96:99]
  s_mov_b64 exec, s[74:75]
  s_nop 6
  v_cvt_pk_f16_f32 v100, v96, v97
  v_cvt_pk_f16_f32 v101, v98, v99
  v_and_or_b32 v100, v100, -2, s88
  s_cmp_eq_u32 s53, 1
  s_cbranch_scc1 si_98
  buffer_store_dwordx2 v[100:101], v7, s[8:11], s81 offen sc1
  s_branch si_99
si_98:
  buffer_store_dwordx2 v[100:101], v7, s[8:11], s81 offen
si_99:
  s_mov_b64 exec, -1
  s_branch bw_96
bw_97:
  s_lshr_b32 s21, 4, s20
  s_bitcmp1_b32 s21, 0
  s_cbranch_scc0 bw_100
  ds_read_b128 v[96:99], v6 offset:0
  ds_read_b128 v[108:111], v6 offset:5440
  ds_read_b128 v[120:123], v6 offset:10880
  ds_read_b128 v[132:135], v6 offset:16320
  ds_read_b128 v[100:103], v6 offset:1088
  ds_read_b128 v[112:115], v6 offset:6528
  ds_read_b128 v[124:127], v6 offset:11968
  ds_read_b128 v[136:139], v6 offset:17408
  ds_read_b128 v[104:107], v6 offset:2176
  ds_read_b128 v[116:119], v6 offset:7616
  ds_read_b128 v[128:131], v6 offset:13056
  ds_read_b128 v[140:143], v6 offset:18496
  s_waitcnt lgkmcnt(8)
  v_pk_add_f32 v[96:97], v[96:97], v[108:109]
  v_pk_add_f32 v[120:121], v[120:121], v[132:133]
  v_pk_add_f32 v[98:99], v[98:99], v[110:111]
  v_pk_add_f32 v[122:123], v[122:123], v[134:135]
  v_pk_add_f32 v[96:97], v[96:97], v[120:121]
  v_pk_add_f32 v[98:99], v[98:99], v[122:123]
  v_cvt_pk_bf16_f32 v212, v96, v97
  v_cvt_pk_bf16_f32 v213, v98, v99
  s_waitcnt lgkmcnt(4)
  v_pk_add_f32 v[100:101], v[100:101], v[112:113]
  v_pk_add_f32 v[124:125], v[124:125], v[136:137]
  v_pk_add_f32 v[102:103], v[102:103], v[114:115]
  v_pk_add_f32 v[126:127], v[126:127], v[138:139]
  v_pk_add_f32 v[100:101], v[100:101], v[124:125]
  v_pk_add_f32 v[102:103], v[102:103], v[126:127]
  v_cvt_pk_bf16_f32 v214, v100, v101
  v_cvt_pk_bf16_f32 v215, v102, v103
  s_waitcnt lgkmcnt(0)
  v_pk_add_f32 v[104:105], v[104:105], v[116:117]
  v_pk_add_f32 v[128:129], v[128:129], v[140:141]
  v_pk_add_f32 v[106:107], v[106:107], v[118:119]
  v_pk_add_f32 v[130:131], v[130:131], v[142:143]
  v_mfma_f32_16x16x32_bf16 v[96:99], v[212:215], v[212:215], 0
  v_pk_add_f32 v[104:105], v[104:105], v[128:129]
  v_pk_add_f32 v[106:107], v[106:107], v[130:131]
  v_cvt_pk_bf16_f32 v216, v104, v105
  v_cvt_pk_bf16_f32 v217, v106, v107
  s_nop 1
  v_mfma_f32_16x16x32_bf16 v[96:99], v[216:219], v[216:219], v[96:99]
  s_mov_b64 exec, s[74:75]
  s_nop 6
  v_cvt_pk_f16_f32 v100, v96, v97
  v_cvt_pk_f16_f32 v101, v98, v99
  v_and_or_b32 v100, v100, -2, s88
  s_cmp_eq_u32 s53, 1
  s_cbranch_scc1 si_101
  buffer_store_dwordx2 v[100:101], v7, s[8:11], s81 offen sc1
  s_branch si_102
si_101:
  buffer_store_dwordx2 v[100:101], v7, s[8:11], s81 offen
si_102:
  s_mov_b64 exec, -1
  s_branch bw_96
bw_100:
  s_lshr_b32 s21, 8, s20
  s_bitcmp1_b32 s21, 0
  s_cbranch_scc0 bw_103
  ds_read_b128 v[96:99], v6 offset:3264
  ds_read_b128 v[100:103], v6 offset:8704
  ds_read_b128 v[104:107], v6 offset:14144
  ds_read_b128 v[108:111], v6 offset:19584
  ds_read_b128 v[112:115], v6 offset:4352
  ds_read_b128 v[116:119], v6 offset:9792
  ds_read_b128 v[120:123], v6 offset:15232
  ds_read_b128 v[124:127], v6 offset:20672
  s_waitcnt lgkmcnt(4)
  v_pk_add_f32 v[96:97], v[96:97], v[100:101]
  v_pk_add_f32 v[98:99], v[98:99], v[102:103]
  v_pk_add_f32 v[104:105], v[104:105], v[108:109]
  v_pk_add_f32 v[106:107], v[106:107], v[110:111]
  v_pk_add_f32 v[96:97], v[96:97], v[104:105]
  v_pk_add_f32 v[98:99], v[98:99], v[106:107]
  v_cvt_pk_bf16_f32 v90, v96, v97
  v_cvt_pk_bf16_f32 v91, v98, v99
  v_min_u32 v90, -2, v90
  v_min_u32 v91, -2, v91
  s_cmp_eq_u32 s53, 1
  s_cbranch_scc1 si_104
  buffer_store_dwordx2 v[90:91], v24, s[8:11], s81 offen sc1
  s_branch si_105
si_104:
  buffer_store_dwordx2 v[90:91], v24, s[8:11], s81 offen
si_105:
  s_waitcnt lgkmcnt(0)
  v_pk_add_f32 v[112:113], v[112:113], v[116:117]
  v_pk_add_f32 v[114:115], v[114:115], v[118:119]
  v_pk_add_f32 v[120:121], v[120:121], v[124:125]
  v_pk_add_f32 v[122:123], v[122:123], v[126:127]
  v_pk_add_f32 v[112:113], v[112:113], v[120:121]
  v_pk_add_f32 v[114:115], v[114:115], v[122:123]
  s_nop 1
  v_add_f32_dpp v116, v112, v112 row_ror:8 row_mask:0xf bank_mask:0xf
  v_add_f32_dpp v117, v113, v113 row_ror:8 row_mask:0xf bank_mask:0xf
  v_add_f32_dpp v118, v114, v114 row_ror:8 row_mask:0xf bank_mask:0xf
  v_add_f32_dpp v119, v115, v115 row_ror:8 row_mask:0xf bank_mask:0xf
  v_cvt_pk_bf16_f32 v92, v116, v117
  v_cvt_pk_bf16_f32 v93, v118, v119
  v_min_u32 v92, -2, v92
  v_min_u32 v93, -2, v93
  s_mov_b64 exec, s[60:61]
  s_cmp_eq_u32 s53, 1
  s_cbranch_scc1 si_106
  buffer_store_dwordx2 v[92:93], v23, s[8:11], s78 offen sc1
  s_branch si_107
si_106:
  buffer_store_dwordx2 v[92:93], v23, s[8:11], s78 offen
si_107:
  s_mov_b64 exec, -1
  s_branch bw_96
bw_103:
bw_96:
  s_cmp_eq_u32 s52, 63
  s_cbranch_scc1 last_91
  s_mov_b32 s54, 0
pv_108:
  buffer_load_dwordx4 v[144:147], v10, s[8:11], s81 offen offset:0 sc1
  buffer_load_dwordx4 v[148:151], v10, s[8:11], s81 offen offset:1024 sc1
  buffer_load_dwordx4 v[152:155], v10, s[8:11], s81 offen offset:2048 sc1
  v_mov_b32 v188, 0
  v_mov_b32 v189, 0
  v_mov_b32 v190, 0
  v_mov_b32 v191, 0
  v_mov_b32 v192, 0
  v_mov_b32 v193, 0
  v_mov_b32 v194, 0
  v_mov_b32 v195, 0
  v_mov_b32 v196, 0
  v_mov_b32 v197, 0
  v_mov_b32 v198, 0
  v_mov_b32 v199, 0
  s_add_u32 s54, s54, 1
  s_cmp_gt_u32 s54, 131072
  s_cbranch_scc1 end0
  s_waitcnt vmcnt(0)
  v_max3_u32 v27, v144, v146, v148
  v_max3_u32 v27, v27, v150, v152
  v_max3_u32 v27, v27, v154, v154
  v_cmp_eq_u32 vcc, -1, v27
  s_nop 1
  s_cbranch_vccnz pv_108
  buffer_load_dwordx2 v[248:249], v9, s[8:11], s81 offen sc1
  buffer_load_dwordx4 v[112:115], v8, s[8:11], s81 offen offset:0 sc1
  buffer_load_dwordx4 v[116:119], v8, s[8:11], s81 offen offset:1024 sc1
  v_smfmac_f32_16x16x64_bf16 v[188:191], v[144:147], a[180:187], v44
  v_smfmac_f32_16x16x64_bf16 v[192:195], v[144:147], a[204:211], v44
  v_smfmac_f32_16x16x64_bf16 v[196:199], v[144:147], a[228:235], v44
  v_smfmac_f32_16x16x64_bf16 v[188:191], v[148:151], a[188:195], v44
  v_smfmac_f32_16x16x64_bf16 v[192:195], v[148:151], a[212:219], v44
  v_smfmac_f32_16x16x64_bf16 v[196:199], v[148:151], a[236:243], v44
  v_smfmac_f32_16x16x64_bf16 v[188:191], v[152:155], a[196:203], v44
  v_smfmac_f32_16x16x64_bf16 v[192:195], v[152:155], a[220:227], v44
  v_smfmac_f32_16x16x64_bf16 v[196:199], v[152:155], a[244:251], v44
  v_readfirstlane_b32 s21, v94
  s_add_u32 s22, s46, 2
  s_min_u32 s22, s22, 64
  s_sub_u32 s55, s21, s22
  s_sub_u32 s56, s21, s46
  s_waitcnt vmcnt(2)
  v_xor_b32 v96, s88, v248
  s_nop 0
  v_permlane16_swap_b32 v248, v249
  v_fma_mix_f32 v250, v248, 1.0, v249 op_sel:[0,0,0] op_sel_hi:[1,0,1]
  v_fma_mix_f32 v251, v248, 1.0, v249 op_sel:[1,0,1] op_sel_hi:[1,0,1]
  v_mov_b32 v248, v250
  v_mov_b32 v249, v251
  s_nop 0
  v_permlane32_swap_b32 v248, v250
  v_permlane32_swap_b32 v249, v251
  s_waitcnt vmcnt(0)
  v_bitop3_b32 v97, v112, v114, s88 bitop3:0x7e
  v_bitop3_b32 v98, v116, v118, s88 bitop3:0x7e
  v_fma_mix_f32 v120, v112, 1.0, v116 op_sel:[0,0,0] op_sel_hi:[1,0,1]
  v_or3_b32 v27, v96, v97, v98
  v_fma_mix_f32 v124, v114, 1.0, v118 op_sel:[0,0,0] op_sel_hi:[1,0,1]
  v_and_b32 v27, 1, v27
  v_fma_mix_f32 v121, v112, 1.0, v116 op_sel:[1,0,1] op_sel_hi:[1,0,1]
  v_cmp_ne_u32 vcc, 0, v27
  v_fma_mix_f32 v125, v114, 1.0, v118 op_sel:[1,0,1] op_sel_hi:[1,0,1]
  v_fma_mix_f32 v122, v113, 1.0, v117 op_sel:[0,0,0] op_sel_hi:[1,0,1]
  v_fma_mix_f32 v126, v115, 1.0, v119 op_sel:[0,0,0] op_sel_hi:[1,0,1]
  s_cbranch_vccnz psr_109
psj_110:
  s_cmp_lt_i32 s56, 0
  s_cbranch_scc1 kvw_111
kvok_112:
  buffer_load_dwordx4 v[160:163], v17, s[28:31], s64 offen offset:0 sc1
  v_fma_mix_f32 v123, v113, 1.0, v117 op_sel:[1,0,1] op_sel_hi:[1,0,1]
  buffer_load_dwordx4 v[164:167], v16, s[28:31], s64 offen offset:1024 sc1
  v_fma_mix_f32 v127, v115, 1.0, v119 op_sel:[1,0,1] op_sel_hi:[1,0,1]
  buffer_load_dwordx4 v[48:51], v26, s[28:31], s64 offen offset:2048 sc1
  v_permlane32_swap_b32 v120, v124
  v_permlane32_swap_b32 v121, v125
  v_permlane32_swap_b32 v122, v126
  s_lshr_b32 s21, 3, s20
  s_bitcmp1_b32 s21, 0
  s_cbranch_scc0 bw_114
  buffer_load_dwordx4 v[168:171], v18, s[16:19], s80 offen sc1
  s_branch bw_113
bw_114:
  s_lshr_b32 s21, 4, s20
  s_bitcmp1_b32 s21, 0
  s_cbranch_scc0 bw_115
  s_branch bw_113
bw_115:
  s_lshr_b32 s21, 8, s20
  s_bitcmp1_b32 s21, 0
  s_cbranch_scc0 bw_116
  s_branch bw_113
bw_116:
bw_113:
  v_permlane32_swap_b32 v123, v127
  v_pk_add_f32 v[120:121], v[120:121], v[124:125]
  v_pk_add_f32 v[122:123], v[122:123], v[126:127]
  s_lshr_b32 s21, 3, s20
  s_bitcmp1_b32 s21, 0
  s_cbranch_scc0 bw_118
  buffer_load_dwordx2 v[172:173], v20, s[16:19], s80 offen sc1
  s_branch bw_117
bw_118:
  s_lshr_b32 s21, 4, s20
  s_bitcmp1_b32 s21, 0
  s_cbranch_scc0 bw_119
  s_branch bw_117
bw_119:
  s_lshr_b32 s21, 8, s20
  s_bitcmp1_b32 s21, 0
  s_cbranch_scc0 bw_120
  s_branch bw_117
bw_120:
bw_117:
  v_pk_add_f32 v[124:125], v[248:249], v[250:251]
  v_max3_f32 v236, v120, v121, v122
  v_max3_f32 v237, v123, v124, v125
  s_lshr_b32 s21, 3, s20
  s_bitcmp1_b32 s21, 0
  s_cbranch_scc0 bw_122
  s_branch bw_121
bw_122:
  s_lshr_b32 s21, 4, s20
  s_bitcmp1_b32 s21, 0
  s_cbranch_scc0 bw_123
  s_branch bw_121
bw_123:
  s_lshr_b32 s21, 8, s20
  s_bitcmp1_b32 s21, 0
  s_cbranch_scc0 bw_124
  v_mov_b32 v240, s67
  v_mov_b32 v241, s67
  s_mov_b64 exec, s[68:69]
  buffer_store_dwordx2 v[240:241], v88, s[12:15], s66 offen sc1
  s_mov_b64 exec, -1
  s_branch bw_121
bw_124:
bw_121:
  v_max_f32 v236, v236, v237
  v_cvt_pk_bf16_f32 v228, v188, v189
  v_cvt_pk_bf16_f32 v229, v190, v191
  v_max_f32_dpp v236, v236, v236 row_ror:8 row_mask:0xf bank_mask:0xf
  v_mov_b32 v237, v236
  v_cvt_pk_bf16_f32 v230, v192, v193
  v_cvt_pk_bf16_f32 v231, v194, v195
  v_permlane32_swap_b32 v236, v237
  v_max_f32 v236, v236, v237
  v_mov_b32 v237, v236
  v_cvt_pk_bf16_f32 v232, v196, v197
  v_cvt_pk_bf16_f32 v233, v198, v199
  v_permlane16_swap_b32 v236, v237
  v_max_f32 v236, v236, v237
  v_mul_f32 v236, s86, v236
  v_fma_f32 v120, v120, s86, -v236
  v_fma_f32 v121, v121, s86, -v236
  v_fma_f32 v122, v122, s86, -v236
  v_fma_f32 v123, v123, s86, -v236
  v_fma_f32 v124, v124, s86, -v236
  v_fma_f32 v125, v125, s86, -v236
  v_exp_f32 v120, v120
  v_exp_f32 v121, v121
  v_exp_f32 v122, v122
  v_exp_f32 v123, v123
  v_exp_f32 v124, v124
  v_exp_f32 v125, v125
  s_mov_b64 exec, s[60:61]
  v_cvt_pk_bf16_f32 v220, v120, v121
  v_cvt_pk_bf16_f32 v221, v122, v123
  v_cvt_pk_bf16_f32 v224, v124, v125
  s_mov_b64 exec, s[62:63]
  v_cvt_pk_bf16_f32 v222, v120, v121
  v_cvt_pk_bf16_f32 v223, v122, v123
  v_cvt_pk_bf16_f32 v225, v124, v125
  s_mov_b64 exec, -1
  v_pk_add_f32 v[126:127], v[120:121], v[122:123]
  v_add_f32 v128, v124, v125
  v_mfma_f32_16x16x32_bf16 v[200:203], v[176:179], v[220:223], 0
  v_add_f32 v236, v126, v127
  v_fmac_f32 v236, v128, v89
  v_mfma_f32_16x16x32_bf16 v[204:207], v[180:183], v[220:223], 0
  v_mfma_f32_16x16x32_bf16 v[208:211], v[184:187], v[220:223], 0
  v_add_f32_dpp v236, v236, v236 row_ror:8 row_mask:0xf bank_mask:0xf
  v_mov_b32 v237, v236
  s_nop 0
  v_mfma_f32_16x16x32_bf16 v[200:203], v[228:231], v[224:227], v[200:203]
  v_mfma_f32_16x16x32_bf16 v[204:207], v[230:233], v[224:227], v[204:207]
  v_permlane32_swap_b32 v236, v237
  v_add_f32 v236, v236, v237
  v_mov_b32 v237, v236
  v_mfma_f32_16x16x32_bf16 v[208:211], v[232:235], v[224:227], v[208:211]
  s_nop 0
  v_permlane16_swap_b32 v236, v237
  v_add_f32 v236, v236, v237
  v_rcp_f32 v236, v236
  s_nop 2
  v_pk_mul_f32 v[200:201], v[200:201], v[236:237] op_sel_hi:[1,0]
  v_pk_mul_f32 v[202:203], v[202:203], v[236:237] op_sel_hi:[1,0]
  ds_write_b128 v11, v[200:203] offset:0
  v_pk_mul_f32 v[204:205], v[204:205], v[236:237] op_sel_hi:[1,0]
  v_pk_mul_f32 v[206:207], v[206:207], v[236:237] op_sel_hi:[1,0]
  ds_write_b128 v11, v[204:207] offset:1024
  v_pk_mul_f32 v[208:209], v[208:209], v[236:237] op_sel_hi:[1,0]
  v_pk_mul_f32 v[210:211], v[210:211], v[236:237] op_sel_hi:[1,0]
  ds_write_b128 v11, v[208:211] offset:2048
  s_waitcnt lgkmcnt(0)
  s_barrier
  s_lshr_b32 s21, 7, s20
  s_bitcmp1_b32 s21, 0
  s_cbranch_scc0 bw_126
  ds_read_b64 v[96:97], v12 offset:0
  ds_read_b64 v[98:99], v12 offset:128
  ds_read_b64 v[100:101], v12 offset:3072
  ds_read_b64 v[102:103], v12 offset:3200
  ds_read_b64 v[104:105], v12 offset:6144
  ds_read_b64 v[106:107], v12 offset:6272
  ds_read_b64 v[108:109], v12 offset:9216
  ds_read_b64 v[110:111], v12 offset:9344
  s_waitcnt lgkmcnt(6)
  v_pk_add_f32 v[96:97], v[96:97], v[98:99]
  s_waitcnt lgkmcnt(4)
  v_pk_add_f32 v[100:101], v[100:101], v[102:103]
  s_waitcnt lgkmcnt(2)
  v_pk_add_f32 v[104:105], v[104:105], v[106:107]
  v_pk_add_f32 v[96:97], v[96:97], v[100:101]
  s_waitcnt lgkmcnt(0)
  v_pk_add_f32 v[108:109], v[108:109], v[110:111]
  v_pk_add_f32 v[96:97], v[96:97], v[104:105]
  v_pk_add_f32 v[96:97], v[96:97], v[108:109]
  v_cvt_pk_f16_f32 v100, v96, v97
  v_perm_b32 v100, s91, v100, v14
  buffer_atomic_pk_add_f16 v100, v13, s[4:7], s3 offen
  s_branch bw_125
bw_126:
  s_lshr_b32 s21, 8, s20
  s_bitcmp1_b32 s21, 0
  s_cbranch_scc0 bw_127
  v_mov_b32 v28, -1
  v_mov_b32 v29, -1
  s_cmp_eq_u32 s53, 1
  s_cbranch_scc1 si_128
  buffer_store_dwordx2 v[28:29], v24, s[8:11], s82 offen sc1
  s_branch si_129
si_128:
  buffer_store_dwordx2 v[28:29], v24, s[8:11], s82 offen
si_129:
  s_mov_b64 exec, s[60:61]
  s_add_u32 s22, s82, 278528
  s_cmp_eq_u32 s53, 1
  s_cbranch_scc1 si_130
  buffer_store_dwordx2 v[28:29], v23, s[8:11], s22 offen sc1
  s_branch si_131
si_130:
  buffer_store_dwordx2 v[28:29], v23, s[8:11], s22 offen
si_131:
  s_and_b32 s21, s52, 7
  s_cmp_lg_u32 s21, s50
  s_cbranch_scc1 zm_132
  s_mov_b64 exec, s[70:71]
  buffer_store_dwordx4 v[156:159], v13, s[4:7], s83 offen sc1
zm_132:
  s_mov_b64 exec, -1
  s_branch bw_125
bw_127:
bw_125:
  s_lshr_b32 s21, 4, s20
  s_bitcmp1_b32 s21, 0
  s_cbranch_scc0 bw_134
  s_mov_b64 exec, s[62:63]
  buffer_store_dwordx4 v[212:215], v21, s[24:27], s85 offen sc1
  buffer_store_dwordx2 v[216:217], v23, s[24:27], s85 offen sc1
  s_mov_b64 exec, -1
  s_branch bw_133
bw_134:
bw_133:
  v_mov_b32 v200, v196
  v_mov_b32 v201, v197
  v_mov_b32 v202, v198
  v_mov_b32 v203, v199
  v_permlane32_swap_b32 v188, v192
  v_permlane32_swap_b32 v189, v193
  v_permlane32_swap_b32 v190, v194
  v_permlane32_swap_b32 v191, v195
  v_permlane32_swap_b32 v196, v200
  v_permlane32_swap_b32 v197, v201
  v_permlane32_swap_b32 v198, v202
  v_permlane32_swap_b32 v199, v203
  v_pk_add_f32 v[188:189], v[188:189], v[192:193]
  v_pk_add_f32 v[190:191], v[190:191], v[194:195]
  v_pk_add_f32 v[196:197], v[196:197], v[200:201]
  v_pk_add_f32 v[198:199], v[198:199], v[202:203]
  v_cvt_pk_bf16_f32 v252, v188, v189
  v_cvt_pk_bf16_f32 v254, v196, v197
  v_cvt_pk_bf16_f32 v253, v190, v191
  v_cvt_pk_bf16_f32 v255, v198, v199
  s_nop 0
  v_permlane16_swap_b32 v252, v254
  v_permlane16_swap_b32 v253, v255
  v_min_u32 v252, -2, v252
  s_mov_b64 exec, s[76:77]
  buffer_store_dwordx4 v[252:255], v15, s[24:27], s57 offen sc1
  s_mov_b64 exec, -1
  s_add_u32 s64, s64, 1310720
  s_add_u32 s52, s52, 1
  s_and_b32 s21, s52, 3
  s_mul_i32 s81, s21, 540672
  s_lshl_b32 s84, s21, 15
  s_branch step_90
fl_94:
  buffer_load_dword v94, v95, s[12:15], s79 offen sc1
  s_branch fl_95
pm_92:
  s_cmp_gt_u32 s52, 3
  s_cbranch_scc1 op_135
  v_readfirstlane_b32 s21, v94
  s_cmp_ge_u32 s21, s46
  s_cbranch_scc1 op_135
  buffer_load_dword v94, v95, s[12:15], s79 offen sc1
  s_waitcnt vmcnt(0)
  v_readfirstlane_b32 s21, v94
  s_add_u32 s22, s46, 2
  s_min_u32 s22, s22, 64
  s_sub_u32 s55, s21, s22
  s_sub_u32 s56, s21, s46
  s_cmp_gt_u32 s21, s52
  s_cselect_b32 s21, s87, 0
  s_cmp_eq_u32 s21, 0
  s_cbranch_scc1 op_135
  s_mov_b32 s87, 0
  s_sub_u32 s21, s64, 1310720
  buffer_load_dwordx4 v[176:179], v16, s[28:31], s21 offen offset:0 sc1
  buffer_load_dwordx4 v[180:183], v16, s[28:31], s21 offen offset:1024 sc1
  buffer_load_dwordx4 v[184:187], v16, s[28:31], s21 offen offset:2048 sc1
op_135:
  buffer_load_dwordx4 v[32:35], v4, s[4:7], s84 offen offset:0 sc1
  buffer_load_dwordx4 v[36:39], v4, s[4:7], s84 offen offset:1024 sc1
  buffer_load_dwordx4 v[40:43], v4, s[4:7], s84 offen offset:2048 sc1
  s_add_u32 s54, s54, 1
  s_cmp_gt_u32 s54, 131072
  s_cbranch_scc1 end0
  s_waitcnt vmcnt(0)
  v_bitop3_b32 v27, v35, v39, v43 bitop3:0x80
  v_perm_b32 v35, v39, v35, s89
  v_cmp_gt_u32 vcc, 0x48000000, v27
  v_mov_b32 v39, v42
  s_cbranch_vccnz pm_92
  s_branch A1_19
psr_109:
  s_cmp_gt_u32 s52, 3
  s_cbranch_scc1 op_136
  v_readfirstlane_b32 s21, v94
  s_cmp_ge_u32 s21, s46
  s_cbranch_scc1 op_136
  buffer_load_dword v94, v95, s[12:15], s79 offen sc1
  s_waitcnt vmcnt(0)
  v_readfirstlane_b32 s21, v94
  s_add_u32 s22, s46, 2
  s_min_u32 s22, s22, 64
  s_sub_u32 s55, s21, s22
  s_sub_u32 s56, s21, s46
  s_cmp_gt_u32 s21, s52
  s_cselect_b32 s21, s87, 0
  s_cmp_eq_u32 s21, 0
  s_cbranch_scc1 op_136
  s_mov_b32 s87, 0
  s_sub_u32 s21, s64, 1310720
  buffer_load_dwordx4 v[176:179], v16, s[28:31], s21 offen offset:0 sc1
  buffer_load_dwordx4 v[180:183], v16, s[28:31], s21 offen offset:1024 sc1
  buffer_load_dwordx4 v[184:187], v16, s[28:31], s21 offen offset:2048 sc1
op_136:
  buffer_load_dwordx2 v[248:249], v9, s[8:11], s81 offen sc1
  buffer_load_dwordx4 v[112:115], v8, s[8:11], s81 offen offset:0 sc1
  buffer_load_dwordx4 v[116:119], v8, s[8:11], s81 offen offset:1024 sc1
  s_add_u32 s54, s54, 1
  s_cmp_gt_u32 s54, 131072
  s_cbranch_scc1 end0
  s_waitcnt vmcnt(2)
  v_xor_b32 v96, s88, v248
  s_nop 0
  v_permlane16_swap_b32 v248, v249
  v_fma_mix_f32 v250, v248, 1.0, v249 op_sel:[0,0,0] op_sel_hi:[1,0,1]
  v_fma_mix_f32 v251, v248, 1.0, v249 op_sel:[1,0,1] op_sel_hi:[1,0,1]
  v_mov_b32 v248, v250
  v_mov_b32 v249, v251
  s_nop 0
  v_permlane32_swap_b32 v248, v250
  v_permlane32_swap_b32 v249, v251
  s_waitcnt vmcnt(0)
  v_bitop3_b32 v97, v112, v114, s88 bitop3:0x7e
  v_bitop3_b32 v98, v116, v118, s88 bitop3:0x7e
  v_fma_mix_f32 v120, v112, 1.0, v116 op_sel:[0,0,0] op_sel_hi:[1,0,1]
  v_or3_b32 v27, v96, v97, v98
  v_fma_mix_f32 v124, v114, 1.0, v118 op_sel:[0,0,0] op_sel_hi:[1,0,1]
  v_and_b32 v27, 1, v27
  v_fma_mix_f32 v121, v112, 1.0, v116 op_sel:[1,0,1] op_sel_hi:[1,0,1]
  v_cmp_ne_u32 vcc, 0, v27
  v_fma_mix_f32 v125, v114, 1.0, v118 op_sel:[1,0,1] op_sel_hi:[1,0,1]
  v_fma_mix_f32 v122, v113, 1.0, v117 op_sel:[0,0,0] op_sel_hi:[1,0,1]
  v_fma_mix_f32 v126, v115, 1.0, v119 op_sel:[0,0,0] op_sel_hi:[1,0,1]
  s_cbranch_vccnz psr_109
  s_branch psj_110
kvw_111:
  s_mov_b32 s22, s87
  s_cmp_eq_u32 s52, 0
  s_cselect_b32 s23, s87, s46
  s_cselect_b32 s55, 0, s55
  s_cselect_b32 s87, 1, 0
  s_cmp_eq_u32 s23, 0
  s_cbranch_scc1 kvok_112
  v_mov_b32 v236, 0
  s_mov_b32 s101, 0
wf_137:
  buffer_load_dword v237, v236, s[12:15], s79 offen sc1
  s_add_u32 s101, s101, 1
  s_cmp_gt_u32 s101, 131072
  s_cbranch_scc1 end0
  s_waitcnt vmcnt(0)
  v_readfirstlane_b32 s100, v237
  s_cmp_ge_u32 s100, s23
  s_cbranch_scc1 wf_138
  s_sleep 3
  s_branch wf_137
wf_138:
  s_cmp_eq_u32 s22, 0
  s_cbranch_scc1 kvok_112
  s_sub_u32 s21, s64, 1310720
  buffer_load_dwordx4 v[176:179], v16, s[28:31], s21 offen offset:0 sc1
  buffer_load_dwordx4 v[180:183], v16, s[28:31], s21 offen offset:1024 sc1
  buffer_load_dwordx4 v[184:187], v16, s[28:31], s21 offen offset:2048 sc1
  s_waitcnt vmcnt(0)
  s_branch kvok_112
last_91:
  s_lshr_b32 s21, 4, s20
  s_bitcmp1_b32 s21, 0
  s_cbranch_scc0 bw_140
  s_mov_b64 exec, s[62:63]
  buffer_store_dwordx4 v[212:215], v21, s[24:27], s85 offen sc1
  buffer_store_dwordx2 v[216:217], v23, s[24:27], s85 offen sc1
  s_mov_b64 exec, -1
  s_branch bw_139
bw_140:
bw_139:
  v_mov_b32 v188, 0
  v_mov_b32 v189, 0
  v_mov_b32 v190, 0
  v_mov_b32 v191, 0
  v_mov_b32 v192, 0
  v_mov_b32 v193, 0
  v_mov_b32 v194, 0
  v_mov_b32 v195, 0
  v_mov_b32 v196, 0
  v_mov_b32 v197, 0
  v_mov_b32 v198, 0
  v_mov_b32 v199, 0
  s_sleep 4
  s_mov_b32 s54, 0
lv_141:
  buffer_load_dwordx4 v[144:147], v10, s[8:11], s81 offen offset:0 sc1
  buffer_load_dwordx4 v[148:151], v10, s[8:11], s81 offen offset:1024 sc1
  buffer_load_dwordx4 v[152:155], v10, s[8:11], s81 offen offset:2048 sc1
  s_add_u32 s54, s54, 1
  s_cmp_gt_u32 s54, 131072
  s_cbranch_scc1 end0
  s_waitcnt vmcnt(0)
  v_max3_u32 v27, v144, v146, v148
  v_max3_u32 v27, v27, v150, v152
  v_max3_u32 v27, v27, v154, v154
  v_cmp_eq_u32 vcc, -1, v27
  s_nop 1
  s_cbranch_vccnz lv_141
  v_smfmac_f32_16x16x64_bf16 v[188:191], v[144:147], a[180:187], v44
  v_smfmac_f32_16x16x64_bf16 v[192:195], v[144:147], a[204:211], v44
  v_smfmac_f32_16x16x64_bf16 v[196:199], v[144:147], a[228:235], v44
  v_smfmac_f32_16x16x64_bf16 v[188:191], v[148:151], a[188:195], v44
  v_smfmac_f32_16x16x64_bf16 v[192:195], v[148:151], a[212:219], v44
  v_smfmac_f32_16x16x64_bf16 v[196:199], v[148:151], a[236:243], v44
  v_smfmac_f32_16x16x64_bf16 v[188:191], v[152:155], a[196:203], v44
  v_smfmac_f32_16x16x64_bf16 v[192:195], v[152:155], a[220:227], v44
  v_smfmac_f32_16x16x64_bf16 v[196:199], v[152:155], a[244:251], v44
  s_lshr_b32 s21, 4, s20
  s_bitcmp1_b32 s21, 0
  s_cbranch_scc0 bw_143
  v_mov_b32 v236, 64
  s_mov_b64 exec, 1
  buffer_store_dword v236, v95, s[12:15], s90 offen sc1
  s_mov_b64 exec, -1
  s_branch bw_142
bw_143:
bw_142:
  s_nop 7
  v_mov_b32 v200, v196
  v_mov_b32 v201, v197
  v_mov_b32 v202, v198
  v_mov_b32 v203, v199
  v_permlane32_swap_b32 v188, v192
  v_permlane32_swap_b32 v189, v193
  v_permlane32_swap_b32 v190, v194
  v_permlane32_swap_b32 v191, v195
  v_permlane32_swap_b32 v196, v200
  v_permlane32_swap_b32 v197, v201
  v_permlane32_swap_b32 v198, v202
  v_permlane32_swap_b32 v199, v203
  v_pk_add_f32 v[188:189], v[188:189], v[192:193]
  v_pk_add_f32 v[190:191], v[190:191], v[194:195]
  v_pk_add_f32 v[196:197], v[196:197], v[200:201]
  v_pk_add_f32 v[198:199], v[198:199], v[202:203]
  v_cvt_pk_bf16_f32 v252, v188, v189
  v_cvt_pk_bf16_f32 v254, v196, v197
  v_cvt_pk_bf16_f32 v253, v190, v191
  v_cvt_pk_bf16_f32 v255, v198, v199
  s_nop 0
  v_permlane16_swap_b32 v252, v254
  v_permlane16_swap_b32 v253, v255
  v_min_u32 v252, -2, v252
  s_mov_b64 exec, s[76:77]
  buffer_store_dwordx4 v[252:255], v15, s[24:27], s57 offen sc1
  s_mov_b64 exec, -1
  s_lshr_b32 s21, 1, s20
  s_bitcmp1_b32 s21, 0
  s_cbranch_scc0 bw_145
  v_mov_b32 v246, 80
  v_mov_b32 v247, 1
  s_mov_b64 exec, 1
  buffer_atomic_add v247, v246, s[32:35], 0 offen sc0 sc1
  s_mov_b64 exec, -1
clm_146:
  s_branch bw_144
bw_145:
bw_144:
  s_branch chain_done
chain_done:
  s_waitcnt vmcnt(0) lgkmcnt(0)
  s_barrier
  s_mov_b32 s84, 0
  s_mov_b32 s85, -1
  s_mov_b32 s86, 0
  v_mov_b32 v21, 0
  v_mov_b32 v23, v247
  s_cmp_lg_u32 s20, 0
  s_cbranch_scc1 queue_b
  s_mov_b64 exec, 1
  s_branch queue_a
end0:
  s_endpgm
gemm_side:
  s_bfe_u32 s23, s22, 0x20005
  s_add_u32 s22, s22, 31
  s_and_b32 s22, s22, 31
  s_lshl_b32 s21, s23, 3
  s_add_u32 s2, s21, s22
  s_add_u32 s3, s2, 72
  s_add_u32 s24, s2, 48
  s_add_u32 s2, s2, s21
  s_cmp_lt_u32 s22, 24
  s_cselect_b32 s3, s24, s3
  s_cmp_lt_u32 s22, 16
  s_cselect_b32 s3, s2, s3
  s_mov_b32 s2, s3
  s_cmp_ge_u32 s3, 64
  s_cbranch_scc1 not_kv
  s_load_dwordx2 s[4:5], s[0:1], 0
  s_load_dwordx2 s[6:7], s[0:1], 24
  s_load_dwordx2 s[36:37], s[0:1], 32
  s_load_dwordx2 s[38:39], s[0:1], 104
  s_and_b32 s43, s3, 1
  s_bfe_u32 s42, s3, 0x50001
  s_lshr_b32 s40, s42, 2
  s_waitcnt lgkmcnt(0)
  s_cmp_eq_u32 s43, 1
  s_cselect_b32 s6, s36, s6
  s_cselect_b32 s7, s37, s7
  s_mov_b32 s8, s4
  s_mov_b32 s9, s5
  s_mov_b32 s10, 2621440
  s_mov_b32 s11, 0x00020000
  s_mov_b32 s12, s6
  s_mov_b32 s13, s7
  s_mov_b32 s14, 7864320
  s_mov_b32 s15, 0x00020000
  s_mov_b32 s16, s38
  s_mov_b32 s17, s39
  s_mov_b32 s18, 50331648
  s_mov_b32 s19, 0x00020000
  s_mul_i32 s44, s42, 384
  s_mov_b32 s62, 1024
  s_mov_b32 s24, 0
  s_mov_b32 s25, 81920
  s_mov_b32 s64, s32
  s_mov_b32 s65, s33
  s_mov_b32 s66, s34
  s_mov_b32 s67, s35
  s_load_dwordx2 s[72:73], s[0:1], 104
  s_waitcnt lgkmcnt(0)
  s_add_u32 s72, s72, 81068032
  s_addc_u32 s73, s73, 0
  s_mov_b32 s74, 116736
  s_mov_b32 s75, 0x00020000
  v_mov_b32 v9, 2731
  v_add_u32 v8, 0, v1
  v_mul_u32_u24 v7, v8, v9
  v_lshrrev_b32 v7, 16, v7
  v_mul_u32_u24 v4, 24, v7
  v_sub_u32 v8, v8, v4
  v_and_b32 v4, 2, v7
  v_xor_b32 v8, v8, v4
  v_xor_b32 v5, 4, v8
  s_mov_b32 s21, 12288
  v_mul_lo_u32 v7, v7, s21
  v_lshl_add_u32 v40, v8, 4, v7
  v_lshl_add_u32 v43, v5, 4, v7
  v_add_u32 v8, 64, v1
  v_mul_u32_u24 v7, v8, v9
  v_lshrrev_b32 v7, 16, v7
  v_mul_u32_u24 v4, 24, v7
  v_sub_u32 v8, v8, v4
  v_and_b32 v4, 2, v7
  v_xor_b32 v8, v8, v4
  v_xor_b32 v5, 4, v8
  s_mov_b32 s21, 12288
  v_mul_lo_u32 v7, v7, s21
  v_lshl_add_u32 v41, v8, 4, v7
  v_lshl_add_u32 v44, v5, 4, v7
  v_add_u32 v8, 128, v1
  v_mul_u32_u24 v7, v8, v9
  v_lshrrev_b32 v7, 16, v7
  v_mul_u32_u24 v4, 24, v7
  v_sub_u32 v8, v8, v4
  v_and_b32 v4, 2, v7
  v_xor_b32 v8, v8, v4
  v_xor_b32 v5, 4, v8
  s_mov_b32 s21, 12288
  v_mul_lo_u32 v7, v7, s21
  v_lshl_add_u32 v42, v8, 4, v7
  v_lshl_add_u32 v45, v5, 4, v7
  s_mul_i32 s21, s20, 393216
  s_add_u32 s21, s21, 0
  s_add_u32 s21, s21, s44
  s_mul_i32 s22, s20, 12288
  s_add_u32 s22, s22, 0
  s_add_u32 m0, s22, 0
  s_nop 0
  buffer_load_dwordx4 v40, s[12:15], s21 offen lds
  s_add_u32 m0, s22, 1024
  s_nop 0
  buffer_load_dwordx4 v41, s[12:15], s21 offen lds
  s_add_u32 m0, s22, 2048
  s_nop 0
  buffer_load_dwordx4 v42, s[12:15], s21 offen lds
  s_mul_i32 s21, s20, 393216
  s_add_u32 s21, s21, 98304
  s_add_u32 s21, s21, s44
  s_mul_i32 s22, s20, 12288
  s_add_u32 s22, s22, 3072
  s_add_u32 m0, s22, 0
  s_nop 0
  buffer_load_dwordx4 v43, s[12:15], s21 offen lds
  s_add_u32 m0, s22, 1024
  s_nop 0
  buffer_load_dwordx4 v44, s[12:15], s21 offen lds
  s_add_u32 m0, s22, 2048
  s_nop 0
  buffer_load_dwordx4 v45, s[12:15], s21 offen lds
  s_mul_i32 s21, s20, 393216
  s_add_u32 s21, s21, 196608
  s_add_u32 s21, s21, s44
  s_mul_i32 s22, s20, 12288
  s_add_u32 s22, s22, 6144
  s_add_u32 m0, s22, 0
  s_nop 0
  buffer_load_dwordx4 v40, s[12:15], s21 offen lds
  s_add_u32 m0, s22, 1024
  s_nop 0
  buffer_load_dwordx4 v41, s[12:15], s21 offen lds
  s_add_u32 m0, s22, 2048
  s_nop 0
  buffer_load_dwordx4 v42, s[12:15], s21 offen lds
  s_mul_i32 s21, s20, 393216
  s_add_u32 s21, s21, 294912
  s_add_u32 s21, s21, s44
  s_mul_i32 s22, s20, 12288
  s_add_u32 s22, s22, 9216
  s_add_u32 m0, s22, 0
  s_nop 0
  buffer_load_dwordx4 v43, s[12:15], s21 offen lds
  s_add_u32 m0, s22, 1024
  s_nop 0
  buffer_load_dwordx4 v44, s[12:15], s21 offen lds
  s_add_u32 m0, s22, 2048
  s_nop 0
  buffer_load_dwordx4 v45, s[12:15], s21 offen lds
  v_lshrrev_b32 v11, 3, v1
  v_and_b32 v12, 7, v1
  v_xor_b32 v12, v12, v11
  v_mul_u32_u24 v11, 1280, v11
  v_lshl_add_u32 v10, v12, 4, v11
  s_mul_i32 s46, s20, 20480
  v_add_u32 v10, s46, v10
  s_lshl_b32 s47, s20, 11
  s_add_u32 s47, s47, 98304
  s_add_u32 s46, s47, 57344
  s_mov_b32 s30, s24
  s_add_u32 s32, s47, 0
  v_add_u32 v11, 9216, v10
  s_mov_b32 m0, s32
  s_nop 0
  buffer_load_dwordx4 v10, s[8:11], s30 offen offset:0 lds
  buffer_load_dwordx4 v11, s[8:11], s30 offen offset:1024 lds
  s_add_u32 s30, s30, 128
  s_add_u32 s32, s32, 8192
  s_cmp_lt_u32 s32, s46
  s_cselect_b32 s32, s32, s47
  s_mov_b32 m0, s32
  s_nop 0
  buffer_load_dwordx4 v10, s[8:11], s30 offen offset:0 lds
  buffer_load_dwordx4 v11, s[8:11], s30 offen offset:1024 lds
  s_add_u32 s30, s30, 128
  s_add_u32 s32, s32, 8192
  s_cmp_lt_u32 s32, s46
  s_cselect_b32 s32, s32, s47
  s_mov_b32 m0, s32
  s_nop 0
  buffer_load_dwordx4 v10, s[8:11], s30 offen offset:0 lds
  buffer_load_dwordx4 v11, s[8:11], s30 offen offset:1024 lds
  s_add_u32 s30, s30, 128
  s_add_u32 s32, s32, 8192
  s_cmp_lt_u32 s32, s46
  s_cselect_b32 s32, s32, s47
  s_mov_b32 m0, s32
  s_nop 0
  buffer_load_dwordx4 v10, s[8:11], s30 offen offset:0 lds
  buffer_load_dwordx4 v11, s[8:11], s30 offen offset:1024 lds
  s_add_u32 s30, s30, 128
  s_add_u32 s32, s32, 8192
  s_cmp_lt_u32 s32, s46
  s_cselect_b32 s32, s32, s47
  s_mov_b32 m0, s32
  s_nop 0
  buffer_load_dwordx4 v10, s[8:11], s30 offen offset:0 lds
  buffer_load_dwordx4 v11, s[8:11], s30 offen offset:1024 lds
  s_add_u32 s30, s30, 128
  s_add_u32 s32, s32, 8192
  s_cmp_lt_u32 s32, s46
  s_cselect_b32 s32, s32, s47
  s_mul_i32 s21, s20, 393216
  s_add_u32 s21, s21, 1572864
  s_add_u32 s21, s21, s44
  s_mul_i32 s22, s20, 12288
  s_add_u32 s22, s22, 49152
  s_add_u32 m0, s22, 0
  s_nop 0
  buffer_load_dwordx4 v40, s[12:15], s21 offen lds
  s_add_u32 m0, s22, 1024
  s_nop 0
  buffer_load_dwordx4 v41, s[12:15], s21 offen lds
  s_add_u32 m0, s22, 2048
  s_nop 0
  buffer_load_dwordx4 v42, s[12:15], s21 offen lds
  s_mul_i32 s21, s20, 393216
  s_add_u32 s21, s21, 1671168
  s_add_u32 s21, s21, s44
  s_mul_i32 s22, s20, 12288
  s_add_u32 s22, s22, 52224
  s_add_u32 m0, s22, 0
  s_nop 0
  buffer_load_dwordx4 v43, s[12:15], s21 offen lds
  s_add_u32 m0, s22, 1024
  s_nop 0
  buffer_load_dwordx4 v44, s[12:15], s21 offen lds
  s_add_u32 m0, s22, 2048
  s_nop 0
  buffer_load_dwordx4 v45, s[12:15], s21 offen lds
  s_mul_i32 s21, s20, 393216
  s_add_u32 s21, s21, 1769472
  s_add_u32 s21, s21, s44
  s_mul_i32 s22, s20, 12288
  s_add_u32 s22, s22, 55296
  s_add_u32 m0, s22, 0
  s_nop 0
  buffer_load_dwordx4 v40, s[12:15], s21 offen lds
  s_add_u32 m0, s22, 1024
  s_nop 0
  buffer_load_dwordx4 v41, s[12:15], s21 offen lds
  s_add_u32 m0, s22, 2048
  s_nop 0
  buffer_load_dwordx4 v42, s[12:15], s21 offen lds
  s_mul_i32 s21, s20, 393216
  s_add_u32 s21, s21, 1867776
  s_add_u32 s21, s21, s44
  s_mul_i32 s22, s20, 12288
  s_add_u32 s22, s22, 58368
  s_add_u32 m0, s22, 0
  s_nop 0
  buffer_load_dwordx4 v43, s[12:15], s21 offen lds
  s_add_u32 m0, s22, 1024
  s_nop 0
  buffer_load_dwordx4 v44, s[12:15], s21 offen lds
  s_add_u32 m0, s22, 2048
  s_nop 0
  buffer_load_dwordx4 v45, s[12:15], s21 offen lds
  v_lshrrev_b32 v7, 2, v2
  v_and_b32 v4, 2, v7
  v_and_b32 v5, 1, v3
  v_lshl_or_b32 v4, v5, 2, v4
  v_lshl_add_u32 v7, v3, 3, v7
  v_mul_u32_u24 v7, 384, v7
  v_and_b32 v5, 1, v2
  v_lshl_add_u32 v7, v5, 3, v7
  v_bfe_u32 v8, v2, 1, 1
  s_mul_i32 s21, s20, 6
  v_add_u32 v8, s21, v8
  v_add_u32 v5, 0, v8
  v_xor_b32 v5, v5, v4
  v_lshl_add_u32 v46, v5, 4, v7
  v_add_u32 v49, 49152, v46
  v_add_u32 v5, 2, v8
  v_xor_b32 v5, v5, v4
  v_lshl_add_u32 v47, v5, 4, v7
  v_add_u32 v50, 49152, v47
  v_add_u32 v5, 4, v8
  v_xor_b32 v5, v5, v4
  v_lshl_add_u32 v48, v5, 4, v7
  v_add_u32 v51, 49152, v48
  s_mov_b32 s26, 6
  s_mul_i32 s27, s42, 12288
  s_mul_i32 s21, s43, 25165824
  s_add_u32 s27, s27, s21
  s_mov_b32 s28, 786432
  s_lshl_b32 s60, s40, 7
  s_add_u32 s60, s60, 0
  s_mov_b32 s61, 0
  v_and_b32 v6, 7, v2
  v_add_u32 v4, 0, v3
  v_xor_b32 v4, v4, v6
  v_lshlrev_b32 v4, 4, v4
  v_lshl_add_u32 v14, v2, 7, v4
  v_add_u32 v4, 4, v3
  v_xor_b32 v4, v4, v6
  v_lshlrev_b32 v4, 4, v4
  v_lshl_add_u32 v15, v2, 7, v4
  v_mul_u32_u24 v22, 400, v2
  v_mul_u32_u24 v4, 16, v3
  s_mul_i32 s21, s20, 96
  s_add_u32 s21, s21, 0
  v_add3_u32 v22, v22, v4, s21
  v_lshlrev_b32 v4, 3, v3
  v_sub_u32 v16, v22, v4
  v_mov_b32 v9, 2731
  s_mul_i32 s21, s20, 6400
  s_add_u32 s21, s21, 0
  v_mul_u32_u24 v4, 400, v2
  v_lshlrev_b32 v5, 4, v3
  v_add3_u32 v23, v4, v5, s21
  v_lshlrev_b32 v26, 4, v1
  s_mov_b32 s33, 98304
  s_mov_b32 s48, 0x80000000
  s_mov_b32 m0, s32
  s_nop 0
  buffer_load_dwordx4 v10, s[8:11], s30 offen offset:0 lds
  s_waitcnt vmcnt(21)
  s_barrier
  v_add_u32 v18, s33, v14
  v_add_u32 v19, s33, v15
  s_add_u32 s33, s33, 8192
  s_cmp_lt_u32 s33, 155648
  s_cselect_b32 s33, s33, 98304
  ds_read_b128 v[160:163], v18 offset:0
  ds_read_b128 v[164:167], v18 offset:2048
  ds_read_b128 v[168:171], v18 offset:4096
  ds_read_b128 v[172:175], v18 offset:6144
  s_waitcnt lgkmcnt(0)
  s_waitcnt vmcnt(23)
  s_barrier
  ds_read_b64_tr_b16 a[0:1], v46 offset:0
  ds_read_b64_tr_b16 a[2:3], v46 offset:1536
  ds_read_b64_tr_b16 a[4:5], v47 offset:0
  ds_read_b64_tr_b16 a[6:7], v47 offset:1536
  ds_read_b64_tr_b16 a[8:9], v48 offset:0
  ds_read_b64_tr_b16 a[10:11], v48 offset:1536
  ds_read_b64_tr_b16 a[12:13], v46 offset:12288
  ds_read_b64_tr_b16 a[14:15], v46 offset:13824
  ds_read_b64_tr_b16 a[16:17], v47 offset:12288
  ds_read_b64_tr_b16 a[18:19], v47 offset:13824
  ds_read_b64_tr_b16 a[20:21], v48 offset:12288
  ds_read_b64_tr_b16 a[22:23], v48 offset:13824
  ds_read_b64_tr_b16 a[24:25], v46 offset:24576
  ds_read_b64_tr_b16 a[26:27], v46 offset:26112
  ds_read_b64_tr_b16 a[28:29], v47 offset:24576
  ds_read_b64_tr_b16 a[30:31], v47 offset:26112
  ds_read_b64_tr_b16 a[32:33], v48 offset:24576
  ds_read_b64_tr_b16 a[34:35], v48 offset:26112
  ds_read_b64_tr_b16 a[36:37], v46 offset:36864
  ds_read_b64_tr_b16 a[38:39], v46 offset:38400
  ds_read_b64_tr_b16 a[40:41], v47 offset:36864
  ds_read_b64_tr_b16 a[42:43], v47 offset:38400
  ds_read_b64_tr_b16 a[44:45], v48 offset:36864
  ds_read_b64_tr_b16 a[46:47], v48 offset:38400
  s_waitcnt lgkmcnt(0)
  s_barrier
  s_mov_b32 s23, m0
  s_mul_i32 s21, s20, 393216
  s_add_u32 s21, s21, 3145728
  s_add_u32 s21, s21, s44
  s_mul_i32 s22, s20, 12288
  s_add_u32 s22, s22, 0
  s_add_u32 m0, s22, 0
  s_nop 0
  buffer_load_dwordx4 v40, s[12:15], s21 offen lds
  s_add_u32 m0, s22, 1024
  s_nop 0
  buffer_load_dwordx4 v41, s[12:15], s21 offen lds
  s_add_u32 m0, s22, 2048
  s_nop 0
  buffer_load_dwordx4 v42, s[12:15], s21 offen lds
  s_mul_i32 s21, s20, 393216
  s_add_u32 s21, s21, 3244032
  s_add_u32 s21, s21, s44
  s_mul_i32 s22, s20, 12288
  s_add_u32 s22, s22, 3072
  s_add_u32 m0, s22, 0
  s_nop 0
  buffer_load_dwordx4 v43, s[12:15], s21 offen lds
  s_add_u32 m0, s22, 1024
  s_nop 0
  buffer_load_dwordx4 v44, s[12:15], s21 offen lds
  s_add_u32 m0, s22, 2048
  s_nop 0
  buffer_load_dwordx4 v45, s[12:15], s21 offen lds
  s_mul_i32 s21, s20, 393216
  s_add_u32 s21, s21, 3342336
  s_add_u32 s21, s21, s44
  s_mul_i32 s22, s20, 12288
  s_add_u32 s22, s22, 6144
  s_add_u32 m0, s22, 0
  s_nop 0
  buffer_load_dwordx4 v40, s[12:15], s21 offen lds
  s_add_u32 m0, s22, 1024
  s_nop 0
  buffer_load_dwordx4 v41, s[12:15], s21 offen lds
  s_add_u32 m0, s22, 2048
  s_nop 0
  buffer_load_dwordx4 v42, s[12:15], s21 offen lds
  s_mul_i32 s21, s20, 393216
  s_add_u32 s21, s21, 3440640
  s_add_u32 s21, s21, s44
  s_mul_i32 s22, s20, 12288
  s_add_u32 s22, s22, 9216
  s_add_u32 m0, s22, 0
  s_nop 0
  buffer_load_dwordx4 v43, s[12:15], s21 offen lds
  s_add_u32 m0, s22, 1024
  s_nop 0
  buffer_load_dwordx4 v44, s[12:15], s21 offen lds
  s_add_u32 m0, s22, 2048
  s_nop 0
  buffer_load_dwordx4 v45, s[12:15], s21 offen lds
  s_mov_b32 m0, s23
  v_mfma_f32_16x16x32_bf16 v[64:67], a[0:3], v[160:163], 0
  ds_read_b128 v[192:195], v19 offset:0
  v_mfma_f32_16x16x32_bf16 v[68:71], a[4:7], v[160:163], 0
  v_add_u32 v18, s33, v14
  v_mfma_f32_16x16x32_bf16 v[72:75], a[8:11], v[160:163], 0
  v_mfma_f32_16x16x32_bf16 v[76:79], a[0:3], v[164:167], 0
  ds_read_b128 v[196:199], v19 offset:2048
  v_mfma_f32_16x16x32_bf16 v[80:83], a[4:7], v[164:167], 0
  buffer_load_dwordx4 v11, s[8:11], s30 offen offset:1024 lds
  v_mfma_f32_16x16x32_bf16 v[84:87], a[8:11], v[164:167], 0
  s_add_u32 s30, s30, 128
  v_mfma_f32_16x16x32_bf16 v[88:91], a[0:3], v[168:171], 0
  ds_read_b128 v[200:203], v19 offset:4096
  s_add_u32 m0, m0, 8192
  v_mfma_f32_16x16x32_bf16 v[92:95], a[4:7], v[168:171], 0
  s_cmp_lt_u32 m0, s46
  s_cselect_b32 m0, m0, s47
  v_mfma_f32_16x16x32_bf16 v[96:99], a[8:11], v[168:171], 0
  v_mfma_f32_16x16x32_bf16 v[100:103], a[0:3], v[172:175], 0
  ds_read_b128 v[204:207], v19 offset:6144
  v_mfma_f32_16x16x32_bf16 v[104:107], a[4:7], v[172:175], 0
  v_mfma_f32_16x16x32_bf16 v[108:111], a[8:11], v[172:175], 0
  s_waitcnt vmcnt(32) lgkmcnt(2)
  s_barrier
  v_mfma_f32_16x16x32_bf16 v[64:67], a[12:15], v[192:195], v[64:67]
  ds_read_b128 v[160:163], v18 offset:0
  v_mfma_f32_16x16x32_bf16 v[68:71], a[16:19], v[192:195], v[68:71]
  v_mfma_f32_16x16x32_bf16 v[72:75], a[20:23], v[192:195], v[72:75]
  v_add_u32 v19, s33, v15
  s_add_u32 s33, s33, 8192
  v_mfma_f32_16x16x32_bf16 v[76:79], a[12:15], v[196:199], v[76:79]
  ds_read_b128 v[164:167], v18 offset:2048
  v_mfma_f32_16x16x32_bf16 v[80:83], a[16:19], v[196:199], v[80:83]
  buffer_load_dwordx4 v10, s[8:11], s30 offen offset:0 lds
  v_mfma_f32_16x16x32_bf16 v[84:87], a[20:23], v[196:199], v[84:87]
  s_waitcnt lgkmcnt(2)
  v_mfma_f32_16x16x32_bf16 v[88:91], a[12:15], v[200:203], v[88:91]
  ds_read_b128 v[168:171], v18 offset:4096
  v_mfma_f32_16x16x32_bf16 v[92:95], a[16:19], v[200:203], v[92:95]
  s_cmp_lt_u32 s33, 155648
  s_cselect_b32 s33, s33, 98304
  v_mfma_f32_16x16x32_bf16 v[96:99], a[20:23], v[200:203], v[96:99]
  v_mfma_f32_16x16x32_bf16 v[100:103], a[12:15], v[204:207], v[100:103]
  ds_read_b128 v[172:175], v18 offset:6144
  v_mfma_f32_16x16x32_bf16 v[104:107], a[16:19], v[204:207], v[104:107]
  v_mfma_f32_16x16x32_bf16 v[108:111], a[20:23], v[204:207], v[108:111]
  s_waitcnt lgkmcnt(2)
  v_mfma_f32_16x16x32_bf16 v[64:67], a[24:27], v[160:163], v[64:67]
  ds_read_b128 v[192:195], v19 offset:0
  v_mfma_f32_16x16x32_bf16 v[68:71], a[28:31], v[160:163], v[68:71]
  v_add_u32 v18, s33, v14
  v_mfma_f32_16x16x32_bf16 v[72:75], a[32:35], v[160:163], v[72:75]
  v_mfma_f32_16x16x32_bf16 v[76:79], a[24:27], v[164:167], v[76:79]
  ds_read_b128 v[196:199], v19 offset:2048
  v_mfma_f32_16x16x32_bf16 v[80:83], a[28:31], v[164:167], v[80:83]
  buffer_load_dwordx4 v11, s[8:11], s30 offen offset:1024 lds
  v_mfma_f32_16x16x32_bf16 v[84:87], a[32:35], v[164:167], v[84:87]
  s_waitcnt lgkmcnt(2)
  s_add_u32 s30, s30, 128
  v_mfma_f32_16x16x32_bf16 v[88:91], a[24:27], v[168:171], v[88:91]
  ds_read_b128 v[200:203], v19 offset:4096
  s_add_u32 m0, m0, 8192
  v_mfma_f32_16x16x32_bf16 v[92:95], a[28:31], v[168:171], v[92:95]
  s_cmp_lt_u32 m0, s46
  s_cselect_b32 m0, m0, s47
  v_mfma_f32_16x16x32_bf16 v[96:99], a[32:35], v[168:171], v[96:99]
  v_mfma_f32_16x16x32_bf16 v[100:103], a[24:27], v[172:175], v[100:103]
  ds_read_b128 v[204:207], v19 offset:6144
  v_mfma_f32_16x16x32_bf16 v[104:107], a[28:31], v[172:175], v[104:107]
  v_mfma_f32_16x16x32_bf16 v[108:111], a[32:35], v[172:175], v[108:111]
  s_waitcnt vmcnt(32) lgkmcnt(2)
  s_barrier
  v_mfma_f32_16x16x32_bf16 v[64:67], a[36:39], v[192:195], v[64:67]
  ds_read_b128 v[160:163], v18 offset:0
  v_mfma_f32_16x16x32_bf16 v[68:71], a[40:43], v[192:195], v[68:71]
  v_mfma_f32_16x16x32_bf16 v[72:75], a[44:47], v[192:195], v[72:75]
  v_add_u32 v19, s33, v15
  s_add_u32 s33, s33, 8192
  v_mfma_f32_16x16x32_bf16 v[76:79], a[36:39], v[196:199], v[76:79]
  ds_read_b128 v[164:167], v18 offset:2048
  v_mfma_f32_16x16x32_bf16 v[80:83], a[40:43], v[196:199], v[80:83]
  buffer_load_dwordx4 v10, s[8:11], s30 offen offset:0 lds
  v_mfma_f32_16x16x32_bf16 v[84:87], a[44:47], v[196:199], v[84:87]
  s_waitcnt lgkmcnt(2)
  v_mfma_f32_16x16x32_bf16 v[88:91], a[36:39], v[200:203], v[88:91]
  ds_read_b128 v[168:171], v18 offset:4096
  v_mfma_f32_16x16x32_bf16 v[92:95], a[40:43], v[200:203], v[92:95]
  s_cmp_lt_u32 s33, 155648
  s_cselect_b32 s33, s33, 98304
  v_mfma_f32_16x16x32_bf16 v[96:99], a[44:47], v[200:203], v[96:99]
  v_mfma_f32_16x16x32_bf16 v[100:103], a[36:39], v[204:207], v[100:103]
  ds_read_b128 v[172:175], v18 offset:6144
  v_mfma_f32_16x16x32_bf16 v[104:107], a[40:43], v[204:207], v[104:107]
  v_mfma_f32_16x16x32_bf16 v[108:111], a[44:47], v[204:207], v[108:111]
  s_waitcnt lgkmcnt(2)
  s_waitcnt vmcnt(17)
  s_barrier
  ds_read_b64_tr_b16 a[48:49], v49 offset:0
  ds_read_b64_tr_b16 a[50:51], v49 offset:1536
  ds_read_b64_tr_b16 a[52:53], v50 offset:0
  ds_read_b64_tr_b16 a[54:55], v50 offset:1536
  ds_read_b64_tr_b16 a[56:57], v51 offset:0
  ds_read_b64_tr_b16 a[58:59], v51 offset:1536
  ds_read_b64_tr_b16 a[60:61], v49 offset:12288
  ds_read_b64_tr_b16 a[62:63], v49 offset:13824
  ds_read_b64_tr_b16 a[64:65], v50 offset:12288
  ds_read_b64_tr_b16 a[66:67], v50 offset:13824
  ds_read_b64_tr_b16 a[68:69], v51 offset:12288
  ds_read_b64_tr_b16 a[70:71], v51 offset:13824
  ds_read_b64_tr_b16 a[72:73], v49 offset:24576
  ds_read_b64_tr_b16 a[74:75], v49 offset:26112
  ds_read_b64_tr_b16 a[76:77], v50 offset:24576
  ds_read_b64_tr_b16 a[78:79], v50 offset:26112
  ds_read_b64_tr_b16 a[80:81], v51 offset:24576
  ds_read_b64_tr_b16 a[82:83], v51 offset:26112
  ds_read_b64_tr_b16 a[84:85], v49 offset:36864
  ds_read_b64_tr_b16 a[86:87], v49 offset:38400
  ds_read_b64_tr_b16 a[88:89], v50 offset:36864
  ds_read_b64_tr_b16 a[90:91], v50 offset:38400
  ds_read_b64_tr_b16 a[92:93], v51 offset:36864
  ds_read_b64_tr_b16 a[94:95], v51 offset:38400
  s_waitcnt lgkmcnt(0)
  s_barrier
  s_mov_b32 s23, m0
  s_mul_i32 s21, s20, 393216
  s_add_u32 s21, s21, 4718592
  s_add_u32 s21, s21, s44
  s_mul_i32 s22, s20, 12288
  s_add_u32 s22, s22, 49152
  s_add_u32 m0, s22, 0
  s_nop 0
  buffer_load_dwordx4 v40, s[12:15], s21 offen lds
  s_add_u32 m0, s22, 1024
  s_nop 0
  buffer_load_dwordx4 v41, s[12:15], s21 offen lds
  s_add_u32 m0, s22, 2048
  s_nop 0
  buffer_load_dwordx4 v42, s[12:15], s21 offen lds
  s_mul_i32 s21, s20, 393216
  s_add_u32 s21, s21, 4816896
  s_add_u32 s21, s21, s44
  s_mul_i32 s22, s20, 12288
  s_add_u32 s22, s22, 52224
  s_add_u32 m0, s22, 0
  s_nop 0
  buffer_load_dwordx4 v43, s[12:15], s21 offen lds
  s_add_u32 m0, s22, 1024
  s_nop 0
  buffer_load_dwordx4 v44, s[12:15], s21 offen lds
  s_add_u32 m0, s22, 2048
  s_nop 0
  buffer_load_dwordx4 v45, s[12:15], s21 offen lds
  s_mul_i32 s21, s20, 393216
  s_add_u32 s21, s21, 4915200
  s_add_u32 s21, s21, s44
  s_mul_i32 s22, s20, 12288
  s_add_u32 s22, s22, 55296
  s_add_u32 m0, s22, 0
  s_nop 0
  buffer_load_dwordx4 v40, s[12:15], s21 offen lds
  s_add_u32 m0, s22, 1024
  s_nop 0
  buffer_load_dwordx4 v41, s[12:15], s21 offen lds
  s_add_u32 m0, s22, 2048
  s_nop 0
  buffer_load_dwordx4 v42, s[12:15], s21 offen lds
  s_mul_i32 s21, s20, 393216
  s_add_u32 s21, s21, 5013504
  s_add_u32 s21, s21, s44
  s_mul_i32 s22, s20, 12288
  s_add_u32 s22, s22, 58368
  s_add_u32 m0, s22, 0
  s_nop 0
  buffer_load_dwordx4 v43, s[12:15], s21 offen lds
  s_add_u32 m0, s22, 1024
  s_nop 0
  buffer_load_dwordx4 v44, s[12:15], s21 offen lds
  s_add_u32 m0, s22, 2048
  s_nop 0
  buffer_load_dwordx4 v45, s[12:15], s21 offen lds
  s_mov_b32 m0, s23
  v_mfma_f32_16x16x32_bf16 v[64:67], a[48:51], v[160:163], v[64:67]
  ds_read_b128 v[192:195], v19 offset:0
  v_mfma_f32_16x16x32_bf16 v[68:71], a[52:55], v[160:163], v[68:71]
  v_add_u32 v18, s33, v14
  v_mfma_f32_16x16x32_bf16 v[72:75], a[56:59], v[160:163], v[72:75]
  v_mfma_f32_16x16x32_bf16 v[76:79], a[48:51], v[164:167], v[76:79]
  ds_read_b128 v[196:199], v19 offset:2048
  v_mfma_f32_16x16x32_bf16 v[80:83], a[52:55], v[164:167], v[80:83]
  buffer_load_dwordx4 v11, s[8:11], s30 offen offset:1024 lds
  v_mfma_f32_16x16x32_bf16 v[84:87], a[56:59], v[164:167], v[84:87]
  s_add_u32 s30, s30, 128
  v_mfma_f32_16x16x32_bf16 v[88:91], a[48:51], v[168:171], v[88:91]
  ds_read_b128 v[200:203], v19 offset:4096
  s_add_u32 m0, m0, 8192
  v_mfma_f32_16x16x32_bf16 v[92:95], a[52:55], v[168:171], v[92:95]
  s_cmp_lt_u32 m0, s46
  s_cselect_b32 m0, m0, s47
  v_mfma_f32_16x16x32_bf16 v[96:99], a[56:59], v[168:171], v[96:99]
  v_mfma_f32_16x16x32_bf16 v[100:103], a[48:51], v[172:175], v[100:103]
  ds_read_b128 v[204:207], v19 offset:6144
  v_mfma_f32_16x16x32_bf16 v[104:107], a[52:55], v[172:175], v[104:107]
  v_mfma_f32_16x16x32_bf16 v[108:111], a[56:59], v[172:175], v[108:111]
  s_waitcnt vmcnt(44) lgkmcnt(2)
  s_barrier
  v_mfma_f32_16x16x32_bf16 v[64:67], a[60:63], v[192:195], v[64:67]
  ds_read_b128 v[160:163], v18 offset:0
  v_mfma_f32_16x16x32_bf16 v[68:71], a[64:67], v[192:195], v[68:71]
  v_mfma_f32_16x16x32_bf16 v[72:75], a[68:71], v[192:195], v[72:75]
  v_add_u32 v19, s33, v15
  s_add_u32 s33, s33, 8192
  v_mfma_f32_16x16x32_bf16 v[76:79], a[60:63], v[196:199], v[76:79]
  ds_read_b128 v[164:167], v18 offset:2048
  v_mfma_f32_16x16x32_bf16 v[80:83], a[64:67], v[196:199], v[80:83]
  buffer_load_dwordx4 v10, s[8:11], s30 offen offset:0 lds
  v_mfma_f32_16x16x32_bf16 v[84:87], a[68:71], v[196:199], v[84:87]
  s_waitcnt lgkmcnt(2)
  v_mfma_f32_16x16x32_bf16 v[88:91], a[60:63], v[200:203], v[88:91]
  ds_read_b128 v[168:171], v18 offset:4096
  v_mfma_f32_16x16x32_bf16 v[92:95], a[64:67], v[200:203], v[92:95]
  s_cmp_lt_u32 s33, 155648
  s_cselect_b32 s33, s33, 98304
  v_mfma_f32_16x16x32_bf16 v[96:99], a[68:71], v[200:203], v[96:99]
  v_mfma_f32_16x16x32_bf16 v[100:103], a[60:63], v[204:207], v[100:103]
  ds_read_b128 v[172:175], v18 offset:6144
  v_mfma_f32_16x16x32_bf16 v[104:107], a[64:67], v[204:207], v[104:107]
  v_mfma_f32_16x16x32_bf16 v[108:111], a[68:71], v[204:207], v[108:111]
  s_waitcnt lgkmcnt(2)
  v_mfma_f32_16x16x32_bf16 v[64:67], a[72:75], v[160:163], v[64:67]
  ds_read_b128 v[192:195], v19 offset:0
  v_mfma_f32_16x16x32_bf16 v[68:71], a[76:79], v[160:163], v[68:71]
  v_add_u32 v18, s33, v14
  v_mfma_f32_16x16x32_bf16 v[72:75], a[80:83], v[160:163], v[72:75]
  v_mfma_f32_16x16x32_bf16 v[76:79], a[72:75], v[164:167], v[76:79]
  ds_read_b128 v[196:199], v19 offset:2048
  v_mfma_f32_16x16x32_bf16 v[80:83], a[76:79], v[164:167], v[80:83]
  buffer_load_dwordx4 v11, s[8:11], s30 offen offset:1024 lds
  v_mfma_f32_16x16x32_bf16 v[84:87], a[80:83], v[164:167], v[84:87]
  s_waitcnt lgkmcnt(2)
  s_add_u32 s30, s30, 128
  v_mfma_f32_16x16x32_bf16 v[88:91], a[72:75], v[168:171], v[88:91]
  ds_read_b128 v[200:203], v19 offset:4096
  s_add_u32 m0, m0, 8192
  v_mfma_f32_16x16x32_bf16 v[92:95], a[76:79], v[168:171], v[92:95]
  s_cmp_lt_u32 m0, s46
  s_cselect_b32 m0, m0, s47
  v_mfma_f32_16x16x32_bf16 v[96:99], a[80:83], v[168:171], v[96:99]
  v_mfma_f32_16x16x32_bf16 v[100:103], a[72:75], v[172:175], v[100:103]
  ds_read_b128 v[204:207], v19 offset:6144
  v_mfma_f32_16x16x32_bf16 v[104:107], a[76:79], v[172:175], v[104:107]
  v_mfma_f32_16x16x32_bf16 v[108:111], a[80:83], v[172:175], v[108:111]
  s_waitcnt vmcnt(44) lgkmcnt(2)
  s_barrier
  v_mfma_f32_16x16x32_bf16 v[64:67], a[84:87], v[192:195], v[64:67]
  ds_read_b128 v[160:163], v18 offset:0
  v_mfma_f32_16x16x32_bf16 v[68:71], a[88:91], v[192:195], v[68:71]
  v_mfma_f32_16x16x32_bf16 v[72:75], a[92:95], v[192:195], v[72:75]
  v_add_u32 v19, s33, v15
  s_add_u32 s33, s33, 8192
  v_mfma_f32_16x16x32_bf16 v[76:79], a[84:87], v[196:199], v[76:79]
  ds_read_b128 v[164:167], v18 offset:2048
  v_mfma_f32_16x16x32_bf16 v[80:83], a[88:91], v[196:199], v[80:83]
  buffer_load_dwordx4 v10, s[8:11], s30 offen offset:0 lds
  v_mfma_f32_16x16x32_bf16 v[84:87], a[92:95], v[196:199], v[84:87]
  s_waitcnt lgkmcnt(2)
  v_mfma_f32_16x16x32_bf16 v[88:91], a[84:87], v[200:203], v[88:91]
  ds_read_b128 v[168:171], v18 offset:4096
  v_mfma_f32_16x16x32_bf16 v[92:95], a[88:91], v[200:203], v[92:95]
  s_cmp_lt_u32 s33, 155648
  s_cselect_b32 s33, s33, 98304
  v_mfma_f32_16x16x32_bf16 v[96:99], a[92:95], v[200:203], v[96:99]
  v_mfma_f32_16x16x32_bf16 v[100:103], a[84:87], v[204:207], v[100:103]
  ds_read_b128 v[172:175], v18 offset:6144
  v_mfma_f32_16x16x32_bf16 v[104:107], a[88:91], v[204:207], v[104:107]
  v_mfma_f32_16x16x32_bf16 v[108:111], a[92:95], v[204:207], v[108:111]
  s_waitcnt lgkmcnt(2)
  s_waitcnt vmcnt(20)
  s_barrier
  ds_read_b64_tr_b16 a[96:97], v46 offset:0
  ds_read_b64_tr_b16 a[98:99], v46 offset:1536
  ds_read_b64_tr_b16 a[100:101], v47 offset:0
  ds_read_b64_tr_b16 a[102:103], v47 offset:1536
  ds_read_b64_tr_b16 a[104:105], v48 offset:0
  ds_read_b64_tr_b16 a[106:107], v48 offset:1536
  ds_read_b64_tr_b16 a[108:109], v46 offset:12288
  ds_read_b64_tr_b16 a[110:111], v46 offset:13824
  ds_read_b64_tr_b16 a[112:113], v47 offset:12288
  ds_read_b64_tr_b16 a[114:115], v47 offset:13824
  ds_read_b64_tr_b16 a[116:117], v48 offset:12288
  ds_read_b64_tr_b16 a[118:119], v48 offset:13824
  ds_read_b64_tr_b16 a[120:121], v46 offset:24576
  ds_read_b64_tr_b16 a[122:123], v46 offset:26112
  ds_read_b64_tr_b16 a[124:125], v47 offset:24576
  ds_read_b64_tr_b16 a[126:127], v47 offset:26112
  ds_read_b64_tr_b16 a[128:129], v48 offset:24576
  ds_read_b64_tr_b16 a[130:131], v48 offset:26112
  ds_read_b64_tr_b16 a[132:133], v46 offset:36864
  ds_read_b64_tr_b16 a[134:135], v46 offset:38400
  ds_read_b64_tr_b16 a[136:137], v47 offset:36864
  ds_read_b64_tr_b16 a[138:139], v47 offset:38400
  ds_read_b64_tr_b16 a[140:141], v48 offset:36864
  ds_read_b64_tr_b16 a[142:143], v48 offset:38400
  s_waitcnt lgkmcnt(0)
  s_barrier
  s_mov_b32 s23, m0
  s_mul_i32 s21, s20, 393216
  s_add_u32 s21, s21, 6291456
  s_add_u32 s21, s21, s44
  s_mul_i32 s22, s20, 12288
  s_add_u32 s22, s22, 0
  s_add_u32 m0, s22, 0
  s_nop 0
  buffer_load_dwordx4 v40, s[12:15], s21 offen lds
  s_add_u32 m0, s22, 1024
  s_nop 0
  buffer_load_dwordx4 v41, s[12:15], s21 offen lds
  s_add_u32 m0, s22, 2048
  s_nop 0
  buffer_load_dwordx4 v42, s[12:15], s21 offen lds
  s_mul_i32 s21, s20, 393216
  s_add_u32 s21, s21, 6389760
  s_add_u32 s21, s21, s44
  s_mul_i32 s22, s20, 12288
  s_add_u32 s22, s22, 3072
  s_add_u32 m0, s22, 0
  s_nop 0
  buffer_load_dwordx4 v43, s[12:15], s21 offen lds
  s_add_u32 m0, s22, 1024
  s_nop 0
  buffer_load_dwordx4 v44, s[12:15], s21 offen lds
  s_add_u32 m0, s22, 2048
  s_nop 0
  buffer_load_dwordx4 v45, s[12:15], s21 offen lds
  s_mul_i32 s21, s20, 393216
  s_add_u32 s21, s21, 6488064
  s_add_u32 s21, s21, s44
  s_mul_i32 s22, s20, 12288
  s_add_u32 s22, s22, 6144
  s_add_u32 m0, s22, 0
  s_nop 0
  buffer_load_dwordx4 v40, s[12:15], s21 offen lds
  s_add_u32 m0, s22, 1024
  s_nop 0
  buffer_load_dwordx4 v41, s[12:15], s21 offen lds
  s_add_u32 m0, s22, 2048
  s_nop 0
  buffer_load_dwordx4 v42, s[12:15], s21 offen lds
  s_mul_i32 s21, s20, 393216
  s_add_u32 s21, s21, 6586368
  s_add_u32 s21, s21, s44
  s_mul_i32 s22, s20, 12288
  s_add_u32 s22, s22, 9216
  s_add_u32 m0, s22, 0
  s_nop 0
  buffer_load_dwordx4 v43, s[12:15], s21 offen lds
  s_add_u32 m0, s22, 1024
  s_nop 0
  buffer_load_dwordx4 v44, s[12:15], s21 offen lds
  s_add_u32 m0, s22, 2048
  s_nop 0
  buffer_load_dwordx4 v45, s[12:15], s21 offen lds
  s_mov_b32 m0, s23
  v_mov_b32 v29, 76
  buffer_load_dword v29, v29, s[64:67], 0 offen sc1
  v_mfma_f32_16x16x32_bf16 v[64:67], a[96:99], v[160:163], v[64:67]
  ds_read_b128 v[192:195], v19 offset:0
  v_mfma_f32_16x16x32_bf16 v[68:71], a[100:103], v[160:163], v[68:71]
  v_add_u32 v18, s33, v14
  s_mov_b32 s61, s60
  v_mfma_f32_16x16x32_bf16 v[72:75], a[104:107], v[160:163], v[72:75]
  s_add_u32 s60, s60, s62
  s_lshr_b32 s48, s20, 1
  v_mfma_f32_16x16x32_bf16 v[76:79], a[96:99], v[164:167], v[76:79]
  ds_read_b128 v[196:199], v19 offset:2048
  s_mul_i32 s48, s48, 393216
  v_mfma_f32_16x16x32_bf16 v[80:83], a[100:103], v[164:167], v[80:83]
  buffer_load_dwordx4 v11, s[8:11], s30 offen offset:1024 lds
  v_mfma_f32_16x16x32_bf16 v[84:87], a[104:107], v[164:167], v[84:87]
  s_add_u32 s30, s30, s25
  v_mfma_f32_16x16x32_bf16 v[88:91], a[96:99], v[168:171], v[88:91]
  ds_read_b128 v[200:203], v19 offset:4096
  s_sub_u32 s30, s30, 1152
  v_mfma_f32_16x16x32_bf16 v[92:95], a[100:103], v[168:171], v[92:95]
  s_add_u32 m0, m0, 8192
  s_and_b32 s21, s20, 1
  v_mfma_f32_16x16x32_bf16 v[96:99], a[104:107], v[168:171], v[96:99]
  s_cmp_lt_u32 m0, s46
  s_cselect_b32 m0, m0, s47
  v_mfma_f32_16x16x32_bf16 v[100:103], a[96:99], v[172:175], v[100:103]
  ds_read_b128 v[204:207], v19 offset:6144
  s_mul_i32 s21, s21, 6144
  v_mfma_f32_16x16x32_bf16 v[104:107], a[100:103], v[172:175], v[104:107]
  s_add_u32 s48, s48, s21
  s_add_u32 s48, s48, s27
  v_mfma_f32_16x16x32_bf16 v[108:111], a[104:107], v[172:175], v[108:111]
  s_waitcnt vmcnt(33) lgkmcnt(2)
  s_barrier
  v_mfma_f32_16x16x32_bf16 v[64:67], a[108:111], v[192:195], v[64:67]
  ds_read_b128 v[160:163], v18 offset:0
  s_add_u32 s27, s27, s28
  v_mfma_f32_16x16x32_bf16 v[68:71], a[112:115], v[192:195], v[68:71]
  s_sub_u32 s26, s26, 1
  v_mfma_f32_16x16x32_bf16 v[72:75], a[116:119], v[192:195], v[72:75]
  v_add_u32 v19, s33, v15
  s_add_u32 s33, s33, 8192
  v_mfma_f32_16x16x32_bf16 v[76:79], a[108:111], v[196:199], v[76:79]
  ds_read_b128 v[164:167], v18 offset:2048
  v_mfma_f32_16x16x32_bf16 v[80:83], a[112:115], v[196:199], v[80:83]
  buffer_load_dwordx4 v10, s[8:11], s30 offen offset:0 lds
  v_mfma_f32_16x16x32_bf16 v[84:87], a[116:119], v[196:199], v[84:87]
  s_waitcnt lgkmcnt(2)
  v_mfma_f32_16x16x32_bf16 v[88:91], a[108:111], v[200:203], v[88:91]
  ds_read_b128 v[168:171], v18 offset:4096
  v_mfma_f32_16x16x32_bf16 v[92:95], a[112:115], v[200:203], v[92:95]
  s_cmp_lt_u32 s33, 155648
  s_cselect_b32 s33, s33, 98304
  v_mfma_f32_16x16x32_bf16 v[96:99], a[116:119], v[200:203], v[96:99]
  v_mfma_f32_16x16x32_bf16 v[100:103], a[108:111], v[204:207], v[100:103]
  ds_read_b128 v[172:175], v18 offset:6144
  v_mfma_f32_16x16x32_bf16 v[104:107], a[112:115], v[204:207], v[104:107]
  v_mfma_f32_16x16x32_bf16 v[108:111], a[116:119], v[204:207], v[108:111]
  s_waitcnt lgkmcnt(2)
  v_mfma_f32_16x16x32_bf16 v[64:67], a[120:123], v[160:163], v[64:67]
  ds_read_b128 v[192:195], v19 offset:0
  v_mfma_f32_16x16x32_bf16 v[68:71], a[124:127], v[160:163], v[68:71]
  v_add_u32 v18, s33, v14
  v_mfma_f32_16x16x32_bf16 v[72:75], a[128:131], v[160:163], v[72:75]
  v_mfma_f32_16x16x32_bf16 v[76:79], a[120:123], v[164:167], v[76:79]
  ds_read_b128 v[196:199], v19 offset:2048
  v_mfma_f32_16x16x32_bf16 v[80:83], a[124:127], v[164:167], v[80:83]
  buffer_load_dwordx4 v11, s[8:11], s30 offen offset:1024 lds
  v_mfma_f32_16x16x32_bf16 v[84:87], a[128:131], v[164:167], v[84:87]
  s_waitcnt lgkmcnt(2)
  s_add_u32 s30, s30, 128
  v_mfma_f32_16x16x32_bf16 v[88:91], a[120:123], v[168:171], v[88:91]
  ds_read_b128 v[200:203], v19 offset:4096
  s_add_u32 m0, m0, 8192
  v_mfma_f32_16x16x32_bf16 v[92:95], a[124:127], v[168:171], v[92:95]
  s_cmp_lt_u32 m0, s46
  s_cselect_b32 m0, m0, s47
  v_mfma_f32_16x16x32_bf16 v[96:99], a[128:131], v[168:171], v[96:99]
  v_mfma_f32_16x16x32_bf16 v[100:103], a[120:123], v[172:175], v[100:103]
  ds_read_b128 v[204:207], v19 offset:6144
  v_mfma_f32_16x16x32_bf16 v[104:107], a[124:127], v[172:175], v[104:107]
  v_mfma_f32_16x16x32_bf16 v[108:111], a[128:131], v[172:175], v[108:111]
  s_waitcnt vmcnt(33) lgkmcnt(2)
  s_barrier
  v_mfma_f32_16x16x32_bf16 v[64:67], a[132:135], v[192:195], v[64:67]
  ds_read_b128 v[160:163], v18 offset:0
  v_mfma_f32_16x16x32_bf16 v[68:71], a[136:139], v[192:195], v[68:71]
  v_mfma_f32_16x16x32_bf16 v[72:75], a[140:143], v[192:195], v[72:75]
  v_add_u32 v19, s33, v15
  s_add_u32 s33, s33, 8192
  v_mfma_f32_16x16x32_bf16 v[76:79], a[132:135], v[196:199], v[76:79]
  ds_read_b128 v[164:167], v18 offset:2048
  v_mfma_f32_16x16x32_bf16 v[80:83], a[136:139], v[196:199], v[80:83]
  buffer_load_dwordx4 v10, s[8:11], s30 offen offset:0 lds
  v_mfma_f32_16x16x32_bf16 v[84:87], a[140:143], v[196:199], v[84:87]
  s_waitcnt lgkmcnt(2)
  v_mfma_f32_16x16x32_bf16 v[88:91], a[132:135], v[200:203], v[88:91]
  ds_read_b128 v[168:171], v18 offset:4096
  v_mfma_f32_16x16x32_bf16 v[92:95], a[136:139], v[200:203], v[92:95]
  s_cmp_lt_u32 s33, 155648
  s_cselect_b32 s33, s33, 98304
  v_mfma_f32_16x16x32_bf16 v[96:99], a[140:143], v[200:203], v[96:99]
  v_mfma_f32_16x16x32_bf16 v[100:103], a[132:135], v[204:207], v[100:103]
  ds_read_b128 v[172:175], v18 offset:6144
  v_mfma_f32_16x16x32_bf16 v[104:107], a[136:139], v[204:207], v[104:107]
  v_mfma_f32_16x16x32_bf16 v[108:111], a[140:143], v[204:207], v[108:111]
  s_waitcnt lgkmcnt(2)
  s_waitcnt vmcnt(21)
  s_barrier
  ds_read_b64_tr_b16 a[144:145], v49 offset:0
  ds_read_b64_tr_b16 a[146:147], v49 offset:1536
  ds_read_b64_tr_b16 a[148:149], v50 offset:0
  ds_read_b64_tr_b16 a[150:151], v50 offset:1536
  ds_read_b64_tr_b16 a[152:153], v51 offset:0
  ds_read_b64_tr_b16 a[154:155], v51 offset:1536
  ds_read_b64_tr_b16 a[156:157], v49 offset:12288
  ds_read_b64_tr_b16 a[158:159], v49 offset:13824
  ds_read_b64_tr_b16 a[160:161], v50 offset:12288
  ds_read_b64_tr_b16 a[162:163], v50 offset:13824
  ds_read_b64_tr_b16 a[164:165], v51 offset:12288
  ds_read_b64_tr_b16 a[166:167], v51 offset:13824
  ds_read_b64_tr_b16 a[168:169], v49 offset:24576
  ds_read_b64_tr_b16 a[170:171], v49 offset:26112
  ds_read_b64_tr_b16 a[172:173], v50 offset:24576
  ds_read_b64_tr_b16 a[174:175], v50 offset:26112
  ds_read_b64_tr_b16 a[176:177], v51 offset:24576
  ds_read_b64_tr_b16 a[178:179], v51 offset:26112
  ds_read_b64_tr_b16 a[180:181], v49 offset:36864
  ds_read_b64_tr_b16 a[182:183], v49 offset:38400
  ds_read_b64_tr_b16 a[184:185], v50 offset:36864
  ds_read_b64_tr_b16 a[186:187], v50 offset:38400
  ds_read_b64_tr_b16 a[188:189], v51 offset:36864
  ds_read_b64_tr_b16 a[190:191], v51 offset:38400
  s_waitcnt lgkmcnt(0)
  s_barrier
  v_mfma_f32_16x16x32_bf16 v[64:67], a[144:147], v[160:163], v[64:67]
  ds_read_b128 v[192:195], v19 offset:0
  v_mfma_f32_16x16x32_bf16 v[68:71], a[148:151], v[160:163], v[68:71]
  v_add_u32 v18, s33, v14
  v_mfma_f32_16x16x32_bf16 v[72:75], a[152:155], v[160:163], v[72:75]
  v_mfma_f32_16x16x32_bf16 v[76:79], a[144:147], v[164:167], v[76:79]
  ds_read_b128 v[196:199], v19 offset:2048
  v_mfma_f32_16x16x32_bf16 v[80:83], a[148:151], v[164:167], v[80:83]
  buffer_load_dwordx4 v11, s[8:11], s30 offen offset:1024 lds
  v_mfma_f32_16x16x32_bf16 v[84:87], a[152:155], v[164:167], v[84:87]
  s_add_u32 s30, s30, 128
  v_mfma_f32_16x16x32_bf16 v[88:91], a[144:147], v[168:171], v[88:91]
  ds_read_b128 v[200:203], v19 offset:4096
  s_add_u32 m0, m0, 8192
  v_mfma_f32_16x16x32_bf16 v[92:95], a[148:151], v[168:171], v[92:95]
  s_cmp_lt_u32 m0, s46
  s_cselect_b32 m0, m0, s47
  v_mfma_f32_16x16x32_bf16 v[96:99], a[152:155], v[168:171], v[96:99]
  v_mfma_f32_16x16x32_bf16 v[100:103], a[144:147], v[172:175], v[100:103]
  ds_read_b128 v[204:207], v19 offset:6144
  v_mfma_f32_16x16x32_bf16 v[104:107], a[148:151], v[172:175], v[104:107]
  v_mfma_f32_16x16x32_bf16 v[108:111], a[152:155], v[172:175], v[108:111]
  s_waitcnt vmcnt(21) lgkmcnt(2)
  s_barrier
  v_mfma_f32_16x16x32_bf16 v[64:67], a[156:159], v[192:195], v[64:67]
  ds_read_b128 v[160:163], v18 offset:0
  v_mfma_f32_16x16x32_bf16 v[68:71], a[160:163], v[192:195], v[68:71]
  v_mfma_f32_16x16x32_bf16 v[72:75], a[164:167], v[192:195], v[72:75]
  v_add_u32 v19, s33, v15
  s_add_u32 s33, s33, 8192
  v_mfma_f32_16x16x32_bf16 v[76:79], a[156:159], v[196:199], v[76:79]
  ds_read_b128 v[164:167], v18 offset:2048
  v_mfma_f32_16x16x32_bf16 v[80:83], a[160:163], v[196:199], v[80:83]
  buffer_load_dwordx4 v10, s[8:11], s30 offen offset:0 lds
  v_mfma_f32_16x16x32_bf16 v[84:87], a[164:167], v[196:199], v[84:87]
  s_waitcnt lgkmcnt(2)
  v_mfma_f32_16x16x32_bf16 v[88:91], a[156:159], v[200:203], v[88:91]
  ds_read_b128 v[168:171], v18 offset:4096
  v_mfma_f32_16x16x32_bf16 v[92:95], a[160:163], v[200:203], v[92:95]
  s_cmp_lt_u32 s33, 155648
  s_cselect_b32 s33, s33, 98304
  v_mfma_f32_16x16x32_bf16 v[96:99], a[164:167], v[200:203], v[96:99]
  v_mfma_f32_16x16x32_bf16 v[100:103], a[156:159], v[204:207], v[100:103]
  ds_read_b128 v[172:175], v18 offset:6144
  v_mfma_f32_16x16x32_bf16 v[104:107], a[160:163], v[204:207], v[104:107]
  v_mfma_f32_16x16x32_bf16 v[108:111], a[164:167], v[204:207], v[108:111]
  s_waitcnt lgkmcnt(2)
  v_mfma_f32_16x16x32_bf16 v[64:67], a[168:171], v[160:163], v[64:67]
  ds_read_b128 v[192:195], v19 offset:0
  v_mfma_f32_16x16x32_bf16 v[68:71], a[172:175], v[160:163], v[68:71]
  v_add_u32 v18, s33, v14
  v_mfma_f32_16x16x32_bf16 v[72:75], a[176:179], v[160:163], v[72:75]
  v_mfma_f32_16x16x32_bf16 v[76:79], a[168:171], v[164:167], v[76:79]
  ds_read_b128 v[196:199], v19 offset:2048
  v_mfma_f32_16x16x32_bf16 v[80:83], a[172:175], v[164:167], v[80:83]
  buffer_load_dwordx4 v11, s[8:11], s30 offen offset:1024 lds
  v_mfma_f32_16x16x32_bf16 v[84:87], a[176:179], v[164:167], v[84:87]
  s_waitcnt lgkmcnt(2)
  s_add_u32 s30, s30, 128
  v_mfma_f32_16x16x32_bf16 v[88:91], a[168:171], v[168:171], v[88:91]
  ds_read_b128 v[200:203], v19 offset:4096
  s_add_u32 m0, m0, 8192
  v_mfma_f32_16x16x32_bf16 v[92:95], a[172:175], v[168:171], v[92:95]
  s_cmp_lt_u32 m0, s46
  s_cselect_b32 m0, m0, s47
  v_mfma_f32_16x16x32_bf16 v[96:99], a[176:179], v[168:171], v[96:99]
  v_mfma_f32_16x16x32_bf16 v[100:103], a[168:171], v[172:175], v[100:103]
  ds_read_b128 v[204:207], v19 offset:6144
  v_mfma_f32_16x16x32_bf16 v[104:107], a[172:175], v[172:175], v[104:107]
  v_mfma_f32_16x16x32_bf16 v[108:111], a[176:179], v[172:175], v[108:111]
  s_waitcnt vmcnt(21) lgkmcnt(2)
  s_barrier
  v_mfma_f32_16x16x32_bf16 v[64:67], a[180:183], v[192:195], v[64:67]
  ds_read_b128 v[160:163], v18 offset:0
  v_mfma_f32_16x16x32_bf16 v[68:71], a[184:187], v[192:195], v[68:71]
  v_mfma_f32_16x16x32_bf16 v[72:75], a[188:191], v[192:195], v[72:75]
  v_add_u32 v19, s33, v15
  s_add_u32 s33, s33, 8192
  v_mfma_f32_16x16x32_bf16 v[76:79], a[180:183], v[196:199], v[76:79]
  ds_read_b128 v[164:167], v18 offset:2048
  v_mfma_f32_16x16x32_bf16 v[80:83], a[184:187], v[196:199], v[80:83]
  buffer_load_dwordx4 v10, s[8:11], s30 offen offset:0 lds
  v_mfma_f32_16x16x32_bf16 v[84:87], a[188:191], v[196:199], v[84:87]
  s_waitcnt lgkmcnt(2)
  v_mfma_f32_16x16x32_bf16 v[88:91], a[180:183], v[200:203], v[88:91]
  ds_read_b128 v[168:171], v18 offset:4096
  v_mfma_f32_16x16x32_bf16 v[92:95], a[184:187], v[200:203], v[92:95]
  s_cmp_lt_u32 s33, 155648
  s_cselect_b32 s33, s33, 98304
  v_mfma_f32_16x16x32_bf16 v[96:99], a[188:191], v[200:203], v[96:99]
  v_mfma_f32_16x16x32_bf16 v[100:103], a[180:183], v[204:207], v[100:103]
  ds_read_b128 v[172:175], v18 offset:6144
  v_mfma_f32_16x16x32_bf16 v[104:107], a[184:187], v[204:207], v[104:107]
  v_mfma_f32_16x16x32_bf16 v[108:111], a[188:191], v[204:207], v[108:111]
  s_waitcnt lgkmcnt(2)
  s_waitcnt vmcnt(9)
  s_barrier
  ds_read_b64_tr_b16 a[192:193], v46 offset:0
  ds_read_b64_tr_b16 a[194:195], v46 offset:1536
  ds_read_b64_tr_b16 a[196:197], v47 offset:0
  ds_read_b64_tr_b16 a[198:199], v47 offset:1536
  ds_read_b64_tr_b16 a[200:201], v48 offset:0
  ds_read_b64_tr_b16 a[202:203], v48 offset:1536
  ds_read_b64_tr_b16 a[204:205], v46 offset:12288
  ds_read_b64_tr_b16 a[206:207], v46 offset:13824
  ds_read_b64_tr_b16 a[208:209], v47 offset:12288
  ds_read_b64_tr_b16 a[210:211], v47 offset:13824
  ds_read_b64_tr_b16 a[212:213], v48 offset:12288
  ds_read_b64_tr_b16 a[214:215], v48 offset:13824
  ds_read_b64_tr_b16 a[216:217], v46 offset:24576
  ds_read_b64_tr_b16 a[218:219], v46 offset:26112
  ds_read_b64_tr_b16 a[220:221], v47 offset:24576
  ds_read_b64_tr_b16 a[222:223], v47 offset:26112
  ds_read_b64_tr_b16 a[224:225], v48 offset:24576
  ds_read_b64_tr_b16 a[226:227], v48 offset:26112
  ds_read_b64_tr_b16 a[228:229], v46 offset:36864
  ds_read_b64_tr_b16 a[230:231], v46 offset:38400
  ds_read_b64_tr_b16 a[232:233], v47 offset:36864
  ds_read_b64_tr_b16 a[234:235], v47 offset:38400
  ds_read_b64_tr_b16 a[236:237], v48 offset:36864
  ds_read_b64_tr_b16 a[238:239], v48 offset:38400
  s_waitcnt lgkmcnt(0)
  s_barrier
  v_mfma_f32_16x16x32_bf16 v[64:67], a[192:195], v[160:163], v[64:67]
  ds_read_b128 v[192:195], v19 offset:0
  v_mfma_f32_16x16x32_bf16 v[68:71], a[196:199], v[160:163], v[68:71]
  v_add_u32 v18, s33, v14
  v_mfma_f32_16x16x32_bf16 v[72:75], a[200:203], v[160:163], v[72:75]
  v_mfma_f32_16x16x32_bf16 v[76:79], a[192:195], v[164:167], v[76:79]
  ds_read_b128 v[196:199], v19 offset:2048
  v_mfma_f32_16x16x32_bf16 v[80:83], a[196:199], v[164:167], v[80:83]
  buffer_load_dwordx4 v11, s[8:11], s30 offen offset:1024 lds
  v_mfma_f32_16x16x32_bf16 v[84:87], a[200:203], v[164:167], v[84:87]
  s_add_u32 s30, s30, 128
  v_mfma_f32_16x16x32_bf16 v[88:91], a[192:195], v[168:171], v[88:91]
  ds_read_b128 v[200:203], v19 offset:4096
  s_add_u32 m0, m0, 8192
  v_mfma_f32_16x16x32_bf16 v[92:95], a[196:199], v[168:171], v[92:95]
  s_cmp_lt_u32 m0, s46
  s_cselect_b32 m0, m0, s47
  v_mfma_f32_16x16x32_bf16 v[96:99], a[200:203], v[168:171], v[96:99]
  v_mfma_f32_16x16x32_bf16 v[100:103], a[192:195], v[172:175], v[100:103]
  ds_read_b128 v[204:207], v19 offset:6144
  v_mfma_f32_16x16x32_bf16 v[104:107], a[196:199], v[172:175], v[104:107]
  v_mfma_f32_16x16x32_bf16 v[108:111], a[200:203], v[172:175], v[108:111]
  s_waitcnt vmcnt(8) lgkmcnt(2)
  s_barrier
  v_mfma_f32_16x16x32_bf16 v[64:67], a[204:207], v[192:195], v[64:67]
  ds_read_b128 v[160:163], v18 offset:0
  v_mfma_f32_16x16x32_bf16 v[68:71], a[208:211], v[192:195], v[68:71]
  v_mfma_f32_16x16x32_bf16 v[72:75], a[212:215], v[192:195], v[72:75]
  v_add_u32 v19, s33, v15
  s_add_u32 s33, s33, 8192
  v_mfma_f32_16x16x32_bf16 v[76:79], a[204:207], v[196:199], v[76:79]
  ds_read_b128 v[164:167], v18 offset:2048
  v_mfma_f32_16x16x32_bf16 v[80:83], a[208:211], v[196:199], v[80:83]
  buffer_load_dwordx4 v10, s[8:11], s30 offen offset:0 lds
  v_mfma_f32_16x16x32_bf16 v[84:87], a[212:215], v[196:199], v[84:87]
  s_waitcnt lgkmcnt(2)
  v_mfma_f32_16x16x32_bf16 v[88:91], a[204:207], v[200:203], v[88:91]
  ds_read_b128 v[168:171], v18 offset:4096
  v_mfma_f32_16x16x32_bf16 v[92:95], a[208:211], v[200:203], v[92:95]
  s_cmp_lt_u32 s33, 155648
  s_cselect_b32 s33, s33, 98304
  v_mfma_f32_16x16x32_bf16 v[96:99], a[212:215], v[200:203], v[96:99]
  v_mfma_f32_16x16x32_bf16 v[100:103], a[204:207], v[204:207], v[100:103]
  ds_read_b128 v[172:175], v18 offset:6144
  v_mfma_f32_16x16x32_bf16 v[104:107], a[208:211], v[204:207], v[104:107]
  v_mfma_f32_16x16x32_bf16 v[108:111], a[212:215], v[204:207], v[108:111]
  s_waitcnt lgkmcnt(2)
  v_mfma_f32_16x16x32_bf16 v[64:67], a[216:219], v[160:163], v[64:67]
  ds_read_b128 v[192:195], v19 offset:0
  v_mfma_f32_16x16x32_bf16 v[68:71], a[220:223], v[160:163], v[68:71]
  v_add_u32 v18, s33, v14
  v_mfma_f32_16x16x32_bf16 v[72:75], a[224:227], v[160:163], v[72:75]
  v_mfma_f32_16x16x32_bf16 v[76:79], a[216:219], v[164:167], v[76:79]
  ds_read_b128 v[196:199], v19 offset:2048
  v_mfma_f32_16x16x32_bf16 v[80:83], a[220:223], v[164:167], v[80:83]
  buffer_load_dwordx4 v11, s[8:11], s30 offen offset:1024 lds
  v_mfma_f32_16x16x32_bf16 v[84:87], a[224:227], v[164:167], v[84:87]
  s_waitcnt lgkmcnt(2)
  s_add_u32 s30, s30, 128
  v_mfma_f32_16x16x32_bf16 v[88:91], a[216:219], v[168:171], v[88:91]
  ds_read_b128 v[200:203], v19 offset:4096
  s_add_u32 m0, m0, 8192
  v_mfma_f32_16x16x32_bf16 v[92:95], a[220:223], v[168:171], v[92:95]
  s_cmp_lt_u32 m0, s46
  s_cselect_b32 m0, m0, s47
  v_mfma_f32_16x16x32_bf16 v[96:99], a[224:227], v[168:171], v[96:99]
  v_mfma_f32_16x16x32_bf16 v[100:103], a[216:219], v[172:175], v[100:103]
  ds_read_b128 v[204:207], v19 offset:6144
  v_mfma_f32_16x16x32_bf16 v[104:107], a[220:223], v[172:175], v[104:107]
  v_mfma_f32_16x16x32_bf16 v[108:111], a[224:227], v[172:175], v[108:111]
  s_waitcnt vmcnt(8) lgkmcnt(2)
  s_barrier
  v_mfma_f32_16x16x32_bf16 v[64:67], a[228:231], v[192:195], v[64:67]
  ds_read_b128 v[160:163], v18 offset:0
  v_mfma_f32_16x16x32_bf16 v[68:71], a[232:235], v[192:195], v[68:71]
  v_mfma_f32_16x16x32_bf16 v[72:75], a[236:239], v[192:195], v[72:75]
  v_add_u32 v19, s33, v15
  s_add_u32 s33, s33, 8192
  v_mfma_f32_16x16x32_bf16 v[76:79], a[228:231], v[196:199], v[76:79]
  ds_read_b128 v[164:167], v18 offset:2048
  v_cvt_pk_bf16_f32 v224, v64, v65
  v_cvt_pk_bf16_f32 v225, v66, v67
  v_mfma_f32_16x16x32_bf16 v[80:83], a[232:235], v[196:199], v[80:83]
  buffer_load_dwordx4 v10, s[8:11], s30 offen offset:0 lds
  v_cvt_pk_bf16_f32 v226, v68, v69
  v_cvt_pk_bf16_f32 v227, v70, v71
  v_mfma_f32_16x16x32_bf16 v[84:87], a[236:239], v[196:199], v[84:87]
  s_waitcnt lgkmcnt(2)
  v_cvt_pk_bf16_f32 v228, v72, v73
  v_cvt_pk_bf16_f32 v229, v74, v75
  v_mfma_f32_16x16x32_bf16 v[88:91], a[228:231], v[200:203], v[88:91]
  ds_read_b128 v[168:171], v18 offset:4096
  ds_write_b64 v22, v[224:225] offset:0
  v_mfma_f32_16x16x32_bf16 v[92:95], a[232:235], v[200:203], v[92:95]
  s_cmp_lt_u32 s33, 155648
  s_cselect_b32 s33, s33, 98304
  ds_write_b64 v22, v[226:227] offset:8
  v_mfma_f32_16x16x32_bf16 v[96:99], a[236:239], v[200:203], v[96:99]
  ds_write_b64 v16, v[228:229] offset:64
  v_cvt_pk_bf16_f32 v230, v76, v77
  v_cvt_pk_bf16_f32 v231, v78, v79
  v_mfma_f32_16x16x32_bf16 v[100:103], a[228:231], v[204:207], v[100:103]
  ds_read_b128 v[172:175], v18 offset:6144
  v_cvt_pk_bf16_f32 v232, v80, v81
  v_cvt_pk_bf16_f32 v233, v82, v83
  v_cvt_pk_bf16_f32 v234, v84, v85
  v_mfma_f32_16x16x32_bf16 v[104:107], a[232:235], v[204:207], v[104:107]
  v_cvt_pk_bf16_f32 v235, v86, v87
  ds_write_b64 v22, v[230:231] offset:6400
  v_mfma_f32_16x16x32_bf16 v[108:111], a[236:239], v[204:207], v[108:111]
  ds_write_b64 v22, v[232:233] offset:6408
  ds_write_b64 v16, v[234:235] offset:6464
  v_readfirstlane_b32 s21, v29
  s_cmp_ge_u32 s21, 32
  s_cbranch_scc1 kvz_151
  s_mov_b32 s21, 76
  v_mov_b32 v4, 0
  s_mov_b32 s101, 0
wf_152:
  buffer_load_dword v5, v4, s[64:67], s21 offen sc1
  s_add_u32 s101, s101, 1
  s_cmp_gt_u32 s101, 131072
  s_cbranch_scc1 main_end
  s_waitcnt vmcnt(0)
  v_readfirstlane_b32 s100, v5
  s_cmp_ge_u32 s100, 32
  s_cbranch_scc1 wf_153
  s_sleep 8
  s_branch wf_152
wf_153:
kvz_151:
  s_branch kvm_end_150
kvm_blk_149:
  v_mfma_f32_16x16x32_bf16 v[64:67], a[0:3], v[160:163], 0
  ds_read_b128 v[192:195], v19 offset:0
  v_mfma_f32_16x16x32_bf16 v[68:71], a[4:7], v[160:163], 0
  v_add_u32 v18, s33, v14
  v_mfma_f32_16x16x32_bf16 v[72:75], a[8:11], v[160:163], 0
  v_mfma_f32_16x16x32_bf16 v[76:79], a[0:3], v[164:167], 0
  ds_read_b128 v[196:199], v19 offset:2048
  v_mfma_f32_16x16x32_bf16 v[80:83], a[4:7], v[164:167], 0
  buffer_load_dwordx4 v11, s[8:11], s30 offen offset:1024 lds
  v_mfma_f32_16x16x32_bf16 v[84:87], a[8:11], v[164:167], 0
  s_waitcnt lgkmcnt(11)
  s_add_u32 s30, s30, 128
  v_mfma_f32_16x16x32_bf16 v[88:91], a[0:3], v[168:171], 0
  ds_read_b128 v[200:203], v19 offset:4096
  s_add_u32 m0, m0, 8192
  v_mfma_f32_16x16x32_bf16 v[92:95], a[4:7], v[168:171], 0
  s_cmp_lt_u32 m0, s46
  s_cselect_b32 m0, m0, s47
  v_mfma_f32_16x16x32_bf16 v[96:99], a[8:11], v[168:171], 0
  v_mfma_f32_16x16x32_bf16 v[100:103], a[0:3], v[172:175], 0
  ds_read_b128 v[204:207], v19 offset:6144
  v_mfma_f32_16x16x32_bf16 v[104:107], a[4:7], v[172:175], 0
  v_mfma_f32_16x16x32_bf16 v[108:111], a[8:11], v[172:175], 0
  s_waitcnt vmcnt(14) lgkmcnt(2)
  s_barrier
  v_mfma_f32_16x16x32_bf16 v[64:67], a[12:15], v[192:195], v[64:67]
  ds_read_b128 v[160:163], v18 offset:0
  v_mfma_f32_16x16x32_bf16 v[68:71], a[16:19], v[192:195], v[68:71]
  v_mfma_f32_16x16x32_bf16 v[72:75], a[20:23], v[192:195], v[72:75]
  v_add_u32 v19, s33, v15
  s_add_u32 s33, s33, 8192
  v_mfma_f32_16x16x32_bf16 v[76:79], a[12:15], v[196:199], v[76:79]
  ds_read_b128 v[164:167], v18 offset:2048
  v_mfma_f32_16x16x32_bf16 v[80:83], a[16:19], v[196:199], v[80:83]
  buffer_load_dwordx4 v10, s[8:11], s30 offen offset:0 lds
  v_mfma_f32_16x16x32_bf16 v[84:87], a[20:23], v[196:199], v[84:87]
  s_waitcnt lgkmcnt(2)
  v_mfma_f32_16x16x32_bf16 v[88:91], a[12:15], v[200:203], v[88:91]
  ds_read_b128 v[168:171], v18 offset:4096
  v_mfma_f32_16x16x32_bf16 v[92:95], a[16:19], v[200:203], v[92:95]
  s_cmp_lt_u32 s33, 155648
  s_cselect_b32 s33, s33, 98304
  v_mfma_f32_16x16x32_bf16 v[96:99], a[20:23], v[200:203], v[96:99]
  v_mfma_f32_16x16x32_bf16 v[100:103], a[12:15], v[204:207], v[100:103]
  ds_read_b128 v[172:175], v18 offset:6144
  v_mfma_f32_16x16x32_bf16 v[104:107], a[16:19], v[204:207], v[104:107]
  v_mfma_f32_16x16x32_bf16 v[108:111], a[20:23], v[204:207], v[108:111]
  s_waitcnt lgkmcnt(2)
  v_mfma_f32_16x16x32_bf16 v[64:67], a[24:27], v[160:163], v[64:67]
  ds_read_b128 v[192:195], v19 offset:0
  v_mfma_f32_16x16x32_bf16 v[68:71], a[28:31], v[160:163], v[68:71]
  v_add_u32 v18, s33, v14
  v_mfma_f32_16x16x32_bf16 v[72:75], a[32:35], v[160:163], v[72:75]
  v_mfma_f32_16x16x32_bf16 v[76:79], a[24:27], v[164:167], v[76:79]
  ds_read_b128 v[196:199], v19 offset:2048
  v_mfma_f32_16x16x32_bf16 v[80:83], a[28:31], v[164:167], v[80:83]
  buffer_load_dwordx4 v11, s[8:11], s30 offen offset:1024 lds
  v_mfma_f32_16x16x32_bf16 v[84:87], a[32:35], v[164:167], v[84:87]
  s_waitcnt lgkmcnt(2)
  s_add_u32 s30, s30, 128
  v_mfma_f32_16x16x32_bf16 v[88:91], a[24:27], v[168:171], v[88:91]
  ds_read_b128 v[200:203], v19 offset:4096
  s_add_u32 m0, m0, 8192
  v_mfma_f32_16x16x32_bf16 v[92:95], a[28:31], v[168:171], v[92:95]
  s_cmp_lt_u32 m0, s46
  s_cselect_b32 m0, m0, s47
  v_mfma_f32_16x16x32_bf16 v[96:99], a[32:35], v[168:171], v[96:99]
  v_mfma_f32_16x16x32_bf16 v[100:103], a[24:27], v[172:175], v[100:103]
  ds_read_b128 v[204:207], v19 offset:6144
  v_mfma_f32_16x16x32_bf16 v[104:107], a[28:31], v[172:175], v[104:107]
  v_mfma_f32_16x16x32_bf16 v[108:111], a[32:35], v[172:175], v[108:111]
  s_waitcnt vmcnt(14) lgkmcnt(2)
  s_barrier
  v_mfma_f32_16x16x32_bf16 v[64:67], a[36:39], v[192:195], v[64:67]
  ds_read_b128 v[160:163], v18 offset:0
  v_mfma_f32_16x16x32_bf16 v[68:71], a[40:43], v[192:195], v[68:71]
  v_mfma_f32_16x16x32_bf16 v[72:75], a[44:47], v[192:195], v[72:75]
  v_add_u32 v19, s33, v15
  s_add_u32 s33, s33, 8192
  v_mfma_f32_16x16x32_bf16 v[76:79], a[36:39], v[196:199], v[76:79]
  ds_read_b128 v[164:167], v18 offset:2048
  v_mfma_f32_16x16x32_bf16 v[80:83], a[40:43], v[196:199], v[80:83]
  buffer_load_dwordx4 v10, s[8:11], s30 offen offset:0 lds
  v_mfma_f32_16x16x32_bf16 v[84:87], a[44:47], v[196:199], v[84:87]
  s_waitcnt lgkmcnt(2)
  v_mfma_f32_16x16x32_bf16 v[88:91], a[36:39], v[200:203], v[88:91]
  ds_read_b128 v[168:171], v18 offset:4096
  v_mfma_f32_16x16x32_bf16 v[92:95], a[40:43], v[200:203], v[92:95]
  s_cmp_lt_u32 s33, 155648
  s_cselect_b32 s33, s33, 98304
  v_mfma_f32_16x16x32_bf16 v[96:99], a[44:47], v[200:203], v[96:99]
  v_mfma_f32_16x16x32_bf16 v[100:103], a[36:39], v[204:207], v[100:103]
  ds_read_b128 v[172:175], v18 offset:6144
  v_mfma_f32_16x16x32_bf16 v[104:107], a[40:43], v[204:207], v[104:107]
  v_mfma_f32_16x16x32_bf16 v[108:111], a[44:47], v[204:207], v[108:111]
  s_waitcnt lgkmcnt(2)
  v_mfma_f32_16x16x32_bf16 v[64:67], a[48:51], v[160:163], v[64:67]
  ds_read_b128 v[192:195], v19 offset:0
  v_mfma_f32_16x16x32_bf16 v[68:71], a[52:55], v[160:163], v[68:71]
  v_add_u32 v18, s33, v14
  v_mfma_f32_16x16x32_bf16 v[72:75], a[56:59], v[160:163], v[72:75]
  v_mfma_f32_16x16x32_bf16 v[76:79], a[48:51], v[164:167], v[76:79]
  ds_read_b128 v[196:199], v19 offset:2048
  v_mfma_f32_16x16x32_bf16 v[80:83], a[52:55], v[164:167], v[80:83]
  buffer_load_dwordx4 v11, s[8:11], s30 offen offset:1024 lds
  v_mfma_f32_16x16x32_bf16 v[84:87], a[56:59], v[164:167], v[84:87]
  s_waitcnt lgkmcnt(2)
  s_add_u32 s30, s30, 128
  v_mfma_f32_16x16x32_bf16 v[88:91], a[48:51], v[168:171], v[88:91]
  ds_read_b128 v[200:203], v19 offset:4096
  s_add_u32 m0, m0, 8192
  v_mfma_f32_16x16x32_bf16 v[92:95], a[52:55], v[168:171], v[92:95]
  s_cmp_lt_u32 m0, s46
  s_cselect_b32 m0, m0, s47
  v_mfma_f32_16x16x32_bf16 v[96:99], a[56:59], v[168:171], v[96:99]
  v_mfma_f32_16x16x32_bf16 v[100:103], a[48:51], v[172:175], v[100:103]
  ds_read_b128 v[204:207], v19 offset:6144
  v_mfma_f32_16x16x32_bf16 v[104:107], a[52:55], v[172:175], v[104:107]
  v_mfma_f32_16x16x32_bf16 v[108:111], a[56:59], v[172:175], v[108:111]
  s_waitcnt vmcnt(14) lgkmcnt(2)
  s_barrier
  v_mfma_f32_16x16x32_bf16 v[64:67], a[60:63], v[192:195], v[64:67]
  ds_read_b128 v[160:163], v18 offset:0
  v_mfma_f32_16x16x32_bf16 v[68:71], a[64:67], v[192:195], v[68:71]
  v_mfma_f32_16x16x32_bf16 v[72:75], a[68:71], v[192:195], v[72:75]
  v_add_u32 v19, s33, v15
  s_add_u32 s33, s33, 8192
  v_mfma_f32_16x16x32_bf16 v[76:79], a[60:63], v[196:199], v[76:79]
  ds_read_b128 v[164:167], v18 offset:2048
  v_mfma_f32_16x16x32_bf16 v[80:83], a[64:67], v[196:199], v[80:83]
  buffer_load_dwordx4 v10, s[8:11], s30 offen offset:0 lds
  v_mfma_f32_16x16x32_bf16 v[84:87], a[68:71], v[196:199], v[84:87]
  s_waitcnt lgkmcnt(2)
  v_mfma_f32_16x16x32_bf16 v[88:91], a[60:63], v[200:203], v[88:91]
  ds_read_b128 v[168:171], v18 offset:4096
  v_mfma_f32_16x16x32_bf16 v[92:95], a[64:67], v[200:203], v[92:95]
  s_cmp_lt_u32 s33, 155648
  s_cselect_b32 s33, s33, 98304
  v_mfma_f32_16x16x32_bf16 v[96:99], a[68:71], v[200:203], v[96:99]
  v_mfma_f32_16x16x32_bf16 v[100:103], a[60:63], v[204:207], v[100:103]
  ds_read_b128 v[172:175], v18 offset:6144
  v_mfma_f32_16x16x32_bf16 v[104:107], a[64:67], v[204:207], v[104:107]
  v_mfma_f32_16x16x32_bf16 v[108:111], a[68:71], v[204:207], v[108:111]
  s_waitcnt lgkmcnt(2)
  v_mfma_f32_16x16x32_bf16 v[64:67], a[72:75], v[160:163], v[64:67]
  ds_read_b128 v[192:195], v19 offset:0
  v_mfma_f32_16x16x32_bf16 v[68:71], a[76:79], v[160:163], v[68:71]
  v_add_u32 v18, s33, v14
  v_mfma_f32_16x16x32_bf16 v[72:75], a[80:83], v[160:163], v[72:75]
  v_mfma_f32_16x16x32_bf16 v[76:79], a[72:75], v[164:167], v[76:79]
  ds_read_b128 v[196:199], v19 offset:2048
  v_mfma_f32_16x16x32_bf16 v[80:83], a[76:79], v[164:167], v[80:83]
  buffer_load_dwordx4 v11, s[8:11], s30 offen offset:1024 lds
  v_mfma_f32_16x16x32_bf16 v[84:87], a[80:83], v[164:167], v[84:87]
  s_waitcnt lgkmcnt(2)
  s_add_u32 s30, s30, 128
  v_mfma_f32_16x16x32_bf16 v[88:91], a[72:75], v[168:171], v[88:91]
  ds_read_b128 v[200:203], v19 offset:4096
  s_add_u32 m0, m0, 8192
  v_mfma_f32_16x16x32_bf16 v[92:95], a[76:79], v[168:171], v[92:95]
  s_cmp_lt_u32 m0, s46
  s_cselect_b32 m0, m0, s47
  v_mfma_f32_16x16x32_bf16 v[96:99], a[80:83], v[168:171], v[96:99]
  v_mfma_f32_16x16x32_bf16 v[100:103], a[72:75], v[172:175], v[100:103]
  ds_read_b128 v[204:207], v19 offset:6144
  v_mfma_f32_16x16x32_bf16 v[104:107], a[76:79], v[172:175], v[104:107]
  v_mfma_f32_16x16x32_bf16 v[108:111], a[80:83], v[172:175], v[108:111]
  s_waitcnt vmcnt(7) lgkmcnt(2)
  s_barrier
  v_mfma_f32_16x16x32_bf16 v[64:67], a[84:87], v[192:195], v[64:67]
  ds_read_b128 v[160:163], v18 offset:0
  v_mfma_f32_16x16x32_bf16 v[68:71], a[88:91], v[192:195], v[68:71]
  s_cmp_eq_u32 s48, 0x80000000
  s_cbranch_scc1 kvm_147
  s_cmp_lg_u32 s20, 0
  s_cbranch_scc1 af_148
  v_mov_b32 v4, 0
  v_mov_b32 v5, 1
  s_mov_b64 exec, 1
  buffer_atomic_add v5, v4, s[72:75], s61 offen sc1
  s_mov_b64 exec, -1
  s_nop 1
af_148:
kvm_147:
  v_mfma_f32_16x16x32_bf16 v[72:75], a[92:95], v[192:195], v[72:75]
  v_add_u32 v19, s33, v15
  s_add_u32 s33, s33, 8192
  v_mfma_f32_16x16x32_bf16 v[76:79], a[84:87], v[196:199], v[76:79]
  ds_read_b128 v[164:167], v18 offset:2048
  v_mfma_f32_16x16x32_bf16 v[80:83], a[88:91], v[196:199], v[80:83]
  buffer_load_dwordx4 v10, s[8:11], s30 offen offset:0 lds
  v_mfma_f32_16x16x32_bf16 v[84:87], a[92:95], v[196:199], v[84:87]
  s_waitcnt lgkmcnt(2)
  v_mfma_f32_16x16x32_bf16 v[88:91], a[84:87], v[200:203], v[88:91]
  ds_read_b128 v[168:171], v18 offset:4096
  v_mfma_f32_16x16x32_bf16 v[92:95], a[88:91], v[200:203], v[92:95]
  s_cmp_lt_u32 s33, 155648
  s_cselect_b32 s33, s33, 98304
  v_mfma_f32_16x16x32_bf16 v[96:99], a[92:95], v[200:203], v[96:99]
  v_mfma_f32_16x16x32_bf16 v[100:103], a[84:87], v[204:207], v[100:103]
  ds_read_b128 v[172:175], v18 offset:6144
  v_mfma_f32_16x16x32_bf16 v[104:107], a[88:91], v[204:207], v[104:107]
  v_mfma_f32_16x16x32_bf16 v[108:111], a[92:95], v[204:207], v[108:111]
  s_waitcnt lgkmcnt(2)
  v_mfma_f32_16x16x32_bf16 v[64:67], a[96:99], v[160:163], v[64:67]
  ds_read_b128 v[192:195], v19 offset:0
  v_mfma_f32_16x16x32_bf16 v[68:71], a[100:103], v[160:163], v[68:71]
  v_add_u32 v18, s33, v14
  s_mov_b32 s61, s60
  v_mfma_f32_16x16x32_bf16 v[72:75], a[104:107], v[160:163], v[72:75]
  s_add_u32 s60, s60, s62
  s_lshr_b32 s48, s20, 1
  v_mfma_f32_16x16x32_bf16 v[76:79], a[96:99], v[164:167], v[76:79]
  ds_read_b128 v[196:199], v19 offset:2048
  s_mul_i32 s48, s48, 393216
  v_mfma_f32_16x16x32_bf16 v[80:83], a[100:103], v[164:167], v[80:83]
  buffer_load_dwordx4 v11, s[8:11], s30 offen offset:1024 lds
  v_mfma_f32_16x16x32_bf16 v[84:87], a[104:107], v[164:167], v[84:87]
  s_waitcnt lgkmcnt(2)
  s_add_u32 s30, s30, s25
  v_mfma_f32_16x16x32_bf16 v[88:91], a[96:99], v[168:171], v[88:91]
  ds_read_b128 v[200:203], v19 offset:4096
  s_sub_u32 s30, s30, 1152
  v_mfma_f32_16x16x32_bf16 v[92:95], a[100:103], v[168:171], v[92:95]
  s_add_u32 m0, m0, 8192
  s_and_b32 s21, s20, 1
  v_mfma_f32_16x16x32_bf16 v[96:99], a[104:107], v[168:171], v[96:99]
  s_cmp_lt_u32 m0, s46
  s_cselect_b32 m0, m0, s47
  v_mfma_f32_16x16x32_bf16 v[100:103], a[96:99], v[172:175], v[100:103]
  ds_read_b128 v[204:207], v19 offset:6144
  s_mul_i32 s21, s21, 6144
  v_mfma_f32_16x16x32_bf16 v[104:107], a[100:103], v[172:175], v[104:107]
  s_add_u32 s48, s48, s21
  s_add_u32 s48, s48, s27
  v_mfma_f32_16x16x32_bf16 v[108:111], a[104:107], v[172:175], v[108:111]
  s_waitcnt vmcnt(8) lgkmcnt(2)
  s_barrier
  v_mfma_f32_16x16x32_bf16 v[64:67], a[108:111], v[192:195], v[64:67]
  ds_read_b128 v[160:163], v18 offset:0
  s_add_u32 s27, s27, s28
  v_mfma_f32_16x16x32_bf16 v[68:71], a[112:115], v[192:195], v[68:71]
  s_sub_u32 s26, s26, 1
  v_mfma_f32_16x16x32_bf16 v[72:75], a[116:119], v[192:195], v[72:75]
  v_add_u32 v19, s33, v15
  s_add_u32 s33, s33, 8192
  v_mfma_f32_16x16x32_bf16 v[76:79], a[108:111], v[196:199], v[76:79]
  ds_read_b128 v[164:167], v18 offset:2048
  v_mfma_f32_16x16x32_bf16 v[80:83], a[112:115], v[196:199], v[80:83]
  buffer_load_dwordx4 v10, s[8:11], s30 offen offset:0 lds
  v_mfma_f32_16x16x32_bf16 v[84:87], a[116:119], v[196:199], v[84:87]
  s_waitcnt lgkmcnt(2)
  v_mfma_f32_16x16x32_bf16 v[88:91], a[108:111], v[200:203], v[88:91]
  ds_read_b128 v[168:171], v18 offset:4096
  v_mfma_f32_16x16x32_bf16 v[92:95], a[112:115], v[200:203], v[92:95]
  s_cmp_lt_u32 s33, 155648
  s_cselect_b32 s33, s33, 98304
  v_mfma_f32_16x16x32_bf16 v[96:99], a[116:119], v[200:203], v[96:99]
  v_mfma_f32_16x16x32_bf16 v[100:103], a[108:111], v[204:207], v[100:103]
  ds_read_b128 v[172:175], v18 offset:6144
  v_mfma_f32_16x16x32_bf16 v[104:107], a[112:115], v[204:207], v[104:107]
  v_mfma_f32_16x16x32_bf16 v[108:111], a[116:119], v[204:207], v[108:111]
  s_waitcnt lgkmcnt(2)
  v_mfma_f32_16x16x32_bf16 v[64:67], a[120:123], v[160:163], v[64:67]
  ds_read_b128 v[192:195], v19 offset:0
  v_mfma_f32_16x16x32_bf16 v[68:71], a[124:127], v[160:163], v[68:71]
  v_add_u32 v18, s33, v14
  v_mfma_f32_16x16x32_bf16 v[72:75], a[128:131], v[160:163], v[72:75]
  v_mfma_f32_16x16x32_bf16 v[76:79], a[120:123], v[164:167], v[76:79]
  ds_read_b128 v[196:199], v19 offset:2048
  v_mfma_f32_16x16x32_bf16 v[80:83], a[124:127], v[164:167], v[80:83]
  buffer_load_dwordx4 v11, s[8:11], s30 offen offset:1024 lds
  v_mfma_f32_16x16x32_bf16 v[84:87], a[128:131], v[164:167], v[84:87]
  s_waitcnt lgkmcnt(2)
  s_add_u32 s30, s30, 128
  v_mfma_f32_16x16x32_bf16 v[88:91], a[120:123], v[168:171], v[88:91]
  ds_read_b128 v[200:203], v19 offset:4096
  s_add_u32 m0, m0, 8192
  v_mfma_f32_16x16x32_bf16 v[92:95], a[124:127], v[168:171], v[92:95]
  s_cmp_lt_u32 m0, s46
  s_cselect_b32 m0, m0, s47
  v_mfma_f32_16x16x32_bf16 v[96:99], a[128:131], v[168:171], v[96:99]
  v_mfma_f32_16x16x32_bf16 v[100:103], a[120:123], v[172:175], v[100:103]
  ds_read_b128 v[204:207], v19 offset:6144
  v_mfma_f32_16x16x32_bf16 v[104:107], a[124:127], v[172:175], v[104:107]
  v_mfma_f32_16x16x32_bf16 v[108:111], a[128:131], v[172:175], v[108:111]
  s_waitcnt vmcnt(8) lgkmcnt(2)
  s_barrier
  v_mfma_f32_16x16x32_bf16 v[64:67], a[132:135], v[192:195], v[64:67]
  ds_read_b128 v[160:163], v18 offset:0
  v_mfma_f32_16x16x32_bf16 v[68:71], a[136:139], v[192:195], v[68:71]
  v_mfma_f32_16x16x32_bf16 v[72:75], a[140:143], v[192:195], v[72:75]
  v_add_u32 v19, s33, v15
  s_add_u32 s33, s33, 8192
  v_mfma_f32_16x16x32_bf16 v[76:79], a[132:135], v[196:199], v[76:79]
  ds_read_b128 v[164:167], v18 offset:2048
  v_mfma_f32_16x16x32_bf16 v[80:83], a[136:139], v[196:199], v[80:83]
  buffer_load_dwordx4 v10, s[8:11], s30 offen offset:0 lds
  v_mfma_f32_16x16x32_bf16 v[84:87], a[140:143], v[196:199], v[84:87]
  s_waitcnt lgkmcnt(2)
  v_mfma_f32_16x16x32_bf16 v[88:91], a[132:135], v[200:203], v[88:91]
  ds_read_b128 v[168:171], v18 offset:4096
  v_mfma_f32_16x16x32_bf16 v[92:95], a[136:139], v[200:203], v[92:95]
  s_cmp_lt_u32 s33, 155648
  s_cselect_b32 s33, s33, 98304
  v_mfma_f32_16x16x32_bf16 v[96:99], a[140:143], v[200:203], v[96:99]
  v_mfma_f32_16x16x32_bf16 v[100:103], a[132:135], v[204:207], v[100:103]
  ds_read_b128 v[172:175], v18 offset:6144
  v_mfma_f32_16x16x32_bf16 v[104:107], a[136:139], v[204:207], v[104:107]
  v_mfma_f32_16x16x32_bf16 v[108:111], a[140:143], v[204:207], v[108:111]
  s_waitcnt lgkmcnt(2)
  v_mfma_f32_16x16x32_bf16 v[64:67], a[144:147], v[160:163], v[64:67]
  ds_read_b128 v[192:195], v19 offset:0
  v_mfma_f32_16x16x32_bf16 v[68:71], a[148:151], v[160:163], v[68:71]
  v_add_u32 v18, s33, v14
  v_mfma_f32_16x16x32_bf16 v[72:75], a[152:155], v[160:163], v[72:75]
  v_mfma_f32_16x16x32_bf16 v[76:79], a[144:147], v[164:167], v[76:79]
  ds_read_b128 v[196:199], v19 offset:2048
  v_mfma_f32_16x16x32_bf16 v[80:83], a[148:151], v[164:167], v[80:83]
  buffer_load_dwordx4 v11, s[8:11], s30 offen offset:1024 lds
  v_mfma_f32_16x16x32_bf16 v[84:87], a[152:155], v[164:167], v[84:87]
  s_waitcnt lgkmcnt(2)
  s_add_u32 s30, s30, 128
  v_mfma_f32_16x16x32_bf16 v[88:91], a[144:147], v[168:171], v[88:91]
  ds_read_b128 v[200:203], v19 offset:4096
  s_add_u32 m0, m0, 8192
  v_mfma_f32_16x16x32_bf16 v[92:95], a[148:151], v[168:171], v[92:95]
  s_cmp_lt_u32 m0, s46
  s_cselect_b32 m0, m0, s47
  v_mfma_f32_16x16x32_bf16 v[96:99], a[152:155], v[168:171], v[96:99]
  v_mfma_f32_16x16x32_bf16 v[100:103], a[144:147], v[172:175], v[100:103]
  ds_read_b128 v[204:207], v19 offset:6144
  v_mfma_f32_16x16x32_bf16 v[104:107], a[148:151], v[172:175], v[104:107]
  v_mfma_f32_16x16x32_bf16 v[108:111], a[152:155], v[172:175], v[108:111]
  s_waitcnt vmcnt(8) lgkmcnt(2)
  s_barrier
  v_mfma_f32_16x16x32_bf16 v[64:67], a[156:159], v[192:195], v[64:67]
  ds_read_b128 v[160:163], v18 offset:0
  v_mfma_f32_16x16x32_bf16 v[68:71], a[160:163], v[192:195], v[68:71]
  v_mfma_f32_16x16x32_bf16 v[72:75], a[164:167], v[192:195], v[72:75]
  v_add_u32 v19, s33, v15
  s_add_u32 s33, s33, 8192
  v_mfma_f32_16x16x32_bf16 v[76:79], a[156:159], v[196:199], v[76:79]
  ds_read_b128 v[164:167], v18 offset:2048
  v_mfma_f32_16x16x32_bf16 v[80:83], a[160:163], v[196:199], v[80:83]
  buffer_load_dwordx4 v10, s[8:11], s30 offen offset:0 lds
  v_mfma_f32_16x16x32_bf16 v[84:87], a[164:167], v[196:199], v[84:87]
  s_waitcnt lgkmcnt(2)
  v_mfma_f32_16x16x32_bf16 v[88:91], a[156:159], v[200:203], v[88:91]
  ds_read_b128 v[168:171], v18 offset:4096
  v_mfma_f32_16x16x32_bf16 v[92:95], a[160:163], v[200:203], v[92:95]
  s_cmp_lt_u32 s33, 155648
  s_cselect_b32 s33, s33, 98304
  v_mfma_f32_16x16x32_bf16 v[96:99], a[164:167], v[200:203], v[96:99]
  v_mfma_f32_16x16x32_bf16 v[100:103], a[156:159], v[204:207], v[100:103]
  ds_read_b128 v[172:175], v18 offset:6144
  v_mfma_f32_16x16x32_bf16 v[104:107], a[160:163], v[204:207], v[104:107]
  v_mfma_f32_16x16x32_bf16 v[108:111], a[164:167], v[204:207], v[108:111]
  s_waitcnt lgkmcnt(2)
  v_mfma_f32_16x16x32_bf16 v[64:67], a[168:171], v[160:163], v[64:67]
  ds_read_b128 v[192:195], v19 offset:0
  v_mfma_f32_16x16x32_bf16 v[68:71], a[172:175], v[160:163], v[68:71]
  v_add_u32 v18, s33, v14
  v_mfma_f32_16x16x32_bf16 v[72:75], a[176:179], v[160:163], v[72:75]
  v_mfma_f32_16x16x32_bf16 v[76:79], a[168:171], v[164:167], v[76:79]
  ds_read_b128 v[196:199], v19 offset:2048
  v_mfma_f32_16x16x32_bf16 v[80:83], a[172:175], v[164:167], v[80:83]
  buffer_load_dwordx4 v11, s[8:11], s30 offen offset:1024 lds
  v_mfma_f32_16x16x32_bf16 v[84:87], a[176:179], v[164:167], v[84:87]
  s_waitcnt lgkmcnt(2)
  s_add_u32 s30, s30, 128
  v_mfma_f32_16x16x32_bf16 v[88:91], a[168:171], v[168:171], v[88:91]
  ds_read_b128 v[200:203], v19 offset:4096
  s_add_u32 m0, m0, 8192
  v_mfma_f32_16x16x32_bf16 v[92:95], a[172:175], v[168:171], v[92:95]
  s_cmp_lt_u32 m0, s46
  s_cselect_b32 m0, m0, s47
  v_mfma_f32_16x16x32_bf16 v[96:99], a[176:179], v[168:171], v[96:99]
  v_mfma_f32_16x16x32_bf16 v[100:103], a[168:171], v[172:175], v[100:103]
  ds_read_b128 v[204:207], v19 offset:6144
  v_mfma_f32_16x16x32_bf16 v[104:107], a[172:175], v[172:175], v[104:107]
  v_mfma_f32_16x16x32_bf16 v[108:111], a[176:179], v[172:175], v[108:111]
  s_waitcnt vmcnt(8) lgkmcnt(2)
  s_barrier
  v_mfma_f32_16x16x32_bf16 v[64:67], a[180:183], v[192:195], v[64:67]
  ds_read_b128 v[160:163], v18 offset:0
  v_mfma_f32_16x16x32_bf16 v[68:71], a[184:187], v[192:195], v[68:71]
  v_mfma_f32_16x16x32_bf16 v[72:75], a[188:191], v[192:195], v[72:75]
  v_add_u32 v19, s33, v15
  s_add_u32 s33, s33, 8192
  v_mfma_f32_16x16x32_bf16 v[76:79], a[180:183], v[196:199], v[76:79]
  ds_read_b128 v[164:167], v18 offset:2048
  v_mfma_f32_16x16x32_bf16 v[80:83], a[184:187], v[196:199], v[80:83]
  buffer_load_dwordx4 v10, s[8:11], s30 offen offset:0 lds
  v_mfma_f32_16x16x32_bf16 v[84:87], a[188:191], v[196:199], v[84:87]
  s_waitcnt lgkmcnt(2)
  v_mfma_f32_16x16x32_bf16 v[88:91], a[180:183], v[200:203], v[88:91]
  ds_read_b128 v[168:171], v18 offset:4096
  v_mfma_f32_16x16x32_bf16 v[92:95], a[184:187], v[200:203], v[92:95]
  s_cmp_lt_u32 s33, 155648
  s_cselect_b32 s33, s33, 98304
  v_mfma_f32_16x16x32_bf16 v[96:99], a[188:191], v[200:203], v[96:99]
  v_mfma_f32_16x16x32_bf16 v[100:103], a[180:183], v[204:207], v[100:103]
  ds_read_b128 v[172:175], v18 offset:6144
  v_mfma_f32_16x16x32_bf16 v[104:107], a[184:187], v[204:207], v[104:107]
  v_mfma_f32_16x16x32_bf16 v[108:111], a[188:191], v[204:207], v[108:111]
  s_waitcnt lgkmcnt(2)
  v_mfma_f32_16x16x32_bf16 v[64:67], a[192:195], v[160:163], v[64:67]
  ds_read_b128 v[192:195], v19 offset:0
  v_mfma_f32_16x16x32_bf16 v[68:71], a[196:199], v[160:163], v[68:71]
  v_add_u32 v18, s33, v14
  v_mfma_f32_16x16x32_bf16 v[72:75], a[200:203], v[160:163], v[72:75]
  v_mfma_f32_16x16x32_bf16 v[76:79], a[192:195], v[164:167], v[76:79]
  ds_read_b128 v[196:199], v19 offset:2048
  v_mfma_f32_16x16x32_bf16 v[80:83], a[196:199], v[164:167], v[80:83]
  buffer_load_dwordx4 v11, s[8:11], s30 offen offset:1024 lds
  v_mfma_f32_16x16x32_bf16 v[84:87], a[200:203], v[164:167], v[84:87]
  s_waitcnt lgkmcnt(2)
  s_add_u32 s30, s30, 128
  v_mfma_f32_16x16x32_bf16 v[88:91], a[192:195], v[168:171], v[88:91]
  ds_read_b128 v[200:203], v19 offset:4096
  s_add_u32 m0, m0, 8192
  v_mfma_f32_16x16x32_bf16 v[92:95], a[196:199], v[168:171], v[92:95]
  s_cmp_lt_u32 m0, s46
  s_cselect_b32 m0, m0, s47
  v_mfma_f32_16x16x32_bf16 v[96:99], a[200:203], v[168:171], v[96:99]
  v_mfma_f32_16x16x32_bf16 v[100:103], a[192:195], v[172:175], v[100:103]
  ds_read_b128 v[204:207], v19 offset:6144
  v_mfma_f32_16x16x32_bf16 v[104:107], a[196:199], v[172:175], v[104:107]
  v_mfma_f32_16x16x32_bf16 v[108:111], a[200:203], v[172:175], v[108:111]
  s_waitcnt vmcnt(8) lgkmcnt(2)
  s_barrier
  v_mfma_f32_16x16x32_bf16 v[64:67], a[204:207], v[192:195], v[64:67]
  ds_read_b128 v[160:163], v18 offset:0
  v_mfma_f32_16x16x32_bf16 v[68:71], a[208:211], v[192:195], v[68:71]
  v_mfma_f32_16x16x32_bf16 v[72:75], a[212:215], v[192:195], v[72:75]
  v_add_u32 v19, s33, v15
  s_add_u32 s33, s33, 8192
  v_mfma_f32_16x16x32_bf16 v[76:79], a[204:207], v[196:199], v[76:79]
  ds_read_b128 v[164:167], v18 offset:2048
  v_mfma_f32_16x16x32_bf16 v[80:83], a[208:211], v[196:199], v[80:83]
  buffer_load_dwordx4 v10, s[8:11], s30 offen offset:0 lds
  v_mfma_f32_16x16x32_bf16 v[84:87], a[212:215], v[196:199], v[84:87]
  s_waitcnt lgkmcnt(2)
  v_mfma_f32_16x16x32_bf16 v[88:91], a[204:207], v[200:203], v[88:91]
  ds_read_b128 v[168:171], v18 offset:4096
  v_mfma_f32_16x16x32_bf16 v[92:95], a[208:211], v[200:203], v[92:95]
  s_cmp_lt_u32 s33, 155648
  s_cselect_b32 s33, s33, 98304
  v_mfma_f32_16x16x32_bf16 v[96:99], a[212:215], v[200:203], v[96:99]
  v_mfma_f32_16x16x32_bf16 v[100:103], a[204:207], v[204:207], v[100:103]
  ds_read_b128 v[172:175], v18 offset:6144
  v_mfma_f32_16x16x32_bf16 v[104:107], a[208:211], v[204:207], v[104:107]
  v_mfma_f32_16x16x32_bf16 v[108:111], a[212:215], v[204:207], v[108:111]
  s_waitcnt lgkmcnt(2)
  v_mfma_f32_16x16x32_bf16 v[64:67], a[216:219], v[160:163], v[64:67]
  ds_read_b128 v[192:195], v19 offset:0
  v_mfma_f32_16x16x32_bf16 v[68:71], a[220:223], v[160:163], v[68:71]
  v_add_u32 v18, s33, v14
  v_mfma_f32_16x16x32_bf16 v[72:75], a[224:227], v[160:163], v[72:75]
  v_mfma_f32_16x16x32_bf16 v[76:79], a[216:219], v[164:167], v[76:79]
  ds_read_b128 v[196:199], v19 offset:2048
  v_mfma_f32_16x16x32_bf16 v[80:83], a[220:223], v[164:167], v[80:83]
  buffer_load_dwordx4 v11, s[8:11], s30 offen offset:1024 lds
  v_mfma_f32_16x16x32_bf16 v[84:87], a[224:227], v[164:167], v[84:87]
  s_waitcnt lgkmcnt(2)
  s_add_u32 s30, s30, 128
  v_mfma_f32_16x16x32_bf16 v[88:91], a[216:219], v[168:171], v[88:91]
  ds_read_b128 v[200:203], v19 offset:4096
  s_add_u32 m0, m0, 8192
  v_mfma_f32_16x16x32_bf16 v[92:95], a[220:223], v[168:171], v[92:95]
  s_cmp_lt_u32 m0, s46
  s_cselect_b32 m0, m0, s47
  v_mfma_f32_16x16x32_bf16 v[96:99], a[224:227], v[168:171], v[96:99]
  v_mfma_f32_16x16x32_bf16 v[100:103], a[216:219], v[172:175], v[100:103]
  ds_read_b128 v[204:207], v19 offset:6144
  v_mfma_f32_16x16x32_bf16 v[104:107], a[220:223], v[172:175], v[104:107]
  v_mfma_f32_16x16x32_bf16 v[108:111], a[224:227], v[172:175], v[108:111]
  s_waitcnt vmcnt(8) lgkmcnt(2)
  s_barrier
  v_mfma_f32_16x16x32_bf16 v[64:67], a[228:231], v[192:195], v[64:67]
  ds_read_b128 v[160:163], v18 offset:0
  v_mfma_f32_16x16x32_bf16 v[68:71], a[232:235], v[192:195], v[68:71]
  v_mfma_f32_16x16x32_bf16 v[72:75], a[236:239], v[192:195], v[72:75]
  v_add_u32 v19, s33, v15
  s_add_u32 s33, s33, 8192
  v_mfma_f32_16x16x32_bf16 v[76:79], a[228:231], v[196:199], v[76:79]
  ds_read_b128 v[164:167], v18 offset:2048
  v_cvt_pk_bf16_f32 v224, v64, v65
  v_cvt_pk_bf16_f32 v225, v66, v67
  v_mfma_f32_16x16x32_bf16 v[80:83], a[232:235], v[196:199], v[80:83]
  buffer_load_dwordx4 v10, s[8:11], s30 offen offset:0 lds
  v_cvt_pk_bf16_f32 v226, v68, v69
  v_cvt_pk_bf16_f32 v227, v70, v71
  v_mfma_f32_16x16x32_bf16 v[84:87], a[236:239], v[196:199], v[84:87]
  s_waitcnt lgkmcnt(2)
  v_cvt_pk_bf16_f32 v228, v72, v73
  v_cvt_pk_bf16_f32 v229, v74, v75
  v_mfma_f32_16x16x32_bf16 v[88:91], a[228:231], v[200:203], v[88:91]
  ds_read_b128 v[168:171], v18 offset:4096
  ds_write_b64 v22, v[224:225] offset:0
  v_mfma_f32_16x16x32_bf16 v[92:95], a[232:235], v[200:203], v[92:95]
  s_cmp_lt_u32 s33, 155648
  s_cselect_b32 s33, s33, 98304
  ds_write_b64 v22, v[226:227] offset:8
  v_mfma_f32_16x16x32_bf16 v[96:99], a[236:239], v[200:203], v[96:99]
  ds_write_b64 v16, v[228:229] offset:64
  v_cvt_pk_bf16_f32 v230, v76, v77
  v_cvt_pk_bf16_f32 v231, v78, v79
  v_mfma_f32_16x16x32_bf16 v[100:103], a[228:231], v[204:207], v[100:103]
  ds_read_b128 v[172:175], v18 offset:6144
  v_cvt_pk_bf16_f32 v232, v80, v81
  v_cvt_pk_bf16_f32 v233, v82, v83
  v_cvt_pk_bf16_f32 v234, v84, v85
  v_mfma_f32_16x16x32_bf16 v[104:107], a[232:235], v[204:207], v[104:107]
  v_cvt_pk_bf16_f32 v235, v86, v87
  ds_write_b64 v22, v[230:231] offset:6400
  v_mfma_f32_16x16x32_bf16 v[108:111], a[236:239], v[204:207], v[108:111]
  ds_write_b64 v22, v[232:233] offset:6408
  ds_write_b64 v16, v[234:235] offset:6464
kvm_end_150:
  v_cvt_pk_bf16_f32 v236, v88, v89
  v_cvt_pk_bf16_f32 v237, v90, v91
  v_cvt_pk_bf16_f32 v238, v92, v93
  v_cvt_pk_bf16_f32 v239, v94, v95
  v_cvt_pk_bf16_f32 v240, v96, v97
  v_cvt_pk_bf16_f32 v241, v98, v99
  ds_write_b64 v22, v[236:237] offset:12800
  ds_write_b64 v22, v[238:239] offset:12808
  ds_write_b64 v16, v[240:241] offset:12864
  v_cvt_pk_bf16_f32 v242, v100, v101
  v_cvt_pk_bf16_f32 v243, v102, v103
  v_cvt_pk_bf16_f32 v244, v104, v105
  v_cvt_pk_bf16_f32 v245, v106, v107
  v_cvt_pk_bf16_f32 v246, v108, v109
  v_cvt_pk_bf16_f32 v247, v110, v111
  ds_write_b64 v22, v[242:243] offset:19200
  ds_write_b64 v22, v[244:245] offset:19208
  ds_write_b64 v16, v[246:247] offset:19264
  s_waitcnt lgkmcnt(0)
  s_barrier
  ds_read_b128 v[224:227], v23 offset:0
  ds_read_b128 v[228:231], v23 offset:64
  ds_read_b128 v[232:235], v23 offset:128
  ds_read_b128 v[236:239], v23 offset:192
  ds_read_b128 v[240:243], v23 offset:256
  ds_read_b128 v[244:247], v23 offset:320
  s_waitcnt lgkmcnt(0)
  s_add_u32 s21, s48, 0
  buffer_store_dwordx4 v[224:227], v26, s[16:19], s21 offen offset:0 sc1
  buffer_store_dwordx4 v[228:231], v26, s[16:19], s21 offen offset:1024 sc1
  buffer_store_dwordx4 v[232:235], v26, s[16:19], s21 offen offset:2048 sc1
  buffer_store_dwordx4 v[236:239], v26, s[16:19], s21 offen offset:3072 sc1
  s_add_u32 s21, s48, 4096
  buffer_store_dwordx4 v[240:243], v26, s[16:19], s21 offen offset:0 sc1
  buffer_store_dwordx4 v[244:247], v26, s[16:19], s21 offen offset:1024 sc1
  s_nop 1
  s_cmp_gt_u32 s26, 0
  s_cbranch_scc1 kvm_blk_149
  s_waitcnt vmcnt(6)
  s_barrier
  s_mov_b32 s24, 491520
  s_mov_b32 s25, 163840
  v_lshrrev_b32 v11, 3, v1
  v_and_b32 v12, 7, v1
  v_xor_b32 v12, v12, v11
  v_mul_u32_u24 v11, 1280, v11
  v_lshl_add_u32 v10, v12, 4, v11
  s_mul_i32 s46, s20, 40960
  v_add_u32 v10, s46, v10
  s_lshl_b32 s47, s20, 12
  s_add_u32 s47, s47, 0
  s_add_u32 s46, s47, 98304
  s_mov_b32 s30, s24
  s_add_u32 s32, s47, 32768
  v_add_u32 v11, 9216, v10
  v_add_u32 v12, 18432, v10
  v_add_u32 v13, 27648, v10
  s_mov_b32 m0, s32
  s_nop 0
  buffer_load_dwordx4 v10, s[8:11], s30 offen offset:0 lds
  buffer_load_dwordx4 v11, s[8:11], s30 offen offset:1024 lds
  buffer_load_dwordx4 v12, s[8:11], s30 offen offset:2048 lds
  buffer_load_dwordx4 v13, s[8:11], s30 offen offset:3072 lds
  s_add_u32 s30, s30, 128
  s_add_u32 s32, s32, 16384
  s_cmp_lt_u32 s32, s46
  s_cselect_b32 s32, s32, s47
  s_mov_b32 m0, s32
  s_nop 0
  buffer_load_dwordx4 v10, s[8:11], s30 offen offset:0 lds
  buffer_load_dwordx4 v11, s[8:11], s30 offen offset:1024 lds
  buffer_load_dwordx4 v12, s[8:11], s30 offen offset:2048 lds
  buffer_load_dwordx4 v13, s[8:11], s30 offen offset:3072 lds
  s_add_u32 s30, s30, 128
  s_add_u32 s32, s32, 16384
  s_cmp_lt_u32 s32, s46
  s_cselect_b32 s32, s32, s47
  s_mov_b32 m0, s32
  s_nop 0
  buffer_load_dwordx4 v10, s[8:11], s30 offen offset:0 lds
  buffer_load_dwordx4 v11, s[8:11], s30 offen offset:1024 lds
  buffer_load_dwordx4 v12, s[8:11], s30 offen offset:2048 lds
  buffer_load_dwordx4 v13, s[8:11], s30 offen offset:3072 lds
  s_add_u32 s30, s30, 128
  s_add_u32 s32, s32, 16384
  s_cmp_lt_u32 s32, s46
  s_cselect_b32 s32, s32, s47
  s_mov_b32 m0, s32
  s_nop 0
  buffer_load_dwordx4 v10, s[8:11], s30 offen offset:0 lds
  buffer_load_dwordx4 v11, s[8:11], s30 offen offset:1024 lds
  buffer_load_dwordx4 v12, s[8:11], s30 offen offset:2048 lds
  buffer_load_dwordx4 v13, s[8:11], s30 offen offset:3072 lds
  s_add_u32 s30, s30, 128
  s_add_u32 s32, s32, 16384
  s_cmp_lt_u32 s32, s46
  s_cselect_b32 s32, s32, s47
  s_waitcnt vmcnt(16)
  s_barrier
  s_cmp_lg_u32 s20, 0
  s_cbranch_scc1 af_154
  v_mov_b32 v4, 0
  v_mov_b32 v5, 1
  s_mov_b64 exec, 1
  buffer_atomic_add v5, v4, s[72:75], s61 offen sc1
  s_mov_b64 exec, -1
  s_nop 1
af_154:
  s_mov_b32 s26, 13
  s_mov_b32 s28, 1572864
kv_main:
  v_and_b32 v6, 7, v2
  v_add_u32 v4, 0, v3
  v_xor_b32 v4, v4, v6
  v_lshlrev_b32 v4, 4, v4
  v_lshl_add_u32 v14, v2, 7, v4
  v_add_u32 v4, 4, v3
  v_xor_b32 v4, v4, v6
  v_lshlrev_b32 v4, 4, v4
  v_lshl_add_u32 v15, v2, 7, v4
  v_mul_u32_u24 v22, 400, v2
  v_mul_u32_u24 v4, 16, v3
  s_mul_i32 s21, s20, 96
  s_add_u32 s21, s21, 98304
  v_add3_u32 v22, v22, v4, s21
  v_lshlrev_b32 v4, 3, v3
  v_sub_u32 v16, v22, v4
  v_mov_b32 v9, 2731
  s_mul_i32 s21, s20, 12800
  s_add_u32 s21, s21, 98304
  v_mul_u32_u24 v4, 400, v2
  v_lshlrev_b32 v5, 4, v3
  v_add3_u32 v23, v4, v5, s21
  v_lshlrev_b32 v26, 4, v1
  s_mov_b32 s33, 32768
  s_mov_b32 s48, 0x80000000
  s_mov_b32 m0, s32
  s_nop 0
  buffer_load_dwordx4 v10, s[8:11], s30 offen offset:0 lds
  buffer_load_dwordx4 v11, s[8:11], s30 offen offset:1024 lds
  s_waitcnt vmcnt(14)
  s_barrier
  v_add_u32 v18, s33, v14
  v_add_u32 v19, s33, v15
  s_add_u32 s33, s33, 16384
  s_cmp_lt_u32 s33, 98304
  s_cselect_b32 s33, s33, 0
  ds_read_b128 v[160:163], v18 offset:0
  ds_read_b128 v[164:167], v18 offset:2048
  ds_read_b128 v[168:171], v18 offset:4096
  ds_read_b128 v[172:175], v18 offset:6144
  ds_read_b128 v[176:179], v18 offset:8192
  ds_read_b128 v[180:183], v18 offset:10240
  ds_read_b128 v[184:187], v18 offset:12288
  ds_read_b128 v[188:191], v18 offset:14336
  s_waitcnt lgkmcnt(0)
kv_blk_157:
  v_mfma_f32_16x16x32_bf16 v[64:67], a[0:3], v[160:163], 0
  ds_read_b128 v[192:195], v19 offset:0
  v_mfma_f32_16x16x32_bf16 v[68:71], a[4:7], v[160:163], 0
  v_add_u32 v18, s33, v14
  v_mfma_f32_16x16x32_bf16 v[72:75], a[8:11], v[160:163], 0
  ds_write_b64 v16, v[234:235] offset:6464
  v_mfma_f32_16x16x32_bf16 v[76:79], a[0:3], v[164:167], 0
  ds_read_b128 v[196:199], v19 offset:2048
  v_cvt_pk_bf16_f32 v236, v88, v89
  v_mfma_f32_16x16x32_bf16 v[80:83], a[4:7], v[164:167], 0
  buffer_load_dwordx4 v12, s[8:11], s30 offen offset:2048 lds
  v_mfma_f32_16x16x32_bf16 v[84:87], a[8:11], v[164:167], 0
  v_cvt_pk_bf16_f32 v237, v90, v91
  v_cvt_pk_bf16_f32 v238, v92, v93
  v_mfma_f32_16x16x32_bf16 v[88:91], a[0:3], v[168:171], 0
  ds_read_b128 v[200:203], v19 offset:4096
  v_cvt_pk_bf16_f32 v239, v94, v95
  v_mfma_f32_16x16x32_bf16 v[92:95], a[4:7], v[168:171], 0
  v_cvt_pk_bf16_f32 v240, v96, v97
  v_cvt_pk_bf16_f32 v241, v98, v99
  v_mfma_f32_16x16x32_bf16 v[96:99], a[8:11], v[168:171], 0
  ds_write_b64 v22, v[236:237] offset:12800
  ds_write_b64 v22, v[238:239] offset:12808
  ds_write_b64 v16, v[240:241] offset:12864
  v_cvt_pk_bf16_f32 v242, v100, v101
  v_cvt_pk_bf16_f32 v243, v102, v103
  v_mfma_f32_16x16x32_bf16 v[100:103], a[0:3], v[172:175], 0
  ds_read_b128 v[204:207], v19 offset:6144
  v_cvt_pk_bf16_f32 v244, v104, v105
  v_cvt_pk_bf16_f32 v245, v106, v107
  v_mfma_f32_16x16x32_bf16 v[104:107], a[4:7], v[172:175], 0
  v_cvt_pk_bf16_f32 v246, v108, v109
  v_cvt_pk_bf16_f32 v247, v110, v111
  v_mfma_f32_16x16x32_bf16 v[108:111], a[8:11], v[172:175], 0
  s_waitcnt lgkmcnt(9)
  ds_write_b64 v22, v[242:243] offset:19200
  ds_write_b64 v22, v[244:245] offset:19208
  ds_write_b64 v16, v[246:247] offset:19264
  v_cvt_pk_bf16_f32 v224, v112, v113
  v_cvt_pk_bf16_f32 v225, v114, v115
  v_mfma_f32_16x16x32_bf16 v[112:115], a[0:3], v[176:179], 0
  ds_read_b128 v[208:211], v19 offset:8192
  v_cvt_pk_bf16_f32 v226, v116, v117
  v_cvt_pk_bf16_f32 v227, v118, v119
  v_mfma_f32_16x16x32_bf16 v[116:119], a[4:7], v[176:179], 0
  v_cvt_pk_bf16_f32 v228, v120, v121
  v_cvt_pk_bf16_f32 v229, v122, v123
  v_mfma_f32_16x16x32_bf16 v[120:123], a[8:11], v[176:179], 0
  ds_write_b64 v22, v[224:225] offset:25600
  ds_write_b64 v22, v[226:227] offset:25608
  ds_write_b64 v16, v[228:229] offset:25664
  v_cvt_pk_bf16_f32 v230, v124, v125
  v_cvt_pk_bf16_f32 v231, v126, v127
  v_mfma_f32_16x16x32_bf16 v[124:127], a[0:3], v[180:183], 0
  ds_read_b128 v[212:215], v19 offset:10240
  v_cvt_pk_bf16_f32 v232, v128, v129
  v_cvt_pk_bf16_f32 v233, v130, v131
  v_mfma_f32_16x16x32_bf16 v[128:131], a[4:7], v[180:183], 0
  buffer_load_dwordx4 v13, s[8:11], s30 offen offset:3072 lds
  v_cvt_pk_bf16_f32 v234, v132, v133
  v_cvt_pk_bf16_f32 v235, v134, v135
  v_mfma_f32_16x16x32_bf16 v[132:135], a[8:11], v[180:183], 0
  s_add_u32 s30, s30, 128
  s_add_u32 m0, m0, 16384
  ds_write_b64 v22, v[230:231] offset:32000
  ds_write_b64 v22, v[232:233] offset:32008
  ds_write_b64 v16, v[234:235] offset:32064
  v_cvt_pk_bf16_f32 v236, v136, v137
  v_cvt_pk_bf16_f32 v237, v138, v139
  v_mfma_f32_16x16x32_bf16 v[136:139], a[0:3], v[184:187], 0
  ds_read_b128 v[216:219], v19 offset:12288
  v_cvt_pk_bf16_f32 v238, v140, v141
  v_cvt_pk_bf16_f32 v239, v142, v143
  v_mfma_f32_16x16x32_bf16 v[140:143], a[4:7], v[184:187], 0
  s_cmp_lt_u32 m0, s46
  s_cselect_b32 m0, m0, s47
  v_cvt_pk_bf16_f32 v240, v144, v145
  v_cvt_pk_bf16_f32 v241, v146, v147
  v_mfma_f32_16x16x32_bf16 v[144:147], a[8:11], v[184:187], 0
  ds_write_b64 v22, v[236:237] offset:38400
  ds_write_b64 v22, v[238:239] offset:38408
  ds_write_b64 v16, v[240:241] offset:38464
  v_cvt_pk_bf16_f32 v242, v148, v149
  v_cvt_pk_bf16_f32 v243, v150, v151
  v_mfma_f32_16x16x32_bf16 v[148:151], a[0:3], v[188:191], 0
  ds_read_b128 v[220:223], v19 offset:14336
  v_cvt_pk_bf16_f32 v244, v152, v153
  v_cvt_pk_bf16_f32 v245, v154, v155
  v_mfma_f32_16x16x32_bf16 v[152:155], a[4:7], v[188:191], 0
  v_cvt_pk_bf16_f32 v246, v156, v157
  v_cvt_pk_bf16_f32 v247, v158, v159
  v_mfma_f32_16x16x32_bf16 v[156:159], a[8:11], v[188:191], 0
  s_waitcnt vmcnt(12) lgkmcnt(15)
  s_barrier
  v_mfma_f32_16x16x32_bf16 v[64:67], a[12:15], v[192:195], v[64:67]
  ds_read_b128 v[160:163], v18 offset:0
  v_mfma_f32_16x16x32_bf16 v[68:71], a[16:19], v[192:195], v[68:71]
  ds_write_b64 v22, v[242:243] offset:44800
  v_mfma_f32_16x16x32_bf16 v[72:75], a[20:23], v[192:195], v[72:75]
  v_add_u32 v19, s33, v15
  s_add_u32 s33, s33, 16384
  v_mfma_f32_16x16x32_bf16 v[76:79], a[12:15], v[196:199], v[76:79]
  ds_read_b128 v[164:167], v18 offset:2048
  v_mfma_f32_16x16x32_bf16 v[80:83], a[16:19], v[196:199], v[80:83]
  buffer_load_dwordx4 v10, s[8:11], s30 offen offset:0 lds
  v_mfma_f32_16x16x32_bf16 v[84:87], a[20:23], v[196:199], v[84:87]
  s_cmp_lt_u32 s33, 98304
  s_cselect_b32 s33, s33, 0
  v_mfma_f32_16x16x32_bf16 v[88:91], a[12:15], v[200:203], v[88:91]
  ds_read_b128 v[168:171], v18 offset:4096
  v_mfma_f32_16x16x32_bf16 v[92:95], a[16:19], v[200:203], v[92:95]
  ds_write_b64 v22, v[244:245] offset:44808
  v_mfma_f32_16x16x32_bf16 v[96:99], a[20:23], v[200:203], v[96:99]
  ds_write_b64 v16, v[246:247] offset:44864
  v_mfma_f32_16x16x32_bf16 v[100:103], a[12:15], v[204:207], v[100:103]
  ds_read_b128 v[172:175], v18 offset:6144
  v_mfma_f32_16x16x32_bf16 v[104:107], a[16:19], v[204:207], v[104:107]
  v_mfma_f32_16x16x32_bf16 v[108:111], a[20:23], v[204:207], v[108:111]
  s_waitcnt lgkmcnt(7)
  v_mfma_f32_16x16x32_bf16 v[112:115], a[12:15], v[208:211], v[112:115]
  ds_read_b128 v[176:179], v18 offset:8192
  v_mfma_f32_16x16x32_bf16 v[116:119], a[16:19], v[208:211], v[116:119]
  v_mfma_f32_16x16x32_bf16 v[120:123], a[20:23], v[208:211], v[120:123]
  v_mfma_f32_16x16x32_bf16 v[124:127], a[12:15], v[212:215], v[124:127]
  ds_read_b128 v[180:183], v18 offset:10240
  v_mfma_f32_16x16x32_bf16 v[128:131], a[16:19], v[212:215], v[128:131]
  buffer_load_dwordx4 v11, s[8:11], s30 offen offset:1024 lds
  v_mfma_f32_16x16x32_bf16 v[132:135], a[20:23], v[212:215], v[132:135]
  v_mfma_f32_16x16x32_bf16 v[136:139], a[12:15], v[216:219], v[136:139]
  ds_read_b128 v[184:187], v18 offset:12288
  v_mfma_f32_16x16x32_bf16 v[140:143], a[16:19], v[216:219], v[140:143]
  v_mfma_f32_16x16x32_bf16 v[144:147], a[20:23], v[216:219], v[144:147]
  v_mfma_f32_16x16x32_bf16 v[148:151], a[12:15], v[220:223], v[148:151]
  ds_read_b128 v[188:191], v18 offset:14336
  v_mfma_f32_16x16x32_bf16 v[152:155], a[16:19], v[220:223], v[152:155]
  v_mfma_f32_16x16x32_bf16 v[156:159], a[20:23], v[220:223], v[156:159]
  s_waitcnt lgkmcnt(4)
  v_mfma_f32_16x16x32_bf16 v[64:67], a[24:27], v[160:163], v[64:67]
  ds_read_b128 v[192:195], v19 offset:0
  v_mfma_f32_16x16x32_bf16 v[68:71], a[28:31], v[160:163], v[68:71]
  v_add_u32 v18, s33, v14
  v_mfma_f32_16x16x32_bf16 v[72:75], a[32:35], v[160:163], v[72:75]
  v_mfma_f32_16x16x32_bf16 v[76:79], a[24:27], v[164:167], v[76:79]
  ds_read_b128 v[196:199], v19 offset:2048
  v_mfma_f32_16x16x32_bf16 v[80:83], a[28:31], v[164:167], v[80:83]
  buffer_load_dwordx4 v12, s[8:11], s30 offen offset:2048 lds
  v_mfma_f32_16x16x32_bf16 v[84:87], a[32:35], v[164:167], v[84:87]
  v_mfma_f32_16x16x32_bf16 v[88:91], a[24:27], v[168:171], v[88:91]
  ds_read_b128 v[200:203], v19 offset:4096
  v_mfma_f32_16x16x32_bf16 v[92:95], a[28:31], v[168:171], v[92:95]
  v_mfma_f32_16x16x32_bf16 v[96:99], a[32:35], v[168:171], v[96:99]
  v_mfma_f32_16x16x32_bf16 v[100:103], a[24:27], v[172:175], v[100:103]
  ds_read_b128 v[204:207], v19 offset:6144
  v_mfma_f32_16x16x32_bf16 v[104:107], a[28:31], v[172:175], v[104:107]
  v_mfma_f32_16x16x32_bf16 v[108:111], a[32:35], v[172:175], v[108:111]
  s_waitcnt lgkmcnt(4)
  v_mfma_f32_16x16x32_bf16 v[112:115], a[24:27], v[176:179], v[112:115]
  ds_read_b128 v[208:211], v19 offset:8192
  v_mfma_f32_16x16x32_bf16 v[116:119], a[28:31], v[176:179], v[116:119]
  v_mfma_f32_16x16x32_bf16 v[120:123], a[32:35], v[176:179], v[120:123]
  v_mfma_f32_16x16x32_bf16 v[124:127], a[24:27], v[180:183], v[124:127]
  ds_read_b128 v[212:215], v19 offset:10240
  v_mfma_f32_16x16x32_bf16 v[128:131], a[28:31], v[180:183], v[128:131]
  buffer_load_dwordx4 v13, s[8:11], s30 offen offset:3072 lds
  v_mfma_f32_16x16x32_bf16 v[132:135], a[32:35], v[180:183], v[132:135]
  s_add_u32 s30, s30, 128
  s_add_u32 m0, m0, 16384
  v_mfma_f32_16x16x32_bf16 v[136:139], a[24:27], v[184:187], v[136:139]
  ds_read_b128 v[216:219], v19 offset:12288
  v_mfma_f32_16x16x32_bf16 v[140:143], a[28:31], v[184:187], v[140:143]
  s_cmp_lt_u32 m0, s46
  s_cselect_b32 m0, m0, s47
  v_mfma_f32_16x16x32_bf16 v[144:147], a[32:35], v[184:187], v[144:147]
  v_mfma_f32_16x16x32_bf16 v[148:151], a[24:27], v[188:191], v[148:151]
  ds_read_b128 v[220:223], v19 offset:14336
  v_mfma_f32_16x16x32_bf16 v[152:155], a[28:31], v[188:191], v[152:155]
  v_mfma_f32_16x16x32_bf16 v[156:159], a[32:35], v[188:191], v[156:159]
  s_waitcnt vmcnt(12) lgkmcnt(4)
  s_barrier
  v_mfma_f32_16x16x32_bf16 v[64:67], a[36:39], v[192:195], v[64:67]
  ds_read_b128 v[160:163], v18 offset:0
  v_mfma_f32_16x16x32_bf16 v[68:71], a[40:43], v[192:195], v[68:71]
  v_mfma_f32_16x16x32_bf16 v[72:75], a[44:47], v[192:195], v[72:75]
  v_add_u32 v19, s33, v15
  s_add_u32 s33, s33, 16384
  v_mfma_f32_16x16x32_bf16 v[76:79], a[36:39], v[196:199], v[76:79]
  ds_read_b128 v[164:167], v18 offset:2048
  v_mfma_f32_16x16x32_bf16 v[80:83], a[40:43], v[196:199], v[80:83]
  buffer_load_dwordx4 v10, s[8:11], s30 offen offset:0 lds
  v_mfma_f32_16x16x32_bf16 v[84:87], a[44:47], v[196:199], v[84:87]
  s_cmp_lt_u32 s33, 98304
  s_cselect_b32 s33, s33, 0
  v_mfma_f32_16x16x32_bf16 v[88:91], a[36:39], v[200:203], v[88:91]
  ds_read_b128 v[168:171], v18 offset:4096
  v_mfma_f32_16x16x32_bf16 v[92:95], a[40:43], v[200:203], v[92:95]
  ds_read_b128 v[224:227], v23 offset:0
  v_mfma_f32_16x16x32_bf16 v[96:99], a[44:47], v[200:203], v[96:99]
  v_mfma_f32_16x16x32_bf16 v[100:103], a[36:39], v[204:207], v[100:103]
  ds_read_b128 v[172:175], v18 offset:6144
  v_mfma_f32_16x16x32_bf16 v[104:107], a[40:43], v[204:207], v[104:107]
  v_mfma_f32_16x16x32_bf16 v[108:111], a[44:47], v[204:207], v[108:111]
  s_waitcnt lgkmcnt(5)
  v_mfma_f32_16x16x32_bf16 v[112:115], a[36:39], v[208:211], v[112:115]
  ds_read_b128 v[176:179], v18 offset:8192
  v_mfma_f32_16x16x32_bf16 v[116:119], a[40:43], v[208:211], v[116:119]
  v_mfma_f32_16x16x32_bf16 v[120:123], a[44:47], v[208:211], v[120:123]
  v_mfma_f32_16x16x32_bf16 v[124:127], a[36:39], v[212:215], v[124:127]
  ds_read_b128 v[180:183], v18 offset:10240
  v_mfma_f32_16x16x32_bf16 v[128:131], a[40:43], v[212:215], v[128:131]
  buffer_load_dwordx4 v11, s[8:11], s30 offen offset:1024 lds
  v_mfma_f32_16x16x32_bf16 v[132:135], a[44:47], v[212:215], v[132:135]
  v_mfma_f32_16x16x32_bf16 v[136:139], a[36:39], v[216:219], v[136:139]
  ds_read_b128 v[184:187], v18 offset:12288
  v_mfma_f32_16x16x32_bf16 v[140:143], a[40:43], v[216:219], v[140:143]
  ds_read_b128 v[228:231], v23 offset:64
  v_mfma_f32_16x16x32_bf16 v[144:147], a[44:47], v[216:219], v[144:147]
  v_mfma_f32_16x16x32_bf16 v[148:151], a[36:39], v[220:223], v[148:151]
  ds_read_b128 v[188:191], v18 offset:14336
  v_mfma_f32_16x16x32_bf16 v[152:155], a[40:43], v[220:223], v[152:155]
  v_mfma_f32_16x16x32_bf16 v[156:159], a[44:47], v[220:223], v[156:159]
  s_waitcnt lgkmcnt(5)
  v_mfma_f32_16x16x32_bf16 v[64:67], a[48:51], v[160:163], v[64:67]
  ds_read_b128 v[192:195], v19 offset:0
  v_mfma_f32_16x16x32_bf16 v[68:71], a[52:55], v[160:163], v[68:71]
  v_add_u32 v18, s33, v14
  v_mfma_f32_16x16x32_bf16 v[72:75], a[56:59], v[160:163], v[72:75]
  v_mfma_f32_16x16x32_bf16 v[76:79], a[48:51], v[164:167], v[76:79]
  ds_read_b128 v[196:199], v19 offset:2048
  v_mfma_f32_16x16x32_bf16 v[80:83], a[52:55], v[164:167], v[80:83]
  buffer_load_dwordx4 v12, s[8:11], s30 offen offset:2048 lds
  v_mfma_f32_16x16x32_bf16 v[84:87], a[56:59], v[164:167], v[84:87]
  v_mfma_f32_16x16x32_bf16 v[88:91], a[48:51], v[168:171], v[88:91]
  ds_read_b128 v[200:203], v19 offset:4096
  v_mfma_f32_16x16x32_bf16 v[92:95], a[52:55], v[168:171], v[92:95]
  s_add_u32 s21, s48, 0
  ds_read_b128 v[232:235], v23 offset:128
  v_mfma_f32_16x16x32_bf16 v[96:99], a[56:59], v[168:171], v[96:99]
  v_mfma_f32_16x16x32_bf16 v[100:103], a[48:51], v[172:175], v[100:103]
  ds_read_b128 v[204:207], v19 offset:6144
  v_mfma_f32_16x16x32_bf16 v[104:107], a[52:55], v[172:175], v[104:107]
  buffer_store_dwordx4 v[224:227], v26, s[16:19], s21 offen offset:0 sc1
  v_mfma_f32_16x16x32_bf16 v[108:111], a[56:59], v[172:175], v[108:111]
  s_waitcnt lgkmcnt(5)
  v_mfma_f32_16x16x32_bf16 v[112:115], a[48:51], v[176:179], v[112:115]
  ds_read_b128 v[208:211], v19 offset:8192
  v_mfma_f32_16x16x32_bf16 v[116:119], a[52:55], v[176:179], v[116:119]
  v_mfma_f32_16x16x32_bf16 v[120:123], a[56:59], v[176:179], v[120:123]
  v_mfma_f32_16x16x32_bf16 v[124:127], a[48:51], v[180:183], v[124:127]
  ds_read_b128 v[212:215], v19 offset:10240
  v_mfma_f32_16x16x32_bf16 v[128:131], a[52:55], v[180:183], v[128:131]
  buffer_load_dwordx4 v13, s[8:11], s30 offen offset:3072 lds
  v_mfma_f32_16x16x32_bf16 v[132:135], a[56:59], v[180:183], v[132:135]
  s_add_u32 s30, s30, 128
  s_add_u32 m0, m0, 16384
  v_mfma_f32_16x16x32_bf16 v[136:139], a[48:51], v[184:187], v[136:139]
  ds_read_b128 v[216:219], v19 offset:12288
  v_mfma_f32_16x16x32_bf16 v[140:143], a[52:55], v[184:187], v[140:143]
  s_cmp_lt_u32 m0, s46
  s_cselect_b32 m0, m0, s47
  v_mfma_f32_16x16x32_bf16 v[144:147], a[56:59], v[184:187], v[144:147]
  ds_read_b128 v[236:239], v23 offset:192
  v_mfma_f32_16x16x32_bf16 v[148:151], a[48:51], v[188:191], v[148:151]
  ds_read_b128 v[220:223], v19 offset:14336
  v_mfma_f32_16x16x32_bf16 v[152:155], a[52:55], v[188:191], v[152:155]
  buffer_store_dwordx4 v[228:231], v26, s[16:19], s21 offen offset:1024 sc1
  v_mfma_f32_16x16x32_bf16 v[156:159], a[56:59], v[188:191], v[156:159]
  s_waitcnt vmcnt(14) lgkmcnt(5)
  s_barrier
  v_mfma_f32_16x16x32_bf16 v[64:67], a[60:63], v[192:195], v[64:67]
  ds_read_b128 v[160:163], v18 offset:0
  v_mfma_f32_16x16x32_bf16 v[68:71], a[64:67], v[192:195], v[68:71]
  v_mfma_f32_16x16x32_bf16 v[72:75], a[68:71], v[192:195], v[72:75]
  v_add_u32 v19, s33, v15
  s_add_u32 s33, s33, 16384
  v_mfma_f32_16x16x32_bf16 v[76:79], a[60:63], v[196:199], v[76:79]
  ds_read_b128 v[164:167], v18 offset:2048
  v_mfma_f32_16x16x32_bf16 v[80:83], a[64:67], v[196:199], v[80:83]
  buffer_load_dwordx4 v10, s[8:11], s30 offen offset:0 lds
  v_mfma_f32_16x16x32_bf16 v[84:87], a[68:71], v[196:199], v[84:87]
  s_cmp_lt_u32 s33, 98304
  s_cselect_b32 s33, s33, 0
  v_mfma_f32_16x16x32_bf16 v[88:91], a[60:63], v[200:203], v[88:91]
  ds_read_b128 v[168:171], v18 offset:4096
  v_mfma_f32_16x16x32_bf16 v[92:95], a[64:67], v[200:203], v[92:95]
  ds_read_b128 v[240:243], v23 offset:256
  v_mfma_f32_16x16x32_bf16 v[96:99], a[68:71], v[200:203], v[96:99]
  v_mfma_f32_16x16x32_bf16 v[100:103], a[60:63], v[204:207], v[100:103]
  ds_read_b128 v[172:175], v18 offset:6144
  v_mfma_f32_16x16x32_bf16 v[104:107], a[64:67], v[204:207], v[104:107]
  buffer_store_dwordx4 v[232:235], v26, s[16:19], s21 offen offset:2048 sc1
  v_mfma_f32_16x16x32_bf16 v[108:111], a[68:71], v[204:207], v[108:111]
  s_waitcnt lgkmcnt(5)
  v_mfma_f32_16x16x32_bf16 v[112:115], a[60:63], v[208:211], v[112:115]
  ds_read_b128 v[176:179], v18 offset:8192
  v_mfma_f32_16x16x32_bf16 v[116:119], a[64:67], v[208:211], v[116:119]
  v_mfma_f32_16x16x32_bf16 v[120:123], a[68:71], v[208:211], v[120:123]
  v_mfma_f32_16x16x32_bf16 v[124:127], a[60:63], v[212:215], v[124:127]
  ds_read_b128 v[180:183], v18 offset:10240
  v_mfma_f32_16x16x32_bf16 v[128:131], a[64:67], v[212:215], v[128:131]
  buffer_load_dwordx4 v11, s[8:11], s30 offen offset:1024 lds
  v_mfma_f32_16x16x32_bf16 v[132:135], a[68:71], v[212:215], v[132:135]
  v_mfma_f32_16x16x32_bf16 v[136:139], a[60:63], v[216:219], v[136:139]
  ds_read_b128 v[184:187], v18 offset:12288
  v_mfma_f32_16x16x32_bf16 v[140:143], a[64:67], v[216:219], v[140:143]
  ds_read_b128 v[244:247], v23 offset:320
  v_mfma_f32_16x16x32_bf16 v[144:147], a[68:71], v[216:219], v[144:147]
  v_mfma_f32_16x16x32_bf16 v[148:151], a[60:63], v[220:223], v[148:151]
  ds_read_b128 v[188:191], v18 offset:14336
  v_mfma_f32_16x16x32_bf16 v[152:155], a[64:67], v[220:223], v[152:155]
  buffer_store_dwordx4 v[236:239], v26, s[16:19], s21 offen offset:3072 sc1
  v_mfma_f32_16x16x32_bf16 v[156:159], a[68:71], v[220:223], v[156:159]
  s_waitcnt lgkmcnt(5)
  v_mfma_f32_16x16x32_bf16 v[64:67], a[72:75], v[160:163], v[64:67]
  ds_read_b128 v[192:195], v19 offset:0
  v_mfma_f32_16x16x32_bf16 v[68:71], a[76:79], v[160:163], v[68:71]
  v_add_u32 v18, s33, v14
  v_mfma_f32_16x16x32_bf16 v[72:75], a[80:83], v[160:163], v[72:75]
  v_mfma_f32_16x16x32_bf16 v[76:79], a[72:75], v[164:167], v[76:79]
  ds_read_b128 v[196:199], v19 offset:2048
  v_mfma_f32_16x16x32_bf16 v[80:83], a[76:79], v[164:167], v[80:83]
  buffer_load_dwordx4 v12, s[8:11], s30 offen offset:2048 lds
  v_mfma_f32_16x16x32_bf16 v[84:87], a[80:83], v[164:167], v[84:87]
  v_mfma_f32_16x16x32_bf16 v[88:91], a[72:75], v[168:171], v[88:91]
  ds_read_b128 v[200:203], v19 offset:4096
  v_mfma_f32_16x16x32_bf16 v[92:95], a[76:79], v[168:171], v[92:95]
  s_add_u32 s21, s48, 4096
  ds_read_b128 v[224:227], v23 offset:6400
  v_mfma_f32_16x16x32_bf16 v[96:99], a[80:83], v[168:171], v[96:99]
  v_mfma_f32_16x16x32_bf16 v[100:103], a[72:75], v[172:175], v[100:103]
  ds_read_b128 v[204:207], v19 offset:6144
  v_mfma_f32_16x16x32_bf16 v[104:107], a[76:79], v[172:175], v[104:107]
  buffer_store_dwordx4 v[240:243], v26, s[16:19], s21 offen offset:0 sc1
  v_mfma_f32_16x16x32_bf16 v[108:111], a[80:83], v[172:175], v[108:111]
  s_waitcnt lgkmcnt(5)
  v_mfma_f32_16x16x32_bf16 v[112:115], a[72:75], v[176:179], v[112:115]
  ds_read_b128 v[208:211], v19 offset:8192
  v_mfma_f32_16x16x32_bf16 v[116:119], a[76:79], v[176:179], v[116:119]
  v_mfma_f32_16x16x32_bf16 v[120:123], a[80:83], v[176:179], v[120:123]
  v_mfma_f32_16x16x32_bf16 v[124:127], a[72:75], v[180:183], v[124:127]
  ds_read_b128 v[212:215], v19 offset:10240
  v_mfma_f32_16x16x32_bf16 v[128:131], a[76:79], v[180:183], v[128:131]
  buffer_load_dwordx4 v13, s[8:11], s30 offen offset:3072 lds
  v_mfma_f32_16x16x32_bf16 v[132:135], a[80:83], v[180:183], v[132:135]
  s_add_u32 s30, s30, 128
  s_add_u32 m0, m0, 16384
  v_mfma_f32_16x16x32_bf16 v[136:139], a[72:75], v[184:187], v[136:139]
  ds_read_b128 v[216:219], v19 offset:12288
  v_mfma_f32_16x16x32_bf16 v[140:143], a[76:79], v[184:187], v[140:143]
  s_cmp_lt_u32 m0, s46
  s_cselect_b32 m0, m0, s47
  v_mfma_f32_16x16x32_bf16 v[144:147], a[80:83], v[184:187], v[144:147]
  ds_read_b128 v[228:231], v23 offset:6464
  v_mfma_f32_16x16x32_bf16 v[148:151], a[72:75], v[188:191], v[148:151]
  ds_read_b128 v[220:223], v19 offset:14336
  v_mfma_f32_16x16x32_bf16 v[152:155], a[76:79], v[188:191], v[152:155]
  buffer_store_dwordx4 v[244:247], v26, s[16:19], s21 offen offset:1024 sc1
  v_mfma_f32_16x16x32_bf16 v[156:159], a[80:83], v[188:191], v[156:159]
  s_waitcnt vmcnt(18) lgkmcnt(5)
  s_barrier
  v_mfma_f32_16x16x32_bf16 v[64:67], a[84:87], v[192:195], v[64:67]
  ds_read_b128 v[160:163], v18 offset:0
  v_mfma_f32_16x16x32_bf16 v[68:71], a[88:91], v[192:195], v[68:71]
  v_mfma_f32_16x16x32_bf16 v[72:75], a[92:95], v[192:195], v[72:75]
  v_add_u32 v19, s33, v15
  s_add_u32 s33, s33, 16384
  v_mfma_f32_16x16x32_bf16 v[76:79], a[84:87], v[196:199], v[76:79]
  ds_read_b128 v[164:167], v18 offset:2048
  v_mfma_f32_16x16x32_bf16 v[80:83], a[88:91], v[196:199], v[80:83]
  buffer_load_dwordx4 v10, s[8:11], s30 offen offset:0 lds
  v_mfma_f32_16x16x32_bf16 v[84:87], a[92:95], v[196:199], v[84:87]
  s_cmp_lt_u32 s33, 98304
  s_cselect_b32 s33, s33, 0
  v_mfma_f32_16x16x32_bf16 v[88:91], a[84:87], v[200:203], v[88:91]
  ds_read_b128 v[168:171], v18 offset:4096
  v_mfma_f32_16x16x32_bf16 v[92:95], a[88:91], v[200:203], v[92:95]
  ds_read_b128 v[232:235], v23 offset:6528
  v_mfma_f32_16x16x32_bf16 v[96:99], a[92:95], v[200:203], v[96:99]
  v_mfma_f32_16x16x32_bf16 v[100:103], a[84:87], v[204:207], v[100:103]
  ds_read_b128 v[172:175], v18 offset:6144
  v_mfma_f32_16x16x32_bf16 v[104:107], a[88:91], v[204:207], v[104:107]
  buffer_store_dwordx4 v[224:227], v26, s[16:19], s21 offen offset:2048 sc1
  v_mfma_f32_16x16x32_bf16 v[108:111], a[92:95], v[204:207], v[108:111]
  s_waitcnt lgkmcnt(5)
  v_mfma_f32_16x16x32_bf16 v[112:115], a[84:87], v[208:211], v[112:115]
  ds_read_b128 v[176:179], v18 offset:8192
  v_mfma_f32_16x16x32_bf16 v[116:119], a[88:91], v[208:211], v[116:119]
  v_mfma_f32_16x16x32_bf16 v[120:123], a[92:95], v[208:211], v[120:123]
  v_mfma_f32_16x16x32_bf16 v[124:127], a[84:87], v[212:215], v[124:127]
  ds_read_b128 v[180:183], v18 offset:10240
  v_mfma_f32_16x16x32_bf16 v[128:131], a[88:91], v[212:215], v[128:131]
  buffer_load_dwordx4 v11, s[8:11], s30 offen offset:1024 lds
  v_mfma_f32_16x16x32_bf16 v[132:135], a[92:95], v[212:215], v[132:135]
  v_mfma_f32_16x16x32_bf16 v[136:139], a[84:87], v[216:219], v[136:139]
  ds_read_b128 v[184:187], v18 offset:12288
  v_mfma_f32_16x16x32_bf16 v[140:143], a[88:91], v[216:219], v[140:143]
  ds_read_b128 v[236:239], v23 offset:6592
  v_mfma_f32_16x16x32_bf16 v[144:147], a[92:95], v[216:219], v[144:147]
  v_mfma_f32_16x16x32_bf16 v[148:151], a[84:87], v[220:223], v[148:151]
  ds_read_b128 v[188:191], v18 offset:14336
  v_mfma_f32_16x16x32_bf16 v[152:155], a[88:91], v[220:223], v[152:155]
  buffer_store_dwordx4 v[228:231], v26, s[16:19], s21 offen offset:3072 sc1
  v_mfma_f32_16x16x32_bf16 v[156:159], a[92:95], v[220:223], v[156:159]
  s_waitcnt lgkmcnt(5)
  v_mfma_f32_16x16x32_bf16 v[64:67], a[96:99], v[160:163], v[64:67]
  ds_read_b128 v[192:195], v19 offset:0
  v_mfma_f32_16x16x32_bf16 v[68:71], a[100:103], v[160:163], v[68:71]
  v_add_u32 v18, s33, v14
  v_mfma_f32_16x16x32_bf16 v[72:75], a[104:107], v[160:163], v[72:75]
  v_mfma_f32_16x16x32_bf16 v[76:79], a[96:99], v[164:167], v[76:79]
  ds_read_b128 v[196:199], v19 offset:2048
  v_mfma_f32_16x16x32_bf16 v[80:83], a[100:103], v[164:167], v[80:83]
  buffer_load_dwordx4 v12, s[8:11], s30 offen offset:2048 lds
  v_mfma_f32_16x16x32_bf16 v[84:87], a[104:107], v[164:167], v[84:87]
  v_mfma_f32_16x16x32_bf16 v[88:91], a[96:99], v[168:171], v[88:91]
  ds_read_b128 v[200:203], v19 offset:4096
  v_mfma_f32_16x16x32_bf16 v[92:95], a[100:103], v[168:171], v[92:95]
  s_add_u32 s21, s48, 8192
  ds_read_b128 v[240:243], v23 offset:6656
  v_mfma_f32_16x16x32_bf16 v[96:99], a[104:107], v[168:171], v[96:99]
  v_mfma_f32_16x16x32_bf16 v[100:103], a[96:99], v[172:175], v[100:103]
  ds_read_b128 v[204:207], v19 offset:6144
  v_mfma_f32_16x16x32_bf16 v[104:107], a[100:103], v[172:175], v[104:107]
  buffer_store_dwordx4 v[232:235], v26, s[16:19], s21 offen offset:0 sc1
  v_mfma_f32_16x16x32_bf16 v[108:111], a[104:107], v[172:175], v[108:111]
  s_waitcnt lgkmcnt(5)
  v_mfma_f32_16x16x32_bf16 v[112:115], a[96:99], v[176:179], v[112:115]
  ds_read_b128 v[208:211], v19 offset:8192
  v_mfma_f32_16x16x32_bf16 v[116:119], a[100:103], v[176:179], v[116:119]
  v_mfma_f32_16x16x32_bf16 v[120:123], a[104:107], v[176:179], v[120:123]
  v_mfma_f32_16x16x32_bf16 v[124:127], a[96:99], v[180:183], v[124:127]
  ds_read_b128 v[212:215], v19 offset:10240
  v_mfma_f32_16x16x32_bf16 v[128:131], a[100:103], v[180:183], v[128:131]
  buffer_load_dwordx4 v13, s[8:11], s30 offen offset:3072 lds
  v_mfma_f32_16x16x32_bf16 v[132:135], a[104:107], v[180:183], v[132:135]
  s_add_u32 s30, s30, 128
  s_add_u32 m0, m0, 16384
  v_mfma_f32_16x16x32_bf16 v[136:139], a[96:99], v[184:187], v[136:139]
  ds_read_b128 v[216:219], v19 offset:12288
  v_mfma_f32_16x16x32_bf16 v[140:143], a[100:103], v[184:187], v[140:143]
  s_cmp_lt_u32 m0, s46
  s_cselect_b32 m0, m0, s47
  v_mfma_f32_16x16x32_bf16 v[144:147], a[104:107], v[184:187], v[144:147]
  ds_read_b128 v[244:247], v23 offset:6720
  v_mfma_f32_16x16x32_bf16 v[148:151], a[96:99], v[188:191], v[148:151]
  ds_read_b128 v[220:223], v19 offset:14336
  v_mfma_f32_16x16x32_bf16 v[152:155], a[100:103], v[188:191], v[152:155]
  buffer_store_dwordx4 v[236:239], v26, s[16:19], s21 offen offset:1024 sc1
  v_mfma_f32_16x16x32_bf16 v[156:159], a[104:107], v[188:191], v[156:159]
  s_waitcnt vmcnt(22) lgkmcnt(5)
  s_barrier
  v_mfma_f32_16x16x32_bf16 v[64:67], a[108:111], v[192:195], v[64:67]
  ds_read_b128 v[160:163], v18 offset:0
  v_mfma_f32_16x16x32_bf16 v[68:71], a[112:115], v[192:195], v[68:71]
  v_mfma_f32_16x16x32_bf16 v[72:75], a[116:119], v[192:195], v[72:75]
  v_add_u32 v19, s33, v15
  s_add_u32 s33, s33, 16384
  v_mfma_f32_16x16x32_bf16 v[76:79], a[108:111], v[196:199], v[76:79]
  ds_read_b128 v[164:167], v18 offset:2048
  v_mfma_f32_16x16x32_bf16 v[80:83], a[112:115], v[196:199], v[80:83]
  buffer_load_dwordx4 v10, s[8:11], s30 offen offset:0 lds
  v_mfma_f32_16x16x32_bf16 v[84:87], a[116:119], v[196:199], v[84:87]
  s_cmp_lt_u32 s33, 98304
  s_cselect_b32 s33, s33, 0
  v_mfma_f32_16x16x32_bf16 v[88:91], a[108:111], v[200:203], v[88:91]
  ds_read_b128 v[168:171], v18 offset:4096
  v_mfma_f32_16x16x32_bf16 v[92:95], a[112:115], v[200:203], v[92:95]
  v_mfma_f32_16x16x32_bf16 v[96:99], a[116:119], v[200:203], v[96:99]
  v_mfma_f32_16x16x32_bf16 v[100:103], a[108:111], v[204:207], v[100:103]
  ds_read_b128 v[172:175], v18 offset:6144
  v_mfma_f32_16x16x32_bf16 v[104:107], a[112:115], v[204:207], v[104:107]
  buffer_store_dwordx4 v[240:243], v26, s[16:19], s21 offen offset:2048 sc1
  v_mfma_f32_16x16x32_bf16 v[108:111], a[116:119], v[204:207], v[108:111]
  s_waitcnt lgkmcnt(4)
  v_mfma_f32_16x16x32_bf16 v[112:115], a[108:111], v[208:211], v[112:115]
  ds_read_b128 v[176:179], v18 offset:8192
  v_mfma_f32_16x16x32_bf16 v[116:119], a[112:115], v[208:211], v[116:119]
  v_mfma_f32_16x16x32_bf16 v[120:123], a[116:119], v[208:211], v[120:123]
  v_mfma_f32_16x16x32_bf16 v[124:127], a[108:111], v[212:215], v[124:127]
  ds_read_b128 v[180:183], v18 offset:10240
  v_mfma_f32_16x16x32_bf16 v[128:131], a[112:115], v[212:215], v[128:131]
  buffer_load_dwordx4 v11, s[8:11], s30 offen offset:1024 lds
  v_mfma_f32_16x16x32_bf16 v[132:135], a[116:119], v[212:215], v[132:135]
  v_mfma_f32_16x16x32_bf16 v[136:139], a[108:111], v[216:219], v[136:139]
  ds_read_b128 v[184:187], v18 offset:12288
  v_mfma_f32_16x16x32_bf16 v[140:143], a[112:115], v[216:219], v[140:143]
  v_mfma_f32_16x16x32_bf16 v[144:147], a[116:119], v[216:219], v[144:147]
  v_mfma_f32_16x16x32_bf16 v[148:151], a[108:111], v[220:223], v[148:151]
  ds_read_b128 v[188:191], v18 offset:14336
  v_mfma_f32_16x16x32_bf16 v[152:155], a[112:115], v[220:223], v[152:155]
  buffer_store_dwordx4 v[244:247], v26, s[16:19], s21 offen offset:3072 sc1
  v_mfma_f32_16x16x32_bf16 v[156:159], a[116:119], v[220:223], v[156:159]
  s_waitcnt lgkmcnt(4)
  v_mfma_f32_16x16x32_bf16 v[64:67], a[120:123], v[160:163], v[64:67]
  ds_read_b128 v[192:195], v19 offset:0
  v_mfma_f32_16x16x32_bf16 v[68:71], a[124:127], v[160:163], v[68:71]
  v_add_u32 v18, s33, v14
  v_mfma_f32_16x16x32_bf16 v[72:75], a[128:131], v[160:163], v[72:75]
  v_mfma_f32_16x16x32_bf16 v[76:79], a[120:123], v[164:167], v[76:79]
  ds_read_b128 v[196:199], v19 offset:2048
  v_mfma_f32_16x16x32_bf16 v[80:83], a[124:127], v[164:167], v[80:83]
  buffer_load_dwordx4 v12, s[8:11], s30 offen offset:2048 lds
  v_mfma_f32_16x16x32_bf16 v[84:87], a[128:131], v[164:167], v[84:87]
  v_mfma_f32_16x16x32_bf16 v[88:91], a[120:123], v[168:171], v[88:91]
  ds_read_b128 v[200:203], v19 offset:4096
  v_mfma_f32_16x16x32_bf16 v[92:95], a[124:127], v[168:171], v[92:95]
  v_mfma_f32_16x16x32_bf16 v[96:99], a[128:131], v[168:171], v[96:99]
  v_mfma_f32_16x16x32_bf16 v[100:103], a[120:123], v[172:175], v[100:103]
  ds_read_b128 v[204:207], v19 offset:6144
  v_mfma_f32_16x16x32_bf16 v[104:107], a[124:127], v[172:175], v[104:107]
  v_mfma_f32_16x16x32_bf16 v[108:111], a[128:131], v[172:175], v[108:111]
  s_waitcnt lgkmcnt(4)
  v_mfma_f32_16x16x32_bf16 v[112:115], a[120:123], v[176:179], v[112:115]
  ds_read_b128 v[208:211], v19 offset:8192
  v_mfma_f32_16x16x32_bf16 v[116:119], a[124:127], v[176:179], v[116:119]
  v_mfma_f32_16x16x32_bf16 v[120:123], a[128:131], v[176:179], v[120:123]
  v_mfma_f32_16x16x32_bf16 v[124:127], a[120:123], v[180:183], v[124:127]
  ds_read_b128 v[212:215], v19 offset:10240
  v_mfma_f32_16x16x32_bf16 v[128:131], a[124:127], v[180:183], v[128:131]
  buffer_load_dwordx4 v13, s[8:11], s30 offen offset:3072 lds
  v_mfma_f32_16x16x32_bf16 v[132:135], a[128:131], v[180:183], v[132:135]
  s_add_u32 s30, s30, s25
  s_sub_u32 s30, s30, 1152
  v_mfma_f32_16x16x32_bf16 v[136:139], a[120:123], v[184:187], v[136:139]
  ds_read_b128 v[216:219], v19 offset:12288
  s_add_u32 m0, m0, 16384
  v_mfma_f32_16x16x32_bf16 v[140:143], a[124:127], v[184:187], v[140:143]
  s_cmp_lt_u32 m0, s46
  s_cselect_b32 m0, m0, s47
  v_mfma_f32_16x16x32_bf16 v[144:147], a[128:131], v[184:187], v[144:147]
  v_mfma_f32_16x16x32_bf16 v[148:151], a[120:123], v[188:191], v[148:151]
  ds_read_b128 v[220:223], v19 offset:14336
  v_mfma_f32_16x16x32_bf16 v[152:155], a[124:127], v[188:191], v[152:155]
  v_mfma_f32_16x16x32_bf16 v[156:159], a[128:131], v[188:191], v[156:159]
  s_waitcnt vmcnt(23) lgkmcnt(4)
  s_barrier
  v_mfma_f32_16x16x32_bf16 v[64:67], a[132:135], v[192:195], v[64:67]
  ds_read_b128 v[160:163], v18 offset:0
  v_mfma_f32_16x16x32_bf16 v[68:71], a[136:139], v[192:195], v[68:71]
  v_mfma_f32_16x16x32_bf16 v[72:75], a[140:143], v[192:195], v[72:75]
  v_add_u32 v19, s33, v15
  s_add_u32 s33, s33, 16384
  v_mfma_f32_16x16x32_bf16 v[76:79], a[132:135], v[196:199], v[76:79]
  ds_read_b128 v[164:167], v18 offset:2048
  v_mfma_f32_16x16x32_bf16 v[80:83], a[136:139], v[196:199], v[80:83]
  buffer_load_dwordx4 v10, s[8:11], s30 offen offset:0 lds
  v_mfma_f32_16x16x32_bf16 v[84:87], a[140:143], v[196:199], v[84:87]
  s_cmp_lt_u32 s33, 98304
  s_cselect_b32 s33, s33, 0
  v_mfma_f32_16x16x32_bf16 v[88:91], a[132:135], v[200:203], v[88:91]
  ds_read_b128 v[168:171], v18 offset:4096
  v_mfma_f32_16x16x32_bf16 v[92:95], a[136:139], v[200:203], v[92:95]
  v_mfma_f32_16x16x32_bf16 v[96:99], a[140:143], v[200:203], v[96:99]
  v_mfma_f32_16x16x32_bf16 v[100:103], a[132:135], v[204:207], v[100:103]
  ds_read_b128 v[172:175], v18 offset:6144
  v_mfma_f32_16x16x32_bf16 v[104:107], a[136:139], v[204:207], v[104:107]
  v_mfma_f32_16x16x32_bf16 v[108:111], a[140:143], v[204:207], v[108:111]
  s_waitcnt lgkmcnt(4)
  v_mfma_f32_16x16x32_bf16 v[112:115], a[132:135], v[208:211], v[112:115]
  ds_read_b128 v[176:179], v18 offset:8192
  v_mfma_f32_16x16x32_bf16 v[116:119], a[136:139], v[208:211], v[116:119]
  v_mfma_f32_16x16x32_bf16 v[120:123], a[140:143], v[208:211], v[120:123]
  v_mfma_f32_16x16x32_bf16 v[124:127], a[132:135], v[212:215], v[124:127]
  ds_read_b128 v[180:183], v18 offset:10240
  v_mfma_f32_16x16x32_bf16 v[128:131], a[136:139], v[212:215], v[128:131]
  buffer_load_dwordx4 v11, s[8:11], s30 offen offset:1024 lds
  v_mfma_f32_16x16x32_bf16 v[132:135], a[140:143], v[212:215], v[132:135]
  v_mfma_f32_16x16x32_bf16 v[136:139], a[132:135], v[216:219], v[136:139]
  ds_read_b128 v[184:187], v18 offset:12288
  v_mfma_f32_16x16x32_bf16 v[140:143], a[136:139], v[216:219], v[140:143]
  v_mfma_f32_16x16x32_bf16 v[144:147], a[140:143], v[216:219], v[144:147]
  v_mfma_f32_16x16x32_bf16 v[148:151], a[132:135], v[220:223], v[148:151]
  ds_read_b128 v[188:191], v18 offset:14336
  v_mfma_f32_16x16x32_bf16 v[152:155], a[136:139], v[220:223], v[152:155]
  v_mfma_f32_16x16x32_bf16 v[156:159], a[140:143], v[220:223], v[156:159]
  s_waitcnt lgkmcnt(4)
  v_mfma_f32_16x16x32_bf16 v[64:67], a[144:147], v[160:163], v[64:67]
  ds_read_b128 v[192:195], v19 offset:0
  v_mfma_f32_16x16x32_bf16 v[68:71], a[148:151], v[160:163], v[68:71]
  v_add_u32 v18, s33, v14
  v_mfma_f32_16x16x32_bf16 v[72:75], a[152:155], v[160:163], v[72:75]
  v_mfma_f32_16x16x32_bf16 v[76:79], a[144:147], v[164:167], v[76:79]
  ds_read_b128 v[196:199], v19 offset:2048
  v_mfma_f32_16x16x32_bf16 v[80:83], a[148:151], v[164:167], v[80:83]
  buffer_load_dwordx4 v12, s[8:11], s30 offen offset:2048 lds
  v_mfma_f32_16x16x32_bf16 v[84:87], a[152:155], v[164:167], v[84:87]
  v_mfma_f32_16x16x32_bf16 v[88:91], a[144:147], v[168:171], v[88:91]
  ds_read_b128 v[200:203], v19 offset:4096
  v_mfma_f32_16x16x32_bf16 v[92:95], a[148:151], v[168:171], v[92:95]
  v_mfma_f32_16x16x32_bf16 v[96:99], a[152:155], v[168:171], v[96:99]
  v_mfma_f32_16x16x32_bf16 v[100:103], a[144:147], v[172:175], v[100:103]
  ds_read_b128 v[204:207], v19 offset:6144
  v_mfma_f32_16x16x32_bf16 v[104:107], a[148:151], v[172:175], v[104:107]
  v_mfma_f32_16x16x32_bf16 v[108:111], a[152:155], v[172:175], v[108:111]
  s_waitcnt lgkmcnt(4)
  v_mfma_f32_16x16x32_bf16 v[112:115], a[144:147], v[176:179], v[112:115]
  ds_read_b128 v[208:211], v19 offset:8192
  v_mfma_f32_16x16x32_bf16 v[116:119], a[148:151], v[176:179], v[116:119]
  v_mfma_f32_16x16x32_bf16 v[120:123], a[152:155], v[176:179], v[120:123]
  v_mfma_f32_16x16x32_bf16 v[124:127], a[144:147], v[180:183], v[124:127]
  ds_read_b128 v[212:215], v19 offset:10240
  v_mfma_f32_16x16x32_bf16 v[128:131], a[148:151], v[180:183], v[128:131]
  buffer_load_dwordx4 v13, s[8:11], s30 offen offset:3072 lds
  v_mfma_f32_16x16x32_bf16 v[132:135], a[152:155], v[180:183], v[132:135]
  s_add_u32 s30, s30, 128
  s_add_u32 m0, m0, 16384
  v_mfma_f32_16x16x32_bf16 v[136:139], a[144:147], v[184:187], v[136:139]
  ds_read_b128 v[216:219], v19 offset:12288
  v_mfma_f32_16x16x32_bf16 v[140:143], a[148:151], v[184:187], v[140:143]
  s_cmp_lt_u32 m0, s46
  s_cselect_b32 m0, m0, s47
  v_mfma_f32_16x16x32_bf16 v[144:147], a[152:155], v[184:187], v[144:147]
  v_mfma_f32_16x16x32_bf16 v[148:151], a[144:147], v[188:191], v[148:151]
  ds_read_b128 v[220:223], v19 offset:14336
  v_mfma_f32_16x16x32_bf16 v[152:155], a[148:151], v[188:191], v[152:155]
  v_mfma_f32_16x16x32_bf16 v[156:159], a[152:155], v[188:191], v[156:159]
  s_waitcnt vmcnt(6) lgkmcnt(4)
  s_barrier
  v_mfma_f32_16x16x32_bf16 v[64:67], a[156:159], v[192:195], v[64:67]
  ds_read_b128 v[160:163], v18 offset:0
  v_mfma_f32_16x16x32_bf16 v[68:71], a[160:163], v[192:195], v[68:71]
  s_cmp_eq_u32 s48, 0x80000000
  s_cbranch_scc1 kv_155
  s_cmp_lg_u32 s20, 0
  s_cbranch_scc1 af_156
  v_mov_b32 v4, 0
  v_mov_b32 v5, 1
  s_mov_b64 exec, 1
  buffer_atomic_add v5, v4, s[72:75], s61 offen sc1
  s_mov_b64 exec, -1
  s_nop 1
af_156:
kv_155:
  v_mfma_f32_16x16x32_bf16 v[72:75], a[164:167], v[192:195], v[72:75]
  v_add_u32 v19, s33, v15
  s_add_u32 s33, s33, 16384
  v_mfma_f32_16x16x32_bf16 v[76:79], a[156:159], v[196:199], v[76:79]
  ds_read_b128 v[164:167], v18 offset:2048
  v_mfma_f32_16x16x32_bf16 v[80:83], a[160:163], v[196:199], v[80:83]
  buffer_load_dwordx4 v10, s[8:11], s30 offen offset:0 lds
  v_mfma_f32_16x16x32_bf16 v[84:87], a[164:167], v[196:199], v[84:87]
  s_cmp_lt_u32 s33, 98304
  s_cselect_b32 s33, s33, 0
  v_mfma_f32_16x16x32_bf16 v[88:91], a[156:159], v[200:203], v[88:91]
  ds_read_b128 v[168:171], v18 offset:4096
  v_mfma_f32_16x16x32_bf16 v[92:95], a[160:163], v[200:203], v[92:95]
  v_mfma_f32_16x16x32_bf16 v[96:99], a[164:167], v[200:203], v[96:99]
  v_mfma_f32_16x16x32_bf16 v[100:103], a[156:159], v[204:207], v[100:103]
  ds_read_b128 v[172:175], v18 offset:6144
  v_mfma_f32_16x16x32_bf16 v[104:107], a[160:163], v[204:207], v[104:107]
  v_mfma_f32_16x16x32_bf16 v[108:111], a[164:167], v[204:207], v[108:111]
  s_waitcnt lgkmcnt(4)
  v_mfma_f32_16x16x32_bf16 v[112:115], a[156:159], v[208:211], v[112:115]
  ds_read_b128 v[176:179], v18 offset:8192
  v_mfma_f32_16x16x32_bf16 v[116:119], a[160:163], v[208:211], v[116:119]
  v_mfma_f32_16x16x32_bf16 v[120:123], a[164:167], v[208:211], v[120:123]
  v_mfma_f32_16x16x32_bf16 v[124:127], a[156:159], v[212:215], v[124:127]
  ds_read_b128 v[180:183], v18 offset:10240
  v_mfma_f32_16x16x32_bf16 v[128:131], a[160:163], v[212:215], v[128:131]
  buffer_load_dwordx4 v11, s[8:11], s30 offen offset:1024 lds
  v_mfma_f32_16x16x32_bf16 v[132:135], a[164:167], v[212:215], v[132:135]
  v_mfma_f32_16x16x32_bf16 v[136:139], a[156:159], v[216:219], v[136:139]
  ds_read_b128 v[184:187], v18 offset:12288
  v_mfma_f32_16x16x32_bf16 v[140:143], a[160:163], v[216:219], v[140:143]
  v_mfma_f32_16x16x32_bf16 v[144:147], a[164:167], v[216:219], v[144:147]
  v_mfma_f32_16x16x32_bf16 v[148:151], a[156:159], v[220:223], v[148:151]
  ds_read_b128 v[188:191], v18 offset:14336
  v_mfma_f32_16x16x32_bf16 v[152:155], a[160:163], v[220:223], v[152:155]
  v_mfma_f32_16x16x32_bf16 v[156:159], a[164:167], v[220:223], v[156:159]
  s_waitcnt lgkmcnt(4)
  v_mfma_f32_16x16x32_bf16 v[64:67], a[168:171], v[160:163], v[64:67]
  ds_read_b128 v[192:195], v19 offset:0
  v_mfma_f32_16x16x32_bf16 v[68:71], a[172:175], v[160:163], v[68:71]
  v_add_u32 v18, s33, v14
  s_mov_b32 s61, s60
  v_mfma_f32_16x16x32_bf16 v[72:75], a[176:179], v[160:163], v[72:75]
  s_add_u32 s60, s60, s62
  s_mul_i32 s48, s20, 393216
  v_mfma_f32_16x16x32_bf16 v[76:79], a[168:171], v[164:167], v[76:79]
  ds_read_b128 v[196:199], v19 offset:2048
  s_add_u32 s48, s48, s27
  v_mfma_f32_16x16x32_bf16 v[80:83], a[172:175], v[164:167], v[80:83]
  buffer_load_dwordx4 v12, s[8:11], s30 offen offset:2048 lds
  v_mfma_f32_16x16x32_bf16 v[84:87], a[176:179], v[164:167], v[84:87]
  s_add_u32 s27, s27, s28
  s_sub_u32 s26, s26, 1
  v_mfma_f32_16x16x32_bf16 v[88:91], a[168:171], v[168:171], v[88:91]
  ds_read_b128 v[200:203], v19 offset:4096
  v_mfma_f32_16x16x32_bf16 v[92:95], a[172:175], v[168:171], v[92:95]
  v_mfma_f32_16x16x32_bf16 v[96:99], a[176:179], v[168:171], v[96:99]
  v_mfma_f32_16x16x32_bf16 v[100:103], a[168:171], v[172:175], v[100:103]
  ds_read_b128 v[204:207], v19 offset:6144
  v_mfma_f32_16x16x32_bf16 v[104:107], a[172:175], v[172:175], v[104:107]
  v_mfma_f32_16x16x32_bf16 v[108:111], a[176:179], v[172:175], v[108:111]
  s_waitcnt lgkmcnt(4)
  v_mfma_f32_16x16x32_bf16 v[112:115], a[168:171], v[176:179], v[112:115]
  ds_read_b128 v[208:211], v19 offset:8192
  v_mfma_f32_16x16x32_bf16 v[116:119], a[172:175], v[176:179], v[116:119]
  v_mfma_f32_16x16x32_bf16 v[120:123], a[176:179], v[176:179], v[120:123]
  v_mfma_f32_16x16x32_bf16 v[124:127], a[168:171], v[180:183], v[124:127]
  ds_read_b128 v[212:215], v19 offset:10240
  v_mfma_f32_16x16x32_bf16 v[128:131], a[172:175], v[180:183], v[128:131]
  buffer_load_dwordx4 v13, s[8:11], s30 offen offset:3072 lds
  v_mfma_f32_16x16x32_bf16 v[132:135], a[176:179], v[180:183], v[132:135]
  s_add_u32 s30, s30, 128
  s_add_u32 m0, m0, 16384
  v_mfma_f32_16x16x32_bf16 v[136:139], a[168:171], v[184:187], v[136:139]
  ds_read_b128 v[216:219], v19 offset:12288
  v_mfma_f32_16x16x32_bf16 v[140:143], a[172:175], v[184:187], v[140:143]
  s_cmp_lt_u32 m0, s46
  s_cselect_b32 m0, m0, s47
  v_mfma_f32_16x16x32_bf16 v[144:147], a[176:179], v[184:187], v[144:147]
  v_mfma_f32_16x16x32_bf16 v[148:151], a[168:171], v[188:191], v[148:151]
  ds_read_b128 v[220:223], v19 offset:14336
  v_mfma_f32_16x16x32_bf16 v[152:155], a[172:175], v[188:191], v[152:155]
  v_mfma_f32_16x16x32_bf16 v[156:159], a[176:179], v[188:191], v[156:159]
  s_waitcnt vmcnt(15) lgkmcnt(4)
  s_barrier
  v_mfma_f32_16x16x32_bf16 v[64:67], a[180:183], v[192:195], v[64:67]
  ds_read_b128 v[160:163], v18 offset:0
  v_mfma_f32_16x16x32_bf16 v[68:71], a[184:187], v[192:195], v[68:71]
  v_mfma_f32_16x16x32_bf16 v[72:75], a[188:191], v[192:195], v[72:75]
  v_add_u32 v19, s33, v15
  s_add_u32 s33, s33, 16384
  v_mfma_f32_16x16x32_bf16 v[76:79], a[180:183], v[196:199], v[76:79]
  ds_read_b128 v[164:167], v18 offset:2048
  v_mfma_f32_16x16x32_bf16 v[80:83], a[184:187], v[196:199], v[80:83]
  buffer_load_dwordx4 v10, s[8:11], s30 offen offset:0 lds
  v_mfma_f32_16x16x32_bf16 v[84:87], a[188:191], v[196:199], v[84:87]
  s_cmp_lt_u32 s33, 98304
  s_cselect_b32 s33, s33, 0
  v_mfma_f32_16x16x32_bf16 v[88:91], a[180:183], v[200:203], v[88:91]
  ds_read_b128 v[168:171], v18 offset:4096
  v_mfma_f32_16x16x32_bf16 v[92:95], a[184:187], v[200:203], v[92:95]
  v_mfma_f32_16x16x32_bf16 v[96:99], a[188:191], v[200:203], v[96:99]
  v_mfma_f32_16x16x32_bf16 v[100:103], a[180:183], v[204:207], v[100:103]
  ds_read_b128 v[172:175], v18 offset:6144
  v_mfma_f32_16x16x32_bf16 v[104:107], a[184:187], v[204:207], v[104:107]
  v_mfma_f32_16x16x32_bf16 v[108:111], a[188:191], v[204:207], v[108:111]
  s_waitcnt lgkmcnt(4)
  v_mfma_f32_16x16x32_bf16 v[112:115], a[180:183], v[208:211], v[112:115]
  ds_read_b128 v[176:179], v18 offset:8192
  v_mfma_f32_16x16x32_bf16 v[116:119], a[184:187], v[208:211], v[116:119]
  v_mfma_f32_16x16x32_bf16 v[120:123], a[188:191], v[208:211], v[120:123]
  v_mfma_f32_16x16x32_bf16 v[124:127], a[180:183], v[212:215], v[124:127]
  ds_read_b128 v[180:183], v18 offset:10240
  v_mfma_f32_16x16x32_bf16 v[128:131], a[184:187], v[212:215], v[128:131]
  buffer_load_dwordx4 v11, s[8:11], s30 offen offset:1024 lds
  v_mfma_f32_16x16x32_bf16 v[132:135], a[188:191], v[212:215], v[132:135]
  v_mfma_f32_16x16x32_bf16 v[136:139], a[180:183], v[216:219], v[136:139]
  ds_read_b128 v[184:187], v18 offset:12288
  v_mfma_f32_16x16x32_bf16 v[140:143], a[184:187], v[216:219], v[140:143]
  v_mfma_f32_16x16x32_bf16 v[144:147], a[188:191], v[216:219], v[144:147]
  v_mfma_f32_16x16x32_bf16 v[148:151], a[180:183], v[220:223], v[148:151]
  ds_read_b128 v[188:191], v18 offset:14336
  v_mfma_f32_16x16x32_bf16 v[152:155], a[184:187], v[220:223], v[152:155]
  v_mfma_f32_16x16x32_bf16 v[156:159], a[188:191], v[220:223], v[156:159]
  s_waitcnt lgkmcnt(4)
  v_mfma_f32_16x16x32_bf16 v[64:67], a[192:195], v[160:163], v[64:67]
  ds_read_b128 v[192:195], v19 offset:0
  v_mfma_f32_16x16x32_bf16 v[68:71], a[196:199], v[160:163], v[68:71]
  v_add_u32 v18, s33, v14
  v_mfma_f32_16x16x32_bf16 v[72:75], a[200:203], v[160:163], v[72:75]
  v_mfma_f32_16x16x32_bf16 v[76:79], a[192:195], v[164:167], v[76:79]
  ds_read_b128 v[196:199], v19 offset:2048
  v_mfma_f32_16x16x32_bf16 v[80:83], a[196:199], v[164:167], v[80:83]
  buffer_load_dwordx4 v12, s[8:11], s30 offen offset:2048 lds
  v_mfma_f32_16x16x32_bf16 v[84:87], a[200:203], v[164:167], v[84:87]
  v_mfma_f32_16x16x32_bf16 v[88:91], a[192:195], v[168:171], v[88:91]
  ds_read_b128 v[200:203], v19 offset:4096
  v_mfma_f32_16x16x32_bf16 v[92:95], a[196:199], v[168:171], v[92:95]
  v_mfma_f32_16x16x32_bf16 v[96:99], a[200:203], v[168:171], v[96:99]
  v_mfma_f32_16x16x32_bf16 v[100:103], a[192:195], v[172:175], v[100:103]
  ds_read_b128 v[204:207], v19 offset:6144
  v_mfma_f32_16x16x32_bf16 v[104:107], a[196:199], v[172:175], v[104:107]
  v_mfma_f32_16x16x32_bf16 v[108:111], a[200:203], v[172:175], v[108:111]
  s_waitcnt lgkmcnt(4)
  v_mfma_f32_16x16x32_bf16 v[112:115], a[192:195], v[176:179], v[112:115]
  ds_read_b128 v[208:211], v19 offset:8192
  v_mfma_f32_16x16x32_bf16 v[116:119], a[196:199], v[176:179], v[116:119]
  v_mfma_f32_16x16x32_bf16 v[120:123], a[200:203], v[176:179], v[120:123]
  v_mfma_f32_16x16x32_bf16 v[124:127], a[192:195], v[180:183], v[124:127]
  ds_read_b128 v[212:215], v19 offset:10240
  v_mfma_f32_16x16x32_bf16 v[128:131], a[196:199], v[180:183], v[128:131]
  buffer_load_dwordx4 v13, s[8:11], s30 offen offset:3072 lds
  v_mfma_f32_16x16x32_bf16 v[132:135], a[200:203], v[180:183], v[132:135]
  s_add_u32 s30, s30, 128
  s_add_u32 m0, m0, 16384
  v_mfma_f32_16x16x32_bf16 v[136:139], a[192:195], v[184:187], v[136:139]
  ds_read_b128 v[216:219], v19 offset:12288
  v_mfma_f32_16x16x32_bf16 v[140:143], a[196:199], v[184:187], v[140:143]
  s_cmp_lt_u32 m0, s46
  s_cselect_b32 m0, m0, s47
  v_mfma_f32_16x16x32_bf16 v[144:147], a[200:203], v[184:187], v[144:147]
  v_mfma_f32_16x16x32_bf16 v[148:151], a[192:195], v[188:191], v[148:151]
  ds_read_b128 v[220:223], v19 offset:14336
  v_mfma_f32_16x16x32_bf16 v[152:155], a[196:199], v[188:191], v[152:155]
  v_mfma_f32_16x16x32_bf16 v[156:159], a[200:203], v[188:191], v[156:159]
  s_waitcnt vmcnt(12) lgkmcnt(4)
  s_barrier
  v_mfma_f32_16x16x32_bf16 v[64:67], a[204:207], v[192:195], v[64:67]
  ds_read_b128 v[160:163], v18 offset:0
  v_mfma_f32_16x16x32_bf16 v[68:71], a[208:211], v[192:195], v[68:71]
  v_mfma_f32_16x16x32_bf16 v[72:75], a[212:215], v[192:195], v[72:75]
  v_add_u32 v19, s33, v15
  s_add_u32 s33, s33, 16384
  v_mfma_f32_16x16x32_bf16 v[76:79], a[204:207], v[196:199], v[76:79]
  ds_read_b128 v[164:167], v18 offset:2048
  v_mfma_f32_16x16x32_bf16 v[80:83], a[208:211], v[196:199], v[80:83]
  buffer_load_dwordx4 v10, s[8:11], s30 offen offset:0 lds
  v_mfma_f32_16x16x32_bf16 v[84:87], a[212:215], v[196:199], v[84:87]
  s_cmp_lt_u32 s33, 98304
  s_cselect_b32 s33, s33, 0
  v_mfma_f32_16x16x32_bf16 v[88:91], a[204:207], v[200:203], v[88:91]
  ds_read_b128 v[168:171], v18 offset:4096
  v_mfma_f32_16x16x32_bf16 v[92:95], a[208:211], v[200:203], v[92:95]
  v_mfma_f32_16x16x32_bf16 v[96:99], a[212:215], v[200:203], v[96:99]
  v_mfma_f32_16x16x32_bf16 v[100:103], a[204:207], v[204:207], v[100:103]
  ds_read_b128 v[172:175], v18 offset:6144
  v_mfma_f32_16x16x32_bf16 v[104:107], a[208:211], v[204:207], v[104:107]
  v_mfma_f32_16x16x32_bf16 v[108:111], a[212:215], v[204:207], v[108:111]
  s_waitcnt lgkmcnt(4)
  v_mfma_f32_16x16x32_bf16 v[112:115], a[204:207], v[208:211], v[112:115]
  ds_read_b128 v[176:179], v18 offset:8192
  v_mfma_f32_16x16x32_bf16 v[116:119], a[208:211], v[208:211], v[116:119]
  v_mfma_f32_16x16x32_bf16 v[120:123], a[212:215], v[208:211], v[120:123]
  v_mfma_f32_16x16x32_bf16 v[124:127], a[204:207], v[212:215], v[124:127]
  ds_read_b128 v[180:183], v18 offset:10240
  v_mfma_f32_16x16x32_bf16 v[128:131], a[208:211], v[212:215], v[128:131]
  buffer_load_dwordx4 v11, s[8:11], s30 offen offset:1024 lds
  v_mfma_f32_16x16x32_bf16 v[132:135], a[212:215], v[212:215], v[132:135]
  v_mfma_f32_16x16x32_bf16 v[136:139], a[204:207], v[216:219], v[136:139]
  ds_read_b128 v[184:187], v18 offset:12288
  v_mfma_f32_16x16x32_bf16 v[140:143], a[208:211], v[216:219], v[140:143]
  v_mfma_f32_16x16x32_bf16 v[144:147], a[212:215], v[216:219], v[144:147]
  v_mfma_f32_16x16x32_bf16 v[148:151], a[204:207], v[220:223], v[148:151]
  ds_read_b128 v[188:191], v18 offset:14336
  v_mfma_f32_16x16x32_bf16 v[152:155], a[208:211], v[220:223], v[152:155]
  v_mfma_f32_16x16x32_bf16 v[156:159], a[212:215], v[220:223], v[156:159]
  s_waitcnt lgkmcnt(4)
  v_mfma_f32_16x16x32_bf16 v[64:67], a[216:219], v[160:163], v[64:67]
  ds_read_b128 v[192:195], v19 offset:0
  v_mfma_f32_16x16x32_bf16 v[68:71], a[220:223], v[160:163], v[68:71]
  v_add_u32 v18, s33, v14
  v_mfma_f32_16x16x32_bf16 v[72:75], a[224:227], v[160:163], v[72:75]
  v_mfma_f32_16x16x32_bf16 v[76:79], a[216:219], v[164:167], v[76:79]
  ds_read_b128 v[196:199], v19 offset:2048
  v_mfma_f32_16x16x32_bf16 v[80:83], a[220:223], v[164:167], v[80:83]
  buffer_load_dwordx4 v12, s[8:11], s30 offen offset:2048 lds
  v_mfma_f32_16x16x32_bf16 v[84:87], a[224:227], v[164:167], v[84:87]
  v_mfma_f32_16x16x32_bf16 v[88:91], a[216:219], v[168:171], v[88:91]
  ds_read_b128 v[200:203], v19 offset:4096
  v_mfma_f32_16x16x32_bf16 v[92:95], a[220:223], v[168:171], v[92:95]
  v_mfma_f32_16x16x32_bf16 v[96:99], a[224:227], v[168:171], v[96:99]
  v_mfma_f32_16x16x32_bf16 v[100:103], a[216:219], v[172:175], v[100:103]
  ds_read_b128 v[204:207], v19 offset:6144
  v_mfma_f32_16x16x32_bf16 v[104:107], a[220:223], v[172:175], v[104:107]
  v_mfma_f32_16x16x32_bf16 v[108:111], a[224:227], v[172:175], v[108:111]
  s_waitcnt lgkmcnt(4)
  v_mfma_f32_16x16x32_bf16 v[112:115], a[216:219], v[176:179], v[112:115]
  ds_read_b128 v[208:211], v19 offset:8192
  v_mfma_f32_16x16x32_bf16 v[116:119], a[220:223], v[176:179], v[116:119]
  v_mfma_f32_16x16x32_bf16 v[120:123], a[224:227], v[176:179], v[120:123]
  v_mfma_f32_16x16x32_bf16 v[124:127], a[216:219], v[180:183], v[124:127]
  ds_read_b128 v[212:215], v19 offset:10240
  v_mfma_f32_16x16x32_bf16 v[128:131], a[220:223], v[180:183], v[128:131]
  buffer_load_dwordx4 v13, s[8:11], s30 offen offset:3072 lds
  v_mfma_f32_16x16x32_bf16 v[132:135], a[224:227], v[180:183], v[132:135]
  s_add_u32 s30, s30, 128
  s_add_u32 m0, m0, 16384
  v_mfma_f32_16x16x32_bf16 v[136:139], a[216:219], v[184:187], v[136:139]
  ds_read_b128 v[216:219], v19 offset:12288
  v_mfma_f32_16x16x32_bf16 v[140:143], a[220:223], v[184:187], v[140:143]
  s_cmp_lt_u32 m0, s46
  s_cselect_b32 m0, m0, s47
  v_mfma_f32_16x16x32_bf16 v[144:147], a[224:227], v[184:187], v[144:147]
  v_mfma_f32_16x16x32_bf16 v[148:151], a[216:219], v[188:191], v[148:151]
  ds_read_b128 v[220:223], v19 offset:14336
  v_mfma_f32_16x16x32_bf16 v[152:155], a[220:223], v[188:191], v[152:155]
  v_mfma_f32_16x16x32_bf16 v[156:159], a[224:227], v[188:191], v[156:159]
  s_waitcnt vmcnt(12) lgkmcnt(4)
  s_barrier
  v_mfma_f32_16x16x32_bf16 v[64:67], a[228:231], v[192:195], v[64:67]
  ds_read_b128 v[160:163], v18 offset:0
  v_mfma_f32_16x16x32_bf16 v[68:71], a[232:235], v[192:195], v[68:71]
  v_mfma_f32_16x16x32_bf16 v[72:75], a[236:239], v[192:195], v[72:75]
  v_add_u32 v19, s33, v15
  s_add_u32 s33, s33, 16384
  v_mfma_f32_16x16x32_bf16 v[76:79], a[228:231], v[196:199], v[76:79]
  ds_read_b128 v[164:167], v18 offset:2048
  v_cvt_pk_bf16_f32 v224, v64, v65
  v_mfma_f32_16x16x32_bf16 v[80:83], a[232:235], v[196:199], v[80:83]
  buffer_load_dwordx4 v10, s[8:11], s30 offen offset:0 lds
  v_mfma_f32_16x16x32_bf16 v[84:87], a[236:239], v[196:199], v[84:87]
  s_cmp_lt_u32 s33, 98304
  s_cselect_b32 s33, s33, 0
  v_mfma_f32_16x16x32_bf16 v[88:91], a[228:231], v[200:203], v[88:91]
  ds_read_b128 v[168:171], v18 offset:4096
  v_cvt_pk_bf16_f32 v225, v66, v67
  v_mfma_f32_16x16x32_bf16 v[92:95], a[232:235], v[200:203], v[92:95]
  v_cvt_pk_bf16_f32 v226, v68, v69
  v_cvt_pk_bf16_f32 v227, v70, v71
  v_mfma_f32_16x16x32_bf16 v[96:99], a[236:239], v[200:203], v[96:99]
  v_cvt_pk_bf16_f32 v228, v72, v73
  v_cvt_pk_bf16_f32 v229, v74, v75
  v_mfma_f32_16x16x32_bf16 v[100:103], a[228:231], v[204:207], v[100:103]
  ds_read_b128 v[172:175], v18 offset:6144
  v_mfma_f32_16x16x32_bf16 v[104:107], a[232:235], v[204:207], v[104:107]
  ds_write_b64 v22, v[224:225] offset:0
  v_mfma_f32_16x16x32_bf16 v[108:111], a[236:239], v[204:207], v[108:111]
  s_waitcnt lgkmcnt(5)
  v_mfma_f32_16x16x32_bf16 v[112:115], a[228:231], v[208:211], v[112:115]
  ds_read_b128 v[176:179], v18 offset:8192
  v_mfma_f32_16x16x32_bf16 v[116:119], a[232:235], v[208:211], v[116:119]
  ds_write_b64 v22, v[226:227] offset:8
  v_mfma_f32_16x16x32_bf16 v[120:123], a[236:239], v[208:211], v[120:123]
  ds_write_b64 v16, v[228:229] offset:64
  v_mfma_f32_16x16x32_bf16 v[124:127], a[228:231], v[212:215], v[124:127]
  ds_read_b128 v[180:183], v18 offset:10240
  v_cvt_pk_bf16_f32 v230, v76, v77
  v_mfma_f32_16x16x32_bf16 v[128:131], a[232:235], v[212:215], v[128:131]
  buffer_load_dwordx4 v11, s[8:11], s30 offen offset:1024 lds
  v_mfma_f32_16x16x32_bf16 v[132:135], a[236:239], v[212:215], v[132:135]
  v_cvt_pk_bf16_f32 v231, v78, v79
  v_cvt_pk_bf16_f32 v232, v80, v81
  v_mfma_f32_16x16x32_bf16 v[136:139], a[228:231], v[216:219], v[136:139]
  ds_read_b128 v[184:187], v18 offset:12288
  v_cvt_pk_bf16_f32 v233, v82, v83
  v_mfma_f32_16x16x32_bf16 v[140:143], a[232:235], v[216:219], v[140:143]
  v_cvt_pk_bf16_f32 v234, v84, v85
  v_cvt_pk_bf16_f32 v235, v86, v87
  v_mfma_f32_16x16x32_bf16 v[144:147], a[236:239], v[216:219], v[144:147]
  ds_write_b64 v22, v[230:231] offset:6400
  v_mfma_f32_16x16x32_bf16 v[148:151], a[228:231], v[220:223], v[148:151]
  ds_read_b128 v[188:191], v18 offset:14336
  v_mfma_f32_16x16x32_bf16 v[152:155], a[232:235], v[220:223], v[152:155]
  ds_write_b64 v22, v[232:233] offset:6408
  v_mfma_f32_16x16x32_bf16 v[156:159], a[236:239], v[220:223], v[156:159]
  s_waitcnt lgkmcnt(9)
kv_end_158:
  s_cmp_gt_u32 s26, 0
  s_cbranch_scc1 kv_blk_157
  s_nop 7
  ds_write_b64 v16, v[234:235] offset:6464
  v_cvt_pk_bf16_f32 v236, v88, v89
  v_cvt_pk_bf16_f32 v237, v90, v91
  v_cvt_pk_bf16_f32 v238, v92, v93
  v_cvt_pk_bf16_f32 v239, v94, v95
  v_cvt_pk_bf16_f32 v240, v96, v97
  v_cvt_pk_bf16_f32 v241, v98, v99
  ds_write_b64 v22, v[236:237] offset:12800
  ds_write_b64 v22, v[238:239] offset:12808
  ds_write_b64 v16, v[240:241] offset:12864
  v_cvt_pk_bf16_f32 v242, v100, v101
  v_cvt_pk_bf16_f32 v243, v102, v103
  v_cvt_pk_bf16_f32 v244, v104, v105
  v_cvt_pk_bf16_f32 v245, v106, v107
  v_cvt_pk_bf16_f32 v246, v108, v109
  v_cvt_pk_bf16_f32 v247, v110, v111
  ds_write_b64 v22, v[242:243] offset:19200
  ds_write_b64 v22, v[244:245] offset:19208
  ds_write_b64 v16, v[246:247] offset:19264
  v_cvt_pk_bf16_f32 v224, v112, v113
  v_cvt_pk_bf16_f32 v225, v114, v115
  v_cvt_pk_bf16_f32 v226, v116, v117
  v_cvt_pk_bf16_f32 v227, v118, v119
  v_cvt_pk_bf16_f32 v228, v120, v121
  v_cvt_pk_bf16_f32 v229, v122, v123
  ds_write_b64 v22, v[224:225] offset:25600
  ds_write_b64 v22, v[226:227] offset:25608
  ds_write_b64 v16, v[228:229] offset:25664
  v_cvt_pk_bf16_f32 v230, v124, v125
  v_cvt_pk_bf16_f32 v231, v126, v127
  v_cvt_pk_bf16_f32 v232, v128, v129
  v_cvt_pk_bf16_f32 v233, v130, v131
  v_cvt_pk_bf16_f32 v234, v132, v133
  v_cvt_pk_bf16_f32 v235, v134, v135
  ds_write_b64 v22, v[230:231] offset:32000
  ds_write_b64 v22, v[232:233] offset:32008
  ds_write_b64 v16, v[234:235] offset:32064
  v_cvt_pk_bf16_f32 v236, v136, v137
  v_cvt_pk_bf16_f32 v237, v138, v139
  v_cvt_pk_bf16_f32 v238, v140, v141
  v_cvt_pk_bf16_f32 v239, v142, v143
  v_cvt_pk_bf16_f32 v240, v144, v145
  v_cvt_pk_bf16_f32 v241, v146, v147
  ds_write_b64 v22, v[236:237] offset:38400
  ds_write_b64 v22, v[238:239] offset:38408
  ds_write_b64 v16, v[240:241] offset:38464
  v_cvt_pk_bf16_f32 v242, v148, v149
  v_cvt_pk_bf16_f32 v243, v150, v151
  v_cvt_pk_bf16_f32 v244, v152, v153
  v_cvt_pk_bf16_f32 v245, v154, v155
  v_cvt_pk_bf16_f32 v246, v156, v157
  v_cvt_pk_bf16_f32 v247, v158, v159
  ds_write_b64 v22, v[242:243] offset:44800
  ds_write_b64 v22, v[244:245] offset:44808
  ds_write_b64 v16, v[246:247] offset:44864
  s_waitcnt vmcnt(0) lgkmcnt(0)
  s_barrier
  ds_read_b128 v[224:227], v23 offset:0
  ds_read_b128 v[228:231], v23 offset:64
  ds_read_b128 v[232:235], v23 offset:128
  ds_read_b128 v[236:239], v23 offset:192
  ds_read_b128 v[240:243], v23 offset:256
  ds_read_b128 v[244:247], v23 offset:320
  s_waitcnt lgkmcnt(0)
  s_add_u32 s21, s48, 0
  buffer_store_dwordx4 v[224:227], v26, s[16:19], s21 offen offset:0 sc1
  buffer_store_dwordx4 v[228:231], v26, s[16:19], s21 offen offset:1024 sc1
  buffer_store_dwordx4 v[232:235], v26, s[16:19], s21 offen offset:2048 sc1
  buffer_store_dwordx4 v[236:239], v26, s[16:19], s21 offen offset:3072 sc1
  s_add_u32 s21, s48, 4096
  buffer_store_dwordx4 v[240:243], v26, s[16:19], s21 offen offset:0 sc1
  buffer_store_dwordx4 v[244:247], v26, s[16:19], s21 offen offset:1024 sc1
  s_nop 1
  ds_read_b128 v[224:227], v23 offset:6400
  ds_read_b128 v[228:231], v23 offset:6464
  ds_read_b128 v[232:235], v23 offset:6528
  ds_read_b128 v[236:239], v23 offset:6592
  ds_read_b128 v[240:243], v23 offset:6656
  ds_read_b128 v[244:247], v23 offset:6720
  s_waitcnt lgkmcnt(0)
  buffer_store_dwordx4 v[224:227], v26, s[16:19], s21 offen offset:2048 sc1
  buffer_store_dwordx4 v[228:231], v26, s[16:19], s21 offen offset:3072 sc1
  s_add_u32 s21, s48, 8192
  buffer_store_dwordx4 v[232:235], v26, s[16:19], s21 offen offset:0 sc1
  buffer_store_dwordx4 v[236:239], v26, s[16:19], s21 offen offset:1024 sc1
  buffer_store_dwordx4 v[240:243], v26, s[16:19], s21 offen offset:2048 sc1
  buffer_store_dwordx4 v[244:247], v26, s[16:19], s21 offen offset:3072 sc1
  s_nop 1
  s_waitcnt vmcnt(0)
  s_barrier
  s_cmp_lg_u32 s20, 0
  s_cbranch_scc1 af_159
  v_mov_b32 v4, 0
  v_mov_b32 v5, 1
  s_mov_b64 exec, 1
  buffer_atomic_add v5, v4, s[72:75], s61 offen sc1
  s_mov_b64 exec, -1
  s_nop 1
af_159:
  s_cmp_lg_u32 s43, 0
  s_cbranch_scc1 kv_fin
  s_mov_b32 s87, -2
  s_add_u32 s21, s42, 32
  s_branch do_opb2
kv_help:
  s_waitcnt vmcnt(0) lgkmcnt(0)
  s_barrier
  s_load_dwordx2 s[4:5], s[0:1], 0
  s_load_dwordx2 s[6:7], s[0:1], 24
  s_load_dwordx2 s[36:37], s[0:1], 32
  s_load_dwordx2 s[38:39], s[0:1], 104
  s_and_b32 s43, s3, 1
  s_bfe_u32 s42, s3, 0x50001
  s_lshr_b32 s40, s42, 2
  s_waitcnt lgkmcnt(0)
  s_cmp_eq_u32 s43, 1
  s_cselect_b32 s6, s36, s6
  s_cselect_b32 s7, s37, s7
  s_mov_b32 s8, s4
  s_mov_b32 s9, s5
  s_mov_b32 s10, 2621440
  s_mov_b32 s11, 0x00020000
  s_mov_b32 s12, s6
  s_mov_b32 s13, s7
  s_mov_b32 s14, 7864320
  s_mov_b32 s15, 0x00020000
  s_mov_b32 s16, s38
  s_mov_b32 s17, s39
  s_mov_b32 s18, 50331648
  s_mov_b32 s19, 0x00020000
  s_mul_i32 s44, s42, 384
  s_mov_b32 s28, 1572864
  s_mov_b32 s43, 2
  s_load_dwordx2 s[6:7], s[0:1], 16
  s_waitcnt lgkmcnt(0)
  s_mov_b32 s12, s6
  s_mov_b32 s13, s7
  s_mov_b32 s14, 7864320
  s_mov_b32 s15, 0x00020000
  s_add_u32 s16, s38, 201326592
  s_addc_u32 s17, s39, 0
  s_mov_b32 s18, 6291456
  s_mov_b32 s19, 0x00020000
  v_mov_b32 v9, 2731
  v_add_u32 v8, 0, v1
  v_mul_u32_u24 v7, v8, v9
  v_lshrrev_b32 v7, 16, v7
  v_mul_u32_u24 v4, 24, v7
  v_sub_u32 v8, v8, v4
  s_mov_b32 s21, 12288
  v_mul_lo_u32 v7, v7, s21
  v_lshl_add_u32 v4, v8, 4, v7
  v_add_u32 v8, 64, v1
  v_mul_u32_u24 v7, v8, v9
  v_lshrrev_b32 v7, 16, v7
  v_mul_u32_u24 v5, 24, v7
  v_sub_u32 v8, v8, v5
  s_mov_b32 s21, 12288
  v_mul_lo_u32 v7, v7, s21
  v_lshl_add_u32 v5, v8, 4, v7
  v_add_u32 v8, 128, v1
  v_mul_u32_u24 v7, v8, v9
  v_lshrrev_b32 v7, 16, v7
  v_mul_u32_u24 v6, 24, v7
  v_sub_u32 v8, v8, v6
  s_mov_b32 s21, 12288
  v_mul_lo_u32 v7, v7, s21
  v_lshl_add_u32 v6, v8, 4, v7
  v_lshrrev_b32 v7, 2, v2
  v_lshl_add_u32 v7, v3, 3, v7
  v_mul_u32_u24 v7, 384, v7
  v_and_b32 v8, 3, v2
  v_lshlrev_b32 v8, 3, v8
  s_mul_i32 s21, s20, 96
  v_add3_u32 v7, v7, v8, s21
  v_add_u32 v8, 61440, v7
  s_mul_i32 s21, s20, 491520
  s_add_u32 s21, s21, 0
  s_add_u32 s21, s21, s44
  s_mul_i32 s22, s20, 15360
  s_add_u32 s22, s22, 0
  s_add_u32 m0, s22, 0
  s_nop 0
  buffer_load_dwordx4 v4, s[12:15], s21 offen lds
  s_add_u32 m0, s22, 1024
  s_nop 0
  buffer_load_dwordx4 v5, s[12:15], s21 offen lds
  s_add_u32 m0, s22, 2048
  s_nop 0
  buffer_load_dwordx4 v6, s[12:15], s21 offen lds
  s_mul_i32 s21, s20, 491520
  s_add_u32 s21, s21, 98304
  s_add_u32 s21, s21, s44
  s_mul_i32 s22, s20, 15360
  s_add_u32 s22, s22, 3072
  s_add_u32 m0, s22, 0
  s_nop 0
  buffer_load_dwordx4 v4, s[12:15], s21 offen lds
  s_add_u32 m0, s22, 1024
  s_nop 0
  buffer_load_dwordx4 v5, s[12:15], s21 offen lds
  s_add_u32 m0, s22, 2048
  s_nop 0
  buffer_load_dwordx4 v6, s[12:15], s21 offen lds
  s_mul_i32 s21, s20, 491520
  s_add_u32 s21, s21, 196608
  s_add_u32 s21, s21, s44
  s_mul_i32 s22, s20, 15360
  s_add_u32 s22, s22, 6144
  s_add_u32 m0, s22, 0
  s_nop 0
  buffer_load_dwordx4 v4, s[12:15], s21 offen lds
  s_add_u32 m0, s22, 1024
  s_nop 0
  buffer_load_dwordx4 v5, s[12:15], s21 offen lds
  s_add_u32 m0, s22, 2048
  s_nop 0
  buffer_load_dwordx4 v6, s[12:15], s21 offen lds
  s_mul_i32 s21, s20, 491520
  s_add_u32 s21, s21, 294912
  s_add_u32 s21, s21, s44
  s_mul_i32 s22, s20, 15360
  s_add_u32 s22, s22, 9216
  s_add_u32 m0, s22, 0
  s_nop 0
  buffer_load_dwordx4 v4, s[12:15], s21 offen lds
  s_add_u32 m0, s22, 1024
  s_nop 0
  buffer_load_dwordx4 v5, s[12:15], s21 offen lds
  s_add_u32 m0, s22, 2048
  s_nop 0
  buffer_load_dwordx4 v6, s[12:15], s21 offen lds
  s_mul_i32 s21, s20, 491520
  s_add_u32 s21, s21, 393216
  s_add_u32 s21, s21, s44
  s_mul_i32 s22, s20, 15360
  s_add_u32 s22, s22, 12288
  s_add_u32 m0, s22, 0
  s_nop 0
  buffer_load_dwordx4 v4, s[12:15], s21 offen lds
  s_add_u32 m0, s22, 1024
  s_nop 0
  buffer_load_dwordx4 v5, s[12:15], s21 offen lds
  s_add_u32 m0, s22, 2048
  s_nop 0
  buffer_load_dwordx4 v6, s[12:15], s21 offen lds
  s_mul_i32 s21, s20, 491520
  s_add_u32 s21, s21, 1966080
  s_add_u32 s21, s21, s44
  s_mul_i32 s22, s20, 15360
  s_add_u32 s22, s22, 61440
  s_add_u32 m0, s22, 0
  s_nop 0
  buffer_load_dwordx4 v4, s[12:15], s21 offen lds
  s_add_u32 m0, s22, 1024
  s_nop 0
  buffer_load_dwordx4 v5, s[12:15], s21 offen lds
  s_add_u32 m0, s22, 2048
  s_nop 0
  buffer_load_dwordx4 v6, s[12:15], s21 offen lds
  s_mul_i32 s21, s20, 491520
  s_add_u32 s21, s21, 2064384
  s_add_u32 s21, s21, s44
  s_mul_i32 s22, s20, 15360
  s_add_u32 s22, s22, 64512
  s_add_u32 m0, s22, 0
  s_nop 0
  buffer_load_dwordx4 v4, s[12:15], s21 offen lds
  s_add_u32 m0, s22, 1024
  s_nop 0
  buffer_load_dwordx4 v5, s[12:15], s21 offen lds
  s_add_u32 m0, s22, 2048
  s_nop 0
  buffer_load_dwordx4 v6, s[12:15], s21 offen lds
  s_mul_i32 s21, s20, 491520
  s_add_u32 s21, s21, 2162688
  s_add_u32 s21, s21, s44
  s_mul_i32 s22, s20, 15360
  s_add_u32 s22, s22, 67584
  s_add_u32 m0, s22, 0
  s_nop 0
  buffer_load_dwordx4 v4, s[12:15], s21 offen lds
  s_add_u32 m0, s22, 1024
  s_nop 0
  buffer_load_dwordx4 v5, s[12:15], s21 offen lds
  s_add_u32 m0, s22, 2048
  s_nop 0
  buffer_load_dwordx4 v6, s[12:15], s21 offen lds
  s_mul_i32 s21, s20, 491520
  s_add_u32 s21, s21, 2260992
  s_add_u32 s21, s21, s44
  s_mul_i32 s22, s20, 15360
  s_add_u32 s22, s22, 70656
  s_add_u32 m0, s22, 0
  s_nop 0
  buffer_load_dwordx4 v4, s[12:15], s21 offen lds
  s_add_u32 m0, s22, 1024
  s_nop 0
  buffer_load_dwordx4 v5, s[12:15], s21 offen lds
  s_add_u32 m0, s22, 2048
  s_nop 0
  buffer_load_dwordx4 v6, s[12:15], s21 offen lds
  s_mul_i32 s21, s20, 491520
  s_add_u32 s21, s21, 2359296
  s_add_u32 s21, s21, s44
  s_mul_i32 s22, s20, 15360
  s_add_u32 s22, s22, 73728
  s_add_u32 m0, s22, 0
  s_nop 0
  buffer_load_dwordx4 v4, s[12:15], s21 offen lds
  s_add_u32 m0, s22, 1024
  s_nop 0
  buffer_load_dwordx4 v5, s[12:15], s21 offen lds
  s_add_u32 m0, s22, 2048
  s_nop 0
  buffer_load_dwordx4 v6, s[12:15], s21 offen lds
  s_mul_i32 s21, s20, 491520
  s_add_u32 s21, s21, 3932160
  s_add_u32 s21, s21, s44
  buffer_load_dwordx4 v[64:67], v4, s[12:15], s21 offen
  buffer_load_dwordx4 v[68:71], v5, s[12:15], s21 offen
  buffer_load_dwordx4 v[72:75], v6, s[12:15], s21 offen
  s_mul_i32 s21, s20, 491520
  s_add_u32 s21, s21, 4030464
  s_add_u32 s21, s21, s44
  buffer_load_dwordx4 v[76:79], v4, s[12:15], s21 offen
  buffer_load_dwordx4 v[80:83], v5, s[12:15], s21 offen
  buffer_load_dwordx4 v[84:87], v6, s[12:15], s21 offen
  s_mul_i32 s21, s20, 491520
  s_add_u32 s21, s21, 4128768
  s_add_u32 s21, s21, s44
  buffer_load_dwordx4 v[88:91], v4, s[12:15], s21 offen
  buffer_load_dwordx4 v[92:95], v5, s[12:15], s21 offen
  buffer_load_dwordx4 v[96:99], v6, s[12:15], s21 offen
  s_mul_i32 s21, s20, 491520
  s_add_u32 s21, s21, 4227072
  s_add_u32 s21, s21, s44
  buffer_load_dwordx4 v[100:103], v4, s[12:15], s21 offen
  buffer_load_dwordx4 v[104:107], v5, s[12:15], s21 offen
  buffer_load_dwordx4 v[108:111], v6, s[12:15], s21 offen
  s_mul_i32 s21, s20, 491520
  s_add_u32 s21, s21, 4325376
  s_add_u32 s21, s21, s44
  buffer_load_dwordx4 v[112:115], v4, s[12:15], s21 offen
  buffer_load_dwordx4 v[116:119], v5, s[12:15], s21 offen
  buffer_load_dwordx4 v[120:123], v6, s[12:15], s21 offen
  s_mul_i32 s21, s20, 491520
  s_add_u32 s21, s21, 5898240
  s_add_u32 s21, s21, s44
  buffer_load_dwordx4 v[124:127], v4, s[12:15], s21 offen
  buffer_load_dwordx4 v[128:131], v5, s[12:15], s21 offen
  buffer_load_dwordx4 v[132:135], v6, s[12:15], s21 offen
  s_mul_i32 s21, s20, 491520
  s_add_u32 s21, s21, 5996544
  s_add_u32 s21, s21, s44
  buffer_load_dwordx4 v[136:139], v4, s[12:15], s21 offen
  buffer_load_dwordx4 v[140:143], v5, s[12:15], s21 offen
  buffer_load_dwordx4 v[144:147], v6, s[12:15], s21 offen
  s_mul_i32 s21, s20, 491520
  s_add_u32 s21, s21, 6094848
  s_add_u32 s21, s21, s44
  buffer_load_dwordx4 v[148:151], v4, s[12:15], s21 offen
  buffer_load_dwordx4 v[152:155], v5, s[12:15], s21 offen
  buffer_load_dwordx4 v[156:159], v6, s[12:15], s21 offen
  s_mul_i32 s21, s20, 491520
  s_add_u32 s21, s21, 6193152
  s_add_u32 s21, s21, s44
  buffer_load_dwordx4 v[160:163], v4, s[12:15], s21 offen
  buffer_load_dwordx4 v[164:167], v5, s[12:15], s21 offen
  buffer_load_dwordx4 v[168:171], v6, s[12:15], s21 offen
  s_mul_i32 s21, s20, 491520
  s_add_u32 s21, s21, 6291456
  s_add_u32 s21, s21, s44
  buffer_load_dwordx4 v[172:175], v4, s[12:15], s21 offen
  buffer_load_dwordx4 v[176:179], v5, s[12:15], s21 offen
  buffer_load_dwordx4 v[180:183], v6, s[12:15], s21 offen
  s_mul_i32 s22, s20, 15360
  v_lshl_add_u32 v30, v1, 4, s22
  v_add_u32 v31, 61440, v30
  s_waitcnt vmcnt(45)
  s_barrier
  ds_read_b64_tr_b16 a[0:1], v7 offset:0
  ds_read_b64_tr_b16 a[2:3], v7 offset:1536
  ds_read_b64_tr_b16 a[4:5], v7 offset:32
  ds_read_b64_tr_b16 a[6:7], v7 offset:1568
  ds_read_b64_tr_b16 a[8:9], v7 offset:64
  ds_read_b64_tr_b16 a[10:11], v7 offset:1600
  ds_read_b64_tr_b16 a[12:13], v7 offset:12288
  ds_read_b64_tr_b16 a[14:15], v7 offset:13824
  ds_read_b64_tr_b16 a[16:17], v7 offset:12320
  ds_read_b64_tr_b16 a[18:19], v7 offset:13856
  ds_read_b64_tr_b16 a[20:21], v7 offset:12352
  ds_read_b64_tr_b16 a[22:23], v7 offset:13888
  ds_read_b64_tr_b16 a[24:25], v7 offset:24576
  ds_read_b64_tr_b16 a[26:27], v7 offset:26112
  ds_read_b64_tr_b16 a[28:29], v7 offset:24608
  ds_read_b64_tr_b16 a[30:31], v7 offset:26144
  ds_read_b64_tr_b16 a[32:33], v7 offset:24640
  ds_read_b64_tr_b16 a[34:35], v7 offset:26176
  ds_read_b64_tr_b16 a[36:37], v7 offset:36864
  ds_read_b64_tr_b16 a[38:39], v7 offset:38400
  ds_read_b64_tr_b16 a[40:41], v7 offset:36896
  ds_read_b64_tr_b16 a[42:43], v7 offset:38432
  ds_read_b64_tr_b16 a[44:45], v7 offset:36928
  ds_read_b64_tr_b16 a[46:47], v7 offset:38464
  ds_read_b64_tr_b16 a[48:49], v7 offset:49152
  ds_read_b64_tr_b16 a[50:51], v7 offset:50688
  ds_read_b64_tr_b16 a[52:53], v7 offset:49184
  ds_read_b64_tr_b16 a[54:55], v7 offset:50720
  ds_read_b64_tr_b16 a[56:57], v7 offset:49216
  ds_read_b64_tr_b16 a[58:59], v7 offset:50752
  s_waitcnt lgkmcnt(0)
  s_barrier
  s_waitcnt vmcnt(30)
  s_barrier
  ds_read_b64_tr_b16 a[60:61], v8 offset:0
  ds_read_b64_tr_b16 a[62:63], v8 offset:1536
  ds_read_b64_tr_b16 a[64:65], v8 offset:32
  ds_read_b64_tr_b16 a[66:67], v8 offset:1568
  ds_read_b64_tr_b16 a[68:69], v8 offset:64
  ds_read_b64_tr_b16 a[70:71], v8 offset:1600
  ds_read_b64_tr_b16 a[72:73], v8 offset:12288
  ds_read_b64_tr_b16 a[74:75], v8 offset:13824
  ds_read_b64_tr_b16 a[76:77], v8 offset:12320
  ds_read_b64_tr_b16 a[78:79], v8 offset:13856
  ds_read_b64_tr_b16 a[80:81], v8 offset:12352
  ds_read_b64_tr_b16 a[82:83], v8 offset:13888
  ds_read_b64_tr_b16 a[84:85], v8 offset:24576
  ds_read_b64_tr_b16 a[86:87], v8 offset:26112
  ds_read_b64_tr_b16 a[88:89], v8 offset:24608
  ds_read_b64_tr_b16 a[90:91], v8 offset:26144
  ds_read_b64_tr_b16 a[92:93], v8 offset:24640
  ds_read_b64_tr_b16 a[94:95], v8 offset:26176
  ds_read_b64_tr_b16 a[96:97], v8 offset:36864
  ds_read_b64_tr_b16 a[98:99], v8 offset:38400
  ds_read_b64_tr_b16 a[100:101], v8 offset:36896
  ds_read_b64_tr_b16 a[102:103], v8 offset:38432
  ds_read_b64_tr_b16 a[104:105], v8 offset:36928
  ds_read_b64_tr_b16 a[106:107], v8 offset:38464
  ds_read_b64_tr_b16 a[108:109], v8 offset:49152
  ds_read_b64_tr_b16 a[110:111], v8 offset:50688
  ds_read_b64_tr_b16 a[112:113], v8 offset:49184
  ds_read_b64_tr_b16 a[114:115], v8 offset:50720
  ds_read_b64_tr_b16 a[116:117], v8 offset:49216
  ds_read_b64_tr_b16 a[118:119], v8 offset:50752
  s_waitcnt lgkmcnt(0)
  s_barrier
  s_waitcnt vmcnt(15)
  ds_write_b128 v30, v[64:67] offset:0
  ds_write_b128 v30, v[68:71] offset:1024
  ds_write_b128 v30, v[72:75] offset:2048
  ds_write_b128 v30, v[76:79] offset:3072
  ds_write_b128 v30, v[80:83] offset:4096
  ds_write_b128 v30, v[84:87] offset:5120
  ds_write_b128 v30, v[88:91] offset:6144
  ds_write_b128 v30, v[92:95] offset:7168
  ds_write_b128 v30, v[96:99] offset:8192
  ds_write_b128 v30, v[100:103] offset:9216
  ds_write_b128 v30, v[104:107] offset:10240
  ds_write_b128 v30, v[108:111] offset:11264
  ds_write_b128 v30, v[112:115] offset:12288
  ds_write_b128 v30, v[116:119] offset:13312
  ds_write_b128 v30, v[120:123] offset:14336
  s_waitcnt lgkmcnt(0)
  s_barrier
  ds_read_b64_tr_b16 a[120:121], v7 offset:0
  ds_read_b64_tr_b16 a[122:123], v7 offset:1536
  ds_read_b64_tr_b16 a[124:125], v7 offset:32
  ds_read_b64_tr_b16 a[126:127], v7 offset:1568
  ds_read_b64_tr_b16 a[128:129], v7 offset:64
  ds_read_b64_tr_b16 a[130:131], v7 offset:1600
  ds_read_b64_tr_b16 a[132:133], v7 offset:12288
  ds_read_b64_tr_b16 a[134:135], v7 offset:13824
  ds_read_b64_tr_b16 a[136:137], v7 offset:12320
  ds_read_b64_tr_b16 a[138:139], v7 offset:13856
  ds_read_b64_tr_b16 a[140:141], v7 offset:12352
  ds_read_b64_tr_b16 a[142:143], v7 offset:13888
  ds_read_b64_tr_b16 a[144:145], v7 offset:24576
  ds_read_b64_tr_b16 a[146:147], v7 offset:26112
  ds_read_b64_tr_b16 a[148:149], v7 offset:24608
  ds_read_b64_tr_b16 a[150:151], v7 offset:26144
  ds_read_b64_tr_b16 a[152:153], v7 offset:24640
  ds_read_b64_tr_b16 a[154:155], v7 offset:26176
  ds_read_b64_tr_b16 a[156:157], v7 offset:36864
  ds_read_b64_tr_b16 a[158:159], v7 offset:38400
  ds_read_b64_tr_b16 a[160:161], v7 offset:36896
  ds_read_b64_tr_b16 a[162:163], v7 offset:38432
  ds_read_b64_tr_b16 a[164:165], v7 offset:36928
  ds_read_b64_tr_b16 a[166:167], v7 offset:38464
  ds_read_b64_tr_b16 a[168:169], v7 offset:49152
  ds_read_b64_tr_b16 a[170:171], v7 offset:50688
  ds_read_b64_tr_b16 a[172:173], v7 offset:49184
  ds_read_b64_tr_b16 a[174:175], v7 offset:50720
  ds_read_b64_tr_b16 a[176:177], v7 offset:49216
  ds_read_b64_tr_b16 a[178:179], v7 offset:50752
  s_waitcnt lgkmcnt(0)
  s_barrier
  s_waitcnt vmcnt(0)
  ds_write_b128 v31, v[124:127] offset:0
  ds_write_b128 v31, v[128:131] offset:1024
  ds_write_b128 v31, v[132:135] offset:2048
  ds_write_b128 v31, v[136:139] offset:3072
  ds_write_b128 v31, v[140:143] offset:4096
  ds_write_b128 v31, v[144:147] offset:5120
  ds_write_b128 v31, v[148:151] offset:6144
  ds_write_b128 v31, v[152:155] offset:7168
  ds_write_b128 v31, v[156:159] offset:8192
  ds_write_b128 v31, v[160:163] offset:9216
  ds_write_b128 v31, v[164:167] offset:10240
  ds_write_b128 v31, v[168:171] offset:11264
  ds_write_b128 v31, v[172:175] offset:12288
  ds_write_b128 v31, v[176:179] offset:13312
  ds_write_b128 v31, v[180:183] offset:14336
  s_waitcnt lgkmcnt(0)
  s_barrier
  ds_read_b64_tr_b16 a[180:181], v8 offset:0
  ds_read_b64_tr_b16 a[182:183], v8 offset:1536
  ds_read_b64_tr_b16 a[184:185], v8 offset:32
  ds_read_b64_tr_b16 a[186:187], v8 offset:1568
  ds_read_b64_tr_b16 a[188:189], v8 offset:64
  ds_read_b64_tr_b16 a[190:191], v8 offset:1600
  ds_read_b64_tr_b16 a[192:193], v8 offset:12288
  ds_read_b64_tr_b16 a[194:195], v8 offset:13824
  ds_read_b64_tr_b16 a[196:197], v8 offset:12320
  ds_read_b64_tr_b16 a[198:199], v8 offset:13856
  ds_read_b64_tr_b16 a[200:201], v8 offset:12352
  ds_read_b64_tr_b16 a[202:203], v8 offset:13888
  ds_read_b64_tr_b16 a[204:205], v8 offset:24576
  ds_read_b64_tr_b16 a[206:207], v8 offset:26112
  ds_read_b64_tr_b16 a[208:209], v8 offset:24608
  ds_read_b64_tr_b16 a[210:211], v8 offset:26144
  ds_read_b64_tr_b16 a[212:213], v8 offset:24640
  ds_read_b64_tr_b16 a[214:215], v8 offset:26176
  ds_read_b64_tr_b16 a[216:217], v8 offset:36864
  ds_read_b64_tr_b16 a[218:219], v8 offset:38400
  ds_read_b64_tr_b16 a[220:221], v8 offset:36896
  ds_read_b64_tr_b16 a[222:223], v8 offset:38432
  ds_read_b64_tr_b16 a[224:225], v8 offset:36928
  ds_read_b64_tr_b16 a[226:227], v8 offset:38464
  ds_read_b64_tr_b16 a[228:229], v8 offset:49152
  ds_read_b64_tr_b16 a[230:231], v8 offset:50688
  ds_read_b64_tr_b16 a[232:233], v8 offset:49184
  ds_read_b64_tr_b16 a[234:235], v8 offset:50720
  ds_read_b64_tr_b16 a[236:237], v8 offset:49216
  ds_read_b64_tr_b16 a[238:239], v8 offset:50752
  s_waitcnt lgkmcnt(0)
  s_barrier
  s_mov_b32 s24, 1966080
  s_mov_b32 s25, 163840
  v_lshrrev_b32 v11, 3, v1
  v_and_b32 v12, 7, v1
  v_xor_b32 v12, v12, v11
  v_mul_u32_u24 v11, 1280, v11
  v_lshl_add_u32 v10, v12, 4, v11
  s_mul_i32 s46, s20, 40960
  v_add_u32 v10, s46, v10
  s_lshl_b32 s47, s20, 12
  s_add_u32 s47, s47, 0
  s_add_u32 s46, s47, 98304
  s_mov_b32 s30, s24
  s_add_u32 s32, s47, 32768
  v_add_u32 v11, 9216, v10
  v_add_u32 v12, 18432, v10
  v_add_u32 v13, 27648, v10
  s_mov_b32 m0, s32
  s_nop 0
  buffer_load_dwordx4 v10, s[8:11], s30 offen offset:0 lds
  buffer_load_dwordx4 v11, s[8:11], s30 offen offset:1024 lds
  buffer_load_dwordx4 v12, s[8:11], s30 offen offset:2048 lds
  buffer_load_dwordx4 v13, s[8:11], s30 offen offset:3072 lds
  s_add_u32 s30, s30, 128
  s_add_u32 s32, s32, 16384
  s_cmp_lt_u32 s32, s46
  s_cselect_b32 s32, s32, s47
  s_mov_b32 m0, s32
  s_nop 0
  buffer_load_dwordx4 v10, s[8:11], s30 offen offset:0 lds
  buffer_load_dwordx4 v11, s[8:11], s30 offen offset:1024 lds
  buffer_load_dwordx4 v12, s[8:11], s30 offen offset:2048 lds
  buffer_load_dwordx4 v13, s[8:11], s30 offen offset:3072 lds
  s_add_u32 s30, s30, 128
  s_add_u32 s32, s32, 16384
  s_cmp_lt_u32 s32, s46
  s_cselect_b32 s32, s32, s47
  s_mov_b32 m0, s32
  s_nop 0
  buffer_load_dwordx4 v10, s[8:11], s30 offen offset:0 lds
  buffer_load_dwordx4 v11, s[8:11], s30 offen offset:1024 lds
  buffer_load_dwordx4 v12, s[8:11], s30 offen offset:2048 lds
  buffer_load_dwordx4 v13, s[8:11], s30 offen offset:3072 lds
  s_add_u32 s30, s30, 128
  s_add_u32 s32, s32, 16384
  s_cmp_lt_u32 s32, s46
  s_cselect_b32 s32, s32, s47
  s_mov_b32 m0, s32
  s_nop 0
  buffer_load_dwordx4 v10, s[8:11], s30 offen offset:0 lds
  buffer_load_dwordx4 v11, s[8:11], s30 offen offset:1024 lds
  buffer_load_dwordx4 v12, s[8:11], s30 offen offset:2048 lds
  buffer_load_dwordx4 v13, s[8:11], s30 offen offset:3072 lds
  s_add_u32 s30, s30, 128
  s_add_u32 s32, s32, 16384
  s_cmp_lt_u32 s32, s46
  s_cselect_b32 s32, s32, s47
  s_mov_b32 s26, 4
  s_mul_i32 s27, s42, 12288
  s_lshl_b32 s60, s42, 7
  s_add_u32 s60, s60, 112640
  s_mov_b32 s62, 0
  s_branch kv_main
kv_fin:
  s_cmp_lg_u32 s43, 2
  s_cbranch_scc1 queue
  s_bfe_u32 s21, s3, 0x20001
  s_cmp_lt_u32 s21, 0
  s_cbranch_scc1 queue
  s_sub_u32 s21, s21, 0
  s_lshl_b32 s21, s21, 3
  s_lshr_b32 s22, s3, 3
  s_add_u32 s21, s21, s22
  s_add_u32 s87, s21, 326
  s_branch tail_item
  s_branch queue
not_kv:
  s_cmp_ge_u32 s3, 96
  s_cbranch_scc1 not_vw
  s_sub_u32 s2, s3, 64
  s_load_dwordx2 s[72:73], s[0:1], 104
  s_waitcnt lgkmcnt(0)
  s_add_u32 s72, s72, 81068032
  s_addc_u32 s73, s73, 0
  s_mov_b32 s74, 116736
  s_mov_b32 s75, 0x00020000
  s_add_u32 s8, s38, 78643200
  s_addc_u32 s9, s39, 0
  s_mov_b32 s10, 2162688
  s_mov_b32 s11, 0x00020000
  s_add_u32 s12, s38, 50331648
  s_addc_u32 s13, s39, 0
  s_mov_b32 s14, 12582912
  s_mov_b32 s15, 0x00020000
  s_add_u32 s16, s38, 83886079
  s_addc_u32 s17, s39, 0
  s_and_b32 s16, s16, 0xffe00000
  s_mov_b32 s18, 2097152
  s_mov_b32 s19, 0x00020000
  v_lshlrev_b32 v8, 4, v0
  v_lshlrev_b32 v9, 4, v1
  v_mov_b32 v4, 0
  v_mov_b32 v12, -1
  v_mov_b32 v5, 0
  v_mov_b32 v13, -1
  v_mov_b32 v6, 0
  v_mov_b32 v14, -1
  v_mov_b32 v7, 0
  v_mov_b32 v15, -1
  s_lshl_b32 s21, s2, 12
  buffer_store_dwordx4 v[4:7], v8, s[72:75], s21 offen sc1
  s_lshr_b32 s21, s2, 3
  s_lshl_b32 s21, s21, 15
  s_bfe_u32 s22, s2, 0x10002
  s_lshl_b32 s22, s22, 13
  s_add_u32 s21, s21, s22
  s_bfe_u32 s22, s2, 0x10001
  s_lshl_b32 s22, s22, 14
  s_add_u32 s21, s21, s22
  s_and_b32 s22, s2, 1
  s_mul_i32 s22, s22, 3
  s_add_u32 s22, s22, s20
  s_lshl_b32 s22, s22, 10
  s_add_u32 s21, s21, s22
  s_cmp_lt_u32 s20, 3
  s_cselect_b32 s21, s21, 0x80000000
  buffer_store_dwordx4 v[4:7], v9, s[16:19], s21 offen sc1
  s_mul_i32 s23, s20, 540672
  s_lshl_b32 s21, s2, 11
  s_add_u32 s21, s21, s23
  s_add_u32 s21, s21, 81920
  buffer_store_dwordx4 v[12:15], v9, s[8:11], s21 offen sc1
  buffer_store_dwordx4 v[12:15], v9, s[8:11], s21 offen offset:1024 sc1
  s_mul_i32 s21, s2, 3072
  s_add_u32 s21, s21, s23
  s_add_u32 s21, s21, 278528
  buffer_store_dwordx4 v[12:15], v9, s[8:11], s21 offen sc1
  buffer_store_dwordx4 v[12:15], v9, s[8:11], s21 offen offset:1024 sc1
  buffer_store_dwordx4 v[12:15], v9, s[8:11], s21 offen offset:2048 sc1
  s_lshl_b32 s21, s2, 9
  s_add_u32 s21, s21, s23
  s_add_u32 s21, s21, 376832
  s_mov_b64 exec, 0xffffffff
  buffer_store_dwordx4 v[12:15], v9, s[8:11], s21 offen sc1
  s_mov_b64 exec, -1
  s_lshl_b32 s21, s20, 5
  s_add_u32 s21, s21, s2
  s_mul_i32 s21, s21, 3072
  s_cmp_lt_u32 s20, 3
  s_cselect_b32 s21, s21, 0x80000000
  s_add_u32 s22, s21, 6291456
  buffer_store_dwordx4 v[12:15], v9, s[12:15], s21 offen offset:0 sc1
  buffer_store_dwordx4 v[12:15], v9, s[12:15], s22 offen offset:0 sc1
  buffer_store_dwordx4 v[12:15], v9, s[12:15], s21 offen offset:1024 sc1
  buffer_store_dwordx4 v[12:15], v9, s[12:15], s22 offen offset:1024 sc1
  buffer_store_dwordx4 v[12:15], v9, s[12:15], s21 offen offset:2048 sc1
  buffer_store_dwordx4 v[12:15], v9, s[12:15], s22 offen offset:2048 sc1
  s_waitcnt vmcnt(0)
  s_barrier
  s_mov_b32 s21, 76
  s_cmp_lg_u32 s20, 0
  s_cbranch_scc1 af_160
  v_mov_b32 v10, 0
  v_mov_b32 v11, 1
  s_mov_b64 exec, 1
  buffer_atomic_add v11, v10, s[32:35], s21 offen sc1
  s_mov_b64 exec, -1
  s_nop 1
af_160:
  s_load_dwordx2 s[6:7], s[0:1], 40
  s_load_dwordx2 s[38:39], s[0:1], 104
  s_waitcnt lgkmcnt(0)
  s_mov_b32 s12, s6
  s_mov_b32 s13, s7
  s_mov_b32 s14, 7864320
  s_mov_b32 s15, 0x00020000
  s_mov_b32 s16, s38
  s_mov_b32 s17, s39
  s_mov_b32 s18, 50331648
  s_mov_b32 s19, 0x00020000
  s_add_u32 s24, s38, 114294784
  s_addc_u32 s25, s39, 0
  s_mov_b32 s26, 83886080
  s_mov_b32 s27, 0x00020000
  s_load_dwordx2 s[72:73], s[0:1], 104
  s_waitcnt lgkmcnt(0)
  s_add_u32 s72, s72, 81068032
  s_addc_u32 s73, s73, 0
  s_mov_b32 s74, 116736
  s_mov_b32 s75, 0x00020000
  v_mov_b32 v29, 52429
  s_mul_i32 s21, s20, 960
  s_add_u32 s21, s21, 0
  v_add_u32 v21, s21, v1
  v_mul_u32_u24 v22, v21, v29
  v_lshrrev_b32 v22, 22, v22
  v_mul_u32_u24 v23, 80, v22
  v_sub_u32 v21, v21, v23
  v_bfe_u32 v23, v22, 3, 1
  v_and_b32 v24, 3, v22
  v_lshl_add_u32 v23, v23, 2, v24
  v_lshlrev_b32 v23, 1, v23
  v_xor_b32 v21, v21, v23
  v_cmp_gt_u32 vcc, 32, v22
  v_bfe_u32 v26, v22, 3, 2
  v_lshl_add_u32 v25, v26, 2, v24
  v_bfe_u32 v26, v22, 2, 1
  v_lshl_add_u32 v25, v26, 4, v25
  v_cndmask_b32 v25, v22, v25, vcc
  v_mul_u32_u24 v25, 1280, v25
  v_lshl_add_u32 v64, v21, 4, v25
  s_mul_i32 s21, s20, 960
  s_add_u32 s21, s21, 64
  v_add_u32 v21, s21, v1
  v_mul_u32_u24 v22, v21, v29
  v_lshrrev_b32 v22, 22, v22
  v_mul_u32_u24 v23, 80, v22
  v_sub_u32 v21, v21, v23
  v_bfe_u32 v23, v22, 3, 1
  v_and_b32 v24, 3, v22
  v_lshl_add_u32 v23, v23, 2, v24
  v_lshlrev_b32 v23, 1, v23
  v_xor_b32 v21, v21, v23
  v_cmp_gt_u32 vcc, 32, v22
  v_bfe_u32 v26, v22, 3, 2
  v_lshl_add_u32 v25, v26, 2, v24
  v_bfe_u32 v26, v22, 2, 1
  v_lshl_add_u32 v25, v26, 4, v25
  v_cndmask_b32 v25, v22, v25, vcc
  v_mul_u32_u24 v25, 1280, v25
  v_lshl_add_u32 v65, v21, 4, v25
  s_mul_i32 s21, s20, 960
  s_add_u32 s21, s21, 128
  v_add_u32 v21, s21, v1
  v_mul_u32_u24 v22, v21, v29
  v_lshrrev_b32 v22, 22, v22
  v_mul_u32_u24 v23, 80, v22
  v_sub_u32 v21, v21, v23
  v_bfe_u32 v23, v22, 3, 1
  v_and_b32 v24, 3, v22
  v_lshl_add_u32 v23, v23, 2, v24
  v_lshlrev_b32 v23, 1, v23
  v_xor_b32 v21, v21, v23
  v_cmp_gt_u32 vcc, 32, v22
  v_bfe_u32 v26, v22, 3, 2
  v_lshl_add_u32 v25, v26, 2, v24
  v_bfe_u32 v26, v22, 2, 1
  v_lshl_add_u32 v25, v26, 4, v25
  v_cndmask_b32 v25, v22, v25, vcc
  v_mul_u32_u24 v25, 1280, v25
  v_lshl_add_u32 v66, v21, 4, v25
  s_mul_i32 s21, s20, 960
  s_add_u32 s21, s21, 192
  v_add_u32 v21, s21, v1
  v_mul_u32_u24 v22, v21, v29
  v_lshrrev_b32 v22, 22, v22
  v_mul_u32_u24 v23, 80, v22
  v_sub_u32 v21, v21, v23
  v_bfe_u32 v23, v22, 3, 1
  v_and_b32 v24, 3, v22
  v_lshl_add_u32 v23, v23, 2, v24
  v_lshlrev_b32 v23, 1, v23
  v_xor_b32 v21, v21, v23
  v_cmp_gt_u32 vcc, 32, v22
  v_bfe_u32 v26, v22, 3, 2
  v_lshl_add_u32 v25, v26, 2, v24
  v_bfe_u32 v26, v22, 2, 1
  v_lshl_add_u32 v25, v26, 4, v25
  v_cndmask_b32 v25, v22, v25, vcc
  v_mul_u32_u24 v25, 1280, v25
  v_lshl_add_u32 v67, v21, 4, v25
  s_mul_i32 s21, s20, 960
  s_add_u32 s21, s21, 256
  v_add_u32 v21, s21, v1
  v_mul_u32_u24 v22, v21, v29
  v_lshrrev_b32 v22, 22, v22
  v_mul_u32_u24 v23, 80, v22
  v_sub_u32 v21, v21, v23
  v_bfe_u32 v23, v22, 3, 1
  v_and_b32 v24, 3, v22
  v_lshl_add_u32 v23, v23, 2, v24
  v_lshlrev_b32 v23, 1, v23
  v_xor_b32 v21, v21, v23
  v_cmp_gt_u32 vcc, 32, v22
  v_bfe_u32 v26, v22, 3, 2
  v_lshl_add_u32 v25, v26, 2, v24
  v_bfe_u32 v26, v22, 2, 1
  v_lshl_add_u32 v25, v26, 4, v25
  v_cndmask_b32 v25, v22, v25, vcc
  v_mul_u32_u24 v25, 1280, v25
  v_lshl_add_u32 v68, v21, 4, v25
  s_mul_i32 s21, s20, 960
  s_add_u32 s21, s21, 320
  v_add_u32 v21, s21, v1
  v_mul_u32_u24 v22, v21, v29
  v_lshrrev_b32 v22, 22, v22
  v_mul_u32_u24 v23, 80, v22
  v_sub_u32 v21, v21, v23
  v_bfe_u32 v23, v22, 3, 1
  v_and_b32 v24, 3, v22
  v_lshl_add_u32 v23, v23, 2, v24
  v_lshlrev_b32 v23, 1, v23
  v_xor_b32 v21, v21, v23
  v_cmp_gt_u32 vcc, 32, v22
  v_bfe_u32 v26, v22, 3, 2
  v_lshl_add_u32 v25, v26, 2, v24
  v_bfe_u32 v26, v22, 2, 1
  v_lshl_add_u32 v25, v26, 4, v25
  v_cndmask_b32 v25, v22, v25, vcc
  v_mul_u32_u24 v25, 1280, v25
  v_lshl_add_u32 v69, v21, 4, v25
  s_mul_i32 s21, s20, 960
  s_add_u32 s21, s21, 384
  v_add_u32 v21, s21, v1
  v_mul_u32_u24 v22, v21, v29
  v_lshrrev_b32 v22, 22, v22
  v_mul_u32_u24 v23, 80, v22
  v_sub_u32 v21, v21, v23
  v_bfe_u32 v23, v22, 3, 1
  v_and_b32 v24, 3, v22
  v_lshl_add_u32 v23, v23, 2, v24
  v_lshlrev_b32 v23, 1, v23
  v_xor_b32 v21, v21, v23
  v_cmp_gt_u32 vcc, 32, v22
  v_bfe_u32 v26, v22, 3, 2
  v_lshl_add_u32 v25, v26, 2, v24
  v_bfe_u32 v26, v22, 2, 1
  v_lshl_add_u32 v25, v26, 4, v25
  v_cndmask_b32 v25, v22, v25, vcc
  v_mul_u32_u24 v25, 1280, v25
  v_lshl_add_u32 v70, v21, 4, v25
  s_mul_i32 s21, s20, 960
  s_add_u32 s21, s21, 448
  v_add_u32 v21, s21, v1
  v_mul_u32_u24 v22, v21, v29
  v_lshrrev_b32 v22, 22, v22
  v_mul_u32_u24 v23, 80, v22
  v_sub_u32 v21, v21, v23
  v_bfe_u32 v23, v22, 3, 1
  v_and_b32 v24, 3, v22
  v_lshl_add_u32 v23, v23, 2, v24
  v_lshlrev_b32 v23, 1, v23
  v_xor_b32 v21, v21, v23
  v_cmp_gt_u32 vcc, 32, v22
  v_bfe_u32 v26, v22, 3, 2
  v_lshl_add_u32 v25, v26, 2, v24
  v_bfe_u32 v26, v22, 2, 1
  v_lshl_add_u32 v25, v26, 4, v25
  v_cndmask_b32 v25, v22, v25, vcc
  v_mul_u32_u24 v25, 1280, v25
  v_lshl_add_u32 v71, v21, 4, v25
  s_mul_i32 s21, s20, 960
  s_add_u32 s21, s21, 512
  v_add_u32 v21, s21, v1
  v_mul_u32_u24 v22, v21, v29
  v_lshrrev_b32 v22, 22, v22
  v_mul_u32_u24 v23, 80, v22
  v_sub_u32 v21, v21, v23
  v_bfe_u32 v23, v22, 3, 1
  v_and_b32 v24, 3, v22
  v_lshl_add_u32 v23, v23, 2, v24
  v_lshlrev_b32 v23, 1, v23
  v_xor_b32 v21, v21, v23
  v_cmp_gt_u32 vcc, 32, v22
  v_bfe_u32 v26, v22, 3, 2
  v_lshl_add_u32 v25, v26, 2, v24
  v_bfe_u32 v26, v22, 2, 1
  v_lshl_add_u32 v25, v26, 4, v25
  v_cndmask_b32 v25, v22, v25, vcc
  v_mul_u32_u24 v25, 1280, v25
  v_lshl_add_u32 v72, v21, 4, v25
  s_mul_i32 s21, s20, 960
  s_add_u32 s21, s21, 576
  v_add_u32 v21, s21, v1
  v_mul_u32_u24 v22, v21, v29
  v_lshrrev_b32 v22, 22, v22
  v_mul_u32_u24 v23, 80, v22
  v_sub_u32 v21, v21, v23
  v_bfe_u32 v23, v22, 3, 1
  v_and_b32 v24, 3, v22
  v_lshl_add_u32 v23, v23, 2, v24
  v_lshlrev_b32 v23, 1, v23
  v_xor_b32 v21, v21, v23
  v_cmp_gt_u32 vcc, 32, v22
  v_bfe_u32 v26, v22, 3, 2
  v_lshl_add_u32 v25, v26, 2, v24
  v_bfe_u32 v26, v22, 2, 1
  v_lshl_add_u32 v25, v26, 4, v25
  v_cndmask_b32 v25, v22, v25, vcc
  v_mul_u32_u24 v25, 1280, v25
  v_lshl_add_u32 v73, v21, 4, v25
  s_mul_i32 s21, s20, 960
  s_add_u32 s21, s21, 640
  v_add_u32 v21, s21, v1
  v_mul_u32_u24 v22, v21, v29
  v_lshrrev_b32 v22, 22, v22
  v_mul_u32_u24 v23, 80, v22
  v_sub_u32 v21, v21, v23
  v_bfe_u32 v23, v22, 3, 1
  v_and_b32 v24, 3, v22
  v_lshl_add_u32 v23, v23, 2, v24
  v_lshlrev_b32 v23, 1, v23
  v_xor_b32 v21, v21, v23
  v_cmp_gt_u32 vcc, 32, v22
  v_bfe_u32 v26, v22, 3, 2
  v_lshl_add_u32 v25, v26, 2, v24
  v_bfe_u32 v26, v22, 2, 1
  v_lshl_add_u32 v25, v26, 4, v25
  v_cndmask_b32 v25, v22, v25, vcc
  v_mul_u32_u24 v25, 1280, v25
  v_lshl_add_u32 v74, v21, 4, v25
  s_mul_i32 s21, s20, 960
  s_add_u32 s21, s21, 704
  v_add_u32 v21, s21, v1
  v_mul_u32_u24 v22, v21, v29
  v_lshrrev_b32 v22, 22, v22
  v_mul_u32_u24 v23, 80, v22
  v_sub_u32 v21, v21, v23
  v_bfe_u32 v23, v22, 3, 1
  v_and_b32 v24, 3, v22
  v_lshl_add_u32 v23, v23, 2, v24
  v_lshlrev_b32 v23, 1, v23
  v_xor_b32 v21, v21, v23
  v_cmp_gt_u32 vcc, 32, v22
  v_bfe_u32 v26, v22, 3, 2
  v_lshl_add_u32 v25, v26, 2, v24
  v_bfe_u32 v26, v22, 2, 1
  v_lshl_add_u32 v25, v26, 4, v25
  v_cndmask_b32 v25, v22, v25, vcc
  v_mul_u32_u24 v25, 1280, v25
  v_lshl_add_u32 v75, v21, 4, v25
  s_mul_i32 s21, s20, 960
  s_add_u32 s21, s21, 768
  v_add_u32 v21, s21, v1
  v_mul_u32_u24 v22, v21, v29
  v_lshrrev_b32 v22, 22, v22
  v_mul_u32_u24 v23, 80, v22
  v_sub_u32 v21, v21, v23
  v_bfe_u32 v23, v22, 3, 1
  v_and_b32 v24, 3, v22
  v_lshl_add_u32 v23, v23, 2, v24
  v_lshlrev_b32 v23, 1, v23
  v_xor_b32 v21, v21, v23
  v_cmp_gt_u32 vcc, 32, v22
  v_bfe_u32 v26, v22, 3, 2
  v_lshl_add_u32 v25, v26, 2, v24
  v_bfe_u32 v26, v22, 2, 1
  v_lshl_add_u32 v25, v26, 4, v25
  v_cndmask_b32 v25, v22, v25, vcc
  v_mul_u32_u24 v25, 1280, v25
  v_lshl_add_u32 v76, v21, 4, v25
  s_mul_i32 s21, s20, 960
  s_add_u32 s21, s21, 832
  v_add_u32 v21, s21, v1
  v_mul_u32_u24 v22, v21, v29
  v_lshrrev_b32 v22, 22, v22
  v_mul_u32_u24 v23, 80, v22
  v_sub_u32 v21, v21, v23
  v_bfe_u32 v23, v22, 3, 1
  v_and_b32 v24, 3, v22
  v_lshl_add_u32 v23, v23, 2, v24
  v_lshlrev_b32 v23, 1, v23
  v_xor_b32 v21, v21, v23
  v_cmp_gt_u32 vcc, 32, v22
  v_bfe_u32 v26, v22, 3, 2
  v_lshl_add_u32 v25, v26, 2, v24
  v_bfe_u32 v26, v22, 2, 1
  v_lshl_add_u32 v25, v26, 4, v25
  v_cndmask_b32 v25, v22, v25, vcc
  v_mul_u32_u24 v25, 1280, v25
  v_lshl_add_u32 v77, v21, 4, v25
  s_mul_i32 s21, s20, 960
  s_add_u32 s21, s21, 896
  v_add_u32 v21, s21, v1
  v_mul_u32_u24 v22, v21, v29
  v_lshrrev_b32 v22, 22, v22
  v_mul_u32_u24 v23, 80, v22
  v_sub_u32 v21, v21, v23
  v_bfe_u32 v23, v22, 3, 1
  v_and_b32 v24, 3, v22
  v_lshl_add_u32 v23, v23, 2, v24
  v_lshlrev_b32 v23, 1, v23
  v_xor_b32 v21, v21, v23
  v_cmp_gt_u32 vcc, 32, v22
  v_bfe_u32 v26, v22, 3, 2
  v_lshl_add_u32 v25, v26, 2, v24
  v_bfe_u32 v26, v22, 2, 1
  v_lshl_add_u32 v25, v26, 4, v25
  v_cndmask_b32 v25, v22, v25, vcc
  v_mul_u32_u24 v25, 1280, v25
  v_lshl_add_u32 v78, v21, 4, v25
  s_mul_i32 s40, s2, 245760
  s_sleep 32
  s_add_u32 s21, s40, 0
  s_mul_i32 s22, s20, 15360
  s_add_u32 s22, s22, 0
  s_add_u32 m0, s22, 0
  s_nop 0
  buffer_load_dwordx4 v64, s[12:15], s21 offen lds
  s_add_u32 m0, s22, 1024
  s_nop 0
  buffer_load_dwordx4 v65, s[12:15], s21 offen lds
  s_add_u32 m0, s22, 2048
  s_nop 0
  buffer_load_dwordx4 v66, s[12:15], s21 offen lds
  s_add_u32 m0, s22, 3072
  s_nop 0
  buffer_load_dwordx4 v67, s[12:15], s21 offen lds
  s_add_u32 m0, s22, 4096
  s_nop 0
  buffer_load_dwordx4 v68, s[12:15], s21 offen lds
  s_add_u32 m0, s22, 5120
  s_nop 0
  buffer_load_dwordx4 v69, s[12:15], s21 offen lds
  s_add_u32 m0, s22, 6144
  s_nop 0
  buffer_load_dwordx4 v70, s[12:15], s21 offen lds
  s_add_u32 m0, s22, 7168
  s_nop 0
  buffer_load_dwordx4 v71, s[12:15], s21 offen lds
  s_add_u32 m0, s22, 8192
  s_nop 0
  buffer_load_dwordx4 v72, s[12:15], s21 offen lds
  s_add_u32 m0, s22, 9216
  s_nop 0
  buffer_load_dwordx4 v73, s[12:15], s21 offen lds
  s_add_u32 m0, s22, 10240
  s_nop 0
  buffer_load_dwordx4 v74, s[12:15], s21 offen lds
  s_add_u32 m0, s22, 11264
  s_nop 0
  buffer_load_dwordx4 v75, s[12:15], s21 offen lds
  s_add_u32 m0, s22, 12288
  s_nop 0
  buffer_load_dwordx4 v76, s[12:15], s21 offen lds
  s_add_u32 m0, s22, 13312
  s_nop 0
  buffer_load_dwordx4 v77, s[12:15], s21 offen lds
  s_add_u32 m0, s22, 14336
  s_nop 0
  buffer_load_dwordx4 v78, s[12:15], s21 offen lds
  s_add_u32 s21, s40, 61440
  s_mul_i32 s22, s20, 15360
  s_add_u32 s22, s22, 61440
  s_add_u32 m0, s22, 0
  s_nop 0
  buffer_load_dwordx4 v64, s[12:15], s21 offen lds
  s_add_u32 m0, s22, 1024
  s_nop 0
  buffer_load_dwordx4 v65, s[12:15], s21 offen lds
  s_add_u32 m0, s22, 2048
  s_nop 0
  buffer_load_dwordx4 v66, s[12:15], s21 offen lds
  s_add_u32 m0, s22, 3072
  s_nop 0
  buffer_load_dwordx4 v67, s[12:15], s21 offen lds
  s_add_u32 m0, s22, 4096
  s_nop 0
  buffer_load_dwordx4 v68, s[12:15], s21 offen lds
  s_add_u32 m0, s22, 5120
  s_nop 0
  buffer_load_dwordx4 v69, s[12:15], s21 offen lds
  s_add_u32 m0, s22, 6144
  s_nop 0
  buffer_load_dwordx4 v70, s[12:15], s21 offen lds
  s_add_u32 m0, s22, 7168
  s_nop 0
  buffer_load_dwordx4 v71, s[12:15], s21 offen lds
  s_add_u32 m0, s22, 8192
  s_nop 0
  buffer_load_dwordx4 v72, s[12:15], s21 offen lds
  s_add_u32 m0, s22, 9216
  s_nop 0
  buffer_load_dwordx4 v73, s[12:15], s21 offen lds
  s_add_u32 m0, s22, 10240
  s_nop 0
  buffer_load_dwordx4 v74, s[12:15], s21 offen lds
  s_add_u32 m0, s22, 11264
  s_nop 0
  buffer_load_dwordx4 v75, s[12:15], s21 offen lds
  s_add_u32 m0, s22, 12288
  s_nop 0
  buffer_load_dwordx4 v76, s[12:15], s21 offen lds
  s_add_u32 m0, s22, 13312
  s_nop 0
  buffer_load_dwordx4 v77, s[12:15], s21 offen lds
  s_add_u32 m0, s22, 14336
  s_nop 0
  buffer_load_dwordx4 v78, s[12:15], s21 offen lds
  s_add_u32 s21, s40, 122880
  s_mul_i32 s22, s20, 15360
  s_add_u32 s22, s22, 0
  buffer_load_dwordx4 v[80:83], v64, s[12:15], s21 offen
  buffer_load_dwordx4 v[84:87], v65, s[12:15], s21 offen
  buffer_load_dwordx4 v[88:91], v66, s[12:15], s21 offen
  buffer_load_dwordx4 v[92:95], v67, s[12:15], s21 offen
  buffer_load_dwordx4 v[96:99], v68, s[12:15], s21 offen
  buffer_load_dwordx4 v[100:103], v69, s[12:15], s21 offen
  buffer_load_dwordx4 v[104:107], v70, s[12:15], s21 offen
  buffer_load_dwordx4 v[108:111], v71, s[12:15], s21 offen
  buffer_load_dwordx4 v[112:115], v72, s[12:15], s21 offen
  buffer_load_dwordx4 v[116:119], v73, s[12:15], s21 offen
  buffer_load_dwordx4 v[120:123], v74, s[12:15], s21 offen
  buffer_load_dwordx4 v[124:127], v75, s[12:15], s21 offen
  buffer_load_dwordx4 v[128:131], v76, s[12:15], s21 offen
  buffer_load_dwordx4 v[132:135], v77, s[12:15], s21 offen
  buffer_load_dwordx4 v[136:139], v78, s[12:15], s21 offen
  s_add_u32 s21, s40, 184320
  s_mul_i32 s22, s20, 15360
  s_add_u32 s22, s22, 61440
  buffer_load_dwordx4 v[140:143], v64, s[12:15], s21 offen
  buffer_load_dwordx4 v[144:147], v65, s[12:15], s21 offen
  buffer_load_dwordx4 v[148:151], v66, s[12:15], s21 offen
  buffer_load_dwordx4 v[152:155], v67, s[12:15], s21 offen
  buffer_load_dwordx4 v[156:159], v68, s[12:15], s21 offen
  buffer_load_dwordx4 v[160:163], v69, s[12:15], s21 offen
  buffer_load_dwordx4 v[164:167], v70, s[12:15], s21 offen
  buffer_load_dwordx4 v[168:171], v71, s[12:15], s21 offen
  buffer_load_dwordx4 v[172:175], v72, s[12:15], s21 offen
  buffer_load_dwordx4 v[176:179], v73, s[12:15], s21 offen
  buffer_load_dwordx4 v[180:183], v74, s[12:15], s21 offen
  buffer_load_dwordx4 v[184:187], v75, s[12:15], s21 offen
  buffer_load_dwordx4 v[188:191], v76, s[12:15], s21 offen
  buffer_load_dwordx4 v[192:195], v77, s[12:15], s21 offen
  buffer_load_dwordx4 v[196:199], v78, s[12:15], s21 offen
  v_lshrrev_b32 v6, 2, v2
  v_lshl_add_u32 v7, v3, 3, v6
  v_mul_u32_u24 v7, 1280, v7
  v_and_b32 v8, 1, v2
  v_lshl_add_u32 v7, v8, 3, v7
  v_and_b32 v8, 1, v3
  v_lshl_add_u32 v6, v8, 2, v6
  v_lshlrev_b32 v6, 1, v6
  v_bfe_u32 v8, v2, 1, 1
  s_mul_i32 s21, s20, 20
  v_add_u32 v8, s21, v8
  v_add_u32 v5, 0, v8
  v_xor_b32 v5, v5, v6
  v_lshl_add_u32 v200, v5, 4, v7
  v_add_u32 v210, 81920, v200
  v_add_u32 v5, 2, v8
  v_xor_b32 v5, v5, v6
  v_lshl_add_u32 v201, v5, 4, v7
  v_add_u32 v211, 81920, v201
  v_add_u32 v5, 4, v8
  v_xor_b32 v5, v5, v6
  v_lshl_add_u32 v202, v5, 4, v7
  v_add_u32 v212, 81920, v202
  v_add_u32 v5, 6, v8
  v_xor_b32 v5, v5, v6
  v_lshl_add_u32 v203, v5, 4, v7
  v_add_u32 v213, 81920, v203
  v_add_u32 v5, 8, v8
  v_xor_b32 v5, v5, v6
  v_lshl_add_u32 v204, v5, 4, v7
  v_add_u32 v214, 81920, v204
  v_add_u32 v5, 10, v8
  v_xor_b32 v5, v5, v6
  v_lshl_add_u32 v205, v5, 4, v7
  v_add_u32 v215, 81920, v205
  v_add_u32 v5, 12, v8
  v_xor_b32 v5, v5, v6
  v_lshl_add_u32 v206, v5, 4, v7
  v_add_u32 v216, 81920, v206
  v_add_u32 v5, 14, v8
  v_xor_b32 v5, v5, v6
  v_lshl_add_u32 v207, v5, 4, v7
  v_add_u32 v217, 81920, v207
  v_add_u32 v5, 16, v8
  v_xor_b32 v5, v5, v6
  v_lshl_add_u32 v208, v5, 4, v7
  v_add_u32 v218, 81920, v208
  v_add_u32 v5, 18, v8
  v_xor_b32 v5, v5, v6
  v_lshl_add_u32 v209, v5, 4, v7
  v_add_u32 v219, 81920, v209
  s_mul_i32 s22, s20, 15360
  v_lshl_add_u32 v30, v1, 4, s22
  v_add_u32 v31, 61440, v30
  s_waitcnt vmcnt(30)
  s_barrier
  ds_read_b64_tr_b16 a[0:1], v200 offset:0
  ds_read_b64_tr_b16 a[2:3], v200 offset:5120
  ds_read_b64_tr_b16 a[24:25], v201 offset:0
  ds_read_b64_tr_b16 a[26:27], v201 offset:5120
  ds_read_b64_tr_b16 a[48:49], v202 offset:0
  ds_read_b64_tr_b16 a[50:51], v202 offset:5120
  ds_read_b64_tr_b16 a[72:73], v203 offset:0
  ds_read_b64_tr_b16 a[74:75], v203 offset:5120
  ds_read_b64_tr_b16 a[96:97], v204 offset:0
  ds_read_b64_tr_b16 a[98:99], v204 offset:5120
  ds_read_b64_tr_b16 a[120:121], v205 offset:0
  ds_read_b64_tr_b16 a[122:123], v205 offset:5120
  ds_read_b64_tr_b16 a[144:145], v206 offset:0
  ds_read_b64_tr_b16 a[146:147], v206 offset:5120
  ds_read_b64_tr_b16 a[168:169], v207 offset:0
  ds_read_b64_tr_b16 a[170:171], v207 offset:5120
  ds_read_b64_tr_b16 a[192:193], v208 offset:0
  ds_read_b64_tr_b16 a[194:195], v208 offset:5120
  ds_read_b64_tr_b16 a[216:217], v209 offset:0
  ds_read_b64_tr_b16 a[218:219], v209 offset:5120
  ds_read_b64_tr_b16 a[4:5], v200 offset:40960
  ds_read_b64_tr_b16 a[6:7], v200 offset:46080
  ds_read_b64_tr_b16 a[28:29], v201 offset:40960
  ds_read_b64_tr_b16 a[30:31], v201 offset:46080
  ds_read_b64_tr_b16 a[52:53], v202 offset:40960
  ds_read_b64_tr_b16 a[54:55], v202 offset:46080
  ds_read_b64_tr_b16 a[76:77], v203 offset:40960
  ds_read_b64_tr_b16 a[78:79], v203 offset:46080
  ds_read_b64_tr_b16 a[100:101], v204 offset:40960
  ds_read_b64_tr_b16 a[102:103], v204 offset:46080
  ds_read_b64_tr_b16 a[124:125], v205 offset:40960
  ds_read_b64_tr_b16 a[126:127], v205 offset:46080
  ds_read_b64_tr_b16 a[148:149], v206 offset:40960
  ds_read_b64_tr_b16 a[150:151], v206 offset:46080
  ds_read_b64_tr_b16 a[172:173], v207 offset:40960
  ds_read_b64_tr_b16 a[174:175], v207 offset:46080
  ds_read_b64_tr_b16 a[196:197], v208 offset:40960
  ds_read_b64_tr_b16 a[198:199], v208 offset:46080
  ds_read_b64_tr_b16 a[220:221], v209 offset:40960
  ds_read_b64_tr_b16 a[222:223], v209 offset:46080
  ds_read_b64_tr_b16 a[8:9], v210 offset:0
  ds_read_b64_tr_b16 a[10:11], v210 offset:5120
  ds_read_b64_tr_b16 a[32:33], v211 offset:0
  ds_read_b64_tr_b16 a[34:35], v211 offset:5120
  ds_read_b64_tr_b16 a[56:57], v212 offset:0
  ds_read_b64_tr_b16 a[58:59], v212 offset:5120
  ds_read_b64_tr_b16 a[80:81], v213 offset:0
  ds_read_b64_tr_b16 a[82:83], v213 offset:5120
  ds_read_b64_tr_b16 a[104:105], v214 offset:0
  ds_read_b64_tr_b16 a[106:107], v214 offset:5120
  ds_read_b64_tr_b16 a[128:129], v215 offset:0
  ds_read_b64_tr_b16 a[130:131], v215 offset:5120
  ds_read_b64_tr_b16 a[152:153], v216 offset:0
  ds_read_b64_tr_b16 a[154:155], v216 offset:5120
  ds_read_b64_tr_b16 a[176:177], v217 offset:0
  ds_read_b64_tr_b16 a[178:179], v217 offset:5120
  ds_read_b64_tr_b16 a[200:201], v218 offset:0
  ds_read_b64_tr_b16 a[202:203], v218 offset:5120
  ds_read_b64_tr_b16 a[224:225], v219 offset:0
  ds_read_b64_tr_b16 a[226:227], v219 offset:5120
  s_waitcnt lgkmcnt(0)
  s_barrier
  s_waitcnt vmcnt(15)
  ds_write_b128 v30, v[80:83] offset:0
  ds_write_b128 v30, v[84:87] offset:1024
  ds_write_b128 v30, v[88:91] offset:2048
  ds_write_b128 v30, v[92:95] offset:3072
  ds_write_b128 v30, v[96:99] offset:4096
  ds_write_b128 v30, v[100:103] offset:5120
  ds_write_b128 v30, v[104:107] offset:6144
  ds_write_b128 v30, v[108:111] offset:7168
  ds_write_b128 v30, v[112:115] offset:8192
  ds_write_b128 v30, v[116:119] offset:9216
  ds_write_b128 v30, v[120:123] offset:10240
  ds_write_b128 v30, v[124:127] offset:11264
  ds_write_b128 v30, v[128:131] offset:12288
  ds_write_b128 v30, v[132:135] offset:13312
  ds_write_b128 v30, v[136:139] offset:14336
  s_waitcnt vmcnt(0)
  ds_write_b128 v31, v[140:143] offset:0
  ds_write_b128 v31, v[144:147] offset:1024
  ds_write_b128 v31, v[148:151] offset:2048
  ds_write_b128 v31, v[152:155] offset:3072
  ds_write_b128 v31, v[156:159] offset:4096
  ds_write_b128 v31, v[160:163] offset:5120
  ds_write_b128 v31, v[164:167] offset:6144
  ds_write_b128 v31, v[168:171] offset:7168
  ds_write_b128 v31, v[172:175] offset:8192
  ds_write_b128 v31, v[176:179] offset:9216
  ds_write_b128 v31, v[180:183] offset:10240
  ds_write_b128 v31, v[184:187] offset:11264
  ds_write_b128 v31, v[188:191] offset:12288
  ds_write_b128 v31, v[192:195] offset:13312
  ds_write_b128 v31, v[196:199] offset:14336
  s_waitcnt lgkmcnt(0)
  s_barrier
  ds_read_b64_tr_b16 a[12:13], v200 offset:0
  ds_read_b64_tr_b16 a[14:15], v200 offset:5120
  ds_read_b64_tr_b16 a[36:37], v201 offset:0
  ds_read_b64_tr_b16 a[38:39], v201 offset:5120
  ds_read_b64_tr_b16 a[60:61], v202 offset:0
  ds_read_b64_tr_b16 a[62:63], v202 offset:5120
  ds_read_b64_tr_b16 a[84:85], v203 offset:0
  ds_read_b64_tr_b16 a[86:87], v203 offset:5120
  ds_read_b64_tr_b16 a[108:109], v204 offset:0
  ds_read_b64_tr_b16 a[110:111], v204 offset:5120
  ds_read_b64_tr_b16 a[132:133], v205 offset:0
  ds_read_b64_tr_b16 a[134:135], v205 offset:5120
  ds_read_b64_tr_b16 a[156:157], v206 offset:0
  ds_read_b64_tr_b16 a[158:159], v206 offset:5120
  ds_read_b64_tr_b16 a[180:181], v207 offset:0
  ds_read_b64_tr_b16 a[182:183], v207 offset:5120
  ds_read_b64_tr_b16 a[204:205], v208 offset:0
  ds_read_b64_tr_b16 a[206:207], v208 offset:5120
  ds_read_b64_tr_b16 a[228:229], v209 offset:0
  ds_read_b64_tr_b16 a[230:231], v209 offset:5120
  ds_read_b64_tr_b16 a[16:17], v200 offset:40960
  ds_read_b64_tr_b16 a[18:19], v200 offset:46080
  ds_read_b64_tr_b16 a[40:41], v201 offset:40960
  ds_read_b64_tr_b16 a[42:43], v201 offset:46080
  ds_read_b64_tr_b16 a[64:65], v202 offset:40960
  ds_read_b64_tr_b16 a[66:67], v202 offset:46080
  ds_read_b64_tr_b16 a[88:89], v203 offset:40960
  ds_read_b64_tr_b16 a[90:91], v203 offset:46080
  ds_read_b64_tr_b16 a[112:113], v204 offset:40960
  ds_read_b64_tr_b16 a[114:115], v204 offset:46080
  ds_read_b64_tr_b16 a[136:137], v205 offset:40960
  ds_read_b64_tr_b16 a[138:139], v205 offset:46080
  ds_read_b64_tr_b16 a[160:161], v206 offset:40960
  ds_read_b64_tr_b16 a[162:163], v206 offset:46080
  ds_read_b64_tr_b16 a[184:185], v207 offset:40960
  ds_read_b64_tr_b16 a[186:187], v207 offset:46080
  ds_read_b64_tr_b16 a[208:209], v208 offset:40960
  ds_read_b64_tr_b16 a[210:211], v208 offset:46080
  ds_read_b64_tr_b16 a[232:233], v209 offset:40960
  ds_read_b64_tr_b16 a[234:235], v209 offset:46080
  ds_read_b64_tr_b16 a[20:21], v210 offset:0
  ds_read_b64_tr_b16 a[22:23], v210 offset:5120
  ds_read_b64_tr_b16 a[44:45], v211 offset:0
  ds_read_b64_tr_b16 a[46:47], v211 offset:5120
  ds_read_b64_tr_b16 a[68:69], v212 offset:0
  ds_read_b64_tr_b16 a[70:71], v212 offset:5120
  ds_read_b64_tr_b16 a[92:93], v213 offset:0
  ds_read_b64_tr_b16 a[94:95], v213 offset:5120
  ds_read_b64_tr_b16 a[116:117], v214 offset:0
  ds_read_b64_tr_b16 a[118:119], v214 offset:5120
  ds_read_b64_tr_b16 a[140:141], v215 offset:0
  ds_read_b64_tr_b16 a[142:143], v215 offset:5120
  ds_read_b64_tr_b16 a[164:165], v216 offset:0
  ds_read_b64_tr_b16 a[166:167], v216 offset:5120
  ds_read_b64_tr_b16 a[188:189], v217 offset:0
  ds_read_b64_tr_b16 a[190:191], v217 offset:5120
  ds_read_b64_tr_b16 a[212:213], v218 offset:0
  ds_read_b64_tr_b16 a[214:215], v218 offset:5120
  ds_read_b64_tr_b16 a[236:237], v219 offset:0
  ds_read_b64_tr_b16 a[238:239], v219 offset:5120
  s_waitcnt lgkmcnt(0)
  s_barrier
  s_load_dwordx2 s[32:33], s[0:1], 96
  s_waitcnt lgkmcnt(0)
  s_mov_b32 s32, s32
  s_mov_b32 s33, s33
  s_mov_b32 s34, 256
  s_mov_b32 s35, 0x00020000
  s_mov_b32 s21, 76
  s_cmp_lg_u32 s20, 0
  s_cbranch_scc1 wf_162
  v_mov_b32 v4, 0
  s_mov_b32 s101, 0
wf_161:
  buffer_load_dword v5, v4, s[32:35], s21 offen sc1
  s_add_u32 s101, s101, 1
  s_cmp_gt_u32 s101, 131072
  s_cbranch_scc1 main_end
  s_waitcnt vmcnt(0)
  v_readfirstlane_b32 s100, v5
  s_cmp_ge_u32 s100, 32
  s_cbranch_scc1 wf_162
  s_sleep 8
  s_branch wf_161
wf_162:
  s_barrier
  s_mul_i32 s41, s2, 12288
  s_add_u32 s47, s41, 25165824
  s_mov_b32 s41, s47
  s_mul_i32 s21, s20, 10
  s_mul_i32 s47, s2, 5
  s_lshr_b32 s22, s21, 3
  s_add_u32 s47, s47, s22
  s_and_b32 s48, s21, 7
  s_mov_b32 s66, 0
  s_mov_b32 s67, 0
  s_lshr_b32 s43, s2, 2
  s_lshl_b32 s43, s43, 7
  s_add_u32 s43, s43, 0
  s_lshl_b32 s44, s2, 7
  s_lshl_b32 s21, s20, 2
  s_add_u32 s44, s44, s21
  s_add_u32 s44, s44, 95232
  s_mov_b32 s45, 0
  s_mov_b32 s49, 1
  s_mov_b32 s50, 0
  v_mov_b32 v10, 0
  v_mov_b32 v11, 1
  v_lshlrev_b32 v4, 4, v1
  s_add_u32 s76, s38, 56623104
  s_addc_u32 s77, s39, 0
  s_mov_b32 s78, 6291456
  s_mov_b32 s79, 0x00020000
  s_add_u32 s80, s38, 93323264
  s_addc_u32 s81, s39, 0
  s_mov_b32 s82, 20971520
  s_mov_b32 s83, 0x00020000
  v_and_b32 v12, 3, v1
  v_lshlrev_b32 v12, 3, v12
  v_add_u32 v12, 4, v12
  v_and_b32 v13, 7, v2
  v_lshlrev_b32 v13, 4, v13
  v_lshl_add_u32 v13, v3, 7, v13
  v_lshrrev_b32 v14, 3, v2
  v_mul_u32_u24 v14, 98304, v14
  v_add_u32 v14, v14, v13
  v_and_b32 v15, 1, v3
  v_lshlrev_b32 v15, 8, v15
  v_lshl_add_u32 v15, v2, 4, v15
  v_lshrrev_b32 v16, 1, v3
  v_mul_u32_u24 v16, 327680, v16
  v_add_u32 v15, v15, v16
  v_lshlrev_b32 v17, 10, v1
  v_mov_b32 v19, 0
  s_lshl_b32 s53, s2, 7
  s_add_u32 s53, s53, 19456
  s_mov_b32 s55, 0
  s_mov_b32 s56, 0
  s_mov_b32 s58, 0
  s_mov_b32 s59, 0
  s_add_u32 s84, s38, 50331648
  s_addc_u32 s85, s39, 0
  s_mov_b32 s86, 12582912
  s_mov_b32 s87, 0x00020000
  s_and_b32 s21, s2, 3
  s_mul_i32 s51, s2, 3072
  s_cmp_eq_u32 s21, s20
  s_cselect_b32 s51, s51, 6291456
  v_mov_b32 v244, -1
  v_mov_b32 v245, -1
  v_mov_b32 v246, -1
  v_mov_b32 v247, -1
  s_add_u32 s88, s38, 85983232
  s_addc_u32 s89, s39, 0
  s_mov_b32 s90, 5242880
  s_mov_b32 s91, 0x00020000
  s_mul_i32 s21, s20, 3072
  s_add_u32 s41, s41, s21
  s_mov_b32 s64, s21
  s_add_u32 s67, s21, 98304
  s_mov_b32 s71, s21
  s_mov_b32 s46, 0
  s_mov_b32 s47, 0
  s_mov_b32 s65, 0
  s_mul_i32 s42, s2, 40960
  s_mul_i32 s21, s20, 10240
  s_add_u32 s42, s42, s21
  s_mov_b32 s68, 0x80000000
  s_mov_b32 s70, 0
  s_mov_b32 s40, 0
  s_mov_b32 s30, 0
  s_mov_b32 s31, 0
  v_min_u32 v5, 18, v1
  v_lshlrev_b32 v5, 10, v5
  v_mov_b32 v9, 0
  s_lshl_b32 s21, s20, 2
  s_add_u32 s21, s21, 110592
  v_mov_b32 v6, s21
  v_mov_b32 v7, 110592
  s_mul_i32 s51, s2, 3072
  s_lshl_b32 s21, s20, 10
  s_add_u32 s51, s51, s21
  s_cmp_lt_u32 s20, 3
  s_cselect_b32 s51, s51, 6291456
  s_add_u32 s51, s51, 6094848
  s_cmp_lg_u32 s20, 0
  s_cbranch_scc1 wf_164
  v_mov_b32 v20, 0
  s_mov_b32 s101, 0
wf_163:
  buffer_load_dword v21, v20, s[72:75], s43 offen sc1
  s_add_u32 s101, s101, 1
  s_cmp_gt_u32 s101, 131072
  s_cbranch_scc1 main_end
  s_waitcnt vmcnt(0)
  v_readfirstlane_b32 s100, v21
  s_cmp_ge_u32 s100, 8
  s_cbranch_scc1 wf_164
  s_sleep 4
  s_branch wf_163
wf_164:
  s_barrier
  v_writelane_b32 v9, 8, 0
  v_cmp_gt_u32 vcc, 8, v9
  s_nop 0
  s_bitset1_b64 vcc, 19
  s_ff1_i32_b64 s21, vcc
  s_lshl_b32 s22, s21, 1
  s_lshl_b32 s21, s21, 2
  s_sub_i32 s21, s21, 12
  s_max_i32 s47, s21, s22
  s_cmp_gt_u32 s47, s45
  s_cbranch_scc1 va_165
  s_mov_b32 s101, 0
  s_branch va_168
va_166:
  s_sleep 8
va_168:
  buffer_load_dword v9, v5, s[72:75], s43 offen sc1
  s_add_u32 s101, s101, 1
  s_cmp_gt_u32 s101, 131072
  s_cbranch_scc1 main_end
  s_waitcnt vmcnt(0)
  v_cmp_gt_u32 vcc, 8, v9
  s_nop 0
  s_bitset1_b64 vcc, 19
  s_ff1_i32_b64 s21, vcc
  s_lshl_b32 s22, s21, 1
  s_lshl_b32 s21, s21, 2
  s_sub_i32 s21, s21, 12
  s_max_i32 s47, s21, s22
  s_cmp_gt_u32 s47, s45
  s_cbranch_scc0 va_166
va_165:
  s_add_u32 s22, s45, 6
  s_min_u32 s22, s22, s47
va_167:
  s_cmp_ge_u32 s46, s22
  s_cbranch_scc1 va_169
  s_mov_b32 m0, s64
  s_mov_b32 s66, s41
  buffer_load_dwordx4 v4, s[16:19], s66 offen offset:0 sc1 lds
  buffer_load_dwordx4 v4, s[16:19], s66 offen offset:1024 sc1 lds
  buffer_load_dwordx4 v4, s[16:19], s66 offen offset:2048 sc1 lds
  s_add_u32 s46, s46, 1
  s_add_u32 s41, s41, 393216
  s_add_u32 s64, s64, 12288
  s_cmp_lt_u32 s64, s67
  s_cselect_b32 s64, s64, s71
  s_branch va_167
va_169:
  s_mov_b32 s48, s46
  s_mov_b32 s49, s46
  s_mov_b32 s50, s46
  s_waitcnt vmcnt(0)
  s_barrier
  v_mov_b32 v8, v4
  s_add_u32 s65, s65, 12288
  s_cmp_lt_u32 s65, 98304
  s_cselect_b32 s65, s65, 0
  ds_read_b128 v[144:147], v8 offset:0
  ds_read_b128 v[148:151], v8 offset:1024
  ds_read_b128 v[152:155], v8 offset:2048
  ds_read_b128 v[156:159], v8 offset:3072
  ds_read_b128 v[160:163], v8 offset:4096
  ds_read_b128 v[164:167], v8 offset:5120
  ds_read_b128 v[168:171], v8 offset:6144
  ds_read_b128 v[172:175], v8 offset:7168
  ds_read_b128 v[176:179], v8 offset:8192
  ds_read_b128 v[180:183], v8 offset:9216
  ds_read_b128 v[184:187], v8 offset:10240
  ds_read_b128 v[188:191], v8 offset:11264
  s_add_u32 s21, s45, 1
  s_min_u32 s21, s21, 63
  s_cmp_lt_u32 s21, s50
  s_addc_u32 s21, s31, s31
  v_mov_b32 v21, s21
  ds_write_b32 v6, v21 offset:0
vwl_170:
  s_waitcnt lgkmcnt(0)
  s_barrier
  v_mfma_f32_16x16x32_bf16 v[64:67], v[144:147], a[0:3], 0
  v_cmp_gt_u32 vcc, 8, v9
  s_nop 0
  v_mfma_f32_16x16x32_bf16 v[72:75], v[144:147], a[24:27], 0
  s_bitset1_b64 vcc, 19
  s_ff1_i32_b64 s21, vcc
  v_mfma_f32_16x16x32_bf16 v[80:83], v[144:147], a[48:51], 0
  s_lshl_b32 s22, s21, 1
  s_lshl_b32 s21, s21, 2
  v_mfma_f32_16x16x32_bf16 v[88:91], v[144:147], a[72:75], 0
  s_sub_i32 s21, s21, 12
  s_max_i32 s47, s21, s22
  v_mfma_f32_16x16x32_bf16 v[96:99], v[144:147], a[96:99], 0
  s_add_u32 s22, s45, 7
  s_min_u32 s22, s22, s47
  v_mfma_f32_16x16x32_bf16 v[68:71], v[168:171], a[0:3], 0
  s_cmp_lt_u32 s46, s22
  s_cselect_b32 s66, s41, 0x80000000
  s_cselect_b32 m0, s64, 98304
  s_cselect_b32 s22, 1, 0
  v_mfma_f32_16x16x32_bf16 v[76:79], v[168:171], a[24:27], 0
  buffer_load_dwordx4 v4, s[16:19], s66 offen offset:0 sc1 lds
  v_mfma_f32_16x16x32_bf16 v[84:87], v[168:171], a[48:51], 0
  v_add_u32 v8, s65, v4
  ds_read_b128 v[240:243], v7 offset:0
  v_mfma_f32_16x16x32_bf16 v[92:95], v[168:171], a[72:75], 0
  buffer_load_dwordx4 v4, s[16:19], s66 offen offset:1024 sc1 lds
  v_mfma_f32_16x16x32_bf16 v[100:103], v[168:171], a[96:99], 0
  s_add_u32 s65, s65, 12288
  v_mfma_f32_16x16x32_bf16 v[64:67], v[148:151], a[4:7], v[64:67]
  buffer_load_dwordx4 v4, s[16:19], s66 offen offset:2048 sc1 lds
  v_mfma_f32_16x16x32_bf16 v[72:75], v[148:151], a[28:31], v[72:75]
  s_cmp_lt_u32 s65, 98304
  s_cselect_b32 s65, s65, 0
  v_mfma_f32_16x16x32_bf16 v[80:83], v[148:151], a[52:55], v[80:83]
  v_cvt_pk_bf16_f32 v44, v104, v105
  v_cvt_pk_bf16_f32 v45, v106, v107
  v_mfma_f32_16x16x32_bf16 v[88:91], v[148:151], a[76:79], v[88:91]
  s_add_u32 s46, s46, s22
  s_mul_i32 s21, s22, 393216
  v_mfma_f32_16x16x32_bf16 v[96:99], v[148:151], a[100:103], v[96:99]
  ds_read_b128 v[192:195], v8 offset:0
  v_cvt_pk_bf16_f32 v46, v108, v109
  v_mfma_f32_16x16x32_bf16 v[68:71], v[172:175], a[4:7], v[68:71]
  s_add_u32 s41, s41, s21
  s_mul_i32 s21, s22, 12288
  v_mfma_f32_16x16x32_bf16 v[76:79], v[172:175], a[28:31], v[76:79]
  v_cvt_pk_bf16_f32 v47, v110, v111
  s_add_u32 s64, s64, s21
  v_mfma_f32_16x16x32_bf16 v[84:87], v[172:175], a[52:55], v[84:87]
  s_add_u32 s69, s68, 4096
  v_mfma_f32_16x16x32_bf16 v[92:95], v[172:175], a[76:79], v[92:95]
  s_cmp_lt_u32 s64, s67
  s_cselect_b32 s64, s64, s71
  v_mfma_f32_16x16x32_bf16 v[100:103], v[172:175], a[100:103], v[100:103]
  buffer_store_dwordx4 v[44:47], v4, s[24:27], s69 offen offset:1024 sc1
  v_mfma_f32_16x16x32_bf16 v[64:67], v[152:155], a[8:11], v[64:67]
  ds_read_b128 v[196:199], v8 offset:1024
  v_mfma_f32_16x16x32_bf16 v[72:75], v[152:155], a[32:35], v[72:75]
  v_cvt_pk_bf16_f32 v48, v112, v113
  v_mfma_f32_16x16x32_bf16 v[80:83], v[152:155], a[56:59], v[80:83]
  v_cvt_pk_bf16_f32 v49, v114, v115
  v_mfma_f32_16x16x32_bf16 v[88:91], v[152:155], a[80:83], v[88:91]
  v_mfma_f32_16x16x32_bf16 v[96:99], v[152:155], a[104:107], v[96:99]
  v_cvt_pk_bf16_f32 v50, v116, v117
  v_mfma_f32_16x16x32_bf16 v[68:71], v[176:179], a[8:11], v[68:71]
  v_mfma_f32_16x16x32_bf16 v[76:79], v[176:179], a[32:35], v[76:79]
  ds_read_b128 v[200:203], v8 offset:2048
  v_cvt_pk_bf16_f32 v51, v118, v119
  v_mfma_f32_16x16x32_bf16 v[84:87], v[176:179], a[56:59], v[84:87]
  buffer_store_dwordx4 v[48:51], v4, s[24:27], s69 offen offset:2048 sc1
  v_mfma_f32_16x16x32_bf16 v[92:95], v[176:179], a[80:83], v[92:95]
  v_mfma_f32_16x16x32_bf16 v[100:103], v[176:179], a[104:107], v[100:103]
  v_cvt_pk_bf16_f32 v52, v120, v121
  v_mfma_f32_16x16x32_bf16 v[64:67], v[156:159], a[12:15], v[64:67]
  v_mfma_f32_16x16x32_bf16 v[72:75], v[156:159], a[36:39], v[72:75]
  v_cvt_pk_bf16_f32 v53, v122, v123
  v_mfma_f32_16x16x32_bf16 v[80:83], v[156:159], a[60:63], v[80:83]
  ds_read_b128 v[204:207], v8 offset:3072
  v_cvt_pk_bf16_f32 v54, v124, v125
  v_mfma_f32_16x16x32_bf16 v[88:91], v[156:159], a[84:87], v[88:91]
  v_mfma_f32_16x16x32_bf16 v[96:99], v[156:159], a[108:111], v[96:99]
  v_cvt_pk_bf16_f32 v55, v126, v127
  v_mfma_f32_16x16x32_bf16 v[68:71], v[180:183], a[12:15], v[68:71]
  v_mfma_f32_16x16x32_bf16 v[76:79], v[180:183], a[36:39], v[76:79]
  buffer_store_dwordx4 v[52:55], v4, s[24:27], s69 offen offset:3072 sc1
  v_mfma_f32_16x16x32_bf16 v[84:87], v[180:183], a[60:63], v[84:87]
  v_cvt_pk_bf16_f32 v56, v128, v129
  v_mfma_f32_16x16x32_bf16 v[92:95], v[180:183], a[84:87], v[92:95]
  ds_read_b128 v[208:211], v8 offset:4096
  v_mfma_f32_16x16x32_bf16 v[100:103], v[180:183], a[108:111], v[100:103]
  v_cvt_pk_bf16_f32 v57, v130, v131
  v_mfma_f32_16x16x32_bf16 v[64:67], v[160:163], a[16:19], v[64:67]
  v_mfma_f32_16x16x32_bf16 v[72:75], v[160:163], a[40:43], v[72:75]
  v_cvt_pk_bf16_f32 v58, v132, v133
  v_mfma_f32_16x16x32_bf16 v[80:83], v[160:163], a[64:67], v[80:83]
  v_cvt_pk_bf16_f32 v59, v134, v135
  v_mfma_f32_16x16x32_bf16 v[88:91], v[160:163], a[88:91], v[88:91]
  v_mfma_f32_16x16x32_bf16 v[96:99], v[160:163], a[112:115], v[96:99]
  ds_read_b128 v[212:215], v8 offset:5120
  s_add_u32 s69, s68, 8192
  v_mfma_f32_16x16x32_bf16 v[68:71], v[184:187], a[16:19], v[68:71]
  v_mfma_f32_16x16x32_bf16 v[76:79], v[184:187], a[40:43], v[76:79]
  buffer_store_dwordx4 v[56:59], v4, s[24:27], s69 offen offset:0 sc1
  v_mfma_f32_16x16x32_bf16 v[84:87], v[184:187], a[64:67], v[84:87]
  v_cvt_pk_bf16_f32 v60, v136, v137
  v_mfma_f32_16x16x32_bf16 v[92:95], v[184:187], a[88:91], v[92:95]
  v_mfma_f32_16x16x32_bf16 v[100:103], v[184:187], a[112:115], v[100:103]
  v_cvt_pk_bf16_f32 v61, v138, v139
  v_mfma_f32_16x16x32_bf16 v[64:67], v[164:167], a[20:23], v[64:67]
  ds_read_b128 v[216:219], v8 offset:6144
  v_mfma_f32_16x16x32_bf16 v[72:75], v[164:167], a[44:47], v[72:75]
  v_cvt_pk_bf16_f32 v62, v140, v141
  v_mfma_f32_16x16x32_bf16 v[80:83], v[164:167], a[68:71], v[80:83]
  v_cvt_pk_bf16_f32 v63, v142, v143
  v_mfma_f32_16x16x32_bf16 v[88:91], v[164:167], a[92:95], v[88:91]
  v_mfma_f32_16x16x32_bf16 v[96:99], v[164:167], a[116:119], v[96:99]
  buffer_store_dwordx4 v[60:63], v4, s[24:27], s69 offen offset:1024 sc1
  v_mfma_f32_16x16x32_bf16 v[68:71], v[188:191], a[20:23], v[68:71]
  v_mfma_f32_16x16x32_bf16 v[76:79], v[188:191], a[44:47], v[76:79]
  ds_read_b128 v[220:223], v8 offset:7168
  v_mfma_f32_16x16x32_bf16 v[84:87], v[188:191], a[68:71], v[84:87]
  v_mfma_f32_16x16x32_bf16 v[92:95], v[188:191], a[92:95], v[92:95]
  v_mfma_f32_16x16x32_bf16 v[100:103], v[188:191], a[116:119], v[100:103]
  v_mfma_f32_16x16x32_bf16 v[104:107], v[144:147], a[120:123], 0
  buffer_load_dword v9, v5, s[72:75], s43 offen sc1
  v_mfma_f32_16x16x32_bf16 v[112:115], v[144:147], a[144:147], 0
  v_mfma_f32_16x16x32_bf16 v[120:123], v[144:147], a[168:171], 0
  ds_read_b128 v[224:227], v8 offset:8192
  v_mfma_f32_16x16x32_bf16 v[128:131], v[144:147], a[192:195], 0
  v_cvt_pk_bf16_f32 v24, v64, v65
  v_mfma_f32_16x16x32_bf16 v[136:139], v[144:147], a[216:219], 0
  v_mfma_f32_16x16x32_bf16 v[108:111], v[168:171], a[120:123], 0
  v_cvt_pk_bf16_f32 v25, v66, v67
  v_mfma_f32_16x16x32_bf16 v[116:119], v[168:171], a[144:147], 0
  s_cmp_lt_u32 s51, 6291456
  s_cselect_b32 s52, s51, 0x80000000
  v_mfma_f32_16x16x32_bf16 v[124:127], v[168:171], a[168:171], 0
  v_cvt_pk_bf16_f32 v26, v68, v69
  v_mfma_f32_16x16x32_bf16 v[132:135], v[168:171], a[192:195], 0
  ds_read_b128 v[228:231], v8 offset:9216
  v_mfma_f32_16x16x32_bf16 v[140:143], v[168:171], a[216:219], 0
  v_cvt_pk_bf16_f32 v27, v70, v71
  v_mfma_f32_16x16x32_bf16 v[104:107], v[148:151], a[124:127], v[104:107]
  buffer_store_dwordx4 v[244:247], v4, s[84:87], s52 offen sc1
  v_mfma_f32_16x16x32_bf16 v[112:115], v[148:151], a[148:151], v[112:115]
  buffer_store_dwordx4 v[24:27], v4, s[24:27], s42 offen offset:0 sc1
  v_mfma_f32_16x16x32_bf16 v[120:123], v[148:151], a[172:175], v[120:123]
  s_add_u32 s51, s51, 98304
  v_mfma_f32_16x16x32_bf16 v[128:131], v[148:151], a[196:199], v[128:131]
  v_cvt_pk_bf16_f32 v28, v72, v73
  v_mfma_f32_16x16x32_bf16 v[136:139], v[148:151], a[220:223], v[136:139]
  ds_read_b128 v[232:235], v8 offset:10240
  v_cvt_pk_bf16_f32 v29, v74, v75
  v_mfma_f32_16x16x32_bf16 v[108:111], v[172:175], a[124:127], v[108:111]
  s_cmp_eq_u32 s40, 3
  s_cbranch_scc1 vwm_172
vwm_173:
  v_mfma_f32_16x16x32_bf16 v[116:119], v[172:175], a[148:151], v[116:119]
  v_cvt_pk_bf16_f32 v30, v76, v77
  v_mfma_f32_16x16x32_bf16 v[124:127], v[172:175], a[172:175], v[124:127]
  v_mfma_f32_16x16x32_bf16 v[132:135], v[172:175], a[196:199], v[132:135]
  v_cvt_pk_bf16_f32 v31, v78, v79
  v_mfma_f32_16x16x32_bf16 v[140:143], v[172:175], a[220:223], v[140:143]
  v_mfma_f32_16x16x32_bf16 v[104:107], v[152:155], a[128:131], v[104:107]
  ds_read_b128 v[236:239], v8 offset:11264
  v_mfma_f32_16x16x32_bf16 v[112:115], v[152:155], a[152:155], v[112:115]
  buffer_store_dwordx4 v[28:31], v4, s[24:27], s42 offen offset:1024 sc1
  v_mfma_f32_16x16x32_bf16 v[120:123], v[152:155], a[176:179], v[120:123]
  v_cvt_pk_bf16_f32 v32, v80, v81
  v_mfma_f32_16x16x32_bf16 v[128:131], v[152:155], a[200:203], v[128:131]
  v_mfma_f32_16x16x32_bf16 v[136:139], v[152:155], a[224:227], v[136:139]
  v_cvt_pk_bf16_f32 v33, v82, v83
  v_mfma_f32_16x16x32_bf16 v[108:111], v[176:179], a[128:131], v[108:111]
  v_cvt_pk_bf16_f32 v34, v84, v85
  v_mfma_f32_16x16x32_bf16 v[116:119], v[176:179], a[152:155], v[116:119]
  v_mfma_f32_16x16x32_bf16 v[124:127], v[176:179], a[176:179], v[124:127]
  v_cvt_pk_bf16_f32 v35, v86, v87
  v_mfma_f32_16x16x32_bf16 v[132:135], v[176:179], a[200:203], v[132:135]
  v_mfma_f32_16x16x32_bf16 v[140:143], v[176:179], a[224:227], v[140:143]
  buffer_store_dwordx4 v[32:35], v4, s[24:27], s42 offen offset:2048 sc1
  v_mfma_f32_16x16x32_bf16 v[104:107], v[156:159], a[132:135], v[104:107]
  v_mfma_f32_16x16x32_bf16 v[112:115], v[156:159], a[156:159], v[112:115]
  v_cvt_pk_bf16_f32 v36, v88, v89
  v_mfma_f32_16x16x32_bf16 v[120:123], v[156:159], a[180:183], v[120:123]
  v_mfma_f32_16x16x32_bf16 v[128:131], v[156:159], a[204:207], v[128:131]
  v_cvt_pk_bf16_f32 v37, v90, v91
  v_mfma_f32_16x16x32_bf16 v[136:139], v[156:159], a[228:231], v[136:139]
  v_mfma_f32_16x16x32_bf16 v[108:111], v[180:183], a[132:135], v[108:111]
  v_cvt_pk_bf16_f32 v38, v92, v93
  v_mfma_f32_16x16x32_bf16 v[116:119], v[180:183], a[156:159], v[116:119]
  v_cvt_pk_bf16_f32 v39, v94, v95
  s_waitcnt lgkmcnt(0)
  v_mfma_f32_16x16x32_bf16 v[124:127], v[180:183], a[180:183], v[124:127]
  v_bitop3_b32 v240, v240, v241, v242 bitop3:0x80
  v_and_b32 v240, v240, v243
  v_mfma_f32_16x16x32_bf16 v[132:135], v[180:183], a[204:207], v[132:135]
  buffer_store_dwordx4 v[36:39], v4, s[24:27], s42 offen offset:3072 sc1
  v_mfma_f32_16x16x32_bf16 v[140:143], v[180:183], a[228:231], v[140:143]
  s_nop 0
  v_readfirstlane_b32 s23, v240
  v_mfma_f32_16x16x32_bf16 v[104:107], v[160:163], a[136:139], v[104:107]
  v_cvt_pk_bf16_f32 v40, v96, v97
  v_mfma_f32_16x16x32_bf16 v[112:115], v[160:163], a[160:163], v[112:115]
  v_mfma_f32_16x16x32_bf16 v[120:123], v[160:163], a[184:187], v[120:123]
  v_cvt_pk_bf16_f32 v41, v98, v99
  v_mfma_f32_16x16x32_bf16 v[128:131], v[160:163], a[208:211], v[128:131]
  v_mfma_f32_16x16x32_bf16 v[136:139], v[160:163], a[232:235], v[136:139]
  v_cvt_pk_bf16_f32 v42, v100, v101
  v_mfma_f32_16x16x32_bf16 v[108:111], v[184:187], a[136:139], v[108:111]
  v_mfma_f32_16x16x32_bf16 v[116:119], v[184:187], a[160:163], v[116:119]
  v_cvt_pk_bf16_f32 v43, v102, v103
  v_mfma_f32_16x16x32_bf16 v[124:127], v[184:187], a[184:187], v[124:127]
  s_add_u32 s69, s42, 4096
  v_mfma_f32_16x16x32_bf16 v[132:135], v[184:187], a[208:211], v[132:135]
  v_mfma_f32_16x16x32_bf16 v[140:143], v[184:187], a[232:235], v[140:143]
  buffer_store_dwordx4 v[40:43], v4, s[24:27], s69 offen offset:0 sc1
  v_mfma_f32_16x16x32_bf16 v[104:107], v[164:167], a[140:143], v[104:107]
  v_mfma_f32_16x16x32_bf16 v[112:115], v[164:167], a[164:167], v[112:115]
  v_mfma_f32_16x16x32_bf16 v[120:123], v[164:167], a[188:191], v[120:123]
  s_waitcnt vmcnt(12)
  s_mov_b32 s50, s46
  s_add_u32 s69, s45, s40
  v_mfma_f32_16x16x32_bf16 v[128:131], v[164:167], a[212:215], v[128:131]
  s_mov_b32 s40, 0
  s_sub_i32 s69, s69, 1
  s_max_i32 s69, s69, s70
  v_mfma_f32_16x16x32_bf16 v[136:139], v[164:167], a[236:239], v[136:139]
  s_add_u32 s45, s45, 1
  s_mov_b32 s68, s42
  s_add_u32 s42, s42, 1310720
  v_mfma_f32_16x16x32_bf16 v[108:111], v[188:191], a[140:143], v[108:111]
  s_add_u32 s21, s45, 1
  s_min_u32 s21, s21, 63
  v_mfma_f32_16x16x32_bf16 v[116:119], v[188:191], a[164:167], v[116:119]
  s_cmp_lt_u32 s21, s50
  s_addc_u32 s21, s31, s31
  v_mov_b32 v21, s21
  v_mfma_f32_16x16x32_bf16 v[124:127], v[188:191], a[188:191], v[124:127]
  ds_write_b32 v6, v21 offset:16
  v_mfma_f32_16x16x32_bf16 v[132:135], v[188:191], a[212:215], v[132:135]
  v_mfma_f32_16x16x32_bf16 v[140:143], v[188:191], a[236:239], v[140:143]
  s_mov_b64 exec, 1
  v_mov_b32 v20, s69
  buffer_store_dword v20, v10, s[72:75], s44 offen sc1
  s_mov_b64 exec, -1
  s_cmp_le_u32 s45, 16
  s_cbranch_scc1 vwe_176
vwe_177:
  s_cmp_eq_u32 s23, 0
  s_cbranch_scc1 vws_174
vwb_175:
  s_waitcnt lgkmcnt(0)
  s_barrier
  v_mfma_f32_16x16x32_bf16 v[64:67], v[192:195], a[0:3], 0
  v_cmp_gt_u32 vcc, 8, v9
  s_nop 0
  v_mfma_f32_16x16x32_bf16 v[72:75], v[192:195], a[24:27], 0
  s_bitset1_b64 vcc, 19
  s_ff1_i32_b64 s21, vcc
  v_mfma_f32_16x16x32_bf16 v[80:83], v[192:195], a[48:51], 0
  s_lshl_b32 s22, s21, 1
  s_lshl_b32 s21, s21, 2
  v_mfma_f32_16x16x32_bf16 v[88:91], v[192:195], a[72:75], 0
  s_sub_i32 s21, s21, 12
  s_max_i32 s47, s21, s22
  v_mfma_f32_16x16x32_bf16 v[96:99], v[192:195], a[96:99], 0
  s_add_u32 s22, s45, 7
  s_min_u32 s22, s22, s47
  v_mfma_f32_16x16x32_bf16 v[68:71], v[216:219], a[0:3], 0
  s_cmp_lt_u32 s46, s22
  s_cselect_b32 s66, s41, 0x80000000
  s_cselect_b32 m0, s64, 98304
  s_cselect_b32 s22, 1, 0
  v_mfma_f32_16x16x32_bf16 v[76:79], v[216:219], a[24:27], 0
  buffer_load_dwordx4 v4, s[16:19], s66 offen offset:0 sc1 lds
  v_mfma_f32_16x16x32_bf16 v[84:87], v[216:219], a[48:51], 0
  v_add_u32 v8, s65, v4
  ds_read_b128 v[240:243], v7 offset:16
  v_mfma_f32_16x16x32_bf16 v[92:95], v[216:219], a[72:75], 0
  buffer_load_dwordx4 v4, s[16:19], s66 offen offset:1024 sc1 lds
  v_mfma_f32_16x16x32_bf16 v[100:103], v[216:219], a[96:99], 0
  s_add_u32 s65, s65, 12288
  v_mfma_f32_16x16x32_bf16 v[64:67], v[196:199], a[4:7], v[64:67]
  buffer_load_dwordx4 v4, s[16:19], s66 offen offset:2048 sc1 lds
  v_mfma_f32_16x16x32_bf16 v[72:75], v[196:199], a[28:31], v[72:75]
  s_cmp_lt_u32 s65, 98304
  s_cselect_b32 s65, s65, 0
  v_mfma_f32_16x16x32_bf16 v[80:83], v[196:199], a[52:55], v[80:83]
  v_cvt_pk_bf16_f32 v44, v104, v105
  v_cvt_pk_bf16_f32 v45, v106, v107
  v_mfma_f32_16x16x32_bf16 v[88:91], v[196:199], a[76:79], v[88:91]
  s_add_u32 s46, s46, s22
  s_mul_i32 s21, s22, 393216
  v_mfma_f32_16x16x32_bf16 v[96:99], v[196:199], a[100:103], v[96:99]
  ds_read_b128 v[144:147], v8 offset:0
  v_cvt_pk_bf16_f32 v46, v108, v109
  v_mfma_f32_16x16x32_bf16 v[68:71], v[220:223], a[4:7], v[68:71]
  s_add_u32 s41, s41, s21
  s_mul_i32 s21, s22, 12288
  v_mfma_f32_16x16x32_bf16 v[76:79], v[220:223], a[28:31], v[76:79]
  v_cvt_pk_bf16_f32 v47, v110, v111
  s_add_u32 s64, s64, s21
  v_mfma_f32_16x16x32_bf16 v[84:87], v[220:223], a[52:55], v[84:87]
  s_add_u32 s69, s68, 4096
  v_mfma_f32_16x16x32_bf16 v[92:95], v[220:223], a[76:79], v[92:95]
  s_cmp_lt_u32 s64, s67
  s_cselect_b32 s64, s64, s71
  v_mfma_f32_16x16x32_bf16 v[100:103], v[220:223], a[100:103], v[100:103]
  buffer_store_dwordx4 v[44:47], v4, s[24:27], s69 offen offset:1024 sc1
  v_mfma_f32_16x16x32_bf16 v[64:67], v[200:203], a[8:11], v[64:67]
  ds_read_b128 v[148:151], v8 offset:1024
  v_mfma_f32_16x16x32_bf16 v[72:75], v[200:203], a[32:35], v[72:75]
  v_cvt_pk_bf16_f32 v48, v112, v113
  v_mfma_f32_16x16x32_bf16 v[80:83], v[200:203], a[56:59], v[80:83]
  v_cvt_pk_bf16_f32 v49, v114, v115
  v_mfma_f32_16x16x32_bf16 v[88:91], v[200:203], a[80:83], v[88:91]
  v_mfma_f32_16x16x32_bf16 v[96:99], v[200:203], a[104:107], v[96:99]
  v_cvt_pk_bf16_f32 v50, v116, v117
  v_mfma_f32_16x16x32_bf16 v[68:71], v[224:227], a[8:11], v[68:71]
  v_mfma_f32_16x16x32_bf16 v[76:79], v[224:227], a[32:35], v[76:79]
  ds_read_b128 v[152:155], v8 offset:2048
  v_cvt_pk_bf16_f32 v51, v118, v119
  v_mfma_f32_16x16x32_bf16 v[84:87], v[224:227], a[56:59], v[84:87]
  buffer_store_dwordx4 v[48:51], v4, s[24:27], s69 offen offset:2048 sc1
  v_mfma_f32_16x16x32_bf16 v[92:95], v[224:227], a[80:83], v[92:95]
  v_mfma_f32_16x16x32_bf16 v[100:103], v[224:227], a[104:107], v[100:103]
  v_cvt_pk_bf16_f32 v52, v120, v121
  v_mfma_f32_16x16x32_bf16 v[64:67], v[204:207], a[12:15], v[64:67]
  v_mfma_f32_16x16x32_bf16 v[72:75], v[204:207], a[36:39], v[72:75]
  v_cvt_pk_bf16_f32 v53, v122, v123
  v_mfma_f32_16x16x32_bf16 v[80:83], v[204:207], a[60:63], v[80:83]
  ds_read_b128 v[156:159], v8 offset:3072
  v_cvt_pk_bf16_f32 v54, v124, v125
  v_mfma_f32_16x16x32_bf16 v[88:91], v[204:207], a[84:87], v[88:91]
  v_mfma_f32_16x16x32_bf16 v[96:99], v[204:207], a[108:111], v[96:99]
  v_cvt_pk_bf16_f32 v55, v126, v127
  v_mfma_f32_16x16x32_bf16 v[68:71], v[228:231], a[12:15], v[68:71]
  v_mfma_f32_16x16x32_bf16 v[76:79], v[228:231], a[36:39], v[76:79]
  buffer_store_dwordx4 v[52:55], v4, s[24:27], s69 offen offset:3072 sc1
  v_mfma_f32_16x16x32_bf16 v[84:87], v[228:231], a[60:63], v[84:87]
  v_cvt_pk_bf16_f32 v56, v128, v129
  v_mfma_f32_16x16x32_bf16 v[92:95], v[228:231], a[84:87], v[92:95]
  ds_read_b128 v[160:163], v8 offset:4096
  v_mfma_f32_16x16x32_bf16 v[100:103], v[228:231], a[108:111], v[100:103]
  v_cvt_pk_bf16_f32 v57, v130, v131
  v_mfma_f32_16x16x32_bf16 v[64:67], v[208:211], a[16:19], v[64:67]
  v_mfma_f32_16x16x32_bf16 v[72:75], v[208:211], a[40:43], v[72:75]
  v_cvt_pk_bf16_f32 v58, v132, v133
  v_mfma_f32_16x16x32_bf16 v[80:83], v[208:211], a[64:67], v[80:83]
  v_cvt_pk_bf16_f32 v59, v134, v135
  v_mfma_f32_16x16x32_bf16 v[88:91], v[208:211], a[88:91], v[88:91]
  v_mfma_f32_16x16x32_bf16 v[96:99], v[208:211], a[112:115], v[96:99]
  ds_read_b128 v[164:167], v8 offset:5120
  s_add_u32 s69, s68, 8192
  v_mfma_f32_16x16x32_bf16 v[68:71], v[232:235], a[16:19], v[68:71]
  v_mfma_f32_16x16x32_bf16 v[76:79], v[232:235], a[40:43], v[76:79]
  buffer_store_dwordx4 v[56:59], v4, s[24:27], s69 offen offset:0 sc1
  v_mfma_f32_16x16x32_bf16 v[84:87], v[232:235], a[64:67], v[84:87]
  v_cvt_pk_bf16_f32 v60, v136, v137
  v_mfma_f32_16x16x32_bf16 v[92:95], v[232:235], a[88:91], v[92:95]
  v_mfma_f32_16x16x32_bf16 v[100:103], v[232:235], a[112:115], v[100:103]
  v_cvt_pk_bf16_f32 v61, v138, v139
  v_mfma_f32_16x16x32_bf16 v[64:67], v[212:215], a[20:23], v[64:67]
  ds_read_b128 v[168:171], v8 offset:6144
  v_mfma_f32_16x16x32_bf16 v[72:75], v[212:215], a[44:47], v[72:75]
  v_cvt_pk_bf16_f32 v62, v140, v141
  v_mfma_f32_16x16x32_bf16 v[80:83], v[212:215], a[68:71], v[80:83]
  v_cvt_pk_bf16_f32 v63, v142, v143
  v_mfma_f32_16x16x32_bf16 v[88:91], v[212:215], a[92:95], v[88:91]
  v_mfma_f32_16x16x32_bf16 v[96:99], v[212:215], a[116:119], v[96:99]
  buffer_store_dwordx4 v[60:63], v4, s[24:27], s69 offen offset:1024 sc1
  v_mfma_f32_16x16x32_bf16 v[68:71], v[236:239], a[20:23], v[68:71]
  v_mfma_f32_16x16x32_bf16 v[76:79], v[236:239], a[44:47], v[76:79]
  ds_read_b128 v[172:175], v8 offset:7168
  v_mfma_f32_16x16x32_bf16 v[84:87], v[236:239], a[68:71], v[84:87]
  v_mfma_f32_16x16x32_bf16 v[92:95], v[236:239], a[92:95], v[92:95]
  v_mfma_f32_16x16x32_bf16 v[100:103], v[236:239], a[116:119], v[100:103]
  v_mfma_f32_16x16x32_bf16 v[104:107], v[192:195], a[120:123], 0
  buffer_load_dword v9, v5, s[72:75], s43 offen sc1
  v_mfma_f32_16x16x32_bf16 v[112:115], v[192:195], a[144:147], 0
  v_mfma_f32_16x16x32_bf16 v[120:123], v[192:195], a[168:171], 0
  ds_read_b128 v[176:179], v8 offset:8192
  v_mfma_f32_16x16x32_bf16 v[128:131], v[192:195], a[192:195], 0
  v_cvt_pk_bf16_f32 v24, v64, v65
  v_mfma_f32_16x16x32_bf16 v[136:139], v[192:195], a[216:219], 0
  v_mfma_f32_16x16x32_bf16 v[108:111], v[216:219], a[120:123], 0
  v_cvt_pk_bf16_f32 v25, v66, v67
  v_mfma_f32_16x16x32_bf16 v[116:119], v[216:219], a[144:147], 0
  s_cmp_lt_u32 s51, 6291456
  s_cselect_b32 s52, s51, 0x80000000
  v_mfma_f32_16x16x32_bf16 v[124:127], v[216:219], a[168:171], 0
  v_cvt_pk_bf16_f32 v26, v68, v69
  v_mfma_f32_16x16x32_bf16 v[132:135], v[216:219], a[192:195], 0
  ds_read_b128 v[180:183], v8 offset:9216
  v_mfma_f32_16x16x32_bf16 v[140:143], v[216:219], a[216:219], 0
  v_cvt_pk_bf16_f32 v27, v70, v71
  v_mfma_f32_16x16x32_bf16 v[104:107], v[196:199], a[124:127], v[104:107]
  buffer_store_dwordx4 v[244:247], v4, s[84:87], s52 offen sc1
  v_mfma_f32_16x16x32_bf16 v[112:115], v[196:199], a[148:151], v[112:115]
  buffer_store_dwordx4 v[24:27], v4, s[24:27], s42 offen offset:0 sc1
  v_mfma_f32_16x16x32_bf16 v[120:123], v[196:199], a[172:175], v[120:123]
  s_add_u32 s51, s51, 98304
  v_mfma_f32_16x16x32_bf16 v[128:131], v[196:199], a[196:199], v[128:131]
  v_cvt_pk_bf16_f32 v28, v72, v73
  v_mfma_f32_16x16x32_bf16 v[136:139], v[196:199], a[220:223], v[136:139]
  ds_read_b128 v[184:187], v8 offset:10240
  v_cvt_pk_bf16_f32 v29, v74, v75
  v_mfma_f32_16x16x32_bf16 v[108:111], v[220:223], a[124:127], v[108:111]
  s_cmp_eq_u32 s40, 3
  s_cbranch_scc1 vwm_180
vwm_181:
  v_mfma_f32_16x16x32_bf16 v[116:119], v[220:223], a[148:151], v[116:119]
  v_cvt_pk_bf16_f32 v30, v76, v77
  v_mfma_f32_16x16x32_bf16 v[124:127], v[220:223], a[172:175], v[124:127]
  v_mfma_f32_16x16x32_bf16 v[132:135], v[220:223], a[196:199], v[132:135]
  v_cvt_pk_bf16_f32 v31, v78, v79
  v_mfma_f32_16x16x32_bf16 v[140:143], v[220:223], a[220:223], v[140:143]
  v_mfma_f32_16x16x32_bf16 v[104:107], v[200:203], a[128:131], v[104:107]
  ds_read_b128 v[188:191], v8 offset:11264
  v_mfma_f32_16x16x32_bf16 v[112:115], v[200:203], a[152:155], v[112:115]
  buffer_store_dwordx4 v[28:31], v4, s[24:27], s42 offen offset:1024 sc1
  v_mfma_f32_16x16x32_bf16 v[120:123], v[200:203], a[176:179], v[120:123]
  v_cvt_pk_bf16_f32 v32, v80, v81
  v_mfma_f32_16x16x32_bf16 v[128:131], v[200:203], a[200:203], v[128:131]
  v_mfma_f32_16x16x32_bf16 v[136:139], v[200:203], a[224:227], v[136:139]
  v_cvt_pk_bf16_f32 v33, v82, v83
  v_mfma_f32_16x16x32_bf16 v[108:111], v[224:227], a[128:131], v[108:111]
  v_cvt_pk_bf16_f32 v34, v84, v85
  v_mfma_f32_16x16x32_bf16 v[116:119], v[224:227], a[152:155], v[116:119]
  v_mfma_f32_16x16x32_bf16 v[124:127], v[224:227], a[176:179], v[124:127]
  v_cvt_pk_bf16_f32 v35, v86, v87
  v_mfma_f32_16x16x32_bf16 v[132:135], v[224:227], a[200:203], v[132:135]
  v_mfma_f32_16x16x32_bf16 v[140:143], v[224:227], a[224:227], v[140:143]
  buffer_store_dwordx4 v[32:35], v4, s[24:27], s42 offen offset:2048 sc1
  v_mfma_f32_16x16x32_bf16 v[104:107], v[204:207], a[132:135], v[104:107]
  v_mfma_f32_16x16x32_bf16 v[112:115], v[204:207], a[156:159], v[112:115]
  v_cvt_pk_bf16_f32 v36, v88, v89
  v_mfma_f32_16x16x32_bf16 v[120:123], v[204:207], a[180:183], v[120:123]
  v_mfma_f32_16x16x32_bf16 v[128:131], v[204:207], a[204:207], v[128:131]
  v_cvt_pk_bf16_f32 v37, v90, v91
  v_mfma_f32_16x16x32_bf16 v[136:139], v[204:207], a[228:231], v[136:139]
  v_mfma_f32_16x16x32_bf16 v[108:111], v[228:231], a[132:135], v[108:111]
  v_cvt_pk_bf16_f32 v38, v92, v93
  v_mfma_f32_16x16x32_bf16 v[116:119], v[228:231], a[156:159], v[116:119]
  v_cvt_pk_bf16_f32 v39, v94, v95
  s_waitcnt lgkmcnt(0)
  v_mfma_f32_16x16x32_bf16 v[124:127], v[228:231], a[180:183], v[124:127]
  v_bitop3_b32 v240, v240, v241, v242 bitop3:0x80
  v_and_b32 v240, v240, v243
  v_mfma_f32_16x16x32_bf16 v[132:135], v[228:231], a[204:207], v[132:135]
  buffer_store_dwordx4 v[36:39], v4, s[24:27], s42 offen offset:3072 sc1
  v_mfma_f32_16x16x32_bf16 v[140:143], v[228:231], a[228:231], v[140:143]
  s_nop 0
  v_readfirstlane_b32 s23, v240
  v_mfma_f32_16x16x32_bf16 v[104:107], v[208:211], a[136:139], v[104:107]
  v_cvt_pk_bf16_f32 v40, v96, v97
  v_mfma_f32_16x16x32_bf16 v[112:115], v[208:211], a[160:163], v[112:115]
  v_mfma_f32_16x16x32_bf16 v[120:123], v[208:211], a[184:187], v[120:123]
  v_cvt_pk_bf16_f32 v41, v98, v99
  v_mfma_f32_16x16x32_bf16 v[128:131], v[208:211], a[208:211], v[128:131]
  v_mfma_f32_16x16x32_bf16 v[136:139], v[208:211], a[232:235], v[136:139]
  v_cvt_pk_bf16_f32 v42, v100, v101
  v_mfma_f32_16x16x32_bf16 v[108:111], v[232:235], a[136:139], v[108:111]
  v_mfma_f32_16x16x32_bf16 v[116:119], v[232:235], a[160:163], v[116:119]
  v_cvt_pk_bf16_f32 v43, v102, v103
  v_mfma_f32_16x16x32_bf16 v[124:127], v[232:235], a[184:187], v[124:127]
  s_add_u32 s69, s42, 4096
  v_mfma_f32_16x16x32_bf16 v[132:135], v[232:235], a[208:211], v[132:135]
  v_mfma_f32_16x16x32_bf16 v[140:143], v[232:235], a[232:235], v[140:143]
  buffer_store_dwordx4 v[40:43], v4, s[24:27], s69 offen offset:0 sc1
  v_mfma_f32_16x16x32_bf16 v[104:107], v[212:215], a[140:143], v[104:107]
  v_mfma_f32_16x16x32_bf16 v[112:115], v[212:215], a[164:167], v[112:115]
  v_mfma_f32_16x16x32_bf16 v[120:123], v[212:215], a[188:191], v[120:123]
  s_waitcnt vmcnt(12)
  s_mov_b32 s50, s46
  s_add_u32 s69, s45, s40
  v_mfma_f32_16x16x32_bf16 v[128:131], v[212:215], a[212:215], v[128:131]
  s_mov_b32 s40, 0
  s_sub_i32 s69, s69, 1
  s_max_i32 s69, s69, s70
  v_mfma_f32_16x16x32_bf16 v[136:139], v[212:215], a[236:239], v[136:139]
  s_add_u32 s45, s45, 1
  s_mov_b32 s68, s42
  s_add_u32 s42, s42, 1310720
  v_mfma_f32_16x16x32_bf16 v[108:111], v[236:239], a[140:143], v[108:111]
  s_add_u32 s21, s45, 1
  s_min_u32 s21, s21, 63
  v_mfma_f32_16x16x32_bf16 v[116:119], v[236:239], a[164:167], v[116:119]
  s_cmp_lt_u32 s21, s50
  s_addc_u32 s21, s31, s31
  v_mov_b32 v21, s21
  v_mfma_f32_16x16x32_bf16 v[124:127], v[236:239], a[188:191], v[124:127]
  ds_write_b32 v6, v21 offset:0
  v_mfma_f32_16x16x32_bf16 v[132:135], v[236:239], a[212:215], v[132:135]
  v_mfma_f32_16x16x32_bf16 v[140:143], v[236:239], a[236:239], v[140:143]
  s_mov_b64 exec, 1
  v_mov_b32 v20, s69
  buffer_store_dword v20, v10, s[72:75], s44 offen sc1
  s_mov_b64 exec, -1
  s_cmp_le_u32 s45, 16
  s_cbranch_scc1 vwe_184
vwe_185:
  s_cmp_lg_u32 s45, 48
  s_cbranch_scc1 arm_188
  s_mul_i32 s21, s2, 10240
  s_mul_i32 s22, s20, 2560
  s_add_u32 s21, s21, s22
  s_add_u32 s21, s21, 18350080
  buffer_store_dwordx4 v[244:247], v15, s[80:83], s21 offen offset:0 sc1
  buffer_store_dwordx4 v[244:247], v15, s[80:83], s21 offen offset:512 sc1
  buffer_store_dwordx4 v[244:247], v15, s[80:83], s21 offen offset:1024 sc1
  buffer_store_dwordx4 v[244:247], v15, s[80:83], s21 offen offset:1536 sc1
  buffer_store_dwordx4 v[244:247], v15, s[80:83], s21 offen offset:2048 sc1
  s_add_u32 s21, s21, 655360
  buffer_store_dwordx4 v[244:247], v15, s[80:83], s21 offen offset:0 sc1
  buffer_store_dwordx4 v[244:247], v15, s[80:83], s21 offen offset:512 sc1
  buffer_store_dwordx4 v[244:247], v15, s[80:83], s21 offen offset:1024 sc1
  buffer_store_dwordx4 v[244:247], v15, s[80:83], s21 offen offset:1536 sc1
  buffer_store_dwordx4 v[244:247], v15, s[80:83], s21 offen offset:2048 sc1
  s_add_u32 s21, s21, 655360
  buffer_store_dwordx4 v[244:247], v15, s[80:83], s21 offen offset:0 sc1
  buffer_store_dwordx4 v[244:247], v15, s[80:83], s21 offen offset:512 sc1
  buffer_store_dwordx4 v[244:247], v15, s[80:83], s21 offen offset:1024 sc1
  buffer_store_dwordx4 v[244:247], v15, s[80:83], s21 offen offset:1536 sc1
  buffer_store_dwordx4 v[244:247], v15, s[80:83], s21 offen offset:2048 sc1
  s_add_u32 s21, s21, 655360
  buffer_store_dwordx4 v[244:247], v15, s[80:83], s21 offen offset:0 sc1
  buffer_store_dwordx4 v[244:247], v15, s[80:83], s21 offen offset:512 sc1
  buffer_store_dwordx4 v[244:247], v15, s[80:83], s21 offen offset:1024 sc1
  buffer_store_dwordx4 v[244:247], v15, s[80:83], s21 offen offset:1536 sc1
  buffer_store_dwordx4 v[244:247], v15, s[80:83], s21 offen offset:2048 sc1
  s_add_u32 s21, s21, 655360
  s_and_b32 s21, s2, 3
  s_cmp_lg_u32 s21, s20
  s_cbranch_scc1 arm_188
  s_mul_i32 s21, s2, 2560
  s_add_u32 s21, s21, 4587520
  v_lshlrev_b32 v21, 3, v1
  buffer_store_dwordx4 v[244:247], v4, s[88:91], s21 offen sc1
  buffer_store_dwordx4 v[244:247], v4, s[88:91], s21 offen offset:1024 sc1
  buffer_store_dwordx2 v[244:245], v21, s[88:91], s21 offen offset:2048 sc1
  s_add_u32 s21, s21, 81920
  buffer_store_dwordx4 v[244:247], v4, s[88:91], s21 offen sc1
  buffer_store_dwordx4 v[244:247], v4, s[88:91], s21 offen offset:1024 sc1
  buffer_store_dwordx2 v[244:245], v21, s[88:91], s21 offen offset:2048 sc1
  s_add_u32 s21, s21, 81920
  buffer_store_dwordx4 v[244:247], v4, s[88:91], s21 offen sc1
  buffer_store_dwordx4 v[244:247], v4, s[88:91], s21 offen offset:1024 sc1
  buffer_store_dwordx2 v[244:245], v21, s[88:91], s21 offen offset:2048 sc1
  s_add_u32 s21, s21, 81920
  buffer_store_dwordx4 v[244:247], v4, s[88:91], s21 offen sc1
  buffer_store_dwordx4 v[244:247], v4, s[88:91], s21 offen offset:1024 sc1
  buffer_store_dwordx2 v[244:245], v21, s[88:91], s21 offen offset:2048 sc1
  s_add_u32 s21, s21, 81920
  buffer_store_dwordx4 v[244:247], v4, s[88:91], s21 offen sc1
  buffer_store_dwordx4 v[244:247], v4, s[88:91], s21 offen offset:1024 sc1
  buffer_store_dwordx2 v[244:245], v21, s[88:91], s21 offen offset:2048 sc1
  s_add_u32 s21, s21, 81920
  buffer_store_dwordx4 v[244:247], v4, s[88:91], s21 offen sc1
  buffer_store_dwordx4 v[244:247], v4, s[88:91], s21 offen offset:1024 sc1
  buffer_store_dwordx2 v[244:245], v21, s[88:91], s21 offen offset:2048 sc1
  s_add_u32 s21, s21, 81920
  buffer_store_dwordx4 v[244:247], v4, s[88:91], s21 offen sc1
  buffer_store_dwordx4 v[244:247], v4, s[88:91], s21 offen offset:1024 sc1
  buffer_store_dwordx2 v[244:245], v21, s[88:91], s21 offen offset:2048 sc1
  s_add_u32 s21, s21, 81920
  buffer_store_dwordx4 v[244:247], v4, s[88:91], s21 offen sc1
  buffer_store_dwordx4 v[244:247], v4, s[88:91], s21 offen offset:1024 sc1
  buffer_store_dwordx2 v[244:245], v21, s[88:91], s21 offen offset:2048 sc1
  s_add_u32 s21, s21, 81920
arm_188:
  s_cmp_ge_u32 s45, 64
  s_cbranch_scc1 vwd_171
  s_cmp_lg_u32 s23, 0
  s_cbranch_scc1 vwl_170
  s_branch vws_182
vws_174:
  v_cmp_gt_u32 vcc, 8, v9
  s_nop 0
  s_bitset1_b64 vcc, 19
  s_ff1_i32_b64 s21, vcc
  s_lshl_b32 s22, s21, 1
  s_lshl_b32 s21, s21, 2
  s_sub_i32 s21, s21, 12
  s_max_i32 s47, s21, s22
  s_cmp_gt_u32 s47, s45
  s_cbranch_scc1 va_190
  s_cmp_eq_u32 s70, s45
  s_cbranch_scc1 va_195
  s_nop 4
  v_cvt_pk_bf16_f32 v44, v104, v105
  v_cvt_pk_bf16_f32 v45, v106, v107
  v_cvt_pk_bf16_f32 v46, v108, v109
  v_cvt_pk_bf16_f32 v47, v110, v111
  s_add_u32 s69, s68, 4096
  buffer_store_dwordx4 v[44:47], v4, s[24:27], s69 offen offset:1024 sc1
  v_cvt_pk_bf16_f32 v48, v112, v113
  v_cvt_pk_bf16_f32 v49, v114, v115
  v_cvt_pk_bf16_f32 v50, v116, v117
  v_cvt_pk_bf16_f32 v51, v118, v119
  buffer_store_dwordx4 v[48:51], v4, s[24:27], s69 offen offset:2048 sc1
  v_cvt_pk_bf16_f32 v52, v120, v121
  v_cvt_pk_bf16_f32 v53, v122, v123
  v_cvt_pk_bf16_f32 v54, v124, v125
  v_cvt_pk_bf16_f32 v55, v126, v127
  buffer_store_dwordx4 v[52:55], v4, s[24:27], s69 offen offset:3072 sc1
  v_cvt_pk_bf16_f32 v56, v128, v129
  v_cvt_pk_bf16_f32 v57, v130, v131
  v_cvt_pk_bf16_f32 v58, v132, v133
  v_cvt_pk_bf16_f32 v59, v134, v135
  s_add_u32 s69, s68, 8192
  buffer_store_dwordx4 v[56:59], v4, s[24:27], s69 offen offset:0 sc1
  v_cvt_pk_bf16_f32 v60, v136, v137
  v_cvt_pk_bf16_f32 v61, v138, v139
  v_cvt_pk_bf16_f32 v62, v140, v141
  v_cvt_pk_bf16_f32 v63, v142, v143
  buffer_store_dwordx4 v[60:63], v4, s[24:27], s69 offen offset:1024 sc1
  s_mov_b32 s68, 0x80000000
  s_waitcnt vmcnt(0)
  s_mov_b64 exec, 1
  v_mov_b32 v20, s45
  buffer_store_dword v20, v10, s[72:75], s44 offen sc1
  s_mov_b64 exec, -1
  s_mov_b32 s70, s45
  s_mov_b32 s40, 0
va_195:
  s_mov_b32 s101, 0
  s_branch va_193
va_191:
  s_sleep 8
va_193:
  buffer_load_dword v9, v5, s[72:75], s43 offen sc1
  s_add_u32 s101, s101, 1
  s_cmp_gt_u32 s101, 131072
  s_cbranch_scc1 main_end
  s_waitcnt vmcnt(0)
  v_cmp_gt_u32 vcc, 8, v9
  s_nop 0
  s_bitset1_b64 vcc, 19
  s_ff1_i32_b64 s21, vcc
  s_lshl_b32 s22, s21, 1
  s_lshl_b32 s21, s21, 2
  s_sub_i32 s21, s21, 12
  s_max_i32 s47, s21, s22
  s_cmp_gt_u32 s47, s45
  s_cbranch_scc0 va_191
va_190:
  s_add_u32 s22, s45, 6
  s_min_u32 s22, s22, s47
va_192:
  s_cmp_ge_u32 s46, s22
  s_cbranch_scc1 va_194
  s_mov_b32 m0, s64
  s_mov_b32 s66, s41
  buffer_load_dwordx4 v4, s[16:19], s66 offen offset:0 sc1 lds
  buffer_load_dwordx4 v4, s[16:19], s66 offen offset:1024 sc1 lds
  buffer_load_dwordx4 v4, s[16:19], s66 offen offset:2048 sc1 lds
  s_add_u32 s46, s46, 1
  s_add_u32 s41, s41, 393216
  s_add_u32 s64, s64, 12288
  s_cmp_lt_u32 s64, s67
  s_cselect_b32 s64, s64, s71
  s_branch va_192
va_194:
  s_mov_b32 s48, s46
  s_mov_b32 s49, s46
  s_mov_b32 s50, s46
  s_waitcnt vmcnt(0)
  s_cmp_eq_u32 s40, 0
  s_cbranch_scc1 va_196
  s_mov_b32 s40, 0
  s_mov_b64 exec, 1
  v_mov_b32 v20, s45
  buffer_store_dword v20, v10, s[72:75], s44 offen sc1
  s_mov_b64 exec, -1
  s_mov_b32 s70, s45
va_196:
  s_barrier
  ds_read_b128 v[192:195], v8 offset:0
  ds_read_b128 v[196:199], v8 offset:1024
  ds_read_b128 v[200:203], v8 offset:2048
  ds_read_b128 v[204:207], v8 offset:3072
  ds_read_b128 v[208:211], v8 offset:4096
  ds_read_b128 v[212:215], v8 offset:5120
  ds_read_b128 v[216:219], v8 offset:6144
  ds_read_b128 v[220:223], v8 offset:7168
  ds_read_b128 v[224:227], v8 offset:8192
  ds_read_b128 v[228:231], v8 offset:9216
  ds_read_b128 v[232:235], v8 offset:10240
  ds_read_b128 v[236:239], v8 offset:11264
  s_add_u32 s21, s45, 1
  s_min_u32 s21, s21, 63
  s_cmp_lt_u32 s21, s50
  s_addc_u32 s21, s31, s31
  v_mov_b32 v21, s21
  ds_write_b32 v6, v21 offset:16
  s_branch vwb_175
vws_182:
  v_cmp_gt_u32 vcc, 8, v9
  s_nop 0
  s_bitset1_b64 vcc, 19
  s_ff1_i32_b64 s21, vcc
  s_lshl_b32 s22, s21, 1
  s_lshl_b32 s21, s21, 2
  s_sub_i32 s21, s21, 12
  s_max_i32 s47, s21, s22
  s_cmp_gt_u32 s47, s45
  s_cbranch_scc1 va_197
  s_cmp_eq_u32 s70, s45
  s_cbranch_scc1 va_202
  s_nop 4
  v_cvt_pk_bf16_f32 v44, v104, v105
  v_cvt_pk_bf16_f32 v45, v106, v107
  v_cvt_pk_bf16_f32 v46, v108, v109
  v_cvt_pk_bf16_f32 v47, v110, v111
  s_add_u32 s69, s68, 4096
  buffer_store_dwordx4 v[44:47], v4, s[24:27], s69 offen offset:1024 sc1
  v_cvt_pk_bf16_f32 v48, v112, v113
  v_cvt_pk_bf16_f32 v49, v114, v115
  v_cvt_pk_bf16_f32 v50, v116, v117
  v_cvt_pk_bf16_f32 v51, v118, v119
  buffer_store_dwordx4 v[48:51], v4, s[24:27], s69 offen offset:2048 sc1
  v_cvt_pk_bf16_f32 v52, v120, v121
  v_cvt_pk_bf16_f32 v53, v122, v123
  v_cvt_pk_bf16_f32 v54, v124, v125
  v_cvt_pk_bf16_f32 v55, v126, v127
  buffer_store_dwordx4 v[52:55], v4, s[24:27], s69 offen offset:3072 sc1
  v_cvt_pk_bf16_f32 v56, v128, v129
  v_cvt_pk_bf16_f32 v57, v130, v131
  v_cvt_pk_bf16_f32 v58, v132, v133
  v_cvt_pk_bf16_f32 v59, v134, v135
  s_add_u32 s69, s68, 8192
  buffer_store_dwordx4 v[56:59], v4, s[24:27], s69 offen offset:0 sc1
  v_cvt_pk_bf16_f32 v60, v136, v137
  v_cvt_pk_bf16_f32 v61, v138, v139
  v_cvt_pk_bf16_f32 v62, v140, v141
  v_cvt_pk_bf16_f32 v63, v142, v143
  buffer_store_dwordx4 v[60:63], v4, s[24:27], s69 offen offset:1024 sc1
  s_mov_b32 s68, 0x80000000
  s_waitcnt vmcnt(0)
  s_mov_b64 exec, 1
  v_mov_b32 v20, s45
  buffer_store_dword v20, v10, s[72:75], s44 offen sc1
  s_mov_b64 exec, -1
  s_mov_b32 s70, s45
  s_mov_b32 s40, 0
va_202:
  s_mov_b32 s101, 0
  s_branch va_200
va_198:
  s_sleep 8
va_200:
  buffer_load_dword v9, v5, s[72:75], s43 offen sc1
  s_add_u32 s101, s101, 1
  s_cmp_gt_u32 s101, 131072
  s_cbranch_scc1 main_end
  s_waitcnt vmcnt(0)
  v_cmp_gt_u32 vcc, 8, v9
  s_nop 0
  s_bitset1_b64 vcc, 19
  s_ff1_i32_b64 s21, vcc
  s_lshl_b32 s22, s21, 1
  s_lshl_b32 s21, s21, 2
  s_sub_i32 s21, s21, 12
  s_max_i32 s47, s21, s22
  s_cmp_gt_u32 s47, s45
  s_cbranch_scc0 va_198
va_197:
  s_add_u32 s22, s45, 6
  s_min_u32 s22, s22, s47
va_199:
  s_cmp_ge_u32 s46, s22
  s_cbranch_scc1 va_201
  s_mov_b32 m0, s64
  s_mov_b32 s66, s41
  buffer_load_dwordx4 v4, s[16:19], s66 offen offset:0 sc1 lds
  buffer_load_dwordx4 v4, s[16:19], s66 offen offset:1024 sc1 lds
  buffer_load_dwordx4 v4, s[16:19], s66 offen offset:2048 sc1 lds
  s_add_u32 s46, s46, 1
  s_add_u32 s41, s41, 393216
  s_add_u32 s64, s64, 12288
  s_cmp_lt_u32 s64, s67
  s_cselect_b32 s64, s64, s71
  s_branch va_199
va_201:
  s_mov_b32 s48, s46
  s_mov_b32 s49, s46
  s_mov_b32 s50, s46
  s_waitcnt vmcnt(0)
  s_cmp_eq_u32 s40, 0
  s_cbranch_scc1 va_203
  s_mov_b32 s40, 0
  s_mov_b64 exec, 1
  v_mov_b32 v20, s45
  buffer_store_dword v20, v10, s[72:75], s44 offen sc1
  s_mov_b64 exec, -1
  s_mov_b32 s70, s45
va_203:
  s_barrier
  ds_read_b128 v[144:147], v8 offset:0
  ds_read_b128 v[148:151], v8 offset:1024
  ds_read_b128 v[152:155], v8 offset:2048
  ds_read_b128 v[156:159], v8 offset:3072
  ds_read_b128 v[160:163], v8 offset:4096
  ds_read_b128 v[164:167], v8 offset:5120
  ds_read_b128 v[168:171], v8 offset:6144
  ds_read_b128 v[172:175], v8 offset:7168
  ds_read_b128 v[176:179], v8 offset:8192
  ds_read_b128 v[180:183], v8 offset:9216
  ds_read_b128 v[184:187], v8 offset:10240
  ds_read_b128 v[188:191], v8 offset:11264
  s_add_u32 s21, s45, 1
  s_min_u32 s21, s21, 63
  s_cmp_lt_u32 s21, s50
  s_addc_u32 s21, s31, s31
  v_mov_b32 v21, s21
  ds_write_b32 v6, v21 offset:0
  s_branch vwl_170
vwe_176:
  s_nop 4
  v_cvt_pk_bf16_f32 v44, v104, v105
  v_cvt_pk_bf16_f32 v45, v106, v107
  v_cvt_pk_bf16_f32 v46, v108, v109
  v_cvt_pk_bf16_f32 v47, v110, v111
  s_add_u32 s69, s68, 4096
  buffer_store_dwordx4 v[44:47], v4, s[24:27], s69 offen offset:1024 sc1
  v_cvt_pk_bf16_f32 v48, v112, v113
  v_cvt_pk_bf16_f32 v49, v114, v115
  v_cvt_pk_bf16_f32 v50, v116, v117
  v_cvt_pk_bf16_f32 v51, v118, v119
  buffer_store_dwordx4 v[48:51], v4, s[24:27], s69 offen offset:2048 sc1
  v_cvt_pk_bf16_f32 v52, v120, v121
  v_cvt_pk_bf16_f32 v53, v122, v123
  v_cvt_pk_bf16_f32 v54, v124, v125
  v_cvt_pk_bf16_f32 v55, v126, v127
  buffer_store_dwordx4 v[52:55], v4, s[24:27], s69 offen offset:3072 sc1
  v_cvt_pk_bf16_f32 v56, v128, v129
  v_cvt_pk_bf16_f32 v57, v130, v131
  v_cvt_pk_bf16_f32 v58, v132, v133
  v_cvt_pk_bf16_f32 v59, v134, v135
  s_add_u32 s69, s68, 8192
  buffer_store_dwordx4 v[56:59], v4, s[24:27], s69 offen offset:0 sc1
  v_cvt_pk_bf16_f32 v60, v136, v137
  v_cvt_pk_bf16_f32 v61, v138, v139
  v_cvt_pk_bf16_f32 v62, v140, v141
  v_cvt_pk_bf16_f32 v63, v142, v143
  buffer_store_dwordx4 v[60:63], v4, s[24:27], s69 offen offset:1024 sc1
  s_mov_b32 s68, 0x80000000
  s_cmp_le_u32 s45, 4
  s_cselect_b32 s40, 3, 1
  s_branch vwe_177
vwe_184:
  s_nop 4
  v_cvt_pk_bf16_f32 v44, v104, v105
  v_cvt_pk_bf16_f32 v45, v106, v107
  v_cvt_pk_bf16_f32 v46, v108, v109
  v_cvt_pk_bf16_f32 v47, v110, v111
  s_add_u32 s69, s68, 4096
  buffer_store_dwordx4 v[44:47], v4, s[24:27], s69 offen offset:1024 sc1
  v_cvt_pk_bf16_f32 v48, v112, v113
  v_cvt_pk_bf16_f32 v49, v114, v115
  v_cvt_pk_bf16_f32 v50, v116, v117
  v_cvt_pk_bf16_f32 v51, v118, v119
  buffer_store_dwordx4 v[48:51], v4, s[24:27], s69 offen offset:2048 sc1
  v_cvt_pk_bf16_f32 v52, v120, v121
  v_cvt_pk_bf16_f32 v53, v122, v123
  v_cvt_pk_bf16_f32 v54, v124, v125
  v_cvt_pk_bf16_f32 v55, v126, v127
  buffer_store_dwordx4 v[52:55], v4, s[24:27], s69 offen offset:3072 sc1
  v_cvt_pk_bf16_f32 v56, v128, v129
  v_cvt_pk_bf16_f32 v57, v130, v131
  v_cvt_pk_bf16_f32 v58, v132, v133
  v_cvt_pk_bf16_f32 v59, v134, v135
  s_add_u32 s69, s68, 8192
  buffer_store_dwordx4 v[56:59], v4, s[24:27], s69 offen offset:0 sc1
  v_cvt_pk_bf16_f32 v60, v136, v137
  v_cvt_pk_bf16_f32 v61, v138, v139
  v_cvt_pk_bf16_f32 v62, v140, v141
  v_cvt_pk_bf16_f32 v63, v142, v143
  buffer_store_dwordx4 v[60:63], v4, s[24:27], s69 offen offset:1024 sc1
  s_mov_b32 s68, 0x80000000
  s_cmp_le_u32 s45, 4
  s_cselect_b32 s40, 3, 1
  s_branch vwe_185
vwm_172:
  s_mov_b32 s40, 0
  s_waitcnt vmcnt(11)
  s_mov_b64 exec, 1
  v_mov_b32 v20, s45
  buffer_store_dword v20, v10, s[72:75], s44 offen sc1
  s_mov_b64 exec, -1
  s_mov_b32 s70, s45
  s_branch vwm_173
vwm_180:
  s_mov_b32 s40, 0
  s_waitcnt vmcnt(11)
  s_mov_b64 exec, 1
  v_mov_b32 v20, s45
  buffer_store_dword v20, v10, s[72:75], s44 offen sc1
  s_mov_b64 exec, -1
  s_mov_b32 s70, s45
  s_branch vwm_181
vwd_171:
  s_nop 4
  v_cvt_pk_bf16_f32 v44, v104, v105
  v_cvt_pk_bf16_f32 v45, v106, v107
  v_cvt_pk_bf16_f32 v46, v108, v109
  v_cvt_pk_bf16_f32 v47, v110, v111
  s_add_u32 s69, s68, 4096
  buffer_store_dwordx4 v[44:47], v4, s[24:27], s69 offen offset:1024 sc1
  v_cvt_pk_bf16_f32 v48, v112, v113
  v_cvt_pk_bf16_f32 v49, v114, v115
  v_cvt_pk_bf16_f32 v50, v116, v117
  v_cvt_pk_bf16_f32 v51, v118, v119
  buffer_store_dwordx4 v[48:51], v4, s[24:27], s69 offen offset:2048 sc1
  v_cvt_pk_bf16_f32 v52, v120, v121
  v_cvt_pk_bf16_f32 v53, v122, v123
  v_cvt_pk_bf16_f32 v54, v124, v125
  v_cvt_pk_bf16_f32 v55, v126, v127
  buffer_store_dwordx4 v[52:55], v4, s[24:27], s69 offen offset:3072 sc1
  v_cvt_pk_bf16_f32 v56, v128, v129
  v_cvt_pk_bf16_f32 v57, v130, v131
  v_cvt_pk_bf16_f32 v58, v132, v133
  v_cvt_pk_bf16_f32 v59, v134, v135
  s_add_u32 s69, s68, 8192
  buffer_store_dwordx4 v[56:59], v4, s[24:27], s69 offen offset:0 sc1
  v_cvt_pk_bf16_f32 v60, v136, v137
  v_cvt_pk_bf16_f32 v61, v138, v139
  v_cvt_pk_bf16_f32 v62, v140, v141
  v_cvt_pk_bf16_f32 v63, v142, v143
  buffer_store_dwordx4 v[60:63], v4, s[24:27], s69 offen offset:1024 sc1
  s_waitcnt vmcnt(0)
  s_mov_b64 exec, 1
  v_mov_b32 v20, s45
  buffer_store_dword v20, v10, s[72:75], s44 offen sc1
  s_mov_b64 exec, -1
  s_mov_b32 s84, 0
  s_mov_b32 s85, -1
  s_and_b32 s21, s3, 3
  s_sub_u32 s22, s21, 0
  s_lshl_b32 s22, s22, 3
  s_bfe_u32 s87, s3, 0x30002
  s_add_u32 s87, s87, s22
  s_add_u32 s87, s87, 358
  s_cmp_lt_u32 s21, 0
  s_cselect_b32 s87, -1, s87
  s_sub_u32 s21, s3, 64
  s_waitcnt vmcnt(0) lgkmcnt(0)
  s_barrier
  s_branch do_opb2
  s_mov_b32 s84, 0
  s_mov_b32 s85, -1
  s_mov_b32 s86, 0
  s_branch queue
not_vw:
  s_sub_u32 s2, s3, 96
  s_cmp_lg_u32 s2, 31
  s_cbranch_scc1 not_cal
  s_add_u32 s8, s38, 83886079
  s_addc_u32 s9, s39, 0
  s_and_b32 s8, s8, 0xffe00000
  s_mov_b32 s10, 2097152
  s_mov_b32 s11, 0x00020000
  v_lshrrev_b32 v9, 4, v0
  v_mul_u32_u24 v9, 16640, v9
  v_bfe_u32 v10, v0, 3, 1
  v_lshl_add_u32 v9, v10, 13, v9
  v_and_b32 v10, 7, v0
  v_lshl_add_u32 v9, v10, 4, v9
  s_mov_b32 s21, 1048576
  buffer_store_dwordx4 v[4:7], v9, s[8:11], s21 offen sc1
  s_waitcnt vmcnt(0)
  s_barrier
  s_cmp_lg_u32 s20, 3
  s_cbranch_scc1 cal_204
  s_mov_b64 exec, 1
  v_mov_b32 v4, 0
  s_mov_b32 s40, -1
  s_mov_b32 s41, -1
  s_mov_b32 s42, 1048576
  s_mov_b32 s43, 0
  s_waitcnt vmcnt(0)
cal_205:
  s_add_u32 s21, s42, 0
  s_memtime s[98:99]
  s_waitcnt lgkmcnt(0)
  buffer_load_dword v5, v4, s[8:11], s21 offen sc1
  s_waitcnt vmcnt(0)
  s_memtime s[100:101]
  s_waitcnt lgkmcnt(0)
  s_sub_u32 s21, s100, s98
  s_min_u32 s40, s40, s21
  s_add_u32 s21, s42, 8192
  s_memtime s[98:99]
  s_waitcnt lgkmcnt(0)
  buffer_load_dword v5, v4, s[8:11], s21 offen sc1
  s_waitcnt vmcnt(0)
  s_memtime s[100:101]
  s_waitcnt lgkmcnt(0)
  s_sub_u32 s21, s100, s98
  s_min_u32 s41, s41, s21
  s_add_u32 s42, s42, 16640
  s_add_u32 s43, s43, 1
  s_cmp_lt_u32 s43, 4
  s_cbranch_scc1 cal_205
  s_cmp_lt_u32 s41, s40
  s_cselect_b32 s21, 1, 2
  v_mov_b32 v4, s21
  v_mov_b32 v5, s40
  v_mov_b32 v6, s41
  v_mov_b32 v8, 84
  buffer_store_dwordx3 v[4:6], v8, s[32:35], 0 offen sc1
  s_waitcnt vmcnt(0)
  s_mov_b64 exec, -1
cal_204:
  s_barrier
  s_branch armed
not_cal:
  s_sleep 32
  s_sleep 32
  s_sleep 32
  s_sleep 32
  s_sleep 32
armed:
  s_load_dwordx2 s[72:73], s[0:1], 104
  s_waitcnt lgkmcnt(0)
  s_add_u32 s72, s72, 81068032
  s_addc_u32 s73, s73, 0
  s_mov_b32 s74, 116736
  s_mov_b32 s75, 0x00020000
  s_load_dwordx2 s[4:5], s[0:1], 0
  s_load_dwordx2 s[6:7], s[0:1], 64
  s_load_dwordx2 s[38:39], s[0:1], 104
  s_lshr_b32 s41, s2, 1
  s_and_b32 s42, s2, 1
  s_waitcnt lgkmcnt(0)
  s_mov_b32 s8, s4
  s_mov_b32 s9, s5
  s_mov_b32 s10, 2621440
  s_mov_b32 s11, 0x00020000
  s_mov_b32 s12, s6
  s_mov_b32 s13, s7
  s_mov_b32 s14, 2457600
  s_mov_b32 s15, 0x00020000
  s_add_u32 s16, s38, 70713344
  s_addc_u32 s17, s39, 0
  s_mov_b32 s18, 2641920
  s_mov_b32 s19, 0x00020000
  s_add_u32 s72, s38, 81068032
  s_addc_u32 s73, s39, 0
  s_mov_b32 s74, 116736
  s_mov_b32 s75, 0x00020000
  v_lshlrev_b32 v6, 1, v3
  v_add_u32 v6, 0, v6
  v_xor_b32 v6, v6, v2
  v_min_u32 v6, 14, v6
  v_mul_u32_u24 v7, 52, v6
  v_lshrrev_b32 v7, 8, v7
  v_mul_u32_u24 v7, 1200, v7
  v_lshl_add_u32 v7, v6, 4, v7
  v_mul_u32_u24 v6, 3840, v3
  v_add_u32 v4, v6, v7
  v_lshlrev_b32 v6, 1, v3
  v_add_u32 v6, 8, v6
  v_xor_b32 v6, v6, v2
  v_min_u32 v6, 14, v6
  v_mul_u32_u24 v7, 52, v6
  v_lshrrev_b32 v7, 8, v7
  v_mul_u32_u24 v7, 1200, v7
  v_lshl_add_u32 v7, v6, 4, v7
  v_mul_u32_u24 v6, 3840, v3
  v_add_u32 v5, v6, v7
  s_mul_i32 s21, s41, 80
  s_mul_i32 s22, s20, 15360
  s_add_u32 s21, s21, s22
  s_lshl_b32 s22, s20, 10
  s_cmp_ge_u32 s20, 2
  s_cselect_b64 vcc, -1, 0
  v_cndmask_b32 v4, v4, v5, vcc
  s_add_u32 m0, s22, 0
  s_nop 0
  buffer_load_dwordx4 v4, s[12:15], s21 offen lds
  s_add_u32 s21, s21, 61440
  s_add_u32 m0, s22, 4096
  s_nop 0
  buffer_load_dwordx4 v4, s[12:15], s21 offen lds
  s_add_u32 s21, s21, 61440
  s_add_u32 m0, s22, 8192
  s_nop 0
  buffer_load_dwordx4 v4, s[12:15], s21 offen lds
  s_add_u32 s21, s21, 61440
  s_add_u32 m0, s22, 12288
  s_nop 0
  buffer_load_dwordx4 v4, s[12:15], s21 offen lds
  s_add_u32 s21, s21, 61440
  s_add_u32 m0, s22, 16384
  s_nop 0
  buffer_load_dwordx4 v4, s[12:15], s21 offen lds
  s_add_u32 s21, s21, 61440
  s_add_u32 m0, s22, 20480
  s_nop 0
  buffer_load_dwordx4 v4, s[12:15], s21 offen lds
  s_add_u32 s21, s21, 61440
  s_add_u32 m0, s22, 24576
  s_nop 0
  buffer_load_dwordx4 v4, s[12:15], s21 offen lds
  s_add_u32 s21, s21, 61440
  s_add_u32 m0, s22, 28672
  s_nop 0
  buffer_load_dwordx4 v4, s[12:15], s21 offen lds
  s_add_u32 s21, s21, 61440
  s_add_u32 m0, s22, 32768
  s_nop 0
  buffer_load_dwordx4 v4, s[12:15], s21 offen lds
  s_add_u32 s21, s21, 61440
  s_add_u32 m0, s22, 36864
  s_nop 0
  buffer_load_dwordx4 v4, s[12:15], s21 offen lds
  s_add_u32 s21, s21, 61440
  s_add_u32 m0, s22, 40960
  s_nop 0
  buffer_load_dwordx4 v4, s[12:15], s21 offen lds
  s_add_u32 s21, s21, 61440
  s_add_u32 m0, s22, 45056
  s_nop 0
  buffer_load_dwordx4 v4, s[12:15], s21 offen lds
  s_add_u32 s21, s21, 61440
  s_add_u32 m0, s22, 49152
  s_nop 0
  buffer_load_dwordx4 v4, s[12:15], s21 offen lds
  s_add_u32 s21, s21, 61440
  s_add_u32 m0, s22, 53248
  s_nop 0
  buffer_load_dwordx4 v4, s[12:15], s21 offen lds
  s_add_u32 s21, s21, 61440
  s_add_u32 m0, s22, 57344
  s_nop 0
  buffer_load_dwordx4 v4, s[12:15], s21 offen lds
  s_add_u32 s21, s21, 61440
  s_add_u32 m0, s22, 61440
  s_nop 0
  buffer_load_dwordx4 v4, s[12:15], s21 offen lds
  s_add_u32 s21, s21, 61440
  s_add_u32 m0, s22, 65536
  s_nop 0
  buffer_load_dwordx4 v4, s[12:15], s21 offen lds
  s_add_u32 s21, s21, 61440
  s_add_u32 m0, s22, 69632
  s_nop 0
  buffer_load_dwordx4 v4, s[12:15], s21 offen lds
  s_add_u32 s21, s21, 61440
  s_add_u32 m0, s22, 73728
  s_nop 0
  buffer_load_dwordx4 v4, s[12:15], s21 offen lds
  s_add_u32 s21, s21, 61440
  s_add_u32 m0, s22, 77824
  s_nop 0
  buffer_load_dwordx4 v4, s[12:15], s21 offen lds
  s_add_u32 s21, s21, 61440
  s_add_u32 m0, s22, 81920
  s_nop 0
  buffer_load_dwordx4 v4, s[12:15], s21 offen lds
  s_add_u32 s21, s21, 61440
  s_add_u32 m0, s22, 86016
  s_nop 0
  buffer_load_dwordx4 v4, s[12:15], s21 offen lds
  s_add_u32 s21, s21, 61440
  s_add_u32 m0, s22, 90112
  s_nop 0
  buffer_load_dwordx4 v4, s[12:15], s21 offen lds
  s_add_u32 s21, s21, 61440
  s_add_u32 m0, s22, 94208
  s_nop 0
  buffer_load_dwordx4 v4, s[12:15], s21 offen lds
  s_add_u32 s21, s21, 61440
  s_add_u32 m0, s22, 98304
  s_nop 0
  buffer_load_dwordx4 v4, s[12:15], s21 offen lds
  s_add_u32 s21, s21, 61440
  s_add_u32 m0, s22, 102400
  s_nop 0
  buffer_load_dwordx4 v4, s[12:15], s21 offen lds
  s_add_u32 s21, s21, 61440
  s_add_u32 m0, s22, 106496
  s_nop 0
  buffer_load_dwordx4 v4, s[12:15], s21 offen lds
  s_add_u32 s21, s21, 61440
  s_add_u32 m0, s22, 110592
  s_nop 0
  buffer_load_dwordx4 v4, s[12:15], s21 offen lds
  s_add_u32 s21, s21, 61440
  s_add_u32 m0, s22, 114688
  s_nop 0
  buffer_load_dwordx4 v4, s[12:15], s21 offen lds
  s_add_u32 s21, s21, 61440
  s_add_u32 m0, s22, 118784
  s_nop 0
  buffer_load_dwordx4 v4, s[12:15], s21 offen lds
  s_add_u32 s21, s21, 61440
  s_add_u32 m0, s22, 122880
  s_nop 0
  buffer_load_dwordx4 v4, s[12:15], s21 offen lds
  s_add_u32 s21, s21, 61440
  s_add_u32 m0, s22, 126976
  s_nop 0
  buffer_load_dwordx4 v4, s[12:15], s21 offen lds
  s_add_u32 s21, s21, 61440
  s_add_u32 m0, s22, 131072
  s_nop 0
  buffer_load_dwordx4 v4, s[12:15], s21 offen lds
  s_add_u32 s21, s21, 61440
  s_add_u32 m0, s22, 135168
  s_nop 0
  buffer_load_dwordx4 v4, s[12:15], s21 offen lds
  s_add_u32 s21, s21, 61440
  s_add_u32 m0, s22, 139264
  s_nop 0
  buffer_load_dwordx4 v4, s[12:15], s21 offen lds
  s_add_u32 s21, s21, 61440
  s_add_u32 m0, s22, 143360
  s_nop 0
  buffer_load_dwordx4 v4, s[12:15], s21 offen lds
  s_add_u32 s21, s21, 61440
  s_add_u32 m0, s22, 147456
  s_nop 0
  buffer_load_dwordx4 v4, s[12:15], s21 offen lds
  s_add_u32 s21, s21, 61440
  s_add_u32 m0, s22, 151552
  s_nop 0
  buffer_load_dwordx4 v4, s[12:15], s21 offen lds
  s_add_u32 s21, s21, 61440
  s_add_u32 m0, s22, 155648
  s_nop 0
  buffer_load_dwordx4 v4, s[12:15], s21 offen lds
  s_add_u32 s21, s21, 61440
  s_add_u32 m0, s22, 159744
  s_nop 0
  buffer_load_dwordx4 v4, s[12:15], s21 offen lds
  s_add_u32 s21, s21, 61440
  s_lshl_b32 s21, s2, 2
  s_add_u32 s21, s21, s20
  s_mul_i32 s21, s21, 20480
  v_lshlrev_b32 v5, 4, v1
  buffer_load_dwordx4 v[64:67], v5, s[8:11], s21 offen offset:0
  buffer_load_dwordx4 v[64:67], v5, s[8:11], s21 offen offset:1024
  buffer_load_dwordx4 v[64:67], v5, s[8:11], s21 offen offset:2048
  buffer_load_dwordx4 v[64:67], v5, s[8:11], s21 offen offset:3072
  s_add_u32 s21, s21, 4096
  buffer_load_dwordx4 v[64:67], v5, s[8:11], s21 offen offset:0
  buffer_load_dwordx4 v[64:67], v5, s[8:11], s21 offen offset:1024
  buffer_load_dwordx4 v[64:67], v5, s[8:11], s21 offen offset:2048
  buffer_load_dwordx4 v[64:67], v5, s[8:11], s21 offen offset:3072
  s_add_u32 s21, s21, 4096
  buffer_load_dwordx4 v[64:67], v5, s[8:11], s21 offen offset:0
  buffer_load_dwordx4 v[64:67], v5, s[8:11], s21 offen offset:1024
  buffer_load_dwordx4 v[64:67], v5, s[8:11], s21 offen offset:2048
  buffer_load_dwordx4 v[64:67], v5, s[8:11], s21 offen offset:3072
  s_add_u32 s21, s21, 4096
  buffer_load_dwordx4 v[64:67], v5, s[8:11], s21 offen offset:0
  buffer_load_dwordx4 v[64:67], v5, s[8:11], s21 offen offset:1024
  buffer_load_dwordx4 v[64:67], v5, s[8:11], s21 offen offset:2048
  buffer_load_dwordx4 v[64:67], v5, s[8:11], s21 offen offset:3072
  s_add_u32 s21, s21, 4096
  buffer_load_dwordx4 v[64:67], v5, s[8:11], s21 offen offset:0
  buffer_load_dwordx4 v[64:67], v5, s[8:11], s21 offen offset:1024
  buffer_load_dwordx4 v[64:67], v5, s[8:11], s21 offen offset:2048
  buffer_load_dwordx4 v[64:67], v5, s[8:11], s21 offen offset:3072
  v_lshrrev_b32 v6, 2, v2
  v_lshl_add_u32 v7, v3, 3, v6
  v_and_b32 v8, 1, v3
  v_lshl_add_u32 v6, v8, 2, v6
  v_lshlrev_b32 v6, 1, v6
  v_bfe_u32 v8, v2, 1, 1
  s_lshl_b32 s21, s20, 2
  v_add_u32 v8, s21, v8
  v_and_b32 v9, 1, v2
  v_lshlrev_b32 v9, 3, v9
  v_lshl_add_u32 v9, v7, 8, v9
  v_add_u32 v5, 0, v8
  v_xor_b32 v5, v5, v6
  v_lshl_add_u32 v10, v5, 4, v9
  v_add_u32 v11, 65536, v10
  v_add_u32 v12, 131072, v10
  v_add_u32 v5, 2, v8
  v_xor_b32 v5, v5, v6
  v_lshl_add_u32 v13, v5, 4, v9
  v_add_u32 v14, 65536, v13
  v_add_u32 v15, 131072, v13
  s_waitcnt vmcnt(50)
  s_barrier
  ds_read_b64_tr_b16 a[0:1], v10 offset:0
  ds_read_b64_tr_b16 a[2:3], v10 offset:1024
  ds_read_b64_tr_b16 a[4:5], v13 offset:0
  ds_read_b64_tr_b16 a[6:7], v13 offset:1024
  ds_read_b64_tr_b16 a[8:9], v10 offset:8192
  ds_read_b64_tr_b16 a[10:11], v10 offset:9216
  ds_read_b64_tr_b16 a[12:13], v13 offset:8192
  ds_read_b64_tr_b16 a[14:15], v13 offset:9216
  ds_read_b64_tr_b16 a[16:17], v10 offset:16384
  ds_read_b64_tr_b16 a[18:19], v10 offset:17408
  ds_read_b64_tr_b16 a[20:21], v13 offset:16384
  ds_read_b64_tr_b16 a[22:23], v13 offset:17408
  ds_read_b64_tr_b16 a[24:25], v10 offset:24576
  ds_read_b64_tr_b16 a[26:27], v10 offset:25600
  ds_read_b64_tr_b16 a[28:29], v13 offset:24576
  ds_read_b64_tr_b16 a[30:31], v13 offset:25600
  ds_read_b64_tr_b16 a[32:33], v10 offset:32768
  ds_read_b64_tr_b16 a[34:35], v10 offset:33792
  ds_read_b64_tr_b16 a[36:37], v13 offset:32768
  ds_read_b64_tr_b16 a[38:39], v13 offset:33792
  s_waitcnt vmcnt(40)
  s_barrier
  ds_read_b64_tr_b16 a[40:41], v10 offset:40960
  ds_read_b64_tr_b16 a[42:43], v10 offset:41984
  ds_read_b64_tr_b16 a[44:45], v13 offset:40960
  ds_read_b64_tr_b16 a[46:47], v13 offset:41984
  ds_read_b64_tr_b16 a[48:49], v10 offset:49152
  ds_read_b64_tr_b16 a[50:51], v10 offset:50176
  ds_read_b64_tr_b16 a[52:53], v13 offset:49152
  ds_read_b64_tr_b16 a[54:55], v13 offset:50176
  ds_read_b64_tr_b16 a[56:57], v10 offset:57344
  ds_read_b64_tr_b16 a[58:59], v10 offset:58368
  ds_read_b64_tr_b16 a[60:61], v13 offset:57344
  ds_read_b64_tr_b16 a[62:63], v13 offset:58368
  ds_read_b64_tr_b16 a[64:65], v11 offset:0
  ds_read_b64_tr_b16 a[66:67], v11 offset:1024
  ds_read_b64_tr_b16 a[68:69], v14 offset:0
  ds_read_b64_tr_b16 a[70:71], v14 offset:1024
  ds_read_b64_tr_b16 a[72:73], v11 offset:8192
  ds_read_b64_tr_b16 a[74:75], v11 offset:9216
  ds_read_b64_tr_b16 a[76:77], v14 offset:8192
  ds_read_b64_tr_b16 a[78:79], v14 offset:9216
  s_waitcnt vmcnt(30)
  s_barrier
  ds_read_b64_tr_b16 a[80:81], v11 offset:16384
  ds_read_b64_tr_b16 a[82:83], v11 offset:17408
  ds_read_b64_tr_b16 a[84:85], v14 offset:16384
  ds_read_b64_tr_b16 a[86:87], v14 offset:17408
  ds_read_b64_tr_b16 a[88:89], v11 offset:24576
  ds_read_b64_tr_b16 a[90:91], v11 offset:25600
  ds_read_b64_tr_b16 a[92:93], v14 offset:24576
  ds_read_b64_tr_b16 a[94:95], v14 offset:25600
  ds_read_b64_tr_b16 a[96:97], v11 offset:32768
  ds_read_b64_tr_b16 a[98:99], v11 offset:33792
  ds_read_b64_tr_b16 a[100:101], v14 offset:32768
  ds_read_b64_tr_b16 a[102:103], v14 offset:33792
  ds_read_b64_tr_b16 a[104:105], v11 offset:40960
  ds_read_b64_tr_b16 a[106:107], v11 offset:41984
  ds_read_b64_tr_b16 a[108:109], v14 offset:40960
  ds_read_b64_tr_b16 a[110:111], v14 offset:41984
  ds_read_b64_tr_b16 a[112:113], v11 offset:49152
  ds_read_b64_tr_b16 a[114:115], v11 offset:50176
  ds_read_b64_tr_b16 a[116:117], v14 offset:49152
  ds_read_b64_tr_b16 a[118:119], v14 offset:50176
  s_waitcnt vmcnt(20)
  s_barrier
  ds_read_b64_tr_b16 a[120:121], v11 offset:57344
  ds_read_b64_tr_b16 a[122:123], v11 offset:58368
  ds_read_b64_tr_b16 a[124:125], v14 offset:57344
  ds_read_b64_tr_b16 a[126:127], v14 offset:58368
  ds_read_b64_tr_b16 a[128:129], v12 offset:0
  ds_read_b64_tr_b16 a[130:131], v12 offset:1024
  ds_read_b64_tr_b16 a[132:133], v15 offset:0
  ds_read_b64_tr_b16 a[134:135], v15 offset:1024
  ds_read_b64_tr_b16 a[136:137], v12 offset:8192
  ds_read_b64_tr_b16 a[138:139], v12 offset:9216
  ds_read_b64_tr_b16 a[140:141], v15 offset:8192
  ds_read_b64_tr_b16 a[142:143], v15 offset:9216
  ds_read_b64_tr_b16 a[144:145], v12 offset:16384
  ds_read_b64_tr_b16 a[146:147], v12 offset:17408
  ds_read_b64_tr_b16 a[148:149], v15 offset:16384
  ds_read_b64_tr_b16 a[150:151], v15 offset:17408
  ds_read_b64_tr_b16 a[152:153], v12 offset:24576
  ds_read_b64_tr_b16 a[154:155], v12 offset:25600
  ds_read_b64_tr_b16 a[156:157], v15 offset:24576
  ds_read_b64_tr_b16 a[158:159], v15 offset:25600
  s_waitcnt lgkmcnt(0)
  s_barrier
  v_and_b32 v4, 31, v1
  s_lshl_b32 s21, s20, 5
  v_add_u32 v36, s21, v4
  v_lshrrev_b32 v5, 5, v1
  v_mul_u32_u24 v6, 264, v36
  v_mul_u32_u24 v7, 40, v5
  s_mov_b32 s21, 114952
  v_add3_u32 v34, v6, v7, s21
  v_lshl_add_u32 v38, v5, 3, v34
  v_lshlrev_b32 v6, 5, v5
  v_sub_u32 v39, v34, v6
  v_lshlrev_b32 v35, 3, v1
  v_add_u32 v35, 114688, v35
  v_mov_b32 v37, 0xf149f2ca
  s_mul_i32 s21, s41, 165120
  s_mul_i32 s22, s42, 16512
  s_add_u32 s21, s21, s22
  v_lshl_add_u32 v7, v36, 4, s21
  v_mul_u32_u24 v6, 99072, v5
  v_add_u32 v29, v6, v7
  v_add_u32 v30, 33024, v29
  v_lshl_add_u32 v31, v5, 3, v7
  v_add_u32 v31, 66048, v31
  v_mov_b32 v8, 0
  v_mov_b32 v9, 0
  ds_write_b64 v35, v[8:9] offset:0
  ds_write_b64 v35, v[8:9] offset:512
  ds_write_b64 v35, v[8:9] offset:1024
  ds_write_b64 v35, v[8:9] offset:1536
  ds_write_b64 v35, v[8:9] offset:2048
  s_mul_i32 s24, s42, 1280
  s_mov_b32 s25, 327680
  s_mov_b32 s26, 8
  s_mov_b32 s27, 0
  s_mov_b32 s60, 0x3e64f92e
  s_mov_b32 s61, 0x3fb8aa3b
  s_mov_b32 s62, 0x05040100
  s_mov_b32 s63, 0x07060302
  v_cmp_le_u32 s[76:77], 0, v36
  v_cmp_le_u32 s[78:79], 1, v36
  v_cmp_le_u32 s[80:81], 2, v36
  v_cmp_le_u32 s[82:83], 3, v36
  v_cmp_le_u32 s[84:85], 4, v36
  v_cmp_le_u32 s[86:87], 5, v36
  v_cmp_le_u32 s[88:89], 6, v36
  v_cmp_le_u32 s[90:91], 7, v36
  v_lshrrev_b32 v11, 3, v1
  v_and_b32 v12, 7, v1
  v_xor_b32 v12, v12, v11
  v_mul_u32_u24 v11, 2560, v11
  v_lshl_add_u32 v10, v12, 4, v11
  s_mul_i32 s46, s20, 81920
  v_add_u32 v10, s46, v10
  s_lshl_b32 s47, s20, 12
  s_add_u32 s47, s47, 0
  s_add_u32 s46, s47, 114688
  s_mov_b32 s30, s24
  s_add_u32 s32, s47, 0
  v_add_u32 v11, 19456, v10
  v_add_u32 v12, 38912, v10
  v_add_u32 v13, 58368, v10
  s_mov_b32 m0, s32
  s_nop 0
  buffer_load_dwordx4 v10, s[8:11], s30 offen offset:0 lds
  buffer_load_dwordx4 v11, s[8:11], s30 offen offset:1024 lds
  buffer_load_dwordx4 v12, s[8:11], s30 offen offset:2048 lds
  buffer_load_dwordx4 v13, s[8:11], s30 offen offset:3072 lds
  s_add_u32 s30, s30, 128
  s_add_u32 s32, s32, 16384
  s_cmp_lt_u32 s32, s46
  s_cselect_b32 s32, s32, s47
  s_mov_b32 m0, s32
  s_nop 0
  buffer_load_dwordx4 v10, s[8:11], s30 offen offset:0 lds
  buffer_load_dwordx4 v11, s[8:11], s30 offen offset:1024 lds
  buffer_load_dwordx4 v12, s[8:11], s30 offen offset:2048 lds
  buffer_load_dwordx4 v13, s[8:11], s30 offen offset:3072 lds
  s_add_u32 s30, s30, 128
  s_add_u32 s32, s32, 16384
  s_cmp_lt_u32 s32, s46
  s_cselect_b32 s32, s32, s47
  s_mov_b32 m0, s32
  s_nop 0
  buffer_load_dwordx4 v10, s[8:11], s30 offen offset:0 lds
  buffer_load_dwordx4 v11, s[8:11], s30 offen offset:1024 lds
  buffer_load_dwordx4 v12, s[8:11], s30 offen offset:2048 lds
  buffer_load_dwordx4 v13, s[8:11], s30 offen offset:3072 lds
  s_add_u32 s30, s30, 128
  s_add_u32 s32, s32, 16384
  s_cmp_lt_u32 s32, s46
  s_cselect_b32 s32, s32, s47
  s_mov_b32 m0, s32
  s_nop 0
  buffer_load_dwordx4 v10, s[8:11], s30 offen offset:0 lds
  buffer_load_dwordx4 v11, s[8:11], s30 offen offset:1024 lds
  buffer_load_dwordx4 v12, s[8:11], s30 offen offset:2048 lds
  buffer_load_dwordx4 v13, s[8:11], s30 offen offset:3072 lds
  s_add_u32 s30, s30, 128
  s_add_u32 s32, s32, 16384
  s_cmp_lt_u32 s32, s46
  s_cselect_b32 s32, s32, s47
  s_mov_b32 m0, s32
  s_nop 0
  buffer_load_dwordx4 v10, s[8:11], s30 offen offset:0 lds
  buffer_load_dwordx4 v11, s[8:11], s30 offen offset:1024 lds
  buffer_load_dwordx4 v12, s[8:11], s30 offen offset:2048 lds
  buffer_load_dwordx4 v13, s[8:11], s30 offen offset:3072 lds
  s_add_u32 s30, s30, 128
  s_add_u32 s32, s32, 16384
  s_cmp_lt_u32 s32, s46
  s_cselect_b32 s32, s32, s47
  v_and_b32 v6, 7, v2
  v_add_u32 v4, 0, v3
  v_xor_b32 v4, v4, v6
  v_lshlrev_b32 v4, 4, v4
  v_lshl_add_u32 v14, v2, 7, v4
  v_add_u32 v4, 4, v3
  v_xor_b32 v4, v4, v6
  v_lshlrev_b32 v4, 4, v4
  v_lshl_add_u32 v15, v2, 7, v4
  v_mul_u32_u24 v22, 264, v2
  v_mul_u32_u24 v4, 8, v3
  s_mul_i32 s21, s20, 64
  s_add_u32 s21, s21, 116800
  v_add3_u32 v22, v22, v4, s21
  v_lshlrev_b32 v4, 3, v3
  v_sub_u32 v16, v22, v4
  v_mov_b32 v9, 2731
  s_mov_b32 s33, 0
  s_mov_b32 s48, 0x80000000
  s_mov_b32 m0, s32
  s_nop 0
  buffer_load_dwordx4 v10, s[8:11], s30 offen offset:0 lds
  buffer_load_dwordx4 v11, s[8:11], s30 offen offset:1024 lds
  s_waitcnt vmcnt(18)
  s_barrier
  v_add_u32 v18, s33, v14
  v_add_u32 v19, s33, v15
  s_add_u32 s33, s33, 16384
  s_cmp_lt_u32 s33, 114688
  s_cselect_b32 s33, s33, 0
  ds_read_b128 v[160:163], v18 offset:0
  ds_read_b128 v[164:167], v18 offset:2048
  ds_read_b128 v[168:171], v18 offset:4096
  ds_read_b128 v[172:175], v18 offset:6144
  ds_read_b128 v[176:179], v18 offset:8192
  ds_read_b128 v[180:183], v18 offset:10240
  ds_read_b128 v[184:187], v18 offset:12288
  ds_read_b128 v[188:191], v18 offset:14336
  s_waitcnt lgkmcnt(0)
bf_blk_206:
  v_mfma_f32_16x16x32_bf16 v[64:67], a[0:3], v[160:163], 0
  ds_read_b128 v[192:195], v19 offset:0
  v_mfma_f32_16x16x32_bf16 v[68:71], a[4:7], v[160:163], 0
  v_add_u32 v18, s33, v14
  v_mfma_f32_16x16x32_bf16 v[72:75], a[0:3], v[164:167], 0
  ds_read_b128 v[196:199], v19 offset:2048
  v_mfma_f32_16x16x32_bf16 v[76:79], a[4:7], v[164:167], 0
  buffer_load_dwordx4 v12, s[8:11], s30 offen offset:2048 lds
  v_mfma_f32_16x16x32_bf16 v[80:83], a[0:3], v[168:171], 0
  ds_read_b128 v[200:203], v19 offset:4096
  v_mfma_f32_16x16x32_bf16 v[84:87], a[4:7], v[168:171], 0
  v_mfma_f32_16x16x32_bf16 v[88:91], a[0:3], v[172:175], 0
  ds_read_b128 v[204:207], v19 offset:6144
  v_mfma_f32_16x16x32_bf16 v[92:95], a[4:7], v[172:175], 0
  s_waitcnt lgkmcnt(14)
  v_mfma_f32_16x16x32_bf16 v[96:99], a[0:3], v[176:179], 0
  ds_read_b128 v[208:211], v19 offset:8192
  v_mfma_f32_16x16x32_bf16 v[100:103], a[4:7], v[176:179], 0
  v_mfma_f32_16x16x32_bf16 v[104:107], a[0:3], v[180:183], 0
  ds_read_b128 v[212:215], v19 offset:10240
  v_mfma_f32_16x16x32_bf16 v[108:111], a[4:7], v[180:183], 0
  buffer_load_dwordx4 v13, s[8:11], s30 offen offset:3072 lds
  v_mfma_f32_16x16x32_bf16 v[112:115], a[0:3], v[184:187], 0
  ds_read_b128 v[216:219], v19 offset:12288
  s_add_u32 s30, s30, 128
  v_mfma_f32_16x16x32_bf16 v[116:119], a[4:7], v[184:187], 0
  s_add_u32 m0, m0, 16384
  v_mfma_f32_16x16x32_bf16 v[120:123], a[0:3], v[188:191], 0
  ds_read_b128 v[220:223], v19 offset:14336
  v_mfma_f32_16x16x32_bf16 v[124:127], a[4:7], v[188:191], 0
  s_waitcnt vmcnt(16) lgkmcnt(4)
  s_barrier
  v_mfma_f32_16x16x32_bf16 v[64:67], a[8:11], v[192:195], v[64:67]
  ds_read_b128 v[160:163], v18 offset:0
  v_mfma_f32_16x16x32_bf16 v[68:71], a[12:15], v[192:195], v[68:71]
  s_cmp_lt_u32 m0, s46
  s_cselect_b32 m0, m0, s47
  v_mfma_f32_16x16x32_bf16 v[72:75], a[8:11], v[196:199], v[72:75]
  ds_read_b128 v[164:167], v18 offset:2048
  v_add_u32 v19, s33, v15
  v_mfma_f32_16x16x32_bf16 v[76:79], a[12:15], v[196:199], v[76:79]
  buffer_load_dwordx4 v10, s[8:11], s30 offen offset:0 lds
  v_mfma_f32_16x16x32_bf16 v[80:83], a[8:11], v[200:203], v[80:83]
  ds_read_b128 v[168:171], v18 offset:4096
  s_add_u32 s33, s33, 16384
  v_mfma_f32_16x16x32_bf16 v[84:87], a[12:15], v[200:203], v[84:87]
  s_cmp_lt_u32 s33, 114688
  s_cselect_b32 s33, s33, 0
  v_mfma_f32_16x16x32_bf16 v[88:91], a[8:11], v[204:207], v[88:91]
  ds_read_b128 v[172:175], v18 offset:6144
  v_mfma_f32_16x16x32_bf16 v[92:95], a[12:15], v[204:207], v[92:95]
  s_waitcnt lgkmcnt(4)
  v_mfma_f32_16x16x32_bf16 v[96:99], a[8:11], v[208:211], v[96:99]
  ds_read_b128 v[176:179], v18 offset:8192
  v_mfma_f32_16x16x32_bf16 v[100:103], a[12:15], v[208:211], v[100:103]
  v_mfma_f32_16x16x32_bf16 v[104:107], a[8:11], v[212:215], v[104:107]
  ds_read_b128 v[180:183], v18 offset:10240
  v_mfma_f32_16x16x32_bf16 v[108:111], a[12:15], v[212:215], v[108:111]
  buffer_load_dwordx4 v11, s[8:11], s30 offen offset:1024 lds
  v_mfma_f32_16x16x32_bf16 v[112:115], a[8:11], v[216:219], v[112:115]
  ds_read_b128 v[184:187], v18 offset:12288
  v_mfma_f32_16x16x32_bf16 v[116:119], a[12:15], v[216:219], v[116:119]
  v_mfma_f32_16x16x32_bf16 v[120:123], a[8:11], v[220:223], v[120:123]
  ds_read_b128 v[188:191], v18 offset:14336
  v_mfma_f32_16x16x32_bf16 v[124:127], a[12:15], v[220:223], v[124:127]
  s_waitcnt lgkmcnt(4)
  v_mfma_f32_16x16x32_bf16 v[64:67], a[16:19], v[160:163], v[64:67]
  ds_read_b128 v[192:195], v19 offset:0
  v_mfma_f32_16x16x32_bf16 v[68:71], a[20:23], v[160:163], v[68:71]
  v_add_u32 v18, s33, v14
  v_mfma_f32_16x16x32_bf16 v[72:75], a[16:19], v[164:167], v[72:75]
  ds_read_b128 v[196:199], v19 offset:2048
  v_mfma_f32_16x16x32_bf16 v[76:79], a[20:23], v[164:167], v[76:79]
  buffer_load_dwordx4 v12, s[8:11], s30 offen offset:2048 lds
  v_mfma_f32_16x16x32_bf16 v[80:83], a[16:19], v[168:171], v[80:83]
  ds_read_b128 v[200:203], v19 offset:4096
  v_mfma_f32_16x16x32_bf16 v[84:87], a[20:23], v[168:171], v[84:87]
  v_mfma_f32_16x16x32_bf16 v[88:91], a[16:19], v[172:175], v[88:91]
  ds_read_b128 v[204:207], v19 offset:6144
  v_mfma_f32_16x16x32_bf16 v[92:95], a[20:23], v[172:175], v[92:95]
  s_waitcnt lgkmcnt(4)
  v_mfma_f32_16x16x32_bf16 v[96:99], a[16:19], v[176:179], v[96:99]
  ds_read_b128 v[208:211], v19 offset:8192
  v_mfma_f32_16x16x32_bf16 v[100:103], a[20:23], v[176:179], v[100:103]
  v_mfma_f32_16x16x32_bf16 v[104:107], a[16:19], v[180:183], v[104:107]
  ds_read_b128 v[212:215], v19 offset:10240
  v_mfma_f32_16x16x32_bf16 v[108:111], a[20:23], v[180:183], v[108:111]
  buffer_load_dwordx4 v13, s[8:11], s30 offen offset:3072 lds
  v_mfma_f32_16x16x32_bf16 v[112:115], a[16:19], v[184:187], v[112:115]
  ds_read_b128 v[216:219], v19 offset:12288
  s_add_u32 s30, s30, 128
  v_mfma_f32_16x16x32_bf16 v[116:119], a[20:23], v[184:187], v[116:119]
  s_add_u32 m0, m0, 16384
  v_mfma_f32_16x16x32_bf16 v[120:123], a[16:19], v[188:191], v[120:123]
  ds_read_b128 v[220:223], v19 offset:14336
  v_mfma_f32_16x16x32_bf16 v[124:127], a[20:23], v[188:191], v[124:127]
  s_waitcnt vmcnt(16) lgkmcnt(4)
  s_barrier
  v_mfma_f32_16x16x32_bf16 v[64:67], a[24:27], v[192:195], v[64:67]
  ds_read_b128 v[160:163], v18 offset:0
  v_mfma_f32_16x16x32_bf16 v[68:71], a[28:31], v[192:195], v[68:71]
  s_cmp_lt_u32 m0, s46
  s_cselect_b32 m0, m0, s47
  v_mfma_f32_16x16x32_bf16 v[72:75], a[24:27], v[196:199], v[72:75]
  ds_read_b128 v[164:167], v18 offset:2048
  v_add_u32 v19, s33, v15
  v_mfma_f32_16x16x32_bf16 v[76:79], a[28:31], v[196:199], v[76:79]
  buffer_load_dwordx4 v10, s[8:11], s30 offen offset:0 lds
  v_mfma_f32_16x16x32_bf16 v[80:83], a[24:27], v[200:203], v[80:83]
  ds_read_b128 v[168:171], v18 offset:4096
  s_add_u32 s33, s33, 16384
  v_mfma_f32_16x16x32_bf16 v[84:87], a[28:31], v[200:203], v[84:87]
  s_cmp_lt_u32 s33, 114688
  s_cselect_b32 s33, s33, 0
  v_mfma_f32_16x16x32_bf16 v[88:91], a[24:27], v[204:207], v[88:91]
  ds_read_b128 v[172:175], v18 offset:6144
  v_mfma_f32_16x16x32_bf16 v[92:95], a[28:31], v[204:207], v[92:95]
  s_waitcnt lgkmcnt(4)
  v_mfma_f32_16x16x32_bf16 v[96:99], a[24:27], v[208:211], v[96:99]
  ds_read_b128 v[176:179], v18 offset:8192
  v_mfma_f32_16x16x32_bf16 v[100:103], a[28:31], v[208:211], v[100:103]
  v_mfma_f32_16x16x32_bf16 v[104:107], a[24:27], v[212:215], v[104:107]
  ds_read_b128 v[180:183], v18 offset:10240
  v_mfma_f32_16x16x32_bf16 v[108:111], a[28:31], v[212:215], v[108:111]
  buffer_load_dwordx4 v11, s[8:11], s30 offen offset:1024 lds
  v_mfma_f32_16x16x32_bf16 v[112:115], a[24:27], v[216:219], v[112:115]
  ds_read_b128 v[184:187], v18 offset:12288
  v_mfma_f32_16x16x32_bf16 v[116:119], a[28:31], v[216:219], v[116:119]
  v_mfma_f32_16x16x32_bf16 v[120:123], a[24:27], v[220:223], v[120:123]
  ds_read_b128 v[188:191], v18 offset:14336
  v_mfma_f32_16x16x32_bf16 v[124:127], a[28:31], v[220:223], v[124:127]
  s_waitcnt lgkmcnt(4)
  v_mfma_f32_16x16x32_bf16 v[64:67], a[32:35], v[160:163], v[64:67]
  ds_read_b128 v[192:195], v19 offset:0
  v_mfma_f32_16x16x32_bf16 v[68:71], a[36:39], v[160:163], v[68:71]
  v_add_u32 v18, s33, v14
  v_mfma_f32_16x16x32_bf16 v[72:75], a[32:35], v[164:167], v[72:75]
  ds_read_b128 v[196:199], v19 offset:2048
  v_mfma_f32_16x16x32_bf16 v[76:79], a[36:39], v[164:167], v[76:79]
  buffer_load_dwordx4 v12, s[8:11], s30 offen offset:2048 lds
  v_mfma_f32_16x16x32_bf16 v[80:83], a[32:35], v[168:171], v[80:83]
  ds_read_b128 v[200:203], v19 offset:4096
  v_mfma_f32_16x16x32_bf16 v[84:87], a[36:39], v[168:171], v[84:87]
  v_mfma_f32_16x16x32_bf16 v[88:91], a[32:35], v[172:175], v[88:91]
  ds_read_b128 v[204:207], v19 offset:6144
  v_mfma_f32_16x16x32_bf16 v[92:95], a[36:39], v[172:175], v[92:95]
  s_waitcnt lgkmcnt(4)
  v_mfma_f32_16x16x32_bf16 v[96:99], a[32:35], v[176:179], v[96:99]
  ds_read_b128 v[208:211], v19 offset:8192
  v_mfma_f32_16x16x32_bf16 v[100:103], a[36:39], v[176:179], v[100:103]
  v_mfma_f32_16x16x32_bf16 v[104:107], a[32:35], v[180:183], v[104:107]
  ds_read_b128 v[212:215], v19 offset:10240
  v_mfma_f32_16x16x32_bf16 v[108:111], a[36:39], v[180:183], v[108:111]
  buffer_load_dwordx4 v13, s[8:11], s30 offen offset:3072 lds
  v_mfma_f32_16x16x32_bf16 v[112:115], a[32:35], v[184:187], v[112:115]
  ds_read_b128 v[216:219], v19 offset:12288
  s_add_u32 s30, s30, 128
  v_mfma_f32_16x16x32_bf16 v[116:119], a[36:39], v[184:187], v[116:119]
  s_add_u32 m0, m0, 16384
  v_mfma_f32_16x16x32_bf16 v[120:123], a[32:35], v[188:191], v[120:123]
  ds_read_b128 v[220:223], v19 offset:14336
  v_mfma_f32_16x16x32_bf16 v[124:127], a[36:39], v[188:191], v[124:127]
  s_waitcnt vmcnt(16) lgkmcnt(4)
  s_barrier
  v_mfma_f32_16x16x32_bf16 v[64:67], a[40:43], v[192:195], v[64:67]
  ds_read_b128 v[160:163], v18 offset:0
  v_mfma_f32_16x16x32_bf16 v[68:71], a[44:47], v[192:195], v[68:71]
  s_cmp_lt_u32 m0, s46
  s_cselect_b32 m0, m0, s47
  v_mfma_f32_16x16x32_bf16 v[72:75], a[40:43], v[196:199], v[72:75]
  ds_read_b128 v[164:167], v18 offset:2048
  v_add_u32 v19, s33, v15
  v_mfma_f32_16x16x32_bf16 v[76:79], a[44:47], v[196:199], v[76:79]
  buffer_load_dwordx4 v10, s[8:11], s30 offen offset:0 lds
  v_mfma_f32_16x16x32_bf16 v[80:83], a[40:43], v[200:203], v[80:83]
  ds_read_b128 v[168:171], v18 offset:4096
  s_add_u32 s33, s33, 16384
  v_mfma_f32_16x16x32_bf16 v[84:87], a[44:47], v[200:203], v[84:87]
  s_cmp_lt_u32 s33, 114688
  s_cselect_b32 s33, s33, 0
  v_mfma_f32_16x16x32_bf16 v[88:91], a[40:43], v[204:207], v[88:91]
  ds_read_b128 v[172:175], v18 offset:6144
  v_mfma_f32_16x16x32_bf16 v[92:95], a[44:47], v[204:207], v[92:95]
  s_waitcnt lgkmcnt(4)
  v_mfma_f32_16x16x32_bf16 v[96:99], a[40:43], v[208:211], v[96:99]
  ds_read_b128 v[176:179], v18 offset:8192
  v_mfma_f32_16x16x32_bf16 v[100:103], a[44:47], v[208:211], v[100:103]
  v_mfma_f32_16x16x32_bf16 v[104:107], a[40:43], v[212:215], v[104:107]
  ds_read_b128 v[180:183], v18 offset:10240
  v_mfma_f32_16x16x32_bf16 v[108:111], a[44:47], v[212:215], v[108:111]
  buffer_load_dwordx4 v11, s[8:11], s30 offen offset:1024 lds
  v_mfma_f32_16x16x32_bf16 v[112:115], a[40:43], v[216:219], v[112:115]
  ds_read_b128 v[184:187], v18 offset:12288
  v_mfma_f32_16x16x32_bf16 v[116:119], a[44:47], v[216:219], v[116:119]
  v_mfma_f32_16x16x32_bf16 v[120:123], a[40:43], v[220:223], v[120:123]
  ds_read_b128 v[188:191], v18 offset:14336
  v_mfma_f32_16x16x32_bf16 v[124:127], a[44:47], v[220:223], v[124:127]
  s_waitcnt lgkmcnt(4)
  v_mfma_f32_16x16x32_bf16 v[64:67], a[48:51], v[160:163], v[64:67]
  ds_read_b128 v[192:195], v19 offset:0
  v_mfma_f32_16x16x32_bf16 v[68:71], a[52:55], v[160:163], v[68:71]
  v_add_u32 v18, s33, v14
  v_mfma_f32_16x16x32_bf16 v[72:75], a[48:51], v[164:167], v[72:75]
  ds_read_b128 v[196:199], v19 offset:2048
  v_mfma_f32_16x16x32_bf16 v[76:79], a[52:55], v[164:167], v[76:79]
  buffer_load_dwordx4 v12, s[8:11], s30 offen offset:2048 lds
  v_mfma_f32_16x16x32_bf16 v[80:83], a[48:51], v[168:171], v[80:83]
  ds_read_b128 v[200:203], v19 offset:4096
  v_mfma_f32_16x16x32_bf16 v[84:87], a[52:55], v[168:171], v[84:87]
  v_mfma_f32_16x16x32_bf16 v[88:91], a[48:51], v[172:175], v[88:91]
  ds_read_b128 v[204:207], v19 offset:6144
  v_mfma_f32_16x16x32_bf16 v[92:95], a[52:55], v[172:175], v[92:95]
  s_waitcnt lgkmcnt(4)
  v_mfma_f32_16x16x32_bf16 v[96:99], a[48:51], v[176:179], v[96:99]
  ds_read_b128 v[208:211], v19 offset:8192
  v_mfma_f32_16x16x32_bf16 v[100:103], a[52:55], v[176:179], v[100:103]
  v_mfma_f32_16x16x32_bf16 v[104:107], a[48:51], v[180:183], v[104:107]
  ds_read_b128 v[212:215], v19 offset:10240
  v_mfma_f32_16x16x32_bf16 v[108:111], a[52:55], v[180:183], v[108:111]
  buffer_load_dwordx4 v13, s[8:11], s30 offen offset:3072 lds
  v_mfma_f32_16x16x32_bf16 v[112:115], a[48:51], v[184:187], v[112:115]
  ds_read_b128 v[216:219], v19 offset:12288
  s_add_u32 s30, s30, 128
  v_mfma_f32_16x16x32_bf16 v[116:119], a[52:55], v[184:187], v[116:119]
  s_add_u32 m0, m0, 16384
  v_mfma_f32_16x16x32_bf16 v[120:123], a[48:51], v[188:191], v[120:123]
  ds_read_b128 v[220:223], v19 offset:14336
  v_mfma_f32_16x16x32_bf16 v[124:127], a[52:55], v[188:191], v[124:127]
  s_waitcnt vmcnt(16) lgkmcnt(4)
  s_barrier
  v_mfma_f32_16x16x32_bf16 v[64:67], a[56:59], v[192:195], v[64:67]
  ds_read_b128 v[160:163], v18 offset:0
  v_mfma_f32_16x16x32_bf16 v[68:71], a[60:63], v[192:195], v[68:71]
  s_cmp_lt_u32 m0, s46
  s_cselect_b32 m0, m0, s47
  v_mfma_f32_16x16x32_bf16 v[72:75], a[56:59], v[196:199], v[72:75]
  ds_read_b128 v[164:167], v18 offset:2048
  v_add_u32 v19, s33, v15
  v_mfma_f32_16x16x32_bf16 v[76:79], a[60:63], v[196:199], v[76:79]
  buffer_load_dwordx4 v10, s[8:11], s30 offen offset:0 lds
  v_mfma_f32_16x16x32_bf16 v[80:83], a[56:59], v[200:203], v[80:83]
  ds_read_b128 v[168:171], v18 offset:4096
  s_add_u32 s33, s33, 16384
  v_mfma_f32_16x16x32_bf16 v[84:87], a[60:63], v[200:203], v[84:87]
  s_cmp_lt_u32 s33, 114688
  s_cselect_b32 s33, s33, 0
  v_mfma_f32_16x16x32_bf16 v[88:91], a[56:59], v[204:207], v[88:91]
  ds_read_b128 v[172:175], v18 offset:6144
  v_mfma_f32_16x16x32_bf16 v[92:95], a[60:63], v[204:207], v[92:95]
  s_waitcnt lgkmcnt(4)
  v_mfma_f32_16x16x32_bf16 v[96:99], a[56:59], v[208:211], v[96:99]
  ds_read_b128 v[176:179], v18 offset:8192
  v_mfma_f32_16x16x32_bf16 v[100:103], a[60:63], v[208:211], v[100:103]
  v_mfma_f32_16x16x32_bf16 v[104:107], a[56:59], v[212:215], v[104:107]
  ds_read_b128 v[180:183], v18 offset:10240
  v_mfma_f32_16x16x32_bf16 v[108:111], a[60:63], v[212:215], v[108:111]
  buffer_load_dwordx4 v11, s[8:11], s30 offen offset:1024 lds
  v_mfma_f32_16x16x32_bf16 v[112:115], a[56:59], v[216:219], v[112:115]
  ds_read_b128 v[184:187], v18 offset:12288
  v_mfma_f32_16x16x32_bf16 v[116:119], a[60:63], v[216:219], v[116:119]
  v_mfma_f32_16x16x32_bf16 v[120:123], a[56:59], v[220:223], v[120:123]
  ds_read_b128 v[188:191], v18 offset:14336
  v_mfma_f32_16x16x32_bf16 v[124:127], a[60:63], v[220:223], v[124:127]
  s_waitcnt lgkmcnt(4)
  v_mfma_f32_16x16x32_bf16 v[64:67], a[64:67], v[160:163], v[64:67]
  ds_read_b128 v[192:195], v19 offset:0
  v_mfma_f32_16x16x32_bf16 v[68:71], a[68:71], v[160:163], v[68:71]
  v_add_u32 v18, s33, v14
  v_mfma_f32_16x16x32_bf16 v[72:75], a[64:67], v[164:167], v[72:75]
  ds_read_b128 v[196:199], v19 offset:2048
  v_mfma_f32_16x16x32_bf16 v[76:79], a[68:71], v[164:167], v[76:79]
  buffer_load_dwordx4 v12, s[8:11], s30 offen offset:2048 lds
  v_mfma_f32_16x16x32_bf16 v[80:83], a[64:67], v[168:171], v[80:83]
  ds_read_b128 v[200:203], v19 offset:4096
  v_mfma_f32_16x16x32_bf16 v[84:87], a[68:71], v[168:171], v[84:87]
  v_mfma_f32_16x16x32_bf16 v[88:91], a[64:67], v[172:175], v[88:91]
  ds_read_b128 v[204:207], v19 offset:6144
  v_mfma_f32_16x16x32_bf16 v[92:95], a[68:71], v[172:175], v[92:95]
  s_waitcnt lgkmcnt(4)
  v_mfma_f32_16x16x32_bf16 v[96:99], a[64:67], v[176:179], v[96:99]
  ds_read_b128 v[208:211], v19 offset:8192
  v_mfma_f32_16x16x32_bf16 v[100:103], a[68:71], v[176:179], v[100:103]
  v_mfma_f32_16x16x32_bf16 v[104:107], a[64:67], v[180:183], v[104:107]
  ds_read_b128 v[212:215], v19 offset:10240
  v_mfma_f32_16x16x32_bf16 v[108:111], a[68:71], v[180:183], v[108:111]
  buffer_load_dwordx4 v13, s[8:11], s30 offen offset:3072 lds
  v_mfma_f32_16x16x32_bf16 v[112:115], a[64:67], v[184:187], v[112:115]
  ds_read_b128 v[216:219], v19 offset:12288
  s_add_u32 s30, s30, s25
  v_mfma_f32_16x16x32_bf16 v[116:119], a[68:71], v[184:187], v[116:119]
  s_sub_u32 s30, s30, 1152
  s_add_u32 m0, m0, 16384
  v_mfma_f32_16x16x32_bf16 v[120:123], a[64:67], v[188:191], v[120:123]
  ds_read_b128 v[220:223], v19 offset:14336
  v_mfma_f32_16x16x32_bf16 v[124:127], a[68:71], v[188:191], v[124:127]
  s_waitcnt vmcnt(16) lgkmcnt(4)
  s_barrier
  v_mfma_f32_16x16x32_bf16 v[64:67], a[72:75], v[192:195], v[64:67]
  ds_read_b128 v[160:163], v18 offset:0
  v_mfma_f32_16x16x32_bf16 v[68:71], a[76:79], v[192:195], v[68:71]
  s_cmp_lt_u32 m0, s46
  s_cselect_b32 m0, m0, s47
  v_mfma_f32_16x16x32_bf16 v[72:75], a[72:75], v[196:199], v[72:75]
  ds_read_b128 v[164:167], v18 offset:2048
  v_add_u32 v19, s33, v15
  v_mfma_f32_16x16x32_bf16 v[76:79], a[76:79], v[196:199], v[76:79]
  buffer_load_dwordx4 v10, s[8:11], s30 offen offset:0 lds
  v_mfma_f32_16x16x32_bf16 v[80:83], a[72:75], v[200:203], v[80:83]
  ds_read_b128 v[168:171], v18 offset:4096
  s_add_u32 s33, s33, 16384
  v_mfma_f32_16x16x32_bf16 v[84:87], a[76:79], v[200:203], v[84:87]
  s_cmp_lt_u32 s33, 114688
  s_cselect_b32 s33, s33, 0
  v_mfma_f32_16x16x32_bf16 v[88:91], a[72:75], v[204:207], v[88:91]
  ds_read_b128 v[172:175], v18 offset:6144
  v_mfma_f32_16x16x32_bf16 v[92:95], a[76:79], v[204:207], v[92:95]
  s_waitcnt lgkmcnt(4)
  v_mfma_f32_16x16x32_bf16 v[96:99], a[72:75], v[208:211], v[96:99]
  ds_read_b128 v[176:179], v18 offset:8192
  v_mfma_f32_16x16x32_bf16 v[100:103], a[76:79], v[208:211], v[100:103]
  v_mfma_f32_16x16x32_bf16 v[104:107], a[72:75], v[212:215], v[104:107]
  ds_read_b128 v[180:183], v18 offset:10240
  v_mfma_f32_16x16x32_bf16 v[108:111], a[76:79], v[212:215], v[108:111]
  buffer_load_dwordx4 v11, s[8:11], s30 offen offset:1024 lds
  v_mfma_f32_16x16x32_bf16 v[112:115], a[72:75], v[216:219], v[112:115]
  ds_read_b128 v[184:187], v18 offset:12288
  v_mfma_f32_16x16x32_bf16 v[116:119], a[76:79], v[216:219], v[116:119]
  v_mfma_f32_16x16x32_bf16 v[120:123], a[72:75], v[220:223], v[120:123]
  ds_read_b128 v[188:191], v18 offset:14336
  v_mfma_f32_16x16x32_bf16 v[124:127], a[76:79], v[220:223], v[124:127]
  s_waitcnt lgkmcnt(4)
  v_mfma_f32_16x16x32_bf16 v[64:67], a[80:83], v[160:163], v[64:67]
  ds_read_b128 v[192:195], v19 offset:0
  v_mfma_f32_16x16x32_bf16 v[68:71], a[84:87], v[160:163], v[68:71]
  v_add_u32 v18, s33, v14
  v_mfma_f32_16x16x32_bf16 v[72:75], a[80:83], v[164:167], v[72:75]
  ds_read_b128 v[196:199], v19 offset:2048
  v_mfma_f32_16x16x32_bf16 v[76:79], a[84:87], v[164:167], v[76:79]
  buffer_load_dwordx4 v12, s[8:11], s30 offen offset:2048 lds
  v_mfma_f32_16x16x32_bf16 v[80:83], a[80:83], v[168:171], v[80:83]
  ds_read_b128 v[200:203], v19 offset:4096
  v_mfma_f32_16x16x32_bf16 v[84:87], a[84:87], v[168:171], v[84:87]
  v_mfma_f32_16x16x32_bf16 v[88:91], a[80:83], v[172:175], v[88:91]
  ds_read_b128 v[204:207], v19 offset:6144
  v_mfma_f32_16x16x32_bf16 v[92:95], a[84:87], v[172:175], v[92:95]
  s_waitcnt lgkmcnt(4)
  v_mfma_f32_16x16x32_bf16 v[96:99], a[80:83], v[176:179], v[96:99]
  ds_read_b128 v[208:211], v19 offset:8192
  v_mfma_f32_16x16x32_bf16 v[100:103], a[84:87], v[176:179], v[100:103]
  v_mfma_f32_16x16x32_bf16 v[104:107], a[80:83], v[180:183], v[104:107]
  ds_read_b128 v[212:215], v19 offset:10240
  v_mfma_f32_16x16x32_bf16 v[108:111], a[84:87], v[180:183], v[108:111]
  buffer_load_dwordx4 v13, s[8:11], s30 offen offset:3072 lds
  v_mfma_f32_16x16x32_bf16 v[112:115], a[80:83], v[184:187], v[112:115]
  ds_read_b128 v[216:219], v19 offset:12288
  s_add_u32 s30, s30, 128
  v_mfma_f32_16x16x32_bf16 v[116:119], a[84:87], v[184:187], v[116:119]
  s_add_u32 m0, m0, 16384
  v_mfma_f32_16x16x32_bf16 v[120:123], a[80:83], v[188:191], v[120:123]
  ds_read_b128 v[220:223], v19 offset:14336
  v_mfma_f32_16x16x32_bf16 v[124:127], a[84:87], v[188:191], v[124:127]
  s_waitcnt vmcnt(16) lgkmcnt(4)
  s_barrier
  v_mfma_f32_16x16x32_bf16 v[64:67], a[88:91], v[192:195], v[64:67]
  ds_read_b128 v[160:163], v18 offset:0
  v_mfma_f32_16x16x32_bf16 v[68:71], a[92:95], v[192:195], v[68:71]
  s_cmp_lt_u32 m0, s46
  s_cselect_b32 m0, m0, s47
  v_mfma_f32_16x16x32_bf16 v[72:75], a[88:91], v[196:199], v[72:75]
  ds_read_b128 v[164:167], v18 offset:2048
  v_add_u32 v19, s33, v15
  v_mfma_f32_16x16x32_bf16 v[76:79], a[92:95], v[196:199], v[76:79]
  buffer_load_dwordx4 v10, s[8:11], s30 offen offset:0 lds
  v_mfma_f32_16x16x32_bf16 v[80:83], a[88:91], v[200:203], v[80:83]
  ds_read_b128 v[168:171], v18 offset:4096
  s_add_u32 s33, s33, 16384
  v_mfma_f32_16x16x32_bf16 v[84:87], a[92:95], v[200:203], v[84:87]
  s_cmp_lt_u32 s33, 114688
  s_cselect_b32 s33, s33, 0
  v_mfma_f32_16x16x32_bf16 v[88:91], a[88:91], v[204:207], v[88:91]
  ds_read_b128 v[172:175], v18 offset:6144
  v_mfma_f32_16x16x32_bf16 v[92:95], a[92:95], v[204:207], v[92:95]
  s_waitcnt lgkmcnt(4)
  v_mfma_f32_16x16x32_bf16 v[96:99], a[88:91], v[208:211], v[96:99]
  ds_read_b128 v[176:179], v18 offset:8192
  v_mfma_f32_16x16x32_bf16 v[100:103], a[92:95], v[208:211], v[100:103]
  v_mfma_f32_16x16x32_bf16 v[104:107], a[88:91], v[212:215], v[104:107]
  ds_read_b128 v[180:183], v18 offset:10240
  v_mfma_f32_16x16x32_bf16 v[108:111], a[92:95], v[212:215], v[108:111]
  buffer_load_dwordx4 v11, s[8:11], s30 offen offset:1024 lds
  v_mfma_f32_16x16x32_bf16 v[112:115], a[88:91], v[216:219], v[112:115]
  ds_read_b128 v[184:187], v18 offset:12288
  v_mfma_f32_16x16x32_bf16 v[116:119], a[92:95], v[216:219], v[116:119]
  v_mfma_f32_16x16x32_bf16 v[120:123], a[88:91], v[220:223], v[120:123]
  ds_read_b128 v[188:191], v18 offset:14336
  v_mfma_f32_16x16x32_bf16 v[124:127], a[92:95], v[220:223], v[124:127]
  s_waitcnt lgkmcnt(4)
  v_mfma_f32_16x16x32_bf16 v[64:67], a[96:99], v[160:163], v[64:67]
  ds_read_b128 v[192:195], v19 offset:0
  v_mfma_f32_16x16x32_bf16 v[68:71], a[100:103], v[160:163], v[68:71]
  v_add_u32 v18, s33, v14
  v_mfma_f32_16x16x32_bf16 v[72:75], a[96:99], v[164:167], v[72:75]
  ds_read_b128 v[196:199], v19 offset:2048
  v_mfma_f32_16x16x32_bf16 v[76:79], a[100:103], v[164:167], v[76:79]
  buffer_load_dwordx4 v12, s[8:11], s30 offen offset:2048 lds
  v_mfma_f32_16x16x32_bf16 v[80:83], a[96:99], v[168:171], v[80:83]
  ds_read_b128 v[200:203], v19 offset:4096
  v_mfma_f32_16x16x32_bf16 v[84:87], a[100:103], v[168:171], v[84:87]
  v_mfma_f32_16x16x32_bf16 v[88:91], a[96:99], v[172:175], v[88:91]
  ds_read_b128 v[204:207], v19 offset:6144
  v_mfma_f32_16x16x32_bf16 v[92:95], a[100:103], v[172:175], v[92:95]
  s_waitcnt lgkmcnt(4)
  v_mfma_f32_16x16x32_bf16 v[96:99], a[96:99], v[176:179], v[96:99]
  ds_read_b128 v[208:211], v19 offset:8192
  v_mfma_f32_16x16x32_bf16 v[100:103], a[100:103], v[176:179], v[100:103]
  v_mfma_f32_16x16x32_bf16 v[104:107], a[96:99], v[180:183], v[104:107]
  ds_read_b128 v[212:215], v19 offset:10240
  v_mfma_f32_16x16x32_bf16 v[108:111], a[100:103], v[180:183], v[108:111]
  buffer_load_dwordx4 v13, s[8:11], s30 offen offset:3072 lds
  v_mfma_f32_16x16x32_bf16 v[112:115], a[96:99], v[184:187], v[112:115]
  ds_read_b128 v[216:219], v19 offset:12288
  s_add_u32 s30, s30, 128
  v_mfma_f32_16x16x32_bf16 v[116:119], a[100:103], v[184:187], v[116:119]
  s_add_u32 m0, m0, 16384
  v_mfma_f32_16x16x32_bf16 v[120:123], a[96:99], v[188:191], v[120:123]
  ds_read_b128 v[220:223], v19 offset:14336
  v_mfma_f32_16x16x32_bf16 v[124:127], a[100:103], v[188:191], v[124:127]
  s_waitcnt vmcnt(16) lgkmcnt(4)
  s_barrier
  v_mfma_f32_16x16x32_bf16 v[64:67], a[104:107], v[192:195], v[64:67]
  ds_read_b128 v[160:163], v18 offset:0
  v_mfma_f32_16x16x32_bf16 v[68:71], a[108:111], v[192:195], v[68:71]
  s_cmp_lt_u32 m0, s46
  s_cselect_b32 m0, m0, s47
  v_mfma_f32_16x16x32_bf16 v[72:75], a[104:107], v[196:199], v[72:75]
  ds_read_b128 v[164:167], v18 offset:2048
  v_add_u32 v19, s33, v15
  v_mfma_f32_16x16x32_bf16 v[76:79], a[108:111], v[196:199], v[76:79]
  buffer_load_dwordx4 v10, s[8:11], s30 offen offset:0 lds
  v_mfma_f32_16x16x32_bf16 v[80:83], a[104:107], v[200:203], v[80:83]
  ds_read_b128 v[168:171], v18 offset:4096
  s_add_u32 s33, s33, 16384
  v_mfma_f32_16x16x32_bf16 v[84:87], a[108:111], v[200:203], v[84:87]
  s_cmp_lt_u32 s33, 114688
  s_cselect_b32 s33, s33, 0
  v_mfma_f32_16x16x32_bf16 v[88:91], a[104:107], v[204:207], v[88:91]
  ds_read_b128 v[172:175], v18 offset:6144
  v_mfma_f32_16x16x32_bf16 v[92:95], a[108:111], v[204:207], v[92:95]
  s_waitcnt lgkmcnt(4)
  v_mfma_f32_16x16x32_bf16 v[96:99], a[104:107], v[208:211], v[96:99]
  ds_read_b128 v[176:179], v18 offset:8192
  v_mfma_f32_16x16x32_bf16 v[100:103], a[108:111], v[208:211], v[100:103]
  v_mfma_f32_16x16x32_bf16 v[104:107], a[104:107], v[212:215], v[104:107]
  ds_read_b128 v[180:183], v18 offset:10240
  v_mfma_f32_16x16x32_bf16 v[108:111], a[108:111], v[212:215], v[108:111]
  buffer_load_dwordx4 v11, s[8:11], s30 offen offset:1024 lds
  v_mfma_f32_16x16x32_bf16 v[112:115], a[104:107], v[216:219], v[112:115]
  ds_read_b128 v[184:187], v18 offset:12288
  v_mfma_f32_16x16x32_bf16 v[116:119], a[108:111], v[216:219], v[116:119]
  v_mfma_f32_16x16x32_bf16 v[120:123], a[104:107], v[220:223], v[120:123]
  ds_read_b128 v[188:191], v18 offset:14336
  v_mfma_f32_16x16x32_bf16 v[124:127], a[108:111], v[220:223], v[124:127]
  s_waitcnt lgkmcnt(4)
  v_mfma_f32_16x16x32_bf16 v[64:67], a[112:115], v[160:163], v[64:67]
  ds_read_b128 v[192:195], v19 offset:0
  v_mfma_f32_16x16x32_bf16 v[68:71], a[116:119], v[160:163], v[68:71]
  v_add_u32 v18, s33, v14
  v_mfma_f32_16x16x32_bf16 v[72:75], a[112:115], v[164:167], v[72:75]
  ds_read_b128 v[196:199], v19 offset:2048
  v_mfma_f32_16x16x32_bf16 v[76:79], a[116:119], v[164:167], v[76:79]
  buffer_load_dwordx4 v12, s[8:11], s30 offen offset:2048 lds
  v_mfma_f32_16x16x32_bf16 v[80:83], a[112:115], v[168:171], v[80:83]
  ds_read_b128 v[200:203], v19 offset:4096
  v_mfma_f32_16x16x32_bf16 v[84:87], a[116:119], v[168:171], v[84:87]
  v_mfma_f32_16x16x32_bf16 v[88:91], a[112:115], v[172:175], v[88:91]
  ds_read_b128 v[204:207], v19 offset:6144
  v_mfma_f32_16x16x32_bf16 v[92:95], a[116:119], v[172:175], v[92:95]
  s_waitcnt lgkmcnt(4)
  v_mfma_f32_16x16x32_bf16 v[96:99], a[112:115], v[176:179], v[96:99]
  ds_read_b128 v[208:211], v19 offset:8192
  v_mfma_f32_16x16x32_bf16 v[100:103], a[116:119], v[176:179], v[100:103]
  v_mfma_f32_16x16x32_bf16 v[104:107], a[112:115], v[180:183], v[104:107]
  ds_read_b128 v[212:215], v19 offset:10240
  v_mfma_f32_16x16x32_bf16 v[108:111], a[116:119], v[180:183], v[108:111]
  buffer_load_dwordx4 v13, s[8:11], s30 offen offset:3072 lds
  v_mfma_f32_16x16x32_bf16 v[112:115], a[112:115], v[184:187], v[112:115]
  ds_read_b128 v[216:219], v19 offset:12288
  s_add_u32 s30, s30, 128
  v_mfma_f32_16x16x32_bf16 v[116:119], a[116:119], v[184:187], v[116:119]
  s_add_u32 m0, m0, 16384
  v_mfma_f32_16x16x32_bf16 v[120:123], a[112:115], v[188:191], v[120:123]
  ds_read_b128 v[220:223], v19 offset:14336
  v_mfma_f32_16x16x32_bf16 v[124:127], a[116:119], v[188:191], v[124:127]
  s_waitcnt vmcnt(16) lgkmcnt(4)
  s_barrier
  v_mfma_f32_16x16x32_bf16 v[64:67], a[120:123], v[192:195], v[64:67]
  ds_read_b128 v[160:163], v18 offset:0
  v_mfma_f32_16x16x32_bf16 v[68:71], a[124:127], v[192:195], v[68:71]
  s_cmp_lt_u32 m0, s46
  s_cselect_b32 m0, m0, s47
  v_mfma_f32_16x16x32_bf16 v[72:75], a[120:123], v[196:199], v[72:75]
  ds_read_b128 v[164:167], v18 offset:2048
  v_add_u32 v19, s33, v15
  v_mfma_f32_16x16x32_bf16 v[76:79], a[124:127], v[196:199], v[76:79]
  buffer_load_dwordx4 v10, s[8:11], s30 offen offset:0 lds
  v_mfma_f32_16x16x32_bf16 v[80:83], a[120:123], v[200:203], v[80:83]
  ds_read_b128 v[168:171], v18 offset:4096
  s_add_u32 s33, s33, 16384
  v_mfma_f32_16x16x32_bf16 v[84:87], a[124:127], v[200:203], v[84:87]
  s_cmp_lt_u32 s33, 114688
  s_cselect_b32 s33, s33, 0
  v_mfma_f32_16x16x32_bf16 v[88:91], a[120:123], v[204:207], v[88:91]
  ds_read_b128 v[172:175], v18 offset:6144
  v_mfma_f32_16x16x32_bf16 v[92:95], a[124:127], v[204:207], v[92:95]
  s_waitcnt lgkmcnt(4)
  v_mfma_f32_16x16x32_bf16 v[96:99], a[120:123], v[208:211], v[96:99]
  ds_read_b128 v[176:179], v18 offset:8192
  v_mfma_f32_16x16x32_bf16 v[100:103], a[124:127], v[208:211], v[100:103]
  v_mfma_f32_16x16x32_bf16 v[104:107], a[120:123], v[212:215], v[104:107]
  ds_read_b128 v[180:183], v18 offset:10240
  v_mfma_f32_16x16x32_bf16 v[108:111], a[124:127], v[212:215], v[108:111]
  buffer_load_dwordx4 v11, s[8:11], s30 offen offset:1024 lds
  v_mfma_f32_16x16x32_bf16 v[112:115], a[120:123], v[216:219], v[112:115]
  ds_read_b128 v[184:187], v18 offset:12288
  v_mfma_f32_16x16x32_bf16 v[116:119], a[124:127], v[216:219], v[116:119]
  v_mfma_f32_16x16x32_bf16 v[120:123], a[120:123], v[220:223], v[120:123]
  ds_read_b128 v[188:191], v18 offset:14336
  v_mfma_f32_16x16x32_bf16 v[124:127], a[124:127], v[220:223], v[124:127]
  s_waitcnt lgkmcnt(4)
  v_mfma_f32_16x16x32_bf16 v[64:67], a[128:131], v[160:163], v[64:67]
  ds_read_b128 v[192:195], v19 offset:0
  v_mfma_f32_16x16x32_bf16 v[68:71], a[132:135], v[160:163], v[68:71]
  v_add_u32 v18, s33, v14
  v_mfma_f32_16x16x32_bf16 v[72:75], a[128:131], v[164:167], v[72:75]
  ds_read_b128 v[196:199], v19 offset:2048
  v_mfma_f32_16x16x32_bf16 v[76:79], a[132:135], v[164:167], v[76:79]
  buffer_load_dwordx4 v12, s[8:11], s30 offen offset:2048 lds
  v_mfma_f32_16x16x32_bf16 v[80:83], a[128:131], v[168:171], v[80:83]
  ds_read_b128 v[200:203], v19 offset:4096
  v_mfma_f32_16x16x32_bf16 v[84:87], a[132:135], v[168:171], v[84:87]
  v_mfma_f32_16x16x32_bf16 v[88:91], a[128:131], v[172:175], v[88:91]
  ds_read_b128 v[204:207], v19 offset:6144
  v_mfma_f32_16x16x32_bf16 v[92:95], a[132:135], v[172:175], v[92:95]
  s_waitcnt lgkmcnt(4)
  v_mfma_f32_16x16x32_bf16 v[96:99], a[128:131], v[176:179], v[96:99]
  ds_read_b128 v[208:211], v19 offset:8192
  v_mfma_f32_16x16x32_bf16 v[100:103], a[132:135], v[176:179], v[100:103]
  v_mfma_f32_16x16x32_bf16 v[104:107], a[128:131], v[180:183], v[104:107]
  ds_read_b128 v[212:215], v19 offset:10240
  v_mfma_f32_16x16x32_bf16 v[108:111], a[132:135], v[180:183], v[108:111]
  buffer_load_dwordx4 v13, s[8:11], s30 offen offset:3072 lds
  v_mfma_f32_16x16x32_bf16 v[112:115], a[128:131], v[184:187], v[112:115]
  ds_read_b128 v[216:219], v19 offset:12288
  s_add_u32 s30, s30, 128
  v_mfma_f32_16x16x32_bf16 v[116:119], a[132:135], v[184:187], v[116:119]
  s_add_u32 m0, m0, 16384
  v_mfma_f32_16x16x32_bf16 v[120:123], a[128:131], v[188:191], v[120:123]
  ds_read_b128 v[220:223], v19 offset:14336
  v_mfma_f32_16x16x32_bf16 v[124:127], a[132:135], v[188:191], v[124:127]
  s_waitcnt vmcnt(16) lgkmcnt(4)
  s_barrier
  v_mfma_f32_16x16x32_bf16 v[64:67], a[136:139], v[192:195], v[64:67]
  ds_read_b128 v[160:163], v18 offset:0
  v_mfma_f32_16x16x32_bf16 v[68:71], a[140:143], v[192:195], v[68:71]
  s_cmp_lt_u32 m0, s46
  s_cselect_b32 m0, m0, s47
  v_mfma_f32_16x16x32_bf16 v[72:75], a[136:139], v[196:199], v[72:75]
  ds_read_b128 v[164:167], v18 offset:2048
  v_add_u32 v19, s33, v15
  v_mfma_f32_16x16x32_bf16 v[76:79], a[140:143], v[196:199], v[76:79]
  buffer_load_dwordx4 v10, s[8:11], s30 offen offset:0 lds
  v_mfma_f32_16x16x32_bf16 v[80:83], a[136:139], v[200:203], v[80:83]
  ds_read_b128 v[168:171], v18 offset:4096
  s_add_u32 s33, s33, 16384
  v_mfma_f32_16x16x32_bf16 v[84:87], a[140:143], v[200:203], v[84:87]
  s_cmp_lt_u32 s33, 114688
  s_cselect_b32 s33, s33, 0
  v_mfma_f32_16x16x32_bf16 v[88:91], a[136:139], v[204:207], v[88:91]
  ds_read_b128 v[172:175], v18 offset:6144
  v_mfma_f32_16x16x32_bf16 v[92:95], a[140:143], v[204:207], v[92:95]
  s_waitcnt lgkmcnt(4)
  v_mfma_f32_16x16x32_bf16 v[96:99], a[136:139], v[208:211], v[96:99]
  ds_read_b128 v[176:179], v18 offset:8192
  v_mfma_f32_16x16x32_bf16 v[100:103], a[140:143], v[208:211], v[100:103]
  v_mfma_f32_16x16x32_bf16 v[104:107], a[136:139], v[212:215], v[104:107]
  ds_read_b128 v[180:183], v18 offset:10240
  v_mfma_f32_16x16x32_bf16 v[108:111], a[140:143], v[212:215], v[108:111]
  buffer_load_dwordx4 v11, s[8:11], s30 offen offset:1024 lds
  v_mfma_f32_16x16x32_bf16 v[112:115], a[136:139], v[216:219], v[112:115]
  ds_read_b128 v[184:187], v18 offset:12288
  v_mfma_f32_16x16x32_bf16 v[116:119], a[140:143], v[216:219], v[116:119]
  v_mfma_f32_16x16x32_bf16 v[120:123], a[136:139], v[220:223], v[120:123]
  ds_read_b128 v[188:191], v18 offset:14336
  v_mfma_f32_16x16x32_bf16 v[124:127], a[140:143], v[220:223], v[124:127]
  s_waitcnt lgkmcnt(4)
  v_mfma_f32_16x16x32_bf16 v[64:67], a[144:147], v[160:163], v[64:67]
  ds_read_b128 v[192:195], v19 offset:0
  v_mfma_f32_16x16x32_bf16 v[68:71], a[148:151], v[160:163], v[68:71]
  v_add_u32 v18, s33, v14
  v_mfma_f32_16x16x32_bf16 v[72:75], a[144:147], v[164:167], v[72:75]
  ds_read_b128 v[196:199], v19 offset:2048
  v_mfma_f32_16x16x32_bf16 v[76:79], a[148:151], v[164:167], v[76:79]
  buffer_load_dwordx4 v12, s[8:11], s30 offen offset:2048 lds
  v_mfma_f32_16x16x32_bf16 v[80:83], a[144:147], v[168:171], v[80:83]
  ds_read_b128 v[200:203], v19 offset:4096
  v_mfma_f32_16x16x32_bf16 v[84:87], a[148:151], v[168:171], v[84:87]
  v_mfma_f32_16x16x32_bf16 v[88:91], a[144:147], v[172:175], v[88:91]
  ds_read_b128 v[204:207], v19 offset:6144
  v_mfma_f32_16x16x32_bf16 v[92:95], a[148:151], v[172:175], v[92:95]
  s_waitcnt lgkmcnt(4)
  v_mfma_f32_16x16x32_bf16 v[96:99], a[144:147], v[176:179], v[96:99]
  ds_read_b128 v[208:211], v19 offset:8192
  v_mfma_f32_16x16x32_bf16 v[100:103], a[148:151], v[176:179], v[100:103]
  v_mfma_f32_16x16x32_bf16 v[104:107], a[144:147], v[180:183], v[104:107]
  ds_read_b128 v[212:215], v19 offset:10240
  v_mfma_f32_16x16x32_bf16 v[108:111], a[148:151], v[180:183], v[108:111]
  buffer_load_dwordx4 v13, s[8:11], s30 offen offset:3072 lds
  v_mfma_f32_16x16x32_bf16 v[112:115], a[144:147], v[184:187], v[112:115]
  ds_read_b128 v[216:219], v19 offset:12288
  s_add_u32 s30, s30, 128
  v_mfma_f32_16x16x32_bf16 v[116:119], a[148:151], v[184:187], v[116:119]
  s_add_u32 m0, m0, 16384
  v_mfma_f32_16x16x32_bf16 v[120:123], a[144:147], v[188:191], v[120:123]
  ds_read_b128 v[220:223], v19 offset:14336
  v_mfma_f32_16x16x32_bf16 v[124:127], a[148:151], v[188:191], v[124:127]
  s_waitcnt vmcnt(16) lgkmcnt(4)
  s_barrier
  v_mfma_f32_16x16x32_bf16 v[64:67], a[152:155], v[192:195], v[64:67]
  ds_read_b128 v[160:163], v18 offset:0
  v_mfma_f32_16x16x32_bf16 v[68:71], a[156:159], v[192:195], v[68:71]
  s_cmp_lt_u32 m0, s46
  s_cselect_b32 m0, m0, s47
  v_mfma_f32_16x16x32_bf16 v[72:75], a[152:155], v[196:199], v[72:75]
  ds_read_b128 v[164:167], v18 offset:2048
  v_add_u32 v19, s33, v15
  v_mfma_f32_16x16x32_bf16 v[76:79], a[156:159], v[196:199], v[76:79]
  buffer_load_dwordx4 v10, s[8:11], s30 offen offset:0 lds
  v_cvt_pk_bf16_f32 v224, v64, v65
  v_cvt_pk_bf16_f32 v225, v66, v67
  v_mfma_f32_16x16x32_bf16 v[80:83], a[152:155], v[200:203], v[80:83]
  ds_read_b128 v[168:171], v18 offset:4096
  s_add_u32 s33, s33, 16384
  v_cvt_pk_bf16_f32 v226, v68, v69
  v_cvt_pk_bf16_f32 v227, v70, v71
  v_mfma_f32_16x16x32_bf16 v[84:87], a[156:159], v[200:203], v[84:87]
  s_cmp_lt_u32 s33, 114688
  s_cselect_b32 s33, s33, 0
  ds_write_b64 v22, v[224:225] offset:0
  v_mfma_f32_16x16x32_bf16 v[88:91], a[152:155], v[204:207], v[88:91]
  ds_read_b128 v[172:175], v18 offset:6144
  ds_write_b64 v22, v[226:227] offset:32
  v_cvt_pk_bf16_f32 v230, v72, v73
  v_mfma_f32_16x16x32_bf16 v[92:95], a[156:159], v[204:207], v[92:95]
  s_waitcnt lgkmcnt(6)
  v_cvt_pk_bf16_f32 v231, v74, v75
  v_cvt_pk_bf16_f32 v232, v76, v77
  v_cvt_pk_bf16_f32 v233, v78, v79
  v_mfma_f32_16x16x32_bf16 v[96:99], a[152:155], v[208:211], v[96:99]
  ds_read_b128 v[176:179], v18 offset:8192
  ds_write_b64 v22, v[230:231] offset:4224
  v_mfma_f32_16x16x32_bf16 v[100:103], a[156:159], v[208:211], v[100:103]
  ds_write_b64 v22, v[232:233] offset:4256
  v_cvt_pk_bf16_f32 v224, v80, v81
  v_cvt_pk_bf16_f32 v225, v82, v83
  v_mfma_f32_16x16x32_bf16 v[104:107], a[152:155], v[212:215], v[104:107]
  ds_read_b128 v[180:183], v18 offset:10240
  v_cvt_pk_bf16_f32 v226, v84, v85
  v_cvt_pk_bf16_f32 v227, v86, v87
  v_mfma_f32_16x16x32_bf16 v[108:111], a[156:159], v[212:215], v[108:111]
  buffer_load_dwordx4 v11, s[8:11], s30 offen offset:1024 lds
  ds_write_b64 v22, v[224:225] offset:8448
  v_mfma_f32_16x16x32_bf16 v[112:115], a[152:155], v[216:219], v[112:115]
  ds_read_b128 v[184:187], v18 offset:12288
  ds_write_b64 v22, v[226:227] offset:8480
  v_cvt_pk_bf16_f32 v230, v88, v89
  v_mfma_f32_16x16x32_bf16 v[116:119], a[156:159], v[216:219], v[116:119]
  v_cvt_pk_bf16_f32 v231, v90, v91
  v_cvt_pk_bf16_f32 v232, v92, v93
  v_cvt_pk_bf16_f32 v233, v94, v95
  v_mfma_f32_16x16x32_bf16 v[120:123], a[152:155], v[220:223], v[120:123]
  ds_read_b128 v[188:191], v18 offset:14336
  ds_write_b64 v22, v[230:231] offset:12672
  v_mfma_f32_16x16x32_bf16 v[124:127], a[156:159], v[220:223], v[124:127]
  ds_write_b64 v22, v[232:233] offset:12704
  v_cvt_pk_bf16_f32 v224, v96, v97
  v_cvt_pk_bf16_f32 v225, v98, v99
bf_end_207:
  v_cvt_pk_bf16_f32 v226, v100, v101
  v_cvt_pk_bf16_f32 v227, v102, v103
  ds_write_b64 v22, v[224:225] offset:16896
  ds_write_b64 v22, v[226:227] offset:16928
  v_cvt_pk_bf16_f32 v230, v104, v105
  v_cvt_pk_bf16_f32 v231, v106, v107
  v_cvt_pk_bf16_f32 v232, v108, v109
  v_cvt_pk_bf16_f32 v233, v110, v111
  ds_write_b64 v22, v[230:231] offset:21120
  ds_write_b64 v22, v[232:233] offset:21152
  v_cvt_pk_bf16_f32 v224, v112, v113
  v_cvt_pk_bf16_f32 v225, v114, v115
  v_cvt_pk_bf16_f32 v226, v116, v117
  v_cvt_pk_bf16_f32 v227, v118, v119
  ds_write_b64 v22, v[224:225] offset:25344
  ds_write_b64 v22, v[226:227] offset:25376
  v_cvt_pk_bf16_f32 v230, v120, v121
  v_cvt_pk_bf16_f32 v231, v122, v123
  v_cvt_pk_bf16_f32 v232, v124, v125
  v_cvt_pk_bf16_f32 v233, v126, v127
  ds_write_b64 v22, v[230:231] offset:29568
  ds_write_b64 v22, v[232:233] offset:29600
  s_waitcnt lgkmcnt(0)
  s_barrier
  ds_read_b64 v[144:145], v34 offset:1848
  ds_read_b64 v[146:147], v34 offset:1856
  ds_read_b64 v[148:149], v34 offset:1864
  ds_read_b64 v[150:151], v34 offset:1872
  ds_read_b64 v[152:153], v34 offset:1880
  ds_read_b64 v[64:65], v34 offset:1928
  ds_read_b64 v[66:67], v34 offset:1936
  ds_read_b64 v[68:69], v34 offset:1944
  ds_read_b64 v[70:71], v34 offset:1952
  ds_read_b64 v[72:73], v34 offset:1960
  ds_read_b64 v[74:75], v34 offset:1664
  ds_read_b64 v[76:77], v34 offset:1672
  ds_read_b64 v[78:79], v34 offset:1680
  ds_read_b64 v[80:81], v34 offset:1688
  ds_read_b64 v[82:83], v34 offset:1696
  ds_read_b64 v[84:85], v34 offset:1400
  ds_read_b64 v[86:87], v34 offset:1408
  ds_read_b64 v[88:89], v34 offset:1416
  ds_read_b64 v[90:91], v34 offset:1424
  ds_read_b64 v[92:93], v34 offset:1432
  ds_read_b64 v[94:95], v34 offset:1136
  ds_read_b64 v[96:97], v34 offset:1144
  ds_read_b64 v[98:99], v34 offset:1152
  ds_read_b64 v[100:101], v34 offset:1160
  ds_read_b64 v[102:103], v34 offset:1168
  ds_read_b64 v[104:105], v34 offset:872
  ds_read_b64 v[106:107], v34 offset:880
  ds_read_b64 v[108:109], v34 offset:888
  ds_read_b64 v[110:111], v34 offset:896
  ds_read_b64 v[112:113], v34 offset:904
  v_mov_b32 v224, 0
  v_mov_b32 v225, 0
  ds_read_b64 v[114:115], v34 offset:608
  ds_read_b64 v[116:117], v34 offset:616
  ds_read_b64 v[118:119], v34 offset:624
  ds_read_b64 v[120:121], v34 offset:632
  ds_read_b64 v[122:123], v34 offset:640
  v_mov_b32 v226, 0
  v_mov_b32 v227, 0
  ds_read_b64 v[124:125], v34 offset:344
  ds_read_b64 v[126:127], v34 offset:352
  ds_read_b64 v[128:129], v34 offset:360
  ds_read_b64 v[130:131], v34 offset:368
  ds_read_b64 v[132:133], v34 offset:376
  v_mov_b32 v228, 0
  v_mov_b32 v229, 0
  ds_read_b64 v[134:135], v34 offset:80
  ds_read_b64 v[136:137], v34 offset:88
  ds_read_b64 v[138:139], v34 offset:96
  ds_read_b64 v[140:141], v34 offset:104
  ds_read_b64 v[142:143], v34 offset:112
  v_mov_b32 v230, 0
  v_mov_b32 v231, 0
  v_mov_b32 v192, 0
  v_mov_b32 v193, 0
  v_mov_b32 v194, 0
  v_mov_b32 v195, 0
  v_mov_b32 v196, 0
  v_mov_b32 v197, 0
  v_mov_b32 v198, 0
  v_mov_b32 v199, 0
  v_mov_b32 v200, 0
  v_mov_b32 v201, 0
  v_mov_b32 v202, 0
  v_mov_b32 v203, 0
  v_mov_b32 v204, 0
  v_mov_b32 v205, 0
  v_mov_b32 v206, 0
  v_mov_b32 v207, 0
  v_mov_b32 v208, 0
  v_mov_b32 v209, 0
  v_mov_b32 v210, 0
  v_mov_b32 v211, 0
  s_waitcnt lgkmcnt(15)
  v_dot2c_f32_bf16 v224, v64, v144
  v_dot2c_f32_bf16 v225, v74, v144
  v_dot2c_f32_bf16 v226, v84, v144
  v_dot2c_f32_bf16 v227, v94, v144
  v_dot2c_f32_bf16 v228, v104, v144
  v_dot2c_f32_bf16 v224, v65, v145
  v_dot2c_f32_bf16 v225, v75, v145
  v_dot2c_f32_bf16 v226, v85, v145
  v_dot2c_f32_bf16 v227, v95, v145
  v_dot2c_f32_bf16 v228, v105, v145
  v_dot2c_f32_bf16 v224, v66, v146
  v_dot2c_f32_bf16 v225, v76, v146
  v_dot2c_f32_bf16 v226, v86, v146
  v_dot2c_f32_bf16 v227, v96, v146
  v_dot2c_f32_bf16 v228, v106, v146
  v_dot2c_f32_bf16 v224, v67, v147
  v_dot2c_f32_bf16 v225, v77, v147
  v_dot2c_f32_bf16 v226, v87, v147
  v_dot2c_f32_bf16 v227, v97, v147
  v_dot2c_f32_bf16 v228, v107, v147
  v_dot2c_f32_bf16 v224, v68, v148
  v_dot2c_f32_bf16 v225, v78, v148
  v_dot2c_f32_bf16 v226, v88, v148
  v_dot2c_f32_bf16 v227, v98, v148
  v_dot2c_f32_bf16 v228, v108, v148
  v_dot2c_f32_bf16 v224, v69, v149
  v_dot2c_f32_bf16 v225, v79, v149
  v_dot2c_f32_bf16 v226, v89, v149
  v_dot2c_f32_bf16 v227, v99, v149
  v_dot2c_f32_bf16 v228, v109, v149
  v_dot2c_f32_bf16 v224, v70, v150
  v_dot2c_f32_bf16 v225, v80, v150
  v_dot2c_f32_bf16 v226, v90, v150
  v_dot2c_f32_bf16 v227, v100, v150
  v_dot2c_f32_bf16 v228, v110, v150
  v_dot2c_f32_bf16 v224, v71, v151
  v_dot2c_f32_bf16 v225, v81, v151
  v_dot2c_f32_bf16 v226, v91, v151
  v_dot2c_f32_bf16 v227, v101, v151
  v_dot2c_f32_bf16 v228, v111, v151
  v_dot2c_f32_bf16 v224, v72, v152
  v_dot2c_f32_bf16 v225, v82, v152
  v_dot2c_f32_bf16 v226, v92, v152
  v_dot2c_f32_bf16 v227, v102, v152
  v_dot2c_f32_bf16 v228, v112, v152
  v_dot2c_f32_bf16 v224, v73, v153
  v_dot2c_f32_bf16 v225, v83, v153
  v_dot2c_f32_bf16 v226, v93, v153
  v_dot2c_f32_bf16 v227, v103, v153
  v_dot2c_f32_bf16 v228, v113, v153
  s_waitcnt lgkmcnt(0)
  v_dot2c_f32_bf16 v229, v114, v144
  v_dot2c_f32_bf16 v230, v124, v144
  v_dot2c_f32_bf16 v231, v134, v144
  v_dot2c_f32_bf16 v229, v115, v145
  v_dot2c_f32_bf16 v230, v125, v145
  v_dot2c_f32_bf16 v231, v135, v145
  v_dot2c_f32_bf16 v229, v116, v146
  v_dot2c_f32_bf16 v230, v126, v146
  v_dot2c_f32_bf16 v231, v136, v146
  v_dot2c_f32_bf16 v229, v117, v147
  v_dot2c_f32_bf16 v230, v127, v147
  v_dot2c_f32_bf16 v231, v137, v147
  v_dot2c_f32_bf16 v229, v118, v148
  v_dot2c_f32_bf16 v230, v128, v148
  v_dot2c_f32_bf16 v231, v138, v148
  v_dot2c_f32_bf16 v229, v119, v149
  v_dot2c_f32_bf16 v230, v129, v149
  v_dot2c_f32_bf16 v231, v139, v149
  v_dot2c_f32_bf16 v229, v120, v150
  v_dot2c_f32_bf16 v230, v130, v150
  v_dot2c_f32_bf16 v231, v140, v150
  v_dot2c_f32_bf16 v229, v121, v151
  v_dot2c_f32_bf16 v230, v131, v151
  v_dot2c_f32_bf16 v231, v141, v151
  v_dot2c_f32_bf16 v229, v122, v152
  v_dot2c_f32_bf16 v230, v132, v152
  v_dot2c_f32_bf16 v231, v142, v152
  v_dot2c_f32_bf16 v229, v123, v153
  v_dot2c_f32_bf16 v230, v133, v153
  v_dot2c_f32_bf16 v231, v143, v153
  ds_read_b64 v[64:65], v38 offset:2008
  ds_read_b64 v[66:67], v38 offset:2016
  ds_read_b64 v[68:69], v38 offset:2024
  ds_read_b64 v[70:71], v38 offset:2032
  ds_read_b64 v[72:73], v39 offset:2040
  ds_read_b64 v[74:75], v38 offset:1744
  ds_read_b64 v[76:77], v38 offset:1752
  ds_read_b64 v[78:79], v38 offset:1760
  ds_read_b64 v[80:81], v38 offset:1768
  ds_read_b64 v[82:83], v39 offset:1776
  ds_read_b64 v[84:85], v38 offset:1480
  ds_read_b64 v[86:87], v38 offset:1488
  ds_read_b64 v[88:89], v38 offset:1496
  ds_read_b64 v[90:91], v38 offset:1504
  ds_read_b64 v[92:93], v39 offset:1512
  ds_read_b64 v[94:95], v38 offset:1216
  ds_read_b64 v[96:97], v38 offset:1224
  ds_read_b64 v[98:99], v38 offset:1232
  ds_read_b64 v[100:101], v38 offset:1240
  ds_read_b64 v[102:103], v39 offset:1248
  ds_read_b64 v[104:105], v38 offset:952
  ds_read_b64 v[106:107], v38 offset:960
  ds_read_b64 v[108:109], v38 offset:968
  ds_read_b64 v[110:111], v38 offset:976
  ds_read_b64 v[112:113], v39 offset:984
  ds_read_b64 v[114:115], v38 offset:688
  ds_read_b64 v[116:117], v38 offset:696
  ds_read_b64 v[118:119], v38 offset:704
  ds_read_b64 v[120:121], v38 offset:712
  ds_read_b64 v[122:123], v39 offset:720
  ds_read_b64 v[124:125], v38 offset:424
  ds_read_b64 v[126:127], v38 offset:432
  ds_read_b64 v[128:129], v38 offset:440
  ds_read_b64 v[130:131], v38 offset:448
  ds_read_b64 v[132:133], v39 offset:456
  ds_read_b64 v[134:135], v38 offset:160
  ds_read_b64 v[136:137], v38 offset:168
  ds_read_b64 v[138:139], v38 offset:176
  ds_read_b64 v[140:141], v38 offset:184
  ds_read_b64 v[142:143], v39 offset:192
  v_cvt_pk_bf16_f32 v4, v224, v225
  v_lshlrev_b32 v224, 16, v4
  v_and_b32 v225, 0xffff0000, v4
  v_mul_f32 v224, s60, v224
  v_mul_f32 v225, s60, v225
  v_cvt_pk_bf16_f32 v4, v224, v225
  v_lshlrev_b32 v224, 16, v4
  v_and_b32 v225, 0xffff0000, v4
  v_cndmask_b32 v224, v37, v224, s[76:77]
  v_cndmask_b32 v225, v37, v225, s[78:79]
  v_cvt_pk_bf16_f32 v4, v226, v227
  v_lshlrev_b32 v226, 16, v4
  v_and_b32 v227, 0xffff0000, v4
  v_mul_f32 v226, s60, v226
  v_mul_f32 v227, s60, v227
  v_cvt_pk_bf16_f32 v4, v226, v227
  v_lshlrev_b32 v226, 16, v4
  v_and_b32 v227, 0xffff0000, v4
  v_cndmask_b32 v226, v37, v226, s[80:81]
  v_cndmask_b32 v227, v37, v227, s[82:83]
  v_cvt_pk_bf16_f32 v4, v228, v229
  v_lshlrev_b32 v228, 16, v4
  v_and_b32 v229, 0xffff0000, v4
  v_mul_f32 v228, s60, v228
  v_mul_f32 v229, s60, v229
  v_cvt_pk_bf16_f32 v4, v228, v229
  v_lshlrev_b32 v228, 16, v4
  v_and_b32 v229, 0xffff0000, v4
  v_cndmask_b32 v228, v37, v228, s[84:85]
  v_cndmask_b32 v229, v37, v229, s[86:87]
  v_cvt_pk_bf16_f32 v4, v230, v231
  v_lshlrev_b32 v230, 16, v4
  v_and_b32 v231, 0xffff0000, v4
  v_mul_f32 v230, s60, v230
  v_mul_f32 v231, s60, v231
  v_cvt_pk_bf16_f32 v4, v230, v231
  v_lshlrev_b32 v230, 16, v4
  v_and_b32 v231, 0xffff0000, v4
  v_cndmask_b32 v230, v37, v230, s[88:89]
  v_cndmask_b32 v231, v37, v231, s[90:91]
  v_max3_f32 v5, v224, v225, v226
  v_max3_f32 v5, v5, v227, v228
  v_max3_f32 v5, v5, v229, v230
  v_max_f32 v5, v5, v231
  v_sub_f32 v224, v224, v5
  v_mul_f32 v224, s61, v224
  v_exp_f32 v224, v224
  v_sub_f32 v225, v225, v5
  v_mul_f32 v225, s61, v225
  v_exp_f32 v225, v225
  v_sub_f32 v226, v226, v5
  v_mul_f32 v226, s61, v226
  v_exp_f32 v226, v226
  v_sub_f32 v227, v227, v5
  v_mul_f32 v227, s61, v227
  v_exp_f32 v227, v227
  v_sub_f32 v228, v228, v5
  v_mul_f32 v228, s61, v228
  v_exp_f32 v228, v228
  v_sub_f32 v229, v229, v5
  v_mul_f32 v229, s61, v229
  v_exp_f32 v229, v229
  v_sub_f32 v230, v230, v5
  v_mul_f32 v230, s61, v230
  v_exp_f32 v230, v230
  v_sub_f32 v231, v231, v5
  v_mul_f32 v231, s61, v231
  v_exp_f32 v231, v231
  s_nop 0
  v_add_f32 v5, v224, v225
  v_add_f32 v5, v5, v226
  v_add_f32 v5, v5, v227
  v_add_f32 v5, v5, v228
  v_add_f32 v5, v5, v229
  v_add_f32 v5, v5, v230
  v_add_f32 v5, v5, v231
  v_rcp_f32 v5, v5
  s_nop 0
  v_mul_f32 v224, v224, v5
  v_mul_f32 v225, v225, v5
  v_mul_f32 v226, v226, v5
  v_mul_f32 v227, v227, v5
  v_mul_f32 v228, v228, v5
  v_mul_f32 v229, v229, v5
  v_mul_f32 v230, v230, v5
  v_mul_f32 v231, v231, v5
  v_cvt_pk_bf16_f32 v232, v224, v225
  v_cvt_pk_bf16_f32 v233, v226, v227
  v_cvt_pk_bf16_f32 v234, v228, v229
  v_cvt_pk_bf16_f32 v235, v230, v231
  s_waitcnt lgkmcnt(15)
  v_perm_b32 v236, v74, v64, s62
  v_perm_b32 v237, v74, v64, s63
  v_dot2c_f32_bf16 v192, v236, v232
  v_dot2c_f32_bf16 v193, v237, v232
  v_perm_b32 v238, v75, v65, s62
  v_perm_b32 v239, v75, v65, s63
  v_dot2c_f32_bf16 v194, v238, v232
  v_dot2c_f32_bf16 v195, v239, v232
  v_perm_b32 v240, v76, v66, s62
  v_perm_b32 v241, v76, v66, s63
  v_dot2c_f32_bf16 v196, v240, v232
  v_dot2c_f32_bf16 v197, v241, v232
  v_perm_b32 v242, v77, v67, s62
  v_perm_b32 v243, v77, v67, s63
  v_dot2c_f32_bf16 v198, v242, v232
  v_dot2c_f32_bf16 v199, v243, v232
  v_perm_b32 v236, v78, v68, s62
  v_perm_b32 v237, v78, v68, s63
  v_dot2c_f32_bf16 v200, v236, v232
  v_dot2c_f32_bf16 v201, v237, v232
  v_perm_b32 v238, v79, v69, s62
  v_perm_b32 v239, v79, v69, s63
  v_dot2c_f32_bf16 v202, v238, v232
  v_dot2c_f32_bf16 v203, v239, v232
  v_perm_b32 v240, v80, v70, s62
  v_perm_b32 v241, v80, v70, s63
  v_dot2c_f32_bf16 v204, v240, v232
  v_dot2c_f32_bf16 v205, v241, v232
  v_perm_b32 v242, v81, v71, s62
  v_perm_b32 v243, v81, v71, s63
  v_dot2c_f32_bf16 v206, v242, v232
  v_dot2c_f32_bf16 v207, v243, v232
  v_perm_b32 v236, v82, v72, s62
  v_perm_b32 v237, v82, v72, s63
  v_dot2c_f32_bf16 v208, v236, v232
  v_dot2c_f32_bf16 v209, v237, v232
  v_perm_b32 v238, v83, v73, s62
  v_perm_b32 v239, v83, v73, s63
  v_dot2c_f32_bf16 v210, v238, v232
  v_dot2c_f32_bf16 v211, v239, v232
  s_waitcnt lgkmcnt(15)
  v_perm_b32 v236, v94, v84, s62
  v_perm_b32 v237, v94, v84, s63
  v_dot2c_f32_bf16 v192, v236, v233
  v_dot2c_f32_bf16 v193, v237, v233
  v_perm_b32 v238, v95, v85, s62
  v_perm_b32 v239, v95, v85, s63
  v_dot2c_f32_bf16 v194, v238, v233
  v_dot2c_f32_bf16 v195, v239, v233
  v_perm_b32 v240, v96, v86, s62
  v_perm_b32 v241, v96, v86, s63
  v_dot2c_f32_bf16 v196, v240, v233
  v_dot2c_f32_bf16 v197, v241, v233
  v_perm_b32 v242, v97, v87, s62
  v_perm_b32 v243, v97, v87, s63
  v_dot2c_f32_bf16 v198, v242, v233
  v_dot2c_f32_bf16 v199, v243, v233
  v_perm_b32 v236, v98, v88, s62
  v_perm_b32 v237, v98, v88, s63
  v_dot2c_f32_bf16 v200, v236, v233
  v_dot2c_f32_bf16 v201, v237, v233
  v_perm_b32 v238, v99, v89, s62
  v_perm_b32 v239, v99, v89, s63
  v_dot2c_f32_bf16 v202, v238, v233
  v_dot2c_f32_bf16 v203, v239, v233
  v_perm_b32 v240, v100, v90, s62
  v_perm_b32 v241, v100, v90, s63
  v_dot2c_f32_bf16 v204, v240, v233
  v_dot2c_f32_bf16 v205, v241, v233
  v_perm_b32 v242, v101, v91, s62
  v_perm_b32 v243, v101, v91, s63
  v_dot2c_f32_bf16 v206, v242, v233
  v_dot2c_f32_bf16 v207, v243, v233
  v_perm_b32 v236, v102, v92, s62
  v_perm_b32 v237, v102, v92, s63
  v_dot2c_f32_bf16 v208, v236, v233
  v_dot2c_f32_bf16 v209, v237, v233
  v_perm_b32 v238, v103, v93, s62
  v_perm_b32 v239, v103, v93, s63
  v_dot2c_f32_bf16 v210, v238, v233
  v_dot2c_f32_bf16 v211, v239, v233
  s_waitcnt lgkmcnt(10)
  v_perm_b32 v236, v114, v104, s62
  v_perm_b32 v237, v114, v104, s63
  v_dot2c_f32_bf16 v192, v236, v234
  v_dot2c_f32_bf16 v193, v237, v234
  v_perm_b32 v238, v115, v105, s62
  v_perm_b32 v239, v115, v105, s63
  v_dot2c_f32_bf16 v194, v238, v234
  v_dot2c_f32_bf16 v195, v239, v234
  v_perm_b32 v240, v116, v106, s62
  v_perm_b32 v241, v116, v106, s63
  v_dot2c_f32_bf16 v196, v240, v234
  v_dot2c_f32_bf16 v197, v241, v234
  v_perm_b32 v242, v117, v107, s62
  v_perm_b32 v243, v117, v107, s63
  v_dot2c_f32_bf16 v198, v242, v234
  v_dot2c_f32_bf16 v199, v243, v234
  v_perm_b32 v236, v118, v108, s62
  v_perm_b32 v237, v118, v108, s63
  v_dot2c_f32_bf16 v200, v236, v234
  v_dot2c_f32_bf16 v201, v237, v234
  v_perm_b32 v238, v119, v109, s62
  v_perm_b32 v239, v119, v109, s63
  v_dot2c_f32_bf16 v202, v238, v234
  v_dot2c_f32_bf16 v203, v239, v234
  v_perm_b32 v240, v120, v110, s62
  v_perm_b32 v241, v120, v110, s63
  v_dot2c_f32_bf16 v204, v240, v234
  v_dot2c_f32_bf16 v205, v241, v234
  v_perm_b32 v242, v121, v111, s62
  v_perm_b32 v243, v121, v111, s63
  v_dot2c_f32_bf16 v206, v242, v234
  v_dot2c_f32_bf16 v207, v243, v234
  v_perm_b32 v236, v122, v112, s62
  v_perm_b32 v237, v122, v112, s63
  v_dot2c_f32_bf16 v208, v236, v234
  v_dot2c_f32_bf16 v209, v237, v234
  v_perm_b32 v238, v123, v113, s62
  v_perm_b32 v239, v123, v113, s63
  v_dot2c_f32_bf16 v210, v238, v234
  v_dot2c_f32_bf16 v211, v239, v234
  s_waitcnt lgkmcnt(0)
  v_perm_b32 v236, v134, v124, s62
  v_perm_b32 v237, v134, v124, s63
  v_dot2c_f32_bf16 v192, v236, v235
  v_dot2c_f32_bf16 v193, v237, v235
  v_perm_b32 v238, v135, v125, s62
  v_perm_b32 v239, v135, v125, s63
  v_dot2c_f32_bf16 v194, v238, v235
  v_dot2c_f32_bf16 v195, v239, v235
  v_perm_b32 v240, v136, v126, s62
  v_perm_b32 v241, v136, v126, s63
  v_dot2c_f32_bf16 v196, v240, v235
  v_dot2c_f32_bf16 v197, v241, v235
  v_perm_b32 v242, v137, v127, s62
  v_perm_b32 v243, v137, v127, s63
  v_dot2c_f32_bf16 v198, v242, v235
  v_dot2c_f32_bf16 v199, v243, v235
  v_perm_b32 v236, v138, v128, s62
  v_perm_b32 v237, v138, v128, s63
  v_dot2c_f32_bf16 v200, v236, v235
  v_dot2c_f32_bf16 v201, v237, v235
  v_perm_b32 v238, v139, v129, s62
  v_perm_b32 v239, v139, v129, s63
  v_dot2c_f32_bf16 v202, v238, v235
  v_dot2c_f32_bf16 v203, v239, v235
  v_perm_b32 v240, v140, v130, s62
  v_perm_b32 v241, v140, v130, s63
  v_dot2c_f32_bf16 v204, v240, v235
  v_dot2c_f32_bf16 v205, v241, v235
  v_perm_b32 v242, v141, v131, s62
  v_perm_b32 v243, v141, v131, s63
  v_dot2c_f32_bf16 v206, v242, v235
  v_dot2c_f32_bf16 v207, v243, v235
  v_perm_b32 v236, v142, v132, s62
  v_perm_b32 v237, v142, v132, s63
  v_dot2c_f32_bf16 v208, v236, v235
  v_dot2c_f32_bf16 v209, v237, v235
  v_perm_b32 v238, v143, v133, s62
  v_perm_b32 v239, v143, v133, s63
  v_dot2c_f32_bf16 v210, v238, v235
  v_dot2c_f32_bf16 v211, v239, v235
  s_cmp_lg_u32 s20, 0
  s_cbranch_scc1 bh_208
  ds_read_b64 v[64:65], v35 offset:33792
  ds_read_b64 v[66:67], v35 offset:34304
  ds_read_b64 v[68:69], v35 offset:34816
  ds_read_b64 v[70:71], v35 offset:35328
  ds_read_b64 v[72:73], v35 offset:35840
  s_waitcnt lgkmcnt(0)
  ds_write_b64 v35, v[64:65] offset:0
  ds_write_b64 v35, v[66:67] offset:512
  ds_write_b64 v35, v[68:69] offset:1024
  ds_write_b64 v35, v[70:71] offset:1536
  ds_write_b64 v35, v[72:73] offset:2048
bh_208:
  s_nop 1
  v_cvt_pk_bf16_f32 v244, v192, v193
  v_cvt_pk_bf16_f32 v245, v194, v195
  v_cvt_pk_bf16_f32 v246, v196, v197
  v_cvt_pk_bf16_f32 v247, v198, v199
  v_cvt_pk_bf16_f32 v248, v200, v201
  v_cvt_pk_bf16_f32 v249, v202, v203
  v_cvt_pk_bf16_f32 v250, v204, v205
  v_cvt_pk_bf16_f32 v251, v206, v207
  v_cvt_pk_bf16_f32 v252, v208, v209
  v_cvt_pk_bf16_f32 v253, v210, v211
  buffer_store_dwordx4 v[244:247], v29, s[16:19], s27 offen sc1
  buffer_store_dwordx4 v[248:251], v30, s[16:19], s27 offen sc1
  buffer_store_dwordx2 v[252:253], v31, s[16:19], s27 offen sc1
  s_add_u32 s27, s27, 2048
  s_mov_b64 s[78:79], -1
  s_mov_b64 s[80:81], -1
  s_mov_b64 s[82:83], -1
  s_mov_b64 s[84:85], -1
  s_mov_b64 s[86:87], -1
  s_mov_b64 s[88:89], -1
  s_mov_b64 s[90:91], -1
  s_sub_u32 s26, s26, 1
  s_cmp_gt_u32 s26, 0
  s_waitcnt lgkmcnt(0)
  s_cbranch_scc1 bf_blk_206
  s_waitcnt vmcnt(0) lgkmcnt(0)
  s_load_dwordx2 s[32:33], s[0:1], 96
  s_waitcnt lgkmcnt(0)
  s_mov_b32 s32, s32
  s_mov_b32 s33, s33
  s_mov_b32 s34, 256
  s_mov_b32 s35, 0x00020000
  s_mov_b32 s21, 76
  s_cmp_lg_u32 s20, 0
  s_cbranch_scc1 wf_210
  v_mov_b32 v4, 0
  s_mov_b32 s101, 0
wf_209:
  buffer_load_dword v5, v4, s[32:35], s21 offen sc1
  s_add_u32 s101, s101, 1
  s_cmp_gt_u32 s101, 131072
  s_cbranch_scc1 main_end
  s_waitcnt vmcnt(0)
  v_readfirstlane_b32 s100, v5
  s_cmp_ge_u32 s100, 32
  s_cbranch_scc1 wf_210
  s_sleep 8
  s_branch wf_209
wf_210:
  s_barrier
  s_load_dwordx2 s[12:13], s[0:1], 72
  s_lshl_b32 s21, s2, 2
  s_add_u32 s21, s21, s20
  s_mul_i32 s21, s21, 6400
  s_add_u32 s22, s21, 4096
  v_lshlrev_b32 v5, 4, v1
  s_mov_b32 s14, 819200
  s_waitcnt lgkmcnt(0)
  buffer_load_dwordx4 v[40:43], v5, s[12:15], s21 offen offset:0
  buffer_load_dwordx4 v[40:43], v5, s[12:15], s21 offen offset:1024
  buffer_load_dwordx4 v[40:43], v5, s[12:15], s21 offen offset:2048
  buffer_load_dwordx4 v[40:43], v5, s[12:15], s21 offen offset:3072
  buffer_load_dwordx4 v[40:43], v5, s[12:15], s22 offen offset:0
  buffer_load_dwordx4 v[40:43], v5, s[12:15], s22 offen offset:1024
  buffer_load_dwordx4 v[40:43], v5, s[12:15], s22 offen offset:2048
  s_mov_b32 s21, 91136
  s_cmp_lg_u32 s20, 0
  s_cbranch_scc1 af_211
  v_mov_b32 v4, 0
  v_mov_b32 v5, 1
  s_mov_b64 exec, 1
  buffer_atomic_add v5, v4, s[72:75], s21 offen sc1
  s_mov_b64 exec, -1
  s_nop 1
af_211:
  s_barrier
  s_mov_b32 s84, 0
  s_mov_b32 s85, -1
  s_load_dwordx2 s[4:5], s[0:1], 0
  s_load_dwordx2 s[6:7], s[0:1], 16
  s_load_dwordx2 s[38:39], s[0:1], 104
  s_mov_b32 s42, s2
  s_mov_b32 s41, 0
  s_waitcnt lgkmcnt(0)
  s_mov_b32 s8, s4
  s_mov_b32 s9, s5
  s_mov_b32 s10, 2621440
  s_mov_b32 s11, 0x00020000
  s_mov_b32 s12, s6
  s_mov_b32 s13, s7
  s_mov_b32 s14, 7864320
  s_mov_b32 s15, 0x00020000
  s_mov_b32 s16, s38
  s_mov_b32 s17, s39
  s_mov_b32 s18, 50331648
  s_mov_b32 s19, 0x00020000
  s_add_u32 s52, s38, 50331648
  s_addc_u32 s53, s39, 0
  s_mov_b32 s54, 6291456
  s_mov_b32 s55, 0x00020000
  s_add_u32 s56, s38, 85983232
  s_addc_u32 s57, s39, 0
  s_mov_b32 s58, 6815744
  s_mov_b32 s59, 0x00020000
  s_load_dwordx2 s[72:73], s[0:1], 104
  s_waitcnt lgkmcnt(0)
  s_add_u32 s72, s72, 81068032
  s_addc_u32 s73, s73, 0
  s_mov_b32 s74, 116736
  s_mov_b32 s75, 0x00020000
  s_mul_i32 s44, s42, 384
  v_mov_b32 v9, 2731
  v_add_u32 v8, 0, v1
  v_mul_u32_u24 v7, v8, v9
  v_lshrrev_b32 v7, 16, v7
  v_mul_u32_u24 v4, 24, v7
  v_sub_u32 v8, v8, v4
  s_mov_b32 s21, 12288
  v_mul_lo_u32 v7, v7, s21
  v_lshl_add_u32 v4, v8, 4, v7
  v_add_u32 v8, 64, v1
  v_mul_u32_u24 v7, v8, v9
  v_lshrrev_b32 v7, 16, v7
  v_mul_u32_u24 v5, 24, v7
  v_sub_u32 v8, v8, v5
  s_mov_b32 s21, 12288
  v_mul_lo_u32 v7, v7, s21
  v_lshl_add_u32 v5, v8, 4, v7
  v_add_u32 v8, 128, v1
  v_mul_u32_u24 v7, v8, v9
  v_lshrrev_b32 v7, 16, v7
  v_mul_u32_u24 v6, 24, v7
  v_sub_u32 v8, v8, v6
  s_mov_b32 s21, 12288
  v_mul_lo_u32 v7, v7, s21
  v_lshl_add_u32 v6, v8, 4, v7
  v_lshrrev_b32 v7, 2, v2
  v_lshl_add_u32 v7, v3, 3, v7
  v_mul_u32_u24 v7, 384, v7
  v_and_b32 v8, 3, v2
  v_lshlrev_b32 v8, 3, v8
  s_mul_i32 s21, s20, 96
  v_add3_u32 v7, v7, v8, s21
  v_add_u32 v8, 61440, v7
  s_mul_i32 s21, s20, 491520
  s_add_u32 s21, s21, 0
  s_add_u32 s21, s21, s44
  s_mul_i32 s22, s20, 15360
  s_add_u32 s22, s22, 0
  s_add_u32 m0, s22, 0
  s_nop 0
  buffer_load_dwordx4 v4, s[12:15], s21 offen lds
  s_add_u32 m0, s22, 1024
  s_nop 0
  buffer_load_dwordx4 v5, s[12:15], s21 offen lds
  s_add_u32 m0, s22, 2048
  s_nop 0
  buffer_load_dwordx4 v6, s[12:15], s21 offen lds
  s_mul_i32 s21, s20, 491520
  s_add_u32 s21, s21, 98304
  s_add_u32 s21, s21, s44
  s_mul_i32 s22, s20, 15360
  s_add_u32 s22, s22, 3072
  s_add_u32 m0, s22, 0
  s_nop 0
  buffer_load_dwordx4 v4, s[12:15], s21 offen lds
  s_add_u32 m0, s22, 1024
  s_nop 0
  buffer_load_dwordx4 v5, s[12:15], s21 offen lds
  s_add_u32 m0, s22, 2048
  s_nop 0
  buffer_load_dwordx4 v6, s[12:15], s21 offen lds
  s_mul_i32 s21, s20, 491520
  s_add_u32 s21, s21, 196608
  s_add_u32 s21, s21, s44
  s_mul_i32 s22, s20, 15360
  s_add_u32 s22, s22, 6144
  s_add_u32 m0, s22, 0
  s_nop 0
  buffer_load_dwordx4 v4, s[12:15], s21 offen lds
  s_add_u32 m0, s22, 1024
  s_nop 0
  buffer_load_dwordx4 v5, s[12:15], s21 offen lds
  s_add_u32 m0, s22, 2048
  s_nop 0
  buffer_load_dwordx4 v6, s[12:15], s21 offen lds
  s_mul_i32 s21, s20, 491520
  s_add_u32 s21, s21, 294912
  s_add_u32 s21, s21, s44
  s_mul_i32 s22, s20, 15360
  s_add_u32 s22, s22, 9216
  s_add_u32 m0, s22, 0
  s_nop 0
  buffer_load_dwordx4 v4, s[12:15], s21 offen lds
  s_add_u32 m0, s22, 1024
  s_nop 0
  buffer_load_dwordx4 v5, s[12:15], s21 offen lds
  s_add_u32 m0, s22, 2048
  s_nop 0
  buffer_load_dwordx4 v6, s[12:15], s21 offen lds
  s_mul_i32 s21, s20, 491520
  s_add_u32 s21, s21, 393216
  s_add_u32 s21, s21, s44
  s_mul_i32 s22, s20, 15360
  s_add_u32 s22, s22, 12288
  s_add_u32 m0, s22, 0
  s_nop 0
  buffer_load_dwordx4 v4, s[12:15], s21 offen lds
  s_add_u32 m0, s22, 1024
  s_nop 0
  buffer_load_dwordx4 v5, s[12:15], s21 offen lds
  s_add_u32 m0, s22, 2048
  s_nop 0
  buffer_load_dwordx4 v6, s[12:15], s21 offen lds
  s_mul_i32 s21, s20, 491520
  s_add_u32 s21, s21, 1966080
  s_add_u32 s21, s21, s44
  s_mul_i32 s22, s20, 15360
  s_add_u32 s22, s22, 61440
  s_add_u32 m0, s22, 0
  s_nop 0
  buffer_load_dwordx4 v4, s[12:15], s21 offen lds
  s_add_u32 m0, s22, 1024
  s_nop 0
  buffer_load_dwordx4 v5, s[12:15], s21 offen lds
  s_add_u32 m0, s22, 2048
  s_nop 0
  buffer_load_dwordx4 v6, s[12:15], s21 offen lds
  s_mul_i32 s21, s20, 491520
  s_add_u32 s21, s21, 2064384
  s_add_u32 s21, s21, s44
  s_mul_i32 s22, s20, 15360
  s_add_u32 s22, s22, 64512
  s_add_u32 m0, s22, 0
  s_nop 0
  buffer_load_dwordx4 v4, s[12:15], s21 offen lds
  s_add_u32 m0, s22, 1024
  s_nop 0
  buffer_load_dwordx4 v5, s[12:15], s21 offen lds
  s_add_u32 m0, s22, 2048
  s_nop 0
  buffer_load_dwordx4 v6, s[12:15], s21 offen lds
  s_mul_i32 s21, s20, 491520
  s_add_u32 s21, s21, 2162688
  s_add_u32 s21, s21, s44
  s_mul_i32 s22, s20, 15360
  s_add_u32 s22, s22, 67584
  s_add_u32 m0, s22, 0
  s_nop 0
  buffer_load_dwordx4 v4, s[12:15], s21 offen lds
  s_add_u32 m0, s22, 1024
  s_nop 0
  buffer_load_dwordx4 v5, s[12:15], s21 offen lds
  s_add_u32 m0, s22, 2048
  s_nop 0
  buffer_load_dwordx4 v6, s[12:15], s21 offen lds
  s_mul_i32 s21, s20, 491520
  s_add_u32 s21, s21, 2260992
  s_add_u32 s21, s21, s44
  s_mul_i32 s22, s20, 15360
  s_add_u32 s22, s22, 70656
  s_add_u32 m0, s22, 0
  s_nop 0
  buffer_load_dwordx4 v4, s[12:15], s21 offen lds
  s_add_u32 m0, s22, 1024
  s_nop 0
  buffer_load_dwordx4 v5, s[12:15], s21 offen lds
  s_add_u32 m0, s22, 2048
  s_nop 0
  buffer_load_dwordx4 v6, s[12:15], s21 offen lds
  s_mul_i32 s21, s20, 491520
  s_add_u32 s21, s21, 2359296
  s_add_u32 s21, s21, s44
  s_mul_i32 s22, s20, 15360
  s_add_u32 s22, s22, 73728
  s_add_u32 m0, s22, 0
  s_nop 0
  buffer_load_dwordx4 v4, s[12:15], s21 offen lds
  s_add_u32 m0, s22, 1024
  s_nop 0
  buffer_load_dwordx4 v5, s[12:15], s21 offen lds
  s_add_u32 m0, s22, 2048
  s_nop 0
  buffer_load_dwordx4 v6, s[12:15], s21 offen lds
  s_mul_i32 s21, s20, 491520
  s_add_u32 s21, s21, 3932160
  s_add_u32 s21, s21, s44
  buffer_load_dwordx4 v[64:67], v4, s[12:15], s21 offen
  buffer_load_dwordx4 v[68:71], v5, s[12:15], s21 offen
  buffer_load_dwordx4 v[72:75], v6, s[12:15], s21 offen
  s_mul_i32 s21, s20, 491520
  s_add_u32 s21, s21, 4030464
  s_add_u32 s21, s21, s44
  buffer_load_dwordx4 v[76:79], v4, s[12:15], s21 offen
  buffer_load_dwordx4 v[80:83], v5, s[12:15], s21 offen
  buffer_load_dwordx4 v[84:87], v6, s[12:15], s21 offen
  s_mul_i32 s21, s20, 491520
  s_add_u32 s21, s21, 4128768
  s_add_u32 s21, s21, s44
  buffer_load_dwordx4 v[88:91], v4, s[12:15], s21 offen
  buffer_load_dwordx4 v[92:95], v5, s[12:15], s21 offen
  buffer_load_dwordx4 v[96:99], v6, s[12:15], s21 offen
  s_mul_i32 s21, s20, 491520
  s_add_u32 s21, s21, 4227072
  s_add_u32 s21, s21, s44
  buffer_load_dwordx4 v[100:103], v4, s[12:15], s21 offen
  buffer_load_dwordx4 v[104:107], v5, s[12:15], s21 offen
  buffer_load_dwordx4 v[108:111], v6, s[12:15], s21 offen
  s_mul_i32 s21, s20, 491520
  s_add_u32 s21, s21, 4325376
  s_add_u32 s21, s21, s44
  buffer_load_dwordx4 v[112:115], v4, s[12:15], s21 offen
  buffer_load_dwordx4 v[116:119], v5, s[12:15], s21 offen
  buffer_load_dwordx4 v[120:123], v6, s[12:15], s21 offen
  s_mul_i32 s21, s20, 491520
  s_add_u32 s21, s21, 5898240
  s_add_u32 s21, s21, s44
  buffer_load_dwordx4 v[124:127], v4, s[12:15], s21 offen
  buffer_load_dwordx4 v[128:131], v5, s[12:15], s21 offen
  buffer_load_dwordx4 v[132:135], v6, s[12:15], s21 offen
  s_mul_i32 s21, s20, 491520
  s_add_u32 s21, s21, 5996544
  s_add_u32 s21, s21, s44
  buffer_load_dwordx4 v[136:139], v4, s[12:15], s21 offen
  buffer_load_dwordx4 v[140:143], v5, s[12:15], s21 offen
  buffer_load_dwordx4 v[144:147], v6, s[12:15], s21 offen
  s_mul_i32 s21, s20, 491520
  s_add_u32 s21, s21, 6094848
  s_add_u32 s21, s21, s44
  buffer_load_dwordx4 v[148:151], v4, s[12:15], s21 offen
  buffer_load_dwordx4 v[152:155], v5, s[12:15], s21 offen
  buffer_load_dwordx4 v[156:159], v6, s[12:15], s21 offen
  s_mul_i32 s21, s20, 491520
  s_add_u32 s21, s21, 6193152
  s_add_u32 s21, s21, s44
  buffer_load_dwordx4 v[160:163], v4, s[12:15], s21 offen
  buffer_load_dwordx4 v[164:167], v5, s[12:15], s21 offen
  buffer_load_dwordx4 v[168:171], v6, s[12:15], s21 offen
  s_mul_i32 s21, s20, 491520
  s_add_u32 s21, s21, 6291456
  s_add_u32 s21, s21, s44
  buffer_load_dwordx4 v[172:175], v4, s[12:15], s21 offen
  buffer_load_dwordx4 v[176:179], v5, s[12:15], s21 offen
  buffer_load_dwordx4 v[180:183], v6, s[12:15], s21 offen
  s_mul_i32 s22, s20, 15360
  v_lshl_add_u32 v30, v1, 4, s22
  v_add_u32 v31, 61440, v30
  s_waitcnt vmcnt(45)
  s_barrier
  ds_read_b64_tr_b16 a[0:1], v7 offset:0
  ds_read_b64_tr_b16 a[2:3], v7 offset:1536
  ds_read_b64_tr_b16 a[4:5], v7 offset:32
  ds_read_b64_tr_b16 a[6:7], v7 offset:1568
  ds_read_b64_tr_b16 a[8:9], v7 offset:64
  ds_read_b64_tr_b16 a[10:11], v7 offset:1600
  ds_read_b64_tr_b16 a[12:13], v7 offset:12288
  ds_read_b64_tr_b16 a[14:15], v7 offset:13824
  ds_read_b64_tr_b16 a[16:17], v7 offset:12320
  ds_read_b64_tr_b16 a[18:19], v7 offset:13856
  ds_read_b64_tr_b16 a[20:21], v7 offset:12352
  ds_read_b64_tr_b16 a[22:23], v7 offset:13888
  ds_read_b64_tr_b16 a[24:25], v7 offset:24576
  ds_read_b64_tr_b16 a[26:27], v7 offset:26112
  ds_read_b64_tr_b16 a[28:29], v7 offset:24608
  ds_read_b64_tr_b16 a[30:31], v7 offset:26144
  ds_read_b64_tr_b16 a[32:33], v7 offset:24640
  ds_read_b64_tr_b16 a[34:35], v7 offset:26176
  ds_read_b64_tr_b16 a[36:37], v7 offset:36864
  ds_read_b64_tr_b16 a[38:39], v7 offset:38400
  ds_read_b64_tr_b16 a[40:41], v7 offset:36896
  ds_read_b64_tr_b16 a[42:43], v7 offset:38432
  ds_read_b64_tr_b16 a[44:45], v7 offset:36928
  ds_read_b64_tr_b16 a[46:47], v7 offset:38464
  ds_read_b64_tr_b16 a[48:49], v7 offset:49152
  ds_read_b64_tr_b16 a[50:51], v7 offset:50688
  ds_read_b64_tr_b16 a[52:53], v7 offset:49184
  ds_read_b64_tr_b16 a[54:55], v7 offset:50720
  ds_read_b64_tr_b16 a[56:57], v7 offset:49216
  ds_read_b64_tr_b16 a[58:59], v7 offset:50752
  s_waitcnt lgkmcnt(0)
  s_barrier
  s_waitcnt vmcnt(30)
  s_barrier
  ds_read_b64_tr_b16 a[60:61], v8 offset:0
  ds_read_b64_tr_b16 a[62:63], v8 offset:1536
  ds_read_b64_tr_b16 a[64:65], v8 offset:32
  ds_read_b64_tr_b16 a[66:67], v8 offset:1568
  ds_read_b64_tr_b16 a[68:69], v8 offset:64
  ds_read_b64_tr_b16 a[70:71], v8 offset:1600
  ds_read_b64_tr_b16 a[72:73], v8 offset:12288
  ds_read_b64_tr_b16 a[74:75], v8 offset:13824
  ds_read_b64_tr_b16 a[76:77], v8 offset:12320
  ds_read_b64_tr_b16 a[78:79], v8 offset:13856
  ds_read_b64_tr_b16 a[80:81], v8 offset:12352
  ds_read_b64_tr_b16 a[82:83], v8 offset:13888
  ds_read_b64_tr_b16 a[84:85], v8 offset:24576
  ds_read_b64_tr_b16 a[86:87], v8 offset:26112
  ds_read_b64_tr_b16 a[88:89], v8 offset:24608
  ds_read_b64_tr_b16 a[90:91], v8 offset:26144
  ds_read_b64_tr_b16 a[92:93], v8 offset:24640
  ds_read_b64_tr_b16 a[94:95], v8 offset:26176
  ds_read_b64_tr_b16 a[96:97], v8 offset:36864
  ds_read_b64_tr_b16 a[98:99], v8 offset:38400
  ds_read_b64_tr_b16 a[100:101], v8 offset:36896
  ds_read_b64_tr_b16 a[102:103], v8 offset:38432
  ds_read_b64_tr_b16 a[104:105], v8 offset:36928
  ds_read_b64_tr_b16 a[106:107], v8 offset:38464
  ds_read_b64_tr_b16 a[108:109], v8 offset:49152
  ds_read_b64_tr_b16 a[110:111], v8 offset:50688
  ds_read_b64_tr_b16 a[112:113], v8 offset:49184
  ds_read_b64_tr_b16 a[114:115], v8 offset:50720
  ds_read_b64_tr_b16 a[116:117], v8 offset:49216
  ds_read_b64_tr_b16 a[118:119], v8 offset:50752
  s_waitcnt lgkmcnt(0)
  s_barrier
  s_waitcnt vmcnt(15)
  ds_write_b128 v30, v[64:67] offset:0
  ds_write_b128 v30, v[68:71] offset:1024
  ds_write_b128 v30, v[72:75] offset:2048
  ds_write_b128 v30, v[76:79] offset:3072
  ds_write_b128 v30, v[80:83] offset:4096
  ds_write_b128 v30, v[84:87] offset:5120
  ds_write_b128 v30, v[88:91] offset:6144
  ds_write_b128 v30, v[92:95] offset:7168
  ds_write_b128 v30, v[96:99] offset:8192
  ds_write_b128 v30, v[100:103] offset:9216
  ds_write_b128 v30, v[104:107] offset:10240
  ds_write_b128 v30, v[108:111] offset:11264
  ds_write_b128 v30, v[112:115] offset:12288
  ds_write_b128 v30, v[116:119] offset:13312
  ds_write_b128 v30, v[120:123] offset:14336
  s_waitcnt lgkmcnt(0)
  s_barrier
  ds_read_b64_tr_b16 a[120:121], v7 offset:0
  ds_read_b64_tr_b16 a[122:123], v7 offset:1536
  ds_read_b64_tr_b16 a[124:125], v7 offset:32
  ds_read_b64_tr_b16 a[126:127], v7 offset:1568
  ds_read_b64_tr_b16 a[128:129], v7 offset:64
  ds_read_b64_tr_b16 a[130:131], v7 offset:1600
  ds_read_b64_tr_b16 a[132:133], v7 offset:12288
  ds_read_b64_tr_b16 a[134:135], v7 offset:13824
  ds_read_b64_tr_b16 a[136:137], v7 offset:12320
  ds_read_b64_tr_b16 a[138:139], v7 offset:13856
  ds_read_b64_tr_b16 a[140:141], v7 offset:12352
  ds_read_b64_tr_b16 a[142:143], v7 offset:13888
  ds_read_b64_tr_b16 a[144:145], v7 offset:24576
  ds_read_b64_tr_b16 a[146:147], v7 offset:26112
  ds_read_b64_tr_b16 a[148:149], v7 offset:24608
  ds_read_b64_tr_b16 a[150:151], v7 offset:26144
  ds_read_b64_tr_b16 a[152:153], v7 offset:24640
  ds_read_b64_tr_b16 a[154:155], v7 offset:26176
  ds_read_b64_tr_b16 a[156:157], v7 offset:36864
  ds_read_b64_tr_b16 a[158:159], v7 offset:38400
  ds_read_b64_tr_b16 a[160:161], v7 offset:36896
  ds_read_b64_tr_b16 a[162:163], v7 offset:38432
  ds_read_b64_tr_b16 a[164:165], v7 offset:36928
  ds_read_b64_tr_b16 a[166:167], v7 offset:38464
  ds_read_b64_tr_b16 a[168:169], v7 offset:49152
  ds_read_b64_tr_b16 a[170:171], v7 offset:50688
  ds_read_b64_tr_b16 a[172:173], v7 offset:49184
  ds_read_b64_tr_b16 a[174:175], v7 offset:50720
  ds_read_b64_tr_b16 a[176:177], v7 offset:49216
  ds_read_b64_tr_b16 a[178:179], v7 offset:50752
  s_waitcnt lgkmcnt(0)
  s_barrier
  s_waitcnt vmcnt(0)
  ds_write_b128 v31, v[124:127] offset:0
  ds_write_b128 v31, v[128:131] offset:1024
  ds_write_b128 v31, v[132:135] offset:2048
  ds_write_b128 v31, v[136:139] offset:3072
  ds_write_b128 v31, v[140:143] offset:4096
  ds_write_b128 v31, v[144:147] offset:5120
  ds_write_b128 v31, v[148:151] offset:6144
  ds_write_b128 v31, v[152:155] offset:7168
  ds_write_b128 v31, v[156:159] offset:8192
  ds_write_b128 v31, v[160:163] offset:9216
  ds_write_b128 v31, v[164:167] offset:10240
  ds_write_b128 v31, v[168:171] offset:11264
  ds_write_b128 v31, v[172:175] offset:12288
  ds_write_b128 v31, v[176:179] offset:13312
  ds_write_b128 v31, v[180:183] offset:14336
  s_waitcnt lgkmcnt(0)
  s_barrier
  ds_read_b64_tr_b16 a[180:181], v8 offset:0
  ds_read_b64_tr_b16 a[182:183], v8 offset:1536
  ds_read_b64_tr_b16 a[184:185], v8 offset:32
  ds_read_b64_tr_b16 a[186:187], v8 offset:1568
  ds_read_b64_tr_b16 a[188:189], v8 offset:64
  ds_read_b64_tr_b16 a[190:191], v8 offset:1600
  ds_read_b64_tr_b16 a[192:193], v8 offset:12288
  ds_read_b64_tr_b16 a[194:195], v8 offset:13824
  ds_read_b64_tr_b16 a[196:197], v8 offset:12320
  ds_read_b64_tr_b16 a[198:199], v8 offset:13856
  ds_read_b64_tr_b16 a[200:201], v8 offset:12352
  ds_read_b64_tr_b16 a[202:203], v8 offset:13888
  ds_read_b64_tr_b16 a[204:205], v8 offset:24576
  ds_read_b64_tr_b16 a[206:207], v8 offset:26112
  ds_read_b64_tr_b16 a[208:209], v8 offset:24608
  ds_read_b64_tr_b16 a[210:211], v8 offset:26144
  ds_read_b64_tr_b16 a[212:213], v8 offset:24640
  ds_read_b64_tr_b16 a[214:215], v8 offset:26176
  ds_read_b64_tr_b16 a[216:217], v8 offset:36864
  ds_read_b64_tr_b16 a[218:219], v8 offset:38400
  ds_read_b64_tr_b16 a[220:221], v8 offset:36896
  ds_read_b64_tr_b16 a[222:223], v8 offset:38432
  ds_read_b64_tr_b16 a[224:225], v8 offset:36928
  ds_read_b64_tr_b16 a[226:227], v8 offset:38464
  ds_read_b64_tr_b16 a[228:229], v8 offset:49152
  ds_read_b64_tr_b16 a[230:231], v8 offset:50688
  ds_read_b64_tr_b16 a[232:233], v8 offset:49184
  ds_read_b64_tr_b16 a[234:235], v8 offset:50720
  ds_read_b64_tr_b16 a[236:237], v8 offset:49216
  ds_read_b64_tr_b16 a[238:239], v8 offset:50752
  s_waitcnt lgkmcnt(0)
  s_barrier
  s_mul_i32 s21, s20, 12800
  s_add_u32 s21, s21, 98304
  v_mul_u32_u24 v4, 400, v2
  v_lshlrev_b32 v5, 4, v3
  v_add3_u32 v29, v4, v5, s21
  v_lshlrev_b32 v30, 4, v1
  v_and_b32 v4, 1, v2
  v_bfe_u32 v5, v2, 1, 1
  v_lshl_or_b32 v4, v5, 2, v4
  v_bfe_u32 v5, v2, 2, 1
  v_lshl_or_b32 v4, v5, 1, v4
  v_lshlrev_b32 v4, 4, v4
  v_lshl_add_u32 v31, v3, 7, v4
  v_lshlrev_b32 v32, 3, v1
  v_and_b32 v4, 3, v1
  v_lshlrev_b32 v33, 3, v4
  v_mov_b32 v34, 0xf149f2ca
  v_lshlrev_b32 v4, 2, v3
  v_sub_u32 v35, v2, v4
  v_cmp_gt_u32 s[60:61], 2, v3
  s_mov_b32 s62, 0x3d93cd3a
  s_mov_b32 s63, 0x3fb8aa3b
  s_mov_b32 s83, 0x3dd53b95
  v_cmp_le_i32 s[64:65], 0, v35
  v_cmp_le_i32 s[66:67], 1, v35
  v_cmp_le_i32 s[68:69], 2, v35
  v_cmp_le_i32 s[70:71], 3, v35
  s_mov_b32 s24, 0
  s_mov_b32 s25, 163840
  s_mov_b32 s26, 12
  s_lshl_b32 s49, s41, 2
  s_add_u32 s49, s49, s20
  s_mov_b32 s29, 4
  s_mov_b32 s78, 0
  s_mov_b32 s81, 0x80000000
  s_mov_b32 s82, 0
  v_lshrrev_b32 v11, 3, v1
  v_and_b32 v12, 7, v1
  v_xor_b32 v12, v12, v11
  v_mul_u32_u24 v11, 1280, v11
  v_lshl_add_u32 v10, v12, 4, v11
  s_mul_i32 s46, s20, 40960
  v_add_u32 v10, s46, v10
  s_lshl_b32 s47, s20, 12
  s_add_u32 s47, s47, 0
  s_add_u32 s46, s47, 98304
  s_mov_b32 s30, s24
  s_add_u32 s32, s47, 0
  v_add_u32 v11, 9216, v10
  v_add_u32 v12, 18432, v10
  v_add_u32 v13, 27648, v10
  s_mov_b32 m0, s32
  s_nop 0
  buffer_load_dwordx4 v10, s[8:11], s30 offen offset:0 lds
  buffer_load_dwordx4 v11, s[8:11], s30 offen offset:1024 lds
  buffer_load_dwordx4 v12, s[8:11], s30 offen offset:2048 lds
  buffer_load_dwordx4 v13, s[8:11], s30 offen offset:3072 lds
  s_add_u32 s30, s30, 128
  s_add_u32 s32, s32, 16384
  s_cmp_lt_u32 s32, s46
  s_cselect_b32 s32, s32, s47
  s_mov_b32 m0, s32
  s_nop 0
  buffer_load_dwordx4 v10, s[8:11], s30 offen offset:0 lds
  buffer_load_dwordx4 v11, s[8:11], s30 offen offset:1024 lds
  buffer_load_dwordx4 v12, s[8:11], s30 offen offset:2048 lds
  buffer_load_dwordx4 v13, s[8:11], s30 offen offset:3072 lds
  s_add_u32 s30, s30, 128
  s_add_u32 s32, s32, 16384
  s_cmp_lt_u32 s32, s46
  s_cselect_b32 s32, s32, s47
  s_mov_b32 m0, s32
  s_nop 0
  buffer_load_dwordx4 v10, s[8:11], s30 offen offset:0 lds
  buffer_load_dwordx4 v11, s[8:11], s30 offen offset:1024 lds
  buffer_load_dwordx4 v12, s[8:11], s30 offen offset:2048 lds
  buffer_load_dwordx4 v13, s[8:11], s30 offen offset:3072 lds
  s_add_u32 s30, s30, 128
  s_add_u32 s32, s32, 16384
  s_cmp_lt_u32 s32, s46
  s_cselect_b32 s32, s32, s47
  s_mov_b32 m0, s32
  s_nop 0
  buffer_load_dwordx4 v10, s[8:11], s30 offen offset:0 lds
  buffer_load_dwordx4 v11, s[8:11], s30 offen offset:1024 lds
  buffer_load_dwordx4 v12, s[8:11], s30 offen offset:2048 lds
  buffer_load_dwordx4 v13, s[8:11], s30 offen offset:3072 lds
  s_add_u32 s30, s30, 128
  s_add_u32 s32, s32, 16384
  s_cmp_lt_u32 s32, s46
  s_cselect_b32 s32, s32, s47
  v_and_b32 v6, 7, v2
  v_add_u32 v4, 0, v3
  v_xor_b32 v4, v4, v6
  v_lshlrev_b32 v4, 4, v4
  v_lshl_add_u32 v14, v2, 7, v4
  v_add_u32 v4, 4, v3
  v_xor_b32 v4, v4, v6
  v_lshlrev_b32 v4, 4, v4
  v_lshl_add_u32 v15, v2, 7, v4
  v_mul_u32_u24 v22, 400, v2
  v_mul_u32_u24 v4, 16, v3
  s_mul_i32 s21, s20, 96
  s_add_u32 s21, s21, 98304
  v_add3_u32 v22, v22, v4, s21
  v_lshlrev_b32 v4, 3, v3
  v_sub_u32 v16, v22, v4
  v_mov_b32 v9, 2731
  s_mov_b32 s33, 0
  s_mov_b32 s48, 0x80000000
  s_mov_b32 m0, s32
  s_nop 0
  buffer_load_dwordx4 v10, s[8:11], s30 offen offset:0 lds
  buffer_load_dwordx4 v11, s[8:11], s30 offen offset:1024 lds
  s_waitcnt vmcnt(14)
  s_barrier
  v_add_u32 v18, s33, v14
  v_add_u32 v19, s33, v15
  s_add_u32 s33, s33, 16384
  s_cmp_lt_u32 s33, 98304
  s_cselect_b32 s33, s33, 0
  ds_read_b128 v[160:163], v18 offset:0
  ds_read_b128 v[164:167], v18 offset:2048
  ds_read_b128 v[168:171], v18 offset:4096
  ds_read_b128 v[172:175], v18 offset:6144
  ds_read_b128 v[176:179], v18 offset:8192
  ds_read_b128 v[180:183], v18 offset:10240
  ds_read_b128 v[184:187], v18 offset:12288
  ds_read_b128 v[188:191], v18 offset:14336
  s_waitcnt lgkmcnt(0)
qa_blk_214:
  v_mfma_f32_16x16x32_bf16 v[64:67], a[0:3], v[160:163], 0
  ds_read_b128 v[192:195], v19 offset:0
  v_mfma_f32_16x16x32_bf16 v[68:71], a[4:7], v[160:163], 0
  v_add_u32 v18, s33, v14
  v_cndmask_b32 v36, v34, v36, s[64:65]
  v_mfma_f32_16x16x32_bf16 v[72:75], a[8:11], v[160:163], 0
  v_cndmask_b32 v48, v34, v48, s[64:65]
  v_cndmask_b32 v37, v34, v37, s[66:67]
  v_mfma_f32_16x16x32_bf16 v[76:79], a[0:3], v[164:167], 0
  ds_read_b128 v[196:199], v19 offset:2048
  v_cndmask_b32 v49, v34, v49, s[66:67]
  v_mfma_f32_16x16x32_bf16 v[80:83], a[4:7], v[164:167], 0
  buffer_load_dwordx4 v12, s[8:11], s30 offen offset:2048 lds
  v_mfma_f32_16x16x32_bf16 v[84:87], a[8:11], v[164:167], 0
  v_cndmask_b32 v38, v34, v38, s[68:69]
  v_cndmask_b32 v50, v34, v50, s[68:69]
  v_mfma_f32_16x16x32_bf16 v[88:91], a[0:3], v[168:171], 0
  ds_read_b128 v[200:203], v19 offset:4096
  v_cndmask_b32 v39, v34, v39, s[70:71]
  v_mfma_f32_16x16x32_bf16 v[92:95], a[4:7], v[168:171], 0
  v_cndmask_b32 v51, v34, v51, s[70:71]
  v_max3_f32 v56, v36, v37, v38
  v_mfma_f32_16x16x32_bf16 v[96:99], a[8:11], v[168:171], 0
  v_max3_f32 v56, v56, v39, v40
  v_max3_f32 v56, v56, v41, v42
  v_mfma_f32_16x16x32_bf16 v[100:103], a[0:3], v[172:175], 0
  ds_read_b128 v[204:207], v19 offset:6144
  v_max_f32 v56, v56, v43
  v_mfma_f32_16x16x32_bf16 v[104:107], a[4:7], v[172:175], 0
  v_mov_b32 v57, v56
  v_mfma_f32_16x16x32_bf16 v[108:111], a[8:11], v[172:175], 0
  s_waitcnt lgkmcnt(15)
  v_mfma_f32_16x16x32_bf16 v[112:115], a[0:3], v[176:179], 0
  ds_read_b128 v[208:211], v19 offset:8192
  v_mfma_f32_16x16x32_bf16 v[116:119], a[4:7], v[176:179], 0
  s_nop 1
  v_mfma_f32_16x16x32_bf16 v[120:123], a[8:11], v[176:179], 0
  v_permlane32_swap_b32 v56, v57
  v_mfma_f32_16x16x32_bf16 v[124:127], a[0:3], v[180:183], 0
  ds_read_b128 v[212:215], v19 offset:10240
  v_max_f32 v56, v56, v57
  v_mfma_f32_16x16x32_bf16 v[128:131], a[4:7], v[180:183], 0
  buffer_load_dwordx4 v13, s[8:11], s30 offen offset:3072 lds
  v_mfma_f32_16x16x32_bf16 v[132:135], a[8:11], v[180:183], 0
  s_add_u32 s30, s30, 128
  s_add_u32 m0, m0, 16384
  v_mfma_f32_16x16x32_bf16 v[136:139], a[0:3], v[184:187], 0
  ds_read_b128 v[216:219], v19 offset:12288
  v_mov_b32 v57, v56
  v_mfma_f32_16x16x32_bf16 v[140:143], a[4:7], v[184:187], 0
  s_cmp_lt_u32 m0, s46
  s_cselect_b32 m0, m0, s47
  v_mfma_f32_16x16x32_bf16 v[144:147], a[8:11], v[184:187], 0
  s_nop 1
  v_mfma_f32_16x16x32_bf16 v[148:151], a[0:3], v[188:191], 0
  ds_read_b128 v[220:223], v19 offset:14336
  v_mfma_f32_16x16x32_bf16 v[152:155], a[4:7], v[188:191], 0
  v_permlane16_swap_b32 v56, v57
  v_mfma_f32_16x16x32_bf16 v[156:159], a[8:11], v[188:191], 0
  s_waitcnt vmcnt(12) lgkmcnt(4)
  s_barrier
  v_mfma_f32_16x16x32_bf16 v[64:67], a[12:15], v[192:195], v[64:67]
  ds_read_b128 v[160:163], v18 offset:0
  v_max_f32 v56, v56, v57
  v_mfma_f32_16x16x32_bf16 v[68:71], a[16:19], v[192:195], v[68:71]
  v_mul_f32 v56, s83, v56
  v_fma_f32 v36, v36, s83, -v56
  v_mfma_f32_16x16x32_bf16 v[72:75], a[20:23], v[192:195], v[72:75]
  v_add_u32 v19, s33, v15
  s_add_u32 s33, s33, 16384
  v_mfma_f32_16x16x32_bf16 v[76:79], a[12:15], v[196:199], v[76:79]
  ds_read_b128 v[164:167], v18 offset:2048
  v_fma_f32 v37, v37, s83, -v56
  v_mfma_f32_16x16x32_bf16 v[80:83], a[16:19], v[196:199], v[80:83]
  buffer_load_dwordx4 v10, s[8:11], s30 offen offset:0 lds
  v_mfma_f32_16x16x32_bf16 v[84:87], a[20:23], v[196:199], v[84:87]
  s_cmp_lt_u32 s33, 98304
  s_cselect_b32 s33, s33, 0
  v_mfma_f32_16x16x32_bf16 v[88:91], a[12:15], v[200:203], v[88:91]
  ds_read_b128 v[168:171], v18 offset:4096
  v_fma_f32 v38, v38, s83, -v56
  v_mfma_f32_16x16x32_bf16 v[92:95], a[16:19], v[200:203], v[92:95]
  v_fma_f32 v39, v39, s83, -v56
  v_fma_f32 v40, v40, s83, -v56
  v_mfma_f32_16x16x32_bf16 v[96:99], a[20:23], v[200:203], v[96:99]
  v_fma_f32 v41, v41, s83, -v56
  v_fma_f32 v42, v42, s83, -v56
  v_mfma_f32_16x16x32_bf16 v[100:103], a[12:15], v[204:207], v[100:103]
  ds_read_b128 v[172:175], v18 offset:6144
  v_fma_f32 v43, v43, s83, -v56
  v_mfma_f32_16x16x32_bf16 v[104:107], a[16:19], v[204:207], v[104:107]
  v_exp_f32 v36, v36
  v_mfma_f32_16x16x32_bf16 v[108:111], a[20:23], v[204:207], v[108:111]
  s_waitcnt lgkmcnt(4)
  v_mfma_f32_16x16x32_bf16 v[112:115], a[12:15], v[208:211], v[112:115]
  ds_read_b128 v[176:179], v18 offset:8192
  v_mfma_f32_16x16x32_bf16 v[116:119], a[16:19], v[208:211], v[116:119]
  v_exp_f32 v37, v37
  v_mfma_f32_16x16x32_bf16 v[120:123], a[20:23], v[208:211], v[120:123]
  v_exp_f32 v38, v38
  v_mfma_f32_16x16x32_bf16 v[124:127], a[12:15], v[212:215], v[124:127]
  ds_read_b128 v[180:183], v18 offset:10240
  v_mfma_f32_16x16x32_bf16 v[128:131], a[16:19], v[212:215], v[128:131]
  buffer_load_dwordx4 v11, s[8:11], s30 offen offset:1024 lds
  v_mfma_f32_16x16x32_bf16 v[132:135], a[20:23], v[212:215], v[132:135]
  v_exp_f32 v39, v39
  v_mfma_f32_16x16x32_bf16 v[136:139], a[12:15], v[216:219], v[136:139]
  ds_read_b128 v[184:187], v18 offset:12288
  v_mfma_f32_16x16x32_bf16 v[140:143], a[16:19], v[216:219], v[140:143]
  v_exp_f32 v40, v40
  v_mfma_f32_16x16x32_bf16 v[144:147], a[20:23], v[216:219], v[144:147]
  v_exp_f32 v41, v41
  v_mfma_f32_16x16x32_bf16 v[148:151], a[12:15], v[220:223], v[148:151]
  ds_read_b128 v[188:191], v18 offset:14336
  v_mfma_f32_16x16x32_bf16 v[152:155], a[16:19], v[220:223], v[152:155]
  v_exp_f32 v42, v42
  v_mfma_f32_16x16x32_bf16 v[156:159], a[20:23], v[220:223], v[156:159]
  s_waitcnt lgkmcnt(4)
  v_mfma_f32_16x16x32_bf16 v[64:67], a[24:27], v[160:163], v[64:67]
  ds_read_b128 v[192:195], v19 offset:0
  v_mfma_f32_16x16x32_bf16 v[68:71], a[28:31], v[160:163], v[68:71]
  v_add_u32 v18, s33, v14
  v_mfma_f32_16x16x32_bf16 v[72:75], a[32:35], v[160:163], v[72:75]
  v_exp_f32 v43, v43
  v_mfma_f32_16x16x32_bf16 v[76:79], a[24:27], v[164:167], v[76:79]
  ds_read_b128 v[196:199], v19 offset:2048
  s_nop 0
  v_mfma_f32_16x16x32_bf16 v[80:83], a[28:31], v[164:167], v[80:83]
  buffer_load_dwordx4 v12, s[8:11], s30 offen offset:2048 lds
  v_mfma_f32_16x16x32_bf16 v[84:87], a[32:35], v[164:167], v[84:87]
  v_add_f32 v56, v40, v41
  v_add_f32 v56, v56, v42
  v_mfma_f32_16x16x32_bf16 v[88:91], a[24:27], v[168:171], v[88:91]
  ds_read_b128 v[200:203], v19 offset:4096
  v_add_f32 v56, v56, v43
  v_mfma_f32_16x16x32_bf16 v[92:95], a[28:31], v[168:171], v[92:95]
  v_cndmask_b32 v56, 0, v56, s[60:61]
  v_add_f32 v56, v56, v36
  v_mfma_f32_16x16x32_bf16 v[96:99], a[32:35], v[168:171], v[96:99]
  v_add_f32 v56, v56, v37
  v_add_f32 v56, v56, v38
  v_mfma_f32_16x16x32_bf16 v[100:103], a[24:27], v[172:175], v[100:103]
  ds_read_b128 v[204:207], v19 offset:6144
  v_add_f32 v56, v56, v39
  v_mfma_f32_16x16x32_bf16 v[104:107], a[28:31], v[172:175], v[104:107]
  v_mov_b32 v57, v56
  v_mfma_f32_16x16x32_bf16 v[108:111], a[32:35], v[172:175], v[108:111]
  s_waitcnt lgkmcnt(4)
  v_mfma_f32_16x16x32_bf16 v[112:115], a[24:27], v[176:179], v[112:115]
  ds_read_b128 v[208:211], v19 offset:8192
  v_mfma_f32_16x16x32_bf16 v[116:119], a[28:31], v[176:179], v[116:119]
  s_nop 1
  v_mfma_f32_16x16x32_bf16 v[120:123], a[32:35], v[176:179], v[120:123]
  v_permlane32_swap_b32 v56, v57
  v_mfma_f32_16x16x32_bf16 v[124:127], a[24:27], v[180:183], v[124:127]
  ds_read_b128 v[212:215], v19 offset:10240
  v_add_f32 v56, v56, v57
  v_mfma_f32_16x16x32_bf16 v[128:131], a[28:31], v[180:183], v[128:131]
  buffer_load_dwordx4 v13, s[8:11], s30 offen offset:3072 lds
  v_mfma_f32_16x16x32_bf16 v[132:135], a[32:35], v[180:183], v[132:135]
  s_add_u32 s30, s30, 128
  s_add_u32 m0, m0, 16384
  v_mfma_f32_16x16x32_bf16 v[136:139], a[24:27], v[184:187], v[136:139]
  ds_read_b128 v[216:219], v19 offset:12288
  v_mov_b32 v57, v56
  v_mfma_f32_16x16x32_bf16 v[140:143], a[28:31], v[184:187], v[140:143]
  s_cmp_lt_u32 m0, s46
  s_cselect_b32 m0, m0, s47
  v_mfma_f32_16x16x32_bf16 v[144:147], a[32:35], v[184:187], v[144:147]
  s_nop 1
  v_mfma_f32_16x16x32_bf16 v[148:151], a[24:27], v[188:191], v[148:151]
  ds_read_b128 v[220:223], v19 offset:14336
  v_mfma_f32_16x16x32_bf16 v[152:155], a[28:31], v[188:191], v[152:155]
  v_permlane16_swap_b32 v56, v57
  v_mfma_f32_16x16x32_bf16 v[156:159], a[32:35], v[188:191], v[156:159]
  s_waitcnt vmcnt(12) lgkmcnt(4)
  s_barrier
  v_mfma_f32_16x16x32_bf16 v[64:67], a[36:39], v[192:195], v[64:67]
  ds_read_b128 v[160:163], v18 offset:0
  v_add_f32 v56, v56, v57
  v_mfma_f32_16x16x32_bf16 v[68:71], a[40:43], v[192:195], v[68:71]
  v_rcp_f32 v56, v56
  v_mfma_f32_16x16x32_bf16 v[72:75], a[44:47], v[192:195], v[72:75]
  v_add_u32 v19, s33, v15
  s_add_u32 s33, s33, 16384
  v_mfma_f32_16x16x32_bf16 v[76:79], a[36:39], v[196:199], v[76:79]
  ds_read_b128 v[164:167], v18 offset:2048
  s_nop 0
  v_mfma_f32_16x16x32_bf16 v[80:83], a[40:43], v[196:199], v[80:83]
  buffer_load_dwordx4 v10, s[8:11], s30 offen offset:0 lds
  v_mfma_f32_16x16x32_bf16 v[84:87], a[44:47], v[196:199], v[84:87]
  s_cmp_lt_u32 s33, 98304
  s_cselect_b32 s33, s33, 0
  v_mfma_f32_16x16x32_bf16 v[88:91], a[36:39], v[200:203], v[88:91]
  ds_read_b128 v[168:171], v18 offset:4096
  v_mul_f32 v36, v36, v56
  v_mfma_f32_16x16x32_bf16 v[92:95], a[40:43], v[200:203], v[92:95]
  v_mul_f32 v37, v37, v56
  v_mul_f32 v38, v38, v56
  v_mfma_f32_16x16x32_bf16 v[96:99], a[44:47], v[200:203], v[96:99]
  v_mul_f32 v39, v39, v56
  v_mul_f32 v40, v40, v56
  v_mfma_f32_16x16x32_bf16 v[100:103], a[36:39], v[204:207], v[100:103]
  ds_read_b128 v[172:175], v18 offset:6144
  v_mul_f32 v41, v41, v56
  v_mfma_f32_16x16x32_bf16 v[104:107], a[40:43], v[204:207], v[104:107]
  v_mul_f32 v42, v42, v56
  v_mul_f32 v43, v43, v56
  v_mfma_f32_16x16x32_bf16 v[108:111], a[44:47], v[204:207], v[108:111]
  s_waitcnt lgkmcnt(4)
  v_max3_f32 v56, v44, v45, v46
  v_mfma_f32_16x16x32_bf16 v[112:115], a[36:39], v[208:211], v[112:115]
  ds_read_b128 v[176:179], v18 offset:8192
  v_max3_f32 v56, v56, v47, v48
  v_mfma_f32_16x16x32_bf16 v[116:119], a[40:43], v[208:211], v[116:119]
  v_max3_f32 v56, v56, v49, v50
  v_max3_f32 v56, v56, v51, v52
  v_mfma_f32_16x16x32_bf16 v[120:123], a[44:47], v[208:211], v[120:123]
  v_max3_f32 v56, v56, v53, v54
  v_max_f32 v56, v56, v55
  v_mfma_f32_16x16x32_bf16 v[124:127], a[36:39], v[212:215], v[124:127]
  ds_read_b128 v[180:183], v18 offset:10240
  v_mov_b32 v57, v56
  v_mfma_f32_16x16x32_bf16 v[128:131], a[40:43], v[212:215], v[128:131]
  buffer_load_dwordx4 v11, s[8:11], s30 offen offset:1024 lds
  v_mfma_f32_16x16x32_bf16 v[132:135], a[44:47], v[212:215], v[132:135]
  s_nop 1
  v_mfma_f32_16x16x32_bf16 v[136:139], a[36:39], v[216:219], v[136:139]
  ds_read_b128 v[184:187], v18 offset:12288
  v_mfma_f32_16x16x32_bf16 v[140:143], a[40:43], v[216:219], v[140:143]
  v_permlane32_swap_b32 v56, v57
  v_mfma_f32_16x16x32_bf16 v[144:147], a[44:47], v[216:219], v[144:147]
  v_max_f32 v56, v56, v57
  v_mov_b32 v57, v56
  v_mfma_f32_16x16x32_bf16 v[148:151], a[36:39], v[220:223], v[148:151]
  ds_read_b128 v[188:191], v18 offset:14336
  v_mfma_f32_16x16x32_bf16 v[152:155], a[40:43], v[220:223], v[152:155]
  s_nop 1
  v_mfma_f32_16x16x32_bf16 v[156:159], a[44:47], v[220:223], v[156:159]
  s_waitcnt lgkmcnt(4)
  v_mfma_f32_16x16x32_bf16 v[64:67], a[48:51], v[160:163], v[64:67]
  ds_read_b128 v[192:195], v19 offset:0
  v_mfma_f32_16x16x32_bf16 v[68:71], a[52:55], v[160:163], v[68:71]
  v_add_u32 v18, s33, v14
  v_mfma_f32_16x16x32_bf16 v[72:75], a[56:59], v[160:163], v[72:75]
  v_permlane16_swap_b32 v56, v57
  v_mfma_f32_16x16x32_bf16 v[76:79], a[48:51], v[164:167], v[76:79]
  ds_read_b128 v[196:199], v19 offset:2048
  v_max_f32 v56, v56, v57
  v_mfma_f32_16x16x32_bf16 v[80:83], a[52:55], v[164:167], v[80:83]
  buffer_load_dwordx4 v12, s[8:11], s30 offen offset:2048 lds
  v_mfma_f32_16x16x32_bf16 v[84:87], a[56:59], v[164:167], v[84:87]
  v_mul_f32 v56, s83, v56
  v_fma_f32 v44, v44, s83, -v56
  v_mfma_f32_16x16x32_bf16 v[88:91], a[48:51], v[168:171], v[88:91]
  ds_read_b128 v[200:203], v19 offset:4096
  v_fma_f32 v45, v45, s83, -v56
  v_mfma_f32_16x16x32_bf16 v[92:95], a[52:55], v[168:171], v[92:95]
  v_fma_f32 v46, v46, s83, -v56
  v_fma_f32 v47, v47, s83, -v56
  v_mfma_f32_16x16x32_bf16 v[96:99], a[56:59], v[168:171], v[96:99]
  v_fma_f32 v48, v48, s83, -v56
  v_fma_f32 v49, v49, s83, -v56
  v_mfma_f32_16x16x32_bf16 v[100:103], a[48:51], v[172:175], v[100:103]
  ds_read_b128 v[204:207], v19 offset:6144
  v_fma_f32 v50, v50, s83, -v56
  v_mfma_f32_16x16x32_bf16 v[104:107], a[52:55], v[172:175], v[104:107]
  v_fma_f32 v51, v51, s83, -v56
  v_fma_f32 v52, v52, s83, -v56
  v_mfma_f32_16x16x32_bf16 v[108:111], a[56:59], v[172:175], v[108:111]
  s_waitcnt lgkmcnt(4)
  v_fma_f32 v53, v53, s83, -v56
  v_mfma_f32_16x16x32_bf16 v[112:115], a[48:51], v[176:179], v[112:115]
  ds_read_b128 v[208:211], v19 offset:8192
  v_fma_f32 v54, v54, s83, -v56
  v_mfma_f32_16x16x32_bf16 v[116:119], a[52:55], v[176:179], v[116:119]
  v_fma_f32 v55, v55, s83, -v56
  v_mfma_f32_16x16x32_bf16 v[120:123], a[56:59], v[176:179], v[120:123]
  v_exp_f32 v44, v44
  v_mfma_f32_16x16x32_bf16 v[124:127], a[48:51], v[180:183], v[124:127]
  ds_read_b128 v[212:215], v19 offset:10240
  v_mfma_f32_16x16x32_bf16 v[128:131], a[52:55], v[180:183], v[128:131]
  buffer_load_dwordx4 v13, s[8:11], s30 offen offset:3072 lds
  v_mfma_f32_16x16x32_bf16 v[132:135], a[56:59], v[180:183], v[132:135]
  s_add_u32 s30, s30, 128
  s_add_u32 m0, m0, 16384
  v_mfma_f32_16x16x32_bf16 v[136:139], a[48:51], v[184:187], v[136:139]
  ds_read_b128 v[216:219], v19 offset:12288
  v_mfma_f32_16x16x32_bf16 v[140:143], a[52:55], v[184:187], v[140:143]
  s_cmp_lt_u32 m0, s46
  s_cselect_b32 m0, m0, s47
  v_mfma_f32_16x16x32_bf16 v[144:147], a[56:59], v[184:187], v[144:147]
  v_exp_f32 v45, v45
  v_mfma_f32_16x16x32_bf16 v[148:151], a[48:51], v[188:191], v[148:151]
  ds_read_b128 v[220:223], v19 offset:14336
  v_mfma_f32_16x16x32_bf16 v[152:155], a[52:55], v[188:191], v[152:155]
  v_exp_f32 v46, v46
  v_mfma_f32_16x16x32_bf16 v[156:159], a[56:59], v[188:191], v[156:159]
  s_waitcnt vmcnt(12) lgkmcnt(4)
  s_barrier
  v_mfma_f32_16x16x32_bf16 v[64:67], a[60:63], v[192:195], v[64:67]
  ds_read_b128 v[160:163], v18 offset:0
  v_mfma_f32_16x16x32_bf16 v[68:71], a[64:67], v[192:195], v[68:71]
  s_waitcnt vmcnt(10)
  s_cmp_eq_u32 s78, 0
  s_cbranch_scc1 pf_212
  v_mov_b32 v4, 0
  v_mov_b32 v5, 1
  s_mov_b64 exec, 1
  buffer_atomic_add v5, v4, s[72:75], s78 offen sc1
  s_mov_b64 exec, -1
  s_mov_b32 s78, 0
pf_212:
  s_mul_i32 s21, s49, 393216
  s_mul_i32 s22, s42, 12288
  s_add_u32 s50, s21, s22
  s_mul_i32 s21, s49, 98304
  s_mul_i32 s22, s42, 3072
  s_add_u32 s51, s21, s22
  s_lshr_b32 s22, s49, 1
  s_lshr_b32 s21, s49, 2
  s_add_u32 s21, s21, 3
  s_cmp_lt_u32 s49, 12
  s_cselect_b32 s21, s22, s21
  s_lshl_b32 s21, s21, 3
  s_lshr_b32 s22, s42, 2
  s_add_u32 s21, s21, s22
  s_lshl_b32 s21, s21, 7
  s_add_u32 s76, s21, 0
  s_lshl_b32 s77, s42, 7
  s_add_u32 s77, s77, 19456
  v_mov_b32 v4, 0
  buffer_load_dword v20, v4, s[72:75], s76 offen sc1
  v_mfma_f32_16x16x32_bf16 v[72:75], a[68:71], v[192:195], v[72:75]
  v_add_u32 v19, s33, v15
  s_add_u32 s33, s33, 16384
  v_mfma_f32_16x16x32_bf16 v[76:79], a[60:63], v[196:199], v[76:79]
  ds_read_b128 v[164:167], v18 offset:2048
  v_mfma_f32_16x16x32_bf16 v[80:83], a[64:67], v[196:199], v[80:83]
  buffer_load_dwordx4 v10, s[8:11], s30 offen offset:0 lds
  v_mfma_f32_16x16x32_bf16 v[84:87], a[68:71], v[196:199], v[84:87]
  s_cmp_lt_u32 s33, 98304
  s_cselect_b32 s33, s33, 0
  v_mfma_f32_16x16x32_bf16 v[88:91], a[60:63], v[200:203], v[88:91]
  ds_read_b128 v[168:171], v18 offset:4096
  v_mfma_f32_16x16x32_bf16 v[92:95], a[64:67], v[200:203], v[92:95]
  v_exp_f32 v47, v47
  v_mfma_f32_16x16x32_bf16 v[96:99], a[68:71], v[200:203], v[96:99]
  v_exp_f32 v48, v48
  v_mfma_f32_16x16x32_bf16 v[100:103], a[60:63], v[204:207], v[100:103]
  ds_read_b128 v[172:175], v18 offset:6144
  v_mfma_f32_16x16x32_bf16 v[104:107], a[64:67], v[204:207], v[104:107]
  v_exp_f32 v49, v49
  v_mfma_f32_16x16x32_bf16 v[108:111], a[68:71], v[204:207], v[108:111]
  s_waitcnt lgkmcnt(4)
  v_mfma_f32_16x16x32_bf16 v[112:115], a[60:63], v[208:211], v[112:115]
  ds_read_b128 v[176:179], v18 offset:8192
  v_mfma_f32_16x16x32_bf16 v[116:119], a[64:67], v[208:211], v[116:119]
  v_exp_f32 v50, v50
  v_mfma_f32_16x16x32_bf16 v[120:123], a[68:71], v[208:211], v[120:123]
  v_exp_f32 v51, v51
  v_mfma_f32_16x16x32_bf16 v[124:127], a[60:63], v[212:215], v[124:127]
  ds_read_b128 v[180:183], v18 offset:10240
  v_mfma_f32_16x16x32_bf16 v[128:131], a[64:67], v[212:215], v[128:131]
  buffer_load_dwordx4 v11, s[8:11], s30 offen offset:1024 lds
  v_mfma_f32_16x16x32_bf16 v[132:135], a[68:71], v[212:215], v[132:135]
  v_exp_f32 v52, v52
  v_mfma_f32_16x16x32_bf16 v[136:139], a[60:63], v[216:219], v[136:139]
  ds_read_b128 v[184:187], v18 offset:12288
  v_mfma_f32_16x16x32_bf16 v[140:143], a[64:67], v[216:219], v[140:143]
  v_exp_f32 v53, v53
  v_mfma_f32_16x16x32_bf16 v[144:147], a[68:71], v[216:219], v[144:147]
  v_exp_f32 v54, v54
  v_mfma_f32_16x16x32_bf16 v[148:151], a[60:63], v[220:223], v[148:151]
  ds_read_b128 v[188:191], v18 offset:14336
  v_mfma_f32_16x16x32_bf16 v[152:155], a[64:67], v[220:223], v[152:155]
  v_exp_f32 v55, v55
  v_mfma_f32_16x16x32_bf16 v[156:159], a[68:71], v[220:223], v[156:159]
  s_waitcnt lgkmcnt(4)
  s_nop 0
  v_mfma_f32_16x16x32_bf16 v[64:67], a[72:75], v[160:163], v[64:67]
  ds_read_b128 v[192:195], v19 offset:0
  v_add_f32 v56, v52, v53
  v_mfma_f32_16x16x32_bf16 v[68:71], a[76:79], v[160:163], v[68:71]
  v_add_u32 v18, s33, v14
  v_add_f32 v56, v56, v54
  v_mfma_f32_16x16x32_bf16 v[72:75], a[80:83], v[160:163], v[72:75]
  v_add_f32 v56, v56, v55
  v_cndmask_b32 v56, 0, v56, s[60:61]
  v_mfma_f32_16x16x32_bf16 v[76:79], a[72:75], v[164:167], v[76:79]
  ds_read_b128 v[196:199], v19 offset:2048
  v_add_f32 v56, v56, v44
  v_mfma_f32_16x16x32_bf16 v[80:83], a[76:79], v[164:167], v[80:83]
  buffer_load_dwordx4 v12, s[8:11], s30 offen offset:2048 lds
  v_mfma_f32_16x16x32_bf16 v[84:87], a[80:83], v[164:167], v[84:87]
  v_add_f32 v56, v56, v45
  v_add_f32 v56, v56, v46
  v_mfma_f32_16x16x32_bf16 v[88:91], a[72:75], v[168:171], v[88:91]
  ds_read_b128 v[200:203], v19 offset:4096
  v_add_f32 v56, v56, v47
  v_mfma_f32_16x16x32_bf16 v[92:95], a[76:79], v[168:171], v[92:95]
  v_add_f32 v56, v56, v48
  v_add_f32 v56, v56, v49
  v_mfma_f32_16x16x32_bf16 v[96:99], a[80:83], v[168:171], v[96:99]
  v_add_f32 v56, v56, v50
  v_add_f32 v56, v56, v51
  v_mfma_f32_16x16x32_bf16 v[100:103], a[72:75], v[172:175], v[100:103]
  ds_read_b128 v[204:207], v19 offset:6144
  v_mov_b32 v57, v56
  v_mfma_f32_16x16x32_bf16 v[104:107], a[76:79], v[172:175], v[104:107]
  s_nop 1
  v_mfma_f32_16x16x32_bf16 v[108:111], a[80:83], v[172:175], v[108:111]
  s_waitcnt lgkmcnt(4)
  v_mfma_f32_16x16x32_bf16 v[112:115], a[72:75], v[176:179], v[112:115]
  ds_read_b128 v[208:211], v19 offset:8192
  v_mfma_f32_16x16x32_bf16 v[116:119], a[76:79], v[176:179], v[116:119]
  v_permlane32_swap_b32 v56, v57
  v_mfma_f32_16x16x32_bf16 v[120:123], a[80:83], v[176:179], v[120:123]
  v_add_f32 v56, v56, v57
  v_mov_b32 v57, v56
  v_mfma_f32_16x16x32_bf16 v[124:127], a[72:75], v[180:183], v[124:127]
  ds_read_b128 v[212:215], v19 offset:10240
  v_mfma_f32_16x16x32_bf16 v[128:131], a[76:79], v[180:183], v[128:131]
  buffer_load_dwordx4 v13, s[8:11], s30 offen offset:3072 lds
  v_mfma_f32_16x16x32_bf16 v[132:135], a[80:83], v[180:183], v[132:135]
  s_add_u32 s30, s30, 128
  s_add_u32 m0, m0, 16384
  v_mfma_f32_16x16x32_bf16 v[136:139], a[72:75], v[184:187], v[136:139]
  ds_read_b128 v[216:219], v19 offset:12288
  v_mfma_f32_16x16x32_bf16 v[140:143], a[76:79], v[184:187], v[140:143]
  s_cmp_lt_u32 m0, s46
  s_cselect_b32 m0, m0, s47
  v_mfma_f32_16x16x32_bf16 v[144:147], a[80:83], v[184:187], v[144:147]
  s_nop 1
  v_mfma_f32_16x16x32_bf16 v[148:151], a[72:75], v[188:191], v[148:151]
  ds_read_b128 v[220:223], v19 offset:14336
  v_mfma_f32_16x16x32_bf16 v[152:155], a[76:79], v[188:191], v[152:155]
  v_permlane16_swap_b32 v56, v57
  v_mfma_f32_16x16x32_bf16 v[156:159], a[80:83], v[188:191], v[156:159]
  s_waitcnt vmcnt(13) lgkmcnt(4)
  s_barrier
  v_mfma_f32_16x16x32_bf16 v[64:67], a[84:87], v[192:195], v[64:67]
  ds_read_b128 v[160:163], v18 offset:0
  v_add_f32 v56, v56, v57
  v_mfma_f32_16x16x32_bf16 v[68:71], a[88:91], v[192:195], v[68:71]
  v_rcp_f32 v56, v56
  v_mfma_f32_16x16x32_bf16 v[72:75], a[92:95], v[192:195], v[72:75]
  v_add_u32 v19, s33, v15
  s_add_u32 s33, s33, 16384
  v_mfma_f32_16x16x32_bf16 v[76:79], a[84:87], v[196:199], v[76:79]
  ds_read_b128 v[164:167], v18 offset:2048
  s_nop 0
  v_mfma_f32_16x16x32_bf16 v[80:83], a[88:91], v[196:199], v[80:83]
  buffer_load_dwordx4 v10, s[8:11], s30 offen offset:0 lds
  v_mfma_f32_16x16x32_bf16 v[84:87], a[92:95], v[196:199], v[84:87]
  s_cmp_lt_u32 s33, 98304
  s_cselect_b32 s33, s33, 0
  v_mfma_f32_16x16x32_bf16 v[88:91], a[84:87], v[200:203], v[88:91]
  ds_read_b128 v[168:171], v18 offset:4096
  v_mul_f32 v44, v44, v56
  v_mfma_f32_16x16x32_bf16 v[92:95], a[88:91], v[200:203], v[92:95]
  v_mul_f32 v45, v45, v56
  v_mul_f32 v46, v46, v56
  v_mfma_f32_16x16x32_bf16 v[96:99], a[92:95], v[200:203], v[96:99]
  v_mul_f32 v47, v47, v56
  v_mul_f32 v48, v48, v56
  v_mfma_f32_16x16x32_bf16 v[100:103], a[84:87], v[204:207], v[100:103]
  ds_read_b128 v[172:175], v18 offset:6144
  v_mul_f32 v49, v49, v56
  v_mfma_f32_16x16x32_bf16 v[104:107], a[88:91], v[204:207], v[104:107]
  v_mul_f32 v50, v50, v56
  v_mul_f32 v51, v51, v56
  v_mfma_f32_16x16x32_bf16 v[108:111], a[92:95], v[204:207], v[108:111]
  s_waitcnt lgkmcnt(4)
  v_mul_f32 v52, v52, v56
  v_mfma_f32_16x16x32_bf16 v[112:115], a[84:87], v[208:211], v[112:115]
  ds_read_b128 v[176:179], v18 offset:8192
  v_mul_f32 v53, v53, v56
  v_mfma_f32_16x16x32_bf16 v[116:119], a[88:91], v[208:211], v[116:119]
  v_mul_f32 v54, v54, v56
  v_mul_f32 v55, v55, v56
  v_mfma_f32_16x16x32_bf16 v[120:123], a[92:95], v[208:211], v[120:123]
  v_cvt_pk_bf16_f32 v240, v40, v41
  v_cvt_pk_bf16_f32 v241, v42, v43
  v_mfma_f32_16x16x32_bf16 v[124:127], a[84:87], v[212:215], v[124:127]
  ds_read_b128 v[180:183], v18 offset:10240
  v_cvt_pk_bf16_f32 v242, v52, v53
  v_mfma_f32_16x16x32_bf16 v[128:131], a[88:91], v[212:215], v[128:131]
  buffer_load_dwordx4 v11, s[8:11], s30 offen offset:1024 lds
  v_mfma_f32_16x16x32_bf16 v[132:135], a[92:95], v[212:215], v[132:135]
  v_cvt_pk_bf16_f32 v243, v54, v55
  v_cvt_pk_bf16_f32 v236, v44, v45
  v_mfma_f32_16x16x32_bf16 v[136:139], a[84:87], v[216:219], v[136:139]
  ds_read_b128 v[184:187], v18 offset:12288
  v_cvt_pk_bf16_f32 v237, v46, v47
  v_mfma_f32_16x16x32_bf16 v[140:143], a[88:91], v[216:219], v[140:143]
  v_cvt_pk_bf16_f32 v238, v48, v49
  v_cvt_pk_bf16_f32 v239, v50, v51
  v_mfma_f32_16x16x32_bf16 v[144:147], a[92:95], v[216:219], v[144:147]
  v_cvt_pk_bf16_f32 v244, v36, v37
  v_cvt_pk_bf16_f32 v245, v38, v39
  v_mfma_f32_16x16x32_bf16 v[148:151], a[84:87], v[220:223], v[148:151]
  ds_read_b128 v[188:191], v18 offset:14336
  v_mfma_f32_16x16x32_bf16 v[152:155], a[88:91], v[220:223], v[152:155]
  v_permlane16_swap_b32 v240, v242
  v_mfma_f32_16x16x32_bf16 v[156:159], a[92:95], v[220:223], v[156:159]
  s_waitcnt lgkmcnt(4)
  v_mfma_f32_16x16x32_bf16 v[64:67], a[96:99], v[160:163], v[64:67]
  ds_read_b128 v[192:195], v19 offset:0
  v_mfma_f32_16x16x32_bf16 v[68:71], a[100:103], v[160:163], v[68:71]
  v_add_u32 v18, s33, v14
  v_mfma_f32_16x16x32_bf16 v[72:75], a[104:107], v[160:163], v[72:75]
  v_permlane16_swap_b32 v241, v243
  v_mfma_f32_16x16x32_bf16 v[76:79], a[96:99], v[164:167], v[76:79]
  ds_read_b128 v[196:199], v19 offset:2048
  v_mfma_f32_16x16x32_bf16 v[80:83], a[100:103], v[164:167], v[80:83]
  buffer_load_dwordx4 v12, s[8:11], s30 offen offset:2048 lds
  v_mfma_f32_16x16x32_bf16 v[84:87], a[104:107], v[164:167], v[84:87]
  v_mfma_f32_16x16x32_bf16 v[88:91], a[96:99], v[168:171], v[88:91]
  ds_read_b128 v[200:203], v19 offset:4096
  v_mfma_f32_16x16x32_bf16 v[92:95], a[100:103], v[168:171], v[92:95]
  v_mfma_f32_16x16x32_bf16 v[96:99], a[104:107], v[168:171], v[96:99]
  v_mfma_f32_16x16x32_bf16 v[100:103], a[96:99], v[172:175], v[100:103]
  ds_read_b128 v[204:207], v19 offset:6144
  v_mfma_f32_16x16x32_bf16 v[104:107], a[100:103], v[172:175], v[104:107]
  v_mfma_f32_16x16x32_bf16 v[108:111], a[104:107], v[172:175], v[108:111]
  s_waitcnt lgkmcnt(4)
  v_mfma_f32_16x16x32_bf16 v[112:115], a[96:99], v[176:179], v[112:115]
  ds_read_b128 v[208:211], v19 offset:8192
  v_mfma_f32_16x16x32_bf16 v[116:119], a[100:103], v[176:179], v[116:119]
  v_mfma_f32_16x16x32_bf16 v[120:123], a[104:107], v[176:179], v[120:123]
  v_mfma_f32_16x16x32_bf16 v[124:127], a[96:99], v[180:183], v[124:127]
  ds_read_b128 v[212:215], v19 offset:10240
  v_mfma_f32_16x16x32_bf16 v[128:131], a[100:103], v[180:183], v[128:131]
  buffer_load_dwordx4 v13, s[8:11], s30 offen offset:3072 lds
  v_mfma_f32_16x16x32_bf16 v[132:135], a[104:107], v[180:183], v[132:135]
  s_add_u32 s30, s30, 128
  s_add_u32 m0, m0, 16384
  v_mfma_f32_16x16x32_bf16 v[136:139], a[96:99], v[184:187], v[136:139]
  ds_read_b128 v[216:219], v19 offset:12288
  v_mfma_f32_16x16x32_bf16 v[140:143], a[100:103], v[184:187], v[140:143]
  s_cmp_lt_u32 m0, s46
  s_cselect_b32 m0, m0, s47
  v_mfma_f32_16x16x32_bf16 v[144:147], a[104:107], v[184:187], v[144:147]
  v_mfma_f32_16x16x32_bf16 v[148:151], a[96:99], v[188:191], v[148:151]
  ds_read_b128 v[220:223], v19 offset:14336
  v_mfma_f32_16x16x32_bf16 v[152:155], a[100:103], v[188:191], v[152:155]
  v_mfma_f32_16x16x32_bf16 v[156:159], a[104:107], v[188:191], v[156:159]
  s_waitcnt vmcnt(13) lgkmcnt(4)
  s_barrier
  v_mfma_f32_16x16x32_bf16 v[64:67], a[108:111], v[192:195], v[64:67]
  ds_read_b128 v[160:163], v18 offset:0
  v_mfma_f32_16x16x32_bf16 v[68:71], a[112:115], v[192:195], v[68:71]
  v_mfma_f32_16x16x32_bf16 v[72:75], a[116:119], v[192:195], v[72:75]
  v_add_u32 v19, s33, v15
  s_add_u32 s33, s33, 16384
  v_mfma_f32_16x16x32_bf16 v[76:79], a[108:111], v[196:199], v[76:79]
  ds_read_b128 v[164:167], v18 offset:2048
  v_mfma_f32_16x16x32_bf16 v[80:83], a[112:115], v[196:199], v[80:83]
  buffer_load_dwordx4 v10, s[8:11], s30 offen offset:0 lds
  v_mfma_f32_16x16x32_bf16 v[84:87], a[116:119], v[196:199], v[84:87]
  s_cmp_lt_u32 s33, 98304
  s_cselect_b32 s33, s33, 0
  v_mfma_f32_16x16x32_bf16 v[88:91], a[108:111], v[200:203], v[88:91]
  ds_read_b128 v[168:171], v18 offset:4096
  v_mfma_f32_16x16x32_bf16 v[92:95], a[112:115], v[200:203], v[92:95]
  v_mfma_f32_16x16x32_bf16 v[96:99], a[116:119], v[200:203], v[96:99]
  v_mfma_f32_16x16x32_bf16 v[100:103], a[108:111], v[204:207], v[100:103]
  ds_read_b128 v[172:175], v18 offset:6144
  v_mfma_f32_16x16x32_bf16 v[104:107], a[112:115], v[204:207], v[104:107]
  v_mfma_f32_16x16x32_bf16 v[108:111], a[116:119], v[204:207], v[108:111]
  s_waitcnt lgkmcnt(4)
  v_mfma_f32_16x16x32_bf16 v[112:115], a[108:111], v[208:211], v[112:115]
  ds_read_b128 v[176:179], v18 offset:8192
  v_mfma_f32_16x16x32_bf16 v[116:119], a[112:115], v[208:211], v[116:119]
  v_mfma_f32_16x16x32_bf16 v[120:123], a[116:119], v[208:211], v[120:123]
  v_mfma_f32_16x16x32_bf16 v[124:127], a[108:111], v[212:215], v[124:127]
  ds_read_b128 v[180:183], v18 offset:10240
  v_mfma_f32_16x16x32_bf16 v[128:131], a[112:115], v[212:215], v[128:131]
  buffer_load_dwordx4 v11, s[8:11], s30 offen offset:1024 lds
  v_mfma_f32_16x16x32_bf16 v[132:135], a[116:119], v[212:215], v[132:135]
  v_mfma_f32_16x16x32_bf16 v[136:139], a[108:111], v[216:219], v[136:139]
  ds_read_b128 v[184:187], v18 offset:12288
  v_mfma_f32_16x16x32_bf16 v[140:143], a[112:115], v[216:219], v[140:143]
  v_mfma_f32_16x16x32_bf16 v[144:147], a[116:119], v[216:219], v[144:147]
  v_mfma_f32_16x16x32_bf16 v[148:151], a[108:111], v[220:223], v[148:151]
  ds_read_b128 v[188:191], v18 offset:14336
  v_mfma_f32_16x16x32_bf16 v[152:155], a[112:115], v[220:223], v[152:155]
  v_mfma_f32_16x16x32_bf16 v[156:159], a[116:119], v[220:223], v[156:159]
  s_waitcnt lgkmcnt(4)
  v_mfma_f32_16x16x32_bf16 v[64:67], a[120:123], v[160:163], v[64:67]
  ds_read_b128 v[192:195], v19 offset:0
  v_mfma_f32_16x16x32_bf16 v[68:71], a[124:127], v[160:163], v[68:71]
  v_add_u32 v18, s33, v14
  v_mfma_f32_16x16x32_bf16 v[72:75], a[128:131], v[160:163], v[72:75]
  v_mfma_f32_16x16x32_bf16 v[76:79], a[120:123], v[164:167], v[76:79]
  ds_read_b128 v[196:199], v19 offset:2048
  v_mfma_f32_16x16x32_bf16 v[80:83], a[124:127], v[164:167], v[80:83]
  buffer_load_dwordx4 v12, s[8:11], s30 offen offset:2048 lds
  v_mfma_f32_16x16x32_bf16 v[84:87], a[128:131], v[164:167], v[84:87]
  v_mfma_f32_16x16x32_bf16 v[88:91], a[120:123], v[168:171], v[88:91]
  ds_read_b128 v[200:203], v19 offset:4096
  v_mfma_f32_16x16x32_bf16 v[92:95], a[124:127], v[168:171], v[92:95]
  v_mfma_f32_16x16x32_bf16 v[96:99], a[128:131], v[168:171], v[96:99]
  v_mfma_f32_16x16x32_bf16 v[100:103], a[120:123], v[172:175], v[100:103]
  ds_read_b128 v[204:207], v19 offset:6144
  v_mfma_f32_16x16x32_bf16 v[104:107], a[124:127], v[172:175], v[104:107]
  v_mfma_f32_16x16x32_bf16 v[108:111], a[128:131], v[172:175], v[108:111]
  s_waitcnt lgkmcnt(4)
  v_mfma_f32_16x16x32_bf16 v[112:115], a[120:123], v[176:179], v[112:115]
  ds_read_b128 v[208:211], v19 offset:8192
  v_mfma_f32_16x16x32_bf16 v[116:119], a[124:127], v[176:179], v[116:119]
  v_mfma_f32_16x16x32_bf16 v[120:123], a[128:131], v[176:179], v[120:123]
  v_mfma_f32_16x16x32_bf16 v[124:127], a[120:123], v[180:183], v[124:127]
  ds_read_b128 v[212:215], v19 offset:10240
  v_mfma_f32_16x16x32_bf16 v[128:131], a[124:127], v[180:183], v[128:131]
  buffer_load_dwordx4 v13, s[8:11], s30 offen offset:3072 lds
  v_mfma_f32_16x16x32_bf16 v[132:135], a[128:131], v[180:183], v[132:135]
  s_add_u32 s30, s30, s25
  s_sub_u32 s30, s30, 1152
  v_mfma_f32_16x16x32_bf16 v[136:139], a[120:123], v[184:187], v[136:139]
  ds_read_b128 v[216:219], v19 offset:12288
  s_mov_b32 s25, 163840
  v_mfma_f32_16x16x32_bf16 v[140:143], a[124:127], v[184:187], v[140:143]
  s_add_u32 m0, m0, 16384
  v_mfma_f32_16x16x32_bf16 v[144:147], a[128:131], v[184:187], v[144:147]
  s_cmp_lt_u32 m0, s46
  s_cselect_b32 m0, m0, s47
  v_mfma_f32_16x16x32_bf16 v[148:151], a[120:123], v[188:191], v[148:151]
  ds_read_b128 v[220:223], v19 offset:14336
  v_mfma_f32_16x16x32_bf16 v[152:155], a[124:127], v[188:191], v[152:155]
  v_mfma_f32_16x16x32_bf16 v[156:159], a[128:131], v[188:191], v[156:159]
  s_waitcnt vmcnt(13) lgkmcnt(4)
  s_barrier
  v_mfma_f32_16x16x32_bf16 v[64:67], a[132:135], v[192:195], v[64:67]
  ds_read_b128 v[160:163], v18 offset:0
  v_mfma_f32_16x16x32_bf16 v[68:71], a[136:139], v[192:195], v[68:71]
  buffer_store_dwordx4 v[236:239], v30, s[56:59], s81 offen sc1
  s_mov_b64 exec, 0xffffffff
  buffer_store_dwordx4 v[240:243], v30, s[56:59], s81 offen offset:1024 sc1
  s_mov_b64 exec, -1
  buffer_store_dwordx2 v[244:245], v32, s[56:59], s81 offen offset:2048 sc1
  s_mov_b32 s78, s82
  s_mov_b32 s82, 0
  s_mov_b32 s81, 0x80000000
  v_mfma_f32_16x16x32_bf16 v[72:75], a[140:143], v[192:195], v[72:75]
  v_add_u32 v19, s33, v15
  s_add_u32 s33, s33, 16384
  v_mfma_f32_16x16x32_bf16 v[76:79], a[132:135], v[196:199], v[76:79]
  ds_read_b128 v[164:167], v18 offset:2048
  v_mfma_f32_16x16x32_bf16 v[80:83], a[136:139], v[196:199], v[80:83]
  buffer_load_dwordx4 v10, s[8:11], s30 offen offset:0 lds
  v_mfma_f32_16x16x32_bf16 v[84:87], a[140:143], v[196:199], v[84:87]
  s_cmp_lt_u32 s33, 98304
  s_cselect_b32 s33, s33, 0
  v_mfma_f32_16x16x32_bf16 v[88:91], a[132:135], v[200:203], v[88:91]
  ds_read_b128 v[168:171], v18 offset:4096
  v_mfma_f32_16x16x32_bf16 v[92:95], a[136:139], v[200:203], v[92:95]
  v_mfma_f32_16x16x32_bf16 v[96:99], a[140:143], v[200:203], v[96:99]
  v_mfma_f32_16x16x32_bf16 v[100:103], a[132:135], v[204:207], v[100:103]
  ds_read_b128 v[172:175], v18 offset:6144
  v_mfma_f32_16x16x32_bf16 v[104:107], a[136:139], v[204:207], v[104:107]
  v_mfma_f32_16x16x32_bf16 v[108:111], a[140:143], v[204:207], v[108:111]
  s_waitcnt lgkmcnt(4)
  v_mfma_f32_16x16x32_bf16 v[112:115], a[132:135], v[208:211], v[112:115]
  ds_read_b128 v[176:179], v18 offset:8192
  v_mfma_f32_16x16x32_bf16 v[116:119], a[136:139], v[208:211], v[116:119]
  v_mfma_f32_16x16x32_bf16 v[120:123], a[140:143], v[208:211], v[120:123]
  v_mfma_f32_16x16x32_bf16 v[124:127], a[132:135], v[212:215], v[124:127]
  ds_read_b128 v[180:183], v18 offset:10240
  v_mfma_f32_16x16x32_bf16 v[128:131], a[136:139], v[212:215], v[128:131]
  buffer_load_dwordx4 v11, s[8:11], s30 offen offset:1024 lds
  v_mfma_f32_16x16x32_bf16 v[132:135], a[140:143], v[212:215], v[132:135]
  v_mfma_f32_16x16x32_bf16 v[136:139], a[132:135], v[216:219], v[136:139]
  ds_read_b128 v[184:187], v18 offset:12288
  v_mfma_f32_16x16x32_bf16 v[140:143], a[136:139], v[216:219], v[140:143]
  v_mfma_f32_16x16x32_bf16 v[144:147], a[140:143], v[216:219], v[144:147]
  v_mfma_f32_16x16x32_bf16 v[148:151], a[132:135], v[220:223], v[148:151]
  ds_read_b128 v[188:191], v18 offset:14336
  v_mfma_f32_16x16x32_bf16 v[152:155], a[136:139], v[220:223], v[152:155]
  v_mfma_f32_16x16x32_bf16 v[156:159], a[140:143], v[220:223], v[156:159]
  s_waitcnt lgkmcnt(4)
  v_mfma_f32_16x16x32_bf16 v[64:67], a[144:147], v[160:163], v[64:67]
  ds_read_b128 v[192:195], v19 offset:0
  v_mfma_f32_16x16x32_bf16 v[68:71], a[148:151], v[160:163], v[68:71]
  v_add_u32 v18, s33, v14
  v_mfma_f32_16x16x32_bf16 v[72:75], a[152:155], v[160:163], v[72:75]
  v_mfma_f32_16x16x32_bf16 v[76:79], a[144:147], v[164:167], v[76:79]
  ds_read_b128 v[196:199], v19 offset:2048
  v_mfma_f32_16x16x32_bf16 v[80:83], a[148:151], v[164:167], v[80:83]
  buffer_load_dwordx4 v12, s[8:11], s30 offen offset:2048 lds
  v_mfma_f32_16x16x32_bf16 v[84:87], a[152:155], v[164:167], v[84:87]
  v_mfma_f32_16x16x32_bf16 v[88:91], a[144:147], v[168:171], v[88:91]
  ds_read_b128 v[200:203], v19 offset:4096
  v_mfma_f32_16x16x32_bf16 v[92:95], a[148:151], v[168:171], v[92:95]
  v_mfma_f32_16x16x32_bf16 v[96:99], a[152:155], v[168:171], v[96:99]
  v_mfma_f32_16x16x32_bf16 v[100:103], a[144:147], v[172:175], v[100:103]
  ds_read_b128 v[204:207], v19 offset:6144
  v_mfma_f32_16x16x32_bf16 v[104:107], a[148:151], v[172:175], v[104:107]
  v_mfma_f32_16x16x32_bf16 v[108:111], a[152:155], v[172:175], v[108:111]
  s_waitcnt lgkmcnt(4)
  v_mfma_f32_16x16x32_bf16 v[112:115], a[144:147], v[176:179], v[112:115]
  ds_read_b128 v[208:211], v19 offset:8192
  v_mfma_f32_16x16x32_bf16 v[116:119], a[148:151], v[176:179], v[116:119]
  v_mfma_f32_16x16x32_bf16 v[120:123], a[152:155], v[176:179], v[120:123]
  v_mfma_f32_16x16x32_bf16 v[124:127], a[144:147], v[180:183], v[124:127]
  ds_read_b128 v[212:215], v19 offset:10240
  v_mfma_f32_16x16x32_bf16 v[128:131], a[148:151], v[180:183], v[128:131]
  buffer_load_dwordx4 v13, s[8:11], s30 offen offset:3072 lds
  v_mfma_f32_16x16x32_bf16 v[132:135], a[152:155], v[180:183], v[132:135]
  s_add_u32 s30, s30, 128
  s_add_u32 m0, m0, 16384
  v_mfma_f32_16x16x32_bf16 v[136:139], a[144:147], v[184:187], v[136:139]
  ds_read_b128 v[216:219], v19 offset:12288
  v_mfma_f32_16x16x32_bf16 v[140:143], a[148:151], v[184:187], v[140:143]
  s_cmp_lt_u32 m0, s46
  s_cselect_b32 m0, m0, s47
  v_mfma_f32_16x16x32_bf16 v[144:147], a[152:155], v[184:187], v[144:147]
  v_mfma_f32_16x16x32_bf16 v[148:151], a[144:147], v[188:191], v[148:151]
  ds_read_b128 v[220:223], v19 offset:14336
  v_mfma_f32_16x16x32_bf16 v[152:155], a[148:151], v[188:191], v[152:155]
  v_mfma_f32_16x16x32_bf16 v[156:159], a[152:155], v[188:191], v[156:159]
  s_waitcnt vmcnt(15) lgkmcnt(4)
  s_barrier
  v_mfma_f32_16x16x32_bf16 v[64:67], a[156:159], v[192:195], v[64:67]
  ds_read_b128 v[160:163], v18 offset:0
  v_mfma_f32_16x16x32_bf16 v[68:71], a[160:163], v[192:195], v[68:71]
  v_readfirstlane_b32 s79, v20
  v_mfma_f32_16x16x32_bf16 v[72:75], a[164:167], v[192:195], v[72:75]
  v_add_u32 v19, s33, v15
  s_add_u32 s33, s33, 16384
  v_mfma_f32_16x16x32_bf16 v[76:79], a[156:159], v[196:199], v[76:79]
  ds_read_b128 v[164:167], v18 offset:2048
  s_add_u32 s21, s50, 0
  v_mfma_f32_16x16x32_bf16 v[80:83], a[160:163], v[196:199], v[80:83]
  buffer_load_dwordx4 v10, s[8:11], s30 offen offset:0 lds
  v_mfma_f32_16x16x32_bf16 v[84:87], a[164:167], v[196:199], v[84:87]
  s_cmp_lt_u32 s33, 98304
  s_cselect_b32 s33, s33, 0
  v_mfma_f32_16x16x32_bf16 v[88:91], a[156:159], v[200:203], v[88:91]
  ds_read_b128 v[168:171], v18 offset:4096
  v_mfma_f32_16x16x32_bf16 v[92:95], a[160:163], v[200:203], v[92:95]
  buffer_load_dwordx4 v[36:39], v30, s[16:19], s21 offen offset:0 sc1
  v_mfma_f32_16x16x32_bf16 v[96:99], a[164:167], v[200:203], v[96:99]
  v_mfma_f32_16x16x32_bf16 v[100:103], a[156:159], v[204:207], v[100:103]
  ds_read_b128 v[172:175], v18 offset:6144
  v_mfma_f32_16x16x32_bf16 v[104:107], a[160:163], v[204:207], v[104:107]
  v_mfma_f32_16x16x32_bf16 v[108:111], a[164:167], v[204:207], v[108:111]
  s_waitcnt lgkmcnt(4)
  v_mfma_f32_16x16x32_bf16 v[112:115], a[156:159], v[208:211], v[112:115]
  ds_read_b128 v[176:179], v18 offset:8192
  v_mfma_f32_16x16x32_bf16 v[116:119], a[160:163], v[208:211], v[116:119]
  buffer_load_dwordx4 v[40:43], v30, s[16:19], s21 offen offset:1024 sc1
  v_mfma_f32_16x16x32_bf16 v[120:123], a[164:167], v[208:211], v[120:123]
  v_mfma_f32_16x16x32_bf16 v[124:127], a[156:159], v[212:215], v[124:127]
  ds_read_b128 v[180:183], v18 offset:10240
  v_mfma_f32_16x16x32_bf16 v[128:131], a[160:163], v[212:215], v[128:131]
  buffer_load_dwordx4 v11, s[8:11], s30 offen offset:1024 lds
  v_mfma_f32_16x16x32_bf16 v[132:135], a[164:167], v[212:215], v[132:135]
  v_mfma_f32_16x16x32_bf16 v[136:139], a[156:159], v[216:219], v[136:139]
  ds_read_b128 v[184:187], v18 offset:12288
  v_mfma_f32_16x16x32_bf16 v[140:143], a[160:163], v[216:219], v[140:143]
  buffer_load_dwordx4 v[44:47], v30, s[16:19], s21 offen offset:2048 sc1
  v_mfma_f32_16x16x32_bf16 v[144:147], a[164:167], v[216:219], v[144:147]
  v_mfma_f32_16x16x32_bf16 v[148:151], a[156:159], v[220:223], v[148:151]
  ds_read_b128 v[188:191], v18 offset:14336
  v_mfma_f32_16x16x32_bf16 v[152:155], a[160:163], v[220:223], v[152:155]
  v_mfma_f32_16x16x32_bf16 v[156:159], a[164:167], v[220:223], v[156:159]
  s_waitcnt lgkmcnt(4)
  v_mfma_f32_16x16x32_bf16 v[64:67], a[168:171], v[160:163], v[64:67]
  ds_read_b128 v[192:195], v19 offset:0
  v_mfma_f32_16x16x32_bf16 v[68:71], a[172:175], v[160:163], v[68:71]
  v_add_u32 v18, s33, v14
  v_mfma_f32_16x16x32_bf16 v[72:75], a[176:179], v[160:163], v[72:75]
  buffer_load_dwordx4 v[48:51], v30, s[16:19], s21 offen offset:3072 sc1
  v_mfma_f32_16x16x32_bf16 v[76:79], a[168:171], v[164:167], v[76:79]
  ds_read_b128 v[196:199], v19 offset:2048
  v_mfma_f32_16x16x32_bf16 v[80:83], a[172:175], v[164:167], v[80:83]
  buffer_load_dwordx4 v12, s[8:11], s30 offen offset:2048 lds
  v_mfma_f32_16x16x32_bf16 v[84:87], a[176:179], v[164:167], v[84:87]
  v_mfma_f32_16x16x32_bf16 v[88:91], a[168:171], v[168:171], v[88:91]
  ds_read_b128 v[200:203], v19 offset:4096
  v_mfma_f32_16x16x32_bf16 v[92:95], a[172:175], v[168:171], v[92:95]
  s_add_u32 s21, s50, 4096
  v_mfma_f32_16x16x32_bf16 v[96:99], a[176:179], v[168:171], v[96:99]
  buffer_load_dwordx4 v[52:55], v30, s[16:19], s21 offen offset:0 sc1
  v_mfma_f32_16x16x32_bf16 v[100:103], a[168:171], v[172:175], v[100:103]
  ds_read_b128 v[204:207], v19 offset:6144
  v_mfma_f32_16x16x32_bf16 v[104:107], a[172:175], v[172:175], v[104:107]
  v_mfma_f32_16x16x32_bf16 v[108:111], a[176:179], v[172:175], v[108:111]
  s_waitcnt lgkmcnt(4)
  v_mfma_f32_16x16x32_bf16 v[112:115], a[168:171], v[176:179], v[112:115]
  ds_read_b128 v[208:211], v19 offset:8192
  v_mfma_f32_16x16x32_bf16 v[116:119], a[172:175], v[176:179], v[116:119]
  buffer_load_dwordx4 v[56:59], v30, s[16:19], s21 offen offset:1024 sc1
  v_mfma_f32_16x16x32_bf16 v[120:123], a[176:179], v[176:179], v[120:123]
  v_mfma_f32_16x16x32_bf16 v[124:127], a[168:171], v[180:183], v[124:127]
  ds_read_b128 v[212:215], v19 offset:10240
  v_mfma_f32_16x16x32_bf16 v[128:131], a[172:175], v[180:183], v[128:131]
  buffer_load_dwordx4 v13, s[8:11], s30 offen offset:3072 lds
  v_mfma_f32_16x16x32_bf16 v[132:135], a[176:179], v[180:183], v[132:135]
  s_add_u32 s30, s30, 128
  s_add_u32 m0, m0, 16384
  v_mfma_f32_16x16x32_bf16 v[136:139], a[168:171], v[184:187], v[136:139]
  ds_read_b128 v[216:219], v19 offset:12288
  v_mfma_f32_16x16x32_bf16 v[140:143], a[172:175], v[184:187], v[140:143]
  s_cmp_lt_u32 m0, s46
  s_cselect_b32 m0, m0, s47
  v_mfma_f32_16x16x32_bf16 v[144:147], a[176:179], v[184:187], v[144:147]
  buffer_load_dwordx4 v[60:63], v30, s[16:19], s21 offen offset:2048 sc1
  v_mfma_f32_16x16x32_bf16 v[148:151], a[168:171], v[188:191], v[148:151]
  ds_read_b128 v[220:223], v19 offset:14336
  v_mfma_f32_16x16x32_bf16 v[152:155], a[172:175], v[188:191], v[152:155]
  v_mfma_f32_16x16x32_bf16 v[156:159], a[176:179], v[188:191], v[156:159]
  s_waitcnt vmcnt(22) lgkmcnt(4)
  s_barrier
  v_mfma_f32_16x16x32_bf16 v[64:67], a[180:183], v[192:195], v[64:67]
  ds_read_b128 v[160:163], v18 offset:0
  v_mfma_f32_16x16x32_bf16 v[68:71], a[184:187], v[192:195], v[68:71]
  buffer_load_dwordx4 v[236:239], v30, s[16:19], s21 offen offset:3072 sc1
  v_mfma_f32_16x16x32_bf16 v[72:75], a[188:191], v[192:195], v[72:75]
  v_add_u32 v19, s33, v15
  s_add_u32 s33, s33, 16384
  v_mfma_f32_16x16x32_bf16 v[76:79], a[180:183], v[196:199], v[76:79]
  ds_read_b128 v[164:167], v18 offset:2048
  v_mfma_f32_16x16x32_bf16 v[80:83], a[184:187], v[196:199], v[80:83]
  buffer_load_dwordx4 v10, s[8:11], s30 offen offset:0 lds
  v_mfma_f32_16x16x32_bf16 v[84:87], a[188:191], v[196:199], v[84:87]
  s_cmp_lt_u32 s33, 98304
  s_cselect_b32 s33, s33, 0
  v_mfma_f32_16x16x32_bf16 v[88:91], a[180:183], v[200:203], v[88:91]
  ds_read_b128 v[168:171], v18 offset:4096
  s_add_u32 s21, s50, 8192
  v_mfma_f32_16x16x32_bf16 v[92:95], a[184:187], v[200:203], v[92:95]
  buffer_load_dwordx4 v[240:243], v30, s[16:19], s21 offen offset:0 sc1
  v_mfma_f32_16x16x32_bf16 v[96:99], a[188:191], v[200:203], v[96:99]
  v_mfma_f32_16x16x32_bf16 v[100:103], a[180:183], v[204:207], v[100:103]
  ds_read_b128 v[172:175], v18 offset:6144
  v_mfma_f32_16x16x32_bf16 v[104:107], a[184:187], v[204:207], v[104:107]
  v_mfma_f32_16x16x32_bf16 v[108:111], a[188:191], v[204:207], v[108:111]
  s_waitcnt lgkmcnt(4)
  v_mfma_f32_16x16x32_bf16 v[112:115], a[180:183], v[208:211], v[112:115]
  ds_read_b128 v[176:179], v18 offset:8192
  v_mfma_f32_16x16x32_bf16 v[116:119], a[184:187], v[208:211], v[116:119]
  buffer_load_dwordx4 v[244:247], v30, s[16:19], s21 offen offset:1024 sc1
  v_mfma_f32_16x16x32_bf16 v[120:123], a[188:191], v[208:211], v[120:123]
  v_mfma_f32_16x16x32_bf16 v[124:127], a[180:183], v[212:215], v[124:127]
  ds_read_b128 v[180:183], v18 offset:10240
  v_mfma_f32_16x16x32_bf16 v[128:131], a[184:187], v[212:215], v[128:131]
  buffer_load_dwordx4 v11, s[8:11], s30 offen offset:1024 lds
  v_mfma_f32_16x16x32_bf16 v[132:135], a[188:191], v[212:215], v[132:135]
  v_mfma_f32_16x16x32_bf16 v[136:139], a[180:183], v[216:219], v[136:139]
  ds_read_b128 v[184:187], v18 offset:12288
  v_mfma_f32_16x16x32_bf16 v[140:143], a[184:187], v[216:219], v[140:143]
  buffer_load_dwordx4 v[248:251], v30, s[16:19], s21 offen offset:2048 sc1
  v_mfma_f32_16x16x32_bf16 v[144:147], a[188:191], v[216:219], v[144:147]
  v_mfma_f32_16x16x32_bf16 v[148:151], a[180:183], v[220:223], v[148:151]
  ds_read_b128 v[188:191], v18 offset:14336
  v_mfma_f32_16x16x32_bf16 v[152:155], a[184:187], v[220:223], v[152:155]
  v_mfma_f32_16x16x32_bf16 v[156:159], a[188:191], v[220:223], v[156:159]
  s_waitcnt lgkmcnt(4)
  v_mfma_f32_16x16x32_bf16 v[64:67], a[192:195], v[160:163], v[64:67]
  ds_read_b128 v[192:195], v19 offset:0
  v_mfma_f32_16x16x32_bf16 v[68:71], a[196:199], v[160:163], v[68:71]
  v_add_u32 v18, s33, v14
  v_mfma_f32_16x16x32_bf16 v[72:75], a[200:203], v[160:163], v[72:75]
  buffer_load_dwordx4 v[252:255], v30, s[16:19], s21 offen offset:3072 sc1
  v_mfma_f32_16x16x32_bf16 v[76:79], a[192:195], v[164:167], v[76:79]
  ds_read_b128 v[196:199], v19 offset:2048
  v_mfma_f32_16x16x32_bf16 v[80:83], a[196:199], v[164:167], v[80:83]
  buffer_load_dwordx4 v12, s[8:11], s30 offen offset:2048 lds
  v_mfma_f32_16x16x32_bf16 v[84:87], a[200:203], v[164:167], v[84:87]
  v_mfma_f32_16x16x32_bf16 v[88:91], a[192:195], v[168:171], v[88:91]
  ds_read_b128 v[200:203], v19 offset:4096
  v_mfma_f32_16x16x32_bf16 v[92:95], a[196:199], v[168:171], v[92:95]
  buffer_load_dword v21, v33, s[72:75], s77 offen sc1
  v_mfma_f32_16x16x32_bf16 v[96:99], a[200:203], v[168:171], v[96:99]
  v_mfma_f32_16x16x32_bf16 v[100:103], a[192:195], v[172:175], v[100:103]
  ds_read_b128 v[204:207], v19 offset:6144
  v_mfma_f32_16x16x32_bf16 v[104:107], a[196:199], v[172:175], v[104:107]
  v_mfma_f32_16x16x32_bf16 v[108:111], a[200:203], v[172:175], v[108:111]
  s_waitcnt lgkmcnt(4)
  v_mfma_f32_16x16x32_bf16 v[112:115], a[192:195], v[176:179], v[112:115]
  ds_read_b128 v[208:211], v19 offset:8192
  v_mfma_f32_16x16x32_bf16 v[116:119], a[196:199], v[176:179], v[116:119]
  v_mfma_f32_16x16x32_bf16 v[120:123], a[200:203], v[176:179], v[120:123]
  v_mfma_f32_16x16x32_bf16 v[124:127], a[192:195], v[180:183], v[124:127]
  ds_read_b128 v[212:215], v19 offset:10240
  v_mfma_f32_16x16x32_bf16 v[128:131], a[196:199], v[180:183], v[128:131]
  buffer_load_dwordx4 v13, s[8:11], s30 offen offset:3072 lds
  v_mfma_f32_16x16x32_bf16 v[132:135], a[200:203], v[180:183], v[132:135]
  s_add_u32 s30, s30, 128
  s_add_u32 m0, m0, 16384
  v_mfma_f32_16x16x32_bf16 v[136:139], a[192:195], v[184:187], v[136:139]
  ds_read_b128 v[216:219], v19 offset:12288
  v_mfma_f32_16x16x32_bf16 v[140:143], a[196:199], v[184:187], v[140:143]
  s_cmp_lt_u32 m0, s46
  s_cselect_b32 m0, m0, s47
  v_mfma_f32_16x16x32_bf16 v[144:147], a[200:203], v[184:187], v[144:147]
  v_mfma_f32_16x16x32_bf16 v[148:151], a[192:195], v[188:191], v[148:151]
  ds_read_b128 v[220:223], v19 offset:14336
  v_mfma_f32_16x16x32_bf16 v[152:155], a[196:199], v[188:191], v[152:155]
  v_mfma_f32_16x16x32_bf16 v[156:159], a[200:203], v[188:191], v[156:159]
  s_waitcnt vmcnt(28) lgkmcnt(4)
  s_barrier
  v_mfma_f32_16x16x32_bf16 v[64:67], a[204:207], v[192:195], v[64:67]
  ds_read_b128 v[160:163], v18 offset:0
  v_mfma_f32_16x16x32_bf16 v[68:71], a[208:211], v[192:195], v[68:71]
  s_waitcnt vmcnt(25)
  s_cmp_eq_u32 s78, 0
  s_cbranch_scc1 pf_213
  v_mov_b32 v4, 0
  v_mov_b32 v5, 1
  s_mov_b64 exec, 1
  buffer_atomic_add v5, v4, s[72:75], s78 offen sc1
  s_mov_b64 exec, -1
  s_mov_b32 s78, 0
pf_213:
  v_mfma_f32_16x16x32_bf16 v[72:75], a[212:215], v[192:195], v[72:75]
  v_add_u32 v19, s33, v15
  s_add_u32 s33, s33, 16384
  v_mfma_f32_16x16x32_bf16 v[76:79], a[204:207], v[196:199], v[76:79]
  ds_read_b128 v[164:167], v18 offset:2048
  v_mfma_f32_16x16x32_bf16 v[80:83], a[208:211], v[196:199], v[80:83]
  buffer_load_dwordx4 v10, s[8:11], s30 offen offset:0 lds
  v_mfma_f32_16x16x32_bf16 v[84:87], a[212:215], v[196:199], v[84:87]
  s_cmp_lt_u32 s33, 98304
  s_cselect_b32 s33, s33, 0
  v_mfma_f32_16x16x32_bf16 v[88:91], a[204:207], v[200:203], v[88:91]
  ds_read_b128 v[168:171], v18 offset:4096
  v_mfma_f32_16x16x32_bf16 v[92:95], a[208:211], v[200:203], v[92:95]
  v_mfma_f32_16x16x32_bf16 v[96:99], a[212:215], v[200:203], v[96:99]
  v_mfma_f32_16x16x32_bf16 v[100:103], a[204:207], v[204:207], v[100:103]
  ds_read_b128 v[172:175], v18 offset:6144
  v_mfma_f32_16x16x32_bf16 v[104:107], a[208:211], v[204:207], v[104:107]
  v_mfma_f32_16x16x32_bf16 v[108:111], a[212:215], v[204:207], v[108:111]
  s_waitcnt lgkmcnt(4)
  v_mfma_f32_16x16x32_bf16 v[112:115], a[204:207], v[208:211], v[112:115]
  ds_read_b128 v[176:179], v18 offset:8192
  v_mfma_f32_16x16x32_bf16 v[116:119], a[208:211], v[208:211], v[116:119]
  v_mfma_f32_16x16x32_bf16 v[120:123], a[212:215], v[208:211], v[120:123]
  v_mfma_f32_16x16x32_bf16 v[124:127], a[204:207], v[212:215], v[124:127]
  ds_read_b128 v[180:183], v18 offset:10240
  v_mfma_f32_16x16x32_bf16 v[128:131], a[208:211], v[212:215], v[128:131]
  buffer_load_dwordx4 v11, s[8:11], s30 offen offset:1024 lds
  v_mfma_f32_16x16x32_bf16 v[132:135], a[212:215], v[212:215], v[132:135]
  v_mfma_f32_16x16x32_bf16 v[136:139], a[204:207], v[216:219], v[136:139]
  ds_read_b128 v[184:187], v18 offset:12288
  v_mfma_f32_16x16x32_bf16 v[140:143], a[208:211], v[216:219], v[140:143]
  v_mfma_f32_16x16x32_bf16 v[144:147], a[212:215], v[216:219], v[144:147]
  v_mfma_f32_16x16x32_bf16 v[148:151], a[204:207], v[220:223], v[148:151]
  ds_read_b128 v[188:191], v18 offset:14336
  v_mfma_f32_16x16x32_bf16 v[152:155], a[208:211], v[220:223], v[152:155]
  v_mfma_f32_16x16x32_bf16 v[156:159], a[212:215], v[220:223], v[156:159]
  s_waitcnt lgkmcnt(4)
  v_mfma_f32_16x16x32_bf16 v[64:67], a[216:219], v[160:163], v[64:67]
  ds_read_b128 v[192:195], v19 offset:0
  v_mfma_f32_16x16x32_bf16 v[68:71], a[220:223], v[160:163], v[68:71]
  v_add_u32 v18, s33, v14
  v_mfma_f32_16x16x32_bf16 v[72:75], a[224:227], v[160:163], v[72:75]
  v_mfma_f32_16x16x32_bf16 v[76:79], a[216:219], v[164:167], v[76:79]
  ds_read_b128 v[196:199], v19 offset:2048
  v_mfma_f32_16x16x32_bf16 v[80:83], a[220:223], v[164:167], v[80:83]
  buffer_load_dwordx4 v12, s[8:11], s30 offen offset:2048 lds
  v_mfma_f32_16x16x32_bf16 v[84:87], a[224:227], v[164:167], v[84:87]
  v_mfma_f32_16x16x32_bf16 v[88:91], a[216:219], v[168:171], v[88:91]
  ds_read_b128 v[200:203], v19 offset:4096
  v_mfma_f32_16x16x32_bf16 v[92:95], a[220:223], v[168:171], v[92:95]
  v_mfma_f32_16x16x32_bf16 v[96:99], a[224:227], v[168:171], v[96:99]
  v_mfma_f32_16x16x32_bf16 v[100:103], a[216:219], v[172:175], v[100:103]
  ds_read_b128 v[204:207], v19 offset:6144
  v_mfma_f32_16x16x32_bf16 v[104:107], a[220:223], v[172:175], v[104:107]
  v_mfma_f32_16x16x32_bf16 v[108:111], a[224:227], v[172:175], v[108:111]
  s_waitcnt lgkmcnt(4)
  v_mfma_f32_16x16x32_bf16 v[112:115], a[216:219], v[176:179], v[112:115]
  ds_read_b128 v[208:211], v19 offset:8192
  v_mfma_f32_16x16x32_bf16 v[116:119], a[220:223], v[176:179], v[116:119]
  v_mfma_f32_16x16x32_bf16 v[120:123], a[224:227], v[176:179], v[120:123]
  v_mfma_f32_16x16x32_bf16 v[124:127], a[216:219], v[180:183], v[124:127]
  ds_read_b128 v[212:215], v19 offset:10240
  v_mfma_f32_16x16x32_bf16 v[128:131], a[220:223], v[180:183], v[128:131]
  buffer_load_dwordx4 v13, s[8:11], s30 offen offset:3072 lds
  v_mfma_f32_16x16x32_bf16 v[132:135], a[224:227], v[180:183], v[132:135]
  s_add_u32 s30, s30, 128
  s_add_u32 m0, m0, 16384
  v_mfma_f32_16x16x32_bf16 v[136:139], a[216:219], v[184:187], v[136:139]
  ds_read_b128 v[216:219], v19 offset:12288
  v_mfma_f32_16x16x32_bf16 v[140:143], a[220:223], v[184:187], v[140:143]
  s_cmp_lt_u32 m0, s46
  s_cselect_b32 m0, m0, s47
  v_mfma_f32_16x16x32_bf16 v[144:147], a[224:227], v[184:187], v[144:147]
  v_mfma_f32_16x16x32_bf16 v[148:151], a[216:219], v[188:191], v[148:151]
  ds_read_b128 v[220:223], v19 offset:14336
  v_mfma_f32_16x16x32_bf16 v[152:155], a[220:223], v[188:191], v[152:155]
  v_mfma_f32_16x16x32_bf16 v[156:159], a[224:227], v[188:191], v[156:159]
  s_waitcnt vmcnt(25) lgkmcnt(4)
  s_barrier
  v_mfma_f32_16x16x32_bf16 v[64:67], a[228:231], v[192:195], v[64:67]
  ds_read_b128 v[160:163], v18 offset:0
  v_mfma_f32_16x16x32_bf16 v[68:71], a[232:235], v[192:195], v[68:71]
  v_mfma_f32_16x16x32_bf16 v[72:75], a[236:239], v[192:195], v[72:75]
  v_add_u32 v19, s33, v15
  s_add_u32 s33, s33, 16384
  v_mfma_f32_16x16x32_bf16 v[76:79], a[228:231], v[196:199], v[76:79]
  ds_read_b128 v[164:167], v18 offset:2048
  v_cvt_pk_bf16_f32 v224, v64, v65
  v_cvt_pk_bf16_f32 v225, v66, v67
  v_mfma_f32_16x16x32_bf16 v[80:83], a[232:235], v[196:199], v[80:83]
  buffer_load_dwordx4 v10, s[8:11], s30 offen offset:0 lds
  v_cvt_pk_bf16_f32 v226, v68, v69
  v_cvt_pk_bf16_f32 v227, v70, v71
  v_mfma_f32_16x16x32_bf16 v[84:87], a[236:239], v[196:199], v[84:87]
  s_cmp_lt_u32 s33, 98304
  s_cselect_b32 s33, s33, 0
  v_cvt_pk_bf16_f32 v228, v72, v73
  v_cvt_pk_bf16_f32 v229, v74, v75
  v_mfma_f32_16x16x32_bf16 v[88:91], a[228:231], v[200:203], v[88:91]
  ds_read_b128 v[168:171], v18 offset:4096
  ds_write_b64 v22, v[224:225] offset:0
  v_mfma_f32_16x16x32_bf16 v[92:95], a[232:235], v[200:203], v[92:95]
  ds_write_b64 v22, v[226:227] offset:8
  ds_write_b64 v16, v[228:229] offset:64
  v_mfma_f32_16x16x32_bf16 v[96:99], a[236:239], v[200:203], v[96:99]
  v_cvt_pk_bf16_f32 v230, v76, v77
  v_cvt_pk_bf16_f32 v231, v78, v79
  v_cvt_pk_bf16_f32 v232, v80, v81
  v_cvt_pk_bf16_f32 v233, v82, v83
  v_mfma_f32_16x16x32_bf16 v[100:103], a[228:231], v[204:207], v[100:103]
  ds_read_b128 v[172:175], v18 offset:6144
  v_cvt_pk_bf16_f32 v234, v84, v85
  v_cvt_pk_bf16_f32 v235, v86, v87
  v_mfma_f32_16x16x32_bf16 v[104:107], a[232:235], v[204:207], v[104:107]
  ds_write_b64 v22, v[230:231] offset:6400
  ds_write_b64 v22, v[232:233] offset:6408
  v_mfma_f32_16x16x32_bf16 v[108:111], a[236:239], v[204:207], v[108:111]
  s_waitcnt lgkmcnt(9)
  ds_write_b64 v16, v[234:235] offset:6464
  v_cvt_pk_bf16_f32 v224, v88, v89
  v_mfma_f32_16x16x32_bf16 v[112:115], a[228:231], v[208:211], v[112:115]
  ds_read_b128 v[176:179], v18 offset:8192
  v_cvt_pk_bf16_f32 v225, v90, v91
  v_cvt_pk_bf16_f32 v226, v92, v93
  v_cvt_pk_bf16_f32 v227, v94, v95
  v_mfma_f32_16x16x32_bf16 v[116:119], a[232:235], v[208:211], v[116:119]
  v_cvt_pk_bf16_f32 v228, v96, v97
  v_cvt_pk_bf16_f32 v229, v98, v99
  ds_write_b64 v22, v[224:225] offset:12800
  v_mfma_f32_16x16x32_bf16 v[120:123], a[236:239], v[208:211], v[120:123]
  ds_write_b64 v22, v[226:227] offset:12808
  ds_write_b64 v16, v[228:229] offset:12864
  v_mfma_f32_16x16x32_bf16 v[124:127], a[228:231], v[212:215], v[124:127]
  ds_read_b128 v[180:183], v18 offset:10240
  v_cvt_pk_bf16_f32 v230, v100, v101
  v_cvt_pk_bf16_f32 v231, v102, v103
  v_cvt_pk_bf16_f32 v232, v104, v105
  v_mfma_f32_16x16x32_bf16 v[128:131], a[232:235], v[212:215], v[128:131]
  buffer_load_dwordx4 v11, s[8:11], s30 offen offset:1024 lds
  v_cvt_pk_bf16_f32 v233, v106, v107
  v_cvt_pk_bf16_f32 v234, v108, v109
  v_mfma_f32_16x16x32_bf16 v[132:135], a[236:239], v[212:215], v[132:135]
  v_cvt_pk_bf16_f32 v235, v110, v111
  ds_write_b64 v22, v[230:231] offset:19200
  v_mfma_f32_16x16x32_bf16 v[136:139], a[228:231], v[216:219], v[136:139]
  ds_read_b128 v[184:187], v18 offset:12288
  ds_write_b64 v22, v[232:233] offset:19208
  v_mfma_f32_16x16x32_bf16 v[140:143], a[232:235], v[216:219], v[140:143]
  ds_write_b64 v16, v[234:235] offset:19264
  v_cvt_pk_bf16_f32 v224, v112, v113
  v_cvt_pk_bf16_f32 v225, v114, v115
  v_mfma_f32_16x16x32_bf16 v[144:147], a[236:239], v[216:219], v[144:147]
  v_cvt_pk_bf16_f32 v226, v116, v117
  v_cvt_pk_bf16_f32 v227, v118, v119
  v_cvt_pk_bf16_f32 v228, v120, v121
  v_cvt_pk_bf16_f32 v229, v122, v123
  v_mfma_f32_16x16x32_bf16 v[148:151], a[228:231], v[220:223], v[148:151]
  ds_read_b128 v[188:191], v18 offset:14336
  ds_write_b64 v22, v[224:225] offset:25600
  v_mfma_f32_16x16x32_bf16 v[152:155], a[232:235], v[220:223], v[152:155]
  ds_write_b64 v22, v[226:227] offset:25608
  ds_write_b64 v16, v[228:229] offset:25664
  v_mfma_f32_16x16x32_bf16 v[156:159], a[236:239], v[220:223], v[156:159]
  v_cvt_pk_bf16_f32 v230, v124, v125
  v_cvt_pk_bf16_f32 v231, v126, v127
  v_cvt_pk_bf16_f32 v232, v128, v129
  v_cvt_pk_bf16_f32 v233, v130, v131
qa_end_215:
  v_cvt_pk_bf16_f32 v234, v132, v133
  v_cvt_pk_bf16_f32 v235, v134, v135
  ds_write_b64 v22, v[230:231] offset:32000
  ds_write_b64 v22, v[232:233] offset:32008
  ds_write_b64 v16, v[234:235] offset:32064
  v_cvt_pk_bf16_f32 v224, v136, v137
  v_cvt_pk_bf16_f32 v225, v138, v139
  v_cvt_pk_bf16_f32 v226, v140, v141
  v_cvt_pk_bf16_f32 v227, v142, v143
  v_cvt_pk_bf16_f32 v228, v144, v145
  v_cvt_pk_bf16_f32 v229, v146, v147
  ds_write_b64 v22, v[224:225] offset:38400
  ds_write_b64 v22, v[226:227] offset:38408
  ds_write_b64 v16, v[228:229] offset:38464
  v_cvt_pk_bf16_f32 v230, v148, v149
  v_cvt_pk_bf16_f32 v231, v150, v151
  v_cvt_pk_bf16_f32 v232, v152, v153
  v_cvt_pk_bf16_f32 v233, v154, v155
  v_cvt_pk_bf16_f32 v234, v156, v157
  v_cvt_pk_bf16_f32 v235, v158, v159
  ds_write_b64 v22, v[230:231] offset:44800
  ds_write_b64 v22, v[232:233] offset:44808
  ds_write_b64 v16, v[234:235] offset:44864
  s_add_u32 s23, s49, 1
  s_waitcnt vmcnt(6)
  v_cmp_gt_u32 vcc, s23, v21
  s_mov_b32 s80, 0
  s_nop 0
  s_cbranch_vccnz qk_218
  s_mov_b32 s80, 1
  buffer_load_dwordx4 v[132:135], v31, s[52:55], s51 offen offset:0 sc1
  buffer_load_dwordx4 v[136:139], v31, s[52:55], s51 offen offset:512 sc1
  buffer_load_dwordx4 v[140:143], v31, s[52:55], s51 offen offset:1024 sc1
  buffer_load_dwordx4 v[144:147], v31, s[52:55], s51 offen offset:1536 sc1
  buffer_load_dwordx4 v[148:151], v31, s[52:55], s51 offen offset:2048 sc1
  buffer_load_dwordx4 v[152:155], v31, s[52:55], s51 offen offset:2560 sc1
qk_218:
  s_cmp_ge_u32 s79, 8
  s_cbranch_scc1 qk_217
  v_mov_b32 v156, 0
  s_mov_b32 s101, 0
wf_219:
  buffer_load_dword v157, v156, s[72:75], s76 offen sc1
  s_add_u32 s101, s101, 1
  s_cmp_gt_u32 s101, 131072
  s_cbranch_scc1 main_end
  s_waitcnt vmcnt(0)
  v_readfirstlane_b32 s100, v157
  s_cmp_ge_u32 s100, 8
  s_cbranch_scc1 wf_220
  s_sleep 2
  s_branch wf_219
wf_220:
  s_add_u32 s21, s50, 0
  buffer_load_dwordx4 v[36:39], v30, s[16:19], s21 offen offset:0 sc1
  buffer_load_dwordx4 v[40:43], v30, s[16:19], s21 offen offset:1024 sc1
  buffer_load_dwordx4 v[44:47], v30, s[16:19], s21 offen offset:2048 sc1
  buffer_load_dwordx4 v[48:51], v30, s[16:19], s21 offen offset:3072 sc1
  s_add_u32 s21, s50, 4096
  buffer_load_dwordx4 v[52:55], v30, s[16:19], s21 offen offset:0 sc1
  buffer_load_dwordx4 v[56:59], v30, s[16:19], s21 offen offset:1024 sc1
  buffer_load_dwordx4 v[60:63], v30, s[16:19], s21 offen offset:2048 sc1
  buffer_load_dwordx4 v[236:239], v30, s[16:19], s21 offen offset:3072 sc1
  s_add_u32 s21, s50, 8192
  buffer_load_dwordx4 v[240:243], v30, s[16:19], s21 offen offset:0 sc1
  buffer_load_dwordx4 v[244:247], v30, s[16:19], s21 offen offset:1024 sc1
  buffer_load_dwordx4 v[248:251], v30, s[16:19], s21 offen offset:2048 sc1
  buffer_load_dwordx4 v[252:255], v30, s[16:19], s21 offen offset:3072 sc1
qk_217:
  s_waitcnt lgkmcnt(0)
  s_barrier
  ds_read_b128 v[64:67], v29 offset:0
  ds_read_b128 v[68:71], v29 offset:64
  ds_read_b128 v[72:75], v29 offset:128
  ds_read_b128 v[76:79], v29 offset:192
  ds_read_b128 v[80:83], v29 offset:256
  ds_read_b128 v[84:87], v29 offset:320
  ds_read_b128 v[88:91], v29 offset:6400
  ds_read_b128 v[92:95], v29 offset:6464
  ds_read_b128 v[96:99], v29 offset:6528
  ds_read_b128 v[100:103], v29 offset:6592
  ds_read_b128 v[104:107], v29 offset:6656
  ds_read_b128 v[108:111], v29 offset:6720
  s_waitcnt lgkmcnt(0)
  s_cmp_eq_u32 s80, 1
  s_cselect_b32 s21, s79, 0
  s_cmp_ge_u32 s21, 8
  s_cbranch_scc1 qw_221
  s_waitcnt vmcnt(0)
qw_221:
  v_mfma_f32_16x16x32_bf16 v[112:115], v[36:39], v[64:67], 0
  v_mfma_f32_16x16x32_bf16 v[120:123], v[36:39], v[88:91], 0
  v_mfma_f32_16x16x32_bf16 v[124:127], v[60:63], v[88:91], 0
  v_mfma_f32_16x16x32_bf16 v[112:115], v[40:43], v[68:71], v[112:115]
  v_mfma_f32_16x16x32_bf16 v[120:123], v[40:43], v[92:95], v[120:123]
  v_mfma_f32_16x16x32_bf16 v[124:127], v[236:239], v[92:95], v[124:127]
  v_mfma_f32_16x16x32_bf16 v[112:115], v[44:47], v[72:75], v[112:115]
  v_mfma_f32_16x16x32_bf16 v[120:123], v[44:47], v[96:99], v[120:123]
  v_mfma_f32_16x16x32_bf16 v[124:127], v[240:243], v[96:99], v[124:127]
  v_mfma_f32_16x16x32_bf16 v[112:115], v[48:51], v[76:79], v[112:115]
  v_mfma_f32_16x16x32_bf16 v[120:123], v[48:51], v[100:103], v[120:123]
  v_mfma_f32_16x16x32_bf16 v[124:127], v[244:247], v[100:103], v[124:127]
  v_mfma_f32_16x16x32_bf16 v[112:115], v[52:55], v[80:83], v[112:115]
  v_mfma_f32_16x16x32_bf16 v[120:123], v[52:55], v[104:107], v[120:123]
  v_mfma_f32_16x16x32_bf16 v[124:127], v[248:251], v[104:107], v[124:127]
  v_mfma_f32_16x16x32_bf16 v[112:115], v[56:59], v[84:87], v[112:115]
  v_mfma_f32_16x16x32_bf16 v[120:123], v[56:59], v[108:111], v[120:123]
  v_mfma_f32_16x16x32_bf16 v[124:127], v[252:255], v[108:111], v[124:127]
  s_cmp_eq_u32 s80, 1
  s_cbranch_scc1 qm_222
  s_add_u32 s23, s49, 1
  s_mov_b32 s101, 0
wm_223:
  buffer_load_dword v156, v33, s[72:75], s77 offen sc1
  s_add_u32 s101, s101, 1
  s_cmp_gt_u32 s101, 131072
  s_cbranch_scc1 main_end
  s_waitcnt vmcnt(0)
  v_cmp_gt_u32 vcc, s23, v156
  v_readfirstlane_b32 s100, v156
  s_nop 0
  s_cbranch_vccz wm_224
  s_sleep 4
  s_add_u32 s100, s100, 2
  s_cmp_ge_u32 s100, s23
  s_cbranch_scc1 wm_223
  s_sleep 90
  s_branch wm_223
wm_224:
  buffer_load_dwordx4 v[132:135], v31, s[52:55], s51 offen offset:0 sc1
  buffer_load_dwordx4 v[136:139], v31, s[52:55], s51 offen offset:512 sc1
  buffer_load_dwordx4 v[140:143], v31, s[52:55], s51 offen offset:1024 sc1
  buffer_load_dwordx4 v[144:147], v31, s[52:55], s51 offen offset:1536 sc1
  buffer_load_dwordx4 v[148:151], v31, s[52:55], s51 offen offset:2048 sc1
  buffer_load_dwordx4 v[152:155], v31, s[52:55], s51 offen offset:2560 sc1
qm_222:
  s_waitcnt vmcnt(0)
  v_mfma_f32_16x16x32_bf16 v[116:119], v[132:135], v[64:67], 0
  v_mfma_f32_16x16x32_bf16 v[128:131], v[132:135], v[88:91], 0
  v_mfma_f32_16x16x32_bf16 v[116:119], v[136:139], v[68:71], v[116:119]
  v_mfma_f32_16x16x32_bf16 v[128:131], v[136:139], v[92:95], v[128:131]
  v_mfma_f32_16x16x32_bf16 v[116:119], v[140:143], v[72:75], v[116:119]
  v_mfma_f32_16x16x32_bf16 v[128:131], v[140:143], v[96:99], v[128:131]
  v_mfma_f32_16x16x32_bf16 v[116:119], v[144:147], v[76:79], v[116:119]
  v_mfma_f32_16x16x32_bf16 v[128:131], v[144:147], v[100:103], v[128:131]
  v_mfma_f32_16x16x32_bf16 v[116:119], v[148:151], v[80:83], v[116:119]
  v_mfma_f32_16x16x32_bf16 v[128:131], v[148:151], v[104:107], v[128:131]
  v_mfma_f32_16x16x32_bf16 v[116:119], v[152:155], v[84:87], v[116:119]
  v_mfma_f32_16x16x32_bf16 v[128:131], v[152:155], v[108:111], v[128:131]
  s_lshl_b32 s21, s49, 5
  s_add_u32 s21, s21, s42
  s_mul_i32 s81, s21, 2560
  s_lshl_b32 s82, s49, 3
  s_and_b32 s21, s42, 7
  s_add_u32 s82, s82, s21
  s_lshl_b32 s82, s82, 7
  s_add_u32 s82, s82, 23552
  s_cmp_gt_u32 s26, 1
  s_cselect_b32 s21, s80, 0
  s_cmp_eq_u32 s21, 0
  s_cbranch_scc1 qi_226
  v_mov_b32 v36, v112
  v_mov_b32 v37, v113
  v_mov_b32 v38, v114
  v_mov_b32 v39, v115
  v_mov_b32 v40, v116
  v_mov_b32 v41, v117
  v_mov_b32 v42, v118
  v_mov_b32 v43, v119
  v_mov_b32 v44, v120
  v_mov_b32 v45, v121
  v_mov_b32 v46, v122
  v_mov_b32 v47, v123
  v_mov_b32 v48, v124
  v_mov_b32 v49, v125
  v_mov_b32 v50, v126
  v_mov_b32 v51, v127
  v_mov_b32 v52, v128
  v_mov_b32 v53, v129
  v_mov_b32 v54, v130
  v_mov_b32 v55, v131
  s_branch qd_225
qi_226:
  v_cndmask_b32 v112, v34, v112, s[64:65]
  v_cndmask_b32 v124, v34, v124, s[64:65]
  v_cndmask_b32 v113, v34, v113, s[66:67]
  v_cndmask_b32 v125, v34, v125, s[66:67]
  v_cndmask_b32 v114, v34, v114, s[68:69]
  v_cndmask_b32 v126, v34, v126, s[68:69]
  v_cndmask_b32 v115, v34, v115, s[70:71]
  v_cndmask_b32 v127, v34, v127, s[70:71]
  v_max3_f32 v156, v112, v113, v114
  v_max3_f32 v156, v156, v115, v116
  v_max3_f32 v156, v156, v117, v118
  v_max_f32 v156, v156, v119
  v_mov_b32 v157, v156
  s_nop 1
  v_permlane32_swap_b32 v156, v157
  v_max_f32 v156, v156, v157
  v_mov_b32 v157, v156
  s_nop 1
  v_permlane16_swap_b32 v156, v157
  v_max_f32 v156, v156, v157
  v_mul_f32 v156, s83, v156
  v_fma_f32 v112, v112, s83, -v156
  v_fma_f32 v113, v113, s83, -v156
  v_fma_f32 v114, v114, s83, -v156
  v_fma_f32 v115, v115, s83, -v156
  v_fma_f32 v116, v116, s83, -v156
  v_fma_f32 v117, v117, s83, -v156
  v_fma_f32 v118, v118, s83, -v156
  v_fma_f32 v119, v119, s83, -v156
  v_exp_f32 v112, v112
  v_exp_f32 v113, v113
  v_exp_f32 v114, v114
  v_exp_f32 v115, v115
  v_exp_f32 v116, v116
  v_exp_f32 v117, v117
  v_exp_f32 v118, v118
  v_exp_f32 v119, v119
  s_nop 0
  v_add_f32 v156, v116, v117
  v_add_f32 v156, v156, v118
  v_add_f32 v156, v156, v119
  v_cndmask_b32 v156, 0, v156, s[60:61]
  v_add_f32 v156, v156, v112
  v_add_f32 v156, v156, v113
  v_add_f32 v156, v156, v114
  v_add_f32 v156, v156, v115
  v_mov_b32 v157, v156
  s_nop 1
  v_permlane32_swap_b32 v156, v157
  v_add_f32 v156, v156, v157
  v_mov_b32 v157, v156
  s_nop 1
  v_permlane16_swap_b32 v156, v157
  v_add_f32 v156, v156, v157
  v_rcp_f32 v156, v156
  s_nop 0
  v_mul_f32 v112, v112, v156
  v_mul_f32 v113, v113, v156
  v_mul_f32 v114, v114, v156
  v_mul_f32 v115, v115, v156
  v_mul_f32 v116, v116, v156
  v_mul_f32 v117, v117, v156
  v_mul_f32 v118, v118, v156
  v_mul_f32 v119, v119, v156
  v_max3_f32 v156, v120, v121, v122
  v_max3_f32 v156, v156, v123, v124
  v_max3_f32 v156, v156, v125, v126
  v_max3_f32 v156, v156, v127, v128
  v_max3_f32 v156, v156, v129, v130
  v_max_f32 v156, v156, v131
  v_mov_b32 v157, v156
  s_nop 1
  v_permlane32_swap_b32 v156, v157
  v_max_f32 v156, v156, v157
  v_mov_b32 v157, v156
  s_nop 1
  v_permlane16_swap_b32 v156, v157
  v_max_f32 v156, v156, v157
  v_mul_f32 v156, s83, v156
  v_fma_f32 v120, v120, s83, -v156
  v_fma_f32 v121, v121, s83, -v156
  v_fma_f32 v122, v122, s83, -v156
  v_fma_f32 v123, v123, s83, -v156
  v_fma_f32 v124, v124, s83, -v156
  v_fma_f32 v125, v125, s83, -v156
  v_fma_f32 v126, v126, s83, -v156
  v_fma_f32 v127, v127, s83, -v156
  v_fma_f32 v128, v128, s83, -v156
  v_fma_f32 v129, v129, s83, -v156
  v_fma_f32 v130, v130, s83, -v156
  v_fma_f32 v131, v131, s83, -v156
  v_exp_f32 v120, v120
  v_exp_f32 v121, v121
  v_exp_f32 v122, v122
  v_exp_f32 v123, v123
  v_exp_f32 v124, v124
  v_exp_f32 v125, v125
  v_exp_f32 v126, v126
  v_exp_f32 v127, v127
  v_exp_f32 v128, v128
  v_exp_f32 v129, v129
  v_exp_f32 v130, v130
  v_exp_f32 v131, v131
  s_nop 0
  v_add_f32 v156, v128, v129
  v_add_f32 v156, v156, v130
  v_add_f32 v156, v156, v131
  v_cndmask_b32 v156, 0, v156, s[60:61]
  v_add_f32 v156, v156, v120
  v_add_f32 v156, v156, v121
  v_add_f32 v156, v156, v122
  v_add_f32 v156, v156, v123
  v_add_f32 v156, v156, v124
  v_add_f32 v156, v156, v125
  v_add_f32 v156, v156, v126
  v_add_f32 v156, v156, v127
  v_mov_b32 v157, v156
  s_nop 1
  v_permlane32_swap_b32 v156, v157
  v_add_f32 v156, v156, v157
  v_mov_b32 v157, v156
  s_nop 1
  v_permlane16_swap_b32 v156, v157
  v_add_f32 v156, v156, v157
  v_rcp_f32 v156, v156
  s_nop 0
  v_mul_f32 v120, v120, v156
  v_mul_f32 v121, v121, v156
  v_mul_f32 v122, v122, v156
  v_mul_f32 v123, v123, v156
  v_mul_f32 v124, v124, v156
  v_mul_f32 v125, v125, v156
  v_mul_f32 v126, v126, v156
  v_mul_f32 v127, v127, v156
  v_mul_f32 v128, v128, v156
  v_mul_f32 v129, v129, v156
  v_mul_f32 v130, v130, v156
  v_mul_f32 v131, v131, v156
  v_cvt_pk_bf16_f32 v196, v116, v117
  v_cvt_pk_bf16_f32 v197, v118, v119
  v_cvt_pk_bf16_f32 v198, v128, v129
  v_cvt_pk_bf16_f32 v199, v130, v131
  v_cvt_pk_bf16_f32 v192, v120, v121
  v_cvt_pk_bf16_f32 v193, v122, v123
  v_cvt_pk_bf16_f32 v194, v124, v125
  v_cvt_pk_bf16_f32 v195, v126, v127
  v_cvt_pk_bf16_f32 v200, v112, v113
  v_cvt_pk_bf16_f32 v201, v114, v115
  v_permlane16_swap_b32 v196, v198
  v_permlane16_swap_b32 v197, v199
  buffer_store_dwordx4 v[192:195], v30, s[56:59], s81 offen sc1
  s_mov_b64 exec, 0xffffffff
  buffer_store_dwordx4 v[196:199], v30, s[56:59], s81 offen offset:1024 sc1
  s_mov_b64 exec, -1
  buffer_store_dwordx2 v[200:201], v32, s[56:59], s81 offen offset:2048 sc1
  s_mov_b32 s78, s82
  s_mov_b32 s81, 0x80000000
  s_mov_b32 s82, 0
  s_cmp_eq_u32 s80, 1
  s_cbranch_scc1 qd_225
  s_waitcnt vmcnt(0)
  s_cmp_eq_u32 s78, 0
  s_cbranch_scc1 pf_227
  v_mov_b32 v4, 0
  v_mov_b32 v5, 1
  s_mov_b64 exec, 1
  buffer_atomic_add v5, v4, s[72:75], s78 offen sc1
  s_mov_b64 exec, -1
  s_mov_b32 s78, 0
pf_227:
qd_225:
  s_add_u32 s49, s49, s29
qbe_216:
  s_sub_u32 s26, s26, 1
  s_cmp_gt_u32 s26, 0
  s_waitcnt lgkmcnt(0)
  s_cbranch_scc1 qa_blk_214
  s_waitcnt vmcnt(0) lgkmcnt(0)
  s_add_u32 s12, s38, 201326592
  s_addc_u32 s13, s39, 0
  s_mov_b32 s14, 6291456
  s_mov_b32 s15, 0x00020000
  s_cmp_eq_u32 s78, 0
  s_cbranch_scc1 pf_228
  v_mov_b32 v4, 0
  v_mov_b32 v5, 1
  s_mov_b64 exec, 1
  buffer_atomic_add v5, v4, s[72:75], s78 offen sc1
  s_mov_b64 exec, -1
  s_mov_b32 s78, 0
pf_228:
  s_lshl_b32 s21, s42, 7
  s_add_u32 s21, s21, 112640
  v_mov_b32 v156, 0
  s_mov_b32 s101, 0
wf_229:
  buffer_load_dword v157, v156, s[72:75], s21 offen sc1
  s_add_u32 s101, s101, 1
  s_cmp_gt_u32 s101, 131072
  s_cbranch_scc1 main_end
  s_waitcnt vmcnt(0)
  v_readfirstlane_b32 s100, v157
  s_cmp_ge_u32 s100, 4
  s_cbranch_scc1 wf_230
  s_sleep 16
  s_branch wf_229
wf_230:
qf_231:
  s_mul_i32 s21, s49, 393216
  s_mul_i32 s22, s42, 12288
  s_add_u32 s50, s21, s22
  s_mul_i32 s21, s49, 98304
  s_mul_i32 s22, s42, 3072
  s_add_u32 s51, s21, s22
  s_lshr_b32 s22, s49, 1
  s_lshr_b32 s21, s49, 2
  s_add_u32 s21, s21, 3
  s_cmp_lt_u32 s49, 12
  s_cselect_b32 s21, s22, s21
  s_lshl_b32 s21, s21, 3
  s_lshr_b32 s22, s42, 2
  s_add_u32 s21, s21, s22
  s_lshl_b32 s21, s21, 7
  s_add_u32 s76, s21, 0
  s_lshl_b32 s77, s42, 7
  s_add_u32 s77, s77, 19456
  s_sub_u32 s43, s50, 18874368
  buffer_load_dword v21, v33, s[72:75], s77 offen sc1
  s_add_u32 s21, s50, 0
  buffer_load_dwordx4 v[36:39], v30, s[16:19], s21 offen offset:0 sc1
  buffer_load_dwordx4 v[40:43], v30, s[16:19], s21 offen offset:1024 sc1
  buffer_load_dwordx4 v[44:47], v30, s[16:19], s21 offen offset:2048 sc1
  buffer_load_dwordx4 v[48:51], v30, s[16:19], s21 offen offset:3072 sc1
  s_add_u32 s21, s50, 4096
  buffer_load_dwordx4 v[52:55], v30, s[16:19], s21 offen offset:0 sc1
  buffer_load_dwordx4 v[56:59], v30, s[16:19], s21 offen offset:1024 sc1
  buffer_load_dwordx4 v[60:63], v30, s[16:19], s21 offen offset:2048 sc1
  buffer_load_dwordx4 v[236:239], v30, s[16:19], s21 offen offset:3072 sc1
  s_add_u32 s21, s50, 8192
  buffer_load_dwordx4 v[240:243], v30, s[16:19], s21 offen offset:0 sc1
  buffer_load_dwordx4 v[244:247], v30, s[16:19], s21 offen offset:1024 sc1
  buffer_load_dwordx4 v[248:251], v30, s[16:19], s21 offen offset:2048 sc1
  buffer_load_dwordx4 v[252:255], v30, s[16:19], s21 offen offset:3072 sc1
  s_add_u32 s21, s43, 0
  buffer_load_dwordx4 v[64:67], v30, s[12:15], s21 offen offset:0 sc1
  buffer_load_dwordx4 v[68:71], v30, s[12:15], s21 offen offset:1024 sc1
  buffer_load_dwordx4 v[72:75], v30, s[12:15], s21 offen offset:2048 sc1
  buffer_load_dwordx4 v[76:79], v30, s[12:15], s21 offen offset:3072 sc1
  s_add_u32 s21, s43, 4096
  buffer_load_dwordx4 v[80:83], v30, s[12:15], s21 offen offset:0 sc1
  buffer_load_dwordx4 v[84:87], v30, s[12:15], s21 offen offset:1024 sc1
  buffer_load_dwordx4 v[88:91], v30, s[12:15], s21 offen offset:2048 sc1
  buffer_load_dwordx4 v[92:95], v30, s[12:15], s21 offen offset:3072 sc1
  s_add_u32 s21, s43, 8192
  buffer_load_dwordx4 v[96:99], v30, s[12:15], s21 offen offset:0 sc1
  buffer_load_dwordx4 v[100:103], v30, s[12:15], s21 offen offset:1024 sc1
  buffer_load_dwordx4 v[104:107], v30, s[12:15], s21 offen offset:2048 sc1
  buffer_load_dwordx4 v[108:111], v30, s[12:15], s21 offen offset:3072 sc1
  s_waitcnt vmcnt(24)
  s_cmp_eq_u32 s78, 0
  s_cbranch_scc1 pf_234
  v_mov_b32 v4, 0
  v_mov_b32 v5, 1
  s_mov_b64 exec, 1
  buffer_atomic_add v5, v4, s[72:75], s78 offen sc1
  s_mov_b64 exec, -1
  s_mov_b32 s78, 0
pf_234:
  s_add_u32 s23, s49, 1
  v_cmp_gt_u32 vcc, s23, v21
  s_mov_b32 s80, 0
  s_nop 0
  s_cbranch_vccnz qk_233
  s_mov_b32 s80, 1
  buffer_load_dwordx4 v[132:135], v31, s[52:55], s51 offen offset:0 sc1
  buffer_load_dwordx4 v[136:139], v31, s[52:55], s51 offen offset:512 sc1
  buffer_load_dwordx4 v[140:143], v31, s[52:55], s51 offen offset:1024 sc1
  buffer_load_dwordx4 v[144:147], v31, s[52:55], s51 offen offset:1536 sc1
  buffer_load_dwordx4 v[148:151], v31, s[52:55], s51 offen offset:2048 sc1
  buffer_load_dwordx4 v[152:155], v31, s[52:55], s51 offen offset:2560 sc1
  s_waitcnt vmcnt(6)
  s_branch qk_233x
qk_233:
  s_waitcnt vmcnt(0)
qk_233x:
  v_mfma_f32_16x16x32_bf16 v[112:115], v[36:39], v[64:67], 0
  v_mfma_f32_16x16x32_bf16 v[120:123], v[36:39], v[88:91], 0
  v_mfma_f32_16x16x32_bf16 v[124:127], v[60:63], v[88:91], 0
  v_mfma_f32_16x16x32_bf16 v[112:115], v[40:43], v[68:71], v[112:115]
  v_mfma_f32_16x16x32_bf16 v[120:123], v[40:43], v[92:95], v[120:123]
  v_mfma_f32_16x16x32_bf16 v[124:127], v[236:239], v[92:95], v[124:127]
  v_mfma_f32_16x16x32_bf16 v[112:115], v[44:47], v[72:75], v[112:115]
  v_mfma_f32_16x16x32_bf16 v[120:123], v[44:47], v[96:99], v[120:123]
  v_mfma_f32_16x16x32_bf16 v[124:127], v[240:243], v[96:99], v[124:127]
  v_mfma_f32_16x16x32_bf16 v[112:115], v[48:51], v[76:79], v[112:115]
  v_mfma_f32_16x16x32_bf16 v[120:123], v[48:51], v[100:103], v[120:123]
  v_mfma_f32_16x16x32_bf16 v[124:127], v[244:247], v[100:103], v[124:127]
  v_mfma_f32_16x16x32_bf16 v[112:115], v[52:55], v[80:83], v[112:115]
  v_mfma_f32_16x16x32_bf16 v[120:123], v[52:55], v[104:107], v[120:123]
  v_mfma_f32_16x16x32_bf16 v[124:127], v[248:251], v[104:107], v[124:127]
  v_mfma_f32_16x16x32_bf16 v[112:115], v[56:59], v[84:87], v[112:115]
  v_mfma_f32_16x16x32_bf16 v[120:123], v[56:59], v[108:111], v[120:123]
  v_mfma_f32_16x16x32_bf16 v[124:127], v[252:255], v[108:111], v[124:127]
  s_cmp_eq_u32 s80, 1
  s_cbranch_scc1 qm_235
  s_add_u32 s23, s49, 1
  s_min_u32 s22, s49, 62
  s_cmp_lt_u32 s49, 62
  s_cselect_b32 s23, s23, s22
  s_mov_b32 s101, 0
wm_236:
  buffer_load_dword v156, v33, s[72:75], s77 offen sc1
  s_add_u32 s101, s101, 1
  s_cmp_gt_u32 s101, 131072
  s_cbranch_scc1 main_end
  s_waitcnt vmcnt(0)
  v_cmp_gt_u32 vcc, s23, v156
  v_readfirstlane_b32 s100, v156
  s_nop 0
  s_cbranch_vccz wm_237
  s_sleep 4
  s_add_u32 s100, s100, 2
  s_cmp_ge_u32 s100, s23
  s_cbranch_scc1 wm_236
  s_sleep 90
  s_branch wm_236
wm_237:
  s_mov_b32 s101, 0
  s_branch qtp_239
qtp_238:
  s_sleep 3
qtp_239:
  buffer_load_dwordx4 v[132:135], v31, s[52:55], s51 offen offset:0 sc1
  buffer_load_dwordx4 v[136:139], v31, s[52:55], s51 offen offset:512 sc1
  buffer_load_dwordx4 v[140:143], v31, s[52:55], s51 offen offset:1024 sc1
  buffer_load_dwordx4 v[144:147], v31, s[52:55], s51 offen offset:1536 sc1
  buffer_load_dwordx4 v[148:151], v31, s[52:55], s51 offen offset:2048 sc1
  buffer_load_dwordx4 v[152:155], v31, s[52:55], s51 offen offset:2560 sc1
  s_add_u32 s101, s101, 1
  s_cmp_gt_u32 s101, 131072
  s_cbranch_scc1 main_end
  s_waitcnt vmcnt(0)
  v_max3_u32 v156, v132, v134, v136
  v_max3_u32 v156, v156, v138, v140
  v_max3_u32 v156, v156, v142, v144
  v_max3_u32 v156, v156, v146, v148
  v_max3_u32 v156, v156, v150, v152
  v_max3_u32 v156, v156, v154, v154
  v_cmp_eq_u32 vcc, -1, v156
  s_nop 1
  s_cbranch_vccnz qtp_238
qm_235:
  s_waitcnt vmcnt(0)
  v_mfma_f32_16x16x32_bf16 v[116:119], v[132:135], v[64:67], 0
  v_mfma_f32_16x16x32_bf16 v[128:131], v[132:135], v[88:91], 0
  v_mfma_f32_16x16x32_bf16 v[116:119], v[136:139], v[68:71], v[116:119]
  v_mfma_f32_16x16x32_bf16 v[128:131], v[136:139], v[92:95], v[128:131]
  v_mfma_f32_16x16x32_bf16 v[116:119], v[140:143], v[72:75], v[116:119]
  v_mfma_f32_16x16x32_bf16 v[128:131], v[140:143], v[96:99], v[128:131]
  v_mfma_f32_16x16x32_bf16 v[116:119], v[144:147], v[76:79], v[116:119]
  v_mfma_f32_16x16x32_bf16 v[128:131], v[144:147], v[100:103], v[128:131]
  v_mfma_f32_16x16x32_bf16 v[116:119], v[148:151], v[80:83], v[116:119]
  v_mfma_f32_16x16x32_bf16 v[128:131], v[148:151], v[104:107], v[128:131]
  v_mfma_f32_16x16x32_bf16 v[116:119], v[152:155], v[84:87], v[116:119]
  v_mfma_f32_16x16x32_bf16 v[128:131], v[152:155], v[108:111], v[128:131]
  s_lshl_b32 s21, s49, 5
  s_add_u32 s21, s21, s42
  s_mul_i32 s81, s21, 2560
  s_lshl_b32 s82, s49, 3
  s_and_b32 s21, s42, 7
  s_add_u32 s82, s82, s21
  s_lshl_b32 s82, s82, 7
  s_add_u32 s82, s82, 23552
  v_cndmask_b32 v112, v34, v112, s[64:65]
  v_cndmask_b32 v124, v34, v124, s[64:65]
  v_cndmask_b32 v113, v34, v113, s[66:67]
  v_cndmask_b32 v125, v34, v125, s[66:67]
  v_cndmask_b32 v114, v34, v114, s[68:69]
  v_cndmask_b32 v126, v34, v126, s[68:69]
  v_cndmask_b32 v115, v34, v115, s[70:71]
  v_cndmask_b32 v127, v34, v127, s[70:71]
  v_max3_f32 v156, v112, v113, v114
  v_max3_f32 v156, v156, v115, v116
  v_max3_f32 v156, v156, v117, v118
  v_max_f32 v156, v156, v119
  v_mov_b32 v157, v156
  s_nop 1
  v_permlane32_swap_b32 v156, v157
  v_max_f32 v156, v156, v157
  v_mov_b32 v157, v156
  s_nop 1
  v_permlane16_swap_b32 v156, v157
  v_max_f32 v156, v156, v157
  v_mul_f32 v156, s83, v156
  v_fma_f32 v112, v112, s83, -v156
  v_fma_f32 v113, v113, s83, -v156
  v_fma_f32 v114, v114, s83, -v156
  v_fma_f32 v115, v115, s83, -v156
  v_fma_f32 v116, v116, s83, -v156
  v_fma_f32 v117, v117, s83, -v156
  v_fma_f32 v118, v118, s83, -v156
  v_fma_f32 v119, v119, s83, -v156
  v_exp_f32 v112, v112
  v_exp_f32 v113, v113
  v_exp_f32 v114, v114
  v_exp_f32 v115, v115
  v_exp_f32 v116, v116
  v_exp_f32 v117, v117
  v_exp_f32 v118, v118
  v_exp_f32 v119, v119
  s_nop 0
  v_add_f32 v156, v116, v117
  v_add_f32 v156, v156, v118
  v_add_f32 v156, v156, v119
  v_cndmask_b32 v156, 0, v156, s[60:61]
  v_add_f32 v156, v156, v112
  v_add_f32 v156, v156, v113
  v_add_f32 v156, v156, v114
  v_add_f32 v156, v156, v115
  v_mov_b32 v157, v156
  s_nop 1
  v_permlane32_swap_b32 v156, v157
  v_add_f32 v156, v156, v157
  v_mov_b32 v157, v156
  s_nop 1
  v_permlane16_swap_b32 v156, v157
  v_add_f32 v156, v156, v157
  v_rcp_f32 v156, v156
  s_nop 0
  v_mul_f32 v112, v112, v156
  v_mul_f32 v113, v113, v156
  v_mul_f32 v114, v114, v156
  v_mul_f32 v115, v115, v156
  v_mul_f32 v116, v116, v156
  v_mul_f32 v117, v117, v156
  v_mul_f32 v118, v118, v156
  v_mul_f32 v119, v119, v156
  v_max3_f32 v156, v120, v121, v122
  v_max3_f32 v156, v156, v123, v124
  v_max3_f32 v156, v156, v125, v126
  v_max3_f32 v156, v156, v127, v128
  v_max3_f32 v156, v156, v129, v130
  v_max_f32 v156, v156, v131
  v_mov_b32 v157, v156
  s_nop 1
  v_permlane32_swap_b32 v156, v157
  v_max_f32 v156, v156, v157
  v_mov_b32 v157, v156
  s_nop 1
  v_permlane16_swap_b32 v156, v157
  v_max_f32 v156, v156, v157
  v_mul_f32 v156, s83, v156
  v_fma_f32 v120, v120, s83, -v156
  v_fma_f32 v121, v121, s83, -v156
  v_fma_f32 v122, v122, s83, -v156
  v_fma_f32 v123, v123, s83, -v156
  v_fma_f32 v124, v124, s83, -v156
  v_fma_f32 v125, v125, s83, -v156
  v_fma_f32 v126, v126, s83, -v156
  v_fma_f32 v127, v127, s83, -v156
  v_fma_f32 v128, v128, s83, -v156
  v_fma_f32 v129, v129, s83, -v156
  v_fma_f32 v130, v130, s83, -v156
  v_fma_f32 v131, v131, s83, -v156
  v_exp_f32 v120, v120
  v_exp_f32 v121, v121
  v_exp_f32 v122, v122
  v_exp_f32 v123, v123
  v_exp_f32 v124, v124
  v_exp_f32 v125, v125
  v_exp_f32 v126, v126
  v_exp_f32 v127, v127
  v_exp_f32 v128, v128
  v_exp_f32 v129, v129
  v_exp_f32 v130, v130
  v_exp_f32 v131, v131
  s_nop 0
  v_add_f32 v156, v128, v129
  v_add_f32 v156, v156, v130
  v_add_f32 v156, v156, v131
  v_cndmask_b32 v156, 0, v156, s[60:61]
  v_add_f32 v156, v156, v120
  v_add_f32 v156, v156, v121
  v_add_f32 v156, v156, v122
  v_add_f32 v156, v156, v123
  v_add_f32 v156, v156, v124
  v_add_f32 v156, v156, v125
  v_add_f32 v156, v156, v126
  v_add_f32 v156, v156, v127
  v_mov_b32 v157, v156
  s_nop 1
  v_permlane32_swap_b32 v156, v157
  v_add_f32 v156, v156, v157
  v_mov_b32 v157, v156
  s_nop 1
  v_permlane16_swap_b32 v156, v157
  v_add_f32 v156, v156, v157
  v_rcp_f32 v156, v156
  s_nop 0
  v_mul_f32 v120, v120, v156
  v_mul_f32 v121, v121, v156
  v_mul_f32 v122, v122, v156
  v_mul_f32 v123, v123, v156
  v_mul_f32 v124, v124, v156
  v_mul_f32 v125, v125, v156
  v_mul_f32 v126, v126, v156
  v_mul_f32 v127, v127, v156
  v_mul_f32 v128, v128, v156
  v_mul_f32 v129, v129, v156
  v_mul_f32 v130, v130, v156
  v_mul_f32 v131, v131, v156
  v_cvt_pk_bf16_f32 v196, v116, v117
  v_cvt_pk_bf16_f32 v197, v118, v119
  v_cvt_pk_bf16_f32 v198, v128, v129
  v_cvt_pk_bf16_f32 v199, v130, v131
  v_cvt_pk_bf16_f32 v192, v120, v121
  v_cvt_pk_bf16_f32 v193, v122, v123
  v_cvt_pk_bf16_f32 v194, v124, v125
  v_cvt_pk_bf16_f32 v195, v126, v127
  v_cvt_pk_bf16_f32 v200, v112, v113
  v_cvt_pk_bf16_f32 v201, v114, v115
  v_permlane16_swap_b32 v196, v198
  v_permlane16_swap_b32 v197, v199
  buffer_store_dwordx4 v[192:195], v30, s[56:59], s81 offen sc1
  s_mov_b64 exec, 0xffffffff
  buffer_store_dwordx4 v[196:199], v30, s[56:59], s81 offen offset:1024 sc1
  s_mov_b64 exec, -1
  buffer_store_dwordx2 v[200:201], v32, s[56:59], s81 offen offset:2048 sc1
  s_mov_b32 s78, s82
  s_mov_b32 s81, 0x80000000
  s_mov_b32 s82, 0
  s_cmp_eq_u32 s80, 1
  s_cbranch_scc1 qd_240
  s_waitcnt vmcnt(0)
  s_cmp_eq_u32 s78, 0
  s_cbranch_scc1 pf_241
  v_mov_b32 v4, 0
  v_mov_b32 v5, 1
  s_mov_b64 exec, 1
  buffer_atomic_add v5, v4, s[72:75], s78 offen sc1
  s_mov_b64 exec, -1
  s_mov_b32 s78, 0
pf_241:
qd_240:
  s_add_u32 s49, s49, s29
qbe_232:
  s_cmp_lt_u32 s49, 64
  s_cbranch_scc1 qf_231
  s_waitcnt vmcnt(0)
  s_cmp_eq_u32 s78, 0
  s_cbranch_scc1 pf_242
  v_mov_b32 v4, 0
  v_mov_b32 v5, 1
  s_mov_b64 exec, 1
  buffer_atomic_add v5, v4, s[72:75], s78 offen sc1
  s_mov_b64 exec, -1
  s_mov_b32 s78, 0
pf_242:
queue:
  s_load_dwordx2 s[4:5], s[0:1], 96
  s_waitcnt lgkmcnt(0)
  s_mov_b32 s32, s4
  s_mov_b32 s33, s5
  s_mov_b32 s34, 256
  s_mov_b32 s35, 0x00020000
  s_waitcnt vmcnt(0) lgkmcnt(0)
  s_barrier
  s_mov_b32 s2, s85
  s_mov_b32 s85, -1
  s_cmp_lg_u32 s2, -1
  s_cbranch_scc1 queue_c
  v_mov_b32 v21, 0
  s_cmp_lg_u32 s20, 0
  s_cbranch_scc1 q_243
  v_mov_b32 v22, 80
  v_mov_b32 v23, 1
  s_mov_b64 exec, 1
  buffer_atomic_add v23, v22, s[32:35], 0 offen sc0 sc1
  s_waitcnt vmcnt(0)
queue_a:
  ds_write_b32 v21, v23
  s_waitcnt lgkmcnt(0)
  s_mov_b64 exec, -1
q_243:
queue_b:
  s_barrier
  ds_read_b32 v23, v21
  s_waitcnt lgkmcnt(0)
  v_readfirstlane_b32 s2, v23
  s_barrier
queue_c:
  s_add_u32 s21, s2, 0
  s_cmp_lt_u32 s2, 326
  s_cbranch_scc1 do_pv
  s_sub_u32 s2, s2, 326
  s_branch main_fin
do_opb:
  s_mov_b32 s87, -1
do_opb2:
  s_mov_b32 s2, s21
  s_load_dwordx2 s[4:5], s[0:1], 0
  s_load_dwordx4 s[40:43], s[0:1], 72
  s_load_dwordx2 s[38:39], s[0:1], 104
  s_lshl_b32 s59, s2, 2
  s_add_u32 s59, s59, s20
  s_lshl_b32 s59, s59, 3
  v_lshlrev_b32 v4, 4, v1
  v_lshlrev_b32 v5, 2, v1
  s_waitcnt lgkmcnt(0)
  s_mov_b32 s8, s4
  s_mov_b32 s9, s5
  s_mov_b32 s10, 2621440
  s_mov_b32 s11, 0x00020000
  s_mov_b32 s12, s42
  s_mov_b32 s13, s43
  s_mov_b32 s14, 1280
  s_mov_b32 s15, 0x00020000
  s_mov_b32 s24, s40
  s_mov_b32 s25, s41
  s_mov_b32 s26, 819200
  s_mov_b32 s27, 0x00020000
  s_add_u32 s16, s38, 70713344
  s_addc_u32 s17, s39, 0
  s_mov_b32 s18, 2641920
  s_mov_b32 s19, 0x00020000
  s_add_u32 s28, s38, 81002496
  s_addc_u32 s29, s39, 0
  s_mov_b32 s30, 8192
  s_mov_b32 s31, 0x00020000
  s_add_u32 s72, s38, 81068032
  s_addc_u32 s73, s39, 0
  s_mov_b32 s74, 116736
  s_mov_b32 s75, 0x00020000
  s_mov_b32 s21, 91136
  v_mov_b32 v20, 0
  buffer_load_dword v21, v20, s[72:75], s21 offen sc1
  v_mov_b32 v29, 3277
  s_mul_i32 s21, s20, 320
  s_add_u32 s21, s21, 0
  v_add_u32 v22, s21, v1
  v_mul_u32_u24 v23, v22, v29
  v_lshrrev_b32 v23, 16, v23
  v_mul_u32_u24 v24, 20, v23
  v_sub_u32 v22, v22, v24
  v_bfe_u32 v24, v23, 3, 1
  v_lshlrev_b32 v24, 1, v24
  v_xor_b32 v22, v22, v24
  v_mul_u32_u24 v23, 1280, v23
  v_lshl_add_u32 v8, v22, 4, v23
  s_mul_i32 s21, s20, 320
  s_add_u32 s21, s21, 64
  v_add_u32 v22, s21, v1
  v_mul_u32_u24 v23, v22, v29
  v_lshrrev_b32 v23, 16, v23
  v_mul_u32_u24 v24, 20, v23
  v_sub_u32 v22, v22, v24
  v_bfe_u32 v24, v23, 3, 1
  v_lshlrev_b32 v24, 1, v24
  v_xor_b32 v22, v22, v24
  v_mul_u32_u24 v23, 1280, v23
  v_lshl_add_u32 v9, v22, 4, v23
  s_mul_i32 s21, s20, 320
  s_add_u32 s21, s21, 128
  v_add_u32 v22, s21, v1
  v_mul_u32_u24 v23, v22, v29
  v_lshrrev_b32 v23, 16, v23
  v_mul_u32_u24 v24, 20, v23
  v_sub_u32 v22, v22, v24
  v_bfe_u32 v24, v23, 3, 1
  v_lshlrev_b32 v24, 1, v24
  v_xor_b32 v22, v22, v24
  v_mul_u32_u24 v23, 1280, v23
  v_lshl_add_u32 v10, v22, 4, v23
  s_mul_i32 s21, s20, 320
  s_add_u32 s21, s21, 192
  v_add_u32 v22, s21, v1
  v_mul_u32_u24 v23, v22, v29
  v_lshrrev_b32 v23, 16, v23
  v_mul_u32_u24 v24, 20, v23
  v_sub_u32 v22, v22, v24
  v_bfe_u32 v24, v23, 3, 1
  v_lshlrev_b32 v24, 1, v24
  v_xor_b32 v22, v22, v24
  v_mul_u32_u24 v23, 1280, v23
  v_lshl_add_u32 v11, v22, 4, v23
  s_mul_i32 s21, s20, 320
  s_add_u32 s21, s21, 256
  v_add_u32 v22, s21, v1
  v_mul_u32_u24 v23, v22, v29
  v_lshrrev_b32 v23, 16, v23
  v_mul_u32_u24 v24, 20, v23
  v_sub_u32 v22, v22, v24
  v_bfe_u32 v24, v23, 3, 1
  v_lshlrev_b32 v24, 1, v24
  v_xor_b32 v22, v22, v24
  v_mul_u32_u24 v23, 1280, v23
  v_lshl_add_u32 v12, v22, 4, v23
  s_and_b32 s44, s2, 3
  s_mul_i32 s45, s44, 320
  s_mul_i32 s46, s20, 5120
  v_and_b32 v22, 1, v2
  v_mul_u32_u24 v22, 16512, v22
  v_mul_u32_u24 v23, 33024, v3
  v_lshrrev_b32 v24, 1, v2
  v_lshlrev_b32 v24, 4, v24
  v_add3_u32 v6, v22, v23, v24
  s_lshr_b32 s47, s2, 2
  s_lshl_b32 s47, s47, 2
  s_add_u32 s47, s47, s20
  s_lshl_b32 s47, s47, 1
  s_lshl_b32 s48, s47, 7
  v_lshrrev_b32 v22, 2, v2
  v_lshl_add_u32 v22, v3, 3, v22
  v_mul_u32_u24 v22, 320, v22
  v_and_b32 v23, 3, v2
  v_lshl_add_u32 v22, v23, 3, v22
  v_and_b32 v23, 1, v3
  v_lshlrev_b32 v23, 5, v23
  v_add_u32 v14, v22, v23
  v_sub_u32 v15, v22, v23
  v_add_u32 v16, 61440, v14
  v_add_u32 v17, 61440, v15
  v_add_u32 v18, 122880, v14
  v_add_u32 v19, 122880, v15
  s_add_u32 m0, s46, 0
  s_add_u32 s49, s45, 0
  s_nop 0
  buffer_load_dwordx4 v8, s[24:27], s49 offen lds
  s_add_u32 m0, s46, 1024
  s_nop 0
  buffer_load_dwordx4 v9, s[24:27], s49 offen lds
  s_add_u32 m0, s46, 2048
  s_nop 0
  buffer_load_dwordx4 v10, s[24:27], s49 offen lds
  s_add_u32 m0, s46, 3072
  s_nop 0
  buffer_load_dwordx4 v11, s[24:27], s49 offen lds
  s_add_u32 m0, s46, 4096
  s_nop 0
  buffer_load_dwordx4 v12, s[24:27], s49 offen lds
  s_add_u32 m0, s46, 20480
  s_add_u32 s49, s45, 81920
  s_nop 0
  buffer_load_dwordx4 v8, s[24:27], s49 offen lds
  s_add_u32 m0, s46, 21504
  s_nop 0
  buffer_load_dwordx4 v9, s[24:27], s49 offen lds
  s_add_u32 m0, s46, 22528
  s_nop 0
  buffer_load_dwordx4 v10, s[24:27], s49 offen lds
  s_add_u32 m0, s46, 23552
  s_nop 0
  buffer_load_dwordx4 v11, s[24:27], s49 offen lds
  s_add_u32 m0, s46, 24576
  s_nop 0
  buffer_load_dwordx4 v12, s[24:27], s49 offen lds
  s_waitcnt vmcnt(10)
  v_readfirstlane_b32 s21, v21
  s_cmp_ge_u32 s21, 32
  s_cbranch_scc1 o2_244
  s_mov_b32 s21, 91136
  v_mov_b32 v20, 0
  s_mov_b32 s101, 0
wf_245:
  buffer_load_dword v21, v20, s[72:75], s21 offen sc1
  s_add_u32 s101, s101, 1
  s_cmp_gt_u32 s101, 131072
  s_cbranch_scc1 main_end
  s_waitcnt vmcnt(0)
  v_readfirstlane_b32 s100, v21
  s_cmp_ge_u32 s100, 32
  s_cbranch_scc1 wf_246
  s_sleep 32
  s_branch wf_245
wf_246:
o2_244:
  buffer_load_dwordx4 a[0:3], v6, s[16:19], s48 offen offset:0 sc1
  buffer_load_dwordx4 a[4:7], v6, s[16:19], s48 offen offset:128 sc1
  s_add_u32 s48, s48, 132096
  buffer_load_dwordx4 a[8:11], v6, s[16:19], s48 offen offset:0 sc1
  buffer_load_dwordx4 a[12:15], v6, s[16:19], s48 offen offset:128 sc1
  s_add_u32 s48, s48, 132096
  buffer_load_dwordx4 a[16:19], v6, s[16:19], s48 offen offset:0 sc1
  buffer_load_dwordx4 a[20:23], v6, s[16:19], s48 offen offset:128 sc1
  s_add_u32 s48, s48, 132096
  buffer_load_dwordx4 a[24:27], v6, s[16:19], s48 offen offset:0 sc1
  buffer_load_dwordx4 a[28:31], v6, s[16:19], s48 offen offset:128 sc1
  s_add_u32 s48, s48, 132096
  s_add_u32 m0, s46, 40960
  s_add_u32 s49, s45, 163840
  s_nop 0
  buffer_load_dwordx4 v8, s[24:27], s49 offen lds
  s_add_u32 m0, s46, 41984
  s_nop 0
  buffer_load_dwordx4 v9, s[24:27], s49 offen lds
  s_add_u32 m0, s46, 43008
  s_nop 0
  buffer_load_dwordx4 v10, s[24:27], s49 offen lds
  s_add_u32 m0, s46, 44032
  s_nop 0
  buffer_load_dwordx4 v11, s[24:27], s49 offen lds
  s_add_u32 m0, s46, 45056
  s_nop 0
  buffer_load_dwordx4 v12, s[24:27], s49 offen lds
  buffer_load_dwordx4 a[32:35], v6, s[16:19], s48 offen offset:0 sc1
  buffer_load_dwordx4 a[36:39], v6, s[16:19], s48 offen offset:128 sc1
  s_add_u32 s48, s48, 132096
  buffer_load_dwordx4 a[40:43], v6, s[16:19], s48 offen offset:0 sc1
  buffer_load_dwordx4 a[44:47], v6, s[16:19], s48 offen offset:128 sc1
  s_add_u32 s48, s48, 132096
  s_add_u32 m0, s46, 61440
  s_add_u32 s49, s45, 245760
  s_nop 0
  buffer_load_dwordx4 v8, s[24:27], s49 offen lds
  s_add_u32 m0, s46, 62464
  s_nop 0
  buffer_load_dwordx4 v9, s[24:27], s49 offen lds
  s_add_u32 m0, s46, 63488
  s_nop 0
  buffer_load_dwordx4 v10, s[24:27], s49 offen lds
  s_add_u32 m0, s46, 64512
  s_nop 0
  buffer_load_dwordx4 v11, s[24:27], s49 offen lds
  s_add_u32 m0, s46, 65536
  s_nop 0
  buffer_load_dwordx4 v12, s[24:27], s49 offen lds
  buffer_load_dwordx4 a[48:51], v6, s[16:19], s48 offen offset:0 sc1
  buffer_load_dwordx4 a[52:55], v6, s[16:19], s48 offen offset:128 sc1
  s_add_u32 s48, s48, 132096
  buffer_load_dwordx4 a[56:59], v6, s[16:19], s48 offen offset:0 sc1
  buffer_load_dwordx4 a[60:63], v6, s[16:19], s48 offen offset:128 sc1
  s_add_u32 s48, s48, 132096
  s_add_u32 m0, s46, 81920
  s_add_u32 s49, s45, 327680
  s_nop 0
  buffer_load_dwordx4 v8, s[24:27], s49 offen lds
  s_add_u32 m0, s46, 82944
  s_nop 0
  buffer_load_dwordx4 v9, s[24:27], s49 offen lds
  s_add_u32 m0, s46, 83968
  s_nop 0
  buffer_load_dwordx4 v10, s[24:27], s49 offen lds
  s_add_u32 m0, s46, 84992
  s_nop 0
  buffer_load_dwordx4 v11, s[24:27], s49 offen lds
  s_add_u32 m0, s46, 86016
  s_nop 0
  buffer_load_dwordx4 v12, s[24:27], s49 offen lds
  buffer_load_dwordx4 a[64:67], v6, s[16:19], s48 offen offset:0 sc1
  buffer_load_dwordx4 a[68:71], v6, s[16:19], s48 offen offset:128 sc1
  s_add_u32 s48, s48, 132096
  buffer_load_dwordx4 a[72:75], v6, s[16:19], s48 offen offset:0 sc1
  buffer_load_dwordx4 a[76:79], v6, s[16:19], s48 offen offset:128 sc1
  s_add_u32 s48, s48, 132096
  s_add_u32 m0, s46, 102400
  s_add_u32 s49, s45, 409600
  s_nop 0
  buffer_load_dwordx4 v8, s[24:27], s49 offen lds
  s_add_u32 m0, s46, 103424
  s_nop 0
  buffer_load_dwordx4 v9, s[24:27], s49 offen lds
  s_add_u32 m0, s46, 104448
  s_nop 0
  buffer_load_dwordx4 v10, s[24:27], s49 offen lds
  s_add_u32 m0, s46, 105472
  s_nop 0
  buffer_load_dwordx4 v11, s[24:27], s49 offen lds
  s_add_u32 m0, s46, 106496
  s_nop 0
  buffer_load_dwordx4 v12, s[24:27], s49 offen lds
  s_add_u32 m0, s46, 122880
  s_add_u32 s49, s45, 491520
  s_nop 0
  buffer_load_dwordx4 v8, s[24:27], s49 offen lds
  s_add_u32 m0, s46, 123904
  s_nop 0
  buffer_load_dwordx4 v9, s[24:27], s49 offen lds
  s_add_u32 m0, s46, 124928
  s_nop 0
  buffer_load_dwordx4 v10, s[24:27], s49 offen lds
  s_add_u32 m0, s46, 125952
  s_nop 0
  buffer_load_dwordx4 v11, s[24:27], s49 offen lds
  s_add_u32 m0, s46, 126976
  s_nop 0
  buffer_load_dwordx4 v12, s[24:27], s49 offen lds
  s_waitcnt vmcnt(50)
  s_barrier
  ds_read_b64_tr_b16 v[144:145], v14 offset:0
  ds_read_b64_tr_b16 v[146:147], v14 offset:1280
  ds_read_b64_tr_b16 v[148:149], v15 offset:32
  ds_read_b64_tr_b16 v[150:151], v15 offset:1312
  ds_read_b64_tr_b16 v[152:153], v14 offset:64
  ds_read_b64_tr_b16 v[154:155], v14 offset:1344
  ds_read_b64_tr_b16 v[156:157], v15 offset:96
  ds_read_b64_tr_b16 v[158:159], v15 offset:1376
  ds_read_b64_tr_b16 v[160:161], v14 offset:128
  ds_read_b64_tr_b16 v[162:163], v14 offset:1408
  ds_read_b64_tr_b16 v[164:165], v15 offset:160
  ds_read_b64_tr_b16 v[166:167], v15 offset:1440
  ds_read_b64_tr_b16 v[168:169], v14 offset:192
  ds_read_b64_tr_b16 v[170:171], v14 offset:1472
  ds_read_b64_tr_b16 v[172:173], v15 offset:224
  ds_read_b64_tr_b16 v[174:175], v15 offset:1504
  ds_read_b64_tr_b16 v[176:177], v14 offset:256
  ds_read_b64_tr_b16 v[178:179], v14 offset:1536
  ds_read_b64_tr_b16 v[180:181], v15 offset:288
  ds_read_b64_tr_b16 v[182:183], v15 offset:1568
  s_waitcnt lgkmcnt(0) vmcnt(43)
  v_mfma_f32_16x16x32_bf16 v[64:67], v[144:147], a[0:3], 0
  ds_read_b64_tr_b16 v[184:185], v14 offset:10240
  ds_read_b64_tr_b16 v[186:187], v14 offset:11520
  v_mfma_f32_16x16x32_bf16 v[104:107], v[144:147], a[4:7], 0
  ds_read_b64_tr_b16 v[188:189], v15 offset:10272
  v_mfma_f32_16x16x32_bf16 v[68:71], v[148:151], a[0:3], 0
  ds_read_b64_tr_b16 v[190:191], v15 offset:11552
  v_mfma_f32_16x16x32_bf16 v[108:111], v[148:151], a[4:7], 0
  ds_read_b64_tr_b16 v[192:193], v14 offset:10304
  v_mfma_f32_16x16x32_bf16 v[72:75], v[152:155], a[0:3], 0
  ds_read_b64_tr_b16 v[194:195], v14 offset:11584
  v_mfma_f32_16x16x32_bf16 v[112:115], v[152:155], a[4:7], 0
  ds_read_b64_tr_b16 v[196:197], v15 offset:10336
  ds_read_b64_tr_b16 v[198:199], v15 offset:11616
  v_mfma_f32_16x16x32_bf16 v[76:79], v[156:159], a[0:3], 0
  ds_read_b64_tr_b16 v[200:201], v14 offset:10368
  v_mfma_f32_16x16x32_bf16 v[116:119], v[156:159], a[4:7], 0
  ds_read_b64_tr_b16 v[202:203], v14 offset:11648
  v_mfma_f32_16x16x32_bf16 v[80:83], v[160:163], a[0:3], 0
  ds_read_b64_tr_b16 v[204:205], v15 offset:10400
  v_mfma_f32_16x16x32_bf16 v[120:123], v[160:163], a[4:7], 0
  ds_read_b64_tr_b16 v[206:207], v15 offset:11680
  v_mfma_f32_16x16x32_bf16 v[84:87], v[164:167], a[0:3], 0
  ds_read_b64_tr_b16 v[208:209], v14 offset:10432
  v_mfma_f32_16x16x32_bf16 v[124:127], v[164:167], a[4:7], 0
  ds_read_b64_tr_b16 v[210:211], v14 offset:11712
  ds_read_b64_tr_b16 v[212:213], v15 offset:10464
  v_mfma_f32_16x16x32_bf16 v[88:91], v[168:171], a[0:3], 0
  ds_read_b64_tr_b16 v[214:215], v15 offset:11744
  v_mfma_f32_16x16x32_bf16 v[128:131], v[168:171], a[4:7], 0
  buffer_load_dwordx4 a[80:83], v6, s[16:19], s48 offen offset:0 sc1
  ds_read_b64_tr_b16 v[216:217], v14 offset:10496
  v_mfma_f32_16x16x32_bf16 v[92:95], v[172:175], a[0:3], 0
  ds_read_b64_tr_b16 v[218:219], v14 offset:11776
  v_mfma_f32_16x16x32_bf16 v[132:135], v[172:175], a[4:7], 0
  ds_read_b64_tr_b16 v[220:221], v15 offset:10528
  v_mfma_f32_16x16x32_bf16 v[96:99], v[176:179], a[0:3], 0
  ds_read_b64_tr_b16 v[222:223], v15 offset:11808
  v_mfma_f32_16x16x32_bf16 v[136:139], v[176:179], a[4:7], 0
  buffer_load_dwordx4 a[84:87], v6, s[16:19], s48 offen offset:128 sc1
  v_mfma_f32_16x16x32_bf16 v[100:103], v[180:183], a[0:3], 0
  s_add_u32 s48, s48, 132096
  v_mfma_f32_16x16x32_bf16 v[140:143], v[180:183], a[4:7], 0
  s_waitcnt lgkmcnt(0) vmcnt(43)
  s_barrier
  v_mfma_f32_16x16x32_bf16 v[64:67], v[184:187], a[8:11], v[64:67]
  s_add_u32 m0, s46, 0
  ds_read_b64_tr_b16 v[144:145], v14 offset:20480
  ds_read_b64_tr_b16 v[146:147], v14 offset:21760
  v_mfma_f32_16x16x32_bf16 v[104:107], v[184:187], a[12:15], v[104:107]
  s_add_u32 s49, s45, 573440
  ds_read_b64_tr_b16 v[148:149], v15 offset:20512
  v_mfma_f32_16x16x32_bf16 v[68:71], v[188:191], a[8:11], v[68:71]
  buffer_load_dwordx4 v8, s[24:27], s49 offen lds
  ds_read_b64_tr_b16 v[150:151], v15 offset:21792
  v_mfma_f32_16x16x32_bf16 v[108:111], v[188:191], a[12:15], v[108:111]
  s_add_u32 m0, s46, 1024
  ds_read_b64_tr_b16 v[152:153], v14 offset:20544
  v_mfma_f32_16x16x32_bf16 v[72:75], v[192:195], a[8:11], v[72:75]
  buffer_load_dwordx4 v9, s[24:27], s49 offen lds
  ds_read_b64_tr_b16 v[154:155], v14 offset:21824
  v_mfma_f32_16x16x32_bf16 v[112:115], v[192:195], a[12:15], v[112:115]
  s_add_u32 m0, s46, 2048
  ds_read_b64_tr_b16 v[156:157], v15 offset:20576
  ds_read_b64_tr_b16 v[158:159], v15 offset:21856
  v_mfma_f32_16x16x32_bf16 v[76:79], v[196:199], a[8:11], v[76:79]
  buffer_load_dwordx4 v10, s[24:27], s49 offen lds
  ds_read_b64_tr_b16 v[160:161], v14 offset:20608
  v_mfma_f32_16x16x32_bf16 v[116:119], v[196:199], a[12:15], v[116:119]
  s_add_u32 m0, s46, 3072
  ds_read_b64_tr_b16 v[162:163], v14 offset:21888
  v_mfma_f32_16x16x32_bf16 v[80:83], v[200:203], a[8:11], v[80:83]
  buffer_load_dwordx4 v11, s[24:27], s49 offen lds
  ds_read_b64_tr_b16 v[164:165], v15 offset:20640
  v_mfma_f32_16x16x32_bf16 v[120:123], v[200:203], a[12:15], v[120:123]
  s_add_u32 m0, s46, 4096
  ds_read_b64_tr_b16 v[166:167], v15 offset:21920
  v_mfma_f32_16x16x32_bf16 v[84:87], v[204:207], a[8:11], v[84:87]
  buffer_load_dwordx4 v12, s[24:27], s49 offen lds
  ds_read_b64_tr_b16 v[168:169], v14 offset:20672
  v_mfma_f32_16x16x32_bf16 v[124:127], v[204:207], a[12:15], v[124:127]
  ds_read_b64_tr_b16 v[170:171], v14 offset:21952
  ds_read_b64_tr_b16 v[172:173], v15 offset:20704
  v_mfma_f32_16x16x32_bf16 v[88:91], v[208:211], a[8:11], v[88:91]
  ds_read_b64_tr_b16 v[174:175], v15 offset:21984
  v_mfma_f32_16x16x32_bf16 v[128:131], v[208:211], a[12:15], v[128:131]
  buffer_load_dwordx4 a[88:91], v6, s[16:19], s48 offen offset:0 sc1
  ds_read_b64_tr_b16 v[176:177], v14 offset:20736
  v_mfma_f32_16x16x32_bf16 v[92:95], v[212:215], a[8:11], v[92:95]
  ds_read_b64_tr_b16 v[178:179], v14 offset:22016
  v_mfma_f32_16x16x32_bf16 v[132:135], v[212:215], a[12:15], v[132:135]
  ds_read_b64_tr_b16 v[180:181], v15 offset:20768
  v_mfma_f32_16x16x32_bf16 v[96:99], v[216:219], a[8:11], v[96:99]
  ds_read_b64_tr_b16 v[182:183], v15 offset:22048
  v_mfma_f32_16x16x32_bf16 v[136:139], v[216:219], a[12:15], v[136:139]
  buffer_load_dwordx4 a[92:95], v6, s[16:19], s48 offen offset:128 sc1
  v_mfma_f32_16x16x32_bf16 v[100:103], v[220:223], a[8:11], v[100:103]
  s_add_u32 s48, s48, 132096
  v_mfma_f32_16x16x32_bf16 v[140:143], v[220:223], a[12:15], v[140:143]
  s_waitcnt lgkmcnt(0) vmcnt(48)
  v_mfma_f32_16x16x32_bf16 v[64:67], v[144:147], a[16:19], v[64:67]
  ds_read_b64_tr_b16 v[184:185], v14 offset:30720
  ds_read_b64_tr_b16 v[186:187], v14 offset:32000
  v_mfma_f32_16x16x32_bf16 v[104:107], v[144:147], a[20:23], v[104:107]
  ds_read_b64_tr_b16 v[188:189], v15 offset:30752
  v_mfma_f32_16x16x32_bf16 v[68:71], v[148:151], a[16:19], v[68:71]
  ds_read_b64_tr_b16 v[190:191], v15 offset:32032
  v_mfma_f32_16x16x32_bf16 v[108:111], v[148:151], a[20:23], v[108:111]
  ds_read_b64_tr_b16 v[192:193], v14 offset:30784
  v_mfma_f32_16x16x32_bf16 v[72:75], v[152:155], a[16:19], v[72:75]
  ds_read_b64_tr_b16 v[194:195], v14 offset:32064
  v_mfma_f32_16x16x32_bf16 v[112:115], v[152:155], a[20:23], v[112:115]
  ds_read_b64_tr_b16 v[196:197], v15 offset:30816
  ds_read_b64_tr_b16 v[198:199], v15 offset:32096
  v_mfma_f32_16x16x32_bf16 v[76:79], v[156:159], a[16:19], v[76:79]
  ds_read_b64_tr_b16 v[200:201], v14 offset:30848
  v_mfma_f32_16x16x32_bf16 v[116:119], v[156:159], a[20:23], v[116:119]
  ds_read_b64_tr_b16 v[202:203], v14 offset:32128
  v_mfma_f32_16x16x32_bf16 v[80:83], v[160:163], a[16:19], v[80:83]
  ds_read_b64_tr_b16 v[204:205], v15 offset:30880
  v_mfma_f32_16x16x32_bf16 v[120:123], v[160:163], a[20:23], v[120:123]
  ds_read_b64_tr_b16 v[206:207], v15 offset:32160
  v_mfma_f32_16x16x32_bf16 v[84:87], v[164:167], a[16:19], v[84:87]
  ds_read_b64_tr_b16 v[208:209], v14 offset:30912
  v_mfma_f32_16x16x32_bf16 v[124:127], v[164:167], a[20:23], v[124:127]
  ds_read_b64_tr_b16 v[210:211], v14 offset:32192
  ds_read_b64_tr_b16 v[212:213], v15 offset:30944
  v_mfma_f32_16x16x32_bf16 v[88:91], v[168:171], a[16:19], v[88:91]
  ds_read_b64_tr_b16 v[214:215], v15 offset:32224
  v_mfma_f32_16x16x32_bf16 v[128:131], v[168:171], a[20:23], v[128:131]
  buffer_load_dwordx4 a[96:99], v6, s[16:19], s48 offen offset:0 sc1
  ds_read_b64_tr_b16 v[216:217], v14 offset:30976
  v_mfma_f32_16x16x32_bf16 v[92:95], v[172:175], a[16:19], v[92:95]
  ds_read_b64_tr_b16 v[218:219], v14 offset:32256
  v_mfma_f32_16x16x32_bf16 v[132:135], v[172:175], a[20:23], v[132:135]
  ds_read_b64_tr_b16 v[220:221], v15 offset:31008
  v_mfma_f32_16x16x32_bf16 v[96:99], v[176:179], a[16:19], v[96:99]
  ds_read_b64_tr_b16 v[222:223], v15 offset:32288
  v_mfma_f32_16x16x32_bf16 v[136:139], v[176:179], a[20:23], v[136:139]
  buffer_load_dwordx4 a[100:103], v6, s[16:19], s48 offen offset:128 sc1
  v_mfma_f32_16x16x32_bf16 v[100:103], v[180:183], a[16:19], v[100:103]
  s_add_u32 s48, s48, 132096
  v_mfma_f32_16x16x32_bf16 v[140:143], v[180:183], a[20:23], v[140:143]
  s_waitcnt lgkmcnt(0) vmcnt(43)
  s_barrier
  v_mfma_f32_16x16x32_bf16 v[64:67], v[184:187], a[24:27], v[64:67]
  s_add_u32 m0, s46, 20480
  ds_read_b64_tr_b16 v[144:145], v14 offset:40960
  ds_read_b64_tr_b16 v[146:147], v14 offset:42240
  v_mfma_f32_16x16x32_bf16 v[104:107], v[184:187], a[28:31], v[104:107]
  s_add_u32 s49, s45, 655360
  ds_read_b64_tr_b16 v[148:149], v15 offset:40992
  v_mfma_f32_16x16x32_bf16 v[68:71], v[188:191], a[24:27], v[68:71]
  buffer_load_dwordx4 v8, s[24:27], s49 offen lds
  ds_read_b64_tr_b16 v[150:151], v15 offset:42272
  v_mfma_f32_16x16x32_bf16 v[108:111], v[188:191], a[28:31], v[108:111]
  s_add_u32 m0, s46, 21504
  ds_read_b64_tr_b16 v[152:153], v14 offset:41024
  v_mfma_f32_16x16x32_bf16 v[72:75], v[192:195], a[24:27], v[72:75]
  buffer_load_dwordx4 v9, s[24:27], s49 offen lds
  ds_read_b64_tr_b16 v[154:155], v14 offset:42304
  v_mfma_f32_16x16x32_bf16 v[112:115], v[192:195], a[28:31], v[112:115]
  s_add_u32 m0, s46, 22528
  ds_read_b64_tr_b16 v[156:157], v15 offset:41056
  ds_read_b64_tr_b16 v[158:159], v15 offset:42336
  v_mfma_f32_16x16x32_bf16 v[76:79], v[196:199], a[24:27], v[76:79]
  buffer_load_dwordx4 v10, s[24:27], s49 offen lds
  ds_read_b64_tr_b16 v[160:161], v14 offset:41088
  v_mfma_f32_16x16x32_bf16 v[116:119], v[196:199], a[28:31], v[116:119]
  s_add_u32 m0, s46, 23552
  ds_read_b64_tr_b16 v[162:163], v14 offset:42368
  v_mfma_f32_16x16x32_bf16 v[80:83], v[200:203], a[24:27], v[80:83]
  buffer_load_dwordx4 v11, s[24:27], s49 offen lds
  ds_read_b64_tr_b16 v[164:165], v15 offset:41120
  v_mfma_f32_16x16x32_bf16 v[120:123], v[200:203], a[28:31], v[120:123]
  s_add_u32 m0, s46, 24576
  ds_read_b64_tr_b16 v[166:167], v15 offset:42400
  v_mfma_f32_16x16x32_bf16 v[84:87], v[204:207], a[24:27], v[84:87]
  buffer_load_dwordx4 v12, s[24:27], s49 offen lds
  ds_read_b64_tr_b16 v[168:169], v14 offset:41152
  v_mfma_f32_16x16x32_bf16 v[124:127], v[204:207], a[28:31], v[124:127]
  ds_read_b64_tr_b16 v[170:171], v14 offset:42432
  ds_read_b64_tr_b16 v[172:173], v15 offset:41184
  v_mfma_f32_16x16x32_bf16 v[88:91], v[208:211], a[24:27], v[88:91]
  ds_read_b64_tr_b16 v[174:175], v15 offset:42464
  v_mfma_f32_16x16x32_bf16 v[128:131], v[208:211], a[28:31], v[128:131]
  buffer_load_dwordx4 a[104:107], v6, s[16:19], s48 offen offset:0 sc1
  ds_read_b64_tr_b16 v[176:177], v14 offset:41216
  v_mfma_f32_16x16x32_bf16 v[92:95], v[212:215], a[24:27], v[92:95]
  ds_read_b64_tr_b16 v[178:179], v14 offset:42496
  v_mfma_f32_16x16x32_bf16 v[132:135], v[212:215], a[28:31], v[132:135]
  ds_read_b64_tr_b16 v[180:181], v15 offset:41248
  v_mfma_f32_16x16x32_bf16 v[96:99], v[216:219], a[24:27], v[96:99]
  ds_read_b64_tr_b16 v[182:183], v15 offset:42528
  v_mfma_f32_16x16x32_bf16 v[136:139], v[216:219], a[28:31], v[136:139]
  buffer_load_dwordx4 a[108:111], v6, s[16:19], s48 offen offset:128 sc1
  v_mfma_f32_16x16x32_bf16 v[100:103], v[220:223], a[24:27], v[100:103]
  s_add_u32 s48, s48, 132096
  v_mfma_f32_16x16x32_bf16 v[140:143], v[220:223], a[28:31], v[140:143]
  s_waitcnt lgkmcnt(0) vmcnt(48)
  v_mfma_f32_16x16x32_bf16 v[64:67], v[144:147], a[32:35], v[64:67]
  ds_read_b64_tr_b16 v[184:185], v14 offset:51200
  ds_read_b64_tr_b16 v[186:187], v14 offset:52480
  v_mfma_f32_16x16x32_bf16 v[104:107], v[144:147], a[36:39], v[104:107]
  ds_read_b64_tr_b16 v[188:189], v15 offset:51232
  v_mfma_f32_16x16x32_bf16 v[68:71], v[148:151], a[32:35], v[68:71]
  ds_read_b64_tr_b16 v[190:191], v15 offset:52512
  v_mfma_f32_16x16x32_bf16 v[108:111], v[148:151], a[36:39], v[108:111]
  ds_read_b64_tr_b16 v[192:193], v14 offset:51264
  v_mfma_f32_16x16x32_bf16 v[72:75], v[152:155], a[32:35], v[72:75]
  ds_read_b64_tr_b16 v[194:195], v14 offset:52544
  v_mfma_f32_16x16x32_bf16 v[112:115], v[152:155], a[36:39], v[112:115]
  ds_read_b64_tr_b16 v[196:197], v15 offset:51296
  ds_read_b64_tr_b16 v[198:199], v15 offset:52576
  v_mfma_f32_16x16x32_bf16 v[76:79], v[156:159], a[32:35], v[76:79]
  ds_read_b64_tr_b16 v[200:201], v14 offset:51328
  v_mfma_f32_16x16x32_bf16 v[116:119], v[156:159], a[36:39], v[116:119]
  ds_read_b64_tr_b16 v[202:203], v14 offset:52608
  v_mfma_f32_16x16x32_bf16 v[80:83], v[160:163], a[32:35], v[80:83]
  ds_read_b64_tr_b16 v[204:205], v15 offset:51360
  v_mfma_f32_16x16x32_bf16 v[120:123], v[160:163], a[36:39], v[120:123]
  ds_read_b64_tr_b16 v[206:207], v15 offset:52640
  v_mfma_f32_16x16x32_bf16 v[84:87], v[164:167], a[32:35], v[84:87]
  ds_read_b64_tr_b16 v[208:209], v14 offset:51392
  v_mfma_f32_16x16x32_bf16 v[124:127], v[164:167], a[36:39], v[124:127]
  ds_read_b64_tr_b16 v[210:211], v14 offset:52672
  ds_read_b64_tr_b16 v[212:213], v15 offset:51424
  v_mfma_f32_16x16x32_bf16 v[88:91], v[168:171], a[32:35], v[88:91]
  ds_read_b64_tr_b16 v[214:215], v15 offset:52704
  v_mfma_f32_16x16x32_bf16 v[128:131], v[168:171], a[36:39], v[128:131]
  buffer_load_dwordx4 a[112:115], v6, s[16:19], s48 offen offset:0 sc1
  ds_read_b64_tr_b16 v[216:217], v14 offset:51456
  v_mfma_f32_16x16x32_bf16 v[92:95], v[172:175], a[32:35], v[92:95]
  ds_read_b64_tr_b16 v[218:219], v14 offset:52736
  v_mfma_f32_16x16x32_bf16 v[132:135], v[172:175], a[36:39], v[132:135]
  ds_read_b64_tr_b16 v[220:221], v15 offset:51488
  v_mfma_f32_16x16x32_bf16 v[96:99], v[176:179], a[32:35], v[96:99]
  ds_read_b64_tr_b16 v[222:223], v15 offset:52768
  v_mfma_f32_16x16x32_bf16 v[136:139], v[176:179], a[36:39], v[136:139]
  buffer_load_dwordx4 a[116:119], v6, s[16:19], s48 offen offset:128 sc1
  v_mfma_f32_16x16x32_bf16 v[100:103], v[180:183], a[32:35], v[100:103]
  s_add_u32 s48, s48, 132096
  v_mfma_f32_16x16x32_bf16 v[140:143], v[180:183], a[36:39], v[140:143]
  s_waitcnt lgkmcnt(0) vmcnt(43)
  s_barrier
  v_mfma_f32_16x16x32_bf16 v[64:67], v[184:187], a[40:43], v[64:67]
  s_add_u32 m0, s46, 40960
  ds_read_b64_tr_b16 v[144:145], v16 offset:0
  ds_read_b64_tr_b16 v[146:147], v16 offset:1280
  v_mfma_f32_16x16x32_bf16 v[104:107], v[184:187], a[44:47], v[104:107]
  s_add_u32 s49, s45, 737280
  ds_read_b64_tr_b16 v[148:149], v17 offset:32
  v_mfma_f32_16x16x32_bf16 v[68:71], v[188:191], a[40:43], v[68:71]
  buffer_load_dwordx4 v8, s[24:27], s49 offen lds
  ds_read_b64_tr_b16 v[150:151], v17 offset:1312
  v_mfma_f32_16x16x32_bf16 v[108:111], v[188:191], a[44:47], v[108:111]
  s_add_u32 m0, s46, 41984
  ds_read_b64_tr_b16 v[152:153], v16 offset:64
  v_mfma_f32_16x16x32_bf16 v[72:75], v[192:195], a[40:43], v[72:75]
  buffer_load_dwordx4 v9, s[24:27], s49 offen lds
  ds_read_b64_tr_b16 v[154:155], v16 offset:1344
  v_mfma_f32_16x16x32_bf16 v[112:115], v[192:195], a[44:47], v[112:115]
  s_add_u32 m0, s46, 43008
  ds_read_b64_tr_b16 v[156:157], v17 offset:96
  ds_read_b64_tr_b16 v[158:159], v17 offset:1376
  v_mfma_f32_16x16x32_bf16 v[76:79], v[196:199], a[40:43], v[76:79]
  buffer_load_dwordx4 v10, s[24:27], s49 offen lds
  ds_read_b64_tr_b16 v[160:161], v16 offset:128
  v_mfma_f32_16x16x32_bf16 v[116:119], v[196:199], a[44:47], v[116:119]
  s_add_u32 m0, s46, 44032
  ds_read_b64_tr_b16 v[162:163], v16 offset:1408
  v_mfma_f32_16x16x32_bf16 v[80:83], v[200:203], a[40:43], v[80:83]
  buffer_load_dwordx4 v11, s[24:27], s49 offen lds
  ds_read_b64_tr_b16 v[164:165], v17 offset:160
  v_mfma_f32_16x16x32_bf16 v[120:123], v[200:203], a[44:47], v[120:123]
  s_add_u32 m0, s46, 45056
  ds_read_b64_tr_b16 v[166:167], v17 offset:1440
  v_mfma_f32_16x16x32_bf16 v[84:87], v[204:207], a[40:43], v[84:87]
  buffer_load_dwordx4 v12, s[24:27], s49 offen lds
  ds_read_b64_tr_b16 v[168:169], v16 offset:192
  v_mfma_f32_16x16x32_bf16 v[124:127], v[204:207], a[44:47], v[124:127]
  ds_read_b64_tr_b16 v[170:171], v16 offset:1472
  ds_read_b64_tr_b16 v[172:173], v17 offset:224
  v_mfma_f32_16x16x32_bf16 v[88:91], v[208:211], a[40:43], v[88:91]
  ds_read_b64_tr_b16 v[174:175], v17 offset:1504
  v_mfma_f32_16x16x32_bf16 v[128:131], v[208:211], a[44:47], v[128:131]
  buffer_load_dwordx4 a[120:123], v6, s[16:19], s48 offen offset:0 sc1
  ds_read_b64_tr_b16 v[176:177], v16 offset:256
  v_mfma_f32_16x16x32_bf16 v[92:95], v[212:215], a[40:43], v[92:95]
  ds_read_b64_tr_b16 v[178:179], v16 offset:1536
  v_mfma_f32_16x16x32_bf16 v[132:135], v[212:215], a[44:47], v[132:135]
  ds_read_b64_tr_b16 v[180:181], v17 offset:288
  v_mfma_f32_16x16x32_bf16 v[96:99], v[216:219], a[40:43], v[96:99]
  ds_read_b64_tr_b16 v[182:183], v17 offset:1568
  v_mfma_f32_16x16x32_bf16 v[136:139], v[216:219], a[44:47], v[136:139]
  buffer_load_dwordx4 a[124:127], v6, s[16:19], s48 offen offset:128 sc1
  v_mfma_f32_16x16x32_bf16 v[100:103], v[220:223], a[40:43], v[100:103]
  s_add_u32 s48, s48, 132096
  v_mfma_f32_16x16x32_bf16 v[140:143], v[220:223], a[44:47], v[140:143]
  s_waitcnt lgkmcnt(0) vmcnt(48)
  v_mfma_f32_16x16x32_bf16 v[64:67], v[144:147], a[48:51], v[64:67]
  ds_read_b64_tr_b16 v[184:185], v16 offset:10240
  ds_read_b64_tr_b16 v[186:187], v16 offset:11520
  v_mfma_f32_16x16x32_bf16 v[104:107], v[144:147], a[52:55], v[104:107]
  ds_read_b64_tr_b16 v[188:189], v17 offset:10272
  v_mfma_f32_16x16x32_bf16 v[68:71], v[148:151], a[48:51], v[68:71]
  ds_read_b64_tr_b16 v[190:191], v17 offset:11552
  v_mfma_f32_16x16x32_bf16 v[108:111], v[148:151], a[52:55], v[108:111]
  ds_read_b64_tr_b16 v[192:193], v16 offset:10304
  v_mfma_f32_16x16x32_bf16 v[72:75], v[152:155], a[48:51], v[72:75]
  ds_read_b64_tr_b16 v[194:195], v16 offset:11584
  v_mfma_f32_16x16x32_bf16 v[112:115], v[152:155], a[52:55], v[112:115]
  ds_read_b64_tr_b16 v[196:197], v17 offset:10336
  ds_read_b64_tr_b16 v[198:199], v17 offset:11616
  v_mfma_f32_16x16x32_bf16 v[76:79], v[156:159], a[48:51], v[76:79]
  ds_read_b64_tr_b16 v[200:201], v16 offset:10368
  v_mfma_f32_16x16x32_bf16 v[116:119], v[156:159], a[52:55], v[116:119]
  ds_read_b64_tr_b16 v[202:203], v16 offset:11648
  v_mfma_f32_16x16x32_bf16 v[80:83], v[160:163], a[48:51], v[80:83]
  ds_read_b64_tr_b16 v[204:205], v17 offset:10400
  v_mfma_f32_16x16x32_bf16 v[120:123], v[160:163], a[52:55], v[120:123]
  ds_read_b64_tr_b16 v[206:207], v17 offset:11680
  v_mfma_f32_16x16x32_bf16 v[84:87], v[164:167], a[48:51], v[84:87]
  ds_read_b64_tr_b16 v[208:209], v16 offset:10432
  v_mfma_f32_16x16x32_bf16 v[124:127], v[164:167], a[52:55], v[124:127]
  ds_read_b64_tr_b16 v[210:211], v16 offset:11712
  ds_read_b64_tr_b16 v[212:213], v17 offset:10464
  v_mfma_f32_16x16x32_bf16 v[88:91], v[168:171], a[48:51], v[88:91]
  ds_read_b64_tr_b16 v[214:215], v17 offset:11744
  v_mfma_f32_16x16x32_bf16 v[128:131], v[168:171], a[52:55], v[128:131]
  buffer_load_dwordx4 a[128:131], v6, s[16:19], s48 offen offset:0 sc1
  ds_read_b64_tr_b16 v[216:217], v16 offset:10496
  v_mfma_f32_16x16x32_bf16 v[92:95], v[172:175], a[48:51], v[92:95]
  ds_read_b64_tr_b16 v[218:219], v16 offset:11776
  v_mfma_f32_16x16x32_bf16 v[132:135], v[172:175], a[52:55], v[132:135]
  ds_read_b64_tr_b16 v[220:221], v17 offset:10528
  v_mfma_f32_16x16x32_bf16 v[96:99], v[176:179], a[48:51], v[96:99]
  ds_read_b64_tr_b16 v[222:223], v17 offset:11808
  v_mfma_f32_16x16x32_bf16 v[136:139], v[176:179], a[52:55], v[136:139]
  buffer_load_dwordx4 a[132:135], v6, s[16:19], s48 offen offset:128 sc1
  v_mfma_f32_16x16x32_bf16 v[100:103], v[180:183], a[48:51], v[100:103]
  s_add_u32 s48, s48, 132096
  v_mfma_f32_16x16x32_bf16 v[140:143], v[180:183], a[52:55], v[140:143]
  s_waitcnt lgkmcnt(0) vmcnt(43)
  s_barrier
  v_mfma_f32_16x16x32_bf16 v[64:67], v[184:187], a[56:59], v[64:67]
  ds_read_b64_tr_b16 v[144:145], v16 offset:20480
  ds_read_b64_tr_b16 v[146:147], v16 offset:21760
  v_mfma_f32_16x16x32_bf16 v[104:107], v[184:187], a[60:63], v[104:107]
  ds_read_b64_tr_b16 v[148:149], v17 offset:20512
  v_mfma_f32_16x16x32_bf16 v[68:71], v[188:191], a[56:59], v[68:71]
  ds_read_b64_tr_b16 v[150:151], v17 offset:21792
  v_mfma_f32_16x16x32_bf16 v[108:111], v[188:191], a[60:63], v[108:111]
  ds_read_b64_tr_b16 v[152:153], v16 offset:20544
  v_mfma_f32_16x16x32_bf16 v[72:75], v[192:195], a[56:59], v[72:75]
  ds_read_b64_tr_b16 v[154:155], v16 offset:21824
  v_mfma_f32_16x16x32_bf16 v[112:115], v[192:195], a[60:63], v[112:115]
  ds_read_b64_tr_b16 v[156:157], v17 offset:20576
  ds_read_b64_tr_b16 v[158:159], v17 offset:21856
  v_mfma_f32_16x16x32_bf16 v[76:79], v[196:199], a[56:59], v[76:79]
  ds_read_b64_tr_b16 v[160:161], v16 offset:20608
  v_mfma_f32_16x16x32_bf16 v[116:119], v[196:199], a[60:63], v[116:119]
  ds_read_b64_tr_b16 v[162:163], v16 offset:21888
  v_mfma_f32_16x16x32_bf16 v[80:83], v[200:203], a[56:59], v[80:83]
  ds_read_b64_tr_b16 v[164:165], v17 offset:20640
  v_mfma_f32_16x16x32_bf16 v[120:123], v[200:203], a[60:63], v[120:123]
  ds_read_b64_tr_b16 v[166:167], v17 offset:21920
  v_mfma_f32_16x16x32_bf16 v[84:87], v[204:207], a[56:59], v[84:87]
  ds_read_b64_tr_b16 v[168:169], v16 offset:20672
  v_mfma_f32_16x16x32_bf16 v[124:127], v[204:207], a[60:63], v[124:127]
  ds_read_b64_tr_b16 v[170:171], v16 offset:21952
  ds_read_b64_tr_b16 v[172:173], v17 offset:20704
  v_mfma_f32_16x16x32_bf16 v[88:91], v[208:211], a[56:59], v[88:91]
  ds_read_b64_tr_b16 v[174:175], v17 offset:21984
  v_mfma_f32_16x16x32_bf16 v[128:131], v[208:211], a[60:63], v[128:131]
  buffer_load_dwordx4 a[136:139], v6, s[16:19], s48 offen offset:0 sc1
  ds_read_b64_tr_b16 v[176:177], v16 offset:20736
  v_mfma_f32_16x16x32_bf16 v[92:95], v[212:215], a[56:59], v[92:95]
  ds_read_b64_tr_b16 v[178:179], v16 offset:22016
  v_mfma_f32_16x16x32_bf16 v[132:135], v[212:215], a[60:63], v[132:135]
  ds_read_b64_tr_b16 v[180:181], v17 offset:20768
  v_mfma_f32_16x16x32_bf16 v[96:99], v[216:219], a[56:59], v[96:99]
  ds_read_b64_tr_b16 v[182:183], v17 offset:22048
  v_mfma_f32_16x16x32_bf16 v[136:139], v[216:219], a[60:63], v[136:139]
  buffer_load_dwordx4 a[140:143], v6, s[16:19], s48 offen offset:128 sc1
  v_mfma_f32_16x16x32_bf16 v[100:103], v[220:223], a[56:59], v[100:103]
  s_add_u32 s48, s48, 132096
  v_mfma_f32_16x16x32_bf16 v[140:143], v[220:223], a[60:63], v[140:143]
  s_waitcnt lgkmcnt(0) vmcnt(43)
  v_mfma_f32_16x16x32_bf16 v[64:67], v[144:147], a[64:67], v[64:67]
  ds_read_b64_tr_b16 v[184:185], v16 offset:30720
  ds_read_b64_tr_b16 v[186:187], v16 offset:32000
  v_mfma_f32_16x16x32_bf16 v[104:107], v[144:147], a[68:71], v[104:107]
  ds_read_b64_tr_b16 v[188:189], v17 offset:30752
  v_mfma_f32_16x16x32_bf16 v[68:71], v[148:151], a[64:67], v[68:71]
  ds_read_b64_tr_b16 v[190:191], v17 offset:32032
  v_mfma_f32_16x16x32_bf16 v[108:111], v[148:151], a[68:71], v[108:111]
  ds_read_b64_tr_b16 v[192:193], v16 offset:30784
  v_mfma_f32_16x16x32_bf16 v[72:75], v[152:155], a[64:67], v[72:75]
  ds_read_b64_tr_b16 v[194:195], v16 offset:32064
  v_mfma_f32_16x16x32_bf16 v[112:115], v[152:155], a[68:71], v[112:115]
  ds_read_b64_tr_b16 v[196:197], v17 offset:30816
  ds_read_b64_tr_b16 v[198:199], v17 offset:32096
  v_mfma_f32_16x16x32_bf16 v[76:79], v[156:159], a[64:67], v[76:79]
  ds_read_b64_tr_b16 v[200:201], v16 offset:30848
  v_mfma_f32_16x16x32_bf16 v[116:119], v[156:159], a[68:71], v[116:119]
  ds_read_b64_tr_b16 v[202:203], v16 offset:32128
  v_mfma_f32_16x16x32_bf16 v[80:83], v[160:163], a[64:67], v[80:83]
  ds_read_b64_tr_b16 v[204:205], v17 offset:30880
  v_mfma_f32_16x16x32_bf16 v[120:123], v[160:163], a[68:71], v[120:123]
  ds_read_b64_tr_b16 v[206:207], v17 offset:32160
  v_mfma_f32_16x16x32_bf16 v[84:87], v[164:167], a[64:67], v[84:87]
  ds_read_b64_tr_b16 v[208:209], v16 offset:30912
  v_mfma_f32_16x16x32_bf16 v[124:127], v[164:167], a[68:71], v[124:127]
  ds_read_b64_tr_b16 v[210:211], v16 offset:32192
  ds_read_b64_tr_b16 v[212:213], v17 offset:30944
  v_mfma_f32_16x16x32_bf16 v[88:91], v[168:171], a[64:67], v[88:91]
  ds_read_b64_tr_b16 v[214:215], v17 offset:32224
  v_mfma_f32_16x16x32_bf16 v[128:131], v[168:171], a[68:71], v[128:131]
  buffer_load_dwordx4 a[144:147], v6, s[16:19], s48 offen offset:0 sc1
  ds_read_b64_tr_b16 v[216:217], v16 offset:30976
  v_mfma_f32_16x16x32_bf16 v[92:95], v[172:175], a[64:67], v[92:95]
  ds_read_b64_tr_b16 v[218:219], v16 offset:32256
  v_mfma_f32_16x16x32_bf16 v[132:135], v[172:175], a[68:71], v[132:135]
  ds_read_b64_tr_b16 v[220:221], v17 offset:31008
  v_mfma_f32_16x16x32_bf16 v[96:99], v[176:179], a[64:67], v[96:99]
  ds_read_b64_tr_b16 v[222:223], v17 offset:32288
  v_mfma_f32_16x16x32_bf16 v[136:139], v[176:179], a[68:71], v[136:139]
  buffer_load_dwordx4 a[148:151], v6, s[16:19], s48 offen offset:128 sc1
  v_mfma_f32_16x16x32_bf16 v[100:103], v[180:183], a[64:67], v[100:103]
  s_add_u32 s48, s48, 132096
  v_mfma_f32_16x16x32_bf16 v[140:143], v[180:183], a[68:71], v[140:143]
  s_waitcnt lgkmcnt(0) vmcnt(38)
  s_barrier
  v_mfma_f32_16x16x32_bf16 v[64:67], v[184:187], a[72:75], v[64:67]
  ds_read_b64_tr_b16 v[144:145], v16 offset:40960
  ds_read_b64_tr_b16 v[146:147], v16 offset:42240
  v_mfma_f32_16x16x32_bf16 v[104:107], v[184:187], a[76:79], v[104:107]
  ds_read_b64_tr_b16 v[148:149], v17 offset:40992
  v_mfma_f32_16x16x32_bf16 v[68:71], v[188:191], a[72:75], v[68:71]
  ds_read_b64_tr_b16 v[150:151], v17 offset:42272
  v_mfma_f32_16x16x32_bf16 v[108:111], v[188:191], a[76:79], v[108:111]
  ds_read_b64_tr_b16 v[152:153], v16 offset:41024
  v_mfma_f32_16x16x32_bf16 v[72:75], v[192:195], a[72:75], v[72:75]
  ds_read_b64_tr_b16 v[154:155], v16 offset:42304
  v_mfma_f32_16x16x32_bf16 v[112:115], v[192:195], a[76:79], v[112:115]
  ds_read_b64_tr_b16 v[156:157], v17 offset:41056
  ds_read_b64_tr_b16 v[158:159], v17 offset:42336
  v_mfma_f32_16x16x32_bf16 v[76:79], v[196:199], a[72:75], v[76:79]
  ds_read_b64_tr_b16 v[160:161], v16 offset:41088
  v_mfma_f32_16x16x32_bf16 v[116:119], v[196:199], a[76:79], v[116:119]
  ds_read_b64_tr_b16 v[162:163], v16 offset:42368
  v_mfma_f32_16x16x32_bf16 v[80:83], v[200:203], a[72:75], v[80:83]
  ds_read_b64_tr_b16 v[164:165], v17 offset:41120
  v_mfma_f32_16x16x32_bf16 v[120:123], v[200:203], a[76:79], v[120:123]
  ds_read_b64_tr_b16 v[166:167], v17 offset:42400
  v_mfma_f32_16x16x32_bf16 v[84:87], v[204:207], a[72:75], v[84:87]
  ds_read_b64_tr_b16 v[168:169], v16 offset:41152
  v_mfma_f32_16x16x32_bf16 v[124:127], v[204:207], a[76:79], v[124:127]
  ds_read_b64_tr_b16 v[170:171], v16 offset:42432
  ds_read_b64_tr_b16 v[172:173], v17 offset:41184
  v_mfma_f32_16x16x32_bf16 v[88:91], v[208:211], a[72:75], v[88:91]
  ds_read_b64_tr_b16 v[174:175], v17 offset:42464
  v_mfma_f32_16x16x32_bf16 v[128:131], v[208:211], a[76:79], v[128:131]
  buffer_load_dwordx4 a[152:155], v6, s[16:19], s48 offen offset:0 sc1
  ds_read_b64_tr_b16 v[176:177], v16 offset:41216
  v_mfma_f32_16x16x32_bf16 v[92:95], v[212:215], a[72:75], v[92:95]
  ds_read_b64_tr_b16 v[178:179], v16 offset:42496
  v_mfma_f32_16x16x32_bf16 v[132:135], v[212:215], a[76:79], v[132:135]
  ds_read_b64_tr_b16 v[180:181], v17 offset:41248
  v_mfma_f32_16x16x32_bf16 v[96:99], v[216:219], a[72:75], v[96:99]
  ds_read_b64_tr_b16 v[182:183], v17 offset:42528
  v_mfma_f32_16x16x32_bf16 v[136:139], v[216:219], a[76:79], v[136:139]
  buffer_load_dwordx4 a[156:159], v6, s[16:19], s48 offen offset:128 sc1
  v_mfma_f32_16x16x32_bf16 v[100:103], v[220:223], a[72:75], v[100:103]
  s_add_u32 s48, s48, 132096
  v_mfma_f32_16x16x32_bf16 v[140:143], v[220:223], a[76:79], v[140:143]
  s_waitcnt lgkmcnt(0) vmcnt(33)
  v_mfma_f32_16x16x32_bf16 v[64:67], v[144:147], a[80:83], v[64:67]
  ds_read_b64_tr_b16 v[184:185], v16 offset:51200
  ds_read_b64_tr_b16 v[186:187], v16 offset:52480
  v_mfma_f32_16x16x32_bf16 v[104:107], v[144:147], a[84:87], v[104:107]
  ds_read_b64_tr_b16 v[188:189], v17 offset:51232
  v_mfma_f32_16x16x32_bf16 v[68:71], v[148:151], a[80:83], v[68:71]
  ds_read_b64_tr_b16 v[190:191], v17 offset:52512
  v_mfma_f32_16x16x32_bf16 v[108:111], v[148:151], a[84:87], v[108:111]
  ds_read_b64_tr_b16 v[192:193], v16 offset:51264
  v_mfma_f32_16x16x32_bf16 v[72:75], v[152:155], a[80:83], v[72:75]
  ds_read_b64_tr_b16 v[194:195], v16 offset:52544
  v_mfma_f32_16x16x32_bf16 v[112:115], v[152:155], a[84:87], v[112:115]
  ds_read_b64_tr_b16 v[196:197], v17 offset:51296
  ds_read_b64_tr_b16 v[198:199], v17 offset:52576
  v_mfma_f32_16x16x32_bf16 v[76:79], v[156:159], a[80:83], v[76:79]
  ds_read_b64_tr_b16 v[200:201], v16 offset:51328
  v_mfma_f32_16x16x32_bf16 v[116:119], v[156:159], a[84:87], v[116:119]
  ds_read_b64_tr_b16 v[202:203], v16 offset:52608
  v_mfma_f32_16x16x32_bf16 v[80:83], v[160:163], a[80:83], v[80:83]
  ds_read_b64_tr_b16 v[204:205], v17 offset:51360
  v_mfma_f32_16x16x32_bf16 v[120:123], v[160:163], a[84:87], v[120:123]
  ds_read_b64_tr_b16 v[206:207], v17 offset:52640
  v_mfma_f32_16x16x32_bf16 v[84:87], v[164:167], a[80:83], v[84:87]
  ds_read_b64_tr_b16 v[208:209], v16 offset:51392
  v_mfma_f32_16x16x32_bf16 v[124:127], v[164:167], a[84:87], v[124:127]
  ds_read_b64_tr_b16 v[210:211], v16 offset:52672
  ds_read_b64_tr_b16 v[212:213], v17 offset:51424
  v_mfma_f32_16x16x32_bf16 v[88:91], v[168:171], a[80:83], v[88:91]
  ds_read_b64_tr_b16 v[214:215], v17 offset:52704
  v_mfma_f32_16x16x32_bf16 v[128:131], v[168:171], a[84:87], v[128:131]
  buffer_load_dwordx4 v[52:55], v4, s[12:15], 0 offen
  ds_read_b64_tr_b16 v[216:217], v16 offset:51456
  v_mfma_f32_16x16x32_bf16 v[92:95], v[172:175], a[80:83], v[92:95]
  ds_read_b64_tr_b16 v[218:219], v16 offset:52736
  v_mfma_f32_16x16x32_bf16 v[132:135], v[172:175], a[84:87], v[132:135]
  ds_read_b64_tr_b16 v[220:221], v17 offset:51488
  v_mfma_f32_16x16x32_bf16 v[96:99], v[176:179], a[80:83], v[96:99]
  ds_read_b64_tr_b16 v[222:223], v17 offset:52768
  v_mfma_f32_16x16x32_bf16 v[136:139], v[176:179], a[84:87], v[136:139]
  buffer_load_dword v56, v5, s[12:15], 0 offen offset:1024
  v_mfma_f32_16x16x32_bf16 v[100:103], v[180:183], a[80:83], v[100:103]
  s_mul_i32 s50, s59, 1280
  v_mfma_f32_16x16x32_bf16 v[140:143], v[180:183], a[84:87], v[140:143]
  s_waitcnt lgkmcnt(0) vmcnt(28)
  s_barrier
  v_mfma_f32_16x16x32_bf16 v[64:67], v[184:187], a[88:91], v[64:67]
  ds_read_b64_tr_b16 v[144:145], v18 offset:0
  ds_read_b64_tr_b16 v[146:147], v18 offset:1280
  v_mfma_f32_16x16x32_bf16 v[104:107], v[184:187], a[92:95], v[104:107]
  ds_read_b64_tr_b16 v[148:149], v19 offset:32
  v_mfma_f32_16x16x32_bf16 v[68:71], v[188:191], a[88:91], v[68:71]
  ds_read_b64_tr_b16 v[150:151], v19 offset:1312
  v_mfma_f32_16x16x32_bf16 v[108:111], v[188:191], a[92:95], v[108:111]
  ds_read_b64_tr_b16 v[152:153], v18 offset:64
  v_mfma_f32_16x16x32_bf16 v[72:75], v[192:195], a[88:91], v[72:75]
  ds_read_b64_tr_b16 v[154:155], v18 offset:1344
  v_mfma_f32_16x16x32_bf16 v[112:115], v[192:195], a[92:95], v[112:115]
  ds_read_b64_tr_b16 v[156:157], v19 offset:96
  ds_read_b64_tr_b16 v[158:159], v19 offset:1376
  v_mfma_f32_16x16x32_bf16 v[76:79], v[196:199], a[88:91], v[76:79]
  ds_read_b64_tr_b16 v[160:161], v18 offset:128
  v_mfma_f32_16x16x32_bf16 v[116:119], v[196:199], a[92:95], v[116:119]
  ds_read_b64_tr_b16 v[162:163], v18 offset:1408
  v_mfma_f32_16x16x32_bf16 v[80:83], v[200:203], a[88:91], v[80:83]
  ds_read_b64_tr_b16 v[164:165], v19 offset:160
  v_mfma_f32_16x16x32_bf16 v[120:123], v[200:203], a[92:95], v[120:123]
  ds_read_b64_tr_b16 v[166:167], v19 offset:1440
  v_mfma_f32_16x16x32_bf16 v[84:87], v[204:207], a[88:91], v[84:87]
  ds_read_b64_tr_b16 v[168:169], v18 offset:192
  v_mfma_f32_16x16x32_bf16 v[124:127], v[204:207], a[92:95], v[124:127]
  ds_read_b64_tr_b16 v[170:171], v18 offset:1472
  ds_read_b64_tr_b16 v[172:173], v19 offset:224
  v_mfma_f32_16x16x32_bf16 v[88:91], v[208:211], a[88:91], v[88:91]
  ds_read_b64_tr_b16 v[174:175], v19 offset:1504
  v_mfma_f32_16x16x32_bf16 v[128:131], v[208:211], a[92:95], v[128:131]
  buffer_load_dwordx4 v[224:227], v4, s[8:11], s50 offen
  ds_read_b64_tr_b16 v[176:177], v18 offset:256
  v_mfma_f32_16x16x32_bf16 v[92:95], v[212:215], a[88:91], v[92:95]
  ds_read_b64_tr_b16 v[178:179], v18 offset:1536
  v_mfma_f32_16x16x32_bf16 v[132:135], v[212:215], a[92:95], v[132:135]
  ds_read_b64_tr_b16 v[180:181], v19 offset:288
  v_mfma_f32_16x16x32_bf16 v[96:99], v[216:219], a[88:91], v[96:99]
  ds_read_b64_tr_b16 v[182:183], v19 offset:1568
  v_mfma_f32_16x16x32_bf16 v[136:139], v[216:219], a[92:95], v[136:139]
  buffer_load_dword v228, v5, s[8:11], s50 offen offset:1024
  v_mfma_f32_16x16x32_bf16 v[100:103], v[220:223], a[88:91], v[100:103]
  s_add_u32 s50, s50, 1280
  v_mfma_f32_16x16x32_bf16 v[140:143], v[220:223], a[92:95], v[140:143]
  s_waitcnt lgkmcnt(0) vmcnt(28)
  v_mfma_f32_16x16x32_bf16 v[64:67], v[144:147], a[96:99], v[64:67]
  ds_read_b64_tr_b16 v[184:185], v18 offset:10240
  ds_read_b64_tr_b16 v[186:187], v18 offset:11520
  v_mfma_f32_16x16x32_bf16 v[104:107], v[144:147], a[100:103], v[104:107]
  ds_read_b64_tr_b16 v[188:189], v19 offset:10272
  v_mfma_f32_16x16x32_bf16 v[68:71], v[148:151], a[96:99], v[68:71]
  ds_read_b64_tr_b16 v[190:191], v19 offset:11552
  v_mfma_f32_16x16x32_bf16 v[108:111], v[148:151], a[100:103], v[108:111]
  ds_read_b64_tr_b16 v[192:193], v18 offset:10304
  v_mfma_f32_16x16x32_bf16 v[72:75], v[152:155], a[96:99], v[72:75]
  ds_read_b64_tr_b16 v[194:195], v18 offset:11584
  v_mfma_f32_16x16x32_bf16 v[112:115], v[152:155], a[100:103], v[112:115]
  ds_read_b64_tr_b16 v[196:197], v19 offset:10336
  ds_read_b64_tr_b16 v[198:199], v19 offset:11616
  v_mfma_f32_16x16x32_bf16 v[76:79], v[156:159], a[96:99], v[76:79]
  ds_read_b64_tr_b16 v[200:201], v18 offset:10368
  v_mfma_f32_16x16x32_bf16 v[116:119], v[156:159], a[100:103], v[116:119]
  ds_read_b64_tr_b16 v[202:203], v18 offset:11648
  v_mfma_f32_16x16x32_bf16 v[80:83], v[160:163], a[96:99], v[80:83]
  ds_read_b64_tr_b16 v[204:205], v19 offset:10400
  v_mfma_f32_16x16x32_bf16 v[120:123], v[160:163], a[100:103], v[120:123]
  ds_read_b64_tr_b16 v[206:207], v19 offset:11680
  v_mfma_f32_16x16x32_bf16 v[84:87], v[164:167], a[96:99], v[84:87]
  ds_read_b64_tr_b16 v[208:209], v18 offset:10432
  v_mfma_f32_16x16x32_bf16 v[124:127], v[164:167], a[100:103], v[124:127]
  ds_read_b64_tr_b16 v[210:211], v18 offset:11712
  ds_read_b64_tr_b16 v[212:213], v19 offset:10464
  v_mfma_f32_16x16x32_bf16 v[88:91], v[168:171], a[96:99], v[88:91]
  ds_read_b64_tr_b16 v[214:215], v19 offset:11744
  v_mfma_f32_16x16x32_bf16 v[128:131], v[168:171], a[100:103], v[128:131]
  buffer_load_dwordx4 v[230:233], v4, s[8:11], s50 offen
  ds_read_b64_tr_b16 v[216:217], v18 offset:10496
  v_mfma_f32_16x16x32_bf16 v[92:95], v[172:175], a[96:99], v[92:95]
  ds_read_b64_tr_b16 v[218:219], v18 offset:11776
  v_mfma_f32_16x16x32_bf16 v[132:135], v[172:175], a[100:103], v[132:135]
  ds_read_b64_tr_b16 v[220:221], v19 offset:10528
  v_mfma_f32_16x16x32_bf16 v[96:99], v[176:179], a[96:99], v[96:99]
  ds_read_b64_tr_b16 v[222:223], v19 offset:11808
  v_mfma_f32_16x16x32_bf16 v[136:139], v[176:179], a[100:103], v[136:139]
  buffer_load_dword v234, v5, s[8:11], s50 offen offset:1024
  v_mfma_f32_16x16x32_bf16 v[100:103], v[180:183], a[96:99], v[100:103]
  s_add_u32 s50, s50, 1280
  v_mfma_f32_16x16x32_bf16 v[140:143], v[180:183], a[100:103], v[140:143]
  s_waitcnt lgkmcnt(0) vmcnt(23)
  s_barrier
  v_mfma_f32_16x16x32_bf16 v[64:67], v[184:187], a[104:107], v[64:67]
  ds_read_b64_tr_b16 v[144:145], v14 offset:0
  ds_read_b64_tr_b16 v[146:147], v14 offset:1280
  v_mfma_f32_16x16x32_bf16 v[104:107], v[184:187], a[108:111], v[104:107]
  ds_read_b64_tr_b16 v[148:149], v15 offset:32
  v_mfma_f32_16x16x32_bf16 v[68:71], v[188:191], a[104:107], v[68:71]
  ds_read_b64_tr_b16 v[150:151], v15 offset:1312
  v_mfma_f32_16x16x32_bf16 v[108:111], v[188:191], a[108:111], v[108:111]
  ds_read_b64_tr_b16 v[152:153], v14 offset:64
  v_mfma_f32_16x16x32_bf16 v[72:75], v[192:195], a[104:107], v[72:75]
  ds_read_b64_tr_b16 v[154:155], v14 offset:1344
  v_mfma_f32_16x16x32_bf16 v[112:115], v[192:195], a[108:111], v[112:115]
  ds_read_b64_tr_b16 v[156:157], v15 offset:96
  ds_read_b64_tr_b16 v[158:159], v15 offset:1376
  v_mfma_f32_16x16x32_bf16 v[76:79], v[196:199], a[104:107], v[76:79]
  ds_read_b64_tr_b16 v[160:161], v14 offset:128
  v_mfma_f32_16x16x32_bf16 v[116:119], v[196:199], a[108:111], v[116:119]
  ds_read_b64_tr_b16 v[162:163], v14 offset:1408
  v_mfma_f32_16x16x32_bf16 v[80:83], v[200:203], a[104:107], v[80:83]
  ds_read_b64_tr_b16 v[164:165], v15 offset:160
  v_mfma_f32_16x16x32_bf16 v[120:123], v[200:203], a[108:111], v[120:123]
  ds_read_b64_tr_b16 v[166:167], v15 offset:1440
  v_mfma_f32_16x16x32_bf16 v[84:87], v[204:207], a[104:107], v[84:87]
  ds_read_b64_tr_b16 v[168:169], v14 offset:192
  v_mfma_f32_16x16x32_bf16 v[124:127], v[204:207], a[108:111], v[124:127]
  ds_read_b64_tr_b16 v[170:171], v14 offset:1472
  ds_read_b64_tr_b16 v[172:173], v15 offset:224
  v_mfma_f32_16x16x32_bf16 v[88:91], v[208:211], a[104:107], v[88:91]
  ds_read_b64_tr_b16 v[174:175], v15 offset:1504
  v_mfma_f32_16x16x32_bf16 v[128:131], v[208:211], a[108:111], v[128:131]
  buffer_load_dwordx4 v[236:239], v4, s[8:11], s50 offen
  ds_read_b64_tr_b16 v[176:177], v14 offset:256
  v_mfma_f32_16x16x32_bf16 v[92:95], v[212:215], a[104:107], v[92:95]
  ds_read_b64_tr_b16 v[178:179], v14 offset:1536
  v_mfma_f32_16x16x32_bf16 v[132:135], v[212:215], a[108:111], v[132:135]
  ds_read_b64_tr_b16 v[180:181], v15 offset:288
  v_mfma_f32_16x16x32_bf16 v[96:99], v[216:219], a[104:107], v[96:99]
  ds_read_b64_tr_b16 v[182:183], v15 offset:1568
  v_mfma_f32_16x16x32_bf16 v[136:139], v[216:219], a[108:111], v[136:139]
  buffer_load_dword v240, v5, s[8:11], s50 offen offset:1024
  v_mfma_f32_16x16x32_bf16 v[100:103], v[220:223], a[104:107], v[100:103]
  s_add_u32 s50, s50, 1280
  v_mfma_f32_16x16x32_bf16 v[140:143], v[220:223], a[108:111], v[140:143]
  s_waitcnt lgkmcnt(0) vmcnt(23)
  v_mfma_f32_16x16x32_bf16 v[64:67], v[144:147], a[112:115], v[64:67]
  ds_read_b64_tr_b16 v[184:185], v14 offset:10240
  ds_read_b64_tr_b16 v[186:187], v14 offset:11520
  v_mfma_f32_16x16x32_bf16 v[104:107], v[144:147], a[116:119], v[104:107]
  ds_read_b64_tr_b16 v[188:189], v15 offset:10272
  v_mfma_f32_16x16x32_bf16 v[68:71], v[148:151], a[112:115], v[68:71]
  ds_read_b64_tr_b16 v[190:191], v15 offset:11552
  v_mfma_f32_16x16x32_bf16 v[108:111], v[148:151], a[116:119], v[108:111]
  ds_read_b64_tr_b16 v[192:193], v14 offset:10304
  v_mfma_f32_16x16x32_bf16 v[72:75], v[152:155], a[112:115], v[72:75]
  ds_read_b64_tr_b16 v[194:195], v14 offset:11584
  v_mfma_f32_16x16x32_bf16 v[112:115], v[152:155], a[116:119], v[112:115]
  ds_read_b64_tr_b16 v[196:197], v15 offset:10336
  ds_read_b64_tr_b16 v[198:199], v15 offset:11616
  v_mfma_f32_16x16x32_bf16 v[76:79], v[156:159], a[112:115], v[76:79]
  ds_read_b64_tr_b16 v[200:201], v14 offset:10368
  v_mfma_f32_16x16x32_bf16 v[116:119], v[156:159], a[116:119], v[116:119]
  ds_read_b64_tr_b16 v[202:203], v14 offset:11648
  v_mfma_f32_16x16x32_bf16 v[80:83], v[160:163], a[112:115], v[80:83]
  ds_read_b64_tr_b16 v[204:205], v15 offset:10400
  v_mfma_f32_16x16x32_bf16 v[120:123], v[160:163], a[116:119], v[120:123]
  ds_read_b64_tr_b16 v[206:207], v15 offset:11680
  v_mfma_f32_16x16x32_bf16 v[84:87], v[164:167], a[112:115], v[84:87]
  ds_read_b64_tr_b16 v[208:209], v14 offset:10432
  v_mfma_f32_16x16x32_bf16 v[124:127], v[164:167], a[116:119], v[124:127]
  ds_read_b64_tr_b16 v[210:211], v14 offset:11712
  ds_read_b64_tr_b16 v[212:213], v15 offset:10464
  v_mfma_f32_16x16x32_bf16 v[88:91], v[168:171], a[112:115], v[88:91]
  ds_read_b64_tr_b16 v[214:215], v15 offset:11744
  v_mfma_f32_16x16x32_bf16 v[128:131], v[168:171], a[116:119], v[128:131]
  buffer_load_dwordx4 v[242:245], v4, s[8:11], s50 offen
  ds_read_b64_tr_b16 v[216:217], v14 offset:10496
  v_mfma_f32_16x16x32_bf16 v[92:95], v[172:175], a[112:115], v[92:95]
  ds_read_b64_tr_b16 v[218:219], v14 offset:11776
  v_mfma_f32_16x16x32_bf16 v[132:135], v[172:175], a[116:119], v[132:135]
  ds_read_b64_tr_b16 v[220:221], v15 offset:10528
  v_mfma_f32_16x16x32_bf16 v[96:99], v[176:179], a[112:115], v[96:99]
  ds_read_b64_tr_b16 v[222:223], v15 offset:11808
  v_mfma_f32_16x16x32_bf16 v[136:139], v[176:179], a[116:119], v[136:139]
  buffer_load_dword v246, v5, s[8:11], s50 offen offset:1024
  v_mfma_f32_16x16x32_bf16 v[100:103], v[180:183], a[112:115], v[100:103]
  s_add_u32 s50, s50, 1280
  v_mfma_f32_16x16x32_bf16 v[140:143], v[180:183], a[116:119], v[140:143]
  s_waitcnt lgkmcnt(0) vmcnt(18)
  s_barrier
  v_mfma_f32_16x16x32_bf16 v[64:67], v[184:187], a[120:123], v[64:67]
  ds_read_b64_tr_b16 v[144:145], v14 offset:20480
  ds_read_b64_tr_b16 v[146:147], v14 offset:21760
  v_mfma_f32_16x16x32_bf16 v[104:107], v[184:187], a[124:127], v[104:107]
  ds_read_b64_tr_b16 v[148:149], v15 offset:20512
  v_mfma_f32_16x16x32_bf16 v[68:71], v[188:191], a[120:123], v[68:71]
  ds_read_b64_tr_b16 v[150:151], v15 offset:21792
  v_mfma_f32_16x16x32_bf16 v[108:111], v[188:191], a[124:127], v[108:111]
  ds_read_b64_tr_b16 v[152:153], v14 offset:20544
  v_mfma_f32_16x16x32_bf16 v[72:75], v[192:195], a[120:123], v[72:75]
  ds_read_b64_tr_b16 v[154:155], v14 offset:21824
  v_mfma_f32_16x16x32_bf16 v[112:115], v[192:195], a[124:127], v[112:115]
  ds_read_b64_tr_b16 v[156:157], v15 offset:20576
  ds_read_b64_tr_b16 v[158:159], v15 offset:21856
  v_mfma_f32_16x16x32_bf16 v[76:79], v[196:199], a[120:123], v[76:79]
  ds_read_b64_tr_b16 v[160:161], v14 offset:20608
  v_mfma_f32_16x16x32_bf16 v[116:119], v[196:199], a[124:127], v[116:119]
  ds_read_b64_tr_b16 v[162:163], v14 offset:21888
  v_mfma_f32_16x16x32_bf16 v[80:83], v[200:203], a[120:123], v[80:83]
  ds_read_b64_tr_b16 v[164:165], v15 offset:20640
  v_mfma_f32_16x16x32_bf16 v[120:123], v[200:203], a[124:127], v[120:123]
  ds_read_b64_tr_b16 v[166:167], v15 offset:21920
  v_mfma_f32_16x16x32_bf16 v[84:87], v[204:207], a[120:123], v[84:87]
  ds_read_b64_tr_b16 v[168:169], v14 offset:20672
  v_mfma_f32_16x16x32_bf16 v[124:127], v[204:207], a[124:127], v[124:127]
  ds_read_b64_tr_b16 v[170:171], v14 offset:21952
  ds_read_b64_tr_b16 v[172:173], v15 offset:20704
  v_mfma_f32_16x16x32_bf16 v[88:91], v[208:211], a[120:123], v[88:91]
  ds_read_b64_tr_b16 v[174:175], v15 offset:21984
  v_mfma_f32_16x16x32_bf16 v[128:131], v[208:211], a[124:127], v[128:131]
  buffer_load_dwordx4 v[248:251], v4, s[8:11], s50 offen
  ds_read_b64_tr_b16 v[176:177], v14 offset:20736
  v_mfma_f32_16x16x32_bf16 v[92:95], v[212:215], a[120:123], v[92:95]
  ds_read_b64_tr_b16 v[178:179], v14 offset:22016
  v_mfma_f32_16x16x32_bf16 v[132:135], v[212:215], a[124:127], v[132:135]
  ds_read_b64_tr_b16 v[180:181], v15 offset:20768
  v_mfma_f32_16x16x32_bf16 v[96:99], v[216:219], a[120:123], v[96:99]
  ds_read_b64_tr_b16 v[182:183], v15 offset:22048
  v_mfma_f32_16x16x32_bf16 v[136:139], v[216:219], a[124:127], v[136:139]
  buffer_load_dword v252, v5, s[8:11], s50 offen offset:1024
  v_mfma_f32_16x16x32_bf16 v[100:103], v[220:223], a[120:123], v[100:103]
  s_add_u32 s50, s50, 1280
  v_mfma_f32_16x16x32_bf16 v[140:143], v[220:223], a[124:127], v[140:143]
  s_waitcnt lgkmcnt(0) vmcnt(18)
  v_mfma_f32_16x16x32_bf16 v[64:67], v[144:147], a[128:131], v[64:67]
  ds_read_b64_tr_b16 v[184:185], v14 offset:30720
  ds_read_b64_tr_b16 v[186:187], v14 offset:32000
  v_mfma_f32_16x16x32_bf16 v[104:107], v[144:147], a[132:135], v[104:107]
  ds_read_b64_tr_b16 v[188:189], v15 offset:30752
  v_mfma_f32_16x16x32_bf16 v[68:71], v[148:151], a[128:131], v[68:71]
  ds_read_b64_tr_b16 v[190:191], v15 offset:32032
  v_mfma_f32_16x16x32_bf16 v[108:111], v[148:151], a[132:135], v[108:111]
  ds_read_b64_tr_b16 v[192:193], v14 offset:30784
  v_mfma_f32_16x16x32_bf16 v[72:75], v[152:155], a[128:131], v[72:75]
  ds_read_b64_tr_b16 v[194:195], v14 offset:32064
  v_mfma_f32_16x16x32_bf16 v[112:115], v[152:155], a[132:135], v[112:115]
  ds_read_b64_tr_b16 v[196:197], v15 offset:30816
  ds_read_b64_tr_b16 v[198:199], v15 offset:32096
  v_mfma_f32_16x16x32_bf16 v[76:79], v[156:159], a[128:131], v[76:79]
  ds_read_b64_tr_b16 v[200:201], v14 offset:30848
  v_mfma_f32_16x16x32_bf16 v[116:119], v[156:159], a[132:135], v[116:119]
  ds_read_b64_tr_b16 v[202:203], v14 offset:32128
  v_mfma_f32_16x16x32_bf16 v[80:83], v[160:163], a[128:131], v[80:83]
  ds_read_b64_tr_b16 v[204:205], v15 offset:30880
  v_mfma_f32_16x16x32_bf16 v[120:123], v[160:163], a[132:135], v[120:123]
  ds_read_b64_tr_b16 v[206:207], v15 offset:32160
  v_mfma_f32_16x16x32_bf16 v[84:87], v[164:167], a[128:131], v[84:87]
  ds_read_b64_tr_b16 v[208:209], v14 offset:30912
  v_mfma_f32_16x16x32_bf16 v[124:127], v[164:167], a[132:135], v[124:127]
  ds_read_b64_tr_b16 v[210:211], v14 offset:32192
  ds_read_b64_tr_b16 v[212:213], v15 offset:30944
  v_mfma_f32_16x16x32_bf16 v[88:91], v[168:171], a[128:131], v[88:91]
  ds_read_b64_tr_b16 v[214:215], v15 offset:32224
  v_mfma_f32_16x16x32_bf16 v[128:131], v[168:171], a[132:135], v[128:131]
  buffer_load_dwordx4 v[30:33], v4, s[8:11], s50 offen
  ds_read_b64_tr_b16 v[216:217], v14 offset:30976
  v_mfma_f32_16x16x32_bf16 v[92:95], v[172:175], a[128:131], v[92:95]
  ds_read_b64_tr_b16 v[218:219], v14 offset:32256
  v_mfma_f32_16x16x32_bf16 v[132:135], v[172:175], a[132:135], v[132:135]
  ds_read_b64_tr_b16 v[220:221], v15 offset:31008
  v_mfma_f32_16x16x32_bf16 v[96:99], v[176:179], a[128:131], v[96:99]
  ds_read_b64_tr_b16 v[222:223], v15 offset:32288
  v_mfma_f32_16x16x32_bf16 v[136:139], v[176:179], a[132:135], v[136:139]
  buffer_load_dword v34, v5, s[8:11], s50 offen offset:1024
  v_mfma_f32_16x16x32_bf16 v[100:103], v[180:183], a[128:131], v[100:103]
  s_add_u32 s50, s50, 1280
  v_mfma_f32_16x16x32_bf16 v[140:143], v[180:183], a[132:135], v[140:143]
  s_waitcnt lgkmcnt(0) vmcnt(18)
  s_barrier
  v_mfma_f32_16x16x32_bf16 v[64:67], v[184:187], a[136:139], v[64:67]
  ds_read_b64_tr_b16 v[144:145], v14 offset:40960
  ds_read_b64_tr_b16 v[146:147], v14 offset:42240
  v_mfma_f32_16x16x32_bf16 v[104:107], v[184:187], a[140:143], v[104:107]
  ds_read_b64_tr_b16 v[148:149], v15 offset:40992
  v_mfma_f32_16x16x32_bf16 v[68:71], v[188:191], a[136:139], v[68:71]
  ds_read_b64_tr_b16 v[150:151], v15 offset:42272
  v_mfma_f32_16x16x32_bf16 v[108:111], v[188:191], a[140:143], v[108:111]
  ds_read_b64_tr_b16 v[152:153], v14 offset:41024
  v_mfma_f32_16x16x32_bf16 v[72:75], v[192:195], a[136:139], v[72:75]
  ds_read_b64_tr_b16 v[154:155], v14 offset:42304
  v_mfma_f32_16x16x32_bf16 v[112:115], v[192:195], a[140:143], v[112:115]
  ds_read_b64_tr_b16 v[156:157], v15 offset:41056
  ds_read_b64_tr_b16 v[158:159], v15 offset:42336
  v_mfma_f32_16x16x32_bf16 v[76:79], v[196:199], a[136:139], v[76:79]
  ds_read_b64_tr_b16 v[160:161], v14 offset:41088
  v_mfma_f32_16x16x32_bf16 v[116:119], v[196:199], a[140:143], v[116:119]
  ds_read_b64_tr_b16 v[162:163], v14 offset:42368
  v_mfma_f32_16x16x32_bf16 v[80:83], v[200:203], a[136:139], v[80:83]
  ds_read_b64_tr_b16 v[164:165], v15 offset:41120
  v_mfma_f32_16x16x32_bf16 v[120:123], v[200:203], a[140:143], v[120:123]
  ds_read_b64_tr_b16 v[166:167], v15 offset:42400
  v_mfma_f32_16x16x32_bf16 v[84:87], v[204:207], a[136:139], v[84:87]
  ds_read_b64_tr_b16 v[168:169], v14 offset:41152
  v_mfma_f32_16x16x32_bf16 v[124:127], v[204:207], a[140:143], v[124:127]
  ds_read_b64_tr_b16 v[170:171], v14 offset:42432
  ds_read_b64_tr_b16 v[172:173], v15 offset:41184
  v_mfma_f32_16x16x32_bf16 v[88:91], v[208:211], a[136:139], v[88:91]
  ds_read_b64_tr_b16 v[174:175], v15 offset:42464
  v_mfma_f32_16x16x32_bf16 v[128:131], v[208:211], a[140:143], v[128:131]
  buffer_load_dwordx4 v[36:39], v4, s[8:11], s50 offen
  ds_read_b64_tr_b16 v[176:177], v14 offset:41216
  v_mfma_f32_16x16x32_bf16 v[92:95], v[212:215], a[136:139], v[92:95]
  ds_read_b64_tr_b16 v[178:179], v14 offset:42496
  v_mfma_f32_16x16x32_bf16 v[132:135], v[212:215], a[140:143], v[132:135]
  ds_read_b64_tr_b16 v[180:181], v15 offset:41248
  v_mfma_f32_16x16x32_bf16 v[96:99], v[216:219], a[136:139], v[96:99]
  ds_read_b64_tr_b16 v[182:183], v15 offset:42528
  v_mfma_f32_16x16x32_bf16 v[136:139], v[216:219], a[140:143], v[136:139]
  buffer_load_dword v40, v5, s[8:11], s50 offen offset:1024
  v_mfma_f32_16x16x32_bf16 v[100:103], v[220:223], a[136:139], v[100:103]
  s_add_u32 s50, s50, 1280
  v_mfma_f32_16x16x32_bf16 v[140:143], v[220:223], a[140:143], v[140:143]
  s_waitcnt lgkmcnt(0) vmcnt(18)
  v_mfma_f32_16x16x32_bf16 v[64:67], v[144:147], a[144:147], v[64:67]
  ds_read_b64_tr_b16 v[184:185], v14 offset:51200
  ds_read_b64_tr_b16 v[186:187], v14 offset:52480
  v_mfma_f32_16x16x32_bf16 v[104:107], v[144:147], a[148:151], v[104:107]
  ds_read_b64_tr_b16 v[188:189], v15 offset:51232
  v_mfma_f32_16x16x32_bf16 v[68:71], v[148:151], a[144:147], v[68:71]
  ds_read_b64_tr_b16 v[190:191], v15 offset:52512
  v_mfma_f32_16x16x32_bf16 v[108:111], v[148:151], a[148:151], v[108:111]
  ds_read_b64_tr_b16 v[192:193], v14 offset:51264
  v_mfma_f32_16x16x32_bf16 v[72:75], v[152:155], a[144:147], v[72:75]
  ds_read_b64_tr_b16 v[194:195], v14 offset:52544
  v_mfma_f32_16x16x32_bf16 v[112:115], v[152:155], a[148:151], v[112:115]
  ds_read_b64_tr_b16 v[196:197], v15 offset:51296
  ds_read_b64_tr_b16 v[198:199], v15 offset:52576
  v_mfma_f32_16x16x32_bf16 v[76:79], v[156:159], a[144:147], v[76:79]
  ds_read_b64_tr_b16 v[200:201], v14 offset:51328
  v_mfma_f32_16x16x32_bf16 v[116:119], v[156:159], a[148:151], v[116:119]
  ds_read_b64_tr_b16 v[202:203], v14 offset:52608
  v_mfma_f32_16x16x32_bf16 v[80:83], v[160:163], a[144:147], v[80:83]
  ds_read_b64_tr_b16 v[204:205], v15 offset:51360
  v_mfma_f32_16x16x32_bf16 v[120:123], v[160:163], a[148:151], v[120:123]
  ds_read_b64_tr_b16 v[206:207], v15 offset:52640
  v_mfma_f32_16x16x32_bf16 v[84:87], v[164:167], a[144:147], v[84:87]
  ds_read_b64_tr_b16 v[208:209], v14 offset:51392
  v_mfma_f32_16x16x32_bf16 v[124:127], v[164:167], a[148:151], v[124:127]
  ds_read_b64_tr_b16 v[210:211], v14 offset:52672
  ds_read_b64_tr_b16 v[212:213], v15 offset:51424
  v_mfma_f32_16x16x32_bf16 v[88:91], v[168:171], a[144:147], v[88:91]
  ds_read_b64_tr_b16 v[214:215], v15 offset:52704
  v_mfma_f32_16x16x32_bf16 v[128:131], v[168:171], a[148:151], v[128:131]
  buffer_load_dwordx4 v[42:45], v4, s[8:11], s50 offen
  ds_read_b64_tr_b16 v[216:217], v14 offset:51456
  v_mfma_f32_16x16x32_bf16 v[92:95], v[172:175], a[144:147], v[92:95]
  ds_read_b64_tr_b16 v[218:219], v14 offset:52736
  v_mfma_f32_16x16x32_bf16 v[132:135], v[172:175], a[148:151], v[132:135]
  ds_read_b64_tr_b16 v[220:221], v15 offset:51488
  v_mfma_f32_16x16x32_bf16 v[96:99], v[176:179], a[144:147], v[96:99]
  ds_read_b64_tr_b16 v[222:223], v15 offset:52768
  v_mfma_f32_16x16x32_bf16 v[136:139], v[176:179], a[148:151], v[136:139]
  buffer_load_dword v46, v5, s[8:11], s50 offen offset:1024
  v_mfma_f32_16x16x32_bf16 v[100:103], v[180:183], a[144:147], v[100:103]
  s_add_u32 s50, s50, 1280
  v_mfma_f32_16x16x32_bf16 v[140:143], v[180:183], a[148:151], v[140:143]
  s_waitcnt lgkmcnt(0) vmcnt(18)
  v_mfma_f32_16x16x32_bf16 v[64:67], v[184:187], a[152:155], v[64:67]
  v_mfma_f32_16x16x32_bf16 v[104:107], v[184:187], a[156:159], v[104:107]
  v_mfma_f32_16x16x32_bf16 v[68:71], v[188:191], a[152:155], v[68:71]
  v_mfma_f32_16x16x32_bf16 v[108:111], v[188:191], a[156:159], v[108:111]
  v_mfma_f32_16x16x32_bf16 v[72:75], v[192:195], a[152:155], v[72:75]
  v_mfma_f32_16x16x32_bf16 v[112:115], v[192:195], a[156:159], v[112:115]
  v_mfma_f32_16x16x32_bf16 v[76:79], v[196:199], a[152:155], v[76:79]
  v_mfma_f32_16x16x32_bf16 v[116:119], v[196:199], a[156:159], v[116:119]
  v_mfma_f32_16x16x32_bf16 v[80:83], v[200:203], a[152:155], v[80:83]
  v_mfma_f32_16x16x32_bf16 v[120:123], v[200:203], a[156:159], v[120:123]
  v_mfma_f32_16x16x32_bf16 v[84:87], v[204:207], a[152:155], v[84:87]
  v_mfma_f32_16x16x32_bf16 v[124:127], v[204:207], a[156:159], v[124:127]
  v_mfma_f32_16x16x32_bf16 v[88:91], v[208:211], a[152:155], v[88:91]
  v_mfma_f32_16x16x32_bf16 v[128:131], v[208:211], a[156:159], v[128:131]
  v_mfma_f32_16x16x32_bf16 v[92:95], v[212:215], a[152:155], v[92:95]
  v_mfma_f32_16x16x32_bf16 v[132:135], v[212:215], a[156:159], v[132:135]
  v_mfma_f32_16x16x32_bf16 v[96:99], v[216:219], a[152:155], v[96:99]
  v_mfma_f32_16x16x32_bf16 v[136:139], v[216:219], a[156:159], v[136:139]
  v_mfma_f32_16x16x32_bf16 v[100:103], v[220:223], a[152:155], v[100:103]
  v_mfma_f32_16x16x32_bf16 v[140:143], v[220:223], a[156:159], v[140:143]
  s_add_u32 s16, s38, 73400320
  s_addc_u32 s17, s39, 0
  s_mov_b32 s18, 5242880
  s_mov_b32 s19, 0x00020000
  s_nop 3
  s_mul_i32 s21, s47, 40
  s_mul_i32 s22, s44, 10
  s_add_u32 s21, s21, s22
  s_lshl_b32 s21, s21, 10
  s_cmp_lt_u32 s2, 32
  s_cbranch_scc1 om_247
  s_add_u32 s22, s21, 0
  buffer_store_dwordx4 v[64:67], v4, s[16:19], s22 offen offset:0 sc1
  buffer_store_dwordx4 v[68:71], v4, s[16:19], s22 offen offset:1024 sc1
  buffer_store_dwordx4 v[72:75], v4, s[16:19], s22 offen offset:2048 sc1
  buffer_store_dwordx4 v[76:79], v4, s[16:19], s22 offen offset:3072 sc1
  s_add_u32 s22, s21, 4096
  buffer_store_dwordx4 v[80:83], v4, s[16:19], s22 offen offset:0 sc1
  buffer_store_dwordx4 v[84:87], v4, s[16:19], s22 offen offset:1024 sc1
  buffer_store_dwordx4 v[88:91], v4, s[16:19], s22 offen offset:2048 sc1
  buffer_store_dwordx4 v[92:95], v4, s[16:19], s22 offen offset:3072 sc1
  s_add_u32 s22, s21, 8192
  buffer_store_dwordx4 v[96:99], v4, s[16:19], s22 offen offset:0 sc1
  buffer_store_dwordx4 v[100:103], v4, s[16:19], s22 offen offset:1024 sc1
  s_add_u32 s22, s21, 40960
  buffer_store_dwordx4 v[104:107], v4, s[16:19], s22 offen offset:0 sc1
  buffer_store_dwordx4 v[108:111], v4, s[16:19], s22 offen offset:1024 sc1
  buffer_store_dwordx4 v[112:115], v4, s[16:19], s22 offen offset:2048 sc1
  buffer_store_dwordx4 v[116:119], v4, s[16:19], s22 offen offset:3072 sc1
  s_add_u32 s22, s21, 45056
  buffer_store_dwordx4 v[120:123], v4, s[16:19], s22 offen offset:0 sc1
  buffer_store_dwordx4 v[124:127], v4, s[16:19], s22 offen offset:1024 sc1
  buffer_store_dwordx4 v[128:131], v4, s[16:19], s22 offen offset:2048 sc1
  buffer_store_dwordx4 v[132:135], v4, s[16:19], s22 offen offset:3072 sc1
  s_add_u32 s22, s21, 49152
  buffer_store_dwordx4 v[136:139], v4, s[16:19], s22 offen offset:0 sc1
  buffer_store_dwordx4 v[140:143], v4, s[16:19], s22 offen offset:1024 sc1
  s_sub_u32 s50, s50, 1320960
  buffer_load_dwordx4 v[160:163], v4, s[8:11], s50 offen
  buffer_load_dword v164, v5, s[8:11], s50 offen offset:1024
  s_add_u32 s50, s50, 1280
  buffer_load_dwordx4 v[166:169], v4, s[8:11], s50 offen
  buffer_load_dword v170, v5, s[8:11], s50 offen offset:1024
  s_add_u32 s50, s50, 1280
  buffer_load_dwordx4 v[172:175], v4, s[8:11], s50 offen
  buffer_load_dword v176, v5, s[8:11], s50 offen offset:1024
  s_add_u32 s50, s50, 1280
  buffer_load_dwordx4 v[178:181], v4, s[8:11], s50 offen
  buffer_load_dword v182, v5, s[8:11], s50 offen offset:1024
  s_add_u32 s50, s50, 1280
  buffer_load_dwordx4 v[184:187], v4, s[8:11], s50 offen
  buffer_load_dword v188, v5, s[8:11], s50 offen offset:1024
  s_add_u32 s50, s50, 1280
  buffer_load_dwordx4 v[190:193], v4, s[8:11], s50 offen
  buffer_load_dword v194, v5, s[8:11], s50 offen offset:1024
  s_add_u32 s50, s50, 1280
  buffer_load_dwordx4 v[196:199], v4, s[8:11], s50 offen
  buffer_load_dword v200, v5, s[8:11], s50 offen offset:1024
  s_add_u32 s50, s50, 1280
  buffer_load_dwordx4 v[202:205], v4, s[8:11], s50 offen
  buffer_load_dword v206, v5, s[8:11], s50 offen offset:1024
  s_add_u32 s50, s50, 1280
  s_waitcnt vmcnt(36)
  v_lshlrev_b32 v57, 16, v52
  v_and_b32 v52, 0xffff0000, v52
  v_lshlrev_b32 v58, 16, v53
  v_and_b32 v53, 0xffff0000, v53
  v_lshlrev_b32 v59, 16, v54
  v_and_b32 v54, 0xffff0000, v54
  v_lshlrev_b32 v60, 16, v55
  v_and_b32 v55, 0xffff0000, v55
  v_lshlrev_b32 v61, 16, v56
  v_and_b32 v56, 0xffff0000, v56
  v_lshlrev_b32 v25, 16, v224
  v_and_b32 v26, 0xffff0000, v224
  v_mul_f32 v25, v25, v57
  v_mul_f32 v26, v26, v52
  v_cvt_pk_bf16_f32 v25, v25, v26
  v_lshlrev_b32 v26, 16, v25
  v_and_b32 v25, 0xffff0000, v25
  v_add_f32 v144, v25, v26
  v_lshlrev_b32 v25, 16, v225
  v_and_b32 v26, 0xffff0000, v225
  v_mul_f32 v25, v25, v58
  v_mul_f32 v26, v26, v53
  v_cvt_pk_bf16_f32 v25, v25, v26
  v_lshlrev_b32 v26, 16, v25
  v_and_b32 v25, 0xffff0000, v25
  v_add_f32 v144, v144, v26
  v_add_f32 v144, v144, v25
  v_lshlrev_b32 v25, 16, v226
  v_and_b32 v26, 0xffff0000, v226
  v_mul_f32 v25, v25, v59
  v_mul_f32 v26, v26, v54
  v_cvt_pk_bf16_f32 v25, v25, v26
  v_lshlrev_b32 v26, 16, v25
  v_and_b32 v25, 0xffff0000, v25
  v_add_f32 v144, v144, v26
  v_add_f32 v144, v144, v25
  v_lshlrev_b32 v25, 16, v227
  v_and_b32 v26, 0xffff0000, v227
  v_mul_f32 v25, v25, v60
  v_mul_f32 v26, v26, v55
  v_cvt_pk_bf16_f32 v25, v25, v26
  v_lshlrev_b32 v26, 16, v25
  v_and_b32 v25, 0xffff0000, v25
  v_add_f32 v144, v144, v26
  v_add_f32 v144, v144, v25
  v_lshlrev_b32 v25, 16, v228
  v_and_b32 v26, 0xffff0000, v228
  v_mul_f32 v25, v25, v61
  v_mul_f32 v26, v26, v56
  v_cvt_pk_bf16_f32 v25, v25, v26
  v_lshlrev_b32 v26, 16, v25
  v_and_b32 v25, 0xffff0000, v25
  v_add_f32 v144, v144, v26
  v_add_f32 v144, v144, v25
  v_lshlrev_b32 v25, 16, v230
  v_and_b32 v26, 0xffff0000, v230
  v_mul_f32 v25, v25, v57
  v_mul_f32 v26, v26, v52
  v_cvt_pk_bf16_f32 v25, v25, v26
  v_lshlrev_b32 v26, 16, v25
  v_and_b32 v25, 0xffff0000, v25
  v_add_f32 v145, v25, v26
  v_lshlrev_b32 v25, 16, v231
  v_and_b32 v26, 0xffff0000, v231
  v_mul_f32 v25, v25, v58
  v_mul_f32 v26, v26, v53
  v_cvt_pk_bf16_f32 v25, v25, v26
  v_lshlrev_b32 v26, 16, v25
  v_and_b32 v25, 0xffff0000, v25
  v_add_f32 v145, v145, v26
  v_add_f32 v145, v145, v25
  v_lshlrev_b32 v25, 16, v232
  v_and_b32 v26, 0xffff0000, v232
  v_mul_f32 v25, v25, v59
  v_mul_f32 v26, v26, v54
  v_cvt_pk_bf16_f32 v25, v25, v26
  v_lshlrev_b32 v26, 16, v25
  v_and_b32 v25, 0xffff0000, v25
  v_add_f32 v145, v145, v26
  v_add_f32 v145, v145, v25
  v_lshlrev_b32 v25, 16, v233
  v_and_b32 v26, 0xffff0000, v233
  v_mul_f32 v25, v25, v60
  v_mul_f32 v26, v26, v55
  v_cvt_pk_bf16_f32 v25, v25, v26
  v_lshlrev_b32 v26, 16, v25
  v_and_b32 v25, 0xffff0000, v25
  v_add_f32 v145, v145, v26
  v_add_f32 v145, v145, v25
  v_lshlrev_b32 v25, 16, v234
  v_and_b32 v26, 0xffff0000, v234
  v_mul_f32 v25, v25, v61
  v_mul_f32 v26, v26, v56
  v_cvt_pk_bf16_f32 v25, v25, v26
  v_lshlrev_b32 v26, 16, v25
  v_and_b32 v25, 0xffff0000, v25
  v_add_f32 v145, v145, v26
  v_add_f32 v145, v145, v25
  v_lshlrev_b32 v25, 16, v236
  v_and_b32 v26, 0xffff0000, v236
  v_mul_f32 v25, v25, v57
  v_mul_f32 v26, v26, v52
  v_cvt_pk_bf16_f32 v25, v25, v26
  v_lshlrev_b32 v26, 16, v25
  v_and_b32 v25, 0xffff0000, v25
  v_add_f32 v146, v25, v26
  v_lshlrev_b32 v25, 16, v237
  v_and_b32 v26, 0xffff0000, v237
  v_mul_f32 v25, v25, v58
  v_mul_f32 v26, v26, v53
  v_cvt_pk_bf16_f32 v25, v25, v26
  v_lshlrev_b32 v26, 16, v25
  v_and_b32 v25, 0xffff0000, v25
  v_add_f32 v146, v146, v26
  v_add_f32 v146, v146, v25
  v_lshlrev_b32 v25, 16, v238
  v_and_b32 v26, 0xffff0000, v238
  v_mul_f32 v25, v25, v59
  v_mul_f32 v26, v26, v54
  v_cvt_pk_bf16_f32 v25, v25, v26
  v_lshlrev_b32 v26, 16, v25
  v_and_b32 v25, 0xffff0000, v25
  v_add_f32 v146, v146, v26
  v_add_f32 v146, v146, v25
  v_lshlrev_b32 v25, 16, v239
  v_and_b32 v26, 0xffff0000, v239
  v_mul_f32 v25, v25, v60
  v_mul_f32 v26, v26, v55
  v_cvt_pk_bf16_f32 v25, v25, v26
  v_lshlrev_b32 v26, 16, v25
  v_and_b32 v25, 0xffff0000, v25
  v_add_f32 v146, v146, v26
  v_add_f32 v146, v146, v25
  v_lshlrev_b32 v25, 16, v240
  v_and_b32 v26, 0xffff0000, v240
  v_mul_f32 v25, v25, v61
  v_mul_f32 v26, v26, v56
  v_cvt_pk_bf16_f32 v25, v25, v26
  v_lshlrev_b32 v26, 16, v25
  v_and_b32 v25, 0xffff0000, v25
  v_add_f32 v146, v146, v26
  v_add_f32 v146, v146, v25
  v_lshlrev_b32 v25, 16, v242
  v_and_b32 v26, 0xffff0000, v242
  v_mul_f32 v25, v25, v57
  v_mul_f32 v26, v26, v52
  v_cvt_pk_bf16_f32 v25, v25, v26
  v_lshlrev_b32 v26, 16, v25
  v_and_b32 v25, 0xffff0000, v25
  v_add_f32 v147, v25, v26
  v_lshlrev_b32 v25, 16, v243
  v_and_b32 v26, 0xffff0000, v243
  v_mul_f32 v25, v25, v58
  v_mul_f32 v26, v26, v53
  v_cvt_pk_bf16_f32 v25, v25, v26
  v_lshlrev_b32 v26, 16, v25
  v_and_b32 v25, 0xffff0000, v25
  v_add_f32 v147, v147, v26
  v_add_f32 v147, v147, v25
  v_lshlrev_b32 v25, 16, v244
  v_and_b32 v26, 0xffff0000, v244
  v_mul_f32 v25, v25, v59
  v_mul_f32 v26, v26, v54
  v_cvt_pk_bf16_f32 v25, v25, v26
  v_lshlrev_b32 v26, 16, v25
  v_and_b32 v25, 0xffff0000, v25
  v_add_f32 v147, v147, v26
  v_add_f32 v147, v147, v25
  v_lshlrev_b32 v25, 16, v245
  v_and_b32 v26, 0xffff0000, v245
  v_mul_f32 v25, v25, v60
  v_mul_f32 v26, v26, v55
  v_cvt_pk_bf16_f32 v25, v25, v26
  v_lshlrev_b32 v26, 16, v25
  v_and_b32 v25, 0xffff0000, v25
  v_add_f32 v147, v147, v26
  v_add_f32 v147, v147, v25
  v_lshlrev_b32 v25, 16, v246
  v_and_b32 v26, 0xffff0000, v246
  v_mul_f32 v25, v25, v61
  v_mul_f32 v26, v26, v56
  v_cvt_pk_bf16_f32 v25, v25, v26
  v_lshlrev_b32 v26, 16, v25
  v_and_b32 v25, 0xffff0000, v25
  v_add_f32 v147, v147, v26
  v_add_f32 v147, v147, v25
  v_lshlrev_b32 v25, 16, v248
  v_and_b32 v26, 0xffff0000, v248
  v_mul_f32 v25, v25, v57
  v_mul_f32 v26, v26, v52
  v_cvt_pk_bf16_f32 v25, v25, v26
  v_lshlrev_b32 v26, 16, v25
  v_and_b32 v25, 0xffff0000, v25
  v_add_f32 v148, v25, v26
  v_lshlrev_b32 v25, 16, v249
  v_and_b32 v26, 0xffff0000, v249
  v_mul_f32 v25, v25, v58
  v_mul_f32 v26, v26, v53
  v_cvt_pk_bf16_f32 v25, v25, v26
  v_lshlrev_b32 v26, 16, v25
  v_and_b32 v25, 0xffff0000, v25
  v_add_f32 v148, v148, v26
  v_add_f32 v148, v148, v25
  v_lshlrev_b32 v25, 16, v250
  v_and_b32 v26, 0xffff0000, v250
  v_mul_f32 v25, v25, v59
  v_mul_f32 v26, v26, v54
  v_cvt_pk_bf16_f32 v25, v25, v26
  v_lshlrev_b32 v26, 16, v25
  v_and_b32 v25, 0xffff0000, v25
  v_add_f32 v148, v148, v26
  v_add_f32 v148, v148, v25
  v_lshlrev_b32 v25, 16, v251
  v_and_b32 v26, 0xffff0000, v251
  v_mul_f32 v25, v25, v60
  v_mul_f32 v26, v26, v55
  v_cvt_pk_bf16_f32 v25, v25, v26
  v_lshlrev_b32 v26, 16, v25
  v_and_b32 v25, 0xffff0000, v25
  v_add_f32 v148, v148, v26
  v_add_f32 v148, v148, v25
  v_lshlrev_b32 v25, 16, v252
  v_and_b32 v26, 0xffff0000, v252
  v_mul_f32 v25, v25, v61
  v_mul_f32 v26, v26, v56
  v_cvt_pk_bf16_f32 v25, v25, v26
  v_lshlrev_b32 v26, 16, v25
  v_and_b32 v25, 0xffff0000, v25
  v_add_f32 v148, v148, v26
  v_add_f32 v148, v148, v25
  v_lshlrev_b32 v25, 16, v30
  v_and_b32 v26, 0xffff0000, v30
  v_mul_f32 v25, v25, v57
  v_mul_f32 v26, v26, v52
  v_cvt_pk_bf16_f32 v25, v25, v26
  v_lshlrev_b32 v26, 16, v25
  v_and_b32 v25, 0xffff0000, v25
  v_add_f32 v149, v25, v26
  v_lshlrev_b32 v25, 16, v31
  v_and_b32 v26, 0xffff0000, v31
  v_mul_f32 v25, v25, v58
  v_mul_f32 v26, v26, v53
  v_cvt_pk_bf16_f32 v25, v25, v26
  v_lshlrev_b32 v26, 16, v25
  v_and_b32 v25, 0xffff0000, v25
  v_add_f32 v149, v149, v26
  v_add_f32 v149, v149, v25
  v_lshlrev_b32 v25, 16, v32
  v_and_b32 v26, 0xffff0000, v32
  v_mul_f32 v25, v25, v59
  v_mul_f32 v26, v26, v54
  v_cvt_pk_bf16_f32 v25, v25, v26
  v_lshlrev_b32 v26, 16, v25
  v_and_b32 v25, 0xffff0000, v25
  v_add_f32 v149, v149, v26
  v_add_f32 v149, v149, v25
  v_lshlrev_b32 v25, 16, v33
  v_and_b32 v26, 0xffff0000, v33
  v_mul_f32 v25, v25, v60
  v_mul_f32 v26, v26, v55
  v_cvt_pk_bf16_f32 v25, v25, v26
  v_lshlrev_b32 v26, 16, v25
  v_and_b32 v25, 0xffff0000, v25
  v_add_f32 v149, v149, v26
  v_add_f32 v149, v149, v25
  v_lshlrev_b32 v25, 16, v34
  v_and_b32 v26, 0xffff0000, v34
  v_mul_f32 v25, v25, v61
  v_mul_f32 v26, v26, v56
  v_cvt_pk_bf16_f32 v25, v25, v26
  v_lshlrev_b32 v26, 16, v25
  v_and_b32 v25, 0xffff0000, v25
  v_add_f32 v149, v149, v26
  v_add_f32 v149, v149, v25
  v_lshlrev_b32 v25, 16, v36
  v_and_b32 v26, 0xffff0000, v36
  v_mul_f32 v25, v25, v57
  v_mul_f32 v26, v26, v52
  v_cvt_pk_bf16_f32 v25, v25, v26
  v_lshlrev_b32 v26, 16, v25
  v_and_b32 v25, 0xffff0000, v25
  v_add_f32 v150, v25, v26
  v_lshlrev_b32 v25, 16, v37
  v_and_b32 v26, 0xffff0000, v37
  v_mul_f32 v25, v25, v58
  v_mul_f32 v26, v26, v53
  v_cvt_pk_bf16_f32 v25, v25, v26
  v_lshlrev_b32 v26, 16, v25
  v_and_b32 v25, 0xffff0000, v25
  v_add_f32 v150, v150, v26
  v_add_f32 v150, v150, v25
  v_lshlrev_b32 v25, 16, v38
  v_and_b32 v26, 0xffff0000, v38
  v_mul_f32 v25, v25, v59
  v_mul_f32 v26, v26, v54
  v_cvt_pk_bf16_f32 v25, v25, v26
  v_lshlrev_b32 v26, 16, v25
  v_and_b32 v25, 0xffff0000, v25
  v_add_f32 v150, v150, v26
  v_add_f32 v150, v150, v25
  v_lshlrev_b32 v25, 16, v39
  v_and_b32 v26, 0xffff0000, v39
  v_mul_f32 v25, v25, v60
  v_mul_f32 v26, v26, v55
  v_cvt_pk_bf16_f32 v25, v25, v26
  v_lshlrev_b32 v26, 16, v25
  v_and_b32 v25, 0xffff0000, v25
  v_add_f32 v150, v150, v26
  v_add_f32 v150, v150, v25
  v_lshlrev_b32 v25, 16, v40
  v_and_b32 v26, 0xffff0000, v40
  v_mul_f32 v25, v25, v61
  v_mul_f32 v26, v26, v56
  v_cvt_pk_bf16_f32 v25, v25, v26
  v_lshlrev_b32 v26, 16, v25
  v_and_b32 v25, 0xffff0000, v25
  v_add_f32 v150, v150, v26
  v_add_f32 v150, v150, v25
  v_lshlrev_b32 v25, 16, v42
  v_and_b32 v26, 0xffff0000, v42
  v_mul_f32 v25, v25, v57
  v_mul_f32 v26, v26, v52
  v_cvt_pk_bf16_f32 v25, v25, v26
  v_lshlrev_b32 v26, 16, v25
  v_and_b32 v25, 0xffff0000, v25
  v_add_f32 v151, v25, v26
  v_lshlrev_b32 v25, 16, v43
  v_and_b32 v26, 0xffff0000, v43
  v_mul_f32 v25, v25, v58
  v_mul_f32 v26, v26, v53
  v_cvt_pk_bf16_f32 v25, v25, v26
  v_lshlrev_b32 v26, 16, v25
  v_and_b32 v25, 0xffff0000, v25
  v_add_f32 v151, v151, v26
  v_add_f32 v151, v151, v25
  v_lshlrev_b32 v25, 16, v44
  v_and_b32 v26, 0xffff0000, v44
  v_mul_f32 v25, v25, v59
  v_mul_f32 v26, v26, v54
  v_cvt_pk_bf16_f32 v25, v25, v26
  v_lshlrev_b32 v26, 16, v25
  v_and_b32 v25, 0xffff0000, v25
  v_add_f32 v151, v151, v26
  v_add_f32 v151, v151, v25
  v_lshlrev_b32 v25, 16, v45
  v_and_b32 v26, 0xffff0000, v45
  v_mul_f32 v25, v25, v60
  v_mul_f32 v26, v26, v55
  v_cvt_pk_bf16_f32 v25, v25, v26
  v_lshlrev_b32 v26, 16, v25
  v_and_b32 v25, 0xffff0000, v25
  v_add_f32 v151, v151, v26
  v_add_f32 v151, v151, v25
  v_lshlrev_b32 v25, 16, v46
  v_and_b32 v26, 0xffff0000, v46
  v_mul_f32 v25, v25, v61
  v_mul_f32 v26, v26, v56
  v_cvt_pk_bf16_f32 v25, v25, v26
  v_lshlrev_b32 v26, 16, v25
  v_and_b32 v25, 0xffff0000, v25
  v_add_f32 v151, v151, v26
  v_add_f32 v151, v151, v25
  v_add_f32_dpp v144, v144, v144 row_ror:8 row_mask:0xf bank_mask:0xf
  v_add_f32_dpp v145, v145, v145 row_ror:8 row_mask:0xf bank_mask:0xf
  v_add_f32_dpp v146, v146, v146 row_ror:8 row_mask:0xf bank_mask:0xf
  v_add_f32_dpp v147, v147, v147 row_ror:8 row_mask:0xf bank_mask:0xf
  v_add_f32_dpp v148, v148, v148 row_ror:8 row_mask:0xf bank_mask:0xf
  v_add_f32_dpp v149, v149, v149 row_ror:8 row_mask:0xf bank_mask:0xf
  v_add_f32_dpp v150, v150, v150 row_ror:8 row_mask:0xf bank_mask:0xf
  v_add_f32_dpp v151, v151, v151 row_ror:8 row_mask:0xf bank_mask:0xf
  v_add_f32_dpp v144, v144, v144 row_ror:4 row_mask:0xf bank_mask:0xf
  v_add_f32_dpp v145, v145, v145 row_ror:4 row_mask:0xf bank_mask:0xf
  v_add_f32_dpp v146, v146, v146 row_ror:4 row_mask:0xf bank_mask:0xf
  v_add_f32_dpp v147, v147, v147 row_ror:4 row_mask:0xf bank_mask:0xf
  v_add_f32_dpp v148, v148, v148 row_ror:4 row_mask:0xf bank_mask:0xf
  v_add_f32_dpp v149, v149, v149 row_ror:4 row_mask:0xf bank_mask:0xf
  v_add_f32_dpp v150, v150, v150 row_ror:4 row_mask:0xf bank_mask:0xf
  v_add_f32_dpp v151, v151, v151 row_ror:4 row_mask:0xf bank_mask:0xf
  v_add_f32_dpp v144, v144, v144 row_ror:2 row_mask:0xf bank_mask:0xf
  v_add_f32_dpp v145, v145, v145 row_ror:2 row_mask:0xf bank_mask:0xf
  v_add_f32_dpp v146, v146, v146 row_ror:2 row_mask:0xf bank_mask:0xf
  v_add_f32_dpp v147, v147, v147 row_ror:2 row_mask:0xf bank_mask:0xf
  v_add_f32_dpp v148, v148, v148 row_ror:2 row_mask:0xf bank_mask:0xf
  v_add_f32_dpp v149, v149, v149 row_ror:2 row_mask:0xf bank_mask:0xf
  v_add_f32_dpp v150, v150, v150 row_ror:2 row_mask:0xf bank_mask:0xf
  v_add_f32_dpp v151, v151, v151 row_ror:2 row_mask:0xf bank_mask:0xf
  v_add_f32_dpp v144, v144, v144 row_ror:1 row_mask:0xf bank_mask:0xf
  v_add_f32_dpp v145, v145, v145 row_ror:1 row_mask:0xf bank_mask:0xf
  v_add_f32_dpp v146, v146, v146 row_ror:1 row_mask:0xf bank_mask:0xf
  v_add_f32_dpp v147, v147, v147 row_ror:1 row_mask:0xf bank_mask:0xf
  v_add_f32_dpp v148, v148, v148 row_ror:1 row_mask:0xf bank_mask:0xf
  v_add_f32_dpp v149, v149, v149 row_ror:1 row_mask:0xf bank_mask:0xf
  v_add_f32_dpp v150, v150, v150 row_ror:1 row_mask:0xf bank_mask:0xf
  v_add_f32_dpp v151, v151, v151 row_ror:1 row_mask:0xf bank_mask:0xf
  v_mov_b32 v152, v144
  v_mov_b32 v153, v145
  v_mov_b32 v154, v146
  v_mov_b32 v155, v147
  v_mov_b32 v156, v148
  v_mov_b32 v157, v149
  v_mov_b32 v158, v150
  v_mov_b32 v159, v151
  v_permlane32_swap_b32 v144, v152
  v_permlane32_swap_b32 v145, v153
  v_permlane32_swap_b32 v146, v154
  v_permlane32_swap_b32 v147, v155
  v_permlane32_swap_b32 v148, v156
  v_permlane32_swap_b32 v149, v157
  v_permlane32_swap_b32 v150, v158
  v_permlane32_swap_b32 v151, v159
  v_add_f32 v144, v144, v152
  v_add_f32 v145, v145, v153
  v_add_f32 v146, v146, v154
  v_add_f32 v147, v147, v155
  v_add_f32 v148, v148, v156
  v_add_f32 v149, v149, v157
  v_add_f32 v150, v150, v158
  v_add_f32 v151, v151, v159
  v_mov_b32 v152, v144
  v_mov_b32 v153, v145
  v_mov_b32 v154, v146
  v_mov_b32 v155, v147
  v_mov_b32 v156, v148
  v_mov_b32 v157, v149
  v_mov_b32 v158, v150
  v_mov_b32 v159, v151
  v_permlane16_swap_b32 v144, v152
  v_permlane16_swap_b32 v145, v153
  v_permlane16_swap_b32 v146, v154
  v_permlane16_swap_b32 v147, v155
  v_permlane16_swap_b32 v148, v156
  v_permlane16_swap_b32 v149, v157
  v_permlane16_swap_b32 v150, v158
  v_permlane16_swap_b32 v151, v159
  v_add_f32 v144, v144, v152
  v_add_f32 v145, v145, v153
  v_add_f32 v146, v146, v154
  v_add_f32 v147, v147, v155
  v_add_f32 v148, v148, v156
  v_add_f32 v149, v149, v157
  v_add_f32 v150, v150, v158
  v_add_f32 v151, v151, v159
  v_mov_b32 v24, v144
  v_cmp_eq_u32 vcc, 1, v1
  s_nop 1
  v_cndmask_b32 v24, v24, v145, vcc
  v_cmp_eq_u32 vcc, 2, v1
  s_nop 1
  v_cndmask_b32 v24, v24, v146, vcc
  v_cmp_eq_u32 vcc, 3, v1
  s_nop 1
  v_cndmask_b32 v24, v24, v147, vcc
  v_cmp_eq_u32 vcc, 4, v1
  s_nop 1
  v_cndmask_b32 v24, v24, v148, vcc
  v_cmp_eq_u32 vcc, 5, v1
  s_nop 1
  v_cndmask_b32 v24, v24, v149, vcc
  v_cmp_eq_u32 vcc, 6, v1
  s_nop 1
  v_cndmask_b32 v24, v24, v150, vcc
  v_cmp_eq_u32 vcc, 7, v1
  s_nop 1
  v_cndmask_b32 v24, v24, v151, vcc
  v_cvt_pk_bf16_f32 v25, v24, v24
  v_lshlrev_b32 v24, 16, v25
  v_mul_f32 v24, 0xbfb8aa3b, v24
  v_exp_f32 v24, v24
  s_nop 0
  v_add_f32 v24, 1.0, v24
  v_rcp_f32 v24, v24
  s_nop 0
  v_cvt_pk_bf16_f32 v25, v24, v24
  v_lshlrev_b32 v24, 16, v25
  s_lshl_b32 s21, s59, 2
  s_mov_b64 exec, 0xff
  buffer_store_dword v24, v5, s[28:31], s21 offen sc1
  s_mov_b64 exec, -1
  s_sub_u32 s59, s59, 1024
  s_waitcnt vmcnt(1)
  v_lshlrev_b32 v25, 16, v160
  v_and_b32 v26, 0xffff0000, v160
  v_mul_f32 v25, v25, v57
  v_mul_f32 v26, v26, v52
  v_cvt_pk_bf16_f32 v25, v25, v26
  v_lshlrev_b32 v26, 16, v25
  v_and_b32 v25, 0xffff0000, v25
  v_add_f32 v144, v25, v26
  v_lshlrev_b32 v25, 16, v161
  v_and_b32 v26, 0xffff0000, v161
  v_mul_f32 v25, v25, v58
  v_mul_f32 v26, v26, v53
  v_cvt_pk_bf16_f32 v25, v25, v26
  v_lshlrev_b32 v26, 16, v25
  v_and_b32 v25, 0xffff0000, v25
  v_add_f32 v144, v144, v26
  v_add_f32 v144, v144, v25
  v_lshlrev_b32 v25, 16, v162
  v_and_b32 v26, 0xffff0000, v162
  v_mul_f32 v25, v25, v59
  v_mul_f32 v26, v26, v54
  v_cvt_pk_bf16_f32 v25, v25, v26
  v_lshlrev_b32 v26, 16, v25
  v_and_b32 v25, 0xffff0000, v25
  v_add_f32 v144, v144, v26
  v_add_f32 v144, v144, v25
  v_lshlrev_b32 v25, 16, v163
  v_and_b32 v26, 0xffff0000, v163
  v_mul_f32 v25, v25, v60
  v_mul_f32 v26, v26, v55
  v_cvt_pk_bf16_f32 v25, v25, v26
  v_lshlrev_b32 v26, 16, v25
  v_and_b32 v25, 0xffff0000, v25
  v_add_f32 v144, v144, v26
  v_add_f32 v144, v144, v25
  v_lshlrev_b32 v25, 16, v164
  v_and_b32 v26, 0xffff0000, v164
  v_mul_f32 v25, v25, v61
  v_mul_f32 v26, v26, v56
  v_cvt_pk_bf16_f32 v25, v25, v26
  v_lshlrev_b32 v26, 16, v25
  v_and_b32 v25, 0xffff0000, v25
  v_add_f32 v144, v144, v26
  v_add_f32 v144, v144, v25
  v_lshlrev_b32 v25, 16, v166
  v_and_b32 v26, 0xffff0000, v166
  v_mul_f32 v25, v25, v57
  v_mul_f32 v26, v26, v52
  v_cvt_pk_bf16_f32 v25, v25, v26
  v_lshlrev_b32 v26, 16, v25
  v_and_b32 v25, 0xffff0000, v25
  v_add_f32 v145, v25, v26
  v_lshlrev_b32 v25, 16, v167
  v_and_b32 v26, 0xffff0000, v167
  v_mul_f32 v25, v25, v58
  v_mul_f32 v26, v26, v53
  v_cvt_pk_bf16_f32 v25, v25, v26
  v_lshlrev_b32 v26, 16, v25
  v_and_b32 v25, 0xffff0000, v25
  v_add_f32 v145, v145, v26
  v_add_f32 v145, v145, v25
  v_lshlrev_b32 v25, 16, v168
  v_and_b32 v26, 0xffff0000, v168
  v_mul_f32 v25, v25, v59
  v_mul_f32 v26, v26, v54
  v_cvt_pk_bf16_f32 v25, v25, v26
  v_lshlrev_b32 v26, 16, v25
  v_and_b32 v25, 0xffff0000, v25
  v_add_f32 v145, v145, v26
  v_add_f32 v145, v145, v25
  v_lshlrev_b32 v25, 16, v169
  v_and_b32 v26, 0xffff0000, v169
  v_mul_f32 v25, v25, v60
  v_mul_f32 v26, v26, v55
  v_cvt_pk_bf16_f32 v25, v25, v26
  v_lshlrev_b32 v26, 16, v25
  v_and_b32 v25, 0xffff0000, v25
  v_add_f32 v145, v145, v26
  v_add_f32 v145, v145, v25
  v_lshlrev_b32 v25, 16, v170
  v_and_b32 v26, 0xffff0000, v170
  v_mul_f32 v25, v25, v61
  v_mul_f32 v26, v26, v56
  v_cvt_pk_bf16_f32 v25, v25, v26
  v_lshlrev_b32 v26, 16, v25
  v_and_b32 v25, 0xffff0000, v25
  v_add_f32 v145, v145, v26
  v_add_f32 v145, v145, v25
  v_lshlrev_b32 v25, 16, v172
  v_and_b32 v26, 0xffff0000, v172
  v_mul_f32 v25, v25, v57
  v_mul_f32 v26, v26, v52
  v_cvt_pk_bf16_f32 v25, v25, v26
  v_lshlrev_b32 v26, 16, v25
  v_and_b32 v25, 0xffff0000, v25
  v_add_f32 v146, v25, v26
  v_lshlrev_b32 v25, 16, v173
  v_and_b32 v26, 0xffff0000, v173
  v_mul_f32 v25, v25, v58
  v_mul_f32 v26, v26, v53
  v_cvt_pk_bf16_f32 v25, v25, v26
  v_lshlrev_b32 v26, 16, v25
  v_and_b32 v25, 0xffff0000, v25
  v_add_f32 v146, v146, v26
  v_add_f32 v146, v146, v25
  v_lshlrev_b32 v25, 16, v174
  v_and_b32 v26, 0xffff0000, v174
  v_mul_f32 v25, v25, v59
  v_mul_f32 v26, v26, v54
  v_cvt_pk_bf16_f32 v25, v25, v26
  v_lshlrev_b32 v26, 16, v25
  v_and_b32 v25, 0xffff0000, v25
  v_add_f32 v146, v146, v26
  v_add_f32 v146, v146, v25
  v_lshlrev_b32 v25, 16, v175
  v_and_b32 v26, 0xffff0000, v175
  v_mul_f32 v25, v25, v60
  v_mul_f32 v26, v26, v55
  v_cvt_pk_bf16_f32 v25, v25, v26
  v_lshlrev_b32 v26, 16, v25
  v_and_b32 v25, 0xffff0000, v25
  v_add_f32 v146, v146, v26
  v_add_f32 v146, v146, v25
  v_lshlrev_b32 v25, 16, v176
  v_and_b32 v26, 0xffff0000, v176
  v_mul_f32 v25, v25, v61
  v_mul_f32 v26, v26, v56
  v_cvt_pk_bf16_f32 v25, v25, v26
  v_lshlrev_b32 v26, 16, v25
  v_and_b32 v25, 0xffff0000, v25
  v_add_f32 v146, v146, v26
  v_add_f32 v146, v146, v25
  v_lshlrev_b32 v25, 16, v178
  v_and_b32 v26, 0xffff0000, v178
  v_mul_f32 v25, v25, v57
  v_mul_f32 v26, v26, v52
  v_cvt_pk_bf16_f32 v25, v25, v26
  v_lshlrev_b32 v26, 16, v25
  v_and_b32 v25, 0xffff0000, v25
  v_add_f32 v147, v25, v26
  v_lshlrev_b32 v25, 16, v179
  v_and_b32 v26, 0xffff0000, v179
  v_mul_f32 v25, v25, v58
  v_mul_f32 v26, v26, v53
  v_cvt_pk_bf16_f32 v25, v25, v26
  v_lshlrev_b32 v26, 16, v25
  v_and_b32 v25, 0xffff0000, v25
  v_add_f32 v147, v147, v26
  v_add_f32 v147, v147, v25
  v_lshlrev_b32 v25, 16, v180
  v_and_b32 v26, 0xffff0000, v180
  v_mul_f32 v25, v25, v59
  v_mul_f32 v26, v26, v54
  v_cvt_pk_bf16_f32 v25, v25, v26
  v_lshlrev_b32 v26, 16, v25
  v_and_b32 v25, 0xffff0000, v25
  v_add_f32 v147, v147, v26
  v_add_f32 v147, v147, v25
  v_lshlrev_b32 v25, 16, v181
  v_and_b32 v26, 0xffff0000, v181
  v_mul_f32 v25, v25, v60
  v_mul_f32 v26, v26, v55
  v_cvt_pk_bf16_f32 v25, v25, v26
  v_lshlrev_b32 v26, 16, v25
  v_and_b32 v25, 0xffff0000, v25
  v_add_f32 v147, v147, v26
  v_add_f32 v147, v147, v25
  v_lshlrev_b32 v25, 16, v182
  v_and_b32 v26, 0xffff0000, v182
  v_mul_f32 v25, v25, v61
  v_mul_f32 v26, v26, v56
  v_cvt_pk_bf16_f32 v25, v25, v26
  v_lshlrev_b32 v26, 16, v25
  v_and_b32 v25, 0xffff0000, v25
  v_add_f32 v147, v147, v26
  v_add_f32 v147, v147, v25
  v_lshlrev_b32 v25, 16, v184
  v_and_b32 v26, 0xffff0000, v184
  v_mul_f32 v25, v25, v57
  v_mul_f32 v26, v26, v52
  v_cvt_pk_bf16_f32 v25, v25, v26
  v_lshlrev_b32 v26, 16, v25
  v_and_b32 v25, 0xffff0000, v25
  v_add_f32 v148, v25, v26
  v_lshlrev_b32 v25, 16, v185
  v_and_b32 v26, 0xffff0000, v185
  v_mul_f32 v25, v25, v58
  v_mul_f32 v26, v26, v53
  v_cvt_pk_bf16_f32 v25, v25, v26
  v_lshlrev_b32 v26, 16, v25
  v_and_b32 v25, 0xffff0000, v25
  v_add_f32 v148, v148, v26
  v_add_f32 v148, v148, v25
  v_lshlrev_b32 v25, 16, v186
  v_and_b32 v26, 0xffff0000, v186
  v_mul_f32 v25, v25, v59
  v_mul_f32 v26, v26, v54
  v_cvt_pk_bf16_f32 v25, v25, v26
  v_lshlrev_b32 v26, 16, v25
  v_and_b32 v25, 0xffff0000, v25
  v_add_f32 v148, v148, v26
  v_add_f32 v148, v148, v25
  v_lshlrev_b32 v25, 16, v187
  v_and_b32 v26, 0xffff0000, v187
  v_mul_f32 v25, v25, v60
  v_mul_f32 v26, v26, v55
  v_cvt_pk_bf16_f32 v25, v25, v26
  v_lshlrev_b32 v26, 16, v25
  v_and_b32 v25, 0xffff0000, v25
  v_add_f32 v148, v148, v26
  v_add_f32 v148, v148, v25
  v_lshlrev_b32 v25, 16, v188
  v_and_b32 v26, 0xffff0000, v188
  v_mul_f32 v25, v25, v61
  v_mul_f32 v26, v26, v56
  v_cvt_pk_bf16_f32 v25, v25, v26
  v_lshlrev_b32 v26, 16, v25
  v_and_b32 v25, 0xffff0000, v25
  v_add_f32 v148, v148, v26
  v_add_f32 v148, v148, v25
  v_lshlrev_b32 v25, 16, v190
  v_and_b32 v26, 0xffff0000, v190
  v_mul_f32 v25, v25, v57
  v_mul_f32 v26, v26, v52
  v_cvt_pk_bf16_f32 v25, v25, v26
  v_lshlrev_b32 v26, 16, v25
  v_and_b32 v25, 0xffff0000, v25
  v_add_f32 v149, v25, v26
  v_lshlrev_b32 v25, 16, v191
  v_and_b32 v26, 0xffff0000, v191
  v_mul_f32 v25, v25, v58
  v_mul_f32 v26, v26, v53
  v_cvt_pk_bf16_f32 v25, v25, v26
  v_lshlrev_b32 v26, 16, v25
  v_and_b32 v25, 0xffff0000, v25
  v_add_f32 v149, v149, v26
  v_add_f32 v149, v149, v25
  v_lshlrev_b32 v25, 16, v192
  v_and_b32 v26, 0xffff0000, v192
  v_mul_f32 v25, v25, v59
  v_mul_f32 v26, v26, v54
  v_cvt_pk_bf16_f32 v25, v25, v26
  v_lshlrev_b32 v26, 16, v25
  v_and_b32 v25, 0xffff0000, v25
  v_add_f32 v149, v149, v26
  v_add_f32 v149, v149, v25
  v_lshlrev_b32 v25, 16, v193
  v_and_b32 v26, 0xffff0000, v193
  v_mul_f32 v25, v25, v60
  v_mul_f32 v26, v26, v55
  v_cvt_pk_bf16_f32 v25, v25, v26
  v_lshlrev_b32 v26, 16, v25
  v_and_b32 v25, 0xffff0000, v25
  v_add_f32 v149, v149, v26
  v_add_f32 v149, v149, v25
  v_lshlrev_b32 v25, 16, v194
  v_and_b32 v26, 0xffff0000, v194
  v_mul_f32 v25, v25, v61
  v_mul_f32 v26, v26, v56
  v_cvt_pk_bf16_f32 v25, v25, v26
  v_lshlrev_b32 v26, 16, v25
  v_and_b32 v25, 0xffff0000, v25
  v_add_f32 v149, v149, v26
  v_add_f32 v149, v149, v25
  v_lshlrev_b32 v25, 16, v196
  v_and_b32 v26, 0xffff0000, v196
  v_mul_f32 v25, v25, v57
  v_mul_f32 v26, v26, v52
  v_cvt_pk_bf16_f32 v25, v25, v26
  v_lshlrev_b32 v26, 16, v25
  v_and_b32 v25, 0xffff0000, v25
  v_add_f32 v150, v25, v26
  v_lshlrev_b32 v25, 16, v197
  v_and_b32 v26, 0xffff0000, v197
  v_mul_f32 v25, v25, v58
  v_mul_f32 v26, v26, v53
  v_cvt_pk_bf16_f32 v25, v25, v26
  v_lshlrev_b32 v26, 16, v25
  v_and_b32 v25, 0xffff0000, v25
  v_add_f32 v150, v150, v26
  v_add_f32 v150, v150, v25
  v_lshlrev_b32 v25, 16, v198
  v_and_b32 v26, 0xffff0000, v198
  v_mul_f32 v25, v25, v59
  v_mul_f32 v26, v26, v54
  v_cvt_pk_bf16_f32 v25, v25, v26
  v_lshlrev_b32 v26, 16, v25
  v_and_b32 v25, 0xffff0000, v25
  v_add_f32 v150, v150, v26
  v_add_f32 v150, v150, v25
  v_lshlrev_b32 v25, 16, v199
  v_and_b32 v26, 0xffff0000, v199
  v_mul_f32 v25, v25, v60
  v_mul_f32 v26, v26, v55
  v_cvt_pk_bf16_f32 v25, v25, v26
  v_lshlrev_b32 v26, 16, v25
  v_and_b32 v25, 0xffff0000, v25
  v_add_f32 v150, v150, v26
  v_add_f32 v150, v150, v25
  v_lshlrev_b32 v25, 16, v200
  v_and_b32 v26, 0xffff0000, v200
  v_mul_f32 v25, v25, v61
  v_mul_f32 v26, v26, v56
  v_cvt_pk_bf16_f32 v25, v25, v26
  v_lshlrev_b32 v26, 16, v25
  v_and_b32 v25, 0xffff0000, v25
  v_add_f32 v150, v150, v26
  v_add_f32 v150, v150, v25
  v_lshlrev_b32 v25, 16, v202
  v_and_b32 v26, 0xffff0000, v202
  v_mul_f32 v25, v25, v57
  v_mul_f32 v26, v26, v52
  v_cvt_pk_bf16_f32 v25, v25, v26
  v_lshlrev_b32 v26, 16, v25
  v_and_b32 v25, 0xffff0000, v25
  v_add_f32 v151, v25, v26
  v_lshlrev_b32 v25, 16, v203
  v_and_b32 v26, 0xffff0000, v203
  v_mul_f32 v25, v25, v58
  v_mul_f32 v26, v26, v53
  v_cvt_pk_bf16_f32 v25, v25, v26
  v_lshlrev_b32 v26, 16, v25
  v_and_b32 v25, 0xffff0000, v25
  v_add_f32 v151, v151, v26
  v_add_f32 v151, v151, v25
  v_lshlrev_b32 v25, 16, v204
  v_and_b32 v26, 0xffff0000, v204
  v_mul_f32 v25, v25, v59
  v_mul_f32 v26, v26, v54
  v_cvt_pk_bf16_f32 v25, v25, v26
  v_lshlrev_b32 v26, 16, v25
  v_and_b32 v25, 0xffff0000, v25
  v_add_f32 v151, v151, v26
  v_add_f32 v151, v151, v25
  v_lshlrev_b32 v25, 16, v205
  v_and_b32 v26, 0xffff0000, v205
  v_mul_f32 v25, v25, v60
  v_mul_f32 v26, v26, v55
  v_cvt_pk_bf16_f32 v25, v25, v26
  v_lshlrev_b32 v26, 16, v25
  v_and_b32 v25, 0xffff0000, v25
  v_add_f32 v151, v151, v26
  v_add_f32 v151, v151, v25
  v_lshlrev_b32 v25, 16, v206
  v_and_b32 v26, 0xffff0000, v206
  v_mul_f32 v25, v25, v61
  v_mul_f32 v26, v26, v56
  v_cvt_pk_bf16_f32 v25, v25, v26
  v_lshlrev_b32 v26, 16, v25
  v_and_b32 v25, 0xffff0000, v25
  v_add_f32 v151, v151, v26
  v_add_f32 v151, v151, v25
  v_add_f32_dpp v144, v144, v144 row_ror:8 row_mask:0xf bank_mask:0xf
  v_add_f32_dpp v145, v145, v145 row_ror:8 row_mask:0xf bank_mask:0xf
  v_add_f32_dpp v146, v146, v146 row_ror:8 row_mask:0xf bank_mask:0xf
  v_add_f32_dpp v147, v147, v147 row_ror:8 row_mask:0xf bank_mask:0xf
  v_add_f32_dpp v148, v148, v148 row_ror:8 row_mask:0xf bank_mask:0xf
  v_add_f32_dpp v149, v149, v149 row_ror:8 row_mask:0xf bank_mask:0xf
  v_add_f32_dpp v150, v150, v150 row_ror:8 row_mask:0xf bank_mask:0xf
  v_add_f32_dpp v151, v151, v151 row_ror:8 row_mask:0xf bank_mask:0xf
  v_add_f32_dpp v144, v144, v144 row_ror:4 row_mask:0xf bank_mask:0xf
  v_add_f32_dpp v145, v145, v145 row_ror:4 row_mask:0xf bank_mask:0xf
  v_add_f32_dpp v146, v146, v146 row_ror:4 row_mask:0xf bank_mask:0xf
  v_add_f32_dpp v147, v147, v147 row_ror:4 row_mask:0xf bank_mask:0xf
  v_add_f32_dpp v148, v148, v148 row_ror:4 row_mask:0xf bank_mask:0xf
  v_add_f32_dpp v149, v149, v149 row_ror:4 row_mask:0xf bank_mask:0xf
  v_add_f32_dpp v150, v150, v150 row_ror:4 row_mask:0xf bank_mask:0xf
  v_add_f32_dpp v151, v151, v151 row_ror:4 row_mask:0xf bank_mask:0xf
  v_add_f32_dpp v144, v144, v144 row_ror:2 row_mask:0xf bank_mask:0xf
  v_add_f32_dpp v145, v145, v145 row_ror:2 row_mask:0xf bank_mask:0xf
  v_add_f32_dpp v146, v146, v146 row_ror:2 row_mask:0xf bank_mask:0xf
  v_add_f32_dpp v147, v147, v147 row_ror:2 row_mask:0xf bank_mask:0xf
  v_add_f32_dpp v148, v148, v148 row_ror:2 row_mask:0xf bank_mask:0xf
  v_add_f32_dpp v149, v149, v149 row_ror:2 row_mask:0xf bank_mask:0xf
  v_add_f32_dpp v150, v150, v150 row_ror:2 row_mask:0xf bank_mask:0xf
  v_add_f32_dpp v151, v151, v151 row_ror:2 row_mask:0xf bank_mask:0xf
  v_add_f32_dpp v144, v144, v144 row_ror:1 row_mask:0xf bank_mask:0xf
  v_add_f32_dpp v145, v145, v145 row_ror:1 row_mask:0xf bank_mask:0xf
  v_add_f32_dpp v146, v146, v146 row_ror:1 row_mask:0xf bank_mask:0xf
  v_add_f32_dpp v147, v147, v147 row_ror:1 row_mask:0xf bank_mask:0xf
  v_add_f32_dpp v148, v148, v148 row_ror:1 row_mask:0xf bank_mask:0xf
  v_add_f32_dpp v149, v149, v149 row_ror:1 row_mask:0xf bank_mask:0xf
  v_add_f32_dpp v150, v150, v150 row_ror:1 row_mask:0xf bank_mask:0xf
  v_add_f32_dpp v151, v151, v151 row_ror:1 row_mask:0xf bank_mask:0xf
  v_mov_b32 v152, v144
  v_mov_b32 v153, v145
  v_mov_b32 v154, v146
  v_mov_b32 v155, v147
  v_mov_b32 v156, v148
  v_mov_b32 v157, v149
  v_mov_b32 v158, v150
  v_mov_b32 v159, v151
  v_permlane32_swap_b32 v144, v152
  v_permlane32_swap_b32 v145, v153
  v_permlane32_swap_b32 v146, v154
  v_permlane32_swap_b32 v147, v155
  v_permlane32_swap_b32 v148, v156
  v_permlane32_swap_b32 v149, v157
  v_permlane32_swap_b32 v150, v158
  v_permlane32_swap_b32 v151, v159
  v_add_f32 v144, v144, v152
  v_add_f32 v145, v145, v153
  v_add_f32 v146, v146, v154
  v_add_f32 v147, v147, v155
  v_add_f32 v148, v148, v156
  v_add_f32 v149, v149, v157
  v_add_f32 v150, v150, v158
  v_add_f32 v151, v151, v159
  v_mov_b32 v152, v144
  v_mov_b32 v153, v145
  v_mov_b32 v154, v146
  v_mov_b32 v155, v147
  v_mov_b32 v156, v148
  v_mov_b32 v157, v149
  v_mov_b32 v158, v150
  v_mov_b32 v159, v151
  v_permlane16_swap_b32 v144, v152
  v_permlane16_swap_b32 v145, v153
  v_permlane16_swap_b32 v146, v154
  v_permlane16_swap_b32 v147, v155
  v_permlane16_swap_b32 v148, v156
  v_permlane16_swap_b32 v149, v157
  v_permlane16_swap_b32 v150, v158
  v_permlane16_swap_b32 v151, v159
  v_add_f32 v144, v144, v152
  v_add_f32 v145, v145, v153
  v_add_f32 v146, v146, v154
  v_add_f32 v147, v147, v155
  v_add_f32 v148, v148, v156
  v_add_f32 v149, v149, v157
  v_add_f32 v150, v150, v158
  v_add_f32 v151, v151, v159
  v_mov_b32 v24, v144
  v_cmp_eq_u32 vcc, 1, v1
  s_nop 1
  v_cndmask_b32 v24, v24, v145, vcc
  v_cmp_eq_u32 vcc, 2, v1
  s_nop 1
  v_cndmask_b32 v24, v24, v146, vcc
  v_cmp_eq_u32 vcc, 3, v1
  s_nop 1
  v_cndmask_b32 v24, v24, v147, vcc
  v_cmp_eq_u32 vcc, 4, v1
  s_nop 1
  v_cndmask_b32 v24, v24, v148, vcc
  v_cmp_eq_u32 vcc, 5, v1
  s_nop 1
  v_cndmask_b32 v24, v24, v149, vcc
  v_cmp_eq_u32 vcc, 6, v1
  s_nop 1
  v_cndmask_b32 v24, v24, v150, vcc
  v_cmp_eq_u32 vcc, 7, v1
  s_nop 1
  v_cndmask_b32 v24, v24, v151, vcc
  v_cvt_pk_bf16_f32 v25, v24, v24
  v_lshlrev_b32 v24, 16, v25
  v_mul_f32 v24, 0xbfb8aa3b, v24
  v_exp_f32 v24, v24
  s_nop 0
  v_add_f32 v24, 1.0, v24
  v_rcp_f32 v24, v24
  s_nop 0
  v_cvt_pk_bf16_f32 v25, v24, v24
  v_lshlrev_b32 v24, 16, v25
  s_lshl_b32 s21, s59, 2
  s_mov_b64 exec, 0xff
  buffer_store_dword v24, v5, s[28:31], s21 offen sc1
  s_mov_b64 exec, -1
  s_waitcnt vmcnt(0)
  s_barrier
  s_lshr_b32 s21, s2, 2
  s_lshl_b32 s21, s21, 7
  s_add_u32 s21, s21, 93184
  s_cmp_lg_u32 s20, 0
  s_cbranch_scc1 af_249
  v_mov_b32 v10, 0
  v_mov_b32 v11, 1
  s_mov_b64 exec, 1
  buffer_atomic_add v11, v10, s[72:75], s21 offen sc1
  s_mov_b64 exec, -1
  s_nop 1
af_249:
  s_branch om_248
om_247:
  s_load_dwordx2 s[8:9], s[0:1], 88
  s_mov_b32 s51, s21
  s_lshr_b32 s52, s2, 2
  s_lshl_b32 s52, s52, 7
  s_add_u32 s21, s52, 94208
  s_cmp_lg_u32 s20, 0
  s_cbranch_scc1 wf_251
  v_mov_b32 v20, 0
  s_mov_b32 s101, 0
wf_250:
  buffer_load_dword v21, v20, s[72:75], s21 offen sc1
  s_add_u32 s101, s101, 1
  s_cmp_gt_u32 s101, 131072
  s_cbranch_scc1 main_end
  s_waitcnt vmcnt(0)
  v_readfirstlane_b32 s100, v21
  s_cmp_ge_u32 s100, 4
  s_cbranch_scc1 wf_251
  s_sleep 32
  s_branch wf_250
wf_251:
  s_barrier
  s_add_u32 s21, s52, 104448
  s_cmp_lg_u32 s20, 0
  s_cbranch_scc1 wf_253
  v_mov_b32 v20, 0
  s_mov_b32 s101, 0
wf_252:
  buffer_load_dword v21, v20, s[72:75], s21 offen sc1
  s_add_u32 s101, s101, 1
  s_cmp_gt_u32 s101, 131072
  s_cbranch_scc1 main_end
  s_waitcnt vmcnt(0)
  v_readfirstlane_b32 s100, v21
  s_cmp_ge_u32 s100, 80
  s_cbranch_scc1 wf_253
  s_sleep 32
  s_branch wf_252
wf_253:
  s_barrier
  v_lshlrev_b32 v6, 2, v2
  s_lshl_b32 s22, s47, 6
  buffer_load_dword v30, v6, s[28:31], s22 offen sc1
  buffer_load_dword v31, v6, s[28:31], s22 offen offset:64 sc1
  s_add_u32 s22, s51, 0
  buffer_load_dwordx4 v[144:147], v4, s[16:19], s22 offen offset:0 sc1
  buffer_load_dwordx4 v[148:151], v4, s[16:19], s22 offen offset:1024 sc1
  buffer_load_dwordx4 v[152:155], v4, s[16:19], s22 offen offset:2048 sc1
  buffer_load_dwordx4 v[156:159], v4, s[16:19], s22 offen offset:3072 sc1
  s_add_u32 s22, s51, 4096
  buffer_load_dwordx4 v[160:163], v4, s[16:19], s22 offen offset:0 sc1
  buffer_load_dwordx4 v[164:167], v4, s[16:19], s22 offen offset:1024 sc1
  buffer_load_dwordx4 v[168:171], v4, s[16:19], s22 offen offset:2048 sc1
  buffer_load_dwordx4 v[172:175], v4, s[16:19], s22 offen offset:3072 sc1
  s_add_u32 s22, s51, 8192
  buffer_load_dwordx4 v[176:179], v4, s[16:19], s22 offen offset:0 sc1
  buffer_load_dwordx4 v[180:183], v4, s[16:19], s22 offen offset:1024 sc1
  s_add_u32 s22, s51, 40960
  buffer_load_dwordx4 v[184:187], v4, s[16:19], s22 offen offset:0 sc1
  buffer_load_dwordx4 v[188:191], v4, s[16:19], s22 offen offset:1024 sc1
  buffer_load_dwordx4 v[192:195], v4, s[16:19], s22 offen offset:2048 sc1
  buffer_load_dwordx4 v[196:199], v4, s[16:19], s22 offen offset:3072 sc1
  s_add_u32 s22, s51, 45056
  buffer_load_dwordx4 v[200:203], v4, s[16:19], s22 offen offset:0 sc1
  buffer_load_dwordx4 v[204:207], v4, s[16:19], s22 offen offset:1024 sc1
  buffer_load_dwordx4 v[208:211], v4, s[16:19], s22 offen offset:2048 sc1
  buffer_load_dwordx4 v[212:215], v4, s[16:19], s22 offen offset:3072 sc1
  s_add_u32 s22, s51, 49152
  buffer_load_dwordx4 v[216:219], v4, s[16:19], s22 offen offset:0 sc1
  buffer_load_dwordx4 v[220:223], v4, s[16:19], s22 offen offset:1024 sc1
  v_mul_u32_u24 v9, 1280, v2
  v_lshl_add_u32 v9, v3, 3, v9
  s_mul_i32 s22, s47, 20480
  s_add_u32 s22, s22, s45
  s_add_u32 s23, s22, 20480
  s_waitcnt vmcnt(20) lgkmcnt(0)
  v_sub_f32 v32, 1.0, v30
  v_sub_f32 v33, 1.0, v31
  v_cvt_pk_bf16_f32 v26, v32, v33
  v_lshlrev_b32 v32, 16, v26
  v_and_b32 v33, 0xffff0000, v26
  v_cvt_pk_bf16_f32 v26, v64, v65
  v_lshlrev_b32 v64, 16, v26
  v_and_b32 v65, 0xffff0000, v26
  v_mul_f32 v64, v64, v32
  v_mul_f32 v65, v65, v32
  v_cvt_pk_bf16_f32 v26, v64, v65
  v_lshlrev_b32 v64, 16, v26
  v_and_b32 v65, 0xffff0000, v26
  v_cvt_pk_bf16_f32 v26, v66, v67
  v_lshlrev_b32 v66, 16, v26
  v_and_b32 v67, 0xffff0000, v26
  v_mul_f32 v66, v66, v32
  v_mul_f32 v67, v67, v32
  v_cvt_pk_bf16_f32 v26, v66, v67
  v_lshlrev_b32 v66, 16, v26
  v_and_b32 v67, 0xffff0000, v26
  v_cvt_pk_bf16_f32 v26, v68, v69
  v_lshlrev_b32 v68, 16, v26
  v_and_b32 v69, 0xffff0000, v26
  v_mul_f32 v68, v68, v32
  v_mul_f32 v69, v69, v32
  v_cvt_pk_bf16_f32 v26, v68, v69
  v_lshlrev_b32 v68, 16, v26
  v_and_b32 v69, 0xffff0000, v26
  v_cvt_pk_bf16_f32 v26, v70, v71
  v_lshlrev_b32 v70, 16, v26
  v_and_b32 v71, 0xffff0000, v26
  v_mul_f32 v70, v70, v32
  v_mul_f32 v71, v71, v32
  v_cvt_pk_bf16_f32 v26, v70, v71
  v_lshlrev_b32 v70, 16, v26
  v_and_b32 v71, 0xffff0000, v26
  v_cvt_pk_bf16_f32 v26, v72, v73
  v_lshlrev_b32 v72, 16, v26
  v_and_b32 v73, 0xffff0000, v26
  v_mul_f32 v72, v72, v32
  v_mul_f32 v73, v73, v32
  v_cvt_pk_bf16_f32 v26, v72, v73
  v_lshlrev_b32 v72, 16, v26
  v_and_b32 v73, 0xffff0000, v26
  v_cvt_pk_bf16_f32 v26, v74, v75
  v_lshlrev_b32 v74, 16, v26
  v_and_b32 v75, 0xffff0000, v26
  v_mul_f32 v74, v74, v32
  v_mul_f32 v75, v75, v32
  v_cvt_pk_bf16_f32 v26, v74, v75
  v_lshlrev_b32 v74, 16, v26
  v_and_b32 v75, 0xffff0000, v26
  v_cvt_pk_bf16_f32 v26, v76, v77
  v_lshlrev_b32 v76, 16, v26
  v_and_b32 v77, 0xffff0000, v26
  v_mul_f32 v76, v76, v32
  v_mul_f32 v77, v77, v32
  v_cvt_pk_bf16_f32 v26, v76, v77
  v_lshlrev_b32 v76, 16, v26
  v_and_b32 v77, 0xffff0000, v26
  v_cvt_pk_bf16_f32 v26, v78, v79
  v_lshlrev_b32 v78, 16, v26
  v_and_b32 v79, 0xffff0000, v26
  v_mul_f32 v78, v78, v32
  v_mul_f32 v79, v79, v32
  v_cvt_pk_bf16_f32 v26, v78, v79
  v_lshlrev_b32 v78, 16, v26
  v_and_b32 v79, 0xffff0000, v26
  v_cvt_pk_bf16_f32 v26, v80, v81
  v_lshlrev_b32 v80, 16, v26
  v_and_b32 v81, 0xffff0000, v26
  v_mul_f32 v80, v80, v32
  v_mul_f32 v81, v81, v32
  v_cvt_pk_bf16_f32 v26, v80, v81
  v_lshlrev_b32 v80, 16, v26
  v_and_b32 v81, 0xffff0000, v26
  v_cvt_pk_bf16_f32 v26, v82, v83
  v_lshlrev_b32 v82, 16, v26
  v_and_b32 v83, 0xffff0000, v26
  v_mul_f32 v82, v82, v32
  v_mul_f32 v83, v83, v32
  v_cvt_pk_bf16_f32 v26, v82, v83
  v_lshlrev_b32 v82, 16, v26
  v_and_b32 v83, 0xffff0000, v26
  v_cvt_pk_bf16_f32 v26, v84, v85
  v_lshlrev_b32 v84, 16, v26
  v_and_b32 v85, 0xffff0000, v26
  v_mul_f32 v84, v84, v32
  v_mul_f32 v85, v85, v32
  v_cvt_pk_bf16_f32 v26, v84, v85
  v_lshlrev_b32 v84, 16, v26
  v_and_b32 v85, 0xffff0000, v26
  v_cvt_pk_bf16_f32 v26, v86, v87
  v_lshlrev_b32 v86, 16, v26
  v_and_b32 v87, 0xffff0000, v26
  v_mul_f32 v86, v86, v32
  v_mul_f32 v87, v87, v32
  v_cvt_pk_bf16_f32 v26, v86, v87
  v_lshlrev_b32 v86, 16, v26
  v_and_b32 v87, 0xffff0000, v26
  v_cvt_pk_bf16_f32 v26, v88, v89
  v_lshlrev_b32 v88, 16, v26
  v_and_b32 v89, 0xffff0000, v26
  v_mul_f32 v88, v88, v32
  v_mul_f32 v89, v89, v32
  v_cvt_pk_bf16_f32 v26, v88, v89
  v_lshlrev_b32 v88, 16, v26
  v_and_b32 v89, 0xffff0000, v26
  v_cvt_pk_bf16_f32 v26, v90, v91
  v_lshlrev_b32 v90, 16, v26
  v_and_b32 v91, 0xffff0000, v26
  v_mul_f32 v90, v90, v32
  v_mul_f32 v91, v91, v32
  v_cvt_pk_bf16_f32 v26, v90, v91
  v_lshlrev_b32 v90, 16, v26
  v_and_b32 v91, 0xffff0000, v26
  v_cvt_pk_bf16_f32 v26, v92, v93
  v_lshlrev_b32 v92, 16, v26
  v_and_b32 v93, 0xffff0000, v26
  v_mul_f32 v92, v92, v32
  v_mul_f32 v93, v93, v32
  v_cvt_pk_bf16_f32 v26, v92, v93
  v_lshlrev_b32 v92, 16, v26
  v_and_b32 v93, 0xffff0000, v26
  v_cvt_pk_bf16_f32 v26, v94, v95
  v_lshlrev_b32 v94, 16, v26
  v_and_b32 v95, 0xffff0000, v26
  v_mul_f32 v94, v94, v32
  v_mul_f32 v95, v95, v32
  v_cvt_pk_bf16_f32 v26, v94, v95
  v_lshlrev_b32 v94, 16, v26
  v_and_b32 v95, 0xffff0000, v26
  v_cvt_pk_bf16_f32 v26, v96, v97
  v_lshlrev_b32 v96, 16, v26
  v_and_b32 v97, 0xffff0000, v26
  v_mul_f32 v96, v96, v32
  v_mul_f32 v97, v97, v32
  v_cvt_pk_bf16_f32 v26, v96, v97
  v_lshlrev_b32 v96, 16, v26
  v_and_b32 v97, 0xffff0000, v26
  v_cvt_pk_bf16_f32 v26, v98, v99
  v_lshlrev_b32 v98, 16, v26
  v_and_b32 v99, 0xffff0000, v26
  v_mul_f32 v98, v98, v32
  v_mul_f32 v99, v99, v32
  v_cvt_pk_bf16_f32 v26, v98, v99
  v_lshlrev_b32 v98, 16, v26
  v_and_b32 v99, 0xffff0000, v26
  v_cvt_pk_bf16_f32 v26, v100, v101
  v_lshlrev_b32 v100, 16, v26
  v_and_b32 v101, 0xffff0000, v26
  v_mul_f32 v100, v100, v32
  v_mul_f32 v101, v101, v32
  v_cvt_pk_bf16_f32 v26, v100, v101
  v_lshlrev_b32 v100, 16, v26
  v_and_b32 v101, 0xffff0000, v26
  v_cvt_pk_bf16_f32 v26, v102, v103
  v_lshlrev_b32 v102, 16, v26
  v_and_b32 v103, 0xffff0000, v26
  v_mul_f32 v102, v102, v32
  v_mul_f32 v103, v103, v32
  v_cvt_pk_bf16_f32 v26, v102, v103
  v_lshlrev_b32 v102, 16, v26
  v_and_b32 v103, 0xffff0000, v26
  v_cvt_pk_bf16_f32 v26, v104, v105
  v_lshlrev_b32 v104, 16, v26
  v_and_b32 v105, 0xffff0000, v26
  v_mul_f32 v104, v104, v33
  v_mul_f32 v105, v105, v33
  v_cvt_pk_bf16_f32 v26, v104, v105
  v_lshlrev_b32 v104, 16, v26
  v_and_b32 v105, 0xffff0000, v26
  v_cvt_pk_bf16_f32 v26, v106, v107
  v_lshlrev_b32 v106, 16, v26
  v_and_b32 v107, 0xffff0000, v26
  v_mul_f32 v106, v106, v33
  v_mul_f32 v107, v107, v33
  v_cvt_pk_bf16_f32 v26, v106, v107
  v_lshlrev_b32 v106, 16, v26
  v_and_b32 v107, 0xffff0000, v26
  v_cvt_pk_bf16_f32 v26, v108, v109
  v_lshlrev_b32 v108, 16, v26
  v_and_b32 v109, 0xffff0000, v26
  v_mul_f32 v108, v108, v33
  v_mul_f32 v109, v109, v33
  v_cvt_pk_bf16_f32 v26, v108, v109
  v_lshlrev_b32 v108, 16, v26
  v_and_b32 v109, 0xffff0000, v26
  v_cvt_pk_bf16_f32 v26, v110, v111
  v_lshlrev_b32 v110, 16, v26
  v_and_b32 v111, 0xffff0000, v26
  v_mul_f32 v110, v110, v33
  v_mul_f32 v111, v111, v33
  v_cvt_pk_bf16_f32 v26, v110, v111
  v_lshlrev_b32 v110, 16, v26
  v_and_b32 v111, 0xffff0000, v26
  v_cvt_pk_bf16_f32 v26, v112, v113
  v_lshlrev_b32 v112, 16, v26
  v_and_b32 v113, 0xffff0000, v26
  v_mul_f32 v112, v112, v33
  v_mul_f32 v113, v113, v33
  v_cvt_pk_bf16_f32 v26, v112, v113
  v_lshlrev_b32 v112, 16, v26
  v_and_b32 v113, 0xffff0000, v26
  v_cvt_pk_bf16_f32 v26, v114, v115
  v_lshlrev_b32 v114, 16, v26
  v_and_b32 v115, 0xffff0000, v26
  v_mul_f32 v114, v114, v33
  v_mul_f32 v115, v115, v33
  v_cvt_pk_bf16_f32 v26, v114, v115
  v_lshlrev_b32 v114, 16, v26
  v_and_b32 v115, 0xffff0000, v26
  v_cvt_pk_bf16_f32 v26, v116, v117
  v_lshlrev_b32 v116, 16, v26
  v_and_b32 v117, 0xffff0000, v26
  v_mul_f32 v116, v116, v33
  v_mul_f32 v117, v117, v33
  v_cvt_pk_bf16_f32 v26, v116, v117
  v_lshlrev_b32 v116, 16, v26
  v_and_b32 v117, 0xffff0000, v26
  v_cvt_pk_bf16_f32 v26, v118, v119
  v_lshlrev_b32 v118, 16, v26
  v_and_b32 v119, 0xffff0000, v26
  v_mul_f32 v118, v118, v33
  v_mul_f32 v119, v119, v33
  v_cvt_pk_bf16_f32 v26, v118, v119
  v_lshlrev_b32 v118, 16, v26
  v_and_b32 v119, 0xffff0000, v26
  v_cvt_pk_bf16_f32 v26, v120, v121
  v_lshlrev_b32 v120, 16, v26
  v_and_b32 v121, 0xffff0000, v26
  v_mul_f32 v120, v120, v33
  v_mul_f32 v121, v121, v33
  v_cvt_pk_bf16_f32 v26, v120, v121
  v_lshlrev_b32 v120, 16, v26
  v_and_b32 v121, 0xffff0000, v26
  v_cvt_pk_bf16_f32 v26, v122, v123
  v_lshlrev_b32 v122, 16, v26
  v_and_b32 v123, 0xffff0000, v26
  v_mul_f32 v122, v122, v33
  v_mul_f32 v123, v123, v33
  v_cvt_pk_bf16_f32 v26, v122, v123
  v_lshlrev_b32 v122, 16, v26
  v_and_b32 v123, 0xffff0000, v26
  v_cvt_pk_bf16_f32 v26, v124, v125
  v_lshlrev_b32 v124, 16, v26
  v_and_b32 v125, 0xffff0000, v26
  v_mul_f32 v124, v124, v33
  v_mul_f32 v125, v125, v33
  v_cvt_pk_bf16_f32 v26, v124, v125
  v_lshlrev_b32 v124, 16, v26
  v_and_b32 v125, 0xffff0000, v26
  v_cvt_pk_bf16_f32 v26, v126, v127
  v_lshlrev_b32 v126, 16, v26
  v_and_b32 v127, 0xffff0000, v26
  v_mul_f32 v126, v126, v33
  v_mul_f32 v127, v127, v33
  v_cvt_pk_bf16_f32 v26, v126, v127
  v_lshlrev_b32 v126, 16, v26
  v_and_b32 v127, 0xffff0000, v26
  v_cvt_pk_bf16_f32 v26, v128, v129
  v_lshlrev_b32 v128, 16, v26
  v_and_b32 v129, 0xffff0000, v26
  v_mul_f32 v128, v128, v33
  v_mul_f32 v129, v129, v33
  v_cvt_pk_bf16_f32 v26, v128, v129
  v_lshlrev_b32 v128, 16, v26
  v_and_b32 v129, 0xffff0000, v26
  v_cvt_pk_bf16_f32 v26, v130, v131
  v_lshlrev_b32 v130, 16, v26
  v_and_b32 v131, 0xffff0000, v26
  v_mul_f32 v130, v130, v33
  v_mul_f32 v131, v131, v33
  v_cvt_pk_bf16_f32 v26, v130, v131
  v_lshlrev_b32 v130, 16, v26
  v_and_b32 v131, 0xffff0000, v26
  v_cvt_pk_bf16_f32 v26, v132, v133
  v_lshlrev_b32 v132, 16, v26
  v_and_b32 v133, 0xffff0000, v26
  v_mul_f32 v132, v132, v33
  v_mul_f32 v133, v133, v33
  v_cvt_pk_bf16_f32 v26, v132, v133
  v_lshlrev_b32 v132, 16, v26
  v_and_b32 v133, 0xffff0000, v26
  v_cvt_pk_bf16_f32 v26, v134, v135
  v_lshlrev_b32 v134, 16, v26
  v_and_b32 v135, 0xffff0000, v26
  v_mul_f32 v134, v134, v33
  v_mul_f32 v135, v135, v33
  v_cvt_pk_bf16_f32 v26, v134, v135
  v_lshlrev_b32 v134, 16, v26
  v_and_b32 v135, 0xffff0000, v26
  v_cvt_pk_bf16_f32 v26, v136, v137
  v_lshlrev_b32 v136, 16, v26
  v_and_b32 v137, 0xffff0000, v26
  v_mul_f32 v136, v136, v33
  v_mul_f32 v137, v137, v33
  v_cvt_pk_bf16_f32 v26, v136, v137
  v_lshlrev_b32 v136, 16, v26
  v_and_b32 v137, 0xffff0000, v26
  v_cvt_pk_bf16_f32 v26, v138, v139
  v_lshlrev_b32 v138, 16, v26
  v_and_b32 v139, 0xffff0000, v26
  v_mul_f32 v138, v138, v33
  v_mul_f32 v139, v139, v33
  v_cvt_pk_bf16_f32 v26, v138, v139
  v_lshlrev_b32 v138, 16, v26
  v_and_b32 v139, 0xffff0000, v26
  v_cvt_pk_bf16_f32 v26, v140, v141
  v_lshlrev_b32 v140, 16, v26
  v_and_b32 v141, 0xffff0000, v26
  v_mul_f32 v140, v140, v33
  v_mul_f32 v141, v141, v33
  v_cvt_pk_bf16_f32 v26, v140, v141
  v_lshlrev_b32 v140, 16, v26
  v_and_b32 v141, 0xffff0000, v26
  v_cvt_pk_bf16_f32 v26, v142, v143
  v_lshlrev_b32 v142, 16, v26
  v_and_b32 v143, 0xffff0000, v26
  v_mul_f32 v142, v142, v33
  v_mul_f32 v143, v143, v33
  v_cvt_pk_bf16_f32 v26, v142, v143
  v_lshlrev_b32 v142, 16, v26
  v_and_b32 v143, 0xffff0000, v26
  s_waitcnt vmcnt(19)
  v_cvt_pk_bf16_f32 v26, v144, v145
  v_lshlrev_b32 v144, 16, v26
  v_and_b32 v145, 0xffff0000, v26
  v_mul_f32 v144, v144, v30
  v_mul_f32 v145, v145, v30
  v_cvt_pk_bf16_f32 v26, v144, v145
  v_lshlrev_b32 v144, 16, v26
  v_and_b32 v145, 0xffff0000, v26
  v_add_f32 v144, v144, v64
  v_add_f32 v145, v145, v65
  v_cvt_pk_bf16_f32 v64, v144, v145
  v_cvt_pk_bf16_f32 v26, v146, v147
  v_lshlrev_b32 v146, 16, v26
  v_and_b32 v147, 0xffff0000, v26
  v_mul_f32 v146, v146, v30
  v_mul_f32 v147, v147, v30
  v_cvt_pk_bf16_f32 v26, v146, v147
  v_lshlrev_b32 v146, 16, v26
  v_and_b32 v147, 0xffff0000, v26
  v_add_f32 v146, v146, v66
  v_add_f32 v147, v147, v67
  v_cvt_pk_bf16_f32 v65, v146, v147
  buffer_store_dwordx2 v[64:65], v9, s[8:11], s22 offen offset:0
  s_waitcnt vmcnt(19)
  v_cvt_pk_bf16_f32 v26, v148, v149
  v_lshlrev_b32 v148, 16, v26
  v_and_b32 v149, 0xffff0000, v26
  v_mul_f32 v148, v148, v30
  v_mul_f32 v149, v149, v30
  v_cvt_pk_bf16_f32 v26, v148, v149
  v_lshlrev_b32 v148, 16, v26
  v_and_b32 v149, 0xffff0000, v26
  v_add_f32 v148, v148, v68
  v_add_f32 v149, v149, v69
  v_cvt_pk_bf16_f32 v68, v148, v149
  v_cvt_pk_bf16_f32 v26, v150, v151
  v_lshlrev_b32 v150, 16, v26
  v_and_b32 v151, 0xffff0000, v26
  v_mul_f32 v150, v150, v30
  v_mul_f32 v151, v151, v30
  v_cvt_pk_bf16_f32 v26, v150, v151
  v_lshlrev_b32 v150, 16, v26
  v_and_b32 v151, 0xffff0000, v26
  v_add_f32 v150, v150, v70
  v_add_f32 v151, v151, v71
  v_cvt_pk_bf16_f32 v69, v150, v151
  buffer_store_dwordx2 v[68:69], v9, s[8:11], s22 offen offset:32
  s_waitcnt vmcnt(19)
  v_cvt_pk_bf16_f32 v26, v152, v153
  v_lshlrev_b32 v152, 16, v26
  v_and_b32 v153, 0xffff0000, v26
  v_mul_f32 v152, v152, v30
  v_mul_f32 v153, v153, v30
  v_cvt_pk_bf16_f32 v26, v152, v153
  v_lshlrev_b32 v152, 16, v26
  v_and_b32 v153, 0xffff0000, v26
  v_add_f32 v152, v152, v72
  v_add_f32 v153, v153, v73
  v_cvt_pk_bf16_f32 v72, v152, v153
  v_cvt_pk_bf16_f32 v26, v154, v155
  v_lshlrev_b32 v154, 16, v26
  v_and_b32 v155, 0xffff0000, v26
  v_mul_f32 v154, v154, v30
  v_mul_f32 v155, v155, v30
  v_cvt_pk_bf16_f32 v26, v154, v155
  v_lshlrev_b32 v154, 16, v26
  v_and_b32 v155, 0xffff0000, v26
  v_add_f32 v154, v154, v74
  v_add_f32 v155, v155, v75
  v_cvt_pk_bf16_f32 v73, v154, v155
  buffer_store_dwordx2 v[72:73], v9, s[8:11], s22 offen offset:64
  s_waitcnt vmcnt(19)
  v_cvt_pk_bf16_f32 v26, v156, v157
  v_lshlrev_b32 v156, 16, v26
  v_and_b32 v157, 0xffff0000, v26
  v_mul_f32 v156, v156, v30
  v_mul_f32 v157, v157, v30
  v_cvt_pk_bf16_f32 v26, v156, v157
  v_lshlrev_b32 v156, 16, v26
  v_and_b32 v157, 0xffff0000, v26
  v_add_f32 v156, v156, v76
  v_add_f32 v157, v157, v77
  v_cvt_pk_bf16_f32 v76, v156, v157
  v_cvt_pk_bf16_f32 v26, v158, v159
  v_lshlrev_b32 v158, 16, v26
  v_and_b32 v159, 0xffff0000, v26
  v_mul_f32 v158, v158, v30
  v_mul_f32 v159, v159, v30
  v_cvt_pk_bf16_f32 v26, v158, v159
  v_lshlrev_b32 v158, 16, v26
  v_and_b32 v159, 0xffff0000, v26
  v_add_f32 v158, v158, v78
  v_add_f32 v159, v159, v79
  v_cvt_pk_bf16_f32 v77, v158, v159
  buffer_store_dwordx2 v[76:77], v9, s[8:11], s22 offen offset:96
  s_waitcnt vmcnt(19)
  v_cvt_pk_bf16_f32 v26, v160, v161
  v_lshlrev_b32 v160, 16, v26
  v_and_b32 v161, 0xffff0000, v26
  v_mul_f32 v160, v160, v30
  v_mul_f32 v161, v161, v30
  v_cvt_pk_bf16_f32 v26, v160, v161
  v_lshlrev_b32 v160, 16, v26
  v_and_b32 v161, 0xffff0000, v26
  v_add_f32 v160, v160, v80
  v_add_f32 v161, v161, v81
  v_cvt_pk_bf16_f32 v80, v160, v161
  v_cvt_pk_bf16_f32 v26, v162, v163
  v_lshlrev_b32 v162, 16, v26
  v_and_b32 v163, 0xffff0000, v26
  v_mul_f32 v162, v162, v30
  v_mul_f32 v163, v163, v30
  v_cvt_pk_bf16_f32 v26, v162, v163
  v_lshlrev_b32 v162, 16, v26
  v_and_b32 v163, 0xffff0000, v26
  v_add_f32 v162, v162, v82
  v_add_f32 v163, v163, v83
  v_cvt_pk_bf16_f32 v81, v162, v163
  buffer_store_dwordx2 v[80:81], v9, s[8:11], s22 offen offset:128
  s_waitcnt vmcnt(19)
  v_cvt_pk_bf16_f32 v26, v164, v165
  v_lshlrev_b32 v164, 16, v26
  v_and_b32 v165, 0xffff0000, v26
  v_mul_f32 v164, v164, v30
  v_mul_f32 v165, v165, v30
  v_cvt_pk_bf16_f32 v26, v164, v165
  v_lshlrev_b32 v164, 16, v26
  v_and_b32 v165, 0xffff0000, v26
  v_add_f32 v164, v164, v84
  v_add_f32 v165, v165, v85
  v_cvt_pk_bf16_f32 v84, v164, v165
  v_cvt_pk_bf16_f32 v26, v166, v167
  v_lshlrev_b32 v166, 16, v26
  v_and_b32 v167, 0xffff0000, v26
  v_mul_f32 v166, v166, v30
  v_mul_f32 v167, v167, v30
  v_cvt_pk_bf16_f32 v26, v166, v167
  v_lshlrev_b32 v166, 16, v26
  v_and_b32 v167, 0xffff0000, v26
  v_add_f32 v166, v166, v86
  v_add_f32 v167, v167, v87
  v_cvt_pk_bf16_f32 v85, v166, v167
  buffer_store_dwordx2 v[84:85], v9, s[8:11], s22 offen offset:160
  s_waitcnt vmcnt(19)
  v_cvt_pk_bf16_f32 v26, v168, v169
  v_lshlrev_b32 v168, 16, v26
  v_and_b32 v169, 0xffff0000, v26
  v_mul_f32 v168, v168, v30
  v_mul_f32 v169, v169, v30
  v_cvt_pk_bf16_f32 v26, v168, v169
  v_lshlrev_b32 v168, 16, v26
  v_and_b32 v169, 0xffff0000, v26
  v_add_f32 v168, v168, v88
  v_add_f32 v169, v169, v89
  v_cvt_pk_bf16_f32 v88, v168, v169
  v_cvt_pk_bf16_f32 v26, v170, v171
  v_lshlrev_b32 v170, 16, v26
  v_and_b32 v171, 0xffff0000, v26
  v_mul_f32 v170, v170, v30
  v_mul_f32 v171, v171, v30
  v_cvt_pk_bf16_f32 v26, v170, v171
  v_lshlrev_b32 v170, 16, v26
  v_and_b32 v171, 0xffff0000, v26
  v_add_f32 v170, v170, v90
  v_add_f32 v171, v171, v91
  v_cvt_pk_bf16_f32 v89, v170, v171
  buffer_store_dwordx2 v[88:89], v9, s[8:11], s22 offen offset:192
  s_waitcnt vmcnt(19)
  v_cvt_pk_bf16_f32 v26, v172, v173
  v_lshlrev_b32 v172, 16, v26
  v_and_b32 v173, 0xffff0000, v26
  v_mul_f32 v172, v172, v30
  v_mul_f32 v173, v173, v30
  v_cvt_pk_bf16_f32 v26, v172, v173
  v_lshlrev_b32 v172, 16, v26
  v_and_b32 v173, 0xffff0000, v26
  v_add_f32 v172, v172, v92
  v_add_f32 v173, v173, v93
  v_cvt_pk_bf16_f32 v92, v172, v173
  v_cvt_pk_bf16_f32 v26, v174, v175
  v_lshlrev_b32 v174, 16, v26
  v_and_b32 v175, 0xffff0000, v26
  v_mul_f32 v174, v174, v30
  v_mul_f32 v175, v175, v30
  v_cvt_pk_bf16_f32 v26, v174, v175
  v_lshlrev_b32 v174, 16, v26
  v_and_b32 v175, 0xffff0000, v26
  v_add_f32 v174, v174, v94
  v_add_f32 v175, v175, v95
  v_cvt_pk_bf16_f32 v93, v174, v175
  buffer_store_dwordx2 v[92:93], v9, s[8:11], s22 offen offset:224
  s_waitcnt vmcnt(19)
  v_cvt_pk_bf16_f32 v26, v176, v177
  v_lshlrev_b32 v176, 16, v26
  v_and_b32 v177, 0xffff0000, v26
  v_mul_f32 v176, v176, v30
  v_mul_f32 v177, v177, v30
  v_cvt_pk_bf16_f32 v26, v176, v177
  v_lshlrev_b32 v176, 16, v26
  v_and_b32 v177, 0xffff0000, v26
  v_add_f32 v176, v176, v96
  v_add_f32 v177, v177, v97
  v_cvt_pk_bf16_f32 v96, v176, v177
  v_cvt_pk_bf16_f32 v26, v178, v179
  v_lshlrev_b32 v178, 16, v26
  v_and_b32 v179, 0xffff0000, v26
  v_mul_f32 v178, v178, v30
  v_mul_f32 v179, v179, v30
  v_cvt_pk_bf16_f32 v26, v178, v179
  v_lshlrev_b32 v178, 16, v26
  v_and_b32 v179, 0xffff0000, v26
  v_add_f32 v178, v178, v98
  v_add_f32 v179, v179, v99
  v_cvt_pk_bf16_f32 v97, v178, v179
  buffer_store_dwordx2 v[96:97], v9, s[8:11], s22 offen offset:256
  s_waitcnt vmcnt(19)
  v_cvt_pk_bf16_f32 v26, v180, v181
  v_lshlrev_b32 v180, 16, v26
  v_and_b32 v181, 0xffff0000, v26
  v_mul_f32 v180, v180, v30
  v_mul_f32 v181, v181, v30
  v_cvt_pk_bf16_f32 v26, v180, v181
  v_lshlrev_b32 v180, 16, v26
  v_and_b32 v181, 0xffff0000, v26
  v_add_f32 v180, v180, v100
  v_add_f32 v181, v181, v101
  v_cvt_pk_bf16_f32 v100, v180, v181
  v_cvt_pk_bf16_f32 v26, v182, v183
  v_lshlrev_b32 v182, 16, v26
  v_and_b32 v183, 0xffff0000, v26
  v_mul_f32 v182, v182, v30
  v_mul_f32 v183, v183, v30
  v_cvt_pk_bf16_f32 v26, v182, v183
  v_lshlrev_b32 v182, 16, v26
  v_and_b32 v183, 0xffff0000, v26
  v_add_f32 v182, v182, v102
  v_add_f32 v183, v183, v103
  v_cvt_pk_bf16_f32 v101, v182, v183
  buffer_store_dwordx2 v[100:101], v9, s[8:11], s22 offen offset:288
  s_waitcnt vmcnt(19)
  v_cvt_pk_bf16_f32 v26, v184, v185
  v_lshlrev_b32 v184, 16, v26
  v_and_b32 v185, 0xffff0000, v26
  v_mul_f32 v184, v184, v31
  v_mul_f32 v185, v185, v31
  v_cvt_pk_bf16_f32 v26, v184, v185
  v_lshlrev_b32 v184, 16, v26
  v_and_b32 v185, 0xffff0000, v26
  v_add_f32 v184, v184, v104
  v_add_f32 v185, v185, v105
  v_cvt_pk_bf16_f32 v104, v184, v185
  v_cvt_pk_bf16_f32 v26, v186, v187
  v_lshlrev_b32 v186, 16, v26
  v_and_b32 v187, 0xffff0000, v26
  v_mul_f32 v186, v186, v31
  v_mul_f32 v187, v187, v31
  v_cvt_pk_bf16_f32 v26, v186, v187
  v_lshlrev_b32 v186, 16, v26
  v_and_b32 v187, 0xffff0000, v26
  v_add_f32 v186, v186, v106
  v_add_f32 v187, v187, v107
  v_cvt_pk_bf16_f32 v105, v186, v187
  buffer_store_dwordx2 v[104:105], v9, s[8:11], s23 offen offset:0
  s_waitcnt vmcnt(19)
  v_cvt_pk_bf16_f32 v26, v188, v189
  v_lshlrev_b32 v188, 16, v26
  v_and_b32 v189, 0xffff0000, v26
  v_mul_f32 v188, v188, v31
  v_mul_f32 v189, v189, v31
  v_cvt_pk_bf16_f32 v26, v188, v189
  v_lshlrev_b32 v188, 16, v26
  v_and_b32 v189, 0xffff0000, v26
  v_add_f32 v188, v188, v108
  v_add_f32 v189, v189, v109
  v_cvt_pk_bf16_f32 v108, v188, v189
  v_cvt_pk_bf16_f32 v26, v190, v191
  v_lshlrev_b32 v190, 16, v26
  v_and_b32 v191, 0xffff0000, v26
  v_mul_f32 v190, v190, v31
  v_mul_f32 v191, v191, v31
  v_cvt_pk_bf16_f32 v26, v190, v191
  v_lshlrev_b32 v190, 16, v26
  v_and_b32 v191, 0xffff0000, v26
  v_add_f32 v190, v190, v110
  v_add_f32 v191, v191, v111
  v_cvt_pk_bf16_f32 v109, v190, v191
  buffer_store_dwordx2 v[108:109], v9, s[8:11], s23 offen offset:32
  s_waitcnt vmcnt(19)
  v_cvt_pk_bf16_f32 v26, v192, v193
  v_lshlrev_b32 v192, 16, v26
  v_and_b32 v193, 0xffff0000, v26
  v_mul_f32 v192, v192, v31
  v_mul_f32 v193, v193, v31
  v_cvt_pk_bf16_f32 v26, v192, v193
  v_lshlrev_b32 v192, 16, v26
  v_and_b32 v193, 0xffff0000, v26
  v_add_f32 v192, v192, v112
  v_add_f32 v193, v193, v113
  v_cvt_pk_bf16_f32 v112, v192, v193
  v_cvt_pk_bf16_f32 v26, v194, v195
  v_lshlrev_b32 v194, 16, v26
  v_and_b32 v195, 0xffff0000, v26
  v_mul_f32 v194, v194, v31
  v_mul_f32 v195, v195, v31
  v_cvt_pk_bf16_f32 v26, v194, v195
  v_lshlrev_b32 v194, 16, v26
  v_and_b32 v195, 0xffff0000, v26
  v_add_f32 v194, v194, v114
  v_add_f32 v195, v195, v115
  v_cvt_pk_bf16_f32 v113, v194, v195
  buffer_store_dwordx2 v[112:113], v9, s[8:11], s23 offen offset:64
  s_waitcnt vmcnt(19)
  v_cvt_pk_bf16_f32 v26, v196, v197
  v_lshlrev_b32 v196, 16, v26
  v_and_b32 v197, 0xffff0000, v26
  v_mul_f32 v196, v196, v31
  v_mul_f32 v197, v197, v31
  v_cvt_pk_bf16_f32 v26, v196, v197
  v_lshlrev_b32 v196, 16, v26
  v_and_b32 v197, 0xffff0000, v26
  v_add_f32 v196, v196, v116
  v_add_f32 v197, v197, v117
  v_cvt_pk_bf16_f32 v116, v196, v197
  v_cvt_pk_bf16_f32 v26, v198, v199
  v_lshlrev_b32 v198, 16, v26
  v_and_b32 v199, 0xffff0000, v26
  v_mul_f32 v198, v198, v31
  v_mul_f32 v199, v199, v31
  v_cvt_pk_bf16_f32 v26, v198, v199
  v_lshlrev_b32 v198, 16, v26
  v_and_b32 v199, 0xffff0000, v26
  v_add_f32 v198, v198, v118
  v_add_f32 v199, v199, v119
  v_cvt_pk_bf16_f32 v117, v198, v199
  buffer_store_dwordx2 v[116:117], v9, s[8:11], s23 offen offset:96
  s_waitcnt vmcnt(19)
  v_cvt_pk_bf16_f32 v26, v200, v201
  v_lshlrev_b32 v200, 16, v26
  v_and_b32 v201, 0xffff0000, v26
  v_mul_f32 v200, v200, v31
  v_mul_f32 v201, v201, v31
  v_cvt_pk_bf16_f32 v26, v200, v201
  v_lshlrev_b32 v200, 16, v26
  v_and_b32 v201, 0xffff0000, v26
  v_add_f32 v200, v200, v120
  v_add_f32 v201, v201, v121
  v_cvt_pk_bf16_f32 v120, v200, v201
  v_cvt_pk_bf16_f32 v26, v202, v203
  v_lshlrev_b32 v202, 16, v26
  v_and_b32 v203, 0xffff0000, v26
  v_mul_f32 v202, v202, v31
  v_mul_f32 v203, v203, v31
  v_cvt_pk_bf16_f32 v26, v202, v203
  v_lshlrev_b32 v202, 16, v26
  v_and_b32 v203, 0xffff0000, v26
  v_add_f32 v202, v202, v122
  v_add_f32 v203, v203, v123
  v_cvt_pk_bf16_f32 v121, v202, v203
  buffer_store_dwordx2 v[120:121], v9, s[8:11], s23 offen offset:128
  s_waitcnt vmcnt(19)
  v_cvt_pk_bf16_f32 v26, v204, v205
  v_lshlrev_b32 v204, 16, v26
  v_and_b32 v205, 0xffff0000, v26
  v_mul_f32 v204, v204, v31
  v_mul_f32 v205, v205, v31
  v_cvt_pk_bf16_f32 v26, v204, v205
  v_lshlrev_b32 v204, 16, v26
  v_and_b32 v205, 0xffff0000, v26
  v_add_f32 v204, v204, v124
  v_add_f32 v205, v205, v125
  v_cvt_pk_bf16_f32 v124, v204, v205
  v_cvt_pk_bf16_f32 v26, v206, v207
  v_lshlrev_b32 v206, 16, v26
  v_and_b32 v207, 0xffff0000, v26
  v_mul_f32 v206, v206, v31
  v_mul_f32 v207, v207, v31
  v_cvt_pk_bf16_f32 v26, v206, v207
  v_lshlrev_b32 v206, 16, v26
  v_and_b32 v207, 0xffff0000, v26
  v_add_f32 v206, v206, v126
  v_add_f32 v207, v207, v127
  v_cvt_pk_bf16_f32 v125, v206, v207
  buffer_store_dwordx2 v[124:125], v9, s[8:11], s23 offen offset:160
  s_waitcnt vmcnt(19)
  v_cvt_pk_bf16_f32 v26, v208, v209
  v_lshlrev_b32 v208, 16, v26
  v_and_b32 v209, 0xffff0000, v26
  v_mul_f32 v208, v208, v31
  v_mul_f32 v209, v209, v31
  v_cvt_pk_bf16_f32 v26, v208, v209
  v_lshlrev_b32 v208, 16, v26
  v_and_b32 v209, 0xffff0000, v26
  v_add_f32 v208, v208, v128
  v_add_f32 v209, v209, v129
  v_cvt_pk_bf16_f32 v128, v208, v209
  v_cvt_pk_bf16_f32 v26, v210, v211
  v_lshlrev_b32 v210, 16, v26
  v_and_b32 v211, 0xffff0000, v26
  v_mul_f32 v210, v210, v31
  v_mul_f32 v211, v211, v31
  v_cvt_pk_bf16_f32 v26, v210, v211
  v_lshlrev_b32 v210, 16, v26
  v_and_b32 v211, 0xffff0000, v26
  v_add_f32 v210, v210, v130
  v_add_f32 v211, v211, v131
  v_cvt_pk_bf16_f32 v129, v210, v211
  buffer_store_dwordx2 v[128:129], v9, s[8:11], s23 offen offset:192
  s_waitcnt vmcnt(19)
  v_cvt_pk_bf16_f32 v26, v212, v213
  v_lshlrev_b32 v212, 16, v26
  v_and_b32 v213, 0xffff0000, v26
  v_mul_f32 v212, v212, v31
  v_mul_f32 v213, v213, v31
  v_cvt_pk_bf16_f32 v26, v212, v213
  v_lshlrev_b32 v212, 16, v26
  v_and_b32 v213, 0xffff0000, v26
  v_add_f32 v212, v212, v132
  v_add_f32 v213, v213, v133
  v_cvt_pk_bf16_f32 v132, v212, v213
  v_cvt_pk_bf16_f32 v26, v214, v215
  v_lshlrev_b32 v214, 16, v26
  v_and_b32 v215, 0xffff0000, v26
  v_mul_f32 v214, v214, v31
  v_mul_f32 v215, v215, v31
  v_cvt_pk_bf16_f32 v26, v214, v215
  v_lshlrev_b32 v214, 16, v26
  v_and_b32 v215, 0xffff0000, v26
  v_add_f32 v214, v214, v134
  v_add_f32 v215, v215, v135
  v_cvt_pk_bf16_f32 v133, v214, v215
  buffer_store_dwordx2 v[132:133], v9, s[8:11], s23 offen offset:224
  s_waitcnt vmcnt(19)
  v_cvt_pk_bf16_f32 v26, v216, v217
  v_lshlrev_b32 v216, 16, v26
  v_and_b32 v217, 0xffff0000, v26
  v_mul_f32 v216, v216, v31
  v_mul_f32 v217, v217, v31
  v_cvt_pk_bf16_f32 v26, v216, v217
  v_lshlrev_b32 v216, 16, v26
  v_and_b32 v217, 0xffff0000, v26
  v_add_f32 v216, v216, v136
  v_add_f32 v217, v217, v137
  v_cvt_pk_bf16_f32 v136, v216, v217
  v_cvt_pk_bf16_f32 v26, v218, v219
  v_lshlrev_b32 v218, 16, v26
  v_and_b32 v219, 0xffff0000, v26
  v_mul_f32 v218, v218, v31
  v_mul_f32 v219, v219, v31
  v_cvt_pk_bf16_f32 v26, v218, v219
  v_lshlrev_b32 v218, 16, v26
  v_and_b32 v219, 0xffff0000, v26
  v_add_f32 v218, v218, v138
  v_add_f32 v219, v219, v139
  v_cvt_pk_bf16_f32 v137, v218, v219
  buffer_store_dwordx2 v[136:137], v9, s[8:11], s23 offen offset:256
  s_waitcnt vmcnt(19)
  v_cvt_pk_bf16_f32 v26, v220, v221
  v_lshlrev_b32 v220, 16, v26
  v_and_b32 v221, 0xffff0000, v26
  v_mul_f32 v220, v220, v31
  v_mul_f32 v221, v221, v31
  v_cvt_pk_bf16_f32 v26, v220, v221
  v_lshlrev_b32 v220, 16, v26
  v_and_b32 v221, 0xffff0000, v26
  v_add_f32 v220, v220, v140
  v_add_f32 v221, v221, v141
  v_cvt_pk_bf16_f32 v140, v220, v221
  v_cvt_pk_bf16_f32 v26, v222, v223
  v_lshlrev_b32 v222, 16, v26
  v_and_b32 v223, 0xffff0000, v26
  v_mul_f32 v222, v222, v31
  v_mul_f32 v223, v223, v31
  v_cvt_pk_bf16_f32 v26, v222, v223
  v_lshlrev_b32 v222, 16, v26
  v_and_b32 v223, 0xffff0000, v26
  v_add_f32 v222, v222, v142
  v_add_f32 v223, v223, v143
  v_cvt_pk_bf16_f32 v141, v222, v223
  buffer_store_dwordx2 v[140:141], v9, s[8:11], s23 offen offset:288
om_248:
  s_cmp_eq_u32 s87, -2
  s_cbranch_scc1 kv_help
  s_cmp_eq_u32 s87, -1
  s_cbranch_scc1 queue
tail_item:
  s_load_dwordx2 s[4:5], s[0:1], 96
  s_waitcnt lgkmcnt(0)
  s_mov_b32 s32, s4
  s_mov_b32 s33, s5
  s_mov_b32 s34, 256
  s_mov_b32 s35, 0x00020000
  s_waitcnt vmcnt(0)
  s_barrier
  s_mov_b32 s21, s87
do_pv:
  s_mov_b32 s2, s21
  s_load_dwordx2 s[4:5], s[0:1], 88
  s_load_dwordx2 s[38:39], s[0:1], 104
  s_waitcnt lgkmcnt(0)
  s_mov_b32 s8, s4
  s_mov_b32 s9, s5
  s_mov_b32 s10, 2621440
  s_mov_b32 s11, 0x00020000
  s_add_u32 s12, s38, 114294784
  s_addc_u32 s13, s39, 0
  s_mov_b32 s14, 83886080
  s_mov_b32 s15, 0x00020000
  s_mov_b32 s59, 0
  s_mov_b32 s60, 0
  s_add_u32 s16, s38, 85983232
  s_addc_u32 s17, s39, 0
  s_mov_b32 s18, 28311552
  s_mov_b32 s19, 0x00020000
  s_add_u32 s24, s38, 73400320
  s_addc_u32 s25, s39, 0
  s_mov_b32 s26, 5242880
  s_mov_b32 s27, 0x00020000
  s_add_u32 s28, s38, 81002496
  s_addc_u32 s29, s39, 0
  s_mov_b32 s30, 8192
  s_mov_b32 s31, 0x00020000
  s_add_u32 s72, s38, 81068032
  s_addc_u32 s73, s39, 0
  s_mov_b32 s74, 116736
  s_mov_b32 s75, 0x00020000
  v_lshlrev_b32 v4, 4, v1
  v_lshlrev_b32 v5, 3, v1
  v_lshlrev_b32 v6, 2, v2
  v_and_b32 v7, 7, v1
  v_lshlrev_b32 v7, 7, v7
  v_lshrrev_b32 v31, 3, v1
  v_lshl_add_u32 v208, v31, 10, v7
  v_bfe_u32 v31, v1, 3, 2
  v_lshl_add_u32 v31, v31, 2, v7
  s_lshl_b32 s21, s20, 10
  s_add_u32 s21, s21, 95232
  buffer_load_dword v8, v31, s[72:75], s21 offen sc1
  v_lshlrev_b32 v25, 7, v2
  s_mov_b32 s21, 93184
  buffer_load_dword v26, v25, s[72:75], s21 offen sc1
  s_mov_b32 s63, 1
  v_mul_u32_u24 v9, 1280, v2
  v_lshl_add_u32 v9, v3, 3, v9
  s_lshl_b32 s21, s20, 13
  v_add_u32 v10, s21, v4
  s_lshl_b32 s21, s20, 10
  v_add_u32 v11, s21, v4
  v_lshrrev_b32 v20, 5, v1
  v_mul_u32_u24 v21, 2560, v20
  v_add_u32 v21, v21, v4
  v_and_b32 v22, 31, v1
  v_lshlrev_b32 v22, 4, v22
  v_mul_u32_u24 v20, 10240, v20
  v_add_u32 v22, v22, v20
  v_mul_u32_u24 v21, 2560, v3
  v_lshl_add_u32 v21, v2, 4, v21
  v_mul_u32_u24 v22, 10240, v3
  v_lshl_add_u32 v22, v2, 4, v22
  v_mov_b32 v28, 80
  v_mov_b32 v30, 32768
  s_mov_b32 s50, 0
  s_mov_b32 s71, 0
  s_mov_b32 s51, 0
  s_and_b32 s43, s20, 1
  s_lshr_b32 s44, s20, 1
  v_mov_b32 v70, 0
  v_mov_b32 v71, 0
  v_mov_b32 v78, 0
  v_mov_b32 v79, 0
  v_mov_b32 v86, 0
  v_mov_b32 v87, 0
  v_mov_b32 v94, 0
  v_mov_b32 v95, 0
  v_mov_b32 v102, 0
  v_mov_b32 v103, 0
  v_mov_b32 v110, 0
  v_mov_b32 v111, 0
  v_mov_b32 v118, 0
  v_mov_b32 v119, 0
  v_mov_b32 v126, 0
  v_mov_b32 v127, 0
  s_mov_b32 s21, s2
pv_loop:
  s_mul_i32 s2, s21, 2
  s_add_u32 s22, s21, 250
  s_cmp_lt_u32 s21, 250
  s_cselect_b32 s2, s2, s22
  s_cselect_b32 s65, 1, 0
  s_mul_hi_u32 s40, s2, 0x1999999a
  s_mul_i32 s21, s40, 10
  s_sub_u32 s41, s2, s21
  s_lshl_b32 s52, s40, 10
  s_add_u32 s52, s52, 23552
  buffer_load_dword v27, v7, s[72:75], s52 offen sc1
  s_cmp_lg_u32 s20, 0
  s_cbranch_scc1 pv_262
  s_sub_u32 s21, s2, 450
  s_cmp_lt_u32 s21, 190
  s_cbranch_scc1 pv_262
  v_mov_b32 v29, 1
  s_mov_b64 exec, 1
  buffer_atomic_add v29, v28, s[32:35], 0 offen sc0 sc1
  s_mov_b64 exec, -1
pv_262:
  s_lshl_b32 s42, s40, 5
  s_lshl_b32 s21, s20, 3
  s_add_u32 s42, s42, s21
  s_mul_i32 s61, s21, 5
  s_lshr_b32 s22, s41, 1
  s_add_u32 s61, s61, s22
  s_and_b32 s62, s41, 1
  s_lshl_b32 s62, s62, 12
  s_mul_i32 s53, s42, 40960
  s_lshl_b32 s22, s41, 12
  s_add_u32 s53, s53, s22
  s_lshl_b32 s21, s40, 1
  s_add_u32 s21, s21, s43
  s_lshl_b32 s45, s21, 6
  s_mul_i32 s46, s21, 20480
  s_mul_i32 s21, s21, 40
  s_lshl_b32 s22, s41, 2
  s_add_u32 s22, s22, s44
  s_add_u32 s21, s21, s22
  s_lshl_b32 s54, s21, 10
  s_lshl_b32 s22, s22, 5
  s_add_u32 s46, s46, s22
  s_mul_i32 s47, s42, 2560
  s_mul_i32 s48, s42, 10240
  s_lshl_b32 s22, s41, 10
  s_add_u32 s48, s48, s22
  s_add_u32 s48, s48, 7340032
  s_add_u32 s23, s40, 1
  s_cmp_ge_u32 s50, s23
  s_cbranch_scc1 pv_255
  s_cmp_eq_u32 s63, 0
  s_cbranch_scc1 pv_258
  s_mov_b32 s63, 0
  s_waitcnt vmcnt(1)
  v_cmp_le_u32 vcc, 4, v26
  s_mov_b32 s51, vcc_lo
  v_cmp_gt_u32 vcc, s23, v8
  s_nop 1
  s_cbranch_vccz pv_259
pv_258:
  s_lshl_b32 s21, s20, 10
  s_add_u32 s21, s21, 95232
  s_mov_b32 s101, 0
wm_263:
  buffer_load_dword v8, v31, s[72:75], s21 offen sc1
  s_add_u32 s101, s101, 1
  s_cmp_gt_u32 s101, 131072
  s_cbranch_scc1 main_end
  s_waitcnt vmcnt(0)
  v_cmp_gt_u32 vcc, s23, v8
  v_readfirstlane_b32 s100, v8
  s_nop 0
  s_cbranch_vccz wm_264
  s_sleep 8
  s_add_u32 s100, s100, 2
  s_cmp_ge_u32 s100, s23
  s_cbranch_scc1 wm_263
  s_sleep 60
  s_branch wm_263
wm_264:
pv_259:
  v_readlane_b32 s50, v8, 0
  v_readlane_b32 s21, v8, 1
  s_min_u32 s50, s50, s21
  v_readlane_b32 s21, v8, 2
  s_min_u32 s50, s50, s21
  v_readlane_b32 s21, v8, 3
  s_min_u32 s50, s50, s21
  v_readlane_b32 s21, v8, 4
  s_min_u32 s50, s50, s21
  v_readlane_b32 s21, v8, 5
  s_min_u32 s50, s50, s21
  v_readlane_b32 s21, v8, 6
  s_min_u32 s50, s50, s21
  v_readlane_b32 s21, v8, 7
  s_min_u32 s50, s50, s21
  v_readlane_b32 s21, v8, 8
  s_min_u32 s50, s50, s21
  v_readlane_b32 s21, v8, 9
  s_min_u32 s50, s50, s21
  v_readlane_b32 s21, v8, 10
  s_min_u32 s50, s50, s21
  v_readlane_b32 s21, v8, 11
  s_min_u32 s50, s50, s21
  v_readlane_b32 s21, v8, 12
  s_min_u32 s50, s50, s21
  v_readlane_b32 s21, v8, 13
  s_min_u32 s50, s50, s21
  v_readlane_b32 s21, v8, 14
  s_min_u32 s50, s50, s21
  v_readlane_b32 s21, v8, 15
  s_min_u32 s50, s50, s21
  v_readlane_b32 s21, v8, 16
  s_min_u32 s50, s50, s21
  v_readlane_b32 s21, v8, 17
  s_min_u32 s50, s50, s21
  v_readlane_b32 s21, v8, 18
  s_min_u32 s50, s50, s21
  v_readlane_b32 s21, v8, 19
  s_min_u32 s50, s50, s21
  v_readlane_b32 s21, v8, 20
  s_min_u32 s50, s50, s21
  v_readlane_b32 s21, v8, 21
  s_min_u32 s50, s50, s21
  v_readlane_b32 s21, v8, 22
  s_min_u32 s50, s50, s21
  v_readlane_b32 s21, v8, 23
  s_min_u32 s50, s50, s21
  v_readlane_b32 s21, v8, 24
  s_min_u32 s50, s50, s21
  v_readlane_b32 s21, v8, 25
  s_min_u32 s50, s50, s21
  v_readlane_b32 s21, v8, 26
  s_min_u32 s50, s50, s21
  v_readlane_b32 s21, v8, 27
  s_min_u32 s50, s50, s21
  v_readlane_b32 s21, v8, 28
  s_min_u32 s50, s50, s21
  v_readlane_b32 s21, v8, 29
  s_min_u32 s50, s50, s21
  v_readlane_b32 s21, v8, 30
  s_min_u32 s50, s50, s21
  v_readlane_b32 s21, v8, 31
  s_min_u32 s50, s50, s21
pv_255:
  s_lshr_b32 s22, s40, 2
  s_cmp_lt_u32 s40, 32
  s_cbranch_scc1 pv_256
  s_bitcmp1_b32 s51, s22
  s_cbranch_scc1 pv_256
  s_mov_b32 s21, 93184
  v_lshlrev_b32 v25, 7, v2
  s_mov_b32 s101, 0
pv_257:
  buffer_load_dword v26, v25, s[72:75], s21 offen sc1
  s_add_u32 s101, s101, 1
  s_cmp_gt_u32 s101, 131072
  s_cbranch_scc1 main_end
  s_waitcnt vmcnt(0)
  v_cmp_le_u32 vcc, 4, v26
  s_mov_b32 s51, vcc_lo
  s_bitcmp1_b32 s51, s22
  s_cbranch_scc1 pv_256
  s_sleep 8
  s_branch pv_257
pv_256:
  buffer_load_dwordx4 a[0:3], v4, s[12:15], s53 offen offset:0 sc1
  buffer_load_dwordx4 a[4:7], v4, s[12:15], s53 offen offset:1024 sc1
  buffer_load_dwordx4 a[8:11], v4, s[12:15], s53 offen offset:2048 sc1
  buffer_load_dwordx4 a[12:15], v4, s[12:15], s53 offen offset:3072 sc1
  s_add_u32 s53, s53, 40960
  buffer_load_dwordx4 a[16:19], v4, s[12:15], s53 offen offset:0 sc1
  buffer_load_dwordx4 a[20:23], v4, s[12:15], s53 offen offset:1024 sc1
  buffer_load_dwordx4 a[24:27], v4, s[12:15], s53 offen offset:2048 sc1
  buffer_load_dwordx4 a[28:31], v4, s[12:15], s53 offen offset:3072 sc1
  s_add_u32 s53, s53, 40960
  buffer_load_dwordx4 a[32:35], v4, s[12:15], s53 offen offset:0 sc1
  buffer_load_dwordx4 a[36:39], v4, s[12:15], s53 offen offset:1024 sc1
  buffer_load_dwordx4 a[40:43], v4, s[12:15], s53 offen offset:2048 sc1
  buffer_load_dwordx4 a[44:47], v4, s[12:15], s53 offen offset:3072 sc1
  s_add_u32 s53, s53, 40960
  buffer_load_dwordx4 a[48:51], v4, s[12:15], s53 offen offset:0 sc1
  buffer_load_dwordx4 a[52:55], v4, s[12:15], s53 offen offset:1024 sc1
  buffer_load_dwordx4 a[56:59], v4, s[12:15], s53 offen offset:2048 sc1
  buffer_load_dwordx4 a[60:63], v4, s[12:15], s53 offen offset:3072 sc1
  s_add_u32 s53, s53, 40960
  buffer_load_dwordx4 a[64:67], v4, s[12:15], s53 offen offset:0 sc1
  buffer_load_dwordx4 a[68:71], v4, s[12:15], s53 offen offset:1024 sc1
  buffer_load_dwordx4 a[72:75], v4, s[12:15], s53 offen offset:2048 sc1
  buffer_load_dwordx4 a[76:79], v4, s[12:15], s53 offen offset:3072 sc1
  s_add_u32 s53, s53, 40960
  buffer_load_dwordx4 a[80:83], v4, s[12:15], s53 offen offset:0 sc1
  buffer_load_dwordx4 a[84:87], v4, s[12:15], s53 offen offset:1024 sc1
  buffer_load_dwordx4 a[88:91], v4, s[12:15], s53 offen offset:2048 sc1
  buffer_load_dwordx4 a[92:95], v4, s[12:15], s53 offen offset:3072 sc1
  s_add_u32 s53, s53, 40960
  buffer_load_dwordx4 a[96:99], v4, s[12:15], s53 offen offset:0 sc1
  buffer_load_dwordx4 a[100:103], v4, s[12:15], s53 offen offset:1024 sc1
  buffer_load_dwordx4 a[104:107], v4, s[12:15], s53 offen offset:2048 sc1
  buffer_load_dwordx4 a[108:111], v4, s[12:15], s53 offen offset:3072 sc1
  s_add_u32 s53, s53, 40960
  buffer_load_dwordx4 a[112:115], v4, s[12:15], s53 offen offset:0 sc1
  buffer_load_dwordx4 a[116:119], v4, s[12:15], s53 offen offset:1024 sc1
  buffer_load_dwordx4 a[120:123], v4, s[12:15], s53 offen offset:2048 sc1
  buffer_load_dwordx4 a[124:127], v4, s[12:15], s53 offen offset:3072 sc1
  s_cmp_lt_u32 s40, 32
  s_cselect_b32 s70, 0x80000000, s54
  buffer_load_dwordx4 v[12:15], v4, s[24:27], s70 offen sc1
  buffer_load_dwordx4 v[16:19], v4, s[24:27], s70 offen offset:2048 sc1
  buffer_load_dword v24, v6, s[28:31], s45 offen sc1
  s_waitcnt vmcnt(35)
  s_cmp_eq_u32 s71, 0
  s_cbranch_scc1 paf_267
  v_mov_b32 v25, 0
  v_mov_b32 v26, 1
  s_mov_b64 exec, 1
  buffer_atomic_add v26, v25, s[72:75], s71 offen sc1
  s_mov_b64 exec, -1
  s_mov_b32 s71, 0
paf_267:
  v_cmp_le_u32 s[68:69], 4, v27
  s_nop 1
  s_and_b32 s21, s68, 255
  s_cmp_lg_u32 s21, 255
  s_cbranch_scc1 pvw_260
  s_mov_b32 s56, s47
  s_mov_b32 s57, s48
  buffer_load_dwordx4 v[64:67], v4, s[16:19], s56 offen sc1
  buffer_load_dwordx2 v[68:69], v5, s[16:19], s56 offen offset:2048 sc1
  buffer_load_dwordx4 v[128:131], v21, s[16:19], s56 offen offset:1024 sc1
  buffer_load_dwordx4 v[132:135], v21, s[16:19], s56 offen offset:1280 sc1
  s_add_u32 s56, s56, 2560
  buffer_load_dwordx4 v[72:75], v4, s[16:19], s56 offen sc1
  buffer_load_dwordx2 v[76:77], v5, s[16:19], s56 offen offset:2048 sc1
  s_add_u32 s56, s56, 2560
  buffer_load_dwordx4 v[80:83], v4, s[16:19], s56 offen sc1
  buffer_load_dwordx2 v[84:85], v5, s[16:19], s56 offen offset:2048 sc1
  s_add_u32 s56, s56, 2560
  buffer_load_dwordx4 v[88:91], v4, s[16:19], s56 offen sc1
  buffer_load_dwordx2 v[92:93], v5, s[16:19], s56 offen offset:2048 sc1
  s_add_u32 s56, s56, 2560
  buffer_load_dwordx4 v[32:35], v22, s[16:19], s57 offen offset:0 sc1
  buffer_load_dwordx4 v[36:39], v22, s[16:19], s57 offen offset:256 sc1
  buffer_load_dwordx4 v[40:43], v22, s[16:19], s57 offen offset:512 sc1
  buffer_load_dwordx4 v[44:47], v22, s[16:19], s57 offen offset:768 sc1
  s_add_u32 s57, s57, 40960
  buffer_load_dwordx4 v[96:99], v4, s[16:19], s56 offen sc1
  buffer_load_dwordx2 v[100:101], v5, s[16:19], s56 offen offset:2048 sc1
  buffer_load_dwordx4 v[136:139], v21, s[16:19], s56 offen offset:1024 sc1
  buffer_load_dwordx4 v[140:143], v21, s[16:19], s56 offen offset:1280 sc1
  s_add_u32 s56, s56, 2560
  buffer_load_dwordx4 v[104:107], v4, s[16:19], s56 offen sc1
  buffer_load_dwordx2 v[108:109], v5, s[16:19], s56 offen offset:2048 sc1
  s_add_u32 s56, s56, 2560
  buffer_load_dwordx4 v[112:115], v4, s[16:19], s56 offen sc1
  buffer_load_dwordx2 v[116:117], v5, s[16:19], s56 offen offset:2048 sc1
  s_add_u32 s56, s56, 2560
  buffer_load_dwordx4 v[120:123], v4, s[16:19], s56 offen sc1
  buffer_load_dwordx2 v[124:125], v5, s[16:19], s56 offen offset:2048 sc1
  s_add_u32 s56, s56, 2560
  buffer_load_dwordx4 v[48:51], v22, s[16:19], s57 offen offset:0 sc1
  buffer_load_dwordx4 v[52:55], v22, s[16:19], s57 offen offset:256 sc1
  buffer_load_dwordx4 v[56:59], v22, s[16:19], s57 offen offset:512 sc1
  buffer_load_dwordx4 v[60:63], v22, s[16:19], s57 offen offset:768 sc1
  s_add_u32 s57, s57, 40960
  s_barrier
  s_waitcnt vmcnt(28)
  v_sub_f32 v25, 1.0, v24
  v_cvt_pk_bf16_f32 v26, v25, v25
  v_lshlrev_b32 v25, 16, v26
  v_cvt_pk_bf16_f32 v26, v12, v12
  v_lshlrev_b32 v12, 16, v26
  v_cvt_pk_bf16_f32 v26, v13, v13
  v_lshlrev_b32 v13, 16, v26
  v_cvt_pk_bf16_f32 v26, v14, v14
  v_lshlrev_b32 v14, 16, v26
  v_cvt_pk_bf16_f32 v26, v15, v15
  v_lshlrev_b32 v15, 16, v26
  v_cvt_pk_bf16_f32 v26, v16, v16
  v_lshlrev_b32 v16, 16, v26
  v_cvt_pk_bf16_f32 v26, v17, v17
  v_lshlrev_b32 v17, 16, v26
  v_cvt_pk_bf16_f32 v26, v18, v18
  v_lshlrev_b32 v18, 16, v26
  v_cvt_pk_bf16_f32 v26, v19, v19
  v_lshlrev_b32 v19, 16, v26
  v_mul_f32 v12, v12, v25
  v_cvt_pk_bf16_f32 v26, v12, v12
  v_lshlrev_b32 v12, 16, v26
  v_mul_f32 v13, v13, v25
  v_cvt_pk_bf16_f32 v26, v13, v13
  v_lshlrev_b32 v13, 16, v26
  v_mul_f32 v14, v14, v25
  v_cvt_pk_bf16_f32 v26, v14, v14
  v_lshlrev_b32 v14, 16, v26
  v_mul_f32 v15, v15, v25
  v_cvt_pk_bf16_f32 v26, v15, v15
  v_lshlrev_b32 v15, 16, v26
  v_mul_f32 v16, v16, v25
  v_cvt_pk_bf16_f32 v26, v16, v16
  v_lshlrev_b32 v16, 16, v26
  v_mul_f32 v17, v17, v25
  v_cvt_pk_bf16_f32 v26, v17, v17
  v_lshlrev_b32 v17, 16, v26
  v_mul_f32 v18, v18, v25
  v_cvt_pk_bf16_f32 v26, v18, v18
  v_lshlrev_b32 v18, 16, v26
  v_mul_f32 v19, v19, v25
  v_cvt_pk_bf16_f32 v26, v19, v19
  v_lshlrev_b32 v19, 16, v26
  s_cmp_ge_u32 s40, 56
  s_cbranch_scc1 pvc_266
  s_branch pvg_265
pvw_260:
  s_waitcnt vmcnt(0)
  v_sub_f32 v25, 1.0, v24
  v_cvt_pk_bf16_f32 v26, v25, v25
  v_lshlrev_b32 v25, 16, v26
  v_cvt_pk_bf16_f32 v26, v12, v12
  v_lshlrev_b32 v12, 16, v26
  v_cvt_pk_bf16_f32 v26, v13, v13
  v_lshlrev_b32 v13, 16, v26
  v_cvt_pk_bf16_f32 v26, v14, v14
  v_lshlrev_b32 v14, 16, v26
  v_cvt_pk_bf16_f32 v26, v15, v15
  v_lshlrev_b32 v15, 16, v26
  v_cvt_pk_bf16_f32 v26, v16, v16
  v_lshlrev_b32 v16, 16, v26
  v_cvt_pk_bf16_f32 v26, v17, v17
  v_lshlrev_b32 v17, 16, v26
  v_cvt_pk_bf16_f32 v26, v18, v18
  v_lshlrev_b32 v18, 16, v26
  v_cvt_pk_bf16_f32 v26, v19, v19
  v_lshlrev_b32 v19, 16, v26
  v_mul_f32 v12, v12, v25
  v_cvt_pk_bf16_f32 v26, v12, v12
  v_lshlrev_b32 v12, 16, v26
  v_mul_f32 v13, v13, v25
  v_cvt_pk_bf16_f32 v26, v13, v13
  v_lshlrev_b32 v13, 16, v26
  v_mul_f32 v14, v14, v25
  v_cvt_pk_bf16_f32 v26, v14, v14
  v_lshlrev_b32 v14, 16, v26
  v_mul_f32 v15, v15, v25
  v_cvt_pk_bf16_f32 v26, v15, v15
  v_lshlrev_b32 v15, 16, v26
  v_mul_f32 v16, v16, v25
  v_cvt_pk_bf16_f32 v26, v16, v16
  v_lshlrev_b32 v16, 16, v26
  v_mul_f32 v17, v17, v25
  v_cvt_pk_bf16_f32 v26, v17, v17
  v_lshlrev_b32 v17, 16, v26
  v_mul_f32 v18, v18, v25
  v_cvt_pk_bf16_f32 v26, v18, v18
  v_lshlrev_b32 v18, 16, v26
  v_mul_f32 v19, v19, v25
  v_cvt_pk_bf16_f32 v26, v19, v19
  v_lshlrev_b32 v19, 16, v26
  s_cmp_ge_u32 s40, 56
  s_cbranch_scc1 pvt_268
  s_cmp_lg_u32 s20, 0
  s_cbranch_scc1 wm_270
  s_mov_b32 s101, 0
wm_269:
  buffer_load_dword v26, v7, s[72:75], s52 offen sc1
  s_add_u32 s101, s101, 1
  s_cmp_gt_u32 s101, 131072
  s_cbranch_scc1 main_end
  s_waitcnt vmcnt(0)
  v_cmp_gt_u32 vcc, 4, v26
  v_readfirstlane_b32 s100, v26
  s_nop 0
  s_cbranch_vccz wm_270
  s_sleep 2
  s_add_u32 s100, s100, 3
  s_cmp_ge_u32 s100, 4
  s_cbranch_scc1 wm_269
  s_sleep 24
  s_branch wm_269
wm_270:
  s_barrier
  buffer_load_dwordx4 v[64:67], v4, s[16:19], s47 offen sc1
  buffer_load_dwordx2 v[68:69], v5, s[16:19], s47 offen offset:2048 sc1
  buffer_load_dwordx4 v[128:131], v21, s[16:19], s47 offen offset:1024 sc1
  buffer_load_dwordx4 v[132:135], v21, s[16:19], s47 offen offset:1280 sc1
  s_add_u32 s47, s47, 2560
  buffer_load_dwordx4 v[72:75], v4, s[16:19], s47 offen sc1
  buffer_load_dwordx2 v[76:77], v5, s[16:19], s47 offen offset:2048 sc1
  s_add_u32 s47, s47, 2560
  buffer_load_dwordx4 v[80:83], v4, s[16:19], s47 offen sc1
  buffer_load_dwordx2 v[84:85], v5, s[16:19], s47 offen offset:2048 sc1
  s_add_u32 s47, s47, 2560
  buffer_load_dwordx4 v[88:91], v4, s[16:19], s47 offen sc1
  buffer_load_dwordx2 v[92:93], v5, s[16:19], s47 offen offset:2048 sc1
  s_add_u32 s47, s47, 2560
  buffer_load_dwordx4 v[32:35], v22, s[16:19], s48 offen offset:0 sc1
  buffer_load_dwordx4 v[36:39], v22, s[16:19], s48 offen offset:256 sc1
  buffer_load_dwordx4 v[40:43], v22, s[16:19], s48 offen offset:512 sc1
  buffer_load_dwordx4 v[44:47], v22, s[16:19], s48 offen offset:768 sc1
  s_add_u32 s48, s48, 40960
  buffer_load_dwordx4 v[96:99], v4, s[16:19], s47 offen sc1
  buffer_load_dwordx2 v[100:101], v5, s[16:19], s47 offen offset:2048 sc1
  buffer_load_dwordx4 v[136:139], v21, s[16:19], s47 offen offset:1024 sc1
  buffer_load_dwordx4 v[140:143], v21, s[16:19], s47 offen offset:1280 sc1
  s_add_u32 s47, s47, 2560
  buffer_load_dwordx4 v[104:107], v4, s[16:19], s47 offen sc1
  buffer_load_dwordx2 v[108:109], v5, s[16:19], s47 offen offset:2048 sc1
  s_add_u32 s47, s47, 2560
  buffer_load_dwordx4 v[112:115], v4, s[16:19], s47 offen sc1
  buffer_load_dwordx2 v[116:117], v5, s[16:19], s47 offen offset:2048 sc1
  s_add_u32 s47, s47, 2560
  buffer_load_dwordx4 v[120:123], v4, s[16:19], s47 offen sc1
  buffer_load_dwordx2 v[124:125], v5, s[16:19], s47 offen offset:2048 sc1
  s_add_u32 s47, s47, 2560
  buffer_load_dwordx4 v[48:51], v22, s[16:19], s48 offen offset:0 sc1
  buffer_load_dwordx4 v[52:55], v22, s[16:19], s48 offen offset:256 sc1
  buffer_load_dwordx4 v[56:59], v22, s[16:19], s48 offen offset:512 sc1
  buffer_load_dwordx4 v[60:63], v22, s[16:19], s48 offen offset:768 sc1
  s_add_u32 s48, s48, 40960
pvg_265:
  s_waitcnt vmcnt(26)
  v_mfma_f32_16x16x32_bf16 v[148:151], a[0:3], v[64:67], 0
  v_mfma_f32_16x16x32_bf16 v[144:147], a[0:3], v[68:71], 0
  v_mfma_f32_16x16x32_bf16 v[156:159], a[4:7], v[64:67], 0
  v_mfma_f32_16x16x32_bf16 v[152:155], a[4:7], v[68:71], 0
  v_mfma_f32_16x16x32_bf16 v[164:167], a[8:11], v[64:67], 0
  v_mfma_f32_16x16x32_bf16 v[160:163], a[8:11], v[68:71], 0
  v_mfma_f32_16x16x32_bf16 v[172:175], a[12:15], v[64:67], 0
  v_mfma_f32_16x16x32_bf16 v[168:171], a[12:15], v[68:71], 0
  s_waitcnt vmcnt(22)
  v_mfma_f32_16x16x32_bf16 v[148:151], a[16:19], v[72:75], v[148:151]
  v_mfma_f32_16x16x32_bf16 v[144:147], a[16:19], v[76:79], v[144:147]
  v_mfma_f32_16x16x32_bf16 v[156:159], a[20:23], v[72:75], v[156:159]
  v_mfma_f32_16x16x32_bf16 v[152:155], a[20:23], v[76:79], v[152:155]
  v_mfma_f32_16x16x32_bf16 v[164:167], a[24:27], v[72:75], v[164:167]
  v_mfma_f32_16x16x32_bf16 v[160:163], a[24:27], v[76:79], v[160:163]
  v_mfma_f32_16x16x32_bf16 v[172:175], a[28:31], v[72:75], v[172:175]
  v_mfma_f32_16x16x32_bf16 v[168:171], a[28:31], v[76:79], v[168:171]
  s_waitcnt vmcnt(20)
  v_mfma_f32_16x16x32_bf16 v[148:151], a[32:35], v[80:83], v[148:151]
  v_mfma_f32_16x16x32_bf16 v[144:147], a[32:35], v[84:87], v[144:147]
  v_mfma_f32_16x16x32_bf16 v[156:159], a[36:39], v[80:83], v[156:159]
  v_mfma_f32_16x16x32_bf16 v[152:155], a[36:39], v[84:87], v[152:155]
  v_mfma_f32_16x16x32_bf16 v[164:167], a[40:43], v[80:83], v[164:167]
  v_mfma_f32_16x16x32_bf16 v[160:163], a[40:43], v[84:87], v[160:163]
  v_mfma_f32_16x16x32_bf16 v[172:175], a[44:47], v[80:83], v[172:175]
  v_mfma_f32_16x16x32_bf16 v[168:171], a[44:47], v[84:87], v[168:171]
  s_waitcnt vmcnt(18)
  v_mfma_f32_16x16x32_bf16 v[148:151], a[48:51], v[88:91], v[148:151]
  v_mfma_f32_16x16x32_bf16 v[144:147], a[48:51], v[92:95], v[144:147]
  v_mfma_f32_16x16x32_bf16 v[156:159], a[52:55], v[88:91], v[156:159]
  v_mfma_f32_16x16x32_bf16 v[152:155], a[52:55], v[92:95], v[152:155]
  v_mfma_f32_16x16x32_bf16 v[164:167], a[56:59], v[88:91], v[164:167]
  v_mfma_f32_16x16x32_bf16 v[160:163], a[56:59], v[92:95], v[160:163]
  v_mfma_f32_16x16x32_bf16 v[172:175], a[60:63], v[88:91], v[172:175]
  v_mfma_f32_16x16x32_bf16 v[168:171], a[60:63], v[92:95], v[168:171]
  s_waitcnt vmcnt(14)
  s_nop 1
  v_mfma_f32_16x16x32_bf16 v[144:147], v[32:35], v[128:131], v[144:147]
  v_mfma_f32_16x16x32_bf16 v[148:151], v[32:35], v[132:135], v[148:151]
  v_mfma_f32_16x16x32_bf16 v[152:155], v[36:39], v[128:131], v[152:155]
  v_mfma_f32_16x16x32_bf16 v[156:159], v[36:39], v[132:135], v[156:159]
  v_mfma_f32_16x16x32_bf16 v[160:163], v[40:43], v[128:131], v[160:163]
  v_mfma_f32_16x16x32_bf16 v[164:167], v[40:43], v[132:135], v[164:167]
  v_mfma_f32_16x16x32_bf16 v[168:171], v[44:47], v[128:131], v[168:171]
  v_mfma_f32_16x16x32_bf16 v[172:175], v[44:47], v[132:135], v[172:175]
  s_waitcnt vmcnt(12)
  v_mfma_f32_16x16x32_bf16 v[148:151], a[64:67], v[96:99], v[148:151]
  v_mfma_f32_16x16x32_bf16 v[144:147], a[64:67], v[100:103], v[144:147]
  v_mfma_f32_16x16x32_bf16 v[156:159], a[68:71], v[96:99], v[156:159]
  v_mfma_f32_16x16x32_bf16 v[152:155], a[68:71], v[100:103], v[152:155]
  v_mfma_f32_16x16x32_bf16 v[164:167], a[72:75], v[96:99], v[164:167]
  v_mfma_f32_16x16x32_bf16 v[160:163], a[72:75], v[100:103], v[160:163]
  v_mfma_f32_16x16x32_bf16 v[172:175], a[76:79], v[96:99], v[172:175]
  v_mfma_f32_16x16x32_bf16 v[168:171], a[76:79], v[100:103], v[168:171]
  s_waitcnt vmcnt(8)
  v_mfma_f32_16x16x32_bf16 v[148:151], a[80:83], v[104:107], v[148:151]
  v_mfma_f32_16x16x32_bf16 v[144:147], a[80:83], v[108:111], v[144:147]
  v_mfma_f32_16x16x32_bf16 v[156:159], a[84:87], v[104:107], v[156:159]
  v_mfma_f32_16x16x32_bf16 v[152:155], a[84:87], v[108:111], v[152:155]
  v_mfma_f32_16x16x32_bf16 v[164:167], a[88:91], v[104:107], v[164:167]
  v_mfma_f32_16x16x32_bf16 v[160:163], a[88:91], v[108:111], v[160:163]
  v_mfma_f32_16x16x32_bf16 v[172:175], a[92:95], v[104:107], v[172:175]
  v_mfma_f32_16x16x32_bf16 v[168:171], a[92:95], v[108:111], v[168:171]
  s_waitcnt vmcnt(6)
  v_mfma_f32_16x16x32_bf16 v[148:151], a[96:99], v[112:115], v[148:151]
  v_mfma_f32_16x16x32_bf16 v[144:147], a[96:99], v[116:119], v[144:147]
  v_mfma_f32_16x16x32_bf16 v[156:159], a[100:103], v[112:115], v[156:159]
  v_mfma_f32_16x16x32_bf16 v[152:155], a[100:103], v[116:119], v[152:155]
  v_mfma_f32_16x16x32_bf16 v[164:167], a[104:107], v[112:115], v[164:167]
  v_mfma_f32_16x16x32_bf16 v[160:163], a[104:107], v[116:119], v[160:163]
  v_mfma_f32_16x16x32_bf16 v[172:175], a[108:111], v[112:115], v[172:175]
  v_mfma_f32_16x16x32_bf16 v[168:171], a[108:111], v[116:119], v[168:171]
  s_waitcnt vmcnt(4)
  v_mfma_f32_16x16x32_bf16 v[148:151], a[112:115], v[120:123], v[148:151]
  v_mfma_f32_16x16x32_bf16 v[144:147], a[112:115], v[124:127], v[144:147]
  v_mfma_f32_16x16x32_bf16 v[156:159], a[116:119], v[120:123], v[156:159]
  v_mfma_f32_16x16x32_bf16 v[152:155], a[116:119], v[124:127], v[152:155]
  v_mfma_f32_16x16x32_bf16 v[164:167], a[120:123], v[120:123], v[164:167]
  v_mfma_f32_16x16x32_bf16 v[160:163], a[120:123], v[124:127], v[160:163]
  v_mfma_f32_16x16x32_bf16 v[172:175], a[124:127], v[120:123], v[172:175]
  v_mfma_f32_16x16x32_bf16 v[168:171], a[124:127], v[124:127], v[168:171]
  s_waitcnt vmcnt(0)
  s_nop 1
  v_mfma_f32_16x16x32_bf16 v[144:147], v[48:51], v[136:139], v[144:147]
  v_mfma_f32_16x16x32_bf16 v[148:151], v[48:51], v[140:143], v[148:151]
  v_mfma_f32_16x16x32_bf16 v[152:155], v[52:55], v[136:139], v[152:155]
  v_mfma_f32_16x16x32_bf16 v[156:159], v[52:55], v[140:143], v[156:159]
  v_mfma_f32_16x16x32_bf16 v[160:163], v[56:59], v[136:139], v[160:163]
  v_mfma_f32_16x16x32_bf16 v[164:167], v[56:59], v[140:143], v[164:167]
  v_mfma_f32_16x16x32_bf16 v[168:171], v[60:63], v[136:139], v[168:171]
  v_mfma_f32_16x16x32_bf16 v[172:175], v[60:63], v[140:143], v[172:175]
  s_branch pve_261
pvt_268:
  s_sub_u32 s55, s52, 1024
  s_cmp_lg_u32 s20, 0
  s_cbranch_scc1 wm_272
  s_mov_b32 s101, 0
wm_271:
  buffer_load_dword v26, v7, s[72:75], s55 offen sc1
  s_add_u32 s101, s101, 1
  s_cmp_gt_u32 s101, 131072
  s_cbranch_scc1 main_end
  s_waitcnt vmcnt(0)
  v_cmp_gt_u32 vcc, 4, v26
  v_readfirstlane_b32 s100, v26
  s_nop 0
  s_cbranch_vccz wm_272
  s_sleep 4
  s_add_u32 s100, s100, 3
  s_cmp_ge_u32 s100, 4
  s_cbranch_scc1 wm_271
  s_sleep 24
  s_branch wm_271
wm_272:
  s_barrier
  s_mov_b32 s56, s47
  s_mov_b32 s57, s48
  buffer_load_dwordx4 v[64:67], v4, s[16:19], s56 offen sc1
  buffer_load_dwordx2 v[68:69], v5, s[16:19], s56 offen offset:2048 sc1
  buffer_load_dwordx4 v[128:131], v21, s[16:19], s56 offen offset:1024 sc1
  buffer_load_dwordx4 v[132:135], v21, s[16:19], s56 offen offset:1280 sc1
  s_add_u32 s56, s56, 2560
  buffer_load_dwordx4 v[72:75], v4, s[16:19], s56 offen sc1
  buffer_load_dwordx2 v[76:77], v5, s[16:19], s56 offen offset:2048 sc1
  s_add_u32 s56, s56, 2560
  buffer_load_dwordx4 v[80:83], v4, s[16:19], s56 offen sc1
  buffer_load_dwordx2 v[84:85], v5, s[16:19], s56 offen offset:2048 sc1
  s_add_u32 s56, s56, 2560
  buffer_load_dwordx4 v[88:91], v4, s[16:19], s56 offen sc1
  buffer_load_dwordx2 v[92:93], v5, s[16:19], s56 offen offset:2048 sc1
  s_add_u32 s56, s56, 2560
  buffer_load_dwordx4 v[32:35], v22, s[16:19], s57 offen offset:0 sc1
  buffer_load_dwordx4 v[36:39], v22, s[16:19], s57 offen offset:256 sc1
  buffer_load_dwordx4 v[40:43], v22, s[16:19], s57 offen offset:512 sc1
  buffer_load_dwordx4 v[44:47], v22, s[16:19], s57 offen offset:768 sc1
  s_add_u32 s57, s57, 40960
  buffer_load_dwordx4 v[96:99], v4, s[16:19], s56 offen sc1
  buffer_load_dwordx2 v[100:101], v5, s[16:19], s56 offen offset:2048 sc1
  buffer_load_dwordx4 v[136:139], v21, s[16:19], s56 offen offset:1024 sc1
  buffer_load_dwordx4 v[140:143], v21, s[16:19], s56 offen offset:1280 sc1
  s_add_u32 s56, s56, 2560
  buffer_load_dwordx4 v[104:107], v4, s[16:19], s56 offen sc1
  buffer_load_dwordx2 v[108:109], v5, s[16:19], s56 offen offset:2048 sc1
  s_add_u32 s56, s56, 2560
  buffer_load_dwordx4 v[112:115], v4, s[16:19], s56 offen sc1
  buffer_load_dwordx2 v[116:117], v5, s[16:19], s56 offen offset:2048 sc1
  s_add_u32 s56, s56, 2560
  buffer_load_dwordx4 v[120:123], v4, s[16:19], s56 offen sc1
  buffer_load_dwordx2 v[124:125], v5, s[16:19], s56 offen offset:2048 sc1
  s_add_u32 s56, s56, 2560
  buffer_load_dwordx4 v[48:51], v22, s[16:19], s57 offen offset:0 sc1
  buffer_load_dwordx4 v[52:55], v22, s[16:19], s57 offen offset:256 sc1
  buffer_load_dwordx4 v[56:59], v22, s[16:19], s57 offen offset:512 sc1
  buffer_load_dwordx4 v[60:63], v22, s[16:19], s57 offen offset:768 sc1
  s_add_u32 s57, s57, 40960
pvc_266:
  s_mov_b32 s101, 0
  s_waitcnt vmcnt(14)
  s_branch pvr_274
pvr_273:
  s_sleep 2
  s_add_u32 s56, s47, 0
  s_add_u32 s57, s48, 0
  buffer_load_dwordx4 v[64:67], v4, s[16:19], s56 offen sc1
  buffer_load_dwordx2 v[68:69], v5, s[16:19], s56 offen offset:2048 sc1
  buffer_load_dwordx4 v[128:131], v21, s[16:19], s56 offen offset:1024 sc1
  buffer_load_dwordx4 v[132:135], v21, s[16:19], s56 offen offset:1280 sc1
  s_add_u32 s56, s56, 2560
  buffer_load_dwordx4 v[72:75], v4, s[16:19], s56 offen sc1
  buffer_load_dwordx2 v[76:77], v5, s[16:19], s56 offen offset:2048 sc1
  s_add_u32 s56, s56, 2560
  buffer_load_dwordx4 v[80:83], v4, s[16:19], s56 offen sc1
  buffer_load_dwordx2 v[84:85], v5, s[16:19], s56 offen offset:2048 sc1
  s_add_u32 s56, s56, 2560
  buffer_load_dwordx4 v[88:91], v4, s[16:19], s56 offen sc1
  buffer_load_dwordx2 v[92:93], v5, s[16:19], s56 offen offset:2048 sc1
  s_add_u32 s56, s56, 2560
  buffer_load_dwordx4 v[32:35], v22, s[16:19], s57 offen offset:0 sc1
  buffer_load_dwordx4 v[36:39], v22, s[16:19], s57 offen offset:256 sc1
  buffer_load_dwordx4 v[40:43], v22, s[16:19], s57 offen offset:512 sc1
  buffer_load_dwordx4 v[44:47], v22, s[16:19], s57 offen offset:768 sc1
  s_add_u32 s57, s57, 40960
  s_add_u32 s101, s101, 1
  s_cmp_gt_u32 s101, 131072
  s_cbranch_scc1 main_end
  s_waitcnt vmcnt(0)
pvr_274:
  v_max3_u32 v26, v64, v68, v72
  v_max3_u32 v26, v26, v76, v80
  v_max3_u32 v26, v26, v84, v88
  v_max3_u32 v26, v26, v92, v128
  v_max3_u32 v26, v26, v132, v32
  v_max3_u32 v26, v26, v36, v40
  v_max3_u32 v26, v26, v44, v44
  v_cmp_eq_u32 vcc, -1, v26
  s_nop 1
  s_cbranch_vccnz pvr_273
  v_mfma_f32_16x16x32_bf16 v[148:151], a[0:3], v[64:67], 0
  v_mfma_f32_16x16x32_bf16 v[144:147], a[0:3], v[68:71], 0
  v_mfma_f32_16x16x32_bf16 v[156:159], a[4:7], v[64:67], 0
  v_mfma_f32_16x16x32_bf16 v[152:155], a[4:7], v[68:71], 0
  v_mfma_f32_16x16x32_bf16 v[164:167], a[8:11], v[64:67], 0
  v_mfma_f32_16x16x32_bf16 v[160:163], a[8:11], v[68:71], 0
  v_mfma_f32_16x16x32_bf16 v[172:175], a[12:15], v[64:67], 0
  v_mfma_f32_16x16x32_bf16 v[168:171], a[12:15], v[68:71], 0
  v_mfma_f32_16x16x32_bf16 v[148:151], a[16:19], v[72:75], v[148:151]
  v_mfma_f32_16x16x32_bf16 v[144:147], a[16:19], v[76:79], v[144:147]
  v_mfma_f32_16x16x32_bf16 v[156:159], a[20:23], v[72:75], v[156:159]
  v_mfma_f32_16x16x32_bf16 v[152:155], a[20:23], v[76:79], v[152:155]
  v_mfma_f32_16x16x32_bf16 v[164:167], a[24:27], v[72:75], v[164:167]
  v_mfma_f32_16x16x32_bf16 v[160:163], a[24:27], v[76:79], v[160:163]
  v_mfma_f32_16x16x32_bf16 v[172:175], a[28:31], v[72:75], v[172:175]
  v_mfma_f32_16x16x32_bf16 v[168:171], a[28:31], v[76:79], v[168:171]
  v_mfma_f32_16x16x32_bf16 v[148:151], a[32:35], v[80:83], v[148:151]
  v_mfma_f32_16x16x32_bf16 v[144:147], a[32:35], v[84:87], v[144:147]
  v_mfma_f32_16x16x32_bf16 v[156:159], a[36:39], v[80:83], v[156:159]
  v_mfma_f32_16x16x32_bf16 v[152:155], a[36:39], v[84:87], v[152:155]
  v_mfma_f32_16x16x32_bf16 v[164:167], a[40:43], v[80:83], v[164:167]
  v_mfma_f32_16x16x32_bf16 v[160:163], a[40:43], v[84:87], v[160:163]
  v_mfma_f32_16x16x32_bf16 v[172:175], a[44:47], v[80:83], v[172:175]
  v_mfma_f32_16x16x32_bf16 v[168:171], a[44:47], v[84:87], v[168:171]
  v_mfma_f32_16x16x32_bf16 v[148:151], a[48:51], v[88:91], v[148:151]
  v_mfma_f32_16x16x32_bf16 v[144:147], a[48:51], v[92:95], v[144:147]
  v_mfma_f32_16x16x32_bf16 v[156:159], a[52:55], v[88:91], v[156:159]
  v_mfma_f32_16x16x32_bf16 v[152:155], a[52:55], v[92:95], v[152:155]
  v_mfma_f32_16x16x32_bf16 v[164:167], a[56:59], v[88:91], v[164:167]
  v_mfma_f32_16x16x32_bf16 v[160:163], a[56:59], v[92:95], v[160:163]
  v_mfma_f32_16x16x32_bf16 v[172:175], a[60:63], v[88:91], v[172:175]
  v_mfma_f32_16x16x32_bf16 v[168:171], a[60:63], v[92:95], v[168:171]
  s_nop 1
  v_mfma_f32_16x16x32_bf16 v[144:147], v[32:35], v[128:131], v[144:147]
  v_mfma_f32_16x16x32_bf16 v[148:151], v[32:35], v[132:135], v[148:151]
  v_mfma_f32_16x16x32_bf16 v[152:155], v[36:39], v[128:131], v[152:155]
  v_mfma_f32_16x16x32_bf16 v[156:159], v[36:39], v[132:135], v[156:159]
  v_mfma_f32_16x16x32_bf16 v[160:163], v[40:43], v[128:131], v[160:163]
  v_mfma_f32_16x16x32_bf16 v[164:167], v[40:43], v[132:135], v[164:167]
  v_mfma_f32_16x16x32_bf16 v[168:171], v[44:47], v[128:131], v[168:171]
  v_mfma_f32_16x16x32_bf16 v[172:175], v[44:47], v[132:135], v[172:175]
  s_mov_b32 s101, 0
  s_waitcnt vmcnt(0)
  s_branch pvr_276
pvr_275:
  s_sleep 2
  s_add_u32 s56, s47, 10240
  s_add_u32 s57, s48, 40960
  buffer_load_dwordx4 v[96:99], v4, s[16:19], s56 offen sc1
  buffer_load_dwordx2 v[100:101], v5, s[16:19], s56 offen offset:2048 sc1
  buffer_load_dwordx4 v[136:139], v21, s[16:19], s56 offen offset:1024 sc1
  buffer_load_dwordx4 v[140:143], v21, s[16:19], s56 offen offset:1280 sc1
  s_add_u32 s56, s56, 2560
  buffer_load_dwordx4 v[104:107], v4, s[16:19], s56 offen sc1
  buffer_load_dwordx2 v[108:109], v5, s[16:19], s56 offen offset:2048 sc1
  s_add_u32 s56, s56, 2560
  buffer_load_dwordx4 v[112:115], v4, s[16:19], s56 offen sc1
  buffer_load_dwordx2 v[116:117], v5, s[16:19], s56 offen offset:2048 sc1
  s_add_u32 s56, s56, 2560
  buffer_load_dwordx4 v[120:123], v4, s[16:19], s56 offen sc1
  buffer_load_dwordx2 v[124:125], v5, s[16:19], s56 offen offset:2048 sc1
  s_add_u32 s56, s56, 2560
  buffer_load_dwordx4 v[48:51], v22, s[16:19], s57 offen offset:0 sc1
  buffer_load_dwordx4 v[52:55], v22, s[16:19], s57 offen offset:256 sc1
  buffer_load_dwordx4 v[56:59], v22, s[16:19], s57 offen offset:512 sc1
  buffer_load_dwordx4 v[60:63], v22, s[16:19], s57 offen offset:768 sc1
  s_add_u32 s57, s57, 40960
  s_add_u32 s101, s101, 1
  s_cmp_gt_u32 s101, 131072
  s_cbranch_scc1 main_end
  s_waitcnt vmcnt(0)
pvr_276:
  v_max3_u32 v26, v96, v100, v104
  v_max3_u32 v26, v26, v108, v112
  v_max3_u32 v26, v26, v116, v120
  v_max3_u32 v26, v26, v124, v136
  v_max3_u32 v26, v26, v140, v48
  v_max3_u32 v26, v26, v52, v56
  v_max3_u32 v26, v26, v60, v60
  v_cmp_eq_u32 vcc, -1, v26
  s_nop 1
  s_cbranch_vccnz pvr_275
  v_mfma_f32_16x16x32_bf16 v[148:151], a[64:67], v[96:99], v[148:151]
  v_mfma_f32_16x16x32_bf16 v[144:147], a[64:67], v[100:103], v[144:147]
  v_mfma_f32_16x16x32_bf16 v[156:159], a[68:71], v[96:99], v[156:159]
  v_mfma_f32_16x16x32_bf16 v[152:155], a[68:71], v[100:103], v[152:155]
  v_mfma_f32_16x16x32_bf16 v[164:167], a[72:75], v[96:99], v[164:167]
  v_mfma_f32_16x16x32_bf16 v[160:163], a[72:75], v[100:103], v[160:163]
  v_mfma_f32_16x16x32_bf16 v[172:175], a[76:79], v[96:99], v[172:175]
  v_mfma_f32_16x16x32_bf16 v[168:171], a[76:79], v[100:103], v[168:171]
  v_mfma_f32_16x16x32_bf16 v[148:151], a[80:83], v[104:107], v[148:151]
  v_mfma_f32_16x16x32_bf16 v[144:147], a[80:83], v[108:111], v[144:147]
  v_mfma_f32_16x16x32_bf16 v[156:159], a[84:87], v[104:107], v[156:159]
  v_mfma_f32_16x16x32_bf16 v[152:155], a[84:87], v[108:111], v[152:155]
  v_mfma_f32_16x16x32_bf16 v[164:167], a[88:91], v[104:107], v[164:167]
  v_mfma_f32_16x16x32_bf16 v[160:163], a[88:91], v[108:111], v[160:163]
  v_mfma_f32_16x16x32_bf16 v[172:175], a[92:95], v[104:107], v[172:175]
  v_mfma_f32_16x16x32_bf16 v[168:171], a[92:95], v[108:111], v[168:171]
  v_mfma_f32_16x16x32_bf16 v[148:151], a[96:99], v[112:115], v[148:151]
  v_mfma_f32_16x16x32_bf16 v[144:147], a[96:99], v[116:119], v[144:147]
  v_mfma_f32_16x16x32_bf16 v[156:159], a[100:103], v[112:115], v[156:159]
  v_mfma_f32_16x16x32_bf16 v[152:155], a[100:103], v[116:119], v[152:155]
  v_mfma_f32_16x16x32_bf16 v[164:167], a[104:107], v[112:115], v[164:167]
  v_mfma_f32_16x16x32_bf16 v[160:163], a[104:107], v[116:119], v[160:163]
  v_mfma_f32_16x16x32_bf16 v[172:175], a[108:111], v[112:115], v[172:175]
  v_mfma_f32_16x16x32_bf16 v[168:171], a[108:111], v[116:119], v[168:171]
  v_mfma_f32_16x16x32_bf16 v[148:151], a[112:115], v[120:123], v[148:151]
  v_mfma_f32_16x16x32_bf16 v[144:147], a[112:115], v[124:127], v[144:147]
  v_mfma_f32_16x16x32_bf16 v[156:159], a[116:119], v[120:123], v[156:159]
  v_mfma_f32_16x16x32_bf16 v[152:155], a[116:119], v[124:127], v[152:155]
  v_mfma_f32_16x16x32_bf16 v[164:167], a[120:123], v[120:123], v[164:167]
  v_mfma_f32_16x16x32_bf16 v[160:163], a[120:123], v[124:127], v[160:163]
  v_mfma_f32_16x16x32_bf16 v[172:175], a[124:127], v[120:123], v[172:175]
  v_mfma_f32_16x16x32_bf16 v[168:171], a[124:127], v[124:127], v[168:171]
  s_nop 1
  v_mfma_f32_16x16x32_bf16 v[144:147], v[48:51], v[136:139], v[144:147]
  v_mfma_f32_16x16x32_bf16 v[148:151], v[48:51], v[140:143], v[148:151]
  v_mfma_f32_16x16x32_bf16 v[152:155], v[52:55], v[136:139], v[152:155]
  v_mfma_f32_16x16x32_bf16 v[156:159], v[52:55], v[140:143], v[156:159]
  v_mfma_f32_16x16x32_bf16 v[160:163], v[56:59], v[136:139], v[160:163]
  v_mfma_f32_16x16x32_bf16 v[164:167], v[56:59], v[140:143], v[164:167]
  v_mfma_f32_16x16x32_bf16 v[168:171], v[60:63], v[136:139], v[168:171]
  v_mfma_f32_16x16x32_bf16 v[172:175], v[60:63], v[140:143], v[172:175]
pve_261:
  s_nop 0
  s_cmp_eq_u32 s65, 0
  s_cbranch_scc1 pvx_277
  s_add_u32 s41, s41, 1
  s_mul_i32 s53, s42, 40960
  s_lshl_b32 s22, s41, 12
  s_add_u32 s53, s53, s22
  s_mul_i32 s48, s42, 10240
  s_lshl_b32 s22, s41, 10
  s_add_u32 s48, s48, s22
  s_add_u32 s48, s48, 7340032
  buffer_load_dwordx4 v[32:35], v22, s[16:19], s48 offen offset:0 sc1
  buffer_load_dwordx4 v[36:39], v22, s[16:19], s48 offen offset:256 sc1
  buffer_load_dwordx4 v[40:43], v22, s[16:19], s48 offen offset:512 sc1
  buffer_load_dwordx4 v[44:47], v22, s[16:19], s48 offen offset:768 sc1
  s_add_u32 s48, s48, 40960
  buffer_load_dwordx4 v[48:51], v22, s[16:19], s48 offen offset:0 sc1
  buffer_load_dwordx4 v[52:55], v22, s[16:19], s48 offen offset:256 sc1
  buffer_load_dwordx4 v[56:59], v22, s[16:19], s48 offen offset:512 sc1
  buffer_load_dwordx4 v[60:63], v22, s[16:19], s48 offen offset:768 sc1
  s_add_u32 s48, s48, 40960
  buffer_load_dwordx4 a[0:3], v4, s[12:15], s53 offen offset:0 sc1
  buffer_load_dwordx4 a[4:7], v4, s[12:15], s53 offen offset:1024 sc1
  buffer_load_dwordx4 a[8:11], v4, s[12:15], s53 offen offset:2048 sc1
  buffer_load_dwordx4 a[12:15], v4, s[12:15], s53 offen offset:3072 sc1
  s_add_u32 s53, s53, 40960
  buffer_load_dwordx4 a[16:19], v4, s[12:15], s53 offen offset:0 sc1
  buffer_load_dwordx4 a[20:23], v4, s[12:15], s53 offen offset:1024 sc1
  buffer_load_dwordx4 a[24:27], v4, s[12:15], s53 offen offset:2048 sc1
  buffer_load_dwordx4 a[28:31], v4, s[12:15], s53 offen offset:3072 sc1
  s_add_u32 s53, s53, 40960
  buffer_load_dwordx4 a[32:35], v4, s[12:15], s53 offen offset:0 sc1
  buffer_load_dwordx4 a[36:39], v4, s[12:15], s53 offen offset:1024 sc1
  buffer_load_dwordx4 a[40:43], v4, s[12:15], s53 offen offset:2048 sc1
  buffer_load_dwordx4 a[44:47], v4, s[12:15], s53 offen offset:3072 sc1
  s_add_u32 s53, s53, 40960
  buffer_load_dwordx4 a[48:51], v4, s[12:15], s53 offen offset:0 sc1
  buffer_load_dwordx4 a[52:55], v4, s[12:15], s53 offen offset:1024 sc1
  buffer_load_dwordx4 a[56:59], v4, s[12:15], s53 offen offset:2048 sc1
  buffer_load_dwordx4 a[60:63], v4, s[12:15], s53 offen offset:3072 sc1
  s_add_u32 s53, s53, 40960
  buffer_load_dwordx4 a[64:67], v4, s[12:15], s53 offen offset:0 sc1
  buffer_load_dwordx4 a[68:71], v4, s[12:15], s53 offen offset:1024 sc1
  buffer_load_dwordx4 a[72:75], v4, s[12:15], s53 offen offset:2048 sc1
  buffer_load_dwordx4 a[76:79], v4, s[12:15], s53 offen offset:3072 sc1
  s_add_u32 s53, s53, 40960
  buffer_load_dwordx4 a[80:83], v4, s[12:15], s53 offen offset:0 sc1
  buffer_load_dwordx4 a[84:87], v4, s[12:15], s53 offen offset:1024 sc1
  buffer_load_dwordx4 a[88:91], v4, s[12:15], s53 offen offset:2048 sc1
  buffer_load_dwordx4 a[92:95], v4, s[12:15], s53 offen offset:3072 sc1
  s_add_u32 s53, s53, 40960
  buffer_load_dwordx4 a[96:99], v4, s[12:15], s53 offen offset:0 sc1
  buffer_load_dwordx4 a[100:103], v4, s[12:15], s53 offen offset:1024 sc1
  buffer_load_dwordx4 a[104:107], v4, s[12:15], s53 offen offset:2048 sc1
  buffer_load_dwordx4 a[108:111], v4, s[12:15], s53 offen offset:3072 sc1
  s_add_u32 s53, s53, 40960
  buffer_load_dwordx4 a[112:115], v4, s[12:15], s53 offen offset:0 sc1
  buffer_load_dwordx4 a[116:119], v4, s[12:15], s53 offen offset:1024 sc1
  buffer_load_dwordx4 a[120:123], v4, s[12:15], s53 offen offset:2048 sc1
  buffer_load_dwordx4 a[124:127], v4, s[12:15], s53 offen offset:3072 sc1
pvx_277:
  s_cmp_lg_u32 s20, 0
  s_cbranch_scc1 lc_278
  s_sub_u32 s21, s2, 450
  s_cmp_ge_u32 s21, 190
  s_cbranch_scc1 lc_278
  v_mov_b32 v29, 1
  s_mov_b64 exec, 1
  buffer_atomic_add v29, v28, s[32:35], 0 offen sc0 sc1
  s_mov_b64 exec, -1
lc_278:
  ds_write_b128 v10, v[144:147] offset:0
  ds_write_b128 v10, v[148:151] offset:1024
  ds_write_b128 v10, v[152:155] offset:2048
  ds_write_b128 v10, v[156:159] offset:3072
  ds_write_b128 v10, v[160:163] offset:4096
  ds_write_b128 v10, v[164:167] offset:5120
  ds_write_b128 v10, v[168:171] offset:6144
  ds_write_b128 v10, v[172:175] offset:7168
  s_cmp_lg_u32 s20, 0
  s_cbranch_scc1 pvq_281
  v_readfirstlane_b32 s21, v29
  s_mov_b32 s23, -1
  v_mov_b32 v213, s23
  s_mov_b64 exec, 1
  ds_write_b32 v30, v29
  ds_write_b32 v30, v213 offset:8
  s_mov_b64 exec, -1
pvq_281:
  s_waitcnt lgkmcnt(0)
  s_barrier
  ds_read_b128 v[176:179], v11 offset:0
  ds_read_b128 v[180:183], v11 offset:8192
  ds_read_b128 v[184:187], v11 offset:16384
  ds_read_b128 v[188:191], v11 offset:24576
  ds_read_b128 v[192:195], v11 offset:4096
  ds_read_b128 v[196:199], v11 offset:12288
  ds_read_b128 v[200:203], v11 offset:20480
  ds_read_b128 v[204:207], v11 offset:28672
  ds_read_b32 v23, v30
  ds_read_b32 v213, v30 offset:8
  s_cmp_ge_u32 s40, 32
  s_cbranch_scc1 pvr_284
  s_waitcnt lgkmcnt(6)
  v_pk_add_f32 v[176:177], v[176:177], v[180:181]
  v_pk_add_f32 v[184:185], v[184:185], v[188:189]
  v_pk_add_f32 v[178:179], v[178:179], v[182:183]
  v_pk_add_f32 v[186:187], v[186:187], v[190:191]
  v_pk_add_f32 v[176:177], v[176:177], v[184:185]
  v_pk_add_f32 v[178:179], v[178:179], v[186:187]
  buffer_store_dwordx4 v[176:179], v4, s[24:27], s54 offen offset:0 sc1
  s_waitcnt lgkmcnt(2)
  v_pk_add_f32 v[192:193], v[192:193], v[196:197]
  v_pk_add_f32 v[200:201], v[200:201], v[204:205]
  v_pk_add_f32 v[194:195], v[194:195], v[198:199]
  v_pk_add_f32 v[202:203], v[202:203], v[206:207]
  v_pk_add_f32 v[192:193], v[192:193], v[200:201]
  v_pk_add_f32 v[194:195], v[194:195], v[202:203]
  buffer_store_dwordx4 v[192:195], v4, s[24:27], s54 offen offset:2048 sc1
  s_lshr_b32 s71, s40, 2
  s_lshl_b32 s71, s71, 7
  s_add_u32 s71, s71, 104448
  s_branch pvr_285
pvr_284:
  s_waitcnt lgkmcnt(6)
  v_pk_add_f32 v[176:177], v[176:177], v[180:181]
  v_pk_add_f32 v[184:185], v[184:185], v[188:189]
  v_pk_add_f32 v[178:179], v[178:179], v[182:183]
  v_pk_add_f32 v[186:187], v[186:187], v[190:191]
  v_pk_add_f32 v[176:177], v[176:177], v[184:185]
  v_pk_add_f32 v[178:179], v[178:179], v[186:187]
  v_cvt_pk_bf16_f32 v26, v176, v177
  v_lshlrev_b32 v176, 16, v26
  v_and_b32 v177, 0xffff0000, v26
  v_mul_f32 v176, v176, v24
  v_mul_f32 v177, v177, v24
  v_cvt_pk_bf16_f32 v26, v176, v177
  v_lshlrev_b32 v176, 16, v26
  v_and_b32 v177, 0xffff0000, v26
  v_add_f32 v176, v176, v12
  v_add_f32 v177, v177, v13
  v_cvt_pk_bf16_f32 v180, v176, v177
  v_cvt_pk_bf16_f32 v26, v178, v179
  v_lshlrev_b32 v178, 16, v26
  v_and_b32 v179, 0xffff0000, v26
  v_mul_f32 v178, v178, v24
  v_mul_f32 v179, v179, v24
  v_cvt_pk_bf16_f32 v26, v178, v179
  v_lshlrev_b32 v178, 16, v26
  v_and_b32 v179, 0xffff0000, v26
  v_add_f32 v178, v178, v14
  v_add_f32 v179, v179, v15
  v_cvt_pk_bf16_f32 v181, v178, v179
  buffer_store_dwordx2 v[180:181], v9, s[8:11], s46 offen offset:0
  s_waitcnt lgkmcnt(2)
  v_pk_add_f32 v[192:193], v[192:193], v[196:197]
  v_pk_add_f32 v[200:201], v[200:201], v[204:205]
  v_pk_add_f32 v[194:195], v[194:195], v[198:199]
  v_pk_add_f32 v[202:203], v[202:203], v[206:207]
  v_pk_add_f32 v[192:193], v[192:193], v[200:201]
  v_pk_add_f32 v[194:195], v[194:195], v[202:203]
  v_cvt_pk_bf16_f32 v26, v192, v193
  v_lshlrev_b32 v192, 16, v26
  v_and_b32 v193, 0xffff0000, v26
  v_mul_f32 v192, v192, v24
  v_mul_f32 v193, v193, v24
  v_cvt_pk_bf16_f32 v26, v192, v193
  v_lshlrev_b32 v192, 16, v26
  v_and_b32 v193, 0xffff0000, v26
  v_add_f32 v192, v192, v16
  v_add_f32 v193, v193, v17
  v_cvt_pk_bf16_f32 v196, v192, v193
  v_cvt_pk_bf16_f32 v26, v194, v195
  v_lshlrev_b32 v194, 16, v26
  v_and_b32 v195, 0xffff0000, v26
  v_mul_f32 v194, v194, v24
  v_mul_f32 v195, v195, v24
  v_cvt_pk_bf16_f32 v26, v194, v195
  v_lshlrev_b32 v194, 16, v26
  v_and_b32 v195, 0xffff0000, v26
  v_add_f32 v194, v194, v18
  v_add_f32 v195, v195, v19
  v_cvt_pk_bf16_f32 v197, v194, v195
  buffer_store_dwordx2 v[196:197], v9, s[8:11], s46 offen offset:64
pvr_285:
pvy_286:
  s_cmp_eq_u32 s65, 0
  s_cbranch_scc1 pvy_287
  s_sub_u32 s65, s65, 1
  s_add_u32 s46, s46, 128
  s_add_u32 s54, s54, 4096
  s_cmp_lt_u32 s40, 32
  s_cselect_b32 s70, 0x80000000, s54
  buffer_load_dwordx4 v[12:15], v4, s[24:27], s70 offen sc1
  buffer_load_dwordx4 v[16:19], v4, s[24:27], s70 offen offset:2048 sc1
  buffer_load_dword v24, v6, s[28:31], s45 offen sc1
  s_waitcnt vmcnt(37) lgkmcnt(0)
  s_barrier
  s_nop 1
  v_mfma_f32_16x16x32_bf16 v[144:147], v[32:35], v[128:131], 0
  v_mfma_f32_16x16x32_bf16 v[148:151], v[32:35], v[132:135], 0
  v_mfma_f32_16x16x32_bf16 v[152:155], v[36:39], v[128:131], 0
  v_mfma_f32_16x16x32_bf16 v[156:159], v[36:39], v[132:135], 0
  v_mfma_f32_16x16x32_bf16 v[160:163], v[40:43], v[128:131], 0
  v_mfma_f32_16x16x32_bf16 v[164:167], v[40:43], v[132:135], 0
  v_mfma_f32_16x16x32_bf16 v[168:171], v[44:47], v[128:131], 0
  v_mfma_f32_16x16x32_bf16 v[172:175], v[44:47], v[132:135], 0
  v_mfma_f32_16x16x32_bf16 v[144:147], v[48:51], v[136:139], v[144:147]
  v_mfma_f32_16x16x32_bf16 v[148:151], v[48:51], v[140:143], v[148:151]
  v_mfma_f32_16x16x32_bf16 v[152:155], v[52:55], v[136:139], v[152:155]
  v_mfma_f32_16x16x32_bf16 v[156:159], v[52:55], v[140:143], v[156:159]
  v_mfma_f32_16x16x32_bf16 v[160:163], v[56:59], v[136:139], v[160:163]
  v_mfma_f32_16x16x32_bf16 v[164:167], v[56:59], v[140:143], v[164:167]
  v_mfma_f32_16x16x32_bf16 v[168:171], v[60:63], v[136:139], v[168:171]
  v_mfma_f32_16x16x32_bf16 v[172:175], v[60:63], v[140:143], v[172:175]
  s_waitcnt vmcnt(33)
  v_mfma_f32_16x16x32_bf16 v[148:151], a[0:3], v[64:67], v[148:151]
  v_mfma_f32_16x16x32_bf16 v[144:147], a[0:3], v[68:71], v[144:147]
  v_mfma_f32_16x16x32_bf16 v[156:159], a[4:7], v[64:67], v[156:159]
  v_mfma_f32_16x16x32_bf16 v[152:155], a[4:7], v[68:71], v[152:155]
  v_mfma_f32_16x16x32_bf16 v[164:167], a[8:11], v[64:67], v[164:167]
  v_mfma_f32_16x16x32_bf16 v[160:163], a[8:11], v[68:71], v[160:163]
  v_mfma_f32_16x16x32_bf16 v[172:175], a[12:15], v[64:67], v[172:175]
  v_mfma_f32_16x16x32_bf16 v[168:171], a[12:15], v[68:71], v[168:171]
  s_waitcnt vmcnt(29)
  v_mfma_f32_16x16x32_bf16 v[148:151], a[16:19], v[72:75], v[148:151]
  v_mfma_f32_16x16x32_bf16 v[144:147], a[16:19], v[76:79], v[144:147]
  v_mfma_f32_16x16x32_bf16 v[156:159], a[20:23], v[72:75], v[156:159]
  v_mfma_f32_16x16x32_bf16 v[152:155], a[20:23], v[76:79], v[152:155]
  v_mfma_f32_16x16x32_bf16 v[164:167], a[24:27], v[72:75], v[164:167]
  v_mfma_f32_16x16x32_bf16 v[160:163], a[24:27], v[76:79], v[160:163]
  v_mfma_f32_16x16x32_bf16 v[172:175], a[28:31], v[72:75], v[172:175]
  v_mfma_f32_16x16x32_bf16 v[168:171], a[28:31], v[76:79], v[168:171]
  s_waitcnt vmcnt(25)
  v_mfma_f32_16x16x32_bf16 v[148:151], a[32:35], v[80:83], v[148:151]
  v_mfma_f32_16x16x32_bf16 v[144:147], a[32:35], v[84:87], v[144:147]
  v_mfma_f32_16x16x32_bf16 v[156:159], a[36:39], v[80:83], v[156:159]
  v_mfma_f32_16x16x32_bf16 v[152:155], a[36:39], v[84:87], v[152:155]
  v_mfma_f32_16x16x32_bf16 v[164:167], a[40:43], v[80:83], v[164:167]
  v_mfma_f32_16x16x32_bf16 v[160:163], a[40:43], v[84:87], v[160:163]
  v_mfma_f32_16x16x32_bf16 v[172:175], a[44:47], v[80:83], v[172:175]
  v_mfma_f32_16x16x32_bf16 v[168:171], a[44:47], v[84:87], v[168:171]
  s_waitcnt vmcnt(21)
  v_mfma_f32_16x16x32_bf16 v[148:151], a[48:51], v[88:91], v[148:151]
  v_mfma_f32_16x16x32_bf16 v[144:147], a[48:51], v[92:95], v[144:147]
  v_mfma_f32_16x16x32_bf16 v[156:159], a[52:55], v[88:91], v[156:159]
  v_mfma_f32_16x16x32_bf16 v[152:155], a[52:55], v[92:95], v[152:155]
  v_mfma_f32_16x16x32_bf16 v[164:167], a[56:59], v[88:91], v[164:167]
  v_mfma_f32_16x16x32_bf16 v[160:163], a[56:59], v[92:95], v[160:163]
  v_mfma_f32_16x16x32_bf16 v[172:175], a[60:63], v[88:91], v[172:175]
  v_mfma_f32_16x16x32_bf16 v[168:171], a[60:63], v[92:95], v[168:171]
  s_waitcnt vmcnt(17)
  v_mfma_f32_16x16x32_bf16 v[148:151], a[64:67], v[96:99], v[148:151]
  v_mfma_f32_16x16x32_bf16 v[144:147], a[64:67], v[100:103], v[144:147]
  v_mfma_f32_16x16x32_bf16 v[156:159], a[68:71], v[96:99], v[156:159]
  v_mfma_f32_16x16x32_bf16 v[152:155], a[68:71], v[100:103], v[152:155]
  v_mfma_f32_16x16x32_bf16 v[164:167], a[72:75], v[96:99], v[164:167]
  v_mfma_f32_16x16x32_bf16 v[160:163], a[72:75], v[100:103], v[160:163]
  v_mfma_f32_16x16x32_bf16 v[172:175], a[76:79], v[96:99], v[172:175]
  v_mfma_f32_16x16x32_bf16 v[168:171], a[76:79], v[100:103], v[168:171]
  s_waitcnt vmcnt(13)
  v_mfma_f32_16x16x32_bf16 v[148:151], a[80:83], v[104:107], v[148:151]
  v_mfma_f32_16x16x32_bf16 v[144:147], a[80:83], v[108:111], v[144:147]
  v_mfma_f32_16x16x32_bf16 v[156:159], a[84:87], v[104:107], v[156:159]
  v_mfma_f32_16x16x32_bf16 v[152:155], a[84:87], v[108:111], v[152:155]
  v_mfma_f32_16x16x32_bf16 v[164:167], a[88:91], v[104:107], v[164:167]
  v_mfma_f32_16x16x32_bf16 v[160:163], a[88:91], v[108:111], v[160:163]
  v_mfma_f32_16x16x32_bf16 v[172:175], a[92:95], v[104:107], v[172:175]
  v_mfma_f32_16x16x32_bf16 v[168:171], a[92:95], v[108:111], v[168:171]
  s_waitcnt vmcnt(9)
  v_mfma_f32_16x16x32_bf16 v[148:151], a[96:99], v[112:115], v[148:151]
  v_mfma_f32_16x16x32_bf16 v[144:147], a[96:99], v[116:119], v[144:147]
  v_mfma_f32_16x16x32_bf16 v[156:159], a[100:103], v[112:115], v[156:159]
  v_mfma_f32_16x16x32_bf16 v[152:155], a[100:103], v[116:119], v[152:155]
  v_mfma_f32_16x16x32_bf16 v[164:167], a[104:107], v[112:115], v[164:167]
  v_mfma_f32_16x16x32_bf16 v[160:163], a[104:107], v[116:119], v[160:163]
  v_mfma_f32_16x16x32_bf16 v[172:175], a[108:111], v[112:115], v[172:175]
  v_mfma_f32_16x16x32_bf16 v[168:171], a[108:111], v[116:119], v[168:171]
  s_waitcnt vmcnt(5)
  v_mfma_f32_16x16x32_bf16 v[148:151], a[112:115], v[120:123], v[148:151]
  v_mfma_f32_16x16x32_bf16 v[144:147], a[112:115], v[124:127], v[144:147]
  v_mfma_f32_16x16x32_bf16 v[156:159], a[116:119], v[120:123], v[156:159]
  v_mfma_f32_16x16x32_bf16 v[152:155], a[116:119], v[124:127], v[152:155]
  v_mfma_f32_16x16x32_bf16 v[164:167], a[120:123], v[120:123], v[164:167]
  v_mfma_f32_16x16x32_bf16 v[160:163], a[120:123], v[124:127], v[160:163]
  v_mfma_f32_16x16x32_bf16 v[172:175], a[124:127], v[120:123], v[172:175]
  v_mfma_f32_16x16x32_bf16 v[168:171], a[124:127], v[124:127], v[168:171]
  s_waitcnt vmcnt(0)
  v_sub_f32 v25, 1.0, v24
  v_cvt_pk_bf16_f32 v26, v25, v25
  v_lshlrev_b32 v25, 16, v26
  v_cvt_pk_bf16_f32 v26, v12, v12
  v_lshlrev_b32 v12, 16, v26
  v_cvt_pk_bf16_f32 v26, v13, v13
  v_lshlrev_b32 v13, 16, v26
  v_cvt_pk_bf16_f32 v26, v14, v14
  v_lshlrev_b32 v14, 16, v26
  v_cvt_pk_bf16_f32 v26, v15, v15
  v_lshlrev_b32 v15, 16, v26
  v_cvt_pk_bf16_f32 v26, v16, v16
  v_lshlrev_b32 v16, 16, v26
  v_cvt_pk_bf16_f32 v26, v17, v17
  v_lshlrev_b32 v17, 16, v26
  v_cvt_pk_bf16_f32 v26, v18, v18
  v_lshlrev_b32 v18, 16, v26
  v_cvt_pk_bf16_f32 v26, v19, v19
  v_lshlrev_b32 v19, 16, v26
  v_mul_f32 v12, v12, v25
  v_cvt_pk_bf16_f32 v26, v12, v12
  v_lshlrev_b32 v12, 16, v26
  v_mul_f32 v13, v13, v25
  v_cvt_pk_bf16_f32 v26, v13, v13
  v_lshlrev_b32 v13, 16, v26
  v_mul_f32 v14, v14, v25
  v_cvt_pk_bf16_f32 v26, v14, v14
  v_lshlrev_b32 v14, 16, v26
  v_mul_f32 v15, v15, v25
  v_cvt_pk_bf16_f32 v26, v15, v15
  v_lshlrev_b32 v15, 16, v26
  v_mul_f32 v16, v16, v25
  v_cvt_pk_bf16_f32 v26, v16, v16
  v_lshlrev_b32 v16, 16, v26
  v_mul_f32 v17, v17, v25
  v_cvt_pk_bf16_f32 v26, v17, v17
  v_lshlrev_b32 v17, 16, v26
  v_mul_f32 v18, v18, v25
  v_cvt_pk_bf16_f32 v26, v18, v18
  v_lshlrev_b32 v18, 16, v26
  v_mul_f32 v19, v19, v25
  v_cvt_pk_bf16_f32 v26, v19, v19
  v_lshlrev_b32 v19, 16, v26
  s_cmp_eq_u32 s65, 0
  s_cbranch_scc1 pvx_288
  s_add_u32 s41, s41, 1
  s_mul_i32 s53, s42, 40960
  s_lshl_b32 s22, s41, 12
  s_add_u32 s53, s53, s22
  s_mul_i32 s48, s42, 10240
  s_lshl_b32 s22, s41, 10
  s_add_u32 s48, s48, s22
  s_add_u32 s48, s48, 7340032
  buffer_load_dwordx4 v[32:35], v22, s[16:19], s48 offen offset:0 sc1
  buffer_load_dwordx4 v[36:39], v22, s[16:19], s48 offen offset:256 sc1
  buffer_load_dwordx4 v[40:43], v22, s[16:19], s48 offen offset:512 sc1
  buffer_load_dwordx4 v[44:47], v22, s[16:19], s48 offen offset:768 sc1
  s_add_u32 s48, s48, 40960
  buffer_load_dwordx4 v[48:51], v22, s[16:19], s48 offen offset:0 sc1
  buffer_load_dwordx4 v[52:55], v22, s[16:19], s48 offen offset:256 sc1
  buffer_load_dwordx4 v[56:59], v22, s[16:19], s48 offen offset:512 sc1
  buffer_load_dwordx4 v[60:63], v22, s[16:19], s48 offen offset:768 sc1
  s_add_u32 s48, s48, 40960
  buffer_load_dwordx4 a[0:3], v4, s[12:15], s53 offen offset:0 sc1
  buffer_load_dwordx4 a[4:7], v4, s[12:15], s53 offen offset:1024 sc1
  buffer_load_dwordx4 a[8:11], v4, s[12:15], s53 offen offset:2048 sc1
  buffer_load_dwordx4 a[12:15], v4, s[12:15], s53 offen offset:3072 sc1
  s_add_u32 s53, s53, 40960
  buffer_load_dwordx4 a[16:19], v4, s[12:15], s53 offen offset:0 sc1
  buffer_load_dwordx4 a[20:23], v4, s[12:15], s53 offen offset:1024 sc1
  buffer_load_dwordx4 a[24:27], v4, s[12:15], s53 offen offset:2048 sc1
  buffer_load_dwordx4 a[28:31], v4, s[12:15], s53 offen offset:3072 sc1
  s_add_u32 s53, s53, 40960
  buffer_load_dwordx4 a[32:35], v4, s[12:15], s53 offen offset:0 sc1
  buffer_load_dwordx4 a[36:39], v4, s[12:15], s53 offen offset:1024 sc1
  buffer_load_dwordx4 a[40:43], v4, s[12:15], s53 offen offset:2048 sc1
  buffer_load_dwordx4 a[44:47], v4, s[12:15], s53 offen offset:3072 sc1
  s_add_u32 s53, s53, 40960
  buffer_load_dwordx4 a[48:51], v4, s[12:15], s53 offen offset:0 sc1
  buffer_load_dwordx4 a[52:55], v4, s[12:15], s53 offen offset:1024 sc1
  buffer_load_dwordx4 a[56:59], v4, s[12:15], s53 offen offset:2048 sc1
  buffer_load_dwordx4 a[60:63], v4, s[12:15], s53 offen offset:3072 sc1
  s_add_u32 s53, s53, 40960
  buffer_load_dwordx4 a[64:67], v4, s[12:15], s53 offen offset:0 sc1
  buffer_load_dwordx4 a[68:71], v4, s[12:15], s53 offen offset:1024 sc1
  buffer_load_dwordx4 a[72:75], v4, s[12:15], s53 offen offset:2048 sc1
  buffer_load_dwordx4 a[76:79], v4, s[12:15], s53 offen offset:3072 sc1
  s_add_u32 s53, s53, 40960
  buffer_load_dwordx4 a[80:83], v4, s[12:15], s53 offen offset:0 sc1
  buffer_load_dwordx4 a[84:87], v4, s[12:15], s53 offen offset:1024 sc1
  buffer_load_dwordx4 a[88:91], v4, s[12:15], s53 offen offset:2048 sc1
  buffer_load_dwordx4 a[92:95], v4, s[12:15], s53 offen offset:3072 sc1
  s_add_u32 s53, s53, 40960
  buffer_load_dwordx4 a[96:99], v4, s[12:15], s53 offen offset:0 sc1
  buffer_load_dwordx4 a[100:103], v4, s[12:15], s53 offen offset:1024 sc1
  buffer_load_dwordx4 a[104:107], v4, s[12:15], s53 offen offset:2048 sc1
  buffer_load_dwordx4 a[108:111], v4, s[12:15], s53 offen offset:3072 sc1
  s_add_u32 s53, s53, 40960
  buffer_load_dwordx4 a[112:115], v4, s[12:15], s53 offen offset:0 sc1
  buffer_load_dwordx4 a[116:119], v4, s[12:15], s53 offen offset:1024 sc1
  buffer_load_dwordx4 a[120:123], v4, s[12:15], s53 offen offset:2048 sc1
  buffer_load_dwordx4 a[124:127], v4, s[12:15], s53 offen offset:3072 sc1
pvx_288:
  ds_write_b128 v10, v[144:147] offset:0
  ds_write_b128 v10, v[148:151] offset:1024
  ds_write_b128 v10, v[152:155] offset:2048
  ds_write_b128 v10, v[156:159] offset:3072
  ds_write_b128 v10, v[160:163] offset:4096
  ds_write_b128 v10, v[164:167] offset:5120
  ds_write_b128 v10, v[168:171] offset:6144
  ds_write_b128 v10, v[172:175] offset:7168
  s_waitcnt lgkmcnt(0)
  s_barrier
  ds_read_b128 v[176:179], v11 offset:0
  ds_read_b128 v[180:183], v11 offset:8192
  ds_read_b128 v[184:187], v11 offset:16384
  ds_read_b128 v[188:191], v11 offset:24576
  ds_read_b128 v[192:195], v11 offset:4096
  ds_read_b128 v[196:199], v11 offset:12288
  ds_read_b128 v[200:203], v11 offset:20480
  ds_read_b128 v[204:207], v11 offset:28672
  s_cmp_ge_u32 s40, 32
  s_cbranch_scc1 pvr_289
  s_waitcnt lgkmcnt(4)
  v_pk_add_f32 v[176:177], v[176:177], v[180:181]
  v_pk_add_f32 v[184:185], v[184:185], v[188:189]
  v_pk_add_f32 v[178:179], v[178:179], v[182:183]
  v_pk_add_f32 v[186:187], v[186:187], v[190:191]
  v_pk_add_f32 v[176:177], v[176:177], v[184:185]
  v_pk_add_f32 v[178:179], v[178:179], v[186:187]
  buffer_store_dwordx4 v[176:179], v4, s[24:27], s54 offen offset:0 sc1
  s_waitcnt lgkmcnt(0)
  v_pk_add_f32 v[192:193], v[192:193], v[196:197]
  v_pk_add_f32 v[200:201], v[200:201], v[204:205]
  v_pk_add_f32 v[194:195], v[194:195], v[198:199]
  v_pk_add_f32 v[202:203], v[202:203], v[206:207]
  v_pk_add_f32 v[192:193], v[192:193], v[200:201]
  v_pk_add_f32 v[194:195], v[194:195], v[202:203]
  buffer_store_dwordx4 v[192:195], v4, s[24:27], s54 offen offset:2048 sc1
  s_lshr_b32 s71, s40, 2
  s_lshl_b32 s71, s71, 7
  s_add_u32 s71, s71, 104448
  s_branch pvr_290
pvr_289:
  s_waitcnt lgkmcnt(4)
  v_pk_add_f32 v[176:177], v[176:177], v[180:181]
  v_pk_add_f32 v[184:185], v[184:185], v[188:189]
  v_pk_add_f32 v[178:179], v[178:179], v[182:183]
  v_pk_add_f32 v[186:187], v[186:187], v[190:191]
  v_pk_add_f32 v[176:177], v[176:177], v[184:185]
  v_pk_add_f32 v[178:179], v[178:179], v[186:187]
  v_cvt_pk_bf16_f32 v26, v176, v177
  v_lshlrev_b32 v176, 16, v26
  v_and_b32 v177, 0xffff0000, v26
  v_mul_f32 v176, v176, v24
  v_mul_f32 v177, v177, v24
  v_cvt_pk_bf16_f32 v26, v176, v177
  v_lshlrev_b32 v176, 16, v26
  v_and_b32 v177, 0xffff0000, v26
  v_add_f32 v176, v176, v12
  v_add_f32 v177, v177, v13
  v_cvt_pk_bf16_f32 v180, v176, v177
  v_cvt_pk_bf16_f32 v26, v178, v179
  v_lshlrev_b32 v178, 16, v26
  v_and_b32 v179, 0xffff0000, v26
  v_mul_f32 v178, v178, v24
  v_mul_f32 v179, v179, v24
  v_cvt_pk_bf16_f32 v26, v178, v179
  v_lshlrev_b32 v178, 16, v26
  v_and_b32 v179, 0xffff0000, v26
  v_add_f32 v178, v178, v14
  v_add_f32 v179, v179, v15
  v_cvt_pk_bf16_f32 v181, v178, v179
  buffer_store_dwordx2 v[180:181], v9, s[8:11], s46 offen offset:0
  s_waitcnt lgkmcnt(0)
  v_pk_add_f32 v[192:193], v[192:193], v[196:197]
  v_pk_add_f32 v[200:201], v[200:201], v[204:205]
  v_pk_add_f32 v[194:195], v[194:195], v[198:199]
  v_pk_add_f32 v[202:203], v[202:203], v[206:207]
  v_pk_add_f32 v[192:193], v[192:193], v[200:201]
  v_pk_add_f32 v[194:195], v[194:195], v[202:203]
  v_cvt_pk_bf16_f32 v26, v192, v193
  v_lshlrev_b32 v192, 16, v26
  v_and_b32 v193, 0xffff0000, v26
  v_mul_f32 v192, v192, v24
  v_mul_f32 v193, v193, v24
  v_cvt_pk_bf16_f32 v26, v192, v193
  v_lshlrev_b32 v192, 16, v26
  v_and_b32 v193, 0xffff0000, v26
  v_add_f32 v192, v192, v16
  v_add_f32 v193, v193, v17
  v_cvt_pk_bf16_f32 v196, v192, v193
  v_cvt_pk_bf16_f32 v26, v194, v195
  v_lshlrev_b32 v194, 16, v26
  v_and_b32 v195, 0xffff0000, v26
  v_mul_f32 v194, v194, v24
  v_mul_f32 v195, v195, v24
  v_cvt_pk_bf16_f32 v26, v194, v195
  v_lshlrev_b32 v194, 16, v26
  v_and_b32 v195, 0xffff0000, v26
  v_add_f32 v194, v194, v18
  v_add_f32 v195, v195, v19
  v_cvt_pk_bf16_f32 v197, v194, v195
  buffer_store_dwordx2 v[196:197], v9, s[8:11], s46 offen offset:64
pvr_290:
  s_branch pvy_286
pvy_287:
  s_sub_u32 s21, s2, 450
  s_cmp_ge_u32 s21, 190
  s_cbranch_scc1 lc_291
  s_cmp_lg_u32 s20, 0
  s_cbranch_scc1 lc_291x
  s_waitcnt vmcnt(2)
  s_mov_b64 exec, 1
  ds_write_b32 v30, v29 offset:12
  s_mov_b64 exec, -1
lc_291x:
  s_waitcnt lgkmcnt(0)
  s_barrier
  ds_read_b32 v23, v30 offset:12
lc_291:
  s_waitcnt lgkmcnt(0)
  v_readfirstlane_b32 s2, v23
  v_readfirstlane_b32 s67, v213
  s_barrier
  s_cmp_lt_u32 s2, 326
  s_cbranch_scc1 pae_292
  s_waitcnt vmcnt(0)
  s_cmp_eq_u32 s71, 0
  s_cbranch_scc1 paf_293
  v_mov_b32 v25, 0
  v_mov_b32 v26, 1
  s_mov_b64 exec, 1
  buffer_atomic_add v26, v25, s[72:75], s71 offen sc1
  s_mov_b64 exec, -1
  s_mov_b32 s71, 0
paf_293:
pae_292:
  s_add_u32 s21, s2, 0
  s_cmp_lt_u32 s2, 326
  s_cbranch_scc1 pv_loop
  s_sub_u32 s2, s2, 326
  s_branch main_fin
  s_branch queue
main_fin:
  s_waitcnt vmcnt(0)
main_end:
  s_endpgm
.section .rodata,"a"
.p2align 6
.amdhsa_kernel gated_mix__memory_aug_recurrent_mem_tr__sliding_local_dilated__prompt_kernel
  .amdhsa_next_free_vgpr 512
  .amdhsa_next_free_sgpr 102
  .amdhsa_accum_offset 256
  .amdhsa_group_segment_fixed_size 0
  .amdhsa_kernarg_size 112
  .amdhsa_user_sgpr_count 2
  .amdhsa_user_sgpr_kernarg_segment_ptr 1
  .amdhsa_system_sgpr_workgroup_id_x 1
.end_amdhsa_kernel
.text
```

```asm
; @launch kernel=gated_mix__memory_aug_recurrent_mem_tr__sliding_local_dilated__prompt_kernel grid=(256,1,1) block=(256,1,1) lds=163840
.amdgcn_target "amdgcn-amd-amdhsa--gfx950"
.text
.globl gated_mix__memory_aug_recurrent_mem_tr__sliding_local_dilated__prompt_kernel
.p2align 8
.type gated_mix__memory_aug_recurrent_mem_tr__sliding_local_dilated__prompt_kernel,@function
gated_mix__memory_aug_recurrent_mem_tr__sliding_local_dilated__prompt_kernel:
  s_cmp_ge_u32 s2, 256
  s_cbranch_scc1 end0
  s_load_dwordx2 s[4:5], s[0:1], 96
  s_load_dwordx2 s[38:39], s[0:1], 104
  v_lshrrev_b32 v1, 6, v0
  v_and_b32 v2, 15, v0
  v_readfirstlane_b32 s20, v1
  v_and_b32 v1, 63, v0
  v_lshrrev_b32 v3, 4, v1
  s_getreg_b32 s50, hwreg(HW_REG_XCC_ID)
  s_and_b32 s50, s50, 7
  s_waitcnt lgkmcnt(0)
  s_mov_b32 s32, s4
  s_mov_b32 s33, s5
  s_mov_b32 s34, 256
  s_mov_b32 s35, 0x00020000
  s_getpc_b64 s[6:7]
cpf_pc:
  s_sub_u32 s6, s6, cpf_pc - gated_mix__memory_aug_recurrent_mem_tr__sliding_local_dilated__prompt_kernel
  s_subb_u32 s7, s7, 0
  s_lshr_b32 s21, s2, 3
  s_lshl_b32 s21, s21, 12
  v_lshl_add_u32 v28, v0, 4, s21
  v_min_u32 v28, code_end - gated_mix__memory_aug_recurrent_mem_tr__sliding_local_dilated__prompt_kernel - 16, v28
  global_load_dwordx4 a[252:255], v28, s[6:7]
  v_mov_b32 v21, 0
  s_cmp_lg_u32 s20, 0
  s_cbranch_scc1 rk_1
  s_and_b32 s21, s50, 1
  s_lshl_b32 s21, s21, 7
  s_lshl_b32 s22, s50, 1
  s_and_b32 s22, s22, 12
  s_add_u32 s21, s21, s22
  v_mov_b32 v22, s21
  v_mov_b32 v23, 1
  s_mov_b64 exec, 1
  buffer_atomic_add v23, v22, s[32:35], 0 offen sc0 sc1
  s_waitcnt vmcnt(0)
  v_readfirstlane_b32 s51, v23
  s_lshl_b32 s22, s50, 5
  s_add_u32 s22, s22, s51
  s_cmp_lt_u32 s51, 32
  s_cbranch_scc1 rk_2
  v_mov_b32 v24, 72
  v_mov_b32 v25, 1
  buffer_atomic_add v25, v24, s[32:35], 0 offen sc0 sc1
  s_waitcnt vmcnt(0)
  v_readfirstlane_b32 s23, v25
  s_mov_b32 s101, 0
  s_mov_b64 exec, -1
  v_lshlrev_b32 v24, 2, v1
rk_3:
  s_sleep 8
  buffer_load_dword v25, v24, s[32:35], 0 offen sc1
  s_add_u32 s101, s101, 1
  s_cmp_gt_u32 s101, 131072
  s_cbranch_scc1 end0
  s_waitcnt vmcnt(0)
  v_readlane_b32 s21, v25, 0
  v_readlane_b32 s22, v25, 32
  s_add_u32 s21, s21, s22
  v_readlane_b32 s22, v25, 1
  s_add_u32 s21, s21, s22
  v_readlane_b32 s22, v25, 33
  s_add_u32 s21, s21, s22
  v_readlane_b32 s22, v25, 2
  s_add_u32 s21, s21, s22
  v_readlane_b32 s22, v25, 34
  s_add_u32 s21, s21, s22
  v_readlane_b32 s22, v25, 3
  s_add_u32 s21, s21, s22
  v_readlane_b32 s22, v25, 35
  s_add_u32 s21, s21, s22
  s_cmp_lt_u32 s21, 256
  s_cbranch_scc1 rk_3
  s_mov_b64 exec, 1
  s_mov_b32 s24, 0
rk_5:
  s_and_b32 s21, s24, 1
  s_lshl_b32 s21, s21, 5
  s_lshr_b32 s22, s24, 1
  s_add_u32 s21, s21, s22
  v_readlane_b32 s21, v25, s21
  s_min_u32 s21, s21, 32
  s_sub_u32 s25, 32, s21
  s_cmp_lt_u32 s23, s25
  s_cbranch_scc1 rk_4
  s_sub_u32 s23, s23, s25
  s_add_u32 s24, s24, 1
  s_cmp_lt_u32 s24, 8
  s_cbranch_scc1 rk_5
  s_branch end0
rk_4:
  s_lshl_b32 s22, s24, 5
  s_add_u32 s22, s22, s21
  s_add_u32 s22, s22, s23
  s_or_b32 s22, s22, 0x100
rk_2:
  v_mov_b32 v23, s22
  ds_write_b32 v21, v23
  s_waitcnt lgkmcnt(0)
  s_mov_b64 exec, -1
rk_1:
  s_barrier
  ds_read_b32 v23, v21
  s_waitcnt lgkmcnt(0)
  v_readfirstlane_b32 s22, v23
  s_barrier
  s_mov_b32 s84, 0
  s_mov_b32 s85, -1

  s_lshr_b32 s53, s22, 8
  s_and_b32 s22, s22, 255
  s_cmp_ge_u32 s22, 128
  s_cbranch_scc1 gemm_side
  s_lshr_b32 s50, s22, 4
  s_and_b32 s51, s22, 15
  s_mov_b32 s86, 0x3dd53b95
  s_load_dwordx2 s[4:5], s[0:1], 8
  s_load_dwordx4 s[36:39], s[0:1], 16
  s_load_dwordx4 s[40:43], s[0:1], 32
  s_load_dwordx2 s[44:45], s[0:1], 104
  s_lshr_b32 s55, s51, 2
  s_and_b32 s56, s51, 3
  s_lshl_b32 s57, s50, 2
  s_add_u32 s58, s57, s55
  s_add_u32 s59, s57, s20
  s_lshr_b32 s21, s51, 1
  s_xor_b32 s21, s21, s55
  s_andn2_b32 s21, 1, s21
  s_xor_b32 s85, s51, s21
  s_xor_b32 s84, s56, 1
  s_mul_i32 s87, s85, 5
  s_lshr_b32 s87, s87, 1
  s_and_b32 s79, s85, 1
  s_waitcnt lgkmcnt(0)
  s_add_u32 s8, s44, 78643200
  s_addc_u32 s9, s45, 0
  s_mov_b32 s10, 2162688
  s_mov_b32 s11, 0x00020000
  s_mov_b32 s16, s44
  s_mov_b32 s17, s45
  s_mov_b32 s18, 50331648
  s_mov_b32 s19, 0x00020000
  s_add_u32 s24, s44, 50331648
  s_addc_u32 s25, s45, 0
  s_mov_b32 s26, 63963136
  s_mov_b32 s27, 0x00020000
  s_mov_b32 s28, s4
  s_mov_b32 s29, s5
  s_mov_b32 s30, 10240
  s_mov_b32 s31, 0x00020000
  s_add_u32 s4, s44, 83886079
  s_addc_u32 s5, s45, 0
  s_and_b32 s4, s4, 0xffe00000
  s_mov_b32 s6, 2097152
  s_mov_b32 s7, 0x00020000
  v_mov_b32 v27, 10923
  v_add_u32 v103, 0, v1
  v_mul_u32_u24 v102, v103, v27
  v_lshrrev_b32 v102, 16, v102
  v_mul_u32_u24 v101, 6, v102
  v_sub_u32 v103, v103, v101
  v_bfe_u32 v101, v102, 1, 1
  v_mul_u32_u24 v101, 20, v101
  v_and_b32 v100, 1, v102
  v_add_u32 v101, v101, v100
  v_lshrrev_b32 v100, 3, v102
  v_mul_u32_u24 v100, 40, v100
  v_bfe_u32 v99, v102, 2, 1
  v_lshl_add_u32 v100, v99, 1, v100
  v_add_u32 v100, v100, v101
  v_mul_u32_u24 v100, 12288, v100
  v_lshl_add_u32 v46, v103, 4, v100
  v_lshrrev_b32 v100, 4, v102
  v_mul_u32_u24 v100, 40, v100
  v_bfe_u32 v99, v102, 2, 2
  v_lshl_add_u32 v100, v99, 1, v100
  v_add_u32 v100, v100, v101
  v_mul_u32_u24 v100, 12288, v100
  v_lshl_add_u32 v96, v103, 4, v100
  v_add_u32 v103, 64, v1
  v_mul_u32_u24 v102, v103, v27
  v_lshrrev_b32 v102, 16, v102
  v_mul_u32_u24 v101, 6, v102
  v_sub_u32 v103, v103, v101
  v_bfe_u32 v101, v102, 1, 1
  v_mul_u32_u24 v101, 20, v101
  v_and_b32 v100, 1, v102
  v_add_u32 v101, v101, v100
  v_lshrrev_b32 v100, 3, v102
  v_mul_u32_u24 v100, 40, v100
  v_bfe_u32 v99, v102, 2, 1
  v_lshl_add_u32 v100, v99, 1, v100
  v_add_u32 v100, v100, v101
  v_mul_u32_u24 v100, 12288, v100
  v_lshl_add_u32 v47, v103, 4, v100
  v_lshrrev_b32 v100, 4, v102
  v_mul_u32_u24 v100, 40, v100
  v_bfe_u32 v99, v102, 2, 2
  v_lshl_add_u32 v100, v99, 1, v100
  v_add_u32 v100, v100, v101
  v_mul_u32_u24 v100, 12288, v100
  v_lshl_add_u32 v97, v103, 4, v100
  v_add_u32 v103, 128, v1
  v_mul_u32_u24 v102, v103, v27
  v_lshrrev_b32 v102, 16, v102
  v_mul_u32_u24 v101, 6, v102
  v_sub_u32 v103, v103, v101
  v_bfe_u32 v101, v102, 1, 1
  v_mul_u32_u24 v101, 20, v101
  v_and_b32 v100, 1, v102
  v_add_u32 v101, v101, v100
  v_lshrrev_b32 v100, 3, v102
  v_mul_u32_u24 v100, 40, v100
  v_bfe_u32 v99, v102, 2, 1
  v_lshl_add_u32 v100, v99, 1, v100
  v_add_u32 v100, v100, v101
  v_mul_u32_u24 v100, 12288, v100
  v_lshl_add_u32 v48, v103, 4, v100
  v_lshrrev_b32 v100, 4, v102
  v_mul_u32_u24 v100, 40, v100
  v_bfe_u32 v99, v102, 2, 2
  v_lshl_add_u32 v100, v99, 1, v100
  v_add_u32 v100, v100, v101
  v_mul_u32_u24 v100, 12288, v100
  v_lshl_add_u32 v98, v103, 4, v100
  s_mul_i32 s80, s58, 384
  s_mul_i32 s22, s56, 96
  s_add_u32 s80, s80, s22
  s_mul_i32 s22, s20, 1966080
  s_add_u32 s80, s80, s22
  s_mul_i32 s88, s84, 96
  s_mul_i32 s21, s56, 96
  s_sub_u32 s88, s88, s21
  s_add_u32 s88, s88, s80
  s_mul_i32 s81, s20, 40448

  s_mul_i32 s82, s59, 245760
  s_lshl_b32 s22, s87, 5
  s_add_u32 s82, s82, s22
  s_mov_b32 s12, s38
  s_mov_b32 s13, s39
  s_mov_b32 s14, 7864320
  s_mov_b32 s15, 0x00020000
  s_add_u32 s21, s80, 0
  s_add_u32 s22, s81, 0
  s_add_u32 m0, s22, 0
  s_nop 0
  buffer_load_dwordx4 v96, s[12:15], s21 offen lds
  s_add_u32 m0, s22, 1024
  s_nop 0
  buffer_load_dwordx4 v97, s[12:15], s21 offen lds
  s_add_u32 m0, s22, 2048
  s_nop 0
  buffer_load_dwordx4 v98, s[12:15], s21 offen lds
  s_add_u32 s21, s80, 983040
  s_add_u32 s22, s81, 3072
  s_add_u32 m0, s22, 0
  s_nop 0
  buffer_load_dwordx4 v96, s[12:15], s21 offen lds
  s_add_u32 m0, s22, 1024
  s_nop 0
  buffer_load_dwordx4 v97, s[12:15], s21 offen lds
  s_add_u32 m0, s22, 2048
  s_nop 0
  buffer_load_dwordx4 v98, s[12:15], s21 offen lds
  s_add_u32 s21, s80, 98304
  s_add_u32 s22, s81, 6144
  s_add_u32 m0, s22, 0
  s_nop 0
  buffer_load_dwordx4 v96, s[12:15], s21 offen lds
  s_add_u32 m0, s22, 1024
  s_nop 0
  buffer_load_dwordx4 v97, s[12:15], s21 offen lds
  s_add_u32 m0, s22, 2048
  s_nop 0
  buffer_load_dwordx4 v98, s[12:15], s21 offen lds
  s_add_u32 s21, s80, 1081344
  s_add_u32 s22, s81, 9216
  s_add_u32 m0, s22, 0
  s_nop 0
  buffer_load_dwordx4 v96, s[12:15], s21 offen lds
  s_add_u32 m0, s22, 1024
  s_nop 0
  buffer_load_dwordx4 v97, s[12:15], s21 offen lds
  s_add_u32 m0, s22, 2048
  s_nop 0
  buffer_load_dwordx4 v98, s[12:15], s21 offen lds
  s_add_u32 s21, s80, 196608
  s_add_u32 s22, s81, 12288
  s_add_u32 m0, s22, 0
  s_nop 0
  buffer_load_dwordx4 v46, s[12:15], s21 offen lds
  s_add_u32 m0, s22, 1024
  s_nop 0
  buffer_load_dwordx4 v47, s[12:15], s21 offen lds
  s_add_u32 m0, s22, 2048
  s_nop 0
  buffer_load_dwordx4 v48, s[12:15], s21 offen lds
  s_mov_b32 s12, s40
  s_mov_b32 s13, s41
  s_mov_b32 s14, 7864320
  s_mov_b32 s15, 0x00020000
  s_add_u32 s21, s88, 0
  s_add_u32 s22, s81, 0
  buffer_load_dwordx4 v[128:131], v96, s[12:15], s21 offen
  buffer_load_dwordx4 v[132:135], v97, s[12:15], s21 offen
  buffer_load_dwordx4 v[136:139], v98, s[12:15], s21 offen
  s_add_u32 s21, s88, 983040
  s_add_u32 s22, s81, 3072
  buffer_load_dwordx4 v[140:143], v96, s[12:15], s21 offen
  buffer_load_dwordx4 v[144:147], v97, s[12:15], s21 offen
  buffer_load_dwordx4 v[148:151], v98, s[12:15], s21 offen
  s_add_u32 s21, s88, 98304
  s_add_u32 s22, s81, 6144
  buffer_load_dwordx4 v[152:155], v96, s[12:15], s21 offen
  buffer_load_dwordx4 v[156:159], v97, s[12:15], s21 offen
  buffer_load_dwordx4 v[160:163], v98, s[12:15], s21 offen
  s_add_u32 s21, s88, 1081344
  s_add_u32 s22, s81, 9216
  buffer_load_dwordx4 v[164:167], v96, s[12:15], s21 offen
  buffer_load_dwordx4 v[168:171], v97, s[12:15], s21 offen
  buffer_load_dwordx4 v[172:175], v98, s[12:15], s21 offen
  s_add_u32 s21, s88, 196608
  s_add_u32 s22, s81, 12288
  buffer_load_dwordx4 v[176:179], v46, s[12:15], s21 offen
  buffer_load_dwordx4 v[180:183], v47, s[12:15], s21 offen
  buffer_load_dwordx4 v[184:187], v48, s[12:15], s21 offen
  v_lshrrev_b32 v99, 2, v2
  v_lshl_add_u32 v99, v3, 3, v99
  v_mul_u32_u24 v99, 96, v99
  v_and_b32 v100, 3, v2
  v_lshlrev_b32 v100, 3, v100
  v_add3_u32 v99, v99, v100, s81
  v_lshlrev_b32 v100, 4, v1
  v_add_u32 v100, s81, v100
  v_and_b32 v236, 7, v2
  v_lshrrev_b32 v237, 3, v2
  v_lshlrev_b32 v238, 7, v3
  v_lshl_add_u32 v238, v236, 4, v238
  v_lshlrev_b32 v16, 4, v1
  v_mul_u32_u24 v244, 1280, v236
  s_mul_i32 s21, s20, 320
  v_add_u32 v244, s21, v244
  v_lshrrev_b32 v245, 3, v1
  v_mul_u32_u24 v245, 40, v245
  v_add_u32 v244, v244, v245
  s_lshr_b32 s21, s20, 1
  s_lshl_b32 s21, s21, 14
  s_and_b32 s22, s20, 1
  s_mul_i32 s22, s22, 3072
  s_add_u32 s21, s21, s22
  v_add_u32 v4, s21, v16
  v_mov_b32 v239, 0x4444
  v_mov_b32 v240, 0xeeee
  v_cmp_eq_u32 vcc, 1, v237
  s_nop 1
  v_cndmask_b32 v44, v239, v240, vcc
  v_cmp_gt_u32 vcc, 2, v3
  s_nop 1
  v_cndmask_b32 v89, 0, 1.0, vcc
  v_lshrrev_b32 v239, 2, v2
  v_mul_u32_u24 v239, 272, v239
  v_lshl_add_u32 v239, v3, 6, v239
  v_and_b32 v240, 3, v2
  v_lshl_add_u32 v239, v240, 2, v239
  s_mul_i32 s21, s20, 5440
  v_add_u32 v5, s21, v239
  v_mul_u32_u24 v239, 272, v3
  v_lshl_add_u32 v6, v2, 4, v239
  v_lshl_add_u32 v239, v236, 4, v239
  v_mul_u32_u24 v240, 10880, v237
  v_add_u32 v45, v239, v240
  s_lshl_b32 s21, s50, 4
  s_add_u32 s21, s21, s51
  s_lshl_b32 s21, s21, 9
  s_lshl_b32 s22, s20, 7
  s_add_u32 s21, s21, s22
  s_add_u32 s21, s21, 81920
  v_and_b32 v239, 1, v3
  v_lshlrev_b32 v239, 8, v239
  v_lshl_add_u32 v239, v236, 4, v239
  v_lshrrev_b32 v240, 1, v3
  v_lshl_add_u32 v239, v240, 3, v239
  v_add_u32 v7, s21, v239
  s_lshl_b32 s22, s58, 9
  s_lshl_b32 s23, s56, 7
  s_add_u32 s22, s22, s23
  s_add_u32 s22, s22, 376704
  v_lshlrev_b32 v239, 6, v3
  v_lshl_add_u32 v239, v236, 3, v239
  v_add_u32 v239, s22, v239
  s_cmp_eq_u32 s20, 2
  s_cselect_b64 vcc, -1, 0
  v_cndmask_b32 v7, v7, v239, vcc
  s_lshl_b32 s21, s59, 11
  s_add_u32 s21, s21, 81920
  v_add_u32 v8, s21, v16
  s_lshl_b32 s21, s59, 9
  s_add_u32 s21, s21, 376832
  v_lshl_add_u32 v9, v1, 3, s21
  s_mul_i32 s21, s59, 3072
  s_add_u32 s21, s21, 278528
  v_and_b32 v239, 0x39, v1
  v_bfe_u32 v240, v1, 1, 1
  v_lshl_or_b32 v239, v240, 2, v239
  v_bfe_u32 v240, v1, 2, 1
  v_lshl_or_b32 v239, v240, 1, v239
  v_lshl_add_u32 v10, v239, 4, s21
  s_cmp_eq_u32 s20, 3
  s_cselect_b32 s22, s84, s56
  s_mul_i32 s22, s22, 12
  v_add_u32 v239, s22, v3
  v_add3_u32 v240, 0, v239, v3
  v_lshrrev_b32 v241, 1, v240
  v_and_b32 v240, 1, v240
  v_lshlrev_b32 v240, 3, v240
  v_lshl_add_u32 v242, v241, 7, v240
  v_lshl_add_u32 v242, v236, 4, v242
  s_mul_i32 s21, s58, 3072
  v_add_u32 v21, s21, v242
  v_lshl_add_u32 v242, v241, 8, v240
  v_lshl_add_u32 v242, v2, 4, v242
  s_mul_i32 s21, s58, 12288
  s_and_b32 s22, s20, 1
  s_mul_i32 s22, s22, 6144
  s_add_u32 s21, s21, s22
  v_add_u32 v18, s21, v242
  v_add3_u32 v240, 1, v239, v3
  v_lshrrev_b32 v241, 1, v240
  v_and_b32 v240, 1, v240
  v_lshlrev_b32 v240, 3, v240
  v_lshl_add_u32 v242, v241, 7, v240
  v_lshl_add_u32 v242, v236, 4, v242
  s_mul_i32 s21, s58, 3072
  v_add_u32 v22, s21, v242
  v_lshl_add_u32 v242, v241, 8, v240
  v_lshl_add_u32 v242, v2, 4, v242
  s_mul_i32 s21, s58, 12288
  s_and_b32 s22, s20, 1
  s_mul_i32 s22, s22, 6144
  s_add_u32 s21, s21, s22
  v_add_u32 v19, s21, v242
  v_add_u32 v240, 8, v239
  v_lshrrev_b32 v241, 1, v240
  v_and_b32 v240, 1, v240
  v_lshlrev_b32 v240, 3, v240
  v_lshl_add_u32 v242, v241, 7, v240
  v_lshl_add_u32 v242, v236, 4, v242
  s_mul_i32 s21, s58, 3072
  v_add_u32 v23, s21, v242
  v_lshl_add_u32 v242, v241, 8, v240
  v_lshl_add_u32 v242, v2, 4, v242
  s_mul_i32 s21, s58, 12288
  s_and_b32 s22, s20, 1
  s_mul_i32 s22, s22, 6144
  s_add_u32 s21, s21, s22
  v_add_u32 v20, s21, v242
  v_cmp_eq_u32 vcc, 1, v237
  s_nop 1
  v_cndmask_b32 v25, v21, v22, vcc
  v_add_u32 v24, 278528, v25
  s_mul_i32 s21, s20, 3072
  s_add_u32 s21, s21, 22528
  v_add_u32 v11, s21, v16
  v_and_b32 v239, 3, v1
  s_lshl_b32 s21, s20, 2
  v_add_u32 v240, s21, v239
  v_cmp_eq_u32 vcc, 10, v240
  s_nop 1
  v_cndmask_b32 v240, v240, 7, vcc
  v_cmp_eq_u32 vcc, 3, v239
  v_lshrrev_b32 v241, 5, v1
  v_mul_u32_u24 v241, 10, v241
  v_cndmask_b32 v240, v240, 3, vcc
  s_lshl_b32 s21, s79, 2
  v_add3_u32 v240, v240, v241, s21
  v_lshrrev_b32 v241, 1, v240
  v_lshlrev_b32 v241, 8, v241
  v_and_b32 v240, 1, v240
  v_lshl_add_u32 v241, v240, 3, v241
  v_bfe_u32 v240, v1, 2, 3
  v_lshl_add_u32 v241, v240, 4, v241
  v_add_u32 v12, 22528, v241
  s_mov_b32 s21, 0x07060100
  s_cmp_eq_u32 s20, 1
  s_cselect_b32 s21, 0x07060302, s21
  s_cmp_eq_u32 s20, 2
  s_cselect_b32 s21, 0x07060c0c, s21
  v_mov_b32 v240, s21
  v_mov_b32 v241, 0x03020100
  v_cndmask_b32 v14, v241, v240, vcc
  s_lshr_b32 s21, s85, 3
  s_lshl_b32 s21, s21, 14
  s_bfe_u32 s22, s85, 0x10002
  s_mul_i32 s22, s22, 3072
  s_add_u32 s21, s21, s22
  s_and_b32 s22, s85, 3
  s_lshl_b32 s22, s22, 8
  s_add_u32 s21, s21, s22
  s_lshl_b32 s22, s20, 10
  s_add_u32 s22, s22, s21
  v_lshl_add_u32 v13, v1, 2, s22
  v_lshlrev_b32 v240, 10, v3
  v_lshl_add_u32 v240, v2, 4, v240
  v_add_u32 v240, s21, v240
  s_cmp_eq_u32 s20, 3
  s_cselect_b64 vcc, -1, 0
  v_cndmask_b32 v13, v13, v240, vcc
  s_mov_b32 s91, 0x3c000000
  v_and_b32 v240, 1, v3
  v_lshrrev_b32 v241, 1, v3
  v_lshl_add_u32 v240, v240, 1, v241
  v_lshlrev_b32 v240, 8, v240
  v_lshl_add_u32 v240, v2, 4, v240
  s_mul_i32 s21, s59, 10240
  s_lshl_b32 s22, s87, 8
  s_add_u32 s21, s21, s22
  v_add_u32 v15, s21, v240
  s_lshl_b32 s21, s79, 4
  s_lshl_b32 s76, -1, s21
  s_mov_b32 s77, 0xffff
  s_lshl_b32 s21, s79, 7
  v_or_b32 v17, s21, v16
  s_or_b32 s21, s21, 0xffffff7f
  v_and_b32 v26, s21, v16
  v_mov_b32 v243, 0
  s_mul_i32 s89, s59, 12288
  s_add_u32 s89, s89, 25165824
  v_cmp_gt_u32 s[60:61], 8, v2
  v_cmp_le_u32 s[62:63], 8, v2
  v_cmp_le_u32 s[72:73], 2, v3
  v_cmp_gt_u32 s[70:71], 48, v1
  s_nop 1
  s_and_b64 s[64:65], s[60:61], s[72:73]
  s_cmp_eq_u32 s20, 2
  s_cselect_b64 s[74:75], s[64:65], s[60:61]
  s_mul_i32 s89, s59, 12288
  s_add_u32 s89, s89, 25165824
  s_not_b64 s[48:49], s[72:73]
  v_mov_b32 v27, 10923
  v_mov_b32 v49, v100
  v_add_u32 v113, 576, v1
  v_mul_u32_u24 v103, v113, v27
  v_lshrrev_b32 v103, 16, v103
  v_mul_u32_u24 v102, 6, v103
  v_sub_u32 v113, v113, v102
  v_bfe_u32 v102, v103, 1, 1
  v_lshlrev_b32 v102, 3, v102
  v_and_b32 v127, 12, v103
  v_lshrrev_b32 v127, 1, v127
  v_and_b32 v103, 0xfffffff1, v103
  v_or3_b32 v103, v103, v102, v127
  v_mul_u32_u24 v102, 1366, v103
  v_lshrrev_b32 v102, 16, v102
  v_mul_u32_u24 v100, 48, v102
  v_sub_u32 v103, v103, v100
  v_cmp_gt_u32 vcc, 32, v103
  v_bfe_u32 v101, v103, 3, 2
  v_and_b32 v126, 3, v103
  v_lshl_add_u32 v126, v101, 2, v126
  v_bfe_u32 v101, v103, 2, 1
  v_lshl_add_u32 v126, v101, 4, v126
  v_cndmask_b32 v103, v103, v126, vcc
  v_add_u32 v100, v100, v103
  v_mul_u32_u24 v100, 1280, v100
  v_lshl_add_u32 v113, v113, 4, v100
  v_add_u32 v114, 640, v1
  v_mul_u32_u24 v103, v114, v27
  v_lshrrev_b32 v103, 16, v103
  v_mul_u32_u24 v102, 6, v103
  v_sub_u32 v114, v114, v102
  v_bfe_u32 v102, v103, 1, 1
  v_lshlrev_b32 v102, 3, v102
  v_and_b32 v127, 12, v103
  v_lshrrev_b32 v127, 1, v127
  v_and_b32 v103, 0xfffffff1, v103
  v_or3_b32 v103, v103, v102, v127
  v_mul_u32_u24 v102, 1366, v103
  v_lshrrev_b32 v102, 16, v102
  v_mul_u32_u24 v100, 48, v102
  v_sub_u32 v103, v103, v100
  v_cmp_gt_u32 vcc, 32, v103
  v_bfe_u32 v101, v103, 3, 2
  v_and_b32 v126, 3, v103
  v_lshl_add_u32 v126, v101, 2, v126
  v_bfe_u32 v101, v103, 2, 1
  v_lshl_add_u32 v126, v101, 4, v126
  v_cndmask_b32 v103, v103, v126, vcc
  v_add_u32 v100, v100, v103
  v_mul_u32_u24 v100, 1280, v100
  v_lshl_add_u32 v114, v114, 4, v100
  v_add_u32 v115, 704, v1
  v_mul_u32_u24 v103, v115, v27
  v_lshrrev_b32 v103, 16, v103
  v_mul_u32_u24 v102, 6, v103
  v_sub_u32 v115, v115, v102
  v_bfe_u32 v102, v103, 1, 1
  v_lshlrev_b32 v102, 3, v102
  v_and_b32 v127, 12, v103
  v_lshrrev_b32 v127, 1, v127
  v_and_b32 v103, 0xfffffff1, v103
  v_or3_b32 v103, v103, v102, v127
  v_mul_u32_u24 v102, 1366, v103
  v_lshrrev_b32 v102, 16, v102
  v_mul_u32_u24 v100, 48, v102
  v_sub_u32 v103, v103, v100
  v_cmp_gt_u32 vcc, 32, v103
  v_bfe_u32 v101, v103, 3, 2
  v_and_b32 v126, 3, v103
  v_lshl_add_u32 v126, v101, 2, v126
  v_bfe_u32 v101, v103, 2, 1
  v_lshl_add_u32 v126, v101, 4, v126
  v_cndmask_b32 v103, v103, v126, vcc
  v_add_u32 v100, v100, v103
  v_mul_u32_u24 v100, 1280, v100
  v_lshl_add_u32 v115, v115, 4, v100
  v_add_u32 v116, 768, v1
  v_mul_u32_u24 v103, v116, v27
  v_lshrrev_b32 v103, 16, v103
  v_mul_u32_u24 v102, 6, v103
  v_sub_u32 v116, v116, v102
  v_bfe_u32 v102, v103, 1, 1
  v_lshlrev_b32 v102, 3, v102
  v_and_b32 v127, 12, v103
  v_lshrrev_b32 v127, 1, v127
  v_and_b32 v103, 0xfffffff1, v103
  v_or3_b32 v103, v103, v102, v127
  v_mul_u32_u24 v102, 1366, v103
  v_lshrrev_b32 v102, 16, v102
  v_mul_u32_u24 v100, 48, v102
  v_sub_u32 v103, v103, v100
  v_cmp_gt_u32 vcc, 32, v103
  v_bfe_u32 v101, v103, 3, 2
  v_and_b32 v126, 3, v103
  v_lshl_add_u32 v126, v101, 2, v126
  v_bfe_u32 v101, v103, 2, 1
  v_lshl_add_u32 v126, v101, 4, v126
  v_cndmask_b32 v103, v103, v126, vcc
  v_add_u32 v100, v100, v103
  v_mul_u32_u24 v100, 1280, v100
  v_lshl_add_u32 v116, v116, 4, v100
  v_add_u32 v117, 832, v1
  v_mul_u32_u24 v103, v117, v27
  v_lshrrev_b32 v103, 16, v103
  v_mul_u32_u24 v102, 6, v103
  v_sub_u32 v117, v117, v102
  v_bfe_u32 v102, v103, 1, 1
  v_lshlrev_b32 v102, 3, v102
  v_and_b32 v127, 12, v103
  v_lshrrev_b32 v127, 1, v127
  v_and_b32 v103, 0xfffffff1, v103
  v_or3_b32 v103, v103, v102, v127
  v_mul_u32_u24 v102, 1366, v103
  v_lshrrev_b32 v102, 16, v102
  v_mul_u32_u24 v100, 48, v102
  v_sub_u32 v103, v103, v100
  v_cmp_gt_u32 vcc, 32, v103
  v_bfe_u32 v101, v103, 3, 2
  v_and_b32 v126, 3, v103
  v_lshl_add_u32 v126, v101, 2, v126
  v_bfe_u32 v101, v103, 2, 1
  v_lshl_add_u32 v126, v101, 4, v126
  v_cndmask_b32 v103, v103, v126, vcc
  v_add_u32 v100, v100, v103
  v_mul_u32_u24 v100, 1280, v100
  v_lshl_add_u32 v117, v117, 4, v100
  v_add_u32 v118, 896, v1
  v_mul_u32_u24 v103, v118, v27
  v_lshrrev_b32 v103, 16, v103
  v_mul_u32_u24 v102, 6, v103
  v_sub_u32 v118, v118, v102
  v_bfe_u32 v102, v103, 1, 1
  v_lshlrev_b32 v102, 3, v102
  v_and_b32 v127, 12, v103
  v_lshrrev_b32 v127, 1, v127
  v_and_b32 v103, 0xfffffff1, v103
  v_or3_b32 v103, v103, v102, v127
  v_mul_u32_u24 v102, 1366, v103
  v_lshrrev_b32 v102, 16, v102
  v_mul_u32_u24 v100, 48, v102
  v_sub_u32 v103, v103, v100
  v_cmp_gt_u32 vcc, 32, v103
  v_bfe_u32 v101, v103, 3, 2
  v_and_b32 v126, 3, v103
  v_lshl_add_u32 v126, v101, 2, v126
  v_bfe_u32 v101, v103, 2, 1
  v_lshl_add_u32 v126, v101, 4, v126
  v_cndmask_b32 v103, v103, v126, vcc
  v_add_u32 v100, v100, v103
  v_mul_u32_u24 v100, 1280, v100
  v_lshl_add_u32 v118, v118, 4, v100
  v_add_u32 v119, 960, v1
  v_mul_u32_u24 v103, v119, v27
  v_lshrrev_b32 v103, 16, v103
  v_mul_u32_u24 v102, 6, v103
  v_sub_u32 v119, v119, v102
  v_bfe_u32 v102, v103, 1, 1
  v_lshlrev_b32 v102, 3, v102
  v_and_b32 v127, 12, v103
  v_lshrrev_b32 v127, 1, v127
  v_and_b32 v103, 0xfffffff1, v103
  v_or3_b32 v103, v103, v102, v127
  v_mul_u32_u24 v102, 1366, v103
  v_lshrrev_b32 v102, 16, v102
  v_mul_u32_u24 v100, 48, v102
  v_sub_u32 v103, v103, v100
  v_cmp_gt_u32 vcc, 32, v103
  v_bfe_u32 v101, v103, 3, 2
  v_and_b32 v126, 3, v103
  v_lshl_add_u32 v126, v101, 2, v126
  v_bfe_u32 v101, v103, 2, 1
  v_lshl_add_u32 v126, v101, 4, v126
  v_cndmask_b32 v103, v103, v126, vcc
  v_add_u32 v100, v100, v103
  v_mul_u32_u24 v100, 1280, v100
  v_lshl_add_u32 v119, v119, 4, v100
  v_add_u32 v120, 1024, v1
  v_mul_u32_u24 v103, v120, v27
  v_lshrrev_b32 v103, 16, v103
  v_mul_u32_u24 v102, 6, v103
  v_sub_u32 v120, v120, v102
  v_bfe_u32 v102, v103, 1, 1
  v_lshlrev_b32 v102, 3, v102
  v_and_b32 v127, 12, v103
  v_lshrrev_b32 v127, 1, v127
  v_and_b32 v103, 0xfffffff1, v103
  v_or3_b32 v103, v103, v102, v127
  v_mul_u32_u24 v102, 1366, v103
  v_lshrrev_b32 v102, 16, v102
  v_mul_u32_u24 v100, 48, v102
  v_sub_u32 v103, v103, v100
  v_cmp_gt_u32 vcc, 32, v103
  v_bfe_u32 v101, v103, 3, 2
  v_and_b32 v126, 3, v103
  v_lshl_add_u32 v126, v101, 2, v126
  v_bfe_u32 v101, v103, 2, 1
  v_lshl_add_u32 v126, v101, 4, v126
  v_cndmask_b32 v103, v103, v126, vcc
  v_add_u32 v100, v100, v103
  v_mul_u32_u24 v100, 1280, v100
  v_lshl_add_u32 v120, v120, 4, v100
  v_add_u32 v121, 1088, v1
  v_mul_u32_u24 v103, v121, v27
  v_lshrrev_b32 v103, 16, v103
  v_mul_u32_u24 v102, 6, v103
  v_sub_u32 v121, v121, v102
  v_bfe_u32 v102, v103, 1, 1
  v_lshlrev_b32 v102, 3, v102
  v_and_b32 v127, 12, v103
  v_lshrrev_b32 v127, 1, v127
  v_and_b32 v103, 0xfffffff1, v103
  v_or3_b32 v103, v103, v102, v127
  v_mul_u32_u24 v102, 1366, v103
  v_lshrrev_b32 v102, 16, v102
  v_mul_u32_u24 v100, 48, v102
  v_sub_u32 v103, v103, v100
  v_cmp_gt_u32 vcc, 32, v103
  v_bfe_u32 v101, v103, 3, 2
  v_and_b32 v126, 3, v103
  v_lshl_add_u32 v126, v101, 2, v126
  v_bfe_u32 v101, v103, 2, 1
  v_lshl_add_u32 v126, v101, 4, v126
  v_cndmask_b32 v103, v103, v126, vcc
  v_add_u32 v100, v100, v103
  v_mul_u32_u24 v100, 1280, v100
  v_lshl_add_u32 v121, v121, 4, v100
  s_waitcnt vmcnt(63)
  s_mov_b32 s12, s42
  s_mov_b32 s13, s43
  s_mov_b32 s14, 7864320
  s_mov_b32 s15, 0x00020000
  buffer_load_dwordx4 v[188:191], v113, s[12:15], s82 offen
  buffer_load_dwordx4 v[192:195], v114, s[12:15], s82 offen
  buffer_load_dwordx4 v[196:199], v115, s[12:15], s82 offen
  buffer_load_dwordx4 v[200:203], v116, s[12:15], s82 offen
  buffer_load_dwordx4 v[204:207], v117, s[12:15], s82 offen
  buffer_load_dwordx4 v[208:211], v118, s[12:15], s82 offen
  buffer_load_dwordx4 v[212:215], v119, s[12:15], s82 offen
  buffer_load_dwordx4 v[216:219], v120, s[12:15], s82 offen
  buffer_load_dwordx4 v[220:223], v121, s[12:15], s82 offen
  v_add_u32 v104, 0, v1
  v_mul_u32_u24 v103, v104, v27
  v_lshrrev_b32 v103, 16, v103
  v_mul_u32_u24 v102, 6, v103
  v_sub_u32 v104, v104, v102
  v_bfe_u32 v102, v103, 1, 1
  v_lshlrev_b32 v102, 3, v102
  v_and_b32 v127, 12, v103
  v_lshrrev_b32 v127, 1, v127
  v_and_b32 v103, 0xfffffff1, v103
  v_or3_b32 v103, v103, v102, v127
  v_mul_u32_u24 v102, 1366, v103
  v_lshrrev_b32 v102, 16, v102
  v_mul_u32_u24 v100, 48, v102
  v_sub_u32 v103, v103, v100
  v_cmp_gt_u32 vcc, 32, v103
  v_bfe_u32 v101, v103, 3, 2
  v_and_b32 v126, 3, v103
  v_lshl_add_u32 v126, v101, 2, v126
  v_bfe_u32 v101, v103, 2, 1
  v_lshl_add_u32 v126, v101, 4, v126
  v_cndmask_b32 v103, v103, v126, vcc
  v_add_u32 v100, v100, v103
  v_mul_u32_u24 v100, 1280, v100
  v_lshl_add_u32 v104, v104, 4, v100
  v_add_u32 v105, 64, v1
  v_mul_u32_u24 v103, v105, v27
  v_lshrrev_b32 v103, 16, v103
  v_mul_u32_u24 v102, 6, v103
  v_sub_u32 v105, v105, v102
  v_bfe_u32 v102, v103, 1, 1
  v_lshlrev_b32 v102, 3, v102
  v_and_b32 v127, 12, v103
  v_lshrrev_b32 v127, 1, v127
  v_and_b32 v103, 0xfffffff1, v103
  v_or3_b32 v103, v103, v102, v127
  v_mul_u32_u24 v102, 1366, v103
  v_lshrrev_b32 v102, 16, v102
  v_mul_u32_u24 v100, 48, v102
  v_sub_u32 v103, v103, v100
  v_cmp_gt_u32 vcc, 32, v103
  v_bfe_u32 v101, v103, 3, 2
  v_and_b32 v126, 3, v103
  v_lshl_add_u32 v126, v101, 2, v126
  v_bfe_u32 v101, v103, 2, 1
  v_lshl_add_u32 v126, v101, 4, v126
  v_cndmask_b32 v103, v103, v126, vcc
  v_add_u32 v100, v100, v103
  v_mul_u32_u24 v100, 1280, v100
  v_lshl_add_u32 v105, v105, 4, v100
  v_add_u32 v106, 128, v1
  v_mul_u32_u24 v103, v106, v27
  v_lshrrev_b32 v103, 16, v103
  v_mul_u32_u24 v102, 6, v103
  v_sub_u32 v106, v106, v102
  v_bfe_u32 v102, v103, 1, 1
  v_lshlrev_b32 v102, 3, v102
  v_and_b32 v127, 12, v103
  v_lshrrev_b32 v127, 1, v127
  v_and_b32 v103, 0xfffffff1, v103
  v_or3_b32 v103, v103, v102, v127
  v_mul_u32_u24 v102, 1366, v103
  v_lshrrev_b32 v102, 16, v102
  v_mul_u32_u24 v100, 48, v102
  v_sub_u32 v103, v103, v100
  v_cmp_gt_u32 vcc, 32, v103
  v_bfe_u32 v101, v103, 3, 2
  v_and_b32 v126, 3, v103
  v_lshl_add_u32 v126, v101, 2, v126
  v_bfe_u32 v101, v103, 2, 1
  v_lshl_add_u32 v126, v101, 4, v126
  v_cndmask_b32 v103, v103, v126, vcc
  v_add_u32 v100, v100, v103
  v_mul_u32_u24 v100, 1280, v100
  v_lshl_add_u32 v106, v106, 4, v100
  v_add_u32 v107, 192, v1
  v_mul_u32_u24 v103, v107, v27
  v_lshrrev_b32 v103, 16, v103
  v_mul_u32_u24 v102, 6, v103
  v_sub_u32 v107, v107, v102
  v_bfe_u32 v102, v103, 1, 1
  v_lshlrev_b32 v102, 3, v102
  v_and_b32 v127, 12, v103
  v_lshrrev_b32 v127, 1, v127
  v_and_b32 v103, 0xfffffff1, v103
  v_or3_b32 v103, v103, v102, v127
  v_mul_u32_u24 v102, 1366, v103
  v_lshrrev_b32 v102, 16, v102
  v_mul_u32_u24 v100, 48, v102
  v_sub_u32 v103, v103, v100
  v_cmp_gt_u32 vcc, 32, v103
  v_bfe_u32 v101, v103, 3, 2
  v_and_b32 v126, 3, v103
  v_lshl_add_u32 v126, v101, 2, v126
  v_bfe_u32 v101, v103, 2, 1
  v_lshl_add_u32 v126, v101, 4, v126
  v_cndmask_b32 v103, v103, v126, vcc
  v_add_u32 v100, v100, v103
  v_mul_u32_u24 v100, 1280, v100
  v_lshl_add_u32 v107, v107, 4, v100
  v_add_u32 v108, 256, v1
  v_mul_u32_u24 v103, v108, v27
  v_lshrrev_b32 v103, 16, v103
  v_mul_u32_u24 v102, 6, v103
  v_sub_u32 v108, v108, v102
  v_bfe_u32 v102, v103, 1, 1
  v_lshlrev_b32 v102, 3, v102
  v_and_b32 v127, 12, v103
  v_lshrrev_b32 v127, 1, v127
  v_and_b32 v103, 0xfffffff1, v103
  v_or3_b32 v103, v103, v102, v127
  v_mul_u32_u24 v102, 1366, v103
  v_lshrrev_b32 v102, 16, v102
  v_mul_u32_u24 v100, 48, v102
  v_sub_u32 v103, v103, v100
  v_cmp_gt_u32 vcc, 32, v103
  v_bfe_u32 v101, v103, 3, 2
  v_and_b32 v126, 3, v103
  v_lshl_add_u32 v126, v101, 2, v126
  v_bfe_u32 v101, v103, 2, 1
  v_lshl_add_u32 v126, v101, 4, v126
  v_cndmask_b32 v103, v103, v126, vcc
  v_add_u32 v100, v100, v103
  v_mul_u32_u24 v100, 1280, v100
  v_lshl_add_u32 v108, v108, 4, v100
  v_add_u32 v109, 320, v1
  v_mul_u32_u24 v103, v109, v27
  v_lshrrev_b32 v103, 16, v103
  v_mul_u32_u24 v102, 6, v103
  v_sub_u32 v109, v109, v102
  v_bfe_u32 v102, v103, 1, 1
  v_lshlrev_b32 v102, 3, v102
  v_and_b32 v127, 12, v103
  v_lshrrev_b32 v127, 1, v127
  v_and_b32 v103, 0xfffffff1, v103
  v_or3_b32 v103, v103, v102, v127
  v_mul_u32_u24 v102, 1366, v103
  v_lshrrev_b32 v102, 16, v102
  v_mul_u32_u24 v100, 48, v102
  v_sub_u32 v103, v103, v100
  v_cmp_gt_u32 vcc, 32, v103
  v_bfe_u32 v101, v103, 3, 2
  v_and_b32 v126, 3, v103
  v_lshl_add_u32 v126, v101, 2, v126
  v_bfe_u32 v101, v103, 2, 1
  v_lshl_add_u32 v126, v101, 4, v126
  v_cndmask_b32 v103, v103, v126, vcc
  v_add_u32 v100, v100, v103
  v_mul_u32_u24 v100, 1280, v100
  v_lshl_add_u32 v109, v109, 4, v100
  v_add_u32 v110, 384, v1
  v_mul_u32_u24 v103, v110, v27
  v_lshrrev_b32 v103, 16, v103
  v_mul_u32_u24 v102, 6, v103
  v_sub_u32 v110, v110, v102
  v_bfe_u32 v102, v103, 1, 1
  v_lshlrev_b32 v102, 3, v102
  v_and_b32 v127, 12, v103
  v_lshrrev_b32 v127, 1, v127
  v_and_b32 v103, 0xfffffff1, v103
  v_or3_b32 v103, v103, v102, v127
  v_mul_u32_u24 v102, 1366, v103
  v_lshrrev_b32 v102, 16, v102
  v_mul_u32_u24 v100, 48, v102
  v_sub_u32 v103, v103, v100
  v_cmp_gt_u32 vcc, 32, v103
  v_bfe_u32 v101, v103, 3, 2
  v_and_b32 v126, 3, v103
  v_lshl_add_u32 v126, v101, 2, v126
  v_bfe_u32 v101, v103, 2, 1
  v_lshl_add_u32 v126, v101, 4, v126
  v_cndmask_b32 v103, v103, v126, vcc
  v_add_u32 v100, v100, v103
  v_mul_u32_u24 v100, 1280, v100
  v_lshl_add_u32 v110, v110, 4, v100
  v_add_u32 v111, 448, v1
  v_mul_u32_u24 v103, v111, v27
  v_lshrrev_b32 v103, 16, v103
  v_mul_u32_u24 v102, 6, v103
  v_sub_u32 v111, v111, v102
  v_bfe_u32 v102, v103, 1, 1
  v_lshlrev_b32 v102, 3, v102
  v_and_b32 v127, 12, v103
  v_lshrrev_b32 v127, 1, v127
  v_and_b32 v103, 0xfffffff1, v103
  v_or3_b32 v103, v103, v102, v127
  v_mul_u32_u24 v102, 1366, v103
  v_lshrrev_b32 v102, 16, v102
  v_mul_u32_u24 v100, 48, v102
  v_sub_u32 v103, v103, v100
  v_cmp_gt_u32 vcc, 32, v103
  v_bfe_u32 v101, v103, 3, 2
  v_and_b32 v126, 3, v103
  v_lshl_add_u32 v126, v101, 2, v126
  v_bfe_u32 v101, v103, 2, 1
  v_lshl_add_u32 v126, v101, 4, v126
  v_cndmask_b32 v103, v103, v126, vcc
  v_add_u32 v100, v100, v103
  v_mul_u32_u24 v100, 1280, v100
  v_lshl_add_u32 v111, v111, 4, v100
  v_add_u32 v112, 512, v1
  v_mul_u32_u24 v103, v112, v27
  v_lshrrev_b32 v103, 16, v103
  v_mul_u32_u24 v102, 6, v103
  v_sub_u32 v112, v112, v102
  v_bfe_u32 v102, v103, 1, 1
  v_lshlrev_b32 v102, 3, v102
  v_and_b32 v127, 12, v103
  v_lshrrev_b32 v127, 1, v127
  v_and_b32 v103, 0xfffffff1, v103
  v_or3_b32 v103, v103, v102, v127
  v_mul_u32_u24 v102, 1366, v103
  v_lshrrev_b32 v102, 16, v102
  v_mul_u32_u24 v100, 48, v102
  v_sub_u32 v103, v103, v100
  v_cmp_gt_u32 vcc, 32, v103
  v_bfe_u32 v101, v103, 3, 2
  v_and_b32 v126, 3, v103
  v_lshl_add_u32 v126, v101, 2, v126
  v_bfe_u32 v101, v103, 2, 1
  v_lshl_add_u32 v126, v101, 4, v126
  v_cndmask_b32 v103, v103, v126, vcc
  v_add_u32 v100, v100, v103
  v_mul_u32_u24 v100, 1280, v100
  v_lshl_add_u32 v112, v112, 4, v100
  s_waitcnt vmcnt(63)
  s_mov_b32 s12, s42
  s_mov_b32 s13, s43
  s_mov_b32 s14, 7864320
  s_mov_b32 s15, 0x00020000
  s_add_u32 m0, s81, 30720
  s_nop 0
  buffer_load_dwordx4 v104, s[12:15], s82 offen lds
  s_add_u32 m0, s81, 31744
  s_nop 0
  buffer_load_dwordx4 v105, s[12:15], s82 offen lds
  s_add_u32 m0, s81, 32768
  s_nop 0
  buffer_load_dwordx4 v106, s[12:15], s82 offen lds
  s_add_u32 m0, s81, 33792
  s_nop 0
  buffer_load_dwordx4 v107, s[12:15], s82 offen lds
  s_add_u32 m0, s81, 34816
  s_nop 0
  buffer_load_dwordx4 v108, s[12:15], s82 offen lds
  s_add_u32 m0, s81, 35840
  s_nop 0
  buffer_load_dwordx4 v109, s[12:15], s82 offen lds
  s_add_u32 m0, s81, 36864
  s_nop 0
  buffer_load_dwordx4 v110, s[12:15], s82 offen lds
  s_add_u32 m0, s81, 37888
  s_nop 0
  buffer_load_dwordx4 v111, s[12:15], s82 offen lds
  s_add_u32 m0, s81, 38912
  s_nop 0
  buffer_load_dwordx4 v112, s[12:15], s82 offen lds
  buffer_load_dwordx4 v[32:35], v244, s[28:31], 0 offen offset:0
  buffer_load_dwordx4 v[36:39], v244, s[28:31], 0 offen offset:16
  buffer_load_dwordx2 v[40:41], v244, s[28:31], 0 offen offset:32
  s_waitcnt vmcnt(63)
  s_mov_b32 s12, s36
  s_mov_b32 s13, s37
  s_mov_b32 s14, 7864320
  s_mov_b32 s15, 0x00020000
  s_add_u32 s21, s80, 0
  s_add_u32 s22, s81, 15360
  s_add_u32 m0, s22, 0
  s_nop 0
  buffer_load_dwordx4 v96, s[12:15], s21 offen lds
  s_add_u32 m0, s22, 1024
  s_nop 0
  buffer_load_dwordx4 v97, s[12:15], s21 offen lds
  s_add_u32 m0, s22, 2048
  s_nop 0
  buffer_load_dwordx4 v98, s[12:15], s21 offen lds
  s_waitcnt vmcnt(63)
  s_mov_b32 s12, s36
  s_mov_b32 s13, s37
  s_mov_b32 s14, 7864320
  s_mov_b32 s15, 0x00020000
  s_add_u32 s21, s80, 983040
  s_add_u32 s22, s81, 18432
  s_add_u32 m0, s22, 0
  s_nop 0
  buffer_load_dwordx4 v96, s[12:15], s21 offen lds
  s_add_u32 m0, s22, 1024
  s_nop 0
  buffer_load_dwordx4 v97, s[12:15], s21 offen lds
  s_add_u32 m0, s22, 2048
  s_nop 0
  buffer_load_dwordx4 v98, s[12:15], s21 offen lds
  s_waitcnt vmcnt(63)
  s_mov_b32 s12, s36
  s_mov_b32 s13, s37
  s_mov_b32 s14, 7864320
  s_mov_b32 s15, 0x00020000
  s_add_u32 s21, s80, 98304
  s_add_u32 s22, s81, 21504
  s_add_u32 m0, s22, 0
  s_nop 0
  buffer_load_dwordx4 v96, s[12:15], s21 offen lds
  s_add_u32 m0, s22, 1024
  s_nop 0
  buffer_load_dwordx4 v97, s[12:15], s21 offen lds
  s_add_u32 m0, s22, 2048
  s_nop 0
  buffer_load_dwordx4 v98, s[12:15], s21 offen lds
  s_waitcnt vmcnt(63)
  s_mov_b32 s12, s36
  s_mov_b32 s13, s37
  s_mov_b32 s14, 7864320
  s_mov_b32 s15, 0x00020000
  s_add_u32 s21, s80, 1081344
  s_add_u32 s22, s81, 24576
  s_add_u32 m0, s22, 0
  s_nop 0
  buffer_load_dwordx4 v96, s[12:15], s21 offen lds
  s_add_u32 m0, s22, 1024
  s_nop 0
  buffer_load_dwordx4 v97, s[12:15], s21 offen lds
  s_add_u32 m0, s22, 2048
  s_nop 0
  buffer_load_dwordx4 v98, s[12:15], s21 offen lds
  s_waitcnt vmcnt(63)
  s_mov_b32 s12, s36
  s_mov_b32 s13, s37
  s_mov_b32 s14, 7864320
  s_mov_b32 s15, 0x00020000
  s_add_u32 s21, s80, 196608
  s_add_u32 s22, s81, 27648
  s_add_u32 m0, s22, 0
  s_nop 0
  buffer_load_dwordx4 v46, s[12:15], s21 offen lds
  s_add_u32 m0, s22, 1024
  s_nop 0
  buffer_load_dwordx4 v47, s[12:15], s21 offen lds
  s_add_u32 m0, s22, 2048
  s_nop 0
  buffer_load_dwordx4 v48, s[12:15], s21 offen lds
  v_mov_b32 v100, v49
  v_lshlrev_b32 v239, 2, v1
  s_waitcnt vmcnt(51)
  ds_read_b64_tr_b16 v[52:53], v99 offset:0
  ds_read_b64_tr_b16 v[54:55], v99 offset:384
  ds_read_b64_tr_b16 v[56:57], v99 offset:32
  ds_read_b64_tr_b16 v[58:59], v99 offset:416
  ds_read_b64_tr_b16 v[60:61], v99 offset:64
  ds_read_b64_tr_b16 v[62:63], v99 offset:448
  ds_read_b64_tr_b16 v[64:65], v99 offset:3072
  ds_read_b64_tr_b16 v[66:67], v99 offset:3456
  ds_read_b64_tr_b16 v[68:69], v99 offset:3104
  ds_read_b64_tr_b16 v[70:71], v99 offset:3488
  ds_read_b64_tr_b16 v[72:73], v99 offset:3136
  ds_read_b64_tr_b16 v[74:75], v99 offset:3520
  ds_read_b64_tr_b16 v[76:77], v99 offset:6144
  ds_read_b64_tr_b16 v[78:79], v99 offset:6528
  ds_read_b64_tr_b16 v[80:81], v99 offset:6176
  ds_read_b64_tr_b16 v[82:83], v99 offset:6560
  ds_read_b64_tr_b16 v[84:85], v99 offset:6208
  ds_read_b64_tr_b16 v[86:87], v99 offset:6592
  s_waitcnt lgkmcnt(12)
  v_lshlrev_b32 v50, 16, v52
  v_and_b32 v52, 0xffff0000, v52
  v_cvt_pk_f16_f32 v52, v50, v52
  v_accvgpr_write_b32 a60, v52
  v_lshlrev_b32 v50, 16, v53
  v_and_b32 v53, 0xffff0000, v53
  v_cvt_pk_f16_f32 v53, v50, v53
  v_accvgpr_write_b32 a61, v53
  v_lshlrev_b32 v50, 16, v54
  v_and_b32 v54, 0xffff0000, v54
  v_cvt_pk_f16_f32 v54, v50, v54
  v_accvgpr_write_b32 a62, v54
  v_lshlrev_b32 v50, 16, v55
  v_and_b32 v55, 0xffff0000, v55
  v_cvt_pk_f16_f32 v55, v50, v55
  v_accvgpr_write_b32 a63, v55
  v_lshlrev_b32 v50, 16, v56
  v_and_b32 v56, 0xffff0000, v56
  v_cvt_pk_f16_f32 v56, v50, v56
  v_accvgpr_write_b32 a80, v56
  v_lshlrev_b32 v50, 16, v57
  v_and_b32 v57, 0xffff0000, v57
  v_cvt_pk_f16_f32 v57, v50, v57
  v_accvgpr_write_b32 a81, v57
  v_lshlrev_b32 v50, 16, v58
  v_and_b32 v58, 0xffff0000, v58
  v_cvt_pk_f16_f32 v58, v50, v58
  v_accvgpr_write_b32 a82, v58
  v_lshlrev_b32 v50, 16, v59
  v_and_b32 v59, 0xffff0000, v59
  v_cvt_pk_f16_f32 v59, v50, v59
  v_accvgpr_write_b32 a83, v59
  v_lshlrev_b32 v50, 16, v60
  v_and_b32 v60, 0xffff0000, v60
  v_cvt_pk_f16_f32 v60, v50, v60
  v_accvgpr_write_b32 a100, v60
  v_lshlrev_b32 v50, 16, v61
  v_and_b32 v61, 0xffff0000, v61
  v_cvt_pk_f16_f32 v61, v50, v61
  v_accvgpr_write_b32 a101, v61
  v_lshlrev_b32 v50, 16, v62
  v_and_b32 v62, 0xffff0000, v62
  v_cvt_pk_f16_f32 v62, v50, v62
  v_accvgpr_write_b32 a102, v62
  v_lshlrev_b32 v50, 16, v63
  v_and_b32 v63, 0xffff0000, v63
  v_cvt_pk_f16_f32 v63, v50, v63
  v_accvgpr_write_b32 a103, v63
  ds_read_b64_tr_b16 v[52:53], v99 offset:9216
  ds_read_b64_tr_b16 v[54:55], v99 offset:9600
  ds_read_b64_tr_b16 v[56:57], v99 offset:9248
  ds_read_b64_tr_b16 v[58:59], v99 offset:9632
  ds_read_b64_tr_b16 v[60:61], v99 offset:9280
  ds_read_b64_tr_b16 v[62:63], v99 offset:9664
  s_waitcnt lgkmcnt(12)
  v_lshlrev_b32 v50, 16, v64
  v_and_b32 v64, 0xffff0000, v64
  v_cvt_pk_f16_f32 v64, v50, v64
  v_accvgpr_write_b32 a64, v64
  v_lshlrev_b32 v50, 16, v65
  v_and_b32 v65, 0xffff0000, v65
  v_cvt_pk_f16_f32 v65, v50, v65
  v_accvgpr_write_b32 a65, v65
  v_lshlrev_b32 v50, 16, v66
  v_and_b32 v66, 0xffff0000, v66
  v_cvt_pk_f16_f32 v66, v50, v66
  v_accvgpr_write_b32 a66, v66
  v_lshlrev_b32 v50, 16, v67
  v_and_b32 v67, 0xffff0000, v67
  v_cvt_pk_f16_f32 v67, v50, v67
  v_accvgpr_write_b32 a67, v67
  v_lshlrev_b32 v50, 16, v68
  v_and_b32 v68, 0xffff0000, v68
  v_cvt_pk_f16_f32 v68, v50, v68
  v_accvgpr_write_b32 a84, v68
  v_lshlrev_b32 v50, 16, v69
  v_and_b32 v69, 0xffff0000, v69
  v_cvt_pk_f16_f32 v69, v50, v69
  v_accvgpr_write_b32 a85, v69
  v_lshlrev_b32 v50, 16, v70
  v_and_b32 v70, 0xffff0000, v70
  v_cvt_pk_f16_f32 v70, v50, v70
  v_accvgpr_write_b32 a86, v70
  v_lshlrev_b32 v50, 16, v71
  v_and_b32 v71, 0xffff0000, v71
  v_cvt_pk_f16_f32 v71, v50, v71
  v_accvgpr_write_b32 a87, v71
  v_lshlrev_b32 v50, 16, v72
  v_and_b32 v72, 0xffff0000, v72
  v_cvt_pk_f16_f32 v72, v50, v72
  v_accvgpr_write_b32 a104, v72
  v_lshlrev_b32 v50, 16, v73
  v_and_b32 v73, 0xffff0000, v73
  v_cvt_pk_f16_f32 v73, v50, v73
  v_accvgpr_write_b32 a105, v73
  v_lshlrev_b32 v50, 16, v74
  v_and_b32 v74, 0xffff0000, v74
  v_cvt_pk_f16_f32 v74, v50, v74
  v_accvgpr_write_b32 a106, v74
  v_lshlrev_b32 v50, 16, v75
  v_and_b32 v75, 0xffff0000, v75
  v_cvt_pk_f16_f32 v75, v50, v75
  v_accvgpr_write_b32 a107, v75
  ds_read_b64_tr_b16 v[64:65], v99 offset:12288
  ds_read_b64_tr_b16 v[66:67], v99 offset:12672
  ds_read_b64_tr_b16 v[68:69], v99 offset:12320
  ds_read_b64_tr_b16 v[70:71], v99 offset:12704
  ds_read_b64_tr_b16 v[72:73], v99 offset:12352
  ds_read_b64_tr_b16 v[74:75], v99 offset:12736
  s_waitcnt lgkmcnt(12)
  v_lshlrev_b32 v50, 16, v76
  v_and_b32 v76, 0xffff0000, v76
  v_cvt_pk_f16_f32 v76, v50, v76
  v_accvgpr_write_b32 a68, v76
  v_lshlrev_b32 v50, 16, v77
  v_and_b32 v77, 0xffff0000, v77
  v_cvt_pk_f16_f32 v77, v50, v77
  v_accvgpr_write_b32 a69, v77
  v_lshlrev_b32 v50, 16, v78
  v_and_b32 v78, 0xffff0000, v78
  v_cvt_pk_f16_f32 v78, v50, v78
  v_accvgpr_write_b32 a70, v78
  v_lshlrev_b32 v50, 16, v79
  v_and_b32 v79, 0xffff0000, v79
  v_cvt_pk_f16_f32 v79, v50, v79
  v_accvgpr_write_b32 a71, v79
  v_lshlrev_b32 v50, 16, v80
  v_and_b32 v80, 0xffff0000, v80
  v_cvt_pk_f16_f32 v80, v50, v80
  v_accvgpr_write_b32 a88, v80
  v_lshlrev_b32 v50, 16, v81
  v_and_b32 v81, 0xffff0000, v81
  v_cvt_pk_f16_f32 v81, v50, v81
  v_accvgpr_write_b32 a89, v81
  v_lshlrev_b32 v50, 16, v82
  v_and_b32 v82, 0xffff0000, v82
  v_cvt_pk_f16_f32 v82, v50, v82
  v_accvgpr_write_b32 a90, v82
  v_lshlrev_b32 v50, 16, v83
  v_and_b32 v83, 0xffff0000, v83
  v_cvt_pk_f16_f32 v83, v50, v83
  v_accvgpr_write_b32 a91, v83
  v_lshlrev_b32 v50, 16, v84
  v_and_b32 v84, 0xffff0000, v84
  v_cvt_pk_f16_f32 v84, v50, v84
  v_accvgpr_write_b32 a108, v84
  v_lshlrev_b32 v50, 16, v85
  v_and_b32 v85, 0xffff0000, v85
  v_cvt_pk_f16_f32 v85, v50, v85
  v_accvgpr_write_b32 a109, v85
  v_lshlrev_b32 v50, 16, v86
  v_and_b32 v86, 0xffff0000, v86
  v_cvt_pk_f16_f32 v86, v50, v86
  v_accvgpr_write_b32 a110, v86
  v_lshlrev_b32 v50, 16, v87
  v_and_b32 v87, 0xffff0000, v87
  v_cvt_pk_f16_f32 v87, v50, v87
  v_accvgpr_write_b32 a111, v87
  s_waitcnt lgkmcnt(6)
  v_lshlrev_b32 v50, 16, v52
  v_and_b32 v52, 0xffff0000, v52
  v_cvt_pk_f16_f32 v52, v50, v52
  v_accvgpr_write_b32 a72, v52
  v_lshlrev_b32 v50, 16, v53
  v_and_b32 v53, 0xffff0000, v53
  v_cvt_pk_f16_f32 v53, v50, v53
  v_accvgpr_write_b32 a73, v53
  v_lshlrev_b32 v50, 16, v54
  v_and_b32 v54, 0xffff0000, v54
  v_cvt_pk_f16_f32 v54, v50, v54
  v_accvgpr_write_b32 a74, v54
  v_lshlrev_b32 v50, 16, v55
  v_and_b32 v55, 0xffff0000, v55
  v_cvt_pk_f16_f32 v55, v50, v55
  v_accvgpr_write_b32 a75, v55
  v_lshlrev_b32 v50, 16, v56
  v_and_b32 v56, 0xffff0000, v56
  v_cvt_pk_f16_f32 v56, v50, v56
  v_accvgpr_write_b32 a92, v56
  v_lshlrev_b32 v50, 16, v57
  v_and_b32 v57, 0xffff0000, v57
  v_cvt_pk_f16_f32 v57, v50, v57
  v_accvgpr_write_b32 a93, v57
  v_lshlrev_b32 v50, 16, v58
  v_and_b32 v58, 0xffff0000, v58
  v_cvt_pk_f16_f32 v58, v50, v58
  v_accvgpr_write_b32 a94, v58
  v_lshlrev_b32 v50, 16, v59
  v_and_b32 v59, 0xffff0000, v59
  v_cvt_pk_f16_f32 v59, v50, v59
  v_accvgpr_write_b32 a95, v59
  v_lshlrev_b32 v50, 16, v60
  v_and_b32 v60, 0xffff0000, v60
  v_cvt_pk_f16_f32 v60, v50, v60
  v_accvgpr_write_b32 a112, v60
  v_lshlrev_b32 v50, 16, v61
  v_and_b32 v61, 0xffff0000, v61
  v_cvt_pk_f16_f32 v61, v50, v61
  v_accvgpr_write_b32 a113, v61
  v_lshlrev_b32 v50, 16, v62
  v_and_b32 v62, 0xffff0000, v62
  v_cvt_pk_f16_f32 v62, v50, v62
  v_accvgpr_write_b32 a114, v62
  v_lshlrev_b32 v50, 16, v63
  v_and_b32 v63, 0xffff0000, v63
  v_cvt_pk_f16_f32 v63, v50, v63
  v_accvgpr_write_b32 a115, v63
  s_waitcnt lgkmcnt(0)
  v_lshlrev_b32 v50, 16, v64
  v_and_b32 v64, 0xffff0000, v64
  v_cvt_pk_f16_f32 v64, v50, v64
  v_accvgpr_write_b32 a76, v64
  v_lshlrev_b32 v50, 16, v65
  v_and_b32 v65, 0xffff0000, v65
  v_cvt_pk_f16_f32 v65, v50, v65
  v_accvgpr_write_b32 a77, v65
  v_lshlrev_b32 v50, 16, v66
  v_and_b32 v66, 0xffff0000, v66
  v_cvt_pk_f16_f32 v66, v50, v66
  v_accvgpr_write_b32 a78, v66
  v_lshlrev_b32 v50, 16, v67
  v_and_b32 v67, 0xffff0000, v67
  v_cvt_pk_f16_f32 v67, v50, v67
  v_accvgpr_write_b32 a79, v67
  v_lshlrev_b32 v50, 16, v68
  v_and_b32 v68, 0xffff0000, v68
  v_cvt_pk_f16_f32 v68, v50, v68
  v_accvgpr_write_b32 a96, v68
  v_lshlrev_b32 v50, 16, v69
  v_and_b32 v69, 0xffff0000, v69
  v_cvt_pk_f16_f32 v69, v50, v69
  v_accvgpr_write_b32 a97, v69
  v_lshlrev_b32 v50, 16, v70
  v_and_b32 v70, 0xffff0000, v70
  v_cvt_pk_f16_f32 v70, v50, v70
  v_accvgpr_write_b32 a98, v70
  v_lshlrev_b32 v50, 16, v71
  v_and_b32 v71, 0xffff0000, v71
  v_cvt_pk_f16_f32 v71, v50, v71
  v_accvgpr_write_b32 a99, v71
  v_lshlrev_b32 v50, 16, v72
  v_and_b32 v72, 0xffff0000, v72
  v_cvt_pk_f16_f32 v72, v50, v72
  v_accvgpr_write_b32 a116, v72
  v_lshlrev_b32 v50, 16, v73
  v_and_b32 v73, 0xffff0000, v73
  v_cvt_pk_f16_f32 v73, v50, v73
  v_accvgpr_write_b32 a117, v73
  v_lshlrev_b32 v50, 16, v74
  v_and_b32 v74, 0xffff0000, v74
  v_cvt_pk_f16_f32 v74, v50, v74
  v_accvgpr_write_b32 a118, v74
  v_lshlrev_b32 v50, 16, v75
  v_and_b32 v75, 0xffff0000, v75
  v_cvt_pk_f16_f32 v75, v50, v75
  v_accvgpr_write_b32 a119, v75
  s_waitcnt vmcnt(36)
  ds_write_b128 v100, v[128:131] offset:0
  ds_write_b128 v100, v[132:135] offset:1024
  ds_write_b128 v100, v[136:139] offset:2048
  ds_write_b128 v100, v[140:143] offset:3072
  ds_write_b128 v100, v[144:147] offset:4096
  ds_write_b128 v100, v[148:151] offset:5120
  ds_write_b128 v100, v[152:155] offset:6144
  ds_write_b128 v100, v[156:159] offset:7168
  ds_write_b128 v100, v[160:163] offset:8192
  ds_write_b128 v100, v[164:167] offset:9216
  ds_write_b128 v100, v[168:171] offset:10240
  ds_write_b128 v100, v[172:175] offset:11264
  ds_write_b128 v100, v[176:179] offset:12288
  ds_write_b128 v100, v[180:183] offset:13312
  ds_write_b128 v100, v[184:187] offset:14336
  s_waitcnt lgkmcnt(0)
  ds_read_b64_tr_b16 v[52:53], v99 offset:0
  ds_read_b64_tr_b16 v[54:55], v99 offset:384
  ds_read_b64_tr_b16 v[56:57], v99 offset:32
  ds_read_b64_tr_b16 v[58:59], v99 offset:416
  ds_read_b64_tr_b16 v[60:61], v99 offset:64
  ds_read_b64_tr_b16 v[62:63], v99 offset:448
  ds_read_b64_tr_b16 v[64:65], v99 offset:3072
  ds_read_b64_tr_b16 v[66:67], v99 offset:3456
  ds_read_b64_tr_b16 v[68:69], v99 offset:3104
  ds_read_b64_tr_b16 v[70:71], v99 offset:3488
  ds_read_b64_tr_b16 v[72:73], v99 offset:3136
  ds_read_b64_tr_b16 v[74:75], v99 offset:3520
  ds_read_b64_tr_b16 v[76:77], v99 offset:6144
  ds_read_b64_tr_b16 v[78:79], v99 offset:6528
  ds_read_b64_tr_b16 v[80:81], v99 offset:6176
  ds_read_b64_tr_b16 v[82:83], v99 offset:6560
  ds_read_b64_tr_b16 v[84:85], v99 offset:6208
  ds_read_b64_tr_b16 v[86:87], v99 offset:6592
  s_waitcnt lgkmcnt(12)
  v_lshlrev_b32 v50, 16, v52
  v_and_b32 v52, 0xffff0000, v52
  v_cvt_pk_f16_f32 v52, v50, v52
  v_accvgpr_write_b32 a120, v52
  v_lshlrev_b32 v50, 16, v53
  v_and_b32 v53, 0xffff0000, v53
  v_cvt_pk_f16_f32 v53, v50, v53
  v_accvgpr_write_b32 a121, v53
  v_lshlrev_b32 v50, 16, v54
  v_and_b32 v54, 0xffff0000, v54
  v_cvt_pk_f16_f32 v54, v50, v54
  v_accvgpr_write_b32 a122, v54
  v_lshlrev_b32 v50, 16, v55
  v_and_b32 v55, 0xffff0000, v55
  v_cvt_pk_f16_f32 v55, v50, v55
  v_accvgpr_write_b32 a123, v55
  v_lshlrev_b32 v50, 16, v56
  v_and_b32 v56, 0xffff0000, v56
  v_cvt_pk_f16_f32 v56, v50, v56
  v_accvgpr_write_b32 a140, v56
  v_lshlrev_b32 v50, 16, v57
  v_and_b32 v57, 0xffff0000, v57
  v_cvt_pk_f16_f32 v57, v50, v57
  v_accvgpr_write_b32 a141, v57
  v_lshlrev_b32 v50, 16, v58
  v_and_b32 v58, 0xffff0000, v58
  v_cvt_pk_f16_f32 v58, v50, v58
  v_accvgpr_write_b32 a142, v58
  v_lshlrev_b32 v50, 16, v59
  v_and_b32 v59, 0xffff0000, v59
  v_cvt_pk_f16_f32 v59, v50, v59
  v_accvgpr_write_b32 a143, v59
  v_lshlrev_b32 v50, 16, v60
  v_and_b32 v60, 0xffff0000, v60
  v_cvt_pk_f16_f32 v60, v50, v60
  v_accvgpr_write_b32 a160, v60
  v_lshlrev_b32 v50, 16, v61
  v_and_b32 v61, 0xffff0000, v61
  v_cvt_pk_f16_f32 v61, v50, v61
  v_accvgpr_write_b32 a161, v61
  v_lshlrev_b32 v50, 16, v62
  v_and_b32 v62, 0xffff0000, v62
  v_cvt_pk_f16_f32 v62, v50, v62
  v_accvgpr_write_b32 a162, v62
  v_lshlrev_b32 v50, 16, v63
  v_and_b32 v63, 0xffff0000, v63
  v_cvt_pk_f16_f32 v63, v50, v63
  v_accvgpr_write_b32 a163, v63
  ds_read_b64_tr_b16 v[52:53], v99 offset:9216
  ds_read_b64_tr_b16 v[54:55], v99 offset:9600
  ds_read_b64_tr_b16 v[56:57], v99 offset:9248
  ds_read_b64_tr_b16 v[58:59], v99 offset:9632
  ds_read_b64_tr_b16 v[60:61], v99 offset:9280
  ds_read_b64_tr_b16 v[62:63], v99 offset:9664
  s_waitcnt lgkmcnt(12)
  v_lshlrev_b32 v50, 16, v64
  v_and_b32 v64, 0xffff0000, v64
  v_cvt_pk_f16_f32 v64, v50, v64
  v_accvgpr_write_b32 a124, v64
  v_lshlrev_b32 v50, 16, v65
  v_and_b32 v65, 0xffff0000, v65
  v_cvt_pk_f16_f32 v65, v50, v65
  v_accvgpr_write_b32 a125, v65
  v_lshlrev_b32 v50, 16, v66
  v_and_b32 v66, 0xffff0000, v66
  v_cvt_pk_f16_f32 v66, v50, v66
  v_accvgpr_write_b32 a126, v66
  v_lshlrev_b32 v50, 16, v67
  v_and_b32 v67, 0xffff0000, v67
  v_cvt_pk_f16_f32 v67, v50, v67
  v_accvgpr_write_b32 a127, v67
  v_lshlrev_b32 v50, 16, v68
  v_and_b32 v68, 0xffff0000, v68
  v_cvt_pk_f16_f32 v68, v50, v68
  v_accvgpr_write_b32 a144, v68
  v_lshlrev_b32 v50, 16, v69
  v_and_b32 v69, 0xffff0000, v69
  v_cvt_pk_f16_f32 v69, v50, v69
  v_accvgpr_write_b32 a145, v69
  v_lshlrev_b32 v50, 16, v70
  v_and_b32 v70, 0xffff0000, v70
  v_cvt_pk_f16_f32 v70, v50, v70
  v_accvgpr_write_b32 a146, v70
  v_lshlrev_b32 v50, 16, v71
  v_and_b32 v71, 0xffff0000, v71
  v_cvt_pk_f16_f32 v71, v50, v71
  v_accvgpr_write_b32 a147, v71
  v_lshlrev_b32 v50, 16, v72
  v_and_b32 v72, 0xffff0000, v72
  v_cvt_pk_f16_f32 v72, v50, v72
  v_accvgpr_write_b32 a164, v72
  v_lshlrev_b32 v50, 16, v73
  v_and_b32 v73, 0xffff0000, v73
  v_cvt_pk_f16_f32 v73, v50, v73
  v_accvgpr_write_b32 a165, v73
  v_lshlrev_b32 v50, 16, v74
  v_and_b32 v74, 0xffff0000, v74
  v_cvt_pk_f16_f32 v74, v50, v74
  v_accvgpr_write_b32 a166, v74
  v_lshlrev_b32 v50, 16, v75
  v_and_b32 v75, 0xffff0000, v75
  v_cvt_pk_f16_f32 v75, v50, v75
  v_accvgpr_write_b32 a167, v75
  ds_read_b64_tr_b16 v[64:65], v99 offset:12288
  ds_read_b64_tr_b16 v[66:67], v99 offset:12672
  ds_read_b64_tr_b16 v[68:69], v99 offset:12320
  ds_read_b64_tr_b16 v[70:71], v99 offset:12704
  ds_read_b64_tr_b16 v[72:73], v99 offset:12352
  ds_read_b64_tr_b16 v[74:75], v99 offset:12736
  s_waitcnt lgkmcnt(12)
  v_lshlrev_b32 v50, 16, v76
  v_and_b32 v76, 0xffff0000, v76
  v_cvt_pk_f16_f32 v76, v50, v76
  v_accvgpr_write_b32 a128, v76
  v_lshlrev_b32 v50, 16, v77
  v_and_b32 v77, 0xffff0000, v77
  v_cvt_pk_f16_f32 v77, v50, v77
  v_accvgpr_write_b32 a129, v77
  v_lshlrev_b32 v50, 16, v78
  v_and_b32 v78, 0xffff0000, v78
  v_cvt_pk_f16_f32 v78, v50, v78
  v_accvgpr_write_b32 a130, v78
  v_lshlrev_b32 v50, 16, v79
  v_and_b32 v79, 0xffff0000, v79
  v_cvt_pk_f16_f32 v79, v50, v79
  v_accvgpr_write_b32 a131, v79
  v_lshlrev_b32 v50, 16, v80
  v_and_b32 v80, 0xffff0000, v80
  v_cvt_pk_f16_f32 v80, v50, v80
  v_accvgpr_write_b32 a148, v80
  v_lshlrev_b32 v50, 16, v81
  v_and_b32 v81, 0xffff0000, v81
  v_cvt_pk_f16_f32 v81, v50, v81
  v_accvgpr_write_b32 a149, v81
  v_lshlrev_b32 v50, 16, v82
  v_and_b32 v82, 0xffff0000, v82
  v_cvt_pk_f16_f32 v82, v50, v82
  v_accvgpr_write_b32 a150, v82
  v_lshlrev_b32 v50, 16, v83
  v_and_b32 v83, 0xffff0000, v83
  v_cvt_pk_f16_f32 v83, v50, v83
  v_accvgpr_write_b32 a151, v83
  v_lshlrev_b32 v50, 16, v84
  v_and_b32 v84, 0xffff0000, v84
  v_cvt_pk_f16_f32 v84, v50, v84
  v_accvgpr_write_b32 a168, v84
  v_lshlrev_b32 v50, 16, v85
  v_and_b32 v85, 0xffff0000, v85
  v_cvt_pk_f16_f32 v85, v50, v85
  v_accvgpr_write_b32 a169, v85
  v_lshlrev_b32 v50, 16, v86
  v_and_b32 v86, 0xffff0000, v86
  v_cvt_pk_f16_f32 v86, v50, v86
  v_accvgpr_write_b32 a170, v86
  v_lshlrev_b32 v50, 16, v87
  v_and_b32 v87, 0xffff0000, v87
  v_cvt_pk_f16_f32 v87, v50, v87
  v_accvgpr_write_b32 a171, v87
  s_waitcnt lgkmcnt(6)
  v_lshlrev_b32 v50, 16, v52
  v_and_b32 v52, 0xffff0000, v52
  v_cvt_pk_f16_f32 v52, v50, v52
  v_accvgpr_write_b32 a132, v52
  v_lshlrev_b32 v50, 16, v53
  v_and_b32 v53, 0xffff0000, v53
  v_cvt_pk_f16_f32 v53, v50, v53
  v_accvgpr_write_b32 a133, v53
  v_lshlrev_b32 v50, 16, v54
  v_and_b32 v54, 0xffff0000, v54
  v_cvt_pk_f16_f32 v54, v50, v54
  v_accvgpr_write_b32 a134, v54
  v_lshlrev_b32 v50, 16, v55
  v_and_b32 v55, 0xffff0000, v55
  v_cvt_pk_f16_f32 v55, v50, v55
  v_accvgpr_write_b32 a135, v55
  v_lshlrev_b32 v50, 16, v56
  v_and_b32 v56, 0xffff0000, v56
  v_cvt_pk_f16_f32 v56, v50, v56
  v_accvgpr_write_b32 a152, v56
  v_lshlrev_b32 v50, 16, v57
  v_and_b32 v57, 0xffff0000, v57
  v_cvt_pk_f16_f32 v57, v50, v57
  v_accvgpr_write_b32 a153, v57
  v_lshlrev_b32 v50, 16, v58
  v_and_b32 v58, 0xffff0000, v58
  v_cvt_pk_f16_f32 v58, v50, v58
  v_accvgpr_write_b32 a154, v58
  v_lshlrev_b32 v50, 16, v59
  v_and_b32 v59, 0xffff0000, v59
  v_cvt_pk_f16_f32 v59, v50, v59
  v_accvgpr_write_b32 a155, v59
  v_lshlrev_b32 v50, 16, v60
  v_and_b32 v60, 0xffff0000, v60
  v_cvt_pk_f16_f32 v60, v50, v60
  v_accvgpr_write_b32 a172, v60
  v_lshlrev_b32 v50, 16, v61
  v_and_b32 v61, 0xffff0000, v61
  v_cvt_pk_f16_f32 v61, v50, v61
  v_accvgpr_write_b32 a173, v61
  v_lshlrev_b32 v50, 16, v62
  v_and_b32 v62, 0xffff0000, v62
  v_cvt_pk_f16_f32 v62, v50, v62
  v_accvgpr_write_b32 a174, v62
  v_lshlrev_b32 v50, 16, v63
  v_and_b32 v63, 0xffff0000, v63
  v_cvt_pk_f16_f32 v63, v50, v63
  v_accvgpr_write_b32 a175, v63
  s_waitcnt lgkmcnt(0)
  v_lshlrev_b32 v50, 16, v64
  v_and_b32 v64, 0xffff0000, v64
  v_cvt_pk_f16_f32 v64, v50, v64
  v_accvgpr_write_b32 a136, v64
  v_lshlrev_b32 v50, 16, v65
  v_and_b32 v65, 0xffff0000, v65
  v_cvt_pk_f16_f32 v65, v50, v65
  v_accvgpr_write_b32 a137, v65
  v_lshlrev_b32 v50, 16, v66
  v_and_b32 v66, 0xffff0000, v66
  v_cvt_pk_f16_f32 v66, v50, v66
  v_accvgpr_write_b32 a138, v66
  v_lshlrev_b32 v50, 16, v67
  v_and_b32 v67, 0xffff0000, v67
  v_cvt_pk_f16_f32 v67, v50, v67
  v_accvgpr_write_b32 a139, v67
  v_lshlrev_b32 v50, 16, v68
  v_and_b32 v68, 0xffff0000, v68
  v_cvt_pk_f16_f32 v68, v50, v68
  v_accvgpr_write_b32 a156, v68
  v_lshlrev_b32 v50, 16, v69
  v_and_b32 v69, 0xffff0000, v69
  v_cvt_pk_f16_f32 v69, v50, v69
  v_accvgpr_write_b32 a157, v69
  v_lshlrev_b32 v50, 16, v70
  v_and_b32 v70, 0xffff0000, v70
  v_cvt_pk_f16_f32 v70, v50, v70
  v_accvgpr_write_b32 a158, v70
  v_lshlrev_b32 v50, 16, v71
  v_and_b32 v71, 0xffff0000, v71
  v_cvt_pk_f16_f32 v71, v50, v71
  v_accvgpr_write_b32 a159, v71
  v_lshlrev_b32 v50, 16, v72
  v_and_b32 v72, 0xffff0000, v72
  v_cvt_pk_f16_f32 v72, v50, v72
  v_accvgpr_write_b32 a176, v72
  v_lshlrev_b32 v50, 16, v73
  v_and_b32 v73, 0xffff0000, v73
  v_cvt_pk_f16_f32 v73, v50, v73
  v_accvgpr_write_b32 a177, v73
  v_lshlrev_b32 v50, 16, v74
  v_and_b32 v74, 0xffff0000, v74
  v_cvt_pk_f16_f32 v74, v50, v74
  v_accvgpr_write_b32 a178, v74
  v_lshlrev_b32 v50, 16, v75
  v_and_b32 v75, 0xffff0000, v75
  v_cvt_pk_f16_f32 v75, v50, v75
  v_accvgpr_write_b32 a179, v75
  s_waitcnt vmcnt(27)
  s_cmp_lg_u32 s20, 0
  s_cbranch_scc1 ic_7
  buffer_load_dword v238, v239, s[32:35], 0 offen sc1
ic_7:
  ds_write_b128 v100, v[188:191] offset:0
  ds_write_b128 v100, v[192:195] offset:1024
  ds_write_b128 v100, v[196:199] offset:2048
  ds_write_b128 v100, v[200:203] offset:3072
  ds_write_b128 v100, v[204:207] offset:4096
  ds_write_b128 v100, v[208:211] offset:5120
  ds_write_b128 v100, v[212:215] offset:6144
  ds_write_b128 v100, v[216:219] offset:7168
  ds_write_b128 v100, v[220:223] offset:8192
  s_waitcnt lgkmcnt(0)
  ds_read_b64_tr_b16 a[192:193], v99 offset:0
  ds_read_b64_tr_b16 a[194:195], v99 offset:384
  ds_read_b64_tr_b16 a[216:217], v99 offset:32
  ds_read_b64_tr_b16 a[218:219], v99 offset:416
  ds_read_b64_tr_b16 a[240:241], v99 offset:64
  ds_read_b64_tr_b16 a[242:243], v99 offset:448
  ds_read_b64_tr_b16 a[196:197], v99 offset:3072
  ds_read_b64_tr_b16 a[198:199], v99 offset:3456
  ds_read_b64_tr_b16 a[220:221], v99 offset:3104
  ds_read_b64_tr_b16 a[222:223], v99 offset:3488
  ds_read_b64_tr_b16 a[244:245], v99 offset:3136
  ds_read_b64_tr_b16 a[246:247], v99 offset:3520
  ds_read_b64_tr_b16 a[200:201], v99 offset:6144
  ds_read_b64_tr_b16 a[202:203], v99 offset:6528
  ds_read_b64_tr_b16 a[224:225], v99 offset:6176
  ds_read_b64_tr_b16 a[226:227], v99 offset:6560
  ds_read_b64_tr_b16 a[248:249], v99 offset:6208
  ds_read_b64_tr_b16 a[250:251], v99 offset:6592
  s_waitcnt lgkmcnt(0)
  s_waitcnt vmcnt(15)
  ds_read_b64_tr_b16 a[180:181], v99 offset:30720
  ds_read_b64_tr_b16 a[182:183], v99 offset:31104
  ds_read_b64_tr_b16 a[204:205], v99 offset:30752
  ds_read_b64_tr_b16 a[206:207], v99 offset:31136
  ds_read_b64_tr_b16 a[228:229], v99 offset:30784
  ds_read_b64_tr_b16 a[230:231], v99 offset:31168
  ds_read_b64_tr_b16 a[184:185], v99 offset:33792
  ds_read_b64_tr_b16 a[186:187], v99 offset:34176
  ds_read_b64_tr_b16 a[208:209], v99 offset:33824
  ds_read_b64_tr_b16 a[210:211], v99 offset:34208
  ds_read_b64_tr_b16 a[232:233], v99 offset:33856
  ds_read_b64_tr_b16 a[234:235], v99 offset:34240
  ds_read_b64_tr_b16 a[188:189], v99 offset:36864
  ds_read_b64_tr_b16 a[190:191], v99 offset:37248
  ds_read_b64_tr_b16 a[212:213], v99 offset:36896
  ds_read_b64_tr_b16 a[214:215], v99 offset:37280
  ds_read_b64_tr_b16 a[236:237], v99 offset:36928
  ds_read_b64_tr_b16 a[238:239], v99 offset:37312
  s_waitcnt lgkmcnt(0)
  v_lshlrev_b32 v50, 16, v32
  v_and_b32 v32, 0xffff0000, v32
  v_cvt_pk_f16_f32 v32, v50, v32
  v_lshlrev_b32 v50, 16, v33
  v_and_b32 v33, 0xffff0000, v33
  v_cvt_pk_f16_f32 v33, v50, v33
  v_lshlrev_b32 v50, 16, v34
  v_and_b32 v34, 0xffff0000, v34
  v_cvt_pk_f16_f32 v34, v50, v34
  v_lshlrev_b32 v50, 16, v35
  v_and_b32 v35, 0xffff0000, v35
  v_cvt_pk_f16_f32 v35, v50, v35
  v_lshlrev_b32 v50, 16, v36
  v_and_b32 v36, 0xffff0000, v36
  v_cvt_pk_f16_f32 v36, v50, v36
  v_lshlrev_b32 v50, 16, v37
  v_and_b32 v37, 0xffff0000, v37
  v_cvt_pk_f16_f32 v37, v50, v37
  v_lshlrev_b32 v50, 16, v38
  v_and_b32 v38, 0xffff0000, v38
  v_cvt_pk_f16_f32 v38, v50, v38
  v_lshlrev_b32 v50, 16, v39
  v_and_b32 v39, 0xffff0000, v39
  v_cvt_pk_f16_f32 v39, v50, v39
  v_lshlrev_b32 v50, 16, v40
  v_and_b32 v40, 0xffff0000, v40
  v_cvt_pk_f16_f32 v40, v50, v40
  v_lshlrev_b32 v50, 16, v41
  v_and_b32 v41, 0xffff0000, v41
  v_cvt_pk_f16_f32 v41, v50, v41
  v_mov_b32 v174, 0
  v_mov_b32 v175, 0
  v_mov_b32 v218, 0
  v_mov_b32 v219, 0
  v_mov_b32 v234, 0
  v_mov_b32 v235, 0
  v_mov_b32 v220, 0
  v_mov_b32 v221, 0
  v_mov_b32 v222, 0
  v_mov_b32 v223, 0
  v_mov_b32 v224, 0
  v_mov_b32 v225, 0
  v_mov_b32 v226, 0
  v_mov_b32 v227, 0
  s_waitcnt vmcnt(12)
  ds_read_b64_tr_b16 v[52:53], v99 offset:15360
  ds_read_b64_tr_b16 v[54:55], v99 offset:15744
  ds_read_b64_tr_b16 v[56:57], v99 offset:15392
  ds_read_b64_tr_b16 v[58:59], v99 offset:15776
  ds_read_b64_tr_b16 v[60:61], v99 offset:15424
  ds_read_b64_tr_b16 v[62:63], v99 offset:15808
  s_waitcnt lgkmcnt(0)
  v_lshlrev_b32 v50, 16, v52
  v_and_b32 v52, 0xffff0000, v52
  v_cvt_pk_f16_f32 v52, v50, v52
  v_accvgpr_write_b32 a0, v52
  v_lshlrev_b32 v50, 16, v53
  v_and_b32 v53, 0xffff0000, v53
  v_cvt_pk_f16_f32 v53, v50, v53
  v_accvgpr_write_b32 a1, v53
  v_lshlrev_b32 v50, 16, v54
  v_and_b32 v54, 0xffff0000, v54
  v_cvt_pk_f16_f32 v54, v50, v54
  v_accvgpr_write_b32 a2, v54
  v_lshlrev_b32 v50, 16, v55
  v_and_b32 v55, 0xffff0000, v55
  v_cvt_pk_f16_f32 v55, v50, v55
  v_accvgpr_write_b32 a3, v55
  v_lshlrev_b32 v50, 16, v56
  v_and_b32 v56, 0xffff0000, v56
  v_cvt_pk_f16_f32 v56, v50, v56
  v_accvgpr_write_b32 a20, v56
  v_lshlrev_b32 v50, 16, v57
  v_and_b32 v57, 0xffff0000, v57
  v_cvt_pk_f16_f32 v57, v50, v57
  v_accvgpr_write_b32 a21, v57
  v_lshlrev_b32 v50, 16, v58
  v_and_b32 v58, 0xffff0000, v58
  v_cvt_pk_f16_f32 v58, v50, v58
  v_accvgpr_write_b32 a22, v58
  v_lshlrev_b32 v50, 16, v59
  v_and_b32 v59, 0xffff0000, v59
  v_cvt_pk_f16_f32 v59, v50, v59
  v_accvgpr_write_b32 a23, v59
  v_lshlrev_b32 v50, 16, v60
  v_and_b32 v60, 0xffff0000, v60
  v_cvt_pk_f16_f32 v60, v50, v60
  v_accvgpr_write_b32 a40, v60
  v_lshlrev_b32 v50, 16, v61
  v_and_b32 v61, 0xffff0000, v61
  v_cvt_pk_f16_f32 v61, v50, v61
  v_accvgpr_write_b32 a41, v61
  v_lshlrev_b32 v50, 16, v62
  v_and_b32 v62, 0xffff0000, v62
  v_cvt_pk_f16_f32 v62, v50, v62
  v_accvgpr_write_b32 a42, v62
  v_lshlrev_b32 v50, 16, v63
  v_and_b32 v63, 0xffff0000, v63
  v_cvt_pk_f16_f32 v63, v50, v63
  v_accvgpr_write_b32 a43, v63
  s_waitcnt vmcnt(9)
  ds_read_b64_tr_b16 v[64:65], v99 offset:18432
  ds_read_b64_tr_b16 v[66:67], v99 offset:18816
  ds_read_b64_tr_b16 v[68:69], v99 offset:18464
  ds_read_b64_tr_b16 v[70:71], v99 offset:18848
  ds_read_b64_tr_b16 v[72:73], v99 offset:18496
  ds_read_b64_tr_b16 v[74:75], v99 offset:18880
  s_waitcnt lgkmcnt(0)
  v_lshlrev_b32 v50, 16, v64
  v_and_b32 v64, 0xffff0000, v64
  v_cvt_pk_f16_f32 v64, v50, v64
  v_accvgpr_write_b32 a4, v64
  v_lshlrev_b32 v50, 16, v65
  v_and_b32 v65, 0xffff0000, v65
  v_cvt_pk_f16_f32 v65, v50, v65
  v_accvgpr_write_b32 a5, v65
  v_lshlrev_b32 v50, 16, v66
  v_and_b32 v66, 0xffff0000, v66
  v_cvt_pk_f16_f32 v66, v50, v66
  v_accvgpr_write_b32 a6, v66
  v_lshlrev_b32 v50, 16, v67
  v_and_b32 v67, 0xffff0000, v67
  v_cvt_pk_f16_f32 v67, v50, v67
  v_accvgpr_write_b32 a7, v67
  v_lshlrev_b32 v50, 16, v68
  v_and_b32 v68, 0xffff0000, v68
  v_cvt_pk_f16_f32 v68, v50, v68
  v_accvgpr_write_b32 a24, v68
  v_lshlrev_b32 v50, 16, v69
  v_and_b32 v69, 0xffff0000, v69
  v_cvt_pk_f16_f32 v69, v50, v69
  v_accvgpr_write_b32 a25, v69
  v_lshlrev_b32 v50, 16, v70
  v_and_b32 v70, 0xffff0000, v70
  v_cvt_pk_f16_f32 v70, v50, v70
  v_accvgpr_write_b32 a26, v70
  v_lshlrev_b32 v50, 16, v71
  v_and_b32 v71, 0xffff0000, v71
  v_cvt_pk_f16_f32 v71, v50, v71
  v_accvgpr_write_b32 a27, v71
  v_lshlrev_b32 v50, 16, v72
  v_and_b32 v72, 0xffff0000, v72
  v_cvt_pk_f16_f32 v72, v50, v72
  v_accvgpr_write_b32 a44, v72
  v_lshlrev_b32 v50, 16, v73
  v_and_b32 v73, 0xffff0000, v73
  v_cvt_pk_f16_f32 v73, v50, v73
  v_accvgpr_write_b32 a45, v73
  v_lshlrev_b32 v50, 16, v74
  v_and_b32 v74, 0xffff0000, v74
  v_cvt_pk_f16_f32 v74, v50, v74
  v_accvgpr_write_b32 a46, v74
  v_lshlrev_b32 v50, 16, v75
  v_and_b32 v75, 0xffff0000, v75
  v_cvt_pk_f16_f32 v75, v50, v75
  v_accvgpr_write_b32 a47, v75
  s_waitcnt vmcnt(6)
  ds_read_b64_tr_b16 v[76:77], v99 offset:21504
  ds_read_b64_tr_b16 v[78:79], v99 offset:21888
  ds_read_b64_tr_b16 v[80:81], v99 offset:21536
  ds_read_b64_tr_b16 v[82:83], v99 offset:21920
  ds_read_b64_tr_b16 v[84:85], v99 offset:21568
  ds_read_b64_tr_b16 v[86:87], v99 offset:21952
  s_waitcnt lgkmcnt(0)
  v_lshlrev_b32 v50, 16, v76
  v_and_b32 v76, 0xffff0000, v76
  v_cvt_pk_f16_f32 v76, v50, v76
  v_accvgpr_write_b32 a8, v76
  v_lshlrev_b32 v50, 16, v77
  v_and_b32 v77, 0xffff0000, v77
  v_cvt_pk_f16_f32 v77, v50, v77
  v_accvgpr_write_b32 a9, v77
  v_lshlrev_b32 v50, 16, v78
  v_and_b32 v78, 0xffff0000, v78
  v_cvt_pk_f16_f32 v78, v50, v78
  v_accvgpr_write_b32 a10, v78
  v_lshlrev_b32 v50, 16, v79
  v_and_b32 v79, 0xffff0000, v79
  v_cvt_pk_f16_f32 v79, v50, v79
  v_accvgpr_write_b32 a11, v79
  v_lshlrev_b32 v50, 16, v80
  v_and_b32 v80, 0xffff0000, v80
  v_cvt_pk_f16_f32 v80, v50, v80
  v_accvgpr_write_b32 a28, v80
  v_lshlrev_b32 v50, 16, v81
  v_and_b32 v81, 0xffff0000, v81
  v_cvt_pk_f16_f32 v81, v50, v81
  v_accvgpr_write_b32 a29, v81
  v_lshlrev_b32 v50, 16, v82
  v_and_b32 v82, 0xffff0000, v82
  v_cvt_pk_f16_f32 v82, v50, v82
  v_accvgpr_write_b32 a30, v82
  v_lshlrev_b32 v50, 16, v83
  v_and_b32 v83, 0xffff0000, v83
  v_cvt_pk_f16_f32 v83, v50, v83
  v_accvgpr_write_b32 a31, v83
  v_lshlrev_b32 v50, 16, v84
  v_and_b32 v84, 0xffff0000, v84
  v_cvt_pk_f16_f32 v84, v50, v84
  v_accvgpr_write_b32 a48, v84
  v_lshlrev_b32 v50, 16, v85
  v_and_b32 v85, 0xffff0000, v85
  v_cvt_pk_f16_f32 v85, v50, v85
  v_accvgpr_write_b32 a49, v85
  v_lshlrev_b32 v50, 16, v86
  v_and_b32 v86, 0xffff0000, v86
  v_cvt_pk_f16_f32 v86, v50, v86
  v_accvgpr_write_b32 a50, v86
  v_lshlrev_b32 v50, 16, v87
  v_and_b32 v87, 0xffff0000, v87
  v_cvt_pk_f16_f32 v87, v50, v87
  v_accvgpr_write_b32 a51, v87
  s_waitcnt vmcnt(3)
  ds_read_b64_tr_b16 v[52:53], v99 offset:24576
  ds_read_b64_tr_b16 v[54:55], v99 offset:24960
  ds_read_b64_tr_b16 v[56:57], v99 offset:24608
  ds_read_b64_tr_b16 v[58:59], v99 offset:24992
  ds_read_b64_tr_b16 v[60:61], v99 offset:24640
  ds_read_b64_tr_b16 v[62:63], v99 offset:25024
  s_waitcnt lgkmcnt(0)
  v_lshlrev_b32 v50, 16, v52
  v_and_b32 v52, 0xffff0000, v52
  v_cvt_pk_f16_f32 v52, v50, v52
  v_accvgpr_write_b32 a12, v52
  v_lshlrev_b32 v50, 16, v53
  v_and_b32 v53, 0xffff0000, v53
  v_cvt_pk_f16_f32 v53, v50, v53
  v_accvgpr_write_b32 a13, v53
  v_lshlrev_b32 v50, 16, v54
  v_and_b32 v54, 0xffff0000, v54
  v_cvt_pk_f16_f32 v54, v50, v54
  v_accvgpr_write_b32 a14, v54
  v_lshlrev_b32 v50, 16, v55
  v_and_b32 v55, 0xffff0000, v55
  v_cvt_pk_f16_f32 v55, v50, v55
  v_accvgpr_write_b32 a15, v55
  v_lshlrev_b32 v50, 16, v56
  v_and_b32 v56, 0xffff0000, v56
  v_cvt_pk_f16_f32 v56, v50, v56
  v_accvgpr_write_b32 a32, v56
  v_lshlrev_b32 v50, 16, v57
  v_and_b32 v57, 0xffff0000, v57
  v_cvt_pk_f16_f32 v57, v50, v57
  v_accvgpr_write_b32 a33, v57
  v_lshlrev_b32 v50, 16, v58
  v_and_b32 v58, 0xffff0000, v58
  v_cvt_pk_f16_f32 v58, v50, v58
  v_accvgpr_write_b32 a34, v58
  v_lshlrev_b32 v50, 16, v59
  v_and_b32 v59, 0xffff0000, v59
  v_cvt_pk_f16_f32 v59, v50, v59
  v_accvgpr_write_b32 a35, v59
  v_lshlrev_b32 v50, 16, v60
  v_and_b32 v60, 0xffff0000, v60
  v_cvt_pk_f16_f32 v60, v50, v60
  v_accvgpr_write_b32 a52, v60
  v_lshlrev_b32 v50, 16, v61
  v_and_b32 v61, 0xffff0000, v61
  v_cvt_pk_f16_f32 v61, v50, v61
  v_accvgpr_write_b32 a53, v61
  v_lshlrev_b32 v50, 16, v62
  v_and_b32 v62, 0xffff0000, v62
  v_cvt_pk_f16_f32 v62, v50, v62
  v_accvgpr_write_b32 a54, v62
  v_lshlrev_b32 v50, 16, v63
  v_and_b32 v63, 0xffff0000, v63
  v_cvt_pk_f16_f32 v63, v50, v63
  v_accvgpr_write_b32 a55, v63
  s_waitcnt vmcnt(0)
  ds_read_b64_tr_b16 v[64:65], v99 offset:27648
  ds_read_b64_tr_b16 v[66:67], v99 offset:28032
  ds_read_b64_tr_b16 v[68:69], v99 offset:27680
  ds_read_b64_tr_b16 v[70:71], v99 offset:28064
  ds_read_b64_tr_b16 v[72:73], v99 offset:27712
  ds_read_b64_tr_b16 v[74:75], v99 offset:28096
  s_waitcnt lgkmcnt(0)
  v_lshlrev_b32 v50, 16, v64
  v_and_b32 v64, 0xffff0000, v64
  v_cvt_pk_f16_f32 v64, v50, v64
  v_accvgpr_write_b32 a16, v64
  v_lshlrev_b32 v50, 16, v65
  v_and_b32 v65, 0xffff0000, v65
  v_cvt_pk_f16_f32 v65, v50, v65
  v_accvgpr_write_b32 a17, v65
  v_lshlrev_b32 v50, 16, v66
  v_and_b32 v66, 0xffff0000, v66
  v_cvt_pk_f16_f32 v66, v50, v66
  v_accvgpr_write_b32 a18, v66
  v_lshlrev_b32 v50, 16, v67
  v_and_b32 v67, 0xffff0000, v67
  v_cvt_pk_f16_f32 v67, v50, v67
  v_accvgpr_write_b32 a19, v67
  v_lshlrev_b32 v50, 16, v68
  v_and_b32 v68, 0xffff0000, v68
  v_cvt_pk_f16_f32 v68, v50, v68
  v_accvgpr_write_b32 a36, v68
  v_lshlrev_b32 v50, 16, v69
  v_and_b32 v69, 0xffff0000, v69
  v_cvt_pk_f16_f32 v69, v50, v69
  v_accvgpr_write_b32 a37, v69
  v_lshlrev_b32 v50, 16, v70
  v_and_b32 v70, 0xffff0000, v70
  v_cvt_pk_f16_f32 v70, v50, v70
  v_accvgpr_write_b32 a38, v70
  v_lshlrev_b32 v50, 16, v71
  v_and_b32 v71, 0xffff0000, v71
  v_cvt_pk_f16_f32 v71, v50, v71
  v_accvgpr_write_b32 a39, v71
  v_lshlrev_b32 v50, 16, v72
  v_and_b32 v72, 0xffff0000, v72
  v_cvt_pk_f16_f32 v72, v50, v72
  v_accvgpr_write_b32 a56, v72
  v_lshlrev_b32 v50, 16, v73
  v_and_b32 v73, 0xffff0000, v73
  v_cvt_pk_f16_f32 v73, v50, v73
  v_accvgpr_write_b32 a57, v73
  v_lshlrev_b32 v50, 16, v74
  v_and_b32 v74, 0xffff0000, v74
  v_cvt_pk_f16_f32 v74, v50, v74
  v_accvgpr_write_b32 a58, v74
  v_lshlrev_b32 v50, 16, v75
  v_and_b32 v75, 0xffff0000, v75
  v_cvt_pk_f16_f32 v75, v50, v75
  v_accvgpr_write_b32 a59, v75
  s_waitcnt vmcnt(0)
  s_barrier
  s_add_u32 s12, s44, 81068032
  s_addc_u32 s13, s45, 0
  s_mov_b32 s14, 116736
  s_mov_b32 s15, 0x00020000
  s_add_u32 s28, s44, 114294784
  s_addc_u32 s29, s45, 0
  s_mov_b32 s30, 83886080
  s_mov_b32 s31, 0x00020000
  s_mul_i32 s64, s59, 40960
  s_lshl_b32 s21, s87, 10
  s_add_u32 s64, s64, s21
  s_add_u32 s64, s64, 1310720
  s_lshl_b32 s79, s59, 7
  s_and_b32 s21, s51, 12
  s_add_u32 s79, s79, s21
  s_add_u32 s79, s79, 95232
  v_mov_b32 v94, 0
  v_mov_b32 v95, 0
  s_lshl_b32 s90, s58, 7
  s_lshl_b32 s21, s56, 3
  s_add_u32 s90, s90, s21
  s_add_u32 s90, s90, 19456
  s_cmp_eq_u32 s56, 0
  s_cselect_b32 s65, s90, 0x80000000
  s_mov_b32 s69, 0
  v_lshlrev_b32 v88, 3, v1
  s_cmp_lg_u32 s20, 0
  s_cbranch_scc1 fm_9
  s_bfe_u32 s82, s50, 0x10001
  s_lshl_b32 s82, s82, 5
  s_lshr_b32 s21, s50, 2
  s_add_u32 s82, s82, s21
  s_and_b32 s80, s50, 1
  s_lshl_b32 s80, s80, 4
  s_add_u32 s80, s80, 16
  s_mov_b32 s101, 0
  s_branch fm_10
fm_8:
  s_sleep 8
  buffer_load_dword v238, v239, s[32:35], 0 offen sc1
  s_add_u32 s101, s101, 1
  s_cmp_gt_u32 s101, 131072
  s_cbranch_scc1 end0
  s_waitcnt vmcnt(0)
fm_10:
  v_readlane_b32 s22, v238, 0
  v_readlane_b32 s23, v238, 32
  s_add_u32 s22, s22, s23
  v_readlane_b32 s23, v238, 1
  s_add_u32 s22, s22, s23
  v_readlane_b32 s23, v238, 33
  s_add_u32 s22, s22, s23
  v_readlane_b32 s23, v238, 2
  s_add_u32 s22, s22, s23
  v_readlane_b32 s23, v238, 34
  s_add_u32 s22, s22, s23
  v_readlane_b32 s23, v238, 3
  s_add_u32 s22, s22, s23
  v_readlane_b32 s23, v238, 35
  s_add_u32 s22, s22, s23
  v_readlane_b32 s21, v238, 19
  v_readlane_b32 s23, v238, 21
  s_cmp_ge_u32 s22, 256
  s_cselect_b32 s23, s23, 0
  s_cmp_ge_u32 s21, 32
  s_cselect_b32 s23, s23, 0
  s_cmp_eq_u32 s23, 0
  s_cbranch_scc1 fm_8
  v_readlane_b32 s21, v238, s82
  s_cmp_ge_u32 s21, s80
  s_cselect_b32 s81, 1, 0
  s_andn2_b32 s53, s81, s53
  v_mov_b32 v244, s23
  v_mov_b32 v245, s53
  v_mov_b32 v236, 0
  ds_write_b64 v236, v[244:245]
  s_waitcnt lgkmcnt(0)
fm_9:
  s_barrier
  v_mov_b32 v236, 0
  ds_read_b64 v[244:245], v236
  buffer_load_dword v94, v95, s[12:15], s79 offen sc1
  s_and_b32 s21, s51, 3
  s_mul_i32 s21, s21, 540672
  buffer_load_dwordx2 v[96:97], v9, s[8:11], s21 offen sc1
  buffer_load_dwordx4 v[96:99], v8, s[8:11], s21 offen offset:0 sc1
  buffer_load_dwordx4 v[96:99], v8, s[8:11], s21 offen offset:1024 sc1
  buffer_load_dwordx4 v[96:99], v10, s[8:11], s21 offen offset:0 sc1
  buffer_load_dwordx4 v[96:99], v10, s[8:11], s21 offen offset:1024 sc1
  buffer_load_dwordx4 v[96:99], v10, s[8:11], s21 offen offset:2048 sc1
  s_waitcnt lgkmcnt(0)
  v_readfirstlane_b32 s53, v245
  v_add_u32 v237, -1, v244
  v_lshlrev_b32 v237, 13, v237
  v_xor_b32 v237, 0, v237
  v_add_u32 v13, v13, v237
  v_add_u32 v4, v4, v237
  s_lshl_b32 s21, s50, 7
  s_add_u32 s21, s21, 0
  s_cmp_lg_u32 s20, 0
  s_cbranch_scc1 wf_12
  v_mov_b32 v240, 0
  s_mov_b32 s101, 0
wf_11:
  buffer_load_dword v241, v240, s[12:15], s21 offen sc1
  s_add_u32 s101, s101, 1
  s_cmp_gt_u32 s101, 131072
  s_cbranch_scc1 end0
  s_waitcnt vmcnt(0)
  v_readfirstlane_b32 s100, v241
  s_cmp_ge_u32 s100, 8
  s_cbranch_scc1 wf_12
  s_sleep 6
  s_branch wf_11
wf_12:
  s_barrier
  s_cmp_ge_u32 s20, 2
  s_cbranch_scc1 pf_13
  buffer_load_dwordx4 v[168:171], v18, s[16:19], 0 offen sc1
  buffer_load_dwordx2 v[172:173], v20, s[16:19], 0 offen sc1
pf_13:
  s_waitcnt vmcnt(6)
  v_readfirstlane_b32 s21, v94
  s_mov_b32 s87, 1
  s_cmp_eq_u32 s21, 0
  s_cbranch_scc1 pf_14
  s_mov_b32 s87, 0
  s_sub_u32 s21, s64, 1310720
  buffer_load_dwordx4 v[176:179], v16, s[28:31], s21 offen offset:0 sc1
  buffer_load_dwordx4 v[180:183], v16, s[28:31], s21 offen offset:1024 sc1
  buffer_load_dwordx4 v[184:187], v16, s[28:31], s21 offen offset:2048 sc1
pf_14:
  v_add_u32 v242, 1088, v5
  v_add_u32 v243, 2176, v5
  v_add_u32 v244, 3264, v5
  v_add_u32 v245, 4352, v5
  s_mov_b32 s52, 0
  s_mov_b32 s89, 0x05040100
  v_mov_b32 v52, 0
  v_mov_b32 v53, 0
  v_mov_b32 v54, 0
  v_mov_b32 v55, 0
  v_mov_b32 v56, 0
  v_mov_b32 v57, 0
  v_mov_b32 v58, 0
  v_mov_b32 v59, 0
  v_mov_b32 v60, 0
  v_mov_b32 v61, 0
  v_mov_b32 v62, 0
  v_mov_b32 v63, 0
  v_mov_b32 v64, 0
  v_mov_b32 v65, 0
  v_mov_b32 v66, 0
  v_mov_b32 v67, 0
  v_mov_b32 v68, 0
  v_mov_b32 v69, 0
  v_mov_b32 v70, 0
  v_mov_b32 v71, 0
  v_mov_b32 v72, 0
  v_mov_b32 v73, 0
  v_mov_b32 v74, 0
  v_mov_b32 v75, 0
  v_mov_b32 v76, 0
  v_mov_b32 v77, 0
  v_mov_b32 v78, 0
  v_mov_b32 v79, 0
  v_mov_b32 v80, 0
  v_mov_b32 v81, 0
  v_mov_b32 v82, 0
  v_mov_b32 v83, 0
  v_mov_b32 v84, 0
  v_mov_b32 v85, 0
  v_mov_b32 v86, 0
  v_mov_b32 v87, 0
  v_mov_b32 v156, 0
  v_mov_b32 v157, 0
  v_mov_b32 v158, 0
  v_mov_b32 v159, 0
  s_and_b32 s21, s52, 3
  s_mul_i32 s81, s21, 540672
  s_lshl_b32 s84, s21, 15
  s_add_u32 s21, s52, 2
  s_and_b32 s21, s21, 3
  s_mul_i32 s82, s21, 540672
  s_add_u32 s21, s52, 3
  s_and_b32 s21, s21, 3
  s_lshl_b32 s83, s21, 15
  s_add_u32 s21, s52, 1
  s_and_b32 s22, s21, 3
  s_lshl_b32 s3, s22, 15
  s_mul_i32 s80, s21, 393216
  s_add_u32 s46, s21, 1
  s_min_u32 s46, s46, 64
  s_mul_i32 s85, s52, 98304
  s_mul_i32 s57, s52, 327680
  s_add_u32 s57, s57, 42991616

  s_bfe_u32 s88, s52, 0x10002
  s_add_u32 s78, s81, 278528
  s_max_u32 s21, s52, 1
  s_sub_u32 s21, s21, 1
  s_cmp_lt_u32 s52, 60
  s_cselect_b32 s66, s65, 0x80000000
  s_cselect_b32 s68, 15, 1
  s_cmp_ge_u32 s52, 61
  s_cselect_b32 s66, s90, s66
  s_cselect_b32 s67, s52, s21
  s_cmp_eq_u32 s53, 0
  s_cbranch_scc1 A1_19
  s_cmp_eq_u32 s20, 0
  s_cbranch_scc1 A1_15
  s_cmp_eq_u32 s20, 1
  s_cbranch_scc1 A1_16
  s_cmp_eq_u32 s20, 2
  s_cbranch_scc1 A1_17
  s_cmp_eq_u32 s20, 3
  s_cbranch_scc1 A1_18
  s_branch A1_19
step_20:
  s_add_u32 s21, s52, 2
  s_and_b32 s21, s21, 3
  s_mul_i32 s82, s21, 540672
  s_add_u32 s21, s52, 3
  s_and_b32 s21, s21, 3
  s_lshl_b32 s83, s21, 15
  s_add_u32 s21, s52, 1
  s_and_b32 s22, s21, 3
  s_lshl_b32 s3, s22, 15
  s_mul_i32 s80, s21, 393216
  s_add_u32 s46, s21, 1
  s_min_u32 s46, s46, 64
  s_mul_i32 s85, s52, 98304
  s_mul_i32 s57, s52, 327680
  s_add_u32 s57, s57, 42991616

  s_bfe_u32 s88, s52, 0x10002
  s_add_u32 s78, s81, 278528
  s_max_u32 s21, s52, 1
  s_sub_u32 s21, s21, 1
  s_cmp_lt_u32 s52, 60
  s_cselect_b32 s66, s65, 0x80000000
  s_cselect_b32 s68, 15, 1
  s_cmp_ge_u32 s52, 61
  s_cselect_b32 s66, s90, s66
  s_cselect_b32 s67, s52, s21
  v_mov_b32 v52, 0
  v_mov_b32 v53, 0
  v_mov_b32 v54, 0
  v_mov_b32 v55, 0
  v_mov_b32 v56, 0
  v_mov_b32 v57, 0
  v_mov_b32 v58, 0
  v_mov_b32 v59, 0
  v_mov_b32 v60, 0
  v_mov_b32 v61, 0
  v_mov_b32 v62, 0
  v_mov_b32 v63, 0
  v_mov_b32 v64, 0
  v_mov_b32 v65, 0
  v_mov_b32 v66, 0
  v_mov_b32 v67, 0
  v_mov_b32 v68, 0
  v_mov_b32 v69, 0
  v_mov_b32 v70, 0
  v_mov_b32 v71, 0
  v_mov_b32 v72, 0
  v_mov_b32 v73, 0
  v_mov_b32 v74, 0
  v_mov_b32 v75, 0
  v_mov_b32 v76, 0
  v_mov_b32 v77, 0
  v_mov_b32 v78, 0
  v_mov_b32 v79, 0
  v_mov_b32 v80, 0
  v_mov_b32 v81, 0
  v_mov_b32 v82, 0
  v_mov_b32 v83, 0
  v_mov_b32 v84, 0
  v_mov_b32 v85, 0
  v_mov_b32 v86, 0
  v_mov_b32 v87, 0
  s_sleep 4
  s_cmp_lt_i32 s55, 0
  s_cbranch_scc1 fl_24
fl_25:
  s_mov_b32 s54, 0
  buffer_load_dwordx4 v[32:35], v4, s[4:7], s84 offen offset:0 sc1
  buffer_load_dwordx4 v[36:39], v4, s[4:7], s84 offen offset:1024 sc1
  buffer_load_dwordx4 v[40:43], v4, s[4:7], s84 offen offset:2048 sc1
  s_waitcnt vmcnt(3)
  v_mov_b32 v176, v160
  v_mov_b32 v177, v161
  v_mov_b32 v178, v162
  v_mov_b32 v179, v163
  v_mov_b32 v180, v164
  v_mov_b32 v181, v165
  v_mov_b32 v182, v166
  v_mov_b32 v183, v167
  v_mov_b32 v184, v48
  v_mov_b32 v185, v49
  v_mov_b32 v186, v50
  v_mov_b32 v187, v51
  s_waitcnt vmcnt(0)
  v_bitop3_b32 v27, v35, v39, v43 bitop3:0x80
  v_perm_b32 v35, v39, v35, s89
  v_cmp_gt_u32 vcc, 0x48000000, v27
  v_mov_b32 v39, v42
  s_cbranch_vccnz pm_22
A1_15:
  v_smfmac_f32_16x16x32_f16 v[52:55], v[40:41], a[16:19], v44
  v_smfmac_f32_16x16x32_f16 v[64:67], v[40:41], a[76:79], v44
  v_smfmac_f32_16x16x32_f16 v[56:59], v[40:41], a[36:39], v44
  v_smfmac_f32_16x16x64_f16 v[52:55], v[32:35], a[0:7], v44
  v_smfmac_f32_16x16x64_f16 v[52:55], v[36:39], a[8:15], v44
  v_smfmac_f32_16x16x32_f16 v[68:71], v[40:41], a[96:99], v44
  v_smfmac_f32_16x16x64_f16 v[64:67], v[32:35], a[60:67], v44
  v_smfmac_f32_16x16x64_f16 v[64:67], v[36:39], a[68:75], v44
  v_smfmac_f32_16x16x32_f16 v[60:63], v[40:41], a[56:59], v44
  v_smfmac_f32_16x16x64_f16 v[56:59], v[32:35], a[20:27], v44
  v_smfmac_f32_16x16x64_f16 v[56:59], v[36:39], a[28:35], v44
  v_permlane32_swap_b32 v52, v64
  v_smfmac_f32_16x16x32_f16 v[72:75], v[40:41], a[116:119], v44
  v_permlane32_swap_b32 v53, v65
  v_add_f32 v52, v52, v64
  v_add_f32 v53, v53, v65
  v_smfmac_f32_16x16x64_f16 v[68:71], v[32:35], a[80:87], v44
  ds_write2_b32 v5, v52, v53 offset0:0 offset1:4
  v_smfmac_f32_16x16x64_f16 v[68:71], v[36:39], a[88:95], v44
  v_permlane32_swap_b32 v54, v66
  v_smfmac_f32_16x16x32_f16 v[76:79], v[40:41], a[136:139], v44
  v_permlane32_swap_b32 v55, v67
  v_add_f32 v54, v54, v66
  v_add_f32 v55, v55, v67
  v_smfmac_f32_16x16x64_f16 v[60:63], v[32:35], a[40:47], v44
  ds_write2_b32 v5, v54, v55 offset0:8 offset1:12
  v_smfmac_f32_16x16x64_f16 v[60:63], v[36:39], a[48:55], v44
  v_permlane32_swap_b32 v56, v68
  v_smfmac_f32_16x16x32_f16 v[80:83], v[40:41], a[156:159], v44
  v_permlane32_swap_b32 v57, v69
  v_add_f32 v56, v56, v68
  v_add_f32 v57, v57, v69
  v_smfmac_f32_16x16x64_f16 v[72:75], v[32:35], a[100:107], v44
  ds_write2_b32 v242, v56, v57 offset0:0 offset1:4
  v_smfmac_f32_16x16x64_f16 v[72:75], v[36:39], a[108:115], v44
  v_permlane32_swap_b32 v58, v70
  v_smfmac_f32_16x16x32_f16 v[84:87], v[40:41], a[176:179], v44
  v_permlane32_swap_b32 v59, v71
  v_add_f32 v58, v58, v70
  v_add_f32 v59, v59, v71
  v_smfmac_f32_16x16x64_f16 v[76:79], v[32:35], a[120:127], v44
  ds_write2_b32 v242, v58, v59 offset0:8 offset1:12
  v_smfmac_f32_16x16x64_f16 v[76:79], v[36:39], a[128:135], v44
  v_permlane32_swap_b32 v60, v72
  v_smfmac_f32_16x16x64_f16 v[80:83], v[32:35], a[140:147], v44
  v_permlane32_swap_b32 v61, v73
  v_add_f32 v60, v60, v72
  v_smfmac_f32_16x16x64_f16 v[80:83], v[36:39], a[148:155], v44
  v_add_f32 v61, v61, v73
  ds_write2_b32 v243, v60, v61 offset0:0 offset1:4
  v_smfmac_f32_16x16x64_f16 v[84:87], v[32:35], a[160:167], v44
  v_permlane32_swap_b32 v62, v74
  v_smfmac_f32_16x16x64_f16 v[84:87], v[36:39], a[168:175], v44
  v_permlane32_swap_b32 v63, v75
  v_add_f32 v62, v62, v74
  v_add_f32 v63, v63, v75
  ds_write2_b32 v243, v62, v63 offset0:8 offset1:12
  v_permlane32_swap_b32 v76, v80
  v_permlane32_swap_b32 v77, v81
  v_add_f32 v76, v76, v80
  v_add_f32 v77, v77, v81
  ds_write2_b32 v244, v76, v77 offset0:0 offset1:4
  v_permlane32_swap_b32 v78, v82
  v_permlane32_swap_b32 v79, v83
  v_add_f32 v78, v78, v82
  v_add_f32 v79, v79, v83
  ds_write2_b32 v244, v78, v79 offset0:8 offset1:12
  ds_write2_b32 v245, v84, v85 offset0:0 offset1:4
  ds_write2_b32 v245, v86, v87 offset0:8 offset1:12
  s_waitcnt lgkmcnt(0) vmcnt(0)
  s_barrier
  ds_read_b128 v[96:99], v45 offset:0
  ds_read_b128 v[108:111], v45 offset:5440
  ds_read_b128 v[100:103], v45 offset:1088
  ds_read_b128 v[112:115], v45 offset:6528
  ds_read_b128 v[104:107], v45 offset:2176
  ds_read_b128 v[116:119], v45 offset:7616
  s_waitcnt lgkmcnt(4)
  v_pk_add_f32 v[96:97], v[96:97], v[108:109]
  v_pk_add_f32 v[98:99], v[98:99], v[110:111]
  s_nop 0
  v_add_f32_dpp v108, v96, v96 row_ror:8 row_mask:0xf bank_mask:0xf
  v_add_f32_dpp v109, v97, v97 row_ror:8 row_mask:0xf bank_mask:0xf
  v_add_f32_dpp v110, v98, v98 row_ror:8 row_mask:0xf bank_mask:0xf
  v_add_f32_dpp v111, v99, v99 row_ror:8 row_mask:0xf bank_mask:0xf
  v_cvt_pk_bf16_f32 v212, v108, v109
  v_cvt_pk_bf16_f32 v213, v110, v111
  s_waitcnt lgkmcnt(2)
  v_pk_add_f32 v[100:101], v[100:101], v[112:113]
  v_pk_add_f32 v[102:103], v[102:103], v[114:115]
  s_nop 0
  v_add_f32_dpp v112, v100, v100 row_ror:8 row_mask:0xf bank_mask:0xf
  v_add_f32_dpp v113, v101, v101 row_ror:8 row_mask:0xf bank_mask:0xf
  v_add_f32_dpp v114, v102, v102 row_ror:8 row_mask:0xf bank_mask:0xf
  v_add_f32_dpp v115, v103, v103 row_ror:8 row_mask:0xf bank_mask:0xf
  v_cvt_pk_bf16_f32 v214, v112, v113
  v_cvt_pk_bf16_f32 v215, v114, v115
  s_waitcnt lgkmcnt(0)
  v_pk_add_f32 v[104:105], v[104:105], v[116:117]
  v_pk_add_f32 v[106:107], v[106:107], v[118:119]
  v_mfma_f32_16x16x32_bf16 v[96:99], v[168:171], v[212:215], 0
  v_add_f32_dpp v116, v104, v104 row_ror:8 row_mask:0xf bank_mask:0xf
  v_add_f32_dpp v117, v105, v105 row_ror:8 row_mask:0xf bank_mask:0xf
  v_add_f32_dpp v118, v106, v106 row_ror:8 row_mask:0xf bank_mask:0xf
  v_add_f32_dpp v119, v107, v107 row_ror:8 row_mask:0xf bank_mask:0xf
  v_cvt_pk_bf16_f32 v216, v116, v117
  v_cvt_pk_bf16_f32 v217, v118, v119
  s_nop 1
  v_mfma_f32_16x16x32_bf16 v[96:99], v[172:175], v[216:219], v[96:99]
  s_mov_b64 exec, s[74:75]
  s_nop 6
  v_cvt_pk_f16_f32 v100, v96, v97
  v_cvt_pk_f16_f32 v101, v98, v99
  v_and_or_b32 v100, v100, -2, s88
  buffer_store_dwordx2 v[100:101], v7, s[8:11], s81 offen
  s_mov_b64 exec, -1
  s_cmp_eq_u32 s52, 63
  s_cbranch_scc1 last_21
  s_sleep 5
  s_mov_b32 s54, 0
  buffer_load_dwordx2 v[248:249], v9, s[8:11], s81 offen sc1
  buffer_load_dwordx4 v[112:115], v8, s[8:11], s81 offen offset:0 sc1
  buffer_load_dwordx4 v[116:119], v8, s[8:11], s81 offen offset:1024 sc1
  s_sleep 2
  buffer_load_dwordx4 v[144:147], v10, s[8:11], s81 offen offset:0 sc1
  buffer_load_dwordx4 v[148:151], v10, s[8:11], s81 offen offset:1024 sc1
  buffer_load_dwordx4 v[152:155], v10, s[8:11], s81 offen offset:2048 sc1
  v_mov_b32 v188, 0
  v_mov_b32 v189, 0
  v_mov_b32 v190, 0
  v_mov_b32 v191, 0
  v_mov_b32 v192, 0
  v_mov_b32 v193, 0
  v_mov_b32 v194, 0
  v_mov_b32 v195, 0
  v_mov_b32 v196, 0
  v_mov_b32 v197, 0
  v_mov_b32 v198, 0
  v_mov_b32 v199, 0
  v_readfirstlane_b32 s21, v94
  s_add_u32 s22, s46, 2
  s_min_u32 s22, s22, 64
  s_sub_u32 s55, s21, s22
  s_sub_u32 s56, s21, s46
  s_waitcnt vmcnt(5)
  v_xor_b32 v96, s88, v248
  s_nop 0
  v_permlane16_swap_b32 v248, v249
  v_fma_mix_f32 v250, v248, 1.0, v249 op_sel:[0,0,0] op_sel_hi:[1,0,1]
  v_fma_mix_f32 v251, v248, 1.0, v249 op_sel:[1,0,1] op_sel_hi:[1,0,1]
  v_mov_b32 v248, v250
  v_mov_b32 v249, v251
  s_nop 0
  v_permlane32_swap_b32 v248, v250
  v_permlane32_swap_b32 v249, v251
  s_waitcnt vmcnt(3)
  v_bitop3_b32 v97, v112, v114, s88 bitop3:0x7e
  v_bitop3_b32 v98, v116, v118, s88 bitop3:0x7e
  v_fma_mix_f32 v120, v112, 1.0, v116 op_sel:[0,0,0] op_sel_hi:[1,0,1]
  v_or3_b32 v27, v96, v97, v98
  v_fma_mix_f32 v124, v114, 1.0, v118 op_sel:[0,0,0] op_sel_hi:[1,0,1]
  v_and_b32 v27, 1, v27
  v_fma_mix_f32 v121, v112, 1.0, v116 op_sel:[1,0,1] op_sel_hi:[1,0,1]
  v_cmp_ne_u32 vcc, 0, v27
  v_fma_mix_f32 v125, v114, 1.0, v118 op_sel:[1,0,1] op_sel_hi:[1,0,1]
  v_fma_mix_f32 v122, v113, 1.0, v117 op_sel:[0,0,0] op_sel_hi:[1,0,1]
  v_fma_mix_f32 v126, v115, 1.0, v119 op_sel:[0,0,0] op_sel_hi:[1,0,1]
  s_cbranch_vccnz psr_27
psj_28:
  s_cmp_lt_i32 s56, 0
  s_cbranch_scc1 kvw_30
kvok_31:
  v_fma_mix_f32 v123, v113, 1.0, v117 op_sel:[1,0,1] op_sel_hi:[1,0,1]
  v_fma_mix_f32 v127, v115, 1.0, v119 op_sel:[1,0,1] op_sel_hi:[1,0,1]
  v_permlane32_swap_b32 v120, v124
  v_permlane32_swap_b32 v121, v125
  v_permlane32_swap_b32 v122, v126
  v_permlane32_swap_b32 v123, v127
  v_pk_add_f32 v[120:121], v[120:121], v[124:125]
  v_pk_add_f32 v[122:123], v[122:123], v[126:127]
  v_pk_add_f32 v[124:125], v[248:249], v[250:251]
  v_max3_f32 v236, v120, v121, v122
  v_max3_f32 v237, v123, v124, v125
  v_max_f32 v236, v236, v237
  s_nop 1
  v_max_f32_dpp v236, v236, v236 row_ror:8 row_mask:0xf bank_mask:0xf
  v_mov_b32 v237, v236
  s_nop 1
  v_permlane32_swap_b32 v236, v237
  v_max_f32 v236, v236, v237
  v_mov_b32 v237, v236
  s_nop 1
  v_permlane16_swap_b32 v236, v237
  v_max_f32 v236, v236, v237
  s_waitcnt vmcnt(0)
  v_max3_u32 v27, v144, v146, v148
  v_max3_u32 v27, v27, v150, v152
  v_max3_u32 v27, v27, v154, v154
  v_cmp_eq_u32 vcc, -1, v27
  s_nop 1
  s_cbranch_vccnz pv_26
pvj_29:
  v_mul_f32 v236, s86, v236
  v_smfmac_f32_16x16x64_bf16 v[188:191], v[144:147], a[180:187], v44
  v_fma_f32 v120, v120, s86, -v236
  v_smfmac_f32_16x16x64_bf16 v[188:191], v[148:151], a[188:195], v44
  v_fma_f32 v121, v121, s86, -v236
  v_smfmac_f32_16x16x64_bf16 v[188:191], v[152:155], a[196:203], v44
  buffer_load_dwordx4 v[160:163], v17, s[28:31], s64 offen offset:0 sc1
  v_fma_f32 v122, v122, s86, -v236
  v_smfmac_f32_16x16x64_bf16 v[192:195], v[144:147], a[204:211], v44
  v_fma_f32 v123, v123, s86, -v236
  v_smfmac_f32_16x16x64_bf16 v[192:195], v[148:151], a[212:219], v44
  buffer_load_dwordx4 v[164:167], v16, s[28:31], s64 offen offset:1024 sc1
  v_fma_f32 v124, v124, s86, -v236
  v_smfmac_f32_16x16x64_bf16 v[192:195], v[152:155], a[220:227], v44
  v_fma_f32 v125, v125, s86, -v236
  v_smfmac_f32_16x16x64_bf16 v[196:199], v[144:147], a[228:235], v44
  buffer_load_dwordx4 v[48:51], v26, s[28:31], s64 offen offset:2048 sc1
  v_exp_f32 v120, v120
  v_smfmac_f32_16x16x64_bf16 v[196:199], v[148:151], a[236:243], v44
  v_exp_f32 v121, v121
  v_smfmac_f32_16x16x64_bf16 v[196:199], v[152:155], a[244:251], v44
  buffer_load_dwordx4 v[168:171], v18, s[16:19], s80 offen sc1
  v_exp_f32 v122, v122
  buffer_load_dwordx2 v[172:173], v20, s[16:19], s80 offen sc1
  v_exp_f32 v123, v123
  v_exp_f32 v124, v124
  v_exp_f32 v125, v125
  s_mov_b64 exec, s[60:61]
  v_cvt_pk_bf16_f32 v220, v120, v121
  v_cvt_pk_bf16_f32 v221, v122, v123
  v_cvt_pk_bf16_f32 v224, v124, v125
  s_mov_b64 exec, s[62:63]
  v_cvt_pk_bf16_f32 v222, v120, v121
  v_cvt_pk_bf16_f32 v223, v122, v123
  v_cvt_pk_bf16_f32 v225, v124, v125
  s_mov_b64 exec, -1
  v_pk_add_f32 v[126:127], v[120:121], v[122:123]
  v_add_f32 v128, v124, v125
  v_mfma_f32_16x16x32_bf16 v[200:203], v[176:179], v[220:223], 0
  v_add_f32 v236, v126, v127
  v_fmac_f32 v236, v128, v89
  v_cvt_pk_bf16_f32 v228, v188, v189
  v_cvt_pk_bf16_f32 v229, v190, v191
  v_mfma_f32_16x16x32_bf16 v[204:207], v[180:183], v[220:223], 0
  v_cvt_pk_bf16_f32 v230, v192, v193
  v_cvt_pk_bf16_f32 v231, v194, v195
  v_mfma_f32_16x16x32_bf16 v[208:211], v[184:187], v[220:223], 0
  v_cvt_pk_bf16_f32 v232, v196, v197
  v_cvt_pk_bf16_f32 v233, v198, v199
  v_add_f32_dpp v236, v236, v236 row_ror:8 row_mask:0xf bank_mask:0xf
  v_mov_b32 v237, v236
  s_nop 0
  v_mfma_f32_16x16x32_bf16 v[200:203], v[228:231], v[224:227], v[200:203]
  v_mfma_f32_16x16x32_bf16 v[204:207], v[230:233], v[224:227], v[204:207]
  v_permlane32_swap_b32 v236, v237
  v_add_f32 v236, v236, v237
  v_mov_b32 v237, v236
  v_mfma_f32_16x16x32_bf16 v[208:211], v[232:235], v[224:227], v[208:211]
  s_nop 0
  v_permlane16_swap_b32 v236, v237
  v_add_f32 v236, v236, v237
  v_rcp_f32 v236, v236
  s_nop 2
  v_pk_mul_f32 v[200:201], v[200:201], v[236:237] op_sel_hi:[1,0]
  v_pk_mul_f32 v[202:203], v[202:203], v[236:237] op_sel_hi:[1,0]
  ds_write_b128 v11, v[200:203] offset:0
  v_pk_mul_f32 v[204:205], v[204:205], v[236:237] op_sel_hi:[1,0]
  v_pk_mul_f32 v[206:207], v[206:207], v[236:237] op_sel_hi:[1,0]
  ds_write_b128 v11, v[204:207] offset:1024
  v_pk_mul_f32 v[208:209], v[208:209], v[236:237] op_sel_hi:[1,0]
  v_pk_mul_f32 v[210:211], v[210:211], v[236:237] op_sel_hi:[1,0]
  ds_write_b128 v11, v[208:211] offset:2048
  s_waitcnt lgkmcnt(0)
  s_barrier
  ds_read_b64 v[96:97], v12 offset:0
  ds_read_b64 v[98:99], v12 offset:128
  ds_read_b64 v[100:101], v12 offset:3072
  ds_read_b64 v[102:103], v12 offset:3200
  ds_read_b64 v[104:105], v12 offset:6144
  ds_read_b64 v[106:107], v12 offset:6272
  ds_read_b64 v[108:109], v12 offset:9216
  ds_read_b64 v[110:111], v12 offset:9344
  s_waitcnt lgkmcnt(6)
  v_pk_add_f32 v[96:97], v[96:97], v[98:99]
  s_waitcnt lgkmcnt(4)
  v_pk_add_f32 v[100:101], v[100:101], v[102:103]
  s_waitcnt lgkmcnt(2)
  v_pk_add_f32 v[104:105], v[104:105], v[106:107]
  v_pk_add_f32 v[96:97], v[96:97], v[100:101]
  s_waitcnt lgkmcnt(0)
  v_pk_add_f32 v[108:109], v[108:109], v[110:111]
  v_pk_add_f32 v[96:97], v[96:97], v[104:105]
  v_pk_add_f32 v[96:97], v[96:97], v[108:109]
  v_cvt_pk_f16_f32 v100, v96, v97
  v_perm_b32 v100, s91, v100, v14
  buffer_atomic_pk_add_f16 v100, v13, s[4:7], s3 offen
  v_mov_b32 v200, v196
  v_mov_b32 v201, v197
  v_mov_b32 v202, v198
  v_mov_b32 v203, v199
  v_permlane32_swap_b32 v188, v192
  v_permlane32_swap_b32 v189, v193
  v_permlane32_swap_b32 v190, v194
  v_permlane32_swap_b32 v191, v195
  v_permlane32_swap_b32 v196, v200
  v_permlane32_swap_b32 v197, v201
  v_permlane32_swap_b32 v198, v202
  v_permlane32_swap_b32 v199, v203
  v_pk_add_f32 v[188:189], v[188:189], v[192:193]
  v_pk_add_f32 v[190:191], v[190:191], v[194:195]
  v_pk_add_f32 v[196:197], v[196:197], v[200:201]
  v_pk_add_f32 v[198:199], v[198:199], v[202:203]
  v_cvt_pk_bf16_f32 v252, v188, v189
  v_cvt_pk_bf16_f32 v254, v196, v197
  v_cvt_pk_bf16_f32 v253, v190, v191
  v_cvt_pk_bf16_f32 v255, v198, v199
  s_nop 0
  v_permlane16_swap_b32 v252, v254
  v_permlane16_swap_b32 v253, v255
  v_min_u32 v252, -2, v252
  s_mov_b64 exec, s[76:77]
  buffer_store_dwordx4 v[252:255], v15, s[24:27], s57 offen sc1
  s_mov_b64 exec, -1
  s_add_u32 s64, s64, 1310720
  s_add_u32 s52, s52, 1
  s_and_b32 s21, s52, 3
  s_mul_i32 s81, s21, 540672
  s_lshl_b32 s84, s21, 15
  s_branch step_20
fl_24:
  buffer_load_dword v94, v95, s[12:15], s79 offen sc1
  s_branch fl_25
pm_22:
  s_cmp_gt_u32 s52, 3
  s_cbranch_scc1 op_32
  v_readfirstlane_b32 s21, v94
  s_cmp_ge_u32 s21, s46
  s_cbranch_scc1 op_32
  buffer_load_dword v94, v95, s[12:15], s79 offen sc1
  s_waitcnt vmcnt(0)
  v_readfirstlane_b32 s21, v94
  s_add_u32 s22, s46, 2
  s_min_u32 s22, s22, 64
  s_sub_u32 s55, s21, s22
  s_sub_u32 s56, s21, s46
  s_cmp_gt_u32 s21, s52
  s_cselect_b32 s21, s87, 0
  s_cmp_eq_u32 s21, 0
  s_cbranch_scc1 op_32
  s_mov_b32 s87, 0
  s_sub_u32 s21, s64, 1310720
  buffer_load_dwordx4 v[176:179], v16, s[28:31], s21 offen offset:0 sc1
  buffer_load_dwordx4 v[180:183], v16, s[28:31], s21 offen offset:1024 sc1
  buffer_load_dwordx4 v[184:187], v16, s[28:31], s21 offen offset:2048 sc1
op_32:
  buffer_load_dwordx4 v[32:35], v4, s[4:7], s84 offen offset:0 sc1
  buffer_load_dwordx4 v[36:39], v4, s[4:7], s84 offen offset:1024 sc1
  buffer_load_dwordx4 v[40:43], v4, s[4:7], s84 offen offset:2048 sc1
  s_add_u32 s54, s54, 1
  s_cmp_gt_u32 s54, 131072
  s_cbranch_scc1 end0
  s_waitcnt vmcnt(0)
  v_bitop3_b32 v27, v35, v39, v43 bitop3:0x80
  v_perm_b32 v35, v39, v35, s89
  v_cmp_gt_u32 vcc, 0x48000000, v27
  v_mov_b32 v39, v42
  s_cbranch_vccnz pm_22
  s_branch A1_15
pv_26:
  buffer_load_dwordx4 v[144:147], v10, s[8:11], s81 offen offset:0 sc1
  buffer_load_dwordx4 v[148:151], v10, s[8:11], s81 offen offset:1024 sc1
  buffer_load_dwordx4 v[152:155], v10, s[8:11], s81 offen offset:2048 sc1
  s_add_u32 s54, s54, 1
  s_cmp_gt_u32 s54, 131072
  s_cbranch_scc1 end0
  s_waitcnt vmcnt(0)
  v_max3_u32 v27, v144, v146, v148
  v_max3_u32 v27, v27, v150, v152
  v_max3_u32 v27, v27, v154, v154
  v_cmp_eq_u32 vcc, -1, v27
  s_nop 1
  s_cbranch_vccnz pv_26
  s_branch pvj_29
psr_27:
  s_cmp_gt_u32 s52, 3
  s_cbranch_scc1 op_33
  v_readfirstlane_b32 s21, v94
  s_cmp_ge_u32 s21, s46
  s_cbranch_scc1 op_33
  buffer_load_dword v94, v95, s[12:15], s79 offen sc1
  s_waitcnt vmcnt(0)
  v_readfirstlane_b32 s21, v94
  s_add_u32 s22, s46, 2
  s_min_u32 s22, s22, 64
  s_sub_u32 s55, s21, s22
  s_sub_u32 s56, s21, s46
  s_cmp_gt_u32 s21, s52
  s_cselect_b32 s21, s87, 0
  s_cmp_eq_u32 s21, 0
  s_cbranch_scc1 op_33
  s_mov_b32 s87, 0
  s_sub_u32 s21, s64, 1310720
  buffer_load_dwordx4 v[176:179], v16, s[28:31], s21 offen offset:0 sc1
  buffer_load_dwordx4 v[180:183], v16, s[28:31], s21 offen offset:1024 sc1
  buffer_load_dwordx4 v[184:187], v16, s[28:31], s21 offen offset:2048 sc1
op_33:
  buffer_load_dwordx2 v[248:249], v9, s[8:11], s81 offen sc1
  buffer_load_dwordx4 v[112:115], v8, s[8:11], s81 offen offset:0 sc1
  buffer_load_dwordx4 v[116:119], v8, s[8:11], s81 offen offset:1024 sc1
  s_add_u32 s54, s54, 1
  s_cmp_gt_u32 s54, 131072
  s_cbranch_scc1 end0
  s_waitcnt vmcnt(2)
  v_xor_b32 v96, s88, v248
  s_nop 0
  v_permlane16_swap_b32 v248, v249
  v_fma_mix_f32 v250, v248, 1.0, v249 op_sel:[0,0,0] op_sel_hi:[1,0,1]
  v_fma_mix_f32 v251, v248, 1.0, v249 op_sel:[1,0,1] op_sel_hi:[1,0,1]
  v_mov_b32 v248, v250
  v_mov_b32 v249, v251
  s_nop 0
  v_permlane32_swap_b32 v248, v250
  v_permlane32_swap_b32 v249, v251
  s_waitcnt vmcnt(0)
  v_bitop3_b32 v97, v112, v114, s88 bitop3:0x7e
  v_bitop3_b32 v98, v116, v118, s88 bitop3:0x7e
  v_fma_mix_f32 v120, v112, 1.0, v116 op_sel:[0,0,0] op_sel_hi:[1,0,1]
  v_or3_b32 v27, v96, v97, v98
  v_fma_mix_f32 v124, v114, 1.0, v118 op_sel:[0,0,0] op_sel_hi:[1,0,1]
  v_and_b32 v27, 1, v27
  v_fma_mix_f32 v121, v112, 1.0, v116 op_sel:[1,0,1] op_sel_hi:[1,0,1]
  v_cmp_ne_u32 vcc, 0, v27
  v_fma_mix_f32 v125, v114, 1.0, v118 op_sel:[1,0,1] op_sel_hi:[1,0,1]
  v_fma_mix_f32 v122, v113, 1.0, v117 op_sel:[0,0,0] op_sel_hi:[1,0,1]
  v_fma_mix_f32 v126, v115, 1.0, v119 op_sel:[0,0,0] op_sel_hi:[1,0,1]
  s_cbranch_vccnz psr_27
  s_branch psj_28
kvw_30:
  s_mov_b32 s22, s87
  s_cmp_eq_u32 s52, 0
  s_cselect_b32 s23, s87, s46
  s_cselect_b32 s55, 0, s55
  s_cselect_b32 s87, 1, 0
  s_cmp_eq_u32 s23, 0
  s_cbranch_scc1 kvok_31
  v_mov_b32 v236, 0
  s_mov_b32 s101, 0
wf_34:
  buffer_load_dword v237, v236, s[12:15], s79 offen sc1
  s_add_u32 s101, s101, 1
  s_cmp_gt_u32 s101, 131072
  s_cbranch_scc1 end0
  s_waitcnt vmcnt(0)
  v_readfirstlane_b32 s100, v237
  s_cmp_ge_u32 s100, s23
  s_cbranch_scc1 wf_35
  s_sleep 3
  s_branch wf_34
wf_35:
  s_cmp_eq_u32 s22, 0
  s_cbranch_scc1 kvok_31
  s_sub_u32 s21, s64, 1310720
  buffer_load_dwordx4 v[176:179], v16, s[28:31], s21 offen offset:0 sc1
  buffer_load_dwordx4 v[180:183], v16, s[28:31], s21 offen offset:1024 sc1
  buffer_load_dwordx4 v[184:187], v16, s[28:31], s21 offen offset:2048 sc1
  s_waitcnt vmcnt(0)
  s_branch kvok_31
last_21:
  v_mov_b32 v188, 0
  v_mov_b32 v189, 0
  v_mov_b32 v190, 0
  v_mov_b32 v191, 0
  v_mov_b32 v192, 0
  v_mov_b32 v193, 0
  v_mov_b32 v194, 0
  v_mov_b32 v195, 0
  v_mov_b32 v196, 0
  v_mov_b32 v197, 0
  v_mov_b32 v198, 0
  v_mov_b32 v199, 0
  s_sleep 4
  s_mov_b32 s54, 0
lv_36:
  buffer_load_dwordx4 v[144:147], v10, s[8:11], s81 offen offset:0 sc1
  buffer_load_dwordx4 v[148:151], v10, s[8:11], s81 offen offset:1024 sc1
  buffer_load_dwordx4 v[152:155], v10, s[8:11], s81 offen offset:2048 sc1
  s_add_u32 s54, s54, 1
  s_cmp_gt_u32 s54, 131072
  s_cbranch_scc1 end0
  s_waitcnt vmcnt(0)
  v_max3_u32 v27, v144, v146, v148
  v_max3_u32 v27, v27, v150, v152
  v_max3_u32 v27, v27, v154, v154
  v_cmp_eq_u32 vcc, -1, v27
  s_nop 1
  s_cbranch_vccnz lv_36
  v_smfmac_f32_16x16x64_bf16 v[188:191], v[144:147], a[180:187], v44
  v_smfmac_f32_16x16x64_bf16 v[192:195], v[144:147], a[204:211], v44
  v_smfmac_f32_16x16x64_bf16 v[196:199], v[144:147], a[228:235], v44
  v_smfmac_f32_16x16x64_bf16 v[188:191], v[148:151], a[188:195], v44
  v_smfmac_f32_16x16x64_bf16 v[192:195], v[148:151], a[212:219], v44
  v_smfmac_f32_16x16x64_bf16 v[196:199], v[148:151], a[236:243], v44
  v_smfmac_f32_16x16x64_bf16 v[188:191], v[152:155], a[196:203], v44
  v_smfmac_f32_16x16x64_bf16 v[192:195], v[152:155], a[220:227], v44
  v_smfmac_f32_16x16x64_bf16 v[196:199], v[152:155], a[244:251], v44
  s_nop 7
  v_mov_b32 v200, v196
  v_mov_b32 v201, v197
  v_mov_b32 v202, v198
  v_mov_b32 v203, v199
  v_permlane32_swap_b32 v188, v192
  v_permlane32_swap_b32 v189, v193
  v_permlane32_swap_b32 v190, v194
  v_permlane32_swap_b32 v191, v195
  v_permlane32_swap_b32 v196, v200
  v_permlane32_swap_b32 v197, v201
  v_permlane32_swap_b32 v198, v202
  v_permlane32_swap_b32 v199, v203
  v_pk_add_f32 v[188:189], v[188:189], v[192:193]
  v_pk_add_f32 v[190:191], v[190:191], v[194:195]
  v_pk_add_f32 v[196:197], v[196:197], v[200:201]
  v_pk_add_f32 v[198:199], v[198:199], v[202:203]
  v_cvt_pk_bf16_f32 v252, v188, v189
  v_cvt_pk_bf16_f32 v254, v196, v197
  v_cvt_pk_bf16_f32 v253, v190, v191
  v_cvt_pk_bf16_f32 v255, v198, v199
  s_nop 0
  v_permlane16_swap_b32 v252, v254
  v_permlane16_swap_b32 v253, v255
  v_min_u32 v252, -2, v252
  s_mov_b64 exec, s[76:77]
  buffer_store_dwordx4 v[252:255], v15, s[24:27], s57 offen sc1
  s_mov_b64 exec, -1
  v_mov_b32 v246, 80
  v_mov_b32 v247, 1
  s_mov_b64 exec, 1
  buffer_atomic_add v247, v246, s[32:35], 0 offen sc0 sc1
  s_mov_b64 exec, -1
clm_37:
  s_branch chain_done
step_38:
  s_add_u32 s21, s52, 2
  s_and_b32 s21, s21, 3
  s_mul_i32 s82, s21, 540672
  s_add_u32 s21, s52, 3
  s_and_b32 s21, s21, 3
  s_lshl_b32 s83, s21, 15
  s_add_u32 s21, s52, 1
  s_and_b32 s22, s21, 3
  s_lshl_b32 s3, s22, 15
  s_mul_i32 s80, s21, 393216
  s_add_u32 s46, s21, 1
  s_min_u32 s46, s46, 64
  s_mul_i32 s85, s52, 98304
  s_mul_i32 s57, s52, 327680
  s_add_u32 s57, s57, 42991616

  s_bfe_u32 s88, s52, 0x10002
  s_add_u32 s78, s81, 278528
  s_max_u32 s21, s52, 1
  s_sub_u32 s21, s21, 1
  s_cmp_lt_u32 s52, 60
  s_cselect_b32 s66, s65, 0x80000000
  s_cselect_b32 s68, 15, 1
  s_cmp_ge_u32 s52, 61
  s_cselect_b32 s66, s90, s66
  s_cselect_b32 s67, s52, s21
  v_mov_b32 v52, 0
  v_mov_b32 v53, 0
  v_mov_b32 v54, 0
  v_mov_b32 v55, 0
  v_mov_b32 v56, 0
  v_mov_b32 v57, 0
  v_mov_b32 v58, 0
  v_mov_b32 v59, 0
  v_mov_b32 v60, 0
  v_mov_b32 v61, 0
  v_mov_b32 v62, 0
  v_mov_b32 v63, 0
  v_mov_b32 v64, 0
  v_mov_b32 v65, 0
  v_mov_b32 v66, 0
  v_mov_b32 v67, 0
  v_mov_b32 v68, 0
  v_mov_b32 v69, 0
  v_mov_b32 v70, 0
  v_mov_b32 v71, 0
  v_mov_b32 v72, 0
  v_mov_b32 v73, 0
  v_mov_b32 v74, 0
  v_mov_b32 v75, 0
  v_mov_b32 v76, 0
  v_mov_b32 v77, 0
  v_mov_b32 v78, 0
  v_mov_b32 v79, 0
  v_mov_b32 v80, 0
  v_mov_b32 v81, 0
  v_mov_b32 v82, 0
  v_mov_b32 v83, 0
  v_mov_b32 v84, 0
  v_mov_b32 v85, 0
  v_mov_b32 v86, 0
  v_mov_b32 v87, 0
  s_sleep 4
  s_cmp_lt_i32 s55, 0
  s_cbranch_scc1 fl_42
fl_43:
  s_mov_b32 s54, 0
  buffer_load_dwordx4 v[32:35], v4, s[4:7], s84 offen offset:0 sc1
  buffer_load_dwordx4 v[36:39], v4, s[4:7], s84 offen offset:1024 sc1
  buffer_load_dwordx4 v[40:43], v4, s[4:7], s84 offen offset:2048 sc1
  s_waitcnt vmcnt(3)
  v_mov_b32 v176, v160
  v_mov_b32 v177, v161
  v_mov_b32 v178, v162
  v_mov_b32 v179, v163
  v_mov_b32 v180, v164
  v_mov_b32 v181, v165
  v_mov_b32 v182, v166
  v_mov_b32 v183, v167
  v_mov_b32 v184, v48
  v_mov_b32 v185, v49
  v_mov_b32 v186, v50
  v_mov_b32 v187, v51
  s_waitcnt vmcnt(0)
  v_bitop3_b32 v27, v35, v39, v43 bitop3:0x80
  v_perm_b32 v35, v39, v35, s89
  v_cmp_gt_u32 vcc, 0x48000000, v27
  v_mov_b32 v39, v42
  s_cbranch_vccnz pm_40
A1_16:
  v_smfmac_f32_16x16x32_f16 v[52:55], v[40:41], a[16:19], v44
  v_smfmac_f32_16x16x32_f16 v[64:67], v[40:41], a[76:79], v44
  v_smfmac_f32_16x16x32_f16 v[56:59], v[40:41], a[36:39], v44
  v_smfmac_f32_16x16x64_f16 v[52:55], v[32:35], a[0:7], v44
  v_smfmac_f32_16x16x64_f16 v[52:55], v[36:39], a[8:15], v44
  v_smfmac_f32_16x16x32_f16 v[68:71], v[40:41], a[96:99], v44
  v_smfmac_f32_16x16x64_f16 v[64:67], v[32:35], a[60:67], v44
  v_smfmac_f32_16x16x64_f16 v[64:67], v[36:39], a[68:75], v44
  v_smfmac_f32_16x16x32_f16 v[60:63], v[40:41], a[56:59], v44
  v_smfmac_f32_16x16x64_f16 v[56:59], v[32:35], a[20:27], v44
  v_smfmac_f32_16x16x64_f16 v[56:59], v[36:39], a[28:35], v44
  v_permlane32_swap_b32 v52, v64
  v_smfmac_f32_16x16x32_f16 v[72:75], v[40:41], a[116:119], v44
  v_permlane32_swap_b32 v53, v65
  v_add_f32 v52, v52, v64
  v_add_f32 v53, v53, v65
  v_smfmac_f32_16x16x64_f16 v[68:71], v[32:35], a[80:87], v44
  ds_write2_b32 v5, v52, v53 offset0:0 offset1:4
  v_smfmac_f32_16x16x64_f16 v[68:71], v[36:39], a[88:95], v44
  v_permlane32_swap_b32 v54, v66
  v_smfmac_f32_16x16x32_f16 v[76:79], v[40:41], a[136:139], v44
  v_permlane32_swap_b32 v55, v67
  v_add_f32 v54, v54, v66
  v_add_f32 v55, v55, v67
  v_smfmac_f32_16x16x64_f16 v[60:63], v[32:35], a[40:47], v44
  ds_write2_b32 v5, v54, v55 offset0:8 offset1:12
  v_smfmac_f32_16x16x64_f16 v[60:63], v[36:39], a[48:55], v44
  v_permlane32_swap_b32 v56, v68
  v_smfmac_f32_16x16x32_f16 v[80:83], v[40:41], a[156:159], v44
  v_permlane32_swap_b32 v57, v69
  v_add_f32 v56, v56, v68
  v_add_f32 v57, v57, v69
  v_smfmac_f32_16x16x64_f16 v[72:75], v[32:35], a[100:107], v44
  ds_write2_b32 v242, v56, v57 offset0:0 offset1:4
  v_smfmac_f32_16x16x64_f16 v[72:75], v[36:39], a[108:115], v44
  v_permlane32_swap_b32 v58, v70
  v_smfmac_f32_16x16x32_f16 v[84:87], v[40:41], a[176:179], v44
  v_permlane32_swap_b32 v59, v71
  v_add_f32 v58, v58, v70
  v_add_f32 v59, v59, v71
  v_smfmac_f32_16x16x64_f16 v[76:79], v[32:35], a[120:127], v44
  ds_write2_b32 v242, v58, v59 offset0:8 offset1:12
  v_smfmac_f32_16x16x64_f16 v[76:79], v[36:39], a[128:135], v44
  v_permlane32_swap_b32 v60, v72
  v_smfmac_f32_16x16x64_f16 v[80:83], v[32:35], a[140:147], v44
  v_permlane32_swap_b32 v61, v73
  v_add_f32 v60, v60, v72
  v_smfmac_f32_16x16x64_f16 v[80:83], v[36:39], a[148:155], v44
  v_add_f32 v61, v61, v73
  ds_write2_b32 v243, v60, v61 offset0:0 offset1:4
  v_smfmac_f32_16x16x64_f16 v[84:87], v[32:35], a[160:167], v44
  v_permlane32_swap_b32 v62, v74
  v_smfmac_f32_16x16x64_f16 v[84:87], v[36:39], a[168:175], v44
  v_permlane32_swap_b32 v63, v75
  v_add_f32 v62, v62, v74
  v_add_f32 v63, v63, v75
  ds_write2_b32 v243, v62, v63 offset0:8 offset1:12
  v_permlane32_swap_b32 v76, v80
  v_permlane32_swap_b32 v77, v81
  v_add_f32 v76, v76, v80
  v_add_f32 v77, v77, v81
  ds_write2_b32 v244, v76, v77 offset0:0 offset1:4
  v_permlane32_swap_b32 v78, v82
  v_permlane32_swap_b32 v79, v83
  v_add_f32 v78, v78, v82
  v_add_f32 v79, v79, v83
  ds_write2_b32 v244, v78, v79 offset0:8 offset1:12
  ds_write2_b32 v245, v84, v85 offset0:0 offset1:4
  ds_write2_b32 v245, v86, v87 offset0:8 offset1:12
  s_waitcnt lgkmcnt(0) vmcnt(0)
  s_barrier
  ds_read_b128 v[96:99], v45 offset:0
  ds_read_b128 v[108:111], v45 offset:5440
  ds_read_b128 v[100:103], v45 offset:1088
  ds_read_b128 v[112:115], v45 offset:6528
  ds_read_b128 v[104:107], v45 offset:2176
  ds_read_b128 v[116:119], v45 offset:7616
  s_waitcnt lgkmcnt(4)
  v_pk_add_f32 v[96:97], v[96:97], v[108:109]
  v_pk_add_f32 v[98:99], v[98:99], v[110:111]
  s_nop 0
  v_add_f32_dpp v108, v96, v96 row_ror:8 row_mask:0xf bank_mask:0xf
  v_add_f32_dpp v109, v97, v97 row_ror:8 row_mask:0xf bank_mask:0xf
  v_add_f32_dpp v110, v98, v98 row_ror:8 row_mask:0xf bank_mask:0xf
  v_add_f32_dpp v111, v99, v99 row_ror:8 row_mask:0xf bank_mask:0xf
  v_cvt_pk_bf16_f32 v212, v108, v109
  v_cvt_pk_bf16_f32 v213, v110, v111
  s_waitcnt lgkmcnt(2)
  v_pk_add_f32 v[100:101], v[100:101], v[112:113]
  v_pk_add_f32 v[102:103], v[102:103], v[114:115]
  s_nop 0
  v_add_f32_dpp v112, v100, v100 row_ror:8 row_mask:0xf bank_mask:0xf
  v_add_f32_dpp v113, v101, v101 row_ror:8 row_mask:0xf bank_mask:0xf
  v_add_f32_dpp v114, v102, v102 row_ror:8 row_mask:0xf bank_mask:0xf
  v_add_f32_dpp v115, v103, v103 row_ror:8 row_mask:0xf bank_mask:0xf
  v_cvt_pk_bf16_f32 v214, v112, v113
  v_cvt_pk_bf16_f32 v215, v114, v115
  s_waitcnt lgkmcnt(0)
  v_pk_add_f32 v[104:105], v[104:105], v[116:117]
  v_pk_add_f32 v[106:107], v[106:107], v[118:119]
  v_mfma_f32_16x16x32_bf16 v[96:99], v[168:171], v[212:215], 0
  v_add_f32_dpp v116, v104, v104 row_ror:8 row_mask:0xf bank_mask:0xf
  v_add_f32_dpp v117, v105, v105 row_ror:8 row_mask:0xf bank_mask:0xf
  v_add_f32_dpp v118, v106, v106 row_ror:8 row_mask:0xf bank_mask:0xf
  v_add_f32_dpp v119, v107, v107 row_ror:8 row_mask:0xf bank_mask:0xf
  v_cvt_pk_bf16_f32 v216, v116, v117
  v_cvt_pk_bf16_f32 v217, v118, v119
  s_nop 1
  v_mfma_f32_16x16x32_bf16 v[96:99], v[172:175], v[216:219], v[96:99]
  s_mov_b64 exec, s[74:75]
  s_nop 6
  v_cvt_pk_f16_f32 v100, v96, v97
  v_cvt_pk_f16_f32 v101, v98, v99
  v_and_or_b32 v100, v100, -2, s88
  buffer_store_dwordx2 v[100:101], v7, s[8:11], s81 offen
  s_mov_b64 exec, -1
  s_cmp_eq_u32 s52, 63
  s_cbranch_scc1 last_39
  s_sleep 5
  s_mov_b32 s54, 0
  buffer_load_dwordx2 v[248:249], v9, s[8:11], s81 offen sc1
  buffer_load_dwordx4 v[112:115], v8, s[8:11], s81 offen offset:0 sc1
  buffer_load_dwordx4 v[116:119], v8, s[8:11], s81 offen offset:1024 sc1
  s_sleep 2
  buffer_load_dwordx4 v[144:147], v10, s[8:11], s81 offen offset:0 sc1
  buffer_load_dwordx4 v[148:151], v10, s[8:11], s81 offen offset:1024 sc1
  buffer_load_dwordx4 v[152:155], v10, s[8:11], s81 offen offset:2048 sc1
  v_mov_b32 v188, 0
  v_mov_b32 v189, 0
  v_mov_b32 v190, 0
  v_mov_b32 v191, 0
  v_mov_b32 v192, 0
  v_mov_b32 v193, 0
  v_mov_b32 v194, 0
  v_mov_b32 v195, 0
  v_mov_b32 v196, 0
  v_mov_b32 v197, 0
  v_mov_b32 v198, 0
  v_mov_b32 v199, 0
  v_readfirstlane_b32 s21, v94
  s_add_u32 s22, s46, 2
  s_min_u32 s22, s22, 64
  s_sub_u32 s55, s21, s22
  s_sub_u32 s56, s21, s46
  s_waitcnt vmcnt(5)
  v_xor_b32 v96, s88, v248
  s_nop 0
  v_permlane16_swap_b32 v248, v249
  v_fma_mix_f32 v250, v248, 1.0, v249 op_sel:[0,0,0] op_sel_hi:[1,0,1]
  v_fma_mix_f32 v251, v248, 1.0, v249 op_sel:[1,0,1] op_sel_hi:[1,0,1]
  v_mov_b32 v248, v250
  v_mov_b32 v249, v251
  s_nop 0
  v_permlane32_swap_b32 v248, v250
  v_permlane32_swap_b32 v249, v251
  s_waitcnt vmcnt(3)
  v_bitop3_b32 v97, v112, v114, s88 bitop3:0x7e
  v_bitop3_b32 v98, v116, v118, s88 bitop3:0x7e
  v_fma_mix_f32 v120, v112, 1.0, v116 op_sel:[0,0,0] op_sel_hi:[1,0,1]
  v_or3_b32 v27, v96, v97, v98
  v_fma_mix_f32 v124, v114, 1.0, v118 op_sel:[0,0,0] op_sel_hi:[1,0,1]
  v_and_b32 v27, 1, v27
  v_fma_mix_f32 v121, v112, 1.0, v116 op_sel:[1,0,1] op_sel_hi:[1,0,1]
  v_cmp_ne_u32 vcc, 0, v27
  v_fma_mix_f32 v125, v114, 1.0, v118 op_sel:[1,0,1] op_sel_hi:[1,0,1]
  v_fma_mix_f32 v122, v113, 1.0, v117 op_sel:[0,0,0] op_sel_hi:[1,0,1]
  v_fma_mix_f32 v126, v115, 1.0, v119 op_sel:[0,0,0] op_sel_hi:[1,0,1]
  s_cbranch_vccnz psr_45
psj_46:
  s_cmp_lt_i32 s56, 0
  s_cbranch_scc1 kvw_48
kvok_49:
  v_fma_mix_f32 v123, v113, 1.0, v117 op_sel:[1,0,1] op_sel_hi:[1,0,1]
  v_fma_mix_f32 v127, v115, 1.0, v119 op_sel:[1,0,1] op_sel_hi:[1,0,1]
  v_permlane32_swap_b32 v120, v124
  v_permlane32_swap_b32 v121, v125
  v_permlane32_swap_b32 v122, v126
  v_permlane32_swap_b32 v123, v127
  v_pk_add_f32 v[120:121], v[120:121], v[124:125]
  v_pk_add_f32 v[122:123], v[122:123], v[126:127]
  v_pk_add_f32 v[124:125], v[248:249], v[250:251]
  v_max3_f32 v236, v120, v121, v122
  v_max3_f32 v237, v123, v124, v125
  v_max_f32 v236, v236, v237
  s_nop 1
  v_max_f32_dpp v236, v236, v236 row_ror:8 row_mask:0xf bank_mask:0xf
  v_mov_b32 v237, v236
  s_nop 1
  v_permlane32_swap_b32 v236, v237
  v_max_f32 v236, v236, v237
  v_mov_b32 v237, v236
  s_nop 1
  v_permlane16_swap_b32 v236, v237
  v_max_f32 v236, v236, v237
  s_waitcnt vmcnt(0)
  v_max3_u32 v27, v144, v146, v148
  v_max3_u32 v27, v27, v150, v152
  v_max3_u32 v27, v27, v154, v154
  v_cmp_eq_u32 vcc, -1, v27
  s_nop 1
  s_cbranch_vccnz pv_44
pvj_47:
  v_mul_f32 v236, s86, v236
  v_smfmac_f32_16x16x64_bf16 v[188:191], v[144:147], a[180:187], v44
  v_fma_f32 v120, v120, s86, -v236
  v_smfmac_f32_16x16x64_bf16 v[188:191], v[148:151], a[188:195], v44
  v_fma_f32 v121, v121, s86, -v236
  v_smfmac_f32_16x16x64_bf16 v[188:191], v[152:155], a[196:203], v44
  buffer_load_dwordx4 v[160:163], v17, s[28:31], s64 offen offset:0 sc1
  v_fma_f32 v122, v122, s86, -v236
  v_smfmac_f32_16x16x64_bf16 v[192:195], v[144:147], a[204:211], v44
  v_fma_f32 v123, v123, s86, -v236
  v_smfmac_f32_16x16x64_bf16 v[192:195], v[148:151], a[212:219], v44
  buffer_load_dwordx4 v[164:167], v16, s[28:31], s64 offen offset:1024 sc1
  v_fma_f32 v124, v124, s86, -v236
  v_smfmac_f32_16x16x64_bf16 v[192:195], v[152:155], a[220:227], v44
  v_fma_f32 v125, v125, s86, -v236
  v_smfmac_f32_16x16x64_bf16 v[196:199], v[144:147], a[228:235], v44
  buffer_load_dwordx4 v[48:51], v26, s[28:31], s64 offen offset:2048 sc1
  v_exp_f32 v120, v120
  v_smfmac_f32_16x16x64_bf16 v[196:199], v[148:151], a[236:243], v44
  v_exp_f32 v121, v121
  v_smfmac_f32_16x16x64_bf16 v[196:199], v[152:155], a[244:251], v44
  buffer_load_dwordx4 v[168:171], v18, s[16:19], s80 offen sc1
  v_exp_f32 v122, v122
  buffer_load_dwordx2 v[172:173], v20, s[16:19], s80 offen sc1
  v_exp_f32 v123, v123
  v_exp_f32 v124, v124
  v_exp_f32 v125, v125
  s_mov_b64 exec, s[60:61]
  v_cvt_pk_bf16_f32 v220, v120, v121
  v_cvt_pk_bf16_f32 v221, v122, v123
  v_cvt_pk_bf16_f32 v224, v124, v125
  s_mov_b64 exec, s[62:63]
  v_cvt_pk_bf16_f32 v222, v120, v121
  v_cvt_pk_bf16_f32 v223, v122, v123
  v_cvt_pk_bf16_f32 v225, v124, v125
  s_mov_b64 exec, -1
  v_pk_add_f32 v[126:127], v[120:121], v[122:123]
  v_add_f32 v128, v124, v125
  v_mfma_f32_16x16x32_bf16 v[200:203], v[176:179], v[220:223], 0
  v_add_f32 v236, v126, v127
  v_fmac_f32 v236, v128, v89
  v_cvt_pk_bf16_f32 v228, v188, v189
  v_cvt_pk_bf16_f32 v229, v190, v191
  v_mfma_f32_16x16x32_bf16 v[204:207], v[180:183], v[220:223], 0
  v_cvt_pk_bf16_f32 v230, v192, v193
  v_cvt_pk_bf16_f32 v231, v194, v195
  v_mfma_f32_16x16x32_bf16 v[208:211], v[184:187], v[220:223], 0
  v_cvt_pk_bf16_f32 v232, v196, v197
  v_cvt_pk_bf16_f32 v233, v198, v199
  v_add_f32_dpp v236, v236, v236 row_ror:8 row_mask:0xf bank_mask:0xf
  v_mov_b32 v237, v236
  s_nop 0
  v_mfma_f32_16x16x32_bf16 v[200:203], v[228:231], v[224:227], v[200:203]
  v_mfma_f32_16x16x32_bf16 v[204:207], v[230:233], v[224:227], v[204:207]
  v_permlane32_swap_b32 v236, v237
  v_add_f32 v236, v236, v237
  v_mov_b32 v237, v236
  v_mfma_f32_16x16x32_bf16 v[208:211], v[232:235], v[224:227], v[208:211]
  s_nop 0
  v_permlane16_swap_b32 v236, v237
  v_add_f32 v236, v236, v237
  v_rcp_f32 v236, v236
  s_nop 2
  v_pk_mul_f32 v[200:201], v[200:201], v[236:237] op_sel_hi:[1,0]
  v_pk_mul_f32 v[202:203], v[202:203], v[236:237] op_sel_hi:[1,0]
  ds_write_b128 v11, v[200:203] offset:0
  v_pk_mul_f32 v[204:205], v[204:205], v[236:237] op_sel_hi:[1,0]
  v_pk_mul_f32 v[206:207], v[206:207], v[236:237] op_sel_hi:[1,0]
  ds_write_b128 v11, v[204:207] offset:1024
  v_pk_mul_f32 v[208:209], v[208:209], v[236:237] op_sel_hi:[1,0]
  v_pk_mul_f32 v[210:211], v[210:211], v[236:237] op_sel_hi:[1,0]
  ds_write_b128 v11, v[208:211] offset:2048
  s_waitcnt lgkmcnt(0)
  s_barrier
  ds_read_b64 v[96:97], v12 offset:0
  ds_read_b64 v[98:99], v12 offset:128
  ds_read_b64 v[100:101], v12 offset:3072
  ds_read_b64 v[102:103], v12 offset:3200
  ds_read_b64 v[104:105], v12 offset:6144
  ds_read_b64 v[106:107], v12 offset:6272
  ds_read_b64 v[108:109], v12 offset:9216
  ds_read_b64 v[110:111], v12 offset:9344
  s_waitcnt lgkmcnt(6)
  v_pk_add_f32 v[96:97], v[96:97], v[98:99]
  s_waitcnt lgkmcnt(4)
  v_pk_add_f32 v[100:101], v[100:101], v[102:103]
  s_waitcnt lgkmcnt(2)
  v_pk_add_f32 v[104:105], v[104:105], v[106:107]
  v_pk_add_f32 v[96:97], v[96:97], v[100:101]
  s_waitcnt lgkmcnt(0)
  v_pk_add_f32 v[108:109], v[108:109], v[110:111]
  v_pk_add_f32 v[96:97], v[96:97], v[104:105]
  v_pk_add_f32 v[96:97], v[96:97], v[108:109]
  v_cvt_pk_f16_f32 v100, v96, v97
  v_perm_b32 v100, s91, v100, v14
  buffer_atomic_pk_add_f16 v100, v13, s[4:7], s3 offen
  v_mov_b32 v200, v196
  v_mov_b32 v201, v197
  v_mov_b32 v202, v198
  v_mov_b32 v203, v199
  v_permlane32_swap_b32 v188, v192
  v_permlane32_swap_b32 v189, v193
  v_permlane32_swap_b32 v190, v194
  v_permlane32_swap_b32 v191, v195
  v_permlane32_swap_b32 v196, v200
  v_permlane32_swap_b32 v197, v201
  v_permlane32_swap_b32 v198, v202
  v_permlane32_swap_b32 v199, v203
  v_pk_add_f32 v[188:189], v[188:189], v[192:193]
  v_pk_add_f32 v[190:191], v[190:191], v[194:195]
  v_pk_add_f32 v[196:197], v[196:197], v[200:201]
  v_pk_add_f32 v[198:199], v[198:199], v[202:203]
  v_cvt_pk_bf16_f32 v252, v188, v189
  v_cvt_pk_bf16_f32 v254, v196, v197
  v_cvt_pk_bf16_f32 v253, v190, v191
  v_cvt_pk_bf16_f32 v255, v198, v199
  s_nop 0
  v_permlane16_swap_b32 v252, v254
  v_permlane16_swap_b32 v253, v255
  v_min_u32 v252, -2, v252
  s_mov_b64 exec, s[76:77]
  buffer_store_dwordx4 v[252:255], v15, s[24:27], s57 offen sc1
  s_mov_b64 exec, -1
  s_add_u32 s64, s64, 1310720
  s_add_u32 s52, s52, 1
  s_and_b32 s21, s52, 3
  s_mul_i32 s81, s21, 540672
  s_lshl_b32 s84, s21, 15
  s_branch step_38
fl_42:
  buffer_load_dword v94, v95, s[12:15], s79 offen sc1
  s_branch fl_43
pm_40:
  s_cmp_gt_u32 s52, 3
  s_cbranch_scc1 op_50
  v_readfirstlane_b32 s21, v94
  s_cmp_ge_u32 s21, s46
  s_cbranch_scc1 op_50
  buffer_load_dword v94, v95, s[12:15], s79 offen sc1
  s_waitcnt vmcnt(0)
  v_readfirstlane_b32 s21, v94
  s_add_u32 s22, s46, 2
  s_min_u32 s22, s22, 64
  s_sub_u32 s55, s21, s22
  s_sub_u32 s56, s21, s46
  s_cmp_gt_u32 s21, s52
  s_cselect_b32 s21, s87, 0
  s_cmp_eq_u32 s21, 0
  s_cbranch_scc1 op_50
  s_mov_b32 s87, 0
  s_sub_u32 s21, s64, 1310720
  buffer_load_dwordx4 v[176:179], v16, s[28:31], s21 offen offset:0 sc1
  buffer_load_dwordx4 v[180:183], v16, s[28:31], s21 offen offset:1024 sc1
  buffer_load_dwordx4 v[184:187], v16, s[28:31], s21 offen offset:2048 sc1
op_50:
  buffer_load_dwordx4 v[32:35], v4, s[4:7], s84 offen offset:0 sc1
  buffer_load_dwordx4 v[36:39], v4, s[4:7], s84 offen offset:1024 sc1
  buffer_load_dwordx4 v[40:43], v4, s[4:7], s84 offen offset:2048 sc1
  s_add_u32 s54, s54, 1
  s_cmp_gt_u32 s54, 131072
  s_cbranch_scc1 end0
  s_waitcnt vmcnt(0)
  v_bitop3_b32 v27, v35, v39, v43 bitop3:0x80
  v_perm_b32 v35, v39, v35, s89
  v_cmp_gt_u32 vcc, 0x48000000, v27
  v_mov_b32 v39, v42
  s_cbranch_vccnz pm_40
  s_branch A1_16
pv_44:
  buffer_load_dwordx4 v[144:147], v10, s[8:11], s81 offen offset:0 sc1
  buffer_load_dwordx4 v[148:151], v10, s[8:11], s81 offen offset:1024 sc1
  buffer_load_dwordx4 v[152:155], v10, s[8:11], s81 offen offset:2048 sc1
  s_add_u32 s54, s54, 1
  s_cmp_gt_u32 s54, 131072
  s_cbranch_scc1 end0
  s_waitcnt vmcnt(0)
  v_max3_u32 v27, v144, v146, v148
  v_max3_u32 v27, v27, v150, v152
  v_max3_u32 v27, v27, v154, v154
  v_cmp_eq_u32 vcc, -1, v27
  s_nop 1
  s_cbranch_vccnz pv_44
  s_branch pvj_47
psr_45:
  s_cmp_gt_u32 s52, 3
  s_cbranch_scc1 op_51
  v_readfirstlane_b32 s21, v94
  s_cmp_ge_u32 s21, s46
  s_cbranch_scc1 op_51
  buffer_load_dword v94, v95, s[12:15], s79 offen sc1
  s_waitcnt vmcnt(0)
  v_readfirstlane_b32 s21, v94
  s_add_u32 s22, s46, 2
  s_min_u32 s22, s22, 64
  s_sub_u32 s55, s21, s22
  s_sub_u32 s56, s21, s46
  s_cmp_gt_u32 s21, s52
  s_cselect_b32 s21, s87, 0
  s_cmp_eq_u32 s21, 0
  s_cbranch_scc1 op_51
  s_mov_b32 s87, 0
  s_sub_u32 s21, s64, 1310720
  buffer_load_dwordx4 v[176:179], v16, s[28:31], s21 offen offset:0 sc1
  buffer_load_dwordx4 v[180:183], v16, s[28:31], s21 offen offset:1024 sc1
  buffer_load_dwordx4 v[184:187], v16, s[28:31], s21 offen offset:2048 sc1
op_51:
  buffer_load_dwordx2 v[248:249], v9, s[8:11], s81 offen sc1
  buffer_load_dwordx4 v[112:115], v8, s[8:11], s81 offen offset:0 sc1
  buffer_load_dwordx4 v[116:119], v8, s[8:11], s81 offen offset:1024 sc1
  s_add_u32 s54, s54, 1
  s_cmp_gt_u32 s54, 131072
  s_cbranch_scc1 end0
  s_waitcnt vmcnt(2)
  v_xor_b32 v96, s88, v248
  s_nop 0
  v_permlane16_swap_b32 v248, v249
  v_fma_mix_f32 v250, v248, 1.0, v249 op_sel:[0,0,0] op_sel_hi:[1,0,1]
  v_fma_mix_f32 v251, v248, 1.0, v249 op_sel:[1,0,1] op_sel_hi:[1,0,1]
  v_mov_b32 v248, v250
  v_mov_b32 v249, v251
  s_nop 0
  v_permlane32_swap_b32 v248, v250
  v_permlane32_swap_b32 v249, v251
  s_waitcnt vmcnt(0)
  v_bitop3_b32 v97, v112, v114, s88 bitop3:0x7e
  v_bitop3_b32 v98, v116, v118, s88 bitop3:0x7e
  v_fma_mix_f32 v120, v112, 1.0, v116 op_sel:[0,0,0] op_sel_hi:[1,0,1]
  v_or3_b32 v27, v96, v97, v98
  v_fma_mix_f32 v124, v114, 1.0, v118 op_sel:[0,0,0] op_sel_hi:[1,0,1]
  v_and_b32 v27, 1, v27
  v_fma_mix_f32 v121, v112, 1.0, v116 op_sel:[1,0,1] op_sel_hi:[1,0,1]
  v_cmp_ne_u32 vcc, 0, v27
  v_fma_mix_f32 v125, v114, 1.0, v118 op_sel:[1,0,1] op_sel_hi:[1,0,1]
  v_fma_mix_f32 v122, v113, 1.0, v117 op_sel:[0,0,0] op_sel_hi:[1,0,1]
  v_fma_mix_f32 v126, v115, 1.0, v119 op_sel:[0,0,0] op_sel_hi:[1,0,1]
  s_cbranch_vccnz psr_45
  s_branch psj_46
kvw_48:
  s_mov_b32 s22, s87
  s_cmp_eq_u32 s52, 0
  s_cselect_b32 s23, s87, s46
  s_cselect_b32 s55, 0, s55
  s_cselect_b32 s87, 1, 0
  s_cmp_eq_u32 s23, 0
  s_cbranch_scc1 kvok_49
  v_mov_b32 v236, 0
  s_mov_b32 s101, 0
wf_52:
  buffer_load_dword v237, v236, s[12:15], s79 offen sc1
  s_add_u32 s101, s101, 1
  s_cmp_gt_u32 s101, 131072
  s_cbranch_scc1 end0
  s_waitcnt vmcnt(0)
  v_readfirstlane_b32 s100, v237
  s_cmp_ge_u32 s100, s23
  s_cbranch_scc1 wf_53
  s_sleep 3
  s_branch wf_52
wf_53:
  s_cmp_eq_u32 s22, 0
  s_cbranch_scc1 kvok_49
  s_sub_u32 s21, s64, 1310720
  buffer_load_dwordx4 v[176:179], v16, s[28:31], s21 offen offset:0 sc1
  buffer_load_dwordx4 v[180:183], v16, s[28:31], s21 offen offset:1024 sc1
  buffer_load_dwordx4 v[184:187], v16, s[28:31], s21 offen offset:2048 sc1
  s_waitcnt vmcnt(0)
  s_branch kvok_49
last_39:
  v_mov_b32 v188, 0
  v_mov_b32 v189, 0
  v_mov_b32 v190, 0
  v_mov_b32 v191, 0
  v_mov_b32 v192, 0
  v_mov_b32 v193, 0
  v_mov_b32 v194, 0
  v_mov_b32 v195, 0
  v_mov_b32 v196, 0
  v_mov_b32 v197, 0
  v_mov_b32 v198, 0
  v_mov_b32 v199, 0
  s_sleep 4
  s_mov_b32 s54, 0
lv_54:
  buffer_load_dwordx4 v[144:147], v10, s[8:11], s81 offen offset:0 sc1
  buffer_load_dwordx4 v[148:151], v10, s[8:11], s81 offen offset:1024 sc1
  buffer_load_dwordx4 v[152:155], v10, s[8:11], s81 offen offset:2048 sc1
  s_add_u32 s54, s54, 1
  s_cmp_gt_u32 s54, 131072
  s_cbranch_scc1 end0
  s_waitcnt vmcnt(0)
  v_max3_u32 v27, v144, v146, v148
  v_max3_u32 v27, v27, v150, v152
  v_max3_u32 v27, v27, v154, v154
  v_cmp_eq_u32 vcc, -1, v27
  s_nop 1
  s_cbranch_vccnz lv_54
  v_smfmac_f32_16x16x64_bf16 v[188:191], v[144:147], a[180:187], v44
  v_smfmac_f32_16x16x64_bf16 v[192:195], v[144:147], a[204:211], v44
  v_smfmac_f32_16x16x64_bf16 v[196:199], v[144:147], a[228:235], v44
  v_smfmac_f32_16x16x64_bf16 v[188:191], v[148:151], a[188:195], v44
  v_smfmac_f32_16x16x64_bf16 v[192:195], v[148:151], a[212:219], v44
  v_smfmac_f32_16x16x64_bf16 v[196:199], v[148:151], a[236:243], v44
  v_smfmac_f32_16x16x64_bf16 v[188:191], v[152:155], a[196:203], v44
  v_smfmac_f32_16x16x64_bf16 v[192:195], v[152:155], a[220:227], v44
  v_smfmac_f32_16x16x64_bf16 v[196:199], v[152:155], a[244:251], v44
  s_nop 7
  v_mov_b32 v200, v196
  v_mov_b32 v201, v197
  v_mov_b32 v202, v198
  v_mov_b32 v203, v199
  v_permlane32_swap_b32 v188, v192
  v_permlane32_swap_b32 v189, v193
  v_permlane32_swap_b32 v190, v194
  v_permlane32_swap_b32 v191, v195
  v_permlane32_swap_b32 v196, v200
  v_permlane32_swap_b32 v197, v201
  v_permlane32_swap_b32 v198, v202
  v_permlane32_swap_b32 v199, v203
  v_pk_add_f32 v[188:189], v[188:189], v[192:193]
  v_pk_add_f32 v[190:191], v[190:191], v[194:195]
  v_pk_add_f32 v[196:197], v[196:197], v[200:201]
  v_pk_add_f32 v[198:199], v[198:199], v[202:203]
  v_cvt_pk_bf16_f32 v252, v188, v189
  v_cvt_pk_bf16_f32 v254, v196, v197
  v_cvt_pk_bf16_f32 v253, v190, v191
  v_cvt_pk_bf16_f32 v255, v198, v199
  s_nop 0
  v_permlane16_swap_b32 v252, v254
  v_permlane16_swap_b32 v253, v255
  v_min_u32 v252, -2, v252
  s_mov_b64 exec, s[76:77]
  buffer_store_dwordx4 v[252:255], v15, s[24:27], s57 offen sc1
  s_mov_b64 exec, -1
  s_branch chain_done
step_55:
  s_add_u32 s21, s52, 2
  s_and_b32 s21, s21, 3
  s_mul_i32 s82, s21, 540672
  s_add_u32 s21, s52, 3
  s_and_b32 s21, s21, 3
  s_lshl_b32 s83, s21, 15
  s_add_u32 s21, s52, 1
  s_and_b32 s22, s21, 3
  s_lshl_b32 s3, s22, 15
  s_mul_i32 s80, s21, 393216
  s_add_u32 s46, s21, 1
  s_min_u32 s46, s46, 64
  s_mul_i32 s85, s52, 98304
  s_mul_i32 s57, s52, 327680
  s_add_u32 s57, s57, 42991616

  s_bfe_u32 s88, s52, 0x10002
  s_add_u32 s78, s81, 278528
  s_max_u32 s21, s52, 1
  s_sub_u32 s21, s21, 1
  s_cmp_lt_u32 s52, 60
  s_cselect_b32 s66, s65, 0x80000000
  s_cselect_b32 s68, 15, 1
  s_cmp_ge_u32 s52, 61
  s_cselect_b32 s66, s90, s66
  s_cselect_b32 s67, s52, s21
  v_mov_b32 v52, 0
  v_mov_b32 v53, 0
  v_mov_b32 v54, 0
  v_mov_b32 v55, 0
  v_mov_b32 v56, 0
  v_mov_b32 v57, 0
  v_mov_b32 v58, 0
  v_mov_b32 v59, 0
  v_mov_b32 v60, 0
  v_mov_b32 v61, 0
  v_mov_b32 v62, 0
  v_mov_b32 v63, 0
  v_mov_b32 v64, 0
  v_mov_b32 v65, 0
  v_mov_b32 v66, 0
  v_mov_b32 v67, 0
  v_mov_b32 v68, 0
  v_mov_b32 v69, 0
  v_mov_b32 v70, 0
  v_mov_b32 v71, 0
  v_mov_b32 v72, 0
  v_mov_b32 v73, 0
  v_mov_b32 v74, 0
  v_mov_b32 v75, 0
  v_mov_b32 v76, 0
  v_mov_b32 v77, 0
  v_mov_b32 v78, 0
  v_mov_b32 v79, 0
  v_mov_b32 v80, 0
  v_mov_b32 v81, 0
  v_mov_b32 v82, 0
  v_mov_b32 v83, 0
  v_mov_b32 v84, 0
  v_mov_b32 v85, 0
  v_mov_b32 v86, 0
  v_mov_b32 v87, 0
  s_sleep 3
  s_cmp_lt_i32 s55, 0
  s_cbranch_scc1 fl_59
fl_60:
  s_mov_b32 s54, 0
  buffer_load_dwordx4 v[32:35], v4, s[4:7], s84 offen offset:0 sc1
  buffer_load_dwordx4 v[36:39], v4, s[4:7], s84 offen offset:1024 sc1
  buffer_load_dwordx4 v[40:43], v4, s[4:7], s84 offen offset:2048 sc1
  s_waitcnt vmcnt(3)
  v_mov_b32 v176, v160
  v_mov_b32 v177, v161
  v_mov_b32 v178, v162
  v_mov_b32 v179, v163
  v_mov_b32 v180, v164
  v_mov_b32 v181, v165
  v_mov_b32 v182, v166
  v_mov_b32 v183, v167
  v_mov_b32 v184, v48
  v_mov_b32 v185, v49
  v_mov_b32 v186, v50
  v_mov_b32 v187, v51
  s_waitcnt vmcnt(0)
  v_bitop3_b32 v27, v35, v39, v43 bitop3:0x80
  v_perm_b32 v35, v39, v35, s89
  v_cmp_gt_u32 vcc, 0x48000000, v27
  v_mov_b32 v39, v42
  s_cbranch_vccnz pm_57
A1_17:
  v_smfmac_f32_16x16x32_f16 v[52:55], v[40:41], a[16:19], v44
  v_smfmac_f32_16x16x32_f16 v[64:67], v[40:41], a[76:79], v44
  v_smfmac_f32_16x16x32_f16 v[56:59], v[40:41], a[36:39], v44
  v_smfmac_f32_16x16x64_f16 v[52:55], v[32:35], a[0:7], v44
  v_smfmac_f32_16x16x64_f16 v[52:55], v[36:39], a[8:15], v44
  v_smfmac_f32_16x16x32_f16 v[68:71], v[40:41], a[96:99], v44
  v_smfmac_f32_16x16x64_f16 v[64:67], v[32:35], a[60:67], v44
  v_smfmac_f32_16x16x64_f16 v[64:67], v[36:39], a[68:75], v44
  v_smfmac_f32_16x16x32_f16 v[60:63], v[40:41], a[56:59], v44
  v_smfmac_f32_16x16x64_f16 v[56:59], v[32:35], a[20:27], v44
  v_smfmac_f32_16x16x64_f16 v[56:59], v[36:39], a[28:35], v44
  v_permlane32_swap_b32 v52, v64
  v_smfmac_f32_16x16x32_f16 v[72:75], v[40:41], a[116:119], v44
  v_permlane32_swap_b32 v53, v65
  v_add_f32 v52, v52, v64
  v_add_f32 v53, v53, v65
  v_smfmac_f32_16x16x64_f16 v[68:71], v[32:35], a[80:87], v44
  ds_write2_b32 v5, v52, v53 offset0:0 offset1:4
  v_smfmac_f32_16x16x64_f16 v[68:71], v[36:39], a[88:95], v44
  v_permlane32_swap_b32 v54, v66
  v_smfmac_f32_16x16x32_f16 v[76:79], v[40:41], a[136:139], v44
  v_permlane32_swap_b32 v55, v67
  v_add_f32 v54, v54, v66
  v_add_f32 v55, v55, v67
  v_smfmac_f32_16x16x64_f16 v[60:63], v[32:35], a[40:47], v44
  ds_write2_b32 v5, v54, v55 offset0:8 offset1:12
  v_smfmac_f32_16x16x64_f16 v[60:63], v[36:39], a[48:55], v44
  v_permlane32_swap_b32 v56, v68
  v_smfmac_f32_16x16x32_f16 v[80:83], v[40:41], a[156:159], v44
  v_permlane32_swap_b32 v57, v69
  v_add_f32 v56, v56, v68
  v_add_f32 v57, v57, v69
  v_smfmac_f32_16x16x64_f16 v[72:75], v[32:35], a[100:107], v44
  ds_write2_b32 v242, v56, v57 offset0:0 offset1:4
  v_smfmac_f32_16x16x64_f16 v[72:75], v[36:39], a[108:115], v44
  v_permlane32_swap_b32 v58, v70
  v_smfmac_f32_16x16x32_f16 v[84:87], v[40:41], a[176:179], v44
  v_permlane32_swap_b32 v59, v71
  v_add_f32 v58, v58, v70
  v_add_f32 v59, v59, v71
  v_smfmac_f32_16x16x64_f16 v[76:79], v[32:35], a[120:127], v44
  ds_write2_b32 v242, v58, v59 offset0:8 offset1:12
  v_smfmac_f32_16x16x64_f16 v[76:79], v[36:39], a[128:135], v44
  v_permlane32_swap_b32 v60, v72
  v_smfmac_f32_16x16x64_f16 v[80:83], v[32:35], a[140:147], v44
  v_permlane32_swap_b32 v61, v73
  v_add_f32 v60, v60, v72
  v_smfmac_f32_16x16x64_f16 v[80:83], v[36:39], a[148:155], v44
  v_add_f32 v61, v61, v73
  ds_write2_b32 v243, v60, v61 offset0:0 offset1:4
  v_smfmac_f32_16x16x64_f16 v[84:87], v[32:35], a[160:167], v44
  v_permlane32_swap_b32 v62, v74
  v_smfmac_f32_16x16x64_f16 v[84:87], v[36:39], a[168:175], v44
  v_permlane32_swap_b32 v63, v75
  v_add_f32 v62, v62, v74
  v_add_f32 v63, v63, v75
  ds_write2_b32 v243, v62, v63 offset0:8 offset1:12
  v_permlane32_swap_b32 v76, v80
  v_permlane32_swap_b32 v77, v81
  v_add_f32 v76, v76, v80
  v_add_f32 v77, v77, v81
  ds_write2_b32 v244, v76, v77 offset0:0 offset1:4
  v_permlane32_swap_b32 v78, v82
  v_permlane32_swap_b32 v79, v83
  v_add_f32 v78, v78, v82
  v_add_f32 v79, v79, v83
  ds_write2_b32 v244, v78, v79 offset0:8 offset1:12
  ds_write2_b32 v245, v84, v85 offset0:0 offset1:4
  ds_write2_b32 v245, v86, v87 offset0:8 offset1:12
  s_waitcnt lgkmcnt(0) vmcnt(0)
  s_barrier
  ds_read_b128 v[96:99], v6 offset:0
  ds_read_b128 v[108:111], v6 offset:5440
  ds_read_b128 v[120:123], v6 offset:10880
  ds_read_b128 v[132:135], v6 offset:16320
  ds_read_b128 v[100:103], v6 offset:1088
  ds_read_b128 v[112:115], v6 offset:6528
  ds_read_b128 v[124:127], v6 offset:11968
  ds_read_b128 v[136:139], v6 offset:17408
  ds_read_b128 v[104:107], v6 offset:2176
  ds_read_b128 v[116:119], v6 offset:7616
  ds_read_b128 v[128:131], v6 offset:13056
  ds_read_b128 v[140:143], v6 offset:18496
  s_waitcnt lgkmcnt(8)
  v_pk_add_f32 v[96:97], v[96:97], v[108:109]
  v_pk_add_f32 v[120:121], v[120:121], v[132:133]
  v_pk_add_f32 v[98:99], v[98:99], v[110:111]
  v_pk_add_f32 v[122:123], v[122:123], v[134:135]
  v_pk_add_f32 v[96:97], v[96:97], v[120:121]
  v_pk_add_f32 v[98:99], v[98:99], v[122:123]
  v_cvt_pk_bf16_f32 v212, v96, v97
  v_cvt_pk_bf16_f32 v213, v98, v99
  s_waitcnt lgkmcnt(4)
  v_pk_add_f32 v[100:101], v[100:101], v[112:113]
  v_pk_add_f32 v[124:125], v[124:125], v[136:137]
  v_pk_add_f32 v[102:103], v[102:103], v[114:115]
  v_pk_add_f32 v[126:127], v[126:127], v[138:139]
  v_pk_add_f32 v[100:101], v[100:101], v[124:125]
  v_pk_add_f32 v[102:103], v[102:103], v[126:127]
  v_cvt_pk_bf16_f32 v214, v100, v101
  v_cvt_pk_bf16_f32 v215, v102, v103
  s_waitcnt lgkmcnt(0)
  v_pk_add_f32 v[104:105], v[104:105], v[116:117]
  v_pk_add_f32 v[128:129], v[128:129], v[140:141]
  v_pk_add_f32 v[106:107], v[106:107], v[118:119]
  v_pk_add_f32 v[130:131], v[130:131], v[142:143]
  v_mfma_f32_16x16x32_bf16 v[96:99], v[212:215], v[212:215], 0
  v_pk_add_f32 v[104:105], v[104:105], v[128:129]
  v_pk_add_f32 v[106:107], v[106:107], v[130:131]
  v_cvt_pk_bf16_f32 v216, v104, v105
  v_cvt_pk_bf16_f32 v217, v106, v107
  s_nop 1
  v_mfma_f32_16x16x32_bf16 v[96:99], v[216:219], v[216:219], v[96:99]
  s_mov_b64 exec, s[74:75]
  s_nop 6
  v_cvt_pk_f16_f32 v100, v96, v97
  v_cvt_pk_f16_f32 v101, v98, v99
  v_and_or_b32 v100, v100, -2, s88
  buffer_store_dwordx2 v[100:101], v7, s[8:11], s81 offen
  s_mov_b64 exec, -1
  s_cmp_eq_u32 s52, 63
  s_cbranch_scc1 last_56
  s_sleep 4
  s_mov_b32 s54, 0
  buffer_load_dwordx2 v[248:249], v9, s[8:11], s81 offen sc1
  buffer_load_dwordx4 v[112:115], v8, s[8:11], s81 offen offset:0 sc1
  buffer_load_dwordx4 v[116:119], v8, s[8:11], s81 offen offset:1024 sc1
  s_sleep 2
  buffer_load_dwordx4 v[144:147], v10, s[8:11], s81 offen offset:0 sc1
  buffer_load_dwordx4 v[148:151], v10, s[8:11], s81 offen offset:1024 sc1
  buffer_load_dwordx4 v[152:155], v10, s[8:11], s81 offen offset:2048 sc1
  v_mov_b32 v188, 0
  v_mov_b32 v189, 0
  v_mov_b32 v190, 0
  v_mov_b32 v191, 0
  v_mov_b32 v192, 0
  v_mov_b32 v193, 0
  v_mov_b32 v194, 0
  v_mov_b32 v195, 0
  v_mov_b32 v196, 0
  v_mov_b32 v197, 0
  v_mov_b32 v198, 0
  v_mov_b32 v199, 0
  v_readfirstlane_b32 s21, v94
  s_add_u32 s22, s46, 2
  s_min_u32 s22, s22, 64
  s_sub_u32 s55, s21, s22
  s_sub_u32 s56, s21, s46
  s_waitcnt vmcnt(5)
  v_xor_b32 v96, s88, v248
  s_nop 0
  v_permlane16_swap_b32 v248, v249
  v_fma_mix_f32 v250, v248, 1.0, v249 op_sel:[0,0,0] op_sel_hi:[1,0,1]
  v_fma_mix_f32 v251, v248, 1.0, v249 op_sel:[1,0,1] op_sel_hi:[1,0,1]
  v_mov_b32 v248, v250
  v_mov_b32 v249, v251
  s_nop 0
  v_permlane32_swap_b32 v248, v250
  v_permlane32_swap_b32 v249, v251
  s_waitcnt vmcnt(3)
  v_bitop3_b32 v97, v112, v114, s88 bitop3:0x7e
  v_bitop3_b32 v98, v116, v118, s88 bitop3:0x7e
  v_fma_mix_f32 v120, v112, 1.0, v116 op_sel:[0,0,0] op_sel_hi:[1,0,1]
  v_or3_b32 v27, v96, v97, v98
  v_fma_mix_f32 v124, v114, 1.0, v118 op_sel:[0,0,0] op_sel_hi:[1,0,1]
  v_and_b32 v27, 1, v27
  v_fma_mix_f32 v121, v112, 1.0, v116 op_sel:[1,0,1] op_sel_hi:[1,0,1]
  v_cmp_ne_u32 vcc, 0, v27
  v_fma_mix_f32 v125, v114, 1.0, v118 op_sel:[1,0,1] op_sel_hi:[1,0,1]
  v_fma_mix_f32 v122, v113, 1.0, v117 op_sel:[0,0,0] op_sel_hi:[1,0,1]
  v_fma_mix_f32 v126, v115, 1.0, v119 op_sel:[0,0,0] op_sel_hi:[1,0,1]
  s_cbranch_vccnz psr_62
psj_63:
  s_cmp_lt_i32 s56, 0
  s_cbranch_scc1 kvw_65
kvok_66:
  v_fma_mix_f32 v123, v113, 1.0, v117 op_sel:[1,0,1] op_sel_hi:[1,0,1]
  v_fma_mix_f32 v127, v115, 1.0, v119 op_sel:[1,0,1] op_sel_hi:[1,0,1]
  v_permlane32_swap_b32 v120, v124
  v_permlane32_swap_b32 v121, v125
  v_permlane32_swap_b32 v122, v126
  v_permlane32_swap_b32 v123, v127
  v_pk_add_f32 v[120:121], v[120:121], v[124:125]
  v_pk_add_f32 v[122:123], v[122:123], v[126:127]
  v_pk_add_f32 v[124:125], v[248:249], v[250:251]
  v_max3_f32 v236, v120, v121, v122
  v_max3_f32 v237, v123, v124, v125
  v_max_f32 v236, v236, v237
  s_nop 1
  v_max_f32_dpp v236, v236, v236 row_ror:8 row_mask:0xf bank_mask:0xf
  v_mov_b32 v237, v236
  s_nop 1
  v_permlane32_swap_b32 v236, v237
  v_max_f32 v236, v236, v237
  v_mov_b32 v237, v236
  s_nop 1
  v_permlane16_swap_b32 v236, v237
  v_max_f32 v236, v236, v237
  s_waitcnt vmcnt(0)
  v_max3_u32 v27, v144, v146, v148
  v_max3_u32 v27, v27, v150, v152
  v_max3_u32 v27, v27, v154, v154
  v_cmp_eq_u32 vcc, -1, v27
  s_nop 1
  s_cbranch_vccnz pv_61
pvj_64:
  v_mul_f32 v236, s86, v236
  v_smfmac_f32_16x16x64_bf16 v[188:191], v[144:147], a[180:187], v44
  v_fma_f32 v120, v120, s86, -v236
  v_smfmac_f32_16x16x64_bf16 v[188:191], v[148:151], a[188:195], v44
  v_fma_f32 v121, v121, s86, -v236
  v_smfmac_f32_16x16x64_bf16 v[188:191], v[152:155], a[196:203], v44
  buffer_load_dwordx4 v[160:163], v17, s[28:31], s64 offen offset:0 sc1
  v_fma_f32 v122, v122, s86, -v236
  v_smfmac_f32_16x16x64_bf16 v[192:195], v[144:147], a[204:211], v44
  v_fma_f32 v123, v123, s86, -v236
  v_smfmac_f32_16x16x64_bf16 v[192:195], v[148:151], a[212:219], v44
  buffer_load_dwordx4 v[164:167], v16, s[28:31], s64 offen offset:1024 sc1
  v_fma_f32 v124, v124, s86, -v236
  v_smfmac_f32_16x16x64_bf16 v[192:195], v[152:155], a[220:227], v44
  v_fma_f32 v125, v125, s86, -v236
  v_smfmac_f32_16x16x64_bf16 v[196:199], v[144:147], a[228:235], v44
  buffer_load_dwordx4 v[48:51], v26, s[28:31], s64 offen offset:2048 sc1
  v_exp_f32 v120, v120
  v_smfmac_f32_16x16x64_bf16 v[196:199], v[148:151], a[236:243], v44
  v_exp_f32 v121, v121
  v_smfmac_f32_16x16x64_bf16 v[196:199], v[152:155], a[244:251], v44
  v_exp_f32 v122, v122
  v_exp_f32 v123, v123
  v_exp_f32 v124, v124
  v_exp_f32 v125, v125
  s_mov_b64 exec, s[60:61]
  v_cvt_pk_bf16_f32 v220, v120, v121
  v_cvt_pk_bf16_f32 v221, v122, v123
  v_cvt_pk_bf16_f32 v224, v124, v125
  s_mov_b64 exec, s[62:63]
  v_cvt_pk_bf16_f32 v222, v120, v121
  v_cvt_pk_bf16_f32 v223, v122, v123
  v_cvt_pk_bf16_f32 v225, v124, v125
  s_mov_b64 exec, -1
  v_pk_add_f32 v[126:127], v[120:121], v[122:123]
  v_add_f32 v128, v124, v125
  v_mfma_f32_16x16x32_bf16 v[200:203], v[176:179], v[220:223], 0
  v_add_f32 v236, v126, v127
  v_fmac_f32 v236, v128, v89
  v_cvt_pk_bf16_f32 v228, v188, v189
  v_cvt_pk_bf16_f32 v229, v190, v191
  v_mfma_f32_16x16x32_bf16 v[204:207], v[180:183], v[220:223], 0
  v_cvt_pk_bf16_f32 v230, v192, v193
  v_cvt_pk_bf16_f32 v231, v194, v195
  v_mfma_f32_16x16x32_bf16 v[208:211], v[184:187], v[220:223], 0
  v_cvt_pk_bf16_f32 v232, v196, v197
  v_cvt_pk_bf16_f32 v233, v198, v199
  v_add_f32_dpp v236, v236, v236 row_ror:8 row_mask:0xf bank_mask:0xf
  v_mov_b32 v237, v236
  s_nop 0
  v_mfma_f32_16x16x32_bf16 v[200:203], v[228:231], v[224:227], v[200:203]
  v_mfma_f32_16x16x32_bf16 v[204:207], v[230:233], v[224:227], v[204:207]
  v_permlane32_swap_b32 v236, v237
  v_add_f32 v236, v236, v237
  v_mov_b32 v237, v236
  v_mfma_f32_16x16x32_bf16 v[208:211], v[232:235], v[224:227], v[208:211]
  s_nop 0
  v_permlane16_swap_b32 v236, v237
  v_add_f32 v236, v236, v237
  v_rcp_f32 v236, v236
  s_nop 2
  v_pk_mul_f32 v[200:201], v[200:201], v[236:237] op_sel_hi:[1,0]
  v_pk_mul_f32 v[202:203], v[202:203], v[236:237] op_sel_hi:[1,0]
  ds_write_b128 v11, v[200:203] offset:0
  v_pk_mul_f32 v[204:205], v[204:205], v[236:237] op_sel_hi:[1,0]
  v_pk_mul_f32 v[206:207], v[206:207], v[236:237] op_sel_hi:[1,0]
  ds_write_b128 v11, v[204:207] offset:1024
  v_pk_mul_f32 v[208:209], v[208:209], v[236:237] op_sel_hi:[1,0]
  v_pk_mul_f32 v[210:211], v[210:211], v[236:237] op_sel_hi:[1,0]
  ds_write_b128 v11, v[208:211] offset:2048
  s_waitcnt lgkmcnt(0)
  s_barrier
  ds_read_b64 v[96:97], v12 offset:0
  ds_read_b64 v[98:99], v12 offset:128
  ds_read_b64 v[100:101], v12 offset:3072
  ds_read_b64 v[102:103], v12 offset:3200
  ds_read_b64 v[104:105], v12 offset:6144
  ds_read_b64 v[106:107], v12 offset:6272
  ds_read_b64 v[108:109], v12 offset:9216
  ds_read_b64 v[110:111], v12 offset:9344
  s_waitcnt lgkmcnt(6)
  v_pk_add_f32 v[96:97], v[96:97], v[98:99]
  s_waitcnt lgkmcnt(4)
  v_pk_add_f32 v[100:101], v[100:101], v[102:103]
  s_waitcnt lgkmcnt(2)
  v_pk_add_f32 v[104:105], v[104:105], v[106:107]
  v_pk_add_f32 v[96:97], v[96:97], v[100:101]
  s_waitcnt lgkmcnt(0)
  v_pk_add_f32 v[108:109], v[108:109], v[110:111]
  v_pk_add_f32 v[96:97], v[96:97], v[104:105]
  v_pk_add_f32 v[96:97], v[96:97], v[108:109]
  v_cvt_pk_f16_f32 v100, v96, v97
  v_perm_b32 v100, s91, v100, v14
  buffer_atomic_pk_add_f16 v100, v13, s[4:7], s3 offen
  s_mov_b64 exec, s[62:63]
  buffer_store_dwordx4 v[212:215], v21, s[24:27], s85 offen sc1
  buffer_store_dwordx2 v[216:217], v23, s[24:27], s85 offen sc1
  s_mov_b64 exec, -1
  v_mov_b32 v200, v196
  v_mov_b32 v201, v197
  v_mov_b32 v202, v198
  v_mov_b32 v203, v199
  v_permlane32_swap_b32 v188, v192
  v_permlane32_swap_b32 v189, v193
  v_permlane32_swap_b32 v190, v194
  v_permlane32_swap_b32 v191, v195
  v_permlane32_swap_b32 v196, v200
  v_permlane32_swap_b32 v197, v201
  v_permlane32_swap_b32 v198, v202
  v_permlane32_swap_b32 v199, v203
  v_pk_add_f32 v[188:189], v[188:189], v[192:193]
  v_pk_add_f32 v[190:191], v[190:191], v[194:195]
  v_pk_add_f32 v[196:197], v[196:197], v[200:201]
  v_pk_add_f32 v[198:199], v[198:199], v[202:203]
  v_cvt_pk_bf16_f32 v252, v188, v189
  v_cvt_pk_bf16_f32 v254, v196, v197
  v_cvt_pk_bf16_f32 v253, v190, v191
  v_cvt_pk_bf16_f32 v255, v198, v199
  s_nop 0
  v_permlane16_swap_b32 v252, v254
  v_permlane16_swap_b32 v253, v255
  v_min_u32 v252, -2, v252
  s_mov_b64 exec, s[76:77]
  buffer_store_dwordx4 v[252:255], v15, s[24:27], s57 offen sc1
  s_mov_b64 exec, -1
  s_add_u32 s64, s64, 1310720
  s_add_u32 s52, s52, 1
  s_and_b32 s21, s52, 3
  s_mul_i32 s81, s21, 540672
  s_lshl_b32 s84, s21, 15
  s_branch step_55
fl_59:
  buffer_load_dword v94, v95, s[12:15], s79 offen sc1
  s_branch fl_60
pm_57:
  s_cmp_gt_u32 s52, 3
  s_cbranch_scc1 op_67
  v_readfirstlane_b32 s21, v94
  s_cmp_ge_u32 s21, s46
  s_cbranch_scc1 op_67
  buffer_load_dword v94, v95, s[12:15], s79 offen sc1
  s_waitcnt vmcnt(0)
  v_readfirstlane_b32 s21, v94
  s_add_u32 s22, s46, 2
  s_min_u32 s22, s22, 64
  s_sub_u32 s55, s21, s22
  s_sub_u32 s56, s21, s46
  s_cmp_gt_u32 s21, s52
  s_cselect_b32 s21, s87, 0
  s_cmp_eq_u32 s21, 0
  s_cbranch_scc1 op_67
  s_mov_b32 s87, 0
  s_sub_u32 s21, s64, 1310720
  buffer_load_dwordx4 v[176:179], v16, s[28:31], s21 offen offset:0 sc1
  buffer_load_dwordx4 v[180:183], v16, s[28:31], s21 offen offset:1024 sc1
  buffer_load_dwordx4 v[184:187], v16, s[28:31], s21 offen offset:2048 sc1
op_67:
  buffer_load_dwordx4 v[32:35], v4, s[4:7], s84 offen offset:0 sc1
  buffer_load_dwordx4 v[36:39], v4, s[4:7], s84 offen offset:1024 sc1
  buffer_load_dwordx4 v[40:43], v4, s[4:7], s84 offen offset:2048 sc1
  s_add_u32 s54, s54, 1
  s_cmp_gt_u32 s54, 131072
  s_cbranch_scc1 end0
  s_waitcnt vmcnt(0)
  v_bitop3_b32 v27, v35, v39, v43 bitop3:0x80
  v_perm_b32 v35, v39, v35, s89
  v_cmp_gt_u32 vcc, 0x48000000, v27
  v_mov_b32 v39, v42
  s_cbranch_vccnz pm_57
  s_branch A1_17
pv_61:
  buffer_load_dwordx4 v[144:147], v10, s[8:11], s81 offen offset:0 sc1
  buffer_load_dwordx4 v[148:151], v10, s[8:11], s81 offen offset:1024 sc1
  buffer_load_dwordx4 v[152:155], v10, s[8:11], s81 offen offset:2048 sc1
  s_add_u32 s54, s54, 1
  s_cmp_gt_u32 s54, 131072
  s_cbranch_scc1 end0
  s_waitcnt vmcnt(0)
  v_max3_u32 v27, v144, v146, v148
  v_max3_u32 v27, v27, v150, v152
  v_max3_u32 v27, v27, v154, v154
  v_cmp_eq_u32 vcc, -1, v27
  s_nop 1
  s_cbranch_vccnz pv_61
  s_branch pvj_64
psr_62:
  s_cmp_gt_u32 s52, 3
  s_cbranch_scc1 op_68
  v_readfirstlane_b32 s21, v94
  s_cmp_ge_u32 s21, s46
  s_cbranch_scc1 op_68
  buffer_load_dword v94, v95, s[12:15], s79 offen sc1
  s_waitcnt vmcnt(0)
  v_readfirstlane_b32 s21, v94
  s_add_u32 s22, s46, 2
  s_min_u32 s22, s22, 64
  s_sub_u32 s55, s21, s22
  s_sub_u32 s56, s21, s46
  s_cmp_gt_u32 s21, s52
  s_cselect_b32 s21, s87, 0
  s_cmp_eq_u32 s21, 0
  s_cbranch_scc1 op_68
  s_mov_b32 s87, 0
  s_sub_u32 s21, s64, 1310720
  buffer_load_dwordx4 v[176:179], v16, s[28:31], s21 offen offset:0 sc1
  buffer_load_dwordx4 v[180:183], v16, s[28:31], s21 offen offset:1024 sc1
  buffer_load_dwordx4 v[184:187], v16, s[28:31], s21 offen offset:2048 sc1
op_68:
  buffer_load_dwordx2 v[248:249], v9, s[8:11], s81 offen sc1
  buffer_load_dwordx4 v[112:115], v8, s[8:11], s81 offen offset:0 sc1
  buffer_load_dwordx4 v[116:119], v8, s[8:11], s81 offen offset:1024 sc1
  s_add_u32 s54, s54, 1
  s_cmp_gt_u32 s54, 131072
  s_cbranch_scc1 end0
  s_waitcnt vmcnt(2)
  v_xor_b32 v96, s88, v248
  s_nop 0
  v_permlane16_swap_b32 v248, v249
  v_fma_mix_f32 v250, v248, 1.0, v249 op_sel:[0,0,0] op_sel_hi:[1,0,1]
  v_fma_mix_f32 v251, v248, 1.0, v249 op_sel:[1,0,1] op_sel_hi:[1,0,1]
  v_mov_b32 v248, v250
  v_mov_b32 v249, v251
  s_nop 0
  v_permlane32_swap_b32 v248, v250
  v_permlane32_swap_b32 v249, v251
  s_waitcnt vmcnt(0)
  v_bitop3_b32 v97, v112, v114, s88 bitop3:0x7e
  v_bitop3_b32 v98, v116, v118, s88 bitop3:0x7e
  v_fma_mix_f32 v120, v112, 1.0, v116 op_sel:[0,0,0] op_sel_hi:[1,0,1]
  v_or3_b32 v27, v96, v97, v98
  v_fma_mix_f32 v124, v114, 1.0, v118 op_sel:[0,0,0] op_sel_hi:[1,0,1]
  v_and_b32 v27, 1, v27
  v_fma_mix_f32 v121, v112, 1.0, v116 op_sel:[1,0,1] op_sel_hi:[1,0,1]
  v_cmp_ne_u32 vcc, 0, v27
  v_fma_mix_f32 v125, v114, 1.0, v118 op_sel:[1,0,1] op_sel_hi:[1,0,1]
  v_fma_mix_f32 v122, v113, 1.0, v117 op_sel:[0,0,0] op_sel_hi:[1,0,1]
  v_fma_mix_f32 v126, v115, 1.0, v119 op_sel:[0,0,0] op_sel_hi:[1,0,1]
  s_cbranch_vccnz psr_62
  s_branch psj_63
kvw_65:
  s_mov_b32 s22, s87
  s_cmp_eq_u32 s52, 0
  s_cselect_b32 s23, s87, s46
  s_cselect_b32 s55, 0, s55
  s_cselect_b32 s87, 1, 0
  s_cmp_eq_u32 s23, 0
  s_cbranch_scc1 kvok_66
  v_mov_b32 v236, 0
  s_mov_b32 s101, 0
wf_69:
  buffer_load_dword v237, v236, s[12:15], s79 offen sc1
  s_add_u32 s101, s101, 1
  s_cmp_gt_u32 s101, 131072
  s_cbranch_scc1 end0
  s_waitcnt vmcnt(0)
  v_readfirstlane_b32 s100, v237
  s_cmp_ge_u32 s100, s23
  s_cbranch_scc1 wf_70
  s_sleep 3
  s_branch wf_69
wf_70:
  s_cmp_eq_u32 s22, 0
  s_cbranch_scc1 kvok_66
  s_sub_u32 s21, s64, 1310720
  buffer_load_dwordx4 v[176:179], v16, s[28:31], s21 offen offset:0 sc1
  buffer_load_dwordx4 v[180:183], v16, s[28:31], s21 offen offset:1024 sc1
  buffer_load_dwordx4 v[184:187], v16, s[28:31], s21 offen offset:2048 sc1
  s_waitcnt vmcnt(0)
  s_branch kvok_66
last_56:
  s_mov_b64 exec, s[62:63]
  buffer_store_dwordx4 v[212:215], v21, s[24:27], s85 offen sc1
  buffer_store_dwordx2 v[216:217], v23, s[24:27], s85 offen sc1
  s_mov_b64 exec, -1
  v_mov_b32 v188, 0
  v_mov_b32 v189, 0
  v_mov_b32 v190, 0
  v_mov_b32 v191, 0
  v_mov_b32 v192, 0
  v_mov_b32 v193, 0
  v_mov_b32 v194, 0
  v_mov_b32 v195, 0
  v_mov_b32 v196, 0
  v_mov_b32 v197, 0
  v_mov_b32 v198, 0
  v_mov_b32 v199, 0
  s_sleep 4
  s_mov_b32 s54, 0
lv_71:
  buffer_load_dwordx4 v[144:147], v10, s[8:11], s81 offen offset:0 sc1
  buffer_load_dwordx4 v[148:151], v10, s[8:11], s81 offen offset:1024 sc1
  buffer_load_dwordx4 v[152:155], v10, s[8:11], s81 offen offset:2048 sc1
  s_add_u32 s54, s54, 1
  s_cmp_gt_u32 s54, 131072
  s_cbranch_scc1 end0
  s_waitcnt vmcnt(0)
  v_max3_u32 v27, v144, v146, v148
  v_max3_u32 v27, v27, v150, v152
  v_max3_u32 v27, v27, v154, v154
  v_cmp_eq_u32 vcc, -1, v27
  s_nop 1
  s_cbranch_vccnz lv_71
  v_smfmac_f32_16x16x64_bf16 v[188:191], v[144:147], a[180:187], v44
  v_smfmac_f32_16x16x64_bf16 v[192:195], v[144:147], a[204:211], v44
  v_smfmac_f32_16x16x64_bf16 v[196:199], v[144:147], a[228:235], v44
  v_smfmac_f32_16x16x64_bf16 v[188:191], v[148:151], a[188:195], v44
  v_smfmac_f32_16x16x64_bf16 v[192:195], v[148:151], a[212:219], v44
  v_smfmac_f32_16x16x64_bf16 v[196:199], v[148:151], a[236:243], v44
  v_smfmac_f32_16x16x64_bf16 v[188:191], v[152:155], a[196:203], v44
  v_smfmac_f32_16x16x64_bf16 v[192:195], v[152:155], a[220:227], v44
  v_smfmac_f32_16x16x64_bf16 v[196:199], v[152:155], a[244:251], v44
  v_mov_b32 v236, 64
  s_mov_b64 exec, 1
  buffer_store_dword v236, v95, s[12:15], s90 offen sc1
  s_mov_b64 exec, -1
  s_nop 7
  v_mov_b32 v200, v196
  v_mov_b32 v201, v197
  v_mov_b32 v202, v198
  v_mov_b32 v203, v199
  v_permlane32_swap_b32 v188, v192
  v_permlane32_swap_b32 v189, v193
  v_permlane32_swap_b32 v190, v194
  v_permlane32_swap_b32 v191, v195
  v_permlane32_swap_b32 v196, v200
  v_permlane32_swap_b32 v197, v201
  v_permlane32_swap_b32 v198, v202
  v_permlane32_swap_b32 v199, v203
  v_pk_add_f32 v[188:189], v[188:189], v[192:193]
  v_pk_add_f32 v[190:191], v[190:191], v[194:195]
  v_pk_add_f32 v[196:197], v[196:197], v[200:201]
  v_pk_add_f32 v[198:199], v[198:199], v[202:203]
  v_cvt_pk_bf16_f32 v252, v188, v189
  v_cvt_pk_bf16_f32 v254, v196, v197
  v_cvt_pk_bf16_f32 v253, v190, v191
  v_cvt_pk_bf16_f32 v255, v198, v199
  s_nop 0
  v_permlane16_swap_b32 v252, v254
  v_permlane16_swap_b32 v253, v255
  v_min_u32 v252, -2, v252
  s_mov_b64 exec, s[76:77]
  buffer_store_dwordx4 v[252:255], v15, s[24:27], s57 offen sc1
  s_mov_b64 exec, -1
  s_branch chain_done
step_72:
  s_add_u32 s21, s52, 2
  s_and_b32 s21, s21, 3
  s_mul_i32 s82, s21, 540672
  s_add_u32 s21, s52, 3
  s_and_b32 s21, s21, 3
  s_lshl_b32 s83, s21, 15
  s_add_u32 s21, s52, 1
  s_and_b32 s22, s21, 3
  s_lshl_b32 s3, s22, 15
  s_mul_i32 s80, s21, 393216
  s_add_u32 s46, s21, 1
  s_min_u32 s46, s46, 64
  s_mul_i32 s85, s52, 98304
  s_mul_i32 s57, s52, 327680
  s_add_u32 s57, s57, 42991616

  s_bfe_u32 s88, s52, 0x10002
  s_add_u32 s78, s81, 278528
  s_max_u32 s21, s52, 1
  s_sub_u32 s21, s21, 1
  s_cmp_lt_u32 s52, 60
  s_cselect_b32 s66, s65, 0x80000000
  s_cselect_b32 s68, 15, 1
  s_cmp_ge_u32 s52, 61
  s_cselect_b32 s66, s90, s66
  s_cselect_b32 s67, s52, s21
  v_mov_b32 v52, 0
  v_mov_b32 v53, 0
  v_mov_b32 v54, 0
  v_mov_b32 v55, 0
  v_mov_b32 v56, 0
  v_mov_b32 v57, 0
  v_mov_b32 v58, 0
  v_mov_b32 v59, 0
  v_mov_b32 v60, 0
  v_mov_b32 v61, 0
  v_mov_b32 v62, 0
  v_mov_b32 v63, 0
  v_mov_b32 v64, 0
  v_mov_b32 v65, 0
  v_mov_b32 v66, 0
  v_mov_b32 v67, 0
  v_mov_b32 v68, 0
  v_mov_b32 v69, 0
  v_mov_b32 v70, 0
  v_mov_b32 v71, 0
  v_mov_b32 v72, 0
  v_mov_b32 v73, 0
  v_mov_b32 v74, 0
  v_mov_b32 v75, 0
  v_mov_b32 v76, 0
  v_mov_b32 v77, 0
  v_mov_b32 v78, 0
  v_mov_b32 v79, 0
  v_mov_b32 v80, 0
  v_mov_b32 v81, 0
  v_mov_b32 v82, 0
  v_mov_b32 v83, 0
  v_mov_b32 v84, 0
  v_mov_b32 v85, 0
  v_mov_b32 v86, 0
  v_mov_b32 v87, 0
  s_sleep 5
  s_cmp_lt_i32 s55, 0
  s_cbranch_scc1 fl_76
fl_77:
  s_mov_b32 s54, 0
  buffer_load_dwordx4 v[32:35], v4, s[4:7], s84 offen offset:0 sc1
  buffer_load_dwordx4 v[36:39], v4, s[4:7], s84 offen offset:1024 sc1
  buffer_load_dwordx4 v[40:43], v4, s[4:7], s84 offen offset:2048 sc1
  s_waitcnt vmcnt(3)
  v_mov_b32 v176, v160
  v_mov_b32 v177, v161
  v_mov_b32 v178, v162
  v_mov_b32 v179, v163
  v_mov_b32 v180, v164
  v_mov_b32 v181, v165
  v_mov_b32 v182, v166
  v_mov_b32 v183, v167
  v_mov_b32 v184, v48
  v_mov_b32 v185, v49
  v_mov_b32 v186, v50
  v_mov_b32 v187, v51
  s_waitcnt vmcnt(0)
  v_bitop3_b32 v27, v35, v39, v43 bitop3:0x80
  v_perm_b32 v35, v39, v35, s89
  v_cmp_gt_u32 vcc, 0x48000000, v27
  v_mov_b32 v39, v42
  s_cbranch_vccnz pm_74
A1_18:
  v_smfmac_f32_16x16x32_f16 v[52:55], v[40:41], a[16:19], v44
  v_smfmac_f32_16x16x32_f16 v[64:67], v[40:41], a[76:79], v44
  v_smfmac_f32_16x16x32_f16 v[56:59], v[40:41], a[36:39], v44
  v_smfmac_f32_16x16x64_f16 v[52:55], v[32:35], a[0:7], v44
  v_smfmac_f32_16x16x64_f16 v[52:55], v[36:39], a[8:15], v44
  v_smfmac_f32_16x16x32_f16 v[68:71], v[40:41], a[96:99], v44
  v_smfmac_f32_16x16x64_f16 v[64:67], v[32:35], a[60:67], v44
  v_smfmac_f32_16x16x64_f16 v[64:67], v[36:39], a[68:75], v44
  v_smfmac_f32_16x16x32_f16 v[60:63], v[40:41], a[56:59], v44
  v_smfmac_f32_16x16x64_f16 v[56:59], v[32:35], a[20:27], v44
  v_smfmac_f32_16x16x64_f16 v[56:59], v[36:39], a[28:35], v44
  v_permlane32_swap_b32 v52, v64
  v_smfmac_f32_16x16x32_f16 v[72:75], v[40:41], a[116:119], v44
  v_permlane32_swap_b32 v53, v65
  v_add_f32 v52, v52, v64
  v_add_f32 v53, v53, v65
  v_smfmac_f32_16x16x64_f16 v[68:71], v[32:35], a[80:87], v44
  ds_write2_b32 v5, v52, v53 offset0:0 offset1:4
  v_smfmac_f32_16x16x64_f16 v[68:71], v[36:39], a[88:95], v44
  v_permlane32_swap_b32 v54, v66
  v_smfmac_f32_16x16x32_f16 v[76:79], v[40:41], a[136:139], v44
  v_permlane32_swap_b32 v55, v67
  v_add_f32 v54, v54, v66
  v_add_f32 v55, v55, v67
  v_smfmac_f32_16x16x64_f16 v[60:63], v[32:35], a[40:47], v44
  ds_write2_b32 v5, v54, v55 offset0:8 offset1:12
  v_smfmac_f32_16x16x64_f16 v[60:63], v[36:39], a[48:55], v44
  v_permlane32_swap_b32 v56, v68
  v_smfmac_f32_16x16x32_f16 v[80:83], v[40:41], a[156:159], v44
  v_permlane32_swap_b32 v57, v69
  v_add_f32 v56, v56, v68
  v_add_f32 v57, v57, v69
  v_smfmac_f32_16x16x64_f16 v[72:75], v[32:35], a[100:107], v44
  ds_write2_b32 v242, v56, v57 offset0:0 offset1:4
  v_smfmac_f32_16x16x64_f16 v[72:75], v[36:39], a[108:115], v44
  v_permlane32_swap_b32 v58, v70
  v_smfmac_f32_16x16x32_f16 v[84:87], v[40:41], a[176:179], v44
  v_permlane32_swap_b32 v59, v71
  v_add_f32 v58, v58, v70
  v_add_f32 v59, v59, v71
  v_smfmac_f32_16x16x64_f16 v[76:79], v[32:35], a[120:127], v44
  ds_write2_b32 v242, v58, v59 offset0:8 offset1:12
  v_smfmac_f32_16x16x64_f16 v[76:79], v[36:39], a[128:135], v44
  v_permlane32_swap_b32 v60, v72
  v_smfmac_f32_16x16x64_f16 v[80:83], v[32:35], a[140:147], v44
  v_permlane32_swap_b32 v61, v73
  v_add_f32 v60, v60, v72
  v_smfmac_f32_16x16x64_f16 v[80:83], v[36:39], a[148:155], v44
  v_add_f32 v61, v61, v73
  ds_write2_b32 v243, v60, v61 offset0:0 offset1:4
  v_smfmac_f32_16x16x64_f16 v[84:87], v[32:35], a[160:167], v44
  v_permlane32_swap_b32 v62, v74
  v_smfmac_f32_16x16x64_f16 v[84:87], v[36:39], a[168:175], v44
  v_permlane32_swap_b32 v63, v75
  v_add_f32 v62, v62, v74
  v_add_f32 v63, v63, v75
  ds_write2_b32 v243, v62, v63 offset0:8 offset1:12
  v_permlane32_swap_b32 v76, v80
  v_permlane32_swap_b32 v77, v81
  v_add_f32 v76, v76, v80
  v_add_f32 v77, v77, v81
  ds_write2_b32 v244, v76, v77 offset0:0 offset1:4
  v_permlane32_swap_b32 v78, v82
  v_permlane32_swap_b32 v79, v83
  v_add_f32 v78, v78, v82
  v_add_f32 v79, v79, v83
  ds_write2_b32 v244, v78, v79 offset0:8 offset1:12
  ds_write2_b32 v245, v84, v85 offset0:0 offset1:4
  ds_write2_b32 v245, v86, v87 offset0:8 offset1:12
  s_waitcnt lgkmcnt(0) vmcnt(0)
  s_barrier
  ds_read_b128 v[96:99], v6 offset:3264
  ds_read_b128 v[100:103], v6 offset:8704
  ds_read_b128 v[104:107], v6 offset:14144
  ds_read_b128 v[108:111], v6 offset:19584
  ds_read_b128 v[112:115], v6 offset:4352
  ds_read_b128 v[116:119], v6 offset:9792
  ds_read_b128 v[120:123], v6 offset:15232
  ds_read_b128 v[124:127], v6 offset:20672
  s_waitcnt lgkmcnt(4)
  v_pk_add_f32 v[96:97], v[96:97], v[100:101]
  v_pk_add_f32 v[98:99], v[98:99], v[102:103]
  v_pk_add_f32 v[104:105], v[104:105], v[108:109]
  v_pk_add_f32 v[106:107], v[106:107], v[110:111]
  v_pk_add_f32 v[96:97], v[96:97], v[104:105]
  v_pk_add_f32 v[98:99], v[98:99], v[106:107]
  v_cvt_pk_bf16_f32 v90, v96, v97
  v_cvt_pk_bf16_f32 v91, v98, v99
  v_min_u32 v90, -2, v90
  v_min_u32 v91, -2, v91
  buffer_store_dwordx2 v[90:91], v24, s[8:11], s81 offen
  s_waitcnt lgkmcnt(0)
  v_pk_add_f32 v[112:113], v[112:113], v[116:117]
  v_pk_add_f32 v[114:115], v[114:115], v[118:119]
  v_pk_add_f32 v[120:121], v[120:121], v[124:125]
  v_pk_add_f32 v[122:123], v[122:123], v[126:127]
  v_pk_add_f32 v[112:113], v[112:113], v[120:121]
  v_pk_add_f32 v[114:115], v[114:115], v[122:123]
  s_nop 1
  v_add_f32_dpp v116, v112, v112 row_ror:8 row_mask:0xf bank_mask:0xf
  v_add_f32_dpp v117, v113, v113 row_ror:8 row_mask:0xf bank_mask:0xf
  v_add_f32_dpp v118, v114, v114 row_ror:8 row_mask:0xf bank_mask:0xf
  v_add_f32_dpp v119, v115, v115 row_ror:8 row_mask:0xf bank_mask:0xf
  v_cvt_pk_bf16_f32 v92, v116, v117
  v_cvt_pk_bf16_f32 v93, v118, v119
  v_min_u32 v92, -2, v92
  v_min_u32 v93, -2, v93
  s_mov_b64 exec, s[60:61]
  buffer_store_dwordx2 v[92:93], v23, s[8:11], s78 offen
  s_mov_b64 exec, -1
  s_cmp_eq_u32 s52, 63
  s_cbranch_scc1 last_73
  s_sleep 5
  s_mov_b32 s54, 0
  buffer_load_dwordx2 v[248:249], v9, s[8:11], s81 offen sc1
  buffer_load_dwordx4 v[112:115], v8, s[8:11], s81 offen offset:0 sc1
  buffer_load_dwordx4 v[116:119], v8, s[8:11], s81 offen offset:1024 sc1
  s_sleep 2
  buffer_load_dwordx4 v[144:147], v10, s[8:11], s81 offen offset:0 sc1
  buffer_load_dwordx4 v[148:151], v10, s[8:11], s81 offen offset:1024 sc1
  buffer_load_dwordx4 v[152:155], v10, s[8:11], s81 offen offset:2048 sc1
  v_mov_b32 v188, 0
  v_mov_b32 v189, 0
  v_mov_b32 v190, 0
  v_mov_b32 v191, 0
  v_mov_b32 v192, 0
  v_mov_b32 v193, 0
  v_mov_b32 v194, 0
  v_mov_b32 v195, 0
  v_mov_b32 v196, 0
  v_mov_b32 v197, 0
  v_mov_b32 v198, 0
  v_mov_b32 v199, 0
  v_readfirstlane_b32 s21, v94
  s_add_u32 s22, s46, 2
  s_min_u32 s22, s22, 64
  s_sub_u32 s55, s21, s22
  s_sub_u32 s56, s21, s46
  s_waitcnt vmcnt(5)
  v_xor_b32 v96, s88, v248
  s_nop 0
  v_permlane16_swap_b32 v248, v249
  v_fma_mix_f32 v250, v248, 1.0, v249 op_sel:[0,0,0] op_sel_hi:[1,0,1]
  v_fma_mix_f32 v251, v248, 1.0, v249 op_sel:[1,0,1] op_sel_hi:[1,0,1]
  v_mov_b32 v248, v250
  v_mov_b32 v249, v251
  s_nop 0
  v_permlane32_swap_b32 v248, v250
  v_permlane32_swap_b32 v249, v251
  s_waitcnt vmcnt(3)
  v_bitop3_b32 v97, v112, v114, s88 bitop3:0x7e
  v_bitop3_b32 v98, v116, v118, s88 bitop3:0x7e
  v_fma_mix_f32 v120, v112, 1.0, v116 op_sel:[0,0,0] op_sel_hi:[1,0,1]
  v_or3_b32 v27, v96, v97, v98
  v_fma_mix_f32 v124, v114, 1.0, v118 op_sel:[0,0,0] op_sel_hi:[1,0,1]
  v_and_b32 v27, 1, v27
  v_fma_mix_f32 v121, v112, 1.0, v116 op_sel:[1,0,1] op_sel_hi:[1,0,1]
  v_cmp_ne_u32 vcc, 0, v27
  v_fma_mix_f32 v125, v114, 1.0, v118 op_sel:[1,0,1] op_sel_hi:[1,0,1]
  v_fma_mix_f32 v122, v113, 1.0, v117 op_sel:[0,0,0] op_sel_hi:[1,0,1]
  v_fma_mix_f32 v126, v115, 1.0, v119 op_sel:[0,0,0] op_sel_hi:[1,0,1]
  s_cbranch_vccnz psr_79
psj_80:
  s_cmp_lt_i32 s56, 0
  s_cbranch_scc1 kvw_82
kvok_83:
  v_fma_mix_f32 v123, v113, 1.0, v117 op_sel:[1,0,1] op_sel_hi:[1,0,1]
  v_fma_mix_f32 v127, v115, 1.0, v119 op_sel:[1,0,1] op_sel_hi:[1,0,1]
  v_permlane32_swap_b32 v120, v124
  v_permlane32_swap_b32 v121, v125
  v_permlane32_swap_b32 v122, v126
  v_permlane32_swap_b32 v123, v127
  v_pk_add_f32 v[120:121], v[120:121], v[124:125]
  v_pk_add_f32 v[122:123], v[122:123], v[126:127]
  v_pk_add_f32 v[124:125], v[248:249], v[250:251]
  v_max3_f32 v236, v120, v121, v122
  v_max3_f32 v237, v123, v124, v125
  v_max_f32 v236, v236, v237
  s_nop 1
  v_max_f32_dpp v236, v236, v236 row_ror:8 row_mask:0xf bank_mask:0xf
  v_mov_b32 v237, v236
  s_nop 1
  v_permlane32_swap_b32 v236, v237
  v_max_f32 v236, v236, v237
  v_mov_b32 v237, v236
  s_nop 1
  v_permlane16_swap_b32 v236, v237
  v_max_f32 v236, v236, v237
  s_waitcnt vmcnt(0)
  v_max3_u32 v27, v144, v146, v148
  v_max3_u32 v27, v27, v150, v152
  v_max3_u32 v27, v27, v154, v154
  v_cmp_eq_u32 vcc, -1, v27
  s_nop 1
  s_cbranch_vccnz pv_78
pvj_81:
  v_mul_f32 v236, s86, v236
  v_smfmac_f32_16x16x64_bf16 v[188:191], v[144:147], a[180:187], v44
  v_fma_f32 v120, v120, s86, -v236
  v_smfmac_f32_16x16x64_bf16 v[188:191], v[148:151], a[188:195], v44
  v_fma_f32 v121, v121, s86, -v236
  v_smfmac_f32_16x16x64_bf16 v[188:191], v[152:155], a[196:203], v44
  buffer_load_dwordx4 v[160:163], v17, s[28:31], s64 offen offset:0 sc1
  v_fma_f32 v122, v122, s86, -v236
  v_smfmac_f32_16x16x64_bf16 v[192:195], v[144:147], a[204:211], v44
  v_fma_f32 v123, v123, s86, -v236
  v_smfmac_f32_16x16x64_bf16 v[192:195], v[148:151], a[212:219], v44
  buffer_load_dwordx4 v[164:167], v16, s[28:31], s64 offen offset:1024 sc1
  v_fma_f32 v124, v124, s86, -v236
  v_smfmac_f32_16x16x64_bf16 v[192:195], v[152:155], a[220:227], v44
  v_fma_f32 v125, v125, s86, -v236
  v_smfmac_f32_16x16x64_bf16 v[196:199], v[144:147], a[228:235], v44
  buffer_load_dwordx4 v[48:51], v26, s[28:31], s64 offen offset:2048 sc1
  v_exp_f32 v120, v120
  v_smfmac_f32_16x16x64_bf16 v[196:199], v[148:151], a[236:243], v44
  v_exp_f32 v121, v121
  v_smfmac_f32_16x16x64_bf16 v[196:199], v[152:155], a[244:251], v44
  v_exp_f32 v122, v122
  v_exp_f32 v123, v123
  v_mov_b32 v240, s67
  v_mov_b32 v241, s67
  s_mov_b64 exec, s[68:69]
  buffer_store_dwordx2 v[240:241], v88, s[12:15], s66 offen sc1
  s_mov_b64 exec, -1
  v_exp_f32 v124, v124
  v_exp_f32 v125, v125
  s_mov_b64 exec, s[60:61]
  v_cvt_pk_bf16_f32 v220, v120, v121
  v_cvt_pk_bf16_f32 v221, v122, v123
  v_cvt_pk_bf16_f32 v224, v124, v125
  s_mov_b64 exec, s[62:63]
  v_cvt_pk_bf16_f32 v222, v120, v121
  v_cvt_pk_bf16_f32 v223, v122, v123
  v_cvt_pk_bf16_f32 v225, v124, v125
  s_mov_b64 exec, -1
  v_pk_add_f32 v[126:127], v[120:121], v[122:123]
  v_add_f32 v128, v124, v125
  v_mfma_f32_16x16x32_bf16 v[200:203], v[176:179], v[220:223], 0
  v_add_f32 v236, v126, v127
  v_fmac_f32 v236, v128, v89
  v_cvt_pk_bf16_f32 v228, v188, v189
  v_cvt_pk_bf16_f32 v229, v190, v191
  v_mfma_f32_16x16x32_bf16 v[204:207], v[180:183], v[220:223], 0
  v_cvt_pk_bf16_f32 v230, v192, v193
  v_cvt_pk_bf16_f32 v231, v194, v195
  v_mfma_f32_16x16x32_bf16 v[208:211], v[184:187], v[220:223], 0
  v_cvt_pk_bf16_f32 v232, v196, v197
  v_cvt_pk_bf16_f32 v233, v198, v199
  v_add_f32_dpp v236, v236, v236 row_ror:8 row_mask:0xf bank_mask:0xf
  v_mov_b32 v237, v236
  s_nop 0
  v_mfma_f32_16x16x32_bf16 v[200:203], v[228:231], v[224:227], v[200:203]
  v_mfma_f32_16x16x32_bf16 v[204:207], v[230:233], v[224:227], v[204:207]
  v_permlane32_swap_b32 v236, v237
  v_add_f32 v236, v236, v237
  v_mov_b32 v237, v236
  v_mfma_f32_16x16x32_bf16 v[208:211], v[232:235], v[224:227], v[208:211]
  s_nop 0
  v_permlane16_swap_b32 v236, v237
  v_add_f32 v236, v236, v237
  v_rcp_f32 v236, v236
  s_nop 2
  v_pk_mul_f32 v[200:201], v[200:201], v[236:237] op_sel_hi:[1,0]
  v_pk_mul_f32 v[202:203], v[202:203], v[236:237] op_sel_hi:[1,0]
  ds_write_b128 v11, v[200:203] offset:0
  v_pk_mul_f32 v[204:205], v[204:205], v[236:237] op_sel_hi:[1,0]
  v_pk_mul_f32 v[206:207], v[206:207], v[236:237] op_sel_hi:[1,0]
  ds_write_b128 v11, v[204:207] offset:1024
  v_pk_mul_f32 v[208:209], v[208:209], v[236:237] op_sel_hi:[1,0]
  v_pk_mul_f32 v[210:211], v[210:211], v[236:237] op_sel_hi:[1,0]
  ds_write_b128 v11, v[208:211] offset:2048
  s_waitcnt lgkmcnt(0)
  s_barrier
  v_mov_b32 v28, -1
  v_mov_b32 v29, -1
  buffer_store_dwordx2 v[28:29], v24, s[8:11], s82 offen
  s_mov_b64 exec, s[60:61]
  s_add_u32 s22, s82, 278528
  buffer_store_dwordx2 v[28:29], v23, s[8:11], s22 offen
  s_and_b32 s21, s52, 7
  s_cmp_lg_u32 s21, s50
  s_cbranch_scc1 zm_84
  s_mov_b64 exec, s[70:71]
  buffer_store_dwordx4 v[156:159], v13, s[4:7], s83 offen sc1
zm_84:
  s_mov_b64 exec, -1
  v_mov_b32 v200, v196
  v_mov_b32 v201, v197
  v_mov_b32 v202, v198
  v_mov_b32 v203, v199
  v_permlane32_swap_b32 v188, v192
  v_permlane32_swap_b32 v189, v193
  v_permlane32_swap_b32 v190, v194
  v_permlane32_swap_b32 v191, v195
  v_permlane32_swap_b32 v196, v200
  v_permlane32_swap_b32 v197, v201
  v_permlane32_swap_b32 v198, v202
  v_permlane32_swap_b32 v199, v203
  v_pk_add_f32 v[188:189], v[188:189], v[192:193]
  v_pk_add_f32 v[190:191], v[190:191], v[194:195]
  v_pk_add_f32 v[196:197], v[196:197], v[200:201]
  v_pk_add_f32 v[198:199], v[198:199], v[202:203]
  v_cvt_pk_bf16_f32 v252, v188, v189
  v_cvt_pk_bf16_f32 v254, v196, v197
  v_cvt_pk_bf16_f32 v253, v190, v191
  v_cvt_pk_bf16_f32 v255, v198, v199
  s_nop 0
  v_permlane16_swap_b32 v252, v254
  v_permlane16_swap_b32 v253, v255
  v_min_u32 v252, -2, v252
  s_mov_b64 exec, s[76:77]
  buffer_store_dwordx4 v[252:255], v15, s[24:27], s57 offen sc1
  s_mov_b64 exec, -1
  s_add_u32 s64, s64, 1310720
  s_add_u32 s52, s52, 1
  s_and_b32 s21, s52, 3
  s_mul_i32 s81, s21, 540672
  s_lshl_b32 s84, s21, 15
  s_branch step_72
fl_76:
  buffer_load_dword v94, v95, s[12:15], s79 offen sc1
  s_branch fl_77
pm_74:
  s_cmp_gt_u32 s52, 3
  s_cbranch_scc1 op_85
  v_readfirstlane_b32 s21, v94
  s_cmp_ge_u32 s21, s46
  s_cbranch_scc1 op_85
  buffer_load_dword v94, v95, s[12:15], s79 offen sc1
  s_waitcnt vmcnt(0)
  v_readfirstlane_b32 s21, v94
  s_add_u32 s22, s46, 2
  s_min_u32 s22, s22, 64
  s_sub_u32 s55, s21, s22
  s_sub_u32 s56, s21, s46
  s_cmp_gt_u32 s21, s52
  s_cselect_b32 s21, s87, 0
  s_cmp_eq_u32 s21, 0
  s_cbranch_scc1 op_85
  s_mov_b32 s87, 0
  s_sub_u32 s21, s64, 1310720
  buffer_load_dwordx4 v[176:179], v16, s[28:31], s21 offen offset:0 sc1
  buffer_load_dwordx4 v[180:183], v16, s[28:31], s21 offen offset:1024 sc1
  buffer_load_dwordx4 v[184:187], v16, s[28:31], s21 offen offset:2048 sc1
op_85:
  buffer_load_dwordx4 v[32:35], v4, s[4:7], s84 offen offset:0 sc1
  buffer_load_dwordx4 v[36:39], v4, s[4:7], s84 offen offset:1024 sc1
  buffer_load_dwordx4 v[40:43], v4, s[4:7], s84 offen offset:2048 sc1
  s_add_u32 s54, s54, 1
  s_cmp_gt_u32 s54, 131072
  s_cbranch_scc1 end0
  s_waitcnt vmcnt(0)
  v_bitop3_b32 v27, v35, v39, v43 bitop3:0x80
  v_perm_b32 v35, v39, v35, s89
  v_cmp_gt_u32 vcc, 0x48000000, v27
  v_mov_b32 v39, v42
  s_cbranch_vccnz pm_74
  s_branch A1_18
pv_78:
  buffer_load_dwordx4 v[144:147], v10, s[8:11], s81 offen offset:0 sc1
  buffer_load_dwordx4 v[148:151], v10, s[8:11], s81 offen offset:1024 sc1
  buffer_load_dwordx4 v[152:155], v10, s[8:11], s81 offen offset:2048 sc1
  s_add_u32 s54, s54, 1
  s_cmp_gt_u32 s54, 131072
  s_cbranch_scc1 end0
  s_waitcnt vmcnt(0)
  v_max3_u32 v27, v144, v146, v148
  v_max3_u32 v27, v27, v150, v152
  v_max3_u32 v27, v27, v154, v154
  v_cmp_eq_u32 vcc, -1, v27
  s_nop 1
  s_cbranch_vccnz pv_78
  s_branch pvj_81
psr_79:
  s_cmp_gt_u32 s52, 3
  s_cbranch_scc1 op_86
  v_readfirstlane_b32 s21, v94
  s_cmp_ge_u32 s21, s46
  s_cbranch_scc1 op_86
  buffer_load_dword v94, v95, s[12:15], s79 offen sc1
  s_waitcnt vmcnt(0)
  v_readfirstlane_b32 s21, v94
  s_add_u32 s22, s46, 2
  s_min_u32 s22, s22, 64
  s_sub_u32 s55, s21, s22
  s_sub_u32 s56, s21, s46
  s_cmp_gt_u32 s21, s52
  s_cselect_b32 s21, s87, 0
  s_cmp_eq_u32 s21, 0
  s_cbranch_scc1 op_86
  s_mov_b32 s87, 0
  s_sub_u32 s21, s64, 1310720
  buffer_load_dwordx4 v[176:179], v16, s[28:31], s21 offen offset:0 sc1
  buffer_load_dwordx4 v[180:183], v16, s[28:31], s21 offen offset:1024 sc1
  buffer_load_dwordx4 v[184:187], v16, s[28:31], s21 offen offset:2048 sc1
op_86:
  buffer_load_dwordx2 v[248:249], v9, s[8:11], s81 offen sc1
  buffer_load_dwordx4 v[112:115], v8, s[8:11], s81 offen offset:0 sc1
  buffer_load_dwordx4 v[116:119], v8, s[8:11], s81 offen offset:1024 sc1
  s_add_u32 s54, s54, 1
  s_cmp_gt_u32 s54, 131072
  s_cbranch_scc1 end0
  s_waitcnt vmcnt(2)
  v_xor_b32 v96, s88, v248
  s_nop 0
  v_permlane16_swap_b32 v248, v249
  v_fma_mix_f32 v250, v248, 1.0, v249 op_sel:[0,0,0] op_sel_hi:[1,0,1]
  v_fma_mix_f32 v251, v248, 1.0, v249 op_sel:[1,0,1] op_sel_hi:[1,0,1]
  v_mov_b32 v248, v250
  v_mov_b32 v249, v251
  s_nop 0
  v_permlane32_swap_b32 v248, v250
  v_permlane32_swap_b32 v249, v251
  s_waitcnt vmcnt(0)
  v_bitop3_b32 v97, v112, v114, s88 bitop3:0x7e
  v_bitop3_b32 v98, v116, v118, s88 bitop3:0x7e
  v_fma_mix_f32 v120, v112, 1.0, v116 op_sel:[0,0,0] op_sel_hi:[1,0,1]
  v_or3_b32 v27, v96, v97, v98
  v_fma_mix_f32 v124, v114, 1.0, v118 op_sel:[0,0,0] op_sel_hi:[1,0,1]
  v_and_b32 v27, 1, v27
  v_fma_mix_f32 v121, v112, 1.0, v116 op_sel:[1,0,1] op_sel_hi:[1,0,1]
  v_cmp_ne_u32 vcc, 0, v27
  v_fma_mix_f32 v125, v114, 1.0, v118 op_sel:[1,0,1] op_sel_hi:[1,0,1]
  v_fma_mix_f32 v122, v113, 1.0, v117 op_sel:[0,0,0] op_sel_hi:[1,0,1]
  v_fma_mix_f32 v126, v115, 1.0, v119 op_sel:[0,0,0] op_sel_hi:[1,0,1]
  s_cbranch_vccnz psr_79
  s_branch psj_80
kvw_82:
  s_mov_b32 s22, s87
  s_cmp_eq_u32 s52, 0
  s_cselect_b32 s23, s87, s46
  s_cselect_b32 s55, 0, s55
  s_cselect_b32 s87, 1, 0
  s_cmp_eq_u32 s23, 0
  s_cbranch_scc1 kvok_83
  v_mov_b32 v236, 0
  s_mov_b32 s101, 0
wf_87:
  buffer_load_dword v237, v236, s[12:15], s79 offen sc1
  s_add_u32 s101, s101, 1
  s_cmp_gt_u32 s101, 131072
  s_cbranch_scc1 end0
  s_waitcnt vmcnt(0)
  v_readfirstlane_b32 s100, v237
  s_cmp_ge_u32 s100, s23
  s_cbranch_scc1 wf_88
  s_sleep 3
  s_branch wf_87
wf_88:
  s_cmp_eq_u32 s22, 0
  s_cbranch_scc1 kvok_83
  s_sub_u32 s21, s64, 1310720
  buffer_load_dwordx4 v[176:179], v16, s[28:31], s21 offen offset:0 sc1
  buffer_load_dwordx4 v[180:183], v16, s[28:31], s21 offen offset:1024 sc1
  buffer_load_dwordx4 v[184:187], v16, s[28:31], s21 offen offset:2048 sc1
  s_waitcnt vmcnt(0)
  s_branch kvok_83
last_73:
  v_mov_b32 v188, 0
  v_mov_b32 v189, 0
  v_mov_b32 v190, 0
  v_mov_b32 v191, 0
  v_mov_b32 v192, 0
  v_mov_b32 v193, 0
  v_mov_b32 v194, 0
  v_mov_b32 v195, 0
  v_mov_b32 v196, 0
  v_mov_b32 v197, 0
  v_mov_b32 v198, 0
  v_mov_b32 v199, 0
  s_sleep 4
  s_mov_b32 s54, 0
lv_89:
  buffer_load_dwordx4 v[144:147], v10, s[8:11], s81 offen offset:0 sc1
  buffer_load_dwordx4 v[148:151], v10, s[8:11], s81 offen offset:1024 sc1
  buffer_load_dwordx4 v[152:155], v10, s[8:11], s81 offen offset:2048 sc1
  s_add_u32 s54, s54, 1
  s_cmp_gt_u32 s54, 131072
  s_cbranch_scc1 end0
  s_waitcnt vmcnt(0)
  v_max3_u32 v27, v144, v146, v148
  v_max3_u32 v27, v27, v150, v152
  v_max3_u32 v27, v27, v154, v154
  v_cmp_eq_u32 vcc, -1, v27
  s_nop 1
  s_cbranch_vccnz lv_89
  v_smfmac_f32_16x16x64_bf16 v[188:191], v[144:147], a[180:187], v44
  v_smfmac_f32_16x16x64_bf16 v[192:195], v[144:147], a[204:211], v44
  v_smfmac_f32_16x16x64_bf16 v[196:199], v[144:147], a[228:235], v44
  v_smfmac_f32_16x16x64_bf16 v[188:191], v[148:151], a[188:195], v44
  v_smfmac_f32_16x16x64_bf16 v[192:195], v[148:151], a[212:219], v44
  v_smfmac_f32_16x16x64_bf16 v[196:199], v[148:151], a[236:243], v44
  v_smfmac_f32_16x16x64_bf16 v[188:191], v[152:155], a[196:203], v44
  v_smfmac_f32_16x16x64_bf16 v[192:195], v[152:155], a[220:227], v44
  v_smfmac_f32_16x16x64_bf16 v[196:199], v[152:155], a[244:251], v44
  s_nop 7
  v_mov_b32 v200, v196
  v_mov_b32 v201, v197
  v_mov_b32 v202, v198
  v_mov_b32 v203, v199
  v_permlane32_swap_b32 v188, v192
  v_permlane32_swap_b32 v189, v193
  v_permlane32_swap_b32 v190, v194
  v_permlane32_swap_b32 v191, v195
  v_permlane32_swap_b32 v196, v200
  v_permlane32_swap_b32 v197, v201
  v_permlane32_swap_b32 v198, v202
  v_permlane32_swap_b32 v199, v203
  v_pk_add_f32 v[188:189], v[188:189], v[192:193]
  v_pk_add_f32 v[190:191], v[190:191], v[194:195]
  v_pk_add_f32 v[196:197], v[196:197], v[200:201]
  v_pk_add_f32 v[198:199], v[198:199], v[202:203]
  v_cvt_pk_bf16_f32 v252, v188, v189
  v_cvt_pk_bf16_f32 v254, v196, v197
  v_cvt_pk_bf16_f32 v253, v190, v191
  v_cvt_pk_bf16_f32 v255, v198, v199
  s_nop 0
  v_permlane16_swap_b32 v252, v254
  v_permlane16_swap_b32 v253, v255
  v_min_u32 v252, -2, v252
  s_mov_b64 exec, s[76:77]
  buffer_store_dwordx4 v[252:255], v15, s[24:27], s57 offen sc1
  s_mov_b64 exec, -1
  s_branch chain_done
step_90:
  s_add_u32 s21, s52, 2
  s_and_b32 s21, s21, 3
  s_mul_i32 s82, s21, 540672
  s_add_u32 s21, s52, 3
  s_and_b32 s21, s21, 3
  s_lshl_b32 s83, s21, 15
  s_add_u32 s21, s52, 1
  s_and_b32 s22, s21, 3
  s_lshl_b32 s3, s22, 15
  s_mul_i32 s80, s21, 393216
  s_add_u32 s46, s21, 1
  s_min_u32 s46, s46, 64
  s_mul_i32 s85, s52, 98304
  s_mul_i32 s57, s52, 327680
  s_add_u32 s57, s57, 42991616

  s_bfe_u32 s88, s52, 0x10002
  s_add_u32 s78, s81, 278528
  s_max_u32 s21, s52, 1
  s_sub_u32 s21, s21, 1
  s_cmp_lt_u32 s52, 60
  s_cselect_b32 s66, s65, 0x80000000
  s_cselect_b32 s68, 15, 1
  s_cmp_ge_u32 s52, 61
  s_cselect_b32 s66, s90, s66
  s_cselect_b32 s67, s52, s21
  v_mov_b32 v52, 0
  v_mov_b32 v53, 0
  v_mov_b32 v54, 0
  v_mov_b32 v55, 0
  v_mov_b32 v56, 0
  v_mov_b32 v57, 0
  v_mov_b32 v58, 0
  v_mov_b32 v59, 0
  v_mov_b32 v60, 0
  v_mov_b32 v61, 0
  v_mov_b32 v62, 0
  v_mov_b32 v63, 0
  v_mov_b32 v64, 0
  v_mov_b32 v65, 0
  v_mov_b32 v66, 0
  v_mov_b32 v67, 0
  v_mov_b32 v68, 0
  v_mov_b32 v69, 0
  v_mov_b32 v70, 0
  v_mov_b32 v71, 0
  v_mov_b32 v72, 0
  v_mov_b32 v73, 0
  v_mov_b32 v74, 0
  v_mov_b32 v75, 0
  v_mov_b32 v76, 0
  v_mov_b32 v77, 0
  v_mov_b32 v78, 0
  v_mov_b32 v79, 0
  v_mov_b32 v80, 0
  v_mov_b32 v81, 0
  v_mov_b32 v82, 0
  v_mov_b32 v83, 0
  v_mov_b32 v84, 0
  v_mov_b32 v85, 0
  v_mov_b32 v86, 0
  v_mov_b32 v87, 0
  s_sleep 8
  s_cmp_lt_i32 s55, 0
  s_cbranch_scc1 fl_94
fl_95:
  s_mov_b32 s54, 0
  buffer_load_dwordx4 v[32:35], v4, s[4:7], s84 offen offset:0 sc1
  buffer_load_dwordx4 v[36:39], v4, s[4:7], s84 offen offset:1024 sc1
  buffer_load_dwordx4 v[40:43], v4, s[4:7], s84 offen offset:2048 sc1
  s_waitcnt vmcnt(3)
  v_mov_b32 v176, v160
  v_mov_b32 v177, v161
  v_mov_b32 v178, v162
  v_mov_b32 v179, v163
  v_mov_b32 v180, v164
  v_mov_b32 v181, v165
  v_mov_b32 v182, v166
  v_mov_b32 v183, v167
  v_mov_b32 v184, v48
  v_mov_b32 v185, v49
  v_mov_b32 v186, v50
  v_mov_b32 v187, v51
  s_waitcnt vmcnt(0)
  v_bitop3_b32 v27, v35, v39, v43 bitop3:0x80
  v_perm_b32 v35, v39, v35, s89
  v_cmp_gt_u32 vcc, 0x48000000, v27
  v_mov_b32 v39, v42
  s_cbranch_vccnz pm_92
A1_19:
  v_smfmac_f32_16x16x32_f16 v[52:55], v[40:41], a[16:19], v44
  v_smfmac_f32_16x16x32_f16 v[64:67], v[40:41], a[76:79], v44
  v_smfmac_f32_16x16x32_f16 v[56:59], v[40:41], a[36:39], v44
  v_smfmac_f32_16x16x64_f16 v[52:55], v[32:35], a[0:7], v44
  v_smfmac_f32_16x16x64_f16 v[52:55], v[36:39], a[8:15], v44
  v_smfmac_f32_16x16x32_f16 v[68:71], v[40:41], a[96:99], v44
  v_smfmac_f32_16x16x64_f16 v[64:67], v[32:35], a[60:67], v44
  v_smfmac_f32_16x16x64_f16 v[64:67], v[36:39], a[68:75], v44
  v_smfmac_f32_16x16x32_f16 v[60:63], v[40:41], a[56:59], v44
  v_smfmac_f32_16x16x64_f16 v[56:59], v[32:35], a[20:27], v44
  v_smfmac_f32_16x16x64_f16 v[56:59], v[36:39], a[28:35], v44
  v_permlane32_swap_b32 v52, v64
  v_smfmac_f32_16x16x32_f16 v[72:75], v[40:41], a[116:119], v44
  v_permlane32_swap_b32 v53, v65
  v_add_f32 v52, v52, v64
  v_add_f32 v53, v53, v65
  v_smfmac_f32_16x16x64_f16 v[68:71], v[32:35], a[80:87], v44
  ds_write2_b32 v5, v52, v53 offset0:0 offset1:4
  v_smfmac_f32_16x16x64_f16 v[68:71], v[36:39], a[88:95], v44
  v_permlane32_swap_b32 v54, v66
  v_smfmac_f32_16x16x32_f16 v[76:79], v[40:41], a[136:139], v44
  v_permlane32_swap_b32 v55, v67
  v_add_f32 v54, v54, v66
  v_add_f32 v55, v55, v67
  v_smfmac_f32_16x16x64_f16 v[60:63], v[32:35], a[40:47], v44
  ds_write2_b32 v5, v54, v55 offset0:8 offset1:12
  v_smfmac_f32_16x16x64_f16 v[60:63], v[36:39], a[48:55], v44
  v_permlane32_swap_b32 v56, v68
  v_smfmac_f32_16x16x32_f16 v[80:83], v[40:41], a[156:159], v44
  v_permlane32_swap_b32 v57, v69
  v_add_f32 v56, v56, v68
  v_add_f32 v57, v57, v69
  v_smfmac_f32_16x16x64_f16 v[72:75], v[32:35], a[100:107], v44
  ds_write2_b32 v242, v56, v57 offset0:0 offset1:4
  v_smfmac_f32_16x16x64_f16 v[72:75], v[36:39], a[108:115], v44
  v_permlane32_swap_b32 v58, v70
  v_smfmac_f32_16x16x32_f16 v[84:87], v[40:41], a[176:179], v44
  v_permlane32_swap_b32 v59, v71
  v_add_f32 v58, v58, v70
  v_add_f32 v59, v59, v71
  v_smfmac_f32_16x16x64_f16 v[76:79], v[32:35], a[120:127], v44
  ds_write2_b32 v242, v58, v59 offset0:8 offset1:12
  v_smfmac_f32_16x16x64_f16 v[76:79], v[36:39], a[128:135], v44
  v_permlane32_swap_b32 v60, v72
  v_smfmac_f32_16x16x64_f16 v[80:83], v[32:35], a[140:147], v44
  v_permlane32_swap_b32 v61, v73
  v_add_f32 v60, v60, v72
  v_smfmac_f32_16x16x64_f16 v[80:83], v[36:39], a[148:155], v44
  v_add_f32 v61, v61, v73
  ds_write2_b32 v243, v60, v61 offset0:0 offset1:4
  v_smfmac_f32_16x16x64_f16 v[84:87], v[32:35], a[160:167], v44
  v_permlane32_swap_b32 v62, v74
  v_smfmac_f32_16x16x64_f16 v[84:87], v[36:39], a[168:175], v44
  v_permlane32_swap_b32 v63, v75
  v_add_f32 v62, v62, v74
  v_add_f32 v63, v63, v75
  ds_write2_b32 v243, v62, v63 offset0:8 offset1:12
  v_permlane32_swap_b32 v76, v80
  v_permlane32_swap_b32 v77, v81
  v_add_f32 v76, v76, v80
  v_add_f32 v77, v77, v81
  ds_write2_b32 v244, v76, v77 offset0:0 offset1:4
  v_permlane32_swap_b32 v78, v82
  v_permlane32_swap_b32 v79, v83
  v_add_f32 v78, v78, v82
  v_add_f32 v79, v79, v83
  ds_write2_b32 v244, v78, v79 offset0:8 offset1:12
  ds_write2_b32 v245, v84, v85 offset0:0 offset1:4
  ds_write2_b32 v245, v86, v87 offset0:8 offset1:12
  s_waitcnt lgkmcnt(0) vmcnt(0)
  s_barrier
  s_lshr_b32 s21, 3, s20
  s_bitcmp1_b32 s21, 0
  s_cbranch_scc0 bw_97
  ds_read_b128 v[96:99], v45 offset:0
  ds_read_b128 v[108:111], v45 offset:5440
  ds_read_b128 v[100:103], v45 offset:1088
  ds_read_b128 v[112:115], v45 offset:6528
  ds_read_b128 v[104:107], v45 offset:2176
  ds_read_b128 v[116:119], v45 offset:7616
  s_waitcnt lgkmcnt(4)
  v_pk_add_f32 v[96:97], v[96:97], v[108:109]
  v_pk_add_f32 v[98:99], v[98:99], v[110:111]
  s_nop 0
  v_add_f32_dpp v108, v96, v96 row_ror:8 row_mask:0xf bank_mask:0xf
  v_add_f32_dpp v109, v97, v97 row_ror:8 row_mask:0xf bank_mask:0xf
  v_add_f32_dpp v110, v98, v98 row_ror:8 row_mask:0xf bank_mask:0xf
  v_add_f32_dpp v111, v99, v99 row_ror:8 row_mask:0xf bank_mask:0xf
  v_cvt_pk_bf16_f32 v212, v108, v109
  v_cvt_pk_bf16_f32 v213, v110, v111
  s_waitcnt lgkmcnt(2)
  v_pk_add_f32 v[100:101], v[100:101], v[112:113]
  v_pk_add_f32 v[102:103], v[102:103], v[114:115]
  s_nop 0
  v_add_f32_dpp v112, v100, v100 row_ror:8 row_mask:0xf bank_mask:0xf
  v_add_f32_dpp v113, v101, v101 row_ror:8 row_mask:0xf bank_mask:0xf
  v_add_f32_dpp v114, v102, v102 row_ror:8 row_mask:0xf bank_mask:0xf
  v_add_f32_dpp v115, v103, v103 row_ror:8 row_mask:0xf bank_mask:0xf
  v_cvt_pk_bf16_f32 v214, v112, v113
  v_cvt_pk_bf16_f32 v215, v114, v115
  s_waitcnt lgkmcnt(0)
  v_pk_add_f32 v[104:105], v[104:105], v[116:117]
  v_pk_add_f32 v[106:107], v[106:107], v[118:119]
  v_mfma_f32_16x16x32_bf16 v[96:99], v[168:171], v[212:215], 0
  v_add_f32_dpp v116, v104, v104 row_ror:8 row_mask:0xf bank_mask:0xf
  v_add_f32_dpp v117, v105, v105 row_ror:8 row_mask:0xf bank_mask:0xf
  v_add_f32_dpp v118, v106, v106 row_ror:8 row_mask:0xf bank_mask:0xf
  v_add_f32_dpp v119, v107, v107 row_ror:8 row_mask:0xf bank_mask:0xf
  v_cvt_pk_bf16_f32 v216, v116, v117
  v_cvt_pk_bf16_f32 v217, v118, v119
  s_nop 1
  v_mfma_f32_16x16x32_bf16 v[96:99], v[172:175], v[216:219], v[96:99]
  s_mov_b64 exec, s[74:75]
  s_nop 6
  v_cvt_pk_f16_f32 v100, v96, v97
  v_cvt_pk_f16_f32 v101, v98, v99
  v_and_or_b32 v100, v100, -2, s88
  s_cmp_eq_u32 s53, 1
  s_cbranch_scc1 si_98
  buffer_store_dwordx2 v[100:101], v7, s[8:11], s81 offen sc1
  s_branch si_99
si_98:
  buffer_store_dwordx2 v[100:101], v7, s[8:11], s81 offen
si_99:
  s_mov_b64 exec, -1
  s_branch bw_96
bw_97:
  s_lshr_b32 s21, 4, s20
  s_bitcmp1_b32 s21, 0
  s_cbranch_scc0 bw_100
  ds_read_b128 v[96:99], v6 offset:0
  ds_read_b128 v[108:111], v6 offset:5440
  ds_read_b128 v[120:123], v6 offset:10880
  ds_read_b128 v[132:135], v6 offset:16320
  ds_read_b128 v[100:103], v6 offset:1088
  ds_read_b128 v[112:115], v6 offset:6528
  ds_read_b128 v[124:127], v6 offset:11968
  ds_read_b128 v[136:139], v6 offset:17408
  ds_read_b128 v[104:107], v6 offset:2176
  ds_read_b128 v[116:119], v6 offset:7616
  ds_read_b128 v[128:131], v6 offset:13056
  ds_read_b128 v[140:143], v6 offset:18496
  s_waitcnt lgkmcnt(8)
  v_pk_add_f32 v[96:97], v[96:97], v[108:109]
  v_pk_add_f32 v[120:121], v[120:121], v[132:133]
  v_pk_add_f32 v[98:99], v[98:99], v[110:111]
  v_pk_add_f32 v[122:123], v[122:123], v[134:135]
  v_pk_add_f32 v[96:97], v[96:97], v[120:121]
  v_pk_add_f32 v[98:99], v[98:99], v[122:123]
  v_cvt_pk_bf16_f32 v212, v96, v97
  v_cvt_pk_bf16_f32 v213, v98, v99
  s_waitcnt lgkmcnt(4)
  v_pk_add_f32 v[100:101], v[100:101], v[112:113]
  v_pk_add_f32 v[124:125], v[124:125], v[136:137]
  v_pk_add_f32 v[102:103], v[102:103], v[114:115]
  v_pk_add_f32 v[126:127], v[126:127], v[138:139]
  v_pk_add_f32 v[100:101], v[100:101], v[124:125]
  v_pk_add_f32 v[102:103], v[102:103], v[126:127]
  v_cvt_pk_bf16_f32 v214, v100, v101
  v_cvt_pk_bf16_f32 v215, v102, v103
  s_waitcnt lgkmcnt(0)
  v_pk_add_f32 v[104:105], v[104:105], v[116:117]
  v_pk_add_f32 v[128:129], v[128:129], v[140:141]
  v_pk_add_f32 v[106:107], v[106:107], v[118:119]
  v_pk_add_f32 v[130:131], v[130:131], v[142:143]
  v_mfma_f32_16x16x32_bf16 v[96:99], v[212:215], v[212:215], 0
  v_pk_add_f32 v[104:105], v[104:105], v[128:129]
  v_pk_add_f32 v[106:107], v[106:107], v[130:131]
  v_cvt_pk_bf16_f32 v216, v104, v105
  v_cvt_pk_bf16_f32 v217, v106, v107
  s_nop 1
  v_mfma_f32_16x16x32_bf16 v[96:99], v[216:219], v[216:219], v[96:99]
  s_mov_b64 exec, s[74:75]
  s_nop 6
  v_cvt_pk_f16_f32 v100, v96, v97
  v_cvt_pk_f16_f32 v101, v98, v99
  v_and_or_b32 v100, v100, -2, s88
  s_cmp_eq_u32 s53, 1
  s_cbranch_scc1 si_101
  buffer_store_dwordx2 v[100:101], v7, s[8:11], s81 offen sc1
  s_branch si_102
si_101:
  buffer_store_dwordx2 v[100:101], v7, s[8:11], s81 offen
si_102:
  s_mov_b64 exec, -1
  s_branch bw_96
bw_100:
  s_lshr_b32 s21, 8, s20
  s_bitcmp1_b32 s21, 0
  s_cbranch_scc0 bw_103
  ds_read_b128 v[96:99], v6 offset:3264
  ds_read_b128 v[100:103], v6 offset:8704
  ds_read_b128 v[104:107], v6 offset:14144
  ds_read_b128 v[108:111], v6 offset:19584
  ds_read_b128 v[112:115], v6 offset:4352
  ds_read_b128 v[116:119], v6 offset:9792
  ds_read_b128 v[120:123], v6 offset:15232
  ds_read_b128 v[124:127], v6 offset:20672
  s_waitcnt lgkmcnt(4)
  v_pk_add_f32 v[96:97], v[96:97], v[100:101]
  v_pk_add_f32 v[98:99], v[98:99], v[102:103]
  v_pk_add_f32 v[104:105], v[104:105], v[108:109]
  v_pk_add_f32 v[106:107], v[106:107], v[110:111]
  v_pk_add_f32 v[96:97], v[96:97], v[104:105]
  v_pk_add_f32 v[98:99], v[98:99], v[106:107]
  v_cvt_pk_bf16_f32 v90, v96, v97
  v_cvt_pk_bf16_f32 v91, v98, v99
  v_min_u32 v90, -2, v90
  v_min_u32 v91, -2, v91
  s_cmp_eq_u32 s53, 1
  s_cbranch_scc1 si_104
  buffer_store_dwordx2 v[90:91], v24, s[8:11], s81 offen sc1
  s_branch si_105
si_104:
  buffer_store_dwordx2 v[90:91], v24, s[8:11], s81 offen
si_105:
  s_waitcnt lgkmcnt(0)
  v_pk_add_f32 v[112:113], v[112:113], v[116:117]
  v_pk_add_f32 v[114:115], v[114:115], v[118:119]
  v_pk_add_f32 v[120:121], v[120:121], v[124:125]
  v_pk_add_f32 v[122:123], v[122:123], v[126:127]
  v_pk_add_f32 v[112:113], v[112:113], v[120:121]
  v_pk_add_f32 v[114:115], v[114:115], v[122:123]
  s_nop 1
  v_add_f32_dpp v116, v112, v112 row_ror:8 row_mask:0xf bank_mask:0xf
  v_add_f32_dpp v117, v113, v113 row_ror:8 row_mask:0xf bank_mask:0xf
  v_add_f32_dpp v118, v114, v114 row_ror:8 row_mask:0xf bank_mask:0xf
  v_add_f32_dpp v119, v115, v115 row_ror:8 row_mask:0xf bank_mask:0xf
  v_cvt_pk_bf16_f32 v92, v116, v117
  v_cvt_pk_bf16_f32 v93, v118, v119
  v_min_u32 v92, -2, v92
  v_min_u32 v93, -2, v93
  s_mov_b64 exec, s[60:61]
  s_cmp_eq_u32 s53, 1
  s_cbranch_scc1 si_106
  buffer_store_dwordx2 v[92:93], v23, s[8:11], s78 offen sc1
  s_branch si_107
si_106:
  buffer_store_dwordx2 v[92:93], v23, s[8:11], s78 offen
si_107:
  s_mov_b64 exec, -1
  s_branch bw_96
bw_103:
bw_96:
  s_cmp_eq_u32 s52, 63
  s_cbranch_scc1 last_91
  s_mov_b32 s54, 0
pv_108:
  buffer_load_dwordx4 v[144:147], v10, s[8:11], s81 offen offset:0 sc1
  buffer_load_dwordx4 v[148:151], v10, s[8:11], s81 offen offset:1024 sc1
  buffer_load_dwordx4 v[152:155], v10, s[8:11], s81 offen offset:2048 sc1
  v_mov_b32 v188, 0
  v_mov_b32 v189, 0
  v_mov_b32 v190, 0
  v_mov_b32 v191, 0
  v_mov_b32 v192, 0
  v_mov_b32 v193, 0
  v_mov_b32 v194, 0
  v_mov_b32 v195, 0
  v_mov_b32 v196, 0
  v_mov_b32 v197, 0
  v_mov_b32 v198, 0
  v_mov_b32 v199, 0
  s_add_u32 s54, s54, 1
  s_cmp_gt_u32 s54, 131072
  s_cbranch_scc1 end0
  s_waitcnt vmcnt(0)
  v_max3_u32 v27, v144, v146, v148
  v_max3_u32 v27, v27, v150, v152
  v_max3_u32 v27, v27, v154, v154
  v_cmp_eq_u32 vcc, -1, v27
  s_nop 1
  s_cbranch_vccnz pv_108
  buffer_load_dwordx2 v[248:249], v9, s[8:11], s81 offen sc1
  buffer_load_dwordx4 v[112:115], v8, s[8:11], s81 offen offset:0 sc1
  buffer_load_dwordx4 v[116:119], v8, s[8:11], s81 offen offset:1024 sc1
  v_smfmac_f32_16x16x64_bf16 v[188:191], v[144:147], a[180:187], v44
  v_smfmac_f32_16x16x64_bf16 v[192:195], v[144:147], a[204:211], v44
  v_smfmac_f32_16x16x64_bf16 v[196:199], v[144:147], a[228:235], v44
  v_smfmac_f32_16x16x64_bf16 v[188:191], v[148:151], a[188:195], v44
  v_smfmac_f32_16x16x64_bf16 v[192:195], v[148:151], a[212:219], v44
  v_smfmac_f32_16x16x64_bf16 v[196:199], v[148:151], a[236:243], v44
  v_smfmac_f32_16x16x64_bf16 v[188:191], v[152:155], a[196:203], v44
  v_smfmac_f32_16x16x64_bf16 v[192:195], v[152:155], a[220:227], v44
  v_smfmac_f32_16x16x64_bf16 v[196:199], v[152:155], a[244:251], v44
  v_readfirstlane_b32 s21, v94
  s_add_u32 s22, s46, 2
  s_min_u32 s22, s22, 64
  s_sub_u32 s55, s21, s22
  s_sub_u32 s56, s21, s46
  s_waitcnt vmcnt(2)
  v_xor_b32 v96, s88, v248
  s_nop 0
  v_permlane16_swap_b32 v248, v249
  v_fma_mix_f32 v250, v248, 1.0, v249 op_sel:[0,0,0] op_sel_hi:[1,0,1]
  v_fma_mix_f32 v251, v248, 1.0, v249 op_sel:[1,0,1] op_sel_hi:[1,0,1]
  v_mov_b32 v248, v250
  v_mov_b32 v249, v251
  s_nop 0
  v_permlane32_swap_b32 v248, v250
  v_permlane32_swap_b32 v249, v251
  s_waitcnt vmcnt(0)
  v_bitop3_b32 v97, v112, v114, s88 bitop3:0x7e
  v_bitop3_b32 v98, v116, v118, s88 bitop3:0x7e
  v_fma_mix_f32 v120, v112, 1.0, v116 op_sel:[0,0,0] op_sel_hi:[1,0,1]
  v_or3_b32 v27, v96, v97, v98
  v_fma_mix_f32 v124, v114, 1.0, v118 op_sel:[0,0,0] op_sel_hi:[1,0,1]
  v_and_b32 v27, 1, v27
  v_fma_mix_f32 v121, v112, 1.0, v116 op_sel:[1,0,1] op_sel_hi:[1,0,1]
  v_cmp_ne_u32 vcc, 0, v27
  v_fma_mix_f32 v125, v114, 1.0, v118 op_sel:[1,0,1] op_sel_hi:[1,0,1]
  v_fma_mix_f32 v122, v113, 1.0, v117 op_sel:[0,0,0] op_sel_hi:[1,0,1]
  v_fma_mix_f32 v126, v115, 1.0, v119 op_sel:[0,0,0] op_sel_hi:[1,0,1]
  s_cbranch_vccnz psr_109
psj_110:
  s_cmp_lt_i32 s56, 0
  s_cbranch_scc1 kvw_111
kvok_112:
  buffer_load_dwordx4 v[160:163], v17, s[28:31], s64 offen offset:0 sc1
  v_fma_mix_f32 v123, v113, 1.0, v117 op_sel:[1,0,1] op_sel_hi:[1,0,1]
  buffer_load_dwordx4 v[164:167], v16, s[28:31], s64 offen offset:1024 sc1
  v_fma_mix_f32 v127, v115, 1.0, v119 op_sel:[1,0,1] op_sel_hi:[1,0,1]
  buffer_load_dwordx4 v[48:51], v26, s[28:31], s64 offen offset:2048 sc1
  v_permlane32_swap_b32 v120, v124
  v_permlane32_swap_b32 v121, v125
  v_permlane32_swap_b32 v122, v126
  s_lshr_b32 s21, 3, s20
  s_bitcmp1_b32 s21, 0
  s_cbranch_scc0 bw_114
  buffer_load_dwordx4 v[168:171], v18, s[16:19], s80 offen sc1
  s_branch bw_113
bw_114:
  s_lshr_b32 s21, 4, s20
  s_bitcmp1_b32 s21, 0
  s_cbranch_scc0 bw_115
  s_branch bw_113
bw_115:
  s_lshr_b32 s21, 8, s20
  s_bitcmp1_b32 s21, 0
  s_cbranch_scc0 bw_116
  s_branch bw_113
bw_116:
bw_113:
  v_permlane32_swap_b32 v123, v127
  v_pk_add_f32 v[120:121], v[120:121], v[124:125]
  v_pk_add_f32 v[122:123], v[122:123], v[126:127]
  s_lshr_b32 s21, 3, s20
  s_bitcmp1_b32 s21, 0
  s_cbranch_scc0 bw_118
  buffer_load_dwordx2 v[172:173], v20, s[16:19], s80 offen sc1
  s_branch bw_117
bw_118:
  s_lshr_b32 s21, 4, s20
  s_bitcmp1_b32 s21, 0
  s_cbranch_scc0 bw_119
  s_branch bw_117
bw_119:
  s_lshr_b32 s21, 8, s20
  s_bitcmp1_b32 s21, 0
  s_cbranch_scc0 bw_120
  s_branch bw_117
bw_120:
bw_117:
  v_pk_add_f32 v[124:125], v[248:249], v[250:251]
  v_max3_f32 v236, v120, v121, v122
  v_max3_f32 v237, v123, v124, v125
  s_lshr_b32 s21, 3, s20
  s_bitcmp1_b32 s21, 0
  s_cbranch_scc0 bw_122
  s_branch bw_121
bw_122:
  s_lshr_b32 s21, 4, s20
  s_bitcmp1_b32 s21, 0
  s_cbranch_scc0 bw_123
  s_branch bw_121
bw_123:
  s_lshr_b32 s21, 8, s20
  s_bitcmp1_b32 s21, 0
  s_cbranch_scc0 bw_124
  v_mov_b32 v240, s67
  v_mov_b32 v241, s67
  s_mov_b64 exec, s[68:69]
  buffer_store_dwordx2 v[240:241], v88, s[12:15], s66 offen sc1
  s_mov_b64 exec, -1
  s_branch bw_121
bw_124:
bw_121:
  v_max_f32 v236, v236, v237
  v_cvt_pk_bf16_f32 v228, v188, v189
  v_cvt_pk_bf16_f32 v229, v190, v191
  v_max_f32_dpp v236, v236, v236 row_ror:8 row_mask:0xf bank_mask:0xf
  v_mov_b32 v237, v236
  v_cvt_pk_bf16_f32 v230, v192, v193
  v_cvt_pk_bf16_f32 v231, v194, v195
  v_permlane32_swap_b32 v236, v237
  v_max_f32 v236, v236, v237
  v_mov_b32 v237, v236
  v_cvt_pk_bf16_f32 v232, v196, v197
  v_cvt_pk_bf16_f32 v233, v198, v199
  v_permlane16_swap_b32 v236, v237
  v_max_f32 v236, v236, v237
  v_mul_f32 v236, s86, v236
  v_fma_f32 v120, v120, s86, -v236
  v_fma_f32 v121, v121, s86, -v236
  v_fma_f32 v122, v122, s86, -v236
  v_fma_f32 v123, v123, s86, -v236
  v_fma_f32 v124, v124, s86, -v236
  v_fma_f32 v125, v125, s86, -v236
  v_exp_f32 v120, v120
  v_exp_f32 v121, v121
  v_exp_f32 v122, v122
  v_exp_f32 v123, v123
  v_exp_f32 v124, v124
  v_exp_f32 v125, v125
  s_mov_b64 exec, s[60:61]
  v_cvt_pk_bf16_f32 v220, v120, v121
  v_cvt_pk_bf16_f32 v221, v122, v123
  v_cvt_pk_bf16_f32 v224, v124, v125
  s_mov_b64 exec, s[62:63]
  v_cvt_pk_bf16_f32 v222, v120, v121
  v_cvt_pk_bf16_f32 v223, v122, v123
  v_cvt_pk_bf16_f32 v225, v124, v125
  s_mov_b64 exec, -1
  v_pk_add_f32 v[126:127], v[120:121], v[122:123]
  v_add_f32 v128, v124, v125
  v_mfma_f32_16x16x32_bf16 v[200:203], v[176:179], v[220:223], 0
  v_add_f32 v236, v126, v127
  v_fmac_f32 v236, v128, v89
  v_mfma_f32_16x16x32_bf16 v[204:207], v[180:183], v[220:223], 0
  v_mfma_f32_16x16x32_bf16 v[208:211], v[184:187], v[220:223], 0
  v_add_f32_dpp v236, v236, v236 row_ror:8 row_mask:0xf bank_mask:0xf
  v_mov_b32 v237, v236
  s_nop 0
  v_mfma_f32_16x16x32_bf16 v[200:203], v[228:231], v[224:227], v[200:203]
  v_mfma_f32_16x16x32_bf16 v[204:207], v[230:233], v[224:227], v[204:207]
  v_permlane32_swap_b32 v236, v237
  v_add_f32 v236, v236, v237
  v_mov_b32 v237, v236
  v_mfma_f32_16x16x32_bf16 v[208:211], v[232:235], v[224:227], v[208:211]
  s_nop 0
  v_permlane16_swap_b32 v236, v237
  v_add_f32 v236, v236, v237
  v_rcp_f32 v236, v236
  s_nop 2
  v_pk_mul_f32 v[200:201], v[200:201], v[236:237] op_sel_hi:[1,0]
  v_pk_mul_f32 v[202:203], v[202:203], v[236:237] op_sel_hi:[1,0]
  ds_write_b128 v11, v[200:203] offset:0
  v_pk_mul_f32 v[204:205], v[204:205], v[236:237] op_sel_hi:[1,0]
  v_pk_mul_f32 v[206:207], v[206:207], v[236:237] op_sel_hi:[1,0]
  ds_write_b128 v11, v[204:207] offset:1024
  v_pk_mul_f32 v[208:209], v[208:209], v[236:237] op_sel_hi:[1,0]
  v_pk_mul_f32 v[210:211], v[210:211], v[236:237] op_sel_hi:[1,0]
  ds_write_b128 v11, v[208:211] offset:2048
  s_waitcnt lgkmcnt(0)
  s_barrier
  s_lshr_b32 s21, 7, s20
  s_bitcmp1_b32 s21, 0
  s_cbranch_scc0 bw_126
  ds_read_b64 v[96:97], v12 offset:0
  ds_read_b64 v[98:99], v12 offset:128
  ds_read_b64 v[100:101], v12 offset:3072
  ds_read_b64 v[102:103], v12 offset:3200
  ds_read_b64 v[104:105], v12 offset:6144
  ds_read_b64 v[106:107], v12 offset:6272
  ds_read_b64 v[108:109], v12 offset:9216
  ds_read_b64 v[110:111], v12 offset:9344
  s_waitcnt lgkmcnt(6)
  v_pk_add_f32 v[96:97], v[96:97], v[98:99]
  s_waitcnt lgkmcnt(4)
  v_pk_add_f32 v[100:101], v[100:101], v[102:103]
  s_waitcnt lgkmcnt(2)
  v_pk_add_f32 v[104:105], v[104:105], v[106:107]
  v_pk_add_f32 v[96:97], v[96:97], v[100:101]
  s_waitcnt lgkmcnt(0)
  v_pk_add_f32 v[108:109], v[108:109], v[110:111]
  v_pk_add_f32 v[96:97], v[96:97], v[104:105]
  v_pk_add_f32 v[96:97], v[96:97], v[108:109]
  v_cvt_pk_f16_f32 v100, v96, v97
  v_perm_b32 v100, s91, v100, v14
  buffer_atomic_pk_add_f16 v100, v13, s[4:7], s3 offen
  s_branch bw_125
bw_126:
  s_lshr_b32 s21, 8, s20
  s_bitcmp1_b32 s21, 0
  s_cbranch_scc0 bw_127
  v_mov_b32 v28, -1
  v_mov_b32 v29, -1
  s_cmp_eq_u32 s53, 1
  s_cbranch_scc1 si_128
  buffer_store_dwordx2 v[28:29], v24, s[8:11], s82 offen sc1
  s_branch si_129
si_128:
  buffer_store_dwordx2 v[28:29], v24, s[8:11], s82 offen
si_129:
  s_mov_b64 exec, s[60:61]
  s_add_u32 s22, s82, 278528
  s_cmp_eq_u32 s53, 1
  s_cbranch_scc1 si_130
  buffer_store_dwordx2 v[28:29], v23, s[8:11], s22 offen sc1
  s_branch si_131
si_130:
  buffer_store_dwordx2 v[28:29], v23, s[8:11], s22 offen
si_131:
  s_and_b32 s21, s52, 7
  s_cmp_lg_u32 s21, s50
  s_cbranch_scc1 zm_132
  s_mov_b64 exec, s[70:71]
  buffer_store_dwordx4 v[156:159], v13, s[4:7], s83 offen sc1
zm_132:
  s_mov_b64 exec, -1
  s_branch bw_125
bw_127:
bw_125:
  s_lshr_b32 s21, 4, s20
  s_bitcmp1_b32 s21, 0
  s_cbranch_scc0 bw_134
  s_mov_b64 exec, s[62:63]
  buffer_store_dwordx4 v[212:215], v21, s[24:27], s85 offen sc1
  buffer_store_dwordx2 v[216:217], v23, s[24:27], s85 offen sc1
  s_mov_b64 exec, -1
  s_branch bw_133
bw_134:
bw_133:
  v_mov_b32 v200, v196
  v_mov_b32 v201, v197
  v_mov_b32 v202, v198
  v_mov_b32 v203, v199
  v_permlane32_swap_b32 v188, v192
  v_permlane32_swap_b32 v189, v193
  v_permlane32_swap_b32 v190, v194
  v_permlane32_swap_b32 v191, v195
  v_permlane32_swap_b32 v196, v200
  v_permlane32_swap_b32 v197, v201
  v_permlane32_swap_b32 v198, v202
  v_permlane32_swap_b32 v199, v203
  v_pk_add_f32 v[188:189], v[188:189], v[192:193]
  v_pk_add_f32 v[190:191], v[190:191], v[194:195]
  v_pk_add_f32 v[196:197], v[196:197], v[200:201]
  v_pk_add_f32 v[198:199], v[198:199], v[202:203]
  v_cvt_pk_bf16_f32 v252, v188, v189
  v_cvt_pk_bf16_f32 v254, v196, v197
  v_cvt_pk_bf16_f32 v253, v190, v191
  v_cvt_pk_bf16_f32 v255, v198, v199
  s_nop 0
  v_permlane16_swap_b32 v252, v254
  v_permlane16_swap_b32 v253, v255
  v_min_u32 v252, -2, v252
  s_mov_b64 exec, s[76:77]
  buffer_store_dwordx4 v[252:255], v15, s[24:27], s57 offen sc1
  s_mov_b64 exec, -1
  s_add_u32 s64, s64, 1310720
  s_add_u32 s52, s52, 1
  s_and_b32 s21, s52, 3
  s_mul_i32 s81, s21, 540672
  s_lshl_b32 s84, s21, 15
  s_branch step_90
fl_94:
  buffer_load_dword v94, v95, s[12:15], s79 offen sc1
  s_branch fl_95
pm_92:
  s_cmp_gt_u32 s52, 3
  s_cbranch_scc1 op_135
  v_readfirstlane_b32 s21, v94
  s_cmp_ge_u32 s21, s46
  s_cbranch_scc1 op_135
  buffer_load_dword v94, v95, s[12:15], s79 offen sc1
  s_waitcnt vmcnt(0)
  v_readfirstlane_b32 s21, v94
  s_add_u32 s22, s46, 2
  s_min_u32 s22, s22, 64
  s_sub_u32 s55, s21, s22
  s_sub_u32 s56, s21, s46
  s_cmp_gt_u32 s21, s52
  s_cselect_b32 s21, s87, 0
  s_cmp_eq_u32 s21, 0
  s_cbranch_scc1 op_135
  s_mov_b32 s87, 0
  s_sub_u32 s21, s64, 1310720
  buffer_load_dwordx4 v[176:179], v16, s[28:31], s21 offen offset:0 sc1
  buffer_load_dwordx4 v[180:183], v16, s[28:31], s21 offen offset:1024 sc1
  buffer_load_dwordx4 v[184:187], v16, s[28:31], s21 offen offset:2048 sc1
op_135:
  buffer_load_dwordx4 v[32:35], v4, s[4:7], s84 offen offset:0 sc1
  buffer_load_dwordx4 v[36:39], v4, s[4:7], s84 offen offset:1024 sc1
  buffer_load_dwordx4 v[40:43], v4, s[4:7], s84 offen offset:2048 sc1
  s_add_u32 s54, s54, 1
  s_cmp_gt_u32 s54, 131072
  s_cbranch_scc1 end0
  s_waitcnt vmcnt(0)
  v_bitop3_b32 v27, v35, v39, v43 bitop3:0x80
  v_perm_b32 v35, v39, v35, s89
  v_cmp_gt_u32 vcc, 0x48000000, v27
  v_mov_b32 v39, v42
  s_cbranch_vccnz pm_92
  s_branch A1_19
psr_109:
  s_cmp_gt_u32 s52, 3
  s_cbranch_scc1 op_136
  v_readfirstlane_b32 s21, v94
  s_cmp_ge_u32 s21, s46
  s_cbranch_scc1 op_136
  buffer_load_dword v94, v95, s[12:15], s79 offen sc1
  s_waitcnt vmcnt(0)
  v_readfirstlane_b32 s21, v94
  s_add_u32 s22, s46, 2
  s_min_u32 s22, s22, 64
  s_sub_u32 s55, s21, s22
  s_sub_u32 s56, s21, s46
  s_cmp_gt_u32 s21, s52
  s_cselect_b32 s21, s87, 0
  s_cmp_eq_u32 s21, 0
  s_cbranch_scc1 op_136
  s_mov_b32 s87, 0
  s_sub_u32 s21, s64, 1310720
  buffer_load_dwordx4 v[176:179], v16, s[28:31], s21 offen offset:0 sc1
  buffer_load_dwordx4 v[180:183], v16, s[28:31], s21 offen offset:1024 sc1
  buffer_load_dwordx4 v[184:187], v16, s[28:31], s21 offen offset:2048 sc1
op_136:
  buffer_load_dwordx2 v[248:249], v9, s[8:11], s81 offen sc1
  buffer_load_dwordx4 v[112:115], v8, s[8:11], s81 offen offset:0 sc1
  buffer_load_dwordx4 v[116:119], v8, s[8:11], s81 offen offset:1024 sc1
  s_add_u32 s54, s54, 1
  s_cmp_gt_u32 s54, 131072
  s_cbranch_scc1 end0
  s_waitcnt vmcnt(2)
  v_xor_b32 v96, s88, v248
  s_nop 0
  v_permlane16_swap_b32 v248, v249
  v_fma_mix_f32 v250, v248, 1.0, v249 op_sel:[0,0,0] op_sel_hi:[1,0,1]
  v_fma_mix_f32 v251, v248, 1.0, v249 op_sel:[1,0,1] op_sel_hi:[1,0,1]
  v_mov_b32 v248, v250
  v_mov_b32 v249, v251
  s_nop 0
  v_permlane32_swap_b32 v248, v250
  v_permlane32_swap_b32 v249, v251
  s_waitcnt vmcnt(0)
  v_bitop3_b32 v97, v112, v114, s88 bitop3:0x7e
  v_bitop3_b32 v98, v116, v118, s88 bitop3:0x7e
  v_fma_mix_f32 v120, v112, 1.0, v116 op_sel:[0,0,0] op_sel_hi:[1,0,1]
  v_or3_b32 v27, v96, v97, v98
  v_fma_mix_f32 v124, v114, 1.0, v118 op_sel:[0,0,0] op_sel_hi:[1,0,1]
  v_and_b32 v27, 1, v27
  v_fma_mix_f32 v121, v112, 1.0, v116 op_sel:[1,0,1] op_sel_hi:[1,0,1]
  v_cmp_ne_u32 vcc, 0, v27
  v_fma_mix_f32 v125, v114, 1.0, v118 op_sel:[1,0,1] op_sel_hi:[1,0,1]
  v_fma_mix_f32 v122, v113, 1.0, v117 op_sel:[0,0,0] op_sel_hi:[1,0,1]
  v_fma_mix_f32 v126, v115, 1.0, v119 op_sel:[0,0,0] op_sel_hi:[1,0,1]
  s_cbranch_vccnz psr_109
  s_branch psj_110
kvw_111:
  s_mov_b32 s22, s87
  s_cmp_eq_u32 s52, 0
  s_cselect_b32 s23, s87, s46
  s_cselect_b32 s55, 0, s55
  s_cselect_b32 s87, 1, 0
  s_cmp_eq_u32 s23, 0
  s_cbranch_scc1 kvok_112
  v_mov_b32 v236, 0
  s_mov_b32 s101, 0
wf_137:
  buffer_load_dword v237, v236, s[12:15], s79 offen sc1
  s_add_u32 s101, s101, 1
  s_cmp_gt_u32 s101, 131072
  s_cbranch_scc1 end0
  s_waitcnt vmcnt(0)
  v_readfirstlane_b32 s100, v237
  s_cmp_ge_u32 s100, s23
  s_cbranch_scc1 wf_138
  s_sleep 3
  s_branch wf_137
wf_138:
  s_cmp_eq_u32 s22, 0
  s_cbranch_scc1 kvok_112
  s_sub_u32 s21, s64, 1310720
  buffer_load_dwordx4 v[176:179], v16, s[28:31], s21 offen offset:0 sc1
  buffer_load_dwordx4 v[180:183], v16, s[28:31], s21 offen offset:1024 sc1
  buffer_load_dwordx4 v[184:187], v16, s[28:31], s21 offen offset:2048 sc1
  s_waitcnt vmcnt(0)
  s_branch kvok_112
last_91:
  s_lshr_b32 s21, 4, s20
  s_bitcmp1_b32 s21, 0
  s_cbranch_scc0 bw_140
  s_mov_b64 exec, s[62:63]
  buffer_store_dwordx4 v[212:215], v21, s[24:27], s85 offen sc1
  buffer_store_dwordx2 v[216:217], v23, s[24:27], s85 offen sc1
  s_mov_b64 exec, -1
  s_branch bw_139
bw_140:
bw_139:
  v_mov_b32 v188, 0
  v_mov_b32 v189, 0
  v_mov_b32 v190, 0
  v_mov_b32 v191, 0
  v_mov_b32 v192, 0
  v_mov_b32 v193, 0
  v_mov_b32 v194, 0
  v_mov_b32 v195, 0
  v_mov_b32 v196, 0
  v_mov_b32 v197, 0
  v_mov_b32 v198, 0
  v_mov_b32 v199, 0
  s_sleep 4
  s_mov_b32 s54, 0
lv_141:
  buffer_load_dwordx4 v[144:147], v10, s[8:11], s81 offen offset:0 sc1
  buffer_load_dwordx4 v[148:151], v10, s[8:11], s81 offen offset:1024 sc1
  buffer_load_dwordx4 v[152:155], v10, s[8:11], s81 offen offset:2048 sc1
  s_add_u32 s54, s54, 1
  s_cmp_gt_u32 s54, 131072
  s_cbranch_scc1 end0
  s_waitcnt vmcnt(0)
  v_max3_u32 v27, v144, v146, v148
  v_max3_u32 v27, v27, v150, v152
  v_max3_u32 v27, v27, v154, v154
  v_cmp_eq_u32 vcc, -1, v27
  s_nop 1
  s_cbranch_vccnz lv_141
  v_smfmac_f32_16x16x64_bf16 v[188:191], v[144:147], a[180:187], v44
  v_smfmac_f32_16x16x64_bf16 v[192:195], v[144:147], a[204:211], v44
  v_smfmac_f32_16x16x64_bf16 v[196:199], v[144:147], a[228:235], v44
  v_smfmac_f32_16x16x64_bf16 v[188:191], v[148:151], a[188:195], v44
  v_smfmac_f32_16x16x64_bf16 v[192:195], v[148:151], a[212:219], v44
  v_smfmac_f32_16x16x64_bf16 v[196:199], v[148:151], a[236:243], v44
  v_smfmac_f32_16x16x64_bf16 v[188:191], v[152:155], a[196:203], v44
  v_smfmac_f32_16x16x64_bf16 v[192:195], v[152:155], a[220:227], v44
  v_smfmac_f32_16x16x64_bf16 v[196:199], v[152:155], a[244:251], v44
  s_lshr_b32 s21, 4, s20
  s_bitcmp1_b32 s21, 0
  s_cbranch_scc0 bw_143
  v_mov_b32 v236, 64
  s_mov_b64 exec, 1
  buffer_store_dword v236, v95, s[12:15], s90 offen sc1
  s_mov_b64 exec, -1
  s_branch bw_142
bw_143:
bw_142:
  s_nop 7
  v_mov_b32 v200, v196
  v_mov_b32 v201, v197
  v_mov_b32 v202, v198
  v_mov_b32 v203, v199
  v_permlane32_swap_b32 v188, v192
  v_permlane32_swap_b32 v189, v193
  v_permlane32_swap_b32 v190, v194
  v_permlane32_swap_b32 v191, v195
  v_permlane32_swap_b32 v196, v200
  v_permlane32_swap_b32 v197, v201
  v_permlane32_swap_b32 v198, v202
  v_permlane32_swap_b32 v199, v203
  v_pk_add_f32 v[188:189], v[188:189], v[192:193]
  v_pk_add_f32 v[190:191], v[190:191], v[194:195]
  v_pk_add_f32 v[196:197], v[196:197], v[200:201]
  v_pk_add_f32 v[198:199], v[198:199], v[202:203]
  v_cvt_pk_bf16_f32 v252, v188, v189
  v_cvt_pk_bf16_f32 v254, v196, v197
  v_cvt_pk_bf16_f32 v253, v190, v191
  v_cvt_pk_bf16_f32 v255, v198, v199
  s_nop 0
  v_permlane16_swap_b32 v252, v254
  v_permlane16_swap_b32 v253, v255
  v_min_u32 v252, -2, v252
  s_mov_b64 exec, s[76:77]
  buffer_store_dwordx4 v[252:255], v15, s[24:27], s57 offen sc1
  s_mov_b64 exec, -1
  s_lshr_b32 s21, 1, s20
  s_bitcmp1_b32 s21, 0
  s_cbranch_scc0 bw_145
  v_mov_b32 v246, 80
  v_mov_b32 v247, 1
  s_mov_b64 exec, 1
  buffer_atomic_add v247, v246, s[32:35], 0 offen sc0 sc1
  s_mov_b64 exec, -1
clm_146:
  s_branch bw_144
bw_145:
bw_144:
  s_branch chain_done
chain_done:
  s_waitcnt vmcnt(0) lgkmcnt(0)
  s_barrier
  s_mov_b32 s84, 0
  s_mov_b32 s85, -1
  s_mov_b32 s86, 0
  v_mov_b32 v21, 0
  v_mov_b32 v23, v247
  s_cmp_lg_u32 s20, 0
  s_cbranch_scc1 queue_b
  s_mov_b64 exec, 1
  s_branch queue_a
end0:
  s_endpgm
gemm_side:
  s_bfe_u32 s23, s22, 0x20005
  s_add_u32 s22, s22, 31
  s_and_b32 s22, s22, 31
  s_lshl_b32 s21, s23, 3
  s_add_u32 s2, s21, s22
  s_add_u32 s3, s2, 72
  s_add_u32 s24, s2, 48
  s_add_u32 s2, s2, s21
  s_cmp_lt_u32 s22, 24
  s_cselect_b32 s3, s24, s3
  s_cmp_lt_u32 s22, 16
  s_cselect_b32 s3, s2, s3
  s_mov_b32 s2, s3
  s_cmp_ge_u32 s3, 64
  s_cbranch_scc1 not_kv
  s_load_dwordx2 s[4:5], s[0:1], 0
  s_load_dwordx2 s[6:7], s[0:1], 24
  s_load_dwordx2 s[36:37], s[0:1], 32
  s_load_dwordx2 s[38:39], s[0:1], 104
  s_and_b32 s43, s3, 1
  s_bfe_u32 s42, s3, 0x50001
  s_lshr_b32 s40, s42, 2
  s_waitcnt lgkmcnt(0)
  s_cmp_eq_u32 s43, 1
  s_cselect_b32 s6, s36, s6
  s_cselect_b32 s7, s37, s7
  s_mov_b32 s8, s4
  s_mov_b32 s9, s5
  s_mov_b32 s10, 2621440
  s_mov_b32 s11, 0x00020000
  s_mov_b32 s12, s6
  s_mov_b32 s13, s7
  s_mov_b32 s14, 7864320
  s_mov_b32 s15, 0x00020000
  s_mov_b32 s16, s38
  s_mov_b32 s17, s39
  s_mov_b32 s18, 50331648
  s_mov_b32 s19, 0x00020000
  s_mul_i32 s44, s42, 384
  s_mov_b32 s62, 1024
  s_mov_b32 s24, 0
  s_mov_b32 s25, 81920
  s_mov_b32 s64, s32
  s_mov_b32 s65, s33
  s_mov_b32 s66, s34
  s_mov_b32 s67, s35
  s_load_dwordx2 s[72:73], s[0:1], 104
  s_waitcnt lgkmcnt(0)
  s_add_u32 s72, s72, 81068032
  s_addc_u32 s73, s73, 0
  s_mov_b32 s74, 116736
  s_mov_b32 s75, 0x00020000
  v_mov_b32 v9, 2731
  v_add_u32 v8, 0, v1
  v_mul_u32_u24 v7, v8, v9
  v_lshrrev_b32 v7, 16, v7
  v_mul_u32_u24 v4, 24, v7
  v_sub_u32 v8, v8, v4
  v_and_b32 v4, 2, v7
  v_xor_b32 v8, v8, v4
  v_xor_b32 v5, 4, v8
  s_mov_b32 s21, 12288
  v_mul_lo_u32 v7, v7, s21
  v_lshl_add_u32 v40, v8, 4, v7
  v_lshl_add_u32 v43, v5, 4, v7
  v_add_u32 v8, 64, v1
  v_mul_u32_u24 v7, v8, v9
  v_lshrrev_b32 v7, 16, v7
  v_mul_u32_u24 v4, 24, v7
  v_sub_u32 v8, v8, v4
  v_and_b32 v4, 2, v7
  v_xor_b32 v8, v8, v4
  v_xor_b32 v5, 4, v8
  s_mov_b32 s21, 12288
  v_mul_lo_u32 v7, v7, s21
  v_lshl_add_u32 v41, v8, 4, v7
  v_lshl_add_u32 v44, v5, 4, v7
  v_add_u32 v8, 128, v1
  v_mul_u32_u24 v7, v8, v9
  v_lshrrev_b32 v7, 16, v7
  v_mul_u32_u24 v4, 24, v7
  v_sub_u32 v8, v8, v4
  v_and_b32 v4, 2, v7
  v_xor_b32 v8, v8, v4
  v_xor_b32 v5, 4, v8
  s_mov_b32 s21, 12288
  v_mul_lo_u32 v7, v7, s21
  v_lshl_add_u32 v42, v8, 4, v7
  v_lshl_add_u32 v45, v5, 4, v7
  s_mul_i32 s21, s20, 393216
  s_add_u32 s21, s21, 0
  s_add_u32 s21, s21, s44
  s_mul_i32 s22, s20, 12288
  s_add_u32 s22, s22, 0
  s_add_u32 m0, s22, 0
  s_nop 0
  buffer_load_dwordx4 v40, s[12:15], s21 offen lds
  s_add_u32 m0, s22, 1024
  s_nop 0
  buffer_load_dwordx4 v41, s[12:15], s21 offen lds
  s_add_u32 m0, s22, 2048
  s_nop 0
  buffer_load_dwordx4 v42, s[12:15], s21 offen lds
  s_mul_i32 s21, s20, 393216
  s_add_u32 s21, s21, 98304
  s_add_u32 s21, s21, s44
  s_mul_i32 s22, s20, 12288
  s_add_u32 s22, s22, 3072
  s_add_u32 m0, s22, 0
  s_nop 0
  buffer_load_dwordx4 v43, s[12:15], s21 offen lds
  s_add_u32 m0, s22, 1024
  s_nop 0
  buffer_load_dwordx4 v44, s[12:15], s21 offen lds
  s_add_u32 m0, s22, 2048
  s_nop 0
  buffer_load_dwordx4 v45, s[12:15], s21 offen lds
  s_mul_i32 s21, s20, 393216
  s_add_u32 s21, s21, 196608
  s_add_u32 s21, s21, s44
  s_mul_i32 s22, s20, 12288
  s_add_u32 s22, s22, 6144
  s_add_u32 m0, s22, 0
  s_nop 0
  buffer_load_dwordx4 v40, s[12:15], s21 offen lds
  s_add_u32 m0, s22, 1024
  s_nop 0
  buffer_load_dwordx4 v41, s[12:15], s21 offen lds
  s_add_u32 m0, s22, 2048
  s_nop 0
  buffer_load_dwordx4 v42, s[12:15], s21 offen lds
  s_mul_i32 s21, s20, 393216
  s_add_u32 s21, s21, 294912
  s_add_u32 s21, s21, s44
  s_mul_i32 s22, s20, 12288
  s_add_u32 s22, s22, 9216
  s_add_u32 m0, s22, 0
  s_nop 0
  buffer_load_dwordx4 v43, s[12:15], s21 offen lds
  s_add_u32 m0, s22, 1024
  s_nop 0
  buffer_load_dwordx4 v44, s[12:15], s21 offen lds
  s_add_u32 m0, s22, 2048
  s_nop 0
  buffer_load_dwordx4 v45, s[12:15], s21 offen lds
  v_lshrrev_b32 v11, 3, v1
  v_and_b32 v12, 7, v1
  v_xor_b32 v12, v12, v11
  v_mul_u32_u24 v11, 1280, v11
  v_lshl_add_u32 v10, v12, 4, v11
  s_mul_i32 s46, s20, 20480
  v_add_u32 v10, s46, v10
  s_lshl_b32 s47, s20, 11
  s_add_u32 s47, s47, 98304
  s_add_u32 s46, s47, 57344
  s_mov_b32 s30, s24
  s_add_u32 s32, s47, 0
  v_add_u32 v11, 9216, v10
  s_mov_b32 m0, s32
  s_nop 0
  buffer_load_dwordx4 v10, s[8:11], s30 offen offset:0 lds
  buffer_load_dwordx4 v11, s[8:11], s30 offen offset:1024 lds
  s_add_u32 s30, s30, 128
  s_add_u32 s32, s32, 8192
  s_cmp_lt_u32 s32, s46
  s_cselect_b32 s32, s32, s47
  s_mov_b32 m0, s32
  s_nop 0
  buffer_load_dwordx4 v10, s[8:11], s30 offen offset:0 lds
  buffer_load_dwordx4 v11, s[8:11], s30 offen offset:1024 lds
  s_add_u32 s30, s30, 128
  s_add_u32 s32, s32, 8192
  s_cmp_lt_u32 s32, s46
  s_cselect_b32 s32, s32, s47
  s_mov_b32 m0, s32
  s_nop 0
  buffer_load_dwordx4 v10, s[8:11], s30 offen offset:0 lds
  buffer_load_dwordx4 v11, s[8:11], s30 offen offset:1024 lds
  s_add_u32 s30, s30, 128
  s_add_u32 s32, s32, 8192
  s_cmp_lt_u32 s32, s46
  s_cselect_b32 s32, s32, s47
  s_mov_b32 m0, s32
  s_nop 0
  buffer_load_dwordx4 v10, s[8:11], s30 offen offset:0 lds
  buffer_load_dwordx4 v11, s[8:11], s30 offen offset:1024 lds
  s_add_u32 s30, s30, 128
  s_add_u32 s32, s32, 8192
  s_cmp_lt_u32 s32, s46
  s_cselect_b32 s32, s32, s47
  s_mov_b32 m0, s32
  s_nop 0
  buffer_load_dwordx4 v10, s[8:11], s30 offen offset:0 lds
  buffer_load_dwordx4 v11, s[8:11], s30 offen offset:1024 lds
  s_add_u32 s30, s30, 128
  s_add_u32 s32, s32, 8192
  s_cmp_lt_u32 s32, s46
  s_cselect_b32 s32, s32, s47
  s_mul_i32 s21, s20, 393216
  s_add_u32 s21, s21, 1572864
  s_add_u32 s21, s21, s44
  s_mul_i32 s22, s20, 12288
  s_add_u32 s22, s22, 49152
  s_add_u32 m0, s22, 0
  s_nop 0
  buffer_load_dwordx4 v40, s[12:15], s21 offen lds
  s_add_u32 m0, s22, 1024
  s_nop 0
  buffer_load_dwordx4 v41, s[12:15], s21 offen lds
  s_add_u32 m0, s22, 2048
  s_nop 0
  buffer_load_dwordx4 v42, s[12:15], s21 offen lds
  s_mul_i32 s21, s20, 393216
  s_add_u32 s21, s21, 1671168
  s_add_u32 s21, s21, s44
  s_mul_i32 s22, s20, 12288
  s_add_u32 s22, s22, 52224
  s_add_u32 m0, s22, 0
  s_nop 0
  buffer_load_dwordx4 v43, s[12:15], s21 offen lds
  s_add_u32 m0, s22, 1024
  s_nop 0
  buffer_load_dwordx4 v44, s[12:15], s21 offen lds
  s_add_u32 m0, s22, 2048
  s_nop 0
  buffer_load_dwordx4 v45, s[12:15], s21 offen lds
  s_mul_i32 s21, s20, 393216
  s_add_u32 s21, s21, 1769472
  s_add_u32 s21, s21, s44
  s_mul_i32 s22, s20, 12288
  s_add_u32 s22, s22, 55296
  s_add_u32 m0, s22, 0
  s_nop 0
  buffer_load_dwordx4 v40, s[12:15], s21 offen lds
  s_add_u32 m0, s22, 1024
  s_nop 0
  buffer_load_dwordx4 v41, s[12:15], s21 offen lds
  s_add_u32 m0, s22, 2048
  s_nop 0
  buffer_load_dwordx4 v42, s[12:15], s21 offen lds
  s_mul_i32 s21, s20, 393216
  s_add_u32 s21, s21, 1867776
  s_add_u32 s21, s21, s44
  s_mul_i32 s22, s20, 12288
  s_add_u32 s22, s22, 58368
  s_add_u32 m0, s22, 0
  s_nop 0
  buffer_load_dwordx4 v43, s[12:15], s21 offen lds
  s_add_u32 m0, s22, 1024
  s_nop 0
  buffer_load_dwordx4 v44, s[12:15], s21 offen lds
  s_add_u32 m0, s22, 2048
  s_nop 0
  buffer_load_dwordx4 v45, s[12:15], s21 offen lds
  v_lshrrev_b32 v7, 2, v2
  v_and_b32 v4, 2, v7
  v_and_b32 v5, 1, v3
  v_lshl_or_b32 v4, v5, 2, v4
  v_lshl_add_u32 v7, v3, 3, v7
  v_mul_u32_u24 v7, 384, v7
  v_and_b32 v5, 1, v2
  v_lshl_add_u32 v7, v5, 3, v7
  v_bfe_u32 v8, v2, 1, 1
  s_mul_i32 s21, s20, 6
  v_add_u32 v8, s21, v8
  v_add_u32 v5, 0, v8
  v_xor_b32 v5, v5, v4
  v_lshl_add_u32 v46, v5, 4, v7
  v_add_u32 v49, 49152, v46
  v_add_u32 v5, 2, v8
  v_xor_b32 v5, v5, v4
  v_lshl_add_u32 v47, v5, 4, v7
  v_add_u32 v50, 49152, v47
  v_add_u32 v5, 4, v8
  v_xor_b32 v5, v5, v4
  v_lshl_add_u32 v48, v5, 4, v7
  v_add_u32 v51, 49152, v48
  s_mov_b32 s26, 6
  s_mul_i32 s27, s42, 12288
  s_mul_i32 s21, s43, 25165824
  s_add_u32 s27, s27, s21
  s_mov_b32 s28, 786432
  s_lshl_b32 s60, s40, 7
  s_add_u32 s60, s60, 0
  s_mov_b32 s61, 0
  v_and_b32 v6, 7, v2
  v_add_u32 v4, 0, v3
  v_xor_b32 v4, v4, v6
  v_lshlrev_b32 v4, 4, v4
  v_lshl_add_u32 v14, v2, 7, v4
  v_add_u32 v4, 4, v3
  v_xor_b32 v4, v4, v6
  v_lshlrev_b32 v4, 4, v4
  v_lshl_add_u32 v15, v2, 7, v4
  v_mul_u32_u24 v22, 400, v2
  v_mul_u32_u24 v4, 16, v3
  s_mul_i32 s21, s20, 96
  s_add_u32 s21, s21, 0
  v_add3_u32 v22, v22, v4, s21
  v_lshlrev_b32 v4, 3, v3
  v_sub_u32 v16, v22, v4
  v_mov_b32 v9, 2731
  s_mul_i32 s21, s20, 6400
  s_add_u32 s21, s21, 0
  v_mul_u32_u24 v4, 400, v2
  v_lshlrev_b32 v5, 4, v3
  v_add3_u32 v23, v4, v5, s21
  v_lshlrev_b32 v26, 4, v1
  s_mov_b32 s33, 98304
  s_mov_b32 s48, 0x80000000
  s_mov_b32 m0, s32
  s_nop 0
  buffer_load_dwordx4 v10, s[8:11], s30 offen offset:0 lds
  s_waitcnt vmcnt(21)
  s_barrier
  v_add_u32 v18, s33, v14
  v_add_u32 v19, s33, v15
  s_add_u32 s33, s33, 8192
  s_cmp_lt_u32 s33, 155648
  s_cselect_b32 s33, s33, 98304
  ds_read_b128 v[160:163], v18 offset:0
  ds_read_b128 v[164:167], v18 offset:2048
  ds_read_b128 v[168:171], v18 offset:4096
  ds_read_b128 v[172:175], v18 offset:6144
  s_waitcnt lgkmcnt(0)
  s_waitcnt vmcnt(23)
  s_barrier
  ds_read_b64_tr_b16 a[0:1], v46 offset:0
  ds_read_b64_tr_b16 a[2:3], v46 offset:1536
  ds_read_b64_tr_b16 a[4:5], v47 offset:0
  ds_read_b64_tr_b16 a[6:7], v47 offset:1536
  ds_read_b64_tr_b16 a[8:9], v48 offset:0
  ds_read_b64_tr_b16 a[10:11], v48 offset:1536
  ds_read_b64_tr_b16 a[12:13], v46 offset:12288
  ds_read_b64_tr_b16 a[14:15], v46 offset:13824
  ds_read_b64_tr_b16 a[16:17], v47 offset:12288
  ds_read_b64_tr_b16 a[18:19], v47 offset:13824
  ds_read_b64_tr_b16 a[20:21], v48 offset:12288
  ds_read_b64_tr_b16 a[22:23], v48 offset:13824
  ds_read_b64_tr_b16 a[24:25], v46 offset:24576
  ds_read_b64_tr_b16 a[26:27], v46 offset:26112
  ds_read_b64_tr_b16 a[28:29], v47 offset:24576
  ds_read_b64_tr_b16 a[30:31], v47 offset:26112
  ds_read_b64_tr_b16 a[32:33], v48 offset:24576
  ds_read_b64_tr_b16 a[34:35], v48 offset:26112
  ds_read_b64_tr_b16 a[36:37], v46 offset:36864
  ds_read_b64_tr_b16 a[38:39], v46 offset:38400
  ds_read_b64_tr_b16 a[40:41], v47 offset:36864
  ds_read_b64_tr_b16 a[42:43], v47 offset:38400
  ds_read_b64_tr_b16 a[44:45], v48 offset:36864
  ds_read_b64_tr_b16 a[46:47], v48 offset:38400
  s_waitcnt lgkmcnt(0)
  s_barrier
  s_mov_b32 s23, m0
  s_mul_i32 s21, s20, 393216
  s_add_u32 s21, s21, 3145728
  s_add_u32 s21, s21, s44
  s_mul_i32 s22, s20, 12288
  s_add_u32 s22, s22, 0
  s_add_u32 m0, s22, 0
  s_nop 0
  buffer_load_dwordx4 v40, s[12:15], s21 offen lds
  s_add_u32 m0, s22, 1024
  s_nop 0
  buffer_load_dwordx4 v41, s[12:15], s21 offen lds
  s_add_u32 m0, s22, 2048
  s_nop 0
  buffer_load_dwordx4 v42, s[12:15], s21 offen lds
  s_mul_i32 s21, s20, 393216
  s_add_u32 s21, s21, 3244032
  s_add_u32 s21, s21, s44
  s_mul_i32 s22, s20, 12288
  s_add_u32 s22, s22, 3072
  s_add_u32 m0, s22, 0
  s_nop 0
  buffer_load_dwordx4 v43, s[12:15], s21 offen lds
  s_add_u32 m0, s22, 1024
  s_nop 0
  buffer_load_dwordx4 v44, s[12:15], s21 offen lds
  s_add_u32 m0, s22, 2048
  s_nop 0
  buffer_load_dwordx4 v45, s[12:15], s21 offen lds
  s_mul_i32 s21, s20, 393216
  s_add_u32 s21, s21, 3342336
  s_add_u32 s21, s21, s44
  s_mul_i32 s22, s20, 12288
  s_add_u32 s22, s22, 6144
  s_add_u32 m0, s22, 0
  s_nop 0
  buffer_load_dwordx4 v40, s[12:15], s21 offen lds
  s_add_u32 m0, s22, 1024
  s_nop 0
  buffer_load_dwordx4 v41, s[12:15], s21 offen lds
  s_add_u32 m0, s22, 2048
  s_nop 0
  buffer_load_dwordx4 v42, s[12:15], s21 offen lds
  s_mul_i32 s21, s20, 393216
  s_add_u32 s21, s21, 3440640
  s_add_u32 s21, s21, s44
  s_mul_i32 s22, s20, 12288
  s_add_u32 s22, s22, 9216
  s_add_u32 m0, s22, 0
  s_nop 0
  buffer_load_dwordx4 v43, s[12:15], s21 offen lds
  s_add_u32 m0, s22, 1024
  s_nop 0
  buffer_load_dwordx4 v44, s[12:15], s21 offen lds
  s_add_u32 m0, s22, 2048
  s_nop 0
  buffer_load_dwordx4 v45, s[12:15], s21 offen lds
  s_mov_b32 m0, s23
  v_mfma_f32_16x16x32_bf16 v[64:67], a[0:3], v[160:163], 0
  ds_read_b128 v[192:195], v19 offset:0
  v_mfma_f32_16x16x32_bf16 v[68:71], a[4:7], v[160:163], 0
  v_add_u32 v18, s33, v14
  v_mfma_f32_16x16x32_bf16 v[72:75], a[8:11], v[160:163], 0
  v_mfma_f32_16x16x32_bf16 v[76:79], a[0:3], v[164:167], 0
  ds_read_b128 v[196:199], v19 offset:2048
  v_mfma_f32_16x16x32_bf16 v[80:83], a[4:7], v[164:167], 0
  buffer_load_dwordx4 v11, s[8:11], s30 offen offset:1024 lds
  v_mfma_f32_16x16x32_bf16 v[84:87], a[8:11], v[164:167], 0
  s_add_u32 s30, s30, 128
  v_mfma_f32_16x16x32_bf16 v[88:91], a[0:3], v[168:171], 0
  ds_read_b128 v[200:203], v19 offset:4096
  s_add_u32 m0, m0, 8192
  v_mfma_f32_16x16x32_bf16 v[92:95], a[4:7], v[168:171], 0
  s_cmp_lt_u32 m0, s46
  s_cselect_b32 m0, m0, s47
  v_mfma_f32_16x16x32_bf16 v[96:99], a[8:11], v[168:171], 0
  v_mfma_f32_16x16x32_bf16 v[100:103], a[0:3], v[172:175], 0
  ds_read_b128 v[204:207], v19 offset:6144
  v_mfma_f32_16x16x32_bf16 v[104:107], a[4:7], v[172:175], 0
  v_mfma_f32_16x16x32_bf16 v[108:111], a[8:11], v[172:175], 0
  s_waitcnt vmcnt(32) lgkmcnt(2)
  s_barrier
  v_mfma_f32_16x16x32_bf16 v[64:67], a[12:15], v[192:195], v[64:67]
  ds_read_b128 v[160:163], v18 offset:0
  v_mfma_f32_16x16x32_bf16 v[68:71], a[16:19], v[192:195], v[68:71]
  v_mfma_f32_16x16x32_bf16 v[72:75], a[20:23], v[192:195], v[72:75]
  v_add_u32 v19, s33, v15
  s_add_u32 s33, s33, 8192
  v_mfma_f32_16x16x32_bf16 v[76:79], a[12:15], v[196:199], v[76:79]
  ds_read_b128 v[164:167], v18 offset:2048
  v_mfma_f32_16x16x32_bf16 v[80:83], a[16:19], v[196:199], v[80:83]
  buffer_load_dwordx4 v10, s[8:11], s30 offen offset:0 lds
  v_mfma_f32_16x16x32_bf16 v[84:87], a[20:23], v[196:199], v[84:87]
  s_waitcnt lgkmcnt(2)
  v_mfma_f32_16x16x32_bf16 v[88:91], a[12:15], v[200:203], v[88:91]
  ds_read_b128 v[168:171], v18 offset:4096
  v_mfma_f32_16x16x32_bf16 v[92:95], a[16:19], v[200:203], v[92:95]
  s_cmp_lt_u32 s33, 155648
  s_cselect_b32 s33, s33, 98304
  v_mfma_f32_16x16x32_bf16 v[96:99], a[20:23], v[200:203], v[96:99]
  v_mfma_f32_16x16x32_bf16 v[100:103], a[12:15], v[204:207], v[100:103]
  ds_read_b128 v[172:175], v18 offset:6144
  v_mfma_f32_16x16x32_bf16 v[104:107], a[16:19], v[204:207], v[104:107]
  v_mfma_f32_16x16x32_bf16 v[108:111], a[20:23], v[204:207], v[108:111]
  s_waitcnt lgkmcnt(2)
  v_mfma_f32_16x16x32_bf16 v[64:67], a[24:27], v[160:163], v[64:67]
  ds_read_b128 v[192:195], v19 offset:0
  v_mfma_f32_16x16x32_bf16 v[68:71], a[28:31], v[160:163], v[68:71]
  v_add_u32 v18, s33, v14
  v_mfma_f32_16x16x32_bf16 v[72:75], a[32:35], v[160:163], v[72:75]
  v_mfma_f32_16x16x32_bf16 v[76:79], a[24:27], v[164:167], v[76:79]
  ds_read_b128 v[196:199], v19 offset:2048
  v_mfma_f32_16x16x32_bf16 v[80:83], a[28:31], v[164:167], v[80:83]
  buffer_load_dwordx4 v11, s[8:11], s30 offen offset:1024 lds
  v_mfma_f32_16x16x32_bf16 v[84:87], a[32:35], v[164:167], v[84:87]
  s_waitcnt lgkmcnt(2)
  s_add_u32 s30, s30, 128
  v_mfma_f32_16x16x32_bf16 v[88:91], a[24:27], v[168:171], v[88:91]
  ds_read_b128 v[200:203], v19 offset:4096
  s_add_u32 m0, m0, 8192
  v_mfma_f32_16x16x32_bf16 v[92:95], a[28:31], v[168:171], v[92:95]
  s_cmp_lt_u32 m0, s46
  s_cselect_b32 m0, m0, s47
  v_mfma_f32_16x16x32_bf16 v[96:99], a[32:35], v[168:171], v[96:99]
  v_mfma_f32_16x16x32_bf16 v[100:103], a[24:27], v[172:175], v[100:103]
  ds_read_b128 v[204:207], v19 offset:6144
  v_mfma_f32_16x16x32_bf16 v[104:107], a[28:31], v[172:175], v[104:107]
  v_mfma_f32_16x16x32_bf16 v[108:111], a[32:35], v[172:175], v[108:111]
  s_waitcnt vmcnt(32) lgkmcnt(2)
  s_barrier
  v_mfma_f32_16x16x32_bf16 v[64:67], a[36:39], v[192:195], v[64:67]
  ds_read_b128 v[160:163], v18 offset:0
  v_mfma_f32_16x16x32_bf16 v[68:71], a[40:43], v[192:195], v[68:71]
  v_mfma_f32_16x16x32_bf16 v[72:75], a[44:47], v[192:195], v[72:75]
  v_add_u32 v19, s33, v15
  s_add_u32 s33, s33, 8192
  v_mfma_f32_16x16x32_bf16 v[76:79], a[36:39], v[196:199], v[76:79]
  ds_read_b128 v[164:167], v18 offset:2048
  v_mfma_f32_16x16x32_bf16 v[80:83], a[40:43], v[196:199], v[80:83]
  buffer_load_dwordx4 v10, s[8:11], s30 offen offset:0 lds
  v_mfma_f32_16x16x32_bf16 v[84:87], a[44:47], v[196:199], v[84:87]
  s_waitcnt lgkmcnt(2)
  v_mfma_f32_16x16x32_bf16 v[88:91], a[36:39], v[200:203], v[88:91]
  ds_read_b128 v[168:171], v18 offset:4096
  v_mfma_f32_16x16x32_bf16 v[92:95], a[40:43], v[200:203], v[92:95]
  s_cmp_lt_u32 s33, 155648
  s_cselect_b32 s33, s33, 98304
  v_mfma_f32_16x16x32_bf16 v[96:99], a[44:47], v[200:203], v[96:99]
  v_mfma_f32_16x16x32_bf16 v[100:103], a[36:39], v[204:207], v[100:103]
  ds_read_b128 v[172:175], v18 offset:6144
  v_mfma_f32_16x16x32_bf16 v[104:107], a[40:43], v[204:207], v[104:107]
  v_mfma_f32_16x16x32_bf16 v[108:111], a[44:47], v[204:207], v[108:111]
  s_waitcnt lgkmcnt(2)
  s_waitcnt vmcnt(17)
  s_barrier
  ds_read_b64_tr_b16 a[48:49], v49 offset:0
  ds_read_b64_tr_b16 a[50:51], v49 offset:1536
  ds_read_b64_tr_b16 a[52:53], v50 offset:0
  ds_read_b64_tr_b16 a[54:55], v50 offset:1536
  ds_read_b64_tr_b16 a[56:57], v51 offset:0
  ds_read_b64_tr_b16 a[58:59], v51 offset:1536
  ds_read_b64_tr_b16 a[60:61], v49 offset:12288
  ds_read_b64_tr_b16 a[62:63], v49 offset:13824
  ds_read_b64_tr_b16 a[64:65], v50 offset:12288
  ds_read_b64_tr_b16 a[66:67], v50 offset:13824
  ds_read_b64_tr_b16 a[68:69], v51 offset:12288
  ds_read_b64_tr_b16 a[70:71], v51 offset:13824
  ds_read_b64_tr_b16 a[72:73], v49 offset:24576
  ds_read_b64_tr_b16 a[74:75], v49 offset:26112
  ds_read_b64_tr_b16 a[76:77], v50 offset:24576
  ds_read_b64_tr_b16 a[78:79], v50 offset:26112
  ds_read_b64_tr_b16 a[80:81], v51 offset:24576
  ds_read_b64_tr_b16 a[82:83], v51 offset:26112
  ds_read_b64_tr_b16 a[84:85], v49 offset:36864
  ds_read_b64_tr_b16 a[86:87], v49 offset:38400
  ds_read_b64_tr_b16 a[88:89], v50 offset:36864
  ds_read_b64_tr_b16 a[90:91], v50 offset:38400
  ds_read_b64_tr_b16 a[92:93], v51 offset:36864
  ds_read_b64_tr_b16 a[94:95], v51 offset:38400
  s_waitcnt lgkmcnt(0)
  s_barrier
  s_mov_b32 s23, m0
  s_mul_i32 s21, s20, 393216
  s_add_u32 s21, s21, 4718592
  s_add_u32 s21, s21, s44
  s_mul_i32 s22, s20, 12288
  s_add_u32 s22, s22, 49152
  s_add_u32 m0, s22, 0
  s_nop 0
  buffer_load_dwordx4 v40, s[12:15], s21 offen lds
  s_add_u32 m0, s22, 1024
  s_nop 0
  buffer_load_dwordx4 v41, s[12:15], s21 offen lds
  s_add_u32 m0, s22, 2048
  s_nop 0
  buffer_load_dwordx4 v42, s[12:15], s21 offen lds
  s_mul_i32 s21, s20, 393216
  s_add_u32 s21, s21, 4816896
  s_add_u32 s21, s21, s44
  s_mul_i32 s22, s20, 12288
  s_add_u32 s22, s22, 52224
  s_add_u32 m0, s22, 0
  s_nop 0
  buffer_load_dwordx4 v43, s[12:15], s21 offen lds
  s_add_u32 m0, s22, 1024
  s_nop 0
  buffer_load_dwordx4 v44, s[12:15], s21 offen lds
  s_add_u32 m0, s22, 2048
  s_nop 0
  buffer_load_dwordx4 v45, s[12:15], s21 offen lds
  s_mul_i32 s21, s20, 393216
  s_add_u32 s21, s21, 4915200
  s_add_u32 s21, s21, s44
  s_mul_i32 s22, s20, 12288
  s_add_u32 s22, s22, 55296
  s_add_u32 m0, s22, 0
  s_nop 0
  buffer_load_dwordx4 v40, s[12:15], s21 offen lds
  s_add_u32 m0, s22, 1024
  s_nop 0
  buffer_load_dwordx4 v41, s[12:15], s21 offen lds
  s_add_u32 m0, s22, 2048
  s_nop 0
  buffer_load_dwordx4 v42, s[12:15], s21 offen lds
  s_mul_i32 s21, s20, 393216
  s_add_u32 s21, s21, 5013504
  s_add_u32 s21, s21, s44
  s_mul_i32 s22, s20, 12288
  s_add_u32 s22, s22, 58368
  s_add_u32 m0, s22, 0
  s_nop 0
  buffer_load_dwordx4 v43, s[12:15], s21 offen lds
  s_add_u32 m0, s22, 1024
  s_nop 0
  buffer_load_dwordx4 v44, s[12:15], s21 offen lds
  s_add_u32 m0, s22, 2048
  s_nop 0
  buffer_load_dwordx4 v45, s[12:15], s21 offen lds
  s_mov_b32 m0, s23
  v_mfma_f32_16x16x32_bf16 v[64:67], a[48:51], v[160:163], v[64:67]
  ds_read_b128 v[192:195], v19 offset:0
  v_mfma_f32_16x16x32_bf16 v[68:71], a[52:55], v[160:163], v[68:71]
  v_add_u32 v18, s33, v14
  v_mfma_f32_16x16x32_bf16 v[72:75], a[56:59], v[160:163], v[72:75]
  v_mfma_f32_16x16x32_bf16 v[76:79], a[48:51], v[164:167], v[76:79]
  ds_read_b128 v[196:199], v19 offset:2048
  v_mfma_f32_16x16x32_bf16 v[80:83], a[52:55], v[164:167], v[80:83]
  buffer_load_dwordx4 v11, s[8:11], s30 offen offset:1024 lds
  v_mfma_f32_16x16x32_bf16 v[84:87], a[56:59], v[164:167], v[84:87]
  s_add_u32 s30, s30, 128
  v_mfma_f32_16x16x32_bf16 v[88:91], a[48:51], v[168:171], v[88:91]
  ds_read_b128 v[200:203], v19 offset:4096
  s_add_u32 m0, m0, 8192
  v_mfma_f32_16x16x32_bf16 v[92:95], a[52:55], v[168:171], v[92:95]
  s_cmp_lt_u32 m0, s46
  s_cselect_b32 m0, m0, s47
  v_mfma_f32_16x16x32_bf16 v[96:99], a[56:59], v[168:171], v[96:99]
  v_mfma_f32_16x16x32_bf16 v[100:103], a[48:51], v[172:175], v[100:103]
  ds_read_b128 v[204:207], v19 offset:6144
  v_mfma_f32_16x16x32_bf16 v[104:107], a[52:55], v[172:175], v[104:107]
  v_mfma_f32_16x16x32_bf16 v[108:111], a[56:59], v[172:175], v[108:111]
  s_waitcnt vmcnt(44) lgkmcnt(2)
  s_barrier
  v_mfma_f32_16x16x32_bf16 v[64:67], a[60:63], v[192:195], v[64:67]
  ds_read_b128 v[160:163], v18 offset:0
  v_mfma_f32_16x16x32_bf16 v[68:71], a[64:67], v[192:195], v[68:71]
  v_mfma_f32_16x16x32_bf16 v[72:75], a[68:71], v[192:195], v[72:75]
  v_add_u32 v19, s33, v15
  s_add_u32 s33, s33, 8192
  v_mfma_f32_16x16x32_bf16 v[76:79], a[60:63], v[196:199], v[76:79]
  ds_read_b128 v[164:167], v18 offset:2048
  v_mfma_f32_16x16x32_bf16 v[80:83], a[64:67], v[196:199], v[80:83]
  buffer_load_dwordx4 v10, s[8:11], s30 offen offset:0 lds
  v_mfma_f32_16x16x32_bf16 v[84:87], a[68:71], v[196:199], v[84:87]
  s_waitcnt lgkmcnt(2)
  v_mfma_f32_16x16x32_bf16 v[88:91], a[60:63], v[200:203], v[88:91]
  ds_read_b128 v[168:171], v18 offset:4096
  v_mfma_f32_16x16x32_bf16 v[92:95], a[64:67], v[200:203], v[92:95]
  s_cmp_lt_u32 s33, 155648
  s_cselect_b32 s33, s33, 98304
  v_mfma_f32_16x16x32_bf16 v[96:99], a[68:71], v[200:203], v[96:99]
  v_mfma_f32_16x16x32_bf16 v[100:103], a[60:63], v[204:207], v[100:103]
  ds_read_b128 v[172:175], v18 offset:6144
  v_mfma_f32_16x16x32_bf16 v[104:107], a[64:67], v[204:207], v[104:107]
  v_mfma_f32_16x16x32_bf16 v[108:111], a[68:71], v[204:207], v[108:111]
  s_waitcnt lgkmcnt(2)
  v_mfma_f32_16x16x32_bf16 v[64:67], a[72:75], v[160:163], v[64:67]
  ds_read_b128 v[192:195], v19 offset:0
  v_mfma_f32_16x16x32_bf16 v[68:71], a[76:79], v[160:163], v[68:71]
  v_add_u32 v18, s33, v14
  v_mfma_f32_16x16x32_bf16 v[72:75], a[80:83], v[160:163], v[72:75]
  v_mfma_f32_16x16x32_bf16 v[76:79], a[72:75], v[164:167], v[76:79]
  ds_read_b128 v[196:199], v19 offset:2048
  v_mfma_f32_16x16x32_bf16 v[80:83], a[76:79], v[164:167], v[80:83]
  buffer_load_dwordx4 v11, s[8:11], s30 offen offset:1024 lds
  v_mfma_f32_16x16x32_bf16 v[84:87], a[80:83], v[164:167], v[84:87]
  s_waitcnt lgkmcnt(2)
  s_add_u32 s30, s30, 128
  v_mfma_f32_16x16x32_bf16 v[88:91], a[72:75], v[168:171], v[88:91]
  ds_read_b128 v[200:203], v19 offset:4096
  s_add_u32 m0, m0, 8192
  v_mfma_f32_16x16x32_bf16 v[92:95], a[76:79], v[168:171], v[92:95]
  s_cmp_lt_u32 m0, s46
  s_cselect_b32 m0, m0, s47
  v_mfma_f32_16x16x32_bf16 v[96:99], a[80:83], v[168:171], v[96:99]
  v_mfma_f32_16x16x32_bf16 v[100:103], a[72:75], v[172:175], v[100:103]
  ds_read_b128 v[204:207], v19 offset:6144
  v_mfma_f32_16x16x32_bf16 v[104:107], a[76:79], v[172:175], v[104:107]
  v_mfma_f32_16x16x32_bf16 v[108:111], a[80:83], v[172:175], v[108:111]
  s_waitcnt vmcnt(44) lgkmcnt(2)
  s_barrier
  v_mfma_f32_16x16x32_bf16 v[64:67], a[84:87], v[192:195], v[64:67]
  ds_read_b128 v[160:163], v18 offset:0
  v_mfma_f32_16x16x32_bf16 v[68:71], a[88:91], v[192:195], v[68:71]
  v_mfma_f32_16x16x32_bf16 v[72:75], a[92:95], v[192:195], v[72:75]
  v_add_u32 v19, s33, v15
  s_add_u32 s33, s33, 8192
  v_mfma_f32_16x16x32_bf16 v[76:79], a[84:87], v[196:199], v[76:79]
  ds_read_b128 v[164:167], v18 offset:2048
  v_mfma_f32_16x16x32_bf16 v[80:83], a[88:91], v[196:199], v[80:83]
  buffer_load_dwordx4 v10, s[8:11], s30 offen offset:0 lds
  v_mfma_f32_16x16x32_bf16 v[84:87], a[92:95], v[196:199], v[84:87]
  s_waitcnt lgkmcnt(2)
  v_mfma_f32_16x16x32_bf16 v[88:91], a[84:87], v[200:203], v[88:91]
  ds_read_b128 v[168:171], v18 offset:4096
  v_mfma_f32_16x16x32_bf16 v[92:95], a[88:91], v[200:203], v[92:95]
  s_cmp_lt_u32 s33, 155648
  s_cselect_b32 s33, s33, 98304
  v_mfma_f32_16x16x32_bf16 v[96:99], a[92:95], v[200:203], v[96:99]
  v_mfma_f32_16x16x32_bf16 v[100:103], a[84:87], v[204:207], v[100:103]
  ds_read_b128 v[172:175], v18 offset:6144
  v_mfma_f32_16x16x32_bf16 v[104:107], a[88:91], v[204:207], v[104:107]
  v_mfma_f32_16x16x32_bf16 v[108:111], a[92:95], v[204:207], v[108:111]
  s_waitcnt lgkmcnt(2)
  s_waitcnt vmcnt(20)
  s_barrier
  ds_read_b64_tr_b16 a[96:97], v46 offset:0
  ds_read_b64_tr_b16 a[98:99], v46 offset:1536
  ds_read_b64_tr_b16 a[100:101], v47 offset:0
  ds_read_b64_tr_b16 a[102:103], v47 offset:1536
  ds_read_b64_tr_b16 a[104:105], v48 offset:0
  ds_read_b64_tr_b16 a[106:107], v48 offset:1536
  ds_read_b64_tr_b16 a[108:109], v46 offset:12288
  ds_read_b64_tr_b16 a[110:111], v46 offset:13824
  ds_read_b64_tr_b16 a[112:113], v47 offset:12288
  ds_read_b64_tr_b16 a[114:115], v47 offset:13824
  ds_read_b64_tr_b16 a[116:117], v48 offset:12288
  ds_read_b64_tr_b16 a[118:119], v48 offset:13824
  ds_read_b64_tr_b16 a[120:121], v46 offset:24576
  ds_read_b64_tr_b16 a[122:123], v46 offset:26112
  ds_read_b64_tr_b16 a[124:125], v47 offset:24576
  ds_read_b64_tr_b16 a[126:127], v47 offset:26112
  ds_read_b64_tr_b16 a[128:129], v48 offset:24576
  ds_read_b64_tr_b16 a[130:131], v48 offset:26112
  ds_read_b64_tr_b16 a[132:133], v46 offset:36864
  ds_read_b64_tr_b16 a[134:135], v46 offset:38400
  ds_read_b64_tr_b16 a[136:137], v47 offset:36864
  ds_read_b64_tr_b16 a[138:139], v47 offset:38400
  ds_read_b64_tr_b16 a[140:141], v48 offset:36864
  ds_read_b64_tr_b16 a[142:143], v48 offset:38400
  s_waitcnt lgkmcnt(0)
  s_barrier
  s_mov_b32 s23, m0
  s_mul_i32 s21, s20, 393216
  s_add_u32 s21, s21, 6291456
  s_add_u32 s21, s21, s44
  s_mul_i32 s22, s20, 12288
  s_add_u32 s22, s22, 0
  s_add_u32 m0, s22, 0
  s_nop 0
  buffer_load_dwordx4 v40, s[12:15], s21 offen lds
  s_add_u32 m0, s22, 1024
  s_nop 0
  buffer_load_dwordx4 v41, s[12:15], s21 offen lds
  s_add_u32 m0, s22, 2048
  s_nop 0
  buffer_load_dwordx4 v42, s[12:15], s21 offen lds
  s_mul_i32 s21, s20, 393216
  s_add_u32 s21, s21, 6389760
  s_add_u32 s21, s21, s44
  s_mul_i32 s22, s20, 12288
  s_add_u32 s22, s22, 3072
  s_add_u32 m0, s22, 0
  s_nop 0
  buffer_load_dwordx4 v43, s[12:15], s21 offen lds
  s_add_u32 m0, s22, 1024
  s_nop 0
  buffer_load_dwordx4 v44, s[12:15], s21 offen lds
  s_add_u32 m0, s22, 2048
  s_nop 0
  buffer_load_dwordx4 v45, s[12:15], s21 offen lds
  s_mul_i32 s21, s20, 393216
  s_add_u32 s21, s21, 6488064
  s_add_u32 s21, s21, s44
  s_mul_i32 s22, s20, 12288
  s_add_u32 s22, s22, 6144
  s_add_u32 m0, s22, 0
  s_nop 0
  buffer_load_dwordx4 v40, s[12:15], s21 offen lds
  s_add_u32 m0, s22, 1024
  s_nop 0
  buffer_load_dwordx4 v41, s[12:15], s21 offen lds
  s_add_u32 m0, s22, 2048
  s_nop 0
  buffer_load_dwordx4 v42, s[12:15], s21 offen lds
  s_mul_i32 s21, s20, 393216
  s_add_u32 s21, s21, 6586368
  s_add_u32 s21, s21, s44
  s_mul_i32 s22, s20, 12288
  s_add_u32 s22, s22, 9216
  s_add_u32 m0, s22, 0
  s_nop 0
  buffer_load_dwordx4 v43, s[12:15], s21 offen lds
  s_add_u32 m0, s22, 1024
  s_nop 0
  buffer_load_dwordx4 v44, s[12:15], s21 offen lds
  s_add_u32 m0, s22, 2048
  s_nop 0
  buffer_load_dwordx4 v45, s[12:15], s21 offen lds
  s_mov_b32 m0, s23
  v_mov_b32 v29, 76
  buffer_load_dword v29, v29, s[64:67], 0 offen sc1
  v_mfma_f32_16x16x32_bf16 v[64:67], a[96:99], v[160:163], v[64:67]
  ds_read_b128 v[192:195], v19 offset:0
  v_mfma_f32_16x16x32_bf16 v[68:71], a[100:103], v[160:163], v[68:71]
  v_add_u32 v18, s33, v14
  s_mov_b32 s61, s60
  v_mfma_f32_16x16x32_bf16 v[72:75], a[104:107], v[160:163], v[72:75]
  s_add_u32 s60, s60, s62
  s_lshr_b32 s48, s20, 1
  v_mfma_f32_16x16x32_bf16 v[76:79], a[96:99], v[164:167], v[76:79]
  ds_read_b128 v[196:199], v19 offset:2048
  s_mul_i32 s48, s48, 393216
  v_mfma_f32_16x16x32_bf16 v[80:83], a[100:103], v[164:167], v[80:83]
  buffer_load_dwordx4 v11, s[8:11], s30 offen offset:1024 lds
  v_mfma_f32_16x16x32_bf16 v[84:87], a[104:107], v[164:167], v[84:87]
  s_add_u32 s30, s30, s25
  v_mfma_f32_16x16x32_bf16 v[88:91], a[96:99], v[168:171], v[88:91]
  ds_read_b128 v[200:203], v19 offset:4096
  s_sub_u32 s30, s30, 1152
  v_mfma_f32_16x16x32_bf16 v[92:95], a[100:103], v[168:171], v[92:95]
  s_add_u32 m0, m0, 8192
  s_and_b32 s21, s20, 1
  v_mfma_f32_16x16x32_bf16 v[96:99], a[104:107], v[168:171], v[96:99]
  s_cmp_lt_u32 m0, s46
  s_cselect_b32 m0, m0, s47
  v_mfma_f32_16x16x32_bf16 v[100:103], a[96:99], v[172:175], v[100:103]
  ds_read_b128 v[204:207], v19 offset:6144
  s_mul_i32 s21, s21, 6144
  v_mfma_f32_16x16x32_bf16 v[104:107], a[100:103], v[172:175], v[104:107]
  s_add_u32 s48, s48, s21
  s_add_u32 s48, s48, s27
  v_mfma_f32_16x16x32_bf16 v[108:111], a[104:107], v[172:175], v[108:111]
  s_waitcnt vmcnt(33) lgkmcnt(2)
  s_barrier
  v_mfma_f32_16x16x32_bf16 v[64:67], a[108:111], v[192:195], v[64:67]
  ds_read_b128 v[160:163], v18 offset:0
  s_add_u32 s27, s27, s28
  v_mfma_f32_16x16x32_bf16 v[68:71], a[112:115], v[192:195], v[68:71]
  s_sub_u32 s26, s26, 1
  v_mfma_f32_16x16x32_bf16 v[72:75], a[116:119], v[192:195], v[72:75]
  v_add_u32 v19, s33, v15
  s_add_u32 s33, s33, 8192
  v_mfma_f32_16x16x32_bf16 v[76:79], a[108:111], v[196:199], v[76:79]
  ds_read_b128 v[164:167], v18 offset:2048
  v_mfma_f32_16x16x32_bf16 v[80:83], a[112:115], v[196:199], v[80:83]
  buffer_load_dwordx4 v10, s[8:11], s30 offen offset:0 lds
  v_mfma_f32_16x16x32_bf16 v[84:87], a[116:119], v[196:199], v[84:87]
  s_waitcnt lgkmcnt(2)
  v_mfma_f32_16x16x32_bf16 v[88:91], a[108:111], v[200:203], v[88:91]
  ds_read_b128 v[168:171], v18 offset:4096
  v_mfma_f32_16x16x32_bf16 v[92:95], a[112:115], v[200:203], v[92:95]
  s_cmp_lt_u32 s33, 155648
  s_cselect_b32 s33, s33, 98304
  v_mfma_f32_16x16x32_bf16 v[96:99], a[116:119], v[200:203], v[96:99]
  v_mfma_f32_16x16x32_bf16 v[100:103], a[108:111], v[204:207], v[100:103]
  ds_read_b128 v[172:175], v18 offset:6144
  v_mfma_f32_16x16x32_bf16 v[104:107], a[112:115], v[204:207], v[104:107]
  v_mfma_f32_16x16x32_bf16 v[108:111], a[116:119], v[204:207], v[108:111]
  s_waitcnt lgkmcnt(2)
  v_mfma_f32_16x16x32_bf16 v[64:67], a[120:123], v[160:163], v[64:67]
  ds_read_b128 v[192:195], v19 offset:0
  v_mfma_f32_16x16x32_bf16 v[68:71], a[124:127], v[160:163], v[68:71]
  v_add_u32 v18, s33, v14
  v_mfma_f32_16x16x32_bf16 v[72:75], a[128:131], v[160:163], v[72:75]
  v_mfma_f32_16x16x32_bf16 v[76:79], a[120:123], v[164:167], v[76:79]
  ds_read_b128 v[196:199], v19 offset:2048
  v_mfma_f32_16x16x32_bf16 v[80:83], a[124:127], v[164:167], v[80:83]
  buffer_load_dwordx4 v11, s[8:11], s30 offen offset:1024 lds
  v_mfma_f32_16x16x32_bf16 v[84:87], a[128:131], v[164:167], v[84:87]
  s_waitcnt lgkmcnt(2)
  s_add_u32 s30, s30, 128
  v_mfma_f32_16x16x32_bf16 v[88:91], a[120:123], v[168:171], v[88:91]
  ds_read_b128 v[200:203], v19 offset:4096
  s_add_u32 m0, m0, 8192
  v_mfma_f32_16x16x32_bf16 v[92:95], a[124:127], v[168:171], v[92:95]
  s_cmp_lt_u32 m0, s46
  s_cselect_b32 m0, m0, s47
  v_mfma_f32_16x16x32_bf16 v[96:99], a[128:131], v[168:171], v[96:99]
  v_mfma_f32_16x16x32_bf16 v[100:103], a[120:123], v[172:175], v[100:103]
  ds_read_b128 v[204:207], v19 offset:6144
  v_mfma_f32_16x16x32_bf16 v[104:107], a[124:127], v[172:175], v[104:107]
  v_mfma_f32_16x16x32_bf16 v[108:111], a[128:131], v[172:175], v[108:111]
  s_waitcnt vmcnt(33) lgkmcnt(2)
  s_barrier
  v_mfma_f32_16x16x32_bf16 v[64:67], a[132:135], v[192:195], v[64:67]
  ds_read_b128 v[160:163], v18 offset:0
  v_mfma_f32_16x16x32_bf16 v[68:71], a[136:139], v[192:195], v[68:71]
  v_mfma_f32_16x16x32_bf16 v[72:75], a[140:143], v[192:195], v[72:75]
  v_add_u32 v19, s33, v15
  s_add_u32 s33, s33, 8192
  v_mfma_f32_16x16x32_bf16 v[76:79], a[132:135], v[196:199], v[76:79]
  ds_read_b128 v[164:167], v18 offset:2048
  v_mfma_f32_16x16x32_bf16 v[80:83], a[136:139], v[196:199], v[80:83]
  buffer_load_dwordx4 v10, s[8:11], s30 offen offset:0 lds
  v_mfma_f32_16x16x32_bf16 v[84:87], a[140:143], v[196:199], v[84:87]
  s_waitcnt lgkmcnt(2)
  v_mfma_f32_16x16x32_bf16 v[88:91], a[132:135], v[200:203], v[88:91]
  ds_read_b128 v[168:171], v18 offset:4096
  v_mfma_f32_16x16x32_bf16 v[92:95], a[136:139], v[200:203], v[92:95]
  s_cmp_lt_u32 s33, 155648
  s_cselect_b32 s33, s33, 98304
  v_mfma_f32_16x16x32_bf16 v[96:99], a[140:143], v[200:203], v[96:99]
  v_mfma_f32_16x16x32_bf16 v[100:103], a[132:135], v[204:207], v[100:103]
  ds_read_b128 v[172:175], v18 offset:6144
  v_mfma_f32_16x16x32_bf16 v[104:107], a[136:139], v[204:207], v[104:107]
  v_mfma_f32_16x16x32_bf16 v[108:111], a[140:143], v[204:207], v[108:111]
  s_waitcnt lgkmcnt(2)
  s_waitcnt vmcnt(21)
  s_barrier
  ds_read_b64_tr_b16 a[144:145], v49 offset:0
  ds_read_b64_tr_b16 a[146:147], v49 offset:1536
  ds_read_b64_tr_b16 a[148:149], v50 offset:0
  ds_read_b64_tr_b16 a[150:151], v50 offset:1536
  ds_read_b64_tr_b16 a[152:153], v51 offset:0
  ds_read_b64_tr_b16 a[154:155], v51 offset:1536
  ds_read_b64_tr_b16 a[156:157], v49 offset:12288
  ds_read_b64_tr_b16 a[158:159], v49 offset:13824
  ds_read_b64_tr_b16 a[160:161], v50 offset:12288
  ds_read_b64_tr_b16 a[162:163], v50 offset:13824
  ds_read_b64_tr_b16 a[164:165], v51 offset:12288
  ds_read_b64_tr_b16 a[166:167], v51 offset:13824
  ds_read_b64_tr_b16 a[168:169], v49 offset:24576
  ds_read_b64_tr_b16 a[170:171], v49 offset:26112
  ds_read_b64_tr_b16 a[172:173], v50 offset:24576
  ds_read_b64_tr_b16 a[174:175], v50 offset:26112
  ds_read_b64_tr_b16 a[176:177], v51 offset:24576
  ds_read_b64_tr_b16 a[178:179], v51 offset:26112
  ds_read_b64_tr_b16 a[180:181], v49 offset:36864
  ds_read_b64_tr_b16 a[182:183], v49 offset:38400
  ds_read_b64_tr_b16 a[184:185], v50 offset:36864
  ds_read_b64_tr_b16 a[186:187], v50 offset:38400
  ds_read_b64_tr_b16 a[188:189], v51 offset:36864
  ds_read_b64_tr_b16 a[190:191], v51 offset:38400
  s_waitcnt lgkmcnt(0)
  s_barrier
  v_mfma_f32_16x16x32_bf16 v[64:67], a[144:147], v[160:163], v[64:67]
  ds_read_b128 v[192:195], v19 offset:0
  v_mfma_f32_16x16x32_bf16 v[68:71], a[148:151], v[160:163], v[68:71]
  v_add_u32 v18, s33, v14
  v_mfma_f32_16x16x32_bf16 v[72:75], a[152:155], v[160:163], v[72:75]
  v_mfma_f32_16x16x32_bf16 v[76:79], a[144:147], v[164:167], v[76:79]
  ds_read_b128 v[196:199], v19 offset:2048
  v_mfma_f32_16x16x32_bf16 v[80:83], a[148:151], v[164:167], v[80:83]
  buffer_load_dwordx4 v11, s[8:11], s30 offen offset:1024 lds
  v_mfma_f32_16x16x32_bf16 v[84:87], a[152:155], v[164:167], v[84:87]
  s_add_u32 s30, s30, 128
  v_mfma_f32_16x16x32_bf16 v[88:91], a[144:147], v[168:171], v[88:91]
  ds_read_b128 v[200:203], v19 offset:4096
  s_add_u32 m0, m0, 8192
  v_mfma_f32_16x16x32_bf16 v[92:95], a[148:151], v[168:171], v[92:95]
  s_cmp_lt_u32 m0, s46
  s_cselect_b32 m0, m0, s47
  v_mfma_f32_16x16x32_bf16 v[96:99], a[152:155], v[168:171], v[96:99]
  v_mfma_f32_16x16x32_bf16 v[100:103], a[144:147], v[172:175], v[100:103]
  ds_read_b128 v[204:207], v19 offset:6144
  v_mfma_f32_16x16x32_bf16 v[104:107], a[148:151], v[172:175], v[104:107]
  v_mfma_f32_16x16x32_bf16 v[108:111], a[152:155], v[172:175], v[108:111]
  s_waitcnt vmcnt(21) lgkmcnt(2)
  s_barrier
  v_mfma_f32_16x16x32_bf16 v[64:67], a[156:159], v[192:195], v[64:67]
  ds_read_b128 v[160:163], v18 offset:0
  v_mfma_f32_16x16x32_bf16 v[68:71], a[160:163], v[192:195], v[68:71]
  v_mfma_f32_16x16x32_bf16 v[72:75], a[164:167], v[192:195], v[72:75]
  v_add_u32 v19, s33, v15
  s_add_u32 s33, s33, 8192
  v_mfma_f32_16x16x32_bf16 v[76:79], a[156:159], v[196:199], v[76:79]
  ds_read_b128 v[164:167], v18 offset:2048
  v_mfma_f32_16x16x32_bf16 v[80:83], a[160:163], v[196:199], v[80:83]
  buffer_load_dwordx4 v10, s[8:11], s30 offen offset:0 lds
  v_mfma_f32_16x16x32_bf16 v[84:87], a[164:167], v[196:199], v[84:87]
  s_waitcnt lgkmcnt(2)
  v_mfma_f32_16x16x32_bf16 v[88:91], a[156:159], v[200:203], v[88:91]
  ds_read_b128 v[168:171], v18 offset:4096
  v_mfma_f32_16x16x32_bf16 v[92:95], a[160:163], v[200:203], v[92:95]
  s_cmp_lt_u32 s33, 155648
  s_cselect_b32 s33, s33, 98304
  v_mfma_f32_16x16x32_bf16 v[96:99], a[164:167], v[200:203], v[96:99]
  v_mfma_f32_16x16x32_bf16 v[100:103], a[156:159], v[204:207], v[100:103]
  ds_read_b128 v[172:175], v18 offset:6144
  v_mfma_f32_16x16x32_bf16 v[104:107], a[160:163], v[204:207], v[104:107]
  v_mfma_f32_16x16x32_bf16 v[108:111], a[164:167], v[204:207], v[108:111]
  s_waitcnt lgkmcnt(2)
  v_mfma_f32_16x16x32_bf16 v[64:67], a[168:171], v[160:163], v[64:67]
  ds_read_b128 v[192:195], v19 offset:0
  v_mfma_f32_16x16x32_bf16 v[68:71], a[172:175], v[160:163], v[68:71]
  v_add_u32 v18, s33, v14
  v_mfma_f32_16x16x32_bf16 v[72:75], a[176:179], v[160:163], v[72:75]
  v_mfma_f32_16x16x32_bf16 v[76:79], a[168:171], v[164:167], v[76:79]
  ds_read_b128 v[196:199], v19 offset:2048
  v_mfma_f32_16x16x32_bf16 v[80:83], a[172:175], v[164:167], v[80:83]
  buffer_load_dwordx4 v11, s[8:11], s30 offen offset:1024 lds
  v_mfma_f32_16x16x32_bf16 v[84:87], a[176:179], v[164:167], v[84:87]
  s_waitcnt lgkmcnt(2)
  s_add_u32 s30, s30, 128
  v_mfma_f32_16x16x32_bf16 v[88:91], a[168:171], v[168:171], v[88:91]
  ds_read_b128 v[200:203], v19 offset:4096
  s_add_u32 m0, m0, 8192
  v_mfma_f32_16x16x32_bf16 v[92:95], a[172:175], v[168:171], v[92:95]
  s_cmp_lt_u32 m0, s46
  s_cselect_b32 m0, m0, s47
  v_mfma_f32_16x16x32_bf16 v[96:99], a[176:179], v[168:171], v[96:99]
  v_mfma_f32_16x16x32_bf16 v[100:103], a[168:171], v[172:175], v[100:103]
  ds_read_b128 v[204:207], v19 offset:6144
  v_mfma_f32_16x16x32_bf16 v[104:107], a[172:175], v[172:175], v[104:107]
  v_mfma_f32_16x16x32_bf16 v[108:111], a[176:179], v[172:175], v[108:111]
  s_waitcnt vmcnt(21) lgkmcnt(2)
  s_barrier
  v_mfma_f32_16x16x32_bf16 v[64:67], a[180:183], v[192:195], v[64:67]
  ds_read_b128 v[160:163], v18 offset:0
  v_mfma_f32_16x16x32_bf16 v[68:71], a[184:187], v[192:195], v[68:71]
  v_mfma_f32_16x16x32_bf16 v[72:75], a[188:191], v[192:195], v[72:75]
  v_add_u32 v19, s33, v15
  s_add_u32 s33, s33, 8192
  v_mfma_f32_16x16x32_bf16 v[76:79], a[180:183], v[196:199], v[76:79]
  ds_read_b128 v[164:167], v18 offset:2048
  v_mfma_f32_16x16x32_bf16 v[80:83], a[184:187], v[196:199], v[80:83]
  buffer_load_dwordx4 v10, s[8:11], s30 offen offset:0 lds
  v_mfma_f32_16x16x32_bf16 v[84:87], a[188:191], v[196:199], v[84:87]
  s_waitcnt lgkmcnt(2)
  v_mfma_f32_16x16x32_bf16 v[88:91], a[180:183], v[200:203], v[88:91]
  ds_read_b128 v[168:171], v18 offset:4096
  v_mfma_f32_16x16x32_bf16 v[92:95], a[184:187], v[200:203], v[92:95]
  s_cmp_lt_u32 s33, 155648
  s_cselect_b32 s33, s33, 98304
  v_mfma_f32_16x16x32_bf16 v[96:99], a[188:191], v[200:203], v[96:99]
  v_mfma_f32_16x16x32_bf16 v[100:103], a[180:183], v[204:207], v[100:103]
  ds_read_b128 v[172:175], v18 offset:6144
  v_mfma_f32_16x16x32_bf16 v[104:107], a[184:187], v[204:207], v[104:107]
  v_mfma_f32_16x16x32_bf16 v[108:111], a[188:191], v[204:207], v[108:111]
  s_waitcnt lgkmcnt(2)
  s_waitcnt vmcnt(9)
  s_barrier
  ds_read_b64_tr_b16 a[192:193], v46 offset:0
  ds_read_b64_tr_b16 a[194:195], v46 offset:1536
  ds_read_b64_tr_b16 a[196:197], v47 offset:0
  ds_read_b64_tr_b16 a[198:199], v47 offset:1536
  ds_read_b64_tr_b16 a[200:201], v48 offset:0
  ds_read_b64_tr_b16 a[202:203], v48 offset:1536
  ds_read_b64_tr_b16 a[204:205], v46 offset:12288
  ds_read_b64_tr_b16 a[206:207], v46 offset:13824
  ds_read_b64_tr_b16 a[208:209], v47 offset:12288
  ds_read_b64_tr_b16 a[210:211], v47 offset:13824
  ds_read_b64_tr_b16 a[212:213], v48 offset:12288
  ds_read_b64_tr_b16 a[214:215], v48 offset:13824
  ds_read_b64_tr_b16 a[216:217], v46 offset:24576
  ds_read_b64_tr_b16 a[218:219], v46 offset:26112
  ds_read_b64_tr_b16 a[220:221], v47 offset:24576
  ds_read_b64_tr_b16 a[222:223], v47 offset:26112
  ds_read_b64_tr_b16 a[224:225], v48 offset:24576
  ds_read_b64_tr_b16 a[226:227], v48 offset:26112
  ds_read_b64_tr_b16 a[228:229], v46 offset:36864
  ds_read_b64_tr_b16 a[230:231], v46 offset:38400
  ds_read_b64_tr_b16 a[232:233], v47 offset:36864
  ds_read_b64_tr_b16 a[234:235], v47 offset:38400
  ds_read_b64_tr_b16 a[236:237], v48 offset:36864
  ds_read_b64_tr_b16 a[238:239], v48 offset:38400
  s_waitcnt lgkmcnt(0)
  s_barrier
  v_mfma_f32_16x16x32_bf16 v[64:67], a[192:195], v[160:163], v[64:67]
  ds_read_b128 v[192:195], v19 offset:0
  v_mfma_f32_16x16x32_bf16 v[68:71], a[196:199], v[160:163], v[68:71]
  v_add_u32 v18, s33, v14
  v_mfma_f32_16x16x32_bf16 v[72:75], a[200:203], v[160:163], v[72:75]
  v_mfma_f32_16x16x32_bf16 v[76:79], a[192:195], v[164:167], v[76:79]
  ds_read_b128 v[196:199], v19 offset:2048
  v_mfma_f32_16x16x32_bf16 v[80:83], a[196:199], v[164:167], v[80:83]
  buffer_load_dwordx4 v11, s[8:11], s30 offen offset:1024 lds
  v_mfma_f32_16x16x32_bf16 v[84:87], a[200:203], v[164:167], v[84:87]
  s_add_u32 s30, s30, 128
  v_mfma_f32_16x16x32_bf16 v[88:91], a[192:195], v[168:171], v[88:91]
  ds_read_b128 v[200:203], v19 offset:4096
  s_add_u32 m0, m0, 8192
  v_mfma_f32_16x16x32_bf16 v[92:95], a[196:199], v[168:171], v[92:95]
  s_cmp_lt_u32 m0, s46
  s_cselect_b32 m0, m0, s47
  v_mfma_f32_16x16x32_bf16 v[96:99], a[200:203], v[168:171], v[96:99]
  v_mfma_f32_16x16x32_bf16 v[100:103], a[192:195], v[172:175], v[100:103]
  ds_read_b128 v[204:207], v19 offset:6144
  v_mfma_f32_16x16x32_bf16 v[104:107], a[196:199], v[172:175], v[104:107]
  v_mfma_f32_16x16x32_bf16 v[108:111], a[200:203], v[172:175], v[108:111]
  s_waitcnt vmcnt(8) lgkmcnt(2)
  s_barrier
  v_mfma_f32_16x16x32_bf16 v[64:67], a[204:207], v[192:195], v[64:67]
  ds_read_b128 v[160:163], v18 offset:0
  v_mfma_f32_16x16x32_bf16 v[68:71], a[208:211], v[192:195], v[68:71]
  v_mfma_f32_16x16x32_bf16 v[72:75], a[212:215], v[192:195], v[72:75]
  v_add_u32 v19, s33, v15
  s_add_u32 s33, s33, 8192
  v_mfma_f32_16x16x32_bf16 v[76:79], a[204:207], v[196:199], v[76:79]
  ds_read_b128 v[164:167], v18 offset:2048
  v_mfma_f32_16x16x32_bf16 v[80:83], a[208:211], v[196:199], v[80:83]
  buffer_load_dwordx4 v10, s[8:11], s30 offen offset:0 lds
  v_mfma_f32_16x16x32_bf16 v[84:87], a[212:215], v[196:199], v[84:87]
  s_waitcnt lgkmcnt(2)
  v_mfma_f32_16x16x32_bf16 v[88:91], a[204:207], v[200:203], v[88:91]
  ds_read_b128 v[168:171], v18 offset:4096
  v_mfma_f32_16x16x32_bf16 v[92:95], a[208:211], v[200:203], v[92:95]
  s_cmp_lt_u32 s33, 155648
  s_cselect_b32 s33, s33, 98304
  v_mfma_f32_16x16x32_bf16 v[96:99], a[212:215], v[200:203], v[96:99]
  v_mfma_f32_16x16x32_bf16 v[100:103], a[204:207], v[204:207], v[100:103]
  ds_read_b128 v[172:175], v18 offset:6144
  v_mfma_f32_16x16x32_bf16 v[104:107], a[208:211], v[204:207], v[104:107]
  v_mfma_f32_16x16x32_bf16 v[108:111], a[212:215], v[204:207], v[108:111]
  s_waitcnt lgkmcnt(2)
  v_mfma_f32_16x16x32_bf16 v[64:67], a[216:219], v[160:163], v[64:67]
  ds_read_b128 v[192:195], v19 offset:0
  v_mfma_f32_16x16x32_bf16 v[68:71], a[220:223], v[160:163], v[68:71]
  v_add_u32 v18, s33, v14
  v_mfma_f32_16x16x32_bf16 v[72:75], a[224:227], v[160:163], v[72:75]
  v_mfma_f32_16x16x32_bf16 v[76:79], a[216:219], v[164:167], v[76:79]
  ds_read_b128 v[196:199], v19 offset:2048
  v_mfma_f32_16x16x32_bf16 v[80:83], a[220:223], v[164:167], v[80:83]
  buffer_load_dwordx4 v11, s[8:11], s30 offen offset:1024 lds
  v_mfma_f32_16x16x32_bf16 v[84:87], a[224:227], v[164:167], v[84:87]
  s_waitcnt lgkmcnt(2)
  s_add_u32 s30, s30, 128
  v_mfma_f32_16x16x32_bf16 v[88:91], a[216:219], v[168:171], v[88:91]
  ds_read_b128 v[200:203], v19 offset:4096
  s_add_u32 m0, m0, 8192
  v_mfma_f32_16x16x32_bf16 v[92:95], a[220:223], v[168:171], v[92:95]
  s_cmp_lt_u32 m0, s46
  s_cselect_b32 m0, m0, s47
  v_mfma_f32_16x16x32_bf16 v[96:99], a[224:227], v[168:171], v[96:99]
  v_mfma_f32_16x16x32_bf16 v[100:103], a[216:219], v[172:175], v[100:103]
  ds_read_b128 v[204:207], v19 offset:6144
  v_mfma_f32_16x16x32_bf16 v[104:107], a[220:223], v[172:175], v[104:107]
  v_mfma_f32_16x16x32_bf16 v[108:111], a[224:227], v[172:175], v[108:111]
  s_waitcnt vmcnt(8) lgkmcnt(2)
  s_barrier
  v_mfma_f32_16x16x32_bf16 v[64:67], a[228:231], v[192:195], v[64:67]
  ds_read_b128 v[160:163], v18 offset:0
  v_mfma_f32_16x16x32_bf16 v[68:71], a[232:235], v[192:195], v[68:71]
  v_mfma_f32_16x16x32_bf16 v[72:75], a[236:239], v[192:195], v[72:75]
  v_add_u32 v19, s33, v15
  s_add_u32 s33, s33, 8192
  v_mfma_f32_16x16x32_bf16 v[76:79], a[228:231], v[196:199], v[76:79]
  ds_read_b128 v[164:167], v18 offset:2048
  v_cvt_pk_bf16_f32 v224, v64, v65
  v_cvt_pk_bf16_f32 v225, v66, v67
  v_mfma_f32_16x16x32_bf16 v[80:83], a[232:235], v[196:199], v[80:83]
  buffer_load_dwordx4 v10, s[8:11], s30 offen offset:0 lds
  v_cvt_pk_bf16_f32 v226, v68, v69
  v_cvt_pk_bf16_f32 v227, v70, v71
  v_mfma_f32_16x16x32_bf16 v[84:87], a[236:239], v[196:199], v[84:87]
  s_waitcnt lgkmcnt(2)
  v_cvt_pk_bf16_f32 v228, v72, v73
  v_cvt_pk_bf16_f32 v229, v74, v75
  v_mfma_f32_16x16x32_bf16 v[88:91], a[228:231], v[200:203], v[88:91]
  ds_read_b128 v[168:171], v18 offset:4096
  ds_write_b64 v22, v[224:225] offset:0
  v_mfma_f32_16x16x32_bf16 v[92:95], a[232:235], v[200:203], v[92:95]
  s_cmp_lt_u32 s33, 155648
  s_cselect_b32 s33, s33, 98304
  ds_write_b64 v22, v[226:227] offset:8
  v_mfma_f32_16x16x32_bf16 v[96:99], a[236:239], v[200:203], v[96:99]
  ds_write_b64 v16, v[228:229] offset:64
  v_cvt_pk_bf16_f32 v230, v76, v77
  v_cvt_pk_bf16_f32 v231, v78, v79
  v_mfma_f32_16x16x32_bf16 v[100:103], a[228:231], v[204:207], v[100:103]
  ds_read_b128 v[172:175], v18 offset:6144
  v_cvt_pk_bf16_f32 v232, v80, v81
  v_cvt_pk_bf16_f32 v233, v82, v83
  v_cvt_pk_bf16_f32 v234, v84, v85
  v_mfma_f32_16x16x32_bf16 v[104:107], a[232:235], v[204:207], v[104:107]
  v_cvt_pk_bf16_f32 v235, v86, v87
  ds_write_b64 v22, v[230:231] offset:6400
  v_mfma_f32_16x16x32_bf16 v[108:111], a[236:239], v[204:207], v[108:111]
  ds_write_b64 v22, v[232:233] offset:6408
  ds_write_b64 v16, v[234:235] offset:6464
  v_readfirstlane_b32 s21, v29
  s_cmp_ge_u32 s21, 32
  s_cbranch_scc1 kvz_151
  s_mov_b32 s21, 76
  v_mov_b32 v4, 0
  s_mov_b32 s101, 0
wf_152:
  buffer_load_dword v5, v4, s[64:67], s21 offen sc1
  s_add_u32 s101, s101, 1
  s_cmp_gt_u32 s101, 131072
  s_cbranch_scc1 main_end
  s_waitcnt vmcnt(0)
  v_readfirstlane_b32 s100, v5
  s_cmp_ge_u32 s100, 32
  s_cbranch_scc1 wf_153
  s_sleep 8
  s_branch wf_152
wf_153:
kvz_151:
  s_branch kvm_end_150
kvm_blk_149:
  v_mfma_f32_16x16x32_bf16 v[64:67], a[0:3], v[160:163], 0
  ds_read_b128 v[192:195], v19 offset:0
  v_mfma_f32_16x16x32_bf16 v[68:71], a[4:7], v[160:163], 0
  v_add_u32 v18, s33, v14
  v_mfma_f32_16x16x32_bf16 v[72:75], a[8:11], v[160:163], 0
  v_mfma_f32_16x16x32_bf16 v[76:79], a[0:3], v[164:167], 0
  ds_read_b128 v[196:199], v19 offset:2048
  v_mfma_f32_16x16x32_bf16 v[80:83], a[4:7], v[164:167], 0
  buffer_load_dwordx4 v11, s[8:11], s30 offen offset:1024 lds
  v_mfma_f32_16x16x32_bf16 v[84:87], a[8:11], v[164:167], 0
  s_waitcnt lgkmcnt(11)
  s_add_u32 s30, s30, 128
  v_mfma_f32_16x16x32_bf16 v[88:91], a[0:3], v[168:171], 0
  ds_read_b128 v[200:203], v19 offset:4096
  s_add_u32 m0, m0, 8192
  v_mfma_f32_16x16x32_bf16 v[92:95], a[4:7], v[168:171], 0
  s_cmp_lt_u32 m0, s46
  s_cselect_b32 m0, m0, s47
  v_mfma_f32_16x16x32_bf16 v[96:99], a[8:11], v[168:171], 0
  v_mfma_f32_16x16x32_bf16 v[100:103], a[0:3], v[172:175], 0
  ds_read_b128 v[204:207], v19 offset:6144
  v_mfma_f32_16x16x32_bf16 v[104:107], a[4:7], v[172:175], 0
  v_mfma_f32_16x16x32_bf16 v[108:111], a[8:11], v[172:175], 0
  s_waitcnt vmcnt(14) lgkmcnt(2)
  s_barrier
  v_mfma_f32_16x16x32_bf16 v[64:67], a[12:15], v[192:195], v[64:67]
  ds_read_b128 v[160:163], v18 offset:0
  v_mfma_f32_16x16x32_bf16 v[68:71], a[16:19], v[192:195], v[68:71]
  v_mfma_f32_16x16x32_bf16 v[72:75], a[20:23], v[192:195], v[72:75]
  v_add_u32 v19, s33, v15
  s_add_u32 s33, s33, 8192
  v_mfma_f32_16x16x32_bf16 v[76:79], a[12:15], v[196:199], v[76:79]
  ds_read_b128 v[164:167], v18 offset:2048
  v_mfma_f32_16x16x32_bf16 v[80:83], a[16:19], v[196:199], v[80:83]
  buffer_load_dwordx4 v10, s[8:11], s30 offen offset:0 lds
  v_mfma_f32_16x16x32_bf16 v[84:87], a[20:23], v[196:199], v[84:87]
  s_waitcnt lgkmcnt(2)
  v_mfma_f32_16x16x32_bf16 v[88:91], a[12:15], v[200:203], v[88:91]
  ds_read_b128 v[168:171], v18 offset:4096
  v_mfma_f32_16x16x32_bf16 v[92:95], a[16:19], v[200:203], v[92:95]
  s_cmp_lt_u32 s33, 155648
  s_cselect_b32 s33, s33, 98304
  v_mfma_f32_16x16x32_bf16 v[96:99], a[20:23], v[200:203], v[96:99]
  v_mfma_f32_16x16x32_bf16 v[100:103], a[12:15], v[204:207], v[100:103]
  ds_read_b128 v[172:175], v18 offset:6144
  v_mfma_f32_16x16x32_bf16 v[104:107], a[16:19], v[204:207], v[104:107]
  v_mfma_f32_16x16x32_bf16 v[108:111], a[20:23], v[204:207], v[108:111]
  s_waitcnt lgkmcnt(2)
  v_mfma_f32_16x16x32_bf16 v[64:67], a[24:27], v[160:163], v[64:67]
  ds_read_b128 v[192:195], v19 offset:0
  v_mfma_f32_16x16x32_bf16 v[68:71], a[28:31], v[160:163], v[68:71]
  v_add_u32 v18, s33, v14
  v_mfma_f32_16x16x32_bf16 v[72:75], a[32:35], v[160:163], v[72:75]
  v_mfma_f32_16x16x32_bf16 v[76:79], a[24:27], v[164:167], v[76:79]
  ds_read_b128 v[196:199], v19 offset:2048
  v_mfma_f32_16x16x32_bf16 v[80:83], a[28:31], v[164:167], v[80:83]
  buffer_load_dwordx4 v11, s[8:11], s30 offen offset:1024 lds
  v_mfma_f32_16x16x32_bf16 v[84:87], a[32:35], v[164:167], v[84:87]
  s_waitcnt lgkmcnt(2)
  s_add_u32 s30, s30, 128
  v_mfma_f32_16x16x32_bf16 v[88:91], a[24:27], v[168:171], v[88:91]
  ds_read_b128 v[200:203], v19 offset:4096
  s_add_u32 m0, m0, 8192
  v_mfma_f32_16x16x32_bf16 v[92:95], a[28:31], v[168:171], v[92:95]
  s_cmp_lt_u32 m0, s46
  s_cselect_b32 m0, m0, s47
  v_mfma_f32_16x16x32_bf16 v[96:99], a[32:35], v[168:171], v[96:99]
  v_mfma_f32_16x16x32_bf16 v[100:103], a[24:27], v[172:175], v[100:103]
  ds_read_b128 v[204:207], v19 offset:6144
  v_mfma_f32_16x16x32_bf16 v[104:107], a[28:31], v[172:175], v[104:107]
  v_mfma_f32_16x16x32_bf16 v[108:111], a[32:35], v[172:175], v[108:111]
  s_waitcnt vmcnt(14) lgkmcnt(2)
  s_barrier
  v_mfma_f32_16x16x32_bf16 v[64:67], a[36:39], v[192:195], v[64:67]
  ds_read_b128 v[160:163], v18 offset:0
  v_mfma_f32_16x16x32_bf16 v[68:71], a[40:43], v[192:195], v[68:71]
  v_mfma_f32_16x16x32_bf16 v[72:75], a[44:47], v[192:195], v[72:75]
  v_add_u32 v19, s33, v15
  s_add_u32 s33, s33, 8192
  v_mfma_f32_16x16x32_bf16 v[76:79], a[36:39], v[196:199], v[76:79]
  ds_read_b128 v[164:167], v18 offset:2048
  v_mfma_f32_16x16x32_bf16 v[80:83], a[40:43], v[196:199], v[80:83]
  buffer_load_dwordx4 v10, s[8:11], s30 offen offset:0 lds
  v_mfma_f32_16x16x32_bf16 v[84:87], a[44:47], v[196:199], v[84:87]
  s_waitcnt lgkmcnt(2)
  v_mfma_f32_16x16x32_bf16 v[88:91], a[36:39], v[200:203], v[88:91]
  ds_read_b128 v[168:171], v18 offset:4096
  v_mfma_f32_16x16x32_bf16 v[92:95], a[40:43], v[200:203], v[92:95]
  s_cmp_lt_u32 s33, 155648
  s_cselect_b32 s33, s33, 98304
  v_mfma_f32_16x16x32_bf16 v[96:99], a[44:47], v[200:203], v[96:99]
  v_mfma_f32_16x16x32_bf16 v[100:103], a[36:39], v[204:207], v[100:103]
  ds_read_b128 v[172:175], v18 offset:6144
  v_mfma_f32_16x16x32_bf16 v[104:107], a[40:43], v[204:207], v[104:107]
  v_mfma_f32_16x16x32_bf16 v[108:111], a[44:47], v[204:207], v[108:111]
  s_waitcnt lgkmcnt(2)
  v_mfma_f32_16x16x32_bf16 v[64:67], a[48:51], v[160:163], v[64:67]
  ds_read_b128 v[192:195], v19 offset:0
  v_mfma_f32_16x16x32_bf16 v[68:71], a[52:55], v[160:163], v[68:71]
  v_add_u32 v18, s33, v14
  v_mfma_f32_16x16x32_bf16 v[72:75], a[56:59], v[160:163], v[72:75]
  v_mfma_f32_16x16x32_bf16 v[76:79], a[48:51], v[164:167], v[76:79]
  ds_read_b128 v[196:199], v19 offset:2048
  v_mfma_f32_16x16x32_bf16 v[80:83], a[52:55], v[164:167], v[80:83]
  buffer_load_dwordx4 v11, s[8:11], s30 offen offset:1024 lds
  v_mfma_f32_16x16x32_bf16 v[84:87], a[56:59], v[164:167], v[84:87]
  s_waitcnt lgkmcnt(2)
  s_add_u32 s30, s30, 128
  v_mfma_f32_16x16x32_bf16 v[88:91], a[48:51], v[168:171], v[88:91]
  ds_read_b128 v[200:203], v19 offset:4096
  s_add_u32 m0, m0, 8192
  v_mfma_f32_16x16x32_bf16 v[92:95], a[52:55], v[168:171], v[92:95]
  s_cmp_lt_u32 m0, s46
  s_cselect_b32 m0, m0, s47
  v_mfma_f32_16x16x32_bf16 v[96:99], a[56:59], v[168:171], v[96:99]
  v_mfma_f32_16x16x32_bf16 v[100:103], a[48:51], v[172:175], v[100:103]
  ds_read_b128 v[204:207], v19 offset:6144
  v_mfma_f32_16x16x32_bf16 v[104:107], a[52:55], v[172:175], v[104:107]
  v_mfma_f32_16x16x32_bf16 v[108:111], a[56:59], v[172:175], v[108:111]
  s_waitcnt vmcnt(14) lgkmcnt(2)
  s_barrier
  v_mfma_f32_16x16x32_bf16 v[64:67], a[60:63], v[192:195], v[64:67]
  ds_read_b128 v[160:163], v18 offset:0
  v_mfma_f32_16x16x32_bf16 v[68:71], a[64:67], v[192:195], v[68:71]
  v_mfma_f32_16x16x32_bf16 v[72:75], a[68:71], v[192:195], v[72:75]
  v_add_u32 v19, s33, v15
  s_add_u32 s33, s33, 8192
  v_mfma_f32_16x16x32_bf16 v[76:79], a[60:63], v[196:199], v[76:79]
  ds_read_b128 v[164:167], v18 offset:2048
  v_mfma_f32_16x16x32_bf16 v[80:83], a[64:67], v[196:199], v[80:83]
  buffer_load_dwordx4 v10, s[8:11], s30 offen offset:0 lds
  v_mfma_f32_16x16x32_bf16 v[84:87], a[68:71], v[196:199], v[84:87]
  s_waitcnt lgkmcnt(2)
  v_mfma_f32_16x16x32_bf16 v[88:91], a[60:63], v[200:203], v[88:91]
  ds_read_b128 v[168:171], v18 offset:4096
  v_mfma_f32_16x16x32_bf16 v[92:95], a[64:67], v[200:203], v[92:95]
  s_cmp_lt_u32 s33, 155648
  s_cselect_b32 s33, s33, 98304
  v_mfma_f32_16x16x32_bf16 v[96:99], a[68:71], v[200:203], v[96:99]
  v_mfma_f32_16x16x32_bf16 v[100:103], a[60:63], v[204:207], v[100:103]
  ds_read_b128 v[172:175], v18 offset:6144
  v_mfma_f32_16x16x32_bf16 v[104:107], a[64:67], v[204:207], v[104:107]
  v_mfma_f32_16x16x32_bf16 v[108:111], a[68:71], v[204:207], v[108:111]
  s_waitcnt lgkmcnt(2)
  v_mfma_f32_16x16x32_bf16 v[64:67], a[72:75], v[160:163], v[64:67]
  ds_read_b128 v[192:195], v19 offset:0
  v_mfma_f32_16x16x32_bf16 v[68:71], a[76:79], v[160:163], v[68:71]
  v_add_u32 v18, s33, v14
  v_mfma_f32_16x16x32_bf16 v[72:75], a[80:83], v[160:163], v[72:75]
  v_mfma_f32_16x16x32_bf16 v[76:79], a[72:75], v[164:167], v[76:79]
  ds_read_b128 v[196:199], v19 offset:2048
  v_mfma_f32_16x16x32_bf16 v[80:83], a[76:79], v[164:167], v[80:83]
  buffer_load_dwordx4 v11, s[8:11], s30 offen offset:1024 lds
  v_mfma_f32_16x16x32_bf16 v[84:87], a[80:83], v[164:167], v[84:87]
  s_waitcnt lgkmcnt(2)
  s_add_u32 s30, s30, 128
  v_mfma_f32_16x16x32_bf16 v[88:91], a[72:75], v[168:171], v[88:91]
  ds_read_b128 v[200:203], v19 offset:4096
  s_add_u32 m0, m0, 8192
  v_mfma_f32_16x16x32_bf16 v[92:95], a[76:79], v[168:171], v[92:95]
  s_cmp_lt_u32 m0, s46
  s_cselect_b32 m0, m0, s47
  v_mfma_f32_16x16x32_bf16 v[96:99], a[80:83], v[168:171], v[96:99]
  v_mfma_f32_16x16x32_bf16 v[100:103], a[72:75], v[172:175], v[100:103]
  ds_read_b128 v[204:207], v19 offset:6144
  v_mfma_f32_16x16x32_bf16 v[104:107], a[76:79], v[172:175], v[104:107]
  v_mfma_f32_16x16x32_bf16 v[108:111], a[80:83], v[172:175], v[108:111]
  s_waitcnt vmcnt(7) lgkmcnt(2)
  s_barrier
  v_mfma_f32_16x16x32_bf16 v[64:67], a[84:87], v[192:195], v[64:67]
  ds_read_b128 v[160:163], v18 offset:0
  v_mfma_f32_16x16x32_bf16 v[68:71], a[88:91], v[192:195], v[68:71]
  s_cmp_eq_u32 s48, 0x80000000
  s_cbranch_scc1 kvm_147
  s_cmp_lg_u32 s20, 0
  s_cbranch_scc1 af_148
  v_mov_b32 v4, 0
  v_mov_b32 v5, 1
  s_mov_b64 exec, 1
  buffer_atomic_add v5, v4, s[72:75], s61 offen sc1
  s_mov_b64 exec, -1
  s_nop 1
af_148:
kvm_147:
  v_mfma_f32_16x16x32_bf16 v[72:75], a[92:95], v[192:195], v[72:75]
  v_add_u32 v19, s33, v15
  s_add_u32 s33, s33, 8192
  v_mfma_f32_16x16x32_bf16 v[76:79], a[84:87], v[196:199], v[76:79]
  ds_read_b128 v[164:167], v18 offset:2048
  v_mfma_f32_16x16x32_bf16 v[80:83], a[88:91], v[196:199], v[80:83]
  buffer_load_dwordx4 v10, s[8:11], s30 offen offset:0 lds
  v_mfma_f32_16x16x32_bf16 v[84:87], a[92:95], v[196:199], v[84:87]
  s_waitcnt lgkmcnt(2)
  v_mfma_f32_16x16x32_bf16 v[88:91], a[84:87], v[200:203], v[88:91]
  ds_read_b128 v[168:171], v18 offset:4096
  v_mfma_f32_16x16x32_bf16 v[92:95], a[88:91], v[200:203], v[92:95]
  s_cmp_lt_u32 s33, 155648
  s_cselect_b32 s33, s33, 98304
  v_mfma_f32_16x16x32_bf16 v[96:99], a[92:95], v[200:203], v[96:99]
  v_mfma_f32_16x16x32_bf16 v[100:103], a[84:87], v[204:207], v[100:103]
  ds_read_b128 v[172:175], v18 offset:6144
  v_mfma_f32_16x16x32_bf16 v[104:107], a[88:91], v[204:207], v[104:107]
  v_mfma_f32_16x16x32_bf16 v[108:111], a[92:95], v[204:207], v[108:111]
  s_waitcnt lgkmcnt(2)
  v_mfma_f32_16x16x32_bf16 v[64:67], a[96:99], v[160:163], v[64:67]
  ds_read_b128 v[192:195], v19 offset:0
  v_mfma_f32_16x16x32_bf16 v[68:71], a[100:103], v[160:163], v[68:71]
  v_add_u32 v18, s33, v14
  s_mov_b32 s61, s60
  v_mfma_f32_16x16x32_bf16 v[72:75], a[104:107], v[160:163], v[72:75]
  s_add_u32 s60, s60, s62
  s_lshr_b32 s48, s20, 1
  v_mfma_f32_16x16x32_bf16 v[76:79], a[96:99], v[164:167], v[76:79]
  ds_read_b128 v[196:199], v19 offset:2048
  s_mul_i32 s48, s48, 393216
  v_mfma_f32_16x16x32_bf16 v[80:83], a[100:103], v[164:167], v[80:83]
  buffer_load_dwordx4 v11, s[8:11], s30 offen offset:1024 lds
  v_mfma_f32_16x16x32_bf16 v[84:87], a[104:107], v[164:167], v[84:87]
  s_waitcnt lgkmcnt(2)
  s_add_u32 s30, s30, s25
  v_mfma_f32_16x16x32_bf16 v[88:91], a[96:99], v[168:171], v[88:91]
  ds_read_b128 v[200:203], v19 offset:4096
  s_sub_u32 s30, s30, 1152
  v_mfma_f32_16x16x32_bf16 v[92:95], a[100:103], v[168:171], v[92:95]
  s_add_u32 m0, m0, 8192
  s_and_b32 s21, s20, 1
  v_mfma_f32_16x16x32_bf16 v[96:99], a[104:107], v[168:171], v[96:99]
  s_cmp_lt_u32 m0, s46
  s_cselect_b32 m0, m0, s47
  v_mfma_f32_16x16x32_bf16 v[100:103], a[96:99], v[172:175], v[100:103]
  ds_read_b128 v[204:207], v19 offset:6144
  s_mul_i32 s21, s21, 6144
  v_mfma_f32_16x16x32_bf16 v[104:107], a[100:103], v[172:175], v[104:107]
  s_add_u32 s48, s48, s21
  s_add_u32 s48, s48, s27
  v_mfma_f32_16x16x32_bf16 v[108:111], a[104:107], v[172:175], v[108:111]
  s_waitcnt vmcnt(8) lgkmcnt(2)
  s_barrier
  v_mfma_f32_16x16x32_bf16 v[64:67], a[108:111], v[192:195], v[64:67]
  ds_read_b128 v[160:163], v18 offset:0
  s_add_u32 s27, s27, s28
  v_mfma_f32_16x16x32_bf16 v[68:71], a[112:115], v[192:195], v[68:71]
  s_sub_u32 s26, s26, 1
  v_mfma_f32_16x16x32_bf16 v[72:75], a[116:119], v[192:195], v[72:75]
  v_add_u32 v19, s33, v15
  s_add_u32 s33, s33, 8192
  v_mfma_f32_16x16x32_bf16 v[76:79], a[108:111], v[196:199], v[76:79]
  ds_read_b128 v[164:167], v18 offset:2048
  v_mfma_f32_16x16x32_bf16 v[80:83], a[112:115], v[196:199], v[80:83]
  buffer_load_dwordx4 v10, s[8:11], s30 offen offset:0 lds
  v_mfma_f32_16x16x32_bf16 v[84:87], a[116:119], v[196:199], v[84:87]
  s_waitcnt lgkmcnt(2)
  v_mfma_f32_16x16x32_bf16 v[88:91], a[108:111], v[200:203], v[88:91]
  ds_read_b128 v[168:171], v18 offset:4096
  v_mfma_f32_16x16x32_bf16 v[92:95], a[112:115], v[200:203], v[92:95]
  s_cmp_lt_u32 s33, 155648
  s_cselect_b32 s33, s33, 98304
  v_mfma_f32_16x16x32_bf16 v[96:99], a[116:119], v[200:203], v[96:99]
  v_mfma_f32_16x16x32_bf16 v[100:103], a[108:111], v[204:207], v[100:103]
  ds_read_b128 v[172:175], v18 offset:6144
  v_mfma_f32_16x16x32_bf16 v[104:107], a[112:115], v[204:207], v[104:107]
  v_mfma_f32_16x16x32_bf16 v[108:111], a[116:119], v[204:207], v[108:111]
  s_waitcnt lgkmcnt(2)
  v_mfma_f32_16x16x32_bf16 v[64:67], a[120:123], v[160:163], v[64:67]
  ds_read_b128 v[192:195], v19 offset:0
  v_mfma_f32_16x16x32_bf16 v[68:71], a[124:127], v[160:163], v[68:71]
  v_add_u32 v18, s33, v14
  v_mfma_f32_16x16x32_bf16 v[72:75], a[128:131], v[160:163], v[72:75]
  v_mfma_f32_16x16x32_bf16 v[76:79], a[120:123], v[164:167], v[76:79]
  ds_read_b128 v[196:199], v19 offset:2048
  v_mfma_f32_16x16x32_bf16 v[80:83], a[124:127], v[164:167], v[80:83]
  buffer_load_dwordx4 v11, s[8:11], s30 offen offset:1024 lds
  v_mfma_f32_16x16x32_bf16 v[84:87], a[128:131], v[164:167], v[84:87]
  s_waitcnt lgkmcnt(2)
  s_add_u32 s30, s30, 128
  v_mfma_f32_16x16x32_bf16 v[88:91], a[120:123], v[168:171], v[88:91]
  ds_read_b128 v[200:203], v19 offset:4096
  s_add_u32 m0, m0, 8192
  v_mfma_f32_16x16x32_bf16 v[92:95], a[124:127], v[168:171], v[92:95]
  s_cmp_lt_u32 m0, s46
  s_cselect_b32 m0, m0, s47
  v_mfma_f32_16x16x32_bf16 v[96:99], a[128:131], v[168:171], v[96:99]
  v_mfma_f32_16x16x32_bf16 v[100:103], a[120:123], v[172:175], v[100:103]
  ds_read_b128 v[204:207], v19 offset:6144
  v_mfma_f32_16x16x32_bf16 v[104:107], a[124:127], v[172:175], v[104:107]
  v_mfma_f32_16x16x32_bf16 v[108:111], a[128:131], v[172:175], v[108:111]
  s_waitcnt vmcnt(8) lgkmcnt(2)
  s_barrier
  v_mfma_f32_16x16x32_bf16 v[64:67], a[132:135], v[192:195], v[64:67]
  ds_read_b128 v[160:163], v18 offset:0
  v_mfma_f32_16x16x32_bf16 v[68:71], a[136:139], v[192:195], v[68:71]
  v_mfma_f32_16x16x32_bf16 v[72:75], a[140:143], v[192:195], v[72:75]
  v_add_u32 v19, s33, v15
  s_add_u32 s33, s33, 8192
  v_mfma_f32_16x16x32_bf16 v[76:79], a[132:135], v[196:199], v[76:79]
  ds_read_b128 v[164:167], v18 offset:2048
  v_mfma_f32_16x16x32_bf16 v[80:83], a[136:139], v[196:199], v[80:83]
  buffer_load_dwordx4 v10, s[8:11], s30 offen offset:0 lds
  v_mfma_f32_16x16x32_bf16 v[84:87], a[140:143], v[196:199], v[84:87]
  s_waitcnt lgkmcnt(2)
  v_mfma_f32_16x16x32_bf16 v[88:91], a[132:135], v[200:203], v[88:91]
  ds_read_b128 v[168:171], v18 offset:4096
  v_mfma_f32_16x16x32_bf16 v[92:95], a[136:139], v[200:203], v[92:95]
  s_cmp_lt_u32 s33, 155648
  s_cselect_b32 s33, s33, 98304
  v_mfma_f32_16x16x32_bf16 v[96:99], a[140:143], v[200:203], v[96:99]
  v_mfma_f32_16x16x32_bf16 v[100:103], a[132:135], v[204:207], v[100:103]
  ds_read_b128 v[172:175], v18 offset:6144
  v_mfma_f32_16x16x32_bf16 v[104:107], a[136:139], v[204:207], v[104:107]
  v_mfma_f32_16x16x32_bf16 v[108:111], a[140:143], v[204:207], v[108:111]
  s_waitcnt lgkmcnt(2)
  v_mfma_f32_16x16x32_bf16 v[64:67], a[144:147], v[160:163], v[64:67]
  ds_read_b128 v[192:195], v19 offset:0
  v_mfma_f32_16x16x32_bf16 v[68:71], a[148:151], v[160:163], v[68:71]
  v_add_u32 v18, s33, v14
  v_mfma_f32_16x16x32_bf16 v[72:75], a[152:155], v[160:163], v[72:75]
  v_mfma_f32_16x16x32_bf16 v[76:79], a[144:147], v[164:167], v[76:79]
  ds_read_b128 v[196:199], v19 offset:2048
  v_mfma_f32_16x16x32_bf16 v[80:83], a[148:151], v[164:167], v[80:83]
  buffer_load_dwordx4 v11, s[8:11], s30 offen offset:1024 lds
  v_mfma_f32_16x16x32_bf16 v[84:87], a[152:155], v[164:167], v[84:87]
  s_waitcnt lgkmcnt(2)
  s_add_u32 s30, s30, 128
  v_mfma_f32_16x16x32_bf16 v[88:91], a[144:147], v[168:171], v[88:91]
  ds_read_b128 v[200:203], v19 offset:4096
  s_add_u32 m0, m0, 8192
  v_mfma_f32_16x16x32_bf16 v[92:95], a[148:151], v[168:171], v[92:95]
  s_cmp_lt_u32 m0, s46
  s_cselect_b32 m0, m0, s47
  v_mfma_f32_16x16x32_bf16 v[96:99], a[152:155], v[168:171], v[96:99]
  v_mfma_f32_16x16x32_bf16 v[100:103], a[144:147], v[172:175], v[100:103]
  ds_read_b128 v[204:207], v19 offset:6144
  v_mfma_f32_16x16x32_bf16 v[104:107], a[148:151], v[172:175], v[104:107]
  v_mfma_f32_16x16x32_bf16 v[108:111], a[152:155], v[172:175], v[108:111]
  s_waitcnt vmcnt(8) lgkmcnt(2)
  s_barrier
  v_mfma_f32_16x16x32_bf16 v[64:67], a[156:159], v[192:195], v[64:67]
  ds_read_b128 v[160:163], v18 offset:0
  v_mfma_f32_16x16x32_bf16 v[68:71], a[160:163], v[192:195], v[68:71]
  v_mfma_f32_16x16x32_bf16 v[72:75], a[164:167], v[192:195], v[72:75]
  v_add_u32 v19, s33, v15
  s_add_u32 s33, s33, 8192
  v_mfma_f32_16x16x32_bf16 v[76:79], a[156:159], v[196:199], v[76:79]
  ds_read_b128 v[164:167], v18 offset:2048
  v_mfma_f32_16x16x32_bf16 v[80:83], a[160:163], v[196:199], v[80:83]
  buffer_load_dwordx4 v10, s[8:11], s30 offen offset:0 lds
  v_mfma_f32_16x16x32_bf16 v[84:87], a[164:167], v[196:199], v[84:87]
  s_waitcnt lgkmcnt(2)
  v_mfma_f32_16x16x32_bf16 v[88:91], a[156:159], v[200:203], v[88:91]
  ds_read_b128 v[168:171], v18 offset:4096
  v_mfma_f32_16x16x32_bf16 v[92:95], a[160:163], v[200:203], v[92:95]
  s_cmp_lt_u32 s33, 155648
  s_cselect_b32 s33, s33, 98304
  v_mfma_f32_16x16x32_bf16 v[96:99], a[164:167], v[200:203], v[96:99]
  v_mfma_f32_16x16x32_bf16 v[100:103], a[156:159], v[204:207], v[100:103]
  ds_read_b128 v[172:175], v18 offset:6144
  v_mfma_f32_16x16x32_bf16 v[104:107], a[160:163], v[204:207], v[104:107]
  v_mfma_f32_16x16x32_bf16 v[108:111], a[164:167], v[204:207], v[108:111]
  s_waitcnt lgkmcnt(2)
  v_mfma_f32_16x16x32_bf16 v[64:67], a[168:171], v[160:163], v[64:67]
  ds_read_b128 v[192:195], v19 offset:0
  v_mfma_f32_16x16x32_bf16 v[68:71], a[172:175], v[160:163], v[68:71]
  v_add_u32 v18, s33, v14
  v_mfma_f32_16x16x32_bf16 v[72:75], a[176:179], v[160:163], v[72:75]
  v_mfma_f32_16x16x32_bf16 v[76:79], a[168:171], v[164:167], v[76:79]
  ds_read_b128 v[196:199], v19 offset:2048
  v_mfma_f32_16x16x32_bf16 v[80:83], a[172:175], v[164:167], v[80:83]
  buffer_load_dwordx4 v11, s[8:11], s30 offen offset:1024 lds
  v_mfma_f32_16x16x32_bf16 v[84:87], a[176:179], v[164:167], v[84:87]
  s_waitcnt lgkmcnt(2)
  s_add_u32 s30, s30, 128
  v_mfma_f32_16x16x32_bf16 v[88:91], a[168:171], v[168:171], v[88:91]
  ds_read_b128 v[200:203], v19 offset:4096
  s_add_u32 m0, m0, 8192
  v_mfma_f32_16x16x32_bf16 v[92:95], a[172:175], v[168:171], v[92:95]
  s_cmp_lt_u32 m0, s46
  s_cselect_b32 m0, m0, s47
  v_mfma_f32_16x16x32_bf16 v[96:99], a[176:179], v[168:171], v[96:99]
  v_mfma_f32_16x16x32_bf16 v[100:103], a[168:171], v[172:175], v[100:103]
  ds_read_b128 v[204:207], v19 offset:6144
  v_mfma_f32_16x16x32_bf16 v[104:107], a[172:175], v[172:175], v[104:107]
  v_mfma_f32_16x16x32_bf16 v[108:111], a[176:179], v[172:175], v[108:111]
  s_waitcnt vmcnt(8) lgkmcnt(2)
  s_barrier
  v_mfma_f32_16x16x32_bf16 v[64:67], a[180:183], v[192:195], v[64:67]
  ds_read_b128 v[160:163], v18 offset:0
  v_mfma_f32_16x16x32_bf16 v[68:71], a[184:187], v[192:195], v[68:71]
  v_mfma_f32_16x16x32_bf16 v[72:75], a[188:191], v[192:195], v[72:75]
  v_add_u32 v19, s33, v15
  s_add_u32 s33, s33, 8192
  v_mfma_f32_16x16x32_bf16 v[76:79], a[180:183], v[196:199], v[76:79]
  ds_read_b128 v[164:167], v18 offset:2048
  v_mfma_f32_16x16x32_bf16 v[80:83], a[184:187], v[196:199], v[80:83]
  buffer_load_dwordx4 v10, s[8:11], s30 offen offset:0 lds
  v_mfma_f32_16x16x32_bf16 v[84:87], a[188:191], v[196:199], v[84:87]
  s_waitcnt lgkmcnt(2)
  v_mfma_f32_16x16x32_bf16 v[88:91], a[180:183], v[200:203], v[88:91]
  ds_read_b128 v[168:171], v18 offset:4096
  v_mfma_f32_16x16x32_bf16 v[92:95], a[184:187], v[200:203], v[92:95]
  s_cmp_lt_u32 s33, 155648
  s_cselect_b32 s33, s33, 98304
  v_mfma_f32_16x16x32_bf16 v[96:99], a[188:191], v[200:203], v[96:99]
  v_mfma_f32_16x16x32_bf16 v[100:103], a[180:183], v[204:207], v[100:103]
  ds_read_b128 v[172:175], v18 offset:6144
  v_mfma_f32_16x16x32_bf16 v[104:107], a[184:187], v[204:207], v[104:107]
  v_mfma_f32_16x16x32_bf16 v[108:111], a[188:191], v[204:207], v[108:111]
  s_waitcnt lgkmcnt(2)
  v_mfma_f32_16x16x32_bf16 v[64:67], a[192:195], v[160:163], v[64:67]
  ds_read_b128 v[192:195], v19 offset:0
  v_mfma_f32_16x16x32_bf16 v[68:71], a[196:199], v[160:163], v[68:71]
  v_add_u32 v18, s33, v14
  v_mfma_f32_16x16x32_bf16 v[72:75], a[200:203], v[160:163], v[72:75]
  v_mfma_f32_16x16x32_bf16 v[76:79], a[192:195], v[164:167], v[76:79]
  ds_read_b128 v[196:199], v19 offset:2048
  v_mfma_f32_16x16x32_bf16 v[80:83], a[196:199], v[164:167], v[80:83]
  buffer_load_dwordx4 v11, s[8:11], s30 offen offset:1024 lds
  v_mfma_f32_16x16x32_bf16 v[84:87], a[200:203], v[164:167], v[84:87]
  s_waitcnt lgkmcnt(2)
  s_add_u32 s30, s30, 128
  v_mfma_f32_16x16x32_bf16 v[88:91], a[192:195], v[168:171], v[88:91]
  ds_read_b128 v[200:203], v19 offset:4096
  s_add_u32 m0, m0, 8192
  v_mfma_f32_16x16x32_bf16 v[92:95], a[196:199], v[168:171], v[92:95]
  s_cmp_lt_u32 m0, s46
  s_cselect_b32 m0, m0, s47
  v_mfma_f32_16x16x32_bf16 v[96:99], a[200:203], v[168:171], v[96:99]
  v_mfma_f32_16x16x32_bf16 v[100:103], a[192:195], v[172:175], v[100:103]
  ds_read_b128 v[204:207], v19 offset:6144
  v_mfma_f32_16x16x32_bf16 v[104:107], a[196:199], v[172:175], v[104:107]
  v_mfma_f32_16x16x32_bf16 v[108:111], a[200:203], v[172:175], v[108:111]
  s_waitcnt vmcnt(8) lgkmcnt(2)
  s_barrier
  v_mfma_f32_16x16x32_bf16 v[64:67], a[204:207], v[192:195], v[64:67]
  ds_read_b128 v[160:163], v18 offset:0
  v_mfma_f32_16x16x32_bf16 v[68:71], a[208:211], v[192:195], v[68:71]
  v_mfma_f32_16x16x32_bf16 v[72:75], a[212:215], v[192:195], v[72:75]
  v_add_u32 v19, s33, v15
  s_add_u32 s33, s33, 8192
  v_mfma_f32_16x16x32_bf16 v[76:79], a[204:207], v[196:199], v[76:79]
  ds_read_b128 v[164:167], v18 offset:2048
  v_mfma_f32_16x16x32_bf16 v[80:83], a[208:211], v[196:199], v[80:83]
  buffer_load_dwordx4 v10, s[8:11], s30 offen offset:0 lds
  v_mfma_f32_16x16x32_bf16 v[84:87], a[212:215], v[196:199], v[84:87]
  s_waitcnt lgkmcnt(2)
  v_mfma_f32_16x16x32_bf16 v[88:91], a[204:207], v[200:203], v[88:91]
  ds_read_b128 v[168:171], v18 offset:4096
  v_mfma_f32_16x16x32_bf16 v[92:95], a[208:211], v[200:203], v[92:95]
  s_cmp_lt_u32 s33, 155648
  s_cselect_b32 s33, s33, 98304
  v_mfma_f32_16x16x32_bf16 v[96:99], a[212:215], v[200:203], v[96:99]
  v_mfma_f32_16x16x32_bf16 v[100:103], a[204:207], v[204:207], v[100:103]
  ds_read_b128 v[172:175], v18 offset:6144
  v_mfma_f32_16x16x32_bf16 v[104:107], a[208:211], v[204:207], v[104:107]
  v_mfma_f32_16x16x32_bf16 v[108:111], a[212:215], v[204:207], v[108:111]
  s_waitcnt lgkmcnt(2)
  v_mfma_f32_16x16x32_bf16 v[64:67], a[216:219], v[160:163], v[64:67]
  ds_read_b128 v[192:195], v19 offset:0
  v_mfma_f32_16x16x32_bf16 v[68:71], a[220:223], v[160:163], v[68:71]
  v_add_u32 v18, s33, v14
  v_mfma_f32_16x16x32_bf16 v[72:75], a[224:227], v[160:163], v[72:75]
  v_mfma_f32_16x16x32_bf16 v[76:79], a[216:219], v[164:167], v[76:79]
  ds_read_b128 v[196:199], v19 offset:2048
  v_mfma_f32_16x16x32_bf16 v[80:83], a[220:223], v[164:167], v[80:83]
  buffer_load_dwordx4 v11, s[8:11], s30 offen offset:1024 lds
  v_mfma_f32_16x16x32_bf16 v[84:87], a[224:227], v[164:167], v[84:87]
  s_waitcnt lgkmcnt(2)
  s_add_u32 s30, s30, 128
  v_mfma_f32_16x16x32_bf16 v[88:91], a[216:219], v[168:171], v[88:91]
  ds_read_b128 v[200:203], v19 offset:4096
  s_add_u32 m0, m0, 8192
  v_mfma_f32_16x16x32_bf16 v[92:95], a[220:223], v[168:171], v[92:95]
  s_cmp_lt_u32 m0, s46
  s_cselect_b32 m0, m0, s47
  v_mfma_f32_16x16x32_bf16 v[96:99], a[224:227], v[168:171], v[96:99]
  v_mfma_f32_16x16x32_bf16 v[100:103], a[216:219], v[172:175], v[100:103]
  ds_read_b128 v[204:207], v19 offset:6144
  v_mfma_f32_16x16x32_bf16 v[104:107], a[220:223], v[172:175], v[104:107]
  v_mfma_f32_16x16x32_bf16 v[108:111], a[224:227], v[172:175], v[108:111]
  s_waitcnt vmcnt(8) lgkmcnt(2)
  s_barrier
  v_mfma_f32_16x16x32_bf16 v[64:67], a[228:231], v[192:195], v[64:67]
  ds_read_b128 v[160:163], v18 offset:0
  v_mfma_f32_16x16x32_bf16 v[68:71], a[232:235], v[192:195], v[68:71]
  v_mfma_f32_16x16x32_bf16 v[72:75], a[236:239], v[192:195], v[72:75]
  v_add_u32 v19, s33, v15
  s_add_u32 s33, s33, 8192
  v_mfma_f32_16x16x32_bf16 v[76:79], a[228:231], v[196:199], v[76:79]
  ds_read_b128 v[164:167], v18 offset:2048
  v_cvt_pk_bf16_f32 v224, v64, v65
  v_cvt_pk_bf16_f32 v225, v66, v67
  v_mfma_f32_16x16x32_bf16 v[80:83], a[232:235], v[196:199], v[80:83]
  buffer_load_dwordx4 v10, s[8:11], s30 offen offset:0 lds
  v_cvt_pk_bf16_f32 v226, v68, v69
  v_cvt_pk_bf16_f32 v227, v70, v71
  v_mfma_f32_16x16x32_bf16 v[84:87], a[236:239], v[196:199], v[84:87]
  s_waitcnt lgkmcnt(2)
  v_cvt_pk_bf16_f32 v228, v72, v73
  v_cvt_pk_bf16_f32 v229, v74, v75
  v_mfma_f32_16x16x32_bf16 v[88:91], a[228:231], v[200:203], v[88:91]
  ds_read_b128 v[168:171], v18 offset:4096
  ds_write_b64 v22, v[224:225] offset:0
  v_mfma_f32_16x16x32_bf16 v[92:95], a[232:235], v[200:203], v[92:95]
  s_cmp_lt_u32 s33, 155648
  s_cselect_b32 s33, s33, 98304
  ds_write_b64 v22, v[226:227] offset:8
  v_mfma_f32_16x16x32_bf16 v[96:99], a[236:239], v[200:203], v[96:99]
  ds_write_b64 v16, v[228:229] offset:64
  v_cvt_pk_bf16_f32 v230, v76, v77
  v_cvt_pk_bf16_f32 v231, v78, v79
  v_mfma_f32_16x16x32_bf16 v[100:103], a[228:231], v[204:207], v[100:103]
  ds_read_b128 v[172:175], v18 offset:6144
  v_cvt_pk_bf16_f32 v232, v80, v81
  v_cvt_pk_bf16_f32 v233, v82, v83
  v_cvt_pk_bf16_f32 v234, v84, v85
  v_mfma_f32_16x16x32_bf16 v[104:107], a[232:235], v[204:207], v[104:107]
  v_cvt_pk_bf16_f32 v235, v86, v87
  ds_write_b64 v22, v[230:231] offset:6400
  v_mfma_f32_16x16x32_bf16 v[108:111], a[236:239], v[204:207], v[108:111]
  ds_write_b64 v22, v[232:233] offset:6408
  ds_write_b64 v16, v[234:235] offset:6464
kvm_end_150:
  v_cvt_pk_bf16_f32 v236, v88, v89
  v_cvt_pk_bf16_f32 v237, v90, v91
  v_cvt_pk_bf16_f32 v238, v92, v93
  v_cvt_pk_bf16_f32 v239, v94, v95
  v_cvt_pk_bf16_f32 v240, v96, v97
  v_cvt_pk_bf16_f32 v241, v98, v99
  ds_write_b64 v22, v[236:237] offset:12800
  ds_write_b64 v22, v[238:239] offset:12808
  ds_write_b64 v16, v[240:241] offset:12864
  v_cvt_pk_bf16_f32 v242, v100, v101
  v_cvt_pk_bf16_f32 v243, v102, v103
  v_cvt_pk_bf16_f32 v244, v104, v105
  v_cvt_pk_bf16_f32 v245, v106, v107
  v_cvt_pk_bf16_f32 v246, v108, v109
  v_cvt_pk_bf16_f32 v247, v110, v111
  ds_write_b64 v22, v[242:243] offset:19200
  ds_write_b64 v22, v[244:245] offset:19208
  ds_write_b64 v16, v[246:247] offset:19264
  s_waitcnt lgkmcnt(0)
  s_barrier
  ds_read_b128 v[224:227], v23 offset:0
  ds_read_b128 v[228:231], v23 offset:64
  ds_read_b128 v[232:235], v23 offset:128
  ds_read_b128 v[236:239], v23 offset:192
  ds_read_b128 v[240:243], v23 offset:256
  ds_read_b128 v[244:247], v23 offset:320
  s_waitcnt lgkmcnt(0)
  s_add_u32 s21, s48, 0
  buffer_store_dwordx4 v[224:227], v26, s[16:19], s21 offen offset:0 sc1
  buffer_store_dwordx4 v[228:231], v26, s[16:19], s21 offen offset:1024 sc1
  buffer_store_dwordx4 v[232:235], v26, s[16:19], s21 offen offset:2048 sc1
  buffer_store_dwordx4 v[236:239], v26, s[16:19], s21 offen offset:3072 sc1
  s_add_u32 s21, s48, 4096
  buffer_store_dwordx4 v[240:243], v26, s[16:19], s21 offen offset:0 sc1
  buffer_store_dwordx4 v[244:247], v26, s[16:19], s21 offen offset:1024 sc1
  s_nop 1
  s_cmp_gt_u32 s26, 0
  s_cbranch_scc1 kvm_blk_149
  s_waitcnt vmcnt(6)
  s_barrier
  s_mov_b32 s24, 491520
  s_mov_b32 s25, 163840
  v_lshrrev_b32 v11, 3, v1
  v_and_b32 v12, 7, v1
  v_xor_b32 v12, v12, v11
  v_mul_u32_u24 v11, 1280, v11
  v_lshl_add_u32 v10, v12, 4, v11
  s_mul_i32 s46, s20, 40960
  v_add_u32 v10, s46, v10
  s_lshl_b32 s47, s20, 12
  s_add_u32 s47, s47, 0
  s_add_u32 s46, s47, 98304
  s_mov_b32 s30, s24
  s_add_u32 s32, s47, 32768
  v_add_u32 v11, 9216, v10
  v_add_u32 v12, 18432, v10
  v_add_u32 v13, 27648, v10
  s_mov_b32 m0, s32
  s_nop 0
  buffer_load_dwordx4 v10, s[8:11], s30 offen offset:0 lds
  buffer_load_dwordx4 v11, s[8:11], s30 offen offset:1024 lds
  buffer_load_dwordx4 v12, s[8:11], s30 offen offset:2048 lds
  buffer_load_dwordx4 v13, s[8:11], s30 offen offset:3072 lds
  s_add_u32 s30, s30, 128
  s_add_u32 s32, s32, 16384
  s_cmp_lt_u32 s32, s46
  s_cselect_b32 s32, s32, s47
  s_mov_b32 m0, s32
  s_nop 0
  buffer_load_dwordx4 v10, s[8:11], s30 offen offset:0 lds
  buffer_load_dwordx4 v11, s[8:11], s30 offen offset:1024 lds
  buffer_load_dwordx4 v12, s[8:11], s30 offen offset:2048 lds
  buffer_load_dwordx4 v13, s[8:11], s30 offen offset:3072 lds
  s_add_u32 s30, s30, 128
  s_add_u32 s32, s32, 16384
  s_cmp_lt_u32 s32, s46
  s_cselect_b32 s32, s32, s47
  s_mov_b32 m0, s32
  s_nop 0
  buffer_load_dwordx4 v10, s[8:11], s30 offen offset:0 lds
  buffer_load_dwordx4 v11, s[8:11], s30 offen offset:1024 lds
  buffer_load_dwordx4 v12, s[8:11], s30 offen offset:2048 lds
  buffer_load_dwordx4 v13, s[8:11], s30 offen offset:3072 lds
  s_add_u32 s30, s30, 128
  s_add_u32 s32, s32, 16384
  s_cmp_lt_u32 s32, s46
  s_cselect_b32 s32, s32, s47
  s_mov_b32 m0, s32
  s_nop 0
  buffer_load_dwordx4 v10, s[8:11], s30 offen offset:0 lds
  buffer_load_dwordx4 v11, s[8:11], s30 offen offset:1024 lds
  buffer_load_dwordx4 v12, s[8:11], s30 offen offset:2048 lds
  buffer_load_dwordx4 v13, s[8:11], s30 offen offset:3072 lds
  s_add_u32 s30, s30, 128
  s_add_u32 s32, s32, 16384
  s_cmp_lt_u32 s32, s46
  s_cselect_b32 s32, s32, s47
  s_waitcnt vmcnt(16)
  s_barrier
  s_cmp_lg_u32 s20, 0
  s_cbranch_scc1 af_154
  v_mov_b32 v4, 0
  v_mov_b32 v5, 1
  s_mov_b64 exec, 1
  buffer_atomic_add v5, v4, s[72:75], s61 offen sc1
  s_mov_b64 exec, -1
  s_nop 1
af_154:
  s_mov_b32 s26, 13
  s_mov_b32 s28, 1572864
kv_main:
  v_and_b32 v6, 7, v2
  v_add_u32 v4, 0, v3
  v_xor_b32 v4, v4, v6
  v_lshlrev_b32 v4, 4, v4
  v_lshl_add_u32 v14, v2, 7, v4
  v_add_u32 v4, 4, v3
  v_xor_b32 v4, v4, v6
  v_lshlrev_b32 v4, 4, v4
  v_lshl_add_u32 v15, v2, 7, v4
  v_mul_u32_u24 v22, 400, v2
  v_mul_u32_u24 v4, 16, v3
  s_mul_i32 s21, s20, 96
  s_add_u32 s21, s21, 98304
  v_add3_u32 v22, v22, v4, s21
  v_lshlrev_b32 v4, 3, v3
  v_sub_u32 v16, v22, v4
  v_mov_b32 v9, 2731
  s_mul_i32 s21, s20, 12800
  s_add_u32 s21, s21, 98304
  v_mul_u32_u24 v4, 400, v2
  v_lshlrev_b32 v5, 4, v3
  v_add3_u32 v23, v4, v5, s21
  v_lshlrev_b32 v26, 4, v1
  s_mov_b32 s33, 32768
  s_mov_b32 s48, 0x80000000
  s_mov_b32 m0, s32
  s_nop 0
  buffer_load_dwordx4 v10, s[8:11], s30 offen offset:0 lds
  buffer_load_dwordx4 v11, s[8:11], s30 offen offset:1024 lds
  s_waitcnt vmcnt(14)
  s_barrier
  v_add_u32 v18, s33, v14
  v_add_u32 v19, s33, v15
  s_add_u32 s33, s33, 16384
  s_cmp_lt_u32 s33, 98304
  s_cselect_b32 s33, s33, 0
  ds_read_b128 v[160:163], v18 offset:0
  ds_read_b128 v[164:167], v18 offset:2048
  ds_read_b128 v[168:171], v18 offset:4096
  ds_read_b128 v[172:175], v18 offset:6144
  ds_read_b128 v[176:179], v18 offset:8192
  ds_read_b128 v[180:183], v18 offset:10240
  ds_read_b128 v[184:187], v18 offset:12288
  ds_read_b128 v[188:191], v18 offset:14336
  s_waitcnt lgkmcnt(0)
kv_blk_157:
  v_mfma_f32_16x16x32_bf16 v[64:67], a[0:3], v[160:163], 0
  ds_read_b128 v[192:195], v19 offset:0
  v_mfma_f32_16x16x32_bf16 v[68:71], a[4:7], v[160:163], 0
  v_add_u32 v18, s33, v14
  v_mfma_f32_16x16x32_bf16 v[72:75], a[8:11], v[160:163], 0
  ds_write_b64 v16, v[234:235] offset:6464
  v_mfma_f32_16x16x32_bf16 v[76:79], a[0:3], v[164:167], 0
  ds_read_b128 v[196:199], v19 offset:2048
  v_cvt_pk_bf16_f32 v236, v88, v89
  v_mfma_f32_16x16x32_bf16 v[80:83], a[4:7], v[164:167], 0
  buffer_load_dwordx4 v12, s[8:11], s30 offen offset:2048 lds
  v_mfma_f32_16x16x32_bf16 v[84:87], a[8:11], v[164:167], 0
  v_cvt_pk_bf16_f32 v237, v90, v91
  v_cvt_pk_bf16_f32 v238, v92, v93
  v_mfma_f32_16x16x32_bf16 v[88:91], a[0:3], v[168:171], 0
  ds_read_b128 v[200:203], v19 offset:4096
  v_cvt_pk_bf16_f32 v239, v94, v95
  v_mfma_f32_16x16x32_bf16 v[92:95], a[4:7], v[168:171], 0
  v_cvt_pk_bf16_f32 v240, v96, v97
  v_cvt_pk_bf16_f32 v241, v98, v99
  v_mfma_f32_16x16x32_bf16 v[96:99], a[8:11], v[168:171], 0
  ds_write_b64 v22, v[236:237] offset:12800
  ds_write_b64 v22, v[238:239] offset:12808
  ds_write_b64 v16, v[240:241] offset:12864
  v_cvt_pk_bf16_f32 v242, v100, v101
  v_cvt_pk_bf16_f32 v243, v102, v103
  v_mfma_f32_16x16x32_bf16 v[100:103], a[0:3], v[172:175], 0
  ds_read_b128 v[204:207], v19 offset:6144
  v_cvt_pk_bf16_f32 v244, v104, v105
  v_cvt_pk_bf16_f32 v245, v106, v107
  v_mfma_f32_16x16x32_bf16 v[104:107], a[4:7], v[172:175], 0
  v_cvt_pk_bf16_f32 v246, v108, v109
  v_cvt_pk_bf16_f32 v247, v110, v111
  v_mfma_f32_16x16x32_bf16 v[108:111], a[8:11], v[172:175], 0
  s_waitcnt lgkmcnt(9)
  ds_write_b64 v22, v[242:243] offset:19200
  ds_write_b64 v22, v[244:245] offset:19208
  ds_write_b64 v16, v[246:247] offset:19264
  v_cvt_pk_bf16_f32 v224, v112, v113
  v_cvt_pk_bf16_f32 v225, v114, v115
  v_mfma_f32_16x16x32_bf16 v[112:115], a[0:3], v[176:179], 0
  ds_read_b128 v[208:211], v19 offset:8192
  v_cvt_pk_bf16_f32 v226, v116, v117
  v_cvt_pk_bf16_f32 v227, v118, v119
  v_mfma_f32_16x16x32_bf16 v[116:119], a[4:7], v[176:179], 0
  v_cvt_pk_bf16_f32 v228, v120, v121
  v_cvt_pk_bf16_f32 v229, v122, v123
  v_mfma_f32_16x16x32_bf16 v[120:123], a[8:11], v[176:179], 0
  ds_write_b64 v22, v[224:225] offset:25600
  ds_write_b64 v22, v[226:227] offset:25608
  ds_write_b64 v16, v[228:229] offset:25664
  v_cvt_pk_bf16_f32 v230, v124, v125
  v_cvt_pk_bf16_f32 v231, v126, v127
  v_mfma_f32_16x16x32_bf16 v[124:127], a[0:3], v[180:183], 0
  ds_read_b128 v[212:215], v19 offset:10240
  v_cvt_pk_bf16_f32 v232, v128, v129
  v_cvt_pk_bf16_f32 v233, v130, v131
  v_mfma_f32_16x16x32_bf16 v[128:131], a[4:7], v[180:183], 0
  buffer_load_dwordx4 v13, s[8:11], s30 offen offset:3072 lds
  v_cvt_pk_bf16_f32 v234, v132, v133
  v_cvt_pk_bf16_f32 v235, v134, v135
  v_mfma_f32_16x16x32_bf16 v[132:135], a[8:11], v[180:183], 0
  s_add_u32 s30, s30, 128
  s_add_u32 m0, m0, 16384
  ds_write_b64 v22, v[230:231] offset:32000
  ds_write_b64 v22, v[232:233] offset:32008
  ds_write_b64 v16, v[234:235] offset:32064
  v_cvt_pk_bf16_f32 v236, v136, v137
  v_cvt_pk_bf16_f32 v237, v138, v139
  v_mfma_f32_16x16x32_bf16 v[136:139], a[0:3], v[184:187], 0
  ds_read_b128 v[216:219], v19 offset:12288
  v_cvt_pk_bf16_f32 v238, v140, v141
  v_cvt_pk_bf16_f32 v239, v142, v143
  v_mfma_f32_16x16x32_bf16 v[140:143], a[4:7], v[184:187], 0
  s_cmp_lt_u32 m0, s46
  s_cselect_b32 m0, m0, s47
  v_cvt_pk_bf16_f32 v240, v144, v145
  v_cvt_pk_bf16_f32 v241, v146, v147
  v_mfma_f32_16x16x32_bf16 v[144:147], a[8:11], v[184:187], 0
  ds_write_b64 v22, v[236:237] offset:38400
  ds_write_b64 v22, v[238:239] offset:38408
  ds_write_b64 v16, v[240:241] offset:38464
  v_cvt_pk_bf16_f32 v242, v148, v149
  v_cvt_pk_bf16_f32 v243, v150, v151
  v_mfma_f32_16x16x32_bf16 v[148:151], a[0:3], v[188:191], 0
  ds_read_b128 v[220:223], v19 offset:14336
  v_cvt_pk_bf16_f32 v244, v152, v153
  v_cvt_pk_bf16_f32 v245, v154, v155
  v_mfma_f32_16x16x32_bf16 v[152:155], a[4:7], v[188:191], 0
  v_cvt_pk_bf16_f32 v246, v156, v157
  v_cvt_pk_bf16_f32 v247, v158, v159
  v_mfma_f32_16x16x32_bf16 v[156:159], a[8:11], v[188:191], 0
  s_waitcnt vmcnt(12) lgkmcnt(15)
  s_barrier
  v_mfma_f32_16x16x32_bf16 v[64:67], a[12:15], v[192:195], v[64:67]
  ds_read_b128 v[160:163], v18 offset:0
  v_mfma_f32_16x16x32_bf16 v[68:71], a[16:19], v[192:195], v[68:71]
  ds_write_b64 v22, v[242:243] offset:44800
  v_mfma_f32_16x16x32_bf16 v[72:75], a[20:23], v[192:195], v[72:75]
  v_add_u32 v19, s33, v15
  s_add_u32 s33, s33, 16384
  v_mfma_f32_16x16x32_bf16 v[76:79], a[12:15], v[196:199], v[76:79]
  ds_read_b128 v[164:167], v18 offset:2048
  v_mfma_f32_16x16x32_bf16 v[80:83], a[16:19], v[196:199], v[80:83]
  buffer_load_dwordx4 v10, s[8:11], s30 offen offset:0 lds
  v_mfma_f32_16x16x32_bf16 v[84:87], a[20:23], v[196:199], v[84:87]
  s_cmp_lt_u32 s33, 98304
  s_cselect_b32 s33, s33, 0
  v_mfma_f32_16x16x32_bf16 v[88:91], a[12:15], v[200:203], v[88:91]
  ds_read_b128 v[168:171], v18 offset:4096
  v_mfma_f32_16x16x32_bf16 v[92:95], a[16:19], v[200:203], v[92:95]
  ds_write_b64 v22, v[244:245] offset:44808
  v_mfma_f32_16x16x32_bf16 v[96:99], a[20:23], v[200:203], v[96:99]
  ds_write_b64 v16, v[246:247] offset:44864
  v_mfma_f32_16x16x32_bf16 v[100:103], a[12:15], v[204:207], v[100:103]
  ds_read_b128 v[172:175], v18 offset:6144
  v_mfma_f32_16x16x32_bf16 v[104:107], a[16:19], v[204:207], v[104:107]
  v_mfma_f32_16x16x32_bf16 v[108:111], a[20:23], v[204:207], v[108:111]
  s_waitcnt lgkmcnt(7)
  v_mfma_f32_16x16x32_bf16 v[112:115], a[12:15], v[208:211], v[112:115]
  ds_read_b128 v[176:179], v18 offset:8192
  v_mfma_f32_16x16x32_bf16 v[116:119], a[16:19], v[208:211], v[116:119]
  v_mfma_f32_16x16x32_bf16 v[120:123], a[20:23], v[208:211], v[120:123]
  v_mfma_f32_16x16x32_bf16 v[124:127], a[12:15], v[212:215], v[124:127]
  ds_read_b128 v[180:183], v18 offset:10240
  v_mfma_f32_16x16x32_bf16 v[128:131], a[16:19], v[212:215], v[128:131]
  buffer_load_dwordx4 v11, s[8:11], s30 offen offset:1024 lds
  v_mfma_f32_16x16x32_bf16 v[132:135], a[20:23], v[212:215], v[132:135]
  v_mfma_f32_16x16x32_bf16 v[136:139], a[12:15], v[216:219], v[136:139]
  ds_read_b128 v[184:187], v18 offset:12288
  v_mfma_f32_16x16x32_bf16 v[140:143], a[16:19], v[216:219], v[140:143]
  v_mfma_f32_16x16x32_bf16 v[144:147], a[20:23], v[216:219], v[144:147]
  v_mfma_f32_16x16x32_bf16 v[148:151], a[12:15], v[220:223], v[148:151]
  ds_read_b128 v[188:191], v18 offset:14336
  v_mfma_f32_16x16x32_bf16 v[152:155], a[16:19], v[220:223], v[152:155]
  v_mfma_f32_16x16x32_bf16 v[156:159], a[20:23], v[220:223], v[156:159]
  s_waitcnt lgkmcnt(4)
  v_mfma_f32_16x16x32_bf16 v[64:67], a[24:27], v[160:163], v[64:67]
  ds_read_b128 v[192:195], v19 offset:0
  v_mfma_f32_16x16x32_bf16 v[68:71], a[28:31], v[160:163], v[68:71]
  v_add_u32 v18, s33, v14
  v_mfma_f32_16x16x32_bf16 v[72:75], a[32:35], v[160:163], v[72:75]
  v_mfma_f32_16x16x32_bf16 v[76:79], a[24:27], v[164:167], v[76:79]
  ds_read_b128 v[196:199], v19 offset:2048
  v_mfma_f32_16x16x32_bf16 v[80:83], a[28:31], v[164:167], v[80:83]
  buffer_load_dwordx4 v12, s[8:11], s30 offen offset:2048 lds
  v_mfma_f32_16x16x32_bf16 v[84:87], a[32:35], v[164:167], v[84:87]
  v_mfma_f32_16x16x32_bf16 v[88:91], a[24:27], v[168:171], v[88:91]
  ds_read_b128 v[200:203], v19 offset:4096
  v_mfma_f32_16x16x32_bf16 v[92:95], a[28:31], v[168:171], v[92:95]
  v_mfma_f32_16x16x32_bf16 v[96:99], a[32:35], v[168:171], v[96:99]
  v_mfma_f32_16x16x32_bf16 v[100:103], a[24:27], v[172:175], v[100:103]
  ds_read_b128 v[204:207], v19 offset:6144
  v_mfma_f32_16x16x32_bf16 v[104:107], a[28:31], v[172:175], v[104:107]
  v_mfma_f32_16x16x32_bf16 v[108:111], a[32:35], v[172:175], v[108:111]
  s_waitcnt lgkmcnt(4)
  v_mfma_f32_16x16x32_bf16 v[112:115], a[24:27], v[176:179], v[112:115]
  ds_read_b128 v[208:211], v19 offset:8192
  v_mfma_f32_16x16x32_bf16 v[116:119], a[28:31], v[176:179], v[116:119]
  v_mfma_f32_16x16x32_bf16 v[120:123], a[32:35], v[176:179], v[120:123]
  v_mfma_f32_16x16x32_bf16 v[124:127], a[24:27], v[180:183], v[124:127]
  ds_read_b128 v[212:215], v19 offset:10240
  v_mfma_f32_16x16x32_bf16 v[128:131], a[28:31], v[180:183], v[128:131]
  buffer_load_dwordx4 v13, s[8:11], s30 offen offset:3072 lds
  v_mfma_f32_16x16x32_bf16 v[132:135], a[32:35], v[180:183], v[132:135]
  s_add_u32 s30, s30, 128
  s_add_u32 m0, m0, 16384
  v_mfma_f32_16x16x32_bf16 v[136:139], a[24:27], v[184:187], v[136:139]
  ds_read_b128 v[216:219], v19 offset:12288
  v_mfma_f32_16x16x32_bf16 v[140:143], a[28:31], v[184:187], v[140:143]
  s_cmp_lt_u32 m0, s46
  s_cselect_b32 m0, m0, s47
  v_mfma_f32_16x16x32_bf16 v[144:147], a[32:35], v[184:187], v[144:147]
  v_mfma_f32_16x16x32_bf16 v[148:151], a[24:27], v[188:191], v[148:151]
  ds_read_b128 v[220:223], v19 offset:14336
  v_mfma_f32_16x16x32_bf16 v[152:155], a[28:31], v[188:191], v[152:155]
  v_mfma_f32_16x16x32_bf16 v[156:159], a[32:35], v[188:191], v[156:159]
  s_waitcnt vmcnt(12) lgkmcnt(4)
  s_barrier
  v_mfma_f32_16x16x32_bf16 v[64:67], a[36:39], v[192:195], v[64:67]
  ds_read_b128 v[160:163], v18 offset:0
  v_mfma_f32_16x16x32_bf16 v[68:71], a[40:43], v[192:195], v[68:71]
  v_mfma_f32_16x16x32_bf16 v[72:75], a[44:47], v[192:195], v[72:75]
  v_add_u32 v19, s33, v15
  s_add_u32 s33, s33, 16384
  v_mfma_f32_16x16x32_bf16 v[76:79], a[36:39], v[196:199], v[76:79]
  ds_read_b128 v[164:167], v18 offset:2048
  v_mfma_f32_16x16x32_bf16 v[80:83], a[40:43], v[196:199], v[80:83]
  buffer_load_dwordx4 v10, s[8:11], s30 offen offset:0 lds
  v_mfma_f32_16x16x32_bf16 v[84:87], a[44:47], v[196:199], v[84:87]
  s_cmp_lt_u32 s33, 98304
  s_cselect_b32 s33, s33, 0
  v_mfma_f32_16x16x32_bf16 v[88:91], a[36:39], v[200:203], v[88:91]
  ds_read_b128 v[168:171], v18 offset:4096
  v_mfma_f32_16x16x32_bf16 v[92:95], a[40:43], v[200:203], v[92:95]
  ds_read_b128 v[224:227], v23 offset:0
  v_mfma_f32_16x16x32_bf16 v[96:99], a[44:47], v[200:203], v[96:99]
  v_mfma_f32_16x16x32_bf16 v[100:103], a[36:39], v[204:207], v[100:103]
  ds_read_b128 v[172:175], v18 offset:6144
  v_mfma_f32_16x16x32_bf16 v[104:107], a[40:43], v[204:207], v[104:107]
  v_mfma_f32_16x16x32_bf16 v[108:111], a[44:47], v[204:207], v[108:111]
  s_waitcnt lgkmcnt(5)
  v_mfma_f32_16x16x32_bf16 v[112:115], a[36:39], v[208:211], v[112:115]
  ds_read_b128 v[176:179], v18 offset:8192
  v_mfma_f32_16x16x32_bf16 v[116:119], a[40:43], v[208:211], v[116:119]
  v_mfma_f32_16x16x32_bf16 v[120:123], a[44:47], v[208:211], v[120:123]
  v_mfma_f32_16x16x32_bf16 v[124:127], a[36:39], v[212:215], v[124:127]
  ds_read_b128 v[180:183], v18 offset:10240
  v_mfma_f32_16x16x32_bf16 v[128:131], a[40:43], v[212:215], v[128:131]
  buffer_load_dwordx4 v11, s[8:11], s30 offen offset:1024 lds
  v_mfma_f32_16x16x32_bf16 v[132:135], a[44:47], v[212:215], v[132:135]
  v_mfma_f32_16x16x32_bf16 v[136:139], a[36:39], v[216:219], v[136:139]
  ds_read_b128 v[184:187], v18 offset:12288
  v_mfma_f32_16x16x32_bf16 v[140:143], a[40:43], v[216:219], v[140:143]
  ds_read_b128 v[228:231], v23 offset:64
  v_mfma_f32_16x16x32_bf16 v[144:147], a[44:47], v[216:219], v[144:147]
  v_mfma_f32_16x16x32_bf16 v[148:151], a[36:39], v[220:223], v[148:151]
  ds_read_b128 v[188:191], v18 offset:14336
  v_mfma_f32_16x16x32_bf16 v[152:155], a[40:43], v[220:223], v[152:155]
  v_mfma_f32_16x16x32_bf16 v[156:159], a[44:47], v[220:223], v[156:159]
  s_waitcnt lgkmcnt(5)
  v_mfma_f32_16x16x32_bf16 v[64:67], a[48:51], v[160:163], v[64:67]
  ds_read_b128 v[192:195], v19 offset:0
  v_mfma_f32_16x16x32_bf16 v[68:71], a[52:55], v[160:163], v[68:71]
  v_add_u32 v18, s33, v14
  v_mfma_f32_16x16x32_bf16 v[72:75], a[56:59], v[160:163], v[72:75]
  v_mfma_f32_16x16x32_bf16 v[76:79], a[48:51], v[164:167], v[76:79]
  ds_read_b128 v[196:199], v19 offset:2048
  v_mfma_f32_16x16x32_bf16 v[80:83], a[52:55], v[164:167], v[80:83]
  buffer_load_dwordx4 v12, s[8:11], s30 offen offset:2048 lds
  v_mfma_f32_16x16x32_bf16 v[84:87], a[56:59], v[164:167], v[84:87]
  v_mfma_f32_16x16x32_bf16 v[88:91], a[48:51], v[168:171], v[88:91]
  ds_read_b128 v[200:203], v19 offset:4096
  v_mfma_f32_16x16x32_bf16 v[92:95], a[52:55], v[168:171], v[92:95]
  s_add_u32 s21, s48, 0
  ds_read_b128 v[232:235], v23 offset:128
  v_mfma_f32_16x16x32_bf16 v[96:99], a[56:59], v[168:171], v[96:99]
  v_mfma_f32_16x16x32_bf16 v[100:103], a[48:51], v[172:175], v[100:103]
  ds_read_b128 v[204:207], v19 offset:6144
  v_mfma_f32_16x16x32_bf16 v[104:107], a[52:55], v[172:175], v[104:107]
  buffer_store_dwordx4 v[224:227], v26, s[16:19], s21 offen offset:0 sc1
  v_mfma_f32_16x16x32_bf16 v[108:111], a[56:59], v[172:175], v[108:111]
  s_waitcnt lgkmcnt(5)
  v_mfma_f32_16x16x32_bf16 v[112:115], a[48:51], v[176:179], v[112:115]
  ds_read_b128 v[208:211], v19 offset:8192
  v_mfma_f32_16x16x32_bf16 v[116:119], a[52:55], v[176:179], v[116:119]
  v_mfma_f32_16x16x32_bf16 v[120:123], a[56:59], v[176:179], v[120:123]
  v_mfma_f32_16x16x32_bf16 v[124:127], a[48:51], v[180:183], v[124:127]
  ds_read_b128 v[212:215], v19 offset:10240
  v_mfma_f32_16x16x32_bf16 v[128:131], a[52:55], v[180:183], v[128:131]
  buffer_load_dwordx4 v13, s[8:11], s30 offen offset:3072 lds
  v_mfma_f32_16x16x32_bf16 v[132:135], a[56:59], v[180:183], v[132:135]
  s_add_u32 s30, s30, 128
  s_add_u32 m0, m0, 16384
  v_mfma_f32_16x16x32_bf16 v[136:139], a[48:51], v[184:187], v[136:139]
  ds_read_b128 v[216:219], v19 offset:12288
  v_mfma_f32_16x16x32_bf16 v[140:143], a[52:55], v[184:187], v[140:143]
  s_cmp_lt_u32 m0, s46
  s_cselect_b32 m0, m0, s47
  v_mfma_f32_16x16x32_bf16 v[144:147], a[56:59], v[184:187], v[144:147]
  ds_read_b128 v[236:239], v23 offset:192
  v_mfma_f32_16x16x32_bf16 v[148:151], a[48:51], v[188:191], v[148:151]
  ds_read_b128 v[220:223], v19 offset:14336
  v_mfma_f32_16x16x32_bf16 v[152:155], a[52:55], v[188:191], v[152:155]
  buffer_store_dwordx4 v[228:231], v26, s[16:19], s21 offen offset:1024 sc1
  v_mfma_f32_16x16x32_bf16 v[156:159], a[56:59], v[188:191], v[156:159]
  s_waitcnt vmcnt(14) lgkmcnt(5)
  s_barrier
  v_mfma_f32_16x16x32_bf16 v[64:67], a[60:63], v[192:195], v[64:67]
  ds_read_b128 v[160:163], v18 offset:0
  v_mfma_f32_16x16x32_bf16 v[68:71], a[64:67], v[192:195], v[68:71]
  v_mfma_f32_16x16x32_bf16 v[72:75], a[68:71], v[192:195], v[72:75]
  v_add_u32 v19, s33, v15
  s_add_u32 s33, s33, 16384
  v_mfma_f32_16x16x32_bf16 v[76:79], a[60:63], v[196:199], v[76:79]
  ds_read_b128 v[164:167], v18 offset:2048
  v_mfma_f32_16x16x32_bf16 v[80:83], a[64:67], v[196:199], v[80:83]
  buffer_load_dwordx4 v10, s[8:11], s30 offen offset:0 lds
  v_mfma_f32_16x16x32_bf16 v[84:87], a[68:71], v[196:199], v[84:87]
  s_cmp_lt_u32 s33, 98304
  s_cselect_b32 s33, s33, 0
  v_mfma_f32_16x16x32_bf16 v[88:91], a[60:63], v[200:203], v[88:91]
  ds_read_b128 v[168:171], v18 offset:4096
  v_mfma_f32_16x16x32_bf16 v[92:95], a[64:67], v[200:203], v[92:95]
  ds_read_b128 v[240:243], v23 offset:256
  v_mfma_f32_16x16x32_bf16 v[96:99], a[68:71], v[200:203], v[96:99]
  v_mfma_f32_16x16x32_bf16 v[100:103], a[60:63], v[204:207], v[100:103]
  ds_read_b128 v[172:175], v18 offset:6144
  v_mfma_f32_16x16x32_bf16 v[104:107], a[64:67], v[204:207], v[104:107]
  buffer_store_dwordx4 v[232:235], v26, s[16:19], s21 offen offset:2048 sc1
  v_mfma_f32_16x16x32_bf16 v[108:111], a[68:71], v[204:207], v[108:111]
  s_waitcnt lgkmcnt(5)
  v_mfma_f32_16x16x32_bf16 v[112:115], a[60:63], v[208:211], v[112:115]
  ds_read_b128 v[176:179], v18 offset:8192
  v_mfma_f32_16x16x32_bf16 v[116:119], a[64:67], v[208:211], v[116:119]
  v_mfma_f32_16x16x32_bf16 v[120:123], a[68:71], v[208:211], v[120:123]
  v_mfma_f32_16x16x32_bf16 v[124:127], a[60:63], v[212:215], v[124:127]
  ds_read_b128 v[180:183], v18 offset:10240
  v_mfma_f32_16x16x32_bf16 v[128:131], a[64:67], v[212:215], v[128:131]
  buffer_load_dwordx4 v11, s[8:11], s30 offen offset:1024 lds
  v_mfma_f32_16x16x32_bf16 v[132:135], a[68:71], v[212:215], v[132:135]
  v_mfma_f32_16x16x32_bf16 v[136:139], a[60:63], v[216:219], v[136:139]
  ds_read_b128 v[184:187], v18 offset:12288
  v_mfma_f32_16x16x32_bf16 v[140:143], a[64:67], v[216:219], v[140:143]
  ds_read_b128 v[244:247], v23 offset:320
  v_mfma_f32_16x16x32_bf16 v[144:147], a[68:71], v[216:219], v[144:147]
  v_mfma_f32_16x16x32_bf16 v[148:151], a[60:63], v[220:223], v[148:151]
  ds_read_b128 v[188:191], v18 offset:14336
  v_mfma_f32_16x16x32_bf16 v[152:155], a[64:67], v[220:223], v[152:155]
  buffer_store_dwordx4 v[236:239], v26, s[16:19], s21 offen offset:3072 sc1
  v_mfma_f32_16x16x32_bf16 v[156:159], a[68:71], v[220:223], v[156:159]
  s_waitcnt lgkmcnt(5)
  v_mfma_f32_16x16x32_bf16 v[64:67], a[72:75], v[160:163], v[64:67]
  ds_read_b128 v[192:195], v19 offset:0
  v_mfma_f32_16x16x32_bf16 v[68:71], a[76:79], v[160:163], v[68:71]
  v_add_u32 v18, s33, v14
  v_mfma_f32_16x16x32_bf16 v[72:75], a[80:83], v[160:163], v[72:75]
  v_mfma_f32_16x16x32_bf16 v[76:79], a[72:75], v[164:167], v[76:79]
  ds_read_b128 v[196:199], v19 offset:2048
  v_mfma_f32_16x16x32_bf16 v[80:83], a[76:79], v[164:167], v[80:83]
  buffer_load_dwordx4 v12, s[8:11], s30 offen offset:2048 lds
  v_mfma_f32_16x16x32_bf16 v[84:87], a[80:83], v[164:167], v[84:87]
  v_mfma_f32_16x16x32_bf16 v[88:91], a[72:75], v[168:171], v[88:91]
  ds_read_b128 v[200:203], v19 offset:4096
  v_mfma_f32_16x16x32_bf16 v[92:95], a[76:79], v[168:171], v[92:95]
  s_add_u32 s21, s48, 4096
  ds_read_b128 v[224:227], v23 offset:6400
  v_mfma_f32_16x16x32_bf16 v[96:99], a[80:83], v[168:171], v[96:99]
  v_mfma_f32_16x16x32_bf16 v[100:103], a[72:75], v[172:175], v[100:103]
  ds_read_b128 v[204:207], v19 offset:6144
  v_mfma_f32_16x16x32_bf16 v[104:107], a[76:79], v[172:175], v[104:107]
  buffer_store_dwordx4 v[240:243], v26, s[16:19], s21 offen offset:0 sc1
  v_mfma_f32_16x16x32_bf16 v[108:111], a[80:83], v[172:175], v[108:111]
  s_waitcnt lgkmcnt(5)
  v_mfma_f32_16x16x32_bf16 v[112:115], a[72:75], v[176:179], v[112:115]
  ds_read_b128 v[208:211], v19 offset:8192
  v_mfma_f32_16x16x32_bf16 v[116:119], a[76:79], v[176:179], v[116:119]
  v_mfma_f32_16x16x32_bf16 v[120:123], a[80:83], v[176:179], v[120:123]
  v_mfma_f32_16x16x32_bf16 v[124:127], a[72:75], v[180:183], v[124:127]
  ds_read_b128 v[212:215], v19 offset:10240
  v_mfma_f32_16x16x32_bf16 v[128:131], a[76:79], v[180:183], v[128:131]
  buffer_load_dwordx4 v13, s[8:11], s30 offen offset:3072 lds
  v_mfma_f32_16x16x32_bf16 v[132:135], a[80:83], v[180:183], v[132:135]
  s_add_u32 s30, s30, 128
  s_add_u32 m0, m0, 16384
  v_mfma_f32_16x16x32_bf16 v[136:139], a[72:75], v[184:187], v[136:139]
  ds_read_b128 v[216:219], v19 offset:12288
  v_mfma_f32_16x16x32_bf16 v[140:143], a[76:79], v[184:187], v[140:143]
  s_cmp_lt_u32 m0, s46
  s_cselect_b32 m0, m0, s47
  v_mfma_f32_16x16x32_bf16 v[144:147], a[80:83], v[184:187], v[144:147]
  ds_read_b128 v[228:231], v23 offset:6464
  v_mfma_f32_16x16x32_bf16 v[148:151], a[72:75], v[188:191], v[148:151]
  ds_read_b128 v[220:223], v19 offset:14336
  v_mfma_f32_16x16x32_bf16 v[152:155], a[76:79], v[188:191], v[152:155]
  buffer_store_dwordx4 v[244:247], v26, s[16:19], s21 offen offset:1024 sc1
  v_mfma_f32_16x16x32_bf16 v[156:159], a[80:83], v[188:191], v[156:159]
  s_waitcnt vmcnt(18) lgkmcnt(5)
  s_barrier
  v_mfma_f32_16x16x32_bf16 v[64:67], a[84:87], v[192:195], v[64:67]
  ds_read_b128 v[160:163], v18 offset:0
  v_mfma_f32_16x16x32_bf16 v[68:71], a[88:91], v[192:195], v[68:71]
  v_mfma_f32_16x16x32_bf16 v[72:75], a[92:95], v[192:195], v[72:75]
  v_add_u32 v19, s33, v15
  s_add_u32 s33, s33, 16384
  v_mfma_f32_16x16x32_bf16 v[76:79], a[84:87], v[196:199], v[76:79]
  ds_read_b128 v[164:167], v18 offset:2048
  v_mfma_f32_16x16x32_bf16 v[80:83], a[88:91], v[196:199], v[80:83]
  buffer_load_dwordx4 v10, s[8:11], s30 offen offset:0 lds
  v_mfma_f32_16x16x32_bf16 v[84:87], a[92:95], v[196:199], v[84:87]
  s_cmp_lt_u32 s33, 98304
  s_cselect_b32 s33, s33, 0
  v_mfma_f32_16x16x32_bf16 v[88:91], a[84:87], v[200:203], v[88:91]
  ds_read_b128 v[168:171], v18 offset:4096
  v_mfma_f32_16x16x32_bf16 v[92:95], a[88:91], v[200:203], v[92:95]
  ds_read_b128 v[232:235], v23 offset:6528
  v_mfma_f32_16x16x32_bf16 v[96:99], a[92:95], v[200:203], v[96:99]
  v_mfma_f32_16x16x32_bf16 v[100:103], a[84:87], v[204:207], v[100:103]
  ds_read_b128 v[172:175], v18 offset:6144
  v_mfma_f32_16x16x32_bf16 v[104:107], a[88:91], v[204:207], v[104:107]
  buffer_store_dwordx4 v[224:227], v26, s[16:19], s21 offen offset:2048 sc1
  v_mfma_f32_16x16x32_bf16 v[108:111], a[92:95], v[204:207], v[108:111]
  s_waitcnt lgkmcnt(5)
  v_mfma_f32_16x16x32_bf16 v[112:115], a[84:87], v[208:211], v[112:115]
  ds_read_b128 v[176:179], v18 offset:8192
  v_mfma_f32_16x16x32_bf16 v[116:119], a[88:91], v[208:211], v[116:119]
  v_mfma_f32_16x16x32_bf16 v[120:123], a[92:95], v[208:211], v[120:123]
  v_mfma_f32_16x16x32_bf16 v[124:127], a[84:87], v[212:215], v[124:127]
  ds_read_b128 v[180:183], v18 offset:10240
  v_mfma_f32_16x16x32_bf16 v[128:131], a[88:91], v[212:215], v[128:131]
  buffer_load_dwordx4 v11, s[8:11], s30 offen offset:1024 lds
  v_mfma_f32_16x16x32_bf16 v[132:135], a[92:95], v[212:215], v[132:135]
  v_mfma_f32_16x16x32_bf16 v[136:139], a[84:87], v[216:219], v[136:139]
  ds_read_b128 v[184:187], v18 offset:12288
  v_mfma_f32_16x16x32_bf16 v[140:143], a[88:91], v[216:219], v[140:143]
  ds_read_b128 v[236:239], v23 offset:6592
  v_mfma_f32_16x16x32_bf16 v[144:147], a[92:95], v[216:219], v[144:147]
  v_mfma_f32_16x16x32_bf16 v[148:151], a[84:87], v[220:223], v[148:151]
  ds_read_b128 v[188:191], v18 offset:14336
  v_mfma_f32_16x16x32_bf16 v[152:155], a[88:91], v[220:223], v[152:155]
  buffer_store_dwordx4 v[228:231], v26, s[16:19], s21 offen offset:3072 sc1
  v_mfma_f32_16x16x32_bf16 v[156:159], a[92:95], v[220:223], v[156:159]
  s_waitcnt lgkmcnt(5)
  v_mfma_f32_16x16x32_bf16 v[64:67], a[96:99], v[160:163], v[64:67]
  ds_read_b128 v[192:195], v19 offset:0
  v_mfma_f32_16x16x32_bf16 v[68:71], a[100:103], v[160:163], v[68:71]
  v_add_u32 v18, s33, v14
  v_mfma_f32_16x16x32_bf16 v[72:75], a[104:107], v[160:163], v[72:75]
  v_mfma_f32_16x16x32_bf16 v[76:79], a[96:99], v[164:167], v[76:79]
  ds_read_b128 v[196:199], v19 offset:2048
  v_mfma_f32_16x16x32_bf16 v[80:83], a[100:103], v[164:167], v[80:83]
  buffer_load_dwordx4 v12, s[8:11], s30 offen offset:2048 lds
  v_mfma_f32_16x16x32_bf16 v[84:87], a[104:107], v[164:167], v[84:87]
  v_mfma_f32_16x16x32_bf16 v[88:91], a[96:99], v[168:171], v[88:91]
  ds_read_b128 v[200:203], v19 offset:4096
  v_mfma_f32_16x16x32_bf16 v[92:95], a[100:103], v[168:171], v[92:95]
  s_add_u32 s21, s48, 8192
  ds_read_b128 v[240:243], v23 offset:6656
  v_mfma_f32_16x16x32_bf16 v[96:99], a[104:107], v[168:171], v[96:99]
  v_mfma_f32_16x16x32_bf16 v[100:103], a[96:99], v[172:175], v[100:103]
  ds_read_b128 v[204:207], v19 offset:6144
  v_mfma_f32_16x16x32_bf16 v[104:107], a[100:103], v[172:175], v[104:107]
  buffer_store_dwordx4 v[232:235], v26, s[16:19], s21 offen offset:0 sc1
  v_mfma_f32_16x16x32_bf16 v[108:111], a[104:107], v[172:175], v[108:111]
  s_waitcnt lgkmcnt(5)
  v_mfma_f32_16x16x32_bf16 v[112:115], a[96:99], v[176:179], v[112:115]
  ds_read_b128 v[208:211], v19 offset:8192
  v_mfma_f32_16x16x32_bf16 v[116:119], a[100:103], v[176:179], v[116:119]
  v_mfma_f32_16x16x32_bf16 v[120:123], a[104:107], v[176:179], v[120:123]
  v_mfma_f32_16x16x32_bf16 v[124:127], a[96:99], v[180:183], v[124:127]
  ds_read_b128 v[212:215], v19 offset:10240
  v_mfma_f32_16x16x32_bf16 v[128:131], a[100:103], v[180:183], v[128:131]
  buffer_load_dwordx4 v13, s[8:11], s30 offen offset:3072 lds
  v_mfma_f32_16x16x32_bf16 v[132:135], a[104:107], v[180:183], v[132:135]
  s_add_u32 s30, s30, 128
  s_add_u32 m0, m0, 16384
  v_mfma_f32_16x16x32_bf16 v[136:139], a[96:99], v[184:187], v[136:139]
  ds_read_b128 v[216:219], v19 offset:12288
  v_mfma_f32_16x16x32_bf16 v[140:143], a[100:103], v[184:187], v[140:143]
  s_cmp_lt_u32 m0, s46
  s_cselect_b32 m0, m0, s47
  v_mfma_f32_16x16x32_bf16 v[144:147], a[104:107], v[184:187], v[144:147]
  ds_read_b128 v[244:247], v23 offset:6720
  v_mfma_f32_16x16x32_bf16 v[148:151], a[96:99], v[188:191], v[148:151]
  ds_read_b128 v[220:223], v19 offset:14336
  v_mfma_f32_16x16x32_bf16 v[152:155], a[100:103], v[188:191], v[152:155]
  buffer_store_dwordx4 v[236:239], v26, s[16:19], s21 offen offset:1024 sc1
  v_mfma_f32_16x16x32_bf16 v[156:159], a[104:107], v[188:191], v[156:159]
  s_waitcnt vmcnt(22) lgkmcnt(5)
  s_barrier
  v_mfma_f32_16x16x32_bf16 v[64:67], a[108:111], v[192:195], v[64:67]
  ds_read_b128 v[160:163], v18 offset:0
  v_mfma_f32_16x16x32_bf16 v[68:71], a[112:115], v[192:195], v[68:71]
  v_mfma_f32_16x16x32_bf16 v[72:75], a[116:119], v[192:195], v[72:75]
  v_add_u32 v19, s33, v15
  s_add_u32 s33, s33, 16384
  v_mfma_f32_16x16x32_bf16 v[76:79], a[108:111], v[196:199], v[76:79]
  ds_read_b128 v[164:167], v18 offset:2048
  v_mfma_f32_16x16x32_bf16 v[80:83], a[112:115], v[196:199], v[80:83]
  buffer_load_dwordx4 v10, s[8:11], s30 offen offset:0 lds
  v_mfma_f32_16x16x32_bf16 v[84:87], a[116:119], v[196:199], v[84:87]
  s_cmp_lt_u32 s33, 98304
  s_cselect_b32 s33, s33, 0
  v_mfma_f32_16x16x32_bf16 v[88:91], a[108:111], v[200:203], v[88:91]
  ds_read_b128 v[168:171], v18 offset:4096
  v_mfma_f32_16x16x32_bf16 v[92:95], a[112:115], v[200:203], v[92:95]
  v_mfma_f32_16x16x32_bf16 v[96:99], a[116:119], v[200:203], v[96:99]
  v_mfma_f32_16x16x32_bf16 v[100:103], a[108:111], v[204:207], v[100:103]
  ds_read_b128 v[172:175], v18 offset:6144
  v_mfma_f32_16x16x32_bf16 v[104:107], a[112:115], v[204:207], v[104:107]
  buffer_store_dwordx4 v[240:243], v26, s[16:19], s21 offen offset:2048 sc1
  v_mfma_f32_16x16x32_bf16 v[108:111], a[116:119], v[204:207], v[108:111]
  s_waitcnt lgkmcnt(4)
  v_mfma_f32_16x16x32_bf16 v[112:115], a[108:111], v[208:211], v[112:115]
  ds_read_b128 v[176:179], v18 offset:8192
  v_mfma_f32_16x16x32_bf16 v[116:119], a[112:115], v[208:211], v[116:119]
  v_mfma_f32_16x16x32_bf16 v[120:123], a[116:119], v[208:211], v[120:123]
  v_mfma_f32_16x16x32_bf16 v[124:127], a[108:111], v[212:215], v[124:127]
  ds_read_b128 v[180:183], v18 offset:10240
  v_mfma_f32_16x16x32_bf16 v[128:131], a[112:115], v[212:215], v[128:131]
  buffer_load_dwordx4 v11, s[8:11], s30 offen offset:1024 lds
  v_mfma_f32_16x16x32_bf16 v[132:135], a[116:119], v[212:215], v[132:135]
  v_mfma_f32_16x16x32_bf16 v[136:139], a[108:111], v[216:219], v[136:139]
  ds_read_b128 v[184:187], v18 offset:12288
  v_mfma_f32_16x16x32_bf16 v[140:143], a[112:115], v[216:219], v[140:143]
  v_mfma_f32_16x16x32_bf16 v[144:147], a[116:119], v[216:219], v[144:147]
  v_mfma_f32_16x16x32_bf16 v[148:151], a[108:111], v[220:223], v[148:151]
  ds_read_b128 v[188:191], v18 offset:14336
  v_mfma_f32_16x16x32_bf16 v[152:155], a[112:115], v[220:223], v[152:155]
  buffer_store_dwordx4 v[244:247], v26, s[16:19], s21 offen offset:3072 sc1
  v_mfma_f32_16x16x32_bf16 v[156:159], a[116:119], v[220:223], v[156:159]
  s_waitcnt lgkmcnt(4)
  v_mfma_f32_16x16x32_bf16 v[64:67], a[120:123], v[160:163], v[64:67]
  ds_read_b128 v[192:195], v19 offset:0
  v_mfma_f32_16x16x32_bf16 v[68:71], a[124:127], v[160:163], v[68:71]
  v_add_u32 v18, s33, v14
  v_mfma_f32_16x16x32_bf16 v[72:75], a[128:131], v[160:163], v[72:75]
  v_mfma_f32_16x16x32_bf16 v[76:79], a[120:123], v[164:167], v[76:79]
  ds_read_b128 v[196:199], v19 offset:2048
  v_mfma_f32_16x16x32_bf16 v[80:83], a[124:127], v[164:167], v[80:83]
  buffer_load_dwordx4 v12, s[8:11], s30 offen offset:2048 lds
  v_mfma_f32_16x16x32_bf16 v[84:87], a[128:131], v[164:167], v[84:87]
  v_mfma_f32_16x16x32_bf16 v[88:91], a[120:123], v[168:171], v[88:91]
  ds_read_b128 v[200:203], v19 offset:4096
  v_mfma_f32_16x16x32_bf16 v[92:95], a[124:127], v[168:171], v[92:95]
  v_mfma_f32_16x16x32_bf16 v[96:99], a[128:131], v[168:171], v[96:99]
  v_mfma_f32_16x16x32_bf16 v[100:103], a[120:123], v[172:175], v[100:103]
  ds_read_b128 v[204:207], v19 offset:6144
  v_mfma_f32_16x16x32_bf16 v[104:107], a[124:127], v[172:175], v[104:107]
  v_mfma_f32_16x16x32_bf16 v[108:111], a[128:131], v[172:175], v[108:111]
  s_waitcnt lgkmcnt(4)
  v_mfma_f32_16x16x32_bf16 v[112:115], a[120:123], v[176:179], v[112:115]
  ds_read_b128 v[208:211], v19 offset:8192
  v_mfma_f32_16x16x32_bf16 v[116:119], a[124:127], v[176:179], v[116:119]
  v_mfma_f32_16x16x32_bf16 v[120:123], a[128:131], v[176:179], v[120:123]
  v_mfma_f32_16x16x32_bf16 v[124:127], a[120:123], v[180:183], v[124:127]
  ds_read_b128 v[212:215], v19 offset:10240
  v_mfma_f32_16x16x32_bf16 v[128:131], a[124:127], v[180:183], v[128:131]
  buffer_load_dwordx4 v13, s[8:11], s30 offen offset:3072 lds
  v_mfma_f32_16x16x32_bf16 v[132:135], a[128:131], v[180:183], v[132:135]
  s_add_u32 s30, s30, s25
  s_sub_u32 s30, s30, 1152
  v_mfma_f32_16x16x32_bf16 v[136:139], a[120:123], v[184:187], v[136:139]
  ds_read_b128 v[216:219], v19 offset:12288
  s_add_u32 m0, m0, 16384
  v_mfma_f32_16x16x32_bf16 v[140:143], a[124:127], v[184:187], v[140:143]
  s_cmp_lt_u32 m0, s46
  s_cselect_b32 m0, m0, s47
  v_mfma_f32_16x16x32_bf16 v[144:147], a[128:131], v[184:187], v[144:147]
  v_mfma_f32_16x16x32_bf16 v[148:151], a[120:123], v[188:191], v[148:151]
  ds_read_b128 v[220:223], v19 offset:14336
  v_mfma_f32_16x16x32_bf16 v[152:155], a[124:127], v[188:191], v[152:155]
  v_mfma_f32_16x16x32_bf16 v[156:159], a[128:131], v[188:191], v[156:159]
  s_waitcnt vmcnt(23) lgkmcnt(4)
  s_barrier
  v_mfma_f32_16x16x32_bf16 v[64:67], a[132:135], v[192:195], v[64:67]
  ds_read_b128 v[160:163], v18 offset:0
  v_mfma_f32_16x16x32_bf16 v[68:71], a[136:139], v[192:195], v[68:71]
  v_mfma_f32_16x16x32_bf16 v[72:75], a[140:143], v[192:195], v[72:75]
  v_add_u32 v19, s33, v15
  s_add_u32 s33, s33, 16384
  v_mfma_f32_16x16x32_bf16 v[76:79], a[132:135], v[196:199], v[76:79]
  ds_read_b128 v[164:167], v18 offset:2048
  v_mfma_f32_16x16x32_bf16 v[80:83], a[136:139], v[196:199], v[80:83]
  buffer_load_dwordx4 v10, s[8:11], s30 offen offset:0 lds
  v_mfma_f32_16x16x32_bf16 v[84:87], a[140:143], v[196:199], v[84:87]
  s_cmp_lt_u32 s33, 98304
  s_cselect_b32 s33, s33, 0
  v_mfma_f32_16x16x32_bf16 v[88:91], a[132:135], v[200:203], v[88:91]
  ds_read_b128 v[168:171], v18 offset:4096
  v_mfma_f32_16x16x32_bf16 v[92:95], a[136:139], v[200:203], v[92:95]
  v_mfma_f32_16x16x32_bf16 v[96:99], a[140:143], v[200:203], v[96:99]
  v_mfma_f32_16x16x32_bf16 v[100:103], a[132:135], v[204:207], v[100:103]
  ds_read_b128 v[172:175], v18 offset:6144
  v_mfma_f32_16x16x32_bf16 v[104:107], a[136:139], v[204:207], v[104:107]
  v_mfma_f32_16x16x32_bf16 v[108:111], a[140:143], v[204:207], v[108:111]
  s_waitcnt lgkmcnt(4)
  v_mfma_f32_16x16x32_bf16 v[112:115], a[132:135], v[208:211], v[112:115]
  ds_read_b128 v[176:179], v18 offset:8192
  v_mfma_f32_16x16x32_bf16 v[116:119], a[136:139], v[208:211], v[116:119]
  v_mfma_f32_16x16x32_bf16 v[120:123], a[140:143], v[208:211], v[120:123]
  v_mfma_f32_16x16x32_bf16 v[124:127], a[132:135], v[212:215], v[124:127]
  ds_read_b128 v[180:183], v18 offset:10240
  v_mfma_f32_16x16x32_bf16 v[128:131], a[136:139], v[212:215], v[128:131]
  buffer_load_dwordx4 v11, s[8:11], s30 offen offset:1024 lds
  v_mfma_f32_16x16x32_bf16 v[132:135], a[140:143], v[212:215], v[132:135]
  v_mfma_f32_16x16x32_bf16 v[136:139], a[132:135], v[216:219], v[136:139]
  ds_read_b128 v[184:187], v18 offset:12288
  v_mfma_f32_16x16x32_bf16 v[140:143], a[136:139], v[216:219], v[140:143]
  v_mfma_f32_16x16x32_bf16 v[144:147], a[140:143], v[216:219], v[144:147]
  v_mfma_f32_16x16x32_bf16 v[148:151], a[132:135], v[220:223], v[148:151]
  ds_read_b128 v[188:191], v18 offset:14336
  v_mfma_f32_16x16x32_bf16 v[152:155], a[136:139], v[220:223], v[152:155]
  v_mfma_f32_16x16x32_bf16 v[156:159], a[140:143], v[220:223], v[156:159]
  s_waitcnt lgkmcnt(4)
  v_mfma_f32_16x16x32_bf16 v[64:67], a[144:147], v[160:163], v[64:67]
  ds_read_b128 v[192:195], v19 offset:0
  v_mfma_f32_16x16x32_bf16 v[68:71], a[148:151], v[160:163], v[68:71]
  v_add_u32 v18, s33, v14
  v_mfma_f32_16x16x32_bf16 v[72:75], a[152:155], v[160:163], v[72:75]
  v_mfma_f32_16x16x32_bf16 v[76:79], a[144:147], v[164:167], v[76:79]
  ds_read_b128 v[196:199], v19 offset:2048
  v_mfma_f32_16x16x32_bf16 v[80:83], a[148:151], v[164:167], v[80:83]
  buffer_load_dwordx4 v12, s[8:11], s30 offen offset:2048 lds
  v_mfma_f32_16x16x32_bf16 v[84:87], a[152:155], v[164:167], v[84:87]
  v_mfma_f32_16x16x32_bf16 v[88:91], a[144:147], v[168:171], v[88:91]
  ds_read_b128 v[200:203], v19 offset:4096
  v_mfma_f32_16x16x32_bf16 v[92:95], a[148:151], v[168:171], v[92:95]
  v_mfma_f32_16x16x32_bf16 v[96:99], a[152:155], v[168:171], v[96:99]
  v_mfma_f32_16x16x32_bf16 v[100:103], a[144:147], v[172:175], v[100:103]
  ds_read_b128 v[204:207], v19 offset:6144
  v_mfma_f32_16x16x32_bf16 v[104:107], a[148:151], v[172:175], v[104:107]
  v_mfma_f32_16x16x32_bf16 v[108:111], a[152:155], v[172:175], v[108:111]
  s_waitcnt lgkmcnt(4)
  v_mfma_f32_16x16x32_bf16 v[112:115], a[144:147], v[176:179], v[112:115]
  ds_read_b128 v[208:211], v19 offset:8192
  v_mfma_f32_16x16x32_bf16 v[116:119], a[148:151], v[176:179], v[116:119]
  v_mfma_f32_16x16x32_bf16 v[120:123], a[152:155], v[176:179], v[120:123]
  v_mfma_f32_16x16x32_bf16 v[124:127], a[144:147], v[180:183], v[124:127]
  ds_read_b128 v[212:215], v19 offset:10240
  v_mfma_f32_16x16x32_bf16 v[128:131], a[148:151], v[180:183], v[128:131]
  buffer_load_dwordx4 v13, s[8:11], s30 offen offset:3072 lds
  v_mfma_f32_16x16x32_bf16 v[132:135], a[152:155], v[180:183], v[132:135]
  s_add_u32 s30, s30, 128
  s_add_u32 m0, m0, 16384
  v_mfma_f32_16x16x32_bf16 v[136:139], a[144:147], v[184:187], v[136:139]
  ds_read_b128 v[216:219], v19 offset:12288
  v_mfma_f32_16x16x32_bf16 v[140:143], a[148:151], v[184:187], v[140:143]
  s_cmp_lt_u32 m0, s46
  s_cselect_b32 m0, m0, s47
  v_mfma_f32_16x16x32_bf16 v[144:147], a[152:155], v[184:187], v[144:147]
  v_mfma_f32_16x16x32_bf16 v[148:151], a[144:147], v[188:191], v[148:151]
  ds_read_b128 v[220:223], v19 offset:14336
  v_mfma_f32_16x16x32_bf16 v[152:155], a[148:151], v[188:191], v[152:155]
  v_mfma_f32_16x16x32_bf16 v[156:159], a[152:155], v[188:191], v[156:159]
  s_waitcnt vmcnt(6) lgkmcnt(4)
  s_barrier
  v_mfma_f32_16x16x32_bf16 v[64:67], a[156:159], v[192:195], v[64:67]
  ds_read_b128 v[160:163], v18 offset:0
  v_mfma_f32_16x16x32_bf16 v[68:71], a[160:163], v[192:195], v[68:71]
  s_cmp_eq_u32 s48, 0x80000000
  s_cbranch_scc1 kv_155
  s_cmp_lg_u32 s20, 0
  s_cbranch_scc1 af_156
  v_mov_b32 v4, 0
  v_mov_b32 v5, 1
  s_mov_b64 exec, 1
  buffer_atomic_add v5, v4, s[72:75], s61 offen sc1
  s_mov_b64 exec, -1
  s_nop 1
af_156:
kv_155:
  v_mfma_f32_16x16x32_bf16 v[72:75], a[164:167], v[192:195], v[72:75]
  v_add_u32 v19, s33, v15
  s_add_u32 s33, s33, 16384
  v_mfma_f32_16x16x32_bf16 v[76:79], a[156:159], v[196:199], v[76:79]
  ds_read_b128 v[164:167], v18 offset:2048
  v_mfma_f32_16x16x32_bf16 v[80:83], a[160:163], v[196:199], v[80:83]
  buffer_load_dwordx4 v10, s[8:11], s30 offen offset:0 lds
  v_mfma_f32_16x16x32_bf16 v[84:87], a[164:167], v[196:199], v[84:87]
  s_cmp_lt_u32 s33, 98304
  s_cselect_b32 s33, s33, 0
  v_mfma_f32_16x16x32_bf16 v[88:91], a[156:159], v[200:203], v[88:91]
  ds_read_b128 v[168:171], v18 offset:4096
  v_mfma_f32_16x16x32_bf16 v[92:95], a[160:163], v[200:203], v[92:95]
  v_mfma_f32_16x16x32_bf16 v[96:99], a[164:167], v[200:203], v[96:99]
  v_mfma_f32_16x16x32_bf16 v[100:103], a[156:159], v[204:207], v[100:103]
  ds_read_b128 v[172:175], v18 offset:6144
  v_mfma_f32_16x16x32_bf16 v[104:107], a[160:163], v[204:207], v[104:107]
  v_mfma_f32_16x16x32_bf16 v[108:111], a[164:167], v[204:207], v[108:111]
  s_waitcnt lgkmcnt(4)
  v_mfma_f32_16x16x32_bf16 v[112:115], a[156:159], v[208:211], v[112:115]
  ds_read_b128 v[176:179], v18 offset:8192
  v_mfma_f32_16x16x32_bf16 v[116:119], a[160:163], v[208:211], v[116:119]
  v_mfma_f32_16x16x32_bf16 v[120:123], a[164:167], v[208:211], v[120:123]
  v_mfma_f32_16x16x32_bf16 v[124:127], a[156:159], v[212:215], v[124:127]
  ds_read_b128 v[180:183], v18 offset:10240
  v_mfma_f32_16x16x32_bf16 v[128:131], a[160:163], v[212:215], v[128:131]
  buffer_load_dwordx4 v11, s[8:11], s30 offen offset:1024 lds
  v_mfma_f32_16x16x32_bf16 v[132:135], a[164:167], v[212:215], v[132:135]
  v_mfma_f32_16x16x32_bf16 v[136:139], a[156:159], v[216:219], v[136:139]
  ds_read_b128 v[184:187], v18 offset:12288
  v_mfma_f32_16x16x32_bf16 v[140:143], a[160:163], v[216:219], v[140:143]
  v_mfma_f32_16x16x32_bf16 v[144:147], a[164:167], v[216:219], v[144:147]
  v_mfma_f32_16x16x32_bf16 v[148:151], a[156:159], v[220:223], v[148:151]
  ds_read_b128 v[188:191], v18 offset:14336
  v_mfma_f32_16x16x32_bf16 v[152:155], a[160:163], v[220:223], v[152:155]
  v_mfma_f32_16x16x32_bf16 v[156:159], a[164:167], v[220:223], v[156:159]
  s_waitcnt lgkmcnt(4)
  v_mfma_f32_16x16x32_bf16 v[64:67], a[168:171], v[160:163], v[64:67]
  ds_read_b128 v[192:195], v19 offset:0
  v_mfma_f32_16x16x32_bf16 v[68:71], a[172:175], v[160:163], v[68:71]
  v_add_u32 v18, s33, v14
  s_mov_b32 s61, s60
  v_mfma_f32_16x16x32_bf16 v[72:75], a[176:179], v[160:163], v[72:75]
  s_add_u32 s60, s60, s62
  s_mul_i32 s48, s20, 393216
  v_mfma_f32_16x16x32_bf16 v[76:79], a[168:171], v[164:167], v[76:79]
  ds_read_b128 v[196:199], v19 offset:2048
  s_add_u32 s48, s48, s27
  v_mfma_f32_16x16x32_bf16 v[80:83], a[172:175], v[164:167], v[80:83]
  buffer_load_dwordx4 v12, s[8:11], s30 offen offset:2048 lds
  v_mfma_f32_16x16x32_bf16 v[84:87], a[176:179], v[164:167], v[84:87]
  s_add_u32 s27, s27, s28
  s_sub_u32 s26, s26, 1
  v_mfma_f32_16x16x32_bf16 v[88:91], a[168:171], v[168:171], v[88:91]
  ds_read_b128 v[200:203], v19 offset:4096
  v_mfma_f32_16x16x32_bf16 v[92:95], a[172:175], v[168:171], v[92:95]
  v_mfma_f32_16x16x32_bf16 v[96:99], a[176:179], v[168:171], v[96:99]
  v_mfma_f32_16x16x32_bf16 v[100:103], a[168:171], v[172:175], v[100:103]
  ds_read_b128 v[204:207], v19 offset:6144
  v_mfma_f32_16x16x32_bf16 v[104:107], a[172:175], v[172:175], v[104:107]
  v_mfma_f32_16x16x32_bf16 v[108:111], a[176:179], v[172:175], v[108:111]
  s_waitcnt lgkmcnt(4)
  v_mfma_f32_16x16x32_bf16 v[112:115], a[168:171], v[176:179], v[112:115]
  ds_read_b128 v[208:211], v19 offset:8192
  v_mfma_f32_16x16x32_bf16 v[116:119], a[172:175], v[176:179], v[116:119]
  v_mfma_f32_16x16x32_bf16 v[120:123], a[176:179], v[176:179], v[120:123]
  v_mfma_f32_16x16x32_bf16 v[124:127], a[168:171], v[180:183], v[124:127]
  ds_read_b128 v[212:215], v19 offset:10240
  v_mfma_f32_16x16x32_bf16 v[128:131], a[172:175], v[180:183], v[128:131]
  buffer_load_dwordx4 v13, s[8:11], s30 offen offset:3072 lds
  v_mfma_f32_16x16x32_bf16 v[132:135], a[176:179], v[180:183], v[132:135]
  s_add_u32 s30, s30, 128
  s_add_u32 m0, m0, 16384
  v_mfma_f32_16x16x32_bf16 v[136:139], a[168:171], v[184:187], v[136:139]
  ds_read_b128 v[216:219], v19 offset:12288
  v_mfma_f32_16x16x32_bf16 v[140:143], a[172:175], v[184:187], v[140:143]
  s_cmp_lt_u32 m0, s46
  s_cselect_b32 m0, m0, s47
  v_mfma_f32_16x16x32_bf16 v[144:147], a[176:179], v[184:187], v[144:147]
  v_mfma_f32_16x16x32_bf16 v[148:151], a[168:171], v[188:191], v[148:151]
  ds_read_b128 v[220:223], v19 offset:14336
  v_mfma_f32_16x16x32_bf16 v[152:155], a[172:175], v[188:191], v[152:155]
  v_mfma_f32_16x16x32_bf16 v[156:159], a[176:179], v[188:191], v[156:159]
  s_waitcnt vmcnt(15) lgkmcnt(4)
  s_barrier
  v_mfma_f32_16x16x32_bf16 v[64:67], a[180:183], v[192:195], v[64:67]
  ds_read_b128 v[160:163], v18 offset:0
  v_mfma_f32_16x16x32_bf16 v[68:71], a[184:187], v[192:195], v[68:71]
  v_mfma_f32_16x16x32_bf16 v[72:75], a[188:191], v[192:195], v[72:75]
  v_add_u32 v19, s33, v15
  s_add_u32 s33, s33, 16384
  v_mfma_f32_16x16x32_bf16 v[76:79], a[180:183], v[196:199], v[76:79]
  ds_read_b128 v[164:167], v18 offset:2048
  v_mfma_f32_16x16x32_bf16 v[80:83], a[184:187], v[196:199], v[80:83]
  buffer_load_dwordx4 v10, s[8:11], s30 offen offset:0 lds
  v_mfma_f32_16x16x32_bf16 v[84:87], a[188:191], v[196:199], v[84:87]
  s_cmp_lt_u32 s33, 98304
  s_cselect_b32 s33, s33, 0
  v_mfma_f32_16x16x32_bf16 v[88:91], a[180:183], v[200:203], v[88:91]
  ds_read_b128 v[168:171], v18 offset:4096
  v_mfma_f32_16x16x32_bf16 v[92:95], a[184:187], v[200:203], v[92:95]
  v_mfma_f32_16x16x32_bf16 v[96:99], a[188:191], v[200:203], v[96:99]
  v_mfma_f32_16x16x32_bf16 v[100:103], a[180:183], v[204:207], v[100:103]
  ds_read_b128 v[172:175], v18 offset:6144
  v_mfma_f32_16x16x32_bf16 v[104:107], a[184:187], v[204:207], v[104:107]
  v_mfma_f32_16x16x32_bf16 v[108:111], a[188:191], v[204:207], v[108:111]
  s_waitcnt lgkmcnt(4)
  v_mfma_f32_16x16x32_bf16 v[112:115], a[180:183], v[208:211], v[112:115]
  ds_read_b128 v[176:179], v18 offset:8192
  v_mfma_f32_16x16x32_bf16 v[116:119], a[184:187], v[208:211], v[116:119]
  v_mfma_f32_16x16x32_bf16 v[120:123], a[188:191], v[208:211], v[120:123]
  v_mfma_f32_16x16x32_bf16 v[124:127], a[180:183], v[212:215], v[124:127]
  ds_read_b128 v[180:183], v18 offset:10240
  v_mfma_f32_16x16x32_bf16 v[128:131], a[184:187], v[212:215], v[128:131]
  buffer_load_dwordx4 v11, s[8:11], s30 offen offset:1024 lds
  v_mfma_f32_16x16x32_bf16 v[132:135], a[188:191], v[212:215], v[132:135]
  v_mfma_f32_16x16x32_bf16 v[136:139], a[180:183], v[216:219], v[136:139]
  ds_read_b128 v[184:187], v18 offset:12288
  v_mfma_f32_16x16x32_bf16 v[140:143], a[184:187], v[216:219], v[140:143]
  v_mfma_f32_16x16x32_bf16 v[144:147], a[188:191], v[216:219], v[144:147]
  v_mfma_f32_16x16x32_bf16 v[148:151], a[180:183], v[220:223], v[148:151]
  ds_read_b128 v[188:191], v18 offset:14336
  v_mfma_f32_16x16x32_bf16 v[152:155], a[184:187], v[220:223], v[152:155]
  v_mfma_f32_16x16x32_bf16 v[156:159], a[188:191], v[220:223], v[156:159]
  s_waitcnt lgkmcnt(4)
  v_mfma_f32_16x16x32_bf16 v[64:67], a[192:195], v[160:163], v[64:67]
  ds_read_b128 v[192:195], v19 offset:0
  v_mfma_f32_16x16x32_bf16 v[68:71], a[196:199], v[160:163], v[68:71]
  v_add_u32 v18, s33, v14
  v_mfma_f32_16x16x32_bf16 v[72:75], a[200:203], v[160:163], v[72:75]
  v_mfma_f32_16x16x32_bf16 v[76:79], a[192:195], v[164:167], v[76:79]
  ds_read_b128 v[196:199], v19 offset:2048
  v_mfma_f32_16x16x32_bf16 v[80:83], a[196:199], v[164:167], v[80:83]
  buffer_load_dwordx4 v12, s[8:11], s30 offen offset:2048 lds
  v_mfma_f32_16x16x32_bf16 v[84:87], a[200:203], v[164:167], v[84:87]
  v_mfma_f32_16x16x32_bf16 v[88:91], a[192:195], v[168:171], v[88:91]
  ds_read_b128 v[200:203], v19 offset:4096
  v_mfma_f32_16x16x32_bf16 v[92:95], a[196:199], v[168:171], v[92:95]
  v_mfma_f32_16x16x32_bf16 v[96:99], a[200:203], v[168:171], v[96:99]
  v_mfma_f32_16x16x32_bf16 v[100:103], a[192:195], v[172:175], v[100:103]
  ds_read_b128 v[204:207], v19 offset:6144
  v_mfma_f32_16x16x32_bf16 v[104:107], a[196:199], v[172:175], v[104:107]
  v_mfma_f32_16x16x32_bf16 v[108:111], a[200:203], v[172:175], v[108:111]
  s_waitcnt lgkmcnt(4)
  v_mfma_f32_16x16x32_bf16 v[112:115], a[192:195], v[176:179], v[112:115]
  ds_read_b128 v[208:211], v19 offset:8192
  v_mfma_f32_16x16x32_bf16 v[116:119], a[196:199], v[176:179], v[116:119]
  v_mfma_f32_16x16x32_bf16 v[120:123], a[200:203], v[176:179], v[120:123]
  v_mfma_f32_16x16x32_bf16 v[124:127], a[192:195], v[180:183], v[124:127]
  ds_read_b128 v[212:215], v19 offset:10240
  v_mfma_f32_16x16x32_bf16 v[128:131], a[196:199], v[180:183], v[128:131]
  buffer_load_dwordx4 v13, s[8:11], s30 offen offset:3072 lds
  v_mfma_f32_16x16x32_bf16 v[132:135], a[200:203], v[180:183], v[132:135]
  s_add_u32 s30, s30, 128
  s_add_u32 m0, m0, 16384
  v_mfma_f32_16x16x32_bf16 v[136:139], a[192:195], v[184:187], v[136:139]
  ds_read_b128 v[216:219], v19 offset:12288
  v_mfma_f32_16x16x32_bf16 v[140:143], a[196:199], v[184:187], v[140:143]
  s_cmp_lt_u32 m0, s46
  s_cselect_b32 m0, m0, s47
  v_mfma_f32_16x16x32_bf16 v[144:147], a[200:203], v[184:187], v[144:147]
  v_mfma_f32_16x16x32_bf16 v[148:151], a[192:195], v[188:191], v[148:151]
  ds_read_b128 v[220:223], v19 offset:14336
  v_mfma_f32_16x16x32_bf16 v[152:155], a[196:199], v[188:191], v[152:155]
  v_mfma_f32_16x16x32_bf16 v[156:159], a[200:203], v[188:191], v[156:159]
  s_waitcnt vmcnt(12) lgkmcnt(4)
  s_barrier
  v_mfma_f32_16x16x32_bf16 v[64:67], a[204:207], v[192:195], v[64:67]
  ds_read_b128 v[160:163], v18 offset:0
  v_mfma_f32_16x16x32_bf16 v[68:71], a[208:211], v[192:195], v[68:71]
  v_mfma_f32_16x16x32_bf16 v[72:75], a[212:215], v[192:195], v[72:75]
  v_add_u32 v19, s33, v15
  s_add_u32 s33, s33, 16384
  v_mfma_f32_16x16x32_bf16 v[76:79], a[204:207], v[196:199], v[76:79]
  ds_read_b128 v[164:167], v18 offset:2048
  v_mfma_f32_16x16x32_bf16 v[80:83], a[208:211], v[196:199], v[80:83]
  buffer_load_dwordx4 v10, s[8:11], s30 offen offset:0 lds
  v_mfma_f32_16x16x32_bf16 v[84:87], a[212:215], v[196:199], v[84:87]
  s_cmp_lt_u32 s33, 98304
  s_cselect_b32 s33, s33, 0
  v_mfma_f32_16x16x32_bf16 v[88:91], a[204:207], v[200:203], v[88:91]
  ds_read_b128 v[168:171], v18 offset:4096
  v_mfma_f32_16x16x32_bf16 v[92:95], a[208:211], v[200:203], v[92:95]
  v_mfma_f32_16x16x32_bf16 v[96:99], a[212:215], v[200:203], v[96:99]
  v_mfma_f32_16x16x32_bf16 v[100:103], a[204:207], v[204:207], v[100:103]
  ds_read_b128 v[172:175], v18 offset:6144
  v_mfma_f32_16x16x32_bf16 v[104:107], a[208:211], v[204:207], v[104:107]
  v_mfma_f32_16x16x32_bf16 v[108:111], a[212:215], v[204:207], v[108:111]
  s_waitcnt lgkmcnt(4)
  v_mfma_f32_16x16x32_bf16 v[112:115], a[204:207], v[208:211], v[112:115]
  ds_read_b128 v[176:179], v18 offset:8192
  v_mfma_f32_16x16x32_bf16 v[116:119], a[208:211], v[208:211], v[116:119]
  v_mfma_f32_16x16x32_bf16 v[120:123], a[212:215], v[208:211], v[120:123]
  v_mfma_f32_16x16x32_bf16 v[124:127], a[204:207], v[212:215], v[124:127]
  ds_read_b128 v[180:183], v18 offset:10240
  v_mfma_f32_16x16x32_bf16 v[128:131], a[208:211], v[212:215], v[128:131]
  buffer_load_dwordx4 v11, s[8:11], s30 offen offset:1024 lds
  v_mfma_f32_16x16x32_bf16 v[132:135], a[212:215], v[212:215], v[132:135]
  v_mfma_f32_16x16x32_bf16 v[136:139], a[204:207], v[216:219], v[136:139]
  ds_read_b128 v[184:187], v18 offset:12288
  v_mfma_f32_16x16x32_bf16 v[140:143], a[208:211], v[216:219], v[140:143]
  v_mfma_f32_16x16x32_bf16 v[144:147], a[212:215], v[216:219], v[144:147]
  v_mfma_f32_16x16x32_bf16 v[148:151], a[204:207], v[220:223], v[148:151]
  ds_read_b128 v[188:191], v18 offset:14336
  v_mfma_f32_16x16x32_bf16 v[152:155], a[208:211], v[220:223], v[152:155]
  v_mfma_f32_16x16x32_bf16 v[156:159], a[212:215], v[220:223], v[156:159]
  s_waitcnt lgkmcnt(4)
  v_mfma_f32_16x16x32_bf16 v[64:67], a[216:219], v[160:163], v[64:67]
  ds_read_b128 v[192:195], v19 offset:0
  v_mfma_f32_16x16x32_bf16 v[68:71], a[220:223], v[160:163], v[68:71]
  v_add_u32 v18, s33, v14
  v_mfma_f32_16x16x32_bf16 v[72:75], a[224:227], v[160:163], v[72:75]
  v_mfma_f32_16x16x32_bf16 v[76:79], a[216:219], v[164:167], v[76:79]
  ds_read_b128 v[196:199], v19 offset:2048
  v_mfma_f32_16x16x32_bf16 v[80:83], a[220:223], v[164:167], v[80:83]
  buffer_load_dwordx4 v12, s[8:11], s30 offen offset:2048 lds
  v_mfma_f32_16x16x32_bf16 v[84:87], a[224:227], v[164:167], v[84:87]
  v_mfma_f32_16x16x32_bf16 v[88:91], a[216:219], v[168:171], v[88:91]
  ds_read_b128 v[200:203], v19 offset:4096
  v_mfma_f32_16x16x32_bf16 v[92:95], a[220:223], v[168:171], v[92:95]
  v_mfma_f32_16x16x32_bf16 v[96:99], a[224:227], v[168:171], v[96:99]
  v_mfma_f32_16x16x32_bf16 v[100:103], a[216:219], v[172:175], v[100:103]
  ds_read_b128 v[204:207], v19 offset:6144
  v_mfma_f32_16x16x32_bf16 v[104:107], a[220:223], v[172:175], v[104:107]
  v_mfma_f32_16x16x32_bf16 v[108:111], a[224:227], v[172:175], v[108:111]
  s_waitcnt lgkmcnt(4)
  v_mfma_f32_16x16x32_bf16 v[112:115], a[216:219], v[176:179], v[112:115]
  ds_read_b128 v[208:211], v19 offset:8192
  v_mfma_f32_16x16x32_bf16 v[116:119], a[220:223], v[176:179], v[116:119]
  v_mfma_f32_16x16x32_bf16 v[120:123], a[224:227], v[176:179], v[120:123]
  v_mfma_f32_16x16x32_bf16 v[124:127], a[216:219], v[180:183], v[124:127]
  ds_read_b128 v[212:215], v19 offset:10240
  v_mfma_f32_16x16x32_bf16 v[128:131], a[220:223], v[180:183], v[128:131]
  buffer_load_dwordx4 v13, s[8:11], s30 offen offset:3072 lds
  v_mfma_f32_16x16x32_bf16 v[132:135], a[224:227], v[180:183], v[132:135]
  s_add_u32 s30, s30, 128
  s_add_u32 m0, m0, 16384
  v_mfma_f32_16x16x32_bf16 v[136:139], a[216:219], v[184:187], v[136:139]
  ds_read_b128 v[216:219], v19 offset:12288
  v_mfma_f32_16x16x32_bf16 v[140:143], a[220:223], v[184:187], v[140:143]
  s_cmp_lt_u32 m0, s46
  s_cselect_b32 m0, m0, s47
  v_mfma_f32_16x16x32_bf16 v[144:147], a[224:227], v[184:187], v[144:147]
  v_mfma_f32_16x16x32_bf16 v[148:151], a[216:219], v[188:191], v[148:151]
  ds_read_b128 v[220:223], v19 offset:14336
  v_mfma_f32_16x16x32_bf16 v[152:155], a[220:223], v[188:191], v[152:155]
  v_mfma_f32_16x16x32_bf16 v[156:159], a[224:227], v[188:191], v[156:159]
  s_waitcnt vmcnt(12) lgkmcnt(4)
  s_barrier
  v_mfma_f32_16x16x32_bf16 v[64:67], a[228:231], v[192:195], v[64:67]
  ds_read_b128 v[160:163], v18 offset:0
  v_mfma_f32_16x16x32_bf16 v[68:71], a[232:235], v[192:195], v[68:71]
  v_mfma_f32_16x16x32_bf16 v[72:75], a[236:239], v[192:195], v[72:75]
  v_add_u32 v19, s33, v15
  s_add_u32 s33, s33, 16384
  v_mfma_f32_16x16x32_bf16 v[76:79], a[228:231], v[196:199], v[76:79]
  ds_read_b128 v[164:167], v18 offset:2048
  v_cvt_pk_bf16_f32 v224, v64, v65
  v_mfma_f32_16x16x32_bf16 v[80:83], a[232:235], v[196:199], v[80:83]
  buffer_load_dwordx4 v10, s[8:11], s30 offen offset:0 lds
  v_mfma_f32_16x16x32_bf16 v[84:87], a[236:239], v[196:199], v[84:87]
  s_cmp_lt_u32 s33, 98304
  s_cselect_b32 s33, s33, 0
  v_mfma_f32_16x16x32_bf16 v[88:91], a[228:231], v[200:203], v[88:91]
  ds_read_b128 v[168:171], v18 offset:4096
  v_cvt_pk_bf16_f32 v225, v66, v67
  v_mfma_f32_16x16x32_bf16 v[92:95], a[232:235], v[200:203], v[92:95]
  v_cvt_pk_bf16_f32 v226, v68, v69
  v_cvt_pk_bf16_f32 v227, v70, v71
  v_mfma_f32_16x16x32_bf16 v[96:99], a[236:239], v[200:203], v[96:99]
  v_cvt_pk_bf16_f32 v228, v72, v73
  v_cvt_pk_bf16_f32 v229, v74, v75
  v_mfma_f32_16x16x32_bf16 v[100:103], a[228:231], v[204:207], v[100:103]
  ds_read_b128 v[172:175], v18 offset:6144
  v_mfma_f32_16x16x32_bf16 v[104:107], a[232:235], v[204:207], v[104:107]
  ds_write_b64 v22, v[224:225] offset:0
  v_mfma_f32_16x16x32_bf16 v[108:111], a[236:239], v[204:207], v[108:111]
  s_waitcnt lgkmcnt(5)
  v_mfma_f32_16x16x32_bf16 v[112:115], a[228:231], v[208:211], v[112:115]
  ds_read_b128 v[176:179], v18 offset:8192
  v_mfma_f32_16x16x32_bf16 v[116:119], a[232:235], v[208:211], v[116:119]
  ds_write_b64 v22, v[226:227] offset:8
  v_mfma_f32_16x16x32_bf16 v[120:123], a[236:239], v[208:211], v[120:123]
  ds_write_b64 v16, v[228:229] offset:64
  v_mfma_f32_16x16x32_bf16 v[124:127], a[228:231], v[212:215], v[124:127]
  ds_read_b128 v[180:183], v18 offset:10240
  v_cvt_pk_bf16_f32 v230, v76, v77
  v_mfma_f32_16x16x32_bf16 v[128:131], a[232:235], v[212:215], v[128:131]
  buffer_load_dwordx4 v11, s[8:11], s30 offen offset:1024 lds
  v_mfma_f32_16x16x32_bf16 v[132:135], a[236:239], v[212:215], v[132:135]
  v_cvt_pk_bf16_f32 v231, v78, v79
  v_cvt_pk_bf16_f32 v232, v80, v81
  v_mfma_f32_16x16x32_bf16 v[136:139], a[228:231], v[216:219], v[136:139]
  ds_read_b128 v[184:187], v18 offset:12288
  v_cvt_pk_bf16_f32 v233, v82, v83
  v_mfma_f32_16x16x32_bf16 v[140:143], a[232:235], v[216:219], v[140:143]
  v_cvt_pk_bf16_f32 v234, v84, v85
  v_cvt_pk_bf16_f32 v235, v86, v87
  v_mfma_f32_16x16x32_bf16 v[144:147], a[236:239], v[216:219], v[144:147]
  ds_write_b64 v22, v[230:231] offset:6400
  v_mfma_f32_16x16x32_bf16 v[148:151], a[228:231], v[220:223], v[148:151]
  ds_read_b128 v[188:191], v18 offset:14336
  v_mfma_f32_16x16x32_bf16 v[152:155], a[232:235], v[220:223], v[152:155]
  ds_write_b64 v22, v[232:233] offset:6408
  v_mfma_f32_16x16x32_bf16 v[156:159], a[236:239], v[220:223], v[156:159]
  s_waitcnt lgkmcnt(9)
kv_end_158:
  s_cmp_gt_u32 s26, 0
  s_cbranch_scc1 kv_blk_157
  s_nop 7
  ds_write_b64 v16, v[234:235] offset:6464
  v_cvt_pk_bf16_f32 v236, v88, v89
  v_cvt_pk_bf16_f32 v237, v90, v91
  v_cvt_pk_bf16_f32 v238, v92, v93
  v_cvt_pk_bf16_f32 v239, v94, v95
  v_cvt_pk_bf16_f32 v240, v96, v97
  v_cvt_pk_bf16_f32 v241, v98, v99
  ds_write_b64 v22, v[236:237] offset:12800
  ds_write_b64 v22, v[238:239] offset:12808
  ds_write_b64 v16, v[240:241] offset:12864
  v_cvt_pk_bf16_f32 v242, v100, v101
  v_cvt_pk_bf16_f32 v243, v102, v103
  v_cvt_pk_bf16_f32 v244, v104, v105
  v_cvt_pk_bf16_f32 v245, v106, v107
  v_cvt_pk_bf16_f32 v246, v108, v109
  v_cvt_pk_bf16_f32 v247, v110, v111
  ds_write_b64 v22, v[242:243] offset:19200
  ds_write_b64 v22, v[244:245] offset:19208
  ds_write_b64 v16, v[246:247] offset:19264
  v_cvt_pk_bf16_f32 v224, v112, v113
  v_cvt_pk_bf16_f32 v225, v114, v115
  v_cvt_pk_bf16_f32 v226, v116, v117
  v_cvt_pk_bf16_f32 v227, v118, v119
  v_cvt_pk_bf16_f32 v228, v120, v121
  v_cvt_pk_bf16_f32 v229, v122, v123
  ds_write_b64 v22, v[224:225] offset:25600
  ds_write_b64 v22, v[226:227] offset:25608
  ds_write_b64 v16, v[228:229] offset:25664
  v_cvt_pk_bf16_f32 v230, v124, v125
  v_cvt_pk_bf16_f32 v231, v126, v127
  v_cvt_pk_bf16_f32 v232, v128, v129
  v_cvt_pk_bf16_f32 v233, v130, v131
  v_cvt_pk_bf16_f32 v234, v132, v133
  v_cvt_pk_bf16_f32 v235, v134, v135
  ds_write_b64 v22, v[230:231] offset:32000
  ds_write_b64 v22, v[232:233] offset:32008
  ds_write_b64 v16, v[234:235] offset:32064
  v_cvt_pk_bf16_f32 v236, v136, v137
  v_cvt_pk_bf16_f32 v237, v138, v139
  v_cvt_pk_bf16_f32 v238, v140, v141
  v_cvt_pk_bf16_f32 v239, v142, v143
  v_cvt_pk_bf16_f32 v240, v144, v145
  v_cvt_pk_bf16_f32 v241, v146, v147
  ds_write_b64 v22, v[236:237] offset:38400
  ds_write_b64 v22, v[238:239] offset:38408
  ds_write_b64 v16, v[240:241] offset:38464
  v_cvt_pk_bf16_f32 v242, v148, v149
  v_cvt_pk_bf16_f32 v243, v150, v151
  v_cvt_pk_bf16_f32 v244, v152, v153
  v_cvt_pk_bf16_f32 v245, v154, v155
  v_cvt_pk_bf16_f32 v246, v156, v157
  v_cvt_pk_bf16_f32 v247, v158, v159
  ds_write_b64 v22, v[242:243] offset:44800
  ds_write_b64 v22, v[244:245] offset:44808
  ds_write_b64 v16, v[246:247] offset:44864
  s_waitcnt vmcnt(0) lgkmcnt(0)
  s_barrier
  ds_read_b128 v[224:227], v23 offset:0
  ds_read_b128 v[228:231], v23 offset:64
  ds_read_b128 v[232:235], v23 offset:128
  ds_read_b128 v[236:239], v23 offset:192
  ds_read_b128 v[240:243], v23 offset:256
  ds_read_b128 v[244:247], v23 offset:320
  s_waitcnt lgkmcnt(0)
  s_add_u32 s21, s48, 0
  buffer_store_dwordx4 v[224:227], v26, s[16:19], s21 offen offset:0 sc1
  buffer_store_dwordx4 v[228:231], v26, s[16:19], s21 offen offset:1024 sc1
  buffer_store_dwordx4 v[232:235], v26, s[16:19], s21 offen offset:2048 sc1
  buffer_store_dwordx4 v[236:239], v26, s[16:19], s21 offen offset:3072 sc1
  s_add_u32 s21, s48, 4096
  buffer_store_dwordx4 v[240:243], v26, s[16:19], s21 offen offset:0 sc1
  buffer_store_dwordx4 v[244:247], v26, s[16:19], s21 offen offset:1024 sc1
  s_nop 1
  ds_read_b128 v[224:227], v23 offset:6400
  ds_read_b128 v[228:231], v23 offset:6464
  ds_read_b128 v[232:235], v23 offset:6528
  ds_read_b128 v[236:239], v23 offset:6592
  ds_read_b128 v[240:243], v23 offset:6656
  ds_read_b128 v[244:247], v23 offset:6720
  s_waitcnt lgkmcnt(0)
  buffer_store_dwordx4 v[224:227], v26, s[16:19], s21 offen offset:2048 sc1
  buffer_store_dwordx4 v[228:231], v26, s[16:19], s21 offen offset:3072 sc1
  s_add_u32 s21, s48, 8192
  buffer_store_dwordx4 v[232:235], v26, s[16:19], s21 offen offset:0 sc1
  buffer_store_dwordx4 v[236:239], v26, s[16:19], s21 offen offset:1024 sc1
  buffer_store_dwordx4 v[240:243], v26, s[16:19], s21 offen offset:2048 sc1
  buffer_store_dwordx4 v[244:247], v26, s[16:19], s21 offen offset:3072 sc1
  s_nop 1
  s_waitcnt vmcnt(0)
  s_barrier
  s_cmp_lg_u32 s20, 0
  s_cbranch_scc1 af_159
  v_mov_b32 v4, 0
  v_mov_b32 v5, 1
  s_mov_b64 exec, 1
  buffer_atomic_add v5, v4, s[72:75], s61 offen sc1
  s_mov_b64 exec, -1
  s_nop 1
af_159:
  s_cmp_lg_u32 s43, 0
  s_cbranch_scc1 kv_fin
  s_mov_b32 s87, -2
  s_add_u32 s21, s42, 32
  s_branch do_opb2
kv_help:
  s_waitcnt vmcnt(0) lgkmcnt(0)
  s_barrier
  s_load_dwordx2 s[4:5], s[0:1], 0
  s_load_dwordx2 s[6:7], s[0:1], 24
  s_load_dwordx2 s[36:37], s[0:1], 32
  s_load_dwordx2 s[38:39], s[0:1], 104
  s_and_b32 s43, s3, 1
  s_bfe_u32 s42, s3, 0x50001
  s_lshr_b32 s40, s42, 2
  s_waitcnt lgkmcnt(0)
  s_cmp_eq_u32 s43, 1
  s_cselect_b32 s6, s36, s6
  s_cselect_b32 s7, s37, s7
  s_mov_b32 s8, s4
  s_mov_b32 s9, s5
  s_mov_b32 s10, 2621440
  s_mov_b32 s11, 0x00020000
  s_mov_b32 s12, s6
  s_mov_b32 s13, s7
  s_mov_b32 s14, 7864320
  s_mov_b32 s15, 0x00020000
  s_mov_b32 s16, s38
  s_mov_b32 s17, s39
  s_mov_b32 s18, 50331648
  s_mov_b32 s19, 0x00020000
  s_mul_i32 s44, s42, 384
  s_mov_b32 s28, 1572864
  s_mov_b32 s43, 2
  s_load_dwordx2 s[6:7], s[0:1], 16
  s_waitcnt lgkmcnt(0)
  s_mov_b32 s12, s6
  s_mov_b32 s13, s7
  s_mov_b32 s14, 7864320
  s_mov_b32 s15, 0x00020000
  s_add_u32 s16, s38, 201326592
  s_addc_u32 s17, s39, 0
  s_mov_b32 s18, 6291456
  s_mov_b32 s19, 0x00020000
  v_mov_b32 v9, 2731
  v_add_u32 v8, 0, v1
  v_mul_u32_u24 v7, v8, v9
  v_lshrrev_b32 v7, 16, v7
  v_mul_u32_u24 v4, 24, v7
  v_sub_u32 v8, v8, v4
  s_mov_b32 s21, 12288
  v_mul_lo_u32 v7, v7, s21
  v_lshl_add_u32 v4, v8, 4, v7
  v_add_u32 v8, 64, v1
  v_mul_u32_u24 v7, v8, v9
  v_lshrrev_b32 v7, 16, v7
  v_mul_u32_u24 v5, 24, v7
  v_sub_u32 v8, v8, v5
  s_mov_b32 s21, 12288
  v_mul_lo_u32 v7, v7, s21
  v_lshl_add_u32 v5, v8, 4, v7
  v_add_u32 v8, 128, v1
  v_mul_u32_u24 v7, v8, v9
  v_lshrrev_b32 v7, 16, v7
  v_mul_u32_u24 v6, 24, v7
  v_sub_u32 v8, v8, v6
  s_mov_b32 s21, 12288
  v_mul_lo_u32 v7, v7, s21
  v_lshl_add_u32 v6, v8, 4, v7
  v_lshrrev_b32 v7, 2, v2
  v_lshl_add_u32 v7, v3, 3, v7
  v_mul_u32_u24 v7, 384, v7
  v_and_b32 v8, 3, v2
  v_lshlrev_b32 v8, 3, v8
  s_mul_i32 s21, s20, 96
  v_add3_u32 v7, v7, v8, s21
  v_add_u32 v8, 61440, v7
  s_mul_i32 s21, s20, 491520
  s_add_u32 s21, s21, 0
  s_add_u32 s21, s21, s44
  s_mul_i32 s22, s20, 15360
  s_add_u32 s22, s22, 0
  s_add_u32 m0, s22, 0
  s_nop 0
  buffer_load_dwordx4 v4, s[12:15], s21 offen lds
  s_add_u32 m0, s22, 1024
  s_nop 0
  buffer_load_dwordx4 v5, s[12:15], s21 offen lds
  s_add_u32 m0, s22, 2048
  s_nop 0
  buffer_load_dwordx4 v6, s[12:15], s21 offen lds
  s_mul_i32 s21, s20, 491520
  s_add_u32 s21, s21, 98304
  s_add_u32 s21, s21, s44
  s_mul_i32 s22, s20, 15360
  s_add_u32 s22, s22, 3072
  s_add_u32 m0, s22, 0
  s_nop 0
  buffer_load_dwordx4 v4, s[12:15], s21 offen lds
  s_add_u32 m0, s22, 1024
  s_nop 0
  buffer_load_dwordx4 v5, s[12:15], s21 offen lds
  s_add_u32 m0, s22, 2048
  s_nop 0
  buffer_load_dwordx4 v6, s[12:15], s21 offen lds
  s_mul_i32 s21, s20, 491520
  s_add_u32 s21, s21, 196608
  s_add_u32 s21, s21, s44
  s_mul_i32 s22, s20, 15360
  s_add_u32 s22, s22, 6144
  s_add_u32 m0, s22, 0
  s_nop 0
  buffer_load_dwordx4 v4, s[12:15], s21 offen lds
  s_add_u32 m0, s22, 1024
  s_nop 0
  buffer_load_dwordx4 v5, s[12:15], s21 offen lds
  s_add_u32 m0, s22, 2048
  s_nop 0
  buffer_load_dwordx4 v6, s[12:15], s21 offen lds
  s_mul_i32 s21, s20, 491520
  s_add_u32 s21, s21, 294912
  s_add_u32 s21, s21, s44
  s_mul_i32 s22, s20, 15360
  s_add_u32 s22, s22, 9216
  s_add_u32 m0, s22, 0
  s_nop 0
  buffer_load_dwordx4 v4, s[12:15], s21 offen lds
  s_add_u32 m0, s22, 1024
  s_nop 0
  buffer_load_dwordx4 v5, s[12:15], s21 offen lds
  s_add_u32 m0, s22, 2048
  s_nop 0
  buffer_load_dwordx4 v6, s[12:15], s21 offen lds
  s_mul_i32 s21, s20, 491520
  s_add_u32 s21, s21, 393216
  s_add_u32 s21, s21, s44
  s_mul_i32 s22, s20, 15360
  s_add_u32 s22, s22, 12288
  s_add_u32 m0, s22, 0
  s_nop 0
  buffer_load_dwordx4 v4, s[12:15], s21 offen lds
  s_add_u32 m0, s22, 1024
  s_nop 0
  buffer_load_dwordx4 v5, s[12:15], s21 offen lds
  s_add_u32 m0, s22, 2048
  s_nop 0
  buffer_load_dwordx4 v6, s[12:15], s21 offen lds
  s_mul_i32 s21, s20, 491520
  s_add_u32 s21, s21, 1966080
  s_add_u32 s21, s21, s44
  s_mul_i32 s22, s20, 15360
  s_add_u32 s22, s22, 61440
  s_add_u32 m0, s22, 0
  s_nop 0
  buffer_load_dwordx4 v4, s[12:15], s21 offen lds
  s_add_u32 m0, s22, 1024
  s_nop 0
  buffer_load_dwordx4 v5, s[12:15], s21 offen lds
  s_add_u32 m0, s22, 2048
  s_nop 0
  buffer_load_dwordx4 v6, s[12:15], s21 offen lds
  s_mul_i32 s21, s20, 491520
  s_add_u32 s21, s21, 2064384
  s_add_u32 s21, s21, s44
  s_mul_i32 s22, s20, 15360
  s_add_u32 s22, s22, 64512
  s_add_u32 m0, s22, 0
  s_nop 0
  buffer_load_dwordx4 v4, s[12:15], s21 offen lds
  s_add_u32 m0, s22, 1024
  s_nop 0
  buffer_load_dwordx4 v5, s[12:15], s21 offen lds
  s_add_u32 m0, s22, 2048
  s_nop 0
  buffer_load_dwordx4 v6, s[12:15], s21 offen lds
  s_mul_i32 s21, s20, 491520
  s_add_u32 s21, s21, 2162688
  s_add_u32 s21, s21, s44
  s_mul_i32 s22, s20, 15360
  s_add_u32 s22, s22, 67584
  s_add_u32 m0, s22, 0
  s_nop 0
  buffer_load_dwordx4 v4, s[12:15], s21 offen lds
  s_add_u32 m0, s22, 1024
  s_nop 0
  buffer_load_dwordx4 v5, s[12:15], s21 offen lds
  s_add_u32 m0, s22, 2048
  s_nop 0
  buffer_load_dwordx4 v6, s[12:15], s21 offen lds
  s_mul_i32 s21, s20, 491520
  s_add_u32 s21, s21, 2260992
  s_add_u32 s21, s21, s44
  s_mul_i32 s22, s20, 15360
  s_add_u32 s22, s22, 70656
  s_add_u32 m0, s22, 0
  s_nop 0
  buffer_load_dwordx4 v4, s[12:15], s21 offen lds
  s_add_u32 m0, s22, 1024
  s_nop 0
  buffer_load_dwordx4 v5, s[12:15], s21 offen lds
  s_add_u32 m0, s22, 2048
  s_nop 0
  buffer_load_dwordx4 v6, s[12:15], s21 offen lds
  s_mul_i32 s21, s20, 491520
  s_add_u32 s21, s21, 2359296
  s_add_u32 s21, s21, s44
  s_mul_i32 s22, s20, 15360
  s_add_u32 s22, s22, 73728
  s_add_u32 m0, s22, 0
  s_nop 0
  buffer_load_dwordx4 v4, s[12:15], s21 offen lds
  s_add_u32 m0, s22, 1024
  s_nop 0
  buffer_load_dwordx4 v5, s[12:15], s21 offen lds
  s_add_u32 m0, s22, 2048
  s_nop 0
  buffer_load_dwordx4 v6, s[12:15], s21 offen lds
  s_mul_i32 s21, s20, 491520
  s_add_u32 s21, s21, 3932160
  s_add_u32 s21, s21, s44
  buffer_load_dwordx4 v[64:67], v4, s[12:15], s21 offen
  buffer_load_dwordx4 v[68:71], v5, s[12:15], s21 offen
  buffer_load_dwordx4 v[72:75], v6, s[12:15], s21 offen
  s_mul_i32 s21, s20, 491520
  s_add_u32 s21, s21, 4030464
  s_add_u32 s21, s21, s44
  buffer_load_dwordx4 v[76:79], v4, s[12:15], s21 offen
  buffer_load_dwordx4 v[80:83], v5, s[12:15], s21 offen
  buffer_load_dwordx4 v[84:87], v6, s[12:15], s21 offen
  s_mul_i32 s21, s20, 491520
  s_add_u32 s21, s21, 4128768
  s_add_u32 s21, s21, s44
  buffer_load_dwordx4 v[88:91], v4, s[12:15], s21 offen
  buffer_load_dwordx4 v[92:95], v5, s[12:15], s21 offen
  buffer_load_dwordx4 v[96:99], v6, s[12:15], s21 offen
  s_mul_i32 s21, s20, 491520
  s_add_u32 s21, s21, 4227072
  s_add_u32 s21, s21, s44
  buffer_load_dwordx4 v[100:103], v4, s[12:15], s21 offen
  buffer_load_dwordx4 v[104:107], v5, s[12:15], s21 offen
  buffer_load_dwordx4 v[108:111], v6, s[12:15], s21 offen
  s_mul_i32 s21, s20, 491520
  s_add_u32 s21, s21, 4325376
  s_add_u32 s21, s21, s44
  buffer_load_dwordx4 v[112:115], v4, s[12:15], s21 offen
  buffer_load_dwordx4 v[116:119], v5, s[12:15], s21 offen
  buffer_load_dwordx4 v[120:123], v6, s[12:15], s21 offen
  s_mul_i32 s21, s20, 491520
  s_add_u32 s21, s21, 5898240
  s_add_u32 s21, s21, s44
  buffer_load_dwordx4 v[124:127], v4, s[12:15], s21 offen
  buffer_load_dwordx4 v[128:131], v5, s[12:15], s21 offen
  buffer_load_dwordx4 v[132:135], v6, s[12:15], s21 offen
  s_mul_i32 s21, s20, 491520
  s_add_u32 s21, s21, 5996544
  s_add_u32 s21, s21, s44
  buffer_load_dwordx4 v[136:139], v4, s[12:15], s21 offen
  buffer_load_dwordx4 v[140:143], v5, s[12:15], s21 offen
  buffer_load_dwordx4 v[144:147], v6, s[12:15], s21 offen
  s_mul_i32 s21, s20, 491520
  s_add_u32 s21, s21, 6094848
  s_add_u32 s21, s21, s44
  buffer_load_dwordx4 v[148:151], v4, s[12:15], s21 offen
  buffer_load_dwordx4 v[152:155], v5, s[12:15], s21 offen
  buffer_load_dwordx4 v[156:159], v6, s[12:15], s21 offen
  s_mul_i32 s21, s20, 491520
  s_add_u32 s21, s21, 6193152
  s_add_u32 s21, s21, s44
  buffer_load_dwordx4 v[160:163], v4, s[12:15], s21 offen
  buffer_load_dwordx4 v[164:167], v5, s[12:15], s21 offen
  buffer_load_dwordx4 v[168:171], v6, s[12:15], s21 offen
  s_mul_i32 s21, s20, 491520
  s_add_u32 s21, s21, 6291456
  s_add_u32 s21, s21, s44
  buffer_load_dwordx4 v[172:175], v4, s[12:15], s21 offen
  buffer_load_dwordx4 v[176:179], v5, s[12:15], s21 offen
  buffer_load_dwordx4 v[180:183], v6, s[12:15], s21 offen
  s_mul_i32 s22, s20, 15360
  v_lshl_add_u32 v30, v1, 4, s22
  v_add_u32 v31, 61440, v30
  s_waitcnt vmcnt(45)
  s_barrier
  ds_read_b64_tr_b16 a[0:1], v7 offset:0
  ds_read_b64_tr_b16 a[2:3], v7 offset:1536
  ds_read_b64_tr_b16 a[4:5], v7 offset:32
  ds_read_b64_tr_b16 a[6:7], v7 offset:1568
  ds_read_b64_tr_b16 a[8:9], v7 offset:64
  ds_read_b64_tr_b16 a[10:11], v7 offset:1600
  ds_read_b64_tr_b16 a[12:13], v7 offset:12288
  ds_read_b64_tr_b16 a[14:15], v7 offset:13824
  ds_read_b64_tr_b16 a[16:17], v7 offset:12320
  ds_read_b64_tr_b16 a[18:19], v7 offset:13856
  ds_read_b64_tr_b16 a[20:21], v7 offset:12352
  ds_read_b64_tr_b16 a[22:23], v7 offset:13888
  ds_read_b64_tr_b16 a[24:25], v7 offset:24576
  ds_read_b64_tr_b16 a[26:27], v7 offset:26112
  ds_read_b64_tr_b16 a[28:29], v7 offset:24608
  ds_read_b64_tr_b16 a[30:31], v7 offset:26144
  ds_read_b64_tr_b16 a[32:33], v7 offset:24640
  ds_read_b64_tr_b16 a[34:35], v7 offset:26176
  ds_read_b64_tr_b16 a[36:37], v7 offset:36864
  ds_read_b64_tr_b16 a[38:39], v7 offset:38400
  ds_read_b64_tr_b16 a[40:41], v7 offset:36896
  ds_read_b64_tr_b16 a[42:43], v7 offset:38432
  ds_read_b64_tr_b16 a[44:45], v7 offset:36928
  ds_read_b64_tr_b16 a[46:47], v7 offset:38464
  ds_read_b64_tr_b16 a[48:49], v7 offset:49152
  ds_read_b64_tr_b16 a[50:51], v7 offset:50688
  ds_read_b64_tr_b16 a[52:53], v7 offset:49184
  ds_read_b64_tr_b16 a[54:55], v7 offset:50720
  ds_read_b64_tr_b16 a[56:57], v7 offset:49216
  ds_read_b64_tr_b16 a[58:59], v7 offset:50752
  s_waitcnt lgkmcnt(0)
  s_barrier
  s_waitcnt vmcnt(30)
  s_barrier
  ds_read_b64_tr_b16 a[60:61], v8 offset:0
  ds_read_b64_tr_b16 a[62:63], v8 offset:1536
  ds_read_b64_tr_b16 a[64:65], v8 offset:32
  ds_read_b64_tr_b16 a[66:67], v8 offset:1568
  ds_read_b64_tr_b16 a[68:69], v8 offset:64
  ds_read_b64_tr_b16 a[70:71], v8 offset:1600
  ds_read_b64_tr_b16 a[72:73], v8 offset:12288
  ds_read_b64_tr_b16 a[74:75], v8 offset:13824
  ds_read_b64_tr_b16 a[76:77], v8 offset:12320
  ds_read_b64_tr_b16 a[78:79], v8 offset:13856
  ds_read_b64_tr_b16 a[80:81], v8 offset:12352
  ds_read_b64_tr_b16 a[82:83], v8 offset:13888
  ds_read_b64_tr_b16 a[84:85], v8 offset:24576
  ds_read_b64_tr_b16 a[86:87], v8 offset:26112
  ds_read_b64_tr_b16 a[88:89], v8 offset:24608
  ds_read_b64_tr_b16 a[90:91], v8 offset:26144
  ds_read_b64_tr_b16 a[92:93], v8 offset:24640
  ds_read_b64_tr_b16 a[94:95], v8 offset:26176
  ds_read_b64_tr_b16 a[96:97], v8 offset:36864
  ds_read_b64_tr_b16 a[98:99], v8 offset:38400
  ds_read_b64_tr_b16 a[100:101], v8 offset:36896
  ds_read_b64_tr_b16 a[102:103], v8 offset:38432
  ds_read_b64_tr_b16 a[104:105], v8 offset:36928
  ds_read_b64_tr_b16 a[106:107], v8 offset:38464
  ds_read_b64_tr_b16 a[108:109], v8 offset:49152
  ds_read_b64_tr_b16 a[110:111], v8 offset:50688
  ds_read_b64_tr_b16 a[112:113], v8 offset:49184
  ds_read_b64_tr_b16 a[114:115], v8 offset:50720
  ds_read_b64_tr_b16 a[116:117], v8 offset:49216
  ds_read_b64_tr_b16 a[118:119], v8 offset:50752
  s_waitcnt lgkmcnt(0)
  s_barrier
  s_waitcnt vmcnt(15)
  ds_write_b128 v30, v[64:67] offset:0
  ds_write_b128 v30, v[68:71] offset:1024
  ds_write_b128 v30, v[72:75] offset:2048
  ds_write_b128 v30, v[76:79] offset:3072
  ds_write_b128 v30, v[80:83] offset:4096
  ds_write_b128 v30, v[84:87] offset:5120
  ds_write_b128 v30, v[88:91] offset:6144
  ds_write_b128 v30, v[92:95] offset:7168
  ds_write_b128 v30, v[96:99] offset:8192
  ds_write_b128 v30, v[100:103] offset:9216
  ds_write_b128 v30, v[104:107] offset:10240
  ds_write_b128 v30, v[108:111] offset:11264
  ds_write_b128 v30, v[112:115] offset:12288
  ds_write_b128 v30, v[116:119] offset:13312
  ds_write_b128 v30, v[120:123] offset:14336
  s_waitcnt lgkmcnt(0)
  s_barrier
  ds_read_b64_tr_b16 a[120:121], v7 offset:0
  ds_read_b64_tr_b16 a[122:123], v7 offset:1536
  ds_read_b64_tr_b16 a[124:125], v7 offset:32
  ds_read_b64_tr_b16 a[126:127], v7 offset:1568
  ds_read_b64_tr_b16 a[128:129], v7 offset:64
  ds_read_b64_tr_b16 a[130:131], v7 offset:1600
  ds_read_b64_tr_b16 a[132:133], v7 offset:12288
  ds_read_b64_tr_b16 a[134:135], v7 offset:13824
  ds_read_b64_tr_b16 a[136:137], v7 offset:12320
  ds_read_b64_tr_b16 a[138:139], v7 offset:13856
  ds_read_b64_tr_b16 a[140:141], v7 offset:12352
  ds_read_b64_tr_b16 a[142:143], v7 offset:13888
  ds_read_b64_tr_b16 a[144:145], v7 offset:24576
  ds_read_b64_tr_b16 a[146:147], v7 offset:26112
  ds_read_b64_tr_b16 a[148:149], v7 offset:24608
  ds_read_b64_tr_b16 a[150:151], v7 offset:26144
  ds_read_b64_tr_b16 a[152:153], v7 offset:24640
  ds_read_b64_tr_b16 a[154:155], v7 offset:26176
  ds_read_b64_tr_b16 a[156:157], v7 offset:36864
  ds_read_b64_tr_b16 a[158:159], v7 offset:38400
  ds_read_b64_tr_b16 a[160:161], v7 offset:36896
  ds_read_b64_tr_b16 a[162:163], v7 offset:38432
  ds_read_b64_tr_b16 a[164:165], v7 offset:36928
  ds_read_b64_tr_b16 a[166:167], v7 offset:38464
  ds_read_b64_tr_b16 a[168:169], v7 offset:49152
  ds_read_b64_tr_b16 a[170:171], v7 offset:50688
  ds_read_b64_tr_b16 a[172:173], v7 offset:49184
  ds_read_b64_tr_b16 a[174:175], v7 offset:50720
  ds_read_b64_tr_b16 a[176:177], v7 offset:49216
  ds_read_b64_tr_b16 a[178:179], v7 offset:50752
  s_waitcnt lgkmcnt(0)
  s_barrier
  s_waitcnt vmcnt(0)
  ds_write_b128 v31, v[124:127] offset:0
  ds_write_b128 v31, v[128:131] offset:1024
  ds_write_b128 v31, v[132:135] offset:2048
  ds_write_b128 v31, v[136:139] offset:3072
  ds_write_b128 v31, v[140:143] offset:4096
  ds_write_b128 v31, v[144:147] offset:5120
  ds_write_b128 v31, v[148:151] offset:6144
  ds_write_b128 v31, v[152:155] offset:7168
  ds_write_b128 v31, v[156:159] offset:8192
  ds_write_b128 v31, v[160:163] offset:9216
  ds_write_b128 v31, v[164:167] offset:10240
  ds_write_b128 v31, v[168:171] offset:11264
  ds_write_b128 v31, v[172:175] offset:12288
  ds_write_b128 v31, v[176:179] offset:13312
  ds_write_b128 v31, v[180:183] offset:14336
  s_waitcnt lgkmcnt(0)
  s_barrier
  ds_read_b64_tr_b16 a[180:181], v8 offset:0
  ds_read_b64_tr_b16 a[182:183], v8 offset:1536
  ds_read_b64_tr_b16 a[184:185], v8 offset:32
  ds_read_b64_tr_b16 a[186:187], v8 offset:1568
  ds_read_b64_tr_b16 a[188:189], v8 offset:64
  ds_read_b64_tr_b16 a[190:191], v8 offset:1600
  ds_read_b64_tr_b16 a[192:193], v8 offset:12288
  ds_read_b64_tr_b16 a[194:195], v8 offset:13824
  ds_read_b64_tr_b16 a[196:197], v8 offset:12320
  ds_read_b64_tr_b16 a[198:199], v8 offset:13856
  ds_read_b64_tr_b16 a[200:201], v8 offset:12352
  ds_read_b64_tr_b16 a[202:203], v8 offset:13888
  ds_read_b64_tr_b16 a[204:205], v8 offset:24576
  ds_read_b64_tr_b16 a[206:207], v8 offset:26112
  ds_read_b64_tr_b16 a[208:209], v8 offset:24608
  ds_read_b64_tr_b16 a[210:211], v8 offset:26144
  ds_read_b64_tr_b16 a[212:213], v8 offset:24640
  ds_read_b64_tr_b16 a[214:215], v8 offset:26176
  ds_read_b64_tr_b16 a[216:217], v8 offset:36864
  ds_read_b64_tr_b16 a[218:219], v8 offset:38400
  ds_read_b64_tr_b16 a[220:221], v8 offset:36896
  ds_read_b64_tr_b16 a[222:223], v8 offset:38432
  ds_read_b64_tr_b16 a[224:225], v8 offset:36928
  ds_read_b64_tr_b16 a[226:227], v8 offset:38464
  ds_read_b64_tr_b16 a[228:229], v8 offset:49152
  ds_read_b64_tr_b16 a[230:231], v8 offset:50688
  ds_read_b64_tr_b16 a[232:233], v8 offset:49184
  ds_read_b64_tr_b16 a[234:235], v8 offset:50720
  ds_read_b64_tr_b16 a[236:237], v8 offset:49216
  ds_read_b64_tr_b16 a[238:239], v8 offset:50752
  s_waitcnt lgkmcnt(0)
  s_barrier
  s_mov_b32 s24, 1966080
  s_mov_b32 s25, 163840
  v_lshrrev_b32 v11, 3, v1
  v_and_b32 v12, 7, v1
  v_xor_b32 v12, v12, v11
  v_mul_u32_u24 v11, 1280, v11
  v_lshl_add_u32 v10, v12, 4, v11
  s_mul_i32 s46, s20, 40960
  v_add_u32 v10, s46, v10
  s_lshl_b32 s47, s20, 12
  s_add_u32 s47, s47, 0
  s_add_u32 s46, s47, 98304
  s_mov_b32 s30, s24
  s_add_u32 s32, s47, 32768
  v_add_u32 v11, 9216, v10
  v_add_u32 v12, 18432, v10
  v_add_u32 v13, 27648, v10
  s_mov_b32 m0, s32
  s_nop 0
  buffer_load_dwordx4 v10, s[8:11], s30 offen offset:0 lds
  buffer_load_dwordx4 v11, s[8:11], s30 offen offset:1024 lds
  buffer_load_dwordx4 v12, s[8:11], s30 offen offset:2048 lds
  buffer_load_dwordx4 v13, s[8:11], s30 offen offset:3072 lds
  s_add_u32 s30, s30, 128
  s_add_u32 s32, s32, 16384
  s_cmp_lt_u32 s32, s46
  s_cselect_b32 s32, s32, s47
  s_mov_b32 m0, s32
  s_nop 0
  buffer_load_dwordx4 v10, s[8:11], s30 offen offset:0 lds
  buffer_load_dwordx4 v11, s[8:11], s30 offen offset:1024 lds
  buffer_load_dwordx4 v12, s[8:11], s30 offen offset:2048 lds
  buffer_load_dwordx4 v13, s[8:11], s30 offen offset:3072 lds
  s_add_u32 s30, s30, 128
  s_add_u32 s32, s32, 16384
  s_cmp_lt_u32 s32, s46
  s_cselect_b32 s32, s32, s47
  s_mov_b32 m0, s32
  s_nop 0
  buffer_load_dwordx4 v10, s[8:11], s30 offen offset:0 lds
  buffer_load_dwordx4 v11, s[8:11], s30 offen offset:1024 lds
  buffer_load_dwordx4 v12, s[8:11], s30 offen offset:2048 lds
  buffer_load_dwordx4 v13, s[8:11], s30 offen offset:3072 lds
  s_add_u32 s30, s30, 128
  s_add_u32 s32, s32, 16384
  s_cmp_lt_u32 s32, s46
  s_cselect_b32 s32, s32, s47
  s_mov_b32 m0, s32
  s_nop 0
  buffer_load_dwordx4 v10, s[8:11], s30 offen offset:0 lds
  buffer_load_dwordx4 v11, s[8:11], s30 offen offset:1024 lds
  buffer_load_dwordx4 v12, s[8:11], s30 offen offset:2048 lds
  buffer_load_dwordx4 v13, s[8:11], s30 offen offset:3072 lds
  s_add_u32 s30, s30, 128
  s_add_u32 s32, s32, 16384
  s_cmp_lt_u32 s32, s46
  s_cselect_b32 s32, s32, s47
  s_mov_b32 s26, 4
  s_mul_i32 s27, s42, 12288
  s_lshl_b32 s60, s42, 7
  s_add_u32 s60, s60, 112640
  s_mov_b32 s62, 0
  s_branch kv_main
kv_fin:
  s_cmp_lg_u32 s43, 2
  s_cbranch_scc1 queue
  s_bfe_u32 s21, s3, 0x20001
  s_cmp_lt_u32 s21, 0
  s_cbranch_scc1 queue
  s_sub_u32 s21, s21, 0
  s_lshl_b32 s21, s21, 3
  s_lshr_b32 s22, s3, 3
  s_add_u32 s21, s21, s22
  s_add_u32 s87, s21, 334
  s_branch tail_item
  s_branch queue
not_kv:
  s_cmp_ge_u32 s3, 96
  s_cbranch_scc1 not_vw
  s_sub_u32 s2, s3, 64
  s_load_dwordx2 s[72:73], s[0:1], 104
  s_waitcnt lgkmcnt(0)
  s_add_u32 s72, s72, 81068032
  s_addc_u32 s73, s73, 0
  s_mov_b32 s74, 116736
  s_mov_b32 s75, 0x00020000
  s_add_u32 s8, s38, 78643200
  s_addc_u32 s9, s39, 0
  s_mov_b32 s10, 2162688
  s_mov_b32 s11, 0x00020000
  s_add_u32 s12, s38, 50331648
  s_addc_u32 s13, s39, 0
  s_mov_b32 s14, 12582912
  s_mov_b32 s15, 0x00020000
  s_add_u32 s16, s38, 83886079
  s_addc_u32 s17, s39, 0
  s_and_b32 s16, s16, 0xffe00000
  s_mov_b32 s18, 2097152
  s_mov_b32 s19, 0x00020000
  v_lshlrev_b32 v8, 4, v0
  v_lshlrev_b32 v9, 4, v1
  v_mov_b32 v4, 0
  v_mov_b32 v12, -1
  v_mov_b32 v5, 0
  v_mov_b32 v13, -1
  v_mov_b32 v6, 0
  v_mov_b32 v14, -1
  v_mov_b32 v7, 0
  v_mov_b32 v15, -1
  s_lshl_b32 s21, s2, 12
  buffer_store_dwordx4 v[4:7], v8, s[72:75], s21 offen sc1
  s_lshr_b32 s21, s2, 3
  s_lshl_b32 s21, s21, 15
  s_bfe_u32 s22, s2, 0x10002
  s_lshl_b32 s22, s22, 13
  s_add_u32 s21, s21, s22
  s_bfe_u32 s22, s2, 0x10001
  s_lshl_b32 s22, s22, 14
  s_add_u32 s21, s21, s22
  s_and_b32 s22, s2, 1
  s_mul_i32 s22, s22, 3
  s_add_u32 s22, s22, s20
  s_lshl_b32 s22, s22, 10
  s_add_u32 s21, s21, s22
  s_cmp_lt_u32 s20, 3
  s_cselect_b32 s21, s21, 0x80000000
  buffer_store_dwordx4 v[4:7], v9, s[16:19], s21 offen sc1
  s_mul_i32 s23, s20, 540672
  s_lshl_b32 s21, s2, 11
  s_add_u32 s21, s21, s23
  s_add_u32 s21, s21, 81920
  buffer_store_dwordx4 v[12:15], v9, s[8:11], s21 offen sc1
  buffer_store_dwordx4 v[12:15], v9, s[8:11], s21 offen offset:1024 sc1
  s_mul_i32 s21, s2, 3072
  s_add_u32 s21, s21, s23
  s_add_u32 s21, s21, 278528
  buffer_store_dwordx4 v[12:15], v9, s[8:11], s21 offen sc1
  buffer_store_dwordx4 v[12:15], v9, s[8:11], s21 offen offset:1024 sc1
  buffer_store_dwordx4 v[12:15], v9, s[8:11], s21 offen offset:2048 sc1
  s_lshl_b32 s21, s2, 9
  s_add_u32 s21, s21, s23
  s_add_u32 s21, s21, 376832
  s_mov_b64 exec, 0xffffffff
  buffer_store_dwordx4 v[12:15], v9, s[8:11], s21 offen sc1
  s_mov_b64 exec, -1
  s_lshl_b32 s21, s20, 5
  s_add_u32 s21, s21, s2
  s_mul_i32 s21, s21, 3072
  s_cmp_lt_u32 s20, 3
  s_cselect_b32 s21, s21, 0x80000000
  s_add_u32 s22, s21, 6291456
  buffer_store_dwordx4 v[12:15], v9, s[12:15], s21 offen offset:0 sc1
  buffer_store_dwordx4 v[12:15], v9, s[12:15], s22 offen offset:0 sc1
  buffer_store_dwordx4 v[12:15], v9, s[12:15], s21 offen offset:1024 sc1
  buffer_store_dwordx4 v[12:15], v9, s[12:15], s22 offen offset:1024 sc1
  buffer_store_dwordx4 v[12:15], v9, s[12:15], s21 offen offset:2048 sc1
  buffer_store_dwordx4 v[12:15], v9, s[12:15], s22 offen offset:2048 sc1
  s_waitcnt vmcnt(0)
  s_barrier
  s_mov_b32 s21, 76
  s_cmp_lg_u32 s20, 0
  s_cbranch_scc1 af_160
  v_mov_b32 v10, 0
  v_mov_b32 v11, 1
  s_mov_b64 exec, 1
  buffer_atomic_add v11, v10, s[32:35], s21 offen sc1
  s_mov_b64 exec, -1
  s_nop 1
af_160:
  s_load_dwordx2 s[6:7], s[0:1], 40
  s_load_dwordx2 s[38:39], s[0:1], 104
  s_waitcnt lgkmcnt(0)
  s_mov_b32 s12, s6
  s_mov_b32 s13, s7
  s_mov_b32 s14, 7864320
  s_mov_b32 s15, 0x00020000
  s_mov_b32 s16, s38
  s_mov_b32 s17, s39
  s_mov_b32 s18, 50331648
  s_mov_b32 s19, 0x00020000
  s_add_u32 s24, s38, 114294784
  s_addc_u32 s25, s39, 0
  s_mov_b32 s26, 83886080
  s_mov_b32 s27, 0x00020000
  s_load_dwordx2 s[72:73], s[0:1], 104
  s_waitcnt lgkmcnt(0)
  s_add_u32 s72, s72, 81068032
  s_addc_u32 s73, s73, 0
  s_mov_b32 s74, 116736
  s_mov_b32 s75, 0x00020000
  v_mov_b32 v29, 52429
  s_mul_i32 s21, s20, 960
  s_add_u32 s21, s21, 0
  v_add_u32 v21, s21, v1
  v_mul_u32_u24 v22, v21, v29
  v_lshrrev_b32 v22, 22, v22
  v_mul_u32_u24 v23, 80, v22
  v_sub_u32 v21, v21, v23
  v_bfe_u32 v23, v22, 3, 1
  v_and_b32 v24, 3, v22
  v_lshl_add_u32 v23, v23, 2, v24
  v_lshlrev_b32 v23, 1, v23
  v_xor_b32 v21, v21, v23
  v_cmp_gt_u32 vcc, 32, v22
  v_bfe_u32 v26, v22, 3, 2
  v_lshl_add_u32 v25, v26, 2, v24
  v_bfe_u32 v26, v22, 2, 1
  v_lshl_add_u32 v25, v26, 4, v25
  v_cndmask_b32 v25, v22, v25, vcc
  v_mul_u32_u24 v25, 1280, v25
  v_lshl_add_u32 v64, v21, 4, v25
  s_mul_i32 s21, s20, 960
  s_add_u32 s21, s21, 64
  v_add_u32 v21, s21, v1
  v_mul_u32_u24 v22, v21, v29
  v_lshrrev_b32 v22, 22, v22
  v_mul_u32_u24 v23, 80, v22
  v_sub_u32 v21, v21, v23
  v_bfe_u32 v23, v22, 3, 1
  v_and_b32 v24, 3, v22
  v_lshl_add_u32 v23, v23, 2, v24
  v_lshlrev_b32 v23, 1, v23
  v_xor_b32 v21, v21, v23
  v_cmp_gt_u32 vcc, 32, v22
  v_bfe_u32 v26, v22, 3, 2
  v_lshl_add_u32 v25, v26, 2, v24
  v_bfe_u32 v26, v22, 2, 1
  v_lshl_add_u32 v25, v26, 4, v25
  v_cndmask_b32 v25, v22, v25, vcc
  v_mul_u32_u24 v25, 1280, v25
  v_lshl_add_u32 v65, v21, 4, v25
  s_mul_i32 s21, s20, 960
  s_add_u32 s21, s21, 128
  v_add_u32 v21, s21, v1
  v_mul_u32_u24 v22, v21, v29
  v_lshrrev_b32 v22, 22, v22
  v_mul_u32_u24 v23, 80, v22
  v_sub_u32 v21, v21, v23
  v_bfe_u32 v23, v22, 3, 1
  v_and_b32 v24, 3, v22
  v_lshl_add_u32 v23, v23, 2, v24
  v_lshlrev_b32 v23, 1, v23
  v_xor_b32 v21, v21, v23
  v_cmp_gt_u32 vcc, 32, v22
  v_bfe_u32 v26, v22, 3, 2
  v_lshl_add_u32 v25, v26, 2, v24
  v_bfe_u32 v26, v22, 2, 1
  v_lshl_add_u32 v25, v26, 4, v25
  v_cndmask_b32 v25, v22, v25, vcc
  v_mul_u32_u24 v25, 1280, v25
  v_lshl_add_u32 v66, v21, 4, v25
  s_mul_i32 s21, s20, 960
  s_add_u32 s21, s21, 192
  v_add_u32 v21, s21, v1
  v_mul_u32_u24 v22, v21, v29
  v_lshrrev_b32 v22, 22, v22
  v_mul_u32_u24 v23, 80, v22
  v_sub_u32 v21, v21, v23
  v_bfe_u32 v23, v22, 3, 1
  v_and_b32 v24, 3, v22
  v_lshl_add_u32 v23, v23, 2, v24
  v_lshlrev_b32 v23, 1, v23
  v_xor_b32 v21, v21, v23
  v_cmp_gt_u32 vcc, 32, v22
  v_bfe_u32 v26, v22, 3, 2
  v_lshl_add_u32 v25, v26, 2, v24
  v_bfe_u32 v26, v22, 2, 1
  v_lshl_add_u32 v25, v26, 4, v25
  v_cndmask_b32 v25, v22, v25, vcc
  v_mul_u32_u24 v25, 1280, v25
  v_lshl_add_u32 v67, v21, 4, v25
  s_mul_i32 s21, s20, 960
  s_add_u32 s21, s21, 256
  v_add_u32 v21, s21, v1
  v_mul_u32_u24 v22, v21, v29
  v_lshrrev_b32 v22, 22, v22
  v_mul_u32_u24 v23, 80, v22
  v_sub_u32 v21, v21, v23
  v_bfe_u32 v23, v22, 3, 1
  v_and_b32 v24, 3, v22
  v_lshl_add_u32 v23, v23, 2, v24
  v_lshlrev_b32 v23, 1, v23
  v_xor_b32 v21, v21, v23
  v_cmp_gt_u32 vcc, 32, v22
  v_bfe_u32 v26, v22, 3, 2
  v_lshl_add_u32 v25, v26, 2, v24
  v_bfe_u32 v26, v22, 2, 1
  v_lshl_add_u32 v25, v26, 4, v25
  v_cndmask_b32 v25, v22, v25, vcc
  v_mul_u32_u24 v25, 1280, v25
  v_lshl_add_u32 v68, v21, 4, v25
  s_mul_i32 s21, s20, 960
  s_add_u32 s21, s21, 320
  v_add_u32 v21, s21, v1
  v_mul_u32_u24 v22, v21, v29
  v_lshrrev_b32 v22, 22, v22
  v_mul_u32_u24 v23, 80, v22
  v_sub_u32 v21, v21, v23
  v_bfe_u32 v23, v22, 3, 1
  v_and_b32 v24, 3, v22
  v_lshl_add_u32 v23, v23, 2, v24
  v_lshlrev_b32 v23, 1, v23
  v_xor_b32 v21, v21, v23
  v_cmp_gt_u32 vcc, 32, v22
  v_bfe_u32 v26, v22, 3, 2
  v_lshl_add_u32 v25, v26, 2, v24
  v_bfe_u32 v26, v22, 2, 1
  v_lshl_add_u32 v25, v26, 4, v25
  v_cndmask_b32 v25, v22, v25, vcc
  v_mul_u32_u24 v25, 1280, v25
  v_lshl_add_u32 v69, v21, 4, v25
  s_mul_i32 s21, s20, 960
  s_add_u32 s21, s21, 384
  v_add_u32 v21, s21, v1
  v_mul_u32_u24 v22, v21, v29
  v_lshrrev_b32 v22, 22, v22
  v_mul_u32_u24 v23, 80, v22
  v_sub_u32 v21, v21, v23
  v_bfe_u32 v23, v22, 3, 1
  v_and_b32 v24, 3, v22
  v_lshl_add_u32 v23, v23, 2, v24
  v_lshlrev_b32 v23, 1, v23
  v_xor_b32 v21, v21, v23
  v_cmp_gt_u32 vcc, 32, v22
  v_bfe_u32 v26, v22, 3, 2
  v_lshl_add_u32 v25, v26, 2, v24
  v_bfe_u32 v26, v22, 2, 1
  v_lshl_add_u32 v25, v26, 4, v25
  v_cndmask_b32 v25, v22, v25, vcc
  v_mul_u32_u24 v25, 1280, v25
  v_lshl_add_u32 v70, v21, 4, v25
  s_mul_i32 s21, s20, 960
  s_add_u32 s21, s21, 448
  v_add_u32 v21, s21, v1
  v_mul_u32_u24 v22, v21, v29
  v_lshrrev_b32 v22, 22, v22
  v_mul_u32_u24 v23, 80, v22
  v_sub_u32 v21, v21, v23
  v_bfe_u32 v23, v22, 3, 1
  v_and_b32 v24, 3, v22
  v_lshl_add_u32 v23, v23, 2, v24
  v_lshlrev_b32 v23, 1, v23
  v_xor_b32 v21, v21, v23
  v_cmp_gt_u32 vcc, 32, v22
  v_bfe_u32 v26, v22, 3, 2
  v_lshl_add_u32 v25, v26, 2, v24
  v_bfe_u32 v26, v22, 2, 1
  v_lshl_add_u32 v25, v26, 4, v25
  v_cndmask_b32 v25, v22, v25, vcc
  v_mul_u32_u24 v25, 1280, v25
  v_lshl_add_u32 v71, v21, 4, v25
  s_mul_i32 s21, s20, 960
  s_add_u32 s21, s21, 512
  v_add_u32 v21, s21, v1
  v_mul_u32_u24 v22, v21, v29
  v_lshrrev_b32 v22, 22, v22
  v_mul_u32_u24 v23, 80, v22
  v_sub_u32 v21, v21, v23
  v_bfe_u32 v23, v22, 3, 1
  v_and_b32 v24, 3, v22
  v_lshl_add_u32 v23, v23, 2, v24
  v_lshlrev_b32 v23, 1, v23
  v_xor_b32 v21, v21, v23
  v_cmp_gt_u32 vcc, 32, v22
  v_bfe_u32 v26, v22, 3, 2
  v_lshl_add_u32 v25, v26, 2, v24
  v_bfe_u32 v26, v22, 2, 1
  v_lshl_add_u32 v25, v26, 4, v25
  v_cndmask_b32 v25, v22, v25, vcc
  v_mul_u32_u24 v25, 1280, v25
  v_lshl_add_u32 v72, v21, 4, v25
  s_mul_i32 s21, s20, 960
  s_add_u32 s21, s21, 576
  v_add_u32 v21, s21, v1
  v_mul_u32_u24 v22, v21, v29
  v_lshrrev_b32 v22, 22, v22
  v_mul_u32_u24 v23, 80, v22
  v_sub_u32 v21, v21, v23
  v_bfe_u32 v23, v22, 3, 1
  v_and_b32 v24, 3, v22
  v_lshl_add_u32 v23, v23, 2, v24
  v_lshlrev_b32 v23, 1, v23
  v_xor_b32 v21, v21, v23
  v_cmp_gt_u32 vcc, 32, v22
  v_bfe_u32 v26, v22, 3, 2
  v_lshl_add_u32 v25, v26, 2, v24
  v_bfe_u32 v26, v22, 2, 1
  v_lshl_add_u32 v25, v26, 4, v25
  v_cndmask_b32 v25, v22, v25, vcc
  v_mul_u32_u24 v25, 1280, v25
  v_lshl_add_u32 v73, v21, 4, v25
  s_mul_i32 s21, s20, 960
  s_add_u32 s21, s21, 640
  v_add_u32 v21, s21, v1
  v_mul_u32_u24 v22, v21, v29
  v_lshrrev_b32 v22, 22, v22
  v_mul_u32_u24 v23, 80, v22
  v_sub_u32 v21, v21, v23
  v_bfe_u32 v23, v22, 3, 1
  v_and_b32 v24, 3, v22
  v_lshl_add_u32 v23, v23, 2, v24
  v_lshlrev_b32 v23, 1, v23
  v_xor_b32 v21, v21, v23
  v_cmp_gt_u32 vcc, 32, v22
  v_bfe_u32 v26, v22, 3, 2
  v_lshl_add_u32 v25, v26, 2, v24
  v_bfe_u32 v26, v22, 2, 1
  v_lshl_add_u32 v25, v26, 4, v25
  v_cndmask_b32 v25, v22, v25, vcc
  v_mul_u32_u24 v25, 1280, v25
  v_lshl_add_u32 v74, v21, 4, v25
  s_mul_i32 s21, s20, 960
  s_add_u32 s21, s21, 704
  v_add_u32 v21, s21, v1
  v_mul_u32_u24 v22, v21, v29
  v_lshrrev_b32 v22, 22, v22
  v_mul_u32_u24 v23, 80, v22
  v_sub_u32 v21, v21, v23
  v_bfe_u32 v23, v22, 3, 1
  v_and_b32 v24, 3, v22
  v_lshl_add_u32 v23, v23, 2, v24
  v_lshlrev_b32 v23, 1, v23
  v_xor_b32 v21, v21, v23
  v_cmp_gt_u32 vcc, 32, v22
  v_bfe_u32 v26, v22, 3, 2
  v_lshl_add_u32 v25, v26, 2, v24
  v_bfe_u32 v26, v22, 2, 1
  v_lshl_add_u32 v25, v26, 4, v25
  v_cndmask_b32 v25, v22, v25, vcc
  v_mul_u32_u24 v25, 1280, v25
  v_lshl_add_u32 v75, v21, 4, v25
  s_mul_i32 s21, s20, 960
  s_add_u32 s21, s21, 768
  v_add_u32 v21, s21, v1
  v_mul_u32_u24 v22, v21, v29
  v_lshrrev_b32 v22, 22, v22
  v_mul_u32_u24 v23, 80, v22
  v_sub_u32 v21, v21, v23
  v_bfe_u32 v23, v22, 3, 1
  v_and_b32 v24, 3, v22
  v_lshl_add_u32 v23, v23, 2, v24
  v_lshlrev_b32 v23, 1, v23
  v_xor_b32 v21, v21, v23
  v_cmp_gt_u32 vcc, 32, v22
  v_bfe_u32 v26, v22, 3, 2
  v_lshl_add_u32 v25, v26, 2, v24
  v_bfe_u32 v26, v22, 2, 1
  v_lshl_add_u32 v25, v26, 4, v25
  v_cndmask_b32 v25, v22, v25, vcc
  v_mul_u32_u24 v25, 1280, v25
  v_lshl_add_u32 v76, v21, 4, v25
  s_mul_i32 s21, s20, 960
  s_add_u32 s21, s21, 832
  v_add_u32 v21, s21, v1
  v_mul_u32_u24 v22, v21, v29
  v_lshrrev_b32 v22, 22, v22
  v_mul_u32_u24 v23, 80, v22
  v_sub_u32 v21, v21, v23
  v_bfe_u32 v23, v22, 3, 1
  v_and_b32 v24, 3, v22
  v_lshl_add_u32 v23, v23, 2, v24
  v_lshlrev_b32 v23, 1, v23
  v_xor_b32 v21, v21, v23
  v_cmp_gt_u32 vcc, 32, v22
  v_bfe_u32 v26, v22, 3, 2
  v_lshl_add_u32 v25, v26, 2, v24
  v_bfe_u32 v26, v22, 2, 1
  v_lshl_add_u32 v25, v26, 4, v25
  v_cndmask_b32 v25, v22, v25, vcc
  v_mul_u32_u24 v25, 1280, v25
  v_lshl_add_u32 v77, v21, 4, v25
  s_mul_i32 s21, s20, 960
  s_add_u32 s21, s21, 896
  v_add_u32 v21, s21, v1
  v_mul_u32_u24 v22, v21, v29
  v_lshrrev_b32 v22, 22, v22
  v_mul_u32_u24 v23, 80, v22
  v_sub_u32 v21, v21, v23
  v_bfe_u32 v23, v22, 3, 1
  v_and_b32 v24, 3, v22
  v_lshl_add_u32 v23, v23, 2, v24
  v_lshlrev_b32 v23, 1, v23
  v_xor_b32 v21, v21, v23
  v_cmp_gt_u32 vcc, 32, v22
  v_bfe_u32 v26, v22, 3, 2
  v_lshl_add_u32 v25, v26, 2, v24
  v_bfe_u32 v26, v22, 2, 1
  v_lshl_add_u32 v25, v26, 4, v25
  v_cndmask_b32 v25, v22, v25, vcc
  v_mul_u32_u24 v25, 1280, v25
  v_lshl_add_u32 v78, v21, 4, v25
  s_mul_i32 s40, s2, 245760
  s_sleep 32
  s_add_u32 s21, s40, 0
  s_mul_i32 s22, s20, 15360
  s_add_u32 s22, s22, 0
  s_add_u32 m0, s22, 0
  s_nop 0
  buffer_load_dwordx4 v64, s[12:15], s21 offen lds
  s_add_u32 m0, s22, 1024
  s_nop 0
  buffer_load_dwordx4 v65, s[12:15], s21 offen lds
  s_add_u32 m0, s22, 2048
  s_nop 0
  buffer_load_dwordx4 v66, s[12:15], s21 offen lds
  s_add_u32 m0, s22, 3072
  s_nop 0
  buffer_load_dwordx4 v67, s[12:15], s21 offen lds
  s_add_u32 m0, s22, 4096
  s_nop 0
  buffer_load_dwordx4 v68, s[12:15], s21 offen lds
  s_add_u32 m0, s22, 5120
  s_nop 0
  buffer_load_dwordx4 v69, s[12:15], s21 offen lds
  s_add_u32 m0, s22, 6144
  s_nop 0
  buffer_load_dwordx4 v70, s[12:15], s21 offen lds
  s_add_u32 m0, s22, 7168
  s_nop 0
  buffer_load_dwordx4 v71, s[12:15], s21 offen lds
  s_add_u32 m0, s22, 8192
  s_nop 0
  buffer_load_dwordx4 v72, s[12:15], s21 offen lds
  s_add_u32 m0, s22, 9216
  s_nop 0
  buffer_load_dwordx4 v73, s[12:15], s21 offen lds
  s_add_u32 m0, s22, 10240
  s_nop 0
  buffer_load_dwordx4 v74, s[12:15], s21 offen lds
  s_add_u32 m0, s22, 11264
  s_nop 0
  buffer_load_dwordx4 v75, s[12:15], s21 offen lds
  s_add_u32 m0, s22, 12288
  s_nop 0
  buffer_load_dwordx4 v76, s[12:15], s21 offen lds
  s_add_u32 m0, s22, 13312
  s_nop 0
  buffer_load_dwordx4 v77, s[12:15], s21 offen lds
  s_add_u32 m0, s22, 14336
  s_nop 0
  buffer_load_dwordx4 v78, s[12:15], s21 offen lds
  s_add_u32 s21, s40, 61440
  s_mul_i32 s22, s20, 15360
  s_add_u32 s22, s22, 61440
  s_add_u32 m0, s22, 0
  s_nop 0
  buffer_load_dwordx4 v64, s[12:15], s21 offen lds
  s_add_u32 m0, s22, 1024
  s_nop 0
  buffer_load_dwordx4 v65, s[12:15], s21 offen lds
  s_add_u32 m0, s22, 2048
  s_nop 0
  buffer_load_dwordx4 v66, s[12:15], s21 offen lds
  s_add_u32 m0, s22, 3072
  s_nop 0
  buffer_load_dwordx4 v67, s[12:15], s21 offen lds
  s_add_u32 m0, s22, 4096
  s_nop 0
  buffer_load_dwordx4 v68, s[12:15], s21 offen lds
  s_add_u32 m0, s22, 5120
  s_nop 0
  buffer_load_dwordx4 v69, s[12:15], s21 offen lds
  s_add_u32 m0, s22, 6144
  s_nop 0
  buffer_load_dwordx4 v70, s[12:15], s21 offen lds
  s_add_u32 m0, s22, 7168
  s_nop 0
  buffer_load_dwordx4 v71, s[12:15], s21 offen lds
  s_add_u32 m0, s22, 8192
  s_nop 0
  buffer_load_dwordx4 v72, s[12:15], s21 offen lds
  s_add_u32 m0, s22, 9216
  s_nop 0
  buffer_load_dwordx4 v73, s[12:15], s21 offen lds
  s_add_u32 m0, s22, 10240
  s_nop 0
  buffer_load_dwordx4 v74, s[12:15], s21 offen lds
  s_add_u32 m0, s22, 11264
  s_nop 0
  buffer_load_dwordx4 v75, s[12:15], s21 offen lds
  s_add_u32 m0, s22, 12288
  s_nop 0
  buffer_load_dwordx4 v76, s[12:15], s21 offen lds
  s_add_u32 m0, s22, 13312
  s_nop 0
  buffer_load_dwordx4 v77, s[12:15], s21 offen lds
  s_add_u32 m0, s22, 14336
  s_nop 0
  buffer_load_dwordx4 v78, s[12:15], s21 offen lds
  s_add_u32 s21, s40, 122880
  s_mul_i32 s22, s20, 15360
  s_add_u32 s22, s22, 0
  buffer_load_dwordx4 v[80:83], v64, s[12:15], s21 offen
  buffer_load_dwordx4 v[84:87], v65, s[12:15], s21 offen
  buffer_load_dwordx4 v[88:91], v66, s[12:15], s21 offen
  buffer_load_dwordx4 v[92:95], v67, s[12:15], s21 offen
  buffer_load_dwordx4 v[96:99], v68, s[12:15], s21 offen
  buffer_load_dwordx4 v[100:103], v69, s[12:15], s21 offen
  buffer_load_dwordx4 v[104:107], v70, s[12:15], s21 offen
  buffer_load_dwordx4 v[108:111], v71, s[12:15], s21 offen
  buffer_load_dwordx4 v[112:115], v72, s[12:15], s21 offen
  buffer_load_dwordx4 v[116:119], v73, s[12:15], s21 offen
  buffer_load_dwordx4 v[120:123], v74, s[12:15], s21 offen
  buffer_load_dwordx4 v[124:127], v75, s[12:15], s21 offen
  buffer_load_dwordx4 v[128:131], v76, s[12:15], s21 offen
  buffer_load_dwordx4 v[132:135], v77, s[12:15], s21 offen
  buffer_load_dwordx4 v[136:139], v78, s[12:15], s21 offen
  s_add_u32 s21, s40, 184320
  s_mul_i32 s22, s20, 15360
  s_add_u32 s22, s22, 61440
  buffer_load_dwordx4 v[140:143], v64, s[12:15], s21 offen
  buffer_load_dwordx4 v[144:147], v65, s[12:15], s21 offen
  buffer_load_dwordx4 v[148:151], v66, s[12:15], s21 offen
  buffer_load_dwordx4 v[152:155], v67, s[12:15], s21 offen
  buffer_load_dwordx4 v[156:159], v68, s[12:15], s21 offen
  buffer_load_dwordx4 v[160:163], v69, s[12:15], s21 offen
  buffer_load_dwordx4 v[164:167], v70, s[12:15], s21 offen
  buffer_load_dwordx4 v[168:171], v71, s[12:15], s21 offen
  buffer_load_dwordx4 v[172:175], v72, s[12:15], s21 offen
  buffer_load_dwordx4 v[176:179], v73, s[12:15], s21 offen
  buffer_load_dwordx4 v[180:183], v74, s[12:15], s21 offen
  buffer_load_dwordx4 v[184:187], v75, s[12:15], s21 offen
  buffer_load_dwordx4 v[188:191], v76, s[12:15], s21 offen
  buffer_load_dwordx4 v[192:195], v77, s[12:15], s21 offen
  buffer_load_dwordx4 v[196:199], v78, s[12:15], s21 offen
  v_lshrrev_b32 v6, 2, v2
  v_lshl_add_u32 v7, v3, 3, v6
  v_mul_u32_u24 v7, 1280, v7
  v_and_b32 v8, 1, v2
  v_lshl_add_u32 v7, v8, 3, v7
  v_and_b32 v8, 1, v3
  v_lshl_add_u32 v6, v8, 2, v6
  v_lshlrev_b32 v6, 1, v6
  v_bfe_u32 v8, v2, 1, 1
  s_mul_i32 s21, s20, 20
  v_add_u32 v8, s21, v8
  v_add_u32 v5, 0, v8
  v_xor_b32 v5, v5, v6
  v_lshl_add_u32 v200, v5, 4, v7
  v_add_u32 v210, 81920, v200
  v_add_u32 v5, 2, v8
  v_xor_b32 v5, v5, v6
  v_lshl_add_u32 v201, v5, 4, v7
  v_add_u32 v211, 81920, v201
  v_add_u32 v5, 4, v8
  v_xor_b32 v5, v5, v6
  v_lshl_add_u32 v202, v5, 4, v7
  v_add_u32 v212, 81920, v202
  v_add_u32 v5, 6, v8
  v_xor_b32 v5, v5, v6
  v_lshl_add_u32 v203, v5, 4, v7
  v_add_u32 v213, 81920, v203
  v_add_u32 v5, 8, v8
  v_xor_b32 v5, v5, v6
  v_lshl_add_u32 v204, v5, 4, v7
  v_add_u32 v214, 81920, v204
  v_add_u32 v5, 10, v8
  v_xor_b32 v5, v5, v6
  v_lshl_add_u32 v205, v5, 4, v7
  v_add_u32 v215, 81920, v205
  v_add_u32 v5, 12, v8
  v_xor_b32 v5, v5, v6
  v_lshl_add_u32 v206, v5, 4, v7
  v_add_u32 v216, 81920, v206
  v_add_u32 v5, 14, v8
  v_xor_b32 v5, v5, v6
  v_lshl_add_u32 v207, v5, 4, v7
  v_add_u32 v217, 81920, v207
  v_add_u32 v5, 16, v8
  v_xor_b32 v5, v5, v6
  v_lshl_add_u32 v208, v5, 4, v7
  v_add_u32 v218, 81920, v208
  v_add_u32 v5, 18, v8
  v_xor_b32 v5, v5, v6
  v_lshl_add_u32 v209, v5, 4, v7
  v_add_u32 v219, 81920, v209
  s_mul_i32 s22, s20, 15360
  v_lshl_add_u32 v30, v1, 4, s22
  v_add_u32 v31, 61440, v30
  s_waitcnt vmcnt(30)
  s_barrier
  ds_read_b64_tr_b16 a[0:1], v200 offset:0
  ds_read_b64_tr_b16 a[2:3], v200 offset:5120
  ds_read_b64_tr_b16 a[24:25], v201 offset:0
  ds_read_b64_tr_b16 a[26:27], v201 offset:5120
  ds_read_b64_tr_b16 a[48:49], v202 offset:0
  ds_read_b64_tr_b16 a[50:51], v202 offset:5120
  ds_read_b64_tr_b16 a[72:73], v203 offset:0
  ds_read_b64_tr_b16 a[74:75], v203 offset:5120
  ds_read_b64_tr_b16 a[96:97], v204 offset:0
  ds_read_b64_tr_b16 a[98:99], v204 offset:5120
  ds_read_b64_tr_b16 a[120:121], v205 offset:0
  ds_read_b64_tr_b16 a[122:123], v205 offset:5120
  ds_read_b64_tr_b16 a[144:145], v206 offset:0
  ds_read_b64_tr_b16 a[146:147], v206 offset:5120
  ds_read_b64_tr_b16 a[168:169], v207 offset:0
  ds_read_b64_tr_b16 a[170:171], v207 offset:5120
  ds_read_b64_tr_b16 a[192:193], v208 offset:0
  ds_read_b64_tr_b16 a[194:195], v208 offset:5120
  ds_read_b64_tr_b16 a[216:217], v209 offset:0
  ds_read_b64_tr_b16 a[218:219], v209 offset:5120
  ds_read_b64_tr_b16 a[4:5], v200 offset:40960
  ds_read_b64_tr_b16 a[6:7], v200 offset:46080
  ds_read_b64_tr_b16 a[28:29], v201 offset:40960
  ds_read_b64_tr_b16 a[30:31], v201 offset:46080
  ds_read_b64_tr_b16 a[52:53], v202 offset:40960
  ds_read_b64_tr_b16 a[54:55], v202 offset:46080
  ds_read_b64_tr_b16 a[76:77], v203 offset:40960
  ds_read_b64_tr_b16 a[78:79], v203 offset:46080
  ds_read_b64_tr_b16 a[100:101], v204 offset:40960
  ds_read_b64_tr_b16 a[102:103], v204 offset:46080
  ds_read_b64_tr_b16 a[124:125], v205 offset:40960
  ds_read_b64_tr_b16 a[126:127], v205 offset:46080
  ds_read_b64_tr_b16 a[148:149], v206 offset:40960
  ds_read_b64_tr_b16 a[150:151], v206 offset:46080
  ds_read_b64_tr_b16 a[172:173], v207 offset:40960
  ds_read_b64_tr_b16 a[174:175], v207 offset:46080
  ds_read_b64_tr_b16 a[196:197], v208 offset:40960
  ds_read_b64_tr_b16 a[198:199], v208 offset:46080
  ds_read_b64_tr_b16 a[220:221], v209 offset:40960
  ds_read_b64_tr_b16 a[222:223], v209 offset:46080
  ds_read_b64_tr_b16 a[8:9], v210 offset:0
  ds_read_b64_tr_b16 a[10:11], v210 offset:5120
  ds_read_b64_tr_b16 a[32:33], v211 offset:0
  ds_read_b64_tr_b16 a[34:35], v211 offset:5120
  ds_read_b64_tr_b16 a[56:57], v212 offset:0
  ds_read_b64_tr_b16 a[58:59], v212 offset:5120
  ds_read_b64_tr_b16 a[80:81], v213 offset:0
  ds_read_b64_tr_b16 a[82:83], v213 offset:5120
  ds_read_b64_tr_b16 a[104:105], v214 offset:0
  ds_read_b64_tr_b16 a[106:107], v214 offset:5120
  ds_read_b64_tr_b16 a[128:129], v215 offset:0
  ds_read_b64_tr_b16 a[130:131], v215 offset:5120
  ds_read_b64_tr_b16 a[152:153], v216 offset:0
  ds_read_b64_tr_b16 a[154:155], v216 offset:5120
  ds_read_b64_tr_b16 a[176:177], v217 offset:0
  ds_read_b64_tr_b16 a[178:179], v217 offset:5120
  ds_read_b64_tr_b16 a[200:201], v218 offset:0
  ds_read_b64_tr_b16 a[202:203], v218 offset:5120
  ds_read_b64_tr_b16 a[224:225], v219 offset:0
  ds_read_b64_tr_b16 a[226:227], v219 offset:5120
  s_waitcnt lgkmcnt(0)
  s_barrier
  s_waitcnt vmcnt(15)
  ds_write_b128 v30, v[80:83] offset:0
  ds_write_b128 v30, v[84:87] offset:1024
  ds_write_b128 v30, v[88:91] offset:2048
  ds_write_b128 v30, v[92:95] offset:3072
  ds_write_b128 v30, v[96:99] offset:4096
  ds_write_b128 v30, v[100:103] offset:5120
  ds_write_b128 v30, v[104:107] offset:6144
  ds_write_b128 v30, v[108:111] offset:7168
  ds_write_b128 v30, v[112:115] offset:8192
  ds_write_b128 v30, v[116:119] offset:9216
  ds_write_b128 v30, v[120:123] offset:10240
  ds_write_b128 v30, v[124:127] offset:11264
  ds_write_b128 v30, v[128:131] offset:12288
  ds_write_b128 v30, v[132:135] offset:13312
  ds_write_b128 v30, v[136:139] offset:14336
  s_waitcnt vmcnt(0)
  ds_write_b128 v31, v[140:143] offset:0
  ds_write_b128 v31, v[144:147] offset:1024
  ds_write_b128 v31, v[148:151] offset:2048
  ds_write_b128 v31, v[152:155] offset:3072
  ds_write_b128 v31, v[156:159] offset:4096
  ds_write_b128 v31, v[160:163] offset:5120
  ds_write_b128 v31, v[164:167] offset:6144
  ds_write_b128 v31, v[168:171] offset:7168
  ds_write_b128 v31, v[172:175] offset:8192
  ds_write_b128 v31, v[176:179] offset:9216
  ds_write_b128 v31, v[180:183] offset:10240
  ds_write_b128 v31, v[184:187] offset:11264
  ds_write_b128 v31, v[188:191] offset:12288
  ds_write_b128 v31, v[192:195] offset:13312
  ds_write_b128 v31, v[196:199] offset:14336
  s_waitcnt lgkmcnt(0)
  s_barrier
  ds_read_b64_tr_b16 a[12:13], v200 offset:0
  ds_read_b64_tr_b16 a[14:15], v200 offset:5120
  ds_read_b64_tr_b16 a[36:37], v201 offset:0
  ds_read_b64_tr_b16 a[38:39], v201 offset:5120
  ds_read_b64_tr_b16 a[60:61], v202 offset:0
  ds_read_b64_tr_b16 a[62:63], v202 offset:5120
  ds_read_b64_tr_b16 a[84:85], v203 offset:0
  ds_read_b64_tr_b16 a[86:87], v203 offset:5120
  ds_read_b64_tr_b16 a[108:109], v204 offset:0
  ds_read_b64_tr_b16 a[110:111], v204 offset:5120
  ds_read_b64_tr_b16 a[132:133], v205 offset:0
  ds_read_b64_tr_b16 a[134:135], v205 offset:5120
  ds_read_b64_tr_b16 a[156:157], v206 offset:0
  ds_read_b64_tr_b16 a[158:159], v206 offset:5120
  ds_read_b64_tr_b16 a[180:181], v207 offset:0
  ds_read_b64_tr_b16 a[182:183], v207 offset:5120
  ds_read_b64_tr_b16 a[204:205], v208 offset:0
  ds_read_b64_tr_b16 a[206:207], v208 offset:5120
  ds_read_b64_tr_b16 a[228:229], v209 offset:0
  ds_read_b64_tr_b16 a[230:231], v209 offset:5120
  ds_read_b64_tr_b16 a[16:17], v200 offset:40960
  ds_read_b64_tr_b16 a[18:19], v200 offset:46080
  ds_read_b64_tr_b16 a[40:41], v201 offset:40960
  ds_read_b64_tr_b16 a[42:43], v201 offset:46080
  ds_read_b64_tr_b16 a[64:65], v202 offset:40960
  ds_read_b64_tr_b16 a[66:67], v202 offset:46080
  ds_read_b64_tr_b16 a[88:89], v203 offset:40960
  ds_read_b64_tr_b16 a[90:91], v203 offset:46080
  ds_read_b64_tr_b16 a[112:113], v204 offset:40960
  ds_read_b64_tr_b16 a[114:115], v204 offset:46080
  ds_read_b64_tr_b16 a[136:137], v205 offset:40960
  ds_read_b64_tr_b16 a[138:139], v205 offset:46080
  ds_read_b64_tr_b16 a[160:161], v206 offset:40960
  ds_read_b64_tr_b16 a[162:163], v206 offset:46080
  ds_read_b64_tr_b16 a[184:185], v207 offset:40960
  ds_read_b64_tr_b16 a[186:187], v207 offset:46080
  ds_read_b64_tr_b16 a[208:209], v208 offset:40960
  ds_read_b64_tr_b16 a[210:211], v208 offset:46080
  ds_read_b64_tr_b16 a[232:233], v209 offset:40960
  ds_read_b64_tr_b16 a[234:235], v209 offset:46080
  ds_read_b64_tr_b16 a[20:21], v210 offset:0
  ds_read_b64_tr_b16 a[22:23], v210 offset:5120
  ds_read_b64_tr_b16 a[44:45], v211 offset:0
  ds_read_b64_tr_b16 a[46:47], v211 offset:5120
  ds_read_b64_tr_b16 a[68:69], v212 offset:0
  ds_read_b64_tr_b16 a[70:71], v212 offset:5120
  ds_read_b64_tr_b16 a[92:93], v213 offset:0
  ds_read_b64_tr_b16 a[94:95], v213 offset:5120
  ds_read_b64_tr_b16 a[116:117], v214 offset:0
  ds_read_b64_tr_b16 a[118:119], v214 offset:5120
  ds_read_b64_tr_b16 a[140:141], v215 offset:0
  ds_read_b64_tr_b16 a[142:143], v215 offset:5120
  ds_read_b64_tr_b16 a[164:165], v216 offset:0
  ds_read_b64_tr_b16 a[166:167], v216 offset:5120
  ds_read_b64_tr_b16 a[188:189], v217 offset:0
  ds_read_b64_tr_b16 a[190:191], v217 offset:5120
  ds_read_b64_tr_b16 a[212:213], v218 offset:0
  ds_read_b64_tr_b16 a[214:215], v218 offset:5120
  ds_read_b64_tr_b16 a[236:237], v219 offset:0
  ds_read_b64_tr_b16 a[238:239], v219 offset:5120
  s_waitcnt lgkmcnt(0)
  s_barrier
  s_load_dwordx2 s[32:33], s[0:1], 96
  s_waitcnt lgkmcnt(0)
  s_mov_b32 s32, s32
  s_mov_b32 s33, s33
  s_mov_b32 s34, 256
  s_mov_b32 s35, 0x00020000
  s_mov_b32 s21, 76
  s_cmp_lg_u32 s20, 0
  s_cbranch_scc1 wf_162
  v_mov_b32 v4, 0
  s_mov_b32 s101, 0
wf_161:
  buffer_load_dword v5, v4, s[32:35], s21 offen sc1
  s_add_u32 s101, s101, 1
  s_cmp_gt_u32 s101, 131072
  s_cbranch_scc1 main_end
  s_waitcnt vmcnt(0)
  v_readfirstlane_b32 s100, v5
  s_cmp_ge_u32 s100, 32
  s_cbranch_scc1 wf_162
  s_sleep 8
  s_branch wf_161
wf_162:
  s_barrier
  s_mul_i32 s41, s2, 12288
  s_add_u32 s47, s41, 25165824
  s_mov_b32 s41, s47
  s_mul_i32 s21, s20, 10
  s_mul_i32 s47, s2, 5
  s_lshr_b32 s22, s21, 3
  s_add_u32 s47, s47, s22
  s_and_b32 s48, s21, 7
  s_mov_b32 s66, 0
  s_mov_b32 s67, 0
  s_lshr_b32 s43, s2, 2
  s_lshl_b32 s43, s43, 7
  s_add_u32 s43, s43, 0
  s_lshl_b32 s44, s2, 7
  s_lshl_b32 s21, s20, 2
  s_add_u32 s44, s44, s21
  s_add_u32 s44, s44, 95232
  s_mov_b32 s45, 0
  s_mov_b32 s49, 1
  s_mov_b32 s50, 0
  v_mov_b32 v10, 0
  v_mov_b32 v11, 1
  v_lshlrev_b32 v4, 4, v1
  s_add_u32 s76, s38, 56623104
  s_addc_u32 s77, s39, 0
  s_mov_b32 s78, 6291456
  s_mov_b32 s79, 0x00020000
  s_add_u32 s80, s38, 93323264
  s_addc_u32 s81, s39, 0
  s_mov_b32 s82, 20971520
  s_mov_b32 s83, 0x00020000
  v_and_b32 v12, 3, v1
  v_lshlrev_b32 v12, 3, v12
  v_add_u32 v12, 4, v12
  v_and_b32 v13, 7, v2
  v_lshlrev_b32 v13, 4, v13
  v_lshl_add_u32 v13, v3, 7, v13
  v_lshrrev_b32 v14, 3, v2
  v_mul_u32_u24 v14, 98304, v14
  v_add_u32 v14, v14, v13
  v_and_b32 v15, 1, v3
  v_lshlrev_b32 v15, 8, v15
  v_lshl_add_u32 v15, v2, 4, v15
  v_lshrrev_b32 v16, 1, v3
  v_mul_u32_u24 v16, 327680, v16
  v_add_u32 v15, v15, v16
  v_lshlrev_b32 v17, 10, v1
  v_mov_b32 v19, 0
  s_lshl_b32 s53, s2, 7
  s_add_u32 s53, s53, 19456
  s_mov_b32 s55, 0
  s_mov_b32 s56, 0
  s_mov_b32 s58, 0
  s_mov_b32 s59, 0
  s_add_u32 s84, s38, 50331648
  s_addc_u32 s85, s39, 0
  s_mov_b32 s86, 12582912
  s_mov_b32 s87, 0x00020000
  s_and_b32 s21, s2, 3
  s_mul_i32 s51, s2, 3072
  s_cmp_eq_u32 s21, s20
  s_cselect_b32 s51, s51, 6291456
  v_mov_b32 v244, -1
  v_mov_b32 v245, -1
  v_mov_b32 v246, -1
  v_mov_b32 v247, -1
  s_add_u32 s88, s38, 85983232
  s_addc_u32 s89, s39, 0
  s_mov_b32 s90, 5242880
  s_mov_b32 s91, 0x00020000
  s_mul_i32 s21, s20, 3072
  s_add_u32 s41, s41, s21
  s_mov_b32 s64, s21
  s_add_u32 s67, s21, 98304
  s_mov_b32 s71, s21
  s_mov_b32 s46, 0
  s_mov_b32 s47, 0
  s_mov_b32 s65, 0
  s_mul_i32 s42, s2, 40960
  s_mul_i32 s21, s20, 10240
  s_add_u32 s42, s42, s21
  s_mov_b32 s68, 0x80000000
  s_mov_b32 s70, 0
  s_mov_b32 s40, 0
  s_mov_b32 s30, 0
  s_mov_b32 s31, 0
  v_min_u32 v5, 18, v1
  v_lshlrev_b32 v5, 10, v5
  v_mov_b32 v9, 0
  s_lshl_b32 s21, s20, 2
  s_add_u32 s21, s21, 110592
  v_mov_b32 v6, s21
  v_mov_b32 v7, 110592
  s_mul_i32 s51, s2, 3072
  s_lshl_b32 s21, s20, 10
  s_add_u32 s51, s51, s21
  s_cmp_lt_u32 s20, 3
  s_cselect_b32 s51, s51, 6291456
  s_add_u32 s51, s51, 6094848
  s_cmp_lg_u32 s20, 0
  s_cbranch_scc1 wf_164
  v_mov_b32 v20, 0
  s_mov_b32 s101, 0
wf_163:
  buffer_load_dword v21, v20, s[72:75], s43 offen sc1
  s_add_u32 s101, s101, 1
  s_cmp_gt_u32 s101, 131072
  s_cbranch_scc1 main_end
  s_waitcnt vmcnt(0)
  v_readfirstlane_b32 s100, v21
  s_cmp_ge_u32 s100, 8
  s_cbranch_scc1 wf_164
  s_sleep 4
  s_branch wf_163
wf_164:
  s_barrier
  v_writelane_b32 v9, 8, 0
  v_cmp_gt_u32 vcc, 8, v9
  s_nop 0
  s_bitset1_b64 vcc, 19
  s_ff1_i32_b64 s21, vcc
  s_lshl_b32 s22, s21, 1
  s_lshl_b32 s21, s21, 2
  s_sub_i32 s21, s21, 12
  s_max_i32 s47, s21, s22
  s_cmp_gt_u32 s47, s45
  s_cbranch_scc1 va_165
  s_mov_b32 s101, 0
  s_branch va_168
va_166:
  s_sleep 8
va_168:
  buffer_load_dword v9, v5, s[72:75], s43 offen sc1
  s_add_u32 s101, s101, 1
  s_cmp_gt_u32 s101, 131072
  s_cbranch_scc1 main_end
  s_waitcnt vmcnt(0)
  v_cmp_gt_u32 vcc, 8, v9
  s_nop 0
  s_bitset1_b64 vcc, 19
  s_ff1_i32_b64 s21, vcc
  s_lshl_b32 s22, s21, 1
  s_lshl_b32 s21, s21, 2
  s_sub_i32 s21, s21, 12
  s_max_i32 s47, s21, s22
  s_cmp_gt_u32 s47, s45
  s_cbranch_scc0 va_166
va_165:
  s_add_u32 s22, s45, 6
  s_min_u32 s22, s22, s47
va_167:
  s_cmp_ge_u32 s46, s22
  s_cbranch_scc1 va_169
  s_mov_b32 m0, s64
  s_mov_b32 s66, s41
  buffer_load_dwordx4 v4, s[16:19], s66 offen offset:0 sc1 lds
  buffer_load_dwordx4 v4, s[16:19], s66 offen offset:1024 sc1 lds
  buffer_load_dwordx4 v4, s[16:19], s66 offen offset:2048 sc1 lds
  s_add_u32 s46, s46, 1
  s_add_u32 s41, s41, 393216
  s_add_u32 s64, s64, 12288
  s_cmp_lt_u32 s64, s67
  s_cselect_b32 s64, s64, s71
  s_branch va_167
va_169:
  s_mov_b32 s48, s46
  s_mov_b32 s49, s46
  s_mov_b32 s50, s46
  s_waitcnt vmcnt(0)
  s_barrier
  v_mov_b32 v8, v4
  s_add_u32 s65, s65, 12288
  s_cmp_lt_u32 s65, 98304
  s_cselect_b32 s65, s65, 0
  ds_read_b128 v[144:147], v8 offset:0
  ds_read_b128 v[148:151], v8 offset:1024
  ds_read_b128 v[152:155], v8 offset:2048
  ds_read_b128 v[156:159], v8 offset:3072
  ds_read_b128 v[160:163], v8 offset:4096
  ds_read_b128 v[164:167], v8 offset:5120
  ds_read_b128 v[168:171], v8 offset:6144
  ds_read_b128 v[172:175], v8 offset:7168
  ds_read_b128 v[176:179], v8 offset:8192
  ds_read_b128 v[180:183], v8 offset:9216
  ds_read_b128 v[184:187], v8 offset:10240
  ds_read_b128 v[188:191], v8 offset:11264
  s_add_u32 s21, s45, 1
  s_min_u32 s21, s21, 63
  s_cmp_lt_u32 s21, s50
  s_addc_u32 s21, s31, s31
  v_mov_b32 v21, s21
  ds_write_b32 v6, v21 offset:0
vwl_170:
  s_waitcnt lgkmcnt(0)
  s_barrier
  v_mfma_f32_16x16x32_bf16 v[64:67], v[144:147], a[0:3], 0
  v_cmp_gt_u32 vcc, 8, v9
  s_nop 0
  v_mfma_f32_16x16x32_bf16 v[72:75], v[144:147], a[24:27], 0
  s_bitset1_b64 vcc, 19
  s_ff1_i32_b64 s21, vcc
  v_mfma_f32_16x16x32_bf16 v[80:83], v[144:147], a[48:51], 0
  s_lshl_b32 s22, s21, 1
  s_lshl_b32 s21, s21, 2
  v_mfma_f32_16x16x32_bf16 v[88:91], v[144:147], a[72:75], 0
  s_sub_i32 s21, s21, 12
  s_max_i32 s47, s21, s22
  v_mfma_f32_16x16x32_bf16 v[96:99], v[144:147], a[96:99], 0
  s_add_u32 s22, s45, 7
  s_min_u32 s22, s22, s47
  v_mfma_f32_16x16x32_bf16 v[68:71], v[168:171], a[0:3], 0
  s_cmp_lt_u32 s46, s22
  s_cselect_b32 s66, s41, 0x80000000
  s_cselect_b32 m0, s64, 98304
  s_cselect_b32 s22, 1, 0
  v_mfma_f32_16x16x32_bf16 v[76:79], v[168:171], a[24:27], 0
  buffer_load_dwordx4 v4, s[16:19], s66 offen offset:0 sc1 lds
  v_mfma_f32_16x16x32_bf16 v[84:87], v[168:171], a[48:51], 0
  v_add_u32 v8, s65, v4
  ds_read_b128 v[240:243], v7 offset:0
  v_mfma_f32_16x16x32_bf16 v[92:95], v[168:171], a[72:75], 0
  buffer_load_dwordx4 v4, s[16:19], s66 offen offset:1024 sc1 lds
  v_mfma_f32_16x16x32_bf16 v[100:103], v[168:171], a[96:99], 0
  s_add_u32 s65, s65, 12288
  v_mfma_f32_16x16x32_bf16 v[64:67], v[148:151], a[4:7], v[64:67]
  buffer_load_dwordx4 v4, s[16:19], s66 offen offset:2048 sc1 lds
  v_mfma_f32_16x16x32_bf16 v[72:75], v[148:151], a[28:31], v[72:75]
  s_cmp_lt_u32 s65, 98304
  s_cselect_b32 s65, s65, 0
  v_mfma_f32_16x16x32_bf16 v[80:83], v[148:151], a[52:55], v[80:83]
  v_cvt_pk_bf16_f32 v44, v104, v105
  v_cvt_pk_bf16_f32 v45, v106, v107
  v_mfma_f32_16x16x32_bf16 v[88:91], v[148:151], a[76:79], v[88:91]
  s_add_u32 s46, s46, s22
  s_mul_i32 s21, s22, 393216
  v_mfma_f32_16x16x32_bf16 v[96:99], v[148:151], a[100:103], v[96:99]
  ds_read_b128 v[192:195], v8 offset:0
  v_cvt_pk_bf16_f32 v46, v108, v109
  v_mfma_f32_16x16x32_bf16 v[68:71], v[172:175], a[4:7], v[68:71]
  s_add_u32 s41, s41, s21
  s_mul_i32 s21, s22, 12288
  v_mfma_f32_16x16x32_bf16 v[76:79], v[172:175], a[28:31], v[76:79]
  v_cvt_pk_bf16_f32 v47, v110, v111
  s_add_u32 s64, s64, s21
  v_mfma_f32_16x16x32_bf16 v[84:87], v[172:175], a[52:55], v[84:87]
  s_add_u32 s69, s68, 4096
  v_mfma_f32_16x16x32_bf16 v[92:95], v[172:175], a[76:79], v[92:95]
  s_cmp_lt_u32 s64, s67
  s_cselect_b32 s64, s64, s71
  v_mfma_f32_16x16x32_bf16 v[100:103], v[172:175], a[100:103], v[100:103]
  buffer_store_dwordx4 v[44:47], v4, s[24:27], s69 offen offset:1024 sc1
  v_mfma_f32_16x16x32_bf16 v[64:67], v[152:155], a[8:11], v[64:67]
  ds_read_b128 v[196:199], v8 offset:1024
  v_mfma_f32_16x16x32_bf16 v[72:75], v[152:155], a[32:35], v[72:75]
  v_cvt_pk_bf16_f32 v48, v112, v113
  v_mfma_f32_16x16x32_bf16 v[80:83], v[152:155], a[56:59], v[80:83]
  v_cvt_pk_bf16_f32 v49, v114, v115
  v_mfma_f32_16x16x32_bf16 v[88:91], v[152:155], a[80:83], v[88:91]
  v_mfma_f32_16x16x32_bf16 v[96:99], v[152:155], a[104:107], v[96:99]
  v_cvt_pk_bf16_f32 v50, v116, v117
  v_mfma_f32_16x16x32_bf16 v[68:71], v[176:179], a[8:11], v[68:71]
  v_mfma_f32_16x16x32_bf16 v[76:79], v[176:179], a[32:35], v[76:79]
  ds_read_b128 v[200:203], v8 offset:2048
  v_cvt_pk_bf16_f32 v51, v118, v119
  v_mfma_f32_16x16x32_bf16 v[84:87], v[176:179], a[56:59], v[84:87]
  buffer_store_dwordx4 v[48:51], v4, s[24:27], s69 offen offset:2048 sc1
  v_mfma_f32_16x16x32_bf16 v[92:95], v[176:179], a[80:83], v[92:95]
  v_mfma_f32_16x16x32_bf16 v[100:103], v[176:179], a[104:107], v[100:103]
  v_cvt_pk_bf16_f32 v52, v120, v121
  v_mfma_f32_16x16x32_bf16 v[64:67], v[156:159], a[12:15], v[64:67]
  v_mfma_f32_16x16x32_bf16 v[72:75], v[156:159], a[36:39], v[72:75]
  v_cvt_pk_bf16_f32 v53, v122, v123
  v_mfma_f32_16x16x32_bf16 v[80:83], v[156:159], a[60:63], v[80:83]
  ds_read_b128 v[204:207], v8 offset:3072
  v_cvt_pk_bf16_f32 v54, v124, v125
  v_mfma_f32_16x16x32_bf16 v[88:91], v[156:159], a[84:87], v[88:91]
  v_mfma_f32_16x16x32_bf16 v[96:99], v[156:159], a[108:111], v[96:99]
  v_cvt_pk_bf16_f32 v55, v126, v127
  v_mfma_f32_16x16x32_bf16 v[68:71], v[180:183], a[12:15], v[68:71]
  v_mfma_f32_16x16x32_bf16 v[76:79], v[180:183], a[36:39], v[76:79]
  buffer_store_dwordx4 v[52:55], v4, s[24:27], s69 offen offset:3072 sc1
  v_mfma_f32_16x16x32_bf16 v[84:87], v[180:183], a[60:63], v[84:87]
  v_cvt_pk_bf16_f32 v56, v128, v129
  v_mfma_f32_16x16x32_bf16 v[92:95], v[180:183], a[84:87], v[92:95]
  ds_read_b128 v[208:211], v8 offset:4096
  v_mfma_f32_16x16x32_bf16 v[100:103], v[180:183], a[108:111], v[100:103]
  v_cvt_pk_bf16_f32 v57, v130, v131
  v_mfma_f32_16x16x32_bf16 v[64:67], v[160:163], a[16:19], v[64:67]
  v_mfma_f32_16x16x32_bf16 v[72:75], v[160:163], a[40:43], v[72:75]
  v_cvt_pk_bf16_f32 v58, v132, v133
  v_mfma_f32_16x16x32_bf16 v[80:83], v[160:163], a[64:67], v[80:83]
  v_cvt_pk_bf16_f32 v59, v134, v135
  v_mfma_f32_16x16x32_bf16 v[88:91], v[160:163], a[88:91], v[88:91]
  v_mfma_f32_16x16x32_bf16 v[96:99], v[160:163], a[112:115], v[96:99]
  ds_read_b128 v[212:215], v8 offset:5120
  s_add_u32 s69, s68, 8192
  v_mfma_f32_16x16x32_bf16 v[68:71], v[184:187], a[16:19], v[68:71]
  v_mfma_f32_16x16x32_bf16 v[76:79], v[184:187], a[40:43], v[76:79]
  buffer_store_dwordx4 v[56:59], v4, s[24:27], s69 offen offset:0 sc1
  v_mfma_f32_16x16x32_bf16 v[84:87], v[184:187], a[64:67], v[84:87]
  v_cvt_pk_bf16_f32 v60, v136, v137
  v_mfma_f32_16x16x32_bf16 v[92:95], v[184:187], a[88:91], v[92:95]
  v_mfma_f32_16x16x32_bf16 v[100:103], v[184:187], a[112:115], v[100:103]
  v_cvt_pk_bf16_f32 v61, v138, v139
  v_mfma_f32_16x16x32_bf16 v[64:67], v[164:167], a[20:23], v[64:67]
  ds_read_b128 v[216:219], v8 offset:6144
  v_mfma_f32_16x16x32_bf16 v[72:75], v[164:167], a[44:47], v[72:75]
  v_cvt_pk_bf16_f32 v62, v140, v141
  v_mfma_f32_16x16x32_bf16 v[80:83], v[164:167], a[68:71], v[80:83]
  v_cvt_pk_bf16_f32 v63, v142, v143
  v_mfma_f32_16x16x32_bf16 v[88:91], v[164:167], a[92:95], v[88:91]
  v_mfma_f32_16x16x32_bf16 v[96:99], v[164:167], a[116:119], v[96:99]
  buffer_store_dwordx4 v[60:63], v4, s[24:27], s69 offen offset:1024 sc1
  v_mfma_f32_16x16x32_bf16 v[68:71], v[188:191], a[20:23], v[68:71]
  v_mfma_f32_16x16x32_bf16 v[76:79], v[188:191], a[44:47], v[76:79]
  ds_read_b128 v[220:223], v8 offset:7168
  v_mfma_f32_16x16x32_bf16 v[84:87], v[188:191], a[68:71], v[84:87]
  v_mfma_f32_16x16x32_bf16 v[92:95], v[188:191], a[92:95], v[92:95]
  v_mfma_f32_16x16x32_bf16 v[100:103], v[188:191], a[116:119], v[100:103]
  v_mfma_f32_16x16x32_bf16 v[104:107], v[144:147], a[120:123], 0
  buffer_load_dword v9, v5, s[72:75], s43 offen sc1
  v_mfma_f32_16x16x32_bf16 v[112:115], v[144:147], a[144:147], 0
  v_mfma_f32_16x16x32_bf16 v[120:123], v[144:147], a[168:171], 0
  ds_read_b128 v[224:227], v8 offset:8192
  v_mfma_f32_16x16x32_bf16 v[128:131], v[144:147], a[192:195], 0
  v_cvt_pk_bf16_f32 v24, v64, v65
  v_mfma_f32_16x16x32_bf16 v[136:139], v[144:147], a[216:219], 0
  v_mfma_f32_16x16x32_bf16 v[108:111], v[168:171], a[120:123], 0
  v_cvt_pk_bf16_f32 v25, v66, v67
  v_mfma_f32_16x16x32_bf16 v[116:119], v[168:171], a[144:147], 0
  s_cmp_lt_u32 s51, 6291456
  s_cselect_b32 s52, s51, 0x80000000
  v_mfma_f32_16x16x32_bf16 v[124:127], v[168:171], a[168:171], 0
  v_cvt_pk_bf16_f32 v26, v68, v69
  v_mfma_f32_16x16x32_bf16 v[132:135], v[168:171], a[192:195], 0
  ds_read_b128 v[228:231], v8 offset:9216
  v_mfma_f32_16x16x32_bf16 v[140:143], v[168:171], a[216:219], 0
  v_cvt_pk_bf16_f32 v27, v70, v71
  v_mfma_f32_16x16x32_bf16 v[104:107], v[148:151], a[124:127], v[104:107]
  buffer_store_dwordx4 v[244:247], v4, s[84:87], s52 offen sc1
  v_mfma_f32_16x16x32_bf16 v[112:115], v[148:151], a[148:151], v[112:115]
  buffer_store_dwordx4 v[24:27], v4, s[24:27], s42 offen offset:0 sc1
  v_mfma_f32_16x16x32_bf16 v[120:123], v[148:151], a[172:175], v[120:123]
  s_add_u32 s51, s51, 98304
  v_mfma_f32_16x16x32_bf16 v[128:131], v[148:151], a[196:199], v[128:131]
  v_cvt_pk_bf16_f32 v28, v72, v73
  v_mfma_f32_16x16x32_bf16 v[136:139], v[148:151], a[220:223], v[136:139]
  ds_read_b128 v[232:235], v8 offset:10240
  v_cvt_pk_bf16_f32 v29, v74, v75
  v_mfma_f32_16x16x32_bf16 v[108:111], v[172:175], a[124:127], v[108:111]
  s_cmp_eq_u32 s40, 3
  s_cbranch_scc1 vwm_172
vwm_173:
  v_mfma_f32_16x16x32_bf16 v[116:119], v[172:175], a[148:151], v[116:119]
  v_cvt_pk_bf16_f32 v30, v76, v77
  v_mfma_f32_16x16x32_bf16 v[124:127], v[172:175], a[172:175], v[124:127]
  v_mfma_f32_16x16x32_bf16 v[132:135], v[172:175], a[196:199], v[132:135]
  v_cvt_pk_bf16_f32 v31, v78, v79
  v_mfma_f32_16x16x32_bf16 v[140:143], v[172:175], a[220:223], v[140:143]
  v_mfma_f32_16x16x32_bf16 v[104:107], v[152:155], a[128:131], v[104:107]
  ds_read_b128 v[236:239], v8 offset:11264
  v_mfma_f32_16x16x32_bf16 v[112:115], v[152:155], a[152:155], v[112:115]
  buffer_store_dwordx4 v[28:31], v4, s[24:27], s42 offen offset:1024 sc1
  v_mfma_f32_16x16x32_bf16 v[120:123], v[152:155], a[176:179], v[120:123]
  v_cvt_pk_bf16_f32 v32, v80, v81
  v_mfma_f32_16x16x32_bf16 v[128:131], v[152:155], a[200:203], v[128:131]
  v_mfma_f32_16x16x32_bf16 v[136:139], v[152:155], a[224:227], v[136:139]
  v_cvt_pk_bf16_f32 v33, v82, v83
  v_mfma_f32_16x16x32_bf16 v[108:111], v[176:179], a[128:131], v[108:111]
  v_cvt_pk_bf16_f32 v34, v84, v85
  v_mfma_f32_16x16x32_bf16 v[116:119], v[176:179], a[152:155], v[116:119]
  v_mfma_f32_16x16x32_bf16 v[124:127], v[176:179], a[176:179], v[124:127]
  v_cvt_pk_bf16_f32 v35, v86, v87
  v_mfma_f32_16x16x32_bf16 v[132:135], v[176:179], a[200:203], v[132:135]
  v_mfma_f32_16x16x32_bf16 v[140:143], v[176:179], a[224:227], v[140:143]
  buffer_store_dwordx4 v[32:35], v4, s[24:27], s42 offen offset:2048 sc1
  v_mfma_f32_16x16x32_bf16 v[104:107], v[156:159], a[132:135], v[104:107]
  v_mfma_f32_16x16x32_bf16 v[112:115], v[156:159], a[156:159], v[112:115]
  v_cvt_pk_bf16_f32 v36, v88, v89
  v_mfma_f32_16x16x32_bf16 v[120:123], v[156:159], a[180:183], v[120:123]
  v_mfma_f32_16x16x32_bf16 v[128:131], v[156:159], a[204:207], v[128:131]
  v_cvt_pk_bf16_f32 v37, v90, v91
  v_mfma_f32_16x16x32_bf16 v[136:139], v[156:159], a[228:231], v[136:139]
  v_mfma_f32_16x16x32_bf16 v[108:111], v[180:183], a[132:135], v[108:111]
  v_cvt_pk_bf16_f32 v38, v92, v93
  v_mfma_f32_16x16x32_bf16 v[116:119], v[180:183], a[156:159], v[116:119]
  v_cvt_pk_bf16_f32 v39, v94, v95
  s_waitcnt lgkmcnt(0)
  v_mfma_f32_16x16x32_bf16 v[124:127], v[180:183], a[180:183], v[124:127]
  v_bitop3_b32 v240, v240, v241, v242 bitop3:0x80
  v_and_b32 v240, v240, v243
  v_mfma_f32_16x16x32_bf16 v[132:135], v[180:183], a[204:207], v[132:135]
  buffer_store_dwordx4 v[36:39], v4, s[24:27], s42 offen offset:3072 sc1
  v_mfma_f32_16x16x32_bf16 v[140:143], v[180:183], a[228:231], v[140:143]
  s_nop 0
  v_readfirstlane_b32 s23, v240
  v_mfma_f32_16x16x32_bf16 v[104:107], v[160:163], a[136:139], v[104:107]
  v_cvt_pk_bf16_f32 v40, v96, v97
  v_mfma_f32_16x16x32_bf16 v[112:115], v[160:163], a[160:163], v[112:115]
  v_mfma_f32_16x16x32_bf16 v[120:123], v[160:163], a[184:187], v[120:123]
  v_cvt_pk_bf16_f32 v41, v98, v99
  v_mfma_f32_16x16x32_bf16 v[128:131], v[160:163], a[208:211], v[128:131]
  v_mfma_f32_16x16x32_bf16 v[136:139], v[160:163], a[232:235], v[136:139]
  v_cvt_pk_bf16_f32 v42, v100, v101
  v_mfma_f32_16x16x32_bf16 v[108:111], v[184:187], a[136:139], v[108:111]
  v_mfma_f32_16x16x32_bf16 v[116:119], v[184:187], a[160:163], v[116:119]
  v_cvt_pk_bf16_f32 v43, v102, v103
  v_mfma_f32_16x16x32_bf16 v[124:127], v[184:187], a[184:187], v[124:127]
  s_add_u32 s69, s42, 4096
  v_mfma_f32_16x16x32_bf16 v[132:135], v[184:187], a[208:211], v[132:135]
  v_mfma_f32_16x16x32_bf16 v[140:143], v[184:187], a[232:235], v[140:143]
  buffer_store_dwordx4 v[40:43], v4, s[24:27], s69 offen offset:0 sc1
  v_mfma_f32_16x16x32_bf16 v[104:107], v[164:167], a[140:143], v[104:107]
  v_mfma_f32_16x16x32_bf16 v[112:115], v[164:167], a[164:167], v[112:115]
  v_mfma_f32_16x16x32_bf16 v[120:123], v[164:167], a[188:191], v[120:123]
  s_waitcnt vmcnt(12)
  s_mov_b32 s50, s46
  s_add_u32 s69, s45, s40
  v_mfma_f32_16x16x32_bf16 v[128:131], v[164:167], a[212:215], v[128:131]
  s_mov_b32 s40, 0
  s_sub_i32 s69, s69, 1
  s_max_i32 s69, s69, s70
  v_mfma_f32_16x16x32_bf16 v[136:139], v[164:167], a[236:239], v[136:139]
  s_add_u32 s45, s45, 1
  s_mov_b32 s68, s42
  s_add_u32 s42, s42, 1310720
  v_mfma_f32_16x16x32_bf16 v[108:111], v[188:191], a[140:143], v[108:111]
  s_add_u32 s21, s45, 1
  s_min_u32 s21, s21, 63
  v_mfma_f32_16x16x32_bf16 v[116:119], v[188:191], a[164:167], v[116:119]
  s_cmp_lt_u32 s21, s50
  s_addc_u32 s21, s31, s31
  v_mov_b32 v21, s21
  v_mfma_f32_16x16x32_bf16 v[124:127], v[188:191], a[188:191], v[124:127]
  ds_write_b32 v6, v21 offset:16
  v_mfma_f32_16x16x32_bf16 v[132:135], v[188:191], a[212:215], v[132:135]
  v_mfma_f32_16x16x32_bf16 v[140:143], v[188:191], a[236:239], v[140:143]
  s_mov_b64 exec, 1
  v_mov_b32 v20, s69
  buffer_store_dword v20, v10, s[72:75], s44 offen sc1
  s_mov_b64 exec, -1
  s_cmp_le_u32 s45, 16
  s_cbranch_scc1 vwe_176
vwe_177:
  s_cmp_eq_u32 s23, 0
  s_cbranch_scc1 vws_174
vwb_175:
  s_waitcnt lgkmcnt(0)
  s_barrier
  v_mfma_f32_16x16x32_bf16 v[64:67], v[192:195], a[0:3], 0
  v_cmp_gt_u32 vcc, 8, v9
  s_nop 0
  v_mfma_f32_16x16x32_bf16 v[72:75], v[192:195], a[24:27], 0
  s_bitset1_b64 vcc, 19
  s_ff1_i32_b64 s21, vcc
  v_mfma_f32_16x16x32_bf16 v[80:83], v[192:195], a[48:51], 0
  s_lshl_b32 s22, s21, 1
  s_lshl_b32 s21, s21, 2
  v_mfma_f32_16x16x32_bf16 v[88:91], v[192:195], a[72:75], 0
  s_sub_i32 s21, s21, 12
  s_max_i32 s47, s21, s22
  v_mfma_f32_16x16x32_bf16 v[96:99], v[192:195], a[96:99], 0
  s_add_u32 s22, s45, 7
  s_min_u32 s22, s22, s47
  v_mfma_f32_16x16x32_bf16 v[68:71], v[216:219], a[0:3], 0
  s_cmp_lt_u32 s46, s22
  s_cselect_b32 s66, s41, 0x80000000
  s_cselect_b32 m0, s64, 98304
  s_cselect_b32 s22, 1, 0
  v_mfma_f32_16x16x32_bf16 v[76:79], v[216:219], a[24:27], 0
  buffer_load_dwordx4 v4, s[16:19], s66 offen offset:0 sc1 lds
  v_mfma_f32_16x16x32_bf16 v[84:87], v[216:219], a[48:51], 0
  v_add_u32 v8, s65, v4
  ds_read_b128 v[240:243], v7 offset:16
  v_mfma_f32_16x16x32_bf16 v[92:95], v[216:219], a[72:75], 0
  buffer_load_dwordx4 v4, s[16:19], s66 offen offset:1024 sc1 lds
  v_mfma_f32_16x16x32_bf16 v[100:103], v[216:219], a[96:99], 0
  s_add_u32 s65, s65, 12288
  v_mfma_f32_16x16x32_bf16 v[64:67], v[196:199], a[4:7], v[64:67]
  buffer_load_dwordx4 v4, s[16:19], s66 offen offset:2048 sc1 lds
  v_mfma_f32_16x16x32_bf16 v[72:75], v[196:199], a[28:31], v[72:75]
  s_cmp_lt_u32 s65, 98304
  s_cselect_b32 s65, s65, 0
  v_mfma_f32_16x16x32_bf16 v[80:83], v[196:199], a[52:55], v[80:83]
  v_cvt_pk_bf16_f32 v44, v104, v105
  v_cvt_pk_bf16_f32 v45, v106, v107
  v_mfma_f32_16x16x32_bf16 v[88:91], v[196:199], a[76:79], v[88:91]
  s_add_u32 s46, s46, s22
  s_mul_i32 s21, s22, 393216
  v_mfma_f32_16x16x32_bf16 v[96:99], v[196:199], a[100:103], v[96:99]
  ds_read_b128 v[144:147], v8 offset:0
  v_cvt_pk_bf16_f32 v46, v108, v109
  v_mfma_f32_16x16x32_bf16 v[68:71], v[220:223], a[4:7], v[68:71]
  s_add_u32 s41, s41, s21
  s_mul_i32 s21, s22, 12288
  v_mfma_f32_16x16x32_bf16 v[76:79], v[220:223], a[28:31], v[76:79]
  v_cvt_pk_bf16_f32 v47, v110, v111
  s_add_u32 s64, s64, s21
  v_mfma_f32_16x16x32_bf16 v[84:87], v[220:223], a[52:55], v[84:87]
  s_add_u32 s69, s68, 4096
  v_mfma_f32_16x16x32_bf16 v[92:95], v[220:223], a[76:79], v[92:95]
  s_cmp_lt_u32 s64, s67
  s_cselect_b32 s64, s64, s71
  v_mfma_f32_16x16x32_bf16 v[100:103], v[220:223], a[100:103], v[100:103]
  buffer_store_dwordx4 v[44:47], v4, s[24:27], s69 offen offset:1024 sc1
  v_mfma_f32_16x16x32_bf16 v[64:67], v[200:203], a[8:11], v[64:67]
  ds_read_b128 v[148:151], v8 offset:1024
  v_mfma_f32_16x16x32_bf16 v[72:75], v[200:203], a[32:35], v[72:75]
  v_cvt_pk_bf16_f32 v48, v112, v113
  v_mfma_f32_16x16x32_bf16 v[80:83], v[200:203], a[56:59], v[80:83]
  v_cvt_pk_bf16_f32 v49, v114, v115
  v_mfma_f32_16x16x32_bf16 v[88:91], v[200:203], a[80:83], v[88:91]
  v_mfma_f32_16x16x32_bf16 v[96:99], v[200:203], a[104:107], v[96:99]
  v_cvt_pk_bf16_f32 v50, v116, v117
  v_mfma_f32_16x16x32_bf16 v[68:71], v[224:227], a[8:11], v[68:71]
  v_mfma_f32_16x16x32_bf16 v[76:79], v[224:227], a[32:35], v[76:79]
  ds_read_b128 v[152:155], v8 offset:2048
  v_cvt_pk_bf16_f32 v51, v118, v119
  v_mfma_f32_16x16x32_bf16 v[84:87], v[224:227], a[56:59], v[84:87]
  buffer_store_dwordx4 v[48:51], v4, s[24:27], s69 offen offset:2048 sc1
  v_mfma_f32_16x16x32_bf16 v[92:95], v[224:227], a[80:83], v[92:95]
  v_mfma_f32_16x16x32_bf16 v[100:103], v[224:227], a[104:107], v[100:103]
  v_cvt_pk_bf16_f32 v52, v120, v121
  v_mfma_f32_16x16x32_bf16 v[64:67], v[204:207], a[12:15], v[64:67]
  v_mfma_f32_16x16x32_bf16 v[72:75], v[204:207], a[36:39], v[72:75]
  v_cvt_pk_bf16_f32 v53, v122, v123
  v_mfma_f32_16x16x32_bf16 v[80:83], v[204:207], a[60:63], v[80:83]
  ds_read_b128 v[156:159], v8 offset:3072
  v_cvt_pk_bf16_f32 v54, v124, v125
  v_mfma_f32_16x16x32_bf16 v[88:91], v[204:207], a[84:87], v[88:91]
  v_mfma_f32_16x16x32_bf16 v[96:99], v[204:207], a[108:111], v[96:99]
  v_cvt_pk_bf16_f32 v55, v126, v127
  v_mfma_f32_16x16x32_bf16 v[68:71], v[228:231], a[12:15], v[68:71]
  v_mfma_f32_16x16x32_bf16 v[76:79], v[228:231], a[36:39], v[76:79]
  buffer_store_dwordx4 v[52:55], v4, s[24:27], s69 offen offset:3072 sc1
  v_mfma_f32_16x16x32_bf16 v[84:87], v[228:231], a[60:63], v[84:87]
  v_cvt_pk_bf16_f32 v56, v128, v129
  v_mfma_f32_16x16x32_bf16 v[92:95], v[228:231], a[84:87], v[92:95]
  ds_read_b128 v[160:163], v8 offset:4096
  v_mfma_f32_16x16x32_bf16 v[100:103], v[228:231], a[108:111], v[100:103]
  v_cvt_pk_bf16_f32 v57, v130, v131
  v_mfma_f32_16x16x32_bf16 v[64:67], v[208:211], a[16:19], v[64:67]
  v_mfma_f32_16x16x32_bf16 v[72:75], v[208:211], a[40:43], v[72:75]
  v_cvt_pk_bf16_f32 v58, v132, v133
  v_mfma_f32_16x16x32_bf16 v[80:83], v[208:211], a[64:67], v[80:83]
  v_cvt_pk_bf16_f32 v59, v134, v135
  v_mfma_f32_16x16x32_bf16 v[88:91], v[208:211], a[88:91], v[88:91]
  v_mfma_f32_16x16x32_bf16 v[96:99], v[208:211], a[112:115], v[96:99]
  ds_read_b128 v[164:167], v8 offset:5120
  s_add_u32 s69, s68, 8192
  v_mfma_f32_16x16x32_bf16 v[68:71], v[232:235], a[16:19], v[68:71]
  v_mfma_f32_16x16x32_bf16 v[76:79], v[232:235], a[40:43], v[76:79]
  buffer_store_dwordx4 v[56:59], v4, s[24:27], s69 offen offset:0 sc1
  v_mfma_f32_16x16x32_bf16 v[84:87], v[232:235], a[64:67], v[84:87]
  v_cvt_pk_bf16_f32 v60, v136, v137
  v_mfma_f32_16x16x32_bf16 v[92:95], v[232:235], a[88:91], v[92:95]
  v_mfma_f32_16x16x32_bf16 v[100:103], v[232:235], a[112:115], v[100:103]
  v_cvt_pk_bf16_f32 v61, v138, v139
  v_mfma_f32_16x16x32_bf16 v[64:67], v[212:215], a[20:23], v[64:67]
  ds_read_b128 v[168:171], v8 offset:6144
  v_mfma_f32_16x16x32_bf16 v[72:75], v[212:215], a[44:47], v[72:75]
  v_cvt_pk_bf16_f32 v62, v140, v141
  v_mfma_f32_16x16x32_bf16 v[80:83], v[212:215], a[68:71], v[80:83]
  v_cvt_pk_bf16_f32 v63, v142, v143
  v_mfma_f32_16x16x32_bf16 v[88:91], v[212:215], a[92:95], v[88:91]
  v_mfma_f32_16x16x32_bf16 v[96:99], v[212:215], a[116:119], v[96:99]
  buffer_store_dwordx4 v[60:63], v4, s[24:27], s69 offen offset:1024 sc1
  v_mfma_f32_16x16x32_bf16 v[68:71], v[236:239], a[20:23], v[68:71]
  v_mfma_f32_16x16x32_bf16 v[76:79], v[236:239], a[44:47], v[76:79]
  ds_read_b128 v[172:175], v8 offset:7168
  v_mfma_f32_16x16x32_bf16 v[84:87], v[236:239], a[68:71], v[84:87]
  v_mfma_f32_16x16x32_bf16 v[92:95], v[236:239], a[92:95], v[92:95]
  v_mfma_f32_16x16x32_bf16 v[100:103], v[236:239], a[116:119], v[100:103]
  v_mfma_f32_16x16x32_bf16 v[104:107], v[192:195], a[120:123], 0
  buffer_load_dword v9, v5, s[72:75], s43 offen sc1
  v_mfma_f32_16x16x32_bf16 v[112:115], v[192:195], a[144:147], 0
  v_mfma_f32_16x16x32_bf16 v[120:123], v[192:195], a[168:171], 0
  ds_read_b128 v[176:179], v8 offset:8192
  v_mfma_f32_16x16x32_bf16 v[128:131], v[192:195], a[192:195], 0
  v_cvt_pk_bf16_f32 v24, v64, v65
  v_mfma_f32_16x16x32_bf16 v[136:139], v[192:195], a[216:219], 0
  v_mfma_f32_16x16x32_bf16 v[108:111], v[216:219], a[120:123], 0
  v_cvt_pk_bf16_f32 v25, v66, v67
  v_mfma_f32_16x16x32_bf16 v[116:119], v[216:219], a[144:147], 0
  s_cmp_lt_u32 s51, 6291456
  s_cselect_b32 s52, s51, 0x80000000
  v_mfma_f32_16x16x32_bf16 v[124:127], v[216:219], a[168:171], 0
  v_cvt_pk_bf16_f32 v26, v68, v69
  v_mfma_f32_16x16x32_bf16 v[132:135], v[216:219], a[192:195], 0
  ds_read_b128 v[180:183], v8 offset:9216
  v_mfma_f32_16x16x32_bf16 v[140:143], v[216:219], a[216:219], 0
  v_cvt_pk_bf16_f32 v27, v70, v71
  v_mfma_f32_16x16x32_bf16 v[104:107], v[196:199], a[124:127], v[104:107]
  buffer_store_dwordx4 v[244:247], v4, s[84:87], s52 offen sc1
  v_mfma_f32_16x16x32_bf16 v[112:115], v[196:199], a[148:151], v[112:115]
  buffer_store_dwordx4 v[24:27], v4, s[24:27], s42 offen offset:0 sc1
  v_mfma_f32_16x16x32_bf16 v[120:123], v[196:199], a[172:175], v[120:123]
  s_add_u32 s51, s51, 98304
  v_mfma_f32_16x16x32_bf16 v[128:131], v[196:199], a[196:199], v[128:131]
  v_cvt_pk_bf16_f32 v28, v72, v73
  v_mfma_f32_16x16x32_bf16 v[136:139], v[196:199], a[220:223], v[136:139]
  ds_read_b128 v[184:187], v8 offset:10240
  v_cvt_pk_bf16_f32 v29, v74, v75
  v_mfma_f32_16x16x32_bf16 v[108:111], v[220:223], a[124:127], v[108:111]
  s_cmp_eq_u32 s40, 3
  s_cbranch_scc1 vwm_180
vwm_181:
  v_mfma_f32_16x16x32_bf16 v[116:119], v[220:223], a[148:151], v[116:119]
  v_cvt_pk_bf16_f32 v30, v76, v77
  v_mfma_f32_16x16x32_bf16 v[124:127], v[220:223], a[172:175], v[124:127]
  v_mfma_f32_16x16x32_bf16 v[132:135], v[220:223], a[196:199], v[132:135]
  v_cvt_pk_bf16_f32 v31, v78, v79
  v_mfma_f32_16x16x32_bf16 v[140:143], v[220:223], a[220:223], v[140:143]
  v_mfma_f32_16x16x32_bf16 v[104:107], v[200:203], a[128:131], v[104:107]
  ds_read_b128 v[188:191], v8 offset:11264
  v_mfma_f32_16x16x32_bf16 v[112:115], v[200:203], a[152:155], v[112:115]
  buffer_store_dwordx4 v[28:31], v4, s[24:27], s42 offen offset:1024 sc1
  v_mfma_f32_16x16x32_bf16 v[120:123], v[200:203], a[176:179], v[120:123]
  v_cvt_pk_bf16_f32 v32, v80, v81
  v_mfma_f32_16x16x32_bf16 v[128:131], v[200:203], a[200:203], v[128:131]
  v_mfma_f32_16x16x32_bf16 v[136:139], v[200:203], a[224:227], v[136:139]
  v_cvt_pk_bf16_f32 v33, v82, v83
  v_mfma_f32_16x16x32_bf16 v[108:111], v[224:227], a[128:131], v[108:111]
  v_cvt_pk_bf16_f32 v34, v84, v85
  v_mfma_f32_16x16x32_bf16 v[116:119], v[224:227], a[152:155], v[116:119]
  v_mfma_f32_16x16x32_bf16 v[124:127], v[224:227], a[176:179], v[124:127]
  v_cvt_pk_bf16_f32 v35, v86, v87
  v_mfma_f32_16x16x32_bf16 v[132:135], v[224:227], a[200:203], v[132:135]
  v_mfma_f32_16x16x32_bf16 v[140:143], v[224:227], a[224:227], v[140:143]
  buffer_store_dwordx4 v[32:35], v4, s[24:27], s42 offen offset:2048 sc1
  v_mfma_f32_16x16x32_bf16 v[104:107], v[204:207], a[132:135], v[104:107]
  v_mfma_f32_16x16x32_bf16 v[112:115], v[204:207], a[156:159], v[112:115]
  v_cvt_pk_bf16_f32 v36, v88, v89
  v_mfma_f32_16x16x32_bf16 v[120:123], v[204:207], a[180:183], v[120:123]
  v_mfma_f32_16x16x32_bf16 v[128:131], v[204:207], a[204:207], v[128:131]
  v_cvt_pk_bf16_f32 v37, v90, v91
  v_mfma_f32_16x16x32_bf16 v[136:139], v[204:207], a[228:231], v[136:139]
  v_mfma_f32_16x16x32_bf16 v[108:111], v[228:231], a[132:135], v[108:111]
  v_cvt_pk_bf16_f32 v38, v92, v93
  v_mfma_f32_16x16x32_bf16 v[116:119], v[228:231], a[156:159], v[116:119]
  v_cvt_pk_bf16_f32 v39, v94, v95
  s_waitcnt lgkmcnt(0)
  v_mfma_f32_16x16x32_bf16 v[124:127], v[228:231], a[180:183], v[124:127]
  v_bitop3_b32 v240, v240, v241, v242 bitop3:0x80
  v_and_b32 v240, v240, v243
  v_mfma_f32_16x16x32_bf16 v[132:135], v[228:231], a[204:207], v[132:135]
  buffer_store_dwordx4 v[36:39], v4, s[24:27], s42 offen offset:3072 sc1
  v_mfma_f32_16x16x32_bf16 v[140:143], v[228:231], a[228:231], v[140:143]
  s_nop 0
  v_readfirstlane_b32 s23, v240
  v_mfma_f32_16x16x32_bf16 v[104:107], v[208:211], a[136:139], v[104:107]
  v_cvt_pk_bf16_f32 v40, v96, v97
  v_mfma_f32_16x16x32_bf16 v[112:115], v[208:211], a[160:163], v[112:115]
  v_mfma_f32_16x16x32_bf16 v[120:123], v[208:211], a[184:187], v[120:123]
  v_cvt_pk_bf16_f32 v41, v98, v99
  v_mfma_f32_16x16x32_bf16 v[128:131], v[208:211], a[208:211], v[128:131]
  v_mfma_f32_16x16x32_bf16 v[136:139], v[208:211], a[232:235], v[136:139]
  v_cvt_pk_bf16_f32 v42, v100, v101
  v_mfma_f32_16x16x32_bf16 v[108:111], v[232:235], a[136:139], v[108:111]
  v_mfma_f32_16x16x32_bf16 v[116:119], v[232:235], a[160:163], v[116:119]
  v_cvt_pk_bf16_f32 v43, v102, v103
  v_mfma_f32_16x16x32_bf16 v[124:127], v[232:235], a[184:187], v[124:127]
  s_add_u32 s69, s42, 4096
  v_mfma_f32_16x16x32_bf16 v[132:135], v[232:235], a[208:211], v[132:135]
  v_mfma_f32_16x16x32_bf16 v[140:143], v[232:235], a[232:235], v[140:143]
  buffer_store_dwordx4 v[40:43], v4, s[24:27], s69 offen offset:0 sc1
  v_mfma_f32_16x16x32_bf16 v[104:107], v[212:215], a[140:143], v[104:107]
  v_mfma_f32_16x16x32_bf16 v[112:115], v[212:215], a[164:167], v[112:115]
  v_mfma_f32_16x16x32_bf16 v[120:123], v[212:215], a[188:191], v[120:123]
  s_waitcnt vmcnt(12)
  s_mov_b32 s50, s46
  s_add_u32 s69, s45, s40
  v_mfma_f32_16x16x32_bf16 v[128:131], v[212:215], a[212:215], v[128:131]
  s_mov_b32 s40, 0
  s_sub_i32 s69, s69, 1
  s_max_i32 s69, s69, s70
  v_mfma_f32_16x16x32_bf16 v[136:139], v[212:215], a[236:239], v[136:139]
  s_add_u32 s45, s45, 1
  s_mov_b32 s68, s42
  s_add_u32 s42, s42, 1310720
  v_mfma_f32_16x16x32_bf16 v[108:111], v[236:239], a[140:143], v[108:111]
  s_add_u32 s21, s45, 1
  s_min_u32 s21, s21, 63
  v_mfma_f32_16x16x32_bf16 v[116:119], v[236:239], a[164:167], v[116:119]
  s_cmp_lt_u32 s21, s50
  s_addc_u32 s21, s31, s31
  v_mov_b32 v21, s21
  v_mfma_f32_16x16x32_bf16 v[124:127], v[236:239], a[188:191], v[124:127]
  ds_write_b32 v6, v21 offset:0
  v_mfma_f32_16x16x32_bf16 v[132:135], v[236:239], a[212:215], v[132:135]
  v_mfma_f32_16x16x32_bf16 v[140:143], v[236:239], a[236:239], v[140:143]
  s_mov_b64 exec, 1
  v_mov_b32 v20, s69
  buffer_store_dword v20, v10, s[72:75], s44 offen sc1
  s_mov_b64 exec, -1
  s_cmp_le_u32 s45, 16
  s_cbranch_scc1 vwe_184
vwe_185:
  s_cmp_lg_u32 s45, 48
  s_cbranch_scc1 arm_188
  s_mul_i32 s21, s2, 10240
  s_mul_i32 s22, s20, 2560
  s_add_u32 s21, s21, s22
  s_add_u32 s21, s21, 18350080
  buffer_store_dwordx4 v[244:247], v15, s[80:83], s21 offen offset:0 sc1
  buffer_store_dwordx4 v[244:247], v15, s[80:83], s21 offen offset:512 sc1
  buffer_store_dwordx4 v[244:247], v15, s[80:83], s21 offen offset:1024 sc1
  buffer_store_dwordx4 v[244:247], v15, s[80:83], s21 offen offset:1536 sc1
  buffer_store_dwordx4 v[244:247], v15, s[80:83], s21 offen offset:2048 sc1
  s_add_u32 s21, s21, 655360
  buffer_store_dwordx4 v[244:247], v15, s[80:83], s21 offen offset:0 sc1
  buffer_store_dwordx4 v[244:247], v15, s[80:83], s21 offen offset:512 sc1
  buffer_store_dwordx4 v[244:247], v15, s[80:83], s21 offen offset:1024 sc1
  buffer_store_dwordx4 v[244:247], v15, s[80:83], s21 offen offset:1536 sc1
  buffer_store_dwordx4 v[244:247], v15, s[80:83], s21 offen offset:2048 sc1
  s_add_u32 s21, s21, 655360
  buffer_store_dwordx4 v[244:247], v15, s[80:83], s21 offen offset:0 sc1
  buffer_store_dwordx4 v[244:247], v15, s[80:83], s21 offen offset:512 sc1
  buffer_store_dwordx4 v[244:247], v15, s[80:83], s21 offen offset:1024 sc1
  buffer_store_dwordx4 v[244:247], v15, s[80:83], s21 offen offset:1536 sc1
  buffer_store_dwordx4 v[244:247], v15, s[80:83], s21 offen offset:2048 sc1
  s_add_u32 s21, s21, 655360
  buffer_store_dwordx4 v[244:247], v15, s[80:83], s21 offen offset:0 sc1
  buffer_store_dwordx4 v[244:247], v15, s[80:83], s21 offen offset:512 sc1
  buffer_store_dwordx4 v[244:247], v15, s[80:83], s21 offen offset:1024 sc1
  buffer_store_dwordx4 v[244:247], v15, s[80:83], s21 offen offset:1536 sc1
  buffer_store_dwordx4 v[244:247], v15, s[80:83], s21 offen offset:2048 sc1
  s_add_u32 s21, s21, 655360
  s_and_b32 s21, s2, 3
  s_cmp_lg_u32 s21, s20
  s_cbranch_scc1 arm_188
  s_mul_i32 s21, s2, 2560
  s_add_u32 s21, s21, 4587520
  v_lshlrev_b32 v21, 3, v1
  buffer_store_dwordx4 v[244:247], v4, s[88:91], s21 offen sc1
  buffer_store_dwordx4 v[244:247], v4, s[88:91], s21 offen offset:1024 sc1
  buffer_store_dwordx2 v[244:245], v21, s[88:91], s21 offen offset:2048 sc1
  s_add_u32 s21, s21, 81920
  buffer_store_dwordx4 v[244:247], v4, s[88:91], s21 offen sc1
  buffer_store_dwordx4 v[244:247], v4, s[88:91], s21 offen offset:1024 sc1
  buffer_store_dwordx2 v[244:245], v21, s[88:91], s21 offen offset:2048 sc1
  s_add_u32 s21, s21, 81920
  buffer_store_dwordx4 v[244:247], v4, s[88:91], s21 offen sc1
  buffer_store_dwordx4 v[244:247], v4, s[88:91], s21 offen offset:1024 sc1
  buffer_store_dwordx2 v[244:245], v21, s[88:91], s21 offen offset:2048 sc1
  s_add_u32 s21, s21, 81920
  buffer_store_dwordx4 v[244:247], v4, s[88:91], s21 offen sc1
  buffer_store_dwordx4 v[244:247], v4, s[88:91], s21 offen offset:1024 sc1
  buffer_store_dwordx2 v[244:245], v21, s[88:91], s21 offen offset:2048 sc1
  s_add_u32 s21, s21, 81920
  buffer_store_dwordx4 v[244:247], v4, s[88:91], s21 offen sc1
  buffer_store_dwordx4 v[244:247], v4, s[88:91], s21 offen offset:1024 sc1
  buffer_store_dwordx2 v[244:245], v21, s[88:91], s21 offen offset:2048 sc1
  s_add_u32 s21, s21, 81920
  buffer_store_dwordx4 v[244:247], v4, s[88:91], s21 offen sc1
  buffer_store_dwordx4 v[244:247], v4, s[88:91], s21 offen offset:1024 sc1
  buffer_store_dwordx2 v[244:245], v21, s[88:91], s21 offen offset:2048 sc1
  s_add_u32 s21, s21, 81920
  buffer_store_dwordx4 v[244:247], v4, s[88:91], s21 offen sc1
  buffer_store_dwordx4 v[244:247], v4, s[88:91], s21 offen offset:1024 sc1
  buffer_store_dwordx2 v[244:245], v21, s[88:91], s21 offen offset:2048 sc1
  s_add_u32 s21, s21, 81920
  buffer_store_dwordx4 v[244:247], v4, s[88:91], s21 offen sc1
  buffer_store_dwordx4 v[244:247], v4, s[88:91], s21 offen offset:1024 sc1
  buffer_store_dwordx2 v[244:245], v21, s[88:91], s21 offen offset:2048 sc1
  s_add_u32 s21, s21, 81920
arm_188:
  s_cmp_ge_u32 s45, 64
  s_cbranch_scc1 vwd_171
  s_cmp_lg_u32 s23, 0
  s_cbranch_scc1 vwl_170
  s_branch vws_182
vws_174:
  v_cmp_gt_u32 vcc, 8, v9
  s_nop 0
  s_bitset1_b64 vcc, 19
  s_ff1_i32_b64 s21, vcc
  s_lshl_b32 s22, s21, 1
  s_lshl_b32 s21, s21, 2
  s_sub_i32 s21, s21, 12
  s_max_i32 s47, s21, s22
  s_cmp_gt_u32 s47, s45
  s_cbranch_scc1 va_190
  s_cmp_eq_u32 s70, s45
  s_cbranch_scc1 va_195
  s_nop 4
  v_cvt_pk_bf16_f32 v44, v104, v105
  v_cvt_pk_bf16_f32 v45, v106, v107
  v_cvt_pk_bf16_f32 v46, v108, v109
  v_cvt_pk_bf16_f32 v47, v110, v111
  s_add_u32 s69, s68, 4096
  buffer_store_dwordx4 v[44:47], v4, s[24:27], s69 offen offset:1024 sc1
  v_cvt_pk_bf16_f32 v48, v112, v113
  v_cvt_pk_bf16_f32 v49, v114, v115
  v_cvt_pk_bf16_f32 v50, v116, v117
  v_cvt_pk_bf16_f32 v51, v118, v119
  buffer_store_dwordx4 v[48:51], v4, s[24:27], s69 offen offset:2048 sc1
  v_cvt_pk_bf16_f32 v52, v120, v121
  v_cvt_pk_bf16_f32 v53, v122, v123
  v_cvt_pk_bf16_f32 v54, v124, v125
  v_cvt_pk_bf16_f32 v55, v126, v127
  buffer_store_dwordx4 v[52:55], v4, s[24:27], s69 offen offset:3072 sc1
  v_cvt_pk_bf16_f32 v56, v128, v129
  v_cvt_pk_bf16_f32 v57, v130, v131
  v_cvt_pk_bf16_f32 v58, v132, v133
  v_cvt_pk_bf16_f32 v59, v134, v135
  s_add_u32 s69, s68, 8192
  buffer_store_dwordx4 v[56:59], v4, s[24:27], s69 offen offset:0 sc1
  v_cvt_pk_bf16_f32 v60, v136, v137
  v_cvt_pk_bf16_f32 v61, v138, v139
  v_cvt_pk_bf16_f32 v62, v140, v141
  v_cvt_pk_bf16_f32 v63, v142, v143
  buffer_store_dwordx4 v[60:63], v4, s[24:27], s69 offen offset:1024 sc1
  s_mov_b32 s68, 0x80000000
  s_waitcnt vmcnt(0)
  s_mov_b64 exec, 1
  v_mov_b32 v20, s45
  buffer_store_dword v20, v10, s[72:75], s44 offen sc1
  s_mov_b64 exec, -1
  s_mov_b32 s70, s45
  s_mov_b32 s40, 0
va_195:
  s_mov_b32 s101, 0
  s_branch va_193
va_191:
  s_sleep 8
va_193:
  buffer_load_dword v9, v5, s[72:75], s43 offen sc1
  s_add_u32 s101, s101, 1
  s_cmp_gt_u32 s101, 131072
  s_cbranch_scc1 main_end
  s_waitcnt vmcnt(0)
  v_cmp_gt_u32 vcc, 8, v9
  s_nop 0
  s_bitset1_b64 vcc, 19
  s_ff1_i32_b64 s21, vcc
  s_lshl_b32 s22, s21, 1
  s_lshl_b32 s21, s21, 2
  s_sub_i32 s21, s21, 12
  s_max_i32 s47, s21, s22
  s_cmp_gt_u32 s47, s45
  s_cbranch_scc0 va_191
va_190:
  s_add_u32 s22, s45, 6
  s_min_u32 s22, s22, s47
va_192:
  s_cmp_ge_u32 s46, s22
  s_cbranch_scc1 va_194
  s_mov_b32 m0, s64
  s_mov_b32 s66, s41
  buffer_load_dwordx4 v4, s[16:19], s66 offen offset:0 sc1 lds
  buffer_load_dwordx4 v4, s[16:19], s66 offen offset:1024 sc1 lds
  buffer_load_dwordx4 v4, s[16:19], s66 offen offset:2048 sc1 lds
  s_add_u32 s46, s46, 1
  s_add_u32 s41, s41, 393216
  s_add_u32 s64, s64, 12288
  s_cmp_lt_u32 s64, s67
  s_cselect_b32 s64, s64, s71
  s_branch va_192
va_194:
  s_mov_b32 s48, s46
  s_mov_b32 s49, s46
  s_mov_b32 s50, s46
  s_waitcnt vmcnt(0)
  s_cmp_eq_u32 s40, 0
  s_cbranch_scc1 va_196
  s_mov_b32 s40, 0
  s_mov_b64 exec, 1
  v_mov_b32 v20, s45
  buffer_store_dword v20, v10, s[72:75], s44 offen sc1
  s_mov_b64 exec, -1
  s_mov_b32 s70, s45
va_196:
  s_barrier
  ds_read_b128 v[192:195], v8 offset:0
  ds_read_b128 v[196:199], v8 offset:1024
  ds_read_b128 v[200:203], v8 offset:2048
  ds_read_b128 v[204:207], v8 offset:3072
  ds_read_b128 v[208:211], v8 offset:4096
  ds_read_b128 v[212:215], v8 offset:5120
  ds_read_b128 v[216:219], v8 offset:6144
  ds_read_b128 v[220:223], v8 offset:7168
  ds_read_b128 v[224:227], v8 offset:8192
  ds_read_b128 v[228:231], v8 offset:9216
  ds_read_b128 v[232:235], v8 offset:10240
  ds_read_b128 v[236:239], v8 offset:11264
  s_add_u32 s21, s45, 1
  s_min_u32 s21, s21, 63
  s_cmp_lt_u32 s21, s50
  s_addc_u32 s21, s31, s31
  v_mov_b32 v21, s21
  ds_write_b32 v6, v21 offset:16
  s_branch vwb_175
vws_182:
  v_cmp_gt_u32 vcc, 8, v9
  s_nop 0
  s_bitset1_b64 vcc, 19
  s_ff1_i32_b64 s21, vcc
  s_lshl_b32 s22, s21, 1
  s_lshl_b32 s21, s21, 2
  s_sub_i32 s21, s21, 12
  s_max_i32 s47, s21, s22
  s_cmp_gt_u32 s47, s45
  s_cbranch_scc1 va_197
  s_cmp_eq_u32 s70, s45
  s_cbranch_scc1 va_202
  s_nop 4
  v_cvt_pk_bf16_f32 v44, v104, v105
  v_cvt_pk_bf16_f32 v45, v106, v107
  v_cvt_pk_bf16_f32 v46, v108, v109
  v_cvt_pk_bf16_f32 v47, v110, v111
  s_add_u32 s69, s68, 4096
  buffer_store_dwordx4 v[44:47], v4, s[24:27], s69 offen offset:1024 sc1
  v_cvt_pk_bf16_f32 v48, v112, v113
  v_cvt_pk_bf16_f32 v49, v114, v115
  v_cvt_pk_bf16_f32 v50, v116, v117
  v_cvt_pk_bf16_f32 v51, v118, v119
  buffer_store_dwordx4 v[48:51], v4, s[24:27], s69 offen offset:2048 sc1
  v_cvt_pk_bf16_f32 v52, v120, v121
  v_cvt_pk_bf16_f32 v53, v122, v123
  v_cvt_pk_bf16_f32 v54, v124, v125
  v_cvt_pk_bf16_f32 v55, v126, v127
  buffer_store_dwordx4 v[52:55], v4, s[24:27], s69 offen offset:3072 sc1
  v_cvt_pk_bf16_f32 v56, v128, v129
  v_cvt_pk_bf16_f32 v57, v130, v131
  v_cvt_pk_bf16_f32 v58, v132, v133
  v_cvt_pk_bf16_f32 v59, v134, v135
  s_add_u32 s69, s68, 8192
  buffer_store_dwordx4 v[56:59], v4, s[24:27], s69 offen offset:0 sc1
  v_cvt_pk_bf16_f32 v60, v136, v137
  v_cvt_pk_bf16_f32 v61, v138, v139
  v_cvt_pk_bf16_f32 v62, v140, v141
  v_cvt_pk_bf16_f32 v63, v142, v143
  buffer_store_dwordx4 v[60:63], v4, s[24:27], s69 offen offset:1024 sc1
  s_mov_b32 s68, 0x80000000
  s_waitcnt vmcnt(0)
  s_mov_b64 exec, 1
  v_mov_b32 v20, s45
  buffer_store_dword v20, v10, s[72:75], s44 offen sc1
  s_mov_b64 exec, -1
  s_mov_b32 s70, s45
  s_mov_b32 s40, 0
va_202:
  s_mov_b32 s101, 0
  s_branch va_200
va_198:
  s_sleep 8
va_200:
  buffer_load_dword v9, v5, s[72:75], s43 offen sc1
  s_add_u32 s101, s101, 1
  s_cmp_gt_u32 s101, 131072
  s_cbranch_scc1 main_end
  s_waitcnt vmcnt(0)
  v_cmp_gt_u32 vcc, 8, v9
  s_nop 0
  s_bitset1_b64 vcc, 19
  s_ff1_i32_b64 s21, vcc
  s_lshl_b32 s22, s21, 1
  s_lshl_b32 s21, s21, 2
  s_sub_i32 s21, s21, 12
  s_max_i32 s47, s21, s22
  s_cmp_gt_u32 s47, s45
  s_cbranch_scc0 va_198
va_197:
  s_add_u32 s22, s45, 6
  s_min_u32 s22, s22, s47
va_199:
  s_cmp_ge_u32 s46, s22
  s_cbranch_scc1 va_201
  s_mov_b32 m0, s64
  s_mov_b32 s66, s41
  buffer_load_dwordx4 v4, s[16:19], s66 offen offset:0 sc1 lds
  buffer_load_dwordx4 v4, s[16:19], s66 offen offset:1024 sc1 lds
  buffer_load_dwordx4 v4, s[16:19], s66 offen offset:2048 sc1 lds
  s_add_u32 s46, s46, 1
  s_add_u32 s41, s41, 393216
  s_add_u32 s64, s64, 12288
  s_cmp_lt_u32 s64, s67
  s_cselect_b32 s64, s64, s71
  s_branch va_199
va_201:
  s_mov_b32 s48, s46
  s_mov_b32 s49, s46
  s_mov_b32 s50, s46
  s_waitcnt vmcnt(0)
  s_cmp_eq_u32 s40, 0
  s_cbranch_scc1 va_203
  s_mov_b32 s40, 0
  s_mov_b64 exec, 1
  v_mov_b32 v20, s45
  buffer_store_dword v20, v10, s[72:75], s44 offen sc1
  s_mov_b64 exec, -1
  s_mov_b32 s70, s45
va_203:
  s_barrier
  ds_read_b128 v[144:147], v8 offset:0
  ds_read_b128 v[148:151], v8 offset:1024
  ds_read_b128 v[152:155], v8 offset:2048
  ds_read_b128 v[156:159], v8 offset:3072
  ds_read_b128 v[160:163], v8 offset:4096
  ds_read_b128 v[164:167], v8 offset:5120
  ds_read_b128 v[168:171], v8 offset:6144
  ds_read_b128 v[172:175], v8 offset:7168
  ds_read_b128 v[176:179], v8 offset:8192
  ds_read_b128 v[180:183], v8 offset:9216
  ds_read_b128 v[184:187], v8 offset:10240
  ds_read_b128 v[188:191], v8 offset:11264
  s_add_u32 s21, s45, 1
  s_min_u32 s21, s21, 63
  s_cmp_lt_u32 s21, s50
  s_addc_u32 s21, s31, s31
  v_mov_b32 v21, s21
  ds_write_b32 v6, v21 offset:0
  s_branch vwl_170
vwe_176:
  s_nop 4
  v_cvt_pk_bf16_f32 v44, v104, v105
  v_cvt_pk_bf16_f32 v45, v106, v107
  v_cvt_pk_bf16_f32 v46, v108, v109
  v_cvt_pk_bf16_f32 v47, v110, v111
  s_add_u32 s69, s68, 4096
  buffer_store_dwordx4 v[44:47], v4, s[24:27], s69 offen offset:1024 sc1
  v_cvt_pk_bf16_f32 v48, v112, v113
  v_cvt_pk_bf16_f32 v49, v114, v115
  v_cvt_pk_bf16_f32 v50, v116, v117
  v_cvt_pk_bf16_f32 v51, v118, v119
  buffer_store_dwordx4 v[48:51], v4, s[24:27], s69 offen offset:2048 sc1
  v_cvt_pk_bf16_f32 v52, v120, v121
  v_cvt_pk_bf16_f32 v53, v122, v123
  v_cvt_pk_bf16_f32 v54, v124, v125
  v_cvt_pk_bf16_f32 v55, v126, v127
  buffer_store_dwordx4 v[52:55], v4, s[24:27], s69 offen offset:3072 sc1
  v_cvt_pk_bf16_f32 v56, v128, v129
  v_cvt_pk_bf16_f32 v57, v130, v131
  v_cvt_pk_bf16_f32 v58, v132, v133
  v_cvt_pk_bf16_f32 v59, v134, v135
  s_add_u32 s69, s68, 8192
  buffer_store_dwordx4 v[56:59], v4, s[24:27], s69 offen offset:0 sc1
  v_cvt_pk_bf16_f32 v60, v136, v137
  v_cvt_pk_bf16_f32 v61, v138, v139
  v_cvt_pk_bf16_f32 v62, v140, v141
  v_cvt_pk_bf16_f32 v63, v142, v143
  buffer_store_dwordx4 v[60:63], v4, s[24:27], s69 offen offset:1024 sc1
  s_mov_b32 s68, 0x80000000
  s_cmp_le_u32 s45, 4
  s_cselect_b32 s40, 3, 1
  s_branch vwe_177
vwe_184:
  s_nop 4
  v_cvt_pk_bf16_f32 v44, v104, v105
  v_cvt_pk_bf16_f32 v45, v106, v107
  v_cvt_pk_bf16_f32 v46, v108, v109
  v_cvt_pk_bf16_f32 v47, v110, v111
  s_add_u32 s69, s68, 4096
  buffer_store_dwordx4 v[44:47], v4, s[24:27], s69 offen offset:1024 sc1
  v_cvt_pk_bf16_f32 v48, v112, v113
  v_cvt_pk_bf16_f32 v49, v114, v115
  v_cvt_pk_bf16_f32 v50, v116, v117
  v_cvt_pk_bf16_f32 v51, v118, v119
  buffer_store_dwordx4 v[48:51], v4, s[24:27], s69 offen offset:2048 sc1
  v_cvt_pk_bf16_f32 v52, v120, v121
  v_cvt_pk_bf16_f32 v53, v122, v123
  v_cvt_pk_bf16_f32 v54, v124, v125
  v_cvt_pk_bf16_f32 v55, v126, v127
  buffer_store_dwordx4 v[52:55], v4, s[24:27], s69 offen offset:3072 sc1
  v_cvt_pk_bf16_f32 v56, v128, v129
  v_cvt_pk_bf16_f32 v57, v130, v131
  v_cvt_pk_bf16_f32 v58, v132, v133
  v_cvt_pk_bf16_f32 v59, v134, v135
  s_add_u32 s69, s68, 8192
  buffer_store_dwordx4 v[56:59], v4, s[24:27], s69 offen offset:0 sc1
  v_cvt_pk_bf16_f32 v60, v136, v137
  v_cvt_pk_bf16_f32 v61, v138, v139
  v_cvt_pk_bf16_f32 v62, v140, v141
  v_cvt_pk_bf16_f32 v63, v142, v143
  buffer_store_dwordx4 v[60:63], v4, s[24:27], s69 offen offset:1024 sc1
  s_mov_b32 s68, 0x80000000
  s_cmp_le_u32 s45, 4
  s_cselect_b32 s40, 3, 1
  s_branch vwe_185
vwm_172:
  s_mov_b32 s40, 0
  s_waitcnt vmcnt(11)
  s_mov_b64 exec, 1
  v_mov_b32 v20, s45
  buffer_store_dword v20, v10, s[72:75], s44 offen sc1
  s_mov_b64 exec, -1
  s_mov_b32 s70, s45
  s_branch vwm_173
vwm_180:
  s_mov_b32 s40, 0
  s_waitcnt vmcnt(11)
  s_mov_b64 exec, 1
  v_mov_b32 v20, s45
  buffer_store_dword v20, v10, s[72:75], s44 offen sc1
  s_mov_b64 exec, -1
  s_mov_b32 s70, s45
  s_branch vwm_181
vwd_171:
  s_nop 4
  v_cvt_pk_bf16_f32 v44, v104, v105
  v_cvt_pk_bf16_f32 v45, v106, v107
  v_cvt_pk_bf16_f32 v46, v108, v109
  v_cvt_pk_bf16_f32 v47, v110, v111
  s_add_u32 s69, s68, 4096
  buffer_store_dwordx4 v[44:47], v4, s[24:27], s69 offen offset:1024 sc1
  v_cvt_pk_bf16_f32 v48, v112, v113
  v_cvt_pk_bf16_f32 v49, v114, v115
  v_cvt_pk_bf16_f32 v50, v116, v117
  v_cvt_pk_bf16_f32 v51, v118, v119
  buffer_store_dwordx4 v[48:51], v4, s[24:27], s69 offen offset:2048 sc1
  v_cvt_pk_bf16_f32 v52, v120, v121
  v_cvt_pk_bf16_f32 v53, v122, v123
  v_cvt_pk_bf16_f32 v54, v124, v125
  v_cvt_pk_bf16_f32 v55, v126, v127
  buffer_store_dwordx4 v[52:55], v4, s[24:27], s69 offen offset:3072 sc1
  v_cvt_pk_bf16_f32 v56, v128, v129
  v_cvt_pk_bf16_f32 v57, v130, v131
  v_cvt_pk_bf16_f32 v58, v132, v133
  v_cvt_pk_bf16_f32 v59, v134, v135
  s_add_u32 s69, s68, 8192
  buffer_store_dwordx4 v[56:59], v4, s[24:27], s69 offen offset:0 sc1
  v_cvt_pk_bf16_f32 v60, v136, v137
  v_cvt_pk_bf16_f32 v61, v138, v139
  v_cvt_pk_bf16_f32 v62, v140, v141
  v_cvt_pk_bf16_f32 v63, v142, v143
  buffer_store_dwordx4 v[60:63], v4, s[24:27], s69 offen offset:1024 sc1
  s_waitcnt vmcnt(0)
  s_mov_b64 exec, 1
  v_mov_b32 v20, s45
  buffer_store_dword v20, v10, s[72:75], s44 offen sc1
  s_mov_b64 exec, -1
  s_mov_b32 s84, 0
  s_mov_b32 s85, -1
  s_and_b32 s21, s3, 3
  s_sub_u32 s22, s21, 1
  s_lshl_b32 s22, s22, 3
  s_bfe_u32 s87, s3, 0x30002
  s_add_u32 s87, s87, s22
  s_add_u32 s87, s87, 366
  s_cmp_lt_u32 s21, 1
  s_cselect_b32 s87, -1, s87
  s_sub_u32 s21, s3, 64
  s_waitcnt vmcnt(0) lgkmcnt(0)
  s_barrier
  s_branch do_opb2
  s_mov_b32 s84, 0
  s_mov_b32 s85, -1
  s_mov_b32 s86, 0
  s_branch queue
not_vw:
  s_sub_u32 s2, s3, 96
  s_cmp_lg_u32 s2, 31
  s_cbranch_scc1 not_cal
  s_add_u32 s8, s38, 83886079
  s_addc_u32 s9, s39, 0
  s_and_b32 s8, s8, 0xffe00000
  s_mov_b32 s10, 2097152
  s_mov_b32 s11, 0x00020000
  v_lshrrev_b32 v9, 4, v0
  v_mul_u32_u24 v9, 16640, v9
  v_bfe_u32 v10, v0, 3, 1
  v_lshl_add_u32 v9, v10, 13, v9
  v_and_b32 v10, 7, v0
  v_lshl_add_u32 v9, v10, 4, v9
  s_mov_b32 s21, 1048576
  buffer_store_dwordx4 v[4:7], v9, s[8:11], s21 offen sc1
  s_waitcnt vmcnt(0)
  s_barrier
  s_cmp_lg_u32 s20, 3
  s_cbranch_scc1 cal_204
  s_mov_b64 exec, 1
  v_mov_b32 v4, 0
  s_mov_b32 s40, -1
  s_mov_b32 s41, -1
  s_mov_b32 s42, 1048576
  s_mov_b32 s43, 0
  s_waitcnt vmcnt(0)
cal_205:
  s_add_u32 s21, s42, 0
  s_memtime s[98:99]
  s_waitcnt lgkmcnt(0)
  buffer_load_dword v5, v4, s[8:11], s21 offen sc1
  s_waitcnt vmcnt(0)
  s_memtime s[100:101]
  s_waitcnt lgkmcnt(0)
  s_sub_u32 s21, s100, s98
  s_min_u32 s40, s40, s21
  s_add_u32 s21, s42, 8192
  s_memtime s[98:99]
  s_waitcnt lgkmcnt(0)
  buffer_load_dword v5, v4, s[8:11], s21 offen sc1
  s_waitcnt vmcnt(0)
  s_memtime s[100:101]
  s_waitcnt lgkmcnt(0)
  s_sub_u32 s21, s100, s98
  s_min_u32 s41, s41, s21
  s_add_u32 s42, s42, 16640
  s_add_u32 s43, s43, 1
  s_cmp_lt_u32 s43, 4
  s_cbranch_scc1 cal_205
  s_cmp_lt_u32 s41, s40
  s_cselect_b32 s21, 1, 2
  v_mov_b32 v4, s21
  v_mov_b32 v5, s40
  v_mov_b32 v6, s41
  v_mov_b32 v8, 84
  buffer_store_dwordx3 v[4:6], v8, s[32:35], 0 offen sc1
  s_waitcnt vmcnt(0)
  s_mov_b64 exec, -1
cal_204:
  s_barrier
  s_branch armed
not_cal:
  s_sleep 32
  s_sleep 32
  s_sleep 32
  s_sleep 32
  s_sleep 32
armed:
  s_load_dwordx2 s[72:73], s[0:1], 104
  s_waitcnt lgkmcnt(0)
  s_add_u32 s72, s72, 81068032
  s_addc_u32 s73, s73, 0
  s_mov_b32 s74, 116736
  s_mov_b32 s75, 0x00020000
  s_load_dwordx2 s[4:5], s[0:1], 0
  s_load_dwordx2 s[6:7], s[0:1], 64
  s_load_dwordx2 s[38:39], s[0:1], 104
  s_lshr_b32 s41, s2, 1
  s_and_b32 s42, s2, 1
  s_waitcnt lgkmcnt(0)
  s_mov_b32 s8, s4
  s_mov_b32 s9, s5
  s_mov_b32 s10, 2621440
  s_mov_b32 s11, 0x00020000
  s_mov_b32 s12, s6
  s_mov_b32 s13, s7
  s_mov_b32 s14, 2457600
  s_mov_b32 s15, 0x00020000
  s_add_u32 s16, s38, 70713344
  s_addc_u32 s17, s39, 0
  s_mov_b32 s18, 2641920
  s_mov_b32 s19, 0x00020000
  s_add_u32 s72, s38, 81068032
  s_addc_u32 s73, s39, 0
  s_mov_b32 s74, 116736
  s_mov_b32 s75, 0x00020000
  v_lshlrev_b32 v6, 1, v3
  v_add_u32 v6, 0, v6
  v_xor_b32 v6, v6, v2
  v_min_u32 v6, 14, v6
  v_mul_u32_u24 v7, 52, v6
  v_lshrrev_b32 v7, 8, v7
  v_mul_u32_u24 v7, 1200, v7
  v_lshl_add_u32 v7, v6, 4, v7
  v_mul_u32_u24 v6, 3840, v3
  v_add_u32 v4, v6, v7
  v_lshlrev_b32 v6, 1, v3
  v_add_u32 v6, 8, v6
  v_xor_b32 v6, v6, v2
  v_min_u32 v6, 14, v6
  v_mul_u32_u24 v7, 52, v6
  v_lshrrev_b32 v7, 8, v7
  v_mul_u32_u24 v7, 1200, v7
  v_lshl_add_u32 v7, v6, 4, v7
  v_mul_u32_u24 v6, 3840, v3
  v_add_u32 v5, v6, v7
  s_mul_i32 s21, s41, 80
  s_mul_i32 s22, s20, 15360
  s_add_u32 s21, s21, s22
  s_lshl_b32 s22, s20, 10
  s_cmp_ge_u32 s20, 2
  s_cselect_b64 vcc, -1, 0
  v_cndmask_b32 v4, v4, v5, vcc
  s_add_u32 m0, s22, 0
  s_nop 0
  buffer_load_dwordx4 v4, s[12:15], s21 offen lds
  s_add_u32 s21, s21, 61440
  s_add_u32 m0, s22, 4096
  s_nop 0
  buffer_load_dwordx4 v4, s[12:15], s21 offen lds
  s_add_u32 s21, s21, 61440
  s_add_u32 m0, s22, 8192
  s_nop 0
  buffer_load_dwordx4 v4, s[12:15], s21 offen lds
  s_add_u32 s21, s21, 61440
  s_add_u32 m0, s22, 12288
  s_nop 0
  buffer_load_dwordx4 v4, s[12:15], s21 offen lds
  s_add_u32 s21, s21, 61440
  s_add_u32 m0, s22, 16384
  s_nop 0
  buffer_load_dwordx4 v4, s[12:15], s21 offen lds
  s_add_u32 s21, s21, 61440
  s_add_u32 m0, s22, 20480
  s_nop 0
  buffer_load_dwordx4 v4, s[12:15], s21 offen lds
  s_add_u32 s21, s21, 61440
  s_add_u32 m0, s22, 24576
  s_nop 0
  buffer_load_dwordx4 v4, s[12:15], s21 offen lds
  s_add_u32 s21, s21, 61440
  s_add_u32 m0, s22, 28672
  s_nop 0
  buffer_load_dwordx4 v4, s[12:15], s21 offen lds
  s_add_u32 s21, s21, 61440
  s_add_u32 m0, s22, 32768
  s_nop 0
  buffer_load_dwordx4 v4, s[12:15], s21 offen lds
  s_add_u32 s21, s21, 61440
  s_add_u32 m0, s22, 36864
  s_nop 0
  buffer_load_dwordx4 v4, s[12:15], s21 offen lds
  s_add_u32 s21, s21, 61440
  s_add_u32 m0, s22, 40960
  s_nop 0
  buffer_load_dwordx4 v4, s[12:15], s21 offen lds
  s_add_u32 s21, s21, 61440
  s_add_u32 m0, s22, 45056
  s_nop 0
  buffer_load_dwordx4 v4, s[12:15], s21 offen lds
  s_add_u32 s21, s21, 61440
  s_add_u32 m0, s22, 49152
  s_nop 0
  buffer_load_dwordx4 v4, s[12:15], s21 offen lds
  s_add_u32 s21, s21, 61440
  s_add_u32 m0, s22, 53248
  s_nop 0
  buffer_load_dwordx4 v4, s[12:15], s21 offen lds
  s_add_u32 s21, s21, 61440
  s_add_u32 m0, s22, 57344
  s_nop 0
  buffer_load_dwordx4 v4, s[12:15], s21 offen lds
  s_add_u32 s21, s21, 61440
  s_add_u32 m0, s22, 61440
  s_nop 0
  buffer_load_dwordx4 v4, s[12:15], s21 offen lds
  s_add_u32 s21, s21, 61440
  s_add_u32 m0, s22, 65536
  s_nop 0
  buffer_load_dwordx4 v4, s[12:15], s21 offen lds
  s_add_u32 s21, s21, 61440
  s_add_u32 m0, s22, 69632
  s_nop 0
  buffer_load_dwordx4 v4, s[12:15], s21 offen lds
  s_add_u32 s21, s21, 61440
  s_add_u32 m0, s22, 73728
  s_nop 0
  buffer_load_dwordx4 v4, s[12:15], s21 offen lds
  s_add_u32 s21, s21, 61440
  s_add_u32 m0, s22, 77824
  s_nop 0
  buffer_load_dwordx4 v4, s[12:15], s21 offen lds
  s_add_u32 s21, s21, 61440
  s_add_u32 m0, s22, 81920
  s_nop 0
  buffer_load_dwordx4 v4, s[12:15], s21 offen lds
  s_add_u32 s21, s21, 61440
  s_add_u32 m0, s22, 86016
  s_nop 0
  buffer_load_dwordx4 v4, s[12:15], s21 offen lds
  s_add_u32 s21, s21, 61440
  s_add_u32 m0, s22, 90112
  s_nop 0
  buffer_load_dwordx4 v4, s[12:15], s21 offen lds
  s_add_u32 s21, s21, 61440
  s_add_u32 m0, s22, 94208
  s_nop 0
  buffer_load_dwordx4 v4, s[12:15], s21 offen lds
  s_add_u32 s21, s21, 61440
  s_add_u32 m0, s22, 98304
  s_nop 0
  buffer_load_dwordx4 v4, s[12:15], s21 offen lds
  s_add_u32 s21, s21, 61440
  s_add_u32 m0, s22, 102400
  s_nop 0
  buffer_load_dwordx4 v4, s[12:15], s21 offen lds
  s_add_u32 s21, s21, 61440
  s_add_u32 m0, s22, 106496
  s_nop 0
  buffer_load_dwordx4 v4, s[12:15], s21 offen lds
  s_add_u32 s21, s21, 61440
  s_add_u32 m0, s22, 110592
  s_nop 0
  buffer_load_dwordx4 v4, s[12:15], s21 offen lds
  s_add_u32 s21, s21, 61440
  s_add_u32 m0, s22, 114688
  s_nop 0
  buffer_load_dwordx4 v4, s[12:15], s21 offen lds
  s_add_u32 s21, s21, 61440
  s_add_u32 m0, s22, 118784
  s_nop 0
  buffer_load_dwordx4 v4, s[12:15], s21 offen lds
  s_add_u32 s21, s21, 61440
  s_add_u32 m0, s22, 122880
  s_nop 0
  buffer_load_dwordx4 v4, s[12:15], s21 offen lds
  s_add_u32 s21, s21, 61440
  s_add_u32 m0, s22, 126976
  s_nop 0
  buffer_load_dwordx4 v4, s[12:15], s21 offen lds
  s_add_u32 s21, s21, 61440
  s_add_u32 m0, s22, 131072
  s_nop 0
  buffer_load_dwordx4 v4, s[12:15], s21 offen lds
  s_add_u32 s21, s21, 61440
  s_add_u32 m0, s22, 135168
  s_nop 0
  buffer_load_dwordx4 v4, s[12:15], s21 offen lds
  s_add_u32 s21, s21, 61440
  s_add_u32 m0, s22, 139264
  s_nop 0
  buffer_load_dwordx4 v4, s[12:15], s21 offen lds
  s_add_u32 s21, s21, 61440
  s_add_u32 m0, s22, 143360
  s_nop 0
  buffer_load_dwordx4 v4, s[12:15], s21 offen lds
  s_add_u32 s21, s21, 61440
  s_add_u32 m0, s22, 147456
  s_nop 0
  buffer_load_dwordx4 v4, s[12:15], s21 offen lds
  s_add_u32 s21, s21, 61440
  s_add_u32 m0, s22, 151552
  s_nop 0
  buffer_load_dwordx4 v4, s[12:15], s21 offen lds
  s_add_u32 s21, s21, 61440
  s_add_u32 m0, s22, 155648
  s_nop 0
  buffer_load_dwordx4 v4, s[12:15], s21 offen lds
  s_add_u32 s21, s21, 61440
  s_add_u32 m0, s22, 159744
  s_nop 0
  buffer_load_dwordx4 v4, s[12:15], s21 offen lds
  s_add_u32 s21, s21, 61440
  s_lshl_b32 s21, s2, 2
  s_add_u32 s21, s21, s20
  s_mul_i32 s21, s21, 20480
  v_lshlrev_b32 v5, 4, v1
  buffer_load_dwordx4 v[64:67], v5, s[8:11], s21 offen offset:0
  buffer_load_dwordx4 v[64:67], v5, s[8:11], s21 offen offset:1024
  buffer_load_dwordx4 v[64:67], v5, s[8:11], s21 offen offset:2048
  buffer_load_dwordx4 v[64:67], v5, s[8:11], s21 offen offset:3072
  s_add_u32 s21, s21, 4096
  buffer_load_dwordx4 v[64:67], v5, s[8:11], s21 offen offset:0
  buffer_load_dwordx4 v[64:67], v5, s[8:11], s21 offen offset:1024
  buffer_load_dwordx4 v[64:67], v5, s[8:11], s21 offen offset:2048
  buffer_load_dwordx4 v[64:67], v5, s[8:11], s21 offen offset:3072
  s_add_u32 s21, s21, 4096
  buffer_load_dwordx4 v[64:67], v5, s[8:11], s21 offen offset:0
  buffer_load_dwordx4 v[64:67], v5, s[8:11], s21 offen offset:1024
  buffer_load_dwordx4 v[64:67], v5, s[8:11], s21 offen offset:2048
  buffer_load_dwordx4 v[64:67], v5, s[8:11], s21 offen offset:3072
  s_add_u32 s21, s21, 4096
  buffer_load_dwordx4 v[64:67], v5, s[8:11], s21 offen offset:0
  buffer_load_dwordx4 v[64:67], v5, s[8:11], s21 offen offset:1024
  buffer_load_dwordx4 v[64:67], v5, s[8:11], s21 offen offset:2048
  buffer_load_dwordx4 v[64:67], v5, s[8:11], s21 offen offset:3072
  s_add_u32 s21, s21, 4096
  buffer_load_dwordx4 v[64:67], v5, s[8:11], s21 offen offset:0
  buffer_load_dwordx4 v[64:67], v5, s[8:11], s21 offen offset:1024
  buffer_load_dwordx4 v[64:67], v5, s[8:11], s21 offen offset:2048
  buffer_load_dwordx4 v[64:67], v5, s[8:11], s21 offen offset:3072
  v_lshrrev_b32 v6, 2, v2
  v_lshl_add_u32 v7, v3, 3, v6
  v_and_b32 v8, 1, v3
  v_lshl_add_u32 v6, v8, 2, v6
  v_lshlrev_b32 v6, 1, v6
  v_bfe_u32 v8, v2, 1, 1
  s_lshl_b32 s21, s20, 2
  v_add_u32 v8, s21, v8
  v_and_b32 v9, 1, v2
  v_lshlrev_b32 v9, 3, v9
  v_lshl_add_u32 v9, v7, 8, v9
  v_add_u32 v5, 0, v8
  v_xor_b32 v5, v5, v6
  v_lshl_add_u32 v10, v5, 4, v9
  v_add_u32 v11, 65536, v10
  v_add_u32 v12, 131072, v10
  v_add_u32 v5, 2, v8
  v_xor_b32 v5, v5, v6
  v_lshl_add_u32 v13, v5, 4, v9
  v_add_u32 v14, 65536, v13
  v_add_u32 v15, 131072, v13
  s_waitcnt vmcnt(50)
  s_barrier
  ds_read_b64_tr_b16 a[0:1], v10 offset:0
  ds_read_b64_tr_b16 a[2:3], v10 offset:1024
  ds_read_b64_tr_b16 a[4:5], v13 offset:0
  ds_read_b64_tr_b16 a[6:7], v13 offset:1024
  ds_read_b64_tr_b16 a[8:9], v10 offset:8192
  ds_read_b64_tr_b16 a[10:11], v10 offset:9216
  ds_read_b64_tr_b16 a[12:13], v13 offset:8192
  ds_read_b64_tr_b16 a[14:15], v13 offset:9216
  ds_read_b64_tr_b16 a[16:17], v10 offset:16384
  ds_read_b64_tr_b16 a[18:19], v10 offset:17408
  ds_read_b64_tr_b16 a[20:21], v13 offset:16384
  ds_read_b64_tr_b16 a[22:23], v13 offset:17408
  ds_read_b64_tr_b16 a[24:25], v10 offset:24576
  ds_read_b64_tr_b16 a[26:27], v10 offset:25600
  ds_read_b64_tr_b16 a[28:29], v13 offset:24576
  ds_read_b64_tr_b16 a[30:31], v13 offset:25600
  ds_read_b64_tr_b16 a[32:33], v10 offset:32768
  ds_read_b64_tr_b16 a[34:35], v10 offset:33792
  ds_read_b64_tr_b16 a[36:37], v13 offset:32768
  ds_read_b64_tr_b16 a[38:39], v13 offset:33792
  s_waitcnt vmcnt(40)
  s_barrier
  ds_read_b64_tr_b16 a[40:41], v10 offset:40960
  ds_read_b64_tr_b16 a[42:43], v10 offset:41984
  ds_read_b64_tr_b16 a[44:45], v13 offset:40960
  ds_read_b64_tr_b16 a[46:47], v13 offset:41984
  ds_read_b64_tr_b16 a[48:49], v10 offset:49152
  ds_read_b64_tr_b16 a[50:51], v10 offset:50176
  ds_read_b64_tr_b16 a[52:53], v13 offset:49152
  ds_read_b64_tr_b16 a[54:55], v13 offset:50176
  ds_read_b64_tr_b16 a[56:57], v10 offset:57344
  ds_read_b64_tr_b16 a[58:59], v10 offset:58368
  ds_read_b64_tr_b16 a[60:61], v13 offset:57344
  ds_read_b64_tr_b16 a[62:63], v13 offset:58368
  ds_read_b64_tr_b16 a[64:65], v11 offset:0
  ds_read_b64_tr_b16 a[66:67], v11 offset:1024
  ds_read_b64_tr_b16 a[68:69], v14 offset:0
  ds_read_b64_tr_b16 a[70:71], v14 offset:1024
  ds_read_b64_tr_b16 a[72:73], v11 offset:8192
  ds_read_b64_tr_b16 a[74:75], v11 offset:9216
  ds_read_b64_tr_b16 a[76:77], v14 offset:8192
  ds_read_b64_tr_b16 a[78:79], v14 offset:9216
  s_waitcnt vmcnt(30)
  s_barrier
  ds_read_b64_tr_b16 a[80:81], v11 offset:16384
  ds_read_b64_tr_b16 a[82:83], v11 offset:17408
  ds_read_b64_tr_b16 a[84:85], v14 offset:16384
  ds_read_b64_tr_b16 a[86:87], v14 offset:17408
  ds_read_b64_tr_b16 a[88:89], v11 offset:24576
  ds_read_b64_tr_b16 a[90:91], v11 offset:25600
  ds_read_b64_tr_b16 a[92:93], v14 offset:24576
  ds_read_b64_tr_b16 a[94:95], v14 offset:25600
  ds_read_b64_tr_b16 a[96:97], v11 offset:32768
  ds_read_b64_tr_b16 a[98:99], v11 offset:33792
  ds_read_b64_tr_b16 a[100:101], v14 offset:32768
  ds_read_b64_tr_b16 a[102:103], v14 offset:33792
  ds_read_b64_tr_b16 a[104:105], v11 offset:40960
  ds_read_b64_tr_b16 a[106:107], v11 offset:41984
  ds_read_b64_tr_b16 a[108:109], v14 offset:40960
  ds_read_b64_tr_b16 a[110:111], v14 offset:41984
  ds_read_b64_tr_b16 a[112:113], v11 offset:49152
  ds_read_b64_tr_b16 a[114:115], v11 offset:50176
  ds_read_b64_tr_b16 a[116:117], v14 offset:49152
  ds_read_b64_tr_b16 a[118:119], v14 offset:50176
  s_waitcnt vmcnt(20)
  s_barrier
  ds_read_b64_tr_b16 a[120:121], v11 offset:57344
  ds_read_b64_tr_b16 a[122:123], v11 offset:58368
  ds_read_b64_tr_b16 a[124:125], v14 offset:57344
  ds_read_b64_tr_b16 a[126:127], v14 offset:58368
  ds_read_b64_tr_b16 a[128:129], v12 offset:0
  ds_read_b64_tr_b16 a[130:131], v12 offset:1024
  ds_read_b64_tr_b16 a[132:133], v15 offset:0
  ds_read_b64_tr_b16 a[134:135], v15 offset:1024
  ds_read_b64_tr_b16 a[136:137], v12 offset:8192
  ds_read_b64_tr_b16 a[138:139], v12 offset:9216
  ds_read_b64_tr_b16 a[140:141], v15 offset:8192
  ds_read_b64_tr_b16 a[142:143], v15 offset:9216
  ds_read_b64_tr_b16 a[144:145], v12 offset:16384
  ds_read_b64_tr_b16 a[146:147], v12 offset:17408
  ds_read_b64_tr_b16 a[148:149], v15 offset:16384
  ds_read_b64_tr_b16 a[150:151], v15 offset:17408
  ds_read_b64_tr_b16 a[152:153], v12 offset:24576
  ds_read_b64_tr_b16 a[154:155], v12 offset:25600
  ds_read_b64_tr_b16 a[156:157], v15 offset:24576
  ds_read_b64_tr_b16 a[158:159], v15 offset:25600
  s_waitcnt lgkmcnt(0)
  s_barrier
  v_and_b32 v4, 31, v1
  s_lshl_b32 s21, s20, 5
  v_add_u32 v36, s21, v4
  v_lshrrev_b32 v5, 5, v1
  v_mul_u32_u24 v6, 264, v36
  v_mul_u32_u24 v7, 40, v5
  s_mov_b32 s21, 114952
  v_add3_u32 v34, v6, v7, s21
  v_lshl_add_u32 v38, v5, 3, v34
  v_lshlrev_b32 v6, 5, v5
  v_sub_u32 v39, v34, v6
  v_lshlrev_b32 v35, 3, v1
  v_add_u32 v35, 114688, v35
  v_mov_b32 v37, 0xf149f2ca
  s_mul_i32 s21, s41, 165120
  s_mul_i32 s22, s42, 16512
  s_add_u32 s21, s21, s22
  v_lshl_add_u32 v7, v36, 4, s21
  v_mul_u32_u24 v6, 99072, v5
  v_add_u32 v29, v6, v7
  v_add_u32 v30, 33024, v29
  v_lshl_add_u32 v31, v5, 3, v7
  v_add_u32 v31, 66048, v31
  v_mov_b32 v8, 0
  v_mov_b32 v9, 0
  ds_write_b64 v35, v[8:9] offset:0
  ds_write_b64 v35, v[8:9] offset:512
  ds_write_b64 v35, v[8:9] offset:1024
  ds_write_b64 v35, v[8:9] offset:1536
  ds_write_b64 v35, v[8:9] offset:2048
  s_mul_i32 s24, s42, 1280
  s_mov_b32 s25, 327680
  s_mov_b32 s26, 8
  s_mov_b32 s27, 0
  s_mov_b32 s60, 0x3e64f92e
  s_mov_b32 s61, 0x3fb8aa3b
  s_mov_b32 s62, 0x05040100
  s_mov_b32 s63, 0x07060302
  v_cmp_le_u32 s[76:77], 0, v36
  v_cmp_le_u32 s[78:79], 1, v36
  v_cmp_le_u32 s[80:81], 2, v36
  v_cmp_le_u32 s[82:83], 3, v36
  v_cmp_le_u32 s[84:85], 4, v36
  v_cmp_le_u32 s[86:87], 5, v36
  v_cmp_le_u32 s[88:89], 6, v36
  v_cmp_le_u32 s[90:91], 7, v36
  v_lshrrev_b32 v11, 3, v1
  v_and_b32 v12, 7, v1
  v_xor_b32 v12, v12, v11
  v_mul_u32_u24 v11, 2560, v11
  v_lshl_add_u32 v10, v12, 4, v11
  s_mul_i32 s46, s20, 81920
  v_add_u32 v10, s46, v10
  s_lshl_b32 s47, s20, 12
  s_add_u32 s47, s47, 0
  s_add_u32 s46, s47, 114688
  s_mov_b32 s30, s24
  s_add_u32 s32, s47, 0
  v_add_u32 v11, 19456, v10
  v_add_u32 v12, 38912, v10
  v_add_u32 v13, 58368, v10
  s_mov_b32 m0, s32
  s_nop 0
  buffer_load_dwordx4 v10, s[8:11], s30 offen offset:0 lds
  buffer_load_dwordx4 v11, s[8:11], s30 offen offset:1024 lds
  buffer_load_dwordx4 v12, s[8:11], s30 offen offset:2048 lds
  buffer_load_dwordx4 v13, s[8:11], s30 offen offset:3072 lds
  s_add_u32 s30, s30, 128
  s_add_u32 s32, s32, 16384
  s_cmp_lt_u32 s32, s46
  s_cselect_b32 s32, s32, s47
  s_mov_b32 m0, s32
  s_nop 0
  buffer_load_dwordx4 v10, s[8:11], s30 offen offset:0 lds
  buffer_load_dwordx4 v11, s[8:11], s30 offen offset:1024 lds
  buffer_load_dwordx4 v12, s[8:11], s30 offen offset:2048 lds
  buffer_load_dwordx4 v13, s[8:11], s30 offen offset:3072 lds
  s_add_u32 s30, s30, 128
  s_add_u32 s32, s32, 16384
  s_cmp_lt_u32 s32, s46
  s_cselect_b32 s32, s32, s47
  s_mov_b32 m0, s32
  s_nop 0
  buffer_load_dwordx4 v10, s[8:11], s30 offen offset:0 lds
  buffer_load_dwordx4 v11, s[8:11], s30 offen offset:1024 lds
  buffer_load_dwordx4 v12, s[8:11], s30 offen offset:2048 lds
  buffer_load_dwordx4 v13, s[8:11], s30 offen offset:3072 lds
  s_add_u32 s30, s30, 128
  s_add_u32 s32, s32, 16384
  s_cmp_lt_u32 s32, s46
  s_cselect_b32 s32, s32, s47
  s_mov_b32 m0, s32
  s_nop 0
  buffer_load_dwordx4 v10, s[8:11], s30 offen offset:0 lds
  buffer_load_dwordx4 v11, s[8:11], s30 offen offset:1024 lds
  buffer_load_dwordx4 v12, s[8:11], s30 offen offset:2048 lds
  buffer_load_dwordx4 v13, s[8:11], s30 offen offset:3072 lds
  s_add_u32 s30, s30, 128
  s_add_u32 s32, s32, 16384
  s_cmp_lt_u32 s32, s46
  s_cselect_b32 s32, s32, s47
  s_mov_b32 m0, s32
  s_nop 0
  buffer_load_dwordx4 v10, s[8:11], s30 offen offset:0 lds
  buffer_load_dwordx4 v11, s[8:11], s30 offen offset:1024 lds
  buffer_load_dwordx4 v12, s[8:11], s30 offen offset:2048 lds
  buffer_load_dwordx4 v13, s[8:11], s30 offen offset:3072 lds
  s_add_u32 s30, s30, 128
  s_add_u32 s32, s32, 16384
  s_cmp_lt_u32 s32, s46
  s_cselect_b32 s32, s32, s47
  v_and_b32 v6, 7, v2
  v_add_u32 v4, 0, v3
  v_xor_b32 v4, v4, v6
  v_lshlrev_b32 v4, 4, v4
  v_lshl_add_u32 v14, v2, 7, v4
  v_add_u32 v4, 4, v3
  v_xor_b32 v4, v4, v6
  v_lshlrev_b32 v4, 4, v4
  v_lshl_add_u32 v15, v2, 7, v4
  v_mul_u32_u24 v22, 264, v2
  v_mul_u32_u24 v4, 8, v3
  s_mul_i32 s21, s20, 64
  s_add_u32 s21, s21, 116800
  v_add3_u32 v22, v22, v4, s21
  v_lshlrev_b32 v4, 3, v3
  v_sub_u32 v16, v22, v4
  v_mov_b32 v9, 2731
  s_mov_b32 s33, 0
  s_mov_b32 s48, 0x80000000
  s_mov_b32 m0, s32
  s_nop 0
  buffer_load_dwordx4 v10, s[8:11], s30 offen offset:0 lds
  buffer_load_dwordx4 v11, s[8:11], s30 offen offset:1024 lds
  s_waitcnt vmcnt(18)
  s_barrier
  v_add_u32 v18, s33, v14
  v_add_u32 v19, s33, v15
  s_add_u32 s33, s33, 16384
  s_cmp_lt_u32 s33, 114688
  s_cselect_b32 s33, s33, 0
  ds_read_b128 v[160:163], v18 offset:0
  ds_read_b128 v[164:167], v18 offset:2048
  ds_read_b128 v[168:171], v18 offset:4096
  ds_read_b128 v[172:175], v18 offset:6144
  ds_read_b128 v[176:179], v18 offset:8192
  ds_read_b128 v[180:183], v18 offset:10240
  ds_read_b128 v[184:187], v18 offset:12288
  ds_read_b128 v[188:191], v18 offset:14336
  s_waitcnt lgkmcnt(0)
bf_blk_206:
  v_mfma_f32_16x16x32_bf16 v[64:67], a[0:3], v[160:163], 0
  ds_read_b128 v[192:195], v19 offset:0
  v_mfma_f32_16x16x32_bf16 v[68:71], a[4:7], v[160:163], 0
  v_add_u32 v18, s33, v14
  v_mfma_f32_16x16x32_bf16 v[72:75], a[0:3], v[164:167], 0
  ds_read_b128 v[196:199], v19 offset:2048
  v_mfma_f32_16x16x32_bf16 v[76:79], a[4:7], v[164:167], 0
  buffer_load_dwordx4 v12, s[8:11], s30 offen offset:2048 lds
  v_mfma_f32_16x16x32_bf16 v[80:83], a[0:3], v[168:171], 0
  ds_read_b128 v[200:203], v19 offset:4096
  v_mfma_f32_16x16x32_bf16 v[84:87], a[4:7], v[168:171], 0
  v_mfma_f32_16x16x32_bf16 v[88:91], a[0:3], v[172:175], 0
  ds_read_b128 v[204:207], v19 offset:6144
  v_mfma_f32_16x16x32_bf16 v[92:95], a[4:7], v[172:175], 0
  s_waitcnt lgkmcnt(14)
  v_mfma_f32_16x16x32_bf16 v[96:99], a[0:3], v[176:179], 0
  ds_read_b128 v[208:211], v19 offset:8192
  v_mfma_f32_16x16x32_bf16 v[100:103], a[4:7], v[176:179], 0
  v_mfma_f32_16x16x32_bf16 v[104:107], a[0:3], v[180:183], 0
  ds_read_b128 v[212:215], v19 offset:10240
  v_mfma_f32_16x16x32_bf16 v[108:111], a[4:7], v[180:183], 0
  buffer_load_dwordx4 v13, s[8:11], s30 offen offset:3072 lds
  v_mfma_f32_16x16x32_bf16 v[112:115], a[0:3], v[184:187], 0
  ds_read_b128 v[216:219], v19 offset:12288
  s_add_u32 s30, s30, 128
  v_mfma_f32_16x16x32_bf16 v[116:119], a[4:7], v[184:187], 0
  s_add_u32 m0, m0, 16384
  v_mfma_f32_16x16x32_bf16 v[120:123], a[0:3], v[188:191], 0
  ds_read_b128 v[220:223], v19 offset:14336
  v_mfma_f32_16x16x32_bf16 v[124:127], a[4:7], v[188:191], 0
  s_waitcnt vmcnt(16) lgkmcnt(4)
  s_barrier
  v_mfma_f32_16x16x32_bf16 v[64:67], a[8:11], v[192:195], v[64:67]
  ds_read_b128 v[160:163], v18 offset:0
  v_mfma_f32_16x16x32_bf16 v[68:71], a[12:15], v[192:195], v[68:71]
  s_cmp_lt_u32 m0, s46
  s_cselect_b32 m0, m0, s47
  v_mfma_f32_16x16x32_bf16 v[72:75], a[8:11], v[196:199], v[72:75]
  ds_read_b128 v[164:167], v18 offset:2048
  v_add_u32 v19, s33, v15
  v_mfma_f32_16x16x32_bf16 v[76:79], a[12:15], v[196:199], v[76:79]
  buffer_load_dwordx4 v10, s[8:11], s30 offen offset:0 lds
  v_mfma_f32_16x16x32_bf16 v[80:83], a[8:11], v[200:203], v[80:83]
  ds_read_b128 v[168:171], v18 offset:4096
  s_add_u32 s33, s33, 16384
  v_mfma_f32_16x16x32_bf16 v[84:87], a[12:15], v[200:203], v[84:87]
  s_cmp_lt_u32 s33, 114688
  s_cselect_b32 s33, s33, 0
  v_mfma_f32_16x16x32_bf16 v[88:91], a[8:11], v[204:207], v[88:91]
  ds_read_b128 v[172:175], v18 offset:6144
  v_mfma_f32_16x16x32_bf16 v[92:95], a[12:15], v[204:207], v[92:95]
  s_waitcnt lgkmcnt(4)
  v_mfma_f32_16x16x32_bf16 v[96:99], a[8:11], v[208:211], v[96:99]
  ds_read_b128 v[176:179], v18 offset:8192
  v_mfma_f32_16x16x32_bf16 v[100:103], a[12:15], v[208:211], v[100:103]
  v_mfma_f32_16x16x32_bf16 v[104:107], a[8:11], v[212:215], v[104:107]
  ds_read_b128 v[180:183], v18 offset:10240
  v_mfma_f32_16x16x32_bf16 v[108:111], a[12:15], v[212:215], v[108:111]
  buffer_load_dwordx4 v11, s[8:11], s30 offen offset:1024 lds
  v_mfma_f32_16x16x32_bf16 v[112:115], a[8:11], v[216:219], v[112:115]
  ds_read_b128 v[184:187], v18 offset:12288
  v_mfma_f32_16x16x32_bf16 v[116:119], a[12:15], v[216:219], v[116:119]
  v_mfma_f32_16x16x32_bf16 v[120:123], a[8:11], v[220:223], v[120:123]
  ds_read_b128 v[188:191], v18 offset:14336
  v_mfma_f32_16x16x32_bf16 v[124:127], a[12:15], v[220:223], v[124:127]
  s_waitcnt lgkmcnt(4)
  v_mfma_f32_16x16x32_bf16 v[64:67], a[16:19], v[160:163], v[64:67]
  ds_read_b128 v[192:195], v19 offset:0
  v_mfma_f32_16x16x32_bf16 v[68:71], a[20:23], v[160:163], v[68:71]
  v_add_u32 v18, s33, v14
  v_mfma_f32_16x16x32_bf16 v[72:75], a[16:19], v[164:167], v[72:75]
  ds_read_b128 v[196:199], v19 offset:2048
  v_mfma_f32_16x16x32_bf16 v[76:79], a[20:23], v[164:167], v[76:79]
  buffer_load_dwordx4 v12, s[8:11], s30 offen offset:2048 lds
  v_mfma_f32_16x16x32_bf16 v[80:83], a[16:19], v[168:171], v[80:83]
  ds_read_b128 v[200:203], v19 offset:4096
  v_mfma_f32_16x16x32_bf16 v[84:87], a[20:23], v[168:171], v[84:87]
  v_mfma_f32_16x16x32_bf16 v[88:91], a[16:19], v[172:175], v[88:91]
  ds_read_b128 v[204:207], v19 offset:6144
  v_mfma_f32_16x16x32_bf16 v[92:95], a[20:23], v[172:175], v[92:95]
  s_waitcnt lgkmcnt(4)
  v_mfma_f32_16x16x32_bf16 v[96:99], a[16:19], v[176:179], v[96:99]
  ds_read_b128 v[208:211], v19 offset:8192
  v_mfma_f32_16x16x32_bf16 v[100:103], a[20:23], v[176:179], v[100:103]
  v_mfma_f32_16x16x32_bf16 v[104:107], a[16:19], v[180:183], v[104:107]
  ds_read_b128 v[212:215], v19 offset:10240
  v_mfma_f32_16x16x32_bf16 v[108:111], a[20:23], v[180:183], v[108:111]
  buffer_load_dwordx4 v13, s[8:11], s30 offen offset:3072 lds
  v_mfma_f32_16x16x32_bf16 v[112:115], a[16:19], v[184:187], v[112:115]
  ds_read_b128 v[216:219], v19 offset:12288
  s_add_u32 s30, s30, 128
  v_mfma_f32_16x16x32_bf16 v[116:119], a[20:23], v[184:187], v[116:119]
  s_add_u32 m0, m0, 16384
  v_mfma_f32_16x16x32_bf16 v[120:123], a[16:19], v[188:191], v[120:123]
  ds_read_b128 v[220:223], v19 offset:14336
  v_mfma_f32_16x16x32_bf16 v[124:127], a[20:23], v[188:191], v[124:127]
  s_waitcnt vmcnt(16) lgkmcnt(4)
  s_barrier
  v_mfma_f32_16x16x32_bf16 v[64:67], a[24:27], v[192:195], v[64:67]
  ds_read_b128 v[160:163], v18 offset:0
  v_mfma_f32_16x16x32_bf16 v[68:71], a[28:31], v[192:195], v[68:71]
  s_cmp_lt_u32 m0, s46
  s_cselect_b32 m0, m0, s47
  v_mfma_f32_16x16x32_bf16 v[72:75], a[24:27], v[196:199], v[72:75]
  ds_read_b128 v[164:167], v18 offset:2048
  v_add_u32 v19, s33, v15
  v_mfma_f32_16x16x32_bf16 v[76:79], a[28:31], v[196:199], v[76:79]
  buffer_load_dwordx4 v10, s[8:11], s30 offen offset:0 lds
  v_mfma_f32_16x16x32_bf16 v[80:83], a[24:27], v[200:203], v[80:83]
  ds_read_b128 v[168:171], v18 offset:4096
  s_add_u32 s33, s33, 16384
  v_mfma_f32_16x16x32_bf16 v[84:87], a[28:31], v[200:203], v[84:87]
  s_cmp_lt_u32 s33, 114688
  s_cselect_b32 s33, s33, 0
  v_mfma_f32_16x16x32_bf16 v[88:91], a[24:27], v[204:207], v[88:91]
  ds_read_b128 v[172:175], v18 offset:6144
  v_mfma_f32_16x16x32_bf16 v[92:95], a[28:31], v[204:207], v[92:95]
  s_waitcnt lgkmcnt(4)
  v_mfma_f32_16x16x32_bf16 v[96:99], a[24:27], v[208:211], v[96:99]
  ds_read_b128 v[176:179], v18 offset:8192
  v_mfma_f32_16x16x32_bf16 v[100:103], a[28:31], v[208:211], v[100:103]
  v_mfma_f32_16x16x32_bf16 v[104:107], a[24:27], v[212:215], v[104:107]
  ds_read_b128 v[180:183], v18 offset:10240
  v_mfma_f32_16x16x32_bf16 v[108:111], a[28:31], v[212:215], v[108:111]
  buffer_load_dwordx4 v11, s[8:11], s30 offen offset:1024 lds
  v_mfma_f32_16x16x32_bf16 v[112:115], a[24:27], v[216:219], v[112:115]
  ds_read_b128 v[184:187], v18 offset:12288
  v_mfma_f32_16x16x32_bf16 v[116:119], a[28:31], v[216:219], v[116:119]
  v_mfma_f32_16x16x32_bf16 v[120:123], a[24:27], v[220:223], v[120:123]
  ds_read_b128 v[188:191], v18 offset:14336
  v_mfma_f32_16x16x32_bf16 v[124:127], a[28:31], v[220:223], v[124:127]
  s_waitcnt lgkmcnt(4)
  v_mfma_f32_16x16x32_bf16 v[64:67], a[32:35], v[160:163], v[64:67]
  ds_read_b128 v[192:195], v19 offset:0
  v_mfma_f32_16x16x32_bf16 v[68:71], a[36:39], v[160:163], v[68:71]
  v_add_u32 v18, s33, v14
  v_mfma_f32_16x16x32_bf16 v[72:75], a[32:35], v[164:167], v[72:75]
  ds_read_b128 v[196:199], v19 offset:2048
  v_mfma_f32_16x16x32_bf16 v[76:79], a[36:39], v[164:167], v[76:79]
  buffer_load_dwordx4 v12, s[8:11], s30 offen offset:2048 lds
  v_mfma_f32_16x16x32_bf16 v[80:83], a[32:35], v[168:171], v[80:83]
  ds_read_b128 v[200:203], v19 offset:4096
  v_mfma_f32_16x16x32_bf16 v[84:87], a[36:39], v[168:171], v[84:87]
  v_mfma_f32_16x16x32_bf16 v[88:91], a[32:35], v[172:175], v[88:91]
  ds_read_b128 v[204:207], v19 offset:6144
  v_mfma_f32_16x16x32_bf16 v[92:95], a[36:39], v[172:175], v[92:95]
  s_waitcnt lgkmcnt(4)
  v_mfma_f32_16x16x32_bf16 v[96:99], a[32:35], v[176:179], v[96:99]
  ds_read_b128 v[208:211], v19 offset:8192
  v_mfma_f32_16x16x32_bf16 v[100:103], a[36:39], v[176:179], v[100:103]
  v_mfma_f32_16x16x32_bf16 v[104:107], a[32:35], v[180:183], v[104:107]
  ds_read_b128 v[212:215], v19 offset:10240
  v_mfma_f32_16x16x32_bf16 v[108:111], a[36:39], v[180:183], v[108:111]
  buffer_load_dwordx4 v13, s[8:11], s30 offen offset:3072 lds
  v_mfma_f32_16x16x32_bf16 v[112:115], a[32:35], v[184:187], v[112:115]
  ds_read_b128 v[216:219], v19 offset:12288
  s_add_u32 s30, s30, 128
  v_mfma_f32_16x16x32_bf16 v[116:119], a[36:39], v[184:187], v[116:119]
  s_add_u32 m0, m0, 16384
  v_mfma_f32_16x16x32_bf16 v[120:123], a[32:35], v[188:191], v[120:123]
  ds_read_b128 v[220:223], v19 offset:14336
  v_mfma_f32_16x16x32_bf16 v[124:127], a[36:39], v[188:191], v[124:127]
  s_waitcnt vmcnt(16) lgkmcnt(4)
  s_barrier
  v_mfma_f32_16x16x32_bf16 v[64:67], a[40:43], v[192:195], v[64:67]
  ds_read_b128 v[160:163], v18 offset:0
  v_mfma_f32_16x16x32_bf16 v[68:71], a[44:47], v[192:195], v[68:71]
  s_cmp_lt_u32 m0, s46
  s_cselect_b32 m0, m0, s47
  v_mfma_f32_16x16x32_bf16 v[72:75], a[40:43], v[196:199], v[72:75]
  ds_read_b128 v[164:167], v18 offset:2048
  v_add_u32 v19, s33, v15
  v_mfma_f32_16x16x32_bf16 v[76:79], a[44:47], v[196:199], v[76:79]
  buffer_load_dwordx4 v10, s[8:11], s30 offen offset:0 lds
  v_mfma_f32_16x16x32_bf16 v[80:83], a[40:43], v[200:203], v[80:83]
  ds_read_b128 v[168:171], v18 offset:4096
  s_add_u32 s33, s33, 16384
  v_mfma_f32_16x16x32_bf16 v[84:87], a[44:47], v[200:203], v[84:87]
  s_cmp_lt_u32 s33, 114688
  s_cselect_b32 s33, s33, 0
  v_mfma_f32_16x16x32_bf16 v[88:91], a[40:43], v[204:207], v[88:91]
  ds_read_b128 v[172:175], v18 offset:6144
  v_mfma_f32_16x16x32_bf16 v[92:95], a[44:47], v[204:207], v[92:95]
  s_waitcnt lgkmcnt(4)
  v_mfma_f32_16x16x32_bf16 v[96:99], a[40:43], v[208:211], v[96:99]
  ds_read_b128 v[176:179], v18 offset:8192
  v_mfma_f32_16x16x32_bf16 v[100:103], a[44:47], v[208:211], v[100:103]
  v_mfma_f32_16x16x32_bf16 v[104:107], a[40:43], v[212:215], v[104:107]
  ds_read_b128 v[180:183], v18 offset:10240
  v_mfma_f32_16x16x32_bf16 v[108:111], a[44:47], v[212:215], v[108:111]
  buffer_load_dwordx4 v11, s[8:11], s30 offen offset:1024 lds
  v_mfma_f32_16x16x32_bf16 v[112:115], a[40:43], v[216:219], v[112:115]
  ds_read_b128 v[184:187], v18 offset:12288
  v_mfma_f32_16x16x32_bf16 v[116:119], a[44:47], v[216:219], v[116:119]
  v_mfma_f32_16x16x32_bf16 v[120:123], a[40:43], v[220:223], v[120:123]
  ds_read_b128 v[188:191], v18 offset:14336
  v_mfma_f32_16x16x32_bf16 v[124:127], a[44:47], v[220:223], v[124:127]
  s_waitcnt lgkmcnt(4)
  v_mfma_f32_16x16x32_bf16 v[64:67], a[48:51], v[160:163], v[64:67]
  ds_read_b128 v[192:195], v19 offset:0
  v_mfma_f32_16x16x32_bf16 v[68:71], a[52:55], v[160:163], v[68:71]
  v_add_u32 v18, s33, v14
  v_mfma_f32_16x16x32_bf16 v[72:75], a[48:51], v[164:167], v[72:75]
  ds_read_b128 v[196:199], v19 offset:2048
  v_mfma_f32_16x16x32_bf16 v[76:79], a[52:55], v[164:167], v[76:79]
  buffer_load_dwordx4 v12, s[8:11], s30 offen offset:2048 lds
  v_mfma_f32_16x16x32_bf16 v[80:83], a[48:51], v[168:171], v[80:83]
  ds_read_b128 v[200:203], v19 offset:4096
  v_mfma_f32_16x16x32_bf16 v[84:87], a[52:55], v[168:171], v[84:87]
  v_mfma_f32_16x16x32_bf16 v[88:91], a[48:51], v[172:175], v[88:91]
  ds_read_b128 v[204:207], v19 offset:6144
  v_mfma_f32_16x16x32_bf16 v[92:95], a[52:55], v[172:175], v[92:95]
  s_waitcnt lgkmcnt(4)
  v_mfma_f32_16x16x32_bf16 v[96:99], a[48:51], v[176:179], v[96:99]
  ds_read_b128 v[208:211], v19 offset:8192
  v_mfma_f32_16x16x32_bf16 v[100:103], a[52:55], v[176:179], v[100:103]
  v_mfma_f32_16x16x32_bf16 v[104:107], a[48:51], v[180:183], v[104:107]
  ds_read_b128 v[212:215], v19 offset:10240
  v_mfma_f32_16x16x32_bf16 v[108:111], a[52:55], v[180:183], v[108:111]
  buffer_load_dwordx4 v13, s[8:11], s30 offen offset:3072 lds
  v_mfma_f32_16x16x32_bf16 v[112:115], a[48:51], v[184:187], v[112:115]
  ds_read_b128 v[216:219], v19 offset:12288
  s_add_u32 s30, s30, 128
  v_mfma_f32_16x16x32_bf16 v[116:119], a[52:55], v[184:187], v[116:119]
  s_add_u32 m0, m0, 16384
  v_mfma_f32_16x16x32_bf16 v[120:123], a[48:51], v[188:191], v[120:123]
  ds_read_b128 v[220:223], v19 offset:14336
  v_mfma_f32_16x16x32_bf16 v[124:127], a[52:55], v[188:191], v[124:127]
  s_waitcnt vmcnt(16) lgkmcnt(4)
  s_barrier
  v_mfma_f32_16x16x32_bf16 v[64:67], a[56:59], v[192:195], v[64:67]
  ds_read_b128 v[160:163], v18 offset:0
  v_mfma_f32_16x16x32_bf16 v[68:71], a[60:63], v[192:195], v[68:71]
  s_cmp_lt_u32 m0, s46
  s_cselect_b32 m0, m0, s47
  v_mfma_f32_16x16x32_bf16 v[72:75], a[56:59], v[196:199], v[72:75]
  ds_read_b128 v[164:167], v18 offset:2048
  v_add_u32 v19, s33, v15
  v_mfma_f32_16x16x32_bf16 v[76:79], a[60:63], v[196:199], v[76:79]
  buffer_load_dwordx4 v10, s[8:11], s30 offen offset:0 lds
  v_mfma_f32_16x16x32_bf16 v[80:83], a[56:59], v[200:203], v[80:83]
  ds_read_b128 v[168:171], v18 offset:4096
  s_add_u32 s33, s33, 16384
  v_mfma_f32_16x16x32_bf16 v[84:87], a[60:63], v[200:203], v[84:87]
  s_cmp_lt_u32 s33, 114688
  s_cselect_b32 s33, s33, 0
  v_mfma_f32_16x16x32_bf16 v[88:91], a[56:59], v[204:207], v[88:91]
  ds_read_b128 v[172:175], v18 offset:6144
  v_mfma_f32_16x16x32_bf16 v[92:95], a[60:63], v[204:207], v[92:95]
  s_waitcnt lgkmcnt(4)
  v_mfma_f32_16x16x32_bf16 v[96:99], a[56:59], v[208:211], v[96:99]
  ds_read_b128 v[176:179], v18 offset:8192
  v_mfma_f32_16x16x32_bf16 v[100:103], a[60:63], v[208:211], v[100:103]
  v_mfma_f32_16x16x32_bf16 v[104:107], a[56:59], v[212:215], v[104:107]
  ds_read_b128 v[180:183], v18 offset:10240
  v_mfma_f32_16x16x32_bf16 v[108:111], a[60:63], v[212:215], v[108:111]
  buffer_load_dwordx4 v11, s[8:11], s30 offen offset:1024 lds
  v_mfma_f32_16x16x32_bf16 v[112:115], a[56:59], v[216:219], v[112:115]
  ds_read_b128 v[184:187], v18 offset:12288
  v_mfma_f32_16x16x32_bf16 v[116:119], a[60:63], v[216:219], v[116:119]
  v_mfma_f32_16x16x32_bf16 v[120:123], a[56:59], v[220:223], v[120:123]
  ds_read_b128 v[188:191], v18 offset:14336
  v_mfma_f32_16x16x32_bf16 v[124:127], a[60:63], v[220:223], v[124:127]
  s_waitcnt lgkmcnt(4)
  v_mfma_f32_16x16x32_bf16 v[64:67], a[64:67], v[160:163], v[64:67]
  ds_read_b128 v[192:195], v19 offset:0
  v_mfma_f32_16x16x32_bf16 v[68:71], a[68:71], v[160:163], v[68:71]
  v_add_u32 v18, s33, v14
  v_mfma_f32_16x16x32_bf16 v[72:75], a[64:67], v[164:167], v[72:75]
  ds_read_b128 v[196:199], v19 offset:2048
  v_mfma_f32_16x16x32_bf16 v[76:79], a[68:71], v[164:167], v[76:79]
  buffer_load_dwordx4 v12, s[8:11], s30 offen offset:2048 lds
  v_mfma_f32_16x16x32_bf16 v[80:83], a[64:67], v[168:171], v[80:83]
  ds_read_b128 v[200:203], v19 offset:4096
  v_mfma_f32_16x16x32_bf16 v[84:87], a[68:71], v[168:171], v[84:87]
  v_mfma_f32_16x16x32_bf16 v[88:91], a[64:67], v[172:175], v[88:91]
  ds_read_b128 v[204:207], v19 offset:6144
  v_mfma_f32_16x16x32_bf16 v[92:95], a[68:71], v[172:175], v[92:95]
  s_waitcnt lgkmcnt(4)
  v_mfma_f32_16x16x32_bf16 v[96:99], a[64:67], v[176:179], v[96:99]
  ds_read_b128 v[208:211], v19 offset:8192
  v_mfma_f32_16x16x32_bf16 v[100:103], a[68:71], v[176:179], v[100:103]
  v_mfma_f32_16x16x32_bf16 v[104:107], a[64:67], v[180:183], v[104:107]
  ds_read_b128 v[212:215], v19 offset:10240
  v_mfma_f32_16x16x32_bf16 v[108:111], a[68:71], v[180:183], v[108:111]
  buffer_load_dwordx4 v13, s[8:11], s30 offen offset:3072 lds
  v_mfma_f32_16x16x32_bf16 v[112:115], a[64:67], v[184:187], v[112:115]
  ds_read_b128 v[216:219], v19 offset:12288
  s_add_u32 s30, s30, s25
  v_mfma_f32_16x16x32_bf16 v[116:119], a[68:71], v[184:187], v[116:119]
  s_sub_u32 s30, s30, 1152
  s_add_u32 m0, m0, 16384
  v_mfma_f32_16x16x32_bf16 v[120:123], a[64:67], v[188:191], v[120:123]
  ds_read_b128 v[220:223], v19 offset:14336
  v_mfma_f32_16x16x32_bf16 v[124:127], a[68:71], v[188:191], v[124:127]
  s_waitcnt vmcnt(16) lgkmcnt(4)
  s_barrier
  v_mfma_f32_16x16x32_bf16 v[64:67], a[72:75], v[192:195], v[64:67]
  ds_read_b128 v[160:163], v18 offset:0
  v_mfma_f32_16x16x32_bf16 v[68:71], a[76:79], v[192:195], v[68:71]
  s_cmp_lt_u32 m0, s46
  s_cselect_b32 m0, m0, s47
  v_mfma_f32_16x16x32_bf16 v[72:75], a[72:75], v[196:199], v[72:75]
  ds_read_b128 v[164:167], v18 offset:2048
  v_add_u32 v19, s33, v15
  v_mfma_f32_16x16x32_bf16 v[76:79], a[76:79], v[196:199], v[76:79]
  buffer_load_dwordx4 v10, s[8:11], s30 offen offset:0 lds
  v_mfma_f32_16x16x32_bf16 v[80:83], a[72:75], v[200:203], v[80:83]
  ds_read_b128 v[168:171], v18 offset:4096
  s_add_u32 s33, s33, 16384
  v_mfma_f32_16x16x32_bf16 v[84:87], a[76:79], v[200:203], v[84:87]
  s_cmp_lt_u32 s33, 114688
  s_cselect_b32 s33, s33, 0
  v_mfma_f32_16x16x32_bf16 v[88:91], a[72:75], v[204:207], v[88:91]
  ds_read_b128 v[172:175], v18 offset:6144
  v_mfma_f32_16x16x32_bf16 v[92:95], a[76:79], v[204:207], v[92:95]
  s_waitcnt lgkmcnt(4)
  v_mfma_f32_16x16x32_bf16 v[96:99], a[72:75], v[208:211], v[96:99]
  ds_read_b128 v[176:179], v18 offset:8192
  v_mfma_f32_16x16x32_bf16 v[100:103], a[76:79], v[208:211], v[100:103]
  v_mfma_f32_16x16x32_bf16 v[104:107], a[72:75], v[212:215], v[104:107]
  ds_read_b128 v[180:183], v18 offset:10240
  v_mfma_f32_16x16x32_bf16 v[108:111], a[76:79], v[212:215], v[108:111]
  buffer_load_dwordx4 v11, s[8:11], s30 offen offset:1024 lds
  v_mfma_f32_16x16x32_bf16 v[112:115], a[72:75], v[216:219], v[112:115]
  ds_read_b128 v[184:187], v18 offset:12288
  v_mfma_f32_16x16x32_bf16 v[116:119], a[76:79], v[216:219], v[116:119]
  v_mfma_f32_16x16x32_bf16 v[120:123], a[72:75], v[220:223], v[120:123]
  ds_read_b128 v[188:191], v18 offset:14336
  v_mfma_f32_16x16x32_bf16 v[124:127], a[76:79], v[220:223], v[124:127]
  s_waitcnt lgkmcnt(4)
  v_mfma_f32_16x16x32_bf16 v[64:67], a[80:83], v[160:163], v[64:67]
  ds_read_b128 v[192:195], v19 offset:0
  v_mfma_f32_16x16x32_bf16 v[68:71], a[84:87], v[160:163], v[68:71]
  v_add_u32 v18, s33, v14
  v_mfma_f32_16x16x32_bf16 v[72:75], a[80:83], v[164:167], v[72:75]
  ds_read_b128 v[196:199], v19 offset:2048
  v_mfma_f32_16x16x32_bf16 v[76:79], a[84:87], v[164:167], v[76:79]
  buffer_load_dwordx4 v12, s[8:11], s30 offen offset:2048 lds
  v_mfma_f32_16x16x32_bf16 v[80:83], a[80:83], v[168:171], v[80:83]
  ds_read_b128 v[200:203], v19 offset:4096
  v_mfma_f32_16x16x32_bf16 v[84:87], a[84:87], v[168:171], v[84:87]
  v_mfma_f32_16x16x32_bf16 v[88:91], a[80:83], v[172:175], v[88:91]
  ds_read_b128 v[204:207], v19 offset:6144
  v_mfma_f32_16x16x32_bf16 v[92:95], a[84:87], v[172:175], v[92:95]
  s_waitcnt lgkmcnt(4)
  v_mfma_f32_16x16x32_bf16 v[96:99], a[80:83], v[176:179], v[96:99]
  ds_read_b128 v[208:211], v19 offset:8192
  v_mfma_f32_16x16x32_bf16 v[100:103], a[84:87], v[176:179], v[100:103]
  v_mfma_f32_16x16x32_bf16 v[104:107], a[80:83], v[180:183], v[104:107]
  ds_read_b128 v[212:215], v19 offset:10240
  v_mfma_f32_16x16x32_bf16 v[108:111], a[84:87], v[180:183], v[108:111]
  buffer_load_dwordx4 v13, s[8:11], s30 offen offset:3072 lds
  v_mfma_f32_16x16x32_bf16 v[112:115], a[80:83], v[184:187], v[112:115]
  ds_read_b128 v[216:219], v19 offset:12288
  s_add_u32 s30, s30, 128
  v_mfma_f32_16x16x32_bf16 v[116:119], a[84:87], v[184:187], v[116:119]
  s_add_u32 m0, m0, 16384
  v_mfma_f32_16x16x32_bf16 v[120:123], a[80:83], v[188:191], v[120:123]
  ds_read_b128 v[220:223], v19 offset:14336
  v_mfma_f32_16x16x32_bf16 v[124:127], a[84:87], v[188:191], v[124:127]
  s_waitcnt vmcnt(16) lgkmcnt(4)
  s_barrier
  v_mfma_f32_16x16x32_bf16 v[64:67], a[88:91], v[192:195], v[64:67]
  ds_read_b128 v[160:163], v18 offset:0
  v_mfma_f32_16x16x32_bf16 v[68:71], a[92:95], v[192:195], v[68:71]
  s_cmp_lt_u32 m0, s46
  s_cselect_b32 m0, m0, s47
  v_mfma_f32_16x16x32_bf16 v[72:75], a[88:91], v[196:199], v[72:75]
  ds_read_b128 v[164:167], v18 offset:2048
  v_add_u32 v19, s33, v15
  v_mfma_f32_16x16x32_bf16 v[76:79], a[92:95], v[196:199], v[76:79]
  buffer_load_dwordx4 v10, s[8:11], s30 offen offset:0 lds
  v_mfma_f32_16x16x32_bf16 v[80:83], a[88:91], v[200:203], v[80:83]
  ds_read_b128 v[168:171], v18 offset:4096
  s_add_u32 s33, s33, 16384
  v_mfma_f32_16x16x32_bf16 v[84:87], a[92:95], v[200:203], v[84:87]
  s_cmp_lt_u32 s33, 114688
  s_cselect_b32 s33, s33, 0
  v_mfma_f32_16x16x32_bf16 v[88:91], a[88:91], v[204:207], v[88:91]
  ds_read_b128 v[172:175], v18 offset:6144
  v_mfma_f32_16x16x32_bf16 v[92:95], a[92:95], v[204:207], v[92:95]
  s_waitcnt lgkmcnt(4)
  v_mfma_f32_16x16x32_bf16 v[96:99], a[88:91], v[208:211], v[96:99]
  ds_read_b128 v[176:179], v18 offset:8192
  v_mfma_f32_16x16x32_bf16 v[100:103], a[92:95], v[208:211], v[100:103]
  v_mfma_f32_16x16x32_bf16 v[104:107], a[88:91], v[212:215], v[104:107]
  ds_read_b128 v[180:183], v18 offset:10240
  v_mfma_f32_16x16x32_bf16 v[108:111], a[92:95], v[212:215], v[108:111]
  buffer_load_dwordx4 v11, s[8:11], s30 offen offset:1024 lds
  v_mfma_f32_16x16x32_bf16 v[112:115], a[88:91], v[216:219], v[112:115]
  ds_read_b128 v[184:187], v18 offset:12288
  v_mfma_f32_16x16x32_bf16 v[116:119], a[92:95], v[216:219], v[116:119]
  v_mfma_f32_16x16x32_bf16 v[120:123], a[88:91], v[220:223], v[120:123]
  ds_read_b128 v[188:191], v18 offset:14336
  v_mfma_f32_16x16x32_bf16 v[124:127], a[92:95], v[220:223], v[124:127]
  s_waitcnt lgkmcnt(4)
  v_mfma_f32_16x16x32_bf16 v[64:67], a[96:99], v[160:163], v[64:67]
  ds_read_b128 v[192:195], v19 offset:0
  v_mfma_f32_16x16x32_bf16 v[68:71], a[100:103], v[160:163], v[68:71]
  v_add_u32 v18, s33, v14
  v_mfma_f32_16x16x32_bf16 v[72:75], a[96:99], v[164:167], v[72:75]
  ds_read_b128 v[196:199], v19 offset:2048
  v_mfma_f32_16x16x32_bf16 v[76:79], a[100:103], v[164:167], v[76:79]
  buffer_load_dwordx4 v12, s[8:11], s30 offen offset:2048 lds
  v_mfma_f32_16x16x32_bf16 v[80:83], a[96:99], v[168:171], v[80:83]
  ds_read_b128 v[200:203], v19 offset:4096
  v_mfma_f32_16x16x32_bf16 v[84:87], a[100:103], v[168:171], v[84:87]
  v_mfma_f32_16x16x32_bf16 v[88:91], a[96:99], v[172:175], v[88:91]
  ds_read_b128 v[204:207], v19 offset:6144
  v_mfma_f32_16x16x32_bf16 v[92:95], a[100:103], v[172:175], v[92:95]
  s_waitcnt lgkmcnt(4)
  v_mfma_f32_16x16x32_bf16 v[96:99], a[96:99], v[176:179], v[96:99]
  ds_read_b128 v[208:211], v19 offset:8192
  v_mfma_f32_16x16x32_bf16 v[100:103], a[100:103], v[176:179], v[100:103]
  v_mfma_f32_16x16x32_bf16 v[104:107], a[96:99], v[180:183], v[104:107]
  ds_read_b128 v[212:215], v19 offset:10240
  v_mfma_f32_16x16x32_bf16 v[108:111], a[100:103], v[180:183], v[108:111]
  buffer_load_dwordx4 v13, s[8:11], s30 offen offset:3072 lds
  v_mfma_f32_16x16x32_bf16 v[112:115], a[96:99], v[184:187], v[112:115]
  ds_read_b128 v[216:219], v19 offset:12288
  s_add_u32 s30, s30, 128
  v_mfma_f32_16x16x32_bf16 v[116:119], a[100:103], v[184:187], v[116:119]
  s_add_u32 m0, m0, 16384
  v_mfma_f32_16x16x32_bf16 v[120:123], a[96:99], v[188:191], v[120:123]
  ds_read_b128 v[220:223], v19 offset:14336
  v_mfma_f32_16x16x32_bf16 v[124:127], a[100:103], v[188:191], v[124:127]
  s_waitcnt vmcnt(16) lgkmcnt(4)
  s_barrier
  v_mfma_f32_16x16x32_bf16 v[64:67], a[104:107], v[192:195], v[64:67]
  ds_read_b128 v[160:163], v18 offset:0
  v_mfma_f32_16x16x32_bf16 v[68:71], a[108:111], v[192:195], v[68:71]
  s_cmp_lt_u32 m0, s46
  s_cselect_b32 m0, m0, s47
  v_mfma_f32_16x16x32_bf16 v[72:75], a[104:107], v[196:199], v[72:75]
  ds_read_b128 v[164:167], v18 offset:2048
  v_add_u32 v19, s33, v15
  v_mfma_f32_16x16x32_bf16 v[76:79], a[108:111], v[196:199], v[76:79]
  buffer_load_dwordx4 v10, s[8:11], s30 offen offset:0 lds
  v_mfma_f32_16x16x32_bf16 v[80:83], a[104:107], v[200:203], v[80:83]
  ds_read_b128 v[168:171], v18 offset:4096
  s_add_u32 s33, s33, 16384
  v_mfma_f32_16x16x32_bf16 v[84:87], a[108:111], v[200:203], v[84:87]
  s_cmp_lt_u32 s33, 114688
  s_cselect_b32 s33, s33, 0
  v_mfma_f32_16x16x32_bf16 v[88:91], a[104:107], v[204:207], v[88:91]
  ds_read_b128 v[172:175], v18 offset:6144
  v_mfma_f32_16x16x32_bf16 v[92:95], a[108:111], v[204:207], v[92:95]
  s_waitcnt lgkmcnt(4)
  v_mfma_f32_16x16x32_bf16 v[96:99], a[104:107], v[208:211], v[96:99]
  ds_read_b128 v[176:179], v18 offset:8192
  v_mfma_f32_16x16x32_bf16 v[100:103], a[108:111], v[208:211], v[100:103]
  v_mfma_f32_16x16x32_bf16 v[104:107], a[104:107], v[212:215], v[104:107]
  ds_read_b128 v[180:183], v18 offset:10240
  v_mfma_f32_16x16x32_bf16 v[108:111], a[108:111], v[212:215], v[108:111]
  buffer_load_dwordx4 v11, s[8:11], s30 offen offset:1024 lds
  v_mfma_f32_16x16x32_bf16 v[112:115], a[104:107], v[216:219], v[112:115]
  ds_read_b128 v[184:187], v18 offset:12288
  v_mfma_f32_16x16x32_bf16 v[116:119], a[108:111], v[216:219], v[116:119]
  v_mfma_f32_16x16x32_bf16 v[120:123], a[104:107], v[220:223], v[120:123]
  ds_read_b128 v[188:191], v18 offset:14336
  v_mfma_f32_16x16x32_bf16 v[124:127], a[108:111], v[220:223], v[124:127]
  s_waitcnt lgkmcnt(4)
  v_mfma_f32_16x16x32_bf16 v[64:67], a[112:115], v[160:163], v[64:67]
  ds_read_b128 v[192:195], v19 offset:0
  v_mfma_f32_16x16x32_bf16 v[68:71], a[116:119], v[160:163], v[68:71]
  v_add_u32 v18, s33, v14
  v_mfma_f32_16x16x32_bf16 v[72:75], a[112:115], v[164:167], v[72:75]
  ds_read_b128 v[196:199], v19 offset:2048
  v_mfma_f32_16x16x32_bf16 v[76:79], a[116:119], v[164:167], v[76:79]
  buffer_load_dwordx4 v12, s[8:11], s30 offen offset:2048 lds
  v_mfma_f32_16x16x32_bf16 v[80:83], a[112:115], v[168:171], v[80:83]
  ds_read_b128 v[200:203], v19 offset:4096
  v_mfma_f32_16x16x32_bf16 v[84:87], a[116:119], v[168:171], v[84:87]
  v_mfma_f32_16x16x32_bf16 v[88:91], a[112:115], v[172:175], v[88:91]
  ds_read_b128 v[204:207], v19 offset:6144
  v_mfma_f32_16x16x32_bf16 v[92:95], a[116:119], v[172:175], v[92:95]
  s_waitcnt lgkmcnt(4)
  v_mfma_f32_16x16x32_bf16 v[96:99], a[112:115], v[176:179], v[96:99]
  ds_read_b128 v[208:211], v19 offset:8192
  v_mfma_f32_16x16x32_bf16 v[100:103], a[116:119], v[176:179], v[100:103]
  v_mfma_f32_16x16x32_bf16 v[104:107], a[112:115], v[180:183], v[104:107]
  ds_read_b128 v[212:215], v19 offset:10240
  v_mfma_f32_16x16x32_bf16 v[108:111], a[116:119], v[180:183], v[108:111]
  buffer_load_dwordx4 v13, s[8:11], s30 offen offset:3072 lds
  v_mfma_f32_16x16x32_bf16 v[112:115], a[112:115], v[184:187], v[112:115]
  ds_read_b128 v[216:219], v19 offset:12288
  s_add_u32 s30, s30, 128
  v_mfma_f32_16x16x32_bf16 v[116:119], a[116:119], v[184:187], v[116:119]
  s_add_u32 m0, m0, 16384
  v_mfma_f32_16x16x32_bf16 v[120:123], a[112:115], v[188:191], v[120:123]
  ds_read_b128 v[220:223], v19 offset:14336
  v_mfma_f32_16x16x32_bf16 v[124:127], a[116:119], v[188:191], v[124:127]
  s_waitcnt vmcnt(16) lgkmcnt(4)
  s_barrier
  v_mfma_f32_16x16x32_bf16 v[64:67], a[120:123], v[192:195], v[64:67]
  ds_read_b128 v[160:163], v18 offset:0
  v_mfma_f32_16x16x32_bf16 v[68:71], a[124:127], v[192:195], v[68:71]
  s_cmp_lt_u32 m0, s46
  s_cselect_b32 m0, m0, s47
  v_mfma_f32_16x16x32_bf16 v[72:75], a[120:123], v[196:199], v[72:75]
  ds_read_b128 v[164:167], v18 offset:2048
  v_add_u32 v19, s33, v15
  v_mfma_f32_16x16x32_bf16 v[76:79], a[124:127], v[196:199], v[76:79]
  buffer_load_dwordx4 v10, s[8:11], s30 offen offset:0 lds
  v_mfma_f32_16x16x32_bf16 v[80:83], a[120:123], v[200:203], v[80:83]
  ds_read_b128 v[168:171], v18 offset:4096
  s_add_u32 s33, s33, 16384
  v_mfma_f32_16x16x32_bf16 v[84:87], a[124:127], v[200:203], v[84:87]
  s_cmp_lt_u32 s33, 114688
  s_cselect_b32 s33, s33, 0
  v_mfma_f32_16x16x32_bf16 v[88:91], a[120:123], v[204:207], v[88:91]
  ds_read_b128 v[172:175], v18 offset:6144
  v_mfma_f32_16x16x32_bf16 v[92:95], a[124:127], v[204:207], v[92:95]
  s_waitcnt lgkmcnt(4)
  v_mfma_f32_16x16x32_bf16 v[96:99], a[120:123], v[208:211], v[96:99]
  ds_read_b128 v[176:179], v18 offset:8192
  v_mfma_f32_16x16x32_bf16 v[100:103], a[124:127], v[208:211], v[100:103]
  v_mfma_f32_16x16x32_bf16 v[104:107], a[120:123], v[212:215], v[104:107]
  ds_read_b128 v[180:183], v18 offset:10240
  v_mfma_f32_16x16x32_bf16 v[108:111], a[124:127], v[212:215], v[108:111]
  buffer_load_dwordx4 v11, s[8:11], s30 offen offset:1024 lds
  v_mfma_f32_16x16x32_bf16 v[112:115], a[120:123], v[216:219], v[112:115]
  ds_read_b128 v[184:187], v18 offset:12288
  v_mfma_f32_16x16x32_bf16 v[116:119], a[124:127], v[216:219], v[116:119]
  v_mfma_f32_16x16x32_bf16 v[120:123], a[120:123], v[220:223], v[120:123]
  ds_read_b128 v[188:191], v18 offset:14336
  v_mfma_f32_16x16x32_bf16 v[124:127], a[124:127], v[220:223], v[124:127]
  s_waitcnt lgkmcnt(4)
  v_mfma_f32_16x16x32_bf16 v[64:67], a[128:131], v[160:163], v[64:67]
  ds_read_b128 v[192:195], v19 offset:0
  v_mfma_f32_16x16x32_bf16 v[68:71], a[132:135], v[160:163], v[68:71]
  v_add_u32 v18, s33, v14
  v_mfma_f32_16x16x32_bf16 v[72:75], a[128:131], v[164:167], v[72:75]
  ds_read_b128 v[196:199], v19 offset:2048
  v_mfma_f32_16x16x32_bf16 v[76:79], a[132:135], v[164:167], v[76:79]
  buffer_load_dwordx4 v12, s[8:11], s30 offen offset:2048 lds
  v_mfma_f32_16x16x32_bf16 v[80:83], a[128:131], v[168:171], v[80:83]
  ds_read_b128 v[200:203], v19 offset:4096
  v_mfma_f32_16x16x32_bf16 v[84:87], a[132:135], v[168:171], v[84:87]
  v_mfma_f32_16x16x32_bf16 v[88:91], a[128:131], v[172:175], v[88:91]
  ds_read_b128 v[204:207], v19 offset:6144
  v_mfma_f32_16x16x32_bf16 v[92:95], a[132:135], v[172:175], v[92:95]
  s_waitcnt lgkmcnt(4)
  v_mfma_f32_16x16x32_bf16 v[96:99], a[128:131], v[176:179], v[96:99]
  ds_read_b128 v[208:211], v19 offset:8192
  v_mfma_f32_16x16x32_bf16 v[100:103], a[132:135], v[176:179], v[100:103]
  v_mfma_f32_16x16x32_bf16 v[104:107], a[128:131], v[180:183], v[104:107]
  ds_read_b128 v[212:215], v19 offset:10240
  v_mfma_f32_16x16x32_bf16 v[108:111], a[132:135], v[180:183], v[108:111]
  buffer_load_dwordx4 v13, s[8:11], s30 offen offset:3072 lds
  v_mfma_f32_16x16x32_bf16 v[112:115], a[128:131], v[184:187], v[112:115]
  ds_read_b128 v[216:219], v19 offset:12288
  s_add_u32 s30, s30, 128
  v_mfma_f32_16x16x32_bf16 v[116:119], a[132:135], v[184:187], v[116:119]
  s_add_u32 m0, m0, 16384
  v_mfma_f32_16x16x32_bf16 v[120:123], a[128:131], v[188:191], v[120:123]
  ds_read_b128 v[220:223], v19 offset:14336
  v_mfma_f32_16x16x32_bf16 v[124:127], a[132:135], v[188:191], v[124:127]
  s_waitcnt vmcnt(16) lgkmcnt(4)
  s_barrier
  v_mfma_f32_16x16x32_bf16 v[64:67], a[136:139], v[192:195], v[64:67]
  ds_read_b128 v[160:163], v18 offset:0
  v_mfma_f32_16x16x32_bf16 v[68:71], a[140:143], v[192:195], v[68:71]
  s_cmp_lt_u32 m0, s46
  s_cselect_b32 m0, m0, s47
  v_mfma_f32_16x16x32_bf16 v[72:75], a[136:139], v[196:199], v[72:75]
  ds_read_b128 v[164:167], v18 offset:2048
  v_add_u32 v19, s33, v15
  v_mfma_f32_16x16x32_bf16 v[76:79], a[140:143], v[196:199], v[76:79]
  buffer_load_dwordx4 v10, s[8:11], s30 offen offset:0 lds
  v_mfma_f32_16x16x32_bf16 v[80:83], a[136:139], v[200:203], v[80:83]
  ds_read_b128 v[168:171], v18 offset:4096
  s_add_u32 s33, s33, 16384
  v_mfma_f32_16x16x32_bf16 v[84:87], a[140:143], v[200:203], v[84:87]
  s_cmp_lt_u32 s33, 114688
  s_cselect_b32 s33, s33, 0
  v_mfma_f32_16x16x32_bf16 v[88:91], a[136:139], v[204:207], v[88:91]
  ds_read_b128 v[172:175], v18 offset:6144
  v_mfma_f32_16x16x32_bf16 v[92:95], a[140:143], v[204:207], v[92:95]
  s_waitcnt lgkmcnt(4)
  v_mfma_f32_16x16x32_bf16 v[96:99], a[136:139], v[208:211], v[96:99]
  ds_read_b128 v[176:179], v18 offset:8192
  v_mfma_f32_16x16x32_bf16 v[100:103], a[140:143], v[208:211], v[100:103]
  v_mfma_f32_16x16x32_bf16 v[104:107], a[136:139], v[212:215], v[104:107]
  ds_read_b128 v[180:183], v18 offset:10240
  v_mfma_f32_16x16x32_bf16 v[108:111], a[140:143], v[212:215], v[108:111]
  buffer_load_dwordx4 v11, s[8:11], s30 offen offset:1024 lds
  v_mfma_f32_16x16x32_bf16 v[112:115], a[136:139], v[216:219], v[112:115]
  ds_read_b128 v[184:187], v18 offset:12288
  v_mfma_f32_16x16x32_bf16 v[116:119], a[140:143], v[216:219], v[116:119]
  v_mfma_f32_16x16x32_bf16 v[120:123], a[136:139], v[220:223], v[120:123]
  ds_read_b128 v[188:191], v18 offset:14336
  v_mfma_f32_16x16x32_bf16 v[124:127], a[140:143], v[220:223], v[124:127]
  s_waitcnt lgkmcnt(4)
  v_mfma_f32_16x16x32_bf16 v[64:67], a[144:147], v[160:163], v[64:67]
  ds_read_b128 v[192:195], v19 offset:0
  v_mfma_f32_16x16x32_bf16 v[68:71], a[148:151], v[160:163], v[68:71]
  v_add_u32 v18, s33, v14
  v_mfma_f32_16x16x32_bf16 v[72:75], a[144:147], v[164:167], v[72:75]
  ds_read_b128 v[196:199], v19 offset:2048
  v_mfma_f32_16x16x32_bf16 v[76:79], a[148:151], v[164:167], v[76:79]
  buffer_load_dwordx4 v12, s[8:11], s30 offen offset:2048 lds
  v_mfma_f32_16x16x32_bf16 v[80:83], a[144:147], v[168:171], v[80:83]
  ds_read_b128 v[200:203], v19 offset:4096
  v_mfma_f32_16x16x32_bf16 v[84:87], a[148:151], v[168:171], v[84:87]
  v_mfma_f32_16x16x32_bf16 v[88:91], a[144:147], v[172:175], v[88:91]
  ds_read_b128 v[204:207], v19 offset:6144
  v_mfma_f32_16x16x32_bf16 v[92:95], a[148:151], v[172:175], v[92:95]
  s_waitcnt lgkmcnt(4)
  v_mfma_f32_16x16x32_bf16 v[96:99], a[144:147], v[176:179], v[96:99]
  ds_read_b128 v[208:211], v19 offset:8192
  v_mfma_f32_16x16x32_bf16 v[100:103], a[148:151], v[176:179], v[100:103]
  v_mfma_f32_16x16x32_bf16 v[104:107], a[144:147], v[180:183], v[104:107]
  ds_read_b128 v[212:215], v19 offset:10240
  v_mfma_f32_16x16x32_bf16 v[108:111], a[148:151], v[180:183], v[108:111]
  buffer_load_dwordx4 v13, s[8:11], s30 offen offset:3072 lds
  v_mfma_f32_16x16x32_bf16 v[112:115], a[144:147], v[184:187], v[112:115]
  ds_read_b128 v[216:219], v19 offset:12288
  s_add_u32 s30, s30, 128
  v_mfma_f32_16x16x32_bf16 v[116:119], a[148:151], v[184:187], v[116:119]
  s_add_u32 m0, m0, 16384
  v_mfma_f32_16x16x32_bf16 v[120:123], a[144:147], v[188:191], v[120:123]
  ds_read_b128 v[220:223], v19 offset:14336
  v_mfma_f32_16x16x32_bf16 v[124:127], a[148:151], v[188:191], v[124:127]
  s_waitcnt vmcnt(16) lgkmcnt(4)
  s_barrier
  v_mfma_f32_16x16x32_bf16 v[64:67], a[152:155], v[192:195], v[64:67]
  ds_read_b128 v[160:163], v18 offset:0
  v_mfma_f32_16x16x32_bf16 v[68:71], a[156:159], v[192:195], v[68:71]
  s_cmp_lt_u32 m0, s46
  s_cselect_b32 m0, m0, s47
  v_mfma_f32_16x16x32_bf16 v[72:75], a[152:155], v[196:199], v[72:75]
  ds_read_b128 v[164:167], v18 offset:2048
  v_add_u32 v19, s33, v15
  v_mfma_f32_16x16x32_bf16 v[76:79], a[156:159], v[196:199], v[76:79]
  buffer_load_dwordx4 v10, s[8:11], s30 offen offset:0 lds
  v_cvt_pk_bf16_f32 v224, v64, v65
  v_cvt_pk_bf16_f32 v225, v66, v67
  v_mfma_f32_16x16x32_bf16 v[80:83], a[152:155], v[200:203], v[80:83]
  ds_read_b128 v[168:171], v18 offset:4096
  s_add_u32 s33, s33, 16384
  v_cvt_pk_bf16_f32 v226, v68, v69
  v_cvt_pk_bf16_f32 v227, v70, v71
  v_mfma_f32_16x16x32_bf16 v[84:87], a[156:159], v[200:203], v[84:87]
  s_cmp_lt_u32 s33, 114688
  s_cselect_b32 s33, s33, 0
  ds_write_b64 v22, v[224:225] offset:0
  v_mfma_f32_16x16x32_bf16 v[88:91], a[152:155], v[204:207], v[88:91]
  ds_read_b128 v[172:175], v18 offset:6144
  ds_write_b64 v22, v[226:227] offset:32
  v_cvt_pk_bf16_f32 v230, v72, v73
  v_mfma_f32_16x16x32_bf16 v[92:95], a[156:159], v[204:207], v[92:95]
  s_waitcnt lgkmcnt(6)
  v_cvt_pk_bf16_f32 v231, v74, v75
  v_cvt_pk_bf16_f32 v232, v76, v77
  v_cvt_pk_bf16_f32 v233, v78, v79
  v_mfma_f32_16x16x32_bf16 v[96:99], a[152:155], v[208:211], v[96:99]
  ds_read_b128 v[176:179], v18 offset:8192
  ds_write_b64 v22, v[230:231] offset:4224
  v_mfma_f32_16x16x32_bf16 v[100:103], a[156:159], v[208:211], v[100:103]
  ds_write_b64 v22, v[232:233] offset:4256
  v_cvt_pk_bf16_f32 v224, v80, v81
  v_cvt_pk_bf16_f32 v225, v82, v83
  v_mfma_f32_16x16x32_bf16 v[104:107], a[152:155], v[212:215], v[104:107]
  ds_read_b128 v[180:183], v18 offset:10240
  v_cvt_pk_bf16_f32 v226, v84, v85
  v_cvt_pk_bf16_f32 v227, v86, v87
  v_mfma_f32_16x16x32_bf16 v[108:111], a[156:159], v[212:215], v[108:111]
  buffer_load_dwordx4 v11, s[8:11], s30 offen offset:1024 lds
  ds_write_b64 v22, v[224:225] offset:8448
  v_mfma_f32_16x16x32_bf16 v[112:115], a[152:155], v[216:219], v[112:115]
  ds_read_b128 v[184:187], v18 offset:12288
  ds_write_b64 v22, v[226:227] offset:8480
  v_cvt_pk_bf16_f32 v230, v88, v89
  v_mfma_f32_16x16x32_bf16 v[116:119], a[156:159], v[216:219], v[116:119]
  v_cvt_pk_bf16_f32 v231, v90, v91
  v_cvt_pk_bf16_f32 v232, v92, v93
  v_cvt_pk_bf16_f32 v233, v94, v95
  v_mfma_f32_16x16x32_bf16 v[120:123], a[152:155], v[220:223], v[120:123]
  ds_read_b128 v[188:191], v18 offset:14336
  ds_write_b64 v22, v[230:231] offset:12672
  v_mfma_f32_16x16x32_bf16 v[124:127], a[156:159], v[220:223], v[124:127]
  ds_write_b64 v22, v[232:233] offset:12704
  v_cvt_pk_bf16_f32 v224, v96, v97
  v_cvt_pk_bf16_f32 v225, v98, v99
bf_end_207:
  v_cvt_pk_bf16_f32 v226, v100, v101
  v_cvt_pk_bf16_f32 v227, v102, v103
  ds_write_b64 v22, v[224:225] offset:16896
  ds_write_b64 v22, v[226:227] offset:16928
  v_cvt_pk_bf16_f32 v230, v104, v105
  v_cvt_pk_bf16_f32 v231, v106, v107
  v_cvt_pk_bf16_f32 v232, v108, v109
  v_cvt_pk_bf16_f32 v233, v110, v111
  ds_write_b64 v22, v[230:231] offset:21120
  ds_write_b64 v22, v[232:233] offset:21152
  v_cvt_pk_bf16_f32 v224, v112, v113
  v_cvt_pk_bf16_f32 v225, v114, v115
  v_cvt_pk_bf16_f32 v226, v116, v117
  v_cvt_pk_bf16_f32 v227, v118, v119
  ds_write_b64 v22, v[224:225] offset:25344
  ds_write_b64 v22, v[226:227] offset:25376
  v_cvt_pk_bf16_f32 v230, v120, v121
  v_cvt_pk_bf16_f32 v231, v122, v123
  v_cvt_pk_bf16_f32 v232, v124, v125
  v_cvt_pk_bf16_f32 v233, v126, v127
  ds_write_b64 v22, v[230:231] offset:29568
  ds_write_b64 v22, v[232:233] offset:29600
  s_waitcnt lgkmcnt(0)
  s_barrier
  ds_read_b64 v[144:145], v34 offset:1848
  ds_read_b64 v[146:147], v34 offset:1856
  ds_read_b64 v[148:149], v34 offset:1864
  ds_read_b64 v[150:151], v34 offset:1872
  ds_read_b64 v[152:153], v34 offset:1880
  ds_read_b64 v[64:65], v34 offset:1928
  ds_read_b64 v[66:67], v34 offset:1936
  ds_read_b64 v[68:69], v34 offset:1944
  ds_read_b64 v[70:71], v34 offset:1952
  ds_read_b64 v[72:73], v34 offset:1960
  ds_read_b64 v[74:75], v34 offset:1664
  ds_read_b64 v[76:77], v34 offset:1672
  ds_read_b64 v[78:79], v34 offset:1680
  ds_read_b64 v[80:81], v34 offset:1688
  ds_read_b64 v[82:83], v34 offset:1696
  ds_read_b64 v[84:85], v34 offset:1400
  ds_read_b64 v[86:87], v34 offset:1408
  ds_read_b64 v[88:89], v34 offset:1416
  ds_read_b64 v[90:91], v34 offset:1424
  ds_read_b64 v[92:93], v34 offset:1432
  ds_read_b64 v[94:95], v34 offset:1136
  ds_read_b64 v[96:97], v34 offset:1144
  ds_read_b64 v[98:99], v34 offset:1152
  ds_read_b64 v[100:101], v34 offset:1160
  ds_read_b64 v[102:103], v34 offset:1168
  ds_read_b64 v[104:105], v34 offset:872
  ds_read_b64 v[106:107], v34 offset:880
  ds_read_b64 v[108:109], v34 offset:888
  ds_read_b64 v[110:111], v34 offset:896
  ds_read_b64 v[112:113], v34 offset:904
  v_mov_b32 v224, 0
  v_mov_b32 v225, 0
  ds_read_b64 v[114:115], v34 offset:608
  ds_read_b64 v[116:117], v34 offset:616
  ds_read_b64 v[118:119], v34 offset:624
  ds_read_b64 v[120:121], v34 offset:632
  ds_read_b64 v[122:123], v34 offset:640
  v_mov_b32 v226, 0
  v_mov_b32 v227, 0
  ds_read_b64 v[124:125], v34 offset:344
  ds_read_b64 v[126:127], v34 offset:352
  ds_read_b64 v[128:129], v34 offset:360
  ds_read_b64 v[130:131], v34 offset:368
  ds_read_b64 v[132:133], v34 offset:376
  v_mov_b32 v228, 0
  v_mov_b32 v229, 0
  ds_read_b64 v[134:135], v34 offset:80
  ds_read_b64 v[136:137], v34 offset:88
  ds_read_b64 v[138:139], v34 offset:96
  ds_read_b64 v[140:141], v34 offset:104
  ds_read_b64 v[142:143], v34 offset:112
  v_mov_b32 v230, 0
  v_mov_b32 v231, 0
  v_mov_b32 v192, 0
  v_mov_b32 v193, 0
  v_mov_b32 v194, 0
  v_mov_b32 v195, 0
  v_mov_b32 v196, 0
  v_mov_b32 v197, 0
  v_mov_b32 v198, 0
  v_mov_b32 v199, 0
  v_mov_b32 v200, 0
  v_mov_b32 v201, 0
  v_mov_b32 v202, 0
  v_mov_b32 v203, 0
  v_mov_b32 v204, 0
  v_mov_b32 v205, 0
  v_mov_b32 v206, 0
  v_mov_b32 v207, 0
  v_mov_b32 v208, 0
  v_mov_b32 v209, 0
  v_mov_b32 v210, 0
  v_mov_b32 v211, 0
  s_waitcnt lgkmcnt(15)
  v_dot2c_f32_bf16 v224, v64, v144
  v_dot2c_f32_bf16 v225, v74, v144
  v_dot2c_f32_bf16 v226, v84, v144
  v_dot2c_f32_bf16 v227, v94, v144
  v_dot2c_f32_bf16 v228, v104, v144
  v_dot2c_f32_bf16 v224, v65, v145
  v_dot2c_f32_bf16 v225, v75, v145
  v_dot2c_f32_bf16 v226, v85, v145
  v_dot2c_f32_bf16 v227, v95, v145
  v_dot2c_f32_bf16 v228, v105, v145
  v_dot2c_f32_bf16 v224, v66, v146
  v_dot2c_f32_bf16 v225, v76, v146
  v_dot2c_f32_bf16 v226, v86, v146
  v_dot2c_f32_bf16 v227, v96, v146
  v_dot2c_f32_bf16 v228, v106, v146
  v_dot2c_f32_bf16 v224, v67, v147
  v_dot2c_f32_bf16 v225, v77, v147
  v_dot2c_f32_bf16 v226, v87, v147
  v_dot2c_f32_bf16 v227, v97, v147
  v_dot2c_f32_bf16 v228, v107, v147
  v_dot2c_f32_bf16 v224, v68, v148
  v_dot2c_f32_bf16 v225, v78, v148
  v_dot2c_f32_bf16 v226, v88, v148
  v_dot2c_f32_bf16 v227, v98, v148
  v_dot2c_f32_bf16 v228, v108, v148
  v_dot2c_f32_bf16 v224, v69, v149
  v_dot2c_f32_bf16 v225, v79, v149
  v_dot2c_f32_bf16 v226, v89, v149
  v_dot2c_f32_bf16 v227, v99, v149
  v_dot2c_f32_bf16 v228, v109, v149
  v_dot2c_f32_bf16 v224, v70, v150
  v_dot2c_f32_bf16 v225, v80, v150
  v_dot2c_f32_bf16 v226, v90, v150
  v_dot2c_f32_bf16 v227, v100, v150
  v_dot2c_f32_bf16 v228, v110, v150
  v_dot2c_f32_bf16 v224, v71, v151
  v_dot2c_f32_bf16 v225, v81, v151
  v_dot2c_f32_bf16 v226, v91, v151
  v_dot2c_f32_bf16 v227, v101, v151
  v_dot2c_f32_bf16 v228, v111, v151
  v_dot2c_f32_bf16 v224, v72, v152
  v_dot2c_f32_bf16 v225, v82, v152
  v_dot2c_f32_bf16 v226, v92, v152
  v_dot2c_f32_bf16 v227, v102, v152
  v_dot2c_f32_bf16 v228, v112, v152
  v_dot2c_f32_bf16 v224, v73, v153
  v_dot2c_f32_bf16 v225, v83, v153
  v_dot2c_f32_bf16 v226, v93, v153
  v_dot2c_f32_bf16 v227, v103, v153
  v_dot2c_f32_bf16 v228, v113, v153
  s_waitcnt lgkmcnt(0)
  v_dot2c_f32_bf16 v229, v114, v144
  v_dot2c_f32_bf16 v230, v124, v144
  v_dot2c_f32_bf16 v231, v134, v144
  v_dot2c_f32_bf16 v229, v115, v145
  v_dot2c_f32_bf16 v230, v125, v145
  v_dot2c_f32_bf16 v231, v135, v145
  v_dot2c_f32_bf16 v229, v116, v146
  v_dot2c_f32_bf16 v230, v126, v146
  v_dot2c_f32_bf16 v231, v136, v146
  v_dot2c_f32_bf16 v229, v117, v147
  v_dot2c_f32_bf16 v230, v127, v147
  v_dot2c_f32_bf16 v231, v137, v147
  v_dot2c_f32_bf16 v229, v118, v148
  v_dot2c_f32_bf16 v230, v128, v148
  v_dot2c_f32_bf16 v231, v138, v148
  v_dot2c_f32_bf16 v229, v119, v149
  v_dot2c_f32_bf16 v230, v129, v149
  v_dot2c_f32_bf16 v231, v139, v149
  v_dot2c_f32_bf16 v229, v120, v150
  v_dot2c_f32_bf16 v230, v130, v150
  v_dot2c_f32_bf16 v231, v140, v150
  v_dot2c_f32_bf16 v229, v121, v151
  v_dot2c_f32_bf16 v230, v131, v151
  v_dot2c_f32_bf16 v231, v141, v151
  v_dot2c_f32_bf16 v229, v122, v152
  v_dot2c_f32_bf16 v230, v132, v152
  v_dot2c_f32_bf16 v231, v142, v152
  v_dot2c_f32_bf16 v229, v123, v153
  v_dot2c_f32_bf16 v230, v133, v153
  v_dot2c_f32_bf16 v231, v143, v153
  ds_read_b64 v[64:65], v38 offset:2008
  ds_read_b64 v[66:67], v38 offset:2016
  ds_read_b64 v[68:69], v38 offset:2024
  ds_read_b64 v[70:71], v38 offset:2032
  ds_read_b64 v[72:73], v39 offset:2040
  ds_read_b64 v[74:75], v38 offset:1744
  ds_read_b64 v[76:77], v38 offset:1752
  ds_read_b64 v[78:79], v38 offset:1760
  ds_read_b64 v[80:81], v38 offset:1768
  ds_read_b64 v[82:83], v39 offset:1776
  ds_read_b64 v[84:85], v38 offset:1480
  ds_read_b64 v[86:87], v38 offset:1488
  ds_read_b64 v[88:89], v38 offset:1496
  ds_read_b64 v[90:91], v38 offset:1504
  ds_read_b64 v[92:93], v39 offset:1512
  ds_read_b64 v[94:95], v38 offset:1216
  ds_read_b64 v[96:97], v38 offset:1224
  ds_read_b64 v[98:99], v38 offset:1232
  ds_read_b64 v[100:101], v38 offset:1240
  ds_read_b64 v[102:103], v39 offset:1248
  ds_read_b64 v[104:105], v38 offset:952
  ds_read_b64 v[106:107], v38 offset:960
  ds_read_b64 v[108:109], v38 offset:968
  ds_read_b64 v[110:111], v38 offset:976
  ds_read_b64 v[112:113], v39 offset:984
  ds_read_b64 v[114:115], v38 offset:688
  ds_read_b64 v[116:117], v38 offset:696
  ds_read_b64 v[118:119], v38 offset:704
  ds_read_b64 v[120:121], v38 offset:712
  ds_read_b64 v[122:123], v39 offset:720
  ds_read_b64 v[124:125], v38 offset:424
  ds_read_b64 v[126:127], v38 offset:432
  ds_read_b64 v[128:129], v38 offset:440
  ds_read_b64 v[130:131], v38 offset:448
  ds_read_b64 v[132:133], v39 offset:456
  ds_read_b64 v[134:135], v38 offset:160
  ds_read_b64 v[136:137], v38 offset:168
  ds_read_b64 v[138:139], v38 offset:176
  ds_read_b64 v[140:141], v38 offset:184
  ds_read_b64 v[142:143], v39 offset:192
  v_cvt_pk_bf16_f32 v4, v224, v225
  v_lshlrev_b32 v224, 16, v4
  v_and_b32 v225, 0xffff0000, v4
  v_mul_f32 v224, s60, v224
  v_mul_f32 v225, s60, v225
  v_cvt_pk_bf16_f32 v4, v224, v225
  v_lshlrev_b32 v224, 16, v4
  v_and_b32 v225, 0xffff0000, v4
  v_cndmask_b32 v224, v37, v224, s[76:77]
  v_cndmask_b32 v225, v37, v225, s[78:79]
  v_cvt_pk_bf16_f32 v4, v226, v227
  v_lshlrev_b32 v226, 16, v4
  v_and_b32 v227, 0xffff0000, v4
  v_mul_f32 v226, s60, v226
  v_mul_f32 v227, s60, v227
  v_cvt_pk_bf16_f32 v4, v226, v227
  v_lshlrev_b32 v226, 16, v4
  v_and_b32 v227, 0xffff0000, v4
  v_cndmask_b32 v226, v37, v226, s[80:81]
  v_cndmask_b32 v227, v37, v227, s[82:83]
  v_cvt_pk_bf16_f32 v4, v228, v229
  v_lshlrev_b32 v228, 16, v4
  v_and_b32 v229, 0xffff0000, v4
  v_mul_f32 v228, s60, v228
  v_mul_f32 v229, s60, v229
  v_cvt_pk_bf16_f32 v4, v228, v229
  v_lshlrev_b32 v228, 16, v4
  v_and_b32 v229, 0xffff0000, v4
  v_cndmask_b32 v228, v37, v228, s[84:85]
  v_cndmask_b32 v229, v37, v229, s[86:87]
  v_cvt_pk_bf16_f32 v4, v230, v231
  v_lshlrev_b32 v230, 16, v4
  v_and_b32 v231, 0xffff0000, v4
  v_mul_f32 v230, s60, v230
  v_mul_f32 v231, s60, v231
  v_cvt_pk_bf16_f32 v4, v230, v231
  v_lshlrev_b32 v230, 16, v4
  v_and_b32 v231, 0xffff0000, v4
  v_cndmask_b32 v230, v37, v230, s[88:89]
  v_cndmask_b32 v231, v37, v231, s[90:91]
  v_max3_f32 v5, v224, v225, v226
  v_max3_f32 v5, v5, v227, v228
  v_max3_f32 v5, v5, v229, v230
  v_max_f32 v5, v5, v231
  v_sub_f32 v224, v224, v5
  v_mul_f32 v224, s61, v224
  v_exp_f32 v224, v224
  v_sub_f32 v225, v225, v5
  v_mul_f32 v225, s61, v225
  v_exp_f32 v225, v225
  v_sub_f32 v226, v226, v5
  v_mul_f32 v226, s61, v226
  v_exp_f32 v226, v226
  v_sub_f32 v227, v227, v5
  v_mul_f32 v227, s61, v227
  v_exp_f32 v227, v227
  v_sub_f32 v228, v228, v5
  v_mul_f32 v228, s61, v228
  v_exp_f32 v228, v228
  v_sub_f32 v229, v229, v5
  v_mul_f32 v229, s61, v229
  v_exp_f32 v229, v229
  v_sub_f32 v230, v230, v5
  v_mul_f32 v230, s61, v230
  v_exp_f32 v230, v230
  v_sub_f32 v231, v231, v5
  v_mul_f32 v231, s61, v231
  v_exp_f32 v231, v231
  s_nop 0
  v_add_f32 v5, v224, v225
  v_add_f32 v5, v5, v226
  v_add_f32 v5, v5, v227
  v_add_f32 v5, v5, v228
  v_add_f32 v5, v5, v229
  v_add_f32 v5, v5, v230
  v_add_f32 v5, v5, v231
  v_rcp_f32 v5, v5
  s_nop 0
  v_mul_f32 v224, v224, v5
  v_mul_f32 v225, v225, v5
  v_mul_f32 v226, v226, v5
  v_mul_f32 v227, v227, v5
  v_mul_f32 v228, v228, v5
  v_mul_f32 v229, v229, v5
  v_mul_f32 v230, v230, v5
  v_mul_f32 v231, v231, v5
  v_cvt_pk_bf16_f32 v232, v224, v225
  v_cvt_pk_bf16_f32 v233, v226, v227
  v_cvt_pk_bf16_f32 v234, v228, v229
  v_cvt_pk_bf16_f32 v235, v230, v231
  s_waitcnt lgkmcnt(15)
  v_perm_b32 v236, v74, v64, s62
  v_perm_b32 v237, v74, v64, s63
  v_dot2c_f32_bf16 v192, v236, v232
  v_dot2c_f32_bf16 v193, v237, v232
  v_perm_b32 v238, v75, v65, s62
  v_perm_b32 v239, v75, v65, s63
  v_dot2c_f32_bf16 v194, v238, v232
  v_dot2c_f32_bf16 v195, v239, v232
  v_perm_b32 v240, v76, v66, s62
  v_perm_b32 v241, v76, v66, s63
  v_dot2c_f32_bf16 v196, v240, v232
  v_dot2c_f32_bf16 v197, v241, v232
  v_perm_b32 v242, v77, v67, s62
  v_perm_b32 v243, v77, v67, s63
  v_dot2c_f32_bf16 v198, v242, v232
  v_dot2c_f32_bf16 v199, v243, v232
  v_perm_b32 v236, v78, v68, s62
  v_perm_b32 v237, v78, v68, s63
  v_dot2c_f32_bf16 v200, v236, v232
  v_dot2c_f32_bf16 v201, v237, v232
  v_perm_b32 v238, v79, v69, s62
  v_perm_b32 v239, v79, v69, s63
  v_dot2c_f32_bf16 v202, v238, v232
  v_dot2c_f32_bf16 v203, v239, v232
  v_perm_b32 v240, v80, v70, s62
  v_perm_b32 v241, v80, v70, s63
  v_dot2c_f32_bf16 v204, v240, v232
  v_dot2c_f32_bf16 v205, v241, v232
  v_perm_b32 v242, v81, v71, s62
  v_perm_b32 v243, v81, v71, s63
  v_dot2c_f32_bf16 v206, v242, v232
  v_dot2c_f32_bf16 v207, v243, v232
  v_perm_b32 v236, v82, v72, s62
  v_perm_b32 v237, v82, v72, s63
  v_dot2c_f32_bf16 v208, v236, v232
  v_dot2c_f32_bf16 v209, v237, v232
  v_perm_b32 v238, v83, v73, s62
  v_perm_b32 v239, v83, v73, s63
  v_dot2c_f32_bf16 v210, v238, v232
  v_dot2c_f32_bf16 v211, v239, v232
  s_waitcnt lgkmcnt(15)
  v_perm_b32 v236, v94, v84, s62
  v_perm_b32 v237, v94, v84, s63
  v_dot2c_f32_bf16 v192, v236, v233
  v_dot2c_f32_bf16 v193, v237, v233
  v_perm_b32 v238, v95, v85, s62
  v_perm_b32 v239, v95, v85, s63
  v_dot2c_f32_bf16 v194, v238, v233
  v_dot2c_f32_bf16 v195, v239, v233
  v_perm_b32 v240, v96, v86, s62
  v_perm_b32 v241, v96, v86, s63
  v_dot2c_f32_bf16 v196, v240, v233
  v_dot2c_f32_bf16 v197, v241, v233
  v_perm_b32 v242, v97, v87, s62
  v_perm_b32 v243, v97, v87, s63
  v_dot2c_f32_bf16 v198, v242, v233
  v_dot2c_f32_bf16 v199, v243, v233
  v_perm_b32 v236, v98, v88, s62
  v_perm_b32 v237, v98, v88, s63
  v_dot2c_f32_bf16 v200, v236, v233
  v_dot2c_f32_bf16 v201, v237, v233
  v_perm_b32 v238, v99, v89, s62
  v_perm_b32 v239, v99, v89, s63
  v_dot2c_f32_bf16 v202, v238, v233
  v_dot2c_f32_bf16 v203, v239, v233
  v_perm_b32 v240, v100, v90, s62
  v_perm_b32 v241, v100, v90, s63
  v_dot2c_f32_bf16 v204, v240, v233
  v_dot2c_f32_bf16 v205, v241, v233
  v_perm_b32 v242, v101, v91, s62
  v_perm_b32 v243, v101, v91, s63
  v_dot2c_f32_bf16 v206, v242, v233
  v_dot2c_f32_bf16 v207, v243, v233
  v_perm_b32 v236, v102, v92, s62
  v_perm_b32 v237, v102, v92, s63
  v_dot2c_f32_bf16 v208, v236, v233
  v_dot2c_f32_bf16 v209, v237, v233
  v_perm_b32 v238, v103, v93, s62
  v_perm_b32 v239, v103, v93, s63
  v_dot2c_f32_bf16 v210, v238, v233
  v_dot2c_f32_bf16 v211, v239, v233
  s_waitcnt lgkmcnt(10)
  v_perm_b32 v236, v114, v104, s62
  v_perm_b32 v237, v114, v104, s63
  v_dot2c_f32_bf16 v192, v236, v234
  v_dot2c_f32_bf16 v193, v237, v234
  v_perm_b32 v238, v115, v105, s62
  v_perm_b32 v239, v115, v105, s63
  v_dot2c_f32_bf16 v194, v238, v234
  v_dot2c_f32_bf16 v195, v239, v234
  v_perm_b32 v240, v116, v106, s62
  v_perm_b32 v241, v116, v106, s63
  v_dot2c_f32_bf16 v196, v240, v234
  v_dot2c_f32_bf16 v197, v241, v234
  v_perm_b32 v242, v117, v107, s62
  v_perm_b32 v243, v117, v107, s63
  v_dot2c_f32_bf16 v198, v242, v234
  v_dot2c_f32_bf16 v199, v243, v234
  v_perm_b32 v236, v118, v108, s62
  v_perm_b32 v237, v118, v108, s63
  v_dot2c_f32_bf16 v200, v236, v234
  v_dot2c_f32_bf16 v201, v237, v234
  v_perm_b32 v238, v119, v109, s62
  v_perm_b32 v239, v119, v109, s63
  v_dot2c_f32_bf16 v202, v238, v234
  v_dot2c_f32_bf16 v203, v239, v234
  v_perm_b32 v240, v120, v110, s62
  v_perm_b32 v241, v120, v110, s63
  v_dot2c_f32_bf16 v204, v240, v234
  v_dot2c_f32_bf16 v205, v241, v234
  v_perm_b32 v242, v121, v111, s62
  v_perm_b32 v243, v121, v111, s63
  v_dot2c_f32_bf16 v206, v242, v234
  v_dot2c_f32_bf16 v207, v243, v234
  v_perm_b32 v236, v122, v112, s62
  v_perm_b32 v237, v122, v112, s63
  v_dot2c_f32_bf16 v208, v236, v234
  v_dot2c_f32_bf16 v209, v237, v234
  v_perm_b32 v238, v123, v113, s62
  v_perm_b32 v239, v123, v113, s63
  v_dot2c_f32_bf16 v210, v238, v234
  v_dot2c_f32_bf16 v211, v239, v234
  s_waitcnt lgkmcnt(0)
  v_perm_b32 v236, v134, v124, s62
  v_perm_b32 v237, v134, v124, s63
  v_dot2c_f32_bf16 v192, v236, v235
  v_dot2c_f32_bf16 v193, v237, v235
  v_perm_b32 v238, v135, v125, s62
  v_perm_b32 v239, v135, v125, s63
  v_dot2c_f32_bf16 v194, v238, v235
  v_dot2c_f32_bf16 v195, v239, v235
  v_perm_b32 v240, v136, v126, s62
  v_perm_b32 v241, v136, v126, s63
  v_dot2c_f32_bf16 v196, v240, v235
  v_dot2c_f32_bf16 v197, v241, v235
  v_perm_b32 v242, v137, v127, s62
  v_perm_b32 v243, v137, v127, s63
  v_dot2c_f32_bf16 v198, v242, v235
  v_dot2c_f32_bf16 v199, v243, v235
  v_perm_b32 v236, v138, v128, s62
  v_perm_b32 v237, v138, v128, s63
  v_dot2c_f32_bf16 v200, v236, v235
  v_dot2c_f32_bf16 v201, v237, v235
  v_perm_b32 v238, v139, v129, s62
  v_perm_b32 v239, v139, v129, s63
  v_dot2c_f32_bf16 v202, v238, v235
  v_dot2c_f32_bf16 v203, v239, v235
  v_perm_b32 v240, v140, v130, s62
  v_perm_b32 v241, v140, v130, s63
  v_dot2c_f32_bf16 v204, v240, v235
  v_dot2c_f32_bf16 v205, v241, v235
  v_perm_b32 v242, v141, v131, s62
  v_perm_b32 v243, v141, v131, s63
  v_dot2c_f32_bf16 v206, v242, v235
  v_dot2c_f32_bf16 v207, v243, v235
  v_perm_b32 v236, v142, v132, s62
  v_perm_b32 v237, v142, v132, s63
  v_dot2c_f32_bf16 v208, v236, v235
  v_dot2c_f32_bf16 v209, v237, v235
  v_perm_b32 v238, v143, v133, s62
  v_perm_b32 v239, v143, v133, s63
  v_dot2c_f32_bf16 v210, v238, v235
  v_dot2c_f32_bf16 v211, v239, v235
  s_cmp_lg_u32 s20, 0
  s_cbranch_scc1 bh_208
  ds_read_b64 v[64:65], v35 offset:33792
  ds_read_b64 v[66:67], v35 offset:34304
  ds_read_b64 v[68:69], v35 offset:34816
  ds_read_b64 v[70:71], v35 offset:35328
  ds_read_b64 v[72:73], v35 offset:35840
  s_waitcnt lgkmcnt(0)
  ds_write_b64 v35, v[64:65] offset:0
  ds_write_b64 v35, v[66:67] offset:512
  ds_write_b64 v35, v[68:69] offset:1024
  ds_write_b64 v35, v[70:71] offset:1536
  ds_write_b64 v35, v[72:73] offset:2048
bh_208:
  s_nop 1
  v_cvt_pk_bf16_f32 v244, v192, v193
  v_cvt_pk_bf16_f32 v245, v194, v195
  v_cvt_pk_bf16_f32 v246, v196, v197
  v_cvt_pk_bf16_f32 v247, v198, v199
  v_cvt_pk_bf16_f32 v248, v200, v201
  v_cvt_pk_bf16_f32 v249, v202, v203
  v_cvt_pk_bf16_f32 v250, v204, v205
  v_cvt_pk_bf16_f32 v251, v206, v207
  v_cvt_pk_bf16_f32 v252, v208, v209
  v_cvt_pk_bf16_f32 v253, v210, v211
  buffer_store_dwordx4 v[244:247], v29, s[16:19], s27 offen sc1
  buffer_store_dwordx4 v[248:251], v30, s[16:19], s27 offen sc1
  buffer_store_dwordx2 v[252:253], v31, s[16:19], s27 offen sc1
  s_add_u32 s27, s27, 2048
  s_mov_b64 s[78:79], -1
  s_mov_b64 s[80:81], -1
  s_mov_b64 s[82:83], -1
  s_mov_b64 s[84:85], -1
  s_mov_b64 s[86:87], -1
  s_mov_b64 s[88:89], -1
  s_mov_b64 s[90:91], -1
  s_sub_u32 s26, s26, 1
  s_cmp_gt_u32 s26, 0
  s_waitcnt lgkmcnt(0)
  s_cbranch_scc1 bf_blk_206
  s_waitcnt vmcnt(0) lgkmcnt(0)
  s_load_dwordx2 s[32:33], s[0:1], 96
  s_waitcnt lgkmcnt(0)
  s_mov_b32 s32, s32
  s_mov_b32 s33, s33
  s_mov_b32 s34, 256
  s_mov_b32 s35, 0x00020000
  s_mov_b32 s21, 76
  s_cmp_lg_u32 s20, 0
  s_cbranch_scc1 wf_210
  v_mov_b32 v4, 0
  s_mov_b32 s101, 0
wf_209:
  buffer_load_dword v5, v4, s[32:35], s21 offen sc1
  s_add_u32 s101, s101, 1
  s_cmp_gt_u32 s101, 131072
  s_cbranch_scc1 main_end
  s_waitcnt vmcnt(0)
  v_readfirstlane_b32 s100, v5
  s_cmp_ge_u32 s100, 32
  s_cbranch_scc1 wf_210
  s_sleep 8
  s_branch wf_209
wf_210:
  s_barrier
  s_load_dwordx2 s[12:13], s[0:1], 72
  s_lshl_b32 s21, s2, 2
  s_add_u32 s21, s21, s20
  s_mul_i32 s21, s21, 6400
  s_add_u32 s22, s21, 4096
  v_lshlrev_b32 v5, 4, v1
  s_mov_b32 s14, 819200
  s_waitcnt lgkmcnt(0)
  buffer_load_dwordx4 v[40:43], v5, s[12:15], s21 offen offset:0
  buffer_load_dwordx4 v[40:43], v5, s[12:15], s21 offen offset:1024
  buffer_load_dwordx4 v[40:43], v5, s[12:15], s21 offen offset:2048
  buffer_load_dwordx4 v[40:43], v5, s[12:15], s21 offen offset:3072
  buffer_load_dwordx4 v[40:43], v5, s[12:15], s22 offen offset:0
  buffer_load_dwordx4 v[40:43], v5, s[12:15], s22 offen offset:1024
  buffer_load_dwordx4 v[40:43], v5, s[12:15], s22 offen offset:2048
  s_mov_b32 s21, 91136
  s_cmp_lg_u32 s20, 0
  s_cbranch_scc1 af_211
  v_mov_b32 v4, 0
  v_mov_b32 v5, 1
  s_mov_b64 exec, 1
  buffer_atomic_add v5, v4, s[72:75], s21 offen sc1
  s_mov_b64 exec, -1
  s_nop 1
af_211:
  s_barrier
  s_mov_b32 s84, 0
  s_mov_b32 s85, -1
  s_load_dwordx2 s[4:5], s[0:1], 0
  s_load_dwordx2 s[6:7], s[0:1], 16
  s_load_dwordx2 s[38:39], s[0:1], 104
  s_mov_b32 s42, s2
  s_mov_b32 s41, 0
  s_waitcnt lgkmcnt(0)
  s_mov_b32 s8, s4
  s_mov_b32 s9, s5
  s_mov_b32 s10, 2621440
  s_mov_b32 s11, 0x00020000
  s_mov_b32 s12, s6
  s_mov_b32 s13, s7
  s_mov_b32 s14, 7864320
  s_mov_b32 s15, 0x00020000
  s_mov_b32 s16, s38
  s_mov_b32 s17, s39
  s_mov_b32 s18, 50331648
  s_mov_b32 s19, 0x00020000
  s_add_u32 s52, s38, 50331648
  s_addc_u32 s53, s39, 0
  s_mov_b32 s54, 6291456
  s_mov_b32 s55, 0x00020000
  s_add_u32 s56, s38, 85983232
  s_addc_u32 s57, s39, 0
  s_mov_b32 s58, 6815744
  s_mov_b32 s59, 0x00020000
  s_load_dwordx2 s[72:73], s[0:1], 104
  s_waitcnt lgkmcnt(0)
  s_add_u32 s72, s72, 81068032
  s_addc_u32 s73, s73, 0
  s_mov_b32 s74, 116736
  s_mov_b32 s75, 0x00020000
  s_mul_i32 s44, s42, 384
  v_mov_b32 v9, 2731
  v_add_u32 v8, 0, v1
  v_mul_u32_u24 v7, v8, v9
  v_lshrrev_b32 v7, 16, v7
  v_mul_u32_u24 v4, 24, v7
  v_sub_u32 v8, v8, v4
  s_mov_b32 s21, 12288
  v_mul_lo_u32 v7, v7, s21
  v_lshl_add_u32 v4, v8, 4, v7
  v_add_u32 v8, 64, v1
  v_mul_u32_u24 v7, v8, v9
  v_lshrrev_b32 v7, 16, v7
  v_mul_u32_u24 v5, 24, v7
  v_sub_u32 v8, v8, v5
  s_mov_b32 s21, 12288
  v_mul_lo_u32 v7, v7, s21
  v_lshl_add_u32 v5, v8, 4, v7
  v_add_u32 v8, 128, v1
  v_mul_u32_u24 v7, v8, v9
  v_lshrrev_b32 v7, 16, v7
  v_mul_u32_u24 v6, 24, v7
  v_sub_u32 v8, v8, v6
  s_mov_b32 s21, 12288
  v_mul_lo_u32 v7, v7, s21
  v_lshl_add_u32 v6, v8, 4, v7
  v_lshrrev_b32 v7, 2, v2
  v_lshl_add_u32 v7, v3, 3, v7
  v_mul_u32_u24 v7, 384, v7
  v_and_b32 v8, 3, v2
  v_lshlrev_b32 v8, 3, v8
  s_mul_i32 s21, s20, 96
  v_add3_u32 v7, v7, v8, s21
  v_add_u32 v8, 61440, v7
  s_mul_i32 s21, s20, 491520
  s_add_u32 s21, s21, 0
  s_add_u32 s21, s21, s44
  s_mul_i32 s22, s20, 15360
  s_add_u32 s22, s22, 0
  s_add_u32 m0, s22, 0
  s_nop 0
  buffer_load_dwordx4 v4, s[12:15], s21 offen lds
  s_add_u32 m0, s22, 1024
  s_nop 0
  buffer_load_dwordx4 v5, s[12:15], s21 offen lds
  s_add_u32 m0, s22, 2048
  s_nop 0
  buffer_load_dwordx4 v6, s[12:15], s21 offen lds
  s_mul_i32 s21, s20, 491520
  s_add_u32 s21, s21, 98304
  s_add_u32 s21, s21, s44
  s_mul_i32 s22, s20, 15360
  s_add_u32 s22, s22, 3072
  s_add_u32 m0, s22, 0
  s_nop 0
  buffer_load_dwordx4 v4, s[12:15], s21 offen lds
  s_add_u32 m0, s22, 1024
  s_nop 0
  buffer_load_dwordx4 v5, s[12:15], s21 offen lds
  s_add_u32 m0, s22, 2048
  s_nop 0
  buffer_load_dwordx4 v6, s[12:15], s21 offen lds
  s_mul_i32 s21, s20, 491520
  s_add_u32 s21, s21, 196608
  s_add_u32 s21, s21, s44
  s_mul_i32 s22, s20, 15360
  s_add_u32 s22, s22, 6144
  s_add_u32 m0, s22, 0
  s_nop 0
  buffer_load_dwordx4 v4, s[12:15], s21 offen lds
  s_add_u32 m0, s22, 1024
  s_nop 0
  buffer_load_dwordx4 v5, s[12:15], s21 offen lds
  s_add_u32 m0, s22, 2048
  s_nop 0
  buffer_load_dwordx4 v6, s[12:15], s21 offen lds
  s_mul_i32 s21, s20, 491520
  s_add_u32 s21, s21, 294912
  s_add_u32 s21, s21, s44
  s_mul_i32 s22, s20, 15360
  s_add_u32 s22, s22, 9216
  s_add_u32 m0, s22, 0
  s_nop 0
  buffer_load_dwordx4 v4, s[12:15], s21 offen lds
  s_add_u32 m0, s22, 1024
  s_nop 0
  buffer_load_dwordx4 v5, s[12:15], s21 offen lds
  s_add_u32 m0, s22, 2048
  s_nop 0
  buffer_load_dwordx4 v6, s[12:15], s21 offen lds
  s_mul_i32 s21, s20, 491520
  s_add_u32 s21, s21, 393216
  s_add_u32 s21, s21, s44
  s_mul_i32 s22, s20, 15360
  s_add_u32 s22, s22, 12288
  s_add_u32 m0, s22, 0
  s_nop 0
  buffer_load_dwordx4 v4, s[12:15], s21 offen lds
  s_add_u32 m0, s22, 1024
  s_nop 0
  buffer_load_dwordx4 v5, s[12:15], s21 offen lds
  s_add_u32 m0, s22, 2048
  s_nop 0
  buffer_load_dwordx4 v6, s[12:15], s21 offen lds
  s_mul_i32 s21, s20, 491520
  s_add_u32 s21, s21, 1966080
  s_add_u32 s21, s21, s44
  s_mul_i32 s22, s20, 15360
  s_add_u32 s22, s22, 61440
  s_add_u32 m0, s22, 0
  s_nop 0
  buffer_load_dwordx4 v4, s[12:15], s21 offen lds
  s_add_u32 m0, s22, 1024
  s_nop 0
  buffer_load_dwordx4 v5, s[12:15], s21 offen lds
  s_add_u32 m0, s22, 2048
  s_nop 0
  buffer_load_dwordx4 v6, s[12:15], s21 offen lds
  s_mul_i32 s21, s20, 491520
  s_add_u32 s21, s21, 2064384
  s_add_u32 s21, s21, s44
  s_mul_i32 s22, s20, 15360
  s_add_u32 s22, s22, 64512
  s_add_u32 m0, s22, 0
  s_nop 0
  buffer_load_dwordx4 v4, s[12:15], s21 offen lds
  s_add_u32 m0, s22, 1024
  s_nop 0
  buffer_load_dwordx4 v5, s[12:15], s21 offen lds
  s_add_u32 m0, s22, 2048
  s_nop 0
  buffer_load_dwordx4 v6, s[12:15], s21 offen lds
  s_mul_i32 s21, s20, 491520
  s_add_u32 s21, s21, 2162688
  s_add_u32 s21, s21, s44
  s_mul_i32 s22, s20, 15360
  s_add_u32 s22, s22, 67584
  s_add_u32 m0, s22, 0
  s_nop 0
  buffer_load_dwordx4 v4, s[12:15], s21 offen lds
  s_add_u32 m0, s22, 1024
  s_nop 0
  buffer_load_dwordx4 v5, s[12:15], s21 offen lds
  s_add_u32 m0, s22, 2048
  s_nop 0
  buffer_load_dwordx4 v6, s[12:15], s21 offen lds
  s_mul_i32 s21, s20, 491520
  s_add_u32 s21, s21, 2260992
  s_add_u32 s21, s21, s44
  s_mul_i32 s22, s20, 15360
  s_add_u32 s22, s22, 70656
  s_add_u32 m0, s22, 0
  s_nop 0
  buffer_load_dwordx4 v4, s[12:15], s21 offen lds
  s_add_u32 m0, s22, 1024
  s_nop 0
  buffer_load_dwordx4 v5, s[12:15], s21 offen lds
  s_add_u32 m0, s22, 2048
  s_nop 0
  buffer_load_dwordx4 v6, s[12:15], s21 offen lds
  s_mul_i32 s21, s20, 491520
  s_add_u32 s21, s21, 2359296
  s_add_u32 s21, s21, s44
  s_mul_i32 s22, s20, 15360
  s_add_u32 s22, s22, 73728
  s_add_u32 m0, s22, 0
  s_nop 0
  buffer_load_dwordx4 v4, s[12:15], s21 offen lds
  s_add_u32 m0, s22, 1024
  s_nop 0
  buffer_load_dwordx4 v5, s[12:15], s21 offen lds
  s_add_u32 m0, s22, 2048
  s_nop 0
  buffer_load_dwordx4 v6, s[12:15], s21 offen lds
  s_mul_i32 s21, s20, 491520
  s_add_u32 s21, s21, 3932160
  s_add_u32 s21, s21, s44
  buffer_load_dwordx4 v[64:67], v4, s[12:15], s21 offen
  buffer_load_dwordx4 v[68:71], v5, s[12:15], s21 offen
  buffer_load_dwordx4 v[72:75], v6, s[12:15], s21 offen
  s_mul_i32 s21, s20, 491520
  s_add_u32 s21, s21, 4030464
  s_add_u32 s21, s21, s44
  buffer_load_dwordx4 v[76:79], v4, s[12:15], s21 offen
  buffer_load_dwordx4 v[80:83], v5, s[12:15], s21 offen
  buffer_load_dwordx4 v[84:87], v6, s[12:15], s21 offen
  s_mul_i32 s21, s20, 491520
  s_add_u32 s21, s21, 4128768
  s_add_u32 s21, s21, s44
  buffer_load_dwordx4 v[88:91], v4, s[12:15], s21 offen
  buffer_load_dwordx4 v[92:95], v5, s[12:15], s21 offen
  buffer_load_dwordx4 v[96:99], v6, s[12:15], s21 offen
  s_mul_i32 s21, s20, 491520
  s_add_u32 s21, s21, 4227072
  s_add_u32 s21, s21, s44
  buffer_load_dwordx4 v[100:103], v4, s[12:15], s21 offen
  buffer_load_dwordx4 v[104:107], v5, s[12:15], s21 offen
  buffer_load_dwordx4 v[108:111], v6, s[12:15], s21 offen
  s_mul_i32 s21, s20, 491520
  s_add_u32 s21, s21, 4325376
  s_add_u32 s21, s21, s44
  buffer_load_dwordx4 v[112:115], v4, s[12:15], s21 offen
  buffer_load_dwordx4 v[116:119], v5, s[12:15], s21 offen
  buffer_load_dwordx4 v[120:123], v6, s[12:15], s21 offen
  s_mul_i32 s21, s20, 491520
  s_add_u32 s21, s21, 5898240
  s_add_u32 s21, s21, s44
  buffer_load_dwordx4 v[124:127], v4, s[12:15], s21 offen
  buffer_load_dwordx4 v[128:131], v5, s[12:15], s21 offen
  buffer_load_dwordx4 v[132:135], v6, s[12:15], s21 offen
  s_mul_i32 s21, s20, 491520
  s_add_u32 s21, s21, 5996544
  s_add_u32 s21, s21, s44
  buffer_load_dwordx4 v[136:139], v4, s[12:15], s21 offen
  buffer_load_dwordx4 v[140:143], v5, s[12:15], s21 offen
  buffer_load_dwordx4 v[144:147], v6, s[12:15], s21 offen
  s_mul_i32 s21, s20, 491520
  s_add_u32 s21, s21, 6094848
  s_add_u32 s21, s21, s44
  buffer_load_dwordx4 v[148:151], v4, s[12:15], s21 offen
  buffer_load_dwordx4 v[152:155], v5, s[12:15], s21 offen
  buffer_load_dwordx4 v[156:159], v6, s[12:15], s21 offen
  s_mul_i32 s21, s20, 491520
  s_add_u32 s21, s21, 6193152
  s_add_u32 s21, s21, s44
  buffer_load_dwordx4 v[160:163], v4, s[12:15], s21 offen
  buffer_load_dwordx4 v[164:167], v5, s[12:15], s21 offen
  buffer_load_dwordx4 v[168:171], v6, s[12:15], s21 offen
  s_mul_i32 s21, s20, 491520
  s_add_u32 s21, s21, 6291456
  s_add_u32 s21, s21, s44
  buffer_load_dwordx4 v[172:175], v4, s[12:15], s21 offen
  buffer_load_dwordx4 v[176:179], v5, s[12:15], s21 offen
  buffer_load_dwordx4 v[180:183], v6, s[12:15], s21 offen
  s_mul_i32 s22, s20, 15360
  v_lshl_add_u32 v30, v1, 4, s22
  v_add_u32 v31, 61440, v30
  s_waitcnt vmcnt(45)
  s_barrier
  ds_read_b64_tr_b16 a[0:1], v7 offset:0
  ds_read_b64_tr_b16 a[2:3], v7 offset:1536
  ds_read_b64_tr_b16 a[4:5], v7 offset:32
  ds_read_b64_tr_b16 a[6:7], v7 offset:1568
  ds_read_b64_tr_b16 a[8:9], v7 offset:64
  ds_read_b64_tr_b16 a[10:11], v7 offset:1600
  ds_read_b64_tr_b16 a[12:13], v7 offset:12288
  ds_read_b64_tr_b16 a[14:15], v7 offset:13824
  ds_read_b64_tr_b16 a[16:17], v7 offset:12320
  ds_read_b64_tr_b16 a[18:19], v7 offset:13856
  ds_read_b64_tr_b16 a[20:21], v7 offset:12352
  ds_read_b64_tr_b16 a[22:23], v7 offset:13888
  ds_read_b64_tr_b16 a[24:25], v7 offset:24576
  ds_read_b64_tr_b16 a[26:27], v7 offset:26112
  ds_read_b64_tr_b16 a[28:29], v7 offset:24608
  ds_read_b64_tr_b16 a[30:31], v7 offset:26144
  ds_read_b64_tr_b16 a[32:33], v7 offset:24640
  ds_read_b64_tr_b16 a[34:35], v7 offset:26176
  ds_read_b64_tr_b16 a[36:37], v7 offset:36864
  ds_read_b64_tr_b16 a[38:39], v7 offset:38400
  ds_read_b64_tr_b16 a[40:41], v7 offset:36896
  ds_read_b64_tr_b16 a[42:43], v7 offset:38432
  ds_read_b64_tr_b16 a[44:45], v7 offset:36928
  ds_read_b64_tr_b16 a[46:47], v7 offset:38464
  ds_read_b64_tr_b16 a[48:49], v7 offset:49152
  ds_read_b64_tr_b16 a[50:51], v7 offset:50688
  ds_read_b64_tr_b16 a[52:53], v7 offset:49184
  ds_read_b64_tr_b16 a[54:55], v7 offset:50720
  ds_read_b64_tr_b16 a[56:57], v7 offset:49216
  ds_read_b64_tr_b16 a[58:59], v7 offset:50752
  s_waitcnt lgkmcnt(0)
  s_barrier
  s_waitcnt vmcnt(30)
  s_barrier
  ds_read_b64_tr_b16 a[60:61], v8 offset:0
  ds_read_b64_tr_b16 a[62:63], v8 offset:1536
  ds_read_b64_tr_b16 a[64:65], v8 offset:32
  ds_read_b64_tr_b16 a[66:67], v8 offset:1568
  ds_read_b64_tr_b16 a[68:69], v8 offset:64
  ds_read_b64_tr_b16 a[70:71], v8 offset:1600
  ds_read_b64_tr_b16 a[72:73], v8 offset:12288
  ds_read_b64_tr_b16 a[74:75], v8 offset:13824
  ds_read_b64_tr_b16 a[76:77], v8 offset:12320
  ds_read_b64_tr_b16 a[78:79], v8 offset:13856
  ds_read_b64_tr_b16 a[80:81], v8 offset:12352
  ds_read_b64_tr_b16 a[82:83], v8 offset:13888
  ds_read_b64_tr_b16 a[84:85], v8 offset:24576
  ds_read_b64_tr_b16 a[86:87], v8 offset:26112
  ds_read_b64_tr_b16 a[88:89], v8 offset:24608
  ds_read_b64_tr_b16 a[90:91], v8 offset:26144
  ds_read_b64_tr_b16 a[92:93], v8 offset:24640
  ds_read_b64_tr_b16 a[94:95], v8 offset:26176
  ds_read_b64_tr_b16 a[96:97], v8 offset:36864
  ds_read_b64_tr_b16 a[98:99], v8 offset:38400
  ds_read_b64_tr_b16 a[100:101], v8 offset:36896
  ds_read_b64_tr_b16 a[102:103], v8 offset:38432
  ds_read_b64_tr_b16 a[104:105], v8 offset:36928
  ds_read_b64_tr_b16 a[106:107], v8 offset:38464
  ds_read_b64_tr_b16 a[108:109], v8 offset:49152
  ds_read_b64_tr_b16 a[110:111], v8 offset:50688
  ds_read_b64_tr_b16 a[112:113], v8 offset:49184
  ds_read_b64_tr_b16 a[114:115], v8 offset:50720
  ds_read_b64_tr_b16 a[116:117], v8 offset:49216
  ds_read_b64_tr_b16 a[118:119], v8 offset:50752
  s_waitcnt lgkmcnt(0)
  s_barrier
  s_waitcnt vmcnt(15)
  ds_write_b128 v30, v[64:67] offset:0
  ds_write_b128 v30, v[68:71] offset:1024
  ds_write_b128 v30, v[72:75] offset:2048
  ds_write_b128 v30, v[76:79] offset:3072
  ds_write_b128 v30, v[80:83] offset:4096
  ds_write_b128 v30, v[84:87] offset:5120
  ds_write_b128 v30, v[88:91] offset:6144
  ds_write_b128 v30, v[92:95] offset:7168
  ds_write_b128 v30, v[96:99] offset:8192
  ds_write_b128 v30, v[100:103] offset:9216
  ds_write_b128 v30, v[104:107] offset:10240
  ds_write_b128 v30, v[108:111] offset:11264
  ds_write_b128 v30, v[112:115] offset:12288
  ds_write_b128 v30, v[116:119] offset:13312
  ds_write_b128 v30, v[120:123] offset:14336
  s_waitcnt lgkmcnt(0)
  s_barrier
  ds_read_b64_tr_b16 a[120:121], v7 offset:0
  ds_read_b64_tr_b16 a[122:123], v7 offset:1536
  ds_read_b64_tr_b16 a[124:125], v7 offset:32
  ds_read_b64_tr_b16 a[126:127], v7 offset:1568
  ds_read_b64_tr_b16 a[128:129], v7 offset:64
  ds_read_b64_tr_b16 a[130:131], v7 offset:1600
  ds_read_b64_tr_b16 a[132:133], v7 offset:12288
  ds_read_b64_tr_b16 a[134:135], v7 offset:13824
  ds_read_b64_tr_b16 a[136:137], v7 offset:12320
  ds_read_b64_tr_b16 a[138:139], v7 offset:13856
  ds_read_b64_tr_b16 a[140:141], v7 offset:12352
  ds_read_b64_tr_b16 a[142:143], v7 offset:13888
  ds_read_b64_tr_b16 a[144:145], v7 offset:24576
  ds_read_b64_tr_b16 a[146:147], v7 offset:26112
  ds_read_b64_tr_b16 a[148:149], v7 offset:24608
  ds_read_b64_tr_b16 a[150:151], v7 offset:26144
  ds_read_b64_tr_b16 a[152:153], v7 offset:24640
  ds_read_b64_tr_b16 a[154:155], v7 offset:26176
  ds_read_b64_tr_b16 a[156:157], v7 offset:36864
  ds_read_b64_tr_b16 a[158:159], v7 offset:38400
  ds_read_b64_tr_b16 a[160:161], v7 offset:36896
  ds_read_b64_tr_b16 a[162:163], v7 offset:38432
  ds_read_b64_tr_b16 a[164:165], v7 offset:36928
  ds_read_b64_tr_b16 a[166:167], v7 offset:38464
  ds_read_b64_tr_b16 a[168:169], v7 offset:49152
  ds_read_b64_tr_b16 a[170:171], v7 offset:50688
  ds_read_b64_tr_b16 a[172:173], v7 offset:49184
  ds_read_b64_tr_b16 a[174:175], v7 offset:50720
  ds_read_b64_tr_b16 a[176:177], v7 offset:49216
  ds_read_b64_tr_b16 a[178:179], v7 offset:50752
  s_waitcnt lgkmcnt(0)
  s_barrier
  s_waitcnt vmcnt(0)
  ds_write_b128 v31, v[124:127] offset:0
  ds_write_b128 v31, v[128:131] offset:1024
  ds_write_b128 v31, v[132:135] offset:2048
  ds_write_b128 v31, v[136:139] offset:3072
  ds_write_b128 v31, v[140:143] offset:4096
  ds_write_b128 v31, v[144:147] offset:5120
  ds_write_b128 v31, v[148:151] offset:6144
  ds_write_b128 v31, v[152:155] offset:7168
  ds_write_b128 v31, v[156:159] offset:8192
  ds_write_b128 v31, v[160:163] offset:9216
  ds_write_b128 v31, v[164:167] offset:10240
  ds_write_b128 v31, v[168:171] offset:11264
  ds_write_b128 v31, v[172:175] offset:12288
  ds_write_b128 v31, v[176:179] offset:13312
  ds_write_b128 v31, v[180:183] offset:14336
  s_waitcnt lgkmcnt(0)
  s_barrier
  ds_read_b64_tr_b16 a[180:181], v8 offset:0
  ds_read_b64_tr_b16 a[182:183], v8 offset:1536
  ds_read_b64_tr_b16 a[184:185], v8 offset:32
  ds_read_b64_tr_b16 a[186:187], v8 offset:1568
  ds_read_b64_tr_b16 a[188:189], v8 offset:64
  ds_read_b64_tr_b16 a[190:191], v8 offset:1600
  ds_read_b64_tr_b16 a[192:193], v8 offset:12288
  ds_read_b64_tr_b16 a[194:195], v8 offset:13824
  ds_read_b64_tr_b16 a[196:197], v8 offset:12320
  ds_read_b64_tr_b16 a[198:199], v8 offset:13856
  ds_read_b64_tr_b16 a[200:201], v8 offset:12352
  ds_read_b64_tr_b16 a[202:203], v8 offset:13888
  ds_read_b64_tr_b16 a[204:205], v8 offset:24576
  ds_read_b64_tr_b16 a[206:207], v8 offset:26112
  ds_read_b64_tr_b16 a[208:209], v8 offset:24608
  ds_read_b64_tr_b16 a[210:211], v8 offset:26144
  ds_read_b64_tr_b16 a[212:213], v8 offset:24640
  ds_read_b64_tr_b16 a[214:215], v8 offset:26176
  ds_read_b64_tr_b16 a[216:217], v8 offset:36864
  ds_read_b64_tr_b16 a[218:219], v8 offset:38400
  ds_read_b64_tr_b16 a[220:221], v8 offset:36896
  ds_read_b64_tr_b16 a[222:223], v8 offset:38432
  ds_read_b64_tr_b16 a[224:225], v8 offset:36928
  ds_read_b64_tr_b16 a[226:227], v8 offset:38464
  ds_read_b64_tr_b16 a[228:229], v8 offset:49152
  ds_read_b64_tr_b16 a[230:231], v8 offset:50688
  ds_read_b64_tr_b16 a[232:233], v8 offset:49184
  ds_read_b64_tr_b16 a[234:235], v8 offset:50720
  ds_read_b64_tr_b16 a[236:237], v8 offset:49216
  ds_read_b64_tr_b16 a[238:239], v8 offset:50752
  s_waitcnt lgkmcnt(0)
  s_barrier
  s_mul_i32 s21, s20, 12800
  s_add_u32 s21, s21, 98304
  v_mul_u32_u24 v4, 400, v2
  v_lshlrev_b32 v5, 4, v3
  v_add3_u32 v29, v4, v5, s21
  v_lshlrev_b32 v30, 4, v1
  v_and_b32 v4, 1, v2
  v_bfe_u32 v5, v2, 1, 1
  v_lshl_or_b32 v4, v5, 2, v4
  v_bfe_u32 v5, v2, 2, 1
  v_lshl_or_b32 v4, v5, 1, v4
  v_lshlrev_b32 v4, 4, v4
  v_lshl_add_u32 v31, v3, 7, v4
  v_lshlrev_b32 v32, 3, v1
  v_and_b32 v4, 3, v1
  v_lshlrev_b32 v33, 3, v4
  v_mov_b32 v34, 0xf149f2ca
  v_lshlrev_b32 v4, 2, v3
  v_sub_u32 v35, v2, v4
  v_cmp_gt_u32 s[60:61], 2, v3
  s_mov_b32 s62, 0x3d93cd3a
  s_mov_b32 s63, 0x3fb8aa3b
  s_mov_b32 s83, 0x3dd53b95
  v_cmp_le_i32 s[64:65], 0, v35
  v_cmp_le_i32 s[66:67], 1, v35
  v_cmp_le_i32 s[68:69], 2, v35
  v_cmp_le_i32 s[70:71], 3, v35
  s_mov_b32 s24, 0
  s_mov_b32 s25, 163840
  s_mov_b32 s26, 12
  s_lshl_b32 s49, s41, 2
  s_add_u32 s49, s49, s20
  s_mov_b32 s29, 4
  s_mov_b32 s78, 0
  s_mov_b32 s81, 0x80000000
  s_mov_b32 s82, 0
  v_lshrrev_b32 v11, 3, v1
  v_and_b32 v12, 7, v1
  v_xor_b32 v12, v12, v11
  v_mul_u32_u24 v11, 1280, v11
  v_lshl_add_u32 v10, v12, 4, v11
  s_mul_i32 s46, s20, 40960
  v_add_u32 v10, s46, v10
  s_lshl_b32 s47, s20, 12
  s_add_u32 s47, s47, 0
  s_add_u32 s46, s47, 98304
  s_mov_b32 s30, s24
  s_add_u32 s32, s47, 0
  v_add_u32 v11, 9216, v10
  v_add_u32 v12, 18432, v10
  v_add_u32 v13, 27648, v10
  s_mov_b32 m0, s32
  s_nop 0
  buffer_load_dwordx4 v10, s[8:11], s30 offen offset:0 lds
  buffer_load_dwordx4 v11, s[8:11], s30 offen offset:1024 lds
  buffer_load_dwordx4 v12, s[8:11], s30 offen offset:2048 lds
  buffer_load_dwordx4 v13, s[8:11], s30 offen offset:3072 lds
  s_add_u32 s30, s30, 128
  s_add_u32 s32, s32, 16384
  s_cmp_lt_u32 s32, s46
  s_cselect_b32 s32, s32, s47
  s_mov_b32 m0, s32
  s_nop 0
  buffer_load_dwordx4 v10, s[8:11], s30 offen offset:0 lds
  buffer_load_dwordx4 v11, s[8:11], s30 offen offset:1024 lds
  buffer_load_dwordx4 v12, s[8:11], s30 offen offset:2048 lds
  buffer_load_dwordx4 v13, s[8:11], s30 offen offset:3072 lds
  s_add_u32 s30, s30, 128
  s_add_u32 s32, s32, 16384
  s_cmp_lt_u32 s32, s46
  s_cselect_b32 s32, s32, s47
  s_mov_b32 m0, s32
  s_nop 0
  buffer_load_dwordx4 v10, s[8:11], s30 offen offset:0 lds
  buffer_load_dwordx4 v11, s[8:11], s30 offen offset:1024 lds
  buffer_load_dwordx4 v12, s[8:11], s30 offen offset:2048 lds
  buffer_load_dwordx4 v13, s[8:11], s30 offen offset:3072 lds
  s_add_u32 s30, s30, 128
  s_add_u32 s32, s32, 16384
  s_cmp_lt_u32 s32, s46
  s_cselect_b32 s32, s32, s47
  s_mov_b32 m0, s32
  s_nop 0
  buffer_load_dwordx4 v10, s[8:11], s30 offen offset:0 lds
  buffer_load_dwordx4 v11, s[8:11], s30 offen offset:1024 lds
  buffer_load_dwordx4 v12, s[8:11], s30 offen offset:2048 lds
  buffer_load_dwordx4 v13, s[8:11], s30 offen offset:3072 lds
  s_add_u32 s30, s30, 128
  s_add_u32 s32, s32, 16384
  s_cmp_lt_u32 s32, s46
  s_cselect_b32 s32, s32, s47
  v_and_b32 v6, 7, v2
  v_add_u32 v4, 0, v3
  v_xor_b32 v4, v4, v6
  v_lshlrev_b32 v4, 4, v4
  v_lshl_add_u32 v14, v2, 7, v4
  v_add_u32 v4, 4, v3
  v_xor_b32 v4, v4, v6
  v_lshlrev_b32 v4, 4, v4
  v_lshl_add_u32 v15, v2, 7, v4
  v_mul_u32_u24 v22, 400, v2
  v_mul_u32_u24 v4, 16, v3
  s_mul_i32 s21, s20, 96
  s_add_u32 s21, s21, 98304
  v_add3_u32 v22, v22, v4, s21
  v_lshlrev_b32 v4, 3, v3
  v_sub_u32 v16, v22, v4
  v_mov_b32 v9, 2731
  s_mov_b32 s33, 0
  s_mov_b32 s48, 0x80000000
  s_mov_b32 m0, s32
  s_nop 0
  buffer_load_dwordx4 v10, s[8:11], s30 offen offset:0 lds
  buffer_load_dwordx4 v11, s[8:11], s30 offen offset:1024 lds
  s_waitcnt vmcnt(14)
  s_barrier
  v_add_u32 v18, s33, v14
  v_add_u32 v19, s33, v15
  s_add_u32 s33, s33, 16384
  s_cmp_lt_u32 s33, 98304
  s_cselect_b32 s33, s33, 0
  ds_read_b128 v[160:163], v18 offset:0
  ds_read_b128 v[164:167], v18 offset:2048
  ds_read_b128 v[168:171], v18 offset:4096
  ds_read_b128 v[172:175], v18 offset:6144
  ds_read_b128 v[176:179], v18 offset:8192
  ds_read_b128 v[180:183], v18 offset:10240
  ds_read_b128 v[184:187], v18 offset:12288
  ds_read_b128 v[188:191], v18 offset:14336
  s_waitcnt lgkmcnt(0)
qa_blk_214:
  v_mfma_f32_16x16x32_bf16 v[64:67], a[0:3], v[160:163], 0
  ds_read_b128 v[192:195], v19 offset:0
  v_mfma_f32_16x16x32_bf16 v[68:71], a[4:7], v[160:163], 0
  v_add_u32 v18, s33, v14
  v_cndmask_b32 v36, v34, v36, s[64:65]
  v_mfma_f32_16x16x32_bf16 v[72:75], a[8:11], v[160:163], 0
  v_cndmask_b32 v48, v34, v48, s[64:65]
  v_cndmask_b32 v37, v34, v37, s[66:67]
  v_mfma_f32_16x16x32_bf16 v[76:79], a[0:3], v[164:167], 0
  ds_read_b128 v[196:199], v19 offset:2048
  v_cndmask_b32 v49, v34, v49, s[66:67]
  v_mfma_f32_16x16x32_bf16 v[80:83], a[4:7], v[164:167], 0
  buffer_load_dwordx4 v12, s[8:11], s30 offen offset:2048 lds
  v_mfma_f32_16x16x32_bf16 v[84:87], a[8:11], v[164:167], 0
  v_cndmask_b32 v38, v34, v38, s[68:69]
  v_cndmask_b32 v50, v34, v50, s[68:69]
  v_mfma_f32_16x16x32_bf16 v[88:91], a[0:3], v[168:171], 0
  ds_read_b128 v[200:203], v19 offset:4096
  v_cndmask_b32 v39, v34, v39, s[70:71]
  v_mfma_f32_16x16x32_bf16 v[92:95], a[4:7], v[168:171], 0
  v_cndmask_b32 v51, v34, v51, s[70:71]
  v_max3_f32 v56, v36, v37, v38
  v_mfma_f32_16x16x32_bf16 v[96:99], a[8:11], v[168:171], 0
  v_max3_f32 v56, v56, v39, v40
  v_max3_f32 v56, v56, v41, v42
  v_mfma_f32_16x16x32_bf16 v[100:103], a[0:3], v[172:175], 0
  ds_read_b128 v[204:207], v19 offset:6144
  v_max_f32 v56, v56, v43
  v_mfma_f32_16x16x32_bf16 v[104:107], a[4:7], v[172:175], 0
  v_mov_b32 v57, v56
  v_mfma_f32_16x16x32_bf16 v[108:111], a[8:11], v[172:175], 0
  s_waitcnt lgkmcnt(15)
  v_mfma_f32_16x16x32_bf16 v[112:115], a[0:3], v[176:179], 0
  ds_read_b128 v[208:211], v19 offset:8192
  v_mfma_f32_16x16x32_bf16 v[116:119], a[4:7], v[176:179], 0
  s_nop 1
  v_mfma_f32_16x16x32_bf16 v[120:123], a[8:11], v[176:179], 0
  v_permlane32_swap_b32 v56, v57
  v_mfma_f32_16x16x32_bf16 v[124:127], a[0:3], v[180:183], 0
  ds_read_b128 v[212:215], v19 offset:10240
  v_max_f32 v56, v56, v57
  v_mfma_f32_16x16x32_bf16 v[128:131], a[4:7], v[180:183], 0
  buffer_load_dwordx4 v13, s[8:11], s30 offen offset:3072 lds
  v_mfma_f32_16x16x32_bf16 v[132:135], a[8:11], v[180:183], 0
  s_add_u32 s30, s30, 128
  s_add_u32 m0, m0, 16384
  v_mfma_f32_16x16x32_bf16 v[136:139], a[0:3], v[184:187], 0
  ds_read_b128 v[216:219], v19 offset:12288
  v_mov_b32 v57, v56
  v_mfma_f32_16x16x32_bf16 v[140:143], a[4:7], v[184:187], 0
  s_cmp_lt_u32 m0, s46
  s_cselect_b32 m0, m0, s47
  v_mfma_f32_16x16x32_bf16 v[144:147], a[8:11], v[184:187], 0
  s_nop 1
  v_mfma_f32_16x16x32_bf16 v[148:151], a[0:3], v[188:191], 0
  ds_read_b128 v[220:223], v19 offset:14336
  v_mfma_f32_16x16x32_bf16 v[152:155], a[4:7], v[188:191], 0
  v_permlane16_swap_b32 v56, v57
  v_mfma_f32_16x16x32_bf16 v[156:159], a[8:11], v[188:191], 0
  s_waitcnt vmcnt(12) lgkmcnt(4)
  s_barrier
  v_mfma_f32_16x16x32_bf16 v[64:67], a[12:15], v[192:195], v[64:67]
  ds_read_b128 v[160:163], v18 offset:0
  v_max_f32 v56, v56, v57
  v_mfma_f32_16x16x32_bf16 v[68:71], a[16:19], v[192:195], v[68:71]
  v_mul_f32 v56, s83, v56
  v_fma_f32 v36, v36, s83, -v56
  v_mfma_f32_16x16x32_bf16 v[72:75], a[20:23], v[192:195], v[72:75]
  v_add_u32 v19, s33, v15
  s_add_u32 s33, s33, 16384
  v_mfma_f32_16x16x32_bf16 v[76:79], a[12:15], v[196:199], v[76:79]
  ds_read_b128 v[164:167], v18 offset:2048
  v_fma_f32 v37, v37, s83, -v56
  v_mfma_f32_16x16x32_bf16 v[80:83], a[16:19], v[196:199], v[80:83]
  buffer_load_dwordx4 v10, s[8:11], s30 offen offset:0 lds
  v_mfma_f32_16x16x32_bf16 v[84:87], a[20:23], v[196:199], v[84:87]
  s_cmp_lt_u32 s33, 98304
  s_cselect_b32 s33, s33, 0
  v_mfma_f32_16x16x32_bf16 v[88:91], a[12:15], v[200:203], v[88:91]
  ds_read_b128 v[168:171], v18 offset:4096
  v_fma_f32 v38, v38, s83, -v56
  v_mfma_f32_16x16x32_bf16 v[92:95], a[16:19], v[200:203], v[92:95]
  v_fma_f32 v39, v39, s83, -v56
  v_fma_f32 v40, v40, s83, -v56
  v_mfma_f32_16x16x32_bf16 v[96:99], a[20:23], v[200:203], v[96:99]
  v_fma_f32 v41, v41, s83, -v56
  v_fma_f32 v42, v42, s83, -v56
  v_mfma_f32_16x16x32_bf16 v[100:103], a[12:15], v[204:207], v[100:103]
  ds_read_b128 v[172:175], v18 offset:6144
  v_fma_f32 v43, v43, s83, -v56
  v_mfma_f32_16x16x32_bf16 v[104:107], a[16:19], v[204:207], v[104:107]
  v_exp_f32 v36, v36
  v_mfma_f32_16x16x32_bf16 v[108:111], a[20:23], v[204:207], v[108:111]
  s_waitcnt lgkmcnt(4)
  v_mfma_f32_16x16x32_bf16 v[112:115], a[12:15], v[208:211], v[112:115]
  ds_read_b128 v[176:179], v18 offset:8192
  v_mfma_f32_16x16x32_bf16 v[116:119], a[16:19], v[208:211], v[116:119]
  v_exp_f32 v37, v37
  v_mfma_f32_16x16x32_bf16 v[120:123], a[20:23], v[208:211], v[120:123]
  v_exp_f32 v38, v38
  v_mfma_f32_16x16x32_bf16 v[124:127], a[12:15], v[212:215], v[124:127]
  ds_read_b128 v[180:183], v18 offset:10240
  v_mfma_f32_16x16x32_bf16 v[128:131], a[16:19], v[212:215], v[128:131]
  buffer_load_dwordx4 v11, s[8:11], s30 offen offset:1024 lds
  v_mfma_f32_16x16x32_bf16 v[132:135], a[20:23], v[212:215], v[132:135]
  v_exp_f32 v39, v39
  v_mfma_f32_16x16x32_bf16 v[136:139], a[12:15], v[216:219], v[136:139]
  ds_read_b128 v[184:187], v18 offset:12288
  v_mfma_f32_16x16x32_bf16 v[140:143], a[16:19], v[216:219], v[140:143]
  v_exp_f32 v40, v40
  v_mfma_f32_16x16x32_bf16 v[144:147], a[20:23], v[216:219], v[144:147]
  v_exp_f32 v41, v41
  v_mfma_f32_16x16x32_bf16 v[148:151], a[12:15], v[220:223], v[148:151]
  ds_read_b128 v[188:191], v18 offset:14336
  v_mfma_f32_16x16x32_bf16 v[152:155], a[16:19], v[220:223], v[152:155]
  v_exp_f32 v42, v42
  v_mfma_f32_16x16x32_bf16 v[156:159], a[20:23], v[220:223], v[156:159]
  s_waitcnt lgkmcnt(4)
  v_mfma_f32_16x16x32_bf16 v[64:67], a[24:27], v[160:163], v[64:67]
  ds_read_b128 v[192:195], v19 offset:0
  v_mfma_f32_16x16x32_bf16 v[68:71], a[28:31], v[160:163], v[68:71]
  v_add_u32 v18, s33, v14
  v_mfma_f32_16x16x32_bf16 v[72:75], a[32:35], v[160:163], v[72:75]
  v_exp_f32 v43, v43
  v_mfma_f32_16x16x32_bf16 v[76:79], a[24:27], v[164:167], v[76:79]
  ds_read_b128 v[196:199], v19 offset:2048
  s_nop 0
  v_mfma_f32_16x16x32_bf16 v[80:83], a[28:31], v[164:167], v[80:83]
  buffer_load_dwordx4 v12, s[8:11], s30 offen offset:2048 lds
  v_mfma_f32_16x16x32_bf16 v[84:87], a[32:35], v[164:167], v[84:87]
  v_add_f32 v56, v40, v41
  v_add_f32 v56, v56, v42
  v_mfma_f32_16x16x32_bf16 v[88:91], a[24:27], v[168:171], v[88:91]
  ds_read_b128 v[200:203], v19 offset:4096
  v_add_f32 v56, v56, v43
  v_mfma_f32_16x16x32_bf16 v[92:95], a[28:31], v[168:171], v[92:95]
  v_cndmask_b32 v56, 0, v56, s[60:61]
  v_add_f32 v56, v56, v36
  v_mfma_f32_16x16x32_bf16 v[96:99], a[32:35], v[168:171], v[96:99]
  v_add_f32 v56, v56, v37
  v_add_f32 v56, v56, v38
  v_mfma_f32_16x16x32_bf16 v[100:103], a[24:27], v[172:175], v[100:103]
  ds_read_b128 v[204:207], v19 offset:6144
  v_add_f32 v56, v56, v39
  v_mfma_f32_16x16x32_bf16 v[104:107], a[28:31], v[172:175], v[104:107]
  v_mov_b32 v57, v56
  v_mfma_f32_16x16x32_bf16 v[108:111], a[32:35], v[172:175], v[108:111]
  s_waitcnt lgkmcnt(4)
  v_mfma_f32_16x16x32_bf16 v[112:115], a[24:27], v[176:179], v[112:115]
  ds_read_b128 v[208:211], v19 offset:8192
  v_mfma_f32_16x16x32_bf16 v[116:119], a[28:31], v[176:179], v[116:119]
  s_nop 1
  v_mfma_f32_16x16x32_bf16 v[120:123], a[32:35], v[176:179], v[120:123]
  v_permlane32_swap_b32 v56, v57
  v_mfma_f32_16x16x32_bf16 v[124:127], a[24:27], v[180:183], v[124:127]
  ds_read_b128 v[212:215], v19 offset:10240
  v_add_f32 v56, v56, v57
  v_mfma_f32_16x16x32_bf16 v[128:131], a[28:31], v[180:183], v[128:131]
  buffer_load_dwordx4 v13, s[8:11], s30 offen offset:3072 lds
  v_mfma_f32_16x16x32_bf16 v[132:135], a[32:35], v[180:183], v[132:135]
  s_add_u32 s30, s30, 128
  s_add_u32 m0, m0, 16384
  v_mfma_f32_16x16x32_bf16 v[136:139], a[24:27], v[184:187], v[136:139]
  ds_read_b128 v[216:219], v19 offset:12288
  v_mov_b32 v57, v56
  v_mfma_f32_16x16x32_bf16 v[140:143], a[28:31], v[184:187], v[140:143]
  s_cmp_lt_u32 m0, s46
  s_cselect_b32 m0, m0, s47
  v_mfma_f32_16x16x32_bf16 v[144:147], a[32:35], v[184:187], v[144:147]
  s_nop 1
  v_mfma_f32_16x16x32_bf16 v[148:151], a[24:27], v[188:191], v[148:151]
  ds_read_b128 v[220:223], v19 offset:14336
  v_mfma_f32_16x16x32_bf16 v[152:155], a[28:31], v[188:191], v[152:155]
  v_permlane16_swap_b32 v56, v57
  v_mfma_f32_16x16x32_bf16 v[156:159], a[32:35], v[188:191], v[156:159]
  s_waitcnt vmcnt(12) lgkmcnt(4)
  s_barrier
  v_mfma_f32_16x16x32_bf16 v[64:67], a[36:39], v[192:195], v[64:67]
  ds_read_b128 v[160:163], v18 offset:0
  v_add_f32 v56, v56, v57
  v_mfma_f32_16x16x32_bf16 v[68:71], a[40:43], v[192:195], v[68:71]
  v_rcp_f32 v56, v56
  v_mfma_f32_16x16x32_bf16 v[72:75], a[44:47], v[192:195], v[72:75]
  v_add_u32 v19, s33, v15
  s_add_u32 s33, s33, 16384
  v_mfma_f32_16x16x32_bf16 v[76:79], a[36:39], v[196:199], v[76:79]
  ds_read_b128 v[164:167], v18 offset:2048
  s_nop 0
  v_mfma_f32_16x16x32_bf16 v[80:83], a[40:43], v[196:199], v[80:83]
  buffer_load_dwordx4 v10, s[8:11], s30 offen offset:0 lds
  v_mfma_f32_16x16x32_bf16 v[84:87], a[44:47], v[196:199], v[84:87]
  s_cmp_lt_u32 s33, 98304
  s_cselect_b32 s33, s33, 0
  v_mfma_f32_16x16x32_bf16 v[88:91], a[36:39], v[200:203], v[88:91]
  ds_read_b128 v[168:171], v18 offset:4096
  v_mul_f32 v36, v36, v56
  v_mfma_f32_16x16x32_bf16 v[92:95], a[40:43], v[200:203], v[92:95]
  v_mul_f32 v37, v37, v56
  v_mul_f32 v38, v38, v56
  v_mfma_f32_16x16x32_bf16 v[96:99], a[44:47], v[200:203], v[96:99]
  v_mul_f32 v39, v39, v56
  v_mul_f32 v40, v40, v56
  v_mfma_f32_16x16x32_bf16 v[100:103], a[36:39], v[204:207], v[100:103]
  ds_read_b128 v[172:175], v18 offset:6144
  v_mul_f32 v41, v41, v56
  v_mfma_f32_16x16x32_bf16 v[104:107], a[40:43], v[204:207], v[104:107]
  v_mul_f32 v42, v42, v56
  v_mul_f32 v43, v43, v56
  v_mfma_f32_16x16x32_bf16 v[108:111], a[44:47], v[204:207], v[108:111]
  s_waitcnt lgkmcnt(4)
  v_max3_f32 v56, v44, v45, v46
  v_mfma_f32_16x16x32_bf16 v[112:115], a[36:39], v[208:211], v[112:115]
  ds_read_b128 v[176:179], v18 offset:8192
  v_max3_f32 v56, v56, v47, v48
  v_mfma_f32_16x16x32_bf16 v[116:119], a[40:43], v[208:211], v[116:119]
  v_max3_f32 v56, v56, v49, v50
  v_max3_f32 v56, v56, v51, v52
  v_mfma_f32_16x16x32_bf16 v[120:123], a[44:47], v[208:211], v[120:123]
  v_max3_f32 v56, v56, v53, v54
  v_max_f32 v56, v56, v55
  v_mfma_f32_16x16x32_bf16 v[124:127], a[36:39], v[212:215], v[124:127]
  ds_read_b128 v[180:183], v18 offset:10240
  v_mov_b32 v57, v56
  v_mfma_f32_16x16x32_bf16 v[128:131], a[40:43], v[212:215], v[128:131]
  buffer_load_dwordx4 v11, s[8:11], s30 offen offset:1024 lds
  v_mfma_f32_16x16x32_bf16 v[132:135], a[44:47], v[212:215], v[132:135]
  s_nop 1
  v_mfma_f32_16x16x32_bf16 v[136:139], a[36:39], v[216:219], v[136:139]
  ds_read_b128 v[184:187], v18 offset:12288
  v_mfma_f32_16x16x32_bf16 v[140:143], a[40:43], v[216:219], v[140:143]
  v_permlane32_swap_b32 v56, v57
  v_mfma_f32_16x16x32_bf16 v[144:147], a[44:47], v[216:219], v[144:147]
  v_max_f32 v56, v56, v57
  v_mov_b32 v57, v56
  v_mfma_f32_16x16x32_bf16 v[148:151], a[36:39], v[220:223], v[148:151]
  ds_read_b128 v[188:191], v18 offset:14336
  v_mfma_f32_16x16x32_bf16 v[152:155], a[40:43], v[220:223], v[152:155]
  s_nop 1
  v_mfma_f32_16x16x32_bf16 v[156:159], a[44:47], v[220:223], v[156:159]
  s_waitcnt lgkmcnt(4)
  v_mfma_f32_16x16x32_bf16 v[64:67], a[48:51], v[160:163], v[64:67]
  ds_read_b128 v[192:195], v19 offset:0
  v_mfma_f32_16x16x32_bf16 v[68:71], a[52:55], v[160:163], v[68:71]
  v_add_u32 v18, s33, v14
  v_mfma_f32_16x16x32_bf16 v[72:75], a[56:59], v[160:163], v[72:75]
  v_permlane16_swap_b32 v56, v57
  v_mfma_f32_16x16x32_bf16 v[76:79], a[48:51], v[164:167], v[76:79]
  ds_read_b128 v[196:199], v19 offset:2048
  v_max_f32 v56, v56, v57
  v_mfma_f32_16x16x32_bf16 v[80:83], a[52:55], v[164:167], v[80:83]
  buffer_load_dwordx4 v12, s[8:11], s30 offen offset:2048 lds
  v_mfma_f32_16x16x32_bf16 v[84:87], a[56:59], v[164:167], v[84:87]
  v_mul_f32 v56, s83, v56
  v_fma_f32 v44, v44, s83, -v56
  v_mfma_f32_16x16x32_bf16 v[88:91], a[48:51], v[168:171], v[88:91]
  ds_read_b128 v[200:203], v19 offset:4096
  v_fma_f32 v45, v45, s83, -v56
  v_mfma_f32_16x16x32_bf16 v[92:95], a[52:55], v[168:171], v[92:95]
  v_fma_f32 v46, v46, s83, -v56
  v_fma_f32 v47, v47, s83, -v56
  v_mfma_f32_16x16x32_bf16 v[96:99], a[56:59], v[168:171], v[96:99]
  v_fma_f32 v48, v48, s83, -v56
  v_fma_f32 v49, v49, s83, -v56
  v_mfma_f32_16x16x32_bf16 v[100:103], a[48:51], v[172:175], v[100:103]
  ds_read_b128 v[204:207], v19 offset:6144
  v_fma_f32 v50, v50, s83, -v56
  v_mfma_f32_16x16x32_bf16 v[104:107], a[52:55], v[172:175], v[104:107]
  v_fma_f32 v51, v51, s83, -v56
  v_fma_f32 v52, v52, s83, -v56
  v_mfma_f32_16x16x32_bf16 v[108:111], a[56:59], v[172:175], v[108:111]
  s_waitcnt lgkmcnt(4)
  v_fma_f32 v53, v53, s83, -v56
  v_mfma_f32_16x16x32_bf16 v[112:115], a[48:51], v[176:179], v[112:115]
  ds_read_b128 v[208:211], v19 offset:8192
  v_fma_f32 v54, v54, s83, -v56
  v_mfma_f32_16x16x32_bf16 v[116:119], a[52:55], v[176:179], v[116:119]
  v_fma_f32 v55, v55, s83, -v56
  v_mfma_f32_16x16x32_bf16 v[120:123], a[56:59], v[176:179], v[120:123]
  v_exp_f32 v44, v44
  v_mfma_f32_16x16x32_bf16 v[124:127], a[48:51], v[180:183], v[124:127]
  ds_read_b128 v[212:215], v19 offset:10240
  v_mfma_f32_16x16x32_bf16 v[128:131], a[52:55], v[180:183], v[128:131]
  buffer_load_dwordx4 v13, s[8:11], s30 offen offset:3072 lds
  v_mfma_f32_16x16x32_bf16 v[132:135], a[56:59], v[180:183], v[132:135]
  s_add_u32 s30, s30, 128
  s_add_u32 m0, m0, 16384
  v_mfma_f32_16x16x32_bf16 v[136:139], a[48:51], v[184:187], v[136:139]
  ds_read_b128 v[216:219], v19 offset:12288
  v_mfma_f32_16x16x32_bf16 v[140:143], a[52:55], v[184:187], v[140:143]
  s_cmp_lt_u32 m0, s46
  s_cselect_b32 m0, m0, s47
  v_mfma_f32_16x16x32_bf16 v[144:147], a[56:59], v[184:187], v[144:147]
  v_exp_f32 v45, v45
  v_mfma_f32_16x16x32_bf16 v[148:151], a[48:51], v[188:191], v[148:151]
  ds_read_b128 v[220:223], v19 offset:14336
  v_mfma_f32_16x16x32_bf16 v[152:155], a[52:55], v[188:191], v[152:155]
  v_exp_f32 v46, v46
  v_mfma_f32_16x16x32_bf16 v[156:159], a[56:59], v[188:191], v[156:159]
  s_waitcnt vmcnt(12) lgkmcnt(4)
  s_barrier
  v_mfma_f32_16x16x32_bf16 v[64:67], a[60:63], v[192:195], v[64:67]
  ds_read_b128 v[160:163], v18 offset:0
  v_mfma_f32_16x16x32_bf16 v[68:71], a[64:67], v[192:195], v[68:71]
  s_waitcnt vmcnt(10)
  s_cmp_eq_u32 s78, 0
  s_cbranch_scc1 pf_212
  v_mov_b32 v4, 0
  v_mov_b32 v5, 1
  s_mov_b64 exec, 1
  buffer_atomic_add v5, v4, s[72:75], s78 offen sc1
  s_mov_b64 exec, -1
  s_mov_b32 s78, 0
pf_212:
  s_mul_i32 s21, s49, 393216
  s_mul_i32 s22, s42, 12288
  s_add_u32 s50, s21, s22
  s_mul_i32 s21, s49, 98304
  s_mul_i32 s22, s42, 3072
  s_add_u32 s51, s21, s22
  s_lshr_b32 s22, s49, 1
  s_lshr_b32 s21, s49, 2
  s_add_u32 s21, s21, 3
  s_cmp_lt_u32 s49, 12
  s_cselect_b32 s21, s22, s21
  s_lshl_b32 s21, s21, 3
  s_lshr_b32 s22, s42, 2
  s_add_u32 s21, s21, s22
  s_lshl_b32 s21, s21, 7
  s_add_u32 s76, s21, 0
  s_lshl_b32 s77, s42, 7
  s_add_u32 s77, s77, 19456
  v_mov_b32 v4, 0
  buffer_load_dword v20, v4, s[72:75], s76 offen sc1
  v_mfma_f32_16x16x32_bf16 v[72:75], a[68:71], v[192:195], v[72:75]
  v_add_u32 v19, s33, v15
  s_add_u32 s33, s33, 16384
  v_mfma_f32_16x16x32_bf16 v[76:79], a[60:63], v[196:199], v[76:79]
  ds_read_b128 v[164:167], v18 offset:2048
  v_mfma_f32_16x16x32_bf16 v[80:83], a[64:67], v[196:199], v[80:83]
  buffer_load_dwordx4 v10, s[8:11], s30 offen offset:0 lds
  v_mfma_f32_16x16x32_bf16 v[84:87], a[68:71], v[196:199], v[84:87]
  s_cmp_lt_u32 s33, 98304
  s_cselect_b32 s33, s33, 0
  v_mfma_f32_16x16x32_bf16 v[88:91], a[60:63], v[200:203], v[88:91]
  ds_read_b128 v[168:171], v18 offset:4096
  v_mfma_f32_16x16x32_bf16 v[92:95], a[64:67], v[200:203], v[92:95]
  v_exp_f32 v47, v47
  v_mfma_f32_16x16x32_bf16 v[96:99], a[68:71], v[200:203], v[96:99]
  v_exp_f32 v48, v48
  v_mfma_f32_16x16x32_bf16 v[100:103], a[60:63], v[204:207], v[100:103]
  ds_read_b128 v[172:175], v18 offset:6144
  v_mfma_f32_16x16x32_bf16 v[104:107], a[64:67], v[204:207], v[104:107]
  v_exp_f32 v49, v49
  v_mfma_f32_16x16x32_bf16 v[108:111], a[68:71], v[204:207], v[108:111]
  s_waitcnt lgkmcnt(4)
  v_mfma_f32_16x16x32_bf16 v[112:115], a[60:63], v[208:211], v[112:115]
  ds_read_b128 v[176:179], v18 offset:8192
  v_mfma_f32_16x16x32_bf16 v[116:119], a[64:67], v[208:211], v[116:119]
  v_exp_f32 v50, v50
  v_mfma_f32_16x16x32_bf16 v[120:123], a[68:71], v[208:211], v[120:123]
  v_exp_f32 v51, v51
  v_mfma_f32_16x16x32_bf16 v[124:127], a[60:63], v[212:215], v[124:127]
  ds_read_b128 v[180:183], v18 offset:10240
  v_mfma_f32_16x16x32_bf16 v[128:131], a[64:67], v[212:215], v[128:131]
  buffer_load_dwordx4 v11, s[8:11], s30 offen offset:1024 lds
  v_mfma_f32_16x16x32_bf16 v[132:135], a[68:71], v[212:215], v[132:135]
  v_exp_f32 v52, v52
  v_mfma_f32_16x16x32_bf16 v[136:139], a[60:63], v[216:219], v[136:139]
  ds_read_b128 v[184:187], v18 offset:12288
  v_mfma_f32_16x16x32_bf16 v[140:143], a[64:67], v[216:219], v[140:143]
  v_exp_f32 v53, v53
  v_mfma_f32_16x16x32_bf16 v[144:147], a[68:71], v[216:219], v[144:147]
  v_exp_f32 v54, v54
  v_mfma_f32_16x16x32_bf16 v[148:151], a[60:63], v[220:223], v[148:151]
  ds_read_b128 v[188:191], v18 offset:14336
  v_mfma_f32_16x16x32_bf16 v[152:155], a[64:67], v[220:223], v[152:155]
  v_exp_f32 v55, v55
  v_mfma_f32_16x16x32_bf16 v[156:159], a[68:71], v[220:223], v[156:159]
  s_waitcnt lgkmcnt(4)
  s_nop 0
  v_mfma_f32_16x16x32_bf16 v[64:67], a[72:75], v[160:163], v[64:67]
  ds_read_b128 v[192:195], v19 offset:0
  v_add_f32 v56, v52, v53
  v_mfma_f32_16x16x32_bf16 v[68:71], a[76:79], v[160:163], v[68:71]
  v_add_u32 v18, s33, v14
  v_add_f32 v56, v56, v54
  v_mfma_f32_16x16x32_bf16 v[72:75], a[80:83], v[160:163], v[72:75]
  v_add_f32 v56, v56, v55
  v_cndmask_b32 v56, 0, v56, s[60:61]
  v_mfma_f32_16x16x32_bf16 v[76:79], a[72:75], v[164:167], v[76:79]
  ds_read_b128 v[196:199], v19 offset:2048
  v_add_f32 v56, v56, v44
  v_mfma_f32_16x16x32_bf16 v[80:83], a[76:79], v[164:167], v[80:83]
  buffer_load_dwordx4 v12, s[8:11], s30 offen offset:2048 lds
  v_mfma_f32_16x16x32_bf16 v[84:87], a[80:83], v[164:167], v[84:87]
  v_add_f32 v56, v56, v45
  v_add_f32 v56, v56, v46
  v_mfma_f32_16x16x32_bf16 v[88:91], a[72:75], v[168:171], v[88:91]
  ds_read_b128 v[200:203], v19 offset:4096
  v_add_f32 v56, v56, v47
  v_mfma_f32_16x16x32_bf16 v[92:95], a[76:79], v[168:171], v[92:95]
  v_add_f32 v56, v56, v48
  v_add_f32 v56, v56, v49
  v_mfma_f32_16x16x32_bf16 v[96:99], a[80:83], v[168:171], v[96:99]
  v_add_f32 v56, v56, v50
  v_add_f32 v56, v56, v51
  v_mfma_f32_16x16x32_bf16 v[100:103], a[72:75], v[172:175], v[100:103]
  ds_read_b128 v[204:207], v19 offset:6144
  v_mov_b32 v57, v56
  v_mfma_f32_16x16x32_bf16 v[104:107], a[76:79], v[172:175], v[104:107]
  s_nop 1
  v_mfma_f32_16x16x32_bf16 v[108:111], a[80:83], v[172:175], v[108:111]
  s_waitcnt lgkmcnt(4)
  v_mfma_f32_16x16x32_bf16 v[112:115], a[72:75], v[176:179], v[112:115]
  ds_read_b128 v[208:211], v19 offset:8192
  v_mfma_f32_16x16x32_bf16 v[116:119], a[76:79], v[176:179], v[116:119]
  v_permlane32_swap_b32 v56, v57
  v_mfma_f32_16x16x32_bf16 v[120:123], a[80:83], v[176:179], v[120:123]
  v_add_f32 v56, v56, v57
  v_mov_b32 v57, v56
  v_mfma_f32_16x16x32_bf16 v[124:127], a[72:75], v[180:183], v[124:127]
  ds_read_b128 v[212:215], v19 offset:10240
  v_mfma_f32_16x16x32_bf16 v[128:131], a[76:79], v[180:183], v[128:131]
  buffer_load_dwordx4 v13, s[8:11], s30 offen offset:3072 lds
  v_mfma_f32_16x16x32_bf16 v[132:135], a[80:83], v[180:183], v[132:135]
  s_add_u32 s30, s30, 128
  s_add_u32 m0, m0, 16384
  v_mfma_f32_16x16x32_bf16 v[136:139], a[72:75], v[184:187], v[136:139]
  ds_read_b128 v[216:219], v19 offset:12288
  v_mfma_f32_16x16x32_bf16 v[140:143], a[76:79], v[184:187], v[140:143]
  s_cmp_lt_u32 m0, s46
  s_cselect_b32 m0, m0, s47
  v_mfma_f32_16x16x32_bf16 v[144:147], a[80:83], v[184:187], v[144:147]
  s_nop 1
  v_mfma_f32_16x16x32_bf16 v[148:151], a[72:75], v[188:191], v[148:151]
  ds_read_b128 v[220:223], v19 offset:14336
  v_mfma_f32_16x16x32_bf16 v[152:155], a[76:79], v[188:191], v[152:155]
  v_permlane16_swap_b32 v56, v57
  v_mfma_f32_16x16x32_bf16 v[156:159], a[80:83], v[188:191], v[156:159]
  s_waitcnt vmcnt(13) lgkmcnt(4)
  s_barrier
  v_mfma_f32_16x16x32_bf16 v[64:67], a[84:87], v[192:195], v[64:67]
  ds_read_b128 v[160:163], v18 offset:0
  v_add_f32 v56, v56, v57
  v_mfma_f32_16x16x32_bf16 v[68:71], a[88:91], v[192:195], v[68:71]
  v_rcp_f32 v56, v56
  v_mfma_f32_16x16x32_bf16 v[72:75], a[92:95], v[192:195], v[72:75]
  v_add_u32 v19, s33, v15
  s_add_u32 s33, s33, 16384
  v_mfma_f32_16x16x32_bf16 v[76:79], a[84:87], v[196:199], v[76:79]
  ds_read_b128 v[164:167], v18 offset:2048
  s_nop 0
  v_mfma_f32_16x16x32_bf16 v[80:83], a[88:91], v[196:199], v[80:83]
  buffer_load_dwordx4 v10, s[8:11], s30 offen offset:0 lds
  v_mfma_f32_16x16x32_bf16 v[84:87], a[92:95], v[196:199], v[84:87]
  s_cmp_lt_u32 s33, 98304
  s_cselect_b32 s33, s33, 0
  v_mfma_f32_16x16x32_bf16 v[88:91], a[84:87], v[200:203], v[88:91]
  ds_read_b128 v[168:171], v18 offset:4096
  v_mul_f32 v44, v44, v56
  v_mfma_f32_16x16x32_bf16 v[92:95], a[88:91], v[200:203], v[92:95]
  v_mul_f32 v45, v45, v56
  v_mul_f32 v46, v46, v56
  v_mfma_f32_16x16x32_bf16 v[96:99], a[92:95], v[200:203], v[96:99]
  v_mul_f32 v47, v47, v56
  v_mul_f32 v48, v48, v56
  v_mfma_f32_16x16x32_bf16 v[100:103], a[84:87], v[204:207], v[100:103]
  ds_read_b128 v[172:175], v18 offset:6144
  v_mul_f32 v49, v49, v56
  v_mfma_f32_16x16x32_bf16 v[104:107], a[88:91], v[204:207], v[104:107]
  v_mul_f32 v50, v50, v56
  v_mul_f32 v51, v51, v56
  v_mfma_f32_16x16x32_bf16 v[108:111], a[92:95], v[204:207], v[108:111]
  s_waitcnt lgkmcnt(4)
  v_mul_f32 v52, v52, v56
  v_mfma_f32_16x16x32_bf16 v[112:115], a[84:87], v[208:211], v[112:115]
  ds_read_b128 v[176:179], v18 offset:8192
  v_mul_f32 v53, v53, v56
  v_mfma_f32_16x16x32_bf16 v[116:119], a[88:91], v[208:211], v[116:119]
  v_mul_f32 v54, v54, v56
  v_mul_f32 v55, v55, v56
  v_mfma_f32_16x16x32_bf16 v[120:123], a[92:95], v[208:211], v[120:123]
  v_cvt_pk_bf16_f32 v240, v40, v41
  v_cvt_pk_bf16_f32 v241, v42, v43
  v_mfma_f32_16x16x32_bf16 v[124:127], a[84:87], v[212:215], v[124:127]
  ds_read_b128 v[180:183], v18 offset:10240
  v_cvt_pk_bf16_f32 v242, v52, v53
  v_mfma_f32_16x16x32_bf16 v[128:131], a[88:91], v[212:215], v[128:131]
  buffer_load_dwordx4 v11, s[8:11], s30 offen offset:1024 lds
  v_mfma_f32_16x16x32_bf16 v[132:135], a[92:95], v[212:215], v[132:135]
  v_cvt_pk_bf16_f32 v243, v54, v55
  v_cvt_pk_bf16_f32 v236, v44, v45
  v_mfma_f32_16x16x32_bf16 v[136:139], a[84:87], v[216:219], v[136:139]
  ds_read_b128 v[184:187], v18 offset:12288
  v_cvt_pk_bf16_f32 v237, v46, v47
  v_mfma_f32_16x16x32_bf16 v[140:143], a[88:91], v[216:219], v[140:143]
  v_cvt_pk_bf16_f32 v238, v48, v49
  v_cvt_pk_bf16_f32 v239, v50, v51
  v_mfma_f32_16x16x32_bf16 v[144:147], a[92:95], v[216:219], v[144:147]
  v_cvt_pk_bf16_f32 v244, v36, v37
  v_cvt_pk_bf16_f32 v245, v38, v39
  v_mfma_f32_16x16x32_bf16 v[148:151], a[84:87], v[220:223], v[148:151]
  ds_read_b128 v[188:191], v18 offset:14336
  v_mfma_f32_16x16x32_bf16 v[152:155], a[88:91], v[220:223], v[152:155]
  v_permlane16_swap_b32 v240, v242
  v_mfma_f32_16x16x32_bf16 v[156:159], a[92:95], v[220:223], v[156:159]
  s_waitcnt lgkmcnt(4)
  v_mfma_f32_16x16x32_bf16 v[64:67], a[96:99], v[160:163], v[64:67]
  ds_read_b128 v[192:195], v19 offset:0
  v_mfma_f32_16x16x32_bf16 v[68:71], a[100:103], v[160:163], v[68:71]
  v_add_u32 v18, s33, v14
  v_mfma_f32_16x16x32_bf16 v[72:75], a[104:107], v[160:163], v[72:75]
  v_permlane16_swap_b32 v241, v243
  v_mfma_f32_16x16x32_bf16 v[76:79], a[96:99], v[164:167], v[76:79]
  ds_read_b128 v[196:199], v19 offset:2048
  v_mfma_f32_16x16x32_bf16 v[80:83], a[100:103], v[164:167], v[80:83]
  buffer_load_dwordx4 v12, s[8:11], s30 offen offset:2048 lds
  v_mfma_f32_16x16x32_bf16 v[84:87], a[104:107], v[164:167], v[84:87]
  v_mfma_f32_16x16x32_bf16 v[88:91], a[96:99], v[168:171], v[88:91]
  ds_read_b128 v[200:203], v19 offset:4096
  v_mfma_f32_16x16x32_bf16 v[92:95], a[100:103], v[168:171], v[92:95]
  v_mfma_f32_16x16x32_bf16 v[96:99], a[104:107], v[168:171], v[96:99]
  v_mfma_f32_16x16x32_bf16 v[100:103], a[96:99], v[172:175], v[100:103]
  ds_read_b128 v[204:207], v19 offset:6144
  v_mfma_f32_16x16x32_bf16 v[104:107], a[100:103], v[172:175], v[104:107]
  v_mfma_f32_16x16x32_bf16 v[108:111], a[104:107], v[172:175], v[108:111]
  s_waitcnt lgkmcnt(4)
  v_mfma_f32_16x16x32_bf16 v[112:115], a[96:99], v[176:179], v[112:115]
  ds_read_b128 v[208:211], v19 offset:8192
  v_mfma_f32_16x16x32_bf16 v[116:119], a[100:103], v[176:179], v[116:119]
  v_mfma_f32_16x16x32_bf16 v[120:123], a[104:107], v[176:179], v[120:123]
  v_mfma_f32_16x16x32_bf16 v[124:127], a[96:99], v[180:183], v[124:127]
  ds_read_b128 v[212:215], v19 offset:10240
  v_mfma_f32_16x16x32_bf16 v[128:131], a[100:103], v[180:183], v[128:131]
  buffer_load_dwordx4 v13, s[8:11], s30 offen offset:3072 lds
  v_mfma_f32_16x16x32_bf16 v[132:135], a[104:107], v[180:183], v[132:135]
  s_add_u32 s30, s30, 128
  s_add_u32 m0, m0, 16384
  v_mfma_f32_16x16x32_bf16 v[136:139], a[96:99], v[184:187], v[136:139]
  ds_read_b128 v[216:219], v19 offset:12288
  v_mfma_f32_16x16x32_bf16 v[140:143], a[100:103], v[184:187], v[140:143]
  s_cmp_lt_u32 m0, s46
  s_cselect_b32 m0, m0, s47
  v_mfma_f32_16x16x32_bf16 v[144:147], a[104:107], v[184:187], v[144:147]
  v_mfma_f32_16x16x32_bf16 v[148:151], a[96:99], v[188:191], v[148:151]
  ds_read_b128 v[220:223], v19 offset:14336
  v_mfma_f32_16x16x32_bf16 v[152:155], a[100:103], v[188:191], v[152:155]
  v_mfma_f32_16x16x32_bf16 v[156:159], a[104:107], v[188:191], v[156:159]
  s_waitcnt vmcnt(13) lgkmcnt(4)
  s_barrier
  v_mfma_f32_16x16x32_bf16 v[64:67], a[108:111], v[192:195], v[64:67]
  ds_read_b128 v[160:163], v18 offset:0
  v_mfma_f32_16x16x32_bf16 v[68:71], a[112:115], v[192:195], v[68:71]
  v_mfma_f32_16x16x32_bf16 v[72:75], a[116:119], v[192:195], v[72:75]
  v_add_u32 v19, s33, v15
  s_add_u32 s33, s33, 16384
  v_mfma_f32_16x16x32_bf16 v[76:79], a[108:111], v[196:199], v[76:79]
  ds_read_b128 v[164:167], v18 offset:2048
  v_mfma_f32_16x16x32_bf16 v[80:83], a[112:115], v[196:199], v[80:83]
  buffer_load_dwordx4 v10, s[8:11], s30 offen offset:0 lds
  v_mfma_f32_16x16x32_bf16 v[84:87], a[116:119], v[196:199], v[84:87]
  s_cmp_lt_u32 s33, 98304
  s_cselect_b32 s33, s33, 0
  v_mfma_f32_16x16x32_bf16 v[88:91], a[108:111], v[200:203], v[88:91]
  ds_read_b128 v[168:171], v18 offset:4096
  v_mfma_f32_16x16x32_bf16 v[92:95], a[112:115], v[200:203], v[92:95]
  v_mfma_f32_16x16x32_bf16 v[96:99], a[116:119], v[200:203], v[96:99]
  v_mfma_f32_16x16x32_bf16 v[100:103], a[108:111], v[204:207], v[100:103]
  ds_read_b128 v[172:175], v18 offset:6144
  v_mfma_f32_16x16x32_bf16 v[104:107], a[112:115], v[204:207], v[104:107]
  v_mfma_f32_16x16x32_bf16 v[108:111], a[116:119], v[204:207], v[108:111]
  s_waitcnt lgkmcnt(4)
  v_mfma_f32_16x16x32_bf16 v[112:115], a[108:111], v[208:211], v[112:115]
  ds_read_b128 v[176:179], v18 offset:8192
  v_mfma_f32_16x16x32_bf16 v[116:119], a[112:115], v[208:211], v[116:119]
  v_mfma_f32_16x16x32_bf16 v[120:123], a[116:119], v[208:211], v[120:123]
  v_mfma_f32_16x16x32_bf16 v[124:127], a[108:111], v[212:215], v[124:127]
  ds_read_b128 v[180:183], v18 offset:10240
  v_mfma_f32_16x16x32_bf16 v[128:131], a[112:115], v[212:215], v[128:131]
  buffer_load_dwordx4 v11, s[8:11], s30 offen offset:1024 lds
  v_mfma_f32_16x16x32_bf16 v[132:135], a[116:119], v[212:215], v[132:135]
  v_mfma_f32_16x16x32_bf16 v[136:139], a[108:111], v[216:219], v[136:139]
  ds_read_b128 v[184:187], v18 offset:12288
  v_mfma_f32_16x16x32_bf16 v[140:143], a[112:115], v[216:219], v[140:143]
  v_mfma_f32_16x16x32_bf16 v[144:147], a[116:119], v[216:219], v[144:147]
  v_mfma_f32_16x16x32_bf16 v[148:151], a[108:111], v[220:223], v[148:151]
  ds_read_b128 v[188:191], v18 offset:14336
  v_mfma_f32_16x16x32_bf16 v[152:155], a[112:115], v[220:223], v[152:155]
  v_mfma_f32_16x16x32_bf16 v[156:159], a[116:119], v[220:223], v[156:159]
  s_waitcnt lgkmcnt(4)
  v_mfma_f32_16x16x32_bf16 v[64:67], a[120:123], v[160:163], v[64:67]
  ds_read_b128 v[192:195], v19 offset:0
  v_mfma_f32_16x16x32_bf16 v[68:71], a[124:127], v[160:163], v[68:71]
  v_add_u32 v18, s33, v14
  v_mfma_f32_16x16x32_bf16 v[72:75], a[128:131], v[160:163], v[72:75]
  v_mfma_f32_16x16x32_bf16 v[76:79], a[120:123], v[164:167], v[76:79]
  ds_read_b128 v[196:199], v19 offset:2048
  v_mfma_f32_16x16x32_bf16 v[80:83], a[124:127], v[164:167], v[80:83]
  buffer_load_dwordx4 v12, s[8:11], s30 offen offset:2048 lds
  v_mfma_f32_16x16x32_bf16 v[84:87], a[128:131], v[164:167], v[84:87]
  v_mfma_f32_16x16x32_bf16 v[88:91], a[120:123], v[168:171], v[88:91]
  ds_read_b128 v[200:203], v19 offset:4096
  v_mfma_f32_16x16x32_bf16 v[92:95], a[124:127], v[168:171], v[92:95]
  v_mfma_f32_16x16x32_bf16 v[96:99], a[128:131], v[168:171], v[96:99]
  v_mfma_f32_16x16x32_bf16 v[100:103], a[120:123], v[172:175], v[100:103]
  ds_read_b128 v[204:207], v19 offset:6144
  v_mfma_f32_16x16x32_bf16 v[104:107], a[124:127], v[172:175], v[104:107]
  v_mfma_f32_16x16x32_bf16 v[108:111], a[128:131], v[172:175], v[108:111]
  s_waitcnt lgkmcnt(4)
  v_mfma_f32_16x16x32_bf16 v[112:115], a[120:123], v[176:179], v[112:115]
  ds_read_b128 v[208:211], v19 offset:8192
  v_mfma_f32_16x16x32_bf16 v[116:119], a[124:127], v[176:179], v[116:119]
  v_mfma_f32_16x16x32_bf16 v[120:123], a[128:131], v[176:179], v[120:123]
  v_mfma_f32_16x16x32_bf16 v[124:127], a[120:123], v[180:183], v[124:127]
  ds_read_b128 v[212:215], v19 offset:10240
  v_mfma_f32_16x16x32_bf16 v[128:131], a[124:127], v[180:183], v[128:131]
  buffer_load_dwordx4 v13, s[8:11], s30 offen offset:3072 lds
  v_mfma_f32_16x16x32_bf16 v[132:135], a[128:131], v[180:183], v[132:135]
  s_add_u32 s30, s30, s25
  s_sub_u32 s30, s30, 1152
  v_mfma_f32_16x16x32_bf16 v[136:139], a[120:123], v[184:187], v[136:139]
  ds_read_b128 v[216:219], v19 offset:12288
  s_mov_b32 s25, 163840
  v_mfma_f32_16x16x32_bf16 v[140:143], a[124:127], v[184:187], v[140:143]
  s_add_u32 m0, m0, 16384
  v_mfma_f32_16x16x32_bf16 v[144:147], a[128:131], v[184:187], v[144:147]
  s_cmp_lt_u32 m0, s46
  s_cselect_b32 m0, m0, s47
  v_mfma_f32_16x16x32_bf16 v[148:151], a[120:123], v[188:191], v[148:151]
  ds_read_b128 v[220:223], v19 offset:14336
  v_mfma_f32_16x16x32_bf16 v[152:155], a[124:127], v[188:191], v[152:155]
  v_mfma_f32_16x16x32_bf16 v[156:159], a[128:131], v[188:191], v[156:159]
  s_waitcnt vmcnt(13) lgkmcnt(4)
  s_barrier
  v_mfma_f32_16x16x32_bf16 v[64:67], a[132:135], v[192:195], v[64:67]
  ds_read_b128 v[160:163], v18 offset:0
  v_mfma_f32_16x16x32_bf16 v[68:71], a[136:139], v[192:195], v[68:71]
  buffer_store_dwordx4 v[236:239], v30, s[56:59], s81 offen sc1
  s_mov_b64 exec, 0xffffffff
  buffer_store_dwordx4 v[240:243], v30, s[56:59], s81 offen offset:1024 sc1
  s_mov_b64 exec, -1
  buffer_store_dwordx2 v[244:245], v32, s[56:59], s81 offen offset:2048 sc1
  s_mov_b32 s78, s82
  s_mov_b32 s82, 0
  s_mov_b32 s81, 0x80000000
  v_mfma_f32_16x16x32_bf16 v[72:75], a[140:143], v[192:195], v[72:75]
  v_add_u32 v19, s33, v15
  s_add_u32 s33, s33, 16384
  v_mfma_f32_16x16x32_bf16 v[76:79], a[132:135], v[196:199], v[76:79]
  ds_read_b128 v[164:167], v18 offset:2048
  v_mfma_f32_16x16x32_bf16 v[80:83], a[136:139], v[196:199], v[80:83]
  buffer_load_dwordx4 v10, s[8:11], s30 offen offset:0 lds
  v_mfma_f32_16x16x32_bf16 v[84:87], a[140:143], v[196:199], v[84:87]
  s_cmp_lt_u32 s33, 98304
  s_cselect_b32 s33, s33, 0
  v_mfma_f32_16x16x32_bf16 v[88:91], a[132:135], v[200:203], v[88:91]
  ds_read_b128 v[168:171], v18 offset:4096
  v_mfma_f32_16x16x32_bf16 v[92:95], a[136:139], v[200:203], v[92:95]
  v_mfma_f32_16x16x32_bf16 v[96:99], a[140:143], v[200:203], v[96:99]
  v_mfma_f32_16x16x32_bf16 v[100:103], a[132:135], v[204:207], v[100:103]
  ds_read_b128 v[172:175], v18 offset:6144
  v_mfma_f32_16x16x32_bf16 v[104:107], a[136:139], v[204:207], v[104:107]
  v_mfma_f32_16x16x32_bf16 v[108:111], a[140:143], v[204:207], v[108:111]
  s_waitcnt lgkmcnt(4)
  v_mfma_f32_16x16x32_bf16 v[112:115], a[132:135], v[208:211], v[112:115]
  ds_read_b128 v[176:179], v18 offset:8192
  v_mfma_f32_16x16x32_bf16 v[116:119], a[136:139], v[208:211], v[116:119]
  v_mfma_f32_16x16x32_bf16 v[120:123], a[140:143], v[208:211], v[120:123]
  v_mfma_f32_16x16x32_bf16 v[124:127], a[132:135], v[212:215], v[124:127]
  ds_read_b128 v[180:183], v18 offset:10240
  v_mfma_f32_16x16x32_bf16 v[128:131], a[136:139], v[212:215], v[128:131]
  buffer_load_dwordx4 v11, s[8:11], s30 offen offset:1024 lds
  v_mfma_f32_16x16x32_bf16 v[132:135], a[140:143], v[212:215], v[132:135]
  v_mfma_f32_16x16x32_bf16 v[136:139], a[132:135], v[216:219], v[136:139]
  ds_read_b128 v[184:187], v18 offset:12288
  v_mfma_f32_16x16x32_bf16 v[140:143], a[136:139], v[216:219], v[140:143]
  v_mfma_f32_16x16x32_bf16 v[144:147], a[140:143], v[216:219], v[144:147]
  v_mfma_f32_16x16x32_bf16 v[148:151], a[132:135], v[220:223], v[148:151]
  ds_read_b128 v[188:191], v18 offset:14336
  v_mfma_f32_16x16x32_bf16 v[152:155], a[136:139], v[220:223], v[152:155]
  v_mfma_f32_16x16x32_bf16 v[156:159], a[140:143], v[220:223], v[156:159]
  s_waitcnt lgkmcnt(4)
  v_mfma_f32_16x16x32_bf16 v[64:67], a[144:147], v[160:163], v[64:67]
  ds_read_b128 v[192:195], v19 offset:0
  v_mfma_f32_16x16x32_bf16 v[68:71], a[148:151], v[160:163], v[68:71]
  v_add_u32 v18, s33, v14
  v_mfma_f32_16x16x32_bf16 v[72:75], a[152:155], v[160:163], v[72:75]
  v_mfma_f32_16x16x32_bf16 v[76:79], a[144:147], v[164:167], v[76:79]
  ds_read_b128 v[196:199], v19 offset:2048
  v_mfma_f32_16x16x32_bf16 v[80:83], a[148:151], v[164:167], v[80:83]
  buffer_load_dwordx4 v12, s[8:11], s30 offen offset:2048 lds
  v_mfma_f32_16x16x32_bf16 v[84:87], a[152:155], v[164:167], v[84:87]
  v_mfma_f32_16x16x32_bf16 v[88:91], a[144:147], v[168:171], v[88:91]
  ds_read_b128 v[200:203], v19 offset:4096
  v_mfma_f32_16x16x32_bf16 v[92:95], a[148:151], v[168:171], v[92:95]
  v_mfma_f32_16x16x32_bf16 v[96:99], a[152:155], v[168:171], v[96:99]
  v_mfma_f32_16x16x32_bf16 v[100:103], a[144:147], v[172:175], v[100:103]
  ds_read_b128 v[204:207], v19 offset:6144
  v_mfma_f32_16x16x32_bf16 v[104:107], a[148:151], v[172:175], v[104:107]
  v_mfma_f32_16x16x32_bf16 v[108:111], a[152:155], v[172:175], v[108:111]
  s_waitcnt lgkmcnt(4)
  v_mfma_f32_16x16x32_bf16 v[112:115], a[144:147], v[176:179], v[112:115]
  ds_read_b128 v[208:211], v19 offset:8192
  v_mfma_f32_16x16x32_bf16 v[116:119], a[148:151], v[176:179], v[116:119]
  v_mfma_f32_16x16x32_bf16 v[120:123], a[152:155], v[176:179], v[120:123]
  v_mfma_f32_16x16x32_bf16 v[124:127], a[144:147], v[180:183], v[124:127]
  ds_read_b128 v[212:215], v19 offset:10240
  v_mfma_f32_16x16x32_bf16 v[128:131], a[148:151], v[180:183], v[128:131]
  buffer_load_dwordx4 v13, s[8:11], s30 offen offset:3072 lds
  v_mfma_f32_16x16x32_bf16 v[132:135], a[152:155], v[180:183], v[132:135]
  s_add_u32 s30, s30, 128
  s_add_u32 m0, m0, 16384
  v_mfma_f32_16x16x32_bf16 v[136:139], a[144:147], v[184:187], v[136:139]
  ds_read_b128 v[216:219], v19 offset:12288
  v_mfma_f32_16x16x32_bf16 v[140:143], a[148:151], v[184:187], v[140:143]
  s_cmp_lt_u32 m0, s46
  s_cselect_b32 m0, m0, s47
  v_mfma_f32_16x16x32_bf16 v[144:147], a[152:155], v[184:187], v[144:147]
  v_mfma_f32_16x16x32_bf16 v[148:151], a[144:147], v[188:191], v[148:151]
  ds_read_b128 v[220:223], v19 offset:14336
  v_mfma_f32_16x16x32_bf16 v[152:155], a[148:151], v[188:191], v[152:155]
  v_mfma_f32_16x16x32_bf16 v[156:159], a[152:155], v[188:191], v[156:159]
  s_waitcnt vmcnt(15) lgkmcnt(4)
  s_barrier
  v_mfma_f32_16x16x32_bf16 v[64:67], a[156:159], v[192:195], v[64:67]
  ds_read_b128 v[160:163], v18 offset:0
  v_mfma_f32_16x16x32_bf16 v[68:71], a[160:163], v[192:195], v[68:71]
  v_readfirstlane_b32 s79, v20
  v_mfma_f32_16x16x32_bf16 v[72:75], a[164:167], v[192:195], v[72:75]
  v_add_u32 v19, s33, v15
  s_add_u32 s33, s33, 16384
  v_mfma_f32_16x16x32_bf16 v[76:79], a[156:159], v[196:199], v[76:79]
  ds_read_b128 v[164:167], v18 offset:2048
  s_add_u32 s21, s50, 0
  v_mfma_f32_16x16x32_bf16 v[80:83], a[160:163], v[196:199], v[80:83]
  buffer_load_dwordx4 v10, s[8:11], s30 offen offset:0 lds
  v_mfma_f32_16x16x32_bf16 v[84:87], a[164:167], v[196:199], v[84:87]
  s_cmp_lt_u32 s33, 98304
  s_cselect_b32 s33, s33, 0
  v_mfma_f32_16x16x32_bf16 v[88:91], a[156:159], v[200:203], v[88:91]
  ds_read_b128 v[168:171], v18 offset:4096
  v_mfma_f32_16x16x32_bf16 v[92:95], a[160:163], v[200:203], v[92:95]
  buffer_load_dwordx4 v[36:39], v30, s[16:19], s21 offen offset:0 sc1
  v_mfma_f32_16x16x32_bf16 v[96:99], a[164:167], v[200:203], v[96:99]
  v_mfma_f32_16x16x32_bf16 v[100:103], a[156:159], v[204:207], v[100:103]
  ds_read_b128 v[172:175], v18 offset:6144
  v_mfma_f32_16x16x32_bf16 v[104:107], a[160:163], v[204:207], v[104:107]
  v_mfma_f32_16x16x32_bf16 v[108:111], a[164:167], v[204:207], v[108:111]
  s_waitcnt lgkmcnt(4)
  v_mfma_f32_16x16x32_bf16 v[112:115], a[156:159], v[208:211], v[112:115]
  ds_read_b128 v[176:179], v18 offset:8192
  v_mfma_f32_16x16x32_bf16 v[116:119], a[160:163], v[208:211], v[116:119]
  buffer_load_dwordx4 v[40:43], v30, s[16:19], s21 offen offset:1024 sc1
  v_mfma_f32_16x16x32_bf16 v[120:123], a[164:167], v[208:211], v[120:123]
  v_mfma_f32_16x16x32_bf16 v[124:127], a[156:159], v[212:215], v[124:127]
  ds_read_b128 v[180:183], v18 offset:10240
  v_mfma_f32_16x16x32_bf16 v[128:131], a[160:163], v[212:215], v[128:131]
  buffer_load_dwordx4 v11, s[8:11], s30 offen offset:1024 lds
  v_mfma_f32_16x16x32_bf16 v[132:135], a[164:167], v[212:215], v[132:135]
  v_mfma_f32_16x16x32_bf16 v[136:139], a[156:159], v[216:219], v[136:139]
  ds_read_b128 v[184:187], v18 offset:12288
  v_mfma_f32_16x16x32_bf16 v[140:143], a[160:163], v[216:219], v[140:143]
  buffer_load_dwordx4 v[44:47], v30, s[16:19], s21 offen offset:2048 sc1
  v_mfma_f32_16x16x32_bf16 v[144:147], a[164:167], v[216:219], v[144:147]
  v_mfma_f32_16x16x32_bf16 v[148:151], a[156:159], v[220:223], v[148:151]
  ds_read_b128 v[188:191], v18 offset:14336
  v_mfma_f32_16x16x32_bf16 v[152:155], a[160:163], v[220:223], v[152:155]
  v_mfma_f32_16x16x32_bf16 v[156:159], a[164:167], v[220:223], v[156:159]
  s_waitcnt lgkmcnt(4)
  v_mfma_f32_16x16x32_bf16 v[64:67], a[168:171], v[160:163], v[64:67]
  ds_read_b128 v[192:195], v19 offset:0
  v_mfma_f32_16x16x32_bf16 v[68:71], a[172:175], v[160:163], v[68:71]
  v_add_u32 v18, s33, v14
  v_mfma_f32_16x16x32_bf16 v[72:75], a[176:179], v[160:163], v[72:75]
  buffer_load_dwordx4 v[48:51], v30, s[16:19], s21 offen offset:3072 sc1
  v_mfma_f32_16x16x32_bf16 v[76:79], a[168:171], v[164:167], v[76:79]
  ds_read_b128 v[196:199], v19 offset:2048
  v_mfma_f32_16x16x32_bf16 v[80:83], a[172:175], v[164:167], v[80:83]
  buffer_load_dwordx4 v12, s[8:11], s30 offen offset:2048 lds
  v_mfma_f32_16x16x32_bf16 v[84:87], a[176:179], v[164:167], v[84:87]
  v_mfma_f32_16x16x32_bf16 v[88:91], a[168:171], v[168:171], v[88:91]
  ds_read_b128 v[200:203], v19 offset:4096
  v_mfma_f32_16x16x32_bf16 v[92:95], a[172:175], v[168:171], v[92:95]
  s_add_u32 s21, s50, 4096
  v_mfma_f32_16x16x32_bf16 v[96:99], a[176:179], v[168:171], v[96:99]
  buffer_load_dwordx4 v[52:55], v30, s[16:19], s21 offen offset:0 sc1
  v_mfma_f32_16x16x32_bf16 v[100:103], a[168:171], v[172:175], v[100:103]
  ds_read_b128 v[204:207], v19 offset:6144
  v_mfma_f32_16x16x32_bf16 v[104:107], a[172:175], v[172:175], v[104:107]
  v_mfma_f32_16x16x32_bf16 v[108:111], a[176:179], v[172:175], v[108:111]
  s_waitcnt lgkmcnt(4)
  v_mfma_f32_16x16x32_bf16 v[112:115], a[168:171], v[176:179], v[112:115]
  ds_read_b128 v[208:211], v19 offset:8192
  v_mfma_f32_16x16x32_bf16 v[116:119], a[172:175], v[176:179], v[116:119]
  buffer_load_dwordx4 v[56:59], v30, s[16:19], s21 offen offset:1024 sc1
  v_mfma_f32_16x16x32_bf16 v[120:123], a[176:179], v[176:179], v[120:123]
  v_mfma_f32_16x16x32_bf16 v[124:127], a[168:171], v[180:183], v[124:127]
  ds_read_b128 v[212:215], v19 offset:10240
  v_mfma_f32_16x16x32_bf16 v[128:131], a[172:175], v[180:183], v[128:131]
  buffer_load_dwordx4 v13, s[8:11], s30 offen offset:3072 lds
  v_mfma_f32_16x16x32_bf16 v[132:135], a[176:179], v[180:183], v[132:135]
  s_add_u32 s30, s30, 128
  s_add_u32 m0, m0, 16384
  v_mfma_f32_16x16x32_bf16 v[136:139], a[168:171], v[184:187], v[136:139]
  ds_read_b128 v[216:219], v19 offset:12288
  v_mfma_f32_16x16x32_bf16 v[140:143], a[172:175], v[184:187], v[140:143]
  s_cmp_lt_u32 m0, s46
  s_cselect_b32 m0, m0, s47
  v_mfma_f32_16x16x32_bf16 v[144:147], a[176:179], v[184:187], v[144:147]
  buffer_load_dwordx4 v[60:63], v30, s[16:19], s21 offen offset:2048 sc1
  v_mfma_f32_16x16x32_bf16 v[148:151], a[168:171], v[188:191], v[148:151]
  ds_read_b128 v[220:223], v19 offset:14336
  v_mfma_f32_16x16x32_bf16 v[152:155], a[172:175], v[188:191], v[152:155]
  v_mfma_f32_16x16x32_bf16 v[156:159], a[176:179], v[188:191], v[156:159]
  s_waitcnt vmcnt(22) lgkmcnt(4)
  s_barrier
  v_mfma_f32_16x16x32_bf16 v[64:67], a[180:183], v[192:195], v[64:67]
  ds_read_b128 v[160:163], v18 offset:0
  v_mfma_f32_16x16x32_bf16 v[68:71], a[184:187], v[192:195], v[68:71]
  buffer_load_dwordx4 v[236:239], v30, s[16:19], s21 offen offset:3072 sc1
  v_mfma_f32_16x16x32_bf16 v[72:75], a[188:191], v[192:195], v[72:75]
  v_add_u32 v19, s33, v15
  s_add_u32 s33, s33, 16384
  v_mfma_f32_16x16x32_bf16 v[76:79], a[180:183], v[196:199], v[76:79]
  ds_read_b128 v[164:167], v18 offset:2048
  v_mfma_f32_16x16x32_bf16 v[80:83], a[184:187], v[196:199], v[80:83]
  buffer_load_dwordx4 v10, s[8:11], s30 offen offset:0 lds
  v_mfma_f32_16x16x32_bf16 v[84:87], a[188:191], v[196:199], v[84:87]
  s_cmp_lt_u32 s33, 98304
  s_cselect_b32 s33, s33, 0
  v_mfma_f32_16x16x32_bf16 v[88:91], a[180:183], v[200:203], v[88:91]
  ds_read_b128 v[168:171], v18 offset:4096
  s_add_u32 s21, s50, 8192
  v_mfma_f32_16x16x32_bf16 v[92:95], a[184:187], v[200:203], v[92:95]
  buffer_load_dwordx4 v[240:243], v30, s[16:19], s21 offen offset:0 sc1
  v_mfma_f32_16x16x32_bf16 v[96:99], a[188:191], v[200:203], v[96:99]
  v_mfma_f32_16x16x32_bf16 v[100:103], a[180:183], v[204:207], v[100:103]
  ds_read_b128 v[172:175], v18 offset:6144
  v_mfma_f32_16x16x32_bf16 v[104:107], a[184:187], v[204:207], v[104:107]
  v_mfma_f32_16x16x32_bf16 v[108:111], a[188:191], v[204:207], v[108:111]
  s_waitcnt lgkmcnt(4)
  v_mfma_f32_16x16x32_bf16 v[112:115], a[180:183], v[208:211], v[112:115]
  ds_read_b128 v[176:179], v18 offset:8192
  v_mfma_f32_16x16x32_bf16 v[116:119], a[184:187], v[208:211], v[116:119]
  buffer_load_dwordx4 v[244:247], v30, s[16:19], s21 offen offset:1024 sc1
  v_mfma_f32_16x16x32_bf16 v[120:123], a[188:191], v[208:211], v[120:123]
  v_mfma_f32_16x16x32_bf16 v[124:127], a[180:183], v[212:215], v[124:127]
  ds_read_b128 v[180:183], v18 offset:10240
  v_mfma_f32_16x16x32_bf16 v[128:131], a[184:187], v[212:215], v[128:131]
  buffer_load_dwordx4 v11, s[8:11], s30 offen offset:1024 lds
  v_mfma_f32_16x16x32_bf16 v[132:135], a[188:191], v[212:215], v[132:135]
  v_mfma_f32_16x16x32_bf16 v[136:139], a[180:183], v[216:219], v[136:139]
  ds_read_b128 v[184:187], v18 offset:12288
  v_mfma_f32_16x16x32_bf16 v[140:143], a[184:187], v[216:219], v[140:143]
  buffer_load_dwordx4 v[248:251], v30, s[16:19], s21 offen offset:2048 sc1
  v_mfma_f32_16x16x32_bf16 v[144:147], a[188:191], v[216:219], v[144:147]
  v_mfma_f32_16x16x32_bf16 v[148:151], a[180:183], v[220:223], v[148:151]
  ds_read_b128 v[188:191], v18 offset:14336
  v_mfma_f32_16x16x32_bf16 v[152:155], a[184:187], v[220:223], v[152:155]
  v_mfma_f32_16x16x32_bf16 v[156:159], a[188:191], v[220:223], v[156:159]
  s_waitcnt lgkmcnt(4)
  v_mfma_f32_16x16x32_bf16 v[64:67], a[192:195], v[160:163], v[64:67]
  ds_read_b128 v[192:195], v19 offset:0
  v_mfma_f32_16x16x32_bf16 v[68:71], a[196:199], v[160:163], v[68:71]
  v_add_u32 v18, s33, v14
  v_mfma_f32_16x16x32_bf16 v[72:75], a[200:203], v[160:163], v[72:75]
  buffer_load_dwordx4 v[252:255], v30, s[16:19], s21 offen offset:3072 sc1
  v_mfma_f32_16x16x32_bf16 v[76:79], a[192:195], v[164:167], v[76:79]
  ds_read_b128 v[196:199], v19 offset:2048
  v_mfma_f32_16x16x32_bf16 v[80:83], a[196:199], v[164:167], v[80:83]
  buffer_load_dwordx4 v12, s[8:11], s30 offen offset:2048 lds
  v_mfma_f32_16x16x32_bf16 v[84:87], a[200:203], v[164:167], v[84:87]
  v_mfma_f32_16x16x32_bf16 v[88:91], a[192:195], v[168:171], v[88:91]
  ds_read_b128 v[200:203], v19 offset:4096
  v_mfma_f32_16x16x32_bf16 v[92:95], a[196:199], v[168:171], v[92:95]
  buffer_load_dword v21, v33, s[72:75], s77 offen sc1
  v_mfma_f32_16x16x32_bf16 v[96:99], a[200:203], v[168:171], v[96:99]
  v_mfma_f32_16x16x32_bf16 v[100:103], a[192:195], v[172:175], v[100:103]
  ds_read_b128 v[204:207], v19 offset:6144
  v_mfma_f32_16x16x32_bf16 v[104:107], a[196:199], v[172:175], v[104:107]
  v_mfma_f32_16x16x32_bf16 v[108:111], a[200:203], v[172:175], v[108:111]
  s_waitcnt lgkmcnt(4)
  v_mfma_f32_16x16x32_bf16 v[112:115], a[192:195], v[176:179], v[112:115]
  ds_read_b128 v[208:211], v19 offset:8192
  v_mfma_f32_16x16x32_bf16 v[116:119], a[196:199], v[176:179], v[116:119]
  v_mfma_f32_16x16x32_bf16 v[120:123], a[200:203], v[176:179], v[120:123]
  v_mfma_f32_16x16x32_bf16 v[124:127], a[192:195], v[180:183], v[124:127]
  ds_read_b128 v[212:215], v19 offset:10240
  v_mfma_f32_16x16x32_bf16 v[128:131], a[196:199], v[180:183], v[128:131]
  buffer_load_dwordx4 v13, s[8:11], s30 offen offset:3072 lds
  v_mfma_f32_16x16x32_bf16 v[132:135], a[200:203], v[180:183], v[132:135]
  s_add_u32 s30, s30, 128
  s_add_u32 m0, m0, 16384
  v_mfma_f32_16x16x32_bf16 v[136:139], a[192:195], v[184:187], v[136:139]
  ds_read_b128 v[216:219], v19 offset:12288
  v_mfma_f32_16x16x32_bf16 v[140:143], a[196:199], v[184:187], v[140:143]
  s_cmp_lt_u32 m0, s46
  s_cselect_b32 m0, m0, s47
  v_mfma_f32_16x16x32_bf16 v[144:147], a[200:203], v[184:187], v[144:147]
  v_mfma_f32_16x16x32_bf16 v[148:151], a[192:195], v[188:191], v[148:151]
  ds_read_b128 v[220:223], v19 offset:14336
  v_mfma_f32_16x16x32_bf16 v[152:155], a[196:199], v[188:191], v[152:155]
  v_mfma_f32_16x16x32_bf16 v[156:159], a[200:203], v[188:191], v[156:159]
  s_waitcnt vmcnt(28) lgkmcnt(4)
  s_barrier
  v_mfma_f32_16x16x32_bf16 v[64:67], a[204:207], v[192:195], v[64:67]
  ds_read_b128 v[160:163], v18 offset:0
  v_mfma_f32_16x16x32_bf16 v[68:71], a[208:211], v[192:195], v[68:71]
  s_waitcnt vmcnt(25)
  s_cmp_eq_u32 s78, 0
  s_cbranch_scc1 pf_213
  v_mov_b32 v4, 0
  v_mov_b32 v5, 1
  s_mov_b64 exec, 1
  buffer_atomic_add v5, v4, s[72:75], s78 offen sc1
  s_mov_b64 exec, -1
  s_mov_b32 s78, 0
pf_213:
  v_mfma_f32_16x16x32_bf16 v[72:75], a[212:215], v[192:195], v[72:75]
  v_add_u32 v19, s33, v15
  s_add_u32 s33, s33, 16384
  v_mfma_f32_16x16x32_bf16 v[76:79], a[204:207], v[196:199], v[76:79]
  ds_read_b128 v[164:167], v18 offset:2048
  v_mfma_f32_16x16x32_bf16 v[80:83], a[208:211], v[196:199], v[80:83]
  buffer_load_dwordx4 v10, s[8:11], s30 offen offset:0 lds
  v_mfma_f32_16x16x32_bf16 v[84:87], a[212:215], v[196:199], v[84:87]
  s_cmp_lt_u32 s33, 98304
  s_cselect_b32 s33, s33, 0
  v_mfma_f32_16x16x32_bf16 v[88:91], a[204:207], v[200:203], v[88:91]
  ds_read_b128 v[168:171], v18 offset:4096
  v_mfma_f32_16x16x32_bf16 v[92:95], a[208:211], v[200:203], v[92:95]
  v_mfma_f32_16x16x32_bf16 v[96:99], a[212:215], v[200:203], v[96:99]
  v_mfma_f32_16x16x32_bf16 v[100:103], a[204:207], v[204:207], v[100:103]
  ds_read_b128 v[172:175], v18 offset:6144
  v_mfma_f32_16x16x32_bf16 v[104:107], a[208:211], v[204:207], v[104:107]
  v_mfma_f32_16x16x32_bf16 v[108:111], a[212:215], v[204:207], v[108:111]
  s_waitcnt lgkmcnt(4)
  v_mfma_f32_16x16x32_bf16 v[112:115], a[204:207], v[208:211], v[112:115]
  ds_read_b128 v[176:179], v18 offset:8192
  v_mfma_f32_16x16x32_bf16 v[116:119], a[208:211], v[208:211], v[116:119]
  v_mfma_f32_16x16x32_bf16 v[120:123], a[212:215], v[208:211], v[120:123]
  v_mfma_f32_16x16x32_bf16 v[124:127], a[204:207], v[212:215], v[124:127]
  ds_read_b128 v[180:183], v18 offset:10240
  v_mfma_f32_16x16x32_bf16 v[128:131], a[208:211], v[212:215], v[128:131]
  buffer_load_dwordx4 v11, s[8:11], s30 offen offset:1024 lds
  v_mfma_f32_16x16x32_bf16 v[132:135], a[212:215], v[212:215], v[132:135]
  v_mfma_f32_16x16x32_bf16 v[136:139], a[204:207], v[216:219], v[136:139]
  ds_read_b128 v[184:187], v18 offset:12288
  v_mfma_f32_16x16x32_bf16 v[140:143], a[208:211], v[216:219], v[140:143]
  v_mfma_f32_16x16x32_bf16 v[144:147], a[212:215], v[216:219], v[144:147]
  v_mfma_f32_16x16x32_bf16 v[148:151], a[204:207], v[220:223], v[148:151]
  ds_read_b128 v[188:191], v18 offset:14336
  v_mfma_f32_16x16x32_bf16 v[152:155], a[208:211], v[220:223], v[152:155]
  v_mfma_f32_16x16x32_bf16 v[156:159], a[212:215], v[220:223], v[156:159]
  s_waitcnt lgkmcnt(4)
  v_mfma_f32_16x16x32_bf16 v[64:67], a[216:219], v[160:163], v[64:67]
  ds_read_b128 v[192:195], v19 offset:0
  v_mfma_f32_16x16x32_bf16 v[68:71], a[220:223], v[160:163], v[68:71]
  v_add_u32 v18, s33, v14
  v_mfma_f32_16x16x32_bf16 v[72:75], a[224:227], v[160:163], v[72:75]
  v_mfma_f32_16x16x32_bf16 v[76:79], a[216:219], v[164:167], v[76:79]
  ds_read_b128 v[196:199], v19 offset:2048
  v_mfma_f32_16x16x32_bf16 v[80:83], a[220:223], v[164:167], v[80:83]
  buffer_load_dwordx4 v12, s[8:11], s30 offen offset:2048 lds
  v_mfma_f32_16x16x32_bf16 v[84:87], a[224:227], v[164:167], v[84:87]
  v_mfma_f32_16x16x32_bf16 v[88:91], a[216:219], v[168:171], v[88:91]
  ds_read_b128 v[200:203], v19 offset:4096
  v_mfma_f32_16x16x32_bf16 v[92:95], a[220:223], v[168:171], v[92:95]
  v_mfma_f32_16x16x32_bf16 v[96:99], a[224:227], v[168:171], v[96:99]
  v_mfma_f32_16x16x32_bf16 v[100:103], a[216:219], v[172:175], v[100:103]
  ds_read_b128 v[204:207], v19 offset:6144
  v_mfma_f32_16x16x32_bf16 v[104:107], a[220:223], v[172:175], v[104:107]
  v_mfma_f32_16x16x32_bf16 v[108:111], a[224:227], v[172:175], v[108:111]
  s_waitcnt lgkmcnt(4)
  v_mfma_f32_16x16x32_bf16 v[112:115], a[216:219], v[176:179], v[112:115]
  ds_read_b128 v[208:211], v19 offset:8192
  v_mfma_f32_16x16x32_bf16 v[116:119], a[220:223], v[176:179], v[116:119]
  v_mfma_f32_16x16x32_bf16 v[120:123], a[224:227], v[176:179], v[120:123]
  v_mfma_f32_16x16x32_bf16 v[124:127], a[216:219], v[180:183], v[124:127]
  ds_read_b128 v[212:215], v19 offset:10240
  v_mfma_f32_16x16x32_bf16 v[128:131], a[220:223], v[180:183], v[128:131]
  buffer_load_dwordx4 v13, s[8:11], s30 offen offset:3072 lds
  v_mfma_f32_16x16x32_bf16 v[132:135], a[224:227], v[180:183], v[132:135]
  s_add_u32 s30, s30, 128
  s_add_u32 m0, m0, 16384
  v_mfma_f32_16x16x32_bf16 v[136:139], a[216:219], v[184:187], v[136:139]
  ds_read_b128 v[216:219], v19 offset:12288
  v_mfma_f32_16x16x32_bf16 v[140:143], a[220:223], v[184:187], v[140:143]
  s_cmp_lt_u32 m0, s46
  s_cselect_b32 m0, m0, s47
  v_mfma_f32_16x16x32_bf16 v[144:147], a[224:227], v[184:187], v[144:147]
  v_mfma_f32_16x16x32_bf16 v[148:151], a[216:219], v[188:191], v[148:151]
  ds_read_b128 v[220:223], v19 offset:14336
  v_mfma_f32_16x16x32_bf16 v[152:155], a[220:223], v[188:191], v[152:155]
  v_mfma_f32_16x16x32_bf16 v[156:159], a[224:227], v[188:191], v[156:159]
  s_waitcnt vmcnt(25) lgkmcnt(4)
  s_barrier
  v_mfma_f32_16x16x32_bf16 v[64:67], a[228:231], v[192:195], v[64:67]
  ds_read_b128 v[160:163], v18 offset:0
  v_mfma_f32_16x16x32_bf16 v[68:71], a[232:235], v[192:195], v[68:71]
  v_mfma_f32_16x16x32_bf16 v[72:75], a[236:239], v[192:195], v[72:75]
  v_add_u32 v19, s33, v15
  s_add_u32 s33, s33, 16384
  v_mfma_f32_16x16x32_bf16 v[76:79], a[228:231], v[196:199], v[76:79]
  ds_read_b128 v[164:167], v18 offset:2048
  v_cvt_pk_bf16_f32 v224, v64, v65
  v_cvt_pk_bf16_f32 v225, v66, v67
  v_mfma_f32_16x16x32_bf16 v[80:83], a[232:235], v[196:199], v[80:83]
  buffer_load_dwordx4 v10, s[8:11], s30 offen offset:0 lds
  v_cvt_pk_bf16_f32 v226, v68, v69
  v_cvt_pk_bf16_f32 v227, v70, v71
  v_mfma_f32_16x16x32_bf16 v[84:87], a[236:239], v[196:199], v[84:87]
  s_cmp_lt_u32 s33, 98304
  s_cselect_b32 s33, s33, 0
  v_cvt_pk_bf16_f32 v228, v72, v73
  v_cvt_pk_bf16_f32 v229, v74, v75
  v_mfma_f32_16x16x32_bf16 v[88:91], a[228:231], v[200:203], v[88:91]
  ds_read_b128 v[168:171], v18 offset:4096
  ds_write_b64 v22, v[224:225] offset:0
  v_mfma_f32_16x16x32_bf16 v[92:95], a[232:235], v[200:203], v[92:95]
  ds_write_b64 v22, v[226:227] offset:8
  ds_write_b64 v16, v[228:229] offset:64
  v_mfma_f32_16x16x32_bf16 v[96:99], a[236:239], v[200:203], v[96:99]
  v_cvt_pk_bf16_f32 v230, v76, v77
  v_cvt_pk_bf16_f32 v231, v78, v79
  v_cvt_pk_bf16_f32 v232, v80, v81
  v_cvt_pk_bf16_f32 v233, v82, v83
  v_mfma_f32_16x16x32_bf16 v[100:103], a[228:231], v[204:207], v[100:103]
  ds_read_b128 v[172:175], v18 offset:6144
  v_cvt_pk_bf16_f32 v234, v84, v85
  v_cvt_pk_bf16_f32 v235, v86, v87
  v_mfma_f32_16x16x32_bf16 v[104:107], a[232:235], v[204:207], v[104:107]
  ds_write_b64 v22, v[230:231] offset:6400
  ds_write_b64 v22, v[232:233] offset:6408
  v_mfma_f32_16x16x32_bf16 v[108:111], a[236:239], v[204:207], v[108:111]
  s_waitcnt lgkmcnt(9)
  ds_write_b64 v16, v[234:235] offset:6464
  v_cvt_pk_bf16_f32 v224, v88, v89
  v_mfma_f32_16x16x32_bf16 v[112:115], a[228:231], v[208:211], v[112:115]
  ds_read_b128 v[176:179], v18 offset:8192
  v_cvt_pk_bf16_f32 v225, v90, v91
  v_cvt_pk_bf16_f32 v226, v92, v93
  v_cvt_pk_bf16_f32 v227, v94, v95
  v_mfma_f32_16x16x32_bf16 v[116:119], a[232:235], v[208:211], v[116:119]
  v_cvt_pk_bf16_f32 v228, v96, v97
  v_cvt_pk_bf16_f32 v229, v98, v99
  ds_write_b64 v22, v[224:225] offset:12800
  v_mfma_f32_16x16x32_bf16 v[120:123], a[236:239], v[208:211], v[120:123]
  ds_write_b64 v22, v[226:227] offset:12808
  ds_write_b64 v16, v[228:229] offset:12864
  v_mfma_f32_16x16x32_bf16 v[124:127], a[228:231], v[212:215], v[124:127]
  ds_read_b128 v[180:183], v18 offset:10240
  v_cvt_pk_bf16_f32 v230, v100, v101
  v_cvt_pk_bf16_f32 v231, v102, v103
  v_cvt_pk_bf16_f32 v232, v104, v105
  v_mfma_f32_16x16x32_bf16 v[128:131], a[232:235], v[212:215], v[128:131]
  buffer_load_dwordx4 v11, s[8:11], s30 offen offset:1024 lds
  v_cvt_pk_bf16_f32 v233, v106, v107
  v_cvt_pk_bf16_f32 v234, v108, v109
  v_mfma_f32_16x16x32_bf16 v[132:135], a[236:239], v[212:215], v[132:135]
  v_cvt_pk_bf16_f32 v235, v110, v111
  ds_write_b64 v22, v[230:231] offset:19200
  v_mfma_f32_16x16x32_bf16 v[136:139], a[228:231], v[216:219], v[136:139]
  ds_read_b128 v[184:187], v18 offset:12288
  ds_write_b64 v22, v[232:233] offset:19208
  v_mfma_f32_16x16x32_bf16 v[140:143], a[232:235], v[216:219], v[140:143]
  ds_write_b64 v16, v[234:235] offset:19264
  v_cvt_pk_bf16_f32 v224, v112, v113
  v_cvt_pk_bf16_f32 v225, v114, v115
  v_mfma_f32_16x16x32_bf16 v[144:147], a[236:239], v[216:219], v[144:147]
  v_cvt_pk_bf16_f32 v226, v116, v117
  v_cvt_pk_bf16_f32 v227, v118, v119
  v_cvt_pk_bf16_f32 v228, v120, v121
  v_cvt_pk_bf16_f32 v229, v122, v123
  v_mfma_f32_16x16x32_bf16 v[148:151], a[228:231], v[220:223], v[148:151]
  ds_read_b128 v[188:191], v18 offset:14336
  ds_write_b64 v22, v[224:225] offset:25600
  v_mfma_f32_16x16x32_bf16 v[152:155], a[232:235], v[220:223], v[152:155]
  ds_write_b64 v22, v[226:227] offset:25608
  ds_write_b64 v16, v[228:229] offset:25664
  v_mfma_f32_16x16x32_bf16 v[156:159], a[236:239], v[220:223], v[156:159]
  v_cvt_pk_bf16_f32 v230, v124, v125
  v_cvt_pk_bf16_f32 v231, v126, v127
  v_cvt_pk_bf16_f32 v232, v128, v129
  v_cvt_pk_bf16_f32 v233, v130, v131
qa_end_215:
  v_cvt_pk_bf16_f32 v234, v132, v133
  v_cvt_pk_bf16_f32 v235, v134, v135
  ds_write_b64 v22, v[230:231] offset:32000
  ds_write_b64 v22, v[232:233] offset:32008
  ds_write_b64 v16, v[234:235] offset:32064
  v_cvt_pk_bf16_f32 v224, v136, v137
  v_cvt_pk_bf16_f32 v225, v138, v139
  v_cvt_pk_bf16_f32 v226, v140, v141
  v_cvt_pk_bf16_f32 v227, v142, v143
  v_cvt_pk_bf16_f32 v228, v144, v145
  v_cvt_pk_bf16_f32 v229, v146, v147
  ds_write_b64 v22, v[224:225] offset:38400
  ds_write_b64 v22, v[226:227] offset:38408
  ds_write_b64 v16, v[228:229] offset:38464
  v_cvt_pk_bf16_f32 v230, v148, v149
  v_cvt_pk_bf16_f32 v231, v150, v151
  v_cvt_pk_bf16_f32 v232, v152, v153
  v_cvt_pk_bf16_f32 v233, v154, v155
  v_cvt_pk_bf16_f32 v234, v156, v157
  v_cvt_pk_bf16_f32 v235, v158, v159
  ds_write_b64 v22, v[230:231] offset:44800
  ds_write_b64 v22, v[232:233] offset:44808
  ds_write_b64 v16, v[234:235] offset:44864
  s_add_u32 s23, s49, 1
  s_waitcnt vmcnt(6)
  v_cmp_gt_u32 vcc, s23, v21
  s_mov_b32 s80, 0
  s_nop 0
  s_cbranch_vccnz qk_218
  s_mov_b32 s80, 1
  buffer_load_dwordx4 v[132:135], v31, s[52:55], s51 offen offset:0 sc1
  buffer_load_dwordx4 v[136:139], v31, s[52:55], s51 offen offset:512 sc1
  buffer_load_dwordx4 v[140:143], v31, s[52:55], s51 offen offset:1024 sc1
  buffer_load_dwordx4 v[144:147], v31, s[52:55], s51 offen offset:1536 sc1
  buffer_load_dwordx4 v[148:151], v31, s[52:55], s51 offen offset:2048 sc1
  buffer_load_dwordx4 v[152:155], v31, s[52:55], s51 offen offset:2560 sc1
qk_218:
  s_cmp_ge_u32 s79, 8
  s_cbranch_scc1 qk_217
  v_mov_b32 v156, 0
  s_mov_b32 s101, 0
wf_219:
  buffer_load_dword v157, v156, s[72:75], s76 offen sc1
  s_add_u32 s101, s101, 1
  s_cmp_gt_u32 s101, 131072
  s_cbranch_scc1 main_end
  s_waitcnt vmcnt(0)
  v_readfirstlane_b32 s100, v157
  s_cmp_ge_u32 s100, 8
  s_cbranch_scc1 wf_220
  s_sleep 2
  s_branch wf_219
wf_220:
  s_add_u32 s21, s50, 0
  buffer_load_dwordx4 v[36:39], v30, s[16:19], s21 offen offset:0 sc1
  buffer_load_dwordx4 v[40:43], v30, s[16:19], s21 offen offset:1024 sc1
  buffer_load_dwordx4 v[44:47], v30, s[16:19], s21 offen offset:2048 sc1
  buffer_load_dwordx4 v[48:51], v30, s[16:19], s21 offen offset:3072 sc1
  s_add_u32 s21, s50, 4096
  buffer_load_dwordx4 v[52:55], v30, s[16:19], s21 offen offset:0 sc1
  buffer_load_dwordx4 v[56:59], v30, s[16:19], s21 offen offset:1024 sc1
  buffer_load_dwordx4 v[60:63], v30, s[16:19], s21 offen offset:2048 sc1
  buffer_load_dwordx4 v[236:239], v30, s[16:19], s21 offen offset:3072 sc1
  s_add_u32 s21, s50, 8192
  buffer_load_dwordx4 v[240:243], v30, s[16:19], s21 offen offset:0 sc1
  buffer_load_dwordx4 v[244:247], v30, s[16:19], s21 offen offset:1024 sc1
  buffer_load_dwordx4 v[248:251], v30, s[16:19], s21 offen offset:2048 sc1
  buffer_load_dwordx4 v[252:255], v30, s[16:19], s21 offen offset:3072 sc1
qk_217:
  s_waitcnt lgkmcnt(0)
  s_barrier
  ds_read_b128 v[64:67], v29 offset:0
  ds_read_b128 v[68:71], v29 offset:64
  ds_read_b128 v[72:75], v29 offset:128
  ds_read_b128 v[76:79], v29 offset:192
  ds_read_b128 v[80:83], v29 offset:256
  ds_read_b128 v[84:87], v29 offset:320
  ds_read_b128 v[88:91], v29 offset:6400
  ds_read_b128 v[92:95], v29 offset:6464
  ds_read_b128 v[96:99], v29 offset:6528
  ds_read_b128 v[100:103], v29 offset:6592
  ds_read_b128 v[104:107], v29 offset:6656
  ds_read_b128 v[108:111], v29 offset:6720
  s_waitcnt lgkmcnt(0)
  s_cmp_eq_u32 s80, 1
  s_cselect_b32 s21, s79, 0
  s_cmp_ge_u32 s21, 8
  s_cbranch_scc1 qw_221
  s_waitcnt vmcnt(0)
qw_221:
  v_mfma_f32_16x16x32_bf16 v[112:115], v[36:39], v[64:67], 0
  v_mfma_f32_16x16x32_bf16 v[120:123], v[36:39], v[88:91], 0
  v_mfma_f32_16x16x32_bf16 v[124:127], v[60:63], v[88:91], 0
  v_mfma_f32_16x16x32_bf16 v[112:115], v[40:43], v[68:71], v[112:115]
  v_mfma_f32_16x16x32_bf16 v[120:123], v[40:43], v[92:95], v[120:123]
  v_mfma_f32_16x16x32_bf16 v[124:127], v[236:239], v[92:95], v[124:127]
  v_mfma_f32_16x16x32_bf16 v[112:115], v[44:47], v[72:75], v[112:115]
  v_mfma_f32_16x16x32_bf16 v[120:123], v[44:47], v[96:99], v[120:123]
  v_mfma_f32_16x16x32_bf16 v[124:127], v[240:243], v[96:99], v[124:127]
  v_mfma_f32_16x16x32_bf16 v[112:115], v[48:51], v[76:79], v[112:115]
  v_mfma_f32_16x16x32_bf16 v[120:123], v[48:51], v[100:103], v[120:123]
  v_mfma_f32_16x16x32_bf16 v[124:127], v[244:247], v[100:103], v[124:127]
  v_mfma_f32_16x16x32_bf16 v[112:115], v[52:55], v[80:83], v[112:115]
  v_mfma_f32_16x16x32_bf16 v[120:123], v[52:55], v[104:107], v[120:123]
  v_mfma_f32_16x16x32_bf16 v[124:127], v[248:251], v[104:107], v[124:127]
  v_mfma_f32_16x16x32_bf16 v[112:115], v[56:59], v[84:87], v[112:115]
  v_mfma_f32_16x16x32_bf16 v[120:123], v[56:59], v[108:111], v[120:123]
  v_mfma_f32_16x16x32_bf16 v[124:127], v[252:255], v[108:111], v[124:127]
  s_cmp_eq_u32 s80, 1
  s_cbranch_scc1 qm_222
  s_add_u32 s23, s49, 1
  s_mov_b32 s101, 0
wm_223:
  buffer_load_dword v156, v33, s[72:75], s77 offen sc1
  s_add_u32 s101, s101, 1
  s_cmp_gt_u32 s101, 131072
  s_cbranch_scc1 main_end
  s_waitcnt vmcnt(0)
  v_cmp_gt_u32 vcc, s23, v156
  v_readfirstlane_b32 s100, v156
  s_nop 0
  s_cbranch_vccz wm_224
  s_sleep 4
  s_add_u32 s100, s100, 2
  s_cmp_ge_u32 s100, s23
  s_cbranch_scc1 wm_223
  s_sleep 90
  s_branch wm_223
wm_224:
  buffer_load_dwordx4 v[132:135], v31, s[52:55], s51 offen offset:0 sc1
  buffer_load_dwordx4 v[136:139], v31, s[52:55], s51 offen offset:512 sc1
  buffer_load_dwordx4 v[140:143], v31, s[52:55], s51 offen offset:1024 sc1
  buffer_load_dwordx4 v[144:147], v31, s[52:55], s51 offen offset:1536 sc1
  buffer_load_dwordx4 v[148:151], v31, s[52:55], s51 offen offset:2048 sc1
  buffer_load_dwordx4 v[152:155], v31, s[52:55], s51 offen offset:2560 sc1
qm_222:
  s_waitcnt vmcnt(0)
  v_mfma_f32_16x16x32_bf16 v[116:119], v[132:135], v[64:67], 0
  v_mfma_f32_16x16x32_bf16 v[128:131], v[132:135], v[88:91], 0
  v_mfma_f32_16x16x32_bf16 v[116:119], v[136:139], v[68:71], v[116:119]
  v_mfma_f32_16x16x32_bf16 v[128:131], v[136:139], v[92:95], v[128:131]
  v_mfma_f32_16x16x32_bf16 v[116:119], v[140:143], v[72:75], v[116:119]
  v_mfma_f32_16x16x32_bf16 v[128:131], v[140:143], v[96:99], v[128:131]
  v_mfma_f32_16x16x32_bf16 v[116:119], v[144:147], v[76:79], v[116:119]
  v_mfma_f32_16x16x32_bf16 v[128:131], v[144:147], v[100:103], v[128:131]
  v_mfma_f32_16x16x32_bf16 v[116:119], v[148:151], v[80:83], v[116:119]
  v_mfma_f32_16x16x32_bf16 v[128:131], v[148:151], v[104:107], v[128:131]
  v_mfma_f32_16x16x32_bf16 v[116:119], v[152:155], v[84:87], v[116:119]
  v_mfma_f32_16x16x32_bf16 v[128:131], v[152:155], v[108:111], v[128:131]
  s_lshl_b32 s21, s49, 5
  s_add_u32 s21, s21, s42
  s_mul_i32 s81, s21, 2560
  s_lshl_b32 s82, s49, 3
  s_and_b32 s21, s42, 7
  s_add_u32 s82, s82, s21
  s_lshl_b32 s82, s82, 7
  s_add_u32 s82, s82, 23552
  s_cmp_gt_u32 s26, 1
  s_cselect_b32 s21, s80, 0
  s_cmp_eq_u32 s21, 0
  s_cbranch_scc1 qi_226
  v_mov_b32 v36, v112
  v_mov_b32 v37, v113
  v_mov_b32 v38, v114
  v_mov_b32 v39, v115
  v_mov_b32 v40, v116
  v_mov_b32 v41, v117
  v_mov_b32 v42, v118
  v_mov_b32 v43, v119
  v_mov_b32 v44, v120
  v_mov_b32 v45, v121
  v_mov_b32 v46, v122
  v_mov_b32 v47, v123
  v_mov_b32 v48, v124
  v_mov_b32 v49, v125
  v_mov_b32 v50, v126
  v_mov_b32 v51, v127
  v_mov_b32 v52, v128
  v_mov_b32 v53, v129
  v_mov_b32 v54, v130
  v_mov_b32 v55, v131
  s_branch qd_225
qi_226:
  v_cndmask_b32 v112, v34, v112, s[64:65]
  v_cndmask_b32 v124, v34, v124, s[64:65]
  v_cndmask_b32 v113, v34, v113, s[66:67]
  v_cndmask_b32 v125, v34, v125, s[66:67]
  v_cndmask_b32 v114, v34, v114, s[68:69]
  v_cndmask_b32 v126, v34, v126, s[68:69]
  v_cndmask_b32 v115, v34, v115, s[70:71]
  v_cndmask_b32 v127, v34, v127, s[70:71]
  v_max3_f32 v156, v112, v113, v114
  v_max3_f32 v156, v156, v115, v116
  v_max3_f32 v156, v156, v117, v118
  v_max_f32 v156, v156, v119
  v_mov_b32 v157, v156
  s_nop 1
  v_permlane32_swap_b32 v156, v157
  v_max_f32 v156, v156, v157
  v_mov_b32 v157, v156
  s_nop 1
  v_permlane16_swap_b32 v156, v157
  v_max_f32 v156, v156, v157
  v_mul_f32 v156, s83, v156
  v_fma_f32 v112, v112, s83, -v156
  v_fma_f32 v113, v113, s83, -v156
  v_fma_f32 v114, v114, s83, -v156
  v_fma_f32 v115, v115, s83, -v156
  v_fma_f32 v116, v116, s83, -v156
  v_fma_f32 v117, v117, s83, -v156
  v_fma_f32 v118, v118, s83, -v156
  v_fma_f32 v119, v119, s83, -v156
  v_exp_f32 v112, v112
  v_exp_f32 v113, v113
  v_exp_f32 v114, v114
  v_exp_f32 v115, v115
  v_exp_f32 v116, v116
  v_exp_f32 v117, v117
  v_exp_f32 v118, v118
  v_exp_f32 v119, v119
  s_nop 0
  v_add_f32 v156, v116, v117
  v_add_f32 v156, v156, v118
  v_add_f32 v156, v156, v119
  v_cndmask_b32 v156, 0, v156, s[60:61]
  v_add_f32 v156, v156, v112
  v_add_f32 v156, v156, v113
  v_add_f32 v156, v156, v114
  v_add_f32 v156, v156, v115
  v_mov_b32 v157, v156
  s_nop 1
  v_permlane32_swap_b32 v156, v157
  v_add_f32 v156, v156, v157
  v_mov_b32 v157, v156
  s_nop 1
  v_permlane16_swap_b32 v156, v157
  v_add_f32 v156, v156, v157
  v_rcp_f32 v156, v156
  s_nop 0
  v_mul_f32 v112, v112, v156
  v_mul_f32 v113, v113, v156
  v_mul_f32 v114, v114, v156
  v_mul_f32 v115, v115, v156
  v_mul_f32 v116, v116, v156
  v_mul_f32 v117, v117, v156
  v_mul_f32 v118, v118, v156
  v_mul_f32 v119, v119, v156
  v_max3_f32 v156, v120, v121, v122
  v_max3_f32 v156, v156, v123, v124
  v_max3_f32 v156, v156, v125, v126
  v_max3_f32 v156, v156, v127, v128
  v_max3_f32 v156, v156, v129, v130
  v_max_f32 v156, v156, v131
  v_mov_b32 v157, v156
  s_nop 1
  v_permlane32_swap_b32 v156, v157
  v_max_f32 v156, v156, v157
  v_mov_b32 v157, v156
  s_nop 1
  v_permlane16_swap_b32 v156, v157
  v_max_f32 v156, v156, v157
  v_mul_f32 v156, s83, v156
  v_fma_f32 v120, v120, s83, -v156
  v_fma_f32 v121, v121, s83, -v156
  v_fma_f32 v122, v122, s83, -v156
  v_fma_f32 v123, v123, s83, -v156
  v_fma_f32 v124, v124, s83, -v156
  v_fma_f32 v125, v125, s83, -v156
  v_fma_f32 v126, v126, s83, -v156
  v_fma_f32 v127, v127, s83, -v156
  v_fma_f32 v128, v128, s83, -v156
  v_fma_f32 v129, v129, s83, -v156
  v_fma_f32 v130, v130, s83, -v156
  v_fma_f32 v131, v131, s83, -v156
  v_exp_f32 v120, v120
  v_exp_f32 v121, v121
  v_exp_f32 v122, v122
  v_exp_f32 v123, v123
  v_exp_f32 v124, v124
  v_exp_f32 v125, v125
  v_exp_f32 v126, v126
  v_exp_f32 v127, v127
  v_exp_f32 v128, v128
  v_exp_f32 v129, v129
  v_exp_f32 v130, v130
  v_exp_f32 v131, v131
  s_nop 0
  v_add_f32 v156, v128, v129
  v_add_f32 v156, v156, v130
  v_add_f32 v156, v156, v131
  v_cndmask_b32 v156, 0, v156, s[60:61]
  v_add_f32 v156, v156, v120
  v_add_f32 v156, v156, v121
  v_add_f32 v156, v156, v122
  v_add_f32 v156, v156, v123
  v_add_f32 v156, v156, v124
  v_add_f32 v156, v156, v125
  v_add_f32 v156, v156, v126
  v_add_f32 v156, v156, v127
  v_mov_b32 v157, v156
  s_nop 1
  v_permlane32_swap_b32 v156, v157
  v_add_f32 v156, v156, v157
  v_mov_b32 v157, v156
  s_nop 1
  v_permlane16_swap_b32 v156, v157
  v_add_f32 v156, v156, v157
  v_rcp_f32 v156, v156
  s_nop 0
  v_mul_f32 v120, v120, v156
  v_mul_f32 v121, v121, v156
  v_mul_f32 v122, v122, v156
  v_mul_f32 v123, v123, v156
  v_mul_f32 v124, v124, v156
  v_mul_f32 v125, v125, v156
  v_mul_f32 v126, v126, v156
  v_mul_f32 v127, v127, v156
  v_mul_f32 v128, v128, v156
  v_mul_f32 v129, v129, v156
  v_mul_f32 v130, v130, v156
  v_mul_f32 v131, v131, v156
  v_cvt_pk_bf16_f32 v196, v116, v117
  v_cvt_pk_bf16_f32 v197, v118, v119
  v_cvt_pk_bf16_f32 v198, v128, v129
  v_cvt_pk_bf16_f32 v199, v130, v131
  v_cvt_pk_bf16_f32 v192, v120, v121
  v_cvt_pk_bf16_f32 v193, v122, v123
  v_cvt_pk_bf16_f32 v194, v124, v125
  v_cvt_pk_bf16_f32 v195, v126, v127
  v_cvt_pk_bf16_f32 v200, v112, v113
  v_cvt_pk_bf16_f32 v201, v114, v115
  v_permlane16_swap_b32 v196, v198
  v_permlane16_swap_b32 v197, v199
  buffer_store_dwordx4 v[192:195], v30, s[56:59], s81 offen sc1
  s_mov_b64 exec, 0xffffffff
  buffer_store_dwordx4 v[196:199], v30, s[56:59], s81 offen offset:1024 sc1
  s_mov_b64 exec, -1
  buffer_store_dwordx2 v[200:201], v32, s[56:59], s81 offen offset:2048 sc1
  s_mov_b32 s78, s82
  s_mov_b32 s81, 0x80000000
  s_mov_b32 s82, 0
  s_cmp_eq_u32 s80, 1
  s_cbranch_scc1 qd_225
  s_waitcnt vmcnt(0)
  s_cmp_eq_u32 s78, 0
  s_cbranch_scc1 pf_227
  v_mov_b32 v4, 0
  v_mov_b32 v5, 1
  s_mov_b64 exec, 1
  buffer_atomic_add v5, v4, s[72:75], s78 offen sc1
  s_mov_b64 exec, -1
  s_mov_b32 s78, 0
pf_227:
qd_225:
  s_add_u32 s49, s49, s29
qbe_216:
  s_sub_u32 s26, s26, 1
  s_cmp_gt_u32 s26, 0
  s_waitcnt lgkmcnt(0)
  s_cbranch_scc1 qa_blk_214
  s_waitcnt vmcnt(0) lgkmcnt(0)
  s_add_u32 s12, s38, 201326592
  s_addc_u32 s13, s39, 0
  s_mov_b32 s14, 6291456
  s_mov_b32 s15, 0x00020000
  s_cmp_eq_u32 s78, 0
  s_cbranch_scc1 pf_228
  v_mov_b32 v4, 0
  v_mov_b32 v5, 1
  s_mov_b64 exec, 1
  buffer_atomic_add v5, v4, s[72:75], s78 offen sc1
  s_mov_b64 exec, -1
  s_mov_b32 s78, 0
pf_228:
  s_lshl_b32 s21, s42, 7
  s_add_u32 s21, s21, 112640
  v_mov_b32 v156, 0
  s_mov_b32 s101, 0
wf_229:
  buffer_load_dword v157, v156, s[72:75], s21 offen sc1
  s_add_u32 s101, s101, 1
  s_cmp_gt_u32 s101, 131072
  s_cbranch_scc1 main_end
  s_waitcnt vmcnt(0)
  v_readfirstlane_b32 s100, v157
  s_cmp_ge_u32 s100, 4
  s_cbranch_scc1 wf_230
  s_sleep 16
  s_branch wf_229
wf_230:
qf_231:
  s_mul_i32 s21, s49, 393216
  s_mul_i32 s22, s42, 12288
  s_add_u32 s50, s21, s22
  s_mul_i32 s21, s49, 98304
  s_mul_i32 s22, s42, 3072
  s_add_u32 s51, s21, s22
  s_lshr_b32 s22, s49, 1
  s_lshr_b32 s21, s49, 2
  s_add_u32 s21, s21, 3
  s_cmp_lt_u32 s49, 12
  s_cselect_b32 s21, s22, s21
  s_lshl_b32 s21, s21, 3
  s_lshr_b32 s22, s42, 2
  s_add_u32 s21, s21, s22
  s_lshl_b32 s21, s21, 7
  s_add_u32 s76, s21, 0
  s_lshl_b32 s77, s42, 7
  s_add_u32 s77, s77, 19456
  s_sub_u32 s43, s50, 18874368
  buffer_load_dword v21, v33, s[72:75], s77 offen sc1
  s_add_u32 s21, s50, 0
  buffer_load_dwordx4 v[36:39], v30, s[16:19], s21 offen offset:0 sc1
  buffer_load_dwordx4 v[40:43], v30, s[16:19], s21 offen offset:1024 sc1
  buffer_load_dwordx4 v[44:47], v30, s[16:19], s21 offen offset:2048 sc1
  buffer_load_dwordx4 v[48:51], v30, s[16:19], s21 offen offset:3072 sc1
  s_add_u32 s21, s50, 4096
  buffer_load_dwordx4 v[52:55], v30, s[16:19], s21 offen offset:0 sc1
  buffer_load_dwordx4 v[56:59], v30, s[16:19], s21 offen offset:1024 sc1
  buffer_load_dwordx4 v[60:63], v30, s[16:19], s21 offen offset:2048 sc1
  buffer_load_dwordx4 v[236:239], v30, s[16:19], s21 offen offset:3072 sc1
  s_add_u32 s21, s50, 8192
  buffer_load_dwordx4 v[240:243], v30, s[16:19], s21 offen offset:0 sc1
  buffer_load_dwordx4 v[244:247], v30, s[16:19], s21 offen offset:1024 sc1
  buffer_load_dwordx4 v[248:251], v30, s[16:19], s21 offen offset:2048 sc1
  buffer_load_dwordx4 v[252:255], v30, s[16:19], s21 offen offset:3072 sc1
  s_add_u32 s21, s43, 0
  buffer_load_dwordx4 v[64:67], v30, s[12:15], s21 offen offset:0 sc1
  buffer_load_dwordx4 v[68:71], v30, s[12:15], s21 offen offset:1024 sc1
  buffer_load_dwordx4 v[72:75], v30, s[12:15], s21 offen offset:2048 sc1
  buffer_load_dwordx4 v[76:79], v30, s[12:15], s21 offen offset:3072 sc1
  s_add_u32 s21, s43, 4096
  buffer_load_dwordx4 v[80:83], v30, s[12:15], s21 offen offset:0 sc1
  buffer_load_dwordx4 v[84:87], v30, s[12:15], s21 offen offset:1024 sc1
  buffer_load_dwordx4 v[88:91], v30, s[12:15], s21 offen offset:2048 sc1
  buffer_load_dwordx4 v[92:95], v30, s[12:15], s21 offen offset:3072 sc1
  s_add_u32 s21, s43, 8192
  buffer_load_dwordx4 v[96:99], v30, s[12:15], s21 offen offset:0 sc1
  buffer_load_dwordx4 v[100:103], v30, s[12:15], s21 offen offset:1024 sc1
  buffer_load_dwordx4 v[104:107], v30, s[12:15], s21 offen offset:2048 sc1
  buffer_load_dwordx4 v[108:111], v30, s[12:15], s21 offen offset:3072 sc1
  s_waitcnt vmcnt(24)
  s_cmp_eq_u32 s78, 0
  s_cbranch_scc1 pf_234
  v_mov_b32 v4, 0
  v_mov_b32 v5, 1
  s_mov_b64 exec, 1
  buffer_atomic_add v5, v4, s[72:75], s78 offen sc1
  s_mov_b64 exec, -1
  s_mov_b32 s78, 0
pf_234:
  s_add_u32 s23, s49, 1
  v_cmp_gt_u32 vcc, s23, v21
  s_mov_b32 s80, 0
  s_nop 0
  s_cbranch_vccnz qk_233
  s_mov_b32 s80, 1
  buffer_load_dwordx4 v[132:135], v31, s[52:55], s51 offen offset:0 sc1
  buffer_load_dwordx4 v[136:139], v31, s[52:55], s51 offen offset:512 sc1
  buffer_load_dwordx4 v[140:143], v31, s[52:55], s51 offen offset:1024 sc1
  buffer_load_dwordx4 v[144:147], v31, s[52:55], s51 offen offset:1536 sc1
  buffer_load_dwordx4 v[148:151], v31, s[52:55], s51 offen offset:2048 sc1
  buffer_load_dwordx4 v[152:155], v31, s[52:55], s51 offen offset:2560 sc1
  s_waitcnt vmcnt(6)
  s_branch qk_233x
qk_233:
  s_waitcnt vmcnt(0)
qk_233x:
  v_mfma_f32_16x16x32_bf16 v[112:115], v[36:39], v[64:67], 0
  v_mfma_f32_16x16x32_bf16 v[120:123], v[36:39], v[88:91], 0
  v_mfma_f32_16x16x32_bf16 v[124:127], v[60:63], v[88:91], 0
  v_mfma_f32_16x16x32_bf16 v[112:115], v[40:43], v[68:71], v[112:115]
  v_mfma_f32_16x16x32_bf16 v[120:123], v[40:43], v[92:95], v[120:123]
  v_mfma_f32_16x16x32_bf16 v[124:127], v[236:239], v[92:95], v[124:127]
  v_mfma_f32_16x16x32_bf16 v[112:115], v[44:47], v[72:75], v[112:115]
  v_mfma_f32_16x16x32_bf16 v[120:123], v[44:47], v[96:99], v[120:123]
  v_mfma_f32_16x16x32_bf16 v[124:127], v[240:243], v[96:99], v[124:127]
  v_mfma_f32_16x16x32_bf16 v[112:115], v[48:51], v[76:79], v[112:115]
  v_mfma_f32_16x16x32_bf16 v[120:123], v[48:51], v[100:103], v[120:123]
  v_mfma_f32_16x16x32_bf16 v[124:127], v[244:247], v[100:103], v[124:127]
  v_mfma_f32_16x16x32_bf16 v[112:115], v[52:55], v[80:83], v[112:115]
  v_mfma_f32_16x16x32_bf16 v[120:123], v[52:55], v[104:107], v[120:123]
  v_mfma_f32_16x16x32_bf16 v[124:127], v[248:251], v[104:107], v[124:127]
  v_mfma_f32_16x16x32_bf16 v[112:115], v[56:59], v[84:87], v[112:115]
  v_mfma_f32_16x16x32_bf16 v[120:123], v[56:59], v[108:111], v[120:123]
  v_mfma_f32_16x16x32_bf16 v[124:127], v[252:255], v[108:111], v[124:127]
  s_cmp_eq_u32 s80, 1
  s_cbranch_scc1 qm_235
  s_add_u32 s23, s49, 1
  s_min_u32 s22, s49, 62
  s_cmp_lt_u32 s49, 62
  s_cselect_b32 s23, s23, s22
  s_mov_b32 s101, 0
wm_236:
  buffer_load_dword v156, v33, s[72:75], s77 offen sc1
  s_add_u32 s101, s101, 1
  s_cmp_gt_u32 s101, 131072
  s_cbranch_scc1 main_end
  s_waitcnt vmcnt(0)
  v_cmp_gt_u32 vcc, s23, v156
  v_readfirstlane_b32 s100, v156
  s_nop 0
  s_cbranch_vccz wm_237
  s_sleep 4
  s_add_u32 s100, s100, 2
  s_cmp_ge_u32 s100, s23
  s_cbranch_scc1 wm_236
  s_sleep 90
  s_branch wm_236
wm_237:
  s_mov_b32 s101, 0
  s_branch qtp_239
qtp_238:
  s_sleep 3
qtp_239:
  buffer_load_dwordx4 v[132:135], v31, s[52:55], s51 offen offset:0 sc1
  buffer_load_dwordx4 v[136:139], v31, s[52:55], s51 offen offset:512 sc1
  buffer_load_dwordx4 v[140:143], v31, s[52:55], s51 offen offset:1024 sc1
  buffer_load_dwordx4 v[144:147], v31, s[52:55], s51 offen offset:1536 sc1
  buffer_load_dwordx4 v[148:151], v31, s[52:55], s51 offen offset:2048 sc1
  buffer_load_dwordx4 v[152:155], v31, s[52:55], s51 offen offset:2560 sc1
  s_add_u32 s101, s101, 1
  s_cmp_gt_u32 s101, 131072
  s_cbranch_scc1 main_end
  s_waitcnt vmcnt(0)
  v_max3_u32 v156, v132, v134, v136
  v_max3_u32 v156, v156, v138, v140
  v_max3_u32 v156, v156, v142, v144
  v_max3_u32 v156, v156, v146, v148
  v_max3_u32 v156, v156, v150, v152
  v_max3_u32 v156, v156, v154, v154
  v_cmp_eq_u32 vcc, -1, v156
  s_nop 1
  s_cbranch_vccnz qtp_238
qm_235:
  s_waitcnt vmcnt(0)
  v_mfma_f32_16x16x32_bf16 v[116:119], v[132:135], v[64:67], 0
  v_mfma_f32_16x16x32_bf16 v[128:131], v[132:135], v[88:91], 0
  v_mfma_f32_16x16x32_bf16 v[116:119], v[136:139], v[68:71], v[116:119]
  v_mfma_f32_16x16x32_bf16 v[128:131], v[136:139], v[92:95], v[128:131]
  v_mfma_f32_16x16x32_bf16 v[116:119], v[140:143], v[72:75], v[116:119]
  v_mfma_f32_16x16x32_bf16 v[128:131], v[140:143], v[96:99], v[128:131]
  v_mfma_f32_16x16x32_bf16 v[116:119], v[144:147], v[76:79], v[116:119]
  v_mfma_f32_16x16x32_bf16 v[128:131], v[144:147], v[100:103], v[128:131]
  v_mfma_f32_16x16x32_bf16 v[116:119], v[148:151], v[80:83], v[116:119]
  v_mfma_f32_16x16x32_bf16 v[128:131], v[148:151], v[104:107], v[128:131]
  v_mfma_f32_16x16x32_bf16 v[116:119], v[152:155], v[84:87], v[116:119]
  v_mfma_f32_16x16x32_bf16 v[128:131], v[152:155], v[108:111], v[128:131]
  s_lshl_b32 s21, s49, 5
  s_add_u32 s21, s21, s42
  s_mul_i32 s81, s21, 2560
  s_lshl_b32 s82, s49, 3
  s_and_b32 s21, s42, 7
  s_add_u32 s82, s82, s21
  s_lshl_b32 s82, s82, 7
  s_add_u32 s82, s82, 23552
  v_cndmask_b32 v112, v34, v112, s[64:65]
  v_cndmask_b32 v124, v34, v124, s[64:65]
  v_cndmask_b32 v113, v34, v113, s[66:67]
  v_cndmask_b32 v125, v34, v125, s[66:67]
  v_cndmask_b32 v114, v34, v114, s[68:69]
  v_cndmask_b32 v126, v34, v126, s[68:69]
  v_cndmask_b32 v115, v34, v115, s[70:71]
  v_cndmask_b32 v127, v34, v127, s[70:71]
  v_max3_f32 v156, v112, v113, v114
  v_max3_f32 v156, v156, v115, v116
  v_max3_f32 v156, v156, v117, v118
  v_max_f32 v156, v156, v119
  v_mov_b32 v157, v156
  s_nop 1
  v_permlane32_swap_b32 v156, v157
  v_max_f32 v156, v156, v157
  v_mov_b32 v157, v156
  s_nop 1
  v_permlane16_swap_b32 v156, v157
  v_max_f32 v156, v156, v157
  v_mul_f32 v156, s83, v156
  v_fma_f32 v112, v112, s83, -v156
  v_fma_f32 v113, v113, s83, -v156
  v_fma_f32 v114, v114, s83, -v156
  v_fma_f32 v115, v115, s83, -v156
  v_fma_f32 v116, v116, s83, -v156
  v_fma_f32 v117, v117, s83, -v156
  v_fma_f32 v118, v118, s83, -v156
  v_fma_f32 v119, v119, s83, -v156
  v_exp_f32 v112, v112
  v_exp_f32 v113, v113
  v_exp_f32 v114, v114
  v_exp_f32 v115, v115
  v_exp_f32 v116, v116
  v_exp_f32 v117, v117
  v_exp_f32 v118, v118
  v_exp_f32 v119, v119
  s_nop 0
  v_add_f32 v156, v116, v117
  v_add_f32 v156, v156, v118
  v_add_f32 v156, v156, v119
  v_cndmask_b32 v156, 0, v156, s[60:61]
  v_add_f32 v156, v156, v112
  v_add_f32 v156, v156, v113
  v_add_f32 v156, v156, v114
  v_add_f32 v156, v156, v115
  v_mov_b32 v157, v156
  s_nop 1
  v_permlane32_swap_b32 v156, v157
  v_add_f32 v156, v156, v157
  v_mov_b32 v157, v156
  s_nop 1
  v_permlane16_swap_b32 v156, v157
  v_add_f32 v156, v156, v157
  v_rcp_f32 v156, v156
  s_nop 0
  v_mul_f32 v112, v112, v156
  v_mul_f32 v113, v113, v156
  v_mul_f32 v114, v114, v156
  v_mul_f32 v115, v115, v156
  v_mul_f32 v116, v116, v156
  v_mul_f32 v117, v117, v156
  v_mul_f32 v118, v118, v156
  v_mul_f32 v119, v119, v156
  v_max3_f32 v156, v120, v121, v122
  v_max3_f32 v156, v156, v123, v124
  v_max3_f32 v156, v156, v125, v126
  v_max3_f32 v156, v156, v127, v128
  v_max3_f32 v156, v156, v129, v130
  v_max_f32 v156, v156, v131
  v_mov_b32 v157, v156
  s_nop 1
  v_permlane32_swap_b32 v156, v157
  v_max_f32 v156, v156, v157
  v_mov_b32 v157, v156
  s_nop 1
  v_permlane16_swap_b32 v156, v157
  v_max_f32 v156, v156, v157
  v_mul_f32 v156, s83, v156
  v_fma_f32 v120, v120, s83, -v156
  v_fma_f32 v121, v121, s83, -v156
  v_fma_f32 v122, v122, s83, -v156
  v_fma_f32 v123, v123, s83, -v156
  v_fma_f32 v124, v124, s83, -v156
  v_fma_f32 v125, v125, s83, -v156
  v_fma_f32 v126, v126, s83, -v156
  v_fma_f32 v127, v127, s83, -v156
  v_fma_f32 v128, v128, s83, -v156
  v_fma_f32 v129, v129, s83, -v156
  v_fma_f32 v130, v130, s83, -v156
  v_fma_f32 v131, v131, s83, -v156
  v_exp_f32 v120, v120
  v_exp_f32 v121, v121
  v_exp_f32 v122, v122
  v_exp_f32 v123, v123
  v_exp_f32 v124, v124
  v_exp_f32 v125, v125
  v_exp_f32 v126, v126
  v_exp_f32 v127, v127
  v_exp_f32 v128, v128
  v_exp_f32 v129, v129
  v_exp_f32 v130, v130
  v_exp_f32 v131, v131
  s_nop 0
  v_add_f32 v156, v128, v129
  v_add_f32 v156, v156, v130
  v_add_f32 v156, v156, v131
  v_cndmask_b32 v156, 0, v156, s[60:61]
  v_add_f32 v156, v156, v120
  v_add_f32 v156, v156, v121
  v_add_f32 v156, v156, v122
  v_add_f32 v156, v156, v123
  v_add_f32 v156, v156, v124
  v_add_f32 v156, v156, v125
  v_add_f32 v156, v156, v126
  v_add_f32 v156, v156, v127
  v_mov_b32 v157, v156
  s_nop 1
  v_permlane32_swap_b32 v156, v157
  v_add_f32 v156, v156, v157
  v_mov_b32 v157, v156
  s_nop 1
  v_permlane16_swap_b32 v156, v157
  v_add_f32 v156, v156, v157
  v_rcp_f32 v156, v156
  s_nop 0
  v_mul_f32 v120, v120, v156
  v_mul_f32 v121, v121, v156
  v_mul_f32 v122, v122, v156
  v_mul_f32 v123, v123, v156
  v_mul_f32 v124, v124, v156
  v_mul_f32 v125, v125, v156
  v_mul_f32 v126, v126, v156
  v_mul_f32 v127, v127, v156
  v_mul_f32 v128, v128, v156
  v_mul_f32 v129, v129, v156
  v_mul_f32 v130, v130, v156
  v_mul_f32 v131, v131, v156
  v_cvt_pk_bf16_f32 v196, v116, v117
  v_cvt_pk_bf16_f32 v197, v118, v119
  v_cvt_pk_bf16_f32 v198, v128, v129
  v_cvt_pk_bf16_f32 v199, v130, v131
  v_cvt_pk_bf16_f32 v192, v120, v121
  v_cvt_pk_bf16_f32 v193, v122, v123
  v_cvt_pk_bf16_f32 v194, v124, v125
  v_cvt_pk_bf16_f32 v195, v126, v127
  v_cvt_pk_bf16_f32 v200, v112, v113
  v_cvt_pk_bf16_f32 v201, v114, v115
  v_permlane16_swap_b32 v196, v198
  v_permlane16_swap_b32 v197, v199
  buffer_store_dwordx4 v[192:195], v30, s[56:59], s81 offen sc1
  s_mov_b64 exec, 0xffffffff
  buffer_store_dwordx4 v[196:199], v30, s[56:59], s81 offen offset:1024 sc1
  s_mov_b64 exec, -1
  buffer_store_dwordx2 v[200:201], v32, s[56:59], s81 offen offset:2048 sc1
  s_mov_b32 s78, s82
  s_mov_b32 s81, 0x80000000
  s_mov_b32 s82, 0
  s_cmp_eq_u32 s80, 1
  s_cbranch_scc1 qd_240
  s_waitcnt vmcnt(0)
  s_cmp_eq_u32 s78, 0
  s_cbranch_scc1 pf_241
  v_mov_b32 v4, 0
  v_mov_b32 v5, 1
  s_mov_b64 exec, 1
  buffer_atomic_add v5, v4, s[72:75], s78 offen sc1
  s_mov_b64 exec, -1
  s_mov_b32 s78, 0
pf_241:
qd_240:
  s_add_u32 s49, s49, s29
qbe_232:
  s_cmp_lt_u32 s49, 64
  s_cbranch_scc1 qf_231
  s_waitcnt vmcnt(0)
  s_cmp_eq_u32 s78, 0
  s_cbranch_scc1 pf_242
  v_mov_b32 v4, 0
  v_mov_b32 v5, 1
  s_mov_b64 exec, 1
  buffer_atomic_add v5, v4, s[72:75], s78 offen sc1
  s_mov_b64 exec, -1
  s_mov_b32 s78, 0
pf_242:
queue:
  s_load_dwordx2 s[4:5], s[0:1], 96
  s_waitcnt lgkmcnt(0)
  s_mov_b32 s32, s4
  s_mov_b32 s33, s5
  s_mov_b32 s34, 256
  s_mov_b32 s35, 0x00020000
  s_waitcnt vmcnt(0) lgkmcnt(0)
  s_barrier
  s_mov_b32 s2, s85
  s_mov_b32 s85, -1
  s_cmp_lg_u32 s2, -1
  s_cbranch_scc1 queue_c
  v_mov_b32 v21, 0
  s_cmp_lg_u32 s20, 0
  s_cbranch_scc1 q_243
  v_mov_b32 v22, 80
  v_mov_b32 v23, 1
  s_mov_b64 exec, 1
  buffer_atomic_add v23, v22, s[32:35], 0 offen sc0 sc1
  s_waitcnt vmcnt(0)
queue_a:
  ds_write_b32 v21, v23
  s_waitcnt lgkmcnt(0)
  s_mov_b64 exec, -1
q_243:
queue_b:
  s_barrier
  ds_read_b32 v23, v21
  s_waitcnt lgkmcnt(0)
  v_readfirstlane_b32 s2, v23
  s_barrier
queue_c:
  s_add_u32 s21, s2, 0
  s_cmp_lt_u32 s2, 334
  s_cbranch_scc1 do_pv
  s_sub_u32 s2, s2, 334
  s_branch main_fin
do_opb:
  s_mov_b32 s87, -1
do_opb2:
  s_mov_b32 s2, s21
  s_load_dwordx2 s[4:5], s[0:1], 0
  s_load_dwordx4 s[40:43], s[0:1], 72
  s_load_dwordx2 s[38:39], s[0:1], 104
  s_lshl_b32 s59, s2, 2
  s_add_u32 s59, s59, s20
  s_lshl_b32 s59, s59, 3
  v_lshlrev_b32 v4, 4, v1
  v_lshlrev_b32 v5, 2, v1
  s_waitcnt lgkmcnt(0)
  s_mov_b32 s8, s4
  s_mov_b32 s9, s5
  s_mov_b32 s10, 2621440
  s_mov_b32 s11, 0x00020000
  s_mov_b32 s12, s42
  s_mov_b32 s13, s43
  s_mov_b32 s14, 1280
  s_mov_b32 s15, 0x00020000
  s_mov_b32 s24, s40
  s_mov_b32 s25, s41
  s_mov_b32 s26, 819200
  s_mov_b32 s27, 0x00020000
  s_add_u32 s16, s38, 70713344
  s_addc_u32 s17, s39, 0
  s_mov_b32 s18, 2641920
  s_mov_b32 s19, 0x00020000
  s_add_u32 s28, s38, 81002496
  s_addc_u32 s29, s39, 0
  s_mov_b32 s30, 8192
  s_mov_b32 s31, 0x00020000
  s_add_u32 s72, s38, 81068032
  s_addc_u32 s73, s39, 0
  s_mov_b32 s74, 116736
  s_mov_b32 s75, 0x00020000
  s_mov_b32 s21, 91136
  v_mov_b32 v20, 0
  buffer_load_dword v21, v20, s[72:75], s21 offen sc1
  v_mov_b32 v29, 3277
  s_mul_i32 s21, s20, 320
  s_add_u32 s21, s21, 0
  v_add_u32 v22, s21, v1
  v_mul_u32_u24 v23, v22, v29
  v_lshrrev_b32 v23, 16, v23
  v_mul_u32_u24 v24, 20, v23
  v_sub_u32 v22, v22, v24
  v_bfe_u32 v24, v23, 3, 1
  v_lshlrev_b32 v24, 1, v24
  v_xor_b32 v22, v22, v24
  v_mul_u32_u24 v23, 1280, v23
  v_lshl_add_u32 v8, v22, 4, v23
  s_mul_i32 s21, s20, 320
  s_add_u32 s21, s21, 64
  v_add_u32 v22, s21, v1
  v_mul_u32_u24 v23, v22, v29
  v_lshrrev_b32 v23, 16, v23
  v_mul_u32_u24 v24, 20, v23
  v_sub_u32 v22, v22, v24
  v_bfe_u32 v24, v23, 3, 1
  v_lshlrev_b32 v24, 1, v24
  v_xor_b32 v22, v22, v24
  v_mul_u32_u24 v23, 1280, v23
  v_lshl_add_u32 v9, v22, 4, v23
  s_mul_i32 s21, s20, 320
  s_add_u32 s21, s21, 128
  v_add_u32 v22, s21, v1
  v_mul_u32_u24 v23, v22, v29
  v_lshrrev_b32 v23, 16, v23
  v_mul_u32_u24 v24, 20, v23
  v_sub_u32 v22, v22, v24
  v_bfe_u32 v24, v23, 3, 1
  v_lshlrev_b32 v24, 1, v24
  v_xor_b32 v22, v22, v24
  v_mul_u32_u24 v23, 1280, v23
  v_lshl_add_u32 v10, v22, 4, v23
  s_mul_i32 s21, s20, 320
  s_add_u32 s21, s21, 192
  v_add_u32 v22, s21, v1
  v_mul_u32_u24 v23, v22, v29
  v_lshrrev_b32 v23, 16, v23
  v_mul_u32_u24 v24, 20, v23
  v_sub_u32 v22, v22, v24
  v_bfe_u32 v24, v23, 3, 1
  v_lshlrev_b32 v24, 1, v24
  v_xor_b32 v22, v22, v24
  v_mul_u32_u24 v23, 1280, v23
  v_lshl_add_u32 v11, v22, 4, v23
  s_mul_i32 s21, s20, 320
  s_add_u32 s21, s21, 256
  v_add_u32 v22, s21, v1
  v_mul_u32_u24 v23, v22, v29
  v_lshrrev_b32 v23, 16, v23
  v_mul_u32_u24 v24, 20, v23
  v_sub_u32 v22, v22, v24
  v_bfe_u32 v24, v23, 3, 1
  v_lshlrev_b32 v24, 1, v24
  v_xor_b32 v22, v22, v24
  v_mul_u32_u24 v23, 1280, v23
  v_lshl_add_u32 v12, v22, 4, v23
  s_and_b32 s44, s2, 3
  s_mul_i32 s45, s44, 320
  s_mul_i32 s46, s20, 5120
  v_and_b32 v22, 1, v2
  v_mul_u32_u24 v22, 16512, v22
  v_mul_u32_u24 v23, 33024, v3
  v_lshrrev_b32 v24, 1, v2
  v_lshlrev_b32 v24, 4, v24
  v_add3_u32 v6, v22, v23, v24
  s_lshr_b32 s47, s2, 2
  s_lshl_b32 s47, s47, 2
  s_add_u32 s47, s47, s20
  s_lshl_b32 s47, s47, 1
  s_lshl_b32 s48, s47, 7
  v_lshrrev_b32 v22, 2, v2
  v_lshl_add_u32 v22, v3, 3, v22
  v_mul_u32_u24 v22, 320, v22
  v_and_b32 v23, 3, v2
  v_lshl_add_u32 v22, v23, 3, v22
  v_and_b32 v23, 1, v3
  v_lshlrev_b32 v23, 5, v23
  v_add_u32 v14, v22, v23
  v_sub_u32 v15, v22, v23
  v_add_u32 v16, 61440, v14
  v_add_u32 v17, 61440, v15
  v_add_u32 v18, 122880, v14
  v_add_u32 v19, 122880, v15
  s_add_u32 m0, s46, 0
  s_add_u32 s49, s45, 0
  s_nop 0
  buffer_load_dwordx4 v8, s[24:27], s49 offen lds
  s_add_u32 m0, s46, 1024
  s_nop 0
  buffer_load_dwordx4 v9, s[24:27], s49 offen lds
  s_add_u32 m0, s46, 2048
  s_nop 0
  buffer_load_dwordx4 v10, s[24:27], s49 offen lds
  s_add_u32 m0, s46, 3072
  s_nop 0
  buffer_load_dwordx4 v11, s[24:27], s49 offen lds
  s_add_u32 m0, s46, 4096
  s_nop 0
  buffer_load_dwordx4 v12, s[24:27], s49 offen lds
  s_add_u32 m0, s46, 20480
  s_add_u32 s49, s45, 81920
  s_nop 0
  buffer_load_dwordx4 v8, s[24:27], s49 offen lds
  s_add_u32 m0, s46, 21504
  s_nop 0
  buffer_load_dwordx4 v9, s[24:27], s49 offen lds
  s_add_u32 m0, s46, 22528
  s_nop 0
  buffer_load_dwordx4 v10, s[24:27], s49 offen lds
  s_add_u32 m0, s46, 23552
  s_nop 0
  buffer_load_dwordx4 v11, s[24:27], s49 offen lds
  s_add_u32 m0, s46, 24576
  s_nop 0
  buffer_load_dwordx4 v12, s[24:27], s49 offen lds
  s_waitcnt vmcnt(10)
  v_readfirstlane_b32 s21, v21
  s_cmp_ge_u32 s21, 32
  s_cbranch_scc1 o2_244
  s_mov_b32 s21, 91136
  v_mov_b32 v20, 0
  s_mov_b32 s101, 0
wf_245:
  buffer_load_dword v21, v20, s[72:75], s21 offen sc1
  s_add_u32 s101, s101, 1
  s_cmp_gt_u32 s101, 131072
  s_cbranch_scc1 main_end
  s_waitcnt vmcnt(0)
  v_readfirstlane_b32 s100, v21
  s_cmp_ge_u32 s100, 32
  s_cbranch_scc1 wf_246
  s_sleep 32
  s_branch wf_245
wf_246:
o2_244:
  buffer_load_dwordx4 a[0:3], v6, s[16:19], s48 offen offset:0 sc1
  buffer_load_dwordx4 a[4:7], v6, s[16:19], s48 offen offset:128 sc1
  s_add_u32 s48, s48, 132096
  buffer_load_dwordx4 a[8:11], v6, s[16:19], s48 offen offset:0 sc1
  buffer_load_dwordx4 a[12:15], v6, s[16:19], s48 offen offset:128 sc1
  s_add_u32 s48, s48, 132096
  buffer_load_dwordx4 a[16:19], v6, s[16:19], s48 offen offset:0 sc1
  buffer_load_dwordx4 a[20:23], v6, s[16:19], s48 offen offset:128 sc1
  s_add_u32 s48, s48, 132096
  buffer_load_dwordx4 a[24:27], v6, s[16:19], s48 offen offset:0 sc1
  buffer_load_dwordx4 a[28:31], v6, s[16:19], s48 offen offset:128 sc1
  s_add_u32 s48, s48, 132096
  s_add_u32 m0, s46, 40960
  s_add_u32 s49, s45, 163840
  s_nop 0
  buffer_load_dwordx4 v8, s[24:27], s49 offen lds
  s_add_u32 m0, s46, 41984
  s_nop 0
  buffer_load_dwordx4 v9, s[24:27], s49 offen lds
  s_add_u32 m0, s46, 43008
  s_nop 0
  buffer_load_dwordx4 v10, s[24:27], s49 offen lds
  s_add_u32 m0, s46, 44032
  s_nop 0
  buffer_load_dwordx4 v11, s[24:27], s49 offen lds
  s_add_u32 m0, s46, 45056
  s_nop 0
  buffer_load_dwordx4 v12, s[24:27], s49 offen lds
  buffer_load_dwordx4 a[32:35], v6, s[16:19], s48 offen offset:0 sc1
  buffer_load_dwordx4 a[36:39], v6, s[16:19], s48 offen offset:128 sc1
  s_add_u32 s48, s48, 132096
  buffer_load_dwordx4 a[40:43], v6, s[16:19], s48 offen offset:0 sc1
  buffer_load_dwordx4 a[44:47], v6, s[16:19], s48 offen offset:128 sc1
  s_add_u32 s48, s48, 132096
  s_add_u32 m0, s46, 61440
  s_add_u32 s49, s45, 245760
  s_nop 0
  buffer_load_dwordx4 v8, s[24:27], s49 offen lds
  s_add_u32 m0, s46, 62464
  s_nop 0
  buffer_load_dwordx4 v9, s[24:27], s49 offen lds
  s_add_u32 m0, s46, 63488
  s_nop 0
  buffer_load_dwordx4 v10, s[24:27], s49 offen lds
  s_add_u32 m0, s46, 64512
  s_nop 0
  buffer_load_dwordx4 v11, s[24:27], s49 offen lds
  s_add_u32 m0, s46, 65536
  s_nop 0
  buffer_load_dwordx4 v12, s[24:27], s49 offen lds
  buffer_load_dwordx4 a[48:51], v6, s[16:19], s48 offen offset:0 sc1
  buffer_load_dwordx4 a[52:55], v6, s[16:19], s48 offen offset:128 sc1
  s_add_u32 s48, s48, 132096
  buffer_load_dwordx4 a[56:59], v6, s[16:19], s48 offen offset:0 sc1
  buffer_load_dwordx4 a[60:63], v6, s[16:19], s48 offen offset:128 sc1
  s_add_u32 s48, s48, 132096
  s_add_u32 m0, s46, 81920
  s_add_u32 s49, s45, 327680
  s_nop 0
  buffer_load_dwordx4 v8, s[24:27], s49 offen lds
  s_add_u32 m0, s46, 82944
  s_nop 0
  buffer_load_dwordx4 v9, s[24:27], s49 offen lds
  s_add_u32 m0, s46, 83968
  s_nop 0
  buffer_load_dwordx4 v10, s[24:27], s49 offen lds
  s_add_u32 m0, s46, 84992
  s_nop 0
  buffer_load_dwordx4 v11, s[24:27], s49 offen lds
  s_add_u32 m0, s46, 86016
  s_nop 0
  buffer_load_dwordx4 v12, s[24:27], s49 offen lds
  buffer_load_dwordx4 a[64:67], v6, s[16:19], s48 offen offset:0 sc1
  buffer_load_dwordx4 a[68:71], v6, s[16:19], s48 offen offset:128 sc1
  s_add_u32 s48, s48, 132096
  buffer_load_dwordx4 a[72:75], v6, s[16:19], s48 offen offset:0 sc1
  buffer_load_dwordx4 a[76:79], v6, s[16:19], s48 offen offset:128 sc1
  s_add_u32 s48, s48, 132096
  s_add_u32 m0, s46, 102400
  s_add_u32 s49, s45, 409600
  s_nop 0
  buffer_load_dwordx4 v8, s[24:27], s49 offen lds
  s_add_u32 m0, s46, 103424
  s_nop 0
  buffer_load_dwordx4 v9, s[24:27], s49 offen lds
  s_add_u32 m0, s46, 104448
  s_nop 0
  buffer_load_dwordx4 v10, s[24:27], s49 offen lds
  s_add_u32 m0, s46, 105472
  s_nop 0
  buffer_load_dwordx4 v11, s[24:27], s49 offen lds
  s_add_u32 m0, s46, 106496
  s_nop 0
  buffer_load_dwordx4 v12, s[24:27], s49 offen lds
  s_add_u32 m0, s46, 122880
  s_add_u32 s49, s45, 491520
  s_nop 0
  buffer_load_dwordx4 v8, s[24:27], s49 offen lds
  s_add_u32 m0, s46, 123904
  s_nop 0
  buffer_load_dwordx4 v9, s[24:27], s49 offen lds
  s_add_u32 m0, s46, 124928
  s_nop 0
  buffer_load_dwordx4 v10, s[24:27], s49 offen lds
  s_add_u32 m0, s46, 125952
  s_nop 0
  buffer_load_dwordx4 v11, s[24:27], s49 offen lds
  s_add_u32 m0, s46, 126976
  s_nop 0
  buffer_load_dwordx4 v12, s[24:27], s49 offen lds
  s_waitcnt vmcnt(50)
  s_barrier
  ds_read_b64_tr_b16 v[144:145], v14 offset:0
  ds_read_b64_tr_b16 v[146:147], v14 offset:1280
  ds_read_b64_tr_b16 v[148:149], v15 offset:32
  ds_read_b64_tr_b16 v[150:151], v15 offset:1312
  ds_read_b64_tr_b16 v[152:153], v14 offset:64
  ds_read_b64_tr_b16 v[154:155], v14 offset:1344
  ds_read_b64_tr_b16 v[156:157], v15 offset:96
  ds_read_b64_tr_b16 v[158:159], v15 offset:1376
  ds_read_b64_tr_b16 v[160:161], v14 offset:128
  ds_read_b64_tr_b16 v[162:163], v14 offset:1408
  ds_read_b64_tr_b16 v[164:165], v15 offset:160
  ds_read_b64_tr_b16 v[166:167], v15 offset:1440
  ds_read_b64_tr_b16 v[168:169], v14 offset:192
  ds_read_b64_tr_b16 v[170:171], v14 offset:1472
  ds_read_b64_tr_b16 v[172:173], v15 offset:224
  ds_read_b64_tr_b16 v[174:175], v15 offset:1504
  ds_read_b64_tr_b16 v[176:177], v14 offset:256
  ds_read_b64_tr_b16 v[178:179], v14 offset:1536
  ds_read_b64_tr_b16 v[180:181], v15 offset:288
  ds_read_b64_tr_b16 v[182:183], v15 offset:1568
  s_waitcnt lgkmcnt(0) vmcnt(43)
  v_mfma_f32_16x16x32_bf16 v[64:67], v[144:147], a[0:3], 0
  ds_read_b64_tr_b16 v[184:185], v14 offset:10240
  ds_read_b64_tr_b16 v[186:187], v14 offset:11520
  v_mfma_f32_16x16x32_bf16 v[104:107], v[144:147], a[4:7], 0
  ds_read_b64_tr_b16 v[188:189], v15 offset:10272
  v_mfma_f32_16x16x32_bf16 v[68:71], v[148:151], a[0:3], 0
  ds_read_b64_tr_b16 v[190:191], v15 offset:11552
  v_mfma_f32_16x16x32_bf16 v[108:111], v[148:151], a[4:7], 0
  ds_read_b64_tr_b16 v[192:193], v14 offset:10304
  v_mfma_f32_16x16x32_bf16 v[72:75], v[152:155], a[0:3], 0
  ds_read_b64_tr_b16 v[194:195], v14 offset:11584
  v_mfma_f32_16x16x32_bf16 v[112:115], v[152:155], a[4:7], 0
  ds_read_b64_tr_b16 v[196:197], v15 offset:10336
  ds_read_b64_tr_b16 v[198:199], v15 offset:11616
  v_mfma_f32_16x16x32_bf16 v[76:79], v[156:159], a[0:3], 0
  ds_read_b64_tr_b16 v[200:201], v14 offset:10368
  v_mfma_f32_16x16x32_bf16 v[116:119], v[156:159], a[4:7], 0
  ds_read_b64_tr_b16 v[202:203], v14 offset:11648
  v_mfma_f32_16x16x32_bf16 v[80:83], v[160:163], a[0:3], 0
  ds_read_b64_tr_b16 v[204:205], v15 offset:10400
  v_mfma_f32_16x16x32_bf16 v[120:123], v[160:163], a[4:7], 0
  ds_read_b64_tr_b16 v[206:207], v15 offset:11680
  v_mfma_f32_16x16x32_bf16 v[84:87], v[164:167], a[0:3], 0
  ds_read_b64_tr_b16 v[208:209], v14 offset:10432
  v_mfma_f32_16x16x32_bf16 v[124:127], v[164:167], a[4:7], 0
  ds_read_b64_tr_b16 v[210:211], v14 offset:11712
  ds_read_b64_tr_b16 v[212:213], v15 offset:10464
  v_mfma_f32_16x16x32_bf16 v[88:91], v[168:171], a[0:3], 0
  ds_read_b64_tr_b16 v[214:215], v15 offset:11744
  v_mfma_f32_16x16x32_bf16 v[128:131], v[168:171], a[4:7], 0
  buffer_load_dwordx4 a[80:83], v6, s[16:19], s48 offen offset:0 sc1
  ds_read_b64_tr_b16 v[216:217], v14 offset:10496
  v_mfma_f32_16x16x32_bf16 v[92:95], v[172:175], a[0:3], 0
  ds_read_b64_tr_b16 v[218:219], v14 offset:11776
  v_mfma_f32_16x16x32_bf16 v[132:135], v[172:175], a[4:7], 0
  ds_read_b64_tr_b16 v[220:221], v15 offset:10528
  v_mfma_f32_16x16x32_bf16 v[96:99], v[176:179], a[0:3], 0
  ds_read_b64_tr_b16 v[222:223], v15 offset:11808
  v_mfma_f32_16x16x32_bf16 v[136:139], v[176:179], a[4:7], 0
  buffer_load_dwordx4 a[84:87], v6, s[16:19], s48 offen offset:128 sc1
  v_mfma_f32_16x16x32_bf16 v[100:103], v[180:183], a[0:3], 0
  s_add_u32 s48, s48, 132096
  v_mfma_f32_16x16x32_bf16 v[140:143], v[180:183], a[4:7], 0
  s_waitcnt lgkmcnt(0) vmcnt(43)
  s_barrier
  v_mfma_f32_16x16x32_bf16 v[64:67], v[184:187], a[8:11], v[64:67]
  s_add_u32 m0, s46, 0
  ds_read_b64_tr_b16 v[144:145], v14 offset:20480
  ds_read_b64_tr_b16 v[146:147], v14 offset:21760
  v_mfma_f32_16x16x32_bf16 v[104:107], v[184:187], a[12:15], v[104:107]
  s_add_u32 s49, s45, 573440
  ds_read_b64_tr_b16 v[148:149], v15 offset:20512
  v_mfma_f32_16x16x32_bf16 v[68:71], v[188:191], a[8:11], v[68:71]
  buffer_load_dwordx4 v8, s[24:27], s49 offen lds
  ds_read_b64_tr_b16 v[150:151], v15 offset:21792
  v_mfma_f32_16x16x32_bf16 v[108:111], v[188:191], a[12:15], v[108:111]
  s_add_u32 m0, s46, 1024
  ds_read_b64_tr_b16 v[152:153], v14 offset:20544
  v_mfma_f32_16x16x32_bf16 v[72:75], v[192:195], a[8:11], v[72:75]
  buffer_load_dwordx4 v9, s[24:27], s49 offen lds
  ds_read_b64_tr_b16 v[154:155], v14 offset:21824
  v_mfma_f32_16x16x32_bf16 v[112:115], v[192:195], a[12:15], v[112:115]
  s_add_u32 m0, s46, 2048
  ds_read_b64_tr_b16 v[156:157], v15 offset:20576
  ds_read_b64_tr_b16 v[158:159], v15 offset:21856
  v_mfma_f32_16x16x32_bf16 v[76:79], v[196:199], a[8:11], v[76:79]
  buffer_load_dwordx4 v10, s[24:27], s49 offen lds
  ds_read_b64_tr_b16 v[160:161], v14 offset:20608
  v_mfma_f32_16x16x32_bf16 v[116:119], v[196:199], a[12:15], v[116:119]
  s_add_u32 m0, s46, 3072
  ds_read_b64_tr_b16 v[162:163], v14 offset:21888
  v_mfma_f32_16x16x32_bf16 v[80:83], v[200:203], a[8:11], v[80:83]
  buffer_load_dwordx4 v11, s[24:27], s49 offen lds
  ds_read_b64_tr_b16 v[164:165], v15 offset:20640
  v_mfma_f32_16x16x32_bf16 v[120:123], v[200:203], a[12:15], v[120:123]
  s_add_u32 m0, s46, 4096
  ds_read_b64_tr_b16 v[166:167], v15 offset:21920
  v_mfma_f32_16x16x32_bf16 v[84:87], v[204:207], a[8:11], v[84:87]
  buffer_load_dwordx4 v12, s[24:27], s49 offen lds
  ds_read_b64_tr_b16 v[168:169], v14 offset:20672
  v_mfma_f32_16x16x32_bf16 v[124:127], v[204:207], a[12:15], v[124:127]
  ds_read_b64_tr_b16 v[170:171], v14 offset:21952
  ds_read_b64_tr_b16 v[172:173], v15 offset:20704
  v_mfma_f32_16x16x32_bf16 v[88:91], v[208:211], a[8:11], v[88:91]
  ds_read_b64_tr_b16 v[174:175], v15 offset:21984
  v_mfma_f32_16x16x32_bf16 v[128:131], v[208:211], a[12:15], v[128:131]
  buffer_load_dwordx4 a[88:91], v6, s[16:19], s48 offen offset:0 sc1
  ds_read_b64_tr_b16 v[176:177], v14 offset:20736
  v_mfma_f32_16x16x32_bf16 v[92:95], v[212:215], a[8:11], v[92:95]
  ds_read_b64_tr_b16 v[178:179], v14 offset:22016
  v_mfma_f32_16x16x32_bf16 v[132:135], v[212:215], a[12:15], v[132:135]
  ds_read_b64_tr_b16 v[180:181], v15 offset:20768
  v_mfma_f32_16x16x32_bf16 v[96:99], v[216:219], a[8:11], v[96:99]
  ds_read_b64_tr_b16 v[182:183], v15 offset:22048
  v_mfma_f32_16x16x32_bf16 v[136:139], v[216:219], a[12:15], v[136:139]
  buffer_load_dwordx4 a[92:95], v6, s[16:19], s48 offen offset:128 sc1
  v_mfma_f32_16x16x32_bf16 v[100:103], v[220:223], a[8:11], v[100:103]
  s_add_u32 s48, s48, 132096
  v_mfma_f32_16x16x32_bf16 v[140:143], v[220:223], a[12:15], v[140:143]
  s_waitcnt lgkmcnt(0) vmcnt(48)
  v_mfma_f32_16x16x32_bf16 v[64:67], v[144:147], a[16:19], v[64:67]
  ds_read_b64_tr_b16 v[184:185], v14 offset:30720
  ds_read_b64_tr_b16 v[186:187], v14 offset:32000
  v_mfma_f32_16x16x32_bf16 v[104:107], v[144:147], a[20:23], v[104:107]
  ds_read_b64_tr_b16 v[188:189], v15 offset:30752
  v_mfma_f32_16x16x32_bf16 v[68:71], v[148:151], a[16:19], v[68:71]
  ds_read_b64_tr_b16 v[190:191], v15 offset:32032
  v_mfma_f32_16x16x32_bf16 v[108:111], v[148:151], a[20:23], v[108:111]
  ds_read_b64_tr_b16 v[192:193], v14 offset:30784
  v_mfma_f32_16x16x32_bf16 v[72:75], v[152:155], a[16:19], v[72:75]
  ds_read_b64_tr_b16 v[194:195], v14 offset:32064
  v_mfma_f32_16x16x32_bf16 v[112:115], v[152:155], a[20:23], v[112:115]
  ds_read_b64_tr_b16 v[196:197], v15 offset:30816
  ds_read_b64_tr_b16 v[198:199], v15 offset:32096
  v_mfma_f32_16x16x32_bf16 v[76:79], v[156:159], a[16:19], v[76:79]
  ds_read_b64_tr_b16 v[200:201], v14 offset:30848
  v_mfma_f32_16x16x32_bf16 v[116:119], v[156:159], a[20:23], v[116:119]
  ds_read_b64_tr_b16 v[202:203], v14 offset:32128
  v_mfma_f32_16x16x32_bf16 v[80:83], v[160:163], a[16:19], v[80:83]
  ds_read_b64_tr_b16 v[204:205], v15 offset:30880
  v_mfma_f32_16x16x32_bf16 v[120:123], v[160:163], a[20:23], v[120:123]
  ds_read_b64_tr_b16 v[206:207], v15 offset:32160
  v_mfma_f32_16x16x32_bf16 v[84:87], v[164:167], a[16:19], v[84:87]
  ds_read_b64_tr_b16 v[208:209], v14 offset:30912
  v_mfma_f32_16x16x32_bf16 v[124:127], v[164:167], a[20:23], v[124:127]
  ds_read_b64_tr_b16 v[210:211], v14 offset:32192
  ds_read_b64_tr_b16 v[212:213], v15 offset:30944
  v_mfma_f32_16x16x32_bf16 v[88:91], v[168:171], a[16:19], v[88:91]
  ds_read_b64_tr_b16 v[214:215], v15 offset:32224
  v_mfma_f32_16x16x32_bf16 v[128:131], v[168:171], a[20:23], v[128:131]
  buffer_load_dwordx4 a[96:99], v6, s[16:19], s48 offen offset:0 sc1
  ds_read_b64_tr_b16 v[216:217], v14 offset:30976
  v_mfma_f32_16x16x32_bf16 v[92:95], v[172:175], a[16:19], v[92:95]
  ds_read_b64_tr_b16 v[218:219], v14 offset:32256
  v_mfma_f32_16x16x32_bf16 v[132:135], v[172:175], a[20:23], v[132:135]
  ds_read_b64_tr_b16 v[220:221], v15 offset:31008
  v_mfma_f32_16x16x32_bf16 v[96:99], v[176:179], a[16:19], v[96:99]
  ds_read_b64_tr_b16 v[222:223], v15 offset:32288
  v_mfma_f32_16x16x32_bf16 v[136:139], v[176:179], a[20:23], v[136:139]
  buffer_load_dwordx4 a[100:103], v6, s[16:19], s48 offen offset:128 sc1
  v_mfma_f32_16x16x32_bf16 v[100:103], v[180:183], a[16:19], v[100:103]
  s_add_u32 s48, s48, 132096
  v_mfma_f32_16x16x32_bf16 v[140:143], v[180:183], a[20:23], v[140:143]
  s_waitcnt lgkmcnt(0) vmcnt(43)
  s_barrier
  v_mfma_f32_16x16x32_bf16 v[64:67], v[184:187], a[24:27], v[64:67]
  s_add_u32 m0, s46, 20480
  ds_read_b64_tr_b16 v[144:145], v14 offset:40960
  ds_read_b64_tr_b16 v[146:147], v14 offset:42240
  v_mfma_f32_16x16x32_bf16 v[104:107], v[184:187], a[28:31], v[104:107]
  s_add_u32 s49, s45, 655360
  ds_read_b64_tr_b16 v[148:149], v15 offset:40992
  v_mfma_f32_16x16x32_bf16 v[68:71], v[188:191], a[24:27], v[68:71]
  buffer_load_dwordx4 v8, s[24:27], s49 offen lds
  ds_read_b64_tr_b16 v[150:151], v15 offset:42272
  v_mfma_f32_16x16x32_bf16 v[108:111], v[188:191], a[28:31], v[108:111]
  s_add_u32 m0, s46, 21504
  ds_read_b64_tr_b16 v[152:153], v14 offset:41024
  v_mfma_f32_16x16x32_bf16 v[72:75], v[192:195], a[24:27], v[72:75]
  buffer_load_dwordx4 v9, s[24:27], s49 offen lds
  ds_read_b64_tr_b16 v[154:155], v14 offset:42304
  v_mfma_f32_16x16x32_bf16 v[112:115], v[192:195], a[28:31], v[112:115]
  s_add_u32 m0, s46, 22528
  ds_read_b64_tr_b16 v[156:157], v15 offset:41056
  ds_read_b64_tr_b16 v[158:159], v15 offset:42336
  v_mfma_f32_16x16x32_bf16 v[76:79], v[196:199], a[24:27], v[76:79]
  buffer_load_dwordx4 v10, s[24:27], s49 offen lds
  ds_read_b64_tr_b16 v[160:161], v14 offset:41088
  v_mfma_f32_16x16x32_bf16 v[116:119], v[196:199], a[28:31], v[116:119]
  s_add_u32 m0, s46, 23552
  ds_read_b64_tr_b16 v[162:163], v14 offset:42368
  v_mfma_f32_16x16x32_bf16 v[80:83], v[200:203], a[24:27], v[80:83]
  buffer_load_dwordx4 v11, s[24:27], s49 offen lds
  ds_read_b64_tr_b16 v[164:165], v15 offset:41120
  v_mfma_f32_16x16x32_bf16 v[120:123], v[200:203], a[28:31], v[120:123]
  s_add_u32 m0, s46, 24576
  ds_read_b64_tr_b16 v[166:167], v15 offset:42400
  v_mfma_f32_16x16x32_bf16 v[84:87], v[204:207], a[24:27], v[84:87]
  buffer_load_dwordx4 v12, s[24:27], s49 offen lds
  ds_read_b64_tr_b16 v[168:169], v14 offset:41152
  v_mfma_f32_16x16x32_bf16 v[124:127], v[204:207], a[28:31], v[124:127]
  ds_read_b64_tr_b16 v[170:171], v14 offset:42432
  ds_read_b64_tr_b16 v[172:173], v15 offset:41184
  v_mfma_f32_16x16x32_bf16 v[88:91], v[208:211], a[24:27], v[88:91]
  ds_read_b64_tr_b16 v[174:175], v15 offset:42464
  v_mfma_f32_16x16x32_bf16 v[128:131], v[208:211], a[28:31], v[128:131]
  buffer_load_dwordx4 a[104:107], v6, s[16:19], s48 offen offset:0 sc1
  ds_read_b64_tr_b16 v[176:177], v14 offset:41216
  v_mfma_f32_16x16x32_bf16 v[92:95], v[212:215], a[24:27], v[92:95]
  ds_read_b64_tr_b16 v[178:179], v14 offset:42496
  v_mfma_f32_16x16x32_bf16 v[132:135], v[212:215], a[28:31], v[132:135]
  ds_read_b64_tr_b16 v[180:181], v15 offset:41248
  v_mfma_f32_16x16x32_bf16 v[96:99], v[216:219], a[24:27], v[96:99]
  ds_read_b64_tr_b16 v[182:183], v15 offset:42528
  v_mfma_f32_16x16x32_bf16 v[136:139], v[216:219], a[28:31], v[136:139]
  buffer_load_dwordx4 a[108:111], v6, s[16:19], s48 offen offset:128 sc1
  v_mfma_f32_16x16x32_bf16 v[100:103], v[220:223], a[24:27], v[100:103]
  s_add_u32 s48, s48, 132096
  v_mfma_f32_16x16x32_bf16 v[140:143], v[220:223], a[28:31], v[140:143]
  s_waitcnt lgkmcnt(0) vmcnt(48)
  v_mfma_f32_16x16x32_bf16 v[64:67], v[144:147], a[32:35], v[64:67]
  ds_read_b64_tr_b16 v[184:185], v14 offset:51200
  ds_read_b64_tr_b16 v[186:187], v14 offset:52480
  v_mfma_f32_16x16x32_bf16 v[104:107], v[144:147], a[36:39], v[104:107]
  ds_read_b64_tr_b16 v[188:189], v15 offset:51232
  v_mfma_f32_16x16x32_bf16 v[68:71], v[148:151], a[32:35], v[68:71]
  ds_read_b64_tr_b16 v[190:191], v15 offset:52512
  v_mfma_f32_16x16x32_bf16 v[108:111], v[148:151], a[36:39], v[108:111]
  ds_read_b64_tr_b16 v[192:193], v14 offset:51264
  v_mfma_f32_16x16x32_bf16 v[72:75], v[152:155], a[32:35], v[72:75]
  ds_read_b64_tr_b16 v[194:195], v14 offset:52544
  v_mfma_f32_16x16x32_bf16 v[112:115], v[152:155], a[36:39], v[112:115]
  ds_read_b64_tr_b16 v[196:197], v15 offset:51296
  ds_read_b64_tr_b16 v[198:199], v15 offset:52576
  v_mfma_f32_16x16x32_bf16 v[76:79], v[156:159], a[32:35], v[76:79]
  ds_read_b64_tr_b16 v[200:201], v14 offset:51328
  v_mfma_f32_16x16x32_bf16 v[116:119], v[156:159], a[36:39], v[116:119]
  ds_read_b64_tr_b16 v[202:203], v14 offset:52608
  v_mfma_f32_16x16x32_bf16 v[80:83], v[160:163], a[32:35], v[80:83]
  ds_read_b64_tr_b16 v[204:205], v15 offset:51360
  v_mfma_f32_16x16x32_bf16 v[120:123], v[160:163], a[36:39], v[120:123]
  ds_read_b64_tr_b16 v[206:207], v15 offset:52640
  v_mfma_f32_16x16x32_bf16 v[84:87], v[164:167], a[32:35], v[84:87]
  ds_read_b64_tr_b16 v[208:209], v14 offset:51392
  v_mfma_f32_16x16x32_bf16 v[124:127], v[164:167], a[36:39], v[124:127]
  ds_read_b64_tr_b16 v[210:211], v14 offset:52672
  ds_read_b64_tr_b16 v[212:213], v15 offset:51424
  v_mfma_f32_16x16x32_bf16 v[88:91], v[168:171], a[32:35], v[88:91]
  ds_read_b64_tr_b16 v[214:215], v15 offset:52704
  v_mfma_f32_16x16x32_bf16 v[128:131], v[168:171], a[36:39], v[128:131]
  buffer_load_dwordx4 a[112:115], v6, s[16:19], s48 offen offset:0 sc1
  ds_read_b64_tr_b16 v[216:217], v14 offset:51456
  v_mfma_f32_16x16x32_bf16 v[92:95], v[172:175], a[32:35], v[92:95]
  ds_read_b64_tr_b16 v[218:219], v14 offset:52736
  v_mfma_f32_16x16x32_bf16 v[132:135], v[172:175], a[36:39], v[132:135]
  ds_read_b64_tr_b16 v[220:221], v15 offset:51488
  v_mfma_f32_16x16x32_bf16 v[96:99], v[176:179], a[32:35], v[96:99]
  ds_read_b64_tr_b16 v[222:223], v15 offset:52768
  v_mfma_f32_16x16x32_bf16 v[136:139], v[176:179], a[36:39], v[136:139]
  buffer_load_dwordx4 a[116:119], v6, s[16:19], s48 offen offset:128 sc1
  v_mfma_f32_16x16x32_bf16 v[100:103], v[180:183], a[32:35], v[100:103]
  s_add_u32 s48, s48, 132096
  v_mfma_f32_16x16x32_bf16 v[140:143], v[180:183], a[36:39], v[140:143]
  s_waitcnt lgkmcnt(0) vmcnt(43)
  s_barrier
  v_mfma_f32_16x16x32_bf16 v[64:67], v[184:187], a[40:43], v[64:67]
  s_add_u32 m0, s46, 40960
  ds_read_b64_tr_b16 v[144:145], v16 offset:0
  ds_read_b64_tr_b16 v[146:147], v16 offset:1280
  v_mfma_f32_16x16x32_bf16 v[104:107], v[184:187], a[44:47], v[104:107]
  s_add_u32 s49, s45, 737280
  ds_read_b64_tr_b16 v[148:149], v17 offset:32
  v_mfma_f32_16x16x32_bf16 v[68:71], v[188:191], a[40:43], v[68:71]
  buffer_load_dwordx4 v8, s[24:27], s49 offen lds
  ds_read_b64_tr_b16 v[150:151], v17 offset:1312
  v_mfma_f32_16x16x32_bf16 v[108:111], v[188:191], a[44:47], v[108:111]
  s_add_u32 m0, s46, 41984
  ds_read_b64_tr_b16 v[152:153], v16 offset:64
  v_mfma_f32_16x16x32_bf16 v[72:75], v[192:195], a[40:43], v[72:75]
  buffer_load_dwordx4 v9, s[24:27], s49 offen lds
  ds_read_b64_tr_b16 v[154:155], v16 offset:1344
  v_mfma_f32_16x16x32_bf16 v[112:115], v[192:195], a[44:47], v[112:115]
  s_add_u32 m0, s46, 43008
  ds_read_b64_tr_b16 v[156:157], v17 offset:96
  ds_read_b64_tr_b16 v[158:159], v17 offset:1376
  v_mfma_f32_16x16x32_bf16 v[76:79], v[196:199], a[40:43], v[76:79]
  buffer_load_dwordx4 v10, s[24:27], s49 offen lds
  ds_read_b64_tr_b16 v[160:161], v16 offset:128
  v_mfma_f32_16x16x32_bf16 v[116:119], v[196:199], a[44:47], v[116:119]
  s_add_u32 m0, s46, 44032
  ds_read_b64_tr_b16 v[162:163], v16 offset:1408
  v_mfma_f32_16x16x32_bf16 v[80:83], v[200:203], a[40:43], v[80:83]
  buffer_load_dwordx4 v11, s[24:27], s49 offen lds
  ds_read_b64_tr_b16 v[164:165], v17 offset:160
  v_mfma_f32_16x16x32_bf16 v[120:123], v[200:203], a[44:47], v[120:123]
  s_add_u32 m0, s46, 45056
  ds_read_b64_tr_b16 v[166:167], v17 offset:1440
  v_mfma_f32_16x16x32_bf16 v[84:87], v[204:207], a[40:43], v[84:87]
  buffer_load_dwordx4 v12, s[24:27], s49 offen lds
  ds_read_b64_tr_b16 v[168:169], v16 offset:192
  v_mfma_f32_16x16x32_bf16 v[124:127], v[204:207], a[44:47], v[124:127]
  ds_read_b64_tr_b16 v[170:171], v16 offset:1472
  ds_read_b64_tr_b16 v[172:173], v17 offset:224
  v_mfma_f32_16x16x32_bf16 v[88:91], v[208:211], a[40:43], v[88:91]
  ds_read_b64_tr_b16 v[174:175], v17 offset:1504
  v_mfma_f32_16x16x32_bf16 v[128:131], v[208:211], a[44:47], v[128:131]
  buffer_load_dwordx4 a[120:123], v6, s[16:19], s48 offen offset:0 sc1
  ds_read_b64_tr_b16 v[176:177], v16 offset:256
  v_mfma_f32_16x16x32_bf16 v[92:95], v[212:215], a[40:43], v[92:95]
  ds_read_b64_tr_b16 v[178:179], v16 offset:1536
  v_mfma_f32_16x16x32_bf16 v[132:135], v[212:215], a[44:47], v[132:135]
  ds_read_b64_tr_b16 v[180:181], v17 offset:288
  v_mfma_f32_16x16x32_bf16 v[96:99], v[216:219], a[40:43], v[96:99]
  ds_read_b64_tr_b16 v[182:183], v17 offset:1568
  v_mfma_f32_16x16x32_bf16 v[136:139], v[216:219], a[44:47], v[136:139]
  buffer_load_dwordx4 a[124:127], v6, s[16:19], s48 offen offset:128 sc1
  v_mfma_f32_16x16x32_bf16 v[100:103], v[220:223], a[40:43], v[100:103]
  s_add_u32 s48, s48, 132096
  v_mfma_f32_16x16x32_bf16 v[140:143], v[220:223], a[44:47], v[140:143]
  s_waitcnt lgkmcnt(0) vmcnt(48)
  v_mfma_f32_16x16x32_bf16 v[64:67], v[144:147], a[48:51], v[64:67]
  ds_read_b64_tr_b16 v[184:185], v16 offset:10240
  ds_read_b64_tr_b16 v[186:187], v16 offset:11520
  v_mfma_f32_16x16x32_bf16 v[104:107], v[144:147], a[52:55], v[104:107]
  ds_read_b64_tr_b16 v[188:189], v17 offset:10272
  v_mfma_f32_16x16x32_bf16 v[68:71], v[148:151], a[48:51], v[68:71]
  ds_read_b64_tr_b16 v[190:191], v17 offset:11552
  v_mfma_f32_16x16x32_bf16 v[108:111], v[148:151], a[52:55], v[108:111]
  ds_read_b64_tr_b16 v[192:193], v16 offset:10304
  v_mfma_f32_16x16x32_bf16 v[72:75], v[152:155], a[48:51], v[72:75]
  ds_read_b64_tr_b16 v[194:195], v16 offset:11584
  v_mfma_f32_16x16x32_bf16 v[112:115], v[152:155], a[52:55], v[112:115]
  ds_read_b64_tr_b16 v[196:197], v17 offset:10336
  ds_read_b64_tr_b16 v[198:199], v17 offset:11616
  v_mfma_f32_16x16x32_bf16 v[76:79], v[156:159], a[48:51], v[76:79]
  ds_read_b64_tr_b16 v[200:201], v16 offset:10368
  v_mfma_f32_16x16x32_bf16 v[116:119], v[156:159], a[52:55], v[116:119]
  ds_read_b64_tr_b16 v[202:203], v16 offset:11648
  v_mfma_f32_16x16x32_bf16 v[80:83], v[160:163], a[48:51], v[80:83]
  ds_read_b64_tr_b16 v[204:205], v17 offset:10400
  v_mfma_f32_16x16x32_bf16 v[120:123], v[160:163], a[52:55], v[120:123]
  ds_read_b64_tr_b16 v[206:207], v17 offset:11680
  v_mfma_f32_16x16x32_bf16 v[84:87], v[164:167], a[48:51], v[84:87]
  ds_read_b64_tr_b16 v[208:209], v16 offset:10432
  v_mfma_f32_16x16x32_bf16 v[124:127], v[164:167], a[52:55], v[124:127]
  ds_read_b64_tr_b16 v[210:211], v16 offset:11712
  ds_read_b64_tr_b16 v[212:213], v17 offset:10464
  v_mfma_f32_16x16x32_bf16 v[88:91], v[168:171], a[48:51], v[88:91]
  ds_read_b64_tr_b16 v[214:215], v17 offset:11744
  v_mfma_f32_16x16x32_bf16 v[128:131], v[168:171], a[52:55], v[128:131]
  buffer_load_dwordx4 a[128:131], v6, s[16:19], s48 offen offset:0 sc1
  ds_read_b64_tr_b16 v[216:217], v16 offset:10496
  v_mfma_f32_16x16x32_bf16 v[92:95], v[172:175], a[48:51], v[92:95]
  ds_read_b64_tr_b16 v[218:219], v16 offset:11776
  v_mfma_f32_16x16x32_bf16 v[132:135], v[172:175], a[52:55], v[132:135]
  ds_read_b64_tr_b16 v[220:221], v17 offset:10528
  v_mfma_f32_16x16x32_bf16 v[96:99], v[176:179], a[48:51], v[96:99]
  ds_read_b64_tr_b16 v[222:223], v17 offset:11808
  v_mfma_f32_16x16x32_bf16 v[136:139], v[176:179], a[52:55], v[136:139]
  buffer_load_dwordx4 a[132:135], v6, s[16:19], s48 offen offset:128 sc1
  v_mfma_f32_16x16x32_bf16 v[100:103], v[180:183], a[48:51], v[100:103]
  s_add_u32 s48, s48, 132096
  v_mfma_f32_16x16x32_bf16 v[140:143], v[180:183], a[52:55], v[140:143]
  s_waitcnt lgkmcnt(0) vmcnt(43)
  s_barrier
  v_mfma_f32_16x16x32_bf16 v[64:67], v[184:187], a[56:59], v[64:67]
  ds_read_b64_tr_b16 v[144:145], v16 offset:20480
  ds_read_b64_tr_b16 v[146:147], v16 offset:21760
  v_mfma_f32_16x16x32_bf16 v[104:107], v[184:187], a[60:63], v[104:107]
  ds_read_b64_tr_b16 v[148:149], v17 offset:20512
  v_mfma_f32_16x16x32_bf16 v[68:71], v[188:191], a[56:59], v[68:71]
  ds_read_b64_tr_b16 v[150:151], v17 offset:21792
  v_mfma_f32_16x16x32_bf16 v[108:111], v[188:191], a[60:63], v[108:111]
  ds_read_b64_tr_b16 v[152:153], v16 offset:20544
  v_mfma_f32_16x16x32_bf16 v[72:75], v[192:195], a[56:59], v[72:75]
  ds_read_b64_tr_b16 v[154:155], v16 offset:21824
  v_mfma_f32_16x16x32_bf16 v[112:115], v[192:195], a[60:63], v[112:115]
  ds_read_b64_tr_b16 v[156:157], v17 offset:20576
  ds_read_b64_tr_b16 v[158:159], v17 offset:21856
  v_mfma_f32_16x16x32_bf16 v[76:79], v[196:199], a[56:59], v[76:79]
  ds_read_b64_tr_b16 v[160:161], v16 offset:20608
  v_mfma_f32_16x16x32_bf16 v[116:119], v[196:199], a[60:63], v[116:119]
  ds_read_b64_tr_b16 v[162:163], v16 offset:21888
  v_mfma_f32_16x16x32_bf16 v[80:83], v[200:203], a[56:59], v[80:83]
  ds_read_b64_tr_b16 v[164:165], v17 offset:20640
  v_mfma_f32_16x16x32_bf16 v[120:123], v[200:203], a[60:63], v[120:123]
  ds_read_b64_tr_b16 v[166:167], v17 offset:21920
  v_mfma_f32_16x16x32_bf16 v[84:87], v[204:207], a[56:59], v[84:87]
  ds_read_b64_tr_b16 v[168:169], v16 offset:20672
  v_mfma_f32_16x16x32_bf16 v[124:127], v[204:207], a[60:63], v[124:127]
  ds_read_b64_tr_b16 v[170:171], v16 offset:21952
  ds_read_b64_tr_b16 v[172:173], v17 offset:20704
  v_mfma_f32_16x16x32_bf16 v[88:91], v[208:211], a[56:59], v[88:91]
  ds_read_b64_tr_b16 v[174:175], v17 offset:21984
  v_mfma_f32_16x16x32_bf16 v[128:131], v[208:211], a[60:63], v[128:131]
  buffer_load_dwordx4 a[136:139], v6, s[16:19], s48 offen offset:0 sc1
  ds_read_b64_tr_b16 v[176:177], v16 offset:20736
  v_mfma_f32_16x16x32_bf16 v[92:95], v[212:215], a[56:59], v[92:95]
  ds_read_b64_tr_b16 v[178:179], v16 offset:22016
  v_mfma_f32_16x16x32_bf16 v[132:135], v[212:215], a[60:63], v[132:135]
  ds_read_b64_tr_b16 v[180:181], v17 offset:20768
  v_mfma_f32_16x16x32_bf16 v[96:99], v[216:219], a[56:59], v[96:99]
  ds_read_b64_tr_b16 v[182:183], v17 offset:22048
  v_mfma_f32_16x16x32_bf16 v[136:139], v[216:219], a[60:63], v[136:139]
  buffer_load_dwordx4 a[140:143], v6, s[16:19], s48 offen offset:128 sc1
  v_mfma_f32_16x16x32_bf16 v[100:103], v[220:223], a[56:59], v[100:103]
  s_add_u32 s48, s48, 132096
  v_mfma_f32_16x16x32_bf16 v[140:143], v[220:223], a[60:63], v[140:143]
  s_waitcnt lgkmcnt(0) vmcnt(43)
  v_mfma_f32_16x16x32_bf16 v[64:67], v[144:147], a[64:67], v[64:67]
  ds_read_b64_tr_b16 v[184:185], v16 offset:30720
  ds_read_b64_tr_b16 v[186:187], v16 offset:32000
  v_mfma_f32_16x16x32_bf16 v[104:107], v[144:147], a[68:71], v[104:107]
  ds_read_b64_tr_b16 v[188:189], v17 offset:30752
  v_mfma_f32_16x16x32_bf16 v[68:71], v[148:151], a[64:67], v[68:71]
  ds_read_b64_tr_b16 v[190:191], v17 offset:32032
  v_mfma_f32_16x16x32_bf16 v[108:111], v[148:151], a[68:71], v[108:111]
  ds_read_b64_tr_b16 v[192:193], v16 offset:30784
  v_mfma_f32_16x16x32_bf16 v[72:75], v[152:155], a[64:67], v[72:75]
  ds_read_b64_tr_b16 v[194:195], v16 offset:32064
  v_mfma_f32_16x16x32_bf16 v[112:115], v[152:155], a[68:71], v[112:115]
  ds_read_b64_tr_b16 v[196:197], v17 offset:30816
  ds_read_b64_tr_b16 v[198:199], v17 offset:32096
  v_mfma_f32_16x16x32_bf16 v[76:79], v[156:159], a[64:67], v[76:79]
  ds_read_b64_tr_b16 v[200:201], v16 offset:30848
  v_mfma_f32_16x16x32_bf16 v[116:119], v[156:159], a[68:71], v[116:119]
  ds_read_b64_tr_b16 v[202:203], v16 offset:32128
  v_mfma_f32_16x16x32_bf16 v[80:83], v[160:163], a[64:67], v[80:83]
  ds_read_b64_tr_b16 v[204:205], v17 offset:30880
  v_mfma_f32_16x16x32_bf16 v[120:123], v[160:163], a[68:71], v[120:123]
  ds_read_b64_tr_b16 v[206:207], v17 offset:32160
  v_mfma_f32_16x16x32_bf16 v[84:87], v[164:167], a[64:67], v[84:87]
  ds_read_b64_tr_b16 v[208:209], v16 offset:30912
  v_mfma_f32_16x16x32_bf16 v[124:127], v[164:167], a[68:71], v[124:127]
  ds_read_b64_tr_b16 v[210:211], v16 offset:32192
  ds_read_b64_tr_b16 v[212:213], v17 offset:30944
  v_mfma_f32_16x16x32_bf16 v[88:91], v[168:171], a[64:67], v[88:91]
  ds_read_b64_tr_b16 v[214:215], v17 offset:32224
  v_mfma_f32_16x16x32_bf16 v[128:131], v[168:171], a[68:71], v[128:131]
  buffer_load_dwordx4 a[144:147], v6, s[16:19], s48 offen offset:0 sc1
  ds_read_b64_tr_b16 v[216:217], v16 offset:30976
  v_mfma_f32_16x16x32_bf16 v[92:95], v[172:175], a[64:67], v[92:95]
  ds_read_b64_tr_b16 v[218:219], v16 offset:32256
  v_mfma_f32_16x16x32_bf16 v[132:135], v[172:175], a[68:71], v[132:135]
  ds_read_b64_tr_b16 v[220:221], v17 offset:31008
  v_mfma_f32_16x16x32_bf16 v[96:99], v[176:179], a[64:67], v[96:99]
  ds_read_b64_tr_b16 v[222:223], v17 offset:32288
  v_mfma_f32_16x16x32_bf16 v[136:139], v[176:179], a[68:71], v[136:139]
  buffer_load_dwordx4 a[148:151], v6, s[16:19], s48 offen offset:128 sc1
  v_mfma_f32_16x16x32_bf16 v[100:103], v[180:183], a[64:67], v[100:103]
  s_add_u32 s48, s48, 132096
  v_mfma_f32_16x16x32_bf16 v[140:143], v[180:183], a[68:71], v[140:143]
  s_waitcnt lgkmcnt(0) vmcnt(38)
  s_barrier
  v_mfma_f32_16x16x32_bf16 v[64:67], v[184:187], a[72:75], v[64:67]
  ds_read_b64_tr_b16 v[144:145], v16 offset:40960
  ds_read_b64_tr_b16 v[146:147], v16 offset:42240
  v_mfma_f32_16x16x32_bf16 v[104:107], v[184:187], a[76:79], v[104:107]
  ds_read_b64_tr_b16 v[148:149], v17 offset:40992
  v_mfma_f32_16x16x32_bf16 v[68:71], v[188:191], a[72:75], v[68:71]
  ds_read_b64_tr_b16 v[150:151], v17 offset:42272
  v_mfma_f32_16x16x32_bf16 v[108:111], v[188:191], a[76:79], v[108:111]
  ds_read_b64_tr_b16 v[152:153], v16 offset:41024
  v_mfma_f32_16x16x32_bf16 v[72:75], v[192:195], a[72:75], v[72:75]
  ds_read_b64_tr_b16 v[154:155], v16 offset:42304
  v_mfma_f32_16x16x32_bf16 v[112:115], v[192:195], a[76:79], v[112:115]
  ds_read_b64_tr_b16 v[156:157], v17 offset:41056
  ds_read_b64_tr_b16 v[158:159], v17 offset:42336
  v_mfma_f32_16x16x32_bf16 v[76:79], v[196:199], a[72:75], v[76:79]
  ds_read_b64_tr_b16 v[160:161], v16 offset:41088
  v_mfma_f32_16x16x32_bf16 v[116:119], v[196:199], a[76:79], v[116:119]
  ds_read_b64_tr_b16 v[162:163], v16 offset:42368
  v_mfma_f32_16x16x32_bf16 v[80:83], v[200:203], a[72:75], v[80:83]
  ds_read_b64_tr_b16 v[164:165], v17 offset:41120
  v_mfma_f32_16x16x32_bf16 v[120:123], v[200:203], a[76:79], v[120:123]
  ds_read_b64_tr_b16 v[166:167], v17 offset:42400
  v_mfma_f32_16x16x32_bf16 v[84:87], v[204:207], a[72:75], v[84:87]
  ds_read_b64_tr_b16 v[168:169], v16 offset:41152
  v_mfma_f32_16x16x32_bf16 v[124:127], v[204:207], a[76:79], v[124:127]
  ds_read_b64_tr_b16 v[170:171], v16 offset:42432
  ds_read_b64_tr_b16 v[172:173], v17 offset:41184
  v_mfma_f32_16x16x32_bf16 v[88:91], v[208:211], a[72:75], v[88:91]
  ds_read_b64_tr_b16 v[174:175], v17 offset:42464
  v_mfma_f32_16x16x32_bf16 v[128:131], v[208:211], a[76:79], v[128:131]
  buffer_load_dwordx4 a[152:155], v6, s[16:19], s48 offen offset:0 sc1
  ds_read_b64_tr_b16 v[176:177], v16 offset:41216
  v_mfma_f32_16x16x32_bf16 v[92:95], v[212:215], a[72:75], v[92:95]
  ds_read_b64_tr_b16 v[178:179], v16 offset:42496
  v_mfma_f32_16x16x32_bf16 v[132:135], v[212:215], a[76:79], v[132:135]
  ds_read_b64_tr_b16 v[180:181], v17 offset:41248
  v_mfma_f32_16x16x32_bf16 v[96:99], v[216:219], a[72:75], v[96:99]
  ds_read_b64_tr_b16 v[182:183], v17 offset:42528
  v_mfma_f32_16x16x32_bf16 v[136:139], v[216:219], a[76:79], v[136:139]
  buffer_load_dwordx4 a[156:159], v6, s[16:19], s48 offen offset:128 sc1
  v_mfma_f32_16x16x32_bf16 v[100:103], v[220:223], a[72:75], v[100:103]
  s_add_u32 s48, s48, 132096
  v_mfma_f32_16x16x32_bf16 v[140:143], v[220:223], a[76:79], v[140:143]
  s_waitcnt lgkmcnt(0) vmcnt(33)
  v_mfma_f32_16x16x32_bf16 v[64:67], v[144:147], a[80:83], v[64:67]
  ds_read_b64_tr_b16 v[184:185], v16 offset:51200
  ds_read_b64_tr_b16 v[186:187], v16 offset:52480
  v_mfma_f32_16x16x32_bf16 v[104:107], v[144:147], a[84:87], v[104:107]
  ds_read_b64_tr_b16 v[188:189], v17 offset:51232
  v_mfma_f32_16x16x32_bf16 v[68:71], v[148:151], a[80:83], v[68:71]
  ds_read_b64_tr_b16 v[190:191], v17 offset:52512
  v_mfma_f32_16x16x32_bf16 v[108:111], v[148:151], a[84:87], v[108:111]
  ds_read_b64_tr_b16 v[192:193], v16 offset:51264
  v_mfma_f32_16x16x32_bf16 v[72:75], v[152:155], a[80:83], v[72:75]
  ds_read_b64_tr_b16 v[194:195], v16 offset:52544
  v_mfma_f32_16x16x32_bf16 v[112:115], v[152:155], a[84:87], v[112:115]
  ds_read_b64_tr_b16 v[196:197], v17 offset:51296
  ds_read_b64_tr_b16 v[198:199], v17 offset:52576
  v_mfma_f32_16x16x32_bf16 v[76:79], v[156:159], a[80:83], v[76:79]
  ds_read_b64_tr_b16 v[200:201], v16 offset:51328
  v_mfma_f32_16x16x32_bf16 v[116:119], v[156:159], a[84:87], v[116:119]
  ds_read_b64_tr_b16 v[202:203], v16 offset:52608
  v_mfma_f32_16x16x32_bf16 v[80:83], v[160:163], a[80:83], v[80:83]
  ds_read_b64_tr_b16 v[204:205], v17 offset:51360
  v_mfma_f32_16x16x32_bf16 v[120:123], v[160:163], a[84:87], v[120:123]
  ds_read_b64_tr_b16 v[206:207], v17 offset:52640
  v_mfma_f32_16x16x32_bf16 v[84:87], v[164:167], a[80:83], v[84:87]
  ds_read_b64_tr_b16 v[208:209], v16 offset:51392
  v_mfma_f32_16x16x32_bf16 v[124:127], v[164:167], a[84:87], v[124:127]
  ds_read_b64_tr_b16 v[210:211], v16 offset:52672
  ds_read_b64_tr_b16 v[212:213], v17 offset:51424
  v_mfma_f32_16x16x32_bf16 v[88:91], v[168:171], a[80:83], v[88:91]
  ds_read_b64_tr_b16 v[214:215], v17 offset:52704
  v_mfma_f32_16x16x32_bf16 v[128:131], v[168:171], a[84:87], v[128:131]
  buffer_load_dwordx4 v[52:55], v4, s[12:15], 0 offen
  ds_read_b64_tr_b16 v[216:217], v16 offset:51456
  v_mfma_f32_16x16x32_bf16 v[92:95], v[172:175], a[80:83], v[92:95]
  ds_read_b64_tr_b16 v[218:219], v16 offset:52736
  v_mfma_f32_16x16x32_bf16 v[132:135], v[172:175], a[84:87], v[132:135]
  ds_read_b64_tr_b16 v[220:221], v17 offset:51488
  v_mfma_f32_16x16x32_bf16 v[96:99], v[176:179], a[80:83], v[96:99]
  ds_read_b64_tr_b16 v[222:223], v17 offset:52768
  v_mfma_f32_16x16x32_bf16 v[136:139], v[176:179], a[84:87], v[136:139]
  buffer_load_dword v56, v5, s[12:15], 0 offen offset:1024
  v_mfma_f32_16x16x32_bf16 v[100:103], v[180:183], a[80:83], v[100:103]
  s_mul_i32 s50, s59, 1280
  v_mfma_f32_16x16x32_bf16 v[140:143], v[180:183], a[84:87], v[140:143]
  s_waitcnt lgkmcnt(0) vmcnt(28)
  s_barrier
  v_mfma_f32_16x16x32_bf16 v[64:67], v[184:187], a[88:91], v[64:67]
  ds_read_b64_tr_b16 v[144:145], v18 offset:0
  ds_read_b64_tr_b16 v[146:147], v18 offset:1280
  v_mfma_f32_16x16x32_bf16 v[104:107], v[184:187], a[92:95], v[104:107]
  ds_read_b64_tr_b16 v[148:149], v19 offset:32
  v_mfma_f32_16x16x32_bf16 v[68:71], v[188:191], a[88:91], v[68:71]
  ds_read_b64_tr_b16 v[150:151], v19 offset:1312
  v_mfma_f32_16x16x32_bf16 v[108:111], v[188:191], a[92:95], v[108:111]
  ds_read_b64_tr_b16 v[152:153], v18 offset:64
  v_mfma_f32_16x16x32_bf16 v[72:75], v[192:195], a[88:91], v[72:75]
  ds_read_b64_tr_b16 v[154:155], v18 offset:1344
  v_mfma_f32_16x16x32_bf16 v[112:115], v[192:195], a[92:95], v[112:115]
  ds_read_b64_tr_b16 v[156:157], v19 offset:96
  ds_read_b64_tr_b16 v[158:159], v19 offset:1376
  v_mfma_f32_16x16x32_bf16 v[76:79], v[196:199], a[88:91], v[76:79]
  ds_read_b64_tr_b16 v[160:161], v18 offset:128
  v_mfma_f32_16x16x32_bf16 v[116:119], v[196:199], a[92:95], v[116:119]
  ds_read_b64_tr_b16 v[162:163], v18 offset:1408
  v_mfma_f32_16x16x32_bf16 v[80:83], v[200:203], a[88:91], v[80:83]
  ds_read_b64_tr_b16 v[164:165], v19 offset:160
  v_mfma_f32_16x16x32_bf16 v[120:123], v[200:203], a[92:95], v[120:123]
  ds_read_b64_tr_b16 v[166:167], v19 offset:1440
  v_mfma_f32_16x16x32_bf16 v[84:87], v[204:207], a[88:91], v[84:87]
  ds_read_b64_tr_b16 v[168:169], v18 offset:192
  v_mfma_f32_16x16x32_bf16 v[124:127], v[204:207], a[92:95], v[124:127]
  ds_read_b64_tr_b16 v[170:171], v18 offset:1472
  ds_read_b64_tr_b16 v[172:173], v19 offset:224
  v_mfma_f32_16x16x32_bf16 v[88:91], v[208:211], a[88:91], v[88:91]
  ds_read_b64_tr_b16 v[174:175], v19 offset:1504
  v_mfma_f32_16x16x32_bf16 v[128:131], v[208:211], a[92:95], v[128:131]
  buffer_load_dwordx4 v[224:227], v4, s[8:11], s50 offen
  ds_read_b64_tr_b16 v[176:177], v18 offset:256
  v_mfma_f32_16x16x32_bf16 v[92:95], v[212:215], a[88:91], v[92:95]
  ds_read_b64_tr_b16 v[178:179], v18 offset:1536
  v_mfma_f32_16x16x32_bf16 v[132:135], v[212:215], a[92:95], v[132:135]
  ds_read_b64_tr_b16 v[180:181], v19 offset:288
  v_mfma_f32_16x16x32_bf16 v[96:99], v[216:219], a[88:91], v[96:99]
  ds_read_b64_tr_b16 v[182:183], v19 offset:1568
  v_mfma_f32_16x16x32_bf16 v[136:139], v[216:219], a[92:95], v[136:139]
  buffer_load_dword v228, v5, s[8:11], s50 offen offset:1024
  v_mfma_f32_16x16x32_bf16 v[100:103], v[220:223], a[88:91], v[100:103]
  s_add_u32 s50, s50, 1280
  v_mfma_f32_16x16x32_bf16 v[140:143], v[220:223], a[92:95], v[140:143]
  s_waitcnt lgkmcnt(0) vmcnt(28)
  v_mfma_f32_16x16x32_bf16 v[64:67], v[144:147], a[96:99], v[64:67]
  ds_read_b64_tr_b16 v[184:185], v18 offset:10240
  ds_read_b64_tr_b16 v[186:187], v18 offset:11520
  v_mfma_f32_16x16x32_bf16 v[104:107], v[144:147], a[100:103], v[104:107]
  ds_read_b64_tr_b16 v[188:189], v19 offset:10272
  v_mfma_f32_16x16x32_bf16 v[68:71], v[148:151], a[96:99], v[68:71]
  ds_read_b64_tr_b16 v[190:191], v19 offset:11552
  v_mfma_f32_16x16x32_bf16 v[108:111], v[148:151], a[100:103], v[108:111]
  ds_read_b64_tr_b16 v[192:193], v18 offset:10304
  v_mfma_f32_16x16x32_bf16 v[72:75], v[152:155], a[96:99], v[72:75]
  ds_read_b64_tr_b16 v[194:195], v18 offset:11584
  v_mfma_f32_16x16x32_bf16 v[112:115], v[152:155], a[100:103], v[112:115]
  ds_read_b64_tr_b16 v[196:197], v19 offset:10336
  ds_read_b64_tr_b16 v[198:199], v19 offset:11616
  v_mfma_f32_16x16x32_bf16 v[76:79], v[156:159], a[96:99], v[76:79]
  ds_read_b64_tr_b16 v[200:201], v18 offset:10368
  v_mfma_f32_16x16x32_bf16 v[116:119], v[156:159], a[100:103], v[116:119]
  ds_read_b64_tr_b16 v[202:203], v18 offset:11648
  v_mfma_f32_16x16x32_bf16 v[80:83], v[160:163], a[96:99], v[80:83]
  ds_read_b64_tr_b16 v[204:205], v19 offset:10400
  v_mfma_f32_16x16x32_bf16 v[120:123], v[160:163], a[100:103], v[120:123]
  ds_read_b64_tr_b16 v[206:207], v19 offset:11680
  v_mfma_f32_16x16x32_bf16 v[84:87], v[164:167], a[96:99], v[84:87]
  ds_read_b64_tr_b16 v[208:209], v18 offset:10432
  v_mfma_f32_16x16x32_bf16 v[124:127], v[164:167], a[100:103], v[124:127]
  ds_read_b64_tr_b16 v[210:211], v18 offset:11712
  ds_read_b64_tr_b16 v[212:213], v19 offset:10464
  v_mfma_f32_16x16x32_bf16 v[88:91], v[168:171], a[96:99], v[88:91]
  ds_read_b64_tr_b16 v[214:215], v19 offset:11744
  v_mfma_f32_16x16x32_bf16 v[128:131], v[168:171], a[100:103], v[128:131]
  buffer_load_dwordx4 v[230:233], v4, s[8:11], s50 offen
  ds_read_b64_tr_b16 v[216:217], v18 offset:10496
  v_mfma_f32_16x16x32_bf16 v[92:95], v[172:175], a[96:99], v[92:95]
  ds_read_b64_tr_b16 v[218:219], v18 offset:11776
  v_mfma_f32_16x16x32_bf16 v[132:135], v[172:175], a[100:103], v[132:135]
  ds_read_b64_tr_b16 v[220:221], v19 offset:10528
  v_mfma_f32_16x16x32_bf16 v[96:99], v[176:179], a[96:99], v[96:99]
  ds_read_b64_tr_b16 v[222:223], v19 offset:11808
  v_mfma_f32_16x16x32_bf16 v[136:139], v[176:179], a[100:103], v[136:139]
  buffer_load_dword v234, v5, s[8:11], s50 offen offset:1024
  v_mfma_f32_16x16x32_bf16 v[100:103], v[180:183], a[96:99], v[100:103]
  s_add_u32 s50, s50, 1280
  v_mfma_f32_16x16x32_bf16 v[140:143], v[180:183], a[100:103], v[140:143]
  s_waitcnt lgkmcnt(0) vmcnt(23)
  s_barrier
  v_mfma_f32_16x16x32_bf16 v[64:67], v[184:187], a[104:107], v[64:67]
  ds_read_b64_tr_b16 v[144:145], v14 offset:0
  ds_read_b64_tr_b16 v[146:147], v14 offset:1280
  v_mfma_f32_16x16x32_bf16 v[104:107], v[184:187], a[108:111], v[104:107]
  ds_read_b64_tr_b16 v[148:149], v15 offset:32
  v_mfma_f32_16x16x32_bf16 v[68:71], v[188:191], a[104:107], v[68:71]
  ds_read_b64_tr_b16 v[150:151], v15 offset:1312
  v_mfma_f32_16x16x32_bf16 v[108:111], v[188:191], a[108:111], v[108:111]
  ds_read_b64_tr_b16 v[152:153], v14 offset:64
  v_mfma_f32_16x16x32_bf16 v[72:75], v[192:195], a[104:107], v[72:75]
  ds_read_b64_tr_b16 v[154:155], v14 offset:1344
  v_mfma_f32_16x16x32_bf16 v[112:115], v[192:195], a[108:111], v[112:115]
  ds_read_b64_tr_b16 v[156:157], v15 offset:96
  ds_read_b64_tr_b16 v[158:159], v15 offset:1376
  v_mfma_f32_16x16x32_bf16 v[76:79], v[196:199], a[104:107], v[76:79]
  ds_read_b64_tr_b16 v[160:161], v14 offset:128
  v_mfma_f32_16x16x32_bf16 v[116:119], v[196:199], a[108:111], v[116:119]
  ds_read_b64_tr_b16 v[162:163], v14 offset:1408
  v_mfma_f32_16x16x32_bf16 v[80:83], v[200:203], a[104:107], v[80:83]
  ds_read_b64_tr_b16 v[164:165], v15 offset:160
  v_mfma_f32_16x16x32_bf16 v[120:123], v[200:203], a[108:111], v[120:123]
  ds_read_b64_tr_b16 v[166:167], v15 offset:1440
  v_mfma_f32_16x16x32_bf16 v[84:87], v[204:207], a[104:107], v[84:87]
  ds_read_b64_tr_b16 v[168:169], v14 offset:192
  v_mfma_f32_16x16x32_bf16 v[124:127], v[204:207], a[108:111], v[124:127]
  ds_read_b64_tr_b16 v[170:171], v14 offset:1472
  ds_read_b64_tr_b16 v[172:173], v15 offset:224
  v_mfma_f32_16x16x32_bf16 v[88:91], v[208:211], a[104:107], v[88:91]
  ds_read_b64_tr_b16 v[174:175], v15 offset:1504
  v_mfma_f32_16x16x32_bf16 v[128:131], v[208:211], a[108:111], v[128:131]
  buffer_load_dwordx4 v[236:239], v4, s[8:11], s50 offen
  ds_read_b64_tr_b16 v[176:177], v14 offset:256
  v_mfma_f32_16x16x32_bf16 v[92:95], v[212:215], a[104:107], v[92:95]
  ds_read_b64_tr_b16 v[178:179], v14 offset:1536
  v_mfma_f32_16x16x32_bf16 v[132:135], v[212:215], a[108:111], v[132:135]
  ds_read_b64_tr_b16 v[180:181], v15 offset:288
  v_mfma_f32_16x16x32_bf16 v[96:99], v[216:219], a[104:107], v[96:99]
  ds_read_b64_tr_b16 v[182:183], v15 offset:1568
  v_mfma_f32_16x16x32_bf16 v[136:139], v[216:219], a[108:111], v[136:139]
  buffer_load_dword v240, v5, s[8:11], s50 offen offset:1024
  v_mfma_f32_16x16x32_bf16 v[100:103], v[220:223], a[104:107], v[100:103]
  s_add_u32 s50, s50, 1280
  v_mfma_f32_16x16x32_bf16 v[140:143], v[220:223], a[108:111], v[140:143]
  s_waitcnt lgkmcnt(0) vmcnt(23)
  v_mfma_f32_16x16x32_bf16 v[64:67], v[144:147], a[112:115], v[64:67]
  ds_read_b64_tr_b16 v[184:185], v14 offset:10240
  ds_read_b64_tr_b16 v[186:187], v14 offset:11520
  v_mfma_f32_16x16x32_bf16 v[104:107], v[144:147], a[116:119], v[104:107]
  ds_read_b64_tr_b16 v[188:189], v15 offset:10272
  v_mfma_f32_16x16x32_bf16 v[68:71], v[148:151], a[112:115], v[68:71]
  ds_read_b64_tr_b16 v[190:191], v15 offset:11552
  v_mfma_f32_16x16x32_bf16 v[108:111], v[148:151], a[116:119], v[108:111]
  ds_read_b64_tr_b16 v[192:193], v14 offset:10304
  v_mfma_f32_16x16x32_bf16 v[72:75], v[152:155], a[112:115], v[72:75]
  ds_read_b64_tr_b16 v[194:195], v14 offset:11584
  v_mfma_f32_16x16x32_bf16 v[112:115], v[152:155], a[116:119], v[112:115]
  ds_read_b64_tr_b16 v[196:197], v15 offset:10336
  ds_read_b64_tr_b16 v[198:199], v15 offset:11616
  v_mfma_f32_16x16x32_bf16 v[76:79], v[156:159], a[112:115], v[76:79]
  ds_read_b64_tr_b16 v[200:201], v14 offset:10368
  v_mfma_f32_16x16x32_bf16 v[116:119], v[156:159], a[116:119], v[116:119]
  ds_read_b64_tr_b16 v[202:203], v14 offset:11648
  v_mfma_f32_16x16x32_bf16 v[80:83], v[160:163], a[112:115], v[80:83]
  ds_read_b64_tr_b16 v[204:205], v15 offset:10400
  v_mfma_f32_16x16x32_bf16 v[120:123], v[160:163], a[116:119], v[120:123]
  ds_read_b64_tr_b16 v[206:207], v15 offset:11680
  v_mfma_f32_16x16x32_bf16 v[84:87], v[164:167], a[112:115], v[84:87]
  ds_read_b64_tr_b16 v[208:209], v14 offset:10432
  v_mfma_f32_16x16x32_bf16 v[124:127], v[164:167], a[116:119], v[124:127]
  ds_read_b64_tr_b16 v[210:211], v14 offset:11712
  ds_read_b64_tr_b16 v[212:213], v15 offset:10464
  v_mfma_f32_16x16x32_bf16 v[88:91], v[168:171], a[112:115], v[88:91]
  ds_read_b64_tr_b16 v[214:215], v15 offset:11744
  v_mfma_f32_16x16x32_bf16 v[128:131], v[168:171], a[116:119], v[128:131]
  buffer_load_dwordx4 v[242:245], v4, s[8:11], s50 offen
  ds_read_b64_tr_b16 v[216:217], v14 offset:10496
  v_mfma_f32_16x16x32_bf16 v[92:95], v[172:175], a[112:115], v[92:95]
  ds_read_b64_tr_b16 v[218:219], v14 offset:11776
  v_mfma_f32_16x16x32_bf16 v[132:135], v[172:175], a[116:119], v[132:135]
  ds_read_b64_tr_b16 v[220:221], v15 offset:10528
  v_mfma_f32_16x16x32_bf16 v[96:99], v[176:179], a[112:115], v[96:99]
  ds_read_b64_tr_b16 v[222:223], v15 offset:11808
  v_mfma_f32_16x16x32_bf16 v[136:139], v[176:179], a[116:119], v[136:139]
  buffer_load_dword v246, v5, s[8:11], s50 offen offset:1024
  v_mfma_f32_16x16x32_bf16 v[100:103], v[180:183], a[112:115], v[100:103]
  s_add_u32 s50, s50, 1280
  v_mfma_f32_16x16x32_bf16 v[140:143], v[180:183], a[116:119], v[140:143]
  s_waitcnt lgkmcnt(0) vmcnt(18)
  s_barrier
  v_mfma_f32_16x16x32_bf16 v[64:67], v[184:187], a[120:123], v[64:67]
  ds_read_b64_tr_b16 v[144:145], v14 offset:20480
  ds_read_b64_tr_b16 v[146:147], v14 offset:21760
  v_mfma_f32_16x16x32_bf16 v[104:107], v[184:187], a[124:127], v[104:107]
  ds_read_b64_tr_b16 v[148:149], v15 offset:20512
  v_mfma_f32_16x16x32_bf16 v[68:71], v[188:191], a[120:123], v[68:71]
  ds_read_b64_tr_b16 v[150:151], v15 offset:21792
  v_mfma_f32_16x16x32_bf16 v[108:111], v[188:191], a[124:127], v[108:111]
  ds_read_b64_tr_b16 v[152:153], v14 offset:20544
  v_mfma_f32_16x16x32_bf16 v[72:75], v[192:195], a[120:123], v[72:75]
  ds_read_b64_tr_b16 v[154:155], v14 offset:21824
  v_mfma_f32_16x16x32_bf16 v[112:115], v[192:195], a[124:127], v[112:115]
  ds_read_b64_tr_b16 v[156:157], v15 offset:20576
  ds_read_b64_tr_b16 v[158:159], v15 offset:21856
  v_mfma_f32_16x16x32_bf16 v[76:79], v[196:199], a[120:123], v[76:79]
  ds_read_b64_tr_b16 v[160:161], v14 offset:20608
  v_mfma_f32_16x16x32_bf16 v[116:119], v[196:199], a[124:127], v[116:119]
  ds_read_b64_tr_b16 v[162:163], v14 offset:21888
  v_mfma_f32_16x16x32_bf16 v[80:83], v[200:203], a[120:123], v[80:83]
  ds_read_b64_tr_b16 v[164:165], v15 offset:20640
  v_mfma_f32_16x16x32_bf16 v[120:123], v[200:203], a[124:127], v[120:123]
  ds_read_b64_tr_b16 v[166:167], v15 offset:21920
  v_mfma_f32_16x16x32_bf16 v[84:87], v[204:207], a[120:123], v[84:87]
  ds_read_b64_tr_b16 v[168:169], v14 offset:20672
  v_mfma_f32_16x16x32_bf16 v[124:127], v[204:207], a[124:127], v[124:127]
  ds_read_b64_tr_b16 v[170:171], v14 offset:21952
  ds_read_b64_tr_b16 v[172:173], v15 offset:20704
  v_mfma_f32_16x16x32_bf16 v[88:91], v[208:211], a[120:123], v[88:91]
  ds_read_b64_tr_b16 v[174:175], v15 offset:21984
  v_mfma_f32_16x16x32_bf16 v[128:131], v[208:211], a[124:127], v[128:131]
  buffer_load_dwordx4 v[248:251], v4, s[8:11], s50 offen
  ds_read_b64_tr_b16 v[176:177], v14 offset:20736
  v_mfma_f32_16x16x32_bf16 v[92:95], v[212:215], a[120:123], v[92:95]
  ds_read_b64_tr_b16 v[178:179], v14 offset:22016
  v_mfma_f32_16x16x32_bf16 v[132:135], v[212:215], a[124:127], v[132:135]
  ds_read_b64_tr_b16 v[180:181], v15 offset:20768
  v_mfma_f32_16x16x32_bf16 v[96:99], v[216:219], a[120:123], v[96:99]
  ds_read_b64_tr_b16 v[182:183], v15 offset:22048
  v_mfma_f32_16x16x32_bf16 v[136:139], v[216:219], a[124:127], v[136:139]
  buffer_load_dword v252, v5, s[8:11], s50 offen offset:1024
  v_mfma_f32_16x16x32_bf16 v[100:103], v[220:223], a[120:123], v[100:103]
  s_add_u32 s50, s50, 1280
  v_mfma_f32_16x16x32_bf16 v[140:143], v[220:223], a[124:127], v[140:143]
  s_waitcnt lgkmcnt(0) vmcnt(18)
  v_mfma_f32_16x16x32_bf16 v[64:67], v[144:147], a[128:131], v[64:67]
  ds_read_b64_tr_b16 v[184:185], v14 offset:30720
  ds_read_b64_tr_b16 v[186:187], v14 offset:32000
  v_mfma_f32_16x16x32_bf16 v[104:107], v[144:147], a[132:135], v[104:107]
  ds_read_b64_tr_b16 v[188:189], v15 offset:30752
  v_mfma_f32_16x16x32_bf16 v[68:71], v[148:151], a[128:131], v[68:71]
  ds_read_b64_tr_b16 v[190:191], v15 offset:32032
  v_mfma_f32_16x16x32_bf16 v[108:111], v[148:151], a[132:135], v[108:111]
  ds_read_b64_tr_b16 v[192:193], v14 offset:30784
  v_mfma_f32_16x16x32_bf16 v[72:75], v[152:155], a[128:131], v[72:75]
  ds_read_b64_tr_b16 v[194:195], v14 offset:32064
  v_mfma_f32_16x16x32_bf16 v[112:115], v[152:155], a[132:135], v[112:115]
  ds_read_b64_tr_b16 v[196:197], v15 offset:30816
  ds_read_b64_tr_b16 v[198:199], v15 offset:32096
  v_mfma_f32_16x16x32_bf16 v[76:79], v[156:159], a[128:131], v[76:79]
  ds_read_b64_tr_b16 v[200:201], v14 offset:30848
  v_mfma_f32_16x16x32_bf16 v[116:119], v[156:159], a[132:135], v[116:119]
  ds_read_b64_tr_b16 v[202:203], v14 offset:32128
  v_mfma_f32_16x16x32_bf16 v[80:83], v[160:163], a[128:131], v[80:83]
  ds_read_b64_tr_b16 v[204:205], v15 offset:30880
  v_mfma_f32_16x16x32_bf16 v[120:123], v[160:163], a[132:135], v[120:123]
  ds_read_b64_tr_b16 v[206:207], v15 offset:32160
  v_mfma_f32_16x16x32_bf16 v[84:87], v[164:167], a[128:131], v[84:87]
  ds_read_b64_tr_b16 v[208:209], v14 offset:30912
  v_mfma_f32_16x16x32_bf16 v[124:127], v[164:167], a[132:135], v[124:127]
  ds_read_b64_tr_b16 v[210:211], v14 offset:32192
  ds_read_b64_tr_b16 v[212:213], v15 offset:30944
  v_mfma_f32_16x16x32_bf16 v[88:91], v[168:171], a[128:131], v[88:91]
  ds_read_b64_tr_b16 v[214:215], v15 offset:32224
  v_mfma_f32_16x16x32_bf16 v[128:131], v[168:171], a[132:135], v[128:131]
  buffer_load_dwordx4 v[30:33], v4, s[8:11], s50 offen
  ds_read_b64_tr_b16 v[216:217], v14 offset:30976
  v_mfma_f32_16x16x32_bf16 v[92:95], v[172:175], a[128:131], v[92:95]
  ds_read_b64_tr_b16 v[218:219], v14 offset:32256
  v_mfma_f32_16x16x32_bf16 v[132:135], v[172:175], a[132:135], v[132:135]
  ds_read_b64_tr_b16 v[220:221], v15 offset:31008
  v_mfma_f32_16x16x32_bf16 v[96:99], v[176:179], a[128:131], v[96:99]
  ds_read_b64_tr_b16 v[222:223], v15 offset:32288
  v_mfma_f32_16x16x32_bf16 v[136:139], v[176:179], a[132:135], v[136:139]
  buffer_load_dword v34, v5, s[8:11], s50 offen offset:1024
  v_mfma_f32_16x16x32_bf16 v[100:103], v[180:183], a[128:131], v[100:103]
  s_add_u32 s50, s50, 1280
  v_mfma_f32_16x16x32_bf16 v[140:143], v[180:183], a[132:135], v[140:143]
  s_waitcnt lgkmcnt(0) vmcnt(18)
  s_barrier
  v_mfma_f32_16x16x32_bf16 v[64:67], v[184:187], a[136:139], v[64:67]
  ds_read_b64_tr_b16 v[144:145], v14 offset:40960
  ds_read_b64_tr_b16 v[146:147], v14 offset:42240
  v_mfma_f32_16x16x32_bf16 v[104:107], v[184:187], a[140:143], v[104:107]
  ds_read_b64_tr_b16 v[148:149], v15 offset:40992
  v_mfma_f32_16x16x32_bf16 v[68:71], v[188:191], a[136:139], v[68:71]
  ds_read_b64_tr_b16 v[150:151], v15 offset:42272
  v_mfma_f32_16x16x32_bf16 v[108:111], v[188:191], a[140:143], v[108:111]
  ds_read_b64_tr_b16 v[152:153], v14 offset:41024
  v_mfma_f32_16x16x32_bf16 v[72:75], v[192:195], a[136:139], v[72:75]
  ds_read_b64_tr_b16 v[154:155], v14 offset:42304
  v_mfma_f32_16x16x32_bf16 v[112:115], v[192:195], a[140:143], v[112:115]
  ds_read_b64_tr_b16 v[156:157], v15 offset:41056
  ds_read_b64_tr_b16 v[158:159], v15 offset:42336
  v_mfma_f32_16x16x32_bf16 v[76:79], v[196:199], a[136:139], v[76:79]
  ds_read_b64_tr_b16 v[160:161], v14 offset:41088
  v_mfma_f32_16x16x32_bf16 v[116:119], v[196:199], a[140:143], v[116:119]
  ds_read_b64_tr_b16 v[162:163], v14 offset:42368
  v_mfma_f32_16x16x32_bf16 v[80:83], v[200:203], a[136:139], v[80:83]
  ds_read_b64_tr_b16 v[164:165], v15 offset:41120
  v_mfma_f32_16x16x32_bf16 v[120:123], v[200:203], a[140:143], v[120:123]
  ds_read_b64_tr_b16 v[166:167], v15 offset:42400
  v_mfma_f32_16x16x32_bf16 v[84:87], v[204:207], a[136:139], v[84:87]
  ds_read_b64_tr_b16 v[168:169], v14 offset:41152
  v_mfma_f32_16x16x32_bf16 v[124:127], v[204:207], a[140:143], v[124:127]
  ds_read_b64_tr_b16 v[170:171], v14 offset:42432
  ds_read_b64_tr_b16 v[172:173], v15 offset:41184
  v_mfma_f32_16x16x32_bf16 v[88:91], v[208:211], a[136:139], v[88:91]
  ds_read_b64_tr_b16 v[174:175], v15 offset:42464
  v_mfma_f32_16x16x32_bf16 v[128:131], v[208:211], a[140:143], v[128:131]
  buffer_load_dwordx4 v[36:39], v4, s[8:11], s50 offen
  ds_read_b64_tr_b16 v[176:177], v14 offset:41216
  v_mfma_f32_16x16x32_bf16 v[92:95], v[212:215], a[136:139], v[92:95]
  ds_read_b64_tr_b16 v[178:179], v14 offset:42496
  v_mfma_f32_16x16x32_bf16 v[132:135], v[212:215], a[140:143], v[132:135]
  ds_read_b64_tr_b16 v[180:181], v15 offset:41248
  v_mfma_f32_16x16x32_bf16 v[96:99], v[216:219], a[136:139], v[96:99]
  ds_read_b64_tr_b16 v[182:183], v15 offset:42528
  v_mfma_f32_16x16x32_bf16 v[136:139], v[216:219], a[140:143], v[136:139]
  buffer_load_dword v40, v5, s[8:11], s50 offen offset:1024
  v_mfma_f32_16x16x32_bf16 v[100:103], v[220:223], a[136:139], v[100:103]
  s_add_u32 s50, s50, 1280
  v_mfma_f32_16x16x32_bf16 v[140:143], v[220:223], a[140:143], v[140:143]
  s_waitcnt lgkmcnt(0) vmcnt(18)
  v_mfma_f32_16x16x32_bf16 v[64:67], v[144:147], a[144:147], v[64:67]
  ds_read_b64_tr_b16 v[184:185], v14 offset:51200
  ds_read_b64_tr_b16 v[186:187], v14 offset:52480
  v_mfma_f32_16x16x32_bf16 v[104:107], v[144:147], a[148:151], v[104:107]
  ds_read_b64_tr_b16 v[188:189], v15 offset:51232
  v_mfma_f32_16x16x32_bf16 v[68:71], v[148:151], a[144:147], v[68:71]
  ds_read_b64_tr_b16 v[190:191], v15 offset:52512
  v_mfma_f32_16x16x32_bf16 v[108:111], v[148:151], a[148:151], v[108:111]
  ds_read_b64_tr_b16 v[192:193], v14 offset:51264
  v_mfma_f32_16x16x32_bf16 v[72:75], v[152:155], a[144:147], v[72:75]
  ds_read_b64_tr_b16 v[194:195], v14 offset:52544
  v_mfma_f32_16x16x32_bf16 v[112:115], v[152:155], a[148:151], v[112:115]
  ds_read_b64_tr_b16 v[196:197], v15 offset:51296
  ds_read_b64_tr_b16 v[198:199], v15 offset:52576
  v_mfma_f32_16x16x32_bf16 v[76:79], v[156:159], a[144:147], v[76:79]
  ds_read_b64_tr_b16 v[200:201], v14 offset:51328
  v_mfma_f32_16x16x32_bf16 v[116:119], v[156:159], a[148:151], v[116:119]
  ds_read_b64_tr_b16 v[202:203], v14 offset:52608
  v_mfma_f32_16x16x32_bf16 v[80:83], v[160:163], a[144:147], v[80:83]
  ds_read_b64_tr_b16 v[204:205], v15 offset:51360
  v_mfma_f32_16x16x32_bf16 v[120:123], v[160:163], a[148:151], v[120:123]
  ds_read_b64_tr_b16 v[206:207], v15 offset:52640
  v_mfma_f32_16x16x32_bf16 v[84:87], v[164:167], a[144:147], v[84:87]
  ds_read_b64_tr_b16 v[208:209], v14 offset:51392
  v_mfma_f32_16x16x32_bf16 v[124:127], v[164:167], a[148:151], v[124:127]
  ds_read_b64_tr_b16 v[210:211], v14 offset:52672
  ds_read_b64_tr_b16 v[212:213], v15 offset:51424
  v_mfma_f32_16x16x32_bf16 v[88:91], v[168:171], a[144:147], v[88:91]
  ds_read_b64_tr_b16 v[214:215], v15 offset:52704
  v_mfma_f32_16x16x32_bf16 v[128:131], v[168:171], a[148:151], v[128:131]
  buffer_load_dwordx4 v[42:45], v4, s[8:11], s50 offen
  ds_read_b64_tr_b16 v[216:217], v14 offset:51456
  v_mfma_f32_16x16x32_bf16 v[92:95], v[172:175], a[144:147], v[92:95]
  ds_read_b64_tr_b16 v[218:219], v14 offset:52736
  v_mfma_f32_16x16x32_bf16 v[132:135], v[172:175], a[148:151], v[132:135]
  ds_read_b64_tr_b16 v[220:221], v15 offset:51488
  v_mfma_f32_16x16x32_bf16 v[96:99], v[176:179], a[144:147], v[96:99]
  ds_read_b64_tr_b16 v[222:223], v15 offset:52768
  v_mfma_f32_16x16x32_bf16 v[136:139], v[176:179], a[148:151], v[136:139]
  buffer_load_dword v46, v5, s[8:11], s50 offen offset:1024
  v_mfma_f32_16x16x32_bf16 v[100:103], v[180:183], a[144:147], v[100:103]
  s_add_u32 s50, s50, 1280
  v_mfma_f32_16x16x32_bf16 v[140:143], v[180:183], a[148:151], v[140:143]
  s_waitcnt lgkmcnt(0) vmcnt(18)
  v_mfma_f32_16x16x32_bf16 v[64:67], v[184:187], a[152:155], v[64:67]
  v_mfma_f32_16x16x32_bf16 v[104:107], v[184:187], a[156:159], v[104:107]
  v_mfma_f32_16x16x32_bf16 v[68:71], v[188:191], a[152:155], v[68:71]
  v_mfma_f32_16x16x32_bf16 v[108:111], v[188:191], a[156:159], v[108:111]
  v_mfma_f32_16x16x32_bf16 v[72:75], v[192:195], a[152:155], v[72:75]
  v_mfma_f32_16x16x32_bf16 v[112:115], v[192:195], a[156:159], v[112:115]
  v_mfma_f32_16x16x32_bf16 v[76:79], v[196:199], a[152:155], v[76:79]
  v_mfma_f32_16x16x32_bf16 v[116:119], v[196:199], a[156:159], v[116:119]
  v_mfma_f32_16x16x32_bf16 v[80:83], v[200:203], a[152:155], v[80:83]
  v_mfma_f32_16x16x32_bf16 v[120:123], v[200:203], a[156:159], v[120:123]
  v_mfma_f32_16x16x32_bf16 v[84:87], v[204:207], a[152:155], v[84:87]
  v_mfma_f32_16x16x32_bf16 v[124:127], v[204:207], a[156:159], v[124:127]
  v_mfma_f32_16x16x32_bf16 v[88:91], v[208:211], a[152:155], v[88:91]
  v_mfma_f32_16x16x32_bf16 v[128:131], v[208:211], a[156:159], v[128:131]
  v_mfma_f32_16x16x32_bf16 v[92:95], v[212:215], a[152:155], v[92:95]
  v_mfma_f32_16x16x32_bf16 v[132:135], v[212:215], a[156:159], v[132:135]
  v_mfma_f32_16x16x32_bf16 v[96:99], v[216:219], a[152:155], v[96:99]
  v_mfma_f32_16x16x32_bf16 v[136:139], v[216:219], a[156:159], v[136:139]
  v_mfma_f32_16x16x32_bf16 v[100:103], v[220:223], a[152:155], v[100:103]
  v_mfma_f32_16x16x32_bf16 v[140:143], v[220:223], a[156:159], v[140:143]
  s_add_u32 s16, s38, 73400320
  s_addc_u32 s17, s39, 0
  s_mov_b32 s18, 5242880
  s_mov_b32 s19, 0x00020000
  s_nop 3
  s_mul_i32 s21, s47, 40
  s_mul_i32 s22, s44, 10
  s_add_u32 s21, s21, s22
  s_lshl_b32 s21, s21, 10
  s_cmp_lt_u32 s2, 32
  s_cbranch_scc1 om_247
  s_add_u32 s22, s21, 0
  buffer_store_dwordx4 v[64:67], v4, s[16:19], s22 offen offset:0 sc1
  buffer_store_dwordx4 v[68:71], v4, s[16:19], s22 offen offset:1024 sc1
  buffer_store_dwordx4 v[72:75], v4, s[16:19], s22 offen offset:2048 sc1
  buffer_store_dwordx4 v[76:79], v4, s[16:19], s22 offen offset:3072 sc1
  s_add_u32 s22, s21, 4096
  buffer_store_dwordx4 v[80:83], v4, s[16:19], s22 offen offset:0 sc1
  buffer_store_dwordx4 v[84:87], v4, s[16:19], s22 offen offset:1024 sc1
  buffer_store_dwordx4 v[88:91], v4, s[16:19], s22 offen offset:2048 sc1
  buffer_store_dwordx4 v[92:95], v4, s[16:19], s22 offen offset:3072 sc1
  s_add_u32 s22, s21, 8192
  buffer_store_dwordx4 v[96:99], v4, s[16:19], s22 offen offset:0 sc1
  buffer_store_dwordx4 v[100:103], v4, s[16:19], s22 offen offset:1024 sc1
  s_add_u32 s22, s21, 40960
  buffer_store_dwordx4 v[104:107], v4, s[16:19], s22 offen offset:0 sc1
  buffer_store_dwordx4 v[108:111], v4, s[16:19], s22 offen offset:1024 sc1
  buffer_store_dwordx4 v[112:115], v4, s[16:19], s22 offen offset:2048 sc1
  buffer_store_dwordx4 v[116:119], v4, s[16:19], s22 offen offset:3072 sc1
  s_add_u32 s22, s21, 45056
  buffer_store_dwordx4 v[120:123], v4, s[16:19], s22 offen offset:0 sc1
  buffer_store_dwordx4 v[124:127], v4, s[16:19], s22 offen offset:1024 sc1
  buffer_store_dwordx4 v[128:131], v4, s[16:19], s22 offen offset:2048 sc1
  buffer_store_dwordx4 v[132:135], v4, s[16:19], s22 offen offset:3072 sc1
  s_add_u32 s22, s21, 49152
  buffer_store_dwordx4 v[136:139], v4, s[16:19], s22 offen offset:0 sc1
  buffer_store_dwordx4 v[140:143], v4, s[16:19], s22 offen offset:1024 sc1
  s_sub_u32 s50, s50, 1320960
  buffer_load_dwordx4 v[160:163], v4, s[8:11], s50 offen
  buffer_load_dword v164, v5, s[8:11], s50 offen offset:1024
  s_add_u32 s50, s50, 1280
  buffer_load_dwordx4 v[166:169], v4, s[8:11], s50 offen
  buffer_load_dword v170, v5, s[8:11], s50 offen offset:1024
  s_add_u32 s50, s50, 1280
  buffer_load_dwordx4 v[172:175], v4, s[8:11], s50 offen
  buffer_load_dword v176, v5, s[8:11], s50 offen offset:1024
  s_add_u32 s50, s50, 1280
  buffer_load_dwordx4 v[178:181], v4, s[8:11], s50 offen
  buffer_load_dword v182, v5, s[8:11], s50 offen offset:1024
  s_add_u32 s50, s50, 1280
  buffer_load_dwordx4 v[184:187], v4, s[8:11], s50 offen
  buffer_load_dword v188, v5, s[8:11], s50 offen offset:1024
  s_add_u32 s50, s50, 1280
  buffer_load_dwordx4 v[190:193], v4, s[8:11], s50 offen
  buffer_load_dword v194, v5, s[8:11], s50 offen offset:1024
  s_add_u32 s50, s50, 1280
  buffer_load_dwordx4 v[196:199], v4, s[8:11], s50 offen
  buffer_load_dword v200, v5, s[8:11], s50 offen offset:1024
  s_add_u32 s50, s50, 1280
  buffer_load_dwordx4 v[202:205], v4, s[8:11], s50 offen
  buffer_load_dword v206, v5, s[8:11], s50 offen offset:1024
  s_add_u32 s50, s50, 1280
  s_waitcnt vmcnt(36)
  v_lshlrev_b32 v57, 16, v52
  v_and_b32 v52, 0xffff0000, v52
  v_lshlrev_b32 v58, 16, v53
  v_and_b32 v53, 0xffff0000, v53
  v_lshlrev_b32 v59, 16, v54
  v_and_b32 v54, 0xffff0000, v54
  v_lshlrev_b32 v60, 16, v55
  v_and_b32 v55, 0xffff0000, v55
  v_lshlrev_b32 v61, 16, v56
  v_and_b32 v56, 0xffff0000, v56
  v_lshlrev_b32 v25, 16, v224
  v_and_b32 v26, 0xffff0000, v224
  v_mul_f32 v25, v25, v57
  v_mul_f32 v26, v26, v52
  v_cvt_pk_bf16_f32 v25, v25, v26
  v_lshlrev_b32 v26, 16, v25
  v_and_b32 v25, 0xffff0000, v25
  v_add_f32 v144, v25, v26
  v_lshlrev_b32 v25, 16, v225
  v_and_b32 v26, 0xffff0000, v225
  v_mul_f32 v25, v25, v58
  v_mul_f32 v26, v26, v53
  v_cvt_pk_bf16_f32 v25, v25, v26
  v_lshlrev_b32 v26, 16, v25
  v_and_b32 v25, 0xffff0000, v25
  v_add_f32 v144, v144, v26
  v_add_f32 v144, v144, v25
  v_lshlrev_b32 v25, 16, v226
  v_and_b32 v26, 0xffff0000, v226
  v_mul_f32 v25, v25, v59
  v_mul_f32 v26, v26, v54
  v_cvt_pk_bf16_f32 v25, v25, v26
  v_lshlrev_b32 v26, 16, v25
  v_and_b32 v25, 0xffff0000, v25
  v_add_f32 v144, v144, v26
  v_add_f32 v144, v144, v25
  v_lshlrev_b32 v25, 16, v227
  v_and_b32 v26, 0xffff0000, v227
  v_mul_f32 v25, v25, v60
  v_mul_f32 v26, v26, v55
  v_cvt_pk_bf16_f32 v25, v25, v26
  v_lshlrev_b32 v26, 16, v25
  v_and_b32 v25, 0xffff0000, v25
  v_add_f32 v144, v144, v26
  v_add_f32 v144, v144, v25
  v_lshlrev_b32 v25, 16, v228
  v_and_b32 v26, 0xffff0000, v228
  v_mul_f32 v25, v25, v61
  v_mul_f32 v26, v26, v56
  v_cvt_pk_bf16_f32 v25, v25, v26
  v_lshlrev_b32 v26, 16, v25
  v_and_b32 v25, 0xffff0000, v25
  v_add_f32 v144, v144, v26
  v_add_f32 v144, v144, v25
  v_lshlrev_b32 v25, 16, v230
  v_and_b32 v26, 0xffff0000, v230
  v_mul_f32 v25, v25, v57
  v_mul_f32 v26, v26, v52
  v_cvt_pk_bf16_f32 v25, v25, v26
  v_lshlrev_b32 v26, 16, v25
  v_and_b32 v25, 0xffff0000, v25
  v_add_f32 v145, v25, v26
  v_lshlrev_b32 v25, 16, v231
  v_and_b32 v26, 0xffff0000, v231
  v_mul_f32 v25, v25, v58
  v_mul_f32 v26, v26, v53
  v_cvt_pk_bf16_f32 v25, v25, v26
  v_lshlrev_b32 v26, 16, v25
  v_and_b32 v25, 0xffff0000, v25
  v_add_f32 v145, v145, v26
  v_add_f32 v145, v145, v25
  v_lshlrev_b32 v25, 16, v232
  v_and_b32 v26, 0xffff0000, v232
  v_mul_f32 v25, v25, v59
  v_mul_f32 v26, v26, v54
  v_cvt_pk_bf16_f32 v25, v25, v26
  v_lshlrev_b32 v26, 16, v25
  v_and_b32 v25, 0xffff0000, v25
  v_add_f32 v145, v145, v26
  v_add_f32 v145, v145, v25
  v_lshlrev_b32 v25, 16, v233
  v_and_b32 v26, 0xffff0000, v233
  v_mul_f32 v25, v25, v60
  v_mul_f32 v26, v26, v55
  v_cvt_pk_bf16_f32 v25, v25, v26
  v_lshlrev_b32 v26, 16, v25
  v_and_b32 v25, 0xffff0000, v25
  v_add_f32 v145, v145, v26
  v_add_f32 v145, v145, v25
  v_lshlrev_b32 v25, 16, v234
  v_and_b32 v26, 0xffff0000, v234
  v_mul_f32 v25, v25, v61
  v_mul_f32 v26, v26, v56
  v_cvt_pk_bf16_f32 v25, v25, v26
  v_lshlrev_b32 v26, 16, v25
  v_and_b32 v25, 0xffff0000, v25
  v_add_f32 v145, v145, v26
  v_add_f32 v145, v145, v25
  v_lshlrev_b32 v25, 16, v236
  v_and_b32 v26, 0xffff0000, v236
  v_mul_f32 v25, v25, v57
  v_mul_f32 v26, v26, v52
  v_cvt_pk_bf16_f32 v25, v25, v26
  v_lshlrev_b32 v26, 16, v25
  v_and_b32 v25, 0xffff0000, v25
  v_add_f32 v146, v25, v26
  v_lshlrev_b32 v25, 16, v237
  v_and_b32 v26, 0xffff0000, v237
  v_mul_f32 v25, v25, v58
  v_mul_f32 v26, v26, v53
  v_cvt_pk_bf16_f32 v25, v25, v26
  v_lshlrev_b32 v26, 16, v25
  v_and_b32 v25, 0xffff0000, v25
  v_add_f32 v146, v146, v26
  v_add_f32 v146, v146, v25
  v_lshlrev_b32 v25, 16, v238
  v_and_b32 v26, 0xffff0000, v238
  v_mul_f32 v25, v25, v59
  v_mul_f32 v26, v26, v54
  v_cvt_pk_bf16_f32 v25, v25, v26
  v_lshlrev_b32 v26, 16, v25
  v_and_b32 v25, 0xffff0000, v25
  v_add_f32 v146, v146, v26
  v_add_f32 v146, v146, v25
  v_lshlrev_b32 v25, 16, v239
  v_and_b32 v26, 0xffff0000, v239
  v_mul_f32 v25, v25, v60
  v_mul_f32 v26, v26, v55
  v_cvt_pk_bf16_f32 v25, v25, v26
  v_lshlrev_b32 v26, 16, v25
  v_and_b32 v25, 0xffff0000, v25
  v_add_f32 v146, v146, v26
  v_add_f32 v146, v146, v25
  v_lshlrev_b32 v25, 16, v240
  v_and_b32 v26, 0xffff0000, v240
  v_mul_f32 v25, v25, v61
  v_mul_f32 v26, v26, v56
  v_cvt_pk_bf16_f32 v25, v25, v26
  v_lshlrev_b32 v26, 16, v25
  v_and_b32 v25, 0xffff0000, v25
  v_add_f32 v146, v146, v26
  v_add_f32 v146, v146, v25
  v_lshlrev_b32 v25, 16, v242
  v_and_b32 v26, 0xffff0000, v242
  v_mul_f32 v25, v25, v57
  v_mul_f32 v26, v26, v52
  v_cvt_pk_bf16_f32 v25, v25, v26
  v_lshlrev_b32 v26, 16, v25
  v_and_b32 v25, 0xffff0000, v25
  v_add_f32 v147, v25, v26
  v_lshlrev_b32 v25, 16, v243
  v_and_b32 v26, 0xffff0000, v243
  v_mul_f32 v25, v25, v58
  v_mul_f32 v26, v26, v53
  v_cvt_pk_bf16_f32 v25, v25, v26
  v_lshlrev_b32 v26, 16, v25
  v_and_b32 v25, 0xffff0000, v25
  v_add_f32 v147, v147, v26
  v_add_f32 v147, v147, v25
  v_lshlrev_b32 v25, 16, v244
  v_and_b32 v26, 0xffff0000, v244
  v_mul_f32 v25, v25, v59
  v_mul_f32 v26, v26, v54
  v_cvt_pk_bf16_f32 v25, v25, v26
  v_lshlrev_b32 v26, 16, v25
  v_and_b32 v25, 0xffff0000, v25
  v_add_f32 v147, v147, v26
  v_add_f32 v147, v147, v25
  v_lshlrev_b32 v25, 16, v245
  v_and_b32 v26, 0xffff0000, v245
  v_mul_f32 v25, v25, v60
  v_mul_f32 v26, v26, v55
  v_cvt_pk_bf16_f32 v25, v25, v26
  v_lshlrev_b32 v26, 16, v25
  v_and_b32 v25, 0xffff0000, v25
  v_add_f32 v147, v147, v26
  v_add_f32 v147, v147, v25
  v_lshlrev_b32 v25, 16, v246
  v_and_b32 v26, 0xffff0000, v246
  v_mul_f32 v25, v25, v61
  v_mul_f32 v26, v26, v56
  v_cvt_pk_bf16_f32 v25, v25, v26
  v_lshlrev_b32 v26, 16, v25
  v_and_b32 v25, 0xffff0000, v25
  v_add_f32 v147, v147, v26
  v_add_f32 v147, v147, v25
  v_lshlrev_b32 v25, 16, v248
  v_and_b32 v26, 0xffff0000, v248
  v_mul_f32 v25, v25, v57
  v_mul_f32 v26, v26, v52
  v_cvt_pk_bf16_f32 v25, v25, v26
  v_lshlrev_b32 v26, 16, v25
  v_and_b32 v25, 0xffff0000, v25
  v_add_f32 v148, v25, v26
  v_lshlrev_b32 v25, 16, v249
  v_and_b32 v26, 0xffff0000, v249
  v_mul_f32 v25, v25, v58
  v_mul_f32 v26, v26, v53
  v_cvt_pk_bf16_f32 v25, v25, v26
  v_lshlrev_b32 v26, 16, v25
  v_and_b32 v25, 0xffff0000, v25
  v_add_f32 v148, v148, v26
  v_add_f32 v148, v148, v25
  v_lshlrev_b32 v25, 16, v250
  v_and_b32 v26, 0xffff0000, v250
  v_mul_f32 v25, v25, v59
  v_mul_f32 v26, v26, v54
  v_cvt_pk_bf16_f32 v25, v25, v26
  v_lshlrev_b32 v26, 16, v25
  v_and_b32 v25, 0xffff0000, v25
  v_add_f32 v148, v148, v26
  v_add_f32 v148, v148, v25
  v_lshlrev_b32 v25, 16, v251
  v_and_b32 v26, 0xffff0000, v251
  v_mul_f32 v25, v25, v60
  v_mul_f32 v26, v26, v55
  v_cvt_pk_bf16_f32 v25, v25, v26
  v_lshlrev_b32 v26, 16, v25
  v_and_b32 v25, 0xffff0000, v25
  v_add_f32 v148, v148, v26
  v_add_f32 v148, v148, v25
  v_lshlrev_b32 v25, 16, v252
  v_and_b32 v26, 0xffff0000, v252
  v_mul_f32 v25, v25, v61
  v_mul_f32 v26, v26, v56
  v_cvt_pk_bf16_f32 v25, v25, v26
  v_lshlrev_b32 v26, 16, v25
  v_and_b32 v25, 0xffff0000, v25
  v_add_f32 v148, v148, v26
  v_add_f32 v148, v148, v25
  v_lshlrev_b32 v25, 16, v30
  v_and_b32 v26, 0xffff0000, v30
  v_mul_f32 v25, v25, v57
  v_mul_f32 v26, v26, v52
  v_cvt_pk_bf16_f32 v25, v25, v26
  v_lshlrev_b32 v26, 16, v25
  v_and_b32 v25, 0xffff0000, v25
  v_add_f32 v149, v25, v26
  v_lshlrev_b32 v25, 16, v31
  v_and_b32 v26, 0xffff0000, v31
  v_mul_f32 v25, v25, v58
  v_mul_f32 v26, v26, v53
  v_cvt_pk_bf16_f32 v25, v25, v26
  v_lshlrev_b32 v26, 16, v25
  v_and_b32 v25, 0xffff0000, v25
  v_add_f32 v149, v149, v26
  v_add_f32 v149, v149, v25
  v_lshlrev_b32 v25, 16, v32
  v_and_b32 v26, 0xffff0000, v32
  v_mul_f32 v25, v25, v59
  v_mul_f32 v26, v26, v54
  v_cvt_pk_bf16_f32 v25, v25, v26
  v_lshlrev_b32 v26, 16, v25
  v_and_b32 v25, 0xffff0000, v25
  v_add_f32 v149, v149, v26
  v_add_f32 v149, v149, v25
  v_lshlrev_b32 v25, 16, v33
  v_and_b32 v26, 0xffff0000, v33
  v_mul_f32 v25, v25, v60
  v_mul_f32 v26, v26, v55
  v_cvt_pk_bf16_f32 v25, v25, v26
  v_lshlrev_b32 v26, 16, v25
  v_and_b32 v25, 0xffff0000, v25
  v_add_f32 v149, v149, v26
  v_add_f32 v149, v149, v25
  v_lshlrev_b32 v25, 16, v34
  v_and_b32 v26, 0xffff0000, v34
  v_mul_f32 v25, v25, v61
  v_mul_f32 v26, v26, v56
  v_cvt_pk_bf16_f32 v25, v25, v26
  v_lshlrev_b32 v26, 16, v25
  v_and_b32 v25, 0xffff0000, v25
  v_add_f32 v149, v149, v26
  v_add_f32 v149, v149, v25
  v_lshlrev_b32 v25, 16, v36
  v_and_b32 v26, 0xffff0000, v36
  v_mul_f32 v25, v25, v57
  v_mul_f32 v26, v26, v52
  v_cvt_pk_bf16_f32 v25, v25, v26
  v_lshlrev_b32 v26, 16, v25
  v_and_b32 v25, 0xffff0000, v25
  v_add_f32 v150, v25, v26
  v_lshlrev_b32 v25, 16, v37
  v_and_b32 v26, 0xffff0000, v37
  v_mul_f32 v25, v25, v58
  v_mul_f32 v26, v26, v53
  v_cvt_pk_bf16_f32 v25, v25, v26
  v_lshlrev_b32 v26, 16, v25
  v_and_b32 v25, 0xffff0000, v25
  v_add_f32 v150, v150, v26
  v_add_f32 v150, v150, v25
  v_lshlrev_b32 v25, 16, v38
  v_and_b32 v26, 0xffff0000, v38
  v_mul_f32 v25, v25, v59
  v_mul_f32 v26, v26, v54
  v_cvt_pk_bf16_f32 v25, v25, v26
  v_lshlrev_b32 v26, 16, v25
  v_and_b32 v25, 0xffff0000, v25
  v_add_f32 v150, v150, v26
  v_add_f32 v150, v150, v25
  v_lshlrev_b32 v25, 16, v39
  v_and_b32 v26, 0xffff0000, v39
  v_mul_f32 v25, v25, v60
  v_mul_f32 v26, v26, v55
  v_cvt_pk_bf16_f32 v25, v25, v26
  v_lshlrev_b32 v26, 16, v25
  v_and_b32 v25, 0xffff0000, v25
  v_add_f32 v150, v150, v26
  v_add_f32 v150, v150, v25
  v_lshlrev_b32 v25, 16, v40
  v_and_b32 v26, 0xffff0000, v40
  v_mul_f32 v25, v25, v61
  v_mul_f32 v26, v26, v56
  v_cvt_pk_bf16_f32 v25, v25, v26
  v_lshlrev_b32 v26, 16, v25
  v_and_b32 v25, 0xffff0000, v25
  v_add_f32 v150, v150, v26
  v_add_f32 v150, v150, v25
  v_lshlrev_b32 v25, 16, v42
  v_and_b32 v26, 0xffff0000, v42
  v_mul_f32 v25, v25, v57
  v_mul_f32 v26, v26, v52
  v_cvt_pk_bf16_f32 v25, v25, v26
  v_lshlrev_b32 v26, 16, v25
  v_and_b32 v25, 0xffff0000, v25
  v_add_f32 v151, v25, v26
  v_lshlrev_b32 v25, 16, v43
  v_and_b32 v26, 0xffff0000, v43
  v_mul_f32 v25, v25, v58
  v_mul_f32 v26, v26, v53
  v_cvt_pk_bf16_f32 v25, v25, v26
  v_lshlrev_b32 v26, 16, v25
  v_and_b32 v25, 0xffff0000, v25
  v_add_f32 v151, v151, v26
  v_add_f32 v151, v151, v25
  v_lshlrev_b32 v25, 16, v44
  v_and_b32 v26, 0xffff0000, v44
  v_mul_f32 v25, v25, v59
  v_mul_f32 v26, v26, v54
  v_cvt_pk_bf16_f32 v25, v25, v26
  v_lshlrev_b32 v26, 16, v25
  v_and_b32 v25, 0xffff0000, v25
  v_add_f32 v151, v151, v26
  v_add_f32 v151, v151, v25
  v_lshlrev_b32 v25, 16, v45
  v_and_b32 v26, 0xffff0000, v45
  v_mul_f32 v25, v25, v60
  v_mul_f32 v26, v26, v55
  v_cvt_pk_bf16_f32 v25, v25, v26
  v_lshlrev_b32 v26, 16, v25
  v_and_b32 v25, 0xffff0000, v25
  v_add_f32 v151, v151, v26
  v_add_f32 v151, v151, v25
  v_lshlrev_b32 v25, 16, v46
  v_and_b32 v26, 0xffff0000, v46
  v_mul_f32 v25, v25, v61
  v_mul_f32 v26, v26, v56
  v_cvt_pk_bf16_f32 v25, v25, v26
  v_lshlrev_b32 v26, 16, v25
  v_and_b32 v25, 0xffff0000, v25
  v_add_f32 v151, v151, v26
  v_add_f32 v151, v151, v25
  v_add_f32_dpp v144, v144, v144 row_ror:8 row_mask:0xf bank_mask:0xf
  v_add_f32_dpp v145, v145, v145 row_ror:8 row_mask:0xf bank_mask:0xf
  v_add_f32_dpp v146, v146, v146 row_ror:8 row_mask:0xf bank_mask:0xf
  v_add_f32_dpp v147, v147, v147 row_ror:8 row_mask:0xf bank_mask:0xf
  v_add_f32_dpp v148, v148, v148 row_ror:8 row_mask:0xf bank_mask:0xf
  v_add_f32_dpp v149, v149, v149 row_ror:8 row_mask:0xf bank_mask:0xf
  v_add_f32_dpp v150, v150, v150 row_ror:8 row_mask:0xf bank_mask:0xf
  v_add_f32_dpp v151, v151, v151 row_ror:8 row_mask:0xf bank_mask:0xf
  v_add_f32_dpp v144, v144, v144 row_ror:4 row_mask:0xf bank_mask:0xf
  v_add_f32_dpp v145, v145, v145 row_ror:4 row_mask:0xf bank_mask:0xf
  v_add_f32_dpp v146, v146, v146 row_ror:4 row_mask:0xf bank_mask:0xf
  v_add_f32_dpp v147, v147, v147 row_ror:4 row_mask:0xf bank_mask:0xf
  v_add_f32_dpp v148, v148, v148 row_ror:4 row_mask:0xf bank_mask:0xf
  v_add_f32_dpp v149, v149, v149 row_ror:4 row_mask:0xf bank_mask:0xf
  v_add_f32_dpp v150, v150, v150 row_ror:4 row_mask:0xf bank_mask:0xf
  v_add_f32_dpp v151, v151, v151 row_ror:4 row_mask:0xf bank_mask:0xf
  v_add_f32_dpp v144, v144, v144 row_ror:2 row_mask:0xf bank_mask:0xf
  v_add_f32_dpp v145, v145, v145 row_ror:2 row_mask:0xf bank_mask:0xf
  v_add_f32_dpp v146, v146, v146 row_ror:2 row_mask:0xf bank_mask:0xf
  v_add_f32_dpp v147, v147, v147 row_ror:2 row_mask:0xf bank_mask:0xf
  v_add_f32_dpp v148, v148, v148 row_ror:2 row_mask:0xf bank_mask:0xf
  v_add_f32_dpp v149, v149, v149 row_ror:2 row_mask:0xf bank_mask:0xf
  v_add_f32_dpp v150, v150, v150 row_ror:2 row_mask:0xf bank_mask:0xf
  v_add_f32_dpp v151, v151, v151 row_ror:2 row_mask:0xf bank_mask:0xf
  v_add_f32_dpp v144, v144, v144 row_ror:1 row_mask:0xf bank_mask:0xf
  v_add_f32_dpp v145, v145, v145 row_ror:1 row_mask:0xf bank_mask:0xf
  v_add_f32_dpp v146, v146, v146 row_ror:1 row_mask:0xf bank_mask:0xf
  v_add_f32_dpp v147, v147, v147 row_ror:1 row_mask:0xf bank_mask:0xf
  v_add_f32_dpp v148, v148, v148 row_ror:1 row_mask:0xf bank_mask:0xf
  v_add_f32_dpp v149, v149, v149 row_ror:1 row_mask:0xf bank_mask:0xf
  v_add_f32_dpp v150, v150, v150 row_ror:1 row_mask:0xf bank_mask:0xf
  v_add_f32_dpp v151, v151, v151 row_ror:1 row_mask:0xf bank_mask:0xf
  v_mov_b32 v152, v144
  v_mov_b32 v153, v145
  v_mov_b32 v154, v146
  v_mov_b32 v155, v147
  v_mov_b32 v156, v148
  v_mov_b32 v157, v149
  v_mov_b32 v158, v150
  v_mov_b32 v159, v151
  v_permlane32_swap_b32 v144, v152
  v_permlane32_swap_b32 v145, v153
  v_permlane32_swap_b32 v146, v154
  v_permlane32_swap_b32 v147, v155
  v_permlane32_swap_b32 v148, v156
  v_permlane32_swap_b32 v149, v157
  v_permlane32_swap_b32 v150, v158
  v_permlane32_swap_b32 v151, v159
  v_add_f32 v144, v144, v152
  v_add_f32 v145, v145, v153
  v_add_f32 v146, v146, v154
  v_add_f32 v147, v147, v155
  v_add_f32 v148, v148, v156
  v_add_f32 v149, v149, v157
  v_add_f32 v150, v150, v158
  v_add_f32 v151, v151, v159
  v_mov_b32 v152, v144
  v_mov_b32 v153, v145
  v_mov_b32 v154, v146
  v_mov_b32 v155, v147
  v_mov_b32 v156, v148
  v_mov_b32 v157, v149
  v_mov_b32 v158, v150
  v_mov_b32 v159, v151
  v_permlane16_swap_b32 v144, v152
  v_permlane16_swap_b32 v145, v153
  v_permlane16_swap_b32 v146, v154
  v_permlane16_swap_b32 v147, v155
  v_permlane16_swap_b32 v148, v156
  v_permlane16_swap_b32 v149, v157
  v_permlane16_swap_b32 v150, v158
  v_permlane16_swap_b32 v151, v159
  v_add_f32 v144, v144, v152
  v_add_f32 v145, v145, v153
  v_add_f32 v146, v146, v154
  v_add_f32 v147, v147, v155
  v_add_f32 v148, v148, v156
  v_add_f32 v149, v149, v157
  v_add_f32 v150, v150, v158
  v_add_f32 v151, v151, v159
  v_mov_b32 v24, v144
  v_cmp_eq_u32 vcc, 1, v1
  s_nop 1
  v_cndmask_b32 v24, v24, v145, vcc
  v_cmp_eq_u32 vcc, 2, v1
  s_nop 1
  v_cndmask_b32 v24, v24, v146, vcc
  v_cmp_eq_u32 vcc, 3, v1
  s_nop 1
  v_cndmask_b32 v24, v24, v147, vcc
  v_cmp_eq_u32 vcc, 4, v1
  s_nop 1
  v_cndmask_b32 v24, v24, v148, vcc
  v_cmp_eq_u32 vcc, 5, v1
  s_nop 1
  v_cndmask_b32 v24, v24, v149, vcc
  v_cmp_eq_u32 vcc, 6, v1
  s_nop 1
  v_cndmask_b32 v24, v24, v150, vcc
  v_cmp_eq_u32 vcc, 7, v1
  s_nop 1
  v_cndmask_b32 v24, v24, v151, vcc
  v_cvt_pk_bf16_f32 v25, v24, v24
  v_lshlrev_b32 v24, 16, v25
  v_mul_f32 v24, 0xbfb8aa3b, v24
  v_exp_f32 v24, v24
  s_nop 0
  v_add_f32 v24, 1.0, v24
  v_rcp_f32 v24, v24
  s_nop 0
  v_cvt_pk_bf16_f32 v25, v24, v24
  v_lshlrev_b32 v24, 16, v25
  s_lshl_b32 s21, s59, 2
  s_mov_b64 exec, 0xff
  buffer_store_dword v24, v5, s[28:31], s21 offen sc1
  s_mov_b64 exec, -1
  s_sub_u32 s59, s59, 1024
  s_waitcnt vmcnt(1)
  v_lshlrev_b32 v25, 16, v160
  v_and_b32 v26, 0xffff0000, v160
  v_mul_f32 v25, v25, v57
  v_mul_f32 v26, v26, v52
  v_cvt_pk_bf16_f32 v25, v25, v26
  v_lshlrev_b32 v26, 16, v25
  v_and_b32 v25, 0xffff0000, v25
  v_add_f32 v144, v25, v26
  v_lshlrev_b32 v25, 16, v161
  v_and_b32 v26, 0xffff0000, v161
  v_mul_f32 v25, v25, v58
  v_mul_f32 v26, v26, v53
  v_cvt_pk_bf16_f32 v25, v25, v26
  v_lshlrev_b32 v26, 16, v25
  v_and_b32 v25, 0xffff0000, v25
  v_add_f32 v144, v144, v26
  v_add_f32 v144, v144, v25
  v_lshlrev_b32 v25, 16, v162
  v_and_b32 v26, 0xffff0000, v162
  v_mul_f32 v25, v25, v59
  v_mul_f32 v26, v26, v54
  v_cvt_pk_bf16_f32 v25, v25, v26
  v_lshlrev_b32 v26, 16, v25
  v_and_b32 v25, 0xffff0000, v25
  v_add_f32 v144, v144, v26
  v_add_f32 v144, v144, v25
  v_lshlrev_b32 v25, 16, v163
  v_and_b32 v26, 0xffff0000, v163
  v_mul_f32 v25, v25, v60
  v_mul_f32 v26, v26, v55
  v_cvt_pk_bf16_f32 v25, v25, v26
  v_lshlrev_b32 v26, 16, v25
  v_and_b32 v25, 0xffff0000, v25
  v_add_f32 v144, v144, v26
  v_add_f32 v144, v144, v25
  v_lshlrev_b32 v25, 16, v164
  v_and_b32 v26, 0xffff0000, v164
  v_mul_f32 v25, v25, v61
  v_mul_f32 v26, v26, v56
  v_cvt_pk_bf16_f32 v25, v25, v26
  v_lshlrev_b32 v26, 16, v25
  v_and_b32 v25, 0xffff0000, v25
  v_add_f32 v144, v144, v26
  v_add_f32 v144, v144, v25
  v_lshlrev_b32 v25, 16, v166
  v_and_b32 v26, 0xffff0000, v166
  v_mul_f32 v25, v25, v57
  v_mul_f32 v26, v26, v52
  v_cvt_pk_bf16_f32 v25, v25, v26
  v_lshlrev_b32 v26, 16, v25
  v_and_b32 v25, 0xffff0000, v25
  v_add_f32 v145, v25, v26
  v_lshlrev_b32 v25, 16, v167
  v_and_b32 v26, 0xffff0000, v167
  v_mul_f32 v25, v25, v58
  v_mul_f32 v26, v26, v53
  v_cvt_pk_bf16_f32 v25, v25, v26
  v_lshlrev_b32 v26, 16, v25
  v_and_b32 v25, 0xffff0000, v25
  v_add_f32 v145, v145, v26
  v_add_f32 v145, v145, v25
  v_lshlrev_b32 v25, 16, v168
  v_and_b32 v26, 0xffff0000, v168
  v_mul_f32 v25, v25, v59
  v_mul_f32 v26, v26, v54
  v_cvt_pk_bf16_f32 v25, v25, v26
  v_lshlrev_b32 v26, 16, v25
  v_and_b32 v25, 0xffff0000, v25
  v_add_f32 v145, v145, v26
  v_add_f32 v145, v145, v25
  v_lshlrev_b32 v25, 16, v169
  v_and_b32 v26, 0xffff0000, v169
  v_mul_f32 v25, v25, v60
  v_mul_f32 v26, v26, v55
  v_cvt_pk_bf16_f32 v25, v25, v26
  v_lshlrev_b32 v26, 16, v25
  v_and_b32 v25, 0xffff0000, v25
  v_add_f32 v145, v145, v26
  v_add_f32 v145, v145, v25
  v_lshlrev_b32 v25, 16, v170
  v_and_b32 v26, 0xffff0000, v170
  v_mul_f32 v25, v25, v61
  v_mul_f32 v26, v26, v56
  v_cvt_pk_bf16_f32 v25, v25, v26
  v_lshlrev_b32 v26, 16, v25
  v_and_b32 v25, 0xffff0000, v25
  v_add_f32 v145, v145, v26
  v_add_f32 v145, v145, v25
  v_lshlrev_b32 v25, 16, v172
  v_and_b32 v26, 0xffff0000, v172
  v_mul_f32 v25, v25, v57
  v_mul_f32 v26, v26, v52
  v_cvt_pk_bf16_f32 v25, v25, v26
  v_lshlrev_b32 v26, 16, v25
  v_and_b32 v25, 0xffff0000, v25
  v_add_f32 v146, v25, v26
  v_lshlrev_b32 v25, 16, v173
  v_and_b32 v26, 0xffff0000, v173
  v_mul_f32 v25, v25, v58
  v_mul_f32 v26, v26, v53
  v_cvt_pk_bf16_f32 v25, v25, v26
  v_lshlrev_b32 v26, 16, v25
  v_and_b32 v25, 0xffff0000, v25
  v_add_f32 v146, v146, v26
  v_add_f32 v146, v146, v25
  v_lshlrev_b32 v25, 16, v174
  v_and_b32 v26, 0xffff0000, v174
  v_mul_f32 v25, v25, v59
  v_mul_f32 v26, v26, v54
  v_cvt_pk_bf16_f32 v25, v25, v26
  v_lshlrev_b32 v26, 16, v25
  v_and_b32 v25, 0xffff0000, v25
  v_add_f32 v146, v146, v26
  v_add_f32 v146, v146, v25
  v_lshlrev_b32 v25, 16, v175
  v_and_b32 v26, 0xffff0000, v175
  v_mul_f32 v25, v25, v60
  v_mul_f32 v26, v26, v55
  v_cvt_pk_bf16_f32 v25, v25, v26
  v_lshlrev_b32 v26, 16, v25
  v_and_b32 v25, 0xffff0000, v25
  v_add_f32 v146, v146, v26
  v_add_f32 v146, v146, v25
  v_lshlrev_b32 v25, 16, v176
  v_and_b32 v26, 0xffff0000, v176
  v_mul_f32 v25, v25, v61
  v_mul_f32 v26, v26, v56
  v_cvt_pk_bf16_f32 v25, v25, v26
  v_lshlrev_b32 v26, 16, v25
  v_and_b32 v25, 0xffff0000, v25
  v_add_f32 v146, v146, v26
  v_add_f32 v146, v146, v25
  v_lshlrev_b32 v25, 16, v178
  v_and_b32 v26, 0xffff0000, v178
  v_mul_f32 v25, v25, v57
  v_mul_f32 v26, v26, v52
  v_cvt_pk_bf16_f32 v25, v25, v26
  v_lshlrev_b32 v26, 16, v25
  v_and_b32 v25, 0xffff0000, v25
  v_add_f32 v147, v25, v26
  v_lshlrev_b32 v25, 16, v179
  v_and_b32 v26, 0xffff0000, v179
  v_mul_f32 v25, v25, v58
  v_mul_f32 v26, v26, v53
  v_cvt_pk_bf16_f32 v25, v25, v26
  v_lshlrev_b32 v26, 16, v25
  v_and_b32 v25, 0xffff0000, v25
  v_add_f32 v147, v147, v26
  v_add_f32 v147, v147, v25
  v_lshlrev_b32 v25, 16, v180
  v_and_b32 v26, 0xffff0000, v180
  v_mul_f32 v25, v25, v59
  v_mul_f32 v26, v26, v54
  v_cvt_pk_bf16_f32 v25, v25, v26
  v_lshlrev_b32 v26, 16, v25
  v_and_b32 v25, 0xffff0000, v25
  v_add_f32 v147, v147, v26
  v_add_f32 v147, v147, v25
  v_lshlrev_b32 v25, 16, v181
  v_and_b32 v26, 0xffff0000, v181
  v_mul_f32 v25, v25, v60
  v_mul_f32 v26, v26, v55
  v_cvt_pk_bf16_f32 v25, v25, v26
  v_lshlrev_b32 v26, 16, v25
  v_and_b32 v25, 0xffff0000, v25
  v_add_f32 v147, v147, v26
  v_add_f32 v147, v147, v25
  v_lshlrev_b32 v25, 16, v182
  v_and_b32 v26, 0xffff0000, v182
  v_mul_f32 v25, v25, v61
  v_mul_f32 v26, v26, v56
  v_cvt_pk_bf16_f32 v25, v25, v26
  v_lshlrev_b32 v26, 16, v25
  v_and_b32 v25, 0xffff0000, v25
  v_add_f32 v147, v147, v26
  v_add_f32 v147, v147, v25
  v_lshlrev_b32 v25, 16, v184
  v_and_b32 v26, 0xffff0000, v184
  v_mul_f32 v25, v25, v57
  v_mul_f32 v26, v26, v52
  v_cvt_pk_bf16_f32 v25, v25, v26
  v_lshlrev_b32 v26, 16, v25
  v_and_b32 v25, 0xffff0000, v25
  v_add_f32 v148, v25, v26
  v_lshlrev_b32 v25, 16, v185
  v_and_b32 v26, 0xffff0000, v185
  v_mul_f32 v25, v25, v58
  v_mul_f32 v26, v26, v53
  v_cvt_pk_bf16_f32 v25, v25, v26
  v_lshlrev_b32 v26, 16, v25
  v_and_b32 v25, 0xffff0000, v25
  v_add_f32 v148, v148, v26
  v_add_f32 v148, v148, v25
  v_lshlrev_b32 v25, 16, v186
  v_and_b32 v26, 0xffff0000, v186
  v_mul_f32 v25, v25, v59
  v_mul_f32 v26, v26, v54
  v_cvt_pk_bf16_f32 v25, v25, v26
  v_lshlrev_b32 v26, 16, v25
  v_and_b32 v25, 0xffff0000, v25
  v_add_f32 v148, v148, v26
  v_add_f32 v148, v148, v25
  v_lshlrev_b32 v25, 16, v187
  v_and_b32 v26, 0xffff0000, v187
  v_mul_f32 v25, v25, v60
  v_mul_f32 v26, v26, v55
  v_cvt_pk_bf16_f32 v25, v25, v26
  v_lshlrev_b32 v26, 16, v25
  v_and_b32 v25, 0xffff0000, v25
  v_add_f32 v148, v148, v26
  v_add_f32 v148, v148, v25
  v_lshlrev_b32 v25, 16, v188
  v_and_b32 v26, 0xffff0000, v188
  v_mul_f32 v25, v25, v61
  v_mul_f32 v26, v26, v56
  v_cvt_pk_bf16_f32 v25, v25, v26
  v_lshlrev_b32 v26, 16, v25
  v_and_b32 v25, 0xffff0000, v25
  v_add_f32 v148, v148, v26
  v_add_f32 v148, v148, v25
  v_lshlrev_b32 v25, 16, v190
  v_and_b32 v26, 0xffff0000, v190
  v_mul_f32 v25, v25, v57
  v_mul_f32 v26, v26, v52
  v_cvt_pk_bf16_f32 v25, v25, v26
  v_lshlrev_b32 v26, 16, v25
  v_and_b32 v25, 0xffff0000, v25
  v_add_f32 v149, v25, v26
  v_lshlrev_b32 v25, 16, v191
  v_and_b32 v26, 0xffff0000, v191
  v_mul_f32 v25, v25, v58
  v_mul_f32 v26, v26, v53
  v_cvt_pk_bf16_f32 v25, v25, v26
  v_lshlrev_b32 v26, 16, v25
  v_and_b32 v25, 0xffff0000, v25
  v_add_f32 v149, v149, v26
  v_add_f32 v149, v149, v25
  v_lshlrev_b32 v25, 16, v192
  v_and_b32 v26, 0xffff0000, v192
  v_mul_f32 v25, v25, v59
  v_mul_f32 v26, v26, v54
  v_cvt_pk_bf16_f32 v25, v25, v26
  v_lshlrev_b32 v26, 16, v25
  v_and_b32 v25, 0xffff0000, v25
  v_add_f32 v149, v149, v26
  v_add_f32 v149, v149, v25
  v_lshlrev_b32 v25, 16, v193
  v_and_b32 v26, 0xffff0000, v193
  v_mul_f32 v25, v25, v60
  v_mul_f32 v26, v26, v55
  v_cvt_pk_bf16_f32 v25, v25, v26
  v_lshlrev_b32 v26, 16, v25
  v_and_b32 v25, 0xffff0000, v25
  v_add_f32 v149, v149, v26
  v_add_f32 v149, v149, v25
  v_lshlrev_b32 v25, 16, v194
  v_and_b32 v26, 0xffff0000, v194
  v_mul_f32 v25, v25, v61
  v_mul_f32 v26, v26, v56
  v_cvt_pk_bf16_f32 v25, v25, v26
  v_lshlrev_b32 v26, 16, v25
  v_and_b32 v25, 0xffff0000, v25
  v_add_f32 v149, v149, v26
  v_add_f32 v149, v149, v25
  v_lshlrev_b32 v25, 16, v196
  v_and_b32 v26, 0xffff0000, v196
  v_mul_f32 v25, v25, v57
  v_mul_f32 v26, v26, v52
  v_cvt_pk_bf16_f32 v25, v25, v26
  v_lshlrev_b32 v26, 16, v25
  v_and_b32 v25, 0xffff0000, v25
  v_add_f32 v150, v25, v26
  v_lshlrev_b32 v25, 16, v197
  v_and_b32 v26, 0xffff0000, v197
  v_mul_f32 v25, v25, v58
  v_mul_f32 v26, v26, v53
  v_cvt_pk_bf16_f32 v25, v25, v26
  v_lshlrev_b32 v26, 16, v25
  v_and_b32 v25, 0xffff0000, v25
  v_add_f32 v150, v150, v26
  v_add_f32 v150, v150, v25
  v_lshlrev_b32 v25, 16, v198
  v_and_b32 v26, 0xffff0000, v198
  v_mul_f32 v25, v25, v59
  v_mul_f32 v26, v26, v54
  v_cvt_pk_bf16_f32 v25, v25, v26
  v_lshlrev_b32 v26, 16, v25
  v_and_b32 v25, 0xffff0000, v25
  v_add_f32 v150, v150, v26
  v_add_f32 v150, v150, v25
  v_lshlrev_b32 v25, 16, v199
  v_and_b32 v26, 0xffff0000, v199
  v_mul_f32 v25, v25, v60
  v_mul_f32 v26, v26, v55
  v_cvt_pk_bf16_f32 v25, v25, v26
  v_lshlrev_b32 v26, 16, v25
  v_and_b32 v25, 0xffff0000, v25
  v_add_f32 v150, v150, v26
  v_add_f32 v150, v150, v25
  v_lshlrev_b32 v25, 16, v200
  v_and_b32 v26, 0xffff0000, v200
  v_mul_f32 v25, v25, v61
  v_mul_f32 v26, v26, v56
  v_cvt_pk_bf16_f32 v25, v25, v26
  v_lshlrev_b32 v26, 16, v25
  v_and_b32 v25, 0xffff0000, v25
  v_add_f32 v150, v150, v26
  v_add_f32 v150, v150, v25
  v_lshlrev_b32 v25, 16, v202
  v_and_b32 v26, 0xffff0000, v202
  v_mul_f32 v25, v25, v57
  v_mul_f32 v26, v26, v52
  v_cvt_pk_bf16_f32 v25, v25, v26
  v_lshlrev_b32 v26, 16, v25
  v_and_b32 v25, 0xffff0000, v25
  v_add_f32 v151, v25, v26
  v_lshlrev_b32 v25, 16, v203
  v_and_b32 v26, 0xffff0000, v203
  v_mul_f32 v25, v25, v58
  v_mul_f32 v26, v26, v53
  v_cvt_pk_bf16_f32 v25, v25, v26
  v_lshlrev_b32 v26, 16, v25
  v_and_b32 v25, 0xffff0000, v25
  v_add_f32 v151, v151, v26
  v_add_f32 v151, v151, v25
  v_lshlrev_b32 v25, 16, v204
  v_and_b32 v26, 0xffff0000, v204
  v_mul_f32 v25, v25, v59
  v_mul_f32 v26, v26, v54
  v_cvt_pk_bf16_f32 v25, v25, v26
  v_lshlrev_b32 v26, 16, v25
  v_and_b32 v25, 0xffff0000, v25
  v_add_f32 v151, v151, v26
  v_add_f32 v151, v151, v25
  v_lshlrev_b32 v25, 16, v205
  v_and_b32 v26, 0xffff0000, v205
  v_mul_f32 v25, v25, v60
  v_mul_f32 v26, v26, v55
  v_cvt_pk_bf16_f32 v25, v25, v26
  v_lshlrev_b32 v26, 16, v25
  v_and_b32 v25, 0xffff0000, v25
  v_add_f32 v151, v151, v26
  v_add_f32 v151, v151, v25
  v_lshlrev_b32 v25, 16, v206
  v_and_b32 v26, 0xffff0000, v206
  v_mul_f32 v25, v25, v61
  v_mul_f32 v26, v26, v56
  v_cvt_pk_bf16_f32 v25, v25, v26
  v_lshlrev_b32 v26, 16, v25
  v_and_b32 v25, 0xffff0000, v25
  v_add_f32 v151, v151, v26
  v_add_f32 v151, v151, v25
  v_add_f32_dpp v144, v144, v144 row_ror:8 row_mask:0xf bank_mask:0xf
  v_add_f32_dpp v145, v145, v145 row_ror:8 row_mask:0xf bank_mask:0xf
  v_add_f32_dpp v146, v146, v146 row_ror:8 row_mask:0xf bank_mask:0xf
  v_add_f32_dpp v147, v147, v147 row_ror:8 row_mask:0xf bank_mask:0xf
  v_add_f32_dpp v148, v148, v148 row_ror:8 row_mask:0xf bank_mask:0xf
  v_add_f32_dpp v149, v149, v149 row_ror:8 row_mask:0xf bank_mask:0xf
  v_add_f32_dpp v150, v150, v150 row_ror:8 row_mask:0xf bank_mask:0xf
  v_add_f32_dpp v151, v151, v151 row_ror:8 row_mask:0xf bank_mask:0xf
  v_add_f32_dpp v144, v144, v144 row_ror:4 row_mask:0xf bank_mask:0xf
  v_add_f32_dpp v145, v145, v145 row_ror:4 row_mask:0xf bank_mask:0xf
  v_add_f32_dpp v146, v146, v146 row_ror:4 row_mask:0xf bank_mask:0xf
  v_add_f32_dpp v147, v147, v147 row_ror:4 row_mask:0xf bank_mask:0xf
  v_add_f32_dpp v148, v148, v148 row_ror:4 row_mask:0xf bank_mask:0xf
  v_add_f32_dpp v149, v149, v149 row_ror:4 row_mask:0xf bank_mask:0xf
  v_add_f32_dpp v150, v150, v150 row_ror:4 row_mask:0xf bank_mask:0xf
  v_add_f32_dpp v151, v151, v151 row_ror:4 row_mask:0xf bank_mask:0xf
  v_add_f32_dpp v144, v144, v144 row_ror:2 row_mask:0xf bank_mask:0xf
  v_add_f32_dpp v145, v145, v145 row_ror:2 row_mask:0xf bank_mask:0xf
  v_add_f32_dpp v146, v146, v146 row_ror:2 row_mask:0xf bank_mask:0xf
  v_add_f32_dpp v147, v147, v147 row_ror:2 row_mask:0xf bank_mask:0xf
  v_add_f32_dpp v148, v148, v148 row_ror:2 row_mask:0xf bank_mask:0xf
  v_add_f32_dpp v149, v149, v149 row_ror:2 row_mask:0xf bank_mask:0xf
  v_add_f32_dpp v150, v150, v150 row_ror:2 row_mask:0xf bank_mask:0xf
  v_add_f32_dpp v151, v151, v151 row_ror:2 row_mask:0xf bank_mask:0xf
  v_add_f32_dpp v144, v144, v144 row_ror:1 row_mask:0xf bank_mask:0xf
  v_add_f32_dpp v145, v145, v145 row_ror:1 row_mask:0xf bank_mask:0xf
  v_add_f32_dpp v146, v146, v146 row_ror:1 row_mask:0xf bank_mask:0xf
  v_add_f32_dpp v147, v147, v147 row_ror:1 row_mask:0xf bank_mask:0xf
  v_add_f32_dpp v148, v148, v148 row_ror:1 row_mask:0xf bank_mask:0xf
  v_add_f32_dpp v149, v149, v149 row_ror:1 row_mask:0xf bank_mask:0xf
  v_add_f32_dpp v150, v150, v150 row_ror:1 row_mask:0xf bank_mask:0xf
  v_add_f32_dpp v151, v151, v151 row_ror:1 row_mask:0xf bank_mask:0xf
  v_mov_b32 v152, v144
  v_mov_b32 v153, v145
  v_mov_b32 v154, v146
  v_mov_b32 v155, v147
  v_mov_b32 v156, v148
  v_mov_b32 v157, v149
  v_mov_b32 v158, v150
  v_mov_b32 v159, v151
  v_permlane32_swap_b32 v144, v152
  v_permlane32_swap_b32 v145, v153
  v_permlane32_swap_b32 v146, v154
  v_permlane32_swap_b32 v147, v155
  v_permlane32_swap_b32 v148, v156
  v_permlane32_swap_b32 v149, v157
  v_permlane32_swap_b32 v150, v158
  v_permlane32_swap_b32 v151, v159
  v_add_f32 v144, v144, v152
  v_add_f32 v145, v145, v153
  v_add_f32 v146, v146, v154
  v_add_f32 v147, v147, v155
  v_add_f32 v148, v148, v156
  v_add_f32 v149, v149, v157
  v_add_f32 v150, v150, v158
  v_add_f32 v151, v151, v159
  v_mov_b32 v152, v144
  v_mov_b32 v153, v145
  v_mov_b32 v154, v146
  v_mov_b32 v155, v147
  v_mov_b32 v156, v148
  v_mov_b32 v157, v149
  v_mov_b32 v158, v150
  v_mov_b32 v159, v151
  v_permlane16_swap_b32 v144, v152
  v_permlane16_swap_b32 v145, v153
  v_permlane16_swap_b32 v146, v154
  v_permlane16_swap_b32 v147, v155
  v_permlane16_swap_b32 v148, v156
  v_permlane16_swap_b32 v149, v157
  v_permlane16_swap_b32 v150, v158
  v_permlane16_swap_b32 v151, v159
  v_add_f32 v144, v144, v152
  v_add_f32 v145, v145, v153
  v_add_f32 v146, v146, v154
  v_add_f32 v147, v147, v155
  v_add_f32 v148, v148, v156
  v_add_f32 v149, v149, v157
  v_add_f32 v150, v150, v158
  v_add_f32 v151, v151, v159
  v_mov_b32 v24, v144
  v_cmp_eq_u32 vcc, 1, v1
  s_nop 1
  v_cndmask_b32 v24, v24, v145, vcc
  v_cmp_eq_u32 vcc, 2, v1
  s_nop 1
  v_cndmask_b32 v24, v24, v146, vcc
  v_cmp_eq_u32 vcc, 3, v1
  s_nop 1
  v_cndmask_b32 v24, v24, v147, vcc
  v_cmp_eq_u32 vcc, 4, v1
  s_nop 1
  v_cndmask_b32 v24, v24, v148, vcc
  v_cmp_eq_u32 vcc, 5, v1
  s_nop 1
  v_cndmask_b32 v24, v24, v149, vcc
  v_cmp_eq_u32 vcc, 6, v1
  s_nop 1
  v_cndmask_b32 v24, v24, v150, vcc
  v_cmp_eq_u32 vcc, 7, v1
  s_nop 1
  v_cndmask_b32 v24, v24, v151, vcc
  v_cvt_pk_bf16_f32 v25, v24, v24
  v_lshlrev_b32 v24, 16, v25
  v_mul_f32 v24, 0xbfb8aa3b, v24
  v_exp_f32 v24, v24
  s_nop 0
  v_add_f32 v24, 1.0, v24
  v_rcp_f32 v24, v24
  s_nop 0
  v_cvt_pk_bf16_f32 v25, v24, v24
  v_lshlrev_b32 v24, 16, v25
  s_lshl_b32 s21, s59, 2
  s_mov_b64 exec, 0xff
  buffer_store_dword v24, v5, s[28:31], s21 offen sc1
  s_mov_b64 exec, -1
  s_waitcnt vmcnt(0)
  s_barrier
  s_lshr_b32 s21, s2, 2
  s_lshl_b32 s21, s21, 7
  s_add_u32 s21, s21, 93184
  s_cmp_lg_u32 s20, 0
  s_cbranch_scc1 af_249
  v_mov_b32 v10, 0
  v_mov_b32 v11, 1
  s_mov_b64 exec, 1
  buffer_atomic_add v11, v10, s[72:75], s21 offen sc1
  s_mov_b64 exec, -1
  s_nop 1
af_249:
  s_branch om_248
om_247:
  s_load_dwordx2 s[8:9], s[0:1], 88
  s_mov_b32 s51, s21
  s_lshr_b32 s52, s2, 2
  s_lshl_b32 s52, s52, 7
  s_add_u32 s21, s52, 94208
  s_cmp_lg_u32 s20, 0
  s_cbranch_scc1 wf_251
  v_mov_b32 v20, 0
  s_mov_b32 s101, 0
wf_250:
  buffer_load_dword v21, v20, s[72:75], s21 offen sc1
  s_add_u32 s101, s101, 1
  s_cmp_gt_u32 s101, 131072
  s_cbranch_scc1 main_end
  s_waitcnt vmcnt(0)
  v_readfirstlane_b32 s100, v21
  s_cmp_ge_u32 s100, 4
  s_cbranch_scc1 wf_251
  s_sleep 32
  s_branch wf_250
wf_251:
  s_barrier
  s_add_u32 s21, s52, 104448
  s_cmp_lg_u32 s20, 0
  s_cbranch_scc1 wf_253
  v_mov_b32 v20, 0
  s_mov_b32 s101, 0
wf_252:
  buffer_load_dword v21, v20, s[72:75], s21 offen sc1
  s_add_u32 s101, s101, 1
  s_cmp_gt_u32 s101, 131072
  s_cbranch_scc1 main_end
  s_waitcnt vmcnt(0)
  v_readfirstlane_b32 s100, v21
  s_cmp_ge_u32 s100, 80
  s_cbranch_scc1 wf_253
  s_sleep 32
  s_branch wf_252
wf_253:
  s_barrier
  v_lshlrev_b32 v6, 2, v2
  s_lshl_b32 s22, s47, 6
  buffer_load_dword v30, v6, s[28:31], s22 offen sc1
  buffer_load_dword v31, v6, s[28:31], s22 offen offset:64 sc1
  s_add_u32 s22, s51, 0
  buffer_load_dwordx4 v[144:147], v4, s[16:19], s22 offen offset:0 sc1
  buffer_load_dwordx4 v[148:151], v4, s[16:19], s22 offen offset:1024 sc1
  buffer_load_dwordx4 v[152:155], v4, s[16:19], s22 offen offset:2048 sc1
  buffer_load_dwordx4 v[156:159], v4, s[16:19], s22 offen offset:3072 sc1
  s_add_u32 s22, s51, 4096
  buffer_load_dwordx4 v[160:163], v4, s[16:19], s22 offen offset:0 sc1
  buffer_load_dwordx4 v[164:167], v4, s[16:19], s22 offen offset:1024 sc1
  buffer_load_dwordx4 v[168:171], v4, s[16:19], s22 offen offset:2048 sc1
  buffer_load_dwordx4 v[172:175], v4, s[16:19], s22 offen offset:3072 sc1
  s_add_u32 s22, s51, 8192
  buffer_load_dwordx4 v[176:179], v4, s[16:19], s22 offen offset:0 sc1
  buffer_load_dwordx4 v[180:183], v4, s[16:19], s22 offen offset:1024 sc1
  s_add_u32 s22, s51, 40960
  buffer_load_dwordx4 v[184:187], v4, s[16:19], s22 offen offset:0 sc1
  buffer_load_dwordx4 v[188:191], v4, s[16:19], s22 offen offset:1024 sc1
  buffer_load_dwordx4 v[192:195], v4, s[16:19], s22 offen offset:2048 sc1
  buffer_load_dwordx4 v[196:199], v4, s[16:19], s22 offen offset:3072 sc1
  s_add_u32 s22, s51, 45056
  buffer_load_dwordx4 v[200:203], v4, s[16:19], s22 offen offset:0 sc1
  buffer_load_dwordx4 v[204:207], v4, s[16:19], s22 offen offset:1024 sc1
  buffer_load_dwordx4 v[208:211], v4, s[16:19], s22 offen offset:2048 sc1
  buffer_load_dwordx4 v[212:215], v4, s[16:19], s22 offen offset:3072 sc1
  s_add_u32 s22, s51, 49152
  buffer_load_dwordx4 v[216:219], v4, s[16:19], s22 offen offset:0 sc1
  buffer_load_dwordx4 v[220:223], v4, s[16:19], s22 offen offset:1024 sc1
  v_mul_u32_u24 v9, 1280, v2
  v_lshl_add_u32 v9, v3, 3, v9
  s_mul_i32 s22, s47, 20480
  s_add_u32 s22, s22, s45
  s_add_u32 s23, s22, 20480
  s_waitcnt vmcnt(20) lgkmcnt(0)
  v_sub_f32 v32, 1.0, v30
  v_sub_f32 v33, 1.0, v31
  v_cvt_pk_bf16_f32 v26, v32, v33
  v_lshlrev_b32 v32, 16, v26
  v_and_b32 v33, 0xffff0000, v26
  v_cvt_pk_bf16_f32 v26, v64, v65
  v_lshlrev_b32 v64, 16, v26
  v_and_b32 v65, 0xffff0000, v26
  v_mul_f32 v64, v64, v32
  v_mul_f32 v65, v65, v32
  v_cvt_pk_bf16_f32 v26, v64, v65
  v_lshlrev_b32 v64, 16, v26
  v_and_b32 v65, 0xffff0000, v26
  v_cvt_pk_bf16_f32 v26, v66, v67
  v_lshlrev_b32 v66, 16, v26
  v_and_b32 v67, 0xffff0000, v26
  v_mul_f32 v66, v66, v32
  v_mul_f32 v67, v67, v32
  v_cvt_pk_bf16_f32 v26, v66, v67
  v_lshlrev_b32 v66, 16, v26
  v_and_b32 v67, 0xffff0000, v26
  v_cvt_pk_bf16_f32 v26, v68, v69
  v_lshlrev_b32 v68, 16, v26
  v_and_b32 v69, 0xffff0000, v26
  v_mul_f32 v68, v68, v32
  v_mul_f32 v69, v69, v32
  v_cvt_pk_bf16_f32 v26, v68, v69
  v_lshlrev_b32 v68, 16, v26
  v_and_b32 v69, 0xffff0000, v26
  v_cvt_pk_bf16_f32 v26, v70, v71
  v_lshlrev_b32 v70, 16, v26
  v_and_b32 v71, 0xffff0000, v26
  v_mul_f32 v70, v70, v32
  v_mul_f32 v71, v71, v32
  v_cvt_pk_bf16_f32 v26, v70, v71
  v_lshlrev_b32 v70, 16, v26
  v_and_b32 v71, 0xffff0000, v26
  v_cvt_pk_bf16_f32 v26, v72, v73
  v_lshlrev_b32 v72, 16, v26
  v_and_b32 v73, 0xffff0000, v26
  v_mul_f32 v72, v72, v32
  v_mul_f32 v73, v73, v32
  v_cvt_pk_bf16_f32 v26, v72, v73
  v_lshlrev_b32 v72, 16, v26
  v_and_b32 v73, 0xffff0000, v26
  v_cvt_pk_bf16_f32 v26, v74, v75
  v_lshlrev_b32 v74, 16, v26
  v_and_b32 v75, 0xffff0000, v26
  v_mul_f32 v74, v74, v32
  v_mul_f32 v75, v75, v32
  v_cvt_pk_bf16_f32 v26, v74, v75
  v_lshlrev_b32 v74, 16, v26
  v_and_b32 v75, 0xffff0000, v26
  v_cvt_pk_bf16_f32 v26, v76, v77
  v_lshlrev_b32 v76, 16, v26
  v_and_b32 v77, 0xffff0000, v26
  v_mul_f32 v76, v76, v32
  v_mul_f32 v77, v77, v32
  v_cvt_pk_bf16_f32 v26, v76, v77
  v_lshlrev_b32 v76, 16, v26
  v_and_b32 v77, 0xffff0000, v26
  v_cvt_pk_bf16_f32 v26, v78, v79
  v_lshlrev_b32 v78, 16, v26
  v_and_b32 v79, 0xffff0000, v26
  v_mul_f32 v78, v78, v32
  v_mul_f32 v79, v79, v32
  v_cvt_pk_bf16_f32 v26, v78, v79
  v_lshlrev_b32 v78, 16, v26
  v_and_b32 v79, 0xffff0000, v26
  v_cvt_pk_bf16_f32 v26, v80, v81
  v_lshlrev_b32 v80, 16, v26
  v_and_b32 v81, 0xffff0000, v26
  v_mul_f32 v80, v80, v32
  v_mul_f32 v81, v81, v32
  v_cvt_pk_bf16_f32 v26, v80, v81
  v_lshlrev_b32 v80, 16, v26
  v_and_b32 v81, 0xffff0000, v26
  v_cvt_pk_bf16_f32 v26, v82, v83
  v_lshlrev_b32 v82, 16, v26
  v_and_b32 v83, 0xffff0000, v26
  v_mul_f32 v82, v82, v32
  v_mul_f32 v83, v83, v32
  v_cvt_pk_bf16_f32 v26, v82, v83
  v_lshlrev_b32 v82, 16, v26
  v_and_b32 v83, 0xffff0000, v26
  v_cvt_pk_bf16_f32 v26, v84, v85
  v_lshlrev_b32 v84, 16, v26
  v_and_b32 v85, 0xffff0000, v26
  v_mul_f32 v84, v84, v32
  v_mul_f32 v85, v85, v32
  v_cvt_pk_bf16_f32 v26, v84, v85
  v_lshlrev_b32 v84, 16, v26
  v_and_b32 v85, 0xffff0000, v26
  v_cvt_pk_bf16_f32 v26, v86, v87
  v_lshlrev_b32 v86, 16, v26
  v_and_b32 v87, 0xffff0000, v26
  v_mul_f32 v86, v86, v32
  v_mul_f32 v87, v87, v32
  v_cvt_pk_bf16_f32 v26, v86, v87
  v_lshlrev_b32 v86, 16, v26
  v_and_b32 v87, 0xffff0000, v26
  v_cvt_pk_bf16_f32 v26, v88, v89
  v_lshlrev_b32 v88, 16, v26
  v_and_b32 v89, 0xffff0000, v26
  v_mul_f32 v88, v88, v32
  v_mul_f32 v89, v89, v32
  v_cvt_pk_bf16_f32 v26, v88, v89
  v_lshlrev_b32 v88, 16, v26
  v_and_b32 v89, 0xffff0000, v26
  v_cvt_pk_bf16_f32 v26, v90, v91
  v_lshlrev_b32 v90, 16, v26
  v_and_b32 v91, 0xffff0000, v26
  v_mul_f32 v90, v90, v32
  v_mul_f32 v91, v91, v32
  v_cvt_pk_bf16_f32 v26, v90, v91
  v_lshlrev_b32 v90, 16, v26
  v_and_b32 v91, 0xffff0000, v26
  v_cvt_pk_bf16_f32 v26, v92, v93
  v_lshlrev_b32 v92, 16, v26
  v_and_b32 v93, 0xffff0000, v26
  v_mul_f32 v92, v92, v32
  v_mul_f32 v93, v93, v32
  v_cvt_pk_bf16_f32 v26, v92, v93
  v_lshlrev_b32 v92, 16, v26
  v_and_b32 v93, 0xffff0000, v26
  v_cvt_pk_bf16_f32 v26, v94, v95
  v_lshlrev_b32 v94, 16, v26
  v_and_b32 v95, 0xffff0000, v26
  v_mul_f32 v94, v94, v32
  v_mul_f32 v95, v95, v32
  v_cvt_pk_bf16_f32 v26, v94, v95
  v_lshlrev_b32 v94, 16, v26
  v_and_b32 v95, 0xffff0000, v26
  v_cvt_pk_bf16_f32 v26, v96, v97
  v_lshlrev_b32 v96, 16, v26
  v_and_b32 v97, 0xffff0000, v26
  v_mul_f32 v96, v96, v32
  v_mul_f32 v97, v97, v32
  v_cvt_pk_bf16_f32 v26, v96, v97
  v_lshlrev_b32 v96, 16, v26
  v_and_b32 v97, 0xffff0000, v26
  v_cvt_pk_bf16_f32 v26, v98, v99
  v_lshlrev_b32 v98, 16, v26
  v_and_b32 v99, 0xffff0000, v26
  v_mul_f32 v98, v98, v32
  v_mul_f32 v99, v99, v32
  v_cvt_pk_bf16_f32 v26, v98, v99
  v_lshlrev_b32 v98, 16, v26
  v_and_b32 v99, 0xffff0000, v26
  v_cvt_pk_bf16_f32 v26, v100, v101
  v_lshlrev_b32 v100, 16, v26
  v_and_b32 v101, 0xffff0000, v26
  v_mul_f32 v100, v100, v32
  v_mul_f32 v101, v101, v32
  v_cvt_pk_bf16_f32 v26, v100, v101
  v_lshlrev_b32 v100, 16, v26
  v_and_b32 v101, 0xffff0000, v26
  v_cvt_pk_bf16_f32 v26, v102, v103
  v_lshlrev_b32 v102, 16, v26
  v_and_b32 v103, 0xffff0000, v26
  v_mul_f32 v102, v102, v32
  v_mul_f32 v103, v103, v32
  v_cvt_pk_bf16_f32 v26, v102, v103
  v_lshlrev_b32 v102, 16, v26
  v_and_b32 v103, 0xffff0000, v26
  v_cvt_pk_bf16_f32 v26, v104, v105
  v_lshlrev_b32 v104, 16, v26
  v_and_b32 v105, 0xffff0000, v26
  v_mul_f32 v104, v104, v33
  v_mul_f32 v105, v105, v33
  v_cvt_pk_bf16_f32 v26, v104, v105
  v_lshlrev_b32 v104, 16, v26
  v_and_b32 v105, 0xffff0000, v26
  v_cvt_pk_bf16_f32 v26, v106, v107
  v_lshlrev_b32 v106, 16, v26
  v_and_b32 v107, 0xffff0000, v26
  v_mul_f32 v106, v106, v33
  v_mul_f32 v107, v107, v33
  v_cvt_pk_bf16_f32 v26, v106, v107
  v_lshlrev_b32 v106, 16, v26
  v_and_b32 v107, 0xffff0000, v26
  v_cvt_pk_bf16_f32 v26, v108, v109
  v_lshlrev_b32 v108, 16, v26
  v_and_b32 v109, 0xffff0000, v26
  v_mul_f32 v108, v108, v33
  v_mul_f32 v109, v109, v33
  v_cvt_pk_bf16_f32 v26, v108, v109
  v_lshlrev_b32 v108, 16, v26
  v_and_b32 v109, 0xffff0000, v26
  v_cvt_pk_bf16_f32 v26, v110, v111
  v_lshlrev_b32 v110, 16, v26
  v_and_b32 v111, 0xffff0000, v26
  v_mul_f32 v110, v110, v33
  v_mul_f32 v111, v111, v33
  v_cvt_pk_bf16_f32 v26, v110, v111
  v_lshlrev_b32 v110, 16, v26
  v_and_b32 v111, 0xffff0000, v26
  v_cvt_pk_bf16_f32 v26, v112, v113
  v_lshlrev_b32 v112, 16, v26
  v_and_b32 v113, 0xffff0000, v26
  v_mul_f32 v112, v112, v33
  v_mul_f32 v113, v113, v33
  v_cvt_pk_bf16_f32 v26, v112, v113
  v_lshlrev_b32 v112, 16, v26
  v_and_b32 v113, 0xffff0000, v26
  v_cvt_pk_bf16_f32 v26, v114, v115
  v_lshlrev_b32 v114, 16, v26
  v_and_b32 v115, 0xffff0000, v26
  v_mul_f32 v114, v114, v33
  v_mul_f32 v115, v115, v33
  v_cvt_pk_bf16_f32 v26, v114, v115
  v_lshlrev_b32 v114, 16, v26
  v_and_b32 v115, 0xffff0000, v26
  v_cvt_pk_bf16_f32 v26, v116, v117
  v_lshlrev_b32 v116, 16, v26
  v_and_b32 v117, 0xffff0000, v26
  v_mul_f32 v116, v116, v33
  v_mul_f32 v117, v117, v33
  v_cvt_pk_bf16_f32 v26, v116, v117
  v_lshlrev_b32 v116, 16, v26
  v_and_b32 v117, 0xffff0000, v26
  v_cvt_pk_bf16_f32 v26, v118, v119
  v_lshlrev_b32 v118, 16, v26
  v_and_b32 v119, 0xffff0000, v26
  v_mul_f32 v118, v118, v33
  v_mul_f32 v119, v119, v33
  v_cvt_pk_bf16_f32 v26, v118, v119
  v_lshlrev_b32 v118, 16, v26
  v_and_b32 v119, 0xffff0000, v26
  v_cvt_pk_bf16_f32 v26, v120, v121
  v_lshlrev_b32 v120, 16, v26
  v_and_b32 v121, 0xffff0000, v26
  v_mul_f32 v120, v120, v33
  v_mul_f32 v121, v121, v33
  v_cvt_pk_bf16_f32 v26, v120, v121
  v_lshlrev_b32 v120, 16, v26
  v_and_b32 v121, 0xffff0000, v26
  v_cvt_pk_bf16_f32 v26, v122, v123
  v_lshlrev_b32 v122, 16, v26
  v_and_b32 v123, 0xffff0000, v26
  v_mul_f32 v122, v122, v33
  v_mul_f32 v123, v123, v33
  v_cvt_pk_bf16_f32 v26, v122, v123
  v_lshlrev_b32 v122, 16, v26
  v_and_b32 v123, 0xffff0000, v26
  v_cvt_pk_bf16_f32 v26, v124, v125
  v_lshlrev_b32 v124, 16, v26
  v_and_b32 v125, 0xffff0000, v26
  v_mul_f32 v124, v124, v33
  v_mul_f32 v125, v125, v33
  v_cvt_pk_bf16_f32 v26, v124, v125
  v_lshlrev_b32 v124, 16, v26
  v_and_b32 v125, 0xffff0000, v26
  v_cvt_pk_bf16_f32 v26, v126, v127
  v_lshlrev_b32 v126, 16, v26
  v_and_b32 v127, 0xffff0000, v26
  v_mul_f32 v126, v126, v33
  v_mul_f32 v127, v127, v33
  v_cvt_pk_bf16_f32 v26, v126, v127
  v_lshlrev_b32 v126, 16, v26
  v_and_b32 v127, 0xffff0000, v26
  v_cvt_pk_bf16_f32 v26, v128, v129
  v_lshlrev_b32 v128, 16, v26
  v_and_b32 v129, 0xffff0000, v26
  v_mul_f32 v128, v128, v33
  v_mul_f32 v129, v129, v33
  v_cvt_pk_bf16_f32 v26, v128, v129
  v_lshlrev_b32 v128, 16, v26
  v_and_b32 v129, 0xffff0000, v26
  v_cvt_pk_bf16_f32 v26, v130, v131
  v_lshlrev_b32 v130, 16, v26
  v_and_b32 v131, 0xffff0000, v26
  v_mul_f32 v130, v130, v33
  v_mul_f32 v131, v131, v33
  v_cvt_pk_bf16_f32 v26, v130, v131
  v_lshlrev_b32 v130, 16, v26
  v_and_b32 v131, 0xffff0000, v26
  v_cvt_pk_bf16_f32 v26, v132, v133
  v_lshlrev_b32 v132, 16, v26
  v_and_b32 v133, 0xffff0000, v26
  v_mul_f32 v132, v132, v33
  v_mul_f32 v133, v133, v33
  v_cvt_pk_bf16_f32 v26, v132, v133
  v_lshlrev_b32 v132, 16, v26
  v_and_b32 v133, 0xffff0000, v26
  v_cvt_pk_bf16_f32 v26, v134, v135
  v_lshlrev_b32 v134, 16, v26
  v_and_b32 v135, 0xffff0000, v26
  v_mul_f32 v134, v134, v33
  v_mul_f32 v135, v135, v33
  v_cvt_pk_bf16_f32 v26, v134, v135
  v_lshlrev_b32 v134, 16, v26
  v_and_b32 v135, 0xffff0000, v26
  v_cvt_pk_bf16_f32 v26, v136, v137
  v_lshlrev_b32 v136, 16, v26
  v_and_b32 v137, 0xffff0000, v26
  v_mul_f32 v136, v136, v33
  v_mul_f32 v137, v137, v33
  v_cvt_pk_bf16_f32 v26, v136, v137
  v_lshlrev_b32 v136, 16, v26
  v_and_b32 v137, 0xffff0000, v26
  v_cvt_pk_bf16_f32 v26, v138, v139
  v_lshlrev_b32 v138, 16, v26
  v_and_b32 v139, 0xffff0000, v26
  v_mul_f32 v138, v138, v33
  v_mul_f32 v139, v139, v33
  v_cvt_pk_bf16_f32 v26, v138, v139
  v_lshlrev_b32 v138, 16, v26
  v_and_b32 v139, 0xffff0000, v26
  v_cvt_pk_bf16_f32 v26, v140, v141
  v_lshlrev_b32 v140, 16, v26
  v_and_b32 v141, 0xffff0000, v26
  v_mul_f32 v140, v140, v33
  v_mul_f32 v141, v141, v33
  v_cvt_pk_bf16_f32 v26, v140, v141
  v_lshlrev_b32 v140, 16, v26
  v_and_b32 v141, 0xffff0000, v26
  v_cvt_pk_bf16_f32 v26, v142, v143
  v_lshlrev_b32 v142, 16, v26
  v_and_b32 v143, 0xffff0000, v26
  v_mul_f32 v142, v142, v33
  v_mul_f32 v143, v143, v33
  v_cvt_pk_bf16_f32 v26, v142, v143
  v_lshlrev_b32 v142, 16, v26
  v_and_b32 v143, 0xffff0000, v26
  s_waitcnt vmcnt(19)
  v_cvt_pk_bf16_f32 v26, v144, v145
  v_lshlrev_b32 v144, 16, v26
  v_and_b32 v145, 0xffff0000, v26
  v_mul_f32 v144, v144, v30
  v_mul_f32 v145, v145, v30
  v_cvt_pk_bf16_f32 v26, v144, v145
  v_lshlrev_b32 v144, 16, v26
  v_and_b32 v145, 0xffff0000, v26
  v_add_f32 v144, v144, v64
  v_add_f32 v145, v145, v65
  v_cvt_pk_bf16_f32 v64, v144, v145
  v_cvt_pk_bf16_f32 v26, v146, v147
  v_lshlrev_b32 v146, 16, v26
  v_and_b32 v147, 0xffff0000, v26
  v_mul_f32 v146, v146, v30
  v_mul_f32 v147, v147, v30
  v_cvt_pk_bf16_f32 v26, v146, v147
  v_lshlrev_b32 v146, 16, v26
  v_and_b32 v147, 0xffff0000, v26
  v_add_f32 v146, v146, v66
  v_add_f32 v147, v147, v67
  v_cvt_pk_bf16_f32 v65, v146, v147
  buffer_store_dwordx2 v[64:65], v9, s[8:11], s22 offen offset:0
  s_waitcnt vmcnt(19)
  v_cvt_pk_bf16_f32 v26, v148, v149
  v_lshlrev_b32 v148, 16, v26
  v_and_b32 v149, 0xffff0000, v26
  v_mul_f32 v148, v148, v30
  v_mul_f32 v149, v149, v30
  v_cvt_pk_bf16_f32 v26, v148, v149
  v_lshlrev_b32 v148, 16, v26
  v_and_b32 v149, 0xffff0000, v26
  v_add_f32 v148, v148, v68
  v_add_f32 v149, v149, v69
  v_cvt_pk_bf16_f32 v68, v148, v149
  v_cvt_pk_bf16_f32 v26, v150, v151
  v_lshlrev_b32 v150, 16, v26
  v_and_b32 v151, 0xffff0000, v26
  v_mul_f32 v150, v150, v30
  v_mul_f32 v151, v151, v30
  v_cvt_pk_bf16_f32 v26, v150, v151
  v_lshlrev_b32 v150, 16, v26
  v_and_b32 v151, 0xffff0000, v26
  v_add_f32 v150, v150, v70
  v_add_f32 v151, v151, v71
  v_cvt_pk_bf16_f32 v69, v150, v151
  buffer_store_dwordx2 v[68:69], v9, s[8:11], s22 offen offset:32
  s_waitcnt vmcnt(19)
  v_cvt_pk_bf16_f32 v26, v152, v153
  v_lshlrev_b32 v152, 16, v26
  v_and_b32 v153, 0xffff0000, v26
  v_mul_f32 v152, v152, v30
  v_mul_f32 v153, v153, v30
  v_cvt_pk_bf16_f32 v26, v152, v153
  v_lshlrev_b32 v152, 16, v26
  v_and_b32 v153, 0xffff0000, v26
  v_add_f32 v152, v152, v72
  v_add_f32 v153, v153, v73
  v_cvt_pk_bf16_f32 v72, v152, v153
  v_cvt_pk_bf16_f32 v26, v154, v155
  v_lshlrev_b32 v154, 16, v26
  v_and_b32 v155, 0xffff0000, v26
  v_mul_f32 v154, v154, v30
  v_mul_f32 v155, v155, v30
  v_cvt_pk_bf16_f32 v26, v154, v155
  v_lshlrev_b32 v154, 16, v26
  v_and_b32 v155, 0xffff0000, v26
  v_add_f32 v154, v154, v74
  v_add_f32 v155, v155, v75
  v_cvt_pk_bf16_f32 v73, v154, v155
  buffer_store_dwordx2 v[72:73], v9, s[8:11], s22 offen offset:64
  s_waitcnt vmcnt(19)
  v_cvt_pk_bf16_f32 v26, v156, v157
  v_lshlrev_b32 v156, 16, v26
  v_and_b32 v157, 0xffff0000, v26
  v_mul_f32 v156, v156, v30
  v_mul_f32 v157, v157, v30
  v_cvt_pk_bf16_f32 v26, v156, v157
  v_lshlrev_b32 v156, 16, v26
  v_and_b32 v157, 0xffff0000, v26
  v_add_f32 v156, v156, v76
  v_add_f32 v157, v157, v77
  v_cvt_pk_bf16_f32 v76, v156, v157
  v_cvt_pk_bf16_f32 v26, v158, v159
  v_lshlrev_b32 v158, 16, v26
  v_and_b32 v159, 0xffff0000, v26
  v_mul_f32 v158, v158, v30
  v_mul_f32 v159, v159, v30
  v_cvt_pk_bf16_f32 v26, v158, v159
  v_lshlrev_b32 v158, 16, v26
  v_and_b32 v159, 0xffff0000, v26
  v_add_f32 v158, v158, v78
  v_add_f32 v159, v159, v79
  v_cvt_pk_bf16_f32 v77, v158, v159
  buffer_store_dwordx2 v[76:77], v9, s[8:11], s22 offen offset:96
  s_waitcnt vmcnt(19)
  v_cvt_pk_bf16_f32 v26, v160, v161
  v_lshlrev_b32 v160, 16, v26
  v_and_b32 v161, 0xffff0000, v26
  v_mul_f32 v160, v160, v30
  v_mul_f32 v161, v161, v30
  v_cvt_pk_bf16_f32 v26, v160, v161
  v_lshlrev_b32 v160, 16, v26
  v_and_b32 v161, 0xffff0000, v26
  v_add_f32 v160, v160, v80
  v_add_f32 v161, v161, v81
  v_cvt_pk_bf16_f32 v80, v160, v161
  v_cvt_pk_bf16_f32 v26, v162, v163
  v_lshlrev_b32 v162, 16, v26
  v_and_b32 v163, 0xffff0000, v26
  v_mul_f32 v162, v162, v30
  v_mul_f32 v163, v163, v30
  v_cvt_pk_bf16_f32 v26, v162, v163
  v_lshlrev_b32 v162, 16, v26
  v_and_b32 v163, 0xffff0000, v26
  v_add_f32 v162, v162, v82
  v_add_f32 v163, v163, v83
  v_cvt_pk_bf16_f32 v81, v162, v163
  buffer_store_dwordx2 v[80:81], v9, s[8:11], s22 offen offset:128
  s_waitcnt vmcnt(19)
  v_cvt_pk_bf16_f32 v26, v164, v165
  v_lshlrev_b32 v164, 16, v26
  v_and_b32 v165, 0xffff0000, v26
  v_mul_f32 v164, v164, v30
  v_mul_f32 v165, v165, v30
  v_cvt_pk_bf16_f32 v26, v164, v165
  v_lshlrev_b32 v164, 16, v26
  v_and_b32 v165, 0xffff0000, v26
  v_add_f32 v164, v164, v84
  v_add_f32 v165, v165, v85
  v_cvt_pk_bf16_f32 v84, v164, v165
  v_cvt_pk_bf16_f32 v26, v166, v167
  v_lshlrev_b32 v166, 16, v26
  v_and_b32 v167, 0xffff0000, v26
  v_mul_f32 v166, v166, v30
  v_mul_f32 v167, v167, v30
  v_cvt_pk_bf16_f32 v26, v166, v167
  v_lshlrev_b32 v166, 16, v26
  v_and_b32 v167, 0xffff0000, v26
  v_add_f32 v166, v166, v86
  v_add_f32 v167, v167, v87
  v_cvt_pk_bf16_f32 v85, v166, v167
  buffer_store_dwordx2 v[84:85], v9, s[8:11], s22 offen offset:160
  s_waitcnt vmcnt(19)
  v_cvt_pk_bf16_f32 v26, v168, v169
  v_lshlrev_b32 v168, 16, v26
  v_and_b32 v169, 0xffff0000, v26
  v_mul_f32 v168, v168, v30
  v_mul_f32 v169, v169, v30
  v_cvt_pk_bf16_f32 v26, v168, v169
  v_lshlrev_b32 v168, 16, v26
  v_and_b32 v169, 0xffff0000, v26
  v_add_f32 v168, v168, v88
  v_add_f32 v169, v169, v89
  v_cvt_pk_bf16_f32 v88, v168, v169
  v_cvt_pk_bf16_f32 v26, v170, v171
  v_lshlrev_b32 v170, 16, v26
  v_and_b32 v171, 0xffff0000, v26
  v_mul_f32 v170, v170, v30
  v_mul_f32 v171, v171, v30
  v_cvt_pk_bf16_f32 v26, v170, v171
  v_lshlrev_b32 v170, 16, v26
  v_and_b32 v171, 0xffff0000, v26
  v_add_f32 v170, v170, v90
  v_add_f32 v171, v171, v91
  v_cvt_pk_bf16_f32 v89, v170, v171
  buffer_store_dwordx2 v[88:89], v9, s[8:11], s22 offen offset:192
  s_waitcnt vmcnt(19)
  v_cvt_pk_bf16_f32 v26, v172, v173
  v_lshlrev_b32 v172, 16, v26
  v_and_b32 v173, 0xffff0000, v26
  v_mul_f32 v172, v172, v30
  v_mul_f32 v173, v173, v30
  v_cvt_pk_bf16_f32 v26, v172, v173
  v_lshlrev_b32 v172, 16, v26
  v_and_b32 v173, 0xffff0000, v26
  v_add_f32 v172, v172, v92
  v_add_f32 v173, v173, v93
  v_cvt_pk_bf16_f32 v92, v172, v173
  v_cvt_pk_bf16_f32 v26, v174, v175
  v_lshlrev_b32 v174, 16, v26
  v_and_b32 v175, 0xffff0000, v26
  v_mul_f32 v174, v174, v30
  v_mul_f32 v175, v175, v30
  v_cvt_pk_bf16_f32 v26, v174, v175
  v_lshlrev_b32 v174, 16, v26
  v_and_b32 v175, 0xffff0000, v26
  v_add_f32 v174, v174, v94
  v_add_f32 v175, v175, v95
  v_cvt_pk_bf16_f32 v93, v174, v175
  buffer_store_dwordx2 v[92:93], v9, s[8:11], s22 offen offset:224
  s_waitcnt vmcnt(19)
  v_cvt_pk_bf16_f32 v26, v176, v177
  v_lshlrev_b32 v176, 16, v26
  v_and_b32 v177, 0xffff0000, v26
  v_mul_f32 v176, v176, v30
  v_mul_f32 v177, v177, v30
  v_cvt_pk_bf16_f32 v26, v176, v177
  v_lshlrev_b32 v176, 16, v26
  v_and_b32 v177, 0xffff0000, v26
  v_add_f32 v176, v176, v96
  v_add_f32 v177, v177, v97
  v_cvt_pk_bf16_f32 v96, v176, v177
  v_cvt_pk_bf16_f32 v26, v178, v179
  v_lshlrev_b32 v178, 16, v26
  v_and_b32 v179, 0xffff0000, v26
  v_mul_f32 v178, v178, v30
  v_mul_f32 v179, v179, v30
  v_cvt_pk_bf16_f32 v26, v178, v179
  v_lshlrev_b32 v178, 16, v26
  v_and_b32 v179, 0xffff0000, v26
  v_add_f32 v178, v178, v98
  v_add_f32 v179, v179, v99
  v_cvt_pk_bf16_f32 v97, v178, v179
  buffer_store_dwordx2 v[96:97], v9, s[8:11], s22 offen offset:256
  s_waitcnt vmcnt(19)
  v_cvt_pk_bf16_f32 v26, v180, v181
  v_lshlrev_b32 v180, 16, v26
  v_and_b32 v181, 0xffff0000, v26
  v_mul_f32 v180, v180, v30
  v_mul_f32 v181, v181, v30
  v_cvt_pk_bf16_f32 v26, v180, v181
  v_lshlrev_b32 v180, 16, v26
  v_and_b32 v181, 0xffff0000, v26
  v_add_f32 v180, v180, v100
  v_add_f32 v181, v181, v101
  v_cvt_pk_bf16_f32 v100, v180, v181
  v_cvt_pk_bf16_f32 v26, v182, v183
  v_lshlrev_b32 v182, 16, v26
  v_and_b32 v183, 0xffff0000, v26
  v_mul_f32 v182, v182, v30
  v_mul_f32 v183, v183, v30
  v_cvt_pk_bf16_f32 v26, v182, v183
  v_lshlrev_b32 v182, 16, v26
  v_and_b32 v183, 0xffff0000, v26
  v_add_f32 v182, v182, v102
  v_add_f32 v183, v183, v103
  v_cvt_pk_bf16_f32 v101, v182, v183
  buffer_store_dwordx2 v[100:101], v9, s[8:11], s22 offen offset:288
  s_waitcnt vmcnt(19)
  v_cvt_pk_bf16_f32 v26, v184, v185
  v_lshlrev_b32 v184, 16, v26
  v_and_b32 v185, 0xffff0000, v26
  v_mul_f32 v184, v184, v31
  v_mul_f32 v185, v185, v31
  v_cvt_pk_bf16_f32 v26, v184, v185
  v_lshlrev_b32 v184, 16, v26
  v_and_b32 v185, 0xffff0000, v26
  v_add_f32 v184, v184, v104
  v_add_f32 v185, v185, v105
  v_cvt_pk_bf16_f32 v104, v184, v185
  v_cvt_pk_bf16_f32 v26, v186, v187
  v_lshlrev_b32 v186, 16, v26
  v_and_b32 v187, 0xffff0000, v26
  v_mul_f32 v186, v186, v31
  v_mul_f32 v187, v187, v31
  v_cvt_pk_bf16_f32 v26, v186, v187
  v_lshlrev_b32 v186, 16, v26
  v_and_b32 v187, 0xffff0000, v26
  v_add_f32 v186, v186, v106
  v_add_f32 v187, v187, v107
  v_cvt_pk_bf16_f32 v105, v186, v187
  buffer_store_dwordx2 v[104:105], v9, s[8:11], s23 offen offset:0
  s_waitcnt vmcnt(19)
  v_cvt_pk_bf16_f32 v26, v188, v189
  v_lshlrev_b32 v188, 16, v26
  v_and_b32 v189, 0xffff0000, v26
  v_mul_f32 v188, v188, v31
  v_mul_f32 v189, v189, v31
  v_cvt_pk_bf16_f32 v26, v188, v189
  v_lshlrev_b32 v188, 16, v26
  v_and_b32 v189, 0xffff0000, v26
  v_add_f32 v188, v188, v108
  v_add_f32 v189, v189, v109
  v_cvt_pk_bf16_f32 v108, v188, v189
  v_cvt_pk_bf16_f32 v26, v190, v191
  v_lshlrev_b32 v190, 16, v26
  v_and_b32 v191, 0xffff0000, v26
  v_mul_f32 v190, v190, v31
  v_mul_f32 v191, v191, v31
  v_cvt_pk_bf16_f32 v26, v190, v191
  v_lshlrev_b32 v190, 16, v26
  v_and_b32 v191, 0xffff0000, v26
  v_add_f32 v190, v190, v110
  v_add_f32 v191, v191, v111
  v_cvt_pk_bf16_f32 v109, v190, v191
  buffer_store_dwordx2 v[108:109], v9, s[8:11], s23 offen offset:32
  s_waitcnt vmcnt(19)
  v_cvt_pk_bf16_f32 v26, v192, v193
  v_lshlrev_b32 v192, 16, v26
  v_and_b32 v193, 0xffff0000, v26
  v_mul_f32 v192, v192, v31
  v_mul_f32 v193, v193, v31
  v_cvt_pk_bf16_f32 v26, v192, v193
  v_lshlrev_b32 v192, 16, v26
  v_and_b32 v193, 0xffff0000, v26
  v_add_f32 v192, v192, v112
  v_add_f32 v193, v193, v113
  v_cvt_pk_bf16_f32 v112, v192, v193
  v_cvt_pk_bf16_f32 v26, v194, v195
  v_lshlrev_b32 v194, 16, v26
  v_and_b32 v195, 0xffff0000, v26
  v_mul_f32 v194, v194, v31
  v_mul_f32 v195, v195, v31
  v_cvt_pk_bf16_f32 v26, v194, v195
  v_lshlrev_b32 v194, 16, v26
  v_and_b32 v195, 0xffff0000, v26
  v_add_f32 v194, v194, v114
  v_add_f32 v195, v195, v115
  v_cvt_pk_bf16_f32 v113, v194, v195
  buffer_store_dwordx2 v[112:113], v9, s[8:11], s23 offen offset:64
  s_waitcnt vmcnt(19)
  v_cvt_pk_bf16_f32 v26, v196, v197
  v_lshlrev_b32 v196, 16, v26
  v_and_b32 v197, 0xffff0000, v26
  v_mul_f32 v196, v196, v31
  v_mul_f32 v197, v197, v31
  v_cvt_pk_bf16_f32 v26, v196, v197
  v_lshlrev_b32 v196, 16, v26
  v_and_b32 v197, 0xffff0000, v26
  v_add_f32 v196, v196, v116
  v_add_f32 v197, v197, v117
  v_cvt_pk_bf16_f32 v116, v196, v197
  v_cvt_pk_bf16_f32 v26, v198, v199
  v_lshlrev_b32 v198, 16, v26
  v_and_b32 v199, 0xffff0000, v26
  v_mul_f32 v198, v198, v31
  v_mul_f32 v199, v199, v31
  v_cvt_pk_bf16_f32 v26, v198, v199
  v_lshlrev_b32 v198, 16, v26
  v_and_b32 v199, 0xffff0000, v26
  v_add_f32 v198, v198, v118
  v_add_f32 v199, v199, v119
  v_cvt_pk_bf16_f32 v117, v198, v199
  buffer_store_dwordx2 v[116:117], v9, s[8:11], s23 offen offset:96
  s_waitcnt vmcnt(19)
  v_cvt_pk_bf16_f32 v26, v200, v201
  v_lshlrev_b32 v200, 16, v26
  v_and_b32 v201, 0xffff0000, v26
  v_mul_f32 v200, v200, v31
  v_mul_f32 v201, v201, v31
  v_cvt_pk_bf16_f32 v26, v200, v201
  v_lshlrev_b32 v200, 16, v26
  v_and_b32 v201, 0xffff0000, v26
  v_add_f32 v200, v200, v120
  v_add_f32 v201, v201, v121
  v_cvt_pk_bf16_f32 v120, v200, v201
  v_cvt_pk_bf16_f32 v26, v202, v203
  v_lshlrev_b32 v202, 16, v26
  v_and_b32 v203, 0xffff0000, v26
  v_mul_f32 v202, v202, v31
  v_mul_f32 v203, v203, v31
  v_cvt_pk_bf16_f32 v26, v202, v203
  v_lshlrev_b32 v202, 16, v26
  v_and_b32 v203, 0xffff0000, v26
  v_add_f32 v202, v202, v122
  v_add_f32 v203, v203, v123
  v_cvt_pk_bf16_f32 v121, v202, v203
  buffer_store_dwordx2 v[120:121], v9, s[8:11], s23 offen offset:128
  s_waitcnt vmcnt(19)
  v_cvt_pk_bf16_f32 v26, v204, v205
  v_lshlrev_b32 v204, 16, v26
  v_and_b32 v205, 0xffff0000, v26
  v_mul_f32 v204, v204, v31
  v_mul_f32 v205, v205, v31
  v_cvt_pk_bf16_f32 v26, v204, v205
  v_lshlrev_b32 v204, 16, v26
  v_and_b32 v205, 0xffff0000, v26
  v_add_f32 v204, v204, v124
  v_add_f32 v205, v205, v125
  v_cvt_pk_bf16_f32 v124, v204, v205
  v_cvt_pk_bf16_f32 v26, v206, v207
  v_lshlrev_b32 v206, 16, v26
  v_and_b32 v207, 0xffff0000, v26
  v_mul_f32 v206, v206, v31
  v_mul_f32 v207, v207, v31
  v_cvt_pk_bf16_f32 v26, v206, v207
  v_lshlrev_b32 v206, 16, v26
  v_and_b32 v207, 0xffff0000, v26
  v_add_f32 v206, v206, v126
  v_add_f32 v207, v207, v127
  v_cvt_pk_bf16_f32 v125, v206, v207
  buffer_store_dwordx2 v[124:125], v9, s[8:11], s23 offen offset:160
  s_waitcnt vmcnt(19)
  v_cvt_pk_bf16_f32 v26, v208, v209
  v_lshlrev_b32 v208, 16, v26
  v_and_b32 v209, 0xffff0000, v26
  v_mul_f32 v208, v208, v31
  v_mul_f32 v209, v209, v31
  v_cvt_pk_bf16_f32 v26, v208, v209
  v_lshlrev_b32 v208, 16, v26
  v_and_b32 v209, 0xffff0000, v26
  v_add_f32 v208, v208, v128
  v_add_f32 v209, v209, v129
  v_cvt_pk_bf16_f32 v128, v208, v209
  v_cvt_pk_bf16_f32 v26, v210, v211
  v_lshlrev_b32 v210, 16, v26
  v_and_b32 v211, 0xffff0000, v26
  v_mul_f32 v210, v210, v31
  v_mul_f32 v211, v211, v31
  v_cvt_pk_bf16_f32 v26, v210, v211
  v_lshlrev_b32 v210, 16, v26
  v_and_b32 v211, 0xffff0000, v26
  v_add_f32 v210, v210, v130
  v_add_f32 v211, v211, v131
  v_cvt_pk_bf16_f32 v129, v210, v211
  buffer_store_dwordx2 v[128:129], v9, s[8:11], s23 offen offset:192
  s_waitcnt vmcnt(19)
  v_cvt_pk_bf16_f32 v26, v212, v213
  v_lshlrev_b32 v212, 16, v26
  v_and_b32 v213, 0xffff0000, v26
  v_mul_f32 v212, v212, v31
  v_mul_f32 v213, v213, v31
  v_cvt_pk_bf16_f32 v26, v212, v213
  v_lshlrev_b32 v212, 16, v26
  v_and_b32 v213, 0xffff0000, v26
  v_add_f32 v212, v212, v132
  v_add_f32 v213, v213, v133
  v_cvt_pk_bf16_f32 v132, v212, v213
  v_cvt_pk_bf16_f32 v26, v214, v215
  v_lshlrev_b32 v214, 16, v26
  v_and_b32 v215, 0xffff0000, v26
  v_mul_f32 v214, v214, v31
  v_mul_f32 v215, v215, v31
  v_cvt_pk_bf16_f32 v26, v214, v215
  v_lshlrev_b32 v214, 16, v26
  v_and_b32 v215, 0xffff0000, v26
  v_add_f32 v214, v214, v134
  v_add_f32 v215, v215, v135
  v_cvt_pk_bf16_f32 v133, v214, v215
  buffer_store_dwordx2 v[132:133], v9, s[8:11], s23 offen offset:224
  s_waitcnt vmcnt(19)
  v_cvt_pk_bf16_f32 v26, v216, v217
  v_lshlrev_b32 v216, 16, v26
  v_and_b32 v217, 0xffff0000, v26
  v_mul_f32 v216, v216, v31
  v_mul_f32 v217, v217, v31
  v_cvt_pk_bf16_f32 v26, v216, v217
  v_lshlrev_b32 v216, 16, v26
  v_and_b32 v217, 0xffff0000, v26
  v_add_f32 v216, v216, v136
  v_add_f32 v217, v217, v137
  v_cvt_pk_bf16_f32 v136, v216, v217
  v_cvt_pk_bf16_f32 v26, v218, v219
  v_lshlrev_b32 v218, 16, v26
  v_and_b32 v219, 0xffff0000, v26
  v_mul_f32 v218, v218, v31
  v_mul_f32 v219, v219, v31
  v_cvt_pk_bf16_f32 v26, v218, v219
  v_lshlrev_b32 v218, 16, v26
  v_and_b32 v219, 0xffff0000, v26
  v_add_f32 v218, v218, v138
  v_add_f32 v219, v219, v139
  v_cvt_pk_bf16_f32 v137, v218, v219
  buffer_store_dwordx2 v[136:137], v9, s[8:11], s23 offen offset:256
  s_waitcnt vmcnt(19)
  v_cvt_pk_bf16_f32 v26, v220, v221
  v_lshlrev_b32 v220, 16, v26
  v_and_b32 v221, 0xffff0000, v26
  v_mul_f32 v220, v220, v31
  v_mul_f32 v221, v221, v31
  v_cvt_pk_bf16_f32 v26, v220, v221
  v_lshlrev_b32 v220, 16, v26
  v_and_b32 v221, 0xffff0000, v26
  v_add_f32 v220, v220, v140
  v_add_f32 v221, v221, v141
  v_cvt_pk_bf16_f32 v140, v220, v221
  v_cvt_pk_bf16_f32 v26, v222, v223
  v_lshlrev_b32 v222, 16, v26
  v_and_b32 v223, 0xffff0000, v26
  v_mul_f32 v222, v222, v31
  v_mul_f32 v223, v223, v31
  v_cvt_pk_bf16_f32 v26, v222, v223
  v_lshlrev_b32 v222, 16, v26
  v_and_b32 v223, 0xffff0000, v26
  v_add_f32 v222, v222, v142
  v_add_f32 v223, v223, v143
  v_cvt_pk_bf16_f32 v141, v222, v223
  buffer_store_dwordx2 v[140:141], v9, s[8:11], s23 offen offset:288
om_248:
  s_cmp_eq_u32 s87, -2
  s_cbranch_scc1 kv_help
  s_cmp_eq_u32 s87, -1
  s_cbranch_scc1 queue
tail_item:
  s_load_dwordx2 s[4:5], s[0:1], 96
  s_waitcnt lgkmcnt(0)
  s_mov_b32 s32, s4
  s_mov_b32 s33, s5
  s_mov_b32 s34, 256
  s_mov_b32 s35, 0x00020000
  s_waitcnt vmcnt(0)
  s_barrier
  s_mov_b32 s21, s87
do_pv:
  s_mov_b32 s2, s21
  s_load_dwordx2 s[4:5], s[0:1], 88
  s_load_dwordx2 s[38:39], s[0:1], 104
  s_waitcnt lgkmcnt(0)
  s_mov_b32 s8, s4
  s_mov_b32 s9, s5
  s_mov_b32 s10, 2621440
  s_mov_b32 s11, 0x00020000
  s_add_u32 s12, s38, 114294784
  s_addc_u32 s13, s39, 0
  s_mov_b32 s14, 83886080
  s_mov_b32 s15, 0x00020000
  s_mov_b32 s59, 0
  s_mov_b32 s60, 0
  s_add_u32 s16, s38, 85983232
  s_addc_u32 s17, s39, 0
  s_mov_b32 s18, 28311552
  s_mov_b32 s19, 0x00020000
  s_add_u32 s24, s38, 73400320
  s_addc_u32 s25, s39, 0
  s_mov_b32 s26, 5242880
  s_mov_b32 s27, 0x00020000
  s_add_u32 s28, s38, 81002496
  s_addc_u32 s29, s39, 0
  s_mov_b32 s30, 8192
  s_mov_b32 s31, 0x00020000
  s_add_u32 s72, s38, 81068032
  s_addc_u32 s73, s39, 0
  s_mov_b32 s74, 116736
  s_mov_b32 s75, 0x00020000
  v_lshlrev_b32 v4, 4, v1
  v_lshlrev_b32 v5, 3, v1
  v_lshlrev_b32 v6, 2, v2
  v_and_b32 v7, 7, v1
  v_lshlrev_b32 v7, 7, v7
  v_lshrrev_b32 v31, 3, v1
  v_lshl_add_u32 v208, v31, 10, v7
  v_bfe_u32 v31, v1, 3, 2
  v_lshl_add_u32 v31, v31, 2, v7
  s_lshl_b32 s21, s20, 10
  s_add_u32 s21, s21, 95232
  buffer_load_dword v8, v31, s[72:75], s21 offen sc1
  v_lshlrev_b32 v25, 7, v2
  s_mov_b32 s21, 93184
  buffer_load_dword v26, v25, s[72:75], s21 offen sc1
  s_mov_b32 s63, 1
  v_mul_u32_u24 v9, 1280, v2
  v_lshl_add_u32 v9, v3, 3, v9
  s_lshl_b32 s21, s20, 13
  v_add_u32 v10, s21, v4
  s_lshl_b32 s21, s20, 10
  v_add_u32 v11, s21, v4
  v_lshrrev_b32 v20, 5, v1
  v_mul_u32_u24 v21, 2560, v20
  v_add_u32 v21, v21, v4
  v_and_b32 v22, 31, v1
  v_lshlrev_b32 v22, 4, v22
  v_mul_u32_u24 v20, 10240, v20
  v_add_u32 v22, v22, v20
  v_mul_u32_u24 v21, 2560, v3
  v_lshl_add_u32 v21, v2, 4, v21
  v_mul_u32_u24 v22, 10240, v3
  v_lshl_add_u32 v22, v2, 4, v22
  v_mov_b32 v28, 80
  v_mov_b32 v30, 32768
  s_mov_b32 s50, 0
  s_mov_b32 s71, 0
  s_mov_b32 s51, 0
  s_and_b32 s43, s20, 1
  s_lshr_b32 s44, s20, 1
  v_mov_b32 v70, 0
  v_mov_b32 v71, 0
  v_mov_b32 v78, 0
  v_mov_b32 v79, 0
  v_mov_b32 v86, 0
  v_mov_b32 v87, 0
  v_mov_b32 v94, 0
  v_mov_b32 v95, 0
  v_mov_b32 v102, 0
  v_mov_b32 v103, 0
  v_mov_b32 v110, 0
  v_mov_b32 v111, 0
  v_mov_b32 v118, 0
  v_mov_b32 v119, 0
  v_mov_b32 v126, 0
  v_mov_b32 v127, 0
  s_mov_b32 s21, s2
pv_loop:
  s_mul_i32 s2, s21, 2
  s_add_u32 s22, s21, 250
  s_cmp_lt_u32 s21, 250
  s_cselect_b32 s2, s2, s22
  s_cselect_b32 s65, 1, 0
  s_mul_hi_u32 s40, s2, 0x1999999a
  s_mul_i32 s21, s40, 10
  s_sub_u32 s41, s2, s21
  s_lshl_b32 s52, s40, 10
  s_add_u32 s52, s52, 23552
  buffer_load_dword v27, v7, s[72:75], s52 offen sc1
  s_cmp_lg_u32 s20, 0
  s_cbranch_scc1 pv_262
  s_sub_u32 s21, s2, 450
  s_cmp_lt_u32 s21, 190
  s_cbranch_scc1 pv_262
  v_mov_b32 v29, 1
  s_mov_b64 exec, 1
  buffer_atomic_add v29, v28, s[32:35], 0 offen sc0 sc1
  s_mov_b64 exec, -1
pv_262:
  s_lshl_b32 s42, s40, 5
  s_lshl_b32 s21, s20, 3
  s_add_u32 s42, s42, s21
  s_mul_i32 s61, s21, 5
  s_lshr_b32 s22, s41, 1
  s_add_u32 s61, s61, s22
  s_and_b32 s62, s41, 1
  s_lshl_b32 s62, s62, 12
  s_mul_i32 s53, s42, 40960
  s_lshl_b32 s22, s41, 12
  s_add_u32 s53, s53, s22
  s_lshl_b32 s21, s40, 1
  s_add_u32 s21, s21, s43
  s_lshl_b32 s45, s21, 6
  s_mul_i32 s46, s21, 20480
  s_mul_i32 s21, s21, 40
  s_lshl_b32 s22, s41, 2
  s_add_u32 s22, s22, s44
  s_add_u32 s21, s21, s22
  s_lshl_b32 s54, s21, 10
  s_lshl_b32 s22, s22, 5
  s_add_u32 s46, s46, s22
  s_mul_i32 s47, s42, 2560
  s_mul_i32 s48, s42, 10240
  s_lshl_b32 s22, s41, 10
  s_add_u32 s48, s48, s22
  s_add_u32 s48, s48, 7340032
  s_add_u32 s23, s40, 1
  s_cmp_ge_u32 s50, s23
  s_cbranch_scc1 pv_255
  s_cmp_eq_u32 s63, 0
  s_cbranch_scc1 pv_258
  s_mov_b32 s63, 0
  s_waitcnt vmcnt(1)
  v_cmp_le_u32 vcc, 4, v26
  s_mov_b32 s51, vcc_lo
  v_cmp_gt_u32 vcc, s23, v8
  s_nop 1
  s_cbranch_vccz pv_259
pv_258:
  s_lshl_b32 s21, s20, 10
  s_add_u32 s21, s21, 95232
  s_mov_b32 s101, 0
wm_263:
  buffer_load_dword v8, v31, s[72:75], s21 offen sc1
  s_add_u32 s101, s101, 1
  s_cmp_gt_u32 s101, 131072
  s_cbranch_scc1 main_end
  s_waitcnt vmcnt(0)
  v_cmp_gt_u32 vcc, s23, v8
  v_readfirstlane_b32 s100, v8
  s_nop 0
  s_cbranch_vccz wm_264
  s_sleep 8
  s_add_u32 s100, s100, 2
  s_cmp_ge_u32 s100, s23
  s_cbranch_scc1 wm_263
  s_sleep 60
  s_branch wm_263
wm_264:
pv_259:
  v_readlane_b32 s50, v8, 0
  v_readlane_b32 s21, v8, 1
  s_min_u32 s50, s50, s21
  v_readlane_b32 s21, v8, 2
  s_min_u32 s50, s50, s21
  v_readlane_b32 s21, v8, 3
  s_min_u32 s50, s50, s21
  v_readlane_b32 s21, v8, 4
  s_min_u32 s50, s50, s21
  v_readlane_b32 s21, v8, 5
  s_min_u32 s50, s50, s21
  v_readlane_b32 s21, v8, 6
  s_min_u32 s50, s50, s21
  v_readlane_b32 s21, v8, 7
  s_min_u32 s50, s50, s21
  v_readlane_b32 s21, v8, 8
  s_min_u32 s50, s50, s21
  v_readlane_b32 s21, v8, 9
  s_min_u32 s50, s50, s21
  v_readlane_b32 s21, v8, 10
  s_min_u32 s50, s50, s21
  v_readlane_b32 s21, v8, 11
  s_min_u32 s50, s50, s21
  v_readlane_b32 s21, v8, 12
  s_min_u32 s50, s50, s21
  v_readlane_b32 s21, v8, 13
  s_min_u32 s50, s50, s21
  v_readlane_b32 s21, v8, 14
  s_min_u32 s50, s50, s21
  v_readlane_b32 s21, v8, 15
  s_min_u32 s50, s50, s21
  v_readlane_b32 s21, v8, 16
  s_min_u32 s50, s50, s21
  v_readlane_b32 s21, v8, 17
  s_min_u32 s50, s50, s21
  v_readlane_b32 s21, v8, 18
  s_min_u32 s50, s50, s21
  v_readlane_b32 s21, v8, 19
  s_min_u32 s50, s50, s21
  v_readlane_b32 s21, v8, 20
  s_min_u32 s50, s50, s21
  v_readlane_b32 s21, v8, 21
  s_min_u32 s50, s50, s21
  v_readlane_b32 s21, v8, 22
  s_min_u32 s50, s50, s21
  v_readlane_b32 s21, v8, 23
  s_min_u32 s50, s50, s21
  v_readlane_b32 s21, v8, 24
  s_min_u32 s50, s50, s21
  v_readlane_b32 s21, v8, 25
  s_min_u32 s50, s50, s21
  v_readlane_b32 s21, v8, 26
  s_min_u32 s50, s50, s21
  v_readlane_b32 s21, v8, 27
  s_min_u32 s50, s50, s21
  v_readlane_b32 s21, v8, 28
  s_min_u32 s50, s50, s21
  v_readlane_b32 s21, v8, 29
  s_min_u32 s50, s50, s21
  v_readlane_b32 s21, v8, 30
  s_min_u32 s50, s50, s21
  v_readlane_b32 s21, v8, 31
  s_min_u32 s50, s50, s21
pv_255:
  s_lshr_b32 s22, s40, 2
  s_cmp_lt_u32 s40, 32
  s_cbranch_scc1 pv_256
  s_bitcmp1_b32 s51, s22
  s_cbranch_scc1 pv_256
  s_mov_b32 s21, 93184
  v_lshlrev_b32 v25, 7, v2
  s_mov_b32 s101, 0
pv_257:
  buffer_load_dword v26, v25, s[72:75], s21 offen sc1
  s_add_u32 s101, s101, 1
  s_cmp_gt_u32 s101, 131072
  s_cbranch_scc1 main_end
  s_waitcnt vmcnt(0)
  v_cmp_le_u32 vcc, 4, v26
  s_mov_b32 s51, vcc_lo
  s_bitcmp1_b32 s51, s22
  s_cbranch_scc1 pv_256
  s_sleep 8
  s_branch pv_257
pv_256:
  buffer_load_dwordx4 a[0:3], v4, s[12:15], s53 offen offset:0 sc1
  buffer_load_dwordx4 a[4:7], v4, s[12:15], s53 offen offset:1024 sc1
  buffer_load_dwordx4 a[8:11], v4, s[12:15], s53 offen offset:2048 sc1
  buffer_load_dwordx4 a[12:15], v4, s[12:15], s53 offen offset:3072 sc1
  s_add_u32 s53, s53, 40960
  buffer_load_dwordx4 a[16:19], v4, s[12:15], s53 offen offset:0 sc1
  buffer_load_dwordx4 a[20:23], v4, s[12:15], s53 offen offset:1024 sc1
  buffer_load_dwordx4 a[24:27], v4, s[12:15], s53 offen offset:2048 sc1
  buffer_load_dwordx4 a[28:31], v4, s[12:15], s53 offen offset:3072 sc1
  s_add_u32 s53, s53, 40960
  buffer_load_dwordx4 a[32:35], v4, s[12:15], s53 offen offset:0 sc1
  buffer_load_dwordx4 a[36:39], v4, s[12:15], s53 offen offset:1024 sc1
  buffer_load_dwordx4 a[40:43], v4, s[12:15], s53 offen offset:2048 sc1
  buffer_load_dwordx4 a[44:47], v4, s[12:15], s53 offen offset:3072 sc1
  s_add_u32 s53, s53, 40960
  buffer_load_dwordx4 a[48:51], v4, s[12:15], s53 offen offset:0 sc1
  buffer_load_dwordx4 a[52:55], v4, s[12:15], s53 offen offset:1024 sc1
  buffer_load_dwordx4 a[56:59], v4, s[12:15], s53 offen offset:2048 sc1
  buffer_load_dwordx4 a[60:63], v4, s[12:15], s53 offen offset:3072 sc1
  s_add_u32 s53, s53, 40960
  buffer_load_dwordx4 a[64:67], v4, s[12:15], s53 offen offset:0 sc1
  buffer_load_dwordx4 a[68:71], v4, s[12:15], s53 offen offset:1024 sc1
  buffer_load_dwordx4 a[72:75], v4, s[12:15], s53 offen offset:2048 sc1
  buffer_load_dwordx4 a[76:79], v4, s[12:15], s53 offen offset:3072 sc1
  s_add_u32 s53, s53, 40960
  buffer_load_dwordx4 a[80:83], v4, s[12:15], s53 offen offset:0 sc1
  buffer_load_dwordx4 a[84:87], v4, s[12:15], s53 offen offset:1024 sc1
  buffer_load_dwordx4 a[88:91], v4, s[12:15], s53 offen offset:2048 sc1
  buffer_load_dwordx4 a[92:95], v4, s[12:15], s53 offen offset:3072 sc1
  s_add_u32 s53, s53, 40960
  buffer_load_dwordx4 a[96:99], v4, s[12:15], s53 offen offset:0 sc1
  buffer_load_dwordx4 a[100:103], v4, s[12:15], s53 offen offset:1024 sc1
  buffer_load_dwordx4 a[104:107], v4, s[12:15], s53 offen offset:2048 sc1
  buffer_load_dwordx4 a[108:111], v4, s[12:15], s53 offen offset:3072 sc1
  s_add_u32 s53, s53, 40960
  buffer_load_dwordx4 a[112:115], v4, s[12:15], s53 offen offset:0 sc1
  buffer_load_dwordx4 a[116:119], v4, s[12:15], s53 offen offset:1024 sc1
  buffer_load_dwordx4 a[120:123], v4, s[12:15], s53 offen offset:2048 sc1
  buffer_load_dwordx4 a[124:127], v4, s[12:15], s53 offen offset:3072 sc1
  s_cmp_lt_u32 s40, 32
  s_cselect_b32 s70, 0x80000000, s54
  buffer_load_dwordx4 v[12:15], v4, s[24:27], s70 offen sc1
  buffer_load_dwordx4 v[16:19], v4, s[24:27], s70 offen offset:2048 sc1
  buffer_load_dword v24, v6, s[28:31], s45 offen sc1
  s_waitcnt vmcnt(35)
  s_cmp_eq_u32 s71, 0
  s_cbranch_scc1 paf_267
  v_mov_b32 v25, 0
  v_mov_b32 v26, 1
  s_mov_b64 exec, 1
  buffer_atomic_add v26, v25, s[72:75], s71 offen sc1
  s_mov_b64 exec, -1
  s_mov_b32 s71, 0
paf_267:
  v_cmp_le_u32 s[68:69], 4, v27
  s_nop 1
  s_and_b32 s21, s68, 255
  s_cmp_lg_u32 s21, 255
  s_cbranch_scc1 pvw_260
  s_mov_b32 s56, s47
  s_mov_b32 s57, s48
  buffer_load_dwordx4 v[64:67], v4, s[16:19], s56 offen sc1
  buffer_load_dwordx2 v[68:69], v5, s[16:19], s56 offen offset:2048 sc1
  buffer_load_dwordx4 v[128:131], v21, s[16:19], s56 offen offset:1024 sc1
  buffer_load_dwordx4 v[132:135], v21, s[16:19], s56 offen offset:1280 sc1
  s_add_u32 s56, s56, 2560
  buffer_load_dwordx4 v[72:75], v4, s[16:19], s56 offen sc1
  buffer_load_dwordx2 v[76:77], v5, s[16:19], s56 offen offset:2048 sc1
  s_add_u32 s56, s56, 2560
  buffer_load_dwordx4 v[80:83], v4, s[16:19], s56 offen sc1
  buffer_load_dwordx2 v[84:85], v5, s[16:19], s56 offen offset:2048 sc1
  s_add_u32 s56, s56, 2560
  buffer_load_dwordx4 v[88:91], v4, s[16:19], s56 offen sc1
  buffer_load_dwordx2 v[92:93], v5, s[16:19], s56 offen offset:2048 sc1
  s_add_u32 s56, s56, 2560
  buffer_load_dwordx4 v[32:35], v22, s[16:19], s57 offen offset:0 sc1
  buffer_load_dwordx4 v[36:39], v22, s[16:19], s57 offen offset:256 sc1
  buffer_load_dwordx4 v[40:43], v22, s[16:19], s57 offen offset:512 sc1
  buffer_load_dwordx4 v[44:47], v22, s[16:19], s57 offen offset:768 sc1
  s_add_u32 s57, s57, 40960
  buffer_load_dwordx4 v[96:99], v4, s[16:19], s56 offen sc1
  buffer_load_dwordx2 v[100:101], v5, s[16:19], s56 offen offset:2048 sc1
  buffer_load_dwordx4 v[136:139], v21, s[16:19], s56 offen offset:1024 sc1
  buffer_load_dwordx4 v[140:143], v21, s[16:19], s56 offen offset:1280 sc1
  s_add_u32 s56, s56, 2560
  buffer_load_dwordx4 v[104:107], v4, s[16:19], s56 offen sc1
  buffer_load_dwordx2 v[108:109], v5, s[16:19], s56 offen offset:2048 sc1
  s_add_u32 s56, s56, 2560
  buffer_load_dwordx4 v[112:115], v4, s[16:19], s56 offen sc1
  buffer_load_dwordx2 v[116:117], v5, s[16:19], s56 offen offset:2048 sc1
  s_add_u32 s56, s56, 2560
  buffer_load_dwordx4 v[120:123], v4, s[16:19], s56 offen sc1
  buffer_load_dwordx2 v[124:125], v5, s[16:19], s56 offen offset:2048 sc1
  s_add_u32 s56, s56, 2560
  buffer_load_dwordx4 v[48:51], v22, s[16:19], s57 offen offset:0 sc1
  buffer_load_dwordx4 v[52:55], v22, s[16:19], s57 offen offset:256 sc1
  buffer_load_dwordx4 v[56:59], v22, s[16:19], s57 offen offset:512 sc1
  buffer_load_dwordx4 v[60:63], v22, s[16:19], s57 offen offset:768 sc1
  s_add_u32 s57, s57, 40960
  s_barrier
  s_waitcnt vmcnt(28)
  v_sub_f32 v25, 1.0, v24
  v_cvt_pk_bf16_f32 v26, v25, v25
  v_lshlrev_b32 v25, 16, v26
  v_cvt_pk_bf16_f32 v26, v12, v12
  v_lshlrev_b32 v12, 16, v26
  v_cvt_pk_bf16_f32 v26, v13, v13
  v_lshlrev_b32 v13, 16, v26
  v_cvt_pk_bf16_f32 v26, v14, v14
  v_lshlrev_b32 v14, 16, v26
  v_cvt_pk_bf16_f32 v26, v15, v15
  v_lshlrev_b32 v15, 16, v26
  v_cvt_pk_bf16_f32 v26, v16, v16
  v_lshlrev_b32 v16, 16, v26
  v_cvt_pk_bf16_f32 v26, v17, v17
  v_lshlrev_b32 v17, 16, v26
  v_cvt_pk_bf16_f32 v26, v18, v18
  v_lshlrev_b32 v18, 16, v26
  v_cvt_pk_bf16_f32 v26, v19, v19
  v_lshlrev_b32 v19, 16, v26
  v_mul_f32 v12, v12, v25
  v_cvt_pk_bf16_f32 v26, v12, v12
  v_lshlrev_b32 v12, 16, v26
  v_mul_f32 v13, v13, v25
  v_cvt_pk_bf16_f32 v26, v13, v13
  v_lshlrev_b32 v13, 16, v26
  v_mul_f32 v14, v14, v25
  v_cvt_pk_bf16_f32 v26, v14, v14
  v_lshlrev_b32 v14, 16, v26
  v_mul_f32 v15, v15, v25
  v_cvt_pk_bf16_f32 v26, v15, v15
  v_lshlrev_b32 v15, 16, v26
  v_mul_f32 v16, v16, v25
  v_cvt_pk_bf16_f32 v26, v16, v16
  v_lshlrev_b32 v16, 16, v26
  v_mul_f32 v17, v17, v25
  v_cvt_pk_bf16_f32 v26, v17, v17
  v_lshlrev_b32 v17, 16, v26
  v_mul_f32 v18, v18, v25
  v_cvt_pk_bf16_f32 v26, v18, v18
  v_lshlrev_b32 v18, 16, v26
  v_mul_f32 v19, v19, v25
  v_cvt_pk_bf16_f32 v26, v19, v19
  v_lshlrev_b32 v19, 16, v26
  s_cmp_ge_u32 s40, 56
  s_cbranch_scc1 pvc_266
  s_branch pvg_265
pvw_260:
  s_waitcnt vmcnt(0)
  v_sub_f32 v25, 1.0, v24
  v_cvt_pk_bf16_f32 v26, v25, v25
  v_lshlrev_b32 v25, 16, v26
  v_cvt_pk_bf16_f32 v26, v12, v12
  v_lshlrev_b32 v12, 16, v26
  v_cvt_pk_bf16_f32 v26, v13, v13
  v_lshlrev_b32 v13, 16, v26
  v_cvt_pk_bf16_f32 v26, v14, v14
  v_lshlrev_b32 v14, 16, v26
  v_cvt_pk_bf16_f32 v26, v15, v15
  v_lshlrev_b32 v15, 16, v26
  v_cvt_pk_bf16_f32 v26, v16, v16
  v_lshlrev_b32 v16, 16, v26
  v_cvt_pk_bf16_f32 v26, v17, v17
  v_lshlrev_b32 v17, 16, v26
  v_cvt_pk_bf16_f32 v26, v18, v18
  v_lshlrev_b32 v18, 16, v26
  v_cvt_pk_bf16_f32 v26, v19, v19
  v_lshlrev_b32 v19, 16, v26
  v_mul_f32 v12, v12, v25
  v_cvt_pk_bf16_f32 v26, v12, v12
  v_lshlrev_b32 v12, 16, v26
  v_mul_f32 v13, v13, v25
  v_cvt_pk_bf16_f32 v26, v13, v13
  v_lshlrev_b32 v13, 16, v26
  v_mul_f32 v14, v14, v25
  v_cvt_pk_bf16_f32 v26, v14, v14
  v_lshlrev_b32 v14, 16, v26
  v_mul_f32 v15, v15, v25
  v_cvt_pk_bf16_f32 v26, v15, v15
  v_lshlrev_b32 v15, 16, v26
  v_mul_f32 v16, v16, v25
  v_cvt_pk_bf16_f32 v26, v16, v16
  v_lshlrev_b32 v16, 16, v26
  v_mul_f32 v17, v17, v25
  v_cvt_pk_bf16_f32 v26, v17, v17
  v_lshlrev_b32 v17, 16, v26
  v_mul_f32 v18, v18, v25
  v_cvt_pk_bf16_f32 v26, v18, v18
  v_lshlrev_b32 v18, 16, v26
  v_mul_f32 v19, v19, v25
  v_cvt_pk_bf16_f32 v26, v19, v19
  v_lshlrev_b32 v19, 16, v26
  s_cmp_ge_u32 s40, 56
  s_cbranch_scc1 pvt_268
  s_cmp_lg_u32 s20, 0
  s_cbranch_scc1 wm_270
  s_mov_b32 s101, 0
wm_269:
  buffer_load_dword v26, v7, s[72:75], s52 offen sc1
  s_add_u32 s101, s101, 1
  s_cmp_gt_u32 s101, 131072
  s_cbranch_scc1 main_end
  s_waitcnt vmcnt(0)
  v_cmp_gt_u32 vcc, 4, v26
  v_readfirstlane_b32 s100, v26
  s_nop 0
  s_cbranch_vccz wm_270
  s_sleep 2
  s_add_u32 s100, s100, 3
  s_cmp_ge_u32 s100, 4
  s_cbranch_scc1 wm_269
  s_sleep 24
  s_branch wm_269
wm_270:
  s_barrier
  buffer_load_dwordx4 v[64:67], v4, s[16:19], s47 offen sc1
  buffer_load_dwordx2 v[68:69], v5, s[16:19], s47 offen offset:2048 sc1
  buffer_load_dwordx4 v[128:131], v21, s[16:19], s47 offen offset:1024 sc1
  buffer_load_dwordx4 v[132:135], v21, s[16:19], s47 offen offset:1280 sc1
  s_add_u32 s47, s47, 2560
  buffer_load_dwordx4 v[72:75], v4, s[16:19], s47 offen sc1
  buffer_load_dwordx2 v[76:77], v5, s[16:19], s47 offen offset:2048 sc1
  s_add_u32 s47, s47, 2560
  buffer_load_dwordx4 v[80:83], v4, s[16:19], s47 offen sc1
  buffer_load_dwordx2 v[84:85], v5, s[16:19], s47 offen offset:2048 sc1
  s_add_u32 s47, s47, 2560
  buffer_load_dwordx4 v[88:91], v4, s[16:19], s47 offen sc1
  buffer_load_dwordx2 v[92:93], v5, s[16:19], s47 offen offset:2048 sc1
  s_add_u32 s47, s47, 2560
  buffer_load_dwordx4 v[32:35], v22, s[16:19], s48 offen offset:0 sc1
  buffer_load_dwordx4 v[36:39], v22, s[16:19], s48 offen offset:256 sc1
  buffer_load_dwordx4 v[40:43], v22, s[16:19], s48 offen offset:512 sc1
  buffer_load_dwordx4 v[44:47], v22, s[16:19], s48 offen offset:768 sc1
  s_add_u32 s48, s48, 40960
  buffer_load_dwordx4 v[96:99], v4, s[16:19], s47 offen sc1
  buffer_load_dwordx2 v[100:101], v5, s[16:19], s47 offen offset:2048 sc1
  buffer_load_dwordx4 v[136:139], v21, s[16:19], s47 offen offset:1024 sc1
  buffer_load_dwordx4 v[140:143], v21, s[16:19], s47 offen offset:1280 sc1
  s_add_u32 s47, s47, 2560
  buffer_load_dwordx4 v[104:107], v4, s[16:19], s47 offen sc1
  buffer_load_dwordx2 v[108:109], v5, s[16:19], s47 offen offset:2048 sc1
  s_add_u32 s47, s47, 2560
  buffer_load_dwordx4 v[112:115], v4, s[16:19], s47 offen sc1
  buffer_load_dwordx2 v[116:117], v5, s[16:19], s47 offen offset:2048 sc1
  s_add_u32 s47, s47, 2560
  buffer_load_dwordx4 v[120:123], v4, s[16:19], s47 offen sc1
  buffer_load_dwordx2 v[124:125], v5, s[16:19], s47 offen offset:2048 sc1
  s_add_u32 s47, s47, 2560
  buffer_load_dwordx4 v[48:51], v22, s[16:19], s48 offen offset:0 sc1
  buffer_load_dwordx4 v[52:55], v22, s[16:19], s48 offen offset:256 sc1
  buffer_load_dwordx4 v[56:59], v22, s[16:19], s48 offen offset:512 sc1
  buffer_load_dwordx4 v[60:63], v22, s[16:19], s48 offen offset:768 sc1
  s_add_u32 s48, s48, 40960
pvg_265:
  s_waitcnt vmcnt(26)
  v_mfma_f32_16x16x32_bf16 v[148:151], a[0:3], v[64:67], 0
  v_mfma_f32_16x16x32_bf16 v[144:147], a[0:3], v[68:71], 0
  v_mfma_f32_16x16x32_bf16 v[156:159], a[4:7], v[64:67], 0
  v_mfma_f32_16x16x32_bf16 v[152:155], a[4:7], v[68:71], 0
  v_mfma_f32_16x16x32_bf16 v[164:167], a[8:11], v[64:67], 0
  v_mfma_f32_16x16x32_bf16 v[160:163], a[8:11], v[68:71], 0
  v_mfma_f32_16x16x32_bf16 v[172:175], a[12:15], v[64:67], 0
  v_mfma_f32_16x16x32_bf16 v[168:171], a[12:15], v[68:71], 0
  s_waitcnt vmcnt(22)
  v_mfma_f32_16x16x32_bf16 v[148:151], a[16:19], v[72:75], v[148:151]
  v_mfma_f32_16x16x32_bf16 v[144:147], a[16:19], v[76:79], v[144:147]
  v_mfma_f32_16x16x32_bf16 v[156:159], a[20:23], v[72:75], v[156:159]
  v_mfma_f32_16x16x32_bf16 v[152:155], a[20:23], v[76:79], v[152:155]
  v_mfma_f32_16x16x32_bf16 v[164:167], a[24:27], v[72:75], v[164:167]
  v_mfma_f32_16x16x32_bf16 v[160:163], a[24:27], v[76:79], v[160:163]
  v_mfma_f32_16x16x32_bf16 v[172:175], a[28:31], v[72:75], v[172:175]
  v_mfma_f32_16x16x32_bf16 v[168:171], a[28:31], v[76:79], v[168:171]
  s_waitcnt vmcnt(20)
  v_mfma_f32_16x16x32_bf16 v[148:151], a[32:35], v[80:83], v[148:151]
  v_mfma_f32_16x16x32_bf16 v[144:147], a[32:35], v[84:87], v[144:147]
  v_mfma_f32_16x16x32_bf16 v[156:159], a[36:39], v[80:83], v[156:159]
  v_mfma_f32_16x16x32_bf16 v[152:155], a[36:39], v[84:87], v[152:155]
  v_mfma_f32_16x16x32_bf16 v[164:167], a[40:43], v[80:83], v[164:167]
  v_mfma_f32_16x16x32_bf16 v[160:163], a[40:43], v[84:87], v[160:163]
  v_mfma_f32_16x16x32_bf16 v[172:175], a[44:47], v[80:83], v[172:175]
  v_mfma_f32_16x16x32_bf16 v[168:171], a[44:47], v[84:87], v[168:171]
  s_waitcnt vmcnt(18)
  v_mfma_f32_16x16x32_bf16 v[148:151], a[48:51], v[88:91], v[148:151]
  v_mfma_f32_16x16x32_bf16 v[144:147], a[48:51], v[92:95], v[144:147]
  v_mfma_f32_16x16x32_bf16 v[156:159], a[52:55], v[88:91], v[156:159]
  v_mfma_f32_16x16x32_bf16 v[152:155], a[52:55], v[92:95], v[152:155]
  v_mfma_f32_16x16x32_bf16 v[164:167], a[56:59], v[88:91], v[164:167]
  v_mfma_f32_16x16x32_bf16 v[160:163], a[56:59], v[92:95], v[160:163]
  v_mfma_f32_16x16x32_bf16 v[172:175], a[60:63], v[88:91], v[172:175]
  v_mfma_f32_16x16x32_bf16 v[168:171], a[60:63], v[92:95], v[168:171]
  s_waitcnt vmcnt(14)
  s_nop 1
  v_mfma_f32_16x16x32_bf16 v[144:147], v[32:35], v[128:131], v[144:147]
  v_mfma_f32_16x16x32_bf16 v[148:151], v[32:35], v[132:135], v[148:151]
  v_mfma_f32_16x16x32_bf16 v[152:155], v[36:39], v[128:131], v[152:155]
  v_mfma_f32_16x16x32_bf16 v[156:159], v[36:39], v[132:135], v[156:159]
  v_mfma_f32_16x16x32_bf16 v[160:163], v[40:43], v[128:131], v[160:163]
  v_mfma_f32_16x16x32_bf16 v[164:167], v[40:43], v[132:135], v[164:167]
  v_mfma_f32_16x16x32_bf16 v[168:171], v[44:47], v[128:131], v[168:171]
  v_mfma_f32_16x16x32_bf16 v[172:175], v[44:47], v[132:135], v[172:175]
  s_waitcnt vmcnt(12)
  v_mfma_f32_16x16x32_bf16 v[148:151], a[64:67], v[96:99], v[148:151]
  v_mfma_f32_16x16x32_bf16 v[144:147], a[64:67], v[100:103], v[144:147]
  v_mfma_f32_16x16x32_bf16 v[156:159], a[68:71], v[96:99], v[156:159]
  v_mfma_f32_16x16x32_bf16 v[152:155], a[68:71], v[100:103], v[152:155]
  v_mfma_f32_16x16x32_bf16 v[164:167], a[72:75], v[96:99], v[164:167]
  v_mfma_f32_16x16x32_bf16 v[160:163], a[72:75], v[100:103], v[160:163]
  v_mfma_f32_16x16x32_bf16 v[172:175], a[76:79], v[96:99], v[172:175]
  v_mfma_f32_16x16x32_bf16 v[168:171], a[76:79], v[100:103], v[168:171]
  s_waitcnt vmcnt(8)
  v_mfma_f32_16x16x32_bf16 v[148:151], a[80:83], v[104:107], v[148:151]
  v_mfma_f32_16x16x32_bf16 v[144:147], a[80:83], v[108:111], v[144:147]
  v_mfma_f32_16x16x32_bf16 v[156:159], a[84:87], v[104:107], v[156:159]
  v_mfma_f32_16x16x32_bf16 v[152:155], a[84:87], v[108:111], v[152:155]
  v_mfma_f32_16x16x32_bf16 v[164:167], a[88:91], v[104:107], v[164:167]
  v_mfma_f32_16x16x32_bf16 v[160:163], a[88:91], v[108:111], v[160:163]
  v_mfma_f32_16x16x32_bf16 v[172:175], a[92:95], v[104:107], v[172:175]
  v_mfma_f32_16x16x32_bf16 v[168:171], a[92:95], v[108:111], v[168:171]
  s_waitcnt vmcnt(6)
  v_mfma_f32_16x16x32_bf16 v[148:151], a[96:99], v[112:115], v[148:151]
  v_mfma_f32_16x16x32_bf16 v[144:147], a[96:99], v[116:119], v[144:147]
  v_mfma_f32_16x16x32_bf16 v[156:159], a[100:103], v[112:115], v[156:159]
  v_mfma_f32_16x16x32_bf16 v[152:155], a[100:103], v[116:119], v[152:155]
  v_mfma_f32_16x16x32_bf16 v[164:167], a[104:107], v[112:115], v[164:167]
  v_mfma_f32_16x16x32_bf16 v[160:163], a[104:107], v[116:119], v[160:163]
  v_mfma_f32_16x16x32_bf16 v[172:175], a[108:111], v[112:115], v[172:175]
  v_mfma_f32_16x16x32_bf16 v[168:171], a[108:111], v[116:119], v[168:171]
  s_waitcnt vmcnt(4)
  v_mfma_f32_16x16x32_bf16 v[148:151], a[112:115], v[120:123], v[148:151]
  v_mfma_f32_16x16x32_bf16 v[144:147], a[112:115], v[124:127], v[144:147]
  v_mfma_f32_16x16x32_bf16 v[156:159], a[116:119], v[120:123], v[156:159]
  v_mfma_f32_16x16x32_bf16 v[152:155], a[116:119], v[124:127], v[152:155]
  v_mfma_f32_16x16x32_bf16 v[164:167], a[120:123], v[120:123], v[164:167]
  v_mfma_f32_16x16x32_bf16 v[160:163], a[120:123], v[124:127], v[160:163]
  v_mfma_f32_16x16x32_bf16 v[172:175], a[124:127], v[120:123], v[172:175]
  v_mfma_f32_16x16x32_bf16 v[168:171], a[124:127], v[124:127], v[168:171]
  s_waitcnt vmcnt(0)
  s_nop 1
  v_mfma_f32_16x16x32_bf16 v[144:147], v[48:51], v[136:139], v[144:147]
  v_mfma_f32_16x16x32_bf16 v[148:151], v[48:51], v[140:143], v[148:151]
  v_mfma_f32_16x16x32_bf16 v[152:155], v[52:55], v[136:139], v[152:155]
  v_mfma_f32_16x16x32_bf16 v[156:159], v[52:55], v[140:143], v[156:159]
  v_mfma_f32_16x16x32_bf16 v[160:163], v[56:59], v[136:139], v[160:163]
  v_mfma_f32_16x16x32_bf16 v[164:167], v[56:59], v[140:143], v[164:167]
  v_mfma_f32_16x16x32_bf16 v[168:171], v[60:63], v[136:139], v[168:171]
  v_mfma_f32_16x16x32_bf16 v[172:175], v[60:63], v[140:143], v[172:175]
  s_branch pve_261
pvt_268:
  s_sub_u32 s55, s52, 1024
  s_cmp_lg_u32 s20, 0
  s_cbranch_scc1 wm_272
  s_mov_b32 s101, 0
wm_271:
  buffer_load_dword v26, v7, s[72:75], s55 offen sc1
  s_add_u32 s101, s101, 1
  s_cmp_gt_u32 s101, 131072
  s_cbranch_scc1 main_end
  s_waitcnt vmcnt(0)
  v_cmp_gt_u32 vcc, 4, v26
  v_readfirstlane_b32 s100, v26
  s_nop 0
  s_cbranch_vccz wm_272
  s_sleep 4
  s_add_u32 s100, s100, 3
  s_cmp_ge_u32 s100, 4
  s_cbranch_scc1 wm_271
  s_sleep 24
  s_branch wm_271
wm_272:
  s_barrier
  s_mov_b32 s56, s47
  s_mov_b32 s57, s48
  buffer_load_dwordx4 v[64:67], v4, s[16:19], s56 offen sc1
  buffer_load_dwordx2 v[68:69], v5, s[16:19], s56 offen offset:2048 sc1
  buffer_load_dwordx4 v[128:131], v21, s[16:19], s56 offen offset:1024 sc1
  buffer_load_dwordx4 v[132:135], v21, s[16:19], s56 offen offset:1280 sc1
  s_add_u32 s56, s56, 2560
  buffer_load_dwordx4 v[72:75], v4, s[16:19], s56 offen sc1
  buffer_load_dwordx2 v[76:77], v5, s[16:19], s56 offen offset:2048 sc1
  s_add_u32 s56, s56, 2560
  buffer_load_dwordx4 v[80:83], v4, s[16:19], s56 offen sc1
  buffer_load_dwordx2 v[84:85], v5, s[16:19], s56 offen offset:2048 sc1
  s_add_u32 s56, s56, 2560
  buffer_load_dwordx4 v[88:91], v4, s[16:19], s56 offen sc1
  buffer_load_dwordx2 v[92:93], v5, s[16:19], s56 offen offset:2048 sc1
  s_add_u32 s56, s56, 2560
  buffer_load_dwordx4 v[32:35], v22, s[16:19], s57 offen offset:0 sc1
  buffer_load_dwordx4 v[36:39], v22, s[16:19], s57 offen offset:256 sc1
  buffer_load_dwordx4 v[40:43], v22, s[16:19], s57 offen offset:512 sc1
  buffer_load_dwordx4 v[44:47], v22, s[16:19], s57 offen offset:768 sc1
  s_add_u32 s57, s57, 40960
  buffer_load_dwordx4 v[96:99], v4, s[16:19], s56 offen sc1
  buffer_load_dwordx2 v[100:101], v5, s[16:19], s56 offen offset:2048 sc1
  buffer_load_dwordx4 v[136:139], v21, s[16:19], s56 offen offset:1024 sc1
  buffer_load_dwordx4 v[140:143], v21, s[16:19], s56 offen offset:1280 sc1
  s_add_u32 s56, s56, 2560
  buffer_load_dwordx4 v[104:107], v4, s[16:19], s56 offen sc1
  buffer_load_dwordx2 v[108:109], v5, s[16:19], s56 offen offset:2048 sc1
  s_add_u32 s56, s56, 2560
  buffer_load_dwordx4 v[112:115], v4, s[16:19], s56 offen sc1
  buffer_load_dwordx2 v[116:117], v5, s[16:19], s56 offen offset:2048 sc1
  s_add_u32 s56, s56, 2560
  buffer_load_dwordx4 v[120:123], v4, s[16:19], s56 offen sc1
  buffer_load_dwordx2 v[124:125], v5, s[16:19], s56 offen offset:2048 sc1
  s_add_u32 s56, s56, 2560
  buffer_load_dwordx4 v[48:51], v22, s[16:19], s57 offen offset:0 sc1
  buffer_load_dwordx4 v[52:55], v22, s[16:19], s57 offen offset:256 sc1
  buffer_load_dwordx4 v[56:59], v22, s[16:19], s57 offen offset:512 sc1
  buffer_load_dwordx4 v[60:63], v22, s[16:19], s57 offen offset:768 sc1
  s_add_u32 s57, s57, 40960
pvc_266:
  s_mov_b32 s101, 0
  s_waitcnt vmcnt(14)
  s_branch pvr_274
pvr_273:
  s_sleep 2
  s_add_u32 s56, s47, 0
  s_add_u32 s57, s48, 0
  buffer_load_dwordx4 v[64:67], v4, s[16:19], s56 offen sc1
  buffer_load_dwordx2 v[68:69], v5, s[16:19], s56 offen offset:2048 sc1
  buffer_load_dwordx4 v[128:131], v21, s[16:19], s56 offen offset:1024 sc1
  buffer_load_dwordx4 v[132:135], v21, s[16:19], s56 offen offset:1280 sc1
  s_add_u32 s56, s56, 2560
  buffer_load_dwordx4 v[72:75], v4, s[16:19], s56 offen sc1
  buffer_load_dwordx2 v[76:77], v5, s[16:19], s56 offen offset:2048 sc1
  s_add_u32 s56, s56, 2560
  buffer_load_dwordx4 v[80:83], v4, s[16:19], s56 offen sc1
  buffer_load_dwordx2 v[84:85], v5, s[16:19], s56 offen offset:2048 sc1
  s_add_u32 s56, s56, 2560
  buffer_load_dwordx4 v[88:91], v4, s[16:19], s56 offen sc1
  buffer_load_dwordx2 v[92:93], v5, s[16:19], s56 offen offset:2048 sc1
  s_add_u32 s56, s56, 2560
  buffer_load_dwordx4 v[32:35], v22, s[16:19], s57 offen offset:0 sc1
  buffer_load_dwordx4 v[36:39], v22, s[16:19], s57 offen offset:256 sc1
  buffer_load_dwordx4 v[40:43], v22, s[16:19], s57 offen offset:512 sc1
  buffer_load_dwordx4 v[44:47], v22, s[16:19], s57 offen offset:768 sc1
  s_add_u32 s57, s57, 40960
  s_add_u32 s101, s101, 1
  s_cmp_gt_u32 s101, 131072
  s_cbranch_scc1 main_end
  s_waitcnt vmcnt(0)
pvr_274:
  v_max3_u32 v26, v64, v68, v72
  v_max3_u32 v26, v26, v76, v80
  v_max3_u32 v26, v26, v84, v88
  v_max3_u32 v26, v26, v92, v128
  v_max3_u32 v26, v26, v132, v32
  v_max3_u32 v26, v26, v36, v40
  v_max3_u32 v26, v26, v44, v44
  v_cmp_eq_u32 vcc, -1, v26
  s_nop 1
  s_cbranch_vccnz pvr_273
  v_mfma_f32_16x16x32_bf16 v[148:151], a[0:3], v[64:67], 0
  v_mfma_f32_16x16x32_bf16 v[144:147], a[0:3], v[68:71], 0
  v_mfma_f32_16x16x32_bf16 v[156:159], a[4:7], v[64:67], 0
  v_mfma_f32_16x16x32_bf16 v[152:155], a[4:7], v[68:71], 0
  v_mfma_f32_16x16x32_bf16 v[164:167], a[8:11], v[64:67], 0
  v_mfma_f32_16x16x32_bf16 v[160:163], a[8:11], v[68:71], 0
  v_mfma_f32_16x16x32_bf16 v[172:175], a[12:15], v[64:67], 0
  v_mfma_f32_16x16x32_bf16 v[168:171], a[12:15], v[68:71], 0
  v_mfma_f32_16x16x32_bf16 v[148:151], a[16:19], v[72:75], v[148:151]
  v_mfma_f32_16x16x32_bf16 v[144:147], a[16:19], v[76:79], v[144:147]
  v_mfma_f32_16x16x32_bf16 v[156:159], a[20:23], v[72:75], v[156:159]
  v_mfma_f32_16x16x32_bf16 v[152:155], a[20:23], v[76:79], v[152:155]
  v_mfma_f32_16x16x32_bf16 v[164:167], a[24:27], v[72:75], v[164:167]
  v_mfma_f32_16x16x32_bf16 v[160:163], a[24:27], v[76:79], v[160:163]
  v_mfma_f32_16x16x32_bf16 v[172:175], a[28:31], v[72:75], v[172:175]
  v_mfma_f32_16x16x32_bf16 v[168:171], a[28:31], v[76:79], v[168:171]
  v_mfma_f32_16x16x32_bf16 v[148:151], a[32:35], v[80:83], v[148:151]
  v_mfma_f32_16x16x32_bf16 v[144:147], a[32:35], v[84:87], v[144:147]
  v_mfma_f32_16x16x32_bf16 v[156:159], a[36:39], v[80:83], v[156:159]
  v_mfma_f32_16x16x32_bf16 v[152:155], a[36:39], v[84:87], v[152:155]
  v_mfma_f32_16x16x32_bf16 v[164:167], a[40:43], v[80:83], v[164:167]
  v_mfma_f32_16x16x32_bf16 v[160:163], a[40:43], v[84:87], v[160:163]
  v_mfma_f32_16x16x32_bf16 v[172:175], a[44:47], v[80:83], v[172:175]
  v_mfma_f32_16x16x32_bf16 v[168:171], a[44:47], v[84:87], v[168:171]
  v_mfma_f32_16x16x32_bf16 v[148:151], a[48:51], v[88:91], v[148:151]
  v_mfma_f32_16x16x32_bf16 v[144:147], a[48:51], v[92:95], v[144:147]
  v_mfma_f32_16x16x32_bf16 v[156:159], a[52:55], v[88:91], v[156:159]
  v_mfma_f32_16x16x32_bf16 v[152:155], a[52:55], v[92:95], v[152:155]
  v_mfma_f32_16x16x32_bf16 v[164:167], a[56:59], v[88:91], v[164:167]
  v_mfma_f32_16x16x32_bf16 v[160:163], a[56:59], v[92:95], v[160:163]
  v_mfma_f32_16x16x32_bf16 v[172:175], a[60:63], v[88:91], v[172:175]
  v_mfma_f32_16x16x32_bf16 v[168:171], a[60:63], v[92:95], v[168:171]
  s_nop 1
  v_mfma_f32_16x16x32_bf16 v[144:147], v[32:35], v[128:131], v[144:147]
  v_mfma_f32_16x16x32_bf16 v[148:151], v[32:35], v[132:135], v[148:151]
  v_mfma_f32_16x16x32_bf16 v[152:155], v[36:39], v[128:131], v[152:155]
  v_mfma_f32_16x16x32_bf16 v[156:159], v[36:39], v[132:135], v[156:159]
  v_mfma_f32_16x16x32_bf16 v[160:163], v[40:43], v[128:131], v[160:163]
  v_mfma_f32_16x16x32_bf16 v[164:167], v[40:43], v[132:135], v[164:167]
  v_mfma_f32_16x16x32_bf16 v[168:171], v[44:47], v[128:131], v[168:171]
  v_mfma_f32_16x16x32_bf16 v[172:175], v[44:47], v[132:135], v[172:175]
  s_mov_b32 s101, 0
  s_waitcnt vmcnt(0)
  s_branch pvr_276
pvr_275:
  s_sleep 2
  s_add_u32 s56, s47, 10240
  s_add_u32 s57, s48, 40960
  buffer_load_dwordx4 v[96:99], v4, s[16:19], s56 offen sc1
  buffer_load_dwordx2 v[100:101], v5, s[16:19], s56 offen offset:2048 sc1
  buffer_load_dwordx4 v[136:139], v21, s[16:19], s56 offen offset:1024 sc1
  buffer_load_dwordx4 v[140:143], v21, s[16:19], s56 offen offset:1280 sc1
  s_add_u32 s56, s56, 2560
  buffer_load_dwordx4 v[104:107], v4, s[16:19], s56 offen sc1
  buffer_load_dwordx2 v[108:109], v5, s[16:19], s56 offen offset:2048 sc1
  s_add_u32 s56, s56, 2560
  buffer_load_dwordx4 v[112:115], v4, s[16:19], s56 offen sc1
  buffer_load_dwordx2 v[116:117], v5, s[16:19], s56 offen offset:2048 sc1
  s_add_u32 s56, s56, 2560
  buffer_load_dwordx4 v[120:123], v4, s[16:19], s56 offen sc1
  buffer_load_dwordx2 v[124:125], v5, s[16:19], s56 offen offset:2048 sc1
  s_add_u32 s56, s56, 2560
  buffer_load_dwordx4 v[48:51], v22, s[16:19], s57 offen offset:0 sc1
  buffer_load_dwordx4 v[52:55], v22, s[16:19], s57 offen offset:256 sc1
  buffer_load_dwordx4 v[56:59], v22, s[16:19], s57 offen offset:512 sc1
  buffer_load_dwordx4 v[60:63], v22, s[16:19], s57 offen offset:768 sc1
  s_add_u32 s57, s57, 40960
  s_add_u32 s101, s101, 1
  s_cmp_gt_u32 s101, 131072
  s_cbranch_scc1 main_end
  s_waitcnt vmcnt(0)
pvr_276:
  v_max3_u32 v26, v96, v100, v104
  v_max3_u32 v26, v26, v108, v112
  v_max3_u32 v26, v26, v116, v120
  v_max3_u32 v26, v26, v124, v136
  v_max3_u32 v26, v26, v140, v48
  v_max3_u32 v26, v26, v52, v56
  v_max3_u32 v26, v26, v60, v60
  v_cmp_eq_u32 vcc, -1, v26
  s_nop 1
  s_cbranch_vccnz pvr_275
  v_mfma_f32_16x16x32_bf16 v[148:151], a[64:67], v[96:99], v[148:151]
  v_mfma_f32_16x16x32_bf16 v[144:147], a[64:67], v[100:103], v[144:147]
  v_mfma_f32_16x16x32_bf16 v[156:159], a[68:71], v[96:99], v[156:159]
  v_mfma_f32_16x16x32_bf16 v[152:155], a[68:71], v[100:103], v[152:155]
  v_mfma_f32_16x16x32_bf16 v[164:167], a[72:75], v[96:99], v[164:167]
  v_mfma_f32_16x16x32_bf16 v[160:163], a[72:75], v[100:103], v[160:163]
  v_mfma_f32_16x16x32_bf16 v[172:175], a[76:79], v[96:99], v[172:175]
  v_mfma_f32_16x16x32_bf16 v[168:171], a[76:79], v[100:103], v[168:171]
  v_mfma_f32_16x16x32_bf16 v[148:151], a[80:83], v[104:107], v[148:151]
  v_mfma_f32_16x16x32_bf16 v[144:147], a[80:83], v[108:111], v[144:147]
  v_mfma_f32_16x16x32_bf16 v[156:159], a[84:87], v[104:107], v[156:159]
  v_mfma_f32_16x16x32_bf16 v[152:155], a[84:87], v[108:111], v[152:155]
  v_mfma_f32_16x16x32_bf16 v[164:167], a[88:91], v[104:107], v[164:167]
  v_mfma_f32_16x16x32_bf16 v[160:163], a[88:91], v[108:111], v[160:163]
  v_mfma_f32_16x16x32_bf16 v[172:175], a[92:95], v[104:107], v[172:175]
  v_mfma_f32_16x16x32_bf16 v[168:171], a[92:95], v[108:111], v[168:171]
  v_mfma_f32_16x16x32_bf16 v[148:151], a[96:99], v[112:115], v[148:151]
  v_mfma_f32_16x16x32_bf16 v[144:147], a[96:99], v[116:119], v[144:147]
  v_mfma_f32_16x16x32_bf16 v[156:159], a[100:103], v[112:115], v[156:159]
  v_mfma_f32_16x16x32_bf16 v[152:155], a[100:103], v[116:119], v[152:155]
  v_mfma_f32_16x16x32_bf16 v[164:167], a[104:107], v[112:115], v[164:167]
  v_mfma_f32_16x16x32_bf16 v[160:163], a[104:107], v[116:119], v[160:163]
  v_mfma_f32_16x16x32_bf16 v[172:175], a[108:111], v[112:115], v[172:175]
  v_mfma_f32_16x16x32_bf16 v[168:171], a[108:111], v[116:119], v[168:171]
  v_mfma_f32_16x16x32_bf16 v[148:151], a[112:115], v[120:123], v[148:151]
  v_mfma_f32_16x16x32_bf16 v[144:147], a[112:115], v[124:127], v[144:147]
  v_mfma_f32_16x16x32_bf16 v[156:159], a[116:119], v[120:123], v[156:159]
  v_mfma_f32_16x16x32_bf16 v[152:155], a[116:119], v[124:127], v[152:155]
  v_mfma_f32_16x16x32_bf16 v[164:167], a[120:123], v[120:123], v[164:167]
  v_mfma_f32_16x16x32_bf16 v[160:163], a[120:123], v[124:127], v[160:163]
  v_mfma_f32_16x16x32_bf16 v[172:175], a[124:127], v[120:123], v[172:175]
  v_mfma_f32_16x16x32_bf16 v[168:171], a[124:127], v[124:127], v[168:171]
  s_nop 1
  v_mfma_f32_16x16x32_bf16 v[144:147], v[48:51], v[136:139], v[144:147]
  v_mfma_f32_16x16x32_bf16 v[148:151], v[48:51], v[140:143], v[148:151]
  v_mfma_f32_16x16x32_bf16 v[152:155], v[52:55], v[136:139], v[152:155]
  v_mfma_f32_16x16x32_bf16 v[156:159], v[52:55], v[140:143], v[156:159]
  v_mfma_f32_16x16x32_bf16 v[160:163], v[56:59], v[136:139], v[160:163]
  v_mfma_f32_16x16x32_bf16 v[164:167], v[56:59], v[140:143], v[164:167]
  v_mfma_f32_16x16x32_bf16 v[168:171], v[60:63], v[136:139], v[168:171]
  v_mfma_f32_16x16x32_bf16 v[172:175], v[60:63], v[140:143], v[172:175]
pve_261:
  s_nop 0
  s_cmp_eq_u32 s65, 0
  s_cbranch_scc1 pvx_277
  s_add_u32 s41, s41, 1
  s_mul_i32 s53, s42, 40960
  s_lshl_b32 s22, s41, 12
  s_add_u32 s53, s53, s22
  s_mul_i32 s48, s42, 10240
  s_lshl_b32 s22, s41, 10
  s_add_u32 s48, s48, s22
  s_add_u32 s48, s48, 7340032
  buffer_load_dwordx4 v[32:35], v22, s[16:19], s48 offen offset:0 sc1
  buffer_load_dwordx4 v[36:39], v22, s[16:19], s48 offen offset:256 sc1
  buffer_load_dwordx4 v[40:43], v22, s[16:19], s48 offen offset:512 sc1
  buffer_load_dwordx4 v[44:47], v22, s[16:19], s48 offen offset:768 sc1
  s_add_u32 s48, s48, 40960
  buffer_load_dwordx4 v[48:51], v22, s[16:19], s48 offen offset:0 sc1
  buffer_load_dwordx4 v[52:55], v22, s[16:19], s48 offen offset:256 sc1
  buffer_load_dwordx4 v[56:59], v22, s[16:19], s48 offen offset:512 sc1
  buffer_load_dwordx4 v[60:63], v22, s[16:19], s48 offen offset:768 sc1
  s_add_u32 s48, s48, 40960
  buffer_load_dwordx4 a[0:3], v4, s[12:15], s53 offen offset:0 sc1
  buffer_load_dwordx4 a[4:7], v4, s[12:15], s53 offen offset:1024 sc1
  buffer_load_dwordx4 a[8:11], v4, s[12:15], s53 offen offset:2048 sc1
  buffer_load_dwordx4 a[12:15], v4, s[12:15], s53 offen offset:3072 sc1
  s_add_u32 s53, s53, 40960
  buffer_load_dwordx4 a[16:19], v4, s[12:15], s53 offen offset:0 sc1
  buffer_load_dwordx4 a[20:23], v4, s[12:15], s53 offen offset:1024 sc1
  buffer_load_dwordx4 a[24:27], v4, s[12:15], s53 offen offset:2048 sc1
  buffer_load_dwordx4 a[28:31], v4, s[12:15], s53 offen offset:3072 sc1
  s_add_u32 s53, s53, 40960
  buffer_load_dwordx4 a[32:35], v4, s[12:15], s53 offen offset:0 sc1
  buffer_load_dwordx4 a[36:39], v4, s[12:15], s53 offen offset:1024 sc1
  buffer_load_dwordx4 a[40:43], v4, s[12:15], s53 offen offset:2048 sc1
  buffer_load_dwordx4 a[44:47], v4, s[12:15], s53 offen offset:3072 sc1
  s_add_u32 s53, s53, 40960
  buffer_load_dwordx4 a[48:51], v4, s[12:15], s53 offen offset:0 sc1
  buffer_load_dwordx4 a[52:55], v4, s[12:15], s53 offen offset:1024 sc1
  buffer_load_dwordx4 a[56:59], v4, s[12:15], s53 offen offset:2048 sc1
  buffer_load_dwordx4 a[60:63], v4, s[12:15], s53 offen offset:3072 sc1
  s_add_u32 s53, s53, 40960
  buffer_load_dwordx4 a[64:67], v4, s[12:15], s53 offen offset:0 sc1
  buffer_load_dwordx4 a[68:71], v4, s[12:15], s53 offen offset:1024 sc1
  buffer_load_dwordx4 a[72:75], v4, s[12:15], s53 offen offset:2048 sc1
  buffer_load_dwordx4 a[76:79], v4, s[12:15], s53 offen offset:3072 sc1
  s_add_u32 s53, s53, 40960
  buffer_load_dwordx4 a[80:83], v4, s[12:15], s53 offen offset:0 sc1
  buffer_load_dwordx4 a[84:87], v4, s[12:15], s53 offen offset:1024 sc1
  buffer_load_dwordx4 a[88:91], v4, s[12:15], s53 offen offset:2048 sc1
  buffer_load_dwordx4 a[92:95], v4, s[12:15], s53 offen offset:3072 sc1
  s_add_u32 s53, s53, 40960
  buffer_load_dwordx4 a[96:99], v4, s[12:15], s53 offen offset:0 sc1
  buffer_load_dwordx4 a[100:103], v4, s[12:15], s53 offen offset:1024 sc1
  buffer_load_dwordx4 a[104:107], v4, s[12:15], s53 offen offset:2048 sc1
  buffer_load_dwordx4 a[108:111], v4, s[12:15], s53 offen offset:3072 sc1
  s_add_u32 s53, s53, 40960
  buffer_load_dwordx4 a[112:115], v4, s[12:15], s53 offen offset:0 sc1
  buffer_load_dwordx4 a[116:119], v4, s[12:15], s53 offen offset:1024 sc1
  buffer_load_dwordx4 a[120:123], v4, s[12:15], s53 offen offset:2048 sc1
  buffer_load_dwordx4 a[124:127], v4, s[12:15], s53 offen offset:3072 sc1
pvx_277:
  s_cmp_lg_u32 s20, 0
  s_cbranch_scc1 lc_278
  s_sub_u32 s21, s2, 450
  s_cmp_ge_u32 s21, 190
  s_cbranch_scc1 lc_278
  v_mov_b32 v29, 1
  s_mov_b64 exec, 1
  buffer_atomic_add v29, v28, s[32:35], 0 offen sc0 sc1
  s_mov_b64 exec, -1
lc_278:
  ds_write_b128 v10, v[144:147] offset:0
  ds_write_b128 v10, v[148:151] offset:1024
  ds_write_b128 v10, v[152:155] offset:2048
  ds_write_b128 v10, v[156:159] offset:3072
  ds_write_b128 v10, v[160:163] offset:4096
  ds_write_b128 v10, v[164:167] offset:5120
  ds_write_b128 v10, v[168:171] offset:6144
  ds_write_b128 v10, v[172:175] offset:7168
  s_cmp_lg_u32 s20, 0
  s_cbranch_scc1 pvq_281
  v_readfirstlane_b32 s21, v29
  s_mov_b32 s23, -1
  v_mov_b32 v213, s23
  s_mov_b64 exec, 1
  ds_write_b32 v30, v29
  ds_write_b32 v30, v213 offset:8
  s_mov_b64 exec, -1
pvq_281:
  s_waitcnt lgkmcnt(0)
  s_barrier
  ds_read_b128 v[176:179], v11 offset:0
  ds_read_b128 v[180:183], v11 offset:8192
  ds_read_b128 v[184:187], v11 offset:16384
  ds_read_b128 v[188:191], v11 offset:24576
  ds_read_b128 v[192:195], v11 offset:4096
  ds_read_b128 v[196:199], v11 offset:12288
  ds_read_b128 v[200:203], v11 offset:20480
  ds_read_b128 v[204:207], v11 offset:28672
  ds_read_b32 v23, v30
  ds_read_b32 v213, v30 offset:8
  s_cmp_ge_u32 s40, 32
  s_cbranch_scc1 pvr_284
  s_waitcnt lgkmcnt(6)
  v_pk_add_f32 v[176:177], v[176:177], v[180:181]
  v_pk_add_f32 v[184:185], v[184:185], v[188:189]
  v_pk_add_f32 v[178:179], v[178:179], v[182:183]
  v_pk_add_f32 v[186:187], v[186:187], v[190:191]
  v_pk_add_f32 v[176:177], v[176:177], v[184:185]
  v_pk_add_f32 v[178:179], v[178:179], v[186:187]
  buffer_store_dwordx4 v[176:179], v4, s[24:27], s54 offen offset:0 sc1
  s_waitcnt lgkmcnt(2)
  v_pk_add_f32 v[192:193], v[192:193], v[196:197]
  v_pk_add_f32 v[200:201], v[200:201], v[204:205]
  v_pk_add_f32 v[194:195], v[194:195], v[198:199]
  v_pk_add_f32 v[202:203], v[202:203], v[206:207]
  v_pk_add_f32 v[192:193], v[192:193], v[200:201]
  v_pk_add_f32 v[194:195], v[194:195], v[202:203]
  buffer_store_dwordx4 v[192:195], v4, s[24:27], s54 offen offset:2048 sc1
  s_lshr_b32 s71, s40, 2
  s_lshl_b32 s71, s71, 7
  s_add_u32 s71, s71, 104448
  s_branch pvr_285
pvr_284:
  s_waitcnt lgkmcnt(6)
  v_pk_add_f32 v[176:177], v[176:177], v[180:181]
  v_pk_add_f32 v[184:185], v[184:185], v[188:189]
  v_pk_add_f32 v[178:179], v[178:179], v[182:183]
  v_pk_add_f32 v[186:187], v[186:187], v[190:191]
  v_pk_add_f32 v[176:177], v[176:177], v[184:185]
  v_pk_add_f32 v[178:179], v[178:179], v[186:187]
  v_cvt_pk_bf16_f32 v26, v176, v177
  v_lshlrev_b32 v176, 16, v26
  v_and_b32 v177, 0xffff0000, v26
  v_mul_f32 v176, v176, v24
  v_mul_f32 v177, v177, v24
  v_cvt_pk_bf16_f32 v26, v176, v177
  v_lshlrev_b32 v176, 16, v26
  v_and_b32 v177, 0xffff0000, v26
  v_add_f32 v176, v176, v12
  v_add_f32 v177, v177, v13
  v_cvt_pk_bf16_f32 v180, v176, v177
  v_cvt_pk_bf16_f32 v26, v178, v179
  v_lshlrev_b32 v178, 16, v26
  v_and_b32 v179, 0xffff0000, v26
  v_mul_f32 v178, v178, v24
  v_mul_f32 v179, v179, v24
  v_cvt_pk_bf16_f32 v26, v178, v179
  v_lshlrev_b32 v178, 16, v26
  v_and_b32 v179, 0xffff0000, v26
  v_add_f32 v178, v178, v14
  v_add_f32 v179, v179, v15
  v_cvt_pk_bf16_f32 v181, v178, v179
  buffer_store_dwordx2 v[180:181], v9, s[8:11], s46 offen offset:0
  s_waitcnt lgkmcnt(2)
  v_pk_add_f32 v[192:193], v[192:193], v[196:197]
  v_pk_add_f32 v[200:201], v[200:201], v[204:205]
  v_pk_add_f32 v[194:195], v[194:195], v[198:199]
  v_pk_add_f32 v[202:203], v[202:203], v[206:207]
  v_pk_add_f32 v[192:193], v[192:193], v[200:201]
  v_pk_add_f32 v[194:195], v[194:195], v[202:203]
  v_cvt_pk_bf16_f32 v26, v192, v193
  v_lshlrev_b32 v192, 16, v26
  v_and_b32 v193, 0xffff0000, v26
  v_mul_f32 v192, v192, v24
  v_mul_f32 v193, v193, v24
  v_cvt_pk_bf16_f32 v26, v192, v193
  v_lshlrev_b32 v192, 16, v26
  v_and_b32 v193, 0xffff0000, v26
  v_add_f32 v192, v192, v16
  v_add_f32 v193, v193, v17
  v_cvt_pk_bf16_f32 v196, v192, v193
  v_cvt_pk_bf16_f32 v26, v194, v195
  v_lshlrev_b32 v194, 16, v26
  v_and_b32 v195, 0xffff0000, v26
  v_mul_f32 v194, v194, v24
  v_mul_f32 v195, v195, v24
  v_cvt_pk_bf16_f32 v26, v194, v195
  v_lshlrev_b32 v194, 16, v26
  v_and_b32 v195, 0xffff0000, v26
  v_add_f32 v194, v194, v18
  v_add_f32 v195, v195, v19
  v_cvt_pk_bf16_f32 v197, v194, v195
  buffer_store_dwordx2 v[196:197], v9, s[8:11], s46 offen offset:64
pvr_285:
pvy_286:
  s_cmp_eq_u32 s65, 0
  s_cbranch_scc1 pvy_287
  s_sub_u32 s65, s65, 1
  s_add_u32 s46, s46, 128
  s_add_u32 s54, s54, 4096
  s_cmp_lt_u32 s40, 32
  s_cselect_b32 s70, 0x80000000, s54
  buffer_load_dwordx4 v[12:15], v4, s[24:27], s70 offen sc1
  buffer_load_dwordx4 v[16:19], v4, s[24:27], s70 offen offset:2048 sc1
  buffer_load_dword v24, v6, s[28:31], s45 offen sc1
  s_waitcnt vmcnt(37) lgkmcnt(0)
  s_barrier
  s_nop 1
  v_mfma_f32_16x16x32_bf16 v[144:147], v[32:35], v[128:131], 0
  v_mfma_f32_16x16x32_bf16 v[148:151], v[32:35], v[132:135], 0
  v_mfma_f32_16x16x32_bf16 v[152:155], v[36:39], v[128:131], 0
  v_mfma_f32_16x16x32_bf16 v[156:159], v[36:39], v[132:135], 0
  v_mfma_f32_16x16x32_bf16 v[160:163], v[40:43], v[128:131], 0
  v_mfma_f32_16x16x32_bf16 v[164:167], v[40:43], v[132:135], 0
  v_mfma_f32_16x16x32_bf16 v[168:171], v[44:47], v[128:131], 0
  v_mfma_f32_16x16x32_bf16 v[172:175], v[44:47], v[132:135], 0
  v_mfma_f32_16x16x32_bf16 v[144:147], v[48:51], v[136:139], v[144:147]
  v_mfma_f32_16x16x32_bf16 v[148:151], v[48:51], v[140:143], v[148:151]
  v_mfma_f32_16x16x32_bf16 v[152:155], v[52:55], v[136:139], v[152:155]
  v_mfma_f32_16x16x32_bf16 v[156:159], v[52:55], v[140:143], v[156:159]
  v_mfma_f32_16x16x32_bf16 v[160:163], v[56:59], v[136:139], v[160:163]
  v_mfma_f32_16x16x32_bf16 v[164:167], v[56:59], v[140:143], v[164:167]
  v_mfma_f32_16x16x32_bf16 v[168:171], v[60:63], v[136:139], v[168:171]
  v_mfma_f32_16x16x32_bf16 v[172:175], v[60:63], v[140:143], v[172:175]
  s_waitcnt vmcnt(33)
  v_mfma_f32_16x16x32_bf16 v[148:151], a[0:3], v[64:67], v[148:151]
  v_mfma_f32_16x16x32_bf16 v[144:147], a[0:3], v[68:71], v[144:147]
  v_mfma_f32_16x16x32_bf16 v[156:159], a[4:7], v[64:67], v[156:159]
  v_mfma_f32_16x16x32_bf16 v[152:155], a[4:7], v[68:71], v[152:155]
  v_mfma_f32_16x16x32_bf16 v[164:167], a[8:11], v[64:67], v[164:167]
  v_mfma_f32_16x16x32_bf16 v[160:163], a[8:11], v[68:71], v[160:163]
  v_mfma_f32_16x16x32_bf16 v[172:175], a[12:15], v[64:67], v[172:175]
  v_mfma_f32_16x16x32_bf16 v[168:171], a[12:15], v[68:71], v[168:171]
  s_waitcnt vmcnt(29)
  v_mfma_f32_16x16x32_bf16 v[148:151], a[16:19], v[72:75], v[148:151]
  v_mfma_f32_16x16x32_bf16 v[144:147], a[16:19], v[76:79], v[144:147]
  v_mfma_f32_16x16x32_bf16 v[156:159], a[20:23], v[72:75], v[156:159]
  v_mfma_f32_16x16x32_bf16 v[152:155], a[20:23], v[76:79], v[152:155]
  v_mfma_f32_16x16x32_bf16 v[164:167], a[24:27], v[72:75], v[164:167]
  v_mfma_f32_16x16x32_bf16 v[160:163], a[24:27], v[76:79], v[160:163]
  v_mfma_f32_16x16x32_bf16 v[172:175], a[28:31], v[72:75], v[172:175]
  v_mfma_f32_16x16x32_bf16 v[168:171], a[28:31], v[76:79], v[168:171]
  s_waitcnt vmcnt(25)
  v_mfma_f32_16x16x32_bf16 v[148:151], a[32:35], v[80:83], v[148:151]
  v_mfma_f32_16x16x32_bf16 v[144:147], a[32:35], v[84:87], v[144:147]
  v_mfma_f32_16x16x32_bf16 v[156:159], a[36:39], v[80:83], v[156:159]
  v_mfma_f32_16x16x32_bf16 v[152:155], a[36:39], v[84:87], v[152:155]
  v_mfma_f32_16x16x32_bf16 v[164:167], a[40:43], v[80:83], v[164:167]
  v_mfma_f32_16x16x32_bf16 v[160:163], a[40:43], v[84:87], v[160:163]
  v_mfma_f32_16x16x32_bf16 v[172:175], a[44:47], v[80:83], v[172:175]
  v_mfma_f32_16x16x32_bf16 v[168:171], a[44:47], v[84:87], v[168:171]
  s_waitcnt vmcnt(21)
  v_mfma_f32_16x16x32_bf16 v[148:151], a[48:51], v[88:91], v[148:151]
  v_mfma_f32_16x16x32_bf16 v[144:147], a[48:51], v[92:95], v[144:147]
  v_mfma_f32_16x16x32_bf16 v[156:159], a[52:55], v[88:91], v[156:159]
  v_mfma_f32_16x16x32_bf16 v[152:155], a[52:55], v[92:95], v[152:155]
  v_mfma_f32_16x16x32_bf16 v[164:167], a[56:59], v[88:91], v[164:167]
  v_mfma_f32_16x16x32_bf16 v[160:163], a[56:59], v[92:95], v[160:163]
  v_mfma_f32_16x16x32_bf16 v[172:175], a[60:63], v[88:91], v[172:175]
  v_mfma_f32_16x16x32_bf16 v[168:171], a[60:63], v[92:95], v[168:171]
  s_waitcnt vmcnt(17)
  v_mfma_f32_16x16x32_bf16 v[148:151], a[64:67], v[96:99], v[148:151]
  v_mfma_f32_16x16x32_bf16 v[144:147], a[64:67], v[100:103], v[144:147]
  v_mfma_f32_16x16x32_bf16 v[156:159], a[68:71], v[96:99], v[156:159]
  v_mfma_f32_16x16x32_bf16 v[152:155], a[68:71], v[100:103], v[152:155]
  v_mfma_f32_16x16x32_bf16 v[164:167], a[72:75], v[96:99], v[164:167]
  v_mfma_f32_16x16x32_bf16 v[160:163], a[72:75], v[100:103], v[160:163]
  v_mfma_f32_16x16x32_bf16 v[172:175], a[76:79], v[96:99], v[172:175]
  v_mfma_f32_16x16x32_bf16 v[168:171], a[76:79], v[100:103], v[168:171]
  s_waitcnt vmcnt(13)
  v_mfma_f32_16x16x32_bf16 v[148:151], a[80:83], v[104:107], v[148:151]
  v_mfma_f32_16x16x32_bf16 v[144:147], a[80:83], v[108:111], v[144:147]
  v_mfma_f32_16x16x32_bf16 v[156:159], a[84:87], v[104:107], v[156:159]
  v_mfma_f32_16x16x32_bf16 v[152:155], a[84:87], v[108:111], v[152:155]
  v_mfma_f32_16x16x32_bf16 v[164:167], a[88:91], v[104:107], v[164:167]
  v_mfma_f32_16x16x32_bf16 v[160:163], a[88:91], v[108:111], v[160:163]
  v_mfma_f32_16x16x32_bf16 v[172:175], a[92:95], v[104:107], v[172:175]
  v_mfma_f32_16x16x32_bf16 v[168:171], a[92:95], v[108:111], v[168:171]
  s_waitcnt vmcnt(9)
  v_mfma_f32_16x16x32_bf16 v[148:151], a[96:99], v[112:115], v[148:151]
  v_mfma_f32_16x16x32_bf16 v[144:147], a[96:99], v[116:119], v[144:147]
  v_mfma_f32_16x16x32_bf16 v[156:159], a[100:103], v[112:115], v[156:159]
  v_mfma_f32_16x16x32_bf16 v[152:155], a[100:103], v[116:119], v[152:155]
  v_mfma_f32_16x16x32_bf16 v[164:167], a[104:107], v[112:115], v[164:167]
  v_mfma_f32_16x16x32_bf16 v[160:163], a[104:107], v[116:119], v[160:163]
  v_mfma_f32_16x16x32_bf16 v[172:175], a[108:111], v[112:115], v[172:175]
  v_mfma_f32_16x16x32_bf16 v[168:171], a[108:111], v[116:119], v[168:171]
  s_waitcnt vmcnt(5)
  v_mfma_f32_16x16x32_bf16 v[148:151], a[112:115], v[120:123], v[148:151]
  v_mfma_f32_16x16x32_bf16 v[144:147], a[112:115], v[124:127], v[144:147]
  v_mfma_f32_16x16x32_bf16 v[156:159], a[116:119], v[120:123], v[156:159]
  v_mfma_f32_16x16x32_bf16 v[152:155], a[116:119], v[124:127], v[152:155]
  v_mfma_f32_16x16x32_bf16 v[164:167], a[120:123], v[120:123], v[164:167]
  v_mfma_f32_16x16x32_bf16 v[160:163], a[120:123], v[124:127], v[160:163]
  v_mfma_f32_16x16x32_bf16 v[172:175], a[124:127], v[120:123], v[172:175]
  v_mfma_f32_16x16x32_bf16 v[168:171], a[124:127], v[124:127], v[168:171]
  s_waitcnt vmcnt(0)
  v_sub_f32 v25, 1.0, v24
  v_cvt_pk_bf16_f32 v26, v25, v25
  v_lshlrev_b32 v25, 16, v26
  v_cvt_pk_bf16_f32 v26, v12, v12
  v_lshlrev_b32 v12, 16, v26
  v_cvt_pk_bf16_f32 v26, v13, v13
  v_lshlrev_b32 v13, 16, v26
  v_cvt_pk_bf16_f32 v26, v14, v14
  v_lshlrev_b32 v14, 16, v26
  v_cvt_pk_bf16_f32 v26, v15, v15
  v_lshlrev_b32 v15, 16, v26
  v_cvt_pk_bf16_f32 v26, v16, v16
  v_lshlrev_b32 v16, 16, v26
  v_cvt_pk_bf16_f32 v26, v17, v17
  v_lshlrev_b32 v17, 16, v26
  v_cvt_pk_bf16_f32 v26, v18, v18
  v_lshlrev_b32 v18, 16, v26
  v_cvt_pk_bf16_f32 v26, v19, v19
  v_lshlrev_b32 v19, 16, v26
  v_mul_f32 v12, v12, v25
  v_cvt_pk_bf16_f32 v26, v12, v12
  v_lshlrev_b32 v12, 16, v26
  v_mul_f32 v13, v13, v25
  v_cvt_pk_bf16_f32 v26, v13, v13
  v_lshlrev_b32 v13, 16, v26
  v_mul_f32 v14, v14, v25
  v_cvt_pk_bf16_f32 v26, v14, v14
  v_lshlrev_b32 v14, 16, v26
  v_mul_f32 v15, v15, v25
  v_cvt_pk_bf16_f32 v26, v15, v15
  v_lshlrev_b32 v15, 16, v26
  v_mul_f32 v16, v16, v25
  v_cvt_pk_bf16_f32 v26, v16, v16
  v_lshlrev_b32 v16, 16, v26
  v_mul_f32 v17, v17, v25
  v_cvt_pk_bf16_f32 v26, v17, v17
  v_lshlrev_b32 v17, 16, v26
  v_mul_f32 v18, v18, v25
  v_cvt_pk_bf16_f32 v26, v18, v18
  v_lshlrev_b32 v18, 16, v26
  v_mul_f32 v19, v19, v25
  v_cvt_pk_bf16_f32 v26, v19, v19
  v_lshlrev_b32 v19, 16, v26
  s_cmp_eq_u32 s65, 0
  s_cbranch_scc1 pvx_288
  s_add_u32 s41, s41, 1
  s_mul_i32 s53, s42, 40960
  s_lshl_b32 s22, s41, 12
  s_add_u32 s53, s53, s22
  s_mul_i32 s48, s42, 10240
  s_lshl_b32 s22, s41, 10
  s_add_u32 s48, s48, s22
  s_add_u32 s48, s48, 7340032
  buffer_load_dwordx4 v[32:35], v22, s[16:19], s48 offen offset:0 sc1
  buffer_load_dwordx4 v[36:39], v22, s[16:19], s48 offen offset:256 sc1
  buffer_load_dwordx4 v[40:43], v22, s[16:19], s48 offen offset:512 sc1
  buffer_load_dwordx4 v[44:47], v22, s[16:19], s48 offen offset:768 sc1
  s_add_u32 s48, s48, 40960
  buffer_load_dwordx4 v[48:51], v22, s[16:19], s48 offen offset:0 sc1
  buffer_load_dwordx4 v[52:55], v22, s[16:19], s48 offen offset:256 sc1
  buffer_load_dwordx4 v[56:59], v22, s[16:19], s48 offen offset:512 sc1
  buffer_load_dwordx4 v[60:63], v22, s[16:19], s48 offen offset:768 sc1
  s_add_u32 s48, s48, 40960
  buffer_load_dwordx4 a[0:3], v4, s[12:15], s53 offen offset:0 sc1
  buffer_load_dwordx4 a[4:7], v4, s[12:15], s53 offen offset:1024 sc1
  buffer_load_dwordx4 a[8:11], v4, s[12:15], s53 offen offset:2048 sc1
  buffer_load_dwordx4 a[12:15], v4, s[12:15], s53 offen offset:3072 sc1
  s_add_u32 s53, s53, 40960
  buffer_load_dwordx4 a[16:19], v4, s[12:15], s53 offen offset:0 sc1
  buffer_load_dwordx4 a[20:23], v4, s[12:15], s53 offen offset:1024 sc1
  buffer_load_dwordx4 a[24:27], v4, s[12:15], s53 offen offset:2048 sc1
  buffer_load_dwordx4 a[28:31], v4, s[12:15], s53 offen offset:3072 sc1
  s_add_u32 s53, s53, 40960
  buffer_load_dwordx4 a[32:35], v4, s[12:15], s53 offen offset:0 sc1
  buffer_load_dwordx4 a[36:39], v4, s[12:15], s53 offen offset:1024 sc1
  buffer_load_dwordx4 a[40:43], v4, s[12:15], s53 offen offset:2048 sc1
  buffer_load_dwordx4 a[44:47], v4, s[12:15], s53 offen offset:3072 sc1
  s_add_u32 s53, s53, 40960
  buffer_load_dwordx4 a[48:51], v4, s[12:15], s53 offen offset:0 sc1
  buffer_load_dwordx4 a[52:55], v4, s[12:15], s53 offen offset:1024 sc1
  buffer_load_dwordx4 a[56:59], v4, s[12:15], s53 offen offset:2048 sc1
  buffer_load_dwordx4 a[60:63], v4, s[12:15], s53 offen offset:3072 sc1
  s_add_u32 s53, s53, 40960
  buffer_load_dwordx4 a[64:67], v4, s[12:15], s53 offen offset:0 sc1
  buffer_load_dwordx4 a[68:71], v4, s[12:15], s53 offen offset:1024 sc1
  buffer_load_dwordx4 a[72:75], v4, s[12:15], s53 offen offset:2048 sc1
  buffer_load_dwordx4 a[76:79], v4, s[12:15], s53 offen offset:3072 sc1
  s_add_u32 s53, s53, 40960
  buffer_load_dwordx4 a[80:83], v4, s[12:15], s53 offen offset:0 sc1
  buffer_load_dwordx4 a[84:87], v4, s[12:15], s53 offen offset:1024 sc1
  buffer_load_dwordx4 a[88:91], v4, s[12:15], s53 offen offset:2048 sc1
  buffer_load_dwordx4 a[92:95], v4, s[12:15], s53 offen offset:3072 sc1
  s_add_u32 s53, s53, 40960
  buffer_load_dwordx4 a[96:99], v4, s[12:15], s53 offen offset:0 sc1
  buffer_load_dwordx4 a[100:103], v4, s[12:15], s53 offen offset:1024 sc1
  buffer_load_dwordx4 a[104:107], v4, s[12:15], s53 offen offset:2048 sc1
  buffer_load_dwordx4 a[108:111], v4, s[12:15], s53 offen offset:3072 sc1
  s_add_u32 s53, s53, 40960
  buffer_load_dwordx4 a[112:115], v4, s[12:15], s53 offen offset:0 sc1
  buffer_load_dwordx4 a[116:119], v4, s[12:15], s53 offen offset:1024 sc1
  buffer_load_dwordx4 a[120:123], v4, s[12:15], s53 offen offset:2048 sc1
  buffer_load_dwordx4 a[124:127], v4, s[12:15], s53 offen offset:3072 sc1
pvx_288:
  ds_write_b128 v10, v[144:147] offset:0
  ds_write_b128 v10, v[148:151] offset:1024
  ds_write_b128 v10, v[152:155] offset:2048
  ds_write_b128 v10, v[156:159] offset:3072
  ds_write_b128 v10, v[160:163] offset:4096
  ds_write_b128 v10, v[164:167] offset:5120
  ds_write_b128 v10, v[168:171] offset:6144
  ds_write_b128 v10, v[172:175] offset:7168
  s_waitcnt lgkmcnt(0)
  s_barrier
  ds_read_b128 v[176:179], v11 offset:0
  ds_read_b128 v[180:183], v11 offset:8192
  ds_read_b128 v[184:187], v11 offset:16384
  ds_read_b128 v[188:191], v11 offset:24576
  ds_read_b128 v[192:195], v11 offset:4096
  ds_read_b128 v[196:199], v11 offset:12288
  ds_read_b128 v[200:203], v11 offset:20480
  ds_read_b128 v[204:207], v11 offset:28672
  s_cmp_ge_u32 s40, 32
  s_cbranch_scc1 pvr_289
  s_waitcnt lgkmcnt(4)
  v_pk_add_f32 v[176:177], v[176:177], v[180:181]
  v_pk_add_f32 v[184:185], v[184:185], v[188:189]
  v_pk_add_f32 v[178:179], v[178:179], v[182:183]
  v_pk_add_f32 v[186:187], v[186:187], v[190:191]
  v_pk_add_f32 v[176:177], v[176:177], v[184:185]
  v_pk_add_f32 v[178:179], v[178:179], v[186:187]
  buffer_store_dwordx4 v[176:179], v4, s[24:27], s54 offen offset:0 sc1
  s_waitcnt lgkmcnt(0)
  v_pk_add_f32 v[192:193], v[192:193], v[196:197]
  v_pk_add_f32 v[200:201], v[200:201], v[204:205]
  v_pk_add_f32 v[194:195], v[194:195], v[198:199]
  v_pk_add_f32 v[202:203], v[202:203], v[206:207]
  v_pk_add_f32 v[192:193], v[192:193], v[200:201]
  v_pk_add_f32 v[194:195], v[194:195], v[202:203]
  buffer_store_dwordx4 v[192:195], v4, s[24:27], s54 offen offset:2048 sc1
  s_lshr_b32 s71, s40, 2
  s_lshl_b32 s71, s71, 7
  s_add_u32 s71, s71, 104448
  s_branch pvr_290
pvr_289:
  s_waitcnt lgkmcnt(4)
  v_pk_add_f32 v[176:177], v[176:177], v[180:181]
  v_pk_add_f32 v[184:185], v[184:185], v[188:189]
  v_pk_add_f32 v[178:179], v[178:179], v[182:183]
  v_pk_add_f32 v[186:187], v[186:187], v[190:191]
  v_pk_add_f32 v[176:177], v[176:177], v[184:185]
  v_pk_add_f32 v[178:179], v[178:179], v[186:187]
  v_cvt_pk_bf16_f32 v26, v176, v177
  v_lshlrev_b32 v176, 16, v26
  v_and_b32 v177, 0xffff0000, v26
  v_mul_f32 v176, v176, v24
  v_mul_f32 v177, v177, v24
  v_cvt_pk_bf16_f32 v26, v176, v177
  v_lshlrev_b32 v176, 16, v26
  v_and_b32 v177, 0xffff0000, v26
  v_add_f32 v176, v176, v12
  v_add_f32 v177, v177, v13
  v_cvt_pk_bf16_f32 v180, v176, v177
  v_cvt_pk_bf16_f32 v26, v178, v179
  v_lshlrev_b32 v178, 16, v26
  v_and_b32 v179, 0xffff0000, v26
  v_mul_f32 v178, v178, v24
  v_mul_f32 v179, v179, v24
  v_cvt_pk_bf16_f32 v26, v178, v179
  v_lshlrev_b32 v178, 16, v26
  v_and_b32 v179, 0xffff0000, v26
  v_add_f32 v178, v178, v14
  v_add_f32 v179, v179, v15
  v_cvt_pk_bf16_f32 v181, v178, v179
  buffer_store_dwordx2 v[180:181], v9, s[8:11], s46 offen offset:0
  s_waitcnt lgkmcnt(0)
  v_pk_add_f32 v[192:193], v[192:193], v[196:197]
  v_pk_add_f32 v[200:201], v[200:201], v[204:205]
  v_pk_add_f32 v[194:195], v[194:195], v[198:199]
  v_pk_add_f32 v[202:203], v[202:203], v[206:207]
  v_pk_add_f32 v[192:193], v[192:193], v[200:201]
  v_pk_add_f32 v[194:195], v[194:195], v[202:203]
  v_cvt_pk_bf16_f32 v26, v192, v193
  v_lshlrev_b32 v192, 16, v26
  v_and_b32 v193, 0xffff0000, v26
  v_mul_f32 v192, v192, v24
  v_mul_f32 v193, v193, v24
  v_cvt_pk_bf16_f32 v26, v192, v193
  v_lshlrev_b32 v192, 16, v26
  v_and_b32 v193, 0xffff0000, v26
  v_add_f32 v192, v192, v16
  v_add_f32 v193, v193, v17
  v_cvt_pk_bf16_f32 v196, v192, v193
  v_cvt_pk_bf16_f32 v26, v194, v195
  v_lshlrev_b32 v194, 16, v26
  v_and_b32 v195, 0xffff0000, v26
  v_mul_f32 v194, v194, v24
  v_mul_f32 v195, v195, v24
  v_cvt_pk_bf16_f32 v26, v194, v195
  v_lshlrev_b32 v194, 16, v26
  v_and_b32 v195, 0xffff0000, v26
  v_add_f32 v194, v194, v18
  v_add_f32 v195, v195, v19
  v_cvt_pk_bf16_f32 v197, v194, v195
  buffer_store_dwordx2 v[196:197], v9, s[8:11], s46 offen offset:64
pvr_290:
  s_branch pvy_286
pvy_287:
  s_sub_u32 s21, s2, 450
  s_cmp_ge_u32 s21, 190
  s_cbranch_scc1 lc_291
  s_cmp_lg_u32 s20, 0
  s_cbranch_scc1 lc_291x
  s_waitcnt vmcnt(2)
  s_mov_b64 exec, 1
  ds_write_b32 v30, v29 offset:12
  s_mov_b64 exec, -1
lc_291x:
  s_waitcnt lgkmcnt(0)
  s_barrier
  ds_read_b32 v23, v30 offset:12
lc_291:
  s_waitcnt lgkmcnt(0)
  v_readfirstlane_b32 s2, v23
  v_readfirstlane_b32 s67, v213
  s_barrier
  s_cmp_lt_u32 s2, 334
  s_cbranch_scc1 pae_292
  s_waitcnt vmcnt(0)
  s_cmp_eq_u32 s71, 0
  s_cbranch_scc1 paf_293
  v_mov_b32 v25, 0
  v_mov_b32 v26, 1
  s_mov_b64 exec, 1
  buffer_atomic_add v26, v25, s[72:75], s71 offen sc1
  s_mov_b64 exec, -1
  s_mov_b32 s71, 0
paf_293:
pae_292:
  s_add_u32 s21, s2, 0
  s_cmp_lt_u32 s2, 334
  s_cbranch_scc1 pv_loop
  s_sub_u32 s2, s2, 334
  s_branch main_fin
  s_branch queue
main_fin:
  s_waitcnt vmcnt(0)
main_end:
  s_endpgm
code_end:
.section .rodata,"a"
.p2align 6
.amdhsa_kernel gated_mix__memory_aug_recurrent_mem_tr__sliding_local_dilated__prompt_kernel
  .amdhsa_next_free_vgpr 512
  .amdhsa_next_free_sgpr 102
  .amdhsa_accum_offset 256
  .amdhsa_group_segment_fixed_size 0
  .amdhsa_kernarg_size 112
  .amdhsa_user_sgpr_count 2
  .amdhsa_user_sgpr_kernarg_segment_ptr 1
  .amdhsa_system_sgpr_workgroup_id_x 1
.end_amdhsa_kernel
.text
```

```asm
; @launch kernel=gated_mix__memory_aug_recurrent_mem_tr__sliding_local_dilated__prompt_kernel grid=(256,1,1) block=(256,1,1) lds=163840
.amdgcn_target "amdgcn-amd-amdhsa--gfx950"
.text
.globl gated_mix__memory_aug_recurrent_mem_tr__sliding_local_dilated__prompt_kernel
.p2align 8
.type gated_mix__memory_aug_recurrent_mem_tr__sliding_local_dilated__prompt_kernel,@function
gated_mix__memory_aug_recurrent_mem_tr__sliding_local_dilated__prompt_kernel:
  s_cmp_ge_u32 s2, 256
  s_cbranch_scc1 end0
  s_load_dwordx2 s[4:5], s[0:1], 96
  s_load_dwordx2 s[38:39], s[0:1], 104
  v_lshrrev_b32 v1, 6, v0
  v_and_b32 v2, 15, v0
  v_readfirstlane_b32 s20, v1
  v_and_b32 v1, 63, v0
  v_lshrrev_b32 v3, 4, v1
  s_getreg_b32 s50, hwreg(HW_REG_XCC_ID)
  s_and_b32 s50, s50, 7
  s_waitcnt lgkmcnt(0)
  s_mov_b32 s32, s4
  s_mov_b32 s33, s5
  s_mov_b32 s34, 256
  s_mov_b32 s35, 0x00020000
  s_getpc_b64 s[6:7]
cpf_pc:
  s_sub_u32 s6, s6, cpf_pc - gated_mix__memory_aug_recurrent_mem_tr__sliding_local_dilated__prompt_kernel
  s_subb_u32 s7, s7, 0
  s_lshr_b32 s21, s2, 3
  s_lshl_b32 s21, s21, 12
  v_lshl_add_u32 v28, v0, 4, s21
  v_min_u32 v28, code_end - gated_mix__memory_aug_recurrent_mem_tr__sliding_local_dilated__prompt_kernel - 16, v28
  global_load_dwordx4 a[252:255], v28, s[6:7]
  v_mov_b32 v21, 0
  s_cmp_lg_u32 s20, 0
  s_cbranch_scc1 rk_1
  s_and_b32 s21, s50, 1
  s_lshl_b32 s21, s21, 7
  s_lshl_b32 s22, s50, 1
  s_and_b32 s22, s22, 12
  s_add_u32 s21, s21, s22
  v_mov_b32 v22, s21
  v_mov_b32 v23, 1
  s_mov_b64 exec, 1
  buffer_atomic_add v23, v22, s[32:35], 0 offen sc0 sc1
  s_waitcnt vmcnt(0)
  v_readfirstlane_b32 s51, v23
  s_lshl_b32 s22, s50, 5
  s_add_u32 s22, s22, s51
  s_cmp_lt_u32 s51, 32
  s_cbranch_scc1 rk_2
  v_mov_b32 v24, 72
  v_mov_b32 v25, 1
  buffer_atomic_add v25, v24, s[32:35], 0 offen sc0 sc1
  s_waitcnt vmcnt(0)
  v_readfirstlane_b32 s23, v25
  s_mov_b32 s101, 0
  s_mov_b64 exec, -1
  v_lshlrev_b32 v24, 2, v1
rk_3:
  s_sleep 8
  buffer_load_dword v25, v24, s[32:35], 0 offen sc1
  s_add_u32 s101, s101, 1
  s_cmp_gt_u32 s101, 131072
  s_cbranch_scc1 end0
  s_waitcnt vmcnt(0)
  v_readlane_b32 s21, v25, 0
  v_readlane_b32 s22, v25, 32
  s_add_u32 s21, s21, s22
  v_readlane_b32 s22, v25, 1
  s_add_u32 s21, s21, s22
  v_readlane_b32 s22, v25, 33
  s_add_u32 s21, s21, s22
  v_readlane_b32 s22, v25, 2
  s_add_u32 s21, s21, s22
  v_readlane_b32 s22, v25, 34
  s_add_u32 s21, s21, s22
  v_readlane_b32 s22, v25, 3
  s_add_u32 s21, s21, s22
  v_readlane_b32 s22, v25, 35
  s_add_u32 s21, s21, s22
  s_cmp_lt_u32 s21, 256
  s_cbranch_scc1 rk_3
  s_mov_b64 exec, 1
  s_mov_b32 s24, 0
rk_5:
  s_and_b32 s21, s24, 1
  s_lshl_b32 s21, s21, 5
  s_lshr_b32 s22, s24, 1
  s_add_u32 s21, s21, s22
  v_readlane_b32 s21, v25, s21
  s_min_u32 s21, s21, 32
  s_sub_u32 s25, 32, s21
  s_cmp_lt_u32 s23, s25
  s_cbranch_scc1 rk_4
  s_sub_u32 s23, s23, s25
  s_add_u32 s24, s24, 1
  s_cmp_lt_u32 s24, 8
  s_cbranch_scc1 rk_5
  s_branch end0
rk_4:
  s_lshl_b32 s22, s24, 5
  s_add_u32 s22, s22, s21
  s_add_u32 s22, s22, s23
  s_or_b32 s22, s22, 0x100
rk_2:
  v_mov_b32 v23, s22
  ds_write_b32 v21, v23
  s_waitcnt lgkmcnt(0)
  s_mov_b64 exec, -1
rk_1:
  s_barrier
  ds_read_b32 v23, v21
  s_waitcnt lgkmcnt(0)
  v_readfirstlane_b32 s22, v23
  s_barrier
  s_mov_b32 s84, 0
  s_mov_b32 s85, -1

  s_lshr_b32 s53, s22, 8
  s_and_b32 s22, s22, 255
  s_cmp_ge_u32 s22, 128
  s_cbranch_scc1 gemm_side
  s_lshr_b32 s50, s22, 4
  s_and_b32 s51, s22, 15
  s_mov_b32 s86, 0x3dd53b95
  s_load_dwordx2 s[4:5], s[0:1], 8
  s_load_dwordx4 s[36:39], s[0:1], 16
  s_load_dwordx4 s[40:43], s[0:1], 32
  s_load_dwordx2 s[44:45], s[0:1], 104
  s_lshr_b32 s55, s51, 2
  s_and_b32 s56, s51, 3
  s_lshl_b32 s57, s50, 2
  s_add_u32 s58, s57, s55
  s_add_u32 s59, s57, s20
  s_lshr_b32 s21, s51, 1
  s_xor_b32 s21, s21, s55
  s_andn2_b32 s21, 1, s21
  s_xor_b32 s85, s51, s21
  s_xor_b32 s84, s56, 1
  s_mul_i32 s87, s85, 5
  s_lshr_b32 s87, s87, 1
  s_and_b32 s79, s85, 1
  s_waitcnt lgkmcnt(0)
  s_add_u32 s8, s44, 78643200
  s_addc_u32 s9, s45, 0
  s_mov_b32 s10, 2162688
  s_mov_b32 s11, 0x00020000
  s_mov_b32 s16, s44
  s_mov_b32 s17, s45
  s_mov_b32 s18, 50331648
  s_mov_b32 s19, 0x00020000
  s_add_u32 s24, s44, 50331648
  s_addc_u32 s25, s45, 0
  s_mov_b32 s26, 63963136
  s_mov_b32 s27, 0x00020000
  s_mov_b32 s28, s4
  s_mov_b32 s29, s5
  s_mov_b32 s30, 10240
  s_mov_b32 s31, 0x00020000
  s_add_u32 s4, s44, 83886079
  s_addc_u32 s5, s45, 0
  s_and_b32 s4, s4, 0xffe00000
  s_mov_b32 s6, 2097152
  s_mov_b32 s7, 0x00020000
  v_mov_b32 v27, 10923
  v_add_u32 v103, 0, v1
  v_mul_u32_u24 v102, v103, v27
  v_lshrrev_b32 v102, 16, v102
  v_mul_u32_u24 v101, 6, v102
  v_sub_u32 v103, v103, v101
  v_bfe_u32 v101, v102, 1, 1
  v_mul_u32_u24 v101, 20, v101
  v_and_b32 v100, 1, v102
  v_add_u32 v101, v101, v100
  v_lshrrev_b32 v100, 3, v102
  v_mul_u32_u24 v100, 40, v100
  v_bfe_u32 v99, v102, 2, 1
  v_lshl_add_u32 v100, v99, 1, v100
  v_add_u32 v100, v100, v101
  v_mul_u32_u24 v100, 12288, v100
  v_lshl_add_u32 v46, v103, 4, v100
  v_lshrrev_b32 v100, 4, v102
  v_mul_u32_u24 v100, 40, v100
  v_bfe_u32 v99, v102, 2, 2
  v_lshl_add_u32 v100, v99, 1, v100
  v_add_u32 v100, v100, v101
  v_mul_u32_u24 v100, 12288, v100
  v_lshl_add_u32 v96, v103, 4, v100
  v_add_u32 v103, 64, v1
  v_mul_u32_u24 v102, v103, v27
  v_lshrrev_b32 v102, 16, v102
  v_mul_u32_u24 v101, 6, v102
  v_sub_u32 v103, v103, v101
  v_bfe_u32 v101, v102, 1, 1
  v_mul_u32_u24 v101, 20, v101
  v_and_b32 v100, 1, v102
  v_add_u32 v101, v101, v100
  v_lshrrev_b32 v100, 3, v102
  v_mul_u32_u24 v100, 40, v100
  v_bfe_u32 v99, v102, 2, 1
  v_lshl_add_u32 v100, v99, 1, v100
  v_add_u32 v100, v100, v101
  v_mul_u32_u24 v100, 12288, v100
  v_lshl_add_u32 v47, v103, 4, v100
  v_lshrrev_b32 v100, 4, v102
  v_mul_u32_u24 v100, 40, v100
  v_bfe_u32 v99, v102, 2, 2
  v_lshl_add_u32 v100, v99, 1, v100
  v_add_u32 v100, v100, v101
  v_mul_u32_u24 v100, 12288, v100
  v_lshl_add_u32 v97, v103, 4, v100
  v_add_u32 v103, 128, v1
  v_mul_u32_u24 v102, v103, v27
  v_lshrrev_b32 v102, 16, v102
  v_mul_u32_u24 v101, 6, v102
  v_sub_u32 v103, v103, v101
  v_bfe_u32 v101, v102, 1, 1
  v_mul_u32_u24 v101, 20, v101
  v_and_b32 v100, 1, v102
  v_add_u32 v101, v101, v100
  v_lshrrev_b32 v100, 3, v102
  v_mul_u32_u24 v100, 40, v100
  v_bfe_u32 v99, v102, 2, 1
  v_lshl_add_u32 v100, v99, 1, v100
  v_add_u32 v100, v100, v101
  v_mul_u32_u24 v100, 12288, v100
  v_lshl_add_u32 v48, v103, 4, v100
  v_lshrrev_b32 v100, 4, v102
  v_mul_u32_u24 v100, 40, v100
  v_bfe_u32 v99, v102, 2, 2
  v_lshl_add_u32 v100, v99, 1, v100
  v_add_u32 v100, v100, v101
  v_mul_u32_u24 v100, 12288, v100
  v_lshl_add_u32 v98, v103, 4, v100
  s_mul_i32 s80, s58, 384
  s_mul_i32 s22, s56, 96
  s_add_u32 s80, s80, s22
  s_mul_i32 s22, s20, 1966080
  s_add_u32 s80, s80, s22
  s_mul_i32 s88, s84, 96
  s_mul_i32 s21, s56, 96
  s_sub_u32 s88, s88, s21
  s_add_u32 s88, s88, s80
  s_mul_i32 s81, s20, 40448

  s_mul_i32 s82, s59, 245760
  s_lshl_b32 s22, s87, 5
  s_add_u32 s82, s82, s22
  s_mov_b32 s12, s38
  s_mov_b32 s13, s39
  s_mov_b32 s14, 7864320
  s_mov_b32 s15, 0x00020000
  s_add_u32 s21, s80, 0
  s_add_u32 s22, s81, 0
  s_add_u32 m0, s22, 0
  s_nop 0
  buffer_load_dwordx4 v96, s[12:15], s21 offen lds
  s_add_u32 m0, s22, 1024
  s_nop 0
  buffer_load_dwordx4 v97, s[12:15], s21 offen lds
  s_add_u32 m0, s22, 2048
  s_nop 0
  buffer_load_dwordx4 v98, s[12:15], s21 offen lds
  s_add_u32 s21, s80, 983040
  s_add_u32 s22, s81, 3072
  s_add_u32 m0, s22, 0
  s_nop 0
  buffer_load_dwordx4 v96, s[12:15], s21 offen lds
  s_add_u32 m0, s22, 1024
  s_nop 0
  buffer_load_dwordx4 v97, s[12:15], s21 offen lds
  s_add_u32 m0, s22, 2048
  s_nop 0
  buffer_load_dwordx4 v98, s[12:15], s21 offen lds
  s_add_u32 s21, s80, 98304
  s_add_u32 s22, s81, 6144
  s_add_u32 m0, s22, 0
  s_nop 0
  buffer_load_dwordx4 v96, s[12:15], s21 offen lds
  s_add_u32 m0, s22, 1024
  s_nop 0
  buffer_load_dwordx4 v97, s[12:15], s21 offen lds
  s_add_u32 m0, s22, 2048
  s_nop 0
  buffer_load_dwordx4 v98, s[12:15], s21 offen lds
  s_add_u32 s21, s80, 1081344
  s_add_u32 s22, s81, 9216
  s_add_u32 m0, s22, 0
  s_nop 0
  buffer_load_dwordx4 v96, s[12:15], s21 offen lds
  s_add_u32 m0, s22, 1024
  s_nop 0
  buffer_load_dwordx4 v97, s[12:15], s21 offen lds
  s_add_u32 m0, s22, 2048
  s_nop 0
  buffer_load_dwordx4 v98, s[12:15], s21 offen lds
  s_add_u32 s21, s80, 196608
  s_add_u32 s22, s81, 12288
  s_add_u32 m0, s22, 0
  s_nop 0
  buffer_load_dwordx4 v46, s[12:15], s21 offen lds
  s_add_u32 m0, s22, 1024
  s_nop 0
  buffer_load_dwordx4 v47, s[12:15], s21 offen lds
  s_add_u32 m0, s22, 2048
  s_nop 0
  buffer_load_dwordx4 v48, s[12:15], s21 offen lds
  s_mov_b32 s12, s40
  s_mov_b32 s13, s41
  s_mov_b32 s14, 7864320
  s_mov_b32 s15, 0x00020000
  s_add_u32 s21, s88, 0
  s_add_u32 s22, s81, 0
  buffer_load_dwordx4 v[128:131], v96, s[12:15], s21 offen
  buffer_load_dwordx4 v[132:135], v97, s[12:15], s21 offen
  buffer_load_dwordx4 v[136:139], v98, s[12:15], s21 offen
  s_add_u32 s21, s88, 983040
  s_add_u32 s22, s81, 3072
  buffer_load_dwordx4 v[140:143], v96, s[12:15], s21 offen
  buffer_load_dwordx4 v[144:147], v97, s[12:15], s21 offen
  buffer_load_dwordx4 v[148:151], v98, s[12:15], s21 offen
  s_add_u32 s21, s88, 98304
  s_add_u32 s22, s81, 6144
  buffer_load_dwordx4 v[152:155], v96, s[12:15], s21 offen
  buffer_load_dwordx4 v[156:159], v97, s[12:15], s21 offen
  buffer_load_dwordx4 v[160:163], v98, s[12:15], s21 offen
  s_add_u32 s21, s88, 1081344
  s_add_u32 s22, s81, 9216
  buffer_load_dwordx4 v[164:167], v96, s[12:15], s21 offen
  buffer_load_dwordx4 v[168:171], v97, s[12:15], s21 offen
  buffer_load_dwordx4 v[172:175], v98, s[12:15], s21 offen
  s_add_u32 s21, s88, 196608
  s_add_u32 s22, s81, 12288
  buffer_load_dwordx4 v[176:179], v46, s[12:15], s21 offen
  buffer_load_dwordx4 v[180:183], v47, s[12:15], s21 offen
  buffer_load_dwordx4 v[184:187], v48, s[12:15], s21 offen
  v_lshrrev_b32 v99, 2, v2
  v_lshl_add_u32 v99, v3, 3, v99
  v_mul_u32_u24 v99, 96, v99
  v_and_b32 v100, 3, v2
  v_lshlrev_b32 v100, 3, v100
  v_add3_u32 v99, v99, v100, s81
  v_lshlrev_b32 v100, 4, v1
  v_add_u32 v100, s81, v100
  v_and_b32 v236, 7, v2
  v_lshrrev_b32 v237, 3, v2
  v_lshlrev_b32 v238, 7, v3
  v_lshl_add_u32 v238, v236, 4, v238
  v_lshlrev_b32 v16, 4, v1
  v_mul_u32_u24 v244, 1280, v236
  s_mul_i32 s21, s20, 320
  v_add_u32 v244, s21, v244
  v_lshrrev_b32 v245, 3, v1
  v_mul_u32_u24 v245, 40, v245
  v_add_u32 v244, v244, v245
  s_lshr_b32 s21, s20, 1
  s_lshl_b32 s21, s21, 14
  s_and_b32 s22, s20, 1
  s_mul_i32 s22, s22, 3072
  s_add_u32 s21, s21, s22
  v_add_u32 v4, s21, v16
  v_mov_b32 v239, 0x4444
  v_mov_b32 v240, 0xeeee
  v_cmp_eq_u32 vcc, 1, v237
  s_nop 1
  v_cndmask_b32 v44, v239, v240, vcc
  v_cmp_gt_u32 vcc, 2, v3
  s_nop 1
  v_cndmask_b32 v89, 0, 1.0, vcc
  v_mul_u32_u24 v239, 40, v2
  v_lshl_add_u32 v239, v3, 3, v239
  s_mul_i32 s21, s20, 3200
  v_add_u32 v5, s21, v239
  v_lshrrev_b32 v239, 2, v1
  v_mul_u32_u24 v239, 40, v239
  v_and_b32 v240, 3, v1
  v_lshl_add_u32 v6, v240, 3, v239
  v_bfe_u32 v240, v1, 1, 1
  v_mul_u32_u24 v240, 6384, v240
  v_add_u32 v45, v6, v240
  s_lshl_b32 s21, s50, 4
  s_add_u32 s21, s21, s51
  s_lshl_b32 s21, s21, 9
  s_lshl_b32 s22, s20, 7
  s_add_u32 s21, s21, s22
  s_add_u32 s21, s21, 81920
  v_and_b32 v239, 1, v3
  v_lshlrev_b32 v239, 8, v239
  v_lshl_add_u32 v239, v236, 4, v239
  v_lshrrev_b32 v240, 1, v3
  v_lshl_add_u32 v239, v240, 3, v239
  v_add_u32 v7, s21, v239
  s_lshl_b32 s22, s58, 9
  s_lshl_b32 s23, s56, 7
  s_add_u32 s22, s22, s23
  s_add_u32 s22, s22, 376704
  v_lshlrev_b32 v239, 6, v3
  v_lshl_add_u32 v239, v236, 3, v239
  v_add_u32 v239, s22, v239
  s_cmp_eq_u32 s20, 2
  s_cselect_b64 vcc, -1, 0
  v_cndmask_b32 v7, v7, v239, vcc
  s_lshl_b32 s21, s59, 11
  s_add_u32 s21, s21, 81920
  v_add_u32 v8, s21, v16
  s_lshl_b32 s21, s59, 9
  s_add_u32 s21, s21, 376832
  v_lshl_add_u32 v9, v1, 3, s21
  s_mul_i32 s21, s59, 3072
  s_add_u32 s21, s21, 278528
  v_and_b32 v239, 0x39, v1
  v_bfe_u32 v240, v1, 1, 1
  v_lshl_or_b32 v239, v240, 2, v239
  v_bfe_u32 v240, v1, 2, 1
  v_lshl_or_b32 v239, v240, 1, v239
  v_lshl_add_u32 v10, v239, 4, s21
  s_cmp_eq_u32 s20, 3
  s_cselect_b32 s22, s84, s56
  s_mul_i32 s22, s22, 12
  v_add_u32 v239, s22, v3
  v_add3_u32 v240, 0, v239, v3
  v_lshrrev_b32 v241, 1, v240
  v_and_b32 v240, 1, v240
  v_lshlrev_b32 v240, 3, v240
  v_lshl_add_u32 v242, v241, 7, v240
  v_lshl_add_u32 v242, v236, 4, v242
  s_mul_i32 s21, s58, 3072
  v_add_u32 v21, s21, v242
  v_lshl_add_u32 v242, v241, 8, v240
  v_lshl_add_u32 v242, v2, 4, v242
  s_mul_i32 s21, s58, 12288
  s_and_b32 s22, s20, 1
  s_mul_i32 s22, s22, 6144
  s_add_u32 s21, s21, s22
  v_add_u32 v18, s21, v242
  v_add3_u32 v240, 1, v239, v3
  v_lshrrev_b32 v241, 1, v240
  v_and_b32 v240, 1, v240
  v_lshlrev_b32 v240, 3, v240
  v_lshl_add_u32 v242, v241, 7, v240
  v_lshl_add_u32 v242, v236, 4, v242
  s_mul_i32 s21, s58, 3072
  v_add_u32 v22, s21, v242
  v_lshl_add_u32 v242, v241, 8, v240
  v_lshl_add_u32 v242, v2, 4, v242
  s_mul_i32 s21, s58, 12288
  s_and_b32 s22, s20, 1
  s_mul_i32 s22, s22, 6144
  s_add_u32 s21, s21, s22
  v_add_u32 v19, s21, v242
  v_add_u32 v240, 8, v239
  v_lshrrev_b32 v241, 1, v240
  v_and_b32 v240, 1, v240
  v_lshlrev_b32 v240, 3, v240
  v_lshl_add_u32 v242, v241, 7, v240
  v_lshl_add_u32 v242, v236, 4, v242
  s_mul_i32 s21, s58, 3072
  v_add_u32 v23, s21, v242
  v_lshl_add_u32 v242, v241, 8, v240
  v_lshl_add_u32 v242, v2, 4, v242
  s_mul_i32 s21, s58, 12288
  s_and_b32 s22, s20, 1
  s_mul_i32 s22, s22, 6144
  s_add_u32 s21, s21, s22
  v_add_u32 v20, s21, v242
  v_cmp_eq_u32 vcc, 1, v237
  s_nop 1
  v_cndmask_b32 v25, v21, v22, vcc
  v_add_u32 v24, 278528, v25
  s_mul_i32 s21, s20, 3072
  s_add_u32 s21, s21, 22528
  v_add_u32 v11, s21, v16
  v_and_b32 v239, 3, v1
  s_lshl_b32 s21, s20, 2
  v_add_u32 v240, s21, v239
  v_cmp_eq_u32 vcc, 10, v240
  s_nop 1
  v_cndmask_b32 v240, v240, 7, vcc
  v_cmp_eq_u32 vcc, 3, v239
  v_lshrrev_b32 v241, 5, v1
  v_mul_u32_u24 v241, 10, v241
  v_cndmask_b32 v240, v240, 3, vcc
  s_lshl_b32 s21, s79, 2
  v_add3_u32 v240, v240, v241, s21
  v_lshrrev_b32 v241, 1, v240
  v_lshlrev_b32 v241, 8, v241
  v_and_b32 v240, 1, v240
  v_lshl_add_u32 v241, v240, 3, v241
  v_bfe_u32 v240, v1, 2, 3
  v_lshl_add_u32 v241, v240, 4, v241
  v_add_u32 v12, 22528, v241
  s_mov_b32 s21, 0x07060100
  s_cmp_eq_u32 s20, 1
  s_cselect_b32 s21, 0x07060302, s21
  s_cmp_eq_u32 s20, 2
  s_cselect_b32 s21, 0x07060c0c, s21
  v_mov_b32 v240, s21
  v_mov_b32 v241, 0x03020100
  v_cndmask_b32 v14, v241, v240, vcc
  s_lshr_b32 s21, s85, 3
  s_lshl_b32 s21, s21, 14
  s_bfe_u32 s22, s85, 0x10002
  s_mul_i32 s22, s22, 3072
  s_add_u32 s21, s21, s22
  s_and_b32 s22, s85, 3
  s_lshl_b32 s22, s22, 8
  s_add_u32 s21, s21, s22
  s_lshl_b32 s22, s20, 10
  s_add_u32 s22, s22, s21
  v_lshl_add_u32 v13, v1, 2, s22
  v_lshlrev_b32 v240, 10, v3
  v_lshl_add_u32 v240, v2, 4, v240
  v_add_u32 v240, s21, v240
  s_cmp_eq_u32 s20, 3
  s_cselect_b64 vcc, -1, 0
  v_cndmask_b32 v13, v13, v240, vcc
  s_mov_b32 s91, 0x3c000000
  v_and_b32 v240, 1, v3
  v_lshrrev_b32 v241, 1, v3
  v_lshl_add_u32 v240, v240, 1, v241
  v_lshlrev_b32 v240, 8, v240
  v_lshl_add_u32 v240, v2, 4, v240
  s_mul_i32 s21, s59, 10240
  s_lshl_b32 s22, s87, 8
  s_add_u32 s21, s21, s22
  v_add_u32 v15, s21, v240
  s_lshl_b32 s21, s79, 4
  s_lshl_b32 s76, -1, s21
  s_mov_b32 s77, 0xffff
  s_lshl_b32 s21, s79, 7
  v_or_b32 v17, s21, v16
  s_or_b32 s21, s21, 0xffffff7f
  v_and_b32 v26, s21, v16
  v_mov_b32 v243, 0
  s_mul_i32 s89, s59, 12288
  s_add_u32 s89, s89, 25165824
  v_cmp_gt_u32 s[60:61], 8, v2
  v_cmp_le_u32 s[62:63], 8, v2
  v_cmp_le_u32 s[72:73], 2, v3
  v_cmp_gt_u32 s[70:71], 48, v1
  s_nop 1
  s_and_b64 s[64:65], s[60:61], s[72:73]
  s_cmp_eq_u32 s20, 2
  s_cselect_b64 s[74:75], s[64:65], s[60:61]
  s_mul_i32 s89, s59, 12288
  s_add_u32 s89, s89, 25165824
  s_not_b64 s[48:49], s[72:73]
  v_mov_b32 v27, 10923
  v_mov_b32 v49, v100
  v_add_u32 v113, 576, v1
  v_mul_u32_u24 v103, v113, v27
  v_lshrrev_b32 v103, 16, v103
  v_mul_u32_u24 v102, 6, v103
  v_sub_u32 v113, v113, v102
  v_bfe_u32 v102, v103, 1, 1
  v_lshlrev_b32 v102, 3, v102
  v_and_b32 v127, 12, v103
  v_lshrrev_b32 v127, 1, v127
  v_and_b32 v103, 0xfffffff1, v103
  v_or3_b32 v103, v103, v102, v127
  v_mul_u32_u24 v102, 1366, v103
  v_lshrrev_b32 v102, 16, v102
  v_mul_u32_u24 v100, 48, v102
  v_sub_u32 v103, v103, v100
  v_cmp_gt_u32 vcc, 32, v103
  v_bfe_u32 v101, v103, 3, 2
  v_and_b32 v126, 3, v103
  v_lshl_add_u32 v126, v101, 2, v126
  v_bfe_u32 v101, v103, 2, 1
  v_lshl_add_u32 v126, v101, 4, v126
  v_cndmask_b32 v103, v103, v126, vcc
  v_add_u32 v100, v100, v103
  v_mul_u32_u24 v100, 1280, v100
  v_lshl_add_u32 v113, v113, 4, v100
  v_add_u32 v114, 640, v1
  v_mul_u32_u24 v103, v114, v27
  v_lshrrev_b32 v103, 16, v103
  v_mul_u32_u24 v102, 6, v103
  v_sub_u32 v114, v114, v102
  v_bfe_u32 v102, v103, 1, 1
  v_lshlrev_b32 v102, 3, v102
  v_and_b32 v127, 12, v103
  v_lshrrev_b32 v127, 1, v127
  v_and_b32 v103, 0xfffffff1, v103
  v_or3_b32 v103, v103, v102, v127
  v_mul_u32_u24 v102, 1366, v103
  v_lshrrev_b32 v102, 16, v102
  v_mul_u32_u24 v100, 48, v102
  v_sub_u32 v103, v103, v100
  v_cmp_gt_u32 vcc, 32, v103
  v_bfe_u32 v101, v103, 3, 2
  v_and_b32 v126, 3, v103
  v_lshl_add_u32 v126, v101, 2, v126
  v_bfe_u32 v101, v103, 2, 1
  v_lshl_add_u32 v126, v101, 4, v126
  v_cndmask_b32 v103, v103, v126, vcc
  v_add_u32 v100, v100, v103
  v_mul_u32_u24 v100, 1280, v100
  v_lshl_add_u32 v114, v114, 4, v100
  v_add_u32 v115, 704, v1
  v_mul_u32_u24 v103, v115, v27
  v_lshrrev_b32 v103, 16, v103
  v_mul_u32_u24 v102, 6, v103
  v_sub_u32 v115, v115, v102
  v_bfe_u32 v102, v103, 1, 1
  v_lshlrev_b32 v102, 3, v102
  v_and_b32 v127, 12, v103
  v_lshrrev_b32 v127, 1, v127
  v_and_b32 v103, 0xfffffff1, v103
  v_or3_b32 v103, v103, v102, v127
  v_mul_u32_u24 v102, 1366, v103
  v_lshrrev_b32 v102, 16, v102
  v_mul_u32_u24 v100, 48, v102
  v_sub_u32 v103, v103, v100
  v_cmp_gt_u32 vcc, 32, v103
  v_bfe_u32 v101, v103, 3, 2
  v_and_b32 v126, 3, v103
  v_lshl_add_u32 v126, v101, 2, v126
  v_bfe_u32 v101, v103, 2, 1
  v_lshl_add_u32 v126, v101, 4, v126
  v_cndmask_b32 v103, v103, v126, vcc
  v_add_u32 v100, v100, v103
  v_mul_u32_u24 v100, 1280, v100
  v_lshl_add_u32 v115, v115, 4, v100
  v_add_u32 v116, 768, v1
  v_mul_u32_u24 v103, v116, v27
  v_lshrrev_b32 v103, 16, v103
  v_mul_u32_u24 v102, 6, v103
  v_sub_u32 v116, v116, v102
  v_bfe_u32 v102, v103, 1, 1
  v_lshlrev_b32 v102, 3, v102
  v_and_b32 v127, 12, v103
  v_lshrrev_b32 v127, 1, v127
  v_and_b32 v103, 0xfffffff1, v103
  v_or3_b32 v103, v103, v102, v127
  v_mul_u32_u24 v102, 1366, v103
  v_lshrrev_b32 v102, 16, v102
  v_mul_u32_u24 v100, 48, v102
  v_sub_u32 v103, v103, v100
  v_cmp_gt_u32 vcc, 32, v103
  v_bfe_u32 v101, v103, 3, 2
  v_and_b32 v126, 3, v103
  v_lshl_add_u32 v126, v101, 2, v126
  v_bfe_u32 v101, v103, 2, 1
  v_lshl_add_u32 v126, v101, 4, v126
  v_cndmask_b32 v103, v103, v126, vcc
  v_add_u32 v100, v100, v103
  v_mul_u32_u24 v100, 1280, v100
  v_lshl_add_u32 v116, v116, 4, v100
  v_add_u32 v117, 832, v1
  v_mul_u32_u24 v103, v117, v27
  v_lshrrev_b32 v103, 16, v103
  v_mul_u32_u24 v102, 6, v103
  v_sub_u32 v117, v117, v102
  v_bfe_u32 v102, v103, 1, 1
  v_lshlrev_b32 v102, 3, v102
  v_and_b32 v127, 12, v103
  v_lshrrev_b32 v127, 1, v127
  v_and_b32 v103, 0xfffffff1, v103
  v_or3_b32 v103, v103, v102, v127
  v_mul_u32_u24 v102, 1366, v103
  v_lshrrev_b32 v102, 16, v102
  v_mul_u32_u24 v100, 48, v102
  v_sub_u32 v103, v103, v100
  v_cmp_gt_u32 vcc, 32, v103
  v_bfe_u32 v101, v103, 3, 2
  v_and_b32 v126, 3, v103
  v_lshl_add_u32 v126, v101, 2, v126
  v_bfe_u32 v101, v103, 2, 1
  v_lshl_add_u32 v126, v101, 4, v126
  v_cndmask_b32 v103, v103, v126, vcc
  v_add_u32 v100, v100, v103
  v_mul_u32_u24 v100, 1280, v100
  v_lshl_add_u32 v117, v117, 4, v100
  v_add_u32 v118, 896, v1
  v_mul_u32_u24 v103, v118, v27
  v_lshrrev_b32 v103, 16, v103
  v_mul_u32_u24 v102, 6, v103
  v_sub_u32 v118, v118, v102
  v_bfe_u32 v102, v103, 1, 1
  v_lshlrev_b32 v102, 3, v102
  v_and_b32 v127, 12, v103
  v_lshrrev_b32 v127, 1, v127
  v_and_b32 v103, 0xfffffff1, v103
  v_or3_b32 v103, v103, v102, v127
  v_mul_u32_u24 v102, 1366, v103
  v_lshrrev_b32 v102, 16, v102
  v_mul_u32_u24 v100, 48, v102
  v_sub_u32 v103, v103, v100
  v_cmp_gt_u32 vcc, 32, v103
  v_bfe_u32 v101, v103, 3, 2
  v_and_b32 v126, 3, v103
  v_lshl_add_u32 v126, v101, 2, v126
  v_bfe_u32 v101, v103, 2, 1
  v_lshl_add_u32 v126, v101, 4, v126
  v_cndmask_b32 v103, v103, v126, vcc
  v_add_u32 v100, v100, v103
  v_mul_u32_u24 v100, 1280, v100
  v_lshl_add_u32 v118, v118, 4, v100
  v_add_u32 v119, 960, v1
  v_mul_u32_u24 v103, v119, v27
  v_lshrrev_b32 v103, 16, v103
  v_mul_u32_u24 v102, 6, v103
  v_sub_u32 v119, v119, v102
  v_bfe_u32 v102, v103, 1, 1
  v_lshlrev_b32 v102, 3, v102
  v_and_b32 v127, 12, v103
  v_lshrrev_b32 v127, 1, v127
  v_and_b32 v103, 0xfffffff1, v103
  v_or3_b32 v103, v103, v102, v127
  v_mul_u32_u24 v102, 1366, v103
  v_lshrrev_b32 v102, 16, v102
  v_mul_u32_u24 v100, 48, v102
  v_sub_u32 v103, v103, v100
  v_cmp_gt_u32 vcc, 32, v103
  v_bfe_u32 v101, v103, 3, 2
  v_and_b32 v126, 3, v103
  v_lshl_add_u32 v126, v101, 2, v126
  v_bfe_u32 v101, v103, 2, 1
  v_lshl_add_u32 v126, v101, 4, v126
  v_cndmask_b32 v103, v103, v126, vcc
  v_add_u32 v100, v100, v103
  v_mul_u32_u24 v100, 1280, v100
  v_lshl_add_u32 v119, v119, 4, v100
  v_add_u32 v120, 1024, v1
  v_mul_u32_u24 v103, v120, v27
  v_lshrrev_b32 v103, 16, v103
  v_mul_u32_u24 v102, 6, v103
  v_sub_u32 v120, v120, v102
  v_bfe_u32 v102, v103, 1, 1
  v_lshlrev_b32 v102, 3, v102
  v_and_b32 v127, 12, v103
  v_lshrrev_b32 v127, 1, v127
  v_and_b32 v103, 0xfffffff1, v103
  v_or3_b32 v103, v103, v102, v127
  v_mul_u32_u24 v102, 1366, v103
  v_lshrrev_b32 v102, 16, v102
  v_mul_u32_u24 v100, 48, v102
  v_sub_u32 v103, v103, v100
  v_cmp_gt_u32 vcc, 32, v103
  v_bfe_u32 v101, v103, 3, 2
  v_and_b32 v126, 3, v103
  v_lshl_add_u32 v126, v101, 2, v126
  v_bfe_u32 v101, v103, 2, 1
  v_lshl_add_u32 v126, v101, 4, v126
  v_cndmask_b32 v103, v103, v126, vcc
  v_add_u32 v100, v100, v103
  v_mul_u32_u24 v100, 1280, v100
  v_lshl_add_u32 v120, v120, 4, v100
  v_add_u32 v121, 1088, v1
  v_mul_u32_u24 v103, v121, v27
  v_lshrrev_b32 v103, 16, v103
  v_mul_u32_u24 v102, 6, v103
  v_sub_u32 v121, v121, v102
  v_bfe_u32 v102, v103, 1, 1
  v_lshlrev_b32 v102, 3, v102
  v_and_b32 v127, 12, v103
  v_lshrrev_b32 v127, 1, v127
  v_and_b32 v103, 0xfffffff1, v103
  v_or3_b32 v103, v103, v102, v127
  v_mul_u32_u24 v102, 1366, v103
  v_lshrrev_b32 v102, 16, v102
  v_mul_u32_u24 v100, 48, v102
  v_sub_u32 v103, v103, v100
  v_cmp_gt_u32 vcc, 32, v103
  v_bfe_u32 v101, v103, 3, 2
  v_and_b32 v126, 3, v103
  v_lshl_add_u32 v126, v101, 2, v126
  v_bfe_u32 v101, v103, 2, 1
  v_lshl_add_u32 v126, v101, 4, v126
  v_cndmask_b32 v103, v103, v126, vcc
  v_add_u32 v100, v100, v103
  v_mul_u32_u24 v100, 1280, v100
  v_lshl_add_u32 v121, v121, 4, v100
  s_waitcnt vmcnt(63)
  s_mov_b32 s12, s42
  s_mov_b32 s13, s43
  s_mov_b32 s14, 7864320
  s_mov_b32 s15, 0x00020000
  buffer_load_dwordx4 v[188:191], v113, s[12:15], s82 offen
  buffer_load_dwordx4 v[192:195], v114, s[12:15], s82 offen
  buffer_load_dwordx4 v[196:199], v115, s[12:15], s82 offen
  buffer_load_dwordx4 v[200:203], v116, s[12:15], s82 offen
  buffer_load_dwordx4 v[204:207], v117, s[12:15], s82 offen
  buffer_load_dwordx4 v[208:211], v118, s[12:15], s82 offen
  buffer_load_dwordx4 v[212:215], v119, s[12:15], s82 offen
  buffer_load_dwordx4 v[216:219], v120, s[12:15], s82 offen
  buffer_load_dwordx4 v[220:223], v121, s[12:15], s82 offen
  v_add_u32 v104, 0, v1
  v_mul_u32_u24 v103, v104, v27
  v_lshrrev_b32 v103, 16, v103
  v_mul_u32_u24 v102, 6, v103
  v_sub_u32 v104, v104, v102
  v_bfe_u32 v102, v103, 1, 1
  v_lshlrev_b32 v102, 3, v102
  v_and_b32 v127, 12, v103
  v_lshrrev_b32 v127, 1, v127
  v_and_b32 v103, 0xfffffff1, v103
  v_or3_b32 v103, v103, v102, v127
  v_mul_u32_u24 v102, 1366, v103
  v_lshrrev_b32 v102, 16, v102
  v_mul_u32_u24 v100, 48, v102
  v_sub_u32 v103, v103, v100
  v_cmp_gt_u32 vcc, 32, v103
  v_bfe_u32 v101, v103, 3, 2
  v_and_b32 v126, 3, v103
  v_lshl_add_u32 v126, v101, 2, v126
  v_bfe_u32 v101, v103, 2, 1
  v_lshl_add_u32 v126, v101, 4, v126
  v_cndmask_b32 v103, v103, v126, vcc
  v_add_u32 v100, v100, v103
  v_mul_u32_u24 v100, 1280, v100
  v_lshl_add_u32 v104, v104, 4, v100
  v_add_u32 v105, 64, v1
  v_mul_u32_u24 v103, v105, v27
  v_lshrrev_b32 v103, 16, v103
  v_mul_u32_u24 v102, 6, v103
  v_sub_u32 v105, v105, v102
  v_bfe_u32 v102, v103, 1, 1
  v_lshlrev_b32 v102, 3, v102
  v_and_b32 v127, 12, v103
  v_lshrrev_b32 v127, 1, v127
  v_and_b32 v103, 0xfffffff1, v103
  v_or3_b32 v103, v103, v102, v127
  v_mul_u32_u24 v102, 1366, v103
  v_lshrrev_b32 v102, 16, v102
  v_mul_u32_u24 v100, 48, v102
  v_sub_u32 v103, v103, v100
  v_cmp_gt_u32 vcc, 32, v103
  v_bfe_u32 v101, v103, 3, 2
  v_and_b32 v126, 3, v103
  v_lshl_add_u32 v126, v101, 2, v126
  v_bfe_u32 v101, v103, 2, 1
  v_lshl_add_u32 v126, v101, 4, v126
  v_cndmask_b32 v103, v103, v126, vcc
  v_add_u32 v100, v100, v103
  v_mul_u32_u24 v100, 1280, v100
  v_lshl_add_u32 v105, v105, 4, v100
  v_add_u32 v106, 128, v1
  v_mul_u32_u24 v103, v106, v27
  v_lshrrev_b32 v103, 16, v103
  v_mul_u32_u24 v102, 6, v103
  v_sub_u32 v106, v106, v102
  v_bfe_u32 v102, v103, 1, 1
  v_lshlrev_b32 v102, 3, v102
  v_and_b32 v127, 12, v103
  v_lshrrev_b32 v127, 1, v127
  v_and_b32 v103, 0xfffffff1, v103
  v_or3_b32 v103, v103, v102, v127
  v_mul_u32_u24 v102, 1366, v103
  v_lshrrev_b32 v102, 16, v102
  v_mul_u32_u24 v100, 48, v102
  v_sub_u32 v103, v103, v100
  v_cmp_gt_u32 vcc, 32, v103
  v_bfe_u32 v101, v103, 3, 2
  v_and_b32 v126, 3, v103
  v_lshl_add_u32 v126, v101, 2, v126
  v_bfe_u32 v101, v103, 2, 1
  v_lshl_add_u32 v126, v101, 4, v126
  v_cndmask_b32 v103, v103, v126, vcc
  v_add_u32 v100, v100, v103
  v_mul_u32_u24 v100, 1280, v100
  v_lshl_add_u32 v106, v106, 4, v100
  v_add_u32 v107, 192, v1
  v_mul_u32_u24 v103, v107, v27
  v_lshrrev_b32 v103, 16, v103
  v_mul_u32_u24 v102, 6, v103
  v_sub_u32 v107, v107, v102
  v_bfe_u32 v102, v103, 1, 1
  v_lshlrev_b32 v102, 3, v102
  v_and_b32 v127, 12, v103
  v_lshrrev_b32 v127, 1, v127
  v_and_b32 v103, 0xfffffff1, v103
  v_or3_b32 v103, v103, v102, v127
  v_mul_u32_u24 v102, 1366, v103
  v_lshrrev_b32 v102, 16, v102
  v_mul_u32_u24 v100, 48, v102
  v_sub_u32 v103, v103, v100
  v_cmp_gt_u32 vcc, 32, v103
  v_bfe_u32 v101, v103, 3, 2
  v_and_b32 v126, 3, v103
  v_lshl_add_u32 v126, v101, 2, v126
  v_bfe_u32 v101, v103, 2, 1
  v_lshl_add_u32 v126, v101, 4, v126
  v_cndmask_b32 v103, v103, v126, vcc
  v_add_u32 v100, v100, v103
  v_mul_u32_u24 v100, 1280, v100
  v_lshl_add_u32 v107, v107, 4, v100
  v_add_u32 v108, 256, v1
  v_mul_u32_u24 v103, v108, v27
  v_lshrrev_b32 v103, 16, v103
  v_mul_u32_u24 v102, 6, v103
  v_sub_u32 v108, v108, v102
  v_bfe_u32 v102, v103, 1, 1
  v_lshlrev_b32 v102, 3, v102
  v_and_b32 v127, 12, v103
  v_lshrrev_b32 v127, 1, v127
  v_and_b32 v103, 0xfffffff1, v103
  v_or3_b32 v103, v103, v102, v127
  v_mul_u32_u24 v102, 1366, v103
  v_lshrrev_b32 v102, 16, v102
  v_mul_u32_u24 v100, 48, v102
  v_sub_u32 v103, v103, v100
  v_cmp_gt_u32 vcc, 32, v103
  v_bfe_u32 v101, v103, 3, 2
  v_and_b32 v126, 3, v103
  v_lshl_add_u32 v126, v101, 2, v126
  v_bfe_u32 v101, v103, 2, 1
  v_lshl_add_u32 v126, v101, 4, v126
  v_cndmask_b32 v103, v103, v126, vcc
  v_add_u32 v100, v100, v103
  v_mul_u32_u24 v100, 1280, v100
  v_lshl_add_u32 v108, v108, 4, v100
  v_add_u32 v109, 320, v1
  v_mul_u32_u24 v103, v109, v27
  v_lshrrev_b32 v103, 16, v103
  v_mul_u32_u24 v102, 6, v103
  v_sub_u32 v109, v109, v102
  v_bfe_u32 v102, v103, 1, 1
  v_lshlrev_b32 v102, 3, v102
  v_and_b32 v127, 12, v103
  v_lshrrev_b32 v127, 1, v127
  v_and_b32 v103, 0xfffffff1, v103
  v_or3_b32 v103, v103, v102, v127
  v_mul_u32_u24 v102, 1366, v103
  v_lshrrev_b32 v102, 16, v102
  v_mul_u32_u24 v100, 48, v102
  v_sub_u32 v103, v103, v100
  v_cmp_gt_u32 vcc, 32, v103
  v_bfe_u32 v101, v103, 3, 2
  v_and_b32 v126, 3, v103
  v_lshl_add_u32 v126, v101, 2, v126
  v_bfe_u32 v101, v103, 2, 1
  v_lshl_add_u32 v126, v101, 4, v126
  v_cndmask_b32 v103, v103, v126, vcc
  v_add_u32 v100, v100, v103
  v_mul_u32_u24 v100, 1280, v100
  v_lshl_add_u32 v109, v109, 4, v100
  v_add_u32 v110, 384, v1
  v_mul_u32_u24 v103, v110, v27
  v_lshrrev_b32 v103, 16, v103
  v_mul_u32_u24 v102, 6, v103
  v_sub_u32 v110, v110, v102
  v_bfe_u32 v102, v103, 1, 1
  v_lshlrev_b32 v102, 3, v102
  v_and_b32 v127, 12, v103
  v_lshrrev_b32 v127, 1, v127
  v_and_b32 v103, 0xfffffff1, v103
  v_or3_b32 v103, v103, v102, v127
  v_mul_u32_u24 v102, 1366, v103
  v_lshrrev_b32 v102, 16, v102
  v_mul_u32_u24 v100, 48, v102
  v_sub_u32 v103, v103, v100
  v_cmp_gt_u32 vcc, 32, v103
  v_bfe_u32 v101, v103, 3, 2
  v_and_b32 v126, 3, v103
  v_lshl_add_u32 v126, v101, 2, v126
  v_bfe_u32 v101, v103, 2, 1
  v_lshl_add_u32 v126, v101, 4, v126
  v_cndmask_b32 v103, v103, v126, vcc
  v_add_u32 v100, v100, v103
  v_mul_u32_u24 v100, 1280, v100
  v_lshl_add_u32 v110, v110, 4, v100
  v_add_u32 v111, 448, v1
  v_mul_u32_u24 v103, v111, v27
  v_lshrrev_b32 v103, 16, v103
  v_mul_u32_u24 v102, 6, v103
  v_sub_u32 v111, v111, v102
  v_bfe_u32 v102, v103, 1, 1
  v_lshlrev_b32 v102, 3, v102
  v_and_b32 v127, 12, v103
  v_lshrrev_b32 v127, 1, v127
  v_and_b32 v103, 0xfffffff1, v103
  v_or3_b32 v103, v103, v102, v127
  v_mul_u32_u24 v102, 1366, v103
  v_lshrrev_b32 v102, 16, v102
  v_mul_u32_u24 v100, 48, v102
  v_sub_u32 v103, v103, v100
  v_cmp_gt_u32 vcc, 32, v103
  v_bfe_u32 v101, v103, 3, 2
  v_and_b32 v126, 3, v103
  v_lshl_add_u32 v126, v101, 2, v126
  v_bfe_u32 v101, v103, 2, 1
  v_lshl_add_u32 v126, v101, 4, v126
  v_cndmask_b32 v103, v103, v126, vcc
  v_add_u32 v100, v100, v103
  v_mul_u32_u24 v100, 1280, v100
  v_lshl_add_u32 v111, v111, 4, v100
  v_add_u32 v112, 512, v1
  v_mul_u32_u24 v103, v112, v27
  v_lshrrev_b32 v103, 16, v103
  v_mul_u32_u24 v102, 6, v103
  v_sub_u32 v112, v112, v102
  v_bfe_u32 v102, v103, 1, 1
  v_lshlrev_b32 v102, 3, v102
  v_and_b32 v127, 12, v103
  v_lshrrev_b32 v127, 1, v127
  v_and_b32 v103, 0xfffffff1, v103
  v_or3_b32 v103, v103, v102, v127
  v_mul_u32_u24 v102, 1366, v103
  v_lshrrev_b32 v102, 16, v102
  v_mul_u32_u24 v100, 48, v102
  v_sub_u32 v103, v103, v100
  v_cmp_gt_u32 vcc, 32, v103
  v_bfe_u32 v101, v103, 3, 2
  v_and_b32 v126, 3, v103
  v_lshl_add_u32 v126, v101, 2, v126
  v_bfe_u32 v101, v103, 2, 1
  v_lshl_add_u32 v126, v101, 4, v126
  v_cndmask_b32 v103, v103, v126, vcc
  v_add_u32 v100, v100, v103
  v_mul_u32_u24 v100, 1280, v100
  v_lshl_add_u32 v112, v112, 4, v100
  s_waitcnt vmcnt(63)
  s_mov_b32 s12, s42
  s_mov_b32 s13, s43
  s_mov_b32 s14, 7864320
  s_mov_b32 s15, 0x00020000
  s_add_u32 m0, s81, 30720
  s_nop 0
  buffer_load_dwordx4 v104, s[12:15], s82 offen lds
  s_add_u32 m0, s81, 31744
  s_nop 0
  buffer_load_dwordx4 v105, s[12:15], s82 offen lds
  s_add_u32 m0, s81, 32768
  s_nop 0
  buffer_load_dwordx4 v106, s[12:15], s82 offen lds
  s_add_u32 m0, s81, 33792
  s_nop 0
  buffer_load_dwordx4 v107, s[12:15], s82 offen lds
  s_add_u32 m0, s81, 34816
  s_nop 0
  buffer_load_dwordx4 v108, s[12:15], s82 offen lds
  s_add_u32 m0, s81, 35840
  s_nop 0
  buffer_load_dwordx4 v109, s[12:15], s82 offen lds
  s_add_u32 m0, s81, 36864
  s_nop 0
  buffer_load_dwordx4 v110, s[12:15], s82 offen lds
  s_add_u32 m0, s81, 37888
  s_nop 0
  buffer_load_dwordx4 v111, s[12:15], s82 offen lds
  s_add_u32 m0, s81, 38912
  s_nop 0
  buffer_load_dwordx4 v112, s[12:15], s82 offen lds
  buffer_load_dwordx4 v[32:35], v244, s[28:31], 0 offen offset:0
  buffer_load_dwordx4 v[36:39], v244, s[28:31], 0 offen offset:16
  buffer_load_dwordx2 v[40:41], v244, s[28:31], 0 offen offset:32
  s_waitcnt vmcnt(63)
  s_mov_b32 s12, s36
  s_mov_b32 s13, s37
  s_mov_b32 s14, 7864320
  s_mov_b32 s15, 0x00020000
  s_add_u32 s21, s80, 0
  s_add_u32 s22, s81, 15360
  s_add_u32 m0, s22, 0
  s_nop 0
  buffer_load_dwordx4 v96, s[12:15], s21 offen lds
  s_add_u32 m0, s22, 1024
  s_nop 0
  buffer_load_dwordx4 v97, s[12:15], s21 offen lds
  s_add_u32 m0, s22, 2048
  s_nop 0
  buffer_load_dwordx4 v98, s[12:15], s21 offen lds
  s_waitcnt vmcnt(63)
  s_mov_b32 s12, s36
  s_mov_b32 s13, s37
  s_mov_b32 s14, 7864320
  s_mov_b32 s15, 0x00020000
  s_add_u32 s21, s80, 983040
  s_add_u32 s22, s81, 18432
  s_add_u32 m0, s22, 0
  s_nop 0
  buffer_load_dwordx4 v96, s[12:15], s21 offen lds
  s_add_u32 m0, s22, 1024
  s_nop 0
  buffer_load_dwordx4 v97, s[12:15], s21 offen lds
  s_add_u32 m0, s22, 2048
  s_nop 0
  buffer_load_dwordx4 v98, s[12:15], s21 offen lds
  s_waitcnt vmcnt(63)
  s_mov_b32 s12, s36
  s_mov_b32 s13, s37
  s_mov_b32 s14, 7864320
  s_mov_b32 s15, 0x00020000
  s_add_u32 s21, s80, 98304
  s_add_u32 s22, s81, 21504
  s_add_u32 m0, s22, 0
  s_nop 0
  buffer_load_dwordx4 v96, s[12:15], s21 offen lds
  s_add_u32 m0, s22, 1024
  s_nop 0
  buffer_load_dwordx4 v97, s[12:15], s21 offen lds
  s_add_u32 m0, s22, 2048
  s_nop 0
  buffer_load_dwordx4 v98, s[12:15], s21 offen lds
  s_waitcnt vmcnt(63)
  s_mov_b32 s12, s36
  s_mov_b32 s13, s37
  s_mov_b32 s14, 7864320
  s_mov_b32 s15, 0x00020000
  s_add_u32 s21, s80, 1081344
  s_add_u32 s22, s81, 24576
  s_add_u32 m0, s22, 0
  s_nop 0
  buffer_load_dwordx4 v96, s[12:15], s21 offen lds
  s_add_u32 m0, s22, 1024
  s_nop 0
  buffer_load_dwordx4 v97, s[12:15], s21 offen lds
  s_add_u32 m0, s22, 2048
  s_nop 0
  buffer_load_dwordx4 v98, s[12:15], s21 offen lds
  s_waitcnt vmcnt(63)
  s_mov_b32 s12, s36
  s_mov_b32 s13, s37
  s_mov_b32 s14, 7864320
  s_mov_b32 s15, 0x00020000
  s_add_u32 s21, s80, 196608
  s_add_u32 s22, s81, 27648
  s_add_u32 m0, s22, 0
  s_nop 0
  buffer_load_dwordx4 v46, s[12:15], s21 offen lds
  s_add_u32 m0, s22, 1024
  s_nop 0
  buffer_load_dwordx4 v47, s[12:15], s21 offen lds
  s_add_u32 m0, s22, 2048
  s_nop 0
  buffer_load_dwordx4 v48, s[12:15], s21 offen lds
  v_mov_b32 v100, v49
  v_lshlrev_b32 v239, 2, v1
  s_waitcnt vmcnt(51)
  ds_read_b64_tr_b16 v[52:53], v99 offset:0
  ds_read_b64_tr_b16 v[54:55], v99 offset:384
  ds_read_b64_tr_b16 v[56:57], v99 offset:32
  ds_read_b64_tr_b16 v[58:59], v99 offset:416
  ds_read_b64_tr_b16 v[60:61], v99 offset:64
  ds_read_b64_tr_b16 v[62:63], v99 offset:448
  ds_read_b64_tr_b16 v[64:65], v99 offset:3072
  ds_read_b64_tr_b16 v[66:67], v99 offset:3456
  ds_read_b64_tr_b16 v[68:69], v99 offset:3104
  ds_read_b64_tr_b16 v[70:71], v99 offset:3488
  ds_read_b64_tr_b16 v[72:73], v99 offset:3136
  ds_read_b64_tr_b16 v[74:75], v99 offset:3520
  ds_read_b64_tr_b16 v[76:77], v99 offset:6144
  ds_read_b64_tr_b16 v[78:79], v99 offset:6528
  ds_read_b64_tr_b16 v[80:81], v99 offset:6176
  ds_read_b64_tr_b16 v[82:83], v99 offset:6560
  ds_read_b64_tr_b16 v[84:85], v99 offset:6208
  ds_read_b64_tr_b16 v[86:87], v99 offset:6592
  s_waitcnt lgkmcnt(12)
  v_lshlrev_b32 v50, 16, v52
  v_and_b32 v52, 0xffff0000, v52
  v_cvt_pk_f16_f32 v52, v50, v52
  v_accvgpr_write_b32 a60, v52
  v_lshlrev_b32 v50, 16, v53
  v_and_b32 v53, 0xffff0000, v53
  v_cvt_pk_f16_f32 v53, v50, v53
  v_accvgpr_write_b32 a61, v53
  v_lshlrev_b32 v50, 16, v54
  v_and_b32 v54, 0xffff0000, v54
  v_cvt_pk_f16_f32 v54, v50, v54
  v_accvgpr_write_b32 a62, v54
  v_lshlrev_b32 v50, 16, v55
  v_and_b32 v55, 0xffff0000, v55
  v_cvt_pk_f16_f32 v55, v50, v55
  v_accvgpr_write_b32 a63, v55
  v_lshlrev_b32 v50, 16, v56
  v_and_b32 v56, 0xffff0000, v56
  v_cvt_pk_f16_f32 v56, v50, v56
  v_accvgpr_write_b32 a80, v56
  v_lshlrev_b32 v50, 16, v57
  v_and_b32 v57, 0xffff0000, v57
  v_cvt_pk_f16_f32 v57, v50, v57
  v_accvgpr_write_b32 a81, v57
  v_lshlrev_b32 v50, 16, v58
  v_and_b32 v58, 0xffff0000, v58
  v_cvt_pk_f16_f32 v58, v50, v58
  v_accvgpr_write_b32 a82, v58
  v_lshlrev_b32 v50, 16, v59
  v_and_b32 v59, 0xffff0000, v59
  v_cvt_pk_f16_f32 v59, v50, v59
  v_accvgpr_write_b32 a83, v59
  v_lshlrev_b32 v50, 16, v60
  v_and_b32 v60, 0xffff0000, v60
  v_cvt_pk_f16_f32 v60, v50, v60
  v_accvgpr_write_b32 a100, v60
  v_lshlrev_b32 v50, 16, v61
  v_and_b32 v61, 0xffff0000, v61
  v_cvt_pk_f16_f32 v61, v50, v61
  v_accvgpr_write_b32 a101, v61
  v_lshlrev_b32 v50, 16, v62
  v_and_b32 v62, 0xffff0000, v62
  v_cvt_pk_f16_f32 v62, v50, v62
  v_accvgpr_write_b32 a102, v62
  v_lshlrev_b32 v50, 16, v63
  v_and_b32 v63, 0xffff0000, v63
  v_cvt_pk_f16_f32 v63, v50, v63
  v_accvgpr_write_b32 a103, v63
  ds_read_b64_tr_b16 v[52:53], v99 offset:9216
  ds_read_b64_tr_b16 v[54:55], v99 offset:9600
  ds_read_b64_tr_b16 v[56:57], v99 offset:9248
  ds_read_b64_tr_b16 v[58:59], v99 offset:9632
  ds_read_b64_tr_b16 v[60:61], v99 offset:9280
  ds_read_b64_tr_b16 v[62:63], v99 offset:9664
  s_waitcnt lgkmcnt(12)
  v_lshlrev_b32 v50, 16, v64
  v_and_b32 v64, 0xffff0000, v64
  v_cvt_pk_f16_f32 v64, v50, v64
  v_accvgpr_write_b32 a64, v64
  v_lshlrev_b32 v50, 16, v65
  v_and_b32 v65, 0xffff0000, v65
  v_cvt_pk_f16_f32 v65, v50, v65
  v_accvgpr_write_b32 a65, v65
  v_lshlrev_b32 v50, 16, v66
  v_and_b32 v66, 0xffff0000, v66
  v_cvt_pk_f16_f32 v66, v50, v66
  v_accvgpr_write_b32 a66, v66
  v_lshlrev_b32 v50, 16, v67
  v_and_b32 v67, 0xffff0000, v67
  v_cvt_pk_f16_f32 v67, v50, v67
  v_accvgpr_write_b32 a67, v67
  v_lshlrev_b32 v50, 16, v68
  v_and_b32 v68, 0xffff0000, v68
  v_cvt_pk_f16_f32 v68, v50, v68
  v_accvgpr_write_b32 a84, v68
  v_lshlrev_b32 v50, 16, v69
  v_and_b32 v69, 0xffff0000, v69
  v_cvt_pk_f16_f32 v69, v50, v69
  v_accvgpr_write_b32 a85, v69
  v_lshlrev_b32 v50, 16, v70
  v_and_b32 v70, 0xffff0000, v70
  v_cvt_pk_f16_f32 v70, v50, v70
  v_accvgpr_write_b32 a86, v70
  v_lshlrev_b32 v50, 16, v71
  v_and_b32 v71, 0xffff0000, v71
  v_cvt_pk_f16_f32 v71, v50, v71
  v_accvgpr_write_b32 a87, v71
  v_lshlrev_b32 v50, 16, v72
  v_and_b32 v72, 0xffff0000, v72
  v_cvt_pk_f16_f32 v72, v50, v72
  v_accvgpr_write_b32 a104, v72
  v_lshlrev_b32 v50, 16, v73
  v_and_b32 v73, 0xffff0000, v73
  v_cvt_pk_f16_f32 v73, v50, v73
  v_accvgpr_write_b32 a105, v73
  v_lshlrev_b32 v50, 16, v74
  v_and_b32 v74, 0xffff0000, v74
  v_cvt_pk_f16_f32 v74, v50, v74
  v_accvgpr_write_b32 a106, v74
  v_lshlrev_b32 v50, 16, v75
  v_and_b32 v75, 0xffff0000, v75
  v_cvt_pk_f16_f32 v75, v50, v75
  v_accvgpr_write_b32 a107, v75
  ds_read_b64_tr_b16 v[64:65], v99 offset:12288
  ds_read_b64_tr_b16 v[66:67], v99 offset:12672
  ds_read_b64_tr_b16 v[68:69], v99 offset:12320
  ds_read_b64_tr_b16 v[70:71], v99 offset:12704
  ds_read_b64_tr_b16 v[72:73], v99 offset:12352
  ds_read_b64_tr_b16 v[74:75], v99 offset:12736
  s_waitcnt lgkmcnt(12)
  v_lshlrev_b32 v50, 16, v76
  v_and_b32 v76, 0xffff0000, v76
  v_cvt_pk_f16_f32 v76, v50, v76
  v_accvgpr_write_b32 a68, v76
  v_lshlrev_b32 v50, 16, v77
  v_and_b32 v77, 0xffff0000, v77
  v_cvt_pk_f16_f32 v77, v50, v77
  v_accvgpr_write_b32 a69, v77
  v_lshlrev_b32 v50, 16, v78
  v_and_b32 v78, 0xffff0000, v78
  v_cvt_pk_f16_f32 v78, v50, v78
  v_accvgpr_write_b32 a70, v78
  v_lshlrev_b32 v50, 16, v79
  v_and_b32 v79, 0xffff0000, v79
  v_cvt_pk_f16_f32 v79, v50, v79
  v_accvgpr_write_b32 a71, v79
  v_lshlrev_b32 v50, 16, v80
  v_and_b32 v80, 0xffff0000, v80
  v_cvt_pk_f16_f32 v80, v50, v80
  v_accvgpr_write_b32 a88, v80
  v_lshlrev_b32 v50, 16, v81
  v_and_b32 v81, 0xffff0000, v81
  v_cvt_pk_f16_f32 v81, v50, v81
  v_accvgpr_write_b32 a89, v81
  v_lshlrev_b32 v50, 16, v82
  v_and_b32 v82, 0xffff0000, v82
  v_cvt_pk_f16_f32 v82, v50, v82
  v_accvgpr_write_b32 a90, v82
  v_lshlrev_b32 v50, 16, v83
  v_and_b32 v83, 0xffff0000, v83
  v_cvt_pk_f16_f32 v83, v50, v83
  v_accvgpr_write_b32 a91, v83
  v_lshlrev_b32 v50, 16, v84
  v_and_b32 v84, 0xffff0000, v84
  v_cvt_pk_f16_f32 v84, v50, v84
  v_accvgpr_write_b32 a108, v84
  v_lshlrev_b32 v50, 16, v85
  v_and_b32 v85, 0xffff0000, v85
  v_cvt_pk_f16_f32 v85, v50, v85
  v_accvgpr_write_b32 a109, v85
  v_lshlrev_b32 v50, 16, v86
  v_and_b32 v86, 0xffff0000, v86
  v_cvt_pk_f16_f32 v86, v50, v86
  v_accvgpr_write_b32 a110, v86
  v_lshlrev_b32 v50, 16, v87
  v_and_b32 v87, 0xffff0000, v87
  v_cvt_pk_f16_f32 v87, v50, v87
  v_accvgpr_write_b32 a111, v87
  s_waitcnt lgkmcnt(6)
  v_lshlrev_b32 v50, 16, v52
  v_and_b32 v52, 0xffff0000, v52
  v_cvt_pk_f16_f32 v52, v50, v52
  v_accvgpr_write_b32 a72, v52
  v_lshlrev_b32 v50, 16, v53
  v_and_b32 v53, 0xffff0000, v53
  v_cvt_pk_f16_f32 v53, v50, v53
  v_accvgpr_write_b32 a73, v53
  v_lshlrev_b32 v50, 16, v54
  v_and_b32 v54, 0xffff0000, v54
  v_cvt_pk_f16_f32 v54, v50, v54
  v_accvgpr_write_b32 a74, v54
  v_lshlrev_b32 v50, 16, v55
  v_and_b32 v55, 0xffff0000, v55
  v_cvt_pk_f16_f32 v55, v50, v55
  v_accvgpr_write_b32 a75, v55
  v_lshlrev_b32 v50, 16, v56
  v_and_b32 v56, 0xffff0000, v56
  v_cvt_pk_f16_f32 v56, v50, v56
  v_accvgpr_write_b32 a92, v56
  v_lshlrev_b32 v50, 16, v57
  v_and_b32 v57, 0xffff0000, v57
  v_cvt_pk_f16_f32 v57, v50, v57
  v_accvgpr_write_b32 a93, v57
  v_lshlrev_b32 v50, 16, v58
  v_and_b32 v58, 0xffff0000, v58
  v_cvt_pk_f16_f32 v58, v50, v58
  v_accvgpr_write_b32 a94, v58
  v_lshlrev_b32 v50, 16, v59
  v_and_b32 v59, 0xffff0000, v59
  v_cvt_pk_f16_f32 v59, v50, v59
  v_accvgpr_write_b32 a95, v59
  v_lshlrev_b32 v50, 16, v60
  v_and_b32 v60, 0xffff0000, v60
  v_cvt_pk_f16_f32 v60, v50, v60
  v_accvgpr_write_b32 a112, v60
  v_lshlrev_b32 v50, 16, v61
  v_and_b32 v61, 0xffff0000, v61
  v_cvt_pk_f16_f32 v61, v50, v61
  v_accvgpr_write_b32 a113, v61
  v_lshlrev_b32 v50, 16, v62
  v_and_b32 v62, 0xffff0000, v62
  v_cvt_pk_f16_f32 v62, v50, v62
  v_accvgpr_write_b32 a114, v62
  v_lshlrev_b32 v50, 16, v63
  v_and_b32 v63, 0xffff0000, v63
  v_cvt_pk_f16_f32 v63, v50, v63
  v_accvgpr_write_b32 a115, v63
  s_waitcnt lgkmcnt(0)
  v_lshlrev_b32 v50, 16, v64
  v_and_b32 v64, 0xffff0000, v64
  v_cvt_pk_f16_f32 v64, v50, v64
  v_accvgpr_write_b32 a76, v64
  v_lshlrev_b32 v50, 16, v65
  v_and_b32 v65, 0xffff0000, v65
  v_cvt_pk_f16_f32 v65, v50, v65
  v_accvgpr_write_b32 a77, v65
  v_lshlrev_b32 v50, 16, v66
  v_and_b32 v66, 0xffff0000, v66
  v_cvt_pk_f16_f32 v66, v50, v66
  v_accvgpr_write_b32 a78, v66
  v_lshlrev_b32 v50, 16, v67
  v_and_b32 v67, 0xffff0000, v67
  v_cvt_pk_f16_f32 v67, v50, v67
  v_accvgpr_write_b32 a79, v67
  v_lshlrev_b32 v50, 16, v68
  v_and_b32 v68, 0xffff0000, v68
  v_cvt_pk_f16_f32 v68, v50, v68
  v_accvgpr_write_b32 a96, v68
  v_lshlrev_b32 v50, 16, v69
  v_and_b32 v69, 0xffff0000, v69
  v_cvt_pk_f16_f32 v69, v50, v69
  v_accvgpr_write_b32 a97, v69
  v_lshlrev_b32 v50, 16, v70
  v_and_b32 v70, 0xffff0000, v70
  v_cvt_pk_f16_f32 v70, v50, v70
  v_accvgpr_write_b32 a98, v70
  v_lshlrev_b32 v50, 16, v71
  v_and_b32 v71, 0xffff0000, v71
  v_cvt_pk_f16_f32 v71, v50, v71
  v_accvgpr_write_b32 a99, v71
  v_lshlrev_b32 v50, 16, v72
  v_and_b32 v72, 0xffff0000, v72
  v_cvt_pk_f16_f32 v72, v50, v72
  v_accvgpr_write_b32 a116, v72
  v_lshlrev_b32 v50, 16, v73
  v_and_b32 v73, 0xffff0000, v73
  v_cvt_pk_f16_f32 v73, v50, v73
  v_accvgpr_write_b32 a117, v73
  v_lshlrev_b32 v50, 16, v74
  v_and_b32 v74, 0xffff0000, v74
  v_cvt_pk_f16_f32 v74, v50, v74
  v_accvgpr_write_b32 a118, v74
  v_lshlrev_b32 v50, 16, v75
  v_and_b32 v75, 0xffff0000, v75
  v_cvt_pk_f16_f32 v75, v50, v75
  v_accvgpr_write_b32 a119, v75
  s_waitcnt vmcnt(36)
  ds_write_b128 v100, v[128:131] offset:0
  ds_write_b128 v100, v[132:135] offset:1024
  ds_write_b128 v100, v[136:139] offset:2048
  ds_write_b128 v100, v[140:143] offset:3072
  ds_write_b128 v100, v[144:147] offset:4096
  ds_write_b128 v100, v[148:151] offset:5120
  ds_write_b128 v100, v[152:155] offset:6144
  ds_write_b128 v100, v[156:159] offset:7168
  ds_write_b128 v100, v[160:163] offset:8192
  ds_write_b128 v100, v[164:167] offset:9216
  ds_write_b128 v100, v[168:171] offset:10240
  ds_write_b128 v100, v[172:175] offset:11264
  ds_write_b128 v100, v[176:179] offset:12288
  ds_write_b128 v100, v[180:183] offset:13312
  ds_write_b128 v100, v[184:187] offset:14336
  s_waitcnt lgkmcnt(0)
  ds_read_b64_tr_b16 v[52:53], v99 offset:0
  ds_read_b64_tr_b16 v[54:55], v99 offset:384
  ds_read_b64_tr_b16 v[56:57], v99 offset:32
  ds_read_b64_tr_b16 v[58:59], v99 offset:416
  ds_read_b64_tr_b16 v[60:61], v99 offset:64
  ds_read_b64_tr_b16 v[62:63], v99 offset:448
  ds_read_b64_tr_b16 v[64:65], v99 offset:3072
  ds_read_b64_tr_b16 v[66:67], v99 offset:3456
  ds_read_b64_tr_b16 v[68:69], v99 offset:3104
  ds_read_b64_tr_b16 v[70:71], v99 offset:3488
  ds_read_b64_tr_b16 v[72:73], v99 offset:3136
  ds_read_b64_tr_b16 v[74:75], v99 offset:3520
  ds_read_b64_tr_b16 v[76:77], v99 offset:6144
  ds_read_b64_tr_b16 v[78:79], v99 offset:6528
  ds_read_b64_tr_b16 v[80:81], v99 offset:6176
  ds_read_b64_tr_b16 v[82:83], v99 offset:6560
  ds_read_b64_tr_b16 v[84:85], v99 offset:6208
  ds_read_b64_tr_b16 v[86:87], v99 offset:6592
  s_waitcnt lgkmcnt(12)
  v_lshlrev_b32 v50, 16, v52
  v_and_b32 v52, 0xffff0000, v52
  v_cvt_pk_f16_f32 v52, v50, v52
  v_accvgpr_write_b32 a120, v52
  v_lshlrev_b32 v50, 16, v53
  v_and_b32 v53, 0xffff0000, v53
  v_cvt_pk_f16_f32 v53, v50, v53
  v_accvgpr_write_b32 a121, v53
  v_lshlrev_b32 v50, 16, v54
  v_and_b32 v54, 0xffff0000, v54
  v_cvt_pk_f16_f32 v54, v50, v54
  v_accvgpr_write_b32 a122, v54
  v_lshlrev_b32 v50, 16, v55
  v_and_b32 v55, 0xffff0000, v55
  v_cvt_pk_f16_f32 v55, v50, v55
  v_accvgpr_write_b32 a123, v55
  v_lshlrev_b32 v50, 16, v56
  v_and_b32 v56, 0xffff0000, v56
  v_cvt_pk_f16_f32 v56, v50, v56
  v_accvgpr_write_b32 a140, v56
  v_lshlrev_b32 v50, 16, v57
  v_and_b32 v57, 0xffff0000, v57
  v_cvt_pk_f16_f32 v57, v50, v57
  v_accvgpr_write_b32 a141, v57
  v_lshlrev_b32 v50, 16, v58
  v_and_b32 v58, 0xffff0000, v58
  v_cvt_pk_f16_f32 v58, v50, v58
  v_accvgpr_write_b32 a142, v58
  v_lshlrev_b32 v50, 16, v59
  v_and_b32 v59, 0xffff0000, v59
  v_cvt_pk_f16_f32 v59, v50, v59
  v_accvgpr_write_b32 a143, v59
  v_lshlrev_b32 v50, 16, v60
  v_and_b32 v60, 0xffff0000, v60
  v_cvt_pk_f16_f32 v60, v50, v60
  v_accvgpr_write_b32 a160, v60
  v_lshlrev_b32 v50, 16, v61
  v_and_b32 v61, 0xffff0000, v61
  v_cvt_pk_f16_f32 v61, v50, v61
  v_accvgpr_write_b32 a161, v61
  v_lshlrev_b32 v50, 16, v62
  v_and_b32 v62, 0xffff0000, v62
  v_cvt_pk_f16_f32 v62, v50, v62
  v_accvgpr_write_b32 a162, v62
  v_lshlrev_b32 v50, 16, v63
  v_and_b32 v63, 0xffff0000, v63
  v_cvt_pk_f16_f32 v63, v50, v63
  v_accvgpr_write_b32 a163, v63
  ds_read_b64_tr_b16 v[52:53], v99 offset:9216
  ds_read_b64_tr_b16 v[54:55], v99 offset:9600
  ds_read_b64_tr_b16 v[56:57], v99 offset:9248
  ds_read_b64_tr_b16 v[58:59], v99 offset:9632
  ds_read_b64_tr_b16 v[60:61], v99 offset:9280
  ds_read_b64_tr_b16 v[62:63], v99 offset:9664
  s_waitcnt lgkmcnt(12)
  v_lshlrev_b32 v50, 16, v64
  v_and_b32 v64, 0xffff0000, v64
  v_cvt_pk_f16_f32 v64, v50, v64
  v_accvgpr_write_b32 a124, v64
  v_lshlrev_b32 v50, 16, v65
  v_and_b32 v65, 0xffff0000, v65
  v_cvt_pk_f16_f32 v65, v50, v65
  v_accvgpr_write_b32 a125, v65
  v_lshlrev_b32 v50, 16, v66
  v_and_b32 v66, 0xffff0000, v66
  v_cvt_pk_f16_f32 v66, v50, v66
  v_accvgpr_write_b32 a126, v66
  v_lshlrev_b32 v50, 16, v67
  v_and_b32 v67, 0xffff0000, v67
  v_cvt_pk_f16_f32 v67, v50, v67
  v_accvgpr_write_b32 a127, v67
  v_lshlrev_b32 v50, 16, v68
  v_and_b32 v68, 0xffff0000, v68
  v_cvt_pk_f16_f32 v68, v50, v68
  v_accvgpr_write_b32 a144, v68
  v_lshlrev_b32 v50, 16, v69
  v_and_b32 v69, 0xffff0000, v69
  v_cvt_pk_f16_f32 v69, v50, v69
  v_accvgpr_write_b32 a145, v69
  v_lshlrev_b32 v50, 16, v70
  v_and_b32 v70, 0xffff0000, v70
  v_cvt_pk_f16_f32 v70, v50, v70
  v_accvgpr_write_b32 a146, v70
  v_lshlrev_b32 v50, 16, v71
  v_and_b32 v71, 0xffff0000, v71
  v_cvt_pk_f16_f32 v71, v50, v71
  v_accvgpr_write_b32 a147, v71
  v_lshlrev_b32 v50, 16, v72
  v_and_b32 v72, 0xffff0000, v72
  v_cvt_pk_f16_f32 v72, v50, v72
  v_accvgpr_write_b32 a164, v72
  v_lshlrev_b32 v50, 16, v73
  v_and_b32 v73, 0xffff0000, v73
  v_cvt_pk_f16_f32 v73, v50, v73
  v_accvgpr_write_b32 a165, v73
  v_lshlrev_b32 v50, 16, v74
  v_and_b32 v74, 0xffff0000, v74
  v_cvt_pk_f16_f32 v74, v50, v74
  v_accvgpr_write_b32 a166, v74
  v_lshlrev_b32 v50, 16, v75
  v_and_b32 v75, 0xffff0000, v75
  v_cvt_pk_f16_f32 v75, v50, v75
  v_accvgpr_write_b32 a167, v75
  ds_read_b64_tr_b16 v[64:65], v99 offset:12288
  ds_read_b64_tr_b16 v[66:67], v99 offset:12672
  ds_read_b64_tr_b16 v[68:69], v99 offset:12320
  ds_read_b64_tr_b16 v[70:71], v99 offset:12704
  ds_read_b64_tr_b16 v[72:73], v99 offset:12352
  ds_read_b64_tr_b16 v[74:75], v99 offset:12736
  s_waitcnt lgkmcnt(12)
  v_lshlrev_b32 v50, 16, v76
  v_and_b32 v76, 0xffff0000, v76
  v_cvt_pk_f16_f32 v76, v50, v76
  v_accvgpr_write_b32 a128, v76
  v_lshlrev_b32 v50, 16, v77
  v_and_b32 v77, 0xffff0000, v77
  v_cvt_pk_f16_f32 v77, v50, v77
  v_accvgpr_write_b32 a129, v77
  v_lshlrev_b32 v50, 16, v78
  v_and_b32 v78, 0xffff0000, v78
  v_cvt_pk_f16_f32 v78, v50, v78
  v_accvgpr_write_b32 a130, v78
  v_lshlrev_b32 v50, 16, v79
  v_and_b32 v79, 0xffff0000, v79
  v_cvt_pk_f16_f32 v79, v50, v79
  v_accvgpr_write_b32 a131, v79
  v_lshlrev_b32 v50, 16, v80
  v_and_b32 v80, 0xffff0000, v80
  v_cvt_pk_f16_f32 v80, v50, v80
  v_accvgpr_write_b32 a148, v80
  v_lshlrev_b32 v50, 16, v81
  v_and_b32 v81, 0xffff0000, v81
  v_cvt_pk_f16_f32 v81, v50, v81
  v_accvgpr_write_b32 a149, v81
  v_lshlrev_b32 v50, 16, v82
  v_and_b32 v82, 0xffff0000, v82
  v_cvt_pk_f16_f32 v82, v50, v82
  v_accvgpr_write_b32 a150, v82
  v_lshlrev_b32 v50, 16, v83
  v_and_b32 v83, 0xffff0000, v83
  v_cvt_pk_f16_f32 v83, v50, v83
  v_accvgpr_write_b32 a151, v83
  v_lshlrev_b32 v50, 16, v84
  v_and_b32 v84, 0xffff0000, v84
  v_cvt_pk_f16_f32 v84, v50, v84
  v_accvgpr_write_b32 a168, v84
  v_lshlrev_b32 v50, 16, v85
  v_and_b32 v85, 0xffff0000, v85
  v_cvt_pk_f16_f32 v85, v50, v85
  v_accvgpr_write_b32 a169, v85
  v_lshlrev_b32 v50, 16, v86
  v_and_b32 v86, 0xffff0000, v86
  v_cvt_pk_f16_f32 v86, v50, v86
  v_accvgpr_write_b32 a170, v86
  v_lshlrev_b32 v50, 16, v87
  v_and_b32 v87, 0xffff0000, v87
  v_cvt_pk_f16_f32 v87, v50, v87
  v_accvgpr_write_b32 a171, v87
  s_waitcnt lgkmcnt(6)
  v_lshlrev_b32 v50, 16, v52
  v_and_b32 v52, 0xffff0000, v52
  v_cvt_pk_f16_f32 v52, v50, v52
  v_accvgpr_write_b32 a132, v52
  v_lshlrev_b32 v50, 16, v53
  v_and_b32 v53, 0xffff0000, v53
  v_cvt_pk_f16_f32 v53, v50, v53
  v_accvgpr_write_b32 a133, v53
  v_lshlrev_b32 v50, 16, v54
  v_and_b32 v54, 0xffff0000, v54
  v_cvt_pk_f16_f32 v54, v50, v54
  v_accvgpr_write_b32 a134, v54
  v_lshlrev_b32 v50, 16, v55
  v_and_b32 v55, 0xffff0000, v55
  v_cvt_pk_f16_f32 v55, v50, v55
  v_accvgpr_write_b32 a135, v55
  v_lshlrev_b32 v50, 16, v56
  v_and_b32 v56, 0xffff0000, v56
  v_cvt_pk_f16_f32 v56, v50, v56
  v_accvgpr_write_b32 a152, v56
  v_lshlrev_b32 v50, 16, v57
  v_and_b32 v57, 0xffff0000, v57
  v_cvt_pk_f16_f32 v57, v50, v57
  v_accvgpr_write_b32 a153, v57
  v_lshlrev_b32 v50, 16, v58
  v_and_b32 v58, 0xffff0000, v58
  v_cvt_pk_f16_f32 v58, v50, v58
  v_accvgpr_write_b32 a154, v58
  v_lshlrev_b32 v50, 16, v59
  v_and_b32 v59, 0xffff0000, v59
  v_cvt_pk_f16_f32 v59, v50, v59
  v_accvgpr_write_b32 a155, v59
  v_lshlrev_b32 v50, 16, v60
  v_and_b32 v60, 0xffff0000, v60
  v_cvt_pk_f16_f32 v60, v50, v60
  v_accvgpr_write_b32 a172, v60
  v_lshlrev_b32 v50, 16, v61
  v_and_b32 v61, 0xffff0000, v61
  v_cvt_pk_f16_f32 v61, v50, v61
  v_accvgpr_write_b32 a173, v61
  v_lshlrev_b32 v50, 16, v62
  v_and_b32 v62, 0xffff0000, v62
  v_cvt_pk_f16_f32 v62, v50, v62
  v_accvgpr_write_b32 a174, v62
  v_lshlrev_b32 v50, 16, v63
  v_and_b32 v63, 0xffff0000, v63
  v_cvt_pk_f16_f32 v63, v50, v63
  v_accvgpr_write_b32 a175, v63
  s_waitcnt lgkmcnt(0)
  v_lshlrev_b32 v50, 16, v64
  v_and_b32 v64, 0xffff0000, v64
  v_cvt_pk_f16_f32 v64, v50, v64
  v_accvgpr_write_b32 a136, v64
  v_lshlrev_b32 v50, 16, v65
  v_and_b32 v65, 0xffff0000, v65
  v_cvt_pk_f16_f32 v65, v50, v65
  v_accvgpr_write_b32 a137, v65
  v_lshlrev_b32 v50, 16, v66
  v_and_b32 v66, 0xffff0000, v66
  v_cvt_pk_f16_f32 v66, v50, v66
  v_accvgpr_write_b32 a138, v66
  v_lshlrev_b32 v50, 16, v67
  v_and_b32 v67, 0xffff0000, v67
  v_cvt_pk_f16_f32 v67, v50, v67
  v_accvgpr_write_b32 a139, v67
  v_lshlrev_b32 v50, 16, v68
  v_and_b32 v68, 0xffff0000, v68
  v_cvt_pk_f16_f32 v68, v50, v68
  v_accvgpr_write_b32 a156, v68
  v_lshlrev_b32 v50, 16, v69
  v_and_b32 v69, 0xffff0000, v69
  v_cvt_pk_f16_f32 v69, v50, v69
  v_accvgpr_write_b32 a157, v69
  v_lshlrev_b32 v50, 16, v70
  v_and_b32 v70, 0xffff0000, v70
  v_cvt_pk_f16_f32 v70, v50, v70
  v_accvgpr_write_b32 a158, v70
  v_lshlrev_b32 v50, 16, v71
  v_and_b32 v71, 0xffff0000, v71
  v_cvt_pk_f16_f32 v71, v50, v71
  v_accvgpr_write_b32 a159, v71
  v_lshlrev_b32 v50, 16, v72
  v_and_b32 v72, 0xffff0000, v72
  v_cvt_pk_f16_f32 v72, v50, v72
  v_accvgpr_write_b32 a176, v72
  v_lshlrev_b32 v50, 16, v73
  v_and_b32 v73, 0xffff0000, v73
  v_cvt_pk_f16_f32 v73, v50, v73
  v_accvgpr_write_b32 a177, v73
  v_lshlrev_b32 v50, 16, v74
  v_and_b32 v74, 0xffff0000, v74
  v_cvt_pk_f16_f32 v74, v50, v74
  v_accvgpr_write_b32 a178, v74
  v_lshlrev_b32 v50, 16, v75
  v_and_b32 v75, 0xffff0000, v75
  v_cvt_pk_f16_f32 v75, v50, v75
  v_accvgpr_write_b32 a179, v75
  s_waitcnt vmcnt(27)
  s_cmp_lg_u32 s20, 0
  s_cbranch_scc1 ic_7
  buffer_load_dword v238, v239, s[32:35], 0 offen sc1
ic_7:
  ds_write_b128 v100, v[188:191] offset:0
  ds_write_b128 v100, v[192:195] offset:1024
  ds_write_b128 v100, v[196:199] offset:2048
  ds_write_b128 v100, v[200:203] offset:3072
  ds_write_b128 v100, v[204:207] offset:4096
  ds_write_b128 v100, v[208:211] offset:5120
  ds_write_b128 v100, v[212:215] offset:6144
  ds_write_b128 v100, v[216:219] offset:7168
  ds_write_b128 v100, v[220:223] offset:8192
  s_waitcnt lgkmcnt(0)
  ds_read_b64_tr_b16 a[192:193], v99 offset:0
  ds_read_b64_tr_b16 a[194:195], v99 offset:384
  ds_read_b64_tr_b16 a[216:217], v99 offset:32
  ds_read_b64_tr_b16 a[218:219], v99 offset:416
  ds_read_b64_tr_b16 a[240:241], v99 offset:64
  ds_read_b64_tr_b16 a[242:243], v99 offset:448
  ds_read_b64_tr_b16 a[196:197], v99 offset:3072
  ds_read_b64_tr_b16 a[198:199], v99 offset:3456
  ds_read_b64_tr_b16 a[220:221], v99 offset:3104
  ds_read_b64_tr_b16 a[222:223], v99 offset:3488
  ds_read_b64_tr_b16 a[244:245], v99 offset:3136
  ds_read_b64_tr_b16 a[246:247], v99 offset:3520
  ds_read_b64_tr_b16 a[200:201], v99 offset:6144
  ds_read_b64_tr_b16 a[202:203], v99 offset:6528
  ds_read_b64_tr_b16 a[224:225], v99 offset:6176
  ds_read_b64_tr_b16 a[226:227], v99 offset:6560
  ds_read_b64_tr_b16 a[248:249], v99 offset:6208
  ds_read_b64_tr_b16 a[250:251], v99 offset:6592
  s_waitcnt lgkmcnt(0)
  s_waitcnt vmcnt(15)
  ds_read_b64_tr_b16 a[180:181], v99 offset:30720
  ds_read_b64_tr_b16 a[182:183], v99 offset:31104
  ds_read_b64_tr_b16 a[204:205], v99 offset:30752
  ds_read_b64_tr_b16 a[206:207], v99 offset:31136
  ds_read_b64_tr_b16 a[228:229], v99 offset:30784
  ds_read_b64_tr_b16 a[230:231], v99 offset:31168
  ds_read_b64_tr_b16 a[184:185], v99 offset:33792
  ds_read_b64_tr_b16 a[186:187], v99 offset:34176
  ds_read_b64_tr_b16 a[208:209], v99 offset:33824
  ds_read_b64_tr_b16 a[210:211], v99 offset:34208
  ds_read_b64_tr_b16 a[232:233], v99 offset:33856
  ds_read_b64_tr_b16 a[234:235], v99 offset:34240
  ds_read_b64_tr_b16 a[188:189], v99 offset:36864
  ds_read_b64_tr_b16 a[190:191], v99 offset:37248
  ds_read_b64_tr_b16 a[212:213], v99 offset:36896
  ds_read_b64_tr_b16 a[214:215], v99 offset:37280
  ds_read_b64_tr_b16 a[236:237], v99 offset:36928
  ds_read_b64_tr_b16 a[238:239], v99 offset:37312
  s_waitcnt lgkmcnt(0)
  v_lshlrev_b32 v50, 16, v32
  v_and_b32 v32, 0xffff0000, v32
  v_cvt_pk_f16_f32 v32, v50, v32
  v_lshlrev_b32 v50, 16, v33
  v_and_b32 v33, 0xffff0000, v33
  v_cvt_pk_f16_f32 v33, v50, v33
  v_lshlrev_b32 v50, 16, v34
  v_and_b32 v34, 0xffff0000, v34
  v_cvt_pk_f16_f32 v34, v50, v34
  v_lshlrev_b32 v50, 16, v35
  v_and_b32 v35, 0xffff0000, v35
  v_cvt_pk_f16_f32 v35, v50, v35
  v_lshlrev_b32 v50, 16, v36
  v_and_b32 v36, 0xffff0000, v36
  v_cvt_pk_f16_f32 v36, v50, v36
  v_lshlrev_b32 v50, 16, v37
  v_and_b32 v37, 0xffff0000, v37
  v_cvt_pk_f16_f32 v37, v50, v37
  v_lshlrev_b32 v50, 16, v38
  v_and_b32 v38, 0xffff0000, v38
  v_cvt_pk_f16_f32 v38, v50, v38
  v_lshlrev_b32 v50, 16, v39
  v_and_b32 v39, 0xffff0000, v39
  v_cvt_pk_f16_f32 v39, v50, v39
  v_lshlrev_b32 v50, 16, v40
  v_and_b32 v40, 0xffff0000, v40
  v_cvt_pk_f16_f32 v40, v50, v40
  v_lshlrev_b32 v50, 16, v41
  v_and_b32 v41, 0xffff0000, v41
  v_cvt_pk_f16_f32 v41, v50, v41
  v_mov_b32 v174, 0
  v_mov_b32 v175, 0
  v_mov_b32 v218, 0
  v_mov_b32 v219, 0
  v_mov_b32 v234, 0
  v_mov_b32 v235, 0
  v_mov_b32 v220, 0
  v_mov_b32 v221, 0
  v_mov_b32 v222, 0
  v_mov_b32 v223, 0
  v_mov_b32 v224, 0
  v_mov_b32 v225, 0
  v_mov_b32 v226, 0
  v_mov_b32 v227, 0
  s_waitcnt vmcnt(12)
  ds_read_b64_tr_b16 v[52:53], v99 offset:15360
  ds_read_b64_tr_b16 v[54:55], v99 offset:15744
  ds_read_b64_tr_b16 v[56:57], v99 offset:15392
  ds_read_b64_tr_b16 v[58:59], v99 offset:15776
  ds_read_b64_tr_b16 v[60:61], v99 offset:15424
  ds_read_b64_tr_b16 v[62:63], v99 offset:15808
  s_waitcnt lgkmcnt(0)
  v_lshlrev_b32 v50, 16, v52
  v_and_b32 v52, 0xffff0000, v52
  v_cvt_pk_f16_f32 v52, v50, v52
  v_accvgpr_write_b32 a0, v52
  v_lshlrev_b32 v50, 16, v53
  v_and_b32 v53, 0xffff0000, v53
  v_cvt_pk_f16_f32 v53, v50, v53
  v_accvgpr_write_b32 a1, v53
  v_lshlrev_b32 v50, 16, v54
  v_and_b32 v54, 0xffff0000, v54
  v_cvt_pk_f16_f32 v54, v50, v54
  v_accvgpr_write_b32 a2, v54
  v_lshlrev_b32 v50, 16, v55
  v_and_b32 v55, 0xffff0000, v55
  v_cvt_pk_f16_f32 v55, v50, v55
  v_accvgpr_write_b32 a3, v55
  v_lshlrev_b32 v50, 16, v56
  v_and_b32 v56, 0xffff0000, v56
  v_cvt_pk_f16_f32 v56, v50, v56
  v_accvgpr_write_b32 a20, v56
  v_lshlrev_b32 v50, 16, v57
  v_and_b32 v57, 0xffff0000, v57
  v_cvt_pk_f16_f32 v57, v50, v57
  v_accvgpr_write_b32 a21, v57
  v_lshlrev_b32 v50, 16, v58
  v_and_b32 v58, 0xffff0000, v58
  v_cvt_pk_f16_f32 v58, v50, v58
  v_accvgpr_write_b32 a22, v58
  v_lshlrev_b32 v50, 16, v59
  v_and_b32 v59, 0xffff0000, v59
  v_cvt_pk_f16_f32 v59, v50, v59
  v_accvgpr_write_b32 a23, v59
  v_lshlrev_b32 v50, 16, v60
  v_and_b32 v60, 0xffff0000, v60
  v_cvt_pk_f16_f32 v60, v50, v60
  v_accvgpr_write_b32 a40, v60
  v_lshlrev_b32 v50, 16, v61
  v_and_b32 v61, 0xffff0000, v61
  v_cvt_pk_f16_f32 v61, v50, v61
  v_accvgpr_write_b32 a41, v61
  v_lshlrev_b32 v50, 16, v62
  v_and_b32 v62, 0xffff0000, v62
  v_cvt_pk_f16_f32 v62, v50, v62
  v_accvgpr_write_b32 a42, v62
  v_lshlrev_b32 v50, 16, v63
  v_and_b32 v63, 0xffff0000, v63
  v_cvt_pk_f16_f32 v63, v50, v63
  v_accvgpr_write_b32 a43, v63
  s_waitcnt vmcnt(9)
  ds_read_b64_tr_b16 v[64:65], v99 offset:18432
  ds_read_b64_tr_b16 v[66:67], v99 offset:18816
  ds_read_b64_tr_b16 v[68:69], v99 offset:18464
  ds_read_b64_tr_b16 v[70:71], v99 offset:18848
  ds_read_b64_tr_b16 v[72:73], v99 offset:18496
  ds_read_b64_tr_b16 v[74:75], v99 offset:18880
  s_waitcnt lgkmcnt(0)
  v_lshlrev_b32 v50, 16, v64
  v_and_b32 v64, 0xffff0000, v64
  v_cvt_pk_f16_f32 v64, v50, v64
  v_accvgpr_write_b32 a4, v64
  v_lshlrev_b32 v50, 16, v65
  v_and_b32 v65, 0xffff0000, v65
  v_cvt_pk_f16_f32 v65, v50, v65
  v_accvgpr_write_b32 a5, v65
  v_lshlrev_b32 v50, 16, v66
  v_and_b32 v66, 0xffff0000, v66
  v_cvt_pk_f16_f32 v66, v50, v66
  v_accvgpr_write_b32 a6, v66
  v_lshlrev_b32 v50, 16, v67
  v_and_b32 v67, 0xffff0000, v67
  v_cvt_pk_f16_f32 v67, v50, v67
  v_accvgpr_write_b32 a7, v67
  v_lshlrev_b32 v50, 16, v68
  v_and_b32 v68, 0xffff0000, v68
  v_cvt_pk_f16_f32 v68, v50, v68
  v_accvgpr_write_b32 a24, v68
  v_lshlrev_b32 v50, 16, v69
  v_and_b32 v69, 0xffff0000, v69
  v_cvt_pk_f16_f32 v69, v50, v69
  v_accvgpr_write_b32 a25, v69
  v_lshlrev_b32 v50, 16, v70
  v_and_b32 v70, 0xffff0000, v70
  v_cvt_pk_f16_f32 v70, v50, v70
  v_accvgpr_write_b32 a26, v70
  v_lshlrev_b32 v50, 16, v71
  v_and_b32 v71, 0xffff0000, v71
  v_cvt_pk_f16_f32 v71, v50, v71
  v_accvgpr_write_b32 a27, v71
  v_lshlrev_b32 v50, 16, v72
  v_and_b32 v72, 0xffff0000, v72
  v_cvt_pk_f16_f32 v72, v50, v72
  v_accvgpr_write_b32 a44, v72
  v_lshlrev_b32 v50, 16, v73
  v_and_b32 v73, 0xffff0000, v73
  v_cvt_pk_f16_f32 v73, v50, v73
  v_accvgpr_write_b32 a45, v73
  v_lshlrev_b32 v50, 16, v74
  v_and_b32 v74, 0xffff0000, v74
  v_cvt_pk_f16_f32 v74, v50, v74
  v_accvgpr_write_b32 a46, v74
  v_lshlrev_b32 v50, 16, v75
  v_and_b32 v75, 0xffff0000, v75
  v_cvt_pk_f16_f32 v75, v50, v75
  v_accvgpr_write_b32 a47, v75
  s_waitcnt vmcnt(6)
  ds_read_b64_tr_b16 v[76:77], v99 offset:21504
  ds_read_b64_tr_b16 v[78:79], v99 offset:21888
  ds_read_b64_tr_b16 v[80:81], v99 offset:21536
  ds_read_b64_tr_b16 v[82:83], v99 offset:21920
  ds_read_b64_tr_b16 v[84:85], v99 offset:21568
  ds_read_b64_tr_b16 v[86:87], v99 offset:21952
  s_waitcnt lgkmcnt(0)
  v_lshlrev_b32 v50, 16, v76
  v_and_b32 v76, 0xffff0000, v76
  v_cvt_pk_f16_f32 v76, v50, v76
  v_accvgpr_write_b32 a8, v76
  v_lshlrev_b32 v50, 16, v77
  v_and_b32 v77, 0xffff0000, v77
  v_cvt_pk_f16_f32 v77, v50, v77
  v_accvgpr_write_b32 a9, v77
  v_lshlrev_b32 v50, 16, v78
  v_and_b32 v78, 0xffff0000, v78
  v_cvt_pk_f16_f32 v78, v50, v78
  v_accvgpr_write_b32 a10, v78
  v_lshlrev_b32 v50, 16, v79
  v_and_b32 v79, 0xffff0000, v79
  v_cvt_pk_f16_f32 v79, v50, v79
  v_accvgpr_write_b32 a11, v79
  v_lshlrev_b32 v50, 16, v80
  v_and_b32 v80, 0xffff0000, v80
  v_cvt_pk_f16_f32 v80, v50, v80
  v_accvgpr_write_b32 a28, v80
  v_lshlrev_b32 v50, 16, v81
  v_and_b32 v81, 0xffff0000, v81
  v_cvt_pk_f16_f32 v81, v50, v81
  v_accvgpr_write_b32 a29, v81
  v_lshlrev_b32 v50, 16, v82
  v_and_b32 v82, 0xffff0000, v82
  v_cvt_pk_f16_f32 v82, v50, v82
  v_accvgpr_write_b32 a30, v82
  v_lshlrev_b32 v50, 16, v83
  v_and_b32 v83, 0xffff0000, v83
  v_cvt_pk_f16_f32 v83, v50, v83
  v_accvgpr_write_b32 a31, v83
  v_lshlrev_b32 v50, 16, v84
  v_and_b32 v84, 0xffff0000, v84
  v_cvt_pk_f16_f32 v84, v50, v84
  v_accvgpr_write_b32 a48, v84
  v_lshlrev_b32 v50, 16, v85
  v_and_b32 v85, 0xffff0000, v85
  v_cvt_pk_f16_f32 v85, v50, v85
  v_accvgpr_write_b32 a49, v85
  v_lshlrev_b32 v50, 16, v86
  v_and_b32 v86, 0xffff0000, v86
  v_cvt_pk_f16_f32 v86, v50, v86
  v_accvgpr_write_b32 a50, v86
  v_lshlrev_b32 v50, 16, v87
  v_and_b32 v87, 0xffff0000, v87
  v_cvt_pk_f16_f32 v87, v50, v87
  v_accvgpr_write_b32 a51, v87
  s_waitcnt vmcnt(3)
  ds_read_b64_tr_b16 v[52:53], v99 offset:24576
  ds_read_b64_tr_b16 v[54:55], v99 offset:24960
  ds_read_b64_tr_b16 v[56:57], v99 offset:24608
  ds_read_b64_tr_b16 v[58:59], v99 offset:24992
  ds_read_b64_tr_b16 v[60:61], v99 offset:24640
  ds_read_b64_tr_b16 v[62:63], v99 offset:25024
  s_waitcnt lgkmcnt(0)
  v_lshlrev_b32 v50, 16, v52
  v_and_b32 v52, 0xffff0000, v52
  v_cvt_pk_f16_f32 v52, v50, v52
  v_accvgpr_write_b32 a12, v52
  v_lshlrev_b32 v50, 16, v53
  v_and_b32 v53, 0xffff0000, v53
  v_cvt_pk_f16_f32 v53, v50, v53
  v_accvgpr_write_b32 a13, v53
  v_lshlrev_b32 v50, 16, v54
  v_and_b32 v54, 0xffff0000, v54
  v_cvt_pk_f16_f32 v54, v50, v54
  v_accvgpr_write_b32 a14, v54
  v_lshlrev_b32 v50, 16, v55
  v_and_b32 v55, 0xffff0000, v55
  v_cvt_pk_f16_f32 v55, v50, v55
  v_accvgpr_write_b32 a15, v55
  v_lshlrev_b32 v50, 16, v56
  v_and_b32 v56, 0xffff0000, v56
  v_cvt_pk_f16_f32 v56, v50, v56
  v_accvgpr_write_b32 a32, v56
  v_lshlrev_b32 v50, 16, v57
  v_and_b32 v57, 0xffff0000, v57
  v_cvt_pk_f16_f32 v57, v50, v57
  v_accvgpr_write_b32 a33, v57
  v_lshlrev_b32 v50, 16, v58
  v_and_b32 v58, 0xffff0000, v58
  v_cvt_pk_f16_f32 v58, v50, v58
  v_accvgpr_write_b32 a34, v58
  v_lshlrev_b32 v50, 16, v59
  v_and_b32 v59, 0xffff0000, v59
  v_cvt_pk_f16_f32 v59, v50, v59
  v_accvgpr_write_b32 a35, v59
  v_lshlrev_b32 v50, 16, v60
  v_and_b32 v60, 0xffff0000, v60
  v_cvt_pk_f16_f32 v60, v50, v60
  v_accvgpr_write_b32 a52, v60
  v_lshlrev_b32 v50, 16, v61
  v_and_b32 v61, 0xffff0000, v61
  v_cvt_pk_f16_f32 v61, v50, v61
  v_accvgpr_write_b32 a53, v61
  v_lshlrev_b32 v50, 16, v62
  v_and_b32 v62, 0xffff0000, v62
  v_cvt_pk_f16_f32 v62, v50, v62
  v_accvgpr_write_b32 a54, v62
  v_lshlrev_b32 v50, 16, v63
  v_and_b32 v63, 0xffff0000, v63
  v_cvt_pk_f16_f32 v63, v50, v63
  v_accvgpr_write_b32 a55, v63
  s_waitcnt vmcnt(0)
  ds_read_b64_tr_b16 v[64:65], v99 offset:27648
  ds_read_b64_tr_b16 v[66:67], v99 offset:28032
  ds_read_b64_tr_b16 v[68:69], v99 offset:27680
  ds_read_b64_tr_b16 v[70:71], v99 offset:28064
  ds_read_b64_tr_b16 v[72:73], v99 offset:27712
  ds_read_b64_tr_b16 v[74:75], v99 offset:28096
  s_waitcnt lgkmcnt(0)
  v_lshlrev_b32 v50, 16, v64
  v_and_b32 v64, 0xffff0000, v64
  v_cvt_pk_f16_f32 v64, v50, v64
  v_accvgpr_write_b32 a16, v64
  v_lshlrev_b32 v50, 16, v65
  v_and_b32 v65, 0xffff0000, v65
  v_cvt_pk_f16_f32 v65, v50, v65
  v_accvgpr_write_b32 a17, v65
  v_lshlrev_b32 v50, 16, v66
  v_and_b32 v66, 0xffff0000, v66
  v_cvt_pk_f16_f32 v66, v50, v66
  v_accvgpr_write_b32 a18, v66
  v_lshlrev_b32 v50, 16, v67
  v_and_b32 v67, 0xffff0000, v67
  v_cvt_pk_f16_f32 v67, v50, v67
  v_accvgpr_write_b32 a19, v67
  v_lshlrev_b32 v50, 16, v68
  v_and_b32 v68, 0xffff0000, v68
  v_cvt_pk_f16_f32 v68, v50, v68
  v_accvgpr_write_b32 a36, v68
  v_lshlrev_b32 v50, 16, v69
  v_and_b32 v69, 0xffff0000, v69
  v_cvt_pk_f16_f32 v69, v50, v69
  v_accvgpr_write_b32 a37, v69
  v_lshlrev_b32 v50, 16, v70
  v_and_b32 v70, 0xffff0000, v70
  v_cvt_pk_f16_f32 v70, v50, v70
  v_accvgpr_write_b32 a38, v70
  v_lshlrev_b32 v50, 16, v71
  v_and_b32 v71, 0xffff0000, v71
  v_cvt_pk_f16_f32 v71, v50, v71
  v_accvgpr_write_b32 a39, v71
  v_lshlrev_b32 v50, 16, v72
  v_and_b32 v72, 0xffff0000, v72
  v_cvt_pk_f16_f32 v72, v50, v72
  v_accvgpr_write_b32 a56, v72
  v_lshlrev_b32 v50, 16, v73
  v_and_b32 v73, 0xffff0000, v73
  v_cvt_pk_f16_f32 v73, v50, v73
  v_accvgpr_write_b32 a57, v73
  v_lshlrev_b32 v50, 16, v74
  v_and_b32 v74, 0xffff0000, v74
  v_cvt_pk_f16_f32 v74, v50, v74
  v_accvgpr_write_b32 a58, v74
  v_lshlrev_b32 v50, 16, v75
  v_and_b32 v75, 0xffff0000, v75
  v_cvt_pk_f16_f32 v75, v50, v75
  v_accvgpr_write_b32 a59, v75
  s_waitcnt vmcnt(0)
  s_barrier
  s_add_u32 s12, s44, 81068032
  s_addc_u32 s13, s45, 0
  s_mov_b32 s14, 116736
  s_mov_b32 s15, 0x00020000
  s_add_u32 s28, s44, 114294784
  s_addc_u32 s29, s45, 0
  s_mov_b32 s30, 83886080
  s_mov_b32 s31, 0x00020000
  s_mul_i32 s64, s59, 40960
  s_lshl_b32 s21, s87, 10
  s_add_u32 s64, s64, s21
  s_add_u32 s64, s64, 1310720
  s_lshl_b32 s79, s59, 7
  s_and_b32 s21, s51, 12
  s_add_u32 s79, s79, s21
  s_add_u32 s79, s79, 95232
  v_mov_b32 v94, 0
  v_mov_b32 v95, 0
  s_lshl_b32 s90, s58, 7
  s_lshl_b32 s21, s56, 3
  s_add_u32 s90, s90, s21
  s_add_u32 s90, s90, 19456
  s_cmp_eq_u32 s56, 0
  s_cselect_b32 s65, s90, 0x80000000
  s_mov_b32 s69, 0
  v_lshlrev_b32 v88, 3, v1
  s_cmp_lg_u32 s20, 0
  s_cbranch_scc1 fm_9
  s_bfe_u32 s82, s50, 0x10001
  s_lshl_b32 s82, s82, 5
  s_lshr_b32 s21, s50, 2
  s_add_u32 s82, s82, s21
  s_and_b32 s80, s50, 1
  s_lshl_b32 s80, s80, 4
  s_add_u32 s80, s80, 16
  s_mov_b32 s101, 0
  s_branch fm_10
fm_8:
  s_sleep 8
  buffer_load_dword v238, v239, s[32:35], 0 offen sc1
  s_add_u32 s101, s101, 1
  s_cmp_gt_u32 s101, 131072
  s_cbranch_scc1 end0
  s_waitcnt vmcnt(0)
fm_10:
  v_readlane_b32 s22, v238, 0
  v_readlane_b32 s23, v238, 32
  s_add_u32 s22, s22, s23
  v_readlane_b32 s23, v238, 1
  s_add_u32 s22, s22, s23
  v_readlane_b32 s23, v238, 33
  s_add_u32 s22, s22, s23
  v_readlane_b32 s23, v238, 2
  s_add_u32 s22, s22, s23
  v_readlane_b32 s23, v238, 34
  s_add_u32 s22, s22, s23
  v_readlane_b32 s23, v238, 3
  s_add_u32 s22, s22, s23
  v_readlane_b32 s23, v238, 35
  s_add_u32 s22, s22, s23
  v_readlane_b32 s21, v238, 19
  v_readlane_b32 s23, v238, 21
  s_cmp_ge_u32 s22, 256
  s_cselect_b32 s23, s23, 0
  s_cmp_ge_u32 s21, 32
  s_cselect_b32 s23, s23, 0
  s_cmp_eq_u32 s23, 0
  s_cbranch_scc1 fm_8
  v_readlane_b32 s21, v238, s82
  s_cmp_ge_u32 s21, s80
  s_cselect_b32 s81, 1, 0
  s_andn2_b32 s53, s81, s53
  v_mov_b32 v244, s23
  v_mov_b32 v245, s53
  v_mov_b32 v236, 0
  ds_write_b64 v236, v[244:245]
  s_waitcnt lgkmcnt(0)
fm_9:
  s_barrier
  v_mov_b32 v236, 0
  ds_read_b64 v[244:245], v236
  buffer_load_dword v94, v95, s[12:15], s79 offen sc1
  s_and_b32 s21, s51, 3
  s_mul_i32 s21, s21, 540672
  buffer_load_dwordx2 v[96:97], v9, s[8:11], s21 offen sc1
  buffer_load_dwordx4 v[96:99], v8, s[8:11], s21 offen offset:0 sc1
  buffer_load_dwordx4 v[96:99], v8, s[8:11], s21 offen offset:1024 sc1
  buffer_load_dwordx4 v[96:99], v10, s[8:11], s21 offen offset:0 sc1
  buffer_load_dwordx4 v[96:99], v10, s[8:11], s21 offen offset:1024 sc1
  buffer_load_dwordx4 v[96:99], v10, s[8:11], s21 offen offset:2048 sc1
  s_waitcnt lgkmcnt(0)
  v_readfirstlane_b32 s53, v245
  v_add_u32 v237, -1, v244
  v_lshlrev_b32 v237, 13, v237
  v_xor_b32 v237, 0, v237
  v_add_u32 v13, v13, v237
  v_add_u32 v4, v4, v237
  s_lshl_b32 s21, s50, 7
  s_add_u32 s21, s21, 0
  s_cmp_lg_u32 s20, 0
  s_cbranch_scc1 wf_12
  v_mov_b32 v240, 0
  s_mov_b32 s101, 0
wf_11:
  buffer_load_dword v241, v240, s[12:15], s21 offen sc1
  s_add_u32 s101, s101, 1
  s_cmp_gt_u32 s101, 131072
  s_cbranch_scc1 end0
  s_waitcnt vmcnt(0)
  v_readfirstlane_b32 s100, v241
  s_cmp_ge_u32 s100, 8
  s_cbranch_scc1 wf_12
  s_sleep 6
  s_branch wf_11
wf_12:
  s_barrier
  s_cmp_ge_u32 s20, 2
  s_cbranch_scc1 pf_13
  buffer_load_dwordx4 v[168:171], v18, s[16:19], 0 offen sc1
  buffer_load_dwordx2 v[172:173], v20, s[16:19], 0 offen sc1
pf_13:
  s_waitcnt vmcnt(6)
  v_readfirstlane_b32 s21, v94
  s_mov_b32 s87, 1
  s_cmp_eq_u32 s21, 0
  s_cbranch_scc1 pf_14
  s_mov_b32 s87, 0
  s_sub_u32 s21, s64, 1310720
  buffer_load_dwordx4 v[176:179], v16, s[28:31], s21 offen offset:0 sc1
  buffer_load_dwordx4 v[180:183], v16, s[28:31], s21 offen offset:1024 sc1
  buffer_load_dwordx4 v[184:187], v16, s[28:31], s21 offen offset:2048 sc1
pf_14:
  s_lshl_b32 s21, s20, 2
  s_add_u32 s21, s21, 34816
  v_add_u32 v242, s21, v16
  v_bfe_u32 v243, v1, 2, 3
  v_lshlrev_b32 v243, 4, v243
  v_add_u32 v243, 34816, v243
  s_mov_b32 s52, 0
  s_mov_b32 s89, 0x05040100
  v_mov_b32 v52, 0
  v_mov_b32 v53, 0
  v_mov_b32 v54, 0
  v_mov_b32 v55, 0
  v_mov_b32 v56, 0
  v_mov_b32 v57, 0
  v_mov_b32 v58, 0
  v_mov_b32 v59, 0
  v_mov_b32 v60, 0
  v_mov_b32 v61, 0
  v_mov_b32 v62, 0
  v_mov_b32 v63, 0
  v_mov_b32 v64, 0
  v_mov_b32 v65, 0
  v_mov_b32 v66, 0
  v_mov_b32 v67, 0
  v_mov_b32 v68, 0
  v_mov_b32 v69, 0
  v_mov_b32 v70, 0
  v_mov_b32 v71, 0
  v_mov_b32 v72, 0
  v_mov_b32 v73, 0
  v_mov_b32 v74, 0
  v_mov_b32 v75, 0
  v_mov_b32 v76, 0
  v_mov_b32 v77, 0
  v_mov_b32 v78, 0
  v_mov_b32 v79, 0
  v_mov_b32 v80, 0
  v_mov_b32 v81, 0
  v_mov_b32 v82, 0
  v_mov_b32 v83, 0
  v_mov_b32 v84, 0
  v_mov_b32 v85, 0
  v_mov_b32 v86, 0
  v_mov_b32 v87, 0
  v_mov_b32 v156, 0
  v_mov_b32 v157, 0
  v_mov_b32 v158, 0
  v_mov_b32 v159, 0
  s_and_b32 s21, s52, 3
  s_mul_i32 s81, s21, 540672
  s_lshl_b32 s84, s21, 15
  s_add_u32 s21, s52, 2
  s_and_b32 s21, s21, 3
  s_mul_i32 s82, s21, 540672
  s_add_u32 s21, s52, 3
  s_and_b32 s21, s21, 3
  s_lshl_b32 s83, s21, 15
  s_add_u32 s21, s52, 1
  s_and_b32 s22, s21, 3
  s_lshl_b32 s3, s22, 15
  s_mul_i32 s80, s21, 393216
  s_add_u32 s46, s21, 1
  s_min_u32 s46, s46, 64
  s_mul_i32 s85, s52, 98304
  s_mul_i32 s57, s52, 327680
  s_add_u32 s57, s57, 42991616

  s_bfe_u32 s88, s52, 0x10002
  s_add_u32 s78, s81, 278528
  s_max_u32 s21, s52, 1
  s_sub_u32 s21, s21, 1
  s_cmp_lt_u32 s52, 98
  s_cselect_b32 s66, s65, 0x80000000
  s_cselect_b32 s68, 15, 1
  s_cmp_ge_u32 s52, 99
  s_cselect_b32 s66, s90, s66
  s_cselect_b32 s67, s52, s21
  s_cmp_eq_u32 s53, 0
  s_cbranch_scc1 A1_19
  s_cmp_eq_u32 s20, 0
  s_cbranch_scc1 A1_15
  s_cmp_eq_u32 s20, 1
  s_cbranch_scc1 A1_16
  s_cmp_eq_u32 s20, 2
  s_cbranch_scc1 A1_17
  s_cmp_eq_u32 s20, 3
  s_cbranch_scc1 A1_18
  s_branch A1_19
step_20:
  s_add_u32 s21, s52, 2
  s_and_b32 s21, s21, 3
  s_mul_i32 s82, s21, 540672
  s_add_u32 s21, s52, 3
  s_and_b32 s21, s21, 3
  s_lshl_b32 s83, s21, 15
  s_add_u32 s21, s52, 1
  s_and_b32 s22, s21, 3
  s_lshl_b32 s3, s22, 15
  s_mul_i32 s80, s21, 393216
  s_add_u32 s46, s21, 1
  s_min_u32 s46, s46, 64
  s_mul_i32 s85, s52, 98304
  s_mul_i32 s57, s52, 327680
  s_add_u32 s57, s57, 42991616

  s_bfe_u32 s88, s52, 0x10002
  s_add_u32 s78, s81, 278528
  s_max_u32 s21, s52, 1
  s_sub_u32 s21, s21, 1
  s_cmp_lt_u32 s52, 98
  s_cselect_b32 s66, s65, 0x80000000
  s_cselect_b32 s68, 15, 1
  s_cmp_ge_u32 s52, 99
  s_cselect_b32 s66, s90, s66
  s_cselect_b32 s67, s52, s21
  v_mov_b32 v52, 0
  v_mov_b32 v53, 0
  v_mov_b32 v54, 0
  v_mov_b32 v55, 0
  v_mov_b32 v56, 0
  v_mov_b32 v57, 0
  v_mov_b32 v58, 0
  v_mov_b32 v59, 0
  v_mov_b32 v60, 0
  v_mov_b32 v61, 0
  v_mov_b32 v62, 0
  v_mov_b32 v63, 0
  v_mov_b32 v64, 0
  v_mov_b32 v65, 0
  v_mov_b32 v66, 0
  v_mov_b32 v67, 0
  v_mov_b32 v68, 0
  v_mov_b32 v69, 0
  v_mov_b32 v70, 0
  v_mov_b32 v71, 0
  v_mov_b32 v72, 0
  v_mov_b32 v73, 0
  v_mov_b32 v74, 0
  v_mov_b32 v75, 0
  v_mov_b32 v76, 0
  v_mov_b32 v77, 0
  v_mov_b32 v78, 0
  v_mov_b32 v79, 0
  v_mov_b32 v80, 0
  v_mov_b32 v81, 0
  v_mov_b32 v82, 0
  v_mov_b32 v83, 0
  v_mov_b32 v84, 0
  v_mov_b32 v85, 0
  v_mov_b32 v86, 0
  v_mov_b32 v87, 0
  s_sleep 4
  s_cmp_lt_i32 s55, 0
  s_cbranch_scc1 fl_24
fl_25:
  s_mov_b32 s54, 0
  buffer_load_dwordx4 v[32:35], v4, s[4:7], s84 offen offset:0 sc1
  buffer_load_dwordx4 v[36:39], v4, s[4:7], s84 offen offset:1024 sc1
  buffer_load_dwordx4 v[40:43], v4, s[4:7], s84 offen offset:2048 sc1
  s_waitcnt vmcnt(3)
  v_mov_b32 v176, v160
  v_mov_b32 v177, v161
  v_mov_b32 v178, v162
  v_mov_b32 v179, v163
  v_mov_b32 v180, v164
  v_mov_b32 v181, v165
  v_mov_b32 v182, v166
  v_mov_b32 v183, v167
  v_mov_b32 v184, v48
  v_mov_b32 v185, v49
  v_mov_b32 v186, v50
  v_mov_b32 v187, v51
  s_waitcnt vmcnt(0)
  v_bitop3_b32 v27, v35, v39, v43 bitop3:0x80
  v_perm_b32 v35, v39, v35, s89
  v_cmp_gt_u32 vcc, 0x48000000, v27
  v_mov_b32 v39, v42
  s_cbranch_vccnz pm_22
A1_15:
  v_smfmac_f32_16x16x32_f16 v[52:55], v[40:41], a[16:19], v44
  v_smfmac_f32_16x16x32_f16 v[64:67], v[40:41], a[76:79], v44
  v_smfmac_f32_16x16x32_f16 v[56:59], v[40:41], a[36:39], v44
  v_smfmac_f32_16x16x32_f16 v[68:71], v[40:41], a[96:99], v44
  v_smfmac_f32_16x16x64_f16 v[52:55], v[32:35], a[0:7], v44
  v_smfmac_f32_16x16x64_f16 v[52:55], v[36:39], a[8:15], v44
  v_smfmac_f32_16x16x64_f16 v[64:67], v[32:35], a[60:67], v44
  v_smfmac_f32_16x16x64_f16 v[64:67], v[36:39], a[68:75], v44
  v_smfmac_f32_16x16x32_f16 v[60:63], v[40:41], a[56:59], v44
  v_cvt_pk_f16_f32 v52, v52, v53
  v_cvt_pk_f16_f32 v53, v54, v55
  v_smfmac_f32_16x16x32_f16 v[72:75], v[40:41], a[116:119], v44
  v_smfmac_f32_16x16x32_f16 v[76:79], v[40:41], a[136:139], v44
  v_cvt_pk_f16_f32 v64, v64, v65
  v_cvt_pk_f16_f32 v65, v66, v67
  s_nop 0
  v_smfmac_f32_16x16x64_f16 v[56:59], v[32:35], a[20:27], v44
  v_permlane32_swap_b32 v52, v64
  v_smfmac_f32_16x16x64_f16 v[56:59], v[36:39], a[28:35], v44
  v_permlane32_swap_b32 v53, v65
  v_pk_add_f16 v52, v52, v64
  v_smfmac_f32_16x16x64_f16 v[68:71], v[32:35], a[80:87], v44
  v_pk_add_f16 v53, v53, v65
  v_smfmac_f32_16x16x64_f16 v[68:71], v[36:39], a[88:95], v44
  ds_write_b64 v5, v[52:53] offset:0
  v_smfmac_f32_16x16x32_f16 v[80:83], v[40:41], a[156:159], v44
  v_cvt_pk_f16_f32 v56, v56, v57
  v_cvt_pk_f16_f32 v57, v58, v59
  v_smfmac_f32_16x16x32_f16 v[84:87], v[40:41], a[176:179], v44
  v_cvt_pk_f16_f32 v68, v68, v69
  v_cvt_pk_f16_f32 v69, v70, v71
  s_nop 0
  v_smfmac_f32_16x16x64_f16 v[60:63], v[32:35], a[40:47], v44
  v_permlane32_swap_b32 v56, v68
  v_smfmac_f32_16x16x64_f16 v[60:63], v[36:39], a[48:55], v44
  v_permlane32_swap_b32 v57, v69
  v_pk_add_f16 v56, v56, v68
  v_smfmac_f32_16x16x64_f16 v[72:75], v[32:35], a[100:107], v44
  v_pk_add_f16 v57, v57, v69
  v_smfmac_f32_16x16x64_f16 v[72:75], v[36:39], a[108:115], v44
  ds_write_b64 v5, v[56:57] offset:640
  v_smfmac_f32_16x16x64_f16 v[76:79], v[32:35], a[120:127], v44
  v_cvt_pk_f16_f32 v60, v60, v61
  v_cvt_pk_f16_f32 v61, v62, v63
  v_smfmac_f32_16x16x64_f16 v[76:79], v[36:39], a[128:135], v44
  v_cvt_pk_f16_f32 v72, v72, v73
  v_cvt_pk_f16_f32 v73, v74, v75
  s_nop 0
  v_smfmac_f32_16x16x64_f16 v[80:83], v[32:35], a[140:147], v44
  v_permlane32_swap_b32 v60, v72
  v_smfmac_f32_16x16x64_f16 v[80:83], v[36:39], a[148:155], v44
  v_permlane32_swap_b32 v61, v73
  v_pk_add_f16 v60, v60, v72
  v_smfmac_f32_16x16x64_f16 v[84:87], v[32:35], a[160:167], v44
  v_pk_add_f16 v61, v61, v73
  v_smfmac_f32_16x16x64_f16 v[84:87], v[36:39], a[168:175], v44
  ds_write_b64 v5, v[60:61] offset:1280
  v_cvt_pk_f16_f32 v76, v76, v77
  v_cvt_pk_f16_f32 v77, v78, v79
  v_cvt_pk_f16_f32 v80, v80, v81
  v_cvt_pk_f16_f32 v81, v82, v83
  s_nop 0
  v_permlane32_swap_b32 v76, v80
  v_permlane32_swap_b32 v77, v81
  v_pk_add_f16 v76, v76, v80
  v_pk_add_f16 v77, v77, v81
  ds_write_b64 v5, v[76:77] offset:1920
  v_cvt_pk_f16_f32 v84, v84, v85
  v_cvt_pk_f16_f32 v85, v86, v87
  ds_write_b64 v5, v[84:85] offset:2560
  s_waitcnt lgkmcnt(0) vmcnt(0)
  s_barrier
  ds_read_b64_tr_b16 v[104:105], v45 offset:0
  ds_read_b64_tr_b16 v[106:107], v45 offset:3200
  ds_read_b64_tr_b16 v[108:109], v45 offset:640
  ds_read_b64_tr_b16 v[110:111], v45 offset:3840
  ds_read_b64_tr_b16 v[112:113], v45 offset:1280
  ds_read_b64_tr_b16 v[114:115], v45 offset:4480
  s_waitcnt lgkmcnt(4)
  v_fma_mix_f32 v120, v104, 1.0, v106 op_sel:[0,0,0] op_sel_hi:[1,0,1]
  v_fma_mix_f32 v121, v104, 1.0, v106 op_sel:[1,0,1] op_sel_hi:[1,0,1]
  v_fma_mix_f32 v122, v105, 1.0, v107 op_sel:[0,0,0] op_sel_hi:[1,0,1]
  v_fma_mix_f32 v123, v105, 1.0, v107 op_sel:[1,0,1] op_sel_hi:[1,0,1]
  v_add_f32_dpp v124, v120, v120 row_ror:8 row_mask:0xf bank_mask:0xf
  v_add_f32_dpp v125, v121, v121 row_ror:8 row_mask:0xf bank_mask:0xf
  v_add_f32_dpp v126, v122, v122 row_ror:8 row_mask:0xf bank_mask:0xf
  v_add_f32_dpp v127, v123, v123 row_ror:8 row_mask:0xf bank_mask:0xf
  v_cvt_pk_bf16_f32 v212, v124, v125
  v_cvt_pk_bf16_f32 v213, v126, v127
  s_waitcnt lgkmcnt(2)
  v_fma_mix_f32 v120, v108, 1.0, v110 op_sel:[0,0,0] op_sel_hi:[1,0,1]
  v_fma_mix_f32 v121, v108, 1.0, v110 op_sel:[1,0,1] op_sel_hi:[1,0,1]
  v_fma_mix_f32 v122, v109, 1.0, v111 op_sel:[0,0,0] op_sel_hi:[1,0,1]
  v_fma_mix_f32 v123, v109, 1.0, v111 op_sel:[1,0,1] op_sel_hi:[1,0,1]
  v_add_f32_dpp v124, v120, v120 row_ror:8 row_mask:0xf bank_mask:0xf
  v_add_f32_dpp v125, v121, v121 row_ror:8 row_mask:0xf bank_mask:0xf
  v_add_f32_dpp v126, v122, v122 row_ror:8 row_mask:0xf bank_mask:0xf
  v_add_f32_dpp v127, v123, v123 row_ror:8 row_mask:0xf bank_mask:0xf
  v_cvt_pk_bf16_f32 v214, v124, v125
  v_cvt_pk_bf16_f32 v215, v126, v127
  s_waitcnt lgkmcnt(0)
  v_fma_mix_f32 v120, v112, 1.0, v114 op_sel:[0,0,0] op_sel_hi:[1,0,1]
  v_fma_mix_f32 v121, v112, 1.0, v114 op_sel:[1,0,1] op_sel_hi:[1,0,1]
  v_fma_mix_f32 v122, v113, 1.0, v115 op_sel:[0,0,0] op_sel_hi:[1,0,1]
  v_fma_mix_f32 v123, v113, 1.0, v115 op_sel:[1,0,1] op_sel_hi:[1,0,1]
  v_mfma_f32_16x16x32_bf16 v[96:99], v[168:171], v[212:215], 0
  v_add_f32_dpp v124, v120, v120 row_ror:8 row_mask:0xf bank_mask:0xf
  v_add_f32_dpp v125, v121, v121 row_ror:8 row_mask:0xf bank_mask:0xf
  v_add_f32_dpp v126, v122, v122 row_ror:8 row_mask:0xf bank_mask:0xf
  v_add_f32_dpp v127, v123, v123 row_ror:8 row_mask:0xf bank_mask:0xf
  v_cvt_pk_bf16_f32 v216, v124, v125
  v_cvt_pk_bf16_f32 v217, v126, v127
  s_nop 1
  v_mfma_f32_16x16x32_bf16 v[96:99], v[172:175], v[216:219], v[96:99]
  s_mov_b64 exec, s[74:75]
  s_nop 6
  v_cvt_pk_f16_f32 v100, v96, v97
  v_cvt_pk_f16_f32 v101, v98, v99
  v_and_or_b32 v100, v100, -2, s88
  buffer_store_dwordx2 v[100:101], v7, s[8:11], s81 offen
  s_mov_b64 exec, -1
  s_cmp_eq_u32 s52, 63
  s_cbranch_scc1 last_21
  s_sleep 4
  s_nop 7
  s_mov_b32 s54, 0
  buffer_load_dwordx2 v[248:249], v9, s[8:11], s81 offen sc1
  buffer_load_dwordx4 v[112:115], v8, s[8:11], s81 offen offset:0 sc1
  buffer_load_dwordx4 v[116:119], v8, s[8:11], s81 offen offset:1024 sc1
  s_sleep 2
  buffer_load_dwordx4 v[144:147], v10, s[8:11], s81 offen offset:0 sc1
  buffer_load_dwordx4 v[148:151], v10, s[8:11], s81 offen offset:1024 sc1
  buffer_load_dwordx4 v[152:155], v10, s[8:11], s81 offen offset:2048 sc1
  v_mov_b32 v188, 0
  v_mov_b32 v189, 0
  v_mov_b32 v190, 0
  v_mov_b32 v191, 0
  v_mov_b32 v192, 0
  v_mov_b32 v193, 0
  v_mov_b32 v194, 0
  v_mov_b32 v195, 0
  v_mov_b32 v196, 0
  v_mov_b32 v197, 0
  v_mov_b32 v198, 0
  v_mov_b32 v199, 0
  v_readfirstlane_b32 s21, v94
  s_add_u32 s22, s46, 2
  s_min_u32 s22, s22, 64
  s_sub_u32 s55, s21, s22
  s_sub_u32 s56, s21, s46
  s_cmp_lt_i32 s56, 0
  s_cbranch_scc1 kvw_30
kvok_31:
  s_waitcnt vmcnt(5)
  v_xor_b32 v96, s88, v248
  s_nop 0
  v_permlane16_swap_b32 v248, v249
  v_fma_mix_f32 v250, v248, 1.0, v249 op_sel:[0,0,0] op_sel_hi:[1,0,1]
  v_fma_mix_f32 v251, v248, 1.0, v249 op_sel:[1,0,1] op_sel_hi:[1,0,1]
  v_mov_b32 v248, v250
  v_mov_b32 v249, v251
  s_nop 0
  v_permlane32_swap_b32 v248, v250
  v_permlane32_swap_b32 v249, v251
  v_pk_add_f32 v[124:125], v[248:249], v[250:251]
  v_max_f32 v238, v124, v125
  s_waitcnt vmcnt(3)
  v_pk_add_f16 v100, v112, v116
  v_pk_add_f16 v102, v114, v118
  v_pk_add_f16 v101, v113, v117
  v_pk_add_f16 v103, v115, v119
  v_permlane32_swap_b32 v100, v102
  v_bitop3_b32 v97, v112, v114, s88 bitop3:0x7e
  v_permlane32_swap_b32 v101, v103
  v_bitop3_b32 v98, v116, v118, s88 bitop3:0x7e
  v_fma_mix_f32 v120, v100, 1.0, v102 op_sel:[0,0,0] op_sel_hi:[1,0,1]
  v_or3_b32 v27, v96, v97, v98
  v_fma_mix_f32 v121, v100, 1.0, v102 op_sel:[1,0,1] op_sel_hi:[1,0,1]
  v_and_b32 v27, 1, v27
  v_fma_mix_f32 v122, v101, 1.0, v103 op_sel:[0,0,0] op_sel_hi:[1,0,1]
  v_cmp_ne_u32 vcc, 0, v27
  v_fma_mix_f32 v123, v101, 1.0, v103 op_sel:[1,0,1] op_sel_hi:[1,0,1]
  v_max3_f32 v236, v120, v121, v238
  s_cbranch_vccnz psr_27
psj_28:
  v_max3_f32 v236, v236, v122, v123
  s_nop 1
  v_max_f32_dpp v236, v236, v236 row_ror:8 row_mask:0xf bank_mask:0xf
  v_mov_b32 v237, v236
  s_waitcnt vmcnt(0)
  v_max3_u32 v27, v144, v146, v148
  v_permlane32_swap_b32 v236, v237
  v_max_f32 v236, v236, v237
  v_mov_b32 v237, v236
  v_max3_u32 v27, v27, v150, v152
  v_max_u32 v27, v27, v154
  v_permlane16_swap_b32 v236, v237
  v_cmp_eq_u32 vcc, -1, v27
  v_max_f32 v236, v236, v237
  v_mul_f32 v236, s86, v236
  s_cbranch_vccnz pv_26
pvj_29:
  v_smfmac_f32_16x16x64_bf16 v[188:191], v[144:147], a[180:187], v44
  v_fma_f32 v120, v120, s86, -v236
  v_smfmac_f32_16x16x64_bf16 v[188:191], v[148:151], a[188:195], v44
  v_fma_f32 v121, v121, s86, -v236
  v_smfmac_f32_16x16x64_bf16 v[188:191], v[152:155], a[196:203], v44
  buffer_load_dwordx4 v[160:163], v17, s[28:31], s64 offen offset:0 sc1
  v_fma_f32 v122, v122, s86, -v236
  v_smfmac_f32_16x16x64_bf16 v[192:195], v[144:147], a[204:211], v44
  v_fma_f32 v123, v123, s86, -v236
  v_smfmac_f32_16x16x64_bf16 v[192:195], v[148:151], a[212:219], v44
  buffer_load_dwordx4 v[164:167], v16, s[28:31], s64 offen offset:1024 sc1
  v_fma_f32 v124, v124, s86, -v236
  v_smfmac_f32_16x16x64_bf16 v[192:195], v[152:155], a[220:227], v44
  v_fma_f32 v125, v125, s86, -v236
  v_smfmac_f32_16x16x64_bf16 v[196:199], v[144:147], a[228:235], v44
  buffer_load_dwordx4 v[48:51], v26, s[28:31], s64 offen offset:2048 sc1
  v_exp_f32 v120, v120
  v_smfmac_f32_16x16x64_bf16 v[196:199], v[148:151], a[236:243], v44
  v_exp_f32 v121, v121
  v_smfmac_f32_16x16x64_bf16 v[196:199], v[152:155], a[244:251], v44
  buffer_load_dwordx4 v[168:171], v18, s[16:19], s80 offen sc1
  v_exp_f32 v122, v122
  buffer_load_dwordx2 v[172:173], v20, s[16:19], s80 offen sc1
  v_exp_f32 v123, v123
  v_exp_f32 v124, v124
  v_exp_f32 v125, v125
  v_cvt_pk_bf16_f32 v220, v120, v121
  v_cvt_pk_bf16_f32 v221, v122, v123
  v_cvt_pk_bf16_f32 v224, v124, v125
  v_mov_b32_dpp v222, v220 row_ror:8 row_mask:0xf bank_mask:0xf
  v_mov_b32_dpp v223, v221 row_ror:8 row_mask:0xf bank_mask:0xf
  v_mov_b32_dpp v225, v224 row_ror:8 row_mask:0xf bank_mask:0xf
  v_cvt_pk_bf16_f32 v228, v188, v189
  v_mfma_f32_16x16x32_bf16 v[200:203], v[176:179], v[220:223], 0
  v_cvt_pk_bf16_f32 v229, v190, v191
  v_cvt_pk_bf16_f32 v230, v192, v193
  v_mfma_f32_16x16x32_bf16 v[204:207], v[180:183], v[220:223], 0
  v_cvt_pk_bf16_f32 v231, v194, v195
  v_cvt_pk_bf16_f32 v232, v196, v197
  v_mfma_f32_16x16x32_bf16 v[208:211], v[184:187], v[220:223], 0
  v_cvt_pk_bf16_f32 v233, v198, v199
  v_add_f32 v126, v120, v121
  v_mfma_f32_16x16x32_bf16 v[200:203], v[228:231], v[224:227], v[200:203]
  v_add_f32 v127, v122, v123
  v_add_f32 v128, v124, v125
  v_mfma_f32_16x16x32_bf16 v[204:207], v[230:233], v[224:227], v[204:207]
  v_add_f32 v236, v126, v127
  v_fmac_f32 v236, v128, v89
  v_mfma_f32_16x16x32_bf16 v[208:211], v[232:235], v[224:227], v[208:211]
  s_nop 0
  v_add_f32_dpp v236, v236, v236 row_ror:8 row_mask:0xf bank_mask:0xf
  v_mov_b32 v237, v236
  ds_write_b128 v11, v[200:203] offset:0
  s_nop 0
  v_permlane32_swap_b32 v236, v237
  v_add_f32 v236, v236, v237
  v_mov_b32 v237, v236
  ds_write_b128 v11, v[204:207] offset:1024
  s_nop 0
  v_permlane16_swap_b32 v236, v237
  v_add_f32 v236, v236, v237
  v_rcp_f32 v236, v236
  ds_write_b128 v11, v[208:211] offset:2048
  s_mov_b64 exec, 0xff
  ds_write_b32 v242, v236
  s_mov_b64 exec, -1
  s_waitcnt lgkmcnt(0)
  s_barrier
  ds_read_b128 v[104:107], v243
  ds_read_b64 v[96:97], v12 offset:0
  ds_read_b64 v[98:99], v12 offset:3072
  ds_read_b64 v[100:101], v12 offset:6144
  ds_read_b64 v[102:103], v12 offset:9216
  s_waitcnt lgkmcnt(2)
  v_pk_mul_f32 v[96:97], v[96:97], v[104:105] op_sel_hi:[1,0]
  v_pk_fma_f32 v[96:97], v[98:99], v[104:105], v[96:97] op_sel:[0,1,0] op_sel_hi:[1,1,1]
  s_waitcnt lgkmcnt(0)
  v_pk_fma_f32 v[96:97], v[100:101], v[106:107], v[96:97] op_sel_hi:[1,0,1]
  v_pk_fma_f32 v[96:97], v[102:103], v[106:107], v[96:97] op_sel:[0,1,0] op_sel_hi:[1,1,1]
  v_cvt_pk_f16_f32 v100, v96, v97
  v_perm_b32 v100, s91, v100, v14
  buffer_atomic_pk_add_f16 v100, v13, s[4:7], s3 offen
  v_mov_b32 v200, v196
  v_mov_b32 v201, v197
  v_mov_b32 v202, v198
  v_mov_b32 v203, v199
  v_permlane32_swap_b32 v188, v192
  v_permlane32_swap_b32 v189, v193
  v_permlane32_swap_b32 v190, v194
  v_permlane32_swap_b32 v191, v195
  v_permlane32_swap_b32 v196, v200
  v_permlane32_swap_b32 v197, v201
  v_permlane32_swap_b32 v198, v202
  v_permlane32_swap_b32 v199, v203
  v_pk_add_f32 v[188:189], v[188:189], v[192:193]
  v_pk_add_f32 v[190:191], v[190:191], v[194:195]
  v_pk_add_f32 v[196:197], v[196:197], v[200:201]
  v_pk_add_f32 v[198:199], v[198:199], v[202:203]
  v_cvt_pk_bf16_f32 v252, v188, v189
  v_cvt_pk_bf16_f32 v254, v196, v197
  v_cvt_pk_bf16_f32 v253, v190, v191
  v_cvt_pk_bf16_f32 v255, v198, v199
  s_nop 0
  v_permlane16_swap_b32 v252, v254
  v_permlane16_swap_b32 v253, v255
  v_min_u32 v252, -2, v252
  s_mov_b64 exec, s[76:77]
  buffer_store_dwordx4 v[252:255], v15, s[24:27], s57 offen sc1
  s_mov_b64 exec, -1
  s_add_u32 s64, s64, 1310720
  s_add_u32 s52, s52, 1
  s_and_b32 s21, s52, 3
  s_mul_i32 s81, s21, 540672
  s_lshl_b32 s84, s21, 15
  s_branch step_20
fl_24:
  buffer_load_dword v94, v95, s[12:15], s79 offen sc1
  s_branch fl_25
pm_22:
  s_cmp_gt_u32 s52, 3
  s_cbranch_scc1 op_32
  v_readfirstlane_b32 s21, v94
  s_cmp_ge_u32 s21, s46
  s_cbranch_scc1 op_32
  buffer_load_dword v94, v95, s[12:15], s79 offen sc1
  s_waitcnt vmcnt(0)
  v_readfirstlane_b32 s21, v94
  s_add_u32 s22, s46, 2
  s_min_u32 s22, s22, 64
  s_sub_u32 s55, s21, s22
  s_sub_u32 s56, s21, s46
  s_cmp_gt_u32 s21, s52
  s_cselect_b32 s21, s87, 0
  s_cmp_eq_u32 s21, 0
  s_cbranch_scc1 op_32
  s_mov_b32 s87, 0
  s_sub_u32 s21, s64, 1310720
  buffer_load_dwordx4 v[176:179], v16, s[28:31], s21 offen offset:0 sc1
  buffer_load_dwordx4 v[180:183], v16, s[28:31], s21 offen offset:1024 sc1
  buffer_load_dwordx4 v[184:187], v16, s[28:31], s21 offen offset:2048 sc1
op_32:
  buffer_load_dwordx4 v[32:35], v4, s[4:7], s84 offen offset:0 sc1
  buffer_load_dwordx4 v[36:39], v4, s[4:7], s84 offen offset:1024 sc1
  buffer_load_dwordx4 v[40:43], v4, s[4:7], s84 offen offset:2048 sc1
  s_add_u32 s54, s54, 1
  s_cmp_gt_u32 s54, 131072
  s_cbranch_scc1 end0
  s_waitcnt vmcnt(0)
  v_bitop3_b32 v27, v35, v39, v43 bitop3:0x80
  v_perm_b32 v35, v39, v35, s89
  v_cmp_gt_u32 vcc, 0x48000000, v27
  v_mov_b32 v39, v42
  s_cbranch_vccnz pm_22
  s_branch A1_15
pv_26:
  buffer_load_dwordx4 v[144:147], v10, s[8:11], s81 offen offset:0 sc1
  buffer_load_dwordx4 v[148:151], v10, s[8:11], s81 offen offset:1024 sc1
  buffer_load_dwordx4 v[152:155], v10, s[8:11], s81 offen offset:2048 sc1
  s_add_u32 s54, s54, 1
  s_cmp_gt_u32 s54, 131072
  s_cbranch_scc1 end0
  s_waitcnt vmcnt(0)
  v_max3_u32 v27, v144, v146, v148
  v_max3_u32 v27, v27, v150, v152
  v_max3_u32 v27, v27, v154, v154
  v_cmp_eq_u32 vcc, -1, v27
  s_nop 1
  s_cbranch_vccnz pv_26
  s_branch pvj_29
psr_27:
  buffer_load_dwordx2 v[248:249], v9, s[8:11], s81 offen sc1
  buffer_load_dwordx4 v[112:115], v8, s[8:11], s81 offen offset:0 sc1
  buffer_load_dwordx4 v[116:119], v8, s[8:11], s81 offen offset:1024 sc1
  s_add_u32 s54, s54, 1
  s_cmp_gt_u32 s54, 131072
  s_cbranch_scc1 end0
  s_waitcnt vmcnt(2)
  v_xor_b32 v96, s88, v248
  s_nop 0
  v_permlane16_swap_b32 v248, v249
  v_fma_mix_f32 v250, v248, 1.0, v249 op_sel:[0,0,0] op_sel_hi:[1,0,1]
  v_fma_mix_f32 v251, v248, 1.0, v249 op_sel:[1,0,1] op_sel_hi:[1,0,1]
  v_mov_b32 v248, v250
  v_mov_b32 v249, v251
  s_nop 0
  v_permlane32_swap_b32 v248, v250
  v_permlane32_swap_b32 v249, v251
  v_pk_add_f32 v[124:125], v[248:249], v[250:251]
  v_max_f32 v238, v124, v125
  s_waitcnt vmcnt(0)
  v_pk_add_f16 v100, v112, v116
  v_pk_add_f16 v102, v114, v118
  v_pk_add_f16 v101, v113, v117
  v_pk_add_f16 v103, v115, v119
  v_permlane32_swap_b32 v100, v102
  v_bitop3_b32 v97, v112, v114, s88 bitop3:0x7e
  v_permlane32_swap_b32 v101, v103
  v_bitop3_b32 v98, v116, v118, s88 bitop3:0x7e
  v_fma_mix_f32 v120, v100, 1.0, v102 op_sel:[0,0,0] op_sel_hi:[1,0,1]
  v_or3_b32 v27, v96, v97, v98
  v_fma_mix_f32 v121, v100, 1.0, v102 op_sel:[1,0,1] op_sel_hi:[1,0,1]
  v_and_b32 v27, 1, v27
  v_fma_mix_f32 v122, v101, 1.0, v103 op_sel:[0,0,0] op_sel_hi:[1,0,1]
  v_cmp_ne_u32 vcc, 0, v27
  v_fma_mix_f32 v123, v101, 1.0, v103 op_sel:[1,0,1] op_sel_hi:[1,0,1]
  v_max3_f32 v236, v120, v121, v238
  s_cbranch_vccnz psr_27
  s_branch psj_28
kvw_30:
  s_mov_b32 s22, s87
  s_cmp_eq_u32 s52, 0
  s_cselect_b32 s23, s87, s46
  s_cselect_b32 s55, 0, s55
  s_cselect_b32 s87, 1, 0
  s_cmp_eq_u32 s23, 0
  s_cbranch_scc1 kvok_31
  v_mov_b32 v236, 0
  s_mov_b32 s101, 0
wf_33:
  buffer_load_dword v237, v236, s[12:15], s79 offen sc1
  s_add_u32 s101, s101, 1
  s_cmp_gt_u32 s101, 131072
  s_cbranch_scc1 end0
  s_waitcnt vmcnt(0)
  v_readfirstlane_b32 s100, v237
  s_cmp_ge_u32 s100, s23
  s_cbranch_scc1 wf_34
  s_sleep 3
  s_branch wf_33
wf_34:
  s_cmp_eq_u32 s22, 0
  s_cbranch_scc1 kvok_31
  s_sub_u32 s21, s64, 1310720
  buffer_load_dwordx4 v[176:179], v16, s[28:31], s21 offen offset:0 sc1
  buffer_load_dwordx4 v[180:183], v16, s[28:31], s21 offen offset:1024 sc1
  buffer_load_dwordx4 v[184:187], v16, s[28:31], s21 offen offset:2048 sc1
  s_waitcnt vmcnt(0)
  s_branch kvok_31
last_21:
  v_mov_b32 v188, 0
  v_mov_b32 v189, 0
  v_mov_b32 v190, 0
  v_mov_b32 v191, 0
  v_mov_b32 v192, 0
  v_mov_b32 v193, 0
  v_mov_b32 v194, 0
  v_mov_b32 v195, 0
  v_mov_b32 v196, 0
  v_mov_b32 v197, 0
  v_mov_b32 v198, 0
  v_mov_b32 v199, 0
  s_sleep 4
  s_mov_b32 s54, 0
lv_35:
  buffer_load_dwordx4 v[144:147], v10, s[8:11], s81 offen offset:0 sc1
  buffer_load_dwordx4 v[148:151], v10, s[8:11], s81 offen offset:1024 sc1
  buffer_load_dwordx4 v[152:155], v10, s[8:11], s81 offen offset:2048 sc1
  s_add_u32 s54, s54, 1
  s_cmp_gt_u32 s54, 131072
  s_cbranch_scc1 end0
  s_waitcnt vmcnt(0)
  v_max3_u32 v27, v144, v146, v148
  v_max3_u32 v27, v27, v150, v152
  v_max3_u32 v27, v27, v154, v154
  v_cmp_eq_u32 vcc, -1, v27
  s_nop 1
  s_cbranch_vccnz lv_35
  v_smfmac_f32_16x16x64_bf16 v[188:191], v[144:147], a[180:187], v44
  v_smfmac_f32_16x16x64_bf16 v[192:195], v[144:147], a[204:211], v44
  v_smfmac_f32_16x16x64_bf16 v[196:199], v[144:147], a[228:235], v44
  v_smfmac_f32_16x16x64_bf16 v[188:191], v[148:151], a[188:195], v44
  v_smfmac_f32_16x16x64_bf16 v[192:195], v[148:151], a[212:219], v44
  v_smfmac_f32_16x16x64_bf16 v[196:199], v[148:151], a[236:243], v44
  v_smfmac_f32_16x16x64_bf16 v[188:191], v[152:155], a[196:203], v44
  v_smfmac_f32_16x16x64_bf16 v[192:195], v[152:155], a[220:227], v44
  v_smfmac_f32_16x16x64_bf16 v[196:199], v[152:155], a[244:251], v44
  s_nop 7
  v_mov_b32 v200, v196
  v_mov_b32 v201, v197
  v_mov_b32 v202, v198
  v_mov_b32 v203, v199
  v_permlane32_swap_b32 v188, v192
  v_permlane32_swap_b32 v189, v193
  v_permlane32_swap_b32 v190, v194
  v_permlane32_swap_b32 v191, v195
  v_permlane32_swap_b32 v196, v200
  v_permlane32_swap_b32 v197, v201
  v_permlane32_swap_b32 v198, v202
  v_permlane32_swap_b32 v199, v203
  v_pk_add_f32 v[188:189], v[188:189], v[192:193]
  v_pk_add_f32 v[190:191], v[190:191], v[194:195]
  v_pk_add_f32 v[196:197], v[196:197], v[200:201]
  v_pk_add_f32 v[198:199], v[198:199], v[202:203]
  v_cvt_pk_bf16_f32 v252, v188, v189
  v_cvt_pk_bf16_f32 v254, v196, v197
  v_cvt_pk_bf16_f32 v253, v190, v191
  v_cvt_pk_bf16_f32 v255, v198, v199
  s_nop 0
  v_permlane16_swap_b32 v252, v254
  v_permlane16_swap_b32 v253, v255
  v_min_u32 v252, -2, v252
  s_mov_b64 exec, s[76:77]
  buffer_store_dwordx4 v[252:255], v15, s[24:27], s57 offen sc1
  s_mov_b64 exec, -1
  v_mov_b32 v246, 80
  v_mov_b32 v247, 1
  s_mov_b64 exec, 1
  buffer_atomic_add v247, v246, s[32:35], 0 offen sc0 sc1
  s_mov_b64 exec, -1
clm_36:
  s_branch chain_done
step_37:
  s_add_u32 s21, s52, 2
  s_and_b32 s21, s21, 3
  s_mul_i32 s82, s21, 540672
  s_add_u32 s21, s52, 3
  s_and_b32 s21, s21, 3
  s_lshl_b32 s83, s21, 15
  s_add_u32 s21, s52, 1
  s_and_b32 s22, s21, 3
  s_lshl_b32 s3, s22, 15
  s_mul_i32 s80, s21, 393216
  s_add_u32 s46, s21, 1
  s_min_u32 s46, s46, 64
  s_mul_i32 s85, s52, 98304
  s_mul_i32 s57, s52, 327680
  s_add_u32 s57, s57, 42991616

  s_bfe_u32 s88, s52, 0x10002
  s_add_u32 s78, s81, 278528
  s_max_u32 s21, s52, 1
  s_sub_u32 s21, s21, 1
  s_cmp_lt_u32 s52, 98
  s_cselect_b32 s66, s65, 0x80000000
  s_cselect_b32 s68, 15, 1
  s_cmp_ge_u32 s52, 99
  s_cselect_b32 s66, s90, s66
  s_cselect_b32 s67, s52, s21
  v_mov_b32 v52, 0
  v_mov_b32 v53, 0
  v_mov_b32 v54, 0
  v_mov_b32 v55, 0
  v_mov_b32 v56, 0
  v_mov_b32 v57, 0
  v_mov_b32 v58, 0
  v_mov_b32 v59, 0
  v_mov_b32 v60, 0
  v_mov_b32 v61, 0
  v_mov_b32 v62, 0
  v_mov_b32 v63, 0
  v_mov_b32 v64, 0
  v_mov_b32 v65, 0
  v_mov_b32 v66, 0
  v_mov_b32 v67, 0
  v_mov_b32 v68, 0
  v_mov_b32 v69, 0
  v_mov_b32 v70, 0
  v_mov_b32 v71, 0
  v_mov_b32 v72, 0
  v_mov_b32 v73, 0
  v_mov_b32 v74, 0
  v_mov_b32 v75, 0
  v_mov_b32 v76, 0
  v_mov_b32 v77, 0
  v_mov_b32 v78, 0
  v_mov_b32 v79, 0
  v_mov_b32 v80, 0
  v_mov_b32 v81, 0
  v_mov_b32 v82, 0
  v_mov_b32 v83, 0
  v_mov_b32 v84, 0
  v_mov_b32 v85, 0
  v_mov_b32 v86, 0
  v_mov_b32 v87, 0
  s_sleep 4
  s_cmp_lt_i32 s55, 0
  s_cbranch_scc1 fl_41
fl_42:
  s_mov_b32 s54, 0
  buffer_load_dwordx4 v[32:35], v4, s[4:7], s84 offen offset:0 sc1
  buffer_load_dwordx4 v[36:39], v4, s[4:7], s84 offen offset:1024 sc1
  buffer_load_dwordx4 v[40:43], v4, s[4:7], s84 offen offset:2048 sc1
  s_waitcnt vmcnt(3)
  v_mov_b32 v176, v160
  v_mov_b32 v177, v161
  v_mov_b32 v178, v162
  v_mov_b32 v179, v163
  v_mov_b32 v180, v164
  v_mov_b32 v181, v165
  v_mov_b32 v182, v166
  v_mov_b32 v183, v167
  v_mov_b32 v184, v48
  v_mov_b32 v185, v49
  v_mov_b32 v186, v50
  v_mov_b32 v187, v51
  s_waitcnt vmcnt(0)
  v_bitop3_b32 v27, v35, v39, v43 bitop3:0x80
  v_perm_b32 v35, v39, v35, s89
  v_cmp_gt_u32 vcc, 0x48000000, v27
  v_mov_b32 v39, v42
  s_cbranch_vccnz pm_39
A1_16:
  v_smfmac_f32_16x16x32_f16 v[52:55], v[40:41], a[16:19], v44
  v_smfmac_f32_16x16x32_f16 v[64:67], v[40:41], a[76:79], v44
  v_smfmac_f32_16x16x32_f16 v[56:59], v[40:41], a[36:39], v44
  v_smfmac_f32_16x16x32_f16 v[68:71], v[40:41], a[96:99], v44
  v_smfmac_f32_16x16x64_f16 v[52:55], v[32:35], a[0:7], v44
  v_smfmac_f32_16x16x64_f16 v[52:55], v[36:39], a[8:15], v44
  v_smfmac_f32_16x16x64_f16 v[64:67], v[32:35], a[60:67], v44
  v_smfmac_f32_16x16x64_f16 v[64:67], v[36:39], a[68:75], v44
  v_smfmac_f32_16x16x32_f16 v[60:63], v[40:41], a[56:59], v44
  v_cvt_pk_f16_f32 v52, v52, v53
  v_cvt_pk_f16_f32 v53, v54, v55
  v_smfmac_f32_16x16x32_f16 v[72:75], v[40:41], a[116:119], v44
  v_smfmac_f32_16x16x32_f16 v[76:79], v[40:41], a[136:139], v44
  v_cvt_pk_f16_f32 v64, v64, v65
  v_cvt_pk_f16_f32 v65, v66, v67
  s_nop 0
  v_smfmac_f32_16x16x64_f16 v[56:59], v[32:35], a[20:27], v44
  v_permlane32_swap_b32 v52, v64
  v_smfmac_f32_16x16x64_f16 v[56:59], v[36:39], a[28:35], v44
  v_permlane32_swap_b32 v53, v65
  v_pk_add_f16 v52, v52, v64
  v_smfmac_f32_16x16x64_f16 v[68:71], v[32:35], a[80:87], v44
  v_pk_add_f16 v53, v53, v65
  v_smfmac_f32_16x16x64_f16 v[68:71], v[36:39], a[88:95], v44
  ds_write_b64 v5, v[52:53] offset:0
  v_smfmac_f32_16x16x32_f16 v[80:83], v[40:41], a[156:159], v44
  v_cvt_pk_f16_f32 v56, v56, v57
  v_cvt_pk_f16_f32 v57, v58, v59
  v_smfmac_f32_16x16x32_f16 v[84:87], v[40:41], a[176:179], v44
  v_cvt_pk_f16_f32 v68, v68, v69
  v_cvt_pk_f16_f32 v69, v70, v71
  s_nop 0
  v_smfmac_f32_16x16x64_f16 v[60:63], v[32:35], a[40:47], v44
  v_permlane32_swap_b32 v56, v68
  v_smfmac_f32_16x16x64_f16 v[60:63], v[36:39], a[48:55], v44
  v_permlane32_swap_b32 v57, v69
  v_pk_add_f16 v56, v56, v68
  v_smfmac_f32_16x16x64_f16 v[72:75], v[32:35], a[100:107], v44
  v_pk_add_f16 v57, v57, v69
  v_smfmac_f32_16x16x64_f16 v[72:75], v[36:39], a[108:115], v44
  ds_write_b64 v5, v[56:57] offset:640
  v_smfmac_f32_16x16x64_f16 v[76:79], v[32:35], a[120:127], v44
  v_cvt_pk_f16_f32 v60, v60, v61
  v_cvt_pk_f16_f32 v61, v62, v63
  v_smfmac_f32_16x16x64_f16 v[76:79], v[36:39], a[128:135], v44
  v_cvt_pk_f16_f32 v72, v72, v73
  v_cvt_pk_f16_f32 v73, v74, v75
  s_nop 0
  v_smfmac_f32_16x16x64_f16 v[80:83], v[32:35], a[140:147], v44
  v_permlane32_swap_b32 v60, v72
  v_smfmac_f32_16x16x64_f16 v[80:83], v[36:39], a[148:155], v44
  v_permlane32_swap_b32 v61, v73
  v_pk_add_f16 v60, v60, v72
  v_smfmac_f32_16x16x64_f16 v[84:87], v[32:35], a[160:167], v44
  v_pk_add_f16 v61, v61, v73
  v_smfmac_f32_16x16x64_f16 v[84:87], v[36:39], a[168:175], v44
  ds_write_b64 v5, v[60:61] offset:1280
  v_cvt_pk_f16_f32 v76, v76, v77
  v_cvt_pk_f16_f32 v77, v78, v79
  v_cvt_pk_f16_f32 v80, v80, v81
  v_cvt_pk_f16_f32 v81, v82, v83
  s_nop 0
  v_permlane32_swap_b32 v76, v80
  v_permlane32_swap_b32 v77, v81
  v_pk_add_f16 v76, v76, v80
  v_pk_add_f16 v77, v77, v81
  ds_write_b64 v5, v[76:77] offset:1920
  v_cvt_pk_f16_f32 v84, v84, v85
  v_cvt_pk_f16_f32 v85, v86, v87
  ds_write_b64 v5, v[84:85] offset:2560
  s_waitcnt lgkmcnt(0) vmcnt(0)
  s_barrier
  ds_read_b64_tr_b16 v[104:105], v45 offset:0
  ds_read_b64_tr_b16 v[106:107], v45 offset:3200
  ds_read_b64_tr_b16 v[108:109], v45 offset:640
  ds_read_b64_tr_b16 v[110:111], v45 offset:3840
  ds_read_b64_tr_b16 v[112:113], v45 offset:1280
  ds_read_b64_tr_b16 v[114:115], v45 offset:4480
  s_waitcnt lgkmcnt(4)
  v_fma_mix_f32 v120, v104, 1.0, v106 op_sel:[0,0,0] op_sel_hi:[1,0,1]
  v_fma_mix_f32 v121, v104, 1.0, v106 op_sel:[1,0,1] op_sel_hi:[1,0,1]
  v_fma_mix_f32 v122, v105, 1.0, v107 op_sel:[0,0,0] op_sel_hi:[1,0,1]
  v_fma_mix_f32 v123, v105, 1.0, v107 op_sel:[1,0,1] op_sel_hi:[1,0,1]
  v_add_f32_dpp v124, v120, v120 row_ror:8 row_mask:0xf bank_mask:0xf
  v_add_f32_dpp v125, v121, v121 row_ror:8 row_mask:0xf bank_mask:0xf
  v_add_f32_dpp v126, v122, v122 row_ror:8 row_mask:0xf bank_mask:0xf
  v_add_f32_dpp v127, v123, v123 row_ror:8 row_mask:0xf bank_mask:0xf
  v_cvt_pk_bf16_f32 v212, v124, v125
  v_cvt_pk_bf16_f32 v213, v126, v127
  s_waitcnt lgkmcnt(2)
  v_fma_mix_f32 v120, v108, 1.0, v110 op_sel:[0,0,0] op_sel_hi:[1,0,1]
  v_fma_mix_f32 v121, v108, 1.0, v110 op_sel:[1,0,1] op_sel_hi:[1,0,1]
  v_fma_mix_f32 v122, v109, 1.0, v111 op_sel:[0,0,0] op_sel_hi:[1,0,1]
  v_fma_mix_f32 v123, v109, 1.0, v111 op_sel:[1,0,1] op_sel_hi:[1,0,1]
  v_add_f32_dpp v124, v120, v120 row_ror:8 row_mask:0xf bank_mask:0xf
  v_add_f32_dpp v125, v121, v121 row_ror:8 row_mask:0xf bank_mask:0xf
  v_add_f32_dpp v126, v122, v122 row_ror:8 row_mask:0xf bank_mask:0xf
  v_add_f32_dpp v127, v123, v123 row_ror:8 row_mask:0xf bank_mask:0xf
  v_cvt_pk_bf16_f32 v214, v124, v125
  v_cvt_pk_bf16_f32 v215, v126, v127
  s_waitcnt lgkmcnt(0)
  v_fma_mix_f32 v120, v112, 1.0, v114 op_sel:[0,0,0] op_sel_hi:[1,0,1]
  v_fma_mix_f32 v121, v112, 1.0, v114 op_sel:[1,0,1] op_sel_hi:[1,0,1]
  v_fma_mix_f32 v122, v113, 1.0, v115 op_sel:[0,0,0] op_sel_hi:[1,0,1]
  v_fma_mix_f32 v123, v113, 1.0, v115 op_sel:[1,0,1] op_sel_hi:[1,0,1]
  v_mfma_f32_16x16x32_bf16 v[96:99], v[168:171], v[212:215], 0
  v_add_f32_dpp v124, v120, v120 row_ror:8 row_mask:0xf bank_mask:0xf
  v_add_f32_dpp v125, v121, v121 row_ror:8 row_mask:0xf bank_mask:0xf
  v_add_f32_dpp v126, v122, v122 row_ror:8 row_mask:0xf bank_mask:0xf
  v_add_f32_dpp v127, v123, v123 row_ror:8 row_mask:0xf bank_mask:0xf
  v_cvt_pk_bf16_f32 v216, v124, v125
  v_cvt_pk_bf16_f32 v217, v126, v127
  s_nop 1
  v_mfma_f32_16x16x32_bf16 v[96:99], v[172:175], v[216:219], v[96:99]
  s_mov_b64 exec, s[74:75]
  s_nop 6
  v_cvt_pk_f16_f32 v100, v96, v97
  v_cvt_pk_f16_f32 v101, v98, v99
  v_and_or_b32 v100, v100, -2, s88
  buffer_store_dwordx2 v[100:101], v7, s[8:11], s81 offen
  s_mov_b64 exec, -1
  s_cmp_eq_u32 s52, 63
  s_cbranch_scc1 last_38
  s_sleep 4
  s_nop 7
  s_mov_b32 s54, 0
  buffer_load_dwordx2 v[248:249], v9, s[8:11], s81 offen sc1
  buffer_load_dwordx4 v[112:115], v8, s[8:11], s81 offen offset:0 sc1
  buffer_load_dwordx4 v[116:119], v8, s[8:11], s81 offen offset:1024 sc1
  s_sleep 2
  buffer_load_dwordx4 v[144:147], v10, s[8:11], s81 offen offset:0 sc1
  buffer_load_dwordx4 v[148:151], v10, s[8:11], s81 offen offset:1024 sc1
  buffer_load_dwordx4 v[152:155], v10, s[8:11], s81 offen offset:2048 sc1
  v_mov_b32 v188, 0
  v_mov_b32 v189, 0
  v_mov_b32 v190, 0
  v_mov_b32 v191, 0
  v_mov_b32 v192, 0
  v_mov_b32 v193, 0
  v_mov_b32 v194, 0
  v_mov_b32 v195, 0
  v_mov_b32 v196, 0
  v_mov_b32 v197, 0
  v_mov_b32 v198, 0
  v_mov_b32 v199, 0
  v_readfirstlane_b32 s21, v94
  s_add_u32 s22, s46, 2
  s_min_u32 s22, s22, 64
  s_sub_u32 s55, s21, s22
  s_sub_u32 s56, s21, s46
  s_cmp_lt_i32 s56, 0
  s_cbranch_scc1 kvw_47
kvok_48:
  s_waitcnt vmcnt(5)
  v_xor_b32 v96, s88, v248
  s_nop 0
  v_permlane16_swap_b32 v248, v249
  v_fma_mix_f32 v250, v248, 1.0, v249 op_sel:[0,0,0] op_sel_hi:[1,0,1]
  v_fma_mix_f32 v251, v248, 1.0, v249 op_sel:[1,0,1] op_sel_hi:[1,0,1]
  v_mov_b32 v248, v250
  v_mov_b32 v249, v251
  s_nop 0
  v_permlane32_swap_b32 v248, v250
  v_permlane32_swap_b32 v249, v251
  v_pk_add_f32 v[124:125], v[248:249], v[250:251]
  v_max_f32 v238, v124, v125
  s_waitcnt vmcnt(3)
  v_pk_add_f16 v100, v112, v116
  v_pk_add_f16 v102, v114, v118
  v_pk_add_f16 v101, v113, v117
  v_pk_add_f16 v103, v115, v119
  v_permlane32_swap_b32 v100, v102
  v_bitop3_b32 v97, v112, v114, s88 bitop3:0x7e
  v_permlane32_swap_b32 v101, v103
  v_bitop3_b32 v98, v116, v118, s88 bitop3:0x7e
  v_fma_mix_f32 v120, v100, 1.0, v102 op_sel:[0,0,0] op_sel_hi:[1,0,1]
  v_or3_b32 v27, v96, v97, v98
  v_fma_mix_f32 v121, v100, 1.0, v102 op_sel:[1,0,1] op_sel_hi:[1,0,1]
  v_and_b32 v27, 1, v27
  v_fma_mix_f32 v122, v101, 1.0, v103 op_sel:[0,0,0] op_sel_hi:[1,0,1]
  v_cmp_ne_u32 vcc, 0, v27
  v_fma_mix_f32 v123, v101, 1.0, v103 op_sel:[1,0,1] op_sel_hi:[1,0,1]
  v_max3_f32 v236, v120, v121, v238
  s_cbranch_vccnz psr_44
psj_45:
  v_max3_f32 v236, v236, v122, v123
  s_nop 1
  v_max_f32_dpp v236, v236, v236 row_ror:8 row_mask:0xf bank_mask:0xf
  v_mov_b32 v237, v236
  s_waitcnt vmcnt(0)
  v_max3_u32 v27, v144, v146, v148
  v_permlane32_swap_b32 v236, v237
  v_max_f32 v236, v236, v237
  v_mov_b32 v237, v236
  v_max3_u32 v27, v27, v150, v152
  v_max_u32 v27, v27, v154
  v_permlane16_swap_b32 v236, v237
  v_cmp_eq_u32 vcc, -1, v27
  v_max_f32 v236, v236, v237
  v_mul_f32 v236, s86, v236
  s_cbranch_vccnz pv_43
pvj_46:
  v_smfmac_f32_16x16x64_bf16 v[188:191], v[144:147], a[180:187], v44
  v_fma_f32 v120, v120, s86, -v236
  v_smfmac_f32_16x16x64_bf16 v[188:191], v[148:151], a[188:195], v44
  v_fma_f32 v121, v121, s86, -v236
  v_smfmac_f32_16x16x64_bf16 v[188:191], v[152:155], a[196:203], v44
  buffer_load_dwordx4 v[160:163], v17, s[28:31], s64 offen offset:0 sc1
  v_fma_f32 v122, v122, s86, -v236
  v_smfmac_f32_16x16x64_bf16 v[192:195], v[144:147], a[204:211], v44
  v_fma_f32 v123, v123, s86, -v236
  v_smfmac_f32_16x16x64_bf16 v[192:195], v[148:151], a[212:219], v44
  buffer_load_dwordx4 v[164:167], v16, s[28:31], s64 offen offset:1024 sc1
  v_fma_f32 v124, v124, s86, -v236
  v_smfmac_f32_16x16x64_bf16 v[192:195], v[152:155], a[220:227], v44
  v_fma_f32 v125, v125, s86, -v236
  v_smfmac_f32_16x16x64_bf16 v[196:199], v[144:147], a[228:235], v44
  buffer_load_dwordx4 v[48:51], v26, s[28:31], s64 offen offset:2048 sc1
  v_exp_f32 v120, v120
  v_smfmac_f32_16x16x64_bf16 v[196:199], v[148:151], a[236:243], v44
  v_exp_f32 v121, v121
  v_smfmac_f32_16x16x64_bf16 v[196:199], v[152:155], a[244:251], v44
  buffer_load_dwordx4 v[168:171], v18, s[16:19], s80 offen sc1
  v_exp_f32 v122, v122
  buffer_load_dwordx2 v[172:173], v20, s[16:19], s80 offen sc1
  v_exp_f32 v123, v123
  v_exp_f32 v124, v124
  v_exp_f32 v125, v125
  v_cvt_pk_bf16_f32 v220, v120, v121
  v_cvt_pk_bf16_f32 v221, v122, v123
  v_cvt_pk_bf16_f32 v224, v124, v125
  v_mov_b32_dpp v222, v220 row_ror:8 row_mask:0xf bank_mask:0xf
  v_mov_b32_dpp v223, v221 row_ror:8 row_mask:0xf bank_mask:0xf
  v_mov_b32_dpp v225, v224 row_ror:8 row_mask:0xf bank_mask:0xf
  v_cvt_pk_bf16_f32 v228, v188, v189
  v_mfma_f32_16x16x32_bf16 v[200:203], v[176:179], v[220:223], 0
  v_cvt_pk_bf16_f32 v229, v190, v191
  v_cvt_pk_bf16_f32 v230, v192, v193
  v_mfma_f32_16x16x32_bf16 v[204:207], v[180:183], v[220:223], 0
  v_cvt_pk_bf16_f32 v231, v194, v195
  v_cvt_pk_bf16_f32 v232, v196, v197
  v_mfma_f32_16x16x32_bf16 v[208:211], v[184:187], v[220:223], 0
  v_cvt_pk_bf16_f32 v233, v198, v199
  v_add_f32 v126, v120, v121
  v_mfma_f32_16x16x32_bf16 v[200:203], v[228:231], v[224:227], v[200:203]
  v_add_f32 v127, v122, v123
  v_add_f32 v128, v124, v125
  v_mfma_f32_16x16x32_bf16 v[204:207], v[230:233], v[224:227], v[204:207]
  v_add_f32 v236, v126, v127
  v_fmac_f32 v236, v128, v89
  v_mfma_f32_16x16x32_bf16 v[208:211], v[232:235], v[224:227], v[208:211]
  s_nop 0
  v_add_f32_dpp v236, v236, v236 row_ror:8 row_mask:0xf bank_mask:0xf
  v_mov_b32 v237, v236
  ds_write_b128 v11, v[200:203] offset:0
  s_nop 0
  v_permlane32_swap_b32 v236, v237
  v_add_f32 v236, v236, v237
  v_mov_b32 v237, v236
  ds_write_b128 v11, v[204:207] offset:1024
  s_nop 0
  v_permlane16_swap_b32 v236, v237
  v_add_f32 v236, v236, v237
  v_rcp_f32 v236, v236
  ds_write_b128 v11, v[208:211] offset:2048
  s_mov_b64 exec, 0xff
  ds_write_b32 v242, v236
  s_mov_b64 exec, -1
  s_waitcnt lgkmcnt(0)
  s_barrier
  ds_read_b128 v[104:107], v243
  ds_read_b64 v[96:97], v12 offset:0
  ds_read_b64 v[98:99], v12 offset:3072
  ds_read_b64 v[100:101], v12 offset:6144
  ds_read_b64 v[102:103], v12 offset:9216
  s_waitcnt lgkmcnt(2)
  v_pk_mul_f32 v[96:97], v[96:97], v[104:105] op_sel_hi:[1,0]
  v_pk_fma_f32 v[96:97], v[98:99], v[104:105], v[96:97] op_sel:[0,1,0] op_sel_hi:[1,1,1]
  s_waitcnt lgkmcnt(0)
  v_pk_fma_f32 v[96:97], v[100:101], v[106:107], v[96:97] op_sel_hi:[1,0,1]
  v_pk_fma_f32 v[96:97], v[102:103], v[106:107], v[96:97] op_sel:[0,1,0] op_sel_hi:[1,1,1]
  v_cvt_pk_f16_f32 v100, v96, v97
  v_perm_b32 v100, s91, v100, v14
  buffer_atomic_pk_add_f16 v100, v13, s[4:7], s3 offen
  v_mov_b32 v200, v196
  v_mov_b32 v201, v197
  v_mov_b32 v202, v198
  v_mov_b32 v203, v199
  v_permlane32_swap_b32 v188, v192
  v_permlane32_swap_b32 v189, v193
  v_permlane32_swap_b32 v190, v194
  v_permlane32_swap_b32 v191, v195
  v_permlane32_swap_b32 v196, v200
  v_permlane32_swap_b32 v197, v201
  v_permlane32_swap_b32 v198, v202
  v_permlane32_swap_b32 v199, v203
  v_pk_add_f32 v[188:189], v[188:189], v[192:193]
  v_pk_add_f32 v[190:191], v[190:191], v[194:195]
  v_pk_add_f32 v[196:197], v[196:197], v[200:201]
  v_pk_add_f32 v[198:199], v[198:199], v[202:203]
  v_cvt_pk_bf16_f32 v252, v188, v189
  v_cvt_pk_bf16_f32 v254, v196, v197
  v_cvt_pk_bf16_f32 v253, v190, v191
  v_cvt_pk_bf16_f32 v255, v198, v199
  s_nop 0
  v_permlane16_swap_b32 v252, v254
  v_permlane16_swap_b32 v253, v255
  v_min_u32 v252, -2, v252
  s_mov_b64 exec, s[76:77]
  buffer_store_dwordx4 v[252:255], v15, s[24:27], s57 offen sc1
  s_mov_b64 exec, -1
  s_add_u32 s64, s64, 1310720
  s_add_u32 s52, s52, 1
  s_and_b32 s21, s52, 3
  s_mul_i32 s81, s21, 540672
  s_lshl_b32 s84, s21, 15
  s_branch step_37
fl_41:
  buffer_load_dword v94, v95, s[12:15], s79 offen sc1
  s_branch fl_42
pm_39:
  s_cmp_gt_u32 s52, 3
  s_cbranch_scc1 op_49
  v_readfirstlane_b32 s21, v94
  s_cmp_ge_u32 s21, s46
  s_cbranch_scc1 op_49
  buffer_load_dword v94, v95, s[12:15], s79 offen sc1
  s_waitcnt vmcnt(0)
  v_readfirstlane_b32 s21, v94
  s_add_u32 s22, s46, 2
  s_min_u32 s22, s22, 64
  s_sub_u32 s55, s21, s22
  s_sub_u32 s56, s21, s46
  s_cmp_gt_u32 s21, s52
  s_cselect_b32 s21, s87, 0
  s_cmp_eq_u32 s21, 0
  s_cbranch_scc1 op_49
  s_mov_b32 s87, 0
  s_sub_u32 s21, s64, 1310720
  buffer_load_dwordx4 v[176:179], v16, s[28:31], s21 offen offset:0 sc1
  buffer_load_dwordx4 v[180:183], v16, s[28:31], s21 offen offset:1024 sc1
  buffer_load_dwordx4 v[184:187], v16, s[28:31], s21 offen offset:2048 sc1
op_49:
  buffer_load_dwordx4 v[32:35], v4, s[4:7], s84 offen offset:0 sc1
  buffer_load_dwordx4 v[36:39], v4, s[4:7], s84 offen offset:1024 sc1
  buffer_load_dwordx4 v[40:43], v4, s[4:7], s84 offen offset:2048 sc1
  s_add_u32 s54, s54, 1
  s_cmp_gt_u32 s54, 131072
  s_cbranch_scc1 end0
  s_waitcnt vmcnt(0)
  v_bitop3_b32 v27, v35, v39, v43 bitop3:0x80
  v_perm_b32 v35, v39, v35, s89
  v_cmp_gt_u32 vcc, 0x48000000, v27
  v_mov_b32 v39, v42
  s_cbranch_vccnz pm_39
  s_branch A1_16
pv_43:
  buffer_load_dwordx4 v[144:147], v10, s[8:11], s81 offen offset:0 sc1
  buffer_load_dwordx4 v[148:151], v10, s[8:11], s81 offen offset:1024 sc1
  buffer_load_dwordx4 v[152:155], v10, s[8:11], s81 offen offset:2048 sc1
  s_add_u32 s54, s54, 1
  s_cmp_gt_u32 s54, 131072
  s_cbranch_scc1 end0
  s_waitcnt vmcnt(0)
  v_max3_u32 v27, v144, v146, v148
  v_max3_u32 v27, v27, v150, v152
  v_max3_u32 v27, v27, v154, v154
  v_cmp_eq_u32 vcc, -1, v27
  s_nop 1
  s_cbranch_vccnz pv_43
  s_branch pvj_46
psr_44:
  buffer_load_dwordx2 v[248:249], v9, s[8:11], s81 offen sc1
  buffer_load_dwordx4 v[112:115], v8, s[8:11], s81 offen offset:0 sc1
  buffer_load_dwordx4 v[116:119], v8, s[8:11], s81 offen offset:1024 sc1
  s_add_u32 s54, s54, 1
  s_cmp_gt_u32 s54, 131072
  s_cbranch_scc1 end0
  s_waitcnt vmcnt(2)
  v_xor_b32 v96, s88, v248
  s_nop 0
  v_permlane16_swap_b32 v248, v249
  v_fma_mix_f32 v250, v248, 1.0, v249 op_sel:[0,0,0] op_sel_hi:[1,0,1]
  v_fma_mix_f32 v251, v248, 1.0, v249 op_sel:[1,0,1] op_sel_hi:[1,0,1]
  v_mov_b32 v248, v250
  v_mov_b32 v249, v251
  s_nop 0
  v_permlane32_swap_b32 v248, v250
  v_permlane32_swap_b32 v249, v251
  v_pk_add_f32 v[124:125], v[248:249], v[250:251]
  v_max_f32 v238, v124, v125
  s_waitcnt vmcnt(0)
  v_pk_add_f16 v100, v112, v116
  v_pk_add_f16 v102, v114, v118
  v_pk_add_f16 v101, v113, v117
  v_pk_add_f16 v103, v115, v119
  v_permlane32_swap_b32 v100, v102
  v_bitop3_b32 v97, v112, v114, s88 bitop3:0x7e
  v_permlane32_swap_b32 v101, v103
  v_bitop3_b32 v98, v116, v118, s88 bitop3:0x7e
  v_fma_mix_f32 v120, v100, 1.0, v102 op_sel:[0,0,0] op_sel_hi:[1,0,1]
  v_or3_b32 v27, v96, v97, v98
  v_fma_mix_f32 v121, v100, 1.0, v102 op_sel:[1,0,1] op_sel_hi:[1,0,1]
  v_and_b32 v27, 1, v27
  v_fma_mix_f32 v122, v101, 1.0, v103 op_sel:[0,0,0] op_sel_hi:[1,0,1]
  v_cmp_ne_u32 vcc, 0, v27
  v_fma_mix_f32 v123, v101, 1.0, v103 op_sel:[1,0,1] op_sel_hi:[1,0,1]
  v_max3_f32 v236, v120, v121, v238
  s_cbranch_vccnz psr_44
  s_branch psj_45
kvw_47:
  s_mov_b32 s22, s87
  s_cmp_eq_u32 s52, 0
  s_cselect_b32 s23, s87, s46
  s_cselect_b32 s55, 0, s55
  s_cselect_b32 s87, 1, 0
  s_cmp_eq_u32 s23, 0
  s_cbranch_scc1 kvok_48
  v_mov_b32 v236, 0
  s_mov_b32 s101, 0
wf_50:
  buffer_load_dword v237, v236, s[12:15], s79 offen sc1
  s_add_u32 s101, s101, 1
  s_cmp_gt_u32 s101, 131072
  s_cbranch_scc1 end0
  s_waitcnt vmcnt(0)
  v_readfirstlane_b32 s100, v237
  s_cmp_ge_u32 s100, s23
  s_cbranch_scc1 wf_51
  s_sleep 3
  s_branch wf_50
wf_51:
  s_cmp_eq_u32 s22, 0
  s_cbranch_scc1 kvok_48
  s_sub_u32 s21, s64, 1310720
  buffer_load_dwordx4 v[176:179], v16, s[28:31], s21 offen offset:0 sc1
  buffer_load_dwordx4 v[180:183], v16, s[28:31], s21 offen offset:1024 sc1
  buffer_load_dwordx4 v[184:187], v16, s[28:31], s21 offen offset:2048 sc1
  s_waitcnt vmcnt(0)
  s_branch kvok_48
last_38:
  v_mov_b32 v188, 0
  v_mov_b32 v189, 0
  v_mov_b32 v190, 0
  v_mov_b32 v191, 0
  v_mov_b32 v192, 0
  v_mov_b32 v193, 0
  v_mov_b32 v194, 0
  v_mov_b32 v195, 0
  v_mov_b32 v196, 0
  v_mov_b32 v197, 0
  v_mov_b32 v198, 0
  v_mov_b32 v199, 0
  s_sleep 4
  s_mov_b32 s54, 0
lv_52:
  buffer_load_dwordx4 v[144:147], v10, s[8:11], s81 offen offset:0 sc1
  buffer_load_dwordx4 v[148:151], v10, s[8:11], s81 offen offset:1024 sc1
  buffer_load_dwordx4 v[152:155], v10, s[8:11], s81 offen offset:2048 sc1
  s_add_u32 s54, s54, 1
  s_cmp_gt_u32 s54, 131072
  s_cbranch_scc1 end0
  s_waitcnt vmcnt(0)
  v_max3_u32 v27, v144, v146, v148
  v_max3_u32 v27, v27, v150, v152
  v_max3_u32 v27, v27, v154, v154
  v_cmp_eq_u32 vcc, -1, v27
  s_nop 1
  s_cbranch_vccnz lv_52
  v_smfmac_f32_16x16x64_bf16 v[188:191], v[144:147], a[180:187], v44
  v_smfmac_f32_16x16x64_bf16 v[192:195], v[144:147], a[204:211], v44
  v_smfmac_f32_16x16x64_bf16 v[196:199], v[144:147], a[228:235], v44
  v_smfmac_f32_16x16x64_bf16 v[188:191], v[148:151], a[188:195], v44
  v_smfmac_f32_16x16x64_bf16 v[192:195], v[148:151], a[212:219], v44
  v_smfmac_f32_16x16x64_bf16 v[196:199], v[148:151], a[236:243], v44
  v_smfmac_f32_16x16x64_bf16 v[188:191], v[152:155], a[196:203], v44
  v_smfmac_f32_16x16x64_bf16 v[192:195], v[152:155], a[220:227], v44
  v_smfmac_f32_16x16x64_bf16 v[196:199], v[152:155], a[244:251], v44
  s_nop 7
  v_mov_b32 v200, v196
  v_mov_b32 v201, v197
  v_mov_b32 v202, v198
  v_mov_b32 v203, v199
  v_permlane32_swap_b32 v188, v192
  v_permlane32_swap_b32 v189, v193
  v_permlane32_swap_b32 v190, v194
  v_permlane32_swap_b32 v191, v195
  v_permlane32_swap_b32 v196, v200
  v_permlane32_swap_b32 v197, v201
  v_permlane32_swap_b32 v198, v202
  v_permlane32_swap_b32 v199, v203
  v_pk_add_f32 v[188:189], v[188:189], v[192:193]
  v_pk_add_f32 v[190:191], v[190:191], v[194:195]
  v_pk_add_f32 v[196:197], v[196:197], v[200:201]
  v_pk_add_f32 v[198:199], v[198:199], v[202:203]
  v_cvt_pk_bf16_f32 v252, v188, v189
  v_cvt_pk_bf16_f32 v254, v196, v197
  v_cvt_pk_bf16_f32 v253, v190, v191
  v_cvt_pk_bf16_f32 v255, v198, v199
  s_nop 0
  v_permlane16_swap_b32 v252, v254
  v_permlane16_swap_b32 v253, v255
  v_min_u32 v252, -2, v252
  s_mov_b64 exec, s[76:77]
  buffer_store_dwordx4 v[252:255], v15, s[24:27], s57 offen sc1
  s_mov_b64 exec, -1
  s_branch chain_done
step_53:
  s_add_u32 s21, s52, 2
  s_and_b32 s21, s21, 3
  s_mul_i32 s82, s21, 540672
  s_add_u32 s21, s52, 3
  s_and_b32 s21, s21, 3
  s_lshl_b32 s83, s21, 15
  s_add_u32 s21, s52, 1
  s_and_b32 s22, s21, 3
  s_lshl_b32 s3, s22, 15
  s_mul_i32 s80, s21, 393216
  s_add_u32 s46, s21, 1
  s_min_u32 s46, s46, 64
  s_mul_i32 s85, s52, 98304
  s_mul_i32 s57, s52, 327680
  s_add_u32 s57, s57, 42991616

  s_bfe_u32 s88, s52, 0x10002
  s_add_u32 s78, s81, 278528
  s_max_u32 s21, s52, 1
  s_sub_u32 s21, s21, 1
  s_cmp_lt_u32 s52, 98
  s_cselect_b32 s66, s65, 0x80000000
  s_cselect_b32 s68, 15, 1
  s_cmp_ge_u32 s52, 99
  s_cselect_b32 s66, s90, s66
  s_cselect_b32 s67, s52, s21
  v_mov_b32 v52, 0
  v_mov_b32 v53, 0
  v_mov_b32 v54, 0
  v_mov_b32 v55, 0
  v_mov_b32 v56, 0
  v_mov_b32 v57, 0
  v_mov_b32 v58, 0
  v_mov_b32 v59, 0
  v_mov_b32 v60, 0
  v_mov_b32 v61, 0
  v_mov_b32 v62, 0
  v_mov_b32 v63, 0
  v_mov_b32 v64, 0
  v_mov_b32 v65, 0
  v_mov_b32 v66, 0
  v_mov_b32 v67, 0
  v_mov_b32 v68, 0
  v_mov_b32 v69, 0
  v_mov_b32 v70, 0
  v_mov_b32 v71, 0
  v_mov_b32 v72, 0
  v_mov_b32 v73, 0
  v_mov_b32 v74, 0
  v_mov_b32 v75, 0
  v_mov_b32 v76, 0
  v_mov_b32 v77, 0
  v_mov_b32 v78, 0
  v_mov_b32 v79, 0
  v_mov_b32 v80, 0
  v_mov_b32 v81, 0
  v_mov_b32 v82, 0
  v_mov_b32 v83, 0
  v_mov_b32 v84, 0
  v_mov_b32 v85, 0
  v_mov_b32 v86, 0
  v_mov_b32 v87, 0
  s_sleep 3
  s_nop 3
  s_cmp_lt_i32 s55, 0
  s_cbranch_scc1 fl_57
fl_58:
  s_mov_b32 s54, 0
  buffer_load_dwordx4 v[32:35], v4, s[4:7], s84 offen offset:0 sc1
  buffer_load_dwordx4 v[36:39], v4, s[4:7], s84 offen offset:1024 sc1
  buffer_load_dwordx4 v[40:43], v4, s[4:7], s84 offen offset:2048 sc1
  s_waitcnt vmcnt(3)
  v_mov_b32 v176, v160
  v_mov_b32 v177, v161
  v_mov_b32 v178, v162
  v_mov_b32 v179, v163
  v_mov_b32 v180, v164
  v_mov_b32 v181, v165
  v_mov_b32 v182, v166
  v_mov_b32 v183, v167
  v_mov_b32 v184, v48
  v_mov_b32 v185, v49
  v_mov_b32 v186, v50
  v_mov_b32 v187, v51
  s_waitcnt vmcnt(0)
  v_bitop3_b32 v27, v35, v39, v43 bitop3:0x80
  v_perm_b32 v35, v39, v35, s89
  v_cmp_gt_u32 vcc, 0x48000000, v27
  v_mov_b32 v39, v42
  s_cbranch_vccnz pm_55
A1_17:
  v_smfmac_f32_16x16x32_f16 v[52:55], v[40:41], a[16:19], v44
  v_smfmac_f32_16x16x32_f16 v[64:67], v[40:41], a[76:79], v44
  v_smfmac_f32_16x16x32_f16 v[56:59], v[40:41], a[36:39], v44
  v_smfmac_f32_16x16x32_f16 v[68:71], v[40:41], a[96:99], v44
  v_smfmac_f32_16x16x64_f16 v[52:55], v[32:35], a[0:7], v44
  v_smfmac_f32_16x16x64_f16 v[52:55], v[36:39], a[8:15], v44
  v_smfmac_f32_16x16x64_f16 v[64:67], v[32:35], a[60:67], v44
  v_smfmac_f32_16x16x64_f16 v[64:67], v[36:39], a[68:75], v44
  v_smfmac_f32_16x16x32_f16 v[60:63], v[40:41], a[56:59], v44
  v_cvt_pk_f16_f32 v52, v52, v53
  v_cvt_pk_f16_f32 v53, v54, v55
  v_smfmac_f32_16x16x32_f16 v[72:75], v[40:41], a[116:119], v44
  v_smfmac_f32_16x16x32_f16 v[76:79], v[40:41], a[136:139], v44
  v_cvt_pk_f16_f32 v64, v64, v65
  v_cvt_pk_f16_f32 v65, v66, v67
  s_nop 0
  v_smfmac_f32_16x16x64_f16 v[56:59], v[32:35], a[20:27], v44
  v_permlane32_swap_b32 v52, v64
  v_smfmac_f32_16x16x64_f16 v[56:59], v[36:39], a[28:35], v44
  v_permlane32_swap_b32 v53, v65
  v_pk_add_f16 v52, v52, v64
  v_smfmac_f32_16x16x64_f16 v[68:71], v[32:35], a[80:87], v44
  v_pk_add_f16 v53, v53, v65
  v_smfmac_f32_16x16x64_f16 v[68:71], v[36:39], a[88:95], v44
  ds_write_b64 v5, v[52:53] offset:0
  v_smfmac_f32_16x16x32_f16 v[80:83], v[40:41], a[156:159], v44
  v_cvt_pk_f16_f32 v56, v56, v57
  v_cvt_pk_f16_f32 v57, v58, v59
  v_smfmac_f32_16x16x32_f16 v[84:87], v[40:41], a[176:179], v44
  v_cvt_pk_f16_f32 v68, v68, v69
  v_cvt_pk_f16_f32 v69, v70, v71
  s_nop 0
  v_smfmac_f32_16x16x64_f16 v[60:63], v[32:35], a[40:47], v44
  v_permlane32_swap_b32 v56, v68
  v_smfmac_f32_16x16x64_f16 v[60:63], v[36:39], a[48:55], v44
  v_permlane32_swap_b32 v57, v69
  v_pk_add_f16 v56, v56, v68
  v_smfmac_f32_16x16x64_f16 v[72:75], v[32:35], a[100:107], v44
  v_pk_add_f16 v57, v57, v69
  v_smfmac_f32_16x16x64_f16 v[72:75], v[36:39], a[108:115], v44
  ds_write_b64 v5, v[56:57] offset:640
  v_smfmac_f32_16x16x64_f16 v[76:79], v[32:35], a[120:127], v44
  v_cvt_pk_f16_f32 v60, v60, v61
  v_cvt_pk_f16_f32 v61, v62, v63
  v_smfmac_f32_16x16x64_f16 v[76:79], v[36:39], a[128:135], v44
  v_cvt_pk_f16_f32 v72, v72, v73
  v_cvt_pk_f16_f32 v73, v74, v75
  s_nop 0
  v_smfmac_f32_16x16x64_f16 v[80:83], v[32:35], a[140:147], v44
  v_permlane32_swap_b32 v60, v72
  v_smfmac_f32_16x16x64_f16 v[80:83], v[36:39], a[148:155], v44
  v_permlane32_swap_b32 v61, v73
  v_pk_add_f16 v60, v60, v72
  v_smfmac_f32_16x16x64_f16 v[84:87], v[32:35], a[160:167], v44
  v_pk_add_f16 v61, v61, v73
  v_smfmac_f32_16x16x64_f16 v[84:87], v[36:39], a[168:175], v44
  ds_write_b64 v5, v[60:61] offset:1280
  v_cvt_pk_f16_f32 v76, v76, v77
  v_cvt_pk_f16_f32 v77, v78, v79
  v_cvt_pk_f16_f32 v80, v80, v81
  v_cvt_pk_f16_f32 v81, v82, v83
  s_nop 0
  v_permlane32_swap_b32 v76, v80
  v_permlane32_swap_b32 v77, v81
  v_pk_add_f16 v76, v76, v80
  v_pk_add_f16 v77, v77, v81
  ds_write_b64 v5, v[76:77] offset:1920
  v_cvt_pk_f16_f32 v84, v84, v85
  v_cvt_pk_f16_f32 v85, v86, v87
  ds_write_b64 v5, v[84:85] offset:2560
  s_waitcnt lgkmcnt(0) vmcnt(0)
  s_barrier
  ds_read_b64_tr_b16 v[104:105], v6 offset:0
  ds_read_b64_tr_b16 v[106:107], v6 offset:3200
  ds_read_b64_tr_b16 v[108:109], v6 offset:6400
  ds_read_b64_tr_b16 v[110:111], v6 offset:9600
  ds_read_b64_tr_b16 v[112:113], v6 offset:640
  ds_read_b64_tr_b16 v[114:115], v6 offset:3840
  ds_read_b64_tr_b16 v[116:117], v6 offset:7040
  ds_read_b64_tr_b16 v[118:119], v6 offset:10240
  ds_read_b64_tr_b16 v[120:121], v6 offset:1280
  ds_read_b64_tr_b16 v[122:123], v6 offset:4480
  ds_read_b64_tr_b16 v[124:125], v6 offset:7680
  ds_read_b64_tr_b16 v[126:127], v6 offset:10880
  s_waitcnt lgkmcnt(8)
  v_pk_add_f16 v104, v104, v106
  v_pk_add_f16 v108, v108, v110
  v_pk_add_f16 v105, v105, v107
  v_pk_add_f16 v109, v109, v111
  v_fma_mix_f32 v128, v104, 1.0, v108 op_sel:[0,0,0] op_sel_hi:[1,0,1]
  v_fma_mix_f32 v129, v104, 1.0, v108 op_sel:[1,0,1] op_sel_hi:[1,0,1]
  v_fma_mix_f32 v130, v105, 1.0, v109 op_sel:[0,0,0] op_sel_hi:[1,0,1]
  v_fma_mix_f32 v131, v105, 1.0, v109 op_sel:[1,0,1] op_sel_hi:[1,0,1]
  v_cvt_pk_bf16_f32 v212, v128, v129
  v_cvt_pk_bf16_f32 v213, v130, v131
  s_waitcnt lgkmcnt(4)
  v_pk_add_f16 v112, v112, v114
  v_pk_add_f16 v116, v116, v118
  v_pk_add_f16 v113, v113, v115
  v_pk_add_f16 v117, v117, v119
  v_fma_mix_f32 v128, v112, 1.0, v116 op_sel:[0,0,0] op_sel_hi:[1,0,1]
  v_fma_mix_f32 v129, v112, 1.0, v116 op_sel:[1,0,1] op_sel_hi:[1,0,1]
  v_fma_mix_f32 v130, v113, 1.0, v117 op_sel:[0,0,0] op_sel_hi:[1,0,1]
  v_fma_mix_f32 v131, v113, 1.0, v117 op_sel:[1,0,1] op_sel_hi:[1,0,1]
  v_cvt_pk_bf16_f32 v214, v128, v129
  v_cvt_pk_bf16_f32 v215, v130, v131
  s_waitcnt lgkmcnt(0)
  v_pk_add_f16 v120, v120, v122
  v_pk_add_f16 v124, v124, v126
  v_pk_add_f16 v121, v121, v123
  v_pk_add_f16 v125, v125, v127
  v_fma_mix_f32 v128, v120, 1.0, v124 op_sel:[0,0,0] op_sel_hi:[1,0,1]
  v_fma_mix_f32 v129, v120, 1.0, v124 op_sel:[1,0,1] op_sel_hi:[1,0,1]
  v_mfma_f32_16x16x32_bf16 v[96:99], v[212:215], v[212:215], 0
  v_fma_mix_f32 v130, v121, 1.0, v125 op_sel:[0,0,0] op_sel_hi:[1,0,1]
  v_fma_mix_f32 v131, v121, 1.0, v125 op_sel:[1,0,1] op_sel_hi:[1,0,1]
  v_cvt_pk_bf16_f32 v216, v128, v129
  v_cvt_pk_bf16_f32 v217, v130, v131
  s_nop 1
  v_mfma_f32_16x16x32_bf16 v[96:99], v[216:219], v[216:219], v[96:99]
  s_mov_b64 exec, s[74:75]
  s_nop 6
  v_cvt_pk_f16_f32 v100, v96, v97
  v_cvt_pk_f16_f32 v101, v98, v99
  v_and_or_b32 v100, v100, -2, s88
  buffer_store_dwordx2 v[100:101], v7, s[8:11], s81 offen
  s_mov_b64 exec, -1
  s_cmp_eq_u32 s52, 63
  s_cbranch_scc1 last_54
  s_sleep 4
  s_nop 7
  s_mov_b32 s54, 0
  buffer_load_dwordx2 v[248:249], v9, s[8:11], s81 offen sc1
  buffer_load_dwordx4 v[112:115], v8, s[8:11], s81 offen offset:0 sc1
  buffer_load_dwordx4 v[116:119], v8, s[8:11], s81 offen offset:1024 sc1
  s_sleep 2
  buffer_load_dwordx4 v[144:147], v10, s[8:11], s81 offen offset:0 sc1
  buffer_load_dwordx4 v[148:151], v10, s[8:11], s81 offen offset:1024 sc1
  buffer_load_dwordx4 v[152:155], v10, s[8:11], s81 offen offset:2048 sc1
  v_mov_b32 v188, 0
  v_mov_b32 v189, 0
  v_mov_b32 v190, 0
  v_mov_b32 v191, 0
  v_mov_b32 v192, 0
  v_mov_b32 v193, 0
  v_mov_b32 v194, 0
  v_mov_b32 v195, 0
  v_mov_b32 v196, 0
  v_mov_b32 v197, 0
  v_mov_b32 v198, 0
  v_mov_b32 v199, 0
  v_readfirstlane_b32 s21, v94
  s_add_u32 s22, s46, 2
  s_min_u32 s22, s22, 64
  s_sub_u32 s55, s21, s22
  s_sub_u32 s56, s21, s46
  s_cmp_lt_i32 s56, 0
  s_cbranch_scc1 kvw_63
kvok_64:
  s_waitcnt vmcnt(5)
  v_xor_b32 v96, s88, v248
  s_nop 0
  v_permlane16_swap_b32 v248, v249
  v_fma_mix_f32 v250, v248, 1.0, v249 op_sel:[0,0,0] op_sel_hi:[1,0,1]
  v_fma_mix_f32 v251, v248, 1.0, v249 op_sel:[1,0,1] op_sel_hi:[1,0,1]
  v_mov_b32 v248, v250
  v_mov_b32 v249, v251
  s_nop 0
  v_permlane32_swap_b32 v248, v250
  v_permlane32_swap_b32 v249, v251
  v_pk_add_f32 v[124:125], v[248:249], v[250:251]
  v_max_f32 v238, v124, v125
  s_waitcnt vmcnt(3)
  v_pk_add_f16 v100, v112, v116
  v_pk_add_f16 v102, v114, v118
  v_pk_add_f16 v101, v113, v117
  v_pk_add_f16 v103, v115, v119
  v_permlane32_swap_b32 v100, v102
  v_bitop3_b32 v97, v112, v114, s88 bitop3:0x7e
  v_permlane32_swap_b32 v101, v103
  v_bitop3_b32 v98, v116, v118, s88 bitop3:0x7e
  v_fma_mix_f32 v120, v100, 1.0, v102 op_sel:[0,0,0] op_sel_hi:[1,0,1]
  v_or3_b32 v27, v96, v97, v98
  v_fma_mix_f32 v121, v100, 1.0, v102 op_sel:[1,0,1] op_sel_hi:[1,0,1]
  v_and_b32 v27, 1, v27
  v_fma_mix_f32 v122, v101, 1.0, v103 op_sel:[0,0,0] op_sel_hi:[1,0,1]
  v_cmp_ne_u32 vcc, 0, v27
  v_fma_mix_f32 v123, v101, 1.0, v103 op_sel:[1,0,1] op_sel_hi:[1,0,1]
  v_max3_f32 v236, v120, v121, v238
  s_cbranch_vccnz psr_60
psj_61:
  v_max3_f32 v236, v236, v122, v123
  s_nop 1
  v_max_f32_dpp v236, v236, v236 row_ror:8 row_mask:0xf bank_mask:0xf
  v_mov_b32 v237, v236
  s_waitcnt vmcnt(0)
  v_max3_u32 v27, v144, v146, v148
  v_permlane32_swap_b32 v236, v237
  v_max_f32 v236, v236, v237
  v_mov_b32 v237, v236
  v_max3_u32 v27, v27, v150, v152
  v_max_u32 v27, v27, v154
  v_permlane16_swap_b32 v236, v237
  v_cmp_eq_u32 vcc, -1, v27
  v_max_f32 v236, v236, v237
  v_mul_f32 v236, s86, v236
  s_cbranch_vccnz pv_59
pvj_62:
  v_smfmac_f32_16x16x64_bf16 v[188:191], v[144:147], a[180:187], v44
  v_fma_f32 v120, v120, s86, -v236
  v_smfmac_f32_16x16x64_bf16 v[188:191], v[148:151], a[188:195], v44
  v_fma_f32 v121, v121, s86, -v236
  v_smfmac_f32_16x16x64_bf16 v[188:191], v[152:155], a[196:203], v44
  buffer_load_dwordx4 v[160:163], v17, s[28:31], s64 offen offset:0 sc1
  v_fma_f32 v122, v122, s86, -v236
  v_smfmac_f32_16x16x64_bf16 v[192:195], v[144:147], a[204:211], v44
  v_fma_f32 v123, v123, s86, -v236
  v_smfmac_f32_16x16x64_bf16 v[192:195], v[148:151], a[212:219], v44
  buffer_load_dwordx4 v[164:167], v16, s[28:31], s64 offen offset:1024 sc1
  v_fma_f32 v124, v124, s86, -v236
  v_smfmac_f32_16x16x64_bf16 v[192:195], v[152:155], a[220:227], v44
  v_fma_f32 v125, v125, s86, -v236
  v_smfmac_f32_16x16x64_bf16 v[196:199], v[144:147], a[228:235], v44
  buffer_load_dwordx4 v[48:51], v26, s[28:31], s64 offen offset:2048 sc1
  v_exp_f32 v120, v120
  v_smfmac_f32_16x16x64_bf16 v[196:199], v[148:151], a[236:243], v44
  v_exp_f32 v121, v121
  v_smfmac_f32_16x16x64_bf16 v[196:199], v[152:155], a[244:251], v44
  v_exp_f32 v122, v122
  v_exp_f32 v123, v123
  v_exp_f32 v124, v124
  v_exp_f32 v125, v125
  v_cvt_pk_bf16_f32 v220, v120, v121
  v_cvt_pk_bf16_f32 v221, v122, v123
  v_cvt_pk_bf16_f32 v224, v124, v125
  v_mov_b32_dpp v222, v220 row_ror:8 row_mask:0xf bank_mask:0xf
  v_mov_b32_dpp v223, v221 row_ror:8 row_mask:0xf bank_mask:0xf
  v_mov_b32_dpp v225, v224 row_ror:8 row_mask:0xf bank_mask:0xf
  v_cvt_pk_bf16_f32 v228, v188, v189
  v_mfma_f32_16x16x32_bf16 v[200:203], v[176:179], v[220:223], 0
  v_cvt_pk_bf16_f32 v229, v190, v191
  v_cvt_pk_bf16_f32 v230, v192, v193
  v_mfma_f32_16x16x32_bf16 v[204:207], v[180:183], v[220:223], 0
  v_cvt_pk_bf16_f32 v231, v194, v195
  v_cvt_pk_bf16_f32 v232, v196, v197
  v_mfma_f32_16x16x32_bf16 v[208:211], v[184:187], v[220:223], 0
  v_cvt_pk_bf16_f32 v233, v198, v199
  v_add_f32 v126, v120, v121
  v_mfma_f32_16x16x32_bf16 v[200:203], v[228:231], v[224:227], v[200:203]
  v_add_f32 v127, v122, v123
  v_add_f32 v128, v124, v125
  v_mfma_f32_16x16x32_bf16 v[204:207], v[230:233], v[224:227], v[204:207]
  v_add_f32 v236, v126, v127
  v_fmac_f32 v236, v128, v89
  v_mfma_f32_16x16x32_bf16 v[208:211], v[232:235], v[224:227], v[208:211]
  s_nop 0
  v_add_f32_dpp v236, v236, v236 row_ror:8 row_mask:0xf bank_mask:0xf
  v_mov_b32 v237, v236
  ds_write_b128 v11, v[200:203] offset:0
  s_nop 0
  v_permlane32_swap_b32 v236, v237
  v_add_f32 v236, v236, v237
  v_mov_b32 v237, v236
  ds_write_b128 v11, v[204:207] offset:1024
  s_nop 0
  v_permlane16_swap_b32 v236, v237
  v_add_f32 v236, v236, v237
  v_rcp_f32 v236, v236
  ds_write_b128 v11, v[208:211] offset:2048
  s_mov_b64 exec, 0xff
  ds_write_b32 v242, v236
  s_mov_b64 exec, -1
  s_waitcnt lgkmcnt(0)
  s_barrier
  ds_read_b128 v[104:107], v243
  ds_read_b64 v[96:97], v12 offset:0
  ds_read_b64 v[98:99], v12 offset:3072
  ds_read_b64 v[100:101], v12 offset:6144
  ds_read_b64 v[102:103], v12 offset:9216
  s_waitcnt lgkmcnt(2)
  v_pk_mul_f32 v[96:97], v[96:97], v[104:105] op_sel_hi:[1,0]
  v_pk_fma_f32 v[96:97], v[98:99], v[104:105], v[96:97] op_sel:[0,1,0] op_sel_hi:[1,1,1]
  s_waitcnt lgkmcnt(0)
  v_pk_fma_f32 v[96:97], v[100:101], v[106:107], v[96:97] op_sel_hi:[1,0,1]
  v_pk_fma_f32 v[96:97], v[102:103], v[106:107], v[96:97] op_sel:[0,1,0] op_sel_hi:[1,1,1]
  v_cvt_pk_f16_f32 v100, v96, v97
  v_perm_b32 v100, s91, v100, v14
  buffer_atomic_pk_add_f16 v100, v13, s[4:7], s3 offen
  s_mov_b64 exec, s[62:63]
  buffer_store_dwordx4 v[212:215], v21, s[24:27], s85 offen sc1
  buffer_store_dwordx2 v[216:217], v23, s[24:27], s85 offen sc1
  s_mov_b64 exec, -1
  v_mov_b32 v200, v196
  v_mov_b32 v201, v197
  v_mov_b32 v202, v198
  v_mov_b32 v203, v199
  v_permlane32_swap_b32 v188, v192
  v_permlane32_swap_b32 v189, v193
  v_permlane32_swap_b32 v190, v194
  v_permlane32_swap_b32 v191, v195
  v_permlane32_swap_b32 v196, v200
  v_permlane32_swap_b32 v197, v201
  v_permlane32_swap_b32 v198, v202
  v_permlane32_swap_b32 v199, v203
  v_pk_add_f32 v[188:189], v[188:189], v[192:193]
  v_pk_add_f32 v[190:191], v[190:191], v[194:195]
  v_pk_add_f32 v[196:197], v[196:197], v[200:201]
  v_pk_add_f32 v[198:199], v[198:199], v[202:203]
  v_cvt_pk_bf16_f32 v252, v188, v189
  v_cvt_pk_bf16_f32 v254, v196, v197
  v_cvt_pk_bf16_f32 v253, v190, v191
  v_cvt_pk_bf16_f32 v255, v198, v199
  s_nop 0
  v_permlane16_swap_b32 v252, v254
  v_permlane16_swap_b32 v253, v255
  v_min_u32 v252, -2, v252
  s_mov_b64 exec, s[76:77]
  buffer_store_dwordx4 v[252:255], v15, s[24:27], s57 offen sc1
  s_mov_b64 exec, -1
  s_add_u32 s64, s64, 1310720
  s_add_u32 s52, s52, 1
  s_and_b32 s21, s52, 3
  s_mul_i32 s81, s21, 540672
  s_lshl_b32 s84, s21, 15
  s_branch step_53
fl_57:
  buffer_load_dword v94, v95, s[12:15], s79 offen sc1
  s_branch fl_58
pm_55:
  s_cmp_gt_u32 s52, 3
  s_cbranch_scc1 op_65
  v_readfirstlane_b32 s21, v94
  s_cmp_ge_u32 s21, s46
  s_cbranch_scc1 op_65
  buffer_load_dword v94, v95, s[12:15], s79 offen sc1
  s_waitcnt vmcnt(0)
  v_readfirstlane_b32 s21, v94
  s_add_u32 s22, s46, 2
  s_min_u32 s22, s22, 64
  s_sub_u32 s55, s21, s22
  s_sub_u32 s56, s21, s46
  s_cmp_gt_u32 s21, s52
  s_cselect_b32 s21, s87, 0
  s_cmp_eq_u32 s21, 0
  s_cbranch_scc1 op_65
  s_mov_b32 s87, 0
  s_sub_u32 s21, s64, 1310720
  buffer_load_dwordx4 v[176:179], v16, s[28:31], s21 offen offset:0 sc1
  buffer_load_dwordx4 v[180:183], v16, s[28:31], s21 offen offset:1024 sc1
  buffer_load_dwordx4 v[184:187], v16, s[28:31], s21 offen offset:2048 sc1
op_65:
  buffer_load_dwordx4 v[32:35], v4, s[4:7], s84 offen offset:0 sc1
  buffer_load_dwordx4 v[36:39], v4, s[4:7], s84 offen offset:1024 sc1
  buffer_load_dwordx4 v[40:43], v4, s[4:7], s84 offen offset:2048 sc1
  s_add_u32 s54, s54, 1
  s_cmp_gt_u32 s54, 131072
  s_cbranch_scc1 end0
  s_waitcnt vmcnt(0)
  v_bitop3_b32 v27, v35, v39, v43 bitop3:0x80
  v_perm_b32 v35, v39, v35, s89
  v_cmp_gt_u32 vcc, 0x48000000, v27
  v_mov_b32 v39, v42
  s_cbranch_vccnz pm_55
  s_branch A1_17
pv_59:
  buffer_load_dwordx4 v[144:147], v10, s[8:11], s81 offen offset:0 sc1
  buffer_load_dwordx4 v[148:151], v10, s[8:11], s81 offen offset:1024 sc1
  buffer_load_dwordx4 v[152:155], v10, s[8:11], s81 offen offset:2048 sc1
  s_add_u32 s54, s54, 1
  s_cmp_gt_u32 s54, 131072
  s_cbranch_scc1 end0
  s_waitcnt vmcnt(0)
  v_max3_u32 v27, v144, v146, v148
  v_max3_u32 v27, v27, v150, v152
  v_max3_u32 v27, v27, v154, v154
  v_cmp_eq_u32 vcc, -1, v27
  s_nop 1
  s_cbranch_vccnz pv_59
  s_branch pvj_62
psr_60:
  buffer_load_dwordx2 v[248:249], v9, s[8:11], s81 offen sc1
  buffer_load_dwordx4 v[112:115], v8, s[8:11], s81 offen offset:0 sc1
  buffer_load_dwordx4 v[116:119], v8, s[8:11], s81 offen offset:1024 sc1
  s_add_u32 s54, s54, 1
  s_cmp_gt_u32 s54, 131072
  s_cbranch_scc1 end0
  s_waitcnt vmcnt(2)
  v_xor_b32 v96, s88, v248
  s_nop 0
  v_permlane16_swap_b32 v248, v249
  v_fma_mix_f32 v250, v248, 1.0, v249 op_sel:[0,0,0] op_sel_hi:[1,0,1]
  v_fma_mix_f32 v251, v248, 1.0, v249 op_sel:[1,0,1] op_sel_hi:[1,0,1]
  v_mov_b32 v248, v250
  v_mov_b32 v249, v251
  s_nop 0
  v_permlane32_swap_b32 v248, v250
  v_permlane32_swap_b32 v249, v251
  v_pk_add_f32 v[124:125], v[248:249], v[250:251]
  v_max_f32 v238, v124, v125
  s_waitcnt vmcnt(0)
  v_pk_add_f16 v100, v112, v116
  v_pk_add_f16 v102, v114, v118
  v_pk_add_f16 v101, v113, v117
  v_pk_add_f16 v103, v115, v119
  v_permlane32_swap_b32 v100, v102
  v_bitop3_b32 v97, v112, v114, s88 bitop3:0x7e
  v_permlane32_swap_b32 v101, v103
  v_bitop3_b32 v98, v116, v118, s88 bitop3:0x7e
  v_fma_mix_f32 v120, v100, 1.0, v102 op_sel:[0,0,0] op_sel_hi:[1,0,1]
  v_or3_b32 v27, v96, v97, v98
  v_fma_mix_f32 v121, v100, 1.0, v102 op_sel:[1,0,1] op_sel_hi:[1,0,1]
  v_and_b32 v27, 1, v27
  v_fma_mix_f32 v122, v101, 1.0, v103 op_sel:[0,0,0] op_sel_hi:[1,0,1]
  v_cmp_ne_u32 vcc, 0, v27
  v_fma_mix_f32 v123, v101, 1.0, v103 op_sel:[1,0,1] op_sel_hi:[1,0,1]
  v_max3_f32 v236, v120, v121, v238
  s_cbranch_vccnz psr_60
  s_branch psj_61
kvw_63:
  s_mov_b32 s22, s87
  s_cmp_eq_u32 s52, 0
  s_cselect_b32 s23, s87, s46
  s_cselect_b32 s55, 0, s55
  s_cselect_b32 s87, 1, 0
  s_cmp_eq_u32 s23, 0
  s_cbranch_scc1 kvok_64
  v_mov_b32 v236, 0
  s_mov_b32 s101, 0
wf_66:
  buffer_load_dword v237, v236, s[12:15], s79 offen sc1
  s_add_u32 s101, s101, 1
  s_cmp_gt_u32 s101, 131072
  s_cbranch_scc1 end0
  s_waitcnt vmcnt(0)
  v_readfirstlane_b32 s100, v237
  s_cmp_ge_u32 s100, s23
  s_cbranch_scc1 wf_67
  s_sleep 3
  s_branch wf_66
wf_67:
  s_cmp_eq_u32 s22, 0
  s_cbranch_scc1 kvok_64
  s_sub_u32 s21, s64, 1310720
  buffer_load_dwordx4 v[176:179], v16, s[28:31], s21 offen offset:0 sc1
  buffer_load_dwordx4 v[180:183], v16, s[28:31], s21 offen offset:1024 sc1
  buffer_load_dwordx4 v[184:187], v16, s[28:31], s21 offen offset:2048 sc1
  s_waitcnt vmcnt(0)
  s_branch kvok_64
last_54:
  s_mov_b64 exec, s[62:63]
  buffer_store_dwordx4 v[212:215], v21, s[24:27], s85 offen sc1
  buffer_store_dwordx2 v[216:217], v23, s[24:27], s85 offen sc1
  s_mov_b64 exec, -1
  v_mov_b32 v188, 0
  v_mov_b32 v189, 0
  v_mov_b32 v190, 0
  v_mov_b32 v191, 0
  v_mov_b32 v192, 0
  v_mov_b32 v193, 0
  v_mov_b32 v194, 0
  v_mov_b32 v195, 0
  v_mov_b32 v196, 0
  v_mov_b32 v197, 0
  v_mov_b32 v198, 0
  v_mov_b32 v199, 0
  s_sleep 4
  s_mov_b32 s54, 0
lv_68:
  buffer_load_dwordx4 v[144:147], v10, s[8:11], s81 offen offset:0 sc1
  buffer_load_dwordx4 v[148:151], v10, s[8:11], s81 offen offset:1024 sc1
  buffer_load_dwordx4 v[152:155], v10, s[8:11], s81 offen offset:2048 sc1
  s_add_u32 s54, s54, 1
  s_cmp_gt_u32 s54, 131072
  s_cbranch_scc1 end0
  s_waitcnt vmcnt(0)
  v_max3_u32 v27, v144, v146, v148
  v_max3_u32 v27, v27, v150, v152
  v_max3_u32 v27, v27, v154, v154
  v_cmp_eq_u32 vcc, -1, v27
  s_nop 1
  s_cbranch_vccnz lv_68
  v_smfmac_f32_16x16x64_bf16 v[188:191], v[144:147], a[180:187], v44
  v_smfmac_f32_16x16x64_bf16 v[192:195], v[144:147], a[204:211], v44
  v_smfmac_f32_16x16x64_bf16 v[196:199], v[144:147], a[228:235], v44
  v_smfmac_f32_16x16x64_bf16 v[188:191], v[148:151], a[188:195], v44
  v_smfmac_f32_16x16x64_bf16 v[192:195], v[148:151], a[212:219], v44
  v_smfmac_f32_16x16x64_bf16 v[196:199], v[148:151], a[236:243], v44
  v_smfmac_f32_16x16x64_bf16 v[188:191], v[152:155], a[196:203], v44
  v_smfmac_f32_16x16x64_bf16 v[192:195], v[152:155], a[220:227], v44
  v_smfmac_f32_16x16x64_bf16 v[196:199], v[152:155], a[244:251], v44
  s_nop 7
  v_mov_b32 v200, v196
  v_mov_b32 v201, v197
  v_mov_b32 v202, v198
  v_mov_b32 v203, v199
  v_permlane32_swap_b32 v188, v192
  v_permlane32_swap_b32 v189, v193
  v_permlane32_swap_b32 v190, v194
  v_permlane32_swap_b32 v191, v195
  v_permlane32_swap_b32 v196, v200
  v_permlane32_swap_b32 v197, v201
  v_permlane32_swap_b32 v198, v202
  v_permlane32_swap_b32 v199, v203
  v_pk_add_f32 v[188:189], v[188:189], v[192:193]
  v_pk_add_f32 v[190:191], v[190:191], v[194:195]
  v_pk_add_f32 v[196:197], v[196:197], v[200:201]
  v_pk_add_f32 v[198:199], v[198:199], v[202:203]
  v_cvt_pk_bf16_f32 v252, v188, v189
  v_cvt_pk_bf16_f32 v254, v196, v197
  v_cvt_pk_bf16_f32 v253, v190, v191
  v_cvt_pk_bf16_f32 v255, v198, v199
  s_nop 0
  v_permlane16_swap_b32 v252, v254
  v_permlane16_swap_b32 v253, v255
  v_min_u32 v252, -2, v252
  s_mov_b64 exec, s[76:77]
  buffer_store_dwordx4 v[252:255], v15, s[24:27], s57 offen sc1
  s_mov_b64 exec, -1
  s_branch chain_done
step_69:
  s_add_u32 s21, s52, 2
  s_and_b32 s21, s21, 3
  s_mul_i32 s82, s21, 540672
  s_add_u32 s21, s52, 3
  s_and_b32 s21, s21, 3
  s_lshl_b32 s83, s21, 15
  s_add_u32 s21, s52, 1
  s_and_b32 s22, s21, 3
  s_lshl_b32 s3, s22, 15
  s_mul_i32 s80, s21, 393216
  s_add_u32 s46, s21, 1
  s_min_u32 s46, s46, 64
  s_mul_i32 s85, s52, 98304
  s_mul_i32 s57, s52, 327680
  s_add_u32 s57, s57, 42991616

  s_bfe_u32 s88, s52, 0x10002
  s_add_u32 s78, s81, 278528
  s_max_u32 s21, s52, 1
  s_sub_u32 s21, s21, 1
  s_cmp_lt_u32 s52, 98
  s_cselect_b32 s66, s65, 0x80000000
  s_cselect_b32 s68, 15, 1
  s_cmp_ge_u32 s52, 99
  s_cselect_b32 s66, s90, s66
  s_cselect_b32 s67, s52, s21
  v_mov_b32 v52, 0
  v_mov_b32 v53, 0
  v_mov_b32 v54, 0
  v_mov_b32 v55, 0
  v_mov_b32 v56, 0
  v_mov_b32 v57, 0
  v_mov_b32 v58, 0
  v_mov_b32 v59, 0
  v_mov_b32 v60, 0
  v_mov_b32 v61, 0
  v_mov_b32 v62, 0
  v_mov_b32 v63, 0
  v_mov_b32 v64, 0
  v_mov_b32 v65, 0
  v_mov_b32 v66, 0
  v_mov_b32 v67, 0
  v_mov_b32 v68, 0
  v_mov_b32 v69, 0
  v_mov_b32 v70, 0
  v_mov_b32 v71, 0
  v_mov_b32 v72, 0
  v_mov_b32 v73, 0
  v_mov_b32 v74, 0
  v_mov_b32 v75, 0
  v_mov_b32 v76, 0
  v_mov_b32 v77, 0
  v_mov_b32 v78, 0
  v_mov_b32 v79, 0
  v_mov_b32 v80, 0
  v_mov_b32 v81, 0
  v_mov_b32 v82, 0
  v_mov_b32 v83, 0
  v_mov_b32 v84, 0
  v_mov_b32 v85, 0
  v_mov_b32 v86, 0
  v_mov_b32 v87, 0
  s_sleep 4
  s_nop 3
  s_cmp_lt_i32 s55, 0
  s_cbranch_scc1 fl_73
fl_74:
  s_mov_b32 s54, 0
  buffer_load_dwordx4 v[32:35], v4, s[4:7], s84 offen offset:0 sc1
  buffer_load_dwordx4 v[36:39], v4, s[4:7], s84 offen offset:1024 sc1
  buffer_load_dwordx4 v[40:43], v4, s[4:7], s84 offen offset:2048 sc1
  s_waitcnt vmcnt(3)
  v_mov_b32 v176, v160
  v_mov_b32 v177, v161
  v_mov_b32 v178, v162
  v_mov_b32 v179, v163
  v_mov_b32 v180, v164
  v_mov_b32 v181, v165
  v_mov_b32 v182, v166
  v_mov_b32 v183, v167
  v_mov_b32 v184, v48
  v_mov_b32 v185, v49
  v_mov_b32 v186, v50
  v_mov_b32 v187, v51
  s_waitcnt vmcnt(0)
  v_bitop3_b32 v27, v35, v39, v43 bitop3:0x80
  v_perm_b32 v35, v39, v35, s89
  v_cmp_gt_u32 vcc, 0x48000000, v27
  v_mov_b32 v39, v42
  s_cbranch_vccnz pm_71
A1_18:
  v_smfmac_f32_16x16x32_f16 v[52:55], v[40:41], a[16:19], v44
  v_smfmac_f32_16x16x32_f16 v[64:67], v[40:41], a[76:79], v44
  v_smfmac_f32_16x16x32_f16 v[56:59], v[40:41], a[36:39], v44
  v_smfmac_f32_16x16x32_f16 v[68:71], v[40:41], a[96:99], v44
  v_smfmac_f32_16x16x64_f16 v[52:55], v[32:35], a[0:7], v44
  v_smfmac_f32_16x16x64_f16 v[52:55], v[36:39], a[8:15], v44
  v_smfmac_f32_16x16x64_f16 v[64:67], v[32:35], a[60:67], v44
  v_smfmac_f32_16x16x64_f16 v[64:67], v[36:39], a[68:75], v44
  v_smfmac_f32_16x16x32_f16 v[60:63], v[40:41], a[56:59], v44
  v_cvt_pk_f16_f32 v52, v52, v53
  v_cvt_pk_f16_f32 v53, v54, v55
  v_smfmac_f32_16x16x32_f16 v[72:75], v[40:41], a[116:119], v44
  v_smfmac_f32_16x16x32_f16 v[76:79], v[40:41], a[136:139], v44
  v_cvt_pk_f16_f32 v64, v64, v65
  v_cvt_pk_f16_f32 v65, v66, v67
  s_nop 0
  v_smfmac_f32_16x16x64_f16 v[56:59], v[32:35], a[20:27], v44
  v_permlane32_swap_b32 v52, v64
  v_smfmac_f32_16x16x64_f16 v[56:59], v[36:39], a[28:35], v44
  v_permlane32_swap_b32 v53, v65
  v_pk_add_f16 v52, v52, v64
  v_smfmac_f32_16x16x64_f16 v[68:71], v[32:35], a[80:87], v44
  v_pk_add_f16 v53, v53, v65
  v_smfmac_f32_16x16x64_f16 v[68:71], v[36:39], a[88:95], v44
  ds_write_b64 v5, v[52:53] offset:0
  v_smfmac_f32_16x16x32_f16 v[80:83], v[40:41], a[156:159], v44
  v_cvt_pk_f16_f32 v56, v56, v57
  v_cvt_pk_f16_f32 v57, v58, v59
  v_smfmac_f32_16x16x32_f16 v[84:87], v[40:41], a[176:179], v44
  v_cvt_pk_f16_f32 v68, v68, v69
  v_cvt_pk_f16_f32 v69, v70, v71
  s_nop 0
  v_smfmac_f32_16x16x64_f16 v[60:63], v[32:35], a[40:47], v44
  v_permlane32_swap_b32 v56, v68
  v_smfmac_f32_16x16x64_f16 v[60:63], v[36:39], a[48:55], v44
  v_permlane32_swap_b32 v57, v69
  v_pk_add_f16 v56, v56, v68
  v_smfmac_f32_16x16x64_f16 v[72:75], v[32:35], a[100:107], v44
  v_pk_add_f16 v57, v57, v69
  v_smfmac_f32_16x16x64_f16 v[72:75], v[36:39], a[108:115], v44
  ds_write_b64 v5, v[56:57] offset:640
  v_smfmac_f32_16x16x64_f16 v[76:79], v[32:35], a[120:127], v44
  v_cvt_pk_f16_f32 v60, v60, v61
  v_cvt_pk_f16_f32 v61, v62, v63
  v_smfmac_f32_16x16x64_f16 v[76:79], v[36:39], a[128:135], v44
  v_cvt_pk_f16_f32 v72, v72, v73
  v_cvt_pk_f16_f32 v73, v74, v75
  s_nop 0
  v_smfmac_f32_16x16x64_f16 v[80:83], v[32:35], a[140:147], v44
  v_permlane32_swap_b32 v60, v72
  v_smfmac_f32_16x16x64_f16 v[80:83], v[36:39], a[148:155], v44
  v_permlane32_swap_b32 v61, v73
  v_pk_add_f16 v60, v60, v72
  v_smfmac_f32_16x16x64_f16 v[84:87], v[32:35], a[160:167], v44
  v_pk_add_f16 v61, v61, v73
  v_smfmac_f32_16x16x64_f16 v[84:87], v[36:39], a[168:175], v44
  ds_write_b64 v5, v[60:61] offset:1280
  v_cvt_pk_f16_f32 v76, v76, v77
  v_cvt_pk_f16_f32 v77, v78, v79
  v_cvt_pk_f16_f32 v80, v80, v81
  v_cvt_pk_f16_f32 v81, v82, v83
  s_nop 0
  v_permlane32_swap_b32 v76, v80
  v_permlane32_swap_b32 v77, v81
  v_pk_add_f16 v76, v76, v80
  v_pk_add_f16 v77, v77, v81
  ds_write_b64 v5, v[76:77] offset:1920
  v_cvt_pk_f16_f32 v84, v84, v85
  v_cvt_pk_f16_f32 v85, v86, v87
  ds_write_b64 v5, v[84:85] offset:2560
  s_waitcnt lgkmcnt(0) vmcnt(0)
  s_barrier
  ds_read_b64_tr_b16 v[96:97], v6 offset:1920
  ds_read_b64_tr_b16 v[98:99], v6 offset:5120
  ds_read_b64_tr_b16 v[100:101], v6 offset:8320
  ds_read_b64_tr_b16 v[102:103], v6 offset:11520
  ds_read_b64_tr_b16 v[104:105], v6 offset:2560
  ds_read_b64_tr_b16 v[106:107], v6 offset:5760
  ds_read_b64_tr_b16 v[108:109], v6 offset:8960
  ds_read_b64_tr_b16 v[110:111], v6 offset:12160
  s_waitcnt lgkmcnt(4)
  v_pk_add_f16 v96, v96, v98
  v_pk_add_f16 v100, v100, v102
  v_pk_add_f16 v97, v97, v99
  v_pk_add_f16 v101, v101, v103
  v_fma_mix_f32 v112, v96, 1.0, v100 op_sel:[0,0,0] op_sel_hi:[1,0,1]
  v_fma_mix_f32 v113, v96, 1.0, v100 op_sel:[1,0,1] op_sel_hi:[1,0,1]
  v_fma_mix_f32 v114, v97, 1.0, v101 op_sel:[0,0,0] op_sel_hi:[1,0,1]
  v_fma_mix_f32 v115, v97, 1.0, v101 op_sel:[1,0,1] op_sel_hi:[1,0,1]
  v_cvt_pk_bf16_f32 v90, v112, v113
  v_cvt_pk_bf16_f32 v91, v114, v115
  v_min_u32 v90, -2, v90
  buffer_store_dwordx2 v[90:91], v24, s[8:11], s81 offen
  s_waitcnt lgkmcnt(0)
  v_pk_add_f16 v104, v104, v106
  v_pk_add_f16 v108, v108, v110
  v_pk_add_f16 v105, v105, v107
  v_pk_add_f16 v109, v109, v111
  v_fma_mix_f32 v112, v104, 1.0, v108 op_sel:[0,0,0] op_sel_hi:[1,0,1]
  v_fma_mix_f32 v113, v104, 1.0, v108 op_sel:[1,0,1] op_sel_hi:[1,0,1]
  v_fma_mix_f32 v114, v105, 1.0, v109 op_sel:[0,0,0] op_sel_hi:[1,0,1]
  v_fma_mix_f32 v115, v105, 1.0, v109 op_sel:[1,0,1] op_sel_hi:[1,0,1]
  v_add_f32_dpp v116, v112, v112 row_ror:8 row_mask:0xf bank_mask:0xf
  v_add_f32_dpp v117, v113, v113 row_ror:8 row_mask:0xf bank_mask:0xf
  v_add_f32_dpp v118, v114, v114 row_ror:8 row_mask:0xf bank_mask:0xf
  v_add_f32_dpp v119, v115, v115 row_ror:8 row_mask:0xf bank_mask:0xf
  v_cvt_pk_bf16_f32 v92, v116, v117
  v_cvt_pk_bf16_f32 v93, v118, v119
  v_min_u32 v92, -2, v92
  s_mov_b64 exec, s[60:61]
  buffer_store_dwordx2 v[92:93], v23, s[8:11], s78 offen
  s_mov_b64 exec, -1
  s_cmp_eq_u32 s52, 63
  s_cbranch_scc1 last_70
  s_sleep 5
  s_nop 3
  s_mov_b32 s54, 0
  buffer_load_dwordx2 v[248:249], v9, s[8:11], s81 offen sc1
  buffer_load_dwordx4 v[112:115], v8, s[8:11], s81 offen offset:0 sc1
  buffer_load_dwordx4 v[116:119], v8, s[8:11], s81 offen offset:1024 sc1
  s_sleep 2
  buffer_load_dwordx4 v[144:147], v10, s[8:11], s81 offen offset:0 sc1
  buffer_load_dwordx4 v[148:151], v10, s[8:11], s81 offen offset:1024 sc1
  buffer_load_dwordx4 v[152:155], v10, s[8:11], s81 offen offset:2048 sc1
  v_mov_b32 v188, 0
  v_mov_b32 v189, 0
  v_mov_b32 v190, 0
  v_mov_b32 v191, 0
  v_mov_b32 v192, 0
  v_mov_b32 v193, 0
  v_mov_b32 v194, 0
  v_mov_b32 v195, 0
  v_mov_b32 v196, 0
  v_mov_b32 v197, 0
  v_mov_b32 v198, 0
  v_mov_b32 v199, 0
  v_readfirstlane_b32 s21, v94
  s_add_u32 s22, s46, 2
  s_min_u32 s22, s22, 64
  s_sub_u32 s55, s21, s22
  s_sub_u32 s56, s21, s46
  s_cmp_lt_i32 s56, 0
  s_cbranch_scc1 kvw_79
kvok_80:
  s_waitcnt vmcnt(5)
  v_xor_b32 v96, s88, v248
  s_nop 0
  v_permlane16_swap_b32 v248, v249
  v_fma_mix_f32 v250, v248, 1.0, v249 op_sel:[0,0,0] op_sel_hi:[1,0,1]
  v_fma_mix_f32 v251, v248, 1.0, v249 op_sel:[1,0,1] op_sel_hi:[1,0,1]
  v_mov_b32 v248, v250
  v_mov_b32 v249, v251
  s_nop 0
  v_permlane32_swap_b32 v248, v250
  v_permlane32_swap_b32 v249, v251
  v_pk_add_f32 v[124:125], v[248:249], v[250:251]
  v_max_f32 v238, v124, v125
  s_waitcnt vmcnt(3)
  v_pk_add_f16 v100, v112, v116
  v_pk_add_f16 v102, v114, v118
  v_pk_add_f16 v101, v113, v117
  v_pk_add_f16 v103, v115, v119
  v_permlane32_swap_b32 v100, v102
  v_bitop3_b32 v97, v112, v114, s88 bitop3:0x7e
  v_permlane32_swap_b32 v101, v103
  v_bitop3_b32 v98, v116, v118, s88 bitop3:0x7e
  v_fma_mix_f32 v120, v100, 1.0, v102 op_sel:[0,0,0] op_sel_hi:[1,0,1]
  v_or3_b32 v27, v96, v97, v98
  v_fma_mix_f32 v121, v100, 1.0, v102 op_sel:[1,0,1] op_sel_hi:[1,0,1]
  v_and_b32 v27, 1, v27
  v_fma_mix_f32 v122, v101, 1.0, v103 op_sel:[0,0,0] op_sel_hi:[1,0,1]
  v_cmp_ne_u32 vcc, 0, v27
  v_fma_mix_f32 v123, v101, 1.0, v103 op_sel:[1,0,1] op_sel_hi:[1,0,1]
  v_max3_f32 v236, v120, v121, v238
  s_cbranch_vccnz psr_76
psj_77:
  v_max3_f32 v236, v236, v122, v123
  s_nop 1
  v_max_f32_dpp v236, v236, v236 row_ror:8 row_mask:0xf bank_mask:0xf
  v_mov_b32 v237, v236
  s_waitcnt vmcnt(0)
  v_max3_u32 v27, v144, v146, v148
  v_permlane32_swap_b32 v236, v237
  v_max_f32 v236, v236, v237
  v_mov_b32 v237, v236
  v_max3_u32 v27, v27, v150, v152
  v_max_u32 v27, v27, v154
  v_permlane16_swap_b32 v236, v237
  v_cmp_eq_u32 vcc, -1, v27
  v_max_f32 v236, v236, v237
  v_mul_f32 v236, s86, v236
  s_cbranch_vccnz pv_75
pvj_78:
  v_smfmac_f32_16x16x64_bf16 v[188:191], v[144:147], a[180:187], v44
  v_fma_f32 v120, v120, s86, -v236
  v_smfmac_f32_16x16x64_bf16 v[188:191], v[148:151], a[188:195], v44
  v_fma_f32 v121, v121, s86, -v236
  v_smfmac_f32_16x16x64_bf16 v[188:191], v[152:155], a[196:203], v44
  buffer_load_dwordx4 v[160:163], v17, s[28:31], s64 offen offset:0 sc1
  v_fma_f32 v122, v122, s86, -v236
  v_smfmac_f32_16x16x64_bf16 v[192:195], v[144:147], a[204:211], v44
  v_fma_f32 v123, v123, s86, -v236
  v_smfmac_f32_16x16x64_bf16 v[192:195], v[148:151], a[212:219], v44
  buffer_load_dwordx4 v[164:167], v16, s[28:31], s64 offen offset:1024 sc1
  v_fma_f32 v124, v124, s86, -v236
  v_smfmac_f32_16x16x64_bf16 v[192:195], v[152:155], a[220:227], v44
  v_fma_f32 v125, v125, s86, -v236
  v_smfmac_f32_16x16x64_bf16 v[196:199], v[144:147], a[228:235], v44
  buffer_load_dwordx4 v[48:51], v26, s[28:31], s64 offen offset:2048 sc1
  v_exp_f32 v120, v120
  v_smfmac_f32_16x16x64_bf16 v[196:199], v[148:151], a[236:243], v44
  v_exp_f32 v121, v121
  v_smfmac_f32_16x16x64_bf16 v[196:199], v[152:155], a[244:251], v44
  v_exp_f32 v122, v122
  v_exp_f32 v123, v123
  v_mov_b32 v240, s67
  v_mov_b32 v241, s67
  s_mov_b64 exec, s[68:69]
  buffer_store_dwordx2 v[240:241], v88, s[12:15], s66 offen sc1
  s_mov_b64 exec, -1
  v_exp_f32 v124, v124
  v_exp_f32 v125, v125
  v_cvt_pk_bf16_f32 v220, v120, v121
  v_cvt_pk_bf16_f32 v221, v122, v123
  v_cvt_pk_bf16_f32 v224, v124, v125
  v_mov_b32_dpp v222, v220 row_ror:8 row_mask:0xf bank_mask:0xf
  v_mov_b32_dpp v223, v221 row_ror:8 row_mask:0xf bank_mask:0xf
  v_mov_b32_dpp v225, v224 row_ror:8 row_mask:0xf bank_mask:0xf
  v_cvt_pk_bf16_f32 v228, v188, v189
  v_mfma_f32_16x16x32_bf16 v[200:203], v[176:179], v[220:223], 0
  v_cvt_pk_bf16_f32 v229, v190, v191
  v_cvt_pk_bf16_f32 v230, v192, v193
  v_mfma_f32_16x16x32_bf16 v[204:207], v[180:183], v[220:223], 0
  v_cvt_pk_bf16_f32 v231, v194, v195
  v_cvt_pk_bf16_f32 v232, v196, v197
  v_mfma_f32_16x16x32_bf16 v[208:211], v[184:187], v[220:223], 0
  v_cvt_pk_bf16_f32 v233, v198, v199
  v_add_f32 v126, v120, v121
  v_mfma_f32_16x16x32_bf16 v[200:203], v[228:231], v[224:227], v[200:203]
  v_add_f32 v127, v122, v123
  v_add_f32 v128, v124, v125
  v_mfma_f32_16x16x32_bf16 v[204:207], v[230:233], v[224:227], v[204:207]
  v_add_f32 v236, v126, v127
  v_fmac_f32 v236, v128, v89
  v_mfma_f32_16x16x32_bf16 v[208:211], v[232:235], v[224:227], v[208:211]
  s_nop 0
  v_add_f32_dpp v236, v236, v236 row_ror:8 row_mask:0xf bank_mask:0xf
  v_mov_b32 v237, v236
  ds_write_b128 v11, v[200:203] offset:0
  s_nop 0
  v_permlane32_swap_b32 v236, v237
  v_add_f32 v236, v236, v237
  v_mov_b32 v237, v236
  ds_write_b128 v11, v[204:207] offset:1024
  s_nop 0
  v_permlane16_swap_b32 v236, v237
  v_add_f32 v236, v236, v237
  v_rcp_f32 v236, v236
  ds_write_b128 v11, v[208:211] offset:2048
  s_mov_b64 exec, 0xff
  ds_write_b32 v242, v236
  s_mov_b64 exec, -1
  s_waitcnt lgkmcnt(0)
  s_barrier
  v_mov_b32 v28, -1
  v_mov_b32 v29, -1
  buffer_store_dwordx2 v[28:29], v24, s[8:11], s82 offen
  s_mov_b64 exec, s[60:61]
  s_add_u32 s22, s82, 278528
  buffer_store_dwordx2 v[28:29], v23, s[8:11], s22 offen
  s_and_b32 s21, s52, 7
  s_cmp_lg_u32 s21, s50
  s_cbranch_scc1 zm_81
  s_mov_b64 exec, s[70:71]
  buffer_store_dwordx4 v[156:159], v13, s[4:7], s83 offen sc1
zm_81:
  s_mov_b64 exec, -1
  v_mov_b32 v200, v196
  v_mov_b32 v201, v197
  v_mov_b32 v202, v198
  v_mov_b32 v203, v199
  v_permlane32_swap_b32 v188, v192
  v_permlane32_swap_b32 v189, v193
  v_permlane32_swap_b32 v190, v194
  v_permlane32_swap_b32 v191, v195
  v_permlane32_swap_b32 v196, v200
  v_permlane32_swap_b32 v197, v201
  v_permlane32_swap_b32 v198, v202
  v_permlane32_swap_b32 v199, v203
  v_pk_add_f32 v[188:189], v[188:189], v[192:193]
  v_pk_add_f32 v[190:191], v[190:191], v[194:195]
  v_pk_add_f32 v[196:197], v[196:197], v[200:201]
  v_pk_add_f32 v[198:199], v[198:199], v[202:203]
  v_cvt_pk_bf16_f32 v252, v188, v189
  v_cvt_pk_bf16_f32 v254, v196, v197
  v_cvt_pk_bf16_f32 v253, v190, v191
  v_cvt_pk_bf16_f32 v255, v198, v199
  s_nop 0
  v_permlane16_swap_b32 v252, v254
  v_permlane16_swap_b32 v253, v255
  v_min_u32 v252, -2, v252
  s_mov_b64 exec, s[76:77]
  buffer_store_dwordx4 v[252:255], v15, s[24:27], s57 offen sc1
  s_mov_b64 exec, -1
  s_add_u32 s64, s64, 1310720
  s_add_u32 s52, s52, 1
  s_and_b32 s21, s52, 3
  s_mul_i32 s81, s21, 540672
  s_lshl_b32 s84, s21, 15
  s_branch step_69
fl_73:
  buffer_load_dword v94, v95, s[12:15], s79 offen sc1
  s_branch fl_74
pm_71:
  s_cmp_gt_u32 s52, 3
  s_cbranch_scc1 op_82
  v_readfirstlane_b32 s21, v94
  s_cmp_ge_u32 s21, s46
  s_cbranch_scc1 op_82
  buffer_load_dword v94, v95, s[12:15], s79 offen sc1
  s_waitcnt vmcnt(0)
  v_readfirstlane_b32 s21, v94
  s_add_u32 s22, s46, 2
  s_min_u32 s22, s22, 64
  s_sub_u32 s55, s21, s22
  s_sub_u32 s56, s21, s46
  s_cmp_gt_u32 s21, s52
  s_cselect_b32 s21, s87, 0
  s_cmp_eq_u32 s21, 0
  s_cbranch_scc1 op_82
  s_mov_b32 s87, 0
  s_sub_u32 s21, s64, 1310720
  buffer_load_dwordx4 v[176:179], v16, s[28:31], s21 offen offset:0 sc1
  buffer_load_dwordx4 v[180:183], v16, s[28:31], s21 offen offset:1024 sc1
  buffer_load_dwordx4 v[184:187], v16, s[28:31], s21 offen offset:2048 sc1
op_82:
  buffer_load_dwordx4 v[32:35], v4, s[4:7], s84 offen offset:0 sc1
  buffer_load_dwordx4 v[36:39], v4, s[4:7], s84 offen offset:1024 sc1
  buffer_load_dwordx4 v[40:43], v4, s[4:7], s84 offen offset:2048 sc1
  s_add_u32 s54, s54, 1
  s_cmp_gt_u32 s54, 131072
  s_cbranch_scc1 end0
  s_waitcnt vmcnt(0)
  v_bitop3_b32 v27, v35, v39, v43 bitop3:0x80
  v_perm_b32 v35, v39, v35, s89
  v_cmp_gt_u32 vcc, 0x48000000, v27
  v_mov_b32 v39, v42
  s_cbranch_vccnz pm_71
  s_branch A1_18
pv_75:
  buffer_load_dwordx4 v[144:147], v10, s[8:11], s81 offen offset:0 sc1
  buffer_load_dwordx4 v[148:151], v10, s[8:11], s81 offen offset:1024 sc1
  buffer_load_dwordx4 v[152:155], v10, s[8:11], s81 offen offset:2048 sc1
  s_add_u32 s54, s54, 1
  s_cmp_gt_u32 s54, 131072
  s_cbranch_scc1 end0
  s_waitcnt vmcnt(0)
  v_max3_u32 v27, v144, v146, v148
  v_max3_u32 v27, v27, v150, v152
  v_max3_u32 v27, v27, v154, v154
  v_cmp_eq_u32 vcc, -1, v27
  s_nop 1
  s_cbranch_vccnz pv_75
  s_branch pvj_78
psr_76:
  buffer_load_dwordx2 v[248:249], v9, s[8:11], s81 offen sc1
  buffer_load_dwordx4 v[112:115], v8, s[8:11], s81 offen offset:0 sc1
  buffer_load_dwordx4 v[116:119], v8, s[8:11], s81 offen offset:1024 sc1
  s_add_u32 s54, s54, 1
  s_cmp_gt_u32 s54, 131072
  s_cbranch_scc1 end0
  s_waitcnt vmcnt(2)
  v_xor_b32 v96, s88, v248
  s_nop 0
  v_permlane16_swap_b32 v248, v249
  v_fma_mix_f32 v250, v248, 1.0, v249 op_sel:[0,0,0] op_sel_hi:[1,0,1]
  v_fma_mix_f32 v251, v248, 1.0, v249 op_sel:[1,0,1] op_sel_hi:[1,0,1]
  v_mov_b32 v248, v250
  v_mov_b32 v249, v251
  s_nop 0
  v_permlane32_swap_b32 v248, v250
  v_permlane32_swap_b32 v249, v251
  v_pk_add_f32 v[124:125], v[248:249], v[250:251]
  v_max_f32 v238, v124, v125
  s_waitcnt vmcnt(0)
  v_pk_add_f16 v100, v112, v116
  v_pk_add_f16 v102, v114, v118
  v_pk_add_f16 v101, v113, v117
  v_pk_add_f16 v103, v115, v119
  v_permlane32_swap_b32 v100, v102
  v_bitop3_b32 v97, v112, v114, s88 bitop3:0x7e
  v_permlane32_swap_b32 v101, v103
  v_bitop3_b32 v98, v116, v118, s88 bitop3:0x7e
  v_fma_mix_f32 v120, v100, 1.0, v102 op_sel:[0,0,0] op_sel_hi:[1,0,1]
  v_or3_b32 v27, v96, v97, v98
  v_fma_mix_f32 v121, v100, 1.0, v102 op_sel:[1,0,1] op_sel_hi:[1,0,1]
  v_and_b32 v27, 1, v27
  v_fma_mix_f32 v122, v101, 1.0, v103 op_sel:[0,0,0] op_sel_hi:[1,0,1]
  v_cmp_ne_u32 vcc, 0, v27
  v_fma_mix_f32 v123, v101, 1.0, v103 op_sel:[1,0,1] op_sel_hi:[1,0,1]
  v_max3_f32 v236, v120, v121, v238
  s_cbranch_vccnz psr_76
  s_branch psj_77
kvw_79:
  s_mov_b32 s22, s87
  s_cmp_eq_u32 s52, 0
  s_cselect_b32 s23, s87, s46
  s_cselect_b32 s55, 0, s55
  s_cselect_b32 s87, 1, 0
  s_cmp_eq_u32 s23, 0
  s_cbranch_scc1 kvok_80
  v_mov_b32 v236, 0
  s_mov_b32 s101, 0
wf_83:
  buffer_load_dword v237, v236, s[12:15], s79 offen sc1
  s_add_u32 s101, s101, 1
  s_cmp_gt_u32 s101, 131072
  s_cbranch_scc1 end0
  s_waitcnt vmcnt(0)
  v_readfirstlane_b32 s100, v237
  s_cmp_ge_u32 s100, s23
  s_cbranch_scc1 wf_84
  s_sleep 3
  s_branch wf_83
wf_84:
  s_cmp_eq_u32 s22, 0
  s_cbranch_scc1 kvok_80
  s_sub_u32 s21, s64, 1310720
  buffer_load_dwordx4 v[176:179], v16, s[28:31], s21 offen offset:0 sc1
  buffer_load_dwordx4 v[180:183], v16, s[28:31], s21 offen offset:1024 sc1
  buffer_load_dwordx4 v[184:187], v16, s[28:31], s21 offen offset:2048 sc1
  s_waitcnt vmcnt(0)
  s_branch kvok_80
last_70:
  v_mov_b32 v188, 0
  v_mov_b32 v189, 0
  v_mov_b32 v190, 0
  v_mov_b32 v191, 0
  v_mov_b32 v192, 0
  v_mov_b32 v193, 0
  v_mov_b32 v194, 0
  v_mov_b32 v195, 0
  v_mov_b32 v196, 0
  v_mov_b32 v197, 0
  v_mov_b32 v198, 0
  v_mov_b32 v199, 0
  s_sleep 4
  s_mov_b32 s54, 0
lv_85:
  buffer_load_dwordx4 v[144:147], v10, s[8:11], s81 offen offset:0 sc1
  buffer_load_dwordx4 v[148:151], v10, s[8:11], s81 offen offset:1024 sc1
  buffer_load_dwordx4 v[152:155], v10, s[8:11], s81 offen offset:2048 sc1
  s_add_u32 s54, s54, 1
  s_cmp_gt_u32 s54, 131072
  s_cbranch_scc1 end0
  s_waitcnt vmcnt(0)
  v_max3_u32 v27, v144, v146, v148
  v_max3_u32 v27, v27, v150, v152
  v_max3_u32 v27, v27, v154, v154
  v_cmp_eq_u32 vcc, -1, v27
  s_nop 1
  s_cbranch_vccnz lv_85
  v_smfmac_f32_16x16x64_bf16 v[188:191], v[144:147], a[180:187], v44
  v_smfmac_f32_16x16x64_bf16 v[192:195], v[144:147], a[204:211], v44
  v_smfmac_f32_16x16x64_bf16 v[196:199], v[144:147], a[228:235], v44
  v_smfmac_f32_16x16x64_bf16 v[188:191], v[148:151], a[188:195], v44
  v_smfmac_f32_16x16x64_bf16 v[192:195], v[148:151], a[212:219], v44
  v_smfmac_f32_16x16x64_bf16 v[196:199], v[148:151], a[236:243], v44
  v_smfmac_f32_16x16x64_bf16 v[188:191], v[152:155], a[196:203], v44
  v_smfmac_f32_16x16x64_bf16 v[192:195], v[152:155], a[220:227], v44
  v_smfmac_f32_16x16x64_bf16 v[196:199], v[152:155], a[244:251], v44
  s_nop 7
  v_mov_b32 v200, v196
  v_mov_b32 v201, v197
  v_mov_b32 v202, v198
  v_mov_b32 v203, v199
  v_permlane32_swap_b32 v188, v192
  v_permlane32_swap_b32 v189, v193
  v_permlane32_swap_b32 v190, v194
  v_permlane32_swap_b32 v191, v195
  v_permlane32_swap_b32 v196, v200
  v_permlane32_swap_b32 v197, v201
  v_permlane32_swap_b32 v198, v202
  v_permlane32_swap_b32 v199, v203
  v_pk_add_f32 v[188:189], v[188:189], v[192:193]
  v_pk_add_f32 v[190:191], v[190:191], v[194:195]
  v_pk_add_f32 v[196:197], v[196:197], v[200:201]
  v_pk_add_f32 v[198:199], v[198:199], v[202:203]
  v_cvt_pk_bf16_f32 v252, v188, v189
  v_cvt_pk_bf16_f32 v254, v196, v197
  v_cvt_pk_bf16_f32 v253, v190, v191
  v_cvt_pk_bf16_f32 v255, v198, v199
  s_nop 0
  v_permlane16_swap_b32 v252, v254
  v_permlane16_swap_b32 v253, v255
  v_min_u32 v252, -2, v252
  s_mov_b64 exec, s[76:77]
  buffer_store_dwordx4 v[252:255], v15, s[24:27], s57 offen sc1
  s_mov_b64 exec, -1
  s_branch chain_done
step_86:
  s_add_u32 s21, s52, 2
  s_and_b32 s21, s21, 3
  s_mul_i32 s82, s21, 540672
  s_add_u32 s21, s52, 3
  s_and_b32 s21, s21, 3
  s_lshl_b32 s83, s21, 15
  s_add_u32 s21, s52, 1
  s_and_b32 s22, s21, 3
  s_lshl_b32 s3, s22, 15
  s_mul_i32 s80, s21, 393216
  s_add_u32 s46, s21, 1
  s_min_u32 s46, s46, 64
  s_mul_i32 s85, s52, 98304
  s_mul_i32 s57, s52, 327680
  s_add_u32 s57, s57, 42991616

  s_bfe_u32 s88, s52, 0x10002
  s_add_u32 s78, s81, 278528
  s_max_u32 s21, s52, 1
  s_sub_u32 s21, s21, 1
  s_cmp_lt_u32 s52, 98
  s_cselect_b32 s66, s65, 0x80000000
  s_cselect_b32 s68, 15, 1
  s_cmp_ge_u32 s52, 99
  s_cselect_b32 s66, s90, s66
  s_cselect_b32 s67, s52, s21
  v_mov_b32 v52, 0
  v_mov_b32 v53, 0
  v_mov_b32 v54, 0
  v_mov_b32 v55, 0
  v_mov_b32 v56, 0
  v_mov_b32 v57, 0
  v_mov_b32 v58, 0
  v_mov_b32 v59, 0
  v_mov_b32 v60, 0
  v_mov_b32 v61, 0
  v_mov_b32 v62, 0
  v_mov_b32 v63, 0
  v_mov_b32 v64, 0
  v_mov_b32 v65, 0
  v_mov_b32 v66, 0
  v_mov_b32 v67, 0
  v_mov_b32 v68, 0
  v_mov_b32 v69, 0
  v_mov_b32 v70, 0
  v_mov_b32 v71, 0
  v_mov_b32 v72, 0
  v_mov_b32 v73, 0
  v_mov_b32 v74, 0
  v_mov_b32 v75, 0
  v_mov_b32 v76, 0
  v_mov_b32 v77, 0
  v_mov_b32 v78, 0
  v_mov_b32 v79, 0
  v_mov_b32 v80, 0
  v_mov_b32 v81, 0
  v_mov_b32 v82, 0
  v_mov_b32 v83, 0
  v_mov_b32 v84, 0
  v_mov_b32 v85, 0
  v_mov_b32 v86, 0
  v_mov_b32 v87, 0
  s_sleep 8
  s_cmp_lt_i32 s55, 0
  s_cbranch_scc1 fl_90
fl_91:
  s_mov_b32 s54, 0
  buffer_load_dwordx4 v[32:35], v4, s[4:7], s84 offen offset:0 sc1
  buffer_load_dwordx4 v[36:39], v4, s[4:7], s84 offen offset:1024 sc1
  buffer_load_dwordx4 v[40:43], v4, s[4:7], s84 offen offset:2048 sc1
  s_waitcnt vmcnt(3)
  v_mov_b32 v176, v160
  v_mov_b32 v177, v161
  v_mov_b32 v178, v162
  v_mov_b32 v179, v163
  v_mov_b32 v180, v164
  v_mov_b32 v181, v165
  v_mov_b32 v182, v166
  v_mov_b32 v183, v167
  v_mov_b32 v184, v48
  v_mov_b32 v185, v49
  v_mov_b32 v186, v50
  v_mov_b32 v187, v51
  s_waitcnt vmcnt(0)
  v_bitop3_b32 v27, v35, v39, v43 bitop3:0x80
  v_perm_b32 v35, v39, v35, s89
  v_cmp_gt_u32 vcc, 0x48000000, v27
  v_mov_b32 v39, v42
  s_cbranch_vccnz pm_88
A1_19:
  v_smfmac_f32_16x16x32_f16 v[52:55], v[40:41], a[16:19], v44
  v_smfmac_f32_16x16x32_f16 v[64:67], v[40:41], a[76:79], v44
  v_smfmac_f32_16x16x32_f16 v[56:59], v[40:41], a[36:39], v44
  v_smfmac_f32_16x16x32_f16 v[68:71], v[40:41], a[96:99], v44
  v_smfmac_f32_16x16x64_f16 v[52:55], v[32:35], a[0:7], v44
  v_smfmac_f32_16x16x64_f16 v[52:55], v[36:39], a[8:15], v44
  v_smfmac_f32_16x16x64_f16 v[64:67], v[32:35], a[60:67], v44
  v_smfmac_f32_16x16x64_f16 v[64:67], v[36:39], a[68:75], v44
  v_smfmac_f32_16x16x32_f16 v[60:63], v[40:41], a[56:59], v44
  v_cvt_pk_f16_f32 v52, v52, v53
  v_cvt_pk_f16_f32 v53, v54, v55
  v_smfmac_f32_16x16x32_f16 v[72:75], v[40:41], a[116:119], v44
  v_smfmac_f32_16x16x32_f16 v[76:79], v[40:41], a[136:139], v44
  v_cvt_pk_f16_f32 v64, v64, v65
  v_cvt_pk_f16_f32 v65, v66, v67
  s_nop 0
  v_smfmac_f32_16x16x64_f16 v[56:59], v[32:35], a[20:27], v44
  v_permlane32_swap_b32 v52, v64
  v_smfmac_f32_16x16x64_f16 v[56:59], v[36:39], a[28:35], v44
  v_permlane32_swap_b32 v53, v65
  v_pk_add_f16 v52, v52, v64
  v_smfmac_f32_16x16x64_f16 v[68:71], v[32:35], a[80:87], v44
  v_pk_add_f16 v53, v53, v65
  v_smfmac_f32_16x16x64_f16 v[68:71], v[36:39], a[88:95], v44
  ds_write_b64 v5, v[52:53] offset:0
  v_smfmac_f32_16x16x32_f16 v[80:83], v[40:41], a[156:159], v44
  v_cvt_pk_f16_f32 v56, v56, v57
  v_cvt_pk_f16_f32 v57, v58, v59
  v_smfmac_f32_16x16x32_f16 v[84:87], v[40:41], a[176:179], v44
  v_cvt_pk_f16_f32 v68, v68, v69
  v_cvt_pk_f16_f32 v69, v70, v71
  s_nop 0
  v_smfmac_f32_16x16x64_f16 v[60:63], v[32:35], a[40:47], v44
  v_permlane32_swap_b32 v56, v68
  v_smfmac_f32_16x16x64_f16 v[60:63], v[36:39], a[48:55], v44
  v_permlane32_swap_b32 v57, v69
  v_pk_add_f16 v56, v56, v68
  v_smfmac_f32_16x16x64_f16 v[72:75], v[32:35], a[100:107], v44
  v_pk_add_f16 v57, v57, v69
  v_smfmac_f32_16x16x64_f16 v[72:75], v[36:39], a[108:115], v44
  ds_write_b64 v5, v[56:57] offset:640
  v_smfmac_f32_16x16x64_f16 v[76:79], v[32:35], a[120:127], v44
  v_cvt_pk_f16_f32 v60, v60, v61
  v_cvt_pk_f16_f32 v61, v62, v63
  v_smfmac_f32_16x16x64_f16 v[76:79], v[36:39], a[128:135], v44
  v_cvt_pk_f16_f32 v72, v72, v73
  v_cvt_pk_f16_f32 v73, v74, v75
  s_nop 0
  v_smfmac_f32_16x16x64_f16 v[80:83], v[32:35], a[140:147], v44
  v_permlane32_swap_b32 v60, v72
  v_smfmac_f32_16x16x64_f16 v[80:83], v[36:39], a[148:155], v44
  v_permlane32_swap_b32 v61, v73
  v_pk_add_f16 v60, v60, v72
  v_smfmac_f32_16x16x64_f16 v[84:87], v[32:35], a[160:167], v44
  v_pk_add_f16 v61, v61, v73
  v_smfmac_f32_16x16x64_f16 v[84:87], v[36:39], a[168:175], v44
  ds_write_b64 v5, v[60:61] offset:1280
  v_cvt_pk_f16_f32 v76, v76, v77
  v_cvt_pk_f16_f32 v77, v78, v79
  v_cvt_pk_f16_f32 v80, v80, v81
  v_cvt_pk_f16_f32 v81, v82, v83
  s_nop 0
  v_permlane32_swap_b32 v76, v80
  v_permlane32_swap_b32 v77, v81
  v_pk_add_f16 v76, v76, v80
  v_pk_add_f16 v77, v77, v81
  ds_write_b64 v5, v[76:77] offset:1920
  v_cvt_pk_f16_f32 v84, v84, v85
  v_cvt_pk_f16_f32 v85, v86, v87
  ds_write_b64 v5, v[84:85] offset:2560
  s_waitcnt lgkmcnt(0) vmcnt(0)
  s_barrier
  s_lshr_b32 s21, 3, s20
  s_bitcmp1_b32 s21, 0
  s_cbranch_scc0 bw_93
  ds_read_b64_tr_b16 v[104:105], v45 offset:0
  ds_read_b64_tr_b16 v[106:107], v45 offset:3200
  ds_read_b64_tr_b16 v[108:109], v45 offset:640
  ds_read_b64_tr_b16 v[110:111], v45 offset:3840
  ds_read_b64_tr_b16 v[112:113], v45 offset:1280
  ds_read_b64_tr_b16 v[114:115], v45 offset:4480
  s_waitcnt lgkmcnt(4)
  v_fma_mix_f32 v120, v104, 1.0, v106 op_sel:[0,0,0] op_sel_hi:[1,0,1]
  v_fma_mix_f32 v121, v104, 1.0, v106 op_sel:[1,0,1] op_sel_hi:[1,0,1]
  v_fma_mix_f32 v122, v105, 1.0, v107 op_sel:[0,0,0] op_sel_hi:[1,0,1]
  v_fma_mix_f32 v123, v105, 1.0, v107 op_sel:[1,0,1] op_sel_hi:[1,0,1]
  v_add_f32_dpp v124, v120, v120 row_ror:8 row_mask:0xf bank_mask:0xf
  v_add_f32_dpp v125, v121, v121 row_ror:8 row_mask:0xf bank_mask:0xf
  v_add_f32_dpp v126, v122, v122 row_ror:8 row_mask:0xf bank_mask:0xf
  v_add_f32_dpp v127, v123, v123 row_ror:8 row_mask:0xf bank_mask:0xf
  v_cvt_pk_bf16_f32 v212, v124, v125
  v_cvt_pk_bf16_f32 v213, v126, v127
  s_waitcnt lgkmcnt(2)
  v_fma_mix_f32 v120, v108, 1.0, v110 op_sel:[0,0,0] op_sel_hi:[1,0,1]
  v_fma_mix_f32 v121, v108, 1.0, v110 op_sel:[1,0,1] op_sel_hi:[1,0,1]
  v_fma_mix_f32 v122, v109, 1.0, v111 op_sel:[0,0,0] op_sel_hi:[1,0,1]
  v_fma_mix_f32 v123, v109, 1.0, v111 op_sel:[1,0,1] op_sel_hi:[1,0,1]
  v_add_f32_dpp v124, v120, v120 row_ror:8 row_mask:0xf bank_mask:0xf
  v_add_f32_dpp v125, v121, v121 row_ror:8 row_mask:0xf bank_mask:0xf
  v_add_f32_dpp v126, v122, v122 row_ror:8 row_mask:0xf bank_mask:0xf
  v_add_f32_dpp v127, v123, v123 row_ror:8 row_mask:0xf bank_mask:0xf
  v_cvt_pk_bf16_f32 v214, v124, v125
  v_cvt_pk_bf16_f32 v215, v126, v127
  s_waitcnt lgkmcnt(0)
  v_fma_mix_f32 v120, v112, 1.0, v114 op_sel:[0,0,0] op_sel_hi:[1,0,1]
  v_fma_mix_f32 v121, v112, 1.0, v114 op_sel:[1,0,1] op_sel_hi:[1,0,1]
  v_fma_mix_f32 v122, v113, 1.0, v115 op_sel:[0,0,0] op_sel_hi:[1,0,1]
  v_fma_mix_f32 v123, v113, 1.0, v115 op_sel:[1,0,1] op_sel_hi:[1,0,1]
  v_mfma_f32_16x16x32_bf16 v[96:99], v[168:171], v[212:215], 0
  v_add_f32_dpp v124, v120, v120 row_ror:8 row_mask:0xf bank_mask:0xf
  v_add_f32_dpp v125, v121, v121 row_ror:8 row_mask:0xf bank_mask:0xf
  v_add_f32_dpp v126, v122, v122 row_ror:8 row_mask:0xf bank_mask:0xf
  v_add_f32_dpp v127, v123, v123 row_ror:8 row_mask:0xf bank_mask:0xf
  v_cvt_pk_bf16_f32 v216, v124, v125
  v_cvt_pk_bf16_f32 v217, v126, v127
  s_nop 1
  v_mfma_f32_16x16x32_bf16 v[96:99], v[172:175], v[216:219], v[96:99]
  s_mov_b64 exec, s[74:75]
  s_nop 6
  v_cvt_pk_f16_f32 v100, v96, v97
  v_cvt_pk_f16_f32 v101, v98, v99
  v_and_or_b32 v100, v100, -2, s88
  s_cmp_eq_u32 s53, 1
  s_cbranch_scc1 si_94
  buffer_store_dwordx2 v[100:101], v7, s[8:11], s81 offen sc1
  s_branch si_95
si_94:
  buffer_store_dwordx2 v[100:101], v7, s[8:11], s81 offen
si_95:
  s_mov_b64 exec, -1
  s_branch bw_92
bw_93:
  s_lshr_b32 s21, 4, s20
  s_bitcmp1_b32 s21, 0
  s_cbranch_scc0 bw_96
  ds_read_b64_tr_b16 v[104:105], v6 offset:0
  ds_read_b64_tr_b16 v[106:107], v6 offset:3200
  ds_read_b64_tr_b16 v[108:109], v6 offset:6400
  ds_read_b64_tr_b16 v[110:111], v6 offset:9600
  ds_read_b64_tr_b16 v[112:113], v6 offset:640
  ds_read_b64_tr_b16 v[114:115], v6 offset:3840
  ds_read_b64_tr_b16 v[116:117], v6 offset:7040
  ds_read_b64_tr_b16 v[118:119], v6 offset:10240
  ds_read_b64_tr_b16 v[120:121], v6 offset:1280
  ds_read_b64_tr_b16 v[122:123], v6 offset:4480
  ds_read_b64_tr_b16 v[124:125], v6 offset:7680
  ds_read_b64_tr_b16 v[126:127], v6 offset:10880
  s_waitcnt lgkmcnt(8)
  v_pk_add_f16 v104, v104, v106
  v_pk_add_f16 v108, v108, v110
  v_pk_add_f16 v105, v105, v107
  v_pk_add_f16 v109, v109, v111
  v_fma_mix_f32 v128, v104, 1.0, v108 op_sel:[0,0,0] op_sel_hi:[1,0,1]
  v_fma_mix_f32 v129, v104, 1.0, v108 op_sel:[1,0,1] op_sel_hi:[1,0,1]
  v_fma_mix_f32 v130, v105, 1.0, v109 op_sel:[0,0,0] op_sel_hi:[1,0,1]
  v_fma_mix_f32 v131, v105, 1.0, v109 op_sel:[1,0,1] op_sel_hi:[1,0,1]
  v_cvt_pk_bf16_f32 v212, v128, v129
  v_cvt_pk_bf16_f32 v213, v130, v131
  s_waitcnt lgkmcnt(4)
  v_pk_add_f16 v112, v112, v114
  v_pk_add_f16 v116, v116, v118
  v_pk_add_f16 v113, v113, v115
  v_pk_add_f16 v117, v117, v119
  v_fma_mix_f32 v128, v112, 1.0, v116 op_sel:[0,0,0] op_sel_hi:[1,0,1]
  v_fma_mix_f32 v129, v112, 1.0, v116 op_sel:[1,0,1] op_sel_hi:[1,0,1]
  v_fma_mix_f32 v130, v113, 1.0, v117 op_sel:[0,0,0] op_sel_hi:[1,0,1]
  v_fma_mix_f32 v131, v113, 1.0, v117 op_sel:[1,0,1] op_sel_hi:[1,0,1]
  v_cvt_pk_bf16_f32 v214, v128, v129
  v_cvt_pk_bf16_f32 v215, v130, v131
  s_waitcnt lgkmcnt(0)
  v_pk_add_f16 v120, v120, v122
  v_pk_add_f16 v124, v124, v126
  v_pk_add_f16 v121, v121, v123
  v_pk_add_f16 v125, v125, v127
  v_fma_mix_f32 v128, v120, 1.0, v124 op_sel:[0,0,0] op_sel_hi:[1,0,1]
  v_fma_mix_f32 v129, v120, 1.0, v124 op_sel:[1,0,1] op_sel_hi:[1,0,1]
  v_mfma_f32_16x16x32_bf16 v[96:99], v[212:215], v[212:215], 0
  v_fma_mix_f32 v130, v121, 1.0, v125 op_sel:[0,0,0] op_sel_hi:[1,0,1]
  v_fma_mix_f32 v131, v121, 1.0, v125 op_sel:[1,0,1] op_sel_hi:[1,0,1]
  v_cvt_pk_bf16_f32 v216, v128, v129
  v_cvt_pk_bf16_f32 v217, v130, v131
  s_nop 1
  v_mfma_f32_16x16x32_bf16 v[96:99], v[216:219], v[216:219], v[96:99]
  s_mov_b64 exec, s[74:75]
  s_nop 6
  v_cvt_pk_f16_f32 v100, v96, v97
  v_cvt_pk_f16_f32 v101, v98, v99
  v_and_or_b32 v100, v100, -2, s88
  s_cmp_eq_u32 s53, 1
  s_cbranch_scc1 si_97
  buffer_store_dwordx2 v[100:101], v7, s[8:11], s81 offen sc1
  s_branch si_98
si_97:
  buffer_store_dwordx2 v[100:101], v7, s[8:11], s81 offen
si_98:
  s_mov_b64 exec, -1
  s_branch bw_92
bw_96:
  s_lshr_b32 s21, 8, s20
  s_bitcmp1_b32 s21, 0
  s_cbranch_scc0 bw_99
  ds_read_b64_tr_b16 v[96:97], v6 offset:1920
  ds_read_b64_tr_b16 v[98:99], v6 offset:5120
  ds_read_b64_tr_b16 v[100:101], v6 offset:8320
  ds_read_b64_tr_b16 v[102:103], v6 offset:11520
  ds_read_b64_tr_b16 v[104:105], v6 offset:2560
  ds_read_b64_tr_b16 v[106:107], v6 offset:5760
  ds_read_b64_tr_b16 v[108:109], v6 offset:8960
  ds_read_b64_tr_b16 v[110:111], v6 offset:12160
  s_waitcnt lgkmcnt(4)
  v_pk_add_f16 v96, v96, v98
  v_pk_add_f16 v100, v100, v102
  v_pk_add_f16 v97, v97, v99
  v_pk_add_f16 v101, v101, v103
  v_fma_mix_f32 v112, v96, 1.0, v100 op_sel:[0,0,0] op_sel_hi:[1,0,1]
  v_fma_mix_f32 v113, v96, 1.0, v100 op_sel:[1,0,1] op_sel_hi:[1,0,1]
  v_fma_mix_f32 v114, v97, 1.0, v101 op_sel:[0,0,0] op_sel_hi:[1,0,1]
  v_fma_mix_f32 v115, v97, 1.0, v101 op_sel:[1,0,1] op_sel_hi:[1,0,1]
  v_cvt_pk_bf16_f32 v90, v112, v113
  v_cvt_pk_bf16_f32 v91, v114, v115
  v_min_u32 v90, -2, v90
  s_cmp_eq_u32 s53, 1
  s_cbranch_scc1 si_100
  buffer_store_dwordx2 v[90:91], v24, s[8:11], s81 offen sc1
  s_branch si_101
si_100:
  buffer_store_dwordx2 v[90:91], v24, s[8:11], s81 offen
si_101:
  s_waitcnt lgkmcnt(0)
  v_pk_add_f16 v104, v104, v106
  v_pk_add_f16 v108, v108, v110
  v_pk_add_f16 v105, v105, v107
  v_pk_add_f16 v109, v109, v111
  v_fma_mix_f32 v112, v104, 1.0, v108 op_sel:[0,0,0] op_sel_hi:[1,0,1]
  v_fma_mix_f32 v113, v104, 1.0, v108 op_sel:[1,0,1] op_sel_hi:[1,0,1]
  v_fma_mix_f32 v114, v105, 1.0, v109 op_sel:[0,0,0] op_sel_hi:[1,0,1]
  v_fma_mix_f32 v115, v105, 1.0, v109 op_sel:[1,0,1] op_sel_hi:[1,0,1]
  v_add_f32_dpp v116, v112, v112 row_ror:8 row_mask:0xf bank_mask:0xf
  v_add_f32_dpp v117, v113, v113 row_ror:8 row_mask:0xf bank_mask:0xf
  v_add_f32_dpp v118, v114, v114 row_ror:8 row_mask:0xf bank_mask:0xf
  v_add_f32_dpp v119, v115, v115 row_ror:8 row_mask:0xf bank_mask:0xf
  v_cvt_pk_bf16_f32 v92, v116, v117
  v_cvt_pk_bf16_f32 v93, v118, v119
  v_min_u32 v92, -2, v92
  s_mov_b64 exec, s[60:61]
  s_cmp_eq_u32 s53, 1
  s_cbranch_scc1 si_102
  buffer_store_dwordx2 v[92:93], v23, s[8:11], s78 offen sc1
  s_branch si_103
si_102:
  buffer_store_dwordx2 v[92:93], v23, s[8:11], s78 offen
si_103:
  s_mov_b64 exec, -1
  s_branch bw_92
bw_99:
bw_92:
  s_cmp_eq_u32 s52, 63
  s_cbranch_scc1 last_87
  s_mov_b32 s54, 0
pv_104:
  buffer_load_dwordx4 v[144:147], v10, s[8:11], s81 offen offset:0 sc1
  buffer_load_dwordx4 v[148:151], v10, s[8:11], s81 offen offset:1024 sc1
  buffer_load_dwordx4 v[152:155], v10, s[8:11], s81 offen offset:2048 sc1
  v_mov_b32 v188, 0
  v_mov_b32 v189, 0
  v_mov_b32 v190, 0
  v_mov_b32 v191, 0
  v_mov_b32 v192, 0
  v_mov_b32 v193, 0
  v_mov_b32 v194, 0
  v_mov_b32 v195, 0
  v_mov_b32 v196, 0
  v_mov_b32 v197, 0
  v_mov_b32 v198, 0
  v_mov_b32 v199, 0
  s_add_u32 s54, s54, 1
  s_cmp_gt_u32 s54, 131072
  s_cbranch_scc1 end0
  s_waitcnt vmcnt(0)
  v_max3_u32 v27, v144, v146, v148
  v_max3_u32 v27, v27, v150, v152
  v_max3_u32 v27, v27, v154, v154
  v_cmp_eq_u32 vcc, -1, v27
  s_nop 1
  s_cbranch_vccnz pv_104
  buffer_load_dwordx2 v[248:249], v9, s[8:11], s81 offen sc1
  buffer_load_dwordx4 v[112:115], v8, s[8:11], s81 offen offset:0 sc1
  buffer_load_dwordx4 v[116:119], v8, s[8:11], s81 offen offset:1024 sc1
  v_smfmac_f32_16x16x64_bf16 v[188:191], v[144:147], a[180:187], v44
  v_smfmac_f32_16x16x64_bf16 v[192:195], v[144:147], a[204:211], v44
  v_smfmac_f32_16x16x64_bf16 v[196:199], v[144:147], a[228:235], v44
  v_smfmac_f32_16x16x64_bf16 v[188:191], v[148:151], a[188:195], v44
  v_smfmac_f32_16x16x64_bf16 v[192:195], v[148:151], a[212:219], v44
  v_smfmac_f32_16x16x64_bf16 v[196:199], v[148:151], a[236:243], v44
  v_smfmac_f32_16x16x64_bf16 v[188:191], v[152:155], a[196:203], v44
  v_smfmac_f32_16x16x64_bf16 v[192:195], v[152:155], a[220:227], v44
  v_smfmac_f32_16x16x64_bf16 v[196:199], v[152:155], a[244:251], v44
  v_readfirstlane_b32 s21, v94
  s_add_u32 s22, s46, 2
  s_min_u32 s22, s22, 64
  s_sub_u32 s55, s21, s22
  s_sub_u32 s56, s21, s46
  s_cmp_lt_i32 s56, 0
  s_cbranch_scc1 kvw_107
kvok_108:
  s_waitcnt vmcnt(2)
  v_xor_b32 v96, s88, v248
  s_nop 0
  v_permlane16_swap_b32 v248, v249
  v_fma_mix_f32 v250, v248, 1.0, v249 op_sel:[0,0,0] op_sel_hi:[1,0,1]
  v_fma_mix_f32 v251, v248, 1.0, v249 op_sel:[1,0,1] op_sel_hi:[1,0,1]
  v_mov_b32 v248, v250
  v_mov_b32 v249, v251
  s_nop 0
  v_permlane32_swap_b32 v248, v250
  v_permlane32_swap_b32 v249, v251
  v_pk_add_f32 v[124:125], v[248:249], v[250:251]
  v_max_f32 v238, v124, v125
  s_waitcnt vmcnt(0)
  v_pk_add_f16 v100, v112, v116
  v_pk_add_f16 v102, v114, v118
  v_pk_add_f16 v101, v113, v117
  v_pk_add_f16 v103, v115, v119
  v_permlane32_swap_b32 v100, v102
  v_bitop3_b32 v97, v112, v114, s88 bitop3:0x7e
  v_permlane32_swap_b32 v101, v103
  v_bitop3_b32 v98, v116, v118, s88 bitop3:0x7e
  v_fma_mix_f32 v120, v100, 1.0, v102 op_sel:[0,0,0] op_sel_hi:[1,0,1]
  v_or3_b32 v27, v96, v97, v98
  v_fma_mix_f32 v121, v100, 1.0, v102 op_sel:[1,0,1] op_sel_hi:[1,0,1]
  v_and_b32 v27, 1, v27
  v_fma_mix_f32 v122, v101, 1.0, v103 op_sel:[0,0,0] op_sel_hi:[1,0,1]
  v_cmp_ne_u32 vcc, 0, v27
  v_fma_mix_f32 v123, v101, 1.0, v103 op_sel:[1,0,1] op_sel_hi:[1,0,1]
  v_max3_f32 v236, v120, v121, v238
  s_cbranch_vccnz psr_105
psj_106:
  v_max3_f32 v236, v236, v122, v123
  s_nop 1
  v_max_f32_dpp v236, v236, v236 row_ror:8 row_mask:0xf bank_mask:0xf
  v_mov_b32 v237, v236
  s_nop 1
  v_permlane32_swap_b32 v236, v237
  v_max_f32 v236, v236, v237
  v_mov_b32 v237, v236
  s_nop 1
  v_permlane16_swap_b32 v236, v237
  v_max_f32 v236, v236, v237
  v_mul_f32 v236, s86, v236
  v_fma_f32 v120, v120, s86, -v236
  v_fma_f32 v121, v121, s86, -v236
  buffer_load_dwordx4 v[160:163], v17, s[28:31], s64 offen offset:0 sc1
  v_fma_f32 v122, v122, s86, -v236
  v_fma_f32 v123, v123, s86, -v236
  buffer_load_dwordx4 v[164:167], v16, s[28:31], s64 offen offset:1024 sc1
  v_fma_f32 v124, v124, s86, -v236
  v_fma_f32 v125, v125, s86, -v236
  buffer_load_dwordx4 v[48:51], v26, s[28:31], s64 offen offset:2048 sc1
  v_exp_f32 v120, v120
  v_exp_f32 v121, v121
  s_lshr_b32 s21, 3, s20
  s_bitcmp1_b32 s21, 0
  s_cbranch_scc0 bw_110
  buffer_load_dwordx4 v[168:171], v18, s[16:19], s80 offen sc1
  s_branch bw_109
bw_110:
  s_lshr_b32 s21, 4, s20
  s_bitcmp1_b32 s21, 0
  s_cbranch_scc0 bw_111
  s_branch bw_109
bw_111:
  s_lshr_b32 s21, 8, s20
  s_bitcmp1_b32 s21, 0
  s_cbranch_scc0 bw_112
  s_branch bw_109
bw_112:
bw_109:
  v_exp_f32 v122, v122
  s_lshr_b32 s21, 3, s20
  s_bitcmp1_b32 s21, 0
  s_cbranch_scc0 bw_114
  buffer_load_dwordx2 v[172:173], v20, s[16:19], s80 offen sc1
  s_branch bw_113
bw_114:
  s_lshr_b32 s21, 4, s20
  s_bitcmp1_b32 s21, 0
  s_cbranch_scc0 bw_115
  s_branch bw_113
bw_115:
  s_lshr_b32 s21, 8, s20
  s_bitcmp1_b32 s21, 0
  s_cbranch_scc0 bw_116
  s_branch bw_113
bw_116:
bw_113:
  v_exp_f32 v123, v123
  s_lshr_b32 s21, 3, s20
  s_bitcmp1_b32 s21, 0
  s_cbranch_scc0 bw_118
  s_branch bw_117
bw_118:
  s_lshr_b32 s21, 4, s20
  s_bitcmp1_b32 s21, 0
  s_cbranch_scc0 bw_119
  s_branch bw_117
bw_119:
  s_lshr_b32 s21, 8, s20
  s_bitcmp1_b32 s21, 0
  s_cbranch_scc0 bw_120
  v_mov_b32 v240, s67
  v_mov_b32 v241, s67
  s_mov_b64 exec, s[68:69]
  buffer_store_dwordx2 v[240:241], v88, s[12:15], s66 offen sc1
  s_mov_b64 exec, -1
  s_branch bw_117
bw_120:
bw_117:
  v_exp_f32 v124, v124
  v_exp_f32 v125, v125
  v_cvt_pk_bf16_f32 v220, v120, v121
  v_cvt_pk_bf16_f32 v221, v122, v123
  v_cvt_pk_bf16_f32 v224, v124, v125
  v_mov_b32_dpp v222, v220 row_ror:8 row_mask:0xf bank_mask:0xf
  v_mov_b32_dpp v223, v221 row_ror:8 row_mask:0xf bank_mask:0xf
  v_mov_b32_dpp v225, v224 row_ror:8 row_mask:0xf bank_mask:0xf
  v_cvt_pk_bf16_f32 v228, v188, v189
  v_mfma_f32_16x16x32_bf16 v[200:203], v[176:179], v[220:223], 0
  v_cvt_pk_bf16_f32 v229, v190, v191
  v_cvt_pk_bf16_f32 v230, v192, v193
  v_mfma_f32_16x16x32_bf16 v[204:207], v[180:183], v[220:223], 0
  v_cvt_pk_bf16_f32 v231, v194, v195
  v_cvt_pk_bf16_f32 v232, v196, v197
  v_mfma_f32_16x16x32_bf16 v[208:211], v[184:187], v[220:223], 0
  v_cvt_pk_bf16_f32 v233, v198, v199
  v_add_f32 v126, v120, v121
  v_mfma_f32_16x16x32_bf16 v[200:203], v[228:231], v[224:227], v[200:203]
  v_add_f32 v127, v122, v123
  v_add_f32 v128, v124, v125
  v_mfma_f32_16x16x32_bf16 v[204:207], v[230:233], v[224:227], v[204:207]
  v_add_f32 v236, v126, v127
  v_fmac_f32 v236, v128, v89
  v_mfma_f32_16x16x32_bf16 v[208:211], v[232:235], v[224:227], v[208:211]
  s_nop 0
  v_add_f32_dpp v236, v236, v236 row_ror:8 row_mask:0xf bank_mask:0xf
  v_mov_b32 v237, v236
  ds_write_b128 v11, v[200:203] offset:0
  s_nop 0
  v_permlane32_swap_b32 v236, v237
  v_add_f32 v236, v236, v237
  v_mov_b32 v237, v236
  ds_write_b128 v11, v[204:207] offset:1024
  s_nop 0
  v_permlane16_swap_b32 v236, v237
  v_add_f32 v236, v236, v237
  v_rcp_f32 v236, v236
  ds_write_b128 v11, v[208:211] offset:2048
  s_mov_b64 exec, 0xff
  ds_write_b32 v242, v236
  s_mov_b64 exec, -1
  s_waitcnt lgkmcnt(0)
  s_barrier
  s_lshr_b32 s21, 7, s20
  s_bitcmp1_b32 s21, 0
  s_cbranch_scc0 bw_122
  ds_read_b128 v[104:107], v243
  ds_read_b64 v[96:97], v12 offset:0
  ds_read_b64 v[98:99], v12 offset:3072
  ds_read_b64 v[100:101], v12 offset:6144
  ds_read_b64 v[102:103], v12 offset:9216
  s_waitcnt lgkmcnt(2)
  v_pk_mul_f32 v[96:97], v[96:97], v[104:105] op_sel_hi:[1,0]
  v_pk_fma_f32 v[96:97], v[98:99], v[104:105], v[96:97] op_sel:[0,1,0] op_sel_hi:[1,1,1]
  s_waitcnt lgkmcnt(0)
  v_pk_fma_f32 v[96:97], v[100:101], v[106:107], v[96:97] op_sel_hi:[1,0,1]
  v_pk_fma_f32 v[96:97], v[102:103], v[106:107], v[96:97] op_sel:[0,1,0] op_sel_hi:[1,1,1]
  v_cvt_pk_f16_f32 v100, v96, v97
  v_perm_b32 v100, s91, v100, v14
  buffer_atomic_pk_add_f16 v100, v13, s[4:7], s3 offen
  s_branch bw_121
bw_122:
  s_lshr_b32 s21, 8, s20
  s_bitcmp1_b32 s21, 0
  s_cbranch_scc0 bw_123
  v_mov_b32 v28, -1
  v_mov_b32 v29, -1
  s_cmp_eq_u32 s53, 1
  s_cbranch_scc1 si_124
  buffer_store_dwordx2 v[28:29], v24, s[8:11], s82 offen sc1
  s_branch si_125
si_124:
  buffer_store_dwordx2 v[28:29], v24, s[8:11], s82 offen
si_125:
  s_mov_b64 exec, s[60:61]
  s_add_u32 s22, s82, 278528
  s_cmp_eq_u32 s53, 1
  s_cbranch_scc1 si_126
  buffer_store_dwordx2 v[28:29], v23, s[8:11], s22 offen sc1
  s_branch si_127
si_126:
  buffer_store_dwordx2 v[28:29], v23, s[8:11], s22 offen
si_127:
  s_and_b32 s21, s52, 7
  s_cmp_lg_u32 s21, s50
  s_cbranch_scc1 zm_128
  s_mov_b64 exec, s[70:71]
  buffer_store_dwordx4 v[156:159], v13, s[4:7], s83 offen sc1
zm_128:
  s_mov_b64 exec, -1
  s_branch bw_121
bw_123:
bw_121:
  s_lshr_b32 s21, 4, s20
  s_bitcmp1_b32 s21, 0
  s_cbranch_scc0 bw_130
  s_mov_b64 exec, s[62:63]
  buffer_store_dwordx4 v[212:215], v21, s[24:27], s85 offen sc1
  buffer_store_dwordx2 v[216:217], v23, s[24:27], s85 offen sc1
  s_mov_b64 exec, -1
  s_branch bw_129
bw_130:
bw_129:
  v_mov_b32 v200, v196
  v_mov_b32 v201, v197
  v_mov_b32 v202, v198
  v_mov_b32 v203, v199
  v_permlane32_swap_b32 v188, v192
  v_permlane32_swap_b32 v189, v193
  v_permlane32_swap_b32 v190, v194
  v_permlane32_swap_b32 v191, v195
  v_permlane32_swap_b32 v196, v200
  v_permlane32_swap_b32 v197, v201
  v_permlane32_swap_b32 v198, v202
  v_permlane32_swap_b32 v199, v203
  v_pk_add_f32 v[188:189], v[188:189], v[192:193]
  v_pk_add_f32 v[190:191], v[190:191], v[194:195]
  v_pk_add_f32 v[196:197], v[196:197], v[200:201]
  v_pk_add_f32 v[198:199], v[198:199], v[202:203]
  v_cvt_pk_bf16_f32 v252, v188, v189
  v_cvt_pk_bf16_f32 v254, v196, v197
  v_cvt_pk_bf16_f32 v253, v190, v191
  v_cvt_pk_bf16_f32 v255, v198, v199
  s_nop 0
  v_permlane16_swap_b32 v252, v254
  v_permlane16_swap_b32 v253, v255
  v_min_u32 v252, -2, v252
  s_mov_b64 exec, s[76:77]
  buffer_store_dwordx4 v[252:255], v15, s[24:27], s57 offen sc1
  s_mov_b64 exec, -1
  s_add_u32 s64, s64, 1310720
  s_add_u32 s52, s52, 1
  s_and_b32 s21, s52, 3
  s_mul_i32 s81, s21, 540672
  s_lshl_b32 s84, s21, 15
  s_branch step_86
fl_90:
  buffer_load_dword v94, v95, s[12:15], s79 offen sc1
  s_branch fl_91
pm_88:
  s_cmp_gt_u32 s52, 3
  s_cbranch_scc1 op_131
  v_readfirstlane_b32 s21, v94
  s_cmp_ge_u32 s21, s46
  s_cbranch_scc1 op_131
  buffer_load_dword v94, v95, s[12:15], s79 offen sc1
  s_waitcnt vmcnt(0)
  v_readfirstlane_b32 s21, v94
  s_add_u32 s22, s46, 2
  s_min_u32 s22, s22, 64
  s_sub_u32 s55, s21, s22
  s_sub_u32 s56, s21, s46
  s_cmp_gt_u32 s21, s52
  s_cselect_b32 s21, s87, 0
  s_cmp_eq_u32 s21, 0
  s_cbranch_scc1 op_131
  s_mov_b32 s87, 0
  s_sub_u32 s21, s64, 1310720
  buffer_load_dwordx4 v[176:179], v16, s[28:31], s21 offen offset:0 sc1
  buffer_load_dwordx4 v[180:183], v16, s[28:31], s21 offen offset:1024 sc1
  buffer_load_dwordx4 v[184:187], v16, s[28:31], s21 offen offset:2048 sc1
op_131:
  buffer_load_dwordx4 v[32:35], v4, s[4:7], s84 offen offset:0 sc1
  buffer_load_dwordx4 v[36:39], v4, s[4:7], s84 offen offset:1024 sc1
  buffer_load_dwordx4 v[40:43], v4, s[4:7], s84 offen offset:2048 sc1
  s_add_u32 s54, s54, 1
  s_cmp_gt_u32 s54, 131072
  s_cbranch_scc1 end0
  s_waitcnt vmcnt(0)
  v_bitop3_b32 v27, v35, v39, v43 bitop3:0x80
  v_perm_b32 v35, v39, v35, s89
  v_cmp_gt_u32 vcc, 0x48000000, v27
  v_mov_b32 v39, v42
  s_cbranch_vccnz pm_88
  s_branch A1_19
psr_105:
  buffer_load_dwordx2 v[248:249], v9, s[8:11], s81 offen sc1
  buffer_load_dwordx4 v[112:115], v8, s[8:11], s81 offen offset:0 sc1
  buffer_load_dwordx4 v[116:119], v8, s[8:11], s81 offen offset:1024 sc1
  s_add_u32 s54, s54, 1
  s_cmp_gt_u32 s54, 131072
  s_cbranch_scc1 end0
  s_waitcnt vmcnt(2)
  v_xor_b32 v96, s88, v248
  s_nop 0
  v_permlane16_swap_b32 v248, v249
  v_fma_mix_f32 v250, v248, 1.0, v249 op_sel:[0,0,0] op_sel_hi:[1,0,1]
  v_fma_mix_f32 v251, v248, 1.0, v249 op_sel:[1,0,1] op_sel_hi:[1,0,1]
  v_mov_b32 v248, v250
  v_mov_b32 v249, v251
  s_nop 0
  v_permlane32_swap_b32 v248, v250
  v_permlane32_swap_b32 v249, v251
  v_pk_add_f32 v[124:125], v[248:249], v[250:251]
  v_max_f32 v238, v124, v125
  s_waitcnt vmcnt(0)
  v_pk_add_f16 v100, v112, v116
  v_pk_add_f16 v102, v114, v118
  v_pk_add_f16 v101, v113, v117
  v_pk_add_f16 v103, v115, v119
  v_permlane32_swap_b32 v100, v102
  v_bitop3_b32 v97, v112, v114, s88 bitop3:0x7e
  v_permlane32_swap_b32 v101, v103
  v_bitop3_b32 v98, v116, v118, s88 bitop3:0x7e
  v_fma_mix_f32 v120, v100, 1.0, v102 op_sel:[0,0,0] op_sel_hi:[1,0,1]
  v_or3_b32 v27, v96, v97, v98
  v_fma_mix_f32 v121, v100, 1.0, v102 op_sel:[1,0,1] op_sel_hi:[1,0,1]
  v_and_b32 v27, 1, v27
  v_fma_mix_f32 v122, v101, 1.0, v103 op_sel:[0,0,0] op_sel_hi:[1,0,1]
  v_cmp_ne_u32 vcc, 0, v27
  v_fma_mix_f32 v123, v101, 1.0, v103 op_sel:[1,0,1] op_sel_hi:[1,0,1]
  v_max3_f32 v236, v120, v121, v238
  s_cbranch_vccnz psr_105
  s_branch psj_106
kvw_107:
  s_mov_b32 s22, s87
  s_cmp_eq_u32 s52, 0
  s_cselect_b32 s23, s87, s46
  s_cselect_b32 s55, 0, s55
  s_cselect_b32 s87, 1, 0
  s_cmp_eq_u32 s23, 0
  s_cbranch_scc1 kvok_108
  v_mov_b32 v236, 0
  s_mov_b32 s101, 0
wf_132:
  buffer_load_dword v237, v236, s[12:15], s79 offen sc1
  s_add_u32 s101, s101, 1
  s_cmp_gt_u32 s101, 131072
  s_cbranch_scc1 end0
  s_waitcnt vmcnt(0)
  v_readfirstlane_b32 s100, v237
  s_cmp_ge_u32 s100, s23
  s_cbranch_scc1 wf_133
  s_sleep 3
  s_branch wf_132
wf_133:
  s_cmp_eq_u32 s22, 0
  s_cbranch_scc1 kvok_108
  s_sub_u32 s21, s64, 1310720
  buffer_load_dwordx4 v[176:179], v16, s[28:31], s21 offen offset:0 sc1
  buffer_load_dwordx4 v[180:183], v16, s[28:31], s21 offen offset:1024 sc1
  buffer_load_dwordx4 v[184:187], v16, s[28:31], s21 offen offset:2048 sc1
  s_waitcnt vmcnt(0)
  s_branch kvok_108
last_87:
  s_lshr_b32 s21, 4, s20
  s_bitcmp1_b32 s21, 0
  s_cbranch_scc0 bw_135
  s_mov_b64 exec, s[62:63]
  buffer_store_dwordx4 v[212:215], v21, s[24:27], s85 offen sc1
  buffer_store_dwordx2 v[216:217], v23, s[24:27], s85 offen sc1
  s_mov_b64 exec, -1
  s_branch bw_134
bw_135:
bw_134:
  v_mov_b32 v188, 0
  v_mov_b32 v189, 0
  v_mov_b32 v190, 0
  v_mov_b32 v191, 0
  v_mov_b32 v192, 0
  v_mov_b32 v193, 0
  v_mov_b32 v194, 0
  v_mov_b32 v195, 0
  v_mov_b32 v196, 0
  v_mov_b32 v197, 0
  v_mov_b32 v198, 0
  v_mov_b32 v199, 0
  s_sleep 4
  s_mov_b32 s54, 0
lv_136:
  buffer_load_dwordx4 v[144:147], v10, s[8:11], s81 offen offset:0 sc1
  buffer_load_dwordx4 v[148:151], v10, s[8:11], s81 offen offset:1024 sc1
  buffer_load_dwordx4 v[152:155], v10, s[8:11], s81 offen offset:2048 sc1
  s_add_u32 s54, s54, 1
  s_cmp_gt_u32 s54, 131072
  s_cbranch_scc1 end0
  s_waitcnt vmcnt(0)
  v_max3_u32 v27, v144, v146, v148
  v_max3_u32 v27, v27, v150, v152
  v_max3_u32 v27, v27, v154, v154
  v_cmp_eq_u32 vcc, -1, v27
  s_nop 1
  s_cbranch_vccnz lv_136
  v_smfmac_f32_16x16x64_bf16 v[188:191], v[144:147], a[180:187], v44
  v_smfmac_f32_16x16x64_bf16 v[192:195], v[144:147], a[204:211], v44
  v_smfmac_f32_16x16x64_bf16 v[196:199], v[144:147], a[228:235], v44
  v_smfmac_f32_16x16x64_bf16 v[188:191], v[148:151], a[188:195], v44
  v_smfmac_f32_16x16x64_bf16 v[192:195], v[148:151], a[212:219], v44
  v_smfmac_f32_16x16x64_bf16 v[196:199], v[148:151], a[236:243], v44
  v_smfmac_f32_16x16x64_bf16 v[188:191], v[152:155], a[196:203], v44
  v_smfmac_f32_16x16x64_bf16 v[192:195], v[152:155], a[220:227], v44
  v_smfmac_f32_16x16x64_bf16 v[196:199], v[152:155], a[244:251], v44
  s_nop 7
  v_mov_b32 v200, v196
  v_mov_b32 v201, v197
  v_mov_b32 v202, v198
  v_mov_b32 v203, v199
  v_permlane32_swap_b32 v188, v192
  v_permlane32_swap_b32 v189, v193
  v_permlane32_swap_b32 v190, v194
  v_permlane32_swap_b32 v191, v195
  v_permlane32_swap_b32 v196, v200
  v_permlane32_swap_b32 v197, v201
  v_permlane32_swap_b32 v198, v202
  v_permlane32_swap_b32 v199, v203
  v_pk_add_f32 v[188:189], v[188:189], v[192:193]
  v_pk_add_f32 v[190:191], v[190:191], v[194:195]
  v_pk_add_f32 v[196:197], v[196:197], v[200:201]
  v_pk_add_f32 v[198:199], v[198:199], v[202:203]
  v_cvt_pk_bf16_f32 v252, v188, v189
  v_cvt_pk_bf16_f32 v254, v196, v197
  v_cvt_pk_bf16_f32 v253, v190, v191
  v_cvt_pk_bf16_f32 v255, v198, v199
  s_nop 0
  v_permlane16_swap_b32 v252, v254
  v_permlane16_swap_b32 v253, v255
  v_min_u32 v252, -2, v252
  s_mov_b64 exec, s[76:77]
  buffer_store_dwordx4 v[252:255], v15, s[24:27], s57 offen sc1
  s_mov_b64 exec, -1
  s_lshr_b32 s21, 1, s20
  s_bitcmp1_b32 s21, 0
  s_cbranch_scc0 bw_138
  v_mov_b32 v246, 80
  v_mov_b32 v247, 1
  s_mov_b64 exec, 1
  buffer_atomic_add v247, v246, s[32:35], 0 offen sc0 sc1
  s_mov_b64 exec, -1
clm_139:
  s_branch bw_137
bw_138:
bw_137:
  s_branch chain_done
chain_done:
  s_waitcnt vmcnt(0) lgkmcnt(0)
  s_barrier
  s_mov_b32 s84, 0
  s_mov_b32 s85, -1
  s_mov_b32 s86, 0
  v_mov_b32 v21, 0
  v_mov_b32 v23, v247
  s_cmp_lg_u32 s20, 0
  s_cbranch_scc1 queue_b
  s_mov_b64 exec, 1
  s_branch queue_a
end0:
  s_endpgm
gemm_side:
  s_bfe_u32 s23, s22, 0x20005
  s_add_u32 s22, s22, 31
  s_and_b32 s22, s22, 31
  s_lshl_b32 s21, s23, 3
  s_add_u32 s2, s21, s22
  s_add_u32 s3, s2, 72
  s_add_u32 s24, s2, 48
  s_add_u32 s2, s2, s21
  s_cmp_lt_u32 s22, 24
  s_cselect_b32 s3, s24, s3
  s_cmp_lt_u32 s22, 16
  s_cselect_b32 s3, s2, s3
  s_mov_b32 s2, s3
  s_cmp_ge_u32 s3, 64
  s_cbranch_scc1 not_kv
  s_load_dwordx2 s[4:5], s[0:1], 0
  s_load_dwordx2 s[6:7], s[0:1], 24
  s_load_dwordx2 s[36:37], s[0:1], 32
  s_load_dwordx2 s[38:39], s[0:1], 104
  s_and_b32 s43, s3, 1
  s_bfe_u32 s42, s3, 0x50001
  s_lshr_b32 s40, s42, 2
  s_waitcnt lgkmcnt(0)
  s_cmp_eq_u32 s43, 1
  s_cselect_b32 s6, s36, s6
  s_cselect_b32 s7, s37, s7
  s_mov_b32 s8, s4
  s_mov_b32 s9, s5
  s_mov_b32 s10, 2621440
  s_mov_b32 s11, 0x00020000
  s_mov_b32 s12, s6
  s_mov_b32 s13, s7
  s_mov_b32 s14, 7864320
  s_mov_b32 s15, 0x00020000
  s_mov_b32 s16, s38
  s_mov_b32 s17, s39
  s_mov_b32 s18, 50331648
  s_mov_b32 s19, 0x00020000
  s_mul_i32 s44, s42, 384
  s_mov_b32 s62, 1024
  s_mov_b32 s24, 0
  s_mov_b32 s25, 81920
  s_mov_b32 s64, s32
  s_mov_b32 s65, s33
  s_mov_b32 s66, s34
  s_mov_b32 s67, s35
  s_load_dwordx2 s[72:73], s[0:1], 104
  s_waitcnt lgkmcnt(0)
  s_add_u32 s72, s72, 81068032
  s_addc_u32 s73, s73, 0
  s_mov_b32 s74, 116736
  s_mov_b32 s75, 0x00020000
  v_mov_b32 v9, 2731
  v_add_u32 v8, 0, v1
  v_mul_u32_u24 v7, v8, v9
  v_lshrrev_b32 v7, 16, v7
  v_mul_u32_u24 v4, 24, v7
  v_sub_u32 v8, v8, v4
  v_and_b32 v4, 2, v7
  v_xor_b32 v8, v8, v4
  v_xor_b32 v5, 4, v8
  s_mov_b32 s21, 12288
  v_mul_lo_u32 v7, v7, s21
  v_lshl_add_u32 v40, v8, 4, v7
  v_lshl_add_u32 v43, v5, 4, v7
  v_add_u32 v8, 64, v1
  v_mul_u32_u24 v7, v8, v9
  v_lshrrev_b32 v7, 16, v7
  v_mul_u32_u24 v4, 24, v7
  v_sub_u32 v8, v8, v4
  v_and_b32 v4, 2, v7
  v_xor_b32 v8, v8, v4
  v_xor_b32 v5, 4, v8
  s_mov_b32 s21, 12288
  v_mul_lo_u32 v7, v7, s21
  v_lshl_add_u32 v41, v8, 4, v7
  v_lshl_add_u32 v44, v5, 4, v7
  v_add_u32 v8, 128, v1
  v_mul_u32_u24 v7, v8, v9
  v_lshrrev_b32 v7, 16, v7
  v_mul_u32_u24 v4, 24, v7
  v_sub_u32 v8, v8, v4
  v_and_b32 v4, 2, v7
  v_xor_b32 v8, v8, v4
  v_xor_b32 v5, 4, v8
  s_mov_b32 s21, 12288
  v_mul_lo_u32 v7, v7, s21
  v_lshl_add_u32 v42, v8, 4, v7
  v_lshl_add_u32 v45, v5, 4, v7
  s_mul_i32 s21, s20, 393216
  s_add_u32 s21, s21, 0
  s_add_u32 s21, s21, s44
  s_mul_i32 s22, s20, 12288
  s_add_u32 s22, s22, 0
  s_add_u32 m0, s22, 0
  s_nop 0
  buffer_load_dwordx4 v40, s[12:15], s21 offen lds
  s_add_u32 m0, s22, 1024
  s_nop 0
  buffer_load_dwordx4 v41, s[12:15], s21 offen lds
  s_add_u32 m0, s22, 2048
  s_nop 0
  buffer_load_dwordx4 v42, s[12:15], s21 offen lds
  s_mul_i32 s21, s20, 393216
  s_add_u32 s21, s21, 98304
  s_add_u32 s21, s21, s44
  s_mul_i32 s22, s20, 12288
  s_add_u32 s22, s22, 3072
  s_add_u32 m0, s22, 0
  s_nop 0
  buffer_load_dwordx4 v43, s[12:15], s21 offen lds
  s_add_u32 m0, s22, 1024
  s_nop 0
  buffer_load_dwordx4 v44, s[12:15], s21 offen lds
  s_add_u32 m0, s22, 2048
  s_nop 0
  buffer_load_dwordx4 v45, s[12:15], s21 offen lds
  s_mul_i32 s21, s20, 393216
  s_add_u32 s21, s21, 196608
  s_add_u32 s21, s21, s44
  s_mul_i32 s22, s20, 12288
  s_add_u32 s22, s22, 6144
  s_add_u32 m0, s22, 0
  s_nop 0
  buffer_load_dwordx4 v40, s[12:15], s21 offen lds
  s_add_u32 m0, s22, 1024
  s_nop 0
  buffer_load_dwordx4 v41, s[12:15], s21 offen lds
  s_add_u32 m0, s22, 2048
  s_nop 0
  buffer_load_dwordx4 v42, s[12:15], s21 offen lds
  s_mul_i32 s21, s20, 393216
  s_add_u32 s21, s21, 294912
  s_add_u32 s21, s21, s44
  s_mul_i32 s22, s20, 12288
  s_add_u32 s22, s22, 9216
  s_add_u32 m0, s22, 0
  s_nop 0
  buffer_load_dwordx4 v43, s[12:15], s21 offen lds
  s_add_u32 m0, s22, 1024
  s_nop 0
  buffer_load_dwordx4 v44, s[12:15], s21 offen lds
  s_add_u32 m0, s22, 2048
  s_nop 0
  buffer_load_dwordx4 v45, s[12:15], s21 offen lds
  v_lshrrev_b32 v11, 3, v1
  v_and_b32 v12, 7, v1
  v_xor_b32 v12, v12, v11
  v_mul_u32_u24 v11, 1280, v11
  v_lshl_add_u32 v10, v12, 4, v11
  s_mul_i32 s46, s20, 20480
  v_add_u32 v10, s46, v10
  s_lshl_b32 s47, s20, 11
  s_add_u32 s47, s47, 98304
  s_add_u32 s46, s47, 57344
  s_mov_b32 s30, s24
  s_add_u32 s32, s47, 0
  v_add_u32 v11, 9216, v10
  s_mov_b32 m0, s32
  s_nop 0
  buffer_load_dwordx4 v10, s[8:11], s30 offen offset:0 lds
  buffer_load_dwordx4 v11, s[8:11], s30 offen offset:1024 lds
  s_add_u32 s30, s30, 128
  s_add_u32 s32, s32, 8192
  s_cmp_lt_u32 s32, s46
  s_cselect_b32 s32, s32, s47
  s_mov_b32 m0, s32
  s_nop 0
  buffer_load_dwordx4 v10, s[8:11], s30 offen offset:0 lds
  buffer_load_dwordx4 v11, s[8:11], s30 offen offset:1024 lds
  s_add_u32 s30, s30, 128
  s_add_u32 s32, s32, 8192
  s_cmp_lt_u32 s32, s46
  s_cselect_b32 s32, s32, s47
  s_mov_b32 m0, s32
  s_nop 0
  buffer_load_dwordx4 v10, s[8:11], s30 offen offset:0 lds
  buffer_load_dwordx4 v11, s[8:11], s30 offen offset:1024 lds
  s_add_u32 s30, s30, 128
  s_add_u32 s32, s32, 8192
  s_cmp_lt_u32 s32, s46
  s_cselect_b32 s32, s32, s47
  s_mov_b32 m0, s32
  s_nop 0
  buffer_load_dwordx4 v10, s[8:11], s30 offen offset:0 lds
  buffer_load_dwordx4 v11, s[8:11], s30 offen offset:1024 lds
  s_add_u32 s30, s30, 128
  s_add_u32 s32, s32, 8192
  s_cmp_lt_u32 s32, s46
  s_cselect_b32 s32, s32, s47
  s_mov_b32 m0, s32
  s_nop 0
  buffer_load_dwordx4 v10, s[8:11], s30 offen offset:0 lds
  buffer_load_dwordx4 v11, s[8:11], s30 offen offset:1024 lds
  s_add_u32 s30, s30, 128
  s_add_u32 s32, s32, 8192
  s_cmp_lt_u32 s32, s46
  s_cselect_b32 s32, s32, s47
  s_mul_i32 s21, s20, 393216
  s_add_u32 s21, s21, 1572864
  s_add_u32 s21, s21, s44
  s_mul_i32 s22, s20, 12288
  s_add_u32 s22, s22, 49152
  s_add_u32 m0, s22, 0
  s_nop 0
  buffer_load_dwordx4 v40, s[12:15], s21 offen lds
  s_add_u32 m0, s22, 1024
  s_nop 0
  buffer_load_dwordx4 v41, s[12:15], s21 offen lds
  s_add_u32 m0, s22, 2048
  s_nop 0
  buffer_load_dwordx4 v42, s[12:15], s21 offen lds
  s_mul_i32 s21, s20, 393216
  s_add_u32 s21, s21, 1671168
  s_add_u32 s21, s21, s44
  s_mul_i32 s22, s20, 12288
  s_add_u32 s22, s22, 52224
  s_add_u32 m0, s22, 0
  s_nop 0
  buffer_load_dwordx4 v43, s[12:15], s21 offen lds
  s_add_u32 m0, s22, 1024
  s_nop 0
  buffer_load_dwordx4 v44, s[12:15], s21 offen lds
  s_add_u32 m0, s22, 2048
  s_nop 0
  buffer_load_dwordx4 v45, s[12:15], s21 offen lds
  s_mul_i32 s21, s20, 393216
  s_add_u32 s21, s21, 1769472
  s_add_u32 s21, s21, s44
  s_mul_i32 s22, s20, 12288
  s_add_u32 s22, s22, 55296
  s_add_u32 m0, s22, 0
  s_nop 0
  buffer_load_dwordx4 v40, s[12:15], s21 offen lds
  s_add_u32 m0, s22, 1024
  s_nop 0
  buffer_load_dwordx4 v41, s[12:15], s21 offen lds
  s_add_u32 m0, s22, 2048
  s_nop 0
  buffer_load_dwordx4 v42, s[12:15], s21 offen lds
  s_mul_i32 s21, s20, 393216
  s_add_u32 s21, s21, 1867776
  s_add_u32 s21, s21, s44
  s_mul_i32 s22, s20, 12288
  s_add_u32 s22, s22, 58368
  s_add_u32 m0, s22, 0
  s_nop 0
  buffer_load_dwordx4 v43, s[12:15], s21 offen lds
  s_add_u32 m0, s22, 1024
  s_nop 0
  buffer_load_dwordx4 v44, s[12:15], s21 offen lds
  s_add_u32 m0, s22, 2048
  s_nop 0
  buffer_load_dwordx4 v45, s[12:15], s21 offen lds
  v_lshrrev_b32 v7, 2, v2
  v_and_b32 v4, 2, v7
  v_and_b32 v5, 1, v3
  v_lshl_or_b32 v4, v5, 2, v4
  v_lshl_add_u32 v7, v3, 3, v7
  v_mul_u32_u24 v7, 384, v7
  v_and_b32 v5, 1, v2
  v_lshl_add_u32 v7, v5, 3, v7
  v_bfe_u32 v8, v2, 1, 1
  s_mul_i32 s21, s20, 6
  v_add_u32 v8, s21, v8
  v_add_u32 v5, 0, v8
  v_xor_b32 v5, v5, v4
  v_lshl_add_u32 v46, v5, 4, v7
  v_add_u32 v49, 49152, v46
  v_add_u32 v5, 2, v8
  v_xor_b32 v5, v5, v4
  v_lshl_add_u32 v47, v5, 4, v7
  v_add_u32 v50, 49152, v47
  v_add_u32 v5, 4, v8
  v_xor_b32 v5, v5, v4
  v_lshl_add_u32 v48, v5, 4, v7
  v_add_u32 v51, 49152, v48
  s_mov_b32 s26, 6
  s_mul_i32 s27, s42, 12288
  s_mul_i32 s21, s43, 25165824
  s_add_u32 s27, s27, s21
  s_mov_b32 s28, 786432
  s_lshl_b32 s60, s40, 7
  s_add_u32 s60, s60, 0
  s_mov_b32 s61, 0
  v_and_b32 v6, 7, v2
  v_add_u32 v4, 0, v3
  v_xor_b32 v4, v4, v6
  v_lshlrev_b32 v4, 4, v4
  v_lshl_add_u32 v14, v2, 7, v4
  v_add_u32 v4, 4, v3
  v_xor_b32 v4, v4, v6
  v_lshlrev_b32 v4, 4, v4
  v_lshl_add_u32 v15, v2, 7, v4
  v_mul_u32_u24 v22, 400, v2
  v_mul_u32_u24 v4, 16, v3
  s_mul_i32 s21, s20, 96
  s_add_u32 s21, s21, 0
  v_add3_u32 v22, v22, v4, s21
  v_lshlrev_b32 v4, 3, v3
  v_sub_u32 v16, v22, v4
  v_mov_b32 v9, 2731
  s_mul_i32 s21, s20, 6400
  s_add_u32 s21, s21, 0
  v_mul_u32_u24 v4, 400, v2
  v_lshlrev_b32 v5, 4, v3
  v_add3_u32 v23, v4, v5, s21
  v_lshlrev_b32 v26, 4, v1
  s_mov_b32 s33, 98304
  s_mov_b32 s48, 0x80000000
  s_mov_b32 m0, s32
  s_nop 0
  buffer_load_dwordx4 v10, s[8:11], s30 offen offset:0 lds
  s_waitcnt vmcnt(21)
  s_barrier
  v_add_u32 v18, s33, v14
  v_add_u32 v19, s33, v15
  s_add_u32 s33, s33, 8192
  s_cmp_lt_u32 s33, 155648
  s_cselect_b32 s33, s33, 98304
  ds_read_b128 v[160:163], v18 offset:0
  ds_read_b128 v[164:167], v18 offset:2048
  ds_read_b128 v[168:171], v18 offset:4096
  ds_read_b128 v[172:175], v18 offset:6144
  s_waitcnt lgkmcnt(0)
  s_waitcnt vmcnt(23)
  s_barrier
  ds_read_b64_tr_b16 a[0:1], v46 offset:0
  ds_read_b64_tr_b16 a[2:3], v46 offset:1536
  ds_read_b64_tr_b16 a[4:5], v47 offset:0
  ds_read_b64_tr_b16 a[6:7], v47 offset:1536
  ds_read_b64_tr_b16 a[8:9], v48 offset:0
  ds_read_b64_tr_b16 a[10:11], v48 offset:1536
  ds_read_b64_tr_b16 a[12:13], v46 offset:12288
  ds_read_b64_tr_b16 a[14:15], v46 offset:13824
  ds_read_b64_tr_b16 a[16:17], v47 offset:12288
  ds_read_b64_tr_b16 a[18:19], v47 offset:13824
  ds_read_b64_tr_b16 a[20:21], v48 offset:12288
  ds_read_b64_tr_b16 a[22:23], v48 offset:13824
  ds_read_b64_tr_b16 a[24:25], v46 offset:24576
  ds_read_b64_tr_b16 a[26:27], v46 offset:26112
  ds_read_b64_tr_b16 a[28:29], v47 offset:24576
  ds_read_b64_tr_b16 a[30:31], v47 offset:26112
  ds_read_b64_tr_b16 a[32:33], v48 offset:24576
  ds_read_b64_tr_b16 a[34:35], v48 offset:26112
  ds_read_b64_tr_b16 a[36:37], v46 offset:36864
  ds_read_b64_tr_b16 a[38:39], v46 offset:38400
  ds_read_b64_tr_b16 a[40:41], v47 offset:36864
  ds_read_b64_tr_b16 a[42:43], v47 offset:38400
  ds_read_b64_tr_b16 a[44:45], v48 offset:36864
  ds_read_b64_tr_b16 a[46:47], v48 offset:38400
  s_waitcnt lgkmcnt(0)
  s_barrier
  s_mov_b32 s23, m0
  s_mul_i32 s21, s20, 393216
  s_add_u32 s21, s21, 3145728
  s_add_u32 s21, s21, s44
  s_mul_i32 s22, s20, 12288
  s_add_u32 s22, s22, 0
  s_add_u32 m0, s22, 0
  s_nop 0
  buffer_load_dwordx4 v40, s[12:15], s21 offen lds
  s_add_u32 m0, s22, 1024
  s_nop 0
  buffer_load_dwordx4 v41, s[12:15], s21 offen lds
  s_add_u32 m0, s22, 2048
  s_nop 0
  buffer_load_dwordx4 v42, s[12:15], s21 offen lds
  s_mul_i32 s21, s20, 393216
  s_add_u32 s21, s21, 3244032
  s_add_u32 s21, s21, s44
  s_mul_i32 s22, s20, 12288
  s_add_u32 s22, s22, 3072
  s_add_u32 m0, s22, 0
  s_nop 0
  buffer_load_dwordx4 v43, s[12:15], s21 offen lds
  s_add_u32 m0, s22, 1024
  s_nop 0
  buffer_load_dwordx4 v44, s[12:15], s21 offen lds
  s_add_u32 m0, s22, 2048
  s_nop 0
  buffer_load_dwordx4 v45, s[12:15], s21 offen lds
  s_mul_i32 s21, s20, 393216
  s_add_u32 s21, s21, 3342336
  s_add_u32 s21, s21, s44
  s_mul_i32 s22, s20, 12288
  s_add_u32 s22, s22, 6144
  s_add_u32 m0, s22, 0
  s_nop 0
  buffer_load_dwordx4 v40, s[12:15], s21 offen lds
  s_add_u32 m0, s22, 1024
  s_nop 0
  buffer_load_dwordx4 v41, s[12:15], s21 offen lds
  s_add_u32 m0, s22, 2048
  s_nop 0
  buffer_load_dwordx4 v42, s[12:15], s21 offen lds
  s_mul_i32 s21, s20, 393216
  s_add_u32 s21, s21, 3440640
  s_add_u32 s21, s21, s44
  s_mul_i32 s22, s20, 12288
  s_add_u32 s22, s22, 9216
  s_add_u32 m0, s22, 0
  s_nop 0
  buffer_load_dwordx4 v43, s[12:15], s21 offen lds
  s_add_u32 m0, s22, 1024
  s_nop 0
  buffer_load_dwordx4 v44, s[12:15], s21 offen lds
  s_add_u32 m0, s22, 2048
  s_nop 0
  buffer_load_dwordx4 v45, s[12:15], s21 offen lds
  s_mov_b32 m0, s23
  v_mfma_f32_16x16x32_bf16 v[64:67], a[0:3], v[160:163], 0
  ds_read_b128 v[192:195], v19 offset:0
  v_mfma_f32_16x16x32_bf16 v[68:71], a[4:7], v[160:163], 0
  v_add_u32 v18, s33, v14
  v_mfma_f32_16x16x32_bf16 v[72:75], a[8:11], v[160:163], 0
  v_mfma_f32_16x16x32_bf16 v[76:79], a[0:3], v[164:167], 0
  ds_read_b128 v[196:199], v19 offset:2048
  v_mfma_f32_16x16x32_bf16 v[80:83], a[4:7], v[164:167], 0
  buffer_load_dwordx4 v11, s[8:11], s30 offen offset:1024 lds
  v_mfma_f32_16x16x32_bf16 v[84:87], a[8:11], v[164:167], 0
  s_add_u32 s30, s30, 128
  v_mfma_f32_16x16x32_bf16 v[88:91], a[0:3], v[168:171], 0
  ds_read_b128 v[200:203], v19 offset:4096
  s_add_u32 m0, m0, 8192
  v_mfma_f32_16x16x32_bf16 v[92:95], a[4:7], v[168:171], 0
  s_cmp_lt_u32 m0, s46
  s_cselect_b32 m0, m0, s47
  v_mfma_f32_16x16x32_bf16 v[96:99], a[8:11], v[168:171], 0
  v_mfma_f32_16x16x32_bf16 v[100:103], a[0:3], v[172:175], 0
  ds_read_b128 v[204:207], v19 offset:6144
  v_mfma_f32_16x16x32_bf16 v[104:107], a[4:7], v[172:175], 0
  v_mfma_f32_16x16x32_bf16 v[108:111], a[8:11], v[172:175], 0
  s_waitcnt vmcnt(32) lgkmcnt(2)
  s_barrier
  v_mfma_f32_16x16x32_bf16 v[64:67], a[12:15], v[192:195], v[64:67]
  ds_read_b128 v[160:163], v18 offset:0
  v_mfma_f32_16x16x32_bf16 v[68:71], a[16:19], v[192:195], v[68:71]
  v_mfma_f32_16x16x32_bf16 v[72:75], a[20:23], v[192:195], v[72:75]
  v_add_u32 v19, s33, v15
  s_add_u32 s33, s33, 8192
  v_mfma_f32_16x16x32_bf16 v[76:79], a[12:15], v[196:199], v[76:79]
  ds_read_b128 v[164:167], v18 offset:2048
  v_mfma_f32_16x16x32_bf16 v[80:83], a[16:19], v[196:199], v[80:83]
  buffer_load_dwordx4 v10, s[8:11], s30 offen offset:0 lds
  v_mfma_f32_16x16x32_bf16 v[84:87], a[20:23], v[196:199], v[84:87]
  s_waitcnt lgkmcnt(2)
  v_mfma_f32_16x16x32_bf16 v[88:91], a[12:15], v[200:203], v[88:91]
  ds_read_b128 v[168:171], v18 offset:4096
  v_mfma_f32_16x16x32_bf16 v[92:95], a[16:19], v[200:203], v[92:95]
  s_cmp_lt_u32 s33, 155648
  s_cselect_b32 s33, s33, 98304
  v_mfma_f32_16x16x32_bf16 v[96:99], a[20:23], v[200:203], v[96:99]
  v_mfma_f32_16x16x32_bf16 v[100:103], a[12:15], v[204:207], v[100:103]
  ds_read_b128 v[172:175], v18 offset:6144
  v_mfma_f32_16x16x32_bf16 v[104:107], a[16:19], v[204:207], v[104:107]
  v_mfma_f32_16x16x32_bf16 v[108:111], a[20:23], v[204:207], v[108:111]
  s_waitcnt lgkmcnt(2)
  v_mfma_f32_16x16x32_bf16 v[64:67], a[24:27], v[160:163], v[64:67]
  ds_read_b128 v[192:195], v19 offset:0
  v_mfma_f32_16x16x32_bf16 v[68:71], a[28:31], v[160:163], v[68:71]
  v_add_u32 v18, s33, v14
  v_mfma_f32_16x16x32_bf16 v[72:75], a[32:35], v[160:163], v[72:75]
  v_mfma_f32_16x16x32_bf16 v[76:79], a[24:27], v[164:167], v[76:79]
  ds_read_b128 v[196:199], v19 offset:2048
  v_mfma_f32_16x16x32_bf16 v[80:83], a[28:31], v[164:167], v[80:83]
  buffer_load_dwordx4 v11, s[8:11], s30 offen offset:1024 lds
  v_mfma_f32_16x16x32_bf16 v[84:87], a[32:35], v[164:167], v[84:87]
  s_waitcnt lgkmcnt(2)
  s_add_u32 s30, s30, 128
  v_mfma_f32_16x16x32_bf16 v[88:91], a[24:27], v[168:171], v[88:91]
  ds_read_b128 v[200:203], v19 offset:4096
  s_add_u32 m0, m0, 8192
  v_mfma_f32_16x16x32_bf16 v[92:95], a[28:31], v[168:171], v[92:95]
  s_cmp_lt_u32 m0, s46
  s_cselect_b32 m0, m0, s47
  v_mfma_f32_16x16x32_bf16 v[96:99], a[32:35], v[168:171], v[96:99]
  v_mfma_f32_16x16x32_bf16 v[100:103], a[24:27], v[172:175], v[100:103]
  ds_read_b128 v[204:207], v19 offset:6144
  v_mfma_f32_16x16x32_bf16 v[104:107], a[28:31], v[172:175], v[104:107]
  v_mfma_f32_16x16x32_bf16 v[108:111], a[32:35], v[172:175], v[108:111]
  s_waitcnt vmcnt(32) lgkmcnt(2)
  s_barrier
  v_mfma_f32_16x16x32_bf16 v[64:67], a[36:39], v[192:195], v[64:67]
  ds_read_b128 v[160:163], v18 offset:0
  v_mfma_f32_16x16x32_bf16 v[68:71], a[40:43], v[192:195], v[68:71]
  v_mfma_f32_16x16x32_bf16 v[72:75], a[44:47], v[192:195], v[72:75]
  v_add_u32 v19, s33, v15
  s_add_u32 s33, s33, 8192
  v_mfma_f32_16x16x32_bf16 v[76:79], a[36:39], v[196:199], v[76:79]
  ds_read_b128 v[164:167], v18 offset:2048
  v_mfma_f32_16x16x32_bf16 v[80:83], a[40:43], v[196:199], v[80:83]
  buffer_load_dwordx4 v10, s[8:11], s30 offen offset:0 lds
  v_mfma_f32_16x16x32_bf16 v[84:87], a[44:47], v[196:199], v[84:87]
  s_waitcnt lgkmcnt(2)
  v_mfma_f32_16x16x32_bf16 v[88:91], a[36:39], v[200:203], v[88:91]
  ds_read_b128 v[168:171], v18 offset:4096
  v_mfma_f32_16x16x32_bf16 v[92:95], a[40:43], v[200:203], v[92:95]
  s_cmp_lt_u32 s33, 155648
  s_cselect_b32 s33, s33, 98304
  v_mfma_f32_16x16x32_bf16 v[96:99], a[44:47], v[200:203], v[96:99]
  v_mfma_f32_16x16x32_bf16 v[100:103], a[36:39], v[204:207], v[100:103]
  ds_read_b128 v[172:175], v18 offset:6144
  v_mfma_f32_16x16x32_bf16 v[104:107], a[40:43], v[204:207], v[104:107]
  v_mfma_f32_16x16x32_bf16 v[108:111], a[44:47], v[204:207], v[108:111]
  s_waitcnt lgkmcnt(2)
  s_waitcnt vmcnt(17)
  s_barrier
  ds_read_b64_tr_b16 a[48:49], v49 offset:0
  ds_read_b64_tr_b16 a[50:51], v49 offset:1536
  ds_read_b64_tr_b16 a[52:53], v50 offset:0
  ds_read_b64_tr_b16 a[54:55], v50 offset:1536
  ds_read_b64_tr_b16 a[56:57], v51 offset:0
  ds_read_b64_tr_b16 a[58:59], v51 offset:1536
  ds_read_b64_tr_b16 a[60:61], v49 offset:12288
  ds_read_b64_tr_b16 a[62:63], v49 offset:13824
  ds_read_b64_tr_b16 a[64:65], v50 offset:12288
  ds_read_b64_tr_b16 a[66:67], v50 offset:13824
  ds_read_b64_tr_b16 a[68:69], v51 offset:12288
  ds_read_b64_tr_b16 a[70:71], v51 offset:13824
  ds_read_b64_tr_b16 a[72:73], v49 offset:24576
  ds_read_b64_tr_b16 a[74:75], v49 offset:26112
  ds_read_b64_tr_b16 a[76:77], v50 offset:24576
  ds_read_b64_tr_b16 a[78:79], v50 offset:26112
  ds_read_b64_tr_b16 a[80:81], v51 offset:24576
  ds_read_b64_tr_b16 a[82:83], v51 offset:26112
  ds_read_b64_tr_b16 a[84:85], v49 offset:36864
  ds_read_b64_tr_b16 a[86:87], v49 offset:38400
  ds_read_b64_tr_b16 a[88:89], v50 offset:36864
  ds_read_b64_tr_b16 a[90:91], v50 offset:38400
  ds_read_b64_tr_b16 a[92:93], v51 offset:36864
  ds_read_b64_tr_b16 a[94:95], v51 offset:38400
  s_waitcnt lgkmcnt(0)
  s_barrier
  s_mov_b32 s23, m0
  s_mul_i32 s21, s20, 393216
  s_add_u32 s21, s21, 4718592
  s_add_u32 s21, s21, s44
  s_mul_i32 s22, s20, 12288
  s_add_u32 s22, s22, 49152
  s_add_u32 m0, s22, 0
  s_nop 0
  buffer_load_dwordx4 v40, s[12:15], s21 offen lds
  s_add_u32 m0, s22, 1024
  s_nop 0
  buffer_load_dwordx4 v41, s[12:15], s21 offen lds
  s_add_u32 m0, s22, 2048
  s_nop 0
  buffer_load_dwordx4 v42, s[12:15], s21 offen lds
  s_mul_i32 s21, s20, 393216
  s_add_u32 s21, s21, 4816896
  s_add_u32 s21, s21, s44
  s_mul_i32 s22, s20, 12288
  s_add_u32 s22, s22, 52224
  s_add_u32 m0, s22, 0
  s_nop 0
  buffer_load_dwordx4 v43, s[12:15], s21 offen lds
  s_add_u32 m0, s22, 1024
  s_nop 0
  buffer_load_dwordx4 v44, s[12:15], s21 offen lds
  s_add_u32 m0, s22, 2048
  s_nop 0
  buffer_load_dwordx4 v45, s[12:15], s21 offen lds
  s_mul_i32 s21, s20, 393216
  s_add_u32 s21, s21, 4915200
  s_add_u32 s21, s21, s44
  s_mul_i32 s22, s20, 12288
  s_add_u32 s22, s22, 55296
  s_add_u32 m0, s22, 0
  s_nop 0
  buffer_load_dwordx4 v40, s[12:15], s21 offen lds
  s_add_u32 m0, s22, 1024
  s_nop 0
  buffer_load_dwordx4 v41, s[12:15], s21 offen lds
  s_add_u32 m0, s22, 2048
  s_nop 0
  buffer_load_dwordx4 v42, s[12:15], s21 offen lds
  s_mul_i32 s21, s20, 393216
  s_add_u32 s21, s21, 5013504
  s_add_u32 s21, s21, s44
  s_mul_i32 s22, s20, 12288
  s_add_u32 s22, s22, 58368
  s_add_u32 m0, s22, 0
  s_nop 0
  buffer_load_dwordx4 v43, s[12:15], s21 offen lds
  s_add_u32 m0, s22, 1024
  s_nop 0
  buffer_load_dwordx4 v44, s[12:15], s21 offen lds
  s_add_u32 m0, s22, 2048
  s_nop 0
  buffer_load_dwordx4 v45, s[12:15], s21 offen lds
  s_mov_b32 m0, s23
  v_mfma_f32_16x16x32_bf16 v[64:67], a[48:51], v[160:163], v[64:67]
  ds_read_b128 v[192:195], v19 offset:0
  v_mfma_f32_16x16x32_bf16 v[68:71], a[52:55], v[160:163], v[68:71]
  v_add_u32 v18, s33, v14
  v_mfma_f32_16x16x32_bf16 v[72:75], a[56:59], v[160:163], v[72:75]
  v_mfma_f32_16x16x32_bf16 v[76:79], a[48:51], v[164:167], v[76:79]
  ds_read_b128 v[196:199], v19 offset:2048
  v_mfma_f32_16x16x32_bf16 v[80:83], a[52:55], v[164:167], v[80:83]
  buffer_load_dwordx4 v11, s[8:11], s30 offen offset:1024 lds
  v_mfma_f32_16x16x32_bf16 v[84:87], a[56:59], v[164:167], v[84:87]
  s_add_u32 s30, s30, 128
  v_mfma_f32_16x16x32_bf16 v[88:91], a[48:51], v[168:171], v[88:91]
  ds_read_b128 v[200:203], v19 offset:4096
  s_add_u32 m0, m0, 8192
  v_mfma_f32_16x16x32_bf16 v[92:95], a[52:55], v[168:171], v[92:95]
  s_cmp_lt_u32 m0, s46
  s_cselect_b32 m0, m0, s47
  v_mfma_f32_16x16x32_bf16 v[96:99], a[56:59], v[168:171], v[96:99]
  v_mfma_f32_16x16x32_bf16 v[100:103], a[48:51], v[172:175], v[100:103]
  ds_read_b128 v[204:207], v19 offset:6144
  v_mfma_f32_16x16x32_bf16 v[104:107], a[52:55], v[172:175], v[104:107]
  v_mfma_f32_16x16x32_bf16 v[108:111], a[56:59], v[172:175], v[108:111]
  s_waitcnt vmcnt(44) lgkmcnt(2)
  s_barrier
  v_mfma_f32_16x16x32_bf16 v[64:67], a[60:63], v[192:195], v[64:67]
  ds_read_b128 v[160:163], v18 offset:0
  v_mfma_f32_16x16x32_bf16 v[68:71], a[64:67], v[192:195], v[68:71]
  v_mfma_f32_16x16x32_bf16 v[72:75], a[68:71], v[192:195], v[72:75]
  v_add_u32 v19, s33, v15
  s_add_u32 s33, s33, 8192
  v_mfma_f32_16x16x32_bf16 v[76:79], a[60:63], v[196:199], v[76:79]
  ds_read_b128 v[164:167], v18 offset:2048
  v_mfma_f32_16x16x32_bf16 v[80:83], a[64:67], v[196:199], v[80:83]
  buffer_load_dwordx4 v10, s[8:11], s30 offen offset:0 lds
  v_mfma_f32_16x16x32_bf16 v[84:87], a[68:71], v[196:199], v[84:87]
  s_waitcnt lgkmcnt(2)
  v_mfma_f32_16x16x32_bf16 v[88:91], a[60:63], v[200:203], v[88:91]
  ds_read_b128 v[168:171], v18 offset:4096
  v_mfma_f32_16x16x32_bf16 v[92:95], a[64:67], v[200:203], v[92:95]
  s_cmp_lt_u32 s33, 155648
  s_cselect_b32 s33, s33, 98304
  v_mfma_f32_16x16x32_bf16 v[96:99], a[68:71], v[200:203], v[96:99]
  v_mfma_f32_16x16x32_bf16 v[100:103], a[60:63], v[204:207], v[100:103]
  ds_read_b128 v[172:175], v18 offset:6144
  v_mfma_f32_16x16x32_bf16 v[104:107], a[64:67], v[204:207], v[104:107]
  v_mfma_f32_16x16x32_bf16 v[108:111], a[68:71], v[204:207], v[108:111]
  s_waitcnt lgkmcnt(2)
  v_mfma_f32_16x16x32_bf16 v[64:67], a[72:75], v[160:163], v[64:67]
  ds_read_b128 v[192:195], v19 offset:0
  v_mfma_f32_16x16x32_bf16 v[68:71], a[76:79], v[160:163], v[68:71]
  v_add_u32 v18, s33, v14
  v_mfma_f32_16x16x32_bf16 v[72:75], a[80:83], v[160:163], v[72:75]
  v_mfma_f32_16x16x32_bf16 v[76:79], a[72:75], v[164:167], v[76:79]
  ds_read_b128 v[196:199], v19 offset:2048
  v_mfma_f32_16x16x32_bf16 v[80:83], a[76:79], v[164:167], v[80:83]
  buffer_load_dwordx4 v11, s[8:11], s30 offen offset:1024 lds
  v_mfma_f32_16x16x32_bf16 v[84:87], a[80:83], v[164:167], v[84:87]
  s_waitcnt lgkmcnt(2)
  s_add_u32 s30, s30, 128
  v_mfma_f32_16x16x32_bf16 v[88:91], a[72:75], v[168:171], v[88:91]
  ds_read_b128 v[200:203], v19 offset:4096
  s_add_u32 m0, m0, 8192
  v_mfma_f32_16x16x32_bf16 v[92:95], a[76:79], v[168:171], v[92:95]
  s_cmp_lt_u32 m0, s46
  s_cselect_b32 m0, m0, s47
  v_mfma_f32_16x16x32_bf16 v[96:99], a[80:83], v[168:171], v[96:99]
  v_mfma_f32_16x16x32_bf16 v[100:103], a[72:75], v[172:175], v[100:103]
  ds_read_b128 v[204:207], v19 offset:6144
  v_mfma_f32_16x16x32_bf16 v[104:107], a[76:79], v[172:175], v[104:107]
  v_mfma_f32_16x16x32_bf16 v[108:111], a[80:83], v[172:175], v[108:111]
  s_waitcnt vmcnt(44) lgkmcnt(2)
  s_barrier
  v_mfma_f32_16x16x32_bf16 v[64:67], a[84:87], v[192:195], v[64:67]
  ds_read_b128 v[160:163], v18 offset:0
  v_mfma_f32_16x16x32_bf16 v[68:71], a[88:91], v[192:195], v[68:71]
  v_mfma_f32_16x16x32_bf16 v[72:75], a[92:95], v[192:195], v[72:75]
  v_add_u32 v19, s33, v15
  s_add_u32 s33, s33, 8192
  v_mfma_f32_16x16x32_bf16 v[76:79], a[84:87], v[196:199], v[76:79]
  ds_read_b128 v[164:167], v18 offset:2048
  v_mfma_f32_16x16x32_bf16 v[80:83], a[88:91], v[196:199], v[80:83]
  buffer_load_dwordx4 v10, s[8:11], s30 offen offset:0 lds
  v_mfma_f32_16x16x32_bf16 v[84:87], a[92:95], v[196:199], v[84:87]
  s_waitcnt lgkmcnt(2)
  v_mfma_f32_16x16x32_bf16 v[88:91], a[84:87], v[200:203], v[88:91]
  ds_read_b128 v[168:171], v18 offset:4096
  v_mfma_f32_16x16x32_bf16 v[92:95], a[88:91], v[200:203], v[92:95]
  s_cmp_lt_u32 s33, 155648
  s_cselect_b32 s33, s33, 98304
  v_mfma_f32_16x16x32_bf16 v[96:99], a[92:95], v[200:203], v[96:99]
  v_mfma_f32_16x16x32_bf16 v[100:103], a[84:87], v[204:207], v[100:103]
  ds_read_b128 v[172:175], v18 offset:6144
  v_mfma_f32_16x16x32_bf16 v[104:107], a[88:91], v[204:207], v[104:107]
  v_mfma_f32_16x16x32_bf16 v[108:111], a[92:95], v[204:207], v[108:111]
  s_waitcnt lgkmcnt(2)
  s_waitcnt vmcnt(20)
  s_barrier
  ds_read_b64_tr_b16 a[96:97], v46 offset:0
  ds_read_b64_tr_b16 a[98:99], v46 offset:1536
  ds_read_b64_tr_b16 a[100:101], v47 offset:0
  ds_read_b64_tr_b16 a[102:103], v47 offset:1536
  ds_read_b64_tr_b16 a[104:105], v48 offset:0
  ds_read_b64_tr_b16 a[106:107], v48 offset:1536
  ds_read_b64_tr_b16 a[108:109], v46 offset:12288
  ds_read_b64_tr_b16 a[110:111], v46 offset:13824
  ds_read_b64_tr_b16 a[112:113], v47 offset:12288
  ds_read_b64_tr_b16 a[114:115], v47 offset:13824
  ds_read_b64_tr_b16 a[116:117], v48 offset:12288
  ds_read_b64_tr_b16 a[118:119], v48 offset:13824
  ds_read_b64_tr_b16 a[120:121], v46 offset:24576
  ds_read_b64_tr_b16 a[122:123], v46 offset:26112
  ds_read_b64_tr_b16 a[124:125], v47 offset:24576
  ds_read_b64_tr_b16 a[126:127], v47 offset:26112
  ds_read_b64_tr_b16 a[128:129], v48 offset:24576
  ds_read_b64_tr_b16 a[130:131], v48 offset:26112
  ds_read_b64_tr_b16 a[132:133], v46 offset:36864
  ds_read_b64_tr_b16 a[134:135], v46 offset:38400
  ds_read_b64_tr_b16 a[136:137], v47 offset:36864
  ds_read_b64_tr_b16 a[138:139], v47 offset:38400
  ds_read_b64_tr_b16 a[140:141], v48 offset:36864
  ds_read_b64_tr_b16 a[142:143], v48 offset:38400
  s_waitcnt lgkmcnt(0)
  s_barrier
  s_mov_b32 s23, m0
  s_mul_i32 s21, s20, 393216
  s_add_u32 s21, s21, 6291456
  s_add_u32 s21, s21, s44
  s_mul_i32 s22, s20, 12288
  s_add_u32 s22, s22, 0
  s_add_u32 m0, s22, 0
  s_nop 0
  buffer_load_dwordx4 v40, s[12:15], s21 offen lds
  s_add_u32 m0, s22, 1024
  s_nop 0
  buffer_load_dwordx4 v41, s[12:15], s21 offen lds
  s_add_u32 m0, s22, 2048
  s_nop 0
  buffer_load_dwordx4 v42, s[12:15], s21 offen lds
  s_mul_i32 s21, s20, 393216
  s_add_u32 s21, s21, 6389760
  s_add_u32 s21, s21, s44
  s_mul_i32 s22, s20, 12288
  s_add_u32 s22, s22, 3072
  s_add_u32 m0, s22, 0
  s_nop 0
  buffer_load_dwordx4 v43, s[12:15], s21 offen lds
  s_add_u32 m0, s22, 1024
  s_nop 0
  buffer_load_dwordx4 v44, s[12:15], s21 offen lds
  s_add_u32 m0, s22, 2048
  s_nop 0
  buffer_load_dwordx4 v45, s[12:15], s21 offen lds
  s_mul_i32 s21, s20, 393216
  s_add_u32 s21, s21, 6488064
  s_add_u32 s21, s21, s44
  s_mul_i32 s22, s20, 12288
  s_add_u32 s22, s22, 6144
  s_add_u32 m0, s22, 0
  s_nop 0
  buffer_load_dwordx4 v40, s[12:15], s21 offen lds
  s_add_u32 m0, s22, 1024
  s_nop 0
  buffer_load_dwordx4 v41, s[12:15], s21 offen lds
  s_add_u32 m0, s22, 2048
  s_nop 0
  buffer_load_dwordx4 v42, s[12:15], s21 offen lds
  s_mul_i32 s21, s20, 393216
  s_add_u32 s21, s21, 6586368
  s_add_u32 s21, s21, s44
  s_mul_i32 s22, s20, 12288
  s_add_u32 s22, s22, 9216
  s_add_u32 m0, s22, 0
  s_nop 0
  buffer_load_dwordx4 v43, s[12:15], s21 offen lds
  s_add_u32 m0, s22, 1024
  s_nop 0
  buffer_load_dwordx4 v44, s[12:15], s21 offen lds
  s_add_u32 m0, s22, 2048
  s_nop 0
  buffer_load_dwordx4 v45, s[12:15], s21 offen lds
  s_mov_b32 m0, s23
  v_mov_b32 v29, 76
  buffer_load_dword v29, v29, s[64:67], 0 offen sc1
  v_mfma_f32_16x16x32_bf16 v[64:67], a[96:99], v[160:163], v[64:67]
  ds_read_b128 v[192:195], v19 offset:0
  v_mfma_f32_16x16x32_bf16 v[68:71], a[100:103], v[160:163], v[68:71]
  v_add_u32 v18, s33, v14
  s_mov_b32 s61, s60
  v_mfma_f32_16x16x32_bf16 v[72:75], a[104:107], v[160:163], v[72:75]
  s_add_u32 s60, s60, s62
  s_lshr_b32 s48, s20, 1
  v_mfma_f32_16x16x32_bf16 v[76:79], a[96:99], v[164:167], v[76:79]
  ds_read_b128 v[196:199], v19 offset:2048
  s_mul_i32 s48, s48, 393216
  v_mfma_f32_16x16x32_bf16 v[80:83], a[100:103], v[164:167], v[80:83]
  buffer_load_dwordx4 v11, s[8:11], s30 offen offset:1024 lds
  v_mfma_f32_16x16x32_bf16 v[84:87], a[104:107], v[164:167], v[84:87]
  s_add_u32 s30, s30, s25
  v_mfma_f32_16x16x32_bf16 v[88:91], a[96:99], v[168:171], v[88:91]
  ds_read_b128 v[200:203], v19 offset:4096
  s_sub_u32 s30, s30, 1152
  v_mfma_f32_16x16x32_bf16 v[92:95], a[100:103], v[168:171], v[92:95]
  s_add_u32 m0, m0, 8192
  s_and_b32 s21, s20, 1
  v_mfma_f32_16x16x32_bf16 v[96:99], a[104:107], v[168:171], v[96:99]
  s_cmp_lt_u32 m0, s46
  s_cselect_b32 m0, m0, s47
  v_mfma_f32_16x16x32_bf16 v[100:103], a[96:99], v[172:175], v[100:103]
  ds_read_b128 v[204:207], v19 offset:6144
  s_mul_i32 s21, s21, 6144
  v_mfma_f32_16x16x32_bf16 v[104:107], a[100:103], v[172:175], v[104:107]
  s_add_u32 s48, s48, s21
  s_add_u32 s48, s48, s27
  v_mfma_f32_16x16x32_bf16 v[108:111], a[104:107], v[172:175], v[108:111]
  s_waitcnt vmcnt(33) lgkmcnt(2)
  s_barrier
  v_mfma_f32_16x16x32_bf16 v[64:67], a[108:111], v[192:195], v[64:67]
  ds_read_b128 v[160:163], v18 offset:0
  s_add_u32 s27, s27, s28
  v_mfma_f32_16x16x32_bf16 v[68:71], a[112:115], v[192:195], v[68:71]
  s_sub_u32 s26, s26, 1
  v_mfma_f32_16x16x32_bf16 v[72:75], a[116:119], v[192:195], v[72:75]
  v_add_u32 v19, s33, v15
  s_add_u32 s33, s33, 8192
  v_mfma_f32_16x16x32_bf16 v[76:79], a[108:111], v[196:199], v[76:79]
  ds_read_b128 v[164:167], v18 offset:2048
  v_mfma_f32_16x16x32_bf16 v[80:83], a[112:115], v[196:199], v[80:83]
  buffer_load_dwordx4 v10, s[8:11], s30 offen offset:0 lds
  v_mfma_f32_16x16x32_bf16 v[84:87], a[116:119], v[196:199], v[84:87]
  s_waitcnt lgkmcnt(2)
  v_mfma_f32_16x16x32_bf16 v[88:91], a[108:111], v[200:203], v[88:91]
  ds_read_b128 v[168:171], v18 offset:4096
  v_mfma_f32_16x16x32_bf16 v[92:95], a[112:115], v[200:203], v[92:95]
  s_cmp_lt_u32 s33, 155648
  s_cselect_b32 s33, s33, 98304
  v_mfma_f32_16x16x32_bf16 v[96:99], a[116:119], v[200:203], v[96:99]
  v_mfma_f32_16x16x32_bf16 v[100:103], a[108:111], v[204:207], v[100:103]
  ds_read_b128 v[172:175], v18 offset:6144
  v_mfma_f32_16x16x32_bf16 v[104:107], a[112:115], v[204:207], v[104:107]
  v_mfma_f32_16x16x32_bf16 v[108:111], a[116:119], v[204:207], v[108:111]
  s_waitcnt lgkmcnt(2)
  v_mfma_f32_16x16x32_bf16 v[64:67], a[120:123], v[160:163], v[64:67]
  ds_read_b128 v[192:195], v19 offset:0
  v_mfma_f32_16x16x32_bf16 v[68:71], a[124:127], v[160:163], v[68:71]
  v_add_u32 v18, s33, v14
  v_mfma_f32_16x16x32_bf16 v[72:75], a[128:131], v[160:163], v[72:75]
  v_mfma_f32_16x16x32_bf16 v[76:79], a[120:123], v[164:167], v[76:79]
  ds_read_b128 v[196:199], v19 offset:2048
  v_mfma_f32_16x16x32_bf16 v[80:83], a[124:127], v[164:167], v[80:83]
  buffer_load_dwordx4 v11, s[8:11], s30 offen offset:1024 lds
  v_mfma_f32_16x16x32_bf16 v[84:87], a[128:131], v[164:167], v[84:87]
  s_waitcnt lgkmcnt(2)
  s_add_u32 s30, s30, 128
  v_mfma_f32_16x16x32_bf16 v[88:91], a[120:123], v[168:171], v[88:91]
  ds_read_b128 v[200:203], v19 offset:4096
  s_add_u32 m0, m0, 8192
  v_mfma_f32_16x16x32_bf16 v[92:95], a[124:127], v[168:171], v[92:95]
  s_cmp_lt_u32 m0, s46
  s_cselect_b32 m0, m0, s47
  v_mfma_f32_16x16x32_bf16 v[96:99], a[128:131], v[168:171], v[96:99]
  v_mfma_f32_16x16x32_bf16 v[100:103], a[120:123], v[172:175], v[100:103]
  ds_read_b128 v[204:207], v19 offset:6144
  v_mfma_f32_16x16x32_bf16 v[104:107], a[124:127], v[172:175], v[104:107]
  v_mfma_f32_16x16x32_bf16 v[108:111], a[128:131], v[172:175], v[108:111]
  s_waitcnt vmcnt(33) lgkmcnt(2)
  s_barrier
  v_mfma_f32_16x16x32_bf16 v[64:67], a[132:135], v[192:195], v[64:67]
  ds_read_b128 v[160:163], v18 offset:0
  v_mfma_f32_16x16x32_bf16 v[68:71], a[136:139], v[192:195], v[68:71]
  v_mfma_f32_16x16x32_bf16 v[72:75], a[140:143], v[192:195], v[72:75]
  v_add_u32 v19, s33, v15
  s_add_u32 s33, s33, 8192
  v_mfma_f32_16x16x32_bf16 v[76:79], a[132:135], v[196:199], v[76:79]
  ds_read_b128 v[164:167], v18 offset:2048
  v_mfma_f32_16x16x32_bf16 v[80:83], a[136:139], v[196:199], v[80:83]
  buffer_load_dwordx4 v10, s[8:11], s30 offen offset:0 lds
  v_mfma_f32_16x16x32_bf16 v[84:87], a[140:143], v[196:199], v[84:87]
  s_waitcnt lgkmcnt(2)
  v_mfma_f32_16x16x32_bf16 v[88:91], a[132:135], v[200:203], v[88:91]
  ds_read_b128 v[168:171], v18 offset:4096
  v_mfma_f32_16x16x32_bf16 v[92:95], a[136:139], v[200:203], v[92:95]
  s_cmp_lt_u32 s33, 155648
  s_cselect_b32 s33, s33, 98304
  v_mfma_f32_16x16x32_bf16 v[96:99], a[140:143], v[200:203], v[96:99]
  v_mfma_f32_16x16x32_bf16 v[100:103], a[132:135], v[204:207], v[100:103]
  ds_read_b128 v[172:175], v18 offset:6144
  v_mfma_f32_16x16x32_bf16 v[104:107], a[136:139], v[204:207], v[104:107]
  v_mfma_f32_16x16x32_bf16 v[108:111], a[140:143], v[204:207], v[108:111]
  s_waitcnt lgkmcnt(2)
  s_waitcnt vmcnt(21)
  s_barrier
  ds_read_b64_tr_b16 a[144:145], v49 offset:0
  ds_read_b64_tr_b16 a[146:147], v49 offset:1536
  ds_read_b64_tr_b16 a[148:149], v50 offset:0
  ds_read_b64_tr_b16 a[150:151], v50 offset:1536
  ds_read_b64_tr_b16 a[152:153], v51 offset:0
  ds_read_b64_tr_b16 a[154:155], v51 offset:1536
  ds_read_b64_tr_b16 a[156:157], v49 offset:12288
  ds_read_b64_tr_b16 a[158:159], v49 offset:13824
  ds_read_b64_tr_b16 a[160:161], v50 offset:12288
  ds_read_b64_tr_b16 a[162:163], v50 offset:13824
  ds_read_b64_tr_b16 a[164:165], v51 offset:12288
  ds_read_b64_tr_b16 a[166:167], v51 offset:13824
  ds_read_b64_tr_b16 a[168:169], v49 offset:24576
  ds_read_b64_tr_b16 a[170:171], v49 offset:26112
  ds_read_b64_tr_b16 a[172:173], v50 offset:24576
  ds_read_b64_tr_b16 a[174:175], v50 offset:26112
  ds_read_b64_tr_b16 a[176:177], v51 offset:24576
  ds_read_b64_tr_b16 a[178:179], v51 offset:26112
  ds_read_b64_tr_b16 a[180:181], v49 offset:36864
  ds_read_b64_tr_b16 a[182:183], v49 offset:38400
  ds_read_b64_tr_b16 a[184:185], v50 offset:36864
  ds_read_b64_tr_b16 a[186:187], v50 offset:38400
  ds_read_b64_tr_b16 a[188:189], v51 offset:36864
  ds_read_b64_tr_b16 a[190:191], v51 offset:38400
  s_waitcnt lgkmcnt(0)
  s_barrier
  v_mfma_f32_16x16x32_bf16 v[64:67], a[144:147], v[160:163], v[64:67]
  ds_read_b128 v[192:195], v19 offset:0
  v_mfma_f32_16x16x32_bf16 v[68:71], a[148:151], v[160:163], v[68:71]
  v_add_u32 v18, s33, v14
  v_mfma_f32_16x16x32_bf16 v[72:75], a[152:155], v[160:163], v[72:75]
  v_mfma_f32_16x16x32_bf16 v[76:79], a[144:147], v[164:167], v[76:79]
  ds_read_b128 v[196:199], v19 offset:2048
  v_mfma_f32_16x16x32_bf16 v[80:83], a[148:151], v[164:167], v[80:83]
  buffer_load_dwordx4 v11, s[8:11], s30 offen offset:1024 lds
  v_mfma_f32_16x16x32_bf16 v[84:87], a[152:155], v[164:167], v[84:87]
  s_add_u32 s30, s30, 128
  v_mfma_f32_16x16x32_bf16 v[88:91], a[144:147], v[168:171], v[88:91]
  ds_read_b128 v[200:203], v19 offset:4096
  s_add_u32 m0, m0, 8192
  v_mfma_f32_16x16x32_bf16 v[92:95], a[148:151], v[168:171], v[92:95]
  s_cmp_lt_u32 m0, s46
  s_cselect_b32 m0, m0, s47
  v_mfma_f32_16x16x32_bf16 v[96:99], a[152:155], v[168:171], v[96:99]
  v_mfma_f32_16x16x32_bf16 v[100:103], a[144:147], v[172:175], v[100:103]
  ds_read_b128 v[204:207], v19 offset:6144
  v_mfma_f32_16x16x32_bf16 v[104:107], a[148:151], v[172:175], v[104:107]
  v_mfma_f32_16x16x32_bf16 v[108:111], a[152:155], v[172:175], v[108:111]
  s_waitcnt vmcnt(21) lgkmcnt(2)
  s_barrier
  v_mfma_f32_16x16x32_bf16 v[64:67], a[156:159], v[192:195], v[64:67]
  ds_read_b128 v[160:163], v18 offset:0
  v_mfma_f32_16x16x32_bf16 v[68:71], a[160:163], v[192:195], v[68:71]
  v_mfma_f32_16x16x32_bf16 v[72:75], a[164:167], v[192:195], v[72:75]
  v_add_u32 v19, s33, v15
  s_add_u32 s33, s33, 8192
  v_mfma_f32_16x16x32_bf16 v[76:79], a[156:159], v[196:199], v[76:79]
  ds_read_b128 v[164:167], v18 offset:2048
  v_mfma_f32_16x16x32_bf16 v[80:83], a[160:163], v[196:199], v[80:83]
  buffer_load_dwordx4 v10, s[8:11], s30 offen offset:0 lds
  v_mfma_f32_16x16x32_bf16 v[84:87], a[164:167], v[196:199], v[84:87]
  s_waitcnt lgkmcnt(2)
  v_mfma_f32_16x16x32_bf16 v[88:91], a[156:159], v[200:203], v[88:91]
  ds_read_b128 v[168:171], v18 offset:4096
  v_mfma_f32_16x16x32_bf16 v[92:95], a[160:163], v[200:203], v[92:95]
  s_cmp_lt_u32 s33, 155648
  s_cselect_b32 s33, s33, 98304
  v_mfma_f32_16x16x32_bf16 v[96:99], a[164:167], v[200:203], v[96:99]
  v_mfma_f32_16x16x32_bf16 v[100:103], a[156:159], v[204:207], v[100:103]
  ds_read_b128 v[172:175], v18 offset:6144
  v_mfma_f32_16x16x32_bf16 v[104:107], a[160:163], v[204:207], v[104:107]
  v_mfma_f32_16x16x32_bf16 v[108:111], a[164:167], v[204:207], v[108:111]
  s_waitcnt lgkmcnt(2)
  v_mfma_f32_16x16x32_bf16 v[64:67], a[168:171], v[160:163], v[64:67]
  ds_read_b128 v[192:195], v19 offset:0
  v_mfma_f32_16x16x32_bf16 v[68:71], a[172:175], v[160:163], v[68:71]
  v_add_u32 v18, s33, v14
  v_mfma_f32_16x16x32_bf16 v[72:75], a[176:179], v[160:163], v[72:75]
  v_mfma_f32_16x16x32_bf16 v[76:79], a[168:171], v[164:167], v[76:79]
  ds_read_b128 v[196:199], v19 offset:2048
  v_mfma_f32_16x16x32_bf16 v[80:83], a[172:175], v[164:167], v[80:83]
  buffer_load_dwordx4 v11, s[8:11], s30 offen offset:1024 lds
  v_mfma_f32_16x16x32_bf16 v[84:87], a[176:179], v[164:167], v[84:87]
  s_waitcnt lgkmcnt(2)
  s_add_u32 s30, s30, 128
  v_mfma_f32_16x16x32_bf16 v[88:91], a[168:171], v[168:171], v[88:91]
  ds_read_b128 v[200:203], v19 offset:4096
  s_add_u32 m0, m0, 8192
  v_mfma_f32_16x16x32_bf16 v[92:95], a[172:175], v[168:171], v[92:95]
  s_cmp_lt_u32 m0, s46
  s_cselect_b32 m0, m0, s47
  v_mfma_f32_16x16x32_bf16 v[96:99], a[176:179], v[168:171], v[96:99]
  v_mfma_f32_16x16x32_bf16 v[100:103], a[168:171], v[172:175], v[100:103]
  ds_read_b128 v[204:207], v19 offset:6144
  v_mfma_f32_16x16x32_bf16 v[104:107], a[172:175], v[172:175], v[104:107]
  v_mfma_f32_16x16x32_bf16 v[108:111], a[176:179], v[172:175], v[108:111]
  s_waitcnt vmcnt(21) lgkmcnt(2)
  s_barrier
  v_mfma_f32_16x16x32_bf16 v[64:67], a[180:183], v[192:195], v[64:67]
  ds_read_b128 v[160:163], v18 offset:0
  v_mfma_f32_16x16x32_bf16 v[68:71], a[184:187], v[192:195], v[68:71]
  v_mfma_f32_16x16x32_bf16 v[72:75], a[188:191], v[192:195], v[72:75]
  v_add_u32 v19, s33, v15
  s_add_u32 s33, s33, 8192
  v_mfma_f32_16x16x32_bf16 v[76:79], a[180:183], v[196:199], v[76:79]
  ds_read_b128 v[164:167], v18 offset:2048
  v_mfma_f32_16x16x32_bf16 v[80:83], a[184:187], v[196:199], v[80:83]
  buffer_load_dwordx4 v10, s[8:11], s30 offen offset:0 lds
  v_mfma_f32_16x16x32_bf16 v[84:87], a[188:191], v[196:199], v[84:87]
  s_waitcnt lgkmcnt(2)
  v_mfma_f32_16x16x32_bf16 v[88:91], a[180:183], v[200:203], v[88:91]
  ds_read_b128 v[168:171], v18 offset:4096
  v_mfma_f32_16x16x32_bf16 v[92:95], a[184:187], v[200:203], v[92:95]
  s_cmp_lt_u32 s33, 155648
  s_cselect_b32 s33, s33, 98304
  v_mfma_f32_16x16x32_bf16 v[96:99], a[188:191], v[200:203], v[96:99]
  v_mfma_f32_16x16x32_bf16 v[100:103], a[180:183], v[204:207], v[100:103]
  ds_read_b128 v[172:175], v18 offset:6144
  v_mfma_f32_16x16x32_bf16 v[104:107], a[184:187], v[204:207], v[104:107]
  v_mfma_f32_16x16x32_bf16 v[108:111], a[188:191], v[204:207], v[108:111]
  s_waitcnt lgkmcnt(2)
  s_waitcnt vmcnt(9)
  s_barrier
  ds_read_b64_tr_b16 a[192:193], v46 offset:0
  ds_read_b64_tr_b16 a[194:195], v46 offset:1536
  ds_read_b64_tr_b16 a[196:197], v47 offset:0
  ds_read_b64_tr_b16 a[198:199], v47 offset:1536
  ds_read_b64_tr_b16 a[200:201], v48 offset:0
  ds_read_b64_tr_b16 a[202:203], v48 offset:1536
  ds_read_b64_tr_b16 a[204:205], v46 offset:12288
  ds_read_b64_tr_b16 a[206:207], v46 offset:13824
  ds_read_b64_tr_b16 a[208:209], v47 offset:12288
  ds_read_b64_tr_b16 a[210:211], v47 offset:13824
  ds_read_b64_tr_b16 a[212:213], v48 offset:12288
  ds_read_b64_tr_b16 a[214:215], v48 offset:13824
  ds_read_b64_tr_b16 a[216:217], v46 offset:24576
  ds_read_b64_tr_b16 a[218:219], v46 offset:26112
  ds_read_b64_tr_b16 a[220:221], v47 offset:24576
  ds_read_b64_tr_b16 a[222:223], v47 offset:26112
  ds_read_b64_tr_b16 a[224:225], v48 offset:24576
  ds_read_b64_tr_b16 a[226:227], v48 offset:26112
  ds_read_b64_tr_b16 a[228:229], v46 offset:36864
  ds_read_b64_tr_b16 a[230:231], v46 offset:38400
  ds_read_b64_tr_b16 a[232:233], v47 offset:36864
  ds_read_b64_tr_b16 a[234:235], v47 offset:38400
  ds_read_b64_tr_b16 a[236:237], v48 offset:36864
  ds_read_b64_tr_b16 a[238:239], v48 offset:38400
  s_waitcnt lgkmcnt(0)
  s_barrier
  v_mfma_f32_16x16x32_bf16 v[64:67], a[192:195], v[160:163], v[64:67]
  ds_read_b128 v[192:195], v19 offset:0
  v_mfma_f32_16x16x32_bf16 v[68:71], a[196:199], v[160:163], v[68:71]
  v_add_u32 v18, s33, v14
  v_mfma_f32_16x16x32_bf16 v[72:75], a[200:203], v[160:163], v[72:75]
  v_mfma_f32_16x16x32_bf16 v[76:79], a[192:195], v[164:167], v[76:79]
  ds_read_b128 v[196:199], v19 offset:2048
  v_mfma_f32_16x16x32_bf16 v[80:83], a[196:199], v[164:167], v[80:83]
  buffer_load_dwordx4 v11, s[8:11], s30 offen offset:1024 lds
  v_mfma_f32_16x16x32_bf16 v[84:87], a[200:203], v[164:167], v[84:87]
  s_add_u32 s30, s30, 128
  v_mfma_f32_16x16x32_bf16 v[88:91], a[192:195], v[168:171], v[88:91]
  ds_read_b128 v[200:203], v19 offset:4096
  s_add_u32 m0, m0, 8192
  v_mfma_f32_16x16x32_bf16 v[92:95], a[196:199], v[168:171], v[92:95]
  s_cmp_lt_u32 m0, s46
  s_cselect_b32 m0, m0, s47
  v_mfma_f32_16x16x32_bf16 v[96:99], a[200:203], v[168:171], v[96:99]
  v_mfma_f32_16x16x32_bf16 v[100:103], a[192:195], v[172:175], v[100:103]
  ds_read_b128 v[204:207], v19 offset:6144
  v_mfma_f32_16x16x32_bf16 v[104:107], a[196:199], v[172:175], v[104:107]
  v_mfma_f32_16x16x32_bf16 v[108:111], a[200:203], v[172:175], v[108:111]
  s_waitcnt vmcnt(8) lgkmcnt(2)
  s_barrier
  v_mfma_f32_16x16x32_bf16 v[64:67], a[204:207], v[192:195], v[64:67]
  ds_read_b128 v[160:163], v18 offset:0
  v_mfma_f32_16x16x32_bf16 v[68:71], a[208:211], v[192:195], v[68:71]
  v_mfma_f32_16x16x32_bf16 v[72:75], a[212:215], v[192:195], v[72:75]
  v_add_u32 v19, s33, v15
  s_add_u32 s33, s33, 8192
  v_mfma_f32_16x16x32_bf16 v[76:79], a[204:207], v[196:199], v[76:79]
  ds_read_b128 v[164:167], v18 offset:2048
  v_mfma_f32_16x16x32_bf16 v[80:83], a[208:211], v[196:199], v[80:83]
  buffer_load_dwordx4 v10, s[8:11], s30 offen offset:0 lds
  v_mfma_f32_16x16x32_bf16 v[84:87], a[212:215], v[196:199], v[84:87]
  s_waitcnt lgkmcnt(2)
  v_mfma_f32_16x16x32_bf16 v[88:91], a[204:207], v[200:203], v[88:91]
  ds_read_b128 v[168:171], v18 offset:4096
  v_mfma_f32_16x16x32_bf16 v[92:95], a[208:211], v[200:203], v[92:95]
  s_cmp_lt_u32 s33, 155648
  s_cselect_b32 s33, s33, 98304
  v_mfma_f32_16x16x32_bf16 v[96:99], a[212:215], v[200:203], v[96:99]
  v_mfma_f32_16x16x32_bf16 v[100:103], a[204:207], v[204:207], v[100:103]
  ds_read_b128 v[172:175], v18 offset:6144
  v_mfma_f32_16x16x32_bf16 v[104:107], a[208:211], v[204:207], v[104:107]
  v_mfma_f32_16x16x32_bf16 v[108:111], a[212:215], v[204:207], v[108:111]
  s_waitcnt lgkmcnt(2)
  v_mfma_f32_16x16x32_bf16 v[64:67], a[216:219], v[160:163], v[64:67]
  ds_read_b128 v[192:195], v19 offset:0
  v_mfma_f32_16x16x32_bf16 v[68:71], a[220:223], v[160:163], v[68:71]
  v_add_u32 v18, s33, v14
  v_mfma_f32_16x16x32_bf16 v[72:75], a[224:227], v[160:163], v[72:75]
  v_mfma_f32_16x16x32_bf16 v[76:79], a[216:219], v[164:167], v[76:79]
  ds_read_b128 v[196:199], v19 offset:2048
  v_mfma_f32_16x16x32_bf16 v[80:83], a[220:223], v[164:167], v[80:83]
  buffer_load_dwordx4 v11, s[8:11], s30 offen offset:1024 lds
  v_mfma_f32_16x16x32_bf16 v[84:87], a[224:227], v[164:167], v[84:87]
  s_waitcnt lgkmcnt(2)
  s_add_u32 s30, s30, 128
  v_mfma_f32_16x16x32_bf16 v[88:91], a[216:219], v[168:171], v[88:91]
  ds_read_b128 v[200:203], v19 offset:4096
  s_add_u32 m0, m0, 8192
  v_mfma_f32_16x16x32_bf16 v[92:95], a[220:223], v[168:171], v[92:95]
  s_cmp_lt_u32 m0, s46
  s_cselect_b32 m0, m0, s47
  v_mfma_f32_16x16x32_bf16 v[96:99], a[224:227], v[168:171], v[96:99]
  v_mfma_f32_16x16x32_bf16 v[100:103], a[216:219], v[172:175], v[100:103]
  ds_read_b128 v[204:207], v19 offset:6144
  v_mfma_f32_16x16x32_bf16 v[104:107], a[220:223], v[172:175], v[104:107]
  v_mfma_f32_16x16x32_bf16 v[108:111], a[224:227], v[172:175], v[108:111]
  s_waitcnt vmcnt(8) lgkmcnt(2)
  s_barrier
  v_mfma_f32_16x16x32_bf16 v[64:67], a[228:231], v[192:195], v[64:67]
  ds_read_b128 v[160:163], v18 offset:0
  v_mfma_f32_16x16x32_bf16 v[68:71], a[232:235], v[192:195], v[68:71]
  v_mfma_f32_16x16x32_bf16 v[72:75], a[236:239], v[192:195], v[72:75]
  v_add_u32 v19, s33, v15
  s_add_u32 s33, s33, 8192
  v_mfma_f32_16x16x32_bf16 v[76:79], a[228:231], v[196:199], v[76:79]
  ds_read_b128 v[164:167], v18 offset:2048
  v_cvt_pk_bf16_f32 v224, v64, v65
  v_cvt_pk_bf16_f32 v225, v66, v67
  v_mfma_f32_16x16x32_bf16 v[80:83], a[232:235], v[196:199], v[80:83]
  buffer_load_dwordx4 v10, s[8:11], s30 offen offset:0 lds
  v_cvt_pk_bf16_f32 v226, v68, v69
  v_cvt_pk_bf16_f32 v227, v70, v71
  v_mfma_f32_16x16x32_bf16 v[84:87], a[236:239], v[196:199], v[84:87]
  s_waitcnt lgkmcnt(2)
  v_cvt_pk_bf16_f32 v228, v72, v73
  v_cvt_pk_bf16_f32 v229, v74, v75
  v_mfma_f32_16x16x32_bf16 v[88:91], a[228:231], v[200:203], v[88:91]
  ds_read_b128 v[168:171], v18 offset:4096
  ds_write_b64 v22, v[224:225] offset:0
  v_mfma_f32_16x16x32_bf16 v[92:95], a[232:235], v[200:203], v[92:95]
  s_cmp_lt_u32 s33, 155648
  s_cselect_b32 s33, s33, 98304
  ds_write_b64 v22, v[226:227] offset:8
  v_mfma_f32_16x16x32_bf16 v[96:99], a[236:239], v[200:203], v[96:99]
  ds_write_b64 v16, v[228:229] offset:64
  v_cvt_pk_bf16_f32 v230, v76, v77
  v_cvt_pk_bf16_f32 v231, v78, v79
  v_mfma_f32_16x16x32_bf16 v[100:103], a[228:231], v[204:207], v[100:103]
  ds_read_b128 v[172:175], v18 offset:6144
  v_cvt_pk_bf16_f32 v232, v80, v81
  v_cvt_pk_bf16_f32 v233, v82, v83
  v_cvt_pk_bf16_f32 v234, v84, v85
  v_mfma_f32_16x16x32_bf16 v[104:107], a[232:235], v[204:207], v[104:107]
  v_cvt_pk_bf16_f32 v235, v86, v87
  ds_write_b64 v22, v[230:231] offset:6400
  v_mfma_f32_16x16x32_bf16 v[108:111], a[236:239], v[204:207], v[108:111]
  ds_write_b64 v22, v[232:233] offset:6408
  ds_write_b64 v16, v[234:235] offset:6464
  v_readfirstlane_b32 s21, v29
  s_cmp_ge_u32 s21, 32
  s_cbranch_scc1 kvz_144
  s_mov_b32 s21, 76
  v_mov_b32 v4, 0
  s_mov_b32 s101, 0
wf_145:
  buffer_load_dword v5, v4, s[64:67], s21 offen sc1
  s_add_u32 s101, s101, 1
  s_cmp_gt_u32 s101, 131072
  s_cbranch_scc1 main_end
  s_waitcnt vmcnt(0)
  v_readfirstlane_b32 s100, v5
  s_cmp_ge_u32 s100, 32
  s_cbranch_scc1 wf_146
  s_sleep 8
  s_branch wf_145
wf_146:
kvz_144:
  s_branch kvm_end_143
kvm_blk_142:
  v_mfma_f32_16x16x32_bf16 v[64:67], a[0:3], v[160:163], 0
  ds_read_b128 v[192:195], v19 offset:0
  v_mfma_f32_16x16x32_bf16 v[68:71], a[4:7], v[160:163], 0
  v_add_u32 v18, s33, v14
  v_mfma_f32_16x16x32_bf16 v[72:75], a[8:11], v[160:163], 0
  v_mfma_f32_16x16x32_bf16 v[76:79], a[0:3], v[164:167], 0
  ds_read_b128 v[196:199], v19 offset:2048
  v_mfma_f32_16x16x32_bf16 v[80:83], a[4:7], v[164:167], 0
  buffer_load_dwordx4 v11, s[8:11], s30 offen offset:1024 lds
  v_mfma_f32_16x16x32_bf16 v[84:87], a[8:11], v[164:167], 0
  s_waitcnt lgkmcnt(11)
  s_add_u32 s30, s30, 128
  v_mfma_f32_16x16x32_bf16 v[88:91], a[0:3], v[168:171], 0
  ds_read_b128 v[200:203], v19 offset:4096
  s_add_u32 m0, m0, 8192
  v_mfma_f32_16x16x32_bf16 v[92:95], a[4:7], v[168:171], 0
  s_cmp_lt_u32 m0, s46
  s_cselect_b32 m0, m0, s47
  v_mfma_f32_16x16x32_bf16 v[96:99], a[8:11], v[168:171], 0
  v_mfma_f32_16x16x32_bf16 v[100:103], a[0:3], v[172:175], 0
  ds_read_b128 v[204:207], v19 offset:6144
  v_mfma_f32_16x16x32_bf16 v[104:107], a[4:7], v[172:175], 0
  v_mfma_f32_16x16x32_bf16 v[108:111], a[8:11], v[172:175], 0
  s_waitcnt vmcnt(14) lgkmcnt(2)
  s_barrier
  v_mfma_f32_16x16x32_bf16 v[64:67], a[12:15], v[192:195], v[64:67]
  ds_read_b128 v[160:163], v18 offset:0
  v_mfma_f32_16x16x32_bf16 v[68:71], a[16:19], v[192:195], v[68:71]
  v_mfma_f32_16x16x32_bf16 v[72:75], a[20:23], v[192:195], v[72:75]
  v_add_u32 v19, s33, v15
  s_add_u32 s33, s33, 8192
  v_mfma_f32_16x16x32_bf16 v[76:79], a[12:15], v[196:199], v[76:79]
  ds_read_b128 v[164:167], v18 offset:2048
  v_mfma_f32_16x16x32_bf16 v[80:83], a[16:19], v[196:199], v[80:83]
  buffer_load_dwordx4 v10, s[8:11], s30 offen offset:0 lds
  v_mfma_f32_16x16x32_bf16 v[84:87], a[20:23], v[196:199], v[84:87]
  s_waitcnt lgkmcnt(2)
  v_mfma_f32_16x16x32_bf16 v[88:91], a[12:15], v[200:203], v[88:91]
  ds_read_b128 v[168:171], v18 offset:4096
  v_mfma_f32_16x16x32_bf16 v[92:95], a[16:19], v[200:203], v[92:95]
  s_cmp_lt_u32 s33, 155648
  s_cselect_b32 s33, s33, 98304
  v_mfma_f32_16x16x32_bf16 v[96:99], a[20:23], v[200:203], v[96:99]
  v_mfma_f32_16x16x32_bf16 v[100:103], a[12:15], v[204:207], v[100:103]
  ds_read_b128 v[172:175], v18 offset:6144
  v_mfma_f32_16x16x32_bf16 v[104:107], a[16:19], v[204:207], v[104:107]
  v_mfma_f32_16x16x32_bf16 v[108:111], a[20:23], v[204:207], v[108:111]
  s_waitcnt lgkmcnt(2)
  v_mfma_f32_16x16x32_bf16 v[64:67], a[24:27], v[160:163], v[64:67]
  ds_read_b128 v[192:195], v19 offset:0
  v_mfma_f32_16x16x32_bf16 v[68:71], a[28:31], v[160:163], v[68:71]
  v_add_u32 v18, s33, v14
  v_mfma_f32_16x16x32_bf16 v[72:75], a[32:35], v[160:163], v[72:75]
  v_mfma_f32_16x16x32_bf16 v[76:79], a[24:27], v[164:167], v[76:79]
  ds_read_b128 v[196:199], v19 offset:2048
  v_mfma_f32_16x16x32_bf16 v[80:83], a[28:31], v[164:167], v[80:83]
  buffer_load_dwordx4 v11, s[8:11], s30 offen offset:1024 lds
  v_mfma_f32_16x16x32_bf16 v[84:87], a[32:35], v[164:167], v[84:87]
  s_waitcnt lgkmcnt(2)
  s_add_u32 s30, s30, 128
  v_mfma_f32_16x16x32_bf16 v[88:91], a[24:27], v[168:171], v[88:91]
  ds_read_b128 v[200:203], v19 offset:4096
  s_add_u32 m0, m0, 8192
  v_mfma_f32_16x16x32_bf16 v[92:95], a[28:31], v[168:171], v[92:95]
  s_cmp_lt_u32 m0, s46
  s_cselect_b32 m0, m0, s47
  v_mfma_f32_16x16x32_bf16 v[96:99], a[32:35], v[168:171], v[96:99]
  v_mfma_f32_16x16x32_bf16 v[100:103], a[24:27], v[172:175], v[100:103]
  ds_read_b128 v[204:207], v19 offset:6144
  v_mfma_f32_16x16x32_bf16 v[104:107], a[28:31], v[172:175], v[104:107]
  v_mfma_f32_16x16x32_bf16 v[108:111], a[32:35], v[172:175], v[108:111]
  s_waitcnt vmcnt(14) lgkmcnt(2)
  s_barrier
  v_mfma_f32_16x16x32_bf16 v[64:67], a[36:39], v[192:195], v[64:67]
  ds_read_b128 v[160:163], v18 offset:0
  v_mfma_f32_16x16x32_bf16 v[68:71], a[40:43], v[192:195], v[68:71]
  v_mfma_f32_16x16x32_bf16 v[72:75], a[44:47], v[192:195], v[72:75]
  v_add_u32 v19, s33, v15
  s_add_u32 s33, s33, 8192
  v_mfma_f32_16x16x32_bf16 v[76:79], a[36:39], v[196:199], v[76:79]
  ds_read_b128 v[164:167], v18 offset:2048
  v_mfma_f32_16x16x32_bf16 v[80:83], a[40:43], v[196:199], v[80:83]
  buffer_load_dwordx4 v10, s[8:11], s30 offen offset:0 lds
  v_mfma_f32_16x16x32_bf16 v[84:87], a[44:47], v[196:199], v[84:87]
  s_waitcnt lgkmcnt(2)
  v_mfma_f32_16x16x32_bf16 v[88:91], a[36:39], v[200:203], v[88:91]
  ds_read_b128 v[168:171], v18 offset:4096
  v_mfma_f32_16x16x32_bf16 v[92:95], a[40:43], v[200:203], v[92:95]
  s_cmp_lt_u32 s33, 155648
  s_cselect_b32 s33, s33, 98304
  v_mfma_f32_16x16x32_bf16 v[96:99], a[44:47], v[200:203], v[96:99]
  v_mfma_f32_16x16x32_bf16 v[100:103], a[36:39], v[204:207], v[100:103]
  ds_read_b128 v[172:175], v18 offset:6144
  v_mfma_f32_16x16x32_bf16 v[104:107], a[40:43], v[204:207], v[104:107]
  v_mfma_f32_16x16x32_bf16 v[108:111], a[44:47], v[204:207], v[108:111]
  s_waitcnt lgkmcnt(2)
  v_mfma_f32_16x16x32_bf16 v[64:67], a[48:51], v[160:163], v[64:67]
  ds_read_b128 v[192:195], v19 offset:0
  v_mfma_f32_16x16x32_bf16 v[68:71], a[52:55], v[160:163], v[68:71]
  v_add_u32 v18, s33, v14
  v_mfma_f32_16x16x32_bf16 v[72:75], a[56:59], v[160:163], v[72:75]
  v_mfma_f32_16x16x32_bf16 v[76:79], a[48:51], v[164:167], v[76:79]
  ds_read_b128 v[196:199], v19 offset:2048
  v_mfma_f32_16x16x32_bf16 v[80:83], a[52:55], v[164:167], v[80:83]
  buffer_load_dwordx4 v11, s[8:11], s30 offen offset:1024 lds
  v_mfma_f32_16x16x32_bf16 v[84:87], a[56:59], v[164:167], v[84:87]
  s_waitcnt lgkmcnt(2)
  s_add_u32 s30, s30, 128
  v_mfma_f32_16x16x32_bf16 v[88:91], a[48:51], v[168:171], v[88:91]
  ds_read_b128 v[200:203], v19 offset:4096
  s_add_u32 m0, m0, 8192
  v_mfma_f32_16x16x32_bf16 v[92:95], a[52:55], v[168:171], v[92:95]
  s_cmp_lt_u32 m0, s46
  s_cselect_b32 m0, m0, s47
  v_mfma_f32_16x16x32_bf16 v[96:99], a[56:59], v[168:171], v[96:99]
  v_mfma_f32_16x16x32_bf16 v[100:103], a[48:51], v[172:175], v[100:103]
  ds_read_b128 v[204:207], v19 offset:6144
  v_mfma_f32_16x16x32_bf16 v[104:107], a[52:55], v[172:175], v[104:107]
  v_mfma_f32_16x16x32_bf16 v[108:111], a[56:59], v[172:175], v[108:111]
  s_waitcnt vmcnt(14) lgkmcnt(2)
  s_barrier
  v_mfma_f32_16x16x32_bf16 v[64:67], a[60:63], v[192:195], v[64:67]
  ds_read_b128 v[160:163], v18 offset:0
  v_mfma_f32_16x16x32_bf16 v[68:71], a[64:67], v[192:195], v[68:71]
  v_mfma_f32_16x16x32_bf16 v[72:75], a[68:71], v[192:195], v[72:75]
  v_add_u32 v19, s33, v15
  s_add_u32 s33, s33, 8192
  v_mfma_f32_16x16x32_bf16 v[76:79], a[60:63], v[196:199], v[76:79]
  ds_read_b128 v[164:167], v18 offset:2048
  v_mfma_f32_16x16x32_bf16 v[80:83], a[64:67], v[196:199], v[80:83]
  buffer_load_dwordx4 v10, s[8:11], s30 offen offset:0 lds
  v_mfma_f32_16x16x32_bf16 v[84:87], a[68:71], v[196:199], v[84:87]
  s_waitcnt lgkmcnt(2)
  v_mfma_f32_16x16x32_bf16 v[88:91], a[60:63], v[200:203], v[88:91]
  ds_read_b128 v[168:171], v18 offset:4096
  v_mfma_f32_16x16x32_bf16 v[92:95], a[64:67], v[200:203], v[92:95]
  s_cmp_lt_u32 s33, 155648
  s_cselect_b32 s33, s33, 98304
  v_mfma_f32_16x16x32_bf16 v[96:99], a[68:71], v[200:203], v[96:99]
  v_mfma_f32_16x16x32_bf16 v[100:103], a[60:63], v[204:207], v[100:103]
  ds_read_b128 v[172:175], v18 offset:6144
  v_mfma_f32_16x16x32_bf16 v[104:107], a[64:67], v[204:207], v[104:107]
  v_mfma_f32_16x16x32_bf16 v[108:111], a[68:71], v[204:207], v[108:111]
  s_waitcnt lgkmcnt(2)
  v_mfma_f32_16x16x32_bf16 v[64:67], a[72:75], v[160:163], v[64:67]
  ds_read_b128 v[192:195], v19 offset:0
  v_mfma_f32_16x16x32_bf16 v[68:71], a[76:79], v[160:163], v[68:71]
  v_add_u32 v18, s33, v14
  v_mfma_f32_16x16x32_bf16 v[72:75], a[80:83], v[160:163], v[72:75]
  v_mfma_f32_16x16x32_bf16 v[76:79], a[72:75], v[164:167], v[76:79]
  ds_read_b128 v[196:199], v19 offset:2048
  v_mfma_f32_16x16x32_bf16 v[80:83], a[76:79], v[164:167], v[80:83]
  buffer_load_dwordx4 v11, s[8:11], s30 offen offset:1024 lds
  v_mfma_f32_16x16x32_bf16 v[84:87], a[80:83], v[164:167], v[84:87]
  s_waitcnt lgkmcnt(2)
  s_add_u32 s30, s30, 128
  v_mfma_f32_16x16x32_bf16 v[88:91], a[72:75], v[168:171], v[88:91]
  ds_read_b128 v[200:203], v19 offset:4096
  s_add_u32 m0, m0, 8192
  v_mfma_f32_16x16x32_bf16 v[92:95], a[76:79], v[168:171], v[92:95]
  s_cmp_lt_u32 m0, s46
  s_cselect_b32 m0, m0, s47
  v_mfma_f32_16x16x32_bf16 v[96:99], a[80:83], v[168:171], v[96:99]
  v_mfma_f32_16x16x32_bf16 v[100:103], a[72:75], v[172:175], v[100:103]
  ds_read_b128 v[204:207], v19 offset:6144
  v_mfma_f32_16x16x32_bf16 v[104:107], a[76:79], v[172:175], v[104:107]
  v_mfma_f32_16x16x32_bf16 v[108:111], a[80:83], v[172:175], v[108:111]
  s_waitcnt vmcnt(7) lgkmcnt(2)
  s_barrier
  v_mfma_f32_16x16x32_bf16 v[64:67], a[84:87], v[192:195], v[64:67]
  ds_read_b128 v[160:163], v18 offset:0
  v_mfma_f32_16x16x32_bf16 v[68:71], a[88:91], v[192:195], v[68:71]
  s_cmp_eq_u32 s48, 0x80000000
  s_cbranch_scc1 kvm_140
  s_cmp_lg_u32 s20, 0
  s_cbranch_scc1 af_141
  v_mov_b32 v4, 0
  v_mov_b32 v5, 1
  s_mov_b64 exec, 1
  buffer_atomic_add v5, v4, s[72:75], s61 offen sc1
  s_mov_b64 exec, -1
  s_nop 1
af_141:
kvm_140:
  v_mfma_f32_16x16x32_bf16 v[72:75], a[92:95], v[192:195], v[72:75]
  v_add_u32 v19, s33, v15
  s_add_u32 s33, s33, 8192
  v_mfma_f32_16x16x32_bf16 v[76:79], a[84:87], v[196:199], v[76:79]
  ds_read_b128 v[164:167], v18 offset:2048
  v_mfma_f32_16x16x32_bf16 v[80:83], a[88:91], v[196:199], v[80:83]
  buffer_load_dwordx4 v10, s[8:11], s30 offen offset:0 lds
  v_mfma_f32_16x16x32_bf16 v[84:87], a[92:95], v[196:199], v[84:87]
  s_waitcnt lgkmcnt(2)
  v_mfma_f32_16x16x32_bf16 v[88:91], a[84:87], v[200:203], v[88:91]
  ds_read_b128 v[168:171], v18 offset:4096
  v_mfma_f32_16x16x32_bf16 v[92:95], a[88:91], v[200:203], v[92:95]
  s_cmp_lt_u32 s33, 155648
  s_cselect_b32 s33, s33, 98304
  v_mfma_f32_16x16x32_bf16 v[96:99], a[92:95], v[200:203], v[96:99]
  v_mfma_f32_16x16x32_bf16 v[100:103], a[84:87], v[204:207], v[100:103]
  ds_read_b128 v[172:175], v18 offset:6144
  v_mfma_f32_16x16x32_bf16 v[104:107], a[88:91], v[204:207], v[104:107]
  v_mfma_f32_16x16x32_bf16 v[108:111], a[92:95], v[204:207], v[108:111]
  s_waitcnt lgkmcnt(2)
  v_mfma_f32_16x16x32_bf16 v[64:67], a[96:99], v[160:163], v[64:67]
  ds_read_b128 v[192:195], v19 offset:0
  v_mfma_f32_16x16x32_bf16 v[68:71], a[100:103], v[160:163], v[68:71]
  v_add_u32 v18, s33, v14
  s_mov_b32 s61, s60
  v_mfma_f32_16x16x32_bf16 v[72:75], a[104:107], v[160:163], v[72:75]
  s_add_u32 s60, s60, s62
  s_lshr_b32 s48, s20, 1
  v_mfma_f32_16x16x32_bf16 v[76:79], a[96:99], v[164:167], v[76:79]
  ds_read_b128 v[196:199], v19 offset:2048
  s_mul_i32 s48, s48, 393216
  v_mfma_f32_16x16x32_bf16 v[80:83], a[100:103], v[164:167], v[80:83]
  buffer_load_dwordx4 v11, s[8:11], s30 offen offset:1024 lds
  v_mfma_f32_16x16x32_bf16 v[84:87], a[104:107], v[164:167], v[84:87]
  s_waitcnt lgkmcnt(2)
  s_add_u32 s30, s30, s25
  v_mfma_f32_16x16x32_bf16 v[88:91], a[96:99], v[168:171], v[88:91]
  ds_read_b128 v[200:203], v19 offset:4096
  s_sub_u32 s30, s30, 1152
  v_mfma_f32_16x16x32_bf16 v[92:95], a[100:103], v[168:171], v[92:95]
  s_add_u32 m0, m0, 8192
  s_and_b32 s21, s20, 1
  v_mfma_f32_16x16x32_bf16 v[96:99], a[104:107], v[168:171], v[96:99]
  s_cmp_lt_u32 m0, s46
  s_cselect_b32 m0, m0, s47
  v_mfma_f32_16x16x32_bf16 v[100:103], a[96:99], v[172:175], v[100:103]
  ds_read_b128 v[204:207], v19 offset:6144
  s_mul_i32 s21, s21, 6144
  v_mfma_f32_16x16x32_bf16 v[104:107], a[100:103], v[172:175], v[104:107]
  s_add_u32 s48, s48, s21
  s_add_u32 s48, s48, s27
  v_mfma_f32_16x16x32_bf16 v[108:111], a[104:107], v[172:175], v[108:111]
  s_waitcnt vmcnt(8) lgkmcnt(2)
  s_barrier
  v_mfma_f32_16x16x32_bf16 v[64:67], a[108:111], v[192:195], v[64:67]
  ds_read_b128 v[160:163], v18 offset:0
  s_add_u32 s27, s27, s28
  v_mfma_f32_16x16x32_bf16 v[68:71], a[112:115], v[192:195], v[68:71]
  s_sub_u32 s26, s26, 1
  v_mfma_f32_16x16x32_bf16 v[72:75], a[116:119], v[192:195], v[72:75]
  v_add_u32 v19, s33, v15
  s_add_u32 s33, s33, 8192
  v_mfma_f32_16x16x32_bf16 v[76:79], a[108:111], v[196:199], v[76:79]
  ds_read_b128 v[164:167], v18 offset:2048
  v_mfma_f32_16x16x32_bf16 v[80:83], a[112:115], v[196:199], v[80:83]
  buffer_load_dwordx4 v10, s[8:11], s30 offen offset:0 lds
  v_mfma_f32_16x16x32_bf16 v[84:87], a[116:119], v[196:199], v[84:87]
  s_waitcnt lgkmcnt(2)
  v_mfma_f32_16x16x32_bf16 v[88:91], a[108:111], v[200:203], v[88:91]
  ds_read_b128 v[168:171], v18 offset:4096
  v_mfma_f32_16x16x32_bf16 v[92:95], a[112:115], v[200:203], v[92:95]
  s_cmp_lt_u32 s33, 155648
  s_cselect_b32 s33, s33, 98304
  v_mfma_f32_16x16x32_bf16 v[96:99], a[116:119], v[200:203], v[96:99]
  v_mfma_f32_16x16x32_bf16 v[100:103], a[108:111], v[204:207], v[100:103]
  ds_read_b128 v[172:175], v18 offset:6144
  v_mfma_f32_16x16x32_bf16 v[104:107], a[112:115], v[204:207], v[104:107]
  v_mfma_f32_16x16x32_bf16 v[108:111], a[116:119], v[204:207], v[108:111]
  s_waitcnt lgkmcnt(2)
  v_mfma_f32_16x16x32_bf16 v[64:67], a[120:123], v[160:163], v[64:67]
  ds_read_b128 v[192:195], v19 offset:0
  v_mfma_f32_16x16x32_bf16 v[68:71], a[124:127], v[160:163], v[68:71]
  v_add_u32 v18, s33, v14
  v_mfma_f32_16x16x32_bf16 v[72:75], a[128:131], v[160:163], v[72:75]
  v_mfma_f32_16x16x32_bf16 v[76:79], a[120:123], v[164:167], v[76:79]
  ds_read_b128 v[196:199], v19 offset:2048
  v_mfma_f32_16x16x32_bf16 v[80:83], a[124:127], v[164:167], v[80:83]
  buffer_load_dwordx4 v11, s[8:11], s30 offen offset:1024 lds
  v_mfma_f32_16x16x32_bf16 v[84:87], a[128:131], v[164:167], v[84:87]
  s_waitcnt lgkmcnt(2)
  s_add_u32 s30, s30, 128
  v_mfma_f32_16x16x32_bf16 v[88:91], a[120:123], v[168:171], v[88:91]
  ds_read_b128 v[200:203], v19 offset:4096
  s_add_u32 m0, m0, 8192
  v_mfma_f32_16x16x32_bf16 v[92:95], a[124:127], v[168:171], v[92:95]
  s_cmp_lt_u32 m0, s46
  s_cselect_b32 m0, m0, s47
  v_mfma_f32_16x16x32_bf16 v[96:99], a[128:131], v[168:171], v[96:99]
  v_mfma_f32_16x16x32_bf16 v[100:103], a[120:123], v[172:175], v[100:103]
  ds_read_b128 v[204:207], v19 offset:6144
  v_mfma_f32_16x16x32_bf16 v[104:107], a[124:127], v[172:175], v[104:107]
  v_mfma_f32_16x16x32_bf16 v[108:111], a[128:131], v[172:175], v[108:111]
  s_waitcnt vmcnt(8) lgkmcnt(2)
  s_barrier
  v_mfma_f32_16x16x32_bf16 v[64:67], a[132:135], v[192:195], v[64:67]
  ds_read_b128 v[160:163], v18 offset:0
  v_mfma_f32_16x16x32_bf16 v[68:71], a[136:139], v[192:195], v[68:71]
  v_mfma_f32_16x16x32_bf16 v[72:75], a[140:143], v[192:195], v[72:75]
  v_add_u32 v19, s33, v15
  s_add_u32 s33, s33, 8192
  v_mfma_f32_16x16x32_bf16 v[76:79], a[132:135], v[196:199], v[76:79]
  ds_read_b128 v[164:167], v18 offset:2048
  v_mfma_f32_16x16x32_bf16 v[80:83], a[136:139], v[196:199], v[80:83]
  buffer_load_dwordx4 v10, s[8:11], s30 offen offset:0 lds
  v_mfma_f32_16x16x32_bf16 v[84:87], a[140:143], v[196:199], v[84:87]
  s_waitcnt lgkmcnt(2)
  v_mfma_f32_16x16x32_bf16 v[88:91], a[132:135], v[200:203], v[88:91]
  ds_read_b128 v[168:171], v18 offset:4096
  v_mfma_f32_16x16x32_bf16 v[92:95], a[136:139], v[200:203], v[92:95]
  s_cmp_lt_u32 s33, 155648
  s_cselect_b32 s33, s33, 98304
  v_mfma_f32_16x16x32_bf16 v[96:99], a[140:143], v[200:203], v[96:99]
  v_mfma_f32_16x16x32_bf16 v[100:103], a[132:135], v[204:207], v[100:103]
  ds_read_b128 v[172:175], v18 offset:6144
  v_mfma_f32_16x16x32_bf16 v[104:107], a[136:139], v[204:207], v[104:107]
  v_mfma_f32_16x16x32_bf16 v[108:111], a[140:143], v[204:207], v[108:111]
  s_waitcnt lgkmcnt(2)
  v_mfma_f32_16x16x32_bf16 v[64:67], a[144:147], v[160:163], v[64:67]
  ds_read_b128 v[192:195], v19 offset:0
  v_mfma_f32_16x16x32_bf16 v[68:71], a[148:151], v[160:163], v[68:71]
  v_add_u32 v18, s33, v14
  v_mfma_f32_16x16x32_bf16 v[72:75], a[152:155], v[160:163], v[72:75]
  v_mfma_f32_16x16x32_bf16 v[76:79], a[144:147], v[164:167], v[76:79]
  ds_read_b128 v[196:199], v19 offset:2048
  v_mfma_f32_16x16x32_bf16 v[80:83], a[148:151], v[164:167], v[80:83]
  buffer_load_dwordx4 v11, s[8:11], s30 offen offset:1024 lds
  v_mfma_f32_16x16x32_bf16 v[84:87], a[152:155], v[164:167], v[84:87]
  s_waitcnt lgkmcnt(2)
  s_add_u32 s30, s30, 128
  v_mfma_f32_16x16x32_bf16 v[88:91], a[144:147], v[168:171], v[88:91]
  ds_read_b128 v[200:203], v19 offset:4096
  s_add_u32 m0, m0, 8192
  v_mfma_f32_16x16x32_bf16 v[92:95], a[148:151], v[168:171], v[92:95]
  s_cmp_lt_u32 m0, s46
  s_cselect_b32 m0, m0, s47
  v_mfma_f32_16x16x32_bf16 v[96:99], a[152:155], v[168:171], v[96:99]
  v_mfma_f32_16x16x32_bf16 v[100:103], a[144:147], v[172:175], v[100:103]
  ds_read_b128 v[204:207], v19 offset:6144
  v_mfma_f32_16x16x32_bf16 v[104:107], a[148:151], v[172:175], v[104:107]
  v_mfma_f32_16x16x32_bf16 v[108:111], a[152:155], v[172:175], v[108:111]
  s_waitcnt vmcnt(8) lgkmcnt(2)
  s_barrier
  v_mfma_f32_16x16x32_bf16 v[64:67], a[156:159], v[192:195], v[64:67]
  ds_read_b128 v[160:163], v18 offset:0
  v_mfma_f32_16x16x32_bf16 v[68:71], a[160:163], v[192:195], v[68:71]
  v_mfma_f32_16x16x32_bf16 v[72:75], a[164:167], v[192:195], v[72:75]
  v_add_u32 v19, s33, v15
  s_add_u32 s33, s33, 8192
  v_mfma_f32_16x16x32_bf16 v[76:79], a[156:159], v[196:199], v[76:79]
  ds_read_b128 v[164:167], v18 offset:2048
  v_mfma_f32_16x16x32_bf16 v[80:83], a[160:163], v[196:199], v[80:83]
  buffer_load_dwordx4 v10, s[8:11], s30 offen offset:0 lds
  v_mfma_f32_16x16x32_bf16 v[84:87], a[164:167], v[196:199], v[84:87]
  s_waitcnt lgkmcnt(2)
  v_mfma_f32_16x16x32_bf16 v[88:91], a[156:159], v[200:203], v[88:91]
  ds_read_b128 v[168:171], v18 offset:4096
  v_mfma_f32_16x16x32_bf16 v[92:95], a[160:163], v[200:203], v[92:95]
  s_cmp_lt_u32 s33, 155648
  s_cselect_b32 s33, s33, 98304
  v_mfma_f32_16x16x32_bf16 v[96:99], a[164:167], v[200:203], v[96:99]
  v_mfma_f32_16x16x32_bf16 v[100:103], a[156:159], v[204:207], v[100:103]
  ds_read_b128 v[172:175], v18 offset:6144
  v_mfma_f32_16x16x32_bf16 v[104:107], a[160:163], v[204:207], v[104:107]
  v_mfma_f32_16x16x32_bf16 v[108:111], a[164:167], v[204:207], v[108:111]
  s_waitcnt lgkmcnt(2)
  v_mfma_f32_16x16x32_bf16 v[64:67], a[168:171], v[160:163], v[64:67]
  ds_read_b128 v[192:195], v19 offset:0
  v_mfma_f32_16x16x32_bf16 v[68:71], a[172:175], v[160:163], v[68:71]
  v_add_u32 v18, s33, v14
  v_mfma_f32_16x16x32_bf16 v[72:75], a[176:179], v[160:163], v[72:75]
  v_mfma_f32_16x16x32_bf16 v[76:79], a[168:171], v[164:167], v[76:79]
  ds_read_b128 v[196:199], v19 offset:2048
  v_mfma_f32_16x16x32_bf16 v[80:83], a[172:175], v[164:167], v[80:83]
  buffer_load_dwordx4 v11, s[8:11], s30 offen offset:1024 lds
  v_mfma_f32_16x16x32_bf16 v[84:87], a[176:179], v[164:167], v[84:87]
  s_waitcnt lgkmcnt(2)
  s_add_u32 s30, s30, 128
  v_mfma_f32_16x16x32_bf16 v[88:91], a[168:171], v[168:171], v[88:91]
  ds_read_b128 v[200:203], v19 offset:4096
  s_add_u32 m0, m0, 8192
  v_mfma_f32_16x16x32_bf16 v[92:95], a[172:175], v[168:171], v[92:95]
  s_cmp_lt_u32 m0, s46
  s_cselect_b32 m0, m0, s47
  v_mfma_f32_16x16x32_bf16 v[96:99], a[176:179], v[168:171], v[96:99]
  v_mfma_f32_16x16x32_bf16 v[100:103], a[168:171], v[172:175], v[100:103]
  ds_read_b128 v[204:207], v19 offset:6144
  v_mfma_f32_16x16x32_bf16 v[104:107], a[172:175], v[172:175], v[104:107]
  v_mfma_f32_16x16x32_bf16 v[108:111], a[176:179], v[172:175], v[108:111]
  s_waitcnt vmcnt(8) lgkmcnt(2)
  s_barrier
  v_mfma_f32_16x16x32_bf16 v[64:67], a[180:183], v[192:195], v[64:67]
  ds_read_b128 v[160:163], v18 offset:0
  v_mfma_f32_16x16x32_bf16 v[68:71], a[184:187], v[192:195], v[68:71]
  v_mfma_f32_16x16x32_bf16 v[72:75], a[188:191], v[192:195], v[72:75]
  v_add_u32 v19, s33, v15
  s_add_u32 s33, s33, 8192
  v_mfma_f32_16x16x32_bf16 v[76:79], a[180:183], v[196:199], v[76:79]
  ds_read_b128 v[164:167], v18 offset:2048
  v_mfma_f32_16x16x32_bf16 v[80:83], a[184:187], v[196:199], v[80:83]
  buffer_load_dwordx4 v10, s[8:11], s30 offen offset:0 lds
  v_mfma_f32_16x16x32_bf16 v[84:87], a[188:191], v[196:199], v[84:87]
  s_waitcnt lgkmcnt(2)
  v_mfma_f32_16x16x32_bf16 v[88:91], a[180:183], v[200:203], v[88:91]
  ds_read_b128 v[168:171], v18 offset:4096
  v_mfma_f32_16x16x32_bf16 v[92:95], a[184:187], v[200:203], v[92:95]
  s_cmp_lt_u32 s33, 155648
  s_cselect_b32 s33, s33, 98304
  v_mfma_f32_16x16x32_bf16 v[96:99], a[188:191], v[200:203], v[96:99]
  v_mfma_f32_16x16x32_bf16 v[100:103], a[180:183], v[204:207], v[100:103]
  ds_read_b128 v[172:175], v18 offset:6144
  v_mfma_f32_16x16x32_bf16 v[104:107], a[184:187], v[204:207], v[104:107]
  v_mfma_f32_16x16x32_bf16 v[108:111], a[188:191], v[204:207], v[108:111]
  s_waitcnt lgkmcnt(2)
  v_mfma_f32_16x16x32_bf16 v[64:67], a[192:195], v[160:163], v[64:67]
  ds_read_b128 v[192:195], v19 offset:0
  v_mfma_f32_16x16x32_bf16 v[68:71], a[196:199], v[160:163], v[68:71]
  v_add_u32 v18, s33, v14
  v_mfma_f32_16x16x32_bf16 v[72:75], a[200:203], v[160:163], v[72:75]
  v_mfma_f32_16x16x32_bf16 v[76:79], a[192:195], v[164:167], v[76:79]
  ds_read_b128 v[196:199], v19 offset:2048
  v_mfma_f32_16x16x32_bf16 v[80:83], a[196:199], v[164:167], v[80:83]
  buffer_load_dwordx4 v11, s[8:11], s30 offen offset:1024 lds
  v_mfma_f32_16x16x32_bf16 v[84:87], a[200:203], v[164:167], v[84:87]
  s_waitcnt lgkmcnt(2)
  s_add_u32 s30, s30, 128
  v_mfma_f32_16x16x32_bf16 v[88:91], a[192:195], v[168:171], v[88:91]
  ds_read_b128 v[200:203], v19 offset:4096
  s_add_u32 m0, m0, 8192
  v_mfma_f32_16x16x32_bf16 v[92:95], a[196:199], v[168:171], v[92:95]
  s_cmp_lt_u32 m0, s46
  s_cselect_b32 m0, m0, s47
  v_mfma_f32_16x16x32_bf16 v[96:99], a[200:203], v[168:171], v[96:99]
  v_mfma_f32_16x16x32_bf16 v[100:103], a[192:195], v[172:175], v[100:103]
  ds_read_b128 v[204:207], v19 offset:6144
  v_mfma_f32_16x16x32_bf16 v[104:107], a[196:199], v[172:175], v[104:107]
  v_mfma_f32_16x16x32_bf16 v[108:111], a[200:203], v[172:175], v[108:111]
  s_waitcnt vmcnt(8) lgkmcnt(2)
  s_barrier
  v_mfma_f32_16x16x32_bf16 v[64:67], a[204:207], v[192:195], v[64:67]
  ds_read_b128 v[160:163], v18 offset:0
  v_mfma_f32_16x16x32_bf16 v[68:71], a[208:211], v[192:195], v[68:71]
  v_mfma_f32_16x16x32_bf16 v[72:75], a[212:215], v[192:195], v[72:75]
  v_add_u32 v19, s33, v15
  s_add_u32 s33, s33, 8192
  v_mfma_f32_16x16x32_bf16 v[76:79], a[204:207], v[196:199], v[76:79]
  ds_read_b128 v[164:167], v18 offset:2048
  v_mfma_f32_16x16x32_bf16 v[80:83], a[208:211], v[196:199], v[80:83]
  buffer_load_dwordx4 v10, s[8:11], s30 offen offset:0 lds
  v_mfma_f32_16x16x32_bf16 v[84:87], a[212:215], v[196:199], v[84:87]
  s_waitcnt lgkmcnt(2)
  v_mfma_f32_16x16x32_bf16 v[88:91], a[204:207], v[200:203], v[88:91]
  ds_read_b128 v[168:171], v18 offset:4096
  v_mfma_f32_16x16x32_bf16 v[92:95], a[208:211], v[200:203], v[92:95]
  s_cmp_lt_u32 s33, 155648
  s_cselect_b32 s33, s33, 98304
  v_mfma_f32_16x16x32_bf16 v[96:99], a[212:215], v[200:203], v[96:99]
  v_mfma_f32_16x16x32_bf16 v[100:103], a[204:207], v[204:207], v[100:103]
  ds_read_b128 v[172:175], v18 offset:6144
  v_mfma_f32_16x16x32_bf16 v[104:107], a[208:211], v[204:207], v[104:107]
  v_mfma_f32_16x16x32_bf16 v[108:111], a[212:215], v[204:207], v[108:111]
  s_waitcnt lgkmcnt(2)
  v_mfma_f32_16x16x32_bf16 v[64:67], a[216:219], v[160:163], v[64:67]
  ds_read_b128 v[192:195], v19 offset:0
  v_mfma_f32_16x16x32_bf16 v[68:71], a[220:223], v[160:163], v[68:71]
  v_add_u32 v18, s33, v14
  v_mfma_f32_16x16x32_bf16 v[72:75], a[224:227], v[160:163], v[72:75]
  v_mfma_f32_16x16x32_bf16 v[76:79], a[216:219], v[164:167], v[76:79]
  ds_read_b128 v[196:199], v19 offset:2048
  v_mfma_f32_16x16x32_bf16 v[80:83], a[220:223], v[164:167], v[80:83]
  buffer_load_dwordx4 v11, s[8:11], s30 offen offset:1024 lds
  v_mfma_f32_16x16x32_bf16 v[84:87], a[224:227], v[164:167], v[84:87]
  s_waitcnt lgkmcnt(2)
  s_add_u32 s30, s30, 128
  v_mfma_f32_16x16x32_bf16 v[88:91], a[216:219], v[168:171], v[88:91]
  ds_read_b128 v[200:203], v19 offset:4096
  s_add_u32 m0, m0, 8192
  v_mfma_f32_16x16x32_bf16 v[92:95], a[220:223], v[168:171], v[92:95]
  s_cmp_lt_u32 m0, s46
  s_cselect_b32 m0, m0, s47
  v_mfma_f32_16x16x32_bf16 v[96:99], a[224:227], v[168:171], v[96:99]
  v_mfma_f32_16x16x32_bf16 v[100:103], a[216:219], v[172:175], v[100:103]
  ds_read_b128 v[204:207], v19 offset:6144
  v_mfma_f32_16x16x32_bf16 v[104:107], a[220:223], v[172:175], v[104:107]
  v_mfma_f32_16x16x32_bf16 v[108:111], a[224:227], v[172:175], v[108:111]
  s_waitcnt vmcnt(8) lgkmcnt(2)
  s_barrier
  v_mfma_f32_16x16x32_bf16 v[64:67], a[228:231], v[192:195], v[64:67]
  ds_read_b128 v[160:163], v18 offset:0
  v_mfma_f32_16x16x32_bf16 v[68:71], a[232:235], v[192:195], v[68:71]
  v_mfma_f32_16x16x32_bf16 v[72:75], a[236:239], v[192:195], v[72:75]
  v_add_u32 v19, s33, v15
  s_add_u32 s33, s33, 8192
  v_mfma_f32_16x16x32_bf16 v[76:79], a[228:231], v[196:199], v[76:79]
  ds_read_b128 v[164:167], v18 offset:2048
  v_cvt_pk_bf16_f32 v224, v64, v65
  v_cvt_pk_bf16_f32 v225, v66, v67
  v_mfma_f32_16x16x32_bf16 v[80:83], a[232:235], v[196:199], v[80:83]
  buffer_load_dwordx4 v10, s[8:11], s30 offen offset:0 lds
  v_cvt_pk_bf16_f32 v226, v68, v69
  v_cvt_pk_bf16_f32 v227, v70, v71
  v_mfma_f32_16x16x32_bf16 v[84:87], a[236:239], v[196:199], v[84:87]
  s_waitcnt lgkmcnt(2)
  v_cvt_pk_bf16_f32 v228, v72, v73
  v_cvt_pk_bf16_f32 v229, v74, v75
  v_mfma_f32_16x16x32_bf16 v[88:91], a[228:231], v[200:203], v[88:91]
  ds_read_b128 v[168:171], v18 offset:4096
  ds_write_b64 v22, v[224:225] offset:0
  v_mfma_f32_16x16x32_bf16 v[92:95], a[232:235], v[200:203], v[92:95]
  s_cmp_lt_u32 s33, 155648
  s_cselect_b32 s33, s33, 98304
  ds_write_b64 v22, v[226:227] offset:8
  v_mfma_f32_16x16x32_bf16 v[96:99], a[236:239], v[200:203], v[96:99]
  ds_write_b64 v16, v[228:229] offset:64
  v_cvt_pk_bf16_f32 v230, v76, v77
  v_cvt_pk_bf16_f32 v231, v78, v79
  v_mfma_f32_16x16x32_bf16 v[100:103], a[228:231], v[204:207], v[100:103]
  ds_read_b128 v[172:175], v18 offset:6144
  v_cvt_pk_bf16_f32 v232, v80, v81
  v_cvt_pk_bf16_f32 v233, v82, v83
  v_cvt_pk_bf16_f32 v234, v84, v85
  v_mfma_f32_16x16x32_bf16 v[104:107], a[232:235], v[204:207], v[104:107]
  v_cvt_pk_bf16_f32 v235, v86, v87
  ds_write_b64 v22, v[230:231] offset:6400
  v_mfma_f32_16x16x32_bf16 v[108:111], a[236:239], v[204:207], v[108:111]
  ds_write_b64 v22, v[232:233] offset:6408
  ds_write_b64 v16, v[234:235] offset:6464
kvm_end_143:
  v_cvt_pk_bf16_f32 v236, v88, v89
  v_cvt_pk_bf16_f32 v237, v90, v91
  v_cvt_pk_bf16_f32 v238, v92, v93
  v_cvt_pk_bf16_f32 v239, v94, v95
  v_cvt_pk_bf16_f32 v240, v96, v97
  v_cvt_pk_bf16_f32 v241, v98, v99
  ds_write_b64 v22, v[236:237] offset:12800
  ds_write_b64 v22, v[238:239] offset:12808
  ds_write_b64 v16, v[240:241] offset:12864
  v_cvt_pk_bf16_f32 v242, v100, v101
  v_cvt_pk_bf16_f32 v243, v102, v103
  v_cvt_pk_bf16_f32 v244, v104, v105
  v_cvt_pk_bf16_f32 v245, v106, v107
  v_cvt_pk_bf16_f32 v246, v108, v109
  v_cvt_pk_bf16_f32 v247, v110, v111
  ds_write_b64 v22, v[242:243] offset:19200
  ds_write_b64 v22, v[244:245] offset:19208
  ds_write_b64 v16, v[246:247] offset:19264
  s_waitcnt lgkmcnt(0)
  s_barrier
  ds_read_b128 v[224:227], v23 offset:0
  ds_read_b128 v[228:231], v23 offset:64
  ds_read_b128 v[232:235], v23 offset:128
  ds_read_b128 v[236:239], v23 offset:192
  ds_read_b128 v[240:243], v23 offset:256
  ds_read_b128 v[244:247], v23 offset:320
  s_waitcnt lgkmcnt(0)
  s_add_u32 s21, s48, 0
  buffer_store_dwordx4 v[224:227], v26, s[16:19], s21 offen offset:0 sc1
  buffer_store_dwordx4 v[228:231], v26, s[16:19], s21 offen offset:1024 sc1
  buffer_store_dwordx4 v[232:235], v26, s[16:19], s21 offen offset:2048 sc1
  buffer_store_dwordx4 v[236:239], v26, s[16:19], s21 offen offset:3072 sc1
  s_add_u32 s21, s48, 4096
  buffer_store_dwordx4 v[240:243], v26, s[16:19], s21 offen offset:0 sc1
  buffer_store_dwordx4 v[244:247], v26, s[16:19], s21 offen offset:1024 sc1
  s_nop 1
  s_cmp_gt_u32 s26, 0
  s_cbranch_scc1 kvm_blk_142
  s_waitcnt vmcnt(6)
  s_barrier
  s_mov_b32 s24, 491520
  s_mov_b32 s25, 163840
  v_lshrrev_b32 v11, 3, v1
  v_and_b32 v12, 7, v1
  v_xor_b32 v12, v12, v11
  v_mul_u32_u24 v11, 1280, v11
  v_lshl_add_u32 v10, v12, 4, v11
  s_mul_i32 s46, s20, 40960
  v_add_u32 v10, s46, v10
  s_lshl_b32 s47, s20, 12
  s_add_u32 s47, s47, 0
  s_add_u32 s46, s47, 98304
  s_mov_b32 s30, s24
  s_add_u32 s32, s47, 32768
  v_add_u32 v11, 9216, v10
  v_add_u32 v12, 18432, v10
  v_add_u32 v13, 27648, v10
  s_mov_b32 m0, s32
  s_nop 0
  buffer_load_dwordx4 v10, s[8:11], s30 offen offset:0 lds
  buffer_load_dwordx4 v11, s[8:11], s30 offen offset:1024 lds
  buffer_load_dwordx4 v12, s[8:11], s30 offen offset:2048 lds
  buffer_load_dwordx4 v13, s[8:11], s30 offen offset:3072 lds
  s_add_u32 s30, s30, 128
  s_add_u32 s32, s32, 16384
  s_cmp_lt_u32 s32, s46
  s_cselect_b32 s32, s32, s47
  s_mov_b32 m0, s32
  s_nop 0
  buffer_load_dwordx4 v10, s[8:11], s30 offen offset:0 lds
  buffer_load_dwordx4 v11, s[8:11], s30 offen offset:1024 lds
  buffer_load_dwordx4 v12, s[8:11], s30 offen offset:2048 lds
  buffer_load_dwordx4 v13, s[8:11], s30 offen offset:3072 lds
  s_add_u32 s30, s30, 128
  s_add_u32 s32, s32, 16384
  s_cmp_lt_u32 s32, s46
  s_cselect_b32 s32, s32, s47
  s_mov_b32 m0, s32
  s_nop 0
  buffer_load_dwordx4 v10, s[8:11], s30 offen offset:0 lds
  buffer_load_dwordx4 v11, s[8:11], s30 offen offset:1024 lds
  buffer_load_dwordx4 v12, s[8:11], s30 offen offset:2048 lds
  buffer_load_dwordx4 v13, s[8:11], s30 offen offset:3072 lds
  s_add_u32 s30, s30, 128
  s_add_u32 s32, s32, 16384
  s_cmp_lt_u32 s32, s46
  s_cselect_b32 s32, s32, s47
  s_mov_b32 m0, s32
  s_nop 0
  buffer_load_dwordx4 v10, s[8:11], s30 offen offset:0 lds
  buffer_load_dwordx4 v11, s[8:11], s30 offen offset:1024 lds
  buffer_load_dwordx4 v12, s[8:11], s30 offen offset:2048 lds
  buffer_load_dwordx4 v13, s[8:11], s30 offen offset:3072 lds
  s_add_u32 s30, s30, 128
  s_add_u32 s32, s32, 16384
  s_cmp_lt_u32 s32, s46
  s_cselect_b32 s32, s32, s47
  s_waitcnt vmcnt(16)
  s_barrier
  s_cmp_lg_u32 s20, 0
  s_cbranch_scc1 af_147
  v_mov_b32 v4, 0
  v_mov_b32 v5, 1
  s_mov_b64 exec, 1
  buffer_atomic_add v5, v4, s[72:75], s61 offen sc1
  s_mov_b64 exec, -1
  s_nop 1
af_147:
  s_mov_b32 s26, 13
  s_mov_b32 s28, 1572864
kv_main:
  v_and_b32 v6, 7, v2
  v_add_u32 v4, 0, v3
  v_xor_b32 v4, v4, v6
  v_lshlrev_b32 v4, 4, v4
  v_lshl_add_u32 v14, v2, 7, v4
  v_add_u32 v4, 4, v3
  v_xor_b32 v4, v4, v6
  v_lshlrev_b32 v4, 4, v4
  v_lshl_add_u32 v15, v2, 7, v4
  v_mul_u32_u24 v22, 400, v2
  v_mul_u32_u24 v4, 16, v3
  s_mul_i32 s21, s20, 96
  s_add_u32 s21, s21, 98304
  v_add3_u32 v22, v22, v4, s21
  v_lshlrev_b32 v4, 3, v3
  v_sub_u32 v16, v22, v4
  v_mov_b32 v9, 2731
  s_mul_i32 s21, s20, 12800
  s_add_u32 s21, s21, 98304
  v_mul_u32_u24 v4, 400, v2
  v_lshlrev_b32 v5, 4, v3
  v_add3_u32 v23, v4, v5, s21
  v_lshlrev_b32 v26, 4, v1
  s_mov_b32 s33, 32768
  s_mov_b32 s48, 0x80000000
  s_mov_b32 m0, s32
  s_nop 0
  buffer_load_dwordx4 v10, s[8:11], s30 offen offset:0 lds
  buffer_load_dwordx4 v11, s[8:11], s30 offen offset:1024 lds
  s_waitcnt vmcnt(14)
  s_barrier
  v_add_u32 v18, s33, v14
  v_add_u32 v19, s33, v15
  s_add_u32 s33, s33, 16384
  s_cmp_lt_u32 s33, 98304
  s_cselect_b32 s33, s33, 0
  ds_read_b128 v[160:163], v18 offset:0
  ds_read_b128 v[164:167], v18 offset:2048
  ds_read_b128 v[168:171], v18 offset:4096
  ds_read_b128 v[172:175], v18 offset:6144
  ds_read_b128 v[176:179], v18 offset:8192
  ds_read_b128 v[180:183], v18 offset:10240
  ds_read_b128 v[184:187], v18 offset:12288
  ds_read_b128 v[188:191], v18 offset:14336
  s_waitcnt lgkmcnt(0)
kv_blk_150:
  v_mfma_f32_16x16x32_bf16 v[64:67], a[0:3], v[160:163], 0
  ds_read_b128 v[192:195], v19 offset:0
  v_mfma_f32_16x16x32_bf16 v[68:71], a[4:7], v[160:163], 0
  v_add_u32 v18, s33, v14
  v_mfma_f32_16x16x32_bf16 v[72:75], a[8:11], v[160:163], 0
  ds_write_b64 v16, v[234:235] offset:6464
  v_mfma_f32_16x16x32_bf16 v[76:79], a[0:3], v[164:167], 0
  ds_read_b128 v[196:199], v19 offset:2048
  v_cvt_pk_bf16_f32 v236, v88, v89
  v_mfma_f32_16x16x32_bf16 v[80:83], a[4:7], v[164:167], 0
  buffer_load_dwordx4 v12, s[8:11], s30 offen offset:2048 lds
  v_mfma_f32_16x16x32_bf16 v[84:87], a[8:11], v[164:167], 0
  v_cvt_pk_bf16_f32 v237, v90, v91
  v_cvt_pk_bf16_f32 v238, v92, v93
  v_mfma_f32_16x16x32_bf16 v[88:91], a[0:3], v[168:171], 0
  ds_read_b128 v[200:203], v19 offset:4096
  v_cvt_pk_bf16_f32 v239, v94, v95
  v_mfma_f32_16x16x32_bf16 v[92:95], a[4:7], v[168:171], 0
  v_cvt_pk_bf16_f32 v240, v96, v97
  v_cvt_pk_bf16_f32 v241, v98, v99
  v_mfma_f32_16x16x32_bf16 v[96:99], a[8:11], v[168:171], 0
  ds_write_b64 v22, v[236:237] offset:12800
  ds_write_b64 v22, v[238:239] offset:12808
  ds_write_b64 v16, v[240:241] offset:12864
  v_cvt_pk_bf16_f32 v242, v100, v101
  v_cvt_pk_bf16_f32 v243, v102, v103
  v_mfma_f32_16x16x32_bf16 v[100:103], a[0:3], v[172:175], 0
  ds_read_b128 v[204:207], v19 offset:6144
  v_cvt_pk_bf16_f32 v244, v104, v105
  v_cvt_pk_bf16_f32 v245, v106, v107
  v_mfma_f32_16x16x32_bf16 v[104:107], a[4:7], v[172:175], 0
  v_cvt_pk_bf16_f32 v246, v108, v109
  v_cvt_pk_bf16_f32 v247, v110, v111
  v_mfma_f32_16x16x32_bf16 v[108:111], a[8:11], v[172:175], 0
  s_waitcnt lgkmcnt(9)
  ds_write_b64 v22, v[242:243] offset:19200
  ds_write_b64 v22, v[244:245] offset:19208
  ds_write_b64 v16, v[246:247] offset:19264
  v_cvt_pk_bf16_f32 v224, v112, v113
  v_cvt_pk_bf16_f32 v225, v114, v115
  v_mfma_f32_16x16x32_bf16 v[112:115], a[0:3], v[176:179], 0
  ds_read_b128 v[208:211], v19 offset:8192
  v_cvt_pk_bf16_f32 v226, v116, v117
  v_cvt_pk_bf16_f32 v227, v118, v119
  v_mfma_f32_16x16x32_bf16 v[116:119], a[4:7], v[176:179], 0
  v_cvt_pk_bf16_f32 v228, v120, v121
  v_cvt_pk_bf16_f32 v229, v122, v123
  v_mfma_f32_16x16x32_bf16 v[120:123], a[8:11], v[176:179], 0
  ds_write_b64 v22, v[224:225] offset:25600
  ds_write_b64 v22, v[226:227] offset:25608
  ds_write_b64 v16, v[228:229] offset:25664
  v_cvt_pk_bf16_f32 v230, v124, v125
  v_cvt_pk_bf16_f32 v231, v126, v127
  v_mfma_f32_16x16x32_bf16 v[124:127], a[0:3], v[180:183], 0
  ds_read_b128 v[212:215], v19 offset:10240
  v_cvt_pk_bf16_f32 v232, v128, v129
  v_cvt_pk_bf16_f32 v233, v130, v131
  v_mfma_f32_16x16x32_bf16 v[128:131], a[4:7], v[180:183], 0
  buffer_load_dwordx4 v13, s[8:11], s30 offen offset:3072 lds
  v_cvt_pk_bf16_f32 v234, v132, v133
  v_cvt_pk_bf16_f32 v235, v134, v135
  v_mfma_f32_16x16x32_bf16 v[132:135], a[8:11], v[180:183], 0
  s_add_u32 s30, s30, 128
  s_add_u32 m0, m0, 16384
  ds_write_b64 v22, v[230:231] offset:32000
  ds_write_b64 v22, v[232:233] offset:32008
  ds_write_b64 v16, v[234:235] offset:32064
  v_cvt_pk_bf16_f32 v236, v136, v137
  v_cvt_pk_bf16_f32 v237, v138, v139
  v_mfma_f32_16x16x32_bf16 v[136:139], a[0:3], v[184:187], 0
  ds_read_b128 v[216:219], v19 offset:12288
  v_cvt_pk_bf16_f32 v238, v140, v141
  v_cvt_pk_bf16_f32 v239, v142, v143
  v_mfma_f32_16x16x32_bf16 v[140:143], a[4:7], v[184:187], 0
  s_cmp_lt_u32 m0, s46
  s_cselect_b32 m0, m0, s47
  v_cvt_pk_bf16_f32 v240, v144, v145
  v_cvt_pk_bf16_f32 v241, v146, v147
  v_mfma_f32_16x16x32_bf16 v[144:147], a[8:11], v[184:187], 0
  ds_write_b64 v22, v[236:237] offset:38400
  ds_write_b64 v22, v[238:239] offset:38408
  ds_write_b64 v16, v[240:241] offset:38464
  v_cvt_pk_bf16_f32 v242, v148, v149
  v_cvt_pk_bf16_f32 v243, v150, v151
  v_mfma_f32_16x16x32_bf16 v[148:151], a[0:3], v[188:191], 0
  ds_read_b128 v[220:223], v19 offset:14336
  v_cvt_pk_bf16_f32 v244, v152, v153
  v_cvt_pk_bf16_f32 v245, v154, v155
  v_mfma_f32_16x16x32_bf16 v[152:155], a[4:7], v[188:191], 0
  v_cvt_pk_bf16_f32 v246, v156, v157
  v_cvt_pk_bf16_f32 v247, v158, v159
  v_mfma_f32_16x16x32_bf16 v[156:159], a[8:11], v[188:191], 0
  s_waitcnt vmcnt(12) lgkmcnt(15)
  s_barrier
  v_mfma_f32_16x16x32_bf16 v[64:67], a[12:15], v[192:195], v[64:67]
  ds_read_b128 v[160:163], v18 offset:0
  v_mfma_f32_16x16x32_bf16 v[68:71], a[16:19], v[192:195], v[68:71]
  ds_write_b64 v22, v[242:243] offset:44800
  v_mfma_f32_16x16x32_bf16 v[72:75], a[20:23], v[192:195], v[72:75]
  v_add_u32 v19, s33, v15
  s_add_u32 s33, s33, 16384
  v_mfma_f32_16x16x32_bf16 v[76:79], a[12:15], v[196:199], v[76:79]
  ds_read_b128 v[164:167], v18 offset:2048
  v_mfma_f32_16x16x32_bf16 v[80:83], a[16:19], v[196:199], v[80:83]
  buffer_load_dwordx4 v10, s[8:11], s30 offen offset:0 lds
  v_mfma_f32_16x16x32_bf16 v[84:87], a[20:23], v[196:199], v[84:87]
  s_cmp_lt_u32 s33, 98304
  s_cselect_b32 s33, s33, 0
  v_mfma_f32_16x16x32_bf16 v[88:91], a[12:15], v[200:203], v[88:91]
  ds_read_b128 v[168:171], v18 offset:4096
  v_mfma_f32_16x16x32_bf16 v[92:95], a[16:19], v[200:203], v[92:95]
  ds_write_b64 v22, v[244:245] offset:44808
  v_mfma_f32_16x16x32_bf16 v[96:99], a[20:23], v[200:203], v[96:99]
  ds_write_b64 v16, v[246:247] offset:44864
  v_mfma_f32_16x16x32_bf16 v[100:103], a[12:15], v[204:207], v[100:103]
  ds_read_b128 v[172:175], v18 offset:6144
  v_mfma_f32_16x16x32_bf16 v[104:107], a[16:19], v[204:207], v[104:107]
  v_mfma_f32_16x16x32_bf16 v[108:111], a[20:23], v[204:207], v[108:111]
  s_waitcnt lgkmcnt(7)
  v_mfma_f32_16x16x32_bf16 v[112:115], a[12:15], v[208:211], v[112:115]
  ds_read_b128 v[176:179], v18 offset:8192
  v_mfma_f32_16x16x32_bf16 v[116:119], a[16:19], v[208:211], v[116:119]
  v_mfma_f32_16x16x32_bf16 v[120:123], a[20:23], v[208:211], v[120:123]
  v_mfma_f32_16x16x32_bf16 v[124:127], a[12:15], v[212:215], v[124:127]
  ds_read_b128 v[180:183], v18 offset:10240
  v_mfma_f32_16x16x32_bf16 v[128:131], a[16:19], v[212:215], v[128:131]
  buffer_load_dwordx4 v11, s[8:11], s30 offen offset:1024 lds
  v_mfma_f32_16x16x32_bf16 v[132:135], a[20:23], v[212:215], v[132:135]
  v_mfma_f32_16x16x32_bf16 v[136:139], a[12:15], v[216:219], v[136:139]
  ds_read_b128 v[184:187], v18 offset:12288
  v_mfma_f32_16x16x32_bf16 v[140:143], a[16:19], v[216:219], v[140:143]
  v_mfma_f32_16x16x32_bf16 v[144:147], a[20:23], v[216:219], v[144:147]
  v_mfma_f32_16x16x32_bf16 v[148:151], a[12:15], v[220:223], v[148:151]
  ds_read_b128 v[188:191], v18 offset:14336
  v_mfma_f32_16x16x32_bf16 v[152:155], a[16:19], v[220:223], v[152:155]
  v_mfma_f32_16x16x32_bf16 v[156:159], a[20:23], v[220:223], v[156:159]
  s_waitcnt lgkmcnt(4)
  v_mfma_f32_16x16x32_bf16 v[64:67], a[24:27], v[160:163], v[64:67]
  ds_read_b128 v[192:195], v19 offset:0
  v_mfma_f32_16x16x32_bf16 v[68:71], a[28:31], v[160:163], v[68:71]
  v_add_u32 v18, s33, v14
  v_mfma_f32_16x16x32_bf16 v[72:75], a[32:35], v[160:163], v[72:75]
  v_mfma_f32_16x16x32_bf16 v[76:79], a[24:27], v[164:167], v[76:79]
  ds_read_b128 v[196:199], v19 offset:2048
  v_mfma_f32_16x16x32_bf16 v[80:83], a[28:31], v[164:167], v[80:83]
  buffer_load_dwordx4 v12, s[8:11], s30 offen offset:2048 lds
  v_mfma_f32_16x16x32_bf16 v[84:87], a[32:35], v[164:167], v[84:87]
  v_mfma_f32_16x16x32_bf16 v[88:91], a[24:27], v[168:171], v[88:91]
  ds_read_b128 v[200:203], v19 offset:4096
  v_mfma_f32_16x16x32_bf16 v[92:95], a[28:31], v[168:171], v[92:95]
  v_mfma_f32_16x16x32_bf16 v[96:99], a[32:35], v[168:171], v[96:99]
  v_mfma_f32_16x16x32_bf16 v[100:103], a[24:27], v[172:175], v[100:103]
  ds_read_b128 v[204:207], v19 offset:6144
  v_mfma_f32_16x16x32_bf16 v[104:107], a[28:31], v[172:175], v[104:107]
  v_mfma_f32_16x16x32_bf16 v[108:111], a[32:35], v[172:175], v[108:111]
  s_waitcnt lgkmcnt(4)
  v_mfma_f32_16x16x32_bf16 v[112:115], a[24:27], v[176:179], v[112:115]
  ds_read_b128 v[208:211], v19 offset:8192
  v_mfma_f32_16x16x32_bf16 v[116:119], a[28:31], v[176:179], v[116:119]
  v_mfma_f32_16x16x32_bf16 v[120:123], a[32:35], v[176:179], v[120:123]
  v_mfma_f32_16x16x32_bf16 v[124:127], a[24:27], v[180:183], v[124:127]
  ds_read_b128 v[212:215], v19 offset:10240
  v_mfma_f32_16x16x32_bf16 v[128:131], a[28:31], v[180:183], v[128:131]
  buffer_load_dwordx4 v13, s[8:11], s30 offen offset:3072 lds
  v_mfma_f32_16x16x32_bf16 v[132:135], a[32:35], v[180:183], v[132:135]
  s_add_u32 s30, s30, 128
  s_add_u32 m0, m0, 16384
  v_mfma_f32_16x16x32_bf16 v[136:139], a[24:27], v[184:187], v[136:139]
  ds_read_b128 v[216:219], v19 offset:12288
  v_mfma_f32_16x16x32_bf16 v[140:143], a[28:31], v[184:187], v[140:143]
  s_cmp_lt_u32 m0, s46
  s_cselect_b32 m0, m0, s47
  v_mfma_f32_16x16x32_bf16 v[144:147], a[32:35], v[184:187], v[144:147]
  v_mfma_f32_16x16x32_bf16 v[148:151], a[24:27], v[188:191], v[148:151]
  ds_read_b128 v[220:223], v19 offset:14336
  v_mfma_f32_16x16x32_bf16 v[152:155], a[28:31], v[188:191], v[152:155]
  v_mfma_f32_16x16x32_bf16 v[156:159], a[32:35], v[188:191], v[156:159]
  s_waitcnt vmcnt(12) lgkmcnt(4)
  s_barrier
  v_mfma_f32_16x16x32_bf16 v[64:67], a[36:39], v[192:195], v[64:67]
  ds_read_b128 v[160:163], v18 offset:0
  v_mfma_f32_16x16x32_bf16 v[68:71], a[40:43], v[192:195], v[68:71]
  v_mfma_f32_16x16x32_bf16 v[72:75], a[44:47], v[192:195], v[72:75]
  v_add_u32 v19, s33, v15
  s_add_u32 s33, s33, 16384
  v_mfma_f32_16x16x32_bf16 v[76:79], a[36:39], v[196:199], v[76:79]
  ds_read_b128 v[164:167], v18 offset:2048
  v_mfma_f32_16x16x32_bf16 v[80:83], a[40:43], v[196:199], v[80:83]
  buffer_load_dwordx4 v10, s[8:11], s30 offen offset:0 lds
  v_mfma_f32_16x16x32_bf16 v[84:87], a[44:47], v[196:199], v[84:87]
  s_cmp_lt_u32 s33, 98304
  s_cselect_b32 s33, s33, 0
  v_mfma_f32_16x16x32_bf16 v[88:91], a[36:39], v[200:203], v[88:91]
  ds_read_b128 v[168:171], v18 offset:4096
  v_mfma_f32_16x16x32_bf16 v[92:95], a[40:43], v[200:203], v[92:95]
  ds_read_b128 v[224:227], v23 offset:0
  v_mfma_f32_16x16x32_bf16 v[96:99], a[44:47], v[200:203], v[96:99]
  v_mfma_f32_16x16x32_bf16 v[100:103], a[36:39], v[204:207], v[100:103]
  ds_read_b128 v[172:175], v18 offset:6144
  v_mfma_f32_16x16x32_bf16 v[104:107], a[40:43], v[204:207], v[104:107]
  v_mfma_f32_16x16x32_bf16 v[108:111], a[44:47], v[204:207], v[108:111]
  s_waitcnt lgkmcnt(5)
  v_mfma_f32_16x16x32_bf16 v[112:115], a[36:39], v[208:211], v[112:115]
  ds_read_b128 v[176:179], v18 offset:8192
  v_mfma_f32_16x16x32_bf16 v[116:119], a[40:43], v[208:211], v[116:119]
  v_mfma_f32_16x16x32_bf16 v[120:123], a[44:47], v[208:211], v[120:123]
  v_mfma_f32_16x16x32_bf16 v[124:127], a[36:39], v[212:215], v[124:127]
  ds_read_b128 v[180:183], v18 offset:10240
  v_mfma_f32_16x16x32_bf16 v[128:131], a[40:43], v[212:215], v[128:131]
  buffer_load_dwordx4 v11, s[8:11], s30 offen offset:1024 lds
  v_mfma_f32_16x16x32_bf16 v[132:135], a[44:47], v[212:215], v[132:135]
  v_mfma_f32_16x16x32_bf16 v[136:139], a[36:39], v[216:219], v[136:139]
  ds_read_b128 v[184:187], v18 offset:12288
  v_mfma_f32_16x16x32_bf16 v[140:143], a[40:43], v[216:219], v[140:143]
  ds_read_b128 v[228:231], v23 offset:64
  v_mfma_f32_16x16x32_bf16 v[144:147], a[44:47], v[216:219], v[144:147]
  v_mfma_f32_16x16x32_bf16 v[148:151], a[36:39], v[220:223], v[148:151]
  ds_read_b128 v[188:191], v18 offset:14336
  v_mfma_f32_16x16x32_bf16 v[152:155], a[40:43], v[220:223], v[152:155]
  v_mfma_f32_16x16x32_bf16 v[156:159], a[44:47], v[220:223], v[156:159]
  s_waitcnt lgkmcnt(5)
  v_mfma_f32_16x16x32_bf16 v[64:67], a[48:51], v[160:163], v[64:67]
  ds_read_b128 v[192:195], v19 offset:0
  v_mfma_f32_16x16x32_bf16 v[68:71], a[52:55], v[160:163], v[68:71]
  v_add_u32 v18, s33, v14
  v_mfma_f32_16x16x32_bf16 v[72:75], a[56:59], v[160:163], v[72:75]
  v_mfma_f32_16x16x32_bf16 v[76:79], a[48:51], v[164:167], v[76:79]
  ds_read_b128 v[196:199], v19 offset:2048
  v_mfma_f32_16x16x32_bf16 v[80:83], a[52:55], v[164:167], v[80:83]
  buffer_load_dwordx4 v12, s[8:11], s30 offen offset:2048 lds
  v_mfma_f32_16x16x32_bf16 v[84:87], a[56:59], v[164:167], v[84:87]
  v_mfma_f32_16x16x32_bf16 v[88:91], a[48:51], v[168:171], v[88:91]
  ds_read_b128 v[200:203], v19 offset:4096
  v_mfma_f32_16x16x32_bf16 v[92:95], a[52:55], v[168:171], v[92:95]
  s_add_u32 s21, s48, 0
  ds_read_b128 v[232:235], v23 offset:128
  v_mfma_f32_16x16x32_bf16 v[96:99], a[56:59], v[168:171], v[96:99]
  v_mfma_f32_16x16x32_bf16 v[100:103], a[48:51], v[172:175], v[100:103]
  ds_read_b128 v[204:207], v19 offset:6144
  v_mfma_f32_16x16x32_bf16 v[104:107], a[52:55], v[172:175], v[104:107]
  buffer_store_dwordx4 v[224:227], v26, s[16:19], s21 offen offset:0 sc1
  v_mfma_f32_16x16x32_bf16 v[108:111], a[56:59], v[172:175], v[108:111]
  s_waitcnt lgkmcnt(5)
  v_mfma_f32_16x16x32_bf16 v[112:115], a[48:51], v[176:179], v[112:115]
  ds_read_b128 v[208:211], v19 offset:8192
  v_mfma_f32_16x16x32_bf16 v[116:119], a[52:55], v[176:179], v[116:119]
  v_mfma_f32_16x16x32_bf16 v[120:123], a[56:59], v[176:179], v[120:123]
  v_mfma_f32_16x16x32_bf16 v[124:127], a[48:51], v[180:183], v[124:127]
  ds_read_b128 v[212:215], v19 offset:10240
  v_mfma_f32_16x16x32_bf16 v[128:131], a[52:55], v[180:183], v[128:131]
  buffer_load_dwordx4 v13, s[8:11], s30 offen offset:3072 lds
  v_mfma_f32_16x16x32_bf16 v[132:135], a[56:59], v[180:183], v[132:135]
  s_add_u32 s30, s30, 128
  s_add_u32 m0, m0, 16384
  v_mfma_f32_16x16x32_bf16 v[136:139], a[48:51], v[184:187], v[136:139]
  ds_read_b128 v[216:219], v19 offset:12288
  v_mfma_f32_16x16x32_bf16 v[140:143], a[52:55], v[184:187], v[140:143]
  s_cmp_lt_u32 m0, s46
  s_cselect_b32 m0, m0, s47
  v_mfma_f32_16x16x32_bf16 v[144:147], a[56:59], v[184:187], v[144:147]
  ds_read_b128 v[236:239], v23 offset:192
  v_mfma_f32_16x16x32_bf16 v[148:151], a[48:51], v[188:191], v[148:151]
  ds_read_b128 v[220:223], v19 offset:14336
  v_mfma_f32_16x16x32_bf16 v[152:155], a[52:55], v[188:191], v[152:155]
  buffer_store_dwordx4 v[228:231], v26, s[16:19], s21 offen offset:1024 sc1
  v_mfma_f32_16x16x32_bf16 v[156:159], a[56:59], v[188:191], v[156:159]
  s_waitcnt vmcnt(14) lgkmcnt(5)
  s_barrier
  v_mfma_f32_16x16x32_bf16 v[64:67], a[60:63], v[192:195], v[64:67]
  ds_read_b128 v[160:163], v18 offset:0
  v_mfma_f32_16x16x32_bf16 v[68:71], a[64:67], v[192:195], v[68:71]
  v_mfma_f32_16x16x32_bf16 v[72:75], a[68:71], v[192:195], v[72:75]
  v_add_u32 v19, s33, v15
  s_add_u32 s33, s33, 16384
  v_mfma_f32_16x16x32_bf16 v[76:79], a[60:63], v[196:199], v[76:79]
  ds_read_b128 v[164:167], v18 offset:2048
  v_mfma_f32_16x16x32_bf16 v[80:83], a[64:67], v[196:199], v[80:83]
  buffer_load_dwordx4 v10, s[8:11], s30 offen offset:0 lds
  v_mfma_f32_16x16x32_bf16 v[84:87], a[68:71], v[196:199], v[84:87]
  s_cmp_lt_u32 s33, 98304
  s_cselect_b32 s33, s33, 0
  v_mfma_f32_16x16x32_bf16 v[88:91], a[60:63], v[200:203], v[88:91]
  ds_read_b128 v[168:171], v18 offset:4096
  v_mfma_f32_16x16x32_bf16 v[92:95], a[64:67], v[200:203], v[92:95]
  ds_read_b128 v[240:243], v23 offset:256
  v_mfma_f32_16x16x32_bf16 v[96:99], a[68:71], v[200:203], v[96:99]
  v_mfma_f32_16x16x32_bf16 v[100:103], a[60:63], v[204:207], v[100:103]
  ds_read_b128 v[172:175], v18 offset:6144
  v_mfma_f32_16x16x32_bf16 v[104:107], a[64:67], v[204:207], v[104:107]
  buffer_store_dwordx4 v[232:235], v26, s[16:19], s21 offen offset:2048 sc1
  v_mfma_f32_16x16x32_bf16 v[108:111], a[68:71], v[204:207], v[108:111]
  s_waitcnt lgkmcnt(5)
  v_mfma_f32_16x16x32_bf16 v[112:115], a[60:63], v[208:211], v[112:115]
  ds_read_b128 v[176:179], v18 offset:8192
  v_mfma_f32_16x16x32_bf16 v[116:119], a[64:67], v[208:211], v[116:119]
  v_mfma_f32_16x16x32_bf16 v[120:123], a[68:71], v[208:211], v[120:123]
  v_mfma_f32_16x16x32_bf16 v[124:127], a[60:63], v[212:215], v[124:127]
  ds_read_b128 v[180:183], v18 offset:10240
  v_mfma_f32_16x16x32_bf16 v[128:131], a[64:67], v[212:215], v[128:131]
  buffer_load_dwordx4 v11, s[8:11], s30 offen offset:1024 lds
  v_mfma_f32_16x16x32_bf16 v[132:135], a[68:71], v[212:215], v[132:135]
  v_mfma_f32_16x16x32_bf16 v[136:139], a[60:63], v[216:219], v[136:139]
  ds_read_b128 v[184:187], v18 offset:12288
  v_mfma_f32_16x16x32_bf16 v[140:143], a[64:67], v[216:219], v[140:143]
  ds_read_b128 v[244:247], v23 offset:320
  v_mfma_f32_16x16x32_bf16 v[144:147], a[68:71], v[216:219], v[144:147]
  v_mfma_f32_16x16x32_bf16 v[148:151], a[60:63], v[220:223], v[148:151]
  ds_read_b128 v[188:191], v18 offset:14336
  v_mfma_f32_16x16x32_bf16 v[152:155], a[64:67], v[220:223], v[152:155]
  buffer_store_dwordx4 v[236:239], v26, s[16:19], s21 offen offset:3072 sc1
  v_mfma_f32_16x16x32_bf16 v[156:159], a[68:71], v[220:223], v[156:159]
  s_waitcnt lgkmcnt(5)
  v_mfma_f32_16x16x32_bf16 v[64:67], a[72:75], v[160:163], v[64:67]
  ds_read_b128 v[192:195], v19 offset:0
  v_mfma_f32_16x16x32_bf16 v[68:71], a[76:79], v[160:163], v[68:71]
  v_add_u32 v18, s33, v14
  v_mfma_f32_16x16x32_bf16 v[72:75], a[80:83], v[160:163], v[72:75]
  v_mfma_f32_16x16x32_bf16 v[76:79], a[72:75], v[164:167], v[76:79]
  ds_read_b128 v[196:199], v19 offset:2048
  v_mfma_f32_16x16x32_bf16 v[80:83], a[76:79], v[164:167], v[80:83]
  buffer_load_dwordx4 v12, s[8:11], s30 offen offset:2048 lds
  v_mfma_f32_16x16x32_bf16 v[84:87], a[80:83], v[164:167], v[84:87]
  v_mfma_f32_16x16x32_bf16 v[88:91], a[72:75], v[168:171], v[88:91]
  ds_read_b128 v[200:203], v19 offset:4096
  v_mfma_f32_16x16x32_bf16 v[92:95], a[76:79], v[168:171], v[92:95]
  s_add_u32 s21, s48, 4096
  ds_read_b128 v[224:227], v23 offset:6400
  v_mfma_f32_16x16x32_bf16 v[96:99], a[80:83], v[168:171], v[96:99]
  v_mfma_f32_16x16x32_bf16 v[100:103], a[72:75], v[172:175], v[100:103]
  ds_read_b128 v[204:207], v19 offset:6144
  v_mfma_f32_16x16x32_bf16 v[104:107], a[76:79], v[172:175], v[104:107]
  buffer_store_dwordx4 v[240:243], v26, s[16:19], s21 offen offset:0 sc1
  v_mfma_f32_16x16x32_bf16 v[108:111], a[80:83], v[172:175], v[108:111]
  s_waitcnt lgkmcnt(5)
  v_mfma_f32_16x16x32_bf16 v[112:115], a[72:75], v[176:179], v[112:115]
  ds_read_b128 v[208:211], v19 offset:8192
  v_mfma_f32_16x16x32_bf16 v[116:119], a[76:79], v[176:179], v[116:119]
  v_mfma_f32_16x16x32_bf16 v[120:123], a[80:83], v[176:179], v[120:123]
  v_mfma_f32_16x16x32_bf16 v[124:127], a[72:75], v[180:183], v[124:127]
  ds_read_b128 v[212:215], v19 offset:10240
  v_mfma_f32_16x16x32_bf16 v[128:131], a[76:79], v[180:183], v[128:131]
  buffer_load_dwordx4 v13, s[8:11], s30 offen offset:3072 lds
  v_mfma_f32_16x16x32_bf16 v[132:135], a[80:83], v[180:183], v[132:135]
  s_add_u32 s30, s30, 128
  s_add_u32 m0, m0, 16384
  v_mfma_f32_16x16x32_bf16 v[136:139], a[72:75], v[184:187], v[136:139]
  ds_read_b128 v[216:219], v19 offset:12288
  v_mfma_f32_16x16x32_bf16 v[140:143], a[76:79], v[184:187], v[140:143]
  s_cmp_lt_u32 m0, s46
  s_cselect_b32 m0, m0, s47
  v_mfma_f32_16x16x32_bf16 v[144:147], a[80:83], v[184:187], v[144:147]
  ds_read_b128 v[228:231], v23 offset:6464
  v_mfma_f32_16x16x32_bf16 v[148:151], a[72:75], v[188:191], v[148:151]
  ds_read_b128 v[220:223], v19 offset:14336
  v_mfma_f32_16x16x32_bf16 v[152:155], a[76:79], v[188:191], v[152:155]
  buffer_store_dwordx4 v[244:247], v26, s[16:19], s21 offen offset:1024 sc1
  v_mfma_f32_16x16x32_bf16 v[156:159], a[80:83], v[188:191], v[156:159]
  s_waitcnt vmcnt(18) lgkmcnt(5)
  s_barrier
  v_mfma_f32_16x16x32_bf16 v[64:67], a[84:87], v[192:195], v[64:67]
  ds_read_b128 v[160:163], v18 offset:0
  v_mfma_f32_16x16x32_bf16 v[68:71], a[88:91], v[192:195], v[68:71]
  v_mfma_f32_16x16x32_bf16 v[72:75], a[92:95], v[192:195], v[72:75]
  v_add_u32 v19, s33, v15
  s_add_u32 s33, s33, 16384
  v_mfma_f32_16x16x32_bf16 v[76:79], a[84:87], v[196:199], v[76:79]
  ds_read_b128 v[164:167], v18 offset:2048
  v_mfma_f32_16x16x32_bf16 v[80:83], a[88:91], v[196:199], v[80:83]
  buffer_load_dwordx4 v10, s[8:11], s30 offen offset:0 lds
  v_mfma_f32_16x16x32_bf16 v[84:87], a[92:95], v[196:199], v[84:87]
  s_cmp_lt_u32 s33, 98304
  s_cselect_b32 s33, s33, 0
  v_mfma_f32_16x16x32_bf16 v[88:91], a[84:87], v[200:203], v[88:91]
  ds_read_b128 v[168:171], v18 offset:4096
  v_mfma_f32_16x16x32_bf16 v[92:95], a[88:91], v[200:203], v[92:95]
  ds_read_b128 v[232:235], v23 offset:6528
  v_mfma_f32_16x16x32_bf16 v[96:99], a[92:95], v[200:203], v[96:99]
  v_mfma_f32_16x16x32_bf16 v[100:103], a[84:87], v[204:207], v[100:103]
  ds_read_b128 v[172:175], v18 offset:6144
  v_mfma_f32_16x16x32_bf16 v[104:107], a[88:91], v[204:207], v[104:107]
  buffer_store_dwordx4 v[224:227], v26, s[16:19], s21 offen offset:2048 sc1
  v_mfma_f32_16x16x32_bf16 v[108:111], a[92:95], v[204:207], v[108:111]
  s_waitcnt lgkmcnt(5)
  v_mfma_f32_16x16x32_bf16 v[112:115], a[84:87], v[208:211], v[112:115]
  ds_read_b128 v[176:179], v18 offset:8192
  v_mfma_f32_16x16x32_bf16 v[116:119], a[88:91], v[208:211], v[116:119]
  v_mfma_f32_16x16x32_bf16 v[120:123], a[92:95], v[208:211], v[120:123]
  v_mfma_f32_16x16x32_bf16 v[124:127], a[84:87], v[212:215], v[124:127]
  ds_read_b128 v[180:183], v18 offset:10240
  v_mfma_f32_16x16x32_bf16 v[128:131], a[88:91], v[212:215], v[128:131]
  buffer_load_dwordx4 v11, s[8:11], s30 offen offset:1024 lds
  v_mfma_f32_16x16x32_bf16 v[132:135], a[92:95], v[212:215], v[132:135]
  v_mfma_f32_16x16x32_bf16 v[136:139], a[84:87], v[216:219], v[136:139]
  ds_read_b128 v[184:187], v18 offset:12288
  v_mfma_f32_16x16x32_bf16 v[140:143], a[88:91], v[216:219], v[140:143]
  ds_read_b128 v[236:239], v23 offset:6592
  v_mfma_f32_16x16x32_bf16 v[144:147], a[92:95], v[216:219], v[144:147]
  v_mfma_f32_16x16x32_bf16 v[148:151], a[84:87], v[220:223], v[148:151]
  ds_read_b128 v[188:191], v18 offset:14336
  v_mfma_f32_16x16x32_bf16 v[152:155], a[88:91], v[220:223], v[152:155]
  buffer_store_dwordx4 v[228:231], v26, s[16:19], s21 offen offset:3072 sc1
  v_mfma_f32_16x16x32_bf16 v[156:159], a[92:95], v[220:223], v[156:159]
  s_waitcnt lgkmcnt(5)
  v_mfma_f32_16x16x32_bf16 v[64:67], a[96:99], v[160:163], v[64:67]
  ds_read_b128 v[192:195], v19 offset:0
  v_mfma_f32_16x16x32_bf16 v[68:71], a[100:103], v[160:163], v[68:71]
  v_add_u32 v18, s33, v14
  v_mfma_f32_16x16x32_bf16 v[72:75], a[104:107], v[160:163], v[72:75]
  v_mfma_f32_16x16x32_bf16 v[76:79], a[96:99], v[164:167], v[76:79]
  ds_read_b128 v[196:199], v19 offset:2048
  v_mfma_f32_16x16x32_bf16 v[80:83], a[100:103], v[164:167], v[80:83]
  buffer_load_dwordx4 v12, s[8:11], s30 offen offset:2048 lds
  v_mfma_f32_16x16x32_bf16 v[84:87], a[104:107], v[164:167], v[84:87]
  v_mfma_f32_16x16x32_bf16 v[88:91], a[96:99], v[168:171], v[88:91]
  ds_read_b128 v[200:203], v19 offset:4096
  v_mfma_f32_16x16x32_bf16 v[92:95], a[100:103], v[168:171], v[92:95]
  s_add_u32 s21, s48, 8192
  ds_read_b128 v[240:243], v23 offset:6656
  v_mfma_f32_16x16x32_bf16 v[96:99], a[104:107], v[168:171], v[96:99]
  v_mfma_f32_16x16x32_bf16 v[100:103], a[96:99], v[172:175], v[100:103]
  ds_read_b128 v[204:207], v19 offset:6144
  v_mfma_f32_16x16x32_bf16 v[104:107], a[100:103], v[172:175], v[104:107]
  buffer_store_dwordx4 v[232:235], v26, s[16:19], s21 offen offset:0 sc1
  v_mfma_f32_16x16x32_bf16 v[108:111], a[104:107], v[172:175], v[108:111]
  s_waitcnt lgkmcnt(5)
  v_mfma_f32_16x16x32_bf16 v[112:115], a[96:99], v[176:179], v[112:115]
  ds_read_b128 v[208:211], v19 offset:8192
  v_mfma_f32_16x16x32_bf16 v[116:119], a[100:103], v[176:179], v[116:119]
  v_mfma_f32_16x16x32_bf16 v[120:123], a[104:107], v[176:179], v[120:123]
  v_mfma_f32_16x16x32_bf16 v[124:127], a[96:99], v[180:183], v[124:127]
  ds_read_b128 v[212:215], v19 offset:10240
  v_mfma_f32_16x16x32_bf16 v[128:131], a[100:103], v[180:183], v[128:131]
  buffer_load_dwordx4 v13, s[8:11], s30 offen offset:3072 lds
  v_mfma_f32_16x16x32_bf16 v[132:135], a[104:107], v[180:183], v[132:135]
  s_add_u32 s30, s30, 128
  s_add_u32 m0, m0, 16384
  v_mfma_f32_16x16x32_bf16 v[136:139], a[96:99], v[184:187], v[136:139]
  ds_read_b128 v[216:219], v19 offset:12288
  v_mfma_f32_16x16x32_bf16 v[140:143], a[100:103], v[184:187], v[140:143]
  s_cmp_lt_u32 m0, s46
  s_cselect_b32 m0, m0, s47
  v_mfma_f32_16x16x32_bf16 v[144:147], a[104:107], v[184:187], v[144:147]
  ds_read_b128 v[244:247], v23 offset:6720
  v_mfma_f32_16x16x32_bf16 v[148:151], a[96:99], v[188:191], v[148:151]
  ds_read_b128 v[220:223], v19 offset:14336
  v_mfma_f32_16x16x32_bf16 v[152:155], a[100:103], v[188:191], v[152:155]
  buffer_store_dwordx4 v[236:239], v26, s[16:19], s21 offen offset:1024 sc1
  v_mfma_f32_16x16x32_bf16 v[156:159], a[104:107], v[188:191], v[156:159]
  s_waitcnt vmcnt(22) lgkmcnt(5)
  s_barrier
  v_mfma_f32_16x16x32_bf16 v[64:67], a[108:111], v[192:195], v[64:67]
  ds_read_b128 v[160:163], v18 offset:0
  v_mfma_f32_16x16x32_bf16 v[68:71], a[112:115], v[192:195], v[68:71]
  v_mfma_f32_16x16x32_bf16 v[72:75], a[116:119], v[192:195], v[72:75]
  v_add_u32 v19, s33, v15
  s_add_u32 s33, s33, 16384
  v_mfma_f32_16x16x32_bf16 v[76:79], a[108:111], v[196:199], v[76:79]
  ds_read_b128 v[164:167], v18 offset:2048
  v_mfma_f32_16x16x32_bf16 v[80:83], a[112:115], v[196:199], v[80:83]
  buffer_load_dwordx4 v10, s[8:11], s30 offen offset:0 lds
  v_mfma_f32_16x16x32_bf16 v[84:87], a[116:119], v[196:199], v[84:87]
  s_cmp_lt_u32 s33, 98304
  s_cselect_b32 s33, s33, 0
  v_mfma_f32_16x16x32_bf16 v[88:91], a[108:111], v[200:203], v[88:91]
  ds_read_b128 v[168:171], v18 offset:4096
  v_mfma_f32_16x16x32_bf16 v[92:95], a[112:115], v[200:203], v[92:95]
  v_mfma_f32_16x16x32_bf16 v[96:99], a[116:119], v[200:203], v[96:99]
  v_mfma_f32_16x16x32_bf16 v[100:103], a[108:111], v[204:207], v[100:103]
  ds_read_b128 v[172:175], v18 offset:6144
  v_mfma_f32_16x16x32_bf16 v[104:107], a[112:115], v[204:207], v[104:107]
  buffer_store_dwordx4 v[240:243], v26, s[16:19], s21 offen offset:2048 sc1
  v_mfma_f32_16x16x32_bf16 v[108:111], a[116:119], v[204:207], v[108:111]
  s_waitcnt lgkmcnt(4)
  v_mfma_f32_16x16x32_bf16 v[112:115], a[108:111], v[208:211], v[112:115]
  ds_read_b128 v[176:179], v18 offset:8192
  v_mfma_f32_16x16x32_bf16 v[116:119], a[112:115], v[208:211], v[116:119]
  v_mfma_f32_16x16x32_bf16 v[120:123], a[116:119], v[208:211], v[120:123]
  v_mfma_f32_16x16x32_bf16 v[124:127], a[108:111], v[212:215], v[124:127]
  ds_read_b128 v[180:183], v18 offset:10240
  v_mfma_f32_16x16x32_bf16 v[128:131], a[112:115], v[212:215], v[128:131]
  buffer_load_dwordx4 v11, s[8:11], s30 offen offset:1024 lds
  v_mfma_f32_16x16x32_bf16 v[132:135], a[116:119], v[212:215], v[132:135]
  v_mfma_f32_16x16x32_bf16 v[136:139], a[108:111], v[216:219], v[136:139]
  ds_read_b128 v[184:187], v18 offset:12288
  v_mfma_f32_16x16x32_bf16 v[140:143], a[112:115], v[216:219], v[140:143]
  v_mfma_f32_16x16x32_bf16 v[144:147], a[116:119], v[216:219], v[144:147]
  v_mfma_f32_16x16x32_bf16 v[148:151], a[108:111], v[220:223], v[148:151]
  ds_read_b128 v[188:191], v18 offset:14336
  v_mfma_f32_16x16x32_bf16 v[152:155], a[112:115], v[220:223], v[152:155]
  buffer_store_dwordx4 v[244:247], v26, s[16:19], s21 offen offset:3072 sc1
  v_mfma_f32_16x16x32_bf16 v[156:159], a[116:119], v[220:223], v[156:159]
  s_waitcnt lgkmcnt(4)
  v_mfma_f32_16x16x32_bf16 v[64:67], a[120:123], v[160:163], v[64:67]
  ds_read_b128 v[192:195], v19 offset:0
  v_mfma_f32_16x16x32_bf16 v[68:71], a[124:127], v[160:163], v[68:71]
  v_add_u32 v18, s33, v14
  v_mfma_f32_16x16x32_bf16 v[72:75], a[128:131], v[160:163], v[72:75]
  v_mfma_f32_16x16x32_bf16 v[76:79], a[120:123], v[164:167], v[76:79]
  ds_read_b128 v[196:199], v19 offset:2048
  v_mfma_f32_16x16x32_bf16 v[80:83], a[124:127], v[164:167], v[80:83]
  buffer_load_dwordx4 v12, s[8:11], s30 offen offset:2048 lds
  v_mfma_f32_16x16x32_bf16 v[84:87], a[128:131], v[164:167], v[84:87]
  v_mfma_f32_16x16x32_bf16 v[88:91], a[120:123], v[168:171], v[88:91]
  ds_read_b128 v[200:203], v19 offset:4096
  v_mfma_f32_16x16x32_bf16 v[92:95], a[124:127], v[168:171], v[92:95]
  v_mfma_f32_16x16x32_bf16 v[96:99], a[128:131], v[168:171], v[96:99]
  v_mfma_f32_16x16x32_bf16 v[100:103], a[120:123], v[172:175], v[100:103]
  ds_read_b128 v[204:207], v19 offset:6144
  v_mfma_f32_16x16x32_bf16 v[104:107], a[124:127], v[172:175], v[104:107]
  v_mfma_f32_16x16x32_bf16 v[108:111], a[128:131], v[172:175], v[108:111]
  s_waitcnt lgkmcnt(4)
  v_mfma_f32_16x16x32_bf16 v[112:115], a[120:123], v[176:179], v[112:115]
  ds_read_b128 v[208:211], v19 offset:8192
  v_mfma_f32_16x16x32_bf16 v[116:119], a[124:127], v[176:179], v[116:119]
  v_mfma_f32_16x16x32_bf16 v[120:123], a[128:131], v[176:179], v[120:123]
  v_mfma_f32_16x16x32_bf16 v[124:127], a[120:123], v[180:183], v[124:127]
  ds_read_b128 v[212:215], v19 offset:10240
  v_mfma_f32_16x16x32_bf16 v[128:131], a[124:127], v[180:183], v[128:131]
  buffer_load_dwordx4 v13, s[8:11], s30 offen offset:3072 lds
  v_mfma_f32_16x16x32_bf16 v[132:135], a[128:131], v[180:183], v[132:135]
  s_add_u32 s30, s30, s25
  s_sub_u32 s30, s30, 1152
  v_mfma_f32_16x16x32_bf16 v[136:139], a[120:123], v[184:187], v[136:139]
  ds_read_b128 v[216:219], v19 offset:12288
  s_add_u32 m0, m0, 16384
  v_mfma_f32_16x16x32_bf16 v[140:143], a[124:127], v[184:187], v[140:143]
  s_cmp_lt_u32 m0, s46
  s_cselect_b32 m0, m0, s47
  v_mfma_f32_16x16x32_bf16 v[144:147], a[128:131], v[184:187], v[144:147]
  v_mfma_f32_16x16x32_bf16 v[148:151], a[120:123], v[188:191], v[148:151]
  ds_read_b128 v[220:223], v19 offset:14336
  v_mfma_f32_16x16x32_bf16 v[152:155], a[124:127], v[188:191], v[152:155]
  v_mfma_f32_16x16x32_bf16 v[156:159], a[128:131], v[188:191], v[156:159]
  s_waitcnt vmcnt(23) lgkmcnt(4)
  s_barrier
  v_mfma_f32_16x16x32_bf16 v[64:67], a[132:135], v[192:195], v[64:67]
  ds_read_b128 v[160:163], v18 offset:0
  v_mfma_f32_16x16x32_bf16 v[68:71], a[136:139], v[192:195], v[68:71]
  v_mfma_f32_16x16x32_bf16 v[72:75], a[140:143], v[192:195], v[72:75]
  v_add_u32 v19, s33, v15
  s_add_u32 s33, s33, 16384
  v_mfma_f32_16x16x32_bf16 v[76:79], a[132:135], v[196:199], v[76:79]
  ds_read_b128 v[164:167], v18 offset:2048
  v_mfma_f32_16x16x32_bf16 v[80:83], a[136:139], v[196:199], v[80:83]
  buffer_load_dwordx4 v10, s[8:11], s30 offen offset:0 lds
  v_mfma_f32_16x16x32_bf16 v[84:87], a[140:143], v[196:199], v[84:87]
  s_cmp_lt_u32 s33, 98304
  s_cselect_b32 s33, s33, 0
  v_mfma_f32_16x16x32_bf16 v[88:91], a[132:135], v[200:203], v[88:91]
  ds_read_b128 v[168:171], v18 offset:4096
  v_mfma_f32_16x16x32_bf16 v[92:95], a[136:139], v[200:203], v[92:95]
  v_mfma_f32_16x16x32_bf16 v[96:99], a[140:143], v[200:203], v[96:99]
  v_mfma_f32_16x16x32_bf16 v[100:103], a[132:135], v[204:207], v[100:103]
  ds_read_b128 v[172:175], v18 offset:6144
  v_mfma_f32_16x16x32_bf16 v[104:107], a[136:139], v[204:207], v[104:107]
  v_mfma_f32_16x16x32_bf16 v[108:111], a[140:143], v[204:207], v[108:111]
  s_waitcnt lgkmcnt(4)
  v_mfma_f32_16x16x32_bf16 v[112:115], a[132:135], v[208:211], v[112:115]
  ds_read_b128 v[176:179], v18 offset:8192
  v_mfma_f32_16x16x32_bf16 v[116:119], a[136:139], v[208:211], v[116:119]
  v_mfma_f32_16x16x32_bf16 v[120:123], a[140:143], v[208:211], v[120:123]
  v_mfma_f32_16x16x32_bf16 v[124:127], a[132:135], v[212:215], v[124:127]
  ds_read_b128 v[180:183], v18 offset:10240
  v_mfma_f32_16x16x32_bf16 v[128:131], a[136:139], v[212:215], v[128:131]
  buffer_load_dwordx4 v11, s[8:11], s30 offen offset:1024 lds
  v_mfma_f32_16x16x32_bf16 v[132:135], a[140:143], v[212:215], v[132:135]
  v_mfma_f32_16x16x32_bf16 v[136:139], a[132:135], v[216:219], v[136:139]
  ds_read_b128 v[184:187], v18 offset:12288
  v_mfma_f32_16x16x32_bf16 v[140:143], a[136:139], v[216:219], v[140:143]
  v_mfma_f32_16x16x32_bf16 v[144:147], a[140:143], v[216:219], v[144:147]
  v_mfma_f32_16x16x32_bf16 v[148:151], a[132:135], v[220:223], v[148:151]
  ds_read_b128 v[188:191], v18 offset:14336
  v_mfma_f32_16x16x32_bf16 v[152:155], a[136:139], v[220:223], v[152:155]
  v_mfma_f32_16x16x32_bf16 v[156:159], a[140:143], v[220:223], v[156:159]
  s_waitcnt lgkmcnt(4)
  v_mfma_f32_16x16x32_bf16 v[64:67], a[144:147], v[160:163], v[64:67]
  ds_read_b128 v[192:195], v19 offset:0
  v_mfma_f32_16x16x32_bf16 v[68:71], a[148:151], v[160:163], v[68:71]
  v_add_u32 v18, s33, v14
  v_mfma_f32_16x16x32_bf16 v[72:75], a[152:155], v[160:163], v[72:75]
  v_mfma_f32_16x16x32_bf16 v[76:79], a[144:147], v[164:167], v[76:79]
  ds_read_b128 v[196:199], v19 offset:2048
  v_mfma_f32_16x16x32_bf16 v[80:83], a[148:151], v[164:167], v[80:83]
  buffer_load_dwordx4 v12, s[8:11], s30 offen offset:2048 lds
  v_mfma_f32_16x16x32_bf16 v[84:87], a[152:155], v[164:167], v[84:87]
  v_mfma_f32_16x16x32_bf16 v[88:91], a[144:147], v[168:171], v[88:91]
  ds_read_b128 v[200:203], v19 offset:4096
  v_mfma_f32_16x16x32_bf16 v[92:95], a[148:151], v[168:171], v[92:95]
  v_mfma_f32_16x16x32_bf16 v[96:99], a[152:155], v[168:171], v[96:99]
  v_mfma_f32_16x16x32_bf16 v[100:103], a[144:147], v[172:175], v[100:103]
  ds_read_b128 v[204:207], v19 offset:6144
  v_mfma_f32_16x16x32_bf16 v[104:107], a[148:151], v[172:175], v[104:107]
  v_mfma_f32_16x16x32_bf16 v[108:111], a[152:155], v[172:175], v[108:111]
  s_waitcnt lgkmcnt(4)
  v_mfma_f32_16x16x32_bf16 v[112:115], a[144:147], v[176:179], v[112:115]
  ds_read_b128 v[208:211], v19 offset:8192
  v_mfma_f32_16x16x32_bf16 v[116:119], a[148:151], v[176:179], v[116:119]
  v_mfma_f32_16x16x32_bf16 v[120:123], a[152:155], v[176:179], v[120:123]
  v_mfma_f32_16x16x32_bf16 v[124:127], a[144:147], v[180:183], v[124:127]
  ds_read_b128 v[212:215], v19 offset:10240
  v_mfma_f32_16x16x32_bf16 v[128:131], a[148:151], v[180:183], v[128:131]
  buffer_load_dwordx4 v13, s[8:11], s30 offen offset:3072 lds
  v_mfma_f32_16x16x32_bf16 v[132:135], a[152:155], v[180:183], v[132:135]
  s_add_u32 s30, s30, 128
  s_add_u32 m0, m0, 16384
  v_mfma_f32_16x16x32_bf16 v[136:139], a[144:147], v[184:187], v[136:139]
  ds_read_b128 v[216:219], v19 offset:12288
  v_mfma_f32_16x16x32_bf16 v[140:143], a[148:151], v[184:187], v[140:143]
  s_cmp_lt_u32 m0, s46
  s_cselect_b32 m0, m0, s47
  v_mfma_f32_16x16x32_bf16 v[144:147], a[152:155], v[184:187], v[144:147]
  v_mfma_f32_16x16x32_bf16 v[148:151], a[144:147], v[188:191], v[148:151]
  ds_read_b128 v[220:223], v19 offset:14336
  v_mfma_f32_16x16x32_bf16 v[152:155], a[148:151], v[188:191], v[152:155]
  v_mfma_f32_16x16x32_bf16 v[156:159], a[152:155], v[188:191], v[156:159]
  s_waitcnt vmcnt(6) lgkmcnt(4)
  s_barrier
  v_mfma_f32_16x16x32_bf16 v[64:67], a[156:159], v[192:195], v[64:67]
  ds_read_b128 v[160:163], v18 offset:0
  v_mfma_f32_16x16x32_bf16 v[68:71], a[160:163], v[192:195], v[68:71]
  s_cmp_eq_u32 s48, 0x80000000
  s_cbranch_scc1 kv_148
  s_cmp_lg_u32 s20, 0
  s_cbranch_scc1 af_149
  v_mov_b32 v4, 0
  v_mov_b32 v5, 1
  s_mov_b64 exec, 1
  buffer_atomic_add v5, v4, s[72:75], s61 offen sc1
  s_mov_b64 exec, -1
  s_nop 1
af_149:
kv_148:
  v_mfma_f32_16x16x32_bf16 v[72:75], a[164:167], v[192:195], v[72:75]
  v_add_u32 v19, s33, v15
  s_add_u32 s33, s33, 16384
  v_mfma_f32_16x16x32_bf16 v[76:79], a[156:159], v[196:199], v[76:79]
  ds_read_b128 v[164:167], v18 offset:2048
  v_mfma_f32_16x16x32_bf16 v[80:83], a[160:163], v[196:199], v[80:83]
  buffer_load_dwordx4 v10, s[8:11], s30 offen offset:0 lds
  v_mfma_f32_16x16x32_bf16 v[84:87], a[164:167], v[196:199], v[84:87]
  s_cmp_lt_u32 s33, 98304
  s_cselect_b32 s33, s33, 0
  v_mfma_f32_16x16x32_bf16 v[88:91], a[156:159], v[200:203], v[88:91]
  ds_read_b128 v[168:171], v18 offset:4096
  v_mfma_f32_16x16x32_bf16 v[92:95], a[160:163], v[200:203], v[92:95]
  v_mfma_f32_16x16x32_bf16 v[96:99], a[164:167], v[200:203], v[96:99]
  v_mfma_f32_16x16x32_bf16 v[100:103], a[156:159], v[204:207], v[100:103]
  ds_read_b128 v[172:175], v18 offset:6144
  v_mfma_f32_16x16x32_bf16 v[104:107], a[160:163], v[204:207], v[104:107]
  v_mfma_f32_16x16x32_bf16 v[108:111], a[164:167], v[204:207], v[108:111]
  s_waitcnt lgkmcnt(4)
  v_mfma_f32_16x16x32_bf16 v[112:115], a[156:159], v[208:211], v[112:115]
  ds_read_b128 v[176:179], v18 offset:8192
  v_mfma_f32_16x16x32_bf16 v[116:119], a[160:163], v[208:211], v[116:119]
  v_mfma_f32_16x16x32_bf16 v[120:123], a[164:167], v[208:211], v[120:123]
  v_mfma_f32_16x16x32_bf16 v[124:127], a[156:159], v[212:215], v[124:127]
  ds_read_b128 v[180:183], v18 offset:10240
  v_mfma_f32_16x16x32_bf16 v[128:131], a[160:163], v[212:215], v[128:131]
  buffer_load_dwordx4 v11, s[8:11], s30 offen offset:1024 lds
  v_mfma_f32_16x16x32_bf16 v[132:135], a[164:167], v[212:215], v[132:135]
  v_mfma_f32_16x16x32_bf16 v[136:139], a[156:159], v[216:219], v[136:139]
  ds_read_b128 v[184:187], v18 offset:12288
  v_mfma_f32_16x16x32_bf16 v[140:143], a[160:163], v[216:219], v[140:143]
  v_mfma_f32_16x16x32_bf16 v[144:147], a[164:167], v[216:219], v[144:147]
  v_mfma_f32_16x16x32_bf16 v[148:151], a[156:159], v[220:223], v[148:151]
  ds_read_b128 v[188:191], v18 offset:14336
  v_mfma_f32_16x16x32_bf16 v[152:155], a[160:163], v[220:223], v[152:155]
  v_mfma_f32_16x16x32_bf16 v[156:159], a[164:167], v[220:223], v[156:159]
  s_waitcnt lgkmcnt(4)
  v_mfma_f32_16x16x32_bf16 v[64:67], a[168:171], v[160:163], v[64:67]
  ds_read_b128 v[192:195], v19 offset:0
  v_mfma_f32_16x16x32_bf16 v[68:71], a[172:175], v[160:163], v[68:71]
  v_add_u32 v18, s33, v14
  s_mov_b32 s61, s60
  v_mfma_f32_16x16x32_bf16 v[72:75], a[176:179], v[160:163], v[72:75]
  s_add_u32 s60, s60, s62
  s_mul_i32 s48, s20, 393216
  v_mfma_f32_16x16x32_bf16 v[76:79], a[168:171], v[164:167], v[76:79]
  ds_read_b128 v[196:199], v19 offset:2048
  s_add_u32 s48, s48, s27
  v_mfma_f32_16x16x32_bf16 v[80:83], a[172:175], v[164:167], v[80:83]
  buffer_load_dwordx4 v12, s[8:11], s30 offen offset:2048 lds
  v_mfma_f32_16x16x32_bf16 v[84:87], a[176:179], v[164:167], v[84:87]
  s_add_u32 s27, s27, s28
  s_sub_u32 s26, s26, 1
  v_mfma_f32_16x16x32_bf16 v[88:91], a[168:171], v[168:171], v[88:91]
  ds_read_b128 v[200:203], v19 offset:4096
  v_mfma_f32_16x16x32_bf16 v[92:95], a[172:175], v[168:171], v[92:95]
  v_mfma_f32_16x16x32_bf16 v[96:99], a[176:179], v[168:171], v[96:99]
  v_mfma_f32_16x16x32_bf16 v[100:103], a[168:171], v[172:175], v[100:103]
  ds_read_b128 v[204:207], v19 offset:6144
  v_mfma_f32_16x16x32_bf16 v[104:107], a[172:175], v[172:175], v[104:107]
  v_mfma_f32_16x16x32_bf16 v[108:111], a[176:179], v[172:175], v[108:111]
  s_waitcnt lgkmcnt(4)
  v_mfma_f32_16x16x32_bf16 v[112:115], a[168:171], v[176:179], v[112:115]
  ds_read_b128 v[208:211], v19 offset:8192
  v_mfma_f32_16x16x32_bf16 v[116:119], a[172:175], v[176:179], v[116:119]
  v_mfma_f32_16x16x32_bf16 v[120:123], a[176:179], v[176:179], v[120:123]
  v_mfma_f32_16x16x32_bf16 v[124:127], a[168:171], v[180:183], v[124:127]
  ds_read_b128 v[212:215], v19 offset:10240
  v_mfma_f32_16x16x32_bf16 v[128:131], a[172:175], v[180:183], v[128:131]
  buffer_load_dwordx4 v13, s[8:11], s30 offen offset:3072 lds
  v_mfma_f32_16x16x32_bf16 v[132:135], a[176:179], v[180:183], v[132:135]
  s_add_u32 s30, s30, 128
  s_add_u32 m0, m0, 16384
  v_mfma_f32_16x16x32_bf16 v[136:139], a[168:171], v[184:187], v[136:139]
  ds_read_b128 v[216:219], v19 offset:12288
  v_mfma_f32_16x16x32_bf16 v[140:143], a[172:175], v[184:187], v[140:143]
  s_cmp_lt_u32 m0, s46
  s_cselect_b32 m0, m0, s47
  v_mfma_f32_16x16x32_bf16 v[144:147], a[176:179], v[184:187], v[144:147]
  v_mfma_f32_16x16x32_bf16 v[148:151], a[168:171], v[188:191], v[148:151]
  ds_read_b128 v[220:223], v19 offset:14336
  v_mfma_f32_16x16x32_bf16 v[152:155], a[172:175], v[188:191], v[152:155]
  v_mfma_f32_16x16x32_bf16 v[156:159], a[176:179], v[188:191], v[156:159]
  s_waitcnt vmcnt(15) lgkmcnt(4)
  s_barrier
  v_mfma_f32_16x16x32_bf16 v[64:67], a[180:183], v[192:195], v[64:67]
  ds_read_b128 v[160:163], v18 offset:0
  v_mfma_f32_16x16x32_bf16 v[68:71], a[184:187], v[192:195], v[68:71]
  v_mfma_f32_16x16x32_bf16 v[72:75], a[188:191], v[192:195], v[72:75]
  v_add_u32 v19, s33, v15
  s_add_u32 s33, s33, 16384
  v_mfma_f32_16x16x32_bf16 v[76:79], a[180:183], v[196:199], v[76:79]
  ds_read_b128 v[164:167], v18 offset:2048
  v_mfma_f32_16x16x32_bf16 v[80:83], a[184:187], v[196:199], v[80:83]
  buffer_load_dwordx4 v10, s[8:11], s30 offen offset:0 lds
  v_mfma_f32_16x16x32_bf16 v[84:87], a[188:191], v[196:199], v[84:87]
  s_cmp_lt_u32 s33, 98304
  s_cselect_b32 s33, s33, 0
  v_mfma_f32_16x16x32_bf16 v[88:91], a[180:183], v[200:203], v[88:91]
  ds_read_b128 v[168:171], v18 offset:4096
  v_mfma_f32_16x16x32_bf16 v[92:95], a[184:187], v[200:203], v[92:95]
  v_mfma_f32_16x16x32_bf16 v[96:99], a[188:191], v[200:203], v[96:99]
  v_mfma_f32_16x16x32_bf16 v[100:103], a[180:183], v[204:207], v[100:103]
  ds_read_b128 v[172:175], v18 offset:6144
  v_mfma_f32_16x16x32_bf16 v[104:107], a[184:187], v[204:207], v[104:107]
  v_mfma_f32_16x16x32_bf16 v[108:111], a[188:191], v[204:207], v[108:111]
  s_waitcnt lgkmcnt(4)
  v_mfma_f32_16x16x32_bf16 v[112:115], a[180:183], v[208:211], v[112:115]
  ds_read_b128 v[176:179], v18 offset:8192
  v_mfma_f32_16x16x32_bf16 v[116:119], a[184:187], v[208:211], v[116:119]
  v_mfma_f32_16x16x32_bf16 v[120:123], a[188:191], v[208:211], v[120:123]
  v_mfma_f32_16x16x32_bf16 v[124:127], a[180:183], v[212:215], v[124:127]
  ds_read_b128 v[180:183], v18 offset:10240
  v_mfma_f32_16x16x32_bf16 v[128:131], a[184:187], v[212:215], v[128:131]
  buffer_load_dwordx4 v11, s[8:11], s30 offen offset:1024 lds
  v_mfma_f32_16x16x32_bf16 v[132:135], a[188:191], v[212:215], v[132:135]
  v_mfma_f32_16x16x32_bf16 v[136:139], a[180:183], v[216:219], v[136:139]
  ds_read_b128 v[184:187], v18 offset:12288
  v_mfma_f32_16x16x32_bf16 v[140:143], a[184:187], v[216:219], v[140:143]
  v_mfma_f32_16x16x32_bf16 v[144:147], a[188:191], v[216:219], v[144:147]
  v_mfma_f32_16x16x32_bf16 v[148:151], a[180:183], v[220:223], v[148:151]
  ds_read_b128 v[188:191], v18 offset:14336
  v_mfma_f32_16x16x32_bf16 v[152:155], a[184:187], v[220:223], v[152:155]
  v_mfma_f32_16x16x32_bf16 v[156:159], a[188:191], v[220:223], v[156:159]
  s_waitcnt lgkmcnt(4)
  v_mfma_f32_16x16x32_bf16 v[64:67], a[192:195], v[160:163], v[64:67]
  ds_read_b128 v[192:195], v19 offset:0
  v_mfma_f32_16x16x32_bf16 v[68:71], a[196:199], v[160:163], v[68:71]
  v_add_u32 v18, s33, v14
  v_mfma_f32_16x16x32_bf16 v[72:75], a[200:203], v[160:163], v[72:75]
  v_mfma_f32_16x16x32_bf16 v[76:79], a[192:195], v[164:167], v[76:79]
  ds_read_b128 v[196:199], v19 offset:2048
  v_mfma_f32_16x16x32_bf16 v[80:83], a[196:199], v[164:167], v[80:83]
  buffer_load_dwordx4 v12, s[8:11], s30 offen offset:2048 lds
  v_mfma_f32_16x16x32_bf16 v[84:87], a[200:203], v[164:167], v[84:87]
  v_mfma_f32_16x16x32_bf16 v[88:91], a[192:195], v[168:171], v[88:91]
  ds_read_b128 v[200:203], v19 offset:4096
  v_mfma_f32_16x16x32_bf16 v[92:95], a[196:199], v[168:171], v[92:95]
  v_mfma_f32_16x16x32_bf16 v[96:99], a[200:203], v[168:171], v[96:99]
  v_mfma_f32_16x16x32_bf16 v[100:103], a[192:195], v[172:175], v[100:103]
  ds_read_b128 v[204:207], v19 offset:6144
  v_mfma_f32_16x16x32_bf16 v[104:107], a[196:199], v[172:175], v[104:107]
  v_mfma_f32_16x16x32_bf16 v[108:111], a[200:203], v[172:175], v[108:111]
  s_waitcnt lgkmcnt(4)
  v_mfma_f32_16x16x32_bf16 v[112:115], a[192:195], v[176:179], v[112:115]
  ds_read_b128 v[208:211], v19 offset:8192
  v_mfma_f32_16x16x32_bf16 v[116:119], a[196:199], v[176:179], v[116:119]
  v_mfma_f32_16x16x32_bf16 v[120:123], a[200:203], v[176:179], v[120:123]
  v_mfma_f32_16x16x32_bf16 v[124:127], a[192:195], v[180:183], v[124:127]
  ds_read_b128 v[212:215], v19 offset:10240
  v_mfma_f32_16x16x32_bf16 v[128:131], a[196:199], v[180:183], v[128:131]
  buffer_load_dwordx4 v13, s[8:11], s30 offen offset:3072 lds
  v_mfma_f32_16x16x32_bf16 v[132:135], a[200:203], v[180:183], v[132:135]
  s_add_u32 s30, s30, 128
  s_add_u32 m0, m0, 16384
  v_mfma_f32_16x16x32_bf16 v[136:139], a[192:195], v[184:187], v[136:139]
  ds_read_b128 v[216:219], v19 offset:12288
  v_mfma_f32_16x16x32_bf16 v[140:143], a[196:199], v[184:187], v[140:143]
  s_cmp_lt_u32 m0, s46
  s_cselect_b32 m0, m0, s47
  v_mfma_f32_16x16x32_bf16 v[144:147], a[200:203], v[184:187], v[144:147]
  v_mfma_f32_16x16x32_bf16 v[148:151], a[192:195], v[188:191], v[148:151]
  ds_read_b128 v[220:223], v19 offset:14336
  v_mfma_f32_16x16x32_bf16 v[152:155], a[196:199], v[188:191], v[152:155]
  v_mfma_f32_16x16x32_bf16 v[156:159], a[200:203], v[188:191], v[156:159]
  s_waitcnt vmcnt(12) lgkmcnt(4)
  s_barrier
  v_mfma_f32_16x16x32_bf16 v[64:67], a[204:207], v[192:195], v[64:67]
  ds_read_b128 v[160:163], v18 offset:0
  v_mfma_f32_16x16x32_bf16 v[68:71], a[208:211], v[192:195], v[68:71]
  v_mfma_f32_16x16x32_bf16 v[72:75], a[212:215], v[192:195], v[72:75]
  v_add_u32 v19, s33, v15
  s_add_u32 s33, s33, 16384
  v_mfma_f32_16x16x32_bf16 v[76:79], a[204:207], v[196:199], v[76:79]
  ds_read_b128 v[164:167], v18 offset:2048
  v_mfma_f32_16x16x32_bf16 v[80:83], a[208:211], v[196:199], v[80:83]
  buffer_load_dwordx4 v10, s[8:11], s30 offen offset:0 lds
  v_mfma_f32_16x16x32_bf16 v[84:87], a[212:215], v[196:199], v[84:87]
  s_cmp_lt_u32 s33, 98304
  s_cselect_b32 s33, s33, 0
  v_mfma_f32_16x16x32_bf16 v[88:91], a[204:207], v[200:203], v[88:91]
  ds_read_b128 v[168:171], v18 offset:4096
  v_mfma_f32_16x16x32_bf16 v[92:95], a[208:211], v[200:203], v[92:95]
  v_mfma_f32_16x16x32_bf16 v[96:99], a[212:215], v[200:203], v[96:99]
  v_mfma_f32_16x16x32_bf16 v[100:103], a[204:207], v[204:207], v[100:103]
  ds_read_b128 v[172:175], v18 offset:6144
  v_mfma_f32_16x16x32_bf16 v[104:107], a[208:211], v[204:207], v[104:107]
  v_mfma_f32_16x16x32_bf16 v[108:111], a[212:215], v[204:207], v[108:111]
  s_waitcnt lgkmcnt(4)
  v_mfma_f32_16x16x32_bf16 v[112:115], a[204:207], v[208:211], v[112:115]
  ds_read_b128 v[176:179], v18 offset:8192
  v_mfma_f32_16x16x32_bf16 v[116:119], a[208:211], v[208:211], v[116:119]
  v_mfma_f32_16x16x32_bf16 v[120:123], a[212:215], v[208:211], v[120:123]
  v_mfma_f32_16x16x32_bf16 v[124:127], a[204:207], v[212:215], v[124:127]
  ds_read_b128 v[180:183], v18 offset:10240
  v_mfma_f32_16x16x32_bf16 v[128:131], a[208:211], v[212:215], v[128:131]
  buffer_load_dwordx4 v11, s[8:11], s30 offen offset:1024 lds
  v_mfma_f32_16x16x32_bf16 v[132:135], a[212:215], v[212:215], v[132:135]
  v_mfma_f32_16x16x32_bf16 v[136:139], a[204:207], v[216:219], v[136:139]
  ds_read_b128 v[184:187], v18 offset:12288
  v_mfma_f32_16x16x32_bf16 v[140:143], a[208:211], v[216:219], v[140:143]
  v_mfma_f32_16x16x32_bf16 v[144:147], a[212:215], v[216:219], v[144:147]
  v_mfma_f32_16x16x32_bf16 v[148:151], a[204:207], v[220:223], v[148:151]
  ds_read_b128 v[188:191], v18 offset:14336
  v_mfma_f32_16x16x32_bf16 v[152:155], a[208:211], v[220:223], v[152:155]
  v_mfma_f32_16x16x32_bf16 v[156:159], a[212:215], v[220:223], v[156:159]
  s_waitcnt lgkmcnt(4)
  v_mfma_f32_16x16x32_bf16 v[64:67], a[216:219], v[160:163], v[64:67]
  ds_read_b128 v[192:195], v19 offset:0
  v_mfma_f32_16x16x32_bf16 v[68:71], a[220:223], v[160:163], v[68:71]
  v_add_u32 v18, s33, v14
  v_mfma_f32_16x16x32_bf16 v[72:75], a[224:227], v[160:163], v[72:75]
  v_mfma_f32_16x16x32_bf16 v[76:79], a[216:219], v[164:167], v[76:79]
  ds_read_b128 v[196:199], v19 offset:2048
  v_mfma_f32_16x16x32_bf16 v[80:83], a[220:223], v[164:167], v[80:83]
  buffer_load_dwordx4 v12, s[8:11], s30 offen offset:2048 lds
  v_mfma_f32_16x16x32_bf16 v[84:87], a[224:227], v[164:167], v[84:87]
  v_mfma_f32_16x16x32_bf16 v[88:91], a[216:219], v[168:171], v[88:91]
  ds_read_b128 v[200:203], v19 offset:4096
  v_mfma_f32_16x16x32_bf16 v[92:95], a[220:223], v[168:171], v[92:95]
  v_mfma_f32_16x16x32_bf16 v[96:99], a[224:227], v[168:171], v[96:99]
  v_mfma_f32_16x16x32_bf16 v[100:103], a[216:219], v[172:175], v[100:103]
  ds_read_b128 v[204:207], v19 offset:6144
  v_mfma_f32_16x16x32_bf16 v[104:107], a[220:223], v[172:175], v[104:107]
  v_mfma_f32_16x16x32_bf16 v[108:111], a[224:227], v[172:175], v[108:111]
  s_waitcnt lgkmcnt(4)
  v_mfma_f32_16x16x32_bf16 v[112:115], a[216:219], v[176:179], v[112:115]
  ds_read_b128 v[208:211], v19 offset:8192
  v_mfma_f32_16x16x32_bf16 v[116:119], a[220:223], v[176:179], v[116:119]
  v_mfma_f32_16x16x32_bf16 v[120:123], a[224:227], v[176:179], v[120:123]
  v_mfma_f32_16x16x32_bf16 v[124:127], a[216:219], v[180:183], v[124:127]
  ds_read_b128 v[212:215], v19 offset:10240
  v_mfma_f32_16x16x32_bf16 v[128:131], a[220:223], v[180:183], v[128:131]
  buffer_load_dwordx4 v13, s[8:11], s30 offen offset:3072 lds
  v_mfma_f32_16x16x32_bf16 v[132:135], a[224:227], v[180:183], v[132:135]
  s_add_u32 s30, s30, 128
  s_add_u32 m0, m0, 16384
  v_mfma_f32_16x16x32_bf16 v[136:139], a[216:219], v[184:187], v[136:139]
  ds_read_b128 v[216:219], v19 offset:12288
  v_mfma_f32_16x16x32_bf16 v[140:143], a[220:223], v[184:187], v[140:143]
  s_cmp_lt_u32 m0, s46
  s_cselect_b32 m0, m0, s47
  v_mfma_f32_16x16x32_bf16 v[144:147], a[224:227], v[184:187], v[144:147]
  v_mfma_f32_16x16x32_bf16 v[148:151], a[216:219], v[188:191], v[148:151]
  ds_read_b128 v[220:223], v19 offset:14336
  v_mfma_f32_16x16x32_bf16 v[152:155], a[220:223], v[188:191], v[152:155]
  v_mfma_f32_16x16x32_bf16 v[156:159], a[224:227], v[188:191], v[156:159]
  s_waitcnt vmcnt(12) lgkmcnt(4)
  s_barrier
  v_mfma_f32_16x16x32_bf16 v[64:67], a[228:231], v[192:195], v[64:67]
  ds_read_b128 v[160:163], v18 offset:0
  v_mfma_f32_16x16x32_bf16 v[68:71], a[232:235], v[192:195], v[68:71]
  v_mfma_f32_16x16x32_bf16 v[72:75], a[236:239], v[192:195], v[72:75]
  v_add_u32 v19, s33, v15
  s_add_u32 s33, s33, 16384
  v_mfma_f32_16x16x32_bf16 v[76:79], a[228:231], v[196:199], v[76:79]
  ds_read_b128 v[164:167], v18 offset:2048
  v_cvt_pk_bf16_f32 v224, v64, v65
  v_mfma_f32_16x16x32_bf16 v[80:83], a[232:235], v[196:199], v[80:83]
  buffer_load_dwordx4 v10, s[8:11], s30 offen offset:0 lds
  v_mfma_f32_16x16x32_bf16 v[84:87], a[236:239], v[196:199], v[84:87]
  s_cmp_lt_u32 s33, 98304
  s_cselect_b32 s33, s33, 0
  v_mfma_f32_16x16x32_bf16 v[88:91], a[228:231], v[200:203], v[88:91]
  ds_read_b128 v[168:171], v18 offset:4096
  v_cvt_pk_bf16_f32 v225, v66, v67
  v_mfma_f32_16x16x32_bf16 v[92:95], a[232:235], v[200:203], v[92:95]
  v_cvt_pk_bf16_f32 v226, v68, v69
  v_cvt_pk_bf16_f32 v227, v70, v71
  v_mfma_f32_16x16x32_bf16 v[96:99], a[236:239], v[200:203], v[96:99]
  v_cvt_pk_bf16_f32 v228, v72, v73
  v_cvt_pk_bf16_f32 v229, v74, v75
  v_mfma_f32_16x16x32_bf16 v[100:103], a[228:231], v[204:207], v[100:103]
  ds_read_b128 v[172:175], v18 offset:6144
  v_mfma_f32_16x16x32_bf16 v[104:107], a[232:235], v[204:207], v[104:107]
  ds_write_b64 v22, v[224:225] offset:0
  v_mfma_f32_16x16x32_bf16 v[108:111], a[236:239], v[204:207], v[108:111]
  s_waitcnt lgkmcnt(5)
  v_mfma_f32_16x16x32_bf16 v[112:115], a[228:231], v[208:211], v[112:115]
  ds_read_b128 v[176:179], v18 offset:8192
  v_mfma_f32_16x16x32_bf16 v[116:119], a[232:235], v[208:211], v[116:119]
  ds_write_b64 v22, v[226:227] offset:8
  v_mfma_f32_16x16x32_bf16 v[120:123], a[236:239], v[208:211], v[120:123]
  ds_write_b64 v16, v[228:229] offset:64
  v_mfma_f32_16x16x32_bf16 v[124:127], a[228:231], v[212:215], v[124:127]
  ds_read_b128 v[180:183], v18 offset:10240
  v_cvt_pk_bf16_f32 v230, v76, v77
  v_mfma_f32_16x16x32_bf16 v[128:131], a[232:235], v[212:215], v[128:131]
  buffer_load_dwordx4 v11, s[8:11], s30 offen offset:1024 lds
  v_mfma_f32_16x16x32_bf16 v[132:135], a[236:239], v[212:215], v[132:135]
  v_cvt_pk_bf16_f32 v231, v78, v79
  v_cvt_pk_bf16_f32 v232, v80, v81
  v_mfma_f32_16x16x32_bf16 v[136:139], a[228:231], v[216:219], v[136:139]
  ds_read_b128 v[184:187], v18 offset:12288
  v_cvt_pk_bf16_f32 v233, v82, v83
  v_mfma_f32_16x16x32_bf16 v[140:143], a[232:235], v[216:219], v[140:143]
  v_cvt_pk_bf16_f32 v234, v84, v85
  v_cvt_pk_bf16_f32 v235, v86, v87
  v_mfma_f32_16x16x32_bf16 v[144:147], a[236:239], v[216:219], v[144:147]
  ds_write_b64 v22, v[230:231] offset:6400
  v_mfma_f32_16x16x32_bf16 v[148:151], a[228:231], v[220:223], v[148:151]
  ds_read_b128 v[188:191], v18 offset:14336
  v_mfma_f32_16x16x32_bf16 v[152:155], a[232:235], v[220:223], v[152:155]
  ds_write_b64 v22, v[232:233] offset:6408
  v_mfma_f32_16x16x32_bf16 v[156:159], a[236:239], v[220:223], v[156:159]
  s_waitcnt lgkmcnt(9)
kv_end_151:
  s_cmp_gt_u32 s26, 0
  s_cbranch_scc1 kv_blk_150
  s_nop 7
  ds_write_b64 v16, v[234:235] offset:6464
  v_cvt_pk_bf16_f32 v236, v88, v89
  v_cvt_pk_bf16_f32 v237, v90, v91
  v_cvt_pk_bf16_f32 v238, v92, v93
  v_cvt_pk_bf16_f32 v239, v94, v95
  v_cvt_pk_bf16_f32 v240, v96, v97
  v_cvt_pk_bf16_f32 v241, v98, v99
  ds_write_b64 v22, v[236:237] offset:12800
  ds_write_b64 v22, v[238:239] offset:12808
  ds_write_b64 v16, v[240:241] offset:12864
  v_cvt_pk_bf16_f32 v242, v100, v101
  v_cvt_pk_bf16_f32 v243, v102, v103
  v_cvt_pk_bf16_f32 v244, v104, v105
  v_cvt_pk_bf16_f32 v245, v106, v107
  v_cvt_pk_bf16_f32 v246, v108, v109
  v_cvt_pk_bf16_f32 v247, v110, v111
  ds_write_b64 v22, v[242:243] offset:19200
  ds_write_b64 v22, v[244:245] offset:19208
  ds_write_b64 v16, v[246:247] offset:19264
  v_cvt_pk_bf16_f32 v224, v112, v113
  v_cvt_pk_bf16_f32 v225, v114, v115
  v_cvt_pk_bf16_f32 v226, v116, v117
  v_cvt_pk_bf16_f32 v227, v118, v119
  v_cvt_pk_bf16_f32 v228, v120, v121
  v_cvt_pk_bf16_f32 v229, v122, v123
  ds_write_b64 v22, v[224:225] offset:25600
  ds_write_b64 v22, v[226:227] offset:25608
  ds_write_b64 v16, v[228:229] offset:25664
  v_cvt_pk_bf16_f32 v230, v124, v125
  v_cvt_pk_bf16_f32 v231, v126, v127
  v_cvt_pk_bf16_f32 v232, v128, v129
  v_cvt_pk_bf16_f32 v233, v130, v131
  v_cvt_pk_bf16_f32 v234, v132, v133
  v_cvt_pk_bf16_f32 v235, v134, v135
  ds_write_b64 v22, v[230:231] offset:32000
  ds_write_b64 v22, v[232:233] offset:32008
  ds_write_b64 v16, v[234:235] offset:32064
  v_cvt_pk_bf16_f32 v236, v136, v137
  v_cvt_pk_bf16_f32 v237, v138, v139
  v_cvt_pk_bf16_f32 v238, v140, v141
  v_cvt_pk_bf16_f32 v239, v142, v143
  v_cvt_pk_bf16_f32 v240, v144, v145
  v_cvt_pk_bf16_f32 v241, v146, v147
  ds_write_b64 v22, v[236:237] offset:38400
  ds_write_b64 v22, v[238:239] offset:38408
  ds_write_b64 v16, v[240:241] offset:38464
  v_cvt_pk_bf16_f32 v242, v148, v149
  v_cvt_pk_bf16_f32 v243, v150, v151
  v_cvt_pk_bf16_f32 v244, v152, v153
  v_cvt_pk_bf16_f32 v245, v154, v155
  v_cvt_pk_bf16_f32 v246, v156, v157
  v_cvt_pk_bf16_f32 v247, v158, v159
  ds_write_b64 v22, v[242:243] offset:44800
  ds_write_b64 v22, v[244:245] offset:44808
  ds_write_b64 v16, v[246:247] offset:44864
  s_waitcnt vmcnt(0) lgkmcnt(0)
  s_barrier
  ds_read_b128 v[224:227], v23 offset:0
  ds_read_b128 v[228:231], v23 offset:64
  ds_read_b128 v[232:235], v23 offset:128
  ds_read_b128 v[236:239], v23 offset:192
  ds_read_b128 v[240:243], v23 offset:256
  ds_read_b128 v[244:247], v23 offset:320
  s_waitcnt lgkmcnt(0)
  s_add_u32 s21, s48, 0
  buffer_store_dwordx4 v[224:227], v26, s[16:19], s21 offen offset:0 sc1
  buffer_store_dwordx4 v[228:231], v26, s[16:19], s21 offen offset:1024 sc1
  buffer_store_dwordx4 v[232:235], v26, s[16:19], s21 offen offset:2048 sc1
  buffer_store_dwordx4 v[236:239], v26, s[16:19], s21 offen offset:3072 sc1
  s_add_u32 s21, s48, 4096
  buffer_store_dwordx4 v[240:243], v26, s[16:19], s21 offen offset:0 sc1
  buffer_store_dwordx4 v[244:247], v26, s[16:19], s21 offen offset:1024 sc1
  s_nop 1
  ds_read_b128 v[224:227], v23 offset:6400
  ds_read_b128 v[228:231], v23 offset:6464
  ds_read_b128 v[232:235], v23 offset:6528
  ds_read_b128 v[236:239], v23 offset:6592
  ds_read_b128 v[240:243], v23 offset:6656
  ds_read_b128 v[244:247], v23 offset:6720
  s_waitcnt lgkmcnt(0)
  buffer_store_dwordx4 v[224:227], v26, s[16:19], s21 offen offset:2048 sc1
  buffer_store_dwordx4 v[228:231], v26, s[16:19], s21 offen offset:3072 sc1
  s_add_u32 s21, s48, 8192
  buffer_store_dwordx4 v[232:235], v26, s[16:19], s21 offen offset:0 sc1
  buffer_store_dwordx4 v[236:239], v26, s[16:19], s21 offen offset:1024 sc1
  buffer_store_dwordx4 v[240:243], v26, s[16:19], s21 offen offset:2048 sc1
  buffer_store_dwordx4 v[244:247], v26, s[16:19], s21 offen offset:3072 sc1
  s_nop 1
  s_waitcnt vmcnt(0)
  s_barrier
  s_cmp_lg_u32 s20, 0
  s_cbranch_scc1 af_152
  v_mov_b32 v4, 0
  v_mov_b32 v5, 1
  s_mov_b64 exec, 1
  buffer_atomic_add v5, v4, s[72:75], s61 offen sc1
  s_mov_b64 exec, -1
  s_nop 1
af_152:
  s_cmp_lg_u32 s43, 0
  s_cbranch_scc1 kv_fin
  s_mov_b32 s87, -2
  s_add_u32 s21, s42, 32
  s_branch do_opb2
kv_help:
  s_waitcnt vmcnt(0) lgkmcnt(0)
  s_barrier
  s_load_dwordx2 s[4:5], s[0:1], 0
  s_load_dwordx2 s[6:7], s[0:1], 24
  s_load_dwordx2 s[36:37], s[0:1], 32
  s_load_dwordx2 s[38:39], s[0:1], 104
  s_and_b32 s43, s3, 1
  s_bfe_u32 s42, s3, 0x50001
  s_lshr_b32 s40, s42, 2
  s_waitcnt lgkmcnt(0)
  s_cmp_eq_u32 s43, 1
  s_cselect_b32 s6, s36, s6
  s_cselect_b32 s7, s37, s7
  s_mov_b32 s8, s4
  s_mov_b32 s9, s5
  s_mov_b32 s10, 2621440
  s_mov_b32 s11, 0x00020000
  s_mov_b32 s12, s6
  s_mov_b32 s13, s7
  s_mov_b32 s14, 7864320
  s_mov_b32 s15, 0x00020000
  s_mov_b32 s16, s38
  s_mov_b32 s17, s39
  s_mov_b32 s18, 50331648
  s_mov_b32 s19, 0x00020000
  s_mul_i32 s44, s42, 384
  s_mov_b32 s28, 1572864
  s_mov_b32 s43, 2
  s_load_dwordx2 s[6:7], s[0:1], 16
  s_waitcnt lgkmcnt(0)
  s_mov_b32 s12, s6
  s_mov_b32 s13, s7
  s_mov_b32 s14, 7864320
  s_mov_b32 s15, 0x00020000
  s_add_u32 s16, s38, 201326592
  s_addc_u32 s17, s39, 0
  s_mov_b32 s18, 4718592
  s_mov_b32 s19, 0x00020000
  v_mov_b32 v9, 2731
  v_add_u32 v8, 0, v1
  v_mul_u32_u24 v7, v8, v9
  v_lshrrev_b32 v7, 16, v7
  v_mul_u32_u24 v4, 24, v7
  v_sub_u32 v8, v8, v4
  s_mov_b32 s21, 12288
  v_mul_lo_u32 v7, v7, s21
  v_lshl_add_u32 v4, v8, 4, v7
  v_add_u32 v8, 64, v1
  v_mul_u32_u24 v7, v8, v9
  v_lshrrev_b32 v7, 16, v7
  v_mul_u32_u24 v5, 24, v7
  v_sub_u32 v8, v8, v5
  s_mov_b32 s21, 12288
  v_mul_lo_u32 v7, v7, s21
  v_lshl_add_u32 v5, v8, 4, v7
  v_add_u32 v8, 128, v1
  v_mul_u32_u24 v7, v8, v9
  v_lshrrev_b32 v7, 16, v7
  v_mul_u32_u24 v6, 24, v7
  v_sub_u32 v8, v8, v6
  s_mov_b32 s21, 12288
  v_mul_lo_u32 v7, v7, s21
  v_lshl_add_u32 v6, v8, 4, v7
  v_lshrrev_b32 v7, 2, v2
  v_lshl_add_u32 v7, v3, 3, v7
  v_mul_u32_u24 v7, 384, v7
  v_and_b32 v8, 3, v2
  v_lshlrev_b32 v8, 3, v8
  s_mul_i32 s21, s20, 96
  v_add3_u32 v7, v7, v8, s21
  v_add_u32 v8, 61440, v7
  s_mul_i32 s21, s20, 491520
  s_add_u32 s21, s21, 0
  s_add_u32 s21, s21, s44
  s_mul_i32 s22, s20, 15360
  s_add_u32 s22, s22, 0
  s_add_u32 m0, s22, 0
  s_nop 0
  buffer_load_dwordx4 v4, s[12:15], s21 offen lds
  s_add_u32 m0, s22, 1024
  s_nop 0
  buffer_load_dwordx4 v5, s[12:15], s21 offen lds
  s_add_u32 m0, s22, 2048
  s_nop 0
  buffer_load_dwordx4 v6, s[12:15], s21 offen lds
  s_mul_i32 s21, s20, 491520
  s_add_u32 s21, s21, 98304
  s_add_u32 s21, s21, s44
  s_mul_i32 s22, s20, 15360
  s_add_u32 s22, s22, 3072
  s_add_u32 m0, s22, 0
  s_nop 0
  buffer_load_dwordx4 v4, s[12:15], s21 offen lds
  s_add_u32 m0, s22, 1024
  s_nop 0
  buffer_load_dwordx4 v5, s[12:15], s21 offen lds
  s_add_u32 m0, s22, 2048
  s_nop 0
  buffer_load_dwordx4 v6, s[12:15], s21 offen lds
  s_mul_i32 s21, s20, 491520
  s_add_u32 s21, s21, 196608
  s_add_u32 s21, s21, s44
  s_mul_i32 s22, s20, 15360
  s_add_u32 s22, s22, 6144
  s_add_u32 m0, s22, 0
  s_nop 0
  buffer_load_dwordx4 v4, s[12:15], s21 offen lds
  s_add_u32 m0, s22, 1024
  s_nop 0
  buffer_load_dwordx4 v5, s[12:15], s21 offen lds
  s_add_u32 m0, s22, 2048
  s_nop 0
  buffer_load_dwordx4 v6, s[12:15], s21 offen lds
  s_mul_i32 s21, s20, 491520
  s_add_u32 s21, s21, 294912
  s_add_u32 s21, s21, s44
  s_mul_i32 s22, s20, 15360
  s_add_u32 s22, s22, 9216
  s_add_u32 m0, s22, 0
  s_nop 0
  buffer_load_dwordx4 v4, s[12:15], s21 offen lds
  s_add_u32 m0, s22, 1024
  s_nop 0
  buffer_load_dwordx4 v5, s[12:15], s21 offen lds
  s_add_u32 m0, s22, 2048
  s_nop 0
  buffer_load_dwordx4 v6, s[12:15], s21 offen lds
  s_mul_i32 s21, s20, 491520
  s_add_u32 s21, s21, 393216
  s_add_u32 s21, s21, s44
  s_mul_i32 s22, s20, 15360
  s_add_u32 s22, s22, 12288
  s_add_u32 m0, s22, 0
  s_nop 0
  buffer_load_dwordx4 v4, s[12:15], s21 offen lds
  s_add_u32 m0, s22, 1024
  s_nop 0
  buffer_load_dwordx4 v5, s[12:15], s21 offen lds
  s_add_u32 m0, s22, 2048
  s_nop 0
  buffer_load_dwordx4 v6, s[12:15], s21 offen lds
  s_mul_i32 s21, s20, 491520
  s_add_u32 s21, s21, 1966080
  s_add_u32 s21, s21, s44
  s_mul_i32 s22, s20, 15360
  s_add_u32 s22, s22, 61440
  s_add_u32 m0, s22, 0
  s_nop 0
  buffer_load_dwordx4 v4, s[12:15], s21 offen lds
  s_add_u32 m0, s22, 1024
  s_nop 0
  buffer_load_dwordx4 v5, s[12:15], s21 offen lds
  s_add_u32 m0, s22, 2048
  s_nop 0
  buffer_load_dwordx4 v6, s[12:15], s21 offen lds
  s_mul_i32 s21, s20, 491520
  s_add_u32 s21, s21, 2064384
  s_add_u32 s21, s21, s44
  s_mul_i32 s22, s20, 15360
  s_add_u32 s22, s22, 64512
  s_add_u32 m0, s22, 0
  s_nop 0
  buffer_load_dwordx4 v4, s[12:15], s21 offen lds
  s_add_u32 m0, s22, 1024
  s_nop 0
  buffer_load_dwordx4 v5, s[12:15], s21 offen lds
  s_add_u32 m0, s22, 2048
  s_nop 0
  buffer_load_dwordx4 v6, s[12:15], s21 offen lds
  s_mul_i32 s21, s20, 491520
  s_add_u32 s21, s21, 2162688
  s_add_u32 s21, s21, s44
  s_mul_i32 s22, s20, 15360
  s_add_u32 s22, s22, 67584
  s_add_u32 m0, s22, 0
  s_nop 0
  buffer_load_dwordx4 v4, s[12:15], s21 offen lds
  s_add_u32 m0, s22, 1024
  s_nop 0
  buffer_load_dwordx4 v5, s[12:15], s21 offen lds
  s_add_u32 m0, s22, 2048
  s_nop 0
  buffer_load_dwordx4 v6, s[12:15], s21 offen lds
  s_mul_i32 s21, s20, 491520
  s_add_u32 s21, s21, 2260992
  s_add_u32 s21, s21, s44
  s_mul_i32 s22, s20, 15360
  s_add_u32 s22, s22, 70656
  s_add_u32 m0, s22, 0
  s_nop 0
  buffer_load_dwordx4 v4, s[12:15], s21 offen lds
  s_add_u32 m0, s22, 1024
  s_nop 0
  buffer_load_dwordx4 v5, s[12:15], s21 offen lds
  s_add_u32 m0, s22, 2048
  s_nop 0
  buffer_load_dwordx4 v6, s[12:15], s21 offen lds
  s_mul_i32 s21, s20, 491520
  s_add_u32 s21, s21, 2359296
  s_add_u32 s21, s21, s44
  s_mul_i32 s22, s20, 15360
  s_add_u32 s22, s22, 73728
  s_add_u32 m0, s22, 0
  s_nop 0
  buffer_load_dwordx4 v4, s[12:15], s21 offen lds
  s_add_u32 m0, s22, 1024
  s_nop 0
  buffer_load_dwordx4 v5, s[12:15], s21 offen lds
  s_add_u32 m0, s22, 2048
  s_nop 0
  buffer_load_dwordx4 v6, s[12:15], s21 offen lds
  s_mul_i32 s21, s20, 491520
  s_add_u32 s21, s21, 3932160
  s_add_u32 s21, s21, s44
  buffer_load_dwordx4 v[64:67], v4, s[12:15], s21 offen
  buffer_load_dwordx4 v[68:71], v5, s[12:15], s21 offen
  buffer_load_dwordx4 v[72:75], v6, s[12:15], s21 offen
  s_mul_i32 s21, s20, 491520
  s_add_u32 s21, s21, 4030464
  s_add_u32 s21, s21, s44
  buffer_load_dwordx4 v[76:79], v4, s[12:15], s21 offen
  buffer_load_dwordx4 v[80:83], v5, s[12:15], s21 offen
  buffer_load_dwordx4 v[84:87], v6, s[12:15], s21 offen
  s_mul_i32 s21, s20, 491520
  s_add_u32 s21, s21, 4128768
  s_add_u32 s21, s21, s44
  buffer_load_dwordx4 v[88:91], v4, s[12:15], s21 offen
  buffer_load_dwordx4 v[92:95], v5, s[12:15], s21 offen
  buffer_load_dwordx4 v[96:99], v6, s[12:15], s21 offen
  s_mul_i32 s21, s20, 491520
  s_add_u32 s21, s21, 4227072
  s_add_u32 s21, s21, s44
  buffer_load_dwordx4 v[100:103], v4, s[12:15], s21 offen
  buffer_load_dwordx4 v[104:107], v5, s[12:15], s21 offen
  buffer_load_dwordx4 v[108:111], v6, s[12:15], s21 offen
  s_mul_i32 s21, s20, 491520
  s_add_u32 s21, s21, 4325376
  s_add_u32 s21, s21, s44
  buffer_load_dwordx4 v[112:115], v4, s[12:15], s21 offen
  buffer_load_dwordx4 v[116:119], v5, s[12:15], s21 offen
  buffer_load_dwordx4 v[120:123], v6, s[12:15], s21 offen
  s_mul_i32 s21, s20, 491520
  s_add_u32 s21, s21, 5898240
  s_add_u32 s21, s21, s44
  buffer_load_dwordx4 v[124:127], v4, s[12:15], s21 offen
  buffer_load_dwordx4 v[128:131], v5, s[12:15], s21 offen
  buffer_load_dwordx4 v[132:135], v6, s[12:15], s21 offen
  s_mul_i32 s21, s20, 491520
  s_add_u32 s21, s21, 5996544
  s_add_u32 s21, s21, s44
  buffer_load_dwordx4 v[136:139], v4, s[12:15], s21 offen
  buffer_load_dwordx4 v[140:143], v5, s[12:15], s21 offen
  buffer_load_dwordx4 v[144:147], v6, s[12:15], s21 offen
  s_mul_i32 s21, s20, 491520
  s_add_u32 s21, s21, 6094848
  s_add_u32 s21, s21, s44
  buffer_load_dwordx4 v[148:151], v4, s[12:15], s21 offen
  buffer_load_dwordx4 v[152:155], v5, s[12:15], s21 offen
  buffer_load_dwordx4 v[156:159], v6, s[12:15], s21 offen
  s_mul_i32 s21, s20, 491520
  s_add_u32 s21, s21, 6193152
  s_add_u32 s21, s21, s44
  buffer_load_dwordx4 v[160:163], v4, s[12:15], s21 offen
  buffer_load_dwordx4 v[164:167], v5, s[12:15], s21 offen
  buffer_load_dwordx4 v[168:171], v6, s[12:15], s21 offen
  s_mul_i32 s21, s20, 491520
  s_add_u32 s21, s21, 6291456
  s_add_u32 s21, s21, s44
  buffer_load_dwordx4 v[172:175], v4, s[12:15], s21 offen
  buffer_load_dwordx4 v[176:179], v5, s[12:15], s21 offen
  buffer_load_dwordx4 v[180:183], v6, s[12:15], s21 offen
  s_mul_i32 s22, s20, 15360
  v_lshl_add_u32 v30, v1, 4, s22
  v_add_u32 v31, 61440, v30
  s_waitcnt vmcnt(45)
  s_barrier
  ds_read_b64_tr_b16 a[0:1], v7 offset:0
  ds_read_b64_tr_b16 a[2:3], v7 offset:1536
  ds_read_b64_tr_b16 a[4:5], v7 offset:32
  ds_read_b64_tr_b16 a[6:7], v7 offset:1568
  ds_read_b64_tr_b16 a[8:9], v7 offset:64
  ds_read_b64_tr_b16 a[10:11], v7 offset:1600
  ds_read_b64_tr_b16 a[12:13], v7 offset:12288
  ds_read_b64_tr_b16 a[14:15], v7 offset:13824
  ds_read_b64_tr_b16 a[16:17], v7 offset:12320
  ds_read_b64_tr_b16 a[18:19], v7 offset:13856
  ds_read_b64_tr_b16 a[20:21], v7 offset:12352
  ds_read_b64_tr_b16 a[22:23], v7 offset:13888
  ds_read_b64_tr_b16 a[24:25], v7 offset:24576
  ds_read_b64_tr_b16 a[26:27], v7 offset:26112
  ds_read_b64_tr_b16 a[28:29], v7 offset:24608
  ds_read_b64_tr_b16 a[30:31], v7 offset:26144
  ds_read_b64_tr_b16 a[32:33], v7 offset:24640
  ds_read_b64_tr_b16 a[34:35], v7 offset:26176
  ds_read_b64_tr_b16 a[36:37], v7 offset:36864
  ds_read_b64_tr_b16 a[38:39], v7 offset:38400
  ds_read_b64_tr_b16 a[40:41], v7 offset:36896
  ds_read_b64_tr_b16 a[42:43], v7 offset:38432
  ds_read_b64_tr_b16 a[44:45], v7 offset:36928
  ds_read_b64_tr_b16 a[46:47], v7 offset:38464
  ds_read_b64_tr_b16 a[48:49], v7 offset:49152
  ds_read_b64_tr_b16 a[50:51], v7 offset:50688
  ds_read_b64_tr_b16 a[52:53], v7 offset:49184
  ds_read_b64_tr_b16 a[54:55], v7 offset:50720
  ds_read_b64_tr_b16 a[56:57], v7 offset:49216
  ds_read_b64_tr_b16 a[58:59], v7 offset:50752
  s_waitcnt lgkmcnt(0)
  s_barrier
  s_waitcnt vmcnt(30)
  s_barrier
  ds_read_b64_tr_b16 a[60:61], v8 offset:0
  ds_read_b64_tr_b16 a[62:63], v8 offset:1536
  ds_read_b64_tr_b16 a[64:65], v8 offset:32
  ds_read_b64_tr_b16 a[66:67], v8 offset:1568
  ds_read_b64_tr_b16 a[68:69], v8 offset:64
  ds_read_b64_tr_b16 a[70:71], v8 offset:1600
  ds_read_b64_tr_b16 a[72:73], v8 offset:12288
  ds_read_b64_tr_b16 a[74:75], v8 offset:13824
  ds_read_b64_tr_b16 a[76:77], v8 offset:12320
  ds_read_b64_tr_b16 a[78:79], v8 offset:13856
  ds_read_b64_tr_b16 a[80:81], v8 offset:12352
  ds_read_b64_tr_b16 a[82:83], v8 offset:13888
  ds_read_b64_tr_b16 a[84:85], v8 offset:24576
  ds_read_b64_tr_b16 a[86:87], v8 offset:26112
  ds_read_b64_tr_b16 a[88:89], v8 offset:24608
  ds_read_b64_tr_b16 a[90:91], v8 offset:26144
  ds_read_b64_tr_b16 a[92:93], v8 offset:24640
  ds_read_b64_tr_b16 a[94:95], v8 offset:26176
  ds_read_b64_tr_b16 a[96:97], v8 offset:36864
  ds_read_b64_tr_b16 a[98:99], v8 offset:38400
  ds_read_b64_tr_b16 a[100:101], v8 offset:36896
  ds_read_b64_tr_b16 a[102:103], v8 offset:38432
  ds_read_b64_tr_b16 a[104:105], v8 offset:36928
  ds_read_b64_tr_b16 a[106:107], v8 offset:38464
  ds_read_b64_tr_b16 a[108:109], v8 offset:49152
  ds_read_b64_tr_b16 a[110:111], v8 offset:50688
  ds_read_b64_tr_b16 a[112:113], v8 offset:49184
  ds_read_b64_tr_b16 a[114:115], v8 offset:50720
  ds_read_b64_tr_b16 a[116:117], v8 offset:49216
  ds_read_b64_tr_b16 a[118:119], v8 offset:50752
  s_waitcnt lgkmcnt(0)
  s_barrier
  s_waitcnt vmcnt(15)
  ds_write_b128 v30, v[64:67] offset:0
  ds_write_b128 v30, v[68:71] offset:1024
  ds_write_b128 v30, v[72:75] offset:2048
  ds_write_b128 v30, v[76:79] offset:3072
  ds_write_b128 v30, v[80:83] offset:4096
  ds_write_b128 v30, v[84:87] offset:5120
  ds_write_b128 v30, v[88:91] offset:6144
  ds_write_b128 v30, v[92:95] offset:7168
  ds_write_b128 v30, v[96:99] offset:8192
  ds_write_b128 v30, v[100:103] offset:9216
  ds_write_b128 v30, v[104:107] offset:10240
  ds_write_b128 v30, v[108:111] offset:11264
  ds_write_b128 v30, v[112:115] offset:12288
  ds_write_b128 v30, v[116:119] offset:13312
  ds_write_b128 v30, v[120:123] offset:14336
  s_waitcnt lgkmcnt(0)
  s_barrier
  ds_read_b64_tr_b16 a[120:121], v7 offset:0
  ds_read_b64_tr_b16 a[122:123], v7 offset:1536
  ds_read_b64_tr_b16 a[124:125], v7 offset:32
  ds_read_b64_tr_b16 a[126:127], v7 offset:1568
  ds_read_b64_tr_b16 a[128:129], v7 offset:64
  ds_read_b64_tr_b16 a[130:131], v7 offset:1600
  ds_read_b64_tr_b16 a[132:133], v7 offset:12288
  ds_read_b64_tr_b16 a[134:135], v7 offset:13824
  ds_read_b64_tr_b16 a[136:137], v7 offset:12320
  ds_read_b64_tr_b16 a[138:139], v7 offset:13856
  ds_read_b64_tr_b16 a[140:141], v7 offset:12352
  ds_read_b64_tr_b16 a[142:143], v7 offset:13888
  ds_read_b64_tr_b16 a[144:145], v7 offset:24576
  ds_read_b64_tr_b16 a[146:147], v7 offset:26112
  ds_read_b64_tr_b16 a[148:149], v7 offset:24608
  ds_read_b64_tr_b16 a[150:151], v7 offset:26144
  ds_read_b64_tr_b16 a[152:153], v7 offset:24640
  ds_read_b64_tr_b16 a[154:155], v7 offset:26176
  ds_read_b64_tr_b16 a[156:157], v7 offset:36864
  ds_read_b64_tr_b16 a[158:159], v7 offset:38400
  ds_read_b64_tr_b16 a[160:161], v7 offset:36896
  ds_read_b64_tr_b16 a[162:163], v7 offset:38432
  ds_read_b64_tr_b16 a[164:165], v7 offset:36928
  ds_read_b64_tr_b16 a[166:167], v7 offset:38464
  ds_read_b64_tr_b16 a[168:169], v7 offset:49152
  ds_read_b64_tr_b16 a[170:171], v7 offset:50688
  ds_read_b64_tr_b16 a[172:173], v7 offset:49184
  ds_read_b64_tr_b16 a[174:175], v7 offset:50720
  ds_read_b64_tr_b16 a[176:177], v7 offset:49216
  ds_read_b64_tr_b16 a[178:179], v7 offset:50752
  s_waitcnt lgkmcnt(0)
  s_barrier
  s_waitcnt vmcnt(0)
  ds_write_b128 v31, v[124:127] offset:0
  ds_write_b128 v31, v[128:131] offset:1024
  ds_write_b128 v31, v[132:135] offset:2048
  ds_write_b128 v31, v[136:139] offset:3072
  ds_write_b128 v31, v[140:143] offset:4096
  ds_write_b128 v31, v[144:147] offset:5120
  ds_write_b128 v31, v[148:151] offset:6144
  ds_write_b128 v31, v[152:155] offset:7168
  ds_write_b128 v31, v[156:159] offset:8192
  ds_write_b128 v31, v[160:163] offset:9216
  ds_write_b128 v31, v[164:167] offset:10240
  ds_write_b128 v31, v[168:171] offset:11264
  ds_write_b128 v31, v[172:175] offset:12288
  ds_write_b128 v31, v[176:179] offset:13312
  ds_write_b128 v31, v[180:183] offset:14336
  s_waitcnt lgkmcnt(0)
  s_barrier
  ds_read_b64_tr_b16 a[180:181], v8 offset:0
  ds_read_b64_tr_b16 a[182:183], v8 offset:1536
  ds_read_b64_tr_b16 a[184:185], v8 offset:32
  ds_read_b64_tr_b16 a[186:187], v8 offset:1568
  ds_read_b64_tr_b16 a[188:189], v8 offset:64
  ds_read_b64_tr_b16 a[190:191], v8 offset:1600
  ds_read_b64_tr_b16 a[192:193], v8 offset:12288
  ds_read_b64_tr_b16 a[194:195], v8 offset:13824
  ds_read_b64_tr_b16 a[196:197], v8 offset:12320
  ds_read_b64_tr_b16 a[198:199], v8 offset:13856
  ds_read_b64_tr_b16 a[200:201], v8 offset:12352
  ds_read_b64_tr_b16 a[202:203], v8 offset:13888
  ds_read_b64_tr_b16 a[204:205], v8 offset:24576
  ds_read_b64_tr_b16 a[206:207], v8 offset:26112
  ds_read_b64_tr_b16 a[208:209], v8 offset:24608
  ds_read_b64_tr_b16 a[210:211], v8 offset:26144
  ds_read_b64_tr_b16 a[212:213], v8 offset:24640
  ds_read_b64_tr_b16 a[214:215], v8 offset:26176
  ds_read_b64_tr_b16 a[216:217], v8 offset:36864
  ds_read_b64_tr_b16 a[218:219], v8 offset:38400
  ds_read_b64_tr_b16 a[220:221], v8 offset:36896
  ds_read_b64_tr_b16 a[222:223], v8 offset:38432
  ds_read_b64_tr_b16 a[224:225], v8 offset:36928
  ds_read_b64_tr_b16 a[226:227], v8 offset:38464
  ds_read_b64_tr_b16 a[228:229], v8 offset:49152
  ds_read_b64_tr_b16 a[230:231], v8 offset:50688
  ds_read_b64_tr_b16 a[232:233], v8 offset:49184
  ds_read_b64_tr_b16 a[234:235], v8 offset:50720
  ds_read_b64_tr_b16 a[236:237], v8 offset:49216
  ds_read_b64_tr_b16 a[238:239], v8 offset:50752
  s_waitcnt lgkmcnt(0)
  s_barrier
  s_mov_b32 s24, 2129920
  s_mov_b32 s25, 163840
  v_lshrrev_b32 v11, 3, v1
  v_and_b32 v12, 7, v1
  v_xor_b32 v12, v12, v11
  v_mul_u32_u24 v11, 1280, v11
  v_lshl_add_u32 v10, v12, 4, v11
  s_mul_i32 s46, s20, 40960
  v_add_u32 v10, s46, v10
  s_lshl_b32 s47, s20, 12
  s_add_u32 s47, s47, 0
  s_add_u32 s46, s47, 98304
  s_mov_b32 s30, s24
  s_add_u32 s32, s47, 32768
  v_add_u32 v11, 9216, v10
  v_add_u32 v12, 18432, v10
  v_add_u32 v13, 27648, v10
  s_mov_b32 m0, s32
  s_nop 0
  buffer_load_dwordx4 v10, s[8:11], s30 offen offset:0 lds
  buffer_load_dwordx4 v11, s[8:11], s30 offen offset:1024 lds
  buffer_load_dwordx4 v12, s[8:11], s30 offen offset:2048 lds
  buffer_load_dwordx4 v13, s[8:11], s30 offen offset:3072 lds
  s_add_u32 s30, s30, 128
  s_add_u32 s32, s32, 16384
  s_cmp_lt_u32 s32, s46
  s_cselect_b32 s32, s32, s47
  s_mov_b32 m0, s32
  s_nop 0
  buffer_load_dwordx4 v10, s[8:11], s30 offen offset:0 lds
  buffer_load_dwordx4 v11, s[8:11], s30 offen offset:1024 lds
  buffer_load_dwordx4 v12, s[8:11], s30 offen offset:2048 lds
  buffer_load_dwordx4 v13, s[8:11], s30 offen offset:3072 lds
  s_add_u32 s30, s30, 128
  s_add_u32 s32, s32, 16384
  s_cmp_lt_u32 s32, s46
  s_cselect_b32 s32, s32, s47
  s_mov_b32 m0, s32
  s_nop 0
  buffer_load_dwordx4 v10, s[8:11], s30 offen offset:0 lds
  buffer_load_dwordx4 v11, s[8:11], s30 offen offset:1024 lds
  buffer_load_dwordx4 v12, s[8:11], s30 offen offset:2048 lds
  buffer_load_dwordx4 v13, s[8:11], s30 offen offset:3072 lds
  s_add_u32 s30, s30, 128
  s_add_u32 s32, s32, 16384
  s_cmp_lt_u32 s32, s46
  s_cselect_b32 s32, s32, s47
  s_mov_b32 m0, s32
  s_nop 0
  buffer_load_dwordx4 v10, s[8:11], s30 offen offset:0 lds
  buffer_load_dwordx4 v11, s[8:11], s30 offen offset:1024 lds
  buffer_load_dwordx4 v12, s[8:11], s30 offen offset:2048 lds
  buffer_load_dwordx4 v13, s[8:11], s30 offen offset:3072 lds
  s_add_u32 s30, s30, 128
  s_add_u32 s32, s32, 16384
  s_cmp_lt_u32 s32, s46
  s_cselect_b32 s32, s32, s47
  s_mov_b32 s26, 3
  s_mul_i32 s27, s42, 12288
  s_lshl_b32 s60, s42, 7
  s_add_u32 s60, s60, 112640
  s_mov_b32 s62, 0
  s_branch kv_main
kv_fin:
  s_cmp_lg_u32 s43, 2
  s_cbranch_scc1 queue
  s_bfe_u32 s21, s3, 0x20001
  s_cmp_lt_u32 s21, 2
  s_cbranch_scc1 queue
  s_sub_u32 s21, s21, 2
  s_lshl_b32 s21, s21, 3
  s_lshr_b32 s22, s3, 3
  s_add_u32 s21, s21, s22
  s_add_u32 s87, s21, 350
  s_branch tail_item
  s_branch queue
not_kv:
  s_cmp_ge_u32 s3, 96
  s_cbranch_scc1 not_vw
  s_sub_u32 s2, s3, 64
  s_load_dwordx2 s[72:73], s[0:1], 104
  s_waitcnt lgkmcnt(0)
  s_add_u32 s72, s72, 81068032
  s_addc_u32 s73, s73, 0
  s_mov_b32 s74, 116736
  s_mov_b32 s75, 0x00020000
  s_add_u32 s8, s38, 78643200
  s_addc_u32 s9, s39, 0
  s_mov_b32 s10, 2162688
  s_mov_b32 s11, 0x00020000
  s_add_u32 s12, s38, 50331648
  s_addc_u32 s13, s39, 0
  s_mov_b32 s14, 12582912
  s_mov_b32 s15, 0x00020000
  s_add_u32 s16, s38, 83886079
  s_addc_u32 s17, s39, 0
  s_and_b32 s16, s16, 0xffe00000
  s_mov_b32 s18, 2097152
  s_mov_b32 s19, 0x00020000
  v_lshlrev_b32 v8, 4, v0
  v_lshlrev_b32 v9, 4, v1
  v_mov_b32 v4, 0
  v_mov_b32 v12, -1
  v_mov_b32 v5, 0
  v_mov_b32 v13, -1
  v_mov_b32 v6, 0
  v_mov_b32 v14, -1
  v_mov_b32 v7, 0
  v_mov_b32 v15, -1
  s_lshl_b32 s21, s2, 12
  buffer_store_dwordx4 v[4:7], v8, s[72:75], s21 offen sc1
  s_lshr_b32 s21, s2, 3
  s_lshl_b32 s21, s21, 15
  s_bfe_u32 s22, s2, 0x10002
  s_lshl_b32 s22, s22, 13
  s_add_u32 s21, s21, s22
  s_bfe_u32 s22, s2, 0x10001
  s_lshl_b32 s22, s22, 14
  s_add_u32 s21, s21, s22
  s_and_b32 s22, s2, 1
  s_mul_i32 s22, s22, 3
  s_add_u32 s22, s22, s20
  s_lshl_b32 s22, s22, 10
  s_add_u32 s21, s21, s22
  s_cmp_lt_u32 s20, 3
  s_cselect_b32 s21, s21, 0x80000000
  buffer_store_dwordx4 v[4:7], v9, s[16:19], s21 offen sc1
  s_mul_i32 s23, s20, 540672
  s_lshl_b32 s21, s2, 11
  s_add_u32 s21, s21, s23
  s_add_u32 s21, s21, 81920
  buffer_store_dwordx4 v[12:15], v9, s[8:11], s21 offen sc1
  buffer_store_dwordx4 v[12:15], v9, s[8:11], s21 offen offset:1024 sc1
  s_mul_i32 s21, s2, 3072
  s_add_u32 s21, s21, s23
  s_add_u32 s21, s21, 278528
  buffer_store_dwordx4 v[12:15], v9, s[8:11], s21 offen sc1
  buffer_store_dwordx4 v[12:15], v9, s[8:11], s21 offen offset:1024 sc1
  buffer_store_dwordx4 v[12:15], v9, s[8:11], s21 offen offset:2048 sc1
  s_lshl_b32 s21, s2, 9
  s_add_u32 s21, s21, s23
  s_add_u32 s21, s21, 376832
  s_mov_b64 exec, 0xffffffff
  buffer_store_dwordx4 v[12:15], v9, s[8:11], s21 offen sc1
  s_mov_b64 exec, -1
  s_lshl_b32 s21, s20, 5
  s_add_u32 s21, s21, s2
  s_mul_i32 s21, s21, 3072
  s_cmp_lt_u32 s20, 3
  s_cselect_b32 s21, s21, 0x80000000
  s_add_u32 s22, s21, 6291456
  buffer_store_dwordx4 v[12:15], v9, s[12:15], s21 offen offset:0 sc1
  buffer_store_dwordx4 v[12:15], v9, s[12:15], s22 offen offset:0 sc1
  buffer_store_dwordx4 v[12:15], v9, s[12:15], s21 offen offset:1024 sc1
  buffer_store_dwordx4 v[12:15], v9, s[12:15], s22 offen offset:1024 sc1
  buffer_store_dwordx4 v[12:15], v9, s[12:15], s21 offen offset:2048 sc1
  buffer_store_dwordx4 v[12:15], v9, s[12:15], s22 offen offset:2048 sc1
  s_waitcnt vmcnt(0)
  s_barrier
  s_mov_b32 s21, 76
  s_cmp_lg_u32 s20, 0
  s_cbranch_scc1 af_153
  v_mov_b32 v10, 0
  v_mov_b32 v11, 1
  s_mov_b64 exec, 1
  buffer_atomic_add v11, v10, s[32:35], s21 offen sc1
  s_mov_b64 exec, -1
  s_nop 1
af_153:
  s_load_dwordx2 s[6:7], s[0:1], 40
  s_load_dwordx2 s[38:39], s[0:1], 104
  s_waitcnt lgkmcnt(0)
  s_mov_b32 s12, s6
  s_mov_b32 s13, s7
  s_mov_b32 s14, 7864320
  s_mov_b32 s15, 0x00020000
  s_mov_b32 s16, s38
  s_mov_b32 s17, s39
  s_mov_b32 s18, 50331648
  s_mov_b32 s19, 0x00020000
  s_add_u32 s24, s38, 114294784
  s_addc_u32 s25, s39, 0
  s_mov_b32 s26, 83886080
  s_mov_b32 s27, 0x00020000
  s_load_dwordx2 s[72:73], s[0:1], 104
  s_waitcnt lgkmcnt(0)
  s_add_u32 s72, s72, 81068032
  s_addc_u32 s73, s73, 0
  s_mov_b32 s74, 116736
  s_mov_b32 s75, 0x00020000
  v_mov_b32 v29, 52429
  s_mul_i32 s21, s20, 960
  s_add_u32 s21, s21, 0
  v_add_u32 v21, s21, v1
  v_mul_u32_u24 v22, v21, v29
  v_lshrrev_b32 v22, 22, v22
  v_mul_u32_u24 v23, 80, v22
  v_sub_u32 v21, v21, v23
  v_bfe_u32 v23, v22, 3, 1
  v_and_b32 v24, 3, v22
  v_lshl_add_u32 v23, v23, 2, v24
  v_lshlrev_b32 v23, 1, v23
  v_xor_b32 v21, v21, v23
  v_cmp_gt_u32 vcc, 32, v22
  v_bfe_u32 v26, v22, 3, 2
  v_lshl_add_u32 v25, v26, 2, v24
  v_bfe_u32 v26, v22, 2, 1
  v_lshl_add_u32 v25, v26, 4, v25
  v_cndmask_b32 v25, v22, v25, vcc
  v_mul_u32_u24 v25, 1280, v25
  v_lshl_add_u32 v64, v21, 4, v25
  s_mul_i32 s21, s20, 960
  s_add_u32 s21, s21, 64
  v_add_u32 v21, s21, v1
  v_mul_u32_u24 v22, v21, v29
  v_lshrrev_b32 v22, 22, v22
  v_mul_u32_u24 v23, 80, v22
  v_sub_u32 v21, v21, v23
  v_bfe_u32 v23, v22, 3, 1
  v_and_b32 v24, 3, v22
  v_lshl_add_u32 v23, v23, 2, v24
  v_lshlrev_b32 v23, 1, v23
  v_xor_b32 v21, v21, v23
  v_cmp_gt_u32 vcc, 32, v22
  v_bfe_u32 v26, v22, 3, 2
  v_lshl_add_u32 v25, v26, 2, v24
  v_bfe_u32 v26, v22, 2, 1
  v_lshl_add_u32 v25, v26, 4, v25
  v_cndmask_b32 v25, v22, v25, vcc
  v_mul_u32_u24 v25, 1280, v25
  v_lshl_add_u32 v65, v21, 4, v25
  s_mul_i32 s21, s20, 960
  s_add_u32 s21, s21, 128
  v_add_u32 v21, s21, v1
  v_mul_u32_u24 v22, v21, v29
  v_lshrrev_b32 v22, 22, v22
  v_mul_u32_u24 v23, 80, v22
  v_sub_u32 v21, v21, v23
  v_bfe_u32 v23, v22, 3, 1
  v_and_b32 v24, 3, v22
  v_lshl_add_u32 v23, v23, 2, v24
  v_lshlrev_b32 v23, 1, v23
  v_xor_b32 v21, v21, v23
  v_cmp_gt_u32 vcc, 32, v22
  v_bfe_u32 v26, v22, 3, 2
  v_lshl_add_u32 v25, v26, 2, v24
  v_bfe_u32 v26, v22, 2, 1
  v_lshl_add_u32 v25, v26, 4, v25
  v_cndmask_b32 v25, v22, v25, vcc
  v_mul_u32_u24 v25, 1280, v25
  v_lshl_add_u32 v66, v21, 4, v25
  s_mul_i32 s21, s20, 960
  s_add_u32 s21, s21, 192
  v_add_u32 v21, s21, v1
  v_mul_u32_u24 v22, v21, v29
  v_lshrrev_b32 v22, 22, v22
  v_mul_u32_u24 v23, 80, v22
  v_sub_u32 v21, v21, v23
  v_bfe_u32 v23, v22, 3, 1
  v_and_b32 v24, 3, v22
  v_lshl_add_u32 v23, v23, 2, v24
  v_lshlrev_b32 v23, 1, v23
  v_xor_b32 v21, v21, v23
  v_cmp_gt_u32 vcc, 32, v22
  v_bfe_u32 v26, v22, 3, 2
  v_lshl_add_u32 v25, v26, 2, v24
  v_bfe_u32 v26, v22, 2, 1
  v_lshl_add_u32 v25, v26, 4, v25
  v_cndmask_b32 v25, v22, v25, vcc
  v_mul_u32_u24 v25, 1280, v25
  v_lshl_add_u32 v67, v21, 4, v25
  s_mul_i32 s21, s20, 960
  s_add_u32 s21, s21, 256
  v_add_u32 v21, s21, v1
  v_mul_u32_u24 v22, v21, v29
  v_lshrrev_b32 v22, 22, v22
  v_mul_u32_u24 v23, 80, v22
  v_sub_u32 v21, v21, v23
  v_bfe_u32 v23, v22, 3, 1
  v_and_b32 v24, 3, v22
  v_lshl_add_u32 v23, v23, 2, v24
  v_lshlrev_b32 v23, 1, v23
  v_xor_b32 v21, v21, v23
  v_cmp_gt_u32 vcc, 32, v22
  v_bfe_u32 v26, v22, 3, 2
  v_lshl_add_u32 v25, v26, 2, v24
  v_bfe_u32 v26, v22, 2, 1
  v_lshl_add_u32 v25, v26, 4, v25
  v_cndmask_b32 v25, v22, v25, vcc
  v_mul_u32_u24 v25, 1280, v25
  v_lshl_add_u32 v68, v21, 4, v25
  s_mul_i32 s21, s20, 960
  s_add_u32 s21, s21, 320
  v_add_u32 v21, s21, v1
  v_mul_u32_u24 v22, v21, v29
  v_lshrrev_b32 v22, 22, v22
  v_mul_u32_u24 v23, 80, v22
  v_sub_u32 v21, v21, v23
  v_bfe_u32 v23, v22, 3, 1
  v_and_b32 v24, 3, v22
  v_lshl_add_u32 v23, v23, 2, v24
  v_lshlrev_b32 v23, 1, v23
  v_xor_b32 v21, v21, v23
  v_cmp_gt_u32 vcc, 32, v22
  v_bfe_u32 v26, v22, 3, 2
  v_lshl_add_u32 v25, v26, 2, v24
  v_bfe_u32 v26, v22, 2, 1
  v_lshl_add_u32 v25, v26, 4, v25
  v_cndmask_b32 v25, v22, v25, vcc
  v_mul_u32_u24 v25, 1280, v25
  v_lshl_add_u32 v69, v21, 4, v25
  s_mul_i32 s21, s20, 960
  s_add_u32 s21, s21, 384
  v_add_u32 v21, s21, v1
  v_mul_u32_u24 v22, v21, v29
  v_lshrrev_b32 v22, 22, v22
  v_mul_u32_u24 v23, 80, v22
  v_sub_u32 v21, v21, v23
  v_bfe_u32 v23, v22, 3, 1
  v_and_b32 v24, 3, v22
  v_lshl_add_u32 v23, v23, 2, v24
  v_lshlrev_b32 v23, 1, v23
  v_xor_b32 v21, v21, v23
  v_cmp_gt_u32 vcc, 32, v22
  v_bfe_u32 v26, v22, 3, 2
  v_lshl_add_u32 v25, v26, 2, v24
  v_bfe_u32 v26, v22, 2, 1
  v_lshl_add_u32 v25, v26, 4, v25
  v_cndmask_b32 v25, v22, v25, vcc
  v_mul_u32_u24 v25, 1280, v25
  v_lshl_add_u32 v70, v21, 4, v25
  s_mul_i32 s21, s20, 960
  s_add_u32 s21, s21, 448
  v_add_u32 v21, s21, v1
  v_mul_u32_u24 v22, v21, v29
  v_lshrrev_b32 v22, 22, v22
  v_mul_u32_u24 v23, 80, v22
  v_sub_u32 v21, v21, v23
  v_bfe_u32 v23, v22, 3, 1
  v_and_b32 v24, 3, v22
  v_lshl_add_u32 v23, v23, 2, v24
  v_lshlrev_b32 v23, 1, v23
  v_xor_b32 v21, v21, v23
  v_cmp_gt_u32 vcc, 32, v22
  v_bfe_u32 v26, v22, 3, 2
  v_lshl_add_u32 v25, v26, 2, v24
  v_bfe_u32 v26, v22, 2, 1
  v_lshl_add_u32 v25, v26, 4, v25
  v_cndmask_b32 v25, v22, v25, vcc
  v_mul_u32_u24 v25, 1280, v25
  v_lshl_add_u32 v71, v21, 4, v25
  s_mul_i32 s21, s20, 960
  s_add_u32 s21, s21, 512
  v_add_u32 v21, s21, v1
  v_mul_u32_u24 v22, v21, v29
  v_lshrrev_b32 v22, 22, v22
  v_mul_u32_u24 v23, 80, v22
  v_sub_u32 v21, v21, v23
  v_bfe_u32 v23, v22, 3, 1
  v_and_b32 v24, 3, v22
  v_lshl_add_u32 v23, v23, 2, v24
  v_lshlrev_b32 v23, 1, v23
  v_xor_b32 v21, v21, v23
  v_cmp_gt_u32 vcc, 32, v22
  v_bfe_u32 v26, v22, 3, 2
  v_lshl_add_u32 v25, v26, 2, v24
  v_bfe_u32 v26, v22, 2, 1
  v_lshl_add_u32 v25, v26, 4, v25
  v_cndmask_b32 v25, v22, v25, vcc
  v_mul_u32_u24 v25, 1280, v25
  v_lshl_add_u32 v72, v21, 4, v25
  s_mul_i32 s21, s20, 960
  s_add_u32 s21, s21, 576
  v_add_u32 v21, s21, v1
  v_mul_u32_u24 v22, v21, v29
  v_lshrrev_b32 v22, 22, v22
  v_mul_u32_u24 v23, 80, v22
  v_sub_u32 v21, v21, v23
  v_bfe_u32 v23, v22, 3, 1
  v_and_b32 v24, 3, v22
  v_lshl_add_u32 v23, v23, 2, v24
  v_lshlrev_b32 v23, 1, v23
  v_xor_b32 v21, v21, v23
  v_cmp_gt_u32 vcc, 32, v22
  v_bfe_u32 v26, v22, 3, 2
  v_lshl_add_u32 v25, v26, 2, v24
  v_bfe_u32 v26, v22, 2, 1
  v_lshl_add_u32 v25, v26, 4, v25
  v_cndmask_b32 v25, v22, v25, vcc
  v_mul_u32_u24 v25, 1280, v25
  v_lshl_add_u32 v73, v21, 4, v25
  s_mul_i32 s21, s20, 960
  s_add_u32 s21, s21, 640
  v_add_u32 v21, s21, v1
  v_mul_u32_u24 v22, v21, v29
  v_lshrrev_b32 v22, 22, v22
  v_mul_u32_u24 v23, 80, v22
  v_sub_u32 v21, v21, v23
  v_bfe_u32 v23, v22, 3, 1
  v_and_b32 v24, 3, v22
  v_lshl_add_u32 v23, v23, 2, v24
  v_lshlrev_b32 v23, 1, v23
  v_xor_b32 v21, v21, v23
  v_cmp_gt_u32 vcc, 32, v22
  v_bfe_u32 v26, v22, 3, 2
  v_lshl_add_u32 v25, v26, 2, v24
  v_bfe_u32 v26, v22, 2, 1
  v_lshl_add_u32 v25, v26, 4, v25
  v_cndmask_b32 v25, v22, v25, vcc
  v_mul_u32_u24 v25, 1280, v25
  v_lshl_add_u32 v74, v21, 4, v25
  s_mul_i32 s21, s20, 960
  s_add_u32 s21, s21, 704
  v_add_u32 v21, s21, v1
  v_mul_u32_u24 v22, v21, v29
  v_lshrrev_b32 v22, 22, v22
  v_mul_u32_u24 v23, 80, v22
  v_sub_u32 v21, v21, v23
  v_bfe_u32 v23, v22, 3, 1
  v_and_b32 v24, 3, v22
  v_lshl_add_u32 v23, v23, 2, v24
  v_lshlrev_b32 v23, 1, v23
  v_xor_b32 v21, v21, v23
  v_cmp_gt_u32 vcc, 32, v22
  v_bfe_u32 v26, v22, 3, 2
  v_lshl_add_u32 v25, v26, 2, v24
  v_bfe_u32 v26, v22, 2, 1
  v_lshl_add_u32 v25, v26, 4, v25
  v_cndmask_b32 v25, v22, v25, vcc
  v_mul_u32_u24 v25, 1280, v25
  v_lshl_add_u32 v75, v21, 4, v25
  s_mul_i32 s21, s20, 960
  s_add_u32 s21, s21, 768
  v_add_u32 v21, s21, v1
  v_mul_u32_u24 v22, v21, v29
  v_lshrrev_b32 v22, 22, v22
  v_mul_u32_u24 v23, 80, v22
  v_sub_u32 v21, v21, v23
  v_bfe_u32 v23, v22, 3, 1
  v_and_b32 v24, 3, v22
  v_lshl_add_u32 v23, v23, 2, v24
  v_lshlrev_b32 v23, 1, v23
  v_xor_b32 v21, v21, v23
  v_cmp_gt_u32 vcc, 32, v22
  v_bfe_u32 v26, v22, 3, 2
  v_lshl_add_u32 v25, v26, 2, v24
  v_bfe_u32 v26, v22, 2, 1
  v_lshl_add_u32 v25, v26, 4, v25
  v_cndmask_b32 v25, v22, v25, vcc
  v_mul_u32_u24 v25, 1280, v25
  v_lshl_add_u32 v76, v21, 4, v25
  s_mul_i32 s21, s20, 960
  s_add_u32 s21, s21, 832
  v_add_u32 v21, s21, v1
  v_mul_u32_u24 v22, v21, v29
  v_lshrrev_b32 v22, 22, v22
  v_mul_u32_u24 v23, 80, v22
  v_sub_u32 v21, v21, v23
  v_bfe_u32 v23, v22, 3, 1
  v_and_b32 v24, 3, v22
  v_lshl_add_u32 v23, v23, 2, v24
  v_lshlrev_b32 v23, 1, v23
  v_xor_b32 v21, v21, v23
  v_cmp_gt_u32 vcc, 32, v22
  v_bfe_u32 v26, v22, 3, 2
  v_lshl_add_u32 v25, v26, 2, v24
  v_bfe_u32 v26, v22, 2, 1
  v_lshl_add_u32 v25, v26, 4, v25
  v_cndmask_b32 v25, v22, v25, vcc
  v_mul_u32_u24 v25, 1280, v25
  v_lshl_add_u32 v77, v21, 4, v25
  s_mul_i32 s21, s20, 960
  s_add_u32 s21, s21, 896
  v_add_u32 v21, s21, v1
  v_mul_u32_u24 v22, v21, v29
  v_lshrrev_b32 v22, 22, v22
  v_mul_u32_u24 v23, 80, v22
  v_sub_u32 v21, v21, v23
  v_bfe_u32 v23, v22, 3, 1
  v_and_b32 v24, 3, v22
  v_lshl_add_u32 v23, v23, 2, v24
  v_lshlrev_b32 v23, 1, v23
  v_xor_b32 v21, v21, v23
  v_cmp_gt_u32 vcc, 32, v22
  v_bfe_u32 v26, v22, 3, 2
  v_lshl_add_u32 v25, v26, 2, v24
  v_bfe_u32 v26, v22, 2, 1
  v_lshl_add_u32 v25, v26, 4, v25
  v_cndmask_b32 v25, v22, v25, vcc
  v_mul_u32_u24 v25, 1280, v25
  v_lshl_add_u32 v78, v21, 4, v25
  s_mul_i32 s40, s2, 245760
  s_sleep 32
  s_add_u32 s21, s40, 0
  s_mul_i32 s22, s20, 15360
  s_add_u32 s22, s22, 0
  s_add_u32 m0, s22, 0
  s_nop 0
  buffer_load_dwordx4 v64, s[12:15], s21 offen lds
  s_add_u32 m0, s22, 1024
  s_nop 0
  buffer_load_dwordx4 v65, s[12:15], s21 offen lds
  s_add_u32 m0, s22, 2048
  s_nop 0
  buffer_load_dwordx4 v66, s[12:15], s21 offen lds
  s_add_u32 m0, s22, 3072
  s_nop 0
  buffer_load_dwordx4 v67, s[12:15], s21 offen lds
  s_add_u32 m0, s22, 4096
  s_nop 0
  buffer_load_dwordx4 v68, s[12:15], s21 offen lds
  s_add_u32 m0, s22, 5120
  s_nop 0
  buffer_load_dwordx4 v69, s[12:15], s21 offen lds
  s_add_u32 m0, s22, 6144
  s_nop 0
  buffer_load_dwordx4 v70, s[12:15], s21 offen lds
  s_add_u32 m0, s22, 7168
  s_nop 0
  buffer_load_dwordx4 v71, s[12:15], s21 offen lds
  s_add_u32 m0, s22, 8192
  s_nop 0
  buffer_load_dwordx4 v72, s[12:15], s21 offen lds
  s_add_u32 m0, s22, 9216
  s_nop 0
  buffer_load_dwordx4 v73, s[12:15], s21 offen lds
  s_add_u32 m0, s22, 10240
  s_nop 0
  buffer_load_dwordx4 v74, s[12:15], s21 offen lds
  s_add_u32 m0, s22, 11264
  s_nop 0
  buffer_load_dwordx4 v75, s[12:15], s21 offen lds
  s_add_u32 m0, s22, 12288
  s_nop 0
  buffer_load_dwordx4 v76, s[12:15], s21 offen lds
  s_add_u32 m0, s22, 13312
  s_nop 0
  buffer_load_dwordx4 v77, s[12:15], s21 offen lds
  s_add_u32 m0, s22, 14336
  s_nop 0
  buffer_load_dwordx4 v78, s[12:15], s21 offen lds
  s_add_u32 s21, s40, 61440
  s_mul_i32 s22, s20, 15360
  s_add_u32 s22, s22, 61440
  s_add_u32 m0, s22, 0
  s_nop 0
  buffer_load_dwordx4 v64, s[12:15], s21 offen lds
  s_add_u32 m0, s22, 1024
  s_nop 0
  buffer_load_dwordx4 v65, s[12:15], s21 offen lds
  s_add_u32 m0, s22, 2048
  s_nop 0
  buffer_load_dwordx4 v66, s[12:15], s21 offen lds
  s_add_u32 m0, s22, 3072
  s_nop 0
  buffer_load_dwordx4 v67, s[12:15], s21 offen lds
  s_add_u32 m0, s22, 4096
  s_nop 0
  buffer_load_dwordx4 v68, s[12:15], s21 offen lds
  s_add_u32 m0, s22, 5120
  s_nop 0
  buffer_load_dwordx4 v69, s[12:15], s21 offen lds
  s_add_u32 m0, s22, 6144
  s_nop 0
  buffer_load_dwordx4 v70, s[12:15], s21 offen lds
  s_add_u32 m0, s22, 7168
  s_nop 0
  buffer_load_dwordx4 v71, s[12:15], s21 offen lds
  s_add_u32 m0, s22, 8192
  s_nop 0
  buffer_load_dwordx4 v72, s[12:15], s21 offen lds
  s_add_u32 m0, s22, 9216
  s_nop 0
  buffer_load_dwordx4 v73, s[12:15], s21 offen lds
  s_add_u32 m0, s22, 10240
  s_nop 0
  buffer_load_dwordx4 v74, s[12:15], s21 offen lds
  s_add_u32 m0, s22, 11264
  s_nop 0
  buffer_load_dwordx4 v75, s[12:15], s21 offen lds
  s_add_u32 m0, s22, 12288
  s_nop 0
  buffer_load_dwordx4 v76, s[12:15], s21 offen lds
  s_add_u32 m0, s22, 13312
  s_nop 0
  buffer_load_dwordx4 v77, s[12:15], s21 offen lds
  s_add_u32 m0, s22, 14336
  s_nop 0
  buffer_load_dwordx4 v78, s[12:15], s21 offen lds
  s_add_u32 s21, s40, 122880
  s_mul_i32 s22, s20, 15360
  s_add_u32 s22, s22, 0
  buffer_load_dwordx4 v[80:83], v64, s[12:15], s21 offen
  buffer_load_dwordx4 v[84:87], v65, s[12:15], s21 offen
  buffer_load_dwordx4 v[88:91], v66, s[12:15], s21 offen
  buffer_load_dwordx4 v[92:95], v67, s[12:15], s21 offen
  buffer_load_dwordx4 v[96:99], v68, s[12:15], s21 offen
  buffer_load_dwordx4 v[100:103], v69, s[12:15], s21 offen
  buffer_load_dwordx4 v[104:107], v70, s[12:15], s21 offen
  buffer_load_dwordx4 v[108:111], v71, s[12:15], s21 offen
  buffer_load_dwordx4 v[112:115], v72, s[12:15], s21 offen
  buffer_load_dwordx4 v[116:119], v73, s[12:15], s21 offen
  buffer_load_dwordx4 v[120:123], v74, s[12:15], s21 offen
  buffer_load_dwordx4 v[124:127], v75, s[12:15], s21 offen
  buffer_load_dwordx4 v[128:131], v76, s[12:15], s21 offen
  buffer_load_dwordx4 v[132:135], v77, s[12:15], s21 offen
  buffer_load_dwordx4 v[136:139], v78, s[12:15], s21 offen
  s_add_u32 s21, s40, 184320
  s_mul_i32 s22, s20, 15360
  s_add_u32 s22, s22, 61440
  buffer_load_dwordx4 v[140:143], v64, s[12:15], s21 offen
  buffer_load_dwordx4 v[144:147], v65, s[12:15], s21 offen
  buffer_load_dwordx4 v[148:151], v66, s[12:15], s21 offen
  buffer_load_dwordx4 v[152:155], v67, s[12:15], s21 offen
  buffer_load_dwordx4 v[156:159], v68, s[12:15], s21 offen
  buffer_load_dwordx4 v[160:163], v69, s[12:15], s21 offen
  buffer_load_dwordx4 v[164:167], v70, s[12:15], s21 offen
  buffer_load_dwordx4 v[168:171], v71, s[12:15], s21 offen
  buffer_load_dwordx4 v[172:175], v72, s[12:15], s21 offen
  buffer_load_dwordx4 v[176:179], v73, s[12:15], s21 offen
  buffer_load_dwordx4 v[180:183], v74, s[12:15], s21 offen
  buffer_load_dwordx4 v[184:187], v75, s[12:15], s21 offen
  buffer_load_dwordx4 v[188:191], v76, s[12:15], s21 offen
  buffer_load_dwordx4 v[192:195], v77, s[12:15], s21 offen
  buffer_load_dwordx4 v[196:199], v78, s[12:15], s21 offen
  v_lshrrev_b32 v6, 2, v2
  v_lshl_add_u32 v7, v3, 3, v6
  v_mul_u32_u24 v7, 1280, v7
  v_and_b32 v8, 1, v2
  v_lshl_add_u32 v7, v8, 3, v7
  v_and_b32 v8, 1, v3
  v_lshl_add_u32 v6, v8, 2, v6
  v_lshlrev_b32 v6, 1, v6
  v_bfe_u32 v8, v2, 1, 1
  s_mul_i32 s21, s20, 20
  v_add_u32 v8, s21, v8
  v_add_u32 v5, 0, v8
  v_xor_b32 v5, v5, v6
  v_lshl_add_u32 v200, v5, 4, v7
  v_add_u32 v210, 81920, v200
  v_add_u32 v5, 2, v8
  v_xor_b32 v5, v5, v6
  v_lshl_add_u32 v201, v5, 4, v7
  v_add_u32 v211, 81920, v201
  v_add_u32 v5, 4, v8
  v_xor_b32 v5, v5, v6
  v_lshl_add_u32 v202, v5, 4, v7
  v_add_u32 v212, 81920, v202
  v_add_u32 v5, 6, v8
  v_xor_b32 v5, v5, v6
  v_lshl_add_u32 v203, v5, 4, v7
  v_add_u32 v213, 81920, v203
  v_add_u32 v5, 8, v8
  v_xor_b32 v5, v5, v6
  v_lshl_add_u32 v204, v5, 4, v7
  v_add_u32 v214, 81920, v204
  v_add_u32 v5, 10, v8
  v_xor_b32 v5, v5, v6
  v_lshl_add_u32 v205, v5, 4, v7
  v_add_u32 v215, 81920, v205
  v_add_u32 v5, 12, v8
  v_xor_b32 v5, v5, v6
  v_lshl_add_u32 v206, v5, 4, v7
  v_add_u32 v216, 81920, v206
  v_add_u32 v5, 14, v8
  v_xor_b32 v5, v5, v6
  v_lshl_add_u32 v207, v5, 4, v7
  v_add_u32 v217, 81920, v207
  v_add_u32 v5, 16, v8
  v_xor_b32 v5, v5, v6
  v_lshl_add_u32 v208, v5, 4, v7
  v_add_u32 v218, 81920, v208
  v_add_u32 v5, 18, v8
  v_xor_b32 v5, v5, v6
  v_lshl_add_u32 v209, v5, 4, v7
  v_add_u32 v219, 81920, v209
  s_mul_i32 s22, s20, 15360
  v_lshl_add_u32 v30, v1, 4, s22
  v_add_u32 v31, 61440, v30
  s_waitcnt vmcnt(30)
  s_barrier
  ds_read_b64_tr_b16 a[0:1], v200 offset:0
  ds_read_b64_tr_b16 a[2:3], v200 offset:5120
  ds_read_b64_tr_b16 a[24:25], v201 offset:0
  ds_read_b64_tr_b16 a[26:27], v201 offset:5120
  ds_read_b64_tr_b16 a[48:49], v202 offset:0
  ds_read_b64_tr_b16 a[50:51], v202 offset:5120
  ds_read_b64_tr_b16 a[72:73], v203 offset:0
  ds_read_b64_tr_b16 a[74:75], v203 offset:5120
  ds_read_b64_tr_b16 a[96:97], v204 offset:0
  ds_read_b64_tr_b16 a[98:99], v204 offset:5120
  ds_read_b64_tr_b16 a[120:121], v205 offset:0
  ds_read_b64_tr_b16 a[122:123], v205 offset:5120
  ds_read_b64_tr_b16 a[144:145], v206 offset:0
  ds_read_b64_tr_b16 a[146:147], v206 offset:5120
  ds_read_b64_tr_b16 a[168:169], v207 offset:0
  ds_read_b64_tr_b16 a[170:171], v207 offset:5120
  ds_read_b64_tr_b16 a[192:193], v208 offset:0
  ds_read_b64_tr_b16 a[194:195], v208 offset:5120
  ds_read_b64_tr_b16 a[216:217], v209 offset:0
  ds_read_b64_tr_b16 a[218:219], v209 offset:5120
  ds_read_b64_tr_b16 a[4:5], v200 offset:40960
  ds_read_b64_tr_b16 a[6:7], v200 offset:46080
  ds_read_b64_tr_b16 a[28:29], v201 offset:40960
  ds_read_b64_tr_b16 a[30:31], v201 offset:46080
  ds_read_b64_tr_b16 a[52:53], v202 offset:40960
  ds_read_b64_tr_b16 a[54:55], v202 offset:46080
  ds_read_b64_tr_b16 a[76:77], v203 offset:40960
  ds_read_b64_tr_b16 a[78:79], v203 offset:46080
  ds_read_b64_tr_b16 a[100:101], v204 offset:40960
  ds_read_b64_tr_b16 a[102:103], v204 offset:46080
  ds_read_b64_tr_b16 a[124:125], v205 offset:40960
  ds_read_b64_tr_b16 a[126:127], v205 offset:46080
  ds_read_b64_tr_b16 a[148:149], v206 offset:40960
  ds_read_b64_tr_b16 a[150:151], v206 offset:46080
  ds_read_b64_tr_b16 a[172:173], v207 offset:40960
  ds_read_b64_tr_b16 a[174:175], v207 offset:46080
  ds_read_b64_tr_b16 a[196:197], v208 offset:40960
  ds_read_b64_tr_b16 a[198:199], v208 offset:46080
  ds_read_b64_tr_b16 a[220:221], v209 offset:40960
  ds_read_b64_tr_b16 a[222:223], v209 offset:46080
  ds_read_b64_tr_b16 a[8:9], v210 offset:0
  ds_read_b64_tr_b16 a[10:11], v210 offset:5120
  ds_read_b64_tr_b16 a[32:33], v211 offset:0
  ds_read_b64_tr_b16 a[34:35], v211 offset:5120
  ds_read_b64_tr_b16 a[56:57], v212 offset:0
  ds_read_b64_tr_b16 a[58:59], v212 offset:5120
  ds_read_b64_tr_b16 a[80:81], v213 offset:0
  ds_read_b64_tr_b16 a[82:83], v213 offset:5120
  ds_read_b64_tr_b16 a[104:105], v214 offset:0
  ds_read_b64_tr_b16 a[106:107], v214 offset:5120
  ds_read_b64_tr_b16 a[128:129], v215 offset:0
  ds_read_b64_tr_b16 a[130:131], v215 offset:5120
  ds_read_b64_tr_b16 a[152:153], v216 offset:0
  ds_read_b64_tr_b16 a[154:155], v216 offset:5120
  ds_read_b64_tr_b16 a[176:177], v217 offset:0
  ds_read_b64_tr_b16 a[178:179], v217 offset:5120
  ds_read_b64_tr_b16 a[200:201], v218 offset:0
  ds_read_b64_tr_b16 a[202:203], v218 offset:5120
  ds_read_b64_tr_b16 a[224:225], v219 offset:0
  ds_read_b64_tr_b16 a[226:227], v219 offset:5120
  s_waitcnt lgkmcnt(0)
  s_barrier
  s_waitcnt vmcnt(15)
  ds_write_b128 v30, v[80:83] offset:0
  ds_write_b128 v30, v[84:87] offset:1024
  ds_write_b128 v30, v[88:91] offset:2048
  ds_write_b128 v30, v[92:95] offset:3072
  ds_write_b128 v30, v[96:99] offset:4096
  ds_write_b128 v30, v[100:103] offset:5120
  ds_write_b128 v30, v[104:107] offset:6144
  ds_write_b128 v30, v[108:111] offset:7168
  ds_write_b128 v30, v[112:115] offset:8192
  ds_write_b128 v30, v[116:119] offset:9216
  ds_write_b128 v30, v[120:123] offset:10240
  ds_write_b128 v30, v[124:127] offset:11264
  ds_write_b128 v30, v[128:131] offset:12288
  ds_write_b128 v30, v[132:135] offset:13312
  ds_write_b128 v30, v[136:139] offset:14336
  s_waitcnt vmcnt(0)
  ds_write_b128 v31, v[140:143] offset:0
  ds_write_b128 v31, v[144:147] offset:1024
  ds_write_b128 v31, v[148:151] offset:2048
  ds_write_b128 v31, v[152:155] offset:3072
  ds_write_b128 v31, v[156:159] offset:4096
  ds_write_b128 v31, v[160:163] offset:5120
  ds_write_b128 v31, v[164:167] offset:6144
  ds_write_b128 v31, v[168:171] offset:7168
  ds_write_b128 v31, v[172:175] offset:8192
  ds_write_b128 v31, v[176:179] offset:9216
  ds_write_b128 v31, v[180:183] offset:10240
  ds_write_b128 v31, v[184:187] offset:11264
  ds_write_b128 v31, v[188:191] offset:12288
  ds_write_b128 v31, v[192:195] offset:13312
  ds_write_b128 v31, v[196:199] offset:14336
  s_waitcnt lgkmcnt(0)
  s_barrier
  ds_read_b64_tr_b16 a[12:13], v200 offset:0
  ds_read_b64_tr_b16 a[14:15], v200 offset:5120
  ds_read_b64_tr_b16 a[36:37], v201 offset:0
  ds_read_b64_tr_b16 a[38:39], v201 offset:5120
  ds_read_b64_tr_b16 a[60:61], v202 offset:0
  ds_read_b64_tr_b16 a[62:63], v202 offset:5120
  ds_read_b64_tr_b16 a[84:85], v203 offset:0
  ds_read_b64_tr_b16 a[86:87], v203 offset:5120
  ds_read_b64_tr_b16 a[108:109], v204 offset:0
  ds_read_b64_tr_b16 a[110:111], v204 offset:5120
  ds_read_b64_tr_b16 a[132:133], v205 offset:0
  ds_read_b64_tr_b16 a[134:135], v205 offset:5120
  ds_read_b64_tr_b16 a[156:157], v206 offset:0
  ds_read_b64_tr_b16 a[158:159], v206 offset:5120
  ds_read_b64_tr_b16 a[180:181], v207 offset:0
  ds_read_b64_tr_b16 a[182:183], v207 offset:5120
  ds_read_b64_tr_b16 a[204:205], v208 offset:0
  ds_read_b64_tr_b16 a[206:207], v208 offset:5120
  ds_read_b64_tr_b16 a[228:229], v209 offset:0
  ds_read_b64_tr_b16 a[230:231], v209 offset:5120
  ds_read_b64_tr_b16 a[16:17], v200 offset:40960
  ds_read_b64_tr_b16 a[18:19], v200 offset:46080
  ds_read_b64_tr_b16 a[40:41], v201 offset:40960
  ds_read_b64_tr_b16 a[42:43], v201 offset:46080
  ds_read_b64_tr_b16 a[64:65], v202 offset:40960
  ds_read_b64_tr_b16 a[66:67], v202 offset:46080
  ds_read_b64_tr_b16 a[88:89], v203 offset:40960
  ds_read_b64_tr_b16 a[90:91], v203 offset:46080
  ds_read_b64_tr_b16 a[112:113], v204 offset:40960
  ds_read_b64_tr_b16 a[114:115], v204 offset:46080
  ds_read_b64_tr_b16 a[136:137], v205 offset:40960
  ds_read_b64_tr_b16 a[138:139], v205 offset:46080
  ds_read_b64_tr_b16 a[160:161], v206 offset:40960
  ds_read_b64_tr_b16 a[162:163], v206 offset:46080
  ds_read_b64_tr_b16 a[184:185], v207 offset:40960
  ds_read_b64_tr_b16 a[186:187], v207 offset:46080
  ds_read_b64_tr_b16 a[208:209], v208 offset:40960
  ds_read_b64_tr_b16 a[210:211], v208 offset:46080
  ds_read_b64_tr_b16 a[232:233], v209 offset:40960
  ds_read_b64_tr_b16 a[234:235], v209 offset:46080
  ds_read_b64_tr_b16 a[20:21], v210 offset:0
  ds_read_b64_tr_b16 a[22:23], v210 offset:5120
  ds_read_b64_tr_b16 a[44:45], v211 offset:0
  ds_read_b64_tr_b16 a[46:47], v211 offset:5120
  ds_read_b64_tr_b16 a[68:69], v212 offset:0
  ds_read_b64_tr_b16 a[70:71], v212 offset:5120
  ds_read_b64_tr_b16 a[92:93], v213 offset:0
  ds_read_b64_tr_b16 a[94:95], v213 offset:5120
  ds_read_b64_tr_b16 a[116:117], v214 offset:0
  ds_read_b64_tr_b16 a[118:119], v214 offset:5120
  ds_read_b64_tr_b16 a[140:141], v215 offset:0
  ds_read_b64_tr_b16 a[142:143], v215 offset:5120
  ds_read_b64_tr_b16 a[164:165], v216 offset:0
  ds_read_b64_tr_b16 a[166:167], v216 offset:5120
  ds_read_b64_tr_b16 a[188:189], v217 offset:0
  ds_read_b64_tr_b16 a[190:191], v217 offset:5120
  ds_read_b64_tr_b16 a[212:213], v218 offset:0
  ds_read_b64_tr_b16 a[214:215], v218 offset:5120
  ds_read_b64_tr_b16 a[236:237], v219 offset:0
  ds_read_b64_tr_b16 a[238:239], v219 offset:5120
  s_waitcnt lgkmcnt(0)
  s_barrier
  s_load_dwordx2 s[32:33], s[0:1], 96
  s_waitcnt lgkmcnt(0)
  s_mov_b32 s32, s32
  s_mov_b32 s33, s33
  s_mov_b32 s34, 256
  s_mov_b32 s35, 0x00020000
  s_mov_b32 s21, 76
  s_cmp_lg_u32 s20, 0
  s_cbranch_scc1 wf_155
  v_mov_b32 v4, 0
  s_mov_b32 s101, 0
wf_154:
  buffer_load_dword v5, v4, s[32:35], s21 offen sc1
  s_add_u32 s101, s101, 1
  s_cmp_gt_u32 s101, 131072
  s_cbranch_scc1 main_end
  s_waitcnt vmcnt(0)
  v_readfirstlane_b32 s100, v5
  s_cmp_ge_u32 s100, 32
  s_cbranch_scc1 wf_155
  s_sleep 8
  s_branch wf_154
wf_155:
  s_barrier
  s_mul_i32 s41, s2, 12288
  s_add_u32 s47, s41, 25165824
  s_mov_b32 s41, s47
  s_mul_i32 s21, s20, 10
  s_mul_i32 s47, s2, 5
  s_lshr_b32 s22, s21, 3
  s_add_u32 s47, s47, s22
  s_and_b32 s48, s21, 7
  s_mov_b32 s66, 0
  s_mov_b32 s67, 0
  s_lshr_b32 s43, s2, 2
  s_lshl_b32 s43, s43, 7
  s_add_u32 s43, s43, 0
  s_lshl_b32 s44, s2, 7
  s_lshl_b32 s21, s20, 2
  s_add_u32 s44, s44, s21
  s_add_u32 s44, s44, 95232
  s_mov_b32 s45, 0
  s_mov_b32 s49, 1
  s_mov_b32 s50, 0
  v_mov_b32 v10, 0
  v_mov_b32 v11, 1
  v_lshlrev_b32 v4, 4, v1
  s_add_u32 s76, s38, 56623104
  s_addc_u32 s77, s39, 0
  s_mov_b32 s78, 6291456
  s_mov_b32 s79, 0x00020000
  s_add_u32 s80, s38, 93323264
  s_addc_u32 s81, s39, 0
  s_mov_b32 s82, 20971520
  s_mov_b32 s83, 0x00020000
  v_and_b32 v12, 3, v1
  v_lshlrev_b32 v12, 3, v12
  v_add_u32 v12, 4, v12
  v_and_b32 v13, 7, v2
  v_lshlrev_b32 v13, 4, v13
  v_lshl_add_u32 v13, v3, 7, v13
  v_lshrrev_b32 v14, 3, v2
  v_mul_u32_u24 v14, 98304, v14
  v_add_u32 v14, v14, v13
  v_and_b32 v15, 1, v3
  v_lshlrev_b32 v15, 8, v15
  v_lshl_add_u32 v15, v2, 4, v15
  v_lshrrev_b32 v16, 1, v3
  v_mul_u32_u24 v16, 327680, v16
  v_add_u32 v15, v15, v16
  v_lshlrev_b32 v17, 10, v1
  v_mov_b32 v19, 0
  s_lshl_b32 s53, s2, 7
  s_add_u32 s53, s53, 19456
  s_mov_b32 s55, 0
  s_mov_b32 s56, 0
  s_mov_b32 s58, 0
  s_mov_b32 s59, 0
  s_add_u32 s84, s38, 50331648
  s_addc_u32 s85, s39, 0
  s_mov_b32 s86, 12582912
  s_mov_b32 s87, 0x00020000
  s_and_b32 s21, s2, 3
  s_mul_i32 s51, s2, 3072
  s_cmp_eq_u32 s21, s20
  s_cselect_b32 s51, s51, 6291456
  v_mov_b32 v244, -1
  v_mov_b32 v245, -1
  v_mov_b32 v246, -1
  v_mov_b32 v247, -1
  s_add_u32 s88, s38, 85983232
  s_addc_u32 s89, s39, 0
  s_mov_b32 s90, 5242880
  s_mov_b32 s91, 0x00020000
  s_mul_i32 s21, s20, 3072
  s_add_u32 s41, s41, s21
  s_mov_b32 s64, s21
  s_add_u32 s67, s21, 98304
  s_mov_b32 s71, s21
  s_mov_b32 s46, 0
  s_mov_b32 s47, 0
  s_mov_b32 s65, 0
  s_mul_i32 s42, s2, 40960
  s_mul_i32 s21, s20, 10240
  s_add_u32 s42, s42, s21
  s_mov_b32 s68, 0x80000000
  s_mov_b32 s70, 0
  s_mov_b32 s40, 0
  s_mov_b32 s30, 0
  s_mov_b32 s31, 0
  v_min_u32 v5, 18, v1
  v_lshlrev_b32 v5, 10, v5
  v_mov_b32 v9, 0
  s_lshl_b32 s21, s20, 2
  s_add_u32 s21, s21, 110592
  v_mov_b32 v6, s21
  v_mov_b32 v7, 110592
  s_mul_i32 s51, s2, 3072
  s_lshl_b32 s21, s20, 10
  s_add_u32 s51, s51, s21
  s_cmp_lt_u32 s20, 3
  s_cselect_b32 s51, s51, 6291456
  s_add_u32 s51, s51, 5701632
  s_cmp_lg_u32 s20, 0
  s_cbranch_scc1 wf_157
  v_mov_b32 v20, 0
  s_mov_b32 s101, 0
wf_156:
  buffer_load_dword v21, v20, s[72:75], s43 offen sc1
  s_add_u32 s101, s101, 1
  s_cmp_gt_u32 s101, 131072
  s_cbranch_scc1 main_end
  s_waitcnt vmcnt(0)
  v_readfirstlane_b32 s100, v21
  s_cmp_ge_u32 s100, 8
  s_cbranch_scc1 wf_157
  s_sleep 4
  s_branch wf_156
wf_157:
  s_barrier
  v_writelane_b32 v9, 8, 0
  v_cmp_gt_u32 vcc, 8, v9
  s_nop 0
  s_bitset1_b64 vcc, 19
  s_ff1_i32_b64 s21, vcc
  s_lshl_b32 s22, s21, 1
  s_lshl_b32 s21, s21, 2
  s_sub_i32 s21, s21, 12
  s_max_i32 s47, s21, s22
  s_cmp_gt_u32 s47, s45
  s_cbranch_scc1 va_158
  s_mov_b32 s101, 0
  s_branch va_161
va_159:
  s_sleep 8
va_161:
  buffer_load_dword v9, v5, s[72:75], s43 offen sc1
  s_add_u32 s101, s101, 1
  s_cmp_gt_u32 s101, 131072
  s_cbranch_scc1 main_end
  s_waitcnt vmcnt(0)
  v_cmp_gt_u32 vcc, 8, v9
  s_nop 0
  s_bitset1_b64 vcc, 19
  s_ff1_i32_b64 s21, vcc
  s_lshl_b32 s22, s21, 1
  s_lshl_b32 s21, s21, 2
  s_sub_i32 s21, s21, 12
  s_max_i32 s47, s21, s22
  s_cmp_gt_u32 s47, s45
  s_cbranch_scc0 va_159
va_158:
  s_add_u32 s22, s45, 6
  s_min_u32 s22, s22, s47
va_160:
  s_cmp_ge_u32 s46, s22
  s_cbranch_scc1 va_162
  s_mov_b32 m0, s64
  s_mov_b32 s66, s41
  buffer_load_dwordx4 v4, s[16:19], s66 offen offset:0 sc1 lds
  buffer_load_dwordx4 v4, s[16:19], s66 offen offset:1024 sc1 lds
  buffer_load_dwordx4 v4, s[16:19], s66 offen offset:2048 sc1 lds
  s_add_u32 s46, s46, 1
  s_add_u32 s41, s41, 393216
  s_add_u32 s64, s64, 12288
  s_cmp_lt_u32 s64, s67
  s_cselect_b32 s64, s64, s71
  s_branch va_160
va_162:
  s_mov_b32 s48, s46
  s_mov_b32 s49, s46
  s_mov_b32 s50, s46
  s_waitcnt vmcnt(0)
  s_barrier
  v_mov_b32 v8, v4
  s_add_u32 s65, s65, 12288
  s_cmp_lt_u32 s65, 98304
  s_cselect_b32 s65, s65, 0
  ds_read_b128 v[144:147], v8 offset:0
  ds_read_b128 v[148:151], v8 offset:1024
  ds_read_b128 v[152:155], v8 offset:2048
  ds_read_b128 v[156:159], v8 offset:3072
  ds_read_b128 v[160:163], v8 offset:4096
  ds_read_b128 v[164:167], v8 offset:5120
  ds_read_b128 v[168:171], v8 offset:6144
  ds_read_b128 v[172:175], v8 offset:7168
  ds_read_b128 v[176:179], v8 offset:8192
  ds_read_b128 v[180:183], v8 offset:9216
  ds_read_b128 v[184:187], v8 offset:10240
  ds_read_b128 v[188:191], v8 offset:11264
  s_add_u32 s21, s45, 1
  s_min_u32 s21, s21, 63
  s_cmp_lt_u32 s21, s50
  s_addc_u32 s21, s31, s31
  v_mov_b32 v21, s21
  ds_write_b32 v6, v21 offset:0
vwl_163:
  s_waitcnt lgkmcnt(0)
  s_barrier
  v_mfma_f32_16x16x32_bf16 v[64:67], v[144:147], a[0:3], 0
  v_cmp_gt_u32 vcc, 8, v9
  s_nop 0
  v_mfma_f32_16x16x32_bf16 v[72:75], v[144:147], a[24:27], 0
  s_bitset1_b64 vcc, 19
  s_ff1_i32_b64 s21, vcc
  v_mfma_f32_16x16x32_bf16 v[80:83], v[144:147], a[48:51], 0
  s_lshl_b32 s22, s21, 1
  s_lshl_b32 s21, s21, 2
  v_mfma_f32_16x16x32_bf16 v[88:91], v[144:147], a[72:75], 0
  s_sub_i32 s21, s21, 12
  s_max_i32 s47, s21, s22
  v_mfma_f32_16x16x32_bf16 v[96:99], v[144:147], a[96:99], 0
  s_add_u32 s22, s45, 7
  s_min_u32 s22, s22, s47
  v_mfma_f32_16x16x32_bf16 v[68:71], v[168:171], a[0:3], 0
  s_cmp_lt_u32 s46, s22
  s_cselect_b32 s66, s41, 0x80000000
  s_cselect_b32 m0, s64, 98304
  s_cselect_b32 s22, 1, 0
  v_mfma_f32_16x16x32_bf16 v[76:79], v[168:171], a[24:27], 0
  buffer_load_dwordx4 v4, s[16:19], s66 offen offset:0 sc1 lds
  v_mfma_f32_16x16x32_bf16 v[84:87], v[168:171], a[48:51], 0
  v_add_u32 v8, s65, v4
  ds_read_b128 v[240:243], v7 offset:0
  v_mfma_f32_16x16x32_bf16 v[92:95], v[168:171], a[72:75], 0
  buffer_load_dwordx4 v4, s[16:19], s66 offen offset:1024 sc1 lds
  v_mfma_f32_16x16x32_bf16 v[100:103], v[168:171], a[96:99], 0
  s_add_u32 s65, s65, 12288
  v_mfma_f32_16x16x32_bf16 v[64:67], v[148:151], a[4:7], v[64:67]
  buffer_load_dwordx4 v4, s[16:19], s66 offen offset:2048 sc1 lds
  v_mfma_f32_16x16x32_bf16 v[72:75], v[148:151], a[28:31], v[72:75]
  s_cmp_lt_u32 s65, 98304
  s_cselect_b32 s65, s65, 0
  v_mfma_f32_16x16x32_bf16 v[80:83], v[148:151], a[52:55], v[80:83]
  v_cvt_pk_bf16_f32 v44, v104, v105
  v_cvt_pk_bf16_f32 v45, v106, v107
  v_mfma_f32_16x16x32_bf16 v[88:91], v[148:151], a[76:79], v[88:91]
  s_add_u32 s46, s46, s22
  s_mul_i32 s21, s22, 393216
  v_mfma_f32_16x16x32_bf16 v[96:99], v[148:151], a[100:103], v[96:99]
  ds_read_b128 v[192:195], v8 offset:0
  v_cvt_pk_bf16_f32 v46, v108, v109
  v_mfma_f32_16x16x32_bf16 v[68:71], v[172:175], a[4:7], v[68:71]
  s_add_u32 s41, s41, s21
  s_mul_i32 s21, s22, 12288
  v_mfma_f32_16x16x32_bf16 v[76:79], v[172:175], a[28:31], v[76:79]
  v_cvt_pk_bf16_f32 v47, v110, v111
  s_add_u32 s64, s64, s21
  v_mfma_f32_16x16x32_bf16 v[84:87], v[172:175], a[52:55], v[84:87]
  s_add_u32 s69, s68, 4096
  v_mfma_f32_16x16x32_bf16 v[92:95], v[172:175], a[76:79], v[92:95]
  s_cmp_lt_u32 s64, s67
  s_cselect_b32 s64, s64, s71
  v_mfma_f32_16x16x32_bf16 v[100:103], v[172:175], a[100:103], v[100:103]
  buffer_store_dwordx4 v[44:47], v4, s[24:27], s69 offen offset:1024 sc1
  v_mfma_f32_16x16x32_bf16 v[64:67], v[152:155], a[8:11], v[64:67]
  ds_read_b128 v[196:199], v8 offset:1024
  v_mfma_f32_16x16x32_bf16 v[72:75], v[152:155], a[32:35], v[72:75]
  v_cvt_pk_bf16_f32 v48, v112, v113
  v_mfma_f32_16x16x32_bf16 v[80:83], v[152:155], a[56:59], v[80:83]
  v_cvt_pk_bf16_f32 v49, v114, v115
  v_mfma_f32_16x16x32_bf16 v[88:91], v[152:155], a[80:83], v[88:91]
  v_mfma_f32_16x16x32_bf16 v[96:99], v[152:155], a[104:107], v[96:99]
  v_cvt_pk_bf16_f32 v50, v116, v117
  v_mfma_f32_16x16x32_bf16 v[68:71], v[176:179], a[8:11], v[68:71]
  v_mfma_f32_16x16x32_bf16 v[76:79], v[176:179], a[32:35], v[76:79]
  ds_read_b128 v[200:203], v8 offset:2048
  v_cvt_pk_bf16_f32 v51, v118, v119
  v_mfma_f32_16x16x32_bf16 v[84:87], v[176:179], a[56:59], v[84:87]
  buffer_store_dwordx4 v[48:51], v4, s[24:27], s69 offen offset:2048 sc1
  v_mfma_f32_16x16x32_bf16 v[92:95], v[176:179], a[80:83], v[92:95]
  v_mfma_f32_16x16x32_bf16 v[100:103], v[176:179], a[104:107], v[100:103]
  v_cvt_pk_bf16_f32 v52, v120, v121
  v_mfma_f32_16x16x32_bf16 v[64:67], v[156:159], a[12:15], v[64:67]
  v_mfma_f32_16x16x32_bf16 v[72:75], v[156:159], a[36:39], v[72:75]
  v_cvt_pk_bf16_f32 v53, v122, v123
  v_mfma_f32_16x16x32_bf16 v[80:83], v[156:159], a[60:63], v[80:83]
  ds_read_b128 v[204:207], v8 offset:3072
  v_cvt_pk_bf16_f32 v54, v124, v125
  v_mfma_f32_16x16x32_bf16 v[88:91], v[156:159], a[84:87], v[88:91]
  v_mfma_f32_16x16x32_bf16 v[96:99], v[156:159], a[108:111], v[96:99]
  v_cvt_pk_bf16_f32 v55, v126, v127
  v_mfma_f32_16x16x32_bf16 v[68:71], v[180:183], a[12:15], v[68:71]
  v_mfma_f32_16x16x32_bf16 v[76:79], v[180:183], a[36:39], v[76:79]
  buffer_store_dwordx4 v[52:55], v4, s[24:27], s69 offen offset:3072 sc1
  v_mfma_f32_16x16x32_bf16 v[84:87], v[180:183], a[60:63], v[84:87]
  v_cvt_pk_bf16_f32 v56, v128, v129
  v_mfma_f32_16x16x32_bf16 v[92:95], v[180:183], a[84:87], v[92:95]
  ds_read_b128 v[208:211], v8 offset:4096
  v_mfma_f32_16x16x32_bf16 v[100:103], v[180:183], a[108:111], v[100:103]
  v_cvt_pk_bf16_f32 v57, v130, v131
  v_mfma_f32_16x16x32_bf16 v[64:67], v[160:163], a[16:19], v[64:67]
  v_mfma_f32_16x16x32_bf16 v[72:75], v[160:163], a[40:43], v[72:75]
  v_cvt_pk_bf16_f32 v58, v132, v133
  v_mfma_f32_16x16x32_bf16 v[80:83], v[160:163], a[64:67], v[80:83]
  v_cvt_pk_bf16_f32 v59, v134, v135
  v_mfma_f32_16x16x32_bf16 v[88:91], v[160:163], a[88:91], v[88:91]
  v_mfma_f32_16x16x32_bf16 v[96:99], v[160:163], a[112:115], v[96:99]
  ds_read_b128 v[212:215], v8 offset:5120
  s_add_u32 s69, s68, 8192
  v_mfma_f32_16x16x32_bf16 v[68:71], v[184:187], a[16:19], v[68:71]
  v_mfma_f32_16x16x32_bf16 v[76:79], v[184:187], a[40:43], v[76:79]
  buffer_store_dwordx4 v[56:59], v4, s[24:27], s69 offen offset:0 sc1
  v_mfma_f32_16x16x32_bf16 v[84:87], v[184:187], a[64:67], v[84:87]
  v_cvt_pk_bf16_f32 v60, v136, v137
  v_mfma_f32_16x16x32_bf16 v[92:95], v[184:187], a[88:91], v[92:95]
  v_mfma_f32_16x16x32_bf16 v[100:103], v[184:187], a[112:115], v[100:103]
  v_cvt_pk_bf16_f32 v61, v138, v139
  v_mfma_f32_16x16x32_bf16 v[64:67], v[164:167], a[20:23], v[64:67]
  ds_read_b128 v[216:219], v8 offset:6144
  v_mfma_f32_16x16x32_bf16 v[72:75], v[164:167], a[44:47], v[72:75]
  v_cvt_pk_bf16_f32 v62, v140, v141
  v_mfma_f32_16x16x32_bf16 v[80:83], v[164:167], a[68:71], v[80:83]
  v_cvt_pk_bf16_f32 v63, v142, v143
  v_mfma_f32_16x16x32_bf16 v[88:91], v[164:167], a[92:95], v[88:91]
  v_mfma_f32_16x16x32_bf16 v[96:99], v[164:167], a[116:119], v[96:99]
  buffer_store_dwordx4 v[60:63], v4, s[24:27], s69 offen offset:1024 sc1
  v_mfma_f32_16x16x32_bf16 v[68:71], v[188:191], a[20:23], v[68:71]
  v_mfma_f32_16x16x32_bf16 v[76:79], v[188:191], a[44:47], v[76:79]
  ds_read_b128 v[220:223], v8 offset:7168
  v_mfma_f32_16x16x32_bf16 v[84:87], v[188:191], a[68:71], v[84:87]
  v_mfma_f32_16x16x32_bf16 v[92:95], v[188:191], a[92:95], v[92:95]
  v_mfma_f32_16x16x32_bf16 v[100:103], v[188:191], a[116:119], v[100:103]
  v_mfma_f32_16x16x32_bf16 v[104:107], v[144:147], a[120:123], 0
  buffer_load_dword v9, v5, s[72:75], s43 offen sc1
  v_mfma_f32_16x16x32_bf16 v[112:115], v[144:147], a[144:147], 0
  v_mfma_f32_16x16x32_bf16 v[120:123], v[144:147], a[168:171], 0
  ds_read_b128 v[224:227], v8 offset:8192
  v_mfma_f32_16x16x32_bf16 v[128:131], v[144:147], a[192:195], 0
  v_cvt_pk_bf16_f32 v24, v64, v65
  v_mfma_f32_16x16x32_bf16 v[136:139], v[144:147], a[216:219], 0
  v_mfma_f32_16x16x32_bf16 v[108:111], v[168:171], a[120:123], 0
  v_cvt_pk_bf16_f32 v25, v66, v67
  v_mfma_f32_16x16x32_bf16 v[116:119], v[168:171], a[144:147], 0
  s_cmp_lt_u32 s51, 6291456
  s_cselect_b32 s52, s51, 0x80000000
  v_mfma_f32_16x16x32_bf16 v[124:127], v[168:171], a[168:171], 0
  v_cvt_pk_bf16_f32 v26, v68, v69
  v_mfma_f32_16x16x32_bf16 v[132:135], v[168:171], a[192:195], 0
  ds_read_b128 v[228:231], v8 offset:9216
  v_mfma_f32_16x16x32_bf16 v[140:143], v[168:171], a[216:219], 0
  v_cvt_pk_bf16_f32 v27, v70, v71
  v_mfma_f32_16x16x32_bf16 v[104:107], v[148:151], a[124:127], v[104:107]
  buffer_store_dwordx4 v[244:247], v4, s[84:87], s52 offen sc1
  v_mfma_f32_16x16x32_bf16 v[112:115], v[148:151], a[148:151], v[112:115]
  buffer_store_dwordx4 v[24:27], v4, s[24:27], s42 offen offset:0 sc1
  v_mfma_f32_16x16x32_bf16 v[120:123], v[148:151], a[172:175], v[120:123]
  s_add_u32 s51, s51, 98304
  v_mfma_f32_16x16x32_bf16 v[128:131], v[148:151], a[196:199], v[128:131]
  v_cvt_pk_bf16_f32 v28, v72, v73
  v_mfma_f32_16x16x32_bf16 v[136:139], v[148:151], a[220:223], v[136:139]
  ds_read_b128 v[232:235], v8 offset:10240
  v_cvt_pk_bf16_f32 v29, v74, v75
  v_mfma_f32_16x16x32_bf16 v[108:111], v[172:175], a[124:127], v[108:111]
  s_cmp_eq_u32 s40, 3
  s_cbranch_scc1 vwm_165
vwm_166:
  v_mfma_f32_16x16x32_bf16 v[116:119], v[172:175], a[148:151], v[116:119]
  v_cvt_pk_bf16_f32 v30, v76, v77
  v_mfma_f32_16x16x32_bf16 v[124:127], v[172:175], a[172:175], v[124:127]
  v_mfma_f32_16x16x32_bf16 v[132:135], v[172:175], a[196:199], v[132:135]
  v_cvt_pk_bf16_f32 v31, v78, v79
  v_mfma_f32_16x16x32_bf16 v[140:143], v[172:175], a[220:223], v[140:143]
  v_mfma_f32_16x16x32_bf16 v[104:107], v[152:155], a[128:131], v[104:107]
  ds_read_b128 v[236:239], v8 offset:11264
  v_mfma_f32_16x16x32_bf16 v[112:115], v[152:155], a[152:155], v[112:115]
  buffer_store_dwordx4 v[28:31], v4, s[24:27], s42 offen offset:1024 sc1
  v_mfma_f32_16x16x32_bf16 v[120:123], v[152:155], a[176:179], v[120:123]
  v_cvt_pk_bf16_f32 v32, v80, v81
  v_mfma_f32_16x16x32_bf16 v[128:131], v[152:155], a[200:203], v[128:131]
  v_mfma_f32_16x16x32_bf16 v[136:139], v[152:155], a[224:227], v[136:139]
  v_cvt_pk_bf16_f32 v33, v82, v83
  v_mfma_f32_16x16x32_bf16 v[108:111], v[176:179], a[128:131], v[108:111]
  v_cvt_pk_bf16_f32 v34, v84, v85
  v_mfma_f32_16x16x32_bf16 v[116:119], v[176:179], a[152:155], v[116:119]
  v_mfma_f32_16x16x32_bf16 v[124:127], v[176:179], a[176:179], v[124:127]
  v_cvt_pk_bf16_f32 v35, v86, v87
  v_mfma_f32_16x16x32_bf16 v[132:135], v[176:179], a[200:203], v[132:135]
  v_mfma_f32_16x16x32_bf16 v[140:143], v[176:179], a[224:227], v[140:143]
  buffer_store_dwordx4 v[32:35], v4, s[24:27], s42 offen offset:2048 sc1
  v_mfma_f32_16x16x32_bf16 v[104:107], v[156:159], a[132:135], v[104:107]
  v_mfma_f32_16x16x32_bf16 v[112:115], v[156:159], a[156:159], v[112:115]
  v_cvt_pk_bf16_f32 v36, v88, v89
  v_mfma_f32_16x16x32_bf16 v[120:123], v[156:159], a[180:183], v[120:123]
  v_mfma_f32_16x16x32_bf16 v[128:131], v[156:159], a[204:207], v[128:131]
  v_cvt_pk_bf16_f32 v37, v90, v91
  v_mfma_f32_16x16x32_bf16 v[136:139], v[156:159], a[228:231], v[136:139]
  v_mfma_f32_16x16x32_bf16 v[108:111], v[180:183], a[132:135], v[108:111]
  v_cvt_pk_bf16_f32 v38, v92, v93
  v_mfma_f32_16x16x32_bf16 v[116:119], v[180:183], a[156:159], v[116:119]
  v_cvt_pk_bf16_f32 v39, v94, v95
  s_waitcnt lgkmcnt(0)
  v_mfma_f32_16x16x32_bf16 v[124:127], v[180:183], a[180:183], v[124:127]
  v_bitop3_b32 v240, v240, v241, v242 bitop3:0x80
  v_and_b32 v240, v240, v243
  v_mfma_f32_16x16x32_bf16 v[132:135], v[180:183], a[204:207], v[132:135]
  buffer_store_dwordx4 v[36:39], v4, s[24:27], s42 offen offset:3072 sc1
  v_mfma_f32_16x16x32_bf16 v[140:143], v[180:183], a[228:231], v[140:143]
  s_nop 0
  v_readfirstlane_b32 s23, v240
  v_mfma_f32_16x16x32_bf16 v[104:107], v[160:163], a[136:139], v[104:107]
  v_cvt_pk_bf16_f32 v40, v96, v97
  v_mfma_f32_16x16x32_bf16 v[112:115], v[160:163], a[160:163], v[112:115]
  v_mfma_f32_16x16x32_bf16 v[120:123], v[160:163], a[184:187], v[120:123]
  v_cvt_pk_bf16_f32 v41, v98, v99
  v_mfma_f32_16x16x32_bf16 v[128:131], v[160:163], a[208:211], v[128:131]
  v_mfma_f32_16x16x32_bf16 v[136:139], v[160:163], a[232:235], v[136:139]
  v_cvt_pk_bf16_f32 v42, v100, v101
  v_mfma_f32_16x16x32_bf16 v[108:111], v[184:187], a[136:139], v[108:111]
  v_mfma_f32_16x16x32_bf16 v[116:119], v[184:187], a[160:163], v[116:119]
  v_cvt_pk_bf16_f32 v43, v102, v103
  v_mfma_f32_16x16x32_bf16 v[124:127], v[184:187], a[184:187], v[124:127]
  s_add_u32 s69, s42, 4096
  v_mfma_f32_16x16x32_bf16 v[132:135], v[184:187], a[208:211], v[132:135]
  v_mfma_f32_16x16x32_bf16 v[140:143], v[184:187], a[232:235], v[140:143]
  buffer_store_dwordx4 v[40:43], v4, s[24:27], s69 offen offset:0 sc1
  v_mfma_f32_16x16x32_bf16 v[104:107], v[164:167], a[140:143], v[104:107]
  v_mfma_f32_16x16x32_bf16 v[112:115], v[164:167], a[164:167], v[112:115]
  v_mfma_f32_16x16x32_bf16 v[120:123], v[164:167], a[188:191], v[120:123]
  s_waitcnt vmcnt(12)
  s_mov_b32 s50, s46
  s_add_u32 s69, s45, s40
  v_mfma_f32_16x16x32_bf16 v[128:131], v[164:167], a[212:215], v[128:131]
  s_mov_b32 s40, 0
  s_sub_i32 s69, s69, 1
  s_max_i32 s69, s69, s70
  v_mfma_f32_16x16x32_bf16 v[136:139], v[164:167], a[236:239], v[136:139]
  s_add_u32 s45, s45, 1
  s_mov_b32 s68, s42
  s_add_u32 s42, s42, 1310720
  v_mfma_f32_16x16x32_bf16 v[108:111], v[188:191], a[140:143], v[108:111]
  s_add_u32 s21, s45, 1
  s_min_u32 s21, s21, 63
  v_mfma_f32_16x16x32_bf16 v[116:119], v[188:191], a[164:167], v[116:119]
  s_cmp_lt_u32 s21, s50
  s_addc_u32 s21, s31, s31
  v_mov_b32 v21, s21
  v_mfma_f32_16x16x32_bf16 v[124:127], v[188:191], a[188:191], v[124:127]
  ds_write_b32 v6, v21 offset:16
  v_mfma_f32_16x16x32_bf16 v[132:135], v[188:191], a[212:215], v[132:135]
  v_mfma_f32_16x16x32_bf16 v[140:143], v[188:191], a[236:239], v[140:143]
  s_mov_b64 exec, 1
  v_mov_b32 v20, s69
  buffer_store_dword v20, v10, s[72:75], s44 offen sc1
  s_mov_b64 exec, -1
  s_cmp_le_u32 s45, 16
  s_cbranch_scc1 vwe_169
vwe_170:
  s_cmp_eq_u32 s23, 0
  s_cbranch_scc1 vws_167
vwb_168:
  s_waitcnt lgkmcnt(0)
  s_barrier
  v_mfma_f32_16x16x32_bf16 v[64:67], v[192:195], a[0:3], 0
  v_cmp_gt_u32 vcc, 8, v9
  s_nop 0
  v_mfma_f32_16x16x32_bf16 v[72:75], v[192:195], a[24:27], 0
  s_bitset1_b64 vcc, 19
  s_ff1_i32_b64 s21, vcc
  v_mfma_f32_16x16x32_bf16 v[80:83], v[192:195], a[48:51], 0
  s_lshl_b32 s22, s21, 1
  s_lshl_b32 s21, s21, 2
  v_mfma_f32_16x16x32_bf16 v[88:91], v[192:195], a[72:75], 0
  s_sub_i32 s21, s21, 12
  s_max_i32 s47, s21, s22
  v_mfma_f32_16x16x32_bf16 v[96:99], v[192:195], a[96:99], 0
  s_add_u32 s22, s45, 7
  s_min_u32 s22, s22, s47
  v_mfma_f32_16x16x32_bf16 v[68:71], v[216:219], a[0:3], 0
  s_cmp_lt_u32 s46, s22
  s_cselect_b32 s66, s41, 0x80000000
  s_cselect_b32 m0, s64, 98304
  s_cselect_b32 s22, 1, 0
  v_mfma_f32_16x16x32_bf16 v[76:79], v[216:219], a[24:27], 0
  buffer_load_dwordx4 v4, s[16:19], s66 offen offset:0 sc1 lds
  v_mfma_f32_16x16x32_bf16 v[84:87], v[216:219], a[48:51], 0
  v_add_u32 v8, s65, v4
  ds_read_b128 v[240:243], v7 offset:16
  v_mfma_f32_16x16x32_bf16 v[92:95], v[216:219], a[72:75], 0
  buffer_load_dwordx4 v4, s[16:19], s66 offen offset:1024 sc1 lds
  v_mfma_f32_16x16x32_bf16 v[100:103], v[216:219], a[96:99], 0
  s_add_u32 s65, s65, 12288
  v_mfma_f32_16x16x32_bf16 v[64:67], v[196:199], a[4:7], v[64:67]
  buffer_load_dwordx4 v4, s[16:19], s66 offen offset:2048 sc1 lds
  v_mfma_f32_16x16x32_bf16 v[72:75], v[196:199], a[28:31], v[72:75]
  s_cmp_lt_u32 s65, 98304
  s_cselect_b32 s65, s65, 0
  v_mfma_f32_16x16x32_bf16 v[80:83], v[196:199], a[52:55], v[80:83]
  v_cvt_pk_bf16_f32 v44, v104, v105
  v_cvt_pk_bf16_f32 v45, v106, v107
  v_mfma_f32_16x16x32_bf16 v[88:91], v[196:199], a[76:79], v[88:91]
  s_add_u32 s46, s46, s22
  s_mul_i32 s21, s22, 393216
  v_mfma_f32_16x16x32_bf16 v[96:99], v[196:199], a[100:103], v[96:99]
  ds_read_b128 v[144:147], v8 offset:0
  v_cvt_pk_bf16_f32 v46, v108, v109
  v_mfma_f32_16x16x32_bf16 v[68:71], v[220:223], a[4:7], v[68:71]
  s_add_u32 s41, s41, s21
  s_mul_i32 s21, s22, 12288
  v_mfma_f32_16x16x32_bf16 v[76:79], v[220:223], a[28:31], v[76:79]
  v_cvt_pk_bf16_f32 v47, v110, v111
  s_add_u32 s64, s64, s21
  v_mfma_f32_16x16x32_bf16 v[84:87], v[220:223], a[52:55], v[84:87]
  s_add_u32 s69, s68, 4096
  v_mfma_f32_16x16x32_bf16 v[92:95], v[220:223], a[76:79], v[92:95]
  s_cmp_lt_u32 s64, s67
  s_cselect_b32 s64, s64, s71
  v_mfma_f32_16x16x32_bf16 v[100:103], v[220:223], a[100:103], v[100:103]
  buffer_store_dwordx4 v[44:47], v4, s[24:27], s69 offen offset:1024 sc1
  v_mfma_f32_16x16x32_bf16 v[64:67], v[200:203], a[8:11], v[64:67]
  ds_read_b128 v[148:151], v8 offset:1024
  v_mfma_f32_16x16x32_bf16 v[72:75], v[200:203], a[32:35], v[72:75]
  v_cvt_pk_bf16_f32 v48, v112, v113
  v_mfma_f32_16x16x32_bf16 v[80:83], v[200:203], a[56:59], v[80:83]
  v_cvt_pk_bf16_f32 v49, v114, v115
  v_mfma_f32_16x16x32_bf16 v[88:91], v[200:203], a[80:83], v[88:91]
  v_mfma_f32_16x16x32_bf16 v[96:99], v[200:203], a[104:107], v[96:99]
  v_cvt_pk_bf16_f32 v50, v116, v117
  v_mfma_f32_16x16x32_bf16 v[68:71], v[224:227], a[8:11], v[68:71]
  v_mfma_f32_16x16x32_bf16 v[76:79], v[224:227], a[32:35], v[76:79]
  ds_read_b128 v[152:155], v8 offset:2048
  v_cvt_pk_bf16_f32 v51, v118, v119
  v_mfma_f32_16x16x32_bf16 v[84:87], v[224:227], a[56:59], v[84:87]
  buffer_store_dwordx4 v[48:51], v4, s[24:27], s69 offen offset:2048 sc1
  v_mfma_f32_16x16x32_bf16 v[92:95], v[224:227], a[80:83], v[92:95]
  v_mfma_f32_16x16x32_bf16 v[100:103], v[224:227], a[104:107], v[100:103]
  v_cvt_pk_bf16_f32 v52, v120, v121
  v_mfma_f32_16x16x32_bf16 v[64:67], v[204:207], a[12:15], v[64:67]
  v_mfma_f32_16x16x32_bf16 v[72:75], v[204:207], a[36:39], v[72:75]
  v_cvt_pk_bf16_f32 v53, v122, v123
  v_mfma_f32_16x16x32_bf16 v[80:83], v[204:207], a[60:63], v[80:83]
  ds_read_b128 v[156:159], v8 offset:3072
  v_cvt_pk_bf16_f32 v54, v124, v125
  v_mfma_f32_16x16x32_bf16 v[88:91], v[204:207], a[84:87], v[88:91]
  v_mfma_f32_16x16x32_bf16 v[96:99], v[204:207], a[108:111], v[96:99]
  v_cvt_pk_bf16_f32 v55, v126, v127
  v_mfma_f32_16x16x32_bf16 v[68:71], v[228:231], a[12:15], v[68:71]
  v_mfma_f32_16x16x32_bf16 v[76:79], v[228:231], a[36:39], v[76:79]
  buffer_store_dwordx4 v[52:55], v4, s[24:27], s69 offen offset:3072 sc1
  v_mfma_f32_16x16x32_bf16 v[84:87], v[228:231], a[60:63], v[84:87]
  v_cvt_pk_bf16_f32 v56, v128, v129
  v_mfma_f32_16x16x32_bf16 v[92:95], v[228:231], a[84:87], v[92:95]
  ds_read_b128 v[160:163], v8 offset:4096
  v_mfma_f32_16x16x32_bf16 v[100:103], v[228:231], a[108:111], v[100:103]
  v_cvt_pk_bf16_f32 v57, v130, v131
  v_mfma_f32_16x16x32_bf16 v[64:67], v[208:211], a[16:19], v[64:67]
  v_mfma_f32_16x16x32_bf16 v[72:75], v[208:211], a[40:43], v[72:75]
  v_cvt_pk_bf16_f32 v58, v132, v133
  v_mfma_f32_16x16x32_bf16 v[80:83], v[208:211], a[64:67], v[80:83]
  v_cvt_pk_bf16_f32 v59, v134, v135
  v_mfma_f32_16x16x32_bf16 v[88:91], v[208:211], a[88:91], v[88:91]
  v_mfma_f32_16x16x32_bf16 v[96:99], v[208:211], a[112:115], v[96:99]
  ds_read_b128 v[164:167], v8 offset:5120
  s_add_u32 s69, s68, 8192
  v_mfma_f32_16x16x32_bf16 v[68:71], v[232:235], a[16:19], v[68:71]
  v_mfma_f32_16x16x32_bf16 v[76:79], v[232:235], a[40:43], v[76:79]
  buffer_store_dwordx4 v[56:59], v4, s[24:27], s69 offen offset:0 sc1
  v_mfma_f32_16x16x32_bf16 v[84:87], v[232:235], a[64:67], v[84:87]
  v_cvt_pk_bf16_f32 v60, v136, v137
  v_mfma_f32_16x16x32_bf16 v[92:95], v[232:235], a[88:91], v[92:95]
  v_mfma_f32_16x16x32_bf16 v[100:103], v[232:235], a[112:115], v[100:103]
  v_cvt_pk_bf16_f32 v61, v138, v139
  v_mfma_f32_16x16x32_bf16 v[64:67], v[212:215], a[20:23], v[64:67]
  ds_read_b128 v[168:171], v8 offset:6144
  v_mfma_f32_16x16x32_bf16 v[72:75], v[212:215], a[44:47], v[72:75]
  v_cvt_pk_bf16_f32 v62, v140, v141
  v_mfma_f32_16x16x32_bf16 v[80:83], v[212:215], a[68:71], v[80:83]
  v_cvt_pk_bf16_f32 v63, v142, v143
  v_mfma_f32_16x16x32_bf16 v[88:91], v[212:215], a[92:95], v[88:91]
  v_mfma_f32_16x16x32_bf16 v[96:99], v[212:215], a[116:119], v[96:99]
  buffer_store_dwordx4 v[60:63], v4, s[24:27], s69 offen offset:1024 sc1
  v_mfma_f32_16x16x32_bf16 v[68:71], v[236:239], a[20:23], v[68:71]
  v_mfma_f32_16x16x32_bf16 v[76:79], v[236:239], a[44:47], v[76:79]
  ds_read_b128 v[172:175], v8 offset:7168
  v_mfma_f32_16x16x32_bf16 v[84:87], v[236:239], a[68:71], v[84:87]
  v_mfma_f32_16x16x32_bf16 v[92:95], v[236:239], a[92:95], v[92:95]
  v_mfma_f32_16x16x32_bf16 v[100:103], v[236:239], a[116:119], v[100:103]
  v_mfma_f32_16x16x32_bf16 v[104:107], v[192:195], a[120:123], 0
  buffer_load_dword v9, v5, s[72:75], s43 offen sc1
  v_mfma_f32_16x16x32_bf16 v[112:115], v[192:195], a[144:147], 0
  v_mfma_f32_16x16x32_bf16 v[120:123], v[192:195], a[168:171], 0
  ds_read_b128 v[176:179], v8 offset:8192
  v_mfma_f32_16x16x32_bf16 v[128:131], v[192:195], a[192:195], 0
  v_cvt_pk_bf16_f32 v24, v64, v65
  v_mfma_f32_16x16x32_bf16 v[136:139], v[192:195], a[216:219], 0
  v_mfma_f32_16x16x32_bf16 v[108:111], v[216:219], a[120:123], 0
  v_cvt_pk_bf16_f32 v25, v66, v67
  v_mfma_f32_16x16x32_bf16 v[116:119], v[216:219], a[144:147], 0
  s_cmp_lt_u32 s51, 6291456
  s_cselect_b32 s52, s51, 0x80000000
  v_mfma_f32_16x16x32_bf16 v[124:127], v[216:219], a[168:171], 0
  v_cvt_pk_bf16_f32 v26, v68, v69
  v_mfma_f32_16x16x32_bf16 v[132:135], v[216:219], a[192:195], 0
  ds_read_b128 v[180:183], v8 offset:9216
  v_mfma_f32_16x16x32_bf16 v[140:143], v[216:219], a[216:219], 0
  v_cvt_pk_bf16_f32 v27, v70, v71
  v_mfma_f32_16x16x32_bf16 v[104:107], v[196:199], a[124:127], v[104:107]
  buffer_store_dwordx4 v[244:247], v4, s[84:87], s52 offen sc1
  v_mfma_f32_16x16x32_bf16 v[112:115], v[196:199], a[148:151], v[112:115]
  buffer_store_dwordx4 v[24:27], v4, s[24:27], s42 offen offset:0 sc1
  v_mfma_f32_16x16x32_bf16 v[120:123], v[196:199], a[172:175], v[120:123]
  s_add_u32 s51, s51, 98304
  v_mfma_f32_16x16x32_bf16 v[128:131], v[196:199], a[196:199], v[128:131]
  v_cvt_pk_bf16_f32 v28, v72, v73
  v_mfma_f32_16x16x32_bf16 v[136:139], v[196:199], a[220:223], v[136:139]
  ds_read_b128 v[184:187], v8 offset:10240
  v_cvt_pk_bf16_f32 v29, v74, v75
  v_mfma_f32_16x16x32_bf16 v[108:111], v[220:223], a[124:127], v[108:111]
  s_cmp_eq_u32 s40, 3
  s_cbranch_scc1 vwm_173
vwm_174:
  v_mfma_f32_16x16x32_bf16 v[116:119], v[220:223], a[148:151], v[116:119]
  v_cvt_pk_bf16_f32 v30, v76, v77
  v_mfma_f32_16x16x32_bf16 v[124:127], v[220:223], a[172:175], v[124:127]
  v_mfma_f32_16x16x32_bf16 v[132:135], v[220:223], a[196:199], v[132:135]
  v_cvt_pk_bf16_f32 v31, v78, v79
  v_mfma_f32_16x16x32_bf16 v[140:143], v[220:223], a[220:223], v[140:143]
  v_mfma_f32_16x16x32_bf16 v[104:107], v[200:203], a[128:131], v[104:107]
  ds_read_b128 v[188:191], v8 offset:11264
  v_mfma_f32_16x16x32_bf16 v[112:115], v[200:203], a[152:155], v[112:115]
  buffer_store_dwordx4 v[28:31], v4, s[24:27], s42 offen offset:1024 sc1
  v_mfma_f32_16x16x32_bf16 v[120:123], v[200:203], a[176:179], v[120:123]
  v_cvt_pk_bf16_f32 v32, v80, v81
  v_mfma_f32_16x16x32_bf16 v[128:131], v[200:203], a[200:203], v[128:131]
  v_mfma_f32_16x16x32_bf16 v[136:139], v[200:203], a[224:227], v[136:139]
  v_cvt_pk_bf16_f32 v33, v82, v83
  v_mfma_f32_16x16x32_bf16 v[108:111], v[224:227], a[128:131], v[108:111]
  v_cvt_pk_bf16_f32 v34, v84, v85
  v_mfma_f32_16x16x32_bf16 v[116:119], v[224:227], a[152:155], v[116:119]
  v_mfma_f32_16x16x32_bf16 v[124:127], v[224:227], a[176:179], v[124:127]
  v_cvt_pk_bf16_f32 v35, v86, v87
  v_mfma_f32_16x16x32_bf16 v[132:135], v[224:227], a[200:203], v[132:135]
  v_mfma_f32_16x16x32_bf16 v[140:143], v[224:227], a[224:227], v[140:143]
  buffer_store_dwordx4 v[32:35], v4, s[24:27], s42 offen offset:2048 sc1
  v_mfma_f32_16x16x32_bf16 v[104:107], v[204:207], a[132:135], v[104:107]
  v_mfma_f32_16x16x32_bf16 v[112:115], v[204:207], a[156:159], v[112:115]
  v_cvt_pk_bf16_f32 v36, v88, v89
  v_mfma_f32_16x16x32_bf16 v[120:123], v[204:207], a[180:183], v[120:123]
  v_mfma_f32_16x16x32_bf16 v[128:131], v[204:207], a[204:207], v[128:131]
  v_cvt_pk_bf16_f32 v37, v90, v91
  v_mfma_f32_16x16x32_bf16 v[136:139], v[204:207], a[228:231], v[136:139]
  v_mfma_f32_16x16x32_bf16 v[108:111], v[228:231], a[132:135], v[108:111]
  v_cvt_pk_bf16_f32 v38, v92, v93
  v_mfma_f32_16x16x32_bf16 v[116:119], v[228:231], a[156:159], v[116:119]
  v_cvt_pk_bf16_f32 v39, v94, v95
  s_waitcnt lgkmcnt(0)
  v_mfma_f32_16x16x32_bf16 v[124:127], v[228:231], a[180:183], v[124:127]
  v_bitop3_b32 v240, v240, v241, v242 bitop3:0x80
  v_and_b32 v240, v240, v243
  v_mfma_f32_16x16x32_bf16 v[132:135], v[228:231], a[204:207], v[132:135]
  buffer_store_dwordx4 v[36:39], v4, s[24:27], s42 offen offset:3072 sc1
  v_mfma_f32_16x16x32_bf16 v[140:143], v[228:231], a[228:231], v[140:143]
  s_nop 0
  v_readfirstlane_b32 s23, v240
  v_mfma_f32_16x16x32_bf16 v[104:107], v[208:211], a[136:139], v[104:107]
  v_cvt_pk_bf16_f32 v40, v96, v97
  v_mfma_f32_16x16x32_bf16 v[112:115], v[208:211], a[160:163], v[112:115]
  v_mfma_f32_16x16x32_bf16 v[120:123], v[208:211], a[184:187], v[120:123]
  v_cvt_pk_bf16_f32 v41, v98, v99
  v_mfma_f32_16x16x32_bf16 v[128:131], v[208:211], a[208:211], v[128:131]
  v_mfma_f32_16x16x32_bf16 v[136:139], v[208:211], a[232:235], v[136:139]
  v_cvt_pk_bf16_f32 v42, v100, v101
  v_mfma_f32_16x16x32_bf16 v[108:111], v[232:235], a[136:139], v[108:111]
  v_mfma_f32_16x16x32_bf16 v[116:119], v[232:235], a[160:163], v[116:119]
  v_cvt_pk_bf16_f32 v43, v102, v103
  v_mfma_f32_16x16x32_bf16 v[124:127], v[232:235], a[184:187], v[124:127]
  s_add_u32 s69, s42, 4096
  v_mfma_f32_16x16x32_bf16 v[132:135], v[232:235], a[208:211], v[132:135]
  v_mfma_f32_16x16x32_bf16 v[140:143], v[232:235], a[232:235], v[140:143]
  buffer_store_dwordx4 v[40:43], v4, s[24:27], s69 offen offset:0 sc1
  v_mfma_f32_16x16x32_bf16 v[104:107], v[212:215], a[140:143], v[104:107]
  v_mfma_f32_16x16x32_bf16 v[112:115], v[212:215], a[164:167], v[112:115]
  v_mfma_f32_16x16x32_bf16 v[120:123], v[212:215], a[188:191], v[120:123]
  s_waitcnt vmcnt(12)
  s_mov_b32 s50, s46
  s_add_u32 s69, s45, s40
  v_mfma_f32_16x16x32_bf16 v[128:131], v[212:215], a[212:215], v[128:131]
  s_mov_b32 s40, 0
  s_sub_i32 s69, s69, 1
  s_max_i32 s69, s69, s70
  v_mfma_f32_16x16x32_bf16 v[136:139], v[212:215], a[236:239], v[136:139]
  s_add_u32 s45, s45, 1
  s_mov_b32 s68, s42
  s_add_u32 s42, s42, 1310720
  v_mfma_f32_16x16x32_bf16 v[108:111], v[236:239], a[140:143], v[108:111]
  s_add_u32 s21, s45, 1
  s_min_u32 s21, s21, 63
  v_mfma_f32_16x16x32_bf16 v[116:119], v[236:239], a[164:167], v[116:119]
  s_cmp_lt_u32 s21, s50
  s_addc_u32 s21, s31, s31
  v_mov_b32 v21, s21
  v_mfma_f32_16x16x32_bf16 v[124:127], v[236:239], a[188:191], v[124:127]
  ds_write_b32 v6, v21 offset:0
  v_mfma_f32_16x16x32_bf16 v[132:135], v[236:239], a[212:215], v[132:135]
  v_mfma_f32_16x16x32_bf16 v[140:143], v[236:239], a[236:239], v[140:143]
  s_mov_b64 exec, 1
  v_mov_b32 v20, s69
  buffer_store_dword v20, v10, s[72:75], s44 offen sc1
  s_mov_b64 exec, -1
  s_cmp_le_u32 s45, 16
  s_cbranch_scc1 vwe_177
vwe_178:
  s_cmp_lg_u32 s45, 48
  s_cbranch_scc1 arm_181
  s_mul_i32 s21, s2, 10240
  s_mul_i32 s22, s20, 2560
  s_add_u32 s21, s21, s22
  s_add_u32 s21, s21, 18350080
  buffer_store_dwordx4 v[244:247], v15, s[80:83], s21 offen offset:0 sc1
  buffer_store_dwordx4 v[244:247], v15, s[80:83], s21 offen offset:512 sc1
  buffer_store_dwordx4 v[244:247], v15, s[80:83], s21 offen offset:1024 sc1
  buffer_store_dwordx4 v[244:247], v15, s[80:83], s21 offen offset:1536 sc1
  buffer_store_dwordx4 v[244:247], v15, s[80:83], s21 offen offset:2048 sc1
  s_add_u32 s21, s21, 655360
  buffer_store_dwordx4 v[244:247], v15, s[80:83], s21 offen offset:0 sc1
  buffer_store_dwordx4 v[244:247], v15, s[80:83], s21 offen offset:512 sc1
  buffer_store_dwordx4 v[244:247], v15, s[80:83], s21 offen offset:1024 sc1
  buffer_store_dwordx4 v[244:247], v15, s[80:83], s21 offen offset:1536 sc1
  buffer_store_dwordx4 v[244:247], v15, s[80:83], s21 offen offset:2048 sc1
  s_add_u32 s21, s21, 655360
  buffer_store_dwordx4 v[244:247], v15, s[80:83], s21 offen offset:0 sc1
  buffer_store_dwordx4 v[244:247], v15, s[80:83], s21 offen offset:512 sc1
  buffer_store_dwordx4 v[244:247], v15, s[80:83], s21 offen offset:1024 sc1
  buffer_store_dwordx4 v[244:247], v15, s[80:83], s21 offen offset:1536 sc1
  buffer_store_dwordx4 v[244:247], v15, s[80:83], s21 offen offset:2048 sc1
  s_add_u32 s21, s21, 655360
  buffer_store_dwordx4 v[244:247], v15, s[80:83], s21 offen offset:0 sc1
  buffer_store_dwordx4 v[244:247], v15, s[80:83], s21 offen offset:512 sc1
  buffer_store_dwordx4 v[244:247], v15, s[80:83], s21 offen offset:1024 sc1
  buffer_store_dwordx4 v[244:247], v15, s[80:83], s21 offen offset:1536 sc1
  buffer_store_dwordx4 v[244:247], v15, s[80:83], s21 offen offset:2048 sc1
  s_add_u32 s21, s21, 655360
  s_and_b32 s21, s2, 3
  s_cmp_lg_u32 s21, s20
  s_cbranch_scc1 arm_181
  s_mul_i32 s21, s2, 2560
  s_add_u32 s21, s21, 4587520
  v_lshlrev_b32 v21, 3, v1
  buffer_store_dwordx4 v[244:247], v4, s[88:91], s21 offen sc1
  buffer_store_dwordx4 v[244:247], v4, s[88:91], s21 offen offset:1024 sc1
  buffer_store_dwordx2 v[244:245], v21, s[88:91], s21 offen offset:2048 sc1
  s_add_u32 s21, s21, 81920
  buffer_store_dwordx4 v[244:247], v4, s[88:91], s21 offen sc1
  buffer_store_dwordx4 v[244:247], v4, s[88:91], s21 offen offset:1024 sc1
  buffer_store_dwordx2 v[244:245], v21, s[88:91], s21 offen offset:2048 sc1
  s_add_u32 s21, s21, 81920
  buffer_store_dwordx4 v[244:247], v4, s[88:91], s21 offen sc1
  buffer_store_dwordx4 v[244:247], v4, s[88:91], s21 offen offset:1024 sc1
  buffer_store_dwordx2 v[244:245], v21, s[88:91], s21 offen offset:2048 sc1
  s_add_u32 s21, s21, 81920
  buffer_store_dwordx4 v[244:247], v4, s[88:91], s21 offen sc1
  buffer_store_dwordx4 v[244:247], v4, s[88:91], s21 offen offset:1024 sc1
  buffer_store_dwordx2 v[244:245], v21, s[88:91], s21 offen offset:2048 sc1
  s_add_u32 s21, s21, 81920
  buffer_store_dwordx4 v[244:247], v4, s[88:91], s21 offen sc1
  buffer_store_dwordx4 v[244:247], v4, s[88:91], s21 offen offset:1024 sc1
  buffer_store_dwordx2 v[244:245], v21, s[88:91], s21 offen offset:2048 sc1
  s_add_u32 s21, s21, 81920
  buffer_store_dwordx4 v[244:247], v4, s[88:91], s21 offen sc1
  buffer_store_dwordx4 v[244:247], v4, s[88:91], s21 offen offset:1024 sc1
  buffer_store_dwordx2 v[244:245], v21, s[88:91], s21 offen offset:2048 sc1
  s_add_u32 s21, s21, 81920
  buffer_store_dwordx4 v[244:247], v4, s[88:91], s21 offen sc1
  buffer_store_dwordx4 v[244:247], v4, s[88:91], s21 offen offset:1024 sc1
  buffer_store_dwordx2 v[244:245], v21, s[88:91], s21 offen offset:2048 sc1
  s_add_u32 s21, s21, 81920
  buffer_store_dwordx4 v[244:247], v4, s[88:91], s21 offen sc1
  buffer_store_dwordx4 v[244:247], v4, s[88:91], s21 offen offset:1024 sc1
  buffer_store_dwordx2 v[244:245], v21, s[88:91], s21 offen offset:2048 sc1
  s_add_u32 s21, s21, 81920
arm_181:
  s_cmp_ge_u32 s45, 64
  s_cbranch_scc1 vwd_164
  s_cmp_lg_u32 s23, 0
  s_cbranch_scc1 vwl_163
  s_branch vws_175
vws_167:
  v_cmp_gt_u32 vcc, 8, v9
  s_nop 0
  s_bitset1_b64 vcc, 19
  s_ff1_i32_b64 s21, vcc
  s_lshl_b32 s22, s21, 1
  s_lshl_b32 s21, s21, 2
  s_sub_i32 s21, s21, 12
  s_max_i32 s47, s21, s22
  s_cmp_gt_u32 s47, s45
  s_cbranch_scc1 va_183
  s_cmp_eq_u32 s70, s45
  s_cbranch_scc1 va_188
  s_nop 4
  v_cvt_pk_bf16_f32 v44, v104, v105
  v_cvt_pk_bf16_f32 v45, v106, v107
  v_cvt_pk_bf16_f32 v46, v108, v109
  v_cvt_pk_bf16_f32 v47, v110, v111
  s_add_u32 s69, s68, 4096
  buffer_store_dwordx4 v[44:47], v4, s[24:27], s69 offen offset:1024 sc1
  v_cvt_pk_bf16_f32 v48, v112, v113
  v_cvt_pk_bf16_f32 v49, v114, v115
  v_cvt_pk_bf16_f32 v50, v116, v117
  v_cvt_pk_bf16_f32 v51, v118, v119
  buffer_store_dwordx4 v[48:51], v4, s[24:27], s69 offen offset:2048 sc1
  v_cvt_pk_bf16_f32 v52, v120, v121
  v_cvt_pk_bf16_f32 v53, v122, v123
  v_cvt_pk_bf16_f32 v54, v124, v125
  v_cvt_pk_bf16_f32 v55, v126, v127
  buffer_store_dwordx4 v[52:55], v4, s[24:27], s69 offen offset:3072 sc1
  v_cvt_pk_bf16_f32 v56, v128, v129
  v_cvt_pk_bf16_f32 v57, v130, v131
  v_cvt_pk_bf16_f32 v58, v132, v133
  v_cvt_pk_bf16_f32 v59, v134, v135
  s_add_u32 s69, s68, 8192
  buffer_store_dwordx4 v[56:59], v4, s[24:27], s69 offen offset:0 sc1
  v_cvt_pk_bf16_f32 v60, v136, v137
  v_cvt_pk_bf16_f32 v61, v138, v139
  v_cvt_pk_bf16_f32 v62, v140, v141
  v_cvt_pk_bf16_f32 v63, v142, v143
  buffer_store_dwordx4 v[60:63], v4, s[24:27], s69 offen offset:1024 sc1
  s_mov_b32 s68, 0x80000000
  s_waitcnt vmcnt(0)
  s_mov_b64 exec, 1
  v_mov_b32 v20, s45
  buffer_store_dword v20, v10, s[72:75], s44 offen sc1
  s_mov_b64 exec, -1
  s_mov_b32 s70, s45
  s_mov_b32 s40, 0
va_188:
  s_mov_b32 s101, 0
  s_branch va_186
va_184:
  s_sleep 8
va_186:
  buffer_load_dword v9, v5, s[72:75], s43 offen sc1
  s_add_u32 s101, s101, 1
  s_cmp_gt_u32 s101, 131072
  s_cbranch_scc1 main_end
  s_waitcnt vmcnt(0)
  v_cmp_gt_u32 vcc, 8, v9
  s_nop 0
  s_bitset1_b64 vcc, 19
  s_ff1_i32_b64 s21, vcc
  s_lshl_b32 s22, s21, 1
  s_lshl_b32 s21, s21, 2
  s_sub_i32 s21, s21, 12
  s_max_i32 s47, s21, s22
  s_cmp_gt_u32 s47, s45
  s_cbranch_scc0 va_184
va_183:
  s_add_u32 s22, s45, 6
  s_min_u32 s22, s22, s47
va_185:
  s_cmp_ge_u32 s46, s22
  s_cbranch_scc1 va_187
  s_mov_b32 m0, s64
  s_mov_b32 s66, s41
  buffer_load_dwordx4 v4, s[16:19], s66 offen offset:0 sc1 lds
  buffer_load_dwordx4 v4, s[16:19], s66 offen offset:1024 sc1 lds
  buffer_load_dwordx4 v4, s[16:19], s66 offen offset:2048 sc1 lds
  s_add_u32 s46, s46, 1
  s_add_u32 s41, s41, 393216
  s_add_u32 s64, s64, 12288
  s_cmp_lt_u32 s64, s67
  s_cselect_b32 s64, s64, s71
  s_branch va_185
va_187:
  s_mov_b32 s48, s46
  s_mov_b32 s49, s46
  s_mov_b32 s50, s46
  s_waitcnt vmcnt(0)
  s_cmp_eq_u32 s40, 0
  s_cbranch_scc1 va_189
  s_mov_b32 s40, 0
  s_mov_b64 exec, 1
  v_mov_b32 v20, s45
  buffer_store_dword v20, v10, s[72:75], s44 offen sc1
  s_mov_b64 exec, -1
  s_mov_b32 s70, s45
va_189:
  s_barrier
  ds_read_b128 v[192:195], v8 offset:0
  ds_read_b128 v[196:199], v8 offset:1024
  ds_read_b128 v[200:203], v8 offset:2048
  ds_read_b128 v[204:207], v8 offset:3072
  ds_read_b128 v[208:211], v8 offset:4096
  ds_read_b128 v[212:215], v8 offset:5120
  ds_read_b128 v[216:219], v8 offset:6144
  ds_read_b128 v[220:223], v8 offset:7168
  ds_read_b128 v[224:227], v8 offset:8192
  ds_read_b128 v[228:231], v8 offset:9216
  ds_read_b128 v[232:235], v8 offset:10240
  ds_read_b128 v[236:239], v8 offset:11264
  s_add_u32 s21, s45, 1
  s_min_u32 s21, s21, 63
  s_cmp_lt_u32 s21, s50
  s_addc_u32 s21, s31, s31
  v_mov_b32 v21, s21
  ds_write_b32 v6, v21 offset:16
  s_branch vwb_168
vws_175:
  v_cmp_gt_u32 vcc, 8, v9
  s_nop 0
  s_bitset1_b64 vcc, 19
  s_ff1_i32_b64 s21, vcc
  s_lshl_b32 s22, s21, 1
  s_lshl_b32 s21, s21, 2
  s_sub_i32 s21, s21, 12
  s_max_i32 s47, s21, s22
  s_cmp_gt_u32 s47, s45
  s_cbranch_scc1 va_190
  s_cmp_eq_u32 s70, s45
  s_cbranch_scc1 va_195
  s_nop 4
  v_cvt_pk_bf16_f32 v44, v104, v105
  v_cvt_pk_bf16_f32 v45, v106, v107
  v_cvt_pk_bf16_f32 v46, v108, v109
  v_cvt_pk_bf16_f32 v47, v110, v111
  s_add_u32 s69, s68, 4096
  buffer_store_dwordx4 v[44:47], v4, s[24:27], s69 offen offset:1024 sc1
  v_cvt_pk_bf16_f32 v48, v112, v113
  v_cvt_pk_bf16_f32 v49, v114, v115
  v_cvt_pk_bf16_f32 v50, v116, v117
  v_cvt_pk_bf16_f32 v51, v118, v119
  buffer_store_dwordx4 v[48:51], v4, s[24:27], s69 offen offset:2048 sc1
  v_cvt_pk_bf16_f32 v52, v120, v121
  v_cvt_pk_bf16_f32 v53, v122, v123
  v_cvt_pk_bf16_f32 v54, v124, v125
  v_cvt_pk_bf16_f32 v55, v126, v127
  buffer_store_dwordx4 v[52:55], v4, s[24:27], s69 offen offset:3072 sc1
  v_cvt_pk_bf16_f32 v56, v128, v129
  v_cvt_pk_bf16_f32 v57, v130, v131
  v_cvt_pk_bf16_f32 v58, v132, v133
  v_cvt_pk_bf16_f32 v59, v134, v135
  s_add_u32 s69, s68, 8192
  buffer_store_dwordx4 v[56:59], v4, s[24:27], s69 offen offset:0 sc1
  v_cvt_pk_bf16_f32 v60, v136, v137
  v_cvt_pk_bf16_f32 v61, v138, v139
  v_cvt_pk_bf16_f32 v62, v140, v141
  v_cvt_pk_bf16_f32 v63, v142, v143
  buffer_store_dwordx4 v[60:63], v4, s[24:27], s69 offen offset:1024 sc1
  s_mov_b32 s68, 0x80000000
  s_waitcnt vmcnt(0)
  s_mov_b64 exec, 1
  v_mov_b32 v20, s45
  buffer_store_dword v20, v10, s[72:75], s44 offen sc1
  s_mov_b64 exec, -1
  s_mov_b32 s70, s45
  s_mov_b32 s40, 0
va_195:
  s_mov_b32 s101, 0
  s_branch va_193
va_191:
  s_sleep 8
va_193:
  buffer_load_dword v9, v5, s[72:75], s43 offen sc1
  s_add_u32 s101, s101, 1
  s_cmp_gt_u32 s101, 131072
  s_cbranch_scc1 main_end
  s_waitcnt vmcnt(0)
  v_cmp_gt_u32 vcc, 8, v9
  s_nop 0
  s_bitset1_b64 vcc, 19
  s_ff1_i32_b64 s21, vcc
  s_lshl_b32 s22, s21, 1
  s_lshl_b32 s21, s21, 2
  s_sub_i32 s21, s21, 12
  s_max_i32 s47, s21, s22
  s_cmp_gt_u32 s47, s45
  s_cbranch_scc0 va_191
va_190:
  s_add_u32 s22, s45, 6
  s_min_u32 s22, s22, s47
va_192:
  s_cmp_ge_u32 s46, s22
  s_cbranch_scc1 va_194
  s_mov_b32 m0, s64
  s_mov_b32 s66, s41
  buffer_load_dwordx4 v4, s[16:19], s66 offen offset:0 sc1 lds
  buffer_load_dwordx4 v4, s[16:19], s66 offen offset:1024 sc1 lds
  buffer_load_dwordx4 v4, s[16:19], s66 offen offset:2048 sc1 lds
  s_add_u32 s46, s46, 1
  s_add_u32 s41, s41, 393216
  s_add_u32 s64, s64, 12288
  s_cmp_lt_u32 s64, s67
  s_cselect_b32 s64, s64, s71
  s_branch va_192
va_194:
  s_mov_b32 s48, s46
  s_mov_b32 s49, s46
  s_mov_b32 s50, s46
  s_waitcnt vmcnt(0)
  s_cmp_eq_u32 s40, 0
  s_cbranch_scc1 va_196
  s_mov_b32 s40, 0
  s_mov_b64 exec, 1
  v_mov_b32 v20, s45
  buffer_store_dword v20, v10, s[72:75], s44 offen sc1
  s_mov_b64 exec, -1
  s_mov_b32 s70, s45
va_196:
  s_barrier
  ds_read_b128 v[144:147], v8 offset:0
  ds_read_b128 v[148:151], v8 offset:1024
  ds_read_b128 v[152:155], v8 offset:2048
  ds_read_b128 v[156:159], v8 offset:3072
  ds_read_b128 v[160:163], v8 offset:4096
  ds_read_b128 v[164:167], v8 offset:5120
  ds_read_b128 v[168:171], v8 offset:6144
  ds_read_b128 v[172:175], v8 offset:7168
  ds_read_b128 v[176:179], v8 offset:8192
  ds_read_b128 v[180:183], v8 offset:9216
  ds_read_b128 v[184:187], v8 offset:10240
  ds_read_b128 v[188:191], v8 offset:11264
  s_add_u32 s21, s45, 1
  s_min_u32 s21, s21, 63
  s_cmp_lt_u32 s21, s50
  s_addc_u32 s21, s31, s31
  v_mov_b32 v21, s21
  ds_write_b32 v6, v21 offset:0
  s_branch vwl_163
vwe_169:
  s_nop 4
  v_cvt_pk_bf16_f32 v44, v104, v105
  v_cvt_pk_bf16_f32 v45, v106, v107
  v_cvt_pk_bf16_f32 v46, v108, v109
  v_cvt_pk_bf16_f32 v47, v110, v111
  s_add_u32 s69, s68, 4096
  buffer_store_dwordx4 v[44:47], v4, s[24:27], s69 offen offset:1024 sc1
  v_cvt_pk_bf16_f32 v48, v112, v113
  v_cvt_pk_bf16_f32 v49, v114, v115
  v_cvt_pk_bf16_f32 v50, v116, v117
  v_cvt_pk_bf16_f32 v51, v118, v119
  buffer_store_dwordx4 v[48:51], v4, s[24:27], s69 offen offset:2048 sc1
  v_cvt_pk_bf16_f32 v52, v120, v121
  v_cvt_pk_bf16_f32 v53, v122, v123
  v_cvt_pk_bf16_f32 v54, v124, v125
  v_cvt_pk_bf16_f32 v55, v126, v127
  buffer_store_dwordx4 v[52:55], v4, s[24:27], s69 offen offset:3072 sc1
  v_cvt_pk_bf16_f32 v56, v128, v129
  v_cvt_pk_bf16_f32 v57, v130, v131
  v_cvt_pk_bf16_f32 v58, v132, v133
  v_cvt_pk_bf16_f32 v59, v134, v135
  s_add_u32 s69, s68, 8192
  buffer_store_dwordx4 v[56:59], v4, s[24:27], s69 offen offset:0 sc1
  v_cvt_pk_bf16_f32 v60, v136, v137
  v_cvt_pk_bf16_f32 v61, v138, v139
  v_cvt_pk_bf16_f32 v62, v140, v141
  v_cvt_pk_bf16_f32 v63, v142, v143
  buffer_store_dwordx4 v[60:63], v4, s[24:27], s69 offen offset:1024 sc1
  s_mov_b32 s68, 0x80000000
  s_cmp_le_u32 s45, 4
  s_cselect_b32 s40, 3, 1
  s_branch vwe_170
vwe_177:
  s_nop 4
  v_cvt_pk_bf16_f32 v44, v104, v105
  v_cvt_pk_bf16_f32 v45, v106, v107
  v_cvt_pk_bf16_f32 v46, v108, v109
  v_cvt_pk_bf16_f32 v47, v110, v111
  s_add_u32 s69, s68, 4096
  buffer_store_dwordx4 v[44:47], v4, s[24:27], s69 offen offset:1024 sc1
  v_cvt_pk_bf16_f32 v48, v112, v113
  v_cvt_pk_bf16_f32 v49, v114, v115
  v_cvt_pk_bf16_f32 v50, v116, v117
  v_cvt_pk_bf16_f32 v51, v118, v119
  buffer_store_dwordx4 v[48:51], v4, s[24:27], s69 offen offset:2048 sc1
  v_cvt_pk_bf16_f32 v52, v120, v121
  v_cvt_pk_bf16_f32 v53, v122, v123
  v_cvt_pk_bf16_f32 v54, v124, v125
  v_cvt_pk_bf16_f32 v55, v126, v127
  buffer_store_dwordx4 v[52:55], v4, s[24:27], s69 offen offset:3072 sc1
  v_cvt_pk_bf16_f32 v56, v128, v129
  v_cvt_pk_bf16_f32 v57, v130, v131
  v_cvt_pk_bf16_f32 v58, v132, v133
  v_cvt_pk_bf16_f32 v59, v134, v135
  s_add_u32 s69, s68, 8192
  buffer_store_dwordx4 v[56:59], v4, s[24:27], s69 offen offset:0 sc1
  v_cvt_pk_bf16_f32 v60, v136, v137
  v_cvt_pk_bf16_f32 v61, v138, v139
  v_cvt_pk_bf16_f32 v62, v140, v141
  v_cvt_pk_bf16_f32 v63, v142, v143
  buffer_store_dwordx4 v[60:63], v4, s[24:27], s69 offen offset:1024 sc1
  s_mov_b32 s68, 0x80000000
  s_cmp_le_u32 s45, 4
  s_cselect_b32 s40, 3, 1
  s_branch vwe_178
vwm_165:
  s_mov_b32 s40, 0
  s_waitcnt vmcnt(11)
  s_mov_b64 exec, 1
  v_mov_b32 v20, s45
  buffer_store_dword v20, v10, s[72:75], s44 offen sc1
  s_mov_b64 exec, -1
  s_mov_b32 s70, s45
  s_branch vwm_166
vwm_173:
  s_mov_b32 s40, 0
  s_waitcnt vmcnt(11)
  s_mov_b64 exec, 1
  v_mov_b32 v20, s45
  buffer_store_dword v20, v10, s[72:75], s44 offen sc1
  s_mov_b64 exec, -1
  s_mov_b32 s70, s45
  s_branch vwm_174
vwd_164:
  s_nop 4
  v_cvt_pk_bf16_f32 v44, v104, v105
  v_cvt_pk_bf16_f32 v45, v106, v107
  v_cvt_pk_bf16_f32 v46, v108, v109
  v_cvt_pk_bf16_f32 v47, v110, v111
  s_add_u32 s69, s68, 4096
  buffer_store_dwordx4 v[44:47], v4, s[24:27], s69 offen offset:1024 sc1
  v_cvt_pk_bf16_f32 v48, v112, v113
  v_cvt_pk_bf16_f32 v49, v114, v115
  v_cvt_pk_bf16_f32 v50, v116, v117
  v_cvt_pk_bf16_f32 v51, v118, v119
  buffer_store_dwordx4 v[48:51], v4, s[24:27], s69 offen offset:2048 sc1
  v_cvt_pk_bf16_f32 v52, v120, v121
  v_cvt_pk_bf16_f32 v53, v122, v123
  v_cvt_pk_bf16_f32 v54, v124, v125
  v_cvt_pk_bf16_f32 v55, v126, v127
  buffer_store_dwordx4 v[52:55], v4, s[24:27], s69 offen offset:3072 sc1
  v_cvt_pk_bf16_f32 v56, v128, v129
  v_cvt_pk_bf16_f32 v57, v130, v131
  v_cvt_pk_bf16_f32 v58, v132, v133
  v_cvt_pk_bf16_f32 v59, v134, v135
  s_add_u32 s69, s68, 8192
  buffer_store_dwordx4 v[56:59], v4, s[24:27], s69 offen offset:0 sc1
  v_cvt_pk_bf16_f32 v60, v136, v137
  v_cvt_pk_bf16_f32 v61, v138, v139
  v_cvt_pk_bf16_f32 v62, v140, v141
  v_cvt_pk_bf16_f32 v63, v142, v143
  buffer_store_dwordx4 v[60:63], v4, s[24:27], s69 offen offset:1024 sc1
  s_waitcnt vmcnt(0)
  s_mov_b64 exec, 1
  v_mov_b32 v20, s45
  buffer_store_dword v20, v10, s[72:75], s44 offen sc1
  s_mov_b64 exec, -1
  s_mov_b32 s84, 0
  s_mov_b32 s85, -1
  s_and_b32 s21, s3, 3
  s_sub_u32 s22, s21, 1
  s_lshl_b32 s22, s22, 3
  s_bfe_u32 s87, s3, 0x30002
  s_add_u32 s87, s87, s22
  s_add_u32 s87, s87, 366
  s_cmp_lt_u32 s21, 1
  s_cselect_b32 s87, -1, s87
  s_sub_u32 s21, s3, 64
  s_waitcnt vmcnt(0) lgkmcnt(0)
  s_barrier
  s_branch do_opb2
  s_mov_b32 s84, 0
  s_mov_b32 s85, -1
  s_mov_b32 s86, 0
  s_branch queue
not_vw:
  s_sub_u32 s2, s3, 96
  s_cmp_lg_u32 s2, 31
  s_cbranch_scc1 not_cal
  s_add_u32 s8, s38, 83886079
  s_addc_u32 s9, s39, 0
  s_and_b32 s8, s8, 0xffe00000
  s_mov_b32 s10, 2097152
  s_mov_b32 s11, 0x00020000
  v_lshrrev_b32 v9, 4, v0
  v_mul_u32_u24 v9, 16640, v9
  v_bfe_u32 v10, v0, 3, 1
  v_lshl_add_u32 v9, v10, 13, v9
  v_and_b32 v10, 7, v0
  v_lshl_add_u32 v9, v10, 4, v9
  s_mov_b32 s21, 1048576
  buffer_store_dwordx4 v[4:7], v9, s[8:11], s21 offen sc1
  s_waitcnt vmcnt(0)
  s_barrier
  s_cmp_lg_u32 s20, 3
  s_cbranch_scc1 cal_197
  s_mov_b64 exec, 1
  v_mov_b32 v4, 0
  s_mov_b32 s40, -1
  s_mov_b32 s41, -1
  s_mov_b32 s42, 1048576
  s_mov_b32 s43, 0
  s_waitcnt vmcnt(0)
cal_198:
  s_add_u32 s21, s42, 0
  s_memtime s[98:99]
  s_waitcnt lgkmcnt(0)
  buffer_load_dword v5, v4, s[8:11], s21 offen sc1
  s_waitcnt vmcnt(0)
  s_memtime s[100:101]
  s_waitcnt lgkmcnt(0)
  s_sub_u32 s21, s100, s98
  s_min_u32 s40, s40, s21
  s_add_u32 s21, s42, 8192
  s_memtime s[98:99]
  s_waitcnt lgkmcnt(0)
  buffer_load_dword v5, v4, s[8:11], s21 offen sc1
  s_waitcnt vmcnt(0)
  s_memtime s[100:101]
  s_waitcnt lgkmcnt(0)
  s_sub_u32 s21, s100, s98
  s_min_u32 s41, s41, s21
  s_add_u32 s42, s42, 16640
  s_add_u32 s43, s43, 1
  s_cmp_lt_u32 s43, 4
  s_cbranch_scc1 cal_198
  s_cmp_lt_u32 s41, s40
  s_cselect_b32 s21, 1, 2
  v_mov_b32 v4, s21
  v_mov_b32 v5, s40
  v_mov_b32 v6, s41
  v_mov_b32 v8, 84
  buffer_store_dwordx3 v[4:6], v8, s[32:35], 0 offen sc1
  s_waitcnt vmcnt(0)
  s_mov_b64 exec, -1
cal_197:
  s_barrier
  s_branch armed
not_cal:
armed:
  s_load_dwordx2 s[72:73], s[0:1], 104
  s_waitcnt lgkmcnt(0)
  s_add_u32 s72, s72, 81068032
  s_addc_u32 s73, s73, 0
  s_mov_b32 s74, 116736
  s_mov_b32 s75, 0x00020000
  s_load_dwordx2 s[4:5], s[0:1], 0
  s_load_dwordx2 s[6:7], s[0:1], 64
  s_load_dwordx2 s[38:39], s[0:1], 104
  s_lshr_b32 s41, s2, 1
  s_and_b32 s42, s2, 1
  s_waitcnt lgkmcnt(0)
  s_mov_b32 s8, s4
  s_mov_b32 s9, s5
  s_mov_b32 s10, 2621440
  s_mov_b32 s11, 0x00020000
  s_mov_b32 s12, s6
  s_mov_b32 s13, s7
  s_mov_b32 s14, 2457600
  s_mov_b32 s15, 0x00020000
  s_add_u32 s16, s38, 70713344
  s_addc_u32 s17, s39, 0
  s_mov_b32 s18, 2641920
  s_mov_b32 s19, 0x00020000
  s_add_u32 s72, s38, 81068032
  s_addc_u32 s73, s39, 0
  s_mov_b32 s74, 116736
  s_mov_b32 s75, 0x00020000
  s_lshl_b32 s21, s2, 2
  s_add_u32 s21, s21, s20
  s_mul_i32 s21, s21, 19200
  v_lshlrev_b32 v5, 4, v1
  buffer_load_dwordx4 v[64:67], v5, s[12:15], s21 offen offset:0
  buffer_load_dwordx4 v[64:67], v5, s[12:15], s21 offen offset:1024
  buffer_load_dwordx4 v[64:67], v5, s[12:15], s21 offen offset:2048
  buffer_load_dwordx4 v[64:67], v5, s[12:15], s21 offen offset:3072
  s_add_u32 s21, s21, 4096
  buffer_load_dwordx4 v[64:67], v5, s[12:15], s21 offen offset:0
  buffer_load_dwordx4 v[64:67], v5, s[12:15], s21 offen offset:1024
  buffer_load_dwordx4 v[64:67], v5, s[12:15], s21 offen offset:2048
  buffer_load_dwordx4 v[64:67], v5, s[12:15], s21 offen offset:3072
  s_add_u32 s21, s21, 4096
  buffer_load_dwordx4 v[64:67], v5, s[12:15], s21 offen offset:0
  buffer_load_dwordx4 v[64:67], v5, s[12:15], s21 offen offset:1024
  buffer_load_dwordx4 v[64:67], v5, s[12:15], s21 offen offset:2048
  buffer_load_dwordx4 v[64:67], v5, s[12:15], s21 offen offset:3072
  s_add_u32 s21, s21, 4096
  buffer_load_dwordx4 v[64:67], v5, s[12:15], s21 offen offset:0
  buffer_load_dwordx4 v[64:67], v5, s[12:15], s21 offen offset:1024
  buffer_load_dwordx4 v[64:67], v5, s[12:15], s21 offen offset:2048
  buffer_load_dwordx4 v[64:67], v5, s[12:15], s21 offen offset:3072
  s_add_u32 s21, s21, 4096
  buffer_load_dwordx4 v[64:67], v5, s[12:15], s21 offen offset:0
  buffer_load_dwordx4 v[64:67], v5, s[12:15], s21 offen offset:1024
  buffer_load_dwordx4 v[64:67], v5, s[12:15], s21 offen offset:2048
  s_waitcnt vmcnt(0)
  v_lshlrev_b32 v6, 1, v3
  v_add_u32 v6, 0, v6
  v_xor_b32 v6, v6, v2
  v_min_u32 v6, 14, v6
  v_mul_u32_u24 v7, 52, v6
  v_lshrrev_b32 v7, 8, v7
  v_mul_u32_u24 v7, 1200, v7
  v_lshl_add_u32 v7, v6, 4, v7
  v_mul_u32_u24 v6, 3840, v3
  v_add_u32 v4, v6, v7
  v_lshlrev_b32 v6, 1, v3
  v_add_u32 v6, 8, v6
  v_xor_b32 v6, v6, v2
  v_min_u32 v6, 14, v6
  v_mul_u32_u24 v7, 52, v6
  v_lshrrev_b32 v7, 8, v7
  v_mul_u32_u24 v7, 1200, v7
  v_lshl_add_u32 v7, v6, 4, v7
  v_mul_u32_u24 v6, 3840, v3
  v_add_u32 v5, v6, v7
  s_mul_i32 s21, s41, 80
  s_mul_i32 s22, s20, 15360
  s_add_u32 s21, s21, s22
  s_lshl_b32 s22, s20, 10
  s_cmp_ge_u32 s20, 2
  s_cselect_b64 vcc, -1, 0
  v_cndmask_b32 v4, v4, v5, vcc
  s_add_u32 m0, s22, 0
  s_nop 0
  buffer_load_dwordx4 v4, s[12:15], s21 offen lds
  s_add_u32 s21, s21, 61440
  s_add_u32 m0, s22, 4096
  s_nop 0
  buffer_load_dwordx4 v4, s[12:15], s21 offen lds
  s_add_u32 s21, s21, 61440
  s_add_u32 m0, s22, 8192
  s_nop 0
  buffer_load_dwordx4 v4, s[12:15], s21 offen lds
  s_add_u32 s21, s21, 61440
  s_add_u32 m0, s22, 12288
  s_nop 0
  buffer_load_dwordx4 v4, s[12:15], s21 offen lds
  s_add_u32 s21, s21, 61440
  s_add_u32 m0, s22, 16384
  s_nop 0
  buffer_load_dwordx4 v4, s[12:15], s21 offen lds
  s_add_u32 s21, s21, 61440
  s_add_u32 m0, s22, 20480
  s_nop 0
  buffer_load_dwordx4 v4, s[12:15], s21 offen lds
  s_add_u32 s21, s21, 61440
  s_add_u32 m0, s22, 24576
  s_nop 0
  buffer_load_dwordx4 v4, s[12:15], s21 offen lds
  s_add_u32 s21, s21, 61440
  s_add_u32 m0, s22, 28672
  s_nop 0
  buffer_load_dwordx4 v4, s[12:15], s21 offen lds
  s_add_u32 s21, s21, 61440
  s_add_u32 m0, s22, 32768
  s_nop 0
  buffer_load_dwordx4 v4, s[12:15], s21 offen lds
  s_add_u32 s21, s21, 61440
  s_add_u32 m0, s22, 36864
  s_nop 0
  buffer_load_dwordx4 v4, s[12:15], s21 offen lds
  s_add_u32 s21, s21, 61440
  s_add_u32 m0, s22, 40960
  s_nop 0
  buffer_load_dwordx4 v4, s[12:15], s21 offen lds
  s_add_u32 s21, s21, 61440
  s_add_u32 m0, s22, 45056
  s_nop 0
  buffer_load_dwordx4 v4, s[12:15], s21 offen lds
  s_add_u32 s21, s21, 61440
  s_add_u32 m0, s22, 49152
  s_nop 0
  buffer_load_dwordx4 v4, s[12:15], s21 offen lds
  s_add_u32 s21, s21, 61440
  s_add_u32 m0, s22, 53248
  s_nop 0
  buffer_load_dwordx4 v4, s[12:15], s21 offen lds
  s_add_u32 s21, s21, 61440
  s_add_u32 m0, s22, 57344
  s_nop 0
  buffer_load_dwordx4 v4, s[12:15], s21 offen lds
  s_add_u32 s21, s21, 61440
  s_add_u32 m0, s22, 61440
  s_nop 0
  buffer_load_dwordx4 v4, s[12:15], s21 offen lds
  s_add_u32 s21, s21, 61440
  s_add_u32 m0, s22, 65536
  s_nop 0
  buffer_load_dwordx4 v4, s[12:15], s21 offen lds
  s_add_u32 s21, s21, 61440
  s_add_u32 m0, s22, 69632
  s_nop 0
  buffer_load_dwordx4 v4, s[12:15], s21 offen lds
  s_add_u32 s21, s21, 61440
  s_add_u32 m0, s22, 73728
  s_nop 0
  buffer_load_dwordx4 v4, s[12:15], s21 offen lds
  s_add_u32 s21, s21, 61440
  s_add_u32 m0, s22, 77824
  s_nop 0
  buffer_load_dwordx4 v4, s[12:15], s21 offen lds
  s_add_u32 s21, s21, 61440
  s_add_u32 m0, s22, 81920
  s_nop 0
  buffer_load_dwordx4 v4, s[12:15], s21 offen lds
  s_add_u32 s21, s21, 61440
  s_add_u32 m0, s22, 86016
  s_nop 0
  buffer_load_dwordx4 v4, s[12:15], s21 offen lds
  s_add_u32 s21, s21, 61440
  s_add_u32 m0, s22, 90112
  s_nop 0
  buffer_load_dwordx4 v4, s[12:15], s21 offen lds
  s_add_u32 s21, s21, 61440
  s_add_u32 m0, s22, 94208
  s_nop 0
  buffer_load_dwordx4 v4, s[12:15], s21 offen lds
  s_add_u32 s21, s21, 61440
  s_add_u32 m0, s22, 98304
  s_nop 0
  buffer_load_dwordx4 v4, s[12:15], s21 offen lds
  s_add_u32 s21, s21, 61440
  s_add_u32 m0, s22, 102400
  s_nop 0
  buffer_load_dwordx4 v4, s[12:15], s21 offen lds
  s_add_u32 s21, s21, 61440
  s_add_u32 m0, s22, 106496
  s_nop 0
  buffer_load_dwordx4 v4, s[12:15], s21 offen lds
  s_add_u32 s21, s21, 61440
  s_add_u32 m0, s22, 110592
  s_nop 0
  buffer_load_dwordx4 v4, s[12:15], s21 offen lds
  s_add_u32 s21, s21, 61440
  s_add_u32 m0, s22, 114688
  s_nop 0
  buffer_load_dwordx4 v4, s[12:15], s21 offen lds
  s_add_u32 s21, s21, 61440
  s_add_u32 m0, s22, 118784
  s_nop 0
  buffer_load_dwordx4 v4, s[12:15], s21 offen lds
  s_add_u32 s21, s21, 61440
  s_add_u32 m0, s22, 122880
  s_nop 0
  buffer_load_dwordx4 v4, s[12:15], s21 offen lds
  s_add_u32 s21, s21, 61440
  s_add_u32 m0, s22, 126976
  s_nop 0
  buffer_load_dwordx4 v4, s[12:15], s21 offen lds
  s_add_u32 s21, s21, 61440
  s_add_u32 m0, s22, 131072
  s_nop 0
  buffer_load_dwordx4 v4, s[12:15], s21 offen lds
  s_add_u32 s21, s21, 61440
  s_add_u32 m0, s22, 135168
  s_nop 0
  buffer_load_dwordx4 v4, s[12:15], s21 offen lds
  s_add_u32 s21, s21, 61440
  s_add_u32 m0, s22, 139264
  s_nop 0
  buffer_load_dwordx4 v4, s[12:15], s21 offen lds
  s_add_u32 s21, s21, 61440
  s_add_u32 m0, s22, 143360
  s_nop 0
  buffer_load_dwordx4 v4, s[12:15], s21 offen lds
  s_add_u32 s21, s21, 61440
  s_add_u32 m0, s22, 147456
  s_nop 0
  buffer_load_dwordx4 v4, s[12:15], s21 offen lds
  s_add_u32 s21, s21, 61440
  s_add_u32 m0, s22, 151552
  s_nop 0
  buffer_load_dwordx4 v4, s[12:15], s21 offen lds
  s_add_u32 s21, s21, 61440
  s_add_u32 m0, s22, 155648
  s_nop 0
  buffer_load_dwordx4 v4, s[12:15], s21 offen lds
  s_add_u32 s21, s21, 61440
  s_add_u32 m0, s22, 159744
  s_nop 0
  buffer_load_dwordx4 v4, s[12:15], s21 offen lds
  s_add_u32 s21, s21, 61440
  s_lshl_b32 s21, s2, 2
  s_add_u32 s21, s21, s20
  s_mul_i32 s21, s21, 20480
  v_lshlrev_b32 v5, 4, v1
  buffer_load_dwordx4 v[64:67], v5, s[8:11], s21 offen offset:0
  buffer_load_dwordx4 v[64:67], v5, s[8:11], s21 offen offset:1024
  buffer_load_dwordx4 v[64:67], v5, s[8:11], s21 offen offset:2048
  buffer_load_dwordx4 v[64:67], v5, s[8:11], s21 offen offset:3072
  s_add_u32 s21, s21, 4096
  buffer_load_dwordx4 v[64:67], v5, s[8:11], s21 offen offset:0
  buffer_load_dwordx4 v[64:67], v5, s[8:11], s21 offen offset:1024
  buffer_load_dwordx4 v[64:67], v5, s[8:11], s21 offen offset:2048
  buffer_load_dwordx4 v[64:67], v5, s[8:11], s21 offen offset:3072
  s_add_u32 s21, s21, 4096
  buffer_load_dwordx4 v[64:67], v5, s[8:11], s21 offen offset:0
  buffer_load_dwordx4 v[64:67], v5, s[8:11], s21 offen offset:1024
  buffer_load_dwordx4 v[64:67], v5, s[8:11], s21 offen offset:2048
  buffer_load_dwordx4 v[64:67], v5, s[8:11], s21 offen offset:3072
  s_add_u32 s21, s21, 4096
  buffer_load_dwordx4 v[64:67], v5, s[8:11], s21 offen offset:0
  buffer_load_dwordx4 v[64:67], v5, s[8:11], s21 offen offset:1024
  buffer_load_dwordx4 v[64:67], v5, s[8:11], s21 offen offset:2048
  buffer_load_dwordx4 v[64:67], v5, s[8:11], s21 offen offset:3072
  s_add_u32 s21, s21, 4096
  buffer_load_dwordx4 v[64:67], v5, s[8:11], s21 offen offset:0
  buffer_load_dwordx4 v[64:67], v5, s[8:11], s21 offen offset:1024
  buffer_load_dwordx4 v[64:67], v5, s[8:11], s21 offen offset:2048
  buffer_load_dwordx4 v[64:67], v5, s[8:11], s21 offen offset:3072
  v_lshrrev_b32 v6, 2, v2
  v_lshl_add_u32 v7, v3, 3, v6
  v_and_b32 v8, 1, v3
  v_lshl_add_u32 v6, v8, 2, v6
  v_lshlrev_b32 v6, 1, v6
  v_bfe_u32 v8, v2, 1, 1
  s_lshl_b32 s21, s20, 2
  v_add_u32 v8, s21, v8
  v_and_b32 v9, 1, v2
  v_lshlrev_b32 v9, 3, v9
  v_lshl_add_u32 v9, v7, 8, v9
  v_add_u32 v5, 0, v8
  v_xor_b32 v5, v5, v6
  v_lshl_add_u32 v10, v5, 4, v9
  v_add_u32 v11, 65536, v10
  v_add_u32 v12, 131072, v10
  v_add_u32 v5, 2, v8
  v_xor_b32 v5, v5, v6
  v_lshl_add_u32 v13, v5, 4, v9
  v_add_u32 v14, 65536, v13
  v_add_u32 v15, 131072, v13
  s_waitcnt vmcnt(50)
  s_barrier
  ds_read_b64_tr_b16 a[0:1], v10 offset:0
  ds_read_b64_tr_b16 a[2:3], v10 offset:1024
  ds_read_b64_tr_b16 a[4:5], v13 offset:0
  ds_read_b64_tr_b16 a[6:7], v13 offset:1024
  ds_read_b64_tr_b16 a[8:9], v10 offset:8192
  ds_read_b64_tr_b16 a[10:11], v10 offset:9216
  ds_read_b64_tr_b16 a[12:13], v13 offset:8192
  ds_read_b64_tr_b16 a[14:15], v13 offset:9216
  ds_read_b64_tr_b16 a[16:17], v10 offset:16384
  ds_read_b64_tr_b16 a[18:19], v10 offset:17408
  ds_read_b64_tr_b16 a[20:21], v13 offset:16384
  ds_read_b64_tr_b16 a[22:23], v13 offset:17408
  ds_read_b64_tr_b16 a[24:25], v10 offset:24576
  ds_read_b64_tr_b16 a[26:27], v10 offset:25600
  ds_read_b64_tr_b16 a[28:29], v13 offset:24576
  ds_read_b64_tr_b16 a[30:31], v13 offset:25600
  ds_read_b64_tr_b16 a[32:33], v10 offset:32768
  ds_read_b64_tr_b16 a[34:35], v10 offset:33792
  ds_read_b64_tr_b16 a[36:37], v13 offset:32768
  ds_read_b64_tr_b16 a[38:39], v13 offset:33792
  s_waitcnt vmcnt(40)
  s_barrier
  ds_read_b64_tr_b16 a[40:41], v10 offset:40960
  ds_read_b64_tr_b16 a[42:43], v10 offset:41984
  ds_read_b64_tr_b16 a[44:45], v13 offset:40960
  ds_read_b64_tr_b16 a[46:47], v13 offset:41984
  ds_read_b64_tr_b16 a[48:49], v10 offset:49152
  ds_read_b64_tr_b16 a[50:51], v10 offset:50176
  ds_read_b64_tr_b16 a[52:53], v13 offset:49152
  ds_read_b64_tr_b16 a[54:55], v13 offset:50176
  ds_read_b64_tr_b16 a[56:57], v10 offset:57344
  ds_read_b64_tr_b16 a[58:59], v10 offset:58368
  ds_read_b64_tr_b16 a[60:61], v13 offset:57344
  ds_read_b64_tr_b16 a[62:63], v13 offset:58368
  ds_read_b64_tr_b16 a[64:65], v11 offset:0
  ds_read_b64_tr_b16 a[66:67], v11 offset:1024
  ds_read_b64_tr_b16 a[68:69], v14 offset:0
  ds_read_b64_tr_b16 a[70:71], v14 offset:1024
  ds_read_b64_tr_b16 a[72:73], v11 offset:8192
  ds_read_b64_tr_b16 a[74:75], v11 offset:9216
  ds_read_b64_tr_b16 a[76:77], v14 offset:8192
  ds_read_b64_tr_b16 a[78:79], v14 offset:9216
  s_waitcnt vmcnt(30)
  s_barrier
  ds_read_b64_tr_b16 a[80:81], v11 offset:16384
  ds_read_b64_tr_b16 a[82:83], v11 offset:17408
  ds_read_b64_tr_b16 a[84:85], v14 offset:16384
  ds_read_b64_tr_b16 a[86:87], v14 offset:17408
  ds_read_b64_tr_b16 a[88:89], v11 offset:24576
  ds_read_b64_tr_b16 a[90:91], v11 offset:25600
  ds_read_b64_tr_b16 a[92:93], v14 offset:24576
  ds_read_b64_tr_b16 a[94:95], v14 offset:25600
  ds_read_b64_tr_b16 a[96:97], v11 offset:32768
  ds_read_b64_tr_b16 a[98:99], v11 offset:33792
  ds_read_b64_tr_b16 a[100:101], v14 offset:32768
  ds_read_b64_tr_b16 a[102:103], v14 offset:33792
  ds_read_b64_tr_b16 a[104:105], v11 offset:40960
  ds_read_b64_tr_b16 a[106:107], v11 offset:41984
  ds_read_b64_tr_b16 a[108:109], v14 offset:40960
  ds_read_b64_tr_b16 a[110:111], v14 offset:41984
  ds_read_b64_tr_b16 a[112:113], v11 offset:49152
  ds_read_b64_tr_b16 a[114:115], v11 offset:50176
  ds_read_b64_tr_b16 a[116:117], v14 offset:49152
  ds_read_b64_tr_b16 a[118:119], v14 offset:50176
  s_waitcnt vmcnt(20)
  s_barrier
  ds_read_b64_tr_b16 a[120:121], v11 offset:57344
  ds_read_b64_tr_b16 a[122:123], v11 offset:58368
  ds_read_b64_tr_b16 a[124:125], v14 offset:57344
  ds_read_b64_tr_b16 a[126:127], v14 offset:58368
  ds_read_b64_tr_b16 a[128:129], v12 offset:0
  ds_read_b64_tr_b16 a[130:131], v12 offset:1024
  ds_read_b64_tr_b16 a[132:133], v15 offset:0
  ds_read_b64_tr_b16 a[134:135], v15 offset:1024
  ds_read_b64_tr_b16 a[136:137], v12 offset:8192
  ds_read_b64_tr_b16 a[138:139], v12 offset:9216
  ds_read_b64_tr_b16 a[140:141], v15 offset:8192
  ds_read_b64_tr_b16 a[142:143], v15 offset:9216
  ds_read_b64_tr_b16 a[144:145], v12 offset:16384
  ds_read_b64_tr_b16 a[146:147], v12 offset:17408
  ds_read_b64_tr_b16 a[148:149], v15 offset:16384
  ds_read_b64_tr_b16 a[150:151], v15 offset:17408
  ds_read_b64_tr_b16 a[152:153], v12 offset:24576
  ds_read_b64_tr_b16 a[154:155], v12 offset:25600
  ds_read_b64_tr_b16 a[156:157], v15 offset:24576
  ds_read_b64_tr_b16 a[158:159], v15 offset:25600
  s_waitcnt lgkmcnt(0)
  s_barrier
  v_and_b32 v4, 31, v1
  s_lshl_b32 s21, s20, 5
  v_add_u32 v36, s21, v4
  v_lshrrev_b32 v5, 5, v1
  v_mul_u32_u24 v6, 264, v36
  v_mul_u32_u24 v7, 40, v5
  s_mov_b32 s21, 114952
  v_add3_u32 v34, v6, v7, s21
  v_lshl_add_u32 v38, v5, 3, v34
  v_lshlrev_b32 v6, 5, v5
  v_sub_u32 v39, v34, v6
  v_lshlrev_b32 v35, 3, v1
  v_add_u32 v35, 114688, v35
  v_mov_b32 v37, 0xf149f2ca
  s_mul_i32 s21, s41, 165120
  s_mul_i32 s22, s42, 16512
  s_add_u32 s21, s21, s22
  v_lshl_add_u32 v7, v36, 4, s21
  v_mul_u32_u24 v6, 99072, v5
  v_add_u32 v29, v6, v7
  v_add_u32 v30, 33024, v29
  v_lshl_add_u32 v31, v5, 3, v7
  v_add_u32 v31, 66048, v31
  v_mov_b32 v8, 0
  v_mov_b32 v9, 0
  ds_write_b64 v35, v[8:9] offset:0
  ds_write_b64 v35, v[8:9] offset:512
  ds_write_b64 v35, v[8:9] offset:1024
  ds_write_b64 v35, v[8:9] offset:1536
  ds_write_b64 v35, v[8:9] offset:2048
  s_mul_i32 s24, s42, 1280
  s_mov_b32 s25, 327680
  s_mov_b32 s26, 8
  s_mov_b32 s27, 0
  s_mov_b32 s60, 0x3e64f92e
  s_mov_b32 s61, 0x3fb8aa3b
  s_mov_b32 s62, 0x05040100
  s_mov_b32 s63, 0x07060302
  v_cmp_le_u32 s[76:77], 0, v36
  v_cmp_le_u32 s[78:79], 1, v36
  v_cmp_le_u32 s[80:81], 2, v36
  v_cmp_le_u32 s[82:83], 3, v36
  v_cmp_le_u32 s[84:85], 4, v36
  v_cmp_le_u32 s[86:87], 5, v36
  v_cmp_le_u32 s[88:89], 6, v36
  v_cmp_le_u32 s[90:91], 7, v36
  v_lshrrev_b32 v11, 3, v1
  v_and_b32 v12, 7, v1
  v_xor_b32 v12, v12, v11
  v_mul_u32_u24 v11, 2560, v11
  v_lshl_add_u32 v10, v12, 4, v11
  s_mul_i32 s46, s20, 81920
  v_add_u32 v10, s46, v10
  s_lshl_b32 s47, s20, 12
  s_add_u32 s47, s47, 0
  s_add_u32 s46, s47, 114688
  s_mov_b32 s30, s24
  s_add_u32 s32, s47, 0
  v_add_u32 v11, 19456, v10
  v_add_u32 v12, 38912, v10
  v_add_u32 v13, 58368, v10
  s_mov_b32 m0, s32
  s_nop 0
  buffer_load_dwordx4 v10, s[8:11], s30 offen offset:0 lds
  buffer_load_dwordx4 v11, s[8:11], s30 offen offset:1024 lds
  buffer_load_dwordx4 v12, s[8:11], s30 offen offset:2048 lds
  buffer_load_dwordx4 v13, s[8:11], s30 offen offset:3072 lds
  s_add_u32 s30, s30, 128
  s_add_u32 s32, s32, 16384
  s_cmp_lt_u32 s32, s46
  s_cselect_b32 s32, s32, s47
  s_mov_b32 m0, s32
  s_nop 0
  buffer_load_dwordx4 v10, s[8:11], s30 offen offset:0 lds
  buffer_load_dwordx4 v11, s[8:11], s30 offen offset:1024 lds
  buffer_load_dwordx4 v12, s[8:11], s30 offen offset:2048 lds
  buffer_load_dwordx4 v13, s[8:11], s30 offen offset:3072 lds
  s_add_u32 s30, s30, 128
  s_add_u32 s32, s32, 16384
  s_cmp_lt_u32 s32, s46
  s_cselect_b32 s32, s32, s47
  s_mov_b32 m0, s32
  s_nop 0
  buffer_load_dwordx4 v10, s[8:11], s30 offen offset:0 lds
  buffer_load_dwordx4 v11, s[8:11], s30 offen offset:1024 lds
  buffer_load_dwordx4 v12, s[8:11], s30 offen offset:2048 lds
  buffer_load_dwordx4 v13, s[8:11], s30 offen offset:3072 lds
  s_add_u32 s30, s30, 128
  s_add_u32 s32, s32, 16384
  s_cmp_lt_u32 s32, s46
  s_cselect_b32 s32, s32, s47
  s_mov_b32 m0, s32
  s_nop 0
  buffer_load_dwordx4 v10, s[8:11], s30 offen offset:0 lds
  buffer_load_dwordx4 v11, s[8:11], s30 offen offset:1024 lds
  buffer_load_dwordx4 v12, s[8:11], s30 offen offset:2048 lds
  buffer_load_dwordx4 v13, s[8:11], s30 offen offset:3072 lds
  s_add_u32 s30, s30, 128
  s_add_u32 s32, s32, 16384
  s_cmp_lt_u32 s32, s46
  s_cselect_b32 s32, s32, s47
  s_mov_b32 m0, s32
  s_nop 0
  buffer_load_dwordx4 v10, s[8:11], s30 offen offset:0 lds
  buffer_load_dwordx4 v11, s[8:11], s30 offen offset:1024 lds
  buffer_load_dwordx4 v12, s[8:11], s30 offen offset:2048 lds
  buffer_load_dwordx4 v13, s[8:11], s30 offen offset:3072 lds
  s_add_u32 s30, s30, 128
  s_add_u32 s32, s32, 16384
  s_cmp_lt_u32 s32, s46
  s_cselect_b32 s32, s32, s47
  v_and_b32 v6, 7, v2
  v_add_u32 v4, 0, v3
  v_xor_b32 v4, v4, v6
  v_lshlrev_b32 v4, 4, v4
  v_lshl_add_u32 v14, v2, 7, v4
  v_add_u32 v4, 4, v3
  v_xor_b32 v4, v4, v6
  v_lshlrev_b32 v4, 4, v4
  v_lshl_add_u32 v15, v2, 7, v4
  v_mul_u32_u24 v22, 264, v2
  v_mul_u32_u24 v4, 8, v3
  s_mul_i32 s21, s20, 64
  s_add_u32 s21, s21, 116800
  v_add3_u32 v22, v22, v4, s21
  v_lshlrev_b32 v4, 3, v3
  v_sub_u32 v16, v22, v4
  v_mov_b32 v9, 2731
  s_mov_b32 s33, 0
  s_mov_b32 s48, 0x80000000
  s_mov_b32 m0, s32
  s_nop 0
  buffer_load_dwordx4 v10, s[8:11], s30 offen offset:0 lds
  buffer_load_dwordx4 v11, s[8:11], s30 offen offset:1024 lds
  s_waitcnt vmcnt(18)
  s_barrier
  v_add_u32 v18, s33, v14
  v_add_u32 v19, s33, v15
  s_add_u32 s33, s33, 16384
  s_cmp_lt_u32 s33, 114688
  s_cselect_b32 s33, s33, 0
  ds_read_b128 v[160:163], v18 offset:0
  ds_read_b128 v[164:167], v18 offset:2048
  ds_read_b128 v[168:171], v18 offset:4096
  ds_read_b128 v[172:175], v18 offset:6144
  ds_read_b128 v[176:179], v18 offset:8192
  ds_read_b128 v[180:183], v18 offset:10240
  ds_read_b128 v[184:187], v18 offset:12288
  ds_read_b128 v[188:191], v18 offset:14336
  s_waitcnt lgkmcnt(0)
bf_blk_199:
  v_mfma_f32_16x16x32_bf16 v[64:67], a[0:3], v[160:163], 0
  ds_read_b128 v[192:195], v19 offset:0
  v_mfma_f32_16x16x32_bf16 v[68:71], a[4:7], v[160:163], 0
  v_add_u32 v18, s33, v14
  v_mfma_f32_16x16x32_bf16 v[72:75], a[0:3], v[164:167], 0
  ds_read_b128 v[196:199], v19 offset:2048
  v_mfma_f32_16x16x32_bf16 v[76:79], a[4:7], v[164:167], 0
  buffer_load_dwordx4 v12, s[8:11], s30 offen offset:2048 lds
  v_mfma_f32_16x16x32_bf16 v[80:83], a[0:3], v[168:171], 0
  ds_read_b128 v[200:203], v19 offset:4096
  v_mfma_f32_16x16x32_bf16 v[84:87], a[4:7], v[168:171], 0
  v_mfma_f32_16x16x32_bf16 v[88:91], a[0:3], v[172:175], 0
  ds_read_b128 v[204:207], v19 offset:6144
  v_mfma_f32_16x16x32_bf16 v[92:95], a[4:7], v[172:175], 0
  s_waitcnt lgkmcnt(14)
  v_mfma_f32_16x16x32_bf16 v[96:99], a[0:3], v[176:179], 0
  ds_read_b128 v[208:211], v19 offset:8192
  v_mfma_f32_16x16x32_bf16 v[100:103], a[4:7], v[176:179], 0
  v_mfma_f32_16x16x32_bf16 v[104:107], a[0:3], v[180:183], 0
  ds_read_b128 v[212:215], v19 offset:10240
  v_mfma_f32_16x16x32_bf16 v[108:111], a[4:7], v[180:183], 0
  buffer_load_dwordx4 v13, s[8:11], s30 offen offset:3072 lds
  v_mfma_f32_16x16x32_bf16 v[112:115], a[0:3], v[184:187], 0
  ds_read_b128 v[216:219], v19 offset:12288
  s_add_u32 s30, s30, 128
  v_mfma_f32_16x16x32_bf16 v[116:119], a[4:7], v[184:187], 0
  s_add_u32 m0, m0, 16384
  v_mfma_f32_16x16x32_bf16 v[120:123], a[0:3], v[188:191], 0
  ds_read_b128 v[220:223], v19 offset:14336
  v_mfma_f32_16x16x32_bf16 v[124:127], a[4:7], v[188:191], 0
  s_waitcnt vmcnt(16) lgkmcnt(4)
  s_barrier
  v_mfma_f32_16x16x32_bf16 v[64:67], a[8:11], v[192:195], v[64:67]
  ds_read_b128 v[160:163], v18 offset:0
  v_mfma_f32_16x16x32_bf16 v[68:71], a[12:15], v[192:195], v[68:71]
  s_cmp_lt_u32 m0, s46
  s_cselect_b32 m0, m0, s47
  v_mfma_f32_16x16x32_bf16 v[72:75], a[8:11], v[196:199], v[72:75]
  ds_read_b128 v[164:167], v18 offset:2048
  v_add_u32 v19, s33, v15
  v_mfma_f32_16x16x32_bf16 v[76:79], a[12:15], v[196:199], v[76:79]
  buffer_load_dwordx4 v10, s[8:11], s30 offen offset:0 lds
  v_mfma_f32_16x16x32_bf16 v[80:83], a[8:11], v[200:203], v[80:83]
  ds_read_b128 v[168:171], v18 offset:4096
  s_add_u32 s33, s33, 16384
  v_mfma_f32_16x16x32_bf16 v[84:87], a[12:15], v[200:203], v[84:87]
  s_cmp_lt_u32 s33, 114688
  s_cselect_b32 s33, s33, 0
  v_mfma_f32_16x16x32_bf16 v[88:91], a[8:11], v[204:207], v[88:91]
  ds_read_b128 v[172:175], v18 offset:6144
  v_mfma_f32_16x16x32_bf16 v[92:95], a[12:15], v[204:207], v[92:95]
  s_waitcnt lgkmcnt(4)
  v_mfma_f32_16x16x32_bf16 v[96:99], a[8:11], v[208:211], v[96:99]
  ds_read_b128 v[176:179], v18 offset:8192
  v_mfma_f32_16x16x32_bf16 v[100:103], a[12:15], v[208:211], v[100:103]
  v_mfma_f32_16x16x32_bf16 v[104:107], a[8:11], v[212:215], v[104:107]
  ds_read_b128 v[180:183], v18 offset:10240
  v_mfma_f32_16x16x32_bf16 v[108:111], a[12:15], v[212:215], v[108:111]
  buffer_load_dwordx4 v11, s[8:11], s30 offen offset:1024 lds
  v_mfma_f32_16x16x32_bf16 v[112:115], a[8:11], v[216:219], v[112:115]
  ds_read_b128 v[184:187], v18 offset:12288
  v_mfma_f32_16x16x32_bf16 v[116:119], a[12:15], v[216:219], v[116:119]
  v_mfma_f32_16x16x32_bf16 v[120:123], a[8:11], v[220:223], v[120:123]
  ds_read_b128 v[188:191], v18 offset:14336
  v_mfma_f32_16x16x32_bf16 v[124:127], a[12:15], v[220:223], v[124:127]
  s_waitcnt lgkmcnt(4)
  v_mfma_f32_16x16x32_bf16 v[64:67], a[16:19], v[160:163], v[64:67]
  ds_read_b128 v[192:195], v19 offset:0
  v_mfma_f32_16x16x32_bf16 v[68:71], a[20:23], v[160:163], v[68:71]
  v_add_u32 v18, s33, v14
  v_mfma_f32_16x16x32_bf16 v[72:75], a[16:19], v[164:167], v[72:75]
  ds_read_b128 v[196:199], v19 offset:2048
  v_mfma_f32_16x16x32_bf16 v[76:79], a[20:23], v[164:167], v[76:79]
  buffer_load_dwordx4 v12, s[8:11], s30 offen offset:2048 lds
  v_mfma_f32_16x16x32_bf16 v[80:83], a[16:19], v[168:171], v[80:83]
  ds_read_b128 v[200:203], v19 offset:4096
  v_mfma_f32_16x16x32_bf16 v[84:87], a[20:23], v[168:171], v[84:87]
  v_mfma_f32_16x16x32_bf16 v[88:91], a[16:19], v[172:175], v[88:91]
  ds_read_b128 v[204:207], v19 offset:6144
  v_mfma_f32_16x16x32_bf16 v[92:95], a[20:23], v[172:175], v[92:95]
  s_waitcnt lgkmcnt(4)
  v_mfma_f32_16x16x32_bf16 v[96:99], a[16:19], v[176:179], v[96:99]
  ds_read_b128 v[208:211], v19 offset:8192
  v_mfma_f32_16x16x32_bf16 v[100:103], a[20:23], v[176:179], v[100:103]
  v_mfma_f32_16x16x32_bf16 v[104:107], a[16:19], v[180:183], v[104:107]
  ds_read_b128 v[212:215], v19 offset:10240
  v_mfma_f32_16x16x32_bf16 v[108:111], a[20:23], v[180:183], v[108:111]
  buffer_load_dwordx4 v13, s[8:11], s30 offen offset:3072 lds
  v_mfma_f32_16x16x32_bf16 v[112:115], a[16:19], v[184:187], v[112:115]
  ds_read_b128 v[216:219], v19 offset:12288
  s_add_u32 s30, s30, 128
  v_mfma_f32_16x16x32_bf16 v[116:119], a[20:23], v[184:187], v[116:119]
  s_add_u32 m0, m0, 16384
  v_mfma_f32_16x16x32_bf16 v[120:123], a[16:19], v[188:191], v[120:123]
  ds_read_b128 v[220:223], v19 offset:14336
  v_mfma_f32_16x16x32_bf16 v[124:127], a[20:23], v[188:191], v[124:127]
  s_waitcnt vmcnt(16) lgkmcnt(4)
  s_barrier
  v_mfma_f32_16x16x32_bf16 v[64:67], a[24:27], v[192:195], v[64:67]
  ds_read_b128 v[160:163], v18 offset:0
  v_mfma_f32_16x16x32_bf16 v[68:71], a[28:31], v[192:195], v[68:71]
  s_cmp_lt_u32 m0, s46
  s_cselect_b32 m0, m0, s47
  v_mfma_f32_16x16x32_bf16 v[72:75], a[24:27], v[196:199], v[72:75]
  ds_read_b128 v[164:167], v18 offset:2048
  v_add_u32 v19, s33, v15
  v_mfma_f32_16x16x32_bf16 v[76:79], a[28:31], v[196:199], v[76:79]
  buffer_load_dwordx4 v10, s[8:11], s30 offen offset:0 lds
  v_mfma_f32_16x16x32_bf16 v[80:83], a[24:27], v[200:203], v[80:83]
  ds_read_b128 v[168:171], v18 offset:4096
  s_add_u32 s33, s33, 16384
  v_mfma_f32_16x16x32_bf16 v[84:87], a[28:31], v[200:203], v[84:87]
  s_cmp_lt_u32 s33, 114688
  s_cselect_b32 s33, s33, 0
  v_mfma_f32_16x16x32_bf16 v[88:91], a[24:27], v[204:207], v[88:91]
  ds_read_b128 v[172:175], v18 offset:6144
  v_mfma_f32_16x16x32_bf16 v[92:95], a[28:31], v[204:207], v[92:95]
  s_waitcnt lgkmcnt(4)
  v_mfma_f32_16x16x32_bf16 v[96:99], a[24:27], v[208:211], v[96:99]
  ds_read_b128 v[176:179], v18 offset:8192
  v_mfma_f32_16x16x32_bf16 v[100:103], a[28:31], v[208:211], v[100:103]
  v_mfma_f32_16x16x32_bf16 v[104:107], a[24:27], v[212:215], v[104:107]
  ds_read_b128 v[180:183], v18 offset:10240
  v_mfma_f32_16x16x32_bf16 v[108:111], a[28:31], v[212:215], v[108:111]
  buffer_load_dwordx4 v11, s[8:11], s30 offen offset:1024 lds
  v_mfma_f32_16x16x32_bf16 v[112:115], a[24:27], v[216:219], v[112:115]
  ds_read_b128 v[184:187], v18 offset:12288
  v_mfma_f32_16x16x32_bf16 v[116:119], a[28:31], v[216:219], v[116:119]
  v_mfma_f32_16x16x32_bf16 v[120:123], a[24:27], v[220:223], v[120:123]
  ds_read_b128 v[188:191], v18 offset:14336
  v_mfma_f32_16x16x32_bf16 v[124:127], a[28:31], v[220:223], v[124:127]
  s_waitcnt lgkmcnt(4)
  v_mfma_f32_16x16x32_bf16 v[64:67], a[32:35], v[160:163], v[64:67]
  ds_read_b128 v[192:195], v19 offset:0
  v_mfma_f32_16x16x32_bf16 v[68:71], a[36:39], v[160:163], v[68:71]
  v_add_u32 v18, s33, v14
  v_mfma_f32_16x16x32_bf16 v[72:75], a[32:35], v[164:167], v[72:75]
  ds_read_b128 v[196:199], v19 offset:2048
  v_mfma_f32_16x16x32_bf16 v[76:79], a[36:39], v[164:167], v[76:79]
  buffer_load_dwordx4 v12, s[8:11], s30 offen offset:2048 lds
  v_mfma_f32_16x16x32_bf16 v[80:83], a[32:35], v[168:171], v[80:83]
  ds_read_b128 v[200:203], v19 offset:4096
  v_mfma_f32_16x16x32_bf16 v[84:87], a[36:39], v[168:171], v[84:87]
  v_mfma_f32_16x16x32_bf16 v[88:91], a[32:35], v[172:175], v[88:91]
  ds_read_b128 v[204:207], v19 offset:6144
  v_mfma_f32_16x16x32_bf16 v[92:95], a[36:39], v[172:175], v[92:95]
  s_waitcnt lgkmcnt(4)
  v_mfma_f32_16x16x32_bf16 v[96:99], a[32:35], v[176:179], v[96:99]
  ds_read_b128 v[208:211], v19 offset:8192
  v_mfma_f32_16x16x32_bf16 v[100:103], a[36:39], v[176:179], v[100:103]
  v_mfma_f32_16x16x32_bf16 v[104:107], a[32:35], v[180:183], v[104:107]
  ds_read_b128 v[212:215], v19 offset:10240
  v_mfma_f32_16x16x32_bf16 v[108:111], a[36:39], v[180:183], v[108:111]
  buffer_load_dwordx4 v13, s[8:11], s30 offen offset:3072 lds
  v_mfma_f32_16x16x32_bf16 v[112:115], a[32:35], v[184:187], v[112:115]
  ds_read_b128 v[216:219], v19 offset:12288
  s_add_u32 s30, s30, 128
  v_mfma_f32_16x16x32_bf16 v[116:119], a[36:39], v[184:187], v[116:119]
  s_add_u32 m0, m0, 16384
  v_mfma_f32_16x16x32_bf16 v[120:123], a[32:35], v[188:191], v[120:123]
  ds_read_b128 v[220:223], v19 offset:14336
  v_mfma_f32_16x16x32_bf16 v[124:127], a[36:39], v[188:191], v[124:127]
  s_waitcnt vmcnt(16) lgkmcnt(4)
  s_barrier
  v_mfma_f32_16x16x32_bf16 v[64:67], a[40:43], v[192:195], v[64:67]
  ds_read_b128 v[160:163], v18 offset:0
  v_mfma_f32_16x16x32_bf16 v[68:71], a[44:47], v[192:195], v[68:71]
  s_cmp_lt_u32 m0, s46
  s_cselect_b32 m0, m0, s47
  v_mfma_f32_16x16x32_bf16 v[72:75], a[40:43], v[196:199], v[72:75]
  ds_read_b128 v[164:167], v18 offset:2048
  v_add_u32 v19, s33, v15
  v_mfma_f32_16x16x32_bf16 v[76:79], a[44:47], v[196:199], v[76:79]
  buffer_load_dwordx4 v10, s[8:11], s30 offen offset:0 lds
  v_mfma_f32_16x16x32_bf16 v[80:83], a[40:43], v[200:203], v[80:83]
  ds_read_b128 v[168:171], v18 offset:4096
  s_add_u32 s33, s33, 16384
  v_mfma_f32_16x16x32_bf16 v[84:87], a[44:47], v[200:203], v[84:87]
  s_cmp_lt_u32 s33, 114688
  s_cselect_b32 s33, s33, 0
  v_mfma_f32_16x16x32_bf16 v[88:91], a[40:43], v[204:207], v[88:91]
  ds_read_b128 v[172:175], v18 offset:6144
  v_mfma_f32_16x16x32_bf16 v[92:95], a[44:47], v[204:207], v[92:95]
  s_waitcnt lgkmcnt(4)
  v_mfma_f32_16x16x32_bf16 v[96:99], a[40:43], v[208:211], v[96:99]
  ds_read_b128 v[176:179], v18 offset:8192
  v_mfma_f32_16x16x32_bf16 v[100:103], a[44:47], v[208:211], v[100:103]
  v_mfma_f32_16x16x32_bf16 v[104:107], a[40:43], v[212:215], v[104:107]
  ds_read_b128 v[180:183], v18 offset:10240
  v_mfma_f32_16x16x32_bf16 v[108:111], a[44:47], v[212:215], v[108:111]
  buffer_load_dwordx4 v11, s[8:11], s30 offen offset:1024 lds
  v_mfma_f32_16x16x32_bf16 v[112:115], a[40:43], v[216:219], v[112:115]
  ds_read_b128 v[184:187], v18 offset:12288
  v_mfma_f32_16x16x32_bf16 v[116:119], a[44:47], v[216:219], v[116:119]
  v_mfma_f32_16x16x32_bf16 v[120:123], a[40:43], v[220:223], v[120:123]
  ds_read_b128 v[188:191], v18 offset:14336
  v_mfma_f32_16x16x32_bf16 v[124:127], a[44:47], v[220:223], v[124:127]
  s_waitcnt lgkmcnt(4)
  v_mfma_f32_16x16x32_bf16 v[64:67], a[48:51], v[160:163], v[64:67]
  ds_read_b128 v[192:195], v19 offset:0
  v_mfma_f32_16x16x32_bf16 v[68:71], a[52:55], v[160:163], v[68:71]
  v_add_u32 v18, s33, v14
  v_mfma_f32_16x16x32_bf16 v[72:75], a[48:51], v[164:167], v[72:75]
  ds_read_b128 v[196:199], v19 offset:2048
  v_mfma_f32_16x16x32_bf16 v[76:79], a[52:55], v[164:167], v[76:79]
  buffer_load_dwordx4 v12, s[8:11], s30 offen offset:2048 lds
  v_mfma_f32_16x16x32_bf16 v[80:83], a[48:51], v[168:171], v[80:83]
  ds_read_b128 v[200:203], v19 offset:4096
  v_mfma_f32_16x16x32_bf16 v[84:87], a[52:55], v[168:171], v[84:87]
  v_mfma_f32_16x16x32_bf16 v[88:91], a[48:51], v[172:175], v[88:91]
  ds_read_b128 v[204:207], v19 offset:6144
  v_mfma_f32_16x16x32_bf16 v[92:95], a[52:55], v[172:175], v[92:95]
  s_waitcnt lgkmcnt(4)
  v_mfma_f32_16x16x32_bf16 v[96:99], a[48:51], v[176:179], v[96:99]
  ds_read_b128 v[208:211], v19 offset:8192
  v_mfma_f32_16x16x32_bf16 v[100:103], a[52:55], v[176:179], v[100:103]
  v_mfma_f32_16x16x32_bf16 v[104:107], a[48:51], v[180:183], v[104:107]
  ds_read_b128 v[212:215], v19 offset:10240
  v_mfma_f32_16x16x32_bf16 v[108:111], a[52:55], v[180:183], v[108:111]
  buffer_load_dwordx4 v13, s[8:11], s30 offen offset:3072 lds
  v_mfma_f32_16x16x32_bf16 v[112:115], a[48:51], v[184:187], v[112:115]
  ds_read_b128 v[216:219], v19 offset:12288
  s_add_u32 s30, s30, 128
  v_mfma_f32_16x16x32_bf16 v[116:119], a[52:55], v[184:187], v[116:119]
  s_add_u32 m0, m0, 16384
  v_mfma_f32_16x16x32_bf16 v[120:123], a[48:51], v[188:191], v[120:123]
  ds_read_b128 v[220:223], v19 offset:14336
  v_mfma_f32_16x16x32_bf16 v[124:127], a[52:55], v[188:191], v[124:127]
  s_waitcnt vmcnt(16) lgkmcnt(4)
  s_barrier
  v_mfma_f32_16x16x32_bf16 v[64:67], a[56:59], v[192:195], v[64:67]
  ds_read_b128 v[160:163], v18 offset:0
  v_mfma_f32_16x16x32_bf16 v[68:71], a[60:63], v[192:195], v[68:71]
  s_cmp_lt_u32 m0, s46
  s_cselect_b32 m0, m0, s47
  v_mfma_f32_16x16x32_bf16 v[72:75], a[56:59], v[196:199], v[72:75]
  ds_read_b128 v[164:167], v18 offset:2048
  v_add_u32 v19, s33, v15
  v_mfma_f32_16x16x32_bf16 v[76:79], a[60:63], v[196:199], v[76:79]
  buffer_load_dwordx4 v10, s[8:11], s30 offen offset:0 lds
  v_mfma_f32_16x16x32_bf16 v[80:83], a[56:59], v[200:203], v[80:83]
  ds_read_b128 v[168:171], v18 offset:4096
  s_add_u32 s33, s33, 16384
  v_mfma_f32_16x16x32_bf16 v[84:87], a[60:63], v[200:203], v[84:87]
  s_cmp_lt_u32 s33, 114688
  s_cselect_b32 s33, s33, 0
  v_mfma_f32_16x16x32_bf16 v[88:91], a[56:59], v[204:207], v[88:91]
  ds_read_b128 v[172:175], v18 offset:6144
  v_mfma_f32_16x16x32_bf16 v[92:95], a[60:63], v[204:207], v[92:95]
  s_waitcnt lgkmcnt(4)
  v_mfma_f32_16x16x32_bf16 v[96:99], a[56:59], v[208:211], v[96:99]
  ds_read_b128 v[176:179], v18 offset:8192
  v_mfma_f32_16x16x32_bf16 v[100:103], a[60:63], v[208:211], v[100:103]
  v_mfma_f32_16x16x32_bf16 v[104:107], a[56:59], v[212:215], v[104:107]
  ds_read_b128 v[180:183], v18 offset:10240
  v_mfma_f32_16x16x32_bf16 v[108:111], a[60:63], v[212:215], v[108:111]
  buffer_load_dwordx4 v11, s[8:11], s30 offen offset:1024 lds
  v_mfma_f32_16x16x32_bf16 v[112:115], a[56:59], v[216:219], v[112:115]
  ds_read_b128 v[184:187], v18 offset:12288
  v_mfma_f32_16x16x32_bf16 v[116:119], a[60:63], v[216:219], v[116:119]
  v_mfma_f32_16x16x32_bf16 v[120:123], a[56:59], v[220:223], v[120:123]
  ds_read_b128 v[188:191], v18 offset:14336
  v_mfma_f32_16x16x32_bf16 v[124:127], a[60:63], v[220:223], v[124:127]
  s_waitcnt lgkmcnt(4)
  v_mfma_f32_16x16x32_bf16 v[64:67], a[64:67], v[160:163], v[64:67]
  ds_read_b128 v[192:195], v19 offset:0
  v_mfma_f32_16x16x32_bf16 v[68:71], a[68:71], v[160:163], v[68:71]
  v_add_u32 v18, s33, v14
  v_mfma_f32_16x16x32_bf16 v[72:75], a[64:67], v[164:167], v[72:75]
  ds_read_b128 v[196:199], v19 offset:2048
  v_mfma_f32_16x16x32_bf16 v[76:79], a[68:71], v[164:167], v[76:79]
  buffer_load_dwordx4 v12, s[8:11], s30 offen offset:2048 lds
  v_mfma_f32_16x16x32_bf16 v[80:83], a[64:67], v[168:171], v[80:83]
  ds_read_b128 v[200:203], v19 offset:4096
  v_mfma_f32_16x16x32_bf16 v[84:87], a[68:71], v[168:171], v[84:87]
  v_mfma_f32_16x16x32_bf16 v[88:91], a[64:67], v[172:175], v[88:91]
  ds_read_b128 v[204:207], v19 offset:6144
  v_mfma_f32_16x16x32_bf16 v[92:95], a[68:71], v[172:175], v[92:95]
  s_waitcnt lgkmcnt(4)
  v_mfma_f32_16x16x32_bf16 v[96:99], a[64:67], v[176:179], v[96:99]
  ds_read_b128 v[208:211], v19 offset:8192
  v_mfma_f32_16x16x32_bf16 v[100:103], a[68:71], v[176:179], v[100:103]
  v_mfma_f32_16x16x32_bf16 v[104:107], a[64:67], v[180:183], v[104:107]
  ds_read_b128 v[212:215], v19 offset:10240
  v_mfma_f32_16x16x32_bf16 v[108:111], a[68:71], v[180:183], v[108:111]
  buffer_load_dwordx4 v13, s[8:11], s30 offen offset:3072 lds
  v_mfma_f32_16x16x32_bf16 v[112:115], a[64:67], v[184:187], v[112:115]
  ds_read_b128 v[216:219], v19 offset:12288
  s_add_u32 s30, s30, s25
  v_mfma_f32_16x16x32_bf16 v[116:119], a[68:71], v[184:187], v[116:119]
  s_sub_u32 s30, s30, 1152
  s_add_u32 m0, m0, 16384
  v_mfma_f32_16x16x32_bf16 v[120:123], a[64:67], v[188:191], v[120:123]
  ds_read_b128 v[220:223], v19 offset:14336
  v_mfma_f32_16x16x32_bf16 v[124:127], a[68:71], v[188:191], v[124:127]
  s_waitcnt vmcnt(16) lgkmcnt(4)
  s_barrier
  v_mfma_f32_16x16x32_bf16 v[64:67], a[72:75], v[192:195], v[64:67]
  ds_read_b128 v[160:163], v18 offset:0
  v_mfma_f32_16x16x32_bf16 v[68:71], a[76:79], v[192:195], v[68:71]
  s_cmp_lt_u32 m0, s46
  s_cselect_b32 m0, m0, s47
  v_mfma_f32_16x16x32_bf16 v[72:75], a[72:75], v[196:199], v[72:75]
  ds_read_b128 v[164:167], v18 offset:2048
  v_add_u32 v19, s33, v15
  v_mfma_f32_16x16x32_bf16 v[76:79], a[76:79], v[196:199], v[76:79]
  buffer_load_dwordx4 v10, s[8:11], s30 offen offset:0 lds
  v_mfma_f32_16x16x32_bf16 v[80:83], a[72:75], v[200:203], v[80:83]
  ds_read_b128 v[168:171], v18 offset:4096
  s_add_u32 s33, s33, 16384
  v_mfma_f32_16x16x32_bf16 v[84:87], a[76:79], v[200:203], v[84:87]
  s_cmp_lt_u32 s33, 114688
  s_cselect_b32 s33, s33, 0
  v_mfma_f32_16x16x32_bf16 v[88:91], a[72:75], v[204:207], v[88:91]
  ds_read_b128 v[172:175], v18 offset:6144
  v_mfma_f32_16x16x32_bf16 v[92:95], a[76:79], v[204:207], v[92:95]
  s_waitcnt lgkmcnt(4)
  v_mfma_f32_16x16x32_bf16 v[96:99], a[72:75], v[208:211], v[96:99]
  ds_read_b128 v[176:179], v18 offset:8192
  v_mfma_f32_16x16x32_bf16 v[100:103], a[76:79], v[208:211], v[100:103]
  v_mfma_f32_16x16x32_bf16 v[104:107], a[72:75], v[212:215], v[104:107]
  ds_read_b128 v[180:183], v18 offset:10240
  v_mfma_f32_16x16x32_bf16 v[108:111], a[76:79], v[212:215], v[108:111]
  buffer_load_dwordx4 v11, s[8:11], s30 offen offset:1024 lds
  v_mfma_f32_16x16x32_bf16 v[112:115], a[72:75], v[216:219], v[112:115]
  ds_read_b128 v[184:187], v18 offset:12288
  v_mfma_f32_16x16x32_bf16 v[116:119], a[76:79], v[216:219], v[116:119]
  v_mfma_f32_16x16x32_bf16 v[120:123], a[72:75], v[220:223], v[120:123]
  ds_read_b128 v[188:191], v18 offset:14336
  v_mfma_f32_16x16x32_bf16 v[124:127], a[76:79], v[220:223], v[124:127]
  s_waitcnt lgkmcnt(4)
  v_mfma_f32_16x16x32_bf16 v[64:67], a[80:83], v[160:163], v[64:67]
  ds_read_b128 v[192:195], v19 offset:0
  v_mfma_f32_16x16x32_bf16 v[68:71], a[84:87], v[160:163], v[68:71]
  v_add_u32 v18, s33, v14
  v_mfma_f32_16x16x32_bf16 v[72:75], a[80:83], v[164:167], v[72:75]
  ds_read_b128 v[196:199], v19 offset:2048
  v_mfma_f32_16x16x32_bf16 v[76:79], a[84:87], v[164:167], v[76:79]
  buffer_load_dwordx4 v12, s[8:11], s30 offen offset:2048 lds
  v_mfma_f32_16x16x32_bf16 v[80:83], a[80:83], v[168:171], v[80:83]
  ds_read_b128 v[200:203], v19 offset:4096
  v_mfma_f32_16x16x32_bf16 v[84:87], a[84:87], v[168:171], v[84:87]
  v_mfma_f32_16x16x32_bf16 v[88:91], a[80:83], v[172:175], v[88:91]
  ds_read_b128 v[204:207], v19 offset:6144
  v_mfma_f32_16x16x32_bf16 v[92:95], a[84:87], v[172:175], v[92:95]
  s_waitcnt lgkmcnt(4)
  v_mfma_f32_16x16x32_bf16 v[96:99], a[80:83], v[176:179], v[96:99]
  ds_read_b128 v[208:211], v19 offset:8192
  v_mfma_f32_16x16x32_bf16 v[100:103], a[84:87], v[176:179], v[100:103]
  v_mfma_f32_16x16x32_bf16 v[104:107], a[80:83], v[180:183], v[104:107]
  ds_read_b128 v[212:215], v19 offset:10240
  v_mfma_f32_16x16x32_bf16 v[108:111], a[84:87], v[180:183], v[108:111]
  buffer_load_dwordx4 v13, s[8:11], s30 offen offset:3072 lds
  v_mfma_f32_16x16x32_bf16 v[112:115], a[80:83], v[184:187], v[112:115]
  ds_read_b128 v[216:219], v19 offset:12288
  s_add_u32 s30, s30, 128
  v_mfma_f32_16x16x32_bf16 v[116:119], a[84:87], v[184:187], v[116:119]
  s_add_u32 m0, m0, 16384
  v_mfma_f32_16x16x32_bf16 v[120:123], a[80:83], v[188:191], v[120:123]
  ds_read_b128 v[220:223], v19 offset:14336
  v_mfma_f32_16x16x32_bf16 v[124:127], a[84:87], v[188:191], v[124:127]
  s_waitcnt vmcnt(16) lgkmcnt(4)
  s_barrier
  v_mfma_f32_16x16x32_bf16 v[64:67], a[88:91], v[192:195], v[64:67]
  ds_read_b128 v[160:163], v18 offset:0
  v_mfma_f32_16x16x32_bf16 v[68:71], a[92:95], v[192:195], v[68:71]
  s_cmp_lt_u32 m0, s46
  s_cselect_b32 m0, m0, s47
  v_mfma_f32_16x16x32_bf16 v[72:75], a[88:91], v[196:199], v[72:75]
  ds_read_b128 v[164:167], v18 offset:2048
  v_add_u32 v19, s33, v15
  v_mfma_f32_16x16x32_bf16 v[76:79], a[92:95], v[196:199], v[76:79]
  buffer_load_dwordx4 v10, s[8:11], s30 offen offset:0 lds
  v_mfma_f32_16x16x32_bf16 v[80:83], a[88:91], v[200:203], v[80:83]
  ds_read_b128 v[168:171], v18 offset:4096
  s_add_u32 s33, s33, 16384
  v_mfma_f32_16x16x32_bf16 v[84:87], a[92:95], v[200:203], v[84:87]
  s_cmp_lt_u32 s33, 114688
  s_cselect_b32 s33, s33, 0
  v_mfma_f32_16x16x32_bf16 v[88:91], a[88:91], v[204:207], v[88:91]
  ds_read_b128 v[172:175], v18 offset:6144
  v_mfma_f32_16x16x32_bf16 v[92:95], a[92:95], v[204:207], v[92:95]
  s_waitcnt lgkmcnt(4)
  v_mfma_f32_16x16x32_bf16 v[96:99], a[88:91], v[208:211], v[96:99]
  ds_read_b128 v[176:179], v18 offset:8192
  v_mfma_f32_16x16x32_bf16 v[100:103], a[92:95], v[208:211], v[100:103]
  v_mfma_f32_16x16x32_bf16 v[104:107], a[88:91], v[212:215], v[104:107]
  ds_read_b128 v[180:183], v18 offset:10240
  v_mfma_f32_16x16x32_bf16 v[108:111], a[92:95], v[212:215], v[108:111]
  buffer_load_dwordx4 v11, s[8:11], s30 offen offset:1024 lds
  v_mfma_f32_16x16x32_bf16 v[112:115], a[88:91], v[216:219], v[112:115]
  ds_read_b128 v[184:187], v18 offset:12288
  v_mfma_f32_16x16x32_bf16 v[116:119], a[92:95], v[216:219], v[116:119]
  v_mfma_f32_16x16x32_bf16 v[120:123], a[88:91], v[220:223], v[120:123]
  ds_read_b128 v[188:191], v18 offset:14336
  v_mfma_f32_16x16x32_bf16 v[124:127], a[92:95], v[220:223], v[124:127]
  s_waitcnt lgkmcnt(4)
  v_mfma_f32_16x16x32_bf16 v[64:67], a[96:99], v[160:163], v[64:67]
  ds_read_b128 v[192:195], v19 offset:0
  v_mfma_f32_16x16x32_bf16 v[68:71], a[100:103], v[160:163], v[68:71]
  v_add_u32 v18, s33, v14
  v_mfma_f32_16x16x32_bf16 v[72:75], a[96:99], v[164:167], v[72:75]
  ds_read_b128 v[196:199], v19 offset:2048
  v_mfma_f32_16x16x32_bf16 v[76:79], a[100:103], v[164:167], v[76:79]
  buffer_load_dwordx4 v12, s[8:11], s30 offen offset:2048 lds
  v_mfma_f32_16x16x32_bf16 v[80:83], a[96:99], v[168:171], v[80:83]
  ds_read_b128 v[200:203], v19 offset:4096
  v_mfma_f32_16x16x32_bf16 v[84:87], a[100:103], v[168:171], v[84:87]
  v_mfma_f32_16x16x32_bf16 v[88:91], a[96:99], v[172:175], v[88:91]
  ds_read_b128 v[204:207], v19 offset:6144
  v_mfma_f32_16x16x32_bf16 v[92:95], a[100:103], v[172:175], v[92:95]
  s_waitcnt lgkmcnt(4)
  v_mfma_f32_16x16x32_bf16 v[96:99], a[96:99], v[176:179], v[96:99]
  ds_read_b128 v[208:211], v19 offset:8192
  v_mfma_f32_16x16x32_bf16 v[100:103], a[100:103], v[176:179], v[100:103]
  v_mfma_f32_16x16x32_bf16 v[104:107], a[96:99], v[180:183], v[104:107]
  ds_read_b128 v[212:215], v19 offset:10240
  v_mfma_f32_16x16x32_bf16 v[108:111], a[100:103], v[180:183], v[108:111]
  buffer_load_dwordx4 v13, s[8:11], s30 offen offset:3072 lds
  v_mfma_f32_16x16x32_bf16 v[112:115], a[96:99], v[184:187], v[112:115]
  ds_read_b128 v[216:219], v19 offset:12288
  s_add_u32 s30, s30, 128
  v_mfma_f32_16x16x32_bf16 v[116:119], a[100:103], v[184:187], v[116:119]
  s_add_u32 m0, m0, 16384
  v_mfma_f32_16x16x32_bf16 v[120:123], a[96:99], v[188:191], v[120:123]
  ds_read_b128 v[220:223], v19 offset:14336
  v_mfma_f32_16x16x32_bf16 v[124:127], a[100:103], v[188:191], v[124:127]
  s_waitcnt vmcnt(16) lgkmcnt(4)
  s_barrier
  v_mfma_f32_16x16x32_bf16 v[64:67], a[104:107], v[192:195], v[64:67]
  ds_read_b128 v[160:163], v18 offset:0
  v_mfma_f32_16x16x32_bf16 v[68:71], a[108:111], v[192:195], v[68:71]
  s_cmp_lt_u32 m0, s46
  s_cselect_b32 m0, m0, s47
  v_mfma_f32_16x16x32_bf16 v[72:75], a[104:107], v[196:199], v[72:75]
  ds_read_b128 v[164:167], v18 offset:2048
  v_add_u32 v19, s33, v15
  v_mfma_f32_16x16x32_bf16 v[76:79], a[108:111], v[196:199], v[76:79]
  buffer_load_dwordx4 v10, s[8:11], s30 offen offset:0 lds
  v_mfma_f32_16x16x32_bf16 v[80:83], a[104:107], v[200:203], v[80:83]
  ds_read_b128 v[168:171], v18 offset:4096
  s_add_u32 s33, s33, 16384
  v_mfma_f32_16x16x32_bf16 v[84:87], a[108:111], v[200:203], v[84:87]
  s_cmp_lt_u32 s33, 114688
  s_cselect_b32 s33, s33, 0
  v_mfma_f32_16x16x32_bf16 v[88:91], a[104:107], v[204:207], v[88:91]
  ds_read_b128 v[172:175], v18 offset:6144
  v_mfma_f32_16x16x32_bf16 v[92:95], a[108:111], v[204:207], v[92:95]
  s_waitcnt lgkmcnt(4)
  v_mfma_f32_16x16x32_bf16 v[96:99], a[104:107], v[208:211], v[96:99]
  ds_read_b128 v[176:179], v18 offset:8192
  v_mfma_f32_16x16x32_bf16 v[100:103], a[108:111], v[208:211], v[100:103]
  v_mfma_f32_16x16x32_bf16 v[104:107], a[104:107], v[212:215], v[104:107]
  ds_read_b128 v[180:183], v18 offset:10240
  v_mfma_f32_16x16x32_bf16 v[108:111], a[108:111], v[212:215], v[108:111]
  buffer_load_dwordx4 v11, s[8:11], s30 offen offset:1024 lds
  v_mfma_f32_16x16x32_bf16 v[112:115], a[104:107], v[216:219], v[112:115]
  ds_read_b128 v[184:187], v18 offset:12288
  v_mfma_f32_16x16x32_bf16 v[116:119], a[108:111], v[216:219], v[116:119]
  v_mfma_f32_16x16x32_bf16 v[120:123], a[104:107], v[220:223], v[120:123]
  ds_read_b128 v[188:191], v18 offset:14336
  v_mfma_f32_16x16x32_bf16 v[124:127], a[108:111], v[220:223], v[124:127]
  s_waitcnt lgkmcnt(4)
  v_mfma_f32_16x16x32_bf16 v[64:67], a[112:115], v[160:163], v[64:67]
  ds_read_b128 v[192:195], v19 offset:0
  v_mfma_f32_16x16x32_bf16 v[68:71], a[116:119], v[160:163], v[68:71]
  v_add_u32 v18, s33, v14
  v_mfma_f32_16x16x32_bf16 v[72:75], a[112:115], v[164:167], v[72:75]
  ds_read_b128 v[196:199], v19 offset:2048
  v_mfma_f32_16x16x32_bf16 v[76:79], a[116:119], v[164:167], v[76:79]
  buffer_load_dwordx4 v12, s[8:11], s30 offen offset:2048 lds
  v_mfma_f32_16x16x32_bf16 v[80:83], a[112:115], v[168:171], v[80:83]
  ds_read_b128 v[200:203], v19 offset:4096
  v_mfma_f32_16x16x32_bf16 v[84:87], a[116:119], v[168:171], v[84:87]
  v_mfma_f32_16x16x32_bf16 v[88:91], a[112:115], v[172:175], v[88:91]
  ds_read_b128 v[204:207], v19 offset:6144
  v_mfma_f32_16x16x32_bf16 v[92:95], a[116:119], v[172:175], v[92:95]
  s_waitcnt lgkmcnt(4)
  v_mfma_f32_16x16x32_bf16 v[96:99], a[112:115], v[176:179], v[96:99]
  ds_read_b128 v[208:211], v19 offset:8192
  v_mfma_f32_16x16x32_bf16 v[100:103], a[116:119], v[176:179], v[100:103]
  v_mfma_f32_16x16x32_bf16 v[104:107], a[112:115], v[180:183], v[104:107]
  ds_read_b128 v[212:215], v19 offset:10240
  v_mfma_f32_16x16x32_bf16 v[108:111], a[116:119], v[180:183], v[108:111]
  buffer_load_dwordx4 v13, s[8:11], s30 offen offset:3072 lds
  v_mfma_f32_16x16x32_bf16 v[112:115], a[112:115], v[184:187], v[112:115]
  ds_read_b128 v[216:219], v19 offset:12288
  s_add_u32 s30, s30, 128
  v_mfma_f32_16x16x32_bf16 v[116:119], a[116:119], v[184:187], v[116:119]
  s_add_u32 m0, m0, 16384
  v_mfma_f32_16x16x32_bf16 v[120:123], a[112:115], v[188:191], v[120:123]
  ds_read_b128 v[220:223], v19 offset:14336
  v_mfma_f32_16x16x32_bf16 v[124:127], a[116:119], v[188:191], v[124:127]
  s_waitcnt vmcnt(16) lgkmcnt(4)
  s_barrier
  v_mfma_f32_16x16x32_bf16 v[64:67], a[120:123], v[192:195], v[64:67]
  ds_read_b128 v[160:163], v18 offset:0
  v_mfma_f32_16x16x32_bf16 v[68:71], a[124:127], v[192:195], v[68:71]
  s_cmp_lt_u32 m0, s46
  s_cselect_b32 m0, m0, s47
  v_mfma_f32_16x16x32_bf16 v[72:75], a[120:123], v[196:199], v[72:75]
  ds_read_b128 v[164:167], v18 offset:2048
  v_add_u32 v19, s33, v15
  v_mfma_f32_16x16x32_bf16 v[76:79], a[124:127], v[196:199], v[76:79]
  buffer_load_dwordx4 v10, s[8:11], s30 offen offset:0 lds
  v_mfma_f32_16x16x32_bf16 v[80:83], a[120:123], v[200:203], v[80:83]
  ds_read_b128 v[168:171], v18 offset:4096
  s_add_u32 s33, s33, 16384
  v_mfma_f32_16x16x32_bf16 v[84:87], a[124:127], v[200:203], v[84:87]
  s_cmp_lt_u32 s33, 114688
  s_cselect_b32 s33, s33, 0
  v_mfma_f32_16x16x32_bf16 v[88:91], a[120:123], v[204:207], v[88:91]
  ds_read_b128 v[172:175], v18 offset:6144
  v_mfma_f32_16x16x32_bf16 v[92:95], a[124:127], v[204:207], v[92:95]
  s_waitcnt lgkmcnt(4)
  v_mfma_f32_16x16x32_bf16 v[96:99], a[120:123], v[208:211], v[96:99]
  ds_read_b128 v[176:179], v18 offset:8192
  v_mfma_f32_16x16x32_bf16 v[100:103], a[124:127], v[208:211], v[100:103]
  v_mfma_f32_16x16x32_bf16 v[104:107], a[120:123], v[212:215], v[104:107]
  ds_read_b128 v[180:183], v18 offset:10240
  v_mfma_f32_16x16x32_bf16 v[108:111], a[124:127], v[212:215], v[108:111]
  buffer_load_dwordx4 v11, s[8:11], s30 offen offset:1024 lds
  v_mfma_f32_16x16x32_bf16 v[112:115], a[120:123], v[216:219], v[112:115]
  ds_read_b128 v[184:187], v18 offset:12288
  v_mfma_f32_16x16x32_bf16 v[116:119], a[124:127], v[216:219], v[116:119]
  v_mfma_f32_16x16x32_bf16 v[120:123], a[120:123], v[220:223], v[120:123]
  ds_read_b128 v[188:191], v18 offset:14336
  v_mfma_f32_16x16x32_bf16 v[124:127], a[124:127], v[220:223], v[124:127]
  s_waitcnt lgkmcnt(4)
  v_mfma_f32_16x16x32_bf16 v[64:67], a[128:131], v[160:163], v[64:67]
  ds_read_b128 v[192:195], v19 offset:0
  v_mfma_f32_16x16x32_bf16 v[68:71], a[132:135], v[160:163], v[68:71]
  v_add_u32 v18, s33, v14
  v_mfma_f32_16x16x32_bf16 v[72:75], a[128:131], v[164:167], v[72:75]
  ds_read_b128 v[196:199], v19 offset:2048
  v_mfma_f32_16x16x32_bf16 v[76:79], a[132:135], v[164:167], v[76:79]
  buffer_load_dwordx4 v12, s[8:11], s30 offen offset:2048 lds
  v_mfma_f32_16x16x32_bf16 v[80:83], a[128:131], v[168:171], v[80:83]
  ds_read_b128 v[200:203], v19 offset:4096
  v_mfma_f32_16x16x32_bf16 v[84:87], a[132:135], v[168:171], v[84:87]
  v_mfma_f32_16x16x32_bf16 v[88:91], a[128:131], v[172:175], v[88:91]
  ds_read_b128 v[204:207], v19 offset:6144
  v_mfma_f32_16x16x32_bf16 v[92:95], a[132:135], v[172:175], v[92:95]
  s_waitcnt lgkmcnt(4)
  v_mfma_f32_16x16x32_bf16 v[96:99], a[128:131], v[176:179], v[96:99]
  ds_read_b128 v[208:211], v19 offset:8192
  v_mfma_f32_16x16x32_bf16 v[100:103], a[132:135], v[176:179], v[100:103]
  v_mfma_f32_16x16x32_bf16 v[104:107], a[128:131], v[180:183], v[104:107]
  ds_read_b128 v[212:215], v19 offset:10240
  v_mfma_f32_16x16x32_bf16 v[108:111], a[132:135], v[180:183], v[108:111]
  buffer_load_dwordx4 v13, s[8:11], s30 offen offset:3072 lds
  v_mfma_f32_16x16x32_bf16 v[112:115], a[128:131], v[184:187], v[112:115]
  ds_read_b128 v[216:219], v19 offset:12288
  s_add_u32 s30, s30, 128
  v_mfma_f32_16x16x32_bf16 v[116:119], a[132:135], v[184:187], v[116:119]
  s_add_u32 m0, m0, 16384
  v_mfma_f32_16x16x32_bf16 v[120:123], a[128:131], v[188:191], v[120:123]
  ds_read_b128 v[220:223], v19 offset:14336
  v_mfma_f32_16x16x32_bf16 v[124:127], a[132:135], v[188:191], v[124:127]
  s_waitcnt vmcnt(16) lgkmcnt(4)
  s_barrier
  v_mfma_f32_16x16x32_bf16 v[64:67], a[136:139], v[192:195], v[64:67]
  ds_read_b128 v[160:163], v18 offset:0
  v_mfma_f32_16x16x32_bf16 v[68:71], a[140:143], v[192:195], v[68:71]
  s_cmp_lt_u32 m0, s46
  s_cselect_b32 m0, m0, s47
  v_mfma_f32_16x16x32_bf16 v[72:75], a[136:139], v[196:199], v[72:75]
  ds_read_b128 v[164:167], v18 offset:2048
  v_add_u32 v19, s33, v15
  v_mfma_f32_16x16x32_bf16 v[76:79], a[140:143], v[196:199], v[76:79]
  buffer_load_dwordx4 v10, s[8:11], s30 offen offset:0 lds
  v_mfma_f32_16x16x32_bf16 v[80:83], a[136:139], v[200:203], v[80:83]
  ds_read_b128 v[168:171], v18 offset:4096
  s_add_u32 s33, s33, 16384
  v_mfma_f32_16x16x32_bf16 v[84:87], a[140:143], v[200:203], v[84:87]
  s_cmp_lt_u32 s33, 114688
  s_cselect_b32 s33, s33, 0
  v_mfma_f32_16x16x32_bf16 v[88:91], a[136:139], v[204:207], v[88:91]
  ds_read_b128 v[172:175], v18 offset:6144
  v_mfma_f32_16x16x32_bf16 v[92:95], a[140:143], v[204:207], v[92:95]
  s_waitcnt lgkmcnt(4)
  v_mfma_f32_16x16x32_bf16 v[96:99], a[136:139], v[208:211], v[96:99]
  ds_read_b128 v[176:179], v18 offset:8192
  v_mfma_f32_16x16x32_bf16 v[100:103], a[140:143], v[208:211], v[100:103]
  v_mfma_f32_16x16x32_bf16 v[104:107], a[136:139], v[212:215], v[104:107]
  ds_read_b128 v[180:183], v18 offset:10240
  v_mfma_f32_16x16x32_bf16 v[108:111], a[140:143], v[212:215], v[108:111]
  buffer_load_dwordx4 v11, s[8:11], s30 offen offset:1024 lds
  v_mfma_f32_16x16x32_bf16 v[112:115], a[136:139], v[216:219], v[112:115]
  ds_read_b128 v[184:187], v18 offset:12288
  v_mfma_f32_16x16x32_bf16 v[116:119], a[140:143], v[216:219], v[116:119]
  v_mfma_f32_16x16x32_bf16 v[120:123], a[136:139], v[220:223], v[120:123]
  ds_read_b128 v[188:191], v18 offset:14336
  v_mfma_f32_16x16x32_bf16 v[124:127], a[140:143], v[220:223], v[124:127]
  s_waitcnt lgkmcnt(4)
  v_mfma_f32_16x16x32_bf16 v[64:67], a[144:147], v[160:163], v[64:67]
  ds_read_b128 v[192:195], v19 offset:0
  v_mfma_f32_16x16x32_bf16 v[68:71], a[148:151], v[160:163], v[68:71]
  v_add_u32 v18, s33, v14
  v_mfma_f32_16x16x32_bf16 v[72:75], a[144:147], v[164:167], v[72:75]
  ds_read_b128 v[196:199], v19 offset:2048
  v_mfma_f32_16x16x32_bf16 v[76:79], a[148:151], v[164:167], v[76:79]
  buffer_load_dwordx4 v12, s[8:11], s30 offen offset:2048 lds
  v_mfma_f32_16x16x32_bf16 v[80:83], a[144:147], v[168:171], v[80:83]
  ds_read_b128 v[200:203], v19 offset:4096
  v_mfma_f32_16x16x32_bf16 v[84:87], a[148:151], v[168:171], v[84:87]
  v_mfma_f32_16x16x32_bf16 v[88:91], a[144:147], v[172:175], v[88:91]
  ds_read_b128 v[204:207], v19 offset:6144
  v_mfma_f32_16x16x32_bf16 v[92:95], a[148:151], v[172:175], v[92:95]
  s_waitcnt lgkmcnt(4)
  v_mfma_f32_16x16x32_bf16 v[96:99], a[144:147], v[176:179], v[96:99]
  ds_read_b128 v[208:211], v19 offset:8192
  v_mfma_f32_16x16x32_bf16 v[100:103], a[148:151], v[176:179], v[100:103]
  v_mfma_f32_16x16x32_bf16 v[104:107], a[144:147], v[180:183], v[104:107]
  ds_read_b128 v[212:215], v19 offset:10240
  v_mfma_f32_16x16x32_bf16 v[108:111], a[148:151], v[180:183], v[108:111]
  buffer_load_dwordx4 v13, s[8:11], s30 offen offset:3072 lds
  v_mfma_f32_16x16x32_bf16 v[112:115], a[144:147], v[184:187], v[112:115]
  ds_read_b128 v[216:219], v19 offset:12288
  s_add_u32 s30, s30, 128
  v_mfma_f32_16x16x32_bf16 v[116:119], a[148:151], v[184:187], v[116:119]
  s_add_u32 m0, m0, 16384
  v_mfma_f32_16x16x32_bf16 v[120:123], a[144:147], v[188:191], v[120:123]
  ds_read_b128 v[220:223], v19 offset:14336
  v_mfma_f32_16x16x32_bf16 v[124:127], a[148:151], v[188:191], v[124:127]
  s_waitcnt vmcnt(16) lgkmcnt(4)
  s_barrier
  v_mfma_f32_16x16x32_bf16 v[64:67], a[152:155], v[192:195], v[64:67]
  ds_read_b128 v[160:163], v18 offset:0
  v_mfma_f32_16x16x32_bf16 v[68:71], a[156:159], v[192:195], v[68:71]
  s_cmp_lt_u32 m0, s46
  s_cselect_b32 m0, m0, s47
  v_mfma_f32_16x16x32_bf16 v[72:75], a[152:155], v[196:199], v[72:75]
  ds_read_b128 v[164:167], v18 offset:2048
  v_add_u32 v19, s33, v15
  v_mfma_f32_16x16x32_bf16 v[76:79], a[156:159], v[196:199], v[76:79]
  buffer_load_dwordx4 v10, s[8:11], s30 offen offset:0 lds
  v_cvt_pk_bf16_f32 v224, v64, v65
  v_cvt_pk_bf16_f32 v225, v66, v67
  v_mfma_f32_16x16x32_bf16 v[80:83], a[152:155], v[200:203], v[80:83]
  ds_read_b128 v[168:171], v18 offset:4096
  s_add_u32 s33, s33, 16384
  v_cvt_pk_bf16_f32 v226, v68, v69
  v_cvt_pk_bf16_f32 v227, v70, v71
  v_mfma_f32_16x16x32_bf16 v[84:87], a[156:159], v[200:203], v[84:87]
  s_cmp_lt_u32 s33, 114688
  s_cselect_b32 s33, s33, 0
  ds_write_b64 v22, v[224:225] offset:0
  v_mfma_f32_16x16x32_bf16 v[88:91], a[152:155], v[204:207], v[88:91]
  ds_read_b128 v[172:175], v18 offset:6144
  ds_write_b64 v22, v[226:227] offset:32
  v_cvt_pk_bf16_f32 v230, v72, v73
  v_mfma_f32_16x16x32_bf16 v[92:95], a[156:159], v[204:207], v[92:95]
  s_waitcnt lgkmcnt(6)
  v_cvt_pk_bf16_f32 v231, v74, v75
  v_cvt_pk_bf16_f32 v232, v76, v77
  v_cvt_pk_bf16_f32 v233, v78, v79
  v_mfma_f32_16x16x32_bf16 v[96:99], a[152:155], v[208:211], v[96:99]
  ds_read_b128 v[176:179], v18 offset:8192
  ds_write_b64 v22, v[230:231] offset:4224
  v_mfma_f32_16x16x32_bf16 v[100:103], a[156:159], v[208:211], v[100:103]
  ds_write_b64 v22, v[232:233] offset:4256
  v_cvt_pk_bf16_f32 v224, v80, v81
  v_cvt_pk_bf16_f32 v225, v82, v83
  v_mfma_f32_16x16x32_bf16 v[104:107], a[152:155], v[212:215], v[104:107]
  ds_read_b128 v[180:183], v18 offset:10240
  v_cvt_pk_bf16_f32 v226, v84, v85
  v_cvt_pk_bf16_f32 v227, v86, v87
  v_mfma_f32_16x16x32_bf16 v[108:111], a[156:159], v[212:215], v[108:111]
  buffer_load_dwordx4 v11, s[8:11], s30 offen offset:1024 lds
  ds_write_b64 v22, v[224:225] offset:8448
  v_mfma_f32_16x16x32_bf16 v[112:115], a[152:155], v[216:219], v[112:115]
  ds_read_b128 v[184:187], v18 offset:12288
  ds_write_b64 v22, v[226:227] offset:8480
  v_cvt_pk_bf16_f32 v230, v88, v89
  v_mfma_f32_16x16x32_bf16 v[116:119], a[156:159], v[216:219], v[116:119]
  v_cvt_pk_bf16_f32 v231, v90, v91
  v_cvt_pk_bf16_f32 v232, v92, v93
  v_cvt_pk_bf16_f32 v233, v94, v95
  v_mfma_f32_16x16x32_bf16 v[120:123], a[152:155], v[220:223], v[120:123]
  ds_read_b128 v[188:191], v18 offset:14336
  ds_write_b64 v22, v[230:231] offset:12672
  v_mfma_f32_16x16x32_bf16 v[124:127], a[156:159], v[220:223], v[124:127]
  ds_write_b64 v22, v[232:233] offset:12704
  v_cvt_pk_bf16_f32 v224, v96, v97
  v_cvt_pk_bf16_f32 v225, v98, v99
bf_end_200:
  v_cvt_pk_bf16_f32 v226, v100, v101
  v_cvt_pk_bf16_f32 v227, v102, v103
  ds_write_b64 v22, v[224:225] offset:16896
  ds_write_b64 v22, v[226:227] offset:16928
  v_cvt_pk_bf16_f32 v230, v104, v105
  v_cvt_pk_bf16_f32 v231, v106, v107
  v_cvt_pk_bf16_f32 v232, v108, v109
  v_cvt_pk_bf16_f32 v233, v110, v111
  ds_write_b64 v22, v[230:231] offset:21120
  ds_write_b64 v22, v[232:233] offset:21152
  v_cvt_pk_bf16_f32 v224, v112, v113
  v_cvt_pk_bf16_f32 v225, v114, v115
  v_cvt_pk_bf16_f32 v226, v116, v117
  v_cvt_pk_bf16_f32 v227, v118, v119
  ds_write_b64 v22, v[224:225] offset:25344
  ds_write_b64 v22, v[226:227] offset:25376
  v_cvt_pk_bf16_f32 v230, v120, v121
  v_cvt_pk_bf16_f32 v231, v122, v123
  v_cvt_pk_bf16_f32 v232, v124, v125
  v_cvt_pk_bf16_f32 v233, v126, v127
  ds_write_b64 v22, v[230:231] offset:29568
  ds_write_b64 v22, v[232:233] offset:29600
  s_waitcnt lgkmcnt(0)
  s_barrier
  ds_read_b64 v[144:145], v34 offset:1848
  ds_read_b64 v[146:147], v34 offset:1856
  ds_read_b64 v[148:149], v34 offset:1864
  ds_read_b64 v[150:151], v34 offset:1872
  ds_read_b64 v[152:153], v34 offset:1880
  ds_read_b64 v[64:65], v34 offset:1928
  ds_read_b64 v[66:67], v34 offset:1936
  ds_read_b64 v[68:69], v34 offset:1944
  ds_read_b64 v[70:71], v34 offset:1952
  ds_read_b64 v[72:73], v34 offset:1960
  ds_read_b64 v[74:75], v34 offset:1664
  ds_read_b64 v[76:77], v34 offset:1672
  ds_read_b64 v[78:79], v34 offset:1680
  ds_read_b64 v[80:81], v34 offset:1688
  ds_read_b64 v[82:83], v34 offset:1696
  ds_read_b64 v[84:85], v34 offset:1400
  ds_read_b64 v[86:87], v34 offset:1408
  ds_read_b64 v[88:89], v34 offset:1416
  ds_read_b64 v[90:91], v34 offset:1424
  ds_read_b64 v[92:93], v34 offset:1432
  ds_read_b64 v[94:95], v34 offset:1136
  ds_read_b64 v[96:97], v34 offset:1144
  ds_read_b64 v[98:99], v34 offset:1152
  ds_read_b64 v[100:101], v34 offset:1160
  ds_read_b64 v[102:103], v34 offset:1168
  ds_read_b64 v[104:105], v34 offset:872
  ds_read_b64 v[106:107], v34 offset:880
  ds_read_b64 v[108:109], v34 offset:888
  ds_read_b64 v[110:111], v34 offset:896
  ds_read_b64 v[112:113], v34 offset:904
  v_mov_b32 v224, 0
  v_mov_b32 v225, 0
  ds_read_b64 v[114:115], v34 offset:608
  ds_read_b64 v[116:117], v34 offset:616
  ds_read_b64 v[118:119], v34 offset:624
  ds_read_b64 v[120:121], v34 offset:632
  ds_read_b64 v[122:123], v34 offset:640
  v_mov_b32 v226, 0
  v_mov_b32 v227, 0
  ds_read_b64 v[124:125], v34 offset:344
  ds_read_b64 v[126:127], v34 offset:352
  ds_read_b64 v[128:129], v34 offset:360
  ds_read_b64 v[130:131], v34 offset:368
  ds_read_b64 v[132:133], v34 offset:376
  v_mov_b32 v228, 0
  v_mov_b32 v229, 0
  ds_read_b64 v[134:135], v34 offset:80
  ds_read_b64 v[136:137], v34 offset:88
  ds_read_b64 v[138:139], v34 offset:96
  ds_read_b64 v[140:141], v34 offset:104
  ds_read_b64 v[142:143], v34 offset:112
  v_mov_b32 v230, 0
  v_mov_b32 v231, 0
  v_mov_b32 v192, 0
  v_mov_b32 v193, 0
  v_mov_b32 v194, 0
  v_mov_b32 v195, 0
  v_mov_b32 v196, 0
  v_mov_b32 v197, 0
  v_mov_b32 v198, 0
  v_mov_b32 v199, 0
  v_mov_b32 v200, 0
  v_mov_b32 v201, 0
  v_mov_b32 v202, 0
  v_mov_b32 v203, 0
  v_mov_b32 v204, 0
  v_mov_b32 v205, 0
  v_mov_b32 v206, 0
  v_mov_b32 v207, 0
  v_mov_b32 v208, 0
  v_mov_b32 v209, 0
  v_mov_b32 v210, 0
  v_mov_b32 v211, 0
  s_waitcnt lgkmcnt(15)
  v_dot2c_f32_bf16 v224, v64, v144
  v_dot2c_f32_bf16 v225, v74, v144
  v_dot2c_f32_bf16 v226, v84, v144
  v_dot2c_f32_bf16 v227, v94, v144
  v_dot2c_f32_bf16 v228, v104, v144
  v_dot2c_f32_bf16 v224, v65, v145
  v_dot2c_f32_bf16 v225, v75, v145
  v_dot2c_f32_bf16 v226, v85, v145
  v_dot2c_f32_bf16 v227, v95, v145
  v_dot2c_f32_bf16 v228, v105, v145
  v_dot2c_f32_bf16 v224, v66, v146
  v_dot2c_f32_bf16 v225, v76, v146
  v_dot2c_f32_bf16 v226, v86, v146
  v_dot2c_f32_bf16 v227, v96, v146
  v_dot2c_f32_bf16 v228, v106, v146
  v_dot2c_f32_bf16 v224, v67, v147
  v_dot2c_f32_bf16 v225, v77, v147
  v_dot2c_f32_bf16 v226, v87, v147
  v_dot2c_f32_bf16 v227, v97, v147
  v_dot2c_f32_bf16 v228, v107, v147
  v_dot2c_f32_bf16 v224, v68, v148
  v_dot2c_f32_bf16 v225, v78, v148
  v_dot2c_f32_bf16 v226, v88, v148
  v_dot2c_f32_bf16 v227, v98, v148
  v_dot2c_f32_bf16 v228, v108, v148
  v_dot2c_f32_bf16 v224, v69, v149
  v_dot2c_f32_bf16 v225, v79, v149
  v_dot2c_f32_bf16 v226, v89, v149
  v_dot2c_f32_bf16 v227, v99, v149
  v_dot2c_f32_bf16 v228, v109, v149
  v_dot2c_f32_bf16 v224, v70, v150
  v_dot2c_f32_bf16 v225, v80, v150
  v_dot2c_f32_bf16 v226, v90, v150
  v_dot2c_f32_bf16 v227, v100, v150
  v_dot2c_f32_bf16 v228, v110, v150
  v_dot2c_f32_bf16 v224, v71, v151
  v_dot2c_f32_bf16 v225, v81, v151
  v_dot2c_f32_bf16 v226, v91, v151
  v_dot2c_f32_bf16 v227, v101, v151
  v_dot2c_f32_bf16 v228, v111, v151
  v_dot2c_f32_bf16 v224, v72, v152
  v_dot2c_f32_bf16 v225, v82, v152
  v_dot2c_f32_bf16 v226, v92, v152
  v_dot2c_f32_bf16 v227, v102, v152
  v_dot2c_f32_bf16 v228, v112, v152
  v_dot2c_f32_bf16 v224, v73, v153
  v_dot2c_f32_bf16 v225, v83, v153
  v_dot2c_f32_bf16 v226, v93, v153
  v_dot2c_f32_bf16 v227, v103, v153
  v_dot2c_f32_bf16 v228, v113, v153
  s_waitcnt lgkmcnt(0)
  v_dot2c_f32_bf16 v229, v114, v144
  v_dot2c_f32_bf16 v230, v124, v144
  v_dot2c_f32_bf16 v231, v134, v144
  v_dot2c_f32_bf16 v229, v115, v145
  v_dot2c_f32_bf16 v230, v125, v145
  v_dot2c_f32_bf16 v231, v135, v145
  v_dot2c_f32_bf16 v229, v116, v146
  v_dot2c_f32_bf16 v230, v126, v146
  v_dot2c_f32_bf16 v231, v136, v146
  v_dot2c_f32_bf16 v229, v117, v147
  v_dot2c_f32_bf16 v230, v127, v147
  v_dot2c_f32_bf16 v231, v137, v147
  v_dot2c_f32_bf16 v229, v118, v148
  v_dot2c_f32_bf16 v230, v128, v148
  v_dot2c_f32_bf16 v231, v138, v148
  v_dot2c_f32_bf16 v229, v119, v149
  v_dot2c_f32_bf16 v230, v129, v149
  v_dot2c_f32_bf16 v231, v139, v149
  v_dot2c_f32_bf16 v229, v120, v150
  v_dot2c_f32_bf16 v230, v130, v150
  v_dot2c_f32_bf16 v231, v140, v150
  v_dot2c_f32_bf16 v229, v121, v151
  v_dot2c_f32_bf16 v230, v131, v151
  v_dot2c_f32_bf16 v231, v141, v151
  v_dot2c_f32_bf16 v229, v122, v152
  v_dot2c_f32_bf16 v230, v132, v152
  v_dot2c_f32_bf16 v231, v142, v152
  v_dot2c_f32_bf16 v229, v123, v153
  v_dot2c_f32_bf16 v230, v133, v153
  v_dot2c_f32_bf16 v231, v143, v153
  ds_read_b64 v[64:65], v38 offset:2008
  ds_read_b64 v[66:67], v38 offset:2016
  ds_read_b64 v[68:69], v38 offset:2024
  ds_read_b64 v[70:71], v38 offset:2032
  ds_read_b64 v[72:73], v39 offset:2040
  ds_read_b64 v[74:75], v38 offset:1744
  ds_read_b64 v[76:77], v38 offset:1752
  ds_read_b64 v[78:79], v38 offset:1760
  ds_read_b64 v[80:81], v38 offset:1768
  ds_read_b64 v[82:83], v39 offset:1776
  ds_read_b64 v[84:85], v38 offset:1480
  ds_read_b64 v[86:87], v38 offset:1488
  ds_read_b64 v[88:89], v38 offset:1496
  ds_read_b64 v[90:91], v38 offset:1504
  ds_read_b64 v[92:93], v39 offset:1512
  ds_read_b64 v[94:95], v38 offset:1216
  ds_read_b64 v[96:97], v38 offset:1224
  ds_read_b64 v[98:99], v38 offset:1232
  ds_read_b64 v[100:101], v38 offset:1240
  ds_read_b64 v[102:103], v39 offset:1248
  ds_read_b64 v[104:105], v38 offset:952
  ds_read_b64 v[106:107], v38 offset:960
  ds_read_b64 v[108:109], v38 offset:968
  ds_read_b64 v[110:111], v38 offset:976
  ds_read_b64 v[112:113], v39 offset:984
  ds_read_b64 v[114:115], v38 offset:688
  ds_read_b64 v[116:117], v38 offset:696
  ds_read_b64 v[118:119], v38 offset:704
  ds_read_b64 v[120:121], v38 offset:712
  ds_read_b64 v[122:123], v39 offset:720
  ds_read_b64 v[124:125], v38 offset:424
  ds_read_b64 v[126:127], v38 offset:432
  ds_read_b64 v[128:129], v38 offset:440
  ds_read_b64 v[130:131], v38 offset:448
  ds_read_b64 v[132:133], v39 offset:456
  ds_read_b64 v[134:135], v38 offset:160
  ds_read_b64 v[136:137], v38 offset:168
  ds_read_b64 v[138:139], v38 offset:176
  ds_read_b64 v[140:141], v38 offset:184
  ds_read_b64 v[142:143], v39 offset:192
  v_cvt_pk_bf16_f32 v4, v224, v225
  v_lshlrev_b32 v224, 16, v4
  v_and_b32 v225, 0xffff0000, v4
  v_mul_f32 v224, s60, v224
  v_mul_f32 v225, s60, v225
  v_cvt_pk_bf16_f32 v4, v224, v225
  v_lshlrev_b32 v224, 16, v4
  v_and_b32 v225, 0xffff0000, v4
  v_cndmask_b32 v224, v37, v224, s[76:77]
  v_cndmask_b32 v225, v37, v225, s[78:79]
  v_cvt_pk_bf16_f32 v4, v226, v227
  v_lshlrev_b32 v226, 16, v4
  v_and_b32 v227, 0xffff0000, v4
  v_mul_f32 v226, s60, v226
  v_mul_f32 v227, s60, v227
  v_cvt_pk_bf16_f32 v4, v226, v227
  v_lshlrev_b32 v226, 16, v4
  v_and_b32 v227, 0xffff0000, v4
  v_cndmask_b32 v226, v37, v226, s[80:81]
  v_cndmask_b32 v227, v37, v227, s[82:83]
  v_cvt_pk_bf16_f32 v4, v228, v229
  v_lshlrev_b32 v228, 16, v4
  v_and_b32 v229, 0xffff0000, v4
  v_mul_f32 v228, s60, v228
  v_mul_f32 v229, s60, v229
  v_cvt_pk_bf16_f32 v4, v228, v229
  v_lshlrev_b32 v228, 16, v4
  v_and_b32 v229, 0xffff0000, v4
  v_cndmask_b32 v228, v37, v228, s[84:85]
  v_cndmask_b32 v229, v37, v229, s[86:87]
  v_cvt_pk_bf16_f32 v4, v230, v231
  v_lshlrev_b32 v230, 16, v4
  v_and_b32 v231, 0xffff0000, v4
  v_mul_f32 v230, s60, v230
  v_mul_f32 v231, s60, v231
  v_cvt_pk_bf16_f32 v4, v230, v231
  v_lshlrev_b32 v230, 16, v4
  v_and_b32 v231, 0xffff0000, v4
  v_cndmask_b32 v230, v37, v230, s[88:89]
  v_cndmask_b32 v231, v37, v231, s[90:91]
  v_max3_f32 v5, v224, v225, v226
  v_max3_f32 v5, v5, v227, v228
  v_max3_f32 v5, v5, v229, v230
  v_max_f32 v5, v5, v231
  v_sub_f32 v224, v224, v5
  v_mul_f32 v224, s61, v224
  v_exp_f32 v224, v224
  v_sub_f32 v225, v225, v5
  v_mul_f32 v225, s61, v225
  v_exp_f32 v225, v225
  v_sub_f32 v226, v226, v5
  v_mul_f32 v226, s61, v226
  v_exp_f32 v226, v226
  v_sub_f32 v227, v227, v5
  v_mul_f32 v227, s61, v227
  v_exp_f32 v227, v227
  v_sub_f32 v228, v228, v5
  v_mul_f32 v228, s61, v228
  v_exp_f32 v228, v228
  v_sub_f32 v229, v229, v5
  v_mul_f32 v229, s61, v229
  v_exp_f32 v229, v229
  v_sub_f32 v230, v230, v5
  v_mul_f32 v230, s61, v230
  v_exp_f32 v230, v230
  v_sub_f32 v231, v231, v5
  v_mul_f32 v231, s61, v231
  v_exp_f32 v231, v231
  s_nop 0
  v_add_f32 v5, v224, v225
  v_add_f32 v5, v5, v226
  v_add_f32 v5, v5, v227
  v_add_f32 v5, v5, v228
  v_add_f32 v5, v5, v229
  v_add_f32 v5, v5, v230
  v_add_f32 v5, v5, v231
  v_rcp_f32 v5, v5
  s_nop 0
  v_mul_f32 v224, v224, v5
  v_mul_f32 v225, v225, v5
  v_mul_f32 v226, v226, v5
  v_mul_f32 v227, v227, v5
  v_mul_f32 v228, v228, v5
  v_mul_f32 v229, v229, v5
  v_mul_f32 v230, v230, v5
  v_mul_f32 v231, v231, v5
  v_cvt_pk_bf16_f32 v232, v224, v225
  v_cvt_pk_bf16_f32 v233, v226, v227
  v_cvt_pk_bf16_f32 v234, v228, v229
  v_cvt_pk_bf16_f32 v235, v230, v231
  s_waitcnt lgkmcnt(15)
  v_perm_b32 v236, v74, v64, s62
  v_perm_b32 v237, v74, v64, s63
  v_dot2c_f32_bf16 v192, v236, v232
  v_dot2c_f32_bf16 v193, v237, v232
  v_perm_b32 v238, v75, v65, s62
  v_perm_b32 v239, v75, v65, s63
  v_dot2c_f32_bf16 v194, v238, v232
  v_dot2c_f32_bf16 v195, v239, v232
  v_perm_b32 v240, v76, v66, s62
  v_perm_b32 v241, v76, v66, s63
  v_dot2c_f32_bf16 v196, v240, v232
  v_dot2c_f32_bf16 v197, v241, v232
  v_perm_b32 v242, v77, v67, s62
  v_perm_b32 v243, v77, v67, s63
  v_dot2c_f32_bf16 v198, v242, v232
  v_dot2c_f32_bf16 v199, v243, v232
  v_perm_b32 v236, v78, v68, s62
  v_perm_b32 v237, v78, v68, s63
  v_dot2c_f32_bf16 v200, v236, v232
  v_dot2c_f32_bf16 v201, v237, v232
  v_perm_b32 v238, v79, v69, s62
  v_perm_b32 v239, v79, v69, s63
  v_dot2c_f32_bf16 v202, v238, v232
  v_dot2c_f32_bf16 v203, v239, v232
  v_perm_b32 v240, v80, v70, s62
  v_perm_b32 v241, v80, v70, s63
  v_dot2c_f32_bf16 v204, v240, v232
  v_dot2c_f32_bf16 v205, v241, v232
  v_perm_b32 v242, v81, v71, s62
  v_perm_b32 v243, v81, v71, s63
  v_dot2c_f32_bf16 v206, v242, v232
  v_dot2c_f32_bf16 v207, v243, v232
  v_perm_b32 v236, v82, v72, s62
  v_perm_b32 v237, v82, v72, s63
  v_dot2c_f32_bf16 v208, v236, v232
  v_dot2c_f32_bf16 v209, v237, v232
  v_perm_b32 v238, v83, v73, s62
  v_perm_b32 v239, v83, v73, s63
  v_dot2c_f32_bf16 v210, v238, v232
  v_dot2c_f32_bf16 v211, v239, v232
  s_waitcnt lgkmcnt(15)
  v_perm_b32 v236, v94, v84, s62
  v_perm_b32 v237, v94, v84, s63
  v_dot2c_f32_bf16 v192, v236, v233
  v_dot2c_f32_bf16 v193, v237, v233
  v_perm_b32 v238, v95, v85, s62
  v_perm_b32 v239, v95, v85, s63
  v_dot2c_f32_bf16 v194, v238, v233
  v_dot2c_f32_bf16 v195, v239, v233
  v_perm_b32 v240, v96, v86, s62
  v_perm_b32 v241, v96, v86, s63
  v_dot2c_f32_bf16 v196, v240, v233
  v_dot2c_f32_bf16 v197, v241, v233
  v_perm_b32 v242, v97, v87, s62
  v_perm_b32 v243, v97, v87, s63
  v_dot2c_f32_bf16 v198, v242, v233
  v_dot2c_f32_bf16 v199, v243, v233
  v_perm_b32 v236, v98, v88, s62
  v_perm_b32 v237, v98, v88, s63
  v_dot2c_f32_bf16 v200, v236, v233
  v_dot2c_f32_bf16 v201, v237, v233
  v_perm_b32 v238, v99, v89, s62
  v_perm_b32 v239, v99, v89, s63
  v_dot2c_f32_bf16 v202, v238, v233
  v_dot2c_f32_bf16 v203, v239, v233
  v_perm_b32 v240, v100, v90, s62
  v_perm_b32 v241, v100, v90, s63
  v_dot2c_f32_bf16 v204, v240, v233
  v_dot2c_f32_bf16 v205, v241, v233
  v_perm_b32 v242, v101, v91, s62
  v_perm_b32 v243, v101, v91, s63
  v_dot2c_f32_bf16 v206, v242, v233
  v_dot2c_f32_bf16 v207, v243, v233
  v_perm_b32 v236, v102, v92, s62
  v_perm_b32 v237, v102, v92, s63
  v_dot2c_f32_bf16 v208, v236, v233
  v_dot2c_f32_bf16 v209, v237, v233
  v_perm_b32 v238, v103, v93, s62
  v_perm_b32 v239, v103, v93, s63
  v_dot2c_f32_bf16 v210, v238, v233
  v_dot2c_f32_bf16 v211, v239, v233
  s_waitcnt lgkmcnt(10)
  v_perm_b32 v236, v114, v104, s62
  v_perm_b32 v237, v114, v104, s63
  v_dot2c_f32_bf16 v192, v236, v234
  v_dot2c_f32_bf16 v193, v237, v234
  v_perm_b32 v238, v115, v105, s62
  v_perm_b32 v239, v115, v105, s63
  v_dot2c_f32_bf16 v194, v238, v234
  v_dot2c_f32_bf16 v195, v239, v234
  v_perm_b32 v240, v116, v106, s62
  v_perm_b32 v241, v116, v106, s63
  v_dot2c_f32_bf16 v196, v240, v234
  v_dot2c_f32_bf16 v197, v241, v234
  v_perm_b32 v242, v117, v107, s62
  v_perm_b32 v243, v117, v107, s63
  v_dot2c_f32_bf16 v198, v242, v234
  v_dot2c_f32_bf16 v199, v243, v234
  v_perm_b32 v236, v118, v108, s62
  v_perm_b32 v237, v118, v108, s63
  v_dot2c_f32_bf16 v200, v236, v234
  v_dot2c_f32_bf16 v201, v237, v234
  v_perm_b32 v238, v119, v109, s62
  v_perm_b32 v239, v119, v109, s63
  v_dot2c_f32_bf16 v202, v238, v234
  v_dot2c_f32_bf16 v203, v239, v234
  v_perm_b32 v240, v120, v110, s62
  v_perm_b32 v241, v120, v110, s63
  v_dot2c_f32_bf16 v204, v240, v234
  v_dot2c_f32_bf16 v205, v241, v234
  v_perm_b32 v242, v121, v111, s62
  v_perm_b32 v243, v121, v111, s63
  v_dot2c_f32_bf16 v206, v242, v234
  v_dot2c_f32_bf16 v207, v243, v234
  v_perm_b32 v236, v122, v112, s62
  v_perm_b32 v237, v122, v112, s63
  v_dot2c_f32_bf16 v208, v236, v234
  v_dot2c_f32_bf16 v209, v237, v234
  v_perm_b32 v238, v123, v113, s62
  v_perm_b32 v239, v123, v113, s63
  v_dot2c_f32_bf16 v210, v238, v234
  v_dot2c_f32_bf16 v211, v239, v234
  s_waitcnt lgkmcnt(0)
  v_perm_b32 v236, v134, v124, s62
  v_perm_b32 v237, v134, v124, s63
  v_dot2c_f32_bf16 v192, v236, v235
  v_dot2c_f32_bf16 v193, v237, v235
  v_perm_b32 v238, v135, v125, s62
  v_perm_b32 v239, v135, v125, s63
  v_dot2c_f32_bf16 v194, v238, v235
  v_dot2c_f32_bf16 v195, v239, v235
  v_perm_b32 v240, v136, v126, s62
  v_perm_b32 v241, v136, v126, s63
  v_dot2c_f32_bf16 v196, v240, v235
  v_dot2c_f32_bf16 v197, v241, v235
  v_perm_b32 v242, v137, v127, s62
  v_perm_b32 v243, v137, v127, s63
  v_dot2c_f32_bf16 v198, v242, v235
  v_dot2c_f32_bf16 v199, v243, v235
  v_perm_b32 v236, v138, v128, s62
  v_perm_b32 v237, v138, v128, s63
  v_dot2c_f32_bf16 v200, v236, v235
  v_dot2c_f32_bf16 v201, v237, v235
  v_perm_b32 v238, v139, v129, s62
  v_perm_b32 v239, v139, v129, s63
  v_dot2c_f32_bf16 v202, v238, v235
  v_dot2c_f32_bf16 v203, v239, v235
  v_perm_b32 v240, v140, v130, s62
  v_perm_b32 v241, v140, v130, s63
  v_dot2c_f32_bf16 v204, v240, v235
  v_dot2c_f32_bf16 v205, v241, v235
  v_perm_b32 v242, v141, v131, s62
  v_perm_b32 v243, v141, v131, s63
  v_dot2c_f32_bf16 v206, v242, v235
  v_dot2c_f32_bf16 v207, v243, v235
  v_perm_b32 v236, v142, v132, s62
  v_perm_b32 v237, v142, v132, s63
  v_dot2c_f32_bf16 v208, v236, v235
  v_dot2c_f32_bf16 v209, v237, v235
  v_perm_b32 v238, v143, v133, s62
  v_perm_b32 v239, v143, v133, s63
  v_dot2c_f32_bf16 v210, v238, v235
  v_dot2c_f32_bf16 v211, v239, v235
  s_cmp_lg_u32 s20, 0
  s_cbranch_scc1 bh_201
  ds_read_b64 v[64:65], v35 offset:33792
  ds_read_b64 v[66:67], v35 offset:34304
  ds_read_b64 v[68:69], v35 offset:34816
  ds_read_b64 v[70:71], v35 offset:35328
  ds_read_b64 v[72:73], v35 offset:35840
  s_waitcnt lgkmcnt(0)
  ds_write_b64 v35, v[64:65] offset:0
  ds_write_b64 v35, v[66:67] offset:512
  ds_write_b64 v35, v[68:69] offset:1024
  ds_write_b64 v35, v[70:71] offset:1536
  ds_write_b64 v35, v[72:73] offset:2048
bh_201:
  s_nop 1
  v_cvt_pk_bf16_f32 v244, v192, v193
  v_cvt_pk_bf16_f32 v245, v194, v195
  v_cvt_pk_bf16_f32 v246, v196, v197
  v_cvt_pk_bf16_f32 v247, v198, v199
  v_cvt_pk_bf16_f32 v248, v200, v201
  v_cvt_pk_bf16_f32 v249, v202, v203
  v_cvt_pk_bf16_f32 v250, v204, v205
  v_cvt_pk_bf16_f32 v251, v206, v207
  v_cvt_pk_bf16_f32 v252, v208, v209
  v_cvt_pk_bf16_f32 v253, v210, v211
  buffer_store_dwordx4 v[244:247], v29, s[16:19], s27 offen sc1
  buffer_store_dwordx4 v[248:251], v30, s[16:19], s27 offen sc1
  buffer_store_dwordx2 v[252:253], v31, s[16:19], s27 offen sc1
  s_add_u32 s27, s27, 2048
  s_mov_b64 s[78:79], -1
  s_mov_b64 s[80:81], -1
  s_mov_b64 s[82:83], -1
  s_mov_b64 s[84:85], -1
  s_mov_b64 s[86:87], -1
  s_mov_b64 s[88:89], -1
  s_mov_b64 s[90:91], -1
  s_sub_u32 s26, s26, 1
  s_cmp_gt_u32 s26, 0
  s_waitcnt lgkmcnt(0)
  s_cbranch_scc1 bf_blk_199
  s_waitcnt vmcnt(0) lgkmcnt(0)
  s_load_dwordx2 s[32:33], s[0:1], 96
  s_waitcnt lgkmcnt(0)
  s_mov_b32 s32, s32
  s_mov_b32 s33, s33
  s_mov_b32 s34, 256
  s_mov_b32 s35, 0x00020000
  s_mov_b32 s21, 76
  s_cmp_lg_u32 s20, 0
  s_cbranch_scc1 wf_203
  v_mov_b32 v4, 0
  s_mov_b32 s101, 0
wf_202:
  buffer_load_dword v5, v4, s[32:35], s21 offen sc1
  s_add_u32 s101, s101, 1
  s_cmp_gt_u32 s101, 131072
  s_cbranch_scc1 main_end
  s_waitcnt vmcnt(0)
  v_readfirstlane_b32 s100, v5
  s_cmp_ge_u32 s100, 32
  s_cbranch_scc1 wf_203
  s_sleep 8
  s_branch wf_202
wf_203:
  s_barrier
  s_load_dwordx2 s[12:13], s[0:1], 72
  s_lshl_b32 s21, s2, 2
  s_add_u32 s21, s21, s20
  s_mul_i32 s21, s21, 6400
  s_add_u32 s22, s21, 4096
  v_lshlrev_b32 v5, 4, v1
  s_mov_b32 s14, 819200
  s_waitcnt lgkmcnt(0)
  buffer_load_dwordx4 v[40:43], v5, s[12:15], s21 offen offset:0
  buffer_load_dwordx4 v[40:43], v5, s[12:15], s21 offen offset:1024
  buffer_load_dwordx4 v[40:43], v5, s[12:15], s21 offen offset:2048
  buffer_load_dwordx4 v[40:43], v5, s[12:15], s21 offen offset:3072
  buffer_load_dwordx4 v[40:43], v5, s[12:15], s22 offen offset:0
  buffer_load_dwordx4 v[40:43], v5, s[12:15], s22 offen offset:1024
  buffer_load_dwordx4 v[40:43], v5, s[12:15], s22 offen offset:2048
  s_mov_b32 s21, 91136
  s_cmp_lg_u32 s20, 0
  s_cbranch_scc1 af_204
  v_mov_b32 v4, 0
  v_mov_b32 v5, 1
  s_mov_b64 exec, 1
  buffer_atomic_add v5, v4, s[72:75], s21 offen sc1
  s_mov_b64 exec, -1
  s_nop 1
af_204:
  s_barrier
  s_mov_b32 s84, 0
  s_mov_b32 s85, -1
  s_load_dwordx2 s[4:5], s[0:1], 0
  s_load_dwordx2 s[6:7], s[0:1], 16
  s_load_dwordx2 s[38:39], s[0:1], 104
  s_mov_b32 s42, s2
  s_mov_b32 s41, 0
  s_waitcnt lgkmcnt(0)
  s_mov_b32 s8, s4
  s_mov_b32 s9, s5
  s_mov_b32 s10, 2621440
  s_mov_b32 s11, 0x00020000
  s_mov_b32 s12, s6
  s_mov_b32 s13, s7
  s_mov_b32 s14, 7864320
  s_mov_b32 s15, 0x00020000
  s_mov_b32 s16, s38
  s_mov_b32 s17, s39
  s_mov_b32 s18, 50331648
  s_mov_b32 s19, 0x00020000
  s_add_u32 s52, s38, 50331648
  s_addc_u32 s53, s39, 0
  s_mov_b32 s54, 6291456
  s_mov_b32 s55, 0x00020000
  s_add_u32 s56, s38, 85983232
  s_addc_u32 s57, s39, 0
  s_mov_b32 s58, 6815744
  s_mov_b32 s59, 0x00020000
  s_load_dwordx2 s[72:73], s[0:1], 104
  s_waitcnt lgkmcnt(0)
  s_add_u32 s72, s72, 81068032
  s_addc_u32 s73, s73, 0
  s_mov_b32 s74, 116736
  s_mov_b32 s75, 0x00020000
  s_mul_i32 s44, s42, 384
  v_mov_b32 v9, 2731
  v_add_u32 v8, 0, v1
  v_mul_u32_u24 v7, v8, v9
  v_lshrrev_b32 v7, 16, v7
  v_mul_u32_u24 v4, 24, v7
  v_sub_u32 v8, v8, v4
  s_mov_b32 s21, 12288
  v_mul_lo_u32 v7, v7, s21
  v_lshl_add_u32 v4, v8, 4, v7
  v_add_u32 v8, 64, v1
  v_mul_u32_u24 v7, v8, v9
  v_lshrrev_b32 v7, 16, v7
  v_mul_u32_u24 v5, 24, v7
  v_sub_u32 v8, v8, v5
  s_mov_b32 s21, 12288
  v_mul_lo_u32 v7, v7, s21
  v_lshl_add_u32 v5, v8, 4, v7
  v_add_u32 v8, 128, v1
  v_mul_u32_u24 v7, v8, v9
  v_lshrrev_b32 v7, 16, v7
  v_mul_u32_u24 v6, 24, v7
  v_sub_u32 v8, v8, v6
  s_mov_b32 s21, 12288
  v_mul_lo_u32 v7, v7, s21
  v_lshl_add_u32 v6, v8, 4, v7
  v_lshrrev_b32 v7, 2, v2
  v_lshl_add_u32 v7, v3, 3, v7
  v_mul_u32_u24 v7, 384, v7
  v_and_b32 v8, 3, v2
  v_lshlrev_b32 v8, 3, v8
  s_mul_i32 s21, s20, 96
  v_add3_u32 v7, v7, v8, s21
  v_add_u32 v8, 61440, v7
  s_mul_i32 s21, s20, 491520
  s_add_u32 s21, s21, 0
  s_add_u32 s21, s21, s44
  s_mul_i32 s22, s20, 15360
  s_add_u32 s22, s22, 0
  s_add_u32 m0, s22, 0
  s_nop 0
  buffer_load_dwordx4 v4, s[12:15], s21 offen lds
  s_add_u32 m0, s22, 1024
  s_nop 0
  buffer_load_dwordx4 v5, s[12:15], s21 offen lds
  s_add_u32 m0, s22, 2048
  s_nop 0
  buffer_load_dwordx4 v6, s[12:15], s21 offen lds
  s_mul_i32 s21, s20, 491520
  s_add_u32 s21, s21, 98304
  s_add_u32 s21, s21, s44
  s_mul_i32 s22, s20, 15360
  s_add_u32 s22, s22, 3072
  s_add_u32 m0, s22, 0
  s_nop 0
  buffer_load_dwordx4 v4, s[12:15], s21 offen lds
  s_add_u32 m0, s22, 1024
  s_nop 0
  buffer_load_dwordx4 v5, s[12:15], s21 offen lds
  s_add_u32 m0, s22, 2048
  s_nop 0
  buffer_load_dwordx4 v6, s[12:15], s21 offen lds
  s_mul_i32 s21, s20, 491520
  s_add_u32 s21, s21, 196608
  s_add_u32 s21, s21, s44
  s_mul_i32 s22, s20, 15360
  s_add_u32 s22, s22, 6144
  s_add_u32 m0, s22, 0
  s_nop 0
  buffer_load_dwordx4 v4, s[12:15], s21 offen lds
  s_add_u32 m0, s22, 1024
  s_nop 0
  buffer_load_dwordx4 v5, s[12:15], s21 offen lds
  s_add_u32 m0, s22, 2048
  s_nop 0
  buffer_load_dwordx4 v6, s[12:15], s21 offen lds
  s_mul_i32 s21, s20, 491520
  s_add_u32 s21, s21, 294912
  s_add_u32 s21, s21, s44
  s_mul_i32 s22, s20, 15360
  s_add_u32 s22, s22, 9216
  s_add_u32 m0, s22, 0
  s_nop 0
  buffer_load_dwordx4 v4, s[12:15], s21 offen lds
  s_add_u32 m0, s22, 1024
  s_nop 0
  buffer_load_dwordx4 v5, s[12:15], s21 offen lds
  s_add_u32 m0, s22, 2048
  s_nop 0
  buffer_load_dwordx4 v6, s[12:15], s21 offen lds
  s_mul_i32 s21, s20, 491520
  s_add_u32 s21, s21, 393216
  s_add_u32 s21, s21, s44
  s_mul_i32 s22, s20, 15360
  s_add_u32 s22, s22, 12288
  s_add_u32 m0, s22, 0
  s_nop 0
  buffer_load_dwordx4 v4, s[12:15], s21 offen lds
  s_add_u32 m0, s22, 1024
  s_nop 0
  buffer_load_dwordx4 v5, s[12:15], s21 offen lds
  s_add_u32 m0, s22, 2048
  s_nop 0
  buffer_load_dwordx4 v6, s[12:15], s21 offen lds
  s_mul_i32 s21, s20, 491520
  s_add_u32 s21, s21, 1966080
  s_add_u32 s21, s21, s44
  s_mul_i32 s22, s20, 15360
  s_add_u32 s22, s22, 61440
  s_add_u32 m0, s22, 0
  s_nop 0
  buffer_load_dwordx4 v4, s[12:15], s21 offen lds
  s_add_u32 m0, s22, 1024
  s_nop 0
  buffer_load_dwordx4 v5, s[12:15], s21 offen lds
  s_add_u32 m0, s22, 2048
  s_nop 0
  buffer_load_dwordx4 v6, s[12:15], s21 offen lds
  s_mul_i32 s21, s20, 491520
  s_add_u32 s21, s21, 2064384
  s_add_u32 s21, s21, s44
  s_mul_i32 s22, s20, 15360
  s_add_u32 s22, s22, 64512
  s_add_u32 m0, s22, 0
  s_nop 0
  buffer_load_dwordx4 v4, s[12:15], s21 offen lds
  s_add_u32 m0, s22, 1024
  s_nop 0
  buffer_load_dwordx4 v5, s[12:15], s21 offen lds
  s_add_u32 m0, s22, 2048
  s_nop 0
  buffer_load_dwordx4 v6, s[12:15], s21 offen lds
  s_mul_i32 s21, s20, 491520
  s_add_u32 s21, s21, 2162688
  s_add_u32 s21, s21, s44
  s_mul_i32 s22, s20, 15360
  s_add_u32 s22, s22, 67584
  s_add_u32 m0, s22, 0
  s_nop 0
  buffer_load_dwordx4 v4, s[12:15], s21 offen lds
  s_add_u32 m0, s22, 1024
  s_nop 0
  buffer_load_dwordx4 v5, s[12:15], s21 offen lds
  s_add_u32 m0, s22, 2048
  s_nop 0
  buffer_load_dwordx4 v6, s[12:15], s21 offen lds
  s_mul_i32 s21, s20, 491520
  s_add_u32 s21, s21, 2260992
  s_add_u32 s21, s21, s44
  s_mul_i32 s22, s20, 15360
  s_add_u32 s22, s22, 70656
  s_add_u32 m0, s22, 0
  s_nop 0
  buffer_load_dwordx4 v4, s[12:15], s21 offen lds
  s_add_u32 m0, s22, 1024
  s_nop 0
  buffer_load_dwordx4 v5, s[12:15], s21 offen lds
  s_add_u32 m0, s22, 2048
  s_nop 0
  buffer_load_dwordx4 v6, s[12:15], s21 offen lds
  s_mul_i32 s21, s20, 491520
  s_add_u32 s21, s21, 2359296
  s_add_u32 s21, s21, s44
  s_mul_i32 s22, s20, 15360
  s_add_u32 s22, s22, 73728
  s_add_u32 m0, s22, 0
  s_nop 0
  buffer_load_dwordx4 v4, s[12:15], s21 offen lds
  s_add_u32 m0, s22, 1024
  s_nop 0
  buffer_load_dwordx4 v5, s[12:15], s21 offen lds
  s_add_u32 m0, s22, 2048
  s_nop 0
  buffer_load_dwordx4 v6, s[12:15], s21 offen lds
  s_mul_i32 s21, s20, 491520
  s_add_u32 s21, s21, 3932160
  s_add_u32 s21, s21, s44
  buffer_load_dwordx4 v[64:67], v4, s[12:15], s21 offen
  buffer_load_dwordx4 v[68:71], v5, s[12:15], s21 offen
  buffer_load_dwordx4 v[72:75], v6, s[12:15], s21 offen
  s_mul_i32 s21, s20, 491520
  s_add_u32 s21, s21, 4030464
  s_add_u32 s21, s21, s44
  buffer_load_dwordx4 v[76:79], v4, s[12:15], s21 offen
  buffer_load_dwordx4 v[80:83], v5, s[12:15], s21 offen
  buffer_load_dwordx4 v[84:87], v6, s[12:15], s21 offen
  s_mul_i32 s21, s20, 491520
  s_add_u32 s21, s21, 4128768
  s_add_u32 s21, s21, s44
  buffer_load_dwordx4 v[88:91], v4, s[12:15], s21 offen
  buffer_load_dwordx4 v[92:95], v5, s[12:15], s21 offen
  buffer_load_dwordx4 v[96:99], v6, s[12:15], s21 offen
  s_mul_i32 s21, s20, 491520
  s_add_u32 s21, s21, 4227072
  s_add_u32 s21, s21, s44
  buffer_load_dwordx4 v[100:103], v4, s[12:15], s21 offen
  buffer_load_dwordx4 v[104:107], v5, s[12:15], s21 offen
  buffer_load_dwordx4 v[108:111], v6, s[12:15], s21 offen
  s_mul_i32 s21, s20, 491520
  s_add_u32 s21, s21, 4325376
  s_add_u32 s21, s21, s44
  buffer_load_dwordx4 v[112:115], v4, s[12:15], s21 offen
  buffer_load_dwordx4 v[116:119], v5, s[12:15], s21 offen
  buffer_load_dwordx4 v[120:123], v6, s[12:15], s21 offen
  s_mul_i32 s21, s20, 491520
  s_add_u32 s21, s21, 5898240
  s_add_u32 s21, s21, s44
  buffer_load_dwordx4 v[124:127], v4, s[12:15], s21 offen
  buffer_load_dwordx4 v[128:131], v5, s[12:15], s21 offen
  buffer_load_dwordx4 v[132:135], v6, s[12:15], s21 offen
  s_mul_i32 s21, s20, 491520
  s_add_u32 s21, s21, 5996544
  s_add_u32 s21, s21, s44
  buffer_load_dwordx4 v[136:139], v4, s[12:15], s21 offen
  buffer_load_dwordx4 v[140:143], v5, s[12:15], s21 offen
  buffer_load_dwordx4 v[144:147], v6, s[12:15], s21 offen
  s_mul_i32 s21, s20, 491520
  s_add_u32 s21, s21, 6094848
  s_add_u32 s21, s21, s44
  buffer_load_dwordx4 v[148:151], v4, s[12:15], s21 offen
  buffer_load_dwordx4 v[152:155], v5, s[12:15], s21 offen
  buffer_load_dwordx4 v[156:159], v6, s[12:15], s21 offen
  s_mul_i32 s21, s20, 491520
  s_add_u32 s21, s21, 6193152
  s_add_u32 s21, s21, s44
  buffer_load_dwordx4 v[160:163], v4, s[12:15], s21 offen
  buffer_load_dwordx4 v[164:167], v5, s[12:15], s21 offen
  buffer_load_dwordx4 v[168:171], v6, s[12:15], s21 offen
  s_mul_i32 s21, s20, 491520
  s_add_u32 s21, s21, 6291456
  s_add_u32 s21, s21, s44
  buffer_load_dwordx4 v[172:175], v4, s[12:15], s21 offen
  buffer_load_dwordx4 v[176:179], v5, s[12:15], s21 offen
  buffer_load_dwordx4 v[180:183], v6, s[12:15], s21 offen
  s_mul_i32 s22, s20, 15360
  v_lshl_add_u32 v30, v1, 4, s22
  v_add_u32 v31, 61440, v30
  s_waitcnt vmcnt(45)
  s_barrier
  ds_read_b64_tr_b16 a[0:1], v7 offset:0
  ds_read_b64_tr_b16 a[2:3], v7 offset:1536
  ds_read_b64_tr_b16 a[4:5], v7 offset:32
  ds_read_b64_tr_b16 a[6:7], v7 offset:1568
  ds_read_b64_tr_b16 a[8:9], v7 offset:64
  ds_read_b64_tr_b16 a[10:11], v7 offset:1600
  ds_read_b64_tr_b16 a[12:13], v7 offset:12288
  ds_read_b64_tr_b16 a[14:15], v7 offset:13824
  ds_read_b64_tr_b16 a[16:17], v7 offset:12320
  ds_read_b64_tr_b16 a[18:19], v7 offset:13856
  ds_read_b64_tr_b16 a[20:21], v7 offset:12352
  ds_read_b64_tr_b16 a[22:23], v7 offset:13888
  ds_read_b64_tr_b16 a[24:25], v7 offset:24576
  ds_read_b64_tr_b16 a[26:27], v7 offset:26112
  ds_read_b64_tr_b16 a[28:29], v7 offset:24608
  ds_read_b64_tr_b16 a[30:31], v7 offset:26144
  ds_read_b64_tr_b16 a[32:33], v7 offset:24640
  ds_read_b64_tr_b16 a[34:35], v7 offset:26176
  ds_read_b64_tr_b16 a[36:37], v7 offset:36864
  ds_read_b64_tr_b16 a[38:39], v7 offset:38400
  ds_read_b64_tr_b16 a[40:41], v7 offset:36896
  ds_read_b64_tr_b16 a[42:43], v7 offset:38432
  ds_read_b64_tr_b16 a[44:45], v7 offset:36928
  ds_read_b64_tr_b16 a[46:47], v7 offset:38464
  ds_read_b64_tr_b16 a[48:49], v7 offset:49152
  ds_read_b64_tr_b16 a[50:51], v7 offset:50688
  ds_read_b64_tr_b16 a[52:53], v7 offset:49184
  ds_read_b64_tr_b16 a[54:55], v7 offset:50720
  ds_read_b64_tr_b16 a[56:57], v7 offset:49216
  ds_read_b64_tr_b16 a[58:59], v7 offset:50752
  s_waitcnt lgkmcnt(0)
  s_barrier
  s_waitcnt vmcnt(30)
  s_barrier
  ds_read_b64_tr_b16 a[60:61], v8 offset:0
  ds_read_b64_tr_b16 a[62:63], v8 offset:1536
  ds_read_b64_tr_b16 a[64:65], v8 offset:32
  ds_read_b64_tr_b16 a[66:67], v8 offset:1568
  ds_read_b64_tr_b16 a[68:69], v8 offset:64
  ds_read_b64_tr_b16 a[70:71], v8 offset:1600
  ds_read_b64_tr_b16 a[72:73], v8 offset:12288
  ds_read_b64_tr_b16 a[74:75], v8 offset:13824
  ds_read_b64_tr_b16 a[76:77], v8 offset:12320
  ds_read_b64_tr_b16 a[78:79], v8 offset:13856
  ds_read_b64_tr_b16 a[80:81], v8 offset:12352
  ds_read_b64_tr_b16 a[82:83], v8 offset:13888
  ds_read_b64_tr_b16 a[84:85], v8 offset:24576
  ds_read_b64_tr_b16 a[86:87], v8 offset:26112
  ds_read_b64_tr_b16 a[88:89], v8 offset:24608
  ds_read_b64_tr_b16 a[90:91], v8 offset:26144
  ds_read_b64_tr_b16 a[92:93], v8 offset:24640
  ds_read_b64_tr_b16 a[94:95], v8 offset:26176
  ds_read_b64_tr_b16 a[96:97], v8 offset:36864
  ds_read_b64_tr_b16 a[98:99], v8 offset:38400
  ds_read_b64_tr_b16 a[100:101], v8 offset:36896
  ds_read_b64_tr_b16 a[102:103], v8 offset:38432
  ds_read_b64_tr_b16 a[104:105], v8 offset:36928
  ds_read_b64_tr_b16 a[106:107], v8 offset:38464
  ds_read_b64_tr_b16 a[108:109], v8 offset:49152
  ds_read_b64_tr_b16 a[110:111], v8 offset:50688
  ds_read_b64_tr_b16 a[112:113], v8 offset:49184
  ds_read_b64_tr_b16 a[114:115], v8 offset:50720
  ds_read_b64_tr_b16 a[116:117], v8 offset:49216
  ds_read_b64_tr_b16 a[118:119], v8 offset:50752
  s_waitcnt lgkmcnt(0)
  s_barrier
  s_waitcnt vmcnt(15)
  ds_write_b128 v30, v[64:67] offset:0
  ds_write_b128 v30, v[68:71] offset:1024
  ds_write_b128 v30, v[72:75] offset:2048
  ds_write_b128 v30, v[76:79] offset:3072
  ds_write_b128 v30, v[80:83] offset:4096
  ds_write_b128 v30, v[84:87] offset:5120
  ds_write_b128 v30, v[88:91] offset:6144
  ds_write_b128 v30, v[92:95] offset:7168
  ds_write_b128 v30, v[96:99] offset:8192
  ds_write_b128 v30, v[100:103] offset:9216
  ds_write_b128 v30, v[104:107] offset:10240
  ds_write_b128 v30, v[108:111] offset:11264
  ds_write_b128 v30, v[112:115] offset:12288
  ds_write_b128 v30, v[116:119] offset:13312
  ds_write_b128 v30, v[120:123] offset:14336
  s_waitcnt lgkmcnt(0)
  s_barrier
  ds_read_b64_tr_b16 a[120:121], v7 offset:0
  ds_read_b64_tr_b16 a[122:123], v7 offset:1536
  ds_read_b64_tr_b16 a[124:125], v7 offset:32
  ds_read_b64_tr_b16 a[126:127], v7 offset:1568
  ds_read_b64_tr_b16 a[128:129], v7 offset:64
  ds_read_b64_tr_b16 a[130:131], v7 offset:1600
  ds_read_b64_tr_b16 a[132:133], v7 offset:12288
  ds_read_b64_tr_b16 a[134:135], v7 offset:13824
  ds_read_b64_tr_b16 a[136:137], v7 offset:12320
  ds_read_b64_tr_b16 a[138:139], v7 offset:13856
  ds_read_b64_tr_b16 a[140:141], v7 offset:12352
  ds_read_b64_tr_b16 a[142:143], v7 offset:13888
  ds_read_b64_tr_b16 a[144:145], v7 offset:24576
  ds_read_b64_tr_b16 a[146:147], v7 offset:26112
  ds_read_b64_tr_b16 a[148:149], v7 offset:24608
  ds_read_b64_tr_b16 a[150:151], v7 offset:26144
  ds_read_b64_tr_b16 a[152:153], v7 offset:24640
  ds_read_b64_tr_b16 a[154:155], v7 offset:26176
  ds_read_b64_tr_b16 a[156:157], v7 offset:36864
  ds_read_b64_tr_b16 a[158:159], v7 offset:38400
  ds_read_b64_tr_b16 a[160:161], v7 offset:36896
  ds_read_b64_tr_b16 a[162:163], v7 offset:38432
  ds_read_b64_tr_b16 a[164:165], v7 offset:36928
  ds_read_b64_tr_b16 a[166:167], v7 offset:38464
  ds_read_b64_tr_b16 a[168:169], v7 offset:49152
  ds_read_b64_tr_b16 a[170:171], v7 offset:50688
  ds_read_b64_tr_b16 a[172:173], v7 offset:49184
  ds_read_b64_tr_b16 a[174:175], v7 offset:50720
  ds_read_b64_tr_b16 a[176:177], v7 offset:49216
  ds_read_b64_tr_b16 a[178:179], v7 offset:50752
  s_waitcnt lgkmcnt(0)
  s_barrier
  s_waitcnt vmcnt(0)
  ds_write_b128 v31, v[124:127] offset:0
  ds_write_b128 v31, v[128:131] offset:1024
  ds_write_b128 v31, v[132:135] offset:2048
  ds_write_b128 v31, v[136:139] offset:3072
  ds_write_b128 v31, v[140:143] offset:4096
  ds_write_b128 v31, v[144:147] offset:5120
  ds_write_b128 v31, v[148:151] offset:6144
  ds_write_b128 v31, v[152:155] offset:7168
  ds_write_b128 v31, v[156:159] offset:8192
  ds_write_b128 v31, v[160:163] offset:9216
  ds_write_b128 v31, v[164:167] offset:10240
  ds_write_b128 v31, v[168:171] offset:11264
  ds_write_b128 v31, v[172:175] offset:12288
  ds_write_b128 v31, v[176:179] offset:13312
  ds_write_b128 v31, v[180:183] offset:14336
  s_waitcnt lgkmcnt(0)
  s_barrier
  ds_read_b64_tr_b16 a[180:181], v8 offset:0
  ds_read_b64_tr_b16 a[182:183], v8 offset:1536
  ds_read_b64_tr_b16 a[184:185], v8 offset:32
  ds_read_b64_tr_b16 a[186:187], v8 offset:1568
  ds_read_b64_tr_b16 a[188:189], v8 offset:64
  ds_read_b64_tr_b16 a[190:191], v8 offset:1600
  ds_read_b64_tr_b16 a[192:193], v8 offset:12288
  ds_read_b64_tr_b16 a[194:195], v8 offset:13824
  ds_read_b64_tr_b16 a[196:197], v8 offset:12320
  ds_read_b64_tr_b16 a[198:199], v8 offset:13856
  ds_read_b64_tr_b16 a[200:201], v8 offset:12352
  ds_read_b64_tr_b16 a[202:203], v8 offset:13888
  ds_read_b64_tr_b16 a[204:205], v8 offset:24576
  ds_read_b64_tr_b16 a[206:207], v8 offset:26112
  ds_read_b64_tr_b16 a[208:209], v8 offset:24608
  ds_read_b64_tr_b16 a[210:211], v8 offset:26144
  ds_read_b64_tr_b16 a[212:213], v8 offset:24640
  ds_read_b64_tr_b16 a[214:215], v8 offset:26176
  ds_read_b64_tr_b16 a[216:217], v8 offset:36864
  ds_read_b64_tr_b16 a[218:219], v8 offset:38400
  ds_read_b64_tr_b16 a[220:221], v8 offset:36896
  ds_read_b64_tr_b16 a[222:223], v8 offset:38432
  ds_read_b64_tr_b16 a[224:225], v8 offset:36928
  ds_read_b64_tr_b16 a[226:227], v8 offset:38464
  ds_read_b64_tr_b16 a[228:229], v8 offset:49152
  ds_read_b64_tr_b16 a[230:231], v8 offset:50688
  ds_read_b64_tr_b16 a[232:233], v8 offset:49184
  ds_read_b64_tr_b16 a[234:235], v8 offset:50720
  ds_read_b64_tr_b16 a[236:237], v8 offset:49216
  ds_read_b64_tr_b16 a[238:239], v8 offset:50752
  s_waitcnt lgkmcnt(0)
  s_barrier
  s_mul_i32 s21, s20, 12800
  s_add_u32 s21, s21, 98304
  v_mul_u32_u24 v4, 400, v2
  v_lshlrev_b32 v5, 4, v3
  v_add3_u32 v29, v4, v5, s21
  v_lshlrev_b32 v30, 4, v1
  v_and_b32 v4, 1, v2
  v_bfe_u32 v5, v2, 1, 1
  v_lshl_or_b32 v4, v5, 2, v4
  v_bfe_u32 v5, v2, 2, 1
  v_lshl_or_b32 v4, v5, 1, v4
  v_lshlrev_b32 v4, 4, v4
  v_lshl_add_u32 v31, v3, 7, v4
  v_lshlrev_b32 v32, 3, v1
  v_and_b32 v4, 3, v1
  v_lshlrev_b32 v33, 3, v4
  v_mov_b32 v34, 0xf149f2ca
  v_lshlrev_b32 v4, 2, v3
  v_sub_u32 v35, v2, v4
  v_cmp_gt_u32 s[60:61], 2, v3
  s_mov_b32 s62, 0x3d93cd3a
  s_mov_b32 s63, 0x3fb8aa3b
  s_mov_b32 s83, 0x3dd53b95
  v_cmp_le_i32 s[64:65], 0, v35
  v_cmp_le_i32 s[66:67], 1, v35
  v_cmp_le_i32 s[68:69], 2, v35
  v_cmp_le_i32 s[70:71], 3, v35
  s_mov_b32 s24, 0
  s_mov_b32 s25, 163840
  s_mov_b32 s26, 13
  s_lshl_b32 s49, s41, 2
  s_add_u32 s49, s49, s20
  s_mov_b32 s29, 4
  s_mov_b32 s78, 0
  s_mov_b32 s81, 0x80000000
  s_mov_b32 s82, 0
  v_lshrrev_b32 v11, 3, v1
  v_and_b32 v12, 7, v1
  v_xor_b32 v12, v12, v11
  v_mul_u32_u24 v11, 1280, v11
  v_lshl_add_u32 v10, v12, 4, v11
  s_mul_i32 s46, s20, 40960
  v_add_u32 v10, s46, v10
  s_lshl_b32 s47, s20, 12
  s_add_u32 s47, s47, 0
  s_add_u32 s46, s47, 98304
  s_mov_b32 s30, s24
  s_add_u32 s32, s47, 0
  v_add_u32 v11, 9216, v10
  v_add_u32 v12, 18432, v10
  v_add_u32 v13, 27648, v10
  s_mov_b32 m0, s32
  s_nop 0
  buffer_load_dwordx4 v10, s[8:11], s30 offen offset:0 lds
  buffer_load_dwordx4 v11, s[8:11], s30 offen offset:1024 lds
  buffer_load_dwordx4 v12, s[8:11], s30 offen offset:2048 lds
  buffer_load_dwordx4 v13, s[8:11], s30 offen offset:3072 lds
  s_add_u32 s30, s30, 128
  s_add_u32 s32, s32, 16384
  s_cmp_lt_u32 s32, s46
  s_cselect_b32 s32, s32, s47
  s_mov_b32 m0, s32
  s_nop 0
  buffer_load_dwordx4 v10, s[8:11], s30 offen offset:0 lds
  buffer_load_dwordx4 v11, s[8:11], s30 offen offset:1024 lds
  buffer_load_dwordx4 v12, s[8:11], s30 offen offset:2048 lds
  buffer_load_dwordx4 v13, s[8:11], s30 offen offset:3072 lds
  s_add_u32 s30, s30, 128
  s_add_u32 s32, s32, 16384
  s_cmp_lt_u32 s32, s46
  s_cselect_b32 s32, s32, s47
  s_mov_b32 m0, s32
  s_nop 0
  buffer_load_dwordx4 v10, s[8:11], s30 offen offset:0 lds
  buffer_load_dwordx4 v11, s[8:11], s30 offen offset:1024 lds
  buffer_load_dwordx4 v12, s[8:11], s30 offen offset:2048 lds
  buffer_load_dwordx4 v13, s[8:11], s30 offen offset:3072 lds
  s_add_u32 s30, s30, 128
  s_add_u32 s32, s32, 16384
  s_cmp_lt_u32 s32, s46
  s_cselect_b32 s32, s32, s47
  s_mov_b32 m0, s32
  s_nop 0
  buffer_load_dwordx4 v10, s[8:11], s30 offen offset:0 lds
  buffer_load_dwordx4 v11, s[8:11], s30 offen offset:1024 lds
  buffer_load_dwordx4 v12, s[8:11], s30 offen offset:2048 lds
  buffer_load_dwordx4 v13, s[8:11], s30 offen offset:3072 lds
  s_add_u32 s30, s30, 128
  s_add_u32 s32, s32, 16384
  s_cmp_lt_u32 s32, s46
  s_cselect_b32 s32, s32, s47
  v_and_b32 v6, 7, v2
  v_add_u32 v4, 0, v3
  v_xor_b32 v4, v4, v6
  v_lshlrev_b32 v4, 4, v4
  v_lshl_add_u32 v14, v2, 7, v4
  v_add_u32 v4, 4, v3
  v_xor_b32 v4, v4, v6
  v_lshlrev_b32 v4, 4, v4
  v_lshl_add_u32 v15, v2, 7, v4
  v_mul_u32_u24 v22, 400, v2
  v_mul_u32_u24 v4, 16, v3
  s_mul_i32 s21, s20, 96
  s_add_u32 s21, s21, 98304
  v_add3_u32 v22, v22, v4, s21
  v_lshlrev_b32 v4, 3, v3
  v_sub_u32 v16, v22, v4
  v_mov_b32 v9, 2731
  s_mov_b32 s33, 0
  s_mov_b32 s48, 0x80000000
  s_mov_b32 m0, s32
  s_nop 0
  buffer_load_dwordx4 v10, s[8:11], s30 offen offset:0 lds
  buffer_load_dwordx4 v11, s[8:11], s30 offen offset:1024 lds
  s_waitcnt vmcnt(14)
  s_barrier
  v_add_u32 v18, s33, v14
  v_add_u32 v19, s33, v15
  s_add_u32 s33, s33, 16384
  s_cmp_lt_u32 s33, 98304
  s_cselect_b32 s33, s33, 0
  ds_read_b128 v[160:163], v18 offset:0
  ds_read_b128 v[164:167], v18 offset:2048
  ds_read_b128 v[168:171], v18 offset:4096
  ds_read_b128 v[172:175], v18 offset:6144
  ds_read_b128 v[176:179], v18 offset:8192
  ds_read_b128 v[180:183], v18 offset:10240
  ds_read_b128 v[184:187], v18 offset:12288
  ds_read_b128 v[188:191], v18 offset:14336
  s_waitcnt lgkmcnt(0)
qa_blk_207:
  v_mfma_f32_16x16x32_bf16 v[64:67], a[0:3], v[160:163], 0
  ds_read_b128 v[192:195], v19 offset:0
  v_mfma_f32_16x16x32_bf16 v[68:71], a[4:7], v[160:163], 0
  v_add_u32 v18, s33, v14
  v_cndmask_b32 v36, v34, v36, s[64:65]
  v_mfma_f32_16x16x32_bf16 v[72:75], a[8:11], v[160:163], 0
  v_cndmask_b32 v48, v34, v48, s[64:65]
  v_cndmask_b32 v37, v34, v37, s[66:67]
  v_mfma_f32_16x16x32_bf16 v[76:79], a[0:3], v[164:167], 0
  ds_read_b128 v[196:199], v19 offset:2048
  v_cndmask_b32 v49, v34, v49, s[66:67]
  v_mfma_f32_16x16x32_bf16 v[80:83], a[4:7], v[164:167], 0
  buffer_load_dwordx4 v12, s[8:11], s30 offen offset:2048 lds
  v_mfma_f32_16x16x32_bf16 v[84:87], a[8:11], v[164:167], 0
  v_cndmask_b32 v38, v34, v38, s[68:69]
  v_cndmask_b32 v50, v34, v50, s[68:69]
  v_mfma_f32_16x16x32_bf16 v[88:91], a[0:3], v[168:171], 0
  ds_read_b128 v[200:203], v19 offset:4096
  v_cndmask_b32 v39, v34, v39, s[70:71]
  v_mfma_f32_16x16x32_bf16 v[92:95], a[4:7], v[168:171], 0
  v_cndmask_b32 v51, v34, v51, s[70:71]
  v_max3_f32 v56, v36, v37, v38
  v_mfma_f32_16x16x32_bf16 v[96:99], a[8:11], v[168:171], 0
  v_max3_f32 v56, v56, v39, v40
  v_max3_f32 v56, v56, v41, v42
  v_mfma_f32_16x16x32_bf16 v[100:103], a[0:3], v[172:175], 0
  ds_read_b128 v[204:207], v19 offset:6144
  v_max_f32 v56, v56, v43
  v_mfma_f32_16x16x32_bf16 v[104:107], a[4:7], v[172:175], 0
  v_mov_b32 v57, v56
  v_mfma_f32_16x16x32_bf16 v[108:111], a[8:11], v[172:175], 0
  s_waitcnt lgkmcnt(15)
  v_mfma_f32_16x16x32_bf16 v[112:115], a[0:3], v[176:179], 0
  ds_read_b128 v[208:211], v19 offset:8192
  v_mfma_f32_16x16x32_bf16 v[116:119], a[4:7], v[176:179], 0
  s_nop 1
  v_mfma_f32_16x16x32_bf16 v[120:123], a[8:11], v[176:179], 0
  v_permlane32_swap_b32 v56, v57
  v_mfma_f32_16x16x32_bf16 v[124:127], a[0:3], v[180:183], 0
  ds_read_b128 v[212:215], v19 offset:10240
  v_max_f32 v56, v56, v57
  v_mfma_f32_16x16x32_bf16 v[128:131], a[4:7], v[180:183], 0
  buffer_load_dwordx4 v13, s[8:11], s30 offen offset:3072 lds
  v_mfma_f32_16x16x32_bf16 v[132:135], a[8:11], v[180:183], 0
  s_add_u32 s30, s30, 128
  s_add_u32 m0, m0, 16384
  v_mfma_f32_16x16x32_bf16 v[136:139], a[0:3], v[184:187], 0
  ds_read_b128 v[216:219], v19 offset:12288
  v_mov_b32 v57, v56
  v_mfma_f32_16x16x32_bf16 v[140:143], a[4:7], v[184:187], 0
  s_cmp_lt_u32 m0, s46
  s_cselect_b32 m0, m0, s47
  v_mfma_f32_16x16x32_bf16 v[144:147], a[8:11], v[184:187], 0
  s_nop 1
  v_mfma_f32_16x16x32_bf16 v[148:151], a[0:3], v[188:191], 0
  ds_read_b128 v[220:223], v19 offset:14336
  v_mfma_f32_16x16x32_bf16 v[152:155], a[4:7], v[188:191], 0
  v_permlane16_swap_b32 v56, v57
  v_mfma_f32_16x16x32_bf16 v[156:159], a[8:11], v[188:191], 0
  s_waitcnt vmcnt(12) lgkmcnt(4)
  s_barrier
  v_mfma_f32_16x16x32_bf16 v[64:67], a[12:15], v[192:195], v[64:67]
  ds_read_b128 v[160:163], v18 offset:0
  v_max_f32 v56, v56, v57
  v_mfma_f32_16x16x32_bf16 v[68:71], a[16:19], v[192:195], v[68:71]
  v_mul_f32 v56, s83, v56
  v_fma_f32 v36, v36, s83, -v56
  v_mfma_f32_16x16x32_bf16 v[72:75], a[20:23], v[192:195], v[72:75]
  v_add_u32 v19, s33, v15
  s_add_u32 s33, s33, 16384
  v_mfma_f32_16x16x32_bf16 v[76:79], a[12:15], v[196:199], v[76:79]
  ds_read_b128 v[164:167], v18 offset:2048
  v_fma_f32 v37, v37, s83, -v56
  v_mfma_f32_16x16x32_bf16 v[80:83], a[16:19], v[196:199], v[80:83]
  buffer_load_dwordx4 v10, s[8:11], s30 offen offset:0 lds
  v_mfma_f32_16x16x32_bf16 v[84:87], a[20:23], v[196:199], v[84:87]
  s_cmp_lt_u32 s33, 98304
  s_cselect_b32 s33, s33, 0
  v_mfma_f32_16x16x32_bf16 v[88:91], a[12:15], v[200:203], v[88:91]
  ds_read_b128 v[168:171], v18 offset:4096
  v_fma_f32 v38, v38, s83, -v56
  v_mfma_f32_16x16x32_bf16 v[92:95], a[16:19], v[200:203], v[92:95]
  v_fma_f32 v39, v39, s83, -v56
  v_fma_f32 v40, v40, s83, -v56
  v_mfma_f32_16x16x32_bf16 v[96:99], a[20:23], v[200:203], v[96:99]
  v_fma_f32 v41, v41, s83, -v56
  v_fma_f32 v42, v42, s83, -v56
  v_mfma_f32_16x16x32_bf16 v[100:103], a[12:15], v[204:207], v[100:103]
  ds_read_b128 v[172:175], v18 offset:6144
  v_fma_f32 v43, v43, s83, -v56
  v_mfma_f32_16x16x32_bf16 v[104:107], a[16:19], v[204:207], v[104:107]
  v_exp_f32 v36, v36
  v_mfma_f32_16x16x32_bf16 v[108:111], a[20:23], v[204:207], v[108:111]
  s_waitcnt lgkmcnt(4)
  v_mfma_f32_16x16x32_bf16 v[112:115], a[12:15], v[208:211], v[112:115]
  ds_read_b128 v[176:179], v18 offset:8192
  v_mfma_f32_16x16x32_bf16 v[116:119], a[16:19], v[208:211], v[116:119]
  v_exp_f32 v37, v37
  v_mfma_f32_16x16x32_bf16 v[120:123], a[20:23], v[208:211], v[120:123]
  v_exp_f32 v38, v38
  v_mfma_f32_16x16x32_bf16 v[124:127], a[12:15], v[212:215], v[124:127]
  ds_read_b128 v[180:183], v18 offset:10240
  v_mfma_f32_16x16x32_bf16 v[128:131], a[16:19], v[212:215], v[128:131]
  buffer_load_dwordx4 v11, s[8:11], s30 offen offset:1024 lds
  v_mfma_f32_16x16x32_bf16 v[132:135], a[20:23], v[212:215], v[132:135]
  v_exp_f32 v39, v39
  v_mfma_f32_16x16x32_bf16 v[136:139], a[12:15], v[216:219], v[136:139]
  ds_read_b128 v[184:187], v18 offset:12288
  v_mfma_f32_16x16x32_bf16 v[140:143], a[16:19], v[216:219], v[140:143]
  v_exp_f32 v40, v40
  v_mfma_f32_16x16x32_bf16 v[144:147], a[20:23], v[216:219], v[144:147]
  v_exp_f32 v41, v41
  v_mfma_f32_16x16x32_bf16 v[148:151], a[12:15], v[220:223], v[148:151]
  ds_read_b128 v[188:191], v18 offset:14336
  v_mfma_f32_16x16x32_bf16 v[152:155], a[16:19], v[220:223], v[152:155]
  v_exp_f32 v42, v42
  v_mfma_f32_16x16x32_bf16 v[156:159], a[20:23], v[220:223], v[156:159]
  s_waitcnt lgkmcnt(4)
  v_mfma_f32_16x16x32_bf16 v[64:67], a[24:27], v[160:163], v[64:67]
  ds_read_b128 v[192:195], v19 offset:0
  v_mfma_f32_16x16x32_bf16 v[68:71], a[28:31], v[160:163], v[68:71]
  v_add_u32 v18, s33, v14
  v_mfma_f32_16x16x32_bf16 v[72:75], a[32:35], v[160:163], v[72:75]
  v_exp_f32 v43, v43
  v_mfma_f32_16x16x32_bf16 v[76:79], a[24:27], v[164:167], v[76:79]
  ds_read_b128 v[196:199], v19 offset:2048
  s_nop 0
  v_mfma_f32_16x16x32_bf16 v[80:83], a[28:31], v[164:167], v[80:83]
  buffer_load_dwordx4 v12, s[8:11], s30 offen offset:2048 lds
  v_mfma_f32_16x16x32_bf16 v[84:87], a[32:35], v[164:167], v[84:87]
  v_add_f32 v56, v40, v41
  v_add_f32 v56, v56, v42
  v_mfma_f32_16x16x32_bf16 v[88:91], a[24:27], v[168:171], v[88:91]
  ds_read_b128 v[200:203], v19 offset:4096
  v_add_f32 v56, v56, v43
  v_mfma_f32_16x16x32_bf16 v[92:95], a[28:31], v[168:171], v[92:95]
  v_cndmask_b32 v56, 0, v56, s[60:61]
  v_add_f32 v56, v56, v36
  v_mfma_f32_16x16x32_bf16 v[96:99], a[32:35], v[168:171], v[96:99]
  v_add_f32 v56, v56, v37
  v_add_f32 v56, v56, v38
  v_mfma_f32_16x16x32_bf16 v[100:103], a[24:27], v[172:175], v[100:103]
  ds_read_b128 v[204:207], v19 offset:6144
  v_add_f32 v56, v56, v39
  v_mfma_f32_16x16x32_bf16 v[104:107], a[28:31], v[172:175], v[104:107]
  v_mov_b32 v57, v56
  v_mfma_f32_16x16x32_bf16 v[108:111], a[32:35], v[172:175], v[108:111]
  s_waitcnt lgkmcnt(4)
  v_mfma_f32_16x16x32_bf16 v[112:115], a[24:27], v[176:179], v[112:115]
  ds_read_b128 v[208:211], v19 offset:8192
  v_mfma_f32_16x16x32_bf16 v[116:119], a[28:31], v[176:179], v[116:119]
  s_nop 1
  v_mfma_f32_16x16x32_bf16 v[120:123], a[32:35], v[176:179], v[120:123]
  v_permlane32_swap_b32 v56, v57
  v_mfma_f32_16x16x32_bf16 v[124:127], a[24:27], v[180:183], v[124:127]
  ds_read_b128 v[212:215], v19 offset:10240
  v_add_f32 v56, v56, v57
  v_mfma_f32_16x16x32_bf16 v[128:131], a[28:31], v[180:183], v[128:131]
  buffer_load_dwordx4 v13, s[8:11], s30 offen offset:3072 lds
  v_mfma_f32_16x16x32_bf16 v[132:135], a[32:35], v[180:183], v[132:135]
  s_add_u32 s30, s30, 128
  s_add_u32 m0, m0, 16384
  v_mfma_f32_16x16x32_bf16 v[136:139], a[24:27], v[184:187], v[136:139]
  ds_read_b128 v[216:219], v19 offset:12288
  v_mov_b32 v57, v56
  v_mfma_f32_16x16x32_bf16 v[140:143], a[28:31], v[184:187], v[140:143]
  s_cmp_lt_u32 m0, s46
  s_cselect_b32 m0, m0, s47
  v_mfma_f32_16x16x32_bf16 v[144:147], a[32:35], v[184:187], v[144:147]
  s_nop 1
  v_mfma_f32_16x16x32_bf16 v[148:151], a[24:27], v[188:191], v[148:151]
  ds_read_b128 v[220:223], v19 offset:14336
  v_mfma_f32_16x16x32_bf16 v[152:155], a[28:31], v[188:191], v[152:155]
  v_permlane16_swap_b32 v56, v57
  v_mfma_f32_16x16x32_bf16 v[156:159], a[32:35], v[188:191], v[156:159]
  s_waitcnt vmcnt(12) lgkmcnt(4)
  s_barrier
  v_mfma_f32_16x16x32_bf16 v[64:67], a[36:39], v[192:195], v[64:67]
  ds_read_b128 v[160:163], v18 offset:0
  v_add_f32 v56, v56, v57
  v_mfma_f32_16x16x32_bf16 v[68:71], a[40:43], v[192:195], v[68:71]
  v_rcp_f32 v56, v56
  v_mfma_f32_16x16x32_bf16 v[72:75], a[44:47], v[192:195], v[72:75]
  v_add_u32 v19, s33, v15
  s_add_u32 s33, s33, 16384
  v_mfma_f32_16x16x32_bf16 v[76:79], a[36:39], v[196:199], v[76:79]
  ds_read_b128 v[164:167], v18 offset:2048
  s_nop 0
  v_mfma_f32_16x16x32_bf16 v[80:83], a[40:43], v[196:199], v[80:83]
  buffer_load_dwordx4 v10, s[8:11], s30 offen offset:0 lds
  v_mfma_f32_16x16x32_bf16 v[84:87], a[44:47], v[196:199], v[84:87]
  s_cmp_lt_u32 s33, 98304
  s_cselect_b32 s33, s33, 0
  v_mfma_f32_16x16x32_bf16 v[88:91], a[36:39], v[200:203], v[88:91]
  ds_read_b128 v[168:171], v18 offset:4096
  v_mul_f32 v36, v36, v56
  v_mfma_f32_16x16x32_bf16 v[92:95], a[40:43], v[200:203], v[92:95]
  v_mul_f32 v37, v37, v56
  v_mul_f32 v38, v38, v56
  v_mfma_f32_16x16x32_bf16 v[96:99], a[44:47], v[200:203], v[96:99]
  v_mul_f32 v39, v39, v56
  v_mul_f32 v40, v40, v56
  v_mfma_f32_16x16x32_bf16 v[100:103], a[36:39], v[204:207], v[100:103]
  ds_read_b128 v[172:175], v18 offset:6144
  v_mul_f32 v41, v41, v56
  v_mfma_f32_16x16x32_bf16 v[104:107], a[40:43], v[204:207], v[104:107]
  v_mul_f32 v42, v42, v56
  v_mul_f32 v43, v43, v56
  v_mfma_f32_16x16x32_bf16 v[108:111], a[44:47], v[204:207], v[108:111]
  s_waitcnt lgkmcnt(4)
  v_max3_f32 v56, v44, v45, v46
  v_mfma_f32_16x16x32_bf16 v[112:115], a[36:39], v[208:211], v[112:115]
  ds_read_b128 v[176:179], v18 offset:8192
  v_max3_f32 v56, v56, v47, v48
  v_mfma_f32_16x16x32_bf16 v[116:119], a[40:43], v[208:211], v[116:119]
  v_max3_f32 v56, v56, v49, v50
  v_max3_f32 v56, v56, v51, v52
  v_mfma_f32_16x16x32_bf16 v[120:123], a[44:47], v[208:211], v[120:123]
  v_max3_f32 v56, v56, v53, v54
  v_max_f32 v56, v56, v55
  v_mfma_f32_16x16x32_bf16 v[124:127], a[36:39], v[212:215], v[124:127]
  ds_read_b128 v[180:183], v18 offset:10240
  v_mov_b32 v57, v56
  v_mfma_f32_16x16x32_bf16 v[128:131], a[40:43], v[212:215], v[128:131]
  buffer_load_dwordx4 v11, s[8:11], s30 offen offset:1024 lds
  v_mfma_f32_16x16x32_bf16 v[132:135], a[44:47], v[212:215], v[132:135]
  s_nop 1
  v_mfma_f32_16x16x32_bf16 v[136:139], a[36:39], v[216:219], v[136:139]
  ds_read_b128 v[184:187], v18 offset:12288
  v_mfma_f32_16x16x32_bf16 v[140:143], a[40:43], v[216:219], v[140:143]
  v_permlane32_swap_b32 v56, v57
  v_mfma_f32_16x16x32_bf16 v[144:147], a[44:47], v[216:219], v[144:147]
  v_max_f32 v56, v56, v57
  v_mov_b32 v57, v56
  v_mfma_f32_16x16x32_bf16 v[148:151], a[36:39], v[220:223], v[148:151]
  ds_read_b128 v[188:191], v18 offset:14336
  v_mfma_f32_16x16x32_bf16 v[152:155], a[40:43], v[220:223], v[152:155]
  s_nop 1
  v_mfma_f32_16x16x32_bf16 v[156:159], a[44:47], v[220:223], v[156:159]
  s_waitcnt lgkmcnt(4)
  v_mfma_f32_16x16x32_bf16 v[64:67], a[48:51], v[160:163], v[64:67]
  ds_read_b128 v[192:195], v19 offset:0
  v_mfma_f32_16x16x32_bf16 v[68:71], a[52:55], v[160:163], v[68:71]
  v_add_u32 v18, s33, v14
  v_mfma_f32_16x16x32_bf16 v[72:75], a[56:59], v[160:163], v[72:75]
  v_permlane16_swap_b32 v56, v57
  v_mfma_f32_16x16x32_bf16 v[76:79], a[48:51], v[164:167], v[76:79]
  ds_read_b128 v[196:199], v19 offset:2048
  v_max_f32 v56, v56, v57
  v_mfma_f32_16x16x32_bf16 v[80:83], a[52:55], v[164:167], v[80:83]
  buffer_load_dwordx4 v12, s[8:11], s30 offen offset:2048 lds
  v_mfma_f32_16x16x32_bf16 v[84:87], a[56:59], v[164:167], v[84:87]
  v_mul_f32 v56, s83, v56
  v_fma_f32 v44, v44, s83, -v56
  v_mfma_f32_16x16x32_bf16 v[88:91], a[48:51], v[168:171], v[88:91]
  ds_read_b128 v[200:203], v19 offset:4096
  v_fma_f32 v45, v45, s83, -v56
  v_mfma_f32_16x16x32_bf16 v[92:95], a[52:55], v[168:171], v[92:95]
  v_fma_f32 v46, v46, s83, -v56
  v_fma_f32 v47, v47, s83, -v56
  v_mfma_f32_16x16x32_bf16 v[96:99], a[56:59], v[168:171], v[96:99]
  v_fma_f32 v48, v48, s83, -v56
  v_fma_f32 v49, v49, s83, -v56
  v_mfma_f32_16x16x32_bf16 v[100:103], a[48:51], v[172:175], v[100:103]
  ds_read_b128 v[204:207], v19 offset:6144
  v_fma_f32 v50, v50, s83, -v56
  v_mfma_f32_16x16x32_bf16 v[104:107], a[52:55], v[172:175], v[104:107]
  v_fma_f32 v51, v51, s83, -v56
  v_fma_f32 v52, v52, s83, -v56
  v_mfma_f32_16x16x32_bf16 v[108:111], a[56:59], v[172:175], v[108:111]
  s_waitcnt lgkmcnt(4)
  v_fma_f32 v53, v53, s83, -v56
  v_mfma_f32_16x16x32_bf16 v[112:115], a[48:51], v[176:179], v[112:115]
  ds_read_b128 v[208:211], v19 offset:8192
  v_fma_f32 v54, v54, s83, -v56
  v_mfma_f32_16x16x32_bf16 v[116:119], a[52:55], v[176:179], v[116:119]
  v_fma_f32 v55, v55, s83, -v56
  v_mfma_f32_16x16x32_bf16 v[120:123], a[56:59], v[176:179], v[120:123]
  v_exp_f32 v44, v44
  v_mfma_f32_16x16x32_bf16 v[124:127], a[48:51], v[180:183], v[124:127]
  ds_read_b128 v[212:215], v19 offset:10240
  v_mfma_f32_16x16x32_bf16 v[128:131], a[52:55], v[180:183], v[128:131]
  buffer_load_dwordx4 v13, s[8:11], s30 offen offset:3072 lds
  v_mfma_f32_16x16x32_bf16 v[132:135], a[56:59], v[180:183], v[132:135]
  s_add_u32 s30, s30, 128
  s_add_u32 m0, m0, 16384
  v_mfma_f32_16x16x32_bf16 v[136:139], a[48:51], v[184:187], v[136:139]
  ds_read_b128 v[216:219], v19 offset:12288
  v_mfma_f32_16x16x32_bf16 v[140:143], a[52:55], v[184:187], v[140:143]
  s_cmp_lt_u32 m0, s46
  s_cselect_b32 m0, m0, s47
  v_mfma_f32_16x16x32_bf16 v[144:147], a[56:59], v[184:187], v[144:147]
  v_exp_f32 v45, v45
  v_mfma_f32_16x16x32_bf16 v[148:151], a[48:51], v[188:191], v[148:151]
  ds_read_b128 v[220:223], v19 offset:14336
  v_mfma_f32_16x16x32_bf16 v[152:155], a[52:55], v[188:191], v[152:155]
  v_exp_f32 v46, v46
  v_mfma_f32_16x16x32_bf16 v[156:159], a[56:59], v[188:191], v[156:159]
  s_waitcnt vmcnt(12) lgkmcnt(4)
  s_barrier
  v_mfma_f32_16x16x32_bf16 v[64:67], a[60:63], v[192:195], v[64:67]
  ds_read_b128 v[160:163], v18 offset:0
  v_mfma_f32_16x16x32_bf16 v[68:71], a[64:67], v[192:195], v[68:71]
  s_waitcnt vmcnt(10)
  s_cmp_eq_u32 s78, 0
  s_cbranch_scc1 pf_205
  v_mov_b32 v4, 0
  v_mov_b32 v5, 1
  s_mov_b64 exec, 1
  buffer_atomic_add v5, v4, s[72:75], s78 offen sc1
  s_mov_b64 exec, -1
  s_mov_b32 s78, 0
pf_205:
  s_mul_i32 s21, s49, 393216
  s_mul_i32 s22, s42, 12288
  s_add_u32 s50, s21, s22
  s_mul_i32 s21, s49, 98304
  s_mul_i32 s22, s42, 3072
  s_add_u32 s51, s21, s22
  s_lshr_b32 s22, s49, 1
  s_lshr_b32 s21, s49, 2
  s_add_u32 s21, s21, 3
  s_cmp_lt_u32 s49, 12
  s_cselect_b32 s21, s22, s21
  s_lshl_b32 s21, s21, 3
  s_lshr_b32 s22, s42, 2
  s_add_u32 s21, s21, s22
  s_lshl_b32 s21, s21, 7
  s_add_u32 s76, s21, 0
  s_lshl_b32 s77, s42, 7
  s_add_u32 s77, s77, 19456
  v_mov_b32 v4, 0
  buffer_load_dword v20, v4, s[72:75], s76 offen sc1
  v_mfma_f32_16x16x32_bf16 v[72:75], a[68:71], v[192:195], v[72:75]
  v_add_u32 v19, s33, v15
  s_add_u32 s33, s33, 16384
  v_mfma_f32_16x16x32_bf16 v[76:79], a[60:63], v[196:199], v[76:79]
  ds_read_b128 v[164:167], v18 offset:2048
  v_mfma_f32_16x16x32_bf16 v[80:83], a[64:67], v[196:199], v[80:83]
  buffer_load_dwordx4 v10, s[8:11], s30 offen offset:0 lds
  v_mfma_f32_16x16x32_bf16 v[84:87], a[68:71], v[196:199], v[84:87]
  s_cmp_lt_u32 s33, 98304
  s_cselect_b32 s33, s33, 0
  v_mfma_f32_16x16x32_bf16 v[88:91], a[60:63], v[200:203], v[88:91]
  ds_read_b128 v[168:171], v18 offset:4096
  v_mfma_f32_16x16x32_bf16 v[92:95], a[64:67], v[200:203], v[92:95]
  v_exp_f32 v47, v47
  v_mfma_f32_16x16x32_bf16 v[96:99], a[68:71], v[200:203], v[96:99]
  v_exp_f32 v48, v48
  v_mfma_f32_16x16x32_bf16 v[100:103], a[60:63], v[204:207], v[100:103]
  ds_read_b128 v[172:175], v18 offset:6144
  v_mfma_f32_16x16x32_bf16 v[104:107], a[64:67], v[204:207], v[104:107]
  v_exp_f32 v49, v49
  v_mfma_f32_16x16x32_bf16 v[108:111], a[68:71], v[204:207], v[108:111]
  s_waitcnt lgkmcnt(4)
  v_mfma_f32_16x16x32_bf16 v[112:115], a[60:63], v[208:211], v[112:115]
  ds_read_b128 v[176:179], v18 offset:8192
  v_mfma_f32_16x16x32_bf16 v[116:119], a[64:67], v[208:211], v[116:119]
  v_exp_f32 v50, v50
  v_mfma_f32_16x16x32_bf16 v[120:123], a[68:71], v[208:211], v[120:123]
  v_exp_f32 v51, v51
  v_mfma_f32_16x16x32_bf16 v[124:127], a[60:63], v[212:215], v[124:127]
  ds_read_b128 v[180:183], v18 offset:10240
  v_mfma_f32_16x16x32_bf16 v[128:131], a[64:67], v[212:215], v[128:131]
  buffer_load_dwordx4 v11, s[8:11], s30 offen offset:1024 lds
  v_mfma_f32_16x16x32_bf16 v[132:135], a[68:71], v[212:215], v[132:135]
  v_exp_f32 v52, v52
  v_mfma_f32_16x16x32_bf16 v[136:139], a[60:63], v[216:219], v[136:139]
  ds_read_b128 v[184:187], v18 offset:12288
  v_mfma_f32_16x16x32_bf16 v[140:143], a[64:67], v[216:219], v[140:143]
  v_exp_f32 v53, v53
  v_mfma_f32_16x16x32_bf16 v[144:147], a[68:71], v[216:219], v[144:147]
  v_exp_f32 v54, v54
  v_mfma_f32_16x16x32_bf16 v[148:151], a[60:63], v[220:223], v[148:151]
  ds_read_b128 v[188:191], v18 offset:14336
  v_mfma_f32_16x16x32_bf16 v[152:155], a[64:67], v[220:223], v[152:155]
  v_exp_f32 v55, v55
  v_mfma_f32_16x16x32_bf16 v[156:159], a[68:71], v[220:223], v[156:159]
  s_waitcnt lgkmcnt(4)
  s_nop 0
  v_mfma_f32_16x16x32_bf16 v[64:67], a[72:75], v[160:163], v[64:67]
  ds_read_b128 v[192:195], v19 offset:0
  v_add_f32 v56, v52, v53
  v_mfma_f32_16x16x32_bf16 v[68:71], a[76:79], v[160:163], v[68:71]
  v_add_u32 v18, s33, v14
  v_add_f32 v56, v56, v54
  v_mfma_f32_16x16x32_bf16 v[72:75], a[80:83], v[160:163], v[72:75]
  v_add_f32 v56, v56, v55
  v_cndmask_b32 v56, 0, v56, s[60:61]
  v_mfma_f32_16x16x32_bf16 v[76:79], a[72:75], v[164:167], v[76:79]
  ds_read_b128 v[196:199], v19 offset:2048
  v_add_f32 v56, v56, v44
  v_mfma_f32_16x16x32_bf16 v[80:83], a[76:79], v[164:167], v[80:83]
  buffer_load_dwordx4 v12, s[8:11], s30 offen offset:2048 lds
  v_mfma_f32_16x16x32_bf16 v[84:87], a[80:83], v[164:167], v[84:87]
  v_add_f32 v56, v56, v45
  v_add_f32 v56, v56, v46
  v_mfma_f32_16x16x32_bf16 v[88:91], a[72:75], v[168:171], v[88:91]
  ds_read_b128 v[200:203], v19 offset:4096
  v_add_f32 v56, v56, v47
  v_mfma_f32_16x16x32_bf16 v[92:95], a[76:79], v[168:171], v[92:95]
  v_add_f32 v56, v56, v48
  v_add_f32 v56, v56, v49
  v_mfma_f32_16x16x32_bf16 v[96:99], a[80:83], v[168:171], v[96:99]
  v_add_f32 v56, v56, v50
  v_add_f32 v56, v56, v51
  v_mfma_f32_16x16x32_bf16 v[100:103], a[72:75], v[172:175], v[100:103]
  ds_read_b128 v[204:207], v19 offset:6144
  v_mov_b32 v57, v56
  v_mfma_f32_16x16x32_bf16 v[104:107], a[76:79], v[172:175], v[104:107]
  s_nop 1
  v_mfma_f32_16x16x32_bf16 v[108:111], a[80:83], v[172:175], v[108:111]
  s_waitcnt lgkmcnt(4)
  v_mfma_f32_16x16x32_bf16 v[112:115], a[72:75], v[176:179], v[112:115]
  ds_read_b128 v[208:211], v19 offset:8192
  v_mfma_f32_16x16x32_bf16 v[116:119], a[76:79], v[176:179], v[116:119]
  v_permlane32_swap_b32 v56, v57
  v_mfma_f32_16x16x32_bf16 v[120:123], a[80:83], v[176:179], v[120:123]
  v_add_f32 v56, v56, v57
  v_mov_b32 v57, v56
  v_mfma_f32_16x16x32_bf16 v[124:127], a[72:75], v[180:183], v[124:127]
  ds_read_b128 v[212:215], v19 offset:10240
  v_mfma_f32_16x16x32_bf16 v[128:131], a[76:79], v[180:183], v[128:131]
  buffer_load_dwordx4 v13, s[8:11], s30 offen offset:3072 lds
  v_mfma_f32_16x16x32_bf16 v[132:135], a[80:83], v[180:183], v[132:135]
  s_add_u32 s30, s30, 128
  s_add_u32 m0, m0, 16384
  v_mfma_f32_16x16x32_bf16 v[136:139], a[72:75], v[184:187], v[136:139]
  ds_read_b128 v[216:219], v19 offset:12288
  v_mfma_f32_16x16x32_bf16 v[140:143], a[76:79], v[184:187], v[140:143]
  s_cmp_lt_u32 m0, s46
  s_cselect_b32 m0, m0, s47
  v_mfma_f32_16x16x32_bf16 v[144:147], a[80:83], v[184:187], v[144:147]
  s_nop 1
  v_mfma_f32_16x16x32_bf16 v[148:151], a[72:75], v[188:191], v[148:151]
  ds_read_b128 v[220:223], v19 offset:14336
  v_mfma_f32_16x16x32_bf16 v[152:155], a[76:79], v[188:191], v[152:155]
  v_permlane16_swap_b32 v56, v57
  v_mfma_f32_16x16x32_bf16 v[156:159], a[80:83], v[188:191], v[156:159]
  s_waitcnt vmcnt(13) lgkmcnt(4)
  s_barrier
  v_mfma_f32_16x16x32_bf16 v[64:67], a[84:87], v[192:195], v[64:67]
  ds_read_b128 v[160:163], v18 offset:0
  v_add_f32 v56, v56, v57
  v_mfma_f32_16x16x32_bf16 v[68:71], a[88:91], v[192:195], v[68:71]
  v_rcp_f32 v56, v56
  v_mfma_f32_16x16x32_bf16 v[72:75], a[92:95], v[192:195], v[72:75]
  v_add_u32 v19, s33, v15
  s_add_u32 s33, s33, 16384
  v_mfma_f32_16x16x32_bf16 v[76:79], a[84:87], v[196:199], v[76:79]
  ds_read_b128 v[164:167], v18 offset:2048
  s_nop 0
  v_mfma_f32_16x16x32_bf16 v[80:83], a[88:91], v[196:199], v[80:83]
  buffer_load_dwordx4 v10, s[8:11], s30 offen offset:0 lds
  v_mfma_f32_16x16x32_bf16 v[84:87], a[92:95], v[196:199], v[84:87]
  s_cmp_lt_u32 s33, 98304
  s_cselect_b32 s33, s33, 0
  v_mfma_f32_16x16x32_bf16 v[88:91], a[84:87], v[200:203], v[88:91]
  ds_read_b128 v[168:171], v18 offset:4096
  v_mul_f32 v44, v44, v56
  v_mfma_f32_16x16x32_bf16 v[92:95], a[88:91], v[200:203], v[92:95]
  v_mul_f32 v45, v45, v56
  v_mul_f32 v46, v46, v56
  v_mfma_f32_16x16x32_bf16 v[96:99], a[92:95], v[200:203], v[96:99]
  v_mul_f32 v47, v47, v56
  v_mul_f32 v48, v48, v56
  v_mfma_f32_16x16x32_bf16 v[100:103], a[84:87], v[204:207], v[100:103]
  ds_read_b128 v[172:175], v18 offset:6144
  v_mul_f32 v49, v49, v56
  v_mfma_f32_16x16x32_bf16 v[104:107], a[88:91], v[204:207], v[104:107]
  v_mul_f32 v50, v50, v56
  v_mul_f32 v51, v51, v56
  v_mfma_f32_16x16x32_bf16 v[108:111], a[92:95], v[204:207], v[108:111]
  s_waitcnt lgkmcnt(4)
  v_mul_f32 v52, v52, v56
  v_mfma_f32_16x16x32_bf16 v[112:115], a[84:87], v[208:211], v[112:115]
  ds_read_b128 v[176:179], v18 offset:8192
  v_mul_f32 v53, v53, v56
  v_mfma_f32_16x16x32_bf16 v[116:119], a[88:91], v[208:211], v[116:119]
  v_mul_f32 v54, v54, v56
  v_mul_f32 v55, v55, v56
  v_mfma_f32_16x16x32_bf16 v[120:123], a[92:95], v[208:211], v[120:123]
  v_cvt_pk_bf16_f32 v240, v40, v41
  v_cvt_pk_bf16_f32 v241, v42, v43
  v_mfma_f32_16x16x32_bf16 v[124:127], a[84:87], v[212:215], v[124:127]
  ds_read_b128 v[180:183], v18 offset:10240
  v_cvt_pk_bf16_f32 v242, v52, v53
  v_mfma_f32_16x16x32_bf16 v[128:131], a[88:91], v[212:215], v[128:131]
  buffer_load_dwordx4 v11, s[8:11], s30 offen offset:1024 lds
  v_mfma_f32_16x16x32_bf16 v[132:135], a[92:95], v[212:215], v[132:135]
  v_cvt_pk_bf16_f32 v243, v54, v55
  v_cvt_pk_bf16_f32 v236, v44, v45
  v_mfma_f32_16x16x32_bf16 v[136:139], a[84:87], v[216:219], v[136:139]
  ds_read_b128 v[184:187], v18 offset:12288
  v_cvt_pk_bf16_f32 v237, v46, v47
  v_mfma_f32_16x16x32_bf16 v[140:143], a[88:91], v[216:219], v[140:143]
  v_cvt_pk_bf16_f32 v238, v48, v49
  v_cvt_pk_bf16_f32 v239, v50, v51
  v_mfma_f32_16x16x32_bf16 v[144:147], a[92:95], v[216:219], v[144:147]
  v_cvt_pk_bf16_f32 v244, v36, v37
  v_cvt_pk_bf16_f32 v245, v38, v39
  v_mfma_f32_16x16x32_bf16 v[148:151], a[84:87], v[220:223], v[148:151]
  ds_read_b128 v[188:191], v18 offset:14336
  v_mfma_f32_16x16x32_bf16 v[152:155], a[88:91], v[220:223], v[152:155]
  v_permlane16_swap_b32 v240, v242
  v_mfma_f32_16x16x32_bf16 v[156:159], a[92:95], v[220:223], v[156:159]
  s_waitcnt lgkmcnt(4)
  v_mfma_f32_16x16x32_bf16 v[64:67], a[96:99], v[160:163], v[64:67]
  ds_read_b128 v[192:195], v19 offset:0
  v_mfma_f32_16x16x32_bf16 v[68:71], a[100:103], v[160:163], v[68:71]
  v_add_u32 v18, s33, v14
  v_mfma_f32_16x16x32_bf16 v[72:75], a[104:107], v[160:163], v[72:75]
  v_permlane16_swap_b32 v241, v243
  v_mfma_f32_16x16x32_bf16 v[76:79], a[96:99], v[164:167], v[76:79]
  ds_read_b128 v[196:199], v19 offset:2048
  v_mfma_f32_16x16x32_bf16 v[80:83], a[100:103], v[164:167], v[80:83]
  buffer_load_dwordx4 v12, s[8:11], s30 offen offset:2048 lds
  v_mfma_f32_16x16x32_bf16 v[84:87], a[104:107], v[164:167], v[84:87]
  v_mfma_f32_16x16x32_bf16 v[88:91], a[96:99], v[168:171], v[88:91]
  ds_read_b128 v[200:203], v19 offset:4096
  v_mfma_f32_16x16x32_bf16 v[92:95], a[100:103], v[168:171], v[92:95]
  v_mfma_f32_16x16x32_bf16 v[96:99], a[104:107], v[168:171], v[96:99]
  v_mfma_f32_16x16x32_bf16 v[100:103], a[96:99], v[172:175], v[100:103]
  ds_read_b128 v[204:207], v19 offset:6144
  v_mfma_f32_16x16x32_bf16 v[104:107], a[100:103], v[172:175], v[104:107]
  v_mfma_f32_16x16x32_bf16 v[108:111], a[104:107], v[172:175], v[108:111]
  s_waitcnt lgkmcnt(4)
  v_mfma_f32_16x16x32_bf16 v[112:115], a[96:99], v[176:179], v[112:115]
  ds_read_b128 v[208:211], v19 offset:8192
  v_mfma_f32_16x16x32_bf16 v[116:119], a[100:103], v[176:179], v[116:119]
  v_mfma_f32_16x16x32_bf16 v[120:123], a[104:107], v[176:179], v[120:123]
  v_mfma_f32_16x16x32_bf16 v[124:127], a[96:99], v[180:183], v[124:127]
  ds_read_b128 v[212:215], v19 offset:10240
  v_mfma_f32_16x16x32_bf16 v[128:131], a[100:103], v[180:183], v[128:131]
  buffer_load_dwordx4 v13, s[8:11], s30 offen offset:3072 lds
  v_mfma_f32_16x16x32_bf16 v[132:135], a[104:107], v[180:183], v[132:135]
  s_add_u32 s30, s30, 128
  s_add_u32 m0, m0, 16384
  v_mfma_f32_16x16x32_bf16 v[136:139], a[96:99], v[184:187], v[136:139]
  ds_read_b128 v[216:219], v19 offset:12288
  v_mfma_f32_16x16x32_bf16 v[140:143], a[100:103], v[184:187], v[140:143]
  s_cmp_lt_u32 m0, s46
  s_cselect_b32 m0, m0, s47
  v_mfma_f32_16x16x32_bf16 v[144:147], a[104:107], v[184:187], v[144:147]
  v_mfma_f32_16x16x32_bf16 v[148:151], a[96:99], v[188:191], v[148:151]
  ds_read_b128 v[220:223], v19 offset:14336
  v_mfma_f32_16x16x32_bf16 v[152:155], a[100:103], v[188:191], v[152:155]
  v_mfma_f32_16x16x32_bf16 v[156:159], a[104:107], v[188:191], v[156:159]
  s_waitcnt vmcnt(13) lgkmcnt(4)
  s_barrier
  v_mfma_f32_16x16x32_bf16 v[64:67], a[108:111], v[192:195], v[64:67]
  ds_read_b128 v[160:163], v18 offset:0
  v_mfma_f32_16x16x32_bf16 v[68:71], a[112:115], v[192:195], v[68:71]
  v_mfma_f32_16x16x32_bf16 v[72:75], a[116:119], v[192:195], v[72:75]
  v_add_u32 v19, s33, v15
  s_add_u32 s33, s33, 16384
  v_mfma_f32_16x16x32_bf16 v[76:79], a[108:111], v[196:199], v[76:79]
  ds_read_b128 v[164:167], v18 offset:2048
  v_mfma_f32_16x16x32_bf16 v[80:83], a[112:115], v[196:199], v[80:83]
  buffer_load_dwordx4 v10, s[8:11], s30 offen offset:0 lds
  v_mfma_f32_16x16x32_bf16 v[84:87], a[116:119], v[196:199], v[84:87]
  s_cmp_lt_u32 s33, 98304
  s_cselect_b32 s33, s33, 0
  v_mfma_f32_16x16x32_bf16 v[88:91], a[108:111], v[200:203], v[88:91]
  ds_read_b128 v[168:171], v18 offset:4096
  v_mfma_f32_16x16x32_bf16 v[92:95], a[112:115], v[200:203], v[92:95]
  v_mfma_f32_16x16x32_bf16 v[96:99], a[116:119], v[200:203], v[96:99]
  v_mfma_f32_16x16x32_bf16 v[100:103], a[108:111], v[204:207], v[100:103]
  ds_read_b128 v[172:175], v18 offset:6144
  v_mfma_f32_16x16x32_bf16 v[104:107], a[112:115], v[204:207], v[104:107]
  v_mfma_f32_16x16x32_bf16 v[108:111], a[116:119], v[204:207], v[108:111]
  s_waitcnt lgkmcnt(4)
  v_mfma_f32_16x16x32_bf16 v[112:115], a[108:111], v[208:211], v[112:115]
  ds_read_b128 v[176:179], v18 offset:8192
  v_mfma_f32_16x16x32_bf16 v[116:119], a[112:115], v[208:211], v[116:119]
  v_mfma_f32_16x16x32_bf16 v[120:123], a[116:119], v[208:211], v[120:123]
  v_mfma_f32_16x16x32_bf16 v[124:127], a[108:111], v[212:215], v[124:127]
  ds_read_b128 v[180:183], v18 offset:10240
  v_mfma_f32_16x16x32_bf16 v[128:131], a[112:115], v[212:215], v[128:131]
  buffer_load_dwordx4 v11, s[8:11], s30 offen offset:1024 lds
  v_mfma_f32_16x16x32_bf16 v[132:135], a[116:119], v[212:215], v[132:135]
  v_mfma_f32_16x16x32_bf16 v[136:139], a[108:111], v[216:219], v[136:139]
  ds_read_b128 v[184:187], v18 offset:12288
  v_mfma_f32_16x16x32_bf16 v[140:143], a[112:115], v[216:219], v[140:143]
  v_mfma_f32_16x16x32_bf16 v[144:147], a[116:119], v[216:219], v[144:147]
  v_mfma_f32_16x16x32_bf16 v[148:151], a[108:111], v[220:223], v[148:151]
  ds_read_b128 v[188:191], v18 offset:14336
  v_mfma_f32_16x16x32_bf16 v[152:155], a[112:115], v[220:223], v[152:155]
  v_mfma_f32_16x16x32_bf16 v[156:159], a[116:119], v[220:223], v[156:159]
  s_waitcnt lgkmcnt(4)
  v_mfma_f32_16x16x32_bf16 v[64:67], a[120:123], v[160:163], v[64:67]
  ds_read_b128 v[192:195], v19 offset:0
  v_mfma_f32_16x16x32_bf16 v[68:71], a[124:127], v[160:163], v[68:71]
  v_add_u32 v18, s33, v14
  v_mfma_f32_16x16x32_bf16 v[72:75], a[128:131], v[160:163], v[72:75]
  v_mfma_f32_16x16x32_bf16 v[76:79], a[120:123], v[164:167], v[76:79]
  ds_read_b128 v[196:199], v19 offset:2048
  v_mfma_f32_16x16x32_bf16 v[80:83], a[124:127], v[164:167], v[80:83]
  buffer_load_dwordx4 v12, s[8:11], s30 offen offset:2048 lds
  v_mfma_f32_16x16x32_bf16 v[84:87], a[128:131], v[164:167], v[84:87]
  v_mfma_f32_16x16x32_bf16 v[88:91], a[120:123], v[168:171], v[88:91]
  ds_read_b128 v[200:203], v19 offset:4096
  v_mfma_f32_16x16x32_bf16 v[92:95], a[124:127], v[168:171], v[92:95]
  v_mfma_f32_16x16x32_bf16 v[96:99], a[128:131], v[168:171], v[96:99]
  v_mfma_f32_16x16x32_bf16 v[100:103], a[120:123], v[172:175], v[100:103]
  ds_read_b128 v[204:207], v19 offset:6144
  v_mfma_f32_16x16x32_bf16 v[104:107], a[124:127], v[172:175], v[104:107]
  v_mfma_f32_16x16x32_bf16 v[108:111], a[128:131], v[172:175], v[108:111]
  s_waitcnt lgkmcnt(4)
  v_mfma_f32_16x16x32_bf16 v[112:115], a[120:123], v[176:179], v[112:115]
  ds_read_b128 v[208:211], v19 offset:8192
  v_mfma_f32_16x16x32_bf16 v[116:119], a[124:127], v[176:179], v[116:119]
  v_mfma_f32_16x16x32_bf16 v[120:123], a[128:131], v[176:179], v[120:123]
  v_mfma_f32_16x16x32_bf16 v[124:127], a[120:123], v[180:183], v[124:127]
  ds_read_b128 v[212:215], v19 offset:10240
  v_mfma_f32_16x16x32_bf16 v[128:131], a[124:127], v[180:183], v[128:131]
  buffer_load_dwordx4 v13, s[8:11], s30 offen offset:3072 lds
  v_mfma_f32_16x16x32_bf16 v[132:135], a[128:131], v[180:183], v[132:135]
  s_add_u32 s30, s30, s25
  s_sub_u32 s30, s30, 1152
  v_mfma_f32_16x16x32_bf16 v[136:139], a[120:123], v[184:187], v[136:139]
  ds_read_b128 v[216:219], v19 offset:12288
  s_mov_b32 s25, 163840
  v_mfma_f32_16x16x32_bf16 v[140:143], a[124:127], v[184:187], v[140:143]
  s_add_u32 m0, m0, 16384
  v_mfma_f32_16x16x32_bf16 v[144:147], a[128:131], v[184:187], v[144:147]
  s_cmp_lt_u32 m0, s46
  s_cselect_b32 m0, m0, s47
  v_mfma_f32_16x16x32_bf16 v[148:151], a[120:123], v[188:191], v[148:151]
  ds_read_b128 v[220:223], v19 offset:14336
  v_mfma_f32_16x16x32_bf16 v[152:155], a[124:127], v[188:191], v[152:155]
  v_mfma_f32_16x16x32_bf16 v[156:159], a[128:131], v[188:191], v[156:159]
  s_waitcnt vmcnt(13) lgkmcnt(4)
  s_barrier
  v_mfma_f32_16x16x32_bf16 v[64:67], a[132:135], v[192:195], v[64:67]
  ds_read_b128 v[160:163], v18 offset:0
  v_mfma_f32_16x16x32_bf16 v[68:71], a[136:139], v[192:195], v[68:71]
  buffer_store_dwordx4 v[236:239], v30, s[56:59], s81 offen sc1
  s_mov_b64 exec, 0xffffffff
  buffer_store_dwordx4 v[240:243], v30, s[56:59], s81 offen offset:1024 sc1
  s_mov_b64 exec, -1
  buffer_store_dwordx2 v[244:245], v32, s[56:59], s81 offen offset:2048 sc1
  s_mov_b32 s78, s82
  s_mov_b32 s82, 0
  s_mov_b32 s81, 0x80000000
  v_mfma_f32_16x16x32_bf16 v[72:75], a[140:143], v[192:195], v[72:75]
  v_add_u32 v19, s33, v15
  s_add_u32 s33, s33, 16384
  v_mfma_f32_16x16x32_bf16 v[76:79], a[132:135], v[196:199], v[76:79]
  ds_read_b128 v[164:167], v18 offset:2048
  v_mfma_f32_16x16x32_bf16 v[80:83], a[136:139], v[196:199], v[80:83]
  buffer_load_dwordx4 v10, s[8:11], s30 offen offset:0 lds
  v_mfma_f32_16x16x32_bf16 v[84:87], a[140:143], v[196:199], v[84:87]
  s_cmp_lt_u32 s33, 98304
  s_cselect_b32 s33, s33, 0
  v_mfma_f32_16x16x32_bf16 v[88:91], a[132:135], v[200:203], v[88:91]
  ds_read_b128 v[168:171], v18 offset:4096
  v_mfma_f32_16x16x32_bf16 v[92:95], a[136:139], v[200:203], v[92:95]
  v_mfma_f32_16x16x32_bf16 v[96:99], a[140:143], v[200:203], v[96:99]
  v_mfma_f32_16x16x32_bf16 v[100:103], a[132:135], v[204:207], v[100:103]
  ds_read_b128 v[172:175], v18 offset:6144
  v_mfma_f32_16x16x32_bf16 v[104:107], a[136:139], v[204:207], v[104:107]
  v_mfma_f32_16x16x32_bf16 v[108:111], a[140:143], v[204:207], v[108:111]
  s_waitcnt lgkmcnt(4)
  v_mfma_f32_16x16x32_bf16 v[112:115], a[132:135], v[208:211], v[112:115]
  ds_read_b128 v[176:179], v18 offset:8192
  v_mfma_f32_16x16x32_bf16 v[116:119], a[136:139], v[208:211], v[116:119]
  v_mfma_f32_16x16x32_bf16 v[120:123], a[140:143], v[208:211], v[120:123]
  v_mfma_f32_16x16x32_bf16 v[124:127], a[132:135], v[212:215], v[124:127]
  ds_read_b128 v[180:183], v18 offset:10240
  v_mfma_f32_16x16x32_bf16 v[128:131], a[136:139], v[212:215], v[128:131]
  buffer_load_dwordx4 v11, s[8:11], s30 offen offset:1024 lds
  v_mfma_f32_16x16x32_bf16 v[132:135], a[140:143], v[212:215], v[132:135]
  v_mfma_f32_16x16x32_bf16 v[136:139], a[132:135], v[216:219], v[136:139]
  ds_read_b128 v[184:187], v18 offset:12288
  v_mfma_f32_16x16x32_bf16 v[140:143], a[136:139], v[216:219], v[140:143]
  v_mfma_f32_16x16x32_bf16 v[144:147], a[140:143], v[216:219], v[144:147]
  v_mfma_f32_16x16x32_bf16 v[148:151], a[132:135], v[220:223], v[148:151]
  ds_read_b128 v[188:191], v18 offset:14336
  v_mfma_f32_16x16x32_bf16 v[152:155], a[136:139], v[220:223], v[152:155]
  v_mfma_f32_16x16x32_bf16 v[156:159], a[140:143], v[220:223], v[156:159]
  s_waitcnt lgkmcnt(4)
  v_mfma_f32_16x16x32_bf16 v[64:67], a[144:147], v[160:163], v[64:67]
  ds_read_b128 v[192:195], v19 offset:0
  v_mfma_f32_16x16x32_bf16 v[68:71], a[148:151], v[160:163], v[68:71]
  v_add_u32 v18, s33, v14
  v_mfma_f32_16x16x32_bf16 v[72:75], a[152:155], v[160:163], v[72:75]
  v_mfma_f32_16x16x32_bf16 v[76:79], a[144:147], v[164:167], v[76:79]
  ds_read_b128 v[196:199], v19 offset:2048
  v_mfma_f32_16x16x32_bf16 v[80:83], a[148:151], v[164:167], v[80:83]
  buffer_load_dwordx4 v12, s[8:11], s30 offen offset:2048 lds
  v_mfma_f32_16x16x32_bf16 v[84:87], a[152:155], v[164:167], v[84:87]
  v_mfma_f32_16x16x32_bf16 v[88:91], a[144:147], v[168:171], v[88:91]
  ds_read_b128 v[200:203], v19 offset:4096
  v_mfma_f32_16x16x32_bf16 v[92:95], a[148:151], v[168:171], v[92:95]
  v_mfma_f32_16x16x32_bf16 v[96:99], a[152:155], v[168:171], v[96:99]
  v_mfma_f32_16x16x32_bf16 v[100:103], a[144:147], v[172:175], v[100:103]
  ds_read_b128 v[204:207], v19 offset:6144
  v_mfma_f32_16x16x32_bf16 v[104:107], a[148:151], v[172:175], v[104:107]
  v_mfma_f32_16x16x32_bf16 v[108:111], a[152:155], v[172:175], v[108:111]
  s_waitcnt lgkmcnt(4)
  v_mfma_f32_16x16x32_bf16 v[112:115], a[144:147], v[176:179], v[112:115]
  ds_read_b128 v[208:211], v19 offset:8192
  v_mfma_f32_16x16x32_bf16 v[116:119], a[148:151], v[176:179], v[116:119]
  v_mfma_f32_16x16x32_bf16 v[120:123], a[152:155], v[176:179], v[120:123]
  v_mfma_f32_16x16x32_bf16 v[124:127], a[144:147], v[180:183], v[124:127]
  ds_read_b128 v[212:215], v19 offset:10240
  v_mfma_f32_16x16x32_bf16 v[128:131], a[148:151], v[180:183], v[128:131]
  buffer_load_dwordx4 v13, s[8:11], s30 offen offset:3072 lds
  v_mfma_f32_16x16x32_bf16 v[132:135], a[152:155], v[180:183], v[132:135]
  s_add_u32 s30, s30, 128
  s_add_u32 m0, m0, 16384
  v_mfma_f32_16x16x32_bf16 v[136:139], a[144:147], v[184:187], v[136:139]
  ds_read_b128 v[216:219], v19 offset:12288
  v_mfma_f32_16x16x32_bf16 v[140:143], a[148:151], v[184:187], v[140:143]
  s_cmp_lt_u32 m0, s46
  s_cselect_b32 m0, m0, s47
  v_mfma_f32_16x16x32_bf16 v[144:147], a[152:155], v[184:187], v[144:147]
  v_mfma_f32_16x16x32_bf16 v[148:151], a[144:147], v[188:191], v[148:151]
  ds_read_b128 v[220:223], v19 offset:14336
  v_mfma_f32_16x16x32_bf16 v[152:155], a[148:151], v[188:191], v[152:155]
  v_mfma_f32_16x16x32_bf16 v[156:159], a[152:155], v[188:191], v[156:159]
  s_waitcnt vmcnt(15) lgkmcnt(4)
  s_barrier
  v_mfma_f32_16x16x32_bf16 v[64:67], a[156:159], v[192:195], v[64:67]
  ds_read_b128 v[160:163], v18 offset:0
  v_mfma_f32_16x16x32_bf16 v[68:71], a[160:163], v[192:195], v[68:71]
  v_readfirstlane_b32 s79, v20
  v_mfma_f32_16x16x32_bf16 v[72:75], a[164:167], v[192:195], v[72:75]
  v_add_u32 v19, s33, v15
  s_add_u32 s33, s33, 16384
  v_mfma_f32_16x16x32_bf16 v[76:79], a[156:159], v[196:199], v[76:79]
  ds_read_b128 v[164:167], v18 offset:2048
  s_add_u32 s21, s50, 0
  v_mfma_f32_16x16x32_bf16 v[80:83], a[160:163], v[196:199], v[80:83]
  buffer_load_dwordx4 v10, s[8:11], s30 offen offset:0 lds
  v_mfma_f32_16x16x32_bf16 v[84:87], a[164:167], v[196:199], v[84:87]
  s_cmp_lt_u32 s33, 98304
  s_cselect_b32 s33, s33, 0
  v_mfma_f32_16x16x32_bf16 v[88:91], a[156:159], v[200:203], v[88:91]
  ds_read_b128 v[168:171], v18 offset:4096
  v_mfma_f32_16x16x32_bf16 v[92:95], a[160:163], v[200:203], v[92:95]
  buffer_load_dwordx4 v[36:39], v30, s[16:19], s21 offen offset:0 sc1
  v_mfma_f32_16x16x32_bf16 v[96:99], a[164:167], v[200:203], v[96:99]
  v_mfma_f32_16x16x32_bf16 v[100:103], a[156:159], v[204:207], v[100:103]
  ds_read_b128 v[172:175], v18 offset:6144
  v_mfma_f32_16x16x32_bf16 v[104:107], a[160:163], v[204:207], v[104:107]
  v_mfma_f32_16x16x32_bf16 v[108:111], a[164:167], v[204:207], v[108:111]
  s_waitcnt lgkmcnt(4)
  v_mfma_f32_16x16x32_bf16 v[112:115], a[156:159], v[208:211], v[112:115]
  ds_read_b128 v[176:179], v18 offset:8192
  v_mfma_f32_16x16x32_bf16 v[116:119], a[160:163], v[208:211], v[116:119]
  buffer_load_dwordx4 v[40:43], v30, s[16:19], s21 offen offset:1024 sc1
  v_mfma_f32_16x16x32_bf16 v[120:123], a[164:167], v[208:211], v[120:123]
  v_mfma_f32_16x16x32_bf16 v[124:127], a[156:159], v[212:215], v[124:127]
  ds_read_b128 v[180:183], v18 offset:10240
  v_mfma_f32_16x16x32_bf16 v[128:131], a[160:163], v[212:215], v[128:131]
  buffer_load_dwordx4 v11, s[8:11], s30 offen offset:1024 lds
  v_mfma_f32_16x16x32_bf16 v[132:135], a[164:167], v[212:215], v[132:135]
  v_mfma_f32_16x16x32_bf16 v[136:139], a[156:159], v[216:219], v[136:139]
  ds_read_b128 v[184:187], v18 offset:12288
  v_mfma_f32_16x16x32_bf16 v[140:143], a[160:163], v[216:219], v[140:143]
  buffer_load_dwordx4 v[44:47], v30, s[16:19], s21 offen offset:2048 sc1
  v_mfma_f32_16x16x32_bf16 v[144:147], a[164:167], v[216:219], v[144:147]
  v_mfma_f32_16x16x32_bf16 v[148:151], a[156:159], v[220:223], v[148:151]
  ds_read_b128 v[188:191], v18 offset:14336
  v_mfma_f32_16x16x32_bf16 v[152:155], a[160:163], v[220:223], v[152:155]
  v_mfma_f32_16x16x32_bf16 v[156:159], a[164:167], v[220:223], v[156:159]
  s_waitcnt lgkmcnt(4)
  v_mfma_f32_16x16x32_bf16 v[64:67], a[168:171], v[160:163], v[64:67]
  ds_read_b128 v[192:195], v19 offset:0
  v_mfma_f32_16x16x32_bf16 v[68:71], a[172:175], v[160:163], v[68:71]
  v_add_u32 v18, s33, v14
  v_mfma_f32_16x16x32_bf16 v[72:75], a[176:179], v[160:163], v[72:75]
  buffer_load_dwordx4 v[48:51], v30, s[16:19], s21 offen offset:3072 sc1
  v_mfma_f32_16x16x32_bf16 v[76:79], a[168:171], v[164:167], v[76:79]
  ds_read_b128 v[196:199], v19 offset:2048
  v_mfma_f32_16x16x32_bf16 v[80:83], a[172:175], v[164:167], v[80:83]
  buffer_load_dwordx4 v12, s[8:11], s30 offen offset:2048 lds
  v_mfma_f32_16x16x32_bf16 v[84:87], a[176:179], v[164:167], v[84:87]
  v_mfma_f32_16x16x32_bf16 v[88:91], a[168:171], v[168:171], v[88:91]
  ds_read_b128 v[200:203], v19 offset:4096
  v_mfma_f32_16x16x32_bf16 v[92:95], a[172:175], v[168:171], v[92:95]
  s_add_u32 s21, s50, 4096
  v_mfma_f32_16x16x32_bf16 v[96:99], a[176:179], v[168:171], v[96:99]
  buffer_load_dwordx4 v[52:55], v30, s[16:19], s21 offen offset:0 sc1
  v_mfma_f32_16x16x32_bf16 v[100:103], a[168:171], v[172:175], v[100:103]
  ds_read_b128 v[204:207], v19 offset:6144
  v_mfma_f32_16x16x32_bf16 v[104:107], a[172:175], v[172:175], v[104:107]
  v_mfma_f32_16x16x32_bf16 v[108:111], a[176:179], v[172:175], v[108:111]
  s_waitcnt lgkmcnt(4)
  v_mfma_f32_16x16x32_bf16 v[112:115], a[168:171], v[176:179], v[112:115]
  ds_read_b128 v[208:211], v19 offset:8192
  v_mfma_f32_16x16x32_bf16 v[116:119], a[172:175], v[176:179], v[116:119]
  buffer_load_dwordx4 v[56:59], v30, s[16:19], s21 offen offset:1024 sc1
  v_mfma_f32_16x16x32_bf16 v[120:123], a[176:179], v[176:179], v[120:123]
  v_mfma_f32_16x16x32_bf16 v[124:127], a[168:171], v[180:183], v[124:127]
  ds_read_b128 v[212:215], v19 offset:10240
  v_mfma_f32_16x16x32_bf16 v[128:131], a[172:175], v[180:183], v[128:131]
  buffer_load_dwordx4 v13, s[8:11], s30 offen offset:3072 lds
  v_mfma_f32_16x16x32_bf16 v[132:135], a[176:179], v[180:183], v[132:135]
  s_add_u32 s30, s30, 128
  s_add_u32 m0, m0, 16384
  v_mfma_f32_16x16x32_bf16 v[136:139], a[168:171], v[184:187], v[136:139]
  ds_read_b128 v[216:219], v19 offset:12288
  v_mfma_f32_16x16x32_bf16 v[140:143], a[172:175], v[184:187], v[140:143]
  s_cmp_lt_u32 m0, s46
  s_cselect_b32 m0, m0, s47
  v_mfma_f32_16x16x32_bf16 v[144:147], a[176:179], v[184:187], v[144:147]
  buffer_load_dwordx4 v[60:63], v30, s[16:19], s21 offen offset:2048 sc1
  v_mfma_f32_16x16x32_bf16 v[148:151], a[168:171], v[188:191], v[148:151]
  ds_read_b128 v[220:223], v19 offset:14336
  v_mfma_f32_16x16x32_bf16 v[152:155], a[172:175], v[188:191], v[152:155]
  v_mfma_f32_16x16x32_bf16 v[156:159], a[176:179], v[188:191], v[156:159]
  s_waitcnt vmcnt(22) lgkmcnt(4)
  s_barrier
  v_mfma_f32_16x16x32_bf16 v[64:67], a[180:183], v[192:195], v[64:67]
  ds_read_b128 v[160:163], v18 offset:0
  v_mfma_f32_16x16x32_bf16 v[68:71], a[184:187], v[192:195], v[68:71]
  buffer_load_dwordx4 v[236:239], v30, s[16:19], s21 offen offset:3072 sc1
  v_mfma_f32_16x16x32_bf16 v[72:75], a[188:191], v[192:195], v[72:75]
  v_add_u32 v19, s33, v15
  s_add_u32 s33, s33, 16384
  v_mfma_f32_16x16x32_bf16 v[76:79], a[180:183], v[196:199], v[76:79]
  ds_read_b128 v[164:167], v18 offset:2048
  v_mfma_f32_16x16x32_bf16 v[80:83], a[184:187], v[196:199], v[80:83]
  buffer_load_dwordx4 v10, s[8:11], s30 offen offset:0 lds
  v_mfma_f32_16x16x32_bf16 v[84:87], a[188:191], v[196:199], v[84:87]
  s_cmp_lt_u32 s33, 98304
  s_cselect_b32 s33, s33, 0
  v_mfma_f32_16x16x32_bf16 v[88:91], a[180:183], v[200:203], v[88:91]
  ds_read_b128 v[168:171], v18 offset:4096
  s_add_u32 s21, s50, 8192
  v_mfma_f32_16x16x32_bf16 v[92:95], a[184:187], v[200:203], v[92:95]
  buffer_load_dwordx4 v[240:243], v30, s[16:19], s21 offen offset:0 sc1
  v_mfma_f32_16x16x32_bf16 v[96:99], a[188:191], v[200:203], v[96:99]
  v_mfma_f32_16x16x32_bf16 v[100:103], a[180:183], v[204:207], v[100:103]
  ds_read_b128 v[172:175], v18 offset:6144
  v_mfma_f32_16x16x32_bf16 v[104:107], a[184:187], v[204:207], v[104:107]
  v_mfma_f32_16x16x32_bf16 v[108:111], a[188:191], v[204:207], v[108:111]
  s_waitcnt lgkmcnt(4)
  v_mfma_f32_16x16x32_bf16 v[112:115], a[180:183], v[208:211], v[112:115]
  ds_read_b128 v[176:179], v18 offset:8192
  v_mfma_f32_16x16x32_bf16 v[116:119], a[184:187], v[208:211], v[116:119]
  buffer_load_dwordx4 v[244:247], v30, s[16:19], s21 offen offset:1024 sc1
  v_mfma_f32_16x16x32_bf16 v[120:123], a[188:191], v[208:211], v[120:123]
  v_mfma_f32_16x16x32_bf16 v[124:127], a[180:183], v[212:215], v[124:127]
  ds_read_b128 v[180:183], v18 offset:10240
  v_mfma_f32_16x16x32_bf16 v[128:131], a[184:187], v[212:215], v[128:131]
  buffer_load_dwordx4 v11, s[8:11], s30 offen offset:1024 lds
  v_mfma_f32_16x16x32_bf16 v[132:135], a[188:191], v[212:215], v[132:135]
  v_mfma_f32_16x16x32_bf16 v[136:139], a[180:183], v[216:219], v[136:139]
  ds_read_b128 v[184:187], v18 offset:12288
  v_mfma_f32_16x16x32_bf16 v[140:143], a[184:187], v[216:219], v[140:143]
  buffer_load_dwordx4 v[248:251], v30, s[16:19], s21 offen offset:2048 sc1
  v_mfma_f32_16x16x32_bf16 v[144:147], a[188:191], v[216:219], v[144:147]
  v_mfma_f32_16x16x32_bf16 v[148:151], a[180:183], v[220:223], v[148:151]
  ds_read_b128 v[188:191], v18 offset:14336
  v_mfma_f32_16x16x32_bf16 v[152:155], a[184:187], v[220:223], v[152:155]
  v_mfma_f32_16x16x32_bf16 v[156:159], a[188:191], v[220:223], v[156:159]
  s_waitcnt lgkmcnt(4)
  v_mfma_f32_16x16x32_bf16 v[64:67], a[192:195], v[160:163], v[64:67]
  ds_read_b128 v[192:195], v19 offset:0
  v_mfma_f32_16x16x32_bf16 v[68:71], a[196:199], v[160:163], v[68:71]
  v_add_u32 v18, s33, v14
  v_mfma_f32_16x16x32_bf16 v[72:75], a[200:203], v[160:163], v[72:75]
  buffer_load_dwordx4 v[252:255], v30, s[16:19], s21 offen offset:3072 sc1
  v_mfma_f32_16x16x32_bf16 v[76:79], a[192:195], v[164:167], v[76:79]
  ds_read_b128 v[196:199], v19 offset:2048
  v_mfma_f32_16x16x32_bf16 v[80:83], a[196:199], v[164:167], v[80:83]
  buffer_load_dwordx4 v12, s[8:11], s30 offen offset:2048 lds
  v_mfma_f32_16x16x32_bf16 v[84:87], a[200:203], v[164:167], v[84:87]
  v_mfma_f32_16x16x32_bf16 v[88:91], a[192:195], v[168:171], v[88:91]
  ds_read_b128 v[200:203], v19 offset:4096
  v_mfma_f32_16x16x32_bf16 v[92:95], a[196:199], v[168:171], v[92:95]
  buffer_load_dword v21, v33, s[72:75], s77 offen sc1
  v_mfma_f32_16x16x32_bf16 v[96:99], a[200:203], v[168:171], v[96:99]
  v_mfma_f32_16x16x32_bf16 v[100:103], a[192:195], v[172:175], v[100:103]
  ds_read_b128 v[204:207], v19 offset:6144
  v_mfma_f32_16x16x32_bf16 v[104:107], a[196:199], v[172:175], v[104:107]
  v_mfma_f32_16x16x32_bf16 v[108:111], a[200:203], v[172:175], v[108:111]
  s_waitcnt lgkmcnt(4)
  v_mfma_f32_16x16x32_bf16 v[112:115], a[192:195], v[176:179], v[112:115]
  ds_read_b128 v[208:211], v19 offset:8192
  v_mfma_f32_16x16x32_bf16 v[116:119], a[196:199], v[176:179], v[116:119]
  v_mfma_f32_16x16x32_bf16 v[120:123], a[200:203], v[176:179], v[120:123]
  v_mfma_f32_16x16x32_bf16 v[124:127], a[192:195], v[180:183], v[124:127]
  ds_read_b128 v[212:215], v19 offset:10240
  v_mfma_f32_16x16x32_bf16 v[128:131], a[196:199], v[180:183], v[128:131]
  buffer_load_dwordx4 v13, s[8:11], s30 offen offset:3072 lds
  v_mfma_f32_16x16x32_bf16 v[132:135], a[200:203], v[180:183], v[132:135]
  s_add_u32 s30, s30, 128
  s_add_u32 m0, m0, 16384
  v_mfma_f32_16x16x32_bf16 v[136:139], a[192:195], v[184:187], v[136:139]
  ds_read_b128 v[216:219], v19 offset:12288
  v_mfma_f32_16x16x32_bf16 v[140:143], a[196:199], v[184:187], v[140:143]
  s_cmp_lt_u32 m0, s46
  s_cselect_b32 m0, m0, s47
  v_mfma_f32_16x16x32_bf16 v[144:147], a[200:203], v[184:187], v[144:147]
  v_mfma_f32_16x16x32_bf16 v[148:151], a[192:195], v[188:191], v[148:151]
  ds_read_b128 v[220:223], v19 offset:14336
  v_mfma_f32_16x16x32_bf16 v[152:155], a[196:199], v[188:191], v[152:155]
  v_mfma_f32_16x16x32_bf16 v[156:159], a[200:203], v[188:191], v[156:159]
  s_waitcnt vmcnt(28) lgkmcnt(4)
  s_barrier
  v_mfma_f32_16x16x32_bf16 v[64:67], a[204:207], v[192:195], v[64:67]
  ds_read_b128 v[160:163], v18 offset:0
  v_mfma_f32_16x16x32_bf16 v[68:71], a[208:211], v[192:195], v[68:71]
  s_waitcnt vmcnt(25)
  s_cmp_eq_u32 s78, 0
  s_cbranch_scc1 pf_206
  v_mov_b32 v4, 0
  v_mov_b32 v5, 1
  s_mov_b64 exec, 1
  buffer_atomic_add v5, v4, s[72:75], s78 offen sc1
  s_mov_b64 exec, -1
  s_mov_b32 s78, 0
pf_206:
  v_mfma_f32_16x16x32_bf16 v[72:75], a[212:215], v[192:195], v[72:75]
  v_add_u32 v19, s33, v15
  s_add_u32 s33, s33, 16384
  v_mfma_f32_16x16x32_bf16 v[76:79], a[204:207], v[196:199], v[76:79]
  ds_read_b128 v[164:167], v18 offset:2048
  v_mfma_f32_16x16x32_bf16 v[80:83], a[208:211], v[196:199], v[80:83]
  buffer_load_dwordx4 v10, s[8:11], s30 offen offset:0 lds
  v_mfma_f32_16x16x32_bf16 v[84:87], a[212:215], v[196:199], v[84:87]
  s_cmp_lt_u32 s33, 98304
  s_cselect_b32 s33, s33, 0
  v_mfma_f32_16x16x32_bf16 v[88:91], a[204:207], v[200:203], v[88:91]
  ds_read_b128 v[168:171], v18 offset:4096
  v_mfma_f32_16x16x32_bf16 v[92:95], a[208:211], v[200:203], v[92:95]
  v_mfma_f32_16x16x32_bf16 v[96:99], a[212:215], v[200:203], v[96:99]
  v_mfma_f32_16x16x32_bf16 v[100:103], a[204:207], v[204:207], v[100:103]
  ds_read_b128 v[172:175], v18 offset:6144
  v_mfma_f32_16x16x32_bf16 v[104:107], a[208:211], v[204:207], v[104:107]
  v_mfma_f32_16x16x32_bf16 v[108:111], a[212:215], v[204:207], v[108:111]
  s_waitcnt lgkmcnt(4)
  v_mfma_f32_16x16x32_bf16 v[112:115], a[204:207], v[208:211], v[112:115]
  ds_read_b128 v[176:179], v18 offset:8192
  v_mfma_f32_16x16x32_bf16 v[116:119], a[208:211], v[208:211], v[116:119]
  v_mfma_f32_16x16x32_bf16 v[120:123], a[212:215], v[208:211], v[120:123]
  v_mfma_f32_16x16x32_bf16 v[124:127], a[204:207], v[212:215], v[124:127]
  ds_read_b128 v[180:183], v18 offset:10240
  v_mfma_f32_16x16x32_bf16 v[128:131], a[208:211], v[212:215], v[128:131]
  buffer_load_dwordx4 v11, s[8:11], s30 offen offset:1024 lds
  v_mfma_f32_16x16x32_bf16 v[132:135], a[212:215], v[212:215], v[132:135]
  v_mfma_f32_16x16x32_bf16 v[136:139], a[204:207], v[216:219], v[136:139]
  ds_read_b128 v[184:187], v18 offset:12288
  v_mfma_f32_16x16x32_bf16 v[140:143], a[208:211], v[216:219], v[140:143]
  v_mfma_f32_16x16x32_bf16 v[144:147], a[212:215], v[216:219], v[144:147]
  v_mfma_f32_16x16x32_bf16 v[148:151], a[204:207], v[220:223], v[148:151]
  ds_read_b128 v[188:191], v18 offset:14336
  v_mfma_f32_16x16x32_bf16 v[152:155], a[208:211], v[220:223], v[152:155]
  v_mfma_f32_16x16x32_bf16 v[156:159], a[212:215], v[220:223], v[156:159]
  s_waitcnt lgkmcnt(4)
  v_mfma_f32_16x16x32_bf16 v[64:67], a[216:219], v[160:163], v[64:67]
  ds_read_b128 v[192:195], v19 offset:0
  v_mfma_f32_16x16x32_bf16 v[68:71], a[220:223], v[160:163], v[68:71]
  v_add_u32 v18, s33, v14
  v_mfma_f32_16x16x32_bf16 v[72:75], a[224:227], v[160:163], v[72:75]
  v_mfma_f32_16x16x32_bf16 v[76:79], a[216:219], v[164:167], v[76:79]
  ds_read_b128 v[196:199], v19 offset:2048
  v_mfma_f32_16x16x32_bf16 v[80:83], a[220:223], v[164:167], v[80:83]
  buffer_load_dwordx4 v12, s[8:11], s30 offen offset:2048 lds
  v_mfma_f32_16x16x32_bf16 v[84:87], a[224:227], v[164:167], v[84:87]
  v_mfma_f32_16x16x32_bf16 v[88:91], a[216:219], v[168:171], v[88:91]
  ds_read_b128 v[200:203], v19 offset:4096
  v_mfma_f32_16x16x32_bf16 v[92:95], a[220:223], v[168:171], v[92:95]
  v_mfma_f32_16x16x32_bf16 v[96:99], a[224:227], v[168:171], v[96:99]
  v_mfma_f32_16x16x32_bf16 v[100:103], a[216:219], v[172:175], v[100:103]
  ds_read_b128 v[204:207], v19 offset:6144
  v_mfma_f32_16x16x32_bf16 v[104:107], a[220:223], v[172:175], v[104:107]
  v_mfma_f32_16x16x32_bf16 v[108:111], a[224:227], v[172:175], v[108:111]
  s_waitcnt lgkmcnt(4)
  v_mfma_f32_16x16x32_bf16 v[112:115], a[216:219], v[176:179], v[112:115]
  ds_read_b128 v[208:211], v19 offset:8192
  v_mfma_f32_16x16x32_bf16 v[116:119], a[220:223], v[176:179], v[116:119]
  v_mfma_f32_16x16x32_bf16 v[120:123], a[224:227], v[176:179], v[120:123]
  v_mfma_f32_16x16x32_bf16 v[124:127], a[216:219], v[180:183], v[124:127]
  ds_read_b128 v[212:215], v19 offset:10240
  v_mfma_f32_16x16x32_bf16 v[128:131], a[220:223], v[180:183], v[128:131]
  buffer_load_dwordx4 v13, s[8:11], s30 offen offset:3072 lds
  v_mfma_f32_16x16x32_bf16 v[132:135], a[224:227], v[180:183], v[132:135]
  s_add_u32 s30, s30, 128
  s_add_u32 m0, m0, 16384
  v_mfma_f32_16x16x32_bf16 v[136:139], a[216:219], v[184:187], v[136:139]
  ds_read_b128 v[216:219], v19 offset:12288
  v_mfma_f32_16x16x32_bf16 v[140:143], a[220:223], v[184:187], v[140:143]
  s_cmp_lt_u32 m0, s46
  s_cselect_b32 m0, m0, s47
  v_mfma_f32_16x16x32_bf16 v[144:147], a[224:227], v[184:187], v[144:147]
  v_mfma_f32_16x16x32_bf16 v[148:151], a[216:219], v[188:191], v[148:151]
  ds_read_b128 v[220:223], v19 offset:14336
  v_mfma_f32_16x16x32_bf16 v[152:155], a[220:223], v[188:191], v[152:155]
  v_mfma_f32_16x16x32_bf16 v[156:159], a[224:227], v[188:191], v[156:159]
  s_waitcnt vmcnt(25) lgkmcnt(4)
  s_barrier
  v_mfma_f32_16x16x32_bf16 v[64:67], a[228:231], v[192:195], v[64:67]
  ds_read_b128 v[160:163], v18 offset:0
  v_mfma_f32_16x16x32_bf16 v[68:71], a[232:235], v[192:195], v[68:71]
  v_mfma_f32_16x16x32_bf16 v[72:75], a[236:239], v[192:195], v[72:75]
  v_add_u32 v19, s33, v15
  s_add_u32 s33, s33, 16384
  v_mfma_f32_16x16x32_bf16 v[76:79], a[228:231], v[196:199], v[76:79]
  ds_read_b128 v[164:167], v18 offset:2048
  v_cvt_pk_bf16_f32 v224, v64, v65
  v_cvt_pk_bf16_f32 v225, v66, v67
  v_mfma_f32_16x16x32_bf16 v[80:83], a[232:235], v[196:199], v[80:83]
  buffer_load_dwordx4 v10, s[8:11], s30 offen offset:0 lds
  v_cvt_pk_bf16_f32 v226, v68, v69
  v_cvt_pk_bf16_f32 v227, v70, v71
  v_mfma_f32_16x16x32_bf16 v[84:87], a[236:239], v[196:199], v[84:87]
  s_cmp_lt_u32 s33, 98304
  s_cselect_b32 s33, s33, 0
  v_cvt_pk_bf16_f32 v228, v72, v73
  v_cvt_pk_bf16_f32 v229, v74, v75
  v_mfma_f32_16x16x32_bf16 v[88:91], a[228:231], v[200:203], v[88:91]
  ds_read_b128 v[168:171], v18 offset:4096
  ds_write_b64 v22, v[224:225] offset:0
  v_mfma_f32_16x16x32_bf16 v[92:95], a[232:235], v[200:203], v[92:95]
  ds_write_b64 v22, v[226:227] offset:8
  ds_write_b64 v16, v[228:229] offset:64
  v_mfma_f32_16x16x32_bf16 v[96:99], a[236:239], v[200:203], v[96:99]
  v_cvt_pk_bf16_f32 v230, v76, v77
  v_cvt_pk_bf16_f32 v231, v78, v79
  v_cvt_pk_bf16_f32 v232, v80, v81
  v_cvt_pk_bf16_f32 v233, v82, v83
  v_mfma_f32_16x16x32_bf16 v[100:103], a[228:231], v[204:207], v[100:103]
  ds_read_b128 v[172:175], v18 offset:6144
  v_cvt_pk_bf16_f32 v234, v84, v85
  v_cvt_pk_bf16_f32 v235, v86, v87
  v_mfma_f32_16x16x32_bf16 v[104:107], a[232:235], v[204:207], v[104:107]
  ds_write_b64 v22, v[230:231] offset:6400
  ds_write_b64 v22, v[232:233] offset:6408
  v_mfma_f32_16x16x32_bf16 v[108:111], a[236:239], v[204:207], v[108:111]
  s_waitcnt lgkmcnt(9)
  ds_write_b64 v16, v[234:235] offset:6464
  v_cvt_pk_bf16_f32 v224, v88, v89
  v_mfma_f32_16x16x32_bf16 v[112:115], a[228:231], v[208:211], v[112:115]
  ds_read_b128 v[176:179], v18 offset:8192
  v_cvt_pk_bf16_f32 v225, v90, v91
  v_cvt_pk_bf16_f32 v226, v92, v93
  v_cvt_pk_bf16_f32 v227, v94, v95
  v_mfma_f32_16x16x32_bf16 v[116:119], a[232:235], v[208:211], v[116:119]
  v_cvt_pk_bf16_f32 v228, v96, v97
  v_cvt_pk_bf16_f32 v229, v98, v99
  ds_write_b64 v22, v[224:225] offset:12800
  v_mfma_f32_16x16x32_bf16 v[120:123], a[236:239], v[208:211], v[120:123]
  ds_write_b64 v22, v[226:227] offset:12808
  ds_write_b64 v16, v[228:229] offset:12864
  v_mfma_f32_16x16x32_bf16 v[124:127], a[228:231], v[212:215], v[124:127]
  ds_read_b128 v[180:183], v18 offset:10240
  v_cvt_pk_bf16_f32 v230, v100, v101
  v_cvt_pk_bf16_f32 v231, v102, v103
  v_cvt_pk_bf16_f32 v232, v104, v105
  v_mfma_f32_16x16x32_bf16 v[128:131], a[232:235], v[212:215], v[128:131]
  buffer_load_dwordx4 v11, s[8:11], s30 offen offset:1024 lds
  v_cvt_pk_bf16_f32 v233, v106, v107
  v_cvt_pk_bf16_f32 v234, v108, v109
  v_mfma_f32_16x16x32_bf16 v[132:135], a[236:239], v[212:215], v[132:135]
  v_cvt_pk_bf16_f32 v235, v110, v111
  ds_write_b64 v22, v[230:231] offset:19200
  v_mfma_f32_16x16x32_bf16 v[136:139], a[228:231], v[216:219], v[136:139]
  ds_read_b128 v[184:187], v18 offset:12288
  ds_write_b64 v22, v[232:233] offset:19208
  v_mfma_f32_16x16x32_bf16 v[140:143], a[232:235], v[216:219], v[140:143]
  ds_write_b64 v16, v[234:235] offset:19264
  v_cvt_pk_bf16_f32 v224, v112, v113
  v_cvt_pk_bf16_f32 v225, v114, v115
  v_mfma_f32_16x16x32_bf16 v[144:147], a[236:239], v[216:219], v[144:147]
  v_cvt_pk_bf16_f32 v226, v116, v117
  v_cvt_pk_bf16_f32 v227, v118, v119
  v_cvt_pk_bf16_f32 v228, v120, v121
  v_cvt_pk_bf16_f32 v229, v122, v123
  v_mfma_f32_16x16x32_bf16 v[148:151], a[228:231], v[220:223], v[148:151]
  ds_read_b128 v[188:191], v18 offset:14336
  ds_write_b64 v22, v[224:225] offset:25600
  v_mfma_f32_16x16x32_bf16 v[152:155], a[232:235], v[220:223], v[152:155]
  ds_write_b64 v22, v[226:227] offset:25608
  ds_write_b64 v16, v[228:229] offset:25664
  v_mfma_f32_16x16x32_bf16 v[156:159], a[236:239], v[220:223], v[156:159]
  v_cvt_pk_bf16_f32 v230, v124, v125
  v_cvt_pk_bf16_f32 v231, v126, v127
  v_cvt_pk_bf16_f32 v232, v128, v129
  v_cvt_pk_bf16_f32 v233, v130, v131
qa_end_208:
  v_cvt_pk_bf16_f32 v234, v132, v133
  v_cvt_pk_bf16_f32 v235, v134, v135
  ds_write_b64 v22, v[230:231] offset:32000
  ds_write_b64 v22, v[232:233] offset:32008
  ds_write_b64 v16, v[234:235] offset:32064
  v_cvt_pk_bf16_f32 v224, v136, v137
  v_cvt_pk_bf16_f32 v225, v138, v139
  v_cvt_pk_bf16_f32 v226, v140, v141
  v_cvt_pk_bf16_f32 v227, v142, v143
  v_cvt_pk_bf16_f32 v228, v144, v145
  v_cvt_pk_bf16_f32 v229, v146, v147
  ds_write_b64 v22, v[224:225] offset:38400
  ds_write_b64 v22, v[226:227] offset:38408
  ds_write_b64 v16, v[228:229] offset:38464
  v_cvt_pk_bf16_f32 v230, v148, v149
  v_cvt_pk_bf16_f32 v231, v150, v151
  v_cvt_pk_bf16_f32 v232, v152, v153
  v_cvt_pk_bf16_f32 v233, v154, v155
  v_cvt_pk_bf16_f32 v234, v156, v157
  v_cvt_pk_bf16_f32 v235, v158, v159
  ds_write_b64 v22, v[230:231] offset:44800
  ds_write_b64 v22, v[232:233] offset:44808
  ds_write_b64 v16, v[234:235] offset:44864
  s_add_u32 s23, s49, 1
  s_waitcnt vmcnt(6)
  v_cmp_gt_u32 vcc, s23, v21
  s_mov_b32 s80, 0
  s_nop 0
  s_cbranch_vccnz qk_211
  s_mov_b32 s80, 1
  buffer_load_dwordx4 v[132:135], v31, s[52:55], s51 offen offset:0 sc1
  buffer_load_dwordx4 v[136:139], v31, s[52:55], s51 offen offset:512 sc1
  buffer_load_dwordx4 v[140:143], v31, s[52:55], s51 offen offset:1024 sc1
  buffer_load_dwordx4 v[144:147], v31, s[52:55], s51 offen offset:1536 sc1
  buffer_load_dwordx4 v[148:151], v31, s[52:55], s51 offen offset:2048 sc1
  buffer_load_dwordx4 v[152:155], v31, s[52:55], s51 offen offset:2560 sc1
qk_211:
  s_cmp_ge_u32 s79, 8
  s_cbranch_scc1 qk_210
  v_mov_b32 v156, 0
  s_mov_b32 s101, 0
wf_212:
  buffer_load_dword v157, v156, s[72:75], s76 offen sc1
  s_add_u32 s101, s101, 1
  s_cmp_gt_u32 s101, 131072
  s_cbranch_scc1 main_end
  s_waitcnt vmcnt(0)
  v_readfirstlane_b32 s100, v157
  s_cmp_ge_u32 s100, 8
  s_cbranch_scc1 wf_213
  s_sleep 2
  s_branch wf_212
wf_213:
  s_add_u32 s21, s50, 0
  buffer_load_dwordx4 v[36:39], v30, s[16:19], s21 offen offset:0 sc1
  buffer_load_dwordx4 v[40:43], v30, s[16:19], s21 offen offset:1024 sc1
  buffer_load_dwordx4 v[44:47], v30, s[16:19], s21 offen offset:2048 sc1
  buffer_load_dwordx4 v[48:51], v30, s[16:19], s21 offen offset:3072 sc1
  s_add_u32 s21, s50, 4096
  buffer_load_dwordx4 v[52:55], v30, s[16:19], s21 offen offset:0 sc1
  buffer_load_dwordx4 v[56:59], v30, s[16:19], s21 offen offset:1024 sc1
  buffer_load_dwordx4 v[60:63], v30, s[16:19], s21 offen offset:2048 sc1
  buffer_load_dwordx4 v[236:239], v30, s[16:19], s21 offen offset:3072 sc1
  s_add_u32 s21, s50, 8192
  buffer_load_dwordx4 v[240:243], v30, s[16:19], s21 offen offset:0 sc1
  buffer_load_dwordx4 v[244:247], v30, s[16:19], s21 offen offset:1024 sc1
  buffer_load_dwordx4 v[248:251], v30, s[16:19], s21 offen offset:2048 sc1
  buffer_load_dwordx4 v[252:255], v30, s[16:19], s21 offen offset:3072 sc1
qk_210:
  s_waitcnt lgkmcnt(0)
  s_barrier
  ds_read_b128 v[64:67], v29 offset:0
  ds_read_b128 v[68:71], v29 offset:64
  ds_read_b128 v[72:75], v29 offset:128
  ds_read_b128 v[76:79], v29 offset:192
  ds_read_b128 v[80:83], v29 offset:256
  ds_read_b128 v[84:87], v29 offset:320
  ds_read_b128 v[88:91], v29 offset:6400
  ds_read_b128 v[92:95], v29 offset:6464
  ds_read_b128 v[96:99], v29 offset:6528
  ds_read_b128 v[100:103], v29 offset:6592
  ds_read_b128 v[104:107], v29 offset:6656
  ds_read_b128 v[108:111], v29 offset:6720
  s_waitcnt lgkmcnt(0)
  s_cmp_eq_u32 s80, 1
  s_cselect_b32 s21, s79, 0
  s_cmp_ge_u32 s21, 8
  s_cbranch_scc1 qw_214
  s_waitcnt vmcnt(0)
qw_214:
  v_mfma_f32_16x16x32_bf16 v[112:115], v[36:39], v[64:67], 0
  v_mfma_f32_16x16x32_bf16 v[120:123], v[36:39], v[88:91], 0
  v_mfma_f32_16x16x32_bf16 v[124:127], v[60:63], v[88:91], 0
  v_mfma_f32_16x16x32_bf16 v[112:115], v[40:43], v[68:71], v[112:115]
  v_mfma_f32_16x16x32_bf16 v[120:123], v[40:43], v[92:95], v[120:123]
  v_mfma_f32_16x16x32_bf16 v[124:127], v[236:239], v[92:95], v[124:127]
  v_mfma_f32_16x16x32_bf16 v[112:115], v[44:47], v[72:75], v[112:115]
  v_mfma_f32_16x16x32_bf16 v[120:123], v[44:47], v[96:99], v[120:123]
  v_mfma_f32_16x16x32_bf16 v[124:127], v[240:243], v[96:99], v[124:127]
  v_mfma_f32_16x16x32_bf16 v[112:115], v[48:51], v[76:79], v[112:115]
  v_mfma_f32_16x16x32_bf16 v[120:123], v[48:51], v[100:103], v[120:123]
  v_mfma_f32_16x16x32_bf16 v[124:127], v[244:247], v[100:103], v[124:127]
  v_mfma_f32_16x16x32_bf16 v[112:115], v[52:55], v[80:83], v[112:115]
  v_mfma_f32_16x16x32_bf16 v[120:123], v[52:55], v[104:107], v[120:123]
  v_mfma_f32_16x16x32_bf16 v[124:127], v[248:251], v[104:107], v[124:127]
  v_mfma_f32_16x16x32_bf16 v[112:115], v[56:59], v[84:87], v[112:115]
  v_mfma_f32_16x16x32_bf16 v[120:123], v[56:59], v[108:111], v[120:123]
  v_mfma_f32_16x16x32_bf16 v[124:127], v[252:255], v[108:111], v[124:127]
  s_cmp_eq_u32 s80, 1
  s_cbranch_scc1 qm_215
  s_add_u32 s23, s49, 1
  s_mov_b32 s101, 0
wm_216:
  buffer_load_dword v156, v33, s[72:75], s77 offen sc1
  s_add_u32 s101, s101, 1
  s_cmp_gt_u32 s101, 131072
  s_cbranch_scc1 main_end
  s_waitcnt vmcnt(0)
  v_cmp_gt_u32 vcc, s23, v156
  v_readfirstlane_b32 s100, v156
  s_nop 0
  s_cbranch_vccz wm_217
  s_sleep 4
  s_add_u32 s100, s100, 2
  s_cmp_ge_u32 s100, s23
  s_cbranch_scc1 wm_216
  s_sleep 90
  s_branch wm_216
wm_217:
  buffer_load_dwordx4 v[132:135], v31, s[52:55], s51 offen offset:0 sc1
  buffer_load_dwordx4 v[136:139], v31, s[52:55], s51 offen offset:512 sc1
  buffer_load_dwordx4 v[140:143], v31, s[52:55], s51 offen offset:1024 sc1
  buffer_load_dwordx4 v[144:147], v31, s[52:55], s51 offen offset:1536 sc1
  buffer_load_dwordx4 v[148:151], v31, s[52:55], s51 offen offset:2048 sc1
  buffer_load_dwordx4 v[152:155], v31, s[52:55], s51 offen offset:2560 sc1
qm_215:
  s_waitcnt vmcnt(0)
  v_mfma_f32_16x16x32_bf16 v[116:119], v[132:135], v[64:67], 0
  v_mfma_f32_16x16x32_bf16 v[128:131], v[132:135], v[88:91], 0
  v_mfma_f32_16x16x32_bf16 v[116:119], v[136:139], v[68:71], v[116:119]
  v_mfma_f32_16x16x32_bf16 v[128:131], v[136:139], v[92:95], v[128:131]
  v_mfma_f32_16x16x32_bf16 v[116:119], v[140:143], v[72:75], v[116:119]
  v_mfma_f32_16x16x32_bf16 v[128:131], v[140:143], v[96:99], v[128:131]
  v_mfma_f32_16x16x32_bf16 v[116:119], v[144:147], v[76:79], v[116:119]
  v_mfma_f32_16x16x32_bf16 v[128:131], v[144:147], v[100:103], v[128:131]
  v_mfma_f32_16x16x32_bf16 v[116:119], v[148:151], v[80:83], v[116:119]
  v_mfma_f32_16x16x32_bf16 v[128:131], v[148:151], v[104:107], v[128:131]
  v_mfma_f32_16x16x32_bf16 v[116:119], v[152:155], v[84:87], v[116:119]
  v_mfma_f32_16x16x32_bf16 v[128:131], v[152:155], v[108:111], v[128:131]
  s_lshl_b32 s21, s49, 5
  s_add_u32 s21, s21, s42
  s_mul_i32 s81, s21, 2560
  s_lshl_b32 s82, s49, 3
  s_and_b32 s21, s42, 7
  s_add_u32 s82, s82, s21
  s_lshl_b32 s82, s82, 7
  s_add_u32 s82, s82, 23552
  s_cmp_gt_u32 s26, 1
  s_cselect_b32 s21, s80, 0
  s_cmp_eq_u32 s21, 0
  s_cbranch_scc1 qi_219
  v_mov_b32 v36, v112
  v_mov_b32 v37, v113
  v_mov_b32 v38, v114
  v_mov_b32 v39, v115
  v_mov_b32 v40, v116
  v_mov_b32 v41, v117
  v_mov_b32 v42, v118
  v_mov_b32 v43, v119
  v_mov_b32 v44, v120
  v_mov_b32 v45, v121
  v_mov_b32 v46, v122
  v_mov_b32 v47, v123
  v_mov_b32 v48, v124
  v_mov_b32 v49, v125
  v_mov_b32 v50, v126
  v_mov_b32 v51, v127
  v_mov_b32 v52, v128
  v_mov_b32 v53, v129
  v_mov_b32 v54, v130
  v_mov_b32 v55, v131
  s_branch qd_218
qi_219:
  v_cndmask_b32 v112, v34, v112, s[64:65]
  v_cndmask_b32 v124, v34, v124, s[64:65]
  v_cndmask_b32 v113, v34, v113, s[66:67]
  v_cndmask_b32 v125, v34, v125, s[66:67]
  v_cndmask_b32 v114, v34, v114, s[68:69]
  v_cndmask_b32 v126, v34, v126, s[68:69]
  v_cndmask_b32 v115, v34, v115, s[70:71]
  v_cndmask_b32 v127, v34, v127, s[70:71]
  v_max3_f32 v156, v112, v113, v114
  v_max3_f32 v156, v156, v115, v116
  v_max3_f32 v156, v156, v117, v118
  v_max_f32 v156, v156, v119
  v_mov_b32 v157, v156
  s_nop 1
  v_permlane32_swap_b32 v156, v157
  v_max_f32 v156, v156, v157
  v_mov_b32 v157, v156
  s_nop 1
  v_permlane16_swap_b32 v156, v157
  v_max_f32 v156, v156, v157
  v_mul_f32 v156, s83, v156
  v_fma_f32 v112, v112, s83, -v156
  v_fma_f32 v113, v113, s83, -v156
  v_fma_f32 v114, v114, s83, -v156
  v_fma_f32 v115, v115, s83, -v156
  v_fma_f32 v116, v116, s83, -v156
  v_fma_f32 v117, v117, s83, -v156
  v_fma_f32 v118, v118, s83, -v156
  v_fma_f32 v119, v119, s83, -v156
  v_exp_f32 v112, v112
  v_exp_f32 v113, v113
  v_exp_f32 v114, v114
  v_exp_f32 v115, v115
  v_exp_f32 v116, v116
  v_exp_f32 v117, v117
  v_exp_f32 v118, v118
  v_exp_f32 v119, v119
  s_nop 0
  v_add_f32 v156, v116, v117
  v_add_f32 v156, v156, v118
  v_add_f32 v156, v156, v119
  v_cndmask_b32 v156, 0, v156, s[60:61]
  v_add_f32 v156, v156, v112
  v_add_f32 v156, v156, v113
  v_add_f32 v156, v156, v114
  v_add_f32 v156, v156, v115
  v_mov_b32 v157, v156
  s_nop 1
  v_permlane32_swap_b32 v156, v157
  v_add_f32 v156, v156, v157
  v_mov_b32 v157, v156
  s_nop 1
  v_permlane16_swap_b32 v156, v157
  v_add_f32 v156, v156, v157
  v_rcp_f32 v156, v156
  s_nop 0
  v_mul_f32 v112, v112, v156
  v_mul_f32 v113, v113, v156
  v_mul_f32 v114, v114, v156
  v_mul_f32 v115, v115, v156
  v_mul_f32 v116, v116, v156
  v_mul_f32 v117, v117, v156
  v_mul_f32 v118, v118, v156
  v_mul_f32 v119, v119, v156
  v_max3_f32 v156, v120, v121, v122
  v_max3_f32 v156, v156, v123, v124
  v_max3_f32 v156, v156, v125, v126
  v_max3_f32 v156, v156, v127, v128
  v_max3_f32 v156, v156, v129, v130
  v_max_f32 v156, v156, v131
  v_mov_b32 v157, v156
  s_nop 1
  v_permlane32_swap_b32 v156, v157
  v_max_f32 v156, v156, v157
  v_mov_b32 v157, v156
  s_nop 1
  v_permlane16_swap_b32 v156, v157
  v_max_f32 v156, v156, v157
  v_mul_f32 v156, s83, v156
  v_fma_f32 v120, v120, s83, -v156
  v_fma_f32 v121, v121, s83, -v156
  v_fma_f32 v122, v122, s83, -v156
  v_fma_f32 v123, v123, s83, -v156
  v_fma_f32 v124, v124, s83, -v156
  v_fma_f32 v125, v125, s83, -v156
  v_fma_f32 v126, v126, s83, -v156
  v_fma_f32 v127, v127, s83, -v156
  v_fma_f32 v128, v128, s83, -v156
  v_fma_f32 v129, v129, s83, -v156
  v_fma_f32 v130, v130, s83, -v156
  v_fma_f32 v131, v131, s83, -v156
  v_exp_f32 v120, v120
  v_exp_f32 v121, v121
  v_exp_f32 v122, v122
  v_exp_f32 v123, v123
  v_exp_f32 v124, v124
  v_exp_f32 v125, v125
  v_exp_f32 v126, v126
  v_exp_f32 v127, v127
  v_exp_f32 v128, v128
  v_exp_f32 v129, v129
  v_exp_f32 v130, v130
  v_exp_f32 v131, v131
  s_nop 0
  v_add_f32 v156, v128, v129
  v_add_f32 v156, v156, v130
  v_add_f32 v156, v156, v131
  v_cndmask_b32 v156, 0, v156, s[60:61]
  v_add_f32 v156, v156, v120
  v_add_f32 v156, v156, v121
  v_add_f32 v156, v156, v122
  v_add_f32 v156, v156, v123
  v_add_f32 v156, v156, v124
  v_add_f32 v156, v156, v125
  v_add_f32 v156, v156, v126
  v_add_f32 v156, v156, v127
  v_mov_b32 v157, v156
  s_nop 1
  v_permlane32_swap_b32 v156, v157
  v_add_f32 v156, v156, v157
  v_mov_b32 v157, v156
  s_nop 1
  v_permlane16_swap_b32 v156, v157
  v_add_f32 v156, v156, v157
  v_rcp_f32 v156, v156
  s_nop 0
  v_mul_f32 v120, v120, v156
  v_mul_f32 v121, v121, v156
  v_mul_f32 v122, v122, v156
  v_mul_f32 v123, v123, v156
  v_mul_f32 v124, v124, v156
  v_mul_f32 v125, v125, v156
  v_mul_f32 v126, v126, v156
  v_mul_f32 v127, v127, v156
  v_mul_f32 v128, v128, v156
  v_mul_f32 v129, v129, v156
  v_mul_f32 v130, v130, v156
  v_mul_f32 v131, v131, v156
  v_cvt_pk_bf16_f32 v196, v116, v117
  v_cvt_pk_bf16_f32 v197, v118, v119
  v_cvt_pk_bf16_f32 v198, v128, v129
  v_cvt_pk_bf16_f32 v199, v130, v131
  v_cvt_pk_bf16_f32 v192, v120, v121
  v_cvt_pk_bf16_f32 v193, v122, v123
  v_cvt_pk_bf16_f32 v194, v124, v125
  v_cvt_pk_bf16_f32 v195, v126, v127
  v_cvt_pk_bf16_f32 v200, v112, v113
  v_cvt_pk_bf16_f32 v201, v114, v115
  v_permlane16_swap_b32 v196, v198
  v_permlane16_swap_b32 v197, v199
  buffer_store_dwordx4 v[192:195], v30, s[56:59], s81 offen sc1
  s_mov_b64 exec, 0xffffffff
  buffer_store_dwordx4 v[196:199], v30, s[56:59], s81 offen offset:1024 sc1
  s_mov_b64 exec, -1
  buffer_store_dwordx2 v[200:201], v32, s[56:59], s81 offen offset:2048 sc1
  s_mov_b32 s78, s82
  s_mov_b32 s81, 0x80000000
  s_mov_b32 s82, 0
  s_cmp_eq_u32 s80, 1
  s_cbranch_scc1 qd_218
  s_waitcnt vmcnt(0)
  s_cmp_eq_u32 s78, 0
  s_cbranch_scc1 pf_220
  v_mov_b32 v4, 0
  v_mov_b32 v5, 1
  s_mov_b64 exec, 1
  buffer_atomic_add v5, v4, s[72:75], s78 offen sc1
  s_mov_b64 exec, -1
  s_mov_b32 s78, 0
pf_220:
qd_218:
  s_add_u32 s49, s49, s29
qbe_209:
  s_sub_u32 s26, s26, 1
  s_cmp_gt_u32 s26, 0
  s_waitcnt lgkmcnt(0)
  s_cbranch_scc1 qa_blk_207
  s_waitcnt vmcnt(0) lgkmcnt(0)
  s_add_u32 s12, s38, 201326592
  s_addc_u32 s13, s39, 0
  s_mov_b32 s14, 4718592
  s_mov_b32 s15, 0x00020000
  s_cmp_eq_u32 s78, 0
  s_cbranch_scc1 pf_221
  v_mov_b32 v4, 0
  v_mov_b32 v5, 1
  s_mov_b64 exec, 1
  buffer_atomic_add v5, v4, s[72:75], s78 offen sc1
  s_mov_b64 exec, -1
  s_mov_b32 s78, 0
pf_221:
  s_lshl_b32 s21, s42, 7
  s_add_u32 s21, s21, 112640
  v_mov_b32 v156, 0
  s_mov_b32 s101, 0
wf_222:
  buffer_load_dword v157, v156, s[72:75], s21 offen sc1
  s_add_u32 s101, s101, 1
  s_cmp_gt_u32 s101, 131072
  s_cbranch_scc1 main_end
  s_waitcnt vmcnt(0)
  v_readfirstlane_b32 s100, v157
  s_cmp_ge_u32 s100, 3
  s_cbranch_scc1 wf_223
  s_sleep 16
  s_branch wf_222
wf_223:
qf_224:
  s_mul_i32 s21, s49, 393216
  s_mul_i32 s22, s42, 12288
  s_add_u32 s50, s21, s22
  s_mul_i32 s21, s49, 98304
  s_mul_i32 s22, s42, 3072
  s_add_u32 s51, s21, s22
  s_lshr_b32 s22, s49, 1
  s_lshr_b32 s21, s49, 2
  s_add_u32 s21, s21, 3
  s_cmp_lt_u32 s49, 12
  s_cselect_b32 s21, s22, s21
  s_lshl_b32 s21, s21, 3
  s_lshr_b32 s22, s42, 2
  s_add_u32 s21, s21, s22
  s_lshl_b32 s21, s21, 7
  s_add_u32 s76, s21, 0
  s_lshl_b32 s77, s42, 7
  s_add_u32 s77, s77, 19456
  s_sub_u32 s43, s50, 20447232
  buffer_load_dword v21, v33, s[72:75], s77 offen sc1
  s_add_u32 s21, s50, 0
  buffer_load_dwordx4 v[36:39], v30, s[16:19], s21 offen offset:0 sc1
  buffer_load_dwordx4 v[40:43], v30, s[16:19], s21 offen offset:1024 sc1
  buffer_load_dwordx4 v[44:47], v30, s[16:19], s21 offen offset:2048 sc1
  buffer_load_dwordx4 v[48:51], v30, s[16:19], s21 offen offset:3072 sc1
  s_add_u32 s21, s50, 4096
  buffer_load_dwordx4 v[52:55], v30, s[16:19], s21 offen offset:0 sc1
  buffer_load_dwordx4 v[56:59], v30, s[16:19], s21 offen offset:1024 sc1
  buffer_load_dwordx4 v[60:63], v30, s[16:19], s21 offen offset:2048 sc1
  buffer_load_dwordx4 v[236:239], v30, s[16:19], s21 offen offset:3072 sc1
  s_add_u32 s21, s50, 8192
  buffer_load_dwordx4 v[240:243], v30, s[16:19], s21 offen offset:0 sc1
  buffer_load_dwordx4 v[244:247], v30, s[16:19], s21 offen offset:1024 sc1
  buffer_load_dwordx4 v[248:251], v30, s[16:19], s21 offen offset:2048 sc1
  buffer_load_dwordx4 v[252:255], v30, s[16:19], s21 offen offset:3072 sc1
  s_add_u32 s21, s43, 0
  buffer_load_dwordx4 v[64:67], v30, s[12:15], s21 offen offset:0 sc1
  buffer_load_dwordx4 v[68:71], v30, s[12:15], s21 offen offset:1024 sc1
  buffer_load_dwordx4 v[72:75], v30, s[12:15], s21 offen offset:2048 sc1
  buffer_load_dwordx4 v[76:79], v30, s[12:15], s21 offen offset:3072 sc1
  s_add_u32 s21, s43, 4096
  buffer_load_dwordx4 v[80:83], v30, s[12:15], s21 offen offset:0 sc1
  buffer_load_dwordx4 v[84:87], v30, s[12:15], s21 offen offset:1024 sc1
  buffer_load_dwordx4 v[88:91], v30, s[12:15], s21 offen offset:2048 sc1
  buffer_load_dwordx4 v[92:95], v30, s[12:15], s21 offen offset:3072 sc1
  s_add_u32 s21, s43, 8192
  buffer_load_dwordx4 v[96:99], v30, s[12:15], s21 offen offset:0 sc1
  buffer_load_dwordx4 v[100:103], v30, s[12:15], s21 offen offset:1024 sc1
  buffer_load_dwordx4 v[104:107], v30, s[12:15], s21 offen offset:2048 sc1
  buffer_load_dwordx4 v[108:111], v30, s[12:15], s21 offen offset:3072 sc1
  s_waitcnt vmcnt(24)
  s_cmp_eq_u32 s78, 0
  s_cbranch_scc1 pf_227
  v_mov_b32 v4, 0
  v_mov_b32 v5, 1
  s_mov_b64 exec, 1
  buffer_atomic_add v5, v4, s[72:75], s78 offen sc1
  s_mov_b64 exec, -1
  s_mov_b32 s78, 0
pf_227:
  s_add_u32 s23, s49, 1
  v_cmp_gt_u32 vcc, s23, v21
  s_mov_b32 s80, 0
  s_nop 0
  s_cbranch_vccnz qk_226
  s_mov_b32 s80, 1
  buffer_load_dwordx4 v[132:135], v31, s[52:55], s51 offen offset:0 sc1
  buffer_load_dwordx4 v[136:139], v31, s[52:55], s51 offen offset:512 sc1
  buffer_load_dwordx4 v[140:143], v31, s[52:55], s51 offen offset:1024 sc1
  buffer_load_dwordx4 v[144:147], v31, s[52:55], s51 offen offset:1536 sc1
  buffer_load_dwordx4 v[148:151], v31, s[52:55], s51 offen offset:2048 sc1
  buffer_load_dwordx4 v[152:155], v31, s[52:55], s51 offen offset:2560 sc1
  s_waitcnt vmcnt(6)
  s_branch qk_226x
qk_226:
  s_waitcnt vmcnt(0)
qk_226x:
  v_mfma_f32_16x16x32_bf16 v[112:115], v[36:39], v[64:67], 0
  v_mfma_f32_16x16x32_bf16 v[120:123], v[36:39], v[88:91], 0
  v_mfma_f32_16x16x32_bf16 v[124:127], v[60:63], v[88:91], 0
  v_mfma_f32_16x16x32_bf16 v[112:115], v[40:43], v[68:71], v[112:115]
  v_mfma_f32_16x16x32_bf16 v[120:123], v[40:43], v[92:95], v[120:123]
  v_mfma_f32_16x16x32_bf16 v[124:127], v[236:239], v[92:95], v[124:127]
  v_mfma_f32_16x16x32_bf16 v[112:115], v[44:47], v[72:75], v[112:115]
  v_mfma_f32_16x16x32_bf16 v[120:123], v[44:47], v[96:99], v[120:123]
  v_mfma_f32_16x16x32_bf16 v[124:127], v[240:243], v[96:99], v[124:127]
  v_mfma_f32_16x16x32_bf16 v[112:115], v[48:51], v[76:79], v[112:115]
  v_mfma_f32_16x16x32_bf16 v[120:123], v[48:51], v[100:103], v[120:123]
  v_mfma_f32_16x16x32_bf16 v[124:127], v[244:247], v[100:103], v[124:127]
  v_mfma_f32_16x16x32_bf16 v[112:115], v[52:55], v[80:83], v[112:115]
  v_mfma_f32_16x16x32_bf16 v[120:123], v[52:55], v[104:107], v[120:123]
  v_mfma_f32_16x16x32_bf16 v[124:127], v[248:251], v[104:107], v[124:127]
  v_mfma_f32_16x16x32_bf16 v[112:115], v[56:59], v[84:87], v[112:115]
  v_mfma_f32_16x16x32_bf16 v[120:123], v[56:59], v[108:111], v[120:123]
  v_mfma_f32_16x16x32_bf16 v[124:127], v[252:255], v[108:111], v[124:127]
  s_cmp_eq_u32 s80, 1
  s_cbranch_scc1 qm_228
  s_add_u32 s23, s49, 1
  s_min_u32 s22, s49, 61
  s_cmp_lt_u32 s49, 58
  s_cselect_b32 s23, s23, s22
  s_mov_b32 s101, 0
wm_229:
  buffer_load_dword v156, v33, s[72:75], s77 offen sc1
  s_add_u32 s101, s101, 1
  s_cmp_gt_u32 s101, 131072
  s_cbranch_scc1 main_end
  s_waitcnt vmcnt(0)
  v_cmp_gt_u32 vcc, s23, v156
  v_readfirstlane_b32 s100, v156
  s_nop 0
  s_cbranch_vccz wm_230
  s_sleep 4
  s_add_u32 s100, s100, 2
  s_cmp_ge_u32 s100, s23
  s_cbranch_scc1 wm_229
  s_sleep 90
  s_branch wm_229
wm_230:
  s_cmp_eq_u32 s49, 63
  s_cselect_b32 s21, s101, 0
  s_cmp_lt_u32 s21, 2
  s_cbranch_scc1 qtz_233
  s_sleep 36
qtz_233:
  s_mov_b32 s101, 0
  s_branch qtp_232
qtp_231:
  s_sleep 3
qtp_232:
  buffer_load_dwordx4 v[132:135], v31, s[52:55], s51 offen offset:0 sc1
  buffer_load_dwordx4 v[136:139], v31, s[52:55], s51 offen offset:512 sc1
  buffer_load_dwordx4 v[140:143], v31, s[52:55], s51 offen offset:1024 sc1
  buffer_load_dwordx4 v[144:147], v31, s[52:55], s51 offen offset:1536 sc1
  buffer_load_dwordx4 v[148:151], v31, s[52:55], s51 offen offset:2048 sc1
  buffer_load_dwordx4 v[152:155], v31, s[52:55], s51 offen offset:2560 sc1
  s_add_u32 s101, s101, 1
  s_cmp_gt_u32 s101, 131072
  s_cbranch_scc1 main_end
  s_waitcnt vmcnt(0)
  v_max3_u32 v156, v132, v134, v136
  v_max3_u32 v156, v156, v138, v140
  v_max3_u32 v156, v156, v142, v144
  v_max3_u32 v156, v156, v146, v148
  v_max3_u32 v156, v156, v150, v152
  v_max3_u32 v156, v156, v154, v154
  v_cmp_eq_u32 vcc, -1, v156
  s_nop 1
  s_cbranch_vccnz qtp_231
qm_228:
  s_waitcnt vmcnt(0)
  v_mfma_f32_16x16x32_bf16 v[116:119], v[132:135], v[64:67], 0
  v_mfma_f32_16x16x32_bf16 v[128:131], v[132:135], v[88:91], 0
  v_mfma_f32_16x16x32_bf16 v[116:119], v[136:139], v[68:71], v[116:119]
  v_mfma_f32_16x16x32_bf16 v[128:131], v[136:139], v[92:95], v[128:131]
  v_mfma_f32_16x16x32_bf16 v[116:119], v[140:143], v[72:75], v[116:119]
  v_mfma_f32_16x16x32_bf16 v[128:131], v[140:143], v[96:99], v[128:131]
  v_mfma_f32_16x16x32_bf16 v[116:119], v[144:147], v[76:79], v[116:119]
  v_mfma_f32_16x16x32_bf16 v[128:131], v[144:147], v[100:103], v[128:131]
  v_mfma_f32_16x16x32_bf16 v[116:119], v[148:151], v[80:83], v[116:119]
  v_mfma_f32_16x16x32_bf16 v[128:131], v[148:151], v[104:107], v[128:131]
  v_mfma_f32_16x16x32_bf16 v[116:119], v[152:155], v[84:87], v[116:119]
  v_mfma_f32_16x16x32_bf16 v[128:131], v[152:155], v[108:111], v[128:131]
  s_lshl_b32 s21, s49, 5
  s_add_u32 s21, s21, s42
  s_mul_i32 s81, s21, 2560
  s_lshl_b32 s82, s49, 3
  s_and_b32 s21, s42, 7
  s_add_u32 s82, s82, s21
  s_lshl_b32 s82, s82, 7
  s_add_u32 s82, s82, 23552
  v_cndmask_b32 v112, v34, v112, s[64:65]
  v_cndmask_b32 v124, v34, v124, s[64:65]
  v_cndmask_b32 v113, v34, v113, s[66:67]
  v_cndmask_b32 v125, v34, v125, s[66:67]
  v_cndmask_b32 v114, v34, v114, s[68:69]
  v_cndmask_b32 v126, v34, v126, s[68:69]
  v_cndmask_b32 v115, v34, v115, s[70:71]
  v_cndmask_b32 v127, v34, v127, s[70:71]
  v_max3_f32 v156, v112, v113, v114
  v_max3_f32 v156, v156, v115, v116
  v_max3_f32 v156, v156, v117, v118
  v_max_f32 v156, v156, v119
  v_mov_b32 v157, v156
  s_nop 1
  v_permlane32_swap_b32 v156, v157
  v_max_f32 v156, v156, v157
  v_mov_b32 v157, v156
  s_nop 1
  v_permlane16_swap_b32 v156, v157
  v_max_f32 v156, v156, v157
  v_mul_f32 v156, s83, v156
  v_fma_f32 v112, v112, s83, -v156
  v_fma_f32 v113, v113, s83, -v156
  v_fma_f32 v114, v114, s83, -v156
  v_fma_f32 v115, v115, s83, -v156
  v_fma_f32 v116, v116, s83, -v156
  v_fma_f32 v117, v117, s83, -v156
  v_fma_f32 v118, v118, s83, -v156
  v_fma_f32 v119, v119, s83, -v156
  v_exp_f32 v112, v112
  v_exp_f32 v113, v113
  v_exp_f32 v114, v114
  v_exp_f32 v115, v115
  v_exp_f32 v116, v116
  v_exp_f32 v117, v117
  v_exp_f32 v118, v118
  v_exp_f32 v119, v119
  s_nop 0
  v_add_f32 v156, v116, v117
  v_add_f32 v156, v156, v118
  v_add_f32 v156, v156, v119
  v_cndmask_b32 v156, 0, v156, s[60:61]
  v_add_f32 v156, v156, v112
  v_add_f32 v156, v156, v113
  v_add_f32 v156, v156, v114
  v_add_f32 v156, v156, v115
  v_mov_b32 v157, v156
  s_nop 1
  v_permlane32_swap_b32 v156, v157
  v_add_f32 v156, v156, v157
  v_mov_b32 v157, v156
  s_nop 1
  v_permlane16_swap_b32 v156, v157
  v_add_f32 v156, v156, v157
  v_rcp_f32 v156, v156
  s_nop 0
  v_mul_f32 v112, v112, v156
  v_mul_f32 v113, v113, v156
  v_mul_f32 v114, v114, v156
  v_mul_f32 v115, v115, v156
  v_mul_f32 v116, v116, v156
  v_mul_f32 v117, v117, v156
  v_mul_f32 v118, v118, v156
  v_mul_f32 v119, v119, v156
  v_max3_f32 v156, v120, v121, v122
  v_max3_f32 v156, v156, v123, v124
  v_max3_f32 v156, v156, v125, v126
  v_max3_f32 v156, v156, v127, v128
  v_max3_f32 v156, v156, v129, v130
  v_max_f32 v156, v156, v131
  v_mov_b32 v157, v156
  s_nop 1
  v_permlane32_swap_b32 v156, v157
  v_max_f32 v156, v156, v157
  v_mov_b32 v157, v156
  s_nop 1
  v_permlane16_swap_b32 v156, v157
  v_max_f32 v156, v156, v157
  v_mul_f32 v156, s83, v156
  v_fma_f32 v120, v120, s83, -v156
  v_fma_f32 v121, v121, s83, -v156
  v_fma_f32 v122, v122, s83, -v156
  v_fma_f32 v123, v123, s83, -v156
  v_fma_f32 v124, v124, s83, -v156
  v_fma_f32 v125, v125, s83, -v156
  v_fma_f32 v126, v126, s83, -v156
  v_fma_f32 v127, v127, s83, -v156
  v_fma_f32 v128, v128, s83, -v156
  v_fma_f32 v129, v129, s83, -v156
  v_fma_f32 v130, v130, s83, -v156
  v_fma_f32 v131, v131, s83, -v156
  v_exp_f32 v120, v120
  v_exp_f32 v121, v121
  v_exp_f32 v122, v122
  v_exp_f32 v123, v123
  v_exp_f32 v124, v124
  v_exp_f32 v125, v125
  v_exp_f32 v126, v126
  v_exp_f32 v127, v127
  v_exp_f32 v128, v128
  v_exp_f32 v129, v129
  v_exp_f32 v130, v130
  v_exp_f32 v131, v131
  s_nop 0
  v_add_f32 v156, v128, v129
  v_add_f32 v156, v156, v130
  v_add_f32 v156, v156, v131
  v_cndmask_b32 v156, 0, v156, s[60:61]
  v_add_f32 v156, v156, v120
  v_add_f32 v156, v156, v121
  v_add_f32 v156, v156, v122
  v_add_f32 v156, v156, v123
  v_add_f32 v156, v156, v124
  v_add_f32 v156, v156, v125
  v_add_f32 v156, v156, v126
  v_add_f32 v156, v156, v127
  v_mov_b32 v157, v156
  s_nop 1
  v_permlane32_swap_b32 v156, v157
  v_add_f32 v156, v156, v157
  v_mov_b32 v157, v156
  s_nop 1
  v_permlane16_swap_b32 v156, v157
  v_add_f32 v156, v156, v157
  v_rcp_f32 v156, v156
  s_nop 0
  v_mul_f32 v120, v120, v156
  v_mul_f32 v121, v121, v156
  v_mul_f32 v122, v122, v156
  v_mul_f32 v123, v123, v156
  v_mul_f32 v124, v124, v156
  v_mul_f32 v125, v125, v156
  v_mul_f32 v126, v126, v156
  v_mul_f32 v127, v127, v156
  v_mul_f32 v128, v128, v156
  v_mul_f32 v129, v129, v156
  v_mul_f32 v130, v130, v156
  v_mul_f32 v131, v131, v156
  v_cvt_pk_bf16_f32 v196, v116, v117
  v_cvt_pk_bf16_f32 v197, v118, v119
  v_cvt_pk_bf16_f32 v198, v128, v129
  v_cvt_pk_bf16_f32 v199, v130, v131
  v_cvt_pk_bf16_f32 v192, v120, v121
  v_cvt_pk_bf16_f32 v193, v122, v123
  v_cvt_pk_bf16_f32 v194, v124, v125
  v_cvt_pk_bf16_f32 v195, v126, v127
  v_cvt_pk_bf16_f32 v200, v112, v113
  v_cvt_pk_bf16_f32 v201, v114, v115
  v_permlane16_swap_b32 v196, v198
  v_permlane16_swap_b32 v197, v199
  buffer_store_dwordx4 v[192:195], v30, s[56:59], s81 offen sc1
  s_mov_b64 exec, 0xffffffff
  buffer_store_dwordx4 v[196:199], v30, s[56:59], s81 offen offset:1024 sc1
  s_mov_b64 exec, -1
  buffer_store_dwordx2 v[200:201], v32, s[56:59], s81 offen offset:2048 sc1
  s_mov_b32 s78, s82
  s_mov_b32 s81, 0x80000000
  s_mov_b32 s82, 0
  s_cmp_eq_u32 s80, 1
  s_cbranch_scc1 qd_234
  s_waitcnt vmcnt(0)
  s_cmp_eq_u32 s78, 0
  s_cbranch_scc1 pf_235
  v_mov_b32 v4, 0
  v_mov_b32 v5, 1
  s_mov_b64 exec, 1
  buffer_atomic_add v5, v4, s[72:75], s78 offen sc1
  s_mov_b64 exec, -1
  s_mov_b32 s78, 0
pf_235:
qd_234:
  s_add_u32 s49, s49, s29
qbe_225:
  s_cmp_lt_u32 s49, 64
  s_cbranch_scc1 qf_224
  s_waitcnt vmcnt(0)
  s_cmp_eq_u32 s78, 0
  s_cbranch_scc1 pf_236
  v_mov_b32 v4, 0
  v_mov_b32 v5, 1
  s_mov_b64 exec, 1
  buffer_atomic_add v5, v4, s[72:75], s78 offen sc1
  s_mov_b64 exec, -1
  s_mov_b32 s78, 0
pf_236:
queue:
  s_load_dwordx2 s[4:5], s[0:1], 96
  s_waitcnt lgkmcnt(0)
  s_mov_b32 s32, s4
  s_mov_b32 s33, s5
  s_mov_b32 s34, 256
  s_mov_b32 s35, 0x00020000
  s_waitcnt vmcnt(0) lgkmcnt(0)
  s_barrier
  s_mov_b32 s2, s85
  s_mov_b32 s85, -1
  s_cmp_lg_u32 s2, -1
  s_cbranch_scc1 queue_c
  v_mov_b32 v21, 0
  s_cmp_lg_u32 s20, 0
  s_cbranch_scc1 q_237
  v_mov_b32 v22, 80
  v_mov_b32 v23, 1
  s_mov_b64 exec, 1
  buffer_atomic_add v23, v22, s[32:35], 0 offen sc0 sc1
  s_waitcnt vmcnt(0)
queue_a:
  ds_write_b32 v21, v23
  s_waitcnt lgkmcnt(0)
  s_mov_b64 exec, -1
q_237:
queue_b:
  s_barrier
  ds_read_b32 v23, v21
  s_waitcnt lgkmcnt(0)
  v_readfirstlane_b32 s2, v23
  s_barrier
queue_c:
  s_add_u32 s21, s2, 0
  s_cmp_lt_u32 s2, 350
  s_cbranch_scc1 do_pv
  s_sub_u32 s2, s2, 350
  s_branch main_fin
do_opb:
  s_mov_b32 s87, -1
do_opb2:
  s_mov_b32 s2, s21
  s_load_dwordx2 s[4:5], s[0:1], 0
  s_load_dwordx4 s[40:43], s[0:1], 72
  s_load_dwordx2 s[38:39], s[0:1], 104
  s_lshl_b32 s59, s2, 2
  s_add_u32 s59, s59, s20
  s_lshl_b32 s59, s59, 3
  v_lshlrev_b32 v4, 4, v1
  v_lshlrev_b32 v5, 2, v1
  s_waitcnt lgkmcnt(0)
  s_mov_b32 s8, s4
  s_mov_b32 s9, s5
  s_mov_b32 s10, 2621440
  s_mov_b32 s11, 0x00020000
  s_mov_b32 s12, s42
  s_mov_b32 s13, s43
  s_mov_b32 s14, 1280
  s_mov_b32 s15, 0x00020000
  s_mov_b32 s24, s40
  s_mov_b32 s25, s41
  s_mov_b32 s26, 819200
  s_mov_b32 s27, 0x00020000
  s_add_u32 s16, s38, 70713344
  s_addc_u32 s17, s39, 0
  s_mov_b32 s18, 2641920
  s_mov_b32 s19, 0x00020000
  s_add_u32 s28, s38, 81002496
  s_addc_u32 s29, s39, 0
  s_mov_b32 s30, 8192
  s_mov_b32 s31, 0x00020000
  s_add_u32 s72, s38, 81068032
  s_addc_u32 s73, s39, 0
  s_mov_b32 s74, 116736
  s_mov_b32 s75, 0x00020000
  s_mov_b32 s21, 91136
  v_mov_b32 v20, 0
  buffer_load_dword v21, v20, s[72:75], s21 offen sc1
  v_mov_b32 v29, 3277
  s_mul_i32 s21, s20, 320
  s_add_u32 s21, s21, 0
  v_add_u32 v22, s21, v1
  v_mul_u32_u24 v23, v22, v29
  v_lshrrev_b32 v23, 16, v23
  v_mul_u32_u24 v24, 20, v23
  v_sub_u32 v22, v22, v24
  v_bfe_u32 v24, v23, 3, 1
  v_lshlrev_b32 v24, 1, v24
  v_xor_b32 v22, v22, v24
  v_mul_u32_u24 v23, 1280, v23
  v_lshl_add_u32 v8, v22, 4, v23
  s_mul_i32 s21, s20, 320
  s_add_u32 s21, s21, 64
  v_add_u32 v22, s21, v1
  v_mul_u32_u24 v23, v22, v29
  v_lshrrev_b32 v23, 16, v23
  v_mul_u32_u24 v24, 20, v23
  v_sub_u32 v22, v22, v24
  v_bfe_u32 v24, v23, 3, 1
  v_lshlrev_b32 v24, 1, v24
  v_xor_b32 v22, v22, v24
  v_mul_u32_u24 v23, 1280, v23
  v_lshl_add_u32 v9, v22, 4, v23
  s_mul_i32 s21, s20, 320
  s_add_u32 s21, s21, 128
  v_add_u32 v22, s21, v1
  v_mul_u32_u24 v23, v22, v29
  v_lshrrev_b32 v23, 16, v23
  v_mul_u32_u24 v24, 20, v23
  v_sub_u32 v22, v22, v24
  v_bfe_u32 v24, v23, 3, 1
  v_lshlrev_b32 v24, 1, v24
  v_xor_b32 v22, v22, v24
  v_mul_u32_u24 v23, 1280, v23
  v_lshl_add_u32 v10, v22, 4, v23
  s_mul_i32 s21, s20, 320
  s_add_u32 s21, s21, 192
  v_add_u32 v22, s21, v1
  v_mul_u32_u24 v23, v22, v29
  v_lshrrev_b32 v23, 16, v23
  v_mul_u32_u24 v24, 20, v23
  v_sub_u32 v22, v22, v24
  v_bfe_u32 v24, v23, 3, 1
  v_lshlrev_b32 v24, 1, v24
  v_xor_b32 v22, v22, v24
  v_mul_u32_u24 v23, 1280, v23
  v_lshl_add_u32 v11, v22, 4, v23
  s_mul_i32 s21, s20, 320
  s_add_u32 s21, s21, 256
  v_add_u32 v22, s21, v1
  v_mul_u32_u24 v23, v22, v29
  v_lshrrev_b32 v23, 16, v23
  v_mul_u32_u24 v24, 20, v23
  v_sub_u32 v22, v22, v24
  v_bfe_u32 v24, v23, 3, 1
  v_lshlrev_b32 v24, 1, v24
  v_xor_b32 v22, v22, v24
  v_mul_u32_u24 v23, 1280, v23
  v_lshl_add_u32 v12, v22, 4, v23
  s_and_b32 s44, s2, 3
  s_mul_i32 s45, s44, 320
  s_mul_i32 s46, s20, 5120
  v_and_b32 v22, 1, v2
  v_mul_u32_u24 v22, 16512, v22
  v_mul_u32_u24 v23, 33024, v3
  v_lshrrev_b32 v24, 1, v2
  v_lshlrev_b32 v24, 4, v24
  v_add3_u32 v6, v22, v23, v24
  s_lshr_b32 s47, s2, 2
  s_lshl_b32 s47, s47, 2
  s_add_u32 s47, s47, s20
  s_lshl_b32 s47, s47, 1
  s_lshl_b32 s48, s47, 7
  v_lshrrev_b32 v22, 2, v2
  v_lshl_add_u32 v22, v3, 3, v22
  v_mul_u32_u24 v22, 320, v22
  v_and_b32 v23, 3, v2
  v_lshl_add_u32 v22, v23, 3, v22
  v_and_b32 v23, 1, v3
  v_lshlrev_b32 v23, 5, v23
  v_add_u32 v14, v22, v23
  v_sub_u32 v15, v22, v23
  v_add_u32 v16, 61440, v14
  v_add_u32 v17, 61440, v15
  v_add_u32 v18, 122880, v14
  v_add_u32 v19, 122880, v15
  s_add_u32 m0, s46, 0
  s_add_u32 s49, s45, 0
  s_nop 0
  buffer_load_dwordx4 v8, s[24:27], s49 offen lds
  s_add_u32 m0, s46, 1024
  s_nop 0
  buffer_load_dwordx4 v9, s[24:27], s49 offen lds
  s_add_u32 m0, s46, 2048
  s_nop 0
  buffer_load_dwordx4 v10, s[24:27], s49 offen lds
  s_add_u32 m0, s46, 3072
  s_nop 0
  buffer_load_dwordx4 v11, s[24:27], s49 offen lds
  s_add_u32 m0, s46, 4096
  s_nop 0
  buffer_load_dwordx4 v12, s[24:27], s49 offen lds
  s_add_u32 m0, s46, 20480
  s_add_u32 s49, s45, 81920
  s_nop 0
  buffer_load_dwordx4 v8, s[24:27], s49 offen lds
  s_add_u32 m0, s46, 21504
  s_nop 0
  buffer_load_dwordx4 v9, s[24:27], s49 offen lds
  s_add_u32 m0, s46, 22528
  s_nop 0
  buffer_load_dwordx4 v10, s[24:27], s49 offen lds
  s_add_u32 m0, s46, 23552
  s_nop 0
  buffer_load_dwordx4 v11, s[24:27], s49 offen lds
  s_add_u32 m0, s46, 24576
  s_nop 0
  buffer_load_dwordx4 v12, s[24:27], s49 offen lds
  s_waitcnt vmcnt(10)
  v_readfirstlane_b32 s21, v21
  s_cmp_ge_u32 s21, 32
  s_cbranch_scc1 o2_238
  s_mov_b32 s21, 91136
  v_mov_b32 v20, 0
  s_mov_b32 s101, 0
wf_239:
  buffer_load_dword v21, v20, s[72:75], s21 offen sc1
  s_add_u32 s101, s101, 1
  s_cmp_gt_u32 s101, 131072
  s_cbranch_scc1 main_end
  s_waitcnt vmcnt(0)
  v_readfirstlane_b32 s100, v21
  s_cmp_ge_u32 s100, 32
  s_cbranch_scc1 wf_240
  s_sleep 32
  s_branch wf_239
wf_240:
o2_238:
  buffer_load_dwordx4 a[0:3], v6, s[16:19], s48 offen offset:0 sc1
  buffer_load_dwordx4 a[4:7], v6, s[16:19], s48 offen offset:128 sc1
  s_add_u32 s48, s48, 132096
  buffer_load_dwordx4 a[8:11], v6, s[16:19], s48 offen offset:0 sc1
  buffer_load_dwordx4 a[12:15], v6, s[16:19], s48 offen offset:128 sc1
  s_add_u32 s48, s48, 132096
  buffer_load_dwordx4 a[16:19], v6, s[16:19], s48 offen offset:0 sc1
  buffer_load_dwordx4 a[20:23], v6, s[16:19], s48 offen offset:128 sc1
  s_add_u32 s48, s48, 132096
  buffer_load_dwordx4 a[24:27], v6, s[16:19], s48 offen offset:0 sc1
  buffer_load_dwordx4 a[28:31], v6, s[16:19], s48 offen offset:128 sc1
  s_add_u32 s48, s48, 132096
  s_add_u32 m0, s46, 40960
  s_add_u32 s49, s45, 163840
  s_nop 0
  buffer_load_dwordx4 v8, s[24:27], s49 offen lds
  s_add_u32 m0, s46, 41984
  s_nop 0
  buffer_load_dwordx4 v9, s[24:27], s49 offen lds
  s_add_u32 m0, s46, 43008
  s_nop 0
  buffer_load_dwordx4 v10, s[24:27], s49 offen lds
  s_add_u32 m0, s46, 44032
  s_nop 0
  buffer_load_dwordx4 v11, s[24:27], s49 offen lds
  s_add_u32 m0, s46, 45056
  s_nop 0
  buffer_load_dwordx4 v12, s[24:27], s49 offen lds
  buffer_load_dwordx4 a[32:35], v6, s[16:19], s48 offen offset:0 sc1
  buffer_load_dwordx4 a[36:39], v6, s[16:19], s48 offen offset:128 sc1
  s_add_u32 s48, s48, 132096
  buffer_load_dwordx4 a[40:43], v6, s[16:19], s48 offen offset:0 sc1
  buffer_load_dwordx4 a[44:47], v6, s[16:19], s48 offen offset:128 sc1
  s_add_u32 s48, s48, 132096
  s_add_u32 m0, s46, 61440
  s_add_u32 s49, s45, 245760
  s_nop 0
  buffer_load_dwordx4 v8, s[24:27], s49 offen lds
  s_add_u32 m0, s46, 62464
  s_nop 0
  buffer_load_dwordx4 v9, s[24:27], s49 offen lds
  s_add_u32 m0, s46, 63488
  s_nop 0
  buffer_load_dwordx4 v10, s[24:27], s49 offen lds
  s_add_u32 m0, s46, 64512
  s_nop 0
  buffer_load_dwordx4 v11, s[24:27], s49 offen lds
  s_add_u32 m0, s46, 65536
  s_nop 0
  buffer_load_dwordx4 v12, s[24:27], s49 offen lds
  buffer_load_dwordx4 a[48:51], v6, s[16:19], s48 offen offset:0 sc1
  buffer_load_dwordx4 a[52:55], v6, s[16:19], s48 offen offset:128 sc1
  s_add_u32 s48, s48, 132096
  buffer_load_dwordx4 a[56:59], v6, s[16:19], s48 offen offset:0 sc1
  buffer_load_dwordx4 a[60:63], v6, s[16:19], s48 offen offset:128 sc1
  s_add_u32 s48, s48, 132096
  s_add_u32 m0, s46, 81920
  s_add_u32 s49, s45, 327680
  s_nop 0
  buffer_load_dwordx4 v8, s[24:27], s49 offen lds
  s_add_u32 m0, s46, 82944
  s_nop 0
  buffer_load_dwordx4 v9, s[24:27], s49 offen lds
  s_add_u32 m0, s46, 83968
  s_nop 0
  buffer_load_dwordx4 v10, s[24:27], s49 offen lds
  s_add_u32 m0, s46, 84992
  s_nop 0
  buffer_load_dwordx4 v11, s[24:27], s49 offen lds
  s_add_u32 m0, s46, 86016
  s_nop 0
  buffer_load_dwordx4 v12, s[24:27], s49 offen lds
  buffer_load_dwordx4 a[64:67], v6, s[16:19], s48 offen offset:0 sc1
  buffer_load_dwordx4 a[68:71], v6, s[16:19], s48 offen offset:128 sc1
  s_add_u32 s48, s48, 132096
  buffer_load_dwordx4 a[72:75], v6, s[16:19], s48 offen offset:0 sc1
  buffer_load_dwordx4 a[76:79], v6, s[16:19], s48 offen offset:128 sc1
  s_add_u32 s48, s48, 132096
  s_add_u32 m0, s46, 102400
  s_add_u32 s49, s45, 409600
  s_nop 0
  buffer_load_dwordx4 v8, s[24:27], s49 offen lds
  s_add_u32 m0, s46, 103424
  s_nop 0
  buffer_load_dwordx4 v9, s[24:27], s49 offen lds
  s_add_u32 m0, s46, 104448
  s_nop 0
  buffer_load_dwordx4 v10, s[24:27], s49 offen lds
  s_add_u32 m0, s46, 105472
  s_nop 0
  buffer_load_dwordx4 v11, s[24:27], s49 offen lds
  s_add_u32 m0, s46, 106496
  s_nop 0
  buffer_load_dwordx4 v12, s[24:27], s49 offen lds
  s_add_u32 m0, s46, 122880
  s_add_u32 s49, s45, 491520
  s_nop 0
  buffer_load_dwordx4 v8, s[24:27], s49 offen lds
  s_add_u32 m0, s46, 123904
  s_nop 0
  buffer_load_dwordx4 v9, s[24:27], s49 offen lds
  s_add_u32 m0, s46, 124928
  s_nop 0
  buffer_load_dwordx4 v10, s[24:27], s49 offen lds
  s_add_u32 m0, s46, 125952
  s_nop 0
  buffer_load_dwordx4 v11, s[24:27], s49 offen lds
  s_add_u32 m0, s46, 126976
  s_nop 0
  buffer_load_dwordx4 v12, s[24:27], s49 offen lds
  s_waitcnt vmcnt(50)
  s_barrier
  ds_read_b64_tr_b16 v[144:145], v14 offset:0
  ds_read_b64_tr_b16 v[146:147], v14 offset:1280
  ds_read_b64_tr_b16 v[148:149], v15 offset:32
  ds_read_b64_tr_b16 v[150:151], v15 offset:1312
  ds_read_b64_tr_b16 v[152:153], v14 offset:64
  ds_read_b64_tr_b16 v[154:155], v14 offset:1344
  ds_read_b64_tr_b16 v[156:157], v15 offset:96
  ds_read_b64_tr_b16 v[158:159], v15 offset:1376
  ds_read_b64_tr_b16 v[160:161], v14 offset:128
  ds_read_b64_tr_b16 v[162:163], v14 offset:1408
  ds_read_b64_tr_b16 v[164:165], v15 offset:160
  ds_read_b64_tr_b16 v[166:167], v15 offset:1440
  ds_read_b64_tr_b16 v[168:169], v14 offset:192
  ds_read_b64_tr_b16 v[170:171], v14 offset:1472
  ds_read_b64_tr_b16 v[172:173], v15 offset:224
  ds_read_b64_tr_b16 v[174:175], v15 offset:1504
  ds_read_b64_tr_b16 v[176:177], v14 offset:256
  ds_read_b64_tr_b16 v[178:179], v14 offset:1536
  ds_read_b64_tr_b16 v[180:181], v15 offset:288
  ds_read_b64_tr_b16 v[182:183], v15 offset:1568
  s_waitcnt lgkmcnt(0) vmcnt(43)
  v_mfma_f32_16x16x32_bf16 v[64:67], v[144:147], a[0:3], 0
  ds_read_b64_tr_b16 v[184:185], v14 offset:10240
  ds_read_b64_tr_b16 v[186:187], v14 offset:11520
  v_mfma_f32_16x16x32_bf16 v[104:107], v[144:147], a[4:7], 0
  ds_read_b64_tr_b16 v[188:189], v15 offset:10272
  v_mfma_f32_16x16x32_bf16 v[68:71], v[148:151], a[0:3], 0
  ds_read_b64_tr_b16 v[190:191], v15 offset:11552
  v_mfma_f32_16x16x32_bf16 v[108:111], v[148:151], a[4:7], 0
  ds_read_b64_tr_b16 v[192:193], v14 offset:10304
  v_mfma_f32_16x16x32_bf16 v[72:75], v[152:155], a[0:3], 0
  ds_read_b64_tr_b16 v[194:195], v14 offset:11584
  v_mfma_f32_16x16x32_bf16 v[112:115], v[152:155], a[4:7], 0
  ds_read_b64_tr_b16 v[196:197], v15 offset:10336
  ds_read_b64_tr_b16 v[198:199], v15 offset:11616
  v_mfma_f32_16x16x32_bf16 v[76:79], v[156:159], a[0:3], 0
  ds_read_b64_tr_b16 v[200:201], v14 offset:10368
  v_mfma_f32_16x16x32_bf16 v[116:119], v[156:159], a[4:7], 0
  ds_read_b64_tr_b16 v[202:203], v14 offset:11648
  v_mfma_f32_16x16x32_bf16 v[80:83], v[160:163], a[0:3], 0
  ds_read_b64_tr_b16 v[204:205], v15 offset:10400
  v_mfma_f32_16x16x32_bf16 v[120:123], v[160:163], a[4:7], 0
  ds_read_b64_tr_b16 v[206:207], v15 offset:11680
  v_mfma_f32_16x16x32_bf16 v[84:87], v[164:167], a[0:3], 0
  ds_read_b64_tr_b16 v[208:209], v14 offset:10432
  v_mfma_f32_16x16x32_bf16 v[124:127], v[164:167], a[4:7], 0
  ds_read_b64_tr_b16 v[210:211], v14 offset:11712
  ds_read_b64_tr_b16 v[212:213], v15 offset:10464
  v_mfma_f32_16x16x32_bf16 v[88:91], v[168:171], a[0:3], 0
  ds_read_b64_tr_b16 v[214:215], v15 offset:11744
  v_mfma_f32_16x16x32_bf16 v[128:131], v[168:171], a[4:7], 0
  buffer_load_dwordx4 a[80:83], v6, s[16:19], s48 offen offset:0 sc1
  ds_read_b64_tr_b16 v[216:217], v14 offset:10496
  v_mfma_f32_16x16x32_bf16 v[92:95], v[172:175], a[0:3], 0
  ds_read_b64_tr_b16 v[218:219], v14 offset:11776
  v_mfma_f32_16x16x32_bf16 v[132:135], v[172:175], a[4:7], 0
  ds_read_b64_tr_b16 v[220:221], v15 offset:10528
  v_mfma_f32_16x16x32_bf16 v[96:99], v[176:179], a[0:3], 0
  ds_read_b64_tr_b16 v[222:223], v15 offset:11808
  v_mfma_f32_16x16x32_bf16 v[136:139], v[176:179], a[4:7], 0
  buffer_load_dwordx4 a[84:87], v6, s[16:19], s48 offen offset:128 sc1
  v_mfma_f32_16x16x32_bf16 v[100:103], v[180:183], a[0:3], 0
  s_add_u32 s48, s48, 132096
  v_mfma_f32_16x16x32_bf16 v[140:143], v[180:183], a[4:7], 0
  s_waitcnt lgkmcnt(0) vmcnt(43)
  s_barrier
  v_mfma_f32_16x16x32_bf16 v[64:67], v[184:187], a[8:11], v[64:67]
  s_add_u32 m0, s46, 0
  ds_read_b64_tr_b16 v[144:145], v14 offset:20480
  ds_read_b64_tr_b16 v[146:147], v14 offset:21760
  v_mfma_f32_16x16x32_bf16 v[104:107], v[184:187], a[12:15], v[104:107]
  s_add_u32 s49, s45, 573440
  ds_read_b64_tr_b16 v[148:149], v15 offset:20512
  v_mfma_f32_16x16x32_bf16 v[68:71], v[188:191], a[8:11], v[68:71]
  buffer_load_dwordx4 v8, s[24:27], s49 offen lds
  ds_read_b64_tr_b16 v[150:151], v15 offset:21792
  v_mfma_f32_16x16x32_bf16 v[108:111], v[188:191], a[12:15], v[108:111]
  s_add_u32 m0, s46, 1024
  ds_read_b64_tr_b16 v[152:153], v14 offset:20544
  v_mfma_f32_16x16x32_bf16 v[72:75], v[192:195], a[8:11], v[72:75]
  buffer_load_dwordx4 v9, s[24:27], s49 offen lds
  ds_read_b64_tr_b16 v[154:155], v14 offset:21824
  v_mfma_f32_16x16x32_bf16 v[112:115], v[192:195], a[12:15], v[112:115]
  s_add_u32 m0, s46, 2048
  ds_read_b64_tr_b16 v[156:157], v15 offset:20576
  ds_read_b64_tr_b16 v[158:159], v15 offset:21856
  v_mfma_f32_16x16x32_bf16 v[76:79], v[196:199], a[8:11], v[76:79]
  buffer_load_dwordx4 v10, s[24:27], s49 offen lds
  ds_read_b64_tr_b16 v[160:161], v14 offset:20608
  v_mfma_f32_16x16x32_bf16 v[116:119], v[196:199], a[12:15], v[116:119]
  s_add_u32 m0, s46, 3072
  ds_read_b64_tr_b16 v[162:163], v14 offset:21888
  v_mfma_f32_16x16x32_bf16 v[80:83], v[200:203], a[8:11], v[80:83]
  buffer_load_dwordx4 v11, s[24:27], s49 offen lds
  ds_read_b64_tr_b16 v[164:165], v15 offset:20640
  v_mfma_f32_16x16x32_bf16 v[120:123], v[200:203], a[12:15], v[120:123]
  s_add_u32 m0, s46, 4096
  ds_read_b64_tr_b16 v[166:167], v15 offset:21920
  v_mfma_f32_16x16x32_bf16 v[84:87], v[204:207], a[8:11], v[84:87]
  buffer_load_dwordx4 v12, s[24:27], s49 offen lds
  ds_read_b64_tr_b16 v[168:169], v14 offset:20672
  v_mfma_f32_16x16x32_bf16 v[124:127], v[204:207], a[12:15], v[124:127]
  ds_read_b64_tr_b16 v[170:171], v14 offset:21952
  ds_read_b64_tr_b16 v[172:173], v15 offset:20704
  v_mfma_f32_16x16x32_bf16 v[88:91], v[208:211], a[8:11], v[88:91]
  ds_read_b64_tr_b16 v[174:175], v15 offset:21984
  v_mfma_f32_16x16x32_bf16 v[128:131], v[208:211], a[12:15], v[128:131]
  buffer_load_dwordx4 a[88:91], v6, s[16:19], s48 offen offset:0 sc1
  ds_read_b64_tr_b16 v[176:177], v14 offset:20736
  v_mfma_f32_16x16x32_bf16 v[92:95], v[212:215], a[8:11], v[92:95]
  ds_read_b64_tr_b16 v[178:179], v14 offset:22016
  v_mfma_f32_16x16x32_bf16 v[132:135], v[212:215], a[12:15], v[132:135]
  ds_read_b64_tr_b16 v[180:181], v15 offset:20768
  v_mfma_f32_16x16x32_bf16 v[96:99], v[216:219], a[8:11], v[96:99]
  ds_read_b64_tr_b16 v[182:183], v15 offset:22048
  v_mfma_f32_16x16x32_bf16 v[136:139], v[216:219], a[12:15], v[136:139]
  buffer_load_dwordx4 a[92:95], v6, s[16:19], s48 offen offset:128 sc1
  v_mfma_f32_16x16x32_bf16 v[100:103], v[220:223], a[8:11], v[100:103]
  s_add_u32 s48, s48, 132096
  v_mfma_f32_16x16x32_bf16 v[140:143], v[220:223], a[12:15], v[140:143]
  s_waitcnt lgkmcnt(0) vmcnt(48)
  v_mfma_f32_16x16x32_bf16 v[64:67], v[144:147], a[16:19], v[64:67]
  ds_read_b64_tr_b16 v[184:185], v14 offset:30720
  ds_read_b64_tr_b16 v[186:187], v14 offset:32000
  v_mfma_f32_16x16x32_bf16 v[104:107], v[144:147], a[20:23], v[104:107]
  ds_read_b64_tr_b16 v[188:189], v15 offset:30752
  v_mfma_f32_16x16x32_bf16 v[68:71], v[148:151], a[16:19], v[68:71]
  ds_read_b64_tr_b16 v[190:191], v15 offset:32032
  v_mfma_f32_16x16x32_bf16 v[108:111], v[148:151], a[20:23], v[108:111]
  ds_read_b64_tr_b16 v[192:193], v14 offset:30784
  v_mfma_f32_16x16x32_bf16 v[72:75], v[152:155], a[16:19], v[72:75]
  ds_read_b64_tr_b16 v[194:195], v14 offset:32064
  v_mfma_f32_16x16x32_bf16 v[112:115], v[152:155], a[20:23], v[112:115]
  ds_read_b64_tr_b16 v[196:197], v15 offset:30816
  ds_read_b64_tr_b16 v[198:199], v15 offset:32096
  v_mfma_f32_16x16x32_bf16 v[76:79], v[156:159], a[16:19], v[76:79]
  ds_read_b64_tr_b16 v[200:201], v14 offset:30848
  v_mfma_f32_16x16x32_bf16 v[116:119], v[156:159], a[20:23], v[116:119]
  ds_read_b64_tr_b16 v[202:203], v14 offset:32128
  v_mfma_f32_16x16x32_bf16 v[80:83], v[160:163], a[16:19], v[80:83]
  ds_read_b64_tr_b16 v[204:205], v15 offset:30880
  v_mfma_f32_16x16x32_bf16 v[120:123], v[160:163], a[20:23], v[120:123]
  ds_read_b64_tr_b16 v[206:207], v15 offset:32160
  v_mfma_f32_16x16x32_bf16 v[84:87], v[164:167], a[16:19], v[84:87]
  ds_read_b64_tr_b16 v[208:209], v14 offset:30912
  v_mfma_f32_16x16x32_bf16 v[124:127], v[164:167], a[20:23], v[124:127]
  ds_read_b64_tr_b16 v[210:211], v14 offset:32192
  ds_read_b64_tr_b16 v[212:213], v15 offset:30944
  v_mfma_f32_16x16x32_bf16 v[88:91], v[168:171], a[16:19], v[88:91]
  ds_read_b64_tr_b16 v[214:215], v15 offset:32224
  v_mfma_f32_16x16x32_bf16 v[128:131], v[168:171], a[20:23], v[128:131]
  buffer_load_dwordx4 a[96:99], v6, s[16:19], s48 offen offset:0 sc1
  ds_read_b64_tr_b16 v[216:217], v14 offset:30976
  v_mfma_f32_16x16x32_bf16 v[92:95], v[172:175], a[16:19], v[92:95]
  ds_read_b64_tr_b16 v[218:219], v14 offset:32256
  v_mfma_f32_16x16x32_bf16 v[132:135], v[172:175], a[20:23], v[132:135]
  ds_read_b64_tr_b16 v[220:221], v15 offset:31008
  v_mfma_f32_16x16x32_bf16 v[96:99], v[176:179], a[16:19], v[96:99]
  ds_read_b64_tr_b16 v[222:223], v15 offset:32288
  v_mfma_f32_16x16x32_bf16 v[136:139], v[176:179], a[20:23], v[136:139]
  buffer_load_dwordx4 a[100:103], v6, s[16:19], s48 offen offset:128 sc1
  v_mfma_f32_16x16x32_bf16 v[100:103], v[180:183], a[16:19], v[100:103]
  s_add_u32 s48, s48, 132096
  v_mfma_f32_16x16x32_bf16 v[140:143], v[180:183], a[20:23], v[140:143]
  s_waitcnt lgkmcnt(0) vmcnt(43)
  s_barrier
  v_mfma_f32_16x16x32_bf16 v[64:67], v[184:187], a[24:27], v[64:67]
  s_add_u32 m0, s46, 20480
  ds_read_b64_tr_b16 v[144:145], v14 offset:40960
  ds_read_b64_tr_b16 v[146:147], v14 offset:42240
  v_mfma_f32_16x16x32_bf16 v[104:107], v[184:187], a[28:31], v[104:107]
  s_add_u32 s49, s45, 655360
  ds_read_b64_tr_b16 v[148:149], v15 offset:40992
  v_mfma_f32_16x16x32_bf16 v[68:71], v[188:191], a[24:27], v[68:71]
  buffer_load_dwordx4 v8, s[24:27], s49 offen lds
  ds_read_b64_tr_b16 v[150:151], v15 offset:42272
  v_mfma_f32_16x16x32_bf16 v[108:111], v[188:191], a[28:31], v[108:111]
  s_add_u32 m0, s46, 21504
  ds_read_b64_tr_b16 v[152:153], v14 offset:41024
  v_mfma_f32_16x16x32_bf16 v[72:75], v[192:195], a[24:27], v[72:75]
  buffer_load_dwordx4 v9, s[24:27], s49 offen lds
  ds_read_b64_tr_b16 v[154:155], v14 offset:42304
  v_mfma_f32_16x16x32_bf16 v[112:115], v[192:195], a[28:31], v[112:115]
  s_add_u32 m0, s46, 22528
  ds_read_b64_tr_b16 v[156:157], v15 offset:41056
  ds_read_b64_tr_b16 v[158:159], v15 offset:42336
  v_mfma_f32_16x16x32_bf16 v[76:79], v[196:199], a[24:27], v[76:79]
  buffer_load_dwordx4 v10, s[24:27], s49 offen lds
  ds_read_b64_tr_b16 v[160:161], v14 offset:41088
  v_mfma_f32_16x16x32_bf16 v[116:119], v[196:199], a[28:31], v[116:119]
  s_add_u32 m0, s46, 23552
  ds_read_b64_tr_b16 v[162:163], v14 offset:42368
  v_mfma_f32_16x16x32_bf16 v[80:83], v[200:203], a[24:27], v[80:83]
  buffer_load_dwordx4 v11, s[24:27], s49 offen lds
  ds_read_b64_tr_b16 v[164:165], v15 offset:41120
  v_mfma_f32_16x16x32_bf16 v[120:123], v[200:203], a[28:31], v[120:123]
  s_add_u32 m0, s46, 24576
  ds_read_b64_tr_b16 v[166:167], v15 offset:42400
  v_mfma_f32_16x16x32_bf16 v[84:87], v[204:207], a[24:27], v[84:87]
  buffer_load_dwordx4 v12, s[24:27], s49 offen lds
  ds_read_b64_tr_b16 v[168:169], v14 offset:41152
  v_mfma_f32_16x16x32_bf16 v[124:127], v[204:207], a[28:31], v[124:127]
  ds_read_b64_tr_b16 v[170:171], v14 offset:42432
  ds_read_b64_tr_b16 v[172:173], v15 offset:41184
  v_mfma_f32_16x16x32_bf16 v[88:91], v[208:211], a[24:27], v[88:91]
  ds_read_b64_tr_b16 v[174:175], v15 offset:42464
  v_mfma_f32_16x16x32_bf16 v[128:131], v[208:211], a[28:31], v[128:131]
  buffer_load_dwordx4 a[104:107], v6, s[16:19], s48 offen offset:0 sc1
  ds_read_b64_tr_b16 v[176:177], v14 offset:41216
  v_mfma_f32_16x16x32_bf16 v[92:95], v[212:215], a[24:27], v[92:95]
  ds_read_b64_tr_b16 v[178:179], v14 offset:42496
  v_mfma_f32_16x16x32_bf16 v[132:135], v[212:215], a[28:31], v[132:135]
  ds_read_b64_tr_b16 v[180:181], v15 offset:41248
  v_mfma_f32_16x16x32_bf16 v[96:99], v[216:219], a[24:27], v[96:99]
  ds_read_b64_tr_b16 v[182:183], v15 offset:42528
  v_mfma_f32_16x16x32_bf16 v[136:139], v[216:219], a[28:31], v[136:139]
  buffer_load_dwordx4 a[108:111], v6, s[16:19], s48 offen offset:128 sc1
  v_mfma_f32_16x16x32_bf16 v[100:103], v[220:223], a[24:27], v[100:103]
  s_add_u32 s48, s48, 132096
  v_mfma_f32_16x16x32_bf16 v[140:143], v[220:223], a[28:31], v[140:143]
  s_waitcnt lgkmcnt(0) vmcnt(48)
  v_mfma_f32_16x16x32_bf16 v[64:67], v[144:147], a[32:35], v[64:67]
  ds_read_b64_tr_b16 v[184:185], v14 offset:51200
  ds_read_b64_tr_b16 v[186:187], v14 offset:52480
  v_mfma_f32_16x16x32_bf16 v[104:107], v[144:147], a[36:39], v[104:107]
  ds_read_b64_tr_b16 v[188:189], v15 offset:51232
  v_mfma_f32_16x16x32_bf16 v[68:71], v[148:151], a[32:35], v[68:71]
  ds_read_b64_tr_b16 v[190:191], v15 offset:52512
  v_mfma_f32_16x16x32_bf16 v[108:111], v[148:151], a[36:39], v[108:111]
  ds_read_b64_tr_b16 v[192:193], v14 offset:51264
  v_mfma_f32_16x16x32_bf16 v[72:75], v[152:155], a[32:35], v[72:75]
  ds_read_b64_tr_b16 v[194:195], v14 offset:52544
  v_mfma_f32_16x16x32_bf16 v[112:115], v[152:155], a[36:39], v[112:115]
  ds_read_b64_tr_b16 v[196:197], v15 offset:51296
  ds_read_b64_tr_b16 v[198:199], v15 offset:52576
  v_mfma_f32_16x16x32_bf16 v[76:79], v[156:159], a[32:35], v[76:79]
  ds_read_b64_tr_b16 v[200:201], v14 offset:51328
  v_mfma_f32_16x16x32_bf16 v[116:119], v[156:159], a[36:39], v[116:119]
  ds_read_b64_tr_b16 v[202:203], v14 offset:52608
  v_mfma_f32_16x16x32_bf16 v[80:83], v[160:163], a[32:35], v[80:83]
  ds_read_b64_tr_b16 v[204:205], v15 offset:51360
  v_mfma_f32_16x16x32_bf16 v[120:123], v[160:163], a[36:39], v[120:123]
  ds_read_b64_tr_b16 v[206:207], v15 offset:52640
  v_mfma_f32_16x16x32_bf16 v[84:87], v[164:167], a[32:35], v[84:87]
  ds_read_b64_tr_b16 v[208:209], v14 offset:51392
  v_mfma_f32_16x16x32_bf16 v[124:127], v[164:167], a[36:39], v[124:127]
  ds_read_b64_tr_b16 v[210:211], v14 offset:52672
  ds_read_b64_tr_b16 v[212:213], v15 offset:51424
  v_mfma_f32_16x16x32_bf16 v[88:91], v[168:171], a[32:35], v[88:91]
  ds_read_b64_tr_b16 v[214:215], v15 offset:52704
  v_mfma_f32_16x16x32_bf16 v[128:131], v[168:171], a[36:39], v[128:131]
  buffer_load_dwordx4 a[112:115], v6, s[16:19], s48 offen offset:0 sc1
  ds_read_b64_tr_b16 v[216:217], v14 offset:51456
  v_mfma_f32_16x16x32_bf16 v[92:95], v[172:175], a[32:35], v[92:95]
  ds_read_b64_tr_b16 v[218:219], v14 offset:52736
  v_mfma_f32_16x16x32_bf16 v[132:135], v[172:175], a[36:39], v[132:135]
  ds_read_b64_tr_b16 v[220:221], v15 offset:51488
  v_mfma_f32_16x16x32_bf16 v[96:99], v[176:179], a[32:35], v[96:99]
  ds_read_b64_tr_b16 v[222:223], v15 offset:52768
  v_mfma_f32_16x16x32_bf16 v[136:139], v[176:179], a[36:39], v[136:139]
  buffer_load_dwordx4 a[116:119], v6, s[16:19], s48 offen offset:128 sc1
  v_mfma_f32_16x16x32_bf16 v[100:103], v[180:183], a[32:35], v[100:103]
  s_add_u32 s48, s48, 132096
  v_mfma_f32_16x16x32_bf16 v[140:143], v[180:183], a[36:39], v[140:143]
  s_waitcnt lgkmcnt(0) vmcnt(43)
  s_barrier
  v_mfma_f32_16x16x32_bf16 v[64:67], v[184:187], a[40:43], v[64:67]
  s_add_u32 m0, s46, 40960
  ds_read_b64_tr_b16 v[144:145], v16 offset:0
  ds_read_b64_tr_b16 v[146:147], v16 offset:1280
  v_mfma_f32_16x16x32_bf16 v[104:107], v[184:187], a[44:47], v[104:107]
  s_add_u32 s49, s45, 737280
  ds_read_b64_tr_b16 v[148:149], v17 offset:32
  v_mfma_f32_16x16x32_bf16 v[68:71], v[188:191], a[40:43], v[68:71]
  buffer_load_dwordx4 v8, s[24:27], s49 offen lds
  ds_read_b64_tr_b16 v[150:151], v17 offset:1312
  v_mfma_f32_16x16x32_bf16 v[108:111], v[188:191], a[44:47], v[108:111]
  s_add_u32 m0, s46, 41984
  ds_read_b64_tr_b16 v[152:153], v16 offset:64
  v_mfma_f32_16x16x32_bf16 v[72:75], v[192:195], a[40:43], v[72:75]
  buffer_load_dwordx4 v9, s[24:27], s49 offen lds
  ds_read_b64_tr_b16 v[154:155], v16 offset:1344
  v_mfma_f32_16x16x32_bf16 v[112:115], v[192:195], a[44:47], v[112:115]
  s_add_u32 m0, s46, 43008
  ds_read_b64_tr_b16 v[156:157], v17 offset:96
  ds_read_b64_tr_b16 v[158:159], v17 offset:1376
  v_mfma_f32_16x16x32_bf16 v[76:79], v[196:199], a[40:43], v[76:79]
  buffer_load_dwordx4 v10, s[24:27], s49 offen lds
  ds_read_b64_tr_b16 v[160:161], v16 offset:128
  v_mfma_f32_16x16x32_bf16 v[116:119], v[196:199], a[44:47], v[116:119]
  s_add_u32 m0, s46, 44032
  ds_read_b64_tr_b16 v[162:163], v16 offset:1408
  v_mfma_f32_16x16x32_bf16 v[80:83], v[200:203], a[40:43], v[80:83]
  buffer_load_dwordx4 v11, s[24:27], s49 offen lds
  ds_read_b64_tr_b16 v[164:165], v17 offset:160
  v_mfma_f32_16x16x32_bf16 v[120:123], v[200:203], a[44:47], v[120:123]
  s_add_u32 m0, s46, 45056
  ds_read_b64_tr_b16 v[166:167], v17 offset:1440
  v_mfma_f32_16x16x32_bf16 v[84:87], v[204:207], a[40:43], v[84:87]
  buffer_load_dwordx4 v12, s[24:27], s49 offen lds
  ds_read_b64_tr_b16 v[168:169], v16 offset:192
  v_mfma_f32_16x16x32_bf16 v[124:127], v[204:207], a[44:47], v[124:127]
  ds_read_b64_tr_b16 v[170:171], v16 offset:1472
  ds_read_b64_tr_b16 v[172:173], v17 offset:224
  v_mfma_f32_16x16x32_bf16 v[88:91], v[208:211], a[40:43], v[88:91]
  ds_read_b64_tr_b16 v[174:175], v17 offset:1504
  v_mfma_f32_16x16x32_bf16 v[128:131], v[208:211], a[44:47], v[128:131]
  buffer_load_dwordx4 a[120:123], v6, s[16:19], s48 offen offset:0 sc1
  ds_read_b64_tr_b16 v[176:177], v16 offset:256
  v_mfma_f32_16x16x32_bf16 v[92:95], v[212:215], a[40:43], v[92:95]
  ds_read_b64_tr_b16 v[178:179], v16 offset:1536
  v_mfma_f32_16x16x32_bf16 v[132:135], v[212:215], a[44:47], v[132:135]
  ds_read_b64_tr_b16 v[180:181], v17 offset:288
  v_mfma_f32_16x16x32_bf16 v[96:99], v[216:219], a[40:43], v[96:99]
  ds_read_b64_tr_b16 v[182:183], v17 offset:1568
  v_mfma_f32_16x16x32_bf16 v[136:139], v[216:219], a[44:47], v[136:139]
  buffer_load_dwordx4 a[124:127], v6, s[16:19], s48 offen offset:128 sc1
  v_mfma_f32_16x16x32_bf16 v[100:103], v[220:223], a[40:43], v[100:103]
  s_add_u32 s48, s48, 132096
  v_mfma_f32_16x16x32_bf16 v[140:143], v[220:223], a[44:47], v[140:143]
  s_waitcnt lgkmcnt(0) vmcnt(48)
  v_mfma_f32_16x16x32_bf16 v[64:67], v[144:147], a[48:51], v[64:67]
  ds_read_b64_tr_b16 v[184:185], v16 offset:10240
  ds_read_b64_tr_b16 v[186:187], v16 offset:11520
  v_mfma_f32_16x16x32_bf16 v[104:107], v[144:147], a[52:55], v[104:107]
  ds_read_b64_tr_b16 v[188:189], v17 offset:10272
  v_mfma_f32_16x16x32_bf16 v[68:71], v[148:151], a[48:51], v[68:71]
  ds_read_b64_tr_b16 v[190:191], v17 offset:11552
  v_mfma_f32_16x16x32_bf16 v[108:111], v[148:151], a[52:55], v[108:111]
  ds_read_b64_tr_b16 v[192:193], v16 offset:10304
  v_mfma_f32_16x16x32_bf16 v[72:75], v[152:155], a[48:51], v[72:75]
  ds_read_b64_tr_b16 v[194:195], v16 offset:11584
  v_mfma_f32_16x16x32_bf16 v[112:115], v[152:155], a[52:55], v[112:115]
  ds_read_b64_tr_b16 v[196:197], v17 offset:10336
  ds_read_b64_tr_b16 v[198:199], v17 offset:11616
  v_mfma_f32_16x16x32_bf16 v[76:79], v[156:159], a[48:51], v[76:79]
  ds_read_b64_tr_b16 v[200:201], v16 offset:10368
  v_mfma_f32_16x16x32_bf16 v[116:119], v[156:159], a[52:55], v[116:119]
  ds_read_b64_tr_b16 v[202:203], v16 offset:11648
  v_mfma_f32_16x16x32_bf16 v[80:83], v[160:163], a[48:51], v[80:83]
  ds_read_b64_tr_b16 v[204:205], v17 offset:10400
  v_mfma_f32_16x16x32_bf16 v[120:123], v[160:163], a[52:55], v[120:123]
  ds_read_b64_tr_b16 v[206:207], v17 offset:11680
  v_mfma_f32_16x16x32_bf16 v[84:87], v[164:167], a[48:51], v[84:87]
  ds_read_b64_tr_b16 v[208:209], v16 offset:10432
  v_mfma_f32_16x16x32_bf16 v[124:127], v[164:167], a[52:55], v[124:127]
  ds_read_b64_tr_b16 v[210:211], v16 offset:11712
  ds_read_b64_tr_b16 v[212:213], v17 offset:10464
  v_mfma_f32_16x16x32_bf16 v[88:91], v[168:171], a[48:51], v[88:91]
  ds_read_b64_tr_b16 v[214:215], v17 offset:11744
  v_mfma_f32_16x16x32_bf16 v[128:131], v[168:171], a[52:55], v[128:131]
  buffer_load_dwordx4 a[128:131], v6, s[16:19], s48 offen offset:0 sc1
  ds_read_b64_tr_b16 v[216:217], v16 offset:10496
  v_mfma_f32_16x16x32_bf16 v[92:95], v[172:175], a[48:51], v[92:95]
  ds_read_b64_tr_b16 v[218:219], v16 offset:11776
  v_mfma_f32_16x16x32_bf16 v[132:135], v[172:175], a[52:55], v[132:135]
  ds_read_b64_tr_b16 v[220:221], v17 offset:10528
  v_mfma_f32_16x16x32_bf16 v[96:99], v[176:179], a[48:51], v[96:99]
  ds_read_b64_tr_b16 v[222:223], v17 offset:11808
  v_mfma_f32_16x16x32_bf16 v[136:139], v[176:179], a[52:55], v[136:139]
  buffer_load_dwordx4 a[132:135], v6, s[16:19], s48 offen offset:128 sc1
  v_mfma_f32_16x16x32_bf16 v[100:103], v[180:183], a[48:51], v[100:103]
  s_add_u32 s48, s48, 132096
  v_mfma_f32_16x16x32_bf16 v[140:143], v[180:183], a[52:55], v[140:143]
  s_waitcnt lgkmcnt(0) vmcnt(43)
  s_barrier
  v_mfma_f32_16x16x32_bf16 v[64:67], v[184:187], a[56:59], v[64:67]
  ds_read_b64_tr_b16 v[144:145], v16 offset:20480
  ds_read_b64_tr_b16 v[146:147], v16 offset:21760
  v_mfma_f32_16x16x32_bf16 v[104:107], v[184:187], a[60:63], v[104:107]
  ds_read_b64_tr_b16 v[148:149], v17 offset:20512
  v_mfma_f32_16x16x32_bf16 v[68:71], v[188:191], a[56:59], v[68:71]
  ds_read_b64_tr_b16 v[150:151], v17 offset:21792
  v_mfma_f32_16x16x32_bf16 v[108:111], v[188:191], a[60:63], v[108:111]
  ds_read_b64_tr_b16 v[152:153], v16 offset:20544
  v_mfma_f32_16x16x32_bf16 v[72:75], v[192:195], a[56:59], v[72:75]
  ds_read_b64_tr_b16 v[154:155], v16 offset:21824
  v_mfma_f32_16x16x32_bf16 v[112:115], v[192:195], a[60:63], v[112:115]
  ds_read_b64_tr_b16 v[156:157], v17 offset:20576
  ds_read_b64_tr_b16 v[158:159], v17 offset:21856
  v_mfma_f32_16x16x32_bf16 v[76:79], v[196:199], a[56:59], v[76:79]
  ds_read_b64_tr_b16 v[160:161], v16 offset:20608
  v_mfma_f32_16x16x32_bf16 v[116:119], v[196:199], a[60:63], v[116:119]
  ds_read_b64_tr_b16 v[162:163], v16 offset:21888
  v_mfma_f32_16x16x32_bf16 v[80:83], v[200:203], a[56:59], v[80:83]
  ds_read_b64_tr_b16 v[164:165], v17 offset:20640
  v_mfma_f32_16x16x32_bf16 v[120:123], v[200:203], a[60:63], v[120:123]
  ds_read_b64_tr_b16 v[166:167], v17 offset:21920
  v_mfma_f32_16x16x32_bf16 v[84:87], v[204:207], a[56:59], v[84:87]
  ds_read_b64_tr_b16 v[168:169], v16 offset:20672
  v_mfma_f32_16x16x32_bf16 v[124:127], v[204:207], a[60:63], v[124:127]
  ds_read_b64_tr_b16 v[170:171], v16 offset:21952
  ds_read_b64_tr_b16 v[172:173], v17 offset:20704
  v_mfma_f32_16x16x32_bf16 v[88:91], v[208:211], a[56:59], v[88:91]
  ds_read_b64_tr_b16 v[174:175], v17 offset:21984
  v_mfma_f32_16x16x32_bf16 v[128:131], v[208:211], a[60:63], v[128:131]
  buffer_load_dwordx4 a[136:139], v6, s[16:19], s48 offen offset:0 sc1
  ds_read_b64_tr_b16 v[176:177], v16 offset:20736
  v_mfma_f32_16x16x32_bf16 v[92:95], v[212:215], a[56:59], v[92:95]
  ds_read_b64_tr_b16 v[178:179], v16 offset:22016
  v_mfma_f32_16x16x32_bf16 v[132:135], v[212:215], a[60:63], v[132:135]
  ds_read_b64_tr_b16 v[180:181], v17 offset:20768
  v_mfma_f32_16x16x32_bf16 v[96:99], v[216:219], a[56:59], v[96:99]
  ds_read_b64_tr_b16 v[182:183], v17 offset:22048
  v_mfma_f32_16x16x32_bf16 v[136:139], v[216:219], a[60:63], v[136:139]
  buffer_load_dwordx4 a[140:143], v6, s[16:19], s48 offen offset:128 sc1
  v_mfma_f32_16x16x32_bf16 v[100:103], v[220:223], a[56:59], v[100:103]
  s_add_u32 s48, s48, 132096
  v_mfma_f32_16x16x32_bf16 v[140:143], v[220:223], a[60:63], v[140:143]
  s_waitcnt lgkmcnt(0) vmcnt(43)
  v_mfma_f32_16x16x32_bf16 v[64:67], v[144:147], a[64:67], v[64:67]
  ds_read_b64_tr_b16 v[184:185], v16 offset:30720
  ds_read_b64_tr_b16 v[186:187], v16 offset:32000
  v_mfma_f32_16x16x32_bf16 v[104:107], v[144:147], a[68:71], v[104:107]
  ds_read_b64_tr_b16 v[188:189], v17 offset:30752
  v_mfma_f32_16x16x32_bf16 v[68:71], v[148:151], a[64:67], v[68:71]
  ds_read_b64_tr_b16 v[190:191], v17 offset:32032
  v_mfma_f32_16x16x32_bf16 v[108:111], v[148:151], a[68:71], v[108:111]
  ds_read_b64_tr_b16 v[192:193], v16 offset:30784
  v_mfma_f32_16x16x32_bf16 v[72:75], v[152:155], a[64:67], v[72:75]
  ds_read_b64_tr_b16 v[194:195], v16 offset:32064
  v_mfma_f32_16x16x32_bf16 v[112:115], v[152:155], a[68:71], v[112:115]
  ds_read_b64_tr_b16 v[196:197], v17 offset:30816
  ds_read_b64_tr_b16 v[198:199], v17 offset:32096
  v_mfma_f32_16x16x32_bf16 v[76:79], v[156:159], a[64:67], v[76:79]
  ds_read_b64_tr_b16 v[200:201], v16 offset:30848
  v_mfma_f32_16x16x32_bf16 v[116:119], v[156:159], a[68:71], v[116:119]
  ds_read_b64_tr_b16 v[202:203], v16 offset:32128
  v_mfma_f32_16x16x32_bf16 v[80:83], v[160:163], a[64:67], v[80:83]
  ds_read_b64_tr_b16 v[204:205], v17 offset:30880
  v_mfma_f32_16x16x32_bf16 v[120:123], v[160:163], a[68:71], v[120:123]
  ds_read_b64_tr_b16 v[206:207], v17 offset:32160
  v_mfma_f32_16x16x32_bf16 v[84:87], v[164:167], a[64:67], v[84:87]
  ds_read_b64_tr_b16 v[208:209], v16 offset:30912
  v_mfma_f32_16x16x32_bf16 v[124:127], v[164:167], a[68:71], v[124:127]
  ds_read_b64_tr_b16 v[210:211], v16 offset:32192
  ds_read_b64_tr_b16 v[212:213], v17 offset:30944
  v_mfma_f32_16x16x32_bf16 v[88:91], v[168:171], a[64:67], v[88:91]
  ds_read_b64_tr_b16 v[214:215], v17 offset:32224
  v_mfma_f32_16x16x32_bf16 v[128:131], v[168:171], a[68:71], v[128:131]
  buffer_load_dwordx4 a[144:147], v6, s[16:19], s48 offen offset:0 sc1
  ds_read_b64_tr_b16 v[216:217], v16 offset:30976
  v_mfma_f32_16x16x32_bf16 v[92:95], v[172:175], a[64:67], v[92:95]
  ds_read_b64_tr_b16 v[218:219], v16 offset:32256
  v_mfma_f32_16x16x32_bf16 v[132:135], v[172:175], a[68:71], v[132:135]
  ds_read_b64_tr_b16 v[220:221], v17 offset:31008
  v_mfma_f32_16x16x32_bf16 v[96:99], v[176:179], a[64:67], v[96:99]
  ds_read_b64_tr_b16 v[222:223], v17 offset:32288
  v_mfma_f32_16x16x32_bf16 v[136:139], v[176:179], a[68:71], v[136:139]
  buffer_load_dwordx4 a[148:151], v6, s[16:19], s48 offen offset:128 sc1
  v_mfma_f32_16x16x32_bf16 v[100:103], v[180:183], a[64:67], v[100:103]
  s_add_u32 s48, s48, 132096
  v_mfma_f32_16x16x32_bf16 v[140:143], v[180:183], a[68:71], v[140:143]
  s_waitcnt lgkmcnt(0) vmcnt(38)
  s_barrier
  v_mfma_f32_16x16x32_bf16 v[64:67], v[184:187], a[72:75], v[64:67]
  ds_read_b64_tr_b16 v[144:145], v16 offset:40960
  ds_read_b64_tr_b16 v[146:147], v16 offset:42240
  v_mfma_f32_16x16x32_bf16 v[104:107], v[184:187], a[76:79], v[104:107]
  ds_read_b64_tr_b16 v[148:149], v17 offset:40992
  v_mfma_f32_16x16x32_bf16 v[68:71], v[188:191], a[72:75], v[68:71]
  ds_read_b64_tr_b16 v[150:151], v17 offset:42272
  v_mfma_f32_16x16x32_bf16 v[108:111], v[188:191], a[76:79], v[108:111]
  ds_read_b64_tr_b16 v[152:153], v16 offset:41024
  v_mfma_f32_16x16x32_bf16 v[72:75], v[192:195], a[72:75], v[72:75]
  ds_read_b64_tr_b16 v[154:155], v16 offset:42304
  v_mfma_f32_16x16x32_bf16 v[112:115], v[192:195], a[76:79], v[112:115]
  ds_read_b64_tr_b16 v[156:157], v17 offset:41056
  ds_read_b64_tr_b16 v[158:159], v17 offset:42336
  v_mfma_f32_16x16x32_bf16 v[76:79], v[196:199], a[72:75], v[76:79]
  ds_read_b64_tr_b16 v[160:161], v16 offset:41088
  v_mfma_f32_16x16x32_bf16 v[116:119], v[196:199], a[76:79], v[116:119]
  ds_read_b64_tr_b16 v[162:163], v16 offset:42368
  v_mfma_f32_16x16x32_bf16 v[80:83], v[200:203], a[72:75], v[80:83]
  ds_read_b64_tr_b16 v[164:165], v17 offset:41120
  v_mfma_f32_16x16x32_bf16 v[120:123], v[200:203], a[76:79], v[120:123]
  ds_read_b64_tr_b16 v[166:167], v17 offset:42400
  v_mfma_f32_16x16x32_bf16 v[84:87], v[204:207], a[72:75], v[84:87]
  ds_read_b64_tr_b16 v[168:169], v16 offset:41152
  v_mfma_f32_16x16x32_bf16 v[124:127], v[204:207], a[76:79], v[124:127]
  ds_read_b64_tr_b16 v[170:171], v16 offset:42432
  ds_read_b64_tr_b16 v[172:173], v17 offset:41184
  v_mfma_f32_16x16x32_bf16 v[88:91], v[208:211], a[72:75], v[88:91]
  ds_read_b64_tr_b16 v[174:175], v17 offset:42464
  v_mfma_f32_16x16x32_bf16 v[128:131], v[208:211], a[76:79], v[128:131]
  buffer_load_dwordx4 a[152:155], v6, s[16:19], s48 offen offset:0 sc1
  ds_read_b64_tr_b16 v[176:177], v16 offset:41216
  v_mfma_f32_16x16x32_bf16 v[92:95], v[212:215], a[72:75], v[92:95]
  ds_read_b64_tr_b16 v[178:179], v16 offset:42496
  v_mfma_f32_16x16x32_bf16 v[132:135], v[212:215], a[76:79], v[132:135]
  ds_read_b64_tr_b16 v[180:181], v17 offset:41248
  v_mfma_f32_16x16x32_bf16 v[96:99], v[216:219], a[72:75], v[96:99]
  ds_read_b64_tr_b16 v[182:183], v17 offset:42528
  v_mfma_f32_16x16x32_bf16 v[136:139], v[216:219], a[76:79], v[136:139]
  buffer_load_dwordx4 a[156:159], v6, s[16:19], s48 offen offset:128 sc1
  v_mfma_f32_16x16x32_bf16 v[100:103], v[220:223], a[72:75], v[100:103]
  s_add_u32 s48, s48, 132096
  v_mfma_f32_16x16x32_bf16 v[140:143], v[220:223], a[76:79], v[140:143]
  s_waitcnt lgkmcnt(0) vmcnt(33)
  v_mfma_f32_16x16x32_bf16 v[64:67], v[144:147], a[80:83], v[64:67]
  ds_read_b64_tr_b16 v[184:185], v16 offset:51200
  ds_read_b64_tr_b16 v[186:187], v16 offset:52480
  v_mfma_f32_16x16x32_bf16 v[104:107], v[144:147], a[84:87], v[104:107]
  ds_read_b64_tr_b16 v[188:189], v17 offset:51232
  v_mfma_f32_16x16x32_bf16 v[68:71], v[148:151], a[80:83], v[68:71]
  ds_read_b64_tr_b16 v[190:191], v17 offset:52512
  v_mfma_f32_16x16x32_bf16 v[108:111], v[148:151], a[84:87], v[108:111]
  ds_read_b64_tr_b16 v[192:193], v16 offset:51264
  v_mfma_f32_16x16x32_bf16 v[72:75], v[152:155], a[80:83], v[72:75]
  ds_read_b64_tr_b16 v[194:195], v16 offset:52544
  v_mfma_f32_16x16x32_bf16 v[112:115], v[152:155], a[84:87], v[112:115]
  ds_read_b64_tr_b16 v[196:197], v17 offset:51296
  ds_read_b64_tr_b16 v[198:199], v17 offset:52576
  v_mfma_f32_16x16x32_bf16 v[76:79], v[156:159], a[80:83], v[76:79]
  ds_read_b64_tr_b16 v[200:201], v16 offset:51328
  v_mfma_f32_16x16x32_bf16 v[116:119], v[156:159], a[84:87], v[116:119]
  ds_read_b64_tr_b16 v[202:203], v16 offset:52608
  v_mfma_f32_16x16x32_bf16 v[80:83], v[160:163], a[80:83], v[80:83]
  ds_read_b64_tr_b16 v[204:205], v17 offset:51360
  v_mfma_f32_16x16x32_bf16 v[120:123], v[160:163], a[84:87], v[120:123]
  ds_read_b64_tr_b16 v[206:207], v17 offset:52640
  v_mfma_f32_16x16x32_bf16 v[84:87], v[164:167], a[80:83], v[84:87]
  ds_read_b64_tr_b16 v[208:209], v16 offset:51392
  v_mfma_f32_16x16x32_bf16 v[124:127], v[164:167], a[84:87], v[124:127]
  ds_read_b64_tr_b16 v[210:211], v16 offset:52672
  ds_read_b64_tr_b16 v[212:213], v17 offset:51424
  v_mfma_f32_16x16x32_bf16 v[88:91], v[168:171], a[80:83], v[88:91]
  ds_read_b64_tr_b16 v[214:215], v17 offset:52704
  v_mfma_f32_16x16x32_bf16 v[128:131], v[168:171], a[84:87], v[128:131]
  buffer_load_dwordx4 v[52:55], v4, s[12:15], 0 offen
  ds_read_b64_tr_b16 v[216:217], v16 offset:51456
  v_mfma_f32_16x16x32_bf16 v[92:95], v[172:175], a[80:83], v[92:95]
  ds_read_b64_tr_b16 v[218:219], v16 offset:52736
  v_mfma_f32_16x16x32_bf16 v[132:135], v[172:175], a[84:87], v[132:135]
  ds_read_b64_tr_b16 v[220:221], v17 offset:51488
  v_mfma_f32_16x16x32_bf16 v[96:99], v[176:179], a[80:83], v[96:99]
  ds_read_b64_tr_b16 v[222:223], v17 offset:52768
  v_mfma_f32_16x16x32_bf16 v[136:139], v[176:179], a[84:87], v[136:139]
  buffer_load_dword v56, v5, s[12:15], 0 offen offset:1024
  v_mfma_f32_16x16x32_bf16 v[100:103], v[180:183], a[80:83], v[100:103]
  s_mul_i32 s50, s59, 1280
  v_mfma_f32_16x16x32_bf16 v[140:143], v[180:183], a[84:87], v[140:143]
  s_waitcnt lgkmcnt(0) vmcnt(28)
  s_barrier
  v_mfma_f32_16x16x32_bf16 v[64:67], v[184:187], a[88:91], v[64:67]
  ds_read_b64_tr_b16 v[144:145], v18 offset:0
  ds_read_b64_tr_b16 v[146:147], v18 offset:1280
  v_mfma_f32_16x16x32_bf16 v[104:107], v[184:187], a[92:95], v[104:107]
  ds_read_b64_tr_b16 v[148:149], v19 offset:32
  v_mfma_f32_16x16x32_bf16 v[68:71], v[188:191], a[88:91], v[68:71]
  ds_read_b64_tr_b16 v[150:151], v19 offset:1312
  v_mfma_f32_16x16x32_bf16 v[108:111], v[188:191], a[92:95], v[108:111]
  ds_read_b64_tr_b16 v[152:153], v18 offset:64
  v_mfma_f32_16x16x32_bf16 v[72:75], v[192:195], a[88:91], v[72:75]
  ds_read_b64_tr_b16 v[154:155], v18 offset:1344
  v_mfma_f32_16x16x32_bf16 v[112:115], v[192:195], a[92:95], v[112:115]
  ds_read_b64_tr_b16 v[156:157], v19 offset:96
  ds_read_b64_tr_b16 v[158:159], v19 offset:1376
  v_mfma_f32_16x16x32_bf16 v[76:79], v[196:199], a[88:91], v[76:79]
  ds_read_b64_tr_b16 v[160:161], v18 offset:128
  v_mfma_f32_16x16x32_bf16 v[116:119], v[196:199], a[92:95], v[116:119]
  ds_read_b64_tr_b16 v[162:163], v18 offset:1408
  v_mfma_f32_16x16x32_bf16 v[80:83], v[200:203], a[88:91], v[80:83]
  ds_read_b64_tr_b16 v[164:165], v19 offset:160
  v_mfma_f32_16x16x32_bf16 v[120:123], v[200:203], a[92:95], v[120:123]
  ds_read_b64_tr_b16 v[166:167], v19 offset:1440
  v_mfma_f32_16x16x32_bf16 v[84:87], v[204:207], a[88:91], v[84:87]
  ds_read_b64_tr_b16 v[168:169], v18 offset:192
  v_mfma_f32_16x16x32_bf16 v[124:127], v[204:207], a[92:95], v[124:127]
  ds_read_b64_tr_b16 v[170:171], v18 offset:1472
  ds_read_b64_tr_b16 v[172:173], v19 offset:224
  v_mfma_f32_16x16x32_bf16 v[88:91], v[208:211], a[88:91], v[88:91]
  ds_read_b64_tr_b16 v[174:175], v19 offset:1504
  v_mfma_f32_16x16x32_bf16 v[128:131], v[208:211], a[92:95], v[128:131]
  buffer_load_dwordx4 v[224:227], v4, s[8:11], s50 offen
  ds_read_b64_tr_b16 v[176:177], v18 offset:256
  v_mfma_f32_16x16x32_bf16 v[92:95], v[212:215], a[88:91], v[92:95]
  ds_read_b64_tr_b16 v[178:179], v18 offset:1536
  v_mfma_f32_16x16x32_bf16 v[132:135], v[212:215], a[92:95], v[132:135]
  ds_read_b64_tr_b16 v[180:181], v19 offset:288
  v_mfma_f32_16x16x32_bf16 v[96:99], v[216:219], a[88:91], v[96:99]
  ds_read_b64_tr_b16 v[182:183], v19 offset:1568
  v_mfma_f32_16x16x32_bf16 v[136:139], v[216:219], a[92:95], v[136:139]
  buffer_load_dword v228, v5, s[8:11], s50 offen offset:1024
  v_mfma_f32_16x16x32_bf16 v[100:103], v[220:223], a[88:91], v[100:103]
  s_add_u32 s50, s50, 1280
  v_mfma_f32_16x16x32_bf16 v[140:143], v[220:223], a[92:95], v[140:143]
  s_waitcnt lgkmcnt(0) vmcnt(28)
  v_mfma_f32_16x16x32_bf16 v[64:67], v[144:147], a[96:99], v[64:67]
  ds_read_b64_tr_b16 v[184:185], v18 offset:10240
  ds_read_b64_tr_b16 v[186:187], v18 offset:11520
  v_mfma_f32_16x16x32_bf16 v[104:107], v[144:147], a[100:103], v[104:107]
  ds_read_b64_tr_b16 v[188:189], v19 offset:10272
  v_mfma_f32_16x16x32_bf16 v[68:71], v[148:151], a[96:99], v[68:71]
  ds_read_b64_tr_b16 v[190:191], v19 offset:11552
  v_mfma_f32_16x16x32_bf16 v[108:111], v[148:151], a[100:103], v[108:111]
  ds_read_b64_tr_b16 v[192:193], v18 offset:10304
  v_mfma_f32_16x16x32_bf16 v[72:75], v[152:155], a[96:99], v[72:75]
  ds_read_b64_tr_b16 v[194:195], v18 offset:11584
  v_mfma_f32_16x16x32_bf16 v[112:115], v[152:155], a[100:103], v[112:115]
  ds_read_b64_tr_b16 v[196:197], v19 offset:10336
  ds_read_b64_tr_b16 v[198:199], v19 offset:11616
  v_mfma_f32_16x16x32_bf16 v[76:79], v[156:159], a[96:99], v[76:79]
  ds_read_b64_tr_b16 v[200:201], v18 offset:10368
  v_mfma_f32_16x16x32_bf16 v[116:119], v[156:159], a[100:103], v[116:119]
  ds_read_b64_tr_b16 v[202:203], v18 offset:11648
  v_mfma_f32_16x16x32_bf16 v[80:83], v[160:163], a[96:99], v[80:83]
  ds_read_b64_tr_b16 v[204:205], v19 offset:10400
  v_mfma_f32_16x16x32_bf16 v[120:123], v[160:163], a[100:103], v[120:123]
  ds_read_b64_tr_b16 v[206:207], v19 offset:11680
  v_mfma_f32_16x16x32_bf16 v[84:87], v[164:167], a[96:99], v[84:87]
  ds_read_b64_tr_b16 v[208:209], v18 offset:10432
  v_mfma_f32_16x16x32_bf16 v[124:127], v[164:167], a[100:103], v[124:127]
  ds_read_b64_tr_b16 v[210:211], v18 offset:11712
  ds_read_b64_tr_b16 v[212:213], v19 offset:10464
  v_mfma_f32_16x16x32_bf16 v[88:91], v[168:171], a[96:99], v[88:91]
  ds_read_b64_tr_b16 v[214:215], v19 offset:11744
  v_mfma_f32_16x16x32_bf16 v[128:131], v[168:171], a[100:103], v[128:131]
  buffer_load_dwordx4 v[230:233], v4, s[8:11], s50 offen
  ds_read_b64_tr_b16 v[216:217], v18 offset:10496
  v_mfma_f32_16x16x32_bf16 v[92:95], v[172:175], a[96:99], v[92:95]
  ds_read_b64_tr_b16 v[218:219], v18 offset:11776
  v_mfma_f32_16x16x32_bf16 v[132:135], v[172:175], a[100:103], v[132:135]
  ds_read_b64_tr_b16 v[220:221], v19 offset:10528
  v_mfma_f32_16x16x32_bf16 v[96:99], v[176:179], a[96:99], v[96:99]
  ds_read_b64_tr_b16 v[222:223], v19 offset:11808
  v_mfma_f32_16x16x32_bf16 v[136:139], v[176:179], a[100:103], v[136:139]
  buffer_load_dword v234, v5, s[8:11], s50 offen offset:1024
  v_mfma_f32_16x16x32_bf16 v[100:103], v[180:183], a[96:99], v[100:103]
  s_add_u32 s50, s50, 1280
  v_mfma_f32_16x16x32_bf16 v[140:143], v[180:183], a[100:103], v[140:143]
  s_waitcnt lgkmcnt(0) vmcnt(23)
  s_barrier
  v_mfma_f32_16x16x32_bf16 v[64:67], v[184:187], a[104:107], v[64:67]
  ds_read_b64_tr_b16 v[144:145], v14 offset:0
  ds_read_b64_tr_b16 v[146:147], v14 offset:1280
  v_mfma_f32_16x16x32_bf16 v[104:107], v[184:187], a[108:111], v[104:107]
  ds_read_b64_tr_b16 v[148:149], v15 offset:32
  v_mfma_f32_16x16x32_bf16 v[68:71], v[188:191], a[104:107], v[68:71]
  ds_read_b64_tr_b16 v[150:151], v15 offset:1312
  v_mfma_f32_16x16x32_bf16 v[108:111], v[188:191], a[108:111], v[108:111]
  ds_read_b64_tr_b16 v[152:153], v14 offset:64
  v_mfma_f32_16x16x32_bf16 v[72:75], v[192:195], a[104:107], v[72:75]
  ds_read_b64_tr_b16 v[154:155], v14 offset:1344
  v_mfma_f32_16x16x32_bf16 v[112:115], v[192:195], a[108:111], v[112:115]
  ds_read_b64_tr_b16 v[156:157], v15 offset:96
  ds_read_b64_tr_b16 v[158:159], v15 offset:1376
  v_mfma_f32_16x16x32_bf16 v[76:79], v[196:199], a[104:107], v[76:79]
  ds_read_b64_tr_b16 v[160:161], v14 offset:128
  v_mfma_f32_16x16x32_bf16 v[116:119], v[196:199], a[108:111], v[116:119]
  ds_read_b64_tr_b16 v[162:163], v14 offset:1408
  v_mfma_f32_16x16x32_bf16 v[80:83], v[200:203], a[104:107], v[80:83]
  ds_read_b64_tr_b16 v[164:165], v15 offset:160
  v_mfma_f32_16x16x32_bf16 v[120:123], v[200:203], a[108:111], v[120:123]
  ds_read_b64_tr_b16 v[166:167], v15 offset:1440
  v_mfma_f32_16x16x32_bf16 v[84:87], v[204:207], a[104:107], v[84:87]
  ds_read_b64_tr_b16 v[168:169], v14 offset:192
  v_mfma_f32_16x16x32_bf16 v[124:127], v[204:207], a[108:111], v[124:127]
  ds_read_b64_tr_b16 v[170:171], v14 offset:1472
  ds_read_b64_tr_b16 v[172:173], v15 offset:224
  v_mfma_f32_16x16x32_bf16 v[88:91], v[208:211], a[104:107], v[88:91]
  ds_read_b64_tr_b16 v[174:175], v15 offset:1504
  v_mfma_f32_16x16x32_bf16 v[128:131], v[208:211], a[108:111], v[128:131]
  buffer_load_dwordx4 v[236:239], v4, s[8:11], s50 offen
  ds_read_b64_tr_b16 v[176:177], v14 offset:256
  v_mfma_f32_16x16x32_bf16 v[92:95], v[212:215], a[104:107], v[92:95]
  ds_read_b64_tr_b16 v[178:179], v14 offset:1536
  v_mfma_f32_16x16x32_bf16 v[132:135], v[212:215], a[108:111], v[132:135]
  ds_read_b64_tr_b16 v[180:181], v15 offset:288
  v_mfma_f32_16x16x32_bf16 v[96:99], v[216:219], a[104:107], v[96:99]
  ds_read_b64_tr_b16 v[182:183], v15 offset:1568
  v_mfma_f32_16x16x32_bf16 v[136:139], v[216:219], a[108:111], v[136:139]
  buffer_load_dword v240, v5, s[8:11], s50 offen offset:1024
  v_mfma_f32_16x16x32_bf16 v[100:103], v[220:223], a[104:107], v[100:103]
  s_add_u32 s50, s50, 1280
  v_mfma_f32_16x16x32_bf16 v[140:143], v[220:223], a[108:111], v[140:143]
  s_waitcnt lgkmcnt(0) vmcnt(23)
  v_mfma_f32_16x16x32_bf16 v[64:67], v[144:147], a[112:115], v[64:67]
  ds_read_b64_tr_b16 v[184:185], v14 offset:10240
  ds_read_b64_tr_b16 v[186:187], v14 offset:11520
  v_mfma_f32_16x16x32_bf16 v[104:107], v[144:147], a[116:119], v[104:107]
  ds_read_b64_tr_b16 v[188:189], v15 offset:10272
  v_mfma_f32_16x16x32_bf16 v[68:71], v[148:151], a[112:115], v[68:71]
  ds_read_b64_tr_b16 v[190:191], v15 offset:11552
  v_mfma_f32_16x16x32_bf16 v[108:111], v[148:151], a[116:119], v[108:111]
  ds_read_b64_tr_b16 v[192:193], v14 offset:10304
  v_mfma_f32_16x16x32_bf16 v[72:75], v[152:155], a[112:115], v[72:75]
  ds_read_b64_tr_b16 v[194:195], v14 offset:11584
  v_mfma_f32_16x16x32_bf16 v[112:115], v[152:155], a[116:119], v[112:115]
  ds_read_b64_tr_b16 v[196:197], v15 offset:10336
  ds_read_b64_tr_b16 v[198:199], v15 offset:11616
  v_mfma_f32_16x16x32_bf16 v[76:79], v[156:159], a[112:115], v[76:79]
  ds_read_b64_tr_b16 v[200:201], v14 offset:10368
  v_mfma_f32_16x16x32_bf16 v[116:119], v[156:159], a[116:119], v[116:119]
  ds_read_b64_tr_b16 v[202:203], v14 offset:11648
  v_mfma_f32_16x16x32_bf16 v[80:83], v[160:163], a[112:115], v[80:83]
  ds_read_b64_tr_b16 v[204:205], v15 offset:10400
  v_mfma_f32_16x16x32_bf16 v[120:123], v[160:163], a[116:119], v[120:123]
  ds_read_b64_tr_b16 v[206:207], v15 offset:11680
  v_mfma_f32_16x16x32_bf16 v[84:87], v[164:167], a[112:115], v[84:87]
  ds_read_b64_tr_b16 v[208:209], v14 offset:10432
  v_mfma_f32_16x16x32_bf16 v[124:127], v[164:167], a[116:119], v[124:127]
  ds_read_b64_tr_b16 v[210:211], v14 offset:11712
  ds_read_b64_tr_b16 v[212:213], v15 offset:10464
  v_mfma_f32_16x16x32_bf16 v[88:91], v[168:171], a[112:115], v[88:91]
  ds_read_b64_tr_b16 v[214:215], v15 offset:11744
  v_mfma_f32_16x16x32_bf16 v[128:131], v[168:171], a[116:119], v[128:131]
  buffer_load_dwordx4 v[242:245], v4, s[8:11], s50 offen
  ds_read_b64_tr_b16 v[216:217], v14 offset:10496
  v_mfma_f32_16x16x32_bf16 v[92:95], v[172:175], a[112:115], v[92:95]
  ds_read_b64_tr_b16 v[218:219], v14 offset:11776
  v_mfma_f32_16x16x32_bf16 v[132:135], v[172:175], a[116:119], v[132:135]
  ds_read_b64_tr_b16 v[220:221], v15 offset:10528
  v_mfma_f32_16x16x32_bf16 v[96:99], v[176:179], a[112:115], v[96:99]
  ds_read_b64_tr_b16 v[222:223], v15 offset:11808
  v_mfma_f32_16x16x32_bf16 v[136:139], v[176:179], a[116:119], v[136:139]
  buffer_load_dword v246, v5, s[8:11], s50 offen offset:1024
  v_mfma_f32_16x16x32_bf16 v[100:103], v[180:183], a[112:115], v[100:103]
  s_add_u32 s50, s50, 1280
  v_mfma_f32_16x16x32_bf16 v[140:143], v[180:183], a[116:119], v[140:143]
  s_waitcnt lgkmcnt(0) vmcnt(18)
  s_barrier
  v_mfma_f32_16x16x32_bf16 v[64:67], v[184:187], a[120:123], v[64:67]
  ds_read_b64_tr_b16 v[144:145], v14 offset:20480
  ds_read_b64_tr_b16 v[146:147], v14 offset:21760
  v_mfma_f32_16x16x32_bf16 v[104:107], v[184:187], a[124:127], v[104:107]
  ds_read_b64_tr_b16 v[148:149], v15 offset:20512
  v_mfma_f32_16x16x32_bf16 v[68:71], v[188:191], a[120:123], v[68:71]
  ds_read_b64_tr_b16 v[150:151], v15 offset:21792
  v_mfma_f32_16x16x32_bf16 v[108:111], v[188:191], a[124:127], v[108:111]
  ds_read_b64_tr_b16 v[152:153], v14 offset:20544
  v_mfma_f32_16x16x32_bf16 v[72:75], v[192:195], a[120:123], v[72:75]
  ds_read_b64_tr_b16 v[154:155], v14 offset:21824
  v_mfma_f32_16x16x32_bf16 v[112:115], v[192:195], a[124:127], v[112:115]
  ds_read_b64_tr_b16 v[156:157], v15 offset:20576
  ds_read_b64_tr_b16 v[158:159], v15 offset:21856
  v_mfma_f32_16x16x32_bf16 v[76:79], v[196:199], a[120:123], v[76:79]
  ds_read_b64_tr_b16 v[160:161], v14 offset:20608
  v_mfma_f32_16x16x32_bf16 v[116:119], v[196:199], a[124:127], v[116:119]
  ds_read_b64_tr_b16 v[162:163], v14 offset:21888
  v_mfma_f32_16x16x32_bf16 v[80:83], v[200:203], a[120:123], v[80:83]
  ds_read_b64_tr_b16 v[164:165], v15 offset:20640
  v_mfma_f32_16x16x32_bf16 v[120:123], v[200:203], a[124:127], v[120:123]
  ds_read_b64_tr_b16 v[166:167], v15 offset:21920
  v_mfma_f32_16x16x32_bf16 v[84:87], v[204:207], a[120:123], v[84:87]
  ds_read_b64_tr_b16 v[168:169], v14 offset:20672
  v_mfma_f32_16x16x32_bf16 v[124:127], v[204:207], a[124:127], v[124:127]
  ds_read_b64_tr_b16 v[170:171], v14 offset:21952
  ds_read_b64_tr_b16 v[172:173], v15 offset:20704
  v_mfma_f32_16x16x32_bf16 v[88:91], v[208:211], a[120:123], v[88:91]
  ds_read_b64_tr_b16 v[174:175], v15 offset:21984
  v_mfma_f32_16x16x32_bf16 v[128:131], v[208:211], a[124:127], v[128:131]
  buffer_load_dwordx4 v[248:251], v4, s[8:11], s50 offen
  ds_read_b64_tr_b16 v[176:177], v14 offset:20736
  v_mfma_f32_16x16x32_bf16 v[92:95], v[212:215], a[120:123], v[92:95]
  ds_read_b64_tr_b16 v[178:179], v14 offset:22016
  v_mfma_f32_16x16x32_bf16 v[132:135], v[212:215], a[124:127], v[132:135]
  ds_read_b64_tr_b16 v[180:181], v15 offset:20768
  v_mfma_f32_16x16x32_bf16 v[96:99], v[216:219], a[120:123], v[96:99]
  ds_read_b64_tr_b16 v[182:183], v15 offset:22048
  v_mfma_f32_16x16x32_bf16 v[136:139], v[216:219], a[124:127], v[136:139]
  buffer_load_dword v252, v5, s[8:11], s50 offen offset:1024
  v_mfma_f32_16x16x32_bf16 v[100:103], v[220:223], a[120:123], v[100:103]
  s_add_u32 s50, s50, 1280
  v_mfma_f32_16x16x32_bf16 v[140:143], v[220:223], a[124:127], v[140:143]
  s_waitcnt lgkmcnt(0) vmcnt(18)
  v_mfma_f32_16x16x32_bf16 v[64:67], v[144:147], a[128:131], v[64:67]
  ds_read_b64_tr_b16 v[184:185], v14 offset:30720
  ds_read_b64_tr_b16 v[186:187], v14 offset:32000
  v_mfma_f32_16x16x32_bf16 v[104:107], v[144:147], a[132:135], v[104:107]
  ds_read_b64_tr_b16 v[188:189], v15 offset:30752
  v_mfma_f32_16x16x32_bf16 v[68:71], v[148:151], a[128:131], v[68:71]
  ds_read_b64_tr_b16 v[190:191], v15 offset:32032
  v_mfma_f32_16x16x32_bf16 v[108:111], v[148:151], a[132:135], v[108:111]
  ds_read_b64_tr_b16 v[192:193], v14 offset:30784
  v_mfma_f32_16x16x32_bf16 v[72:75], v[152:155], a[128:131], v[72:75]
  ds_read_b64_tr_b16 v[194:195], v14 offset:32064
  v_mfma_f32_16x16x32_bf16 v[112:115], v[152:155], a[132:135], v[112:115]
  ds_read_b64_tr_b16 v[196:197], v15 offset:30816
  ds_read_b64_tr_b16 v[198:199], v15 offset:32096
  v_mfma_f32_16x16x32_bf16 v[76:79], v[156:159], a[128:131], v[76:79]
  ds_read_b64_tr_b16 v[200:201], v14 offset:30848
  v_mfma_f32_16x16x32_bf16 v[116:119], v[156:159], a[132:135], v[116:119]
  ds_read_b64_tr_b16 v[202:203], v14 offset:32128
  v_mfma_f32_16x16x32_bf16 v[80:83], v[160:163], a[128:131], v[80:83]
  ds_read_b64_tr_b16 v[204:205], v15 offset:30880
  v_mfma_f32_16x16x32_bf16 v[120:123], v[160:163], a[132:135], v[120:123]
  ds_read_b64_tr_b16 v[206:207], v15 offset:32160
  v_mfma_f32_16x16x32_bf16 v[84:87], v[164:167], a[128:131], v[84:87]
  ds_read_b64_tr_b16 v[208:209], v14 offset:30912
  v_mfma_f32_16x16x32_bf16 v[124:127], v[164:167], a[132:135], v[124:127]
  ds_read_b64_tr_b16 v[210:211], v14 offset:32192
  ds_read_b64_tr_b16 v[212:213], v15 offset:30944
  v_mfma_f32_16x16x32_bf16 v[88:91], v[168:171], a[128:131], v[88:91]
  ds_read_b64_tr_b16 v[214:215], v15 offset:32224
  v_mfma_f32_16x16x32_bf16 v[128:131], v[168:171], a[132:135], v[128:131]
  buffer_load_dwordx4 v[30:33], v4, s[8:11], s50 offen
  ds_read_b64_tr_b16 v[216:217], v14 offset:30976
  v_mfma_f32_16x16x32_bf16 v[92:95], v[172:175], a[128:131], v[92:95]
  ds_read_b64_tr_b16 v[218:219], v14 offset:32256
  v_mfma_f32_16x16x32_bf16 v[132:135], v[172:175], a[132:135], v[132:135]
  ds_read_b64_tr_b16 v[220:221], v15 offset:31008
  v_mfma_f32_16x16x32_bf16 v[96:99], v[176:179], a[128:131], v[96:99]
  ds_read_b64_tr_b16 v[222:223], v15 offset:32288
  v_mfma_f32_16x16x32_bf16 v[136:139], v[176:179], a[132:135], v[136:139]
  buffer_load_dword v34, v5, s[8:11], s50 offen offset:1024
  v_mfma_f32_16x16x32_bf16 v[100:103], v[180:183], a[128:131], v[100:103]
  s_add_u32 s50, s50, 1280
  v_mfma_f32_16x16x32_bf16 v[140:143], v[180:183], a[132:135], v[140:143]
  s_waitcnt lgkmcnt(0) vmcnt(18)
  s_barrier
  v_mfma_f32_16x16x32_bf16 v[64:67], v[184:187], a[136:139], v[64:67]
  ds_read_b64_tr_b16 v[144:145], v14 offset:40960
  ds_read_b64_tr_b16 v[146:147], v14 offset:42240
  v_mfma_f32_16x16x32_bf16 v[104:107], v[184:187], a[140:143], v[104:107]
  ds_read_b64_tr_b16 v[148:149], v15 offset:40992
  v_mfma_f32_16x16x32_bf16 v[68:71], v[188:191], a[136:139], v[68:71]
  ds_read_b64_tr_b16 v[150:151], v15 offset:42272
  v_mfma_f32_16x16x32_bf16 v[108:111], v[188:191], a[140:143], v[108:111]
  ds_read_b64_tr_b16 v[152:153], v14 offset:41024
  v_mfma_f32_16x16x32_bf16 v[72:75], v[192:195], a[136:139], v[72:75]
  ds_read_b64_tr_b16 v[154:155], v14 offset:42304
  v_mfma_f32_16x16x32_bf16 v[112:115], v[192:195], a[140:143], v[112:115]
  ds_read_b64_tr_b16 v[156:157], v15 offset:41056
  ds_read_b64_tr_b16 v[158:159], v15 offset:42336
  v_mfma_f32_16x16x32_bf16 v[76:79], v[196:199], a[136:139], v[76:79]
  ds_read_b64_tr_b16 v[160:161], v14 offset:41088
  v_mfma_f32_16x16x32_bf16 v[116:119], v[196:199], a[140:143], v[116:119]
  ds_read_b64_tr_b16 v[162:163], v14 offset:42368
  v_mfma_f32_16x16x32_bf16 v[80:83], v[200:203], a[136:139], v[80:83]
  ds_read_b64_tr_b16 v[164:165], v15 offset:41120
  v_mfma_f32_16x16x32_bf16 v[120:123], v[200:203], a[140:143], v[120:123]
  ds_read_b64_tr_b16 v[166:167], v15 offset:42400
  v_mfma_f32_16x16x32_bf16 v[84:87], v[204:207], a[136:139], v[84:87]
  ds_read_b64_tr_b16 v[168:169], v14 offset:41152
  v_mfma_f32_16x16x32_bf16 v[124:127], v[204:207], a[140:143], v[124:127]
  ds_read_b64_tr_b16 v[170:171], v14 offset:42432
  ds_read_b64_tr_b16 v[172:173], v15 offset:41184
  v_mfma_f32_16x16x32_bf16 v[88:91], v[208:211], a[136:139], v[88:91]
  ds_read_b64_tr_b16 v[174:175], v15 offset:42464
  v_mfma_f32_16x16x32_bf16 v[128:131], v[208:211], a[140:143], v[128:131]
  buffer_load_dwordx4 v[36:39], v4, s[8:11], s50 offen
  ds_read_b64_tr_b16 v[176:177], v14 offset:41216
  v_mfma_f32_16x16x32_bf16 v[92:95], v[212:215], a[136:139], v[92:95]
  ds_read_b64_tr_b16 v[178:179], v14 offset:42496
  v_mfma_f32_16x16x32_bf16 v[132:135], v[212:215], a[140:143], v[132:135]
  ds_read_b64_tr_b16 v[180:181], v15 offset:41248
  v_mfma_f32_16x16x32_bf16 v[96:99], v[216:219], a[136:139], v[96:99]
  ds_read_b64_tr_b16 v[182:183], v15 offset:42528
  v_mfma_f32_16x16x32_bf16 v[136:139], v[216:219], a[140:143], v[136:139]
  buffer_load_dword v40, v5, s[8:11], s50 offen offset:1024
  v_mfma_f32_16x16x32_bf16 v[100:103], v[220:223], a[136:139], v[100:103]
  s_add_u32 s50, s50, 1280
  v_mfma_f32_16x16x32_bf16 v[140:143], v[220:223], a[140:143], v[140:143]
  s_waitcnt lgkmcnt(0) vmcnt(18)
  v_mfma_f32_16x16x32_bf16 v[64:67], v[144:147], a[144:147], v[64:67]
  ds_read_b64_tr_b16 v[184:185], v14 offset:51200
  ds_read_b64_tr_b16 v[186:187], v14 offset:52480
  v_mfma_f32_16x16x32_bf16 v[104:107], v[144:147], a[148:151], v[104:107]
  ds_read_b64_tr_b16 v[188:189], v15 offset:51232
  v_mfma_f32_16x16x32_bf16 v[68:71], v[148:151], a[144:147], v[68:71]
  ds_read_b64_tr_b16 v[190:191], v15 offset:52512
  v_mfma_f32_16x16x32_bf16 v[108:111], v[148:151], a[148:151], v[108:111]
  ds_read_b64_tr_b16 v[192:193], v14 offset:51264
  v_mfma_f32_16x16x32_bf16 v[72:75], v[152:155], a[144:147], v[72:75]
  ds_read_b64_tr_b16 v[194:195], v14 offset:52544
  v_mfma_f32_16x16x32_bf16 v[112:115], v[152:155], a[148:151], v[112:115]
  ds_read_b64_tr_b16 v[196:197], v15 offset:51296
  ds_read_b64_tr_b16 v[198:199], v15 offset:52576
  v_mfma_f32_16x16x32_bf16 v[76:79], v[156:159], a[144:147], v[76:79]
  ds_read_b64_tr_b16 v[200:201], v14 offset:51328
  v_mfma_f32_16x16x32_bf16 v[116:119], v[156:159], a[148:151], v[116:119]
  ds_read_b64_tr_b16 v[202:203], v14 offset:52608
  v_mfma_f32_16x16x32_bf16 v[80:83], v[160:163], a[144:147], v[80:83]
  ds_read_b64_tr_b16 v[204:205], v15 offset:51360
  v_mfma_f32_16x16x32_bf16 v[120:123], v[160:163], a[148:151], v[120:123]
  ds_read_b64_tr_b16 v[206:207], v15 offset:52640
  v_mfma_f32_16x16x32_bf16 v[84:87], v[164:167], a[144:147], v[84:87]
  ds_read_b64_tr_b16 v[208:209], v14 offset:51392
  v_mfma_f32_16x16x32_bf16 v[124:127], v[164:167], a[148:151], v[124:127]
  ds_read_b64_tr_b16 v[210:211], v14 offset:52672
  ds_read_b64_tr_b16 v[212:213], v15 offset:51424
  v_mfma_f32_16x16x32_bf16 v[88:91], v[168:171], a[144:147], v[88:91]
  ds_read_b64_tr_b16 v[214:215], v15 offset:52704
  v_mfma_f32_16x16x32_bf16 v[128:131], v[168:171], a[148:151], v[128:131]
  buffer_load_dwordx4 v[42:45], v4, s[8:11], s50 offen
  ds_read_b64_tr_b16 v[216:217], v14 offset:51456
  v_mfma_f32_16x16x32_bf16 v[92:95], v[172:175], a[144:147], v[92:95]
  ds_read_b64_tr_b16 v[218:219], v14 offset:52736
  v_mfma_f32_16x16x32_bf16 v[132:135], v[172:175], a[148:151], v[132:135]
  ds_read_b64_tr_b16 v[220:221], v15 offset:51488
  v_mfma_f32_16x16x32_bf16 v[96:99], v[176:179], a[144:147], v[96:99]
  ds_read_b64_tr_b16 v[222:223], v15 offset:52768
  v_mfma_f32_16x16x32_bf16 v[136:139], v[176:179], a[148:151], v[136:139]
  buffer_load_dword v46, v5, s[8:11], s50 offen offset:1024
  v_mfma_f32_16x16x32_bf16 v[100:103], v[180:183], a[144:147], v[100:103]
  s_add_u32 s50, s50, 1280
  v_mfma_f32_16x16x32_bf16 v[140:143], v[180:183], a[148:151], v[140:143]
  s_waitcnt lgkmcnt(0) vmcnt(18)
  v_mfma_f32_16x16x32_bf16 v[64:67], v[184:187], a[152:155], v[64:67]
  v_mfma_f32_16x16x32_bf16 v[104:107], v[184:187], a[156:159], v[104:107]
  v_mfma_f32_16x16x32_bf16 v[68:71], v[188:191], a[152:155], v[68:71]
  v_mfma_f32_16x16x32_bf16 v[108:111], v[188:191], a[156:159], v[108:111]
  v_mfma_f32_16x16x32_bf16 v[72:75], v[192:195], a[152:155], v[72:75]
  v_mfma_f32_16x16x32_bf16 v[112:115], v[192:195], a[156:159], v[112:115]
  v_mfma_f32_16x16x32_bf16 v[76:79], v[196:199], a[152:155], v[76:79]
  v_mfma_f32_16x16x32_bf16 v[116:119], v[196:199], a[156:159], v[116:119]
  v_mfma_f32_16x16x32_bf16 v[80:83], v[200:203], a[152:155], v[80:83]
  v_mfma_f32_16x16x32_bf16 v[120:123], v[200:203], a[156:159], v[120:123]
  v_mfma_f32_16x16x32_bf16 v[84:87], v[204:207], a[152:155], v[84:87]
  v_mfma_f32_16x16x32_bf16 v[124:127], v[204:207], a[156:159], v[124:127]
  v_mfma_f32_16x16x32_bf16 v[88:91], v[208:211], a[152:155], v[88:91]
  v_mfma_f32_16x16x32_bf16 v[128:131], v[208:211], a[156:159], v[128:131]
  v_mfma_f32_16x16x32_bf16 v[92:95], v[212:215], a[152:155], v[92:95]
  v_mfma_f32_16x16x32_bf16 v[132:135], v[212:215], a[156:159], v[132:135]
  v_mfma_f32_16x16x32_bf16 v[96:99], v[216:219], a[152:155], v[96:99]
  v_mfma_f32_16x16x32_bf16 v[136:139], v[216:219], a[156:159], v[136:139]
  v_mfma_f32_16x16x32_bf16 v[100:103], v[220:223], a[152:155], v[100:103]
  v_mfma_f32_16x16x32_bf16 v[140:143], v[220:223], a[156:159], v[140:143]
  s_add_u32 s16, s38, 73400320
  s_addc_u32 s17, s39, 0
  s_mov_b32 s18, 5242880
  s_mov_b32 s19, 0x00020000
  s_nop 3
  s_mul_i32 s21, s47, 40
  s_mul_i32 s22, s44, 10
  s_add_u32 s21, s21, s22
  s_lshl_b32 s21, s21, 10
  s_cmp_lt_u32 s2, 32
  s_cbranch_scc1 om_241
  s_add_u32 s22, s21, 0
  buffer_store_dwordx4 v[64:67], v4, s[16:19], s22 offen offset:0 sc1
  buffer_store_dwordx4 v[68:71], v4, s[16:19], s22 offen offset:1024 sc1
  buffer_store_dwordx4 v[72:75], v4, s[16:19], s22 offen offset:2048 sc1
  buffer_store_dwordx4 v[76:79], v4, s[16:19], s22 offen offset:3072 sc1
  s_add_u32 s22, s21, 4096
  buffer_store_dwordx4 v[80:83], v4, s[16:19], s22 offen offset:0 sc1
  buffer_store_dwordx4 v[84:87], v4, s[16:19], s22 offen offset:1024 sc1
  buffer_store_dwordx4 v[88:91], v4, s[16:19], s22 offen offset:2048 sc1
  buffer_store_dwordx4 v[92:95], v4, s[16:19], s22 offen offset:3072 sc1
  s_add_u32 s22, s21, 8192
  buffer_store_dwordx4 v[96:99], v4, s[16:19], s22 offen offset:0 sc1
  buffer_store_dwordx4 v[100:103], v4, s[16:19], s22 offen offset:1024 sc1
  s_add_u32 s22, s21, 40960
  buffer_store_dwordx4 v[104:107], v4, s[16:19], s22 offen offset:0 sc1
  buffer_store_dwordx4 v[108:111], v4, s[16:19], s22 offen offset:1024 sc1
  buffer_store_dwordx4 v[112:115], v4, s[16:19], s22 offen offset:2048 sc1
  buffer_store_dwordx4 v[116:119], v4, s[16:19], s22 offen offset:3072 sc1
  s_add_u32 s22, s21, 45056
  buffer_store_dwordx4 v[120:123], v4, s[16:19], s22 offen offset:0 sc1
  buffer_store_dwordx4 v[124:127], v4, s[16:19], s22 offen offset:1024 sc1
  buffer_store_dwordx4 v[128:131], v4, s[16:19], s22 offen offset:2048 sc1
  buffer_store_dwordx4 v[132:135], v4, s[16:19], s22 offen offset:3072 sc1
  s_add_u32 s22, s21, 49152
  buffer_store_dwordx4 v[136:139], v4, s[16:19], s22 offen offset:0 sc1
  buffer_store_dwordx4 v[140:143], v4, s[16:19], s22 offen offset:1024 sc1
  s_sub_u32 s50, s50, 1320960
  buffer_load_dwordx4 v[160:163], v4, s[8:11], s50 offen
  buffer_load_dword v164, v5, s[8:11], s50 offen offset:1024
  s_add_u32 s50, s50, 1280
  buffer_load_dwordx4 v[166:169], v4, s[8:11], s50 offen
  buffer_load_dword v170, v5, s[8:11], s50 offen offset:1024
  s_add_u32 s50, s50, 1280
  buffer_load_dwordx4 v[172:175], v4, s[8:11], s50 offen
  buffer_load_dword v176, v5, s[8:11], s50 offen offset:1024
  s_add_u32 s50, s50, 1280
  buffer_load_dwordx4 v[178:181], v4, s[8:11], s50 offen
  buffer_load_dword v182, v5, s[8:11], s50 offen offset:1024
  s_add_u32 s50, s50, 1280
  buffer_load_dwordx4 v[184:187], v4, s[8:11], s50 offen
  buffer_load_dword v188, v5, s[8:11], s50 offen offset:1024
  s_add_u32 s50, s50, 1280
  buffer_load_dwordx4 v[190:193], v4, s[8:11], s50 offen
  buffer_load_dword v194, v5, s[8:11], s50 offen offset:1024
  s_add_u32 s50, s50, 1280
  buffer_load_dwordx4 v[196:199], v4, s[8:11], s50 offen
  buffer_load_dword v200, v5, s[8:11], s50 offen offset:1024
  s_add_u32 s50, s50, 1280
  buffer_load_dwordx4 v[202:205], v4, s[8:11], s50 offen
  buffer_load_dword v206, v5, s[8:11], s50 offen offset:1024
  s_add_u32 s50, s50, 1280
  s_waitcnt vmcnt(36)
  v_lshlrev_b32 v57, 16, v52
  v_and_b32 v52, 0xffff0000, v52
  v_lshlrev_b32 v58, 16, v53
  v_and_b32 v53, 0xffff0000, v53
  v_lshlrev_b32 v59, 16, v54
  v_and_b32 v54, 0xffff0000, v54
  v_lshlrev_b32 v60, 16, v55
  v_and_b32 v55, 0xffff0000, v55
  v_lshlrev_b32 v61, 16, v56
  v_and_b32 v56, 0xffff0000, v56
  v_lshlrev_b32 v25, 16, v224
  v_and_b32 v26, 0xffff0000, v224
  v_mul_f32 v25, v25, v57
  v_mul_f32 v26, v26, v52
  v_cvt_pk_bf16_f32 v25, v25, v26
  v_lshlrev_b32 v26, 16, v25
  v_and_b32 v25, 0xffff0000, v25
  v_add_f32 v144, v25, v26
  v_lshlrev_b32 v25, 16, v225
  v_and_b32 v26, 0xffff0000, v225
  v_mul_f32 v25, v25, v58
  v_mul_f32 v26, v26, v53
  v_cvt_pk_bf16_f32 v25, v25, v26
  v_lshlrev_b32 v26, 16, v25
  v_and_b32 v25, 0xffff0000, v25
  v_add_f32 v144, v144, v26
  v_add_f32 v144, v144, v25
  v_lshlrev_b32 v25, 16, v226
  v_and_b32 v26, 0xffff0000, v226
  v_mul_f32 v25, v25, v59
  v_mul_f32 v26, v26, v54
  v_cvt_pk_bf16_f32 v25, v25, v26
  v_lshlrev_b32 v26, 16, v25
  v_and_b32 v25, 0xffff0000, v25
  v_add_f32 v144, v144, v26
  v_add_f32 v144, v144, v25
  v_lshlrev_b32 v25, 16, v227
  v_and_b32 v26, 0xffff0000, v227
  v_mul_f32 v25, v25, v60
  v_mul_f32 v26, v26, v55
  v_cvt_pk_bf16_f32 v25, v25, v26
  v_lshlrev_b32 v26, 16, v25
  v_and_b32 v25, 0xffff0000, v25
  v_add_f32 v144, v144, v26
  v_add_f32 v144, v144, v25
  v_lshlrev_b32 v25, 16, v228
  v_and_b32 v26, 0xffff0000, v228
  v_mul_f32 v25, v25, v61
  v_mul_f32 v26, v26, v56
  v_cvt_pk_bf16_f32 v25, v25, v26
  v_lshlrev_b32 v26, 16, v25
  v_and_b32 v25, 0xffff0000, v25
  v_add_f32 v144, v144, v26
  v_add_f32 v144, v144, v25
  v_lshlrev_b32 v25, 16, v230
  v_and_b32 v26, 0xffff0000, v230
  v_mul_f32 v25, v25, v57
  v_mul_f32 v26, v26, v52
  v_cvt_pk_bf16_f32 v25, v25, v26
  v_lshlrev_b32 v26, 16, v25
  v_and_b32 v25, 0xffff0000, v25
  v_add_f32 v145, v25, v26
  v_lshlrev_b32 v25, 16, v231
  v_and_b32 v26, 0xffff0000, v231
  v_mul_f32 v25, v25, v58
  v_mul_f32 v26, v26, v53
  v_cvt_pk_bf16_f32 v25, v25, v26
  v_lshlrev_b32 v26, 16, v25
  v_and_b32 v25, 0xffff0000, v25
  v_add_f32 v145, v145, v26
  v_add_f32 v145, v145, v25
  v_lshlrev_b32 v25, 16, v232
  v_and_b32 v26, 0xffff0000, v232
  v_mul_f32 v25, v25, v59
  v_mul_f32 v26, v26, v54
  v_cvt_pk_bf16_f32 v25, v25, v26
  v_lshlrev_b32 v26, 16, v25
  v_and_b32 v25, 0xffff0000, v25
  v_add_f32 v145, v145, v26
  v_add_f32 v145, v145, v25
  v_lshlrev_b32 v25, 16, v233
  v_and_b32 v26, 0xffff0000, v233
  v_mul_f32 v25, v25, v60
  v_mul_f32 v26, v26, v55
  v_cvt_pk_bf16_f32 v25, v25, v26
  v_lshlrev_b32 v26, 16, v25
  v_and_b32 v25, 0xffff0000, v25
  v_add_f32 v145, v145, v26
  v_add_f32 v145, v145, v25
  v_lshlrev_b32 v25, 16, v234
  v_and_b32 v26, 0xffff0000, v234
  v_mul_f32 v25, v25, v61
  v_mul_f32 v26, v26, v56
  v_cvt_pk_bf16_f32 v25, v25, v26
  v_lshlrev_b32 v26, 16, v25
  v_and_b32 v25, 0xffff0000, v25
  v_add_f32 v145, v145, v26
  v_add_f32 v145, v145, v25
  v_lshlrev_b32 v25, 16, v236
  v_and_b32 v26, 0xffff0000, v236
  v_mul_f32 v25, v25, v57
  v_mul_f32 v26, v26, v52
  v_cvt_pk_bf16_f32 v25, v25, v26
  v_lshlrev_b32 v26, 16, v25
  v_and_b32 v25, 0xffff0000, v25
  v_add_f32 v146, v25, v26
  v_lshlrev_b32 v25, 16, v237
  v_and_b32 v26, 0xffff0000, v237
  v_mul_f32 v25, v25, v58
  v_mul_f32 v26, v26, v53
  v_cvt_pk_bf16_f32 v25, v25, v26
  v_lshlrev_b32 v26, 16, v25
  v_and_b32 v25, 0xffff0000, v25
  v_add_f32 v146, v146, v26
  v_add_f32 v146, v146, v25
  v_lshlrev_b32 v25, 16, v238
  v_and_b32 v26, 0xffff0000, v238
  v_mul_f32 v25, v25, v59
  v_mul_f32 v26, v26, v54
  v_cvt_pk_bf16_f32 v25, v25, v26
  v_lshlrev_b32 v26, 16, v25
  v_and_b32 v25, 0xffff0000, v25
  v_add_f32 v146, v146, v26
  v_add_f32 v146, v146, v25
  v_lshlrev_b32 v25, 16, v239
  v_and_b32 v26, 0xffff0000, v239
  v_mul_f32 v25, v25, v60
  v_mul_f32 v26, v26, v55
  v_cvt_pk_bf16_f32 v25, v25, v26
  v_lshlrev_b32 v26, 16, v25
  v_and_b32 v25, 0xffff0000, v25
  v_add_f32 v146, v146, v26
  v_add_f32 v146, v146, v25
  v_lshlrev_b32 v25, 16, v240
  v_and_b32 v26, 0xffff0000, v240
  v_mul_f32 v25, v25, v61
  v_mul_f32 v26, v26, v56
  v_cvt_pk_bf16_f32 v25, v25, v26
  v_lshlrev_b32 v26, 16, v25
  v_and_b32 v25, 0xffff0000, v25
  v_add_f32 v146, v146, v26
  v_add_f32 v146, v146, v25
  v_lshlrev_b32 v25, 16, v242
  v_and_b32 v26, 0xffff0000, v242
  v_mul_f32 v25, v25, v57
  v_mul_f32 v26, v26, v52
  v_cvt_pk_bf16_f32 v25, v25, v26
  v_lshlrev_b32 v26, 16, v25
  v_and_b32 v25, 0xffff0000, v25
  v_add_f32 v147, v25, v26
  v_lshlrev_b32 v25, 16, v243
  v_and_b32 v26, 0xffff0000, v243
  v_mul_f32 v25, v25, v58
  v_mul_f32 v26, v26, v53
  v_cvt_pk_bf16_f32 v25, v25, v26
  v_lshlrev_b32 v26, 16, v25
  v_and_b32 v25, 0xffff0000, v25
  v_add_f32 v147, v147, v26
  v_add_f32 v147, v147, v25
  v_lshlrev_b32 v25, 16, v244
  v_and_b32 v26, 0xffff0000, v244
  v_mul_f32 v25, v25, v59
  v_mul_f32 v26, v26, v54
  v_cvt_pk_bf16_f32 v25, v25, v26
  v_lshlrev_b32 v26, 16, v25
  v_and_b32 v25, 0xffff0000, v25
  v_add_f32 v147, v147, v26
  v_add_f32 v147, v147, v25
  v_lshlrev_b32 v25, 16, v245
  v_and_b32 v26, 0xffff0000, v245
  v_mul_f32 v25, v25, v60
  v_mul_f32 v26, v26, v55
  v_cvt_pk_bf16_f32 v25, v25, v26
  v_lshlrev_b32 v26, 16, v25
  v_and_b32 v25, 0xffff0000, v25
  v_add_f32 v147, v147, v26
  v_add_f32 v147, v147, v25
  v_lshlrev_b32 v25, 16, v246
  v_and_b32 v26, 0xffff0000, v246
  v_mul_f32 v25, v25, v61
  v_mul_f32 v26, v26, v56
  v_cvt_pk_bf16_f32 v25, v25, v26
  v_lshlrev_b32 v26, 16, v25
  v_and_b32 v25, 0xffff0000, v25
  v_add_f32 v147, v147, v26
  v_add_f32 v147, v147, v25
  v_lshlrev_b32 v25, 16, v248
  v_and_b32 v26, 0xffff0000, v248
  v_mul_f32 v25, v25, v57
  v_mul_f32 v26, v26, v52
  v_cvt_pk_bf16_f32 v25, v25, v26
  v_lshlrev_b32 v26, 16, v25
  v_and_b32 v25, 0xffff0000, v25
  v_add_f32 v148, v25, v26
  v_lshlrev_b32 v25, 16, v249
  v_and_b32 v26, 0xffff0000, v249
  v_mul_f32 v25, v25, v58
  v_mul_f32 v26, v26, v53
  v_cvt_pk_bf16_f32 v25, v25, v26
  v_lshlrev_b32 v26, 16, v25
  v_and_b32 v25, 0xffff0000, v25
  v_add_f32 v148, v148, v26
  v_add_f32 v148, v148, v25
  v_lshlrev_b32 v25, 16, v250
  v_and_b32 v26, 0xffff0000, v250
  v_mul_f32 v25, v25, v59
  v_mul_f32 v26, v26, v54
  v_cvt_pk_bf16_f32 v25, v25, v26
  v_lshlrev_b32 v26, 16, v25
  v_and_b32 v25, 0xffff0000, v25
  v_add_f32 v148, v148, v26
  v_add_f32 v148, v148, v25
  v_lshlrev_b32 v25, 16, v251
  v_and_b32 v26, 0xffff0000, v251
  v_mul_f32 v25, v25, v60
  v_mul_f32 v26, v26, v55
  v_cvt_pk_bf16_f32 v25, v25, v26
  v_lshlrev_b32 v26, 16, v25
  v_and_b32 v25, 0xffff0000, v25
  v_add_f32 v148, v148, v26
  v_add_f32 v148, v148, v25
  v_lshlrev_b32 v25, 16, v252
  v_and_b32 v26, 0xffff0000, v252
  v_mul_f32 v25, v25, v61
  v_mul_f32 v26, v26, v56
  v_cvt_pk_bf16_f32 v25, v25, v26
  v_lshlrev_b32 v26, 16, v25
  v_and_b32 v25, 0xffff0000, v25
  v_add_f32 v148, v148, v26
  v_add_f32 v148, v148, v25
  v_lshlrev_b32 v25, 16, v30
  v_and_b32 v26, 0xffff0000, v30
  v_mul_f32 v25, v25, v57
  v_mul_f32 v26, v26, v52
  v_cvt_pk_bf16_f32 v25, v25, v26
  v_lshlrev_b32 v26, 16, v25
  v_and_b32 v25, 0xffff0000, v25
  v_add_f32 v149, v25, v26
  v_lshlrev_b32 v25, 16, v31
  v_and_b32 v26, 0xffff0000, v31
  v_mul_f32 v25, v25, v58
  v_mul_f32 v26, v26, v53
  v_cvt_pk_bf16_f32 v25, v25, v26
  v_lshlrev_b32 v26, 16, v25
  v_and_b32 v25, 0xffff0000, v25
  v_add_f32 v149, v149, v26
  v_add_f32 v149, v149, v25
  v_lshlrev_b32 v25, 16, v32
  v_and_b32 v26, 0xffff0000, v32
  v_mul_f32 v25, v25, v59
  v_mul_f32 v26, v26, v54
  v_cvt_pk_bf16_f32 v25, v25, v26
  v_lshlrev_b32 v26, 16, v25
  v_and_b32 v25, 0xffff0000, v25
  v_add_f32 v149, v149, v26
  v_add_f32 v149, v149, v25
  v_lshlrev_b32 v25, 16, v33
  v_and_b32 v26, 0xffff0000, v33
  v_mul_f32 v25, v25, v60
  v_mul_f32 v26, v26, v55
  v_cvt_pk_bf16_f32 v25, v25, v26
  v_lshlrev_b32 v26, 16, v25
  v_and_b32 v25, 0xffff0000, v25
  v_add_f32 v149, v149, v26
  v_add_f32 v149, v149, v25
  v_lshlrev_b32 v25, 16, v34
  v_and_b32 v26, 0xffff0000, v34
  v_mul_f32 v25, v25, v61
  v_mul_f32 v26, v26, v56
  v_cvt_pk_bf16_f32 v25, v25, v26
  v_lshlrev_b32 v26, 16, v25
  v_and_b32 v25, 0xffff0000, v25
  v_add_f32 v149, v149, v26
  v_add_f32 v149, v149, v25
  v_lshlrev_b32 v25, 16, v36
  v_and_b32 v26, 0xffff0000, v36
  v_mul_f32 v25, v25, v57
  v_mul_f32 v26, v26, v52
  v_cvt_pk_bf16_f32 v25, v25, v26
  v_lshlrev_b32 v26, 16, v25
  v_and_b32 v25, 0xffff0000, v25
  v_add_f32 v150, v25, v26
  v_lshlrev_b32 v25, 16, v37
  v_and_b32 v26, 0xffff0000, v37
  v_mul_f32 v25, v25, v58
  v_mul_f32 v26, v26, v53
  v_cvt_pk_bf16_f32 v25, v25, v26
  v_lshlrev_b32 v26, 16, v25
  v_and_b32 v25, 0xffff0000, v25
  v_add_f32 v150, v150, v26
  v_add_f32 v150, v150, v25
  v_lshlrev_b32 v25, 16, v38
  v_and_b32 v26, 0xffff0000, v38
  v_mul_f32 v25, v25, v59
  v_mul_f32 v26, v26, v54
  v_cvt_pk_bf16_f32 v25, v25, v26
  v_lshlrev_b32 v26, 16, v25
  v_and_b32 v25, 0xffff0000, v25
  v_add_f32 v150, v150, v26
  v_add_f32 v150, v150, v25
  v_lshlrev_b32 v25, 16, v39
  v_and_b32 v26, 0xffff0000, v39
  v_mul_f32 v25, v25, v60
  v_mul_f32 v26, v26, v55
  v_cvt_pk_bf16_f32 v25, v25, v26
  v_lshlrev_b32 v26, 16, v25
  v_and_b32 v25, 0xffff0000, v25
  v_add_f32 v150, v150, v26
  v_add_f32 v150, v150, v25
  v_lshlrev_b32 v25, 16, v40
  v_and_b32 v26, 0xffff0000, v40
  v_mul_f32 v25, v25, v61
  v_mul_f32 v26, v26, v56
  v_cvt_pk_bf16_f32 v25, v25, v26
  v_lshlrev_b32 v26, 16, v25
  v_and_b32 v25, 0xffff0000, v25
  v_add_f32 v150, v150, v26
  v_add_f32 v150, v150, v25
  v_lshlrev_b32 v25, 16, v42
  v_and_b32 v26, 0xffff0000, v42
  v_mul_f32 v25, v25, v57
  v_mul_f32 v26, v26, v52
  v_cvt_pk_bf16_f32 v25, v25, v26
  v_lshlrev_b32 v26, 16, v25
  v_and_b32 v25, 0xffff0000, v25
  v_add_f32 v151, v25, v26
  v_lshlrev_b32 v25, 16, v43
  v_and_b32 v26, 0xffff0000, v43
  v_mul_f32 v25, v25, v58
  v_mul_f32 v26, v26, v53
  v_cvt_pk_bf16_f32 v25, v25, v26
  v_lshlrev_b32 v26, 16, v25
  v_and_b32 v25, 0xffff0000, v25
  v_add_f32 v151, v151, v26
  v_add_f32 v151, v151, v25
  v_lshlrev_b32 v25, 16, v44
  v_and_b32 v26, 0xffff0000, v44
  v_mul_f32 v25, v25, v59
  v_mul_f32 v26, v26, v54
  v_cvt_pk_bf16_f32 v25, v25, v26
  v_lshlrev_b32 v26, 16, v25
  v_and_b32 v25, 0xffff0000, v25
  v_add_f32 v151, v151, v26
  v_add_f32 v151, v151, v25
  v_lshlrev_b32 v25, 16, v45
  v_and_b32 v26, 0xffff0000, v45
  v_mul_f32 v25, v25, v60
  v_mul_f32 v26, v26, v55
  v_cvt_pk_bf16_f32 v25, v25, v26
  v_lshlrev_b32 v26, 16, v25
  v_and_b32 v25, 0xffff0000, v25
  v_add_f32 v151, v151, v26
  v_add_f32 v151, v151, v25
  v_lshlrev_b32 v25, 16, v46
  v_and_b32 v26, 0xffff0000, v46
  v_mul_f32 v25, v25, v61
  v_mul_f32 v26, v26, v56
  v_cvt_pk_bf16_f32 v25, v25, v26
  v_lshlrev_b32 v26, 16, v25
  v_and_b32 v25, 0xffff0000, v25
  v_add_f32 v151, v151, v26
  v_add_f32 v151, v151, v25
  v_add_f32_dpp v144, v144, v144 row_ror:8 row_mask:0xf bank_mask:0xf
  v_add_f32_dpp v145, v145, v145 row_ror:8 row_mask:0xf bank_mask:0xf
  v_add_f32_dpp v146, v146, v146 row_ror:8 row_mask:0xf bank_mask:0xf
  v_add_f32_dpp v147, v147, v147 row_ror:8 row_mask:0xf bank_mask:0xf
  v_add_f32_dpp v148, v148, v148 row_ror:8 row_mask:0xf bank_mask:0xf
  v_add_f32_dpp v149, v149, v149 row_ror:8 row_mask:0xf bank_mask:0xf
  v_add_f32_dpp v150, v150, v150 row_ror:8 row_mask:0xf bank_mask:0xf
  v_add_f32_dpp v151, v151, v151 row_ror:8 row_mask:0xf bank_mask:0xf
  v_add_f32_dpp v144, v144, v144 row_ror:4 row_mask:0xf bank_mask:0xf
  v_add_f32_dpp v145, v145, v145 row_ror:4 row_mask:0xf bank_mask:0xf
  v_add_f32_dpp v146, v146, v146 row_ror:4 row_mask:0xf bank_mask:0xf
  v_add_f32_dpp v147, v147, v147 row_ror:4 row_mask:0xf bank_mask:0xf
  v_add_f32_dpp v148, v148, v148 row_ror:4 row_mask:0xf bank_mask:0xf
  v_add_f32_dpp v149, v149, v149 row_ror:4 row_mask:0xf bank_mask:0xf
  v_add_f32_dpp v150, v150, v150 row_ror:4 row_mask:0xf bank_mask:0xf
  v_add_f32_dpp v151, v151, v151 row_ror:4 row_mask:0xf bank_mask:0xf
  v_add_f32_dpp v144, v144, v144 row_ror:2 row_mask:0xf bank_mask:0xf
  v_add_f32_dpp v145, v145, v145 row_ror:2 row_mask:0xf bank_mask:0xf
  v_add_f32_dpp v146, v146, v146 row_ror:2 row_mask:0xf bank_mask:0xf
  v_add_f32_dpp v147, v147, v147 row_ror:2 row_mask:0xf bank_mask:0xf
  v_add_f32_dpp v148, v148, v148 row_ror:2 row_mask:0xf bank_mask:0xf
  v_add_f32_dpp v149, v149, v149 row_ror:2 row_mask:0xf bank_mask:0xf
  v_add_f32_dpp v150, v150, v150 row_ror:2 row_mask:0xf bank_mask:0xf
  v_add_f32_dpp v151, v151, v151 row_ror:2 row_mask:0xf bank_mask:0xf
  v_add_f32_dpp v144, v144, v144 row_ror:1 row_mask:0xf bank_mask:0xf
  v_add_f32_dpp v145, v145, v145 row_ror:1 row_mask:0xf bank_mask:0xf
  v_add_f32_dpp v146, v146, v146 row_ror:1 row_mask:0xf bank_mask:0xf
  v_add_f32_dpp v147, v147, v147 row_ror:1 row_mask:0xf bank_mask:0xf
  v_add_f32_dpp v148, v148, v148 row_ror:1 row_mask:0xf bank_mask:0xf
  v_add_f32_dpp v149, v149, v149 row_ror:1 row_mask:0xf bank_mask:0xf
  v_add_f32_dpp v150, v150, v150 row_ror:1 row_mask:0xf bank_mask:0xf
  v_add_f32_dpp v151, v151, v151 row_ror:1 row_mask:0xf bank_mask:0xf
  v_mov_b32 v152, v144
  v_mov_b32 v153, v145
  v_mov_b32 v154, v146
  v_mov_b32 v155, v147
  v_mov_b32 v156, v148
  v_mov_b32 v157, v149
  v_mov_b32 v158, v150
  v_mov_b32 v159, v151
  v_permlane32_swap_b32 v144, v152
  v_permlane32_swap_b32 v145, v153
  v_permlane32_swap_b32 v146, v154
  v_permlane32_swap_b32 v147, v155
  v_permlane32_swap_b32 v148, v156
  v_permlane32_swap_b32 v149, v157
  v_permlane32_swap_b32 v150, v158
  v_permlane32_swap_b32 v151, v159
  v_add_f32 v144, v144, v152
  v_add_f32 v145, v145, v153
  v_add_f32 v146, v146, v154
  v_add_f32 v147, v147, v155
  v_add_f32 v148, v148, v156
  v_add_f32 v149, v149, v157
  v_add_f32 v150, v150, v158
  v_add_f32 v151, v151, v159
  v_mov_b32 v152, v144
  v_mov_b32 v153, v145
  v_mov_b32 v154, v146
  v_mov_b32 v155, v147
  v_mov_b32 v156, v148
  v_mov_b32 v157, v149
  v_mov_b32 v158, v150
  v_mov_b32 v159, v151
  v_permlane16_swap_b32 v144, v152
  v_permlane16_swap_b32 v145, v153
  v_permlane16_swap_b32 v146, v154
  v_permlane16_swap_b32 v147, v155
  v_permlane16_swap_b32 v148, v156
  v_permlane16_swap_b32 v149, v157
  v_permlane16_swap_b32 v150, v158
  v_permlane16_swap_b32 v151, v159
  v_add_f32 v144, v144, v152
  v_add_f32 v145, v145, v153
  v_add_f32 v146, v146, v154
  v_add_f32 v147, v147, v155
  v_add_f32 v148, v148, v156
  v_add_f32 v149, v149, v157
  v_add_f32 v150, v150, v158
  v_add_f32 v151, v151, v159
  v_mov_b32 v24, v144
  v_cmp_eq_u32 vcc, 1, v1
  s_nop 1
  v_cndmask_b32 v24, v24, v145, vcc
  v_cmp_eq_u32 vcc, 2, v1
  s_nop 1
  v_cndmask_b32 v24, v24, v146, vcc
  v_cmp_eq_u32 vcc, 3, v1
  s_nop 1
  v_cndmask_b32 v24, v24, v147, vcc
  v_cmp_eq_u32 vcc, 4, v1
  s_nop 1
  v_cndmask_b32 v24, v24, v148, vcc
  v_cmp_eq_u32 vcc, 5, v1
  s_nop 1
  v_cndmask_b32 v24, v24, v149, vcc
  v_cmp_eq_u32 vcc, 6, v1
  s_nop 1
  v_cndmask_b32 v24, v24, v150, vcc
  v_cmp_eq_u32 vcc, 7, v1
  s_nop 1
  v_cndmask_b32 v24, v24, v151, vcc
  v_cvt_pk_bf16_f32 v25, v24, v24
  v_lshlrev_b32 v24, 16, v25
  v_mul_f32 v24, 0xbfb8aa3b, v24
  v_exp_f32 v24, v24
  s_nop 0
  v_add_f32 v24, 1.0, v24
  v_rcp_f32 v24, v24
  s_nop 0
  v_cvt_pk_bf16_f32 v25, v24, v24
  v_lshlrev_b32 v24, 16, v25
  s_lshl_b32 s21, s59, 2
  s_mov_b64 exec, 0xff
  buffer_store_dword v24, v5, s[28:31], s21 offen sc1
  s_mov_b64 exec, -1
  s_sub_u32 s59, s59, 1024
  s_waitcnt vmcnt(1)
  v_lshlrev_b32 v25, 16, v160
  v_and_b32 v26, 0xffff0000, v160
  v_mul_f32 v25, v25, v57
  v_mul_f32 v26, v26, v52
  v_cvt_pk_bf16_f32 v25, v25, v26
  v_lshlrev_b32 v26, 16, v25
  v_and_b32 v25, 0xffff0000, v25
  v_add_f32 v144, v25, v26
  v_lshlrev_b32 v25, 16, v161
  v_and_b32 v26, 0xffff0000, v161
  v_mul_f32 v25, v25, v58
  v_mul_f32 v26, v26, v53
  v_cvt_pk_bf16_f32 v25, v25, v26
  v_lshlrev_b32 v26, 16, v25
  v_and_b32 v25, 0xffff0000, v25
  v_add_f32 v144, v144, v26
  v_add_f32 v144, v144, v25
  v_lshlrev_b32 v25, 16, v162
  v_and_b32 v26, 0xffff0000, v162
  v_mul_f32 v25, v25, v59
  v_mul_f32 v26, v26, v54
  v_cvt_pk_bf16_f32 v25, v25, v26
  v_lshlrev_b32 v26, 16, v25
  v_and_b32 v25, 0xffff0000, v25
  v_add_f32 v144, v144, v26
  v_add_f32 v144, v144, v25
  v_lshlrev_b32 v25, 16, v163
  v_and_b32 v26, 0xffff0000, v163
  v_mul_f32 v25, v25, v60
  v_mul_f32 v26, v26, v55
  v_cvt_pk_bf16_f32 v25, v25, v26
  v_lshlrev_b32 v26, 16, v25
  v_and_b32 v25, 0xffff0000, v25
  v_add_f32 v144, v144, v26
  v_add_f32 v144, v144, v25
  v_lshlrev_b32 v25, 16, v164
  v_and_b32 v26, 0xffff0000, v164
  v_mul_f32 v25, v25, v61
  v_mul_f32 v26, v26, v56
  v_cvt_pk_bf16_f32 v25, v25, v26
  v_lshlrev_b32 v26, 16, v25
  v_and_b32 v25, 0xffff0000, v25
  v_add_f32 v144, v144, v26
  v_add_f32 v144, v144, v25
  v_lshlrev_b32 v25, 16, v166
  v_and_b32 v26, 0xffff0000, v166
  v_mul_f32 v25, v25, v57
  v_mul_f32 v26, v26, v52
  v_cvt_pk_bf16_f32 v25, v25, v26
  v_lshlrev_b32 v26, 16, v25
  v_and_b32 v25, 0xffff0000, v25
  v_add_f32 v145, v25, v26
  v_lshlrev_b32 v25, 16, v167
  v_and_b32 v26, 0xffff0000, v167
  v_mul_f32 v25, v25, v58
  v_mul_f32 v26, v26, v53
  v_cvt_pk_bf16_f32 v25, v25, v26
  v_lshlrev_b32 v26, 16, v25
  v_and_b32 v25, 0xffff0000, v25
  v_add_f32 v145, v145, v26
  v_add_f32 v145, v145, v25
  v_lshlrev_b32 v25, 16, v168
  v_and_b32 v26, 0xffff0000, v168
  v_mul_f32 v25, v25, v59
  v_mul_f32 v26, v26, v54
  v_cvt_pk_bf16_f32 v25, v25, v26
  v_lshlrev_b32 v26, 16, v25
  v_and_b32 v25, 0xffff0000, v25
  v_add_f32 v145, v145, v26
  v_add_f32 v145, v145, v25
  v_lshlrev_b32 v25, 16, v169
  v_and_b32 v26, 0xffff0000, v169
  v_mul_f32 v25, v25, v60
  v_mul_f32 v26, v26, v55
  v_cvt_pk_bf16_f32 v25, v25, v26
  v_lshlrev_b32 v26, 16, v25
  v_and_b32 v25, 0xffff0000, v25
  v_add_f32 v145, v145, v26
  v_add_f32 v145, v145, v25
  v_lshlrev_b32 v25, 16, v170
  v_and_b32 v26, 0xffff0000, v170
  v_mul_f32 v25, v25, v61
  v_mul_f32 v26, v26, v56
  v_cvt_pk_bf16_f32 v25, v25, v26
  v_lshlrev_b32 v26, 16, v25
  v_and_b32 v25, 0xffff0000, v25
  v_add_f32 v145, v145, v26
  v_add_f32 v145, v145, v25
  v_lshlrev_b32 v25, 16, v172
  v_and_b32 v26, 0xffff0000, v172
  v_mul_f32 v25, v25, v57
  v_mul_f32 v26, v26, v52
  v_cvt_pk_bf16_f32 v25, v25, v26
  v_lshlrev_b32 v26, 16, v25
  v_and_b32 v25, 0xffff0000, v25
  v_add_f32 v146, v25, v26
  v_lshlrev_b32 v25, 16, v173
  v_and_b32 v26, 0xffff0000, v173
  v_mul_f32 v25, v25, v58
  v_mul_f32 v26, v26, v53
  v_cvt_pk_bf16_f32 v25, v25, v26
  v_lshlrev_b32 v26, 16, v25
  v_and_b32 v25, 0xffff0000, v25
  v_add_f32 v146, v146, v26
  v_add_f32 v146, v146, v25
  v_lshlrev_b32 v25, 16, v174
  v_and_b32 v26, 0xffff0000, v174
  v_mul_f32 v25, v25, v59
  v_mul_f32 v26, v26, v54
  v_cvt_pk_bf16_f32 v25, v25, v26
  v_lshlrev_b32 v26, 16, v25
  v_and_b32 v25, 0xffff0000, v25
  v_add_f32 v146, v146, v26
  v_add_f32 v146, v146, v25
  v_lshlrev_b32 v25, 16, v175
  v_and_b32 v26, 0xffff0000, v175
  v_mul_f32 v25, v25, v60
  v_mul_f32 v26, v26, v55
  v_cvt_pk_bf16_f32 v25, v25, v26
  v_lshlrev_b32 v26, 16, v25
  v_and_b32 v25, 0xffff0000, v25
  v_add_f32 v146, v146, v26
  v_add_f32 v146, v146, v25
  v_lshlrev_b32 v25, 16, v176
  v_and_b32 v26, 0xffff0000, v176
  v_mul_f32 v25, v25, v61
  v_mul_f32 v26, v26, v56
  v_cvt_pk_bf16_f32 v25, v25, v26
  v_lshlrev_b32 v26, 16, v25
  v_and_b32 v25, 0xffff0000, v25
  v_add_f32 v146, v146, v26
  v_add_f32 v146, v146, v25
  v_lshlrev_b32 v25, 16, v178
  v_and_b32 v26, 0xffff0000, v178
  v_mul_f32 v25, v25, v57
  v_mul_f32 v26, v26, v52
  v_cvt_pk_bf16_f32 v25, v25, v26
  v_lshlrev_b32 v26, 16, v25
  v_and_b32 v25, 0xffff0000, v25
  v_add_f32 v147, v25, v26
  v_lshlrev_b32 v25, 16, v179
  v_and_b32 v26, 0xffff0000, v179
  v_mul_f32 v25, v25, v58
  v_mul_f32 v26, v26, v53
  v_cvt_pk_bf16_f32 v25, v25, v26
  v_lshlrev_b32 v26, 16, v25
  v_and_b32 v25, 0xffff0000, v25
  v_add_f32 v147, v147, v26
  v_add_f32 v147, v147, v25
  v_lshlrev_b32 v25, 16, v180
  v_and_b32 v26, 0xffff0000, v180
  v_mul_f32 v25, v25, v59
  v_mul_f32 v26, v26, v54
  v_cvt_pk_bf16_f32 v25, v25, v26
  v_lshlrev_b32 v26, 16, v25
  v_and_b32 v25, 0xffff0000, v25
  v_add_f32 v147, v147, v26
  v_add_f32 v147, v147, v25
  v_lshlrev_b32 v25, 16, v181
  v_and_b32 v26, 0xffff0000, v181
  v_mul_f32 v25, v25, v60
  v_mul_f32 v26, v26, v55
  v_cvt_pk_bf16_f32 v25, v25, v26
  v_lshlrev_b32 v26, 16, v25
  v_and_b32 v25, 0xffff0000, v25
  v_add_f32 v147, v147, v26
  v_add_f32 v147, v147, v25
  v_lshlrev_b32 v25, 16, v182
  v_and_b32 v26, 0xffff0000, v182
  v_mul_f32 v25, v25, v61
  v_mul_f32 v26, v26, v56
  v_cvt_pk_bf16_f32 v25, v25, v26
  v_lshlrev_b32 v26, 16, v25
  v_and_b32 v25, 0xffff0000, v25
  v_add_f32 v147, v147, v26
  v_add_f32 v147, v147, v25
  v_lshlrev_b32 v25, 16, v184
  v_and_b32 v26, 0xffff0000, v184
  v_mul_f32 v25, v25, v57
  v_mul_f32 v26, v26, v52
  v_cvt_pk_bf16_f32 v25, v25, v26
  v_lshlrev_b32 v26, 16, v25
  v_and_b32 v25, 0xffff0000, v25
  v_add_f32 v148, v25, v26
  v_lshlrev_b32 v25, 16, v185
  v_and_b32 v26, 0xffff0000, v185
  v_mul_f32 v25, v25, v58
  v_mul_f32 v26, v26, v53
  v_cvt_pk_bf16_f32 v25, v25, v26
  v_lshlrev_b32 v26, 16, v25
  v_and_b32 v25, 0xffff0000, v25
  v_add_f32 v148, v148, v26
  v_add_f32 v148, v148, v25
  v_lshlrev_b32 v25, 16, v186
  v_and_b32 v26, 0xffff0000, v186
  v_mul_f32 v25, v25, v59
  v_mul_f32 v26, v26, v54
  v_cvt_pk_bf16_f32 v25, v25, v26
  v_lshlrev_b32 v26, 16, v25
  v_and_b32 v25, 0xffff0000, v25
  v_add_f32 v148, v148, v26
  v_add_f32 v148, v148, v25
  v_lshlrev_b32 v25, 16, v187
  v_and_b32 v26, 0xffff0000, v187
  v_mul_f32 v25, v25, v60
  v_mul_f32 v26, v26, v55
  v_cvt_pk_bf16_f32 v25, v25, v26
  v_lshlrev_b32 v26, 16, v25
  v_and_b32 v25, 0xffff0000, v25
  v_add_f32 v148, v148, v26
  v_add_f32 v148, v148, v25
  v_lshlrev_b32 v25, 16, v188
  v_and_b32 v26, 0xffff0000, v188
  v_mul_f32 v25, v25, v61
  v_mul_f32 v26, v26, v56
  v_cvt_pk_bf16_f32 v25, v25, v26
  v_lshlrev_b32 v26, 16, v25
  v_and_b32 v25, 0xffff0000, v25
  v_add_f32 v148, v148, v26
  v_add_f32 v148, v148, v25
  v_lshlrev_b32 v25, 16, v190
  v_and_b32 v26, 0xffff0000, v190
  v_mul_f32 v25, v25, v57
  v_mul_f32 v26, v26, v52
  v_cvt_pk_bf16_f32 v25, v25, v26
  v_lshlrev_b32 v26, 16, v25
  v_and_b32 v25, 0xffff0000, v25
  v_add_f32 v149, v25, v26
  v_lshlrev_b32 v25, 16, v191
  v_and_b32 v26, 0xffff0000, v191
  v_mul_f32 v25, v25, v58
  v_mul_f32 v26, v26, v53
  v_cvt_pk_bf16_f32 v25, v25, v26
  v_lshlrev_b32 v26, 16, v25
  v_and_b32 v25, 0xffff0000, v25
  v_add_f32 v149, v149, v26
  v_add_f32 v149, v149, v25
  v_lshlrev_b32 v25, 16, v192
  v_and_b32 v26, 0xffff0000, v192
  v_mul_f32 v25, v25, v59
  v_mul_f32 v26, v26, v54
  v_cvt_pk_bf16_f32 v25, v25, v26
  v_lshlrev_b32 v26, 16, v25
  v_and_b32 v25, 0xffff0000, v25
  v_add_f32 v149, v149, v26
  v_add_f32 v149, v149, v25
  v_lshlrev_b32 v25, 16, v193
  v_and_b32 v26, 0xffff0000, v193
  v_mul_f32 v25, v25, v60
  v_mul_f32 v26, v26, v55
  v_cvt_pk_bf16_f32 v25, v25, v26
  v_lshlrev_b32 v26, 16, v25
  v_and_b32 v25, 0xffff0000, v25
  v_add_f32 v149, v149, v26
  v_add_f32 v149, v149, v25
  v_lshlrev_b32 v25, 16, v194
  v_and_b32 v26, 0xffff0000, v194
  v_mul_f32 v25, v25, v61
  v_mul_f32 v26, v26, v56
  v_cvt_pk_bf16_f32 v25, v25, v26
  v_lshlrev_b32 v26, 16, v25
  v_and_b32 v25, 0xffff0000, v25
  v_add_f32 v149, v149, v26
  v_add_f32 v149, v149, v25
  v_lshlrev_b32 v25, 16, v196
  v_and_b32 v26, 0xffff0000, v196
  v_mul_f32 v25, v25, v57
  v_mul_f32 v26, v26, v52
  v_cvt_pk_bf16_f32 v25, v25, v26
  v_lshlrev_b32 v26, 16, v25
  v_and_b32 v25, 0xffff0000, v25
  v_add_f32 v150, v25, v26
  v_lshlrev_b32 v25, 16, v197
  v_and_b32 v26, 0xffff0000, v197
  v_mul_f32 v25, v25, v58
  v_mul_f32 v26, v26, v53
  v_cvt_pk_bf16_f32 v25, v25, v26
  v_lshlrev_b32 v26, 16, v25
  v_and_b32 v25, 0xffff0000, v25
  v_add_f32 v150, v150, v26
  v_add_f32 v150, v150, v25
  v_lshlrev_b32 v25, 16, v198
  v_and_b32 v26, 0xffff0000, v198
  v_mul_f32 v25, v25, v59
  v_mul_f32 v26, v26, v54
  v_cvt_pk_bf16_f32 v25, v25, v26
  v_lshlrev_b32 v26, 16, v25
  v_and_b32 v25, 0xffff0000, v25
  v_add_f32 v150, v150, v26
  v_add_f32 v150, v150, v25
  v_lshlrev_b32 v25, 16, v199
  v_and_b32 v26, 0xffff0000, v199
  v_mul_f32 v25, v25, v60
  v_mul_f32 v26, v26, v55
  v_cvt_pk_bf16_f32 v25, v25, v26
  v_lshlrev_b32 v26, 16, v25
  v_and_b32 v25, 0xffff0000, v25
  v_add_f32 v150, v150, v26
  v_add_f32 v150, v150, v25
  v_lshlrev_b32 v25, 16, v200
  v_and_b32 v26, 0xffff0000, v200
  v_mul_f32 v25, v25, v61
  v_mul_f32 v26, v26, v56
  v_cvt_pk_bf16_f32 v25, v25, v26
  v_lshlrev_b32 v26, 16, v25
  v_and_b32 v25, 0xffff0000, v25
  v_add_f32 v150, v150, v26
  v_add_f32 v150, v150, v25
  v_lshlrev_b32 v25, 16, v202
  v_and_b32 v26, 0xffff0000, v202
  v_mul_f32 v25, v25, v57
  v_mul_f32 v26, v26, v52
  v_cvt_pk_bf16_f32 v25, v25, v26
  v_lshlrev_b32 v26, 16, v25
  v_and_b32 v25, 0xffff0000, v25
  v_add_f32 v151, v25, v26
  v_lshlrev_b32 v25, 16, v203
  v_and_b32 v26, 0xffff0000, v203
  v_mul_f32 v25, v25, v58
  v_mul_f32 v26, v26, v53
  v_cvt_pk_bf16_f32 v25, v25, v26
  v_lshlrev_b32 v26, 16, v25
  v_and_b32 v25, 0xffff0000, v25
  v_add_f32 v151, v151, v26
  v_add_f32 v151, v151, v25
  v_lshlrev_b32 v25, 16, v204
  v_and_b32 v26, 0xffff0000, v204
  v_mul_f32 v25, v25, v59
  v_mul_f32 v26, v26, v54
  v_cvt_pk_bf16_f32 v25, v25, v26
  v_lshlrev_b32 v26, 16, v25
  v_and_b32 v25, 0xffff0000, v25
  v_add_f32 v151, v151, v26
  v_add_f32 v151, v151, v25
  v_lshlrev_b32 v25, 16, v205
  v_and_b32 v26, 0xffff0000, v205
  v_mul_f32 v25, v25, v60
  v_mul_f32 v26, v26, v55
  v_cvt_pk_bf16_f32 v25, v25, v26
  v_lshlrev_b32 v26, 16, v25
  v_and_b32 v25, 0xffff0000, v25
  v_add_f32 v151, v151, v26
  v_add_f32 v151, v151, v25
  v_lshlrev_b32 v25, 16, v206
  v_and_b32 v26, 0xffff0000, v206
  v_mul_f32 v25, v25, v61
  v_mul_f32 v26, v26, v56
  v_cvt_pk_bf16_f32 v25, v25, v26
  v_lshlrev_b32 v26, 16, v25
  v_and_b32 v25, 0xffff0000, v25
  v_add_f32 v151, v151, v26
  v_add_f32 v151, v151, v25
  v_add_f32_dpp v144, v144, v144 row_ror:8 row_mask:0xf bank_mask:0xf
  v_add_f32_dpp v145, v145, v145 row_ror:8 row_mask:0xf bank_mask:0xf
  v_add_f32_dpp v146, v146, v146 row_ror:8 row_mask:0xf bank_mask:0xf
  v_add_f32_dpp v147, v147, v147 row_ror:8 row_mask:0xf bank_mask:0xf
  v_add_f32_dpp v148, v148, v148 row_ror:8 row_mask:0xf bank_mask:0xf
  v_add_f32_dpp v149, v149, v149 row_ror:8 row_mask:0xf bank_mask:0xf
  v_add_f32_dpp v150, v150, v150 row_ror:8 row_mask:0xf bank_mask:0xf
  v_add_f32_dpp v151, v151, v151 row_ror:8 row_mask:0xf bank_mask:0xf
  v_add_f32_dpp v144, v144, v144 row_ror:4 row_mask:0xf bank_mask:0xf
  v_add_f32_dpp v145, v145, v145 row_ror:4 row_mask:0xf bank_mask:0xf
  v_add_f32_dpp v146, v146, v146 row_ror:4 row_mask:0xf bank_mask:0xf
  v_add_f32_dpp v147, v147, v147 row_ror:4 row_mask:0xf bank_mask:0xf
  v_add_f32_dpp v148, v148, v148 row_ror:4 row_mask:0xf bank_mask:0xf
  v_add_f32_dpp v149, v149, v149 row_ror:4 row_mask:0xf bank_mask:0xf
  v_add_f32_dpp v150, v150, v150 row_ror:4 row_mask:0xf bank_mask:0xf
  v_add_f32_dpp v151, v151, v151 row_ror:4 row_mask:0xf bank_mask:0xf
  v_add_f32_dpp v144, v144, v144 row_ror:2 row_mask:0xf bank_mask:0xf
  v_add_f32_dpp v145, v145, v145 row_ror:2 row_mask:0xf bank_mask:0xf
  v_add_f32_dpp v146, v146, v146 row_ror:2 row_mask:0xf bank_mask:0xf
  v_add_f32_dpp v147, v147, v147 row_ror:2 row_mask:0xf bank_mask:0xf
  v_add_f32_dpp v148, v148, v148 row_ror:2 row_mask:0xf bank_mask:0xf
  v_add_f32_dpp v149, v149, v149 row_ror:2 row_mask:0xf bank_mask:0xf
  v_add_f32_dpp v150, v150, v150 row_ror:2 row_mask:0xf bank_mask:0xf
  v_add_f32_dpp v151, v151, v151 row_ror:2 row_mask:0xf bank_mask:0xf
  v_add_f32_dpp v144, v144, v144 row_ror:1 row_mask:0xf bank_mask:0xf
  v_add_f32_dpp v145, v145, v145 row_ror:1 row_mask:0xf bank_mask:0xf
  v_add_f32_dpp v146, v146, v146 row_ror:1 row_mask:0xf bank_mask:0xf
  v_add_f32_dpp v147, v147, v147 row_ror:1 row_mask:0xf bank_mask:0xf
  v_add_f32_dpp v148, v148, v148 row_ror:1 row_mask:0xf bank_mask:0xf
  v_add_f32_dpp v149, v149, v149 row_ror:1 row_mask:0xf bank_mask:0xf
  v_add_f32_dpp v150, v150, v150 row_ror:1 row_mask:0xf bank_mask:0xf
  v_add_f32_dpp v151, v151, v151 row_ror:1 row_mask:0xf bank_mask:0xf
  v_mov_b32 v152, v144
  v_mov_b32 v153, v145
  v_mov_b32 v154, v146
  v_mov_b32 v155, v147
  v_mov_b32 v156, v148
  v_mov_b32 v157, v149
  v_mov_b32 v158, v150
  v_mov_b32 v159, v151
  v_permlane32_swap_b32 v144, v152
  v_permlane32_swap_b32 v145, v153
  v_permlane32_swap_b32 v146, v154
  v_permlane32_swap_b32 v147, v155
  v_permlane32_swap_b32 v148, v156
  v_permlane32_swap_b32 v149, v157
  v_permlane32_swap_b32 v150, v158
  v_permlane32_swap_b32 v151, v159
  v_add_f32 v144, v144, v152
  v_add_f32 v145, v145, v153
  v_add_f32 v146, v146, v154
  v_add_f32 v147, v147, v155
  v_add_f32 v148, v148, v156
  v_add_f32 v149, v149, v157
  v_add_f32 v150, v150, v158
  v_add_f32 v151, v151, v159
  v_mov_b32 v152, v144
  v_mov_b32 v153, v145
  v_mov_b32 v154, v146
  v_mov_b32 v155, v147
  v_mov_b32 v156, v148
  v_mov_b32 v157, v149
  v_mov_b32 v158, v150
  v_mov_b32 v159, v151
  v_permlane16_swap_b32 v144, v152
  v_permlane16_swap_b32 v145, v153
  v_permlane16_swap_b32 v146, v154
  v_permlane16_swap_b32 v147, v155
  v_permlane16_swap_b32 v148, v156
  v_permlane16_swap_b32 v149, v157
  v_permlane16_swap_b32 v150, v158
  v_permlane16_swap_b32 v151, v159
  v_add_f32 v144, v144, v152
  v_add_f32 v145, v145, v153
  v_add_f32 v146, v146, v154
  v_add_f32 v147, v147, v155
  v_add_f32 v148, v148, v156
  v_add_f32 v149, v149, v157
  v_add_f32 v150, v150, v158
  v_add_f32 v151, v151, v159
  v_mov_b32 v24, v144
  v_cmp_eq_u32 vcc, 1, v1
  s_nop 1
  v_cndmask_b32 v24, v24, v145, vcc
  v_cmp_eq_u32 vcc, 2, v1
  s_nop 1
  v_cndmask_b32 v24, v24, v146, vcc
  v_cmp_eq_u32 vcc, 3, v1
  s_nop 1
  v_cndmask_b32 v24, v24, v147, vcc
  v_cmp_eq_u32 vcc, 4, v1
  s_nop 1
  v_cndmask_b32 v24, v24, v148, vcc
  v_cmp_eq_u32 vcc, 5, v1
  s_nop 1
  v_cndmask_b32 v24, v24, v149, vcc
  v_cmp_eq_u32 vcc, 6, v1
  s_nop 1
  v_cndmask_b32 v24, v24, v150, vcc
  v_cmp_eq_u32 vcc, 7, v1
  s_nop 1
  v_cndmask_b32 v24, v24, v151, vcc
  v_cvt_pk_bf16_f32 v25, v24, v24
  v_lshlrev_b32 v24, 16, v25
  v_mul_f32 v24, 0xbfb8aa3b, v24
  v_exp_f32 v24, v24
  s_nop 0
  v_add_f32 v24, 1.0, v24
  v_rcp_f32 v24, v24
  s_nop 0
  v_cvt_pk_bf16_f32 v25, v24, v24
  v_lshlrev_b32 v24, 16, v25
  s_lshl_b32 s21, s59, 2
  s_mov_b64 exec, 0xff
  buffer_store_dword v24, v5, s[28:31], s21 offen sc1
  s_mov_b64 exec, -1
  s_waitcnt vmcnt(0)
  s_barrier
  s_lshr_b32 s21, s2, 2
  s_lshl_b32 s21, s21, 7
  s_add_u32 s21, s21, 93184
  s_cmp_lg_u32 s20, 0
  s_cbranch_scc1 af_243
  v_mov_b32 v10, 0
  v_mov_b32 v11, 1
  s_mov_b64 exec, 1
  buffer_atomic_add v11, v10, s[72:75], s21 offen sc1
  s_mov_b64 exec, -1
  s_nop 1
af_243:
  s_branch om_242
om_241:
  s_load_dwordx2 s[8:9], s[0:1], 88
  s_mov_b32 s51, s21
  s_lshr_b32 s52, s2, 2
  s_lshl_b32 s52, s52, 7
  s_add_u32 s21, s52, 94208
  s_cmp_lg_u32 s20, 0
  s_cbranch_scc1 wf_245
  v_mov_b32 v20, 0
  s_mov_b32 s101, 0
wf_244:
  buffer_load_dword v21, v20, s[72:75], s21 offen sc1
  s_add_u32 s101, s101, 1
  s_cmp_gt_u32 s101, 131072
  s_cbranch_scc1 main_end
  s_waitcnt vmcnt(0)
  v_readfirstlane_b32 s100, v21
  s_cmp_ge_u32 s100, 4
  s_cbranch_scc1 wf_245
  s_sleep 32
  s_branch wf_244
wf_245:
  s_barrier
  s_add_u32 s21, s52, 104448
  s_cmp_lg_u32 s20, 0
  s_cbranch_scc1 wf_247
  v_mov_b32 v20, 0
  s_mov_b32 s101, 0
wf_246:
  buffer_load_dword v21, v20, s[72:75], s21 offen sc1
  s_add_u32 s101, s101, 1
  s_cmp_gt_u32 s101, 131072
  s_cbranch_scc1 main_end
  s_waitcnt vmcnt(0)
  v_readfirstlane_b32 s100, v21
  s_cmp_ge_u32 s100, 80
  s_cbranch_scc1 wf_247
  s_sleep 32
  s_branch wf_246
wf_247:
  s_barrier
  v_lshlrev_b32 v6, 2, v2
  s_lshl_b32 s22, s47, 6
  buffer_load_dword v30, v6, s[28:31], s22 offen sc1
  buffer_load_dword v31, v6, s[28:31], s22 offen offset:64 sc1
  s_add_u32 s22, s51, 0
  buffer_load_dwordx4 v[144:147], v4, s[16:19], s22 offen offset:0 sc1
  buffer_load_dwordx4 v[148:151], v4, s[16:19], s22 offen offset:1024 sc1
  buffer_load_dwordx4 v[152:155], v4, s[16:19], s22 offen offset:2048 sc1
  buffer_load_dwordx4 v[156:159], v4, s[16:19], s22 offen offset:3072 sc1
  s_add_u32 s22, s51, 4096
  buffer_load_dwordx4 v[160:163], v4, s[16:19], s22 offen offset:0 sc1
  buffer_load_dwordx4 v[164:167], v4, s[16:19], s22 offen offset:1024 sc1
  buffer_load_dwordx4 v[168:171], v4, s[16:19], s22 offen offset:2048 sc1
  buffer_load_dwordx4 v[172:175], v4, s[16:19], s22 offen offset:3072 sc1
  s_add_u32 s22, s51, 8192
  buffer_load_dwordx4 v[176:179], v4, s[16:19], s22 offen offset:0 sc1
  buffer_load_dwordx4 v[180:183], v4, s[16:19], s22 offen offset:1024 sc1
  s_add_u32 s22, s51, 40960
  buffer_load_dwordx4 v[184:187], v4, s[16:19], s22 offen offset:0 sc1
  buffer_load_dwordx4 v[188:191], v4, s[16:19], s22 offen offset:1024 sc1
  buffer_load_dwordx4 v[192:195], v4, s[16:19], s22 offen offset:2048 sc1
  buffer_load_dwordx4 v[196:199], v4, s[16:19], s22 offen offset:3072 sc1
  s_add_u32 s22, s51, 45056
  buffer_load_dwordx4 v[200:203], v4, s[16:19], s22 offen offset:0 sc1
  buffer_load_dwordx4 v[204:207], v4, s[16:19], s22 offen offset:1024 sc1
  buffer_load_dwordx4 v[208:211], v4, s[16:19], s22 offen offset:2048 sc1
  buffer_load_dwordx4 v[212:215], v4, s[16:19], s22 offen offset:3072 sc1
  s_add_u32 s22, s51, 49152
  buffer_load_dwordx4 v[216:219], v4, s[16:19], s22 offen offset:0 sc1
  buffer_load_dwordx4 v[220:223], v4, s[16:19], s22 offen offset:1024 sc1
  v_mul_u32_u24 v9, 1280, v2
  v_lshl_add_u32 v9, v3, 3, v9
  s_mul_i32 s22, s47, 20480
  s_add_u32 s22, s22, s45
  s_add_u32 s23, s22, 20480
  s_waitcnt vmcnt(20) lgkmcnt(0)
  v_sub_f32 v32, 1.0, v30
  v_sub_f32 v33, 1.0, v31
  v_cvt_pk_bf16_f32 v26, v32, v33
  v_lshlrev_b32 v32, 16, v26
  v_and_b32 v33, 0xffff0000, v26
  v_cvt_pk_bf16_f32 v26, v64, v65
  v_lshlrev_b32 v64, 16, v26
  v_and_b32 v65, 0xffff0000, v26
  v_mul_f32 v64, v64, v32
  v_mul_f32 v65, v65, v32
  v_cvt_pk_bf16_f32 v26, v64, v65
  v_lshlrev_b32 v64, 16, v26
  v_and_b32 v65, 0xffff0000, v26
  v_cvt_pk_bf16_f32 v26, v66, v67
  v_lshlrev_b32 v66, 16, v26
  v_and_b32 v67, 0xffff0000, v26
  v_mul_f32 v66, v66, v32
  v_mul_f32 v67, v67, v32
  v_cvt_pk_bf16_f32 v26, v66, v67
  v_lshlrev_b32 v66, 16, v26
  v_and_b32 v67, 0xffff0000, v26
  v_cvt_pk_bf16_f32 v26, v68, v69
  v_lshlrev_b32 v68, 16, v26
  v_and_b32 v69, 0xffff0000, v26
  v_mul_f32 v68, v68, v32
  v_mul_f32 v69, v69, v32
  v_cvt_pk_bf16_f32 v26, v68, v69
  v_lshlrev_b32 v68, 16, v26
  v_and_b32 v69, 0xffff0000, v26
  v_cvt_pk_bf16_f32 v26, v70, v71
  v_lshlrev_b32 v70, 16, v26
  v_and_b32 v71, 0xffff0000, v26
  v_mul_f32 v70, v70, v32
  v_mul_f32 v71, v71, v32
  v_cvt_pk_bf16_f32 v26, v70, v71
  v_lshlrev_b32 v70, 16, v26
  v_and_b32 v71, 0xffff0000, v26
  v_cvt_pk_bf16_f32 v26, v72, v73
  v_lshlrev_b32 v72, 16, v26
  v_and_b32 v73, 0xffff0000, v26
  v_mul_f32 v72, v72, v32
  v_mul_f32 v73, v73, v32
  v_cvt_pk_bf16_f32 v26, v72, v73
  v_lshlrev_b32 v72, 16, v26
  v_and_b32 v73, 0xffff0000, v26
  v_cvt_pk_bf16_f32 v26, v74, v75
  v_lshlrev_b32 v74, 16, v26
  v_and_b32 v75, 0xffff0000, v26
  v_mul_f32 v74, v74, v32
  v_mul_f32 v75, v75, v32
  v_cvt_pk_bf16_f32 v26, v74, v75
  v_lshlrev_b32 v74, 16, v26
  v_and_b32 v75, 0xffff0000, v26
  v_cvt_pk_bf16_f32 v26, v76, v77
  v_lshlrev_b32 v76, 16, v26
  v_and_b32 v77, 0xffff0000, v26
  v_mul_f32 v76, v76, v32
  v_mul_f32 v77, v77, v32
  v_cvt_pk_bf16_f32 v26, v76, v77
  v_lshlrev_b32 v76, 16, v26
  v_and_b32 v77, 0xffff0000, v26
  v_cvt_pk_bf16_f32 v26, v78, v79
  v_lshlrev_b32 v78, 16, v26
  v_and_b32 v79, 0xffff0000, v26
  v_mul_f32 v78, v78, v32
  v_mul_f32 v79, v79, v32
  v_cvt_pk_bf16_f32 v26, v78, v79
  v_lshlrev_b32 v78, 16, v26
  v_and_b32 v79, 0xffff0000, v26
  v_cvt_pk_bf16_f32 v26, v80, v81
  v_lshlrev_b32 v80, 16, v26
  v_and_b32 v81, 0xffff0000, v26
  v_mul_f32 v80, v80, v32
  v_mul_f32 v81, v81, v32
  v_cvt_pk_bf16_f32 v26, v80, v81
  v_lshlrev_b32 v80, 16, v26
  v_and_b32 v81, 0xffff0000, v26
  v_cvt_pk_bf16_f32 v26, v82, v83
  v_lshlrev_b32 v82, 16, v26
  v_and_b32 v83, 0xffff0000, v26
  v_mul_f32 v82, v82, v32
  v_mul_f32 v83, v83, v32
  v_cvt_pk_bf16_f32 v26, v82, v83
  v_lshlrev_b32 v82, 16, v26
  v_and_b32 v83, 0xffff0000, v26
  v_cvt_pk_bf16_f32 v26, v84, v85
  v_lshlrev_b32 v84, 16, v26
  v_and_b32 v85, 0xffff0000, v26
  v_mul_f32 v84, v84, v32
  v_mul_f32 v85, v85, v32
  v_cvt_pk_bf16_f32 v26, v84, v85
  v_lshlrev_b32 v84, 16, v26
  v_and_b32 v85, 0xffff0000, v26
  v_cvt_pk_bf16_f32 v26, v86, v87
  v_lshlrev_b32 v86, 16, v26
  v_and_b32 v87, 0xffff0000, v26
  v_mul_f32 v86, v86, v32
  v_mul_f32 v87, v87, v32
  v_cvt_pk_bf16_f32 v26, v86, v87
  v_lshlrev_b32 v86, 16, v26
  v_and_b32 v87, 0xffff0000, v26
  v_cvt_pk_bf16_f32 v26, v88, v89
  v_lshlrev_b32 v88, 16, v26
  v_and_b32 v89, 0xffff0000, v26
  v_mul_f32 v88, v88, v32
  v_mul_f32 v89, v89, v32
  v_cvt_pk_bf16_f32 v26, v88, v89
  v_lshlrev_b32 v88, 16, v26
  v_and_b32 v89, 0xffff0000, v26
  v_cvt_pk_bf16_f32 v26, v90, v91
  v_lshlrev_b32 v90, 16, v26
  v_and_b32 v91, 0xffff0000, v26
  v_mul_f32 v90, v90, v32
  v_mul_f32 v91, v91, v32
  v_cvt_pk_bf16_f32 v26, v90, v91
  v_lshlrev_b32 v90, 16, v26
  v_and_b32 v91, 0xffff0000, v26
  v_cvt_pk_bf16_f32 v26, v92, v93
  v_lshlrev_b32 v92, 16, v26
  v_and_b32 v93, 0xffff0000, v26
  v_mul_f32 v92, v92, v32
  v_mul_f32 v93, v93, v32
  v_cvt_pk_bf16_f32 v26, v92, v93
  v_lshlrev_b32 v92, 16, v26
  v_and_b32 v93, 0xffff0000, v26
  v_cvt_pk_bf16_f32 v26, v94, v95
  v_lshlrev_b32 v94, 16, v26
  v_and_b32 v95, 0xffff0000, v26
  v_mul_f32 v94, v94, v32
  v_mul_f32 v95, v95, v32
  v_cvt_pk_bf16_f32 v26, v94, v95
  v_lshlrev_b32 v94, 16, v26
  v_and_b32 v95, 0xffff0000, v26
  v_cvt_pk_bf16_f32 v26, v96, v97
  v_lshlrev_b32 v96, 16, v26
  v_and_b32 v97, 0xffff0000, v26
  v_mul_f32 v96, v96, v32
  v_mul_f32 v97, v97, v32
  v_cvt_pk_bf16_f32 v26, v96, v97
  v_lshlrev_b32 v96, 16, v26
  v_and_b32 v97, 0xffff0000, v26
  v_cvt_pk_bf16_f32 v26, v98, v99
  v_lshlrev_b32 v98, 16, v26
  v_and_b32 v99, 0xffff0000, v26
  v_mul_f32 v98, v98, v32
  v_mul_f32 v99, v99, v32
  v_cvt_pk_bf16_f32 v26, v98, v99
  v_lshlrev_b32 v98, 16, v26
  v_and_b32 v99, 0xffff0000, v26
  v_cvt_pk_bf16_f32 v26, v100, v101
  v_lshlrev_b32 v100, 16, v26
  v_and_b32 v101, 0xffff0000, v26
  v_mul_f32 v100, v100, v32
  v_mul_f32 v101, v101, v32
  v_cvt_pk_bf16_f32 v26, v100, v101
  v_lshlrev_b32 v100, 16, v26
  v_and_b32 v101, 0xffff0000, v26
  v_cvt_pk_bf16_f32 v26, v102, v103
  v_lshlrev_b32 v102, 16, v26
  v_and_b32 v103, 0xffff0000, v26
  v_mul_f32 v102, v102, v32
  v_mul_f32 v103, v103, v32
  v_cvt_pk_bf16_f32 v26, v102, v103
  v_lshlrev_b32 v102, 16, v26
  v_and_b32 v103, 0xffff0000, v26
  v_cvt_pk_bf16_f32 v26, v104, v105
  v_lshlrev_b32 v104, 16, v26
  v_and_b32 v105, 0xffff0000, v26
  v_mul_f32 v104, v104, v33
  v_mul_f32 v105, v105, v33
  v_cvt_pk_bf16_f32 v26, v104, v105
  v_lshlrev_b32 v104, 16, v26
  v_and_b32 v105, 0xffff0000, v26
  v_cvt_pk_bf16_f32 v26, v106, v107
  v_lshlrev_b32 v106, 16, v26
  v_and_b32 v107, 0xffff0000, v26
  v_mul_f32 v106, v106, v33
  v_mul_f32 v107, v107, v33
  v_cvt_pk_bf16_f32 v26, v106, v107
  v_lshlrev_b32 v106, 16, v26
  v_and_b32 v107, 0xffff0000, v26
  v_cvt_pk_bf16_f32 v26, v108, v109
  v_lshlrev_b32 v108, 16, v26
  v_and_b32 v109, 0xffff0000, v26
  v_mul_f32 v108, v108, v33
  v_mul_f32 v109, v109, v33
  v_cvt_pk_bf16_f32 v26, v108, v109
  v_lshlrev_b32 v108, 16, v26
  v_and_b32 v109, 0xffff0000, v26
  v_cvt_pk_bf16_f32 v26, v110, v111
  v_lshlrev_b32 v110, 16, v26
  v_and_b32 v111, 0xffff0000, v26
  v_mul_f32 v110, v110, v33
  v_mul_f32 v111, v111, v33
  v_cvt_pk_bf16_f32 v26, v110, v111
  v_lshlrev_b32 v110, 16, v26
  v_and_b32 v111, 0xffff0000, v26
  v_cvt_pk_bf16_f32 v26, v112, v113
  v_lshlrev_b32 v112, 16, v26
  v_and_b32 v113, 0xffff0000, v26
  v_mul_f32 v112, v112, v33
  v_mul_f32 v113, v113, v33
  v_cvt_pk_bf16_f32 v26, v112, v113
  v_lshlrev_b32 v112, 16, v26
  v_and_b32 v113, 0xffff0000, v26
  v_cvt_pk_bf16_f32 v26, v114, v115
  v_lshlrev_b32 v114, 16, v26
  v_and_b32 v115, 0xffff0000, v26
  v_mul_f32 v114, v114, v33
  v_mul_f32 v115, v115, v33
  v_cvt_pk_bf16_f32 v26, v114, v115
  v_lshlrev_b32 v114, 16, v26
  v_and_b32 v115, 0xffff0000, v26
  v_cvt_pk_bf16_f32 v26, v116, v117
  v_lshlrev_b32 v116, 16, v26
  v_and_b32 v117, 0xffff0000, v26
  v_mul_f32 v116, v116, v33
  v_mul_f32 v117, v117, v33
  v_cvt_pk_bf16_f32 v26, v116, v117
  v_lshlrev_b32 v116, 16, v26
  v_and_b32 v117, 0xffff0000, v26
  v_cvt_pk_bf16_f32 v26, v118, v119
  v_lshlrev_b32 v118, 16, v26
  v_and_b32 v119, 0xffff0000, v26
  v_mul_f32 v118, v118, v33
  v_mul_f32 v119, v119, v33
  v_cvt_pk_bf16_f32 v26, v118, v119
  v_lshlrev_b32 v118, 16, v26
  v_and_b32 v119, 0xffff0000, v26
  v_cvt_pk_bf16_f32 v26, v120, v121
  v_lshlrev_b32 v120, 16, v26
  v_and_b32 v121, 0xffff0000, v26
  v_mul_f32 v120, v120, v33
  v_mul_f32 v121, v121, v33
  v_cvt_pk_bf16_f32 v26, v120, v121
  v_lshlrev_b32 v120, 16, v26
  v_and_b32 v121, 0xffff0000, v26
  v_cvt_pk_bf16_f32 v26, v122, v123
  v_lshlrev_b32 v122, 16, v26
  v_and_b32 v123, 0xffff0000, v26
  v_mul_f32 v122, v122, v33
  v_mul_f32 v123, v123, v33
  v_cvt_pk_bf16_f32 v26, v122, v123
  v_lshlrev_b32 v122, 16, v26
  v_and_b32 v123, 0xffff0000, v26
  v_cvt_pk_bf16_f32 v26, v124, v125
  v_lshlrev_b32 v124, 16, v26
  v_and_b32 v125, 0xffff0000, v26
  v_mul_f32 v124, v124, v33
  v_mul_f32 v125, v125, v33
  v_cvt_pk_bf16_f32 v26, v124, v125
  v_lshlrev_b32 v124, 16, v26
  v_and_b32 v125, 0xffff0000, v26
  v_cvt_pk_bf16_f32 v26, v126, v127
  v_lshlrev_b32 v126, 16, v26
  v_and_b32 v127, 0xffff0000, v26
  v_mul_f32 v126, v126, v33
  v_mul_f32 v127, v127, v33
  v_cvt_pk_bf16_f32 v26, v126, v127
  v_lshlrev_b32 v126, 16, v26
  v_and_b32 v127, 0xffff0000, v26
  v_cvt_pk_bf16_f32 v26, v128, v129
  v_lshlrev_b32 v128, 16, v26
  v_and_b32 v129, 0xffff0000, v26
  v_mul_f32 v128, v128, v33
  v_mul_f32 v129, v129, v33
  v_cvt_pk_bf16_f32 v26, v128, v129
  v_lshlrev_b32 v128, 16, v26
  v_and_b32 v129, 0xffff0000, v26
  v_cvt_pk_bf16_f32 v26, v130, v131
  v_lshlrev_b32 v130, 16, v26
  v_and_b32 v131, 0xffff0000, v26
  v_mul_f32 v130, v130, v33
  v_mul_f32 v131, v131, v33
  v_cvt_pk_bf16_f32 v26, v130, v131
  v_lshlrev_b32 v130, 16, v26
  v_and_b32 v131, 0xffff0000, v26
  v_cvt_pk_bf16_f32 v26, v132, v133
  v_lshlrev_b32 v132, 16, v26
  v_and_b32 v133, 0xffff0000, v26
  v_mul_f32 v132, v132, v33
  v_mul_f32 v133, v133, v33
  v_cvt_pk_bf16_f32 v26, v132, v133
  v_lshlrev_b32 v132, 16, v26
  v_and_b32 v133, 0xffff0000, v26
  v_cvt_pk_bf16_f32 v26, v134, v135
  v_lshlrev_b32 v134, 16, v26
  v_and_b32 v135, 0xffff0000, v26
  v_mul_f32 v134, v134, v33
  v_mul_f32 v135, v135, v33
  v_cvt_pk_bf16_f32 v26, v134, v135
  v_lshlrev_b32 v134, 16, v26
  v_and_b32 v135, 0xffff0000, v26
  v_cvt_pk_bf16_f32 v26, v136, v137
  v_lshlrev_b32 v136, 16, v26
  v_and_b32 v137, 0xffff0000, v26
  v_mul_f32 v136, v136, v33
  v_mul_f32 v137, v137, v33
  v_cvt_pk_bf16_f32 v26, v136, v137
  v_lshlrev_b32 v136, 16, v26
  v_and_b32 v137, 0xffff0000, v26
  v_cvt_pk_bf16_f32 v26, v138, v139
  v_lshlrev_b32 v138, 16, v26
  v_and_b32 v139, 0xffff0000, v26
  v_mul_f32 v138, v138, v33
  v_mul_f32 v139, v139, v33
  v_cvt_pk_bf16_f32 v26, v138, v139
  v_lshlrev_b32 v138, 16, v26
  v_and_b32 v139, 0xffff0000, v26
  v_cvt_pk_bf16_f32 v26, v140, v141
  v_lshlrev_b32 v140, 16, v26
  v_and_b32 v141, 0xffff0000, v26
  v_mul_f32 v140, v140, v33
  v_mul_f32 v141, v141, v33
  v_cvt_pk_bf16_f32 v26, v140, v141
  v_lshlrev_b32 v140, 16, v26
  v_and_b32 v141, 0xffff0000, v26
  v_cvt_pk_bf16_f32 v26, v142, v143
  v_lshlrev_b32 v142, 16, v26
  v_and_b32 v143, 0xffff0000, v26
  v_mul_f32 v142, v142, v33
  v_mul_f32 v143, v143, v33
  v_cvt_pk_bf16_f32 v26, v142, v143
  v_lshlrev_b32 v142, 16, v26
  v_and_b32 v143, 0xffff0000, v26
  s_waitcnt vmcnt(19)
  v_cvt_pk_bf16_f32 v26, v144, v145
  v_lshlrev_b32 v144, 16, v26
  v_and_b32 v145, 0xffff0000, v26
  v_mul_f32 v144, v144, v30
  v_mul_f32 v145, v145, v30
  v_cvt_pk_bf16_f32 v26, v144, v145
  v_lshlrev_b32 v144, 16, v26
  v_and_b32 v145, 0xffff0000, v26
  v_add_f32 v144, v144, v64
  v_add_f32 v145, v145, v65
  v_cvt_pk_bf16_f32 v64, v144, v145
  v_cvt_pk_bf16_f32 v26, v146, v147
  v_lshlrev_b32 v146, 16, v26
  v_and_b32 v147, 0xffff0000, v26
  v_mul_f32 v146, v146, v30
  v_mul_f32 v147, v147, v30
  v_cvt_pk_bf16_f32 v26, v146, v147
  v_lshlrev_b32 v146, 16, v26
  v_and_b32 v147, 0xffff0000, v26
  v_add_f32 v146, v146, v66
  v_add_f32 v147, v147, v67
  v_cvt_pk_bf16_f32 v65, v146, v147
  buffer_store_dwordx2 v[64:65], v9, s[8:11], s22 offen offset:0
  s_waitcnt vmcnt(19)
  v_cvt_pk_bf16_f32 v26, v148, v149
  v_lshlrev_b32 v148, 16, v26
  v_and_b32 v149, 0xffff0000, v26
  v_mul_f32 v148, v148, v30
  v_mul_f32 v149, v149, v30
  v_cvt_pk_bf16_f32 v26, v148, v149
  v_lshlrev_b32 v148, 16, v26
  v_and_b32 v149, 0xffff0000, v26
  v_add_f32 v148, v148, v68
  v_add_f32 v149, v149, v69
  v_cvt_pk_bf16_f32 v68, v148, v149
  v_cvt_pk_bf16_f32 v26, v150, v151
  v_lshlrev_b32 v150, 16, v26
  v_and_b32 v151, 0xffff0000, v26
  v_mul_f32 v150, v150, v30
  v_mul_f32 v151, v151, v30
  v_cvt_pk_bf16_f32 v26, v150, v151
  v_lshlrev_b32 v150, 16, v26
  v_and_b32 v151, 0xffff0000, v26
  v_add_f32 v150, v150, v70
  v_add_f32 v151, v151, v71
  v_cvt_pk_bf16_f32 v69, v150, v151
  buffer_store_dwordx2 v[68:69], v9, s[8:11], s22 offen offset:32
  s_waitcnt vmcnt(19)
  v_cvt_pk_bf16_f32 v26, v152, v153
  v_lshlrev_b32 v152, 16, v26
  v_and_b32 v153, 0xffff0000, v26
  v_mul_f32 v152, v152, v30
  v_mul_f32 v153, v153, v30
  v_cvt_pk_bf16_f32 v26, v152, v153
  v_lshlrev_b32 v152, 16, v26
  v_and_b32 v153, 0xffff0000, v26
  v_add_f32 v152, v152, v72
  v_add_f32 v153, v153, v73
  v_cvt_pk_bf16_f32 v72, v152, v153
  v_cvt_pk_bf16_f32 v26, v154, v155
  v_lshlrev_b32 v154, 16, v26
  v_and_b32 v155, 0xffff0000, v26
  v_mul_f32 v154, v154, v30
  v_mul_f32 v155, v155, v30
  v_cvt_pk_bf16_f32 v26, v154, v155
  v_lshlrev_b32 v154, 16, v26
  v_and_b32 v155, 0xffff0000, v26
  v_add_f32 v154, v154, v74
  v_add_f32 v155, v155, v75
  v_cvt_pk_bf16_f32 v73, v154, v155
  buffer_store_dwordx2 v[72:73], v9, s[8:11], s22 offen offset:64
  s_waitcnt vmcnt(19)
  v_cvt_pk_bf16_f32 v26, v156, v157
  v_lshlrev_b32 v156, 16, v26
  v_and_b32 v157, 0xffff0000, v26
  v_mul_f32 v156, v156, v30
  v_mul_f32 v157, v157, v30
  v_cvt_pk_bf16_f32 v26, v156, v157
  v_lshlrev_b32 v156, 16, v26
  v_and_b32 v157, 0xffff0000, v26
  v_add_f32 v156, v156, v76
  v_add_f32 v157, v157, v77
  v_cvt_pk_bf16_f32 v76, v156, v157
  v_cvt_pk_bf16_f32 v26, v158, v159
  v_lshlrev_b32 v158, 16, v26
  v_and_b32 v159, 0xffff0000, v26
  v_mul_f32 v158, v158, v30
  v_mul_f32 v159, v159, v30
  v_cvt_pk_bf16_f32 v26, v158, v159
  v_lshlrev_b32 v158, 16, v26
  v_and_b32 v159, 0xffff0000, v26
  v_add_f32 v158, v158, v78
  v_add_f32 v159, v159, v79
  v_cvt_pk_bf16_f32 v77, v158, v159
  buffer_store_dwordx2 v[76:77], v9, s[8:11], s22 offen offset:96
  s_waitcnt vmcnt(19)
  v_cvt_pk_bf16_f32 v26, v160, v161
  v_lshlrev_b32 v160, 16, v26
  v_and_b32 v161, 0xffff0000, v26
  v_mul_f32 v160, v160, v30
  v_mul_f32 v161, v161, v30
  v_cvt_pk_bf16_f32 v26, v160, v161
  v_lshlrev_b32 v160, 16, v26
  v_and_b32 v161, 0xffff0000, v26
  v_add_f32 v160, v160, v80
  v_add_f32 v161, v161, v81
  v_cvt_pk_bf16_f32 v80, v160, v161
  v_cvt_pk_bf16_f32 v26, v162, v163
  v_lshlrev_b32 v162, 16, v26
  v_and_b32 v163, 0xffff0000, v26
  v_mul_f32 v162, v162, v30
  v_mul_f32 v163, v163, v30
  v_cvt_pk_bf16_f32 v26, v162, v163
  v_lshlrev_b32 v162, 16, v26
  v_and_b32 v163, 0xffff0000, v26
  v_add_f32 v162, v162, v82
  v_add_f32 v163, v163, v83
  v_cvt_pk_bf16_f32 v81, v162, v163
  buffer_store_dwordx2 v[80:81], v9, s[8:11], s22 offen offset:128
  s_waitcnt vmcnt(19)
  v_cvt_pk_bf16_f32 v26, v164, v165
  v_lshlrev_b32 v164, 16, v26
  v_and_b32 v165, 0xffff0000, v26
  v_mul_f32 v164, v164, v30
  v_mul_f32 v165, v165, v30
  v_cvt_pk_bf16_f32 v26, v164, v165
  v_lshlrev_b32 v164, 16, v26
  v_and_b32 v165, 0xffff0000, v26
  v_add_f32 v164, v164, v84
  v_add_f32 v165, v165, v85
  v_cvt_pk_bf16_f32 v84, v164, v165
  v_cvt_pk_bf16_f32 v26, v166, v167
  v_lshlrev_b32 v166, 16, v26
  v_and_b32 v167, 0xffff0000, v26
  v_mul_f32 v166, v166, v30
  v_mul_f32 v167, v167, v30
  v_cvt_pk_bf16_f32 v26, v166, v167
  v_lshlrev_b32 v166, 16, v26
  v_and_b32 v167, 0xffff0000, v26
  v_add_f32 v166, v166, v86
  v_add_f32 v167, v167, v87
  v_cvt_pk_bf16_f32 v85, v166, v167
  buffer_store_dwordx2 v[84:85], v9, s[8:11], s22 offen offset:160
  s_waitcnt vmcnt(19)
  v_cvt_pk_bf16_f32 v26, v168, v169
  v_lshlrev_b32 v168, 16, v26
  v_and_b32 v169, 0xffff0000, v26
  v_mul_f32 v168, v168, v30
  v_mul_f32 v169, v169, v30
  v_cvt_pk_bf16_f32 v26, v168, v169
  v_lshlrev_b32 v168, 16, v26
  v_and_b32 v169, 0xffff0000, v26
  v_add_f32 v168, v168, v88
  v_add_f32 v169, v169, v89
  v_cvt_pk_bf16_f32 v88, v168, v169
  v_cvt_pk_bf16_f32 v26, v170, v171
  v_lshlrev_b32 v170, 16, v26
  v_and_b32 v171, 0xffff0000, v26
  v_mul_f32 v170, v170, v30
  v_mul_f32 v171, v171, v30
  v_cvt_pk_bf16_f32 v26, v170, v171
  v_lshlrev_b32 v170, 16, v26
  v_and_b32 v171, 0xffff0000, v26
  v_add_f32 v170, v170, v90
  v_add_f32 v171, v171, v91
  v_cvt_pk_bf16_f32 v89, v170, v171
  buffer_store_dwordx2 v[88:89], v9, s[8:11], s22 offen offset:192
  s_waitcnt vmcnt(19)
  v_cvt_pk_bf16_f32 v26, v172, v173
  v_lshlrev_b32 v172, 16, v26
  v_and_b32 v173, 0xffff0000, v26
  v_mul_f32 v172, v172, v30
  v_mul_f32 v173, v173, v30
  v_cvt_pk_bf16_f32 v26, v172, v173
  v_lshlrev_b32 v172, 16, v26
  v_and_b32 v173, 0xffff0000, v26
  v_add_f32 v172, v172, v92
  v_add_f32 v173, v173, v93
  v_cvt_pk_bf16_f32 v92, v172, v173
  v_cvt_pk_bf16_f32 v26, v174, v175
  v_lshlrev_b32 v174, 16, v26
  v_and_b32 v175, 0xffff0000, v26
  v_mul_f32 v174, v174, v30
  v_mul_f32 v175, v175, v30
  v_cvt_pk_bf16_f32 v26, v174, v175
  v_lshlrev_b32 v174, 16, v26
  v_and_b32 v175, 0xffff0000, v26
  v_add_f32 v174, v174, v94
  v_add_f32 v175, v175, v95
  v_cvt_pk_bf16_f32 v93, v174, v175
  buffer_store_dwordx2 v[92:93], v9, s[8:11], s22 offen offset:224
  s_waitcnt vmcnt(19)
  v_cvt_pk_bf16_f32 v26, v176, v177
  v_lshlrev_b32 v176, 16, v26
  v_and_b32 v177, 0xffff0000, v26
  v_mul_f32 v176, v176, v30
  v_mul_f32 v177, v177, v30
  v_cvt_pk_bf16_f32 v26, v176, v177
  v_lshlrev_b32 v176, 16, v26
  v_and_b32 v177, 0xffff0000, v26
  v_add_f32 v176, v176, v96
  v_add_f32 v177, v177, v97
  v_cvt_pk_bf16_f32 v96, v176, v177
  v_cvt_pk_bf16_f32 v26, v178, v179
  v_lshlrev_b32 v178, 16, v26
  v_and_b32 v179, 0xffff0000, v26
  v_mul_f32 v178, v178, v30
  v_mul_f32 v179, v179, v30
  v_cvt_pk_bf16_f32 v26, v178, v179
  v_lshlrev_b32 v178, 16, v26
  v_and_b32 v179, 0xffff0000, v26
  v_add_f32 v178, v178, v98
  v_add_f32 v179, v179, v99
  v_cvt_pk_bf16_f32 v97, v178, v179
  buffer_store_dwordx2 v[96:97], v9, s[8:11], s22 offen offset:256
  s_waitcnt vmcnt(19)
  v_cvt_pk_bf16_f32 v26, v180, v181
  v_lshlrev_b32 v180, 16, v26
  v_and_b32 v181, 0xffff0000, v26
  v_mul_f32 v180, v180, v30
  v_mul_f32 v181, v181, v30
  v_cvt_pk_bf16_f32 v26, v180, v181
  v_lshlrev_b32 v180, 16, v26
  v_and_b32 v181, 0xffff0000, v26
  v_add_f32 v180, v180, v100
  v_add_f32 v181, v181, v101
  v_cvt_pk_bf16_f32 v100, v180, v181
  v_cvt_pk_bf16_f32 v26, v182, v183
  v_lshlrev_b32 v182, 16, v26
  v_and_b32 v183, 0xffff0000, v26
  v_mul_f32 v182, v182, v30
  v_mul_f32 v183, v183, v30
  v_cvt_pk_bf16_f32 v26, v182, v183
  v_lshlrev_b32 v182, 16, v26
  v_and_b32 v183, 0xffff0000, v26
  v_add_f32 v182, v182, v102
  v_add_f32 v183, v183, v103
  v_cvt_pk_bf16_f32 v101, v182, v183
  buffer_store_dwordx2 v[100:101], v9, s[8:11], s22 offen offset:288
  s_waitcnt vmcnt(19)
  v_cvt_pk_bf16_f32 v26, v184, v185
  v_lshlrev_b32 v184, 16, v26
  v_and_b32 v185, 0xffff0000, v26
  v_mul_f32 v184, v184, v31
  v_mul_f32 v185, v185, v31
  v_cvt_pk_bf16_f32 v26, v184, v185
  v_lshlrev_b32 v184, 16, v26
  v_and_b32 v185, 0xffff0000, v26
  v_add_f32 v184, v184, v104
  v_add_f32 v185, v185, v105
  v_cvt_pk_bf16_f32 v104, v184, v185
  v_cvt_pk_bf16_f32 v26, v186, v187
  v_lshlrev_b32 v186, 16, v26
  v_and_b32 v187, 0xffff0000, v26
  v_mul_f32 v186, v186, v31
  v_mul_f32 v187, v187, v31
  v_cvt_pk_bf16_f32 v26, v186, v187
  v_lshlrev_b32 v186, 16, v26
  v_and_b32 v187, 0xffff0000, v26
  v_add_f32 v186, v186, v106
  v_add_f32 v187, v187, v107
  v_cvt_pk_bf16_f32 v105, v186, v187
  buffer_store_dwordx2 v[104:105], v9, s[8:11], s23 offen offset:0
  s_waitcnt vmcnt(19)
  v_cvt_pk_bf16_f32 v26, v188, v189
  v_lshlrev_b32 v188, 16, v26
  v_and_b32 v189, 0xffff0000, v26
  v_mul_f32 v188, v188, v31
  v_mul_f32 v189, v189, v31
  v_cvt_pk_bf16_f32 v26, v188, v189
  v_lshlrev_b32 v188, 16, v26
  v_and_b32 v189, 0xffff0000, v26
  v_add_f32 v188, v188, v108
  v_add_f32 v189, v189, v109
  v_cvt_pk_bf16_f32 v108, v188, v189
  v_cvt_pk_bf16_f32 v26, v190, v191
  v_lshlrev_b32 v190, 16, v26
  v_and_b32 v191, 0xffff0000, v26
  v_mul_f32 v190, v190, v31
  v_mul_f32 v191, v191, v31
  v_cvt_pk_bf16_f32 v26, v190, v191
  v_lshlrev_b32 v190, 16, v26
  v_and_b32 v191, 0xffff0000, v26
  v_add_f32 v190, v190, v110
  v_add_f32 v191, v191, v111
  v_cvt_pk_bf16_f32 v109, v190, v191
  buffer_store_dwordx2 v[108:109], v9, s[8:11], s23 offen offset:32
  s_waitcnt vmcnt(19)
  v_cvt_pk_bf16_f32 v26, v192, v193
  v_lshlrev_b32 v192, 16, v26
  v_and_b32 v193, 0xffff0000, v26
  v_mul_f32 v192, v192, v31
  v_mul_f32 v193, v193, v31
  v_cvt_pk_bf16_f32 v26, v192, v193
  v_lshlrev_b32 v192, 16, v26
  v_and_b32 v193, 0xffff0000, v26
  v_add_f32 v192, v192, v112
  v_add_f32 v193, v193, v113
  v_cvt_pk_bf16_f32 v112, v192, v193
  v_cvt_pk_bf16_f32 v26, v194, v195
  v_lshlrev_b32 v194, 16, v26
  v_and_b32 v195, 0xffff0000, v26
  v_mul_f32 v194, v194, v31
  v_mul_f32 v195, v195, v31
  v_cvt_pk_bf16_f32 v26, v194, v195
  v_lshlrev_b32 v194, 16, v26
  v_and_b32 v195, 0xffff0000, v26
  v_add_f32 v194, v194, v114
  v_add_f32 v195, v195, v115
  v_cvt_pk_bf16_f32 v113, v194, v195
  buffer_store_dwordx2 v[112:113], v9, s[8:11], s23 offen offset:64
  s_waitcnt vmcnt(19)
  v_cvt_pk_bf16_f32 v26, v196, v197
  v_lshlrev_b32 v196, 16, v26
  v_and_b32 v197, 0xffff0000, v26
  v_mul_f32 v196, v196, v31
  v_mul_f32 v197, v197, v31
  v_cvt_pk_bf16_f32 v26, v196, v197
  v_lshlrev_b32 v196, 16, v26
  v_and_b32 v197, 0xffff0000, v26
  v_add_f32 v196, v196, v116
  v_add_f32 v197, v197, v117
  v_cvt_pk_bf16_f32 v116, v196, v197
  v_cvt_pk_bf16_f32 v26, v198, v199
  v_lshlrev_b32 v198, 16, v26
  v_and_b32 v199, 0xffff0000, v26
  v_mul_f32 v198, v198, v31
  v_mul_f32 v199, v199, v31
  v_cvt_pk_bf16_f32 v26, v198, v199
  v_lshlrev_b32 v198, 16, v26
  v_and_b32 v199, 0xffff0000, v26
  v_add_f32 v198, v198, v118
  v_add_f32 v199, v199, v119
  v_cvt_pk_bf16_f32 v117, v198, v199
  buffer_store_dwordx2 v[116:117], v9, s[8:11], s23 offen offset:96
  s_waitcnt vmcnt(19)
  v_cvt_pk_bf16_f32 v26, v200, v201
  v_lshlrev_b32 v200, 16, v26
  v_and_b32 v201, 0xffff0000, v26
  v_mul_f32 v200, v200, v31
  v_mul_f32 v201, v201, v31
  v_cvt_pk_bf16_f32 v26, v200, v201
  v_lshlrev_b32 v200, 16, v26
  v_and_b32 v201, 0xffff0000, v26
  v_add_f32 v200, v200, v120
  v_add_f32 v201, v201, v121
  v_cvt_pk_bf16_f32 v120, v200, v201
  v_cvt_pk_bf16_f32 v26, v202, v203
  v_lshlrev_b32 v202, 16, v26
  v_and_b32 v203, 0xffff0000, v26
  v_mul_f32 v202, v202, v31
  v_mul_f32 v203, v203, v31
  v_cvt_pk_bf16_f32 v26, v202, v203
  v_lshlrev_b32 v202, 16, v26
  v_and_b32 v203, 0xffff0000, v26
  v_add_f32 v202, v202, v122
  v_add_f32 v203, v203, v123
  v_cvt_pk_bf16_f32 v121, v202, v203
  buffer_store_dwordx2 v[120:121], v9, s[8:11], s23 offen offset:128
  s_waitcnt vmcnt(19)
  v_cvt_pk_bf16_f32 v26, v204, v205
  v_lshlrev_b32 v204, 16, v26
  v_and_b32 v205, 0xffff0000, v26
  v_mul_f32 v204, v204, v31
  v_mul_f32 v205, v205, v31
  v_cvt_pk_bf16_f32 v26, v204, v205
  v_lshlrev_b32 v204, 16, v26
  v_and_b32 v205, 0xffff0000, v26
  v_add_f32 v204, v204, v124
  v_add_f32 v205, v205, v125
  v_cvt_pk_bf16_f32 v124, v204, v205
  v_cvt_pk_bf16_f32 v26, v206, v207
  v_lshlrev_b32 v206, 16, v26
  v_and_b32 v207, 0xffff0000, v26
  v_mul_f32 v206, v206, v31
  v_mul_f32 v207, v207, v31
  v_cvt_pk_bf16_f32 v26, v206, v207
  v_lshlrev_b32 v206, 16, v26
  v_and_b32 v207, 0xffff0000, v26
  v_add_f32 v206, v206, v126
  v_add_f32 v207, v207, v127
  v_cvt_pk_bf16_f32 v125, v206, v207
  buffer_store_dwordx2 v[124:125], v9, s[8:11], s23 offen offset:160
  s_waitcnt vmcnt(19)
  v_cvt_pk_bf16_f32 v26, v208, v209
  v_lshlrev_b32 v208, 16, v26
  v_and_b32 v209, 0xffff0000, v26
  v_mul_f32 v208, v208, v31
  v_mul_f32 v209, v209, v31
  v_cvt_pk_bf16_f32 v26, v208, v209
  v_lshlrev_b32 v208, 16, v26
  v_and_b32 v209, 0xffff0000, v26
  v_add_f32 v208, v208, v128
  v_add_f32 v209, v209, v129
  v_cvt_pk_bf16_f32 v128, v208, v209
  v_cvt_pk_bf16_f32 v26, v210, v211
  v_lshlrev_b32 v210, 16, v26
  v_and_b32 v211, 0xffff0000, v26
  v_mul_f32 v210, v210, v31
  v_mul_f32 v211, v211, v31
  v_cvt_pk_bf16_f32 v26, v210, v211
  v_lshlrev_b32 v210, 16, v26
  v_and_b32 v211, 0xffff0000, v26
  v_add_f32 v210, v210, v130
  v_add_f32 v211, v211, v131
  v_cvt_pk_bf16_f32 v129, v210, v211
  buffer_store_dwordx2 v[128:129], v9, s[8:11], s23 offen offset:192
  s_waitcnt vmcnt(19)
  v_cvt_pk_bf16_f32 v26, v212, v213
  v_lshlrev_b32 v212, 16, v26
  v_and_b32 v213, 0xffff0000, v26
  v_mul_f32 v212, v212, v31
  v_mul_f32 v213, v213, v31
  v_cvt_pk_bf16_f32 v26, v212, v213
  v_lshlrev_b32 v212, 16, v26
  v_and_b32 v213, 0xffff0000, v26
  v_add_f32 v212, v212, v132
  v_add_f32 v213, v213, v133
  v_cvt_pk_bf16_f32 v132, v212, v213
  v_cvt_pk_bf16_f32 v26, v214, v215
  v_lshlrev_b32 v214, 16, v26
  v_and_b32 v215, 0xffff0000, v26
  v_mul_f32 v214, v214, v31
  v_mul_f32 v215, v215, v31
  v_cvt_pk_bf16_f32 v26, v214, v215
  v_lshlrev_b32 v214, 16, v26
  v_and_b32 v215, 0xffff0000, v26
  v_add_f32 v214, v214, v134
  v_add_f32 v215, v215, v135
  v_cvt_pk_bf16_f32 v133, v214, v215
  buffer_store_dwordx2 v[132:133], v9, s[8:11], s23 offen offset:224
  s_waitcnt vmcnt(19)
  v_cvt_pk_bf16_f32 v26, v216, v217
  v_lshlrev_b32 v216, 16, v26
  v_and_b32 v217, 0xffff0000, v26
  v_mul_f32 v216, v216, v31
  v_mul_f32 v217, v217, v31
  v_cvt_pk_bf16_f32 v26, v216, v217
  v_lshlrev_b32 v216, 16, v26
  v_and_b32 v217, 0xffff0000, v26
  v_add_f32 v216, v216, v136
  v_add_f32 v217, v217, v137
  v_cvt_pk_bf16_f32 v136, v216, v217
  v_cvt_pk_bf16_f32 v26, v218, v219
  v_lshlrev_b32 v218, 16, v26
  v_and_b32 v219, 0xffff0000, v26
  v_mul_f32 v218, v218, v31
  v_mul_f32 v219, v219, v31
  v_cvt_pk_bf16_f32 v26, v218, v219
  v_lshlrev_b32 v218, 16, v26
  v_and_b32 v219, 0xffff0000, v26
  v_add_f32 v218, v218, v138
  v_add_f32 v219, v219, v139
  v_cvt_pk_bf16_f32 v137, v218, v219
  buffer_store_dwordx2 v[136:137], v9, s[8:11], s23 offen offset:256
  s_waitcnt vmcnt(19)
  v_cvt_pk_bf16_f32 v26, v220, v221
  v_lshlrev_b32 v220, 16, v26
  v_and_b32 v221, 0xffff0000, v26
  v_mul_f32 v220, v220, v31
  v_mul_f32 v221, v221, v31
  v_cvt_pk_bf16_f32 v26, v220, v221
  v_lshlrev_b32 v220, 16, v26
  v_and_b32 v221, 0xffff0000, v26
  v_add_f32 v220, v220, v140
  v_add_f32 v221, v221, v141
  v_cvt_pk_bf16_f32 v140, v220, v221
  v_cvt_pk_bf16_f32 v26, v222, v223
  v_lshlrev_b32 v222, 16, v26
  v_and_b32 v223, 0xffff0000, v26
  v_mul_f32 v222, v222, v31
  v_mul_f32 v223, v223, v31
  v_cvt_pk_bf16_f32 v26, v222, v223
  v_lshlrev_b32 v222, 16, v26
  v_and_b32 v223, 0xffff0000, v26
  v_add_f32 v222, v222, v142
  v_add_f32 v223, v223, v143
  v_cvt_pk_bf16_f32 v141, v222, v223
  buffer_store_dwordx2 v[140:141], v9, s[8:11], s23 offen offset:288
om_242:
  s_cmp_eq_u32 s87, -2
  s_cbranch_scc1 kv_help
  s_cmp_eq_u32 s87, -1
  s_cbranch_scc1 queue
tail_item:
  s_load_dwordx2 s[4:5], s[0:1], 96
  s_waitcnt lgkmcnt(0)
  s_mov_b32 s32, s4
  s_mov_b32 s33, s5
  s_mov_b32 s34, 256
  s_mov_b32 s35, 0x00020000
  s_waitcnt vmcnt(0)
  s_barrier
  s_mov_b32 s21, s87
do_pv:
  s_mov_b32 s2, s21
  s_load_dwordx2 s[4:5], s[0:1], 88
  s_load_dwordx2 s[38:39], s[0:1], 104
  s_waitcnt lgkmcnt(0)
  s_mov_b32 s8, s4
  s_mov_b32 s9, s5
  s_mov_b32 s10, 2621440
  s_mov_b32 s11, 0x00020000
  s_add_u32 s12, s38, 114294784
  s_addc_u32 s13, s39, 0
  s_mov_b32 s14, 83886080
  s_mov_b32 s15, 0x00020000
  s_mov_b32 s59, 0
  s_mov_b32 s60, 0
  s_add_u32 s16, s38, 85983232
  s_addc_u32 s17, s39, 0
  s_mov_b32 s18, 28311552
  s_mov_b32 s19, 0x00020000
  s_add_u32 s24, s38, 73400320
  s_addc_u32 s25, s39, 0
  s_mov_b32 s26, 5242880
  s_mov_b32 s27, 0x00020000
  s_add_u32 s28, s38, 81002496
  s_addc_u32 s29, s39, 0
  s_mov_b32 s30, 8192
  s_mov_b32 s31, 0x00020000
  s_add_u32 s72, s38, 81068032
  s_addc_u32 s73, s39, 0
  s_mov_b32 s74, 116736
  s_mov_b32 s75, 0x00020000
  v_lshlrev_b32 v4, 4, v1
  v_lshlrev_b32 v5, 3, v1
  v_lshlrev_b32 v6, 2, v2
  v_and_b32 v7, 7, v1
  v_lshlrev_b32 v7, 7, v7
  v_lshrrev_b32 v31, 3, v1
  v_lshl_add_u32 v208, v31, 10, v7
  v_bfe_u32 v31, v1, 3, 2
  v_lshl_add_u32 v31, v31, 2, v7
  s_lshl_b32 s21, s20, 10
  s_add_u32 s21, s21, 95232
  buffer_load_dword v8, v31, s[72:75], s21 offen sc1
  v_lshlrev_b32 v25, 7, v2
  s_mov_b32 s21, 93184
  buffer_load_dword v26, v25, s[72:75], s21 offen sc1
  s_mov_b32 s63, 1
  v_mul_u32_u24 v9, 1280, v2
  v_lshl_add_u32 v9, v3, 3, v9
  s_lshl_b32 s21, s20, 13
  v_add_u32 v10, s21, v4
  s_lshl_b32 s21, s20, 10
  v_add_u32 v11, s21, v4
  v_lshrrev_b32 v20, 5, v1
  v_mul_u32_u24 v21, 2560, v20
  v_add_u32 v21, v21, v4
  v_and_b32 v22, 31, v1
  v_lshlrev_b32 v22, 4, v22
  v_mul_u32_u24 v20, 10240, v20
  v_add_u32 v22, v22, v20
  v_mul_u32_u24 v21, 2560, v3
  v_lshl_add_u32 v21, v2, 4, v21
  v_mul_u32_u24 v22, 10240, v3
  v_lshl_add_u32 v22, v2, 4, v22
  v_mov_b32 v28, 80
  v_mov_b32 v30, 32768
  s_mov_b32 s50, 0
  s_mov_b32 s71, 0
  s_mov_b32 s51, 0
  s_and_b32 s43, s20, 1
  s_lshr_b32 s44, s20, 1
  v_mov_b32 v70, 0
  v_mov_b32 v71, 0
  v_mov_b32 v78, 0
  v_mov_b32 v79, 0
  v_mov_b32 v86, 0
  v_mov_b32 v87, 0
  v_mov_b32 v94, 0
  v_mov_b32 v95, 0
  v_mov_b32 v102, 0
  v_mov_b32 v103, 0
  v_mov_b32 v110, 0
  v_mov_b32 v111, 0
  v_mov_b32 v118, 0
  v_mov_b32 v119, 0
  v_mov_b32 v126, 0
  v_mov_b32 v127, 0
  s_mov_b32 s21, s2
pv_loop:
  s_mul_i32 s2, s21, 2
  s_add_u32 s22, s21, 250
  s_cmp_lt_u32 s21, 250
  s_cselect_b32 s2, s2, s22
  s_cselect_b32 s65, 1, 0
  s_mul_hi_u32 s40, s2, 0x1999999a
  s_mul_i32 s21, s40, 10
  s_sub_u32 s41, s2, s21
  s_lshl_b32 s52, s40, 10
  s_add_u32 s52, s52, 23552
  buffer_load_dword v27, v7, s[72:75], s52 offen sc1
  s_cmp_lg_u32 s20, 0
  s_cbranch_scc1 pv_256
  s_sub_u32 s21, s2, 450
  s_cmp_lt_u32 s21, 190
  s_cbranch_scc1 pv_256
  v_mov_b32 v29, 1
  s_mov_b64 exec, 1
  buffer_atomic_add v29, v28, s[32:35], 0 offen sc0 sc1
  s_mov_b64 exec, -1
pv_256:
  s_lshl_b32 s42, s40, 5
  s_lshl_b32 s21, s20, 3
  s_add_u32 s42, s42, s21
  s_mul_i32 s61, s21, 5
  s_lshr_b32 s22, s41, 1
  s_add_u32 s61, s61, s22
  s_and_b32 s62, s41, 1
  s_lshl_b32 s62, s62, 12
  s_mul_i32 s53, s42, 40960
  s_lshl_b32 s22, s41, 12
  s_add_u32 s53, s53, s22
  s_lshl_b32 s21, s40, 1
  s_add_u32 s21, s21, s43
  s_lshl_b32 s45, s21, 6
  s_mul_i32 s46, s21, 20480
  s_mul_i32 s21, s21, 40
  s_lshl_b32 s22, s41, 2
  s_add_u32 s22, s22, s44
  s_add_u32 s21, s21, s22
  s_lshl_b32 s54, s21, 10
  s_lshl_b32 s22, s22, 5
  s_add_u32 s46, s46, s22
  s_mul_i32 s47, s42, 2560
  s_mul_i32 s48, s42, 10240
  s_lshl_b32 s22, s41, 10
  s_add_u32 s48, s48, s22
  s_add_u32 s48, s48, 7340032
  s_add_u32 s23, s40, 1
  s_cmp_ge_u32 s50, s23
  s_cbranch_scc1 pv_249
  s_cmp_eq_u32 s63, 0
  s_cbranch_scc1 pv_252
  s_mov_b32 s63, 0
  s_waitcnt vmcnt(1)
  v_cmp_le_u32 vcc, 4, v26
  s_mov_b32 s51, vcc_lo
  v_cmp_gt_u32 vcc, s23, v8
  s_nop 1
  s_cbranch_vccz pv_253
pv_252:
  s_lshl_b32 s21, s20, 10
  s_add_u32 s21, s21, 95232
  s_mov_b32 s101, 0
wm_257:
  buffer_load_dword v8, v31, s[72:75], s21 offen sc1
  s_add_u32 s101, s101, 1
  s_cmp_gt_u32 s101, 131072
  s_cbranch_scc1 main_end
  s_waitcnt vmcnt(0)
  v_cmp_gt_u32 vcc, s23, v8
  v_readfirstlane_b32 s100, v8
  s_nop 0
  s_cbranch_vccz wm_258
  s_sleep 8
  s_add_u32 s100, s100, 2
  s_cmp_ge_u32 s100, s23
  s_cbranch_scc1 wm_257
  s_sleep 60
  s_branch wm_257
wm_258:
pv_253:
  v_readlane_b32 s50, v8, 0
  v_readlane_b32 s21, v8, 1
  s_min_u32 s50, s50, s21
  v_readlane_b32 s21, v8, 2
  s_min_u32 s50, s50, s21
  v_readlane_b32 s21, v8, 3
  s_min_u32 s50, s50, s21
  v_readlane_b32 s21, v8, 4
  s_min_u32 s50, s50, s21
  v_readlane_b32 s21, v8, 5
  s_min_u32 s50, s50, s21
  v_readlane_b32 s21, v8, 6
  s_min_u32 s50, s50, s21
  v_readlane_b32 s21, v8, 7
  s_min_u32 s50, s50, s21
  v_readlane_b32 s21, v8, 8
  s_min_u32 s50, s50, s21
  v_readlane_b32 s21, v8, 9
  s_min_u32 s50, s50, s21
  v_readlane_b32 s21, v8, 10
  s_min_u32 s50, s50, s21
  v_readlane_b32 s21, v8, 11
  s_min_u32 s50, s50, s21
  v_readlane_b32 s21, v8, 12
  s_min_u32 s50, s50, s21
  v_readlane_b32 s21, v8, 13
  s_min_u32 s50, s50, s21
  v_readlane_b32 s21, v8, 14
  s_min_u32 s50, s50, s21
  v_readlane_b32 s21, v8, 15
  s_min_u32 s50, s50, s21
  v_readlane_b32 s21, v8, 16
  s_min_u32 s50, s50, s21
  v_readlane_b32 s21, v8, 17
  s_min_u32 s50, s50, s21
  v_readlane_b32 s21, v8, 18
  s_min_u32 s50, s50, s21
  v_readlane_b32 s21, v8, 19
  s_min_u32 s50, s50, s21
  v_readlane_b32 s21, v8, 20
  s_min_u32 s50, s50, s21
  v_readlane_b32 s21, v8, 21
  s_min_u32 s50, s50, s21
  v_readlane_b32 s21, v8, 22
  s_min_u32 s50, s50, s21
  v_readlane_b32 s21, v8, 23
  s_min_u32 s50, s50, s21
  v_readlane_b32 s21, v8, 24
  s_min_u32 s50, s50, s21
  v_readlane_b32 s21, v8, 25
  s_min_u32 s50, s50, s21
  v_readlane_b32 s21, v8, 26
  s_min_u32 s50, s50, s21
  v_readlane_b32 s21, v8, 27
  s_min_u32 s50, s50, s21
  v_readlane_b32 s21, v8, 28
  s_min_u32 s50, s50, s21
  v_readlane_b32 s21, v8, 29
  s_min_u32 s50, s50, s21
  v_readlane_b32 s21, v8, 30
  s_min_u32 s50, s50, s21
  v_readlane_b32 s21, v8, 31
  s_min_u32 s50, s50, s21
pv_249:
  s_lshr_b32 s22, s40, 2
  s_cmp_lt_u32 s40, 32
  s_cbranch_scc1 pv_250
  s_bitcmp1_b32 s51, s22
  s_cbranch_scc1 pv_250
  s_mov_b32 s21, 93184
  v_lshlrev_b32 v25, 7, v2
  s_mov_b32 s101, 0
pv_251:
  buffer_load_dword v26, v25, s[72:75], s21 offen sc1
  s_add_u32 s101, s101, 1
  s_cmp_gt_u32 s101, 131072
  s_cbranch_scc1 main_end
  s_waitcnt vmcnt(0)
  v_cmp_le_u32 vcc, 4, v26
  s_mov_b32 s51, vcc_lo
  s_bitcmp1_b32 s51, s22
  s_cbranch_scc1 pv_250
  s_sleep 8
  s_branch pv_251
pv_250:
  buffer_load_dwordx4 a[0:3], v4, s[12:15], s53 offen offset:0 sc1
  buffer_load_dwordx4 a[4:7], v4, s[12:15], s53 offen offset:1024 sc1
  buffer_load_dwordx4 a[8:11], v4, s[12:15], s53 offen offset:2048 sc1
  buffer_load_dwordx4 a[12:15], v4, s[12:15], s53 offen offset:3072 sc1
  s_add_u32 s53, s53, 40960
  buffer_load_dwordx4 a[16:19], v4, s[12:15], s53 offen offset:0 sc1
  buffer_load_dwordx4 a[20:23], v4, s[12:15], s53 offen offset:1024 sc1
  buffer_load_dwordx4 a[24:27], v4, s[12:15], s53 offen offset:2048 sc1
  buffer_load_dwordx4 a[28:31], v4, s[12:15], s53 offen offset:3072 sc1
  s_add_u32 s53, s53, 40960
  buffer_load_dwordx4 a[32:35], v4, s[12:15], s53 offen offset:0 sc1
  buffer_load_dwordx4 a[36:39], v4, s[12:15], s53 offen offset:1024 sc1
  buffer_load_dwordx4 a[40:43], v4, s[12:15], s53 offen offset:2048 sc1
  buffer_load_dwordx4 a[44:47], v4, s[12:15], s53 offen offset:3072 sc1
  s_add_u32 s53, s53, 40960
  buffer_load_dwordx4 a[48:51], v4, s[12:15], s53 offen offset:0 sc1
  buffer_load_dwordx4 a[52:55], v4, s[12:15], s53 offen offset:1024 sc1
  buffer_load_dwordx4 a[56:59], v4, s[12:15], s53 offen offset:2048 sc1
  buffer_load_dwordx4 a[60:63], v4, s[12:15], s53 offen offset:3072 sc1
  s_add_u32 s53, s53, 40960
  buffer_load_dwordx4 a[64:67], v4, s[12:15], s53 offen offset:0 sc1
  buffer_load_dwordx4 a[68:71], v4, s[12:15], s53 offen offset:1024 sc1
  buffer_load_dwordx4 a[72:75], v4, s[12:15], s53 offen offset:2048 sc1
  buffer_load_dwordx4 a[76:79], v4, s[12:15], s53 offen offset:3072 sc1
  s_add_u32 s53, s53, 40960
  buffer_load_dwordx4 a[80:83], v4, s[12:15], s53 offen offset:0 sc1
  buffer_load_dwordx4 a[84:87], v4, s[12:15], s53 offen offset:1024 sc1
  buffer_load_dwordx4 a[88:91], v4, s[12:15], s53 offen offset:2048 sc1
  buffer_load_dwordx4 a[92:95], v4, s[12:15], s53 offen offset:3072 sc1
  s_add_u32 s53, s53, 40960
  buffer_load_dwordx4 a[96:99], v4, s[12:15], s53 offen offset:0 sc1
  buffer_load_dwordx4 a[100:103], v4, s[12:15], s53 offen offset:1024 sc1
  buffer_load_dwordx4 a[104:107], v4, s[12:15], s53 offen offset:2048 sc1
  buffer_load_dwordx4 a[108:111], v4, s[12:15], s53 offen offset:3072 sc1
  s_add_u32 s53, s53, 40960
  buffer_load_dwordx4 a[112:115], v4, s[12:15], s53 offen offset:0 sc1
  buffer_load_dwordx4 a[116:119], v4, s[12:15], s53 offen offset:1024 sc1
  buffer_load_dwordx4 a[120:123], v4, s[12:15], s53 offen offset:2048 sc1
  buffer_load_dwordx4 a[124:127], v4, s[12:15], s53 offen offset:3072 sc1
  s_cmp_lt_u32 s40, 32
  s_cselect_b32 s70, 0x80000000, s54
  buffer_load_dwordx4 v[12:15], v4, s[24:27], s70 offen sc1
  buffer_load_dwordx4 v[16:19], v4, s[24:27], s70 offen offset:2048 sc1
  buffer_load_dword v24, v6, s[28:31], s45 offen sc1
  s_waitcnt vmcnt(35)
  s_cmp_eq_u32 s71, 0
  s_cbranch_scc1 paf_261
  v_mov_b32 v25, 0
  v_mov_b32 v26, 1
  s_mov_b64 exec, 1
  buffer_atomic_add v26, v25, s[72:75], s71 offen sc1
  s_mov_b64 exec, -1
  s_mov_b32 s71, 0
paf_261:
  v_cmp_le_u32 s[68:69], 4, v27
  s_nop 1
  s_and_b32 s21, s68, 255
  s_cmp_lg_u32 s21, 255
  s_cbranch_scc1 pvw_254
  s_mov_b32 s56, s47
  s_mov_b32 s57, s48
  buffer_load_dwordx4 v[64:67], v4, s[16:19], s56 offen sc1
  buffer_load_dwordx2 v[68:69], v5, s[16:19], s56 offen offset:2048 sc1
  buffer_load_dwordx4 v[128:131], v21, s[16:19], s56 offen offset:1024 sc1
  buffer_load_dwordx4 v[132:135], v21, s[16:19], s56 offen offset:1280 sc1
  s_add_u32 s56, s56, 2560
  buffer_load_dwordx4 v[72:75], v4, s[16:19], s56 offen sc1
  buffer_load_dwordx2 v[76:77], v5, s[16:19], s56 offen offset:2048 sc1
  s_add_u32 s56, s56, 2560
  buffer_load_dwordx4 v[80:83], v4, s[16:19], s56 offen sc1
  buffer_load_dwordx2 v[84:85], v5, s[16:19], s56 offen offset:2048 sc1
  s_add_u32 s56, s56, 2560
  buffer_load_dwordx4 v[88:91], v4, s[16:19], s56 offen sc1
  buffer_load_dwordx2 v[92:93], v5, s[16:19], s56 offen offset:2048 sc1
  s_add_u32 s56, s56, 2560
  buffer_load_dwordx4 v[32:35], v22, s[16:19], s57 offen offset:0 sc1
  buffer_load_dwordx4 v[36:39], v22, s[16:19], s57 offen offset:256 sc1
  buffer_load_dwordx4 v[40:43], v22, s[16:19], s57 offen offset:512 sc1
  buffer_load_dwordx4 v[44:47], v22, s[16:19], s57 offen offset:768 sc1
  s_add_u32 s57, s57, 40960
  buffer_load_dwordx4 v[96:99], v4, s[16:19], s56 offen sc1
  buffer_load_dwordx2 v[100:101], v5, s[16:19], s56 offen offset:2048 sc1
  buffer_load_dwordx4 v[136:139], v21, s[16:19], s56 offen offset:1024 sc1
  buffer_load_dwordx4 v[140:143], v21, s[16:19], s56 offen offset:1280 sc1
  s_add_u32 s56, s56, 2560
  buffer_load_dwordx4 v[104:107], v4, s[16:19], s56 offen sc1
  buffer_load_dwordx2 v[108:109], v5, s[16:19], s56 offen offset:2048 sc1
  s_add_u32 s56, s56, 2560
  buffer_load_dwordx4 v[112:115], v4, s[16:19], s56 offen sc1
  buffer_load_dwordx2 v[116:117], v5, s[16:19], s56 offen offset:2048 sc1
  s_add_u32 s56, s56, 2560
  buffer_load_dwordx4 v[120:123], v4, s[16:19], s56 offen sc1
  buffer_load_dwordx2 v[124:125], v5, s[16:19], s56 offen offset:2048 sc1
  s_add_u32 s56, s56, 2560
  buffer_load_dwordx4 v[48:51], v22, s[16:19], s57 offen offset:0 sc1
  buffer_load_dwordx4 v[52:55], v22, s[16:19], s57 offen offset:256 sc1
  buffer_load_dwordx4 v[56:59], v22, s[16:19], s57 offen offset:512 sc1
  buffer_load_dwordx4 v[60:63], v22, s[16:19], s57 offen offset:768 sc1
  s_add_u32 s57, s57, 40960
  s_barrier
  s_waitcnt vmcnt(28)
  v_sub_f32 v25, 1.0, v24
  v_cvt_pk_bf16_f32 v26, v25, v25
  v_lshlrev_b32 v25, 16, v26
  v_cvt_pk_bf16_f32 v26, v12, v12
  v_lshlrev_b32 v12, 16, v26
  v_cvt_pk_bf16_f32 v26, v13, v13
  v_lshlrev_b32 v13, 16, v26
  v_cvt_pk_bf16_f32 v26, v14, v14
  v_lshlrev_b32 v14, 16, v26
  v_cvt_pk_bf16_f32 v26, v15, v15
  v_lshlrev_b32 v15, 16, v26
  v_cvt_pk_bf16_f32 v26, v16, v16
  v_lshlrev_b32 v16, 16, v26
  v_cvt_pk_bf16_f32 v26, v17, v17
  v_lshlrev_b32 v17, 16, v26
  v_cvt_pk_bf16_f32 v26, v18, v18
  v_lshlrev_b32 v18, 16, v26
  v_cvt_pk_bf16_f32 v26, v19, v19
  v_lshlrev_b32 v19, 16, v26
  v_mul_f32 v12, v12, v25
  v_cvt_pk_bf16_f32 v26, v12, v12
  v_lshlrev_b32 v12, 16, v26
  v_mul_f32 v13, v13, v25
  v_cvt_pk_bf16_f32 v26, v13, v13
  v_lshlrev_b32 v13, 16, v26
  v_mul_f32 v14, v14, v25
  v_cvt_pk_bf16_f32 v26, v14, v14
  v_lshlrev_b32 v14, 16, v26
  v_mul_f32 v15, v15, v25
  v_cvt_pk_bf16_f32 v26, v15, v15
  v_lshlrev_b32 v15, 16, v26
  v_mul_f32 v16, v16, v25
  v_cvt_pk_bf16_f32 v26, v16, v16
  v_lshlrev_b32 v16, 16, v26
  v_mul_f32 v17, v17, v25
  v_cvt_pk_bf16_f32 v26, v17, v17
  v_lshlrev_b32 v17, 16, v26
  v_mul_f32 v18, v18, v25
  v_cvt_pk_bf16_f32 v26, v18, v18
  v_lshlrev_b32 v18, 16, v26
  v_mul_f32 v19, v19, v25
  v_cvt_pk_bf16_f32 v26, v19, v19
  v_lshlrev_b32 v19, 16, v26
  s_cmp_ge_u32 s40, 56
  s_cbranch_scc1 pvc_260
  s_branch pvg_259
pvw_254:
  s_waitcnt vmcnt(0)
  v_sub_f32 v25, 1.0, v24
  v_cvt_pk_bf16_f32 v26, v25, v25
  v_lshlrev_b32 v25, 16, v26
  v_cvt_pk_bf16_f32 v26, v12, v12
  v_lshlrev_b32 v12, 16, v26
  v_cvt_pk_bf16_f32 v26, v13, v13
  v_lshlrev_b32 v13, 16, v26
  v_cvt_pk_bf16_f32 v26, v14, v14
  v_lshlrev_b32 v14, 16, v26
  v_cvt_pk_bf16_f32 v26, v15, v15
  v_lshlrev_b32 v15, 16, v26
  v_cvt_pk_bf16_f32 v26, v16, v16
  v_lshlrev_b32 v16, 16, v26
  v_cvt_pk_bf16_f32 v26, v17, v17
  v_lshlrev_b32 v17, 16, v26
  v_cvt_pk_bf16_f32 v26, v18, v18
  v_lshlrev_b32 v18, 16, v26
  v_cvt_pk_bf16_f32 v26, v19, v19
  v_lshlrev_b32 v19, 16, v26
  v_mul_f32 v12, v12, v25
  v_cvt_pk_bf16_f32 v26, v12, v12
  v_lshlrev_b32 v12, 16, v26
  v_mul_f32 v13, v13, v25
  v_cvt_pk_bf16_f32 v26, v13, v13
  v_lshlrev_b32 v13, 16, v26
  v_mul_f32 v14, v14, v25
  v_cvt_pk_bf16_f32 v26, v14, v14
  v_lshlrev_b32 v14, 16, v26
  v_mul_f32 v15, v15, v25
  v_cvt_pk_bf16_f32 v26, v15, v15
  v_lshlrev_b32 v15, 16, v26
  v_mul_f32 v16, v16, v25
  v_cvt_pk_bf16_f32 v26, v16, v16
  v_lshlrev_b32 v16, 16, v26
  v_mul_f32 v17, v17, v25
  v_cvt_pk_bf16_f32 v26, v17, v17
  v_lshlrev_b32 v17, 16, v26
  v_mul_f32 v18, v18, v25
  v_cvt_pk_bf16_f32 v26, v18, v18
  v_lshlrev_b32 v18, 16, v26
  v_mul_f32 v19, v19, v25
  v_cvt_pk_bf16_f32 v26, v19, v19
  v_lshlrev_b32 v19, 16, v26
  s_cmp_ge_u32 s40, 56
  s_cbranch_scc1 pvt_262
  s_cmp_lg_u32 s20, 0
  s_cbranch_scc1 wm_264
  s_mov_b32 s101, 0
wm_263:
  buffer_load_dword v26, v7, s[72:75], s52 offen sc1
  s_add_u32 s101, s101, 1
  s_cmp_gt_u32 s101, 131072
  s_cbranch_scc1 main_end
  s_waitcnt vmcnt(0)
  v_cmp_gt_u32 vcc, 4, v26
  v_readfirstlane_b32 s100, v26
  s_nop 0
  s_cbranch_vccz wm_264
  s_sleep 2
  s_add_u32 s100, s100, 3
  s_cmp_ge_u32 s100, 4
  s_cbranch_scc1 wm_263
  s_sleep 24
  s_branch wm_263
wm_264:
  s_barrier
  buffer_load_dwordx4 v[64:67], v4, s[16:19], s47 offen sc1
  buffer_load_dwordx2 v[68:69], v5, s[16:19], s47 offen offset:2048 sc1
  buffer_load_dwordx4 v[128:131], v21, s[16:19], s47 offen offset:1024 sc1
  buffer_load_dwordx4 v[132:135], v21, s[16:19], s47 offen offset:1280 sc1
  s_add_u32 s47, s47, 2560
  buffer_load_dwordx4 v[72:75], v4, s[16:19], s47 offen sc1
  buffer_load_dwordx2 v[76:77], v5, s[16:19], s47 offen offset:2048 sc1
  s_add_u32 s47, s47, 2560
  buffer_load_dwordx4 v[80:83], v4, s[16:19], s47 offen sc1
  buffer_load_dwordx2 v[84:85], v5, s[16:19], s47 offen offset:2048 sc1
  s_add_u32 s47, s47, 2560
  buffer_load_dwordx4 v[88:91], v4, s[16:19], s47 offen sc1
  buffer_load_dwordx2 v[92:93], v5, s[16:19], s47 offen offset:2048 sc1
  s_add_u32 s47, s47, 2560
  buffer_load_dwordx4 v[32:35], v22, s[16:19], s48 offen offset:0 sc1
  buffer_load_dwordx4 v[36:39], v22, s[16:19], s48 offen offset:256 sc1
  buffer_load_dwordx4 v[40:43], v22, s[16:19], s48 offen offset:512 sc1
  buffer_load_dwordx4 v[44:47], v22, s[16:19], s48 offen offset:768 sc1
  s_add_u32 s48, s48, 40960
  buffer_load_dwordx4 v[96:99], v4, s[16:19], s47 offen sc1
  buffer_load_dwordx2 v[100:101], v5, s[16:19], s47 offen offset:2048 sc1
  buffer_load_dwordx4 v[136:139], v21, s[16:19], s47 offen offset:1024 sc1
  buffer_load_dwordx4 v[140:143], v21, s[16:19], s47 offen offset:1280 sc1
  s_add_u32 s47, s47, 2560
  buffer_load_dwordx4 v[104:107], v4, s[16:19], s47 offen sc1
  buffer_load_dwordx2 v[108:109], v5, s[16:19], s47 offen offset:2048 sc1
  s_add_u32 s47, s47, 2560
  buffer_load_dwordx4 v[112:115], v4, s[16:19], s47 offen sc1
  buffer_load_dwordx2 v[116:117], v5, s[16:19], s47 offen offset:2048 sc1
  s_add_u32 s47, s47, 2560
  buffer_load_dwordx4 v[120:123], v4, s[16:19], s47 offen sc1
  buffer_load_dwordx2 v[124:125], v5, s[16:19], s47 offen offset:2048 sc1
  s_add_u32 s47, s47, 2560
  buffer_load_dwordx4 v[48:51], v22, s[16:19], s48 offen offset:0 sc1
  buffer_load_dwordx4 v[52:55], v22, s[16:19], s48 offen offset:256 sc1
  buffer_load_dwordx4 v[56:59], v22, s[16:19], s48 offen offset:512 sc1
  buffer_load_dwordx4 v[60:63], v22, s[16:19], s48 offen offset:768 sc1
  s_add_u32 s48, s48, 40960
pvg_259:
  s_waitcnt vmcnt(26)
  v_mfma_f32_16x16x32_bf16 v[148:151], a[0:3], v[64:67], 0
  v_mfma_f32_16x16x32_bf16 v[144:147], a[0:3], v[68:71], 0
  v_mfma_f32_16x16x32_bf16 v[156:159], a[4:7], v[64:67], 0
  v_mfma_f32_16x16x32_bf16 v[152:155], a[4:7], v[68:71], 0
  v_mfma_f32_16x16x32_bf16 v[164:167], a[8:11], v[64:67], 0
  v_mfma_f32_16x16x32_bf16 v[160:163], a[8:11], v[68:71], 0
  v_mfma_f32_16x16x32_bf16 v[172:175], a[12:15], v[64:67], 0
  v_mfma_f32_16x16x32_bf16 v[168:171], a[12:15], v[68:71], 0
  s_waitcnt vmcnt(22)
  v_mfma_f32_16x16x32_bf16 v[148:151], a[16:19], v[72:75], v[148:151]
  v_mfma_f32_16x16x32_bf16 v[144:147], a[16:19], v[76:79], v[144:147]
  v_mfma_f32_16x16x32_bf16 v[156:159], a[20:23], v[72:75], v[156:159]
  v_mfma_f32_16x16x32_bf16 v[152:155], a[20:23], v[76:79], v[152:155]
  v_mfma_f32_16x16x32_bf16 v[164:167], a[24:27], v[72:75], v[164:167]
  v_mfma_f32_16x16x32_bf16 v[160:163], a[24:27], v[76:79], v[160:163]
  v_mfma_f32_16x16x32_bf16 v[172:175], a[28:31], v[72:75], v[172:175]
  v_mfma_f32_16x16x32_bf16 v[168:171], a[28:31], v[76:79], v[168:171]
  s_waitcnt vmcnt(20)
  v_mfma_f32_16x16x32_bf16 v[148:151], a[32:35], v[80:83], v[148:151]
  v_mfma_f32_16x16x32_bf16 v[144:147], a[32:35], v[84:87], v[144:147]
  v_mfma_f32_16x16x32_bf16 v[156:159], a[36:39], v[80:83], v[156:159]
  v_mfma_f32_16x16x32_bf16 v[152:155], a[36:39], v[84:87], v[152:155]
  v_mfma_f32_16x16x32_bf16 v[164:167], a[40:43], v[80:83], v[164:167]
  v_mfma_f32_16x16x32_bf16 v[160:163], a[40:43], v[84:87], v[160:163]
  v_mfma_f32_16x16x32_bf16 v[172:175], a[44:47], v[80:83], v[172:175]
  v_mfma_f32_16x16x32_bf16 v[168:171], a[44:47], v[84:87], v[168:171]
  s_waitcnt vmcnt(18)
  v_mfma_f32_16x16x32_bf16 v[148:151], a[48:51], v[88:91], v[148:151]
  v_mfma_f32_16x16x32_bf16 v[144:147], a[48:51], v[92:95], v[144:147]
  v_mfma_f32_16x16x32_bf16 v[156:159], a[52:55], v[88:91], v[156:159]
  v_mfma_f32_16x16x32_bf16 v[152:155], a[52:55], v[92:95], v[152:155]
  v_mfma_f32_16x16x32_bf16 v[164:167], a[56:59], v[88:91], v[164:167]
  v_mfma_f32_16x16x32_bf16 v[160:163], a[56:59], v[92:95], v[160:163]
  v_mfma_f32_16x16x32_bf16 v[172:175], a[60:63], v[88:91], v[172:175]
  v_mfma_f32_16x16x32_bf16 v[168:171], a[60:63], v[92:95], v[168:171]
  s_waitcnt vmcnt(14)
  s_nop 1
  v_mfma_f32_16x16x32_bf16 v[144:147], v[32:35], v[128:131], v[144:147]
  v_mfma_f32_16x16x32_bf16 v[148:151], v[32:35], v[132:135], v[148:151]
  v_mfma_f32_16x16x32_bf16 v[152:155], v[36:39], v[128:131], v[152:155]
  v_mfma_f32_16x16x32_bf16 v[156:159], v[36:39], v[132:135], v[156:159]
  v_mfma_f32_16x16x32_bf16 v[160:163], v[40:43], v[128:131], v[160:163]
  v_mfma_f32_16x16x32_bf16 v[164:167], v[40:43], v[132:135], v[164:167]
  v_mfma_f32_16x16x32_bf16 v[168:171], v[44:47], v[128:131], v[168:171]
  v_mfma_f32_16x16x32_bf16 v[172:175], v[44:47], v[132:135], v[172:175]
  s_waitcnt vmcnt(12)
  v_mfma_f32_16x16x32_bf16 v[148:151], a[64:67], v[96:99], v[148:151]
  v_mfma_f32_16x16x32_bf16 v[144:147], a[64:67], v[100:103], v[144:147]
  v_mfma_f32_16x16x32_bf16 v[156:159], a[68:71], v[96:99], v[156:159]
  v_mfma_f32_16x16x32_bf16 v[152:155], a[68:71], v[100:103], v[152:155]
  v_mfma_f32_16x16x32_bf16 v[164:167], a[72:75], v[96:99], v[164:167]
  v_mfma_f32_16x16x32_bf16 v[160:163], a[72:75], v[100:103], v[160:163]
  v_mfma_f32_16x16x32_bf16 v[172:175], a[76:79], v[96:99], v[172:175]
  v_mfma_f32_16x16x32_bf16 v[168:171], a[76:79], v[100:103], v[168:171]
  s_waitcnt vmcnt(8)
  v_mfma_f32_16x16x32_bf16 v[148:151], a[80:83], v[104:107], v[148:151]
  v_mfma_f32_16x16x32_bf16 v[144:147], a[80:83], v[108:111], v[144:147]
  v_mfma_f32_16x16x32_bf16 v[156:159], a[84:87], v[104:107], v[156:159]
  v_mfma_f32_16x16x32_bf16 v[152:155], a[84:87], v[108:111], v[152:155]
  v_mfma_f32_16x16x32_bf16 v[164:167], a[88:91], v[104:107], v[164:167]
  v_mfma_f32_16x16x32_bf16 v[160:163], a[88:91], v[108:111], v[160:163]
  v_mfma_f32_16x16x32_bf16 v[172:175], a[92:95], v[104:107], v[172:175]
  v_mfma_f32_16x16x32_bf16 v[168:171], a[92:95], v[108:111], v[168:171]
  s_waitcnt vmcnt(6)
  v_mfma_f32_16x16x32_bf16 v[148:151], a[96:99], v[112:115], v[148:151]
  v_mfma_f32_16x16x32_bf16 v[144:147], a[96:99], v[116:119], v[144:147]
  v_mfma_f32_16x16x32_bf16 v[156:159], a[100:103], v[112:115], v[156:159]
  v_mfma_f32_16x16x32_bf16 v[152:155], a[100:103], v[116:119], v[152:155]
  v_mfma_f32_16x16x32_bf16 v[164:167], a[104:107], v[112:115], v[164:167]
  v_mfma_f32_16x16x32_bf16 v[160:163], a[104:107], v[116:119], v[160:163]
  v_mfma_f32_16x16x32_bf16 v[172:175], a[108:111], v[112:115], v[172:175]
  v_mfma_f32_16x16x32_bf16 v[168:171], a[108:111], v[116:119], v[168:171]
  s_waitcnt vmcnt(4)
  v_mfma_f32_16x16x32_bf16 v[148:151], a[112:115], v[120:123], v[148:151]
  v_mfma_f32_16x16x32_bf16 v[144:147], a[112:115], v[124:127], v[144:147]
  v_mfma_f32_16x16x32_bf16 v[156:159], a[116:119], v[120:123], v[156:159]
  v_mfma_f32_16x16x32_bf16 v[152:155], a[116:119], v[124:127], v[152:155]
  v_mfma_f32_16x16x32_bf16 v[164:167], a[120:123], v[120:123], v[164:167]
  v_mfma_f32_16x16x32_bf16 v[160:163], a[120:123], v[124:127], v[160:163]
  v_mfma_f32_16x16x32_bf16 v[172:175], a[124:127], v[120:123], v[172:175]
  v_mfma_f32_16x16x32_bf16 v[168:171], a[124:127], v[124:127], v[168:171]
  s_waitcnt vmcnt(0)
  s_nop 1
  v_mfma_f32_16x16x32_bf16 v[144:147], v[48:51], v[136:139], v[144:147]
  v_mfma_f32_16x16x32_bf16 v[148:151], v[48:51], v[140:143], v[148:151]
  v_mfma_f32_16x16x32_bf16 v[152:155], v[52:55], v[136:139], v[152:155]
  v_mfma_f32_16x16x32_bf16 v[156:159], v[52:55], v[140:143], v[156:159]
  v_mfma_f32_16x16x32_bf16 v[160:163], v[56:59], v[136:139], v[160:163]
  v_mfma_f32_16x16x32_bf16 v[164:167], v[56:59], v[140:143], v[164:167]
  v_mfma_f32_16x16x32_bf16 v[168:171], v[60:63], v[136:139], v[168:171]
  v_mfma_f32_16x16x32_bf16 v[172:175], v[60:63], v[140:143], v[172:175]
  s_branch pve_255
pvt_262:
  s_sub_u32 s55, s52, 2048
  s_cmp_lg_u32 s20, 0
  s_cbranch_scc1 wm_266
  s_mov_b32 s101, 0
wm_265:
  buffer_load_dword v26, v7, s[72:75], s55 offen sc1
  s_add_u32 s101, s101, 1
  s_cmp_gt_u32 s101, 131072
  s_cbranch_scc1 main_end
  s_waitcnt vmcnt(0)
  v_cmp_gt_u32 vcc, 4, v26
  v_readfirstlane_b32 s100, v26
  s_nop 0
  s_cbranch_vccz wm_266
  s_sleep 4
  s_add_u32 s100, s100, 3
  s_cmp_ge_u32 s100, 4
  s_cbranch_scc1 wm_265
  s_sleep 24
  s_branch wm_265
wm_266:
  s_barrier
  s_mov_b32 s56, s47
  s_mov_b32 s57, s48
  buffer_load_dwordx4 v[64:67], v4, s[16:19], s56 offen sc1
  buffer_load_dwordx2 v[68:69], v5, s[16:19], s56 offen offset:2048 sc1
  buffer_load_dwordx4 v[128:131], v21, s[16:19], s56 offen offset:1024 sc1
  buffer_load_dwordx4 v[132:135], v21, s[16:19], s56 offen offset:1280 sc1
  s_add_u32 s56, s56, 2560
  buffer_load_dwordx4 v[72:75], v4, s[16:19], s56 offen sc1
  buffer_load_dwordx2 v[76:77], v5, s[16:19], s56 offen offset:2048 sc1
  s_add_u32 s56, s56, 2560
  buffer_load_dwordx4 v[80:83], v4, s[16:19], s56 offen sc1
  buffer_load_dwordx2 v[84:85], v5, s[16:19], s56 offen offset:2048 sc1
  s_add_u32 s56, s56, 2560
  buffer_load_dwordx4 v[88:91], v4, s[16:19], s56 offen sc1
  buffer_load_dwordx2 v[92:93], v5, s[16:19], s56 offen offset:2048 sc1
  s_add_u32 s56, s56, 2560
  buffer_load_dwordx4 v[32:35], v22, s[16:19], s57 offen offset:0 sc1
  buffer_load_dwordx4 v[36:39], v22, s[16:19], s57 offen offset:256 sc1
  buffer_load_dwordx4 v[40:43], v22, s[16:19], s57 offen offset:512 sc1
  buffer_load_dwordx4 v[44:47], v22, s[16:19], s57 offen offset:768 sc1
  s_add_u32 s57, s57, 40960
  buffer_load_dwordx4 v[96:99], v4, s[16:19], s56 offen sc1
  buffer_load_dwordx2 v[100:101], v5, s[16:19], s56 offen offset:2048 sc1
  buffer_load_dwordx4 v[136:139], v21, s[16:19], s56 offen offset:1024 sc1
  buffer_load_dwordx4 v[140:143], v21, s[16:19], s56 offen offset:1280 sc1
  s_add_u32 s56, s56, 2560
  buffer_load_dwordx4 v[104:107], v4, s[16:19], s56 offen sc1
  buffer_load_dwordx2 v[108:109], v5, s[16:19], s56 offen offset:2048 sc1
  s_add_u32 s56, s56, 2560
  buffer_load_dwordx4 v[112:115], v4, s[16:19], s56 offen sc1
  buffer_load_dwordx2 v[116:117], v5, s[16:19], s56 offen offset:2048 sc1
  s_add_u32 s56, s56, 2560
  buffer_load_dwordx4 v[120:123], v4, s[16:19], s56 offen sc1
  buffer_load_dwordx2 v[124:125], v5, s[16:19], s56 offen offset:2048 sc1
  s_add_u32 s56, s56, 2560
  buffer_load_dwordx4 v[48:51], v22, s[16:19], s57 offen offset:0 sc1
  buffer_load_dwordx4 v[52:55], v22, s[16:19], s57 offen offset:256 sc1
  buffer_load_dwordx4 v[56:59], v22, s[16:19], s57 offen offset:512 sc1
  buffer_load_dwordx4 v[60:63], v22, s[16:19], s57 offen offset:768 sc1
  s_add_u32 s57, s57, 40960
pvc_260:
  s_mov_b32 s101, 0
  s_waitcnt vmcnt(14)
  s_branch pvr_268
pvr_267:
  s_sleep 2
  s_add_u32 s56, s47, 0
  s_add_u32 s57, s48, 0
  buffer_load_dwordx4 v[64:67], v4, s[16:19], s56 offen sc1
  buffer_load_dwordx2 v[68:69], v5, s[16:19], s56 offen offset:2048 sc1
  buffer_load_dwordx4 v[128:131], v21, s[16:19], s56 offen offset:1024 sc1
  buffer_load_dwordx4 v[132:135], v21, s[16:19], s56 offen offset:1280 sc1
  s_add_u32 s56, s56, 2560
  buffer_load_dwordx4 v[72:75], v4, s[16:19], s56 offen sc1
  buffer_load_dwordx2 v[76:77], v5, s[16:19], s56 offen offset:2048 sc1
  s_add_u32 s56, s56, 2560
  buffer_load_dwordx4 v[80:83], v4, s[16:19], s56 offen sc1
  buffer_load_dwordx2 v[84:85], v5, s[16:19], s56 offen offset:2048 sc1
  s_add_u32 s56, s56, 2560
  buffer_load_dwordx4 v[88:91], v4, s[16:19], s56 offen sc1
  buffer_load_dwordx2 v[92:93], v5, s[16:19], s56 offen offset:2048 sc1
  s_add_u32 s56, s56, 2560
  buffer_load_dwordx4 v[32:35], v22, s[16:19], s57 offen offset:0 sc1
  buffer_load_dwordx4 v[36:39], v22, s[16:19], s57 offen offset:256 sc1
  buffer_load_dwordx4 v[40:43], v22, s[16:19], s57 offen offset:512 sc1
  buffer_load_dwordx4 v[44:47], v22, s[16:19], s57 offen offset:768 sc1
  s_add_u32 s57, s57, 40960
  s_add_u32 s101, s101, 1
  s_cmp_gt_u32 s101, 131072
  s_cbranch_scc1 main_end
  s_waitcnt vmcnt(0)
pvr_268:
  v_max3_u32 v26, v64, v68, v72
  v_max3_u32 v26, v26, v76, v80
  v_max3_u32 v26, v26, v84, v88
  v_max3_u32 v26, v26, v92, v128
  v_max3_u32 v26, v26, v132, v32
  v_max3_u32 v26, v26, v36, v40
  v_max3_u32 v26, v26, v44, v44
  v_cmp_eq_u32 vcc, -1, v26
  s_nop 1
  s_cbranch_vccnz pvr_267
  v_mfma_f32_16x16x32_bf16 v[148:151], a[0:3], v[64:67], 0
  v_mfma_f32_16x16x32_bf16 v[144:147], a[0:3], v[68:71], 0
  v_mfma_f32_16x16x32_bf16 v[156:159], a[4:7], v[64:67], 0
  v_mfma_f32_16x16x32_bf16 v[152:155], a[4:7], v[68:71], 0
  v_mfma_f32_16x16x32_bf16 v[164:167], a[8:11], v[64:67], 0
  v_mfma_f32_16x16x32_bf16 v[160:163], a[8:11], v[68:71], 0
  v_mfma_f32_16x16x32_bf16 v[172:175], a[12:15], v[64:67], 0
  v_mfma_f32_16x16x32_bf16 v[168:171], a[12:15], v[68:71], 0
  v_mfma_f32_16x16x32_bf16 v[148:151], a[16:19], v[72:75], v[148:151]
  v_mfma_f32_16x16x32_bf16 v[144:147], a[16:19], v[76:79], v[144:147]
  v_mfma_f32_16x16x32_bf16 v[156:159], a[20:23], v[72:75], v[156:159]
  v_mfma_f32_16x16x32_bf16 v[152:155], a[20:23], v[76:79], v[152:155]
  v_mfma_f32_16x16x32_bf16 v[164:167], a[24:27], v[72:75], v[164:167]
  v_mfma_f32_16x16x32_bf16 v[160:163], a[24:27], v[76:79], v[160:163]
  v_mfma_f32_16x16x32_bf16 v[172:175], a[28:31], v[72:75], v[172:175]
  v_mfma_f32_16x16x32_bf16 v[168:171], a[28:31], v[76:79], v[168:171]
  v_mfma_f32_16x16x32_bf16 v[148:151], a[32:35], v[80:83], v[148:151]
  v_mfma_f32_16x16x32_bf16 v[144:147], a[32:35], v[84:87], v[144:147]
  v_mfma_f32_16x16x32_bf16 v[156:159], a[36:39], v[80:83], v[156:159]
  v_mfma_f32_16x16x32_bf16 v[152:155], a[36:39], v[84:87], v[152:155]
  v_mfma_f32_16x16x32_bf16 v[164:167], a[40:43], v[80:83], v[164:167]
  v_mfma_f32_16x16x32_bf16 v[160:163], a[40:43], v[84:87], v[160:163]
  v_mfma_f32_16x16x32_bf16 v[172:175], a[44:47], v[80:83], v[172:175]
  v_mfma_f32_16x16x32_bf16 v[168:171], a[44:47], v[84:87], v[168:171]
  v_mfma_f32_16x16x32_bf16 v[148:151], a[48:51], v[88:91], v[148:151]
  v_mfma_f32_16x16x32_bf16 v[144:147], a[48:51], v[92:95], v[144:147]
  v_mfma_f32_16x16x32_bf16 v[156:159], a[52:55], v[88:91], v[156:159]
  v_mfma_f32_16x16x32_bf16 v[152:155], a[52:55], v[92:95], v[152:155]
  v_mfma_f32_16x16x32_bf16 v[164:167], a[56:59], v[88:91], v[164:167]
  v_mfma_f32_16x16x32_bf16 v[160:163], a[56:59], v[92:95], v[160:163]
  v_mfma_f32_16x16x32_bf16 v[172:175], a[60:63], v[88:91], v[172:175]
  v_mfma_f32_16x16x32_bf16 v[168:171], a[60:63], v[92:95], v[168:171]
  s_nop 1
  v_mfma_f32_16x16x32_bf16 v[144:147], v[32:35], v[128:131], v[144:147]
  v_mfma_f32_16x16x32_bf16 v[148:151], v[32:35], v[132:135], v[148:151]
  v_mfma_f32_16x16x32_bf16 v[152:155], v[36:39], v[128:131], v[152:155]
  v_mfma_f32_16x16x32_bf16 v[156:159], v[36:39], v[132:135], v[156:159]
  v_mfma_f32_16x16x32_bf16 v[160:163], v[40:43], v[128:131], v[160:163]
  v_mfma_f32_16x16x32_bf16 v[164:167], v[40:43], v[132:135], v[164:167]
  v_mfma_f32_16x16x32_bf16 v[168:171], v[44:47], v[128:131], v[168:171]
  v_mfma_f32_16x16x32_bf16 v[172:175], v[44:47], v[132:135], v[172:175]
  s_mov_b32 s101, 0
  s_waitcnt vmcnt(0)
  s_branch pvr_270
pvr_269:
  s_sleep 2
  s_add_u32 s56, s47, 10240
  s_add_u32 s57, s48, 40960
  buffer_load_dwordx4 v[96:99], v4, s[16:19], s56 offen sc1
  buffer_load_dwordx2 v[100:101], v5, s[16:19], s56 offen offset:2048 sc1
  buffer_load_dwordx4 v[136:139], v21, s[16:19], s56 offen offset:1024 sc1
  buffer_load_dwordx4 v[140:143], v21, s[16:19], s56 offen offset:1280 sc1
  s_add_u32 s56, s56, 2560
  buffer_load_dwordx4 v[104:107], v4, s[16:19], s56 offen sc1
  buffer_load_dwordx2 v[108:109], v5, s[16:19], s56 offen offset:2048 sc1
  s_add_u32 s56, s56, 2560
  buffer_load_dwordx4 v[112:115], v4, s[16:19], s56 offen sc1
  buffer_load_dwordx2 v[116:117], v5, s[16:19], s56 offen offset:2048 sc1
  s_add_u32 s56, s56, 2560
  buffer_load_dwordx4 v[120:123], v4, s[16:19], s56 offen sc1
  buffer_load_dwordx2 v[124:125], v5, s[16:19], s56 offen offset:2048 sc1
  s_add_u32 s56, s56, 2560
  buffer_load_dwordx4 v[48:51], v22, s[16:19], s57 offen offset:0 sc1
  buffer_load_dwordx4 v[52:55], v22, s[16:19], s57 offen offset:256 sc1
  buffer_load_dwordx4 v[56:59], v22, s[16:19], s57 offen offset:512 sc1
  buffer_load_dwordx4 v[60:63], v22, s[16:19], s57 offen offset:768 sc1
  s_add_u32 s57, s57, 40960
  s_add_u32 s101, s101, 1
  s_cmp_gt_u32 s101, 131072
  s_cbranch_scc1 main_end
  s_waitcnt vmcnt(0)
pvr_270:
  v_max3_u32 v26, v96, v100, v104
  v_max3_u32 v26, v26, v108, v112
  v_max3_u32 v26, v26, v116, v120
  v_max3_u32 v26, v26, v124, v136
  v_max3_u32 v26, v26, v140, v48
  v_max3_u32 v26, v26, v52, v56
  v_max3_u32 v26, v26, v60, v60
  v_cmp_eq_u32 vcc, -1, v26
  s_nop 1
  s_cbranch_vccnz pvr_269
  v_mfma_f32_16x16x32_bf16 v[148:151], a[64:67], v[96:99], v[148:151]
  v_mfma_f32_16x16x32_bf16 v[144:147], a[64:67], v[100:103], v[144:147]
  v_mfma_f32_16x16x32_bf16 v[156:159], a[68:71], v[96:99], v[156:159]
  v_mfma_f32_16x16x32_bf16 v[152:155], a[68:71], v[100:103], v[152:155]
  v_mfma_f32_16x16x32_bf16 v[164:167], a[72:75], v[96:99], v[164:167]
  v_mfma_f32_16x16x32_bf16 v[160:163], a[72:75], v[100:103], v[160:163]
  v_mfma_f32_16x16x32_bf16 v[172:175], a[76:79], v[96:99], v[172:175]
  v_mfma_f32_16x16x32_bf16 v[168:171], a[76:79], v[100:103], v[168:171]
  v_mfma_f32_16x16x32_bf16 v[148:151], a[80:83], v[104:107], v[148:151]
  v_mfma_f32_16x16x32_bf16 v[144:147], a[80:83], v[108:111], v[144:147]
  v_mfma_f32_16x16x32_bf16 v[156:159], a[84:87], v[104:107], v[156:159]
  v_mfma_f32_16x16x32_bf16 v[152:155], a[84:87], v[108:111], v[152:155]
  v_mfma_f32_16x16x32_bf16 v[164:167], a[88:91], v[104:107], v[164:167]
  v_mfma_f32_16x16x32_bf16 v[160:163], a[88:91], v[108:111], v[160:163]
  v_mfma_f32_16x16x32_bf16 v[172:175], a[92:95], v[104:107], v[172:175]
  v_mfma_f32_16x16x32_bf16 v[168:171], a[92:95], v[108:111], v[168:171]
  v_mfma_f32_16x16x32_bf16 v[148:151], a[96:99], v[112:115], v[148:151]
  v_mfma_f32_16x16x32_bf16 v[144:147], a[96:99], v[116:119], v[144:147]
  v_mfma_f32_16x16x32_bf16 v[156:159], a[100:103], v[112:115], v[156:159]
  v_mfma_f32_16x16x32_bf16 v[152:155], a[100:103], v[116:119], v[152:155]
  v_mfma_f32_16x16x32_bf16 v[164:167], a[104:107], v[112:115], v[164:167]
  v_mfma_f32_16x16x32_bf16 v[160:163], a[104:107], v[116:119], v[160:163]
  v_mfma_f32_16x16x32_bf16 v[172:175], a[108:111], v[112:115], v[172:175]
  v_mfma_f32_16x16x32_bf16 v[168:171], a[108:111], v[116:119], v[168:171]
  v_mfma_f32_16x16x32_bf16 v[148:151], a[112:115], v[120:123], v[148:151]
  v_mfma_f32_16x16x32_bf16 v[144:147], a[112:115], v[124:127], v[144:147]
  v_mfma_f32_16x16x32_bf16 v[156:159], a[116:119], v[120:123], v[156:159]
  v_mfma_f32_16x16x32_bf16 v[152:155], a[116:119], v[124:127], v[152:155]
  v_mfma_f32_16x16x32_bf16 v[164:167], a[120:123], v[120:123], v[164:167]
  v_mfma_f32_16x16x32_bf16 v[160:163], a[120:123], v[124:127], v[160:163]
  v_mfma_f32_16x16x32_bf16 v[172:175], a[124:127], v[120:123], v[172:175]
  v_mfma_f32_16x16x32_bf16 v[168:171], a[124:127], v[124:127], v[168:171]
  s_nop 1
  v_mfma_f32_16x16x32_bf16 v[144:147], v[48:51], v[136:139], v[144:147]
  v_mfma_f32_16x16x32_bf16 v[148:151], v[48:51], v[140:143], v[148:151]
  v_mfma_f32_16x16x32_bf16 v[152:155], v[52:55], v[136:139], v[152:155]
  v_mfma_f32_16x16x32_bf16 v[156:159], v[52:55], v[140:143], v[156:159]
  v_mfma_f32_16x16x32_bf16 v[160:163], v[56:59], v[136:139], v[160:163]
  v_mfma_f32_16x16x32_bf16 v[164:167], v[56:59], v[140:143], v[164:167]
  v_mfma_f32_16x16x32_bf16 v[168:171], v[60:63], v[136:139], v[168:171]
  v_mfma_f32_16x16x32_bf16 v[172:175], v[60:63], v[140:143], v[172:175]
pve_255:
  s_nop 0
  s_cmp_eq_u32 s65, 0
  s_cbranch_scc1 pvx_271
  s_add_u32 s41, s41, 1
  s_mul_i32 s53, s42, 40960
  s_lshl_b32 s22, s41, 12
  s_add_u32 s53, s53, s22
  s_mul_i32 s48, s42, 10240
  s_lshl_b32 s22, s41, 10
  s_add_u32 s48, s48, s22
  s_add_u32 s48, s48, 7340032
  buffer_load_dwordx4 v[32:35], v22, s[16:19], s48 offen offset:0 sc1
  buffer_load_dwordx4 v[36:39], v22, s[16:19], s48 offen offset:256 sc1
  buffer_load_dwordx4 v[40:43], v22, s[16:19], s48 offen offset:512 sc1
  buffer_load_dwordx4 v[44:47], v22, s[16:19], s48 offen offset:768 sc1
  s_add_u32 s48, s48, 40960
  buffer_load_dwordx4 v[48:51], v22, s[16:19], s48 offen offset:0 sc1
  buffer_load_dwordx4 v[52:55], v22, s[16:19], s48 offen offset:256 sc1
  buffer_load_dwordx4 v[56:59], v22, s[16:19], s48 offen offset:512 sc1
  buffer_load_dwordx4 v[60:63], v22, s[16:19], s48 offen offset:768 sc1
  s_add_u32 s48, s48, 40960
  buffer_load_dwordx4 a[0:3], v4, s[12:15], s53 offen offset:0 sc1
  buffer_load_dwordx4 a[4:7], v4, s[12:15], s53 offen offset:1024 sc1
  buffer_load_dwordx4 a[8:11], v4, s[12:15], s53 offen offset:2048 sc1
  buffer_load_dwordx4 a[12:15], v4, s[12:15], s53 offen offset:3072 sc1
  s_add_u32 s53, s53, 40960
  buffer_load_dwordx4 a[16:19], v4, s[12:15], s53 offen offset:0 sc1
  buffer_load_dwordx4 a[20:23], v4, s[12:15], s53 offen offset:1024 sc1
  buffer_load_dwordx4 a[24:27], v4, s[12:15], s53 offen offset:2048 sc1
  buffer_load_dwordx4 a[28:31], v4, s[12:15], s53 offen offset:3072 sc1
  s_add_u32 s53, s53, 40960
  buffer_load_dwordx4 a[32:35], v4, s[12:15], s53 offen offset:0 sc1
  buffer_load_dwordx4 a[36:39], v4, s[12:15], s53 offen offset:1024 sc1
  buffer_load_dwordx4 a[40:43], v4, s[12:15], s53 offen offset:2048 sc1
  buffer_load_dwordx4 a[44:47], v4, s[12:15], s53 offen offset:3072 sc1
  s_add_u32 s53, s53, 40960
  buffer_load_dwordx4 a[48:51], v4, s[12:15], s53 offen offset:0 sc1
  buffer_load_dwordx4 a[52:55], v4, s[12:15], s53 offen offset:1024 sc1
  buffer_load_dwordx4 a[56:59], v4, s[12:15], s53 offen offset:2048 sc1
  buffer_load_dwordx4 a[60:63], v4, s[12:15], s53 offen offset:3072 sc1
  s_add_u32 s53, s53, 40960
  buffer_load_dwordx4 a[64:67], v4, s[12:15], s53 offen offset:0 sc1
  buffer_load_dwordx4 a[68:71], v4, s[12:15], s53 offen offset:1024 sc1
  buffer_load_dwordx4 a[72:75], v4, s[12:15], s53 offen offset:2048 sc1
  buffer_load_dwordx4 a[76:79], v4, s[12:15], s53 offen offset:3072 sc1
  s_add_u32 s53, s53, 40960
  buffer_load_dwordx4 a[80:83], v4, s[12:15], s53 offen offset:0 sc1
  buffer_load_dwordx4 a[84:87], v4, s[12:15], s53 offen offset:1024 sc1
  buffer_load_dwordx4 a[88:91], v4, s[12:15], s53 offen offset:2048 sc1
  buffer_load_dwordx4 a[92:95], v4, s[12:15], s53 offen offset:3072 sc1
  s_add_u32 s53, s53, 40960
  buffer_load_dwordx4 a[96:99], v4, s[12:15], s53 offen offset:0 sc1
  buffer_load_dwordx4 a[100:103], v4, s[12:15], s53 offen offset:1024 sc1
  buffer_load_dwordx4 a[104:107], v4, s[12:15], s53 offen offset:2048 sc1
  buffer_load_dwordx4 a[108:111], v4, s[12:15], s53 offen offset:3072 sc1
  s_add_u32 s53, s53, 40960
  buffer_load_dwordx4 a[112:115], v4, s[12:15], s53 offen offset:0 sc1
  buffer_load_dwordx4 a[116:119], v4, s[12:15], s53 offen offset:1024 sc1
  buffer_load_dwordx4 a[120:123], v4, s[12:15], s53 offen offset:2048 sc1
  buffer_load_dwordx4 a[124:127], v4, s[12:15], s53 offen offset:3072 sc1
pvx_271:
  s_cmp_lg_u32 s20, 0
  s_cbranch_scc1 lc_272
  s_sub_u32 s21, s2, 450
  s_cmp_ge_u32 s21, 190
  s_cbranch_scc1 lc_272
  v_mov_b32 v29, 1
  s_mov_b64 exec, 1
  buffer_atomic_add v29, v28, s[32:35], 0 offen sc0 sc1
  s_mov_b64 exec, -1
lc_272:
  ds_write_b128 v10, v[144:147] offset:0
  ds_write_b128 v10, v[148:151] offset:1024
  ds_write_b128 v10, v[152:155] offset:2048
  ds_write_b128 v10, v[156:159] offset:3072
  ds_write_b128 v10, v[160:163] offset:4096
  ds_write_b128 v10, v[164:167] offset:5120
  ds_write_b128 v10, v[168:171] offset:6144
  ds_write_b128 v10, v[172:175] offset:7168
  s_cmp_lg_u32 s20, 0
  s_cbranch_scc1 pvq_275
  v_readfirstlane_b32 s21, v29
  s_mov_b32 s23, -1
  v_mov_b32 v213, s23
  s_mov_b64 exec, 1
  ds_write_b32 v30, v29
  ds_write_b32 v30, v213 offset:8
  s_mov_b64 exec, -1
pvq_275:
  s_waitcnt lgkmcnt(0)
  s_barrier
  ds_read_b128 v[176:179], v11 offset:0
  ds_read_b128 v[180:183], v11 offset:8192
  ds_read_b128 v[184:187], v11 offset:16384
  ds_read_b128 v[188:191], v11 offset:24576
  ds_read_b128 v[192:195], v11 offset:4096
  ds_read_b128 v[196:199], v11 offset:12288
  ds_read_b128 v[200:203], v11 offset:20480
  ds_read_b128 v[204:207], v11 offset:28672
  ds_read_b32 v23, v30
  ds_read_b32 v213, v30 offset:8
  s_cmp_ge_u32 s40, 32
  s_cbranch_scc1 pvr_278
  s_waitcnt lgkmcnt(6)
  v_pk_add_f32 v[176:177], v[176:177], v[180:181]
  v_pk_add_f32 v[184:185], v[184:185], v[188:189]
  v_pk_add_f32 v[178:179], v[178:179], v[182:183]
  v_pk_add_f32 v[186:187], v[186:187], v[190:191]
  v_pk_add_f32 v[176:177], v[176:177], v[184:185]
  v_pk_add_f32 v[178:179], v[178:179], v[186:187]
  buffer_store_dwordx4 v[176:179], v4, s[24:27], s54 offen offset:0 sc1
  s_waitcnt lgkmcnt(2)
  v_pk_add_f32 v[192:193], v[192:193], v[196:197]
  v_pk_add_f32 v[200:201], v[200:201], v[204:205]
  v_pk_add_f32 v[194:195], v[194:195], v[198:199]
  v_pk_add_f32 v[202:203], v[202:203], v[206:207]
  v_pk_add_f32 v[192:193], v[192:193], v[200:201]
  v_pk_add_f32 v[194:195], v[194:195], v[202:203]
  buffer_store_dwordx4 v[192:195], v4, s[24:27], s54 offen offset:2048 sc1
  s_lshr_b32 s71, s40, 2
  s_lshl_b32 s71, s71, 7
  s_add_u32 s71, s71, 104448
  s_branch pvr_279
pvr_278:
  s_waitcnt lgkmcnt(6)
  v_pk_add_f32 v[176:177], v[176:177], v[180:181]
  v_pk_add_f32 v[184:185], v[184:185], v[188:189]
  v_pk_add_f32 v[178:179], v[178:179], v[182:183]
  v_pk_add_f32 v[186:187], v[186:187], v[190:191]
  v_pk_add_f32 v[176:177], v[176:177], v[184:185]
  v_pk_add_f32 v[178:179], v[178:179], v[186:187]
  v_cvt_pk_bf16_f32 v26, v176, v177
  v_lshlrev_b32 v176, 16, v26
  v_and_b32 v177, 0xffff0000, v26
  v_mul_f32 v176, v176, v24
  v_mul_f32 v177, v177, v24
  v_cvt_pk_bf16_f32 v26, v176, v177
  v_lshlrev_b32 v176, 16, v26
  v_and_b32 v177, 0xffff0000, v26
  v_add_f32 v176, v176, v12
  v_add_f32 v177, v177, v13
  v_cvt_pk_bf16_f32 v180, v176, v177
  v_cvt_pk_bf16_f32 v26, v178, v179
  v_lshlrev_b32 v178, 16, v26
  v_and_b32 v179, 0xffff0000, v26
  v_mul_f32 v178, v178, v24
  v_mul_f32 v179, v179, v24
  v_cvt_pk_bf16_f32 v26, v178, v179
  v_lshlrev_b32 v178, 16, v26
  v_and_b32 v179, 0xffff0000, v26
  v_add_f32 v178, v178, v14
  v_add_f32 v179, v179, v15
  v_cvt_pk_bf16_f32 v181, v178, v179
  buffer_store_dwordx2 v[180:181], v9, s[8:11], s46 offen offset:0
  s_waitcnt lgkmcnt(2)
  v_pk_add_f32 v[192:193], v[192:193], v[196:197]
  v_pk_add_f32 v[200:201], v[200:201], v[204:205]
  v_pk_add_f32 v[194:195], v[194:195], v[198:199]
  v_pk_add_f32 v[202:203], v[202:203], v[206:207]
  v_pk_add_f32 v[192:193], v[192:193], v[200:201]
  v_pk_add_f32 v[194:195], v[194:195], v[202:203]
  v_cvt_pk_bf16_f32 v26, v192, v193
  v_lshlrev_b32 v192, 16, v26
  v_and_b32 v193, 0xffff0000, v26
  v_mul_f32 v192, v192, v24
  v_mul_f32 v193, v193, v24
  v_cvt_pk_bf16_f32 v26, v192, v193
  v_lshlrev_b32 v192, 16, v26
  v_and_b32 v193, 0xffff0000, v26
  v_add_f32 v192, v192, v16
  v_add_f32 v193, v193, v17
  v_cvt_pk_bf16_f32 v196, v192, v193
  v_cvt_pk_bf16_f32 v26, v194, v195
  v_lshlrev_b32 v194, 16, v26
  v_and_b32 v195, 0xffff0000, v26
  v_mul_f32 v194, v194, v24
  v_mul_f32 v195, v195, v24
  v_cvt_pk_bf16_f32 v26, v194, v195
  v_lshlrev_b32 v194, 16, v26
  v_and_b32 v195, 0xffff0000, v26
  v_add_f32 v194, v194, v18
  v_add_f32 v195, v195, v19
  v_cvt_pk_bf16_f32 v197, v194, v195
  buffer_store_dwordx2 v[196:197], v9, s[8:11], s46 offen offset:64
pvr_279:
pvy_280:
  s_cmp_eq_u32 s65, 0
  s_cbranch_scc1 pvy_281
  s_sub_u32 s65, s65, 1
  s_add_u32 s46, s46, 128
  s_add_u32 s54, s54, 4096
  s_cmp_lt_u32 s40, 32
  s_cselect_b32 s70, 0x80000000, s54
  buffer_load_dwordx4 v[12:15], v4, s[24:27], s70 offen sc1
  buffer_load_dwordx4 v[16:19], v4, s[24:27], s70 offen offset:2048 sc1
  buffer_load_dword v24, v6, s[28:31], s45 offen sc1
  s_waitcnt vmcnt(37) lgkmcnt(0)
  s_barrier
  s_nop 1
  v_mfma_f32_16x16x32_bf16 v[144:147], v[32:35], v[128:131], 0
  v_mfma_f32_16x16x32_bf16 v[148:151], v[32:35], v[132:135], 0
  v_mfma_f32_16x16x32_bf16 v[152:155], v[36:39], v[128:131], 0
  v_mfma_f32_16x16x32_bf16 v[156:159], v[36:39], v[132:135], 0
  v_mfma_f32_16x16x32_bf16 v[160:163], v[40:43], v[128:131], 0
  v_mfma_f32_16x16x32_bf16 v[164:167], v[40:43], v[132:135], 0
  v_mfma_f32_16x16x32_bf16 v[168:171], v[44:47], v[128:131], 0
  v_mfma_f32_16x16x32_bf16 v[172:175], v[44:47], v[132:135], 0
  v_mfma_f32_16x16x32_bf16 v[144:147], v[48:51], v[136:139], v[144:147]
  v_mfma_f32_16x16x32_bf16 v[148:151], v[48:51], v[140:143], v[148:151]
  v_mfma_f32_16x16x32_bf16 v[152:155], v[52:55], v[136:139], v[152:155]
  v_mfma_f32_16x16x32_bf16 v[156:159], v[52:55], v[140:143], v[156:159]
  v_mfma_f32_16x16x32_bf16 v[160:163], v[56:59], v[136:139], v[160:163]
  v_mfma_f32_16x16x32_bf16 v[164:167], v[56:59], v[140:143], v[164:167]
  v_mfma_f32_16x16x32_bf16 v[168:171], v[60:63], v[136:139], v[168:171]
  v_mfma_f32_16x16x32_bf16 v[172:175], v[60:63], v[140:143], v[172:175]
  s_waitcnt vmcnt(33)
  v_mfma_f32_16x16x32_bf16 v[148:151], a[0:3], v[64:67], v[148:151]
  v_mfma_f32_16x16x32_bf16 v[144:147], a[0:3], v[68:71], v[144:147]
  v_mfma_f32_16x16x32_bf16 v[156:159], a[4:7], v[64:67], v[156:159]
  v_mfma_f32_16x16x32_bf16 v[152:155], a[4:7], v[68:71], v[152:155]
  v_mfma_f32_16x16x32_bf16 v[164:167], a[8:11], v[64:67], v[164:167]
  v_mfma_f32_16x16x32_bf16 v[160:163], a[8:11], v[68:71], v[160:163]
  v_mfma_f32_16x16x32_bf16 v[172:175], a[12:15], v[64:67], v[172:175]
  v_mfma_f32_16x16x32_bf16 v[168:171], a[12:15], v[68:71], v[168:171]
  s_waitcnt vmcnt(29)
  v_mfma_f32_16x16x32_bf16 v[148:151], a[16:19], v[72:75], v[148:151]
  v_mfma_f32_16x16x32_bf16 v[144:147], a[16:19], v[76:79], v[144:147]
  v_mfma_f32_16x16x32_bf16 v[156:159], a[20:23], v[72:75], v[156:159]
  v_mfma_f32_16x16x32_bf16 v[152:155], a[20:23], v[76:79], v[152:155]
  v_mfma_f32_16x16x32_bf16 v[164:167], a[24:27], v[72:75], v[164:167]
  v_mfma_f32_16x16x32_bf16 v[160:163], a[24:27], v[76:79], v[160:163]
  v_mfma_f32_16x16x32_bf16 v[172:175], a[28:31], v[72:75], v[172:175]
  v_mfma_f32_16x16x32_bf16 v[168:171], a[28:31], v[76:79], v[168:171]
  s_waitcnt vmcnt(25)
  v_mfma_f32_16x16x32_bf16 v[148:151], a[32:35], v[80:83], v[148:151]
  v_mfma_f32_16x16x32_bf16 v[144:147], a[32:35], v[84:87], v[144:147]
  v_mfma_f32_16x16x32_bf16 v[156:159], a[36:39], v[80:83], v[156:159]
  v_mfma_f32_16x16x32_bf16 v[152:155], a[36:39], v[84:87], v[152:155]
  v_mfma_f32_16x16x32_bf16 v[164:167], a[40:43], v[80:83], v[164:167]
  v_mfma_f32_16x16x32_bf16 v[160:163], a[40:43], v[84:87], v[160:163]
  v_mfma_f32_16x16x32_bf16 v[172:175], a[44:47], v[80:83], v[172:175]
  v_mfma_f32_16x16x32_bf16 v[168:171], a[44:47], v[84:87], v[168:171]
  s_waitcnt vmcnt(21)
  v_mfma_f32_16x16x32_bf16 v[148:151], a[48:51], v[88:91], v[148:151]
  v_mfma_f32_16x16x32_bf16 v[144:147], a[48:51], v[92:95], v[144:147]
  v_mfma_f32_16x16x32_bf16 v[156:159], a[52:55], v[88:91], v[156:159]
  v_mfma_f32_16x16x32_bf16 v[152:155], a[52:55], v[92:95], v[152:155]
  v_mfma_f32_16x16x32_bf16 v[164:167], a[56:59], v[88:91], v[164:167]
  v_mfma_f32_16x16x32_bf16 v[160:163], a[56:59], v[92:95], v[160:163]
  v_mfma_f32_16x16x32_bf16 v[172:175], a[60:63], v[88:91], v[172:175]
  v_mfma_f32_16x16x32_bf16 v[168:171], a[60:63], v[92:95], v[168:171]
  s_waitcnt vmcnt(17)
  v_mfma_f32_16x16x32_bf16 v[148:151], a[64:67], v[96:99], v[148:151]
  v_mfma_f32_16x16x32_bf16 v[144:147], a[64:67], v[100:103], v[144:147]
  v_mfma_f32_16x16x32_bf16 v[156:159], a[68:71], v[96:99], v[156:159]
  v_mfma_f32_16x16x32_bf16 v[152:155], a[68:71], v[100:103], v[152:155]
  v_mfma_f32_16x16x32_bf16 v[164:167], a[72:75], v[96:99], v[164:167]
  v_mfma_f32_16x16x32_bf16 v[160:163], a[72:75], v[100:103], v[160:163]
  v_mfma_f32_16x16x32_bf16 v[172:175], a[76:79], v[96:99], v[172:175]
  v_mfma_f32_16x16x32_bf16 v[168:171], a[76:79], v[100:103], v[168:171]
  s_waitcnt vmcnt(13)
  v_mfma_f32_16x16x32_bf16 v[148:151], a[80:83], v[104:107], v[148:151]
  v_mfma_f32_16x16x32_bf16 v[144:147], a[80:83], v[108:111], v[144:147]
  v_mfma_f32_16x16x32_bf16 v[156:159], a[84:87], v[104:107], v[156:159]
  v_mfma_f32_16x16x32_bf16 v[152:155], a[84:87], v[108:111], v[152:155]
  v_mfma_f32_16x16x32_bf16 v[164:167], a[88:91], v[104:107], v[164:167]
  v_mfma_f32_16x16x32_bf16 v[160:163], a[88:91], v[108:111], v[160:163]
  v_mfma_f32_16x16x32_bf16 v[172:175], a[92:95], v[104:107], v[172:175]
  v_mfma_f32_16x16x32_bf16 v[168:171], a[92:95], v[108:111], v[168:171]
  s_waitcnt vmcnt(9)
  v_mfma_f32_16x16x32_bf16 v[148:151], a[96:99], v[112:115], v[148:151]
  v_mfma_f32_16x16x32_bf16 v[144:147], a[96:99], v[116:119], v[144:147]
  v_mfma_f32_16x16x32_bf16 v[156:159], a[100:103], v[112:115], v[156:159]
  v_mfma_f32_16x16x32_bf16 v[152:155], a[100:103], v[116:119], v[152:155]
  v_mfma_f32_16x16x32_bf16 v[164:167], a[104:107], v[112:115], v[164:167]
  v_mfma_f32_16x16x32_bf16 v[160:163], a[104:107], v[116:119], v[160:163]
  v_mfma_f32_16x16x32_bf16 v[172:175], a[108:111], v[112:115], v[172:175]
  v_mfma_f32_16x16x32_bf16 v[168:171], a[108:111], v[116:119], v[168:171]
  s_waitcnt vmcnt(5)
  v_mfma_f32_16x16x32_bf16 v[148:151], a[112:115], v[120:123], v[148:151]
  v_mfma_f32_16x16x32_bf16 v[144:147], a[112:115], v[124:127], v[144:147]
  v_mfma_f32_16x16x32_bf16 v[156:159], a[116:119], v[120:123], v[156:159]
  v_mfma_f32_16x16x32_bf16 v[152:155], a[116:119], v[124:127], v[152:155]
  v_mfma_f32_16x16x32_bf16 v[164:167], a[120:123], v[120:123], v[164:167]
  v_mfma_f32_16x16x32_bf16 v[160:163], a[120:123], v[124:127], v[160:163]
  v_mfma_f32_16x16x32_bf16 v[172:175], a[124:127], v[120:123], v[172:175]
  v_mfma_f32_16x16x32_bf16 v[168:171], a[124:127], v[124:127], v[168:171]
  s_waitcnt vmcnt(0)
  v_sub_f32 v25, 1.0, v24
  v_cvt_pk_bf16_f32 v26, v25, v25
  v_lshlrev_b32 v25, 16, v26
  v_cvt_pk_bf16_f32 v26, v12, v12
  v_lshlrev_b32 v12, 16, v26
  v_cvt_pk_bf16_f32 v26, v13, v13
  v_lshlrev_b32 v13, 16, v26
  v_cvt_pk_bf16_f32 v26, v14, v14
  v_lshlrev_b32 v14, 16, v26
  v_cvt_pk_bf16_f32 v26, v15, v15
  v_lshlrev_b32 v15, 16, v26
  v_cvt_pk_bf16_f32 v26, v16, v16
  v_lshlrev_b32 v16, 16, v26
  v_cvt_pk_bf16_f32 v26, v17, v17
  v_lshlrev_b32 v17, 16, v26
  v_cvt_pk_bf16_f32 v26, v18, v18
  v_lshlrev_b32 v18, 16, v26
  v_cvt_pk_bf16_f32 v26, v19, v19
  v_lshlrev_b32 v19, 16, v26
  v_mul_f32 v12, v12, v25
  v_cvt_pk_bf16_f32 v26, v12, v12
  v_lshlrev_b32 v12, 16, v26
  v_mul_f32 v13, v13, v25
  v_cvt_pk_bf16_f32 v26, v13, v13
  v_lshlrev_b32 v13, 16, v26
  v_mul_f32 v14, v14, v25
  v_cvt_pk_bf16_f32 v26, v14, v14
  v_lshlrev_b32 v14, 16, v26
  v_mul_f32 v15, v15, v25
  v_cvt_pk_bf16_f32 v26, v15, v15
  v_lshlrev_b32 v15, 16, v26
  v_mul_f32 v16, v16, v25
  v_cvt_pk_bf16_f32 v26, v16, v16
  v_lshlrev_b32 v16, 16, v26
  v_mul_f32 v17, v17, v25
  v_cvt_pk_bf16_f32 v26, v17, v17
  v_lshlrev_b32 v17, 16, v26
  v_mul_f32 v18, v18, v25
  v_cvt_pk_bf16_f32 v26, v18, v18
  v_lshlrev_b32 v18, 16, v26
  v_mul_f32 v19, v19, v25
  v_cvt_pk_bf16_f32 v26, v19, v19
  v_lshlrev_b32 v19, 16, v26
  s_cmp_eq_u32 s65, 0
  s_cbranch_scc1 pvx_282
  s_add_u32 s41, s41, 1
  s_mul_i32 s53, s42, 40960
  s_lshl_b32 s22, s41, 12
  s_add_u32 s53, s53, s22
  s_mul_i32 s48, s42, 10240
  s_lshl_b32 s22, s41, 10
  s_add_u32 s48, s48, s22
  s_add_u32 s48, s48, 7340032
  buffer_load_dwordx4 v[32:35], v22, s[16:19], s48 offen offset:0 sc1
  buffer_load_dwordx4 v[36:39], v22, s[16:19], s48 offen offset:256 sc1
  buffer_load_dwordx4 v[40:43], v22, s[16:19], s48 offen offset:512 sc1
  buffer_load_dwordx4 v[44:47], v22, s[16:19], s48 offen offset:768 sc1
  s_add_u32 s48, s48, 40960
  buffer_load_dwordx4 v[48:51], v22, s[16:19], s48 offen offset:0 sc1
  buffer_load_dwordx4 v[52:55], v22, s[16:19], s48 offen offset:256 sc1
  buffer_load_dwordx4 v[56:59], v22, s[16:19], s48 offen offset:512 sc1
  buffer_load_dwordx4 v[60:63], v22, s[16:19], s48 offen offset:768 sc1
  s_add_u32 s48, s48, 40960
  buffer_load_dwordx4 a[0:3], v4, s[12:15], s53 offen offset:0 sc1
  buffer_load_dwordx4 a[4:7], v4, s[12:15], s53 offen offset:1024 sc1
  buffer_load_dwordx4 a[8:11], v4, s[12:15], s53 offen offset:2048 sc1
  buffer_load_dwordx4 a[12:15], v4, s[12:15], s53 offen offset:3072 sc1
  s_add_u32 s53, s53, 40960
  buffer_load_dwordx4 a[16:19], v4, s[12:15], s53 offen offset:0 sc1
  buffer_load_dwordx4 a[20:23], v4, s[12:15], s53 offen offset:1024 sc1
  buffer_load_dwordx4 a[24:27], v4, s[12:15], s53 offen offset:2048 sc1
  buffer_load_dwordx4 a[28:31], v4, s[12:15], s53 offen offset:3072 sc1
  s_add_u32 s53, s53, 40960
  buffer_load_dwordx4 a[32:35], v4, s[12:15], s53 offen offset:0 sc1
  buffer_load_dwordx4 a[36:39], v4, s[12:15], s53 offen offset:1024 sc1
  buffer_load_dwordx4 a[40:43], v4, s[12:15], s53 offen offset:2048 sc1
  buffer_load_dwordx4 a[44:47], v4, s[12:15], s53 offen offset:3072 sc1
  s_add_u32 s53, s53, 40960
  buffer_load_dwordx4 a[48:51], v4, s[12:15], s53 offen offset:0 sc1
  buffer_load_dwordx4 a[52:55], v4, s[12:15], s53 offen offset:1024 sc1
  buffer_load_dwordx4 a[56:59], v4, s[12:15], s53 offen offset:2048 sc1
  buffer_load_dwordx4 a[60:63], v4, s[12:15], s53 offen offset:3072 sc1
  s_add_u32 s53, s53, 40960
  buffer_load_dwordx4 a[64:67], v4, s[12:15], s53 offen offset:0 sc1
  buffer_load_dwordx4 a[68:71], v4, s[12:15], s53 offen offset:1024 sc1
  buffer_load_dwordx4 a[72:75], v4, s[12:15], s53 offen offset:2048 sc1
  buffer_load_dwordx4 a[76:79], v4, s[12:15], s53 offen offset:3072 sc1
  s_add_u32 s53, s53, 40960
  buffer_load_dwordx4 a[80:83], v4, s[12:15], s53 offen offset:0 sc1
  buffer_load_dwordx4 a[84:87], v4, s[12:15], s53 offen offset:1024 sc1
  buffer_load_dwordx4 a[88:91], v4, s[12:15], s53 offen offset:2048 sc1
  buffer_load_dwordx4 a[92:95], v4, s[12:15], s53 offen offset:3072 sc1
  s_add_u32 s53, s53, 40960
  buffer_load_dwordx4 a[96:99], v4, s[12:15], s53 offen offset:0 sc1
  buffer_load_dwordx4 a[100:103], v4, s[12:15], s53 offen offset:1024 sc1
  buffer_load_dwordx4 a[104:107], v4, s[12:15], s53 offen offset:2048 sc1
  buffer_load_dwordx4 a[108:111], v4, s[12:15], s53 offen offset:3072 sc1
  s_add_u32 s53, s53, 40960
  buffer_load_dwordx4 a[112:115], v4, s[12:15], s53 offen offset:0 sc1
  buffer_load_dwordx4 a[116:119], v4, s[12:15], s53 offen offset:1024 sc1
  buffer_load_dwordx4 a[120:123], v4, s[12:15], s53 offen offset:2048 sc1
  buffer_load_dwordx4 a[124:127], v4, s[12:15], s53 offen offset:3072 sc1
pvx_282:
  ds_write_b128 v10, v[144:147] offset:0
  ds_write_b128 v10, v[148:151] offset:1024
  ds_write_b128 v10, v[152:155] offset:2048
  ds_write_b128 v10, v[156:159] offset:3072
  ds_write_b128 v10, v[160:163] offset:4096
  ds_write_b128 v10, v[164:167] offset:5120
  ds_write_b128 v10, v[168:171] offset:6144
  ds_write_b128 v10, v[172:175] offset:7168
  s_waitcnt lgkmcnt(0)
  s_barrier
  ds_read_b128 v[176:179], v11 offset:0
  ds_read_b128 v[180:183], v11 offset:8192
  ds_read_b128 v[184:187], v11 offset:16384
  ds_read_b128 v[188:191], v11 offset:24576
  ds_read_b128 v[192:195], v11 offset:4096
  ds_read_b128 v[196:199], v11 offset:12288
  ds_read_b128 v[200:203], v11 offset:20480
  ds_read_b128 v[204:207], v11 offset:28672
  s_cmp_ge_u32 s40, 32
  s_cbranch_scc1 pvr_283
  s_waitcnt lgkmcnt(4)
  v_pk_add_f32 v[176:177], v[176:177], v[180:181]
  v_pk_add_f32 v[184:185], v[184:185], v[188:189]
  v_pk_add_f32 v[178:179], v[178:179], v[182:183]
  v_pk_add_f32 v[186:187], v[186:187], v[190:191]
  v_pk_add_f32 v[176:177], v[176:177], v[184:185]
  v_pk_add_f32 v[178:179], v[178:179], v[186:187]
  buffer_store_dwordx4 v[176:179], v4, s[24:27], s54 offen offset:0 sc1
  s_waitcnt lgkmcnt(0)
  v_pk_add_f32 v[192:193], v[192:193], v[196:197]
  v_pk_add_f32 v[200:201], v[200:201], v[204:205]
  v_pk_add_f32 v[194:195], v[194:195], v[198:199]
  v_pk_add_f32 v[202:203], v[202:203], v[206:207]
  v_pk_add_f32 v[192:193], v[192:193], v[200:201]
  v_pk_add_f32 v[194:195], v[194:195], v[202:203]
  buffer_store_dwordx4 v[192:195], v4, s[24:27], s54 offen offset:2048 sc1
  s_lshr_b32 s71, s40, 2
  s_lshl_b32 s71, s71, 7
  s_add_u32 s71, s71, 104448
  s_branch pvr_284
pvr_283:
  s_waitcnt lgkmcnt(4)
  v_pk_add_f32 v[176:177], v[176:177], v[180:181]
  v_pk_add_f32 v[184:185], v[184:185], v[188:189]
  v_pk_add_f32 v[178:179], v[178:179], v[182:183]
  v_pk_add_f32 v[186:187], v[186:187], v[190:191]
  v_pk_add_f32 v[176:177], v[176:177], v[184:185]
  v_pk_add_f32 v[178:179], v[178:179], v[186:187]
  v_cvt_pk_bf16_f32 v26, v176, v177
  v_lshlrev_b32 v176, 16, v26
  v_and_b32 v177, 0xffff0000, v26
  v_mul_f32 v176, v176, v24
  v_mul_f32 v177, v177, v24
  v_cvt_pk_bf16_f32 v26, v176, v177
  v_lshlrev_b32 v176, 16, v26
  v_and_b32 v177, 0xffff0000, v26
  v_add_f32 v176, v176, v12
  v_add_f32 v177, v177, v13
  v_cvt_pk_bf16_f32 v180, v176, v177
  v_cvt_pk_bf16_f32 v26, v178, v179
  v_lshlrev_b32 v178, 16, v26
  v_and_b32 v179, 0xffff0000, v26
  v_mul_f32 v178, v178, v24
  v_mul_f32 v179, v179, v24
  v_cvt_pk_bf16_f32 v26, v178, v179
  v_lshlrev_b32 v178, 16, v26
  v_and_b32 v179, 0xffff0000, v26
  v_add_f32 v178, v178, v14
  v_add_f32 v179, v179, v15
  v_cvt_pk_bf16_f32 v181, v178, v179
  buffer_store_dwordx2 v[180:181], v9, s[8:11], s46 offen offset:0
  s_waitcnt lgkmcnt(0)
  v_pk_add_f32 v[192:193], v[192:193], v[196:197]
  v_pk_add_f32 v[200:201], v[200:201], v[204:205]
  v_pk_add_f32 v[194:195], v[194:195], v[198:199]
  v_pk_add_f32 v[202:203], v[202:203], v[206:207]
  v_pk_add_f32 v[192:193], v[192:193], v[200:201]
  v_pk_add_f32 v[194:195], v[194:195], v[202:203]
  v_cvt_pk_bf16_f32 v26, v192, v193
  v_lshlrev_b32 v192, 16, v26
  v_and_b32 v193, 0xffff0000, v26
  v_mul_f32 v192, v192, v24
  v_mul_f32 v193, v193, v24
  v_cvt_pk_bf16_f32 v26, v192, v193
  v_lshlrev_b32 v192, 16, v26
  v_and_b32 v193, 0xffff0000, v26
  v_add_f32 v192, v192, v16
  v_add_f32 v193, v193, v17
  v_cvt_pk_bf16_f32 v196, v192, v193
  v_cvt_pk_bf16_f32 v26, v194, v195
  v_lshlrev_b32 v194, 16, v26
  v_and_b32 v195, 0xffff0000, v26
  v_mul_f32 v194, v194, v24
  v_mul_f32 v195, v195, v24
  v_cvt_pk_bf16_f32 v26, v194, v195
  v_lshlrev_b32 v194, 16, v26
  v_and_b32 v195, 0xffff0000, v26
  v_add_f32 v194, v194, v18
  v_add_f32 v195, v195, v19
  v_cvt_pk_bf16_f32 v197, v194, v195
  buffer_store_dwordx2 v[196:197], v9, s[8:11], s46 offen offset:64
pvr_284:
  s_branch pvy_280
pvy_281:
  s_sub_u32 s21, s2, 450
  s_cmp_ge_u32 s21, 190
  s_cbranch_scc1 lc_285
  s_cmp_lg_u32 s20, 0
  s_cbranch_scc1 lc_285x
  s_waitcnt vmcnt(2)
  s_mov_b64 exec, 1
  ds_write_b32 v30, v29 offset:12
  s_mov_b64 exec, -1
lc_285x:
  s_waitcnt lgkmcnt(0)
  s_barrier
  ds_read_b32 v23, v30 offset:12
lc_285:
  s_waitcnt lgkmcnt(0)
  v_readfirstlane_b32 s2, v23
  v_readfirstlane_b32 s67, v213
  s_barrier
  s_cmp_lt_u32 s2, 350
  s_cbranch_scc1 pae_286
  s_waitcnt vmcnt(0)
  s_cmp_eq_u32 s71, 0
  s_cbranch_scc1 paf_287
  v_mov_b32 v25, 0
  v_mov_b32 v26, 1
  s_mov_b64 exec, 1
  buffer_atomic_add v26, v25, s[72:75], s71 offen sc1
  s_mov_b64 exec, -1
  s_mov_b32 s71, 0
paf_287:
pae_286:
  s_add_u32 s21, s2, 0
  s_cmp_lt_u32 s2, 350
  s_cbranch_scc1 pv_loop
  s_sub_u32 s2, s2, 350
  s_branch main_fin
  s_branch queue
main_fin:
  s_waitcnt vmcnt(0)
main_end:
  s_endpgm
code_end:
.section .rodata,"a"
.p2align 6
.amdhsa_kernel gated_mix__memory_aug_recurrent_mem_tr__sliding_local_dilated__prompt_kernel
  .amdhsa_next_free_vgpr 512
  .amdhsa_next_free_sgpr 102
  .amdhsa_accum_offset 256
  .amdhsa_group_segment_fixed_size 0
  .amdhsa_kernarg_size 112
  .amdhsa_user_sgpr_count 2
  .amdhsa_user_sgpr_kernarg_segment_ptr 1
  .amdhsa_system_sgpr_workgroup_id_x 1
.end_amdhsa_kernel
.text
```

```asm
; @launch kernel=gated_mix__memory_aug_recurrent_mem_tr__sliding_local_dilated__prompt_kernel grid=(256,1,1) block=(256,1,1) lds=163840
.amdgcn_target "amdgcn-amd-amdhsa--gfx950"
.text
.globl gated_mix__memory_aug_recurrent_mem_tr__sliding_local_dilated__prompt_kernel
.p2align 8
.type gated_mix__memory_aug_recurrent_mem_tr__sliding_local_dilated__prompt_kernel,@function
gated_mix__memory_aug_recurrent_mem_tr__sliding_local_dilated__prompt_kernel:
  s_cmp_ge_u32 s2, 256
  s_cbranch_scc1 end0
  s_load_dwordx2 s[4:5], s[0:1], 96
  s_load_dwordx2 s[38:39], s[0:1], 104
  v_lshrrev_b32 v1, 6, v0
  v_and_b32 v2, 15, v0
  v_readfirstlane_b32 s20, v1
  v_and_b32 v1, 63, v0
  v_lshrrev_b32 v3, 4, v1
  s_getreg_b32 s50, hwreg(HW_REG_XCC_ID)
  s_and_b32 s50, s50, 7
  s_waitcnt lgkmcnt(0)
  s_mov_b32 s32, s4
  s_mov_b32 s33, s5
  s_mov_b32 s34, 256
  s_mov_b32 s35, 0x00020000
  s_getpc_b64 s[6:7]
cpf_pc:
  s_sub_u32 s6, s6, cpf_pc - gated_mix__memory_aug_recurrent_mem_tr__sliding_local_dilated__prompt_kernel
  s_subb_u32 s7, s7, 0
  s_lshr_b32 s21, s2, 3
  s_lshl_b32 s21, s21, 12
  v_lshl_add_u32 v28, v0, 4, s21
  v_min_u32 v28, code_end - gated_mix__memory_aug_recurrent_mem_tr__sliding_local_dilated__prompt_kernel - 16, v28
  global_load_dwordx4 a[252:255], v28, s[6:7]
  v_mov_b32 v21, 0
  s_cmp_lg_u32 s20, 0
  s_cbranch_scc1 rk_1
  s_and_b32 s21, s50, 1
  s_lshl_b32 s21, s21, 7
  s_lshl_b32 s22, s50, 1
  s_and_b32 s22, s22, 12
  s_add_u32 s21, s21, s22
  v_mov_b32 v22, s21
  v_mov_b32 v23, 1
  s_mov_b64 exec, 1
  buffer_atomic_add v23, v22, s[32:35], 0 offen sc0 sc1
  s_waitcnt vmcnt(0)
  v_readfirstlane_b32 s51, v23
  s_lshl_b32 s22, s50, 5
  s_add_u32 s22, s22, s51
  s_cmp_lt_u32 s51, 32
  s_cbranch_scc1 rk_2
  v_mov_b32 v24, 72
  v_mov_b32 v25, 1
  buffer_atomic_add v25, v24, s[32:35], 0 offen sc0 sc1
  s_waitcnt vmcnt(0)
  v_readfirstlane_b32 s23, v25
  s_mov_b32 s101, 0
  s_mov_b64 exec, -1
  v_lshlrev_b32 v24, 2, v1
rk_3:
  s_sleep 8
  buffer_load_dword v25, v24, s[32:35], 0 offen sc1
  s_add_u32 s101, s101, 1
  s_cmp_gt_u32 s101, 131072
  s_cbranch_scc1 end0
  s_waitcnt vmcnt(0)
  v_readlane_b32 s21, v25, 0
  v_readlane_b32 s22, v25, 32
  s_add_u32 s21, s21, s22
  v_readlane_b32 s22, v25, 1
  s_add_u32 s21, s21, s22
  v_readlane_b32 s22, v25, 33
  s_add_u32 s21, s21, s22
  v_readlane_b32 s22, v25, 2
  s_add_u32 s21, s21, s22
  v_readlane_b32 s22, v25, 34
  s_add_u32 s21, s21, s22
  v_readlane_b32 s22, v25, 3
  s_add_u32 s21, s21, s22
  v_readlane_b32 s22, v25, 35
  s_add_u32 s21, s21, s22
  s_cmp_lt_u32 s21, 256
  s_cbranch_scc1 rk_3
  s_mov_b64 exec, 1
  s_mov_b32 s24, 0
rk_5:
  s_and_b32 s21, s24, 1
  s_lshl_b32 s21, s21, 5
  s_lshr_b32 s22, s24, 1
  s_add_u32 s21, s21, s22
  v_readlane_b32 s21, v25, s21
  s_min_u32 s21, s21, 32
  s_sub_u32 s25, 32, s21
  s_cmp_lt_u32 s23, s25
  s_cbranch_scc1 rk_4
  s_sub_u32 s23, s23, s25
  s_add_u32 s24, s24, 1
  s_cmp_lt_u32 s24, 8
  s_cbranch_scc1 rk_5
  s_branch end0
rk_4:
  s_lshl_b32 s22, s24, 5
  s_add_u32 s22, s22, s21
  s_add_u32 s22, s22, s23
  s_or_b32 s22, s22, 0x100
rk_2:
  v_mov_b32 v23, s22
  ds_write_b32 v21, v23
  s_waitcnt lgkmcnt(0)
  s_mov_b64 exec, -1
rk_1:
  s_barrier
  ds_read_b32 v23, v21
  s_waitcnt lgkmcnt(0)
  v_readfirstlane_b32 s22, v23
  s_barrier
  s_mov_b32 s84, 0
  s_mov_b32 s85, -1

  s_lshr_b32 s53, s22, 8
  s_and_b32 s22, s22, 255
  s_cmp_ge_u32 s22, 128
  s_cbranch_scc1 gemm_side
  s_lshr_b32 s50, s22, 4
  s_and_b32 s51, s22, 15
  s_mov_b32 s86, 0x3dd53b95
  s_load_dwordx2 s[4:5], s[0:1], 8
  s_load_dwordx4 s[36:39], s[0:1], 16
  s_load_dwordx4 s[40:43], s[0:1], 32
  s_load_dwordx2 s[44:45], s[0:1], 104
  s_lshr_b32 s55, s51, 2
  s_and_b32 s56, s51, 3
  s_lshl_b32 s57, s50, 2
  s_add_u32 s58, s57, s55
  s_add_u32 s59, s57, s20
  s_lshr_b32 s21, s51, 1
  s_xor_b32 s21, s21, s55
  s_andn2_b32 s21, 1, s21
  s_xor_b32 s85, s51, s21
  s_xor_b32 s84, s56, 1
  s_mul_i32 s87, s85, 5
  s_lshr_b32 s87, s87, 1
  s_and_b32 s79, s85, 1
  s_waitcnt lgkmcnt(0)
  s_add_u32 s8, s44, 78643200
  s_addc_u32 s9, s45, 0
  s_mov_b32 s10, 2162688
  s_mov_b32 s11, 0x00020000
  s_mov_b32 s16, s44
  s_mov_b32 s17, s45
  s_mov_b32 s18, 50331648
  s_mov_b32 s19, 0x00020000
  s_add_u32 s24, s44, 50331648
  s_addc_u32 s25, s45, 0
  s_mov_b32 s26, 63963136
  s_mov_b32 s27, 0x00020000
  s_mov_b32 s28, s4
  s_mov_b32 s29, s5
  s_mov_b32 s30, 10240
  s_mov_b32 s31, 0x00020000
  s_add_u32 s4, s44, 83886079
  s_addc_u32 s5, s45, 0
  s_and_b32 s4, s4, 0xffe00000
  s_mov_b32 s6, 2097152
  s_mov_b32 s7, 0x00020000
  v_mov_b32 v27, 10923
  v_add_u32 v103, 0, v1
  v_mul_u32_u24 v102, v103, v27
  v_lshrrev_b32 v102, 16, v102
  v_mul_u32_u24 v101, 6, v102
  v_sub_u32 v103, v103, v101
  v_bfe_u32 v101, v102, 1, 1
  v_mul_u32_u24 v101, 20, v101
  v_and_b32 v100, 1, v102
  v_add_u32 v101, v101, v100
  v_lshrrev_b32 v100, 3, v102
  v_mul_u32_u24 v100, 40, v100
  v_bfe_u32 v99, v102, 2, 1
  v_lshl_add_u32 v100, v99, 1, v100
  v_add_u32 v100, v100, v101
  v_mul_u32_u24 v100, 12288, v100
  v_lshl_add_u32 v46, v103, 4, v100
  v_lshrrev_b32 v100, 4, v102
  v_mul_u32_u24 v100, 40, v100
  v_bfe_u32 v99, v102, 2, 2
  v_lshl_add_u32 v100, v99, 1, v100
  v_add_u32 v100, v100, v101
  v_mul_u32_u24 v100, 12288, v100
  v_lshl_add_u32 v96, v103, 4, v100
  v_add_u32 v103, 64, v1
  v_mul_u32_u24 v102, v103, v27
  v_lshrrev_b32 v102, 16, v102
  v_mul_u32_u24 v101, 6, v102
  v_sub_u32 v103, v103, v101
  v_bfe_u32 v101, v102, 1, 1
  v_mul_u32_u24 v101, 20, v101
  v_and_b32 v100, 1, v102
  v_add_u32 v101, v101, v100
  v_lshrrev_b32 v100, 3, v102
  v_mul_u32_u24 v100, 40, v100
  v_bfe_u32 v99, v102, 2, 1
  v_lshl_add_u32 v100, v99, 1, v100
  v_add_u32 v100, v100, v101
  v_mul_u32_u24 v100, 12288, v100
  v_lshl_add_u32 v47, v103, 4, v100
  v_lshrrev_b32 v100, 4, v102
  v_mul_u32_u24 v100, 40, v100
  v_bfe_u32 v99, v102, 2, 2
  v_lshl_add_u32 v100, v99, 1, v100
  v_add_u32 v100, v100, v101
  v_mul_u32_u24 v100, 12288, v100
  v_lshl_add_u32 v97, v103, 4, v100
  v_add_u32 v103, 128, v1
  v_mul_u32_u24 v102, v103, v27
  v_lshrrev_b32 v102, 16, v102
  v_mul_u32_u24 v101, 6, v102
  v_sub_u32 v103, v103, v101
  v_bfe_u32 v101, v102, 1, 1
  v_mul_u32_u24 v101, 20, v101
  v_and_b32 v100, 1, v102
  v_add_u32 v101, v101, v100
  v_lshrrev_b32 v100, 3, v102
  v_mul_u32_u24 v100, 40, v100
  v_bfe_u32 v99, v102, 2, 1
  v_lshl_add_u32 v100, v99, 1, v100
  v_add_u32 v100, v100, v101
  v_mul_u32_u24 v100, 12288, v100
  v_lshl_add_u32 v48, v103, 4, v100
  v_lshrrev_b32 v100, 4, v102
  v_mul_u32_u24 v100, 40, v100
  v_bfe_u32 v99, v102, 2, 2
  v_lshl_add_u32 v100, v99, 1, v100
  v_add_u32 v100, v100, v101
  v_mul_u32_u24 v100, 12288, v100
  v_lshl_add_u32 v98, v103, 4, v100
  s_mul_i32 s80, s58, 384
  s_mul_i32 s22, s56, 96
  s_add_u32 s80, s80, s22
  s_mul_i32 s22, s20, 1966080
  s_add_u32 s80, s80, s22
  s_mul_i32 s88, s84, 96
  s_mul_i32 s21, s56, 96
  s_sub_u32 s88, s88, s21
  s_add_u32 s88, s88, s80
  s_mul_i32 s81, s20, 40448

  s_mul_i32 s82, s59, 245760
  s_lshl_b32 s22, s87, 5
  s_add_u32 s82, s82, s22
  s_mov_b32 s12, s38
  s_mov_b32 s13, s39
  s_mov_b32 s14, 7864320
  s_mov_b32 s15, 0x00020000
  s_add_u32 s21, s80, 0
  s_add_u32 s22, s81, 0
  s_add_u32 m0, s22, 0
  s_nop 0
  buffer_load_dwordx4 v96, s[12:15], s21 offen lds
  s_add_u32 m0, s22, 1024
  s_nop 0
  buffer_load_dwordx4 v97, s[12:15], s21 offen lds
  s_add_u32 m0, s22, 2048
  s_nop 0
  buffer_load_dwordx4 v98, s[12:15], s21 offen lds
  s_add_u32 s21, s80, 983040
  s_add_u32 s22, s81, 3072
  s_add_u32 m0, s22, 0
  s_nop 0
  buffer_load_dwordx4 v96, s[12:15], s21 offen lds
  s_add_u32 m0, s22, 1024
  s_nop 0
  buffer_load_dwordx4 v97, s[12:15], s21 offen lds
  s_add_u32 m0, s22, 2048
  s_nop 0
  buffer_load_dwordx4 v98, s[12:15], s21 offen lds
  s_add_u32 s21, s80, 98304
  s_add_u32 s22, s81, 6144
  s_add_u32 m0, s22, 0
  s_nop 0
  buffer_load_dwordx4 v96, s[12:15], s21 offen lds
  s_add_u32 m0, s22, 1024
  s_nop 0
  buffer_load_dwordx4 v97, s[12:15], s21 offen lds
  s_add_u32 m0, s22, 2048
  s_nop 0
  buffer_load_dwordx4 v98, s[12:15], s21 offen lds
  s_add_u32 s21, s80, 1081344
  s_add_u32 s22, s81, 9216
  s_add_u32 m0, s22, 0
  s_nop 0
  buffer_load_dwordx4 v96, s[12:15], s21 offen lds
  s_add_u32 m0, s22, 1024
  s_nop 0
  buffer_load_dwordx4 v97, s[12:15], s21 offen lds
  s_add_u32 m0, s22, 2048
  s_nop 0
  buffer_load_dwordx4 v98, s[12:15], s21 offen lds
  s_add_u32 s21, s80, 196608
  s_add_u32 s22, s81, 12288
  s_add_u32 m0, s22, 0
  s_nop 0
  buffer_load_dwordx4 v46, s[12:15], s21 offen lds
  s_add_u32 m0, s22, 1024
  s_nop 0
  buffer_load_dwordx4 v47, s[12:15], s21 offen lds
  s_add_u32 m0, s22, 2048
  s_nop 0
  buffer_load_dwordx4 v48, s[12:15], s21 offen lds
  s_mov_b32 s12, s40
  s_mov_b32 s13, s41
  s_mov_b32 s14, 7864320
  s_mov_b32 s15, 0x00020000
  s_add_u32 s21, s88, 0
  s_add_u32 s22, s81, 0
  buffer_load_dwordx4 v[128:131], v96, s[12:15], s21 offen
  buffer_load_dwordx4 v[132:135], v97, s[12:15], s21 offen
  buffer_load_dwordx4 v[136:139], v98, s[12:15], s21 offen
  s_add_u32 s21, s88, 983040
  s_add_u32 s22, s81, 3072
  buffer_load_dwordx4 v[140:143], v96, s[12:15], s21 offen
  buffer_load_dwordx4 v[144:147], v97, s[12:15], s21 offen
  buffer_load_dwordx4 v[148:151], v98, s[12:15], s21 offen
  s_add_u32 s21, s88, 98304
  s_add_u32 s22, s81, 6144
  buffer_load_dwordx4 v[152:155], v96, s[12:15], s21 offen
  buffer_load_dwordx4 v[156:159], v97, s[12:15], s21 offen
  buffer_load_dwordx4 v[160:163], v98, s[12:15], s21 offen
  s_add_u32 s21, s88, 1081344
  s_add_u32 s22, s81, 9216
  buffer_load_dwordx4 v[164:167], v96, s[12:15], s21 offen
  buffer_load_dwordx4 v[168:171], v97, s[12:15], s21 offen
  buffer_load_dwordx4 v[172:175], v98, s[12:15], s21 offen
  s_add_u32 s21, s88, 196608
  s_add_u32 s22, s81, 12288
  buffer_load_dwordx4 v[176:179], v46, s[12:15], s21 offen
  buffer_load_dwordx4 v[180:183], v47, s[12:15], s21 offen
  buffer_load_dwordx4 v[184:187], v48, s[12:15], s21 offen
  v_lshrrev_b32 v99, 2, v2
  v_lshl_add_u32 v99, v3, 3, v99
  v_mul_u32_u24 v99, 96, v99
  v_and_b32 v100, 3, v2
  v_lshlrev_b32 v100, 3, v100
  v_add3_u32 v99, v99, v100, s81
  v_lshlrev_b32 v100, 4, v1
  v_add_u32 v100, s81, v100
  v_and_b32 v236, 7, v2
  v_lshrrev_b32 v237, 3, v2
  v_lshlrev_b32 v238, 7, v3
  v_lshl_add_u32 v238, v236, 4, v238
  v_lshlrev_b32 v16, 4, v1
  v_mul_u32_u24 v244, 1280, v236
  s_mul_i32 s21, s20, 320
  v_add_u32 v244, s21, v244
  v_lshrrev_b32 v245, 3, v1
  v_mul_u32_u24 v245, 40, v245
  v_add_u32 v244, v244, v245
  s_lshr_b32 s21, s20, 1
  s_lshl_b32 s21, s21, 14
  s_and_b32 s22, s20, 1
  s_mul_i32 s22, s22, 3072
  s_add_u32 s21, s21, s22
  v_add_u32 v4, s21, v16
  v_mov_b32 v239, 0x4444
  v_mov_b32 v240, 0xeeee
  v_cmp_eq_u32 vcc, 1, v237
  s_nop 1
  v_cndmask_b32 v44, v239, v240, vcc
  v_cmp_gt_u32 vcc, 2, v3
  s_nop 1
  v_cndmask_b32 v89, 0, 1.0, vcc
  v_mul_u32_u24 v239, 40, v2
  v_lshl_add_u32 v239, v3, 3, v239
  s_mul_i32 s21, s20, 3200
  v_add_u32 v5, s21, v239
  v_lshrrev_b32 v239, 2, v1
  v_mul_u32_u24 v239, 40, v239
  v_and_b32 v240, 3, v1
  v_lshl_add_u32 v6, v240, 3, v239
  v_bfe_u32 v240, v1, 1, 1
  v_mul_u32_u24 v240, 6384, v240
  v_add_u32 v45, v6, v240
  s_lshl_b32 s21, s50, 4
  s_add_u32 s21, s21, s51
  s_lshl_b32 s21, s21, 9
  s_lshl_b32 s22, s20, 7
  s_add_u32 s21, s21, s22
  s_add_u32 s21, s21, 81920
  v_and_b32 v239, 1, v3
  v_lshlrev_b32 v239, 8, v239
  v_lshl_add_u32 v239, v236, 4, v239
  v_lshrrev_b32 v240, 1, v3
  v_lshl_add_u32 v239, v240, 3, v239
  v_add_u32 v7, s21, v239
  s_lshl_b32 s22, s58, 9
  s_lshl_b32 s23, s56, 7
  s_add_u32 s22, s22, s23
  s_add_u32 s22, s22, 376704
  v_lshlrev_b32 v239, 6, v3
  v_lshl_add_u32 v239, v236, 3, v239
  v_add_u32 v239, s22, v239
  s_cmp_eq_u32 s20, 2
  s_cselect_b64 vcc, -1, 0
  v_cndmask_b32 v7, v7, v239, vcc
  s_lshl_b32 s21, s59, 11
  s_add_u32 s21, s21, 81920
  v_add_u32 v8, s21, v16
  s_lshl_b32 s21, s59, 9
  s_add_u32 s21, s21, 376832
  v_lshl_add_u32 v9, v1, 3, s21
  s_mul_i32 s21, s59, 3072
  s_add_u32 s21, s21, 278528
  v_and_b32 v239, 0x39, v1
  v_bfe_u32 v240, v1, 1, 1
  v_lshl_or_b32 v239, v240, 2, v239
  v_bfe_u32 v240, v1, 2, 1
  v_lshl_or_b32 v239, v240, 1, v239
  v_lshl_add_u32 v10, v239, 4, s21
  s_cmp_eq_u32 s20, 3
  s_cselect_b32 s22, s84, s56
  s_mul_i32 s22, s22, 12
  v_add_u32 v239, s22, v3
  v_add3_u32 v240, 0, v239, v3
  v_lshrrev_b32 v241, 1, v240
  v_and_b32 v240, 1, v240
  v_lshlrev_b32 v240, 3, v240
  v_lshl_add_u32 v242, v241, 7, v240
  v_lshl_add_u32 v242, v236, 4, v242
  s_mul_i32 s21, s58, 3072
  v_add_u32 v21, s21, v242
  v_lshl_add_u32 v242, v241, 8, v240
  v_lshl_add_u32 v242, v2, 4, v242
  s_mul_i32 s21, s58, 12288
  s_and_b32 s22, s20, 1
  s_mul_i32 s22, s22, 6144
  s_add_u32 s21, s21, s22
  v_add_u32 v18, s21, v242
  v_add3_u32 v240, 1, v239, v3
  v_lshrrev_b32 v241, 1, v240
  v_and_b32 v240, 1, v240
  v_lshlrev_b32 v240, 3, v240
  v_lshl_add_u32 v242, v241, 7, v240
  v_lshl_add_u32 v242, v236, 4, v242
  s_mul_i32 s21, s58, 3072
  v_add_u32 v22, s21, v242
  v_lshl_add_u32 v242, v241, 8, v240
  v_lshl_add_u32 v242, v2, 4, v242
  s_mul_i32 s21, s58, 12288
  s_and_b32 s22, s20, 1
  s_mul_i32 s22, s22, 6144
  s_add_u32 s21, s21, s22
  v_add_u32 v19, s21, v242
  v_add_u32 v240, 8, v239
  v_lshrrev_b32 v241, 1, v240
  v_and_b32 v240, 1, v240
  v_lshlrev_b32 v240, 3, v240
  v_lshl_add_u32 v242, v241, 7, v240
  v_lshl_add_u32 v242, v236, 4, v242
  s_mul_i32 s21, s58, 3072
  v_add_u32 v23, s21, v242
  v_lshl_add_u32 v242, v241, 8, v240
  v_lshl_add_u32 v242, v2, 4, v242
  s_mul_i32 s21, s58, 12288
  s_and_b32 s22, s20, 1
  s_mul_i32 s22, s22, 6144
  s_add_u32 s21, s21, s22
  v_add_u32 v20, s21, v242
  v_cmp_eq_u32 vcc, 1, v237
  s_nop 1
  v_cndmask_b32 v25, v21, v22, vcc
  v_add_u32 v24, 278528, v25
  s_mul_i32 s21, s20, 3072
  s_add_u32 s21, s21, 22528
  v_add_u32 v11, s21, v16
  v_and_b32 v239, 3, v1
  s_lshl_b32 s21, s20, 2
  v_add_u32 v240, s21, v239
  v_cmp_eq_u32 vcc, 10, v240
  s_nop 1
  v_cndmask_b32 v240, v240, 7, vcc
  v_cmp_eq_u32 vcc, 3, v239
  v_lshrrev_b32 v241, 5, v1
  v_mul_u32_u24 v241, 10, v241
  v_cndmask_b32 v240, v240, 3, vcc
  s_lshl_b32 s21, s79, 2
  v_add3_u32 v240, v240, v241, s21
  v_lshrrev_b32 v241, 1, v240
  v_lshlrev_b32 v241, 8, v241
  v_and_b32 v240, 1, v240
  v_lshl_add_u32 v241, v240, 3, v241
  v_bfe_u32 v240, v1, 2, 3
  v_lshl_add_u32 v241, v240, 4, v241
  v_add_u32 v12, 22528, v241
  s_mov_b32 s21, 0x07060100
  s_cmp_eq_u32 s20, 1
  s_cselect_b32 s21, 0x07060302, s21
  s_cmp_eq_u32 s20, 2
  s_cselect_b32 s21, 0x07060c0c, s21
  v_mov_b32 v240, s21
  v_mov_b32 v241, 0x03020100
  v_cndmask_b32 v14, v241, v240, vcc
  s_lshr_b32 s21, s85, 3
  s_lshl_b32 s21, s21, 14
  s_bfe_u32 s22, s85, 0x10002
  s_mul_i32 s22, s22, 3072
  s_add_u32 s21, s21, s22
  s_and_b32 s22, s85, 3
  s_lshl_b32 s22, s22, 8
  s_add_u32 s21, s21, s22
  s_lshl_b32 s22, s20, 10
  s_add_u32 s22, s22, s21
  v_lshl_add_u32 v13, v1, 2, s22
  v_lshlrev_b32 v240, 10, v3
  v_lshl_add_u32 v240, v2, 4, v240
  v_add_u32 v240, s21, v240
  s_cmp_eq_u32 s20, 3
  s_cselect_b64 vcc, -1, 0
  v_cndmask_b32 v13, v13, v240, vcc
  s_mov_b32 s91, 0x3c000000
  v_and_b32 v240, 1, v3
  v_lshrrev_b32 v241, 1, v3
  v_lshl_add_u32 v240, v240, 1, v241
  v_lshlrev_b32 v240, 8, v240
  v_lshl_add_u32 v240, v2, 4, v240
  s_mul_i32 s21, s59, 10240
  s_lshl_b32 s22, s87, 8
  s_add_u32 s21, s21, s22
  v_add_u32 v15, s21, v240
  s_lshl_b32 s21, s79, 4
  s_lshl_b32 s76, -1, s21
  s_mov_b32 s77, 0xffff
  s_lshl_b32 s21, s79, 7
  v_or_b32 v17, s21, v16
  s_or_b32 s21, s21, 0xffffff7f
  v_and_b32 v26, s21, v16
  v_mov_b32 v243, 0
  s_mul_i32 s89, s59, 12288
  s_add_u32 s89, s89, 25165824
  v_cmp_gt_u32 s[60:61], 8, v2
  v_cmp_le_u32 s[62:63], 8, v2
  v_cmp_le_u32 s[72:73], 2, v3
  v_cmp_gt_u32 s[70:71], 48, v1
  s_nop 1
  s_and_b64 s[64:65], s[60:61], s[72:73]
  s_cmp_eq_u32 s20, 2
  s_cselect_b64 s[74:75], s[64:65], s[60:61]
  s_mul_i32 s89, s59, 12288
  s_add_u32 s89, s89, 25165824
  s_not_b64 s[48:49], s[72:73]
  v_mov_b32 v27, 10923
  v_mov_b32 v49, v100
  v_add_u32 v113, 576, v1
  v_mul_u32_u24 v103, v113, v27
  v_lshrrev_b32 v103, 16, v103
  v_mul_u32_u24 v102, 6, v103
  v_sub_u32 v113, v113, v102
  v_bfe_u32 v102, v103, 1, 1
  v_lshlrev_b32 v102, 3, v102
  v_and_b32 v127, 12, v103
  v_lshrrev_b32 v127, 1, v127
  v_and_b32 v103, 0xfffffff1, v103
  v_or3_b32 v103, v103, v102, v127
  v_mul_u32_u24 v102, 1366, v103
  v_lshrrev_b32 v102, 16, v102
  v_mul_u32_u24 v100, 48, v102
  v_sub_u32 v103, v103, v100
  v_cmp_gt_u32 vcc, 32, v103
  v_bfe_u32 v101, v103, 3, 2
  v_and_b32 v126, 3, v103
  v_lshl_add_u32 v126, v101, 2, v126
  v_bfe_u32 v101, v103, 2, 1
  v_lshl_add_u32 v126, v101, 4, v126
  v_cndmask_b32 v103, v103, v126, vcc
  v_add_u32 v100, v100, v103
  v_mul_u32_u24 v100, 1280, v100
  v_lshl_add_u32 v113, v113, 4, v100
  v_add_u32 v114, 640, v1
  v_mul_u32_u24 v103, v114, v27
  v_lshrrev_b32 v103, 16, v103
  v_mul_u32_u24 v102, 6, v103
  v_sub_u32 v114, v114, v102
  v_bfe_u32 v102, v103, 1, 1
  v_lshlrev_b32 v102, 3, v102
  v_and_b32 v127, 12, v103
  v_lshrrev_b32 v127, 1, v127
  v_and_b32 v103, 0xfffffff1, v103
  v_or3_b32 v103, v103, v102, v127
  v_mul_u32_u24 v102, 1366, v103
  v_lshrrev_b32 v102, 16, v102
  v_mul_u32_u24 v100, 48, v102
  v_sub_u32 v103, v103, v100
  v_cmp_gt_u32 vcc, 32, v103
  v_bfe_u32 v101, v103, 3, 2
  v_and_b32 v126, 3, v103
  v_lshl_add_u32 v126, v101, 2, v126
  v_bfe_u32 v101, v103, 2, 1
  v_lshl_add_u32 v126, v101, 4, v126
  v_cndmask_b32 v103, v103, v126, vcc
  v_add_u32 v100, v100, v103
  v_mul_u32_u24 v100, 1280, v100
  v_lshl_add_u32 v114, v114, 4, v100
  v_add_u32 v115, 704, v1
  v_mul_u32_u24 v103, v115, v27
  v_lshrrev_b32 v103, 16, v103
  v_mul_u32_u24 v102, 6, v103
  v_sub_u32 v115, v115, v102
  v_bfe_u32 v102, v103, 1, 1
  v_lshlrev_b32 v102, 3, v102
  v_and_b32 v127, 12, v103
  v_lshrrev_b32 v127, 1, v127
  v_and_b32 v103, 0xfffffff1, v103
  v_or3_b32 v103, v103, v102, v127
  v_mul_u32_u24 v102, 1366, v103
  v_lshrrev_b32 v102, 16, v102
  v_mul_u32_u24 v100, 48, v102
  v_sub_u32 v103, v103, v100
  v_cmp_gt_u32 vcc, 32, v103
  v_bfe_u32 v101, v103, 3, 2
  v_and_b32 v126, 3, v103
  v_lshl_add_u32 v126, v101, 2, v126
  v_bfe_u32 v101, v103, 2, 1
  v_lshl_add_u32 v126, v101, 4, v126
  v_cndmask_b32 v103, v103, v126, vcc
  v_add_u32 v100, v100, v103
  v_mul_u32_u24 v100, 1280, v100
  v_lshl_add_u32 v115, v115, 4, v100
  v_add_u32 v116, 768, v1
  v_mul_u32_u24 v103, v116, v27
  v_lshrrev_b32 v103, 16, v103
  v_mul_u32_u24 v102, 6, v103
  v_sub_u32 v116, v116, v102
  v_bfe_u32 v102, v103, 1, 1
  v_lshlrev_b32 v102, 3, v102
  v_and_b32 v127, 12, v103
  v_lshrrev_b32 v127, 1, v127
  v_and_b32 v103, 0xfffffff1, v103
  v_or3_b32 v103, v103, v102, v127
  v_mul_u32_u24 v102, 1366, v103
  v_lshrrev_b32 v102, 16, v102
  v_mul_u32_u24 v100, 48, v102
  v_sub_u32 v103, v103, v100
  v_cmp_gt_u32 vcc, 32, v103
  v_bfe_u32 v101, v103, 3, 2
  v_and_b32 v126, 3, v103
  v_lshl_add_u32 v126, v101, 2, v126
  v_bfe_u32 v101, v103, 2, 1
  v_lshl_add_u32 v126, v101, 4, v126
  v_cndmask_b32 v103, v103, v126, vcc
  v_add_u32 v100, v100, v103
  v_mul_u32_u24 v100, 1280, v100
  v_lshl_add_u32 v116, v116, 4, v100
  v_add_u32 v117, 832, v1
  v_mul_u32_u24 v103, v117, v27
  v_lshrrev_b32 v103, 16, v103
  v_mul_u32_u24 v102, 6, v103
  v_sub_u32 v117, v117, v102
  v_bfe_u32 v102, v103, 1, 1
  v_lshlrev_b32 v102, 3, v102
  v_and_b32 v127, 12, v103
  v_lshrrev_b32 v127, 1, v127
  v_and_b32 v103, 0xfffffff1, v103
  v_or3_b32 v103, v103, v102, v127
  v_mul_u32_u24 v102, 1366, v103
  v_lshrrev_b32 v102, 16, v102
  v_mul_u32_u24 v100, 48, v102
  v_sub_u32 v103, v103, v100
  v_cmp_gt_u32 vcc, 32, v103
  v_bfe_u32 v101, v103, 3, 2
  v_and_b32 v126, 3, v103
  v_lshl_add_u32 v126, v101, 2, v126
  v_bfe_u32 v101, v103, 2, 1
  v_lshl_add_u32 v126, v101, 4, v126
  v_cndmask_b32 v103, v103, v126, vcc
  v_add_u32 v100, v100, v103
  v_mul_u32_u24 v100, 1280, v100
  v_lshl_add_u32 v117, v117, 4, v100
  v_add_u32 v118, 896, v1
  v_mul_u32_u24 v103, v118, v27
  v_lshrrev_b32 v103, 16, v103
  v_mul_u32_u24 v102, 6, v103
  v_sub_u32 v118, v118, v102
  v_bfe_u32 v102, v103, 1, 1
  v_lshlrev_b32 v102, 3, v102
  v_and_b32 v127, 12, v103
  v_lshrrev_b32 v127, 1, v127
  v_and_b32 v103, 0xfffffff1, v103
  v_or3_b32 v103, v103, v102, v127
  v_mul_u32_u24 v102, 1366, v103
  v_lshrrev_b32 v102, 16, v102
  v_mul_u32_u24 v100, 48, v102
  v_sub_u32 v103, v103, v100
  v_cmp_gt_u32 vcc, 32, v103
  v_bfe_u32 v101, v103, 3, 2
  v_and_b32 v126, 3, v103
  v_lshl_add_u32 v126, v101, 2, v126
  v_bfe_u32 v101, v103, 2, 1
  v_lshl_add_u32 v126, v101, 4, v126
  v_cndmask_b32 v103, v103, v126, vcc
  v_add_u32 v100, v100, v103
  v_mul_u32_u24 v100, 1280, v100
  v_lshl_add_u32 v118, v118, 4, v100
  v_add_u32 v119, 960, v1
  v_mul_u32_u24 v103, v119, v27
  v_lshrrev_b32 v103, 16, v103
  v_mul_u32_u24 v102, 6, v103
  v_sub_u32 v119, v119, v102
  v_bfe_u32 v102, v103, 1, 1
  v_lshlrev_b32 v102, 3, v102
  v_and_b32 v127, 12, v103
  v_lshrrev_b32 v127, 1, v127
  v_and_b32 v103, 0xfffffff1, v103
  v_or3_b32 v103, v103, v102, v127
  v_mul_u32_u24 v102, 1366, v103
  v_lshrrev_b32 v102, 16, v102
  v_mul_u32_u24 v100, 48, v102
  v_sub_u32 v103, v103, v100
  v_cmp_gt_u32 vcc, 32, v103
  v_bfe_u32 v101, v103, 3, 2
  v_and_b32 v126, 3, v103
  v_lshl_add_u32 v126, v101, 2, v126
  v_bfe_u32 v101, v103, 2, 1
  v_lshl_add_u32 v126, v101, 4, v126
  v_cndmask_b32 v103, v103, v126, vcc
  v_add_u32 v100, v100, v103
  v_mul_u32_u24 v100, 1280, v100
  v_lshl_add_u32 v119, v119, 4, v100
  v_add_u32 v120, 1024, v1
  v_mul_u32_u24 v103, v120, v27
  v_lshrrev_b32 v103, 16, v103
  v_mul_u32_u24 v102, 6, v103
  v_sub_u32 v120, v120, v102
  v_bfe_u32 v102, v103, 1, 1
  v_lshlrev_b32 v102, 3, v102
  v_and_b32 v127, 12, v103
  v_lshrrev_b32 v127, 1, v127
  v_and_b32 v103, 0xfffffff1, v103
  v_or3_b32 v103, v103, v102, v127
  v_mul_u32_u24 v102, 1366, v103
  v_lshrrev_b32 v102, 16, v102
  v_mul_u32_u24 v100, 48, v102
  v_sub_u32 v103, v103, v100
  v_cmp_gt_u32 vcc, 32, v103
  v_bfe_u32 v101, v103, 3, 2
  v_and_b32 v126, 3, v103
  v_lshl_add_u32 v126, v101, 2, v126
  v_bfe_u32 v101, v103, 2, 1
  v_lshl_add_u32 v126, v101, 4, v126
  v_cndmask_b32 v103, v103, v126, vcc
  v_add_u32 v100, v100, v103
  v_mul_u32_u24 v100, 1280, v100
  v_lshl_add_u32 v120, v120, 4, v100
  v_add_u32 v121, 1088, v1
  v_mul_u32_u24 v103, v121, v27
  v_lshrrev_b32 v103, 16, v103
  v_mul_u32_u24 v102, 6, v103
  v_sub_u32 v121, v121, v102
  v_bfe_u32 v102, v103, 1, 1
  v_lshlrev_b32 v102, 3, v102
  v_and_b32 v127, 12, v103
  v_lshrrev_b32 v127, 1, v127
  v_and_b32 v103, 0xfffffff1, v103
  v_or3_b32 v103, v103, v102, v127
  v_mul_u32_u24 v102, 1366, v103
  v_lshrrev_b32 v102, 16, v102
  v_mul_u32_u24 v100, 48, v102
  v_sub_u32 v103, v103, v100
  v_cmp_gt_u32 vcc, 32, v103
  v_bfe_u32 v101, v103, 3, 2
  v_and_b32 v126, 3, v103
  v_lshl_add_u32 v126, v101, 2, v126
  v_bfe_u32 v101, v103, 2, 1
  v_lshl_add_u32 v126, v101, 4, v126
  v_cndmask_b32 v103, v103, v126, vcc
  v_add_u32 v100, v100, v103
  v_mul_u32_u24 v100, 1280, v100
  v_lshl_add_u32 v121, v121, 4, v100
  s_waitcnt vmcnt(63)
  s_mov_b32 s12, s42
  s_mov_b32 s13, s43
  s_mov_b32 s14, 7864320
  s_mov_b32 s15, 0x00020000
  buffer_load_dwordx4 v[188:191], v113, s[12:15], s82 offen
  buffer_load_dwordx4 v[192:195], v114, s[12:15], s82 offen
  buffer_load_dwordx4 v[196:199], v115, s[12:15], s82 offen
  buffer_load_dwordx4 v[200:203], v116, s[12:15], s82 offen
  buffer_load_dwordx4 v[204:207], v117, s[12:15], s82 offen
  buffer_load_dwordx4 v[208:211], v118, s[12:15], s82 offen
  buffer_load_dwordx4 v[212:215], v119, s[12:15], s82 offen
  buffer_load_dwordx4 v[216:219], v120, s[12:15], s82 offen
  buffer_load_dwordx4 v[220:223], v121, s[12:15], s82 offen
  v_add_u32 v104, 0, v1
  v_mul_u32_u24 v103, v104, v27
  v_lshrrev_b32 v103, 16, v103
  v_mul_u32_u24 v102, 6, v103
  v_sub_u32 v104, v104, v102
  v_bfe_u32 v102, v103, 1, 1
  v_lshlrev_b32 v102, 3, v102
  v_and_b32 v127, 12, v103
  v_lshrrev_b32 v127, 1, v127
  v_and_b32 v103, 0xfffffff1, v103
  v_or3_b32 v103, v103, v102, v127
  v_mul_u32_u24 v102, 1366, v103
  v_lshrrev_b32 v102, 16, v102
  v_mul_u32_u24 v100, 48, v102
  v_sub_u32 v103, v103, v100
  v_cmp_gt_u32 vcc, 32, v103
  v_bfe_u32 v101, v103, 3, 2
  v_and_b32 v126, 3, v103
  v_lshl_add_u32 v126, v101, 2, v126
  v_bfe_u32 v101, v103, 2, 1
  v_lshl_add_u32 v126, v101, 4, v126
  v_cndmask_b32 v103, v103, v126, vcc
  v_add_u32 v100, v100, v103
  v_mul_u32_u24 v100, 1280, v100
  v_lshl_add_u32 v104, v104, 4, v100
  v_add_u32 v105, 64, v1
  v_mul_u32_u24 v103, v105, v27
  v_lshrrev_b32 v103, 16, v103
  v_mul_u32_u24 v102, 6, v103
  v_sub_u32 v105, v105, v102
  v_bfe_u32 v102, v103, 1, 1
  v_lshlrev_b32 v102, 3, v102
  v_and_b32 v127, 12, v103
  v_lshrrev_b32 v127, 1, v127
  v_and_b32 v103, 0xfffffff1, v103
  v_or3_b32 v103, v103, v102, v127
  v_mul_u32_u24 v102, 1366, v103
  v_lshrrev_b32 v102, 16, v102
  v_mul_u32_u24 v100, 48, v102
  v_sub_u32 v103, v103, v100
  v_cmp_gt_u32 vcc, 32, v103
  v_bfe_u32 v101, v103, 3, 2
  v_and_b32 v126, 3, v103
  v_lshl_add_u32 v126, v101, 2, v126
  v_bfe_u32 v101, v103, 2, 1
  v_lshl_add_u32 v126, v101, 4, v126
  v_cndmask_b32 v103, v103, v126, vcc
  v_add_u32 v100, v100, v103
  v_mul_u32_u24 v100, 1280, v100
  v_lshl_add_u32 v105, v105, 4, v100
  v_add_u32 v106, 128, v1
  v_mul_u32_u24 v103, v106, v27
  v_lshrrev_b32 v103, 16, v103
  v_mul_u32_u24 v102, 6, v103
  v_sub_u32 v106, v106, v102
  v_bfe_u32 v102, v103, 1, 1
  v_lshlrev_b32 v102, 3, v102
  v_and_b32 v127, 12, v103
  v_lshrrev_b32 v127, 1, v127
  v_and_b32 v103, 0xfffffff1, v103
  v_or3_b32 v103, v103, v102, v127
  v_mul_u32_u24 v102, 1366, v103
  v_lshrrev_b32 v102, 16, v102
  v_mul_u32_u24 v100, 48, v102
  v_sub_u32 v103, v103, v100
  v_cmp_gt_u32 vcc, 32, v103
  v_bfe_u32 v101, v103, 3, 2
  v_and_b32 v126, 3, v103
  v_lshl_add_u32 v126, v101, 2, v126
  v_bfe_u32 v101, v103, 2, 1
  v_lshl_add_u32 v126, v101, 4, v126
  v_cndmask_b32 v103, v103, v126, vcc
  v_add_u32 v100, v100, v103
  v_mul_u32_u24 v100, 1280, v100
  v_lshl_add_u32 v106, v106, 4, v100
  v_add_u32 v107, 192, v1
  v_mul_u32_u24 v103, v107, v27
  v_lshrrev_b32 v103, 16, v103
  v_mul_u32_u24 v102, 6, v103
  v_sub_u32 v107, v107, v102
  v_bfe_u32 v102, v103, 1, 1
  v_lshlrev_b32 v102, 3, v102
  v_and_b32 v127, 12, v103
  v_lshrrev_b32 v127, 1, v127
  v_and_b32 v103, 0xfffffff1, v103
  v_or3_b32 v103, v103, v102, v127
  v_mul_u32_u24 v102, 1366, v103
  v_lshrrev_b32 v102, 16, v102
  v_mul_u32_u24 v100, 48, v102
  v_sub_u32 v103, v103, v100
  v_cmp_gt_u32 vcc, 32, v103
  v_bfe_u32 v101, v103, 3, 2
  v_and_b32 v126, 3, v103
  v_lshl_add_u32 v126, v101, 2, v126
  v_bfe_u32 v101, v103, 2, 1
  v_lshl_add_u32 v126, v101, 4, v126
  v_cndmask_b32 v103, v103, v126, vcc
  v_add_u32 v100, v100, v103
  v_mul_u32_u24 v100, 1280, v100
  v_lshl_add_u32 v107, v107, 4, v100
  v_add_u32 v108, 256, v1
  v_mul_u32_u24 v103, v108, v27
  v_lshrrev_b32 v103, 16, v103
  v_mul_u32_u24 v102, 6, v103
  v_sub_u32 v108, v108, v102
  v_bfe_u32 v102, v103, 1, 1
  v_lshlrev_b32 v102, 3, v102
  v_and_b32 v127, 12, v103
  v_lshrrev_b32 v127, 1, v127
  v_and_b32 v103, 0xfffffff1, v103
  v_or3_b32 v103, v103, v102, v127
  v_mul_u32_u24 v102, 1366, v103
  v_lshrrev_b32 v102, 16, v102
  v_mul_u32_u24 v100, 48, v102
  v_sub_u32 v103, v103, v100
  v_cmp_gt_u32 vcc, 32, v103
  v_bfe_u32 v101, v103, 3, 2
  v_and_b32 v126, 3, v103
  v_lshl_add_u32 v126, v101, 2, v126
  v_bfe_u32 v101, v103, 2, 1
  v_lshl_add_u32 v126, v101, 4, v126
  v_cndmask_b32 v103, v103, v126, vcc
  v_add_u32 v100, v100, v103
  v_mul_u32_u24 v100, 1280, v100
  v_lshl_add_u32 v108, v108, 4, v100
  v_add_u32 v109, 320, v1
  v_mul_u32_u24 v103, v109, v27
  v_lshrrev_b32 v103, 16, v103
  v_mul_u32_u24 v102, 6, v103
  v_sub_u32 v109, v109, v102
  v_bfe_u32 v102, v103, 1, 1
  v_lshlrev_b32 v102, 3, v102
  v_and_b32 v127, 12, v103
  v_lshrrev_b32 v127, 1, v127
  v_and_b32 v103, 0xfffffff1, v103
  v_or3_b32 v103, v103, v102, v127
  v_mul_u32_u24 v102, 1366, v103
  v_lshrrev_b32 v102, 16, v102
  v_mul_u32_u24 v100, 48, v102
  v_sub_u32 v103, v103, v100
  v_cmp_gt_u32 vcc, 32, v103
  v_bfe_u32 v101, v103, 3, 2
  v_and_b32 v126, 3, v103
  v_lshl_add_u32 v126, v101, 2, v126
  v_bfe_u32 v101, v103, 2, 1
  v_lshl_add_u32 v126, v101, 4, v126
  v_cndmask_b32 v103, v103, v126, vcc
  v_add_u32 v100, v100, v103
  v_mul_u32_u24 v100, 1280, v100
  v_lshl_add_u32 v109, v109, 4, v100
  v_add_u32 v110, 384, v1
  v_mul_u32_u24 v103, v110, v27
  v_lshrrev_b32 v103, 16, v103
  v_mul_u32_u24 v102, 6, v103
  v_sub_u32 v110, v110, v102
  v_bfe_u32 v102, v103, 1, 1
  v_lshlrev_b32 v102, 3, v102
  v_and_b32 v127, 12, v103
  v_lshrrev_b32 v127, 1, v127
  v_and_b32 v103, 0xfffffff1, v103
  v_or3_b32 v103, v103, v102, v127
  v_mul_u32_u24 v102, 1366, v103
  v_lshrrev_b32 v102, 16, v102
  v_mul_u32_u24 v100, 48, v102
  v_sub_u32 v103, v103, v100
  v_cmp_gt_u32 vcc, 32, v103
  v_bfe_u32 v101, v103, 3, 2
  v_and_b32 v126, 3, v103
  v_lshl_add_u32 v126, v101, 2, v126
  v_bfe_u32 v101, v103, 2, 1
  v_lshl_add_u32 v126, v101, 4, v126
  v_cndmask_b32 v103, v103, v126, vcc
  v_add_u32 v100, v100, v103
  v_mul_u32_u24 v100, 1280, v100
  v_lshl_add_u32 v110, v110, 4, v100
  v_add_u32 v111, 448, v1
  v_mul_u32_u24 v103, v111, v27
  v_lshrrev_b32 v103, 16, v103
  v_mul_u32_u24 v102, 6, v103
  v_sub_u32 v111, v111, v102
  v_bfe_u32 v102, v103, 1, 1
  v_lshlrev_b32 v102, 3, v102
  v_and_b32 v127, 12, v103
  v_lshrrev_b32 v127, 1, v127
  v_and_b32 v103, 0xfffffff1, v103
  v_or3_b32 v103, v103, v102, v127
  v_mul_u32_u24 v102, 1366, v103
  v_lshrrev_b32 v102, 16, v102
  v_mul_u32_u24 v100, 48, v102
  v_sub_u32 v103, v103, v100
  v_cmp_gt_u32 vcc, 32, v103
  v_bfe_u32 v101, v103, 3, 2
  v_and_b32 v126, 3, v103
  v_lshl_add_u32 v126, v101, 2, v126
  v_bfe_u32 v101, v103, 2, 1
  v_lshl_add_u32 v126, v101, 4, v126
  v_cndmask_b32 v103, v103, v126, vcc
  v_add_u32 v100, v100, v103
  v_mul_u32_u24 v100, 1280, v100
  v_lshl_add_u32 v111, v111, 4, v100
  v_add_u32 v112, 512, v1
  v_mul_u32_u24 v103, v112, v27
  v_lshrrev_b32 v103, 16, v103
  v_mul_u32_u24 v102, 6, v103
  v_sub_u32 v112, v112, v102
  v_bfe_u32 v102, v103, 1, 1
  v_lshlrev_b32 v102, 3, v102
  v_and_b32 v127, 12, v103
  v_lshrrev_b32 v127, 1, v127
  v_and_b32 v103, 0xfffffff1, v103
  v_or3_b32 v103, v103, v102, v127
  v_mul_u32_u24 v102, 1366, v103
  v_lshrrev_b32 v102, 16, v102
  v_mul_u32_u24 v100, 48, v102
  v_sub_u32 v103, v103, v100
  v_cmp_gt_u32 vcc, 32, v103
  v_bfe_u32 v101, v103, 3, 2
  v_and_b32 v126, 3, v103
  v_lshl_add_u32 v126, v101, 2, v126
  v_bfe_u32 v101, v103, 2, 1
  v_lshl_add_u32 v126, v101, 4, v126
  v_cndmask_b32 v103, v103, v126, vcc
  v_add_u32 v100, v100, v103
  v_mul_u32_u24 v100, 1280, v100
  v_lshl_add_u32 v112, v112, 4, v100
  s_waitcnt vmcnt(63)
  s_mov_b32 s12, s42
  s_mov_b32 s13, s43
  s_mov_b32 s14, 7864320
  s_mov_b32 s15, 0x00020000
  s_add_u32 m0, s81, 30720
  s_nop 0
  buffer_load_dwordx4 v104, s[12:15], s82 offen lds
  s_add_u32 m0, s81, 31744
  s_nop 0
  buffer_load_dwordx4 v105, s[12:15], s82 offen lds
  s_add_u32 m0, s81, 32768
  s_nop 0
  buffer_load_dwordx4 v106, s[12:15], s82 offen lds
  s_add_u32 m0, s81, 33792
  s_nop 0
  buffer_load_dwordx4 v107, s[12:15], s82 offen lds
  s_add_u32 m0, s81, 34816
  s_nop 0
  buffer_load_dwordx4 v108, s[12:15], s82 offen lds
  s_add_u32 m0, s81, 35840
  s_nop 0
  buffer_load_dwordx4 v109, s[12:15], s82 offen lds
  s_add_u32 m0, s81, 36864
  s_nop 0
  buffer_load_dwordx4 v110, s[12:15], s82 offen lds
  s_add_u32 m0, s81, 37888
  s_nop 0
  buffer_load_dwordx4 v111, s[12:15], s82 offen lds
  s_add_u32 m0, s81, 38912
  s_nop 0
  buffer_load_dwordx4 v112, s[12:15], s82 offen lds
  buffer_load_dwordx4 v[32:35], v244, s[28:31], 0 offen offset:0
  buffer_load_dwordx4 v[36:39], v244, s[28:31], 0 offen offset:16
  buffer_load_dwordx2 v[40:41], v244, s[28:31], 0 offen offset:32
  s_waitcnt vmcnt(63)
  s_mov_b32 s12, s36
  s_mov_b32 s13, s37
  s_mov_b32 s14, 7864320
  s_mov_b32 s15, 0x00020000
  s_add_u32 s21, s80, 0
  s_add_u32 s22, s81, 15360
  s_add_u32 m0, s22, 0
  s_nop 0
  buffer_load_dwordx4 v96, s[12:15], s21 offen lds
  s_add_u32 m0, s22, 1024
  s_nop 0
  buffer_load_dwordx4 v97, s[12:15], s21 offen lds
  s_add_u32 m0, s22, 2048
  s_nop 0
  buffer_load_dwordx4 v98, s[12:15], s21 offen lds
  s_waitcnt vmcnt(63)
  s_mov_b32 s12, s36
  s_mov_b32 s13, s37
  s_mov_b32 s14, 7864320
  s_mov_b32 s15, 0x00020000
  s_add_u32 s21, s80, 983040
  s_add_u32 s22, s81, 18432
  s_add_u32 m0, s22, 0
  s_nop 0
  buffer_load_dwordx4 v96, s[12:15], s21 offen lds
  s_add_u32 m0, s22, 1024
  s_nop 0
  buffer_load_dwordx4 v97, s[12:15], s21 offen lds
  s_add_u32 m0, s22, 2048
  s_nop 0
  buffer_load_dwordx4 v98, s[12:15], s21 offen lds
  s_waitcnt vmcnt(63)
  s_mov_b32 s12, s36
  s_mov_b32 s13, s37
  s_mov_b32 s14, 7864320
  s_mov_b32 s15, 0x00020000
  s_add_u32 s21, s80, 98304
  s_add_u32 s22, s81, 21504
  s_add_u32 m0, s22, 0
  s_nop 0
  buffer_load_dwordx4 v96, s[12:15], s21 offen lds
  s_add_u32 m0, s22, 1024
  s_nop 0
  buffer_load_dwordx4 v97, s[12:15], s21 offen lds
  s_add_u32 m0, s22, 2048
  s_nop 0
  buffer_load_dwordx4 v98, s[12:15], s21 offen lds
  s_waitcnt vmcnt(63)
  s_mov_b32 s12, s36
  s_mov_b32 s13, s37
  s_mov_b32 s14, 7864320
  s_mov_b32 s15, 0x00020000
  s_add_u32 s21, s80, 1081344
  s_add_u32 s22, s81, 24576
  s_add_u32 m0, s22, 0
  s_nop 0
  buffer_load_dwordx4 v96, s[12:15], s21 offen lds
  s_add_u32 m0, s22, 1024
  s_nop 0
  buffer_load_dwordx4 v97, s[12:15], s21 offen lds
  s_add_u32 m0, s22, 2048
  s_nop 0
  buffer_load_dwordx4 v98, s[12:15], s21 offen lds
  s_waitcnt vmcnt(63)
  s_mov_b32 s12, s36
  s_mov_b32 s13, s37
  s_mov_b32 s14, 7864320
  s_mov_b32 s15, 0x00020000
  s_add_u32 s21, s80, 196608
  s_add_u32 s22, s81, 27648
  s_add_u32 m0, s22, 0
  s_nop 0
  buffer_load_dwordx4 v46, s[12:15], s21 offen lds
  s_add_u32 m0, s22, 1024
  s_nop 0
  buffer_load_dwordx4 v47, s[12:15], s21 offen lds
  s_add_u32 m0, s22, 2048
  s_nop 0
  buffer_load_dwordx4 v48, s[12:15], s21 offen lds
  v_mov_b32 v100, v49
  v_lshlrev_b32 v239, 2, v1
  s_waitcnt vmcnt(51)
  ds_read_b64_tr_b16 v[52:53], v99 offset:0
  ds_read_b64_tr_b16 v[54:55], v99 offset:384
  ds_read_b64_tr_b16 v[56:57], v99 offset:32
  ds_read_b64_tr_b16 v[58:59], v99 offset:416
  ds_read_b64_tr_b16 v[60:61], v99 offset:64
  ds_read_b64_tr_b16 v[62:63], v99 offset:448
  ds_read_b64_tr_b16 v[64:65], v99 offset:3072
  ds_read_b64_tr_b16 v[66:67], v99 offset:3456
  ds_read_b64_tr_b16 v[68:69], v99 offset:3104
  ds_read_b64_tr_b16 v[70:71], v99 offset:3488
  ds_read_b64_tr_b16 v[72:73], v99 offset:3136
  ds_read_b64_tr_b16 v[74:75], v99 offset:3520
  ds_read_b64_tr_b16 v[76:77], v99 offset:6144
  ds_read_b64_tr_b16 v[78:79], v99 offset:6528
  ds_read_b64_tr_b16 v[80:81], v99 offset:6176
  ds_read_b64_tr_b16 v[82:83], v99 offset:6560
  ds_read_b64_tr_b16 v[84:85], v99 offset:6208
  ds_read_b64_tr_b16 v[86:87], v99 offset:6592
  s_waitcnt lgkmcnt(12)
  v_lshlrev_b32 v50, 16, v52
  v_and_b32 v52, 0xffff0000, v52
  v_cvt_pk_f16_f32 v52, v50, v52
  v_accvgpr_write_b32 a60, v52
  v_lshlrev_b32 v50, 16, v53
  v_and_b32 v53, 0xffff0000, v53
  v_cvt_pk_f16_f32 v53, v50, v53
  v_accvgpr_write_b32 a61, v53
  v_lshlrev_b32 v50, 16, v54
  v_and_b32 v54, 0xffff0000, v54
  v_cvt_pk_f16_f32 v54, v50, v54
  v_accvgpr_write_b32 a62, v54
  v_lshlrev_b32 v50, 16, v55
  v_and_b32 v55, 0xffff0000, v55
  v_cvt_pk_f16_f32 v55, v50, v55
  v_accvgpr_write_b32 a63, v55
  v_lshlrev_b32 v50, 16, v56
  v_and_b32 v56, 0xffff0000, v56
  v_cvt_pk_f16_f32 v56, v50, v56
  v_accvgpr_write_b32 a80, v56
  v_lshlrev_b32 v50, 16, v57
  v_and_b32 v57, 0xffff0000, v57
  v_cvt_pk_f16_f32 v57, v50, v57
  v_accvgpr_write_b32 a81, v57
  v_lshlrev_b32 v50, 16, v58
  v_and_b32 v58, 0xffff0000, v58
  v_cvt_pk_f16_f32 v58, v50, v58
  v_accvgpr_write_b32 a82, v58
  v_lshlrev_b32 v50, 16, v59
  v_and_b32 v59, 0xffff0000, v59
  v_cvt_pk_f16_f32 v59, v50, v59
  v_accvgpr_write_b32 a83, v59
  v_lshlrev_b32 v50, 16, v60
  v_and_b32 v60, 0xffff0000, v60
  v_cvt_pk_f16_f32 v60, v50, v60
  v_accvgpr_write_b32 a100, v60
  v_lshlrev_b32 v50, 16, v61
  v_and_b32 v61, 0xffff0000, v61
  v_cvt_pk_f16_f32 v61, v50, v61
  v_accvgpr_write_b32 a101, v61
  v_lshlrev_b32 v50, 16, v62
  v_and_b32 v62, 0xffff0000, v62
  v_cvt_pk_f16_f32 v62, v50, v62
  v_accvgpr_write_b32 a102, v62
  v_lshlrev_b32 v50, 16, v63
  v_and_b32 v63, 0xffff0000, v63
  v_cvt_pk_f16_f32 v63, v50, v63
  v_accvgpr_write_b32 a103, v63
  ds_read_b64_tr_b16 v[52:53], v99 offset:9216
  ds_read_b64_tr_b16 v[54:55], v99 offset:9600
  ds_read_b64_tr_b16 v[56:57], v99 offset:9248
  ds_read_b64_tr_b16 v[58:59], v99 offset:9632
  ds_read_b64_tr_b16 v[60:61], v99 offset:9280
  ds_read_b64_tr_b16 v[62:63], v99 offset:9664
  s_waitcnt lgkmcnt(12)
  v_lshlrev_b32 v50, 16, v64
  v_and_b32 v64, 0xffff0000, v64
  v_cvt_pk_f16_f32 v64, v50, v64
  v_accvgpr_write_b32 a64, v64
  v_lshlrev_b32 v50, 16, v65
  v_and_b32 v65, 0xffff0000, v65
  v_cvt_pk_f16_f32 v65, v50, v65
  v_accvgpr_write_b32 a65, v65
  v_lshlrev_b32 v50, 16, v66
  v_and_b32 v66, 0xffff0000, v66
  v_cvt_pk_f16_f32 v66, v50, v66
  v_accvgpr_write_b32 a66, v66
  v_lshlrev_b32 v50, 16, v67
  v_and_b32 v67, 0xffff0000, v67
  v_cvt_pk_f16_f32 v67, v50, v67
  v_accvgpr_write_b32 a67, v67
  v_lshlrev_b32 v50, 16, v68
  v_and_b32 v68, 0xffff0000, v68
  v_cvt_pk_f16_f32 v68, v50, v68
  v_accvgpr_write_b32 a84, v68
  v_lshlrev_b32 v50, 16, v69
  v_and_b32 v69, 0xffff0000, v69
  v_cvt_pk_f16_f32 v69, v50, v69
  v_accvgpr_write_b32 a85, v69
  v_lshlrev_b32 v50, 16, v70
  v_and_b32 v70, 0xffff0000, v70
  v_cvt_pk_f16_f32 v70, v50, v70
  v_accvgpr_write_b32 a86, v70
  v_lshlrev_b32 v50, 16, v71
  v_and_b32 v71, 0xffff0000, v71
  v_cvt_pk_f16_f32 v71, v50, v71
  v_accvgpr_write_b32 a87, v71
  v_lshlrev_b32 v50, 16, v72
  v_and_b32 v72, 0xffff0000, v72
  v_cvt_pk_f16_f32 v72, v50, v72
  v_accvgpr_write_b32 a104, v72
  v_lshlrev_b32 v50, 16, v73
  v_and_b32 v73, 0xffff0000, v73
  v_cvt_pk_f16_f32 v73, v50, v73
  v_accvgpr_write_b32 a105, v73
  v_lshlrev_b32 v50, 16, v74
  v_and_b32 v74, 0xffff0000, v74
  v_cvt_pk_f16_f32 v74, v50, v74
  v_accvgpr_write_b32 a106, v74
  v_lshlrev_b32 v50, 16, v75
  v_and_b32 v75, 0xffff0000, v75
  v_cvt_pk_f16_f32 v75, v50, v75
  v_accvgpr_write_b32 a107, v75
  ds_read_b64_tr_b16 v[64:65], v99 offset:12288
  ds_read_b64_tr_b16 v[66:67], v99 offset:12672
  ds_read_b64_tr_b16 v[68:69], v99 offset:12320
  ds_read_b64_tr_b16 v[70:71], v99 offset:12704
  ds_read_b64_tr_b16 v[72:73], v99 offset:12352
  ds_read_b64_tr_b16 v[74:75], v99 offset:12736
  s_waitcnt lgkmcnt(12)
  v_lshlrev_b32 v50, 16, v76
  v_and_b32 v76, 0xffff0000, v76
  v_cvt_pk_f16_f32 v76, v50, v76
  v_accvgpr_write_b32 a68, v76
  v_lshlrev_b32 v50, 16, v77
  v_and_b32 v77, 0xffff0000, v77
  v_cvt_pk_f16_f32 v77, v50, v77
  v_accvgpr_write_b32 a69, v77
  v_lshlrev_b32 v50, 16, v78
  v_and_b32 v78, 0xffff0000, v78
  v_cvt_pk_f16_f32 v78, v50, v78
  v_accvgpr_write_b32 a70, v78
  v_lshlrev_b32 v50, 16, v79
  v_and_b32 v79, 0xffff0000, v79
  v_cvt_pk_f16_f32 v79, v50, v79
  v_accvgpr_write_b32 a71, v79
  v_lshlrev_b32 v50, 16, v80
  v_and_b32 v80, 0xffff0000, v80
  v_cvt_pk_f16_f32 v80, v50, v80
  v_accvgpr_write_b32 a88, v80
  v_lshlrev_b32 v50, 16, v81
  v_and_b32 v81, 0xffff0000, v81
  v_cvt_pk_f16_f32 v81, v50, v81
  v_accvgpr_write_b32 a89, v81
  v_lshlrev_b32 v50, 16, v82
  v_and_b32 v82, 0xffff0000, v82
  v_cvt_pk_f16_f32 v82, v50, v82
  v_accvgpr_write_b32 a90, v82
  v_lshlrev_b32 v50, 16, v83
  v_and_b32 v83, 0xffff0000, v83
  v_cvt_pk_f16_f32 v83, v50, v83
  v_accvgpr_write_b32 a91, v83
  v_lshlrev_b32 v50, 16, v84
  v_and_b32 v84, 0xffff0000, v84
  v_cvt_pk_f16_f32 v84, v50, v84
  v_accvgpr_write_b32 a108, v84
  v_lshlrev_b32 v50, 16, v85
  v_and_b32 v85, 0xffff0000, v85
  v_cvt_pk_f16_f32 v85, v50, v85
  v_accvgpr_write_b32 a109, v85
  v_lshlrev_b32 v50, 16, v86
  v_and_b32 v86, 0xffff0000, v86
  v_cvt_pk_f16_f32 v86, v50, v86
  v_accvgpr_write_b32 a110, v86
  v_lshlrev_b32 v50, 16, v87
  v_and_b32 v87, 0xffff0000, v87
  v_cvt_pk_f16_f32 v87, v50, v87
  v_accvgpr_write_b32 a111, v87
  s_waitcnt lgkmcnt(6)
  v_lshlrev_b32 v50, 16, v52
  v_and_b32 v52, 0xffff0000, v52
  v_cvt_pk_f16_f32 v52, v50, v52
  v_accvgpr_write_b32 a72, v52
  v_lshlrev_b32 v50, 16, v53
  v_and_b32 v53, 0xffff0000, v53
  v_cvt_pk_f16_f32 v53, v50, v53
  v_accvgpr_write_b32 a73, v53
  v_lshlrev_b32 v50, 16, v54
  v_and_b32 v54, 0xffff0000, v54
  v_cvt_pk_f16_f32 v54, v50, v54
  v_accvgpr_write_b32 a74, v54
  v_lshlrev_b32 v50, 16, v55
  v_and_b32 v55, 0xffff0000, v55
  v_cvt_pk_f16_f32 v55, v50, v55
  v_accvgpr_write_b32 a75, v55
  v_lshlrev_b32 v50, 16, v56
  v_and_b32 v56, 0xffff0000, v56
  v_cvt_pk_f16_f32 v56, v50, v56
  v_accvgpr_write_b32 a92, v56
  v_lshlrev_b32 v50, 16, v57
  v_and_b32 v57, 0xffff0000, v57
  v_cvt_pk_f16_f32 v57, v50, v57
  v_accvgpr_write_b32 a93, v57
  v_lshlrev_b32 v50, 16, v58
  v_and_b32 v58, 0xffff0000, v58
  v_cvt_pk_f16_f32 v58, v50, v58
  v_accvgpr_write_b32 a94, v58
  v_lshlrev_b32 v50, 16, v59
  v_and_b32 v59, 0xffff0000, v59
  v_cvt_pk_f16_f32 v59, v50, v59
  v_accvgpr_write_b32 a95, v59
  v_lshlrev_b32 v50, 16, v60
  v_and_b32 v60, 0xffff0000, v60
  v_cvt_pk_f16_f32 v60, v50, v60
  v_accvgpr_write_b32 a112, v60
  v_lshlrev_b32 v50, 16, v61
  v_and_b32 v61, 0xffff0000, v61
  v_cvt_pk_f16_f32 v61, v50, v61
  v_accvgpr_write_b32 a113, v61
  v_lshlrev_b32 v50, 16, v62
  v_and_b32 v62, 0xffff0000, v62
  v_cvt_pk_f16_f32 v62, v50, v62
  v_accvgpr_write_b32 a114, v62
  v_lshlrev_b32 v50, 16, v63
  v_and_b32 v63, 0xffff0000, v63
  v_cvt_pk_f16_f32 v63, v50, v63
  v_accvgpr_write_b32 a115, v63
  s_waitcnt lgkmcnt(0)
  v_lshlrev_b32 v50, 16, v64
  v_and_b32 v64, 0xffff0000, v64
  v_cvt_pk_f16_f32 v64, v50, v64
  v_accvgpr_write_b32 a76, v64
  v_lshlrev_b32 v50, 16, v65
  v_and_b32 v65, 0xffff0000, v65
  v_cvt_pk_f16_f32 v65, v50, v65
  v_accvgpr_write_b32 a77, v65
  v_lshlrev_b32 v50, 16, v66
  v_and_b32 v66, 0xffff0000, v66
  v_cvt_pk_f16_f32 v66, v50, v66
  v_accvgpr_write_b32 a78, v66
  v_lshlrev_b32 v50, 16, v67
  v_and_b32 v67, 0xffff0000, v67
  v_cvt_pk_f16_f32 v67, v50, v67
  v_accvgpr_write_b32 a79, v67
  v_lshlrev_b32 v50, 16, v68
  v_and_b32 v68, 0xffff0000, v68
  v_cvt_pk_f16_f32 v68, v50, v68
  v_accvgpr_write_b32 a96, v68
  v_lshlrev_b32 v50, 16, v69
  v_and_b32 v69, 0xffff0000, v69
  v_cvt_pk_f16_f32 v69, v50, v69
  v_accvgpr_write_b32 a97, v69
  v_lshlrev_b32 v50, 16, v70
  v_and_b32 v70, 0xffff0000, v70
  v_cvt_pk_f16_f32 v70, v50, v70
  v_accvgpr_write_b32 a98, v70
  v_lshlrev_b32 v50, 16, v71
  v_and_b32 v71, 0xffff0000, v71
  v_cvt_pk_f16_f32 v71, v50, v71
  v_accvgpr_write_b32 a99, v71
  v_lshlrev_b32 v50, 16, v72
  v_and_b32 v72, 0xffff0000, v72
  v_cvt_pk_f16_f32 v72, v50, v72
  v_accvgpr_write_b32 a116, v72
  v_lshlrev_b32 v50, 16, v73
  v_and_b32 v73, 0xffff0000, v73
  v_cvt_pk_f16_f32 v73, v50, v73
  v_accvgpr_write_b32 a117, v73
  v_lshlrev_b32 v50, 16, v74
  v_and_b32 v74, 0xffff0000, v74
  v_cvt_pk_f16_f32 v74, v50, v74
  v_accvgpr_write_b32 a118, v74
  v_lshlrev_b32 v50, 16, v75
  v_and_b32 v75, 0xffff0000, v75
  v_cvt_pk_f16_f32 v75, v50, v75
  v_accvgpr_write_b32 a119, v75
  s_waitcnt vmcnt(36)
  ds_write_b128 v100, v[128:131] offset:0
  ds_write_b128 v100, v[132:135] offset:1024
  ds_write_b128 v100, v[136:139] offset:2048
  ds_write_b128 v100, v[140:143] offset:3072
  ds_write_b128 v100, v[144:147] offset:4096
  ds_write_b128 v100, v[148:151] offset:5120
  ds_write_b128 v100, v[152:155] offset:6144
  ds_write_b128 v100, v[156:159] offset:7168
  ds_write_b128 v100, v[160:163] offset:8192
  ds_write_b128 v100, v[164:167] offset:9216
  ds_write_b128 v100, v[168:171] offset:10240
  ds_write_b128 v100, v[172:175] offset:11264
  ds_write_b128 v100, v[176:179] offset:12288
  ds_write_b128 v100, v[180:183] offset:13312
  ds_write_b128 v100, v[184:187] offset:14336
  s_waitcnt lgkmcnt(0)
  ds_read_b64_tr_b16 v[52:53], v99 offset:0
  ds_read_b64_tr_b16 v[54:55], v99 offset:384
  ds_read_b64_tr_b16 v[56:57], v99 offset:32
  ds_read_b64_tr_b16 v[58:59], v99 offset:416
  ds_read_b64_tr_b16 v[60:61], v99 offset:64
  ds_read_b64_tr_b16 v[62:63], v99 offset:448
  ds_read_b64_tr_b16 v[64:65], v99 offset:3072
  ds_read_b64_tr_b16 v[66:67], v99 offset:3456
  ds_read_b64_tr_b16 v[68:69], v99 offset:3104
  ds_read_b64_tr_b16 v[70:71], v99 offset:3488
  ds_read_b64_tr_b16 v[72:73], v99 offset:3136
  ds_read_b64_tr_b16 v[74:75], v99 offset:3520
  ds_read_b64_tr_b16 v[76:77], v99 offset:6144
  ds_read_b64_tr_b16 v[78:79], v99 offset:6528
  ds_read_b64_tr_b16 v[80:81], v99 offset:6176
  ds_read_b64_tr_b16 v[82:83], v99 offset:6560
  ds_read_b64_tr_b16 v[84:85], v99 offset:6208
  ds_read_b64_tr_b16 v[86:87], v99 offset:6592
  s_waitcnt lgkmcnt(12)
  v_lshlrev_b32 v50, 16, v52
  v_and_b32 v52, 0xffff0000, v52
  v_cvt_pk_f16_f32 v52, v50, v52
  v_accvgpr_write_b32 a120, v52
  v_lshlrev_b32 v50, 16, v53
  v_and_b32 v53, 0xffff0000, v53
  v_cvt_pk_f16_f32 v53, v50, v53
  v_accvgpr_write_b32 a121, v53
  v_lshlrev_b32 v50, 16, v54
  v_and_b32 v54, 0xffff0000, v54
  v_cvt_pk_f16_f32 v54, v50, v54
  v_accvgpr_write_b32 a122, v54
  v_lshlrev_b32 v50, 16, v55
  v_and_b32 v55, 0xffff0000, v55
  v_cvt_pk_f16_f32 v55, v50, v55
  v_accvgpr_write_b32 a123, v55
  v_lshlrev_b32 v50, 16, v56
  v_and_b32 v56, 0xffff0000, v56
  v_cvt_pk_f16_f32 v56, v50, v56
  v_accvgpr_write_b32 a140, v56
  v_lshlrev_b32 v50, 16, v57
  v_and_b32 v57, 0xffff0000, v57
  v_cvt_pk_f16_f32 v57, v50, v57
  v_accvgpr_write_b32 a141, v57
  v_lshlrev_b32 v50, 16, v58
  v_and_b32 v58, 0xffff0000, v58
  v_cvt_pk_f16_f32 v58, v50, v58
  v_accvgpr_write_b32 a142, v58
  v_lshlrev_b32 v50, 16, v59
  v_and_b32 v59, 0xffff0000, v59
  v_cvt_pk_f16_f32 v59, v50, v59
  v_accvgpr_write_b32 a143, v59
  v_lshlrev_b32 v50, 16, v60
  v_and_b32 v60, 0xffff0000, v60
  v_cvt_pk_f16_f32 v60, v50, v60
  v_accvgpr_write_b32 a160, v60
  v_lshlrev_b32 v50, 16, v61
  v_and_b32 v61, 0xffff0000, v61
  v_cvt_pk_f16_f32 v61, v50, v61
  v_accvgpr_write_b32 a161, v61
  v_lshlrev_b32 v50, 16, v62
  v_and_b32 v62, 0xffff0000, v62
  v_cvt_pk_f16_f32 v62, v50, v62
  v_accvgpr_write_b32 a162, v62
  v_lshlrev_b32 v50, 16, v63
  v_and_b32 v63, 0xffff0000, v63
  v_cvt_pk_f16_f32 v63, v50, v63
  v_accvgpr_write_b32 a163, v63
  ds_read_b64_tr_b16 v[52:53], v99 offset:9216
  ds_read_b64_tr_b16 v[54:55], v99 offset:9600
  ds_read_b64_tr_b16 v[56:57], v99 offset:9248
  ds_read_b64_tr_b16 v[58:59], v99 offset:9632
  ds_read_b64_tr_b16 v[60:61], v99 offset:9280
  ds_read_b64_tr_b16 v[62:63], v99 offset:9664
  s_waitcnt lgkmcnt(12)
  v_lshlrev_b32 v50, 16, v64
  v_and_b32 v64, 0xffff0000, v64
  v_cvt_pk_f16_f32 v64, v50, v64
  v_accvgpr_write_b32 a124, v64
  v_lshlrev_b32 v50, 16, v65
  v_and_b32 v65, 0xffff0000, v65
  v_cvt_pk_f16_f32 v65, v50, v65
  v_accvgpr_write_b32 a125, v65
  v_lshlrev_b32 v50, 16, v66
  v_and_b32 v66, 0xffff0000, v66
  v_cvt_pk_f16_f32 v66, v50, v66
  v_accvgpr_write_b32 a126, v66
  v_lshlrev_b32 v50, 16, v67
  v_and_b32 v67, 0xffff0000, v67
  v_cvt_pk_f16_f32 v67, v50, v67
  v_accvgpr_write_b32 a127, v67
  v_lshlrev_b32 v50, 16, v68
  v_and_b32 v68, 0xffff0000, v68
  v_cvt_pk_f16_f32 v68, v50, v68
  v_accvgpr_write_b32 a144, v68
  v_lshlrev_b32 v50, 16, v69
  v_and_b32 v69, 0xffff0000, v69
  v_cvt_pk_f16_f32 v69, v50, v69
  v_accvgpr_write_b32 a145, v69
  v_lshlrev_b32 v50, 16, v70
  v_and_b32 v70, 0xffff0000, v70
  v_cvt_pk_f16_f32 v70, v50, v70
  v_accvgpr_write_b32 a146, v70
  v_lshlrev_b32 v50, 16, v71
  v_and_b32 v71, 0xffff0000, v71
  v_cvt_pk_f16_f32 v71, v50, v71
  v_accvgpr_write_b32 a147, v71
  v_lshlrev_b32 v50, 16, v72
  v_and_b32 v72, 0xffff0000, v72
  v_cvt_pk_f16_f32 v72, v50, v72
  v_accvgpr_write_b32 a164, v72
  v_lshlrev_b32 v50, 16, v73
  v_and_b32 v73, 0xffff0000, v73
  v_cvt_pk_f16_f32 v73, v50, v73
  v_accvgpr_write_b32 a165, v73
  v_lshlrev_b32 v50, 16, v74
  v_and_b32 v74, 0xffff0000, v74
  v_cvt_pk_f16_f32 v74, v50, v74
  v_accvgpr_write_b32 a166, v74
  v_lshlrev_b32 v50, 16, v75
  v_and_b32 v75, 0xffff0000, v75
  v_cvt_pk_f16_f32 v75, v50, v75
  v_accvgpr_write_b32 a167, v75
  ds_read_b64_tr_b16 v[64:65], v99 offset:12288
  ds_read_b64_tr_b16 v[66:67], v99 offset:12672
  ds_read_b64_tr_b16 v[68:69], v99 offset:12320
  ds_read_b64_tr_b16 v[70:71], v99 offset:12704
  ds_read_b64_tr_b16 v[72:73], v99 offset:12352
  ds_read_b64_tr_b16 v[74:75], v99 offset:12736
  s_waitcnt lgkmcnt(12)
  v_lshlrev_b32 v50, 16, v76
  v_and_b32 v76, 0xffff0000, v76
  v_cvt_pk_f16_f32 v76, v50, v76
  v_accvgpr_write_b32 a128, v76
  v_lshlrev_b32 v50, 16, v77
  v_and_b32 v77, 0xffff0000, v77
  v_cvt_pk_f16_f32 v77, v50, v77
  v_accvgpr_write_b32 a129, v77
  v_lshlrev_b32 v50, 16, v78
  v_and_b32 v78, 0xffff0000, v78
  v_cvt_pk_f16_f32 v78, v50, v78
  v_accvgpr_write_b32 a130, v78
  v_lshlrev_b32 v50, 16, v79
  v_and_b32 v79, 0xffff0000, v79
  v_cvt_pk_f16_f32 v79, v50, v79
  v_accvgpr_write_b32 a131, v79
  v_lshlrev_b32 v50, 16, v80
  v_and_b32 v80, 0xffff0000, v80
  v_cvt_pk_f16_f32 v80, v50, v80
  v_accvgpr_write_b32 a148, v80
  v_lshlrev_b32 v50, 16, v81
  v_and_b32 v81, 0xffff0000, v81
  v_cvt_pk_f16_f32 v81, v50, v81
  v_accvgpr_write_b32 a149, v81
  v_lshlrev_b32 v50, 16, v82
  v_and_b32 v82, 0xffff0000, v82
  v_cvt_pk_f16_f32 v82, v50, v82
  v_accvgpr_write_b32 a150, v82
  v_lshlrev_b32 v50, 16, v83
  v_and_b32 v83, 0xffff0000, v83
  v_cvt_pk_f16_f32 v83, v50, v83
  v_accvgpr_write_b32 a151, v83
  v_lshlrev_b32 v50, 16, v84
  v_and_b32 v84, 0xffff0000, v84
  v_cvt_pk_f16_f32 v84, v50, v84
  v_accvgpr_write_b32 a168, v84
  v_lshlrev_b32 v50, 16, v85
  v_and_b32 v85, 0xffff0000, v85
  v_cvt_pk_f16_f32 v85, v50, v85
  v_accvgpr_write_b32 a169, v85
  v_lshlrev_b32 v50, 16, v86
  v_and_b32 v86, 0xffff0000, v86
  v_cvt_pk_f16_f32 v86, v50, v86
  v_accvgpr_write_b32 a170, v86
  v_lshlrev_b32 v50, 16, v87
  v_and_b32 v87, 0xffff0000, v87
  v_cvt_pk_f16_f32 v87, v50, v87
  v_accvgpr_write_b32 a171, v87
  s_waitcnt lgkmcnt(6)
  v_lshlrev_b32 v50, 16, v52
  v_and_b32 v52, 0xffff0000, v52
  v_cvt_pk_f16_f32 v52, v50, v52
  v_accvgpr_write_b32 a132, v52
  v_lshlrev_b32 v50, 16, v53
  v_and_b32 v53, 0xffff0000, v53
  v_cvt_pk_f16_f32 v53, v50, v53
  v_accvgpr_write_b32 a133, v53
  v_lshlrev_b32 v50, 16, v54
  v_and_b32 v54, 0xffff0000, v54
  v_cvt_pk_f16_f32 v54, v50, v54
  v_accvgpr_write_b32 a134, v54
  v_lshlrev_b32 v50, 16, v55
  v_and_b32 v55, 0xffff0000, v55
  v_cvt_pk_f16_f32 v55, v50, v55
  v_accvgpr_write_b32 a135, v55
  v_lshlrev_b32 v50, 16, v56
  v_and_b32 v56, 0xffff0000, v56
  v_cvt_pk_f16_f32 v56, v50, v56
  v_accvgpr_write_b32 a152, v56
  v_lshlrev_b32 v50, 16, v57
  v_and_b32 v57, 0xffff0000, v57
  v_cvt_pk_f16_f32 v57, v50, v57
  v_accvgpr_write_b32 a153, v57
  v_lshlrev_b32 v50, 16, v58
  v_and_b32 v58, 0xffff0000, v58
  v_cvt_pk_f16_f32 v58, v50, v58
  v_accvgpr_write_b32 a154, v58
  v_lshlrev_b32 v50, 16, v59
  v_and_b32 v59, 0xffff0000, v59
  v_cvt_pk_f16_f32 v59, v50, v59
  v_accvgpr_write_b32 a155, v59
  v_lshlrev_b32 v50, 16, v60
  v_and_b32 v60, 0xffff0000, v60
  v_cvt_pk_f16_f32 v60, v50, v60
  v_accvgpr_write_b32 a172, v60
  v_lshlrev_b32 v50, 16, v61
  v_and_b32 v61, 0xffff0000, v61
  v_cvt_pk_f16_f32 v61, v50, v61
  v_accvgpr_write_b32 a173, v61
  v_lshlrev_b32 v50, 16, v62
  v_and_b32 v62, 0xffff0000, v62
  v_cvt_pk_f16_f32 v62, v50, v62
  v_accvgpr_write_b32 a174, v62
  v_lshlrev_b32 v50, 16, v63
  v_and_b32 v63, 0xffff0000, v63
  v_cvt_pk_f16_f32 v63, v50, v63
  v_accvgpr_write_b32 a175, v63
  s_waitcnt lgkmcnt(0)
  v_lshlrev_b32 v50, 16, v64
  v_and_b32 v64, 0xffff0000, v64
  v_cvt_pk_f16_f32 v64, v50, v64
  v_accvgpr_write_b32 a136, v64
  v_lshlrev_b32 v50, 16, v65
  v_and_b32 v65, 0xffff0000, v65
  v_cvt_pk_f16_f32 v65, v50, v65
  v_accvgpr_write_b32 a137, v65
  v_lshlrev_b32 v50, 16, v66
  v_and_b32 v66, 0xffff0000, v66
  v_cvt_pk_f16_f32 v66, v50, v66
  v_accvgpr_write_b32 a138, v66
  v_lshlrev_b32 v50, 16, v67
  v_and_b32 v67, 0xffff0000, v67
  v_cvt_pk_f16_f32 v67, v50, v67
  v_accvgpr_write_b32 a139, v67
  v_lshlrev_b32 v50, 16, v68
  v_and_b32 v68, 0xffff0000, v68
  v_cvt_pk_f16_f32 v68, v50, v68
  v_accvgpr_write_b32 a156, v68
  v_lshlrev_b32 v50, 16, v69
  v_and_b32 v69, 0xffff0000, v69
  v_cvt_pk_f16_f32 v69, v50, v69
  v_accvgpr_write_b32 a157, v69
  v_lshlrev_b32 v50, 16, v70
  v_and_b32 v70, 0xffff0000, v70
  v_cvt_pk_f16_f32 v70, v50, v70
  v_accvgpr_write_b32 a158, v70
  v_lshlrev_b32 v50, 16, v71
  v_and_b32 v71, 0xffff0000, v71
  v_cvt_pk_f16_f32 v71, v50, v71
  v_accvgpr_write_b32 a159, v71
  v_lshlrev_b32 v50, 16, v72
  v_and_b32 v72, 0xffff0000, v72
  v_cvt_pk_f16_f32 v72, v50, v72
  v_accvgpr_write_b32 a176, v72
  v_lshlrev_b32 v50, 16, v73
  v_and_b32 v73, 0xffff0000, v73
  v_cvt_pk_f16_f32 v73, v50, v73
  v_accvgpr_write_b32 a177, v73
  v_lshlrev_b32 v50, 16, v74
  v_and_b32 v74, 0xffff0000, v74
  v_cvt_pk_f16_f32 v74, v50, v74
  v_accvgpr_write_b32 a178, v74
  v_lshlrev_b32 v50, 16, v75
  v_and_b32 v75, 0xffff0000, v75
  v_cvt_pk_f16_f32 v75, v50, v75
  v_accvgpr_write_b32 a179, v75
  s_waitcnt vmcnt(27)
  s_cmp_lg_u32 s20, 0
  s_cbranch_scc1 ic_7
  buffer_load_dword v238, v239, s[32:35], 0 offen sc1
ic_7:
  ds_write_b128 v100, v[188:191] offset:0
  ds_write_b128 v100, v[192:195] offset:1024
  ds_write_b128 v100, v[196:199] offset:2048
  ds_write_b128 v100, v[200:203] offset:3072
  ds_write_b128 v100, v[204:207] offset:4096
  ds_write_b128 v100, v[208:211] offset:5120
  ds_write_b128 v100, v[212:215] offset:6144
  ds_write_b128 v100, v[216:219] offset:7168
  ds_write_b128 v100, v[220:223] offset:8192
  s_waitcnt lgkmcnt(0)
  ds_read_b64_tr_b16 a[192:193], v99 offset:0
  ds_read_b64_tr_b16 a[194:195], v99 offset:384
  ds_read_b64_tr_b16 a[216:217], v99 offset:32
  ds_read_b64_tr_b16 a[218:219], v99 offset:416
  ds_read_b64_tr_b16 a[240:241], v99 offset:64
  ds_read_b64_tr_b16 a[242:243], v99 offset:448
  ds_read_b64_tr_b16 a[196:197], v99 offset:3072
  ds_read_b64_tr_b16 a[198:199], v99 offset:3456
  ds_read_b64_tr_b16 a[220:221], v99 offset:3104
  ds_read_b64_tr_b16 a[222:223], v99 offset:3488
  ds_read_b64_tr_b16 a[244:245], v99 offset:3136
  ds_read_b64_tr_b16 a[246:247], v99 offset:3520
  ds_read_b64_tr_b16 a[200:201], v99 offset:6144
  ds_read_b64_tr_b16 a[202:203], v99 offset:6528
  ds_read_b64_tr_b16 a[224:225], v99 offset:6176
  ds_read_b64_tr_b16 a[226:227], v99 offset:6560
  ds_read_b64_tr_b16 a[248:249], v99 offset:6208
  ds_read_b64_tr_b16 a[250:251], v99 offset:6592
  s_waitcnt lgkmcnt(0)
  s_waitcnt vmcnt(15)
  ds_read_b64_tr_b16 a[180:181], v99 offset:30720
  ds_read_b64_tr_b16 a[182:183], v99 offset:31104
  ds_read_b64_tr_b16 a[204:205], v99 offset:30752
  ds_read_b64_tr_b16 a[206:207], v99 offset:31136
  ds_read_b64_tr_b16 a[228:229], v99 offset:30784
  ds_read_b64_tr_b16 a[230:231], v99 offset:31168
  ds_read_b64_tr_b16 a[184:185], v99 offset:33792
  ds_read_b64_tr_b16 a[186:187], v99 offset:34176
  ds_read_b64_tr_b16 a[208:209], v99 offset:33824
  ds_read_b64_tr_b16 a[210:211], v99 offset:34208
  ds_read_b64_tr_b16 a[232:233], v99 offset:33856
  ds_read_b64_tr_b16 a[234:235], v99 offset:34240
  ds_read_b64_tr_b16 a[188:189], v99 offset:36864
  ds_read_b64_tr_b16 a[190:191], v99 offset:37248
  ds_read_b64_tr_b16 a[212:213], v99 offset:36896
  ds_read_b64_tr_b16 a[214:215], v99 offset:37280
  ds_read_b64_tr_b16 a[236:237], v99 offset:36928
  ds_read_b64_tr_b16 a[238:239], v99 offset:37312
  s_waitcnt lgkmcnt(0)
  v_lshlrev_b32 v50, 16, v32
  v_and_b32 v32, 0xffff0000, v32
  v_cvt_pk_f16_f32 v32, v50, v32
  v_lshlrev_b32 v50, 16, v33
  v_and_b32 v33, 0xffff0000, v33
  v_cvt_pk_f16_f32 v33, v50, v33
  v_lshlrev_b32 v50, 16, v34
  v_and_b32 v34, 0xffff0000, v34
  v_cvt_pk_f16_f32 v34, v50, v34
  v_lshlrev_b32 v50, 16, v35
  v_and_b32 v35, 0xffff0000, v35
  v_cvt_pk_f16_f32 v35, v50, v35
  v_lshlrev_b32 v50, 16, v36
  v_and_b32 v36, 0xffff0000, v36
  v_cvt_pk_f16_f32 v36, v50, v36
  v_lshlrev_b32 v50, 16, v37
  v_and_b32 v37, 0xffff0000, v37
  v_cvt_pk_f16_f32 v37, v50, v37
  v_lshlrev_b32 v50, 16, v38
  v_and_b32 v38, 0xffff0000, v38
  v_cvt_pk_f16_f32 v38, v50, v38
  v_lshlrev_b32 v50, 16, v39
  v_and_b32 v39, 0xffff0000, v39
  v_cvt_pk_f16_f32 v39, v50, v39
  v_lshlrev_b32 v50, 16, v40
  v_and_b32 v40, 0xffff0000, v40
  v_cvt_pk_f16_f32 v40, v50, v40
  v_lshlrev_b32 v50, 16, v41
  v_and_b32 v41, 0xffff0000, v41
  v_cvt_pk_f16_f32 v41, v50, v41
  v_mov_b32 v174, 0
  v_mov_b32 v175, 0
  v_mov_b32 v218, 0
  v_mov_b32 v219, 0
  v_mov_b32 v234, 0
  v_mov_b32 v235, 0
  v_mov_b32 v220, 0
  v_mov_b32 v221, 0
  v_mov_b32 v222, 0
  v_mov_b32 v223, 0
  v_mov_b32 v224, 0
  v_mov_b32 v225, 0
  v_mov_b32 v226, 0
  v_mov_b32 v227, 0
  s_waitcnt vmcnt(12)
  ds_read_b64_tr_b16 v[52:53], v99 offset:15360
  ds_read_b64_tr_b16 v[54:55], v99 offset:15744
  ds_read_b64_tr_b16 v[56:57], v99 offset:15392
  ds_read_b64_tr_b16 v[58:59], v99 offset:15776
  ds_read_b64_tr_b16 v[60:61], v99 offset:15424
  ds_read_b64_tr_b16 v[62:63], v99 offset:15808
  s_waitcnt lgkmcnt(0)
  v_lshlrev_b32 v50, 16, v52
  v_and_b32 v52, 0xffff0000, v52
  v_cvt_pk_f16_f32 v52, v50, v52
  v_accvgpr_write_b32 a0, v52
  v_lshlrev_b32 v50, 16, v53
  v_and_b32 v53, 0xffff0000, v53
  v_cvt_pk_f16_f32 v53, v50, v53
  v_accvgpr_write_b32 a1, v53
  v_lshlrev_b32 v50, 16, v54
  v_and_b32 v54, 0xffff0000, v54
  v_cvt_pk_f16_f32 v54, v50, v54
  v_accvgpr_write_b32 a2, v54
  v_lshlrev_b32 v50, 16, v55
  v_and_b32 v55, 0xffff0000, v55
  v_cvt_pk_f16_f32 v55, v50, v55
  v_accvgpr_write_b32 a3, v55
  v_lshlrev_b32 v50, 16, v56
  v_and_b32 v56, 0xffff0000, v56
  v_cvt_pk_f16_f32 v56, v50, v56
  v_accvgpr_write_b32 a20, v56
  v_lshlrev_b32 v50, 16, v57
  v_and_b32 v57, 0xffff0000, v57
  v_cvt_pk_f16_f32 v57, v50, v57
  v_accvgpr_write_b32 a21, v57
  v_lshlrev_b32 v50, 16, v58
  v_and_b32 v58, 0xffff0000, v58
  v_cvt_pk_f16_f32 v58, v50, v58
  v_accvgpr_write_b32 a22, v58
  v_lshlrev_b32 v50, 16, v59
  v_and_b32 v59, 0xffff0000, v59
  v_cvt_pk_f16_f32 v59, v50, v59
  v_accvgpr_write_b32 a23, v59
  v_lshlrev_b32 v50, 16, v60
  v_and_b32 v60, 0xffff0000, v60
  v_cvt_pk_f16_f32 v60, v50, v60
  v_accvgpr_write_b32 a40, v60
  v_lshlrev_b32 v50, 16, v61
  v_and_b32 v61, 0xffff0000, v61
  v_cvt_pk_f16_f32 v61, v50, v61
  v_accvgpr_write_b32 a41, v61
  v_lshlrev_b32 v50, 16, v62
  v_and_b32 v62, 0xffff0000, v62
  v_cvt_pk_f16_f32 v62, v50, v62
  v_accvgpr_write_b32 a42, v62
  v_lshlrev_b32 v50, 16, v63
  v_and_b32 v63, 0xffff0000, v63
  v_cvt_pk_f16_f32 v63, v50, v63
  v_accvgpr_write_b32 a43, v63
  s_waitcnt vmcnt(9)
  ds_read_b64_tr_b16 v[64:65], v99 offset:18432
  ds_read_b64_tr_b16 v[66:67], v99 offset:18816
  ds_read_b64_tr_b16 v[68:69], v99 offset:18464
  ds_read_b64_tr_b16 v[70:71], v99 offset:18848
  ds_read_b64_tr_b16 v[72:73], v99 offset:18496
  ds_read_b64_tr_b16 v[74:75], v99 offset:18880
  s_waitcnt lgkmcnt(0)
  v_lshlrev_b32 v50, 16, v64
  v_and_b32 v64, 0xffff0000, v64
  v_cvt_pk_f16_f32 v64, v50, v64
  v_accvgpr_write_b32 a4, v64
  v_lshlrev_b32 v50, 16, v65
  v_and_b32 v65, 0xffff0000, v65
  v_cvt_pk_f16_f32 v65, v50, v65
  v_accvgpr_write_b32 a5, v65
  v_lshlrev_b32 v50, 16, v66
  v_and_b32 v66, 0xffff0000, v66
  v_cvt_pk_f16_f32 v66, v50, v66
  v_accvgpr_write_b32 a6, v66
  v_lshlrev_b32 v50, 16, v67
  v_and_b32 v67, 0xffff0000, v67
  v_cvt_pk_f16_f32 v67, v50, v67
  v_accvgpr_write_b32 a7, v67
  v_lshlrev_b32 v50, 16, v68
  v_and_b32 v68, 0xffff0000, v68
  v_cvt_pk_f16_f32 v68, v50, v68
  v_accvgpr_write_b32 a24, v68
  v_lshlrev_b32 v50, 16, v69
  v_and_b32 v69, 0xffff0000, v69
  v_cvt_pk_f16_f32 v69, v50, v69
  v_accvgpr_write_b32 a25, v69
  v_lshlrev_b32 v50, 16, v70
  v_and_b32 v70, 0xffff0000, v70
  v_cvt_pk_f16_f32 v70, v50, v70
  v_accvgpr_write_b32 a26, v70
  v_lshlrev_b32 v50, 16, v71
  v_and_b32 v71, 0xffff0000, v71
  v_cvt_pk_f16_f32 v71, v50, v71
  v_accvgpr_write_b32 a27, v71
  v_lshlrev_b32 v50, 16, v72
  v_and_b32 v72, 0xffff0000, v72
  v_cvt_pk_f16_f32 v72, v50, v72
  v_accvgpr_write_b32 a44, v72
  v_lshlrev_b32 v50, 16, v73
  v_and_b32 v73, 0xffff0000, v73
  v_cvt_pk_f16_f32 v73, v50, v73
  v_accvgpr_write_b32 a45, v73
  v_lshlrev_b32 v50, 16, v74
  v_and_b32 v74, 0xffff0000, v74
  v_cvt_pk_f16_f32 v74, v50, v74
  v_accvgpr_write_b32 a46, v74
  v_lshlrev_b32 v50, 16, v75
  v_and_b32 v75, 0xffff0000, v75
  v_cvt_pk_f16_f32 v75, v50, v75
  v_accvgpr_write_b32 a47, v75
  s_waitcnt vmcnt(6)
  ds_read_b64_tr_b16 v[76:77], v99 offset:21504
  ds_read_b64_tr_b16 v[78:79], v99 offset:21888
  ds_read_b64_tr_b16 v[80:81], v99 offset:21536
  ds_read_b64_tr_b16 v[82:83], v99 offset:21920
  ds_read_b64_tr_b16 v[84:85], v99 offset:21568
  ds_read_b64_tr_b16 v[86:87], v99 offset:21952
  s_waitcnt lgkmcnt(0)
  v_lshlrev_b32 v50, 16, v76
  v_and_b32 v76, 0xffff0000, v76
  v_cvt_pk_f16_f32 v76, v50, v76
  v_accvgpr_write_b32 a8, v76
  v_lshlrev_b32 v50, 16, v77
  v_and_b32 v77, 0xffff0000, v77
  v_cvt_pk_f16_f32 v77, v50, v77
  v_accvgpr_write_b32 a9, v77
  v_lshlrev_b32 v50, 16, v78
  v_and_b32 v78, 0xffff0000, v78
  v_cvt_pk_f16_f32 v78, v50, v78
  v_accvgpr_write_b32 a10, v78
  v_lshlrev_b32 v50, 16, v79
  v_and_b32 v79, 0xffff0000, v79
  v_cvt_pk_f16_f32 v79, v50, v79
  v_accvgpr_write_b32 a11, v79
  v_lshlrev_b32 v50, 16, v80
  v_and_b32 v80, 0xffff0000, v80
  v_cvt_pk_f16_f32 v80, v50, v80
  v_accvgpr_write_b32 a28, v80
  v_lshlrev_b32 v50, 16, v81
  v_and_b32 v81, 0xffff0000, v81
  v_cvt_pk_f16_f32 v81, v50, v81
  v_accvgpr_write_b32 a29, v81
  v_lshlrev_b32 v50, 16, v82
  v_and_b32 v82, 0xffff0000, v82
  v_cvt_pk_f16_f32 v82, v50, v82
  v_accvgpr_write_b32 a30, v82
  v_lshlrev_b32 v50, 16, v83
  v_and_b32 v83, 0xffff0000, v83
  v_cvt_pk_f16_f32 v83, v50, v83
  v_accvgpr_write_b32 a31, v83
  v_lshlrev_b32 v50, 16, v84
  v_and_b32 v84, 0xffff0000, v84
  v_cvt_pk_f16_f32 v84, v50, v84
  v_accvgpr_write_b32 a48, v84
  v_lshlrev_b32 v50, 16, v85
  v_and_b32 v85, 0xffff0000, v85
  v_cvt_pk_f16_f32 v85, v50, v85
  v_accvgpr_write_b32 a49, v85
  v_lshlrev_b32 v50, 16, v86
  v_and_b32 v86, 0xffff0000, v86
  v_cvt_pk_f16_f32 v86, v50, v86
  v_accvgpr_write_b32 a50, v86
  v_lshlrev_b32 v50, 16, v87
  v_and_b32 v87, 0xffff0000, v87
  v_cvt_pk_f16_f32 v87, v50, v87
  v_accvgpr_write_b32 a51, v87
  s_waitcnt vmcnt(3)
  ds_read_b64_tr_b16 v[52:53], v99 offset:24576
  ds_read_b64_tr_b16 v[54:55], v99 offset:24960
  ds_read_b64_tr_b16 v[56:57], v99 offset:24608
  ds_read_b64_tr_b16 v[58:59], v99 offset:24992
  ds_read_b64_tr_b16 v[60:61], v99 offset:24640
  ds_read_b64_tr_b16 v[62:63], v99 offset:25024
  s_waitcnt lgkmcnt(0)
  v_lshlrev_b32 v50, 16, v52
  v_and_b32 v52, 0xffff0000, v52
  v_cvt_pk_f16_f32 v52, v50, v52
  v_accvgpr_write_b32 a12, v52
  v_lshlrev_b32 v50, 16, v53
  v_and_b32 v53, 0xffff0000, v53
  v_cvt_pk_f16_f32 v53, v50, v53
  v_accvgpr_write_b32 a13, v53
  v_lshlrev_b32 v50, 16, v54
  v_and_b32 v54, 0xffff0000, v54
  v_cvt_pk_f16_f32 v54, v50, v54
  v_accvgpr_write_b32 a14, v54
  v_lshlrev_b32 v50, 16, v55
  v_and_b32 v55, 0xffff0000, v55
  v_cvt_pk_f16_f32 v55, v50, v55
  v_accvgpr_write_b32 a15, v55
  v_lshlrev_b32 v50, 16, v56
  v_and_b32 v56, 0xffff0000, v56
  v_cvt_pk_f16_f32 v56, v50, v56
  v_accvgpr_write_b32 a32, v56
  v_lshlrev_b32 v50, 16, v57
  v_and_b32 v57, 0xffff0000, v57
  v_cvt_pk_f16_f32 v57, v50, v57
  v_accvgpr_write_b32 a33, v57
  v_lshlrev_b32 v50, 16, v58
  v_and_b32 v58, 0xffff0000, v58
  v_cvt_pk_f16_f32 v58, v50, v58
  v_accvgpr_write_b32 a34, v58
  v_lshlrev_b32 v50, 16, v59
  v_and_b32 v59, 0xffff0000, v59
  v_cvt_pk_f16_f32 v59, v50, v59
  v_accvgpr_write_b32 a35, v59
  v_lshlrev_b32 v50, 16, v60
  v_and_b32 v60, 0xffff0000, v60
  v_cvt_pk_f16_f32 v60, v50, v60
  v_accvgpr_write_b32 a52, v60
  v_lshlrev_b32 v50, 16, v61
  v_and_b32 v61, 0xffff0000, v61
  v_cvt_pk_f16_f32 v61, v50, v61
  v_accvgpr_write_b32 a53, v61
  v_lshlrev_b32 v50, 16, v62
  v_and_b32 v62, 0xffff0000, v62
  v_cvt_pk_f16_f32 v62, v50, v62
  v_accvgpr_write_b32 a54, v62
  v_lshlrev_b32 v50, 16, v63
  v_and_b32 v63, 0xffff0000, v63
  v_cvt_pk_f16_f32 v63, v50, v63
  v_accvgpr_write_b32 a55, v63
  s_waitcnt vmcnt(0)
  ds_read_b64_tr_b16 v[64:65], v99 offset:27648
  ds_read_b64_tr_b16 v[66:67], v99 offset:28032
  ds_read_b64_tr_b16 v[68:69], v99 offset:27680
  ds_read_b64_tr_b16 v[70:71], v99 offset:28064
  ds_read_b64_tr_b16 v[72:73], v99 offset:27712
  ds_read_b64_tr_b16 v[74:75], v99 offset:28096
  s_waitcnt lgkmcnt(0)
  v_lshlrev_b32 v50, 16, v64
  v_and_b32 v64, 0xffff0000, v64
  v_cvt_pk_f16_f32 v64, v50, v64
  v_accvgpr_write_b32 a16, v64
  v_lshlrev_b32 v50, 16, v65
  v_and_b32 v65, 0xffff0000, v65
  v_cvt_pk_f16_f32 v65, v50, v65
  v_accvgpr_write_b32 a17, v65
  v_lshlrev_b32 v50, 16, v66
  v_and_b32 v66, 0xffff0000, v66
  v_cvt_pk_f16_f32 v66, v50, v66
  v_accvgpr_write_b32 a18, v66
  v_lshlrev_b32 v50, 16, v67
  v_and_b32 v67, 0xffff0000, v67
  v_cvt_pk_f16_f32 v67, v50, v67
  v_accvgpr_write_b32 a19, v67
  v_lshlrev_b32 v50, 16, v68
  v_and_b32 v68, 0xffff0000, v68
  v_cvt_pk_f16_f32 v68, v50, v68
  v_accvgpr_write_b32 a36, v68
  v_lshlrev_b32 v50, 16, v69
  v_and_b32 v69, 0xffff0000, v69
  v_cvt_pk_f16_f32 v69, v50, v69
  v_accvgpr_write_b32 a37, v69
  v_lshlrev_b32 v50, 16, v70
  v_and_b32 v70, 0xffff0000, v70
  v_cvt_pk_f16_f32 v70, v50, v70
  v_accvgpr_write_b32 a38, v70
  v_lshlrev_b32 v50, 16, v71
  v_and_b32 v71, 0xffff0000, v71
  v_cvt_pk_f16_f32 v71, v50, v71
  v_accvgpr_write_b32 a39, v71
  v_lshlrev_b32 v50, 16, v72
  v_and_b32 v72, 0xffff0000, v72
  v_cvt_pk_f16_f32 v72, v50, v72
  v_accvgpr_write_b32 a56, v72
  v_lshlrev_b32 v50, 16, v73
  v_and_b32 v73, 0xffff0000, v73
  v_cvt_pk_f16_f32 v73, v50, v73
  v_accvgpr_write_b32 a57, v73
  v_lshlrev_b32 v50, 16, v74
  v_and_b32 v74, 0xffff0000, v74
  v_cvt_pk_f16_f32 v74, v50, v74
  v_accvgpr_write_b32 a58, v74
  v_lshlrev_b32 v50, 16, v75
  v_and_b32 v75, 0xffff0000, v75
  v_cvt_pk_f16_f32 v75, v50, v75
  v_accvgpr_write_b32 a59, v75
  s_waitcnt vmcnt(0)
  s_barrier
  s_add_u32 s12, s44, 81068032
  s_addc_u32 s13, s45, 0
  s_mov_b32 s14, 116736
  s_mov_b32 s15, 0x00020000
  s_add_u32 s28, s44, 114294784
  s_addc_u32 s29, s45, 0
  s_mov_b32 s30, 83886080
  s_mov_b32 s31, 0x00020000
  s_mul_i32 s64, s59, 40960
  s_lshl_b32 s21, s87, 10
  s_add_u32 s64, s64, s21
  s_add_u32 s64, s64, 1310720
  s_lshl_b32 s79, s59, 7
  s_and_b32 s21, s51, 12
  s_add_u32 s79, s79, s21
  s_add_u32 s79, s79, 95232
  v_mov_b32 v94, 0
  v_mov_b32 v95, 0
  s_lshl_b32 s90, s58, 7
  s_lshl_b32 s21, s56, 3
  s_add_u32 s90, s90, s21
  s_add_u32 s90, s90, 19456
  s_cmp_eq_u32 s56, 0
  s_cselect_b32 s65, s90, 0x80000000
  s_mov_b32 s69, 0
  v_lshlrev_b32 v88, 3, v1
  s_cmp_lg_u32 s20, 0
  s_cbranch_scc1 fm_9
  s_bfe_u32 s82, s50, 0x10001
  s_lshl_b32 s82, s82, 5
  s_lshr_b32 s21, s50, 2
  s_add_u32 s82, s82, s21
  s_and_b32 s80, s50, 1
  s_lshl_b32 s80, s80, 4
  s_add_u32 s80, s80, 16
  s_mov_b32 s101, 0
  s_branch fm_10
fm_8:
  s_sleep 8
  buffer_load_dword v238, v239, s[32:35], 0 offen sc1
  s_add_u32 s101, s101, 1
  s_cmp_gt_u32 s101, 131072
  s_cbranch_scc1 end0
  s_waitcnt vmcnt(0)
fm_10:
  v_readlane_b32 s22, v238, 0
  v_readlane_b32 s23, v238, 32
  s_add_u32 s22, s22, s23
  v_readlane_b32 s23, v238, 1
  s_add_u32 s22, s22, s23
  v_readlane_b32 s23, v238, 33
  s_add_u32 s22, s22, s23
  v_readlane_b32 s23, v238, 2
  s_add_u32 s22, s22, s23
  v_readlane_b32 s23, v238, 34
  s_add_u32 s22, s22, s23
  v_readlane_b32 s23, v238, 3
  s_add_u32 s22, s22, s23
  v_readlane_b32 s23, v238, 35
  s_add_u32 s22, s22, s23
  v_readlane_b32 s21, v238, 19
  v_readlane_b32 s23, v238, 21
  s_cmp_ge_u32 s22, 256
  s_cselect_b32 s23, s23, 0
  s_cmp_ge_u32 s21, 32
  s_cselect_b32 s23, s23, 0
  s_cmp_eq_u32 s23, 0
  s_cbranch_scc1 fm_8
  v_readlane_b32 s21, v238, s82
  s_cmp_ge_u32 s21, s80
  s_cselect_b32 s81, 1, 0
  s_andn2_b32 s53, s81, s53
  v_mov_b32 v244, s23
  v_mov_b32 v245, s53
  v_mov_b32 v236, 0
  ds_write_b64 v236, v[244:245]
  s_waitcnt lgkmcnt(0)
fm_9:
  s_barrier
  v_mov_b32 v236, 0
  ds_read_b64 v[244:245], v236
  buffer_load_dword v94, v95, s[12:15], s79 offen sc1
  s_and_b32 s21, s51, 3
  s_mul_i32 s21, s21, 540672
  buffer_load_dwordx2 v[96:97], v9, s[8:11], s21 offen sc1
  buffer_load_dwordx4 v[96:99], v8, s[8:11], s21 offen offset:0 sc1
  buffer_load_dwordx4 v[96:99], v8, s[8:11], s21 offen offset:1024 sc1
  buffer_load_dwordx4 v[96:99], v10, s[8:11], s21 offen offset:0 sc1
  buffer_load_dwordx4 v[96:99], v10, s[8:11], s21 offen offset:1024 sc1
  buffer_load_dwordx4 v[96:99], v10, s[8:11], s21 offen offset:2048 sc1
  s_waitcnt lgkmcnt(0)
  v_readfirstlane_b32 s53, v245
  v_add_u32 v237, -1, v244
  v_lshlrev_b32 v237, 13, v237
  v_xor_b32 v237, 0, v237
  v_add_u32 v13, v13, v237
  v_add_u32 v4, v4, v237
  s_lshl_b32 s21, s50, 7
  s_add_u32 s21, s21, 0
  s_cmp_lg_u32 s20, 0
  s_cbranch_scc1 wf_12
  v_mov_b32 v240, 0
  s_mov_b32 s101, 0
wf_11:
  buffer_load_dword v241, v240, s[12:15], s21 offen sc1
  s_add_u32 s101, s101, 1
  s_cmp_gt_u32 s101, 131072
  s_cbranch_scc1 end0
  s_waitcnt vmcnt(0)
  v_readfirstlane_b32 s100, v241
  s_cmp_ge_u32 s100, 8
  s_cbranch_scc1 wf_12
  s_sleep 6
  s_branch wf_11
wf_12:
  s_barrier
  s_cmp_ge_u32 s20, 2
  s_cbranch_scc1 pf_13
  buffer_load_dwordx4 v[168:171], v18, s[16:19], 0 offen sc1
  buffer_load_dwordx2 v[172:173], v20, s[16:19], 0 offen sc1
pf_13:
  s_waitcnt vmcnt(6)
  v_readfirstlane_b32 s21, v94
  s_mov_b32 s87, 1
  s_cmp_eq_u32 s21, 0
  s_cbranch_scc1 pf_14
  s_mov_b32 s87, 0
  s_sub_u32 s21, s64, 1310720
  buffer_load_dwordx4 v[176:179], v16, s[28:31], s21 offen offset:0 sc1
  buffer_load_dwordx4 v[180:183], v16, s[28:31], s21 offen offset:1024 sc1
  buffer_load_dwordx4 v[184:187], v16, s[28:31], s21 offen offset:2048 sc1
pf_14:
  s_lshl_b32 s21, s20, 2
  s_add_u32 s21, s21, 34816
  v_add_u32 v242, s21, v16
  v_bfe_u32 v243, v1, 2, 3
  v_lshlrev_b32 v243, 4, v243
  v_add_u32 v243, 34816, v243
  s_mov_b32 s52, 0
  s_mov_b32 s89, 0x05040100
  v_mov_b32 v52, 0
  v_mov_b32 v53, 0
  v_mov_b32 v54, 0
  v_mov_b32 v55, 0
  v_mov_b32 v56, 0
  v_mov_b32 v57, 0
  v_mov_b32 v58, 0
  v_mov_b32 v59, 0
  v_mov_b32 v60, 0
  v_mov_b32 v61, 0
  v_mov_b32 v62, 0
  v_mov_b32 v63, 0
  v_mov_b32 v64, 0
  v_mov_b32 v65, 0
  v_mov_b32 v66, 0
  v_mov_b32 v67, 0
  v_mov_b32 v68, 0
  v_mov_b32 v69, 0
  v_mov_b32 v70, 0
  v_mov_b32 v71, 0
  v_mov_b32 v72, 0
  v_mov_b32 v73, 0
  v_mov_b32 v74, 0
  v_mov_b32 v75, 0
  v_mov_b32 v76, 0
  v_mov_b32 v77, 0
  v_mov_b32 v78, 0
  v_mov_b32 v79, 0
  v_mov_b32 v80, 0
  v_mov_b32 v81, 0
  v_mov_b32 v82, 0
  v_mov_b32 v83, 0
  v_mov_b32 v84, 0
  v_mov_b32 v85, 0
  v_mov_b32 v86, 0
  v_mov_b32 v87, 0
  v_mov_b32 v156, 0
  v_mov_b32 v157, 0
  v_mov_b32 v158, 0
  v_mov_b32 v159, 0
  s_and_b32 s21, s52, 3
  s_mul_i32 s81, s21, 540672
  s_lshl_b32 s84, s21, 15
  s_add_u32 s21, s52, 2
  s_and_b32 s21, s21, 3
  s_mul_i32 s82, s21, 540672
  s_add_u32 s21, s52, 3
  s_and_b32 s21, s21, 3
  s_lshl_b32 s83, s21, 15
  s_add_u32 s21, s52, 1
  s_and_b32 s22, s21, 3
  s_lshl_b32 s3, s22, 15
  s_mul_i32 s80, s21, 393216
  s_add_u32 s46, s21, 1
  s_min_u32 s46, s46, 64
  s_mul_i32 s85, s52, 98304
  s_mul_i32 s57, s52, 327680
  s_add_u32 s57, s57, 42991616

  s_bfe_u32 s88, s52, 0x10002
  s_add_u32 s78, s81, 278528
  s_max_u32 s21, s52, 1
  s_sub_u32 s21, s21, 1
  s_cmp_lt_u32 s52, 98
  s_cselect_b32 s66, s65, 0x80000000
  s_cselect_b32 s68, 15, 1
  s_cmp_ge_u32 s52, 99
  s_cselect_b32 s66, s90, s66
  s_cselect_b32 s67, s52, s21
  s_cmp_eq_u32 s53, 0
  s_cbranch_scc1 A1_19
  s_cmp_eq_u32 s20, 0
  s_cbranch_scc1 A1_15
  s_cmp_eq_u32 s20, 1
  s_cbranch_scc1 A1_16
  s_cmp_eq_u32 s20, 2
  s_cbranch_scc1 A1_17
  s_cmp_eq_u32 s20, 3
  s_cbranch_scc1 A1_18
  s_branch A1_19
step_20:
  s_add_u32 s21, s52, 2
  s_and_b32 s21, s21, 3
  s_mul_i32 s82, s21, 540672
  s_add_u32 s21, s52, 3
  s_and_b32 s21, s21, 3
  s_lshl_b32 s83, s21, 15
  s_add_u32 s21, s52, 1
  s_and_b32 s22, s21, 3
  s_lshl_b32 s3, s22, 15
  s_mul_i32 s80, s21, 393216
  s_add_u32 s46, s21, 1
  s_min_u32 s46, s46, 64
  s_mul_i32 s85, s52, 98304
  s_mul_i32 s57, s52, 327680
  s_add_u32 s57, s57, 42991616

  s_bfe_u32 s88, s52, 0x10002
  s_add_u32 s78, s81, 278528
  s_max_u32 s21, s52, 1
  s_sub_u32 s21, s21, 1
  s_cmp_lt_u32 s52, 98
  s_cselect_b32 s66, s65, 0x80000000
  s_cselect_b32 s68, 15, 1
  s_cmp_ge_u32 s52, 99
  s_cselect_b32 s66, s90, s66
  s_cselect_b32 s67, s52, s21
  v_mov_b32 v52, 0
  v_mov_b32 v53, 0
  v_mov_b32 v54, 0
  v_mov_b32 v55, 0
  v_mov_b32 v56, 0
  v_mov_b32 v57, 0
  v_mov_b32 v58, 0
  v_mov_b32 v59, 0
  v_mov_b32 v60, 0
  v_mov_b32 v61, 0
  v_mov_b32 v62, 0
  v_mov_b32 v63, 0
  v_mov_b32 v64, 0
  v_mov_b32 v65, 0
  v_mov_b32 v66, 0
  v_mov_b32 v67, 0
  v_mov_b32 v68, 0
  v_mov_b32 v69, 0
  v_mov_b32 v70, 0
  v_mov_b32 v71, 0
  v_mov_b32 v72, 0
  v_mov_b32 v73, 0
  v_mov_b32 v74, 0
  v_mov_b32 v75, 0
  v_mov_b32 v76, 0
  v_mov_b32 v77, 0
  v_mov_b32 v78, 0
  v_mov_b32 v79, 0
  v_mov_b32 v80, 0
  v_mov_b32 v81, 0
  v_mov_b32 v82, 0
  v_mov_b32 v83, 0
  v_mov_b32 v84, 0
  v_mov_b32 v85, 0
  v_mov_b32 v86, 0
  v_mov_b32 v87, 0
  s_sleep 4
  v_readfirstlane_b32 s21, v94
  s_cmp_lt_u32 s21, s46
  s_cselect_b32 s55, s55, 0
  s_cmp_lt_i32 s55, 0
  s_cbranch_scc1 fl_24
fl_25:
  s_mov_b32 s54, 0
  buffer_load_dwordx4 v[32:35], v4, s[4:7], s84 offen offset:0 sc1
  buffer_load_dwordx4 v[36:39], v4, s[4:7], s84 offen offset:1024 sc1
  buffer_load_dwordx4 v[40:43], v4, s[4:7], s84 offen offset:2048 sc1
  s_waitcnt vmcnt(3)
  v_mov_b32 v176, v160
  v_mov_b32 v177, v161
  v_mov_b32 v178, v162
  v_mov_b32 v179, v163
  v_mov_b32 v180, v164
  v_mov_b32 v181, v165
  v_mov_b32 v182, v166
  v_mov_b32 v183, v167
  v_mov_b32 v184, v48
  v_mov_b32 v185, v49
  v_mov_b32 v186, v50
  v_mov_b32 v187, v51
  s_waitcnt vmcnt(0)
  v_bitop3_b32 v27, v35, v39, v43 bitop3:0x80
  v_perm_b32 v35, v39, v35, s89
  v_cmp_gt_u32 vcc, 0x48000000, v27
  v_mov_b32 v39, v42
  s_cbranch_vccnz pm_22
A1_15:
  v_smfmac_f32_16x16x32_f16 v[52:55], v[40:41], a[16:19], v44
  v_smfmac_f32_16x16x32_f16 v[64:67], v[40:41], a[76:79], v44
  v_smfmac_f32_16x16x32_f16 v[56:59], v[40:41], a[36:39], v44
  v_smfmac_f32_16x16x32_f16 v[68:71], v[40:41], a[96:99], v44
  v_smfmac_f32_16x16x64_f16 v[52:55], v[32:35], a[0:7], v44
  v_smfmac_f32_16x16x64_f16 v[52:55], v[36:39], a[8:15], v44
  v_smfmac_f32_16x16x64_f16 v[64:67], v[32:35], a[60:67], v44
  v_smfmac_f32_16x16x64_f16 v[64:67], v[36:39], a[68:75], v44
  v_smfmac_f32_16x16x32_f16 v[60:63], v[40:41], a[56:59], v44
  v_cvt_pk_f16_f32 v52, v52, v53
  v_cvt_pk_f16_f32 v53, v54, v55
  v_smfmac_f32_16x16x32_f16 v[72:75], v[40:41], a[116:119], v44
  v_smfmac_f32_16x16x32_f16 v[76:79], v[40:41], a[136:139], v44
  v_cvt_pk_f16_f32 v64, v64, v65
  v_cvt_pk_f16_f32 v65, v66, v67
  s_nop 0
  v_smfmac_f32_16x16x64_f16 v[56:59], v[32:35], a[20:27], v44
  v_permlane32_swap_b32 v52, v64
  v_smfmac_f32_16x16x64_f16 v[56:59], v[36:39], a[28:35], v44
  v_permlane32_swap_b32 v53, v65
  v_pk_add_f16 v52, v52, v64
  v_smfmac_f32_16x16x64_f16 v[68:71], v[32:35], a[80:87], v44
  v_pk_add_f16 v53, v53, v65
  v_smfmac_f32_16x16x64_f16 v[68:71], v[36:39], a[88:95], v44
  ds_write_b64 v5, v[52:53] offset:0
  v_smfmac_f32_16x16x32_f16 v[80:83], v[40:41], a[156:159], v44
  v_cvt_pk_f16_f32 v56, v56, v57
  v_cvt_pk_f16_f32 v57, v58, v59
  v_smfmac_f32_16x16x32_f16 v[84:87], v[40:41], a[176:179], v44
  v_cvt_pk_f16_f32 v68, v68, v69
  v_cvt_pk_f16_f32 v69, v70, v71
  s_nop 0
  v_smfmac_f32_16x16x64_f16 v[60:63], v[32:35], a[40:47], v44
  v_permlane32_swap_b32 v56, v68
  v_smfmac_f32_16x16x64_f16 v[60:63], v[36:39], a[48:55], v44
  v_permlane32_swap_b32 v57, v69
  v_pk_add_f16 v56, v56, v68
  v_smfmac_f32_16x16x64_f16 v[72:75], v[32:35], a[100:107], v44
  v_pk_add_f16 v57, v57, v69
  v_smfmac_f32_16x16x64_f16 v[72:75], v[36:39], a[108:115], v44
  ds_write_b64 v5, v[56:57] offset:640
  v_smfmac_f32_16x16x64_f16 v[76:79], v[32:35], a[120:127], v44
  v_cvt_pk_f16_f32 v60, v60, v61
  v_cvt_pk_f16_f32 v61, v62, v63
  v_smfmac_f32_16x16x64_f16 v[76:79], v[36:39], a[128:135], v44
  v_cvt_pk_f16_f32 v72, v72, v73
  v_cvt_pk_f16_f32 v73, v74, v75
  s_nop 0
  v_smfmac_f32_16x16x64_f16 v[80:83], v[32:35], a[140:147], v44
  v_permlane32_swap_b32 v60, v72
  v_smfmac_f32_16x16x64_f16 v[80:83], v[36:39], a[148:155], v44
  v_permlane32_swap_b32 v61, v73
  v_pk_add_f16 v60, v60, v72
  v_smfmac_f32_16x16x64_f16 v[84:87], v[32:35], a[160:167], v44
  v_pk_add_f16 v61, v61, v73
  v_smfmac_f32_16x16x64_f16 v[84:87], v[36:39], a[168:175], v44
  ds_write_b64 v5, v[60:61] offset:1280
  v_cvt_pk_f16_f32 v76, v76, v77
  v_cvt_pk_f16_f32 v77, v78, v79
  v_cvt_pk_f16_f32 v80, v80, v81
  v_cvt_pk_f16_f32 v81, v82, v83
  s_nop 0
  v_permlane32_swap_b32 v76, v80
  v_permlane32_swap_b32 v77, v81
  v_pk_add_f16 v76, v76, v80
  v_pk_add_f16 v77, v77, v81
  ds_write_b64 v5, v[76:77] offset:1920
  v_cvt_pk_f16_f32 v84, v84, v85
  v_cvt_pk_f16_f32 v85, v86, v87
  ds_write_b64 v5, v[84:85] offset:2560
  s_waitcnt lgkmcnt(0) vmcnt(0)
  s_barrier
  ds_read_b64_tr_b16 v[104:105], v45 offset:0
  ds_read_b64_tr_b16 v[106:107], v45 offset:3200
  ds_read_b64_tr_b16 v[108:109], v45 offset:640
  ds_read_b64_tr_b16 v[110:111], v45 offset:3840
  ds_read_b64_tr_b16 v[112:113], v45 offset:1280
  ds_read_b64_tr_b16 v[114:115], v45 offset:4480
  s_waitcnt lgkmcnt(4)
  v_fma_mix_f32 v120, v104, 1.0, v106 op_sel:[0,0,0] op_sel_hi:[1,0,1]
  v_fma_mix_f32 v121, v104, 1.0, v106 op_sel:[1,0,1] op_sel_hi:[1,0,1]
  v_fma_mix_f32 v122, v105, 1.0, v107 op_sel:[0,0,0] op_sel_hi:[1,0,1]
  v_fma_mix_f32 v123, v105, 1.0, v107 op_sel:[1,0,1] op_sel_hi:[1,0,1]
  v_add_f32_dpp v124, v120, v120 row_ror:8 row_mask:0xf bank_mask:0xf
  v_add_f32_dpp v125, v121, v121 row_ror:8 row_mask:0xf bank_mask:0xf
  v_add_f32_dpp v126, v122, v122 row_ror:8 row_mask:0xf bank_mask:0xf
  v_add_f32_dpp v127, v123, v123 row_ror:8 row_mask:0xf bank_mask:0xf
  v_cvt_pk_bf16_f32 v212, v124, v125
  v_cvt_pk_bf16_f32 v213, v126, v127
  s_waitcnt lgkmcnt(2)
  v_fma_mix_f32 v120, v108, 1.0, v110 op_sel:[0,0,0] op_sel_hi:[1,0,1]
  v_fma_mix_f32 v121, v108, 1.0, v110 op_sel:[1,0,1] op_sel_hi:[1,0,1]
  v_fma_mix_f32 v122, v109, 1.0, v111 op_sel:[0,0,0] op_sel_hi:[1,0,1]
  v_fma_mix_f32 v123, v109, 1.0, v111 op_sel:[1,0,1] op_sel_hi:[1,0,1]
  v_add_f32_dpp v124, v120, v120 row_ror:8 row_mask:0xf bank_mask:0xf
  v_add_f32_dpp v125, v121, v121 row_ror:8 row_mask:0xf bank_mask:0xf
  v_add_f32_dpp v126, v122, v122 row_ror:8 row_mask:0xf bank_mask:0xf
  v_add_f32_dpp v127, v123, v123 row_ror:8 row_mask:0xf bank_mask:0xf
  v_cvt_pk_bf16_f32 v214, v124, v125
  v_cvt_pk_bf16_f32 v215, v126, v127
  s_waitcnt lgkmcnt(0)
  v_fma_mix_f32 v120, v112, 1.0, v114 op_sel:[0,0,0] op_sel_hi:[1,0,1]
  v_fma_mix_f32 v121, v112, 1.0, v114 op_sel:[1,0,1] op_sel_hi:[1,0,1]
  v_fma_mix_f32 v122, v113, 1.0, v115 op_sel:[0,0,0] op_sel_hi:[1,0,1]
  v_fma_mix_f32 v123, v113, 1.0, v115 op_sel:[1,0,1] op_sel_hi:[1,0,1]
  v_mfma_f32_16x16x32_bf16 v[96:99], v[168:171], v[212:215], 0
  v_add_f32_dpp v124, v120, v120 row_ror:8 row_mask:0xf bank_mask:0xf
  v_add_f32_dpp v125, v121, v121 row_ror:8 row_mask:0xf bank_mask:0xf
  v_add_f32_dpp v126, v122, v122 row_ror:8 row_mask:0xf bank_mask:0xf
  v_add_f32_dpp v127, v123, v123 row_ror:8 row_mask:0xf bank_mask:0xf
  v_cvt_pk_bf16_f32 v216, v124, v125
  v_cvt_pk_bf16_f32 v217, v126, v127
  s_nop 1
  v_mfma_f32_16x16x32_bf16 v[96:99], v[172:175], v[216:219], v[96:99]
  s_mov_b64 exec, s[74:75]
  s_nop 6
  v_cvt_pk_f16_f32 v100, v96, v97
  v_cvt_pk_f16_f32 v101, v98, v99
  v_and_or_b32 v100, v100, -2, s88
  buffer_store_dwordx2 v[100:101], v7, s[8:11], s81 offen
  s_mov_b64 exec, -1
  s_cmp_eq_u32 s52, 63
  s_cbranch_scc1 last_21
  s_sleep 4
  s_nop 7
  s_mov_b32 s54, 0
  buffer_load_dwordx2 v[248:249], v9, s[8:11], s81 offen sc1
  buffer_load_dwordx4 v[112:115], v8, s[8:11], s81 offen offset:0 sc1
  buffer_load_dwordx4 v[116:119], v8, s[8:11], s81 offen offset:1024 sc1
  s_sleep 2
  buffer_load_dwordx4 v[144:147], v10, s[8:11], s81 offen offset:0 sc1
  buffer_load_dwordx4 v[148:151], v10, s[8:11], s81 offen offset:1024 sc1
  buffer_load_dwordx4 v[152:155], v10, s[8:11], s81 offen offset:2048 sc1
  v_mov_b32 v188, 0
  v_mov_b32 v189, 0
  v_mov_b32 v190, 0
  v_mov_b32 v191, 0
  v_mov_b32 v192, 0
  v_mov_b32 v193, 0
  v_mov_b32 v194, 0
  v_mov_b32 v195, 0
  v_mov_b32 v196, 0
  v_mov_b32 v197, 0
  v_mov_b32 v198, 0
  v_mov_b32 v199, 0
  v_readfirstlane_b32 s21, v94
  s_add_u32 s22, s46, 3
  s_min_u32 s22, s22, 64
  s_sub_u32 s55, s21, s22
  s_sub_u32 s56, s21, s46
  s_cmp_lt_i32 s56, 0
  s_cbranch_scc1 kvw_31
kvok_32:
  s_waitcnt vmcnt(5)
  v_xor_b32 v96, s88, v248
  s_nop 0
  v_permlane16_swap_b32 v248, v249
  v_fma_mix_f32 v250, v248, 1.0, v249 op_sel:[0,0,0] op_sel_hi:[1,0,1]
  v_fma_mix_f32 v251, v248, 1.0, v249 op_sel:[1,0,1] op_sel_hi:[1,0,1]
  v_mov_b32 v248, v250
  v_mov_b32 v249, v251
  s_nop 0
  v_permlane32_swap_b32 v248, v250
  v_permlane32_swap_b32 v249, v251
  v_pk_add_f32 v[124:125], v[248:249], v[250:251]
  v_max_f32 v238, v124, v125
  s_waitcnt vmcnt(3)
  v_pk_add_f16 v100, v112, v116
  v_pk_add_f16 v102, v114, v118
  v_pk_add_f16 v101, v113, v117
  v_pk_add_f16 v103, v115, v119
  v_permlane32_swap_b32 v100, v102
  v_bitop3_b32 v97, v112, v114, s88 bitop3:0x7e
  v_permlane32_swap_b32 v101, v103
  v_bitop3_b32 v98, v116, v118, s88 bitop3:0x7e
  v_fma_mix_f32 v120, v100, 1.0, v102 op_sel:[0,0,0] op_sel_hi:[1,0,1]
  v_or3_b32 v27, v96, v97, v98
  v_fma_mix_f32 v121, v100, 1.0, v102 op_sel:[1,0,1] op_sel_hi:[1,0,1]
  v_and_b32 v27, 1, v27
  v_fma_mix_f32 v122, v101, 1.0, v103 op_sel:[0,0,0] op_sel_hi:[1,0,1]
  v_cmp_ne_u32 vcc, 0, v27
  v_fma_mix_f32 v123, v101, 1.0, v103 op_sel:[1,0,1] op_sel_hi:[1,0,1]
  v_max3_f32 v236, v120, v121, v238
  s_cbranch_vccnz psr_28
psj_29:
  v_max3_f32 v236, v236, v122, v123
  s_nop 1
  v_max_f32_dpp v236, v236, v236 row_ror:8 row_mask:0xf bank_mask:0xf
  v_mov_b32 v237, v236
  s_waitcnt vmcnt(0)
  v_max3_u32 v27, v144, v146, v148
  v_permlane32_swap_b32 v236, v237
  v_max_f32 v236, v236, v237
  v_mov_b32 v237, v236
  v_max3_u32 v27, v27, v150, v152
  v_max_u32 v27, v27, v154
  v_permlane16_swap_b32 v236, v237
  v_cmp_eq_u32 vcc, -1, v27
  v_max_f32 v236, v236, v237
  v_mul_f32 v236, s86, v236
  s_cbranch_vccnz pv_27
pvj_30:
  v_smfmac_f32_16x16x64_bf16 v[188:191], v[144:147], a[180:187], v44
  v_fma_f32 v120, v120, s86, -v236
  v_smfmac_f32_16x16x64_bf16 v[188:191], v[148:151], a[188:195], v44
  v_fma_f32 v121, v121, s86, -v236
  v_smfmac_f32_16x16x64_bf16 v[188:191], v[152:155], a[196:203], v44
  buffer_load_dwordx4 v[160:163], v17, s[28:31], s64 offen offset:0 sc1
  v_fma_f32 v122, v122, s86, -v236
  v_smfmac_f32_16x16x64_bf16 v[192:195], v[144:147], a[204:211], v44
  v_fma_f32 v123, v123, s86, -v236
  v_smfmac_f32_16x16x64_bf16 v[192:195], v[148:151], a[212:219], v44
  buffer_load_dwordx4 v[164:167], v16, s[28:31], s64 offen offset:1024 sc1
  v_fma_f32 v124, v124, s86, -v236
  v_smfmac_f32_16x16x64_bf16 v[192:195], v[152:155], a[220:227], v44
  v_fma_f32 v125, v125, s86, -v236
  v_smfmac_f32_16x16x64_bf16 v[196:199], v[144:147], a[228:235], v44
  buffer_load_dwordx4 v[48:51], v26, s[28:31], s64 offen offset:2048 sc1
  v_exp_f32 v120, v120
  v_smfmac_f32_16x16x64_bf16 v[196:199], v[148:151], a[236:243], v44
  v_exp_f32 v121, v121
  v_smfmac_f32_16x16x64_bf16 v[196:199], v[152:155], a[244:251], v44
  buffer_load_dwordx4 v[168:171], v18, s[16:19], s80 offen sc1
  v_exp_f32 v122, v122
  buffer_load_dwordx2 v[172:173], v20, s[16:19], s80 offen sc1
  v_exp_f32 v123, v123
  v_exp_f32 v124, v124
  s_cmp_lt_i32 s55, 0
  s_cbranch_scc1 fl_33
fl_34:
  v_exp_f32 v125, v125
  v_cvt_pk_bf16_f32 v220, v120, v121
  v_cvt_pk_bf16_f32 v221, v122, v123
  v_cvt_pk_bf16_f32 v224, v124, v125
  v_mov_b32_dpp v222, v220 row_ror:8 row_mask:0xf bank_mask:0xf
  v_mov_b32_dpp v223, v221 row_ror:8 row_mask:0xf bank_mask:0xf
  v_mov_b32_dpp v225, v224 row_ror:8 row_mask:0xf bank_mask:0xf
  v_cvt_pk_bf16_f32 v228, v188, v189
  v_mfma_f32_16x16x32_bf16 v[200:203], v[176:179], v[220:223], 0
  v_cvt_pk_bf16_f32 v229, v190, v191
  v_cvt_pk_bf16_f32 v230, v192, v193
  v_mfma_f32_16x16x32_bf16 v[204:207], v[180:183], v[220:223], 0
  v_cvt_pk_bf16_f32 v231, v194, v195
  v_cvt_pk_bf16_f32 v232, v196, v197
  v_mfma_f32_16x16x32_bf16 v[208:211], v[184:187], v[220:223], 0
  v_cvt_pk_bf16_f32 v233, v198, v199
  v_add_f32 v126, v120, v121
  v_mfma_f32_16x16x32_bf16 v[200:203], v[228:231], v[224:227], v[200:203]
  v_add_f32 v127, v122, v123
  v_add_f32 v128, v124, v125
  v_mfma_f32_16x16x32_bf16 v[204:207], v[230:233], v[224:227], v[204:207]
  v_add_f32 v236, v126, v127
  v_fmac_f32 v236, v128, v89
  v_mfma_f32_16x16x32_bf16 v[208:211], v[232:235], v[224:227], v[208:211]
  s_nop 0
  v_add_f32_dpp v236, v236, v236 row_ror:8 row_mask:0xf bank_mask:0xf
  v_mov_b32 v237, v236
  ds_write_b128 v11, v[200:203] offset:0
  s_nop 0
  v_permlane32_swap_b32 v236, v237
  v_add_f32 v236, v236, v237
  v_mov_b32 v237, v236
  ds_write_b128 v11, v[204:207] offset:1024
  s_nop 0
  v_permlane16_swap_b32 v236, v237
  v_add_f32 v236, v236, v237
  v_rcp_f32 v236, v236
  ds_write_b128 v11, v[208:211] offset:2048
  s_mov_b64 exec, 0xff
  ds_write_b32 v242, v236
  s_mov_b64 exec, -1
  s_waitcnt lgkmcnt(0)
  s_barrier
  ds_read_b128 v[104:107], v243
  ds_read_b64 v[96:97], v12 offset:0
  ds_read_b64 v[98:99], v12 offset:3072
  ds_read_b64 v[100:101], v12 offset:6144
  ds_read_b64 v[102:103], v12 offset:9216
  s_waitcnt lgkmcnt(2)
  v_pk_mul_f32 v[96:97], v[96:97], v[104:105] op_sel_hi:[1,0]
  v_pk_fma_f32 v[96:97], v[98:99], v[104:105], v[96:97] op_sel:[0,1,0] op_sel_hi:[1,1,1]
  s_waitcnt lgkmcnt(0)
  v_pk_fma_f32 v[96:97], v[100:101], v[106:107], v[96:97] op_sel_hi:[1,0,1]
  v_pk_fma_f32 v[96:97], v[102:103], v[106:107], v[96:97] op_sel:[0,1,0] op_sel_hi:[1,1,1]
  v_cvt_pk_f16_f32 v100, v96, v97
  v_perm_b32 v100, s91, v100, v14
  buffer_atomic_pk_add_f16 v100, v13, s[4:7], s3 offen
  v_mov_b32 v200, v196
  v_mov_b32 v201, v197
  v_mov_b32 v202, v198
  v_mov_b32 v203, v199
  v_permlane32_swap_b32 v188, v192
  v_permlane32_swap_b32 v189, v193
  v_permlane32_swap_b32 v190, v194
  v_permlane32_swap_b32 v191, v195
  v_permlane32_swap_b32 v196, v200
  v_permlane32_swap_b32 v197, v201
  v_permlane32_swap_b32 v198, v202
  v_permlane32_swap_b32 v199, v203
  v_pk_add_f32 v[188:189], v[188:189], v[192:193]
  v_pk_add_f32 v[190:191], v[190:191], v[194:195]
  v_pk_add_f32 v[196:197], v[196:197], v[200:201]
  v_pk_add_f32 v[198:199], v[198:199], v[202:203]
  v_cvt_pk_bf16_f32 v252, v188, v189
  v_cvt_pk_bf16_f32 v254, v196, v197
  v_cvt_pk_bf16_f32 v253, v190, v191
  v_cvt_pk_bf16_f32 v255, v198, v199
  s_nop 0
  v_permlane16_swap_b32 v252, v254
  v_permlane16_swap_b32 v253, v255
  v_min_u32 v252, -2, v252
  s_mov_b64 exec, s[76:77]
  buffer_store_dwordx4 v[252:255], v15, s[24:27], s57 offen sc1
  s_mov_b64 exec, -1
  s_add_u32 s64, s64, 1310720
  s_add_u32 s52, s52, 1
  s_and_b32 s21, s52, 3
  s_mul_i32 s81, s21, 540672
  s_lshl_b32 s84, s21, 15
  s_branch step_20
fl_24:
  buffer_load_dword v94, v95, s[12:15], s79 offen sc1
  s_branch fl_25
pm_22:
  s_cmp_gt_u32 s52, 3
  s_cbranch_scc1 op_35
  v_readfirstlane_b32 s21, v94
  s_cmp_ge_u32 s21, s46
  s_cbranch_scc1 op_35
  buffer_load_dword v94, v95, s[12:15], s79 offen sc1
  s_waitcnt vmcnt(0)
  v_readfirstlane_b32 s21, v94
  s_add_u32 s22, s46, 3
  s_min_u32 s22, s22, 64
  s_sub_u32 s55, s21, s22
  s_sub_u32 s56, s21, s46
  s_cmp_gt_u32 s21, s52
  s_cselect_b32 s21, s87, 0
  s_cmp_eq_u32 s21, 0
  s_cbranch_scc1 op_35
  s_mov_b32 s87, 0
  s_sub_u32 s21, s64, 1310720
  buffer_load_dwordx4 v[176:179], v16, s[28:31], s21 offen offset:0 sc1
  buffer_load_dwordx4 v[180:183], v16, s[28:31], s21 offen offset:1024 sc1
  buffer_load_dwordx4 v[184:187], v16, s[28:31], s21 offen offset:2048 sc1
op_35:
  buffer_load_dwordx4 v[32:35], v4, s[4:7], s84 offen offset:0 sc1
  buffer_load_dwordx4 v[36:39], v4, s[4:7], s84 offen offset:1024 sc1
  buffer_load_dwordx4 v[40:43], v4, s[4:7], s84 offen offset:2048 sc1
  s_add_u32 s54, s54, 1
  s_cmp_gt_u32 s54, 131072
  s_cbranch_scc1 end0
  s_waitcnt vmcnt(0)
  v_bitop3_b32 v27, v35, v39, v43 bitop3:0x80
  v_perm_b32 v35, v39, v35, s89
  v_cmp_gt_u32 vcc, 0x48000000, v27
  v_mov_b32 v39, v42
  s_cbranch_vccnz pm_22
  s_branch A1_15
pv_27:
  buffer_load_dwordx4 v[144:147], v10, s[8:11], s81 offen offset:0 sc1
  buffer_load_dwordx4 v[148:151], v10, s[8:11], s81 offen offset:1024 sc1
  buffer_load_dwordx4 v[152:155], v10, s[8:11], s81 offen offset:2048 sc1
  s_add_u32 s54, s54, 1
  s_cmp_gt_u32 s54, 131072
  s_cbranch_scc1 end0
  s_waitcnt vmcnt(0)
  v_max3_u32 v27, v144, v146, v148
  v_max3_u32 v27, v27, v150, v152
  v_max3_u32 v27, v27, v154, v154
  v_cmp_eq_u32 vcc, -1, v27
  s_nop 1
  s_cbranch_vccnz pv_27
  s_branch pvj_30
psr_28:
  buffer_load_dwordx2 v[248:249], v9, s[8:11], s81 offen sc1
  buffer_load_dwordx4 v[112:115], v8, s[8:11], s81 offen offset:0 sc1
  buffer_load_dwordx4 v[116:119], v8, s[8:11], s81 offen offset:1024 sc1
  s_add_u32 s54, s54, 1
  s_cmp_gt_u32 s54, 131072
  s_cbranch_scc1 end0
  s_waitcnt vmcnt(2)
  v_xor_b32 v96, s88, v248
  s_nop 0
  v_permlane16_swap_b32 v248, v249
  v_fma_mix_f32 v250, v248, 1.0, v249 op_sel:[0,0,0] op_sel_hi:[1,0,1]
  v_fma_mix_f32 v251, v248, 1.0, v249 op_sel:[1,0,1] op_sel_hi:[1,0,1]
  v_mov_b32 v248, v250
  v_mov_b32 v249, v251
  s_nop 0
  v_permlane32_swap_b32 v248, v250
  v_permlane32_swap_b32 v249, v251
  v_pk_add_f32 v[124:125], v[248:249], v[250:251]
  v_max_f32 v238, v124, v125
  s_waitcnt vmcnt(0)
  v_pk_add_f16 v100, v112, v116
  v_pk_add_f16 v102, v114, v118
  v_pk_add_f16 v101, v113, v117
  v_pk_add_f16 v103, v115, v119
  v_permlane32_swap_b32 v100, v102
  v_bitop3_b32 v97, v112, v114, s88 bitop3:0x7e
  v_permlane32_swap_b32 v101, v103
  v_bitop3_b32 v98, v116, v118, s88 bitop3:0x7e
  v_fma_mix_f32 v120, v100, 1.0, v102 op_sel:[0,0,0] op_sel_hi:[1,0,1]
  v_or3_b32 v27, v96, v97, v98
  v_fma_mix_f32 v121, v100, 1.0, v102 op_sel:[1,0,1] op_sel_hi:[1,0,1]
  v_and_b32 v27, 1, v27
  v_fma_mix_f32 v122, v101, 1.0, v103 op_sel:[0,0,0] op_sel_hi:[1,0,1]
  v_cmp_ne_u32 vcc, 0, v27
  v_fma_mix_f32 v123, v101, 1.0, v103 op_sel:[1,0,1] op_sel_hi:[1,0,1]
  v_max3_f32 v236, v120, v121, v238
  s_cbranch_vccnz psr_28
  s_branch psj_29
kvw_31:
  s_mov_b32 s22, s87
  s_cmp_eq_u32 s52, 0
  s_cselect_b32 s23, s87, s46
  s_cselect_b32 s55, 0, s55
  s_cselect_b32 s87, 1, 0
  s_cmp_eq_u32 s23, 0
  s_cbranch_scc1 kvok_32
  v_mov_b32 v236, 0
  s_mov_b32 s101, 0
wf_36:
  buffer_load_dword v237, v236, s[12:15], s79 offen sc1
  s_add_u32 s101, s101, 1
  s_cmp_gt_u32 s101, 131072
  s_cbranch_scc1 end0
  s_waitcnt vmcnt(0)
  v_readfirstlane_b32 s100, v237
  s_cmp_ge_u32 s100, s23
  s_cbranch_scc1 wf_37
  s_sleep 3
  s_branch wf_36
wf_37:
  s_cmp_eq_u32 s22, 0
  s_cbranch_scc1 kvok_32
  s_sub_u32 s21, s64, 1310720
  buffer_load_dwordx4 v[176:179], v16, s[28:31], s21 offen offset:0 sc1
  buffer_load_dwordx4 v[180:183], v16, s[28:31], s21 offen offset:1024 sc1
  buffer_load_dwordx4 v[184:187], v16, s[28:31], s21 offen offset:2048 sc1
  s_waitcnt vmcnt(0)
  s_branch kvok_32
fl_33:
  buffer_load_dword v94, v95, s[12:15], s79 offen sc1
  s_branch fl_34
last_21:
  v_mov_b32 v188, 0
  v_mov_b32 v189, 0
  v_mov_b32 v190, 0
  v_mov_b32 v191, 0
  v_mov_b32 v192, 0
  v_mov_b32 v193, 0
  v_mov_b32 v194, 0
  v_mov_b32 v195, 0
  v_mov_b32 v196, 0
  v_mov_b32 v197, 0
  v_mov_b32 v198, 0
  v_mov_b32 v199, 0
  s_sleep 4
  s_mov_b32 s54, 0
lv_38:
  buffer_load_dwordx4 v[144:147], v10, s[8:11], s81 offen offset:0 sc1
  buffer_load_dwordx4 v[148:151], v10, s[8:11], s81 offen offset:1024 sc1
  buffer_load_dwordx4 v[152:155], v10, s[8:11], s81 offen offset:2048 sc1
  s_add_u32 s54, s54, 1
  s_cmp_gt_u32 s54, 131072
  s_cbranch_scc1 end0
  s_waitcnt vmcnt(0)
  v_max3_u32 v27, v144, v146, v148
  v_max3_u32 v27, v27, v150, v152
  v_max3_u32 v27, v27, v154, v154
  v_cmp_eq_u32 vcc, -1, v27
  s_nop 1
  s_cbranch_vccnz lv_38
  v_smfmac_f32_16x16x64_bf16 v[188:191], v[144:147], a[180:187], v44
  v_smfmac_f32_16x16x64_bf16 v[192:195], v[144:147], a[204:211], v44
  v_smfmac_f32_16x16x64_bf16 v[196:199], v[144:147], a[228:235], v44
  v_smfmac_f32_16x16x64_bf16 v[188:191], v[148:151], a[188:195], v44
  v_smfmac_f32_16x16x64_bf16 v[192:195], v[148:151], a[212:219], v44
  v_smfmac_f32_16x16x64_bf16 v[196:199], v[148:151], a[236:243], v44
  v_smfmac_f32_16x16x64_bf16 v[188:191], v[152:155], a[196:203], v44
  v_smfmac_f32_16x16x64_bf16 v[192:195], v[152:155], a[220:227], v44
  v_smfmac_f32_16x16x64_bf16 v[196:199], v[152:155], a[244:251], v44
  s_nop 7
  v_mov_b32 v200, v196
  v_mov_b32 v201, v197
  v_mov_b32 v202, v198
  v_mov_b32 v203, v199
  v_permlane32_swap_b32 v188, v192
  v_permlane32_swap_b32 v189, v193
  v_permlane32_swap_b32 v190, v194
  v_permlane32_swap_b32 v191, v195
  v_permlane32_swap_b32 v196, v200
  v_permlane32_swap_b32 v197, v201
  v_permlane32_swap_b32 v198, v202
  v_permlane32_swap_b32 v199, v203
  v_pk_add_f32 v[188:189], v[188:189], v[192:193]
  v_pk_add_f32 v[190:191], v[190:191], v[194:195]
  v_pk_add_f32 v[196:197], v[196:197], v[200:201]
  v_pk_add_f32 v[198:199], v[198:199], v[202:203]
  v_cvt_pk_bf16_f32 v252, v188, v189
  v_cvt_pk_bf16_f32 v254, v196, v197
  v_cvt_pk_bf16_f32 v253, v190, v191
  v_cvt_pk_bf16_f32 v255, v198, v199
  s_nop 0
  v_permlane16_swap_b32 v252, v254
  v_permlane16_swap_b32 v253, v255
  v_min_u32 v252, -2, v252
  s_mov_b64 exec, s[76:77]
  buffer_store_dwordx4 v[252:255], v15, s[24:27], s57 offen sc1
  s_mov_b64 exec, -1
  v_mov_b32 v246, 80
  v_mov_b32 v247, 1
  s_mov_b64 exec, 1
  buffer_atomic_add v247, v246, s[32:35], 0 offen sc0 sc1
  s_mov_b64 exec, -1
clm_39:
  s_branch chain_done
step_40:
  s_add_u32 s21, s52, 2
  s_and_b32 s21, s21, 3
  s_mul_i32 s82, s21, 540672
  s_add_u32 s21, s52, 3
  s_and_b32 s21, s21, 3
  s_lshl_b32 s83, s21, 15
  s_add_u32 s21, s52, 1
  s_and_b32 s22, s21, 3
  s_lshl_b32 s3, s22, 15
  s_mul_i32 s80, s21, 393216
  s_add_u32 s46, s21, 1
  s_min_u32 s46, s46, 64
  s_mul_i32 s85, s52, 98304
  s_mul_i32 s57, s52, 327680
  s_add_u32 s57, s57, 42991616

  s_bfe_u32 s88, s52, 0x10002
  s_add_u32 s78, s81, 278528
  s_max_u32 s21, s52, 1
  s_sub_u32 s21, s21, 1
  s_cmp_lt_u32 s52, 98
  s_cselect_b32 s66, s65, 0x80000000
  s_cselect_b32 s68, 15, 1
  s_cmp_ge_u32 s52, 99
  s_cselect_b32 s66, s90, s66
  s_cselect_b32 s67, s52, s21
  v_mov_b32 v52, 0
  v_mov_b32 v53, 0
  v_mov_b32 v54, 0
  v_mov_b32 v55, 0
  v_mov_b32 v56, 0
  v_mov_b32 v57, 0
  v_mov_b32 v58, 0
  v_mov_b32 v59, 0
  v_mov_b32 v60, 0
  v_mov_b32 v61, 0
  v_mov_b32 v62, 0
  v_mov_b32 v63, 0
  v_mov_b32 v64, 0
  v_mov_b32 v65, 0
  v_mov_b32 v66, 0
  v_mov_b32 v67, 0
  v_mov_b32 v68, 0
  v_mov_b32 v69, 0
  v_mov_b32 v70, 0
  v_mov_b32 v71, 0
  v_mov_b32 v72, 0
  v_mov_b32 v73, 0
  v_mov_b32 v74, 0
  v_mov_b32 v75, 0
  v_mov_b32 v76, 0
  v_mov_b32 v77, 0
  v_mov_b32 v78, 0
  v_mov_b32 v79, 0
  v_mov_b32 v80, 0
  v_mov_b32 v81, 0
  v_mov_b32 v82, 0
  v_mov_b32 v83, 0
  v_mov_b32 v84, 0
  v_mov_b32 v85, 0
  v_mov_b32 v86, 0
  v_mov_b32 v87, 0
  s_sleep 4
  v_readfirstlane_b32 s21, v94
  s_cmp_lt_u32 s21, s46
  s_cselect_b32 s55, s55, 0
  s_cmp_lt_i32 s55, 0
  s_cbranch_scc1 fl_44
fl_45:
  s_mov_b32 s54, 0
  buffer_load_dwordx4 v[32:35], v4, s[4:7], s84 offen offset:0 sc1
  buffer_load_dwordx4 v[36:39], v4, s[4:7], s84 offen offset:1024 sc1
  buffer_load_dwordx4 v[40:43], v4, s[4:7], s84 offen offset:2048 sc1
  s_waitcnt vmcnt(3)
  v_mov_b32 v176, v160
  v_mov_b32 v177, v161
  v_mov_b32 v178, v162
  v_mov_b32 v179, v163
  v_mov_b32 v180, v164
  v_mov_b32 v181, v165
  v_mov_b32 v182, v166
  v_mov_b32 v183, v167
  v_mov_b32 v184, v48
  v_mov_b32 v185, v49
  v_mov_b32 v186, v50
  v_mov_b32 v187, v51
  s_waitcnt vmcnt(0)
  v_bitop3_b32 v27, v35, v39, v43 bitop3:0x80
  v_perm_b32 v35, v39, v35, s89
  v_cmp_gt_u32 vcc, 0x48000000, v27
  v_mov_b32 v39, v42
  s_cbranch_vccnz pm_42
A1_16:
  v_smfmac_f32_16x16x32_f16 v[52:55], v[40:41], a[16:19], v44
  v_smfmac_f32_16x16x32_f16 v[64:67], v[40:41], a[76:79], v44
  v_smfmac_f32_16x16x32_f16 v[56:59], v[40:41], a[36:39], v44
  v_smfmac_f32_16x16x32_f16 v[68:71], v[40:41], a[96:99], v44
  v_smfmac_f32_16x16x64_f16 v[52:55], v[32:35], a[0:7], v44
  v_smfmac_f32_16x16x64_f16 v[52:55], v[36:39], a[8:15], v44
  v_smfmac_f32_16x16x64_f16 v[64:67], v[32:35], a[60:67], v44
  v_smfmac_f32_16x16x64_f16 v[64:67], v[36:39], a[68:75], v44
  v_smfmac_f32_16x16x32_f16 v[60:63], v[40:41], a[56:59], v44
  v_cvt_pk_f16_f32 v52, v52, v53
  v_cvt_pk_f16_f32 v53, v54, v55
  v_smfmac_f32_16x16x32_f16 v[72:75], v[40:41], a[116:119], v44
  v_smfmac_f32_16x16x32_f16 v[76:79], v[40:41], a[136:139], v44
  v_cvt_pk_f16_f32 v64, v64, v65
  v_cvt_pk_f16_f32 v65, v66, v67
  s_nop 0
  v_smfmac_f32_16x16x64_f16 v[56:59], v[32:35], a[20:27], v44
  v_permlane32_swap_b32 v52, v64
  v_smfmac_f32_16x16x64_f16 v[56:59], v[36:39], a[28:35], v44
  v_permlane32_swap_b32 v53, v65
  v_pk_add_f16 v52, v52, v64
  v_smfmac_f32_16x16x64_f16 v[68:71], v[32:35], a[80:87], v44
  v_pk_add_f16 v53, v53, v65
  v_smfmac_f32_16x16x64_f16 v[68:71], v[36:39], a[88:95], v44
  ds_write_b64 v5, v[52:53] offset:0
  v_smfmac_f32_16x16x32_f16 v[80:83], v[40:41], a[156:159], v44
  v_cvt_pk_f16_f32 v56, v56, v57
  v_cvt_pk_f16_f32 v57, v58, v59
  v_smfmac_f32_16x16x32_f16 v[84:87], v[40:41], a[176:179], v44
  v_cvt_pk_f16_f32 v68, v68, v69
  v_cvt_pk_f16_f32 v69, v70, v71
  s_nop 0
  v_smfmac_f32_16x16x64_f16 v[60:63], v[32:35], a[40:47], v44
  v_permlane32_swap_b32 v56, v68
  v_smfmac_f32_16x16x64_f16 v[60:63], v[36:39], a[48:55], v44
  v_permlane32_swap_b32 v57, v69
  v_pk_add_f16 v56, v56, v68
  v_smfmac_f32_16x16x64_f16 v[72:75], v[32:35], a[100:107], v44
  v_pk_add_f16 v57, v57, v69
  v_smfmac_f32_16x16x64_f16 v[72:75], v[36:39], a[108:115], v44
  ds_write_b64 v5, v[56:57] offset:640
  v_smfmac_f32_16x16x64_f16 v[76:79], v[32:35], a[120:127], v44
  v_cvt_pk_f16_f32 v60, v60, v61
  v_cvt_pk_f16_f32 v61, v62, v63
  v_smfmac_f32_16x16x64_f16 v[76:79], v[36:39], a[128:135], v44
  v_cvt_pk_f16_f32 v72, v72, v73
  v_cvt_pk_f16_f32 v73, v74, v75
  s_nop 0
  v_smfmac_f32_16x16x64_f16 v[80:83], v[32:35], a[140:147], v44
  v_permlane32_swap_b32 v60, v72
  v_smfmac_f32_16x16x64_f16 v[80:83], v[36:39], a[148:155], v44
  v_permlane32_swap_b32 v61, v73
  v_pk_add_f16 v60, v60, v72
  v_smfmac_f32_16x16x64_f16 v[84:87], v[32:35], a[160:167], v44
  v_pk_add_f16 v61, v61, v73
  v_smfmac_f32_16x16x64_f16 v[84:87], v[36:39], a[168:175], v44
  ds_write_b64 v5, v[60:61] offset:1280
  v_cvt_pk_f16_f32 v76, v76, v77
  v_cvt_pk_f16_f32 v77, v78, v79
  v_cvt_pk_f16_f32 v80, v80, v81
  v_cvt_pk_f16_f32 v81, v82, v83
  s_nop 0
  v_permlane32_swap_b32 v76, v80
  v_permlane32_swap_b32 v77, v81
  v_pk_add_f16 v76, v76, v80
  v_pk_add_f16 v77, v77, v81
  ds_write_b64 v5, v[76:77] offset:1920
  v_cvt_pk_f16_f32 v84, v84, v85
  v_cvt_pk_f16_f32 v85, v86, v87
  ds_write_b64 v5, v[84:85] offset:2560
  s_waitcnt lgkmcnt(0) vmcnt(0)
  s_barrier
  ds_read_b64_tr_b16 v[104:105], v45 offset:0
  ds_read_b64_tr_b16 v[106:107], v45 offset:3200
  ds_read_b64_tr_b16 v[108:109], v45 offset:640
  ds_read_b64_tr_b16 v[110:111], v45 offset:3840
  ds_read_b64_tr_b16 v[112:113], v45 offset:1280
  ds_read_b64_tr_b16 v[114:115], v45 offset:4480
  s_waitcnt lgkmcnt(4)
  v_fma_mix_f32 v120, v104, 1.0, v106 op_sel:[0,0,0] op_sel_hi:[1,0,1]
  v_fma_mix_f32 v121, v104, 1.0, v106 op_sel:[1,0,1] op_sel_hi:[1,0,1]
  v_fma_mix_f32 v122, v105, 1.0, v107 op_sel:[0,0,0] op_sel_hi:[1,0,1]
  v_fma_mix_f32 v123, v105, 1.0, v107 op_sel:[1,0,1] op_sel_hi:[1,0,1]
  v_add_f32_dpp v124, v120, v120 row_ror:8 row_mask:0xf bank_mask:0xf
  v_add_f32_dpp v125, v121, v121 row_ror:8 row_mask:0xf bank_mask:0xf
  v_add_f32_dpp v126, v122, v122 row_ror:8 row_mask:0xf bank_mask:0xf
  v_add_f32_dpp v127, v123, v123 row_ror:8 row_mask:0xf bank_mask:0xf
  v_cvt_pk_bf16_f32 v212, v124, v125
  v_cvt_pk_bf16_f32 v213, v126, v127
  s_waitcnt lgkmcnt(2)
  v_fma_mix_f32 v120, v108, 1.0, v110 op_sel:[0,0,0] op_sel_hi:[1,0,1]
  v_fma_mix_f32 v121, v108, 1.0, v110 op_sel:[1,0,1] op_sel_hi:[1,0,1]
  v_fma_mix_f32 v122, v109, 1.0, v111 op_sel:[0,0,0] op_sel_hi:[1,0,1]
  v_fma_mix_f32 v123, v109, 1.0, v111 op_sel:[1,0,1] op_sel_hi:[1,0,1]
  v_add_f32_dpp v124, v120, v120 row_ror:8 row_mask:0xf bank_mask:0xf
  v_add_f32_dpp v125, v121, v121 row_ror:8 row_mask:0xf bank_mask:0xf
  v_add_f32_dpp v126, v122, v122 row_ror:8 row_mask:0xf bank_mask:0xf
  v_add_f32_dpp v127, v123, v123 row_ror:8 row_mask:0xf bank_mask:0xf
  v_cvt_pk_bf16_f32 v214, v124, v125
  v_cvt_pk_bf16_f32 v215, v126, v127
  s_waitcnt lgkmcnt(0)
  v_fma_mix_f32 v120, v112, 1.0, v114 op_sel:[0,0,0] op_sel_hi:[1,0,1]
  v_fma_mix_f32 v121, v112, 1.0, v114 op_sel:[1,0,1] op_sel_hi:[1,0,1]
  v_fma_mix_f32 v122, v113, 1.0, v115 op_sel:[0,0,0] op_sel_hi:[1,0,1]
  v_fma_mix_f32 v123, v113, 1.0, v115 op_sel:[1,0,1] op_sel_hi:[1,0,1]
  v_mfma_f32_16x16x32_bf16 v[96:99], v[168:171], v[212:215], 0
  v_add_f32_dpp v124, v120, v120 row_ror:8 row_mask:0xf bank_mask:0xf
  v_add_f32_dpp v125, v121, v121 row_ror:8 row_mask:0xf bank_mask:0xf
  v_add_f32_dpp v126, v122, v122 row_ror:8 row_mask:0xf bank_mask:0xf
  v_add_f32_dpp v127, v123, v123 row_ror:8 row_mask:0xf bank_mask:0xf
  v_cvt_pk_bf16_f32 v216, v124, v125
  v_cvt_pk_bf16_f32 v217, v126, v127
  s_nop 1
  v_mfma_f32_16x16x32_bf16 v[96:99], v[172:175], v[216:219], v[96:99]
  s_mov_b64 exec, s[74:75]
  s_nop 6
  v_cvt_pk_f16_f32 v100, v96, v97
  v_cvt_pk_f16_f32 v101, v98, v99
  v_and_or_b32 v100, v100, -2, s88
  buffer_store_dwordx2 v[100:101], v7, s[8:11], s81 offen
  s_mov_b64 exec, -1
  s_cmp_eq_u32 s52, 63
  s_cbranch_scc1 last_41
  s_sleep 4
  s_nop 7
  s_mov_b32 s54, 0
  buffer_load_dwordx2 v[248:249], v9, s[8:11], s81 offen sc1
  buffer_load_dwordx4 v[112:115], v8, s[8:11], s81 offen offset:0 sc1
  buffer_load_dwordx4 v[116:119], v8, s[8:11], s81 offen offset:1024 sc1
  s_sleep 2
  buffer_load_dwordx4 v[144:147], v10, s[8:11], s81 offen offset:0 sc1
  buffer_load_dwordx4 v[148:151], v10, s[8:11], s81 offen offset:1024 sc1
  buffer_load_dwordx4 v[152:155], v10, s[8:11], s81 offen offset:2048 sc1
  v_mov_b32 v188, 0
  v_mov_b32 v189, 0
  v_mov_b32 v190, 0
  v_mov_b32 v191, 0
  v_mov_b32 v192, 0
  v_mov_b32 v193, 0
  v_mov_b32 v194, 0
  v_mov_b32 v195, 0
  v_mov_b32 v196, 0
  v_mov_b32 v197, 0
  v_mov_b32 v198, 0
  v_mov_b32 v199, 0
  v_readfirstlane_b32 s21, v94
  s_add_u32 s22, s46, 3
  s_min_u32 s22, s22, 64
  s_sub_u32 s55, s21, s22
  s_sub_u32 s56, s21, s46
  s_cmp_lt_i32 s56, 0
  s_cbranch_scc1 kvw_51
kvok_52:
  s_waitcnt vmcnt(5)
  v_xor_b32 v96, s88, v248
  s_nop 0
  v_permlane16_swap_b32 v248, v249
  v_fma_mix_f32 v250, v248, 1.0, v249 op_sel:[0,0,0] op_sel_hi:[1,0,1]
  v_fma_mix_f32 v251, v248, 1.0, v249 op_sel:[1,0,1] op_sel_hi:[1,0,1]
  v_mov_b32 v248, v250
  v_mov_b32 v249, v251
  s_nop 0
  v_permlane32_swap_b32 v248, v250
  v_permlane32_swap_b32 v249, v251
  v_pk_add_f32 v[124:125], v[248:249], v[250:251]
  v_max_f32 v238, v124, v125
  s_waitcnt vmcnt(3)
  v_pk_add_f16 v100, v112, v116
  v_pk_add_f16 v102, v114, v118
  v_pk_add_f16 v101, v113, v117
  v_pk_add_f16 v103, v115, v119
  v_permlane32_swap_b32 v100, v102
  v_bitop3_b32 v97, v112, v114, s88 bitop3:0x7e
  v_permlane32_swap_b32 v101, v103
  v_bitop3_b32 v98, v116, v118, s88 bitop3:0x7e
  v_fma_mix_f32 v120, v100, 1.0, v102 op_sel:[0,0,0] op_sel_hi:[1,0,1]
  v_or3_b32 v27, v96, v97, v98
  v_fma_mix_f32 v121, v100, 1.0, v102 op_sel:[1,0,1] op_sel_hi:[1,0,1]
  v_and_b32 v27, 1, v27
  v_fma_mix_f32 v122, v101, 1.0, v103 op_sel:[0,0,0] op_sel_hi:[1,0,1]
  v_cmp_ne_u32 vcc, 0, v27
  v_fma_mix_f32 v123, v101, 1.0, v103 op_sel:[1,0,1] op_sel_hi:[1,0,1]
  v_max3_f32 v236, v120, v121, v238
  s_cbranch_vccnz psr_48
psj_49:
  v_max3_f32 v236, v236, v122, v123
  s_nop 1
  v_max_f32_dpp v236, v236, v236 row_ror:8 row_mask:0xf bank_mask:0xf
  v_mov_b32 v237, v236
  s_waitcnt vmcnt(0)
  v_max3_u32 v27, v144, v146, v148
  v_permlane32_swap_b32 v236, v237
  v_max_f32 v236, v236, v237
  v_mov_b32 v237, v236
  v_max3_u32 v27, v27, v150, v152
  v_max_u32 v27, v27, v154
  v_permlane16_swap_b32 v236, v237
  v_cmp_eq_u32 vcc, -1, v27
  v_max_f32 v236, v236, v237
  v_mul_f32 v236, s86, v236
  s_cbranch_vccnz pv_47
pvj_50:
  v_smfmac_f32_16x16x64_bf16 v[188:191], v[144:147], a[180:187], v44
  v_fma_f32 v120, v120, s86, -v236
  v_smfmac_f32_16x16x64_bf16 v[188:191], v[148:151], a[188:195], v44
  v_fma_f32 v121, v121, s86, -v236
  v_smfmac_f32_16x16x64_bf16 v[188:191], v[152:155], a[196:203], v44
  buffer_load_dwordx4 v[160:163], v17, s[28:31], s64 offen offset:0 sc1
  v_fma_f32 v122, v122, s86, -v236
  v_smfmac_f32_16x16x64_bf16 v[192:195], v[144:147], a[204:211], v44
  v_fma_f32 v123, v123, s86, -v236
  v_smfmac_f32_16x16x64_bf16 v[192:195], v[148:151], a[212:219], v44
  buffer_load_dwordx4 v[164:167], v16, s[28:31], s64 offen offset:1024 sc1
  v_fma_f32 v124, v124, s86, -v236
  v_smfmac_f32_16x16x64_bf16 v[192:195], v[152:155], a[220:227], v44
  v_fma_f32 v125, v125, s86, -v236
  v_smfmac_f32_16x16x64_bf16 v[196:199], v[144:147], a[228:235], v44
  buffer_load_dwordx4 v[48:51], v26, s[28:31], s64 offen offset:2048 sc1
  v_exp_f32 v120, v120
  v_smfmac_f32_16x16x64_bf16 v[196:199], v[148:151], a[236:243], v44
  v_exp_f32 v121, v121
  v_smfmac_f32_16x16x64_bf16 v[196:199], v[152:155], a[244:251], v44
  buffer_load_dwordx4 v[168:171], v18, s[16:19], s80 offen sc1
  v_exp_f32 v122, v122
  buffer_load_dwordx2 v[172:173], v20, s[16:19], s80 offen sc1
  v_exp_f32 v123, v123
  v_exp_f32 v124, v124
  s_cmp_lt_i32 s55, 0
  s_cbranch_scc1 fl_53
fl_54:
  v_exp_f32 v125, v125
  v_cvt_pk_bf16_f32 v220, v120, v121
  v_cvt_pk_bf16_f32 v221, v122, v123
  v_cvt_pk_bf16_f32 v224, v124, v125
  v_mov_b32_dpp v222, v220 row_ror:8 row_mask:0xf bank_mask:0xf
  v_mov_b32_dpp v223, v221 row_ror:8 row_mask:0xf bank_mask:0xf
  v_mov_b32_dpp v225, v224 row_ror:8 row_mask:0xf bank_mask:0xf
  v_cvt_pk_bf16_f32 v228, v188, v189
  v_mfma_f32_16x16x32_bf16 v[200:203], v[176:179], v[220:223], 0
  v_cvt_pk_bf16_f32 v229, v190, v191
  v_cvt_pk_bf16_f32 v230, v192, v193
  v_mfma_f32_16x16x32_bf16 v[204:207], v[180:183], v[220:223], 0
  v_cvt_pk_bf16_f32 v231, v194, v195
  v_cvt_pk_bf16_f32 v232, v196, v197
  v_mfma_f32_16x16x32_bf16 v[208:211], v[184:187], v[220:223], 0
  v_cvt_pk_bf16_f32 v233, v198, v199
  v_add_f32 v126, v120, v121
  v_mfma_f32_16x16x32_bf16 v[200:203], v[228:231], v[224:227], v[200:203]
  v_add_f32 v127, v122, v123
  v_add_f32 v128, v124, v125
  v_mfma_f32_16x16x32_bf16 v[204:207], v[230:233], v[224:227], v[204:207]
  v_add_f32 v236, v126, v127
  v_fmac_f32 v236, v128, v89
  v_mfma_f32_16x16x32_bf16 v[208:211], v[232:235], v[224:227], v[208:211]
  s_nop 0
  v_add_f32_dpp v236, v236, v236 row_ror:8 row_mask:0xf bank_mask:0xf
  v_mov_b32 v237, v236
  ds_write_b128 v11, v[200:203] offset:0
  s_nop 0
  v_permlane32_swap_b32 v236, v237
  v_add_f32 v236, v236, v237
  v_mov_b32 v237, v236
  ds_write_b128 v11, v[204:207] offset:1024
  s_nop 0
  v_permlane16_swap_b32 v236, v237
  v_add_f32 v236, v236, v237
  v_rcp_f32 v236, v236
  ds_write_b128 v11, v[208:211] offset:2048
  s_mov_b64 exec, 0xff
  ds_write_b32 v242, v236
  s_mov_b64 exec, -1
  s_waitcnt lgkmcnt(0)
  s_barrier
  ds_read_b128 v[104:107], v243
  ds_read_b64 v[96:97], v12 offset:0
  ds_read_b64 v[98:99], v12 offset:3072
  ds_read_b64 v[100:101], v12 offset:6144
  ds_read_b64 v[102:103], v12 offset:9216
  s_waitcnt lgkmcnt(2)
  v_pk_mul_f32 v[96:97], v[96:97], v[104:105] op_sel_hi:[1,0]
  v_pk_fma_f32 v[96:97], v[98:99], v[104:105], v[96:97] op_sel:[0,1,0] op_sel_hi:[1,1,1]
  s_waitcnt lgkmcnt(0)
  v_pk_fma_f32 v[96:97], v[100:101], v[106:107], v[96:97] op_sel_hi:[1,0,1]
  v_pk_fma_f32 v[96:97], v[102:103], v[106:107], v[96:97] op_sel:[0,1,0] op_sel_hi:[1,1,1]
  v_cvt_pk_f16_f32 v100, v96, v97
  v_perm_b32 v100, s91, v100, v14
  buffer_atomic_pk_add_f16 v100, v13, s[4:7], s3 offen
  v_mov_b32 v200, v196
  v_mov_b32 v201, v197
  v_mov_b32 v202, v198
  v_mov_b32 v203, v199
  v_permlane32_swap_b32 v188, v192
  v_permlane32_swap_b32 v189, v193
  v_permlane32_swap_b32 v190, v194
  v_permlane32_swap_b32 v191, v195
  v_permlane32_swap_b32 v196, v200
  v_permlane32_swap_b32 v197, v201
  v_permlane32_swap_b32 v198, v202
  v_permlane32_swap_b32 v199, v203
  v_pk_add_f32 v[188:189], v[188:189], v[192:193]
  v_pk_add_f32 v[190:191], v[190:191], v[194:195]
  v_pk_add_f32 v[196:197], v[196:197], v[200:201]
  v_pk_add_f32 v[198:199], v[198:199], v[202:203]
  v_cvt_pk_bf16_f32 v252, v188, v189
  v_cvt_pk_bf16_f32 v254, v196, v197
  v_cvt_pk_bf16_f32 v253, v190, v191
  v_cvt_pk_bf16_f32 v255, v198, v199
  s_nop 0
  v_permlane16_swap_b32 v252, v254
  v_permlane16_swap_b32 v253, v255
  v_min_u32 v252, -2, v252
  s_mov_b64 exec, s[76:77]
  buffer_store_dwordx4 v[252:255], v15, s[24:27], s57 offen sc1
  s_mov_b64 exec, -1
  s_add_u32 s64, s64, 1310720
  s_add_u32 s52, s52, 1
  s_and_b32 s21, s52, 3
  s_mul_i32 s81, s21, 540672
  s_lshl_b32 s84, s21, 15
  s_branch step_40
fl_44:
  buffer_load_dword v94, v95, s[12:15], s79 offen sc1
  s_branch fl_45
pm_42:
  s_cmp_gt_u32 s52, 3
  s_cbranch_scc1 op_55
  v_readfirstlane_b32 s21, v94
  s_cmp_ge_u32 s21, s46
  s_cbranch_scc1 op_55
  buffer_load_dword v94, v95, s[12:15], s79 offen sc1
  s_waitcnt vmcnt(0)
  v_readfirstlane_b32 s21, v94
  s_add_u32 s22, s46, 3
  s_min_u32 s22, s22, 64
  s_sub_u32 s55, s21, s22
  s_sub_u32 s56, s21, s46
  s_cmp_gt_u32 s21, s52
  s_cselect_b32 s21, s87, 0
  s_cmp_eq_u32 s21, 0
  s_cbranch_scc1 op_55
  s_mov_b32 s87, 0
  s_sub_u32 s21, s64, 1310720
  buffer_load_dwordx4 v[176:179], v16, s[28:31], s21 offen offset:0 sc1
  buffer_load_dwordx4 v[180:183], v16, s[28:31], s21 offen offset:1024 sc1
  buffer_load_dwordx4 v[184:187], v16, s[28:31], s21 offen offset:2048 sc1
op_55:
  buffer_load_dwordx4 v[32:35], v4, s[4:7], s84 offen offset:0 sc1
  buffer_load_dwordx4 v[36:39], v4, s[4:7], s84 offen offset:1024 sc1
  buffer_load_dwordx4 v[40:43], v4, s[4:7], s84 offen offset:2048 sc1
  s_add_u32 s54, s54, 1
  s_cmp_gt_u32 s54, 131072
  s_cbranch_scc1 end0
  s_waitcnt vmcnt(0)
  v_bitop3_b32 v27, v35, v39, v43 bitop3:0x80
  v_perm_b32 v35, v39, v35, s89
  v_cmp_gt_u32 vcc, 0x48000000, v27
  v_mov_b32 v39, v42
  s_cbranch_vccnz pm_42
  s_branch A1_16
pv_47:
  buffer_load_dwordx4 v[144:147], v10, s[8:11], s81 offen offset:0 sc1
  buffer_load_dwordx4 v[148:151], v10, s[8:11], s81 offen offset:1024 sc1
  buffer_load_dwordx4 v[152:155], v10, s[8:11], s81 offen offset:2048 sc1
  s_add_u32 s54, s54, 1
  s_cmp_gt_u32 s54, 131072
  s_cbranch_scc1 end0
  s_waitcnt vmcnt(0)
  v_max3_u32 v27, v144, v146, v148
  v_max3_u32 v27, v27, v150, v152
  v_max3_u32 v27, v27, v154, v154
  v_cmp_eq_u32 vcc, -1, v27
  s_nop 1
  s_cbranch_vccnz pv_47
  s_branch pvj_50
psr_48:
  buffer_load_dwordx2 v[248:249], v9, s[8:11], s81 offen sc1
  buffer_load_dwordx4 v[112:115], v8, s[8:11], s81 offen offset:0 sc1
  buffer_load_dwordx4 v[116:119], v8, s[8:11], s81 offen offset:1024 sc1
  s_add_u32 s54, s54, 1
  s_cmp_gt_u32 s54, 131072
  s_cbranch_scc1 end0
  s_waitcnt vmcnt(2)
  v_xor_b32 v96, s88, v248
  s_nop 0
  v_permlane16_swap_b32 v248, v249
  v_fma_mix_f32 v250, v248, 1.0, v249 op_sel:[0,0,0] op_sel_hi:[1,0,1]
  v_fma_mix_f32 v251, v248, 1.0, v249 op_sel:[1,0,1] op_sel_hi:[1,0,1]
  v_mov_b32 v248, v250
  v_mov_b32 v249, v251
  s_nop 0
  v_permlane32_swap_b32 v248, v250
  v_permlane32_swap_b32 v249, v251
  v_pk_add_f32 v[124:125], v[248:249], v[250:251]
  v_max_f32 v238, v124, v125
  s_waitcnt vmcnt(0)
  v_pk_add_f16 v100, v112, v116
  v_pk_add_f16 v102, v114, v118
  v_pk_add_f16 v101, v113, v117
  v_pk_add_f16 v103, v115, v119
  v_permlane32_swap_b32 v100, v102
  v_bitop3_b32 v97, v112, v114, s88 bitop3:0x7e
  v_permlane32_swap_b32 v101, v103
  v_bitop3_b32 v98, v116, v118, s88 bitop3:0x7e
  v_fma_mix_f32 v120, v100, 1.0, v102 op_sel:[0,0,0] op_sel_hi:[1,0,1]
  v_or3_b32 v27, v96, v97, v98
  v_fma_mix_f32 v121, v100, 1.0, v102 op_sel:[1,0,1] op_sel_hi:[1,0,1]
  v_and_b32 v27, 1, v27
  v_fma_mix_f32 v122, v101, 1.0, v103 op_sel:[0,0,0] op_sel_hi:[1,0,1]
  v_cmp_ne_u32 vcc, 0, v27
  v_fma_mix_f32 v123, v101, 1.0, v103 op_sel:[1,0,1] op_sel_hi:[1,0,1]
  v_max3_f32 v236, v120, v121, v238
  s_cbranch_vccnz psr_48
  s_branch psj_49
kvw_51:
  s_mov_b32 s22, s87
  s_cmp_eq_u32 s52, 0
  s_cselect_b32 s23, s87, s46
  s_cselect_b32 s55, 0, s55
  s_cselect_b32 s87, 1, 0
  s_cmp_eq_u32 s23, 0
  s_cbranch_scc1 kvok_52
  v_mov_b32 v236, 0
  s_mov_b32 s101, 0
wf_56:
  buffer_load_dword v237, v236, s[12:15], s79 offen sc1
  s_add_u32 s101, s101, 1
  s_cmp_gt_u32 s101, 131072
  s_cbranch_scc1 end0
  s_waitcnt vmcnt(0)
  v_readfirstlane_b32 s100, v237
  s_cmp_ge_u32 s100, s23
  s_cbranch_scc1 wf_57
  s_sleep 3
  s_branch wf_56
wf_57:
  s_cmp_eq_u32 s22, 0
  s_cbranch_scc1 kvok_52
  s_sub_u32 s21, s64, 1310720
  buffer_load_dwordx4 v[176:179], v16, s[28:31], s21 offen offset:0 sc1
  buffer_load_dwordx4 v[180:183], v16, s[28:31], s21 offen offset:1024 sc1
  buffer_load_dwordx4 v[184:187], v16, s[28:31], s21 offen offset:2048 sc1
  s_waitcnt vmcnt(0)
  s_branch kvok_52
fl_53:
  buffer_load_dword v94, v95, s[12:15], s79 offen sc1
  s_branch fl_54
last_41:
  v_mov_b32 v188, 0
  v_mov_b32 v189, 0
  v_mov_b32 v190, 0
  v_mov_b32 v191, 0
  v_mov_b32 v192, 0
  v_mov_b32 v193, 0
  v_mov_b32 v194, 0
  v_mov_b32 v195, 0
  v_mov_b32 v196, 0
  v_mov_b32 v197, 0
  v_mov_b32 v198, 0
  v_mov_b32 v199, 0
  s_sleep 4
  s_mov_b32 s54, 0
lv_58:
  buffer_load_dwordx4 v[144:147], v10, s[8:11], s81 offen offset:0 sc1
  buffer_load_dwordx4 v[148:151], v10, s[8:11], s81 offen offset:1024 sc1
  buffer_load_dwordx4 v[152:155], v10, s[8:11], s81 offen offset:2048 sc1
  s_add_u32 s54, s54, 1
  s_cmp_gt_u32 s54, 131072
  s_cbranch_scc1 end0
  s_waitcnt vmcnt(0)
  v_max3_u32 v27, v144, v146, v148
  v_max3_u32 v27, v27, v150, v152
  v_max3_u32 v27, v27, v154, v154
  v_cmp_eq_u32 vcc, -1, v27
  s_nop 1
  s_cbranch_vccnz lv_58
  v_smfmac_f32_16x16x64_bf16 v[188:191], v[144:147], a[180:187], v44
  v_smfmac_f32_16x16x64_bf16 v[192:195], v[144:147], a[204:211], v44
  v_smfmac_f32_16x16x64_bf16 v[196:199], v[144:147], a[228:235], v44
  v_smfmac_f32_16x16x64_bf16 v[188:191], v[148:151], a[188:195], v44
  v_smfmac_f32_16x16x64_bf16 v[192:195], v[148:151], a[212:219], v44
  v_smfmac_f32_16x16x64_bf16 v[196:199], v[148:151], a[236:243], v44
  v_smfmac_f32_16x16x64_bf16 v[188:191], v[152:155], a[196:203], v44
  v_smfmac_f32_16x16x64_bf16 v[192:195], v[152:155], a[220:227], v44
  v_smfmac_f32_16x16x64_bf16 v[196:199], v[152:155], a[244:251], v44
  s_nop 7
  v_mov_b32 v200, v196
  v_mov_b32 v201, v197
  v_mov_b32 v202, v198
  v_mov_b32 v203, v199
  v_permlane32_swap_b32 v188, v192
  v_permlane32_swap_b32 v189, v193
  v_permlane32_swap_b32 v190, v194
  v_permlane32_swap_b32 v191, v195
  v_permlane32_swap_b32 v196, v200
  v_permlane32_swap_b32 v197, v201
  v_permlane32_swap_b32 v198, v202
  v_permlane32_swap_b32 v199, v203
  v_pk_add_f32 v[188:189], v[188:189], v[192:193]
  v_pk_add_f32 v[190:191], v[190:191], v[194:195]
  v_pk_add_f32 v[196:197], v[196:197], v[200:201]
  v_pk_add_f32 v[198:199], v[198:199], v[202:203]
  v_cvt_pk_bf16_f32 v252, v188, v189
  v_cvt_pk_bf16_f32 v254, v196, v197
  v_cvt_pk_bf16_f32 v253, v190, v191
  v_cvt_pk_bf16_f32 v255, v198, v199
  s_nop 0
  v_permlane16_swap_b32 v252, v254
  v_permlane16_swap_b32 v253, v255
  v_min_u32 v252, -2, v252
  s_mov_b64 exec, s[76:77]
  buffer_store_dwordx4 v[252:255], v15, s[24:27], s57 offen sc1
  s_mov_b64 exec, -1
  s_branch chain_done
step_59:
  s_add_u32 s21, s52, 2
  s_and_b32 s21, s21, 3
  s_mul_i32 s82, s21, 540672
  s_add_u32 s21, s52, 3
  s_and_b32 s21, s21, 3
  s_lshl_b32 s83, s21, 15
  s_add_u32 s21, s52, 1
  s_and_b32 s22, s21, 3
  s_lshl_b32 s3, s22, 15
  s_mul_i32 s80, s21, 393216
  s_add_u32 s46, s21, 1
  s_min_u32 s46, s46, 64
  s_mul_i32 s85, s52, 98304
  s_mul_i32 s57, s52, 327680
  s_add_u32 s57, s57, 42991616

  s_bfe_u32 s88, s52, 0x10002
  s_add_u32 s78, s81, 278528
  s_max_u32 s21, s52, 1
  s_sub_u32 s21, s21, 1
  s_cmp_lt_u32 s52, 98
  s_cselect_b32 s66, s65, 0x80000000
  s_cselect_b32 s68, 15, 1
  s_cmp_ge_u32 s52, 99
  s_cselect_b32 s66, s90, s66
  s_cselect_b32 s67, s52, s21
  v_mov_b32 v52, 0
  v_mov_b32 v53, 0
  v_mov_b32 v54, 0
  v_mov_b32 v55, 0
  v_mov_b32 v56, 0
  v_mov_b32 v57, 0
  v_mov_b32 v58, 0
  v_mov_b32 v59, 0
  v_mov_b32 v60, 0
  v_mov_b32 v61, 0
  v_mov_b32 v62, 0
  v_mov_b32 v63, 0
  v_mov_b32 v64, 0
  v_mov_b32 v65, 0
  v_mov_b32 v66, 0
  v_mov_b32 v67, 0
  v_mov_b32 v68, 0
  v_mov_b32 v69, 0
  v_mov_b32 v70, 0
  v_mov_b32 v71, 0
  v_mov_b32 v72, 0
  v_mov_b32 v73, 0
  v_mov_b32 v74, 0
  v_mov_b32 v75, 0
  v_mov_b32 v76, 0
  v_mov_b32 v77, 0
  v_mov_b32 v78, 0
  v_mov_b32 v79, 0
  v_mov_b32 v80, 0
  v_mov_b32 v81, 0
  v_mov_b32 v82, 0
  v_mov_b32 v83, 0
  v_mov_b32 v84, 0
  v_mov_b32 v85, 0
  v_mov_b32 v86, 0
  v_mov_b32 v87, 0
  s_sleep 3
  s_nop 3
  v_readfirstlane_b32 s21, v94
  s_cmp_lt_u32 s21, s46
  s_cselect_b32 s55, s55, 0
  s_cmp_lt_i32 s55, 0
  s_cbranch_scc1 fl_63
fl_64:
  s_mov_b32 s54, 0
  buffer_load_dwordx4 v[32:35], v4, s[4:7], s84 offen offset:0 sc1
  buffer_load_dwordx4 v[36:39], v4, s[4:7], s84 offen offset:1024 sc1
  buffer_load_dwordx4 v[40:43], v4, s[4:7], s84 offen offset:2048 sc1
  s_waitcnt vmcnt(3)
  v_mov_b32 v176, v160
  v_mov_b32 v177, v161
  v_mov_b32 v178, v162
  v_mov_b32 v179, v163
  v_mov_b32 v180, v164
  v_mov_b32 v181, v165
  v_mov_b32 v182, v166
  v_mov_b32 v183, v167
  v_mov_b32 v184, v48
  v_mov_b32 v185, v49
  v_mov_b32 v186, v50
  v_mov_b32 v187, v51
  s_waitcnt vmcnt(0)
  v_bitop3_b32 v27, v35, v39, v43 bitop3:0x80
  v_perm_b32 v35, v39, v35, s89
  v_cmp_gt_u32 vcc, 0x48000000, v27
  v_mov_b32 v39, v42
  s_cbranch_vccnz pm_61
A1_17:
  v_smfmac_f32_16x16x32_f16 v[52:55], v[40:41], a[16:19], v44
  v_smfmac_f32_16x16x32_f16 v[64:67], v[40:41], a[76:79], v44
  v_smfmac_f32_16x16x32_f16 v[56:59], v[40:41], a[36:39], v44
  v_smfmac_f32_16x16x32_f16 v[68:71], v[40:41], a[96:99], v44
  v_smfmac_f32_16x16x64_f16 v[52:55], v[32:35], a[0:7], v44
  v_smfmac_f32_16x16x64_f16 v[52:55], v[36:39], a[8:15], v44
  v_smfmac_f32_16x16x64_f16 v[64:67], v[32:35], a[60:67], v44
  v_smfmac_f32_16x16x64_f16 v[64:67], v[36:39], a[68:75], v44
  v_smfmac_f32_16x16x32_f16 v[60:63], v[40:41], a[56:59], v44
  v_cvt_pk_f16_f32 v52, v52, v53
  v_cvt_pk_f16_f32 v53, v54, v55
  v_smfmac_f32_16x16x32_f16 v[72:75], v[40:41], a[116:119], v44
  v_smfmac_f32_16x16x32_f16 v[76:79], v[40:41], a[136:139], v44
  v_cvt_pk_f16_f32 v64, v64, v65
  v_cvt_pk_f16_f32 v65, v66, v67
  s_nop 0
  v_smfmac_f32_16x16x64_f16 v[56:59], v[32:35], a[20:27], v44
  v_permlane32_swap_b32 v52, v64
  v_smfmac_f32_16x16x64_f16 v[56:59], v[36:39], a[28:35], v44
  v_permlane32_swap_b32 v53, v65
  v_pk_add_f16 v52, v52, v64
  v_smfmac_f32_16x16x64_f16 v[68:71], v[32:35], a[80:87], v44
  v_pk_add_f16 v53, v53, v65
  v_smfmac_f32_16x16x64_f16 v[68:71], v[36:39], a[88:95], v44
  ds_write_b64 v5, v[52:53] offset:0
  v_smfmac_f32_16x16x32_f16 v[80:83], v[40:41], a[156:159], v44
  v_cvt_pk_f16_f32 v56, v56, v57
  v_cvt_pk_f16_f32 v57, v58, v59
  v_smfmac_f32_16x16x32_f16 v[84:87], v[40:41], a[176:179], v44
  v_cvt_pk_f16_f32 v68, v68, v69
  v_cvt_pk_f16_f32 v69, v70, v71
  s_nop 0
  v_smfmac_f32_16x16x64_f16 v[60:63], v[32:35], a[40:47], v44
  v_permlane32_swap_b32 v56, v68
  v_smfmac_f32_16x16x64_f16 v[60:63], v[36:39], a[48:55], v44
  v_permlane32_swap_b32 v57, v69
  v_pk_add_f16 v56, v56, v68
  v_smfmac_f32_16x16x64_f16 v[72:75], v[32:35], a[100:107], v44
  v_pk_add_f16 v57, v57, v69
  v_smfmac_f32_16x16x64_f16 v[72:75], v[36:39], a[108:115], v44
  ds_write_b64 v5, v[56:57] offset:640
  v_smfmac_f32_16x16x64_f16 v[76:79], v[32:35], a[120:127], v44
  v_cvt_pk_f16_f32 v60, v60, v61
  v_cvt_pk_f16_f32 v61, v62, v63
  v_smfmac_f32_16x16x64_f16 v[76:79], v[36:39], a[128:135], v44
  v_cvt_pk_f16_f32 v72, v72, v73
  v_cvt_pk_f16_f32 v73, v74, v75
  s_nop 0
  v_smfmac_f32_16x16x64_f16 v[80:83], v[32:35], a[140:147], v44
  v_permlane32_swap_b32 v60, v72
  v_smfmac_f32_16x16x64_f16 v[80:83], v[36:39], a[148:155], v44
  v_permlane32_swap_b32 v61, v73
  v_pk_add_f16 v60, v60, v72
  v_smfmac_f32_16x16x64_f16 v[84:87], v[32:35], a[160:167], v44
  v_pk_add_f16 v61, v61, v73
  v_smfmac_f32_16x16x64_f16 v[84:87], v[36:39], a[168:175], v44
  ds_write_b64 v5, v[60:61] offset:1280
  v_cvt_pk_f16_f32 v76, v76, v77
  v_cvt_pk_f16_f32 v77, v78, v79
  v_cvt_pk_f16_f32 v80, v80, v81
  v_cvt_pk_f16_f32 v81, v82, v83
  s_nop 0
  v_permlane32_swap_b32 v76, v80
  v_permlane32_swap_b32 v77, v81
  v_pk_add_f16 v76, v76, v80
  v_pk_add_f16 v77, v77, v81
  ds_write_b64 v5, v[76:77] offset:1920
  v_cvt_pk_f16_f32 v84, v84, v85
  v_cvt_pk_f16_f32 v85, v86, v87
  ds_write_b64 v5, v[84:85] offset:2560
  s_waitcnt lgkmcnt(0) vmcnt(0)
  s_barrier
  ds_read_b64_tr_b16 v[104:105], v6 offset:0
  ds_read_b64_tr_b16 v[106:107], v6 offset:3200
  ds_read_b64_tr_b16 v[108:109], v6 offset:6400
  ds_read_b64_tr_b16 v[110:111], v6 offset:9600
  ds_read_b64_tr_b16 v[112:113], v6 offset:640
  ds_read_b64_tr_b16 v[114:115], v6 offset:3840
  ds_read_b64_tr_b16 v[116:117], v6 offset:7040
  ds_read_b64_tr_b16 v[118:119], v6 offset:10240
  ds_read_b64_tr_b16 v[120:121], v6 offset:1280
  ds_read_b64_tr_b16 v[122:123], v6 offset:4480
  ds_read_b64_tr_b16 v[124:125], v6 offset:7680
  ds_read_b64_tr_b16 v[126:127], v6 offset:10880
  s_waitcnt lgkmcnt(8)
  v_pk_add_f16 v104, v104, v106
  v_pk_add_f16 v108, v108, v110
  v_pk_add_f16 v105, v105, v107
  v_pk_add_f16 v109, v109, v111
  v_fma_mix_f32 v128, v104, 1.0, v108 op_sel:[0,0,0] op_sel_hi:[1,0,1]
  v_fma_mix_f32 v129, v104, 1.0, v108 op_sel:[1,0,1] op_sel_hi:[1,0,1]
  v_fma_mix_f32 v130, v105, 1.0, v109 op_sel:[0,0,0] op_sel_hi:[1,0,1]
  v_fma_mix_f32 v131, v105, 1.0, v109 op_sel:[1,0,1] op_sel_hi:[1,0,1]
  v_cvt_pk_bf16_f32 v212, v128, v129
  v_cvt_pk_bf16_f32 v213, v130, v131
  s_waitcnt lgkmcnt(4)
  v_pk_add_f16 v112, v112, v114
  v_pk_add_f16 v116, v116, v118
  v_pk_add_f16 v113, v113, v115
  v_pk_add_f16 v117, v117, v119
  v_fma_mix_f32 v128, v112, 1.0, v116 op_sel:[0,0,0] op_sel_hi:[1,0,1]
  v_fma_mix_f32 v129, v112, 1.0, v116 op_sel:[1,0,1] op_sel_hi:[1,0,1]
  v_fma_mix_f32 v130, v113, 1.0, v117 op_sel:[0,0,0] op_sel_hi:[1,0,1]
  v_fma_mix_f32 v131, v113, 1.0, v117 op_sel:[1,0,1] op_sel_hi:[1,0,1]
  v_cvt_pk_bf16_f32 v214, v128, v129
  v_cvt_pk_bf16_f32 v215, v130, v131
  s_waitcnt lgkmcnt(0)
  v_pk_add_f16 v120, v120, v122
  v_pk_add_f16 v124, v124, v126
  v_pk_add_f16 v121, v121, v123
  v_pk_add_f16 v125, v125, v127
  v_fma_mix_f32 v128, v120, 1.0, v124 op_sel:[0,0,0] op_sel_hi:[1,0,1]
  v_fma_mix_f32 v129, v120, 1.0, v124 op_sel:[1,0,1] op_sel_hi:[1,0,1]
  v_mfma_f32_16x16x32_bf16 v[96:99], v[212:215], v[212:215], 0
  v_fma_mix_f32 v130, v121, 1.0, v125 op_sel:[0,0,0] op_sel_hi:[1,0,1]
  v_fma_mix_f32 v131, v121, 1.0, v125 op_sel:[1,0,1] op_sel_hi:[1,0,1]
  v_cvt_pk_bf16_f32 v216, v128, v129
  v_cvt_pk_bf16_f32 v217, v130, v131
  s_nop 1
  v_mfma_f32_16x16x32_bf16 v[96:99], v[216:219], v[216:219], v[96:99]
  s_mov_b64 exec, s[74:75]
  s_nop 6
  v_cvt_pk_f16_f32 v100, v96, v97
  v_cvt_pk_f16_f32 v101, v98, v99
  v_and_or_b32 v100, v100, -2, s88
  buffer_store_dwordx2 v[100:101], v7, s[8:11], s81 offen
  s_mov_b64 exec, -1
  s_cmp_eq_u32 s52, 63
  s_cbranch_scc1 last_60
  s_sleep 4
  s_nop 7
  s_mov_b32 s54, 0
  buffer_load_dwordx2 v[248:249], v9, s[8:11], s81 offen sc1
  buffer_load_dwordx4 v[112:115], v8, s[8:11], s81 offen offset:0 sc1
  buffer_load_dwordx4 v[116:119], v8, s[8:11], s81 offen offset:1024 sc1
  s_sleep 2
  buffer_load_dwordx4 v[144:147], v10, s[8:11], s81 offen offset:0 sc1
  buffer_load_dwordx4 v[148:151], v10, s[8:11], s81 offen offset:1024 sc1
  buffer_load_dwordx4 v[152:155], v10, s[8:11], s81 offen offset:2048 sc1
  v_mov_b32 v188, 0
  v_mov_b32 v189, 0
  v_mov_b32 v190, 0
  v_mov_b32 v191, 0
  v_mov_b32 v192, 0
  v_mov_b32 v193, 0
  v_mov_b32 v194, 0
  v_mov_b32 v195, 0
  v_mov_b32 v196, 0
  v_mov_b32 v197, 0
  v_mov_b32 v198, 0
  v_mov_b32 v199, 0
  v_readfirstlane_b32 s21, v94
  s_add_u32 s22, s46, 3
  s_min_u32 s22, s22, 64
  s_sub_u32 s55, s21, s22
  s_sub_u32 s56, s21, s46
  s_cmp_lt_i32 s56, 0
  s_cbranch_scc1 kvw_70
kvok_71:
  s_waitcnt vmcnt(5)
  v_xor_b32 v96, s88, v248
  s_nop 0
  v_permlane16_swap_b32 v248, v249
  v_fma_mix_f32 v250, v248, 1.0, v249 op_sel:[0,0,0] op_sel_hi:[1,0,1]
  v_fma_mix_f32 v251, v248, 1.0, v249 op_sel:[1,0,1] op_sel_hi:[1,0,1]
  v_mov_b32 v248, v250
  v_mov_b32 v249, v251
  s_nop 0
  v_permlane32_swap_b32 v248, v250
  v_permlane32_swap_b32 v249, v251
  v_pk_add_f32 v[124:125], v[248:249], v[250:251]
  v_max_f32 v238, v124, v125
  s_waitcnt vmcnt(3)
  v_pk_add_f16 v100, v112, v116
  v_pk_add_f16 v102, v114, v118
  v_pk_add_f16 v101, v113, v117
  v_pk_add_f16 v103, v115, v119
  v_permlane32_swap_b32 v100, v102
  v_bitop3_b32 v97, v112, v114, s88 bitop3:0x7e
  v_permlane32_swap_b32 v101, v103
  v_bitop3_b32 v98, v116, v118, s88 bitop3:0x7e
  v_fma_mix_f32 v120, v100, 1.0, v102 op_sel:[0,0,0] op_sel_hi:[1,0,1]
  v_or3_b32 v27, v96, v97, v98
  v_fma_mix_f32 v121, v100, 1.0, v102 op_sel:[1,0,1] op_sel_hi:[1,0,1]
  v_and_b32 v27, 1, v27
  v_fma_mix_f32 v122, v101, 1.0, v103 op_sel:[0,0,0] op_sel_hi:[1,0,1]
  v_cmp_ne_u32 vcc, 0, v27
  v_fma_mix_f32 v123, v101, 1.0, v103 op_sel:[1,0,1] op_sel_hi:[1,0,1]
  v_max3_f32 v236, v120, v121, v238
  s_cbranch_vccnz psr_67
psj_68:
  v_max3_f32 v236, v236, v122, v123
  s_nop 1
  v_max_f32_dpp v236, v236, v236 row_ror:8 row_mask:0xf bank_mask:0xf
  v_mov_b32 v237, v236
  s_waitcnt vmcnt(0)
  v_max3_u32 v27, v144, v146, v148
  v_permlane32_swap_b32 v236, v237
  v_max_f32 v236, v236, v237
  v_mov_b32 v237, v236
  v_max3_u32 v27, v27, v150, v152
  v_max_u32 v27, v27, v154
  v_permlane16_swap_b32 v236, v237
  v_cmp_eq_u32 vcc, -1, v27
  v_max_f32 v236, v236, v237
  v_mul_f32 v236, s86, v236
  s_cbranch_vccnz pv_66
pvj_69:
  v_smfmac_f32_16x16x64_bf16 v[188:191], v[144:147], a[180:187], v44
  v_fma_f32 v120, v120, s86, -v236
  v_smfmac_f32_16x16x64_bf16 v[188:191], v[148:151], a[188:195], v44
  v_fma_f32 v121, v121, s86, -v236
  v_smfmac_f32_16x16x64_bf16 v[188:191], v[152:155], a[196:203], v44
  buffer_load_dwordx4 v[160:163], v17, s[28:31], s64 offen offset:0 sc1
  v_fma_f32 v122, v122, s86, -v236
  v_smfmac_f32_16x16x64_bf16 v[192:195], v[144:147], a[204:211], v44
  v_fma_f32 v123, v123, s86, -v236
  v_smfmac_f32_16x16x64_bf16 v[192:195], v[148:151], a[212:219], v44
  buffer_load_dwordx4 v[164:167], v16, s[28:31], s64 offen offset:1024 sc1
  v_fma_f32 v124, v124, s86, -v236
  v_smfmac_f32_16x16x64_bf16 v[192:195], v[152:155], a[220:227], v44
  v_fma_f32 v125, v125, s86, -v236
  v_smfmac_f32_16x16x64_bf16 v[196:199], v[144:147], a[228:235], v44
  buffer_load_dwordx4 v[48:51], v26, s[28:31], s64 offen offset:2048 sc1
  v_exp_f32 v120, v120
  v_smfmac_f32_16x16x64_bf16 v[196:199], v[148:151], a[236:243], v44
  v_exp_f32 v121, v121
  v_smfmac_f32_16x16x64_bf16 v[196:199], v[152:155], a[244:251], v44
  v_exp_f32 v122, v122
  v_exp_f32 v123, v123
  v_exp_f32 v124, v124
  s_cmp_lt_i32 s55, 0
  s_cbranch_scc1 fl_72
fl_73:
  v_exp_f32 v125, v125
  v_cvt_pk_bf16_f32 v220, v120, v121
  v_cvt_pk_bf16_f32 v221, v122, v123
  v_cvt_pk_bf16_f32 v224, v124, v125
  v_mov_b32_dpp v222, v220 row_ror:8 row_mask:0xf bank_mask:0xf
  v_mov_b32_dpp v223, v221 row_ror:8 row_mask:0xf bank_mask:0xf
  v_mov_b32_dpp v225, v224 row_ror:8 row_mask:0xf bank_mask:0xf
  v_cvt_pk_bf16_f32 v228, v188, v189
  v_mfma_f32_16x16x32_bf16 v[200:203], v[176:179], v[220:223], 0
  v_cvt_pk_bf16_f32 v229, v190, v191
  v_cvt_pk_bf16_f32 v230, v192, v193
  v_mfma_f32_16x16x32_bf16 v[204:207], v[180:183], v[220:223], 0
  v_cvt_pk_bf16_f32 v231, v194, v195
  v_cvt_pk_bf16_f32 v232, v196, v197
  v_mfma_f32_16x16x32_bf16 v[208:211], v[184:187], v[220:223], 0
  v_cvt_pk_bf16_f32 v233, v198, v199
  v_add_f32 v126, v120, v121
  v_mfma_f32_16x16x32_bf16 v[200:203], v[228:231], v[224:227], v[200:203]
  v_add_f32 v127, v122, v123
  v_add_f32 v128, v124, v125
  v_mfma_f32_16x16x32_bf16 v[204:207], v[230:233], v[224:227], v[204:207]
  v_add_f32 v236, v126, v127
  v_fmac_f32 v236, v128, v89
  v_mfma_f32_16x16x32_bf16 v[208:211], v[232:235], v[224:227], v[208:211]
  s_nop 0
  v_add_f32_dpp v236, v236, v236 row_ror:8 row_mask:0xf bank_mask:0xf
  v_mov_b32 v237, v236
  ds_write_b128 v11, v[200:203] offset:0
  s_nop 0
  v_permlane32_swap_b32 v236, v237
  v_add_f32 v236, v236, v237
  v_mov_b32 v237, v236
  ds_write_b128 v11, v[204:207] offset:1024
  s_nop 0
  v_permlane16_swap_b32 v236, v237
  v_add_f32 v236, v236, v237
  v_rcp_f32 v236, v236
  ds_write_b128 v11, v[208:211] offset:2048
  s_mov_b64 exec, 0xff
  ds_write_b32 v242, v236
  s_mov_b64 exec, -1
  s_waitcnt lgkmcnt(0)
  s_barrier
  ds_read_b128 v[104:107], v243
  ds_read_b64 v[96:97], v12 offset:0
  ds_read_b64 v[98:99], v12 offset:3072
  ds_read_b64 v[100:101], v12 offset:6144
  ds_read_b64 v[102:103], v12 offset:9216
  s_waitcnt lgkmcnt(2)
  v_pk_mul_f32 v[96:97], v[96:97], v[104:105] op_sel_hi:[1,0]
  v_pk_fma_f32 v[96:97], v[98:99], v[104:105], v[96:97] op_sel:[0,1,0] op_sel_hi:[1,1,1]
  s_waitcnt lgkmcnt(0)
  v_pk_fma_f32 v[96:97], v[100:101], v[106:107], v[96:97] op_sel_hi:[1,0,1]
  v_pk_fma_f32 v[96:97], v[102:103], v[106:107], v[96:97] op_sel:[0,1,0] op_sel_hi:[1,1,1]
  v_cvt_pk_f16_f32 v100, v96, v97
  v_perm_b32 v100, s91, v100, v14
  buffer_atomic_pk_add_f16 v100, v13, s[4:7], s3 offen
  s_mov_b64 exec, s[62:63]
  buffer_store_dwordx4 v[212:215], v21, s[24:27], s85 offen sc1
  buffer_store_dwordx2 v[216:217], v23, s[24:27], s85 offen sc1
  s_mov_b64 exec, -1
  v_mov_b32 v200, v196
  v_mov_b32 v201, v197
  v_mov_b32 v202, v198
  v_mov_b32 v203, v199
  v_permlane32_swap_b32 v188, v192
  v_permlane32_swap_b32 v189, v193
  v_permlane32_swap_b32 v190, v194
  v_permlane32_swap_b32 v191, v195
  v_permlane32_swap_b32 v196, v200
  v_permlane32_swap_b32 v197, v201
  v_permlane32_swap_b32 v198, v202
  v_permlane32_swap_b32 v199, v203
  v_pk_add_f32 v[188:189], v[188:189], v[192:193]
  v_pk_add_f32 v[190:191], v[190:191], v[194:195]
  v_pk_add_f32 v[196:197], v[196:197], v[200:201]
  v_pk_add_f32 v[198:199], v[198:199], v[202:203]
  v_cvt_pk_bf16_f32 v252, v188, v189
  v_cvt_pk_bf16_f32 v254, v196, v197
  v_cvt_pk_bf16_f32 v253, v190, v191
  v_cvt_pk_bf16_f32 v255, v198, v199
  s_nop 0
  v_permlane16_swap_b32 v252, v254
  v_permlane16_swap_b32 v253, v255
  v_min_u32 v252, -2, v252
  s_mov_b64 exec, s[76:77]
  buffer_store_dwordx4 v[252:255], v15, s[24:27], s57 offen sc1
  s_mov_b64 exec, -1
  s_add_u32 s64, s64, 1310720
  s_add_u32 s52, s52, 1
  s_and_b32 s21, s52, 3
  s_mul_i32 s81, s21, 540672
  s_lshl_b32 s84, s21, 15
  s_branch step_59
fl_63:
  buffer_load_dword v94, v95, s[12:15], s79 offen sc1
  s_branch fl_64
pm_61:
  s_cmp_gt_u32 s52, 3
  s_cbranch_scc1 op_74
  v_readfirstlane_b32 s21, v94
  s_cmp_ge_u32 s21, s46
  s_cbranch_scc1 op_74
  buffer_load_dword v94, v95, s[12:15], s79 offen sc1
  s_waitcnt vmcnt(0)
  v_readfirstlane_b32 s21, v94
  s_add_u32 s22, s46, 3
  s_min_u32 s22, s22, 64
  s_sub_u32 s55, s21, s22
  s_sub_u32 s56, s21, s46
  s_cmp_gt_u32 s21, s52
  s_cselect_b32 s21, s87, 0
  s_cmp_eq_u32 s21, 0
  s_cbranch_scc1 op_74
  s_mov_b32 s87, 0
  s_sub_u32 s21, s64, 1310720
  buffer_load_dwordx4 v[176:179], v16, s[28:31], s21 offen offset:0 sc1
  buffer_load_dwordx4 v[180:183], v16, s[28:31], s21 offen offset:1024 sc1
  buffer_load_dwordx4 v[184:187], v16, s[28:31], s21 offen offset:2048 sc1
op_74:
  buffer_load_dwordx4 v[32:35], v4, s[4:7], s84 offen offset:0 sc1
  buffer_load_dwordx4 v[36:39], v4, s[4:7], s84 offen offset:1024 sc1
  buffer_load_dwordx4 v[40:43], v4, s[4:7], s84 offen offset:2048 sc1
  s_add_u32 s54, s54, 1
  s_cmp_gt_u32 s54, 131072
  s_cbranch_scc1 end0
  s_waitcnt vmcnt(0)
  v_bitop3_b32 v27, v35, v39, v43 bitop3:0x80
  v_perm_b32 v35, v39, v35, s89
  v_cmp_gt_u32 vcc, 0x48000000, v27
  v_mov_b32 v39, v42
  s_cbranch_vccnz pm_61
  s_branch A1_17
pv_66:
  buffer_load_dwordx4 v[144:147], v10, s[8:11], s81 offen offset:0 sc1
  buffer_load_dwordx4 v[148:151], v10, s[8:11], s81 offen offset:1024 sc1
  buffer_load_dwordx4 v[152:155], v10, s[8:11], s81 offen offset:2048 sc1
  s_add_u32 s54, s54, 1
  s_cmp_gt_u32 s54, 131072
  s_cbranch_scc1 end0
  s_waitcnt vmcnt(0)
  v_max3_u32 v27, v144, v146, v148
  v_max3_u32 v27, v27, v150, v152
  v_max3_u32 v27, v27, v154, v154
  v_cmp_eq_u32 vcc, -1, v27
  s_nop 1
  s_cbranch_vccnz pv_66
  s_branch pvj_69
psr_67:
  buffer_load_dwordx2 v[248:249], v9, s[8:11], s81 offen sc1
  buffer_load_dwordx4 v[112:115], v8, s[8:11], s81 offen offset:0 sc1
  buffer_load_dwordx4 v[116:119], v8, s[8:11], s81 offen offset:1024 sc1
  s_add_u32 s54, s54, 1
  s_cmp_gt_u32 s54, 131072
  s_cbranch_scc1 end0
  s_waitcnt vmcnt(2)
  v_xor_b32 v96, s88, v248
  s_nop 0
  v_permlane16_swap_b32 v248, v249
  v_fma_mix_f32 v250, v248, 1.0, v249 op_sel:[0,0,0] op_sel_hi:[1,0,1]
  v_fma_mix_f32 v251, v248, 1.0, v249 op_sel:[1,0,1] op_sel_hi:[1,0,1]
  v_mov_b32 v248, v250
  v_mov_b32 v249, v251
  s_nop 0
  v_permlane32_swap_b32 v248, v250
  v_permlane32_swap_b32 v249, v251
  v_pk_add_f32 v[124:125], v[248:249], v[250:251]
  v_max_f32 v238, v124, v125
  s_waitcnt vmcnt(0)
  v_pk_add_f16 v100, v112, v116
  v_pk_add_f16 v102, v114, v118
  v_pk_add_f16 v101, v113, v117
  v_pk_add_f16 v103, v115, v119
  v_permlane32_swap_b32 v100, v102
  v_bitop3_b32 v97, v112, v114, s88 bitop3:0x7e
  v_permlane32_swap_b32 v101, v103
  v_bitop3_b32 v98, v116, v118, s88 bitop3:0x7e
  v_fma_mix_f32 v120, v100, 1.0, v102 op_sel:[0,0,0] op_sel_hi:[1,0,1]
  v_or3_b32 v27, v96, v97, v98
  v_fma_mix_f32 v121, v100, 1.0, v102 op_sel:[1,0,1] op_sel_hi:[1,0,1]
  v_and_b32 v27, 1, v27
  v_fma_mix_f32 v122, v101, 1.0, v103 op_sel:[0,0,0] op_sel_hi:[1,0,1]
  v_cmp_ne_u32 vcc, 0, v27
  v_fma_mix_f32 v123, v101, 1.0, v103 op_sel:[1,0,1] op_sel_hi:[1,0,1]
  v_max3_f32 v236, v120, v121, v238
  s_cbranch_vccnz psr_67
  s_branch psj_68
kvw_70:
  s_mov_b32 s22, s87
  s_cmp_eq_u32 s52, 0
  s_cselect_b32 s23, s87, s46
  s_cselect_b32 s55, 0, s55
  s_cselect_b32 s87, 1, 0
  s_cmp_eq_u32 s23, 0
  s_cbranch_scc1 kvok_71
  v_mov_b32 v236, 0
  s_mov_b32 s101, 0
wf_75:
  buffer_load_dword v237, v236, s[12:15], s79 offen sc1
  s_add_u32 s101, s101, 1
  s_cmp_gt_u32 s101, 131072
  s_cbranch_scc1 end0
  s_waitcnt vmcnt(0)
  v_readfirstlane_b32 s100, v237
  s_cmp_ge_u32 s100, s23
  s_cbranch_scc1 wf_76
  s_sleep 3
  s_branch wf_75
wf_76:
  s_cmp_eq_u32 s22, 0
  s_cbranch_scc1 kvok_71
  s_sub_u32 s21, s64, 1310720
  buffer_load_dwordx4 v[176:179], v16, s[28:31], s21 offen offset:0 sc1
  buffer_load_dwordx4 v[180:183], v16, s[28:31], s21 offen offset:1024 sc1
  buffer_load_dwordx4 v[184:187], v16, s[28:31], s21 offen offset:2048 sc1
  s_waitcnt vmcnt(0)
  s_branch kvok_71
fl_72:
  buffer_load_dword v94, v95, s[12:15], s79 offen sc1
  s_branch fl_73
last_60:
  s_mov_b64 exec, s[62:63]
  buffer_store_dwordx4 v[212:215], v21, s[24:27], s85 offen sc1
  buffer_store_dwordx2 v[216:217], v23, s[24:27], s85 offen sc1
  s_mov_b64 exec, -1
  v_mov_b32 v188, 0
  v_mov_b32 v189, 0
  v_mov_b32 v190, 0
  v_mov_b32 v191, 0
  v_mov_b32 v192, 0
  v_mov_b32 v193, 0
  v_mov_b32 v194, 0
  v_mov_b32 v195, 0
  v_mov_b32 v196, 0
  v_mov_b32 v197, 0
  v_mov_b32 v198, 0
  v_mov_b32 v199, 0
  s_sleep 4
  s_mov_b32 s54, 0
lv_77:
  buffer_load_dwordx4 v[144:147], v10, s[8:11], s81 offen offset:0 sc1
  buffer_load_dwordx4 v[148:151], v10, s[8:11], s81 offen offset:1024 sc1
  buffer_load_dwordx4 v[152:155], v10, s[8:11], s81 offen offset:2048 sc1
  s_add_u32 s54, s54, 1
  s_cmp_gt_u32 s54, 131072
  s_cbranch_scc1 end0
  s_waitcnt vmcnt(0)
  v_max3_u32 v27, v144, v146, v148
  v_max3_u32 v27, v27, v150, v152
  v_max3_u32 v27, v27, v154, v154
  v_cmp_eq_u32 vcc, -1, v27
  s_nop 1
  s_cbranch_vccnz lv_77
  v_smfmac_f32_16x16x64_bf16 v[188:191], v[144:147], a[180:187], v44
  v_smfmac_f32_16x16x64_bf16 v[192:195], v[144:147], a[204:211], v44
  v_smfmac_f32_16x16x64_bf16 v[196:199], v[144:147], a[228:235], v44
  v_smfmac_f32_16x16x64_bf16 v[188:191], v[148:151], a[188:195], v44
  v_smfmac_f32_16x16x64_bf16 v[192:195], v[148:151], a[212:219], v44
  v_smfmac_f32_16x16x64_bf16 v[196:199], v[148:151], a[236:243], v44
  v_smfmac_f32_16x16x64_bf16 v[188:191], v[152:155], a[196:203], v44
  v_smfmac_f32_16x16x64_bf16 v[192:195], v[152:155], a[220:227], v44
  v_smfmac_f32_16x16x64_bf16 v[196:199], v[152:155], a[244:251], v44
  s_nop 7
  v_mov_b32 v200, v196
  v_mov_b32 v201, v197
  v_mov_b32 v202, v198
  v_mov_b32 v203, v199
  v_permlane32_swap_b32 v188, v192
  v_permlane32_swap_b32 v189, v193
  v_permlane32_swap_b32 v190, v194
  v_permlane32_swap_b32 v191, v195
  v_permlane32_swap_b32 v196, v200
  v_permlane32_swap_b32 v197, v201
  v_permlane32_swap_b32 v198, v202
  v_permlane32_swap_b32 v199, v203
  v_pk_add_f32 v[188:189], v[188:189], v[192:193]
  v_pk_add_f32 v[190:191], v[190:191], v[194:195]
  v_pk_add_f32 v[196:197], v[196:197], v[200:201]
  v_pk_add_f32 v[198:199], v[198:199], v[202:203]
  v_cvt_pk_bf16_f32 v252, v188, v189
  v_cvt_pk_bf16_f32 v254, v196, v197
  v_cvt_pk_bf16_f32 v253, v190, v191
  v_cvt_pk_bf16_f32 v255, v198, v199
  s_nop 0
  v_permlane16_swap_b32 v252, v254
  v_permlane16_swap_b32 v253, v255
  v_min_u32 v252, -2, v252
  s_mov_b64 exec, s[76:77]
  buffer_store_dwordx4 v[252:255], v15, s[24:27], s57 offen sc1
  s_mov_b64 exec, -1
  s_branch chain_done
step_78:
  s_add_u32 s21, s52, 2
  s_and_b32 s21, s21, 3
  s_mul_i32 s82, s21, 540672
  s_add_u32 s21, s52, 3
  s_and_b32 s21, s21, 3
  s_lshl_b32 s83, s21, 15
  s_add_u32 s21, s52, 1
  s_and_b32 s22, s21, 3
  s_lshl_b32 s3, s22, 15
  s_mul_i32 s80, s21, 393216
  s_add_u32 s46, s21, 1
  s_min_u32 s46, s46, 64
  s_mul_i32 s85, s52, 98304
  s_mul_i32 s57, s52, 327680
  s_add_u32 s57, s57, 42991616

  s_bfe_u32 s88, s52, 0x10002
  s_add_u32 s78, s81, 278528
  s_max_u32 s21, s52, 1
  s_sub_u32 s21, s21, 1
  s_cmp_lt_u32 s52, 98
  s_cselect_b32 s66, s65, 0x80000000
  s_cselect_b32 s68, 15, 1
  s_cmp_ge_u32 s52, 99
  s_cselect_b32 s66, s90, s66
  s_cselect_b32 s67, s52, s21
  v_mov_b32 v52, 0
  v_mov_b32 v53, 0
  v_mov_b32 v54, 0
  v_mov_b32 v55, 0
  v_mov_b32 v56, 0
  v_mov_b32 v57, 0
  v_mov_b32 v58, 0
  v_mov_b32 v59, 0
  v_mov_b32 v60, 0
  v_mov_b32 v61, 0
  v_mov_b32 v62, 0
  v_mov_b32 v63, 0
  v_mov_b32 v64, 0
  v_mov_b32 v65, 0
  v_mov_b32 v66, 0
  v_mov_b32 v67, 0
  v_mov_b32 v68, 0
  v_mov_b32 v69, 0
  v_mov_b32 v70, 0
  v_mov_b32 v71, 0
  v_mov_b32 v72, 0
  v_mov_b32 v73, 0
  v_mov_b32 v74, 0
  v_mov_b32 v75, 0
  v_mov_b32 v76, 0
  v_mov_b32 v77, 0
  v_mov_b32 v78, 0
  v_mov_b32 v79, 0
  v_mov_b32 v80, 0
  v_mov_b32 v81, 0
  v_mov_b32 v82, 0
  v_mov_b32 v83, 0
  v_mov_b32 v84, 0
  v_mov_b32 v85, 0
  v_mov_b32 v86, 0
  v_mov_b32 v87, 0
  s_sleep 4
  s_nop 3
  v_readfirstlane_b32 s21, v94
  s_cmp_lt_u32 s21, s46
  s_cselect_b32 s55, s55, 0
  s_cmp_lt_i32 s55, 0
  s_cbranch_scc1 fl_82
fl_83:
  s_mov_b32 s54, 0
  buffer_load_dwordx4 v[32:35], v4, s[4:7], s84 offen offset:0 sc1
  buffer_load_dwordx4 v[36:39], v4, s[4:7], s84 offen offset:1024 sc1
  buffer_load_dwordx4 v[40:43], v4, s[4:7], s84 offen offset:2048 sc1
  s_waitcnt vmcnt(3)
  v_mov_b32 v176, v160
  v_mov_b32 v177, v161
  v_mov_b32 v178, v162
  v_mov_b32 v179, v163
  v_mov_b32 v180, v164
  v_mov_b32 v181, v165
  v_mov_b32 v182, v166
  v_mov_b32 v183, v167
  v_mov_b32 v184, v48
  v_mov_b32 v185, v49
  v_mov_b32 v186, v50
  v_mov_b32 v187, v51
  s_waitcnt vmcnt(0)
  v_bitop3_b32 v27, v35, v39, v43 bitop3:0x80
  v_perm_b32 v35, v39, v35, s89
  v_cmp_gt_u32 vcc, 0x48000000, v27
  v_mov_b32 v39, v42
  s_cbranch_vccnz pm_80
A1_18:
  v_smfmac_f32_16x16x32_f16 v[52:55], v[40:41], a[16:19], v44
  v_smfmac_f32_16x16x32_f16 v[64:67], v[40:41], a[76:79], v44
  v_smfmac_f32_16x16x32_f16 v[56:59], v[40:41], a[36:39], v44
  v_smfmac_f32_16x16x32_f16 v[68:71], v[40:41], a[96:99], v44
  v_smfmac_f32_16x16x64_f16 v[52:55], v[32:35], a[0:7], v44
  v_smfmac_f32_16x16x64_f16 v[52:55], v[36:39], a[8:15], v44
  v_smfmac_f32_16x16x64_f16 v[64:67], v[32:35], a[60:67], v44
  v_smfmac_f32_16x16x64_f16 v[64:67], v[36:39], a[68:75], v44
  v_smfmac_f32_16x16x32_f16 v[60:63], v[40:41], a[56:59], v44
  v_cvt_pk_f16_f32 v52, v52, v53
  v_cvt_pk_f16_f32 v53, v54, v55
  v_smfmac_f32_16x16x32_f16 v[72:75], v[40:41], a[116:119], v44
  v_smfmac_f32_16x16x32_f16 v[76:79], v[40:41], a[136:139], v44
  v_cvt_pk_f16_f32 v64, v64, v65
  v_cvt_pk_f16_f32 v65, v66, v67
  s_nop 0
  v_smfmac_f32_16x16x64_f16 v[56:59], v[32:35], a[20:27], v44
  v_permlane32_swap_b32 v52, v64
  v_smfmac_f32_16x16x64_f16 v[56:59], v[36:39], a[28:35], v44
  v_permlane32_swap_b32 v53, v65
  v_pk_add_f16 v52, v52, v64
  v_smfmac_f32_16x16x64_f16 v[68:71], v[32:35], a[80:87], v44
  v_pk_add_f16 v53, v53, v65
  v_smfmac_f32_16x16x64_f16 v[68:71], v[36:39], a[88:95], v44
  ds_write_b64 v5, v[52:53] offset:0
  v_smfmac_f32_16x16x32_f16 v[80:83], v[40:41], a[156:159], v44
  v_cvt_pk_f16_f32 v56, v56, v57
  v_cvt_pk_f16_f32 v57, v58, v59
  v_smfmac_f32_16x16x32_f16 v[84:87], v[40:41], a[176:179], v44
  v_cvt_pk_f16_f32 v68, v68, v69
  v_cvt_pk_f16_f32 v69, v70, v71
  s_nop 0
  v_smfmac_f32_16x16x64_f16 v[60:63], v[32:35], a[40:47], v44
  v_permlane32_swap_b32 v56, v68
  v_smfmac_f32_16x16x64_f16 v[60:63], v[36:39], a[48:55], v44
  v_permlane32_swap_b32 v57, v69
  v_pk_add_f16 v56, v56, v68
  v_smfmac_f32_16x16x64_f16 v[72:75], v[32:35], a[100:107], v44
  v_pk_add_f16 v57, v57, v69
  v_smfmac_f32_16x16x64_f16 v[72:75], v[36:39], a[108:115], v44
  ds_write_b64 v5, v[56:57] offset:640
  v_smfmac_f32_16x16x64_f16 v[76:79], v[32:35], a[120:127], v44
  v_cvt_pk_f16_f32 v60, v60, v61
  v_cvt_pk_f16_f32 v61, v62, v63
  v_smfmac_f32_16x16x64_f16 v[76:79], v[36:39], a[128:135], v44
  v_cvt_pk_f16_f32 v72, v72, v73
  v_cvt_pk_f16_f32 v73, v74, v75
  s_nop 0
  v_smfmac_f32_16x16x64_f16 v[80:83], v[32:35], a[140:147], v44
  v_permlane32_swap_b32 v60, v72
  v_smfmac_f32_16x16x64_f16 v[80:83], v[36:39], a[148:155], v44
  v_permlane32_swap_b32 v61, v73
  v_pk_add_f16 v60, v60, v72
  v_smfmac_f32_16x16x64_f16 v[84:87], v[32:35], a[160:167], v44
  v_pk_add_f16 v61, v61, v73
  v_smfmac_f32_16x16x64_f16 v[84:87], v[36:39], a[168:175], v44
  ds_write_b64 v5, v[60:61] offset:1280
  v_cvt_pk_f16_f32 v76, v76, v77
  v_cvt_pk_f16_f32 v77, v78, v79
  v_cvt_pk_f16_f32 v80, v80, v81
  v_cvt_pk_f16_f32 v81, v82, v83
  s_nop 0
  v_permlane32_swap_b32 v76, v80
  v_permlane32_swap_b32 v77, v81
  v_pk_add_f16 v76, v76, v80
  v_pk_add_f16 v77, v77, v81
  ds_write_b64 v5, v[76:77] offset:1920
  v_cvt_pk_f16_f32 v84, v84, v85
  v_cvt_pk_f16_f32 v85, v86, v87
  ds_write_b64 v5, v[84:85] offset:2560
  s_waitcnt lgkmcnt(0) vmcnt(0)
  s_barrier
  ds_read_b64_tr_b16 v[96:97], v6 offset:1920
  ds_read_b64_tr_b16 v[98:99], v6 offset:5120
  ds_read_b64_tr_b16 v[100:101], v6 offset:8320
  ds_read_b64_tr_b16 v[102:103], v6 offset:11520
  ds_read_b64_tr_b16 v[104:105], v6 offset:2560
  ds_read_b64_tr_b16 v[106:107], v6 offset:5760
  ds_read_b64_tr_b16 v[108:109], v6 offset:8960
  ds_read_b64_tr_b16 v[110:111], v6 offset:12160
  s_waitcnt lgkmcnt(4)
  v_pk_add_f16 v96, v96, v98
  v_pk_add_f16 v100, v100, v102
  v_pk_add_f16 v97, v97, v99
  v_pk_add_f16 v101, v101, v103
  v_fma_mix_f32 v112, v96, 1.0, v100 op_sel:[0,0,0] op_sel_hi:[1,0,1]
  v_fma_mix_f32 v113, v96, 1.0, v100 op_sel:[1,0,1] op_sel_hi:[1,0,1]
  v_fma_mix_f32 v114, v97, 1.0, v101 op_sel:[0,0,0] op_sel_hi:[1,0,1]
  v_fma_mix_f32 v115, v97, 1.0, v101 op_sel:[1,0,1] op_sel_hi:[1,0,1]
  v_cvt_pk_bf16_f32 v90, v112, v113
  v_cvt_pk_bf16_f32 v91, v114, v115
  v_min_u32 v90, -2, v90
  buffer_store_dwordx2 v[90:91], v24, s[8:11], s81 offen
  s_waitcnt lgkmcnt(0)
  v_pk_add_f16 v104, v104, v106
  v_pk_add_f16 v108, v108, v110
  v_pk_add_f16 v105, v105, v107
  v_pk_add_f16 v109, v109, v111
  v_fma_mix_f32 v112, v104, 1.0, v108 op_sel:[0,0,0] op_sel_hi:[1,0,1]
  v_fma_mix_f32 v113, v104, 1.0, v108 op_sel:[1,0,1] op_sel_hi:[1,0,1]
  v_fma_mix_f32 v114, v105, 1.0, v109 op_sel:[0,0,0] op_sel_hi:[1,0,1]
  v_fma_mix_f32 v115, v105, 1.0, v109 op_sel:[1,0,1] op_sel_hi:[1,0,1]
  v_add_f32_dpp v116, v112, v112 row_ror:8 row_mask:0xf bank_mask:0xf
  v_add_f32_dpp v117, v113, v113 row_ror:8 row_mask:0xf bank_mask:0xf
  v_add_f32_dpp v118, v114, v114 row_ror:8 row_mask:0xf bank_mask:0xf
  v_add_f32_dpp v119, v115, v115 row_ror:8 row_mask:0xf bank_mask:0xf
  v_cvt_pk_bf16_f32 v92, v116, v117
  v_cvt_pk_bf16_f32 v93, v118, v119
  v_min_u32 v92, -2, v92
  s_mov_b64 exec, s[60:61]
  buffer_store_dwordx2 v[92:93], v23, s[8:11], s78 offen
  s_mov_b64 exec, -1
  s_cmp_eq_u32 s52, 63
  s_cbranch_scc1 last_79
  s_sleep 5
  s_nop 3
  s_mov_b32 s54, 0
  buffer_load_dwordx2 v[248:249], v9, s[8:11], s81 offen sc1
  buffer_load_dwordx4 v[112:115], v8, s[8:11], s81 offen offset:0 sc1
  buffer_load_dwordx4 v[116:119], v8, s[8:11], s81 offen offset:1024 sc1
  s_sleep 2
  buffer_load_dwordx4 v[144:147], v10, s[8:11], s81 offen offset:0 sc1
  buffer_load_dwordx4 v[148:151], v10, s[8:11], s81 offen offset:1024 sc1
  buffer_load_dwordx4 v[152:155], v10, s[8:11], s81 offen offset:2048 sc1
  v_mov_b32 v188, 0
  v_mov_b32 v189, 0
  v_mov_b32 v190, 0
  v_mov_b32 v191, 0
  v_mov_b32 v192, 0
  v_mov_b32 v193, 0
  v_mov_b32 v194, 0
  v_mov_b32 v195, 0
  v_mov_b32 v196, 0
  v_mov_b32 v197, 0
  v_mov_b32 v198, 0
  v_mov_b32 v199, 0
  v_readfirstlane_b32 s21, v94
  s_add_u32 s22, s46, 3
  s_min_u32 s22, s22, 64
  s_sub_u32 s55, s21, s22
  s_sub_u32 s56, s21, s46
  s_cmp_lt_i32 s56, 0
  s_cbranch_scc1 kvw_89
kvok_90:
  s_waitcnt vmcnt(5)
  v_xor_b32 v96, s88, v248
  s_nop 0
  v_permlane16_swap_b32 v248, v249
  v_fma_mix_f32 v250, v248, 1.0, v249 op_sel:[0,0,0] op_sel_hi:[1,0,1]
  v_fma_mix_f32 v251, v248, 1.0, v249 op_sel:[1,0,1] op_sel_hi:[1,0,1]
  v_mov_b32 v248, v250
  v_mov_b32 v249, v251
  s_nop 0
  v_permlane32_swap_b32 v248, v250
  v_permlane32_swap_b32 v249, v251
  v_pk_add_f32 v[124:125], v[248:249], v[250:251]
  v_max_f32 v238, v124, v125
  s_waitcnt vmcnt(3)
  v_pk_add_f16 v100, v112, v116
  v_pk_add_f16 v102, v114, v118
  v_pk_add_f16 v101, v113, v117
  v_pk_add_f16 v103, v115, v119
  v_permlane32_swap_b32 v100, v102
  v_bitop3_b32 v97, v112, v114, s88 bitop3:0x7e
  v_permlane32_swap_b32 v101, v103
  v_bitop3_b32 v98, v116, v118, s88 bitop3:0x7e
  v_fma_mix_f32 v120, v100, 1.0, v102 op_sel:[0,0,0] op_sel_hi:[1,0,1]
  v_or3_b32 v27, v96, v97, v98
  v_fma_mix_f32 v121, v100, 1.0, v102 op_sel:[1,0,1] op_sel_hi:[1,0,1]
  v_and_b32 v27, 1, v27
  v_fma_mix_f32 v122, v101, 1.0, v103 op_sel:[0,0,0] op_sel_hi:[1,0,1]
  v_cmp_ne_u32 vcc, 0, v27
  v_fma_mix_f32 v123, v101, 1.0, v103 op_sel:[1,0,1] op_sel_hi:[1,0,1]
  v_max3_f32 v236, v120, v121, v238
  s_cbranch_vccnz psr_86
psj_87:
  v_max3_f32 v236, v236, v122, v123
  s_nop 1
  v_max_f32_dpp v236, v236, v236 row_ror:8 row_mask:0xf bank_mask:0xf
  v_mov_b32 v237, v236
  s_waitcnt vmcnt(0)
  v_max3_u32 v27, v144, v146, v148
  v_permlane32_swap_b32 v236, v237
  v_max_f32 v236, v236, v237
  v_mov_b32 v237, v236
  v_max3_u32 v27, v27, v150, v152
  v_max_u32 v27, v27, v154
  v_permlane16_swap_b32 v236, v237
  v_cmp_eq_u32 vcc, -1, v27
  v_max_f32 v236, v236, v237
  v_mul_f32 v236, s86, v236
  s_cbranch_vccnz pv_85
pvj_88:
  v_smfmac_f32_16x16x64_bf16 v[188:191], v[144:147], a[180:187], v44
  v_fma_f32 v120, v120, s86, -v236
  v_smfmac_f32_16x16x64_bf16 v[188:191], v[148:151], a[188:195], v44
  v_fma_f32 v121, v121, s86, -v236
  v_smfmac_f32_16x16x64_bf16 v[188:191], v[152:155], a[196:203], v44
  buffer_load_dwordx4 v[160:163], v17, s[28:31], s64 offen offset:0 sc1
  v_fma_f32 v122, v122, s86, -v236
  v_smfmac_f32_16x16x64_bf16 v[192:195], v[144:147], a[204:211], v44
  v_fma_f32 v123, v123, s86, -v236
  v_smfmac_f32_16x16x64_bf16 v[192:195], v[148:151], a[212:219], v44
  buffer_load_dwordx4 v[164:167], v16, s[28:31], s64 offen offset:1024 sc1
  v_fma_f32 v124, v124, s86, -v236
  v_smfmac_f32_16x16x64_bf16 v[192:195], v[152:155], a[220:227], v44
  v_fma_f32 v125, v125, s86, -v236
  v_smfmac_f32_16x16x64_bf16 v[196:199], v[144:147], a[228:235], v44
  buffer_load_dwordx4 v[48:51], v26, s[28:31], s64 offen offset:2048 sc1
  v_exp_f32 v120, v120
  v_smfmac_f32_16x16x64_bf16 v[196:199], v[148:151], a[236:243], v44
  v_exp_f32 v121, v121
  v_smfmac_f32_16x16x64_bf16 v[196:199], v[152:155], a[244:251], v44
  v_exp_f32 v122, v122
  v_exp_f32 v123, v123
  v_mov_b32 v240, s67
  v_mov_b32 v241, s67
  s_mov_b64 exec, s[68:69]
  buffer_store_dwordx2 v[240:241], v88, s[12:15], s66 offen sc1
  s_mov_b64 exec, -1
  v_exp_f32 v124, v124
  s_cmp_lt_i32 s55, 0
  s_cbranch_scc1 fl_91
fl_92:
  v_exp_f32 v125, v125
  v_cvt_pk_bf16_f32 v220, v120, v121
  v_cvt_pk_bf16_f32 v221, v122, v123
  v_cvt_pk_bf16_f32 v224, v124, v125
  v_mov_b32_dpp v222, v220 row_ror:8 row_mask:0xf bank_mask:0xf
  v_mov_b32_dpp v223, v221 row_ror:8 row_mask:0xf bank_mask:0xf
  v_mov_b32_dpp v225, v224 row_ror:8 row_mask:0xf bank_mask:0xf
  v_cvt_pk_bf16_f32 v228, v188, v189
  v_mfma_f32_16x16x32_bf16 v[200:203], v[176:179], v[220:223], 0
  v_cvt_pk_bf16_f32 v229, v190, v191
  v_cvt_pk_bf16_f32 v230, v192, v193
  v_mfma_f32_16x16x32_bf16 v[204:207], v[180:183], v[220:223], 0
  v_cvt_pk_bf16_f32 v231, v194, v195
  v_cvt_pk_bf16_f32 v232, v196, v197
  v_mfma_f32_16x16x32_bf16 v[208:211], v[184:187], v[220:223], 0
  v_cvt_pk_bf16_f32 v233, v198, v199
  v_add_f32 v126, v120, v121
  v_mfma_f32_16x16x32_bf16 v[200:203], v[228:231], v[224:227], v[200:203]
  v_add_f32 v127, v122, v123
  v_add_f32 v128, v124, v125
  v_mfma_f32_16x16x32_bf16 v[204:207], v[230:233], v[224:227], v[204:207]
  v_add_f32 v236, v126, v127
  v_fmac_f32 v236, v128, v89
  v_mfma_f32_16x16x32_bf16 v[208:211], v[232:235], v[224:227], v[208:211]
  s_nop 0
  v_add_f32_dpp v236, v236, v236 row_ror:8 row_mask:0xf bank_mask:0xf
  v_mov_b32 v237, v236
  ds_write_b128 v11, v[200:203] offset:0
  s_nop 0
  v_permlane32_swap_b32 v236, v237
  v_add_f32 v236, v236, v237
  v_mov_b32 v237, v236
  ds_write_b128 v11, v[204:207] offset:1024
  s_nop 0
  v_permlane16_swap_b32 v236, v237
  v_add_f32 v236, v236, v237
  v_rcp_f32 v236, v236
  ds_write_b128 v11, v[208:211] offset:2048
  s_mov_b64 exec, 0xff
  ds_write_b32 v242, v236
  s_mov_b64 exec, -1
  s_waitcnt lgkmcnt(0)
  s_barrier
  v_mov_b32 v28, -1
  v_mov_b32 v29, -1
  buffer_store_dwordx2 v[28:29], v24, s[8:11], s82 offen
  s_mov_b64 exec, s[60:61]
  s_add_u32 s22, s82, 278528
  buffer_store_dwordx2 v[28:29], v23, s[8:11], s22 offen
  s_and_b32 s21, s52, 7
  s_cmp_lg_u32 s21, s50
  s_cbranch_scc1 zm_93
  s_mov_b64 exec, s[70:71]
  buffer_store_dwordx4 v[156:159], v13, s[4:7], s83 offen sc1
zm_93:
  s_mov_b64 exec, -1
  v_mov_b32 v200, v196
  v_mov_b32 v201, v197
  v_mov_b32 v202, v198
  v_mov_b32 v203, v199
  v_permlane32_swap_b32 v188, v192
  v_permlane32_swap_b32 v189, v193
  v_permlane32_swap_b32 v190, v194
  v_permlane32_swap_b32 v191, v195
  v_permlane32_swap_b32 v196, v200
  v_permlane32_swap_b32 v197, v201
  v_permlane32_swap_b32 v198, v202
  v_permlane32_swap_b32 v199, v203
  v_pk_add_f32 v[188:189], v[188:189], v[192:193]
  v_pk_add_f32 v[190:191], v[190:191], v[194:195]
  v_pk_add_f32 v[196:197], v[196:197], v[200:201]
  v_pk_add_f32 v[198:199], v[198:199], v[202:203]
  v_cvt_pk_bf16_f32 v252, v188, v189
  v_cvt_pk_bf16_f32 v254, v196, v197
  v_cvt_pk_bf16_f32 v253, v190, v191
  v_cvt_pk_bf16_f32 v255, v198, v199
  s_nop 0
  v_permlane16_swap_b32 v252, v254
  v_permlane16_swap_b32 v253, v255
  v_min_u32 v252, -2, v252
  s_mov_b64 exec, s[76:77]
  buffer_store_dwordx4 v[252:255], v15, s[24:27], s57 offen sc1
  s_mov_b64 exec, -1
  s_add_u32 s64, s64, 1310720
  s_add_u32 s52, s52, 1
  s_and_b32 s21, s52, 3
  s_mul_i32 s81, s21, 540672
  s_lshl_b32 s84, s21, 15
  s_branch step_78
fl_82:
  buffer_load_dword v94, v95, s[12:15], s79 offen sc1
  s_branch fl_83
pm_80:
  s_cmp_gt_u32 s52, 3
  s_cbranch_scc1 op_94
  v_readfirstlane_b32 s21, v94
  s_cmp_ge_u32 s21, s46
  s_cbranch_scc1 op_94
  buffer_load_dword v94, v95, s[12:15], s79 offen sc1
  s_waitcnt vmcnt(0)
  v_readfirstlane_b32 s21, v94
  s_add_u32 s22, s46, 3
  s_min_u32 s22, s22, 64
  s_sub_u32 s55, s21, s22
  s_sub_u32 s56, s21, s46
  s_cmp_gt_u32 s21, s52
  s_cselect_b32 s21, s87, 0
  s_cmp_eq_u32 s21, 0
  s_cbranch_scc1 op_94
  s_mov_b32 s87, 0
  s_sub_u32 s21, s64, 1310720
  buffer_load_dwordx4 v[176:179], v16, s[28:31], s21 offen offset:0 sc1
  buffer_load_dwordx4 v[180:183], v16, s[28:31], s21 offen offset:1024 sc1
  buffer_load_dwordx4 v[184:187], v16, s[28:31], s21 offen offset:2048 sc1
op_94:
  buffer_load_dwordx4 v[32:35], v4, s[4:7], s84 offen offset:0 sc1
  buffer_load_dwordx4 v[36:39], v4, s[4:7], s84 offen offset:1024 sc1
  buffer_load_dwordx4 v[40:43], v4, s[4:7], s84 offen offset:2048 sc1
  s_add_u32 s54, s54, 1
  s_cmp_gt_u32 s54, 131072
  s_cbranch_scc1 end0
  s_waitcnt vmcnt(0)
  v_bitop3_b32 v27, v35, v39, v43 bitop3:0x80
  v_perm_b32 v35, v39, v35, s89
  v_cmp_gt_u32 vcc, 0x48000000, v27
  v_mov_b32 v39, v42
  s_cbranch_vccnz pm_80
  s_branch A1_18
pv_85:
  buffer_load_dwordx4 v[144:147], v10, s[8:11], s81 offen offset:0 sc1
  buffer_load_dwordx4 v[148:151], v10, s[8:11], s81 offen offset:1024 sc1
  buffer_load_dwordx4 v[152:155], v10, s[8:11], s81 offen offset:2048 sc1
  s_add_u32 s54, s54, 1
  s_cmp_gt_u32 s54, 131072
  s_cbranch_scc1 end0
  s_waitcnt vmcnt(0)
  v_max3_u32 v27, v144, v146, v148
  v_max3_u32 v27, v27, v150, v152
  v_max3_u32 v27, v27, v154, v154
  v_cmp_eq_u32 vcc, -1, v27
  s_nop 1
  s_cbranch_vccnz pv_85
  s_branch pvj_88
psr_86:
  buffer_load_dwordx2 v[248:249], v9, s[8:11], s81 offen sc1
  buffer_load_dwordx4 v[112:115], v8, s[8:11], s81 offen offset:0 sc1
  buffer_load_dwordx4 v[116:119], v8, s[8:11], s81 offen offset:1024 sc1
  s_add_u32 s54, s54, 1
  s_cmp_gt_u32 s54, 131072
  s_cbranch_scc1 end0
  s_waitcnt vmcnt(2)
  v_xor_b32 v96, s88, v248
  s_nop 0
  v_permlane16_swap_b32 v248, v249
  v_fma_mix_f32 v250, v248, 1.0, v249 op_sel:[0,0,0] op_sel_hi:[1,0,1]
  v_fma_mix_f32 v251, v248, 1.0, v249 op_sel:[1,0,1] op_sel_hi:[1,0,1]
  v_mov_b32 v248, v250
  v_mov_b32 v249, v251
  s_nop 0
  v_permlane32_swap_b32 v248, v250
  v_permlane32_swap_b32 v249, v251
  v_pk_add_f32 v[124:125], v[248:249], v[250:251]
  v_max_f32 v238, v124, v125
  s_waitcnt vmcnt(0)
  v_pk_add_f16 v100, v112, v116
  v_pk_add_f16 v102, v114, v118
  v_pk_add_f16 v101, v113, v117
  v_pk_add_f16 v103, v115, v119
  v_permlane32_swap_b32 v100, v102
  v_bitop3_b32 v97, v112, v114, s88 bitop3:0x7e
  v_permlane32_swap_b32 v101, v103
  v_bitop3_b32 v98, v116, v118, s88 bitop3:0x7e
  v_fma_mix_f32 v120, v100, 1.0, v102 op_sel:[0,0,0] op_sel_hi:[1,0,1]
  v_or3_b32 v27, v96, v97, v98
  v_fma_mix_f32 v121, v100, 1.0, v102 op_sel:[1,0,1] op_sel_hi:[1,0,1]
  v_and_b32 v27, 1, v27
  v_fma_mix_f32 v122, v101, 1.0, v103 op_sel:[0,0,0] op_sel_hi:[1,0,1]
  v_cmp_ne_u32 vcc, 0, v27
  v_fma_mix_f32 v123, v101, 1.0, v103 op_sel:[1,0,1] op_sel_hi:[1,0,1]
  v_max3_f32 v236, v120, v121, v238
  s_cbranch_vccnz psr_86
  s_branch psj_87
kvw_89:
  s_mov_b32 s22, s87
  s_cmp_eq_u32 s52, 0
  s_cselect_b32 s23, s87, s46
  s_cselect_b32 s55, 0, s55
  s_cselect_b32 s87, 1, 0
  s_cmp_eq_u32 s23, 0
  s_cbranch_scc1 kvok_90
  v_mov_b32 v236, 0
  s_mov_b32 s101, 0
wf_95:
  buffer_load_dword v237, v236, s[12:15], s79 offen sc1
  s_add_u32 s101, s101, 1
  s_cmp_gt_u32 s101, 131072
  s_cbranch_scc1 end0
  s_waitcnt vmcnt(0)
  v_readfirstlane_b32 s100, v237
  s_cmp_ge_u32 s100, s23
  s_cbranch_scc1 wf_96
  s_sleep 3
  s_branch wf_95
wf_96:
  s_cmp_eq_u32 s22, 0
  s_cbranch_scc1 kvok_90
  s_sub_u32 s21, s64, 1310720
  buffer_load_dwordx4 v[176:179], v16, s[28:31], s21 offen offset:0 sc1
  buffer_load_dwordx4 v[180:183], v16, s[28:31], s21 offen offset:1024 sc1
  buffer_load_dwordx4 v[184:187], v16, s[28:31], s21 offen offset:2048 sc1
  s_waitcnt vmcnt(0)
  s_branch kvok_90
fl_91:
  buffer_load_dword v94, v95, s[12:15], s79 offen sc1
  s_branch fl_92
last_79:
  v_mov_b32 v188, 0
  v_mov_b32 v189, 0
  v_mov_b32 v190, 0
  v_mov_b32 v191, 0
  v_mov_b32 v192, 0
  v_mov_b32 v193, 0
  v_mov_b32 v194, 0
  v_mov_b32 v195, 0
  v_mov_b32 v196, 0
  v_mov_b32 v197, 0
  v_mov_b32 v198, 0
  v_mov_b32 v199, 0
  s_sleep 4
  s_mov_b32 s54, 0
lv_97:
  buffer_load_dwordx4 v[144:147], v10, s[8:11], s81 offen offset:0 sc1
  buffer_load_dwordx4 v[148:151], v10, s[8:11], s81 offen offset:1024 sc1
  buffer_load_dwordx4 v[152:155], v10, s[8:11], s81 offen offset:2048 sc1
  s_add_u32 s54, s54, 1
  s_cmp_gt_u32 s54, 131072
  s_cbranch_scc1 end0
  s_waitcnt vmcnt(0)
  v_max3_u32 v27, v144, v146, v148
  v_max3_u32 v27, v27, v150, v152
  v_max3_u32 v27, v27, v154, v154
  v_cmp_eq_u32 vcc, -1, v27
  s_nop 1
  s_cbranch_vccnz lv_97
  v_smfmac_f32_16x16x64_bf16 v[188:191], v[144:147], a[180:187], v44
  v_smfmac_f32_16x16x64_bf16 v[192:195], v[144:147], a[204:211], v44
  v_smfmac_f32_16x16x64_bf16 v[196:199], v[144:147], a[228:235], v44
  v_smfmac_f32_16x16x64_bf16 v[188:191], v[148:151], a[188:195], v44
  v_smfmac_f32_16x16x64_bf16 v[192:195], v[148:151], a[212:219], v44
  v_smfmac_f32_16x16x64_bf16 v[196:199], v[148:151], a[236:243], v44
  v_smfmac_f32_16x16x64_bf16 v[188:191], v[152:155], a[196:203], v44
  v_smfmac_f32_16x16x64_bf16 v[192:195], v[152:155], a[220:227], v44
  v_smfmac_f32_16x16x64_bf16 v[196:199], v[152:155], a[244:251], v44
  s_nop 7
  v_mov_b32 v200, v196
  v_mov_b32 v201, v197
  v_mov_b32 v202, v198
  v_mov_b32 v203, v199
  v_permlane32_swap_b32 v188, v192
  v_permlane32_swap_b32 v189, v193
  v_permlane32_swap_b32 v190, v194
  v_permlane32_swap_b32 v191, v195
  v_permlane32_swap_b32 v196, v200
  v_permlane32_swap_b32 v197, v201
  v_permlane32_swap_b32 v198, v202
  v_permlane32_swap_b32 v199, v203
  v_pk_add_f32 v[188:189], v[188:189], v[192:193]
  v_pk_add_f32 v[190:191], v[190:191], v[194:195]
  v_pk_add_f32 v[196:197], v[196:197], v[200:201]
  v_pk_add_f32 v[198:199], v[198:199], v[202:203]
  v_cvt_pk_bf16_f32 v252, v188, v189
  v_cvt_pk_bf16_f32 v254, v196, v197
  v_cvt_pk_bf16_f32 v253, v190, v191
  v_cvt_pk_bf16_f32 v255, v198, v199
  s_nop 0
  v_permlane16_swap_b32 v252, v254
  v_permlane16_swap_b32 v253, v255
  v_min_u32 v252, -2, v252
  s_mov_b64 exec, s[76:77]
  buffer_store_dwordx4 v[252:255], v15, s[24:27], s57 offen sc1
  s_mov_b64 exec, -1
  s_branch chain_done
step_98:
  s_add_u32 s21, s52, 2
  s_and_b32 s21, s21, 3
  s_mul_i32 s82, s21, 540672
  s_add_u32 s21, s52, 3
  s_and_b32 s21, s21, 3
  s_lshl_b32 s83, s21, 15
  s_add_u32 s21, s52, 1
  s_and_b32 s22, s21, 3
  s_lshl_b32 s3, s22, 15
  s_mul_i32 s80, s21, 393216
  s_add_u32 s46, s21, 1
  s_min_u32 s46, s46, 64
  s_mul_i32 s85, s52, 98304
  s_mul_i32 s57, s52, 327680
  s_add_u32 s57, s57, 42991616

  s_bfe_u32 s88, s52, 0x10002
  s_add_u32 s78, s81, 278528
  s_max_u32 s21, s52, 1
  s_sub_u32 s21, s21, 1
  s_cmp_lt_u32 s52, 98
  s_cselect_b32 s66, s65, 0x80000000
  s_cselect_b32 s68, 15, 1
  s_cmp_ge_u32 s52, 99
  s_cselect_b32 s66, s90, s66
  s_cselect_b32 s67, s52, s21
  v_mov_b32 v52, 0
  v_mov_b32 v53, 0
  v_mov_b32 v54, 0
  v_mov_b32 v55, 0
  v_mov_b32 v56, 0
  v_mov_b32 v57, 0
  v_mov_b32 v58, 0
  v_mov_b32 v59, 0
  v_mov_b32 v60, 0
  v_mov_b32 v61, 0
  v_mov_b32 v62, 0
  v_mov_b32 v63, 0
  v_mov_b32 v64, 0
  v_mov_b32 v65, 0
  v_mov_b32 v66, 0
  v_mov_b32 v67, 0
  v_mov_b32 v68, 0
  v_mov_b32 v69, 0
  v_mov_b32 v70, 0
  v_mov_b32 v71, 0
  v_mov_b32 v72, 0
  v_mov_b32 v73, 0
  v_mov_b32 v74, 0
  v_mov_b32 v75, 0
  v_mov_b32 v76, 0
  v_mov_b32 v77, 0
  v_mov_b32 v78, 0
  v_mov_b32 v79, 0
  v_mov_b32 v80, 0
  v_mov_b32 v81, 0
  v_mov_b32 v82, 0
  v_mov_b32 v83, 0
  v_mov_b32 v84, 0
  v_mov_b32 v85, 0
  v_mov_b32 v86, 0
  v_mov_b32 v87, 0
  s_sleep 8
  v_readfirstlane_b32 s21, v94
  s_cmp_lt_u32 s21, s46
  s_cselect_b32 s55, s55, 0
  s_cmp_lt_i32 s55, 0
  s_cbranch_scc1 fl_102
fl_103:
  s_mov_b32 s54, 0
  buffer_load_dwordx4 v[32:35], v4, s[4:7], s84 offen offset:0 sc1
  buffer_load_dwordx4 v[36:39], v4, s[4:7], s84 offen offset:1024 sc1
  buffer_load_dwordx4 v[40:43], v4, s[4:7], s84 offen offset:2048 sc1
  s_waitcnt vmcnt(3)
  v_mov_b32 v176, v160
  v_mov_b32 v177, v161
  v_mov_b32 v178, v162
  v_mov_b32 v179, v163
  v_mov_b32 v180, v164
  v_mov_b32 v181, v165
  v_mov_b32 v182, v166
  v_mov_b32 v183, v167
  v_mov_b32 v184, v48
  v_mov_b32 v185, v49
  v_mov_b32 v186, v50
  v_mov_b32 v187, v51
  s_waitcnt vmcnt(0)
  v_bitop3_b32 v27, v35, v39, v43 bitop3:0x80
  v_perm_b32 v35, v39, v35, s89
  v_cmp_gt_u32 vcc, 0x48000000, v27
  v_mov_b32 v39, v42
  s_cbranch_vccnz pm_100
A1_19:
  v_smfmac_f32_16x16x32_f16 v[52:55], v[40:41], a[16:19], v44
  v_smfmac_f32_16x16x32_f16 v[64:67], v[40:41], a[76:79], v44
  v_smfmac_f32_16x16x32_f16 v[56:59], v[40:41], a[36:39], v44
  v_smfmac_f32_16x16x32_f16 v[68:71], v[40:41], a[96:99], v44
  v_smfmac_f32_16x16x64_f16 v[52:55], v[32:35], a[0:7], v44
  v_smfmac_f32_16x16x64_f16 v[52:55], v[36:39], a[8:15], v44
  v_smfmac_f32_16x16x64_f16 v[64:67], v[32:35], a[60:67], v44
  v_smfmac_f32_16x16x64_f16 v[64:67], v[36:39], a[68:75], v44
  v_smfmac_f32_16x16x32_f16 v[60:63], v[40:41], a[56:59], v44
  v_cvt_pk_f16_f32 v52, v52, v53
  v_cvt_pk_f16_f32 v53, v54, v55
  v_smfmac_f32_16x16x32_f16 v[72:75], v[40:41], a[116:119], v44
  v_smfmac_f32_16x16x32_f16 v[76:79], v[40:41], a[136:139], v44
  v_cvt_pk_f16_f32 v64, v64, v65
  v_cvt_pk_f16_f32 v65, v66, v67
  s_nop 0
  v_smfmac_f32_16x16x64_f16 v[56:59], v[32:35], a[20:27], v44
  v_permlane32_swap_b32 v52, v64
  v_smfmac_f32_16x16x64_f16 v[56:59], v[36:39], a[28:35], v44
  v_permlane32_swap_b32 v53, v65
  v_pk_add_f16 v52, v52, v64
  v_smfmac_f32_16x16x64_f16 v[68:71], v[32:35], a[80:87], v44
  v_pk_add_f16 v53, v53, v65
  v_smfmac_f32_16x16x64_f16 v[68:71], v[36:39], a[88:95], v44
  ds_write_b64 v5, v[52:53] offset:0
  v_smfmac_f32_16x16x32_f16 v[80:83], v[40:41], a[156:159], v44
  v_cvt_pk_f16_f32 v56, v56, v57
  v_cvt_pk_f16_f32 v57, v58, v59
  v_smfmac_f32_16x16x32_f16 v[84:87], v[40:41], a[176:179], v44
  v_cvt_pk_f16_f32 v68, v68, v69
  v_cvt_pk_f16_f32 v69, v70, v71
  s_nop 0
  v_smfmac_f32_16x16x64_f16 v[60:63], v[32:35], a[40:47], v44
  v_permlane32_swap_b32 v56, v68
  v_smfmac_f32_16x16x64_f16 v[60:63], v[36:39], a[48:55], v44
  v_permlane32_swap_b32 v57, v69
  v_pk_add_f16 v56, v56, v68
  v_smfmac_f32_16x16x64_f16 v[72:75], v[32:35], a[100:107], v44
  v_pk_add_f16 v57, v57, v69
  v_smfmac_f32_16x16x64_f16 v[72:75], v[36:39], a[108:115], v44
  ds_write_b64 v5, v[56:57] offset:640
  v_smfmac_f32_16x16x64_f16 v[76:79], v[32:35], a[120:127], v44
  v_cvt_pk_f16_f32 v60, v60, v61
  v_cvt_pk_f16_f32 v61, v62, v63
  v_smfmac_f32_16x16x64_f16 v[76:79], v[36:39], a[128:135], v44
  v_cvt_pk_f16_f32 v72, v72, v73
  v_cvt_pk_f16_f32 v73, v74, v75
  s_nop 0
  v_smfmac_f32_16x16x64_f16 v[80:83], v[32:35], a[140:147], v44
  v_permlane32_swap_b32 v60, v72
  v_smfmac_f32_16x16x64_f16 v[80:83], v[36:39], a[148:155], v44
  v_permlane32_swap_b32 v61, v73
  v_pk_add_f16 v60, v60, v72
  v_smfmac_f32_16x16x64_f16 v[84:87], v[32:35], a[160:167], v44
  v_pk_add_f16 v61, v61, v73
  v_smfmac_f32_16x16x64_f16 v[84:87], v[36:39], a[168:175], v44
  ds_write_b64 v5, v[60:61] offset:1280
  v_cvt_pk_f16_f32 v76, v76, v77
  v_cvt_pk_f16_f32 v77, v78, v79
  v_cvt_pk_f16_f32 v80, v80, v81
  v_cvt_pk_f16_f32 v81, v82, v83
  s_nop 0
  v_permlane32_swap_b32 v76, v80
  v_permlane32_swap_b32 v77, v81
  v_pk_add_f16 v76, v76, v80
  v_pk_add_f16 v77, v77, v81
  ds_write_b64 v5, v[76:77] offset:1920
  v_cvt_pk_f16_f32 v84, v84, v85
  v_cvt_pk_f16_f32 v85, v86, v87
  ds_write_b64 v5, v[84:85] offset:2560
  s_waitcnt lgkmcnt(0) vmcnt(0)
  s_barrier
  s_lshr_b32 s21, 3, s20
  s_bitcmp1_b32 s21, 0
  s_cbranch_scc0 bw_106
  ds_read_b64_tr_b16 v[104:105], v45 offset:0
  ds_read_b64_tr_b16 v[106:107], v45 offset:3200
  ds_read_b64_tr_b16 v[108:109], v45 offset:640
  ds_read_b64_tr_b16 v[110:111], v45 offset:3840
  ds_read_b64_tr_b16 v[112:113], v45 offset:1280
  ds_read_b64_tr_b16 v[114:115], v45 offset:4480
  s_waitcnt lgkmcnt(4)
  v_fma_mix_f32 v120, v104, 1.0, v106 op_sel:[0,0,0] op_sel_hi:[1,0,1]
  v_fma_mix_f32 v121, v104, 1.0, v106 op_sel:[1,0,1] op_sel_hi:[1,0,1]
  v_fma_mix_f32 v122, v105, 1.0, v107 op_sel:[0,0,0] op_sel_hi:[1,0,1]
  v_fma_mix_f32 v123, v105, 1.0, v107 op_sel:[1,0,1] op_sel_hi:[1,0,1]
  v_add_f32_dpp v124, v120, v120 row_ror:8 row_mask:0xf bank_mask:0xf
  v_add_f32_dpp v125, v121, v121 row_ror:8 row_mask:0xf bank_mask:0xf
  v_add_f32_dpp v126, v122, v122 row_ror:8 row_mask:0xf bank_mask:0xf
  v_add_f32_dpp v127, v123, v123 row_ror:8 row_mask:0xf bank_mask:0xf
  v_cvt_pk_bf16_f32 v212, v124, v125
  v_cvt_pk_bf16_f32 v213, v126, v127
  s_waitcnt lgkmcnt(2)
  v_fma_mix_f32 v120, v108, 1.0, v110 op_sel:[0,0,0] op_sel_hi:[1,0,1]
  v_fma_mix_f32 v121, v108, 1.0, v110 op_sel:[1,0,1] op_sel_hi:[1,0,1]
  v_fma_mix_f32 v122, v109, 1.0, v111 op_sel:[0,0,0] op_sel_hi:[1,0,1]
  v_fma_mix_f32 v123, v109, 1.0, v111 op_sel:[1,0,1] op_sel_hi:[1,0,1]
  v_add_f32_dpp v124, v120, v120 row_ror:8 row_mask:0xf bank_mask:0xf
  v_add_f32_dpp v125, v121, v121 row_ror:8 row_mask:0xf bank_mask:0xf
  v_add_f32_dpp v126, v122, v122 row_ror:8 row_mask:0xf bank_mask:0xf
  v_add_f32_dpp v127, v123, v123 row_ror:8 row_mask:0xf bank_mask:0xf
  v_cvt_pk_bf16_f32 v214, v124, v125
  v_cvt_pk_bf16_f32 v215, v126, v127
  s_waitcnt lgkmcnt(0)
  v_fma_mix_f32 v120, v112, 1.0, v114 op_sel:[0,0,0] op_sel_hi:[1,0,1]
  v_fma_mix_f32 v121, v112, 1.0, v114 op_sel:[1,0,1] op_sel_hi:[1,0,1]
  v_fma_mix_f32 v122, v113, 1.0, v115 op_sel:[0,0,0] op_sel_hi:[1,0,1]
  v_fma_mix_f32 v123, v113, 1.0, v115 op_sel:[1,0,1] op_sel_hi:[1,0,1]
  v_mfma_f32_16x16x32_bf16 v[96:99], v[168:171], v[212:215], 0
  v_add_f32_dpp v124, v120, v120 row_ror:8 row_mask:0xf bank_mask:0xf
  v_add_f32_dpp v125, v121, v121 row_ror:8 row_mask:0xf bank_mask:0xf
  v_add_f32_dpp v126, v122, v122 row_ror:8 row_mask:0xf bank_mask:0xf
  v_add_f32_dpp v127, v123, v123 row_ror:8 row_mask:0xf bank_mask:0xf
  v_cvt_pk_bf16_f32 v216, v124, v125
  v_cvt_pk_bf16_f32 v217, v126, v127
  s_nop 1
  v_mfma_f32_16x16x32_bf16 v[96:99], v[172:175], v[216:219], v[96:99]
  s_mov_b64 exec, s[74:75]
  s_nop 6
  v_cvt_pk_f16_f32 v100, v96, v97
  v_cvt_pk_f16_f32 v101, v98, v99
  v_and_or_b32 v100, v100, -2, s88
  s_cmp_eq_u32 s53, 1
  s_cbranch_scc1 si_107
  buffer_store_dwordx2 v[100:101], v7, s[8:11], s81 offen sc1
  s_branch si_108
si_107:
  buffer_store_dwordx2 v[100:101], v7, s[8:11], s81 offen
si_108:
  s_mov_b64 exec, -1
  s_branch bw_105
bw_106:
  s_lshr_b32 s21, 4, s20
  s_bitcmp1_b32 s21, 0
  s_cbranch_scc0 bw_109
  ds_read_b64_tr_b16 v[104:105], v6 offset:0
  ds_read_b64_tr_b16 v[106:107], v6 offset:3200
  ds_read_b64_tr_b16 v[108:109], v6 offset:6400
  ds_read_b64_tr_b16 v[110:111], v6 offset:9600
  ds_read_b64_tr_b16 v[112:113], v6 offset:640
  ds_read_b64_tr_b16 v[114:115], v6 offset:3840
  ds_read_b64_tr_b16 v[116:117], v6 offset:7040
  ds_read_b64_tr_b16 v[118:119], v6 offset:10240
  ds_read_b64_tr_b16 v[120:121], v6 offset:1280
  ds_read_b64_tr_b16 v[122:123], v6 offset:4480
  ds_read_b64_tr_b16 v[124:125], v6 offset:7680
  ds_read_b64_tr_b16 v[126:127], v6 offset:10880
  s_waitcnt lgkmcnt(8)
  v_pk_add_f16 v104, v104, v106
  v_pk_add_f16 v108, v108, v110
  v_pk_add_f16 v105, v105, v107
  v_pk_add_f16 v109, v109, v111
  v_fma_mix_f32 v128, v104, 1.0, v108 op_sel:[0,0,0] op_sel_hi:[1,0,1]
  v_fma_mix_f32 v129, v104, 1.0, v108 op_sel:[1,0,1] op_sel_hi:[1,0,1]
  v_fma_mix_f32 v130, v105, 1.0, v109 op_sel:[0,0,0] op_sel_hi:[1,0,1]
  v_fma_mix_f32 v131, v105, 1.0, v109 op_sel:[1,0,1] op_sel_hi:[1,0,1]
  v_cvt_pk_bf16_f32 v212, v128, v129
  v_cvt_pk_bf16_f32 v213, v130, v131
  s_waitcnt lgkmcnt(4)
  v_pk_add_f16 v112, v112, v114
  v_pk_add_f16 v116, v116, v118
  v_pk_add_f16 v113, v113, v115
  v_pk_add_f16 v117, v117, v119
  v_fma_mix_f32 v128, v112, 1.0, v116 op_sel:[0,0,0] op_sel_hi:[1,0,1]
  v_fma_mix_f32 v129, v112, 1.0, v116 op_sel:[1,0,1] op_sel_hi:[1,0,1]
  v_fma_mix_f32 v130, v113, 1.0, v117 op_sel:[0,0,0] op_sel_hi:[1,0,1]
  v_fma_mix_f32 v131, v113, 1.0, v117 op_sel:[1,0,1] op_sel_hi:[1,0,1]
  v_cvt_pk_bf16_f32 v214, v128, v129
  v_cvt_pk_bf16_f32 v215, v130, v131
  s_waitcnt lgkmcnt(0)
  v_pk_add_f16 v120, v120, v122
  v_pk_add_f16 v124, v124, v126
  v_pk_add_f16 v121, v121, v123
  v_pk_add_f16 v125, v125, v127
  v_fma_mix_f32 v128, v120, 1.0, v124 op_sel:[0,0,0] op_sel_hi:[1,0,1]
  v_fma_mix_f32 v129, v120, 1.0, v124 op_sel:[1,0,1] op_sel_hi:[1,0,1]
  v_mfma_f32_16x16x32_bf16 v[96:99], v[212:215], v[212:215], 0
  v_fma_mix_f32 v130, v121, 1.0, v125 op_sel:[0,0,0] op_sel_hi:[1,0,1]
  v_fma_mix_f32 v131, v121, 1.0, v125 op_sel:[1,0,1] op_sel_hi:[1,0,1]
  v_cvt_pk_bf16_f32 v216, v128, v129
  v_cvt_pk_bf16_f32 v217, v130, v131
  s_nop 1
  v_mfma_f32_16x16x32_bf16 v[96:99], v[216:219], v[216:219], v[96:99]
  s_mov_b64 exec, s[74:75]
  s_nop 6
  v_cvt_pk_f16_f32 v100, v96, v97
  v_cvt_pk_f16_f32 v101, v98, v99
  v_and_or_b32 v100, v100, -2, s88
  s_cmp_eq_u32 s53, 1
  s_cbranch_scc1 si_110
  buffer_store_dwordx2 v[100:101], v7, s[8:11], s81 offen sc1
  s_branch si_111
si_110:
  buffer_store_dwordx2 v[100:101], v7, s[8:11], s81 offen
si_111:
  s_mov_b64 exec, -1
  s_branch bw_105
bw_109:
  s_lshr_b32 s21, 8, s20
  s_bitcmp1_b32 s21, 0
  s_cbranch_scc0 bw_112
  ds_read_b64_tr_b16 v[96:97], v6 offset:1920
  ds_read_b64_tr_b16 v[98:99], v6 offset:5120
  ds_read_b64_tr_b16 v[100:101], v6 offset:8320
  ds_read_b64_tr_b16 v[102:103], v6 offset:11520
  ds_read_b64_tr_b16 v[104:105], v6 offset:2560
  ds_read_b64_tr_b16 v[106:107], v6 offset:5760
  ds_read_b64_tr_b16 v[108:109], v6 offset:8960
  ds_read_b64_tr_b16 v[110:111], v6 offset:12160
  s_waitcnt lgkmcnt(4)
  v_pk_add_f16 v96, v96, v98
  v_pk_add_f16 v100, v100, v102
  v_pk_add_f16 v97, v97, v99
  v_pk_add_f16 v101, v101, v103
  v_fma_mix_f32 v112, v96, 1.0, v100 op_sel:[0,0,0] op_sel_hi:[1,0,1]
  v_fma_mix_f32 v113, v96, 1.0, v100 op_sel:[1,0,1] op_sel_hi:[1,0,1]
  v_fma_mix_f32 v114, v97, 1.0, v101 op_sel:[0,0,0] op_sel_hi:[1,0,1]
  v_fma_mix_f32 v115, v97, 1.0, v101 op_sel:[1,0,1] op_sel_hi:[1,0,1]
  v_cvt_pk_bf16_f32 v90, v112, v113
  v_cvt_pk_bf16_f32 v91, v114, v115
  v_min_u32 v90, -2, v90
  s_cmp_eq_u32 s53, 1
  s_cbranch_scc1 si_113
  buffer_store_dwordx2 v[90:91], v24, s[8:11], s81 offen sc1
  s_branch si_114
si_113:
  buffer_store_dwordx2 v[90:91], v24, s[8:11], s81 offen
si_114:
  s_waitcnt lgkmcnt(0)
  v_pk_add_f16 v104, v104, v106
  v_pk_add_f16 v108, v108, v110
  v_pk_add_f16 v105, v105, v107
  v_pk_add_f16 v109, v109, v111
  v_fma_mix_f32 v112, v104, 1.0, v108 op_sel:[0,0,0] op_sel_hi:[1,0,1]
  v_fma_mix_f32 v113, v104, 1.0, v108 op_sel:[1,0,1] op_sel_hi:[1,0,1]
  v_fma_mix_f32 v114, v105, 1.0, v109 op_sel:[0,0,0] op_sel_hi:[1,0,1]
  v_fma_mix_f32 v115, v105, 1.0, v109 op_sel:[1,0,1] op_sel_hi:[1,0,1]
  v_add_f32_dpp v116, v112, v112 row_ror:8 row_mask:0xf bank_mask:0xf
  v_add_f32_dpp v117, v113, v113 row_ror:8 row_mask:0xf bank_mask:0xf
  v_add_f32_dpp v118, v114, v114 row_ror:8 row_mask:0xf bank_mask:0xf
  v_add_f32_dpp v119, v115, v115 row_ror:8 row_mask:0xf bank_mask:0xf
  v_cvt_pk_bf16_f32 v92, v116, v117
  v_cvt_pk_bf16_f32 v93, v118, v119
  v_min_u32 v92, -2, v92
  s_mov_b64 exec, s[60:61]
  s_cmp_eq_u32 s53, 1
  s_cbranch_scc1 si_115
  buffer_store_dwordx2 v[92:93], v23, s[8:11], s78 offen sc1
  s_branch si_116
si_115:
  buffer_store_dwordx2 v[92:93], v23, s[8:11], s78 offen
si_116:
  s_mov_b64 exec, -1
  s_branch bw_105
bw_112:
bw_105:
  s_cmp_eq_u32 s52, 63
  s_cbranch_scc1 last_99
  s_mov_b32 s54, 0
pv_117:
  buffer_load_dwordx4 v[144:147], v10, s[8:11], s81 offen offset:0 sc1
  buffer_load_dwordx4 v[148:151], v10, s[8:11], s81 offen offset:1024 sc1
  buffer_load_dwordx4 v[152:155], v10, s[8:11], s81 offen offset:2048 sc1
  v_mov_b32 v188, 0
  v_mov_b32 v189, 0
  v_mov_b32 v190, 0
  v_mov_b32 v191, 0
  v_mov_b32 v192, 0
  v_mov_b32 v193, 0
  v_mov_b32 v194, 0
  v_mov_b32 v195, 0
  v_mov_b32 v196, 0
  v_mov_b32 v197, 0
  v_mov_b32 v198, 0
  v_mov_b32 v199, 0
  s_add_u32 s54, s54, 1
  s_cmp_gt_u32 s54, 131072
  s_cbranch_scc1 end0
  s_waitcnt vmcnt(0)
  v_max3_u32 v27, v144, v146, v148
  v_max3_u32 v27, v27, v150, v152
  v_max3_u32 v27, v27, v154, v154
  v_cmp_eq_u32 vcc, -1, v27
  s_nop 1
  s_cbranch_vccnz pv_117
  buffer_load_dwordx2 v[248:249], v9, s[8:11], s81 offen sc1
  buffer_load_dwordx4 v[112:115], v8, s[8:11], s81 offen offset:0 sc1
  buffer_load_dwordx4 v[116:119], v8, s[8:11], s81 offen offset:1024 sc1
  v_smfmac_f32_16x16x64_bf16 v[188:191], v[144:147], a[180:187], v44
  v_smfmac_f32_16x16x64_bf16 v[192:195], v[144:147], a[204:211], v44
  v_smfmac_f32_16x16x64_bf16 v[196:199], v[144:147], a[228:235], v44
  v_smfmac_f32_16x16x64_bf16 v[188:191], v[148:151], a[188:195], v44
  v_smfmac_f32_16x16x64_bf16 v[192:195], v[148:151], a[212:219], v44
  v_smfmac_f32_16x16x64_bf16 v[196:199], v[148:151], a[236:243], v44
  v_smfmac_f32_16x16x64_bf16 v[188:191], v[152:155], a[196:203], v44
  v_smfmac_f32_16x16x64_bf16 v[192:195], v[152:155], a[220:227], v44
  v_smfmac_f32_16x16x64_bf16 v[196:199], v[152:155], a[244:251], v44
  v_readfirstlane_b32 s21, v94
  s_add_u32 s22, s46, 3
  s_min_u32 s22, s22, 64
  s_sub_u32 s55, s21, s22
  s_sub_u32 s56, s21, s46
  s_cmp_lt_i32 s56, 0
  s_cbranch_scc1 kvw_120
kvok_121:
  s_waitcnt vmcnt(2)
  v_xor_b32 v96, s88, v248
  s_nop 0
  v_permlane16_swap_b32 v248, v249
  v_fma_mix_f32 v250, v248, 1.0, v249 op_sel:[0,0,0] op_sel_hi:[1,0,1]
  v_fma_mix_f32 v251, v248, 1.0, v249 op_sel:[1,0,1] op_sel_hi:[1,0,1]
  v_mov_b32 v248, v250
  v_mov_b32 v249, v251
  s_nop 0
  v_permlane32_swap_b32 v248, v250
  v_permlane32_swap_b32 v249, v251
  v_pk_add_f32 v[124:125], v[248:249], v[250:251]
  v_max_f32 v238, v124, v125
  s_waitcnt vmcnt(0)
  v_pk_add_f16 v100, v112, v116
  v_pk_add_f16 v102, v114, v118
  v_pk_add_f16 v101, v113, v117
  v_pk_add_f16 v103, v115, v119
  v_permlane32_swap_b32 v100, v102
  v_bitop3_b32 v97, v112, v114, s88 bitop3:0x7e
  v_permlane32_swap_b32 v101, v103
  v_bitop3_b32 v98, v116, v118, s88 bitop3:0x7e
  v_fma_mix_f32 v120, v100, 1.0, v102 op_sel:[0,0,0] op_sel_hi:[1,0,1]
  v_or3_b32 v27, v96, v97, v98
  v_fma_mix_f32 v121, v100, 1.0, v102 op_sel:[1,0,1] op_sel_hi:[1,0,1]
  v_and_b32 v27, 1, v27
  v_fma_mix_f32 v122, v101, 1.0, v103 op_sel:[0,0,0] op_sel_hi:[1,0,1]
  v_cmp_ne_u32 vcc, 0, v27
  v_fma_mix_f32 v123, v101, 1.0, v103 op_sel:[1,0,1] op_sel_hi:[1,0,1]
  v_max3_f32 v236, v120, v121, v238
  s_cbranch_vccnz psr_118
psj_119:
  v_max3_f32 v236, v236, v122, v123
  s_nop 1
  v_max_f32_dpp v236, v236, v236 row_ror:8 row_mask:0xf bank_mask:0xf
  v_mov_b32 v237, v236
  s_nop 1
  v_permlane32_swap_b32 v236, v237
  v_max_f32 v236, v236, v237
  v_mov_b32 v237, v236
  s_nop 1
  v_permlane16_swap_b32 v236, v237
  v_max_f32 v236, v236, v237
  v_mul_f32 v236, s86, v236
  v_fma_f32 v120, v120, s86, -v236
  v_fma_f32 v121, v121, s86, -v236
  buffer_load_dwordx4 v[160:163], v17, s[28:31], s64 offen offset:0 sc1
  v_fma_f32 v122, v122, s86, -v236
  v_fma_f32 v123, v123, s86, -v236
  buffer_load_dwordx4 v[164:167], v16, s[28:31], s64 offen offset:1024 sc1
  v_fma_f32 v124, v124, s86, -v236
  v_fma_f32 v125, v125, s86, -v236
  buffer_load_dwordx4 v[48:51], v26, s[28:31], s64 offen offset:2048 sc1
  v_exp_f32 v120, v120
  v_exp_f32 v121, v121
  s_lshr_b32 s21, 3, s20
  s_bitcmp1_b32 s21, 0
  s_cbranch_scc0 bw_123
  buffer_load_dwordx4 v[168:171], v18, s[16:19], s80 offen sc1
  s_branch bw_122
bw_123:
  s_lshr_b32 s21, 4, s20
  s_bitcmp1_b32 s21, 0
  s_cbranch_scc0 bw_124
  s_branch bw_122
bw_124:
  s_lshr_b32 s21, 8, s20
  s_bitcmp1_b32 s21, 0
  s_cbranch_scc0 bw_125
  s_branch bw_122
bw_125:
bw_122:
  v_exp_f32 v122, v122
  s_lshr_b32 s21, 3, s20
  s_bitcmp1_b32 s21, 0
  s_cbranch_scc0 bw_127
  buffer_load_dwordx2 v[172:173], v20, s[16:19], s80 offen sc1
  s_branch bw_126
bw_127:
  s_lshr_b32 s21, 4, s20
  s_bitcmp1_b32 s21, 0
  s_cbranch_scc0 bw_128
  s_branch bw_126
bw_128:
  s_lshr_b32 s21, 8, s20
  s_bitcmp1_b32 s21, 0
  s_cbranch_scc0 bw_129
  s_branch bw_126
bw_129:
bw_126:
  v_exp_f32 v123, v123
  s_lshr_b32 s21, 3, s20
  s_bitcmp1_b32 s21, 0
  s_cbranch_scc0 bw_131
  s_branch bw_130
bw_131:
  s_lshr_b32 s21, 4, s20
  s_bitcmp1_b32 s21, 0
  s_cbranch_scc0 bw_132
  s_branch bw_130
bw_132:
  s_lshr_b32 s21, 8, s20
  s_bitcmp1_b32 s21, 0
  s_cbranch_scc0 bw_133
  v_mov_b32 v240, s67
  v_mov_b32 v241, s67
  s_mov_b64 exec, s[68:69]
  buffer_store_dwordx2 v[240:241], v88, s[12:15], s66 offen sc1
  s_mov_b64 exec, -1
  s_branch bw_130
bw_133:
bw_130:
  v_exp_f32 v124, v124
  s_cmp_lt_i32 s55, 0
  s_cbranch_scc1 fl_134
fl_135:
  v_exp_f32 v125, v125
  v_cvt_pk_bf16_f32 v220, v120, v121
  v_cvt_pk_bf16_f32 v221, v122, v123
  v_cvt_pk_bf16_f32 v224, v124, v125
  v_mov_b32_dpp v222, v220 row_ror:8 row_mask:0xf bank_mask:0xf
  v_mov_b32_dpp v223, v221 row_ror:8 row_mask:0xf bank_mask:0xf
  v_mov_b32_dpp v225, v224 row_ror:8 row_mask:0xf bank_mask:0xf
  v_cvt_pk_bf16_f32 v228, v188, v189
  v_mfma_f32_16x16x32_bf16 v[200:203], v[176:179], v[220:223], 0
  v_cvt_pk_bf16_f32 v229, v190, v191
  v_cvt_pk_bf16_f32 v230, v192, v193
  v_mfma_f32_16x16x32_bf16 v[204:207], v[180:183], v[220:223], 0
  v_cvt_pk_bf16_f32 v231, v194, v195
  v_cvt_pk_bf16_f32 v232, v196, v197
  v_mfma_f32_16x16x32_bf16 v[208:211], v[184:187], v[220:223], 0
  v_cvt_pk_bf16_f32 v233, v198, v199
  v_add_f32 v126, v120, v121
  v_mfma_f32_16x16x32_bf16 v[200:203], v[228:231], v[224:227], v[200:203]
  v_add_f32 v127, v122, v123
  v_add_f32 v128, v124, v125
  v_mfma_f32_16x16x32_bf16 v[204:207], v[230:233], v[224:227], v[204:207]
  v_add_f32 v236, v126, v127
  v_fmac_f32 v236, v128, v89
  v_mfma_f32_16x16x32_bf16 v[208:211], v[232:235], v[224:227], v[208:211]
  s_nop 0
  v_add_f32_dpp v236, v236, v236 row_ror:8 row_mask:0xf bank_mask:0xf
  v_mov_b32 v237, v236
  ds_write_b128 v11, v[200:203] offset:0
  s_nop 0
  v_permlane32_swap_b32 v236, v237
  v_add_f32 v236, v236, v237
  v_mov_b32 v237, v236
  ds_write_b128 v11, v[204:207] offset:1024
  s_nop 0
  v_permlane16_swap_b32 v236, v237
  v_add_f32 v236, v236, v237
  v_rcp_f32 v236, v236
  ds_write_b128 v11, v[208:211] offset:2048
  s_mov_b64 exec, 0xff
  ds_write_b32 v242, v236
  s_mov_b64 exec, -1
  s_waitcnt lgkmcnt(0)
  s_barrier
  s_lshr_b32 s21, 7, s20
  s_bitcmp1_b32 s21, 0
  s_cbranch_scc0 bw_137
  ds_read_b128 v[104:107], v243
  ds_read_b64 v[96:97], v12 offset:0
  ds_read_b64 v[98:99], v12 offset:3072
  ds_read_b64 v[100:101], v12 offset:6144
  ds_read_b64 v[102:103], v12 offset:9216
  s_waitcnt lgkmcnt(2)
  v_pk_mul_f32 v[96:97], v[96:97], v[104:105] op_sel_hi:[1,0]
  v_pk_fma_f32 v[96:97], v[98:99], v[104:105], v[96:97] op_sel:[0,1,0] op_sel_hi:[1,1,1]
  s_waitcnt lgkmcnt(0)
  v_pk_fma_f32 v[96:97], v[100:101], v[106:107], v[96:97] op_sel_hi:[1,0,1]
  v_pk_fma_f32 v[96:97], v[102:103], v[106:107], v[96:97] op_sel:[0,1,0] op_sel_hi:[1,1,1]
  v_cvt_pk_f16_f32 v100, v96, v97
  v_perm_b32 v100, s91, v100, v14
  buffer_atomic_pk_add_f16 v100, v13, s[4:7], s3 offen
  s_branch bw_136
bw_137:
  s_lshr_b32 s21, 8, s20
  s_bitcmp1_b32 s21, 0
  s_cbranch_scc0 bw_138
  v_mov_b32 v28, -1
  v_mov_b32 v29, -1
  s_cmp_eq_u32 s53, 1
  s_cbranch_scc1 si_139
  buffer_store_dwordx2 v[28:29], v24, s[8:11], s82 offen sc1
  s_branch si_140
si_139:
  buffer_store_dwordx2 v[28:29], v24, s[8:11], s82 offen
si_140:
  s_mov_b64 exec, s[60:61]
  s_add_u32 s22, s82, 278528
  s_cmp_eq_u32 s53, 1
  s_cbranch_scc1 si_141
  buffer_store_dwordx2 v[28:29], v23, s[8:11], s22 offen sc1
  s_branch si_142
si_141:
  buffer_store_dwordx2 v[28:29], v23, s[8:11], s22 offen
si_142:
  s_and_b32 s21, s52, 7
  s_cmp_lg_u32 s21, s50
  s_cbranch_scc1 zm_143
  s_mov_b64 exec, s[70:71]
  buffer_store_dwordx4 v[156:159], v13, s[4:7], s83 offen sc1
zm_143:
  s_mov_b64 exec, -1
  s_branch bw_136
bw_138:
bw_136:
  s_lshr_b32 s21, 4, s20
  s_bitcmp1_b32 s21, 0
  s_cbranch_scc0 bw_145
  s_mov_b64 exec, s[62:63]
  buffer_store_dwordx4 v[212:215], v21, s[24:27], s85 offen sc1
  buffer_store_dwordx2 v[216:217], v23, s[24:27], s85 offen sc1
  s_mov_b64 exec, -1
  s_branch bw_144
bw_145:
bw_144:
  v_mov_b32 v200, v196
  v_mov_b32 v201, v197
  v_mov_b32 v202, v198
  v_mov_b32 v203, v199
  v_permlane32_swap_b32 v188, v192
  v_permlane32_swap_b32 v189, v193
  v_permlane32_swap_b32 v190, v194
  v_permlane32_swap_b32 v191, v195
  v_permlane32_swap_b32 v196, v200
  v_permlane32_swap_b32 v197, v201
  v_permlane32_swap_b32 v198, v202
  v_permlane32_swap_b32 v199, v203
  v_pk_add_f32 v[188:189], v[188:189], v[192:193]
  v_pk_add_f32 v[190:191], v[190:191], v[194:195]
  v_pk_add_f32 v[196:197], v[196:197], v[200:201]
  v_pk_add_f32 v[198:199], v[198:199], v[202:203]
  v_cvt_pk_bf16_f32 v252, v188, v189
  v_cvt_pk_bf16_f32 v254, v196, v197
  v_cvt_pk_bf16_f32 v253, v190, v191
  v_cvt_pk_bf16_f32 v255, v198, v199
  s_nop 0
  v_permlane16_swap_b32 v252, v254
  v_permlane16_swap_b32 v253, v255
  v_min_u32 v252, -2, v252
  s_mov_b64 exec, s[76:77]
  buffer_store_dwordx4 v[252:255], v15, s[24:27], s57 offen sc1
  s_mov_b64 exec, -1
  s_add_u32 s64, s64, 1310720
  s_add_u32 s52, s52, 1
  s_and_b32 s21, s52, 3
  s_mul_i32 s81, s21, 540672
  s_lshl_b32 s84, s21, 15
  s_branch step_98
fl_102:
  buffer_load_dword v94, v95, s[12:15], s79 offen sc1
  s_branch fl_103
pm_100:
  s_cmp_gt_u32 s52, 3
  s_cbranch_scc1 op_146
  v_readfirstlane_b32 s21, v94
  s_cmp_ge_u32 s21, s46
  s_cbranch_scc1 op_146
  buffer_load_dword v94, v95, s[12:15], s79 offen sc1
  s_waitcnt vmcnt(0)
  v_readfirstlane_b32 s21, v94
  s_add_u32 s22, s46, 3
  s_min_u32 s22, s22, 64
  s_sub_u32 s55, s21, s22
  s_sub_u32 s56, s21, s46
  s_cmp_gt_u32 s21, s52
  s_cselect_b32 s21, s87, 0
  s_cmp_eq_u32 s21, 0
  s_cbranch_scc1 op_146
  s_mov_b32 s87, 0
  s_sub_u32 s21, s64, 1310720
  buffer_load_dwordx4 v[176:179], v16, s[28:31], s21 offen offset:0 sc1
  buffer_load_dwordx4 v[180:183], v16, s[28:31], s21 offen offset:1024 sc1
  buffer_load_dwordx4 v[184:187], v16, s[28:31], s21 offen offset:2048 sc1
op_146:
  buffer_load_dwordx4 v[32:35], v4, s[4:7], s84 offen offset:0 sc1
  buffer_load_dwordx4 v[36:39], v4, s[4:7], s84 offen offset:1024 sc1
  buffer_load_dwordx4 v[40:43], v4, s[4:7], s84 offen offset:2048 sc1
  s_add_u32 s54, s54, 1
  s_cmp_gt_u32 s54, 131072
  s_cbranch_scc1 end0
  s_waitcnt vmcnt(0)
  v_bitop3_b32 v27, v35, v39, v43 bitop3:0x80
  v_perm_b32 v35, v39, v35, s89
  v_cmp_gt_u32 vcc, 0x48000000, v27
  v_mov_b32 v39, v42
  s_cbranch_vccnz pm_100
  s_branch A1_19
psr_118:
  buffer_load_dwordx2 v[248:249], v9, s[8:11], s81 offen sc1
  buffer_load_dwordx4 v[112:115], v8, s[8:11], s81 offen offset:0 sc1
  buffer_load_dwordx4 v[116:119], v8, s[8:11], s81 offen offset:1024 sc1
  s_add_u32 s54, s54, 1
  s_cmp_gt_u32 s54, 131072
  s_cbranch_scc1 end0
  s_waitcnt vmcnt(2)
  v_xor_b32 v96, s88, v248
  s_nop 0
  v_permlane16_swap_b32 v248, v249
  v_fma_mix_f32 v250, v248, 1.0, v249 op_sel:[0,0,0] op_sel_hi:[1,0,1]
  v_fma_mix_f32 v251, v248, 1.0, v249 op_sel:[1,0,1] op_sel_hi:[1,0,1]
  v_mov_b32 v248, v250
  v_mov_b32 v249, v251
  s_nop 0
  v_permlane32_swap_b32 v248, v250
  v_permlane32_swap_b32 v249, v251
  v_pk_add_f32 v[124:125], v[248:249], v[250:251]
  v_max_f32 v238, v124, v125
  s_waitcnt vmcnt(0)
  v_pk_add_f16 v100, v112, v116
  v_pk_add_f16 v102, v114, v118
  v_pk_add_f16 v101, v113, v117
  v_pk_add_f16 v103, v115, v119
  v_permlane32_swap_b32 v100, v102
  v_bitop3_b32 v97, v112, v114, s88 bitop3:0x7e
  v_permlane32_swap_b32 v101, v103
  v_bitop3_b32 v98, v116, v118, s88 bitop3:0x7e
  v_fma_mix_f32 v120, v100, 1.0, v102 op_sel:[0,0,0] op_sel_hi:[1,0,1]
  v_or3_b32 v27, v96, v97, v98
  v_fma_mix_f32 v121, v100, 1.0, v102 op_sel:[1,0,1] op_sel_hi:[1,0,1]
  v_and_b32 v27, 1, v27
  v_fma_mix_f32 v122, v101, 1.0, v103 op_sel:[0,0,0] op_sel_hi:[1,0,1]
  v_cmp_ne_u32 vcc, 0, v27
  v_fma_mix_f32 v123, v101, 1.0, v103 op_sel:[1,0,1] op_sel_hi:[1,0,1]
  v_max3_f32 v236, v120, v121, v238
  s_cbranch_vccnz psr_118
  s_branch psj_119
kvw_120:
  s_mov_b32 s22, s87
  s_cmp_eq_u32 s52, 0
  s_cselect_b32 s23, s87, s46
  s_cselect_b32 s55, 0, s55
  s_cselect_b32 s87, 1, 0
  s_cmp_eq_u32 s23, 0
  s_cbranch_scc1 kvok_121
  v_mov_b32 v236, 0
  s_mov_b32 s101, 0
wf_147:
  buffer_load_dword v237, v236, s[12:15], s79 offen sc1
  s_add_u32 s101, s101, 1
  s_cmp_gt_u32 s101, 131072
  s_cbranch_scc1 end0
  s_waitcnt vmcnt(0)
  v_readfirstlane_b32 s100, v237
  s_cmp_ge_u32 s100, s23
  s_cbranch_scc1 wf_148
  s_sleep 3
  s_branch wf_147
wf_148:
  s_cmp_eq_u32 s22, 0
  s_cbranch_scc1 kvok_121
  s_sub_u32 s21, s64, 1310720
  buffer_load_dwordx4 v[176:179], v16, s[28:31], s21 offen offset:0 sc1
  buffer_load_dwordx4 v[180:183], v16, s[28:31], s21 offen offset:1024 sc1
  buffer_load_dwordx4 v[184:187], v16, s[28:31], s21 offen offset:2048 sc1
  s_waitcnt vmcnt(0)
  s_branch kvok_121
fl_134:
  buffer_load_dword v94, v95, s[12:15], s79 offen sc1
  s_branch fl_135
last_99:
  s_lshr_b32 s21, 4, s20
  s_bitcmp1_b32 s21, 0
  s_cbranch_scc0 bw_150
  s_mov_b64 exec, s[62:63]
  buffer_store_dwordx4 v[212:215], v21, s[24:27], s85 offen sc1
  buffer_store_dwordx2 v[216:217], v23, s[24:27], s85 offen sc1
  s_mov_b64 exec, -1
  s_branch bw_149
bw_150:
bw_149:
  v_mov_b32 v188, 0
  v_mov_b32 v189, 0
  v_mov_b32 v190, 0
  v_mov_b32 v191, 0
  v_mov_b32 v192, 0
  v_mov_b32 v193, 0
  v_mov_b32 v194, 0
  v_mov_b32 v195, 0
  v_mov_b32 v196, 0
  v_mov_b32 v197, 0
  v_mov_b32 v198, 0
  v_mov_b32 v199, 0
  s_sleep 4
  s_mov_b32 s54, 0
lv_151:
  buffer_load_dwordx4 v[144:147], v10, s[8:11], s81 offen offset:0 sc1
  buffer_load_dwordx4 v[148:151], v10, s[8:11], s81 offen offset:1024 sc1
  buffer_load_dwordx4 v[152:155], v10, s[8:11], s81 offen offset:2048 sc1
  s_add_u32 s54, s54, 1
  s_cmp_gt_u32 s54, 131072
  s_cbranch_scc1 end0
  s_waitcnt vmcnt(0)
  v_max3_u32 v27, v144, v146, v148
  v_max3_u32 v27, v27, v150, v152
  v_max3_u32 v27, v27, v154, v154
  v_cmp_eq_u32 vcc, -1, v27
  s_nop 1
  s_cbranch_vccnz lv_151
  v_smfmac_f32_16x16x64_bf16 v[188:191], v[144:147], a[180:187], v44
  v_smfmac_f32_16x16x64_bf16 v[192:195], v[144:147], a[204:211], v44
  v_smfmac_f32_16x16x64_bf16 v[196:199], v[144:147], a[228:235], v44
  v_smfmac_f32_16x16x64_bf16 v[188:191], v[148:151], a[188:195], v44
  v_smfmac_f32_16x16x64_bf16 v[192:195], v[148:151], a[212:219], v44
  v_smfmac_f32_16x16x64_bf16 v[196:199], v[148:151], a[236:243], v44
  v_smfmac_f32_16x16x64_bf16 v[188:191], v[152:155], a[196:203], v44
  v_smfmac_f32_16x16x64_bf16 v[192:195], v[152:155], a[220:227], v44
  v_smfmac_f32_16x16x64_bf16 v[196:199], v[152:155], a[244:251], v44
  s_nop 7
  v_mov_b32 v200, v196
  v_mov_b32 v201, v197
  v_mov_b32 v202, v198
  v_mov_b32 v203, v199
  v_permlane32_swap_b32 v188, v192
  v_permlane32_swap_b32 v189, v193
  v_permlane32_swap_b32 v190, v194
  v_permlane32_swap_b32 v191, v195
  v_permlane32_swap_b32 v196, v200
  v_permlane32_swap_b32 v197, v201
  v_permlane32_swap_b32 v198, v202
  v_permlane32_swap_b32 v199, v203
  v_pk_add_f32 v[188:189], v[188:189], v[192:193]
  v_pk_add_f32 v[190:191], v[190:191], v[194:195]
  v_pk_add_f32 v[196:197], v[196:197], v[200:201]
  v_pk_add_f32 v[198:199], v[198:199], v[202:203]
  v_cvt_pk_bf16_f32 v252, v188, v189
  v_cvt_pk_bf16_f32 v254, v196, v197
  v_cvt_pk_bf16_f32 v253, v190, v191
  v_cvt_pk_bf16_f32 v255, v198, v199
  s_nop 0
  v_permlane16_swap_b32 v252, v254
  v_permlane16_swap_b32 v253, v255
  v_min_u32 v252, -2, v252
  s_mov_b64 exec, s[76:77]
  buffer_store_dwordx4 v[252:255], v15, s[24:27], s57 offen sc1
  s_mov_b64 exec, -1
  s_lshr_b32 s21, 1, s20
  s_bitcmp1_b32 s21, 0
  s_cbranch_scc0 bw_153
  v_mov_b32 v246, 80
  v_mov_b32 v247, 1
  s_mov_b64 exec, 1
  buffer_atomic_add v247, v246, s[32:35], 0 offen sc0 sc1
  s_mov_b64 exec, -1
clm_154:
  s_branch bw_152
bw_153:
bw_152:
  s_branch chain_done
chain_done:
  s_waitcnt vmcnt(0) lgkmcnt(0)
  s_barrier
  s_mov_b32 s84, 0
  s_mov_b32 s85, -1
  s_mov_b32 s86, 0
  v_mov_b32 v21, 0
  v_mov_b32 v23, v247
  s_cmp_lg_u32 s20, 0
  s_cbranch_scc1 queue_b
  s_mov_b64 exec, 1
  s_branch queue_a
end0:
  s_endpgm
gemm_side:
  s_bfe_u32 s23, s22, 0x20005
  s_add_u32 s22, s22, 31
  s_and_b32 s22, s22, 31
  s_lshl_b32 s21, s23, 3
  s_add_u32 s2, s21, s22
  s_add_u32 s3, s2, 72
  s_add_u32 s24, s2, 48
  s_add_u32 s2, s2, s21
  s_cmp_lt_u32 s22, 24
  s_cselect_b32 s3, s24, s3
  s_cmp_lt_u32 s22, 16
  s_cselect_b32 s3, s2, s3
  s_mov_b32 s2, s3
  s_cmp_ge_u32 s3, 64
  s_cbranch_scc1 not_kv
  s_load_dwordx2 s[4:5], s[0:1], 0
  s_load_dwordx2 s[6:7], s[0:1], 24
  s_load_dwordx2 s[36:37], s[0:1], 32
  s_load_dwordx2 s[38:39], s[0:1], 104
  s_and_b32 s43, s3, 1
  s_bfe_u32 s42, s3, 0x50001
  s_lshr_b32 s40, s42, 2
  s_waitcnt lgkmcnt(0)
  s_cmp_eq_u32 s43, 1
  s_cselect_b32 s6, s36, s6
  s_cselect_b32 s7, s37, s7
  s_mov_b32 s8, s4
  s_mov_b32 s9, s5
  s_mov_b32 s10, 2621440
  s_mov_b32 s11, 0x00020000
  s_mov_b32 s12, s6
  s_mov_b32 s13, s7
  s_mov_b32 s14, 7864320
  s_mov_b32 s15, 0x00020000
  s_mov_b32 s16, s38
  s_mov_b32 s17, s39
  s_mov_b32 s18, 50331648
  s_mov_b32 s19, 0x00020000
  s_mul_i32 s44, s42, 384
  s_mov_b32 s62, 1024
  s_mov_b32 s24, 0
  s_mov_b32 s25, 81920
  s_mov_b32 s64, s32
  s_mov_b32 s65, s33
  s_mov_b32 s66, s34
  s_mov_b32 s67, s35
  s_load_dwordx2 s[72:73], s[0:1], 104
  s_waitcnt lgkmcnt(0)
  s_add_u32 s72, s72, 81068032
  s_addc_u32 s73, s73, 0
  s_mov_b32 s74, 116736
  s_mov_b32 s75, 0x00020000
  v_mov_b32 v9, 2731
  v_add_u32 v8, 0, v1
  v_mul_u32_u24 v7, v8, v9
  v_lshrrev_b32 v7, 16, v7
  v_mul_u32_u24 v4, 24, v7
  v_sub_u32 v8, v8, v4
  v_and_b32 v4, 2, v7
  v_xor_b32 v8, v8, v4
  v_xor_b32 v5, 4, v8
  s_mov_b32 s21, 12288
  v_mul_lo_u32 v7, v7, s21
  v_lshl_add_u32 v40, v8, 4, v7
  v_lshl_add_u32 v43, v5, 4, v7
  v_add_u32 v8, 64, v1
  v_mul_u32_u24 v7, v8, v9
  v_lshrrev_b32 v7, 16, v7
  v_mul_u32_u24 v4, 24, v7
  v_sub_u32 v8, v8, v4
  v_and_b32 v4, 2, v7
  v_xor_b32 v8, v8, v4
  v_xor_b32 v5, 4, v8
  s_mov_b32 s21, 12288
  v_mul_lo_u32 v7, v7, s21
  v_lshl_add_u32 v41, v8, 4, v7
  v_lshl_add_u32 v44, v5, 4, v7
  v_add_u32 v8, 128, v1
  v_mul_u32_u24 v7, v8, v9
  v_lshrrev_b32 v7, 16, v7
  v_mul_u32_u24 v4, 24, v7
  v_sub_u32 v8, v8, v4
  v_and_b32 v4, 2, v7
  v_xor_b32 v8, v8, v4
  v_xor_b32 v5, 4, v8
  s_mov_b32 s21, 12288
  v_mul_lo_u32 v7, v7, s21
  v_lshl_add_u32 v42, v8, 4, v7
  v_lshl_add_u32 v45, v5, 4, v7
  s_mul_i32 s21, s20, 393216
  s_add_u32 s21, s21, 0
  s_add_u32 s21, s21, s44
  s_mul_i32 s22, s20, 12288
  s_add_u32 s22, s22, 0
  s_add_u32 m0, s22, 0
  s_nop 0
  buffer_load_dwordx4 v40, s[12:15], s21 offen lds
  s_add_u32 m0, s22, 1024
  s_nop 0
  buffer_load_dwordx4 v41, s[12:15], s21 offen lds
  s_add_u32 m0, s22, 2048
  s_nop 0
  buffer_load_dwordx4 v42, s[12:15], s21 offen lds
  s_mul_i32 s21, s20, 393216
  s_add_u32 s21, s21, 98304
  s_add_u32 s21, s21, s44
  s_mul_i32 s22, s20, 12288
  s_add_u32 s22, s22, 3072
  s_add_u32 m0, s22, 0
  s_nop 0
  buffer_load_dwordx4 v43, s[12:15], s21 offen lds
  s_add_u32 m0, s22, 1024
  s_nop 0
  buffer_load_dwordx4 v44, s[12:15], s21 offen lds
  s_add_u32 m0, s22, 2048
  s_nop 0
  buffer_load_dwordx4 v45, s[12:15], s21 offen lds
  s_mul_i32 s21, s20, 393216
  s_add_u32 s21, s21, 196608
  s_add_u32 s21, s21, s44
  s_mul_i32 s22, s20, 12288
  s_add_u32 s22, s22, 6144
  s_add_u32 m0, s22, 0
  s_nop 0
  buffer_load_dwordx4 v40, s[12:15], s21 offen lds
  s_add_u32 m0, s22, 1024
  s_nop 0
  buffer_load_dwordx4 v41, s[12:15], s21 offen lds
  s_add_u32 m0, s22, 2048
  s_nop 0
  buffer_load_dwordx4 v42, s[12:15], s21 offen lds
  s_mul_i32 s21, s20, 393216
  s_add_u32 s21, s21, 294912
  s_add_u32 s21, s21, s44
  s_mul_i32 s22, s20, 12288
  s_add_u32 s22, s22, 9216
  s_add_u32 m0, s22, 0
  s_nop 0
  buffer_load_dwordx4 v43, s[12:15], s21 offen lds
  s_add_u32 m0, s22, 1024
  s_nop 0
  buffer_load_dwordx4 v44, s[12:15], s21 offen lds
  s_add_u32 m0, s22, 2048
  s_nop 0
  buffer_load_dwordx4 v45, s[12:15], s21 offen lds
  v_lshrrev_b32 v11, 3, v1
  v_and_b32 v12, 7, v1
  v_xor_b32 v12, v12, v11
  v_mul_u32_u24 v11, 1280, v11
  v_lshl_add_u32 v10, v12, 4, v11
  s_mul_i32 s46, s20, 20480
  v_add_u32 v10, s46, v10
  s_lshl_b32 s47, s20, 11
  s_add_u32 s47, s47, 98304
  s_add_u32 s46, s47, 57344
  s_mov_b32 s30, s24
  s_add_u32 s32, s47, 0
  v_add_u32 v11, 9216, v10
  s_mov_b32 m0, s32
  s_nop 0
  buffer_load_dwordx4 v10, s[8:11], s30 offen offset:0 lds
  buffer_load_dwordx4 v11, s[8:11], s30 offen offset:1024 lds
  s_add_u32 s30, s30, 128
  s_add_u32 s32, s32, 8192
  s_cmp_lt_u32 s32, s46
  s_cselect_b32 s32, s32, s47
  s_mov_b32 m0, s32
  s_nop 0
  buffer_load_dwordx4 v10, s[8:11], s30 offen offset:0 lds
  buffer_load_dwordx4 v11, s[8:11], s30 offen offset:1024 lds
  s_add_u32 s30, s30, 128
  s_add_u32 s32, s32, 8192
  s_cmp_lt_u32 s32, s46
  s_cselect_b32 s32, s32, s47
  s_mov_b32 m0, s32
  s_nop 0
  buffer_load_dwordx4 v10, s[8:11], s30 offen offset:0 lds
  buffer_load_dwordx4 v11, s[8:11], s30 offen offset:1024 lds
  s_add_u32 s30, s30, 128
  s_add_u32 s32, s32, 8192
  s_cmp_lt_u32 s32, s46
  s_cselect_b32 s32, s32, s47
  s_mov_b32 m0, s32
  s_nop 0
  buffer_load_dwordx4 v10, s[8:11], s30 offen offset:0 lds
  buffer_load_dwordx4 v11, s[8:11], s30 offen offset:1024 lds
  s_add_u32 s30, s30, 128
  s_add_u32 s32, s32, 8192
  s_cmp_lt_u32 s32, s46
  s_cselect_b32 s32, s32, s47
  s_mov_b32 m0, s32
  s_nop 0
  buffer_load_dwordx4 v10, s[8:11], s30 offen offset:0 lds
  buffer_load_dwordx4 v11, s[8:11], s30 offen offset:1024 lds
  s_add_u32 s30, s30, 128
  s_add_u32 s32, s32, 8192
  s_cmp_lt_u32 s32, s46
  s_cselect_b32 s32, s32, s47
  s_mul_i32 s21, s20, 393216
  s_add_u32 s21, s21, 1572864
  s_add_u32 s21, s21, s44
  s_mul_i32 s22, s20, 12288
  s_add_u32 s22, s22, 49152
  s_add_u32 m0, s22, 0
  s_nop 0
  buffer_load_dwordx4 v40, s[12:15], s21 offen lds
  s_add_u32 m0, s22, 1024
  s_nop 0
  buffer_load_dwordx4 v41, s[12:15], s21 offen lds
  s_add_u32 m0, s22, 2048
  s_nop 0
  buffer_load_dwordx4 v42, s[12:15], s21 offen lds
  s_mul_i32 s21, s20, 393216
  s_add_u32 s21, s21, 1671168
  s_add_u32 s21, s21, s44
  s_mul_i32 s22, s20, 12288
  s_add_u32 s22, s22, 52224
  s_add_u32 m0, s22, 0
  s_nop 0
  buffer_load_dwordx4 v43, s[12:15], s21 offen lds
  s_add_u32 m0, s22, 1024
  s_nop 0
  buffer_load_dwordx4 v44, s[12:15], s21 offen lds
  s_add_u32 m0, s22, 2048
  s_nop 0
  buffer_load_dwordx4 v45, s[12:15], s21 offen lds
  s_mul_i32 s21, s20, 393216
  s_add_u32 s21, s21, 1769472
  s_add_u32 s21, s21, s44
  s_mul_i32 s22, s20, 12288
  s_add_u32 s22, s22, 55296
  s_add_u32 m0, s22, 0
  s_nop 0
  buffer_load_dwordx4 v40, s[12:15], s21 offen lds
  s_add_u32 m0, s22, 1024
  s_nop 0
  buffer_load_dwordx4 v41, s[12:15], s21 offen lds
  s_add_u32 m0, s22, 2048
  s_nop 0
  buffer_load_dwordx4 v42, s[12:15], s21 offen lds
  s_mul_i32 s21, s20, 393216
  s_add_u32 s21, s21, 1867776
  s_add_u32 s21, s21, s44
  s_mul_i32 s22, s20, 12288
  s_add_u32 s22, s22, 58368
  s_add_u32 m0, s22, 0
  s_nop 0
  buffer_load_dwordx4 v43, s[12:15], s21 offen lds
  s_add_u32 m0, s22, 1024
  s_nop 0
  buffer_load_dwordx4 v44, s[12:15], s21 offen lds
  s_add_u32 m0, s22, 2048
  s_nop 0
  buffer_load_dwordx4 v45, s[12:15], s21 offen lds
  v_lshrrev_b32 v7, 2, v2
  v_and_b32 v4, 2, v7
  v_and_b32 v5, 1, v3
  v_lshl_or_b32 v4, v5, 2, v4
  v_lshl_add_u32 v7, v3, 3, v7
  v_mul_u32_u24 v7, 384, v7
  v_and_b32 v5, 1, v2
  v_lshl_add_u32 v7, v5, 3, v7
  v_bfe_u32 v8, v2, 1, 1
  s_mul_i32 s21, s20, 6
  v_add_u32 v8, s21, v8
  v_add_u32 v5, 0, v8
  v_xor_b32 v5, v5, v4
  v_lshl_add_u32 v46, v5, 4, v7
  v_add_u32 v49, 49152, v46
  v_add_u32 v5, 2, v8
  v_xor_b32 v5, v5, v4
  v_lshl_add_u32 v47, v5, 4, v7
  v_add_u32 v50, 49152, v47
  v_add_u32 v5, 4, v8
  v_xor_b32 v5, v5, v4
  v_lshl_add_u32 v48, v5, 4, v7
  v_add_u32 v51, 49152, v48
  s_mov_b32 s26, 6
  s_mul_i32 s27, s42, 12288
  s_mul_i32 s21, s43, 25165824
  s_add_u32 s27, s27, s21
  s_mov_b32 s28, 786432
  s_lshl_b32 s60, s40, 7
  s_add_u32 s60, s60, 0
  s_mov_b32 s61, 0
  v_and_b32 v6, 7, v2
  v_add_u32 v4, 0, v3
  v_xor_b32 v4, v4, v6
  v_lshlrev_b32 v4, 4, v4
  v_lshl_add_u32 v14, v2, 7, v4
  v_add_u32 v4, 4, v3
  v_xor_b32 v4, v4, v6
  v_lshlrev_b32 v4, 4, v4
  v_lshl_add_u32 v15, v2, 7, v4
  v_mul_u32_u24 v22, 400, v2
  v_mul_u32_u24 v4, 16, v3
  s_mul_i32 s21, s20, 96
  s_add_u32 s21, s21, 0
  v_add3_u32 v22, v22, v4, s21
  v_lshlrev_b32 v4, 3, v3
  v_sub_u32 v16, v22, v4
  v_mov_b32 v9, 2731
  s_mul_i32 s21, s20, 6400
  s_add_u32 s21, s21, 0
  v_mul_u32_u24 v4, 400, v2
  v_lshlrev_b32 v5, 4, v3
  v_add3_u32 v23, v4, v5, s21
  v_lshlrev_b32 v26, 4, v1
  s_mov_b32 s33, 98304
  s_mov_b32 s48, 0x80000000
  s_mov_b32 m0, s32
  s_nop 0
  buffer_load_dwordx4 v10, s[8:11], s30 offen offset:0 lds
  s_waitcnt vmcnt(21)
  s_barrier
  v_add_u32 v18, s33, v14
  v_add_u32 v19, s33, v15
  s_add_u32 s33, s33, 8192
  s_cmp_lt_u32 s33, 155648
  s_cselect_b32 s33, s33, 98304
  ds_read_b128 v[160:163], v18 offset:0
  ds_read_b128 v[164:167], v18 offset:2048
  ds_read_b128 v[168:171], v18 offset:4096
  ds_read_b128 v[172:175], v18 offset:6144
  s_waitcnt lgkmcnt(0)
  s_waitcnt vmcnt(23)
  s_barrier
  ds_read_b64_tr_b16 a[0:1], v46 offset:0
  ds_read_b64_tr_b16 a[2:3], v46 offset:1536
  ds_read_b64_tr_b16 a[4:5], v47 offset:0
  ds_read_b64_tr_b16 a[6:7], v47 offset:1536
  ds_read_b64_tr_b16 a[8:9], v48 offset:0
  ds_read_b64_tr_b16 a[10:11], v48 offset:1536
  ds_read_b64_tr_b16 a[12:13], v46 offset:12288
  ds_read_b64_tr_b16 a[14:15], v46 offset:13824
  ds_read_b64_tr_b16 a[16:17], v47 offset:12288
  ds_read_b64_tr_b16 a[18:19], v47 offset:13824
  ds_read_b64_tr_b16 a[20:21], v48 offset:12288
  ds_read_b64_tr_b16 a[22:23], v48 offset:13824
  ds_read_b64_tr_b16 a[24:25], v46 offset:24576
  ds_read_b64_tr_b16 a[26:27], v46 offset:26112
  ds_read_b64_tr_b16 a[28:29], v47 offset:24576
  ds_read_b64_tr_b16 a[30:31], v47 offset:26112
  ds_read_b64_tr_b16 a[32:33], v48 offset:24576
  ds_read_b64_tr_b16 a[34:35], v48 offset:26112
  ds_read_b64_tr_b16 a[36:37], v46 offset:36864
  ds_read_b64_tr_b16 a[38:39], v46 offset:38400
  ds_read_b64_tr_b16 a[40:41], v47 offset:36864
  ds_read_b64_tr_b16 a[42:43], v47 offset:38400
  ds_read_b64_tr_b16 a[44:45], v48 offset:36864
  ds_read_b64_tr_b16 a[46:47], v48 offset:38400
  s_waitcnt lgkmcnt(0)
  s_barrier
  s_mov_b32 s23, m0
  s_mul_i32 s21, s20, 393216
  s_add_u32 s21, s21, 3145728
  s_add_u32 s21, s21, s44
  s_mul_i32 s22, s20, 12288
  s_add_u32 s22, s22, 0
  s_add_u32 m0, s22, 0
  s_nop 0
  buffer_load_dwordx4 v40, s[12:15], s21 offen lds
  s_add_u32 m0, s22, 1024
  s_nop 0
  buffer_load_dwordx4 v41, s[12:15], s21 offen lds
  s_add_u32 m0, s22, 2048
  s_nop 0
  buffer_load_dwordx4 v42, s[12:15], s21 offen lds
  s_mul_i32 s21, s20, 393216
  s_add_u32 s21, s21, 3244032
  s_add_u32 s21, s21, s44
  s_mul_i32 s22, s20, 12288
  s_add_u32 s22, s22, 3072
  s_add_u32 m0, s22, 0
  s_nop 0
  buffer_load_dwordx4 v43, s[12:15], s21 offen lds
  s_add_u32 m0, s22, 1024
  s_nop 0
  buffer_load_dwordx4 v44, s[12:15], s21 offen lds
  s_add_u32 m0, s22, 2048
  s_nop 0
  buffer_load_dwordx4 v45, s[12:15], s21 offen lds
  s_mul_i32 s21, s20, 393216
  s_add_u32 s21, s21, 3342336
  s_add_u32 s21, s21, s44
  s_mul_i32 s22, s20, 12288
  s_add_u32 s22, s22, 6144
  s_add_u32 m0, s22, 0
  s_nop 0
  buffer_load_dwordx4 v40, s[12:15], s21 offen lds
  s_add_u32 m0, s22, 1024
  s_nop 0
  buffer_load_dwordx4 v41, s[12:15], s21 offen lds
  s_add_u32 m0, s22, 2048
  s_nop 0
  buffer_load_dwordx4 v42, s[12:15], s21 offen lds
  s_mul_i32 s21, s20, 393216
  s_add_u32 s21, s21, 3440640
  s_add_u32 s21, s21, s44
  s_mul_i32 s22, s20, 12288
  s_add_u32 s22, s22, 9216
  s_add_u32 m0, s22, 0
  s_nop 0
  buffer_load_dwordx4 v43, s[12:15], s21 offen lds
  s_add_u32 m0, s22, 1024
  s_nop 0
  buffer_load_dwordx4 v44, s[12:15], s21 offen lds
  s_add_u32 m0, s22, 2048
  s_nop 0
  buffer_load_dwordx4 v45, s[12:15], s21 offen lds
  s_mov_b32 m0, s23
  v_mfma_f32_16x16x32_bf16 v[64:67], a[0:3], v[160:163], 0
  ds_read_b128 v[192:195], v19 offset:0
  v_mfma_f32_16x16x32_bf16 v[68:71], a[4:7], v[160:163], 0
  v_add_u32 v18, s33, v14
  v_mfma_f32_16x16x32_bf16 v[72:75], a[8:11], v[160:163], 0
  v_mfma_f32_16x16x32_bf16 v[76:79], a[0:3], v[164:167], 0
  ds_read_b128 v[196:199], v19 offset:2048
  v_mfma_f32_16x16x32_bf16 v[80:83], a[4:7], v[164:167], 0
  buffer_load_dwordx4 v11, s[8:11], s30 offen offset:1024 lds
  v_mfma_f32_16x16x32_bf16 v[84:87], a[8:11], v[164:167], 0
  s_add_u32 s30, s30, 128
  v_mfma_f32_16x16x32_bf16 v[88:91], a[0:3], v[168:171], 0
  ds_read_b128 v[200:203], v19 offset:4096
  s_add_u32 m0, m0, 8192
  v_mfma_f32_16x16x32_bf16 v[92:95], a[4:7], v[168:171], 0
  s_cmp_lt_u32 m0, s46
  s_cselect_b32 m0, m0, s47
  v_mfma_f32_16x16x32_bf16 v[96:99], a[8:11], v[168:171], 0
  v_mfma_f32_16x16x32_bf16 v[100:103], a[0:3], v[172:175], 0
  ds_read_b128 v[204:207], v19 offset:6144
  v_mfma_f32_16x16x32_bf16 v[104:107], a[4:7], v[172:175], 0
  v_mfma_f32_16x16x32_bf16 v[108:111], a[8:11], v[172:175], 0
  s_waitcnt vmcnt(32) lgkmcnt(2)
  s_barrier
  v_mfma_f32_16x16x32_bf16 v[64:67], a[12:15], v[192:195], v[64:67]
  ds_read_b128 v[160:163], v18 offset:0
  v_mfma_f32_16x16x32_bf16 v[68:71], a[16:19], v[192:195], v[68:71]
  v_mfma_f32_16x16x32_bf16 v[72:75], a[20:23], v[192:195], v[72:75]
  v_add_u32 v19, s33, v15
  s_add_u32 s33, s33, 8192
  v_mfma_f32_16x16x32_bf16 v[76:79], a[12:15], v[196:199], v[76:79]
  ds_read_b128 v[164:167], v18 offset:2048
  v_mfma_f32_16x16x32_bf16 v[80:83], a[16:19], v[196:199], v[80:83]
  buffer_load_dwordx4 v10, s[8:11], s30 offen offset:0 lds
  v_mfma_f32_16x16x32_bf16 v[84:87], a[20:23], v[196:199], v[84:87]
  s_waitcnt lgkmcnt(2)
  v_mfma_f32_16x16x32_bf16 v[88:91], a[12:15], v[200:203], v[88:91]
  ds_read_b128 v[168:171], v18 offset:4096
  v_mfma_f32_16x16x32_bf16 v[92:95], a[16:19], v[200:203], v[92:95]
  s_cmp_lt_u32 s33, 155648
  s_cselect_b32 s33, s33, 98304
  v_mfma_f32_16x16x32_bf16 v[96:99], a[20:23], v[200:203], v[96:99]
  v_mfma_f32_16x16x32_bf16 v[100:103], a[12:15], v[204:207], v[100:103]
  ds_read_b128 v[172:175], v18 offset:6144
  v_mfma_f32_16x16x32_bf16 v[104:107], a[16:19], v[204:207], v[104:107]
  v_mfma_f32_16x16x32_bf16 v[108:111], a[20:23], v[204:207], v[108:111]
  s_waitcnt lgkmcnt(2)
  v_mfma_f32_16x16x32_bf16 v[64:67], a[24:27], v[160:163], v[64:67]
  ds_read_b128 v[192:195], v19 offset:0
  v_mfma_f32_16x16x32_bf16 v[68:71], a[28:31], v[160:163], v[68:71]
  v_add_u32 v18, s33, v14
  v_mfma_f32_16x16x32_bf16 v[72:75], a[32:35], v[160:163], v[72:75]
  v_mfma_f32_16x16x32_bf16 v[76:79], a[24:27], v[164:167], v[76:79]
  ds_read_b128 v[196:199], v19 offset:2048
  v_mfma_f32_16x16x32_bf16 v[80:83], a[28:31], v[164:167], v[80:83]
  buffer_load_dwordx4 v11, s[8:11], s30 offen offset:1024 lds
  v_mfma_f32_16x16x32_bf16 v[84:87], a[32:35], v[164:167], v[84:87]
  s_waitcnt lgkmcnt(2)
  s_add_u32 s30, s30, 128
  v_mfma_f32_16x16x32_bf16 v[88:91], a[24:27], v[168:171], v[88:91]
  ds_read_b128 v[200:203], v19 offset:4096
  s_add_u32 m0, m0, 8192
  v_mfma_f32_16x16x32_bf16 v[92:95], a[28:31], v[168:171], v[92:95]
  s_cmp_lt_u32 m0, s46
  s_cselect_b32 m0, m0, s47
  v_mfma_f32_16x16x32_bf16 v[96:99], a[32:35], v[168:171], v[96:99]
  v_mfma_f32_16x16x32_bf16 v[100:103], a[24:27], v[172:175], v[100:103]
  ds_read_b128 v[204:207], v19 offset:6144
  v_mfma_f32_16x16x32_bf16 v[104:107], a[28:31], v[172:175], v[104:107]
  v_mfma_f32_16x16x32_bf16 v[108:111], a[32:35], v[172:175], v[108:111]
  s_waitcnt vmcnt(32) lgkmcnt(2)
  s_barrier
  v_mfma_f32_16x16x32_bf16 v[64:67], a[36:39], v[192:195], v[64:67]
  ds_read_b128 v[160:163], v18 offset:0
  v_mfma_f32_16x16x32_bf16 v[68:71], a[40:43], v[192:195], v[68:71]
  v_mfma_f32_16x16x32_bf16 v[72:75], a[44:47], v[192:195], v[72:75]
  v_add_u32 v19, s33, v15
  s_add_u32 s33, s33, 8192
  v_mfma_f32_16x16x32_bf16 v[76:79], a[36:39], v[196:199], v[76:79]
  ds_read_b128 v[164:167], v18 offset:2048
  v_mfma_f32_16x16x32_bf16 v[80:83], a[40:43], v[196:199], v[80:83]
  buffer_load_dwordx4 v10, s[8:11], s30 offen offset:0 lds
  v_mfma_f32_16x16x32_bf16 v[84:87], a[44:47], v[196:199], v[84:87]
  s_waitcnt lgkmcnt(2)
  v_mfma_f32_16x16x32_bf16 v[88:91], a[36:39], v[200:203], v[88:91]
  ds_read_b128 v[168:171], v18 offset:4096
  v_mfma_f32_16x16x32_bf16 v[92:95], a[40:43], v[200:203], v[92:95]
  s_cmp_lt_u32 s33, 155648
  s_cselect_b32 s33, s33, 98304
  v_mfma_f32_16x16x32_bf16 v[96:99], a[44:47], v[200:203], v[96:99]
  v_mfma_f32_16x16x32_bf16 v[100:103], a[36:39], v[204:207], v[100:103]
  ds_read_b128 v[172:175], v18 offset:6144
  v_mfma_f32_16x16x32_bf16 v[104:107], a[40:43], v[204:207], v[104:107]
  v_mfma_f32_16x16x32_bf16 v[108:111], a[44:47], v[204:207], v[108:111]
  s_waitcnt lgkmcnt(2)
  s_waitcnt vmcnt(17)
  s_barrier
  ds_read_b64_tr_b16 a[48:49], v49 offset:0
  ds_read_b64_tr_b16 a[50:51], v49 offset:1536
  ds_read_b64_tr_b16 a[52:53], v50 offset:0
  ds_read_b64_tr_b16 a[54:55], v50 offset:1536
  ds_read_b64_tr_b16 a[56:57], v51 offset:0
  ds_read_b64_tr_b16 a[58:59], v51 offset:1536
  ds_read_b64_tr_b16 a[60:61], v49 offset:12288
  ds_read_b64_tr_b16 a[62:63], v49 offset:13824
  ds_read_b64_tr_b16 a[64:65], v50 offset:12288
  ds_read_b64_tr_b16 a[66:67], v50 offset:13824
  ds_read_b64_tr_b16 a[68:69], v51 offset:12288
  ds_read_b64_tr_b16 a[70:71], v51 offset:13824
  ds_read_b64_tr_b16 a[72:73], v49 offset:24576
  ds_read_b64_tr_b16 a[74:75], v49 offset:26112
  ds_read_b64_tr_b16 a[76:77], v50 offset:24576
  ds_read_b64_tr_b16 a[78:79], v50 offset:26112
  ds_read_b64_tr_b16 a[80:81], v51 offset:24576
  ds_read_b64_tr_b16 a[82:83], v51 offset:26112
  ds_read_b64_tr_b16 a[84:85], v49 offset:36864
  ds_read_b64_tr_b16 a[86:87], v49 offset:38400
  ds_read_b64_tr_b16 a[88:89], v50 offset:36864
  ds_read_b64_tr_b16 a[90:91], v50 offset:38400
  ds_read_b64_tr_b16 a[92:93], v51 offset:36864
  ds_read_b64_tr_b16 a[94:95], v51 offset:38400
  s_waitcnt lgkmcnt(0)
  s_barrier
  s_mov_b32 s23, m0
  s_mul_i32 s21, s20, 393216
  s_add_u32 s21, s21, 4718592
  s_add_u32 s21, s21, s44
  s_mul_i32 s22, s20, 12288
  s_add_u32 s22, s22, 49152
  s_add_u32 m0, s22, 0
  s_nop 0
  buffer_load_dwordx4 v40, s[12:15], s21 offen lds
  s_add_u32 m0, s22, 1024
  s_nop 0
  buffer_load_dwordx4 v41, s[12:15], s21 offen lds
  s_add_u32 m0, s22, 2048
  s_nop 0
  buffer_load_dwordx4 v42, s[12:15], s21 offen lds
  s_mul_i32 s21, s20, 393216
  s_add_u32 s21, s21, 4816896
  s_add_u32 s21, s21, s44
  s_mul_i32 s22, s20, 12288
  s_add_u32 s22, s22, 52224
  s_add_u32 m0, s22, 0
  s_nop 0
  buffer_load_dwordx4 v43, s[12:15], s21 offen lds
  s_add_u32 m0, s22, 1024
  s_nop 0
  buffer_load_dwordx4 v44, s[12:15], s21 offen lds
  s_add_u32 m0, s22, 2048
  s_nop 0
  buffer_load_dwordx4 v45, s[12:15], s21 offen lds
  s_mul_i32 s21, s20, 393216
  s_add_u32 s21, s21, 4915200
  s_add_u32 s21, s21, s44
  s_mul_i32 s22, s20, 12288
  s_add_u32 s22, s22, 55296
  s_add_u32 m0, s22, 0
  s_nop 0
  buffer_load_dwordx4 v40, s[12:15], s21 offen lds
  s_add_u32 m0, s22, 1024
  s_nop 0
  buffer_load_dwordx4 v41, s[12:15], s21 offen lds
  s_add_u32 m0, s22, 2048
  s_nop 0
  buffer_load_dwordx4 v42, s[12:15], s21 offen lds
  s_mul_i32 s21, s20, 393216
  s_add_u32 s21, s21, 5013504
  s_add_u32 s21, s21, s44
  s_mul_i32 s22, s20, 12288
  s_add_u32 s22, s22, 58368
  s_add_u32 m0, s22, 0
  s_nop 0
  buffer_load_dwordx4 v43, s[12:15], s21 offen lds
  s_add_u32 m0, s22, 1024
  s_nop 0
  buffer_load_dwordx4 v44, s[12:15], s21 offen lds
  s_add_u32 m0, s22, 2048
  s_nop 0
  buffer_load_dwordx4 v45, s[12:15], s21 offen lds
  s_mov_b32 m0, s23
  v_mfma_f32_16x16x32_bf16 v[64:67], a[48:51], v[160:163], v[64:67]
  ds_read_b128 v[192:195], v19 offset:0
  v_mfma_f32_16x16x32_bf16 v[68:71], a[52:55], v[160:163], v[68:71]
  v_add_u32 v18, s33, v14
  v_mfma_f32_16x16x32_bf16 v[72:75], a[56:59], v[160:163], v[72:75]
  v_mfma_f32_16x16x32_bf16 v[76:79], a[48:51], v[164:167], v[76:79]
  ds_read_b128 v[196:199], v19 offset:2048
  v_mfma_f32_16x16x32_bf16 v[80:83], a[52:55], v[164:167], v[80:83]
  buffer_load_dwordx4 v11, s[8:11], s30 offen offset:1024 lds
  v_mfma_f32_16x16x32_bf16 v[84:87], a[56:59], v[164:167], v[84:87]
  s_add_u32 s30, s30, 128
  v_mfma_f32_16x16x32_bf16 v[88:91], a[48:51], v[168:171], v[88:91]
  ds_read_b128 v[200:203], v19 offset:4096
  s_add_u32 m0, m0, 8192
  v_mfma_f32_16x16x32_bf16 v[92:95], a[52:55], v[168:171], v[92:95]
  s_cmp_lt_u32 m0, s46
  s_cselect_b32 m0, m0, s47
  v_mfma_f32_16x16x32_bf16 v[96:99], a[56:59], v[168:171], v[96:99]
  v_mfma_f32_16x16x32_bf16 v[100:103], a[48:51], v[172:175], v[100:103]
  ds_read_b128 v[204:207], v19 offset:6144
  v_mfma_f32_16x16x32_bf16 v[104:107], a[52:55], v[172:175], v[104:107]
  v_mfma_f32_16x16x32_bf16 v[108:111], a[56:59], v[172:175], v[108:111]
  s_waitcnt vmcnt(44) lgkmcnt(2)
  s_barrier
  v_mfma_f32_16x16x32_bf16 v[64:67], a[60:63], v[192:195], v[64:67]
  ds_read_b128 v[160:163], v18 offset:0
  v_mfma_f32_16x16x32_bf16 v[68:71], a[64:67], v[192:195], v[68:71]
  v_mfma_f32_16x16x32_bf16 v[72:75], a[68:71], v[192:195], v[72:75]
  v_add_u32 v19, s33, v15
  s_add_u32 s33, s33, 8192
  v_mfma_f32_16x16x32_bf16 v[76:79], a[60:63], v[196:199], v[76:79]
  ds_read_b128 v[164:167], v18 offset:2048
  v_mfma_f32_16x16x32_bf16 v[80:83], a[64:67], v[196:199], v[80:83]
  buffer_load_dwordx4 v10, s[8:11], s30 offen offset:0 lds
  v_mfma_f32_16x16x32_bf16 v[84:87], a[68:71], v[196:199], v[84:87]
  s_waitcnt lgkmcnt(2)
  v_mfma_f32_16x16x32_bf16 v[88:91], a[60:63], v[200:203], v[88:91]
  ds_read_b128 v[168:171], v18 offset:4096
  v_mfma_f32_16x16x32_bf16 v[92:95], a[64:67], v[200:203], v[92:95]
  s_cmp_lt_u32 s33, 155648
  s_cselect_b32 s33, s33, 98304
  v_mfma_f32_16x16x32_bf16 v[96:99], a[68:71], v[200:203], v[96:99]
  v_mfma_f32_16x16x32_bf16 v[100:103], a[60:63], v[204:207], v[100:103]
  ds_read_b128 v[172:175], v18 offset:6144
  v_mfma_f32_16x16x32_bf16 v[104:107], a[64:67], v[204:207], v[104:107]
  v_mfma_f32_16x16x32_bf16 v[108:111], a[68:71], v[204:207], v[108:111]
  s_waitcnt lgkmcnt(2)
  v_mfma_f32_16x16x32_bf16 v[64:67], a[72:75], v[160:163], v[64:67]
  ds_read_b128 v[192:195], v19 offset:0
  v_mfma_f32_16x16x32_bf16 v[68:71], a[76:79], v[160:163], v[68:71]
  v_add_u32 v18, s33, v14
  v_mfma_f32_16x16x32_bf16 v[72:75], a[80:83], v[160:163], v[72:75]
  v_mfma_f32_16x16x32_bf16 v[76:79], a[72:75], v[164:167], v[76:79]
  ds_read_b128 v[196:199], v19 offset:2048
  v_mfma_f32_16x16x32_bf16 v[80:83], a[76:79], v[164:167], v[80:83]
  buffer_load_dwordx4 v11, s[8:11], s30 offen offset:1024 lds
  v_mfma_f32_16x16x32_bf16 v[84:87], a[80:83], v[164:167], v[84:87]
  s_waitcnt lgkmcnt(2)
  s_add_u32 s30, s30, 128
  v_mfma_f32_16x16x32_bf16 v[88:91], a[72:75], v[168:171], v[88:91]
  ds_read_b128 v[200:203], v19 offset:4096
  s_add_u32 m0, m0, 8192
  v_mfma_f32_16x16x32_bf16 v[92:95], a[76:79], v[168:171], v[92:95]
  s_cmp_lt_u32 m0, s46
  s_cselect_b32 m0, m0, s47
  v_mfma_f32_16x16x32_bf16 v[96:99], a[80:83], v[168:171], v[96:99]
  v_mfma_f32_16x16x32_bf16 v[100:103], a[72:75], v[172:175], v[100:103]
  ds_read_b128 v[204:207], v19 offset:6144
  v_mfma_f32_16x16x32_bf16 v[104:107], a[76:79], v[172:175], v[104:107]
  v_mfma_f32_16x16x32_bf16 v[108:111], a[80:83], v[172:175], v[108:111]
  s_waitcnt vmcnt(44) lgkmcnt(2)
  s_barrier
  v_mfma_f32_16x16x32_bf16 v[64:67], a[84:87], v[192:195], v[64:67]
  ds_read_b128 v[160:163], v18 offset:0
  v_mfma_f32_16x16x32_bf16 v[68:71], a[88:91], v[192:195], v[68:71]
  v_mfma_f32_16x16x32_bf16 v[72:75], a[92:95], v[192:195], v[72:75]
  v_add_u32 v19, s33, v15
  s_add_u32 s33, s33, 8192
  v_mfma_f32_16x16x32_bf16 v[76:79], a[84:87], v[196:199], v[76:79]
  ds_read_b128 v[164:167], v18 offset:2048
  v_mfma_f32_16x16x32_bf16 v[80:83], a[88:91], v[196:199], v[80:83]
  buffer_load_dwordx4 v10, s[8:11], s30 offen offset:0 lds
  v_mfma_f32_16x16x32_bf16 v[84:87], a[92:95], v[196:199], v[84:87]
  s_waitcnt lgkmcnt(2)
  v_mfma_f32_16x16x32_bf16 v[88:91], a[84:87], v[200:203], v[88:91]
  ds_read_b128 v[168:171], v18 offset:4096
  v_mfma_f32_16x16x32_bf16 v[92:95], a[88:91], v[200:203], v[92:95]
  s_cmp_lt_u32 s33, 155648
  s_cselect_b32 s33, s33, 98304
  v_mfma_f32_16x16x32_bf16 v[96:99], a[92:95], v[200:203], v[96:99]
  v_mfma_f32_16x16x32_bf16 v[100:103], a[84:87], v[204:207], v[100:103]
  ds_read_b128 v[172:175], v18 offset:6144
  v_mfma_f32_16x16x32_bf16 v[104:107], a[88:91], v[204:207], v[104:107]
  v_mfma_f32_16x16x32_bf16 v[108:111], a[92:95], v[204:207], v[108:111]
  s_waitcnt lgkmcnt(2)
  s_waitcnt vmcnt(20)
  s_barrier
  ds_read_b64_tr_b16 a[96:97], v46 offset:0
  ds_read_b64_tr_b16 a[98:99], v46 offset:1536
  ds_read_b64_tr_b16 a[100:101], v47 offset:0
  ds_read_b64_tr_b16 a[102:103], v47 offset:1536
  ds_read_b64_tr_b16 a[104:105], v48 offset:0
  ds_read_b64_tr_b16 a[106:107], v48 offset:1536
  ds_read_b64_tr_b16 a[108:109], v46 offset:12288
  ds_read_b64_tr_b16 a[110:111], v46 offset:13824
  ds_read_b64_tr_b16 a[112:113], v47 offset:12288
  ds_read_b64_tr_b16 a[114:115], v47 offset:13824
  ds_read_b64_tr_b16 a[116:117], v48 offset:12288
  ds_read_b64_tr_b16 a[118:119], v48 offset:13824
  ds_read_b64_tr_b16 a[120:121], v46 offset:24576
  ds_read_b64_tr_b16 a[122:123], v46 offset:26112
  ds_read_b64_tr_b16 a[124:125], v47 offset:24576
  ds_read_b64_tr_b16 a[126:127], v47 offset:26112
  ds_read_b64_tr_b16 a[128:129], v48 offset:24576
  ds_read_b64_tr_b16 a[130:131], v48 offset:26112
  ds_read_b64_tr_b16 a[132:133], v46 offset:36864
  ds_read_b64_tr_b16 a[134:135], v46 offset:38400
  ds_read_b64_tr_b16 a[136:137], v47 offset:36864
  ds_read_b64_tr_b16 a[138:139], v47 offset:38400
  ds_read_b64_tr_b16 a[140:141], v48 offset:36864
  ds_read_b64_tr_b16 a[142:143], v48 offset:38400
  s_waitcnt lgkmcnt(0)
  s_barrier
  s_mov_b32 s23, m0
  s_mul_i32 s21, s20, 393216
  s_add_u32 s21, s21, 6291456
  s_add_u32 s21, s21, s44
  s_mul_i32 s22, s20, 12288
  s_add_u32 s22, s22, 0
  s_add_u32 m0, s22, 0
  s_nop 0
  buffer_load_dwordx4 v40, s[12:15], s21 offen lds
  s_add_u32 m0, s22, 1024
  s_nop 0
  buffer_load_dwordx4 v41, s[12:15], s21 offen lds
  s_add_u32 m0, s22, 2048
  s_nop 0
  buffer_load_dwordx4 v42, s[12:15], s21 offen lds
  s_mul_i32 s21, s20, 393216
  s_add_u32 s21, s21, 6389760
  s_add_u32 s21, s21, s44
  s_mul_i32 s22, s20, 12288
  s_add_u32 s22, s22, 3072
  s_add_u32 m0, s22, 0
  s_nop 0
  buffer_load_dwordx4 v43, s[12:15], s21 offen lds
  s_add_u32 m0, s22, 1024
  s_nop 0
  buffer_load_dwordx4 v44, s[12:15], s21 offen lds
  s_add_u32 m0, s22, 2048
  s_nop 0
  buffer_load_dwordx4 v45, s[12:15], s21 offen lds
  s_mul_i32 s21, s20, 393216
  s_add_u32 s21, s21, 6488064
  s_add_u32 s21, s21, s44
  s_mul_i32 s22, s20, 12288
  s_add_u32 s22, s22, 6144
  s_add_u32 m0, s22, 0
  s_nop 0
  buffer_load_dwordx4 v40, s[12:15], s21 offen lds
  s_add_u32 m0, s22, 1024
  s_nop 0
  buffer_load_dwordx4 v41, s[12:15], s21 offen lds
  s_add_u32 m0, s22, 2048
  s_nop 0
  buffer_load_dwordx4 v42, s[12:15], s21 offen lds
  s_mul_i32 s21, s20, 393216
  s_add_u32 s21, s21, 6586368
  s_add_u32 s21, s21, s44
  s_mul_i32 s22, s20, 12288
  s_add_u32 s22, s22, 9216
  s_add_u32 m0, s22, 0
  s_nop 0
  buffer_load_dwordx4 v43, s[12:15], s21 offen lds
  s_add_u32 m0, s22, 1024
  s_nop 0
  buffer_load_dwordx4 v44, s[12:15], s21 offen lds
  s_add_u32 m0, s22, 2048
  s_nop 0
  buffer_load_dwordx4 v45, s[12:15], s21 offen lds
  s_mov_b32 m0, s23
  v_mov_b32 v29, 76
  buffer_load_dword v29, v29, s[64:67], 0 offen sc1
  v_mfma_f32_16x16x32_bf16 v[64:67], a[96:99], v[160:163], v[64:67]
  ds_read_b128 v[192:195], v19 offset:0
  v_mfma_f32_16x16x32_bf16 v[68:71], a[100:103], v[160:163], v[68:71]
  v_add_u32 v18, s33, v14
  s_mov_b32 s61, s60
  v_mfma_f32_16x16x32_bf16 v[72:75], a[104:107], v[160:163], v[72:75]
  s_add_u32 s60, s60, s62
  s_lshr_b32 s48, s20, 1
  v_mfma_f32_16x16x32_bf16 v[76:79], a[96:99], v[164:167], v[76:79]
  ds_read_b128 v[196:199], v19 offset:2048
  s_mul_i32 s48, s48, 393216
  v_mfma_f32_16x16x32_bf16 v[80:83], a[100:103], v[164:167], v[80:83]
  buffer_load_dwordx4 v11, s[8:11], s30 offen offset:1024 lds
  v_mfma_f32_16x16x32_bf16 v[84:87], a[104:107], v[164:167], v[84:87]
  s_add_u32 s30, s30, s25
  v_mfma_f32_16x16x32_bf16 v[88:91], a[96:99], v[168:171], v[88:91]
  ds_read_b128 v[200:203], v19 offset:4096
  s_sub_u32 s30, s30, 1152
  v_mfma_f32_16x16x32_bf16 v[92:95], a[100:103], v[168:171], v[92:95]
  s_add_u32 m0, m0, 8192
  s_and_b32 s21, s20, 1
  v_mfma_f32_16x16x32_bf16 v[96:99], a[104:107], v[168:171], v[96:99]
  s_cmp_lt_u32 m0, s46
  s_cselect_b32 m0, m0, s47
  v_mfma_f32_16x16x32_bf16 v[100:103], a[96:99], v[172:175], v[100:103]
  ds_read_b128 v[204:207], v19 offset:6144
  s_mul_i32 s21, s21, 6144
  v_mfma_f32_16x16x32_bf16 v[104:107], a[100:103], v[172:175], v[104:107]
  s_add_u32 s48, s48, s21
  s_add_u32 s48, s48, s27
  v_mfma_f32_16x16x32_bf16 v[108:111], a[104:107], v[172:175], v[108:111]
  s_waitcnt vmcnt(33) lgkmcnt(2)
  s_barrier
  v_mfma_f32_16x16x32_bf16 v[64:67], a[108:111], v[192:195], v[64:67]
  ds_read_b128 v[160:163], v18 offset:0
  s_add_u32 s27, s27, s28
  v_mfma_f32_16x16x32_bf16 v[68:71], a[112:115], v[192:195], v[68:71]
  s_sub_u32 s26, s26, 1
  v_mfma_f32_16x16x32_bf16 v[72:75], a[116:119], v[192:195], v[72:75]
  v_add_u32 v19, s33, v15
  s_add_u32 s33, s33, 8192
  v_mfma_f32_16x16x32_bf16 v[76:79], a[108:111], v[196:199], v[76:79]
  ds_read_b128 v[164:167], v18 offset:2048
  v_mfma_f32_16x16x32_bf16 v[80:83], a[112:115], v[196:199], v[80:83]
  buffer_load_dwordx4 v10, s[8:11], s30 offen offset:0 lds
  v_mfma_f32_16x16x32_bf16 v[84:87], a[116:119], v[196:199], v[84:87]
  s_waitcnt lgkmcnt(2)
  v_mfma_f32_16x16x32_bf16 v[88:91], a[108:111], v[200:203], v[88:91]
  ds_read_b128 v[168:171], v18 offset:4096
  v_mfma_f32_16x16x32_bf16 v[92:95], a[112:115], v[200:203], v[92:95]
  s_cmp_lt_u32 s33, 155648
  s_cselect_b32 s33, s33, 98304
  v_mfma_f32_16x16x32_bf16 v[96:99], a[116:119], v[200:203], v[96:99]
  v_mfma_f32_16x16x32_bf16 v[100:103], a[108:111], v[204:207], v[100:103]
  ds_read_b128 v[172:175], v18 offset:6144
  v_mfma_f32_16x16x32_bf16 v[104:107], a[112:115], v[204:207], v[104:107]
  v_mfma_f32_16x16x32_bf16 v[108:111], a[116:119], v[204:207], v[108:111]
  s_waitcnt lgkmcnt(2)
  v_mfma_f32_16x16x32_bf16 v[64:67], a[120:123], v[160:163], v[64:67]
  ds_read_b128 v[192:195], v19 offset:0
  v_mfma_f32_16x16x32_bf16 v[68:71], a[124:127], v[160:163], v[68:71]
  v_add_u32 v18, s33, v14
  v_mfma_f32_16x16x32_bf16 v[72:75], a[128:131], v[160:163], v[72:75]
  v_mfma_f32_16x16x32_bf16 v[76:79], a[120:123], v[164:167], v[76:79]
  ds_read_b128 v[196:199], v19 offset:2048
  v_mfma_f32_16x16x32_bf16 v[80:83], a[124:127], v[164:167], v[80:83]
  buffer_load_dwordx4 v11, s[8:11], s30 offen offset:1024 lds
  v_mfma_f32_16x16x32_bf16 v[84:87], a[128:131], v[164:167], v[84:87]
  s_waitcnt lgkmcnt(2)
  s_add_u32 s30, s30, 128
  v_mfma_f32_16x16x32_bf16 v[88:91], a[120:123], v[168:171], v[88:91]
  ds_read_b128 v[200:203], v19 offset:4096
  s_add_u32 m0, m0, 8192
  v_mfma_f32_16x16x32_bf16 v[92:95], a[124:127], v[168:171], v[92:95]
  s_cmp_lt_u32 m0, s46
  s_cselect_b32 m0, m0, s47
  v_mfma_f32_16x16x32_bf16 v[96:99], a[128:131], v[168:171], v[96:99]
  v_mfma_f32_16x16x32_bf16 v[100:103], a[120:123], v[172:175], v[100:103]
  ds_read_b128 v[204:207], v19 offset:6144
  v_mfma_f32_16x16x32_bf16 v[104:107], a[124:127], v[172:175], v[104:107]
  v_mfma_f32_16x16x32_bf16 v[108:111], a[128:131], v[172:175], v[108:111]
  s_waitcnt vmcnt(33) lgkmcnt(2)
  s_barrier
  v_mfma_f32_16x16x32_bf16 v[64:67], a[132:135], v[192:195], v[64:67]
  ds_read_b128 v[160:163], v18 offset:0
  v_mfma_f32_16x16x32_bf16 v[68:71], a[136:139], v[192:195], v[68:71]
  v_mfma_f32_16x16x32_bf16 v[72:75], a[140:143], v[192:195], v[72:75]
  v_add_u32 v19, s33, v15
  s_add_u32 s33, s33, 8192
  v_mfma_f32_16x16x32_bf16 v[76:79], a[132:135], v[196:199], v[76:79]
  ds_read_b128 v[164:167], v18 offset:2048
  v_mfma_f32_16x16x32_bf16 v[80:83], a[136:139], v[196:199], v[80:83]
  buffer_load_dwordx4 v10, s[8:11], s30 offen offset:0 lds
  v_mfma_f32_16x16x32_bf16 v[84:87], a[140:143], v[196:199], v[84:87]
  s_waitcnt lgkmcnt(2)
  v_mfma_f32_16x16x32_bf16 v[88:91], a[132:135], v[200:203], v[88:91]
  ds_read_b128 v[168:171], v18 offset:4096
  v_mfma_f32_16x16x32_bf16 v[92:95], a[136:139], v[200:203], v[92:95]
  s_cmp_lt_u32 s33, 155648
  s_cselect_b32 s33, s33, 98304
  v_mfma_f32_16x16x32_bf16 v[96:99], a[140:143], v[200:203], v[96:99]
  v_mfma_f32_16x16x32_bf16 v[100:103], a[132:135], v[204:207], v[100:103]
  ds_read_b128 v[172:175], v18 offset:6144
  v_mfma_f32_16x16x32_bf16 v[104:107], a[136:139], v[204:207], v[104:107]
  v_mfma_f32_16x16x32_bf16 v[108:111], a[140:143], v[204:207], v[108:111]
  s_waitcnt lgkmcnt(2)
  s_waitcnt vmcnt(21)
  s_barrier
  ds_read_b64_tr_b16 a[144:145], v49 offset:0
  ds_read_b64_tr_b16 a[146:147], v49 offset:1536
  ds_read_b64_tr_b16 a[148:149], v50 offset:0
  ds_read_b64_tr_b16 a[150:151], v50 offset:1536
  ds_read_b64_tr_b16 a[152:153], v51 offset:0
  ds_read_b64_tr_b16 a[154:155], v51 offset:1536
  ds_read_b64_tr_b16 a[156:157], v49 offset:12288
  ds_read_b64_tr_b16 a[158:159], v49 offset:13824
  ds_read_b64_tr_b16 a[160:161], v50 offset:12288
  ds_read_b64_tr_b16 a[162:163], v50 offset:13824
  ds_read_b64_tr_b16 a[164:165], v51 offset:12288
  ds_read_b64_tr_b16 a[166:167], v51 offset:13824
  ds_read_b64_tr_b16 a[168:169], v49 offset:24576
  ds_read_b64_tr_b16 a[170:171], v49 offset:26112
  ds_read_b64_tr_b16 a[172:173], v50 offset:24576
  ds_read_b64_tr_b16 a[174:175], v50 offset:26112
  ds_read_b64_tr_b16 a[176:177], v51 offset:24576
  ds_read_b64_tr_b16 a[178:179], v51 offset:26112
  ds_read_b64_tr_b16 a[180:181], v49 offset:36864
  ds_read_b64_tr_b16 a[182:183], v49 offset:38400
  ds_read_b64_tr_b16 a[184:185], v50 offset:36864
  ds_read_b64_tr_b16 a[186:187], v50 offset:38400
  ds_read_b64_tr_b16 a[188:189], v51 offset:36864
  ds_read_b64_tr_b16 a[190:191], v51 offset:38400
  s_waitcnt lgkmcnt(0)
  s_barrier
  v_mfma_f32_16x16x32_bf16 v[64:67], a[144:147], v[160:163], v[64:67]
  ds_read_b128 v[192:195], v19 offset:0
  v_mfma_f32_16x16x32_bf16 v[68:71], a[148:151], v[160:163], v[68:71]
  v_add_u32 v18, s33, v14
  v_mfma_f32_16x16x32_bf16 v[72:75], a[152:155], v[160:163], v[72:75]
  v_mfma_f32_16x16x32_bf16 v[76:79], a[144:147], v[164:167], v[76:79]
  ds_read_b128 v[196:199], v19 offset:2048
  v_mfma_f32_16x16x32_bf16 v[80:83], a[148:151], v[164:167], v[80:83]
  buffer_load_dwordx4 v11, s[8:11], s30 offen offset:1024 lds
  v_mfma_f32_16x16x32_bf16 v[84:87], a[152:155], v[164:167], v[84:87]
  s_add_u32 s30, s30, 128
  v_mfma_f32_16x16x32_bf16 v[88:91], a[144:147], v[168:171], v[88:91]
  ds_read_b128 v[200:203], v19 offset:4096
  s_add_u32 m0, m0, 8192
  v_mfma_f32_16x16x32_bf16 v[92:95], a[148:151], v[168:171], v[92:95]
  s_cmp_lt_u32 m0, s46
  s_cselect_b32 m0, m0, s47
  v_mfma_f32_16x16x32_bf16 v[96:99], a[152:155], v[168:171], v[96:99]
  v_mfma_f32_16x16x32_bf16 v[100:103], a[144:147], v[172:175], v[100:103]
  ds_read_b128 v[204:207], v19 offset:6144
  v_mfma_f32_16x16x32_bf16 v[104:107], a[148:151], v[172:175], v[104:107]
  v_mfma_f32_16x16x32_bf16 v[108:111], a[152:155], v[172:175], v[108:111]
  s_waitcnt vmcnt(21) lgkmcnt(2)
  s_barrier
  v_mfma_f32_16x16x32_bf16 v[64:67], a[156:159], v[192:195], v[64:67]
  ds_read_b128 v[160:163], v18 offset:0
  v_mfma_f32_16x16x32_bf16 v[68:71], a[160:163], v[192:195], v[68:71]
  v_mfma_f32_16x16x32_bf16 v[72:75], a[164:167], v[192:195], v[72:75]
  v_add_u32 v19, s33, v15
  s_add_u32 s33, s33, 8192
  v_mfma_f32_16x16x32_bf16 v[76:79], a[156:159], v[196:199], v[76:79]
  ds_read_b128 v[164:167], v18 offset:2048
  v_mfma_f32_16x16x32_bf16 v[80:83], a[160:163], v[196:199], v[80:83]
  buffer_load_dwordx4 v10, s[8:11], s30 offen offset:0 lds
  v_mfma_f32_16x16x32_bf16 v[84:87], a[164:167], v[196:199], v[84:87]
  s_waitcnt lgkmcnt(2)
  v_mfma_f32_16x16x32_bf16 v[88:91], a[156:159], v[200:203], v[88:91]
  ds_read_b128 v[168:171], v18 offset:4096
  v_mfma_f32_16x16x32_bf16 v[92:95], a[160:163], v[200:203], v[92:95]
  s_cmp_lt_u32 s33, 155648
  s_cselect_b32 s33, s33, 98304
  v_mfma_f32_16x16x32_bf16 v[96:99], a[164:167], v[200:203], v[96:99]
  v_mfma_f32_16x16x32_bf16 v[100:103], a[156:159], v[204:207], v[100:103]
  ds_read_b128 v[172:175], v18 offset:6144
  v_mfma_f32_16x16x32_bf16 v[104:107], a[160:163], v[204:207], v[104:107]
  v_mfma_f32_16x16x32_bf16 v[108:111], a[164:167], v[204:207], v[108:111]
  s_waitcnt lgkmcnt(2)
  v_mfma_f32_16x16x32_bf16 v[64:67], a[168:171], v[160:163], v[64:67]
  ds_read_b128 v[192:195], v19 offset:0
  v_mfma_f32_16x16x32_bf16 v[68:71], a[172:175], v[160:163], v[68:71]
  v_add_u32 v18, s33, v14
  v_mfma_f32_16x16x32_bf16 v[72:75], a[176:179], v[160:163], v[72:75]
  v_mfma_f32_16x16x32_bf16 v[76:79], a[168:171], v[164:167], v[76:79]
  ds_read_b128 v[196:199], v19 offset:2048
  v_mfma_f32_16x16x32_bf16 v[80:83], a[172:175], v[164:167], v[80:83]
  buffer_load_dwordx4 v11, s[8:11], s30 offen offset:1024 lds
  v_mfma_f32_16x16x32_bf16 v[84:87], a[176:179], v[164:167], v[84:87]
  s_waitcnt lgkmcnt(2)
  s_add_u32 s30, s30, 128
  v_mfma_f32_16x16x32_bf16 v[88:91], a[168:171], v[168:171], v[88:91]
  ds_read_b128 v[200:203], v19 offset:4096
  s_add_u32 m0, m0, 8192
  v_mfma_f32_16x16x32_bf16 v[92:95], a[172:175], v[168:171], v[92:95]
  s_cmp_lt_u32 m0, s46
  s_cselect_b32 m0, m0, s47
  v_mfma_f32_16x16x32_bf16 v[96:99], a[176:179], v[168:171], v[96:99]
  v_mfma_f32_16x16x32_bf16 v[100:103], a[168:171], v[172:175], v[100:103]
  ds_read_b128 v[204:207], v19 offset:6144
  v_mfma_f32_16x16x32_bf16 v[104:107], a[172:175], v[172:175], v[104:107]
  v_mfma_f32_16x16x32_bf16 v[108:111], a[176:179], v[172:175], v[108:111]
  s_waitcnt vmcnt(21) lgkmcnt(2)
  s_barrier
  v_mfma_f32_16x16x32_bf16 v[64:67], a[180:183], v[192:195], v[64:67]
  ds_read_b128 v[160:163], v18 offset:0
  v_mfma_f32_16x16x32_bf16 v[68:71], a[184:187], v[192:195], v[68:71]
  v_mfma_f32_16x16x32_bf16 v[72:75], a[188:191], v[192:195], v[72:75]
  v_add_u32 v19, s33, v15
  s_add_u32 s33, s33, 8192
  v_mfma_f32_16x16x32_bf16 v[76:79], a[180:183], v[196:199], v[76:79]
  ds_read_b128 v[164:167], v18 offset:2048
  v_mfma_f32_16x16x32_bf16 v[80:83], a[184:187], v[196:199], v[80:83]
  buffer_load_dwordx4 v10, s[8:11], s30 offen offset:0 lds
  v_mfma_f32_16x16x32_bf16 v[84:87], a[188:191], v[196:199], v[84:87]
  s_waitcnt lgkmcnt(2)
  v_mfma_f32_16x16x32_bf16 v[88:91], a[180:183], v[200:203], v[88:91]
  ds_read_b128 v[168:171], v18 offset:4096
  v_mfma_f32_16x16x32_bf16 v[92:95], a[184:187], v[200:203], v[92:95]
  s_cmp_lt_u32 s33, 155648
  s_cselect_b32 s33, s33, 98304
  v_mfma_f32_16x16x32_bf16 v[96:99], a[188:191], v[200:203], v[96:99]
  v_mfma_f32_16x16x32_bf16 v[100:103], a[180:183], v[204:207], v[100:103]
  ds_read_b128 v[172:175], v18 offset:6144
  v_mfma_f32_16x16x32_bf16 v[104:107], a[184:187], v[204:207], v[104:107]
  v_mfma_f32_16x16x32_bf16 v[108:111], a[188:191], v[204:207], v[108:111]
  s_waitcnt lgkmcnt(2)
  s_waitcnt vmcnt(9)
  s_barrier
  ds_read_b64_tr_b16 a[192:193], v46 offset:0
  ds_read_b64_tr_b16 a[194:195], v46 offset:1536
  ds_read_b64_tr_b16 a[196:197], v47 offset:0
  ds_read_b64_tr_b16 a[198:199], v47 offset:1536
  ds_read_b64_tr_b16 a[200:201], v48 offset:0
  ds_read_b64_tr_b16 a[202:203], v48 offset:1536
  ds_read_b64_tr_b16 a[204:205], v46 offset:12288
  ds_read_b64_tr_b16 a[206:207], v46 offset:13824
  ds_read_b64_tr_b16 a[208:209], v47 offset:12288
  ds_read_b64_tr_b16 a[210:211], v47 offset:13824
  ds_read_b64_tr_b16 a[212:213], v48 offset:12288
  ds_read_b64_tr_b16 a[214:215], v48 offset:13824
  ds_read_b64_tr_b16 a[216:217], v46 offset:24576
  ds_read_b64_tr_b16 a[218:219], v46 offset:26112
  ds_read_b64_tr_b16 a[220:221], v47 offset:24576
  ds_read_b64_tr_b16 a[222:223], v47 offset:26112
  ds_read_b64_tr_b16 a[224:225], v48 offset:24576
  ds_read_b64_tr_b16 a[226:227], v48 offset:26112
  ds_read_b64_tr_b16 a[228:229], v46 offset:36864
  ds_read_b64_tr_b16 a[230:231], v46 offset:38400
  ds_read_b64_tr_b16 a[232:233], v47 offset:36864
  ds_read_b64_tr_b16 a[234:235], v47 offset:38400
  ds_read_b64_tr_b16 a[236:237], v48 offset:36864
  ds_read_b64_tr_b16 a[238:239], v48 offset:38400
  s_waitcnt lgkmcnt(0)
  s_barrier
  v_mfma_f32_16x16x32_bf16 v[64:67], a[192:195], v[160:163], v[64:67]
  ds_read_b128 v[192:195], v19 offset:0
  v_mfma_f32_16x16x32_bf16 v[68:71], a[196:199], v[160:163], v[68:71]
  v_add_u32 v18, s33, v14
  v_mfma_f32_16x16x32_bf16 v[72:75], a[200:203], v[160:163], v[72:75]
  v_mfma_f32_16x16x32_bf16 v[76:79], a[192:195], v[164:167], v[76:79]
  ds_read_b128 v[196:199], v19 offset:2048
  v_mfma_f32_16x16x32_bf16 v[80:83], a[196:199], v[164:167], v[80:83]
  buffer_load_dwordx4 v11, s[8:11], s30 offen offset:1024 lds
  v_mfma_f32_16x16x32_bf16 v[84:87], a[200:203], v[164:167], v[84:87]
  s_add_u32 s30, s30, 128
  v_mfma_f32_16x16x32_bf16 v[88:91], a[192:195], v[168:171], v[88:91]
  ds_read_b128 v[200:203], v19 offset:4096
  s_add_u32 m0, m0, 8192
  v_mfma_f32_16x16x32_bf16 v[92:95], a[196:199], v[168:171], v[92:95]
  s_cmp_lt_u32 m0, s46
  s_cselect_b32 m0, m0, s47
  v_mfma_f32_16x16x32_bf16 v[96:99], a[200:203], v[168:171], v[96:99]
  v_mfma_f32_16x16x32_bf16 v[100:103], a[192:195], v[172:175], v[100:103]
  ds_read_b128 v[204:207], v19 offset:6144
  v_mfma_f32_16x16x32_bf16 v[104:107], a[196:199], v[172:175], v[104:107]
  v_mfma_f32_16x16x32_bf16 v[108:111], a[200:203], v[172:175], v[108:111]
  s_waitcnt vmcnt(8) lgkmcnt(2)
  s_barrier
  v_mfma_f32_16x16x32_bf16 v[64:67], a[204:207], v[192:195], v[64:67]
  ds_read_b128 v[160:163], v18 offset:0
  v_mfma_f32_16x16x32_bf16 v[68:71], a[208:211], v[192:195], v[68:71]
  v_mfma_f32_16x16x32_bf16 v[72:75], a[212:215], v[192:195], v[72:75]
  v_add_u32 v19, s33, v15
  s_add_u32 s33, s33, 8192
  v_mfma_f32_16x16x32_bf16 v[76:79], a[204:207], v[196:199], v[76:79]
  ds_read_b128 v[164:167], v18 offset:2048
  v_mfma_f32_16x16x32_bf16 v[80:83], a[208:211], v[196:199], v[80:83]
  buffer_load_dwordx4 v10, s[8:11], s30 offen offset:0 lds
  v_mfma_f32_16x16x32_bf16 v[84:87], a[212:215], v[196:199], v[84:87]
  s_waitcnt lgkmcnt(2)
  v_mfma_f32_16x16x32_bf16 v[88:91], a[204:207], v[200:203], v[88:91]
  ds_read_b128 v[168:171], v18 offset:4096
  v_mfma_f32_16x16x32_bf16 v[92:95], a[208:211], v[200:203], v[92:95]
  s_cmp_lt_u32 s33, 155648
  s_cselect_b32 s33, s33, 98304
  v_mfma_f32_16x16x32_bf16 v[96:99], a[212:215], v[200:203], v[96:99]
  v_mfma_f32_16x16x32_bf16 v[100:103], a[204:207], v[204:207], v[100:103]
  ds_read_b128 v[172:175], v18 offset:6144
  v_mfma_f32_16x16x32_bf16 v[104:107], a[208:211], v[204:207], v[104:107]
  v_mfma_f32_16x16x32_bf16 v[108:111], a[212:215], v[204:207], v[108:111]
  s_waitcnt lgkmcnt(2)
  v_mfma_f32_16x16x32_bf16 v[64:67], a[216:219], v[160:163], v[64:67]
  ds_read_b128 v[192:195], v19 offset:0
  v_mfma_f32_16x16x32_bf16 v[68:71], a[220:223], v[160:163], v[68:71]
  v_add_u32 v18, s33, v14
  v_mfma_f32_16x16x32_bf16 v[72:75], a[224:227], v[160:163], v[72:75]
  v_mfma_f32_16x16x32_bf16 v[76:79], a[216:219], v[164:167], v[76:79]
  ds_read_b128 v[196:199], v19 offset:2048
  v_mfma_f32_16x16x32_bf16 v[80:83], a[220:223], v[164:167], v[80:83]
  buffer_load_dwordx4 v11, s[8:11], s30 offen offset:1024 lds
  v_mfma_f32_16x16x32_bf16 v[84:87], a[224:227], v[164:167], v[84:87]
  s_waitcnt lgkmcnt(2)
  s_add_u32 s30, s30, 128
  v_mfma_f32_16x16x32_bf16 v[88:91], a[216:219], v[168:171], v[88:91]
  ds_read_b128 v[200:203], v19 offset:4096
  s_add_u32 m0, m0, 8192
  v_mfma_f32_16x16x32_bf16 v[92:95], a[220:223], v[168:171], v[92:95]
  s_cmp_lt_u32 m0, s46
  s_cselect_b32 m0, m0, s47
  v_mfma_f32_16x16x32_bf16 v[96:99], a[224:227], v[168:171], v[96:99]
  v_mfma_f32_16x16x32_bf16 v[100:103], a[216:219], v[172:175], v[100:103]
  ds_read_b128 v[204:207], v19 offset:6144
  v_mfma_f32_16x16x32_bf16 v[104:107], a[220:223], v[172:175], v[104:107]
  v_mfma_f32_16x16x32_bf16 v[108:111], a[224:227], v[172:175], v[108:111]
  s_waitcnt vmcnt(8) lgkmcnt(2)
  s_barrier
  v_mfma_f32_16x16x32_bf16 v[64:67], a[228:231], v[192:195], v[64:67]
  ds_read_b128 v[160:163], v18 offset:0
  v_mfma_f32_16x16x32_bf16 v[68:71], a[232:235], v[192:195], v[68:71]
  v_mfma_f32_16x16x32_bf16 v[72:75], a[236:239], v[192:195], v[72:75]
  v_add_u32 v19, s33, v15
  s_add_u32 s33, s33, 8192
  v_mfma_f32_16x16x32_bf16 v[76:79], a[228:231], v[196:199], v[76:79]
  ds_read_b128 v[164:167], v18 offset:2048
  v_cvt_pk_bf16_f32 v224, v64, v65
  v_cvt_pk_bf16_f32 v225, v66, v67
  v_mfma_f32_16x16x32_bf16 v[80:83], a[232:235], v[196:199], v[80:83]
  buffer_load_dwordx4 v10, s[8:11], s30 offen offset:0 lds
  v_cvt_pk_bf16_f32 v226, v68, v69
  v_cvt_pk_bf16_f32 v227, v70, v71
  v_mfma_f32_16x16x32_bf16 v[84:87], a[236:239], v[196:199], v[84:87]
  s_waitcnt lgkmcnt(2)
  v_cvt_pk_bf16_f32 v228, v72, v73
  v_cvt_pk_bf16_f32 v229, v74, v75
  v_mfma_f32_16x16x32_bf16 v[88:91], a[228:231], v[200:203], v[88:91]
  ds_read_b128 v[168:171], v18 offset:4096
  ds_write_b64 v22, v[224:225] offset:0
  v_mfma_f32_16x16x32_bf16 v[92:95], a[232:235], v[200:203], v[92:95]
  s_cmp_lt_u32 s33, 155648
  s_cselect_b32 s33, s33, 98304
  ds_write_b64 v22, v[226:227] offset:8
  v_mfma_f32_16x16x32_bf16 v[96:99], a[236:239], v[200:203], v[96:99]
  ds_write_b64 v16, v[228:229] offset:64
  v_cvt_pk_bf16_f32 v230, v76, v77
  v_cvt_pk_bf16_f32 v231, v78, v79
  v_mfma_f32_16x16x32_bf16 v[100:103], a[228:231], v[204:207], v[100:103]
  ds_read_b128 v[172:175], v18 offset:6144
  v_cvt_pk_bf16_f32 v232, v80, v81
  v_cvt_pk_bf16_f32 v233, v82, v83
  v_cvt_pk_bf16_f32 v234, v84, v85
  v_mfma_f32_16x16x32_bf16 v[104:107], a[232:235], v[204:207], v[104:107]
  v_cvt_pk_bf16_f32 v235, v86, v87
  ds_write_b64 v22, v[230:231] offset:6400
  v_mfma_f32_16x16x32_bf16 v[108:111], a[236:239], v[204:207], v[108:111]
  ds_write_b64 v22, v[232:233] offset:6408
  ds_write_b64 v16, v[234:235] offset:6464
  v_readfirstlane_b32 s21, v29
  s_cmp_ge_u32 s21, 32
  s_cbranch_scc1 kvz_159
  s_mov_b32 s21, 76
  v_mov_b32 v4, 0
  s_mov_b32 s101, 0
wf_160:
  buffer_load_dword v5, v4, s[64:67], s21 offen sc1
  s_add_u32 s101, s101, 1
  s_cmp_gt_u32 s101, 131072
  s_cbranch_scc1 main_end
  s_waitcnt vmcnt(0)
  v_readfirstlane_b32 s100, v5
  s_cmp_ge_u32 s100, 32
  s_cbranch_scc1 wf_161
  s_sleep 8
  s_branch wf_160
wf_161:
kvz_159:
  s_branch kvm_end_158
kvm_blk_157:
  v_mfma_f32_16x16x32_bf16 v[64:67], a[0:3], v[160:163], 0
  ds_read_b128 v[192:195], v19 offset:0
  v_mfma_f32_16x16x32_bf16 v[68:71], a[4:7], v[160:163], 0
  v_add_u32 v18, s33, v14
  v_mfma_f32_16x16x32_bf16 v[72:75], a[8:11], v[160:163], 0
  v_mfma_f32_16x16x32_bf16 v[76:79], a[0:3], v[164:167], 0
  ds_read_b128 v[196:199], v19 offset:2048
  v_mfma_f32_16x16x32_bf16 v[80:83], a[4:7], v[164:167], 0
  buffer_load_dwordx4 v11, s[8:11], s30 offen offset:1024 lds
  v_mfma_f32_16x16x32_bf16 v[84:87], a[8:11], v[164:167], 0
  s_waitcnt lgkmcnt(11)
  s_add_u32 s30, s30, 128
  v_mfma_f32_16x16x32_bf16 v[88:91], a[0:3], v[168:171], 0
  ds_read_b128 v[200:203], v19 offset:4096
  s_add_u32 m0, m0, 8192
  v_mfma_f32_16x16x32_bf16 v[92:95], a[4:7], v[168:171], 0
  s_cmp_lt_u32 m0, s46
  s_cselect_b32 m0, m0, s47
  v_mfma_f32_16x16x32_bf16 v[96:99], a[8:11], v[168:171], 0
  v_mfma_f32_16x16x32_bf16 v[100:103], a[0:3], v[172:175], 0
  ds_read_b128 v[204:207], v19 offset:6144
  v_mfma_f32_16x16x32_bf16 v[104:107], a[4:7], v[172:175], 0
  v_mfma_f32_16x16x32_bf16 v[108:111], a[8:11], v[172:175], 0
  s_waitcnt vmcnt(14) lgkmcnt(2)
  s_barrier
  v_mfma_f32_16x16x32_bf16 v[64:67], a[12:15], v[192:195], v[64:67]
  ds_read_b128 v[160:163], v18 offset:0
  v_mfma_f32_16x16x32_bf16 v[68:71], a[16:19], v[192:195], v[68:71]
  v_mfma_f32_16x16x32_bf16 v[72:75], a[20:23], v[192:195], v[72:75]
  v_add_u32 v19, s33, v15
  s_add_u32 s33, s33, 8192
  v_mfma_f32_16x16x32_bf16 v[76:79], a[12:15], v[196:199], v[76:79]
  ds_read_b128 v[164:167], v18 offset:2048
  v_mfma_f32_16x16x32_bf16 v[80:83], a[16:19], v[196:199], v[80:83]
  buffer_load_dwordx4 v10, s[8:11], s30 offen offset:0 lds
  v_mfma_f32_16x16x32_bf16 v[84:87], a[20:23], v[196:199], v[84:87]
  s_waitcnt lgkmcnt(2)
  v_mfma_f32_16x16x32_bf16 v[88:91], a[12:15], v[200:203], v[88:91]
  ds_read_b128 v[168:171], v18 offset:4096
  v_mfma_f32_16x16x32_bf16 v[92:95], a[16:19], v[200:203], v[92:95]
  s_cmp_lt_u32 s33, 155648
  s_cselect_b32 s33, s33, 98304
  v_mfma_f32_16x16x32_bf16 v[96:99], a[20:23], v[200:203], v[96:99]
  v_mfma_f32_16x16x32_bf16 v[100:103], a[12:15], v[204:207], v[100:103]
  ds_read_b128 v[172:175], v18 offset:6144
  v_mfma_f32_16x16x32_bf16 v[104:107], a[16:19], v[204:207], v[104:107]
  v_mfma_f32_16x16x32_bf16 v[108:111], a[20:23], v[204:207], v[108:111]
  s_waitcnt lgkmcnt(2)
  v_mfma_f32_16x16x32_bf16 v[64:67], a[24:27], v[160:163], v[64:67]
  ds_read_b128 v[192:195], v19 offset:0
  v_mfma_f32_16x16x32_bf16 v[68:71], a[28:31], v[160:163], v[68:71]
  v_add_u32 v18, s33, v14
  v_mfma_f32_16x16x32_bf16 v[72:75], a[32:35], v[160:163], v[72:75]
  v_mfma_f32_16x16x32_bf16 v[76:79], a[24:27], v[164:167], v[76:79]
  ds_read_b128 v[196:199], v19 offset:2048
  v_mfma_f32_16x16x32_bf16 v[80:83], a[28:31], v[164:167], v[80:83]
  buffer_load_dwordx4 v11, s[8:11], s30 offen offset:1024 lds
  v_mfma_f32_16x16x32_bf16 v[84:87], a[32:35], v[164:167], v[84:87]
  s_waitcnt lgkmcnt(2)
  s_add_u32 s30, s30, 128
  v_mfma_f32_16x16x32_bf16 v[88:91], a[24:27], v[168:171], v[88:91]
  ds_read_b128 v[200:203], v19 offset:4096
  s_add_u32 m0, m0, 8192
  v_mfma_f32_16x16x32_bf16 v[92:95], a[28:31], v[168:171], v[92:95]
  s_cmp_lt_u32 m0, s46
  s_cselect_b32 m0, m0, s47
  v_mfma_f32_16x16x32_bf16 v[96:99], a[32:35], v[168:171], v[96:99]
  v_mfma_f32_16x16x32_bf16 v[100:103], a[24:27], v[172:175], v[100:103]
  ds_read_b128 v[204:207], v19 offset:6144
  v_mfma_f32_16x16x32_bf16 v[104:107], a[28:31], v[172:175], v[104:107]
  v_mfma_f32_16x16x32_bf16 v[108:111], a[32:35], v[172:175], v[108:111]
  s_waitcnt vmcnt(14) lgkmcnt(2)
  s_barrier
  v_mfma_f32_16x16x32_bf16 v[64:67], a[36:39], v[192:195], v[64:67]
  ds_read_b128 v[160:163], v18 offset:0
  v_mfma_f32_16x16x32_bf16 v[68:71], a[40:43], v[192:195], v[68:71]
  v_mfma_f32_16x16x32_bf16 v[72:75], a[44:47], v[192:195], v[72:75]
  v_add_u32 v19, s33, v15
  s_add_u32 s33, s33, 8192
  v_mfma_f32_16x16x32_bf16 v[76:79], a[36:39], v[196:199], v[76:79]
  ds_read_b128 v[164:167], v18 offset:2048
  v_mfma_f32_16x16x32_bf16 v[80:83], a[40:43], v[196:199], v[80:83]
  buffer_load_dwordx4 v10, s[8:11], s30 offen offset:0 lds
  v_mfma_f32_16x16x32_bf16 v[84:87], a[44:47], v[196:199], v[84:87]
  s_waitcnt lgkmcnt(2)
  v_mfma_f32_16x16x32_bf16 v[88:91], a[36:39], v[200:203], v[88:91]
  ds_read_b128 v[168:171], v18 offset:4096
  v_mfma_f32_16x16x32_bf16 v[92:95], a[40:43], v[200:203], v[92:95]
  s_cmp_lt_u32 s33, 155648
  s_cselect_b32 s33, s33, 98304
  v_mfma_f32_16x16x32_bf16 v[96:99], a[44:47], v[200:203], v[96:99]
  v_mfma_f32_16x16x32_bf16 v[100:103], a[36:39], v[204:207], v[100:103]
  ds_read_b128 v[172:175], v18 offset:6144
  v_mfma_f32_16x16x32_bf16 v[104:107], a[40:43], v[204:207], v[104:107]
  v_mfma_f32_16x16x32_bf16 v[108:111], a[44:47], v[204:207], v[108:111]
  s_waitcnt lgkmcnt(2)
  v_mfma_f32_16x16x32_bf16 v[64:67], a[48:51], v[160:163], v[64:67]
  ds_read_b128 v[192:195], v19 offset:0
  v_mfma_f32_16x16x32_bf16 v[68:71], a[52:55], v[160:163], v[68:71]
  v_add_u32 v18, s33, v14
  v_mfma_f32_16x16x32_bf16 v[72:75], a[56:59], v[160:163], v[72:75]
  v_mfma_f32_16x16x32_bf16 v[76:79], a[48:51], v[164:167], v[76:79]
  ds_read_b128 v[196:199], v19 offset:2048
  v_mfma_f32_16x16x32_bf16 v[80:83], a[52:55], v[164:167], v[80:83]
  buffer_load_dwordx4 v11, s[8:11], s30 offen offset:1024 lds
  v_mfma_f32_16x16x32_bf16 v[84:87], a[56:59], v[164:167], v[84:87]
  s_waitcnt lgkmcnt(2)
  s_add_u32 s30, s30, 128
  v_mfma_f32_16x16x32_bf16 v[88:91], a[48:51], v[168:171], v[88:91]
  ds_read_b128 v[200:203], v19 offset:4096
  s_add_u32 m0, m0, 8192
  v_mfma_f32_16x16x32_bf16 v[92:95], a[52:55], v[168:171], v[92:95]
  s_cmp_lt_u32 m0, s46
  s_cselect_b32 m0, m0, s47
  v_mfma_f32_16x16x32_bf16 v[96:99], a[56:59], v[168:171], v[96:99]
  v_mfma_f32_16x16x32_bf16 v[100:103], a[48:51], v[172:175], v[100:103]
  ds_read_b128 v[204:207], v19 offset:6144
  v_mfma_f32_16x16x32_bf16 v[104:107], a[52:55], v[172:175], v[104:107]
  v_mfma_f32_16x16x32_bf16 v[108:111], a[56:59], v[172:175], v[108:111]
  s_waitcnt vmcnt(14) lgkmcnt(2)
  s_barrier
  v_mfma_f32_16x16x32_bf16 v[64:67], a[60:63], v[192:195], v[64:67]
  ds_read_b128 v[160:163], v18 offset:0
  v_mfma_f32_16x16x32_bf16 v[68:71], a[64:67], v[192:195], v[68:71]
  v_mfma_f32_16x16x32_bf16 v[72:75], a[68:71], v[192:195], v[72:75]
  v_add_u32 v19, s33, v15
  s_add_u32 s33, s33, 8192
  v_mfma_f32_16x16x32_bf16 v[76:79], a[60:63], v[196:199], v[76:79]
  ds_read_b128 v[164:167], v18 offset:2048
  v_mfma_f32_16x16x32_bf16 v[80:83], a[64:67], v[196:199], v[80:83]
  buffer_load_dwordx4 v10, s[8:11], s30 offen offset:0 lds
  v_mfma_f32_16x16x32_bf16 v[84:87], a[68:71], v[196:199], v[84:87]
  s_waitcnt lgkmcnt(2)
  v_mfma_f32_16x16x32_bf16 v[88:91], a[60:63], v[200:203], v[88:91]
  ds_read_b128 v[168:171], v18 offset:4096
  v_mfma_f32_16x16x32_bf16 v[92:95], a[64:67], v[200:203], v[92:95]
  s_cmp_lt_u32 s33, 155648
  s_cselect_b32 s33, s33, 98304
  v_mfma_f32_16x16x32_bf16 v[96:99], a[68:71], v[200:203], v[96:99]
  v_mfma_f32_16x16x32_bf16 v[100:103], a[60:63], v[204:207], v[100:103]
  ds_read_b128 v[172:175], v18 offset:6144
  v_mfma_f32_16x16x32_bf16 v[104:107], a[64:67], v[204:207], v[104:107]
  v_mfma_f32_16x16x32_bf16 v[108:111], a[68:71], v[204:207], v[108:111]
  s_waitcnt lgkmcnt(2)
  v_mfma_f32_16x16x32_bf16 v[64:67], a[72:75], v[160:163], v[64:67]
  ds_read_b128 v[192:195], v19 offset:0
  v_mfma_f32_16x16x32_bf16 v[68:71], a[76:79], v[160:163], v[68:71]
  v_add_u32 v18, s33, v14
  v_mfma_f32_16x16x32_bf16 v[72:75], a[80:83], v[160:163], v[72:75]
  v_mfma_f32_16x16x32_bf16 v[76:79], a[72:75], v[164:167], v[76:79]
  ds_read_b128 v[196:199], v19 offset:2048
  v_mfma_f32_16x16x32_bf16 v[80:83], a[76:79], v[164:167], v[80:83]
  buffer_load_dwordx4 v11, s[8:11], s30 offen offset:1024 lds
  v_mfma_f32_16x16x32_bf16 v[84:87], a[80:83], v[164:167], v[84:87]
  s_waitcnt lgkmcnt(2)
  s_add_u32 s30, s30, 128
  v_mfma_f32_16x16x32_bf16 v[88:91], a[72:75], v[168:171], v[88:91]
  ds_read_b128 v[200:203], v19 offset:4096
  s_add_u32 m0, m0, 8192
  v_mfma_f32_16x16x32_bf16 v[92:95], a[76:79], v[168:171], v[92:95]
  s_cmp_lt_u32 m0, s46
  s_cselect_b32 m0, m0, s47
  v_mfma_f32_16x16x32_bf16 v[96:99], a[80:83], v[168:171], v[96:99]
  v_mfma_f32_16x16x32_bf16 v[100:103], a[72:75], v[172:175], v[100:103]
  ds_read_b128 v[204:207], v19 offset:6144
  v_mfma_f32_16x16x32_bf16 v[104:107], a[76:79], v[172:175], v[104:107]
  v_mfma_f32_16x16x32_bf16 v[108:111], a[80:83], v[172:175], v[108:111]
  s_waitcnt vmcnt(7) lgkmcnt(2)
  s_barrier
  v_mfma_f32_16x16x32_bf16 v[64:67], a[84:87], v[192:195], v[64:67]
  ds_read_b128 v[160:163], v18 offset:0
  v_mfma_f32_16x16x32_bf16 v[68:71], a[88:91], v[192:195], v[68:71]
  s_cmp_eq_u32 s48, 0x80000000
  s_cbranch_scc1 kvm_155
  s_cmp_lg_u32 s20, 0
  s_cbranch_scc1 af_156
  v_mov_b32 v4, 0
  v_mov_b32 v5, 1
  s_mov_b64 exec, 1
  buffer_atomic_add v5, v4, s[72:75], s61 offen sc1
  s_mov_b64 exec, -1
  s_nop 1
af_156:
kvm_155:
  v_mfma_f32_16x16x32_bf16 v[72:75], a[92:95], v[192:195], v[72:75]
  v_add_u32 v19, s33, v15
  s_add_u32 s33, s33, 8192
  v_mfma_f32_16x16x32_bf16 v[76:79], a[84:87], v[196:199], v[76:79]
  ds_read_b128 v[164:167], v18 offset:2048
  v_mfma_f32_16x16x32_bf16 v[80:83], a[88:91], v[196:199], v[80:83]
  buffer_load_dwordx4 v10, s[8:11], s30 offen offset:0 lds
  v_mfma_f32_16x16x32_bf16 v[84:87], a[92:95], v[196:199], v[84:87]
  s_waitcnt lgkmcnt(2)
  v_mfma_f32_16x16x32_bf16 v[88:91], a[84:87], v[200:203], v[88:91]
  ds_read_b128 v[168:171], v18 offset:4096
  v_mfma_f32_16x16x32_bf16 v[92:95], a[88:91], v[200:203], v[92:95]
  s_cmp_lt_u32 s33, 155648
  s_cselect_b32 s33, s33, 98304
  v_mfma_f32_16x16x32_bf16 v[96:99], a[92:95], v[200:203], v[96:99]
  v_mfma_f32_16x16x32_bf16 v[100:103], a[84:87], v[204:207], v[100:103]
  ds_read_b128 v[172:175], v18 offset:6144
  v_mfma_f32_16x16x32_bf16 v[104:107], a[88:91], v[204:207], v[104:107]
  v_mfma_f32_16x16x32_bf16 v[108:111], a[92:95], v[204:207], v[108:111]
  s_waitcnt lgkmcnt(2)
  v_mfma_f32_16x16x32_bf16 v[64:67], a[96:99], v[160:163], v[64:67]
  ds_read_b128 v[192:195], v19 offset:0
  v_mfma_f32_16x16x32_bf16 v[68:71], a[100:103], v[160:163], v[68:71]
  v_add_u32 v18, s33, v14
  s_mov_b32 s61, s60
  v_mfma_f32_16x16x32_bf16 v[72:75], a[104:107], v[160:163], v[72:75]
  s_add_u32 s60, s60, s62
  s_lshr_b32 s48, s20, 1
  v_mfma_f32_16x16x32_bf16 v[76:79], a[96:99], v[164:167], v[76:79]
  ds_read_b128 v[196:199], v19 offset:2048
  s_mul_i32 s48, s48, 393216
  v_mfma_f32_16x16x32_bf16 v[80:83], a[100:103], v[164:167], v[80:83]
  buffer_load_dwordx4 v11, s[8:11], s30 offen offset:1024 lds
  v_mfma_f32_16x16x32_bf16 v[84:87], a[104:107], v[164:167], v[84:87]
  s_waitcnt lgkmcnt(2)
  s_add_u32 s30, s30, s25
  v_mfma_f32_16x16x32_bf16 v[88:91], a[96:99], v[168:171], v[88:91]
  ds_read_b128 v[200:203], v19 offset:4096
  s_sub_u32 s30, s30, 1152
  v_mfma_f32_16x16x32_bf16 v[92:95], a[100:103], v[168:171], v[92:95]
  s_add_u32 m0, m0, 8192
  s_and_b32 s21, s20, 1
  v_mfma_f32_16x16x32_bf16 v[96:99], a[104:107], v[168:171], v[96:99]
  s_cmp_lt_u32 m0, s46
  s_cselect_b32 m0, m0, s47
  v_mfma_f32_16x16x32_bf16 v[100:103], a[96:99], v[172:175], v[100:103]
  ds_read_b128 v[204:207], v19 offset:6144
  s_mul_i32 s21, s21, 6144
  v_mfma_f32_16x16x32_bf16 v[104:107], a[100:103], v[172:175], v[104:107]
  s_add_u32 s48, s48, s21
  s_add_u32 s48, s48, s27
  v_mfma_f32_16x16x32_bf16 v[108:111], a[104:107], v[172:175], v[108:111]
  s_waitcnt vmcnt(8) lgkmcnt(2)
  s_barrier
  v_mfma_f32_16x16x32_bf16 v[64:67], a[108:111], v[192:195], v[64:67]
  ds_read_b128 v[160:163], v18 offset:0
  s_add_u32 s27, s27, s28
  v_mfma_f32_16x16x32_bf16 v[68:71], a[112:115], v[192:195], v[68:71]
  s_sub_u32 s26, s26, 1
  v_mfma_f32_16x16x32_bf16 v[72:75], a[116:119], v[192:195], v[72:75]
  v_add_u32 v19, s33, v15
  s_add_u32 s33, s33, 8192
  v_mfma_f32_16x16x32_bf16 v[76:79], a[108:111], v[196:199], v[76:79]
  ds_read_b128 v[164:167], v18 offset:2048
  v_mfma_f32_16x16x32_bf16 v[80:83], a[112:115], v[196:199], v[80:83]
  buffer_load_dwordx4 v10, s[8:11], s30 offen offset:0 lds
  v_mfma_f32_16x16x32_bf16 v[84:87], a[116:119], v[196:199], v[84:87]
  s_waitcnt lgkmcnt(2)
  v_mfma_f32_16x16x32_bf16 v[88:91], a[108:111], v[200:203], v[88:91]
  ds_read_b128 v[168:171], v18 offset:4096
  v_mfma_f32_16x16x32_bf16 v[92:95], a[112:115], v[200:203], v[92:95]
  s_cmp_lt_u32 s33, 155648
  s_cselect_b32 s33, s33, 98304
  v_mfma_f32_16x16x32_bf16 v[96:99], a[116:119], v[200:203], v[96:99]
  v_mfma_f32_16x16x32_bf16 v[100:103], a[108:111], v[204:207], v[100:103]
  ds_read_b128 v[172:175], v18 offset:6144
  v_mfma_f32_16x16x32_bf16 v[104:107], a[112:115], v[204:207], v[104:107]
  v_mfma_f32_16x16x32_bf16 v[108:111], a[116:119], v[204:207], v[108:111]
  s_waitcnt lgkmcnt(2)
  v_mfma_f32_16x16x32_bf16 v[64:67], a[120:123], v[160:163], v[64:67]
  ds_read_b128 v[192:195], v19 offset:0
  v_mfma_f32_16x16x32_bf16 v[68:71], a[124:127], v[160:163], v[68:71]
  v_add_u32 v18, s33, v14
  v_mfma_f32_16x16x32_bf16 v[72:75], a[128:131], v[160:163], v[72:75]
  v_mfma_f32_16x16x32_bf16 v[76:79], a[120:123], v[164:167], v[76:79]
  ds_read_b128 v[196:199], v19 offset:2048
  v_mfma_f32_16x16x32_bf16 v[80:83], a[124:127], v[164:167], v[80:83]
  buffer_load_dwordx4 v11, s[8:11], s30 offen offset:1024 lds
  v_mfma_f32_16x16x32_bf16 v[84:87], a[128:131], v[164:167], v[84:87]
  s_waitcnt lgkmcnt(2)
  s_add_u32 s30, s30, 128
  v_mfma_f32_16x16x32_bf16 v[88:91], a[120:123], v[168:171], v[88:91]
  ds_read_b128 v[200:203], v19 offset:4096
  s_add_u32 m0, m0, 8192
  v_mfma_f32_16x16x32_bf16 v[92:95], a[124:127], v[168:171], v[92:95]
  s_cmp_lt_u32 m0, s46
  s_cselect_b32 m0, m0, s47
  v_mfma_f32_16x16x32_bf16 v[96:99], a[128:131], v[168:171], v[96:99]
  v_mfma_f32_16x16x32_bf16 v[100:103], a[120:123], v[172:175], v[100:103]
  ds_read_b128 v[204:207], v19 offset:6144
  v_mfma_f32_16x16x32_bf16 v[104:107], a[124:127], v[172:175], v[104:107]
  v_mfma_f32_16x16x32_bf16 v[108:111], a[128:131], v[172:175], v[108:111]
  s_waitcnt vmcnt(8) lgkmcnt(2)
  s_barrier
  v_mfma_f32_16x16x32_bf16 v[64:67], a[132:135], v[192:195], v[64:67]
  ds_read_b128 v[160:163], v18 offset:0
  v_mfma_f32_16x16x32_bf16 v[68:71], a[136:139], v[192:195], v[68:71]
  v_mfma_f32_16x16x32_bf16 v[72:75], a[140:143], v[192:195], v[72:75]
  v_add_u32 v19, s33, v15
  s_add_u32 s33, s33, 8192
  v_mfma_f32_16x16x32_bf16 v[76:79], a[132:135], v[196:199], v[76:79]
  ds_read_b128 v[164:167], v18 offset:2048
  v_mfma_f32_16x16x32_bf16 v[80:83], a[136:139], v[196:199], v[80:83]
  buffer_load_dwordx4 v10, s[8:11], s30 offen offset:0 lds
  v_mfma_f32_16x16x32_bf16 v[84:87], a[140:143], v[196:199], v[84:87]
  s_waitcnt lgkmcnt(2)
  v_mfma_f32_16x16x32_bf16 v[88:91], a[132:135], v[200:203], v[88:91]
  ds_read_b128 v[168:171], v18 offset:4096
  v_mfma_f32_16x16x32_bf16 v[92:95], a[136:139], v[200:203], v[92:95]
  s_cmp_lt_u32 s33, 155648
  s_cselect_b32 s33, s33, 98304
  v_mfma_f32_16x16x32_bf16 v[96:99], a[140:143], v[200:203], v[96:99]
  v_mfma_f32_16x16x32_bf16 v[100:103], a[132:135], v[204:207], v[100:103]
  ds_read_b128 v[172:175], v18 offset:6144
  v_mfma_f32_16x16x32_bf16 v[104:107], a[136:139], v[204:207], v[104:107]
  v_mfma_f32_16x16x32_bf16 v[108:111], a[140:143], v[204:207], v[108:111]
  s_waitcnt lgkmcnt(2)
  v_mfma_f32_16x16x32_bf16 v[64:67], a[144:147], v[160:163], v[64:67]
  ds_read_b128 v[192:195], v19 offset:0
  v_mfma_f32_16x16x32_bf16 v[68:71], a[148:151], v[160:163], v[68:71]
  v_add_u32 v18, s33, v14
  v_mfma_f32_16x16x32_bf16 v[72:75], a[152:155], v[160:163], v[72:75]
  v_mfma_f32_16x16x32_bf16 v[76:79], a[144:147], v[164:167], v[76:79]
  ds_read_b128 v[196:199], v19 offset:2048
  v_mfma_f32_16x16x32_bf16 v[80:83], a[148:151], v[164:167], v[80:83]
  buffer_load_dwordx4 v11, s[8:11], s30 offen offset:1024 lds
  v_mfma_f32_16x16x32_bf16 v[84:87], a[152:155], v[164:167], v[84:87]
  s_waitcnt lgkmcnt(2)
  s_add_u32 s30, s30, 128
  v_mfma_f32_16x16x32_bf16 v[88:91], a[144:147], v[168:171], v[88:91]
  ds_read_b128 v[200:203], v19 offset:4096
  s_add_u32 m0, m0, 8192
  v_mfma_f32_16x16x32_bf16 v[92:95], a[148:151], v[168:171], v[92:95]
  s_cmp_lt_u32 m0, s46
  s_cselect_b32 m0, m0, s47
  v_mfma_f32_16x16x32_bf16 v[96:99], a[152:155], v[168:171], v[96:99]
  v_mfma_f32_16x16x32_bf16 v[100:103], a[144:147], v[172:175], v[100:103]
  ds_read_b128 v[204:207], v19 offset:6144
  v_mfma_f32_16x16x32_bf16 v[104:107], a[148:151], v[172:175], v[104:107]
  v_mfma_f32_16x16x32_bf16 v[108:111], a[152:155], v[172:175], v[108:111]
  s_waitcnt vmcnt(8) lgkmcnt(2)
  s_barrier
  v_mfma_f32_16x16x32_bf16 v[64:67], a[156:159], v[192:195], v[64:67]
  ds_read_b128 v[160:163], v18 offset:0
  v_mfma_f32_16x16x32_bf16 v[68:71], a[160:163], v[192:195], v[68:71]
  v_mfma_f32_16x16x32_bf16 v[72:75], a[164:167], v[192:195], v[72:75]
  v_add_u32 v19, s33, v15
  s_add_u32 s33, s33, 8192
  v_mfma_f32_16x16x32_bf16 v[76:79], a[156:159], v[196:199], v[76:79]
  ds_read_b128 v[164:167], v18 offset:2048
  v_mfma_f32_16x16x32_bf16 v[80:83], a[160:163], v[196:199], v[80:83]
  buffer_load_dwordx4 v10, s[8:11], s30 offen offset:0 lds
  v_mfma_f32_16x16x32_bf16 v[84:87], a[164:167], v[196:199], v[84:87]
  s_waitcnt lgkmcnt(2)
  v_mfma_f32_16x16x32_bf16 v[88:91], a[156:159], v[200:203], v[88:91]
  ds_read_b128 v[168:171], v18 offset:4096
  v_mfma_f32_16x16x32_bf16 v[92:95], a[160:163], v[200:203], v[92:95]
  s_cmp_lt_u32 s33, 155648
  s_cselect_b32 s33, s33, 98304
  v_mfma_f32_16x16x32_bf16 v[96:99], a[164:167], v[200:203], v[96:99]
  v_mfma_f32_16x16x32_bf16 v[100:103], a[156:159], v[204:207], v[100:103]
  ds_read_b128 v[172:175], v18 offset:6144
  v_mfma_f32_16x16x32_bf16 v[104:107], a[160:163], v[204:207], v[104:107]
  v_mfma_f32_16x16x32_bf16 v[108:111], a[164:167], v[204:207], v[108:111]
  s_waitcnt lgkmcnt(2)
  v_mfma_f32_16x16x32_bf16 v[64:67], a[168:171], v[160:163], v[64:67]
  ds_read_b128 v[192:195], v19 offset:0
  v_mfma_f32_16x16x32_bf16 v[68:71], a[172:175], v[160:163], v[68:71]
  v_add_u32 v18, s33, v14
  v_mfma_f32_16x16x32_bf16 v[72:75], a[176:179], v[160:163], v[72:75]
  v_mfma_f32_16x16x32_bf16 v[76:79], a[168:171], v[164:167], v[76:79]
  ds_read_b128 v[196:199], v19 offset:2048
  v_mfma_f32_16x16x32_bf16 v[80:83], a[172:175], v[164:167], v[80:83]
  buffer_load_dwordx4 v11, s[8:11], s30 offen offset:1024 lds
  v_mfma_f32_16x16x32_bf16 v[84:87], a[176:179], v[164:167], v[84:87]
  s_waitcnt lgkmcnt(2)
  s_add_u32 s30, s30, 128
  v_mfma_f32_16x16x32_bf16 v[88:91], a[168:171], v[168:171], v[88:91]
  ds_read_b128 v[200:203], v19 offset:4096
  s_add_u32 m0, m0, 8192
  v_mfma_f32_16x16x32_bf16 v[92:95], a[172:175], v[168:171], v[92:95]
  s_cmp_lt_u32 m0, s46
  s_cselect_b32 m0, m0, s47
  v_mfma_f32_16x16x32_bf16 v[96:99], a[176:179], v[168:171], v[96:99]
  v_mfma_f32_16x16x32_bf16 v[100:103], a[168:171], v[172:175], v[100:103]
  ds_read_b128 v[204:207], v19 offset:6144
  v_mfma_f32_16x16x32_bf16 v[104:107], a[172:175], v[172:175], v[104:107]
  v_mfma_f32_16x16x32_bf16 v[108:111], a[176:179], v[172:175], v[108:111]
  s_waitcnt vmcnt(8) lgkmcnt(2)
  s_barrier
  v_mfma_f32_16x16x32_bf16 v[64:67], a[180:183], v[192:195], v[64:67]
  ds_read_b128 v[160:163], v18 offset:0
  v_mfma_f32_16x16x32_bf16 v[68:71], a[184:187], v[192:195], v[68:71]
  v_mfma_f32_16x16x32_bf16 v[72:75], a[188:191], v[192:195], v[72:75]
  v_add_u32 v19, s33, v15
  s_add_u32 s33, s33, 8192
  v_mfma_f32_16x16x32_bf16 v[76:79], a[180:183], v[196:199], v[76:79]
  ds_read_b128 v[164:167], v18 offset:2048
  v_mfma_f32_16x16x32_bf16 v[80:83], a[184:187], v[196:199], v[80:83]
  buffer_load_dwordx4 v10, s[8:11], s30 offen offset:0 lds
  v_mfma_f32_16x16x32_bf16 v[84:87], a[188:191], v[196:199], v[84:87]
  s_waitcnt lgkmcnt(2)
  v_mfma_f32_16x16x32_bf16 v[88:91], a[180:183], v[200:203], v[88:91]
  ds_read_b128 v[168:171], v18 offset:4096
  v_mfma_f32_16x16x32_bf16 v[92:95], a[184:187], v[200:203], v[92:95]
  s_cmp_lt_u32 s33, 155648
  s_cselect_b32 s33, s33, 98304
  v_mfma_f32_16x16x32_bf16 v[96:99], a[188:191], v[200:203], v[96:99]
  v_mfma_f32_16x16x32_bf16 v[100:103], a[180:183], v[204:207], v[100:103]
  ds_read_b128 v[172:175], v18 offset:6144
  v_mfma_f32_16x16x32_bf16 v[104:107], a[184:187], v[204:207], v[104:107]
  v_mfma_f32_16x16x32_bf16 v[108:111], a[188:191], v[204:207], v[108:111]
  s_waitcnt lgkmcnt(2)
  v_mfma_f32_16x16x32_bf16 v[64:67], a[192:195], v[160:163], v[64:67]
  ds_read_b128 v[192:195], v19 offset:0
  v_mfma_f32_16x16x32_bf16 v[68:71], a[196:199], v[160:163], v[68:71]
  v_add_u32 v18, s33, v14
  v_mfma_f32_16x16x32_bf16 v[72:75], a[200:203], v[160:163], v[72:75]
  v_mfma_f32_16x16x32_bf16 v[76:79], a[192:195], v[164:167], v[76:79]
  ds_read_b128 v[196:199], v19 offset:2048
  v_mfma_f32_16x16x32_bf16 v[80:83], a[196:199], v[164:167], v[80:83]
  buffer_load_dwordx4 v11, s[8:11], s30 offen offset:1024 lds
  v_mfma_f32_16x16x32_bf16 v[84:87], a[200:203], v[164:167], v[84:87]
  s_waitcnt lgkmcnt(2)
  s_add_u32 s30, s30, 128
  v_mfma_f32_16x16x32_bf16 v[88:91], a[192:195], v[168:171], v[88:91]
  ds_read_b128 v[200:203], v19 offset:4096
  s_add_u32 m0, m0, 8192
  v_mfma_f32_16x16x32_bf16 v[92:95], a[196:199], v[168:171], v[92:95]
  s_cmp_lt_u32 m0, s46
  s_cselect_b32 m0, m0, s47
  v_mfma_f32_16x16x32_bf16 v[96:99], a[200:203], v[168:171], v[96:99]
  v_mfma_f32_16x16x32_bf16 v[100:103], a[192:195], v[172:175], v[100:103]
  ds_read_b128 v[204:207], v19 offset:6144
  v_mfma_f32_16x16x32_bf16 v[104:107], a[196:199], v[172:175], v[104:107]
  v_mfma_f32_16x16x32_bf16 v[108:111], a[200:203], v[172:175], v[108:111]
  s_waitcnt vmcnt(8) lgkmcnt(2)
  s_barrier
  v_mfma_f32_16x16x32_bf16 v[64:67], a[204:207], v[192:195], v[64:67]
  ds_read_b128 v[160:163], v18 offset:0
  v_mfma_f32_16x16x32_bf16 v[68:71], a[208:211], v[192:195], v[68:71]
  v_mfma_f32_16x16x32_bf16 v[72:75], a[212:215], v[192:195], v[72:75]
  v_add_u32 v19, s33, v15
  s_add_u32 s33, s33, 8192
  v_mfma_f32_16x16x32_bf16 v[76:79], a[204:207], v[196:199], v[76:79]
  ds_read_b128 v[164:167], v18 offset:2048
  v_mfma_f32_16x16x32_bf16 v[80:83], a[208:211], v[196:199], v[80:83]
  buffer_load_dwordx4 v10, s[8:11], s30 offen offset:0 lds
  v_mfma_f32_16x16x32_bf16 v[84:87], a[212:215], v[196:199], v[84:87]
  s_waitcnt lgkmcnt(2)
  v_mfma_f32_16x16x32_bf16 v[88:91], a[204:207], v[200:203], v[88:91]
  ds_read_b128 v[168:171], v18 offset:4096
  v_mfma_f32_16x16x32_bf16 v[92:95], a[208:211], v[200:203], v[92:95]
  s_cmp_lt_u32 s33, 155648
  s_cselect_b32 s33, s33, 98304
  v_mfma_f32_16x16x32_bf16 v[96:99], a[212:215], v[200:203], v[96:99]
  v_mfma_f32_16x16x32_bf16 v[100:103], a[204:207], v[204:207], v[100:103]
  ds_read_b128 v[172:175], v18 offset:6144
  v_mfma_f32_16x16x32_bf16 v[104:107], a[208:211], v[204:207], v[104:107]
  v_mfma_f32_16x16x32_bf16 v[108:111], a[212:215], v[204:207], v[108:111]
  s_waitcnt lgkmcnt(2)
  v_mfma_f32_16x16x32_bf16 v[64:67], a[216:219], v[160:163], v[64:67]
  ds_read_b128 v[192:195], v19 offset:0
  v_mfma_f32_16x16x32_bf16 v[68:71], a[220:223], v[160:163], v[68:71]
  v_add_u32 v18, s33, v14
  v_mfma_f32_16x16x32_bf16 v[72:75], a[224:227], v[160:163], v[72:75]
  v_mfma_f32_16x16x32_bf16 v[76:79], a[216:219], v[164:167], v[76:79]
  ds_read_b128 v[196:199], v19 offset:2048
  v_mfma_f32_16x16x32_bf16 v[80:83], a[220:223], v[164:167], v[80:83]
  buffer_load_dwordx4 v11, s[8:11], s30 offen offset:1024 lds
  v_mfma_f32_16x16x32_bf16 v[84:87], a[224:227], v[164:167], v[84:87]
  s_waitcnt lgkmcnt(2)
  s_add_u32 s30, s30, 128
  v_mfma_f32_16x16x32_bf16 v[88:91], a[216:219], v[168:171], v[88:91]
  ds_read_b128 v[200:203], v19 offset:4096
  s_add_u32 m0, m0, 8192
  v_mfma_f32_16x16x32_bf16 v[92:95], a[220:223], v[168:171], v[92:95]
  s_cmp_lt_u32 m0, s46
  s_cselect_b32 m0, m0, s47
  v_mfma_f32_16x16x32_bf16 v[96:99], a[224:227], v[168:171], v[96:99]
  v_mfma_f32_16x16x32_bf16 v[100:103], a[216:219], v[172:175], v[100:103]
  ds_read_b128 v[204:207], v19 offset:6144
  v_mfma_f32_16x16x32_bf16 v[104:107], a[220:223], v[172:175], v[104:107]
  v_mfma_f32_16x16x32_bf16 v[108:111], a[224:227], v[172:175], v[108:111]
  s_waitcnt vmcnt(8) lgkmcnt(2)
  s_barrier
  v_mfma_f32_16x16x32_bf16 v[64:67], a[228:231], v[192:195], v[64:67]
  ds_read_b128 v[160:163], v18 offset:0
  v_mfma_f32_16x16x32_bf16 v[68:71], a[232:235], v[192:195], v[68:71]
  v_mfma_f32_16x16x32_bf16 v[72:75], a[236:239], v[192:195], v[72:75]
  v_add_u32 v19, s33, v15
  s_add_u32 s33, s33, 8192
  v_mfma_f32_16x16x32_bf16 v[76:79], a[228:231], v[196:199], v[76:79]
  ds_read_b128 v[164:167], v18 offset:2048
  v_cvt_pk_bf16_f32 v224, v64, v65
  v_cvt_pk_bf16_f32 v225, v66, v67
  v_mfma_f32_16x16x32_bf16 v[80:83], a[232:235], v[196:199], v[80:83]
  buffer_load_dwordx4 v10, s[8:11], s30 offen offset:0 lds
  v_cvt_pk_bf16_f32 v226, v68, v69
  v_cvt_pk_bf16_f32 v227, v70, v71
  v_mfma_f32_16x16x32_bf16 v[84:87], a[236:239], v[196:199], v[84:87]
  s_waitcnt lgkmcnt(2)
  v_cvt_pk_bf16_f32 v228, v72, v73
  v_cvt_pk_bf16_f32 v229, v74, v75
  v_mfma_f32_16x16x32_bf16 v[88:91], a[228:231], v[200:203], v[88:91]
  ds_read_b128 v[168:171], v18 offset:4096
  ds_write_b64 v22, v[224:225] offset:0
  v_mfma_f32_16x16x32_bf16 v[92:95], a[232:235], v[200:203], v[92:95]
  s_cmp_lt_u32 s33, 155648
  s_cselect_b32 s33, s33, 98304
  ds_write_b64 v22, v[226:227] offset:8
  v_mfma_f32_16x16x32_bf16 v[96:99], a[236:239], v[200:203], v[96:99]
  ds_write_b64 v16, v[228:229] offset:64
  v_cvt_pk_bf16_f32 v230, v76, v77
  v_cvt_pk_bf16_f32 v231, v78, v79
  v_mfma_f32_16x16x32_bf16 v[100:103], a[228:231], v[204:207], v[100:103]
  ds_read_b128 v[172:175], v18 offset:6144
  v_cvt_pk_bf16_f32 v232, v80, v81
  v_cvt_pk_bf16_f32 v233, v82, v83
  v_cvt_pk_bf16_f32 v234, v84, v85
  v_mfma_f32_16x16x32_bf16 v[104:107], a[232:235], v[204:207], v[104:107]
  v_cvt_pk_bf16_f32 v235, v86, v87
  ds_write_b64 v22, v[230:231] offset:6400
  v_mfma_f32_16x16x32_bf16 v[108:111], a[236:239], v[204:207], v[108:111]
  ds_write_b64 v22, v[232:233] offset:6408
  ds_write_b64 v16, v[234:235] offset:6464
kvm_end_158:
  v_cvt_pk_bf16_f32 v236, v88, v89
  v_cvt_pk_bf16_f32 v237, v90, v91
  v_cvt_pk_bf16_f32 v238, v92, v93
  v_cvt_pk_bf16_f32 v239, v94, v95
  v_cvt_pk_bf16_f32 v240, v96, v97
  v_cvt_pk_bf16_f32 v241, v98, v99
  ds_write_b64 v22, v[236:237] offset:12800
  ds_write_b64 v22, v[238:239] offset:12808
  ds_write_b64 v16, v[240:241] offset:12864
  v_cvt_pk_bf16_f32 v242, v100, v101
  v_cvt_pk_bf16_f32 v243, v102, v103
  v_cvt_pk_bf16_f32 v244, v104, v105
  v_cvt_pk_bf16_f32 v245, v106, v107
  v_cvt_pk_bf16_f32 v246, v108, v109
  v_cvt_pk_bf16_f32 v247, v110, v111
  ds_write_b64 v22, v[242:243] offset:19200
  ds_write_b64 v22, v[244:245] offset:19208
  ds_write_b64 v16, v[246:247] offset:19264
  s_waitcnt lgkmcnt(0)
  s_barrier
  ds_read_b128 v[224:227], v23 offset:0
  ds_read_b128 v[228:231], v23 offset:64
  ds_read_b128 v[232:235], v23 offset:128
  ds_read_b128 v[236:239], v23 offset:192
  ds_read_b128 v[240:243], v23 offset:256
  ds_read_b128 v[244:247], v23 offset:320
  s_waitcnt lgkmcnt(0)
  s_add_u32 s21, s48, 0
  buffer_store_dwordx4 v[224:227], v26, s[16:19], s21 offen offset:0 sc1
  buffer_store_dwordx4 v[228:231], v26, s[16:19], s21 offen offset:1024 sc1
  buffer_store_dwordx4 v[232:235], v26, s[16:19], s21 offen offset:2048 sc1
  buffer_store_dwordx4 v[236:239], v26, s[16:19], s21 offen offset:3072 sc1
  s_add_u32 s21, s48, 4096
  buffer_store_dwordx4 v[240:243], v26, s[16:19], s21 offen offset:0 sc1
  buffer_store_dwordx4 v[244:247], v26, s[16:19], s21 offen offset:1024 sc1
  s_nop 1
  s_cmp_gt_u32 s26, 0
  s_cbranch_scc1 kvm_blk_157
  s_waitcnt vmcnt(6)
  s_barrier
  s_mov_b32 s24, 491520
  s_mov_b32 s25, 163840
  v_lshrrev_b32 v11, 3, v1
  v_and_b32 v12, 7, v1
  v_xor_b32 v12, v12, v11
  v_mul_u32_u24 v11, 1280, v11
  v_lshl_add_u32 v10, v12, 4, v11
  s_mul_i32 s46, s20, 40960
  v_add_u32 v10, s46, v10
  s_lshl_b32 s47, s20, 12
  s_add_u32 s47, s47, 0
  s_add_u32 s46, s47, 98304
  s_mov_b32 s30, s24
  s_add_u32 s32, s47, 32768
  v_add_u32 v11, 9216, v10
  v_add_u32 v12, 18432, v10
  v_add_u32 v13, 27648, v10
  s_mov_b32 m0, s32
  s_nop 0
  buffer_load_dwordx4 v10, s[8:11], s30 offen offset:0 lds
  buffer_load_dwordx4 v11, s[8:11], s30 offen offset:1024 lds
  buffer_load_dwordx4 v12, s[8:11], s30 offen offset:2048 lds
  buffer_load_dwordx4 v13, s[8:11], s30 offen offset:3072 lds
  s_add_u32 s30, s30, 128
  s_add_u32 s32, s32, 16384
  s_cmp_lt_u32 s32, s46
  s_cselect_b32 s32, s32, s47
  s_mov_b32 m0, s32
  s_nop 0
  buffer_load_dwordx4 v10, s[8:11], s30 offen offset:0 lds
  buffer_load_dwordx4 v11, s[8:11], s30 offen offset:1024 lds
  buffer_load_dwordx4 v12, s[8:11], s30 offen offset:2048 lds
  buffer_load_dwordx4 v13, s[8:11], s30 offen offset:3072 lds
  s_add_u32 s30, s30, 128
  s_add_u32 s32, s32, 16384
  s_cmp_lt_u32 s32, s46
  s_cselect_b32 s32, s32, s47
  s_mov_b32 m0, s32
  s_nop 0
  buffer_load_dwordx4 v10, s[8:11], s30 offen offset:0 lds
  buffer_load_dwordx4 v11, s[8:11], s30 offen offset:1024 lds
  buffer_load_dwordx4 v12, s[8:11], s30 offen offset:2048 lds
  buffer_load_dwordx4 v13, s[8:11], s30 offen offset:3072 lds
  s_add_u32 s30, s30, 128
  s_add_u32 s32, s32, 16384
  s_cmp_lt_u32 s32, s46
  s_cselect_b32 s32, s32, s47
  s_mov_b32 m0, s32
  s_nop 0
  buffer_load_dwordx4 v10, s[8:11], s30 offen offset:0 lds
  buffer_load_dwordx4 v11, s[8:11], s30 offen offset:1024 lds
  buffer_load_dwordx4 v12, s[8:11], s30 offen offset:2048 lds
  buffer_load_dwordx4 v13, s[8:11], s30 offen offset:3072 lds
  s_add_u32 s30, s30, 128
  s_add_u32 s32, s32, 16384
  s_cmp_lt_u32 s32, s46
  s_cselect_b32 s32, s32, s47
  s_waitcnt vmcnt(16)
  s_barrier
  s_cmp_lg_u32 s20, 0
  s_cbranch_scc1 af_162
  v_mov_b32 v4, 0
  v_mov_b32 v5, 1
  s_mov_b64 exec, 1
  buffer_atomic_add v5, v4, s[72:75], s61 offen sc1
  s_mov_b64 exec, -1
  s_nop 1
af_162:
  s_mov_b32 s26, 13
  s_mov_b32 s28, 1572864
kv_main:
  v_and_b32 v6, 7, v2
  v_add_u32 v4, 0, v3
  v_xor_b32 v4, v4, v6
  v_lshlrev_b32 v4, 4, v4
  v_lshl_add_u32 v14, v2, 7, v4
  v_add_u32 v4, 4, v3
  v_xor_b32 v4, v4, v6
  v_lshlrev_b32 v4, 4, v4
  v_lshl_add_u32 v15, v2, 7, v4
  v_mul_u32_u24 v22, 400, v2
  v_mul_u32_u24 v4, 16, v3
  s_mul_i32 s21, s20, 96
  s_add_u32 s21, s21, 98304
  v_add3_u32 v22, v22, v4, s21
  v_lshlrev_b32 v4, 3, v3
  v_sub_u32 v16, v22, v4
  v_mov_b32 v9, 2731
  s_mul_i32 s21, s20, 12800
  s_add_u32 s21, s21, 98304
  v_mul_u32_u24 v4, 400, v2
  v_lshlrev_b32 v5, 4, v3
  v_add3_u32 v23, v4, v5, s21
  v_lshlrev_b32 v26, 4, v1
  s_mov_b32 s33, 32768
  s_mov_b32 s48, 0x80000000
  s_mov_b32 m0, s32
  s_nop 0
  buffer_load_dwordx4 v10, s[8:11], s30 offen offset:0 lds
  buffer_load_dwordx4 v11, s[8:11], s30 offen offset:1024 lds
  s_waitcnt vmcnt(14)
  s_barrier
  v_add_u32 v18, s33, v14
  v_add_u32 v19, s33, v15
  s_add_u32 s33, s33, 16384
  s_cmp_lt_u32 s33, 98304
  s_cselect_b32 s33, s33, 0
  ds_read_b128 v[160:163], v18 offset:0
  ds_read_b128 v[164:167], v18 offset:2048
  ds_read_b128 v[168:171], v18 offset:4096
  ds_read_b128 v[172:175], v18 offset:6144
  ds_read_b128 v[176:179], v18 offset:8192
  ds_read_b128 v[180:183], v18 offset:10240
  ds_read_b128 v[184:187], v18 offset:12288
  ds_read_b128 v[188:191], v18 offset:14336
  s_waitcnt lgkmcnt(0)
kv_blk_165:
  v_mfma_f32_16x16x32_bf16 v[64:67], a[0:3], v[160:163], 0
  ds_read_b128 v[192:195], v19 offset:0
  v_mfma_f32_16x16x32_bf16 v[68:71], a[4:7], v[160:163], 0
  v_add_u32 v18, s33, v14
  v_mfma_f32_16x16x32_bf16 v[72:75], a[8:11], v[160:163], 0
  ds_write_b64 v16, v[234:235] offset:6464
  v_mfma_f32_16x16x32_bf16 v[76:79], a[0:3], v[164:167], 0
  ds_read_b128 v[196:199], v19 offset:2048
  v_cvt_pk_bf16_f32 v236, v88, v89
  v_mfma_f32_16x16x32_bf16 v[80:83], a[4:7], v[164:167], 0
  buffer_load_dwordx4 v12, s[8:11], s30 offen offset:2048 lds
  v_mfma_f32_16x16x32_bf16 v[84:87], a[8:11], v[164:167], 0
  v_cvt_pk_bf16_f32 v237, v90, v91
  v_cvt_pk_bf16_f32 v238, v92, v93
  v_mfma_f32_16x16x32_bf16 v[88:91], a[0:3], v[168:171], 0
  ds_read_b128 v[200:203], v19 offset:4096
  v_cvt_pk_bf16_f32 v239, v94, v95
  v_mfma_f32_16x16x32_bf16 v[92:95], a[4:7], v[168:171], 0
  v_cvt_pk_bf16_f32 v240, v96, v97
  v_cvt_pk_bf16_f32 v241, v98, v99
  v_mfma_f32_16x16x32_bf16 v[96:99], a[8:11], v[168:171], 0
  ds_write_b64 v22, v[236:237] offset:12800
  ds_write_b64 v22, v[238:239] offset:12808
  ds_write_b64 v16, v[240:241] offset:12864
  v_cvt_pk_bf16_f32 v242, v100, v101
  v_cvt_pk_bf16_f32 v243, v102, v103
  v_mfma_f32_16x16x32_bf16 v[100:103], a[0:3], v[172:175], 0
  ds_read_b128 v[204:207], v19 offset:6144
  v_cvt_pk_bf16_f32 v244, v104, v105
  v_cvt_pk_bf16_f32 v245, v106, v107
  v_mfma_f32_16x16x32_bf16 v[104:107], a[4:7], v[172:175], 0
  v_cvt_pk_bf16_f32 v246, v108, v109
  v_cvt_pk_bf16_f32 v247, v110, v111
  v_mfma_f32_16x16x32_bf16 v[108:111], a[8:11], v[172:175], 0
  s_waitcnt lgkmcnt(9)
  ds_write_b64 v22, v[242:243] offset:19200
  ds_write_b64 v22, v[244:245] offset:19208
  ds_write_b64 v16, v[246:247] offset:19264
  v_cvt_pk_bf16_f32 v224, v112, v113
  v_cvt_pk_bf16_f32 v225, v114, v115
  v_mfma_f32_16x16x32_bf16 v[112:115], a[0:3], v[176:179], 0
  ds_read_b128 v[208:211], v19 offset:8192
  v_cvt_pk_bf16_f32 v226, v116, v117
  v_cvt_pk_bf16_f32 v227, v118, v119
  v_mfma_f32_16x16x32_bf16 v[116:119], a[4:7], v[176:179], 0
  v_cvt_pk_bf16_f32 v228, v120, v121
  v_cvt_pk_bf16_f32 v229, v122, v123
  v_mfma_f32_16x16x32_bf16 v[120:123], a[8:11], v[176:179], 0
  ds_write_b64 v22, v[224:225] offset:25600
  ds_write_b64 v22, v[226:227] offset:25608
  ds_write_b64 v16, v[228:229] offset:25664
  v_cvt_pk_bf16_f32 v230, v124, v125
  v_cvt_pk_bf16_f32 v231, v126, v127
  v_mfma_f32_16x16x32_bf16 v[124:127], a[0:3], v[180:183], 0
  ds_read_b128 v[212:215], v19 offset:10240
  v_cvt_pk_bf16_f32 v232, v128, v129
  v_cvt_pk_bf16_f32 v233, v130, v131
  v_mfma_f32_16x16x32_bf16 v[128:131], a[4:7], v[180:183], 0
  buffer_load_dwordx4 v13, s[8:11], s30 offen offset:3072 lds
  v_cvt_pk_bf16_f32 v234, v132, v133
  v_cvt_pk_bf16_f32 v235, v134, v135
  v_mfma_f32_16x16x32_bf16 v[132:135], a[8:11], v[180:183], 0
  s_add_u32 s30, s30, 128
  s_add_u32 m0, m0, 16384
  ds_write_b64 v22, v[230:231] offset:32000
  ds_write_b64 v22, v[232:233] offset:32008
  ds_write_b64 v16, v[234:235] offset:32064
  v_cvt_pk_bf16_f32 v236, v136, v137
  v_cvt_pk_bf16_f32 v237, v138, v139
  v_mfma_f32_16x16x32_bf16 v[136:139], a[0:3], v[184:187], 0
  ds_read_b128 v[216:219], v19 offset:12288
  v_cvt_pk_bf16_f32 v238, v140, v141
  v_cvt_pk_bf16_f32 v239, v142, v143
  v_mfma_f32_16x16x32_bf16 v[140:143], a[4:7], v[184:187], 0
  s_cmp_lt_u32 m0, s46
  s_cselect_b32 m0, m0, s47
  v_cvt_pk_bf16_f32 v240, v144, v145
  v_cvt_pk_bf16_f32 v241, v146, v147
  v_mfma_f32_16x16x32_bf16 v[144:147], a[8:11], v[184:187], 0
  ds_write_b64 v22, v[236:237] offset:38400
  ds_write_b64 v22, v[238:239] offset:38408
  ds_write_b64 v16, v[240:241] offset:38464
  v_cvt_pk_bf16_f32 v242, v148, v149
  v_cvt_pk_bf16_f32 v243, v150, v151
  v_mfma_f32_16x16x32_bf16 v[148:151], a[0:3], v[188:191], 0
  ds_read_b128 v[220:223], v19 offset:14336
  v_cvt_pk_bf16_f32 v244, v152, v153
  v_cvt_pk_bf16_f32 v245, v154, v155
  v_mfma_f32_16x16x32_bf16 v[152:155], a[4:7], v[188:191], 0
  v_cvt_pk_bf16_f32 v246, v156, v157
  v_cvt_pk_bf16_f32 v247, v158, v159
  v_mfma_f32_16x16x32_bf16 v[156:159], a[8:11], v[188:191], 0
  s_waitcnt vmcnt(12) lgkmcnt(15)
  s_barrier
  v_mfma_f32_16x16x32_bf16 v[64:67], a[12:15], v[192:195], v[64:67]
  ds_read_b128 v[160:163], v18 offset:0
  v_mfma_f32_16x16x32_bf16 v[68:71], a[16:19], v[192:195], v[68:71]
  ds_write_b64 v22, v[242:243] offset:44800
  v_mfma_f32_16x16x32_bf16 v[72:75], a[20:23], v[192:195], v[72:75]
  v_add_u32 v19, s33, v15
  s_add_u32 s33, s33, 16384
  v_mfma_f32_16x16x32_bf16 v[76:79], a[12:15], v[196:199], v[76:79]
  ds_read_b128 v[164:167], v18 offset:2048
  v_mfma_f32_16x16x32_bf16 v[80:83], a[16:19], v[196:199], v[80:83]
  buffer_load_dwordx4 v10, s[8:11], s30 offen offset:0 lds
  v_mfma_f32_16x16x32_bf16 v[84:87], a[20:23], v[196:199], v[84:87]
  s_cmp_lt_u32 s33, 98304
  s_cselect_b32 s33, s33, 0
  v_mfma_f32_16x16x32_bf16 v[88:91], a[12:15], v[200:203], v[88:91]
  ds_read_b128 v[168:171], v18 offset:4096
  v_mfma_f32_16x16x32_bf16 v[92:95], a[16:19], v[200:203], v[92:95]
  ds_write_b64 v22, v[244:245] offset:44808
  v_mfma_f32_16x16x32_bf16 v[96:99], a[20:23], v[200:203], v[96:99]
  ds_write_b64 v16, v[246:247] offset:44864
  v_mfma_f32_16x16x32_bf16 v[100:103], a[12:15], v[204:207], v[100:103]
  ds_read_b128 v[172:175], v18 offset:6144
  v_mfma_f32_16x16x32_bf16 v[104:107], a[16:19], v[204:207], v[104:107]
  v_mfma_f32_16x16x32_bf16 v[108:111], a[20:23], v[204:207], v[108:111]
  s_waitcnt lgkmcnt(7)
  v_mfma_f32_16x16x32_bf16 v[112:115], a[12:15], v[208:211], v[112:115]
  ds_read_b128 v[176:179], v18 offset:8192
  v_mfma_f32_16x16x32_bf16 v[116:119], a[16:19], v[208:211], v[116:119]
  v_mfma_f32_16x16x32_bf16 v[120:123], a[20:23], v[208:211], v[120:123]
  v_mfma_f32_16x16x32_bf16 v[124:127], a[12:15], v[212:215], v[124:127]
  ds_read_b128 v[180:183], v18 offset:10240
  v_mfma_f32_16x16x32_bf16 v[128:131], a[16:19], v[212:215], v[128:131]
  buffer_load_dwordx4 v11, s[8:11], s30 offen offset:1024 lds
  v_mfma_f32_16x16x32_bf16 v[132:135], a[20:23], v[212:215], v[132:135]
  v_mfma_f32_16x16x32_bf16 v[136:139], a[12:15], v[216:219], v[136:139]
  ds_read_b128 v[184:187], v18 offset:12288
  v_mfma_f32_16x16x32_bf16 v[140:143], a[16:19], v[216:219], v[140:143]
  v_mfma_f32_16x16x32_bf16 v[144:147], a[20:23], v[216:219], v[144:147]
  v_mfma_f32_16x16x32_bf16 v[148:151], a[12:15], v[220:223], v[148:151]
  ds_read_b128 v[188:191], v18 offset:14336
  v_mfma_f32_16x16x32_bf16 v[152:155], a[16:19], v[220:223], v[152:155]
  v_mfma_f32_16x16x32_bf16 v[156:159], a[20:23], v[220:223], v[156:159]
  s_waitcnt lgkmcnt(4)
  v_mfma_f32_16x16x32_bf16 v[64:67], a[24:27], v[160:163], v[64:67]
  ds_read_b128 v[192:195], v19 offset:0
  v_mfma_f32_16x16x32_bf16 v[68:71], a[28:31], v[160:163], v[68:71]
  v_add_u32 v18, s33, v14
  v_mfma_f32_16x16x32_bf16 v[72:75], a[32:35], v[160:163], v[72:75]
  v_mfma_f32_16x16x32_bf16 v[76:79], a[24:27], v[164:167], v[76:79]
  ds_read_b128 v[196:199], v19 offset:2048
  v_mfma_f32_16x16x32_bf16 v[80:83], a[28:31], v[164:167], v[80:83]
  buffer_load_dwordx4 v12, s[8:11], s30 offen offset:2048 lds
  v_mfma_f32_16x16x32_bf16 v[84:87], a[32:35], v[164:167], v[84:87]
  v_mfma_f32_16x16x32_bf16 v[88:91], a[24:27], v[168:171], v[88:91]
  ds_read_b128 v[200:203], v19 offset:4096
  v_mfma_f32_16x16x32_bf16 v[92:95], a[28:31], v[168:171], v[92:95]
  v_mfma_f32_16x16x32_bf16 v[96:99], a[32:35], v[168:171], v[96:99]
  v_mfma_f32_16x16x32_bf16 v[100:103], a[24:27], v[172:175], v[100:103]
  ds_read_b128 v[204:207], v19 offset:6144
  v_mfma_f32_16x16x32_bf16 v[104:107], a[28:31], v[172:175], v[104:107]
  v_mfma_f32_16x16x32_bf16 v[108:111], a[32:35], v[172:175], v[108:111]
  s_waitcnt lgkmcnt(4)
  v_mfma_f32_16x16x32_bf16 v[112:115], a[24:27], v[176:179], v[112:115]
  ds_read_b128 v[208:211], v19 offset:8192
  v_mfma_f32_16x16x32_bf16 v[116:119], a[28:31], v[176:179], v[116:119]
  v_mfma_f32_16x16x32_bf16 v[120:123], a[32:35], v[176:179], v[120:123]
  v_mfma_f32_16x16x32_bf16 v[124:127], a[24:27], v[180:183], v[124:127]
  ds_read_b128 v[212:215], v19 offset:10240
  v_mfma_f32_16x16x32_bf16 v[128:131], a[28:31], v[180:183], v[128:131]
  buffer_load_dwordx4 v13, s[8:11], s30 offen offset:3072 lds
  v_mfma_f32_16x16x32_bf16 v[132:135], a[32:35], v[180:183], v[132:135]
  s_add_u32 s30, s30, 128
  s_add_u32 m0, m0, 16384
  v_mfma_f32_16x16x32_bf16 v[136:139], a[24:27], v[184:187], v[136:139]
  ds_read_b128 v[216:219], v19 offset:12288
  v_mfma_f32_16x16x32_bf16 v[140:143], a[28:31], v[184:187], v[140:143]
  s_cmp_lt_u32 m0, s46
  s_cselect_b32 m0, m0, s47
  v_mfma_f32_16x16x32_bf16 v[144:147], a[32:35], v[184:187], v[144:147]
  v_mfma_f32_16x16x32_bf16 v[148:151], a[24:27], v[188:191], v[148:151]
  ds_read_b128 v[220:223], v19 offset:14336
  v_mfma_f32_16x16x32_bf16 v[152:155], a[28:31], v[188:191], v[152:155]
  v_mfma_f32_16x16x32_bf16 v[156:159], a[32:35], v[188:191], v[156:159]
  s_waitcnt vmcnt(12) lgkmcnt(4)
  s_barrier
  v_mfma_f32_16x16x32_bf16 v[64:67], a[36:39], v[192:195], v[64:67]
  ds_read_b128 v[160:163], v18 offset:0
  v_mfma_f32_16x16x32_bf16 v[68:71], a[40:43], v[192:195], v[68:71]
  v_mfma_f32_16x16x32_bf16 v[72:75], a[44:47], v[192:195], v[72:75]
  v_add_u32 v19, s33, v15
  s_add_u32 s33, s33, 16384
  v_mfma_f32_16x16x32_bf16 v[76:79], a[36:39], v[196:199], v[76:79]
  ds_read_b128 v[164:167], v18 offset:2048
  v_mfma_f32_16x16x32_bf16 v[80:83], a[40:43], v[196:199], v[80:83]
  buffer_load_dwordx4 v10, s[8:11], s30 offen offset:0 lds
  v_mfma_f32_16x16x32_bf16 v[84:87], a[44:47], v[196:199], v[84:87]
  s_cmp_lt_u32 s33, 98304
  s_cselect_b32 s33, s33, 0
  v_mfma_f32_16x16x32_bf16 v[88:91], a[36:39], v[200:203], v[88:91]
  ds_read_b128 v[168:171], v18 offset:4096
  v_mfma_f32_16x16x32_bf16 v[92:95], a[40:43], v[200:203], v[92:95]
  ds_read_b128 v[224:227], v23 offset:0
  v_mfma_f32_16x16x32_bf16 v[96:99], a[44:47], v[200:203], v[96:99]
  v_mfma_f32_16x16x32_bf16 v[100:103], a[36:39], v[204:207], v[100:103]
  ds_read_b128 v[172:175], v18 offset:6144
  v_mfma_f32_16x16x32_bf16 v[104:107], a[40:43], v[204:207], v[104:107]
  v_mfma_f32_16x16x32_bf16 v[108:111], a[44:47], v[204:207], v[108:111]
  s_waitcnt lgkmcnt(5)
  v_mfma_f32_16x16x32_bf16 v[112:115], a[36:39], v[208:211], v[112:115]
  ds_read_b128 v[176:179], v18 offset:8192
  v_mfma_f32_16x16x32_bf16 v[116:119], a[40:43], v[208:211], v[116:119]
  v_mfma_f32_16x16x32_bf16 v[120:123], a[44:47], v[208:211], v[120:123]
  v_mfma_f32_16x16x32_bf16 v[124:127], a[36:39], v[212:215], v[124:127]
  ds_read_b128 v[180:183], v18 offset:10240
  v_mfma_f32_16x16x32_bf16 v[128:131], a[40:43], v[212:215], v[128:131]
  buffer_load_dwordx4 v11, s[8:11], s30 offen offset:1024 lds
  v_mfma_f32_16x16x32_bf16 v[132:135], a[44:47], v[212:215], v[132:135]
  v_mfma_f32_16x16x32_bf16 v[136:139], a[36:39], v[216:219], v[136:139]
  ds_read_b128 v[184:187], v18 offset:12288
  v_mfma_f32_16x16x32_bf16 v[140:143], a[40:43], v[216:219], v[140:143]
  ds_read_b128 v[228:231], v23 offset:64
  v_mfma_f32_16x16x32_bf16 v[144:147], a[44:47], v[216:219], v[144:147]
  v_mfma_f32_16x16x32_bf16 v[148:151], a[36:39], v[220:223], v[148:151]
  ds_read_b128 v[188:191], v18 offset:14336
  v_mfma_f32_16x16x32_bf16 v[152:155], a[40:43], v[220:223], v[152:155]
  v_mfma_f32_16x16x32_bf16 v[156:159], a[44:47], v[220:223], v[156:159]
  s_waitcnt lgkmcnt(5)
  v_mfma_f32_16x16x32_bf16 v[64:67], a[48:51], v[160:163], v[64:67]
  ds_read_b128 v[192:195], v19 offset:0
  v_mfma_f32_16x16x32_bf16 v[68:71], a[52:55], v[160:163], v[68:71]
  v_add_u32 v18, s33, v14
  v_mfma_f32_16x16x32_bf16 v[72:75], a[56:59], v[160:163], v[72:75]
  v_mfma_f32_16x16x32_bf16 v[76:79], a[48:51], v[164:167], v[76:79]
  ds_read_b128 v[196:199], v19 offset:2048
  v_mfma_f32_16x16x32_bf16 v[80:83], a[52:55], v[164:167], v[80:83]
  buffer_load_dwordx4 v12, s[8:11], s30 offen offset:2048 lds
  v_mfma_f32_16x16x32_bf16 v[84:87], a[56:59], v[164:167], v[84:87]
  v_mfma_f32_16x16x32_bf16 v[88:91], a[48:51], v[168:171], v[88:91]
  ds_read_b128 v[200:203], v19 offset:4096
  v_mfma_f32_16x16x32_bf16 v[92:95], a[52:55], v[168:171], v[92:95]
  s_add_u32 s21, s48, 0
  ds_read_b128 v[232:235], v23 offset:128
  v_mfma_f32_16x16x32_bf16 v[96:99], a[56:59], v[168:171], v[96:99]
  v_mfma_f32_16x16x32_bf16 v[100:103], a[48:51], v[172:175], v[100:103]
  ds_read_b128 v[204:207], v19 offset:6144
  v_mfma_f32_16x16x32_bf16 v[104:107], a[52:55], v[172:175], v[104:107]
  buffer_store_dwordx4 v[224:227], v26, s[16:19], s21 offen offset:0 sc1
  v_mfma_f32_16x16x32_bf16 v[108:111], a[56:59], v[172:175], v[108:111]
  s_waitcnt lgkmcnt(5)
  v_mfma_f32_16x16x32_bf16 v[112:115], a[48:51], v[176:179], v[112:115]
  ds_read_b128 v[208:211], v19 offset:8192
  v_mfma_f32_16x16x32_bf16 v[116:119], a[52:55], v[176:179], v[116:119]
  v_mfma_f32_16x16x32_bf16 v[120:123], a[56:59], v[176:179], v[120:123]
  v_mfma_f32_16x16x32_bf16 v[124:127], a[48:51], v[180:183], v[124:127]
  ds_read_b128 v[212:215], v19 offset:10240
  v_mfma_f32_16x16x32_bf16 v[128:131], a[52:55], v[180:183], v[128:131]
  buffer_load_dwordx4 v13, s[8:11], s30 offen offset:3072 lds
  v_mfma_f32_16x16x32_bf16 v[132:135], a[56:59], v[180:183], v[132:135]
  s_add_u32 s30, s30, 128
  s_add_u32 m0, m0, 16384
  v_mfma_f32_16x16x32_bf16 v[136:139], a[48:51], v[184:187], v[136:139]
  ds_read_b128 v[216:219], v19 offset:12288
  v_mfma_f32_16x16x32_bf16 v[140:143], a[52:55], v[184:187], v[140:143]
  s_cmp_lt_u32 m0, s46
  s_cselect_b32 m0, m0, s47
  v_mfma_f32_16x16x32_bf16 v[144:147], a[56:59], v[184:187], v[144:147]
  ds_read_b128 v[236:239], v23 offset:192
  v_mfma_f32_16x16x32_bf16 v[148:151], a[48:51], v[188:191], v[148:151]
  ds_read_b128 v[220:223], v19 offset:14336
  v_mfma_f32_16x16x32_bf16 v[152:155], a[52:55], v[188:191], v[152:155]
  buffer_store_dwordx4 v[228:231], v26, s[16:19], s21 offen offset:1024 sc1
  v_mfma_f32_16x16x32_bf16 v[156:159], a[56:59], v[188:191], v[156:159]
  s_waitcnt vmcnt(14) lgkmcnt(5)
  s_barrier
  v_mfma_f32_16x16x32_bf16 v[64:67], a[60:63], v[192:195], v[64:67]
  ds_read_b128 v[160:163], v18 offset:0
  v_mfma_f32_16x16x32_bf16 v[68:71], a[64:67], v[192:195], v[68:71]
  v_mfma_f32_16x16x32_bf16 v[72:75], a[68:71], v[192:195], v[72:75]
  v_add_u32 v19, s33, v15
  s_add_u32 s33, s33, 16384
  v_mfma_f32_16x16x32_bf16 v[76:79], a[60:63], v[196:199], v[76:79]
  ds_read_b128 v[164:167], v18 offset:2048
  v_mfma_f32_16x16x32_bf16 v[80:83], a[64:67], v[196:199], v[80:83]
  buffer_load_dwordx4 v10, s[8:11], s30 offen offset:0 lds
  v_mfma_f32_16x16x32_bf16 v[84:87], a[68:71], v[196:199], v[84:87]
  s_cmp_lt_u32 s33, 98304
  s_cselect_b32 s33, s33, 0
  v_mfma_f32_16x16x32_bf16 v[88:91], a[60:63], v[200:203], v[88:91]
  ds_read_b128 v[168:171], v18 offset:4096
  v_mfma_f32_16x16x32_bf16 v[92:95], a[64:67], v[200:203], v[92:95]
  ds_read_b128 v[240:243], v23 offset:256
  v_mfma_f32_16x16x32_bf16 v[96:99], a[68:71], v[200:203], v[96:99]
  v_mfma_f32_16x16x32_bf16 v[100:103], a[60:63], v[204:207], v[100:103]
  ds_read_b128 v[172:175], v18 offset:6144
  v_mfma_f32_16x16x32_bf16 v[104:107], a[64:67], v[204:207], v[104:107]
  buffer_store_dwordx4 v[232:235], v26, s[16:19], s21 offen offset:2048 sc1
  v_mfma_f32_16x16x32_bf16 v[108:111], a[68:71], v[204:207], v[108:111]
  s_waitcnt lgkmcnt(5)
  v_mfma_f32_16x16x32_bf16 v[112:115], a[60:63], v[208:211], v[112:115]
  ds_read_b128 v[176:179], v18 offset:8192
  v_mfma_f32_16x16x32_bf16 v[116:119], a[64:67], v[208:211], v[116:119]
  v_mfma_f32_16x16x32_bf16 v[120:123], a[68:71], v[208:211], v[120:123]
  v_mfma_f32_16x16x32_bf16 v[124:127], a[60:63], v[212:215], v[124:127]
  ds_read_b128 v[180:183], v18 offset:10240
  v_mfma_f32_16x16x32_bf16 v[128:131], a[64:67], v[212:215], v[128:131]
  buffer_load_dwordx4 v11, s[8:11], s30 offen offset:1024 lds
  v_mfma_f32_16x16x32_bf16 v[132:135], a[68:71], v[212:215], v[132:135]
  v_mfma_f32_16x16x32_bf16 v[136:139], a[60:63], v[216:219], v[136:139]
  ds_read_b128 v[184:187], v18 offset:12288
  v_mfma_f32_16x16x32_bf16 v[140:143], a[64:67], v[216:219], v[140:143]
  ds_read_b128 v[244:247], v23 offset:320
  v_mfma_f32_16x16x32_bf16 v[144:147], a[68:71], v[216:219], v[144:147]
  v_mfma_f32_16x16x32_bf16 v[148:151], a[60:63], v[220:223], v[148:151]
  ds_read_b128 v[188:191], v18 offset:14336
  v_mfma_f32_16x16x32_bf16 v[152:155], a[64:67], v[220:223], v[152:155]
  buffer_store_dwordx4 v[236:239], v26, s[16:19], s21 offen offset:3072 sc1
  v_mfma_f32_16x16x32_bf16 v[156:159], a[68:71], v[220:223], v[156:159]
  s_waitcnt lgkmcnt(5)
  v_mfma_f32_16x16x32_bf16 v[64:67], a[72:75], v[160:163], v[64:67]
  ds_read_b128 v[192:195], v19 offset:0
  v_mfma_f32_16x16x32_bf16 v[68:71], a[76:79], v[160:163], v[68:71]
  v_add_u32 v18, s33, v14
  v_mfma_f32_16x16x32_bf16 v[72:75], a[80:83], v[160:163], v[72:75]
  v_mfma_f32_16x16x32_bf16 v[76:79], a[72:75], v[164:167], v[76:79]
  ds_read_b128 v[196:199], v19 offset:2048
  v_mfma_f32_16x16x32_bf16 v[80:83], a[76:79], v[164:167], v[80:83]
  buffer_load_dwordx4 v12, s[8:11], s30 offen offset:2048 lds
  v_mfma_f32_16x16x32_bf16 v[84:87], a[80:83], v[164:167], v[84:87]
  v_mfma_f32_16x16x32_bf16 v[88:91], a[72:75], v[168:171], v[88:91]
  ds_read_b128 v[200:203], v19 offset:4096
  v_mfma_f32_16x16x32_bf16 v[92:95], a[76:79], v[168:171], v[92:95]
  s_add_u32 s21, s48, 4096
  ds_read_b128 v[224:227], v23 offset:6400
  v_mfma_f32_16x16x32_bf16 v[96:99], a[80:83], v[168:171], v[96:99]
  v_mfma_f32_16x16x32_bf16 v[100:103], a[72:75], v[172:175], v[100:103]
  ds_read_b128 v[204:207], v19 offset:6144
  v_mfma_f32_16x16x32_bf16 v[104:107], a[76:79], v[172:175], v[104:107]
  buffer_store_dwordx4 v[240:243], v26, s[16:19], s21 offen offset:0 sc1
  v_mfma_f32_16x16x32_bf16 v[108:111], a[80:83], v[172:175], v[108:111]
  s_waitcnt lgkmcnt(5)
  v_mfma_f32_16x16x32_bf16 v[112:115], a[72:75], v[176:179], v[112:115]
  ds_read_b128 v[208:211], v19 offset:8192
  v_mfma_f32_16x16x32_bf16 v[116:119], a[76:79], v[176:179], v[116:119]
  v_mfma_f32_16x16x32_bf16 v[120:123], a[80:83], v[176:179], v[120:123]
  v_mfma_f32_16x16x32_bf16 v[124:127], a[72:75], v[180:183], v[124:127]
  ds_read_b128 v[212:215], v19 offset:10240
  v_mfma_f32_16x16x32_bf16 v[128:131], a[76:79], v[180:183], v[128:131]
  buffer_load_dwordx4 v13, s[8:11], s30 offen offset:3072 lds
  v_mfma_f32_16x16x32_bf16 v[132:135], a[80:83], v[180:183], v[132:135]
  s_add_u32 s30, s30, 128
  s_add_u32 m0, m0, 16384
  v_mfma_f32_16x16x32_bf16 v[136:139], a[72:75], v[184:187], v[136:139]
  ds_read_b128 v[216:219], v19 offset:12288
  v_mfma_f32_16x16x32_bf16 v[140:143], a[76:79], v[184:187], v[140:143]
  s_cmp_lt_u32 m0, s46
  s_cselect_b32 m0, m0, s47
  v_mfma_f32_16x16x32_bf16 v[144:147], a[80:83], v[184:187], v[144:147]
  ds_read_b128 v[228:231], v23 offset:6464
  v_mfma_f32_16x16x32_bf16 v[148:151], a[72:75], v[188:191], v[148:151]
  ds_read_b128 v[220:223], v19 offset:14336
  v_mfma_f32_16x16x32_bf16 v[152:155], a[76:79], v[188:191], v[152:155]
  buffer_store_dwordx4 v[244:247], v26, s[16:19], s21 offen offset:1024 sc1
  v_mfma_f32_16x16x32_bf16 v[156:159], a[80:83], v[188:191], v[156:159]
  s_waitcnt vmcnt(18) lgkmcnt(5)
  s_barrier
  v_mfma_f32_16x16x32_bf16 v[64:67], a[84:87], v[192:195], v[64:67]
  ds_read_b128 v[160:163], v18 offset:0
  v_mfma_f32_16x16x32_bf16 v[68:71], a[88:91], v[192:195], v[68:71]
  v_mfma_f32_16x16x32_bf16 v[72:75], a[92:95], v[192:195], v[72:75]
  v_add_u32 v19, s33, v15
  s_add_u32 s33, s33, 16384
  v_mfma_f32_16x16x32_bf16 v[76:79], a[84:87], v[196:199], v[76:79]
  ds_read_b128 v[164:167], v18 offset:2048
  v_mfma_f32_16x16x32_bf16 v[80:83], a[88:91], v[196:199], v[80:83]
  buffer_load_dwordx4 v10, s[8:11], s30 offen offset:0 lds
  v_mfma_f32_16x16x32_bf16 v[84:87], a[92:95], v[196:199], v[84:87]
  s_cmp_lt_u32 s33, 98304
  s_cselect_b32 s33, s33, 0
  v_mfma_f32_16x16x32_bf16 v[88:91], a[84:87], v[200:203], v[88:91]
  ds_read_b128 v[168:171], v18 offset:4096
  v_mfma_f32_16x16x32_bf16 v[92:95], a[88:91], v[200:203], v[92:95]
  ds_read_b128 v[232:235], v23 offset:6528
  v_mfma_f32_16x16x32_bf16 v[96:99], a[92:95], v[200:203], v[96:99]
  v_mfma_f32_16x16x32_bf16 v[100:103], a[84:87], v[204:207], v[100:103]
  ds_read_b128 v[172:175], v18 offset:6144
  v_mfma_f32_16x16x32_bf16 v[104:107], a[88:91], v[204:207], v[104:107]
  buffer_store_dwordx4 v[224:227], v26, s[16:19], s21 offen offset:2048 sc1
  v_mfma_f32_16x16x32_bf16 v[108:111], a[92:95], v[204:207], v[108:111]
  s_waitcnt lgkmcnt(5)
  v_mfma_f32_16x16x32_bf16 v[112:115], a[84:87], v[208:211], v[112:115]
  ds_read_b128 v[176:179], v18 offset:8192
  v_mfma_f32_16x16x32_bf16 v[116:119], a[88:91], v[208:211], v[116:119]
  v_mfma_f32_16x16x32_bf16 v[120:123], a[92:95], v[208:211], v[120:123]
  v_mfma_f32_16x16x32_bf16 v[124:127], a[84:87], v[212:215], v[124:127]
  ds_read_b128 v[180:183], v18 offset:10240
  v_mfma_f32_16x16x32_bf16 v[128:131], a[88:91], v[212:215], v[128:131]
  buffer_load_dwordx4 v11, s[8:11], s30 offen offset:1024 lds
  v_mfma_f32_16x16x32_bf16 v[132:135], a[92:95], v[212:215], v[132:135]
  v_mfma_f32_16x16x32_bf16 v[136:139], a[84:87], v[216:219], v[136:139]
  ds_read_b128 v[184:187], v18 offset:12288
  v_mfma_f32_16x16x32_bf16 v[140:143], a[88:91], v[216:219], v[140:143]
  ds_read_b128 v[236:239], v23 offset:6592
  v_mfma_f32_16x16x32_bf16 v[144:147], a[92:95], v[216:219], v[144:147]
  v_mfma_f32_16x16x32_bf16 v[148:151], a[84:87], v[220:223], v[148:151]
  ds_read_b128 v[188:191], v18 offset:14336
  v_mfma_f32_16x16x32_bf16 v[152:155], a[88:91], v[220:223], v[152:155]
  buffer_store_dwordx4 v[228:231], v26, s[16:19], s21 offen offset:3072 sc1
  v_mfma_f32_16x16x32_bf16 v[156:159], a[92:95], v[220:223], v[156:159]
  s_waitcnt lgkmcnt(5)
  v_mfma_f32_16x16x32_bf16 v[64:67], a[96:99], v[160:163], v[64:67]
  ds_read_b128 v[192:195], v19 offset:0
  v_mfma_f32_16x16x32_bf16 v[68:71], a[100:103], v[160:163], v[68:71]
  v_add_u32 v18, s33, v14
  v_mfma_f32_16x16x32_bf16 v[72:75], a[104:107], v[160:163], v[72:75]
  v_mfma_f32_16x16x32_bf16 v[76:79], a[96:99], v[164:167], v[76:79]
  ds_read_b128 v[196:199], v19 offset:2048
  v_mfma_f32_16x16x32_bf16 v[80:83], a[100:103], v[164:167], v[80:83]
  buffer_load_dwordx4 v12, s[8:11], s30 offen offset:2048 lds
  v_mfma_f32_16x16x32_bf16 v[84:87], a[104:107], v[164:167], v[84:87]
  v_mfma_f32_16x16x32_bf16 v[88:91], a[96:99], v[168:171], v[88:91]
  ds_read_b128 v[200:203], v19 offset:4096
  v_mfma_f32_16x16x32_bf16 v[92:95], a[100:103], v[168:171], v[92:95]
  s_add_u32 s21, s48, 8192
  ds_read_b128 v[240:243], v23 offset:6656
  v_mfma_f32_16x16x32_bf16 v[96:99], a[104:107], v[168:171], v[96:99]
  v_mfma_f32_16x16x32_bf16 v[100:103], a[96:99], v[172:175], v[100:103]
  ds_read_b128 v[204:207], v19 offset:6144
  v_mfma_f32_16x16x32_bf16 v[104:107], a[100:103], v[172:175], v[104:107]
  buffer_store_dwordx4 v[232:235], v26, s[16:19], s21 offen offset:0 sc1
  v_mfma_f32_16x16x32_bf16 v[108:111], a[104:107], v[172:175], v[108:111]
  s_waitcnt lgkmcnt(5)
  v_mfma_f32_16x16x32_bf16 v[112:115], a[96:99], v[176:179], v[112:115]
  ds_read_b128 v[208:211], v19 offset:8192
  v_mfma_f32_16x16x32_bf16 v[116:119], a[100:103], v[176:179], v[116:119]
  v_mfma_f32_16x16x32_bf16 v[120:123], a[104:107], v[176:179], v[120:123]
  v_mfma_f32_16x16x32_bf16 v[124:127], a[96:99], v[180:183], v[124:127]
  ds_read_b128 v[212:215], v19 offset:10240
  v_mfma_f32_16x16x32_bf16 v[128:131], a[100:103], v[180:183], v[128:131]
  buffer_load_dwordx4 v13, s[8:11], s30 offen offset:3072 lds
  v_mfma_f32_16x16x32_bf16 v[132:135], a[104:107], v[180:183], v[132:135]
  s_add_u32 s30, s30, 128
  s_add_u32 m0, m0, 16384
  v_mfma_f32_16x16x32_bf16 v[136:139], a[96:99], v[184:187], v[136:139]
  ds_read_b128 v[216:219], v19 offset:12288
  v_mfma_f32_16x16x32_bf16 v[140:143], a[100:103], v[184:187], v[140:143]
  s_cmp_lt_u32 m0, s46
  s_cselect_b32 m0, m0, s47
  v_mfma_f32_16x16x32_bf16 v[144:147], a[104:107], v[184:187], v[144:147]
  ds_read_b128 v[244:247], v23 offset:6720
  v_mfma_f32_16x16x32_bf16 v[148:151], a[96:99], v[188:191], v[148:151]
  ds_read_b128 v[220:223], v19 offset:14336
  v_mfma_f32_16x16x32_bf16 v[152:155], a[100:103], v[188:191], v[152:155]
  buffer_store_dwordx4 v[236:239], v26, s[16:19], s21 offen offset:1024 sc1
  v_mfma_f32_16x16x32_bf16 v[156:159], a[104:107], v[188:191], v[156:159]
  s_waitcnt vmcnt(22) lgkmcnt(5)
  s_barrier
  v_mfma_f32_16x16x32_bf16 v[64:67], a[108:111], v[192:195], v[64:67]
  ds_read_b128 v[160:163], v18 offset:0
  v_mfma_f32_16x16x32_bf16 v[68:71], a[112:115], v[192:195], v[68:71]
  v_mfma_f32_16x16x32_bf16 v[72:75], a[116:119], v[192:195], v[72:75]
  v_add_u32 v19, s33, v15
  s_add_u32 s33, s33, 16384
  v_mfma_f32_16x16x32_bf16 v[76:79], a[108:111], v[196:199], v[76:79]
  ds_read_b128 v[164:167], v18 offset:2048
  v_mfma_f32_16x16x32_bf16 v[80:83], a[112:115], v[196:199], v[80:83]
  buffer_load_dwordx4 v10, s[8:11], s30 offen offset:0 lds
  v_mfma_f32_16x16x32_bf16 v[84:87], a[116:119], v[196:199], v[84:87]
  s_cmp_lt_u32 s33, 98304
  s_cselect_b32 s33, s33, 0
  v_mfma_f32_16x16x32_bf16 v[88:91], a[108:111], v[200:203], v[88:91]
  ds_read_b128 v[168:171], v18 offset:4096
  v_mfma_f32_16x16x32_bf16 v[92:95], a[112:115], v[200:203], v[92:95]
  v_mfma_f32_16x16x32_bf16 v[96:99], a[116:119], v[200:203], v[96:99]
  v_mfma_f32_16x16x32_bf16 v[100:103], a[108:111], v[204:207], v[100:103]
  ds_read_b128 v[172:175], v18 offset:6144
  v_mfma_f32_16x16x32_bf16 v[104:107], a[112:115], v[204:207], v[104:107]
  buffer_store_dwordx4 v[240:243], v26, s[16:19], s21 offen offset:2048 sc1
  v_mfma_f32_16x16x32_bf16 v[108:111], a[116:119], v[204:207], v[108:111]
  s_waitcnt lgkmcnt(4)
  v_mfma_f32_16x16x32_bf16 v[112:115], a[108:111], v[208:211], v[112:115]
  ds_read_b128 v[176:179], v18 offset:8192
  v_mfma_f32_16x16x32_bf16 v[116:119], a[112:115], v[208:211], v[116:119]
  v_mfma_f32_16x16x32_bf16 v[120:123], a[116:119], v[208:211], v[120:123]
  v_mfma_f32_16x16x32_bf16 v[124:127], a[108:111], v[212:215], v[124:127]
  ds_read_b128 v[180:183], v18 offset:10240
  v_mfma_f32_16x16x32_bf16 v[128:131], a[112:115], v[212:215], v[128:131]
  buffer_load_dwordx4 v11, s[8:11], s30 offen offset:1024 lds
  v_mfma_f32_16x16x32_bf16 v[132:135], a[116:119], v[212:215], v[132:135]
  v_mfma_f32_16x16x32_bf16 v[136:139], a[108:111], v[216:219], v[136:139]
  ds_read_b128 v[184:187], v18 offset:12288
  v_mfma_f32_16x16x32_bf16 v[140:143], a[112:115], v[216:219], v[140:143]
  v_mfma_f32_16x16x32_bf16 v[144:147], a[116:119], v[216:219], v[144:147]
  v_mfma_f32_16x16x32_bf16 v[148:151], a[108:111], v[220:223], v[148:151]
  ds_read_b128 v[188:191], v18 offset:14336
  v_mfma_f32_16x16x32_bf16 v[152:155], a[112:115], v[220:223], v[152:155]
  buffer_store_dwordx4 v[244:247], v26, s[16:19], s21 offen offset:3072 sc1
  v_mfma_f32_16x16x32_bf16 v[156:159], a[116:119], v[220:223], v[156:159]
  s_waitcnt lgkmcnt(4)
  v_mfma_f32_16x16x32_bf16 v[64:67], a[120:123], v[160:163], v[64:67]
  ds_read_b128 v[192:195], v19 offset:0
  v_mfma_f32_16x16x32_bf16 v[68:71], a[124:127], v[160:163], v[68:71]
  v_add_u32 v18, s33, v14
  v_mfma_f32_16x16x32_bf16 v[72:75], a[128:131], v[160:163], v[72:75]
  v_mfma_f32_16x16x32_bf16 v[76:79], a[120:123], v[164:167], v[76:79]
  ds_read_b128 v[196:199], v19 offset:2048
  v_mfma_f32_16x16x32_bf16 v[80:83], a[124:127], v[164:167], v[80:83]
  buffer_load_dwordx4 v12, s[8:11], s30 offen offset:2048 lds
  v_mfma_f32_16x16x32_bf16 v[84:87], a[128:131], v[164:167], v[84:87]
  v_mfma_f32_16x16x32_bf16 v[88:91], a[120:123], v[168:171], v[88:91]
  ds_read_b128 v[200:203], v19 offset:4096
  v_mfma_f32_16x16x32_bf16 v[92:95], a[124:127], v[168:171], v[92:95]
  v_mfma_f32_16x16x32_bf16 v[96:99], a[128:131], v[168:171], v[96:99]
  v_mfma_f32_16x16x32_bf16 v[100:103], a[120:123], v[172:175], v[100:103]
  ds_read_b128 v[204:207], v19 offset:6144
  v_mfma_f32_16x16x32_bf16 v[104:107], a[124:127], v[172:175], v[104:107]
  v_mfma_f32_16x16x32_bf16 v[108:111], a[128:131], v[172:175], v[108:111]
  s_waitcnt lgkmcnt(4)
  v_mfma_f32_16x16x32_bf16 v[112:115], a[120:123], v[176:179], v[112:115]
  ds_read_b128 v[208:211], v19 offset:8192
  v_mfma_f32_16x16x32_bf16 v[116:119], a[124:127], v[176:179], v[116:119]
  v_mfma_f32_16x16x32_bf16 v[120:123], a[128:131], v[176:179], v[120:123]
  v_mfma_f32_16x16x32_bf16 v[124:127], a[120:123], v[180:183], v[124:127]
  ds_read_b128 v[212:215], v19 offset:10240
  v_mfma_f32_16x16x32_bf16 v[128:131], a[124:127], v[180:183], v[128:131]
  buffer_load_dwordx4 v13, s[8:11], s30 offen offset:3072 lds
  v_mfma_f32_16x16x32_bf16 v[132:135], a[128:131], v[180:183], v[132:135]
  s_add_u32 s30, s30, s25
  s_sub_u32 s30, s30, 1152
  v_mfma_f32_16x16x32_bf16 v[136:139], a[120:123], v[184:187], v[136:139]
  ds_read_b128 v[216:219], v19 offset:12288
  s_add_u32 m0, m0, 16384
  v_mfma_f32_16x16x32_bf16 v[140:143], a[124:127], v[184:187], v[140:143]
  s_cmp_lt_u32 m0, s46
  s_cselect_b32 m0, m0, s47
  v_mfma_f32_16x16x32_bf16 v[144:147], a[128:131], v[184:187], v[144:147]
  v_mfma_f32_16x16x32_bf16 v[148:151], a[120:123], v[188:191], v[148:151]
  ds_read_b128 v[220:223], v19 offset:14336
  v_mfma_f32_16x16x32_bf16 v[152:155], a[124:127], v[188:191], v[152:155]
  v_mfma_f32_16x16x32_bf16 v[156:159], a[128:131], v[188:191], v[156:159]
  s_waitcnt vmcnt(23) lgkmcnt(4)
  s_barrier
  v_mfma_f32_16x16x32_bf16 v[64:67], a[132:135], v[192:195], v[64:67]
  ds_read_b128 v[160:163], v18 offset:0
  v_mfma_f32_16x16x32_bf16 v[68:71], a[136:139], v[192:195], v[68:71]
  v_mfma_f32_16x16x32_bf16 v[72:75], a[140:143], v[192:195], v[72:75]
  v_add_u32 v19, s33, v15
  s_add_u32 s33, s33, 16384
  v_mfma_f32_16x16x32_bf16 v[76:79], a[132:135], v[196:199], v[76:79]
  ds_read_b128 v[164:167], v18 offset:2048
  v_mfma_f32_16x16x32_bf16 v[80:83], a[136:139], v[196:199], v[80:83]
  buffer_load_dwordx4 v10, s[8:11], s30 offen offset:0 lds
  v_mfma_f32_16x16x32_bf16 v[84:87], a[140:143], v[196:199], v[84:87]
  s_cmp_lt_u32 s33, 98304
  s_cselect_b32 s33, s33, 0
  v_mfma_f32_16x16x32_bf16 v[88:91], a[132:135], v[200:203], v[88:91]
  ds_read_b128 v[168:171], v18 offset:4096
  v_mfma_f32_16x16x32_bf16 v[92:95], a[136:139], v[200:203], v[92:95]
  v_mfma_f32_16x16x32_bf16 v[96:99], a[140:143], v[200:203], v[96:99]
  v_mfma_f32_16x16x32_bf16 v[100:103], a[132:135], v[204:207], v[100:103]
  ds_read_b128 v[172:175], v18 offset:6144
  v_mfma_f32_16x16x32_bf16 v[104:107], a[136:139], v[204:207], v[104:107]
  v_mfma_f32_16x16x32_bf16 v[108:111], a[140:143], v[204:207], v[108:111]
  s_waitcnt lgkmcnt(4)
  v_mfma_f32_16x16x32_bf16 v[112:115], a[132:135], v[208:211], v[112:115]
  ds_read_b128 v[176:179], v18 offset:8192
  v_mfma_f32_16x16x32_bf16 v[116:119], a[136:139], v[208:211], v[116:119]
  v_mfma_f32_16x16x32_bf16 v[120:123], a[140:143], v[208:211], v[120:123]
  v_mfma_f32_16x16x32_bf16 v[124:127], a[132:135], v[212:215], v[124:127]
  ds_read_b128 v[180:183], v18 offset:10240
  v_mfma_f32_16x16x32_bf16 v[128:131], a[136:139], v[212:215], v[128:131]
  buffer_load_dwordx4 v11, s[8:11], s30 offen offset:1024 lds
  v_mfma_f32_16x16x32_bf16 v[132:135], a[140:143], v[212:215], v[132:135]
  v_mfma_f32_16x16x32_bf16 v[136:139], a[132:135], v[216:219], v[136:139]
  ds_read_b128 v[184:187], v18 offset:12288
  v_mfma_f32_16x16x32_bf16 v[140:143], a[136:139], v[216:219], v[140:143]
  v_mfma_f32_16x16x32_bf16 v[144:147], a[140:143], v[216:219], v[144:147]
  v_mfma_f32_16x16x32_bf16 v[148:151], a[132:135], v[220:223], v[148:151]
  ds_read_b128 v[188:191], v18 offset:14336
  v_mfma_f32_16x16x32_bf16 v[152:155], a[136:139], v[220:223], v[152:155]
  v_mfma_f32_16x16x32_bf16 v[156:159], a[140:143], v[220:223], v[156:159]
  s_waitcnt lgkmcnt(4)
  v_mfma_f32_16x16x32_bf16 v[64:67], a[144:147], v[160:163], v[64:67]
  ds_read_b128 v[192:195], v19 offset:0
  v_mfma_f32_16x16x32_bf16 v[68:71], a[148:151], v[160:163], v[68:71]
  v_add_u32 v18, s33, v14
  v_mfma_f32_16x16x32_bf16 v[72:75], a[152:155], v[160:163], v[72:75]
  v_mfma_f32_16x16x32_bf16 v[76:79], a[144:147], v[164:167], v[76:79]
  ds_read_b128 v[196:199], v19 offset:2048
  v_mfma_f32_16x16x32_bf16 v[80:83], a[148:151], v[164:167], v[80:83]
  buffer_load_dwordx4 v12, s[8:11], s30 offen offset:2048 lds
  v_mfma_f32_16x16x32_bf16 v[84:87], a[152:155], v[164:167], v[84:87]
  v_mfma_f32_16x16x32_bf16 v[88:91], a[144:147], v[168:171], v[88:91]
  ds_read_b128 v[200:203], v19 offset:4096
  v_mfma_f32_16x16x32_bf16 v[92:95], a[148:151], v[168:171], v[92:95]
  v_mfma_f32_16x16x32_bf16 v[96:99], a[152:155], v[168:171], v[96:99]
  v_mfma_f32_16x16x32_bf16 v[100:103], a[144:147], v[172:175], v[100:103]
  ds_read_b128 v[204:207], v19 offset:6144
  v_mfma_f32_16x16x32_bf16 v[104:107], a[148:151], v[172:175], v[104:107]
  v_mfma_f32_16x16x32_bf16 v[108:111], a[152:155], v[172:175], v[108:111]
  s_waitcnt lgkmcnt(4)
  v_mfma_f32_16x16x32_bf16 v[112:115], a[144:147], v[176:179], v[112:115]
  ds_read_b128 v[208:211], v19 offset:8192
  v_mfma_f32_16x16x32_bf16 v[116:119], a[148:151], v[176:179], v[116:119]
  v_mfma_f32_16x16x32_bf16 v[120:123], a[152:155], v[176:179], v[120:123]
  v_mfma_f32_16x16x32_bf16 v[124:127], a[144:147], v[180:183], v[124:127]
  ds_read_b128 v[212:215], v19 offset:10240
  v_mfma_f32_16x16x32_bf16 v[128:131], a[148:151], v[180:183], v[128:131]
  buffer_load_dwordx4 v13, s[8:11], s30 offen offset:3072 lds
  v_mfma_f32_16x16x32_bf16 v[132:135], a[152:155], v[180:183], v[132:135]
  s_add_u32 s30, s30, 128
  s_add_u32 m0, m0, 16384
  v_mfma_f32_16x16x32_bf16 v[136:139], a[144:147], v[184:187], v[136:139]
  ds_read_b128 v[216:219], v19 offset:12288
  v_mfma_f32_16x16x32_bf16 v[140:143], a[148:151], v[184:187], v[140:143]
  s_cmp_lt_u32 m0, s46
  s_cselect_b32 m0, m0, s47
  v_mfma_f32_16x16x32_bf16 v[144:147], a[152:155], v[184:187], v[144:147]
  v_mfma_f32_16x16x32_bf16 v[148:151], a[144:147], v[188:191], v[148:151]
  ds_read_b128 v[220:223], v19 offset:14336
  v_mfma_f32_16x16x32_bf16 v[152:155], a[148:151], v[188:191], v[152:155]
  v_mfma_f32_16x16x32_bf16 v[156:159], a[152:155], v[188:191], v[156:159]
  s_waitcnt vmcnt(6) lgkmcnt(4)
  s_barrier
  v_mfma_f32_16x16x32_bf16 v[64:67], a[156:159], v[192:195], v[64:67]
  ds_read_b128 v[160:163], v18 offset:0
  v_mfma_f32_16x16x32_bf16 v[68:71], a[160:163], v[192:195], v[68:71]
  s_cmp_eq_u32 s48, 0x80000000
  s_cbranch_scc1 kv_163
  s_cmp_lg_u32 s20, 0
  s_cbranch_scc1 af_164
  v_mov_b32 v4, 0
  v_mov_b32 v5, 1
  s_mov_b64 exec, 1
  buffer_atomic_add v5, v4, s[72:75], s61 offen sc1
  s_mov_b64 exec, -1
  s_nop 1
af_164:
kv_163:
  v_mfma_f32_16x16x32_bf16 v[72:75], a[164:167], v[192:195], v[72:75]
  v_add_u32 v19, s33, v15
  s_add_u32 s33, s33, 16384
  v_mfma_f32_16x16x32_bf16 v[76:79], a[156:159], v[196:199], v[76:79]
  ds_read_b128 v[164:167], v18 offset:2048
  v_mfma_f32_16x16x32_bf16 v[80:83], a[160:163], v[196:199], v[80:83]
  buffer_load_dwordx4 v10, s[8:11], s30 offen offset:0 lds
  v_mfma_f32_16x16x32_bf16 v[84:87], a[164:167], v[196:199], v[84:87]
  s_cmp_lt_u32 s33, 98304
  s_cselect_b32 s33, s33, 0
  v_mfma_f32_16x16x32_bf16 v[88:91], a[156:159], v[200:203], v[88:91]
  ds_read_b128 v[168:171], v18 offset:4096
  v_mfma_f32_16x16x32_bf16 v[92:95], a[160:163], v[200:203], v[92:95]
  v_mfma_f32_16x16x32_bf16 v[96:99], a[164:167], v[200:203], v[96:99]
  v_mfma_f32_16x16x32_bf16 v[100:103], a[156:159], v[204:207], v[100:103]
  ds_read_b128 v[172:175], v18 offset:6144
  v_mfma_f32_16x16x32_bf16 v[104:107], a[160:163], v[204:207], v[104:107]
  v_mfma_f32_16x16x32_bf16 v[108:111], a[164:167], v[204:207], v[108:111]
  s_waitcnt lgkmcnt(4)
  v_mfma_f32_16x16x32_bf16 v[112:115], a[156:159], v[208:211], v[112:115]
  ds_read_b128 v[176:179], v18 offset:8192
  v_mfma_f32_16x16x32_bf16 v[116:119], a[160:163], v[208:211], v[116:119]
  v_mfma_f32_16x16x32_bf16 v[120:123], a[164:167], v[208:211], v[120:123]
  v_mfma_f32_16x16x32_bf16 v[124:127], a[156:159], v[212:215], v[124:127]
  ds_read_b128 v[180:183], v18 offset:10240
  v_mfma_f32_16x16x32_bf16 v[128:131], a[160:163], v[212:215], v[128:131]
  buffer_load_dwordx4 v11, s[8:11], s30 offen offset:1024 lds
  v_mfma_f32_16x16x32_bf16 v[132:135], a[164:167], v[212:215], v[132:135]
  v_mfma_f32_16x16x32_bf16 v[136:139], a[156:159], v[216:219], v[136:139]
  ds_read_b128 v[184:187], v18 offset:12288
  v_mfma_f32_16x16x32_bf16 v[140:143], a[160:163], v[216:219], v[140:143]
  v_mfma_f32_16x16x32_bf16 v[144:147], a[164:167], v[216:219], v[144:147]
  v_mfma_f32_16x16x32_bf16 v[148:151], a[156:159], v[220:223], v[148:151]
  ds_read_b128 v[188:191], v18 offset:14336
  v_mfma_f32_16x16x32_bf16 v[152:155], a[160:163], v[220:223], v[152:155]
  v_mfma_f32_16x16x32_bf16 v[156:159], a[164:167], v[220:223], v[156:159]
  s_waitcnt lgkmcnt(4)
  v_mfma_f32_16x16x32_bf16 v[64:67], a[168:171], v[160:163], v[64:67]
  ds_read_b128 v[192:195], v19 offset:0
  v_mfma_f32_16x16x32_bf16 v[68:71], a[172:175], v[160:163], v[68:71]
  v_add_u32 v18, s33, v14
  s_mov_b32 s61, s60
  v_mfma_f32_16x16x32_bf16 v[72:75], a[176:179], v[160:163], v[72:75]
  s_add_u32 s60, s60, s62
  s_mul_i32 s48, s20, 393216
  v_mfma_f32_16x16x32_bf16 v[76:79], a[168:171], v[164:167], v[76:79]
  ds_read_b128 v[196:199], v19 offset:2048
  s_add_u32 s48, s48, s27
  v_mfma_f32_16x16x32_bf16 v[80:83], a[172:175], v[164:167], v[80:83]
  buffer_load_dwordx4 v12, s[8:11], s30 offen offset:2048 lds
  v_mfma_f32_16x16x32_bf16 v[84:87], a[176:179], v[164:167], v[84:87]
  s_add_u32 s27, s27, s28
  s_sub_u32 s26, s26, 1
  v_mfma_f32_16x16x32_bf16 v[88:91], a[168:171], v[168:171], v[88:91]
  ds_read_b128 v[200:203], v19 offset:4096
  v_mfma_f32_16x16x32_bf16 v[92:95], a[172:175], v[168:171], v[92:95]
  v_mfma_f32_16x16x32_bf16 v[96:99], a[176:179], v[168:171], v[96:99]
  v_mfma_f32_16x16x32_bf16 v[100:103], a[168:171], v[172:175], v[100:103]
  ds_read_b128 v[204:207], v19 offset:6144
  v_mfma_f32_16x16x32_bf16 v[104:107], a[172:175], v[172:175], v[104:107]
  v_mfma_f32_16x16x32_bf16 v[108:111], a[176:179], v[172:175], v[108:111]
  s_waitcnt lgkmcnt(4)
  v_mfma_f32_16x16x32_bf16 v[112:115], a[168:171], v[176:179], v[112:115]
  ds_read_b128 v[208:211], v19 offset:8192
  v_mfma_f32_16x16x32_bf16 v[116:119], a[172:175], v[176:179], v[116:119]
  v_mfma_f32_16x16x32_bf16 v[120:123], a[176:179], v[176:179], v[120:123]
  v_mfma_f32_16x16x32_bf16 v[124:127], a[168:171], v[180:183], v[124:127]
  ds_read_b128 v[212:215], v19 offset:10240
  v_mfma_f32_16x16x32_bf16 v[128:131], a[172:175], v[180:183], v[128:131]
  buffer_load_dwordx4 v13, s[8:11], s30 offen offset:3072 lds
  v_mfma_f32_16x16x32_bf16 v[132:135], a[176:179], v[180:183], v[132:135]
  s_add_u32 s30, s30, 128
  s_add_u32 m0, m0, 16384
  v_mfma_f32_16x16x32_bf16 v[136:139], a[168:171], v[184:187], v[136:139]
  ds_read_b128 v[216:219], v19 offset:12288
  v_mfma_f32_16x16x32_bf16 v[140:143], a[172:175], v[184:187], v[140:143]
  s_cmp_lt_u32 m0, s46
  s_cselect_b32 m0, m0, s47
  v_mfma_f32_16x16x32_bf16 v[144:147], a[176:179], v[184:187], v[144:147]
  v_mfma_f32_16x16x32_bf16 v[148:151], a[168:171], v[188:191], v[148:151]
  ds_read_b128 v[220:223], v19 offset:14336
  v_mfma_f32_16x16x32_bf16 v[152:155], a[172:175], v[188:191], v[152:155]
  v_mfma_f32_16x16x32_bf16 v[156:159], a[176:179], v[188:191], v[156:159]
  s_waitcnt vmcnt(15) lgkmcnt(4)
  s_barrier
  v_mfma_f32_16x16x32_bf16 v[64:67], a[180:183], v[192:195], v[64:67]
  ds_read_b128 v[160:163], v18 offset:0
  v_mfma_f32_16x16x32_bf16 v[68:71], a[184:187], v[192:195], v[68:71]
  v_mfma_f32_16x16x32_bf16 v[72:75], a[188:191], v[192:195], v[72:75]
  v_add_u32 v19, s33, v15
  s_add_u32 s33, s33, 16384
  v_mfma_f32_16x16x32_bf16 v[76:79], a[180:183], v[196:199], v[76:79]
  ds_read_b128 v[164:167], v18 offset:2048
  v_mfma_f32_16x16x32_bf16 v[80:83], a[184:187], v[196:199], v[80:83]
  buffer_load_dwordx4 v10, s[8:11], s30 offen offset:0 lds
  v_mfma_f32_16x16x32_bf16 v[84:87], a[188:191], v[196:199], v[84:87]
  s_cmp_lt_u32 s33, 98304
  s_cselect_b32 s33, s33, 0
  v_mfma_f32_16x16x32_bf16 v[88:91], a[180:183], v[200:203], v[88:91]
  ds_read_b128 v[168:171], v18 offset:4096
  v_mfma_f32_16x16x32_bf16 v[92:95], a[184:187], v[200:203], v[92:95]
  v_mfma_f32_16x16x32_bf16 v[96:99], a[188:191], v[200:203], v[96:99]
  v_mfma_f32_16x16x32_bf16 v[100:103], a[180:183], v[204:207], v[100:103]
  ds_read_b128 v[172:175], v18 offset:6144
  v_mfma_f32_16x16x32_bf16 v[104:107], a[184:187], v[204:207], v[104:107]
  v_mfma_f32_16x16x32_bf16 v[108:111], a[188:191], v[204:207], v[108:111]
  s_waitcnt lgkmcnt(4)
  v_mfma_f32_16x16x32_bf16 v[112:115], a[180:183], v[208:211], v[112:115]
  ds_read_b128 v[176:179], v18 offset:8192
  v_mfma_f32_16x16x32_bf16 v[116:119], a[184:187], v[208:211], v[116:119]
  v_mfma_f32_16x16x32_bf16 v[120:123], a[188:191], v[208:211], v[120:123]
  v_mfma_f32_16x16x32_bf16 v[124:127], a[180:183], v[212:215], v[124:127]
  ds_read_b128 v[180:183], v18 offset:10240
  v_mfma_f32_16x16x32_bf16 v[128:131], a[184:187], v[212:215], v[128:131]
  buffer_load_dwordx4 v11, s[8:11], s30 offen offset:1024 lds
  v_mfma_f32_16x16x32_bf16 v[132:135], a[188:191], v[212:215], v[132:135]
  v_mfma_f32_16x16x32_bf16 v[136:139], a[180:183], v[216:219], v[136:139]
  ds_read_b128 v[184:187], v18 offset:12288
  v_mfma_f32_16x16x32_bf16 v[140:143], a[184:187], v[216:219], v[140:143]
  v_mfma_f32_16x16x32_bf16 v[144:147], a[188:191], v[216:219], v[144:147]
  v_mfma_f32_16x16x32_bf16 v[148:151], a[180:183], v[220:223], v[148:151]
  ds_read_b128 v[188:191], v18 offset:14336
  v_mfma_f32_16x16x32_bf16 v[152:155], a[184:187], v[220:223], v[152:155]
  v_mfma_f32_16x16x32_bf16 v[156:159], a[188:191], v[220:223], v[156:159]
  s_waitcnt lgkmcnt(4)
  v_mfma_f32_16x16x32_bf16 v[64:67], a[192:195], v[160:163], v[64:67]
  ds_read_b128 v[192:195], v19 offset:0
  v_mfma_f32_16x16x32_bf16 v[68:71], a[196:199], v[160:163], v[68:71]
  v_add_u32 v18, s33, v14
  v_mfma_f32_16x16x32_bf16 v[72:75], a[200:203], v[160:163], v[72:75]
  v_mfma_f32_16x16x32_bf16 v[76:79], a[192:195], v[164:167], v[76:79]
  ds_read_b128 v[196:199], v19 offset:2048
  v_mfma_f32_16x16x32_bf16 v[80:83], a[196:199], v[164:167], v[80:83]
  buffer_load_dwordx4 v12, s[8:11], s30 offen offset:2048 lds
  v_mfma_f32_16x16x32_bf16 v[84:87], a[200:203], v[164:167], v[84:87]
  v_mfma_f32_16x16x32_bf16 v[88:91], a[192:195], v[168:171], v[88:91]
  ds_read_b128 v[200:203], v19 offset:4096
  v_mfma_f32_16x16x32_bf16 v[92:95], a[196:199], v[168:171], v[92:95]
  v_mfma_f32_16x16x32_bf16 v[96:99], a[200:203], v[168:171], v[96:99]
  v_mfma_f32_16x16x32_bf16 v[100:103], a[192:195], v[172:175], v[100:103]
  ds_read_b128 v[204:207], v19 offset:6144
  v_mfma_f32_16x16x32_bf16 v[104:107], a[196:199], v[172:175], v[104:107]
  v_mfma_f32_16x16x32_bf16 v[108:111], a[200:203], v[172:175], v[108:111]
  s_waitcnt lgkmcnt(4)
  v_mfma_f32_16x16x32_bf16 v[112:115], a[192:195], v[176:179], v[112:115]
  ds_read_b128 v[208:211], v19 offset:8192
  v_mfma_f32_16x16x32_bf16 v[116:119], a[196:199], v[176:179], v[116:119]
  v_mfma_f32_16x16x32_bf16 v[120:123], a[200:203], v[176:179], v[120:123]
  v_mfma_f32_16x16x32_bf16 v[124:127], a[192:195], v[180:183], v[124:127]
  ds_read_b128 v[212:215], v19 offset:10240
  v_mfma_f32_16x16x32_bf16 v[128:131], a[196:199], v[180:183], v[128:131]
  buffer_load_dwordx4 v13, s[8:11], s30 offen offset:3072 lds
  v_mfma_f32_16x16x32_bf16 v[132:135], a[200:203], v[180:183], v[132:135]
  s_add_u32 s30, s30, 128
  s_add_u32 m0, m0, 16384
  v_mfma_f32_16x16x32_bf16 v[136:139], a[192:195], v[184:187], v[136:139]
  ds_read_b128 v[216:219], v19 offset:12288
  v_mfma_f32_16x16x32_bf16 v[140:143], a[196:199], v[184:187], v[140:143]
  s_cmp_lt_u32 m0, s46
  s_cselect_b32 m0, m0, s47
  v_mfma_f32_16x16x32_bf16 v[144:147], a[200:203], v[184:187], v[144:147]
  v_mfma_f32_16x16x32_bf16 v[148:151], a[192:195], v[188:191], v[148:151]
  ds_read_b128 v[220:223], v19 offset:14336
  v_mfma_f32_16x16x32_bf16 v[152:155], a[196:199], v[188:191], v[152:155]
  v_mfma_f32_16x16x32_bf16 v[156:159], a[200:203], v[188:191], v[156:159]
  s_waitcnt vmcnt(12) lgkmcnt(4)
  s_barrier
  v_mfma_f32_16x16x32_bf16 v[64:67], a[204:207], v[192:195], v[64:67]
  ds_read_b128 v[160:163], v18 offset:0
  v_mfma_f32_16x16x32_bf16 v[68:71], a[208:211], v[192:195], v[68:71]
  v_mfma_f32_16x16x32_bf16 v[72:75], a[212:215], v[192:195], v[72:75]
  v_add_u32 v19, s33, v15
  s_add_u32 s33, s33, 16384
  v_mfma_f32_16x16x32_bf16 v[76:79], a[204:207], v[196:199], v[76:79]
  ds_read_b128 v[164:167], v18 offset:2048
  v_mfma_f32_16x16x32_bf16 v[80:83], a[208:211], v[196:199], v[80:83]
  buffer_load_dwordx4 v10, s[8:11], s30 offen offset:0 lds
  v_mfma_f32_16x16x32_bf16 v[84:87], a[212:215], v[196:199], v[84:87]
  s_cmp_lt_u32 s33, 98304
  s_cselect_b32 s33, s33, 0
  v_mfma_f32_16x16x32_bf16 v[88:91], a[204:207], v[200:203], v[88:91]
  ds_read_b128 v[168:171], v18 offset:4096
  v_mfma_f32_16x16x32_bf16 v[92:95], a[208:211], v[200:203], v[92:95]
  v_mfma_f32_16x16x32_bf16 v[96:99], a[212:215], v[200:203], v[96:99]
  v_mfma_f32_16x16x32_bf16 v[100:103], a[204:207], v[204:207], v[100:103]
  ds_read_b128 v[172:175], v18 offset:6144
  v_mfma_f32_16x16x32_bf16 v[104:107], a[208:211], v[204:207], v[104:107]
  v_mfma_f32_16x16x32_bf16 v[108:111], a[212:215], v[204:207], v[108:111]
  s_waitcnt lgkmcnt(4)
  v_mfma_f32_16x16x32_bf16 v[112:115], a[204:207], v[208:211], v[112:115]
  ds_read_b128 v[176:179], v18 offset:8192
  v_mfma_f32_16x16x32_bf16 v[116:119], a[208:211], v[208:211], v[116:119]
  v_mfma_f32_16x16x32_bf16 v[120:123], a[212:215], v[208:211], v[120:123]
  v_mfma_f32_16x16x32_bf16 v[124:127], a[204:207], v[212:215], v[124:127]
  ds_read_b128 v[180:183], v18 offset:10240
  v_mfma_f32_16x16x32_bf16 v[128:131], a[208:211], v[212:215], v[128:131]
  buffer_load_dwordx4 v11, s[8:11], s30 offen offset:1024 lds
  v_mfma_f32_16x16x32_bf16 v[132:135], a[212:215], v[212:215], v[132:135]
  v_mfma_f32_16x16x32_bf16 v[136:139], a[204:207], v[216:219], v[136:139]
  ds_read_b128 v[184:187], v18 offset:12288
  v_mfma_f32_16x16x32_bf16 v[140:143], a[208:211], v[216:219], v[140:143]
  v_mfma_f32_16x16x32_bf16 v[144:147], a[212:215], v[216:219], v[144:147]
  v_mfma_f32_16x16x32_bf16 v[148:151], a[204:207], v[220:223], v[148:151]
  ds_read_b128 v[188:191], v18 offset:14336
  v_mfma_f32_16x16x32_bf16 v[152:155], a[208:211], v[220:223], v[152:155]
  v_mfma_f32_16x16x32_bf16 v[156:159], a[212:215], v[220:223], v[156:159]
  s_waitcnt lgkmcnt(4)
  v_mfma_f32_16x16x32_bf16 v[64:67], a[216:219], v[160:163], v[64:67]
  ds_read_b128 v[192:195], v19 offset:0
  v_mfma_f32_16x16x32_bf16 v[68:71], a[220:223], v[160:163], v[68:71]
  v_add_u32 v18, s33, v14
  v_mfma_f32_16x16x32_bf16 v[72:75], a[224:227], v[160:163], v[72:75]
  v_mfma_f32_16x16x32_bf16 v[76:79], a[216:219], v[164:167], v[76:79]
  ds_read_b128 v[196:199], v19 offset:2048
  v_mfma_f32_16x16x32_bf16 v[80:83], a[220:223], v[164:167], v[80:83]
  buffer_load_dwordx4 v12, s[8:11], s30 offen offset:2048 lds
  v_mfma_f32_16x16x32_bf16 v[84:87], a[224:227], v[164:167], v[84:87]
  v_mfma_f32_16x16x32_bf16 v[88:91], a[216:219], v[168:171], v[88:91]
  ds_read_b128 v[200:203], v19 offset:4096
  v_mfma_f32_16x16x32_bf16 v[92:95], a[220:223], v[168:171], v[92:95]
  v_mfma_f32_16x16x32_bf16 v[96:99], a[224:227], v[168:171], v[96:99]
  v_mfma_f32_16x16x32_bf16 v[100:103], a[216:219], v[172:175], v[100:103]
  ds_read_b128 v[204:207], v19 offset:6144
  v_mfma_f32_16x16x32_bf16 v[104:107], a[220:223], v[172:175], v[104:107]
  v_mfma_f32_16x16x32_bf16 v[108:111], a[224:227], v[172:175], v[108:111]
  s_waitcnt lgkmcnt(4)
  v_mfma_f32_16x16x32_bf16 v[112:115], a[216:219], v[176:179], v[112:115]
  ds_read_b128 v[208:211], v19 offset:8192
  v_mfma_f32_16x16x32_bf16 v[116:119], a[220:223], v[176:179], v[116:119]
  v_mfma_f32_16x16x32_bf16 v[120:123], a[224:227], v[176:179], v[120:123]
  v_mfma_f32_16x16x32_bf16 v[124:127], a[216:219], v[180:183], v[124:127]
  ds_read_b128 v[212:215], v19 offset:10240
  v_mfma_f32_16x16x32_bf16 v[128:131], a[220:223], v[180:183], v[128:131]
  buffer_load_dwordx4 v13, s[8:11], s30 offen offset:3072 lds
  v_mfma_f32_16x16x32_bf16 v[132:135], a[224:227], v[180:183], v[132:135]
  s_add_u32 s30, s30, 128
  s_add_u32 m0, m0, 16384
  v_mfma_f32_16x16x32_bf16 v[136:139], a[216:219], v[184:187], v[136:139]
  ds_read_b128 v[216:219], v19 offset:12288
  v_mfma_f32_16x16x32_bf16 v[140:143], a[220:223], v[184:187], v[140:143]
  s_cmp_lt_u32 m0, s46
  s_cselect_b32 m0, m0, s47
  v_mfma_f32_16x16x32_bf16 v[144:147], a[224:227], v[184:187], v[144:147]
  v_mfma_f32_16x16x32_bf16 v[148:151], a[216:219], v[188:191], v[148:151]
  ds_read_b128 v[220:223], v19 offset:14336
  v_mfma_f32_16x16x32_bf16 v[152:155], a[220:223], v[188:191], v[152:155]
  v_mfma_f32_16x16x32_bf16 v[156:159], a[224:227], v[188:191], v[156:159]
  s_waitcnt vmcnt(12) lgkmcnt(4)
  s_barrier
  v_mfma_f32_16x16x32_bf16 v[64:67], a[228:231], v[192:195], v[64:67]
  ds_read_b128 v[160:163], v18 offset:0
  v_mfma_f32_16x16x32_bf16 v[68:71], a[232:235], v[192:195], v[68:71]
  v_mfma_f32_16x16x32_bf16 v[72:75], a[236:239], v[192:195], v[72:75]
  v_add_u32 v19, s33, v15
  s_add_u32 s33, s33, 16384
  v_mfma_f32_16x16x32_bf16 v[76:79], a[228:231], v[196:199], v[76:79]
  ds_read_b128 v[164:167], v18 offset:2048
  v_cvt_pk_bf16_f32 v224, v64, v65
  v_mfma_f32_16x16x32_bf16 v[80:83], a[232:235], v[196:199], v[80:83]
  buffer_load_dwordx4 v10, s[8:11], s30 offen offset:0 lds
  v_mfma_f32_16x16x32_bf16 v[84:87], a[236:239], v[196:199], v[84:87]
  s_cmp_lt_u32 s33, 98304
  s_cselect_b32 s33, s33, 0
  v_mfma_f32_16x16x32_bf16 v[88:91], a[228:231], v[200:203], v[88:91]
  ds_read_b128 v[168:171], v18 offset:4096
  v_cvt_pk_bf16_f32 v225, v66, v67
  v_mfma_f32_16x16x32_bf16 v[92:95], a[232:235], v[200:203], v[92:95]
  v_cvt_pk_bf16_f32 v226, v68, v69
  v_cvt_pk_bf16_f32 v227, v70, v71
  v_mfma_f32_16x16x32_bf16 v[96:99], a[236:239], v[200:203], v[96:99]
  v_cvt_pk_bf16_f32 v228, v72, v73
  v_cvt_pk_bf16_f32 v229, v74, v75
  v_mfma_f32_16x16x32_bf16 v[100:103], a[228:231], v[204:207], v[100:103]
  ds_read_b128 v[172:175], v18 offset:6144
  v_mfma_f32_16x16x32_bf16 v[104:107], a[232:235], v[204:207], v[104:107]
  ds_write_b64 v22, v[224:225] offset:0
  v_mfma_f32_16x16x32_bf16 v[108:111], a[236:239], v[204:207], v[108:111]
  s_waitcnt lgkmcnt(5)
  v_mfma_f32_16x16x32_bf16 v[112:115], a[228:231], v[208:211], v[112:115]
  ds_read_b128 v[176:179], v18 offset:8192
  v_mfma_f32_16x16x32_bf16 v[116:119], a[232:235], v[208:211], v[116:119]
  ds_write_b64 v22, v[226:227] offset:8
  v_mfma_f32_16x16x32_bf16 v[120:123], a[236:239], v[208:211], v[120:123]
  ds_write_b64 v16, v[228:229] offset:64
  v_mfma_f32_16x16x32_bf16 v[124:127], a[228:231], v[212:215], v[124:127]
  ds_read_b128 v[180:183], v18 offset:10240
  v_cvt_pk_bf16_f32 v230, v76, v77
  v_mfma_f32_16x16x32_bf16 v[128:131], a[232:235], v[212:215], v[128:131]
  buffer_load_dwordx4 v11, s[8:11], s30 offen offset:1024 lds
  v_mfma_f32_16x16x32_bf16 v[132:135], a[236:239], v[212:215], v[132:135]
  v_cvt_pk_bf16_f32 v231, v78, v79
  v_cvt_pk_bf16_f32 v232, v80, v81
  v_mfma_f32_16x16x32_bf16 v[136:139], a[228:231], v[216:219], v[136:139]
  ds_read_b128 v[184:187], v18 offset:12288
  v_cvt_pk_bf16_f32 v233, v82, v83
  v_mfma_f32_16x16x32_bf16 v[140:143], a[232:235], v[216:219], v[140:143]
  v_cvt_pk_bf16_f32 v234, v84, v85
  v_cvt_pk_bf16_f32 v235, v86, v87
  v_mfma_f32_16x16x32_bf16 v[144:147], a[236:239], v[216:219], v[144:147]
  ds_write_b64 v22, v[230:231] offset:6400
  v_mfma_f32_16x16x32_bf16 v[148:151], a[228:231], v[220:223], v[148:151]
  ds_read_b128 v[188:191], v18 offset:14336
  v_mfma_f32_16x16x32_bf16 v[152:155], a[232:235], v[220:223], v[152:155]
  ds_write_b64 v22, v[232:233] offset:6408
  v_mfma_f32_16x16x32_bf16 v[156:159], a[236:239], v[220:223], v[156:159]
  s_waitcnt lgkmcnt(9)
kv_end_166:
  s_cmp_gt_u32 s26, 0
  s_cbranch_scc1 kv_blk_165
  s_nop 7
  ds_write_b64 v16, v[234:235] offset:6464
  v_cvt_pk_bf16_f32 v236, v88, v89
  v_cvt_pk_bf16_f32 v237, v90, v91
  v_cvt_pk_bf16_f32 v238, v92, v93
  v_cvt_pk_bf16_f32 v239, v94, v95
  v_cvt_pk_bf16_f32 v240, v96, v97
  v_cvt_pk_bf16_f32 v241, v98, v99
  ds_write_b64 v22, v[236:237] offset:12800
  ds_write_b64 v22, v[238:239] offset:12808
  ds_write_b64 v16, v[240:241] offset:12864
  v_cvt_pk_bf16_f32 v242, v100, v101
  v_cvt_pk_bf16_f32 v243, v102, v103
  v_cvt_pk_bf16_f32 v244, v104, v105
  v_cvt_pk_bf16_f32 v245, v106, v107
  v_cvt_pk_bf16_f32 v246, v108, v109
  v_cvt_pk_bf16_f32 v247, v110, v111
  ds_write_b64 v22, v[242:243] offset:19200
  ds_write_b64 v22, v[244:245] offset:19208
  ds_write_b64 v16, v[246:247] offset:19264
  v_cvt_pk_bf16_f32 v224, v112, v113
  v_cvt_pk_bf16_f32 v225, v114, v115
  v_cvt_pk_bf16_f32 v226, v116, v117
  v_cvt_pk_bf16_f32 v227, v118, v119
  v_cvt_pk_bf16_f32 v228, v120, v121
  v_cvt_pk_bf16_f32 v229, v122, v123
  ds_write_b64 v22, v[224:225] offset:25600
  ds_write_b64 v22, v[226:227] offset:25608
  ds_write_b64 v16, v[228:229] offset:25664
  v_cvt_pk_bf16_f32 v230, v124, v125
  v_cvt_pk_bf16_f32 v231, v126, v127
  v_cvt_pk_bf16_f32 v232, v128, v129
  v_cvt_pk_bf16_f32 v233, v130, v131
  v_cvt_pk_bf16_f32 v234, v132, v133
  v_cvt_pk_bf16_f32 v235, v134, v135
  ds_write_b64 v22, v[230:231] offset:32000
  ds_write_b64 v22, v[232:233] offset:32008
  ds_write_b64 v16, v[234:235] offset:32064
  v_cvt_pk_bf16_f32 v236, v136, v137
  v_cvt_pk_bf16_f32 v237, v138, v139
  v_cvt_pk_bf16_f32 v238, v140, v141
  v_cvt_pk_bf16_f32 v239, v142, v143
  v_cvt_pk_bf16_f32 v240, v144, v145
  v_cvt_pk_bf16_f32 v241, v146, v147
  ds_write_b64 v22, v[236:237] offset:38400
  ds_write_b64 v22, v[238:239] offset:38408
  ds_write_b64 v16, v[240:241] offset:38464
  v_cvt_pk_bf16_f32 v242, v148, v149
  v_cvt_pk_bf16_f32 v243, v150, v151
  v_cvt_pk_bf16_f32 v244, v152, v153
  v_cvt_pk_bf16_f32 v245, v154, v155
  v_cvt_pk_bf16_f32 v246, v156, v157
  v_cvt_pk_bf16_f32 v247, v158, v159
  ds_write_b64 v22, v[242:243] offset:44800
  ds_write_b64 v22, v[244:245] offset:44808
  ds_write_b64 v16, v[246:247] offset:44864
  s_waitcnt vmcnt(0) lgkmcnt(0)
  s_barrier
  ds_read_b128 v[224:227], v23 offset:0
  ds_read_b128 v[228:231], v23 offset:64
  ds_read_b128 v[232:235], v23 offset:128
  ds_read_b128 v[236:239], v23 offset:192
  ds_read_b128 v[240:243], v23 offset:256
  ds_read_b128 v[244:247], v23 offset:320
  s_waitcnt lgkmcnt(0)
  s_add_u32 s21, s48, 0
  buffer_store_dwordx4 v[224:227], v26, s[16:19], s21 offen offset:0 sc1
  buffer_store_dwordx4 v[228:231], v26, s[16:19], s21 offen offset:1024 sc1
  buffer_store_dwordx4 v[232:235], v26, s[16:19], s21 offen offset:2048 sc1
  buffer_store_dwordx4 v[236:239], v26, s[16:19], s21 offen offset:3072 sc1
  s_add_u32 s21, s48, 4096
  buffer_store_dwordx4 v[240:243], v26, s[16:19], s21 offen offset:0 sc1
  buffer_store_dwordx4 v[244:247], v26, s[16:19], s21 offen offset:1024 sc1
  s_nop 1
  ds_read_b128 v[224:227], v23 offset:6400
  ds_read_b128 v[228:231], v23 offset:6464
  ds_read_b128 v[232:235], v23 offset:6528
  ds_read_b128 v[236:239], v23 offset:6592
  ds_read_b128 v[240:243], v23 offset:6656
  ds_read_b128 v[244:247], v23 offset:6720
  s_waitcnt lgkmcnt(0)
  buffer_store_dwordx4 v[224:227], v26, s[16:19], s21 offen offset:2048 sc1
  buffer_store_dwordx4 v[228:231], v26, s[16:19], s21 offen offset:3072 sc1
  s_add_u32 s21, s48, 8192
  buffer_store_dwordx4 v[232:235], v26, s[16:19], s21 offen offset:0 sc1
  buffer_store_dwordx4 v[236:239], v26, s[16:19], s21 offen offset:1024 sc1
  buffer_store_dwordx4 v[240:243], v26, s[16:19], s21 offen offset:2048 sc1
  buffer_store_dwordx4 v[244:247], v26, s[16:19], s21 offen offset:3072 sc1
  s_nop 1
  s_waitcnt vmcnt(0)
  s_barrier
  s_cmp_lg_u32 s20, 0
  s_cbranch_scc1 af_167
  v_mov_b32 v4, 0
  v_mov_b32 v5, 1
  s_mov_b64 exec, 1
  buffer_atomic_add v5, v4, s[72:75], s61 offen sc1
  s_mov_b64 exec, -1
  s_nop 1
af_167:
  s_cmp_lg_u32 s43, 0
  s_cbranch_scc1 kv_fin
  s_mov_b32 s87, -2
  s_add_u32 s21, s42, 32
  s_branch do_opb2
kv_help:
  s_waitcnt vmcnt(0) lgkmcnt(0)
  s_barrier
  s_load_dwordx2 s[4:5], s[0:1], 0
  s_load_dwordx2 s[6:7], s[0:1], 24
  s_load_dwordx2 s[36:37], s[0:1], 32
  s_load_dwordx2 s[38:39], s[0:1], 104
  s_and_b32 s43, s3, 1
  s_bfe_u32 s42, s3, 0x50001
  s_lshr_b32 s40, s42, 2
  s_waitcnt lgkmcnt(0)
  s_cmp_eq_u32 s43, 1
  s_cselect_b32 s6, s36, s6
  s_cselect_b32 s7, s37, s7
  s_mov_b32 s8, s4
  s_mov_b32 s9, s5
  s_mov_b32 s10, 2621440
  s_mov_b32 s11, 0x00020000
  s_mov_b32 s12, s6
  s_mov_b32 s13, s7
  s_mov_b32 s14, 7864320
  s_mov_b32 s15, 0x00020000
  s_mov_b32 s16, s38
  s_mov_b32 s17, s39
  s_mov_b32 s18, 50331648
  s_mov_b32 s19, 0x00020000
  s_mul_i32 s44, s42, 384
  s_mov_b32 s28, 1572864
  s_mov_b32 s43, 2
  s_load_dwordx2 s[6:7], s[0:1], 16
  s_waitcnt lgkmcnt(0)
  s_mov_b32 s12, s6
  s_mov_b32 s13, s7
  s_mov_b32 s14, 7864320
  s_mov_b32 s15, 0x00020000
  s_add_u32 s16, s38, 201326592
  s_addc_u32 s17, s39, 0
  s_mov_b32 s18, 3145728
  s_mov_b32 s19, 0x00020000
  s_mov_b32 s24, 2293760
  s_mov_b32 s25, 163840
  v_mov_b32 v9, 2731
  s_and_b32 s22, s20, 1
  s_lshl_b32 s22, s22, 2
  v_add_u32 v8, 0, v1
  v_mul_u32_u24 v7, v8, v9
  v_lshrrev_b32 v7, 16, v7
  v_mul_u32_u24 v4, 24, v7
  v_sub_u32 v8, v8, v4
  v_and_b32 v4, 2, v7
  v_xor_b32 v8, v8, v4
  v_xor_b32 v8, s22, v8
  v_xor_b32 v5, 4, v8
  s_mov_b32 s21, 12288
  v_mul_lo_u32 v7, v7, s21
  v_lshl_add_u32 v40, v8, 4, v7
  v_lshl_add_u32 v43, v5, 4, v7
  v_add_u32 v8, 64, v1
  v_mul_u32_u24 v7, v8, v9
  v_lshrrev_b32 v7, 16, v7
  v_mul_u32_u24 v4, 24, v7
  v_sub_u32 v8, v8, v4
  v_and_b32 v4, 2, v7
  v_xor_b32 v8, v8, v4
  v_xor_b32 v8, s22, v8
  v_xor_b32 v5, 4, v8
  s_mov_b32 s21, 12288
  v_mul_lo_u32 v7, v7, s21
  v_lshl_add_u32 v41, v8, 4, v7
  v_lshl_add_u32 v44, v5, 4, v7
  v_add_u32 v8, 128, v1
  v_mul_u32_u24 v7, v8, v9
  v_lshrrev_b32 v7, 16, v7
  v_mul_u32_u24 v4, 24, v7
  v_sub_u32 v8, v8, v4
  v_and_b32 v4, 2, v7
  v_xor_b32 v8, v8, v4
  v_xor_b32 v8, s22, v8
  v_xor_b32 v5, 4, v8
  s_mov_b32 s21, 12288
  v_mul_lo_u32 v7, v7, s21
  v_lshl_add_u32 v42, v8, 4, v7
  v_lshl_add_u32 v45, v5, 4, v7
  s_mul_i32 s23, s20, 491520
  s_add_u32 s23, s23, s44
  s_mul_i32 s22, s20, 15360
  s_add_u32 s22, s22, 98304
  s_add_u32 s21, s23, 0
  s_add_u32 m0, s22, 0
  s_nop 0
  buffer_load_dwordx4 v40, s[12:15], s21 offen lds
  s_add_u32 m0, s22, 1024
  s_nop 0
  buffer_load_dwordx4 v41, s[12:15], s21 offen lds
  s_add_u32 m0, s22, 2048
  s_nop 0
  buffer_load_dwordx4 v42, s[12:15], s21 offen lds
  s_add_u32 s21, s23, 98304
  s_add_u32 m0, s22, 3072
  s_nop 0
  buffer_load_dwordx4 v43, s[12:15], s21 offen lds
  s_add_u32 m0, s22, 4096
  s_nop 0
  buffer_load_dwordx4 v44, s[12:15], s21 offen lds
  s_add_u32 m0, s22, 5120
  s_nop 0
  buffer_load_dwordx4 v45, s[12:15], s21 offen lds
  s_add_u32 s21, s23, 196608
  s_add_u32 m0, s22, 6144
  s_nop 0
  buffer_load_dwordx4 v40, s[12:15], s21 offen lds
  s_add_u32 m0, s22, 7168
  s_nop 0
  buffer_load_dwordx4 v41, s[12:15], s21 offen lds
  s_add_u32 m0, s22, 8192
  s_nop 0
  buffer_load_dwordx4 v42, s[12:15], s21 offen lds
  s_add_u32 s21, s23, 294912
  s_add_u32 m0, s22, 9216
  s_nop 0
  buffer_load_dwordx4 v43, s[12:15], s21 offen lds
  s_add_u32 m0, s22, 10240
  s_nop 0
  buffer_load_dwordx4 v44, s[12:15], s21 offen lds
  s_add_u32 m0, s22, 11264
  s_nop 0
  buffer_load_dwordx4 v45, s[12:15], s21 offen lds
  s_add_u32 s21, s23, 393216
  s_add_u32 m0, s22, 12288
  s_nop 0
  buffer_load_dwordx4 v40, s[12:15], s21 offen lds
  s_add_u32 m0, s22, 13312
  s_nop 0
  buffer_load_dwordx4 v41, s[12:15], s21 offen lds
  s_add_u32 m0, s22, 14336
  s_nop 0
  buffer_load_dwordx4 v42, s[12:15], s21 offen lds
  s_add_u32 s21, s23, 1966080
  buffer_load_dwordx4 v[64:67], v40, s[12:15], s21 offen
  buffer_load_dwordx4 v[68:71], v41, s[12:15], s21 offen
  buffer_load_dwordx4 v[72:75], v42, s[12:15], s21 offen
  s_add_u32 s21, s23, 2064384
  buffer_load_dwordx4 v[76:79], v43, s[12:15], s21 offen
  buffer_load_dwordx4 v[80:83], v44, s[12:15], s21 offen
  buffer_load_dwordx4 v[84:87], v45, s[12:15], s21 offen
  s_add_u32 s21, s23, 2162688
  buffer_load_dwordx4 v[88:91], v40, s[12:15], s21 offen
  buffer_load_dwordx4 v[92:95], v41, s[12:15], s21 offen
  buffer_load_dwordx4 v[96:99], v42, s[12:15], s21 offen
  s_add_u32 s21, s23, 2260992
  buffer_load_dwordx4 v[100:103], v43, s[12:15], s21 offen
  buffer_load_dwordx4 v[104:107], v44, s[12:15], s21 offen
  buffer_load_dwordx4 v[108:111], v45, s[12:15], s21 offen
  s_add_u32 s21, s23, 2359296
  buffer_load_dwordx4 v[112:115], v40, s[12:15], s21 offen
  buffer_load_dwordx4 v[116:119], v41, s[12:15], s21 offen
  buffer_load_dwordx4 v[120:123], v42, s[12:15], s21 offen
  s_add_u32 s21, s23, 3932160
  buffer_load_dwordx4 v[124:127], v40, s[12:15], s21 offen
  buffer_load_dwordx4 v[128:131], v41, s[12:15], s21 offen
  buffer_load_dwordx4 v[132:135], v42, s[12:15], s21 offen
  s_add_u32 s21, s23, 4030464
  buffer_load_dwordx4 v[136:139], v43, s[12:15], s21 offen
  buffer_load_dwordx4 v[140:143], v44, s[12:15], s21 offen
  buffer_load_dwordx4 v[144:147], v45, s[12:15], s21 offen
  s_add_u32 s21, s23, 4128768
  buffer_load_dwordx4 v[148:151], v40, s[12:15], s21 offen
  buffer_load_dwordx4 v[152:155], v41, s[12:15], s21 offen
  buffer_load_dwordx4 v[156:159], v42, s[12:15], s21 offen
  s_add_u32 s21, s23, 4227072
  buffer_load_dwordx4 v[160:163], v43, s[12:15], s21 offen
  buffer_load_dwordx4 v[164:167], v44, s[12:15], s21 offen
  buffer_load_dwordx4 v[168:171], v45, s[12:15], s21 offen
  s_add_u32 s21, s23, 4325376
  buffer_load_dwordx4 v[172:175], v40, s[12:15], s21 offen
  buffer_load_dwordx4 v[176:179], v41, s[12:15], s21 offen
  buffer_load_dwordx4 v[180:183], v42, s[12:15], s21 offen
  s_add_u32 s21, s23, 5898240
  buffer_load_dwordx4 v[184:187], v40, s[12:15], s21 offen
  buffer_load_dwordx4 v[188:191], v41, s[12:15], s21 offen
  buffer_load_dwordx4 v[192:195], v42, s[12:15], s21 offen
  s_add_u32 s21, s23, 5996544
  buffer_load_dwordx4 v[196:199], v43, s[12:15], s21 offen
  buffer_load_dwordx4 v[200:203], v44, s[12:15], s21 offen
  buffer_load_dwordx4 v[204:207], v45, s[12:15], s21 offen
  s_add_u32 s21, s23, 6094848
  buffer_load_dwordx4 v[208:211], v40, s[12:15], s21 offen
  buffer_load_dwordx4 v[212:215], v41, s[12:15], s21 offen
  buffer_load_dwordx4 v[216:219], v42, s[12:15], s21 offen
  s_add_u32 s21, s23, 6193152
  buffer_load_dwordx4 v[220:223], v43, s[12:15], s21 offen
  buffer_load_dwordx4 v[224:227], v44, s[12:15], s21 offen
  buffer_load_dwordx4 v[228:231], v45, s[12:15], s21 offen
  s_add_u32 s21, s23, 6291456
  buffer_load_dwordx4 v[232:235], v40, s[12:15], s21 offen
  buffer_load_dwordx4 v[236:239], v41, s[12:15], s21 offen
  buffer_load_dwordx4 v[240:243], v42, s[12:15], s21 offen
  v_lshl_add_u32 v49, v1, 4, s22
  v_lshrrev_b32 v7, 2, v2
  v_and_b32 v4, 2, v7
  v_and_b32 v5, 1, v3
  v_lshl_or_b32 v4, v5, 2, v4
  v_lshl_add_u32 v7, v3, 3, v7
  v_mul_u32_u24 v7, 384, v7
  v_and_b32 v5, 1, v2
  v_lshl_add_u32 v7, v5, 3, v7
  v_add_u32 v7, 98304, v7
  v_bfe_u32 v8, v2, 1, 1
  s_mul_i32 s21, s20, 6
  v_add_u32 v8, s21, v8
  v_add_u32 v5, 0, v8
  v_xor_b32 v5, v5, v4
  v_lshl_add_u32 v46, v5, 4, v7
  v_add_u32 v5, 2, v8
  v_xor_b32 v5, v5, v4
  v_lshl_add_u32 v47, v5, 4, v7
  v_add_u32 v5, 4, v8
  v_xor_b32 v5, v5, v4
  v_lshl_add_u32 v48, v5, 4, v7
  s_waitcnt vmcnt(45)
  s_barrier
  ds_read_b64_tr_b16 a[0:1], v46 offset:0
  ds_read_b64_tr_b16 a[2:3], v46 offset:1536
  ds_read_b64_tr_b16 a[4:5], v47 offset:0
  ds_read_b64_tr_b16 a[6:7], v47 offset:1536
  ds_read_b64_tr_b16 a[8:9], v48 offset:0
  ds_read_b64_tr_b16 a[10:11], v48 offset:1536
  ds_read_b64_tr_b16 a[12:13], v46 offset:12288
  ds_read_b64_tr_b16 a[14:15], v46 offset:13824
  ds_read_b64_tr_b16 a[16:17], v47 offset:12288
  ds_read_b64_tr_b16 a[18:19], v47 offset:13824
  ds_read_b64_tr_b16 a[20:21], v48 offset:12288
  ds_read_b64_tr_b16 a[22:23], v48 offset:13824
  ds_read_b64_tr_b16 a[24:25], v46 offset:24576
  ds_read_b64_tr_b16 a[26:27], v46 offset:26112
  ds_read_b64_tr_b16 a[28:29], v47 offset:24576
  ds_read_b64_tr_b16 a[30:31], v47 offset:26112
  ds_read_b64_tr_b16 a[32:33], v48 offset:24576
  ds_read_b64_tr_b16 a[34:35], v48 offset:26112
  ds_read_b64_tr_b16 a[36:37], v46 offset:36864
  ds_read_b64_tr_b16 a[38:39], v46 offset:38400
  ds_read_b64_tr_b16 a[40:41], v47 offset:36864
  ds_read_b64_tr_b16 a[42:43], v47 offset:38400
  ds_read_b64_tr_b16 a[44:45], v48 offset:36864
  ds_read_b64_tr_b16 a[46:47], v48 offset:38400
  ds_read_b64_tr_b16 a[48:49], v46 offset:49152
  ds_read_b64_tr_b16 a[50:51], v46 offset:50688
  ds_read_b64_tr_b16 a[52:53], v47 offset:49152
  ds_read_b64_tr_b16 a[54:55], v47 offset:50688
  ds_read_b64_tr_b16 a[56:57], v48 offset:49152
  ds_read_b64_tr_b16 a[58:59], v48 offset:50688
  v_lshrrev_b32 v11, 3, v1
  v_and_b32 v12, 7, v1
  v_xor_b32 v12, v12, v11
  v_mul_u32_u24 v11, 1280, v11
  v_lshl_add_u32 v10, v12, 4, v11
  s_mul_i32 s46, s20, 40960
  v_add_u32 v10, s46, v10
  s_lshl_b32 s47, s20, 12
  s_add_u32 s47, s47, 0
  s_add_u32 s46, s47, 98304
  s_mov_b32 s30, s24
  s_add_u32 s32, s47, 32768
  v_add_u32 v11, 9216, v10
  v_add_u32 v12, 18432, v10
  v_add_u32 v13, 27648, v10
  s_mov_b32 m0, s32
  s_nop 0
  buffer_load_dwordx4 v10, s[8:11], s30 offen offset:0 lds
  buffer_load_dwordx4 v11, s[8:11], s30 offen offset:1024 lds
  buffer_load_dwordx4 v12, s[8:11], s30 offen offset:2048 lds
  buffer_load_dwordx4 v13, s[8:11], s30 offen offset:3072 lds
  s_add_u32 s30, s30, 128
  s_add_u32 s32, s32, 16384
  s_cmp_lt_u32 s32, s46
  s_cselect_b32 s32, s32, s47
  s_mov_b32 m0, s32
  s_nop 0
  buffer_load_dwordx4 v10, s[8:11], s30 offen offset:0 lds
  buffer_load_dwordx4 v11, s[8:11], s30 offen offset:1024 lds
  buffer_load_dwordx4 v12, s[8:11], s30 offen offset:2048 lds
  buffer_load_dwordx4 v13, s[8:11], s30 offen offset:3072 lds
  s_add_u32 s30, s30, 128
  s_add_u32 s32, s32, 16384
  s_cmp_lt_u32 s32, s46
  s_cselect_b32 s32, s32, s47
  s_mov_b32 m0, s32
  s_nop 0
  buffer_load_dwordx4 v10, s[8:11], s30 offen offset:0 lds
  buffer_load_dwordx4 v11, s[8:11], s30 offen offset:1024 lds
  buffer_load_dwordx4 v12, s[8:11], s30 offen offset:2048 lds
  buffer_load_dwordx4 v13, s[8:11], s30 offen offset:3072 lds
  s_add_u32 s30, s30, 128
  s_add_u32 s32, s32, 16384
  s_cmp_lt_u32 s32, s46
  s_cselect_b32 s32, s32, s47
  s_mov_b32 m0, s32
  s_nop 0
  buffer_load_dwordx4 v10, s[8:11], s30 offen offset:0 lds
  buffer_load_dwordx4 v11, s[8:11], s30 offen offset:1024 lds
  buffer_load_dwordx4 v12, s[8:11], s30 offen offset:2048 lds
  buffer_load_dwordx4 v13, s[8:11], s30 offen offset:3072 lds
  s_add_u32 s30, s30, 128
  s_add_u32 s32, s32, 16384
  s_cmp_lt_u32 s32, s46
  s_cselect_b32 s32, s32, s47
  s_waitcnt lgkmcnt(0)
  s_barrier
  s_waitcnt vmcnt(46)
  ds_write_b128 v49, v[64:67] offset:0
  ds_write_b128 v49, v[68:71] offset:1024
  ds_write_b128 v49, v[72:75] offset:2048
  ds_write_b128 v49, v[76:79] offset:3072
  ds_write_b128 v49, v[80:83] offset:4096
  ds_write_b128 v49, v[84:87] offset:5120
  ds_write_b128 v49, v[88:91] offset:6144
  ds_write_b128 v49, v[92:95] offset:7168
  ds_write_b128 v49, v[96:99] offset:8192
  ds_write_b128 v49, v[100:103] offset:9216
  ds_write_b128 v49, v[104:107] offset:10240
  ds_write_b128 v49, v[108:111] offset:11264
  ds_write_b128 v49, v[112:115] offset:12288
  ds_write_b128 v49, v[116:119] offset:13312
  ds_write_b128 v49, v[120:123] offset:14336
  s_waitcnt lgkmcnt(0)
  s_barrier
  ds_read_b64_tr_b16 a[60:61], v46 offset:0
  ds_read_b64_tr_b16 a[62:63], v46 offset:1536
  ds_read_b64_tr_b16 a[64:65], v47 offset:0
  ds_read_b64_tr_b16 a[66:67], v47 offset:1536
  ds_read_b64_tr_b16 a[68:69], v48 offset:0
  ds_read_b64_tr_b16 a[70:71], v48 offset:1536
  ds_read_b64_tr_b16 a[72:73], v46 offset:12288
  ds_read_b64_tr_b16 a[74:75], v46 offset:13824
  ds_read_b64_tr_b16 a[76:77], v47 offset:12288
  ds_read_b64_tr_b16 a[78:79], v47 offset:13824
  ds_read_b64_tr_b16 a[80:81], v48 offset:12288
  ds_read_b64_tr_b16 a[82:83], v48 offset:13824
  ds_read_b64_tr_b16 a[84:85], v46 offset:24576
  ds_read_b64_tr_b16 a[86:87], v46 offset:26112
  ds_read_b64_tr_b16 a[88:89], v47 offset:24576
  ds_read_b64_tr_b16 a[90:91], v47 offset:26112
  ds_read_b64_tr_b16 a[92:93], v48 offset:24576
  ds_read_b64_tr_b16 a[94:95], v48 offset:26112
  ds_read_b64_tr_b16 a[96:97], v46 offset:36864
  ds_read_b64_tr_b16 a[98:99], v46 offset:38400
  ds_read_b64_tr_b16 a[100:101], v47 offset:36864
  ds_read_b64_tr_b16 a[102:103], v47 offset:38400
  ds_read_b64_tr_b16 a[104:105], v48 offset:36864
  ds_read_b64_tr_b16 a[106:107], v48 offset:38400
  ds_read_b64_tr_b16 a[108:109], v46 offset:49152
  ds_read_b64_tr_b16 a[110:111], v46 offset:50688
  ds_read_b64_tr_b16 a[112:113], v47 offset:49152
  ds_read_b64_tr_b16 a[114:115], v47 offset:50688
  ds_read_b64_tr_b16 a[116:117], v48 offset:49152
  ds_read_b64_tr_b16 a[118:119], v48 offset:50688
  s_waitcnt lgkmcnt(0)
  s_barrier
  s_waitcnt vmcnt(31)
  ds_write_b128 v49, v[124:127] offset:0
  ds_write_b128 v49, v[128:131] offset:1024
  ds_write_b128 v49, v[132:135] offset:2048
  ds_write_b128 v49, v[136:139] offset:3072
  ds_write_b128 v49, v[140:143] offset:4096
  ds_write_b128 v49, v[144:147] offset:5120
  ds_write_b128 v49, v[148:151] offset:6144
  ds_write_b128 v49, v[152:155] offset:7168
  ds_write_b128 v49, v[156:159] offset:8192
  ds_write_b128 v49, v[160:163] offset:9216
  ds_write_b128 v49, v[164:167] offset:10240
  ds_write_b128 v49, v[168:171] offset:11264
  ds_write_b128 v49, v[172:175] offset:12288
  ds_write_b128 v49, v[176:179] offset:13312
  ds_write_b128 v49, v[180:183] offset:14336
  s_waitcnt lgkmcnt(0)
  s_barrier
  ds_read_b64_tr_b16 a[120:121], v46 offset:0
  ds_read_b64_tr_b16 a[122:123], v46 offset:1536
  ds_read_b64_tr_b16 a[124:125], v47 offset:0
  ds_read_b64_tr_b16 a[126:127], v47 offset:1536
  ds_read_b64_tr_b16 a[128:129], v48 offset:0
  ds_read_b64_tr_b16 a[130:131], v48 offset:1536
  ds_read_b64_tr_b16 a[132:133], v46 offset:12288
  ds_read_b64_tr_b16 a[134:135], v46 offset:13824
  ds_read_b64_tr_b16 a[136:137], v47 offset:12288
  ds_read_b64_tr_b16 a[138:139], v47 offset:13824
  ds_read_b64_tr_b16 a[140:141], v48 offset:12288
  ds_read_b64_tr_b16 a[142:143], v48 offset:13824
  ds_read_b64_tr_b16 a[144:145], v46 offset:24576
  ds_read_b64_tr_b16 a[146:147], v46 offset:26112
  ds_read_b64_tr_b16 a[148:149], v47 offset:24576
  ds_read_b64_tr_b16 a[150:151], v47 offset:26112
  ds_read_b64_tr_b16 a[152:153], v48 offset:24576
  ds_read_b64_tr_b16 a[154:155], v48 offset:26112
  ds_read_b64_tr_b16 a[156:157], v46 offset:36864
  ds_read_b64_tr_b16 a[158:159], v46 offset:38400
  ds_read_b64_tr_b16 a[160:161], v47 offset:36864
  ds_read_b64_tr_b16 a[162:163], v47 offset:38400
  ds_read_b64_tr_b16 a[164:165], v48 offset:36864
  ds_read_b64_tr_b16 a[166:167], v48 offset:38400
  ds_read_b64_tr_b16 a[168:169], v46 offset:49152
  ds_read_b64_tr_b16 a[170:171], v46 offset:50688
  ds_read_b64_tr_b16 a[172:173], v47 offset:49152
  ds_read_b64_tr_b16 a[174:175], v47 offset:50688
  ds_read_b64_tr_b16 a[176:177], v48 offset:49152
  ds_read_b64_tr_b16 a[178:179], v48 offset:50688
  s_waitcnt lgkmcnt(0)
  s_barrier
  s_waitcnt vmcnt(16)
  ds_write_b128 v49, v[184:187] offset:0
  ds_write_b128 v49, v[188:191] offset:1024
  ds_write_b128 v49, v[192:195] offset:2048
  ds_write_b128 v49, v[196:199] offset:3072
  ds_write_b128 v49, v[200:203] offset:4096
  ds_write_b128 v49, v[204:207] offset:5120
  ds_write_b128 v49, v[208:211] offset:6144
  ds_write_b128 v49, v[212:215] offset:7168
  ds_write_b128 v49, v[216:219] offset:8192
  ds_write_b128 v49, v[220:223] offset:9216
  ds_write_b128 v49, v[224:227] offset:10240
  ds_write_b128 v49, v[228:231] offset:11264
  ds_write_b128 v49, v[232:235] offset:12288
  ds_write_b128 v49, v[236:239] offset:13312
  ds_write_b128 v49, v[240:243] offset:14336
  s_waitcnt lgkmcnt(0)
  s_barrier
  ds_read_b64_tr_b16 a[180:181], v46 offset:0
  ds_read_b64_tr_b16 a[182:183], v46 offset:1536
  ds_read_b64_tr_b16 a[184:185], v47 offset:0
  ds_read_b64_tr_b16 a[186:187], v47 offset:1536
  ds_read_b64_tr_b16 a[188:189], v48 offset:0
  ds_read_b64_tr_b16 a[190:191], v48 offset:1536
  ds_read_b64_tr_b16 a[192:193], v46 offset:12288
  ds_read_b64_tr_b16 a[194:195], v46 offset:13824
  ds_read_b64_tr_b16 a[196:197], v47 offset:12288
  ds_read_b64_tr_b16 a[198:199], v47 offset:13824
  ds_read_b64_tr_b16 a[200:201], v48 offset:12288
  ds_read_b64_tr_b16 a[202:203], v48 offset:13824
  ds_read_b64_tr_b16 a[204:205], v46 offset:24576
  ds_read_b64_tr_b16 a[206:207], v46 offset:26112
  ds_read_b64_tr_b16 a[208:209], v47 offset:24576
  ds_read_b64_tr_b16 a[210:211], v47 offset:26112
  ds_read_b64_tr_b16 a[212:213], v48 offset:24576
  ds_read_b64_tr_b16 a[214:215], v48 offset:26112
  ds_read_b64_tr_b16 a[216:217], v46 offset:36864
  ds_read_b64_tr_b16 a[218:219], v46 offset:38400
  ds_read_b64_tr_b16 a[220:221], v47 offset:36864
  ds_read_b64_tr_b16 a[222:223], v47 offset:38400
  ds_read_b64_tr_b16 a[224:225], v48 offset:36864
  ds_read_b64_tr_b16 a[226:227], v48 offset:38400
  ds_read_b64_tr_b16 a[228:229], v46 offset:49152
  ds_read_b64_tr_b16 a[230:231], v46 offset:50688
  ds_read_b64_tr_b16 a[232:233], v47 offset:49152
  ds_read_b64_tr_b16 a[234:235], v47 offset:50688
  ds_read_b64_tr_b16 a[236:237], v48 offset:49152
  ds_read_b64_tr_b16 a[238:239], v48 offset:50688
  s_waitcnt lgkmcnt(0)
  s_barrier
  s_mov_b32 s26, 2
  s_mul_i32 s27, s42, 12288
  s_lshl_b32 s60, s42, 7
  s_add_u32 s60, s60, 112640
  s_mov_b32 s62, 0
  s_branch kv_main
kv_fin:
  s_cmp_eq_u32 s43, 2
  s_cbranch_scc1 q_final
  s_branch queue
not_kv:
  s_cmp_ge_u32 s3, 96
  s_cbranch_scc1 not_vw
  s_sub_u32 s2, s3, 64
  s_load_dwordx2 s[72:73], s[0:1], 104
  s_waitcnt lgkmcnt(0)
  s_add_u32 s72, s72, 81068032
  s_addc_u32 s73, s73, 0
  s_mov_b32 s74, 116736
  s_mov_b32 s75, 0x00020000
  s_add_u32 s8, s38, 78643200
  s_addc_u32 s9, s39, 0
  s_mov_b32 s10, 2162688
  s_mov_b32 s11, 0x00020000
  s_add_u32 s12, s38, 50331648
  s_addc_u32 s13, s39, 0
  s_mov_b32 s14, 12582912
  s_mov_b32 s15, 0x00020000
  s_add_u32 s16, s38, 83886079
  s_addc_u32 s17, s39, 0
  s_and_b32 s16, s16, 0xffe00000
  s_mov_b32 s18, 2097152
  s_mov_b32 s19, 0x00020000
  v_lshlrev_b32 v8, 4, v0
  v_lshlrev_b32 v9, 4, v1
  v_mov_b32 v4, 0
  v_mov_b32 v12, -1
  v_mov_b32 v5, 0
  v_mov_b32 v13, -1
  v_mov_b32 v6, 0
  v_mov_b32 v14, -1
  v_mov_b32 v7, 0
  v_mov_b32 v15, -1
  s_lshl_b32 s21, s2, 12
  buffer_store_dwordx4 v[4:7], v8, s[72:75], s21 offen sc1
  s_lshr_b32 s21, s2, 3
  s_lshl_b32 s21, s21, 15
  s_bfe_u32 s22, s2, 0x10002
  s_lshl_b32 s22, s22, 13
  s_add_u32 s21, s21, s22
  s_bfe_u32 s22, s2, 0x10001
  s_lshl_b32 s22, s22, 14
  s_add_u32 s21, s21, s22
  s_and_b32 s22, s2, 1
  s_mul_i32 s22, s22, 3
  s_add_u32 s22, s22, s20
  s_lshl_b32 s22, s22, 10
  s_add_u32 s21, s21, s22
  s_cmp_lt_u32 s20, 3
  s_cselect_b32 s21, s21, 0x80000000
  buffer_store_dwordx4 v[4:7], v9, s[16:19], s21 offen sc1
  s_mul_i32 s23, s20, 540672
  s_lshl_b32 s21, s2, 11
  s_add_u32 s21, s21, s23
  s_add_u32 s21, s21, 81920
  buffer_store_dwordx4 v[12:15], v9, s[8:11], s21 offen sc1
  buffer_store_dwordx4 v[12:15], v9, s[8:11], s21 offen offset:1024 sc1
  s_mul_i32 s21, s2, 3072
  s_add_u32 s21, s21, s23
  s_add_u32 s21, s21, 278528
  buffer_store_dwordx4 v[12:15], v9, s[8:11], s21 offen sc1
  buffer_store_dwordx4 v[12:15], v9, s[8:11], s21 offen offset:1024 sc1
  buffer_store_dwordx4 v[12:15], v9, s[8:11], s21 offen offset:2048 sc1
  s_lshl_b32 s21, s2, 9
  s_add_u32 s21, s21, s23
  s_add_u32 s21, s21, 376832
  s_mov_b64 exec, 0xffffffff
  buffer_store_dwordx4 v[12:15], v9, s[8:11], s21 offen sc1
  s_mov_b64 exec, -1
  s_lshl_b32 s21, s20, 5
  s_add_u32 s21, s21, s2
  s_mul_i32 s21, s21, 3072
  s_cmp_lt_u32 s20, 3
  s_cselect_b32 s21, s21, 0x80000000
  s_add_u32 s22, s21, 6291456
  buffer_store_dwordx4 v[12:15], v9, s[12:15], s21 offen offset:0 sc1
  buffer_store_dwordx4 v[12:15], v9, s[12:15], s22 offen offset:0 sc1
  buffer_store_dwordx4 v[12:15], v9, s[12:15], s21 offen offset:1024 sc1
  buffer_store_dwordx4 v[12:15], v9, s[12:15], s22 offen offset:1024 sc1
  buffer_store_dwordx4 v[12:15], v9, s[12:15], s21 offen offset:2048 sc1
  buffer_store_dwordx4 v[12:15], v9, s[12:15], s22 offen offset:2048 sc1
  s_waitcnt vmcnt(0)
  s_barrier
  s_mov_b32 s21, 76
  s_cmp_lg_u32 s20, 0
  s_cbranch_scc1 af_168
  v_mov_b32 v10, 0
  v_mov_b32 v11, 1
  s_mov_b64 exec, 1
  buffer_atomic_add v11, v10, s[32:35], s21 offen sc1
  s_mov_b64 exec, -1
  s_nop 1
af_168:
  s_load_dwordx2 s[6:7], s[0:1], 40
  s_load_dwordx2 s[38:39], s[0:1], 104
  s_waitcnt lgkmcnt(0)
  s_mov_b32 s12, s6
  s_mov_b32 s13, s7
  s_mov_b32 s14, 7864320
  s_mov_b32 s15, 0x00020000
  s_mov_b32 s16, s38
  s_mov_b32 s17, s39
  s_mov_b32 s18, 50331648
  s_mov_b32 s19, 0x00020000
  s_add_u32 s24, s38, 114294784
  s_addc_u32 s25, s39, 0
  s_mov_b32 s26, 83886080
  s_mov_b32 s27, 0x00020000
  s_load_dwordx2 s[72:73], s[0:1], 104
  s_waitcnt lgkmcnt(0)
  s_add_u32 s72, s72, 81068032
  s_addc_u32 s73, s73, 0
  s_mov_b32 s74, 116736
  s_mov_b32 s75, 0x00020000
  v_mov_b32 v29, 52429
  s_mul_i32 s21, s20, 960
  s_add_u32 s21, s21, 0
  v_add_u32 v21, s21, v1
  v_mul_u32_u24 v22, v21, v29
  v_lshrrev_b32 v22, 22, v22
  v_mul_u32_u24 v23, 80, v22
  v_sub_u32 v21, v21, v23
  v_bfe_u32 v23, v22, 3, 1
  v_and_b32 v24, 3, v22
  v_lshl_add_u32 v23, v23, 2, v24
  v_lshlrev_b32 v23, 1, v23
  v_xor_b32 v21, v21, v23
  v_cmp_gt_u32 vcc, 32, v22
  v_bfe_u32 v26, v22, 3, 2
  v_lshl_add_u32 v25, v26, 2, v24
  v_bfe_u32 v26, v22, 2, 1
  v_lshl_add_u32 v25, v26, 4, v25
  v_cndmask_b32 v25, v22, v25, vcc
  v_mul_u32_u24 v25, 1280, v25
  v_lshl_add_u32 v64, v21, 4, v25
  s_mul_i32 s21, s20, 960
  s_add_u32 s21, s21, 64
  v_add_u32 v21, s21, v1
  v_mul_u32_u24 v22, v21, v29
  v_lshrrev_b32 v22, 22, v22
  v_mul_u32_u24 v23, 80, v22
  v_sub_u32 v21, v21, v23
  v_bfe_u32 v23, v22, 3, 1
  v_and_b32 v24, 3, v22
  v_lshl_add_u32 v23, v23, 2, v24
  v_lshlrev_b32 v23, 1, v23
  v_xor_b32 v21, v21, v23
  v_cmp_gt_u32 vcc, 32, v22
  v_bfe_u32 v26, v22, 3, 2
  v_lshl_add_u32 v25, v26, 2, v24
  v_bfe_u32 v26, v22, 2, 1
  v_lshl_add_u32 v25, v26, 4, v25
  v_cndmask_b32 v25, v22, v25, vcc
  v_mul_u32_u24 v25, 1280, v25
  v_lshl_add_u32 v65, v21, 4, v25
  s_mul_i32 s21, s20, 960
  s_add_u32 s21, s21, 128
  v_add_u32 v21, s21, v1
  v_mul_u32_u24 v22, v21, v29
  v_lshrrev_b32 v22, 22, v22
  v_mul_u32_u24 v23, 80, v22
  v_sub_u32 v21, v21, v23
  v_bfe_u32 v23, v22, 3, 1
  v_and_b32 v24, 3, v22
  v_lshl_add_u32 v23, v23, 2, v24
  v_lshlrev_b32 v23, 1, v23
  v_xor_b32 v21, v21, v23
  v_cmp_gt_u32 vcc, 32, v22
  v_bfe_u32 v26, v22, 3, 2
  v_lshl_add_u32 v25, v26, 2, v24
  v_bfe_u32 v26, v22, 2, 1
  v_lshl_add_u32 v25, v26, 4, v25
  v_cndmask_b32 v25, v22, v25, vcc
  v_mul_u32_u24 v25, 1280, v25
  v_lshl_add_u32 v66, v21, 4, v25
  s_mul_i32 s21, s20, 960
  s_add_u32 s21, s21, 192
  v_add_u32 v21, s21, v1
  v_mul_u32_u24 v22, v21, v29
  v_lshrrev_b32 v22, 22, v22
  v_mul_u32_u24 v23, 80, v22
  v_sub_u32 v21, v21, v23
  v_bfe_u32 v23, v22, 3, 1
  v_and_b32 v24, 3, v22
  v_lshl_add_u32 v23, v23, 2, v24
  v_lshlrev_b32 v23, 1, v23
  v_xor_b32 v21, v21, v23
  v_cmp_gt_u32 vcc, 32, v22
  v_bfe_u32 v26, v22, 3, 2
  v_lshl_add_u32 v25, v26, 2, v24
  v_bfe_u32 v26, v22, 2, 1
  v_lshl_add_u32 v25, v26, 4, v25
  v_cndmask_b32 v25, v22, v25, vcc
  v_mul_u32_u24 v25, 1280, v25
  v_lshl_add_u32 v67, v21, 4, v25
  s_mul_i32 s21, s20, 960
  s_add_u32 s21, s21, 256
  v_add_u32 v21, s21, v1
  v_mul_u32_u24 v22, v21, v29
  v_lshrrev_b32 v22, 22, v22
  v_mul_u32_u24 v23, 80, v22
  v_sub_u32 v21, v21, v23
  v_bfe_u32 v23, v22, 3, 1
  v_and_b32 v24, 3, v22
  v_lshl_add_u32 v23, v23, 2, v24
  v_lshlrev_b32 v23, 1, v23
  v_xor_b32 v21, v21, v23
  v_cmp_gt_u32 vcc, 32, v22
  v_bfe_u32 v26, v22, 3, 2
  v_lshl_add_u32 v25, v26, 2, v24
  v_bfe_u32 v26, v22, 2, 1
  v_lshl_add_u32 v25, v26, 4, v25
  v_cndmask_b32 v25, v22, v25, vcc
  v_mul_u32_u24 v25, 1280, v25
  v_lshl_add_u32 v68, v21, 4, v25
  s_mul_i32 s21, s20, 960
  s_add_u32 s21, s21, 320
  v_add_u32 v21, s21, v1
  v_mul_u32_u24 v22, v21, v29
  v_lshrrev_b32 v22, 22, v22
  v_mul_u32_u24 v23, 80, v22
  v_sub_u32 v21, v21, v23
  v_bfe_u32 v23, v22, 3, 1
  v_and_b32 v24, 3, v22
  v_lshl_add_u32 v23, v23, 2, v24
  v_lshlrev_b32 v23, 1, v23
  v_xor_b32 v21, v21, v23
  v_cmp_gt_u32 vcc, 32, v22
  v_bfe_u32 v26, v22, 3, 2
  v_lshl_add_u32 v25, v26, 2, v24
  v_bfe_u32 v26, v22, 2, 1
  v_lshl_add_u32 v25, v26, 4, v25
  v_cndmask_b32 v25, v22, v25, vcc
  v_mul_u32_u24 v25, 1280, v25
  v_lshl_add_u32 v69, v21, 4, v25
  s_mul_i32 s21, s20, 960
  s_add_u32 s21, s21, 384
  v_add_u32 v21, s21, v1
  v_mul_u32_u24 v22, v21, v29
  v_lshrrev_b32 v22, 22, v22
  v_mul_u32_u24 v23, 80, v22
  v_sub_u32 v21, v21, v23
  v_bfe_u32 v23, v22, 3, 1
  v_and_b32 v24, 3, v22
  v_lshl_add_u32 v23, v23, 2, v24
  v_lshlrev_b32 v23, 1, v23
  v_xor_b32 v21, v21, v23
  v_cmp_gt_u32 vcc, 32, v22
  v_bfe_u32 v26, v22, 3, 2
  v_lshl_add_u32 v25, v26, 2, v24
  v_bfe_u32 v26, v22, 2, 1
  v_lshl_add_u32 v25, v26, 4, v25
  v_cndmask_b32 v25, v22, v25, vcc
  v_mul_u32_u24 v25, 1280, v25
  v_lshl_add_u32 v70, v21, 4, v25
  s_mul_i32 s21, s20, 960
  s_add_u32 s21, s21, 448
  v_add_u32 v21, s21, v1
  v_mul_u32_u24 v22, v21, v29
  v_lshrrev_b32 v22, 22, v22
  v_mul_u32_u24 v23, 80, v22
  v_sub_u32 v21, v21, v23
  v_bfe_u32 v23, v22, 3, 1
  v_and_b32 v24, 3, v22
  v_lshl_add_u32 v23, v23, 2, v24
  v_lshlrev_b32 v23, 1, v23
  v_xor_b32 v21, v21, v23
  v_cmp_gt_u32 vcc, 32, v22
  v_bfe_u32 v26, v22, 3, 2
  v_lshl_add_u32 v25, v26, 2, v24
  v_bfe_u32 v26, v22, 2, 1
  v_lshl_add_u32 v25, v26, 4, v25
  v_cndmask_b32 v25, v22, v25, vcc
  v_mul_u32_u24 v25, 1280, v25
  v_lshl_add_u32 v71, v21, 4, v25
  s_mul_i32 s21, s20, 960
  s_add_u32 s21, s21, 512
  v_add_u32 v21, s21, v1
  v_mul_u32_u24 v22, v21, v29
  v_lshrrev_b32 v22, 22, v22
  v_mul_u32_u24 v23, 80, v22
  v_sub_u32 v21, v21, v23
  v_bfe_u32 v23, v22, 3, 1
  v_and_b32 v24, 3, v22
  v_lshl_add_u32 v23, v23, 2, v24
  v_lshlrev_b32 v23, 1, v23
  v_xor_b32 v21, v21, v23
  v_cmp_gt_u32 vcc, 32, v22
  v_bfe_u32 v26, v22, 3, 2
  v_lshl_add_u32 v25, v26, 2, v24
  v_bfe_u32 v26, v22, 2, 1
  v_lshl_add_u32 v25, v26, 4, v25
  v_cndmask_b32 v25, v22, v25, vcc
  v_mul_u32_u24 v25, 1280, v25
  v_lshl_add_u32 v72, v21, 4, v25
  s_mul_i32 s21, s20, 960
  s_add_u32 s21, s21, 576
  v_add_u32 v21, s21, v1
  v_mul_u32_u24 v22, v21, v29
  v_lshrrev_b32 v22, 22, v22
  v_mul_u32_u24 v23, 80, v22
  v_sub_u32 v21, v21, v23
  v_bfe_u32 v23, v22, 3, 1
  v_and_b32 v24, 3, v22
  v_lshl_add_u32 v23, v23, 2, v24
  v_lshlrev_b32 v23, 1, v23
  v_xor_b32 v21, v21, v23
  v_cmp_gt_u32 vcc, 32, v22
  v_bfe_u32 v26, v22, 3, 2
  v_lshl_add_u32 v25, v26, 2, v24
  v_bfe_u32 v26, v22, 2, 1
  v_lshl_add_u32 v25, v26, 4, v25
  v_cndmask_b32 v25, v22, v25, vcc
  v_mul_u32_u24 v25, 1280, v25
  v_lshl_add_u32 v73, v21, 4, v25
  s_mul_i32 s21, s20, 960
  s_add_u32 s21, s21, 640
  v_add_u32 v21, s21, v1
  v_mul_u32_u24 v22, v21, v29
  v_lshrrev_b32 v22, 22, v22
  v_mul_u32_u24 v23, 80, v22
  v_sub_u32 v21, v21, v23
  v_bfe_u32 v23, v22, 3, 1
  v_and_b32 v24, 3, v22
  v_lshl_add_u32 v23, v23, 2, v24
  v_lshlrev_b32 v23, 1, v23
  v_xor_b32 v21, v21, v23
  v_cmp_gt_u32 vcc, 32, v22
  v_bfe_u32 v26, v22, 3, 2
  v_lshl_add_u32 v25, v26, 2, v24
  v_bfe_u32 v26, v22, 2, 1
  v_lshl_add_u32 v25, v26, 4, v25
  v_cndmask_b32 v25, v22, v25, vcc
  v_mul_u32_u24 v25, 1280, v25
  v_lshl_add_u32 v74, v21, 4, v25
  s_mul_i32 s21, s20, 960
  s_add_u32 s21, s21, 704
  v_add_u32 v21, s21, v1
  v_mul_u32_u24 v22, v21, v29
  v_lshrrev_b32 v22, 22, v22
  v_mul_u32_u24 v23, 80, v22
  v_sub_u32 v21, v21, v23
  v_bfe_u32 v23, v22, 3, 1
  v_and_b32 v24, 3, v22
  v_lshl_add_u32 v23, v23, 2, v24
  v_lshlrev_b32 v23, 1, v23
  v_xor_b32 v21, v21, v23
  v_cmp_gt_u32 vcc, 32, v22
  v_bfe_u32 v26, v22, 3, 2
  v_lshl_add_u32 v25, v26, 2, v24
  v_bfe_u32 v26, v22, 2, 1
  v_lshl_add_u32 v25, v26, 4, v25
  v_cndmask_b32 v25, v22, v25, vcc
  v_mul_u32_u24 v25, 1280, v25
  v_lshl_add_u32 v75, v21, 4, v25
  s_mul_i32 s21, s20, 960
  s_add_u32 s21, s21, 768
  v_add_u32 v21, s21, v1
  v_mul_u32_u24 v22, v21, v29
  v_lshrrev_b32 v22, 22, v22
  v_mul_u32_u24 v23, 80, v22
  v_sub_u32 v21, v21, v23
  v_bfe_u32 v23, v22, 3, 1
  v_and_b32 v24, 3, v22
  v_lshl_add_u32 v23, v23, 2, v24
  v_lshlrev_b32 v23, 1, v23
  v_xor_b32 v21, v21, v23
  v_cmp_gt_u32 vcc, 32, v22
  v_bfe_u32 v26, v22, 3, 2
  v_lshl_add_u32 v25, v26, 2, v24
  v_bfe_u32 v26, v22, 2, 1
  v_lshl_add_u32 v25, v26, 4, v25
  v_cndmask_b32 v25, v22, v25, vcc
  v_mul_u32_u24 v25, 1280, v25
  v_lshl_add_u32 v76, v21, 4, v25
  s_mul_i32 s21, s20, 960
  s_add_u32 s21, s21, 832
  v_add_u32 v21, s21, v1
  v_mul_u32_u24 v22, v21, v29
  v_lshrrev_b32 v22, 22, v22
  v_mul_u32_u24 v23, 80, v22
  v_sub_u32 v21, v21, v23
  v_bfe_u32 v23, v22, 3, 1
  v_and_b32 v24, 3, v22
  v_lshl_add_u32 v23, v23, 2, v24
  v_lshlrev_b32 v23, 1, v23
  v_xor_b32 v21, v21, v23
  v_cmp_gt_u32 vcc, 32, v22
  v_bfe_u32 v26, v22, 3, 2
  v_lshl_add_u32 v25, v26, 2, v24
  v_bfe_u32 v26, v22, 2, 1
  v_lshl_add_u32 v25, v26, 4, v25
  v_cndmask_b32 v25, v22, v25, vcc
  v_mul_u32_u24 v25, 1280, v25
  v_lshl_add_u32 v77, v21, 4, v25
  s_mul_i32 s21, s20, 960
  s_add_u32 s21, s21, 896
  v_add_u32 v21, s21, v1
  v_mul_u32_u24 v22, v21, v29
  v_lshrrev_b32 v22, 22, v22
  v_mul_u32_u24 v23, 80, v22
  v_sub_u32 v21, v21, v23
  v_bfe_u32 v23, v22, 3, 1
  v_and_b32 v24, 3, v22
  v_lshl_add_u32 v23, v23, 2, v24
  v_lshlrev_b32 v23, 1, v23
  v_xor_b32 v21, v21, v23
  v_cmp_gt_u32 vcc, 32, v22
  v_bfe_u32 v26, v22, 3, 2
  v_lshl_add_u32 v25, v26, 2, v24
  v_bfe_u32 v26, v22, 2, 1
  v_lshl_add_u32 v25, v26, 4, v25
  v_cndmask_b32 v25, v22, v25, vcc
  v_mul_u32_u24 v25, 1280, v25
  v_lshl_add_u32 v78, v21, 4, v25
  s_mul_i32 s40, s2, 245760
  s_sleep 32
  s_add_u32 s21, s40, 0
  s_mul_i32 s22, s20, 15360
  s_add_u32 s22, s22, 0
  s_add_u32 m0, s22, 0
  s_nop 0
  buffer_load_dwordx4 v64, s[12:15], s21 offen lds
  s_add_u32 m0, s22, 1024
  s_nop 0
  buffer_load_dwordx4 v65, s[12:15], s21 offen lds
  s_add_u32 m0, s22, 2048
  s_nop 0
  buffer_load_dwordx4 v66, s[12:15], s21 offen lds
  s_add_u32 m0, s22, 3072
  s_nop 0
  buffer_load_dwordx4 v67, s[12:15], s21 offen lds
  s_add_u32 m0, s22, 4096
  s_nop 0
  buffer_load_dwordx4 v68, s[12:15], s21 offen lds
  s_add_u32 m0, s22, 5120
  s_nop 0
  buffer_load_dwordx4 v69, s[12:15], s21 offen lds
  s_add_u32 m0, s22, 6144
  s_nop 0
  buffer_load_dwordx4 v70, s[12:15], s21 offen lds
  s_add_u32 m0, s22, 7168
  s_nop 0
  buffer_load_dwordx4 v71, s[12:15], s21 offen lds
  s_add_u32 m0, s22, 8192
  s_nop 0
  buffer_load_dwordx4 v72, s[12:15], s21 offen lds
  s_add_u32 m0, s22, 9216
  s_nop 0
  buffer_load_dwordx4 v73, s[12:15], s21 offen lds
  s_add_u32 m0, s22, 10240
  s_nop 0
  buffer_load_dwordx4 v74, s[12:15], s21 offen lds
  s_add_u32 m0, s22, 11264
  s_nop 0
  buffer_load_dwordx4 v75, s[12:15], s21 offen lds
  s_add_u32 m0, s22, 12288
  s_nop 0
  buffer_load_dwordx4 v76, s[12:15], s21 offen lds
  s_add_u32 m0, s22, 13312
  s_nop 0
  buffer_load_dwordx4 v77, s[12:15], s21 offen lds
  s_add_u32 m0, s22, 14336
  s_nop 0
  buffer_load_dwordx4 v78, s[12:15], s21 offen lds
  s_add_u32 s21, s40, 61440
  s_mul_i32 s22, s20, 15360
  s_add_u32 s22, s22, 61440
  s_add_u32 m0, s22, 0
  s_nop 0
  buffer_load_dwordx4 v64, s[12:15], s21 offen lds
  s_add_u32 m0, s22, 1024
  s_nop 0
  buffer_load_dwordx4 v65, s[12:15], s21 offen lds
  s_add_u32 m0, s22, 2048
  s_nop 0
  buffer_load_dwordx4 v66, s[12:15], s21 offen lds
  s_add_u32 m0, s22, 3072
  s_nop 0
  buffer_load_dwordx4 v67, s[12:15], s21 offen lds
  s_add_u32 m0, s22, 4096
  s_nop 0
  buffer_load_dwordx4 v68, s[12:15], s21 offen lds
  s_add_u32 m0, s22, 5120
  s_nop 0
  buffer_load_dwordx4 v69, s[12:15], s21 offen lds
  s_add_u32 m0, s22, 6144
  s_nop 0
  buffer_load_dwordx4 v70, s[12:15], s21 offen lds
  s_add_u32 m0, s22, 7168
  s_nop 0
  buffer_load_dwordx4 v71, s[12:15], s21 offen lds
  s_add_u32 m0, s22, 8192
  s_nop 0
  buffer_load_dwordx4 v72, s[12:15], s21 offen lds
  s_add_u32 m0, s22, 9216
  s_nop 0
  buffer_load_dwordx4 v73, s[12:15], s21 offen lds
  s_add_u32 m0, s22, 10240
  s_nop 0
  buffer_load_dwordx4 v74, s[12:15], s21 offen lds
  s_add_u32 m0, s22, 11264
  s_nop 0
  buffer_load_dwordx4 v75, s[12:15], s21 offen lds
  s_add_u32 m0, s22, 12288
  s_nop 0
  buffer_load_dwordx4 v76, s[12:15], s21 offen lds
  s_add_u32 m0, s22, 13312
  s_nop 0
  buffer_load_dwordx4 v77, s[12:15], s21 offen lds
  s_add_u32 m0, s22, 14336
  s_nop 0
  buffer_load_dwordx4 v78, s[12:15], s21 offen lds
  s_add_u32 s21, s40, 122880
  s_mul_i32 s22, s20, 15360
  s_add_u32 s22, s22, 0
  buffer_load_dwordx4 v[80:83], v64, s[12:15], s21 offen
  buffer_load_dwordx4 v[84:87], v65, s[12:15], s21 offen
  buffer_load_dwordx4 v[88:91], v66, s[12:15], s21 offen
  buffer_load_dwordx4 v[92:95], v67, s[12:15], s21 offen
  buffer_load_dwordx4 v[96:99], v68, s[12:15], s21 offen
  buffer_load_dwordx4 v[100:103], v69, s[12:15], s21 offen
  buffer_load_dwordx4 v[104:107], v70, s[12:15], s21 offen
  buffer_load_dwordx4 v[108:111], v71, s[12:15], s21 offen
  buffer_load_dwordx4 v[112:115], v72, s[12:15], s21 offen
  buffer_load_dwordx4 v[116:119], v73, s[12:15], s21 offen
  buffer_load_dwordx4 v[120:123], v74, s[12:15], s21 offen
  buffer_load_dwordx4 v[124:127], v75, s[12:15], s21 offen
  buffer_load_dwordx4 v[128:131], v76, s[12:15], s21 offen
  buffer_load_dwordx4 v[132:135], v77, s[12:15], s21 offen
  buffer_load_dwordx4 v[136:139], v78, s[12:15], s21 offen
  s_add_u32 s21, s40, 184320
  s_mul_i32 s22, s20, 15360
  s_add_u32 s22, s22, 61440
  buffer_load_dwordx4 v[140:143], v64, s[12:15], s21 offen
  buffer_load_dwordx4 v[144:147], v65, s[12:15], s21 offen
  buffer_load_dwordx4 v[148:151], v66, s[12:15], s21 offen
  buffer_load_dwordx4 v[152:155], v67, s[12:15], s21 offen
  buffer_load_dwordx4 v[156:159], v68, s[12:15], s21 offen
  buffer_load_dwordx4 v[160:163], v69, s[12:15], s21 offen
  buffer_load_dwordx4 v[164:167], v70, s[12:15], s21 offen
  buffer_load_dwordx4 v[168:171], v71, s[12:15], s21 offen
  buffer_load_dwordx4 v[172:175], v72, s[12:15], s21 offen
  buffer_load_dwordx4 v[176:179], v73, s[12:15], s21 offen
  buffer_load_dwordx4 v[180:183], v74, s[12:15], s21 offen
  buffer_load_dwordx4 v[184:187], v75, s[12:15], s21 offen
  buffer_load_dwordx4 v[188:191], v76, s[12:15], s21 offen
  buffer_load_dwordx4 v[192:195], v77, s[12:15], s21 offen
  buffer_load_dwordx4 v[196:199], v78, s[12:15], s21 offen
  v_lshrrev_b32 v6, 2, v2
  v_lshl_add_u32 v7, v3, 3, v6
  v_mul_u32_u24 v7, 1280, v7
  v_and_b32 v8, 1, v2
  v_lshl_add_u32 v7, v8, 3, v7
  v_and_b32 v8, 1, v3
  v_lshl_add_u32 v6, v8, 2, v6
  v_lshlrev_b32 v6, 1, v6
  v_bfe_u32 v8, v2, 1, 1
  s_mul_i32 s21, s20, 20
  v_add_u32 v8, s21, v8
  v_add_u32 v5, 0, v8
  v_xor_b32 v5, v5, v6
  v_lshl_add_u32 v200, v5, 4, v7
  v_add_u32 v210, 81920, v200
  v_add_u32 v5, 2, v8
  v_xor_b32 v5, v5, v6
  v_lshl_add_u32 v201, v5, 4, v7
  v_add_u32 v211, 81920, v201
  v_add_u32 v5, 4, v8
  v_xor_b32 v5, v5, v6
  v_lshl_add_u32 v202, v5, 4, v7
  v_add_u32 v212, 81920, v202
  v_add_u32 v5, 6, v8
  v_xor_b32 v5, v5, v6
  v_lshl_add_u32 v203, v5, 4, v7
  v_add_u32 v213, 81920, v203
  v_add_u32 v5, 8, v8
  v_xor_b32 v5, v5, v6
  v_lshl_add_u32 v204, v5, 4, v7
  v_add_u32 v214, 81920, v204
  v_add_u32 v5, 10, v8
  v_xor_b32 v5, v5, v6
  v_lshl_add_u32 v205, v5, 4, v7
  v_add_u32 v215, 81920, v205
  v_add_u32 v5, 12, v8
  v_xor_b32 v5, v5, v6
  v_lshl_add_u32 v206, v5, 4, v7
  v_add_u32 v216, 81920, v206
  v_add_u32 v5, 14, v8
  v_xor_b32 v5, v5, v6
  v_lshl_add_u32 v207, v5, 4, v7
  v_add_u32 v217, 81920, v207
  v_add_u32 v5, 16, v8
  v_xor_b32 v5, v5, v6
  v_lshl_add_u32 v208, v5, 4, v7
  v_add_u32 v218, 81920, v208
  v_add_u32 v5, 18, v8
  v_xor_b32 v5, v5, v6
  v_lshl_add_u32 v209, v5, 4, v7
  v_add_u32 v219, 81920, v209
  s_mul_i32 s22, s20, 15360
  v_lshl_add_u32 v30, v1, 4, s22
  v_add_u32 v31, 61440, v30
  s_waitcnt vmcnt(30)
  s_barrier
  ds_read_b64_tr_b16 a[0:1], v200 offset:0
  ds_read_b64_tr_b16 a[2:3], v200 offset:5120
  ds_read_b64_tr_b16 a[24:25], v201 offset:0
  ds_read_b64_tr_b16 a[26:27], v201 offset:5120
  ds_read_b64_tr_b16 a[48:49], v202 offset:0
  ds_read_b64_tr_b16 a[50:51], v202 offset:5120
  ds_read_b64_tr_b16 a[72:73], v203 offset:0
  ds_read_b64_tr_b16 a[74:75], v203 offset:5120
  ds_read_b64_tr_b16 a[96:97], v204 offset:0
  ds_read_b64_tr_b16 a[98:99], v204 offset:5120
  ds_read_b64_tr_b16 a[120:121], v205 offset:0
  ds_read_b64_tr_b16 a[122:123], v205 offset:5120
  ds_read_b64_tr_b16 a[144:145], v206 offset:0
  ds_read_b64_tr_b16 a[146:147], v206 offset:5120
  ds_read_b64_tr_b16 a[168:169], v207 offset:0
  ds_read_b64_tr_b16 a[170:171], v207 offset:5120
  ds_read_b64_tr_b16 a[192:193], v208 offset:0
  ds_read_b64_tr_b16 a[194:195], v208 offset:5120
  ds_read_b64_tr_b16 a[216:217], v209 offset:0
  ds_read_b64_tr_b16 a[218:219], v209 offset:5120
  ds_read_b64_tr_b16 a[4:5], v200 offset:40960
  ds_read_b64_tr_b16 a[6:7], v200 offset:46080
  ds_read_b64_tr_b16 a[28:29], v201 offset:40960
  ds_read_b64_tr_b16 a[30:31], v201 offset:46080
  ds_read_b64_tr_b16 a[52:53], v202 offset:40960
  ds_read_b64_tr_b16 a[54:55], v202 offset:46080
  ds_read_b64_tr_b16 a[76:77], v203 offset:40960
  ds_read_b64_tr_b16 a[78:79], v203 offset:46080
  ds_read_b64_tr_b16 a[100:101], v204 offset:40960
  ds_read_b64_tr_b16 a[102:103], v204 offset:46080
  ds_read_b64_tr_b16 a[124:125], v205 offset:40960
  ds_read_b64_tr_b16 a[126:127], v205 offset:46080
  ds_read_b64_tr_b16 a[148:149], v206 offset:40960
  ds_read_b64_tr_b16 a[150:151], v206 offset:46080
  ds_read_b64_tr_b16 a[172:173], v207 offset:40960
  ds_read_b64_tr_b16 a[174:175], v207 offset:46080
  ds_read_b64_tr_b16 a[196:197], v208 offset:40960
  ds_read_b64_tr_b16 a[198:199], v208 offset:46080
  ds_read_b64_tr_b16 a[220:221], v209 offset:40960
  ds_read_b64_tr_b16 a[222:223], v209 offset:46080
  ds_read_b64_tr_b16 a[8:9], v210 offset:0
  ds_read_b64_tr_b16 a[10:11], v210 offset:5120
  ds_read_b64_tr_b16 a[32:33], v211 offset:0
  ds_read_b64_tr_b16 a[34:35], v211 offset:5120
  ds_read_b64_tr_b16 a[56:57], v212 offset:0
  ds_read_b64_tr_b16 a[58:59], v212 offset:5120
  ds_read_b64_tr_b16 a[80:81], v213 offset:0
  ds_read_b64_tr_b16 a[82:83], v213 offset:5120
  ds_read_b64_tr_b16 a[104:105], v214 offset:0
  ds_read_b64_tr_b16 a[106:107], v214 offset:5120
  ds_read_b64_tr_b16 a[128:129], v215 offset:0
  ds_read_b64_tr_b16 a[130:131], v215 offset:5120
  ds_read_b64_tr_b16 a[152:153], v216 offset:0
  ds_read_b64_tr_b16 a[154:155], v216 offset:5120
  ds_read_b64_tr_b16 a[176:177], v217 offset:0
  ds_read_b64_tr_b16 a[178:179], v217 offset:5120
  ds_read_b64_tr_b16 a[200:201], v218 offset:0
  ds_read_b64_tr_b16 a[202:203], v218 offset:5120
  ds_read_b64_tr_b16 a[224:225], v219 offset:0
  ds_read_b64_tr_b16 a[226:227], v219 offset:5120
  s_waitcnt lgkmcnt(0)
  s_barrier
  s_waitcnt vmcnt(15)
  ds_write_b128 v30, v[80:83] offset:0
  ds_write_b128 v30, v[84:87] offset:1024
  ds_write_b128 v30, v[88:91] offset:2048
  ds_write_b128 v30, v[92:95] offset:3072
  ds_write_b128 v30, v[96:99] offset:4096
  ds_write_b128 v30, v[100:103] offset:5120
  ds_write_b128 v30, v[104:107] offset:6144
  ds_write_b128 v30, v[108:111] offset:7168
  ds_write_b128 v30, v[112:115] offset:8192
  ds_write_b128 v30, v[116:119] offset:9216
  ds_write_b128 v30, v[120:123] offset:10240
  ds_write_b128 v30, v[124:127] offset:11264
  ds_write_b128 v30, v[128:131] offset:12288
  ds_write_b128 v30, v[132:135] offset:13312
  ds_write_b128 v30, v[136:139] offset:14336
  s_waitcnt vmcnt(0)
  ds_write_b128 v31, v[140:143] offset:0
  ds_write_b128 v31, v[144:147] offset:1024
  ds_write_b128 v31, v[148:151] offset:2048
  ds_write_b128 v31, v[152:155] offset:3072
  ds_write_b128 v31, v[156:159] offset:4096
  ds_write_b128 v31, v[160:163] offset:5120
  ds_write_b128 v31, v[164:167] offset:6144
  ds_write_b128 v31, v[168:171] offset:7168
  ds_write_b128 v31, v[172:175] offset:8192
  ds_write_b128 v31, v[176:179] offset:9216
  ds_write_b128 v31, v[180:183] offset:10240
  ds_write_b128 v31, v[184:187] offset:11264
  ds_write_b128 v31, v[188:191] offset:12288
  ds_write_b128 v31, v[192:195] offset:13312
  ds_write_b128 v31, v[196:199] offset:14336
  s_waitcnt lgkmcnt(0)
  s_barrier
  ds_read_b64_tr_b16 a[12:13], v200 offset:0
  ds_read_b64_tr_b16 a[14:15], v200 offset:5120
  ds_read_b64_tr_b16 a[36:37], v201 offset:0
  ds_read_b64_tr_b16 a[38:39], v201 offset:5120
  ds_read_b64_tr_b16 a[60:61], v202 offset:0
  ds_read_b64_tr_b16 a[62:63], v202 offset:5120
  ds_read_b64_tr_b16 a[84:85], v203 offset:0
  ds_read_b64_tr_b16 a[86:87], v203 offset:5120
  ds_read_b64_tr_b16 a[108:109], v204 offset:0
  ds_read_b64_tr_b16 a[110:111], v204 offset:5120
  ds_read_b64_tr_b16 a[132:133], v205 offset:0
  ds_read_b64_tr_b16 a[134:135], v205 offset:5120
  ds_read_b64_tr_b16 a[156:157], v206 offset:0
  ds_read_b64_tr_b16 a[158:159], v206 offset:5120
  ds_read_b64_tr_b16 a[180:181], v207 offset:0
  ds_read_b64_tr_b16 a[182:183], v207 offset:5120
  ds_read_b64_tr_b16 a[204:205], v208 offset:0
  ds_read_b64_tr_b16 a[206:207], v208 offset:5120
  ds_read_b64_tr_b16 a[228:229], v209 offset:0
  ds_read_b64_tr_b16 a[230:231], v209 offset:5120
  ds_read_b64_tr_b16 a[16:17], v200 offset:40960
  ds_read_b64_tr_b16 a[18:19], v200 offset:46080
  ds_read_b64_tr_b16 a[40:41], v201 offset:40960
  ds_read_b64_tr_b16 a[42:43], v201 offset:46080
  ds_read_b64_tr_b16 a[64:65], v202 offset:40960
  ds_read_b64_tr_b16 a[66:67], v202 offset:46080
  ds_read_b64_tr_b16 a[88:89], v203 offset:40960
  ds_read_b64_tr_b16 a[90:91], v203 offset:46080
  ds_read_b64_tr_b16 a[112:113], v204 offset:40960
  ds_read_b64_tr_b16 a[114:115], v204 offset:46080
  ds_read_b64_tr_b16 a[136:137], v205 offset:40960
  ds_read_b64_tr_b16 a[138:139], v205 offset:46080
  ds_read_b64_tr_b16 a[160:161], v206 offset:40960
  ds_read_b64_tr_b16 a[162:163], v206 offset:46080
  ds_read_b64_tr_b16 a[184:185], v207 offset:40960
  ds_read_b64_tr_b16 a[186:187], v207 offset:46080
  ds_read_b64_tr_b16 a[208:209], v208 offset:40960
  ds_read_b64_tr_b16 a[210:211], v208 offset:46080
  ds_read_b64_tr_b16 a[232:233], v209 offset:40960
  ds_read_b64_tr_b16 a[234:235], v209 offset:46080
  ds_read_b64_tr_b16 a[20:21], v210 offset:0
  ds_read_b64_tr_b16 a[22:23], v210 offset:5120
  ds_read_b64_tr_b16 a[44:45], v211 offset:0
  ds_read_b64_tr_b16 a[46:47], v211 offset:5120
  ds_read_b64_tr_b16 a[68:69], v212 offset:0
  ds_read_b64_tr_b16 a[70:71], v212 offset:5120
  ds_read_b64_tr_b16 a[92:93], v213 offset:0
  ds_read_b64_tr_b16 a[94:95], v213 offset:5120
  ds_read_b64_tr_b16 a[116:117], v214 offset:0
  ds_read_b64_tr_b16 a[118:119], v214 offset:5120
  ds_read_b64_tr_b16 a[140:141], v215 offset:0
  ds_read_b64_tr_b16 a[142:143], v215 offset:5120
  ds_read_b64_tr_b16 a[164:165], v216 offset:0
  ds_read_b64_tr_b16 a[166:167], v216 offset:5120
  ds_read_b64_tr_b16 a[188:189], v217 offset:0
  ds_read_b64_tr_b16 a[190:191], v217 offset:5120
  ds_read_b64_tr_b16 a[212:213], v218 offset:0
  ds_read_b64_tr_b16 a[214:215], v218 offset:5120
  ds_read_b64_tr_b16 a[236:237], v219 offset:0
  ds_read_b64_tr_b16 a[238:239], v219 offset:5120
  s_waitcnt lgkmcnt(0)
  s_barrier
  s_load_dwordx2 s[32:33], s[0:1], 96
  s_waitcnt lgkmcnt(0)
  s_mov_b32 s32, s32
  s_mov_b32 s33, s33
  s_mov_b32 s34, 256
  s_mov_b32 s35, 0x00020000
  s_mov_b32 s21, 76
  s_cmp_lg_u32 s20, 0
  s_cbranch_scc1 wf_170
  v_mov_b32 v4, 0
  s_mov_b32 s101, 0
wf_169:
  buffer_load_dword v5, v4, s[32:35], s21 offen sc1
  s_add_u32 s101, s101, 1
  s_cmp_gt_u32 s101, 131072
  s_cbranch_scc1 main_end
  s_waitcnt vmcnt(0)
  v_readfirstlane_b32 s100, v5
  s_cmp_ge_u32 s100, 32
  s_cbranch_scc1 wf_170
  s_sleep 8
  s_branch wf_169
wf_170:
  s_barrier
  s_mul_i32 s41, s2, 12288
  s_add_u32 s47, s41, 25165824
  s_mov_b32 s41, s47
  s_mul_i32 s21, s20, 10
  s_mul_i32 s47, s2, 5
  s_lshr_b32 s22, s21, 3
  s_add_u32 s47, s47, s22
  s_and_b32 s48, s21, 7
  s_mov_b32 s66, 0
  s_mov_b32 s67, 0
  s_lshr_b32 s43, s2, 2
  s_lshl_b32 s43, s43, 7
  s_add_u32 s43, s43, 0
  s_lshl_b32 s44, s2, 7
  s_lshl_b32 s21, s20, 2
  s_add_u32 s44, s44, s21
  s_add_u32 s44, s44, 95232
  s_mov_b32 s45, 0
  s_mov_b32 s49, 1
  s_mov_b32 s50, 0
  v_mov_b32 v10, 0
  v_mov_b32 v11, 1
  v_lshlrev_b32 v4, 4, v1
  s_add_u32 s76, s38, 56623104
  s_addc_u32 s77, s39, 0
  s_mov_b32 s78, 6291456
  s_mov_b32 s79, 0x00020000
  s_add_u32 s80, s38, 93323264
  s_addc_u32 s81, s39, 0
  s_mov_b32 s82, 20971520
  s_mov_b32 s83, 0x00020000
  v_and_b32 v12, 3, v1
  v_lshlrev_b32 v12, 3, v12
  v_add_u32 v12, 4, v12
  v_and_b32 v13, 7, v2
  v_lshlrev_b32 v13, 4, v13
  v_lshl_add_u32 v13, v3, 7, v13
  v_lshrrev_b32 v14, 3, v2
  v_mul_u32_u24 v14, 98304, v14
  v_add_u32 v14, v14, v13
  v_and_b32 v15, 1, v3
  v_lshlrev_b32 v15, 8, v15
  v_lshl_add_u32 v15, v2, 4, v15
  v_lshrrev_b32 v16, 1, v3
  v_mul_u32_u24 v16, 327680, v16
  v_add_u32 v15, v15, v16
  v_lshlrev_b32 v17, 10, v1
  v_mov_b32 v19, 0
  s_lshl_b32 s53, s2, 7
  s_add_u32 s53, s53, 19456
  s_mov_b32 s55, 0
  s_mov_b32 s56, 0
  s_mov_b32 s58, 0
  s_mov_b32 s59, 0
  s_add_u32 s84, s38, 50331648
  s_addc_u32 s85, s39, 0
  s_mov_b32 s86, 12582912
  s_mov_b32 s87, 0x00020000
  s_and_b32 s21, s2, 3
  s_mul_i32 s51, s2, 3072
  s_cmp_eq_u32 s21, s20
  s_cselect_b32 s51, s51, 6291456
  v_mov_b32 v244, -1
  v_mov_b32 v245, -1
  v_mov_b32 v246, -1
  v_mov_b32 v247, -1
  s_add_u32 s88, s38, 85983232
  s_addc_u32 s89, s39, 0
  s_mov_b32 s90, 5242880
  s_mov_b32 s91, 0x00020000
  s_mul_i32 s21, s20, 3072
  s_add_u32 s41, s41, s21
  s_mov_b32 s64, s21
  s_add_u32 s67, s21, 98304
  s_mov_b32 s71, s21
  s_mov_b32 s46, 0
  s_mov_b32 s47, 0
  s_mov_b32 s65, 0
  s_mul_i32 s42, s2, 40960
  s_mul_i32 s21, s20, 10240
  s_add_u32 s42, s42, s21
  s_mov_b32 s68, 0x80000000
  s_mov_b32 s70, 0
  s_mov_b32 s40, 0
  s_mov_b32 s30, 0
  s_mov_b32 s31, 0
  v_min_u32 v5, 18, v1
  v_lshlrev_b32 v5, 10, v5
  v_mov_b32 v9, 0
  s_lshl_b32 s21, s20, 2
  s_add_u32 s21, s21, 110592
  v_mov_b32 v6, s21
  v_mov_b32 v7, 110592
  s_mul_i32 s51, s2, 3072
  s_lshl_b32 s21, s20, 10
  s_add_u32 s51, s51, s21
  s_cmp_lt_u32 s20, 3
  s_cselect_b32 s51, s51, 6291456
  s_add_u32 s51, s51, 5701632
  s_cmp_lg_u32 s20, 0
  s_cbranch_scc1 wf_172
  v_mov_b32 v20, 0
  s_mov_b32 s101, 0
wf_171:
  buffer_load_dword v21, v20, s[72:75], s43 offen sc1
  s_add_u32 s101, s101, 1
  s_cmp_gt_u32 s101, 131072
  s_cbranch_scc1 main_end
  s_waitcnt vmcnt(0)
  v_readfirstlane_b32 s100, v21
  s_cmp_ge_u32 s100, 8
  s_cbranch_scc1 wf_172
  s_sleep 4
  s_branch wf_171
wf_172:
  s_barrier
  v_writelane_b32 v9, 8, 0
  v_cmp_gt_u32 vcc, 8, v9
  s_nop 0
  s_bitset1_b64 vcc, 19
  s_ff1_i32_b64 s21, vcc
  s_lshl_b32 s22, s21, 1
  s_lshl_b32 s21, s21, 2
  s_sub_i32 s21, s21, 12
  s_max_i32 s47, s21, s22
  s_cmp_gt_u32 s47, s45
  s_cbranch_scc1 va_173
  s_mov_b32 s101, 0
  s_branch va_176
va_174:
  s_sleep 8
va_176:
  buffer_load_dword v9, v5, s[72:75], s43 offen sc1
  s_add_u32 s101, s101, 1
  s_cmp_gt_u32 s101, 131072
  s_cbranch_scc1 main_end
  s_waitcnt vmcnt(0)
  v_cmp_gt_u32 vcc, 8, v9
  s_nop 0
  s_bitset1_b64 vcc, 19
  s_ff1_i32_b64 s21, vcc
  s_lshl_b32 s22, s21, 1
  s_lshl_b32 s21, s21, 2
  s_sub_i32 s21, s21, 12
  s_max_i32 s47, s21, s22
  s_cmp_gt_u32 s47, s45
  s_cbranch_scc0 va_174
va_173:
  s_add_u32 s22, s45, 6
  s_min_u32 s22, s22, s47
va_175:
  s_cmp_ge_u32 s46, s22
  s_cbranch_scc1 va_177
  s_mov_b32 m0, s64
  s_mov_b32 s66, s41
  buffer_load_dwordx4 v4, s[16:19], s66 offen offset:0 sc1 lds
  buffer_load_dwordx4 v4, s[16:19], s66 offen offset:1024 sc1 lds
  buffer_load_dwordx4 v4, s[16:19], s66 offen offset:2048 sc1 lds
  s_add_u32 s46, s46, 1
  s_add_u32 s41, s41, 393216
  s_add_u32 s64, s64, 12288
  s_cmp_lt_u32 s64, s67
  s_cselect_b32 s64, s64, s71
  s_branch va_175
va_177:
  s_mov_b32 s48, s46
  s_mov_b32 s49, s46
  s_mov_b32 s50, s46
  s_waitcnt vmcnt(0)
  s_barrier
  v_mov_b32 v8, v4
  s_add_u32 s65, s65, 12288
  s_cmp_lt_u32 s65, 98304
  s_cselect_b32 s65, s65, 0
  ds_read_b128 v[144:147], v8 offset:0
  ds_read_b128 v[148:151], v8 offset:1024
  ds_read_b128 v[152:155], v8 offset:2048
  ds_read_b128 v[156:159], v8 offset:3072
  ds_read_b128 v[160:163], v8 offset:4096
  ds_read_b128 v[164:167], v8 offset:5120
  ds_read_b128 v[168:171], v8 offset:6144
  ds_read_b128 v[172:175], v8 offset:7168
  ds_read_b128 v[176:179], v8 offset:8192
  ds_read_b128 v[180:183], v8 offset:9216
  ds_read_b128 v[184:187], v8 offset:10240
  ds_read_b128 v[188:191], v8 offset:11264
  s_add_u32 s21, s45, 1
  s_min_u32 s21, s21, 63
  s_cmp_lt_u32 s21, s50
  s_addc_u32 s21, s31, s31
  v_mov_b32 v21, s21
  ds_write_b32 v6, v21 offset:0
vwl_178:
  s_waitcnt lgkmcnt(0)
  s_barrier
  v_mfma_f32_16x16x32_bf16 v[64:67], v[144:147], a[0:3], 0
  v_cmp_gt_u32 vcc, 8, v9
  s_nop 0
  v_mfma_f32_16x16x32_bf16 v[72:75], v[144:147], a[24:27], 0
  s_bitset1_b64 vcc, 19
  s_ff1_i32_b64 s21, vcc
  v_mfma_f32_16x16x32_bf16 v[80:83], v[144:147], a[48:51], 0
  s_lshl_b32 s22, s21, 1
  s_lshl_b32 s21, s21, 2
  v_mfma_f32_16x16x32_bf16 v[88:91], v[144:147], a[72:75], 0
  s_sub_i32 s21, s21, 12
  s_max_i32 s47, s21, s22
  v_mfma_f32_16x16x32_bf16 v[96:99], v[144:147], a[96:99], 0
  s_add_u32 s22, s45, 7
  s_min_u32 s22, s22, s47
  v_mfma_f32_16x16x32_bf16 v[68:71], v[168:171], a[0:3], 0
  s_cmp_lt_u32 s46, s22
  s_cselect_b32 s66, s41, 0x80000000
  s_cselect_b32 m0, s64, 98304
  s_cselect_b32 s22, 1, 0
  v_mfma_f32_16x16x32_bf16 v[76:79], v[168:171], a[24:27], 0
  buffer_load_dwordx4 v4, s[16:19], s66 offen offset:0 sc1 lds
  v_mfma_f32_16x16x32_bf16 v[84:87], v[168:171], a[48:51], 0
  v_add_u32 v8, s65, v4
  ds_read_b128 v[240:243], v7 offset:0
  v_mfma_f32_16x16x32_bf16 v[92:95], v[168:171], a[72:75], 0
  buffer_load_dwordx4 v4, s[16:19], s66 offen offset:1024 sc1 lds
  v_mfma_f32_16x16x32_bf16 v[100:103], v[168:171], a[96:99], 0
  s_add_u32 s65, s65, 12288
  v_mfma_f32_16x16x32_bf16 v[64:67], v[148:151], a[4:7], v[64:67]
  buffer_load_dwordx4 v4, s[16:19], s66 offen offset:2048 sc1 lds
  v_mfma_f32_16x16x32_bf16 v[72:75], v[148:151], a[28:31], v[72:75]
  s_cmp_lt_u32 s65, 98304
  s_cselect_b32 s65, s65, 0
  v_mfma_f32_16x16x32_bf16 v[80:83], v[148:151], a[52:55], v[80:83]
  v_cvt_pk_bf16_f32 v44, v104, v105
  v_cvt_pk_bf16_f32 v45, v106, v107
  v_mfma_f32_16x16x32_bf16 v[88:91], v[148:151], a[76:79], v[88:91]
  s_add_u32 s46, s46, s22
  s_mul_i32 s21, s22, 393216
  v_mfma_f32_16x16x32_bf16 v[96:99], v[148:151], a[100:103], v[96:99]
  ds_read_b128 v[192:195], v8 offset:0
  v_cvt_pk_bf16_f32 v46, v108, v109
  v_mfma_f32_16x16x32_bf16 v[68:71], v[172:175], a[4:7], v[68:71]
  s_add_u32 s41, s41, s21
  s_mul_i32 s21, s22, 12288
  v_mfma_f32_16x16x32_bf16 v[76:79], v[172:175], a[28:31], v[76:79]
  v_cvt_pk_bf16_f32 v47, v110, v111
  s_add_u32 s64, s64, s21
  v_mfma_f32_16x16x32_bf16 v[84:87], v[172:175], a[52:55], v[84:87]
  s_add_u32 s69, s68, 4096
  v_mfma_f32_16x16x32_bf16 v[92:95], v[172:175], a[76:79], v[92:95]
  s_cmp_lt_u32 s64, s67
  s_cselect_b32 s64, s64, s71
  v_mfma_f32_16x16x32_bf16 v[100:103], v[172:175], a[100:103], v[100:103]
  buffer_store_dwordx4 v[44:47], v4, s[24:27], s69 offen offset:1024 sc1
  v_mfma_f32_16x16x32_bf16 v[64:67], v[152:155], a[8:11], v[64:67]
  ds_read_b128 v[196:199], v8 offset:1024
  v_mfma_f32_16x16x32_bf16 v[72:75], v[152:155], a[32:35], v[72:75]
  v_cvt_pk_bf16_f32 v48, v112, v113
  v_mfma_f32_16x16x32_bf16 v[80:83], v[152:155], a[56:59], v[80:83]
  v_cvt_pk_bf16_f32 v49, v114, v115
  v_mfma_f32_16x16x32_bf16 v[88:91], v[152:155], a[80:83], v[88:91]
  v_mfma_f32_16x16x32_bf16 v[96:99], v[152:155], a[104:107], v[96:99]
  v_cvt_pk_bf16_f32 v50, v116, v117
  v_mfma_f32_16x16x32_bf16 v[68:71], v[176:179], a[8:11], v[68:71]
  v_mfma_f32_16x16x32_bf16 v[76:79], v[176:179], a[32:35], v[76:79]
  ds_read_b128 v[200:203], v8 offset:2048
  v_cvt_pk_bf16_f32 v51, v118, v119
  v_mfma_f32_16x16x32_bf16 v[84:87], v[176:179], a[56:59], v[84:87]
  buffer_store_dwordx4 v[48:51], v4, s[24:27], s69 offen offset:2048 sc1
  v_mfma_f32_16x16x32_bf16 v[92:95], v[176:179], a[80:83], v[92:95]
  v_mfma_f32_16x16x32_bf16 v[100:103], v[176:179], a[104:107], v[100:103]
  v_cvt_pk_bf16_f32 v52, v120, v121
  v_mfma_f32_16x16x32_bf16 v[64:67], v[156:159], a[12:15], v[64:67]
  v_mfma_f32_16x16x32_bf16 v[72:75], v[156:159], a[36:39], v[72:75]
  v_cvt_pk_bf16_f32 v53, v122, v123
  v_mfma_f32_16x16x32_bf16 v[80:83], v[156:159], a[60:63], v[80:83]
  ds_read_b128 v[204:207], v8 offset:3072
  v_cvt_pk_bf16_f32 v54, v124, v125
  v_mfma_f32_16x16x32_bf16 v[88:91], v[156:159], a[84:87], v[88:91]
  v_mfma_f32_16x16x32_bf16 v[96:99], v[156:159], a[108:111], v[96:99]
  v_cvt_pk_bf16_f32 v55, v126, v127
  v_mfma_f32_16x16x32_bf16 v[68:71], v[180:183], a[12:15], v[68:71]
  v_mfma_f32_16x16x32_bf16 v[76:79], v[180:183], a[36:39], v[76:79]
  buffer_store_dwordx4 v[52:55], v4, s[24:27], s69 offen offset:3072 sc1
  v_mfma_f32_16x16x32_bf16 v[84:87], v[180:183], a[60:63], v[84:87]
  v_cvt_pk_bf16_f32 v56, v128, v129
  v_mfma_f32_16x16x32_bf16 v[92:95], v[180:183], a[84:87], v[92:95]
  ds_read_b128 v[208:211], v8 offset:4096
  v_mfma_f32_16x16x32_bf16 v[100:103], v[180:183], a[108:111], v[100:103]
  v_cvt_pk_bf16_f32 v57, v130, v131
  v_mfma_f32_16x16x32_bf16 v[64:67], v[160:163], a[16:19], v[64:67]
  v_mfma_f32_16x16x32_bf16 v[72:75], v[160:163], a[40:43], v[72:75]
  v_cvt_pk_bf16_f32 v58, v132, v133
  v_mfma_f32_16x16x32_bf16 v[80:83], v[160:163], a[64:67], v[80:83]
  v_cvt_pk_bf16_f32 v59, v134, v135
  v_mfma_f32_16x16x32_bf16 v[88:91], v[160:163], a[88:91], v[88:91]
  v_mfma_f32_16x16x32_bf16 v[96:99], v[160:163], a[112:115], v[96:99]
  ds_read_b128 v[212:215], v8 offset:5120
  s_add_u32 s69, s68, 8192
  v_mfma_f32_16x16x32_bf16 v[68:71], v[184:187], a[16:19], v[68:71]
  v_mfma_f32_16x16x32_bf16 v[76:79], v[184:187], a[40:43], v[76:79]
  buffer_store_dwordx4 v[56:59], v4, s[24:27], s69 offen offset:0 sc1
  v_mfma_f32_16x16x32_bf16 v[84:87], v[184:187], a[64:67], v[84:87]
  v_cvt_pk_bf16_f32 v60, v136, v137
  v_mfma_f32_16x16x32_bf16 v[92:95], v[184:187], a[88:91], v[92:95]
  v_mfma_f32_16x16x32_bf16 v[100:103], v[184:187], a[112:115], v[100:103]
  v_cvt_pk_bf16_f32 v61, v138, v139
  v_mfma_f32_16x16x32_bf16 v[64:67], v[164:167], a[20:23], v[64:67]
  ds_read_b128 v[216:219], v8 offset:6144
  v_mfma_f32_16x16x32_bf16 v[72:75], v[164:167], a[44:47], v[72:75]
  v_cvt_pk_bf16_f32 v62, v140, v141
  v_mfma_f32_16x16x32_bf16 v[80:83], v[164:167], a[68:71], v[80:83]
  v_cvt_pk_bf16_f32 v63, v142, v143
  v_mfma_f32_16x16x32_bf16 v[88:91], v[164:167], a[92:95], v[88:91]
  v_mfma_f32_16x16x32_bf16 v[96:99], v[164:167], a[116:119], v[96:99]
  buffer_store_dwordx4 v[60:63], v4, s[24:27], s69 offen offset:1024 sc1
  v_mfma_f32_16x16x32_bf16 v[68:71], v[188:191], a[20:23], v[68:71]
  v_mfma_f32_16x16x32_bf16 v[76:79], v[188:191], a[44:47], v[76:79]
  ds_read_b128 v[220:223], v8 offset:7168
  v_mfma_f32_16x16x32_bf16 v[84:87], v[188:191], a[68:71], v[84:87]
  v_mfma_f32_16x16x32_bf16 v[92:95], v[188:191], a[92:95], v[92:95]
  v_mfma_f32_16x16x32_bf16 v[100:103], v[188:191], a[116:119], v[100:103]
  v_mfma_f32_16x16x32_bf16 v[104:107], v[144:147], a[120:123], 0
  buffer_load_dword v9, v5, s[72:75], s43 offen sc1
  v_mfma_f32_16x16x32_bf16 v[112:115], v[144:147], a[144:147], 0
  v_mfma_f32_16x16x32_bf16 v[120:123], v[144:147], a[168:171], 0
  ds_read_b128 v[224:227], v8 offset:8192
  v_mfma_f32_16x16x32_bf16 v[128:131], v[144:147], a[192:195], 0
  v_cvt_pk_bf16_f32 v24, v64, v65
  v_mfma_f32_16x16x32_bf16 v[136:139], v[144:147], a[216:219], 0
  v_mfma_f32_16x16x32_bf16 v[108:111], v[168:171], a[120:123], 0
  v_cvt_pk_bf16_f32 v25, v66, v67
  v_mfma_f32_16x16x32_bf16 v[116:119], v[168:171], a[144:147], 0
  s_cmp_lt_u32 s51, 6291456
  s_cselect_b32 s52, s51, 0x80000000
  v_mfma_f32_16x16x32_bf16 v[124:127], v[168:171], a[168:171], 0
  v_cvt_pk_bf16_f32 v26, v68, v69
  v_mfma_f32_16x16x32_bf16 v[132:135], v[168:171], a[192:195], 0
  ds_read_b128 v[228:231], v8 offset:9216
  v_mfma_f32_16x16x32_bf16 v[140:143], v[168:171], a[216:219], 0
  v_cvt_pk_bf16_f32 v27, v70, v71
  v_mfma_f32_16x16x32_bf16 v[104:107], v[148:151], a[124:127], v[104:107]
  buffer_store_dwordx4 v[244:247], v4, s[84:87], s52 offen sc1
  v_mfma_f32_16x16x32_bf16 v[112:115], v[148:151], a[148:151], v[112:115]
  buffer_store_dwordx4 v[24:27], v4, s[24:27], s42 offen offset:0 sc1
  v_mfma_f32_16x16x32_bf16 v[120:123], v[148:151], a[172:175], v[120:123]
  s_add_u32 s51, s51, 98304
  v_mfma_f32_16x16x32_bf16 v[128:131], v[148:151], a[196:199], v[128:131]
  v_cvt_pk_bf16_f32 v28, v72, v73
  v_mfma_f32_16x16x32_bf16 v[136:139], v[148:151], a[220:223], v[136:139]
  ds_read_b128 v[232:235], v8 offset:10240
  v_cvt_pk_bf16_f32 v29, v74, v75
  v_mfma_f32_16x16x32_bf16 v[108:111], v[172:175], a[124:127], v[108:111]
  s_cmp_eq_u32 s40, 3
  s_cbranch_scc1 vwm_180
vwm_181:
  v_mfma_f32_16x16x32_bf16 v[116:119], v[172:175], a[148:151], v[116:119]
  v_cvt_pk_bf16_f32 v30, v76, v77
  v_mfma_f32_16x16x32_bf16 v[124:127], v[172:175], a[172:175], v[124:127]
  v_mfma_f32_16x16x32_bf16 v[132:135], v[172:175], a[196:199], v[132:135]
  v_cvt_pk_bf16_f32 v31, v78, v79
  v_mfma_f32_16x16x32_bf16 v[140:143], v[172:175], a[220:223], v[140:143]
  v_mfma_f32_16x16x32_bf16 v[104:107], v[152:155], a[128:131], v[104:107]
  ds_read_b128 v[236:239], v8 offset:11264
  v_mfma_f32_16x16x32_bf16 v[112:115], v[152:155], a[152:155], v[112:115]
  buffer_store_dwordx4 v[28:31], v4, s[24:27], s42 offen offset:1024 sc1
  v_mfma_f32_16x16x32_bf16 v[120:123], v[152:155], a[176:179], v[120:123]
  v_cvt_pk_bf16_f32 v32, v80, v81
  v_mfma_f32_16x16x32_bf16 v[128:131], v[152:155], a[200:203], v[128:131]
  v_mfma_f32_16x16x32_bf16 v[136:139], v[152:155], a[224:227], v[136:139]
  v_cvt_pk_bf16_f32 v33, v82, v83
  v_mfma_f32_16x16x32_bf16 v[108:111], v[176:179], a[128:131], v[108:111]
  v_cvt_pk_bf16_f32 v34, v84, v85
  v_mfma_f32_16x16x32_bf16 v[116:119], v[176:179], a[152:155], v[116:119]
  v_mfma_f32_16x16x32_bf16 v[124:127], v[176:179], a[176:179], v[124:127]
  v_cvt_pk_bf16_f32 v35, v86, v87
  v_mfma_f32_16x16x32_bf16 v[132:135], v[176:179], a[200:203], v[132:135]
  v_mfma_f32_16x16x32_bf16 v[140:143], v[176:179], a[224:227], v[140:143]
  buffer_store_dwordx4 v[32:35], v4, s[24:27], s42 offen offset:2048 sc1
  v_mfma_f32_16x16x32_bf16 v[104:107], v[156:159], a[132:135], v[104:107]
  v_mfma_f32_16x16x32_bf16 v[112:115], v[156:159], a[156:159], v[112:115]
  v_cvt_pk_bf16_f32 v36, v88, v89
  v_mfma_f32_16x16x32_bf16 v[120:123], v[156:159], a[180:183], v[120:123]
  v_mfma_f32_16x16x32_bf16 v[128:131], v[156:159], a[204:207], v[128:131]
  v_cvt_pk_bf16_f32 v37, v90, v91
  v_mfma_f32_16x16x32_bf16 v[136:139], v[156:159], a[228:231], v[136:139]
  v_mfma_f32_16x16x32_bf16 v[108:111], v[180:183], a[132:135], v[108:111]
  v_cvt_pk_bf16_f32 v38, v92, v93
  v_mfma_f32_16x16x32_bf16 v[116:119], v[180:183], a[156:159], v[116:119]
  v_cvt_pk_bf16_f32 v39, v94, v95
  s_waitcnt lgkmcnt(0)
  v_mfma_f32_16x16x32_bf16 v[124:127], v[180:183], a[180:183], v[124:127]
  v_bitop3_b32 v240, v240, v241, v242 bitop3:0x80
  v_and_b32 v240, v240, v243
  v_mfma_f32_16x16x32_bf16 v[132:135], v[180:183], a[204:207], v[132:135]
  buffer_store_dwordx4 v[36:39], v4, s[24:27], s42 offen offset:3072 sc1
  v_mfma_f32_16x16x32_bf16 v[140:143], v[180:183], a[228:231], v[140:143]
  s_nop 0
  v_readfirstlane_b32 s23, v240
  v_mfma_f32_16x16x32_bf16 v[104:107], v[160:163], a[136:139], v[104:107]
  v_cvt_pk_bf16_f32 v40, v96, v97
  v_mfma_f32_16x16x32_bf16 v[112:115], v[160:163], a[160:163], v[112:115]
  v_mfma_f32_16x16x32_bf16 v[120:123], v[160:163], a[184:187], v[120:123]
  v_cvt_pk_bf16_f32 v41, v98, v99
  v_mfma_f32_16x16x32_bf16 v[128:131], v[160:163], a[208:211], v[128:131]
  v_mfma_f32_16x16x32_bf16 v[136:139], v[160:163], a[232:235], v[136:139]
  v_cvt_pk_bf16_f32 v42, v100, v101
  v_mfma_f32_16x16x32_bf16 v[108:111], v[184:187], a[136:139], v[108:111]
  v_mfma_f32_16x16x32_bf16 v[116:119], v[184:187], a[160:163], v[116:119]
  v_cvt_pk_bf16_f32 v43, v102, v103
  v_mfma_f32_16x16x32_bf16 v[124:127], v[184:187], a[184:187], v[124:127]
  s_add_u32 s69, s42, 4096
  v_mfma_f32_16x16x32_bf16 v[132:135], v[184:187], a[208:211], v[132:135]
  v_mfma_f32_16x16x32_bf16 v[140:143], v[184:187], a[232:235], v[140:143]
  buffer_store_dwordx4 v[40:43], v4, s[24:27], s69 offen offset:0 sc1
  v_mfma_f32_16x16x32_bf16 v[104:107], v[164:167], a[140:143], v[104:107]
  v_mfma_f32_16x16x32_bf16 v[112:115], v[164:167], a[164:167], v[112:115]
  v_mfma_f32_16x16x32_bf16 v[120:123], v[164:167], a[188:191], v[120:123]
  s_waitcnt vmcnt(12)
  s_mov_b32 s50, s46
  s_add_u32 s69, s45, s40
  v_mfma_f32_16x16x32_bf16 v[128:131], v[164:167], a[212:215], v[128:131]
  s_mov_b32 s40, 0
  s_sub_i32 s69, s69, 1
  s_max_i32 s69, s69, s70
  v_mfma_f32_16x16x32_bf16 v[136:139], v[164:167], a[236:239], v[136:139]
  s_add_u32 s45, s45, 1
  s_mov_b32 s68, s42
  s_add_u32 s42, s42, 1310720
  v_mfma_f32_16x16x32_bf16 v[108:111], v[188:191], a[140:143], v[108:111]
  s_add_u32 s21, s45, 1
  s_min_u32 s21, s21, 63
  v_mfma_f32_16x16x32_bf16 v[116:119], v[188:191], a[164:167], v[116:119]
  s_cmp_lt_u32 s21, s50
  s_addc_u32 s21, s31, s31
  v_mov_b32 v21, s21
  v_mfma_f32_16x16x32_bf16 v[124:127], v[188:191], a[188:191], v[124:127]
  ds_write_b32 v6, v21 offset:16
  v_mfma_f32_16x16x32_bf16 v[132:135], v[188:191], a[212:215], v[132:135]
  v_mfma_f32_16x16x32_bf16 v[140:143], v[188:191], a[236:239], v[140:143]
  s_mov_b64 exec, 1
  v_mov_b32 v20, s69
  buffer_store_dword v20, v10, s[72:75], s44 offen sc1
  s_mov_b64 exec, -1
  s_cmp_le_u32 s45, 16
  s_cbranch_scc1 vwe_184
vwe_185:
  s_cmp_eq_u32 s23, 0
  s_cbranch_scc1 vws_182
vwb_183:
  s_waitcnt lgkmcnt(0)
  s_barrier
  v_mfma_f32_16x16x32_bf16 v[64:67], v[192:195], a[0:3], 0
  v_cmp_gt_u32 vcc, 8, v9
  s_nop 0
  v_mfma_f32_16x16x32_bf16 v[72:75], v[192:195], a[24:27], 0
  s_bitset1_b64 vcc, 19
  s_ff1_i32_b64 s21, vcc
  v_mfma_f32_16x16x32_bf16 v[80:83], v[192:195], a[48:51], 0
  s_lshl_b32 s22, s21, 1
  s_lshl_b32 s21, s21, 2
  v_mfma_f32_16x16x32_bf16 v[88:91], v[192:195], a[72:75], 0
  s_sub_i32 s21, s21, 12
  s_max_i32 s47, s21, s22
  v_mfma_f32_16x16x32_bf16 v[96:99], v[192:195], a[96:99], 0
  s_add_u32 s22, s45, 7
  s_min_u32 s22, s22, s47
  v_mfma_f32_16x16x32_bf16 v[68:71], v[216:219], a[0:3], 0
  s_cmp_lt_u32 s46, s22
  s_cselect_b32 s66, s41, 0x80000000
  s_cselect_b32 m0, s64, 98304
  s_cselect_b32 s22, 1, 0
  v_mfma_f32_16x16x32_bf16 v[76:79], v[216:219], a[24:27], 0
  buffer_load_dwordx4 v4, s[16:19], s66 offen offset:0 sc1 lds
  v_mfma_f32_16x16x32_bf16 v[84:87], v[216:219], a[48:51], 0
  v_add_u32 v8, s65, v4
  ds_read_b128 v[240:243], v7 offset:16
  v_mfma_f32_16x16x32_bf16 v[92:95], v[216:219], a[72:75], 0
  buffer_load_dwordx4 v4, s[16:19], s66 offen offset:1024 sc1 lds
  v_mfma_f32_16x16x32_bf16 v[100:103], v[216:219], a[96:99], 0
  s_add_u32 s65, s65, 12288
  v_mfma_f32_16x16x32_bf16 v[64:67], v[196:199], a[4:7], v[64:67]
  buffer_load_dwordx4 v4, s[16:19], s66 offen offset:2048 sc1 lds
  v_mfma_f32_16x16x32_bf16 v[72:75], v[196:199], a[28:31], v[72:75]
  s_cmp_lt_u32 s65, 98304
  s_cselect_b32 s65, s65, 0
  v_mfma_f32_16x16x32_bf16 v[80:83], v[196:199], a[52:55], v[80:83]
  v_cvt_pk_bf16_f32 v44, v104, v105
  v_cvt_pk_bf16_f32 v45, v106, v107
  v_mfma_f32_16x16x32_bf16 v[88:91], v[196:199], a[76:79], v[88:91]
  s_add_u32 s46, s46, s22
  s_mul_i32 s21, s22, 393216
  v_mfma_f32_16x16x32_bf16 v[96:99], v[196:199], a[100:103], v[96:99]
  ds_read_b128 v[144:147], v8 offset:0
  v_cvt_pk_bf16_f32 v46, v108, v109
  v_mfma_f32_16x16x32_bf16 v[68:71], v[220:223], a[4:7], v[68:71]
  s_add_u32 s41, s41, s21
  s_mul_i32 s21, s22, 12288
  v_mfma_f32_16x16x32_bf16 v[76:79], v[220:223], a[28:31], v[76:79]
  v_cvt_pk_bf16_f32 v47, v110, v111
  s_add_u32 s64, s64, s21
  v_mfma_f32_16x16x32_bf16 v[84:87], v[220:223], a[52:55], v[84:87]
  s_add_u32 s69, s68, 4096
  v_mfma_f32_16x16x32_bf16 v[92:95], v[220:223], a[76:79], v[92:95]
  s_cmp_lt_u32 s64, s67
  s_cselect_b32 s64, s64, s71
  v_mfma_f32_16x16x32_bf16 v[100:103], v[220:223], a[100:103], v[100:103]
  buffer_store_dwordx4 v[44:47], v4, s[24:27], s69 offen offset:1024 sc1
  v_mfma_f32_16x16x32_bf16 v[64:67], v[200:203], a[8:11], v[64:67]
  ds_read_b128 v[148:151], v8 offset:1024
  v_mfma_f32_16x16x32_bf16 v[72:75], v[200:203], a[32:35], v[72:75]
  v_cvt_pk_bf16_f32 v48, v112, v113
  v_mfma_f32_16x16x32_bf16 v[80:83], v[200:203], a[56:59], v[80:83]
  v_cvt_pk_bf16_f32 v49, v114, v115
  v_mfma_f32_16x16x32_bf16 v[88:91], v[200:203], a[80:83], v[88:91]
  v_mfma_f32_16x16x32_bf16 v[96:99], v[200:203], a[104:107], v[96:99]
  v_cvt_pk_bf16_f32 v50, v116, v117
  v_mfma_f32_16x16x32_bf16 v[68:71], v[224:227], a[8:11], v[68:71]
  v_mfma_f32_16x16x32_bf16 v[76:79], v[224:227], a[32:35], v[76:79]
  ds_read_b128 v[152:155], v8 offset:2048
  v_cvt_pk_bf16_f32 v51, v118, v119
  v_mfma_f32_16x16x32_bf16 v[84:87], v[224:227], a[56:59], v[84:87]
  buffer_store_dwordx4 v[48:51], v4, s[24:27], s69 offen offset:2048 sc1
  v_mfma_f32_16x16x32_bf16 v[92:95], v[224:227], a[80:83], v[92:95]
  v_mfma_f32_16x16x32_bf16 v[100:103], v[224:227], a[104:107], v[100:103]
  v_cvt_pk_bf16_f32 v52, v120, v121
  v_mfma_f32_16x16x32_bf16 v[64:67], v[204:207], a[12:15], v[64:67]
  v_mfma_f32_16x16x32_bf16 v[72:75], v[204:207], a[36:39], v[72:75]
  v_cvt_pk_bf16_f32 v53, v122, v123
  v_mfma_f32_16x16x32_bf16 v[80:83], v[204:207], a[60:63], v[80:83]
  ds_read_b128 v[156:159], v8 offset:3072
  v_cvt_pk_bf16_f32 v54, v124, v125
  v_mfma_f32_16x16x32_bf16 v[88:91], v[204:207], a[84:87], v[88:91]
  v_mfma_f32_16x16x32_bf16 v[96:99], v[204:207], a[108:111], v[96:99]
  v_cvt_pk_bf16_f32 v55, v126, v127
  v_mfma_f32_16x16x32_bf16 v[68:71], v[228:231], a[12:15], v[68:71]
  v_mfma_f32_16x16x32_bf16 v[76:79], v[228:231], a[36:39], v[76:79]
  buffer_store_dwordx4 v[52:55], v4, s[24:27], s69 offen offset:3072 sc1
  v_mfma_f32_16x16x32_bf16 v[84:87], v[228:231], a[60:63], v[84:87]
  v_cvt_pk_bf16_f32 v56, v128, v129
  v_mfma_f32_16x16x32_bf16 v[92:95], v[228:231], a[84:87], v[92:95]
  ds_read_b128 v[160:163], v8 offset:4096
  v_mfma_f32_16x16x32_bf16 v[100:103], v[228:231], a[108:111], v[100:103]
  v_cvt_pk_bf16_f32 v57, v130, v131
  v_mfma_f32_16x16x32_bf16 v[64:67], v[208:211], a[16:19], v[64:67]
  v_mfma_f32_16x16x32_bf16 v[72:75], v[208:211], a[40:43], v[72:75]
  v_cvt_pk_bf16_f32 v58, v132, v133
  v_mfma_f32_16x16x32_bf16 v[80:83], v[208:211], a[64:67], v[80:83]
  v_cvt_pk_bf16_f32 v59, v134, v135
  v_mfma_f32_16x16x32_bf16 v[88:91], v[208:211], a[88:91], v[88:91]
  v_mfma_f32_16x16x32_bf16 v[96:99], v[208:211], a[112:115], v[96:99]
  ds_read_b128 v[164:167], v8 offset:5120
  s_add_u32 s69, s68, 8192
  v_mfma_f32_16x16x32_bf16 v[68:71], v[232:235], a[16:19], v[68:71]
  v_mfma_f32_16x16x32_bf16 v[76:79], v[232:235], a[40:43], v[76:79]
  buffer_store_dwordx4 v[56:59], v4, s[24:27], s69 offen offset:0 sc1
  v_mfma_f32_16x16x32_bf16 v[84:87], v[232:235], a[64:67], v[84:87]
  v_cvt_pk_bf16_f32 v60, v136, v137
  v_mfma_f32_16x16x32_bf16 v[92:95], v[232:235], a[88:91], v[92:95]
  v_mfma_f32_16x16x32_bf16 v[100:103], v[232:235], a[112:115], v[100:103]
  v_cvt_pk_bf16_f32 v61, v138, v139
  v_mfma_f32_16x16x32_bf16 v[64:67], v[212:215], a[20:23], v[64:67]
  ds_read_b128 v[168:171], v8 offset:6144
  v_mfma_f32_16x16x32_bf16 v[72:75], v[212:215], a[44:47], v[72:75]
  v_cvt_pk_bf16_f32 v62, v140, v141
  v_mfma_f32_16x16x32_bf16 v[80:83], v[212:215], a[68:71], v[80:83]
  v_cvt_pk_bf16_f32 v63, v142, v143
  v_mfma_f32_16x16x32_bf16 v[88:91], v[212:215], a[92:95], v[88:91]
  v_mfma_f32_16x16x32_bf16 v[96:99], v[212:215], a[116:119], v[96:99]
  buffer_store_dwordx4 v[60:63], v4, s[24:27], s69 offen offset:1024 sc1
  v_mfma_f32_16x16x32_bf16 v[68:71], v[236:239], a[20:23], v[68:71]
  v_mfma_f32_16x16x32_bf16 v[76:79], v[236:239], a[44:47], v[76:79]
  ds_read_b128 v[172:175], v8 offset:7168
  v_mfma_f32_16x16x32_bf16 v[84:87], v[236:239], a[68:71], v[84:87]
  v_mfma_f32_16x16x32_bf16 v[92:95], v[236:239], a[92:95], v[92:95]
  v_mfma_f32_16x16x32_bf16 v[100:103], v[236:239], a[116:119], v[100:103]
  v_mfma_f32_16x16x32_bf16 v[104:107], v[192:195], a[120:123], 0
  buffer_load_dword v9, v5, s[72:75], s43 offen sc1
  v_mfma_f32_16x16x32_bf16 v[112:115], v[192:195], a[144:147], 0
  v_mfma_f32_16x16x32_bf16 v[120:123], v[192:195], a[168:171], 0
  ds_read_b128 v[176:179], v8 offset:8192
  v_mfma_f32_16x16x32_bf16 v[128:131], v[192:195], a[192:195], 0
  v_cvt_pk_bf16_f32 v24, v64, v65
  v_mfma_f32_16x16x32_bf16 v[136:139], v[192:195], a[216:219], 0
  v_mfma_f32_16x16x32_bf16 v[108:111], v[216:219], a[120:123], 0
  v_cvt_pk_bf16_f32 v25, v66, v67
  v_mfma_f32_16x16x32_bf16 v[116:119], v[216:219], a[144:147], 0
  s_cmp_lt_u32 s51, 6291456
  s_cselect_b32 s52, s51, 0x80000000
  v_mfma_f32_16x16x32_bf16 v[124:127], v[216:219], a[168:171], 0
  v_cvt_pk_bf16_f32 v26, v68, v69
  v_mfma_f32_16x16x32_bf16 v[132:135], v[216:219], a[192:195], 0
  ds_read_b128 v[180:183], v8 offset:9216
  v_mfma_f32_16x16x32_bf16 v[140:143], v[216:219], a[216:219], 0
  v_cvt_pk_bf16_f32 v27, v70, v71
  v_mfma_f32_16x16x32_bf16 v[104:107], v[196:199], a[124:127], v[104:107]
  buffer_store_dwordx4 v[244:247], v4, s[84:87], s52 offen sc1
  v_mfma_f32_16x16x32_bf16 v[112:115], v[196:199], a[148:151], v[112:115]
  buffer_store_dwordx4 v[24:27], v4, s[24:27], s42 offen offset:0 sc1
  v_mfma_f32_16x16x32_bf16 v[120:123], v[196:199], a[172:175], v[120:123]
  s_add_u32 s51, s51, 98304
  v_mfma_f32_16x16x32_bf16 v[128:131], v[196:199], a[196:199], v[128:131]
  v_cvt_pk_bf16_f32 v28, v72, v73
  v_mfma_f32_16x16x32_bf16 v[136:139], v[196:199], a[220:223], v[136:139]
  ds_read_b128 v[184:187], v8 offset:10240
  v_cvt_pk_bf16_f32 v29, v74, v75
  v_mfma_f32_16x16x32_bf16 v[108:111], v[220:223], a[124:127], v[108:111]
  s_cmp_eq_u32 s40, 3
  s_cbranch_scc1 vwm_188
vwm_189:
  v_mfma_f32_16x16x32_bf16 v[116:119], v[220:223], a[148:151], v[116:119]
  v_cvt_pk_bf16_f32 v30, v76, v77
  v_mfma_f32_16x16x32_bf16 v[124:127], v[220:223], a[172:175], v[124:127]
  v_mfma_f32_16x16x32_bf16 v[132:135], v[220:223], a[196:199], v[132:135]
  v_cvt_pk_bf16_f32 v31, v78, v79
  v_mfma_f32_16x16x32_bf16 v[140:143], v[220:223], a[220:223], v[140:143]
  v_mfma_f32_16x16x32_bf16 v[104:107], v[200:203], a[128:131], v[104:107]
  ds_read_b128 v[188:191], v8 offset:11264
  v_mfma_f32_16x16x32_bf16 v[112:115], v[200:203], a[152:155], v[112:115]
  buffer_store_dwordx4 v[28:31], v4, s[24:27], s42 offen offset:1024 sc1
  v_mfma_f32_16x16x32_bf16 v[120:123], v[200:203], a[176:179], v[120:123]
  v_cvt_pk_bf16_f32 v32, v80, v81
  v_mfma_f32_16x16x32_bf16 v[128:131], v[200:203], a[200:203], v[128:131]
  v_mfma_f32_16x16x32_bf16 v[136:139], v[200:203], a[224:227], v[136:139]
  v_cvt_pk_bf16_f32 v33, v82, v83
  v_mfma_f32_16x16x32_bf16 v[108:111], v[224:227], a[128:131], v[108:111]
  v_cvt_pk_bf16_f32 v34, v84, v85
  v_mfma_f32_16x16x32_bf16 v[116:119], v[224:227], a[152:155], v[116:119]
  v_mfma_f32_16x16x32_bf16 v[124:127], v[224:227], a[176:179], v[124:127]
  v_cvt_pk_bf16_f32 v35, v86, v87
  v_mfma_f32_16x16x32_bf16 v[132:135], v[224:227], a[200:203], v[132:135]
  v_mfma_f32_16x16x32_bf16 v[140:143], v[224:227], a[224:227], v[140:143]
  buffer_store_dwordx4 v[32:35], v4, s[24:27], s42 offen offset:2048 sc1
  v_mfma_f32_16x16x32_bf16 v[104:107], v[204:207], a[132:135], v[104:107]
  v_mfma_f32_16x16x32_bf16 v[112:115], v[204:207], a[156:159], v[112:115]
  v_cvt_pk_bf16_f32 v36, v88, v89
  v_mfma_f32_16x16x32_bf16 v[120:123], v[204:207], a[180:183], v[120:123]
  v_mfma_f32_16x16x32_bf16 v[128:131], v[204:207], a[204:207], v[128:131]
  v_cvt_pk_bf16_f32 v37, v90, v91
  v_mfma_f32_16x16x32_bf16 v[136:139], v[204:207], a[228:231], v[136:139]
  v_mfma_f32_16x16x32_bf16 v[108:111], v[228:231], a[132:135], v[108:111]
  v_cvt_pk_bf16_f32 v38, v92, v93
  v_mfma_f32_16x16x32_bf16 v[116:119], v[228:231], a[156:159], v[116:119]
  v_cvt_pk_bf16_f32 v39, v94, v95
  s_waitcnt lgkmcnt(0)
  v_mfma_f32_16x16x32_bf16 v[124:127], v[228:231], a[180:183], v[124:127]
  v_bitop3_b32 v240, v240, v241, v242 bitop3:0x80
  v_and_b32 v240, v240, v243
  v_mfma_f32_16x16x32_bf16 v[132:135], v[228:231], a[204:207], v[132:135]
  buffer_store_dwordx4 v[36:39], v4, s[24:27], s42 offen offset:3072 sc1
  v_mfma_f32_16x16x32_bf16 v[140:143], v[228:231], a[228:231], v[140:143]
  s_nop 0
  v_readfirstlane_b32 s23, v240
  v_mfma_f32_16x16x32_bf16 v[104:107], v[208:211], a[136:139], v[104:107]
  v_cvt_pk_bf16_f32 v40, v96, v97
  v_mfma_f32_16x16x32_bf16 v[112:115], v[208:211], a[160:163], v[112:115]
  v_mfma_f32_16x16x32_bf16 v[120:123], v[208:211], a[184:187], v[120:123]
  v_cvt_pk_bf16_f32 v41, v98, v99
  v_mfma_f32_16x16x32_bf16 v[128:131], v[208:211], a[208:211], v[128:131]
  v_mfma_f32_16x16x32_bf16 v[136:139], v[208:211], a[232:235], v[136:139]
  v_cvt_pk_bf16_f32 v42, v100, v101
  v_mfma_f32_16x16x32_bf16 v[108:111], v[232:235], a[136:139], v[108:111]
  v_mfma_f32_16x16x32_bf16 v[116:119], v[232:235], a[160:163], v[116:119]
  v_cvt_pk_bf16_f32 v43, v102, v103
  v_mfma_f32_16x16x32_bf16 v[124:127], v[232:235], a[184:187], v[124:127]
  s_add_u32 s69, s42, 4096
  v_mfma_f32_16x16x32_bf16 v[132:135], v[232:235], a[208:211], v[132:135]
  v_mfma_f32_16x16x32_bf16 v[140:143], v[232:235], a[232:235], v[140:143]
  buffer_store_dwordx4 v[40:43], v4, s[24:27], s69 offen offset:0 sc1
  v_mfma_f32_16x16x32_bf16 v[104:107], v[212:215], a[140:143], v[104:107]
  v_mfma_f32_16x16x32_bf16 v[112:115], v[212:215], a[164:167], v[112:115]
  v_mfma_f32_16x16x32_bf16 v[120:123], v[212:215], a[188:191], v[120:123]
  s_waitcnt vmcnt(12)
  s_mov_b32 s50, s46
  s_add_u32 s69, s45, s40
  v_mfma_f32_16x16x32_bf16 v[128:131], v[212:215], a[212:215], v[128:131]
  s_mov_b32 s40, 0
  s_sub_i32 s69, s69, 1
  s_max_i32 s69, s69, s70
  v_mfma_f32_16x16x32_bf16 v[136:139], v[212:215], a[236:239], v[136:139]
  s_add_u32 s45, s45, 1
  s_mov_b32 s68, s42
  s_add_u32 s42, s42, 1310720
  v_mfma_f32_16x16x32_bf16 v[108:111], v[236:239], a[140:143], v[108:111]
  s_add_u32 s21, s45, 1
  s_min_u32 s21, s21, 63
  v_mfma_f32_16x16x32_bf16 v[116:119], v[236:239], a[164:167], v[116:119]
  s_cmp_lt_u32 s21, s50
  s_addc_u32 s21, s31, s31
  v_mov_b32 v21, s21
  v_mfma_f32_16x16x32_bf16 v[124:127], v[236:239], a[188:191], v[124:127]
  ds_write_b32 v6, v21 offset:0
  v_mfma_f32_16x16x32_bf16 v[132:135], v[236:239], a[212:215], v[132:135]
  v_mfma_f32_16x16x32_bf16 v[140:143], v[236:239], a[236:239], v[140:143]
  s_mov_b64 exec, 1
  v_mov_b32 v20, s69
  buffer_store_dword v20, v10, s[72:75], s44 offen sc1
  s_mov_b64 exec, -1
  s_cmp_le_u32 s45, 16
  s_cbranch_scc1 vwe_192
vwe_193:
  s_cmp_lg_u32 s45, 48
  s_cbranch_scc1 arm_196
  s_mul_i32 s21, s2, 10240
  s_mul_i32 s22, s20, 2560
  s_add_u32 s21, s21, s22
  s_add_u32 s21, s21, 18350080
  buffer_store_dwordx4 v[244:247], v15, s[80:83], s21 offen offset:0 sc1
  buffer_store_dwordx4 v[244:247], v15, s[80:83], s21 offen offset:512 sc1
  buffer_store_dwordx4 v[244:247], v15, s[80:83], s21 offen offset:1024 sc1
  buffer_store_dwordx4 v[244:247], v15, s[80:83], s21 offen offset:1536 sc1
  buffer_store_dwordx4 v[244:247], v15, s[80:83], s21 offen offset:2048 sc1
  s_add_u32 s21, s21, 655360
  buffer_store_dwordx4 v[244:247], v15, s[80:83], s21 offen offset:0 sc1
  buffer_store_dwordx4 v[244:247], v15, s[80:83], s21 offen offset:512 sc1
  buffer_store_dwordx4 v[244:247], v15, s[80:83], s21 offen offset:1024 sc1
  buffer_store_dwordx4 v[244:247], v15, s[80:83], s21 offen offset:1536 sc1
  buffer_store_dwordx4 v[244:247], v15, s[80:83], s21 offen offset:2048 sc1
  s_add_u32 s21, s21, 655360
  buffer_store_dwordx4 v[244:247], v15, s[80:83], s21 offen offset:0 sc1
  buffer_store_dwordx4 v[244:247], v15, s[80:83], s21 offen offset:512 sc1
  buffer_store_dwordx4 v[244:247], v15, s[80:83], s21 offen offset:1024 sc1
  buffer_store_dwordx4 v[244:247], v15, s[80:83], s21 offen offset:1536 sc1
  buffer_store_dwordx4 v[244:247], v15, s[80:83], s21 offen offset:2048 sc1
  s_add_u32 s21, s21, 655360
  buffer_store_dwordx4 v[244:247], v15, s[80:83], s21 offen offset:0 sc1
  buffer_store_dwordx4 v[244:247], v15, s[80:83], s21 offen offset:512 sc1
  buffer_store_dwordx4 v[244:247], v15, s[80:83], s21 offen offset:1024 sc1
  buffer_store_dwordx4 v[244:247], v15, s[80:83], s21 offen offset:1536 sc1
  buffer_store_dwordx4 v[244:247], v15, s[80:83], s21 offen offset:2048 sc1
  s_add_u32 s21, s21, 655360
  s_and_b32 s21, s2, 3
  s_cmp_lg_u32 s21, s20
  s_cbranch_scc1 arm_196
  s_mul_i32 s21, s2, 2560
  s_add_u32 s21, s21, 4587520
  v_lshlrev_b32 v21, 3, v1
  buffer_store_dwordx4 v[244:247], v4, s[88:91], s21 offen sc1
  buffer_store_dwordx4 v[244:247], v4, s[88:91], s21 offen offset:1024 sc1
  buffer_store_dwordx2 v[244:245], v21, s[88:91], s21 offen offset:2048 sc1
  s_add_u32 s21, s21, 81920
  buffer_store_dwordx4 v[244:247], v4, s[88:91], s21 offen sc1
  buffer_store_dwordx4 v[244:247], v4, s[88:91], s21 offen offset:1024 sc1
  buffer_store_dwordx2 v[244:245], v21, s[88:91], s21 offen offset:2048 sc1
  s_add_u32 s21, s21, 81920
  buffer_store_dwordx4 v[244:247], v4, s[88:91], s21 offen sc1
  buffer_store_dwordx4 v[244:247], v4, s[88:91], s21 offen offset:1024 sc1
  buffer_store_dwordx2 v[244:245], v21, s[88:91], s21 offen offset:2048 sc1
  s_add_u32 s21, s21, 81920
  buffer_store_dwordx4 v[244:247], v4, s[88:91], s21 offen sc1
  buffer_store_dwordx4 v[244:247], v4, s[88:91], s21 offen offset:1024 sc1
  buffer_store_dwordx2 v[244:245], v21, s[88:91], s21 offen offset:2048 sc1
  s_add_u32 s21, s21, 81920
  buffer_store_dwordx4 v[244:247], v4, s[88:91], s21 offen sc1
  buffer_store_dwordx4 v[244:247], v4, s[88:91], s21 offen offset:1024 sc1
  buffer_store_dwordx2 v[244:245], v21, s[88:91], s21 offen offset:2048 sc1
  s_add_u32 s21, s21, 81920
  buffer_store_dwordx4 v[244:247], v4, s[88:91], s21 offen sc1
  buffer_store_dwordx4 v[244:247], v4, s[88:91], s21 offen offset:1024 sc1
  buffer_store_dwordx2 v[244:245], v21, s[88:91], s21 offen offset:2048 sc1
  s_add_u32 s21, s21, 81920
  buffer_store_dwordx4 v[244:247], v4, s[88:91], s21 offen sc1
  buffer_store_dwordx4 v[244:247], v4, s[88:91], s21 offen offset:1024 sc1
  buffer_store_dwordx2 v[244:245], v21, s[88:91], s21 offen offset:2048 sc1
  s_add_u32 s21, s21, 81920
  buffer_store_dwordx4 v[244:247], v4, s[88:91], s21 offen sc1
  buffer_store_dwordx4 v[244:247], v4, s[88:91], s21 offen offset:1024 sc1
  buffer_store_dwordx2 v[244:245], v21, s[88:91], s21 offen offset:2048 sc1
  s_add_u32 s21, s21, 81920
arm_196:
  s_cmp_ge_u32 s45, 64
  s_cbranch_scc1 vwd_179
  s_cmp_lg_u32 s23, 0
  s_cbranch_scc1 vwl_178
  s_branch vws_190
vws_182:
  v_cmp_gt_u32 vcc, 8, v9
  s_nop 0
  s_bitset1_b64 vcc, 19
  s_ff1_i32_b64 s21, vcc
  s_lshl_b32 s22, s21, 1
  s_lshl_b32 s21, s21, 2
  s_sub_i32 s21, s21, 12
  s_max_i32 s47, s21, s22
  s_cmp_gt_u32 s47, s45
  s_cbranch_scc1 va_198
  s_cmp_eq_u32 s70, s45
  s_cbranch_scc1 va_203
  s_nop 4
  v_cvt_pk_bf16_f32 v44, v104, v105
  v_cvt_pk_bf16_f32 v45, v106, v107
  v_cvt_pk_bf16_f32 v46, v108, v109
  v_cvt_pk_bf16_f32 v47, v110, v111
  s_add_u32 s69, s68, 4096
  buffer_store_dwordx4 v[44:47], v4, s[24:27], s69 offen offset:1024 sc1
  v_cvt_pk_bf16_f32 v48, v112, v113
  v_cvt_pk_bf16_f32 v49, v114, v115
  v_cvt_pk_bf16_f32 v50, v116, v117
  v_cvt_pk_bf16_f32 v51, v118, v119
  buffer_store_dwordx4 v[48:51], v4, s[24:27], s69 offen offset:2048 sc1
  v_cvt_pk_bf16_f32 v52, v120, v121
  v_cvt_pk_bf16_f32 v53, v122, v123
  v_cvt_pk_bf16_f32 v54, v124, v125
  v_cvt_pk_bf16_f32 v55, v126, v127
  buffer_store_dwordx4 v[52:55], v4, s[24:27], s69 offen offset:3072 sc1
  v_cvt_pk_bf16_f32 v56, v128, v129
  v_cvt_pk_bf16_f32 v57, v130, v131
  v_cvt_pk_bf16_f32 v58, v132, v133
  v_cvt_pk_bf16_f32 v59, v134, v135
  s_add_u32 s69, s68, 8192
  buffer_store_dwordx4 v[56:59], v4, s[24:27], s69 offen offset:0 sc1
  v_cvt_pk_bf16_f32 v60, v136, v137
  v_cvt_pk_bf16_f32 v61, v138, v139
  v_cvt_pk_bf16_f32 v62, v140, v141
  v_cvt_pk_bf16_f32 v63, v142, v143
  buffer_store_dwordx4 v[60:63], v4, s[24:27], s69 offen offset:1024 sc1
  s_mov_b32 s68, 0x80000000
  s_waitcnt vmcnt(0)
  s_mov_b64 exec, 1
  v_mov_b32 v20, s45
  buffer_store_dword v20, v10, s[72:75], s44 offen sc1
  s_mov_b64 exec, -1
  s_mov_b32 s70, s45
  s_mov_b32 s40, 0
va_203:
  s_mov_b32 s101, 0
  s_branch va_201
va_199:
  s_sleep 8
va_201:
  buffer_load_dword v9, v5, s[72:75], s43 offen sc1
  s_add_u32 s101, s101, 1
  s_cmp_gt_u32 s101, 131072
  s_cbranch_scc1 main_end
  s_waitcnt vmcnt(0)
  v_cmp_gt_u32 vcc, 8, v9
  s_nop 0
  s_bitset1_b64 vcc, 19
  s_ff1_i32_b64 s21, vcc
  s_lshl_b32 s22, s21, 1
  s_lshl_b32 s21, s21, 2
  s_sub_i32 s21, s21, 12
  s_max_i32 s47, s21, s22
  s_cmp_gt_u32 s47, s45
  s_cbranch_scc0 va_199
va_198:
  s_add_u32 s22, s45, 6
  s_min_u32 s22, s22, s47
va_200:
  s_cmp_ge_u32 s46, s22
  s_cbranch_scc1 va_202
  s_mov_b32 m0, s64
  s_mov_b32 s66, s41
  buffer_load_dwordx4 v4, s[16:19], s66 offen offset:0 sc1 lds
  buffer_load_dwordx4 v4, s[16:19], s66 offen offset:1024 sc1 lds
  buffer_load_dwordx4 v4, s[16:19], s66 offen offset:2048 sc1 lds
  s_add_u32 s46, s46, 1
  s_add_u32 s41, s41, 393216
  s_add_u32 s64, s64, 12288
  s_cmp_lt_u32 s64, s67
  s_cselect_b32 s64, s64, s71
  s_branch va_200
va_202:
  s_mov_b32 s48, s46
  s_mov_b32 s49, s46
  s_mov_b32 s50, s46
  s_waitcnt vmcnt(0)
  s_cmp_eq_u32 s40, 0
  s_cbranch_scc1 va_204
  s_mov_b32 s40, 0
  s_mov_b64 exec, 1
  v_mov_b32 v20, s45
  buffer_store_dword v20, v10, s[72:75], s44 offen sc1
  s_mov_b64 exec, -1
  s_mov_b32 s70, s45
va_204:
  s_barrier
  ds_read_b128 v[192:195], v8 offset:0
  ds_read_b128 v[196:199], v8 offset:1024
  ds_read_b128 v[200:203], v8 offset:2048
  ds_read_b128 v[204:207], v8 offset:3072
  ds_read_b128 v[208:211], v8 offset:4096
  ds_read_b128 v[212:215], v8 offset:5120
  ds_read_b128 v[216:219], v8 offset:6144
  ds_read_b128 v[220:223], v8 offset:7168
  ds_read_b128 v[224:227], v8 offset:8192
  ds_read_b128 v[228:231], v8 offset:9216
  ds_read_b128 v[232:235], v8 offset:10240
  ds_read_b128 v[236:239], v8 offset:11264
  s_add_u32 s21, s45, 1
  s_min_u32 s21, s21, 63
  s_cmp_lt_u32 s21, s50
  s_addc_u32 s21, s31, s31
  v_mov_b32 v21, s21
  ds_write_b32 v6, v21 offset:16
  s_branch vwb_183
vws_190:
  v_cmp_gt_u32 vcc, 8, v9
  s_nop 0
  s_bitset1_b64 vcc, 19
  s_ff1_i32_b64 s21, vcc
  s_lshl_b32 s22, s21, 1
  s_lshl_b32 s21, s21, 2
  s_sub_i32 s21, s21, 12
  s_max_i32 s47, s21, s22
  s_cmp_gt_u32 s47, s45
  s_cbranch_scc1 va_205
  s_cmp_eq_u32 s70, s45
  s_cbranch_scc1 va_210
  s_nop 4
  v_cvt_pk_bf16_f32 v44, v104, v105
  v_cvt_pk_bf16_f32 v45, v106, v107
  v_cvt_pk_bf16_f32 v46, v108, v109
  v_cvt_pk_bf16_f32 v47, v110, v111
  s_add_u32 s69, s68, 4096
  buffer_store_dwordx4 v[44:47], v4, s[24:27], s69 offen offset:1024 sc1
  v_cvt_pk_bf16_f32 v48, v112, v113
  v_cvt_pk_bf16_f32 v49, v114, v115
  v_cvt_pk_bf16_f32 v50, v116, v117
  v_cvt_pk_bf16_f32 v51, v118, v119
  buffer_store_dwordx4 v[48:51], v4, s[24:27], s69 offen offset:2048 sc1
  v_cvt_pk_bf16_f32 v52, v120, v121
  v_cvt_pk_bf16_f32 v53, v122, v123
  v_cvt_pk_bf16_f32 v54, v124, v125
  v_cvt_pk_bf16_f32 v55, v126, v127
  buffer_store_dwordx4 v[52:55], v4, s[24:27], s69 offen offset:3072 sc1
  v_cvt_pk_bf16_f32 v56, v128, v129
  v_cvt_pk_bf16_f32 v57, v130, v131
  v_cvt_pk_bf16_f32 v58, v132, v133
  v_cvt_pk_bf16_f32 v59, v134, v135
  s_add_u32 s69, s68, 8192
  buffer_store_dwordx4 v[56:59], v4, s[24:27], s69 offen offset:0 sc1
  v_cvt_pk_bf16_f32 v60, v136, v137
  v_cvt_pk_bf16_f32 v61, v138, v139
  v_cvt_pk_bf16_f32 v62, v140, v141
  v_cvt_pk_bf16_f32 v63, v142, v143
  buffer_store_dwordx4 v[60:63], v4, s[24:27], s69 offen offset:1024 sc1
  s_mov_b32 s68, 0x80000000
  s_waitcnt vmcnt(0)
  s_mov_b64 exec, 1
  v_mov_b32 v20, s45
  buffer_store_dword v20, v10, s[72:75], s44 offen sc1
  s_mov_b64 exec, -1
  s_mov_b32 s70, s45
  s_mov_b32 s40, 0
va_210:
  s_mov_b32 s101, 0
  s_branch va_208
va_206:
  s_sleep 8
va_208:
  buffer_load_dword v9, v5, s[72:75], s43 offen sc1
  s_add_u32 s101, s101, 1
  s_cmp_gt_u32 s101, 131072
  s_cbranch_scc1 main_end
  s_waitcnt vmcnt(0)
  v_cmp_gt_u32 vcc, 8, v9
  s_nop 0
  s_bitset1_b64 vcc, 19
  s_ff1_i32_b64 s21, vcc
  s_lshl_b32 s22, s21, 1
  s_lshl_b32 s21, s21, 2
  s_sub_i32 s21, s21, 12
  s_max_i32 s47, s21, s22
  s_cmp_gt_u32 s47, s45
  s_cbranch_scc0 va_206
va_205:
  s_add_u32 s22, s45, 6
  s_min_u32 s22, s22, s47
va_207:
  s_cmp_ge_u32 s46, s22
  s_cbranch_scc1 va_209
  s_mov_b32 m0, s64
  s_mov_b32 s66, s41
  buffer_load_dwordx4 v4, s[16:19], s66 offen offset:0 sc1 lds
  buffer_load_dwordx4 v4, s[16:19], s66 offen offset:1024 sc1 lds
  buffer_load_dwordx4 v4, s[16:19], s66 offen offset:2048 sc1 lds
  s_add_u32 s46, s46, 1
  s_add_u32 s41, s41, 393216
  s_add_u32 s64, s64, 12288
  s_cmp_lt_u32 s64, s67
  s_cselect_b32 s64, s64, s71
  s_branch va_207
va_209:
  s_mov_b32 s48, s46
  s_mov_b32 s49, s46
  s_mov_b32 s50, s46
  s_waitcnt vmcnt(0)
  s_cmp_eq_u32 s40, 0
  s_cbranch_scc1 va_211
  s_mov_b32 s40, 0
  s_mov_b64 exec, 1
  v_mov_b32 v20, s45
  buffer_store_dword v20, v10, s[72:75], s44 offen sc1
  s_mov_b64 exec, -1
  s_mov_b32 s70, s45
va_211:
  s_barrier
  ds_read_b128 v[144:147], v8 offset:0
  ds_read_b128 v[148:151], v8 offset:1024
  ds_read_b128 v[152:155], v8 offset:2048
  ds_read_b128 v[156:159], v8 offset:3072
  ds_read_b128 v[160:163], v8 offset:4096
  ds_read_b128 v[164:167], v8 offset:5120
  ds_read_b128 v[168:171], v8 offset:6144
  ds_read_b128 v[172:175], v8 offset:7168
  ds_read_b128 v[176:179], v8 offset:8192
  ds_read_b128 v[180:183], v8 offset:9216
  ds_read_b128 v[184:187], v8 offset:10240
  ds_read_b128 v[188:191], v8 offset:11264
  s_add_u32 s21, s45, 1
  s_min_u32 s21, s21, 63
  s_cmp_lt_u32 s21, s50
  s_addc_u32 s21, s31, s31
  v_mov_b32 v21, s21
  ds_write_b32 v6, v21 offset:0
  s_branch vwl_178
vwe_184:
  s_nop 4
  v_cvt_pk_bf16_f32 v44, v104, v105
  v_cvt_pk_bf16_f32 v45, v106, v107
  v_cvt_pk_bf16_f32 v46, v108, v109
  v_cvt_pk_bf16_f32 v47, v110, v111
  s_add_u32 s69, s68, 4096
  buffer_store_dwordx4 v[44:47], v4, s[24:27], s69 offen offset:1024 sc1
  v_cvt_pk_bf16_f32 v48, v112, v113
  v_cvt_pk_bf16_f32 v49, v114, v115
  v_cvt_pk_bf16_f32 v50, v116, v117
  v_cvt_pk_bf16_f32 v51, v118, v119
  buffer_store_dwordx4 v[48:51], v4, s[24:27], s69 offen offset:2048 sc1
  v_cvt_pk_bf16_f32 v52, v120, v121
  v_cvt_pk_bf16_f32 v53, v122, v123
  v_cvt_pk_bf16_f32 v54, v124, v125
  v_cvt_pk_bf16_f32 v55, v126, v127
  buffer_store_dwordx4 v[52:55], v4, s[24:27], s69 offen offset:3072 sc1
  v_cvt_pk_bf16_f32 v56, v128, v129
  v_cvt_pk_bf16_f32 v57, v130, v131
  v_cvt_pk_bf16_f32 v58, v132, v133
  v_cvt_pk_bf16_f32 v59, v134, v135
  s_add_u32 s69, s68, 8192
  buffer_store_dwordx4 v[56:59], v4, s[24:27], s69 offen offset:0 sc1
  v_cvt_pk_bf16_f32 v60, v136, v137
  v_cvt_pk_bf16_f32 v61, v138, v139
  v_cvt_pk_bf16_f32 v62, v140, v141
  v_cvt_pk_bf16_f32 v63, v142, v143
  buffer_store_dwordx4 v[60:63], v4, s[24:27], s69 offen offset:1024 sc1
  s_mov_b32 s68, 0x80000000
  s_cmp_le_u32 s45, 4
  s_cselect_b32 s40, 3, 1
  s_branch vwe_185
vwe_192:
  s_nop 4
  v_cvt_pk_bf16_f32 v44, v104, v105
  v_cvt_pk_bf16_f32 v45, v106, v107
  v_cvt_pk_bf16_f32 v46, v108, v109
  v_cvt_pk_bf16_f32 v47, v110, v111
  s_add_u32 s69, s68, 4096
  buffer_store_dwordx4 v[44:47], v4, s[24:27], s69 offen offset:1024 sc1
  v_cvt_pk_bf16_f32 v48, v112, v113
  v_cvt_pk_bf16_f32 v49, v114, v115
  v_cvt_pk_bf16_f32 v50, v116, v117
  v_cvt_pk_bf16_f32 v51, v118, v119
  buffer_store_dwordx4 v[48:51], v4, s[24:27], s69 offen offset:2048 sc1
  v_cvt_pk_bf16_f32 v52, v120, v121
  v_cvt_pk_bf16_f32 v53, v122, v123
  v_cvt_pk_bf16_f32 v54, v124, v125
  v_cvt_pk_bf16_f32 v55, v126, v127
  buffer_store_dwordx4 v[52:55], v4, s[24:27], s69 offen offset:3072 sc1
  v_cvt_pk_bf16_f32 v56, v128, v129
  v_cvt_pk_bf16_f32 v57, v130, v131
  v_cvt_pk_bf16_f32 v58, v132, v133
  v_cvt_pk_bf16_f32 v59, v134, v135
  s_add_u32 s69, s68, 8192
  buffer_store_dwordx4 v[56:59], v4, s[24:27], s69 offen offset:0 sc1
  v_cvt_pk_bf16_f32 v60, v136, v137
  v_cvt_pk_bf16_f32 v61, v138, v139
  v_cvt_pk_bf16_f32 v62, v140, v141
  v_cvt_pk_bf16_f32 v63, v142, v143
  buffer_store_dwordx4 v[60:63], v4, s[24:27], s69 offen offset:1024 sc1
  s_mov_b32 s68, 0x80000000
  s_cmp_le_u32 s45, 4
  s_cselect_b32 s40, 3, 1
  s_branch vwe_193
vwm_180:
  s_mov_b32 s40, 0
  s_waitcnt vmcnt(11)
  s_mov_b64 exec, 1
  v_mov_b32 v20, s45
  buffer_store_dword v20, v10, s[72:75], s44 offen sc1
  s_mov_b64 exec, -1
  s_mov_b32 s70, s45
  s_branch vwm_181
vwm_188:
  s_mov_b32 s40, 0
  s_waitcnt vmcnt(11)
  s_mov_b64 exec, 1
  v_mov_b32 v20, s45
  buffer_store_dword v20, v10, s[72:75], s44 offen sc1
  s_mov_b64 exec, -1
  s_mov_b32 s70, s45
  s_branch vwm_189
vwd_179:
  s_nop 4
  v_cvt_pk_bf16_f32 v44, v104, v105
  v_cvt_pk_bf16_f32 v45, v106, v107
  v_cvt_pk_bf16_f32 v46, v108, v109
  v_cvt_pk_bf16_f32 v47, v110, v111
  s_add_u32 s69, s68, 4096
  buffer_store_dwordx4 v[44:47], v4, s[24:27], s69 offen offset:1024 sc1
  v_cvt_pk_bf16_f32 v48, v112, v113
  v_cvt_pk_bf16_f32 v49, v114, v115
  v_cvt_pk_bf16_f32 v50, v116, v117
  v_cvt_pk_bf16_f32 v51, v118, v119
  buffer_store_dwordx4 v[48:51], v4, s[24:27], s69 offen offset:2048 sc1
  v_cvt_pk_bf16_f32 v52, v120, v121
  v_cvt_pk_bf16_f32 v53, v122, v123
  v_cvt_pk_bf16_f32 v54, v124, v125
  v_cvt_pk_bf16_f32 v55, v126, v127
  buffer_store_dwordx4 v[52:55], v4, s[24:27], s69 offen offset:3072 sc1
  v_cvt_pk_bf16_f32 v56, v128, v129
  v_cvt_pk_bf16_f32 v57, v130, v131
  v_cvt_pk_bf16_f32 v58, v132, v133
  v_cvt_pk_bf16_f32 v59, v134, v135
  s_add_u32 s69, s68, 8192
  buffer_store_dwordx4 v[56:59], v4, s[24:27], s69 offen offset:0 sc1
  v_cvt_pk_bf16_f32 v60, v136, v137
  v_cvt_pk_bf16_f32 v61, v138, v139
  v_cvt_pk_bf16_f32 v62, v140, v141
  v_cvt_pk_bf16_f32 v63, v142, v143
  buffer_store_dwordx4 v[60:63], v4, s[24:27], s69 offen offset:1024 sc1
  s_waitcnt vmcnt(0)
  s_mov_b64 exec, 1
  v_mov_b32 v20, s45
  buffer_store_dword v20, v10, s[72:75], s44 offen sc1
  s_mov_b64 exec, -1
  s_mov_b32 s84, 0
  s_mov_b32 s85, -1
  s_and_b32 s21, s3, 3
  s_cmp_lt_u32 s21, 1
  s_cbranch_scc1 queue
  s_sub_u32 s22, s21, 1
  s_lshl_b32 s22, s22, 3
  s_bfe_u32 s21, s3, 0x30002
  s_add_u32 s21, s21, s22
  s_add_u32 s87, s21, 366
  s_waitcnt vmcnt(0) lgkmcnt(0)
  s_barrier
  s_branch do_opb2
  s_mov_b32 s84, 0
  s_mov_b32 s85, -1
  s_mov_b32 s86, 0
  s_branch queue
not_vw:
  s_sub_u32 s2, s3, 96
  s_cmp_lg_u32 s2, 31
  s_cbranch_scc1 not_cal
  s_add_u32 s8, s38, 83886079
  s_addc_u32 s9, s39, 0
  s_and_b32 s8, s8, 0xffe00000
  s_mov_b32 s10, 2097152
  s_mov_b32 s11, 0x00020000
  v_lshrrev_b32 v9, 4, v0
  v_mul_u32_u24 v9, 16640, v9
  v_bfe_u32 v10, v0, 3, 1
  v_lshl_add_u32 v9, v10, 13, v9
  v_and_b32 v10, 7, v0
  v_lshl_add_u32 v9, v10, 4, v9
  s_mov_b32 s21, 1048576
  buffer_store_dwordx4 v[4:7], v9, s[8:11], s21 offen sc1
  s_waitcnt vmcnt(0)
  s_barrier
  s_cmp_lg_u32 s20, 3
  s_cbranch_scc1 cal_212
  s_mov_b64 exec, 1
  v_mov_b32 v4, 0
  s_mov_b32 s40, -1
  s_mov_b32 s41, -1
  s_mov_b32 s42, 1048576
  s_mov_b32 s43, 0
  s_waitcnt vmcnt(0)
cal_213:
  s_add_u32 s21, s42, 0
  s_memtime s[98:99]
  s_waitcnt lgkmcnt(0)
  buffer_load_dword v5, v4, s[8:11], s21 offen sc1
  s_waitcnt vmcnt(0)
  s_memtime s[100:101]
  s_waitcnt lgkmcnt(0)
  s_sub_u32 s21, s100, s98
  s_min_u32 s40, s40, s21
  s_add_u32 s21, s42, 8192
  s_memtime s[98:99]
  s_waitcnt lgkmcnt(0)
  buffer_load_dword v5, v4, s[8:11], s21 offen sc1
  s_waitcnt vmcnt(0)
  s_memtime s[100:101]
  s_waitcnt lgkmcnt(0)
  s_sub_u32 s21, s100, s98
  s_min_u32 s41, s41, s21
  s_add_u32 s42, s42, 16640
  s_add_u32 s43, s43, 1
  s_cmp_lt_u32 s43, 4
  s_cbranch_scc1 cal_213
  s_cmp_lt_u32 s41, s40
  s_cselect_b32 s21, 1, 2
  v_mov_b32 v4, s21
  v_mov_b32 v5, s40
  v_mov_b32 v6, s41
  v_mov_b32 v8, 84
  buffer_store_dwordx3 v[4:6], v8, s[32:35], 0 offen sc1
  s_waitcnt vmcnt(0)
  s_mov_b64 exec, -1
cal_212:
  s_barrier
  s_branch armed
not_cal:
  s_sleep 32
  s_sleep 32
  s_sleep 32
  s_sleep 32
  s_sleep 32
armed:
  s_load_dwordx2 s[72:73], s[0:1], 104
  s_waitcnt lgkmcnt(0)
  s_add_u32 s72, s72, 81068032
  s_addc_u32 s73, s73, 0
  s_mov_b32 s74, 116736
  s_mov_b32 s75, 0x00020000
  s_load_dwordx2 s[4:5], s[0:1], 0
  s_load_dwordx2 s[6:7], s[0:1], 64
  s_load_dwordx2 s[38:39], s[0:1], 104
  s_lshr_b32 s41, s2, 1
  s_and_b32 s42, s2, 1
  s_waitcnt lgkmcnt(0)
  s_mov_b32 s8, s4
  s_mov_b32 s9, s5
  s_mov_b32 s10, 2621440
  s_mov_b32 s11, 0x00020000
  s_mov_b32 s12, s6
  s_mov_b32 s13, s7
  s_mov_b32 s14, 2457600
  s_mov_b32 s15, 0x00020000
  s_add_u32 s16, s38, 70713344
  s_addc_u32 s17, s39, 0
  s_mov_b32 s18, 2641920
  s_mov_b32 s19, 0x00020000
  s_add_u32 s72, s38, 81068032
  s_addc_u32 s73, s39, 0
  s_mov_b32 s74, 116736
  s_mov_b32 s75, 0x00020000
  v_lshlrev_b32 v6, 1, v3
  v_add_u32 v6, 0, v6
  v_xor_b32 v6, v6, v2
  v_min_u32 v6, 14, v6
  v_mul_u32_u24 v7, 52, v6
  v_lshrrev_b32 v7, 8, v7
  v_mul_u32_u24 v7, 1200, v7
  v_lshl_add_u32 v7, v6, 4, v7
  v_mul_u32_u24 v6, 3840, v3
  v_add_u32 v4, v6, v7
  v_lshlrev_b32 v6, 1, v3
  v_add_u32 v6, 8, v6
  v_xor_b32 v6, v6, v2
  v_min_u32 v6, 14, v6
  v_mul_u32_u24 v7, 52, v6
  v_lshrrev_b32 v7, 8, v7
  v_mul_u32_u24 v7, 1200, v7
  v_lshl_add_u32 v7, v6, 4, v7
  v_mul_u32_u24 v6, 3840, v3
  v_add_u32 v5, v6, v7
  s_mul_i32 s21, s41, 80
  s_mul_i32 s22, s20, 15360
  s_add_u32 s21, s21, s22
  s_lshl_b32 s22, s20, 10
  s_cmp_ge_u32 s20, 2
  s_cselect_b64 vcc, -1, 0
  v_cndmask_b32 v4, v4, v5, vcc
  s_add_u32 m0, s22, 0
  s_nop 0
  buffer_load_dwordx4 v4, s[12:15], s21 offen lds
  s_add_u32 s21, s21, 61440
  s_add_u32 m0, s22, 4096
  s_nop 0
  buffer_load_dwordx4 v4, s[12:15], s21 offen lds
  s_add_u32 s21, s21, 61440
  s_add_u32 m0, s22, 8192
  s_nop 0
  buffer_load_dwordx4 v4, s[12:15], s21 offen lds
  s_add_u32 s21, s21, 61440
  s_add_u32 m0, s22, 12288
  s_nop 0
  buffer_load_dwordx4 v4, s[12:15], s21 offen lds
  s_add_u32 s21, s21, 61440
  s_add_u32 m0, s22, 16384
  s_nop 0
  buffer_load_dwordx4 v4, s[12:15], s21 offen lds
  s_add_u32 s21, s21, 61440
  s_add_u32 m0, s22, 20480
  s_nop 0
  buffer_load_dwordx4 v4, s[12:15], s21 offen lds
  s_add_u32 s21, s21, 61440
  s_add_u32 m0, s22, 24576
  s_nop 0
  buffer_load_dwordx4 v4, s[12:15], s21 offen lds
  s_add_u32 s21, s21, 61440
  s_add_u32 m0, s22, 28672
  s_nop 0
  buffer_load_dwordx4 v4, s[12:15], s21 offen lds
  s_add_u32 s21, s21, 61440
  s_add_u32 m0, s22, 32768
  s_nop 0
  buffer_load_dwordx4 v4, s[12:15], s21 offen lds
  s_add_u32 s21, s21, 61440
  s_add_u32 m0, s22, 36864
  s_nop 0
  buffer_load_dwordx4 v4, s[12:15], s21 offen lds
  s_add_u32 s21, s21, 61440
  s_add_u32 m0, s22, 40960
  s_nop 0
  buffer_load_dwordx4 v4, s[12:15], s21 offen lds
  s_add_u32 s21, s21, 61440
  s_add_u32 m0, s22, 45056
  s_nop 0
  buffer_load_dwordx4 v4, s[12:15], s21 offen lds
  s_add_u32 s21, s21, 61440
  s_add_u32 m0, s22, 49152
  s_nop 0
  buffer_load_dwordx4 v4, s[12:15], s21 offen lds
  s_add_u32 s21, s21, 61440
  s_add_u32 m0, s22, 53248
  s_nop 0
  buffer_load_dwordx4 v4, s[12:15], s21 offen lds
  s_add_u32 s21, s21, 61440
  s_add_u32 m0, s22, 57344
  s_nop 0
  buffer_load_dwordx4 v4, s[12:15], s21 offen lds
  s_add_u32 s21, s21, 61440
  s_add_u32 m0, s22, 61440
  s_nop 0
  buffer_load_dwordx4 v4, s[12:15], s21 offen lds
  s_add_u32 s21, s21, 61440
  s_add_u32 m0, s22, 65536
  s_nop 0
  buffer_load_dwordx4 v4, s[12:15], s21 offen lds
  s_add_u32 s21, s21, 61440
  s_add_u32 m0, s22, 69632
  s_nop 0
  buffer_load_dwordx4 v4, s[12:15], s21 offen lds
  s_add_u32 s21, s21, 61440
  s_add_u32 m0, s22, 73728
  s_nop 0
  buffer_load_dwordx4 v4, s[12:15], s21 offen lds
  s_add_u32 s21, s21, 61440
  s_add_u32 m0, s22, 77824
  s_nop 0
  buffer_load_dwordx4 v4, s[12:15], s21 offen lds
  s_add_u32 s21, s21, 61440
  s_add_u32 m0, s22, 81920
  s_nop 0
  buffer_load_dwordx4 v4, s[12:15], s21 offen lds
  s_add_u32 s21, s21, 61440
  s_add_u32 m0, s22, 86016
  s_nop 0
  buffer_load_dwordx4 v4, s[12:15], s21 offen lds
  s_add_u32 s21, s21, 61440
  s_add_u32 m0, s22, 90112
  s_nop 0
  buffer_load_dwordx4 v4, s[12:15], s21 offen lds
  s_add_u32 s21, s21, 61440
  s_add_u32 m0, s22, 94208
  s_nop 0
  buffer_load_dwordx4 v4, s[12:15], s21 offen lds
  s_add_u32 s21, s21, 61440
  s_add_u32 m0, s22, 98304
  s_nop 0
  buffer_load_dwordx4 v4, s[12:15], s21 offen lds
  s_add_u32 s21, s21, 61440
  s_add_u32 m0, s22, 102400
  s_nop 0
  buffer_load_dwordx4 v4, s[12:15], s21 offen lds
  s_add_u32 s21, s21, 61440
  s_add_u32 m0, s22, 106496
  s_nop 0
  buffer_load_dwordx4 v4, s[12:15], s21 offen lds
  s_add_u32 s21, s21, 61440
  s_add_u32 m0, s22, 110592
  s_nop 0
  buffer_load_dwordx4 v4, s[12:15], s21 offen lds
  s_add_u32 s21, s21, 61440
  s_add_u32 m0, s22, 114688
  s_nop 0
  buffer_load_dwordx4 v4, s[12:15], s21 offen lds
  s_add_u32 s21, s21, 61440
  s_add_u32 m0, s22, 118784
  s_nop 0
  buffer_load_dwordx4 v4, s[12:15], s21 offen lds
  s_add_u32 s21, s21, 61440
  s_add_u32 m0, s22, 122880
  s_nop 0
  buffer_load_dwordx4 v4, s[12:15], s21 offen lds
  s_add_u32 s21, s21, 61440
  s_add_u32 m0, s22, 126976
  s_nop 0
  buffer_load_dwordx4 v4, s[12:15], s21 offen lds
  s_add_u32 s21, s21, 61440
  s_add_u32 m0, s22, 131072
  s_nop 0
  buffer_load_dwordx4 v4, s[12:15], s21 offen lds
  s_add_u32 s21, s21, 61440
  s_add_u32 m0, s22, 135168
  s_nop 0
  buffer_load_dwordx4 v4, s[12:15], s21 offen lds
  s_add_u32 s21, s21, 61440
  s_add_u32 m0, s22, 139264
  s_nop 0
  buffer_load_dwordx4 v4, s[12:15], s21 offen lds
  s_add_u32 s21, s21, 61440
  s_add_u32 m0, s22, 143360
  s_nop 0
  buffer_load_dwordx4 v4, s[12:15], s21 offen lds
  s_add_u32 s21, s21, 61440
  s_add_u32 m0, s22, 147456
  s_nop 0
  buffer_load_dwordx4 v4, s[12:15], s21 offen lds
  s_add_u32 s21, s21, 61440
  s_add_u32 m0, s22, 151552
  s_nop 0
  buffer_load_dwordx4 v4, s[12:15], s21 offen lds
  s_add_u32 s21, s21, 61440
  s_add_u32 m0, s22, 155648
  s_nop 0
  buffer_load_dwordx4 v4, s[12:15], s21 offen lds
  s_add_u32 s21, s21, 61440
  s_add_u32 m0, s22, 159744
  s_nop 0
  buffer_load_dwordx4 v4, s[12:15], s21 offen lds
  s_add_u32 s21, s21, 61440
  s_lshl_b32 s21, s2, 2
  s_add_u32 s21, s21, s20
  s_mul_i32 s21, s21, 20480
  v_lshlrev_b32 v5, 4, v1
  buffer_load_dwordx4 v[64:67], v5, s[8:11], s21 offen offset:0
  buffer_load_dwordx4 v[64:67], v5, s[8:11], s21 offen offset:1024
  buffer_load_dwordx4 v[64:67], v5, s[8:11], s21 offen offset:2048
  buffer_load_dwordx4 v[64:67], v5, s[8:11], s21 offen offset:3072
  s_add_u32 s21, s21, 4096
  buffer_load_dwordx4 v[64:67], v5, s[8:11], s21 offen offset:0
  buffer_load_dwordx4 v[64:67], v5, s[8:11], s21 offen offset:1024
  buffer_load_dwordx4 v[64:67], v5, s[8:11], s21 offen offset:2048
  buffer_load_dwordx4 v[64:67], v5, s[8:11], s21 offen offset:3072
  s_add_u32 s21, s21, 4096
  buffer_load_dwordx4 v[64:67], v5, s[8:11], s21 offen offset:0
  buffer_load_dwordx4 v[64:67], v5, s[8:11], s21 offen offset:1024
  buffer_load_dwordx4 v[64:67], v5, s[8:11], s21 offen offset:2048
  buffer_load_dwordx4 v[64:67], v5, s[8:11], s21 offen offset:3072
  s_add_u32 s21, s21, 4096
  buffer_load_dwordx4 v[64:67], v5, s[8:11], s21 offen offset:0
  buffer_load_dwordx4 v[64:67], v5, s[8:11], s21 offen offset:1024
  buffer_load_dwordx4 v[64:67], v5, s[8:11], s21 offen offset:2048
  buffer_load_dwordx4 v[64:67], v5, s[8:11], s21 offen offset:3072
  s_add_u32 s21, s21, 4096
  buffer_load_dwordx4 v[64:67], v5, s[8:11], s21 offen offset:0
  buffer_load_dwordx4 v[64:67], v5, s[8:11], s21 offen offset:1024
  buffer_load_dwordx4 v[64:67], v5, s[8:11], s21 offen offset:2048
  buffer_load_dwordx4 v[64:67], v5, s[8:11], s21 offen offset:3072
  v_lshrrev_b32 v6, 2, v2
  v_lshl_add_u32 v7, v3, 3, v6
  v_and_b32 v8, 1, v3
  v_lshl_add_u32 v6, v8, 2, v6
  v_lshlrev_b32 v6, 1, v6
  v_bfe_u32 v8, v2, 1, 1
  s_lshl_b32 s21, s20, 2
  v_add_u32 v8, s21, v8
  v_and_b32 v9, 1, v2
  v_lshlrev_b32 v9, 3, v9
  v_lshl_add_u32 v9, v7, 8, v9
  v_add_u32 v5, 0, v8
  v_xor_b32 v5, v5, v6
  v_lshl_add_u32 v10, v5, 4, v9
  v_add_u32 v11, 65536, v10
  v_add_u32 v12, 131072, v10
  v_add_u32 v5, 2, v8
  v_xor_b32 v5, v5, v6
  v_lshl_add_u32 v13, v5, 4, v9
  v_add_u32 v14, 65536, v13
  v_add_u32 v15, 131072, v13
  s_waitcnt vmcnt(50)
  s_barrier
  ds_read_b64_tr_b16 a[0:1], v10 offset:0
  ds_read_b64_tr_b16 a[2:3], v10 offset:1024
  ds_read_b64_tr_b16 a[4:5], v13 offset:0
  ds_read_b64_tr_b16 a[6:7], v13 offset:1024
  ds_read_b64_tr_b16 a[8:9], v10 offset:8192
  ds_read_b64_tr_b16 a[10:11], v10 offset:9216
  ds_read_b64_tr_b16 a[12:13], v13 offset:8192
  ds_read_b64_tr_b16 a[14:15], v13 offset:9216
  ds_read_b64_tr_b16 a[16:17], v10 offset:16384
  ds_read_b64_tr_b16 a[18:19], v10 offset:17408
  ds_read_b64_tr_b16 a[20:21], v13 offset:16384
  ds_read_b64_tr_b16 a[22:23], v13 offset:17408
  ds_read_b64_tr_b16 a[24:25], v10 offset:24576
  ds_read_b64_tr_b16 a[26:27], v10 offset:25600
  ds_read_b64_tr_b16 a[28:29], v13 offset:24576
  ds_read_b64_tr_b16 a[30:31], v13 offset:25600
  ds_read_b64_tr_b16 a[32:33], v10 offset:32768
  ds_read_b64_tr_b16 a[34:35], v10 offset:33792
  ds_read_b64_tr_b16 a[36:37], v13 offset:32768
  ds_read_b64_tr_b16 a[38:39], v13 offset:33792
  s_waitcnt vmcnt(40)
  s_barrier
  ds_read_b64_tr_b16 a[40:41], v10 offset:40960
  ds_read_b64_tr_b16 a[42:43], v10 offset:41984
  ds_read_b64_tr_b16 a[44:45], v13 offset:40960
  ds_read_b64_tr_b16 a[46:47], v13 offset:41984
  ds_read_b64_tr_b16 a[48:49], v10 offset:49152
  ds_read_b64_tr_b16 a[50:51], v10 offset:50176
  ds_read_b64_tr_b16 a[52:53], v13 offset:49152
  ds_read_b64_tr_b16 a[54:55], v13 offset:50176
  ds_read_b64_tr_b16 a[56:57], v10 offset:57344
  ds_read_b64_tr_b16 a[58:59], v10 offset:58368
  ds_read_b64_tr_b16 a[60:61], v13 offset:57344
  ds_read_b64_tr_b16 a[62:63], v13 offset:58368
  ds_read_b64_tr_b16 a[64:65], v11 offset:0
  ds_read_b64_tr_b16 a[66:67], v11 offset:1024
  ds_read_b64_tr_b16 a[68:69], v14 offset:0
  ds_read_b64_tr_b16 a[70:71], v14 offset:1024
  ds_read_b64_tr_b16 a[72:73], v11 offset:8192
  ds_read_b64_tr_b16 a[74:75], v11 offset:9216
  ds_read_b64_tr_b16 a[76:77], v14 offset:8192
  ds_read_b64_tr_b16 a[78:79], v14 offset:9216
  s_waitcnt vmcnt(30)
  s_barrier
  ds_read_b64_tr_b16 a[80:81], v11 offset:16384
  ds_read_b64_tr_b16 a[82:83], v11 offset:17408
  ds_read_b64_tr_b16 a[84:85], v14 offset:16384
  ds_read_b64_tr_b16 a[86:87], v14 offset:17408
  ds_read_b64_tr_b16 a[88:89], v11 offset:24576
  ds_read_b64_tr_b16 a[90:91], v11 offset:25600
  ds_read_b64_tr_b16 a[92:93], v14 offset:24576
  ds_read_b64_tr_b16 a[94:95], v14 offset:25600
  ds_read_b64_tr_b16 a[96:97], v11 offset:32768
  ds_read_b64_tr_b16 a[98:99], v11 offset:33792
  ds_read_b64_tr_b16 a[100:101], v14 offset:32768
  ds_read_b64_tr_b16 a[102:103], v14 offset:33792
  ds_read_b64_tr_b16 a[104:105], v11 offset:40960
  ds_read_b64_tr_b16 a[106:107], v11 offset:41984
  ds_read_b64_tr_b16 a[108:109], v14 offset:40960
  ds_read_b64_tr_b16 a[110:111], v14 offset:41984
  ds_read_b64_tr_b16 a[112:113], v11 offset:49152
  ds_read_b64_tr_b16 a[114:115], v11 offset:50176
  ds_read_b64_tr_b16 a[116:117], v14 offset:49152
  ds_read_b64_tr_b16 a[118:119], v14 offset:50176
  s_waitcnt vmcnt(20)
  s_barrier
  ds_read_b64_tr_b16 a[120:121], v11 offset:57344
  ds_read_b64_tr_b16 a[122:123], v11 offset:58368
  ds_read_b64_tr_b16 a[124:125], v14 offset:57344
  ds_read_b64_tr_b16 a[126:127], v14 offset:58368
  ds_read_b64_tr_b16 a[128:129], v12 offset:0
  ds_read_b64_tr_b16 a[130:131], v12 offset:1024
  ds_read_b64_tr_b16 a[132:133], v15 offset:0
  ds_read_b64_tr_b16 a[134:135], v15 offset:1024
  ds_read_b64_tr_b16 a[136:137], v12 offset:8192
  ds_read_b64_tr_b16 a[138:139], v12 offset:9216
  ds_read_b64_tr_b16 a[140:141], v15 offset:8192
  ds_read_b64_tr_b16 a[142:143], v15 offset:9216
  ds_read_b64_tr_b16 a[144:145], v12 offset:16384
  ds_read_b64_tr_b16 a[146:147], v12 offset:17408
  ds_read_b64_tr_b16 a[148:149], v15 offset:16384
  ds_read_b64_tr_b16 a[150:151], v15 offset:17408
  ds_read_b64_tr_b16 a[152:153], v12 offset:24576
  ds_read_b64_tr_b16 a[154:155], v12 offset:25600
  ds_read_b64_tr_b16 a[156:157], v15 offset:24576
  ds_read_b64_tr_b16 a[158:159], v15 offset:25600
  s_waitcnt lgkmcnt(0)
  s_barrier
  s_load_dwordx2 s[12:13], s[0:1], 72
  s_lshl_b32 s21, s2, 2
  s_add_u32 s21, s21, s20
  s_mul_i32 s50, s21, 6400
  s_add_u32 s51, s50, 4096
  v_lshlrev_b32 v33, 4, v1
  s_mov_b32 s14, 819200
  s_mov_b32 s64, s32
  s_mov_b32 s65, s33
  s_mov_b32 s66, s34
  s_mov_b32 s67, s35
  v_mov_b32 v32, 76
  s_waitcnt lgkmcnt(0)
  v_and_b32 v4, 31, v1
  s_lshl_b32 s21, s20, 5
  v_add_u32 v36, s21, v4
  v_lshrrev_b32 v5, 5, v1
  v_mul_u32_u24 v6, 264, v36
  v_mul_u32_u24 v7, 40, v5
  s_mov_b32 s21, 114952
  v_add3_u32 v34, v6, v7, s21
  v_lshl_add_u32 v38, v5, 3, v34
  v_lshlrev_b32 v6, 5, v5
  v_sub_u32 v39, v34, v6
  v_lshlrev_b32 v35, 3, v1
  v_add_u32 v35, 114688, v35
  v_mov_b32 v37, 0xf149f2ca
  s_mul_i32 s21, s41, 165120
  s_mul_i32 s22, s42, 16512
  s_add_u32 s21, s21, s22
  v_lshl_add_u32 v7, v36, 4, s21
  v_mul_u32_u24 v6, 99072, v5
  v_add_u32 v29, v6, v7
  v_add_u32 v30, 33024, v29
  v_lshl_add_u32 v31, v5, 3, v7
  v_add_u32 v31, 66048, v31
  v_mov_b32 v8, 0
  v_mov_b32 v9, 0
  ds_write_b64 v35, v[8:9] offset:0
  ds_write_b64 v35, v[8:9] offset:512
  ds_write_b64 v35, v[8:9] offset:1024
  ds_write_b64 v35, v[8:9] offset:1536
  ds_write_b64 v35, v[8:9] offset:2048
  s_mul_i32 s24, s42, 1280
  s_mov_b32 s25, 327680
  s_mov_b32 s26, 8
  s_mov_b32 s27, 0
  s_mov_b32 s60, 0x3e64f92e
  s_mov_b32 s61, 0x3fb8aa3b
  s_mov_b32 s62, 0x05040100
  s_mov_b32 s63, 0x07060302
  v_cmp_le_u32 s[76:77], 0, v36
  v_cmp_le_u32 s[78:79], 1, v36
  v_cmp_le_u32 s[80:81], 2, v36
  v_cmp_le_u32 s[82:83], 3, v36
  v_cmp_le_u32 s[84:85], 4, v36
  v_cmp_le_u32 s[86:87], 5, v36
  v_cmp_le_u32 s[88:89], 6, v36
  v_cmp_le_u32 s[90:91], 7, v36
  v_lshrrev_b32 v11, 3, v1
  v_and_b32 v12, 7, v1
  v_xor_b32 v12, v12, v11
  v_mul_u32_u24 v11, 2560, v11
  v_lshl_add_u32 v10, v12, 4, v11
  s_mul_i32 s46, s20, 81920
  v_add_u32 v10, s46, v10
  s_lshl_b32 s47, s20, 12
  s_add_u32 s47, s47, 0
  s_add_u32 s46, s47, 114688
  s_mov_b32 s30, s24
  s_add_u32 s32, s47, 0
  v_add_u32 v11, 19456, v10
  v_add_u32 v12, 38912, v10
  v_add_u32 v13, 58368, v10
  s_mov_b32 m0, s32
  s_nop 0
  buffer_load_dwordx4 v10, s[8:11], s30 offen offset:0 lds
  buffer_load_dwordx4 v11, s[8:11], s30 offen offset:1024 lds
  buffer_load_dwordx4 v12, s[8:11], s30 offen offset:2048 lds
  buffer_load_dwordx4 v13, s[8:11], s30 offen offset:3072 lds
  s_add_u32 s30, s30, 128
  s_add_u32 s32, s32, 16384
  s_cmp_lt_u32 s32, s46
  s_cselect_b32 s32, s32, s47
  s_mov_b32 m0, s32
  s_nop 0
  buffer_load_dwordx4 v10, s[8:11], s30 offen offset:0 lds
  buffer_load_dwordx4 v11, s[8:11], s30 offen offset:1024 lds
  buffer_load_dwordx4 v12, s[8:11], s30 offen offset:2048 lds
  buffer_load_dwordx4 v13, s[8:11], s30 offen offset:3072 lds
  s_add_u32 s30, s30, 128
  s_add_u32 s32, s32, 16384
  s_cmp_lt_u32 s32, s46
  s_cselect_b32 s32, s32, s47
  s_mov_b32 m0, s32
  s_nop 0
  buffer_load_dwordx4 v10, s[8:11], s30 offen offset:0 lds
  buffer_load_dwordx4 v11, s[8:11], s30 offen offset:1024 lds
  buffer_load_dwordx4 v12, s[8:11], s30 offen offset:2048 lds
  buffer_load_dwordx4 v13, s[8:11], s30 offen offset:3072 lds
  s_add_u32 s30, s30, 128
  s_add_u32 s32, s32, 16384
  s_cmp_lt_u32 s32, s46
  s_cselect_b32 s32, s32, s47
  s_mov_b32 m0, s32
  s_nop 0
  buffer_load_dwordx4 v10, s[8:11], s30 offen offset:0 lds
  buffer_load_dwordx4 v11, s[8:11], s30 offen offset:1024 lds
  buffer_load_dwordx4 v12, s[8:11], s30 offen offset:2048 lds
  buffer_load_dwordx4 v13, s[8:11], s30 offen offset:3072 lds
  s_add_u32 s30, s30, 128
  s_add_u32 s32, s32, 16384
  s_cmp_lt_u32 s32, s46
  s_cselect_b32 s32, s32, s47
  s_mov_b32 m0, s32
  s_nop 0
  buffer_load_dwordx4 v10, s[8:11], s30 offen offset:0 lds
  buffer_load_dwordx4 v11, s[8:11], s30 offen offset:1024 lds
  buffer_load_dwordx4 v12, s[8:11], s30 offen offset:2048 lds
  buffer_load_dwordx4 v13, s[8:11], s30 offen offset:3072 lds
  s_add_u32 s30, s30, 128
  s_add_u32 s32, s32, 16384
  s_cmp_lt_u32 s32, s46
  s_cselect_b32 s32, s32, s47
  v_and_b32 v6, 7, v2
  v_add_u32 v4, 0, v3
  v_xor_b32 v4, v4, v6
  v_lshlrev_b32 v4, 4, v4
  v_lshl_add_u32 v14, v2, 7, v4
  v_add_u32 v4, 4, v3
  v_xor_b32 v4, v4, v6
  v_lshlrev_b32 v4, 4, v4
  v_lshl_add_u32 v15, v2, 7, v4
  v_mul_u32_u24 v22, 264, v2
  v_mul_u32_u24 v4, 8, v3
  s_mul_i32 s21, s20, 64
  s_add_u32 s21, s21, 116800
  v_add3_u32 v22, v22, v4, s21
  v_lshlrev_b32 v4, 3, v3
  v_sub_u32 v16, v22, v4
  v_mov_b32 v9, 2731
  s_mov_b32 s33, 0
  s_mov_b32 s48, 0x80000000
  s_mov_b32 m0, s32
  s_nop 0
  buffer_load_dwordx4 v10, s[8:11], s30 offen offset:0 lds
  buffer_load_dwordx4 v11, s[8:11], s30 offen offset:1024 lds
  s_waitcnt vmcnt(18)
  s_barrier
  v_add_u32 v18, s33, v14
  v_add_u32 v19, s33, v15
  s_add_u32 s33, s33, 16384
  s_cmp_lt_u32 s33, 114688
  s_cselect_b32 s33, s33, 0
  ds_read_b128 v[160:163], v18 offset:0
  ds_read_b128 v[164:167], v18 offset:2048
  ds_read_b128 v[168:171], v18 offset:4096
  ds_read_b128 v[172:175], v18 offset:6144
  ds_read_b128 v[176:179], v18 offset:8192
  ds_read_b128 v[180:183], v18 offset:10240
  ds_read_b128 v[184:187], v18 offset:12288
  ds_read_b128 v[188:191], v18 offset:14336
  s_waitcnt lgkmcnt(0)
bf_blk_214:
  v_mfma_f32_16x16x32_bf16 v[64:67], a[0:3], v[160:163], 0
  ds_read_b128 v[192:195], v19 offset:0
  v_mfma_f32_16x16x32_bf16 v[68:71], a[4:7], v[160:163], 0
  v_add_u32 v18, s33, v14
  v_mfma_f32_16x16x32_bf16 v[72:75], a[0:3], v[164:167], 0
  ds_read_b128 v[196:199], v19 offset:2048
  v_mfma_f32_16x16x32_bf16 v[76:79], a[4:7], v[164:167], 0
  buffer_load_dwordx4 v12, s[8:11], s30 offen offset:2048 lds
  v_mfma_f32_16x16x32_bf16 v[80:83], a[0:3], v[168:171], 0
  ds_read_b128 v[200:203], v19 offset:4096
  v_mfma_f32_16x16x32_bf16 v[84:87], a[4:7], v[168:171], 0
  v_mfma_f32_16x16x32_bf16 v[88:91], a[0:3], v[172:175], 0
  ds_read_b128 v[204:207], v19 offset:6144
  v_mfma_f32_16x16x32_bf16 v[92:95], a[4:7], v[172:175], 0
  s_waitcnt lgkmcnt(14)
  v_mfma_f32_16x16x32_bf16 v[96:99], a[0:3], v[176:179], 0
  ds_read_b128 v[208:211], v19 offset:8192
  v_mfma_f32_16x16x32_bf16 v[100:103], a[4:7], v[176:179], 0
  v_mfma_f32_16x16x32_bf16 v[104:107], a[0:3], v[180:183], 0
  ds_read_b128 v[212:215], v19 offset:10240
  v_mfma_f32_16x16x32_bf16 v[108:111], a[4:7], v[180:183], 0
  buffer_load_dwordx4 v13, s[8:11], s30 offen offset:3072 lds
  v_mfma_f32_16x16x32_bf16 v[112:115], a[0:3], v[184:187], 0
  ds_read_b128 v[216:219], v19 offset:12288
  s_add_u32 s30, s30, 128
  v_mfma_f32_16x16x32_bf16 v[116:119], a[4:7], v[184:187], 0
  s_add_u32 m0, m0, 16384
  v_mfma_f32_16x16x32_bf16 v[120:123], a[0:3], v[188:191], 0
  ds_read_b128 v[220:223], v19 offset:14336
  v_mfma_f32_16x16x32_bf16 v[124:127], a[4:7], v[188:191], 0
  s_waitcnt vmcnt(16) lgkmcnt(4)
  s_barrier
  v_mfma_f32_16x16x32_bf16 v[64:67], a[8:11], v[192:195], v[64:67]
  ds_read_b128 v[160:163], v18 offset:0
  v_mfma_f32_16x16x32_bf16 v[68:71], a[12:15], v[192:195], v[68:71]
  s_cmp_lt_u32 m0, s46
  s_cselect_b32 m0, m0, s47
  v_mfma_f32_16x16x32_bf16 v[72:75], a[8:11], v[196:199], v[72:75]
  ds_read_b128 v[164:167], v18 offset:2048
  v_add_u32 v19, s33, v15
  v_mfma_f32_16x16x32_bf16 v[76:79], a[12:15], v[196:199], v[76:79]
  buffer_load_dwordx4 v10, s[8:11], s30 offen offset:0 lds
  v_mfma_f32_16x16x32_bf16 v[80:83], a[8:11], v[200:203], v[80:83]
  ds_read_b128 v[168:171], v18 offset:4096
  s_add_u32 s33, s33, 16384
  v_mfma_f32_16x16x32_bf16 v[84:87], a[12:15], v[200:203], v[84:87]
  s_cmp_lt_u32 s33, 114688
  s_cselect_b32 s33, s33, 0
  v_mfma_f32_16x16x32_bf16 v[88:91], a[8:11], v[204:207], v[88:91]
  ds_read_b128 v[172:175], v18 offset:6144
  v_mfma_f32_16x16x32_bf16 v[92:95], a[12:15], v[204:207], v[92:95]
  s_waitcnt lgkmcnt(4)
  v_mfma_f32_16x16x32_bf16 v[96:99], a[8:11], v[208:211], v[96:99]
  ds_read_b128 v[176:179], v18 offset:8192
  v_mfma_f32_16x16x32_bf16 v[100:103], a[12:15], v[208:211], v[100:103]
  v_mfma_f32_16x16x32_bf16 v[104:107], a[8:11], v[212:215], v[104:107]
  ds_read_b128 v[180:183], v18 offset:10240
  v_mfma_f32_16x16x32_bf16 v[108:111], a[12:15], v[212:215], v[108:111]
  buffer_load_dwordx4 v11, s[8:11], s30 offen offset:1024 lds
  v_mfma_f32_16x16x32_bf16 v[112:115], a[8:11], v[216:219], v[112:115]
  ds_read_b128 v[184:187], v18 offset:12288
  v_mfma_f32_16x16x32_bf16 v[116:119], a[12:15], v[216:219], v[116:119]
  v_mfma_f32_16x16x32_bf16 v[120:123], a[8:11], v[220:223], v[120:123]
  ds_read_b128 v[188:191], v18 offset:14336
  v_mfma_f32_16x16x32_bf16 v[124:127], a[12:15], v[220:223], v[124:127]
  s_waitcnt lgkmcnt(4)
  v_mfma_f32_16x16x32_bf16 v[64:67], a[16:19], v[160:163], v[64:67]
  ds_read_b128 v[192:195], v19 offset:0
  v_mfma_f32_16x16x32_bf16 v[68:71], a[20:23], v[160:163], v[68:71]
  v_add_u32 v18, s33, v14
  v_mfma_f32_16x16x32_bf16 v[72:75], a[16:19], v[164:167], v[72:75]
  ds_read_b128 v[196:199], v19 offset:2048
  v_mfma_f32_16x16x32_bf16 v[76:79], a[20:23], v[164:167], v[76:79]
  buffer_load_dwordx4 v12, s[8:11], s30 offen offset:2048 lds
  v_mfma_f32_16x16x32_bf16 v[80:83], a[16:19], v[168:171], v[80:83]
  ds_read_b128 v[200:203], v19 offset:4096
  v_mfma_f32_16x16x32_bf16 v[84:87], a[20:23], v[168:171], v[84:87]
  v_mfma_f32_16x16x32_bf16 v[88:91], a[16:19], v[172:175], v[88:91]
  ds_read_b128 v[204:207], v19 offset:6144
  v_mfma_f32_16x16x32_bf16 v[92:95], a[20:23], v[172:175], v[92:95]
  s_waitcnt lgkmcnt(4)
  v_mfma_f32_16x16x32_bf16 v[96:99], a[16:19], v[176:179], v[96:99]
  ds_read_b128 v[208:211], v19 offset:8192
  v_mfma_f32_16x16x32_bf16 v[100:103], a[20:23], v[176:179], v[100:103]
  v_mfma_f32_16x16x32_bf16 v[104:107], a[16:19], v[180:183], v[104:107]
  ds_read_b128 v[212:215], v19 offset:10240
  v_mfma_f32_16x16x32_bf16 v[108:111], a[20:23], v[180:183], v[108:111]
  buffer_load_dwordx4 v13, s[8:11], s30 offen offset:3072 lds
  v_mfma_f32_16x16x32_bf16 v[112:115], a[16:19], v[184:187], v[112:115]
  ds_read_b128 v[216:219], v19 offset:12288
  s_add_u32 s30, s30, 128
  v_mfma_f32_16x16x32_bf16 v[116:119], a[20:23], v[184:187], v[116:119]
  s_add_u32 m0, m0, 16384
  v_mfma_f32_16x16x32_bf16 v[120:123], a[16:19], v[188:191], v[120:123]
  ds_read_b128 v[220:223], v19 offset:14336
  v_mfma_f32_16x16x32_bf16 v[124:127], a[20:23], v[188:191], v[124:127]
  s_waitcnt vmcnt(16) lgkmcnt(4)
  s_barrier
  v_mfma_f32_16x16x32_bf16 v[64:67], a[24:27], v[192:195], v[64:67]
  ds_read_b128 v[160:163], v18 offset:0
  v_mfma_f32_16x16x32_bf16 v[68:71], a[28:31], v[192:195], v[68:71]
  s_cmp_lt_u32 m0, s46
  s_cselect_b32 m0, m0, s47
  v_mfma_f32_16x16x32_bf16 v[72:75], a[24:27], v[196:199], v[72:75]
  ds_read_b128 v[164:167], v18 offset:2048
  v_add_u32 v19, s33, v15
  v_mfma_f32_16x16x32_bf16 v[76:79], a[28:31], v[196:199], v[76:79]
  buffer_load_dwordx4 v10, s[8:11], s30 offen offset:0 lds
  v_mfma_f32_16x16x32_bf16 v[80:83], a[24:27], v[200:203], v[80:83]
  ds_read_b128 v[168:171], v18 offset:4096
  s_add_u32 s33, s33, 16384
  v_mfma_f32_16x16x32_bf16 v[84:87], a[28:31], v[200:203], v[84:87]
  s_cmp_lt_u32 s33, 114688
  s_cselect_b32 s33, s33, 0
  v_mfma_f32_16x16x32_bf16 v[88:91], a[24:27], v[204:207], v[88:91]
  ds_read_b128 v[172:175], v18 offset:6144
  v_mfma_f32_16x16x32_bf16 v[92:95], a[28:31], v[204:207], v[92:95]
  s_waitcnt lgkmcnt(4)
  v_mfma_f32_16x16x32_bf16 v[96:99], a[24:27], v[208:211], v[96:99]
  ds_read_b128 v[176:179], v18 offset:8192
  v_mfma_f32_16x16x32_bf16 v[100:103], a[28:31], v[208:211], v[100:103]
  v_mfma_f32_16x16x32_bf16 v[104:107], a[24:27], v[212:215], v[104:107]
  ds_read_b128 v[180:183], v18 offset:10240
  v_mfma_f32_16x16x32_bf16 v[108:111], a[28:31], v[212:215], v[108:111]
  buffer_load_dwordx4 v11, s[8:11], s30 offen offset:1024 lds
  v_mfma_f32_16x16x32_bf16 v[112:115], a[24:27], v[216:219], v[112:115]
  ds_read_b128 v[184:187], v18 offset:12288
  v_mfma_f32_16x16x32_bf16 v[116:119], a[28:31], v[216:219], v[116:119]
  v_mfma_f32_16x16x32_bf16 v[120:123], a[24:27], v[220:223], v[120:123]
  ds_read_b128 v[188:191], v18 offset:14336
  v_mfma_f32_16x16x32_bf16 v[124:127], a[28:31], v[220:223], v[124:127]
  s_waitcnt lgkmcnt(4)
  v_mfma_f32_16x16x32_bf16 v[64:67], a[32:35], v[160:163], v[64:67]
  ds_read_b128 v[192:195], v19 offset:0
  v_mfma_f32_16x16x32_bf16 v[68:71], a[36:39], v[160:163], v[68:71]
  v_add_u32 v18, s33, v14
  v_mfma_f32_16x16x32_bf16 v[72:75], a[32:35], v[164:167], v[72:75]
  ds_read_b128 v[196:199], v19 offset:2048
  v_mfma_f32_16x16x32_bf16 v[76:79], a[36:39], v[164:167], v[76:79]
  buffer_load_dwordx4 v12, s[8:11], s30 offen offset:2048 lds
  v_mfma_f32_16x16x32_bf16 v[80:83], a[32:35], v[168:171], v[80:83]
  ds_read_b128 v[200:203], v19 offset:4096
  v_mfma_f32_16x16x32_bf16 v[84:87], a[36:39], v[168:171], v[84:87]
  v_mfma_f32_16x16x32_bf16 v[88:91], a[32:35], v[172:175], v[88:91]
  ds_read_b128 v[204:207], v19 offset:6144
  v_mfma_f32_16x16x32_bf16 v[92:95], a[36:39], v[172:175], v[92:95]
  s_waitcnt lgkmcnt(4)
  v_mfma_f32_16x16x32_bf16 v[96:99], a[32:35], v[176:179], v[96:99]
  ds_read_b128 v[208:211], v19 offset:8192
  v_mfma_f32_16x16x32_bf16 v[100:103], a[36:39], v[176:179], v[100:103]
  v_mfma_f32_16x16x32_bf16 v[104:107], a[32:35], v[180:183], v[104:107]
  ds_read_b128 v[212:215], v19 offset:10240
  v_mfma_f32_16x16x32_bf16 v[108:111], a[36:39], v[180:183], v[108:111]
  buffer_load_dwordx4 v13, s[8:11], s30 offen offset:3072 lds
  v_mfma_f32_16x16x32_bf16 v[112:115], a[32:35], v[184:187], v[112:115]
  ds_read_b128 v[216:219], v19 offset:12288
  s_add_u32 s30, s30, 128
  v_mfma_f32_16x16x32_bf16 v[116:119], a[36:39], v[184:187], v[116:119]
  s_add_u32 m0, m0, 16384
  v_mfma_f32_16x16x32_bf16 v[120:123], a[32:35], v[188:191], v[120:123]
  ds_read_b128 v[220:223], v19 offset:14336
  v_mfma_f32_16x16x32_bf16 v[124:127], a[36:39], v[188:191], v[124:127]
  s_waitcnt vmcnt(16) lgkmcnt(4)
  s_barrier
  v_mfma_f32_16x16x32_bf16 v[64:67], a[40:43], v[192:195], v[64:67]
  ds_read_b128 v[160:163], v18 offset:0
  v_mfma_f32_16x16x32_bf16 v[68:71], a[44:47], v[192:195], v[68:71]
  s_cmp_lt_u32 m0, s46
  s_cselect_b32 m0, m0, s47
  v_mfma_f32_16x16x32_bf16 v[72:75], a[40:43], v[196:199], v[72:75]
  ds_read_b128 v[164:167], v18 offset:2048
  v_add_u32 v19, s33, v15
  v_mfma_f32_16x16x32_bf16 v[76:79], a[44:47], v[196:199], v[76:79]
  buffer_load_dwordx4 v10, s[8:11], s30 offen offset:0 lds
  v_mfma_f32_16x16x32_bf16 v[80:83], a[40:43], v[200:203], v[80:83]
  ds_read_b128 v[168:171], v18 offset:4096
  s_add_u32 s33, s33, 16384
  v_mfma_f32_16x16x32_bf16 v[84:87], a[44:47], v[200:203], v[84:87]
  s_cmp_lt_u32 s33, 114688
  s_cselect_b32 s33, s33, 0
  v_mfma_f32_16x16x32_bf16 v[88:91], a[40:43], v[204:207], v[88:91]
  ds_read_b128 v[172:175], v18 offset:6144
  v_mfma_f32_16x16x32_bf16 v[92:95], a[44:47], v[204:207], v[92:95]
  s_waitcnt lgkmcnt(4)
  v_mfma_f32_16x16x32_bf16 v[96:99], a[40:43], v[208:211], v[96:99]
  ds_read_b128 v[176:179], v18 offset:8192
  v_mfma_f32_16x16x32_bf16 v[100:103], a[44:47], v[208:211], v[100:103]
  v_mfma_f32_16x16x32_bf16 v[104:107], a[40:43], v[212:215], v[104:107]
  ds_read_b128 v[180:183], v18 offset:10240
  v_mfma_f32_16x16x32_bf16 v[108:111], a[44:47], v[212:215], v[108:111]
  buffer_load_dwordx4 v11, s[8:11], s30 offen offset:1024 lds
  v_mfma_f32_16x16x32_bf16 v[112:115], a[40:43], v[216:219], v[112:115]
  ds_read_b128 v[184:187], v18 offset:12288
  v_mfma_f32_16x16x32_bf16 v[116:119], a[44:47], v[216:219], v[116:119]
  v_mfma_f32_16x16x32_bf16 v[120:123], a[40:43], v[220:223], v[120:123]
  ds_read_b128 v[188:191], v18 offset:14336
  v_mfma_f32_16x16x32_bf16 v[124:127], a[44:47], v[220:223], v[124:127]
  s_waitcnt lgkmcnt(4)
  v_mfma_f32_16x16x32_bf16 v[64:67], a[48:51], v[160:163], v[64:67]
  ds_read_b128 v[192:195], v19 offset:0
  v_mfma_f32_16x16x32_bf16 v[68:71], a[52:55], v[160:163], v[68:71]
  v_add_u32 v18, s33, v14
  v_mfma_f32_16x16x32_bf16 v[72:75], a[48:51], v[164:167], v[72:75]
  ds_read_b128 v[196:199], v19 offset:2048
  v_mfma_f32_16x16x32_bf16 v[76:79], a[52:55], v[164:167], v[76:79]
  buffer_load_dwordx4 v12, s[8:11], s30 offen offset:2048 lds
  v_mfma_f32_16x16x32_bf16 v[80:83], a[48:51], v[168:171], v[80:83]
  ds_read_b128 v[200:203], v19 offset:4096
  v_mfma_f32_16x16x32_bf16 v[84:87], a[52:55], v[168:171], v[84:87]
  v_mfma_f32_16x16x32_bf16 v[88:91], a[48:51], v[172:175], v[88:91]
  ds_read_b128 v[204:207], v19 offset:6144
  v_mfma_f32_16x16x32_bf16 v[92:95], a[52:55], v[172:175], v[92:95]
  s_waitcnt lgkmcnt(4)
  v_mfma_f32_16x16x32_bf16 v[96:99], a[48:51], v[176:179], v[96:99]
  ds_read_b128 v[208:211], v19 offset:8192
  v_mfma_f32_16x16x32_bf16 v[100:103], a[52:55], v[176:179], v[100:103]
  v_mfma_f32_16x16x32_bf16 v[104:107], a[48:51], v[180:183], v[104:107]
  ds_read_b128 v[212:215], v19 offset:10240
  v_mfma_f32_16x16x32_bf16 v[108:111], a[52:55], v[180:183], v[108:111]
  buffer_load_dwordx4 v13, s[8:11], s30 offen offset:3072 lds
  v_mfma_f32_16x16x32_bf16 v[112:115], a[48:51], v[184:187], v[112:115]
  ds_read_b128 v[216:219], v19 offset:12288
  s_add_u32 s30, s30, 128
  v_mfma_f32_16x16x32_bf16 v[116:119], a[52:55], v[184:187], v[116:119]
  s_add_u32 m0, m0, 16384
  v_mfma_f32_16x16x32_bf16 v[120:123], a[48:51], v[188:191], v[120:123]
  ds_read_b128 v[220:223], v19 offset:14336
  v_mfma_f32_16x16x32_bf16 v[124:127], a[52:55], v[188:191], v[124:127]
  s_waitcnt vmcnt(16) lgkmcnt(4)
  s_barrier
  v_mfma_f32_16x16x32_bf16 v[64:67], a[56:59], v[192:195], v[64:67]
  ds_read_b128 v[160:163], v18 offset:0
  v_mfma_f32_16x16x32_bf16 v[68:71], a[60:63], v[192:195], v[68:71]
  s_cmp_lt_u32 m0, s46
  s_cselect_b32 m0, m0, s47
  v_mfma_f32_16x16x32_bf16 v[72:75], a[56:59], v[196:199], v[72:75]
  ds_read_b128 v[164:167], v18 offset:2048
  v_add_u32 v19, s33, v15
  v_mfma_f32_16x16x32_bf16 v[76:79], a[60:63], v[196:199], v[76:79]
  buffer_load_dwordx4 v10, s[8:11], s30 offen offset:0 lds
  v_mfma_f32_16x16x32_bf16 v[80:83], a[56:59], v[200:203], v[80:83]
  ds_read_b128 v[168:171], v18 offset:4096
  s_add_u32 s33, s33, 16384
  v_mfma_f32_16x16x32_bf16 v[84:87], a[60:63], v[200:203], v[84:87]
  s_cmp_lt_u32 s33, 114688
  s_cselect_b32 s33, s33, 0
  v_mfma_f32_16x16x32_bf16 v[88:91], a[56:59], v[204:207], v[88:91]
  ds_read_b128 v[172:175], v18 offset:6144
  v_mfma_f32_16x16x32_bf16 v[92:95], a[60:63], v[204:207], v[92:95]
  s_waitcnt lgkmcnt(4)
  v_mfma_f32_16x16x32_bf16 v[96:99], a[56:59], v[208:211], v[96:99]
  ds_read_b128 v[176:179], v18 offset:8192
  v_mfma_f32_16x16x32_bf16 v[100:103], a[60:63], v[208:211], v[100:103]
  v_mfma_f32_16x16x32_bf16 v[104:107], a[56:59], v[212:215], v[104:107]
  ds_read_b128 v[180:183], v18 offset:10240
  v_mfma_f32_16x16x32_bf16 v[108:111], a[60:63], v[212:215], v[108:111]
  buffer_load_dwordx4 v11, s[8:11], s30 offen offset:1024 lds
  v_mfma_f32_16x16x32_bf16 v[112:115], a[56:59], v[216:219], v[112:115]
  ds_read_b128 v[184:187], v18 offset:12288
  v_mfma_f32_16x16x32_bf16 v[116:119], a[60:63], v[216:219], v[116:119]
  v_mfma_f32_16x16x32_bf16 v[120:123], a[56:59], v[220:223], v[120:123]
  ds_read_b128 v[188:191], v18 offset:14336
  v_mfma_f32_16x16x32_bf16 v[124:127], a[60:63], v[220:223], v[124:127]
  s_waitcnt lgkmcnt(4)
  v_mfma_f32_16x16x32_bf16 v[64:67], a[64:67], v[160:163], v[64:67]
  ds_read_b128 v[192:195], v19 offset:0
  v_mfma_f32_16x16x32_bf16 v[68:71], a[68:71], v[160:163], v[68:71]
  v_add_u32 v18, s33, v14
  v_mfma_f32_16x16x32_bf16 v[72:75], a[64:67], v[164:167], v[72:75]
  ds_read_b128 v[196:199], v19 offset:2048
  v_mfma_f32_16x16x32_bf16 v[76:79], a[68:71], v[164:167], v[76:79]
  buffer_load_dwordx4 v12, s[8:11], s30 offen offset:2048 lds
  v_mfma_f32_16x16x32_bf16 v[80:83], a[64:67], v[168:171], v[80:83]
  ds_read_b128 v[200:203], v19 offset:4096
  v_mfma_f32_16x16x32_bf16 v[84:87], a[68:71], v[168:171], v[84:87]
  v_mfma_f32_16x16x32_bf16 v[88:91], a[64:67], v[172:175], v[88:91]
  ds_read_b128 v[204:207], v19 offset:6144
  v_mfma_f32_16x16x32_bf16 v[92:95], a[68:71], v[172:175], v[92:95]
  s_waitcnt lgkmcnt(4)
  v_mfma_f32_16x16x32_bf16 v[96:99], a[64:67], v[176:179], v[96:99]
  ds_read_b128 v[208:211], v19 offset:8192
  v_mfma_f32_16x16x32_bf16 v[100:103], a[68:71], v[176:179], v[100:103]
  v_mfma_f32_16x16x32_bf16 v[104:107], a[64:67], v[180:183], v[104:107]
  ds_read_b128 v[212:215], v19 offset:10240
  v_mfma_f32_16x16x32_bf16 v[108:111], a[68:71], v[180:183], v[108:111]
  buffer_load_dwordx4 v13, s[8:11], s30 offen offset:3072 lds
  v_mfma_f32_16x16x32_bf16 v[112:115], a[64:67], v[184:187], v[112:115]
  ds_read_b128 v[216:219], v19 offset:12288
  s_add_u32 s30, s30, s25
  v_mfma_f32_16x16x32_bf16 v[116:119], a[68:71], v[184:187], v[116:119]
  s_sub_u32 s30, s30, 1152
  s_add_u32 m0, m0, 16384
  v_mfma_f32_16x16x32_bf16 v[120:123], a[64:67], v[188:191], v[120:123]
  ds_read_b128 v[220:223], v19 offset:14336
  v_mfma_f32_16x16x32_bf16 v[124:127], a[68:71], v[188:191], v[124:127]
  s_waitcnt vmcnt(16) lgkmcnt(4)
  s_barrier
  v_mfma_f32_16x16x32_bf16 v[64:67], a[72:75], v[192:195], v[64:67]
  ds_read_b128 v[160:163], v18 offset:0
  v_mfma_f32_16x16x32_bf16 v[68:71], a[76:79], v[192:195], v[68:71]
  s_cmp_lt_u32 m0, s46
  s_cselect_b32 m0, m0, s47
  v_mfma_f32_16x16x32_bf16 v[72:75], a[72:75], v[196:199], v[72:75]
  ds_read_b128 v[164:167], v18 offset:2048
  v_add_u32 v19, s33, v15
  v_mfma_f32_16x16x32_bf16 v[76:79], a[76:79], v[196:199], v[76:79]
  buffer_load_dwordx4 v10, s[8:11], s30 offen offset:0 lds
  v_mfma_f32_16x16x32_bf16 v[80:83], a[72:75], v[200:203], v[80:83]
  ds_read_b128 v[168:171], v18 offset:4096
  s_add_u32 s33, s33, 16384
  v_mfma_f32_16x16x32_bf16 v[84:87], a[76:79], v[200:203], v[84:87]
  s_cmp_lt_u32 s33, 114688
  s_cselect_b32 s33, s33, 0
  v_mfma_f32_16x16x32_bf16 v[88:91], a[72:75], v[204:207], v[88:91]
  ds_read_b128 v[172:175], v18 offset:6144
  v_mfma_f32_16x16x32_bf16 v[92:95], a[76:79], v[204:207], v[92:95]
  s_waitcnt lgkmcnt(4)
  v_mfma_f32_16x16x32_bf16 v[96:99], a[72:75], v[208:211], v[96:99]
  ds_read_b128 v[176:179], v18 offset:8192
  v_mfma_f32_16x16x32_bf16 v[100:103], a[76:79], v[208:211], v[100:103]
  v_mfma_f32_16x16x32_bf16 v[104:107], a[72:75], v[212:215], v[104:107]
  ds_read_b128 v[180:183], v18 offset:10240
  v_mfma_f32_16x16x32_bf16 v[108:111], a[76:79], v[212:215], v[108:111]
  buffer_load_dwordx4 v11, s[8:11], s30 offen offset:1024 lds
  v_mfma_f32_16x16x32_bf16 v[112:115], a[72:75], v[216:219], v[112:115]
  ds_read_b128 v[184:187], v18 offset:12288
  v_mfma_f32_16x16x32_bf16 v[116:119], a[76:79], v[216:219], v[116:119]
  v_mfma_f32_16x16x32_bf16 v[120:123], a[72:75], v[220:223], v[120:123]
  ds_read_b128 v[188:191], v18 offset:14336
  v_mfma_f32_16x16x32_bf16 v[124:127], a[76:79], v[220:223], v[124:127]
  s_waitcnt lgkmcnt(4)
  v_mfma_f32_16x16x32_bf16 v[64:67], a[80:83], v[160:163], v[64:67]
  ds_read_b128 v[192:195], v19 offset:0
  v_mfma_f32_16x16x32_bf16 v[68:71], a[84:87], v[160:163], v[68:71]
  v_add_u32 v18, s33, v14
  v_mfma_f32_16x16x32_bf16 v[72:75], a[80:83], v[164:167], v[72:75]
  ds_read_b128 v[196:199], v19 offset:2048
  v_mfma_f32_16x16x32_bf16 v[76:79], a[84:87], v[164:167], v[76:79]
  buffer_load_dwordx4 v12, s[8:11], s30 offen offset:2048 lds
  v_mfma_f32_16x16x32_bf16 v[80:83], a[80:83], v[168:171], v[80:83]
  ds_read_b128 v[200:203], v19 offset:4096
  v_mfma_f32_16x16x32_bf16 v[84:87], a[84:87], v[168:171], v[84:87]
  v_mfma_f32_16x16x32_bf16 v[88:91], a[80:83], v[172:175], v[88:91]
  ds_read_b128 v[204:207], v19 offset:6144
  v_mfma_f32_16x16x32_bf16 v[92:95], a[84:87], v[172:175], v[92:95]
  s_waitcnt lgkmcnt(4)
  v_mfma_f32_16x16x32_bf16 v[96:99], a[80:83], v[176:179], v[96:99]
  ds_read_b128 v[208:211], v19 offset:8192
  v_mfma_f32_16x16x32_bf16 v[100:103], a[84:87], v[176:179], v[100:103]
  v_mfma_f32_16x16x32_bf16 v[104:107], a[80:83], v[180:183], v[104:107]
  ds_read_b128 v[212:215], v19 offset:10240
  v_mfma_f32_16x16x32_bf16 v[108:111], a[84:87], v[180:183], v[108:111]
  buffer_load_dwordx4 v13, s[8:11], s30 offen offset:3072 lds
  v_mfma_f32_16x16x32_bf16 v[112:115], a[80:83], v[184:187], v[112:115]
  ds_read_b128 v[216:219], v19 offset:12288
  s_add_u32 s30, s30, 128
  v_mfma_f32_16x16x32_bf16 v[116:119], a[84:87], v[184:187], v[116:119]
  s_add_u32 m0, m0, 16384
  v_mfma_f32_16x16x32_bf16 v[120:123], a[80:83], v[188:191], v[120:123]
  ds_read_b128 v[220:223], v19 offset:14336
  v_mfma_f32_16x16x32_bf16 v[124:127], a[84:87], v[188:191], v[124:127]
  s_waitcnt vmcnt(16) lgkmcnt(4)
  s_barrier
  v_mfma_f32_16x16x32_bf16 v[64:67], a[88:91], v[192:195], v[64:67]
  ds_read_b128 v[160:163], v18 offset:0
  v_mfma_f32_16x16x32_bf16 v[68:71], a[92:95], v[192:195], v[68:71]
  s_cmp_lt_u32 m0, s46
  s_cselect_b32 m0, m0, s47
  v_mfma_f32_16x16x32_bf16 v[72:75], a[88:91], v[196:199], v[72:75]
  ds_read_b128 v[164:167], v18 offset:2048
  v_add_u32 v19, s33, v15
  v_mfma_f32_16x16x32_bf16 v[76:79], a[92:95], v[196:199], v[76:79]
  buffer_load_dwordx4 v10, s[8:11], s30 offen offset:0 lds
  v_mfma_f32_16x16x32_bf16 v[80:83], a[88:91], v[200:203], v[80:83]
  ds_read_b128 v[168:171], v18 offset:4096
  s_add_u32 s33, s33, 16384
  v_mfma_f32_16x16x32_bf16 v[84:87], a[92:95], v[200:203], v[84:87]
  s_cmp_lt_u32 s33, 114688
  s_cselect_b32 s33, s33, 0
  v_mfma_f32_16x16x32_bf16 v[88:91], a[88:91], v[204:207], v[88:91]
  ds_read_b128 v[172:175], v18 offset:6144
  v_mfma_f32_16x16x32_bf16 v[92:95], a[92:95], v[204:207], v[92:95]
  s_waitcnt lgkmcnt(4)
  v_mfma_f32_16x16x32_bf16 v[96:99], a[88:91], v[208:211], v[96:99]
  ds_read_b128 v[176:179], v18 offset:8192
  v_mfma_f32_16x16x32_bf16 v[100:103], a[92:95], v[208:211], v[100:103]
  v_mfma_f32_16x16x32_bf16 v[104:107], a[88:91], v[212:215], v[104:107]
  ds_read_b128 v[180:183], v18 offset:10240
  v_mfma_f32_16x16x32_bf16 v[108:111], a[92:95], v[212:215], v[108:111]
  buffer_load_dwordx4 v11, s[8:11], s30 offen offset:1024 lds
  v_mfma_f32_16x16x32_bf16 v[112:115], a[88:91], v[216:219], v[112:115]
  ds_read_b128 v[184:187], v18 offset:12288
  v_mfma_f32_16x16x32_bf16 v[116:119], a[92:95], v[216:219], v[116:119]
  v_mfma_f32_16x16x32_bf16 v[120:123], a[88:91], v[220:223], v[120:123]
  ds_read_b128 v[188:191], v18 offset:14336
  v_mfma_f32_16x16x32_bf16 v[124:127], a[92:95], v[220:223], v[124:127]
  s_waitcnt lgkmcnt(4)
  v_mfma_f32_16x16x32_bf16 v[64:67], a[96:99], v[160:163], v[64:67]
  ds_read_b128 v[192:195], v19 offset:0
  v_mfma_f32_16x16x32_bf16 v[68:71], a[100:103], v[160:163], v[68:71]
  v_add_u32 v18, s33, v14
  v_mfma_f32_16x16x32_bf16 v[72:75], a[96:99], v[164:167], v[72:75]
  ds_read_b128 v[196:199], v19 offset:2048
  v_mfma_f32_16x16x32_bf16 v[76:79], a[100:103], v[164:167], v[76:79]
  buffer_load_dwordx4 v12, s[8:11], s30 offen offset:2048 lds
  v_mfma_f32_16x16x32_bf16 v[80:83], a[96:99], v[168:171], v[80:83]
  ds_read_b128 v[200:203], v19 offset:4096
  v_mfma_f32_16x16x32_bf16 v[84:87], a[100:103], v[168:171], v[84:87]
  v_mfma_f32_16x16x32_bf16 v[88:91], a[96:99], v[172:175], v[88:91]
  ds_read_b128 v[204:207], v19 offset:6144
  v_mfma_f32_16x16x32_bf16 v[92:95], a[100:103], v[172:175], v[92:95]
  s_waitcnt lgkmcnt(4)
  v_mfma_f32_16x16x32_bf16 v[96:99], a[96:99], v[176:179], v[96:99]
  ds_read_b128 v[208:211], v19 offset:8192
  v_mfma_f32_16x16x32_bf16 v[100:103], a[100:103], v[176:179], v[100:103]
  v_mfma_f32_16x16x32_bf16 v[104:107], a[96:99], v[180:183], v[104:107]
  ds_read_b128 v[212:215], v19 offset:10240
  v_mfma_f32_16x16x32_bf16 v[108:111], a[100:103], v[180:183], v[108:111]
  buffer_load_dwordx4 v13, s[8:11], s30 offen offset:3072 lds
  v_mfma_f32_16x16x32_bf16 v[112:115], a[96:99], v[184:187], v[112:115]
  ds_read_b128 v[216:219], v19 offset:12288
  s_add_u32 s30, s30, 128
  v_mfma_f32_16x16x32_bf16 v[116:119], a[100:103], v[184:187], v[116:119]
  s_add_u32 m0, m0, 16384
  v_mfma_f32_16x16x32_bf16 v[120:123], a[96:99], v[188:191], v[120:123]
  ds_read_b128 v[220:223], v19 offset:14336
  v_mfma_f32_16x16x32_bf16 v[124:127], a[100:103], v[188:191], v[124:127]
  s_waitcnt vmcnt(16) lgkmcnt(4)
  s_barrier
  v_mfma_f32_16x16x32_bf16 v[64:67], a[104:107], v[192:195], v[64:67]
  ds_read_b128 v[160:163], v18 offset:0
  v_mfma_f32_16x16x32_bf16 v[68:71], a[108:111], v[192:195], v[68:71]
  s_cmp_lt_u32 m0, s46
  s_cselect_b32 m0, m0, s47
  v_mfma_f32_16x16x32_bf16 v[72:75], a[104:107], v[196:199], v[72:75]
  ds_read_b128 v[164:167], v18 offset:2048
  v_add_u32 v19, s33, v15
  v_mfma_f32_16x16x32_bf16 v[76:79], a[108:111], v[196:199], v[76:79]
  buffer_load_dwordx4 v10, s[8:11], s30 offen offset:0 lds
  v_mfma_f32_16x16x32_bf16 v[80:83], a[104:107], v[200:203], v[80:83]
  ds_read_b128 v[168:171], v18 offset:4096
  s_add_u32 s33, s33, 16384
  v_mfma_f32_16x16x32_bf16 v[84:87], a[108:111], v[200:203], v[84:87]
  s_cmp_lt_u32 s33, 114688
  s_cselect_b32 s33, s33, 0
  v_mfma_f32_16x16x32_bf16 v[88:91], a[104:107], v[204:207], v[88:91]
  ds_read_b128 v[172:175], v18 offset:6144
  v_mfma_f32_16x16x32_bf16 v[92:95], a[108:111], v[204:207], v[92:95]
  s_waitcnt lgkmcnt(4)
  v_mfma_f32_16x16x32_bf16 v[96:99], a[104:107], v[208:211], v[96:99]
  ds_read_b128 v[176:179], v18 offset:8192
  v_mfma_f32_16x16x32_bf16 v[100:103], a[108:111], v[208:211], v[100:103]
  v_mfma_f32_16x16x32_bf16 v[104:107], a[104:107], v[212:215], v[104:107]
  ds_read_b128 v[180:183], v18 offset:10240
  v_mfma_f32_16x16x32_bf16 v[108:111], a[108:111], v[212:215], v[108:111]
  buffer_load_dwordx4 v11, s[8:11], s30 offen offset:1024 lds
  v_mfma_f32_16x16x32_bf16 v[112:115], a[104:107], v[216:219], v[112:115]
  ds_read_b128 v[184:187], v18 offset:12288
  v_mfma_f32_16x16x32_bf16 v[116:119], a[108:111], v[216:219], v[116:119]
  v_mfma_f32_16x16x32_bf16 v[120:123], a[104:107], v[220:223], v[120:123]
  ds_read_b128 v[188:191], v18 offset:14336
  v_mfma_f32_16x16x32_bf16 v[124:127], a[108:111], v[220:223], v[124:127]
  s_waitcnt lgkmcnt(4)
  v_mfma_f32_16x16x32_bf16 v[64:67], a[112:115], v[160:163], v[64:67]
  ds_read_b128 v[192:195], v19 offset:0
  v_mfma_f32_16x16x32_bf16 v[68:71], a[116:119], v[160:163], v[68:71]
  v_add_u32 v18, s33, v14
  v_mfma_f32_16x16x32_bf16 v[72:75], a[112:115], v[164:167], v[72:75]
  ds_read_b128 v[196:199], v19 offset:2048
  v_mfma_f32_16x16x32_bf16 v[76:79], a[116:119], v[164:167], v[76:79]
  buffer_load_dwordx4 v12, s[8:11], s30 offen offset:2048 lds
  v_mfma_f32_16x16x32_bf16 v[80:83], a[112:115], v[168:171], v[80:83]
  ds_read_b128 v[200:203], v19 offset:4096
  v_mfma_f32_16x16x32_bf16 v[84:87], a[116:119], v[168:171], v[84:87]
  v_mfma_f32_16x16x32_bf16 v[88:91], a[112:115], v[172:175], v[88:91]
  ds_read_b128 v[204:207], v19 offset:6144
  v_mfma_f32_16x16x32_bf16 v[92:95], a[116:119], v[172:175], v[92:95]
  s_waitcnt lgkmcnt(4)
  v_mfma_f32_16x16x32_bf16 v[96:99], a[112:115], v[176:179], v[96:99]
  ds_read_b128 v[208:211], v19 offset:8192
  v_mfma_f32_16x16x32_bf16 v[100:103], a[116:119], v[176:179], v[100:103]
  v_mfma_f32_16x16x32_bf16 v[104:107], a[112:115], v[180:183], v[104:107]
  ds_read_b128 v[212:215], v19 offset:10240
  v_mfma_f32_16x16x32_bf16 v[108:111], a[116:119], v[180:183], v[108:111]
  buffer_load_dwordx4 v13, s[8:11], s30 offen offset:3072 lds
  v_mfma_f32_16x16x32_bf16 v[112:115], a[112:115], v[184:187], v[112:115]
  ds_read_b128 v[216:219], v19 offset:12288
  s_add_u32 s30, s30, 128
  v_mfma_f32_16x16x32_bf16 v[116:119], a[116:119], v[184:187], v[116:119]
  s_add_u32 m0, m0, 16384
  v_mfma_f32_16x16x32_bf16 v[120:123], a[112:115], v[188:191], v[120:123]
  ds_read_b128 v[220:223], v19 offset:14336
  v_mfma_f32_16x16x32_bf16 v[124:127], a[116:119], v[188:191], v[124:127]
  s_waitcnt vmcnt(16) lgkmcnt(4)
  s_barrier
  v_mfma_f32_16x16x32_bf16 v[64:67], a[120:123], v[192:195], v[64:67]
  ds_read_b128 v[160:163], v18 offset:0
  v_mfma_f32_16x16x32_bf16 v[68:71], a[124:127], v[192:195], v[68:71]
  s_cmp_lt_u32 m0, s46
  s_cselect_b32 m0, m0, s47
  v_mfma_f32_16x16x32_bf16 v[72:75], a[120:123], v[196:199], v[72:75]
  ds_read_b128 v[164:167], v18 offset:2048
  v_add_u32 v19, s33, v15
  v_mfma_f32_16x16x32_bf16 v[76:79], a[124:127], v[196:199], v[76:79]
  buffer_load_dwordx4 v10, s[8:11], s30 offen offset:0 lds
  v_mfma_f32_16x16x32_bf16 v[80:83], a[120:123], v[200:203], v[80:83]
  ds_read_b128 v[168:171], v18 offset:4096
  s_add_u32 s33, s33, 16384
  v_mfma_f32_16x16x32_bf16 v[84:87], a[124:127], v[200:203], v[84:87]
  s_cmp_lt_u32 s33, 114688
  s_cselect_b32 s33, s33, 0
  v_mfma_f32_16x16x32_bf16 v[88:91], a[120:123], v[204:207], v[88:91]
  ds_read_b128 v[172:175], v18 offset:6144
  v_mfma_f32_16x16x32_bf16 v[92:95], a[124:127], v[204:207], v[92:95]
  s_waitcnt lgkmcnt(4)
  v_mfma_f32_16x16x32_bf16 v[96:99], a[120:123], v[208:211], v[96:99]
  ds_read_b128 v[176:179], v18 offset:8192
  v_mfma_f32_16x16x32_bf16 v[100:103], a[124:127], v[208:211], v[100:103]
  v_mfma_f32_16x16x32_bf16 v[104:107], a[120:123], v[212:215], v[104:107]
  ds_read_b128 v[180:183], v18 offset:10240
  v_mfma_f32_16x16x32_bf16 v[108:111], a[124:127], v[212:215], v[108:111]
  buffer_load_dwordx4 v11, s[8:11], s30 offen offset:1024 lds
  v_mfma_f32_16x16x32_bf16 v[112:115], a[120:123], v[216:219], v[112:115]
  ds_read_b128 v[184:187], v18 offset:12288
  v_mfma_f32_16x16x32_bf16 v[116:119], a[124:127], v[216:219], v[116:119]
  v_mfma_f32_16x16x32_bf16 v[120:123], a[120:123], v[220:223], v[120:123]
  ds_read_b128 v[188:191], v18 offset:14336
  v_mfma_f32_16x16x32_bf16 v[124:127], a[124:127], v[220:223], v[124:127]
  s_waitcnt lgkmcnt(4)
  v_mfma_f32_16x16x32_bf16 v[64:67], a[128:131], v[160:163], v[64:67]
  ds_read_b128 v[192:195], v19 offset:0
  v_mfma_f32_16x16x32_bf16 v[68:71], a[132:135], v[160:163], v[68:71]
  v_add_u32 v18, s33, v14
  v_mfma_f32_16x16x32_bf16 v[72:75], a[128:131], v[164:167], v[72:75]
  ds_read_b128 v[196:199], v19 offset:2048
  v_mfma_f32_16x16x32_bf16 v[76:79], a[132:135], v[164:167], v[76:79]
  buffer_load_dwordx4 v12, s[8:11], s30 offen offset:2048 lds
  v_mfma_f32_16x16x32_bf16 v[80:83], a[128:131], v[168:171], v[80:83]
  ds_read_b128 v[200:203], v19 offset:4096
  v_mfma_f32_16x16x32_bf16 v[84:87], a[132:135], v[168:171], v[84:87]
  v_mfma_f32_16x16x32_bf16 v[88:91], a[128:131], v[172:175], v[88:91]
  ds_read_b128 v[204:207], v19 offset:6144
  v_mfma_f32_16x16x32_bf16 v[92:95], a[132:135], v[172:175], v[92:95]
  s_waitcnt lgkmcnt(4)
  v_mfma_f32_16x16x32_bf16 v[96:99], a[128:131], v[176:179], v[96:99]
  ds_read_b128 v[208:211], v19 offset:8192
  v_mfma_f32_16x16x32_bf16 v[100:103], a[132:135], v[176:179], v[100:103]
  v_mfma_f32_16x16x32_bf16 v[104:107], a[128:131], v[180:183], v[104:107]
  ds_read_b128 v[212:215], v19 offset:10240
  v_mfma_f32_16x16x32_bf16 v[108:111], a[132:135], v[180:183], v[108:111]
  buffer_load_dwordx4 v13, s[8:11], s30 offen offset:3072 lds
  v_mfma_f32_16x16x32_bf16 v[112:115], a[128:131], v[184:187], v[112:115]
  ds_read_b128 v[216:219], v19 offset:12288
  s_add_u32 s30, s30, 128
  v_mfma_f32_16x16x32_bf16 v[116:119], a[132:135], v[184:187], v[116:119]
  s_add_u32 m0, m0, 16384
  v_mfma_f32_16x16x32_bf16 v[120:123], a[128:131], v[188:191], v[120:123]
  ds_read_b128 v[220:223], v19 offset:14336
  v_mfma_f32_16x16x32_bf16 v[124:127], a[132:135], v[188:191], v[124:127]
  s_waitcnt vmcnt(16) lgkmcnt(4)
  s_barrier
  v_mfma_f32_16x16x32_bf16 v[64:67], a[136:139], v[192:195], v[64:67]
  ds_read_b128 v[160:163], v18 offset:0
  v_mfma_f32_16x16x32_bf16 v[68:71], a[140:143], v[192:195], v[68:71]
  s_cmp_lt_u32 m0, s46
  s_cselect_b32 m0, m0, s47
  v_mfma_f32_16x16x32_bf16 v[72:75], a[136:139], v[196:199], v[72:75]
  ds_read_b128 v[164:167], v18 offset:2048
  v_add_u32 v19, s33, v15
  v_mfma_f32_16x16x32_bf16 v[76:79], a[140:143], v[196:199], v[76:79]
  buffer_load_dwordx4 v10, s[8:11], s30 offen offset:0 lds
  v_mfma_f32_16x16x32_bf16 v[80:83], a[136:139], v[200:203], v[80:83]
  ds_read_b128 v[168:171], v18 offset:4096
  s_add_u32 s33, s33, 16384
  v_mfma_f32_16x16x32_bf16 v[84:87], a[140:143], v[200:203], v[84:87]
  s_cmp_lt_u32 s33, 114688
  s_cselect_b32 s33, s33, 0
  v_mfma_f32_16x16x32_bf16 v[88:91], a[136:139], v[204:207], v[88:91]
  ds_read_b128 v[172:175], v18 offset:6144
  v_mfma_f32_16x16x32_bf16 v[92:95], a[140:143], v[204:207], v[92:95]
  s_waitcnt lgkmcnt(4)
  v_mfma_f32_16x16x32_bf16 v[96:99], a[136:139], v[208:211], v[96:99]
  ds_read_b128 v[176:179], v18 offset:8192
  v_mfma_f32_16x16x32_bf16 v[100:103], a[140:143], v[208:211], v[100:103]
  v_mfma_f32_16x16x32_bf16 v[104:107], a[136:139], v[212:215], v[104:107]
  ds_read_b128 v[180:183], v18 offset:10240
  v_mfma_f32_16x16x32_bf16 v[108:111], a[140:143], v[212:215], v[108:111]
  buffer_load_dwordx4 v11, s[8:11], s30 offen offset:1024 lds
  v_mfma_f32_16x16x32_bf16 v[112:115], a[136:139], v[216:219], v[112:115]
  ds_read_b128 v[184:187], v18 offset:12288
  v_mfma_f32_16x16x32_bf16 v[116:119], a[140:143], v[216:219], v[116:119]
  v_mfma_f32_16x16x32_bf16 v[120:123], a[136:139], v[220:223], v[120:123]
  ds_read_b128 v[188:191], v18 offset:14336
  v_mfma_f32_16x16x32_bf16 v[124:127], a[140:143], v[220:223], v[124:127]
  s_waitcnt lgkmcnt(4)
  v_mfma_f32_16x16x32_bf16 v[64:67], a[144:147], v[160:163], v[64:67]
  ds_read_b128 v[192:195], v19 offset:0
  v_mfma_f32_16x16x32_bf16 v[68:71], a[148:151], v[160:163], v[68:71]
  v_add_u32 v18, s33, v14
  v_mfma_f32_16x16x32_bf16 v[72:75], a[144:147], v[164:167], v[72:75]
  ds_read_b128 v[196:199], v19 offset:2048
  v_mfma_f32_16x16x32_bf16 v[76:79], a[148:151], v[164:167], v[76:79]
  buffer_load_dwordx4 v12, s[8:11], s30 offen offset:2048 lds
  v_mfma_f32_16x16x32_bf16 v[80:83], a[144:147], v[168:171], v[80:83]
  ds_read_b128 v[200:203], v19 offset:4096
  v_mfma_f32_16x16x32_bf16 v[84:87], a[148:151], v[168:171], v[84:87]
  v_mfma_f32_16x16x32_bf16 v[88:91], a[144:147], v[172:175], v[88:91]
  ds_read_b128 v[204:207], v19 offset:6144
  v_mfma_f32_16x16x32_bf16 v[92:95], a[148:151], v[172:175], v[92:95]
  s_waitcnt lgkmcnt(4)
  v_mfma_f32_16x16x32_bf16 v[96:99], a[144:147], v[176:179], v[96:99]
  ds_read_b128 v[208:211], v19 offset:8192
  v_mfma_f32_16x16x32_bf16 v[100:103], a[148:151], v[176:179], v[100:103]
  v_mfma_f32_16x16x32_bf16 v[104:107], a[144:147], v[180:183], v[104:107]
  ds_read_b128 v[212:215], v19 offset:10240
  v_mfma_f32_16x16x32_bf16 v[108:111], a[148:151], v[180:183], v[108:111]
  buffer_load_dwordx4 v13, s[8:11], s30 offen offset:3072 lds
  v_mfma_f32_16x16x32_bf16 v[112:115], a[144:147], v[184:187], v[112:115]
  ds_read_b128 v[216:219], v19 offset:12288
  s_add_u32 s30, s30, 128
  v_mfma_f32_16x16x32_bf16 v[116:119], a[148:151], v[184:187], v[116:119]
  s_add_u32 m0, m0, 16384
  v_mfma_f32_16x16x32_bf16 v[120:123], a[144:147], v[188:191], v[120:123]
  ds_read_b128 v[220:223], v19 offset:14336
  v_mfma_f32_16x16x32_bf16 v[124:127], a[148:151], v[188:191], v[124:127]
  s_waitcnt vmcnt(16) lgkmcnt(4)
  s_barrier
  v_mfma_f32_16x16x32_bf16 v[64:67], a[152:155], v[192:195], v[64:67]
  ds_read_b128 v[160:163], v18 offset:0
  v_mfma_f32_16x16x32_bf16 v[68:71], a[156:159], v[192:195], v[68:71]
  s_cmp_lt_u32 m0, s46
  s_cselect_b32 m0, m0, s47
  v_mfma_f32_16x16x32_bf16 v[72:75], a[152:155], v[196:199], v[72:75]
  ds_read_b128 v[164:167], v18 offset:2048
  v_add_u32 v19, s33, v15
  v_mfma_f32_16x16x32_bf16 v[76:79], a[156:159], v[196:199], v[76:79]
  buffer_load_dwordx4 v10, s[8:11], s30 offen offset:0 lds
  v_cvt_pk_bf16_f32 v224, v64, v65
  v_cvt_pk_bf16_f32 v225, v66, v67
  v_mfma_f32_16x16x32_bf16 v[80:83], a[152:155], v[200:203], v[80:83]
  ds_read_b128 v[168:171], v18 offset:4096
  s_add_u32 s33, s33, 16384
  v_cvt_pk_bf16_f32 v226, v68, v69
  v_cvt_pk_bf16_f32 v227, v70, v71
  v_mfma_f32_16x16x32_bf16 v[84:87], a[156:159], v[200:203], v[84:87]
  s_cmp_lt_u32 s33, 114688
  s_cselect_b32 s33, s33, 0
  ds_write_b64 v22, v[224:225] offset:0
  v_mfma_f32_16x16x32_bf16 v[88:91], a[152:155], v[204:207], v[88:91]
  ds_read_b128 v[172:175], v18 offset:6144
  ds_write_b64 v22, v[226:227] offset:32
  v_cvt_pk_bf16_f32 v230, v72, v73
  v_mfma_f32_16x16x32_bf16 v[92:95], a[156:159], v[204:207], v[92:95]
  s_waitcnt lgkmcnt(6)
  v_cvt_pk_bf16_f32 v231, v74, v75
  v_cvt_pk_bf16_f32 v232, v76, v77
  v_cvt_pk_bf16_f32 v233, v78, v79
  v_mfma_f32_16x16x32_bf16 v[96:99], a[152:155], v[208:211], v[96:99]
  ds_read_b128 v[176:179], v18 offset:8192
  ds_write_b64 v22, v[230:231] offset:4224
  v_mfma_f32_16x16x32_bf16 v[100:103], a[156:159], v[208:211], v[100:103]
  ds_write_b64 v22, v[232:233] offset:4256
  v_cvt_pk_bf16_f32 v224, v80, v81
  v_cvt_pk_bf16_f32 v225, v82, v83
  v_mfma_f32_16x16x32_bf16 v[104:107], a[152:155], v[212:215], v[104:107]
  ds_read_b128 v[180:183], v18 offset:10240
  v_cvt_pk_bf16_f32 v226, v84, v85
  v_cvt_pk_bf16_f32 v227, v86, v87
  v_mfma_f32_16x16x32_bf16 v[108:111], a[156:159], v[212:215], v[108:111]
  buffer_load_dwordx4 v11, s[8:11], s30 offen offset:1024 lds
  ds_write_b64 v22, v[224:225] offset:8448
  v_mfma_f32_16x16x32_bf16 v[112:115], a[152:155], v[216:219], v[112:115]
  ds_read_b128 v[184:187], v18 offset:12288
  ds_write_b64 v22, v[226:227] offset:8480
  v_cvt_pk_bf16_f32 v230, v88, v89
  v_mfma_f32_16x16x32_bf16 v[116:119], a[156:159], v[216:219], v[116:119]
  v_cvt_pk_bf16_f32 v231, v90, v91
  v_cvt_pk_bf16_f32 v232, v92, v93
  v_cvt_pk_bf16_f32 v233, v94, v95
  v_mfma_f32_16x16x32_bf16 v[120:123], a[152:155], v[220:223], v[120:123]
  ds_read_b128 v[188:191], v18 offset:14336
  ds_write_b64 v22, v[230:231] offset:12672
  v_mfma_f32_16x16x32_bf16 v[124:127], a[156:159], v[220:223], v[124:127]
  ds_write_b64 v22, v[232:233] offset:12704
  v_cvt_pk_bf16_f32 v224, v96, v97
  v_cvt_pk_bf16_f32 v225, v98, v99
bf_end_215:
  v_cvt_pk_bf16_f32 v226, v100, v101
  v_cvt_pk_bf16_f32 v227, v102, v103
  ds_write_b64 v22, v[224:225] offset:16896
  ds_write_b64 v22, v[226:227] offset:16928
  v_cvt_pk_bf16_f32 v230, v104, v105
  v_cvt_pk_bf16_f32 v231, v106, v107
  v_cvt_pk_bf16_f32 v232, v108, v109
  v_cvt_pk_bf16_f32 v233, v110, v111
  ds_write_b64 v22, v[230:231] offset:21120
  ds_write_b64 v22, v[232:233] offset:21152
  v_cvt_pk_bf16_f32 v224, v112, v113
  v_cvt_pk_bf16_f32 v225, v114, v115
  v_cvt_pk_bf16_f32 v226, v116, v117
  v_cvt_pk_bf16_f32 v227, v118, v119
  ds_write_b64 v22, v[224:225] offset:25344
  ds_write_b64 v22, v[226:227] offset:25376
  v_cvt_pk_bf16_f32 v230, v120, v121
  v_cvt_pk_bf16_f32 v231, v122, v123
  v_cvt_pk_bf16_f32 v232, v124, v125
  v_cvt_pk_bf16_f32 v233, v126, v127
  ds_write_b64 v22, v[230:231] offset:29568
  ds_write_b64 v22, v[232:233] offset:29600
  s_cmp_lg_u32 s26, 6
  s_cbranch_scc1 bw_216
  buffer_load_dword v32, v32, s[64:67], 0 offen sc1
  buffer_load_dwordx4 v[40:43], v33, s[12:15], s50 offen offset:0
  buffer_load_dwordx4 v[40:43], v33, s[12:15], s50 offen offset:1024
  buffer_load_dwordx4 v[40:43], v33, s[12:15], s50 offen offset:2048
  buffer_load_dwordx4 v[40:43], v33, s[12:15], s50 offen offset:3072
  buffer_load_dwordx4 v[40:43], v33, s[12:15], s51 offen offset:0
  buffer_load_dwordx4 v[40:43], v33, s[12:15], s51 offen offset:1024
  buffer_load_dwordx4 v[40:43], v33, s[12:15], s51 offen offset:2048
bw_216:
  s_waitcnt lgkmcnt(0)
  s_barrier
  ds_read_b64 v[144:145], v34 offset:1848
  ds_read_b64 v[146:147], v34 offset:1856
  ds_read_b64 v[148:149], v34 offset:1864
  ds_read_b64 v[150:151], v34 offset:1872
  ds_read_b64 v[152:153], v34 offset:1880
  ds_read_b64 v[64:65], v34 offset:1928
  ds_read_b64 v[66:67], v34 offset:1936
  ds_read_b64 v[68:69], v34 offset:1944
  ds_read_b64 v[70:71], v34 offset:1952
  ds_read_b64 v[72:73], v34 offset:1960
  ds_read_b64 v[74:75], v34 offset:1664
  ds_read_b64 v[76:77], v34 offset:1672
  ds_read_b64 v[78:79], v34 offset:1680
  ds_read_b64 v[80:81], v34 offset:1688
  ds_read_b64 v[82:83], v34 offset:1696
  ds_read_b64 v[84:85], v34 offset:1400
  ds_read_b64 v[86:87], v34 offset:1408
  ds_read_b64 v[88:89], v34 offset:1416
  ds_read_b64 v[90:91], v34 offset:1424
  ds_read_b64 v[92:93], v34 offset:1432
  ds_read_b64 v[94:95], v34 offset:1136
  ds_read_b64 v[96:97], v34 offset:1144
  ds_read_b64 v[98:99], v34 offset:1152
  ds_read_b64 v[100:101], v34 offset:1160
  ds_read_b64 v[102:103], v34 offset:1168
  ds_read_b64 v[104:105], v34 offset:872
  ds_read_b64 v[106:107], v34 offset:880
  ds_read_b64 v[108:109], v34 offset:888
  ds_read_b64 v[110:111], v34 offset:896
  ds_read_b64 v[112:113], v34 offset:904
  v_mov_b32 v224, 0
  v_mov_b32 v225, 0
  ds_read_b64 v[114:115], v34 offset:608
  ds_read_b64 v[116:117], v34 offset:616
  ds_read_b64 v[118:119], v34 offset:624
  ds_read_b64 v[120:121], v34 offset:632
  ds_read_b64 v[122:123], v34 offset:640
  v_mov_b32 v226, 0
  v_mov_b32 v227, 0
  ds_read_b64 v[124:125], v34 offset:344
  ds_read_b64 v[126:127], v34 offset:352
  ds_read_b64 v[128:129], v34 offset:360
  ds_read_b64 v[130:131], v34 offset:368
  ds_read_b64 v[132:133], v34 offset:376
  v_mov_b32 v228, 0
  v_mov_b32 v229, 0
  ds_read_b64 v[134:135], v34 offset:80
  ds_read_b64 v[136:137], v34 offset:88
  ds_read_b64 v[138:139], v34 offset:96
  ds_read_b64 v[140:141], v34 offset:104
  ds_read_b64 v[142:143], v34 offset:112
  v_mov_b32 v230, 0
  v_mov_b32 v231, 0
  v_mov_b32 v192, 0
  v_mov_b32 v193, 0
  v_mov_b32 v194, 0
  v_mov_b32 v195, 0
  v_mov_b32 v196, 0
  v_mov_b32 v197, 0
  v_mov_b32 v198, 0
  v_mov_b32 v199, 0
  v_mov_b32 v200, 0
  v_mov_b32 v201, 0
  v_mov_b32 v202, 0
  v_mov_b32 v203, 0
  v_mov_b32 v204, 0
  v_mov_b32 v205, 0
  v_mov_b32 v206, 0
  v_mov_b32 v207, 0
  v_mov_b32 v208, 0
  v_mov_b32 v209, 0
  v_mov_b32 v210, 0
  v_mov_b32 v211, 0
  s_waitcnt lgkmcnt(15)
  v_dot2c_f32_bf16 v224, v64, v144
  v_dot2c_f32_bf16 v225, v74, v144
  v_dot2c_f32_bf16 v226, v84, v144
  v_dot2c_f32_bf16 v227, v94, v144
  v_dot2c_f32_bf16 v228, v104, v144
  v_dot2c_f32_bf16 v224, v65, v145
  v_dot2c_f32_bf16 v225, v75, v145
  v_dot2c_f32_bf16 v226, v85, v145
  v_dot2c_f32_bf16 v227, v95, v145
  v_dot2c_f32_bf16 v228, v105, v145
  v_dot2c_f32_bf16 v224, v66, v146
  v_dot2c_f32_bf16 v225, v76, v146
  v_dot2c_f32_bf16 v226, v86, v146
  v_dot2c_f32_bf16 v227, v96, v146
  v_dot2c_f32_bf16 v228, v106, v146
  v_dot2c_f32_bf16 v224, v67, v147
  v_dot2c_f32_bf16 v225, v77, v147
  v_dot2c_f32_bf16 v226, v87, v147
  v_dot2c_f32_bf16 v227, v97, v147
  v_dot2c_f32_bf16 v228, v107, v147
  v_dot2c_f32_bf16 v224, v68, v148
  v_dot2c_f32_bf16 v225, v78, v148
  v_dot2c_f32_bf16 v226, v88, v148
  v_dot2c_f32_bf16 v227, v98, v148
  v_dot2c_f32_bf16 v228, v108, v148
  v_dot2c_f32_bf16 v224, v69, v149
  v_dot2c_f32_bf16 v225, v79, v149
  v_dot2c_f32_bf16 v226, v89, v149
  v_dot2c_f32_bf16 v227, v99, v149
  v_dot2c_f32_bf16 v228, v109, v149
  v_dot2c_f32_bf16 v224, v70, v150
  v_dot2c_f32_bf16 v225, v80, v150
  v_dot2c_f32_bf16 v226, v90, v150
  v_dot2c_f32_bf16 v227, v100, v150
  v_dot2c_f32_bf16 v228, v110, v150
  v_dot2c_f32_bf16 v224, v71, v151
  v_dot2c_f32_bf16 v225, v81, v151
  v_dot2c_f32_bf16 v226, v91, v151
  v_dot2c_f32_bf16 v227, v101, v151
  v_dot2c_f32_bf16 v228, v111, v151
  v_dot2c_f32_bf16 v224, v72, v152
  v_dot2c_f32_bf16 v225, v82, v152
  v_dot2c_f32_bf16 v226, v92, v152
  v_dot2c_f32_bf16 v227, v102, v152
  v_dot2c_f32_bf16 v228, v112, v152
  v_dot2c_f32_bf16 v224, v73, v153
  v_dot2c_f32_bf16 v225, v83, v153
  v_dot2c_f32_bf16 v226, v93, v153
  v_dot2c_f32_bf16 v227, v103, v153
  v_dot2c_f32_bf16 v228, v113, v153
  s_waitcnt lgkmcnt(0)
  v_dot2c_f32_bf16 v229, v114, v144
  v_dot2c_f32_bf16 v230, v124, v144
  v_dot2c_f32_bf16 v231, v134, v144
  v_dot2c_f32_bf16 v229, v115, v145
  v_dot2c_f32_bf16 v230, v125, v145
  v_dot2c_f32_bf16 v231, v135, v145
  v_dot2c_f32_bf16 v229, v116, v146
  v_dot2c_f32_bf16 v230, v126, v146
  v_dot2c_f32_bf16 v231, v136, v146
  v_dot2c_f32_bf16 v229, v117, v147
  v_dot2c_f32_bf16 v230, v127, v147
  v_dot2c_f32_bf16 v231, v137, v147
  v_dot2c_f32_bf16 v229, v118, v148
  v_dot2c_f32_bf16 v230, v128, v148
  v_dot2c_f32_bf16 v231, v138, v148
  v_dot2c_f32_bf16 v229, v119, v149
  v_dot2c_f32_bf16 v230, v129, v149
  v_dot2c_f32_bf16 v231, v139, v149
  v_dot2c_f32_bf16 v229, v120, v150
  v_dot2c_f32_bf16 v230, v130, v150
  v_dot2c_f32_bf16 v231, v140, v150
  v_dot2c_f32_bf16 v229, v121, v151
  v_dot2c_f32_bf16 v230, v131, v151
  v_dot2c_f32_bf16 v231, v141, v151
  v_dot2c_f32_bf16 v229, v122, v152
  v_dot2c_f32_bf16 v230, v132, v152
  v_dot2c_f32_bf16 v231, v142, v152
  v_dot2c_f32_bf16 v229, v123, v153
  v_dot2c_f32_bf16 v230, v133, v153
  v_dot2c_f32_bf16 v231, v143, v153
  ds_read_b64 v[64:65], v38 offset:2008
  ds_read_b64 v[66:67], v38 offset:2016
  ds_read_b64 v[68:69], v38 offset:2024
  ds_read_b64 v[70:71], v38 offset:2032
  ds_read_b64 v[72:73], v39 offset:2040
  ds_read_b64 v[74:75], v38 offset:1744
  ds_read_b64 v[76:77], v38 offset:1752
  ds_read_b64 v[78:79], v38 offset:1760
  ds_read_b64 v[80:81], v38 offset:1768
  ds_read_b64 v[82:83], v39 offset:1776
  ds_read_b64 v[84:85], v38 offset:1480
  ds_read_b64 v[86:87], v38 offset:1488
  ds_read_b64 v[88:89], v38 offset:1496
  ds_read_b64 v[90:91], v38 offset:1504
  ds_read_b64 v[92:93], v39 offset:1512
  ds_read_b64 v[94:95], v38 offset:1216
  ds_read_b64 v[96:97], v38 offset:1224
  ds_read_b64 v[98:99], v38 offset:1232
  ds_read_b64 v[100:101], v38 offset:1240
  ds_read_b64 v[102:103], v39 offset:1248
  ds_read_b64 v[104:105], v38 offset:952
  ds_read_b64 v[106:107], v38 offset:960
  ds_read_b64 v[108:109], v38 offset:968
  ds_read_b64 v[110:111], v38 offset:976
  ds_read_b64 v[112:113], v39 offset:984
  ds_read_b64 v[114:115], v38 offset:688
  ds_read_b64 v[116:117], v38 offset:696
  ds_read_b64 v[118:119], v38 offset:704
  ds_read_b64 v[120:121], v38 offset:712
  ds_read_b64 v[122:123], v39 offset:720
  ds_read_b64 v[124:125], v38 offset:424
  ds_read_b64 v[126:127], v38 offset:432
  ds_read_b64 v[128:129], v38 offset:440
  ds_read_b64 v[130:131], v38 offset:448
  ds_read_b64 v[132:133], v39 offset:456
  ds_read_b64 v[134:135], v38 offset:160
  ds_read_b64 v[136:137], v38 offset:168
  ds_read_b64 v[138:139], v38 offset:176
  ds_read_b64 v[140:141], v38 offset:184
  ds_read_b64 v[142:143], v39 offset:192
  v_cvt_pk_bf16_f32 v4, v224, v225
  v_lshlrev_b32 v224, 16, v4
  v_and_b32 v225, 0xffff0000, v4
  v_mul_f32 v224, s60, v224
  v_mul_f32 v225, s60, v225
  v_cvt_pk_bf16_f32 v4, v224, v225
  v_lshlrev_b32 v224, 16, v4
  v_and_b32 v225, 0xffff0000, v4
  v_cndmask_b32 v224, v37, v224, s[76:77]
  v_cndmask_b32 v225, v37, v225, s[78:79]
  v_cvt_pk_bf16_f32 v4, v226, v227
  v_lshlrev_b32 v226, 16, v4
  v_and_b32 v227, 0xffff0000, v4
  v_mul_f32 v226, s60, v226
  v_mul_f32 v227, s60, v227
  v_cvt_pk_bf16_f32 v4, v226, v227
  v_lshlrev_b32 v226, 16, v4
  v_and_b32 v227, 0xffff0000, v4
  v_cndmask_b32 v226, v37, v226, s[80:81]
  v_cndmask_b32 v227, v37, v227, s[82:83]
  v_cvt_pk_bf16_f32 v4, v228, v229
  v_lshlrev_b32 v228, 16, v4
  v_and_b32 v229, 0xffff0000, v4
  v_mul_f32 v228, s60, v228
  v_mul_f32 v229, s60, v229
  v_cvt_pk_bf16_f32 v4, v228, v229
  v_lshlrev_b32 v228, 16, v4
  v_and_b32 v229, 0xffff0000, v4
  v_cndmask_b32 v228, v37, v228, s[84:85]
  v_cndmask_b32 v229, v37, v229, s[86:87]
  v_cvt_pk_bf16_f32 v4, v230, v231
  v_lshlrev_b32 v230, 16, v4
  v_and_b32 v231, 0xffff0000, v4
  v_mul_f32 v230, s60, v230
  v_mul_f32 v231, s60, v231
  v_cvt_pk_bf16_f32 v4, v230, v231
  v_lshlrev_b32 v230, 16, v4
  v_and_b32 v231, 0xffff0000, v4
  v_cndmask_b32 v230, v37, v230, s[88:89]
  v_cndmask_b32 v231, v37, v231, s[90:91]
  v_max3_f32 v5, v224, v225, v226
  v_max3_f32 v5, v5, v227, v228
  v_max3_f32 v5, v5, v229, v230
  v_max_f32 v5, v5, v231
  v_sub_f32 v224, v224, v5
  v_mul_f32 v224, s61, v224
  v_exp_f32 v224, v224
  v_sub_f32 v225, v225, v5
  v_mul_f32 v225, s61, v225
  v_exp_f32 v225, v225
  v_sub_f32 v226, v226, v5
  v_mul_f32 v226, s61, v226
  v_exp_f32 v226, v226
  v_sub_f32 v227, v227, v5
  v_mul_f32 v227, s61, v227
  v_exp_f32 v227, v227
  v_sub_f32 v228, v228, v5
  v_mul_f32 v228, s61, v228
  v_exp_f32 v228, v228
  v_sub_f32 v229, v229, v5
  v_mul_f32 v229, s61, v229
  v_exp_f32 v229, v229
  v_sub_f32 v230, v230, v5
  v_mul_f32 v230, s61, v230
  v_exp_f32 v230, v230
  v_sub_f32 v231, v231, v5
  v_mul_f32 v231, s61, v231
  v_exp_f32 v231, v231
  s_nop 0
  v_add_f32 v5, v224, v225
  v_add_f32 v5, v5, v226
  v_add_f32 v5, v5, v227
  v_add_f32 v5, v5, v228
  v_add_f32 v5, v5, v229
  v_add_f32 v5, v5, v230
  v_add_f32 v5, v5, v231
  v_rcp_f32 v5, v5
  s_nop 0
  v_mul_f32 v224, v224, v5
  v_mul_f32 v225, v225, v5
  v_mul_f32 v226, v226, v5
  v_mul_f32 v227, v227, v5
  v_mul_f32 v228, v228, v5
  v_mul_f32 v229, v229, v5
  v_mul_f32 v230, v230, v5
  v_mul_f32 v231, v231, v5
  v_cvt_pk_bf16_f32 v232, v224, v225
  v_cvt_pk_bf16_f32 v233, v226, v227
  v_cvt_pk_bf16_f32 v234, v228, v229
  v_cvt_pk_bf16_f32 v235, v230, v231
  s_waitcnt lgkmcnt(15)
  v_perm_b32 v236, v74, v64, s62
  v_perm_b32 v237, v74, v64, s63
  v_dot2c_f32_bf16 v192, v236, v232
  v_dot2c_f32_bf16 v193, v237, v232
  v_perm_b32 v238, v75, v65, s62
  v_perm_b32 v239, v75, v65, s63
  v_dot2c_f32_bf16 v194, v238, v232
  v_dot2c_f32_bf16 v195, v239, v232
  v_perm_b32 v240, v76, v66, s62
  v_perm_b32 v241, v76, v66, s63
  v_dot2c_f32_bf16 v196, v240, v232
  v_dot2c_f32_bf16 v197, v241, v232
  v_perm_b32 v242, v77, v67, s62
  v_perm_b32 v243, v77, v67, s63
  v_dot2c_f32_bf16 v198, v242, v232
  v_dot2c_f32_bf16 v199, v243, v232
  v_perm_b32 v236, v78, v68, s62
  v_perm_b32 v237, v78, v68, s63
  v_dot2c_f32_bf16 v200, v236, v232
  v_dot2c_f32_bf16 v201, v237, v232
  v_perm_b32 v238, v79, v69, s62
  v_perm_b32 v239, v79, v69, s63
  v_dot2c_f32_bf16 v202, v238, v232
  v_dot2c_f32_bf16 v203, v239, v232
  v_perm_b32 v240, v80, v70, s62
  v_perm_b32 v241, v80, v70, s63
  v_dot2c_f32_bf16 v204, v240, v232
  v_dot2c_f32_bf16 v205, v241, v232
  v_perm_b32 v242, v81, v71, s62
  v_perm_b32 v243, v81, v71, s63
  v_dot2c_f32_bf16 v206, v242, v232
  v_dot2c_f32_bf16 v207, v243, v232
  v_perm_b32 v236, v82, v72, s62
  v_perm_b32 v237, v82, v72, s63
  v_dot2c_f32_bf16 v208, v236, v232
  v_dot2c_f32_bf16 v209, v237, v232
  v_perm_b32 v238, v83, v73, s62
  v_perm_b32 v239, v83, v73, s63
  v_dot2c_f32_bf16 v210, v238, v232
  v_dot2c_f32_bf16 v211, v239, v232
  s_waitcnt lgkmcnt(15)
  v_perm_b32 v236, v94, v84, s62
  v_perm_b32 v237, v94, v84, s63
  v_dot2c_f32_bf16 v192, v236, v233
  v_dot2c_f32_bf16 v193, v237, v233
  v_perm_b32 v238, v95, v85, s62
  v_perm_b32 v239, v95, v85, s63
  v_dot2c_f32_bf16 v194, v238, v233
  v_dot2c_f32_bf16 v195, v239, v233
  v_perm_b32 v240, v96, v86, s62
  v_perm_b32 v241, v96, v86, s63
  v_dot2c_f32_bf16 v196, v240, v233
  v_dot2c_f32_bf16 v197, v241, v233
  v_perm_b32 v242, v97, v87, s62
  v_perm_b32 v243, v97, v87, s63
  v_dot2c_f32_bf16 v198, v242, v233
  v_dot2c_f32_bf16 v199, v243, v233
  v_perm_b32 v236, v98, v88, s62
  v_perm_b32 v237, v98, v88, s63
  v_dot2c_f32_bf16 v200, v236, v233
  v_dot2c_f32_bf16 v201, v237, v233
  v_perm_b32 v238, v99, v89, s62
  v_perm_b32 v239, v99, v89, s63
  v_dot2c_f32_bf16 v202, v238, v233
  v_dot2c_f32_bf16 v203, v239, v233
  v_perm_b32 v240, v100, v90, s62
  v_perm_b32 v241, v100, v90, s63
  v_dot2c_f32_bf16 v204, v240, v233
  v_dot2c_f32_bf16 v205, v241, v233
  v_perm_b32 v242, v101, v91, s62
  v_perm_b32 v243, v101, v91, s63
  v_dot2c_f32_bf16 v206, v242, v233
  v_dot2c_f32_bf16 v207, v243, v233
  v_perm_b32 v236, v102, v92, s62
  v_perm_b32 v237, v102, v92, s63
  v_dot2c_f32_bf16 v208, v236, v233
  v_dot2c_f32_bf16 v209, v237, v233
  v_perm_b32 v238, v103, v93, s62
  v_perm_b32 v239, v103, v93, s63
  v_dot2c_f32_bf16 v210, v238, v233
  v_dot2c_f32_bf16 v211, v239, v233
  s_waitcnt lgkmcnt(10)
  v_perm_b32 v236, v114, v104, s62
  v_perm_b32 v237, v114, v104, s63
  v_dot2c_f32_bf16 v192, v236, v234
  v_dot2c_f32_bf16 v193, v237, v234
  v_perm_b32 v238, v115, v105, s62
  v_perm_b32 v239, v115, v105, s63
  v_dot2c_f32_bf16 v194, v238, v234
  v_dot2c_f32_bf16 v195, v239, v234
  v_perm_b32 v240, v116, v106, s62
  v_perm_b32 v241, v116, v106, s63
  v_dot2c_f32_bf16 v196, v240, v234
  v_dot2c_f32_bf16 v197, v241, v234
  v_perm_b32 v242, v117, v107, s62
  v_perm_b32 v243, v117, v107, s63
  v_dot2c_f32_bf16 v198, v242, v234
  v_dot2c_f32_bf16 v199, v243, v234
  v_perm_b32 v236, v118, v108, s62
  v_perm_b32 v237, v118, v108, s63
  v_dot2c_f32_bf16 v200, v236, v234
  v_dot2c_f32_bf16 v201, v237, v234
  v_perm_b32 v238, v119, v109, s62
  v_perm_b32 v239, v119, v109, s63
  v_dot2c_f32_bf16 v202, v238, v234
  v_dot2c_f32_bf16 v203, v239, v234
  v_perm_b32 v240, v120, v110, s62
  v_perm_b32 v241, v120, v110, s63
  v_dot2c_f32_bf16 v204, v240, v234
  v_dot2c_f32_bf16 v205, v241, v234
  v_perm_b32 v242, v121, v111, s62
  v_perm_b32 v243, v121, v111, s63
  v_dot2c_f32_bf16 v206, v242, v234
  v_dot2c_f32_bf16 v207, v243, v234
  v_perm_b32 v236, v122, v112, s62
  v_perm_b32 v237, v122, v112, s63
  v_dot2c_f32_bf16 v208, v236, v234
  v_dot2c_f32_bf16 v209, v237, v234
  v_perm_b32 v238, v123, v113, s62
  v_perm_b32 v239, v123, v113, s63
  v_dot2c_f32_bf16 v210, v238, v234
  v_dot2c_f32_bf16 v211, v239, v234
  s_waitcnt lgkmcnt(0)
  v_perm_b32 v236, v134, v124, s62
  v_perm_b32 v237, v134, v124, s63
  v_dot2c_f32_bf16 v192, v236, v235
  v_dot2c_f32_bf16 v193, v237, v235
  v_perm_b32 v238, v135, v125, s62
  v_perm_b32 v239, v135, v125, s63
  v_dot2c_f32_bf16 v194, v238, v235
  v_dot2c_f32_bf16 v195, v239, v235
  v_perm_b32 v240, v136, v126, s62
  v_perm_b32 v241, v136, v126, s63
  v_dot2c_f32_bf16 v196, v240, v235
  v_dot2c_f32_bf16 v197, v241, v235
  v_perm_b32 v242, v137, v127, s62
  v_perm_b32 v243, v137, v127, s63
  v_dot2c_f32_bf16 v198, v242, v235
  v_dot2c_f32_bf16 v199, v243, v235
  v_perm_b32 v236, v138, v128, s62
  v_perm_b32 v237, v138, v128, s63
  v_dot2c_f32_bf16 v200, v236, v235
  v_dot2c_f32_bf16 v201, v237, v235
  v_perm_b32 v238, v139, v129, s62
  v_perm_b32 v239, v139, v129, s63
  v_dot2c_f32_bf16 v202, v238, v235
  v_dot2c_f32_bf16 v203, v239, v235
  v_perm_b32 v240, v140, v130, s62
  v_perm_b32 v241, v140, v130, s63
  v_dot2c_f32_bf16 v204, v240, v235
  v_dot2c_f32_bf16 v205, v241, v235
  v_perm_b32 v242, v141, v131, s62
  v_perm_b32 v243, v141, v131, s63
  v_dot2c_f32_bf16 v206, v242, v235
  v_dot2c_f32_bf16 v207, v243, v235
  v_perm_b32 v236, v142, v132, s62
  v_perm_b32 v237, v142, v132, s63
  v_dot2c_f32_bf16 v208, v236, v235
  v_dot2c_f32_bf16 v209, v237, v235
  v_perm_b32 v238, v143, v133, s62
  v_perm_b32 v239, v143, v133, s63
  v_dot2c_f32_bf16 v210, v238, v235
  v_dot2c_f32_bf16 v211, v239, v235
  s_cmp_lg_u32 s20, 0
  s_cbranch_scc1 bh_217
  ds_read_b64 v[64:65], v35 offset:33792
  ds_read_b64 v[66:67], v35 offset:34304
  ds_read_b64 v[68:69], v35 offset:34816
  ds_read_b64 v[70:71], v35 offset:35328
  ds_read_b64 v[72:73], v35 offset:35840
  s_waitcnt lgkmcnt(0)
  ds_write_b64 v35, v[64:65] offset:0
  ds_write_b64 v35, v[66:67] offset:512
  ds_write_b64 v35, v[68:69] offset:1024
  ds_write_b64 v35, v[70:71] offset:1536
  ds_write_b64 v35, v[72:73] offset:2048
bh_217:
  s_nop 1
  v_cvt_pk_bf16_f32 v244, v192, v193
  v_cvt_pk_bf16_f32 v245, v194, v195
  v_cvt_pk_bf16_f32 v246, v196, v197
  v_cvt_pk_bf16_f32 v247, v198, v199
  v_cvt_pk_bf16_f32 v248, v200, v201
  v_cvt_pk_bf16_f32 v249, v202, v203
  v_cvt_pk_bf16_f32 v250, v204, v205
  v_cvt_pk_bf16_f32 v251, v206, v207
  v_cvt_pk_bf16_f32 v252, v208, v209
  v_cvt_pk_bf16_f32 v253, v210, v211
  buffer_store_dwordx4 v[244:247], v29, s[16:19], s27 offen sc1
  buffer_store_dwordx4 v[248:251], v30, s[16:19], s27 offen sc1
  buffer_store_dwordx2 v[252:253], v31, s[16:19], s27 offen sc1
  s_add_u32 s27, s27, 2048
  s_mov_b64 s[78:79], -1
  s_mov_b64 s[80:81], -1
  s_mov_b64 s[82:83], -1
  s_mov_b64 s[84:85], -1
  s_mov_b64 s[86:87], -1
  s_mov_b64 s[88:89], -1
  s_mov_b64 s[90:91], -1
  s_sub_u32 s26, s26, 1
  s_cmp_gt_u32 s26, 0
  s_waitcnt lgkmcnt(0)
  s_cbranch_scc1 bf_blk_214
  s_waitcnt vmcnt(0) lgkmcnt(0)
  s_barrier
  s_mov_b32 s84, 0
  s_mov_b32 s85, -1
  s_load_dwordx2 s[4:5], s[0:1], 0
  s_load_dwordx2 s[6:7], s[0:1], 16
  s_load_dwordx2 s[38:39], s[0:1], 104
  s_mov_b32 s42, s2
  s_mov_b32 s41, 0
  s_waitcnt lgkmcnt(0)
  s_mov_b32 s8, s4
  s_mov_b32 s9, s5
  s_mov_b32 s10, 2621440
  s_mov_b32 s11, 0x00020000
  s_mov_b32 s12, s6
  s_mov_b32 s13, s7
  s_mov_b32 s14, 7864320
  s_mov_b32 s15, 0x00020000
  s_mov_b32 s16, s38
  s_mov_b32 s17, s39
  s_mov_b32 s18, 50331648
  s_mov_b32 s19, 0x00020000
  s_add_u32 s52, s38, 50331648
  s_addc_u32 s53, s39, 0
  s_mov_b32 s54, 6291456
  s_mov_b32 s55, 0x00020000
  s_add_u32 s56, s38, 85983232
  s_addc_u32 s57, s39, 0
  s_mov_b32 s58, 6815744
  s_mov_b32 s59, 0x00020000
  s_load_dwordx2 s[72:73], s[0:1], 104
  s_waitcnt lgkmcnt(0)
  s_add_u32 s72, s72, 81068032
  s_addc_u32 s73, s73, 0
  s_mov_b32 s74, 116736
  s_mov_b32 s75, 0x00020000
  s_mul_i32 s44, s42, 384
  s_mov_b32 s24, 0
  v_mov_b32 v9, 2731
  s_and_b32 s22, s20, 1
  s_lshl_b32 s22, s22, 2
  v_add_u32 v8, 0, v1
  v_mul_u32_u24 v7, v8, v9
  v_lshrrev_b32 v7, 16, v7
  v_mul_u32_u24 v4, 24, v7
  v_sub_u32 v8, v8, v4
  v_and_b32 v4, 2, v7
  v_xor_b32 v8, v8, v4
  v_xor_b32 v8, s22, v8
  v_xor_b32 v5, 4, v8
  s_mov_b32 s21, 12288
  v_mul_lo_u32 v7, v7, s21
  v_lshl_add_u32 v40, v8, 4, v7
  v_lshl_add_u32 v43, v5, 4, v7
  v_add_u32 v8, 64, v1
  v_mul_u32_u24 v7, v8, v9
  v_lshrrev_b32 v7, 16, v7
  v_mul_u32_u24 v4, 24, v7
  v_sub_u32 v8, v8, v4
  v_and_b32 v4, 2, v7
  v_xor_b32 v8, v8, v4
  v_xor_b32 v8, s22, v8
  v_xor_b32 v5, 4, v8
  s_mov_b32 s21, 12288
  v_mul_lo_u32 v7, v7, s21
  v_lshl_add_u32 v41, v8, 4, v7
  v_lshl_add_u32 v44, v5, 4, v7
  v_add_u32 v8, 128, v1
  v_mul_u32_u24 v7, v8, v9
  v_lshrrev_b32 v7, 16, v7
  v_mul_u32_u24 v4, 24, v7
  v_sub_u32 v8, v8, v4
  v_and_b32 v4, 2, v7
  v_xor_b32 v8, v8, v4
  v_xor_b32 v8, s22, v8
  v_xor_b32 v5, 4, v8
  s_mov_b32 s21, 12288
  v_mul_lo_u32 v7, v7, s21
  v_lshl_add_u32 v42, v8, 4, v7
  v_lshl_add_u32 v45, v5, 4, v7
  s_mul_i32 s23, s20, 491520
  s_add_u32 s23, s23, s44
  s_mul_i32 s22, s20, 15360
  s_add_u32 s22, s22, 98304
  s_add_u32 s21, s23, 0
  s_add_u32 m0, s22, 0
  s_nop 0
  buffer_load_dwordx4 v40, s[12:15], s21 offen lds
  s_add_u32 m0, s22, 1024
  s_nop 0
  buffer_load_dwordx4 v41, s[12:15], s21 offen lds
  s_add_u32 m0, s22, 2048
  s_nop 0
  buffer_load_dwordx4 v42, s[12:15], s21 offen lds
  s_add_u32 s21, s23, 98304
  s_add_u32 m0, s22, 3072
  s_nop 0
  buffer_load_dwordx4 v43, s[12:15], s21 offen lds
  s_add_u32 m0, s22, 4096
  s_nop 0
  buffer_load_dwordx4 v44, s[12:15], s21 offen lds
  s_add_u32 m0, s22, 5120
  s_nop 0
  buffer_load_dwordx4 v45, s[12:15], s21 offen lds
  s_add_u32 s21, s23, 196608
  s_add_u32 m0, s22, 6144
  s_nop 0
  buffer_load_dwordx4 v40, s[12:15], s21 offen lds
  s_add_u32 m0, s22, 7168
  s_nop 0
  buffer_load_dwordx4 v41, s[12:15], s21 offen lds
  s_add_u32 m0, s22, 8192
  s_nop 0
  buffer_load_dwordx4 v42, s[12:15], s21 offen lds
  s_add_u32 s21, s23, 294912
  s_add_u32 m0, s22, 9216
  s_nop 0
  buffer_load_dwordx4 v43, s[12:15], s21 offen lds
  s_add_u32 m0, s22, 10240
  s_nop 0
  buffer_load_dwordx4 v44, s[12:15], s21 offen lds
  s_add_u32 m0, s22, 11264
  s_nop 0
  buffer_load_dwordx4 v45, s[12:15], s21 offen lds
  s_add_u32 s21, s23, 393216
  s_add_u32 m0, s22, 12288
  s_nop 0
  buffer_load_dwordx4 v40, s[12:15], s21 offen lds
  s_add_u32 m0, s22, 13312
  s_nop 0
  buffer_load_dwordx4 v41, s[12:15], s21 offen lds
  s_add_u32 m0, s22, 14336
  s_nop 0
  buffer_load_dwordx4 v42, s[12:15], s21 offen lds
  s_add_u32 s21, s23, 1966080
  buffer_load_dwordx4 v[64:67], v40, s[12:15], s21 offen
  buffer_load_dwordx4 v[68:71], v41, s[12:15], s21 offen
  buffer_load_dwordx4 v[72:75], v42, s[12:15], s21 offen
  s_add_u32 s21, s23, 2064384
  buffer_load_dwordx4 v[76:79], v43, s[12:15], s21 offen
  buffer_load_dwordx4 v[80:83], v44, s[12:15], s21 offen
  buffer_load_dwordx4 v[84:87], v45, s[12:15], s21 offen
  s_add_u32 s21, s23, 2162688
  buffer_load_dwordx4 v[88:91], v40, s[12:15], s21 offen
  buffer_load_dwordx4 v[92:95], v41, s[12:15], s21 offen
  buffer_load_dwordx4 v[96:99], v42, s[12:15], s21 offen
  s_add_u32 s21, s23, 2260992
  buffer_load_dwordx4 v[100:103], v43, s[12:15], s21 offen
  buffer_load_dwordx4 v[104:107], v44, s[12:15], s21 offen
  buffer_load_dwordx4 v[108:111], v45, s[12:15], s21 offen
  s_add_u32 s21, s23, 2359296
  buffer_load_dwordx4 v[112:115], v40, s[12:15], s21 offen
  buffer_load_dwordx4 v[116:119], v41, s[12:15], s21 offen
  buffer_load_dwordx4 v[120:123], v42, s[12:15], s21 offen
  s_add_u32 s21, s23, 3932160
  buffer_load_dwordx4 v[124:127], v40, s[12:15], s21 offen
  buffer_load_dwordx4 v[128:131], v41, s[12:15], s21 offen
  buffer_load_dwordx4 v[132:135], v42, s[12:15], s21 offen
  s_add_u32 s21, s23, 4030464
  buffer_load_dwordx4 v[136:139], v43, s[12:15], s21 offen
  buffer_load_dwordx4 v[140:143], v44, s[12:15], s21 offen
  buffer_load_dwordx4 v[144:147], v45, s[12:15], s21 offen
  s_add_u32 s21, s23, 4128768
  buffer_load_dwordx4 v[148:151], v40, s[12:15], s21 offen
  buffer_load_dwordx4 v[152:155], v41, s[12:15], s21 offen
  buffer_load_dwordx4 v[156:159], v42, s[12:15], s21 offen
  s_add_u32 s21, s23, 4227072
  buffer_load_dwordx4 v[160:163], v43, s[12:15], s21 offen
  buffer_load_dwordx4 v[164:167], v44, s[12:15], s21 offen
  buffer_load_dwordx4 v[168:171], v45, s[12:15], s21 offen
  s_add_u32 s21, s23, 4325376
  buffer_load_dwordx4 v[172:175], v40, s[12:15], s21 offen
  buffer_load_dwordx4 v[176:179], v41, s[12:15], s21 offen
  buffer_load_dwordx4 v[180:183], v42, s[12:15], s21 offen
  s_add_u32 s21, s23, 5898240
  buffer_load_dwordx4 v[184:187], v40, s[12:15], s21 offen
  buffer_load_dwordx4 v[188:191], v41, s[12:15], s21 offen
  buffer_load_dwordx4 v[192:195], v42, s[12:15], s21 offen
  s_add_u32 s21, s23, 5996544
  buffer_load_dwordx4 v[196:199], v43, s[12:15], s21 offen
  buffer_load_dwordx4 v[200:203], v44, s[12:15], s21 offen
  buffer_load_dwordx4 v[204:207], v45, s[12:15], s21 offen
  s_add_u32 s21, s23, 6094848
  buffer_load_dwordx4 v[208:211], v40, s[12:15], s21 offen
  buffer_load_dwordx4 v[212:215], v41, s[12:15], s21 offen
  buffer_load_dwordx4 v[216:219], v42, s[12:15], s21 offen
  s_add_u32 s21, s23, 6193152
  buffer_load_dwordx4 v[220:223], v43, s[12:15], s21 offen
  buffer_load_dwordx4 v[224:227], v44, s[12:15], s21 offen
  buffer_load_dwordx4 v[228:231], v45, s[12:15], s21 offen
  s_add_u32 s21, s23, 6291456
  buffer_load_dwordx4 v[232:235], v40, s[12:15], s21 offen
  buffer_load_dwordx4 v[236:239], v41, s[12:15], s21 offen
  buffer_load_dwordx4 v[240:243], v42, s[12:15], s21 offen
  v_lshl_add_u32 v49, v1, 4, s22
  v_lshrrev_b32 v7, 2, v2
  v_and_b32 v4, 2, v7
  v_and_b32 v5, 1, v3
  v_lshl_or_b32 v4, v5, 2, v4
  v_lshl_add_u32 v7, v3, 3, v7
  v_mul_u32_u24 v7, 384, v7
  v_and_b32 v5, 1, v2
  v_lshl_add_u32 v7, v5, 3, v7
  v_add_u32 v7, 98304, v7
  v_bfe_u32 v8, v2, 1, 1
  s_mul_i32 s21, s20, 6
  v_add_u32 v8, s21, v8
  v_add_u32 v5, 0, v8
  v_xor_b32 v5, v5, v4
  v_lshl_add_u32 v46, v5, 4, v7
  v_add_u32 v5, 2, v8
  v_xor_b32 v5, v5, v4
  v_lshl_add_u32 v47, v5, 4, v7
  v_add_u32 v5, 4, v8
  v_xor_b32 v5, v5, v4
  v_lshl_add_u32 v48, v5, 4, v7
  s_waitcnt vmcnt(45)
  s_barrier
  ds_read_b64_tr_b16 a[0:1], v46 offset:0
  ds_read_b64_tr_b16 a[2:3], v46 offset:1536
  ds_read_b64_tr_b16 a[4:5], v47 offset:0
  ds_read_b64_tr_b16 a[6:7], v47 offset:1536
  ds_read_b64_tr_b16 a[8:9], v48 offset:0
  ds_read_b64_tr_b16 a[10:11], v48 offset:1536
  ds_read_b64_tr_b16 a[12:13], v46 offset:12288
  ds_read_b64_tr_b16 a[14:15], v46 offset:13824
  ds_read_b64_tr_b16 a[16:17], v47 offset:12288
  ds_read_b64_tr_b16 a[18:19], v47 offset:13824
  ds_read_b64_tr_b16 a[20:21], v48 offset:12288
  ds_read_b64_tr_b16 a[22:23], v48 offset:13824
  ds_read_b64_tr_b16 a[24:25], v46 offset:24576
  ds_read_b64_tr_b16 a[26:27], v46 offset:26112
  ds_read_b64_tr_b16 a[28:29], v47 offset:24576
  ds_read_b64_tr_b16 a[30:31], v47 offset:26112
  ds_read_b64_tr_b16 a[32:33], v48 offset:24576
  ds_read_b64_tr_b16 a[34:35], v48 offset:26112
  ds_read_b64_tr_b16 a[36:37], v46 offset:36864
  ds_read_b64_tr_b16 a[38:39], v46 offset:38400
  ds_read_b64_tr_b16 a[40:41], v47 offset:36864
  ds_read_b64_tr_b16 a[42:43], v47 offset:38400
  ds_read_b64_tr_b16 a[44:45], v48 offset:36864
  ds_read_b64_tr_b16 a[46:47], v48 offset:38400
  ds_read_b64_tr_b16 a[48:49], v46 offset:49152
  ds_read_b64_tr_b16 a[50:51], v46 offset:50688
  ds_read_b64_tr_b16 a[52:53], v47 offset:49152
  ds_read_b64_tr_b16 a[54:55], v47 offset:50688
  ds_read_b64_tr_b16 a[56:57], v48 offset:49152
  ds_read_b64_tr_b16 a[58:59], v48 offset:50688
  v_lshrrev_b32 v11, 3, v1
  v_and_b32 v12, 7, v1
  v_xor_b32 v12, v12, v11
  v_mul_u32_u24 v11, 1280, v11
  v_lshl_add_u32 v10, v12, 4, v11
  s_mul_i32 s46, s20, 40960
  v_add_u32 v10, s46, v10
  s_lshl_b32 s47, s20, 12
  s_add_u32 s47, s47, 0
  s_add_u32 s46, s47, 98304
  s_mov_b32 s30, s24
  s_add_u32 s32, s47, 0
  v_add_u32 v11, 9216, v10
  v_add_u32 v12, 18432, v10
  v_add_u32 v13, 27648, v10
  s_mov_b32 m0, s32
  s_nop 0
  buffer_load_dwordx4 v10, s[8:11], s30 offen offset:0 lds
  buffer_load_dwordx4 v11, s[8:11], s30 offen offset:1024 lds
  buffer_load_dwordx4 v12, s[8:11], s30 offen offset:2048 lds
  buffer_load_dwordx4 v13, s[8:11], s30 offen offset:3072 lds
  s_add_u32 s30, s30, 128
  s_add_u32 s32, s32, 16384
  s_cmp_lt_u32 s32, s46
  s_cselect_b32 s32, s32, s47
  s_mov_b32 m0, s32
  s_nop 0
  buffer_load_dwordx4 v10, s[8:11], s30 offen offset:0 lds
  buffer_load_dwordx4 v11, s[8:11], s30 offen offset:1024 lds
  buffer_load_dwordx4 v12, s[8:11], s30 offen offset:2048 lds
  buffer_load_dwordx4 v13, s[8:11], s30 offen offset:3072 lds
  s_add_u32 s30, s30, 128
  s_add_u32 s32, s32, 16384
  s_cmp_lt_u32 s32, s46
  s_cselect_b32 s32, s32, s47
  s_mov_b32 m0, s32
  s_nop 0
  buffer_load_dwordx4 v10, s[8:11], s30 offen offset:0 lds
  buffer_load_dwordx4 v11, s[8:11], s30 offen offset:1024 lds
  buffer_load_dwordx4 v12, s[8:11], s30 offen offset:2048 lds
  buffer_load_dwordx4 v13, s[8:11], s30 offen offset:3072 lds
  s_add_u32 s30, s30, 128
  s_add_u32 s32, s32, 16384
  s_cmp_lt_u32 s32, s46
  s_cselect_b32 s32, s32, s47
  s_mov_b32 m0, s32
  s_nop 0
  buffer_load_dwordx4 v10, s[8:11], s30 offen offset:0 lds
  buffer_load_dwordx4 v11, s[8:11], s30 offen offset:1024 lds
  buffer_load_dwordx4 v12, s[8:11], s30 offen offset:2048 lds
  buffer_load_dwordx4 v13, s[8:11], s30 offen offset:3072 lds
  s_add_u32 s30, s30, 128
  s_add_u32 s32, s32, 16384
  s_cmp_lt_u32 s32, s46
  s_cselect_b32 s32, s32, s47
  s_waitcnt lgkmcnt(0)
  s_barrier
  s_waitcnt vmcnt(46)
  ds_write_b128 v49, v[64:67] offset:0
  ds_write_b128 v49, v[68:71] offset:1024
  ds_write_b128 v49, v[72:75] offset:2048
  ds_write_b128 v49, v[76:79] offset:3072
  ds_write_b128 v49, v[80:83] offset:4096
  ds_write_b128 v49, v[84:87] offset:5120
  ds_write_b128 v49, v[88:91] offset:6144
  ds_write_b128 v49, v[92:95] offset:7168
  ds_write_b128 v49, v[96:99] offset:8192
  ds_write_b128 v49, v[100:103] offset:9216
  ds_write_b128 v49, v[104:107] offset:10240
  ds_write_b128 v49, v[108:111] offset:11264
  ds_write_b128 v49, v[112:115] offset:12288
  ds_write_b128 v49, v[116:119] offset:13312
  ds_write_b128 v49, v[120:123] offset:14336
  s_waitcnt lgkmcnt(0)
  s_barrier
  ds_read_b64_tr_b16 a[60:61], v46 offset:0
  ds_read_b64_tr_b16 a[62:63], v46 offset:1536
  ds_read_b64_tr_b16 a[64:65], v47 offset:0
  ds_read_b64_tr_b16 a[66:67], v47 offset:1536
  ds_read_b64_tr_b16 a[68:69], v48 offset:0
  ds_read_b64_tr_b16 a[70:71], v48 offset:1536
  ds_read_b64_tr_b16 a[72:73], v46 offset:12288
  ds_read_b64_tr_b16 a[74:75], v46 offset:13824
  ds_read_b64_tr_b16 a[76:77], v47 offset:12288
  ds_read_b64_tr_b16 a[78:79], v47 offset:13824
  ds_read_b64_tr_b16 a[80:81], v48 offset:12288
  ds_read_b64_tr_b16 a[82:83], v48 offset:13824
  ds_read_b64_tr_b16 a[84:85], v46 offset:24576
  ds_read_b64_tr_b16 a[86:87], v46 offset:26112
  ds_read_b64_tr_b16 a[88:89], v47 offset:24576
  ds_read_b64_tr_b16 a[90:91], v47 offset:26112
  ds_read_b64_tr_b16 a[92:93], v48 offset:24576
  ds_read_b64_tr_b16 a[94:95], v48 offset:26112
  ds_read_b64_tr_b16 a[96:97], v46 offset:36864
  ds_read_b64_tr_b16 a[98:99], v46 offset:38400
  ds_read_b64_tr_b16 a[100:101], v47 offset:36864
  ds_read_b64_tr_b16 a[102:103], v47 offset:38400
  ds_read_b64_tr_b16 a[104:105], v48 offset:36864
  ds_read_b64_tr_b16 a[106:107], v48 offset:38400
  ds_read_b64_tr_b16 a[108:109], v46 offset:49152
  ds_read_b64_tr_b16 a[110:111], v46 offset:50688
  ds_read_b64_tr_b16 a[112:113], v47 offset:49152
  ds_read_b64_tr_b16 a[114:115], v47 offset:50688
  ds_read_b64_tr_b16 a[116:117], v48 offset:49152
  ds_read_b64_tr_b16 a[118:119], v48 offset:50688
  s_waitcnt lgkmcnt(0)
  s_barrier
  s_waitcnt vmcnt(31)
  ds_write_b128 v49, v[124:127] offset:0
  ds_write_b128 v49, v[128:131] offset:1024
  ds_write_b128 v49, v[132:135] offset:2048
  ds_write_b128 v49, v[136:139] offset:3072
  ds_write_b128 v49, v[140:143] offset:4096
  ds_write_b128 v49, v[144:147] offset:5120
  ds_write_b128 v49, v[148:151] offset:6144
  ds_write_b128 v49, v[152:155] offset:7168
  ds_write_b128 v49, v[156:159] offset:8192
  ds_write_b128 v49, v[160:163] offset:9216
  ds_write_b128 v49, v[164:167] offset:10240
  ds_write_b128 v49, v[168:171] offset:11264
  ds_write_b128 v49, v[172:175] offset:12288
  ds_write_b128 v49, v[176:179] offset:13312
  ds_write_b128 v49, v[180:183] offset:14336
  s_waitcnt lgkmcnt(0)
  s_barrier
  ds_read_b64_tr_b16 a[120:121], v46 offset:0
  ds_read_b64_tr_b16 a[122:123], v46 offset:1536
  ds_read_b64_tr_b16 a[124:125], v47 offset:0
  ds_read_b64_tr_b16 a[126:127], v47 offset:1536
  ds_read_b64_tr_b16 a[128:129], v48 offset:0
  ds_read_b64_tr_b16 a[130:131], v48 offset:1536
  ds_read_b64_tr_b16 a[132:133], v46 offset:12288
  ds_read_b64_tr_b16 a[134:135], v46 offset:13824
  ds_read_b64_tr_b16 a[136:137], v47 offset:12288
  ds_read_b64_tr_b16 a[138:139], v47 offset:13824
  ds_read_b64_tr_b16 a[140:141], v48 offset:12288
  ds_read_b64_tr_b16 a[142:143], v48 offset:13824
  ds_read_b64_tr_b16 a[144:145], v46 offset:24576
  ds_read_b64_tr_b16 a[146:147], v46 offset:26112
  ds_read_b64_tr_b16 a[148:149], v47 offset:24576
  ds_read_b64_tr_b16 a[150:151], v47 offset:26112
  ds_read_b64_tr_b16 a[152:153], v48 offset:24576
  ds_read_b64_tr_b16 a[154:155], v48 offset:26112
  ds_read_b64_tr_b16 a[156:157], v46 offset:36864
  ds_read_b64_tr_b16 a[158:159], v46 offset:38400
  ds_read_b64_tr_b16 a[160:161], v47 offset:36864
  ds_read_b64_tr_b16 a[162:163], v47 offset:38400
  ds_read_b64_tr_b16 a[164:165], v48 offset:36864
  ds_read_b64_tr_b16 a[166:167], v48 offset:38400
  ds_read_b64_tr_b16 a[168:169], v46 offset:49152
  ds_read_b64_tr_b16 a[170:171], v46 offset:50688
  ds_read_b64_tr_b16 a[172:173], v47 offset:49152
  ds_read_b64_tr_b16 a[174:175], v47 offset:50688
  ds_read_b64_tr_b16 a[176:177], v48 offset:49152
  ds_read_b64_tr_b16 a[178:179], v48 offset:50688
  s_waitcnt lgkmcnt(0)
  s_barrier
  s_waitcnt vmcnt(16)
  ds_write_b128 v49, v[184:187] offset:0
  ds_write_b128 v49, v[188:191] offset:1024
  ds_write_b128 v49, v[192:195] offset:2048
  ds_write_b128 v49, v[196:199] offset:3072
  ds_write_b128 v49, v[200:203] offset:4096
  ds_write_b128 v49, v[204:207] offset:5120
  ds_write_b128 v49, v[208:211] offset:6144
  ds_write_b128 v49, v[212:215] offset:7168
  ds_write_b128 v49, v[216:219] offset:8192
  ds_write_b128 v49, v[220:223] offset:9216
  ds_write_b128 v49, v[224:227] offset:10240
  ds_write_b128 v49, v[228:231] offset:11264
  ds_write_b128 v49, v[232:235] offset:12288
  ds_write_b128 v49, v[236:239] offset:13312
  ds_write_b128 v49, v[240:243] offset:14336
  s_waitcnt lgkmcnt(0)
  s_barrier
  ds_read_b64_tr_b16 a[180:181], v46 offset:0
  ds_read_b64_tr_b16 a[182:183], v46 offset:1536
  ds_read_b64_tr_b16 a[184:185], v47 offset:0
  ds_read_b64_tr_b16 a[186:187], v47 offset:1536
  ds_read_b64_tr_b16 a[188:189], v48 offset:0
  ds_read_b64_tr_b16 a[190:191], v48 offset:1536
  ds_read_b64_tr_b16 a[192:193], v46 offset:12288
  ds_read_b64_tr_b16 a[194:195], v46 offset:13824
  ds_read_b64_tr_b16 a[196:197], v47 offset:12288
  ds_read_b64_tr_b16 a[198:199], v47 offset:13824
  ds_read_b64_tr_b16 a[200:201], v48 offset:12288
  ds_read_b64_tr_b16 a[202:203], v48 offset:13824
  ds_read_b64_tr_b16 a[204:205], v46 offset:24576
  ds_read_b64_tr_b16 a[206:207], v46 offset:26112
  ds_read_b64_tr_b16 a[208:209], v47 offset:24576
  ds_read_b64_tr_b16 a[210:211], v47 offset:26112
  ds_read_b64_tr_b16 a[212:213], v48 offset:24576
  ds_read_b64_tr_b16 a[214:215], v48 offset:26112
  ds_read_b64_tr_b16 a[216:217], v46 offset:36864
  ds_read_b64_tr_b16 a[218:219], v46 offset:38400
  ds_read_b64_tr_b16 a[220:221], v47 offset:36864
  ds_read_b64_tr_b16 a[222:223], v47 offset:38400
  ds_read_b64_tr_b16 a[224:225], v48 offset:36864
  ds_read_b64_tr_b16 a[226:227], v48 offset:38400
  ds_read_b64_tr_b16 a[228:229], v46 offset:49152
  ds_read_b64_tr_b16 a[230:231], v46 offset:50688
  ds_read_b64_tr_b16 a[232:233], v47 offset:49152
  ds_read_b64_tr_b16 a[234:235], v47 offset:50688
  ds_read_b64_tr_b16 a[236:237], v48 offset:49152
  ds_read_b64_tr_b16 a[238:239], v48 offset:50688
  s_waitcnt lgkmcnt(0)
  s_barrier
  v_readfirstlane_b32 s21, v32
  s_cmp_ge_u32 s21, 32
  s_cbranch_scc1 bt_218
  s_mov_b32 s21, 76
  v_mov_b32 v4, 0
  s_mov_b32 s101, 0
wf_219:
  buffer_load_dword v5, v4, s[64:67], s21 offen sc1
  s_add_u32 s101, s101, 1
  s_cmp_gt_u32 s101, 131072
  s_cbranch_scc1 main_end
  s_waitcnt vmcnt(0)
  v_readfirstlane_b32 s100, v5
  s_cmp_ge_u32 s100, 32
  s_cbranch_scc1 wf_220
  s_sleep 8
  s_branch wf_219
wf_220:
bt_218:
  s_mov_b32 s21, 91136
  s_cmp_lg_u32 s20, 0
  s_cbranch_scc1 af_221
  v_mov_b32 v4, 0
  v_mov_b32 v5, 1
  s_mov_b64 exec, 1
  buffer_atomic_add v5, v4, s[72:75], s21 offen sc1
  s_mov_b64 exec, -1
  s_nop 1
af_221:
  s_mul_i32 s21, s20, 12800
  s_add_u32 s21, s21, 98304
  v_mul_u32_u24 v4, 400, v2
  v_lshlrev_b32 v5, 4, v3
  v_add3_u32 v29, v4, v5, s21
  v_lshlrev_b32 v30, 4, v1
  v_and_b32 v4, 1, v2
  v_bfe_u32 v5, v2, 1, 1
  v_lshl_or_b32 v4, v5, 2, v4
  v_bfe_u32 v5, v2, 2, 1
  v_lshl_or_b32 v4, v5, 1, v4
  v_lshlrev_b32 v4, 4, v4
  v_lshl_add_u32 v31, v3, 7, v4
  v_lshlrev_b32 v32, 3, v1
  v_and_b32 v4, 3, v1
  v_lshlrev_b32 v33, 3, v4
  v_mov_b32 v34, 0xf149f2ca
  v_lshlrev_b32 v4, 2, v3
  v_sub_u32 v35, v2, v4
  v_cmp_gt_u32 s[60:61], 2, v3
  s_mov_b32 s62, 0x3d93cd3a
  s_mov_b32 s63, 0x3fb8aa3b
  s_mov_b32 s83, 0x3dd53b95
  v_cmp_le_i32 s[64:65], 0, v35
  v_cmp_le_i32 s[66:67], 1, v35
  v_cmp_le_i32 s[68:69], 2, v35
  v_cmp_le_i32 s[70:71], 3, v35
  s_mov_b32 s24, 0
  s_mov_b32 s25, 163840
  s_mov_b32 s26, 14
  s_lshl_b32 s49, s41, 2
  s_add_u32 s49, s49, s20
  s_mov_b32 s29, 4
  s_mov_b32 s78, 0
  s_mov_b32 s81, 0x80000000
  s_mov_b32 s82, 0
  s_mul_i32 s21, s49, 393216
  s_mul_i32 s22, s42, 12288
  s_add_u32 s50, s21, s22
  s_mul_i32 s21, s49, 98304
  s_mul_i32 s22, s42, 3072
  s_add_u32 s51, s21, s22
  s_lshr_b32 s22, s49, 1
  s_lshr_b32 s21, s49, 2
  s_add_u32 s21, s21, 3
  s_cmp_lt_u32 s49, 12
  s_cselect_b32 s21, s22, s21
  s_lshl_b32 s21, s21, 3
  s_lshr_b32 s22, s42, 2
  s_add_u32 s21, s21, s22
  s_lshl_b32 s21, s21, 7
  s_add_u32 s76, s21, 0
  s_lshl_b32 s77, s42, 7
  s_add_u32 s77, s77, 19456
  v_mov_b32 v21, 0
  buffer_load_dword v21, v33, s[72:75], s77 offen sc1
  v_and_b32 v6, 7, v2
  v_add_u32 v4, 0, v3
  v_xor_b32 v4, v4, v6
  v_lshlrev_b32 v4, 4, v4
  v_lshl_add_u32 v14, v2, 7, v4
  v_add_u32 v4, 4, v3
  v_xor_b32 v4, v4, v6
  v_lshlrev_b32 v4, 4, v4
  v_lshl_add_u32 v15, v2, 7, v4
  v_mul_u32_u24 v22, 400, v2
  v_mul_u32_u24 v4, 16, v3
  s_mul_i32 s21, s20, 96
  s_add_u32 s21, s21, 98304
  v_add3_u32 v22, v22, v4, s21
  v_lshlrev_b32 v4, 3, v3
  v_sub_u32 v16, v22, v4
  v_mov_b32 v9, 2731
  s_mov_b32 s33, 0
  s_mov_b32 s48, 0x80000000
  s_mov_b32 m0, s32
  s_nop 0
  buffer_load_dwordx4 v10, s[8:11], s30 offen offset:0 lds
  buffer_load_dwordx4 v11, s[8:11], s30 offen offset:1024 lds
  s_waitcnt vmcnt(14)
  s_barrier
  v_add_u32 v18, s33, v14
  v_add_u32 v19, s33, v15
  s_add_u32 s33, s33, 16384
  s_cmp_lt_u32 s33, 98304
  s_cselect_b32 s33, s33, 0
  ds_read_b128 v[160:163], v18 offset:0
  ds_read_b128 v[164:167], v18 offset:2048
  ds_read_b128 v[168:171], v18 offset:4096
  ds_read_b128 v[172:175], v18 offset:6144
  ds_read_b128 v[176:179], v18 offset:8192
  ds_read_b128 v[180:183], v18 offset:10240
  ds_read_b128 v[184:187], v18 offset:12288
  ds_read_b128 v[188:191], v18 offset:14336
  s_waitcnt lgkmcnt(0)
qa_blk_223:
  v_mfma_f32_16x16x32_bf16 v[64:67], a[0:3], v[160:163], 0
  ds_read_b128 v[192:195], v19 offset:0
  v_mfma_f32_16x16x32_bf16 v[68:71], a[4:7], v[160:163], 0
  v_add_u32 v18, s33, v14
  v_cndmask_b32 v36, v34, v36, s[64:65]
  v_mfma_f32_16x16x32_bf16 v[72:75], a[8:11], v[160:163], 0
  v_cndmask_b32 v48, v34, v48, s[64:65]
  v_cndmask_b32 v37, v34, v37, s[66:67]
  v_mfma_f32_16x16x32_bf16 v[76:79], a[0:3], v[164:167], 0
  ds_read_b128 v[196:199], v19 offset:2048
  v_cndmask_b32 v49, v34, v49, s[66:67]
  v_mfma_f32_16x16x32_bf16 v[80:83], a[4:7], v[164:167], 0
  buffer_load_dwordx4 v12, s[8:11], s30 offen offset:2048 lds
  v_mfma_f32_16x16x32_bf16 v[84:87], a[8:11], v[164:167], 0
  v_cndmask_b32 v38, v34, v38, s[68:69]
  v_cndmask_b32 v50, v34, v50, s[68:69]
  v_mfma_f32_16x16x32_bf16 v[88:91], a[0:3], v[168:171], 0
  ds_read_b128 v[200:203], v19 offset:4096
  v_cndmask_b32 v39, v34, v39, s[70:71]
  v_mfma_f32_16x16x32_bf16 v[92:95], a[4:7], v[168:171], 0
  v_cndmask_b32 v51, v34, v51, s[70:71]
  v_max3_f32 v56, v36, v37, v38
  v_mfma_f32_16x16x32_bf16 v[96:99], a[8:11], v[168:171], 0
  v_max3_f32 v56, v56, v39, v40
  v_max3_f32 v56, v56, v41, v42
  v_mfma_f32_16x16x32_bf16 v[100:103], a[0:3], v[172:175], 0
  ds_read_b128 v[204:207], v19 offset:6144
  v_max_f32 v56, v56, v43
  v_mfma_f32_16x16x32_bf16 v[104:107], a[4:7], v[172:175], 0
  v_mov_b32 v57, v56
  v_mfma_f32_16x16x32_bf16 v[108:111], a[8:11], v[172:175], 0
  s_waitcnt lgkmcnt(15)
  v_mfma_f32_16x16x32_bf16 v[112:115], a[0:3], v[176:179], 0
  ds_read_b128 v[208:211], v19 offset:8192
  v_mfma_f32_16x16x32_bf16 v[116:119], a[4:7], v[176:179], 0
  s_nop 1
  v_mfma_f32_16x16x32_bf16 v[120:123], a[8:11], v[176:179], 0
  v_permlane32_swap_b32 v56, v57
  v_mfma_f32_16x16x32_bf16 v[124:127], a[0:3], v[180:183], 0
  ds_read_b128 v[212:215], v19 offset:10240
  v_max_f32 v56, v56, v57
  v_mfma_f32_16x16x32_bf16 v[128:131], a[4:7], v[180:183], 0
  buffer_load_dwordx4 v13, s[8:11], s30 offen offset:3072 lds
  v_mfma_f32_16x16x32_bf16 v[132:135], a[8:11], v[180:183], 0
  s_add_u32 s30, s30, 128
  s_add_u32 m0, m0, 16384
  v_mfma_f32_16x16x32_bf16 v[136:139], a[0:3], v[184:187], 0
  ds_read_b128 v[216:219], v19 offset:12288
  v_mov_b32 v57, v56
  v_mfma_f32_16x16x32_bf16 v[140:143], a[4:7], v[184:187], 0
  s_cmp_lt_u32 m0, s46
  s_cselect_b32 m0, m0, s47
  v_mfma_f32_16x16x32_bf16 v[144:147], a[8:11], v[184:187], 0
  s_nop 1
  v_mfma_f32_16x16x32_bf16 v[148:151], a[0:3], v[188:191], 0
  ds_read_b128 v[220:223], v19 offset:14336
  v_mfma_f32_16x16x32_bf16 v[152:155], a[4:7], v[188:191], 0
  v_permlane16_swap_b32 v56, v57
  v_mfma_f32_16x16x32_bf16 v[156:159], a[8:11], v[188:191], 0
  s_waitcnt vmcnt(12) lgkmcnt(4)
  s_barrier
  v_mfma_f32_16x16x32_bf16 v[64:67], a[12:15], v[192:195], v[64:67]
  ds_read_b128 v[160:163], v18 offset:0
  v_max_f32 v56, v56, v57
  v_mfma_f32_16x16x32_bf16 v[68:71], a[16:19], v[192:195], v[68:71]
  v_mul_f32 v56, s83, v56
  v_fma_f32 v36, v36, s83, -v56
  v_mfma_f32_16x16x32_bf16 v[72:75], a[20:23], v[192:195], v[72:75]
  v_add_u32 v19, s33, v15
  s_add_u32 s33, s33, 16384
  v_mfma_f32_16x16x32_bf16 v[76:79], a[12:15], v[196:199], v[76:79]
  ds_read_b128 v[164:167], v18 offset:2048
  s_mul_i32 s21, s49, 393216
  v_mfma_f32_16x16x32_bf16 v[80:83], a[16:19], v[196:199], v[80:83]
  buffer_load_dwordx4 v10, s[8:11], s30 offen offset:0 lds
  v_mfma_f32_16x16x32_bf16 v[84:87], a[20:23], v[196:199], v[84:87]
  s_cmp_lt_u32 s33, 98304
  s_cselect_b32 s33, s33, 0
  v_mfma_f32_16x16x32_bf16 v[88:91], a[12:15], v[200:203], v[88:91]
  ds_read_b128 v[168:171], v18 offset:4096
  s_mul_i32 s22, s42, 12288
  v_mfma_f32_16x16x32_bf16 v[92:95], a[16:19], v[200:203], v[92:95]
  s_add_u32 s50, s21, s22
  s_lshr_b32 s51, s50, 2
  v_mfma_f32_16x16x32_bf16 v[96:99], a[20:23], v[200:203], v[96:99]
  s_add_u32 s23, s49, 1
  v_cmp_gt_u32 vcc, s23, v21
  v_mfma_f32_16x16x32_bf16 v[100:103], a[12:15], v[204:207], v[100:103]
  ds_read_b128 v[172:175], v18 offset:6144
  v_fma_f32 v37, v37, s83, -v56
  v_mfma_f32_16x16x32_bf16 v[104:107], a[16:19], v[204:207], v[104:107]
  s_cmp_eq_u64 vcc, 0
  s_cselect_b32 s80, 1, 0
  v_mfma_f32_16x16x32_bf16 v[108:111], a[20:23], v[204:207], v[108:111]
  s_waitcnt lgkmcnt(4)
  s_lshl_b32 s79, s80, 3
  v_mfma_f32_16x16x32_bf16 v[112:115], a[12:15], v[208:211], v[112:115]
  ds_read_b128 v[176:179], v18 offset:8192
  v_fma_f32 v38, v38, s83, -v56
  v_mfma_f32_16x16x32_bf16 v[116:119], a[16:19], v[208:211], v[116:119]
  buffer_load_dwordx4 a[240:243], v31, s[52:55], s51 offen offset:0 sc1
  v_mfma_f32_16x16x32_bf16 v[120:123], a[20:23], v[208:211], v[120:123]
  v_fma_f32 v39, v39, s83, -v56
  v_fma_f32 v40, v40, s83, -v56
  v_mfma_f32_16x16x32_bf16 v[124:127], a[12:15], v[212:215], v[124:127]
  ds_read_b128 v[180:183], v18 offset:10240
  v_fma_f32 v41, v41, s83, -v56
  v_mfma_f32_16x16x32_bf16 v[128:131], a[16:19], v[212:215], v[128:131]
  buffer_load_dwordx4 v11, s[8:11], s30 offen offset:1024 lds
  v_mfma_f32_16x16x32_bf16 v[132:135], a[20:23], v[212:215], v[132:135]
  v_fma_f32 v42, v42, s83, -v56
  v_fma_f32 v43, v43, s83, -v56
  v_mfma_f32_16x16x32_bf16 v[136:139], a[12:15], v[216:219], v[136:139]
  ds_read_b128 v[184:187], v18 offset:12288
  v_mfma_f32_16x16x32_bf16 v[140:143], a[16:19], v[216:219], v[140:143]
  v_exp_f32 v36, v36
  v_mfma_f32_16x16x32_bf16 v[144:147], a[20:23], v[216:219], v[144:147]
  v_exp_f32 v37, v37
  v_mfma_f32_16x16x32_bf16 v[148:151], a[12:15], v[220:223], v[148:151]
  ds_read_b128 v[188:191], v18 offset:14336
  v_mfma_f32_16x16x32_bf16 v[152:155], a[16:19], v[220:223], v[152:155]
  v_exp_f32 v38, v38
  v_mfma_f32_16x16x32_bf16 v[156:159], a[20:23], v[220:223], v[156:159]
  s_waitcnt lgkmcnt(4)
  v_mfma_f32_16x16x32_bf16 v[64:67], a[24:27], v[160:163], v[64:67]
  ds_read_b128 v[192:195], v19 offset:0
  v_mfma_f32_16x16x32_bf16 v[68:71], a[28:31], v[160:163], v[68:71]
  v_add_u32 v18, s33, v14
  v_mfma_f32_16x16x32_bf16 v[72:75], a[32:35], v[160:163], v[72:75]
  v_exp_f32 v39, v39
  v_mfma_f32_16x16x32_bf16 v[76:79], a[24:27], v[164:167], v[76:79]
  ds_read_b128 v[196:199], v19 offset:2048
  v_mfma_f32_16x16x32_bf16 v[80:83], a[28:31], v[164:167], v[80:83]
  buffer_load_dwordx4 v12, s[8:11], s30 offen offset:2048 lds
  v_mfma_f32_16x16x32_bf16 v[84:87], a[32:35], v[164:167], v[84:87]
  v_exp_f32 v40, v40
  v_mfma_f32_16x16x32_bf16 v[88:91], a[24:27], v[168:171], v[88:91]
  ds_read_b128 v[200:203], v19 offset:4096
  v_mfma_f32_16x16x32_bf16 v[92:95], a[28:31], v[168:171], v[92:95]
  v_exp_f32 v41, v41
  v_mfma_f32_16x16x32_bf16 v[96:99], a[32:35], v[168:171], v[96:99]
  v_exp_f32 v42, v42
  v_mfma_f32_16x16x32_bf16 v[100:103], a[24:27], v[172:175], v[100:103]
  ds_read_b128 v[204:207], v19 offset:6144
  v_mfma_f32_16x16x32_bf16 v[104:107], a[28:31], v[172:175], v[104:107]
  buffer_load_dwordx4 a[244:247], v31, s[52:55], s51 offen offset:512 sc1
  v_mfma_f32_16x16x32_bf16 v[108:111], a[32:35], v[172:175], v[108:111]
  s_waitcnt lgkmcnt(4)
  v_mfma_f32_16x16x32_bf16 v[112:115], a[24:27], v[176:179], v[112:115]
  ds_read_b128 v[208:211], v19 offset:8192
  v_mfma_f32_16x16x32_bf16 v[116:119], a[28:31], v[176:179], v[116:119]
  v_exp_f32 v43, v43
  v_mfma_f32_16x16x32_bf16 v[120:123], a[32:35], v[176:179], v[120:123]
  s_nop 0
  v_add_f32 v56, v40, v41
  v_mfma_f32_16x16x32_bf16 v[124:127], a[24:27], v[180:183], v[124:127]
  ds_read_b128 v[212:215], v19 offset:10240
  v_add_f32 v56, v56, v42
  v_mfma_f32_16x16x32_bf16 v[128:131], a[28:31], v[180:183], v[128:131]
  buffer_load_dwordx4 v13, s[8:11], s30 offen offset:3072 lds
  v_mfma_f32_16x16x32_bf16 v[132:135], a[32:35], v[180:183], v[132:135]
  s_add_u32 s30, s30, 128
  s_add_u32 m0, m0, 16384
  v_mfma_f32_16x16x32_bf16 v[136:139], a[24:27], v[184:187], v[136:139]
  ds_read_b128 v[216:219], v19 offset:12288
  v_add_f32 v56, v56, v43
  v_mfma_f32_16x16x32_bf16 v[140:143], a[28:31], v[184:187], v[140:143]
  s_cmp_lt_u32 m0, s46
  s_cselect_b32 m0, m0, s47
  v_mfma_f32_16x16x32_bf16 v[144:147], a[32:35], v[184:187], v[144:147]
  v_cndmask_b32 v56, 0, v56, s[60:61]
  v_add_f32 v56, v56, v36
  v_mfma_f32_16x16x32_bf16 v[148:151], a[24:27], v[188:191], v[148:151]
  ds_read_b128 v[220:223], v19 offset:14336
  v_add_f32 v56, v56, v37
  v_mfma_f32_16x16x32_bf16 v[152:155], a[28:31], v[188:191], v[152:155]
  v_add_f32 v56, v56, v38
  v_add_f32 v56, v56, v39
  v_mfma_f32_16x16x32_bf16 v[156:159], a[32:35], v[188:191], v[156:159]
  s_waitcnt vmcnt(14) lgkmcnt(4)
  s_barrier
  v_mfma_f32_16x16x32_bf16 v[64:67], a[36:39], v[192:195], v[64:67]
  ds_read_b128 v[160:163], v18 offset:0
  v_mov_b32 v57, v56
  v_mfma_f32_16x16x32_bf16 v[68:71], a[40:43], v[192:195], v[68:71]
  s_nop 1
  v_mfma_f32_16x16x32_bf16 v[72:75], a[44:47], v[192:195], v[72:75]
  v_add_u32 v19, s33, v15
  s_add_u32 s33, s33, 16384
  v_mfma_f32_16x16x32_bf16 v[76:79], a[36:39], v[196:199], v[76:79]
  ds_read_b128 v[164:167], v18 offset:2048
  v_mfma_f32_16x16x32_bf16 v[80:83], a[40:43], v[196:199], v[80:83]
  buffer_load_dwordx4 v10, s[8:11], s30 offen offset:0 lds
  v_mfma_f32_16x16x32_bf16 v[84:87], a[44:47], v[196:199], v[84:87]
  s_cmp_lt_u32 s33, 98304
  s_cselect_b32 s33, s33, 0
  v_mfma_f32_16x16x32_bf16 v[88:91], a[36:39], v[200:203], v[88:91]
  ds_read_b128 v[168:171], v18 offset:4096
  v_mfma_f32_16x16x32_bf16 v[92:95], a[40:43], v[200:203], v[92:95]
  buffer_load_dwordx4 a[248:251], v31, s[52:55], s51 offen offset:1024 sc1
  v_mfma_f32_16x16x32_bf16 v[96:99], a[44:47], v[200:203], v[96:99]
  v_permlane32_swap_b32 v56, v57
  v_mfma_f32_16x16x32_bf16 v[100:103], a[36:39], v[204:207], v[100:103]
  ds_read_b128 v[172:175], v18 offset:6144
  v_add_f32 v56, v56, v57
  v_mfma_f32_16x16x32_bf16 v[104:107], a[40:43], v[204:207], v[104:107]
  v_mov_b32 v57, v56
  v_mfma_f32_16x16x32_bf16 v[108:111], a[44:47], v[204:207], v[108:111]
  s_waitcnt lgkmcnt(4)
  v_mfma_f32_16x16x32_bf16 v[112:115], a[36:39], v[208:211], v[112:115]
  ds_read_b128 v[176:179], v18 offset:8192
  v_mfma_f32_16x16x32_bf16 v[116:119], a[40:43], v[208:211], v[116:119]
  s_nop 1
  v_mfma_f32_16x16x32_bf16 v[120:123], a[44:47], v[208:211], v[120:123]
  v_permlane16_swap_b32 v56, v57
  v_mfma_f32_16x16x32_bf16 v[124:127], a[36:39], v[212:215], v[124:127]
  ds_read_b128 v[180:183], v18 offset:10240
  v_add_f32 v56, v56, v57
  v_mfma_f32_16x16x32_bf16 v[128:131], a[40:43], v[212:215], v[128:131]
  buffer_load_dwordx4 v11, s[8:11], s30 offen offset:1024 lds
  v_mfma_f32_16x16x32_bf16 v[132:135], a[44:47], v[212:215], v[132:135]
  v_rcp_f32 v56, v56
  v_mfma_f32_16x16x32_bf16 v[136:139], a[36:39], v[216:219], v[136:139]
  ds_read_b128 v[184:187], v18 offset:12288
  s_nop 0
  v_mfma_f32_16x16x32_bf16 v[140:143], a[40:43], v[216:219], v[140:143]
  v_mul_f32 v36, v36, v56
  v_mul_f32 v37, v37, v56
  v_mfma_f32_16x16x32_bf16 v[144:147], a[44:47], v[216:219], v[144:147]
  v_mul_f32 v38, v38, v56
  v_mul_f32 v39, v39, v56
  v_mfma_f32_16x16x32_bf16 v[148:151], a[36:39], v[220:223], v[148:151]
  ds_read_b128 v[188:191], v18 offset:14336
  v_mul_f32 v40, v40, v56
  v_mfma_f32_16x16x32_bf16 v[152:155], a[40:43], v[220:223], v[152:155]
  v_mul_f32 v41, v41, v56
  v_mul_f32 v42, v42, v56
  v_mfma_f32_16x16x32_bf16 v[156:159], a[44:47], v[220:223], v[156:159]
  s_waitcnt lgkmcnt(4)
  v_mul_f32 v43, v43, v56
  v_mfma_f32_16x16x32_bf16 v[64:67], a[48:51], v[160:163], v[64:67]
  ds_read_b128 v[192:195], v19 offset:0
  v_max3_f32 v56, v44, v45, v46
  v_mfma_f32_16x16x32_bf16 v[68:71], a[52:55], v[160:163], v[68:71]
  v_add_u32 v18, s33, v14
  v_max3_f32 v56, v56, v47, v48
  v_mfma_f32_16x16x32_bf16 v[72:75], a[56:59], v[160:163], v[72:75]
  v_max3_f32 v56, v56, v49, v50
  v_max3_f32 v56, v56, v51, v52
  v_mfma_f32_16x16x32_bf16 v[76:79], a[48:51], v[164:167], v[76:79]
  ds_read_b128 v[196:199], v19 offset:2048
  v_max3_f32 v56, v56, v53, v54
  v_mfma_f32_16x16x32_bf16 v[80:83], a[52:55], v[164:167], v[80:83]
  buffer_load_dwordx4 v12, s[8:11], s30 offen offset:2048 lds
  v_mfma_f32_16x16x32_bf16 v[84:87], a[56:59], v[164:167], v[84:87]
  buffer_load_dwordx4 a[252:255], v31, s[52:55], s51 offen offset:1536 sc1
  v_mfma_f32_16x16x32_bf16 v[88:91], a[48:51], v[168:171], v[88:91]
  ds_read_b128 v[200:203], v19 offset:4096
  v_max_f32 v56, v56, v55
  v_mfma_f32_16x16x32_bf16 v[92:95], a[52:55], v[168:171], v[92:95]
  v_mov_b32 v57, v56
  v_mfma_f32_16x16x32_bf16 v[96:99], a[56:59], v[168:171], v[96:99]
  s_nop 1
  v_mfma_f32_16x16x32_bf16 v[100:103], a[48:51], v[172:175], v[100:103]
  ds_read_b128 v[204:207], v19 offset:6144
  v_mfma_f32_16x16x32_bf16 v[104:107], a[52:55], v[172:175], v[104:107]
  v_permlane32_swap_b32 v56, v57
  v_mfma_f32_16x16x32_bf16 v[108:111], a[56:59], v[172:175], v[108:111]
  s_waitcnt lgkmcnt(4)
  v_max_f32 v56, v56, v57
  v_mfma_f32_16x16x32_bf16 v[112:115], a[48:51], v[176:179], v[112:115]
  ds_read_b128 v[208:211], v19 offset:8192
  v_mov_b32 v57, v56
  v_mfma_f32_16x16x32_bf16 v[116:119], a[52:55], v[176:179], v[116:119]
  s_nop 1
  v_mfma_f32_16x16x32_bf16 v[120:123], a[56:59], v[176:179], v[120:123]
  v_permlane16_swap_b32 v56, v57
  v_mfma_f32_16x16x32_bf16 v[124:127], a[48:51], v[180:183], v[124:127]
  ds_read_b128 v[212:215], v19 offset:10240
  v_max_f32 v56, v56, v57
  v_mfma_f32_16x16x32_bf16 v[128:131], a[52:55], v[180:183], v[128:131]
  buffer_load_dwordx4 v13, s[8:11], s30 offen offset:3072 lds
  v_mfma_f32_16x16x32_bf16 v[132:135], a[56:59], v[180:183], v[132:135]
  s_add_u32 s30, s30, 128
  s_add_u32 m0, m0, 16384
  v_mfma_f32_16x16x32_bf16 v[136:139], a[48:51], v[184:187], v[136:139]
  ds_read_b128 v[216:219], v19 offset:12288
  v_mul_f32 v56, s83, v56
  v_mfma_f32_16x16x32_bf16 v[140:143], a[52:55], v[184:187], v[140:143]
  s_cmp_lt_u32 m0, s46
  s_cselect_b32 m0, m0, s47
  v_mfma_f32_16x16x32_bf16 v[144:147], a[56:59], v[184:187], v[144:147]
  v_fma_f32 v44, v44, s83, -v56
  v_fma_f32 v45, v45, s83, -v56
  v_mfma_f32_16x16x32_bf16 v[148:151], a[48:51], v[188:191], v[148:151]
  ds_read_b128 v[220:223], v19 offset:14336
  v_fma_f32 v46, v46, s83, -v56
  v_mfma_f32_16x16x32_bf16 v[152:155], a[52:55], v[188:191], v[152:155]
  v_fma_f32 v47, v47, s83, -v56
  v_fma_f32 v48, v48, s83, -v56
  v_mfma_f32_16x16x32_bf16 v[156:159], a[56:59], v[188:191], v[156:159]
  s_waitcnt vmcnt(16) lgkmcnt(4)
  s_barrier
  v_mfma_f32_16x16x32_bf16 v[64:67], a[60:63], v[192:195], v[64:67]
  ds_read_b128 v[160:163], v18 offset:0
  v_fma_f32 v49, v49, s83, -v56
  v_mfma_f32_16x16x32_bf16 v[68:71], a[64:67], v[192:195], v[68:71]
  buffer_load_dwordx4 v[24:27], v31, s[52:55], s51 offen offset:2048 sc1
  v_mfma_f32_16x16x32_bf16 v[72:75], a[68:71], v[192:195], v[72:75]
  v_add_u32 v19, s33, v15
  s_add_u32 s33, s33, 16384
  v_mfma_f32_16x16x32_bf16 v[76:79], a[60:63], v[196:199], v[76:79]
  ds_read_b128 v[164:167], v18 offset:2048
  v_fma_f32 v50, v50, s83, -v56
  v_mfma_f32_16x16x32_bf16 v[80:83], a[64:67], v[196:199], v[80:83]
  buffer_load_dwordx4 v10, s[8:11], s30 offen offset:0 lds
  v_mfma_f32_16x16x32_bf16 v[84:87], a[68:71], v[196:199], v[84:87]
  s_cmp_lt_u32 s33, 98304
  s_cselect_b32 s33, s33, 0
  v_mfma_f32_16x16x32_bf16 v[88:91], a[60:63], v[200:203], v[88:91]
  ds_read_b128 v[168:171], v18 offset:4096
  v_fma_f32 v51, v51, s83, -v56
  v_mfma_f32_16x16x32_bf16 v[92:95], a[64:67], v[200:203], v[92:95]
  v_fma_f32 v52, v52, s83, -v56
  v_fma_f32 v53, v53, s83, -v56
  v_mfma_f32_16x16x32_bf16 v[96:99], a[68:71], v[200:203], v[96:99]
  v_fma_f32 v54, v54, s83, -v56
  v_fma_f32 v55, v55, s83, -v56
  v_mfma_f32_16x16x32_bf16 v[100:103], a[60:63], v[204:207], v[100:103]
  ds_read_b128 v[172:175], v18 offset:6144
  v_mfma_f32_16x16x32_bf16 v[104:107], a[64:67], v[204:207], v[104:107]
  v_exp_f32 v44, v44
  v_mfma_f32_16x16x32_bf16 v[108:111], a[68:71], v[204:207], v[108:111]
  s_waitcnt lgkmcnt(4)
  v_mfma_f32_16x16x32_bf16 v[112:115], a[60:63], v[208:211], v[112:115]
  ds_read_b128 v[176:179], v18 offset:8192
  v_mfma_f32_16x16x32_bf16 v[116:119], a[64:67], v[208:211], v[116:119]
  v_exp_f32 v45, v45
  v_mfma_f32_16x16x32_bf16 v[120:123], a[68:71], v[208:211], v[120:123]
  v_exp_f32 v46, v46
  v_mfma_f32_16x16x32_bf16 v[124:127], a[60:63], v[212:215], v[124:127]
  ds_read_b128 v[180:183], v18 offset:10240
  v_mfma_f32_16x16x32_bf16 v[128:131], a[64:67], v[212:215], v[128:131]
  buffer_load_dwordx4 v11, s[8:11], s30 offen offset:1024 lds
  v_mfma_f32_16x16x32_bf16 v[132:135], a[68:71], v[212:215], v[132:135]
  v_exp_f32 v47, v47
  v_mfma_f32_16x16x32_bf16 v[136:139], a[60:63], v[216:219], v[136:139]
  ds_read_b128 v[184:187], v18 offset:12288
  v_mfma_f32_16x16x32_bf16 v[140:143], a[64:67], v[216:219], v[140:143]
  v_exp_f32 v48, v48
  v_mfma_f32_16x16x32_bf16 v[144:147], a[68:71], v[216:219], v[144:147]
  v_exp_f32 v49, v49
  v_mfma_f32_16x16x32_bf16 v[148:151], a[60:63], v[220:223], v[148:151]
  ds_read_b128 v[188:191], v18 offset:14336
  v_mfma_f32_16x16x32_bf16 v[152:155], a[64:67], v[220:223], v[152:155]
  buffer_load_dwordx4 v[6:9], v31, s[52:55], s51 offen offset:2560 sc1
  v_mfma_f32_16x16x32_bf16 v[156:159], a[68:71], v[220:223], v[156:159]
  s_waitcnt lgkmcnt(4)
  v_mfma_f32_16x16x32_bf16 v[64:67], a[72:75], v[160:163], v[64:67]
  ds_read_b128 v[192:195], v19 offset:0
  v_mfma_f32_16x16x32_bf16 v[68:71], a[76:79], v[160:163], v[68:71]
  v_add_u32 v18, s33, v14
  v_mfma_f32_16x16x32_bf16 v[72:75], a[80:83], v[160:163], v[72:75]
  v_exp_f32 v50, v50
  v_mfma_f32_16x16x32_bf16 v[76:79], a[72:75], v[164:167], v[76:79]
  ds_read_b128 v[196:199], v19 offset:2048
  v_mfma_f32_16x16x32_bf16 v[80:83], a[76:79], v[164:167], v[80:83]
  buffer_load_dwordx4 v12, s[8:11], s30 offen offset:2048 lds
  v_mfma_f32_16x16x32_bf16 v[84:87], a[80:83], v[164:167], v[84:87]
  v_exp_f32 v51, v51
  v_mfma_f32_16x16x32_bf16 v[88:91], a[72:75], v[168:171], v[88:91]
  ds_read_b128 v[200:203], v19 offset:4096
  v_mfma_f32_16x16x32_bf16 v[92:95], a[76:79], v[168:171], v[92:95]
  v_exp_f32 v52, v52
  v_mfma_f32_16x16x32_bf16 v[96:99], a[80:83], v[168:171], v[96:99]
  v_exp_f32 v53, v53
  v_mfma_f32_16x16x32_bf16 v[100:103], a[72:75], v[172:175], v[100:103]
  ds_read_b128 v[204:207], v19 offset:6144
  v_mfma_f32_16x16x32_bf16 v[104:107], a[76:79], v[172:175], v[104:107]
  v_exp_f32 v54, v54
  v_mfma_f32_16x16x32_bf16 v[108:111], a[80:83], v[172:175], v[108:111]
  s_waitcnt lgkmcnt(4)
  v_mfma_f32_16x16x32_bf16 v[112:115], a[72:75], v[176:179], v[112:115]
  ds_read_b128 v[208:211], v19 offset:8192
  v_mfma_f32_16x16x32_bf16 v[116:119], a[76:79], v[176:179], v[116:119]
  v_exp_f32 v55, v55
  v_mfma_f32_16x16x32_bf16 v[120:123], a[80:83], v[176:179], v[120:123]
  s_nop 0
  v_add_f32 v56, v52, v53
  v_mfma_f32_16x16x32_bf16 v[124:127], a[72:75], v[180:183], v[124:127]
  ds_read_b128 v[212:215], v19 offset:10240
  v_add_f32 v56, v56, v54
  v_mfma_f32_16x16x32_bf16 v[128:131], a[76:79], v[180:183], v[128:131]
  buffer_load_dwordx4 v13, s[8:11], s30 offen offset:3072 lds
  v_mfma_f32_16x16x32_bf16 v[132:135], a[80:83], v[180:183], v[132:135]
  s_add_u32 s30, s30, 128
  s_add_u32 m0, m0, 16384
  v_mfma_f32_16x16x32_bf16 v[136:139], a[72:75], v[184:187], v[136:139]
  ds_read_b128 v[216:219], v19 offset:12288
  s_add_u32 s21, s50, 4096
  v_mfma_f32_16x16x32_bf16 v[140:143], a[76:79], v[184:187], v[140:143]
  s_cmp_lt_u32 m0, s46
  s_cselect_b32 m0, m0, s47
  v_mfma_f32_16x16x32_bf16 v[144:147], a[80:83], v[184:187], v[144:147]
  buffer_load_dwordx4 v[60:63], v30, s[16:19], s21 offen offset:2048 sc1
  v_mfma_f32_16x16x32_bf16 v[148:151], a[72:75], v[188:191], v[148:151]
  ds_read_b128 v[220:223], v19 offset:14336
  v_add_f32 v56, v56, v55
  v_mfma_f32_16x16x32_bf16 v[152:155], a[76:79], v[188:191], v[152:155]
  v_cndmask_b32 v56, 0, v56, s[60:61]
  v_add_f32 v56, v56, v44
  v_mfma_f32_16x16x32_bf16 v[156:159], a[80:83], v[188:191], v[156:159]
  s_waitcnt vmcnt(19) lgkmcnt(4)
  s_barrier
  v_mfma_f32_16x16x32_bf16 v[64:67], a[84:87], v[192:195], v[64:67]
  ds_read_b128 v[160:163], v18 offset:0
  v_add_f32 v56, v56, v45
  v_mfma_f32_16x16x32_bf16 v[68:71], a[88:91], v[192:195], v[68:71]
  v_add_f32 v56, v56, v46
  v_add_f32 v56, v56, v47
  v_mfma_f32_16x16x32_bf16 v[72:75], a[92:95], v[192:195], v[72:75]
  v_add_u32 v19, s33, v15
  s_add_u32 s33, s33, 16384
  v_mfma_f32_16x16x32_bf16 v[76:79], a[84:87], v[196:199], v[76:79]
  ds_read_b128 v[164:167], v18 offset:2048
  v_add_f32 v56, v56, v48
  v_mfma_f32_16x16x32_bf16 v[80:83], a[88:91], v[196:199], v[80:83]
  buffer_load_dwordx4 v10, s[8:11], s30 offen offset:0 lds
  v_mfma_f32_16x16x32_bf16 v[84:87], a[92:95], v[196:199], v[84:87]
  s_cmp_lt_u32 s33, 98304
  s_cselect_b32 s33, s33, 0
  v_mfma_f32_16x16x32_bf16 v[88:91], a[84:87], v[200:203], v[88:91]
  ds_read_b128 v[168:171], v18 offset:4096
  v_add_f32 v56, v56, v49
  v_mfma_f32_16x16x32_bf16 v[92:95], a[88:91], v[200:203], v[92:95]
  v_add_f32 v56, v56, v50
  v_add_f32 v56, v56, v51
  v_mfma_f32_16x16x32_bf16 v[96:99], a[92:95], v[200:203], v[96:99]
  v_mov_b32 v57, v56
  v_mfma_f32_16x16x32_bf16 v[100:103], a[84:87], v[204:207], v[100:103]
  ds_read_b128 v[172:175], v18 offset:6144
  v_mfma_f32_16x16x32_bf16 v[104:107], a[88:91], v[204:207], v[104:107]
  s_nop 1
  v_mfma_f32_16x16x32_bf16 v[108:111], a[92:95], v[204:207], v[108:111]
  s_waitcnt lgkmcnt(4)
  v_mfma_f32_16x16x32_bf16 v[112:115], a[84:87], v[208:211], v[112:115]
  ds_read_b128 v[176:179], v18 offset:8192
  v_mfma_f32_16x16x32_bf16 v[116:119], a[88:91], v[208:211], v[116:119]
  v_permlane32_swap_b32 v56, v57
  v_mfma_f32_16x16x32_bf16 v[120:123], a[92:95], v[208:211], v[120:123]
  v_add_f32 v56, v56, v57
  v_mov_b32 v57, v56
  v_mfma_f32_16x16x32_bf16 v[124:127], a[84:87], v[212:215], v[124:127]
  ds_read_b128 v[180:183], v18 offset:10240
  v_mfma_f32_16x16x32_bf16 v[128:131], a[88:91], v[212:215], v[128:131]
  buffer_load_dwordx4 v11, s[8:11], s30 offen offset:1024 lds
  v_mfma_f32_16x16x32_bf16 v[132:135], a[92:95], v[212:215], v[132:135]
  s_add_u32 s21, s50, 8192
  v_mfma_f32_16x16x32_bf16 v[136:139], a[84:87], v[216:219], v[136:139]
  ds_read_b128 v[184:187], v18 offset:12288
  v_mfma_f32_16x16x32_bf16 v[140:143], a[88:91], v[216:219], v[140:143]
  buffer_load_dwordx4 v[248:251], v30, s[16:19], s21 offen offset:2048 sc1
  v_mfma_f32_16x16x32_bf16 v[144:147], a[92:95], v[216:219], v[144:147]
  s_nop 1
  v_mfma_f32_16x16x32_bf16 v[148:151], a[84:87], v[220:223], v[148:151]
  ds_read_b128 v[188:191], v18 offset:14336
  v_mfma_f32_16x16x32_bf16 v[152:155], a[88:91], v[220:223], v[152:155]
  v_permlane16_swap_b32 v56, v57
  v_mfma_f32_16x16x32_bf16 v[156:159], a[92:95], v[220:223], v[156:159]
  s_waitcnt lgkmcnt(4)
  v_add_f32 v56, v56, v57
  v_mfma_f32_16x16x32_bf16 v[64:67], a[96:99], v[160:163], v[64:67]
  ds_read_b128 v[192:195], v19 offset:0
  v_mfma_f32_16x16x32_bf16 v[68:71], a[100:103], v[160:163], v[68:71]
  v_add_u32 v18, s33, v14
  v_mfma_f32_16x16x32_bf16 v[72:75], a[104:107], v[160:163], v[72:75]
  v_rcp_f32 v56, v56
  v_mfma_f32_16x16x32_bf16 v[76:79], a[96:99], v[164:167], v[76:79]
  ds_read_b128 v[196:199], v19 offset:2048
  s_nop 0
  v_mfma_f32_16x16x32_bf16 v[80:83], a[100:103], v[164:167], v[80:83]
  buffer_load_dwordx4 v12, s[8:11], s30 offen offset:2048 lds
  v_mfma_f32_16x16x32_bf16 v[84:87], a[104:107], v[164:167], v[84:87]
  v_mul_f32 v44, v44, v56
  v_mul_f32 v45, v45, v56
  v_mfma_f32_16x16x32_bf16 v[88:91], a[96:99], v[168:171], v[88:91]
  ds_read_b128 v[200:203], v19 offset:4096
  v_mul_f32 v46, v46, v56
  v_mfma_f32_16x16x32_bf16 v[92:95], a[100:103], v[168:171], v[92:95]
  v_mul_f32 v47, v47, v56
  v_mul_f32 v48, v48, v56
  v_mfma_f32_16x16x32_bf16 v[96:99], a[104:107], v[168:171], v[96:99]
  v_mul_f32 v49, v49, v56
  v_mul_f32 v50, v50, v56
  v_mfma_f32_16x16x32_bf16 v[100:103], a[96:99], v[172:175], v[100:103]
  ds_read_b128 v[204:207], v19 offset:6144
  v_mul_f32 v51, v51, v56
  v_mfma_f32_16x16x32_bf16 v[104:107], a[100:103], v[172:175], v[104:107]
  v_mul_f32 v52, v52, v56
  v_mul_f32 v53, v53, v56
  v_mfma_f32_16x16x32_bf16 v[108:111], a[104:107], v[172:175], v[108:111]
  s_waitcnt lgkmcnt(4)
  v_mul_f32 v54, v54, v56
  v_mfma_f32_16x16x32_bf16 v[112:115], a[96:99], v[176:179], v[112:115]
  ds_read_b128 v[208:211], v19 offset:8192
  v_mul_f32 v55, v55, v56
  v_mfma_f32_16x16x32_bf16 v[116:119], a[100:103], v[176:179], v[116:119]
  v_cvt_pk_bf16_f32 v240, v40, v41
  v_cvt_pk_bf16_f32 v241, v42, v43
  v_mfma_f32_16x16x32_bf16 v[120:123], a[104:107], v[176:179], v[120:123]
  v_cvt_pk_bf16_f32 v242, v52, v53
  v_cvt_pk_bf16_f32 v243, v54, v55
  v_mfma_f32_16x16x32_bf16 v[124:127], a[96:99], v[180:183], v[124:127]
  ds_read_b128 v[212:215], v19 offset:10240
  s_add_u32 s21, s50, 8192
  v_mfma_f32_16x16x32_bf16 v[128:131], a[100:103], v[180:183], v[128:131]
  buffer_load_dwordx4 v13, s[8:11], s30 offen offset:3072 lds
  v_mfma_f32_16x16x32_bf16 v[132:135], a[104:107], v[180:183], v[132:135]
  s_add_u32 s30, s30, 128
  s_add_u32 m0, m0, 16384
  v_mfma_f32_16x16x32_bf16 v[136:139], a[96:99], v[184:187], v[136:139]
  ds_read_b128 v[216:219], v19 offset:12288
  v_cvt_pk_bf16_f32 v236, v44, v45
  v_mfma_f32_16x16x32_bf16 v[140:143], a[100:103], v[184:187], v[140:143]
  s_cmp_lt_u32 m0, s46
  s_cselect_b32 m0, m0, s47
  v_mfma_f32_16x16x32_bf16 v[144:147], a[104:107], v[184:187], v[144:147]
  buffer_load_dwordx4 v[252:255], v30, s[16:19], s21 offen offset:3072 sc1
  v_mfma_f32_16x16x32_bf16 v[148:151], a[96:99], v[188:191], v[148:151]
  ds_read_b128 v[220:223], v19 offset:14336
  v_cvt_pk_bf16_f32 v237, v46, v47
  v_mfma_f32_16x16x32_bf16 v[152:155], a[100:103], v[188:191], v[152:155]
  v_cvt_pk_bf16_f32 v238, v48, v49
  v_cvt_pk_bf16_f32 v239, v50, v51
  v_mfma_f32_16x16x32_bf16 v[156:159], a[104:107], v[188:191], v[156:159]
  s_waitcnt vmcnt(19) lgkmcnt(4)
  s_barrier
  v_mfma_f32_16x16x32_bf16 v[64:67], a[108:111], v[192:195], v[64:67]
  ds_read_b128 v[160:163], v18 offset:0
  v_cvt_pk_bf16_f32 v244, v36, v37
  v_mfma_f32_16x16x32_bf16 v[68:71], a[112:115], v[192:195], v[68:71]
  v_cvt_pk_bf16_f32 v245, v38, v39
  v_mfma_f32_16x16x32_bf16 v[72:75], a[116:119], v[192:195], v[72:75]
  v_add_u32 v19, s33, v15
  s_add_u32 s33, s33, 16384
  v_mfma_f32_16x16x32_bf16 v[76:79], a[108:111], v[196:199], v[76:79]
  ds_read_b128 v[164:167], v18 offset:2048
  v_mfma_f32_16x16x32_bf16 v[80:83], a[112:115], v[196:199], v[80:83]
  buffer_load_dwordx4 v10, s[8:11], s30 offen offset:0 lds
  v_mfma_f32_16x16x32_bf16 v[84:87], a[116:119], v[196:199], v[84:87]
  s_cmp_lt_u32 s33, 98304
  s_cselect_b32 s33, s33, 0
  v_mfma_f32_16x16x32_bf16 v[88:91], a[108:111], v[200:203], v[88:91]
  ds_read_b128 v[168:171], v18 offset:4096
  v_mfma_f32_16x16x32_bf16 v[92:95], a[112:115], v[200:203], v[92:95]
  v_permlane16_swap_b32 v240, v242
  v_mfma_f32_16x16x32_bf16 v[96:99], a[116:119], v[200:203], v[96:99]
  v_permlane16_swap_b32 v241, v243
  v_mfma_f32_16x16x32_bf16 v[100:103], a[108:111], v[204:207], v[100:103]
  ds_read_b128 v[172:175], v18 offset:6144
  v_mfma_f32_16x16x32_bf16 v[104:107], a[112:115], v[204:207], v[104:107]
  v_mfma_f32_16x16x32_bf16 v[108:111], a[116:119], v[204:207], v[108:111]
  s_waitcnt lgkmcnt(4)
  v_mfma_f32_16x16x32_bf16 v[112:115], a[108:111], v[208:211], v[112:115]
  ds_read_b128 v[176:179], v18 offset:8192
  v_mfma_f32_16x16x32_bf16 v[116:119], a[112:115], v[208:211], v[116:119]
  v_mfma_f32_16x16x32_bf16 v[120:123], a[116:119], v[208:211], v[120:123]
  v_mfma_f32_16x16x32_bf16 v[124:127], a[108:111], v[212:215], v[124:127]
  ds_read_b128 v[180:183], v18 offset:10240
  v_mfma_f32_16x16x32_bf16 v[128:131], a[112:115], v[212:215], v[128:131]
  buffer_load_dwordx4 v11, s[8:11], s30 offen offset:1024 lds
  v_mfma_f32_16x16x32_bf16 v[132:135], a[116:119], v[212:215], v[132:135]
  v_mfma_f32_16x16x32_bf16 v[136:139], a[108:111], v[216:219], v[136:139]
  ds_read_b128 v[184:187], v18 offset:12288
  v_mfma_f32_16x16x32_bf16 v[140:143], a[112:115], v[216:219], v[140:143]
  v_mfma_f32_16x16x32_bf16 v[144:147], a[116:119], v[216:219], v[144:147]
  v_mfma_f32_16x16x32_bf16 v[148:151], a[108:111], v[220:223], v[148:151]
  ds_read_b128 v[188:191], v18 offset:14336
  v_mfma_f32_16x16x32_bf16 v[152:155], a[112:115], v[220:223], v[152:155]
  v_mfma_f32_16x16x32_bf16 v[156:159], a[116:119], v[220:223], v[156:159]
  s_waitcnt lgkmcnt(4)
  v_mfma_f32_16x16x32_bf16 v[64:67], a[120:123], v[160:163], v[64:67]
  ds_read_b128 v[192:195], v19 offset:0
  v_mfma_f32_16x16x32_bf16 v[68:71], a[124:127], v[160:163], v[68:71]
  v_add_u32 v18, s33, v14
  v_mfma_f32_16x16x32_bf16 v[72:75], a[128:131], v[160:163], v[72:75]
  v_mfma_f32_16x16x32_bf16 v[76:79], a[120:123], v[164:167], v[76:79]
  ds_read_b128 v[196:199], v19 offset:2048
  v_mfma_f32_16x16x32_bf16 v[80:83], a[124:127], v[164:167], v[80:83]
  buffer_load_dwordx4 v12, s[8:11], s30 offen offset:2048 lds
  v_mfma_f32_16x16x32_bf16 v[84:87], a[128:131], v[164:167], v[84:87]
  v_mfma_f32_16x16x32_bf16 v[88:91], a[120:123], v[168:171], v[88:91]
  ds_read_b128 v[200:203], v19 offset:4096
  v_mfma_f32_16x16x32_bf16 v[92:95], a[124:127], v[168:171], v[92:95]
  v_mfma_f32_16x16x32_bf16 v[96:99], a[128:131], v[168:171], v[96:99]
  v_mfma_f32_16x16x32_bf16 v[100:103], a[120:123], v[172:175], v[100:103]
  ds_read_b128 v[204:207], v19 offset:6144
  v_mfma_f32_16x16x32_bf16 v[104:107], a[124:127], v[172:175], v[104:107]
  v_mfma_f32_16x16x32_bf16 v[108:111], a[128:131], v[172:175], v[108:111]
  s_waitcnt lgkmcnt(4)
  v_mfma_f32_16x16x32_bf16 v[112:115], a[120:123], v[176:179], v[112:115]
  ds_read_b128 v[208:211], v19 offset:8192
  v_mfma_f32_16x16x32_bf16 v[116:119], a[124:127], v[176:179], v[116:119]
  v_mfma_f32_16x16x32_bf16 v[120:123], a[128:131], v[176:179], v[120:123]
  v_mfma_f32_16x16x32_bf16 v[124:127], a[120:123], v[180:183], v[124:127]
  ds_read_b128 v[212:215], v19 offset:10240
  v_mfma_f32_16x16x32_bf16 v[128:131], a[124:127], v[180:183], v[128:131]
  buffer_load_dwordx4 v13, s[8:11], s30 offen offset:3072 lds
  v_mfma_f32_16x16x32_bf16 v[132:135], a[128:131], v[180:183], v[132:135]
  s_add_u32 s30, s30, s25
  s_sub_u32 s30, s30, 1152
  v_mfma_f32_16x16x32_bf16 v[136:139], a[120:123], v[184:187], v[136:139]
  ds_read_b128 v[216:219], v19 offset:12288
  s_mov_b32 s25, 163840
  v_mfma_f32_16x16x32_bf16 v[140:143], a[124:127], v[184:187], v[140:143]
  s_add_u32 m0, m0, 16384
  v_mfma_f32_16x16x32_bf16 v[144:147], a[128:131], v[184:187], v[144:147]
  s_cmp_lt_u32 m0, s46
  s_cselect_b32 m0, m0, s47
  v_mfma_f32_16x16x32_bf16 v[148:151], a[120:123], v[188:191], v[148:151]
  ds_read_b128 v[220:223], v19 offset:14336
  v_mfma_f32_16x16x32_bf16 v[152:155], a[124:127], v[188:191], v[152:155]
  v_mfma_f32_16x16x32_bf16 v[156:159], a[128:131], v[188:191], v[156:159]
  s_waitcnt vmcnt(17) lgkmcnt(4)
  s_barrier
  v_mfma_f32_16x16x32_bf16 v[64:67], a[132:135], v[192:195], v[64:67]
  ds_read_b128 v[160:163], v18 offset:0
  v_mfma_f32_16x16x32_bf16 v[68:71], a[136:139], v[192:195], v[68:71]
  v_mfma_f32_16x16x32_bf16 v[72:75], a[140:143], v[192:195], v[72:75]
  v_add_u32 v19, s33, v15
  s_add_u32 s33, s33, 16384
  v_mfma_f32_16x16x32_bf16 v[76:79], a[132:135], v[196:199], v[76:79]
  ds_read_b128 v[164:167], v18 offset:2048
  v_mfma_f32_16x16x32_bf16 v[80:83], a[136:139], v[196:199], v[80:83]
  buffer_load_dwordx4 v10, s[8:11], s30 offen offset:0 lds
  v_mfma_f32_16x16x32_bf16 v[84:87], a[140:143], v[196:199], v[84:87]
  s_cmp_lt_u32 s33, 98304
  s_cselect_b32 s33, s33, 0
  v_mfma_f32_16x16x32_bf16 v[88:91], a[132:135], v[200:203], v[88:91]
  ds_read_b128 v[168:171], v18 offset:4096
  v_mfma_f32_16x16x32_bf16 v[92:95], a[136:139], v[200:203], v[92:95]
  buffer_store_dwordx4 v[236:239], v30, s[56:59], s81 offen sc1
  v_mfma_f32_16x16x32_bf16 v[96:99], a[140:143], v[200:203], v[96:99]
  v_mfma_f32_16x16x32_bf16 v[100:103], a[132:135], v[204:207], v[100:103]
  ds_read_b128 v[172:175], v18 offset:6144
  v_mfma_f32_16x16x32_bf16 v[104:107], a[136:139], v[204:207], v[104:107]
  v_mfma_f32_16x16x32_bf16 v[108:111], a[140:143], v[204:207], v[108:111]
  s_waitcnt lgkmcnt(4)
  v_mfma_f32_16x16x32_bf16 v[112:115], a[132:135], v[208:211], v[112:115]
  ds_read_b128 v[176:179], v18 offset:8192
  v_mfma_f32_16x16x32_bf16 v[116:119], a[136:139], v[208:211], v[116:119]
  s_mov_b64 exec, 0xffffffff
  buffer_store_dwordx4 v[240:243], v30, s[56:59], s81 offen offset:1024 sc1
  s_mov_b64 exec, -1
  v_mfma_f32_16x16x32_bf16 v[120:123], a[140:143], v[208:211], v[120:123]
  v_mfma_f32_16x16x32_bf16 v[124:127], a[132:135], v[212:215], v[124:127]
  ds_read_b128 v[180:183], v18 offset:10240
  v_mfma_f32_16x16x32_bf16 v[128:131], a[136:139], v[212:215], v[128:131]
  buffer_load_dwordx4 v11, s[8:11], s30 offen offset:1024 lds
  v_mfma_f32_16x16x32_bf16 v[132:135], a[140:143], v[212:215], v[132:135]
  v_mfma_f32_16x16x32_bf16 v[136:139], a[132:135], v[216:219], v[136:139]
  ds_read_b128 v[184:187], v18 offset:12288
  v_mfma_f32_16x16x32_bf16 v[140:143], a[136:139], v[216:219], v[140:143]
  buffer_store_dwordx2 v[244:245], v32, s[56:59], s81 offen offset:2048 sc1
  v_mfma_f32_16x16x32_bf16 v[144:147], a[140:143], v[216:219], v[144:147]
  s_mov_b32 s78, s82
  s_mov_b32 s82, 0
  v_mfma_f32_16x16x32_bf16 v[148:151], a[132:135], v[220:223], v[148:151]
  ds_read_b128 v[188:191], v18 offset:14336
  s_mov_b32 s81, 0x80000000
  v_mfma_f32_16x16x32_bf16 v[152:155], a[136:139], v[220:223], v[152:155]
  v_mfma_f32_16x16x32_bf16 v[156:159], a[140:143], v[220:223], v[156:159]
  s_waitcnt lgkmcnt(4)
  s_add_u32 s21, s50, 0
  v_mfma_f32_16x16x32_bf16 v[64:67], a[144:147], v[160:163], v[64:67]
  ds_read_b128 v[192:195], v19 offset:0
  v_mfma_f32_16x16x32_bf16 v[68:71], a[148:151], v[160:163], v[68:71]
  v_add_u32 v18, s33, v14
  v_mfma_f32_16x16x32_bf16 v[72:75], a[152:155], v[160:163], v[72:75]
  buffer_load_dwordx4 v[36:39], v30, s[16:19], s21 offen offset:0 sc1
  v_mfma_f32_16x16x32_bf16 v[76:79], a[144:147], v[164:167], v[76:79]
  ds_read_b128 v[196:199], v19 offset:2048
  v_mfma_f32_16x16x32_bf16 v[80:83], a[148:151], v[164:167], v[80:83]
  buffer_load_dwordx4 v12, s[8:11], s30 offen offset:2048 lds
  v_mfma_f32_16x16x32_bf16 v[84:87], a[152:155], v[164:167], v[84:87]
  v_mfma_f32_16x16x32_bf16 v[88:91], a[144:147], v[168:171], v[88:91]
  ds_read_b128 v[200:203], v19 offset:4096
  v_mfma_f32_16x16x32_bf16 v[92:95], a[148:151], v[168:171], v[92:95]
  v_mfma_f32_16x16x32_bf16 v[96:99], a[152:155], v[168:171], v[96:99]
  v_mfma_f32_16x16x32_bf16 v[100:103], a[144:147], v[172:175], v[100:103]
  ds_read_b128 v[204:207], v19 offset:6144
  v_mfma_f32_16x16x32_bf16 v[104:107], a[148:151], v[172:175], v[104:107]
  v_mfma_f32_16x16x32_bf16 v[108:111], a[152:155], v[172:175], v[108:111]
  s_waitcnt lgkmcnt(4)
  v_mfma_f32_16x16x32_bf16 v[112:115], a[144:147], v[176:179], v[112:115]
  ds_read_b128 v[208:211], v19 offset:8192
  s_add_u32 s21, s50, 0
  v_mfma_f32_16x16x32_bf16 v[116:119], a[148:151], v[176:179], v[116:119]
  buffer_load_dwordx4 v[40:43], v30, s[16:19], s21 offen offset:1024 sc1
  v_mfma_f32_16x16x32_bf16 v[120:123], a[152:155], v[176:179], v[120:123]
  v_mfma_f32_16x16x32_bf16 v[124:127], a[144:147], v[180:183], v[124:127]
  ds_read_b128 v[212:215], v19 offset:10240
  v_mfma_f32_16x16x32_bf16 v[128:131], a[148:151], v[180:183], v[128:131]
  buffer_load_dwordx4 v13, s[8:11], s30 offen offset:3072 lds
  v_mfma_f32_16x16x32_bf16 v[132:135], a[152:155], v[180:183], v[132:135]
  s_add_u32 s30, s30, 128
  s_add_u32 m0, m0, 16384
  v_mfma_f32_16x16x32_bf16 v[136:139], a[144:147], v[184:187], v[136:139]
  ds_read_b128 v[216:219], v19 offset:12288
  v_mfma_f32_16x16x32_bf16 v[140:143], a[148:151], v[184:187], v[140:143]
  s_cmp_lt_u32 m0, s46
  s_cselect_b32 m0, m0, s47
  v_mfma_f32_16x16x32_bf16 v[144:147], a[152:155], v[184:187], v[144:147]
  v_mfma_f32_16x16x32_bf16 v[148:151], a[144:147], v[188:191], v[148:151]
  ds_read_b128 v[220:223], v19 offset:14336
  v_mfma_f32_16x16x32_bf16 v[152:155], a[148:151], v[188:191], v[152:155]
  v_mfma_f32_16x16x32_bf16 v[156:159], a[152:155], v[188:191], v[156:159]
  s_waitcnt vmcnt(20) lgkmcnt(4)
  s_barrier
  v_mfma_f32_16x16x32_bf16 v[64:67], a[156:159], v[192:195], v[64:67]
  ds_read_b128 v[160:163], v18 offset:0
  s_add_u32 s21, s50, 0
  v_mfma_f32_16x16x32_bf16 v[68:71], a[160:163], v[192:195], v[68:71]
  buffer_load_dwordx4 v[44:47], v30, s[16:19], s21 offen offset:2048 sc1
  v_mfma_f32_16x16x32_bf16 v[72:75], a[164:167], v[192:195], v[72:75]
  v_add_u32 v19, s33, v15
  s_add_u32 s33, s33, 16384
  v_mfma_f32_16x16x32_bf16 v[76:79], a[156:159], v[196:199], v[76:79]
  ds_read_b128 v[164:167], v18 offset:2048
  v_mfma_f32_16x16x32_bf16 v[80:83], a[160:163], v[196:199], v[80:83]
  buffer_load_dwordx4 v10, s[8:11], s30 offen offset:0 lds
  v_mfma_f32_16x16x32_bf16 v[84:87], a[164:167], v[196:199], v[84:87]
  s_cmp_lt_u32 s33, 98304
  s_cselect_b32 s33, s33, 0
  v_mfma_f32_16x16x32_bf16 v[88:91], a[156:159], v[200:203], v[88:91]
  ds_read_b128 v[168:171], v18 offset:4096
  v_mfma_f32_16x16x32_bf16 v[92:95], a[160:163], v[200:203], v[92:95]
  v_mfma_f32_16x16x32_bf16 v[96:99], a[164:167], v[200:203], v[96:99]
  v_mfma_f32_16x16x32_bf16 v[100:103], a[156:159], v[204:207], v[100:103]
  ds_read_b128 v[172:175], v18 offset:6144
  v_mfma_f32_16x16x32_bf16 v[104:107], a[160:163], v[204:207], v[104:107]
  v_mfma_f32_16x16x32_bf16 v[108:111], a[164:167], v[204:207], v[108:111]
  s_waitcnt lgkmcnt(4)
  s_add_u32 s21, s50, 0
  v_mfma_f32_16x16x32_bf16 v[112:115], a[156:159], v[208:211], v[112:115]
  ds_read_b128 v[176:179], v18 offset:8192
  v_mfma_f32_16x16x32_bf16 v[116:119], a[160:163], v[208:211], v[116:119]
  buffer_load_dwordx4 v[48:51], v30, s[16:19], s21 offen offset:3072 sc1
  v_mfma_f32_16x16x32_bf16 v[120:123], a[164:167], v[208:211], v[120:123]
  v_mfma_f32_16x16x32_bf16 v[124:127], a[156:159], v[212:215], v[124:127]
  ds_read_b128 v[180:183], v18 offset:10240
  v_mfma_f32_16x16x32_bf16 v[128:131], a[160:163], v[212:215], v[128:131]
  buffer_load_dwordx4 v11, s[8:11], s30 offen offset:1024 lds
  v_mfma_f32_16x16x32_bf16 v[132:135], a[164:167], v[212:215], v[132:135]
  v_mfma_f32_16x16x32_bf16 v[136:139], a[156:159], v[216:219], v[136:139]
  ds_read_b128 v[184:187], v18 offset:12288
  v_mfma_f32_16x16x32_bf16 v[140:143], a[160:163], v[216:219], v[140:143]
  v_mfma_f32_16x16x32_bf16 v[144:147], a[164:167], v[216:219], v[144:147]
  v_mfma_f32_16x16x32_bf16 v[148:151], a[156:159], v[220:223], v[148:151]
  ds_read_b128 v[188:191], v18 offset:14336
  v_mfma_f32_16x16x32_bf16 v[152:155], a[160:163], v[220:223], v[152:155]
  v_mfma_f32_16x16x32_bf16 v[156:159], a[164:167], v[220:223], v[156:159]
  s_waitcnt lgkmcnt(4)
  s_add_u32 s21, s50, 4096
  v_mfma_f32_16x16x32_bf16 v[64:67], a[168:171], v[160:163], v[64:67]
  ds_read_b128 v[192:195], v19 offset:0
  v_mfma_f32_16x16x32_bf16 v[68:71], a[172:175], v[160:163], v[68:71]
  v_add_u32 v18, s33, v14
  v_mfma_f32_16x16x32_bf16 v[72:75], a[176:179], v[160:163], v[72:75]
  buffer_load_dwordx4 v[52:55], v30, s[16:19], s21 offen offset:0 sc1
  v_mfma_f32_16x16x32_bf16 v[76:79], a[168:171], v[164:167], v[76:79]
  ds_read_b128 v[196:199], v19 offset:2048
  v_mfma_f32_16x16x32_bf16 v[80:83], a[172:175], v[164:167], v[80:83]
  buffer_load_dwordx4 v12, s[8:11], s30 offen offset:2048 lds
  v_mfma_f32_16x16x32_bf16 v[84:87], a[176:179], v[164:167], v[84:87]
  v_mfma_f32_16x16x32_bf16 v[88:91], a[168:171], v[168:171], v[88:91]
  ds_read_b128 v[200:203], v19 offset:4096
  v_mfma_f32_16x16x32_bf16 v[92:95], a[172:175], v[168:171], v[92:95]
  v_mfma_f32_16x16x32_bf16 v[96:99], a[176:179], v[168:171], v[96:99]
  v_mfma_f32_16x16x32_bf16 v[100:103], a[168:171], v[172:175], v[100:103]
  ds_read_b128 v[204:207], v19 offset:6144
  v_mfma_f32_16x16x32_bf16 v[104:107], a[172:175], v[172:175], v[104:107]
  v_mfma_f32_16x16x32_bf16 v[108:111], a[176:179], v[172:175], v[108:111]
  s_waitcnt lgkmcnt(4)
  v_mfma_f32_16x16x32_bf16 v[112:115], a[168:171], v[176:179], v[112:115]
  ds_read_b128 v[208:211], v19 offset:8192
  s_add_u32 s21, s50, 4096
  v_mfma_f32_16x16x32_bf16 v[116:119], a[172:175], v[176:179], v[116:119]
  buffer_load_dwordx4 v[56:59], v30, s[16:19], s21 offen offset:1024 sc1
  v_mfma_f32_16x16x32_bf16 v[120:123], a[176:179], v[176:179], v[120:123]
  v_mfma_f32_16x16x32_bf16 v[124:127], a[168:171], v[180:183], v[124:127]
  ds_read_b128 v[212:215], v19 offset:10240
  v_mfma_f32_16x16x32_bf16 v[128:131], a[172:175], v[180:183], v[128:131]
  buffer_load_dwordx4 v13, s[8:11], s30 offen offset:3072 lds
  v_mfma_f32_16x16x32_bf16 v[132:135], a[176:179], v[180:183], v[132:135]
  s_add_u32 s30, s30, 128
  s_add_u32 m0, m0, 16384
  v_mfma_f32_16x16x32_bf16 v[136:139], a[168:171], v[184:187], v[136:139]
  ds_read_b128 v[216:219], v19 offset:12288
  v_mfma_f32_16x16x32_bf16 v[140:143], a[172:175], v[184:187], v[140:143]
  s_cmp_lt_u32 m0, s46
  s_cselect_b32 m0, m0, s47
  v_mfma_f32_16x16x32_bf16 v[144:147], a[176:179], v[184:187], v[144:147]
  v_mfma_f32_16x16x32_bf16 v[148:151], a[168:171], v[188:191], v[148:151]
  ds_read_b128 v[220:223], v19 offset:14336
  v_mfma_f32_16x16x32_bf16 v[152:155], a[172:175], v[188:191], v[152:155]
  v_mfma_f32_16x16x32_bf16 v[156:159], a[176:179], v[188:191], v[156:159]
  s_waitcnt vmcnt(22) lgkmcnt(4)
  s_barrier
  v_mfma_f32_16x16x32_bf16 v[64:67], a[180:183], v[192:195], v[64:67]
  ds_read_b128 v[160:163], v18 offset:0
  s_add_u32 s21, s50, 4096
  v_mfma_f32_16x16x32_bf16 v[68:71], a[184:187], v[192:195], v[68:71]
  buffer_load_dwordx4 v[236:239], v30, s[16:19], s21 offen offset:3072 sc1
  v_mfma_f32_16x16x32_bf16 v[72:75], a[188:191], v[192:195], v[72:75]
  v_add_u32 v19, s33, v15
  s_add_u32 s33, s33, 16384
  v_mfma_f32_16x16x32_bf16 v[76:79], a[180:183], v[196:199], v[76:79]
  ds_read_b128 v[164:167], v18 offset:2048
  v_mfma_f32_16x16x32_bf16 v[80:83], a[184:187], v[196:199], v[80:83]
  buffer_load_dwordx4 v10, s[8:11], s30 offen offset:0 lds
  v_mfma_f32_16x16x32_bf16 v[84:87], a[188:191], v[196:199], v[84:87]
  s_cmp_lt_u32 s33, 98304
  s_cselect_b32 s33, s33, 0
  v_mfma_f32_16x16x32_bf16 v[88:91], a[180:183], v[200:203], v[88:91]
  ds_read_b128 v[168:171], v18 offset:4096
  v_mfma_f32_16x16x32_bf16 v[92:95], a[184:187], v[200:203], v[92:95]
  v_mfma_f32_16x16x32_bf16 v[96:99], a[188:191], v[200:203], v[96:99]
  v_mfma_f32_16x16x32_bf16 v[100:103], a[180:183], v[204:207], v[100:103]
  ds_read_b128 v[172:175], v18 offset:6144
  v_mfma_f32_16x16x32_bf16 v[104:107], a[184:187], v[204:207], v[104:107]
  v_mfma_f32_16x16x32_bf16 v[108:111], a[188:191], v[204:207], v[108:111]
  s_waitcnt lgkmcnt(4)
  s_add_u32 s21, s50, 8192
  v_mfma_f32_16x16x32_bf16 v[112:115], a[180:183], v[208:211], v[112:115]
  ds_read_b128 v[176:179], v18 offset:8192
  v_mfma_f32_16x16x32_bf16 v[116:119], a[184:187], v[208:211], v[116:119]
  buffer_load_dwordx4 v[240:243], v30, s[16:19], s21 offen offset:0 sc1
  v_mfma_f32_16x16x32_bf16 v[120:123], a[188:191], v[208:211], v[120:123]
  v_mfma_f32_16x16x32_bf16 v[124:127], a[180:183], v[212:215], v[124:127]
  ds_read_b128 v[180:183], v18 offset:10240
  v_mfma_f32_16x16x32_bf16 v[128:131], a[184:187], v[212:215], v[128:131]
  buffer_load_dwordx4 v11, s[8:11], s30 offen offset:1024 lds
  v_mfma_f32_16x16x32_bf16 v[132:135], a[188:191], v[212:215], v[132:135]
  v_mfma_f32_16x16x32_bf16 v[136:139], a[180:183], v[216:219], v[136:139]
  ds_read_b128 v[184:187], v18 offset:12288
  v_mfma_f32_16x16x32_bf16 v[140:143], a[184:187], v[216:219], v[140:143]
  v_mfma_f32_16x16x32_bf16 v[144:147], a[188:191], v[216:219], v[144:147]
  v_mfma_f32_16x16x32_bf16 v[148:151], a[180:183], v[220:223], v[148:151]
  ds_read_b128 v[188:191], v18 offset:14336
  v_mfma_f32_16x16x32_bf16 v[152:155], a[184:187], v[220:223], v[152:155]
  v_mfma_f32_16x16x32_bf16 v[156:159], a[188:191], v[220:223], v[156:159]
  s_waitcnt lgkmcnt(4)
  s_add_u32 s21, s50, 8192
  v_mfma_f32_16x16x32_bf16 v[64:67], a[192:195], v[160:163], v[64:67]
  ds_read_b128 v[192:195], v19 offset:0
  v_mfma_f32_16x16x32_bf16 v[68:71], a[196:199], v[160:163], v[68:71]
  v_add_u32 v18, s33, v14
  v_mfma_f32_16x16x32_bf16 v[72:75], a[200:203], v[160:163], v[72:75]
  buffer_load_dwordx4 v[244:247], v30, s[16:19], s21 offen offset:1024 sc1
  v_mfma_f32_16x16x32_bf16 v[76:79], a[192:195], v[164:167], v[76:79]
  ds_read_b128 v[196:199], v19 offset:2048
  v_mfma_f32_16x16x32_bf16 v[80:83], a[196:199], v[164:167], v[80:83]
  buffer_load_dwordx4 v12, s[8:11], s30 offen offset:2048 lds
  v_mfma_f32_16x16x32_bf16 v[84:87], a[200:203], v[164:167], v[84:87]
  v_mfma_f32_16x16x32_bf16 v[88:91], a[192:195], v[168:171], v[88:91]
  ds_read_b128 v[200:203], v19 offset:4096
  v_mfma_f32_16x16x32_bf16 v[92:95], a[196:199], v[168:171], v[92:95]
  v_mfma_f32_16x16x32_bf16 v[96:99], a[200:203], v[168:171], v[96:99]
  v_mfma_f32_16x16x32_bf16 v[100:103], a[192:195], v[172:175], v[100:103]
  ds_read_b128 v[204:207], v19 offset:6144
  v_mfma_f32_16x16x32_bf16 v[104:107], a[196:199], v[172:175], v[104:107]
  v_mfma_f32_16x16x32_bf16 v[108:111], a[200:203], v[172:175], v[108:111]
  s_waitcnt lgkmcnt(4)
  v_mfma_f32_16x16x32_bf16 v[112:115], a[192:195], v[176:179], v[112:115]
  ds_read_b128 v[208:211], v19 offset:8192
  v_mfma_f32_16x16x32_bf16 v[116:119], a[196:199], v[176:179], v[116:119]
  v_mfma_f32_16x16x32_bf16 v[120:123], a[200:203], v[176:179], v[120:123]
  v_mfma_f32_16x16x32_bf16 v[124:127], a[192:195], v[180:183], v[124:127]
  ds_read_b128 v[212:215], v19 offset:10240
  v_mfma_f32_16x16x32_bf16 v[128:131], a[196:199], v[180:183], v[128:131]
  buffer_load_dwordx4 v13, s[8:11], s30 offen offset:3072 lds
  v_mfma_f32_16x16x32_bf16 v[132:135], a[200:203], v[180:183], v[132:135]
  s_add_u32 s30, s30, 128
  s_add_u32 m0, m0, 16384
  v_mfma_f32_16x16x32_bf16 v[136:139], a[192:195], v[184:187], v[136:139]
  ds_read_b128 v[216:219], v19 offset:12288
  v_mfma_f32_16x16x32_bf16 v[140:143], a[196:199], v[184:187], v[140:143]
  s_cmp_lt_u32 m0, s46
  s_cselect_b32 m0, m0, s47
  v_mfma_f32_16x16x32_bf16 v[144:147], a[200:203], v[184:187], v[144:147]
  v_mfma_f32_16x16x32_bf16 v[148:151], a[192:195], v[188:191], v[148:151]
  ds_read_b128 v[220:223], v19 offset:14336
  v_mfma_f32_16x16x32_bf16 v[152:155], a[196:199], v[188:191], v[152:155]
  v_mfma_f32_16x16x32_bf16 v[156:159], a[200:203], v[188:191], v[156:159]
  s_waitcnt vmcnt(24) lgkmcnt(4)
  s_barrier
  v_mfma_f32_16x16x32_bf16 v[64:67], a[204:207], v[192:195], v[64:67]
  ds_read_b128 v[160:163], v18 offset:0
  v_mfma_f32_16x16x32_bf16 v[68:71], a[208:211], v[192:195], v[68:71]
  v_mfma_f32_16x16x32_bf16 v[72:75], a[212:215], v[192:195], v[72:75]
  v_add_u32 v19, s33, v15
  s_add_u32 s33, s33, 16384
  v_mfma_f32_16x16x32_bf16 v[76:79], a[204:207], v[196:199], v[76:79]
  ds_read_b128 v[164:167], v18 offset:2048
  v_mfma_f32_16x16x32_bf16 v[80:83], a[208:211], v[196:199], v[80:83]
  buffer_load_dwordx4 v10, s[8:11], s30 offen offset:0 lds
  v_mfma_f32_16x16x32_bf16 v[84:87], a[212:215], v[196:199], v[84:87]
  s_cmp_lt_u32 s33, 98304
  s_cselect_b32 s33, s33, 0
  v_mfma_f32_16x16x32_bf16 v[88:91], a[204:207], v[200:203], v[88:91]
  ds_read_b128 v[168:171], v18 offset:4096
  v_mfma_f32_16x16x32_bf16 v[92:95], a[208:211], v[200:203], v[92:95]
  v_mfma_f32_16x16x32_bf16 v[96:99], a[212:215], v[200:203], v[96:99]
  v_mfma_f32_16x16x32_bf16 v[100:103], a[204:207], v[204:207], v[100:103]
  ds_read_b128 v[172:175], v18 offset:6144
  v_mfma_f32_16x16x32_bf16 v[104:107], a[208:211], v[204:207], v[104:107]
  v_mfma_f32_16x16x32_bf16 v[108:111], a[212:215], v[204:207], v[108:111]
  s_waitcnt lgkmcnt(4)
  v_mfma_f32_16x16x32_bf16 v[112:115], a[204:207], v[208:211], v[112:115]
  ds_read_b128 v[176:179], v18 offset:8192
  v_mfma_f32_16x16x32_bf16 v[116:119], a[208:211], v[208:211], v[116:119]
  v_mfma_f32_16x16x32_bf16 v[120:123], a[212:215], v[208:211], v[120:123]
  v_mfma_f32_16x16x32_bf16 v[124:127], a[204:207], v[212:215], v[124:127]
  ds_read_b128 v[180:183], v18 offset:10240
  v_mfma_f32_16x16x32_bf16 v[128:131], a[208:211], v[212:215], v[128:131]
  buffer_load_dwordx4 v11, s[8:11], s30 offen offset:1024 lds
  v_mfma_f32_16x16x32_bf16 v[132:135], a[212:215], v[212:215], v[132:135]
  v_mfma_f32_16x16x32_bf16 v[136:139], a[204:207], v[216:219], v[136:139]
  ds_read_b128 v[184:187], v18 offset:12288
  v_mfma_f32_16x16x32_bf16 v[140:143], a[208:211], v[216:219], v[140:143]
  v_mfma_f32_16x16x32_bf16 v[144:147], a[212:215], v[216:219], v[144:147]
  v_mfma_f32_16x16x32_bf16 v[148:151], a[204:207], v[220:223], v[148:151]
  ds_read_b128 v[188:191], v18 offset:14336
  v_mfma_f32_16x16x32_bf16 v[152:155], a[208:211], v[220:223], v[152:155]
  v_mfma_f32_16x16x32_bf16 v[156:159], a[212:215], v[220:223], v[156:159]
  s_waitcnt lgkmcnt(4)
  v_mfma_f32_16x16x32_bf16 v[64:67], a[216:219], v[160:163], v[64:67]
  ds_read_b128 v[192:195], v19 offset:0
  v_mfma_f32_16x16x32_bf16 v[68:71], a[220:223], v[160:163], v[68:71]
  v_add_u32 v18, s33, v14
  v_mfma_f32_16x16x32_bf16 v[72:75], a[224:227], v[160:163], v[72:75]
  v_mfma_f32_16x16x32_bf16 v[76:79], a[216:219], v[164:167], v[76:79]
  ds_read_b128 v[196:199], v19 offset:2048
  v_mfma_f32_16x16x32_bf16 v[80:83], a[220:223], v[164:167], v[80:83]
  buffer_load_dwordx4 v12, s[8:11], s30 offen offset:2048 lds
  v_mfma_f32_16x16x32_bf16 v[84:87], a[224:227], v[164:167], v[84:87]
  v_mfma_f32_16x16x32_bf16 v[88:91], a[216:219], v[168:171], v[88:91]
  ds_read_b128 v[200:203], v19 offset:4096
  v_mfma_f32_16x16x32_bf16 v[92:95], a[220:223], v[168:171], v[92:95]
  v_mfma_f32_16x16x32_bf16 v[96:99], a[224:227], v[168:171], v[96:99]
  v_mfma_f32_16x16x32_bf16 v[100:103], a[216:219], v[172:175], v[100:103]
  ds_read_b128 v[204:207], v19 offset:6144
  v_mfma_f32_16x16x32_bf16 v[104:107], a[220:223], v[172:175], v[104:107]
  v_mfma_f32_16x16x32_bf16 v[108:111], a[224:227], v[172:175], v[108:111]
  s_waitcnt lgkmcnt(4)
  v_mfma_f32_16x16x32_bf16 v[112:115], a[216:219], v[176:179], v[112:115]
  ds_read_b128 v[208:211], v19 offset:8192
  v_mfma_f32_16x16x32_bf16 v[116:119], a[220:223], v[176:179], v[116:119]
  v_mfma_f32_16x16x32_bf16 v[120:123], a[224:227], v[176:179], v[120:123]
  v_mfma_f32_16x16x32_bf16 v[124:127], a[216:219], v[180:183], v[124:127]
  ds_read_b128 v[212:215], v19 offset:10240
  v_mfma_f32_16x16x32_bf16 v[128:131], a[220:223], v[180:183], v[128:131]
  buffer_load_dwordx4 v13, s[8:11], s30 offen offset:3072 lds
  v_mfma_f32_16x16x32_bf16 v[132:135], a[224:227], v[180:183], v[132:135]
  s_add_u32 s30, s30, 128
  s_add_u32 m0, m0, 16384
  v_mfma_f32_16x16x32_bf16 v[136:139], a[216:219], v[184:187], v[136:139]
  ds_read_b128 v[216:219], v19 offset:12288
  v_mfma_f32_16x16x32_bf16 v[140:143], a[220:223], v[184:187], v[140:143]
  s_cmp_lt_u32 m0, s46
  s_cselect_b32 m0, m0, s47
  v_mfma_f32_16x16x32_bf16 v[144:147], a[224:227], v[184:187], v[144:147]
  v_mfma_f32_16x16x32_bf16 v[148:151], a[216:219], v[188:191], v[148:151]
  ds_read_b128 v[220:223], v19 offset:14336
  v_mfma_f32_16x16x32_bf16 v[152:155], a[220:223], v[188:191], v[152:155]
  v_mfma_f32_16x16x32_bf16 v[156:159], a[224:227], v[188:191], v[156:159]
  s_waitcnt vmcnt(19) lgkmcnt(4)
  s_barrier
  v_mfma_f32_16x16x32_bf16 v[64:67], a[228:231], v[192:195], v[64:67]
  ds_read_b128 v[160:163], v18 offset:0
  v_mfma_f32_16x16x32_bf16 v[68:71], a[232:235], v[192:195], v[68:71]
  s_waitcnt vmcnt(22)
  s_cmp_eq_u32 s78, 0
  s_cbranch_scc1 pf_222
  v_mov_b32 v4, 0
  v_mov_b32 v5, 1
  s_mov_b64 exec, 1
  buffer_atomic_add v5, v4, s[72:75], s78 offen sc1
  s_mov_b64 exec, -1
  s_mov_b32 s78, 0
pf_222:
  buffer_load_dword v21, v33, s[72:75], s77 offen sc1
  v_mfma_f32_16x16x32_bf16 v[72:75], a[236:239], v[192:195], v[72:75]
  v_add_u32 v19, s33, v15
  s_add_u32 s33, s33, 16384
  v_mfma_f32_16x16x32_bf16 v[76:79], a[228:231], v[196:199], v[76:79]
  ds_read_b128 v[164:167], v18 offset:2048
  v_cvt_pk_bf16_f32 v224, v64, v65
  v_cvt_pk_bf16_f32 v225, v66, v67
  v_mfma_f32_16x16x32_bf16 v[80:83], a[232:235], v[196:199], v[80:83]
  buffer_load_dwordx4 v10, s[8:11], s30 offen offset:0 lds
  v_cvt_pk_bf16_f32 v226, v68, v69
  v_cvt_pk_bf16_f32 v227, v70, v71
  v_mfma_f32_16x16x32_bf16 v[84:87], a[236:239], v[196:199], v[84:87]
  s_cmp_lt_u32 s33, 98304
  s_cselect_b32 s33, s33, 0
  v_cvt_pk_bf16_f32 v228, v72, v73
  v_cvt_pk_bf16_f32 v229, v74, v75
  v_mfma_f32_16x16x32_bf16 v[88:91], a[228:231], v[200:203], v[88:91]
  ds_read_b128 v[168:171], v18 offset:4096
  ds_write_b64 v22, v[224:225] offset:0
  v_mfma_f32_16x16x32_bf16 v[92:95], a[232:235], v[200:203], v[92:95]
  ds_write_b64 v22, v[226:227] offset:8
  ds_write_b64 v16, v[228:229] offset:64
  v_mfma_f32_16x16x32_bf16 v[96:99], a[236:239], v[200:203], v[96:99]
  v_cvt_pk_bf16_f32 v230, v76, v77
  v_cvt_pk_bf16_f32 v231, v78, v79
  v_cvt_pk_bf16_f32 v232, v80, v81
  v_cvt_pk_bf16_f32 v233, v82, v83
  v_mfma_f32_16x16x32_bf16 v[100:103], a[228:231], v[204:207], v[100:103]
  ds_read_b128 v[172:175], v18 offset:6144
  v_cvt_pk_bf16_f32 v234, v84, v85
  v_cvt_pk_bf16_f32 v235, v86, v87
  v_mfma_f32_16x16x32_bf16 v[104:107], a[232:235], v[204:207], v[104:107]
  ds_write_b64 v22, v[230:231] offset:6400
  ds_write_b64 v22, v[232:233] offset:6408
  v_mfma_f32_16x16x32_bf16 v[108:111], a[236:239], v[204:207], v[108:111]
  s_waitcnt lgkmcnt(9)
  ds_write_b64 v16, v[234:235] offset:6464
  v_cvt_pk_bf16_f32 v224, v88, v89
  v_mfma_f32_16x16x32_bf16 v[112:115], a[228:231], v[208:211], v[112:115]
  ds_read_b128 v[176:179], v18 offset:8192
  v_cvt_pk_bf16_f32 v225, v90, v91
  v_cvt_pk_bf16_f32 v226, v92, v93
  v_cvt_pk_bf16_f32 v227, v94, v95
  v_mfma_f32_16x16x32_bf16 v[116:119], a[232:235], v[208:211], v[116:119]
  v_cvt_pk_bf16_f32 v228, v96, v97
  v_cvt_pk_bf16_f32 v229, v98, v99
  ds_write_b64 v22, v[224:225] offset:12800
  v_mfma_f32_16x16x32_bf16 v[120:123], a[236:239], v[208:211], v[120:123]
  ds_write_b64 v22, v[226:227] offset:12808
  ds_write_b64 v16, v[228:229] offset:12864
  v_mfma_f32_16x16x32_bf16 v[124:127], a[228:231], v[212:215], v[124:127]
  ds_read_b128 v[180:183], v18 offset:10240
  v_cvt_pk_bf16_f32 v230, v100, v101
  v_cvt_pk_bf16_f32 v231, v102, v103
  v_cvt_pk_bf16_f32 v232, v104, v105
  v_mfma_f32_16x16x32_bf16 v[128:131], a[232:235], v[212:215], v[128:131]
  buffer_load_dwordx4 v11, s[8:11], s30 offen offset:1024 lds
  v_cvt_pk_bf16_f32 v233, v106, v107
  v_cvt_pk_bf16_f32 v234, v108, v109
  v_mfma_f32_16x16x32_bf16 v[132:135], a[236:239], v[212:215], v[132:135]
  v_cvt_pk_bf16_f32 v235, v110, v111
  ds_write_b64 v22, v[230:231] offset:19200
  v_mfma_f32_16x16x32_bf16 v[136:139], a[228:231], v[216:219], v[136:139]
  ds_read_b128 v[184:187], v18 offset:12288
  ds_write_b64 v22, v[232:233] offset:19208
  v_mfma_f32_16x16x32_bf16 v[140:143], a[232:235], v[216:219], v[140:143]
  ds_write_b64 v16, v[234:235] offset:19264
  v_cvt_pk_bf16_f32 v224, v112, v113
  v_cvt_pk_bf16_f32 v225, v114, v115
  v_mfma_f32_16x16x32_bf16 v[144:147], a[236:239], v[216:219], v[144:147]
  v_cvt_pk_bf16_f32 v226, v116, v117
  v_cvt_pk_bf16_f32 v227, v118, v119
  v_cvt_pk_bf16_f32 v228, v120, v121
  v_cvt_pk_bf16_f32 v229, v122, v123
  v_mfma_f32_16x16x32_bf16 v[148:151], a[228:231], v[220:223], v[148:151]
  ds_read_b128 v[188:191], v18 offset:14336
  ds_write_b64 v22, v[224:225] offset:25600
  v_mfma_f32_16x16x32_bf16 v[152:155], a[232:235], v[220:223], v[152:155]
  ds_write_b64 v22, v[226:227] offset:25608
  ds_write_b64 v16, v[228:229] offset:25664
  v_mfma_f32_16x16x32_bf16 v[156:159], a[236:239], v[220:223], v[156:159]
  v_cvt_pk_bf16_f32 v230, v124, v125
  v_cvt_pk_bf16_f32 v231, v126, v127
  v_cvt_pk_bf16_f32 v232, v128, v129
  v_cvt_pk_bf16_f32 v233, v130, v131
qa_end_224:
  v_cvt_pk_bf16_f32 v234, v132, v133
  v_cvt_pk_bf16_f32 v235, v134, v135
  ds_write_b64 v22, v[230:231] offset:32000
  ds_write_b64 v22, v[232:233] offset:32008
  ds_write_b64 v16, v[234:235] offset:32064
  v_cvt_pk_bf16_f32 v224, v136, v137
  v_cvt_pk_bf16_f32 v225, v138, v139
  v_cvt_pk_bf16_f32 v226, v140, v141
  v_cvt_pk_bf16_f32 v227, v142, v143
  v_cvt_pk_bf16_f32 v228, v144, v145
  v_cvt_pk_bf16_f32 v229, v146, v147
  ds_write_b64 v22, v[224:225] offset:38400
  ds_write_b64 v22, v[226:227] offset:38408
  ds_write_b64 v16, v[228:229] offset:38464
  v_cvt_pk_bf16_f32 v230, v148, v149
  v_cvt_pk_bf16_f32 v231, v150, v151
  v_cvt_pk_bf16_f32 v232, v152, v153
  v_cvt_pk_bf16_f32 v233, v154, v155
  v_cvt_pk_bf16_f32 v234, v156, v157
  v_cvt_pk_bf16_f32 v235, v158, v159
  ds_write_b64 v22, v[230:231] offset:44800
  ds_write_b64 v22, v[232:233] offset:44808
  ds_write_b64 v16, v[234:235] offset:44864
  s_cmp_eq_u32 s80, 1
  s_cselect_b32 s21, s79, 0
  s_cmp_ge_u32 s21, 8
  s_cbranch_scc0 qx_227
  s_waitcnt lgkmcnt(0) vmcnt(5)
  s_barrier
  ds_read_b128 v[64:67], v29 offset:0
  ds_read_b128 v[88:91], v29 offset:6400
  ds_read_b128 v[68:71], v29 offset:64
  ds_read_b128 v[92:95], v29 offset:6464
  ds_read_b128 v[72:75], v29 offset:128
  ds_read_b128 v[96:99], v29 offset:6528
  ds_read_b128 v[76:79], v29 offset:192
  ds_read_b128 v[100:103], v29 offset:6592
  ds_read_b128 v[80:83], v29 offset:256
  ds_read_b128 v[104:107], v29 offset:6656
  ds_read_b128 v[84:87], v29 offset:320
  ds_read_b128 v[108:111], v29 offset:6720
  s_waitcnt lgkmcnt(10)
  v_mfma_f32_16x16x32_bf16 v[112:115], v[36:39], v[64:67], 0
  v_mfma_f32_16x16x32_bf16 v[116:119], a[240:243], v[64:67], 0
  v_mfma_f32_16x16x32_bf16 v[120:123], v[36:39], v[88:91], 0
  v_mfma_f32_16x16x32_bf16 v[124:127], v[60:63], v[88:91], 0
  v_mfma_f32_16x16x32_bf16 v[128:131], a[240:243], v[88:91], 0
  s_waitcnt lgkmcnt(8)
  v_mfma_f32_16x16x32_bf16 v[112:115], v[40:43], v[68:71], v[112:115]
  v_mfma_f32_16x16x32_bf16 v[116:119], a[244:247], v[68:71], v[116:119]
  v_mfma_f32_16x16x32_bf16 v[120:123], v[40:43], v[92:95], v[120:123]
  v_mfma_f32_16x16x32_bf16 v[124:127], v[236:239], v[92:95], v[124:127]
  v_mfma_f32_16x16x32_bf16 v[128:131], a[244:247], v[92:95], v[128:131]
  s_waitcnt lgkmcnt(6)
  v_mfma_f32_16x16x32_bf16 v[112:115], v[44:47], v[72:75], v[112:115]
  v_mfma_f32_16x16x32_bf16 v[116:119], a[248:251], v[72:75], v[116:119]
  v_mfma_f32_16x16x32_bf16 v[120:123], v[44:47], v[96:99], v[120:123]
  v_mfma_f32_16x16x32_bf16 v[124:127], v[240:243], v[96:99], v[124:127]
  v_mfma_f32_16x16x32_bf16 v[128:131], a[248:251], v[96:99], v[128:131]
  s_waitcnt lgkmcnt(4)
  v_mfma_f32_16x16x32_bf16 v[112:115], v[48:51], v[76:79], v[112:115]
  v_mfma_f32_16x16x32_bf16 v[116:119], a[252:255], v[76:79], v[116:119]
  v_mfma_f32_16x16x32_bf16 v[120:123], v[48:51], v[100:103], v[120:123]
  v_mfma_f32_16x16x32_bf16 v[124:127], v[244:247], v[100:103], v[124:127]
  v_mfma_f32_16x16x32_bf16 v[128:131], a[252:255], v[100:103], v[128:131]
  s_waitcnt lgkmcnt(2)
  v_mfma_f32_16x16x32_bf16 v[112:115], v[52:55], v[80:83], v[112:115]
  v_mfma_f32_16x16x32_bf16 v[116:119], v[24:27], v[80:83], v[116:119]
  v_mfma_f32_16x16x32_bf16 v[120:123], v[52:55], v[104:107], v[120:123]
  v_mfma_f32_16x16x32_bf16 v[124:127], v[248:251], v[104:107], v[124:127]
  v_mfma_f32_16x16x32_bf16 v[128:131], v[24:27], v[104:107], v[128:131]
  s_waitcnt lgkmcnt(0)
  v_mfma_f32_16x16x32_bf16 v[112:115], v[56:59], v[84:87], v[112:115]
  v_mfma_f32_16x16x32_bf16 v[116:119], v[6:9], v[84:87], v[116:119]
  v_mfma_f32_16x16x32_bf16 v[120:123], v[56:59], v[108:111], v[120:123]
  v_mfma_f32_16x16x32_bf16 v[124:127], v[252:255], v[108:111], v[124:127]
  v_mfma_f32_16x16x32_bf16 v[128:131], v[6:9], v[108:111], v[128:131]
  s_branch qx_226
qx_227:
  buffer_load_dword v21, v33, s[72:75], s77 offen sc1
  s_waitcnt vmcnt(0)
  s_mul_i32 s21, s49, 393216
  s_mul_i32 s22, s42, 12288
  s_add_u32 s50, s21, s22
  s_mul_i32 s21, s49, 98304
  s_mul_i32 s22, s42, 3072
  s_add_u32 s51, s21, s22
  s_lshr_b32 s22, s49, 1
  s_lshr_b32 s21, s49, 2
  s_add_u32 s21, s21, 3
  s_cmp_lt_u32 s49, 12
  s_cselect_b32 s21, s22, s21
  s_lshl_b32 s21, s21, 3
  s_lshr_b32 s22, s42, 2
  s_add_u32 s21, s21, s22
  s_lshl_b32 s21, s21, 7
  s_add_u32 s76, s21, 0
  s_lshl_b32 s77, s42, 7
  s_add_u32 s77, s77, 19456
  s_add_u32 s23, s49, 1
  s_waitcnt vmcnt(6)
  v_cmp_gt_u32 vcc, s23, v21
  s_mov_b32 s80, 0
  s_nop 0
  s_cbranch_vccnz qk_229
  s_mov_b32 s80, 1
  buffer_load_dwordx4 a[240:243], v31, s[52:55], s51 offen offset:0 sc1
  buffer_load_dwordx4 a[244:247], v31, s[52:55], s51 offen offset:512 sc1
  buffer_load_dwordx4 a[248:251], v31, s[52:55], s51 offen offset:1024 sc1
  buffer_load_dwordx4 a[252:255], v31, s[52:55], s51 offen offset:1536 sc1
  buffer_load_dwordx4 v[24:27], v31, s[52:55], s51 offen offset:2048 sc1
  buffer_load_dwordx4 v[6:9], v31, s[52:55], s51 offen offset:2560 sc1
qk_229:
  s_cmp_ge_u32 s79, 8
  s_cbranch_scc1 qk_228
  v_mov_b32 v156, 0
  s_mov_b32 s101, 0
wf_230:
  buffer_load_dword v157, v156, s[72:75], s76 offen sc1
  s_add_u32 s101, s101, 1
  s_cmp_gt_u32 s101, 131072
  s_cbranch_scc1 main_end
  s_waitcnt vmcnt(0)
  v_readfirstlane_b32 s100, v157
  s_cmp_ge_u32 s100, 8
  s_cbranch_scc1 wf_231
  s_sleep 2
  s_branch wf_230
wf_231:
  s_add_u32 s21, s50, 0
  buffer_load_dwordx4 v[36:39], v30, s[16:19], s21 offen offset:0 sc1
  buffer_load_dwordx4 v[40:43], v30, s[16:19], s21 offen offset:1024 sc1
  buffer_load_dwordx4 v[44:47], v30, s[16:19], s21 offen offset:2048 sc1
  buffer_load_dwordx4 v[48:51], v30, s[16:19], s21 offen offset:3072 sc1
  s_add_u32 s21, s50, 4096
  buffer_load_dwordx4 v[52:55], v30, s[16:19], s21 offen offset:0 sc1
  buffer_load_dwordx4 v[56:59], v30, s[16:19], s21 offen offset:1024 sc1
  buffer_load_dwordx4 v[60:63], v30, s[16:19], s21 offen offset:2048 sc1
  buffer_load_dwordx4 v[236:239], v30, s[16:19], s21 offen offset:3072 sc1
  s_add_u32 s21, s50, 8192
  buffer_load_dwordx4 v[240:243], v30, s[16:19], s21 offen offset:0 sc1
  buffer_load_dwordx4 v[244:247], v30, s[16:19], s21 offen offset:1024 sc1
  buffer_load_dwordx4 v[248:251], v30, s[16:19], s21 offen offset:2048 sc1
  buffer_load_dwordx4 v[252:255], v30, s[16:19], s21 offen offset:3072 sc1
qk_228:
  s_waitcnt lgkmcnt(0)
  s_barrier
  ds_read_b128 v[64:67], v29 offset:0
  ds_read_b128 v[68:71], v29 offset:64
  ds_read_b128 v[72:75], v29 offset:128
  ds_read_b128 v[76:79], v29 offset:192
  ds_read_b128 v[80:83], v29 offset:256
  ds_read_b128 v[84:87], v29 offset:320
  ds_read_b128 v[88:91], v29 offset:6400
  ds_read_b128 v[92:95], v29 offset:6464
  ds_read_b128 v[96:99], v29 offset:6528
  ds_read_b128 v[100:103], v29 offset:6592
  ds_read_b128 v[104:107], v29 offset:6656
  ds_read_b128 v[108:111], v29 offset:6720
  s_waitcnt lgkmcnt(0)
  s_cmp_eq_u32 s80, 1
  s_cselect_b32 s21, s79, 0
  s_cmp_ge_u32 s21, 8
  s_cbranch_scc1 qw_232
  s_waitcnt vmcnt(0)
qw_232:
  v_mfma_f32_16x16x32_bf16 v[112:115], v[36:39], v[64:67], 0
  v_mfma_f32_16x16x32_bf16 v[120:123], v[36:39], v[88:91], 0
  v_mfma_f32_16x16x32_bf16 v[124:127], v[60:63], v[88:91], 0
  v_mfma_f32_16x16x32_bf16 v[112:115], v[40:43], v[68:71], v[112:115]
  v_mfma_f32_16x16x32_bf16 v[120:123], v[40:43], v[92:95], v[120:123]
  v_mfma_f32_16x16x32_bf16 v[124:127], v[236:239], v[92:95], v[124:127]
  v_mfma_f32_16x16x32_bf16 v[112:115], v[44:47], v[72:75], v[112:115]
  v_mfma_f32_16x16x32_bf16 v[120:123], v[44:47], v[96:99], v[120:123]
  v_mfma_f32_16x16x32_bf16 v[124:127], v[240:243], v[96:99], v[124:127]
  v_mfma_f32_16x16x32_bf16 v[112:115], v[48:51], v[76:79], v[112:115]
  v_mfma_f32_16x16x32_bf16 v[120:123], v[48:51], v[100:103], v[120:123]
  v_mfma_f32_16x16x32_bf16 v[124:127], v[244:247], v[100:103], v[124:127]
  v_mfma_f32_16x16x32_bf16 v[112:115], v[52:55], v[80:83], v[112:115]
  v_mfma_f32_16x16x32_bf16 v[120:123], v[52:55], v[104:107], v[120:123]
  v_mfma_f32_16x16x32_bf16 v[124:127], v[248:251], v[104:107], v[124:127]
  v_mfma_f32_16x16x32_bf16 v[112:115], v[56:59], v[84:87], v[112:115]
  v_mfma_f32_16x16x32_bf16 v[120:123], v[56:59], v[108:111], v[120:123]
  v_mfma_f32_16x16x32_bf16 v[124:127], v[252:255], v[108:111], v[124:127]
  s_cmp_eq_u32 s80, 1
  s_cbranch_scc1 qm_233
  s_add_u32 s23, s49, 1
  s_mov_b32 s101, 0
wm_234:
  buffer_load_dword v156, v33, s[72:75], s77 offen sc1
  s_add_u32 s101, s101, 1
  s_cmp_gt_u32 s101, 131072
  s_cbranch_scc1 main_end
  s_waitcnt vmcnt(0)
  v_cmp_gt_u32 vcc, s23, v156
  v_readfirstlane_b32 s100, v156
  s_nop 0
  s_cbranch_vccz wm_235
  s_sleep 16
  s_add_u32 s100, s100, 2
  s_cmp_ge_u32 s100, s23
  s_cbranch_scc1 wm_234
  s_sleep 90
  s_branch wm_234
wm_235:
  buffer_load_dwordx4 a[240:243], v31, s[52:55], s51 offen offset:0 sc1
  buffer_load_dwordx4 a[244:247], v31, s[52:55], s51 offen offset:512 sc1
  buffer_load_dwordx4 a[248:251], v31, s[52:55], s51 offen offset:1024 sc1
  buffer_load_dwordx4 a[252:255], v31, s[52:55], s51 offen offset:1536 sc1
  buffer_load_dwordx4 v[24:27], v31, s[52:55], s51 offen offset:2048 sc1
  buffer_load_dwordx4 v[6:9], v31, s[52:55], s51 offen offset:2560 sc1
qm_233:
  s_waitcnt vmcnt(0)
  v_mfma_f32_16x16x32_bf16 v[116:119], a[240:243], v[64:67], 0
  v_mfma_f32_16x16x32_bf16 v[128:131], a[240:243], v[88:91], 0
  v_mfma_f32_16x16x32_bf16 v[116:119], a[244:247], v[68:71], v[116:119]
  v_mfma_f32_16x16x32_bf16 v[128:131], a[244:247], v[92:95], v[128:131]
  v_mfma_f32_16x16x32_bf16 v[116:119], a[248:251], v[72:75], v[116:119]
  v_mfma_f32_16x16x32_bf16 v[128:131], a[248:251], v[96:99], v[128:131]
  v_mfma_f32_16x16x32_bf16 v[116:119], a[252:255], v[76:79], v[116:119]
  v_mfma_f32_16x16x32_bf16 v[128:131], a[252:255], v[100:103], v[128:131]
  v_mfma_f32_16x16x32_bf16 v[116:119], v[24:27], v[80:83], v[116:119]
  v_mfma_f32_16x16x32_bf16 v[128:131], v[24:27], v[104:107], v[128:131]
  v_mfma_f32_16x16x32_bf16 v[116:119], v[6:9], v[84:87], v[116:119]
  v_mfma_f32_16x16x32_bf16 v[128:131], v[6:9], v[108:111], v[128:131]
qx_226:
  s_lshl_b32 s21, s49, 5
  s_add_u32 s21, s21, s42
  s_mul_i32 s81, s21, 2560
  s_lshl_b32 s82, s49, 3
  s_and_b32 s21, s42, 7
  s_add_u32 s82, s82, s21
  s_lshl_b32 s82, s82, 7
  s_add_u32 s82, s82, 23552
  s_cmp_gt_u32 s26, 1
  s_cselect_b32 s21, s80, 0
  s_cmp_eq_u32 s21, 0
  s_cbranch_scc1 qi_237
  v_mov_b32 v36, v112
  v_mov_b32 v37, v113
  v_mov_b32 v38, v114
  v_mov_b32 v39, v115
  v_mov_b32 v40, v116
  v_mov_b32 v41, v117
  v_mov_b32 v42, v118
  v_mov_b32 v43, v119
  v_mov_b32 v44, v120
  v_mov_b32 v45, v121
  v_mov_b32 v46, v122
  v_mov_b32 v47, v123
  v_mov_b32 v48, v124
  v_mov_b32 v49, v125
  v_mov_b32 v50, v126
  v_mov_b32 v51, v127
  v_mov_b32 v52, v128
  v_mov_b32 v53, v129
  v_mov_b32 v54, v130
  v_mov_b32 v55, v131
  s_branch qd_236
qi_237:
  v_cndmask_b32 v112, v34, v112, s[64:65]
  v_cndmask_b32 v124, v34, v124, s[64:65]
  v_cndmask_b32 v113, v34, v113, s[66:67]
  v_cndmask_b32 v125, v34, v125, s[66:67]
  v_cndmask_b32 v114, v34, v114, s[68:69]
  v_cndmask_b32 v126, v34, v126, s[68:69]
  v_cndmask_b32 v115, v34, v115, s[70:71]
  v_cndmask_b32 v127, v34, v127, s[70:71]
  v_max3_f32 v156, v112, v113, v114
  v_max3_f32 v156, v156, v115, v116
  v_max3_f32 v156, v156, v117, v118
  v_max_f32 v156, v156, v119
  v_mov_b32 v157, v156
  s_nop 1
  v_permlane32_swap_b32 v156, v157
  v_max_f32 v156, v156, v157
  v_mov_b32 v157, v156
  s_nop 1
  v_permlane16_swap_b32 v156, v157
  v_max_f32 v156, v156, v157
  v_mul_f32 v156, s83, v156
  v_fma_f32 v112, v112, s83, -v156
  v_fma_f32 v113, v113, s83, -v156
  v_fma_f32 v114, v114, s83, -v156
  v_fma_f32 v115, v115, s83, -v156
  v_fma_f32 v116, v116, s83, -v156
  v_fma_f32 v117, v117, s83, -v156
  v_fma_f32 v118, v118, s83, -v156
  v_fma_f32 v119, v119, s83, -v156
  v_exp_f32 v112, v112
  v_exp_f32 v113, v113
  v_exp_f32 v114, v114
  v_exp_f32 v115, v115
  v_exp_f32 v116, v116
  v_exp_f32 v117, v117
  v_exp_f32 v118, v118
  v_exp_f32 v119, v119
  s_nop 0
  v_add_f32 v156, v116, v117
  v_add_f32 v156, v156, v118
  v_add_f32 v156, v156, v119
  v_cndmask_b32 v156, 0, v156, s[60:61]
  v_add_f32 v156, v156, v112
  v_add_f32 v156, v156, v113
  v_add_f32 v156, v156, v114
  v_add_f32 v156, v156, v115
  v_mov_b32 v157, v156
  s_nop 1
  v_permlane32_swap_b32 v156, v157
  v_add_f32 v156, v156, v157
  v_mov_b32 v157, v156
  s_nop 1
  v_permlane16_swap_b32 v156, v157
  v_add_f32 v156, v156, v157
  v_rcp_f32 v156, v156
  s_nop 0
  v_mul_f32 v112, v112, v156
  v_mul_f32 v113, v113, v156
  v_mul_f32 v114, v114, v156
  v_mul_f32 v115, v115, v156
  v_mul_f32 v116, v116, v156
  v_mul_f32 v117, v117, v156
  v_mul_f32 v118, v118, v156
  v_mul_f32 v119, v119, v156
  v_max3_f32 v156, v120, v121, v122
  v_max3_f32 v156, v156, v123, v124
  v_max3_f32 v156, v156, v125, v126
  v_max3_f32 v156, v156, v127, v128
  v_max3_f32 v156, v156, v129, v130
  v_max_f32 v156, v156, v131
  v_mov_b32 v157, v156
  s_nop 1
  v_permlane32_swap_b32 v156, v157
  v_max_f32 v156, v156, v157
  v_mov_b32 v157, v156
  s_nop 1
  v_permlane16_swap_b32 v156, v157
  v_max_f32 v156, v156, v157
  v_mul_f32 v156, s83, v156
  v_fma_f32 v120, v120, s83, -v156
  v_fma_f32 v121, v121, s83, -v156
  v_fma_f32 v122, v122, s83, -v156
  v_fma_f32 v123, v123, s83, -v156
  v_fma_f32 v124, v124, s83, -v156
  v_fma_f32 v125, v125, s83, -v156
  v_fma_f32 v126, v126, s83, -v156
  v_fma_f32 v127, v127, s83, -v156
  v_fma_f32 v128, v128, s83, -v156
  v_fma_f32 v129, v129, s83, -v156
  v_fma_f32 v130, v130, s83, -v156
  v_fma_f32 v131, v131, s83, -v156
  v_exp_f32 v120, v120
  v_exp_f32 v121, v121
  v_exp_f32 v122, v122
  v_exp_f32 v123, v123
  v_exp_f32 v124, v124
  v_exp_f32 v125, v125
  v_exp_f32 v126, v126
  v_exp_f32 v127, v127
  v_exp_f32 v128, v128
  v_exp_f32 v129, v129
  v_exp_f32 v130, v130
  v_exp_f32 v131, v131
  s_nop 0
  v_add_f32 v156, v128, v129
  v_add_f32 v156, v156, v130
  v_add_f32 v156, v156, v131
  v_cndmask_b32 v156, 0, v156, s[60:61]
  v_add_f32 v156, v156, v120
  v_add_f32 v156, v156, v121
  v_add_f32 v156, v156, v122
  v_add_f32 v156, v156, v123
  v_add_f32 v156, v156, v124
  v_add_f32 v156, v156, v125
  v_add_f32 v156, v156, v126
  v_add_f32 v156, v156, v127
  v_mov_b32 v157, v156
  s_nop 1
  v_permlane32_swap_b32 v156, v157
  v_add_f32 v156, v156, v157
  v_mov_b32 v157, v156
  s_nop 1
  v_permlane16_swap_b32 v156, v157
  v_add_f32 v156, v156, v157
  v_rcp_f32 v156, v156
  s_nop 0
  v_mul_f32 v120, v120, v156
  v_mul_f32 v121, v121, v156
  v_mul_f32 v122, v122, v156
  v_mul_f32 v123, v123, v156
  v_mul_f32 v124, v124, v156
  v_mul_f32 v125, v125, v156
  v_mul_f32 v126, v126, v156
  v_mul_f32 v127, v127, v156
  v_mul_f32 v128, v128, v156
  v_mul_f32 v129, v129, v156
  v_mul_f32 v130, v130, v156
  v_mul_f32 v131, v131, v156
  v_cvt_pk_bf16_f32 v196, v116, v117
  v_cvt_pk_bf16_f32 v197, v118, v119
  v_cvt_pk_bf16_f32 v198, v128, v129
  v_cvt_pk_bf16_f32 v199, v130, v131
  v_cvt_pk_bf16_f32 v192, v120, v121
  v_cvt_pk_bf16_f32 v193, v122, v123
  v_cvt_pk_bf16_f32 v194, v124, v125
  v_cvt_pk_bf16_f32 v195, v126, v127
  v_cvt_pk_bf16_f32 v200, v112, v113
  v_cvt_pk_bf16_f32 v201, v114, v115
  v_permlane16_swap_b32 v196, v198
  v_permlane16_swap_b32 v197, v199
  buffer_store_dwordx4 v[192:195], v30, s[56:59], s81 offen sc1
  s_mov_b64 exec, 0xffffffff
  buffer_store_dwordx4 v[196:199], v30, s[56:59], s81 offen offset:1024 sc1
  s_mov_b64 exec, -1
  buffer_store_dwordx2 v[200:201], v32, s[56:59], s81 offen offset:2048 sc1
  s_mov_b32 s78, s82
  s_mov_b32 s81, 0x80000000
  s_mov_b32 s82, 0
  s_cmp_eq_u32 s80, 1
  s_cbranch_scc1 qd_236
  s_waitcnt vmcnt(0)
  s_cmp_eq_u32 s78, 0
  s_cbranch_scc1 pf_238
  v_mov_b32 v4, 0
  v_mov_b32 v5, 1
  s_mov_b64 exec, 1
  buffer_atomic_add v5, v4, s[72:75], s78 offen sc1
  s_mov_b64 exec, -1
  s_mov_b32 s78, 0
pf_238:
qd_236:
  s_add_u32 s49, s49, s29
qbe_225:
  s_sub_u32 s26, s26, 1
  s_cmp_gt_u32 s26, 0
  s_waitcnt lgkmcnt(0)
  s_cbranch_scc1 qa_blk_223
  s_waitcnt vmcnt(0) lgkmcnt(0)
  s_cmp_eq_u32 s78, 0
  s_cbranch_scc1 pf_239
  v_mov_b32 v4, 0
  v_mov_b32 v5, 1
  s_mov_b64 exec, 1
  buffer_atomic_add v5, v4, s[72:75], s78 offen sc1
  s_mov_b64 exec, -1
  s_mov_b32 s78, 0
pf_239:
  s_branch q_done
q_final:
  s_mov_b32 s16, s38
  s_mov_b32 s17, s39
  s_mov_b32 s18, 50331648
  s_mov_b32 s19, 0x00020000
  s_add_u32 s52, s38, 50331648
  s_addc_u32 s53, s39, 0
  s_mov_b32 s54, 6291456
  s_mov_b32 s55, 0x00020000
  s_add_u32 s56, s38, 85983232
  s_addc_u32 s57, s39, 0
  s_mov_b32 s58, 5242880
  s_mov_b32 s59, 0x00020000
  s_mul_i32 s21, s20, 12800
  s_add_u32 s21, s21, 98304
  v_mul_u32_u24 v4, 400, v2
  v_lshlrev_b32 v5, 4, v3
  v_add3_u32 v29, v4, v5, s21
  v_lshlrev_b32 v30, 4, v1
  v_and_b32 v4, 1, v2
  v_bfe_u32 v5, v2, 1, 1
  v_lshl_or_b32 v4, v5, 2, v4
  v_bfe_u32 v5, v2, 2, 1
  v_lshl_or_b32 v4, v5, 1, v4
  v_lshlrev_b32 v4, 4, v4
  v_lshl_add_u32 v31, v3, 7, v4
  v_lshlrev_b32 v32, 3, v1
  v_and_b32 v4, 3, v1
  v_lshlrev_b32 v33, 3, v4
  v_mov_b32 v34, 0xf149f2ca
  v_lshlrev_b32 v4, 2, v3
  v_sub_u32 v35, v2, v4
  v_cmp_gt_u32 s[60:61], 2, v3
  s_mov_b32 s62, 0x3d93cd3a
  s_mov_b32 s63, 0x3fb8aa3b
  s_mov_b32 s83, 0x3dd53b95
  v_cmp_le_i32 s[64:65], 0, v35
  v_cmp_le_i32 s[66:67], 1, v35
  v_cmp_le_i32 s[68:69], 2, v35
  v_cmp_le_i32 s[70:71], 3, v35
  s_add_u32 s49, s20, 56
  s_mov_b32 s29, 4
  s_mov_b32 s78, 0
  s_add_u32 s12, s38, 201326592
  s_addc_u32 s13, s39, 0
  s_mov_b32 s14, 3145728
  s_mov_b32 s15, 0x00020000
qf_240:
  s_mul_i32 s21, s49, 393216
  s_mul_i32 s22, s42, 12288
  s_add_u32 s50, s21, s22
  s_mul_i32 s21, s49, 98304
  s_mul_i32 s22, s42, 3072
  s_add_u32 s51, s21, s22
  s_lshr_b32 s22, s49, 1
  s_lshr_b32 s21, s49, 2
  s_add_u32 s21, s21, 3
  s_cmp_lt_u32 s49, 12
  s_cselect_b32 s21, s22, s21
  s_lshl_b32 s21, s21, 3
  s_lshr_b32 s22, s42, 2
  s_add_u32 s21, s21, s22
  s_lshl_b32 s21, s21, 7
  s_add_u32 s76, s21, 0
  s_lshl_b32 s77, s42, 7
  s_add_u32 s77, s77, 19456
  s_sub_u32 s43, s50, 22020096
  buffer_load_dword v21, v33, s[72:75], s77 offen sc1
  s_add_u32 s21, s50, 0
  buffer_load_dwordx4 v[36:39], v30, s[16:19], s21 offen offset:0 sc1
  buffer_load_dwordx4 v[40:43], v30, s[16:19], s21 offen offset:1024 sc1
  buffer_load_dwordx4 v[44:47], v30, s[16:19], s21 offen offset:2048 sc1
  buffer_load_dwordx4 v[48:51], v30, s[16:19], s21 offen offset:3072 sc1
  s_add_u32 s21, s50, 4096
  buffer_load_dwordx4 v[52:55], v30, s[16:19], s21 offen offset:0 sc1
  buffer_load_dwordx4 v[56:59], v30, s[16:19], s21 offen offset:1024 sc1
  buffer_load_dwordx4 v[60:63], v30, s[16:19], s21 offen offset:2048 sc1
  buffer_load_dwordx4 v[236:239], v30, s[16:19], s21 offen offset:3072 sc1
  s_add_u32 s21, s50, 8192
  buffer_load_dwordx4 v[240:243], v30, s[16:19], s21 offen offset:0 sc1
  buffer_load_dwordx4 v[244:247], v30, s[16:19], s21 offen offset:1024 sc1
  buffer_load_dwordx4 v[248:251], v30, s[16:19], s21 offen offset:2048 sc1
  buffer_load_dwordx4 v[252:255], v30, s[16:19], s21 offen offset:3072 sc1
  s_add_u32 s21, s43, 0
  buffer_load_dwordx4 v[64:67], v30, s[12:15], s21 offen offset:0 sc1
  buffer_load_dwordx4 v[68:71], v30, s[12:15], s21 offen offset:1024 sc1
  buffer_load_dwordx4 v[72:75], v30, s[12:15], s21 offen offset:2048 sc1
  buffer_load_dwordx4 v[76:79], v30, s[12:15], s21 offen offset:3072 sc1
  s_add_u32 s21, s43, 4096
  buffer_load_dwordx4 v[80:83], v30, s[12:15], s21 offen offset:0 sc1
  buffer_load_dwordx4 v[84:87], v30, s[12:15], s21 offen offset:1024 sc1
  buffer_load_dwordx4 v[88:91], v30, s[12:15], s21 offen offset:2048 sc1
  buffer_load_dwordx4 v[92:95], v30, s[12:15], s21 offen offset:3072 sc1
  s_add_u32 s21, s43, 8192
  buffer_load_dwordx4 v[96:99], v30, s[12:15], s21 offen offset:0 sc1
  buffer_load_dwordx4 v[100:103], v30, s[12:15], s21 offen offset:1024 sc1
  buffer_load_dwordx4 v[104:107], v30, s[12:15], s21 offen offset:2048 sc1
  buffer_load_dwordx4 v[108:111], v30, s[12:15], s21 offen offset:3072 sc1
  s_waitcnt vmcnt(24)
  s_cmp_eq_u32 s78, 0
  s_cbranch_scc1 pf_244
  v_mov_b32 v4, 0
  v_mov_b32 v5, 1
  s_mov_b64 exec, 1
  buffer_atomic_add v5, v4, s[72:75], s78 offen sc1
  s_mov_b64 exec, -1
  s_mov_b32 s78, 0
pf_244:
  s_add_u32 s23, s49, 1
  v_cmp_gt_u32 vcc, s23, v21
  s_mov_b32 s80, 0
  s_nop 0
  s_cbranch_vccnz qk_243
  s_mov_b32 s80, 1
  buffer_load_dwordx4 v[132:135], v31, s[52:55], s51 offen offset:0 sc1
  buffer_load_dwordx4 v[136:139], v31, s[52:55], s51 offen offset:512 sc1
  buffer_load_dwordx4 v[140:143], v31, s[52:55], s51 offen offset:1024 sc1
  buffer_load_dwordx4 v[144:147], v31, s[52:55], s51 offen offset:1536 sc1
  buffer_load_dwordx4 v[148:151], v31, s[52:55], s51 offen offset:2048 sc1
  buffer_load_dwordx4 v[152:155], v31, s[52:55], s51 offen offset:2560 sc1
  s_waitcnt vmcnt(6)
  s_branch qk_243x
qk_243:
  s_waitcnt vmcnt(0)
qk_243x:
  v_mfma_f32_16x16x32_bf16 v[112:115], v[36:39], v[64:67], 0
  v_mfma_f32_16x16x32_bf16 v[120:123], v[36:39], v[88:91], 0
  v_mfma_f32_16x16x32_bf16 v[124:127], v[60:63], v[88:91], 0
  v_mfma_f32_16x16x32_bf16 v[112:115], v[40:43], v[68:71], v[112:115]
  v_mfma_f32_16x16x32_bf16 v[120:123], v[40:43], v[92:95], v[120:123]
  v_mfma_f32_16x16x32_bf16 v[124:127], v[236:239], v[92:95], v[124:127]
  v_mfma_f32_16x16x32_bf16 v[112:115], v[44:47], v[72:75], v[112:115]
  v_mfma_f32_16x16x32_bf16 v[120:123], v[44:47], v[96:99], v[120:123]
  v_mfma_f32_16x16x32_bf16 v[124:127], v[240:243], v[96:99], v[124:127]
  v_mfma_f32_16x16x32_bf16 v[112:115], v[48:51], v[76:79], v[112:115]
  v_mfma_f32_16x16x32_bf16 v[120:123], v[48:51], v[100:103], v[120:123]
  v_mfma_f32_16x16x32_bf16 v[124:127], v[244:247], v[100:103], v[124:127]
  v_mfma_f32_16x16x32_bf16 v[112:115], v[52:55], v[80:83], v[112:115]
  v_mfma_f32_16x16x32_bf16 v[120:123], v[52:55], v[104:107], v[120:123]
  v_mfma_f32_16x16x32_bf16 v[124:127], v[248:251], v[104:107], v[124:127]
  v_mfma_f32_16x16x32_bf16 v[112:115], v[56:59], v[84:87], v[112:115]
  v_mfma_f32_16x16x32_bf16 v[120:123], v[56:59], v[108:111], v[120:123]
  v_mfma_f32_16x16x32_bf16 v[124:127], v[252:255], v[108:111], v[124:127]
  s_cmp_eq_u32 s80, 1
  s_cbranch_scc1 qm_245
  s_add_u32 s23, s49, 1
  s_min_u32 s22, s49, 61
  s_cmp_lt_u32 s49, 58
  s_cselect_b32 s23, s23, s22
  s_mov_b32 s101, 0
wm_246:
  buffer_load_dword v156, v33, s[72:75], s77 offen sc1
  s_add_u32 s101, s101, 1
  s_cmp_gt_u32 s101, 131072
  s_cbranch_scc1 main_end
  s_waitcnt vmcnt(0)
  v_cmp_gt_u32 vcc, s23, v156
  v_readfirstlane_b32 s100, v156
  s_nop 0
  s_cbranch_vccz wm_247
  s_sleep 16
  s_add_u32 s100, s100, 2
  s_cmp_ge_u32 s100, s23
  s_cbranch_scc1 wm_246
  s_sleep 90
  s_branch wm_246
wm_247:
  s_cmp_eq_u32 s49, 63
  s_cselect_b32 s21, s101, 0
  s_cmp_lt_u32 s21, 2
  s_cbranch_scc1 qtz_250
  s_sleep 36
qtz_250:
  s_mov_b32 s101, 0
  s_branch qtp_249
qtp_248:
  s_sleep 3
qtp_249:
  buffer_load_dwordx4 v[132:135], v31, s[52:55], s51 offen offset:0 sc1
  buffer_load_dwordx4 v[136:139], v31, s[52:55], s51 offen offset:512 sc1
  buffer_load_dwordx4 v[140:143], v31, s[52:55], s51 offen offset:1024 sc1
  buffer_load_dwordx4 v[144:147], v31, s[52:55], s51 offen offset:1536 sc1
  buffer_load_dwordx4 v[148:151], v31, s[52:55], s51 offen offset:2048 sc1
  buffer_load_dwordx4 v[152:155], v31, s[52:55], s51 offen offset:2560 sc1
  s_add_u32 s101, s101, 1
  s_cmp_gt_u32 s101, 131072
  s_cbranch_scc1 main_end
  s_waitcnt vmcnt(0)
  v_max3_u32 v156, v132, v134, v136
  v_max3_u32 v156, v156, v138, v140
  v_max3_u32 v156, v156, v142, v144
  v_max3_u32 v156, v156, v146, v148
  v_max3_u32 v156, v156, v150, v152
  v_max3_u32 v156, v156, v154, v154
  v_cmp_eq_u32 vcc, -1, v156
  s_nop 1
  s_cbranch_vccnz qtp_248
qm_245:
  s_waitcnt vmcnt(0)
  v_mfma_f32_16x16x32_bf16 v[116:119], v[132:135], v[64:67], 0
  v_mfma_f32_16x16x32_bf16 v[128:131], v[132:135], v[88:91], 0
  v_mfma_f32_16x16x32_bf16 v[116:119], v[136:139], v[68:71], v[116:119]
  v_mfma_f32_16x16x32_bf16 v[128:131], v[136:139], v[92:95], v[128:131]
  v_mfma_f32_16x16x32_bf16 v[116:119], v[140:143], v[72:75], v[116:119]
  v_mfma_f32_16x16x32_bf16 v[128:131], v[140:143], v[96:99], v[128:131]
  v_mfma_f32_16x16x32_bf16 v[116:119], v[144:147], v[76:79], v[116:119]
  v_mfma_f32_16x16x32_bf16 v[128:131], v[144:147], v[100:103], v[128:131]
  v_mfma_f32_16x16x32_bf16 v[116:119], v[148:151], v[80:83], v[116:119]
  v_mfma_f32_16x16x32_bf16 v[128:131], v[148:151], v[104:107], v[128:131]
  v_mfma_f32_16x16x32_bf16 v[116:119], v[152:155], v[84:87], v[116:119]
  v_mfma_f32_16x16x32_bf16 v[128:131], v[152:155], v[108:111], v[128:131]
qx_242:
  s_lshl_b32 s21, s49, 5
  s_add_u32 s21, s21, s42
  s_mul_i32 s81, s21, 2560
  s_lshl_b32 s82, s49, 3
  s_and_b32 s21, s42, 7
  s_add_u32 s82, s82, s21
  s_lshl_b32 s82, s82, 7
  s_add_u32 s82, s82, 23552
  v_cndmask_b32 v112, v34, v112, s[64:65]
  v_cndmask_b32 v124, v34, v124, s[64:65]
  v_cndmask_b32 v113, v34, v113, s[66:67]
  v_cndmask_b32 v125, v34, v125, s[66:67]
  v_cndmask_b32 v114, v34, v114, s[68:69]
  v_cndmask_b32 v126, v34, v126, s[68:69]
  v_cndmask_b32 v115, v34, v115, s[70:71]
  v_cndmask_b32 v127, v34, v127, s[70:71]
  v_max3_f32 v156, v112, v113, v114
  v_max3_f32 v156, v156, v115, v116
  v_max3_f32 v156, v156, v117, v118
  v_max_f32 v156, v156, v119
  v_mov_b32 v157, v156
  s_nop 1
  v_permlane32_swap_b32 v156, v157
  v_max_f32 v156, v156, v157
  v_mov_b32 v157, v156
  s_nop 1
  v_permlane16_swap_b32 v156, v157
  v_max_f32 v156, v156, v157
  v_mul_f32 v156, s83, v156
  v_fma_f32 v112, v112, s83, -v156
  v_fma_f32 v113, v113, s83, -v156
  v_fma_f32 v114, v114, s83, -v156
  v_fma_f32 v115, v115, s83, -v156
  v_fma_f32 v116, v116, s83, -v156
  v_fma_f32 v117, v117, s83, -v156
  v_fma_f32 v118, v118, s83, -v156
  v_fma_f32 v119, v119, s83, -v156
  v_exp_f32 v112, v112
  v_exp_f32 v113, v113
  v_exp_f32 v114, v114
  v_exp_f32 v115, v115
  v_exp_f32 v116, v116
  v_exp_f32 v117, v117
  v_exp_f32 v118, v118
  v_exp_f32 v119, v119
  s_nop 0
  v_add_f32 v156, v116, v117
  v_add_f32 v156, v156, v118
  v_add_f32 v156, v156, v119
  v_cndmask_b32 v156, 0, v156, s[60:61]
  v_add_f32 v156, v156, v112
  v_add_f32 v156, v156, v113
  v_add_f32 v156, v156, v114
  v_add_f32 v156, v156, v115
  v_mov_b32 v157, v156
  s_nop 1
  v_permlane32_swap_b32 v156, v157
  v_add_f32 v156, v156, v157
  v_mov_b32 v157, v156
  s_nop 1
  v_permlane16_swap_b32 v156, v157
  v_add_f32 v156, v156, v157
  v_rcp_f32 v156, v156
  s_nop 0
  v_mul_f32 v112, v112, v156
  v_mul_f32 v113, v113, v156
  v_mul_f32 v114, v114, v156
  v_mul_f32 v115, v115, v156
  v_mul_f32 v116, v116, v156
  v_mul_f32 v117, v117, v156
  v_mul_f32 v118, v118, v156
  v_mul_f32 v119, v119, v156
  v_max3_f32 v156, v120, v121, v122
  v_max3_f32 v156, v156, v123, v124
  v_max3_f32 v156, v156, v125, v126
  v_max3_f32 v156, v156, v127, v128
  v_max3_f32 v156, v156, v129, v130
  v_max_f32 v156, v156, v131
  v_mov_b32 v157, v156
  s_nop 1
  v_permlane32_swap_b32 v156, v157
  v_max_f32 v156, v156, v157
  v_mov_b32 v157, v156
  s_nop 1
  v_permlane16_swap_b32 v156, v157
  v_max_f32 v156, v156, v157
  v_mul_f32 v156, s83, v156
  v_fma_f32 v120, v120, s83, -v156
  v_fma_f32 v121, v121, s83, -v156
  v_fma_f32 v122, v122, s83, -v156
  v_fma_f32 v123, v123, s83, -v156
  v_fma_f32 v124, v124, s83, -v156
  v_fma_f32 v125, v125, s83, -v156
  v_fma_f32 v126, v126, s83, -v156
  v_fma_f32 v127, v127, s83, -v156
  v_fma_f32 v128, v128, s83, -v156
  v_fma_f32 v129, v129, s83, -v156
  v_fma_f32 v130, v130, s83, -v156
  v_fma_f32 v131, v131, s83, -v156
  v_exp_f32 v120, v120
  v_exp_f32 v121, v121
  v_exp_f32 v122, v122
  v_exp_f32 v123, v123
  v_exp_f32 v124, v124
  v_exp_f32 v125, v125
  v_exp_f32 v126, v126
  v_exp_f32 v127, v127
  v_exp_f32 v128, v128
  v_exp_f32 v129, v129
  v_exp_f32 v130, v130
  v_exp_f32 v131, v131
  s_nop 0
  v_add_f32 v156, v128, v129
  v_add_f32 v156, v156, v130
  v_add_f32 v156, v156, v131
  v_cndmask_b32 v156, 0, v156, s[60:61]
  v_add_f32 v156, v156, v120
  v_add_f32 v156, v156, v121
  v_add_f32 v156, v156, v122
  v_add_f32 v156, v156, v123
  v_add_f32 v156, v156, v124
  v_add_f32 v156, v156, v125
  v_add_f32 v156, v156, v126
  v_add_f32 v156, v156, v127
  v_mov_b32 v157, v156
  s_nop 1
  v_permlane32_swap_b32 v156, v157
  v_add_f32 v156, v156, v157
  v_mov_b32 v157, v156
  s_nop 1
  v_permlane16_swap_b32 v156, v157
  v_add_f32 v156, v156, v157
  v_rcp_f32 v156, v156
  s_nop 0
  v_mul_f32 v120, v120, v156
  v_mul_f32 v121, v121, v156
  v_mul_f32 v122, v122, v156
  v_mul_f32 v123, v123, v156
  v_mul_f32 v124, v124, v156
  v_mul_f32 v125, v125, v156
  v_mul_f32 v126, v126, v156
  v_mul_f32 v127, v127, v156
  v_mul_f32 v128, v128, v156
  v_mul_f32 v129, v129, v156
  v_mul_f32 v130, v130, v156
  v_mul_f32 v131, v131, v156
  v_cvt_pk_bf16_f32 v196, v116, v117
  v_cvt_pk_bf16_f32 v197, v118, v119
  v_cvt_pk_bf16_f32 v198, v128, v129
  v_cvt_pk_bf16_f32 v199, v130, v131
  v_cvt_pk_bf16_f32 v192, v120, v121
  v_cvt_pk_bf16_f32 v193, v122, v123
  v_cvt_pk_bf16_f32 v194, v124, v125
  v_cvt_pk_bf16_f32 v195, v126, v127
  v_cvt_pk_bf16_f32 v200, v112, v113
  v_cvt_pk_bf16_f32 v201, v114, v115
  v_permlane16_swap_b32 v196, v198
  v_permlane16_swap_b32 v197, v199
  buffer_store_dwordx4 v[192:195], v30, s[56:59], s81 offen sc1
  s_mov_b64 exec, 0xffffffff
  buffer_store_dwordx4 v[196:199], v30, s[56:59], s81 offen offset:1024 sc1
  s_mov_b64 exec, -1
  buffer_store_dwordx2 v[200:201], v32, s[56:59], s81 offen offset:2048 sc1
  s_mov_b32 s78, s82
  s_mov_b32 s81, 0x80000000
  s_mov_b32 s82, 0
  s_cmp_eq_u32 s80, 1
  s_cbranch_scc1 qd_251
  s_waitcnt vmcnt(0)
  s_cmp_eq_u32 s78, 0
  s_cbranch_scc1 pf_252
  v_mov_b32 v4, 0
  v_mov_b32 v5, 1
  s_mov_b64 exec, 1
  buffer_atomic_add v5, v4, s[72:75], s78 offen sc1
  s_mov_b64 exec, -1
  s_mov_b32 s78, 0
pf_252:
qd_251:
  s_add_u32 s49, s49, s29
qbe_241:
  s_cmp_lt_u32 s49, 64
  s_cbranch_scc1 qf_240
  s_waitcnt vmcnt(0)
  s_cmp_eq_u32 s78, 0
  s_cbranch_scc1 pf_253
  v_mov_b32 v4, 0
  v_mov_b32 v5, 1
  s_mov_b64 exec, 1
  buffer_atomic_add v5, v4, s[72:75], s78 offen sc1
  s_mov_b64 exec, -1
  s_mov_b32 s78, 0
pf_253:
  s_branch queue
q_done:
  s_and_b32 s21, s3, 3
  s_cmp_lt_u32 s21, 0
  s_cbranch_scc1 queue
  s_sub_u32 s21, s21, 0
  s_lshl_b32 s21, s21, 3
  s_bfe_u32 s22, s3, 0x30002
  s_add_u32 s21, s21, s22
  s_add_u32 s87, s21, 334
  s_branch tail_item
queue:
  s_load_dwordx2 s[4:5], s[0:1], 96
  s_waitcnt lgkmcnt(0)
  s_mov_b32 s32, s4
  s_mov_b32 s33, s5
  s_mov_b32 s34, 256
  s_mov_b32 s35, 0x00020000
  s_waitcnt vmcnt(0) lgkmcnt(0)
  s_barrier
  s_mov_b32 s2, s85
  s_mov_b32 s85, -1
  s_cmp_lg_u32 s2, -1
  s_cbranch_scc1 queue_c
  v_mov_b32 v21, 0
  s_cmp_lg_u32 s20, 0
  s_cbranch_scc1 q_254
  v_mov_b32 v22, 80
  v_mov_b32 v23, 1
  s_mov_b64 exec, 1
  buffer_atomic_add v23, v22, s[32:35], 0 offen sc0 sc1
  s_waitcnt vmcnt(0)
queue_a:
  ds_write_b32 v21, v23
  s_waitcnt lgkmcnt(0)
  s_mov_b64 exec, -1
q_254:
queue_b:
  s_barrier
  ds_read_b32 v23, v21
  s_waitcnt lgkmcnt(0)
  v_readfirstlane_b32 s2, v23
  s_barrier
queue_c:
  s_add_u32 s21, s2, 0
  s_cmp_lt_u32 s2, 270
  s_cbranch_scc1 do_pv
  s_sub_u32 s2, s2, 270
  s_add_u32 s21, s2, 310
  s_cmp_lt_u32 s2, 24
  s_cbranch_scc1 do_pv
  s_sub_u32 s2, s2, 24
  s_add_u32 s21, s2, 270
  s_cmp_lt_u32 s2, 40
  s_cbranch_scc1 do_pv
  s_sub_u32 s2, s2, 40
  s_branch main_fin
do_opb:
  s_mov_b32 s87, -1
do_opb2:
  s_mov_b32 s2, s21
  s_load_dwordx2 s[4:5], s[0:1], 0
  s_load_dwordx4 s[40:43], s[0:1], 72
  s_load_dwordx2 s[38:39], s[0:1], 104
  s_lshl_b32 s59, s2, 2
  s_add_u32 s59, s59, s20
  s_lshl_b32 s59, s59, 3
  v_lshlrev_b32 v4, 4, v1
  v_lshlrev_b32 v5, 2, v1
  s_waitcnt lgkmcnt(0)
  s_mov_b32 s8, s4
  s_mov_b32 s9, s5
  s_mov_b32 s10, 2621440
  s_mov_b32 s11, 0x00020000
  s_mov_b32 s12, s42
  s_mov_b32 s13, s43
  s_mov_b32 s14, 1280
  s_mov_b32 s15, 0x00020000
  s_mov_b32 s24, s40
  s_mov_b32 s25, s41
  s_mov_b32 s26, 819200
  s_mov_b32 s27, 0x00020000
  s_add_u32 s16, s38, 70713344
  s_addc_u32 s17, s39, 0
  s_mov_b32 s18, 2641920
  s_mov_b32 s19, 0x00020000
  s_add_u32 s28, s38, 81002496
  s_addc_u32 s29, s39, 0
  s_mov_b32 s30, 8192
  s_mov_b32 s31, 0x00020000
  s_add_u32 s72, s38, 81068032
  s_addc_u32 s73, s39, 0
  s_mov_b32 s74, 116736
  s_mov_b32 s75, 0x00020000
  s_mov_b32 s21, 91136
  v_mov_b32 v20, 0
  buffer_load_dword v21, v20, s[72:75], s21 offen sc1
  v_mov_b32 v29, 3277
  s_mul_i32 s21, s20, 320
  s_add_u32 s21, s21, 0
  v_add_u32 v22, s21, v1
  v_mul_u32_u24 v23, v22, v29
  v_lshrrev_b32 v23, 16, v23
  v_mul_u32_u24 v24, 20, v23
  v_sub_u32 v22, v22, v24
  v_bfe_u32 v24, v23, 3, 1
  v_lshlrev_b32 v24, 1, v24
  v_xor_b32 v22, v22, v24
  v_mul_u32_u24 v23, 1280, v23
  v_lshl_add_u32 v8, v22, 4, v23
  s_mul_i32 s21, s20, 320
  s_add_u32 s21, s21, 64
  v_add_u32 v22, s21, v1
  v_mul_u32_u24 v23, v22, v29
  v_lshrrev_b32 v23, 16, v23
  v_mul_u32_u24 v24, 20, v23
  v_sub_u32 v22, v22, v24
  v_bfe_u32 v24, v23, 3, 1
  v_lshlrev_b32 v24, 1, v24
  v_xor_b32 v22, v22, v24
  v_mul_u32_u24 v23, 1280, v23
  v_lshl_add_u32 v9, v22, 4, v23
  s_mul_i32 s21, s20, 320
  s_add_u32 s21, s21, 128
  v_add_u32 v22, s21, v1
  v_mul_u32_u24 v23, v22, v29
  v_lshrrev_b32 v23, 16, v23
  v_mul_u32_u24 v24, 20, v23
  v_sub_u32 v22, v22, v24
  v_bfe_u32 v24, v23, 3, 1
  v_lshlrev_b32 v24, 1, v24
  v_xor_b32 v22, v22, v24
  v_mul_u32_u24 v23, 1280, v23
  v_lshl_add_u32 v10, v22, 4, v23
  s_mul_i32 s21, s20, 320
  s_add_u32 s21, s21, 192
  v_add_u32 v22, s21, v1
  v_mul_u32_u24 v23, v22, v29
  v_lshrrev_b32 v23, 16, v23
  v_mul_u32_u24 v24, 20, v23
  v_sub_u32 v22, v22, v24
  v_bfe_u32 v24, v23, 3, 1
  v_lshlrev_b32 v24, 1, v24
  v_xor_b32 v22, v22, v24
  v_mul_u32_u24 v23, 1280, v23
  v_lshl_add_u32 v11, v22, 4, v23
  s_mul_i32 s21, s20, 320
  s_add_u32 s21, s21, 256
  v_add_u32 v22, s21, v1
  v_mul_u32_u24 v23, v22, v29
  v_lshrrev_b32 v23, 16, v23
  v_mul_u32_u24 v24, 20, v23
  v_sub_u32 v22, v22, v24
  v_bfe_u32 v24, v23, 3, 1
  v_lshlrev_b32 v24, 1, v24
  v_xor_b32 v22, v22, v24
  v_mul_u32_u24 v23, 1280, v23
  v_lshl_add_u32 v12, v22, 4, v23
  s_and_b32 s44, s2, 3
  s_mul_i32 s45, s44, 320
  s_mul_i32 s46, s20, 5120
  v_and_b32 v22, 1, v2
  v_mul_u32_u24 v22, 16512, v22
  v_mul_u32_u24 v23, 33024, v3
  v_lshrrev_b32 v24, 1, v2
  v_lshlrev_b32 v24, 4, v24
  v_add3_u32 v6, v22, v23, v24
  s_lshr_b32 s47, s2, 2
  s_lshl_b32 s47, s47, 2
  s_add_u32 s47, s47, s20
  s_lshl_b32 s47, s47, 1
  s_lshl_b32 s48, s47, 7
  v_lshrrev_b32 v22, 2, v2
  v_lshl_add_u32 v22, v3, 3, v22
  v_mul_u32_u24 v22, 320, v22
  v_and_b32 v23, 3, v2
  v_lshl_add_u32 v22, v23, 3, v22
  v_and_b32 v23, 1, v3
  v_lshlrev_b32 v23, 5, v23
  v_add_u32 v14, v22, v23
  v_sub_u32 v15, v22, v23
  v_add_u32 v16, 61440, v14
  v_add_u32 v17, 61440, v15
  v_add_u32 v18, 122880, v14
  v_add_u32 v19, 122880, v15
  s_add_u32 m0, s46, 0
  s_add_u32 s49, s45, 0
  s_nop 0
  buffer_load_dwordx4 v8, s[24:27], s49 offen lds
  s_add_u32 m0, s46, 1024
  s_nop 0
  buffer_load_dwordx4 v9, s[24:27], s49 offen lds
  s_add_u32 m0, s46, 2048
  s_nop 0
  buffer_load_dwordx4 v10, s[24:27], s49 offen lds
  s_add_u32 m0, s46, 3072
  s_nop 0
  buffer_load_dwordx4 v11, s[24:27], s49 offen lds
  s_add_u32 m0, s46, 4096
  s_nop 0
  buffer_load_dwordx4 v12, s[24:27], s49 offen lds
  s_add_u32 m0, s46, 20480
  s_add_u32 s49, s45, 81920
  s_nop 0
  buffer_load_dwordx4 v8, s[24:27], s49 offen lds
  s_add_u32 m0, s46, 21504
  s_nop 0
  buffer_load_dwordx4 v9, s[24:27], s49 offen lds
  s_add_u32 m0, s46, 22528
  s_nop 0
  buffer_load_dwordx4 v10, s[24:27], s49 offen lds
  s_add_u32 m0, s46, 23552
  s_nop 0
  buffer_load_dwordx4 v11, s[24:27], s49 offen lds
  s_add_u32 m0, s46, 24576
  s_nop 0
  buffer_load_dwordx4 v12, s[24:27], s49 offen lds
  s_waitcnt vmcnt(10)
  v_readfirstlane_b32 s21, v21
  s_cmp_ge_u32 s21, 32
  s_cbranch_scc1 o2_255
  s_mov_b32 s21, 91136
  v_mov_b32 v20, 0
  s_mov_b32 s101, 0
wf_256:
  buffer_load_dword v21, v20, s[72:75], s21 offen sc1
  s_add_u32 s101, s101, 1
  s_cmp_gt_u32 s101, 131072
  s_cbranch_scc1 main_end
  s_waitcnt vmcnt(0)
  v_readfirstlane_b32 s100, v21
  s_cmp_ge_u32 s100, 32
  s_cbranch_scc1 wf_257
  s_sleep 32
  s_branch wf_256
wf_257:
o2_255:
  buffer_load_dwordx4 a[0:3], v6, s[16:19], s48 offen offset:0 sc1
  buffer_load_dwordx4 a[4:7], v6, s[16:19], s48 offen offset:128 sc1
  s_add_u32 s48, s48, 132096
  buffer_load_dwordx4 a[8:11], v6, s[16:19], s48 offen offset:0 sc1
  buffer_load_dwordx4 a[12:15], v6, s[16:19], s48 offen offset:128 sc1
  s_add_u32 s48, s48, 132096
  buffer_load_dwordx4 a[16:19], v6, s[16:19], s48 offen offset:0 sc1
  buffer_load_dwordx4 a[20:23], v6, s[16:19], s48 offen offset:128 sc1
  s_add_u32 s48, s48, 132096
  buffer_load_dwordx4 a[24:27], v6, s[16:19], s48 offen offset:0 sc1
  buffer_load_dwordx4 a[28:31], v6, s[16:19], s48 offen offset:128 sc1
  s_add_u32 s48, s48, 132096
  s_add_u32 m0, s46, 40960
  s_add_u32 s49, s45, 163840
  s_nop 0
  buffer_load_dwordx4 v8, s[24:27], s49 offen lds
  s_add_u32 m0, s46, 41984
  s_nop 0
  buffer_load_dwordx4 v9, s[24:27], s49 offen lds
  s_add_u32 m0, s46, 43008
  s_nop 0
  buffer_load_dwordx4 v10, s[24:27], s49 offen lds
  s_add_u32 m0, s46, 44032
  s_nop 0
  buffer_load_dwordx4 v11, s[24:27], s49 offen lds
  s_add_u32 m0, s46, 45056
  s_nop 0
  buffer_load_dwordx4 v12, s[24:27], s49 offen lds
  buffer_load_dwordx4 a[32:35], v6, s[16:19], s48 offen offset:0 sc1
  buffer_load_dwordx4 a[36:39], v6, s[16:19], s48 offen offset:128 sc1
  s_add_u32 s48, s48, 132096
  buffer_load_dwordx4 a[40:43], v6, s[16:19], s48 offen offset:0 sc1
  buffer_load_dwordx4 a[44:47], v6, s[16:19], s48 offen offset:128 sc1
  s_add_u32 s48, s48, 132096
  s_add_u32 m0, s46, 61440
  s_add_u32 s49, s45, 245760
  s_nop 0
  buffer_load_dwordx4 v8, s[24:27], s49 offen lds
  s_add_u32 m0, s46, 62464
  s_nop 0
  buffer_load_dwordx4 v9, s[24:27], s49 offen lds
  s_add_u32 m0, s46, 63488
  s_nop 0
  buffer_load_dwordx4 v10, s[24:27], s49 offen lds
  s_add_u32 m0, s46, 64512
  s_nop 0
  buffer_load_dwordx4 v11, s[24:27], s49 offen lds
  s_add_u32 m0, s46, 65536
  s_nop 0
  buffer_load_dwordx4 v12, s[24:27], s49 offen lds
  buffer_load_dwordx4 a[48:51], v6, s[16:19], s48 offen offset:0 sc1
  buffer_load_dwordx4 a[52:55], v6, s[16:19], s48 offen offset:128 sc1
  s_add_u32 s48, s48, 132096
  buffer_load_dwordx4 a[56:59], v6, s[16:19], s48 offen offset:0 sc1
  buffer_load_dwordx4 a[60:63], v6, s[16:19], s48 offen offset:128 sc1
  s_add_u32 s48, s48, 132096
  s_add_u32 m0, s46, 81920
  s_add_u32 s49, s45, 327680
  s_nop 0
  buffer_load_dwordx4 v8, s[24:27], s49 offen lds
  s_add_u32 m0, s46, 82944
  s_nop 0
  buffer_load_dwordx4 v9, s[24:27], s49 offen lds
  s_add_u32 m0, s46, 83968
  s_nop 0
  buffer_load_dwordx4 v10, s[24:27], s49 offen lds
  s_add_u32 m0, s46, 84992
  s_nop 0
  buffer_load_dwordx4 v11, s[24:27], s49 offen lds
  s_add_u32 m0, s46, 86016
  s_nop 0
  buffer_load_dwordx4 v12, s[24:27], s49 offen lds
  buffer_load_dwordx4 a[64:67], v6, s[16:19], s48 offen offset:0 sc1
  buffer_load_dwordx4 a[68:71], v6, s[16:19], s48 offen offset:128 sc1
  s_add_u32 s48, s48, 132096
  buffer_load_dwordx4 a[72:75], v6, s[16:19], s48 offen offset:0 sc1
  buffer_load_dwordx4 a[76:79], v6, s[16:19], s48 offen offset:128 sc1
  s_add_u32 s48, s48, 132096
  s_add_u32 m0, s46, 102400
  s_add_u32 s49, s45, 409600
  s_nop 0
  buffer_load_dwordx4 v8, s[24:27], s49 offen lds
  s_add_u32 m0, s46, 103424
  s_nop 0
  buffer_load_dwordx4 v9, s[24:27], s49 offen lds
  s_add_u32 m0, s46, 104448
  s_nop 0
  buffer_load_dwordx4 v10, s[24:27], s49 offen lds
  s_add_u32 m0, s46, 105472
  s_nop 0
  buffer_load_dwordx4 v11, s[24:27], s49 offen lds
  s_add_u32 m0, s46, 106496
  s_nop 0
  buffer_load_dwordx4 v12, s[24:27], s49 offen lds
  s_add_u32 m0, s46, 122880
  s_add_u32 s49, s45, 491520
  s_nop 0
  buffer_load_dwordx4 v8, s[24:27], s49 offen lds
  s_add_u32 m0, s46, 123904
  s_nop 0
  buffer_load_dwordx4 v9, s[24:27], s49 offen lds
  s_add_u32 m0, s46, 124928
  s_nop 0
  buffer_load_dwordx4 v10, s[24:27], s49 offen lds
  s_add_u32 m0, s46, 125952
  s_nop 0
  buffer_load_dwordx4 v11, s[24:27], s49 offen lds
  s_add_u32 m0, s46, 126976
  s_nop 0
  buffer_load_dwordx4 v12, s[24:27], s49 offen lds
  s_waitcnt vmcnt(50)
  s_barrier
  ds_read_b64_tr_b16 v[144:145], v14 offset:0
  ds_read_b64_tr_b16 v[146:147], v14 offset:1280
  ds_read_b64_tr_b16 v[148:149], v15 offset:32
  ds_read_b64_tr_b16 v[150:151], v15 offset:1312
  ds_read_b64_tr_b16 v[152:153], v14 offset:64
  ds_read_b64_tr_b16 v[154:155], v14 offset:1344
  ds_read_b64_tr_b16 v[156:157], v15 offset:96
  ds_read_b64_tr_b16 v[158:159], v15 offset:1376
  ds_read_b64_tr_b16 v[160:161], v14 offset:128
  ds_read_b64_tr_b16 v[162:163], v14 offset:1408
  ds_read_b64_tr_b16 v[164:165], v15 offset:160
  ds_read_b64_tr_b16 v[166:167], v15 offset:1440
  ds_read_b64_tr_b16 v[168:169], v14 offset:192
  ds_read_b64_tr_b16 v[170:171], v14 offset:1472
  ds_read_b64_tr_b16 v[172:173], v15 offset:224
  ds_read_b64_tr_b16 v[174:175], v15 offset:1504
  ds_read_b64_tr_b16 v[176:177], v14 offset:256
  ds_read_b64_tr_b16 v[178:179], v14 offset:1536
  ds_read_b64_tr_b16 v[180:181], v15 offset:288
  ds_read_b64_tr_b16 v[182:183], v15 offset:1568
  s_waitcnt lgkmcnt(0) vmcnt(43)
  v_mfma_f32_16x16x32_bf16 v[64:67], v[144:147], a[0:3], 0
  ds_read_b64_tr_b16 v[184:185], v14 offset:10240
  ds_read_b64_tr_b16 v[186:187], v14 offset:11520
  v_mfma_f32_16x16x32_bf16 v[104:107], v[144:147], a[4:7], 0
  ds_read_b64_tr_b16 v[188:189], v15 offset:10272
  v_mfma_f32_16x16x32_bf16 v[68:71], v[148:151], a[0:3], 0
  ds_read_b64_tr_b16 v[190:191], v15 offset:11552
  v_mfma_f32_16x16x32_bf16 v[108:111], v[148:151], a[4:7], 0
  ds_read_b64_tr_b16 v[192:193], v14 offset:10304
  v_mfma_f32_16x16x32_bf16 v[72:75], v[152:155], a[0:3], 0
  ds_read_b64_tr_b16 v[194:195], v14 offset:11584
  v_mfma_f32_16x16x32_bf16 v[112:115], v[152:155], a[4:7], 0
  ds_read_b64_tr_b16 v[196:197], v15 offset:10336
  ds_read_b64_tr_b16 v[198:199], v15 offset:11616
  v_mfma_f32_16x16x32_bf16 v[76:79], v[156:159], a[0:3], 0
  ds_read_b64_tr_b16 v[200:201], v14 offset:10368
  v_mfma_f32_16x16x32_bf16 v[116:119], v[156:159], a[4:7], 0
  ds_read_b64_tr_b16 v[202:203], v14 offset:11648
  v_mfma_f32_16x16x32_bf16 v[80:83], v[160:163], a[0:3], 0
  ds_read_b64_tr_b16 v[204:205], v15 offset:10400
  v_mfma_f32_16x16x32_bf16 v[120:123], v[160:163], a[4:7], 0
  ds_read_b64_tr_b16 v[206:207], v15 offset:11680
  v_mfma_f32_16x16x32_bf16 v[84:87], v[164:167], a[0:3], 0
  ds_read_b64_tr_b16 v[208:209], v14 offset:10432
  v_mfma_f32_16x16x32_bf16 v[124:127], v[164:167], a[4:7], 0
  ds_read_b64_tr_b16 v[210:211], v14 offset:11712
  ds_read_b64_tr_b16 v[212:213], v15 offset:10464
  v_mfma_f32_16x16x32_bf16 v[88:91], v[168:171], a[0:3], 0
  ds_read_b64_tr_b16 v[214:215], v15 offset:11744
  v_mfma_f32_16x16x32_bf16 v[128:131], v[168:171], a[4:7], 0
  buffer_load_dwordx4 a[80:83], v6, s[16:19], s48 offen offset:0 sc1
  ds_read_b64_tr_b16 v[216:217], v14 offset:10496
  v_mfma_f32_16x16x32_bf16 v[92:95], v[172:175], a[0:3], 0
  ds_read_b64_tr_b16 v[218:219], v14 offset:11776
  v_mfma_f32_16x16x32_bf16 v[132:135], v[172:175], a[4:7], 0
  ds_read_b64_tr_b16 v[220:221], v15 offset:10528
  v_mfma_f32_16x16x32_bf16 v[96:99], v[176:179], a[0:3], 0
  ds_read_b64_tr_b16 v[222:223], v15 offset:11808
  v_mfma_f32_16x16x32_bf16 v[136:139], v[176:179], a[4:7], 0
  buffer_load_dwordx4 a[84:87], v6, s[16:19], s48 offen offset:128 sc1
  v_mfma_f32_16x16x32_bf16 v[100:103], v[180:183], a[0:3], 0
  s_add_u32 s48, s48, 132096
  v_mfma_f32_16x16x32_bf16 v[140:143], v[180:183], a[4:7], 0
  s_waitcnt lgkmcnt(0) vmcnt(43)
  s_barrier
  v_mfma_f32_16x16x32_bf16 v[64:67], v[184:187], a[8:11], v[64:67]
  s_add_u32 m0, s46, 0
  ds_read_b64_tr_b16 v[144:145], v14 offset:20480
  ds_read_b64_tr_b16 v[146:147], v14 offset:21760
  v_mfma_f32_16x16x32_bf16 v[104:107], v[184:187], a[12:15], v[104:107]
  s_add_u32 s49, s45, 573440
  ds_read_b64_tr_b16 v[148:149], v15 offset:20512
  v_mfma_f32_16x16x32_bf16 v[68:71], v[188:191], a[8:11], v[68:71]
  buffer_load_dwordx4 v8, s[24:27], s49 offen lds
  ds_read_b64_tr_b16 v[150:151], v15 offset:21792
  v_mfma_f32_16x16x32_bf16 v[108:111], v[188:191], a[12:15], v[108:111]
  s_add_u32 m0, s46, 1024
  ds_read_b64_tr_b16 v[152:153], v14 offset:20544
  v_mfma_f32_16x16x32_bf16 v[72:75], v[192:195], a[8:11], v[72:75]
  buffer_load_dwordx4 v9, s[24:27], s49 offen lds
  ds_read_b64_tr_b16 v[154:155], v14 offset:21824
  v_mfma_f32_16x16x32_bf16 v[112:115], v[192:195], a[12:15], v[112:115]
  s_add_u32 m0, s46, 2048
  ds_read_b64_tr_b16 v[156:157], v15 offset:20576
  ds_read_b64_tr_b16 v[158:159], v15 offset:21856
  v_mfma_f32_16x16x32_bf16 v[76:79], v[196:199], a[8:11], v[76:79]
  buffer_load_dwordx4 v10, s[24:27], s49 offen lds
  ds_read_b64_tr_b16 v[160:161], v14 offset:20608
  v_mfma_f32_16x16x32_bf16 v[116:119], v[196:199], a[12:15], v[116:119]
  s_add_u32 m0, s46, 3072
  ds_read_b64_tr_b16 v[162:163], v14 offset:21888
  v_mfma_f32_16x16x32_bf16 v[80:83], v[200:203], a[8:11], v[80:83]
  buffer_load_dwordx4 v11, s[24:27], s49 offen lds
  ds_read_b64_tr_b16 v[164:165], v15 offset:20640
  v_mfma_f32_16x16x32_bf16 v[120:123], v[200:203], a[12:15], v[120:123]
  s_add_u32 m0, s46, 4096
  ds_read_b64_tr_b16 v[166:167], v15 offset:21920
  v_mfma_f32_16x16x32_bf16 v[84:87], v[204:207], a[8:11], v[84:87]
  buffer_load_dwordx4 v12, s[24:27], s49 offen lds
  ds_read_b64_tr_b16 v[168:169], v14 offset:20672
  v_mfma_f32_16x16x32_bf16 v[124:127], v[204:207], a[12:15], v[124:127]
  ds_read_b64_tr_b16 v[170:171], v14 offset:21952
  ds_read_b64_tr_b16 v[172:173], v15 offset:20704
  v_mfma_f32_16x16x32_bf16 v[88:91], v[208:211], a[8:11], v[88:91]
  ds_read_b64_tr_b16 v[174:175], v15 offset:21984
  v_mfma_f32_16x16x32_bf16 v[128:131], v[208:211], a[12:15], v[128:131]
  buffer_load_dwordx4 a[88:91], v6, s[16:19], s48 offen offset:0 sc1
  ds_read_b64_tr_b16 v[176:177], v14 offset:20736
  v_mfma_f32_16x16x32_bf16 v[92:95], v[212:215], a[8:11], v[92:95]
  ds_read_b64_tr_b16 v[178:179], v14 offset:22016
  v_mfma_f32_16x16x32_bf16 v[132:135], v[212:215], a[12:15], v[132:135]
  ds_read_b64_tr_b16 v[180:181], v15 offset:20768
  v_mfma_f32_16x16x32_bf16 v[96:99], v[216:219], a[8:11], v[96:99]
  ds_read_b64_tr_b16 v[182:183], v15 offset:22048
  v_mfma_f32_16x16x32_bf16 v[136:139], v[216:219], a[12:15], v[136:139]
  buffer_load_dwordx4 a[92:95], v6, s[16:19], s48 offen offset:128 sc1
  v_mfma_f32_16x16x32_bf16 v[100:103], v[220:223], a[8:11], v[100:103]
  s_add_u32 s48, s48, 132096
  v_mfma_f32_16x16x32_bf16 v[140:143], v[220:223], a[12:15], v[140:143]
  s_waitcnt lgkmcnt(0) vmcnt(48)
  v_mfma_f32_16x16x32_bf16 v[64:67], v[144:147], a[16:19], v[64:67]
  ds_read_b64_tr_b16 v[184:185], v14 offset:30720
  ds_read_b64_tr_b16 v[186:187], v14 offset:32000
  v_mfma_f32_16x16x32_bf16 v[104:107], v[144:147], a[20:23], v[104:107]
  ds_read_b64_tr_b16 v[188:189], v15 offset:30752
  v_mfma_f32_16x16x32_bf16 v[68:71], v[148:151], a[16:19], v[68:71]
  ds_read_b64_tr_b16 v[190:191], v15 offset:32032
  v_mfma_f32_16x16x32_bf16 v[108:111], v[148:151], a[20:23], v[108:111]
  ds_read_b64_tr_b16 v[192:193], v14 offset:30784
  v_mfma_f32_16x16x32_bf16 v[72:75], v[152:155], a[16:19], v[72:75]
  ds_read_b64_tr_b16 v[194:195], v14 offset:32064
  v_mfma_f32_16x16x32_bf16 v[112:115], v[152:155], a[20:23], v[112:115]
  ds_read_b64_tr_b16 v[196:197], v15 offset:30816
  ds_read_b64_tr_b16 v[198:199], v15 offset:32096
  v_mfma_f32_16x16x32_bf16 v[76:79], v[156:159], a[16:19], v[76:79]
  ds_read_b64_tr_b16 v[200:201], v14 offset:30848
  v_mfma_f32_16x16x32_bf16 v[116:119], v[156:159], a[20:23], v[116:119]
  ds_read_b64_tr_b16 v[202:203], v14 offset:32128
  v_mfma_f32_16x16x32_bf16 v[80:83], v[160:163], a[16:19], v[80:83]
  ds_read_b64_tr_b16 v[204:205], v15 offset:30880
  v_mfma_f32_16x16x32_bf16 v[120:123], v[160:163], a[20:23], v[120:123]
  ds_read_b64_tr_b16 v[206:207], v15 offset:32160
  v_mfma_f32_16x16x32_bf16 v[84:87], v[164:167], a[16:19], v[84:87]
  ds_read_b64_tr_b16 v[208:209], v14 offset:30912
  v_mfma_f32_16x16x32_bf16 v[124:127], v[164:167], a[20:23], v[124:127]
  ds_read_b64_tr_b16 v[210:211], v14 offset:32192
  ds_read_b64_tr_b16 v[212:213], v15 offset:30944
  v_mfma_f32_16x16x32_bf16 v[88:91], v[168:171], a[16:19], v[88:91]
  ds_read_b64_tr_b16 v[214:215], v15 offset:32224
  v_mfma_f32_16x16x32_bf16 v[128:131], v[168:171], a[20:23], v[128:131]
  buffer_load_dwordx4 a[96:99], v6, s[16:19], s48 offen offset:0 sc1
  ds_read_b64_tr_b16 v[216:217], v14 offset:30976
  v_mfma_f32_16x16x32_bf16 v[92:95], v[172:175], a[16:19], v[92:95]
  ds_read_b64_tr_b16 v[218:219], v14 offset:32256
  v_mfma_f32_16x16x32_bf16 v[132:135], v[172:175], a[20:23], v[132:135]
  ds_read_b64_tr_b16 v[220:221], v15 offset:31008
  v_mfma_f32_16x16x32_bf16 v[96:99], v[176:179], a[16:19], v[96:99]
  ds_read_b64_tr_b16 v[222:223], v15 offset:32288
  v_mfma_f32_16x16x32_bf16 v[136:139], v[176:179], a[20:23], v[136:139]
  buffer_load_dwordx4 a[100:103], v6, s[16:19], s48 offen offset:128 sc1
  v_mfma_f32_16x16x32_bf16 v[100:103], v[180:183], a[16:19], v[100:103]
  s_add_u32 s48, s48, 132096
  v_mfma_f32_16x16x32_bf16 v[140:143], v[180:183], a[20:23], v[140:143]
  s_waitcnt lgkmcnt(0) vmcnt(43)
  s_barrier
  v_mfma_f32_16x16x32_bf16 v[64:67], v[184:187], a[24:27], v[64:67]
  s_add_u32 m0, s46, 20480
  ds_read_b64_tr_b16 v[144:145], v14 offset:40960
  ds_read_b64_tr_b16 v[146:147], v14 offset:42240
  v_mfma_f32_16x16x32_bf16 v[104:107], v[184:187], a[28:31], v[104:107]
  s_add_u32 s49, s45, 655360
  ds_read_b64_tr_b16 v[148:149], v15 offset:40992
  v_mfma_f32_16x16x32_bf16 v[68:71], v[188:191], a[24:27], v[68:71]
  buffer_load_dwordx4 v8, s[24:27], s49 offen lds
  ds_read_b64_tr_b16 v[150:151], v15 offset:42272
  v_mfma_f32_16x16x32_bf16 v[108:111], v[188:191], a[28:31], v[108:111]
  s_add_u32 m0, s46, 21504
  ds_read_b64_tr_b16 v[152:153], v14 offset:41024
  v_mfma_f32_16x16x32_bf16 v[72:75], v[192:195], a[24:27], v[72:75]
  buffer_load_dwordx4 v9, s[24:27], s49 offen lds
  ds_read_b64_tr_b16 v[154:155], v14 offset:42304
  v_mfma_f32_16x16x32_bf16 v[112:115], v[192:195], a[28:31], v[112:115]
  s_add_u32 m0, s46, 22528
  ds_read_b64_tr_b16 v[156:157], v15 offset:41056
  ds_read_b64_tr_b16 v[158:159], v15 offset:42336
  v_mfma_f32_16x16x32_bf16 v[76:79], v[196:199], a[24:27], v[76:79]
  buffer_load_dwordx4 v10, s[24:27], s49 offen lds
  ds_read_b64_tr_b16 v[160:161], v14 offset:41088
  v_mfma_f32_16x16x32_bf16 v[116:119], v[196:199], a[28:31], v[116:119]
  s_add_u32 m0, s46, 23552
  ds_read_b64_tr_b16 v[162:163], v14 offset:42368
  v_mfma_f32_16x16x32_bf16 v[80:83], v[200:203], a[24:27], v[80:83]
  buffer_load_dwordx4 v11, s[24:27], s49 offen lds
  ds_read_b64_tr_b16 v[164:165], v15 offset:41120
  v_mfma_f32_16x16x32_bf16 v[120:123], v[200:203], a[28:31], v[120:123]
  s_add_u32 m0, s46, 24576
  ds_read_b64_tr_b16 v[166:167], v15 offset:42400
  v_mfma_f32_16x16x32_bf16 v[84:87], v[204:207], a[24:27], v[84:87]
  buffer_load_dwordx4 v12, s[24:27], s49 offen lds
  ds_read_b64_tr_b16 v[168:169], v14 offset:41152
  v_mfma_f32_16x16x32_bf16 v[124:127], v[204:207], a[28:31], v[124:127]
  ds_read_b64_tr_b16 v[170:171], v14 offset:42432
  ds_read_b64_tr_b16 v[172:173], v15 offset:41184
  v_mfma_f32_16x16x32_bf16 v[88:91], v[208:211], a[24:27], v[88:91]
  ds_read_b64_tr_b16 v[174:175], v15 offset:42464
  v_mfma_f32_16x16x32_bf16 v[128:131], v[208:211], a[28:31], v[128:131]
  buffer_load_dwordx4 a[104:107], v6, s[16:19], s48 offen offset:0 sc1
  ds_read_b64_tr_b16 v[176:177], v14 offset:41216
  v_mfma_f32_16x16x32_bf16 v[92:95], v[212:215], a[24:27], v[92:95]
  ds_read_b64_tr_b16 v[178:179], v14 offset:42496
  v_mfma_f32_16x16x32_bf16 v[132:135], v[212:215], a[28:31], v[132:135]
  ds_read_b64_tr_b16 v[180:181], v15 offset:41248
  v_mfma_f32_16x16x32_bf16 v[96:99], v[216:219], a[24:27], v[96:99]
  ds_read_b64_tr_b16 v[182:183], v15 offset:42528
  v_mfma_f32_16x16x32_bf16 v[136:139], v[216:219], a[28:31], v[136:139]
  buffer_load_dwordx4 a[108:111], v6, s[16:19], s48 offen offset:128 sc1
  v_mfma_f32_16x16x32_bf16 v[100:103], v[220:223], a[24:27], v[100:103]
  s_add_u32 s48, s48, 132096
  v_mfma_f32_16x16x32_bf16 v[140:143], v[220:223], a[28:31], v[140:143]
  s_waitcnt lgkmcnt(0) vmcnt(48)
  v_mfma_f32_16x16x32_bf16 v[64:67], v[144:147], a[32:35], v[64:67]
  ds_read_b64_tr_b16 v[184:185], v14 offset:51200
  ds_read_b64_tr_b16 v[186:187], v14 offset:52480
  v_mfma_f32_16x16x32_bf16 v[104:107], v[144:147], a[36:39], v[104:107]
  ds_read_b64_tr_b16 v[188:189], v15 offset:51232
  v_mfma_f32_16x16x32_bf16 v[68:71], v[148:151], a[32:35], v[68:71]
  ds_read_b64_tr_b16 v[190:191], v15 offset:52512
  v_mfma_f32_16x16x32_bf16 v[108:111], v[148:151], a[36:39], v[108:111]
  ds_read_b64_tr_b16 v[192:193], v14 offset:51264
  v_mfma_f32_16x16x32_bf16 v[72:75], v[152:155], a[32:35], v[72:75]
  ds_read_b64_tr_b16 v[194:195], v14 offset:52544
  v_mfma_f32_16x16x32_bf16 v[112:115], v[152:155], a[36:39], v[112:115]
  ds_read_b64_tr_b16 v[196:197], v15 offset:51296
  ds_read_b64_tr_b16 v[198:199], v15 offset:52576
  v_mfma_f32_16x16x32_bf16 v[76:79], v[156:159], a[32:35], v[76:79]
  ds_read_b64_tr_b16 v[200:201], v14 offset:51328
  v_mfma_f32_16x16x32_bf16 v[116:119], v[156:159], a[36:39], v[116:119]
  ds_read_b64_tr_b16 v[202:203], v14 offset:52608
  v_mfma_f32_16x16x32_bf16 v[80:83], v[160:163], a[32:35], v[80:83]
  ds_read_b64_tr_b16 v[204:205], v15 offset:51360
  v_mfma_f32_16x16x32_bf16 v[120:123], v[160:163], a[36:39], v[120:123]
  ds_read_b64_tr_b16 v[206:207], v15 offset:52640
  v_mfma_f32_16x16x32_bf16 v[84:87], v[164:167], a[32:35], v[84:87]
  ds_read_b64_tr_b16 v[208:209], v14 offset:51392
  v_mfma_f32_16x16x32_bf16 v[124:127], v[164:167], a[36:39], v[124:127]
  ds_read_b64_tr_b16 v[210:211], v14 offset:52672
  ds_read_b64_tr_b16 v[212:213], v15 offset:51424
  v_mfma_f32_16x16x32_bf16 v[88:91], v[168:171], a[32:35], v[88:91]
  ds_read_b64_tr_b16 v[214:215], v15 offset:52704
  v_mfma_f32_16x16x32_bf16 v[128:131], v[168:171], a[36:39], v[128:131]
  buffer_load_dwordx4 a[112:115], v6, s[16:19], s48 offen offset:0 sc1
  ds_read_b64_tr_b16 v[216:217], v14 offset:51456
  v_mfma_f32_16x16x32_bf16 v[92:95], v[172:175], a[32:35], v[92:95]
  ds_read_b64_tr_b16 v[218:219], v14 offset:52736
  v_mfma_f32_16x16x32_bf16 v[132:135], v[172:175], a[36:39], v[132:135]
  ds_read_b64_tr_b16 v[220:221], v15 offset:51488
  v_mfma_f32_16x16x32_bf16 v[96:99], v[176:179], a[32:35], v[96:99]
  ds_read_b64_tr_b16 v[222:223], v15 offset:52768
  v_mfma_f32_16x16x32_bf16 v[136:139], v[176:179], a[36:39], v[136:139]
  buffer_load_dwordx4 a[116:119], v6, s[16:19], s48 offen offset:128 sc1
  v_mfma_f32_16x16x32_bf16 v[100:103], v[180:183], a[32:35], v[100:103]
  s_add_u32 s48, s48, 132096
  v_mfma_f32_16x16x32_bf16 v[140:143], v[180:183], a[36:39], v[140:143]
  s_waitcnt lgkmcnt(0) vmcnt(43)
  s_barrier
  v_mfma_f32_16x16x32_bf16 v[64:67], v[184:187], a[40:43], v[64:67]
  s_add_u32 m0, s46, 40960
  ds_read_b64_tr_b16 v[144:145], v16 offset:0
  ds_read_b64_tr_b16 v[146:147], v16 offset:1280
  v_mfma_f32_16x16x32_bf16 v[104:107], v[184:187], a[44:47], v[104:107]
  s_add_u32 s49, s45, 737280
  ds_read_b64_tr_b16 v[148:149], v17 offset:32
  v_mfma_f32_16x16x32_bf16 v[68:71], v[188:191], a[40:43], v[68:71]
  buffer_load_dwordx4 v8, s[24:27], s49 offen lds
  ds_read_b64_tr_b16 v[150:151], v17 offset:1312
  v_mfma_f32_16x16x32_bf16 v[108:111], v[188:191], a[44:47], v[108:111]
  s_add_u32 m0, s46, 41984
  ds_read_b64_tr_b16 v[152:153], v16 offset:64
  v_mfma_f32_16x16x32_bf16 v[72:75], v[192:195], a[40:43], v[72:75]
  buffer_load_dwordx4 v9, s[24:27], s49 offen lds
  ds_read_b64_tr_b16 v[154:155], v16 offset:1344
  v_mfma_f32_16x16x32_bf16 v[112:115], v[192:195], a[44:47], v[112:115]
  s_add_u32 m0, s46, 43008
  ds_read_b64_tr_b16 v[156:157], v17 offset:96
  ds_read_b64_tr_b16 v[158:159], v17 offset:1376
  v_mfma_f32_16x16x32_bf16 v[76:79], v[196:199], a[40:43], v[76:79]
  buffer_load_dwordx4 v10, s[24:27], s49 offen lds
  ds_read_b64_tr_b16 v[160:161], v16 offset:128
  v_mfma_f32_16x16x32_bf16 v[116:119], v[196:199], a[44:47], v[116:119]
  s_add_u32 m0, s46, 44032
  ds_read_b64_tr_b16 v[162:163], v16 offset:1408
  v_mfma_f32_16x16x32_bf16 v[80:83], v[200:203], a[40:43], v[80:83]
  buffer_load_dwordx4 v11, s[24:27], s49 offen lds
  ds_read_b64_tr_b16 v[164:165], v17 offset:160
  v_mfma_f32_16x16x32_bf16 v[120:123], v[200:203], a[44:47], v[120:123]
  s_add_u32 m0, s46, 45056
  ds_read_b64_tr_b16 v[166:167], v17 offset:1440
  v_mfma_f32_16x16x32_bf16 v[84:87], v[204:207], a[40:43], v[84:87]
  buffer_load_dwordx4 v12, s[24:27], s49 offen lds
  ds_read_b64_tr_b16 v[168:169], v16 offset:192
  v_mfma_f32_16x16x32_bf16 v[124:127], v[204:207], a[44:47], v[124:127]
  ds_read_b64_tr_b16 v[170:171], v16 offset:1472
  ds_read_b64_tr_b16 v[172:173], v17 offset:224
  v_mfma_f32_16x16x32_bf16 v[88:91], v[208:211], a[40:43], v[88:91]
  ds_read_b64_tr_b16 v[174:175], v17 offset:1504
  v_mfma_f32_16x16x32_bf16 v[128:131], v[208:211], a[44:47], v[128:131]
  buffer_load_dwordx4 a[120:123], v6, s[16:19], s48 offen offset:0 sc1
  ds_read_b64_tr_b16 v[176:177], v16 offset:256
  v_mfma_f32_16x16x32_bf16 v[92:95], v[212:215], a[40:43], v[92:95]
  ds_read_b64_tr_b16 v[178:179], v16 offset:1536
  v_mfma_f32_16x16x32_bf16 v[132:135], v[212:215], a[44:47], v[132:135]
  ds_read_b64_tr_b16 v[180:181], v17 offset:288
  v_mfma_f32_16x16x32_bf16 v[96:99], v[216:219], a[40:43], v[96:99]
  ds_read_b64_tr_b16 v[182:183], v17 offset:1568
  v_mfma_f32_16x16x32_bf16 v[136:139], v[216:219], a[44:47], v[136:139]
  buffer_load_dwordx4 a[124:127], v6, s[16:19], s48 offen offset:128 sc1
  v_mfma_f32_16x16x32_bf16 v[100:103], v[220:223], a[40:43], v[100:103]
  s_add_u32 s48, s48, 132096
  v_mfma_f32_16x16x32_bf16 v[140:143], v[220:223], a[44:47], v[140:143]
  s_waitcnt lgkmcnt(0) vmcnt(48)
  v_mfma_f32_16x16x32_bf16 v[64:67], v[144:147], a[48:51], v[64:67]
  ds_read_b64_tr_b16 v[184:185], v16 offset:10240
  ds_read_b64_tr_b16 v[186:187], v16 offset:11520
  v_mfma_f32_16x16x32_bf16 v[104:107], v[144:147], a[52:55], v[104:107]
  ds_read_b64_tr_b16 v[188:189], v17 offset:10272
  v_mfma_f32_16x16x32_bf16 v[68:71], v[148:151], a[48:51], v[68:71]
  ds_read_b64_tr_b16 v[190:191], v17 offset:11552
  v_mfma_f32_16x16x32_bf16 v[108:111], v[148:151], a[52:55], v[108:111]
  ds_read_b64_tr_b16 v[192:193], v16 offset:10304
  v_mfma_f32_16x16x32_bf16 v[72:75], v[152:155], a[48:51], v[72:75]
  ds_read_b64_tr_b16 v[194:195], v16 offset:11584
  v_mfma_f32_16x16x32_bf16 v[112:115], v[152:155], a[52:55], v[112:115]
  ds_read_b64_tr_b16 v[196:197], v17 offset:10336
  ds_read_b64_tr_b16 v[198:199], v17 offset:11616
  v_mfma_f32_16x16x32_bf16 v[76:79], v[156:159], a[48:51], v[76:79]
  ds_read_b64_tr_b16 v[200:201], v16 offset:10368
  v_mfma_f32_16x16x32_bf16 v[116:119], v[156:159], a[52:55], v[116:119]
  ds_read_b64_tr_b16 v[202:203], v16 offset:11648
  v_mfma_f32_16x16x32_bf16 v[80:83], v[160:163], a[48:51], v[80:83]
  ds_read_b64_tr_b16 v[204:205], v17 offset:10400
  v_mfma_f32_16x16x32_bf16 v[120:123], v[160:163], a[52:55], v[120:123]
  ds_read_b64_tr_b16 v[206:207], v17 offset:11680
  v_mfma_f32_16x16x32_bf16 v[84:87], v[164:167], a[48:51], v[84:87]
  ds_read_b64_tr_b16 v[208:209], v16 offset:10432
  v_mfma_f32_16x16x32_bf16 v[124:127], v[164:167], a[52:55], v[124:127]
  ds_read_b64_tr_b16 v[210:211], v16 offset:11712
  ds_read_b64_tr_b16 v[212:213], v17 offset:10464
  v_mfma_f32_16x16x32_bf16 v[88:91], v[168:171], a[48:51], v[88:91]
  ds_read_b64_tr_b16 v[214:215], v17 offset:11744
  v_mfma_f32_16x16x32_bf16 v[128:131], v[168:171], a[52:55], v[128:131]
  buffer_load_dwordx4 a[128:131], v6, s[16:19], s48 offen offset:0 sc1
  ds_read_b64_tr_b16 v[216:217], v16 offset:10496
  v_mfma_f32_16x16x32_bf16 v[92:95], v[172:175], a[48:51], v[92:95]
  ds_read_b64_tr_b16 v[218:219], v16 offset:11776
  v_mfma_f32_16x16x32_bf16 v[132:135], v[172:175], a[52:55], v[132:135]
  ds_read_b64_tr_b16 v[220:221], v17 offset:10528
  v_mfma_f32_16x16x32_bf16 v[96:99], v[176:179], a[48:51], v[96:99]
  ds_read_b64_tr_b16 v[222:223], v17 offset:11808
  v_mfma_f32_16x16x32_bf16 v[136:139], v[176:179], a[52:55], v[136:139]
  buffer_load_dwordx4 a[132:135], v6, s[16:19], s48 offen offset:128 sc1
  v_mfma_f32_16x16x32_bf16 v[100:103], v[180:183], a[48:51], v[100:103]
  s_add_u32 s48, s48, 132096
  v_mfma_f32_16x16x32_bf16 v[140:143], v[180:183], a[52:55], v[140:143]
  s_waitcnt lgkmcnt(0) vmcnt(43)
  s_barrier
  v_mfma_f32_16x16x32_bf16 v[64:67], v[184:187], a[56:59], v[64:67]
  ds_read_b64_tr_b16 v[144:145], v16 offset:20480
  ds_read_b64_tr_b16 v[146:147], v16 offset:21760
  v_mfma_f32_16x16x32_bf16 v[104:107], v[184:187], a[60:63], v[104:107]
  ds_read_b64_tr_b16 v[148:149], v17 offset:20512
  v_mfma_f32_16x16x32_bf16 v[68:71], v[188:191], a[56:59], v[68:71]
  ds_read_b64_tr_b16 v[150:151], v17 offset:21792
  v_mfma_f32_16x16x32_bf16 v[108:111], v[188:191], a[60:63], v[108:111]
  ds_read_b64_tr_b16 v[152:153], v16 offset:20544
  v_mfma_f32_16x16x32_bf16 v[72:75], v[192:195], a[56:59], v[72:75]
  ds_read_b64_tr_b16 v[154:155], v16 offset:21824
  v_mfma_f32_16x16x32_bf16 v[112:115], v[192:195], a[60:63], v[112:115]
  ds_read_b64_tr_b16 v[156:157], v17 offset:20576
  ds_read_b64_tr_b16 v[158:159], v17 offset:21856
  v_mfma_f32_16x16x32_bf16 v[76:79], v[196:199], a[56:59], v[76:79]
  ds_read_b64_tr_b16 v[160:161], v16 offset:20608
  v_mfma_f32_16x16x32_bf16 v[116:119], v[196:199], a[60:63], v[116:119]
  ds_read_b64_tr_b16 v[162:163], v16 offset:21888
  v_mfma_f32_16x16x32_bf16 v[80:83], v[200:203], a[56:59], v[80:83]
  ds_read_b64_tr_b16 v[164:165], v17 offset:20640
  v_mfma_f32_16x16x32_bf16 v[120:123], v[200:203], a[60:63], v[120:123]
  ds_read_b64_tr_b16 v[166:167], v17 offset:21920
  v_mfma_f32_16x16x32_bf16 v[84:87], v[204:207], a[56:59], v[84:87]
  ds_read_b64_tr_b16 v[168:169], v16 offset:20672
  v_mfma_f32_16x16x32_bf16 v[124:127], v[204:207], a[60:63], v[124:127]
  ds_read_b64_tr_b16 v[170:171], v16 offset:21952
  ds_read_b64_tr_b16 v[172:173], v17 offset:20704
  v_mfma_f32_16x16x32_bf16 v[88:91], v[208:211], a[56:59], v[88:91]
  ds_read_b64_tr_b16 v[174:175], v17 offset:21984
  v_mfma_f32_16x16x32_bf16 v[128:131], v[208:211], a[60:63], v[128:131]
  buffer_load_dwordx4 a[136:139], v6, s[16:19], s48 offen offset:0 sc1
  ds_read_b64_tr_b16 v[176:177], v16 offset:20736
  v_mfma_f32_16x16x32_bf16 v[92:95], v[212:215], a[56:59], v[92:95]
  ds_read_b64_tr_b16 v[178:179], v16 offset:22016
  v_mfma_f32_16x16x32_bf16 v[132:135], v[212:215], a[60:63], v[132:135]
  ds_read_b64_tr_b16 v[180:181], v17 offset:20768
  v_mfma_f32_16x16x32_bf16 v[96:99], v[216:219], a[56:59], v[96:99]
  ds_read_b64_tr_b16 v[182:183], v17 offset:22048
  v_mfma_f32_16x16x32_bf16 v[136:139], v[216:219], a[60:63], v[136:139]
  buffer_load_dwordx4 a[140:143], v6, s[16:19], s48 offen offset:128 sc1
  v_mfma_f32_16x16x32_bf16 v[100:103], v[220:223], a[56:59], v[100:103]
  s_add_u32 s48, s48, 132096
  v_mfma_f32_16x16x32_bf16 v[140:143], v[220:223], a[60:63], v[140:143]
  s_waitcnt lgkmcnt(0) vmcnt(43)
  v_mfma_f32_16x16x32_bf16 v[64:67], v[144:147], a[64:67], v[64:67]
  ds_read_b64_tr_b16 v[184:185], v16 offset:30720
  ds_read_b64_tr_b16 v[186:187], v16 offset:32000
  v_mfma_f32_16x16x32_bf16 v[104:107], v[144:147], a[68:71], v[104:107]
  ds_read_b64_tr_b16 v[188:189], v17 offset:30752
  v_mfma_f32_16x16x32_bf16 v[68:71], v[148:151], a[64:67], v[68:71]
  ds_read_b64_tr_b16 v[190:191], v17 offset:32032
  v_mfma_f32_16x16x32_bf16 v[108:111], v[148:151], a[68:71], v[108:111]
  ds_read_b64_tr_b16 v[192:193], v16 offset:30784
  v_mfma_f32_16x16x32_bf16 v[72:75], v[152:155], a[64:67], v[72:75]
  ds_read_b64_tr_b16 v[194:195], v16 offset:32064
  v_mfma_f32_16x16x32_bf16 v[112:115], v[152:155], a[68:71], v[112:115]
  ds_read_b64_tr_b16 v[196:197], v17 offset:30816
  ds_read_b64_tr_b16 v[198:199], v17 offset:32096
  v_mfma_f32_16x16x32_bf16 v[76:79], v[156:159], a[64:67], v[76:79]
  ds_read_b64_tr_b16 v[200:201], v16 offset:30848
  v_mfma_f32_16x16x32_bf16 v[116:119], v[156:159], a[68:71], v[116:119]
  ds_read_b64_tr_b16 v[202:203], v16 offset:32128
  v_mfma_f32_16x16x32_bf16 v[80:83], v[160:163], a[64:67], v[80:83]
  ds_read_b64_tr_b16 v[204:205], v17 offset:30880
  v_mfma_f32_16x16x32_bf16 v[120:123], v[160:163], a[68:71], v[120:123]
  ds_read_b64_tr_b16 v[206:207], v17 offset:32160
  v_mfma_f32_16x16x32_bf16 v[84:87], v[164:167], a[64:67], v[84:87]
  ds_read_b64_tr_b16 v[208:209], v16 offset:30912
  v_mfma_f32_16x16x32_bf16 v[124:127], v[164:167], a[68:71], v[124:127]
  ds_read_b64_tr_b16 v[210:211], v16 offset:32192
  ds_read_b64_tr_b16 v[212:213], v17 offset:30944
  v_mfma_f32_16x16x32_bf16 v[88:91], v[168:171], a[64:67], v[88:91]
  ds_read_b64_tr_b16 v[214:215], v17 offset:32224
  v_mfma_f32_16x16x32_bf16 v[128:131], v[168:171], a[68:71], v[128:131]
  buffer_load_dwordx4 a[144:147], v6, s[16:19], s48 offen offset:0 sc1
  ds_read_b64_tr_b16 v[216:217], v16 offset:30976
  v_mfma_f32_16x16x32_bf16 v[92:95], v[172:175], a[64:67], v[92:95]
  ds_read_b64_tr_b16 v[218:219], v16 offset:32256
  v_mfma_f32_16x16x32_bf16 v[132:135], v[172:175], a[68:71], v[132:135]
  ds_read_b64_tr_b16 v[220:221], v17 offset:31008
  v_mfma_f32_16x16x32_bf16 v[96:99], v[176:179], a[64:67], v[96:99]
  ds_read_b64_tr_b16 v[222:223], v17 offset:32288
  v_mfma_f32_16x16x32_bf16 v[136:139], v[176:179], a[68:71], v[136:139]
  buffer_load_dwordx4 a[148:151], v6, s[16:19], s48 offen offset:128 sc1
  v_mfma_f32_16x16x32_bf16 v[100:103], v[180:183], a[64:67], v[100:103]
  s_add_u32 s48, s48, 132096
  v_mfma_f32_16x16x32_bf16 v[140:143], v[180:183], a[68:71], v[140:143]
  s_waitcnt lgkmcnt(0) vmcnt(38)
  s_barrier
  v_mfma_f32_16x16x32_bf16 v[64:67], v[184:187], a[72:75], v[64:67]
  ds_read_b64_tr_b16 v[144:145], v16 offset:40960
  ds_read_b64_tr_b16 v[146:147], v16 offset:42240
  v_mfma_f32_16x16x32_bf16 v[104:107], v[184:187], a[76:79], v[104:107]
  ds_read_b64_tr_b16 v[148:149], v17 offset:40992
  v_mfma_f32_16x16x32_bf16 v[68:71], v[188:191], a[72:75], v[68:71]
  ds_read_b64_tr_b16 v[150:151], v17 offset:42272
  v_mfma_f32_16x16x32_bf16 v[108:111], v[188:191], a[76:79], v[108:111]
  ds_read_b64_tr_b16 v[152:153], v16 offset:41024
  v_mfma_f32_16x16x32_bf16 v[72:75], v[192:195], a[72:75], v[72:75]
  ds_read_b64_tr_b16 v[154:155], v16 offset:42304
  v_mfma_f32_16x16x32_bf16 v[112:115], v[192:195], a[76:79], v[112:115]
  ds_read_b64_tr_b16 v[156:157], v17 offset:41056
  ds_read_b64_tr_b16 v[158:159], v17 offset:42336
  v_mfma_f32_16x16x32_bf16 v[76:79], v[196:199], a[72:75], v[76:79]
  ds_read_b64_tr_b16 v[160:161], v16 offset:41088
  v_mfma_f32_16x16x32_bf16 v[116:119], v[196:199], a[76:79], v[116:119]
  ds_read_b64_tr_b16 v[162:163], v16 offset:42368
  v_mfma_f32_16x16x32_bf16 v[80:83], v[200:203], a[72:75], v[80:83]
  ds_read_b64_tr_b16 v[164:165], v17 offset:41120
  v_mfma_f32_16x16x32_bf16 v[120:123], v[200:203], a[76:79], v[120:123]
  ds_read_b64_tr_b16 v[166:167], v17 offset:42400
  v_mfma_f32_16x16x32_bf16 v[84:87], v[204:207], a[72:75], v[84:87]
  ds_read_b64_tr_b16 v[168:169], v16 offset:41152
  v_mfma_f32_16x16x32_bf16 v[124:127], v[204:207], a[76:79], v[124:127]
  ds_read_b64_tr_b16 v[170:171], v16 offset:42432
  ds_read_b64_tr_b16 v[172:173], v17 offset:41184
  v_mfma_f32_16x16x32_bf16 v[88:91], v[208:211], a[72:75], v[88:91]
  ds_read_b64_tr_b16 v[174:175], v17 offset:42464
  v_mfma_f32_16x16x32_bf16 v[128:131], v[208:211], a[76:79], v[128:131]
  buffer_load_dwordx4 a[152:155], v6, s[16:19], s48 offen offset:0 sc1
  ds_read_b64_tr_b16 v[176:177], v16 offset:41216
  v_mfma_f32_16x16x32_bf16 v[92:95], v[212:215], a[72:75], v[92:95]
  ds_read_b64_tr_b16 v[178:179], v16 offset:42496
  v_mfma_f32_16x16x32_bf16 v[132:135], v[212:215], a[76:79], v[132:135]
  ds_read_b64_tr_b16 v[180:181], v17 offset:41248
  v_mfma_f32_16x16x32_bf16 v[96:99], v[216:219], a[72:75], v[96:99]
  ds_read_b64_tr_b16 v[182:183], v17 offset:42528
  v_mfma_f32_16x16x32_bf16 v[136:139], v[216:219], a[76:79], v[136:139]
  buffer_load_dwordx4 a[156:159], v6, s[16:19], s48 offen offset:128 sc1
  v_mfma_f32_16x16x32_bf16 v[100:103], v[220:223], a[72:75], v[100:103]
  s_add_u32 s48, s48, 132096
  v_mfma_f32_16x16x32_bf16 v[140:143], v[220:223], a[76:79], v[140:143]
  s_waitcnt lgkmcnt(0) vmcnt(33)
  v_mfma_f32_16x16x32_bf16 v[64:67], v[144:147], a[80:83], v[64:67]
  ds_read_b64_tr_b16 v[184:185], v16 offset:51200
  ds_read_b64_tr_b16 v[186:187], v16 offset:52480
  v_mfma_f32_16x16x32_bf16 v[104:107], v[144:147], a[84:87], v[104:107]
  ds_read_b64_tr_b16 v[188:189], v17 offset:51232
  v_mfma_f32_16x16x32_bf16 v[68:71], v[148:151], a[80:83], v[68:71]
  ds_read_b64_tr_b16 v[190:191], v17 offset:52512
  v_mfma_f32_16x16x32_bf16 v[108:111], v[148:151], a[84:87], v[108:111]
  ds_read_b64_tr_b16 v[192:193], v16 offset:51264
  v_mfma_f32_16x16x32_bf16 v[72:75], v[152:155], a[80:83], v[72:75]
  ds_read_b64_tr_b16 v[194:195], v16 offset:52544
  v_mfma_f32_16x16x32_bf16 v[112:115], v[152:155], a[84:87], v[112:115]
  ds_read_b64_tr_b16 v[196:197], v17 offset:51296
  ds_read_b64_tr_b16 v[198:199], v17 offset:52576
  v_mfma_f32_16x16x32_bf16 v[76:79], v[156:159], a[80:83], v[76:79]
  ds_read_b64_tr_b16 v[200:201], v16 offset:51328
  v_mfma_f32_16x16x32_bf16 v[116:119], v[156:159], a[84:87], v[116:119]
  ds_read_b64_tr_b16 v[202:203], v16 offset:52608
  v_mfma_f32_16x16x32_bf16 v[80:83], v[160:163], a[80:83], v[80:83]
  ds_read_b64_tr_b16 v[204:205], v17 offset:51360
  v_mfma_f32_16x16x32_bf16 v[120:123], v[160:163], a[84:87], v[120:123]
  ds_read_b64_tr_b16 v[206:207], v17 offset:52640
  v_mfma_f32_16x16x32_bf16 v[84:87], v[164:167], a[80:83], v[84:87]
  ds_read_b64_tr_b16 v[208:209], v16 offset:51392
  v_mfma_f32_16x16x32_bf16 v[124:127], v[164:167], a[84:87], v[124:127]
  ds_read_b64_tr_b16 v[210:211], v16 offset:52672
  ds_read_b64_tr_b16 v[212:213], v17 offset:51424
  v_mfma_f32_16x16x32_bf16 v[88:91], v[168:171], a[80:83], v[88:91]
  ds_read_b64_tr_b16 v[214:215], v17 offset:52704
  v_mfma_f32_16x16x32_bf16 v[128:131], v[168:171], a[84:87], v[128:131]
  buffer_load_dwordx4 v[52:55], v4, s[12:15], 0 offen
  ds_read_b64_tr_b16 v[216:217], v16 offset:51456
  v_mfma_f32_16x16x32_bf16 v[92:95], v[172:175], a[80:83], v[92:95]
  ds_read_b64_tr_b16 v[218:219], v16 offset:52736
  v_mfma_f32_16x16x32_bf16 v[132:135], v[172:175], a[84:87], v[132:135]
  ds_read_b64_tr_b16 v[220:221], v17 offset:51488
  v_mfma_f32_16x16x32_bf16 v[96:99], v[176:179], a[80:83], v[96:99]
  ds_read_b64_tr_b16 v[222:223], v17 offset:52768
  v_mfma_f32_16x16x32_bf16 v[136:139], v[176:179], a[84:87], v[136:139]
  buffer_load_dword v56, v5, s[12:15], 0 offen offset:1024
  v_mfma_f32_16x16x32_bf16 v[100:103], v[180:183], a[80:83], v[100:103]
  s_mul_i32 s50, s59, 1280
  v_mfma_f32_16x16x32_bf16 v[140:143], v[180:183], a[84:87], v[140:143]
  s_waitcnt lgkmcnt(0) vmcnt(28)
  s_barrier
  v_mfma_f32_16x16x32_bf16 v[64:67], v[184:187], a[88:91], v[64:67]
  ds_read_b64_tr_b16 v[144:145], v18 offset:0
  ds_read_b64_tr_b16 v[146:147], v18 offset:1280
  v_mfma_f32_16x16x32_bf16 v[104:107], v[184:187], a[92:95], v[104:107]
  ds_read_b64_tr_b16 v[148:149], v19 offset:32
  v_mfma_f32_16x16x32_bf16 v[68:71], v[188:191], a[88:91], v[68:71]
  ds_read_b64_tr_b16 v[150:151], v19 offset:1312
  v_mfma_f32_16x16x32_bf16 v[108:111], v[188:191], a[92:95], v[108:111]
  ds_read_b64_tr_b16 v[152:153], v18 offset:64
  v_mfma_f32_16x16x32_bf16 v[72:75], v[192:195], a[88:91], v[72:75]
  ds_read_b64_tr_b16 v[154:155], v18 offset:1344
  v_mfma_f32_16x16x32_bf16 v[112:115], v[192:195], a[92:95], v[112:115]
  ds_read_b64_tr_b16 v[156:157], v19 offset:96
  ds_read_b64_tr_b16 v[158:159], v19 offset:1376
  v_mfma_f32_16x16x32_bf16 v[76:79], v[196:199], a[88:91], v[76:79]
  ds_read_b64_tr_b16 v[160:161], v18 offset:128
  v_mfma_f32_16x16x32_bf16 v[116:119], v[196:199], a[92:95], v[116:119]
  ds_read_b64_tr_b16 v[162:163], v18 offset:1408
  v_mfma_f32_16x16x32_bf16 v[80:83], v[200:203], a[88:91], v[80:83]
  ds_read_b64_tr_b16 v[164:165], v19 offset:160
  v_mfma_f32_16x16x32_bf16 v[120:123], v[200:203], a[92:95], v[120:123]
  ds_read_b64_tr_b16 v[166:167], v19 offset:1440
  v_mfma_f32_16x16x32_bf16 v[84:87], v[204:207], a[88:91], v[84:87]
  ds_read_b64_tr_b16 v[168:169], v18 offset:192
  v_mfma_f32_16x16x32_bf16 v[124:127], v[204:207], a[92:95], v[124:127]
  ds_read_b64_tr_b16 v[170:171], v18 offset:1472
  ds_read_b64_tr_b16 v[172:173], v19 offset:224
  v_mfma_f32_16x16x32_bf16 v[88:91], v[208:211], a[88:91], v[88:91]
  ds_read_b64_tr_b16 v[174:175], v19 offset:1504
  v_mfma_f32_16x16x32_bf16 v[128:131], v[208:211], a[92:95], v[128:131]
  buffer_load_dwordx4 v[224:227], v4, s[8:11], s50 offen
  ds_read_b64_tr_b16 v[176:177], v18 offset:256
  v_mfma_f32_16x16x32_bf16 v[92:95], v[212:215], a[88:91], v[92:95]
  ds_read_b64_tr_b16 v[178:179], v18 offset:1536
  v_mfma_f32_16x16x32_bf16 v[132:135], v[212:215], a[92:95], v[132:135]
  ds_read_b64_tr_b16 v[180:181], v19 offset:288
  v_mfma_f32_16x16x32_bf16 v[96:99], v[216:219], a[88:91], v[96:99]
  ds_read_b64_tr_b16 v[182:183], v19 offset:1568
  v_mfma_f32_16x16x32_bf16 v[136:139], v[216:219], a[92:95], v[136:139]
  buffer_load_dword v228, v5, s[8:11], s50 offen offset:1024
  v_mfma_f32_16x16x32_bf16 v[100:103], v[220:223], a[88:91], v[100:103]
  s_add_u32 s50, s50, 1280
  v_mfma_f32_16x16x32_bf16 v[140:143], v[220:223], a[92:95], v[140:143]
  s_waitcnt lgkmcnt(0) vmcnt(28)
  v_mfma_f32_16x16x32_bf16 v[64:67], v[144:147], a[96:99], v[64:67]
  ds_read_b64_tr_b16 v[184:185], v18 offset:10240
  ds_read_b64_tr_b16 v[186:187], v18 offset:11520
  v_mfma_f32_16x16x32_bf16 v[104:107], v[144:147], a[100:103], v[104:107]
  ds_read_b64_tr_b16 v[188:189], v19 offset:10272
  v_mfma_f32_16x16x32_bf16 v[68:71], v[148:151], a[96:99], v[68:71]
  ds_read_b64_tr_b16 v[190:191], v19 offset:11552
  v_mfma_f32_16x16x32_bf16 v[108:111], v[148:151], a[100:103], v[108:111]
  ds_read_b64_tr_b16 v[192:193], v18 offset:10304
  v_mfma_f32_16x16x32_bf16 v[72:75], v[152:155], a[96:99], v[72:75]
  ds_read_b64_tr_b16 v[194:195], v18 offset:11584
  v_mfma_f32_16x16x32_bf16 v[112:115], v[152:155], a[100:103], v[112:115]
  ds_read_b64_tr_b16 v[196:197], v19 offset:10336
  ds_read_b64_tr_b16 v[198:199], v19 offset:11616
  v_mfma_f32_16x16x32_bf16 v[76:79], v[156:159], a[96:99], v[76:79]
  ds_read_b64_tr_b16 v[200:201], v18 offset:10368
  v_mfma_f32_16x16x32_bf16 v[116:119], v[156:159], a[100:103], v[116:119]
  ds_read_b64_tr_b16 v[202:203], v18 offset:11648
  v_mfma_f32_16x16x32_bf16 v[80:83], v[160:163], a[96:99], v[80:83]
  ds_read_b64_tr_b16 v[204:205], v19 offset:10400
  v_mfma_f32_16x16x32_bf16 v[120:123], v[160:163], a[100:103], v[120:123]
  ds_read_b64_tr_b16 v[206:207], v19 offset:11680
  v_mfma_f32_16x16x32_bf16 v[84:87], v[164:167], a[96:99], v[84:87]
  ds_read_b64_tr_b16 v[208:209], v18 offset:10432
  v_mfma_f32_16x16x32_bf16 v[124:127], v[164:167], a[100:103], v[124:127]
  ds_read_b64_tr_b16 v[210:211], v18 offset:11712
  ds_read_b64_tr_b16 v[212:213], v19 offset:10464
  v_mfma_f32_16x16x32_bf16 v[88:91], v[168:171], a[96:99], v[88:91]
  ds_read_b64_tr_b16 v[214:215], v19 offset:11744
  v_mfma_f32_16x16x32_bf16 v[128:131], v[168:171], a[100:103], v[128:131]
  buffer_load_dwordx4 v[230:233], v4, s[8:11], s50 offen
  ds_read_b64_tr_b16 v[216:217], v18 offset:10496
  v_mfma_f32_16x16x32_bf16 v[92:95], v[172:175], a[96:99], v[92:95]
  ds_read_b64_tr_b16 v[218:219], v18 offset:11776
  v_mfma_f32_16x16x32_bf16 v[132:135], v[172:175], a[100:103], v[132:135]
  ds_read_b64_tr_b16 v[220:221], v19 offset:10528
  v_mfma_f32_16x16x32_bf16 v[96:99], v[176:179], a[96:99], v[96:99]
  ds_read_b64_tr_b16 v[222:223], v19 offset:11808
  v_mfma_f32_16x16x32_bf16 v[136:139], v[176:179], a[100:103], v[136:139]
  buffer_load_dword v234, v5, s[8:11], s50 offen offset:1024
  v_mfma_f32_16x16x32_bf16 v[100:103], v[180:183], a[96:99], v[100:103]
  s_add_u32 s50, s50, 1280
  v_mfma_f32_16x16x32_bf16 v[140:143], v[180:183], a[100:103], v[140:143]
  s_waitcnt lgkmcnt(0) vmcnt(23)
  s_barrier
  v_mfma_f32_16x16x32_bf16 v[64:67], v[184:187], a[104:107], v[64:67]
  ds_read_b64_tr_b16 v[144:145], v14 offset:0
  ds_read_b64_tr_b16 v[146:147], v14 offset:1280
  v_mfma_f32_16x16x32_bf16 v[104:107], v[184:187], a[108:111], v[104:107]
  ds_read_b64_tr_b16 v[148:149], v15 offset:32
  v_mfma_f32_16x16x32_bf16 v[68:71], v[188:191], a[104:107], v[68:71]
  ds_read_b64_tr_b16 v[150:151], v15 offset:1312
  v_mfma_f32_16x16x32_bf16 v[108:111], v[188:191], a[108:111], v[108:111]
  ds_read_b64_tr_b16 v[152:153], v14 offset:64
  v_mfma_f32_16x16x32_bf16 v[72:75], v[192:195], a[104:107], v[72:75]
  ds_read_b64_tr_b16 v[154:155], v14 offset:1344
  v_mfma_f32_16x16x32_bf16 v[112:115], v[192:195], a[108:111], v[112:115]
  ds_read_b64_tr_b16 v[156:157], v15 offset:96
  ds_read_b64_tr_b16 v[158:159], v15 offset:1376
  v_mfma_f32_16x16x32_bf16 v[76:79], v[196:199], a[104:107], v[76:79]
  ds_read_b64_tr_b16 v[160:161], v14 offset:128
  v_mfma_f32_16x16x32_bf16 v[116:119], v[196:199], a[108:111], v[116:119]
  ds_read_b64_tr_b16 v[162:163], v14 offset:1408
  v_mfma_f32_16x16x32_bf16 v[80:83], v[200:203], a[104:107], v[80:83]
  ds_read_b64_tr_b16 v[164:165], v15 offset:160
  v_mfma_f32_16x16x32_bf16 v[120:123], v[200:203], a[108:111], v[120:123]
  ds_read_b64_tr_b16 v[166:167], v15 offset:1440
  v_mfma_f32_16x16x32_bf16 v[84:87], v[204:207], a[104:107], v[84:87]
  ds_read_b64_tr_b16 v[168:169], v14 offset:192
  v_mfma_f32_16x16x32_bf16 v[124:127], v[204:207], a[108:111], v[124:127]
  ds_read_b64_tr_b16 v[170:171], v14 offset:1472
  ds_read_b64_tr_b16 v[172:173], v15 offset:224
  v_mfma_f32_16x16x32_bf16 v[88:91], v[208:211], a[104:107], v[88:91]
  ds_read_b64_tr_b16 v[174:175], v15 offset:1504
  v_mfma_f32_16x16x32_bf16 v[128:131], v[208:211], a[108:111], v[128:131]
  buffer_load_dwordx4 v[236:239], v4, s[8:11], s50 offen
  ds_read_b64_tr_b16 v[176:177], v14 offset:256
  v_mfma_f32_16x16x32_bf16 v[92:95], v[212:215], a[104:107], v[92:95]
  ds_read_b64_tr_b16 v[178:179], v14 offset:1536
  v_mfma_f32_16x16x32_bf16 v[132:135], v[212:215], a[108:111], v[132:135]
  ds_read_b64_tr_b16 v[180:181], v15 offset:288
  v_mfma_f32_16x16x32_bf16 v[96:99], v[216:219], a[104:107], v[96:99]
  ds_read_b64_tr_b16 v[182:183], v15 offset:1568
  v_mfma_f32_16x16x32_bf16 v[136:139], v[216:219], a[108:111], v[136:139]
  buffer_load_dword v240, v5, s[8:11], s50 offen offset:1024
  v_mfma_f32_16x16x32_bf16 v[100:103], v[220:223], a[104:107], v[100:103]
  s_add_u32 s50, s50, 1280
  v_mfma_f32_16x16x32_bf16 v[140:143], v[220:223], a[108:111], v[140:143]
  s_waitcnt lgkmcnt(0) vmcnt(23)
  v_mfma_f32_16x16x32_bf16 v[64:67], v[144:147], a[112:115], v[64:67]
  ds_read_b64_tr_b16 v[184:185], v14 offset:10240
  ds_read_b64_tr_b16 v[186:187], v14 offset:11520
  v_mfma_f32_16x16x32_bf16 v[104:107], v[144:147], a[116:119], v[104:107]
  ds_read_b64_tr_b16 v[188:189], v15 offset:10272
  v_mfma_f32_16x16x32_bf16 v[68:71], v[148:151], a[112:115], v[68:71]
  ds_read_b64_tr_b16 v[190:191], v15 offset:11552
  v_mfma_f32_16x16x32_bf16 v[108:111], v[148:151], a[116:119], v[108:111]
  ds_read_b64_tr_b16 v[192:193], v14 offset:10304
  v_mfma_f32_16x16x32_bf16 v[72:75], v[152:155], a[112:115], v[72:75]
  ds_read_b64_tr_b16 v[194:195], v14 offset:11584
  v_mfma_f32_16x16x32_bf16 v[112:115], v[152:155], a[116:119], v[112:115]
  ds_read_b64_tr_b16 v[196:197], v15 offset:10336
  ds_read_b64_tr_b16 v[198:199], v15 offset:11616
  v_mfma_f32_16x16x32_bf16 v[76:79], v[156:159], a[112:115], v[76:79]
  ds_read_b64_tr_b16 v[200:201], v14 offset:10368
  v_mfma_f32_16x16x32_bf16 v[116:119], v[156:159], a[116:119], v[116:119]
  ds_read_b64_tr_b16 v[202:203], v14 offset:11648
  v_mfma_f32_16x16x32_bf16 v[80:83], v[160:163], a[112:115], v[80:83]
  ds_read_b64_tr_b16 v[204:205], v15 offset:10400
  v_mfma_f32_16x16x32_bf16 v[120:123], v[160:163], a[116:119], v[120:123]
  ds_read_b64_tr_b16 v[206:207], v15 offset:11680
  v_mfma_f32_16x16x32_bf16 v[84:87], v[164:167], a[112:115], v[84:87]
  ds_read_b64_tr_b16 v[208:209], v14 offset:10432
  v_mfma_f32_16x16x32_bf16 v[124:127], v[164:167], a[116:119], v[124:127]
  ds_read_b64_tr_b16 v[210:211], v14 offset:11712
  ds_read_b64_tr_b16 v[212:213], v15 offset:10464
  v_mfma_f32_16x16x32_bf16 v[88:91], v[168:171], a[112:115], v[88:91]
  ds_read_b64_tr_b16 v[214:215], v15 offset:11744
  v_mfma_f32_16x16x32_bf16 v[128:131], v[168:171], a[116:119], v[128:131]
  buffer_load_dwordx4 v[242:245], v4, s[8:11], s50 offen
  ds_read_b64_tr_b16 v[216:217], v14 offset:10496
  v_mfma_f32_16x16x32_bf16 v[92:95], v[172:175], a[112:115], v[92:95]
  ds_read_b64_tr_b16 v[218:219], v14 offset:11776
  v_mfma_f32_16x16x32_bf16 v[132:135], v[172:175], a[116:119], v[132:135]
  ds_read_b64_tr_b16 v[220:221], v15 offset:10528
  v_mfma_f32_16x16x32_bf16 v[96:99], v[176:179], a[112:115], v[96:99]
  ds_read_b64_tr_b16 v[222:223], v15 offset:11808
  v_mfma_f32_16x16x32_bf16 v[136:139], v[176:179], a[116:119], v[136:139]
  buffer_load_dword v246, v5, s[8:11], s50 offen offset:1024
  v_mfma_f32_16x16x32_bf16 v[100:103], v[180:183], a[112:115], v[100:103]
  s_add_u32 s50, s50, 1280
  v_mfma_f32_16x16x32_bf16 v[140:143], v[180:183], a[116:119], v[140:143]
  s_waitcnt lgkmcnt(0) vmcnt(18)
  s_barrier
  v_mfma_f32_16x16x32_bf16 v[64:67], v[184:187], a[120:123], v[64:67]
  ds_read_b64_tr_b16 v[144:145], v14 offset:20480
  ds_read_b64_tr_b16 v[146:147], v14 offset:21760
  v_mfma_f32_16x16x32_bf16 v[104:107], v[184:187], a[124:127], v[104:107]
  ds_read_b64_tr_b16 v[148:149], v15 offset:20512
  v_mfma_f32_16x16x32_bf16 v[68:71], v[188:191], a[120:123], v[68:71]
  ds_read_b64_tr_b16 v[150:151], v15 offset:21792
  v_mfma_f32_16x16x32_bf16 v[108:111], v[188:191], a[124:127], v[108:111]
  ds_read_b64_tr_b16 v[152:153], v14 offset:20544
  v_mfma_f32_16x16x32_bf16 v[72:75], v[192:195], a[120:123], v[72:75]
  ds_read_b64_tr_b16 v[154:155], v14 offset:21824
  v_mfma_f32_16x16x32_bf16 v[112:115], v[192:195], a[124:127], v[112:115]
  ds_read_b64_tr_b16 v[156:157], v15 offset:20576
  ds_read_b64_tr_b16 v[158:159], v15 offset:21856
  v_mfma_f32_16x16x32_bf16 v[76:79], v[196:199], a[120:123], v[76:79]
  ds_read_b64_tr_b16 v[160:161], v14 offset:20608
  v_mfma_f32_16x16x32_bf16 v[116:119], v[196:199], a[124:127], v[116:119]
  ds_read_b64_tr_b16 v[162:163], v14 offset:21888
  v_mfma_f32_16x16x32_bf16 v[80:83], v[200:203], a[120:123], v[80:83]
  ds_read_b64_tr_b16 v[164:165], v15 offset:20640
  v_mfma_f32_16x16x32_bf16 v[120:123], v[200:203], a[124:127], v[120:123]
  ds_read_b64_tr_b16 v[166:167], v15 offset:21920
  v_mfma_f32_16x16x32_bf16 v[84:87], v[204:207], a[120:123], v[84:87]
  ds_read_b64_tr_b16 v[168:169], v14 offset:20672
  v_mfma_f32_16x16x32_bf16 v[124:127], v[204:207], a[124:127], v[124:127]
  ds_read_b64_tr_b16 v[170:171], v14 offset:21952
  ds_read_b64_tr_b16 v[172:173], v15 offset:20704
  v_mfma_f32_16x16x32_bf16 v[88:91], v[208:211], a[120:123], v[88:91]
  ds_read_b64_tr_b16 v[174:175], v15 offset:21984
  v_mfma_f32_16x16x32_bf16 v[128:131], v[208:211], a[124:127], v[128:131]
  buffer_load_dwordx4 v[248:251], v4, s[8:11], s50 offen
  ds_read_b64_tr_b16 v[176:177], v14 offset:20736
  v_mfma_f32_16x16x32_bf16 v[92:95], v[212:215], a[120:123], v[92:95]
  ds_read_b64_tr_b16 v[178:179], v14 offset:22016
  v_mfma_f32_16x16x32_bf16 v[132:135], v[212:215], a[124:127], v[132:135]
  ds_read_b64_tr_b16 v[180:181], v15 offset:20768
  v_mfma_f32_16x16x32_bf16 v[96:99], v[216:219], a[120:123], v[96:99]
  ds_read_b64_tr_b16 v[182:183], v15 offset:22048
  v_mfma_f32_16x16x32_bf16 v[136:139], v[216:219], a[124:127], v[136:139]
  buffer_load_dword v252, v5, s[8:11], s50 offen offset:1024
  v_mfma_f32_16x16x32_bf16 v[100:103], v[220:223], a[120:123], v[100:103]
  s_add_u32 s50, s50, 1280
  v_mfma_f32_16x16x32_bf16 v[140:143], v[220:223], a[124:127], v[140:143]
  s_waitcnt lgkmcnt(0) vmcnt(18)
  v_mfma_f32_16x16x32_bf16 v[64:67], v[144:147], a[128:131], v[64:67]
  ds_read_b64_tr_b16 v[184:185], v14 offset:30720
  ds_read_b64_tr_b16 v[186:187], v14 offset:32000
  v_mfma_f32_16x16x32_bf16 v[104:107], v[144:147], a[132:135], v[104:107]
  ds_read_b64_tr_b16 v[188:189], v15 offset:30752
  v_mfma_f32_16x16x32_bf16 v[68:71], v[148:151], a[128:131], v[68:71]
  ds_read_b64_tr_b16 v[190:191], v15 offset:32032
  v_mfma_f32_16x16x32_bf16 v[108:111], v[148:151], a[132:135], v[108:111]
  ds_read_b64_tr_b16 v[192:193], v14 offset:30784
  v_mfma_f32_16x16x32_bf16 v[72:75], v[152:155], a[128:131], v[72:75]
  ds_read_b64_tr_b16 v[194:195], v14 offset:32064
  v_mfma_f32_16x16x32_bf16 v[112:115], v[152:155], a[132:135], v[112:115]
  ds_read_b64_tr_b16 v[196:197], v15 offset:30816
  ds_read_b64_tr_b16 v[198:199], v15 offset:32096
  v_mfma_f32_16x16x32_bf16 v[76:79], v[156:159], a[128:131], v[76:79]
  ds_read_b64_tr_b16 v[200:201], v14 offset:30848
  v_mfma_f32_16x16x32_bf16 v[116:119], v[156:159], a[132:135], v[116:119]
  ds_read_b64_tr_b16 v[202:203], v14 offset:32128
  v_mfma_f32_16x16x32_bf16 v[80:83], v[160:163], a[128:131], v[80:83]
  ds_read_b64_tr_b16 v[204:205], v15 offset:30880
  v_mfma_f32_16x16x32_bf16 v[120:123], v[160:163], a[132:135], v[120:123]
  ds_read_b64_tr_b16 v[206:207], v15 offset:32160
  v_mfma_f32_16x16x32_bf16 v[84:87], v[164:167], a[128:131], v[84:87]
  ds_read_b64_tr_b16 v[208:209], v14 offset:30912
  v_mfma_f32_16x16x32_bf16 v[124:127], v[164:167], a[132:135], v[124:127]
  ds_read_b64_tr_b16 v[210:211], v14 offset:32192
  ds_read_b64_tr_b16 v[212:213], v15 offset:30944
  v_mfma_f32_16x16x32_bf16 v[88:91], v[168:171], a[128:131], v[88:91]
  ds_read_b64_tr_b16 v[214:215], v15 offset:32224
  v_mfma_f32_16x16x32_bf16 v[128:131], v[168:171], a[132:135], v[128:131]
  buffer_load_dwordx4 v[30:33], v4, s[8:11], s50 offen
  ds_read_b64_tr_b16 v[216:217], v14 offset:30976
  v_mfma_f32_16x16x32_bf16 v[92:95], v[172:175], a[128:131], v[92:95]
  ds_read_b64_tr_b16 v[218:219], v14 offset:32256
  v_mfma_f32_16x16x32_bf16 v[132:135], v[172:175], a[132:135], v[132:135]
  ds_read_b64_tr_b16 v[220:221], v15 offset:31008
  v_mfma_f32_16x16x32_bf16 v[96:99], v[176:179], a[128:131], v[96:99]
  ds_read_b64_tr_b16 v[222:223], v15 offset:32288
  v_mfma_f32_16x16x32_bf16 v[136:139], v[176:179], a[132:135], v[136:139]
  buffer_load_dword v34, v5, s[8:11], s50 offen offset:1024
  v_mfma_f32_16x16x32_bf16 v[100:103], v[180:183], a[128:131], v[100:103]
  s_add_u32 s50, s50, 1280
  v_mfma_f32_16x16x32_bf16 v[140:143], v[180:183], a[132:135], v[140:143]
  s_waitcnt lgkmcnt(0) vmcnt(18)
  s_barrier
  v_mfma_f32_16x16x32_bf16 v[64:67], v[184:187], a[136:139], v[64:67]
  ds_read_b64_tr_b16 v[144:145], v14 offset:40960
  ds_read_b64_tr_b16 v[146:147], v14 offset:42240
  v_mfma_f32_16x16x32_bf16 v[104:107], v[184:187], a[140:143], v[104:107]
  ds_read_b64_tr_b16 v[148:149], v15 offset:40992
  v_mfma_f32_16x16x32_bf16 v[68:71], v[188:191], a[136:139], v[68:71]
  ds_read_b64_tr_b16 v[150:151], v15 offset:42272
  v_mfma_f32_16x16x32_bf16 v[108:111], v[188:191], a[140:143], v[108:111]
  ds_read_b64_tr_b16 v[152:153], v14 offset:41024
  v_mfma_f32_16x16x32_bf16 v[72:75], v[192:195], a[136:139], v[72:75]
  ds_read_b64_tr_b16 v[154:155], v14 offset:42304
  v_mfma_f32_16x16x32_bf16 v[112:115], v[192:195], a[140:143], v[112:115]
  ds_read_b64_tr_b16 v[156:157], v15 offset:41056
  ds_read_b64_tr_b16 v[158:159], v15 offset:42336
  v_mfma_f32_16x16x32_bf16 v[76:79], v[196:199], a[136:139], v[76:79]
  ds_read_b64_tr_b16 v[160:161], v14 offset:41088
  v_mfma_f32_16x16x32_bf16 v[116:119], v[196:199], a[140:143], v[116:119]
  ds_read_b64_tr_b16 v[162:163], v14 offset:42368
  v_mfma_f32_16x16x32_bf16 v[80:83], v[200:203], a[136:139], v[80:83]
  ds_read_b64_tr_b16 v[164:165], v15 offset:41120
  v_mfma_f32_16x16x32_bf16 v[120:123], v[200:203], a[140:143], v[120:123]
  ds_read_b64_tr_b16 v[166:167], v15 offset:42400
  v_mfma_f32_16x16x32_bf16 v[84:87], v[204:207], a[136:139], v[84:87]
  ds_read_b64_tr_b16 v[168:169], v14 offset:41152
  v_mfma_f32_16x16x32_bf16 v[124:127], v[204:207], a[140:143], v[124:127]
  ds_read_b64_tr_b16 v[170:171], v14 offset:42432
  ds_read_b64_tr_b16 v[172:173], v15 offset:41184
  v_mfma_f32_16x16x32_bf16 v[88:91], v[208:211], a[136:139], v[88:91]
  ds_read_b64_tr_b16 v[174:175], v15 offset:42464
  v_mfma_f32_16x16x32_bf16 v[128:131], v[208:211], a[140:143], v[128:131]
  buffer_load_dwordx4 v[36:39], v4, s[8:11], s50 offen
  ds_read_b64_tr_b16 v[176:177], v14 offset:41216
  v_mfma_f32_16x16x32_bf16 v[92:95], v[212:215], a[136:139], v[92:95]
  ds_read_b64_tr_b16 v[178:179], v14 offset:42496
  v_mfma_f32_16x16x32_bf16 v[132:135], v[212:215], a[140:143], v[132:135]
  ds_read_b64_tr_b16 v[180:181], v15 offset:41248
  v_mfma_f32_16x16x32_bf16 v[96:99], v[216:219], a[136:139], v[96:99]
  ds_read_b64_tr_b16 v[182:183], v15 offset:42528
  v_mfma_f32_16x16x32_bf16 v[136:139], v[216:219], a[140:143], v[136:139]
  buffer_load_dword v40, v5, s[8:11], s50 offen offset:1024
  v_mfma_f32_16x16x32_bf16 v[100:103], v[220:223], a[136:139], v[100:103]
  s_add_u32 s50, s50, 1280
  v_mfma_f32_16x16x32_bf16 v[140:143], v[220:223], a[140:143], v[140:143]
  s_waitcnt lgkmcnt(0) vmcnt(18)
  v_mfma_f32_16x16x32_bf16 v[64:67], v[144:147], a[144:147], v[64:67]
  ds_read_b64_tr_b16 v[184:185], v14 offset:51200
  ds_read_b64_tr_b16 v[186:187], v14 offset:52480
  v_mfma_f32_16x16x32_bf16 v[104:107], v[144:147], a[148:151], v[104:107]
  ds_read_b64_tr_b16 v[188:189], v15 offset:51232
  v_mfma_f32_16x16x32_bf16 v[68:71], v[148:151], a[144:147], v[68:71]
  ds_read_b64_tr_b16 v[190:191], v15 offset:52512
  v_mfma_f32_16x16x32_bf16 v[108:111], v[148:151], a[148:151], v[108:111]
  ds_read_b64_tr_b16 v[192:193], v14 offset:51264
  v_mfma_f32_16x16x32_bf16 v[72:75], v[152:155], a[144:147], v[72:75]
  ds_read_b64_tr_b16 v[194:195], v14 offset:52544
  v_mfma_f32_16x16x32_bf16 v[112:115], v[152:155], a[148:151], v[112:115]
  ds_read_b64_tr_b16 v[196:197], v15 offset:51296
  ds_read_b64_tr_b16 v[198:199], v15 offset:52576
  v_mfma_f32_16x16x32_bf16 v[76:79], v[156:159], a[144:147], v[76:79]
  ds_read_b64_tr_b16 v[200:201], v14 offset:51328
  v_mfma_f32_16x16x32_bf16 v[116:119], v[156:159], a[148:151], v[116:119]
  ds_read_b64_tr_b16 v[202:203], v14 offset:52608
  v_mfma_f32_16x16x32_bf16 v[80:83], v[160:163], a[144:147], v[80:83]
  ds_read_b64_tr_b16 v[204:205], v15 offset:51360
  v_mfma_f32_16x16x32_bf16 v[120:123], v[160:163], a[148:151], v[120:123]
  ds_read_b64_tr_b16 v[206:207], v15 offset:52640
  v_mfma_f32_16x16x32_bf16 v[84:87], v[164:167], a[144:147], v[84:87]
  ds_read_b64_tr_b16 v[208:209], v14 offset:51392
  v_mfma_f32_16x16x32_bf16 v[124:127], v[164:167], a[148:151], v[124:127]
  ds_read_b64_tr_b16 v[210:211], v14 offset:52672
  ds_read_b64_tr_b16 v[212:213], v15 offset:51424
  v_mfma_f32_16x16x32_bf16 v[88:91], v[168:171], a[144:147], v[88:91]
  ds_read_b64_tr_b16 v[214:215], v15 offset:52704
  v_mfma_f32_16x16x32_bf16 v[128:131], v[168:171], a[148:151], v[128:131]
  buffer_load_dwordx4 v[42:45], v4, s[8:11], s50 offen
  ds_read_b64_tr_b16 v[216:217], v14 offset:51456
  v_mfma_f32_16x16x32_bf16 v[92:95], v[172:175], a[144:147], v[92:95]
  ds_read_b64_tr_b16 v[218:219], v14 offset:52736
  v_mfma_f32_16x16x32_bf16 v[132:135], v[172:175], a[148:151], v[132:135]
  ds_read_b64_tr_b16 v[220:221], v15 offset:51488
  v_mfma_f32_16x16x32_bf16 v[96:99], v[176:179], a[144:147], v[96:99]
  ds_read_b64_tr_b16 v[222:223], v15 offset:52768
  v_mfma_f32_16x16x32_bf16 v[136:139], v[176:179], a[148:151], v[136:139]
  buffer_load_dword v46, v5, s[8:11], s50 offen offset:1024
  v_mfma_f32_16x16x32_bf16 v[100:103], v[180:183], a[144:147], v[100:103]
  s_add_u32 s50, s50, 1280
  v_mfma_f32_16x16x32_bf16 v[140:143], v[180:183], a[148:151], v[140:143]
  s_waitcnt lgkmcnt(0) vmcnt(18)
  v_mfma_f32_16x16x32_bf16 v[64:67], v[184:187], a[152:155], v[64:67]
  v_mfma_f32_16x16x32_bf16 v[104:107], v[184:187], a[156:159], v[104:107]
  v_mfma_f32_16x16x32_bf16 v[68:71], v[188:191], a[152:155], v[68:71]
  v_mfma_f32_16x16x32_bf16 v[108:111], v[188:191], a[156:159], v[108:111]
  v_mfma_f32_16x16x32_bf16 v[72:75], v[192:195], a[152:155], v[72:75]
  v_mfma_f32_16x16x32_bf16 v[112:115], v[192:195], a[156:159], v[112:115]
  v_mfma_f32_16x16x32_bf16 v[76:79], v[196:199], a[152:155], v[76:79]
  v_mfma_f32_16x16x32_bf16 v[116:119], v[196:199], a[156:159], v[116:119]
  v_mfma_f32_16x16x32_bf16 v[80:83], v[200:203], a[152:155], v[80:83]
  v_mfma_f32_16x16x32_bf16 v[120:123], v[200:203], a[156:159], v[120:123]
  v_mfma_f32_16x16x32_bf16 v[84:87], v[204:207], a[152:155], v[84:87]
  v_mfma_f32_16x16x32_bf16 v[124:127], v[204:207], a[156:159], v[124:127]
  v_mfma_f32_16x16x32_bf16 v[88:91], v[208:211], a[152:155], v[88:91]
  v_mfma_f32_16x16x32_bf16 v[128:131], v[208:211], a[156:159], v[128:131]
  v_mfma_f32_16x16x32_bf16 v[92:95], v[212:215], a[152:155], v[92:95]
  v_mfma_f32_16x16x32_bf16 v[132:135], v[212:215], a[156:159], v[132:135]
  v_mfma_f32_16x16x32_bf16 v[96:99], v[216:219], a[152:155], v[96:99]
  v_mfma_f32_16x16x32_bf16 v[136:139], v[216:219], a[156:159], v[136:139]
  v_mfma_f32_16x16x32_bf16 v[100:103], v[220:223], a[152:155], v[100:103]
  v_mfma_f32_16x16x32_bf16 v[140:143], v[220:223], a[156:159], v[140:143]
  s_add_u32 s16, s38, 73400320
  s_addc_u32 s17, s39, 0
  s_mov_b32 s18, 5242880
  s_mov_b32 s19, 0x00020000
  s_nop 3
  s_mul_i32 s21, s47, 40
  s_mul_i32 s22, s44, 10
  s_add_u32 s21, s21, s22
  s_lshl_b32 s21, s21, 10
  s_cmp_lt_u32 s2, 32
  s_cbranch_scc1 om_258
  s_add_u32 s22, s21, 0
  buffer_store_dwordx4 v[64:67], v4, s[16:19], s22 offen offset:0 sc1
  buffer_store_dwordx4 v[68:71], v4, s[16:19], s22 offen offset:1024 sc1
  buffer_store_dwordx4 v[72:75], v4, s[16:19], s22 offen offset:2048 sc1
  buffer_store_dwordx4 v[76:79], v4, s[16:19], s22 offen offset:3072 sc1
  s_add_u32 s22, s21, 4096
  buffer_store_dwordx4 v[80:83], v4, s[16:19], s22 offen offset:0 sc1
  buffer_store_dwordx4 v[84:87], v4, s[16:19], s22 offen offset:1024 sc1
  buffer_store_dwordx4 v[88:91], v4, s[16:19], s22 offen offset:2048 sc1
  buffer_store_dwordx4 v[92:95], v4, s[16:19], s22 offen offset:3072 sc1
  s_add_u32 s22, s21, 8192
  buffer_store_dwordx4 v[96:99], v4, s[16:19], s22 offen offset:0 sc1
  buffer_store_dwordx4 v[100:103], v4, s[16:19], s22 offen offset:1024 sc1
  s_add_u32 s22, s21, 40960
  buffer_store_dwordx4 v[104:107], v4, s[16:19], s22 offen offset:0 sc1
  buffer_store_dwordx4 v[108:111], v4, s[16:19], s22 offen offset:1024 sc1
  buffer_store_dwordx4 v[112:115], v4, s[16:19], s22 offen offset:2048 sc1
  buffer_store_dwordx4 v[116:119], v4, s[16:19], s22 offen offset:3072 sc1
  s_add_u32 s22, s21, 45056
  buffer_store_dwordx4 v[120:123], v4, s[16:19], s22 offen offset:0 sc1
  buffer_store_dwordx4 v[124:127], v4, s[16:19], s22 offen offset:1024 sc1
  buffer_store_dwordx4 v[128:131], v4, s[16:19], s22 offen offset:2048 sc1
  buffer_store_dwordx4 v[132:135], v4, s[16:19], s22 offen offset:3072 sc1
  s_add_u32 s22, s21, 49152
  buffer_store_dwordx4 v[136:139], v4, s[16:19], s22 offen offset:0 sc1
  buffer_store_dwordx4 v[140:143], v4, s[16:19], s22 offen offset:1024 sc1
  s_sub_u32 s50, s50, 1320960
  buffer_load_dwordx4 v[160:163], v4, s[8:11], s50 offen
  buffer_load_dword v164, v5, s[8:11], s50 offen offset:1024
  s_add_u32 s50, s50, 1280
  buffer_load_dwordx4 v[166:169], v4, s[8:11], s50 offen
  buffer_load_dword v170, v5, s[8:11], s50 offen offset:1024
  s_add_u32 s50, s50, 1280
  buffer_load_dwordx4 v[172:175], v4, s[8:11], s50 offen
  buffer_load_dword v176, v5, s[8:11], s50 offen offset:1024
  s_add_u32 s50, s50, 1280
  buffer_load_dwordx4 v[178:181], v4, s[8:11], s50 offen
  buffer_load_dword v182, v5, s[8:11], s50 offen offset:1024
  s_add_u32 s50, s50, 1280
  buffer_load_dwordx4 v[184:187], v4, s[8:11], s50 offen
  buffer_load_dword v188, v5, s[8:11], s50 offen offset:1024
  s_add_u32 s50, s50, 1280
  buffer_load_dwordx4 v[190:193], v4, s[8:11], s50 offen
  buffer_load_dword v194, v5, s[8:11], s50 offen offset:1024
  s_add_u32 s50, s50, 1280
  buffer_load_dwordx4 v[196:199], v4, s[8:11], s50 offen
  buffer_load_dword v200, v5, s[8:11], s50 offen offset:1024
  s_add_u32 s50, s50, 1280
  buffer_load_dwordx4 v[202:205], v4, s[8:11], s50 offen
  buffer_load_dword v206, v5, s[8:11], s50 offen offset:1024
  s_add_u32 s50, s50, 1280
  s_waitcnt vmcnt(36)
  v_lshlrev_b32 v57, 16, v52
  v_and_b32 v52, 0xffff0000, v52
  v_lshlrev_b32 v58, 16, v53
  v_and_b32 v53, 0xffff0000, v53
  v_lshlrev_b32 v59, 16, v54
  v_and_b32 v54, 0xffff0000, v54
  v_lshlrev_b32 v60, 16, v55
  v_and_b32 v55, 0xffff0000, v55
  v_lshlrev_b32 v61, 16, v56
  v_and_b32 v56, 0xffff0000, v56
  v_lshlrev_b32 v25, 16, v224
  v_and_b32 v26, 0xffff0000, v224
  v_mul_f32 v25, v25, v57
  v_mul_f32 v26, v26, v52
  v_cvt_pk_bf16_f32 v25, v25, v26
  v_lshlrev_b32 v26, 16, v25
  v_and_b32 v25, 0xffff0000, v25
  v_add_f32 v144, v25, v26
  v_lshlrev_b32 v25, 16, v225
  v_and_b32 v26, 0xffff0000, v225
  v_mul_f32 v25, v25, v58
  v_mul_f32 v26, v26, v53
  v_cvt_pk_bf16_f32 v25, v25, v26
  v_lshlrev_b32 v26, 16, v25
  v_and_b32 v25, 0xffff0000, v25
  v_add_f32 v144, v144, v26
  v_add_f32 v144, v144, v25
  v_lshlrev_b32 v25, 16, v226
  v_and_b32 v26, 0xffff0000, v226
  v_mul_f32 v25, v25, v59
  v_mul_f32 v26, v26, v54
  v_cvt_pk_bf16_f32 v25, v25, v26
  v_lshlrev_b32 v26, 16, v25
  v_and_b32 v25, 0xffff0000, v25
  v_add_f32 v144, v144, v26
  v_add_f32 v144, v144, v25
  v_lshlrev_b32 v25, 16, v227
  v_and_b32 v26, 0xffff0000, v227
  v_mul_f32 v25, v25, v60
  v_mul_f32 v26, v26, v55
  v_cvt_pk_bf16_f32 v25, v25, v26
  v_lshlrev_b32 v26, 16, v25
  v_and_b32 v25, 0xffff0000, v25
  v_add_f32 v144, v144, v26
  v_add_f32 v144, v144, v25
  v_lshlrev_b32 v25, 16, v228
  v_and_b32 v26, 0xffff0000, v228
  v_mul_f32 v25, v25, v61
  v_mul_f32 v26, v26, v56
  v_cvt_pk_bf16_f32 v25, v25, v26
  v_lshlrev_b32 v26, 16, v25
  v_and_b32 v25, 0xffff0000, v25
  v_add_f32 v144, v144, v26
  v_add_f32 v144, v144, v25
  v_lshlrev_b32 v25, 16, v230
  v_and_b32 v26, 0xffff0000, v230
  v_mul_f32 v25, v25, v57
  v_mul_f32 v26, v26, v52
  v_cvt_pk_bf16_f32 v25, v25, v26
  v_lshlrev_b32 v26, 16, v25
  v_and_b32 v25, 0xffff0000, v25
  v_add_f32 v145, v25, v26
  v_lshlrev_b32 v25, 16, v231
  v_and_b32 v26, 0xffff0000, v231
  v_mul_f32 v25, v25, v58
  v_mul_f32 v26, v26, v53
  v_cvt_pk_bf16_f32 v25, v25, v26
  v_lshlrev_b32 v26, 16, v25
  v_and_b32 v25, 0xffff0000, v25
  v_add_f32 v145, v145, v26
  v_add_f32 v145, v145, v25
  v_lshlrev_b32 v25, 16, v232
  v_and_b32 v26, 0xffff0000, v232
  v_mul_f32 v25, v25, v59
  v_mul_f32 v26, v26, v54
  v_cvt_pk_bf16_f32 v25, v25, v26
  v_lshlrev_b32 v26, 16, v25
  v_and_b32 v25, 0xffff0000, v25
  v_add_f32 v145, v145, v26
  v_add_f32 v145, v145, v25
  v_lshlrev_b32 v25, 16, v233
  v_and_b32 v26, 0xffff0000, v233
  v_mul_f32 v25, v25, v60
  v_mul_f32 v26, v26, v55
  v_cvt_pk_bf16_f32 v25, v25, v26
  v_lshlrev_b32 v26, 16, v25
  v_and_b32 v25, 0xffff0000, v25
  v_add_f32 v145, v145, v26
  v_add_f32 v145, v145, v25
  v_lshlrev_b32 v25, 16, v234
  v_and_b32 v26, 0xffff0000, v234
  v_mul_f32 v25, v25, v61
  v_mul_f32 v26, v26, v56
  v_cvt_pk_bf16_f32 v25, v25, v26
  v_lshlrev_b32 v26, 16, v25
  v_and_b32 v25, 0xffff0000, v25
  v_add_f32 v145, v145, v26
  v_add_f32 v145, v145, v25
  v_lshlrev_b32 v25, 16, v236
  v_and_b32 v26, 0xffff0000, v236
  v_mul_f32 v25, v25, v57
  v_mul_f32 v26, v26, v52
  v_cvt_pk_bf16_f32 v25, v25, v26
  v_lshlrev_b32 v26, 16, v25
  v_and_b32 v25, 0xffff0000, v25
  v_add_f32 v146, v25, v26
  v_lshlrev_b32 v25, 16, v237
  v_and_b32 v26, 0xffff0000, v237
  v_mul_f32 v25, v25, v58
  v_mul_f32 v26, v26, v53
  v_cvt_pk_bf16_f32 v25, v25, v26
  v_lshlrev_b32 v26, 16, v25
  v_and_b32 v25, 0xffff0000, v25
  v_add_f32 v146, v146, v26
  v_add_f32 v146, v146, v25
  v_lshlrev_b32 v25, 16, v238
  v_and_b32 v26, 0xffff0000, v238
  v_mul_f32 v25, v25, v59
  v_mul_f32 v26, v26, v54
  v_cvt_pk_bf16_f32 v25, v25, v26
  v_lshlrev_b32 v26, 16, v25
  v_and_b32 v25, 0xffff0000, v25
  v_add_f32 v146, v146, v26
  v_add_f32 v146, v146, v25
  v_lshlrev_b32 v25, 16, v239
  v_and_b32 v26, 0xffff0000, v239
  v_mul_f32 v25, v25, v60
  v_mul_f32 v26, v26, v55
  v_cvt_pk_bf16_f32 v25, v25, v26
  v_lshlrev_b32 v26, 16, v25
  v_and_b32 v25, 0xffff0000, v25
  v_add_f32 v146, v146, v26
  v_add_f32 v146, v146, v25
  v_lshlrev_b32 v25, 16, v240
  v_and_b32 v26, 0xffff0000, v240
  v_mul_f32 v25, v25, v61
  v_mul_f32 v26, v26, v56
  v_cvt_pk_bf16_f32 v25, v25, v26
  v_lshlrev_b32 v26, 16, v25
  v_and_b32 v25, 0xffff0000, v25
  v_add_f32 v146, v146, v26
  v_add_f32 v146, v146, v25
  v_lshlrev_b32 v25, 16, v242
  v_and_b32 v26, 0xffff0000, v242
  v_mul_f32 v25, v25, v57
  v_mul_f32 v26, v26, v52
  v_cvt_pk_bf16_f32 v25, v25, v26
  v_lshlrev_b32 v26, 16, v25
  v_and_b32 v25, 0xffff0000, v25
  v_add_f32 v147, v25, v26
  v_lshlrev_b32 v25, 16, v243
  v_and_b32 v26, 0xffff0000, v243
  v_mul_f32 v25, v25, v58
  v_mul_f32 v26, v26, v53
  v_cvt_pk_bf16_f32 v25, v25, v26
  v_lshlrev_b32 v26, 16, v25
  v_and_b32 v25, 0xffff0000, v25
  v_add_f32 v147, v147, v26
  v_add_f32 v147, v147, v25
  v_lshlrev_b32 v25, 16, v244
  v_and_b32 v26, 0xffff0000, v244
  v_mul_f32 v25, v25, v59
  v_mul_f32 v26, v26, v54
  v_cvt_pk_bf16_f32 v25, v25, v26
  v_lshlrev_b32 v26, 16, v25
  v_and_b32 v25, 0xffff0000, v25
  v_add_f32 v147, v147, v26
  v_add_f32 v147, v147, v25
  v_lshlrev_b32 v25, 16, v245
  v_and_b32 v26, 0xffff0000, v245
  v_mul_f32 v25, v25, v60
  v_mul_f32 v26, v26, v55
  v_cvt_pk_bf16_f32 v25, v25, v26
  v_lshlrev_b32 v26, 16, v25
  v_and_b32 v25, 0xffff0000, v25
  v_add_f32 v147, v147, v26
  v_add_f32 v147, v147, v25
  v_lshlrev_b32 v25, 16, v246
  v_and_b32 v26, 0xffff0000, v246
  v_mul_f32 v25, v25, v61
  v_mul_f32 v26, v26, v56
  v_cvt_pk_bf16_f32 v25, v25, v26
  v_lshlrev_b32 v26, 16, v25
  v_and_b32 v25, 0xffff0000, v25
  v_add_f32 v147, v147, v26
  v_add_f32 v147, v147, v25
  v_lshlrev_b32 v25, 16, v248
  v_and_b32 v26, 0xffff0000, v248
  v_mul_f32 v25, v25, v57
  v_mul_f32 v26, v26, v52
  v_cvt_pk_bf16_f32 v25, v25, v26
  v_lshlrev_b32 v26, 16, v25
  v_and_b32 v25, 0xffff0000, v25
  v_add_f32 v148, v25, v26
  v_lshlrev_b32 v25, 16, v249
  v_and_b32 v26, 0xffff0000, v249
  v_mul_f32 v25, v25, v58
  v_mul_f32 v26, v26, v53
  v_cvt_pk_bf16_f32 v25, v25, v26
  v_lshlrev_b32 v26, 16, v25
  v_and_b32 v25, 0xffff0000, v25
  v_add_f32 v148, v148, v26
  v_add_f32 v148, v148, v25
  v_lshlrev_b32 v25, 16, v250
  v_and_b32 v26, 0xffff0000, v250
  v_mul_f32 v25, v25, v59
  v_mul_f32 v26, v26, v54
  v_cvt_pk_bf16_f32 v25, v25, v26
  v_lshlrev_b32 v26, 16, v25
  v_and_b32 v25, 0xffff0000, v25
  v_add_f32 v148, v148, v26
  v_add_f32 v148, v148, v25
  v_lshlrev_b32 v25, 16, v251
  v_and_b32 v26, 0xffff0000, v251
  v_mul_f32 v25, v25, v60
  v_mul_f32 v26, v26, v55
  v_cvt_pk_bf16_f32 v25, v25, v26
  v_lshlrev_b32 v26, 16, v25
  v_and_b32 v25, 0xffff0000, v25
  v_add_f32 v148, v148, v26
  v_add_f32 v148, v148, v25
  v_lshlrev_b32 v25, 16, v252
  v_and_b32 v26, 0xffff0000, v252
  v_mul_f32 v25, v25, v61
  v_mul_f32 v26, v26, v56
  v_cvt_pk_bf16_f32 v25, v25, v26
  v_lshlrev_b32 v26, 16, v25
  v_and_b32 v25, 0xffff0000, v25
  v_add_f32 v148, v148, v26
  v_add_f32 v148, v148, v25
  v_lshlrev_b32 v25, 16, v30
  v_and_b32 v26, 0xffff0000, v30
  v_mul_f32 v25, v25, v57
  v_mul_f32 v26, v26, v52
  v_cvt_pk_bf16_f32 v25, v25, v26
  v_lshlrev_b32 v26, 16, v25
  v_and_b32 v25, 0xffff0000, v25
  v_add_f32 v149, v25, v26
  v_lshlrev_b32 v25, 16, v31
  v_and_b32 v26, 0xffff0000, v31
  v_mul_f32 v25, v25, v58
  v_mul_f32 v26, v26, v53
  v_cvt_pk_bf16_f32 v25, v25, v26
  v_lshlrev_b32 v26, 16, v25
  v_and_b32 v25, 0xffff0000, v25
  v_add_f32 v149, v149, v26
  v_add_f32 v149, v149, v25
  v_lshlrev_b32 v25, 16, v32
  v_and_b32 v26, 0xffff0000, v32
  v_mul_f32 v25, v25, v59
  v_mul_f32 v26, v26, v54
  v_cvt_pk_bf16_f32 v25, v25, v26
  v_lshlrev_b32 v26, 16, v25
  v_and_b32 v25, 0xffff0000, v25
  v_add_f32 v149, v149, v26
  v_add_f32 v149, v149, v25
  v_lshlrev_b32 v25, 16, v33
  v_and_b32 v26, 0xffff0000, v33
  v_mul_f32 v25, v25, v60
  v_mul_f32 v26, v26, v55
  v_cvt_pk_bf16_f32 v25, v25, v26
  v_lshlrev_b32 v26, 16, v25
  v_and_b32 v25, 0xffff0000, v25
  v_add_f32 v149, v149, v26
  v_add_f32 v149, v149, v25
  v_lshlrev_b32 v25, 16, v34
  v_and_b32 v26, 0xffff0000, v34
  v_mul_f32 v25, v25, v61
  v_mul_f32 v26, v26, v56
  v_cvt_pk_bf16_f32 v25, v25, v26
  v_lshlrev_b32 v26, 16, v25
  v_and_b32 v25, 0xffff0000, v25
  v_add_f32 v149, v149, v26
  v_add_f32 v149, v149, v25
  v_lshlrev_b32 v25, 16, v36
  v_and_b32 v26, 0xffff0000, v36
  v_mul_f32 v25, v25, v57
  v_mul_f32 v26, v26, v52
  v_cvt_pk_bf16_f32 v25, v25, v26
  v_lshlrev_b32 v26, 16, v25
  v_and_b32 v25, 0xffff0000, v25
  v_add_f32 v150, v25, v26
  v_lshlrev_b32 v25, 16, v37
  v_and_b32 v26, 0xffff0000, v37
  v_mul_f32 v25, v25, v58
  v_mul_f32 v26, v26, v53
  v_cvt_pk_bf16_f32 v25, v25, v26
  v_lshlrev_b32 v26, 16, v25
  v_and_b32 v25, 0xffff0000, v25
  v_add_f32 v150, v150, v26
  v_add_f32 v150, v150, v25
  v_lshlrev_b32 v25, 16, v38
  v_and_b32 v26, 0xffff0000, v38
  v_mul_f32 v25, v25, v59
  v_mul_f32 v26, v26, v54
  v_cvt_pk_bf16_f32 v25, v25, v26
  v_lshlrev_b32 v26, 16, v25
  v_and_b32 v25, 0xffff0000, v25
  v_add_f32 v150, v150, v26
  v_add_f32 v150, v150, v25
  v_lshlrev_b32 v25, 16, v39
  v_and_b32 v26, 0xffff0000, v39
  v_mul_f32 v25, v25, v60
  v_mul_f32 v26, v26, v55
  v_cvt_pk_bf16_f32 v25, v25, v26
  v_lshlrev_b32 v26, 16, v25
  v_and_b32 v25, 0xffff0000, v25
  v_add_f32 v150, v150, v26
  v_add_f32 v150, v150, v25
  v_lshlrev_b32 v25, 16, v40
  v_and_b32 v26, 0xffff0000, v40
  v_mul_f32 v25, v25, v61
  v_mul_f32 v26, v26, v56
  v_cvt_pk_bf16_f32 v25, v25, v26
  v_lshlrev_b32 v26, 16, v25
  v_and_b32 v25, 0xffff0000, v25
  v_add_f32 v150, v150, v26
  v_add_f32 v150, v150, v25
  v_lshlrev_b32 v25, 16, v42
  v_and_b32 v26, 0xffff0000, v42
  v_mul_f32 v25, v25, v57
  v_mul_f32 v26, v26, v52
  v_cvt_pk_bf16_f32 v25, v25, v26
  v_lshlrev_b32 v26, 16, v25
  v_and_b32 v25, 0xffff0000, v25
  v_add_f32 v151, v25, v26
  v_lshlrev_b32 v25, 16, v43
  v_and_b32 v26, 0xffff0000, v43
  v_mul_f32 v25, v25, v58
  v_mul_f32 v26, v26, v53
  v_cvt_pk_bf16_f32 v25, v25, v26
  v_lshlrev_b32 v26, 16, v25
  v_and_b32 v25, 0xffff0000, v25
  v_add_f32 v151, v151, v26
  v_add_f32 v151, v151, v25
  v_lshlrev_b32 v25, 16, v44
  v_and_b32 v26, 0xffff0000, v44
  v_mul_f32 v25, v25, v59
  v_mul_f32 v26, v26, v54
  v_cvt_pk_bf16_f32 v25, v25, v26
  v_lshlrev_b32 v26, 16, v25
  v_and_b32 v25, 0xffff0000, v25
  v_add_f32 v151, v151, v26
  v_add_f32 v151, v151, v25
  v_lshlrev_b32 v25, 16, v45
  v_and_b32 v26, 0xffff0000, v45
  v_mul_f32 v25, v25, v60
  v_mul_f32 v26, v26, v55
  v_cvt_pk_bf16_f32 v25, v25, v26
  v_lshlrev_b32 v26, 16, v25
  v_and_b32 v25, 0xffff0000, v25
  v_add_f32 v151, v151, v26
  v_add_f32 v151, v151, v25
  v_lshlrev_b32 v25, 16, v46
  v_and_b32 v26, 0xffff0000, v46
  v_mul_f32 v25, v25, v61
  v_mul_f32 v26, v26, v56
  v_cvt_pk_bf16_f32 v25, v25, v26
  v_lshlrev_b32 v26, 16, v25
  v_and_b32 v25, 0xffff0000, v25
  v_add_f32 v151, v151, v26
  v_add_f32 v151, v151, v25
  v_add_f32_dpp v144, v144, v144 row_ror:8 row_mask:0xf bank_mask:0xf
  v_add_f32_dpp v145, v145, v145 row_ror:8 row_mask:0xf bank_mask:0xf
  v_add_f32_dpp v146, v146, v146 row_ror:8 row_mask:0xf bank_mask:0xf
  v_add_f32_dpp v147, v147, v147 row_ror:8 row_mask:0xf bank_mask:0xf
  v_add_f32_dpp v148, v148, v148 row_ror:8 row_mask:0xf bank_mask:0xf
  v_add_f32_dpp v149, v149, v149 row_ror:8 row_mask:0xf bank_mask:0xf
  v_add_f32_dpp v150, v150, v150 row_ror:8 row_mask:0xf bank_mask:0xf
  v_add_f32_dpp v151, v151, v151 row_ror:8 row_mask:0xf bank_mask:0xf
  v_add_f32_dpp v144, v144, v144 row_ror:4 row_mask:0xf bank_mask:0xf
  v_add_f32_dpp v145, v145, v145 row_ror:4 row_mask:0xf bank_mask:0xf
  v_add_f32_dpp v146, v146, v146 row_ror:4 row_mask:0xf bank_mask:0xf
  v_add_f32_dpp v147, v147, v147 row_ror:4 row_mask:0xf bank_mask:0xf
  v_add_f32_dpp v148, v148, v148 row_ror:4 row_mask:0xf bank_mask:0xf
  v_add_f32_dpp v149, v149, v149 row_ror:4 row_mask:0xf bank_mask:0xf
  v_add_f32_dpp v150, v150, v150 row_ror:4 row_mask:0xf bank_mask:0xf
  v_add_f32_dpp v151, v151, v151 row_ror:4 row_mask:0xf bank_mask:0xf
  v_add_f32_dpp v144, v144, v144 row_ror:2 row_mask:0xf bank_mask:0xf
  v_add_f32_dpp v145, v145, v145 row_ror:2 row_mask:0xf bank_mask:0xf
  v_add_f32_dpp v146, v146, v146 row_ror:2 row_mask:0xf bank_mask:0xf
  v_add_f32_dpp v147, v147, v147 row_ror:2 row_mask:0xf bank_mask:0xf
  v_add_f32_dpp v148, v148, v148 row_ror:2 row_mask:0xf bank_mask:0xf
  v_add_f32_dpp v149, v149, v149 row_ror:2 row_mask:0xf bank_mask:0xf
  v_add_f32_dpp v150, v150, v150 row_ror:2 row_mask:0xf bank_mask:0xf
  v_add_f32_dpp v151, v151, v151 row_ror:2 row_mask:0xf bank_mask:0xf
  v_add_f32_dpp v144, v144, v144 row_ror:1 row_mask:0xf bank_mask:0xf
  v_add_f32_dpp v145, v145, v145 row_ror:1 row_mask:0xf bank_mask:0xf
  v_add_f32_dpp v146, v146, v146 row_ror:1 row_mask:0xf bank_mask:0xf
  v_add_f32_dpp v147, v147, v147 row_ror:1 row_mask:0xf bank_mask:0xf
  v_add_f32_dpp v148, v148, v148 row_ror:1 row_mask:0xf bank_mask:0xf
  v_add_f32_dpp v149, v149, v149 row_ror:1 row_mask:0xf bank_mask:0xf
  v_add_f32_dpp v150, v150, v150 row_ror:1 row_mask:0xf bank_mask:0xf
  v_add_f32_dpp v151, v151, v151 row_ror:1 row_mask:0xf bank_mask:0xf
  v_mov_b32 v152, v144
  v_mov_b32 v153, v145
  v_mov_b32 v154, v146
  v_mov_b32 v155, v147
  v_mov_b32 v156, v148
  v_mov_b32 v157, v149
  v_mov_b32 v158, v150
  v_mov_b32 v159, v151
  v_permlane32_swap_b32 v144, v152
  v_permlane32_swap_b32 v145, v153
  v_permlane32_swap_b32 v146, v154
  v_permlane32_swap_b32 v147, v155
  v_permlane32_swap_b32 v148, v156
  v_permlane32_swap_b32 v149, v157
  v_permlane32_swap_b32 v150, v158
  v_permlane32_swap_b32 v151, v159
  v_add_f32 v144, v144, v152
  v_add_f32 v145, v145, v153
  v_add_f32 v146, v146, v154
  v_add_f32 v147, v147, v155
  v_add_f32 v148, v148, v156
  v_add_f32 v149, v149, v157
  v_add_f32 v150, v150, v158
  v_add_f32 v151, v151, v159
  v_mov_b32 v152, v144
  v_mov_b32 v153, v145
  v_mov_b32 v154, v146
  v_mov_b32 v155, v147
  v_mov_b32 v156, v148
  v_mov_b32 v157, v149
  v_mov_b32 v158, v150
  v_mov_b32 v159, v151
  v_permlane16_swap_b32 v144, v152
  v_permlane16_swap_b32 v145, v153
  v_permlane16_swap_b32 v146, v154
  v_permlane16_swap_b32 v147, v155
  v_permlane16_swap_b32 v148, v156
  v_permlane16_swap_b32 v149, v157
  v_permlane16_swap_b32 v150, v158
  v_permlane16_swap_b32 v151, v159
  v_add_f32 v144, v144, v152
  v_add_f32 v145, v145, v153
  v_add_f32 v146, v146, v154
  v_add_f32 v147, v147, v155
  v_add_f32 v148, v148, v156
  v_add_f32 v149, v149, v157
  v_add_f32 v150, v150, v158
  v_add_f32 v151, v151, v159
  v_mov_b32 v24, v144
  v_cmp_eq_u32 vcc, 1, v1
  s_nop 1
  v_cndmask_b32 v24, v24, v145, vcc
  v_cmp_eq_u32 vcc, 2, v1
  s_nop 1
  v_cndmask_b32 v24, v24, v146, vcc
  v_cmp_eq_u32 vcc, 3, v1
  s_nop 1
  v_cndmask_b32 v24, v24, v147, vcc
  v_cmp_eq_u32 vcc, 4, v1
  s_nop 1
  v_cndmask_b32 v24, v24, v148, vcc
  v_cmp_eq_u32 vcc, 5, v1
  s_nop 1
  v_cndmask_b32 v24, v24, v149, vcc
  v_cmp_eq_u32 vcc, 6, v1
  s_nop 1
  v_cndmask_b32 v24, v24, v150, vcc
  v_cmp_eq_u32 vcc, 7, v1
  s_nop 1
  v_cndmask_b32 v24, v24, v151, vcc
  v_cvt_pk_bf16_f32 v25, v24, v24
  v_lshlrev_b32 v24, 16, v25
  v_mul_f32 v24, 0xbfb8aa3b, v24
  v_exp_f32 v24, v24
  s_nop 0
  v_add_f32 v24, 1.0, v24
  v_rcp_f32 v24, v24
  s_nop 0
  v_cvt_pk_bf16_f32 v25, v24, v24
  v_lshlrev_b32 v24, 16, v25
  s_lshl_b32 s21, s59, 2
  s_mov_b64 exec, 0xff
  buffer_store_dword v24, v5, s[28:31], s21 offen sc1
  s_mov_b64 exec, -1
  s_sub_u32 s59, s59, 1024
  s_waitcnt vmcnt(1)
  v_lshlrev_b32 v25, 16, v160
  v_and_b32 v26, 0xffff0000, v160
  v_mul_f32 v25, v25, v57
  v_mul_f32 v26, v26, v52
  v_cvt_pk_bf16_f32 v25, v25, v26
  v_lshlrev_b32 v26, 16, v25
  v_and_b32 v25, 0xffff0000, v25
  v_add_f32 v144, v25, v26
  v_lshlrev_b32 v25, 16, v161
  v_and_b32 v26, 0xffff0000, v161
  v_mul_f32 v25, v25, v58
  v_mul_f32 v26, v26, v53
  v_cvt_pk_bf16_f32 v25, v25, v26
  v_lshlrev_b32 v26, 16, v25
  v_and_b32 v25, 0xffff0000, v25
  v_add_f32 v144, v144, v26
  v_add_f32 v144, v144, v25
  v_lshlrev_b32 v25, 16, v162
  v_and_b32 v26, 0xffff0000, v162
  v_mul_f32 v25, v25, v59
  v_mul_f32 v26, v26, v54
  v_cvt_pk_bf16_f32 v25, v25, v26
  v_lshlrev_b32 v26, 16, v25
  v_and_b32 v25, 0xffff0000, v25
  v_add_f32 v144, v144, v26
  v_add_f32 v144, v144, v25
  v_lshlrev_b32 v25, 16, v163
  v_and_b32 v26, 0xffff0000, v163
  v_mul_f32 v25, v25, v60
  v_mul_f32 v26, v26, v55
  v_cvt_pk_bf16_f32 v25, v25, v26
  v_lshlrev_b32 v26, 16, v25
  v_and_b32 v25, 0xffff0000, v25
  v_add_f32 v144, v144, v26
  v_add_f32 v144, v144, v25
  v_lshlrev_b32 v25, 16, v164
  v_and_b32 v26, 0xffff0000, v164
  v_mul_f32 v25, v25, v61
  v_mul_f32 v26, v26, v56
  v_cvt_pk_bf16_f32 v25, v25, v26
  v_lshlrev_b32 v26, 16, v25
  v_and_b32 v25, 0xffff0000, v25
  v_add_f32 v144, v144, v26
  v_add_f32 v144, v144, v25
  v_lshlrev_b32 v25, 16, v166
  v_and_b32 v26, 0xffff0000, v166
  v_mul_f32 v25, v25, v57
  v_mul_f32 v26, v26, v52
  v_cvt_pk_bf16_f32 v25, v25, v26
  v_lshlrev_b32 v26, 16, v25
  v_and_b32 v25, 0xffff0000, v25
  v_add_f32 v145, v25, v26
  v_lshlrev_b32 v25, 16, v167
  v_and_b32 v26, 0xffff0000, v167
  v_mul_f32 v25, v25, v58
  v_mul_f32 v26, v26, v53
  v_cvt_pk_bf16_f32 v25, v25, v26
  v_lshlrev_b32 v26, 16, v25
  v_and_b32 v25, 0xffff0000, v25
  v_add_f32 v145, v145, v26
  v_add_f32 v145, v145, v25
  v_lshlrev_b32 v25, 16, v168
  v_and_b32 v26, 0xffff0000, v168
  v_mul_f32 v25, v25, v59
  v_mul_f32 v26, v26, v54
  v_cvt_pk_bf16_f32 v25, v25, v26
  v_lshlrev_b32 v26, 16, v25
  v_and_b32 v25, 0xffff0000, v25
  v_add_f32 v145, v145, v26
  v_add_f32 v145, v145, v25
  v_lshlrev_b32 v25, 16, v169
  v_and_b32 v26, 0xffff0000, v169
  v_mul_f32 v25, v25, v60
  v_mul_f32 v26, v26, v55
  v_cvt_pk_bf16_f32 v25, v25, v26
  v_lshlrev_b32 v26, 16, v25
  v_and_b32 v25, 0xffff0000, v25
  v_add_f32 v145, v145, v26
  v_add_f32 v145, v145, v25
  v_lshlrev_b32 v25, 16, v170
  v_and_b32 v26, 0xffff0000, v170
  v_mul_f32 v25, v25, v61
  v_mul_f32 v26, v26, v56
  v_cvt_pk_bf16_f32 v25, v25, v26
  v_lshlrev_b32 v26, 16, v25
  v_and_b32 v25, 0xffff0000, v25
  v_add_f32 v145, v145, v26
  v_add_f32 v145, v145, v25
  v_lshlrev_b32 v25, 16, v172
  v_and_b32 v26, 0xffff0000, v172
  v_mul_f32 v25, v25, v57
  v_mul_f32 v26, v26, v52
  v_cvt_pk_bf16_f32 v25, v25, v26
  v_lshlrev_b32 v26, 16, v25
  v_and_b32 v25, 0xffff0000, v25
  v_add_f32 v146, v25, v26
  v_lshlrev_b32 v25, 16, v173
  v_and_b32 v26, 0xffff0000, v173
  v_mul_f32 v25, v25, v58
  v_mul_f32 v26, v26, v53
  v_cvt_pk_bf16_f32 v25, v25, v26
  v_lshlrev_b32 v26, 16, v25
  v_and_b32 v25, 0xffff0000, v25
  v_add_f32 v146, v146, v26
  v_add_f32 v146, v146, v25
  v_lshlrev_b32 v25, 16, v174
  v_and_b32 v26, 0xffff0000, v174
  v_mul_f32 v25, v25, v59
  v_mul_f32 v26, v26, v54
  v_cvt_pk_bf16_f32 v25, v25, v26
  v_lshlrev_b32 v26, 16, v25
  v_and_b32 v25, 0xffff0000, v25
  v_add_f32 v146, v146, v26
  v_add_f32 v146, v146, v25
  v_lshlrev_b32 v25, 16, v175
  v_and_b32 v26, 0xffff0000, v175
  v_mul_f32 v25, v25, v60
  v_mul_f32 v26, v26, v55
  v_cvt_pk_bf16_f32 v25, v25, v26
  v_lshlrev_b32 v26, 16, v25
  v_and_b32 v25, 0xffff0000, v25
  v_add_f32 v146, v146, v26
  v_add_f32 v146, v146, v25
  v_lshlrev_b32 v25, 16, v176
  v_and_b32 v26, 0xffff0000, v176
  v_mul_f32 v25, v25, v61
  v_mul_f32 v26, v26, v56
  v_cvt_pk_bf16_f32 v25, v25, v26
  v_lshlrev_b32 v26, 16, v25
  v_and_b32 v25, 0xffff0000, v25
  v_add_f32 v146, v146, v26
  v_add_f32 v146, v146, v25
  v_lshlrev_b32 v25, 16, v178
  v_and_b32 v26, 0xffff0000, v178
  v_mul_f32 v25, v25, v57
  v_mul_f32 v26, v26, v52
  v_cvt_pk_bf16_f32 v25, v25, v26
  v_lshlrev_b32 v26, 16, v25
  v_and_b32 v25, 0xffff0000, v25
  v_add_f32 v147, v25, v26
  v_lshlrev_b32 v25, 16, v179
  v_and_b32 v26, 0xffff0000, v179
  v_mul_f32 v25, v25, v58
  v_mul_f32 v26, v26, v53
  v_cvt_pk_bf16_f32 v25, v25, v26
  v_lshlrev_b32 v26, 16, v25
  v_and_b32 v25, 0xffff0000, v25
  v_add_f32 v147, v147, v26
  v_add_f32 v147, v147, v25
  v_lshlrev_b32 v25, 16, v180
  v_and_b32 v26, 0xffff0000, v180
  v_mul_f32 v25, v25, v59
  v_mul_f32 v26, v26, v54
  v_cvt_pk_bf16_f32 v25, v25, v26
  v_lshlrev_b32 v26, 16, v25
  v_and_b32 v25, 0xffff0000, v25
  v_add_f32 v147, v147, v26
  v_add_f32 v147, v147, v25
  v_lshlrev_b32 v25, 16, v181
  v_and_b32 v26, 0xffff0000, v181
  v_mul_f32 v25, v25, v60
  v_mul_f32 v26, v26, v55
  v_cvt_pk_bf16_f32 v25, v25, v26
  v_lshlrev_b32 v26, 16, v25
  v_and_b32 v25, 0xffff0000, v25
  v_add_f32 v147, v147, v26
  v_add_f32 v147, v147, v25
  v_lshlrev_b32 v25, 16, v182
  v_and_b32 v26, 0xffff0000, v182
  v_mul_f32 v25, v25, v61
  v_mul_f32 v26, v26, v56
  v_cvt_pk_bf16_f32 v25, v25, v26
  v_lshlrev_b32 v26, 16, v25
  v_and_b32 v25, 0xffff0000, v25
  v_add_f32 v147, v147, v26
  v_add_f32 v147, v147, v25
  v_lshlrev_b32 v25, 16, v184
  v_and_b32 v26, 0xffff0000, v184
  v_mul_f32 v25, v25, v57
  v_mul_f32 v26, v26, v52
  v_cvt_pk_bf16_f32 v25, v25, v26
  v_lshlrev_b32 v26, 16, v25
  v_and_b32 v25, 0xffff0000, v25
  v_add_f32 v148, v25, v26
  v_lshlrev_b32 v25, 16, v185
  v_and_b32 v26, 0xffff0000, v185
  v_mul_f32 v25, v25, v58
  v_mul_f32 v26, v26, v53
  v_cvt_pk_bf16_f32 v25, v25, v26
  v_lshlrev_b32 v26, 16, v25
  v_and_b32 v25, 0xffff0000, v25
  v_add_f32 v148, v148, v26
  v_add_f32 v148, v148, v25
  v_lshlrev_b32 v25, 16, v186
  v_and_b32 v26, 0xffff0000, v186
  v_mul_f32 v25, v25, v59
  v_mul_f32 v26, v26, v54
  v_cvt_pk_bf16_f32 v25, v25, v26
  v_lshlrev_b32 v26, 16, v25
  v_and_b32 v25, 0xffff0000, v25
  v_add_f32 v148, v148, v26
  v_add_f32 v148, v148, v25
  v_lshlrev_b32 v25, 16, v187
  v_and_b32 v26, 0xffff0000, v187
  v_mul_f32 v25, v25, v60
  v_mul_f32 v26, v26, v55
  v_cvt_pk_bf16_f32 v25, v25, v26
  v_lshlrev_b32 v26, 16, v25
  v_and_b32 v25, 0xffff0000, v25
  v_add_f32 v148, v148, v26
  v_add_f32 v148, v148, v25
  v_lshlrev_b32 v25, 16, v188
  v_and_b32 v26, 0xffff0000, v188
  v_mul_f32 v25, v25, v61
  v_mul_f32 v26, v26, v56
  v_cvt_pk_bf16_f32 v25, v25, v26
  v_lshlrev_b32 v26, 16, v25
  v_and_b32 v25, 0xffff0000, v25
  v_add_f32 v148, v148, v26
  v_add_f32 v148, v148, v25
  v_lshlrev_b32 v25, 16, v190
  v_and_b32 v26, 0xffff0000, v190
  v_mul_f32 v25, v25, v57
  v_mul_f32 v26, v26, v52
  v_cvt_pk_bf16_f32 v25, v25, v26
  v_lshlrev_b32 v26, 16, v25
  v_and_b32 v25, 0xffff0000, v25
  v_add_f32 v149, v25, v26
  v_lshlrev_b32 v25, 16, v191
  v_and_b32 v26, 0xffff0000, v191
  v_mul_f32 v25, v25, v58
  v_mul_f32 v26, v26, v53
  v_cvt_pk_bf16_f32 v25, v25, v26
  v_lshlrev_b32 v26, 16, v25
  v_and_b32 v25, 0xffff0000, v25
  v_add_f32 v149, v149, v26
  v_add_f32 v149, v149, v25
  v_lshlrev_b32 v25, 16, v192
  v_and_b32 v26, 0xffff0000, v192
  v_mul_f32 v25, v25, v59
  v_mul_f32 v26, v26, v54
  v_cvt_pk_bf16_f32 v25, v25, v26
  v_lshlrev_b32 v26, 16, v25
  v_and_b32 v25, 0xffff0000, v25
  v_add_f32 v149, v149, v26
  v_add_f32 v149, v149, v25
  v_lshlrev_b32 v25, 16, v193
  v_and_b32 v26, 0xffff0000, v193
  v_mul_f32 v25, v25, v60
  v_mul_f32 v26, v26, v55
  v_cvt_pk_bf16_f32 v25, v25, v26
  v_lshlrev_b32 v26, 16, v25
  v_and_b32 v25, 0xffff0000, v25
  v_add_f32 v149, v149, v26
  v_add_f32 v149, v149, v25
  v_lshlrev_b32 v25, 16, v194
  v_and_b32 v26, 0xffff0000, v194
  v_mul_f32 v25, v25, v61
  v_mul_f32 v26, v26, v56
  v_cvt_pk_bf16_f32 v25, v25, v26
  v_lshlrev_b32 v26, 16, v25
  v_and_b32 v25, 0xffff0000, v25
  v_add_f32 v149, v149, v26
  v_add_f32 v149, v149, v25
  v_lshlrev_b32 v25, 16, v196
  v_and_b32 v26, 0xffff0000, v196
  v_mul_f32 v25, v25, v57
  v_mul_f32 v26, v26, v52
  v_cvt_pk_bf16_f32 v25, v25, v26
  v_lshlrev_b32 v26, 16, v25
  v_and_b32 v25, 0xffff0000, v25
  v_add_f32 v150, v25, v26
  v_lshlrev_b32 v25, 16, v197
  v_and_b32 v26, 0xffff0000, v197
  v_mul_f32 v25, v25, v58
  v_mul_f32 v26, v26, v53
  v_cvt_pk_bf16_f32 v25, v25, v26
  v_lshlrev_b32 v26, 16, v25
  v_and_b32 v25, 0xffff0000, v25
  v_add_f32 v150, v150, v26
  v_add_f32 v150, v150, v25
  v_lshlrev_b32 v25, 16, v198
  v_and_b32 v26, 0xffff0000, v198
  v_mul_f32 v25, v25, v59
  v_mul_f32 v26, v26, v54
  v_cvt_pk_bf16_f32 v25, v25, v26
  v_lshlrev_b32 v26, 16, v25
  v_and_b32 v25, 0xffff0000, v25
  v_add_f32 v150, v150, v26
  v_add_f32 v150, v150, v25
  v_lshlrev_b32 v25, 16, v199
  v_and_b32 v26, 0xffff0000, v199
  v_mul_f32 v25, v25, v60
  v_mul_f32 v26, v26, v55
  v_cvt_pk_bf16_f32 v25, v25, v26
  v_lshlrev_b32 v26, 16, v25
  v_and_b32 v25, 0xffff0000, v25
  v_add_f32 v150, v150, v26
  v_add_f32 v150, v150, v25
  v_lshlrev_b32 v25, 16, v200
  v_and_b32 v26, 0xffff0000, v200
  v_mul_f32 v25, v25, v61
  v_mul_f32 v26, v26, v56
  v_cvt_pk_bf16_f32 v25, v25, v26
  v_lshlrev_b32 v26, 16, v25
  v_and_b32 v25, 0xffff0000, v25
  v_add_f32 v150, v150, v26
  v_add_f32 v150, v150, v25
  v_lshlrev_b32 v25, 16, v202
  v_and_b32 v26, 0xffff0000, v202
  v_mul_f32 v25, v25, v57
  v_mul_f32 v26, v26, v52
  v_cvt_pk_bf16_f32 v25, v25, v26
  v_lshlrev_b32 v26, 16, v25
  v_and_b32 v25, 0xffff0000, v25
  v_add_f32 v151, v25, v26
  v_lshlrev_b32 v25, 16, v203
  v_and_b32 v26, 0xffff0000, v203
  v_mul_f32 v25, v25, v58
  v_mul_f32 v26, v26, v53
  v_cvt_pk_bf16_f32 v25, v25, v26
  v_lshlrev_b32 v26, 16, v25
  v_and_b32 v25, 0xffff0000, v25
  v_add_f32 v151, v151, v26
  v_add_f32 v151, v151, v25
  v_lshlrev_b32 v25, 16, v204
  v_and_b32 v26, 0xffff0000, v204
  v_mul_f32 v25, v25, v59
  v_mul_f32 v26, v26, v54
  v_cvt_pk_bf16_f32 v25, v25, v26
  v_lshlrev_b32 v26, 16, v25
  v_and_b32 v25, 0xffff0000, v25
  v_add_f32 v151, v151, v26
  v_add_f32 v151, v151, v25
  v_lshlrev_b32 v25, 16, v205
  v_and_b32 v26, 0xffff0000, v205
  v_mul_f32 v25, v25, v60
  v_mul_f32 v26, v26, v55
  v_cvt_pk_bf16_f32 v25, v25, v26
  v_lshlrev_b32 v26, 16, v25
  v_and_b32 v25, 0xffff0000, v25
  v_add_f32 v151, v151, v26
  v_add_f32 v151, v151, v25
  v_lshlrev_b32 v25, 16, v206
  v_and_b32 v26, 0xffff0000, v206
  v_mul_f32 v25, v25, v61
  v_mul_f32 v26, v26, v56
  v_cvt_pk_bf16_f32 v25, v25, v26
  v_lshlrev_b32 v26, 16, v25
  v_and_b32 v25, 0xffff0000, v25
  v_add_f32 v151, v151, v26
  v_add_f32 v151, v151, v25
  v_add_f32_dpp v144, v144, v144 row_ror:8 row_mask:0xf bank_mask:0xf
  v_add_f32_dpp v145, v145, v145 row_ror:8 row_mask:0xf bank_mask:0xf
  v_add_f32_dpp v146, v146, v146 row_ror:8 row_mask:0xf bank_mask:0xf
  v_add_f32_dpp v147, v147, v147 row_ror:8 row_mask:0xf bank_mask:0xf
  v_add_f32_dpp v148, v148, v148 row_ror:8 row_mask:0xf bank_mask:0xf
  v_add_f32_dpp v149, v149, v149 row_ror:8 row_mask:0xf bank_mask:0xf
  v_add_f32_dpp v150, v150, v150 row_ror:8 row_mask:0xf bank_mask:0xf
  v_add_f32_dpp v151, v151, v151 row_ror:8 row_mask:0xf bank_mask:0xf
  v_add_f32_dpp v144, v144, v144 row_ror:4 row_mask:0xf bank_mask:0xf
  v_add_f32_dpp v145, v145, v145 row_ror:4 row_mask:0xf bank_mask:0xf
  v_add_f32_dpp v146, v146, v146 row_ror:4 row_mask:0xf bank_mask:0xf
  v_add_f32_dpp v147, v147, v147 row_ror:4 row_mask:0xf bank_mask:0xf
  v_add_f32_dpp v148, v148, v148 row_ror:4 row_mask:0xf bank_mask:0xf
  v_add_f32_dpp v149, v149, v149 row_ror:4 row_mask:0xf bank_mask:0xf
  v_add_f32_dpp v150, v150, v150 row_ror:4 row_mask:0xf bank_mask:0xf
  v_add_f32_dpp v151, v151, v151 row_ror:4 row_mask:0xf bank_mask:0xf
  v_add_f32_dpp v144, v144, v144 row_ror:2 row_mask:0xf bank_mask:0xf
  v_add_f32_dpp v145, v145, v145 row_ror:2 row_mask:0xf bank_mask:0xf
  v_add_f32_dpp v146, v146, v146 row_ror:2 row_mask:0xf bank_mask:0xf
  v_add_f32_dpp v147, v147, v147 row_ror:2 row_mask:0xf bank_mask:0xf
  v_add_f32_dpp v148, v148, v148 row_ror:2 row_mask:0xf bank_mask:0xf
  v_add_f32_dpp v149, v149, v149 row_ror:2 row_mask:0xf bank_mask:0xf
  v_add_f32_dpp v150, v150, v150 row_ror:2 row_mask:0xf bank_mask:0xf
  v_add_f32_dpp v151, v151, v151 row_ror:2 row_mask:0xf bank_mask:0xf
  v_add_f32_dpp v144, v144, v144 row_ror:1 row_mask:0xf bank_mask:0xf
  v_add_f32_dpp v145, v145, v145 row_ror:1 row_mask:0xf bank_mask:0xf
  v_add_f32_dpp v146, v146, v146 row_ror:1 row_mask:0xf bank_mask:0xf
  v_add_f32_dpp v147, v147, v147 row_ror:1 row_mask:0xf bank_mask:0xf
  v_add_f32_dpp v148, v148, v148 row_ror:1 row_mask:0xf bank_mask:0xf
  v_add_f32_dpp v149, v149, v149 row_ror:1 row_mask:0xf bank_mask:0xf
  v_add_f32_dpp v150, v150, v150 row_ror:1 row_mask:0xf bank_mask:0xf
  v_add_f32_dpp v151, v151, v151 row_ror:1 row_mask:0xf bank_mask:0xf
  v_mov_b32 v152, v144
  v_mov_b32 v153, v145
  v_mov_b32 v154, v146
  v_mov_b32 v155, v147
  v_mov_b32 v156, v148
  v_mov_b32 v157, v149
  v_mov_b32 v158, v150
  v_mov_b32 v159, v151
  v_permlane32_swap_b32 v144, v152
  v_permlane32_swap_b32 v145, v153
  v_permlane32_swap_b32 v146, v154
  v_permlane32_swap_b32 v147, v155
  v_permlane32_swap_b32 v148, v156
  v_permlane32_swap_b32 v149, v157
  v_permlane32_swap_b32 v150, v158
  v_permlane32_swap_b32 v151, v159
  v_add_f32 v144, v144, v152
  v_add_f32 v145, v145, v153
  v_add_f32 v146, v146, v154
  v_add_f32 v147, v147, v155
  v_add_f32 v148, v148, v156
  v_add_f32 v149, v149, v157
  v_add_f32 v150, v150, v158
  v_add_f32 v151, v151, v159
  v_mov_b32 v152, v144
  v_mov_b32 v153, v145
  v_mov_b32 v154, v146
  v_mov_b32 v155, v147
  v_mov_b32 v156, v148
  v_mov_b32 v157, v149
  v_mov_b32 v158, v150
  v_mov_b32 v159, v151
  v_permlane16_swap_b32 v144, v152
  v_permlane16_swap_b32 v145, v153
  v_permlane16_swap_b32 v146, v154
  v_permlane16_swap_b32 v147, v155
  v_permlane16_swap_b32 v148, v156
  v_permlane16_swap_b32 v149, v157
  v_permlane16_swap_b32 v150, v158
  v_permlane16_swap_b32 v151, v159
  v_add_f32 v144, v144, v152
  v_add_f32 v145, v145, v153
  v_add_f32 v146, v146, v154
  v_add_f32 v147, v147, v155
  v_add_f32 v148, v148, v156
  v_add_f32 v149, v149, v157
  v_add_f32 v150, v150, v158
  v_add_f32 v151, v151, v159
  v_mov_b32 v24, v144
  v_cmp_eq_u32 vcc, 1, v1
  s_nop 1
  v_cndmask_b32 v24, v24, v145, vcc
  v_cmp_eq_u32 vcc, 2, v1
  s_nop 1
  v_cndmask_b32 v24, v24, v146, vcc
  v_cmp_eq_u32 vcc, 3, v1
  s_nop 1
  v_cndmask_b32 v24, v24, v147, vcc
  v_cmp_eq_u32 vcc, 4, v1
  s_nop 1
  v_cndmask_b32 v24, v24, v148, vcc
  v_cmp_eq_u32 vcc, 5, v1
  s_nop 1
  v_cndmask_b32 v24, v24, v149, vcc
  v_cmp_eq_u32 vcc, 6, v1
  s_nop 1
  v_cndmask_b32 v24, v24, v150, vcc
  v_cmp_eq_u32 vcc, 7, v1
  s_nop 1
  v_cndmask_b32 v24, v24, v151, vcc
  v_cvt_pk_bf16_f32 v25, v24, v24
  v_lshlrev_b32 v24, 16, v25
  v_mul_f32 v24, 0xbfb8aa3b, v24
  v_exp_f32 v24, v24
  s_nop 0
  v_add_f32 v24, 1.0, v24
  v_rcp_f32 v24, v24
  s_nop 0
  v_cvt_pk_bf16_f32 v25, v24, v24
  v_lshlrev_b32 v24, 16, v25
  s_lshl_b32 s21, s59, 2
  s_mov_b64 exec, 0xff
  buffer_store_dword v24, v5, s[28:31], s21 offen sc1
  s_mov_b64 exec, -1
  s_waitcnt vmcnt(0)
  s_barrier
  s_lshr_b32 s21, s2, 2
  s_lshl_b32 s21, s21, 7
  s_add_u32 s21, s21, 93184
  s_cmp_lg_u32 s20, 0
  s_cbranch_scc1 af_260
  v_mov_b32 v10, 0
  v_mov_b32 v11, 1
  s_mov_b64 exec, 1
  buffer_atomic_add v11, v10, s[72:75], s21 offen sc1
  s_mov_b64 exec, -1
  s_nop 1
af_260:
  s_branch om_259
om_258:
  s_load_dwordx2 s[8:9], s[0:1], 88
  s_mov_b32 s51, s21
  s_lshr_b32 s52, s2, 2
  s_lshl_b32 s52, s52, 7
  s_add_u32 s21, s52, 94208
  s_cmp_lg_u32 s20, 0
  s_cbranch_scc1 wf_262
  v_mov_b32 v20, 0
  s_mov_b32 s101, 0
wf_261:
  buffer_load_dword v21, v20, s[72:75], s21 offen sc1
  s_add_u32 s101, s101, 1
  s_cmp_gt_u32 s101, 131072
  s_cbranch_scc1 main_end
  s_waitcnt vmcnt(0)
  v_readfirstlane_b32 s100, v21
  s_cmp_ge_u32 s100, 4
  s_cbranch_scc1 wf_262
  s_sleep 32
  s_branch wf_261
wf_262:
  s_barrier
  s_add_u32 s21, s52, 104448
  s_cmp_lg_u32 s20, 0
  s_cbranch_scc1 wf_264
  v_mov_b32 v20, 0
  s_mov_b32 s101, 0
wf_263:
  buffer_load_dword v21, v20, s[72:75], s21 offen sc1
  s_add_u32 s101, s101, 1
  s_cmp_gt_u32 s101, 131072
  s_cbranch_scc1 main_end
  s_waitcnt vmcnt(0)
  v_readfirstlane_b32 s100, v21
  s_cmp_ge_u32 s100, 80
  s_cbranch_scc1 wf_264
  s_sleep 32
  s_branch wf_263
wf_264:
  s_barrier
  v_lshlrev_b32 v6, 2, v2
  s_lshl_b32 s22, s47, 6
  buffer_load_dword v30, v6, s[28:31], s22 offen sc1
  buffer_load_dword v31, v6, s[28:31], s22 offen offset:64 sc1
  s_add_u32 s22, s51, 0
  buffer_load_dwordx4 v[144:147], v4, s[16:19], s22 offen offset:0 sc1
  buffer_load_dwordx4 v[148:151], v4, s[16:19], s22 offen offset:1024 sc1
  buffer_load_dwordx4 v[152:155], v4, s[16:19], s22 offen offset:2048 sc1
  buffer_load_dwordx4 v[156:159], v4, s[16:19], s22 offen offset:3072 sc1
  s_add_u32 s22, s51, 4096
  buffer_load_dwordx4 v[160:163], v4, s[16:19], s22 offen offset:0 sc1
  buffer_load_dwordx4 v[164:167], v4, s[16:19], s22 offen offset:1024 sc1
  buffer_load_dwordx4 v[168:171], v4, s[16:19], s22 offen offset:2048 sc1
  buffer_load_dwordx4 v[172:175], v4, s[16:19], s22 offen offset:3072 sc1
  s_add_u32 s22, s51, 8192
  buffer_load_dwordx4 v[176:179], v4, s[16:19], s22 offen offset:0 sc1
  buffer_load_dwordx4 v[180:183], v4, s[16:19], s22 offen offset:1024 sc1
  s_add_u32 s22, s51, 40960
  buffer_load_dwordx4 v[184:187], v4, s[16:19], s22 offen offset:0 sc1
  buffer_load_dwordx4 v[188:191], v4, s[16:19], s22 offen offset:1024 sc1
  buffer_load_dwordx4 v[192:195], v4, s[16:19], s22 offen offset:2048 sc1
  buffer_load_dwordx4 v[196:199], v4, s[16:19], s22 offen offset:3072 sc1
  s_add_u32 s22, s51, 45056
  buffer_load_dwordx4 v[200:203], v4, s[16:19], s22 offen offset:0 sc1
  buffer_load_dwordx4 v[204:207], v4, s[16:19], s22 offen offset:1024 sc1
  buffer_load_dwordx4 v[208:211], v4, s[16:19], s22 offen offset:2048 sc1
  buffer_load_dwordx4 v[212:215], v4, s[16:19], s22 offen offset:3072 sc1
  s_add_u32 s22, s51, 49152
  buffer_load_dwordx4 v[216:219], v4, s[16:19], s22 offen offset:0 sc1
  buffer_load_dwordx4 v[220:223], v4, s[16:19], s22 offen offset:1024 sc1
  v_mul_u32_u24 v9, 1280, v2
  v_lshl_add_u32 v9, v3, 3, v9
  s_mul_i32 s22, s47, 20480
  s_add_u32 s22, s22, s45
  s_add_u32 s23, s22, 20480
  s_waitcnt vmcnt(20) lgkmcnt(0)
  v_sub_f32 v32, 1.0, v30
  v_sub_f32 v33, 1.0, v31
  v_cvt_pk_bf16_f32 v26, v32, v33
  v_lshlrev_b32 v32, 16, v26
  v_and_b32 v33, 0xffff0000, v26
  v_cvt_pk_bf16_f32 v26, v64, v65
  v_lshlrev_b32 v64, 16, v26
  v_and_b32 v65, 0xffff0000, v26
  v_mul_f32 v64, v64, v32
  v_mul_f32 v65, v65, v32
  v_cvt_pk_bf16_f32 v26, v64, v65
  v_lshlrev_b32 v64, 16, v26
  v_and_b32 v65, 0xffff0000, v26
  v_cvt_pk_bf16_f32 v26, v66, v67
  v_lshlrev_b32 v66, 16, v26
  v_and_b32 v67, 0xffff0000, v26
  v_mul_f32 v66, v66, v32
  v_mul_f32 v67, v67, v32
  v_cvt_pk_bf16_f32 v26, v66, v67
  v_lshlrev_b32 v66, 16, v26
  v_and_b32 v67, 0xffff0000, v26
  v_cvt_pk_bf16_f32 v26, v68, v69
  v_lshlrev_b32 v68, 16, v26
  v_and_b32 v69, 0xffff0000, v26
  v_mul_f32 v68, v68, v32
  v_mul_f32 v69, v69, v32
  v_cvt_pk_bf16_f32 v26, v68, v69
  v_lshlrev_b32 v68, 16, v26
  v_and_b32 v69, 0xffff0000, v26
  v_cvt_pk_bf16_f32 v26, v70, v71
  v_lshlrev_b32 v70, 16, v26
  v_and_b32 v71, 0xffff0000, v26
  v_mul_f32 v70, v70, v32
  v_mul_f32 v71, v71, v32
  v_cvt_pk_bf16_f32 v26, v70, v71
  v_lshlrev_b32 v70, 16, v26
  v_and_b32 v71, 0xffff0000, v26
  v_cvt_pk_bf16_f32 v26, v72, v73
  v_lshlrev_b32 v72, 16, v26
  v_and_b32 v73, 0xffff0000, v26
  v_mul_f32 v72, v72, v32
  v_mul_f32 v73, v73, v32
  v_cvt_pk_bf16_f32 v26, v72, v73
  v_lshlrev_b32 v72, 16, v26
  v_and_b32 v73, 0xffff0000, v26
  v_cvt_pk_bf16_f32 v26, v74, v75
  v_lshlrev_b32 v74, 16, v26
  v_and_b32 v75, 0xffff0000, v26
  v_mul_f32 v74, v74, v32
  v_mul_f32 v75, v75, v32
  v_cvt_pk_bf16_f32 v26, v74, v75
  v_lshlrev_b32 v74, 16, v26
  v_and_b32 v75, 0xffff0000, v26
  v_cvt_pk_bf16_f32 v26, v76, v77
  v_lshlrev_b32 v76, 16, v26
  v_and_b32 v77, 0xffff0000, v26
  v_mul_f32 v76, v76, v32
  v_mul_f32 v77, v77, v32
  v_cvt_pk_bf16_f32 v26, v76, v77
  v_lshlrev_b32 v76, 16, v26
  v_and_b32 v77, 0xffff0000, v26
  v_cvt_pk_bf16_f32 v26, v78, v79
  v_lshlrev_b32 v78, 16, v26
  v_and_b32 v79, 0xffff0000, v26
  v_mul_f32 v78, v78, v32
  v_mul_f32 v79, v79, v32
  v_cvt_pk_bf16_f32 v26, v78, v79
  v_lshlrev_b32 v78, 16, v26
  v_and_b32 v79, 0xffff0000, v26
  v_cvt_pk_bf16_f32 v26, v80, v81
  v_lshlrev_b32 v80, 16, v26
  v_and_b32 v81, 0xffff0000, v26
  v_mul_f32 v80, v80, v32
  v_mul_f32 v81, v81, v32
  v_cvt_pk_bf16_f32 v26, v80, v81
  v_lshlrev_b32 v80, 16, v26
  v_and_b32 v81, 0xffff0000, v26
  v_cvt_pk_bf16_f32 v26, v82, v83
  v_lshlrev_b32 v82, 16, v26
  v_and_b32 v83, 0xffff0000, v26
  v_mul_f32 v82, v82, v32
  v_mul_f32 v83, v83, v32
  v_cvt_pk_bf16_f32 v26, v82, v83
  v_lshlrev_b32 v82, 16, v26
  v_and_b32 v83, 0xffff0000, v26
  v_cvt_pk_bf16_f32 v26, v84, v85
  v_lshlrev_b32 v84, 16, v26
  v_and_b32 v85, 0xffff0000, v26
  v_mul_f32 v84, v84, v32
  v_mul_f32 v85, v85, v32
  v_cvt_pk_bf16_f32 v26, v84, v85
  v_lshlrev_b32 v84, 16, v26
  v_and_b32 v85, 0xffff0000, v26
  v_cvt_pk_bf16_f32 v26, v86, v87
  v_lshlrev_b32 v86, 16, v26
  v_and_b32 v87, 0xffff0000, v26
  v_mul_f32 v86, v86, v32
  v_mul_f32 v87, v87, v32
  v_cvt_pk_bf16_f32 v26, v86, v87
  v_lshlrev_b32 v86, 16, v26
  v_and_b32 v87, 0xffff0000, v26
  v_cvt_pk_bf16_f32 v26, v88, v89
  v_lshlrev_b32 v88, 16, v26
  v_and_b32 v89, 0xffff0000, v26
  v_mul_f32 v88, v88, v32
  v_mul_f32 v89, v89, v32
  v_cvt_pk_bf16_f32 v26, v88, v89
  v_lshlrev_b32 v88, 16, v26
  v_and_b32 v89, 0xffff0000, v26
  v_cvt_pk_bf16_f32 v26, v90, v91
  v_lshlrev_b32 v90, 16, v26
  v_and_b32 v91, 0xffff0000, v26
  v_mul_f32 v90, v90, v32
  v_mul_f32 v91, v91, v32
  v_cvt_pk_bf16_f32 v26, v90, v91
  v_lshlrev_b32 v90, 16, v26
  v_and_b32 v91, 0xffff0000, v26
  v_cvt_pk_bf16_f32 v26, v92, v93
  v_lshlrev_b32 v92, 16, v26
  v_and_b32 v93, 0xffff0000, v26
  v_mul_f32 v92, v92, v32
  v_mul_f32 v93, v93, v32
  v_cvt_pk_bf16_f32 v26, v92, v93
  v_lshlrev_b32 v92, 16, v26
  v_and_b32 v93, 0xffff0000, v26
  v_cvt_pk_bf16_f32 v26, v94, v95
  v_lshlrev_b32 v94, 16, v26
  v_and_b32 v95, 0xffff0000, v26
  v_mul_f32 v94, v94, v32
  v_mul_f32 v95, v95, v32
  v_cvt_pk_bf16_f32 v26, v94, v95
  v_lshlrev_b32 v94, 16, v26
  v_and_b32 v95, 0xffff0000, v26
  v_cvt_pk_bf16_f32 v26, v96, v97
  v_lshlrev_b32 v96, 16, v26
  v_and_b32 v97, 0xffff0000, v26
  v_mul_f32 v96, v96, v32
  v_mul_f32 v97, v97, v32
  v_cvt_pk_bf16_f32 v26, v96, v97
  v_lshlrev_b32 v96, 16, v26
  v_and_b32 v97, 0xffff0000, v26
  v_cvt_pk_bf16_f32 v26, v98, v99
  v_lshlrev_b32 v98, 16, v26
  v_and_b32 v99, 0xffff0000, v26
  v_mul_f32 v98, v98, v32
  v_mul_f32 v99, v99, v32
  v_cvt_pk_bf16_f32 v26, v98, v99
  v_lshlrev_b32 v98, 16, v26
  v_and_b32 v99, 0xffff0000, v26
  v_cvt_pk_bf16_f32 v26, v100, v101
  v_lshlrev_b32 v100, 16, v26
  v_and_b32 v101, 0xffff0000, v26
  v_mul_f32 v100, v100, v32
  v_mul_f32 v101, v101, v32
  v_cvt_pk_bf16_f32 v26, v100, v101
  v_lshlrev_b32 v100, 16, v26
  v_and_b32 v101, 0xffff0000, v26
  v_cvt_pk_bf16_f32 v26, v102, v103
  v_lshlrev_b32 v102, 16, v26
  v_and_b32 v103, 0xffff0000, v26
  v_mul_f32 v102, v102, v32
  v_mul_f32 v103, v103, v32
  v_cvt_pk_bf16_f32 v26, v102, v103
  v_lshlrev_b32 v102, 16, v26
  v_and_b32 v103, 0xffff0000, v26
  v_cvt_pk_bf16_f32 v26, v104, v105
  v_lshlrev_b32 v104, 16, v26
  v_and_b32 v105, 0xffff0000, v26
  v_mul_f32 v104, v104, v33
  v_mul_f32 v105, v105, v33
  v_cvt_pk_bf16_f32 v26, v104, v105
  v_lshlrev_b32 v104, 16, v26
  v_and_b32 v105, 0xffff0000, v26
  v_cvt_pk_bf16_f32 v26, v106, v107
  v_lshlrev_b32 v106, 16, v26
  v_and_b32 v107, 0xffff0000, v26
  v_mul_f32 v106, v106, v33
  v_mul_f32 v107, v107, v33
  v_cvt_pk_bf16_f32 v26, v106, v107
  v_lshlrev_b32 v106, 16, v26
  v_and_b32 v107, 0xffff0000, v26
  v_cvt_pk_bf16_f32 v26, v108, v109
  v_lshlrev_b32 v108, 16, v26
  v_and_b32 v109, 0xffff0000, v26
  v_mul_f32 v108, v108, v33
  v_mul_f32 v109, v109, v33
  v_cvt_pk_bf16_f32 v26, v108, v109
  v_lshlrev_b32 v108, 16, v26
  v_and_b32 v109, 0xffff0000, v26
  v_cvt_pk_bf16_f32 v26, v110, v111
  v_lshlrev_b32 v110, 16, v26
  v_and_b32 v111, 0xffff0000, v26
  v_mul_f32 v110, v110, v33
  v_mul_f32 v111, v111, v33
  v_cvt_pk_bf16_f32 v26, v110, v111
  v_lshlrev_b32 v110, 16, v26
  v_and_b32 v111, 0xffff0000, v26
  v_cvt_pk_bf16_f32 v26, v112, v113
  v_lshlrev_b32 v112, 16, v26
  v_and_b32 v113, 0xffff0000, v26
  v_mul_f32 v112, v112, v33
  v_mul_f32 v113, v113, v33
  v_cvt_pk_bf16_f32 v26, v112, v113
  v_lshlrev_b32 v112, 16, v26
  v_and_b32 v113, 0xffff0000, v26
  v_cvt_pk_bf16_f32 v26, v114, v115
  v_lshlrev_b32 v114, 16, v26
  v_and_b32 v115, 0xffff0000, v26
  v_mul_f32 v114, v114, v33
  v_mul_f32 v115, v115, v33
  v_cvt_pk_bf16_f32 v26, v114, v115
  v_lshlrev_b32 v114, 16, v26
  v_and_b32 v115, 0xffff0000, v26
  v_cvt_pk_bf16_f32 v26, v116, v117
  v_lshlrev_b32 v116, 16, v26
  v_and_b32 v117, 0xffff0000, v26
  v_mul_f32 v116, v116, v33
  v_mul_f32 v117, v117, v33
  v_cvt_pk_bf16_f32 v26, v116, v117
  v_lshlrev_b32 v116, 16, v26
  v_and_b32 v117, 0xffff0000, v26
  v_cvt_pk_bf16_f32 v26, v118, v119
  v_lshlrev_b32 v118, 16, v26
  v_and_b32 v119, 0xffff0000, v26
  v_mul_f32 v118, v118, v33
  v_mul_f32 v119, v119, v33
  v_cvt_pk_bf16_f32 v26, v118, v119
  v_lshlrev_b32 v118, 16, v26
  v_and_b32 v119, 0xffff0000, v26
  v_cvt_pk_bf16_f32 v26, v120, v121
  v_lshlrev_b32 v120, 16, v26
  v_and_b32 v121, 0xffff0000, v26
  v_mul_f32 v120, v120, v33
  v_mul_f32 v121, v121, v33
  v_cvt_pk_bf16_f32 v26, v120, v121
  v_lshlrev_b32 v120, 16, v26
  v_and_b32 v121, 0xffff0000, v26
  v_cvt_pk_bf16_f32 v26, v122, v123
  v_lshlrev_b32 v122, 16, v26
  v_and_b32 v123, 0xffff0000, v26
  v_mul_f32 v122, v122, v33
  v_mul_f32 v123, v123, v33
  v_cvt_pk_bf16_f32 v26, v122, v123
  v_lshlrev_b32 v122, 16, v26
  v_and_b32 v123, 0xffff0000, v26
  v_cvt_pk_bf16_f32 v26, v124, v125
  v_lshlrev_b32 v124, 16, v26
  v_and_b32 v125, 0xffff0000, v26
  v_mul_f32 v124, v124, v33
  v_mul_f32 v125, v125, v33
  v_cvt_pk_bf16_f32 v26, v124, v125
  v_lshlrev_b32 v124, 16, v26
  v_and_b32 v125, 0xffff0000, v26
  v_cvt_pk_bf16_f32 v26, v126, v127
  v_lshlrev_b32 v126, 16, v26
  v_and_b32 v127, 0xffff0000, v26
  v_mul_f32 v126, v126, v33
  v_mul_f32 v127, v127, v33
  v_cvt_pk_bf16_f32 v26, v126, v127
  v_lshlrev_b32 v126, 16, v26
  v_and_b32 v127, 0xffff0000, v26
  v_cvt_pk_bf16_f32 v26, v128, v129
  v_lshlrev_b32 v128, 16, v26
  v_and_b32 v129, 0xffff0000, v26
  v_mul_f32 v128, v128, v33
  v_mul_f32 v129, v129, v33
  v_cvt_pk_bf16_f32 v26, v128, v129
  v_lshlrev_b32 v128, 16, v26
  v_and_b32 v129, 0xffff0000, v26
  v_cvt_pk_bf16_f32 v26, v130, v131
  v_lshlrev_b32 v130, 16, v26
  v_and_b32 v131, 0xffff0000, v26
  v_mul_f32 v130, v130, v33
  v_mul_f32 v131, v131, v33
  v_cvt_pk_bf16_f32 v26, v130, v131
  v_lshlrev_b32 v130, 16, v26
  v_and_b32 v131, 0xffff0000, v26
  v_cvt_pk_bf16_f32 v26, v132, v133
  v_lshlrev_b32 v132, 16, v26
  v_and_b32 v133, 0xffff0000, v26
  v_mul_f32 v132, v132, v33
  v_mul_f32 v133, v133, v33
  v_cvt_pk_bf16_f32 v26, v132, v133
  v_lshlrev_b32 v132, 16, v26
  v_and_b32 v133, 0xffff0000, v26
  v_cvt_pk_bf16_f32 v26, v134, v135
  v_lshlrev_b32 v134, 16, v26
  v_and_b32 v135, 0xffff0000, v26
  v_mul_f32 v134, v134, v33
  v_mul_f32 v135, v135, v33
  v_cvt_pk_bf16_f32 v26, v134, v135
  v_lshlrev_b32 v134, 16, v26
  v_and_b32 v135, 0xffff0000, v26
  v_cvt_pk_bf16_f32 v26, v136, v137
  v_lshlrev_b32 v136, 16, v26
  v_and_b32 v137, 0xffff0000, v26
  v_mul_f32 v136, v136, v33
  v_mul_f32 v137, v137, v33
  v_cvt_pk_bf16_f32 v26, v136, v137
  v_lshlrev_b32 v136, 16, v26
  v_and_b32 v137, 0xffff0000, v26
  v_cvt_pk_bf16_f32 v26, v138, v139
  v_lshlrev_b32 v138, 16, v26
  v_and_b32 v139, 0xffff0000, v26
  v_mul_f32 v138, v138, v33
  v_mul_f32 v139, v139, v33
  v_cvt_pk_bf16_f32 v26, v138, v139
  v_lshlrev_b32 v138, 16, v26
  v_and_b32 v139, 0xffff0000, v26
  v_cvt_pk_bf16_f32 v26, v140, v141
  v_lshlrev_b32 v140, 16, v26
  v_and_b32 v141, 0xffff0000, v26
  v_mul_f32 v140, v140, v33
  v_mul_f32 v141, v141, v33
  v_cvt_pk_bf16_f32 v26, v140, v141
  v_lshlrev_b32 v140, 16, v26
  v_and_b32 v141, 0xffff0000, v26
  v_cvt_pk_bf16_f32 v26, v142, v143
  v_lshlrev_b32 v142, 16, v26
  v_and_b32 v143, 0xffff0000, v26
  v_mul_f32 v142, v142, v33
  v_mul_f32 v143, v143, v33
  v_cvt_pk_bf16_f32 v26, v142, v143
  v_lshlrev_b32 v142, 16, v26
  v_and_b32 v143, 0xffff0000, v26
  s_waitcnt vmcnt(19)
  v_cvt_pk_bf16_f32 v26, v144, v145
  v_lshlrev_b32 v144, 16, v26
  v_and_b32 v145, 0xffff0000, v26
  v_mul_f32 v144, v144, v30
  v_mul_f32 v145, v145, v30
  v_cvt_pk_bf16_f32 v26, v144, v145
  v_lshlrev_b32 v144, 16, v26
  v_and_b32 v145, 0xffff0000, v26
  v_add_f32 v144, v144, v64
  v_add_f32 v145, v145, v65
  v_cvt_pk_bf16_f32 v64, v144, v145
  v_cvt_pk_bf16_f32 v26, v146, v147
  v_lshlrev_b32 v146, 16, v26
  v_and_b32 v147, 0xffff0000, v26
  v_mul_f32 v146, v146, v30
  v_mul_f32 v147, v147, v30
  v_cvt_pk_bf16_f32 v26, v146, v147
  v_lshlrev_b32 v146, 16, v26
  v_and_b32 v147, 0xffff0000, v26
  v_add_f32 v146, v146, v66
  v_add_f32 v147, v147, v67
  v_cvt_pk_bf16_f32 v65, v146, v147
  buffer_store_dwordx2 v[64:65], v9, s[8:11], s22 offen offset:0
  s_waitcnt vmcnt(19)
  v_cvt_pk_bf16_f32 v26, v148, v149
  v_lshlrev_b32 v148, 16, v26
  v_and_b32 v149, 0xffff0000, v26
  v_mul_f32 v148, v148, v30
  v_mul_f32 v149, v149, v30
  v_cvt_pk_bf16_f32 v26, v148, v149
  v_lshlrev_b32 v148, 16, v26
  v_and_b32 v149, 0xffff0000, v26
  v_add_f32 v148, v148, v68
  v_add_f32 v149, v149, v69
  v_cvt_pk_bf16_f32 v68, v148, v149
  v_cvt_pk_bf16_f32 v26, v150, v151
  v_lshlrev_b32 v150, 16, v26
  v_and_b32 v151, 0xffff0000, v26
  v_mul_f32 v150, v150, v30
  v_mul_f32 v151, v151, v30
  v_cvt_pk_bf16_f32 v26, v150, v151
  v_lshlrev_b32 v150, 16, v26
  v_and_b32 v151, 0xffff0000, v26
  v_add_f32 v150, v150, v70
  v_add_f32 v151, v151, v71
  v_cvt_pk_bf16_f32 v69, v150, v151
  buffer_store_dwordx2 v[68:69], v9, s[8:11], s22 offen offset:32
  s_waitcnt vmcnt(19)
  v_cvt_pk_bf16_f32 v26, v152, v153
  v_lshlrev_b32 v152, 16, v26
  v_and_b32 v153, 0xffff0000, v26
  v_mul_f32 v152, v152, v30
  v_mul_f32 v153, v153, v30
  v_cvt_pk_bf16_f32 v26, v152, v153
  v_lshlrev_b32 v152, 16, v26
  v_and_b32 v153, 0xffff0000, v26
  v_add_f32 v152, v152, v72
  v_add_f32 v153, v153, v73
  v_cvt_pk_bf16_f32 v72, v152, v153
  v_cvt_pk_bf16_f32 v26, v154, v155
  v_lshlrev_b32 v154, 16, v26
  v_and_b32 v155, 0xffff0000, v26
  v_mul_f32 v154, v154, v30
  v_mul_f32 v155, v155, v30
  v_cvt_pk_bf16_f32 v26, v154, v155
  v_lshlrev_b32 v154, 16, v26
  v_and_b32 v155, 0xffff0000, v26
  v_add_f32 v154, v154, v74
  v_add_f32 v155, v155, v75
  v_cvt_pk_bf16_f32 v73, v154, v155
  buffer_store_dwordx2 v[72:73], v9, s[8:11], s22 offen offset:64
  s_waitcnt vmcnt(19)
  v_cvt_pk_bf16_f32 v26, v156, v157
  v_lshlrev_b32 v156, 16, v26
  v_and_b32 v157, 0xffff0000, v26
  v_mul_f32 v156, v156, v30
  v_mul_f32 v157, v157, v30
  v_cvt_pk_bf16_f32 v26, v156, v157
  v_lshlrev_b32 v156, 16, v26
  v_and_b32 v157, 0xffff0000, v26
  v_add_f32 v156, v156, v76
  v_add_f32 v157, v157, v77
  v_cvt_pk_bf16_f32 v76, v156, v157
  v_cvt_pk_bf16_f32 v26, v158, v159
  v_lshlrev_b32 v158, 16, v26
  v_and_b32 v159, 0xffff0000, v26
  v_mul_f32 v158, v158, v30
  v_mul_f32 v159, v159, v30
  v_cvt_pk_bf16_f32 v26, v158, v159
  v_lshlrev_b32 v158, 16, v26
  v_and_b32 v159, 0xffff0000, v26
  v_add_f32 v158, v158, v78
  v_add_f32 v159, v159, v79
  v_cvt_pk_bf16_f32 v77, v158, v159
  buffer_store_dwordx2 v[76:77], v9, s[8:11], s22 offen offset:96
  s_waitcnt vmcnt(19)
  v_cvt_pk_bf16_f32 v26, v160, v161
  v_lshlrev_b32 v160, 16, v26
  v_and_b32 v161, 0xffff0000, v26
  v_mul_f32 v160, v160, v30
  v_mul_f32 v161, v161, v30
  v_cvt_pk_bf16_f32 v26, v160, v161
  v_lshlrev_b32 v160, 16, v26
  v_and_b32 v161, 0xffff0000, v26
  v_add_f32 v160, v160, v80
  v_add_f32 v161, v161, v81
  v_cvt_pk_bf16_f32 v80, v160, v161
  v_cvt_pk_bf16_f32 v26, v162, v163
  v_lshlrev_b32 v162, 16, v26
  v_and_b32 v163, 0xffff0000, v26
  v_mul_f32 v162, v162, v30
  v_mul_f32 v163, v163, v30
  v_cvt_pk_bf16_f32 v26, v162, v163
  v_lshlrev_b32 v162, 16, v26
  v_and_b32 v163, 0xffff0000, v26
  v_add_f32 v162, v162, v82
  v_add_f32 v163, v163, v83
  v_cvt_pk_bf16_f32 v81, v162, v163
  buffer_store_dwordx2 v[80:81], v9, s[8:11], s22 offen offset:128
  s_waitcnt vmcnt(19)
  v_cvt_pk_bf16_f32 v26, v164, v165
  v_lshlrev_b32 v164, 16, v26
  v_and_b32 v165, 0xffff0000, v26
  v_mul_f32 v164, v164, v30
  v_mul_f32 v165, v165, v30
  v_cvt_pk_bf16_f32 v26, v164, v165
  v_lshlrev_b32 v164, 16, v26
  v_and_b32 v165, 0xffff0000, v26
  v_add_f32 v164, v164, v84
  v_add_f32 v165, v165, v85
  v_cvt_pk_bf16_f32 v84, v164, v165
  v_cvt_pk_bf16_f32 v26, v166, v167
  v_lshlrev_b32 v166, 16, v26
  v_and_b32 v167, 0xffff0000, v26
  v_mul_f32 v166, v166, v30
  v_mul_f32 v167, v167, v30
  v_cvt_pk_bf16_f32 v26, v166, v167
  v_lshlrev_b32 v166, 16, v26
  v_and_b32 v167, 0xffff0000, v26
  v_add_f32 v166, v166, v86
  v_add_f32 v167, v167, v87
  v_cvt_pk_bf16_f32 v85, v166, v167
  buffer_store_dwordx2 v[84:85], v9, s[8:11], s22 offen offset:160
  s_waitcnt vmcnt(19)
  v_cvt_pk_bf16_f32 v26, v168, v169
  v_lshlrev_b32 v168, 16, v26
  v_and_b32 v169, 0xffff0000, v26
  v_mul_f32 v168, v168, v30
  v_mul_f32 v169, v169, v30
  v_cvt_pk_bf16_f32 v26, v168, v169
  v_lshlrev_b32 v168, 16, v26
  v_and_b32 v169, 0xffff0000, v26
  v_add_f32 v168, v168, v88
  v_add_f32 v169, v169, v89
  v_cvt_pk_bf16_f32 v88, v168, v169
  v_cvt_pk_bf16_f32 v26, v170, v171
  v_lshlrev_b32 v170, 16, v26
  v_and_b32 v171, 0xffff0000, v26
  v_mul_f32 v170, v170, v30
  v_mul_f32 v171, v171, v30
  v_cvt_pk_bf16_f32 v26, v170, v171
  v_lshlrev_b32 v170, 16, v26
  v_and_b32 v171, 0xffff0000, v26
  v_add_f32 v170, v170, v90
  v_add_f32 v171, v171, v91
  v_cvt_pk_bf16_f32 v89, v170, v171
  buffer_store_dwordx2 v[88:89], v9, s[8:11], s22 offen offset:192
  s_waitcnt vmcnt(19)
  v_cvt_pk_bf16_f32 v26, v172, v173
  v_lshlrev_b32 v172, 16, v26
  v_and_b32 v173, 0xffff0000, v26
  v_mul_f32 v172, v172, v30
  v_mul_f32 v173, v173, v30
  v_cvt_pk_bf16_f32 v26, v172, v173
  v_lshlrev_b32 v172, 16, v26
  v_and_b32 v173, 0xffff0000, v26
  v_add_f32 v172, v172, v92
  v_add_f32 v173, v173, v93
  v_cvt_pk_bf16_f32 v92, v172, v173
  v_cvt_pk_bf16_f32 v26, v174, v175
  v_lshlrev_b32 v174, 16, v26
  v_and_b32 v175, 0xffff0000, v26
  v_mul_f32 v174, v174, v30
  v_mul_f32 v175, v175, v30
  v_cvt_pk_bf16_f32 v26, v174, v175
  v_lshlrev_b32 v174, 16, v26
  v_and_b32 v175, 0xffff0000, v26
  v_add_f32 v174, v174, v94
  v_add_f32 v175, v175, v95
  v_cvt_pk_bf16_f32 v93, v174, v175
  buffer_store_dwordx2 v[92:93], v9, s[8:11], s22 offen offset:224
  s_waitcnt vmcnt(19)
  v_cvt_pk_bf16_f32 v26, v176, v177
  v_lshlrev_b32 v176, 16, v26
  v_and_b32 v177, 0xffff0000, v26
  v_mul_f32 v176, v176, v30
  v_mul_f32 v177, v177, v30
  v_cvt_pk_bf16_f32 v26, v176, v177
  v_lshlrev_b32 v176, 16, v26
  v_and_b32 v177, 0xffff0000, v26
  v_add_f32 v176, v176, v96
  v_add_f32 v177, v177, v97
  v_cvt_pk_bf16_f32 v96, v176, v177
  v_cvt_pk_bf16_f32 v26, v178, v179
  v_lshlrev_b32 v178, 16, v26
  v_and_b32 v179, 0xffff0000, v26
  v_mul_f32 v178, v178, v30
  v_mul_f32 v179, v179, v30
  v_cvt_pk_bf16_f32 v26, v178, v179
  v_lshlrev_b32 v178, 16, v26
  v_and_b32 v179, 0xffff0000, v26
  v_add_f32 v178, v178, v98
  v_add_f32 v179, v179, v99
  v_cvt_pk_bf16_f32 v97, v178, v179
  buffer_store_dwordx2 v[96:97], v9, s[8:11], s22 offen offset:256
  s_waitcnt vmcnt(19)
  v_cvt_pk_bf16_f32 v26, v180, v181
  v_lshlrev_b32 v180, 16, v26
  v_and_b32 v181, 0xffff0000, v26
  v_mul_f32 v180, v180, v30
  v_mul_f32 v181, v181, v30
  v_cvt_pk_bf16_f32 v26, v180, v181
  v_lshlrev_b32 v180, 16, v26
  v_and_b32 v181, 0xffff0000, v26
  v_add_f32 v180, v180, v100
  v_add_f32 v181, v181, v101
  v_cvt_pk_bf16_f32 v100, v180, v181
  v_cvt_pk_bf16_f32 v26, v182, v183
  v_lshlrev_b32 v182, 16, v26
  v_and_b32 v183, 0xffff0000, v26
  v_mul_f32 v182, v182, v30
  v_mul_f32 v183, v183, v30
  v_cvt_pk_bf16_f32 v26, v182, v183
  v_lshlrev_b32 v182, 16, v26
  v_and_b32 v183, 0xffff0000, v26
  v_add_f32 v182, v182, v102
  v_add_f32 v183, v183, v103
  v_cvt_pk_bf16_f32 v101, v182, v183
  buffer_store_dwordx2 v[100:101], v9, s[8:11], s22 offen offset:288
  s_waitcnt vmcnt(19)
  v_cvt_pk_bf16_f32 v26, v184, v185
  v_lshlrev_b32 v184, 16, v26
  v_and_b32 v185, 0xffff0000, v26
  v_mul_f32 v184, v184, v31
  v_mul_f32 v185, v185, v31
  v_cvt_pk_bf16_f32 v26, v184, v185
  v_lshlrev_b32 v184, 16, v26
  v_and_b32 v185, 0xffff0000, v26
  v_add_f32 v184, v184, v104
  v_add_f32 v185, v185, v105
  v_cvt_pk_bf16_f32 v104, v184, v185
  v_cvt_pk_bf16_f32 v26, v186, v187
  v_lshlrev_b32 v186, 16, v26
  v_and_b32 v187, 0xffff0000, v26
  v_mul_f32 v186, v186, v31
  v_mul_f32 v187, v187, v31
  v_cvt_pk_bf16_f32 v26, v186, v187
  v_lshlrev_b32 v186, 16, v26
  v_and_b32 v187, 0xffff0000, v26
  v_add_f32 v186, v186, v106
  v_add_f32 v187, v187, v107
  v_cvt_pk_bf16_f32 v105, v186, v187
  buffer_store_dwordx2 v[104:105], v9, s[8:11], s23 offen offset:0
  s_waitcnt vmcnt(19)
  v_cvt_pk_bf16_f32 v26, v188, v189
  v_lshlrev_b32 v188, 16, v26
  v_and_b32 v189, 0xffff0000, v26
  v_mul_f32 v188, v188, v31
  v_mul_f32 v189, v189, v31
  v_cvt_pk_bf16_f32 v26, v188, v189
  v_lshlrev_b32 v188, 16, v26
  v_and_b32 v189, 0xffff0000, v26
  v_add_f32 v188, v188, v108
  v_add_f32 v189, v189, v109
  v_cvt_pk_bf16_f32 v108, v188, v189
  v_cvt_pk_bf16_f32 v26, v190, v191
  v_lshlrev_b32 v190, 16, v26
  v_and_b32 v191, 0xffff0000, v26
  v_mul_f32 v190, v190, v31
  v_mul_f32 v191, v191, v31
  v_cvt_pk_bf16_f32 v26, v190, v191
  v_lshlrev_b32 v190, 16, v26
  v_and_b32 v191, 0xffff0000, v26
  v_add_f32 v190, v190, v110
  v_add_f32 v191, v191, v111
  v_cvt_pk_bf16_f32 v109, v190, v191
  buffer_store_dwordx2 v[108:109], v9, s[8:11], s23 offen offset:32
  s_waitcnt vmcnt(19)
  v_cvt_pk_bf16_f32 v26, v192, v193
  v_lshlrev_b32 v192, 16, v26
  v_and_b32 v193, 0xffff0000, v26
  v_mul_f32 v192, v192, v31
  v_mul_f32 v193, v193, v31
  v_cvt_pk_bf16_f32 v26, v192, v193
  v_lshlrev_b32 v192, 16, v26
  v_and_b32 v193, 0xffff0000, v26
  v_add_f32 v192, v192, v112
  v_add_f32 v193, v193, v113
  v_cvt_pk_bf16_f32 v112, v192, v193
  v_cvt_pk_bf16_f32 v26, v194, v195
  v_lshlrev_b32 v194, 16, v26
  v_and_b32 v195, 0xffff0000, v26
  v_mul_f32 v194, v194, v31
  v_mul_f32 v195, v195, v31
  v_cvt_pk_bf16_f32 v26, v194, v195
  v_lshlrev_b32 v194, 16, v26
  v_and_b32 v195, 0xffff0000, v26
  v_add_f32 v194, v194, v114
  v_add_f32 v195, v195, v115
  v_cvt_pk_bf16_f32 v113, v194, v195
  buffer_store_dwordx2 v[112:113], v9, s[8:11], s23 offen offset:64
  s_waitcnt vmcnt(19)
  v_cvt_pk_bf16_f32 v26, v196, v197
  v_lshlrev_b32 v196, 16, v26
  v_and_b32 v197, 0xffff0000, v26
  v_mul_f32 v196, v196, v31
  v_mul_f32 v197, v197, v31
  v_cvt_pk_bf16_f32 v26, v196, v197
  v_lshlrev_b32 v196, 16, v26
  v_and_b32 v197, 0xffff0000, v26
  v_add_f32 v196, v196, v116
  v_add_f32 v197, v197, v117
  v_cvt_pk_bf16_f32 v116, v196, v197
  v_cvt_pk_bf16_f32 v26, v198, v199
  v_lshlrev_b32 v198, 16, v26
  v_and_b32 v199, 0xffff0000, v26
  v_mul_f32 v198, v198, v31
  v_mul_f32 v199, v199, v31
  v_cvt_pk_bf16_f32 v26, v198, v199
  v_lshlrev_b32 v198, 16, v26
  v_and_b32 v199, 0xffff0000, v26
  v_add_f32 v198, v198, v118
  v_add_f32 v199, v199, v119
  v_cvt_pk_bf16_f32 v117, v198, v199
  buffer_store_dwordx2 v[116:117], v9, s[8:11], s23 offen offset:96
  s_waitcnt vmcnt(19)
  v_cvt_pk_bf16_f32 v26, v200, v201
  v_lshlrev_b32 v200, 16, v26
  v_and_b32 v201, 0xffff0000, v26
  v_mul_f32 v200, v200, v31
  v_mul_f32 v201, v201, v31
  v_cvt_pk_bf16_f32 v26, v200, v201
  v_lshlrev_b32 v200, 16, v26
  v_and_b32 v201, 0xffff0000, v26
  v_add_f32 v200, v200, v120
  v_add_f32 v201, v201, v121
  v_cvt_pk_bf16_f32 v120, v200, v201
  v_cvt_pk_bf16_f32 v26, v202, v203
  v_lshlrev_b32 v202, 16, v26
  v_and_b32 v203, 0xffff0000, v26
  v_mul_f32 v202, v202, v31
  v_mul_f32 v203, v203, v31
  v_cvt_pk_bf16_f32 v26, v202, v203
  v_lshlrev_b32 v202, 16, v26
  v_and_b32 v203, 0xffff0000, v26
  v_add_f32 v202, v202, v122
  v_add_f32 v203, v203, v123
  v_cvt_pk_bf16_f32 v121, v202, v203
  buffer_store_dwordx2 v[120:121], v9, s[8:11], s23 offen offset:128
  s_waitcnt vmcnt(19)
  v_cvt_pk_bf16_f32 v26, v204, v205
  v_lshlrev_b32 v204, 16, v26
  v_and_b32 v205, 0xffff0000, v26
  v_mul_f32 v204, v204, v31
  v_mul_f32 v205, v205, v31
  v_cvt_pk_bf16_f32 v26, v204, v205
  v_lshlrev_b32 v204, 16, v26
  v_and_b32 v205, 0xffff0000, v26
  v_add_f32 v204, v204, v124
  v_add_f32 v205, v205, v125
  v_cvt_pk_bf16_f32 v124, v204, v205
  v_cvt_pk_bf16_f32 v26, v206, v207
  v_lshlrev_b32 v206, 16, v26
  v_and_b32 v207, 0xffff0000, v26
  v_mul_f32 v206, v206, v31
  v_mul_f32 v207, v207, v31
  v_cvt_pk_bf16_f32 v26, v206, v207
  v_lshlrev_b32 v206, 16, v26
  v_and_b32 v207, 0xffff0000, v26
  v_add_f32 v206, v206, v126
  v_add_f32 v207, v207, v127
  v_cvt_pk_bf16_f32 v125, v206, v207
  buffer_store_dwordx2 v[124:125], v9, s[8:11], s23 offen offset:160
  s_waitcnt vmcnt(19)
  v_cvt_pk_bf16_f32 v26, v208, v209
  v_lshlrev_b32 v208, 16, v26
  v_and_b32 v209, 0xffff0000, v26
  v_mul_f32 v208, v208, v31
  v_mul_f32 v209, v209, v31
  v_cvt_pk_bf16_f32 v26, v208, v209
  v_lshlrev_b32 v208, 16, v26
  v_and_b32 v209, 0xffff0000, v26
  v_add_f32 v208, v208, v128
  v_add_f32 v209, v209, v129
  v_cvt_pk_bf16_f32 v128, v208, v209
  v_cvt_pk_bf16_f32 v26, v210, v211
  v_lshlrev_b32 v210, 16, v26
  v_and_b32 v211, 0xffff0000, v26
  v_mul_f32 v210, v210, v31
  v_mul_f32 v211, v211, v31
  v_cvt_pk_bf16_f32 v26, v210, v211
  v_lshlrev_b32 v210, 16, v26
  v_and_b32 v211, 0xffff0000, v26
  v_add_f32 v210, v210, v130
  v_add_f32 v211, v211, v131
  v_cvt_pk_bf16_f32 v129, v210, v211
  buffer_store_dwordx2 v[128:129], v9, s[8:11], s23 offen offset:192
  s_waitcnt vmcnt(19)
  v_cvt_pk_bf16_f32 v26, v212, v213
  v_lshlrev_b32 v212, 16, v26
  v_and_b32 v213, 0xffff0000, v26
  v_mul_f32 v212, v212, v31
  v_mul_f32 v213, v213, v31
  v_cvt_pk_bf16_f32 v26, v212, v213
  v_lshlrev_b32 v212, 16, v26
  v_and_b32 v213, 0xffff0000, v26
  v_add_f32 v212, v212, v132
  v_add_f32 v213, v213, v133
  v_cvt_pk_bf16_f32 v132, v212, v213
  v_cvt_pk_bf16_f32 v26, v214, v215
  v_lshlrev_b32 v214, 16, v26
  v_and_b32 v215, 0xffff0000, v26
  v_mul_f32 v214, v214, v31
  v_mul_f32 v215, v215, v31
  v_cvt_pk_bf16_f32 v26, v214, v215
  v_lshlrev_b32 v214, 16, v26
  v_and_b32 v215, 0xffff0000, v26
  v_add_f32 v214, v214, v134
  v_add_f32 v215, v215, v135
  v_cvt_pk_bf16_f32 v133, v214, v215
  buffer_store_dwordx2 v[132:133], v9, s[8:11], s23 offen offset:224
  s_waitcnt vmcnt(19)
  v_cvt_pk_bf16_f32 v26, v216, v217
  v_lshlrev_b32 v216, 16, v26
  v_and_b32 v217, 0xffff0000, v26
  v_mul_f32 v216, v216, v31
  v_mul_f32 v217, v217, v31
  v_cvt_pk_bf16_f32 v26, v216, v217
  v_lshlrev_b32 v216, 16, v26
  v_and_b32 v217, 0xffff0000, v26
  v_add_f32 v216, v216, v136
  v_add_f32 v217, v217, v137
  v_cvt_pk_bf16_f32 v136, v216, v217
  v_cvt_pk_bf16_f32 v26, v218, v219
  v_lshlrev_b32 v218, 16, v26
  v_and_b32 v219, 0xffff0000, v26
  v_mul_f32 v218, v218, v31
  v_mul_f32 v219, v219, v31
  v_cvt_pk_bf16_f32 v26, v218, v219
  v_lshlrev_b32 v218, 16, v26
  v_and_b32 v219, 0xffff0000, v26
  v_add_f32 v218, v218, v138
  v_add_f32 v219, v219, v139
  v_cvt_pk_bf16_f32 v137, v218, v219
  buffer_store_dwordx2 v[136:137], v9, s[8:11], s23 offen offset:256
  s_waitcnt vmcnt(19)
  v_cvt_pk_bf16_f32 v26, v220, v221
  v_lshlrev_b32 v220, 16, v26
  v_and_b32 v221, 0xffff0000, v26
  v_mul_f32 v220, v220, v31
  v_mul_f32 v221, v221, v31
  v_cvt_pk_bf16_f32 v26, v220, v221
  v_lshlrev_b32 v220, 16, v26
  v_and_b32 v221, 0xffff0000, v26
  v_add_f32 v220, v220, v140
  v_add_f32 v221, v221, v141
  v_cvt_pk_bf16_f32 v140, v220, v221
  v_cvt_pk_bf16_f32 v26, v222, v223
  v_lshlrev_b32 v222, 16, v26
  v_and_b32 v223, 0xffff0000, v26
  v_mul_f32 v222, v222, v31
  v_mul_f32 v223, v223, v31
  v_cvt_pk_bf16_f32 v26, v222, v223
  v_lshlrev_b32 v222, 16, v26
  v_and_b32 v223, 0xffff0000, v26
  v_add_f32 v222, v222, v142
  v_add_f32 v223, v223, v143
  v_cvt_pk_bf16_f32 v141, v222, v223
  buffer_store_dwordx2 v[140:141], v9, s[8:11], s23 offen offset:288
om_259:
  s_cmp_eq_u32 s87, -2
  s_cbranch_scc1 kv_help
  s_waitcnt vmcnt(0) lgkmcnt(0)
  s_barrier
  s_add_u32 s21, s2, 24
  s_cmp_lt_u32 s21, 32
  s_cbranch_scc1 do_opb2
  s_cmp_eq_u32 s87, -1
  s_cbranch_scc1 queue
tail_item:
  s_load_dwordx2 s[4:5], s[0:1], 96
  s_waitcnt lgkmcnt(0)
  s_mov_b32 s32, s4
  s_mov_b32 s33, s5
  s_mov_b32 s34, 256
  s_mov_b32 s35, 0x00020000
  s_waitcnt vmcnt(0)
  s_barrier
  s_mov_b32 s21, s87
do_pv:
  s_mov_b32 s2, s21
  s_load_dwordx2 s[4:5], s[0:1], 88
  s_load_dwordx2 s[38:39], s[0:1], 104
  s_waitcnt lgkmcnt(0)
  s_mov_b32 s8, s4
  s_mov_b32 s9, s5
  s_mov_b32 s10, 2621440
  s_mov_b32 s11, 0x00020000
  s_add_u32 s12, s38, 114294784
  s_addc_u32 s13, s39, 0
  s_mov_b32 s14, 83886080
  s_mov_b32 s15, 0x00020000
  s_mov_b32 s59, 0
  s_mov_b32 s60, 0
  s_add_u32 s16, s38, 85983232
  s_addc_u32 s17, s39, 0
  s_mov_b32 s18, 28311552
  s_mov_b32 s19, 0x00020000
  s_add_u32 s24, s38, 73400320
  s_addc_u32 s25, s39, 0
  s_mov_b32 s26, 5242880
  s_mov_b32 s27, 0x00020000
  s_add_u32 s28, s38, 81002496
  s_addc_u32 s29, s39, 0
  s_mov_b32 s30, 8192
  s_mov_b32 s31, 0x00020000
  s_add_u32 s72, s38, 81068032
  s_addc_u32 s73, s39, 0
  s_mov_b32 s74, 116736
  s_mov_b32 s75, 0x00020000
  v_lshlrev_b32 v4, 4, v1
  v_lshlrev_b32 v5, 3, v1
  v_lshlrev_b32 v6, 2, v2
  v_and_b32 v7, 7, v1
  v_lshlrev_b32 v7, 7, v7
  v_lshrrev_b32 v31, 3, v1
  v_lshl_add_u32 v208, v31, 10, v7
  v_bfe_u32 v31, v1, 3, 2
  v_lshl_add_u32 v31, v31, 2, v7
  s_lshl_b32 s21, s20, 10
  s_add_u32 s21, s21, 95232
  buffer_load_dword v8, v31, s[72:75], s21 offen sc1
  v_lshlrev_b32 v25, 7, v2
  s_mov_b32 s21, 93184
  buffer_load_dword v26, v25, s[72:75], s21 offen sc1
  s_mov_b32 s63, 1
  v_mul_u32_u24 v9, 1280, v2
  v_lshl_add_u32 v9, v3, 3, v9
  s_lshl_b32 s21, s20, 13
  v_add_u32 v10, s21, v4
  s_lshl_b32 s21, s20, 10
  v_add_u32 v11, s21, v4
  v_lshrrev_b32 v20, 5, v1
  v_mul_u32_u24 v21, 2560, v20
  v_add_u32 v21, v21, v4
  v_and_b32 v22, 31, v1
  v_lshlrev_b32 v22, 4, v22
  v_mul_u32_u24 v20, 10240, v20
  v_add_u32 v22, v22, v20
  v_mul_u32_u24 v21, 2560, v3
  v_lshl_add_u32 v21, v2, 4, v21
  v_mul_u32_u24 v22, 10240, v3
  v_lshl_add_u32 v22, v2, 4, v22
  v_mov_b32 v28, 80
  v_mov_b32 v30, 32768
  s_mov_b32 s50, 0
  s_mov_b32 s71, 0
  s_mov_b32 s51, 0
  s_and_b32 s43, s20, 1
  s_lshr_b32 s44, s20, 1
  v_mov_b32 v70, 0
  v_mov_b32 v71, 0
  v_mov_b32 v78, 0
  v_mov_b32 v79, 0
  v_mov_b32 v86, 0
  v_mov_b32 v87, 0
  v_mov_b32 v94, 0
  v_mov_b32 v95, 0
  v_mov_b32 v102, 0
  v_mov_b32 v103, 0
  v_mov_b32 v110, 0
  v_mov_b32 v111, 0
  v_mov_b32 v118, 0
  v_mov_b32 v119, 0
  v_mov_b32 v126, 0
  v_mov_b32 v127, 0
  s_mov_b32 s21, s2
pv_loop:
  s_mul_i32 s2, s21, 2
  s_add_u32 s22, s21, 250
  s_cmp_lt_u32 s21, 250
  s_cselect_b32 s2, s2, s22
  s_cselect_b32 s65, 1, 0
  s_mul_hi_u32 s40, s2, 0x1999999a
  s_mul_i32 s21, s40, 10
  s_sub_u32 s41, s2, s21
  s_lshl_b32 s52, s40, 10
  s_add_u32 s52, s52, 23552
  buffer_load_dword v27, v7, s[72:75], s52 offen sc1
  s_cmp_lg_u32 s20, 0
  s_cbranch_scc1 pv_273
  s_sub_u32 s21, s2, 400
  s_cmp_lt_u32 s21, 240
  s_cbranch_scc1 pv_273
  v_mov_b32 v29, 1
  s_mov_b64 exec, 1
  buffer_atomic_add v29, v28, s[32:35], 0 offen sc0 sc1
  s_mov_b64 exec, -1
pv_273:
  s_lshl_b32 s42, s40, 5
  s_lshl_b32 s21, s20, 3
  s_add_u32 s42, s42, s21
  s_mul_i32 s61, s21, 5
  s_lshr_b32 s22, s41, 1
  s_add_u32 s61, s61, s22
  s_and_b32 s62, s41, 1
  s_lshl_b32 s62, s62, 12
  s_mul_i32 s53, s42, 40960
  s_lshl_b32 s22, s41, 12
  s_add_u32 s53, s53, s22
  s_lshl_b32 s21, s40, 1
  s_add_u32 s21, s21, s43
  s_lshl_b32 s45, s21, 6
  s_mul_i32 s46, s21, 20480
  s_mul_i32 s21, s21, 40
  s_lshl_b32 s22, s41, 2
  s_add_u32 s22, s22, s44
  s_add_u32 s21, s21, s22
  s_lshl_b32 s54, s21, 10
  s_lshl_b32 s22, s22, 5
  s_add_u32 s46, s46, s22
  s_mul_i32 s47, s42, 2560
  s_mul_i32 s48, s42, 10240
  s_lshl_b32 s22, s41, 10
  s_add_u32 s48, s48, s22
  s_add_u32 s48, s48, 7340032
  s_add_u32 s23, s40, 1
  s_cmp_ge_u32 s50, s23
  s_cbranch_scc1 pv_266
  s_cmp_eq_u32 s63, 0
  s_cbranch_scc1 pv_269
  s_mov_b32 s63, 0
  s_waitcnt vmcnt(1)
  v_cmp_le_u32 vcc, 4, v26
  s_mov_b32 s51, vcc_lo
  v_cmp_gt_u32 vcc, s23, v8
  s_nop 1
  s_cbranch_vccz pv_270
pv_269:
  s_lshl_b32 s21, s20, 10
  s_add_u32 s21, s21, 95232
  s_mov_b32 s101, 0
wm_274:
  buffer_load_dword v8, v31, s[72:75], s21 offen sc1
  s_add_u32 s101, s101, 1
  s_cmp_gt_u32 s101, 131072
  s_cbranch_scc1 main_end
  s_waitcnt vmcnt(0)
  v_cmp_gt_u32 vcc, s23, v8
  v_readfirstlane_b32 s100, v8
  s_nop 0
  s_cbranch_vccz wm_275
  s_sleep 8
  s_add_u32 s100, s100, 2
  s_cmp_ge_u32 s100, s23
  s_cbranch_scc1 wm_274
  s_sleep 60
  s_branch wm_274
wm_275:
pv_270:
  v_readlane_b32 s50, v8, 0
  v_readlane_b32 s21, v8, 1
  s_min_u32 s50, s50, s21
  v_readlane_b32 s21, v8, 2
  s_min_u32 s50, s50, s21
  v_readlane_b32 s21, v8, 3
  s_min_u32 s50, s50, s21
  v_readlane_b32 s21, v8, 4
  s_min_u32 s50, s50, s21
  v_readlane_b32 s21, v8, 5
  s_min_u32 s50, s50, s21
  v_readlane_b32 s21, v8, 6
  s_min_u32 s50, s50, s21
  v_readlane_b32 s21, v8, 7
  s_min_u32 s50, s50, s21
  v_readlane_b32 s21, v8, 8
  s_min_u32 s50, s50, s21
  v_readlane_b32 s21, v8, 9
  s_min_u32 s50, s50, s21
  v_readlane_b32 s21, v8, 10
  s_min_u32 s50, s50, s21
  v_readlane_b32 s21, v8, 11
  s_min_u32 s50, s50, s21
  v_readlane_b32 s21, v8, 12
  s_min_u32 s50, s50, s21
  v_readlane_b32 s21, v8, 13
  s_min_u32 s50, s50, s21
  v_readlane_b32 s21, v8, 14
  s_min_u32 s50, s50, s21
  v_readlane_b32 s21, v8, 15
  s_min_u32 s50, s50, s21
  v_readlane_b32 s21, v8, 16
  s_min_u32 s50, s50, s21
  v_readlane_b32 s21, v8, 17
  s_min_u32 s50, s50, s21
  v_readlane_b32 s21, v8, 18
  s_min_u32 s50, s50, s21
  v_readlane_b32 s21, v8, 19
  s_min_u32 s50, s50, s21
  v_readlane_b32 s21, v8, 20
  s_min_u32 s50, s50, s21
  v_readlane_b32 s21, v8, 21
  s_min_u32 s50, s50, s21
  v_readlane_b32 s21, v8, 22
  s_min_u32 s50, s50, s21
  v_readlane_b32 s21, v8, 23
  s_min_u32 s50, s50, s21
  v_readlane_b32 s21, v8, 24
  s_min_u32 s50, s50, s21
  v_readlane_b32 s21, v8, 25
  s_min_u32 s50, s50, s21
  v_readlane_b32 s21, v8, 26
  s_min_u32 s50, s50, s21
  v_readlane_b32 s21, v8, 27
  s_min_u32 s50, s50, s21
  v_readlane_b32 s21, v8, 28
  s_min_u32 s50, s50, s21
  v_readlane_b32 s21, v8, 29
  s_min_u32 s50, s50, s21
  v_readlane_b32 s21, v8, 30
  s_min_u32 s50, s50, s21
  v_readlane_b32 s21, v8, 31
  s_min_u32 s50, s50, s21
pv_266:
  s_lshr_b32 s22, s40, 2
  s_cmp_lt_u32 s40, 32
  s_cbranch_scc1 pv_267
  s_bitcmp1_b32 s51, s22
  s_cbranch_scc1 pv_267
  s_mov_b32 s21, 93184
  v_lshlrev_b32 v25, 7, v2
  s_mov_b32 s101, 0
pv_268:
  buffer_load_dword v26, v25, s[72:75], s21 offen sc1
  s_add_u32 s101, s101, 1
  s_cmp_gt_u32 s101, 131072
  s_cbranch_scc1 main_end
  s_waitcnt vmcnt(0)
  v_cmp_le_u32 vcc, 4, v26
  s_mov_b32 s51, vcc_lo
  s_bitcmp1_b32 s51, s22
  s_cbranch_scc1 pv_267
  s_sleep 8
  s_branch pv_268
pv_267:
  buffer_load_dwordx4 a[0:3], v4, s[12:15], s53 offen offset:0 sc1
  buffer_load_dwordx4 a[4:7], v4, s[12:15], s53 offen offset:1024 sc1
  buffer_load_dwordx4 a[8:11], v4, s[12:15], s53 offen offset:2048 sc1
  buffer_load_dwordx4 a[12:15], v4, s[12:15], s53 offen offset:3072 sc1
  s_add_u32 s53, s53, 40960
  buffer_load_dwordx4 a[16:19], v4, s[12:15], s53 offen offset:0 sc1
  buffer_load_dwordx4 a[20:23], v4, s[12:15], s53 offen offset:1024 sc1
  buffer_load_dwordx4 a[24:27], v4, s[12:15], s53 offen offset:2048 sc1
  buffer_load_dwordx4 a[28:31], v4, s[12:15], s53 offen offset:3072 sc1
  s_add_u32 s53, s53, 40960
  buffer_load_dwordx4 a[32:35], v4, s[12:15], s53 offen offset:0 sc1
  buffer_load_dwordx4 a[36:39], v4, s[12:15], s53 offen offset:1024 sc1
  buffer_load_dwordx4 a[40:43], v4, s[12:15], s53 offen offset:2048 sc1
  buffer_load_dwordx4 a[44:47], v4, s[12:15], s53 offen offset:3072 sc1
  s_add_u32 s53, s53, 40960
  buffer_load_dwordx4 a[48:51], v4, s[12:15], s53 offen offset:0 sc1
  buffer_load_dwordx4 a[52:55], v4, s[12:15], s53 offen offset:1024 sc1
  buffer_load_dwordx4 a[56:59], v4, s[12:15], s53 offen offset:2048 sc1
  buffer_load_dwordx4 a[60:63], v4, s[12:15], s53 offen offset:3072 sc1
  s_add_u32 s53, s53, 40960
  buffer_load_dwordx4 a[64:67], v4, s[12:15], s53 offen offset:0 sc1
  buffer_load_dwordx4 a[68:71], v4, s[12:15], s53 offen offset:1024 sc1
  buffer_load_dwordx4 a[72:75], v4, s[12:15], s53 offen offset:2048 sc1
  buffer_load_dwordx4 a[76:79], v4, s[12:15], s53 offen offset:3072 sc1
  s_add_u32 s53, s53, 40960
  buffer_load_dwordx4 a[80:83], v4, s[12:15], s53 offen offset:0 sc1
  buffer_load_dwordx4 a[84:87], v4, s[12:15], s53 offen offset:1024 sc1
  buffer_load_dwordx4 a[88:91], v4, s[12:15], s53 offen offset:2048 sc1
  buffer_load_dwordx4 a[92:95], v4, s[12:15], s53 offen offset:3072 sc1
  s_add_u32 s53, s53, 40960
  buffer_load_dwordx4 a[96:99], v4, s[12:15], s53 offen offset:0 sc1
  buffer_load_dwordx4 a[100:103], v4, s[12:15], s53 offen offset:1024 sc1
  buffer_load_dwordx4 a[104:107], v4, s[12:15], s53 offen offset:2048 sc1
  buffer_load_dwordx4 a[108:111], v4, s[12:15], s53 offen offset:3072 sc1
  s_add_u32 s53, s53, 40960
  buffer_load_dwordx4 a[112:115], v4, s[12:15], s53 offen offset:0 sc1
  buffer_load_dwordx4 a[116:119], v4, s[12:15], s53 offen offset:1024 sc1
  buffer_load_dwordx4 a[120:123], v4, s[12:15], s53 offen offset:2048 sc1
  buffer_load_dwordx4 a[124:127], v4, s[12:15], s53 offen offset:3072 sc1
  s_cmp_lt_u32 s40, 32
  s_cselect_b32 s70, 0x80000000, s54
  buffer_load_dwordx4 v[12:15], v4, s[24:27], s70 offen sc1
  buffer_load_dwordx4 v[16:19], v4, s[24:27], s70 offen offset:2048 sc1
  buffer_load_dword v24, v6, s[28:31], s45 offen sc1
  s_waitcnt vmcnt(35)
  s_cmp_eq_u32 s71, 0
  s_cbranch_scc1 paf_278
  v_mov_b32 v25, 0
  v_mov_b32 v26, 1
  s_mov_b64 exec, 1
  buffer_atomic_add v26, v25, s[72:75], s71 offen sc1
  s_mov_b64 exec, -1
  s_mov_b32 s71, 0
paf_278:
  v_cmp_le_u32 s[68:69], 4, v27
  s_nop 1
  s_and_b32 s21, s68, 255
  s_cmp_lg_u32 s21, 255
  s_cbranch_scc1 pvw_271
  s_mov_b32 s56, s47
  s_mov_b32 s57, s48
  buffer_load_dwordx4 v[64:67], v4, s[16:19], s56 offen sc1
  buffer_load_dwordx2 v[68:69], v5, s[16:19], s56 offen offset:2048 sc1
  buffer_load_dwordx4 v[128:131], v21, s[16:19], s56 offen offset:1024 sc1
  buffer_load_dwordx4 v[132:135], v21, s[16:19], s56 offen offset:1280 sc1
  s_add_u32 s56, s56, 2560
  buffer_load_dwordx4 v[72:75], v4, s[16:19], s56 offen sc1
  buffer_load_dwordx2 v[76:77], v5, s[16:19], s56 offen offset:2048 sc1
  s_add_u32 s56, s56, 2560
  buffer_load_dwordx4 v[80:83], v4, s[16:19], s56 offen sc1
  buffer_load_dwordx2 v[84:85], v5, s[16:19], s56 offen offset:2048 sc1
  s_add_u32 s56, s56, 2560
  buffer_load_dwordx4 v[88:91], v4, s[16:19], s56 offen sc1
  buffer_load_dwordx2 v[92:93], v5, s[16:19], s56 offen offset:2048 sc1
  s_add_u32 s56, s56, 2560
  buffer_load_dwordx4 v[32:35], v22, s[16:19], s57 offen offset:0 sc1
  buffer_load_dwordx4 v[36:39], v22, s[16:19], s57 offen offset:256 sc1
  buffer_load_dwordx4 v[40:43], v22, s[16:19], s57 offen offset:512 sc1
  buffer_load_dwordx4 v[44:47], v22, s[16:19], s57 offen offset:768 sc1
  s_add_u32 s57, s57, 40960
  buffer_load_dwordx4 v[96:99], v4, s[16:19], s56 offen sc1
  buffer_load_dwordx2 v[100:101], v5, s[16:19], s56 offen offset:2048 sc1
  buffer_load_dwordx4 v[136:139], v21, s[16:19], s56 offen offset:1024 sc1
  buffer_load_dwordx4 v[140:143], v21, s[16:19], s56 offen offset:1280 sc1
  s_add_u32 s56, s56, 2560
  buffer_load_dwordx4 v[104:107], v4, s[16:19], s56 offen sc1
  buffer_load_dwordx2 v[108:109], v5, s[16:19], s56 offen offset:2048 sc1
  s_add_u32 s56, s56, 2560
  buffer_load_dwordx4 v[112:115], v4, s[16:19], s56 offen sc1
  buffer_load_dwordx2 v[116:117], v5, s[16:19], s56 offen offset:2048 sc1
  s_add_u32 s56, s56, 2560
  buffer_load_dwordx4 v[120:123], v4, s[16:19], s56 offen sc1
  buffer_load_dwordx2 v[124:125], v5, s[16:19], s56 offen offset:2048 sc1
  s_add_u32 s56, s56, 2560
  buffer_load_dwordx4 v[48:51], v22, s[16:19], s57 offen offset:0 sc1
  buffer_load_dwordx4 v[52:55], v22, s[16:19], s57 offen offset:256 sc1
  buffer_load_dwordx4 v[56:59], v22, s[16:19], s57 offen offset:512 sc1
  buffer_load_dwordx4 v[60:63], v22, s[16:19], s57 offen offset:768 sc1
  s_add_u32 s57, s57, 40960
  s_barrier
  s_waitcnt vmcnt(28)
  v_sub_f32 v25, 1.0, v24
  v_cvt_pk_bf16_f32 v26, v25, v25
  v_lshlrev_b32 v25, 16, v26
  v_cvt_pk_bf16_f32 v26, v12, v12
  v_lshlrev_b32 v12, 16, v26
  v_cvt_pk_bf16_f32 v26, v13, v13
  v_lshlrev_b32 v13, 16, v26
  v_cvt_pk_bf16_f32 v26, v14, v14
  v_lshlrev_b32 v14, 16, v26
  v_cvt_pk_bf16_f32 v26, v15, v15
  v_lshlrev_b32 v15, 16, v26
  v_cvt_pk_bf16_f32 v26, v16, v16
  v_lshlrev_b32 v16, 16, v26
  v_cvt_pk_bf16_f32 v26, v17, v17
  v_lshlrev_b32 v17, 16, v26
  v_cvt_pk_bf16_f32 v26, v18, v18
  v_lshlrev_b32 v18, 16, v26
  v_cvt_pk_bf16_f32 v26, v19, v19
  v_lshlrev_b32 v19, 16, v26
  v_mul_f32 v12, v12, v25
  v_cvt_pk_bf16_f32 v26, v12, v12
  v_lshlrev_b32 v12, 16, v26
  v_mul_f32 v13, v13, v25
  v_cvt_pk_bf16_f32 v26, v13, v13
  v_lshlrev_b32 v13, 16, v26
  v_mul_f32 v14, v14, v25
  v_cvt_pk_bf16_f32 v26, v14, v14
  v_lshlrev_b32 v14, 16, v26
  v_mul_f32 v15, v15, v25
  v_cvt_pk_bf16_f32 v26, v15, v15
  v_lshlrev_b32 v15, 16, v26
  v_mul_f32 v16, v16, v25
  v_cvt_pk_bf16_f32 v26, v16, v16
  v_lshlrev_b32 v16, 16, v26
  v_mul_f32 v17, v17, v25
  v_cvt_pk_bf16_f32 v26, v17, v17
  v_lshlrev_b32 v17, 16, v26
  v_mul_f32 v18, v18, v25
  v_cvt_pk_bf16_f32 v26, v18, v18
  v_lshlrev_b32 v18, 16, v26
  v_mul_f32 v19, v19, v25
  v_cvt_pk_bf16_f32 v26, v19, v19
  v_lshlrev_b32 v19, 16, v26
  s_cmp_ge_u32 s40, 56
  s_cbranch_scc1 pvc_277
  s_branch pvg_276
pvw_271:
  s_waitcnt vmcnt(0)
  v_sub_f32 v25, 1.0, v24
  v_cvt_pk_bf16_f32 v26, v25, v25
  v_lshlrev_b32 v25, 16, v26
  v_cvt_pk_bf16_f32 v26, v12, v12
  v_lshlrev_b32 v12, 16, v26
  v_cvt_pk_bf16_f32 v26, v13, v13
  v_lshlrev_b32 v13, 16, v26
  v_cvt_pk_bf16_f32 v26, v14, v14
  v_lshlrev_b32 v14, 16, v26
  v_cvt_pk_bf16_f32 v26, v15, v15
  v_lshlrev_b32 v15, 16, v26
  v_cvt_pk_bf16_f32 v26, v16, v16
  v_lshlrev_b32 v16, 16, v26
  v_cvt_pk_bf16_f32 v26, v17, v17
  v_lshlrev_b32 v17, 16, v26
  v_cvt_pk_bf16_f32 v26, v18, v18
  v_lshlrev_b32 v18, 16, v26
  v_cvt_pk_bf16_f32 v26, v19, v19
  v_lshlrev_b32 v19, 16, v26
  v_mul_f32 v12, v12, v25
  v_cvt_pk_bf16_f32 v26, v12, v12
  v_lshlrev_b32 v12, 16, v26
  v_mul_f32 v13, v13, v25
  v_cvt_pk_bf16_f32 v26, v13, v13
  v_lshlrev_b32 v13, 16, v26
  v_mul_f32 v14, v14, v25
  v_cvt_pk_bf16_f32 v26, v14, v14
  v_lshlrev_b32 v14, 16, v26
  v_mul_f32 v15, v15, v25
  v_cvt_pk_bf16_f32 v26, v15, v15
  v_lshlrev_b32 v15, 16, v26
  v_mul_f32 v16, v16, v25
  v_cvt_pk_bf16_f32 v26, v16, v16
  v_lshlrev_b32 v16, 16, v26
  v_mul_f32 v17, v17, v25
  v_cvt_pk_bf16_f32 v26, v17, v17
  v_lshlrev_b32 v17, 16, v26
  v_mul_f32 v18, v18, v25
  v_cvt_pk_bf16_f32 v26, v18, v18
  v_lshlrev_b32 v18, 16, v26
  v_mul_f32 v19, v19, v25
  v_cvt_pk_bf16_f32 v26, v19, v19
  v_lshlrev_b32 v19, 16, v26
  s_cmp_ge_u32 s40, 56
  s_cbranch_scc1 pvt_279
  s_cmp_lg_u32 s20, 0
  s_cbranch_scc1 wm_281
  s_mov_b32 s101, 0
wm_280:
  buffer_load_dword v26, v7, s[72:75], s52 offen sc1
  s_add_u32 s101, s101, 1
  s_cmp_gt_u32 s101, 131072
  s_cbranch_scc1 main_end
  s_waitcnt vmcnt(0)
  v_cmp_gt_u32 vcc, 4, v26
  v_readfirstlane_b32 s100, v26
  s_nop 0
  s_cbranch_vccz wm_281
  s_sleep 2
  s_add_u32 s100, s100, 3
  s_cmp_ge_u32 s100, 4
  s_cbranch_scc1 wm_280
  s_sleep 24
  s_branch wm_280
wm_281:
  s_barrier
  buffer_load_dwordx4 v[64:67], v4, s[16:19], s47 offen sc1
  buffer_load_dwordx2 v[68:69], v5, s[16:19], s47 offen offset:2048 sc1
  buffer_load_dwordx4 v[128:131], v21, s[16:19], s47 offen offset:1024 sc1
  buffer_load_dwordx4 v[132:135], v21, s[16:19], s47 offen offset:1280 sc1
  s_add_u32 s47, s47, 2560
  buffer_load_dwordx4 v[72:75], v4, s[16:19], s47 offen sc1
  buffer_load_dwordx2 v[76:77], v5, s[16:19], s47 offen offset:2048 sc1
  s_add_u32 s47, s47, 2560
  buffer_load_dwordx4 v[80:83], v4, s[16:19], s47 offen sc1
  buffer_load_dwordx2 v[84:85], v5, s[16:19], s47 offen offset:2048 sc1
  s_add_u32 s47, s47, 2560
  buffer_load_dwordx4 v[88:91], v4, s[16:19], s47 offen sc1
  buffer_load_dwordx2 v[92:93], v5, s[16:19], s47 offen offset:2048 sc1
  s_add_u32 s47, s47, 2560
  buffer_load_dwordx4 v[32:35], v22, s[16:19], s48 offen offset:0 sc1
  buffer_load_dwordx4 v[36:39], v22, s[16:19], s48 offen offset:256 sc1
  buffer_load_dwordx4 v[40:43], v22, s[16:19], s48 offen offset:512 sc1
  buffer_load_dwordx4 v[44:47], v22, s[16:19], s48 offen offset:768 sc1
  s_add_u32 s48, s48, 40960
  buffer_load_dwordx4 v[96:99], v4, s[16:19], s47 offen sc1
  buffer_load_dwordx2 v[100:101], v5, s[16:19], s47 offen offset:2048 sc1
  buffer_load_dwordx4 v[136:139], v21, s[16:19], s47 offen offset:1024 sc1
  buffer_load_dwordx4 v[140:143], v21, s[16:19], s47 offen offset:1280 sc1
  s_add_u32 s47, s47, 2560
  buffer_load_dwordx4 v[104:107], v4, s[16:19], s47 offen sc1
  buffer_load_dwordx2 v[108:109], v5, s[16:19], s47 offen offset:2048 sc1
  s_add_u32 s47, s47, 2560
  buffer_load_dwordx4 v[112:115], v4, s[16:19], s47 offen sc1
  buffer_load_dwordx2 v[116:117], v5, s[16:19], s47 offen offset:2048 sc1
  s_add_u32 s47, s47, 2560
  buffer_load_dwordx4 v[120:123], v4, s[16:19], s47 offen sc1
  buffer_load_dwordx2 v[124:125], v5, s[16:19], s47 offen offset:2048 sc1
  s_add_u32 s47, s47, 2560
  buffer_load_dwordx4 v[48:51], v22, s[16:19], s48 offen offset:0 sc1
  buffer_load_dwordx4 v[52:55], v22, s[16:19], s48 offen offset:256 sc1
  buffer_load_dwordx4 v[56:59], v22, s[16:19], s48 offen offset:512 sc1
  buffer_load_dwordx4 v[60:63], v22, s[16:19], s48 offen offset:768 sc1
  s_add_u32 s48, s48, 40960
pvg_276:
  s_waitcnt vmcnt(26)
  v_mfma_f32_16x16x32_bf16 v[148:151], a[0:3], v[64:67], 0
  v_mfma_f32_16x16x32_bf16 v[144:147], a[0:3], v[68:71], 0
  v_mfma_f32_16x16x32_bf16 v[156:159], a[4:7], v[64:67], 0
  v_mfma_f32_16x16x32_bf16 v[152:155], a[4:7], v[68:71], 0
  v_mfma_f32_16x16x32_bf16 v[164:167], a[8:11], v[64:67], 0
  v_mfma_f32_16x16x32_bf16 v[160:163], a[8:11], v[68:71], 0
  v_mfma_f32_16x16x32_bf16 v[172:175], a[12:15], v[64:67], 0
  v_mfma_f32_16x16x32_bf16 v[168:171], a[12:15], v[68:71], 0
  s_waitcnt vmcnt(22)
  v_mfma_f32_16x16x32_bf16 v[148:151], a[16:19], v[72:75], v[148:151]
  v_mfma_f32_16x16x32_bf16 v[144:147], a[16:19], v[76:79], v[144:147]
  v_mfma_f32_16x16x32_bf16 v[156:159], a[20:23], v[72:75], v[156:159]
  v_mfma_f32_16x16x32_bf16 v[152:155], a[20:23], v[76:79], v[152:155]
  v_mfma_f32_16x16x32_bf16 v[164:167], a[24:27], v[72:75], v[164:167]
  v_mfma_f32_16x16x32_bf16 v[160:163], a[24:27], v[76:79], v[160:163]
  v_mfma_f32_16x16x32_bf16 v[172:175], a[28:31], v[72:75], v[172:175]
  v_mfma_f32_16x16x32_bf16 v[168:171], a[28:31], v[76:79], v[168:171]
  s_waitcnt vmcnt(20)
  v_mfma_f32_16x16x32_bf16 v[148:151], a[32:35], v[80:83], v[148:151]
  v_mfma_f32_16x16x32_bf16 v[144:147], a[32:35], v[84:87], v[144:147]
  v_mfma_f32_16x16x32_bf16 v[156:159], a[36:39], v[80:83], v[156:159]
  v_mfma_f32_16x16x32_bf16 v[152:155], a[36:39], v[84:87], v[152:155]
  v_mfma_f32_16x16x32_bf16 v[164:167], a[40:43], v[80:83], v[164:167]
  v_mfma_f32_16x16x32_bf16 v[160:163], a[40:43], v[84:87], v[160:163]
  v_mfma_f32_16x16x32_bf16 v[172:175], a[44:47], v[80:83], v[172:175]
  v_mfma_f32_16x16x32_bf16 v[168:171], a[44:47], v[84:87], v[168:171]
  s_waitcnt vmcnt(18)
  v_mfma_f32_16x16x32_bf16 v[148:151], a[48:51], v[88:91], v[148:151]
  v_mfma_f32_16x16x32_bf16 v[144:147], a[48:51], v[92:95], v[144:147]
  v_mfma_f32_16x16x32_bf16 v[156:159], a[52:55], v[88:91], v[156:159]
  v_mfma_f32_16x16x32_bf16 v[152:155], a[52:55], v[92:95], v[152:155]
  v_mfma_f32_16x16x32_bf16 v[164:167], a[56:59], v[88:91], v[164:167]
  v_mfma_f32_16x16x32_bf16 v[160:163], a[56:59], v[92:95], v[160:163]
  v_mfma_f32_16x16x32_bf16 v[172:175], a[60:63], v[88:91], v[172:175]
  v_mfma_f32_16x16x32_bf16 v[168:171], a[60:63], v[92:95], v[168:171]
  s_waitcnt vmcnt(14)
  s_nop 1
  v_mfma_f32_16x16x32_bf16 v[144:147], v[32:35], v[128:131], v[144:147]
  v_mfma_f32_16x16x32_bf16 v[148:151], v[32:35], v[132:135], v[148:151]
  v_mfma_f32_16x16x32_bf16 v[152:155], v[36:39], v[128:131], v[152:155]
  v_mfma_f32_16x16x32_bf16 v[156:159], v[36:39], v[132:135], v[156:159]
  v_mfma_f32_16x16x32_bf16 v[160:163], v[40:43], v[128:131], v[160:163]
  v_mfma_f32_16x16x32_bf16 v[164:167], v[40:43], v[132:135], v[164:167]
  v_mfma_f32_16x16x32_bf16 v[168:171], v[44:47], v[128:131], v[168:171]
  v_mfma_f32_16x16x32_bf16 v[172:175], v[44:47], v[132:135], v[172:175]
  s_waitcnt vmcnt(12)
  v_mfma_f32_16x16x32_bf16 v[148:151], a[64:67], v[96:99], v[148:151]
  v_mfma_f32_16x16x32_bf16 v[144:147], a[64:67], v[100:103], v[144:147]
  v_mfma_f32_16x16x32_bf16 v[156:159], a[68:71], v[96:99], v[156:159]
  v_mfma_f32_16x16x32_bf16 v[152:155], a[68:71], v[100:103], v[152:155]
  v_mfma_f32_16x16x32_bf16 v[164:167], a[72:75], v[96:99], v[164:167]
  v_mfma_f32_16x16x32_bf16 v[160:163], a[72:75], v[100:103], v[160:163]
  v_mfma_f32_16x16x32_bf16 v[172:175], a[76:79], v[96:99], v[172:175]
  v_mfma_f32_16x16x32_bf16 v[168:171], a[76:79], v[100:103], v[168:171]
  s_waitcnt vmcnt(8)
  v_mfma_f32_16x16x32_bf16 v[148:151], a[80:83], v[104:107], v[148:151]
  v_mfma_f32_16x16x32_bf16 v[144:147], a[80:83], v[108:111], v[144:147]
  v_mfma_f32_16x16x32_bf16 v[156:159], a[84:87], v[104:107], v[156:159]
  v_mfma_f32_16x16x32_bf16 v[152:155], a[84:87], v[108:111], v[152:155]
  v_mfma_f32_16x16x32_bf16 v[164:167], a[88:91], v[104:107], v[164:167]
  v_mfma_f32_16x16x32_bf16 v[160:163], a[88:91], v[108:111], v[160:163]
  v_mfma_f32_16x16x32_bf16 v[172:175], a[92:95], v[104:107], v[172:175]
  v_mfma_f32_16x16x32_bf16 v[168:171], a[92:95], v[108:111], v[168:171]
  s_waitcnt vmcnt(6)
  v_mfma_f32_16x16x32_bf16 v[148:151], a[96:99], v[112:115], v[148:151]
  v_mfma_f32_16x16x32_bf16 v[144:147], a[96:99], v[116:119], v[144:147]
  v_mfma_f32_16x16x32_bf16 v[156:159], a[100:103], v[112:115], v[156:159]
  v_mfma_f32_16x16x32_bf16 v[152:155], a[100:103], v[116:119], v[152:155]
  v_mfma_f32_16x16x32_bf16 v[164:167], a[104:107], v[112:115], v[164:167]
  v_mfma_f32_16x16x32_bf16 v[160:163], a[104:107], v[116:119], v[160:163]
  v_mfma_f32_16x16x32_bf16 v[172:175], a[108:111], v[112:115], v[172:175]
  v_mfma_f32_16x16x32_bf16 v[168:171], a[108:111], v[116:119], v[168:171]
  s_waitcnt vmcnt(4)
  v_mfma_f32_16x16x32_bf16 v[148:151], a[112:115], v[120:123], v[148:151]
  v_mfma_f32_16x16x32_bf16 v[144:147], a[112:115], v[124:127], v[144:147]
  v_mfma_f32_16x16x32_bf16 v[156:159], a[116:119], v[120:123], v[156:159]
  v_mfma_f32_16x16x32_bf16 v[152:155], a[116:119], v[124:127], v[152:155]
  v_mfma_f32_16x16x32_bf16 v[164:167], a[120:123], v[120:123], v[164:167]
  v_mfma_f32_16x16x32_bf16 v[160:163], a[120:123], v[124:127], v[160:163]
  v_mfma_f32_16x16x32_bf16 v[172:175], a[124:127], v[120:123], v[172:175]
  v_mfma_f32_16x16x32_bf16 v[168:171], a[124:127], v[124:127], v[168:171]
  s_waitcnt vmcnt(0)
  s_nop 1
  v_mfma_f32_16x16x32_bf16 v[144:147], v[48:51], v[136:139], v[144:147]
  v_mfma_f32_16x16x32_bf16 v[148:151], v[48:51], v[140:143], v[148:151]
  v_mfma_f32_16x16x32_bf16 v[152:155], v[52:55], v[136:139], v[152:155]
  v_mfma_f32_16x16x32_bf16 v[156:159], v[52:55], v[140:143], v[156:159]
  v_mfma_f32_16x16x32_bf16 v[160:163], v[56:59], v[136:139], v[160:163]
  v_mfma_f32_16x16x32_bf16 v[164:167], v[56:59], v[140:143], v[164:167]
  v_mfma_f32_16x16x32_bf16 v[168:171], v[60:63], v[136:139], v[168:171]
  v_mfma_f32_16x16x32_bf16 v[172:175], v[60:63], v[140:143], v[172:175]
  s_branch pve_272
pvt_279:
  s_sub_u32 s55, s52, 2048
  s_cmp_lg_u32 s20, 0
  s_cbranch_scc1 wm_283
  s_mov_b32 s101, 0
wm_282:
  buffer_load_dword v26, v7, s[72:75], s55 offen sc1
  s_add_u32 s101, s101, 1
  s_cmp_gt_u32 s101, 131072
  s_cbranch_scc1 main_end
  s_waitcnt vmcnt(0)
  v_cmp_gt_u32 vcc, 4, v26
  v_readfirstlane_b32 s100, v26
  s_nop 0
  s_cbranch_vccz wm_283
  s_sleep 4
  s_add_u32 s100, s100, 3
  s_cmp_ge_u32 s100, 4
  s_cbranch_scc1 wm_282
  s_sleep 24
  s_branch wm_282
wm_283:
  s_barrier
  s_mov_b32 s56, s47
  s_mov_b32 s57, s48
  buffer_load_dwordx4 v[64:67], v4, s[16:19], s56 offen sc1
  buffer_load_dwordx2 v[68:69], v5, s[16:19], s56 offen offset:2048 sc1
  buffer_load_dwordx4 v[128:131], v21, s[16:19], s56 offen offset:1024 sc1
  buffer_load_dwordx4 v[132:135], v21, s[16:19], s56 offen offset:1280 sc1
  s_add_u32 s56, s56, 2560
  buffer_load_dwordx4 v[72:75], v4, s[16:19], s56 offen sc1
  buffer_load_dwordx2 v[76:77], v5, s[16:19], s56 offen offset:2048 sc1
  s_add_u32 s56, s56, 2560
  buffer_load_dwordx4 v[80:83], v4, s[16:19], s56 offen sc1
  buffer_load_dwordx2 v[84:85], v5, s[16:19], s56 offen offset:2048 sc1
  s_add_u32 s56, s56, 2560
  buffer_load_dwordx4 v[88:91], v4, s[16:19], s56 offen sc1
  buffer_load_dwordx2 v[92:93], v5, s[16:19], s56 offen offset:2048 sc1
  s_add_u32 s56, s56, 2560
  buffer_load_dwordx4 v[32:35], v22, s[16:19], s57 offen offset:0 sc1
  buffer_load_dwordx4 v[36:39], v22, s[16:19], s57 offen offset:256 sc1
  buffer_load_dwordx4 v[40:43], v22, s[16:19], s57 offen offset:512 sc1
  buffer_load_dwordx4 v[44:47], v22, s[16:19], s57 offen offset:768 sc1
  s_add_u32 s57, s57, 40960
  buffer_load_dwordx4 v[96:99], v4, s[16:19], s56 offen sc1
  buffer_load_dwordx2 v[100:101], v5, s[16:19], s56 offen offset:2048 sc1
  buffer_load_dwordx4 v[136:139], v21, s[16:19], s56 offen offset:1024 sc1
  buffer_load_dwordx4 v[140:143], v21, s[16:19], s56 offen offset:1280 sc1
  s_add_u32 s56, s56, 2560
  buffer_load_dwordx4 v[104:107], v4, s[16:19], s56 offen sc1
  buffer_load_dwordx2 v[108:109], v5, s[16:19], s56 offen offset:2048 sc1
  s_add_u32 s56, s56, 2560
  buffer_load_dwordx4 v[112:115], v4, s[16:19], s56 offen sc1
  buffer_load_dwordx2 v[116:117], v5, s[16:19], s56 offen offset:2048 sc1
  s_add_u32 s56, s56, 2560
  buffer_load_dwordx4 v[120:123], v4, s[16:19], s56 offen sc1
  buffer_load_dwordx2 v[124:125], v5, s[16:19], s56 offen offset:2048 sc1
  s_add_u32 s56, s56, 2560
  buffer_load_dwordx4 v[48:51], v22, s[16:19], s57 offen offset:0 sc1
  buffer_load_dwordx4 v[52:55], v22, s[16:19], s57 offen offset:256 sc1
  buffer_load_dwordx4 v[56:59], v22, s[16:19], s57 offen offset:512 sc1
  buffer_load_dwordx4 v[60:63], v22, s[16:19], s57 offen offset:768 sc1
  s_add_u32 s57, s57, 40960
pvc_277:
  s_mov_b32 s101, 0
  s_waitcnt vmcnt(14)
  s_branch pvr_285
pvr_284:
  s_sleep 2
  s_add_u32 s56, s47, 0
  s_add_u32 s57, s48, 0
  buffer_load_dwordx4 v[64:67], v4, s[16:19], s56 offen sc1
  buffer_load_dwordx2 v[68:69], v5, s[16:19], s56 offen offset:2048 sc1
  buffer_load_dwordx4 v[128:131], v21, s[16:19], s56 offen offset:1024 sc1
  buffer_load_dwordx4 v[132:135], v21, s[16:19], s56 offen offset:1280 sc1
  s_add_u32 s56, s56, 2560
  buffer_load_dwordx4 v[72:75], v4, s[16:19], s56 offen sc1
  buffer_load_dwordx2 v[76:77], v5, s[16:19], s56 offen offset:2048 sc1
  s_add_u32 s56, s56, 2560
  buffer_load_dwordx4 v[80:83], v4, s[16:19], s56 offen sc1
  buffer_load_dwordx2 v[84:85], v5, s[16:19], s56 offen offset:2048 sc1
  s_add_u32 s56, s56, 2560
  buffer_load_dwordx4 v[88:91], v4, s[16:19], s56 offen sc1
  buffer_load_dwordx2 v[92:93], v5, s[16:19], s56 offen offset:2048 sc1
  s_add_u32 s56, s56, 2560
  buffer_load_dwordx4 v[32:35], v22, s[16:19], s57 offen offset:0 sc1
  buffer_load_dwordx4 v[36:39], v22, s[16:19], s57 offen offset:256 sc1
  buffer_load_dwordx4 v[40:43], v22, s[16:19], s57 offen offset:512 sc1
  buffer_load_dwordx4 v[44:47], v22, s[16:19], s57 offen offset:768 sc1
  s_add_u32 s57, s57, 40960
  s_add_u32 s101, s101, 1
  s_cmp_gt_u32 s101, 131072
  s_cbranch_scc1 main_end
  s_waitcnt vmcnt(0)
pvr_285:
  v_max3_u32 v26, v64, v68, v72
  v_max3_u32 v26, v26, v76, v80
  v_max3_u32 v26, v26, v84, v88
  v_max3_u32 v26, v26, v92, v128
  v_max3_u32 v26, v26, v132, v32
  v_max3_u32 v26, v26, v36, v40
  v_max3_u32 v26, v26, v44, v44
  v_cmp_eq_u32 vcc, -1, v26
  s_nop 1
  s_cbranch_vccnz pvr_284
  v_mfma_f32_16x16x32_bf16 v[148:151], a[0:3], v[64:67], 0
  v_mfma_f32_16x16x32_bf16 v[144:147], a[0:3], v[68:71], 0
  v_mfma_f32_16x16x32_bf16 v[156:159], a[4:7], v[64:67], 0
  v_mfma_f32_16x16x32_bf16 v[152:155], a[4:7], v[68:71], 0
  v_mfma_f32_16x16x32_bf16 v[164:167], a[8:11], v[64:67], 0
  v_mfma_f32_16x16x32_bf16 v[160:163], a[8:11], v[68:71], 0
  v_mfma_f32_16x16x32_bf16 v[172:175], a[12:15], v[64:67], 0
  v_mfma_f32_16x16x32_bf16 v[168:171], a[12:15], v[68:71], 0
  v_mfma_f32_16x16x32_bf16 v[148:151], a[16:19], v[72:75], v[148:151]
  v_mfma_f32_16x16x32_bf16 v[144:147], a[16:19], v[76:79], v[144:147]
  v_mfma_f32_16x16x32_bf16 v[156:159], a[20:23], v[72:75], v[156:159]
  v_mfma_f32_16x16x32_bf16 v[152:155], a[20:23], v[76:79], v[152:155]
  v_mfma_f32_16x16x32_bf16 v[164:167], a[24:27], v[72:75], v[164:167]
  v_mfma_f32_16x16x32_bf16 v[160:163], a[24:27], v[76:79], v[160:163]
  v_mfma_f32_16x16x32_bf16 v[172:175], a[28:31], v[72:75], v[172:175]
  v_mfma_f32_16x16x32_bf16 v[168:171], a[28:31], v[76:79], v[168:171]
  v_mfma_f32_16x16x32_bf16 v[148:151], a[32:35], v[80:83], v[148:151]
  v_mfma_f32_16x16x32_bf16 v[144:147], a[32:35], v[84:87], v[144:147]
  v_mfma_f32_16x16x32_bf16 v[156:159], a[36:39], v[80:83], v[156:159]
  v_mfma_f32_16x16x32_bf16 v[152:155], a[36:39], v[84:87], v[152:155]
  v_mfma_f32_16x16x32_bf16 v[164:167], a[40:43], v[80:83], v[164:167]
  v_mfma_f32_16x16x32_bf16 v[160:163], a[40:43], v[84:87], v[160:163]
  v_mfma_f32_16x16x32_bf16 v[172:175], a[44:47], v[80:83], v[172:175]
  v_mfma_f32_16x16x32_bf16 v[168:171], a[44:47], v[84:87], v[168:171]
  v_mfma_f32_16x16x32_bf16 v[148:151], a[48:51], v[88:91], v[148:151]
  v_mfma_f32_16x16x32_bf16 v[144:147], a[48:51], v[92:95], v[144:147]
  v_mfma_f32_16x16x32_bf16 v[156:159], a[52:55], v[88:91], v[156:159]
  v_mfma_f32_16x16x32_bf16 v[152:155], a[52:55], v[92:95], v[152:155]
  v_mfma_f32_16x16x32_bf16 v[164:167], a[56:59], v[88:91], v[164:167]
  v_mfma_f32_16x16x32_bf16 v[160:163], a[56:59], v[92:95], v[160:163]
  v_mfma_f32_16x16x32_bf16 v[172:175], a[60:63], v[88:91], v[172:175]
  v_mfma_f32_16x16x32_bf16 v[168:171], a[60:63], v[92:95], v[168:171]
  s_nop 1
  v_mfma_f32_16x16x32_bf16 v[144:147], v[32:35], v[128:131], v[144:147]
  v_mfma_f32_16x16x32_bf16 v[148:151], v[32:35], v[132:135], v[148:151]
  v_mfma_f32_16x16x32_bf16 v[152:155], v[36:39], v[128:131], v[152:155]
  v_mfma_f32_16x16x32_bf16 v[156:159], v[36:39], v[132:135], v[156:159]
  v_mfma_f32_16x16x32_bf16 v[160:163], v[40:43], v[128:131], v[160:163]
  v_mfma_f32_16x16x32_bf16 v[164:167], v[40:43], v[132:135], v[164:167]
  v_mfma_f32_16x16x32_bf16 v[168:171], v[44:47], v[128:131], v[168:171]
  v_mfma_f32_16x16x32_bf16 v[172:175], v[44:47], v[132:135], v[172:175]
  s_mov_b32 s101, 0
  s_waitcnt vmcnt(0)
  s_branch pvr_287
pvr_286:
  s_sleep 2
  s_add_u32 s56, s47, 10240
  s_add_u32 s57, s48, 40960
  buffer_load_dwordx4 v[96:99], v4, s[16:19], s56 offen sc1
  buffer_load_dwordx2 v[100:101], v5, s[16:19], s56 offen offset:2048 sc1
  buffer_load_dwordx4 v[136:139], v21, s[16:19], s56 offen offset:1024 sc1
  buffer_load_dwordx4 v[140:143], v21, s[16:19], s56 offen offset:1280 sc1
  s_add_u32 s56, s56, 2560
  buffer_load_dwordx4 v[104:107], v4, s[16:19], s56 offen sc1
  buffer_load_dwordx2 v[108:109], v5, s[16:19], s56 offen offset:2048 sc1
  s_add_u32 s56, s56, 2560
  buffer_load_dwordx4 v[112:115], v4, s[16:19], s56 offen sc1
  buffer_load_dwordx2 v[116:117], v5, s[16:19], s56 offen offset:2048 sc1
  s_add_u32 s56, s56, 2560
  buffer_load_dwordx4 v[120:123], v4, s[16:19], s56 offen sc1
  buffer_load_dwordx2 v[124:125], v5, s[16:19], s56 offen offset:2048 sc1
  s_add_u32 s56, s56, 2560
  buffer_load_dwordx4 v[48:51], v22, s[16:19], s57 offen offset:0 sc1
  buffer_load_dwordx4 v[52:55], v22, s[16:19], s57 offen offset:256 sc1
  buffer_load_dwordx4 v[56:59], v22, s[16:19], s57 offen offset:512 sc1
  buffer_load_dwordx4 v[60:63], v22, s[16:19], s57 offen offset:768 sc1
  s_add_u32 s57, s57, 40960
  s_add_u32 s101, s101, 1
  s_cmp_gt_u32 s101, 131072
  s_cbranch_scc1 main_end
  s_waitcnt vmcnt(0)
pvr_287:
  v_max3_u32 v26, v96, v100, v104
  v_max3_u32 v26, v26, v108, v112
  v_max3_u32 v26, v26, v116, v120
  v_max3_u32 v26, v26, v124, v136
  v_max3_u32 v26, v26, v140, v48
  v_max3_u32 v26, v26, v52, v56
  v_max3_u32 v26, v26, v60, v60
  v_cmp_eq_u32 vcc, -1, v26
  s_nop 1
  s_cbranch_vccnz pvr_286
  v_mfma_f32_16x16x32_bf16 v[148:151], a[64:67], v[96:99], v[148:151]
  v_mfma_f32_16x16x32_bf16 v[144:147], a[64:67], v[100:103], v[144:147]
  v_mfma_f32_16x16x32_bf16 v[156:159], a[68:71], v[96:99], v[156:159]
  v_mfma_f32_16x16x32_bf16 v[152:155], a[68:71], v[100:103], v[152:155]
  v_mfma_f32_16x16x32_bf16 v[164:167], a[72:75], v[96:99], v[164:167]
  v_mfma_f32_16x16x32_bf16 v[160:163], a[72:75], v[100:103], v[160:163]
  v_mfma_f32_16x16x32_bf16 v[172:175], a[76:79], v[96:99], v[172:175]
  v_mfma_f32_16x16x32_bf16 v[168:171], a[76:79], v[100:103], v[168:171]
  v_mfma_f32_16x16x32_bf16 v[148:151], a[80:83], v[104:107], v[148:151]
  v_mfma_f32_16x16x32_bf16 v[144:147], a[80:83], v[108:111], v[144:147]
  v_mfma_f32_16x16x32_bf16 v[156:159], a[84:87], v[104:107], v[156:159]
  v_mfma_f32_16x16x32_bf16 v[152:155], a[84:87], v[108:111], v[152:155]
  v_mfma_f32_16x16x32_bf16 v[164:167], a[88:91], v[104:107], v[164:167]
  v_mfma_f32_16x16x32_bf16 v[160:163], a[88:91], v[108:111], v[160:163]
  v_mfma_f32_16x16x32_bf16 v[172:175], a[92:95], v[104:107], v[172:175]
  v_mfma_f32_16x16x32_bf16 v[168:171], a[92:95], v[108:111], v[168:171]
  v_mfma_f32_16x16x32_bf16 v[148:151], a[96:99], v[112:115], v[148:151]
  v_mfma_f32_16x16x32_bf16 v[144:147], a[96:99], v[116:119], v[144:147]
  v_mfma_f32_16x16x32_bf16 v[156:159], a[100:103], v[112:115], v[156:159]
  v_mfma_f32_16x16x32_bf16 v[152:155], a[100:103], v[116:119], v[152:155]
  v_mfma_f32_16x16x32_bf16 v[164:167], a[104:107], v[112:115], v[164:167]
  v_mfma_f32_16x16x32_bf16 v[160:163], a[104:107], v[116:119], v[160:163]
  v_mfma_f32_16x16x32_bf16 v[172:175], a[108:111], v[112:115], v[172:175]
  v_mfma_f32_16x16x32_bf16 v[168:171], a[108:111], v[116:119], v[168:171]
  v_mfma_f32_16x16x32_bf16 v[148:151], a[112:115], v[120:123], v[148:151]
  v_mfma_f32_16x16x32_bf16 v[144:147], a[112:115], v[124:127], v[144:147]
  v_mfma_f32_16x16x32_bf16 v[156:159], a[116:119], v[120:123], v[156:159]
  v_mfma_f32_16x16x32_bf16 v[152:155], a[116:119], v[124:127], v[152:155]
  v_mfma_f32_16x16x32_bf16 v[164:167], a[120:123], v[120:123], v[164:167]
  v_mfma_f32_16x16x32_bf16 v[160:163], a[120:123], v[124:127], v[160:163]
  v_mfma_f32_16x16x32_bf16 v[172:175], a[124:127], v[120:123], v[172:175]
  v_mfma_f32_16x16x32_bf16 v[168:171], a[124:127], v[124:127], v[168:171]
  s_nop 1
  v_mfma_f32_16x16x32_bf16 v[144:147], v[48:51], v[136:139], v[144:147]
  v_mfma_f32_16x16x32_bf16 v[148:151], v[48:51], v[140:143], v[148:151]
  v_mfma_f32_16x16x32_bf16 v[152:155], v[52:55], v[136:139], v[152:155]
  v_mfma_f32_16x16x32_bf16 v[156:159], v[52:55], v[140:143], v[156:159]
  v_mfma_f32_16x16x32_bf16 v[160:163], v[56:59], v[136:139], v[160:163]
  v_mfma_f32_16x16x32_bf16 v[164:167], v[56:59], v[140:143], v[164:167]
  v_mfma_f32_16x16x32_bf16 v[168:171], v[60:63], v[136:139], v[168:171]
  v_mfma_f32_16x16x32_bf16 v[172:175], v[60:63], v[140:143], v[172:175]
pve_272:
  s_nop 0
  s_cmp_eq_u32 s65, 0
  s_cbranch_scc1 pvx_288
  s_add_u32 s41, s41, 1
  s_mul_i32 s53, s42, 40960
  s_lshl_b32 s22, s41, 12
  s_add_u32 s53, s53, s22
  s_mul_i32 s48, s42, 10240
  s_lshl_b32 s22, s41, 10
  s_add_u32 s48, s48, s22
  s_add_u32 s48, s48, 7340032
  buffer_load_dwordx4 v[32:35], v22, s[16:19], s48 offen offset:0 sc1
  buffer_load_dwordx4 v[36:39], v22, s[16:19], s48 offen offset:256 sc1
  buffer_load_dwordx4 v[40:43], v22, s[16:19], s48 offen offset:512 sc1
  buffer_load_dwordx4 v[44:47], v22, s[16:19], s48 offen offset:768 sc1
  s_add_u32 s48, s48, 40960
  buffer_load_dwordx4 v[48:51], v22, s[16:19], s48 offen offset:0 sc1
  buffer_load_dwordx4 v[52:55], v22, s[16:19], s48 offen offset:256 sc1
  buffer_load_dwordx4 v[56:59], v22, s[16:19], s48 offen offset:512 sc1
  buffer_load_dwordx4 v[60:63], v22, s[16:19], s48 offen offset:768 sc1
  s_add_u32 s48, s48, 40960
  buffer_load_dwordx4 a[0:3], v4, s[12:15], s53 offen offset:0 sc1
  buffer_load_dwordx4 a[4:7], v4, s[12:15], s53 offen offset:1024 sc1
  buffer_load_dwordx4 a[8:11], v4, s[12:15], s53 offen offset:2048 sc1
  buffer_load_dwordx4 a[12:15], v4, s[12:15], s53 offen offset:3072 sc1
  s_add_u32 s53, s53, 40960
  buffer_load_dwordx4 a[16:19], v4, s[12:15], s53 offen offset:0 sc1
  buffer_load_dwordx4 a[20:23], v4, s[12:15], s53 offen offset:1024 sc1
  buffer_load_dwordx4 a[24:27], v4, s[12:15], s53 offen offset:2048 sc1
  buffer_load_dwordx4 a[28:31], v4, s[12:15], s53 offen offset:3072 sc1
  s_add_u32 s53, s53, 40960
  buffer_load_dwordx4 a[32:35], v4, s[12:15], s53 offen offset:0 sc1
  buffer_load_dwordx4 a[36:39], v4, s[12:15], s53 offen offset:1024 sc1
  buffer_load_dwordx4 a[40:43], v4, s[12:15], s53 offen offset:2048 sc1
  buffer_load_dwordx4 a[44:47], v4, s[12:15], s53 offen offset:3072 sc1
  s_add_u32 s53, s53, 40960
  buffer_load_dwordx4 a[48:51], v4, s[12:15], s53 offen offset:0 sc1
  buffer_load_dwordx4 a[52:55], v4, s[12:15], s53 offen offset:1024 sc1
  buffer_load_dwordx4 a[56:59], v4, s[12:15], s53 offen offset:2048 sc1
  buffer_load_dwordx4 a[60:63], v4, s[12:15], s53 offen offset:3072 sc1
  s_add_u32 s53, s53, 40960
  buffer_load_dwordx4 a[64:67], v4, s[12:15], s53 offen offset:0 sc1
  buffer_load_dwordx4 a[68:71], v4, s[12:15], s53 offen offset:1024 sc1
  buffer_load_dwordx4 a[72:75], v4, s[12:15], s53 offen offset:2048 sc1
  buffer_load_dwordx4 a[76:79], v4, s[12:15], s53 offen offset:3072 sc1
  s_add_u32 s53, s53, 40960
  buffer_load_dwordx4 a[80:83], v4, s[12:15], s53 offen offset:0 sc1
  buffer_load_dwordx4 a[84:87], v4, s[12:15], s53 offen offset:1024 sc1
  buffer_load_dwordx4 a[88:91], v4, s[12:15], s53 offen offset:2048 sc1
  buffer_load_dwordx4 a[92:95], v4, s[12:15], s53 offen offset:3072 sc1
  s_add_u32 s53, s53, 40960
  buffer_load_dwordx4 a[96:99], v4, s[12:15], s53 offen offset:0 sc1
  buffer_load_dwordx4 a[100:103], v4, s[12:15], s53 offen offset:1024 sc1
  buffer_load_dwordx4 a[104:107], v4, s[12:15], s53 offen offset:2048 sc1
  buffer_load_dwordx4 a[108:111], v4, s[12:15], s53 offen offset:3072 sc1
  s_add_u32 s53, s53, 40960
  buffer_load_dwordx4 a[112:115], v4, s[12:15], s53 offen offset:0 sc1
  buffer_load_dwordx4 a[116:119], v4, s[12:15], s53 offen offset:1024 sc1
  buffer_load_dwordx4 a[120:123], v4, s[12:15], s53 offen offset:2048 sc1
  buffer_load_dwordx4 a[124:127], v4, s[12:15], s53 offen offset:3072 sc1
pvx_288:
  s_cmp_lg_u32 s20, 0
  s_cbranch_scc1 lc_289
  s_sub_u32 s21, s2, 400
  s_cmp_ge_u32 s21, 240
  s_cbranch_scc1 lc_289
  v_mov_b32 v29, 1
  s_mov_b64 exec, 1
  buffer_atomic_add v29, v28, s[32:35], 0 offen sc0 sc1
  s_mov_b64 exec, -1
lc_289:
  ds_write_b128 v10, v[144:147] offset:0
  ds_write_b128 v10, v[148:151] offset:1024
  ds_write_b128 v10, v[152:155] offset:2048
  ds_write_b128 v10, v[156:159] offset:3072
  ds_write_b128 v10, v[160:163] offset:4096
  ds_write_b128 v10, v[164:167] offset:5120
  ds_write_b128 v10, v[168:171] offset:6144
  ds_write_b128 v10, v[172:175] offset:7168
  s_cmp_lg_u32 s20, 0
  s_cbranch_scc1 pvq_292
  v_readfirstlane_b32 s21, v29
  s_mov_b32 s23, -1
  v_mov_b32 v213, s23
  s_mov_b64 exec, 1
  ds_write_b32 v30, v29
  ds_write_b32 v30, v213 offset:8
  s_mov_b64 exec, -1
pvq_292:
  s_waitcnt lgkmcnt(0)
  s_barrier
  ds_read_b128 v[176:179], v11 offset:0
  ds_read_b128 v[180:183], v11 offset:8192
  ds_read_b128 v[184:187], v11 offset:16384
  ds_read_b128 v[188:191], v11 offset:24576
  ds_read_b128 v[192:195], v11 offset:4096
  ds_read_b128 v[196:199], v11 offset:12288
  ds_read_b128 v[200:203], v11 offset:20480
  ds_read_b128 v[204:207], v11 offset:28672
  ds_read_b32 v23, v30
  ds_read_b32 v213, v30 offset:8
  s_cmp_ge_u32 s40, 32
  s_cbranch_scc1 pvr_295
  s_waitcnt lgkmcnt(6)
  v_pk_add_f32 v[176:177], v[176:177], v[180:181]
  v_pk_add_f32 v[184:185], v[184:185], v[188:189]
  v_pk_add_f32 v[178:179], v[178:179], v[182:183]
  v_pk_add_f32 v[186:187], v[186:187], v[190:191]
  v_pk_add_f32 v[176:177], v[176:177], v[184:185]
  v_pk_add_f32 v[178:179], v[178:179], v[186:187]
  buffer_store_dwordx4 v[176:179], v4, s[24:27], s54 offen offset:0 sc1
  s_waitcnt lgkmcnt(2)
  v_pk_add_f32 v[192:193], v[192:193], v[196:197]
  v_pk_add_f32 v[200:201], v[200:201], v[204:205]
  v_pk_add_f32 v[194:195], v[194:195], v[198:199]
  v_pk_add_f32 v[202:203], v[202:203], v[206:207]
  v_pk_add_f32 v[192:193], v[192:193], v[200:201]
  v_pk_add_f32 v[194:195], v[194:195], v[202:203]
  buffer_store_dwordx4 v[192:195], v4, s[24:27], s54 offen offset:2048 sc1
  s_lshr_b32 s71, s40, 2
  s_lshl_b32 s71, s71, 7
  s_add_u32 s71, s71, 104448
  s_branch pvr_296
pvr_295:
  s_waitcnt lgkmcnt(6)
  v_pk_add_f32 v[176:177], v[176:177], v[180:181]
  v_pk_add_f32 v[184:185], v[184:185], v[188:189]
  v_pk_add_f32 v[178:179], v[178:179], v[182:183]
  v_pk_add_f32 v[186:187], v[186:187], v[190:191]
  v_pk_add_f32 v[176:177], v[176:177], v[184:185]
  v_pk_add_f32 v[178:179], v[178:179], v[186:187]
  v_cvt_pk_bf16_f32 v26, v176, v177
  v_lshlrev_b32 v176, 16, v26
  v_and_b32 v177, 0xffff0000, v26
  v_mul_f32 v176, v176, v24
  v_mul_f32 v177, v177, v24
  v_cvt_pk_bf16_f32 v26, v176, v177
  v_lshlrev_b32 v176, 16, v26
  v_and_b32 v177, 0xffff0000, v26
  v_add_f32 v176, v176, v12
  v_add_f32 v177, v177, v13
  v_cvt_pk_bf16_f32 v180, v176, v177
  v_cvt_pk_bf16_f32 v26, v178, v179
  v_lshlrev_b32 v178, 16, v26
  v_and_b32 v179, 0xffff0000, v26
  v_mul_f32 v178, v178, v24
  v_mul_f32 v179, v179, v24
  v_cvt_pk_bf16_f32 v26, v178, v179
  v_lshlrev_b32 v178, 16, v26
  v_and_b32 v179, 0xffff0000, v26
  v_add_f32 v178, v178, v14
  v_add_f32 v179, v179, v15
  v_cvt_pk_bf16_f32 v181, v178, v179
  buffer_store_dwordx2 v[180:181], v9, s[8:11], s46 offen offset:0
  s_waitcnt lgkmcnt(2)
  v_pk_add_f32 v[192:193], v[192:193], v[196:197]
  v_pk_add_f32 v[200:201], v[200:201], v[204:205]
  v_pk_add_f32 v[194:195], v[194:195], v[198:199]
  v_pk_add_f32 v[202:203], v[202:203], v[206:207]
  v_pk_add_f32 v[192:193], v[192:193], v[200:201]
  v_pk_add_f32 v[194:195], v[194:195], v[202:203]
  v_cvt_pk_bf16_f32 v26, v192, v193
  v_lshlrev_b32 v192, 16, v26
  v_and_b32 v193, 0xffff0000, v26
  v_mul_f32 v192, v192, v24
  v_mul_f32 v193, v193, v24
  v_cvt_pk_bf16_f32 v26, v192, v193
  v_lshlrev_b32 v192, 16, v26
  v_and_b32 v193, 0xffff0000, v26
  v_add_f32 v192, v192, v16
  v_add_f32 v193, v193, v17
  v_cvt_pk_bf16_f32 v196, v192, v193
  v_cvt_pk_bf16_f32 v26, v194, v195
  v_lshlrev_b32 v194, 16, v26
  v_and_b32 v195, 0xffff0000, v26
  v_mul_f32 v194, v194, v24
  v_mul_f32 v195, v195, v24
  v_cvt_pk_bf16_f32 v26, v194, v195
  v_lshlrev_b32 v194, 16, v26
  v_and_b32 v195, 0xffff0000, v26
  v_add_f32 v194, v194, v18
  v_add_f32 v195, v195, v19
  v_cvt_pk_bf16_f32 v197, v194, v195
  buffer_store_dwordx2 v[196:197], v9, s[8:11], s46 offen offset:64
pvr_296:
pvy_297:
  s_cmp_eq_u32 s65, 0
  s_cbranch_scc1 pvy_298
  s_sub_u32 s65, s65, 1
  s_add_u32 s46, s46, 128
  s_add_u32 s54, s54, 4096
  s_cmp_lt_u32 s40, 32
  s_cselect_b32 s70, 0x80000000, s54
  buffer_load_dwordx4 v[12:15], v4, s[24:27], s70 offen sc1
  buffer_load_dwordx4 v[16:19], v4, s[24:27], s70 offen offset:2048 sc1
  buffer_load_dword v24, v6, s[28:31], s45 offen sc1
  s_waitcnt vmcnt(37) lgkmcnt(0)
  s_barrier
  s_nop 1
  v_mfma_f32_16x16x32_bf16 v[144:147], v[32:35], v[128:131], 0
  v_mfma_f32_16x16x32_bf16 v[148:151], v[32:35], v[132:135], 0
  v_mfma_f32_16x16x32_bf16 v[152:155], v[36:39], v[128:131], 0
  v_mfma_f32_16x16x32_bf16 v[156:159], v[36:39], v[132:135], 0
  v_mfma_f32_16x16x32_bf16 v[160:163], v[40:43], v[128:131], 0
  v_mfma_f32_16x16x32_bf16 v[164:167], v[40:43], v[132:135], 0
  v_mfma_f32_16x16x32_bf16 v[168:171], v[44:47], v[128:131], 0
  v_mfma_f32_16x16x32_bf16 v[172:175], v[44:47], v[132:135], 0
  v_mfma_f32_16x16x32_bf16 v[144:147], v[48:51], v[136:139], v[144:147]
  v_mfma_f32_16x16x32_bf16 v[148:151], v[48:51], v[140:143], v[148:151]
  v_mfma_f32_16x16x32_bf16 v[152:155], v[52:55], v[136:139], v[152:155]
  v_mfma_f32_16x16x32_bf16 v[156:159], v[52:55], v[140:143], v[156:159]
  v_mfma_f32_16x16x32_bf16 v[160:163], v[56:59], v[136:139], v[160:163]
  v_mfma_f32_16x16x32_bf16 v[164:167], v[56:59], v[140:143], v[164:167]
  v_mfma_f32_16x16x32_bf16 v[168:171], v[60:63], v[136:139], v[168:171]
  v_mfma_f32_16x16x32_bf16 v[172:175], v[60:63], v[140:143], v[172:175]
  s_waitcnt vmcnt(33)
  v_mfma_f32_16x16x32_bf16 v[148:151], a[0:3], v[64:67], v[148:151]
  v_mfma_f32_16x16x32_bf16 v[144:147], a[0:3], v[68:71], v[144:147]
  v_mfma_f32_16x16x32_bf16 v[156:159], a[4:7], v[64:67], v[156:159]
  v_mfma_f32_16x16x32_bf16 v[152:155], a[4:7], v[68:71], v[152:155]
  v_mfma_f32_16x16x32_bf16 v[164:167], a[8:11], v[64:67], v[164:167]
  v_mfma_f32_16x16x32_bf16 v[160:163], a[8:11], v[68:71], v[160:163]
  v_mfma_f32_16x16x32_bf16 v[172:175], a[12:15], v[64:67], v[172:175]
  v_mfma_f32_16x16x32_bf16 v[168:171], a[12:15], v[68:71], v[168:171]
  s_waitcnt vmcnt(29)
  v_mfma_f32_16x16x32_bf16 v[148:151], a[16:19], v[72:75], v[148:151]
  v_mfma_f32_16x16x32_bf16 v[144:147], a[16:19], v[76:79], v[144:147]
  v_mfma_f32_16x16x32_bf16 v[156:159], a[20:23], v[72:75], v[156:159]
  v_mfma_f32_16x16x32_bf16 v[152:155], a[20:23], v[76:79], v[152:155]
  v_mfma_f32_16x16x32_bf16 v[164:167], a[24:27], v[72:75], v[164:167]
  v_mfma_f32_16x16x32_bf16 v[160:163], a[24:27], v[76:79], v[160:163]
  v_mfma_f32_16x16x32_bf16 v[172:175], a[28:31], v[72:75], v[172:175]
  v_mfma_f32_16x16x32_bf16 v[168:171], a[28:31], v[76:79], v[168:171]
  s_waitcnt vmcnt(25)
  v_mfma_f32_16x16x32_bf16 v[148:151], a[32:35], v[80:83], v[148:151]
  v_mfma_f32_16x16x32_bf16 v[144:147], a[32:35], v[84:87], v[144:147]
  v_mfma_f32_16x16x32_bf16 v[156:159], a[36:39], v[80:83], v[156:159]
  v_mfma_f32_16x16x32_bf16 v[152:155], a[36:39], v[84:87], v[152:155]
  v_mfma_f32_16x16x32_bf16 v[164:167], a[40:43], v[80:83], v[164:167]
  v_mfma_f32_16x16x32_bf16 v[160:163], a[40:43], v[84:87], v[160:163]
  v_mfma_f32_16x16x32_bf16 v[172:175], a[44:47], v[80:83], v[172:175]
  v_mfma_f32_16x16x32_bf16 v[168:171], a[44:47], v[84:87], v[168:171]
  s_waitcnt vmcnt(21)
  v_mfma_f32_16x16x32_bf16 v[148:151], a[48:51], v[88:91], v[148:151]
  v_mfma_f32_16x16x32_bf16 v[144:147], a[48:51], v[92:95], v[144:147]
  v_mfma_f32_16x16x32_bf16 v[156:159], a[52:55], v[88:91], v[156:159]
  v_mfma_f32_16x16x32_bf16 v[152:155], a[52:55], v[92:95], v[152:155]
  v_mfma_f32_16x16x32_bf16 v[164:167], a[56:59], v[88:91], v[164:167]
  v_mfma_f32_16x16x32_bf16 v[160:163], a[56:59], v[92:95], v[160:163]
  v_mfma_f32_16x16x32_bf16 v[172:175], a[60:63], v[88:91], v[172:175]
  v_mfma_f32_16x16x32_bf16 v[168:171], a[60:63], v[92:95], v[168:171]
  s_waitcnt vmcnt(17)
  v_mfma_f32_16x16x32_bf16 v[148:151], a[64:67], v[96:99], v[148:151]
  v_mfma_f32_16x16x32_bf16 v[144:147], a[64:67], v[100:103], v[144:147]
  v_mfma_f32_16x16x32_bf16 v[156:159], a[68:71], v[96:99], v[156:159]
  v_mfma_f32_16x16x32_bf16 v[152:155], a[68:71], v[100:103], v[152:155]
  v_mfma_f32_16x16x32_bf16 v[164:167], a[72:75], v[96:99], v[164:167]
  v_mfma_f32_16x16x32_bf16 v[160:163], a[72:75], v[100:103], v[160:163]
  v_mfma_f32_16x16x32_bf16 v[172:175], a[76:79], v[96:99], v[172:175]
  v_mfma_f32_16x16x32_bf16 v[168:171], a[76:79], v[100:103], v[168:171]
  s_waitcnt vmcnt(13)
  v_mfma_f32_16x16x32_bf16 v[148:151], a[80:83], v[104:107], v[148:151]
  v_mfma_f32_16x16x32_bf16 v[144:147], a[80:83], v[108:111], v[144:147]
  v_mfma_f32_16x16x32_bf16 v[156:159], a[84:87], v[104:107], v[156:159]
  v_mfma_f32_16x16x32_bf16 v[152:155], a[84:87], v[108:111], v[152:155]
  v_mfma_f32_16x16x32_bf16 v[164:167], a[88:91], v[104:107], v[164:167]
  v_mfma_f32_16x16x32_bf16 v[160:163], a[88:91], v[108:111], v[160:163]
  v_mfma_f32_16x16x32_bf16 v[172:175], a[92:95], v[104:107], v[172:175]
  v_mfma_f32_16x16x32_bf16 v[168:171], a[92:95], v[108:111], v[168:171]
  s_waitcnt vmcnt(9)
  v_mfma_f32_16x16x32_bf16 v[148:151], a[96:99], v[112:115], v[148:151]
  v_mfma_f32_16x16x32_bf16 v[144:147], a[96:99], v[116:119], v[144:147]
  v_mfma_f32_16x16x32_bf16 v[156:159], a[100:103], v[112:115], v[156:159]
  v_mfma_f32_16x16x32_bf16 v[152:155], a[100:103], v[116:119], v[152:155]
  v_mfma_f32_16x16x32_bf16 v[164:167], a[104:107], v[112:115], v[164:167]
  v_mfma_f32_16x16x32_bf16 v[160:163], a[104:107], v[116:119], v[160:163]
  v_mfma_f32_16x16x32_bf16 v[172:175], a[108:111], v[112:115], v[172:175]
  v_mfma_f32_16x16x32_bf16 v[168:171], a[108:111], v[116:119], v[168:171]
  s_waitcnt vmcnt(5)
  v_mfma_f32_16x16x32_bf16 v[148:151], a[112:115], v[120:123], v[148:151]
  v_mfma_f32_16x16x32_bf16 v[144:147], a[112:115], v[124:127], v[144:147]
  v_mfma_f32_16x16x32_bf16 v[156:159], a[116:119], v[120:123], v[156:159]
  v_mfma_f32_16x16x32_bf16 v[152:155], a[116:119], v[124:127], v[152:155]
  v_mfma_f32_16x16x32_bf16 v[164:167], a[120:123], v[120:123], v[164:167]
  v_mfma_f32_16x16x32_bf16 v[160:163], a[120:123], v[124:127], v[160:163]
  v_mfma_f32_16x16x32_bf16 v[172:175], a[124:127], v[120:123], v[172:175]
  v_mfma_f32_16x16x32_bf16 v[168:171], a[124:127], v[124:127], v[168:171]
  s_waitcnt vmcnt(0)
  v_sub_f32 v25, 1.0, v24
  v_cvt_pk_bf16_f32 v26, v25, v25
  v_lshlrev_b32 v25, 16, v26
  v_cvt_pk_bf16_f32 v26, v12, v12
  v_lshlrev_b32 v12, 16, v26
  v_cvt_pk_bf16_f32 v26, v13, v13
  v_lshlrev_b32 v13, 16, v26
  v_cvt_pk_bf16_f32 v26, v14, v14
  v_lshlrev_b32 v14, 16, v26
  v_cvt_pk_bf16_f32 v26, v15, v15
  v_lshlrev_b32 v15, 16, v26
  v_cvt_pk_bf16_f32 v26, v16, v16
  v_lshlrev_b32 v16, 16, v26
  v_cvt_pk_bf16_f32 v26, v17, v17
  v_lshlrev_b32 v17, 16, v26
  v_cvt_pk_bf16_f32 v26, v18, v18
  v_lshlrev_b32 v18, 16, v26
  v_cvt_pk_bf16_f32 v26, v19, v19
  v_lshlrev_b32 v19, 16, v26
  v_mul_f32 v12, v12, v25
  v_cvt_pk_bf16_f32 v26, v12, v12
  v_lshlrev_b32 v12, 16, v26
  v_mul_f32 v13, v13, v25
  v_cvt_pk_bf16_f32 v26, v13, v13
  v_lshlrev_b32 v13, 16, v26
  v_mul_f32 v14, v14, v25
  v_cvt_pk_bf16_f32 v26, v14, v14
  v_lshlrev_b32 v14, 16, v26
  v_mul_f32 v15, v15, v25
  v_cvt_pk_bf16_f32 v26, v15, v15
  v_lshlrev_b32 v15, 16, v26
  v_mul_f32 v16, v16, v25
  v_cvt_pk_bf16_f32 v26, v16, v16
  v_lshlrev_b32 v16, 16, v26
  v_mul_f32 v17, v17, v25
  v_cvt_pk_bf16_f32 v26, v17, v17
  v_lshlrev_b32 v17, 16, v26
  v_mul_f32 v18, v18, v25
  v_cvt_pk_bf16_f32 v26, v18, v18
  v_lshlrev_b32 v18, 16, v26
  v_mul_f32 v19, v19, v25
  v_cvt_pk_bf16_f32 v26, v19, v19
  v_lshlrev_b32 v19, 16, v26
  s_cmp_eq_u32 s65, 0
  s_cbranch_scc1 pvx_299
  s_add_u32 s41, s41, 1
  s_mul_i32 s53, s42, 40960
  s_lshl_b32 s22, s41, 12
  s_add_u32 s53, s53, s22
  s_mul_i32 s48, s42, 10240
  s_lshl_b32 s22, s41, 10
  s_add_u32 s48, s48, s22
  s_add_u32 s48, s48, 7340032
  buffer_load_dwordx4 v[32:35], v22, s[16:19], s48 offen offset:0 sc1
  buffer_load_dwordx4 v[36:39], v22, s[16:19], s48 offen offset:256 sc1
  buffer_load_dwordx4 v[40:43], v22, s[16:19], s48 offen offset:512 sc1
  buffer_load_dwordx4 v[44:47], v22, s[16:19], s48 offen offset:768 sc1
  s_add_u32 s48, s48, 40960
  buffer_load_dwordx4 v[48:51], v22, s[16:19], s48 offen offset:0 sc1
  buffer_load_dwordx4 v[52:55], v22, s[16:19], s48 offen offset:256 sc1
  buffer_load_dwordx4 v[56:59], v22, s[16:19], s48 offen offset:512 sc1
  buffer_load_dwordx4 v[60:63], v22, s[16:19], s48 offen offset:768 sc1
  s_add_u32 s48, s48, 40960
  buffer_load_dwordx4 a[0:3], v4, s[12:15], s53 offen offset:0 sc1
  buffer_load_dwordx4 a[4:7], v4, s[12:15], s53 offen offset:1024 sc1
  buffer_load_dwordx4 a[8:11], v4, s[12:15], s53 offen offset:2048 sc1
  buffer_load_dwordx4 a[12:15], v4, s[12:15], s53 offen offset:3072 sc1
  s_add_u32 s53, s53, 40960
  buffer_load_dwordx4 a[16:19], v4, s[12:15], s53 offen offset:0 sc1
  buffer_load_dwordx4 a[20:23], v4, s[12:15], s53 offen offset:1024 sc1
  buffer_load_dwordx4 a[24:27], v4, s[12:15], s53 offen offset:2048 sc1
  buffer_load_dwordx4 a[28:31], v4, s[12:15], s53 offen offset:3072 sc1
  s_add_u32 s53, s53, 40960
  buffer_load_dwordx4 a[32:35], v4, s[12:15], s53 offen offset:0 sc1
  buffer_load_dwordx4 a[36:39], v4, s[12:15], s53 offen offset:1024 sc1
  buffer_load_dwordx4 a[40:43], v4, s[12:15], s53 offen offset:2048 sc1
  buffer_load_dwordx4 a[44:47], v4, s[12:15], s53 offen offset:3072 sc1
  s_add_u32 s53, s53, 40960
  buffer_load_dwordx4 a[48:51], v4, s[12:15], s53 offen offset:0 sc1
  buffer_load_dwordx4 a[52:55], v4, s[12:15], s53 offen offset:1024 sc1
  buffer_load_dwordx4 a[56:59], v4, s[12:15], s53 offen offset:2048 sc1
  buffer_load_dwordx4 a[60:63], v4, s[12:15], s53 offen offset:3072 sc1
  s_add_u32 s53, s53, 40960
  buffer_load_dwordx4 a[64:67], v4, s[12:15], s53 offen offset:0 sc1
  buffer_load_dwordx4 a[68:71], v4, s[12:15], s53 offen offset:1024 sc1
  buffer_load_dwordx4 a[72:75], v4, s[12:15], s53 offen offset:2048 sc1
  buffer_load_dwordx4 a[76:79], v4, s[12:15], s53 offen offset:3072 sc1
  s_add_u32 s53, s53, 40960
  buffer_load_dwordx4 a[80:83], v4, s[12:15], s53 offen offset:0 sc1
  buffer_load_dwordx4 a[84:87], v4, s[12:15], s53 offen offset:1024 sc1
  buffer_load_dwordx4 a[88:91], v4, s[12:15], s53 offen offset:2048 sc1
  buffer_load_dwordx4 a[92:95], v4, s[12:15], s53 offen offset:3072 sc1
  s_add_u32 s53, s53, 40960
  buffer_load_dwordx4 a[96:99], v4, s[12:15], s53 offen offset:0 sc1
  buffer_load_dwordx4 a[100:103], v4, s[12:15], s53 offen offset:1024 sc1
  buffer_load_dwordx4 a[104:107], v4, s[12:15], s53 offen offset:2048 sc1
  buffer_load_dwordx4 a[108:111], v4, s[12:15], s53 offen offset:3072 sc1
  s_add_u32 s53, s53, 40960
  buffer_load_dwordx4 a[112:115], v4, s[12:15], s53 offen offset:0 sc1
  buffer_load_dwordx4 a[116:119], v4, s[12:15], s53 offen offset:1024 sc1
  buffer_load_dwordx4 a[120:123], v4, s[12:15], s53 offen offset:2048 sc1
  buffer_load_dwordx4 a[124:127], v4, s[12:15], s53 offen offset:3072 sc1
pvx_299:
  ds_write_b128 v10, v[144:147] offset:0
  ds_write_b128 v10, v[148:151] offset:1024
  ds_write_b128 v10, v[152:155] offset:2048
  ds_write_b128 v10, v[156:159] offset:3072
  ds_write_b128 v10, v[160:163] offset:4096
  ds_write_b128 v10, v[164:167] offset:5120
  ds_write_b128 v10, v[168:171] offset:6144
  ds_write_b128 v10, v[172:175] offset:7168
  s_waitcnt lgkmcnt(0)
  s_barrier
  ds_read_b128 v[176:179], v11 offset:0
  ds_read_b128 v[180:183], v11 offset:8192
  ds_read_b128 v[184:187], v11 offset:16384
  ds_read_b128 v[188:191], v11 offset:24576
  ds_read_b128 v[192:195], v11 offset:4096
  ds_read_b128 v[196:199], v11 offset:12288
  ds_read_b128 v[200:203], v11 offset:20480
  ds_read_b128 v[204:207], v11 offset:28672
  s_cmp_ge_u32 s40, 32
  s_cbranch_scc1 pvr_300
  s_waitcnt lgkmcnt(4)
  v_pk_add_f32 v[176:177], v[176:177], v[180:181]
  v_pk_add_f32 v[184:185], v[184:185], v[188:189]
  v_pk_add_f32 v[178:179], v[178:179], v[182:183]
  v_pk_add_f32 v[186:187], v[186:187], v[190:191]
  v_pk_add_f32 v[176:177], v[176:177], v[184:185]
  v_pk_add_f32 v[178:179], v[178:179], v[186:187]
  buffer_store_dwordx4 v[176:179], v4, s[24:27], s54 offen offset:0 sc1
  s_waitcnt lgkmcnt(0)
  v_pk_add_f32 v[192:193], v[192:193], v[196:197]
  v_pk_add_f32 v[200:201], v[200:201], v[204:205]
  v_pk_add_f32 v[194:195], v[194:195], v[198:199]
  v_pk_add_f32 v[202:203], v[202:203], v[206:207]
  v_pk_add_f32 v[192:193], v[192:193], v[200:201]
  v_pk_add_f32 v[194:195], v[194:195], v[202:203]
  buffer_store_dwordx4 v[192:195], v4, s[24:27], s54 offen offset:2048 sc1
  s_lshr_b32 s71, s40, 2
  s_lshl_b32 s71, s71, 7
  s_add_u32 s71, s71, 104448
  s_branch pvr_301
pvr_300:
  s_waitcnt lgkmcnt(4)
  v_pk_add_f32 v[176:177], v[176:177], v[180:181]
  v_pk_add_f32 v[184:185], v[184:185], v[188:189]
  v_pk_add_f32 v[178:179], v[178:179], v[182:183]
  v_pk_add_f32 v[186:187], v[186:187], v[190:191]
  v_pk_add_f32 v[176:177], v[176:177], v[184:185]
  v_pk_add_f32 v[178:179], v[178:179], v[186:187]
  v_cvt_pk_bf16_f32 v26, v176, v177
  v_lshlrev_b32 v176, 16, v26
  v_and_b32 v177, 0xffff0000, v26
  v_mul_f32 v176, v176, v24
  v_mul_f32 v177, v177, v24
  v_cvt_pk_bf16_f32 v26, v176, v177
  v_lshlrev_b32 v176, 16, v26
  v_and_b32 v177, 0xffff0000, v26
  v_add_f32 v176, v176, v12
  v_add_f32 v177, v177, v13
  v_cvt_pk_bf16_f32 v180, v176, v177
  v_cvt_pk_bf16_f32 v26, v178, v179
  v_lshlrev_b32 v178, 16, v26
  v_and_b32 v179, 0xffff0000, v26
  v_mul_f32 v178, v178, v24
  v_mul_f32 v179, v179, v24
  v_cvt_pk_bf16_f32 v26, v178, v179
  v_lshlrev_b32 v178, 16, v26
  v_and_b32 v179, 0xffff0000, v26
  v_add_f32 v178, v178, v14
  v_add_f32 v179, v179, v15
  v_cvt_pk_bf16_f32 v181, v178, v179
  buffer_store_dwordx2 v[180:181], v9, s[8:11], s46 offen offset:0
  s_waitcnt lgkmcnt(0)
  v_pk_add_f32 v[192:193], v[192:193], v[196:197]
  v_pk_add_f32 v[200:201], v[200:201], v[204:205]
  v_pk_add_f32 v[194:195], v[194:195], v[198:199]
  v_pk_add_f32 v[202:203], v[202:203], v[206:207]
  v_pk_add_f32 v[192:193], v[192:193], v[200:201]
  v_pk_add_f32 v[194:195], v[194:195], v[202:203]
  v_cvt_pk_bf16_f32 v26, v192, v193
  v_lshlrev_b32 v192, 16, v26
  v_and_b32 v193, 0xffff0000, v26
  v_mul_f32 v192, v192, v24
  v_mul_f32 v193, v193, v24
  v_cvt_pk_bf16_f32 v26, v192, v193
  v_lshlrev_b32 v192, 16, v26
  v_and_b32 v193, 0xffff0000, v26
  v_add_f32 v192, v192, v16
  v_add_f32 v193, v193, v17
  v_cvt_pk_bf16_f32 v196, v192, v193
  v_cvt_pk_bf16_f32 v26, v194, v195
  v_lshlrev_b32 v194, 16, v26
  v_and_b32 v195, 0xffff0000, v26
  v_mul_f32 v194, v194, v24
  v_mul_f32 v195, v195, v24
  v_cvt_pk_bf16_f32 v26, v194, v195
  v_lshlrev_b32 v194, 16, v26
  v_and_b32 v195, 0xffff0000, v26
  v_add_f32 v194, v194, v18
  v_add_f32 v195, v195, v19
  v_cvt_pk_bf16_f32 v197, v194, v195
  buffer_store_dwordx2 v[196:197], v9, s[8:11], s46 offen offset:64
pvr_301:
  s_branch pvy_297
pvy_298:
  s_sub_u32 s21, s2, 400
  s_cmp_ge_u32 s21, 240
  s_cbranch_scc1 lc_302
  s_cmp_lg_u32 s20, 0
  s_cbranch_scc1 lc_302x
  s_waitcnt vmcnt(2)
  s_mov_b64 exec, 1
  ds_write_b32 v30, v29 offset:12
  s_mov_b64 exec, -1
lc_302x:
  s_waitcnt lgkmcnt(0)
  s_barrier
  ds_read_b32 v23, v30 offset:12
lc_302:
  s_waitcnt lgkmcnt(0)
  v_readfirstlane_b32 s2, v23
  v_readfirstlane_b32 s67, v213
  s_barrier
  s_cmp_lt_u32 s2, 334
  s_cbranch_scc1 pae_303
  s_waitcnt vmcnt(0)
  s_cmp_eq_u32 s71, 0
  s_cbranch_scc1 paf_304
  v_mov_b32 v25, 0
  v_mov_b32 v26, 1
  s_mov_b64 exec, 1
  buffer_atomic_add v26, v25, s[72:75], s71 offen sc1
  s_mov_b64 exec, -1
  s_mov_b32 s71, 0
paf_304:
pae_303:
  s_add_u32 s21, s2, 0
  s_cmp_lt_u32 s2, 270
  s_cbranch_scc1 pv_loop
  s_sub_u32 s2, s2, 270
  s_add_u32 s21, s2, 310
  s_cmp_lt_u32 s2, 24
  s_cbranch_scc1 pv_loop
  s_sub_u32 s2, s2, 24
  s_add_u32 s21, s2, 270
  s_cmp_lt_u32 s2, 40
  s_cbranch_scc1 pv_loop
  s_sub_u32 s2, s2, 40
  s_branch main_fin
  s_branch queue
main_fin:
  s_waitcnt vmcnt(0)
main_end:
  s_endpgm
code_end:
.section .rodata,"a"
.p2align 6
.amdhsa_kernel gated_mix__memory_aug_recurrent_mem_tr__sliding_local_dilated__prompt_kernel
  .amdhsa_next_free_vgpr 512
  .amdhsa_next_free_sgpr 102
  .amdhsa_accum_offset 256
  .amdhsa_group_segment_fixed_size 0
  .amdhsa_kernarg_size 112
  .amdhsa_user_sgpr_count 2
  .amdhsa_user_sgpr_kernarg_segment_ptr 1
  .amdhsa_system_sgpr_workgroup_id_x 1
.end_amdhsa_kernel
.text
```

```asm
; @launch kernel=gated_mix__memory_aug_recurrent_mem_tr__sliding_local_dilated__prompt_kernel grid=(256,1,1) block=(256,1,1) lds=163840
.amdgcn_target "amdgcn-amd-amdhsa--gfx950"
.text
.globl gated_mix__memory_aug_recurrent_mem_tr__sliding_local_dilated__prompt_kernel
.p2align 8
.type gated_mix__memory_aug_recurrent_mem_tr__sliding_local_dilated__prompt_kernel,@function
gated_mix__memory_aug_recurrent_mem_tr__sliding_local_dilated__prompt_kernel:
  s_cmp_ge_u32 s2, 256
  s_cbranch_scc1 end0
  s_load_dwordx2 s[4:5], s[0:1], 96
  s_load_dwordx2 s[38:39], s[0:1], 104
  v_lshrrev_b32 v1, 6, v0
  v_and_b32 v2, 15, v0
  v_readfirstlane_b32 s20, v1
  v_and_b32 v1, 63, v0
  v_lshrrev_b32 v3, 4, v1
  s_getreg_b32 s50, hwreg(HW_REG_XCC_ID)
  s_and_b32 s50, s50, 7
  s_waitcnt lgkmcnt(0)
  s_mov_b32 s32, s4
  s_mov_b32 s33, s5
  s_mov_b32 s34, 256
  s_mov_b32 s35, 0x00020000
  s_getpc_b64 s[6:7]
cpf_pc:
  s_sub_u32 s6, s6, cpf_pc - gated_mix__memory_aug_recurrent_mem_tr__sliding_local_dilated__prompt_kernel
  s_subb_u32 s7, s7, 0
  s_lshr_b32 s21, s2, 3
  s_lshl_b32 s21, s21, 12
  v_lshl_add_u32 v28, v0, 4, s21
  v_min_u32 v28, code_end - gated_mix__memory_aug_recurrent_mem_tr__sliding_local_dilated__prompt_kernel - 16, v28
  global_load_dwordx4 a[252:255], v28, s[6:7]
  v_mov_b32 v21, 0
  s_cmp_lg_u32 s20, 0
  s_cbranch_scc1 rk_1
  s_and_b32 s21, s50, 1
  s_lshl_b32 s21, s21, 7
  s_lshl_b32 s22, s50, 1
  s_and_b32 s22, s22, 12
  s_add_u32 s21, s21, s22
  v_mov_b32 v22, s21
  v_mov_b32 v23, 1
  s_mov_b64 exec, 1
  buffer_atomic_add v23, v22, s[32:35], 0 offen sc0 sc1
  s_waitcnt vmcnt(0)
  v_readfirstlane_b32 s51, v23
  s_lshl_b32 s22, s50, 5
  s_add_u32 s22, s22, s51
  s_cmp_lt_u32 s51, 32
  s_cbranch_scc1 rk_2
  v_mov_b32 v24, 72
  v_mov_b32 v25, 1
  buffer_atomic_add v25, v24, s[32:35], 0 offen sc0 sc1
  s_waitcnt vmcnt(0)
  v_readfirstlane_b32 s23, v25
  s_mov_b32 s101, 0
  s_mov_b64 exec, -1
  v_lshlrev_b32 v24, 2, v1
rk_3:
  s_sleep 8
  buffer_load_dword v25, v24, s[32:35], 0 offen sc1
  s_add_u32 s101, s101, 1
  s_cmp_gt_u32 s101, 131072
  s_cbranch_scc1 end0
  s_waitcnt vmcnt(0)
  v_readlane_b32 s21, v25, 0
  v_readlane_b32 s22, v25, 32
  s_add_u32 s21, s21, s22
  v_readlane_b32 s22, v25, 1
  s_add_u32 s21, s21, s22
  v_readlane_b32 s22, v25, 33
  s_add_u32 s21, s21, s22
  v_readlane_b32 s22, v25, 2
  s_add_u32 s21, s21, s22
  v_readlane_b32 s22, v25, 34
  s_add_u32 s21, s21, s22
  v_readlane_b32 s22, v25, 3
  s_add_u32 s21, s21, s22
  v_readlane_b32 s22, v25, 35
  s_add_u32 s21, s21, s22
  s_cmp_lt_u32 s21, 256
  s_cbranch_scc1 rk_3
  s_mov_b64 exec, 1
  s_mov_b32 s24, 0
rk_5:
  s_and_b32 s21, s24, 1
  s_lshl_b32 s21, s21, 5
  s_lshr_b32 s22, s24, 1
  s_add_u32 s21, s21, s22
  v_readlane_b32 s21, v25, s21
  s_min_u32 s21, s21, 32
  s_sub_u32 s25, 32, s21
  s_cmp_lt_u32 s23, s25
  s_cbranch_scc1 rk_4
  s_sub_u32 s23, s23, s25
  s_add_u32 s24, s24, 1
  s_cmp_lt_u32 s24, 8
  s_cbranch_scc1 rk_5
  s_branch end0
rk_4:
  s_lshl_b32 s22, s24, 5
  s_add_u32 s22, s22, s21
  s_add_u32 s22, s22, s23
  s_or_b32 s22, s22, 0x100
rk_2:
  v_mov_b32 v23, s22
  ds_write_b32 v21, v23
  s_waitcnt lgkmcnt(0)
  s_mov_b64 exec, -1
rk_1:
  s_barrier
  ds_read_b32 v23, v21
  s_waitcnt lgkmcnt(0)
  v_readfirstlane_b32 s22, v23
  s_barrier
  s_mov_b32 s84, 0
  s_mov_b32 s85, -1

  s_lshr_b32 s53, s22, 8
  s_and_b32 s22, s22, 255
  s_cmp_ge_u32 s22, 128
  s_cbranch_scc1 gemm_side
  s_lshr_b32 s50, s22, 4
  s_and_b32 s51, s22, 15
  s_mov_b32 s86, 0x3dd53b95
  s_load_dwordx2 s[4:5], s[0:1], 8
  s_load_dwordx4 s[36:39], s[0:1], 16
  s_load_dwordx4 s[40:43], s[0:1], 32
  s_load_dwordx2 s[44:45], s[0:1], 104
  s_lshr_b32 s55, s51, 2
  s_and_b32 s56, s51, 3
  s_lshl_b32 s57, s50, 2
  s_add_u32 s58, s57, s55
  s_add_u32 s59, s57, s20
  s_lshr_b32 s21, s51, 1
  s_xor_b32 s21, s21, s55
  s_andn2_b32 s21, 1, s21
  s_xor_b32 s85, s51, s21
  s_xor_b32 s84, s56, 1
  s_mul_i32 s87, s85, 5
  s_lshr_b32 s87, s87, 1
  s_and_b32 s79, s85, 1
  s_waitcnt lgkmcnt(0)
  s_add_u32 s8, s44, 78643200
  s_addc_u32 s9, s45, 0
  s_mov_b32 s10, 2162688
  s_mov_b32 s11, 0x00020000
  s_mov_b32 s16, s44
  s_mov_b32 s17, s45
  s_mov_b32 s18, 50331648
  s_mov_b32 s19, 0x00020000
  s_add_u32 s24, s44, 50331648
  s_addc_u32 s25, s45, 0
  s_mov_b32 s26, 63963136
  s_mov_b32 s27, 0x00020000
  s_mov_b32 s28, s4
  s_mov_b32 s29, s5
  s_mov_b32 s30, 10240
  s_mov_b32 s31, 0x00020000
  s_add_u32 s4, s44, 83886079
  s_addc_u32 s5, s45, 0
  s_and_b32 s4, s4, 0xffe00000
  s_mov_b32 s6, 2097152
  s_mov_b32 s7, 0x00020000
  v_mov_b32 v27, 10923
  v_add_u32 v103, 0, v1
  v_mul_u32_u24 v102, v103, v27
  v_lshrrev_b32 v102, 16, v102
  v_mul_u32_u24 v101, 6, v102
  v_sub_u32 v103, v103, v101
  v_bfe_u32 v101, v102, 1, 1
  v_mul_u32_u24 v101, 20, v101
  v_and_b32 v100, 1, v102
  v_add_u32 v101, v101, v100
  v_lshrrev_b32 v100, 3, v102
  v_mul_u32_u24 v100, 40, v100
  v_bfe_u32 v99, v102, 2, 1
  v_lshl_add_u32 v100, v99, 1, v100
  v_add_u32 v100, v100, v101
  v_mul_u32_u24 v100, 12288, v100
  v_lshl_add_u32 v46, v103, 4, v100
  v_lshrrev_b32 v100, 4, v102
  v_mul_u32_u24 v100, 40, v100
  v_bfe_u32 v99, v102, 2, 2
  v_lshl_add_u32 v100, v99, 1, v100
  v_add_u32 v100, v100, v101
  v_mul_u32_u24 v100, 12288, v100
  v_lshl_add_u32 v96, v103, 4, v100
  v_add_u32 v103, 64, v1
  v_mul_u32_u24 v102, v103, v27
  v_lshrrev_b32 v102, 16, v102
  v_mul_u32_u24 v101, 6, v102
  v_sub_u32 v103, v103, v101
  v_bfe_u32 v101, v102, 1, 1
  v_mul_u32_u24 v101, 20, v101
  v_and_b32 v100, 1, v102
  v_add_u32 v101, v101, v100
  v_lshrrev_b32 v100, 3, v102
  v_mul_u32_u24 v100, 40, v100
  v_bfe_u32 v99, v102, 2, 1
  v_lshl_add_u32 v100, v99, 1, v100
  v_add_u32 v100, v100, v101
  v_mul_u32_u24 v100, 12288, v100
  v_lshl_add_u32 v47, v103, 4, v100
  v_lshrrev_b32 v100, 4, v102
  v_mul_u32_u24 v100, 40, v100
  v_bfe_u32 v99, v102, 2, 2
  v_lshl_add_u32 v100, v99, 1, v100
  v_add_u32 v100, v100, v101
  v_mul_u32_u24 v100, 12288, v100
  v_lshl_add_u32 v97, v103, 4, v100
  v_add_u32 v103, 128, v1
  v_mul_u32_u24 v102, v103, v27
  v_lshrrev_b32 v102, 16, v102
  v_mul_u32_u24 v101, 6, v102
  v_sub_u32 v103, v103, v101
  v_bfe_u32 v101, v102, 1, 1
  v_mul_u32_u24 v101, 20, v101
  v_and_b32 v100, 1, v102
  v_add_u32 v101, v101, v100
  v_lshrrev_b32 v100, 3, v102
  v_mul_u32_u24 v100, 40, v100
  v_bfe_u32 v99, v102, 2, 1
  v_lshl_add_u32 v100, v99, 1, v100
  v_add_u32 v100, v100, v101
  v_mul_u32_u24 v100, 12288, v100
  v_lshl_add_u32 v48, v103, 4, v100
  v_lshrrev_b32 v100, 4, v102
  v_mul_u32_u24 v100, 40, v100
  v_bfe_u32 v99, v102, 2, 2
  v_lshl_add_u32 v100, v99, 1, v100
  v_add_u32 v100, v100, v101
  v_mul_u32_u24 v100, 12288, v100
  v_lshl_add_u32 v98, v103, 4, v100
  s_mul_i32 s80, s58, 384
  s_mul_i32 s22, s56, 96
  s_add_u32 s80, s80, s22
  s_mul_i32 s22, s20, 1966080
  s_add_u32 s80, s80, s22
  s_mul_i32 s88, s84, 96
  s_mul_i32 s21, s56, 96
  s_sub_u32 s88, s88, s21
  s_add_u32 s88, s88, s80
  s_mul_i32 s81, s20, 40448

  s_mul_i32 s82, s59, 245760
  s_lshl_b32 s22, s87, 5
  s_add_u32 s82, s82, s22
  s_mov_b32 s12, s38
  s_mov_b32 s13, s39
  s_mov_b32 s14, 7864320
  s_mov_b32 s15, 0x00020000
  s_add_u32 s21, s80, 0
  s_add_u32 s22, s81, 0
  s_add_u32 m0, s22, 0
  s_nop 0
  buffer_load_dwordx4 v96, s[12:15], s21 offen lds
  s_add_u32 m0, s22, 1024
  s_nop 0
  buffer_load_dwordx4 v97, s[12:15], s21 offen lds
  s_add_u32 m0, s22, 2048
  s_nop 0
  buffer_load_dwordx4 v98, s[12:15], s21 offen lds
  s_add_u32 s21, s80, 983040
  s_add_u32 s22, s81, 3072
  s_add_u32 m0, s22, 0
  s_nop 0
  buffer_load_dwordx4 v96, s[12:15], s21 offen lds
  s_add_u32 m0, s22, 1024
  s_nop 0
  buffer_load_dwordx4 v97, s[12:15], s21 offen lds
  s_add_u32 m0, s22, 2048
  s_nop 0
  buffer_load_dwordx4 v98, s[12:15], s21 offen lds
  s_add_u32 s21, s80, 98304
  s_add_u32 s22, s81, 6144
  s_add_u32 m0, s22, 0
  s_nop 0
  buffer_load_dwordx4 v96, s[12:15], s21 offen lds
  s_add_u32 m0, s22, 1024
  s_nop 0
  buffer_load_dwordx4 v97, s[12:15], s21 offen lds
  s_add_u32 m0, s22, 2048
  s_nop 0
  buffer_load_dwordx4 v98, s[12:15], s21 offen lds
  s_add_u32 s21, s80, 1081344
  s_add_u32 s22, s81, 9216
  s_add_u32 m0, s22, 0
  s_nop 0
  buffer_load_dwordx4 v96, s[12:15], s21 offen lds
  s_add_u32 m0, s22, 1024
  s_nop 0
  buffer_load_dwordx4 v97, s[12:15], s21 offen lds
  s_add_u32 m0, s22, 2048
  s_nop 0
  buffer_load_dwordx4 v98, s[12:15], s21 offen lds
  s_add_u32 s21, s80, 196608
  s_add_u32 s22, s81, 12288
  s_add_u32 m0, s22, 0
  s_nop 0
  buffer_load_dwordx4 v46, s[12:15], s21 offen lds
  s_add_u32 m0, s22, 1024
  s_nop 0
  buffer_load_dwordx4 v47, s[12:15], s21 offen lds
  s_add_u32 m0, s22, 2048
  s_nop 0
  buffer_load_dwordx4 v48, s[12:15], s21 offen lds
  s_mov_b32 s12, s40
  s_mov_b32 s13, s41
  s_mov_b32 s14, 7864320
  s_mov_b32 s15, 0x00020000
  s_add_u32 s21, s88, 0
  s_add_u32 s22, s81, 0
  buffer_load_dwordx4 v[128:131], v96, s[12:15], s21 offen
  buffer_load_dwordx4 v[132:135], v97, s[12:15], s21 offen
  buffer_load_dwordx4 v[136:139], v98, s[12:15], s21 offen
  s_add_u32 s21, s88, 983040
  s_add_u32 s22, s81, 3072
  buffer_load_dwordx4 v[140:143], v96, s[12:15], s21 offen
  buffer_load_dwordx4 v[144:147], v97, s[12:15], s21 offen
  buffer_load_dwordx4 v[148:151], v98, s[12:15], s21 offen
  s_add_u32 s21, s88, 98304
  s_add_u32 s22, s81, 6144
  buffer_load_dwordx4 v[152:155], v96, s[12:15], s21 offen
  buffer_load_dwordx4 v[156:159], v97, s[12:15], s21 offen
  buffer_load_dwordx4 v[160:163], v98, s[12:15], s21 offen
  s_add_u32 s21, s88, 1081344
  s_add_u32 s22, s81, 9216
  buffer_load_dwordx4 v[164:167], v96, s[12:15], s21 offen
  buffer_load_dwordx4 v[168:171], v97, s[12:15], s21 offen
  buffer_load_dwordx4 v[172:175], v98, s[12:15], s21 offen
  s_add_u32 s21, s88, 196608
  s_add_u32 s22, s81, 12288
  buffer_load_dwordx4 v[176:179], v46, s[12:15], s21 offen
  buffer_load_dwordx4 v[180:183], v47, s[12:15], s21 offen
  buffer_load_dwordx4 v[184:187], v48, s[12:15], s21 offen
  v_lshrrev_b32 v99, 2, v2
  v_lshl_add_u32 v99, v3, 3, v99
  v_mul_u32_u24 v99, 96, v99
  v_and_b32 v100, 3, v2
  v_lshlrev_b32 v100, 3, v100
  v_add3_u32 v99, v99, v100, s81
  v_lshlrev_b32 v100, 4, v1
  v_add_u32 v100, s81, v100
  v_and_b32 v236, 7, v2
  v_lshrrev_b32 v237, 3, v2
  v_lshlrev_b32 v238, 7, v3
  v_lshl_add_u32 v238, v236, 4, v238
  v_lshlrev_b32 v16, 4, v1
  v_mul_u32_u24 v244, 1280, v236
  s_mul_i32 s21, s20, 320
  v_add_u32 v244, s21, v244
  v_lshrrev_b32 v245, 3, v1
  v_mul_u32_u24 v245, 40, v245
  v_add_u32 v244, v244, v245
  s_lshr_b32 s21, s20, 1
  s_lshl_b32 s21, s21, 14
  s_and_b32 s22, s20, 1
  s_mul_i32 s22, s22, 3072
  s_add_u32 s21, s21, s22
  v_add_u32 v4, s21, v16
  v_mov_b32 v239, 0x4444
  v_mov_b32 v240, 0xeeee
  v_cmp_eq_u32 vcc, 1, v237
  s_nop 1
  v_cndmask_b32 v44, v239, v240, vcc
  v_cmp_gt_u32 vcc, 2, v3
  s_nop 1
  v_cndmask_b32 v89, 0, 1.0, vcc
  v_mul_u32_u24 v239, 40, v2
  v_lshl_add_u32 v239, v3, 3, v239
  s_mul_i32 s21, s20, 3200
  v_add_u32 v5, s21, v239
  v_lshrrev_b32 v239, 2, v1
  v_mul_u32_u24 v239, 40, v239
  v_and_b32 v240, 3, v1
  v_lshl_add_u32 v6, v240, 3, v239
  v_bfe_u32 v240, v1, 1, 1
  v_mul_u32_u24 v240, 6384, v240
  v_add_u32 v45, v6, v240
  s_lshl_b32 s21, s50, 4
  s_add_u32 s21, s21, s51
  s_lshl_b32 s21, s21, 9
  s_lshl_b32 s22, s20, 7
  s_add_u32 s21, s21, s22
  s_add_u32 s21, s21, 81920
  v_and_b32 v239, 1, v3
  v_lshlrev_b32 v239, 8, v239
  v_lshl_add_u32 v239, v236, 4, v239
  v_lshrrev_b32 v240, 1, v3
  v_lshl_add_u32 v239, v240, 3, v239
  v_add_u32 v7, s21, v239
  s_lshl_b32 s22, s58, 9
  s_lshl_b32 s23, s56, 7
  s_add_u32 s22, s22, s23
  s_add_u32 s22, s22, 376704
  v_lshlrev_b32 v239, 6, v3
  v_lshl_add_u32 v239, v236, 3, v239
  v_add_u32 v239, s22, v239
  s_cmp_eq_u32 s20, 2
  s_cselect_b64 vcc, -1, 0
  v_cndmask_b32 v7, v7, v239, vcc
  s_lshl_b32 s21, s59, 11
  s_add_u32 s21, s21, 81920
  v_add_u32 v8, s21, v16
  s_lshl_b32 s21, s59, 9
  s_add_u32 s21, s21, 376832
  v_lshl_add_u32 v9, v1, 3, s21
  s_mul_i32 s21, s59, 3072
  s_add_u32 s21, s21, 278528
  v_and_b32 v239, 0x39, v1
  v_bfe_u32 v240, v1, 1, 1
  v_lshl_or_b32 v239, v240, 2, v239
  v_bfe_u32 v240, v1, 2, 1
  v_lshl_or_b32 v239, v240, 1, v239
  v_lshl_add_u32 v10, v239, 4, s21
  s_cmp_eq_u32 s20, 3
  s_cselect_b32 s22, s84, s56
  s_mul_i32 s22, s22, 12
  v_add_u32 v239, s22, v3
  v_add3_u32 v240, 0, v239, v3
  v_lshrrev_b32 v241, 1, v240
  v_and_b32 v240, 1, v240
  v_lshlrev_b32 v240, 3, v240
  v_lshl_add_u32 v242, v241, 7, v240
  v_lshl_add_u32 v242, v236, 4, v242
  s_mul_i32 s21, s58, 3072
  v_add_u32 v21, s21, v242
  v_lshl_add_u32 v242, v241, 8, v240
  v_lshl_add_u32 v242, v2, 4, v242
  s_mul_i32 s21, s58, 12288
  s_and_b32 s22, s20, 1
  s_mul_i32 s22, s22, 6144
  s_add_u32 s21, s21, s22
  v_add_u32 v18, s21, v242
  v_add3_u32 v240, 1, v239, v3
  v_lshrrev_b32 v241, 1, v240
  v_and_b32 v240, 1, v240
  v_lshlrev_b32 v240, 3, v240
  v_lshl_add_u32 v242, v241, 7, v240
  v_lshl_add_u32 v242, v236, 4, v242
  s_mul_i32 s21, s58, 3072
  v_add_u32 v22, s21, v242
  v_lshl_add_u32 v242, v241, 8, v240
  v_lshl_add_u32 v242, v2, 4, v242
  s_mul_i32 s21, s58, 12288
  s_and_b32 s22, s20, 1
  s_mul_i32 s22, s22, 6144
  s_add_u32 s21, s21, s22
  v_add_u32 v19, s21, v242
  v_add_u32 v240, 8, v239
  v_lshrrev_b32 v241, 1, v240
  v_and_b32 v240, 1, v240
  v_lshlrev_b32 v240, 3, v240
  v_lshl_add_u32 v242, v241, 7, v240
  v_lshl_add_u32 v242, v236, 4, v242
  s_mul_i32 s21, s58, 3072
  v_add_u32 v23, s21, v242
  v_lshl_add_u32 v242, v241, 8, v240
  v_lshl_add_u32 v242, v2, 4, v242
  s_mul_i32 s21, s58, 12288
  s_and_b32 s22, s20, 1
  s_mul_i32 s22, s22, 6144
  s_add_u32 s21, s21, s22
  v_add_u32 v20, s21, v242
  v_cmp_eq_u32 vcc, 1, v237
  s_nop 1
  v_cndmask_b32 v25, v21, v22, vcc
  v_add_u32 v24, 278528, v25
  s_mul_i32 s21, s20, 3072
  s_add_u32 s21, s21, 22528
  v_add_u32 v11, s21, v16
  v_and_b32 v239, 3, v1
  s_lshl_b32 s21, s20, 2
  v_add_u32 v240, s21, v239
  v_cmp_eq_u32 vcc, 10, v240
  s_nop 1
  v_cndmask_b32 v240, v240, 7, vcc
  v_cmp_eq_u32 vcc, 3, v239
  v_lshrrev_b32 v241, 5, v1
  v_mul_u32_u24 v241, 10, v241
  v_cndmask_b32 v240, v240, 3, vcc
  s_lshl_b32 s21, s79, 2
  v_add3_u32 v240, v240, v241, s21
  v_lshrrev_b32 v241, 1, v240
  v_lshlrev_b32 v241, 8, v241
  v_and_b32 v240, 1, v240
  v_lshl_add_u32 v241, v240, 3, v241
  v_bfe_u32 v240, v1, 2, 3
  v_lshl_add_u32 v241, v240, 4, v241
  v_add_u32 v12, 22528, v241
  s_mov_b32 s21, 0x07060100
  s_cmp_eq_u32 s20, 1
  s_cselect_b32 s21, 0x07060302, s21
  s_cmp_eq_u32 s20, 2
  s_cselect_b32 s21, 0x07060c0c, s21
  v_mov_b32 v240, s21
  v_mov_b32 v241, 0x03020100
  v_cndmask_b32 v14, v241, v240, vcc
  s_lshr_b32 s21, s85, 3
  s_lshl_b32 s21, s21, 14
  s_bfe_u32 s22, s85, 0x10002
  s_mul_i32 s22, s22, 3072
  s_add_u32 s21, s21, s22
  s_and_b32 s22, s85, 3
  s_lshl_b32 s22, s22, 8
  s_add_u32 s21, s21, s22
  s_lshl_b32 s22, s20, 10
  s_add_u32 s22, s22, s21
  v_lshl_add_u32 v13, v1, 2, s22
  v_lshlrev_b32 v240, 10, v3
  v_lshl_add_u32 v240, v2, 4, v240
  v_add_u32 v240, s21, v240
  s_cmp_eq_u32 s20, 3
  s_cselect_b64 vcc, -1, 0
  v_cndmask_b32 v13, v13, v240, vcc
  s_mov_b32 s91, 0x3c000000
  v_and_b32 v240, 1, v3
  v_lshrrev_b32 v241, 1, v3
  v_lshl_add_u32 v240, v240, 1, v241
  v_lshlrev_b32 v240, 8, v240
  v_lshl_add_u32 v240, v2, 4, v240
  s_mul_i32 s21, s59, 10240
  s_lshl_b32 s22, s87, 8
  s_add_u32 s21, s21, s22
  v_add_u32 v15, s21, v240
  s_lshl_b32 s21, s79, 4
  s_lshl_b32 s76, -1, s21
  s_mov_b32 s77, 0xffff
  s_lshl_b32 s21, s79, 7
  v_or_b32 v17, s21, v16
  s_or_b32 s21, s21, 0xffffff7f
  v_and_b32 v26, s21, v16
  v_mov_b32 v243, 0
  s_mul_i32 s89, s59, 12288
  s_add_u32 s89, s89, 25165824
  v_cmp_gt_u32 s[60:61], 8, v2
  v_cmp_le_u32 s[62:63], 8, v2
  v_cmp_le_u32 s[72:73], 2, v3
  v_cmp_gt_u32 s[70:71], 48, v1
  s_nop 1
  s_and_b64 s[64:65], s[60:61], s[72:73]
  s_cmp_eq_u32 s20, 2
  s_cselect_b64 s[74:75], s[64:65], s[60:61]
  s_mul_i32 s89, s59, 12288
  s_add_u32 s89, s89, 25165824
  s_not_b64 s[48:49], s[72:73]
  v_mov_b32 v27, 10923
  v_mov_b32 v49, v100
  v_add_u32 v113, 576, v1
  v_mul_u32_u24 v103, v113, v27
  v_lshrrev_b32 v103, 16, v103
  v_mul_u32_u24 v102, 6, v103
  v_sub_u32 v113, v113, v102
  v_bfe_u32 v102, v103, 1, 1
  v_lshlrev_b32 v102, 3, v102
  v_and_b32 v127, 12, v103
  v_lshrrev_b32 v127, 1, v127
  v_and_b32 v103, 0xfffffff1, v103
  v_or3_b32 v103, v103, v102, v127
  v_mul_u32_u24 v102, 1366, v103
  v_lshrrev_b32 v102, 16, v102
  v_mul_u32_u24 v100, 48, v102
  v_sub_u32 v103, v103, v100
  v_cmp_gt_u32 vcc, 32, v103
  v_bfe_u32 v101, v103, 3, 2
  v_and_b32 v126, 3, v103
  v_lshl_add_u32 v126, v101, 2, v126
  v_bfe_u32 v101, v103, 2, 1
  v_lshl_add_u32 v126, v101, 4, v126
  v_cndmask_b32 v103, v103, v126, vcc
  v_add_u32 v100, v100, v103
  v_mul_u32_u24 v100, 1280, v100
  v_lshl_add_u32 v113, v113, 4, v100
  v_add_u32 v114, 640, v1
  v_mul_u32_u24 v103, v114, v27
  v_lshrrev_b32 v103, 16, v103
  v_mul_u32_u24 v102, 6, v103
  v_sub_u32 v114, v114, v102
  v_bfe_u32 v102, v103, 1, 1
  v_lshlrev_b32 v102, 3, v102
  v_and_b32 v127, 12, v103
  v_lshrrev_b32 v127, 1, v127
  v_and_b32 v103, 0xfffffff1, v103
  v_or3_b32 v103, v103, v102, v127
  v_mul_u32_u24 v102, 1366, v103
  v_lshrrev_b32 v102, 16, v102
  v_mul_u32_u24 v100, 48, v102
  v_sub_u32 v103, v103, v100
  v_cmp_gt_u32 vcc, 32, v103
  v_bfe_u32 v101, v103, 3, 2
  v_and_b32 v126, 3, v103
  v_lshl_add_u32 v126, v101, 2, v126
  v_bfe_u32 v101, v103, 2, 1
  v_lshl_add_u32 v126, v101, 4, v126
  v_cndmask_b32 v103, v103, v126, vcc
  v_add_u32 v100, v100, v103
  v_mul_u32_u24 v100, 1280, v100
  v_lshl_add_u32 v114, v114, 4, v100
  v_add_u32 v115, 704, v1
  v_mul_u32_u24 v103, v115, v27
  v_lshrrev_b32 v103, 16, v103
  v_mul_u32_u24 v102, 6, v103
  v_sub_u32 v115, v115, v102
  v_bfe_u32 v102, v103, 1, 1
  v_lshlrev_b32 v102, 3, v102
  v_and_b32 v127, 12, v103
  v_lshrrev_b32 v127, 1, v127
  v_and_b32 v103, 0xfffffff1, v103
  v_or3_b32 v103, v103, v102, v127
  v_mul_u32_u24 v102, 1366, v103
  v_lshrrev_b32 v102, 16, v102
  v_mul_u32_u24 v100, 48, v102
  v_sub_u32 v103, v103, v100
  v_cmp_gt_u32 vcc, 32, v103
  v_bfe_u32 v101, v103, 3, 2
  v_and_b32 v126, 3, v103
  v_lshl_add_u32 v126, v101, 2, v126
  v_bfe_u32 v101, v103, 2, 1
  v_lshl_add_u32 v126, v101, 4, v126
  v_cndmask_b32 v103, v103, v126, vcc
  v_add_u32 v100, v100, v103
  v_mul_u32_u24 v100, 1280, v100
  v_lshl_add_u32 v115, v115, 4, v100
  v_add_u32 v116, 768, v1
  v_mul_u32_u24 v103, v116, v27
  v_lshrrev_b32 v103, 16, v103
  v_mul_u32_u24 v102, 6, v103
  v_sub_u32 v116, v116, v102
  v_bfe_u32 v102, v103, 1, 1
  v_lshlrev_b32 v102, 3, v102
  v_and_b32 v127, 12, v103
  v_lshrrev_b32 v127, 1, v127
  v_and_b32 v103, 0xfffffff1, v103
  v_or3_b32 v103, v103, v102, v127
  v_mul_u32_u24 v102, 1366, v103
  v_lshrrev_b32 v102, 16, v102
  v_mul_u32_u24 v100, 48, v102
  v_sub_u32 v103, v103, v100
  v_cmp_gt_u32 vcc, 32, v103
  v_bfe_u32 v101, v103, 3, 2
  v_and_b32 v126, 3, v103
  v_lshl_add_u32 v126, v101, 2, v126
  v_bfe_u32 v101, v103, 2, 1
  v_lshl_add_u32 v126, v101, 4, v126
  v_cndmask_b32 v103, v103, v126, vcc
  v_add_u32 v100, v100, v103
  v_mul_u32_u24 v100, 1280, v100
  v_lshl_add_u32 v116, v116, 4, v100
  v_add_u32 v117, 832, v1
  v_mul_u32_u24 v103, v117, v27
  v_lshrrev_b32 v103, 16, v103
  v_mul_u32_u24 v102, 6, v103
  v_sub_u32 v117, v117, v102
  v_bfe_u32 v102, v103, 1, 1
  v_lshlrev_b32 v102, 3, v102
  v_and_b32 v127, 12, v103
  v_lshrrev_b32 v127, 1, v127
  v_and_b32 v103, 0xfffffff1, v103
  v_or3_b32 v103, v103, v102, v127
  v_mul_u32_u24 v102, 1366, v103
  v_lshrrev_b32 v102, 16, v102
  v_mul_u32_u24 v100, 48, v102
  v_sub_u32 v103, v103, v100
  v_cmp_gt_u32 vcc, 32, v103
  v_bfe_u32 v101, v103, 3, 2
  v_and_b32 v126, 3, v103
  v_lshl_add_u32 v126, v101, 2, v126
  v_bfe_u32 v101, v103, 2, 1
  v_lshl_add_u32 v126, v101, 4, v126
  v_cndmask_b32 v103, v103, v126, vcc
  v_add_u32 v100, v100, v103
  v_mul_u32_u24 v100, 1280, v100
  v_lshl_add_u32 v117, v117, 4, v100
  v_add_u32 v118, 896, v1
  v_mul_u32_u24 v103, v118, v27
  v_lshrrev_b32 v103, 16, v103
  v_mul_u32_u24 v102, 6, v103
  v_sub_u32 v118, v118, v102
  v_bfe_u32 v102, v103, 1, 1
  v_lshlrev_b32 v102, 3, v102
  v_and_b32 v127, 12, v103
  v_lshrrev_b32 v127, 1, v127
  v_and_b32 v103, 0xfffffff1, v103
  v_or3_b32 v103, v103, v102, v127
  v_mul_u32_u24 v102, 1366, v103
  v_lshrrev_b32 v102, 16, v102
  v_mul_u32_u24 v100, 48, v102
  v_sub_u32 v103, v103, v100
  v_cmp_gt_u32 vcc, 32, v103
  v_bfe_u32 v101, v103, 3, 2
  v_and_b32 v126, 3, v103
  v_lshl_add_u32 v126, v101, 2, v126
  v_bfe_u32 v101, v103, 2, 1
  v_lshl_add_u32 v126, v101, 4, v126
  v_cndmask_b32 v103, v103, v126, vcc
  v_add_u32 v100, v100, v103
  v_mul_u32_u24 v100, 1280, v100
  v_lshl_add_u32 v118, v118, 4, v100
  v_add_u32 v119, 960, v1
  v_mul_u32_u24 v103, v119, v27
  v_lshrrev_b32 v103, 16, v103
  v_mul_u32_u24 v102, 6, v103
  v_sub_u32 v119, v119, v102
  v_bfe_u32 v102, v103, 1, 1
  v_lshlrev_b32 v102, 3, v102
  v_and_b32 v127, 12, v103
  v_lshrrev_b32 v127, 1, v127
  v_and_b32 v103, 0xfffffff1, v103
  v_or3_b32 v103, v103, v102, v127
  v_mul_u32_u24 v102, 1366, v103
  v_lshrrev_b32 v102, 16, v102
  v_mul_u32_u24 v100, 48, v102
  v_sub_u32 v103, v103, v100
  v_cmp_gt_u32 vcc, 32, v103
  v_bfe_u32 v101, v103, 3, 2
  v_and_b32 v126, 3, v103
  v_lshl_add_u32 v126, v101, 2, v126
  v_bfe_u32 v101, v103, 2, 1
  v_lshl_add_u32 v126, v101, 4, v126
  v_cndmask_b32 v103, v103, v126, vcc
  v_add_u32 v100, v100, v103
  v_mul_u32_u24 v100, 1280, v100
  v_lshl_add_u32 v119, v119, 4, v100
  v_add_u32 v120, 1024, v1
  v_mul_u32_u24 v103, v120, v27
  v_lshrrev_b32 v103, 16, v103
  v_mul_u32_u24 v102, 6, v103
  v_sub_u32 v120, v120, v102
  v_bfe_u32 v102, v103, 1, 1
  v_lshlrev_b32 v102, 3, v102
  v_and_b32 v127, 12, v103
  v_lshrrev_b32 v127, 1, v127
  v_and_b32 v103, 0xfffffff1, v103
  v_or3_b32 v103, v103, v102, v127
  v_mul_u32_u24 v102, 1366, v103
  v_lshrrev_b32 v102, 16, v102
  v_mul_u32_u24 v100, 48, v102
  v_sub_u32 v103, v103, v100
  v_cmp_gt_u32 vcc, 32, v103
  v_bfe_u32 v101, v103, 3, 2
  v_and_b32 v126, 3, v103
  v_lshl_add_u32 v126, v101, 2, v126
  v_bfe_u32 v101, v103, 2, 1
  v_lshl_add_u32 v126, v101, 4, v126
  v_cndmask_b32 v103, v103, v126, vcc
  v_add_u32 v100, v100, v103
  v_mul_u32_u24 v100, 1280, v100
  v_lshl_add_u32 v120, v120, 4, v100
  v_add_u32 v121, 1088, v1
  v_mul_u32_u24 v103, v121, v27
  v_lshrrev_b32 v103, 16, v103
  v_mul_u32_u24 v102, 6, v103
  v_sub_u32 v121, v121, v102
  v_bfe_u32 v102, v103, 1, 1
  v_lshlrev_b32 v102, 3, v102
  v_and_b32 v127, 12, v103
  v_lshrrev_b32 v127, 1, v127
  v_and_b32 v103, 0xfffffff1, v103
  v_or3_b32 v103, v103, v102, v127
  v_mul_u32_u24 v102, 1366, v103
  v_lshrrev_b32 v102, 16, v102
  v_mul_u32_u24 v100, 48, v102
  v_sub_u32 v103, v103, v100
  v_cmp_gt_u32 vcc, 32, v103
  v_bfe_u32 v101, v103, 3, 2
  v_and_b32 v126, 3, v103
  v_lshl_add_u32 v126, v101, 2, v126
  v_bfe_u32 v101, v103, 2, 1
  v_lshl_add_u32 v126, v101, 4, v126
  v_cndmask_b32 v103, v103, v126, vcc
  v_add_u32 v100, v100, v103
  v_mul_u32_u24 v100, 1280, v100
  v_lshl_add_u32 v121, v121, 4, v100
  s_waitcnt vmcnt(63)
  s_mov_b32 s12, s42
  s_mov_b32 s13, s43
  s_mov_b32 s14, 7864320
  s_mov_b32 s15, 0x00020000
  buffer_load_dwordx4 v[188:191], v113, s[12:15], s82 offen
  buffer_load_dwordx4 v[192:195], v114, s[12:15], s82 offen
  buffer_load_dwordx4 v[196:199], v115, s[12:15], s82 offen
  buffer_load_dwordx4 v[200:203], v116, s[12:15], s82 offen
  buffer_load_dwordx4 v[204:207], v117, s[12:15], s82 offen
  buffer_load_dwordx4 v[208:211], v118, s[12:15], s82 offen
  buffer_load_dwordx4 v[212:215], v119, s[12:15], s82 offen
  buffer_load_dwordx4 v[216:219], v120, s[12:15], s82 offen
  buffer_load_dwordx4 v[220:223], v121, s[12:15], s82 offen
  v_add_u32 v104, 0, v1
  v_mul_u32_u24 v103, v104, v27
  v_lshrrev_b32 v103, 16, v103
  v_mul_u32_u24 v102, 6, v103
  v_sub_u32 v104, v104, v102
  v_bfe_u32 v102, v103, 1, 1
  v_lshlrev_b32 v102, 3, v102
  v_and_b32 v127, 12, v103
  v_lshrrev_b32 v127, 1, v127
  v_and_b32 v103, 0xfffffff1, v103
  v_or3_b32 v103, v103, v102, v127
  v_mul_u32_u24 v102, 1366, v103
  v_lshrrev_b32 v102, 16, v102
  v_mul_u32_u24 v100, 48, v102
  v_sub_u32 v103, v103, v100
  v_cmp_gt_u32 vcc, 32, v103
  v_bfe_u32 v101, v103, 3, 2
  v_and_b32 v126, 3, v103
  v_lshl_add_u32 v126, v101, 2, v126
  v_bfe_u32 v101, v103, 2, 1
  v_lshl_add_u32 v126, v101, 4, v126
  v_cndmask_b32 v103, v103, v126, vcc
  v_add_u32 v100, v100, v103
  v_mul_u32_u24 v100, 1280, v100
  v_lshl_add_u32 v104, v104, 4, v100
  v_add_u32 v105, 64, v1
  v_mul_u32_u24 v103, v105, v27
  v_lshrrev_b32 v103, 16, v103
  v_mul_u32_u24 v102, 6, v103
  v_sub_u32 v105, v105, v102
  v_bfe_u32 v102, v103, 1, 1
  v_lshlrev_b32 v102, 3, v102
  v_and_b32 v127, 12, v103
  v_lshrrev_b32 v127, 1, v127
  v_and_b32 v103, 0xfffffff1, v103
  v_or3_b32 v103, v103, v102, v127
  v_mul_u32_u24 v102, 1366, v103
  v_lshrrev_b32 v102, 16, v102
  v_mul_u32_u24 v100, 48, v102
  v_sub_u32 v103, v103, v100
  v_cmp_gt_u32 vcc, 32, v103
  v_bfe_u32 v101, v103, 3, 2
  v_and_b32 v126, 3, v103
  v_lshl_add_u32 v126, v101, 2, v126
  v_bfe_u32 v101, v103, 2, 1
  v_lshl_add_u32 v126, v101, 4, v126
  v_cndmask_b32 v103, v103, v126, vcc
  v_add_u32 v100, v100, v103
  v_mul_u32_u24 v100, 1280, v100
  v_lshl_add_u32 v105, v105, 4, v100
  v_add_u32 v106, 128, v1
  v_mul_u32_u24 v103, v106, v27
  v_lshrrev_b32 v103, 16, v103
  v_mul_u32_u24 v102, 6, v103
  v_sub_u32 v106, v106, v102
  v_bfe_u32 v102, v103, 1, 1
  v_lshlrev_b32 v102, 3, v102
  v_and_b32 v127, 12, v103
  v_lshrrev_b32 v127, 1, v127
  v_and_b32 v103, 0xfffffff1, v103
  v_or3_b32 v103, v103, v102, v127
  v_mul_u32_u24 v102, 1366, v103
  v_lshrrev_b32 v102, 16, v102
  v_mul_u32_u24 v100, 48, v102
  v_sub_u32 v103, v103, v100
  v_cmp_gt_u32 vcc, 32, v103
  v_bfe_u32 v101, v103, 3, 2
  v_and_b32 v126, 3, v103
  v_lshl_add_u32 v126, v101, 2, v126
  v_bfe_u32 v101, v103, 2, 1
  v_lshl_add_u32 v126, v101, 4, v126
  v_cndmask_b32 v103, v103, v126, vcc
  v_add_u32 v100, v100, v103
  v_mul_u32_u24 v100, 1280, v100
  v_lshl_add_u32 v106, v106, 4, v100
  v_add_u32 v107, 192, v1
  v_mul_u32_u24 v103, v107, v27
  v_lshrrev_b32 v103, 16, v103
  v_mul_u32_u24 v102, 6, v103
  v_sub_u32 v107, v107, v102
  v_bfe_u32 v102, v103, 1, 1
  v_lshlrev_b32 v102, 3, v102
  v_and_b32 v127, 12, v103
  v_lshrrev_b32 v127, 1, v127
  v_and_b32 v103, 0xfffffff1, v103
  v_or3_b32 v103, v103, v102, v127
  v_mul_u32_u24 v102, 1366, v103
  v_lshrrev_b32 v102, 16, v102
  v_mul_u32_u24 v100, 48, v102
  v_sub_u32 v103, v103, v100
  v_cmp_gt_u32 vcc, 32, v103
  v_bfe_u32 v101, v103, 3, 2
  v_and_b32 v126, 3, v103
  v_lshl_add_u32 v126, v101, 2, v126
  v_bfe_u32 v101, v103, 2, 1
  v_lshl_add_u32 v126, v101, 4, v126
  v_cndmask_b32 v103, v103, v126, vcc
  v_add_u32 v100, v100, v103
  v_mul_u32_u24 v100, 1280, v100
  v_lshl_add_u32 v107, v107, 4, v100
  v_add_u32 v108, 256, v1
  v_mul_u32_u24 v103, v108, v27
  v_lshrrev_b32 v103, 16, v103
  v_mul_u32_u24 v102, 6, v103
  v_sub_u32 v108, v108, v102
  v_bfe_u32 v102, v103, 1, 1
  v_lshlrev_b32 v102, 3, v102
  v_and_b32 v127, 12, v103
  v_lshrrev_b32 v127, 1, v127
  v_and_b32 v103, 0xfffffff1, v103
  v_or3_b32 v103, v103, v102, v127
  v_mul_u32_u24 v102, 1366, v103
  v_lshrrev_b32 v102, 16, v102
  v_mul_u32_u24 v100, 48, v102
  v_sub_u32 v103, v103, v100
  v_cmp_gt_u32 vcc, 32, v103
  v_bfe_u32 v101, v103, 3, 2
  v_and_b32 v126, 3, v103
  v_lshl_add_u32 v126, v101, 2, v126
  v_bfe_u32 v101, v103, 2, 1
  v_lshl_add_u32 v126, v101, 4, v126
  v_cndmask_b32 v103, v103, v126, vcc
  v_add_u32 v100, v100, v103
  v_mul_u32_u24 v100, 1280, v100
  v_lshl_add_u32 v108, v108, 4, v100
  v_add_u32 v109, 320, v1
  v_mul_u32_u24 v103, v109, v27
  v_lshrrev_b32 v103, 16, v103
  v_mul_u32_u24 v102, 6, v103
  v_sub_u32 v109, v109, v102
  v_bfe_u32 v102, v103, 1, 1
  v_lshlrev_b32 v102, 3, v102
  v_and_b32 v127, 12, v103
  v_lshrrev_b32 v127, 1, v127
  v_and_b32 v103, 0xfffffff1, v103
  v_or3_b32 v103, v103, v102, v127
  v_mul_u32_u24 v102, 1366, v103
  v_lshrrev_b32 v102, 16, v102
  v_mul_u32_u24 v100, 48, v102
  v_sub_u32 v103, v103, v100
  v_cmp_gt_u32 vcc, 32, v103
  v_bfe_u32 v101, v103, 3, 2
  v_and_b32 v126, 3, v103
  v_lshl_add_u32 v126, v101, 2, v126
  v_bfe_u32 v101, v103, 2, 1
  v_lshl_add_u32 v126, v101, 4, v126
  v_cndmask_b32 v103, v103, v126, vcc
  v_add_u32 v100, v100, v103
  v_mul_u32_u24 v100, 1280, v100
  v_lshl_add_u32 v109, v109, 4, v100
  v_add_u32 v110, 384, v1
  v_mul_u32_u24 v103, v110, v27
  v_lshrrev_b32 v103, 16, v103
  v_mul_u32_u24 v102, 6, v103
  v_sub_u32 v110, v110, v102
  v_bfe_u32 v102, v103, 1, 1
  v_lshlrev_b32 v102, 3, v102
  v_and_b32 v127, 12, v103
  v_lshrrev_b32 v127, 1, v127
  v_and_b32 v103, 0xfffffff1, v103
  v_or3_b32 v103, v103, v102, v127
  v_mul_u32_u24 v102, 1366, v103
  v_lshrrev_b32 v102, 16, v102
  v_mul_u32_u24 v100, 48, v102
  v_sub_u32 v103, v103, v100
  v_cmp_gt_u32 vcc, 32, v103
  v_bfe_u32 v101, v103, 3, 2
  v_and_b32 v126, 3, v103
  v_lshl_add_u32 v126, v101, 2, v126
  v_bfe_u32 v101, v103, 2, 1
  v_lshl_add_u32 v126, v101, 4, v126
  v_cndmask_b32 v103, v103, v126, vcc
  v_add_u32 v100, v100, v103
  v_mul_u32_u24 v100, 1280, v100
  v_lshl_add_u32 v110, v110, 4, v100
  v_add_u32 v111, 448, v1
  v_mul_u32_u24 v103, v111, v27
  v_lshrrev_b32 v103, 16, v103
  v_mul_u32_u24 v102, 6, v103
  v_sub_u32 v111, v111, v102
  v_bfe_u32 v102, v103, 1, 1
  v_lshlrev_b32 v102, 3, v102
  v_and_b32 v127, 12, v103
  v_lshrrev_b32 v127, 1, v127
  v_and_b32 v103, 0xfffffff1, v103
  v_or3_b32 v103, v103, v102, v127
  v_mul_u32_u24 v102, 1366, v103
  v_lshrrev_b32 v102, 16, v102
  v_mul_u32_u24 v100, 48, v102
  v_sub_u32 v103, v103, v100
  v_cmp_gt_u32 vcc, 32, v103
  v_bfe_u32 v101, v103, 3, 2
  v_and_b32 v126, 3, v103
  v_lshl_add_u32 v126, v101, 2, v126
  v_bfe_u32 v101, v103, 2, 1
  v_lshl_add_u32 v126, v101, 4, v126
  v_cndmask_b32 v103, v103, v126, vcc
  v_add_u32 v100, v100, v103
  v_mul_u32_u24 v100, 1280, v100
  v_lshl_add_u32 v111, v111, 4, v100
  v_add_u32 v112, 512, v1
  v_mul_u32_u24 v103, v112, v27
  v_lshrrev_b32 v103, 16, v103
  v_mul_u32_u24 v102, 6, v103
  v_sub_u32 v112, v112, v102
  v_bfe_u32 v102, v103, 1, 1
  v_lshlrev_b32 v102, 3, v102
  v_and_b32 v127, 12, v103
  v_lshrrev_b32 v127, 1, v127
  v_and_b32 v103, 0xfffffff1, v103
  v_or3_b32 v103, v103, v102, v127
  v_mul_u32_u24 v102, 1366, v103
  v_lshrrev_b32 v102, 16, v102
  v_mul_u32_u24 v100, 48, v102
  v_sub_u32 v103, v103, v100
  v_cmp_gt_u32 vcc, 32, v103
  v_bfe_u32 v101, v103, 3, 2
  v_and_b32 v126, 3, v103
  v_lshl_add_u32 v126, v101, 2, v126
  v_bfe_u32 v101, v103, 2, 1
  v_lshl_add_u32 v126, v101, 4, v126
  v_cndmask_b32 v103, v103, v126, vcc
  v_add_u32 v100, v100, v103
  v_mul_u32_u24 v100, 1280, v100
  v_lshl_add_u32 v112, v112, 4, v100
  s_waitcnt vmcnt(63)
  s_mov_b32 s12, s42
  s_mov_b32 s13, s43
  s_mov_b32 s14, 7864320
  s_mov_b32 s15, 0x00020000
  s_add_u32 m0, s81, 30720
  s_nop 0
  buffer_load_dwordx4 v104, s[12:15], s82 offen lds
  s_add_u32 m0, s81, 31744
  s_nop 0
  buffer_load_dwordx4 v105, s[12:15], s82 offen lds
  s_add_u32 m0, s81, 32768
  s_nop 0
  buffer_load_dwordx4 v106, s[12:15], s82 offen lds
  s_add_u32 m0, s81, 33792
  s_nop 0
  buffer_load_dwordx4 v107, s[12:15], s82 offen lds
  s_add_u32 m0, s81, 34816
  s_nop 0
  buffer_load_dwordx4 v108, s[12:15], s82 offen lds
  s_add_u32 m0, s81, 35840
  s_nop 0
  buffer_load_dwordx4 v109, s[12:15], s82 offen lds
  s_add_u32 m0, s81, 36864
  s_nop 0
  buffer_load_dwordx4 v110, s[12:15], s82 offen lds
  s_add_u32 m0, s81, 37888
  s_nop 0
  buffer_load_dwordx4 v111, s[12:15], s82 offen lds
  s_add_u32 m0, s81, 38912
  s_nop 0
  buffer_load_dwordx4 v112, s[12:15], s82 offen lds
  buffer_load_dwordx4 v[32:35], v244, s[28:31], 0 offen offset:0
  buffer_load_dwordx4 v[36:39], v244, s[28:31], 0 offen offset:16
  buffer_load_dwordx2 v[40:41], v244, s[28:31], 0 offen offset:32
  s_waitcnt vmcnt(63)
  s_mov_b32 s12, s36
  s_mov_b32 s13, s37
  s_mov_b32 s14, 7864320
  s_mov_b32 s15, 0x00020000
  s_add_u32 s21, s80, 0
  s_add_u32 s22, s81, 15360
  s_add_u32 m0, s22, 0
  s_nop 0
  buffer_load_dwordx4 v96, s[12:15], s21 offen lds
  s_add_u32 m0, s22, 1024
  s_nop 0
  buffer_load_dwordx4 v97, s[12:15], s21 offen lds
  s_add_u32 m0, s22, 2048
  s_nop 0
  buffer_load_dwordx4 v98, s[12:15], s21 offen lds
  s_waitcnt vmcnt(63)
  s_mov_b32 s12, s36
  s_mov_b32 s13, s37
  s_mov_b32 s14, 7864320
  s_mov_b32 s15, 0x00020000
  s_add_u32 s21, s80, 983040
  s_add_u32 s22, s81, 18432
  s_add_u32 m0, s22, 0
  s_nop 0
  buffer_load_dwordx4 v96, s[12:15], s21 offen lds
  s_add_u32 m0, s22, 1024
  s_nop 0
  buffer_load_dwordx4 v97, s[12:15], s21 offen lds
  s_add_u32 m0, s22, 2048
  s_nop 0
  buffer_load_dwordx4 v98, s[12:15], s21 offen lds
  s_waitcnt vmcnt(63)
  s_mov_b32 s12, s36
  s_mov_b32 s13, s37
  s_mov_b32 s14, 7864320
  s_mov_b32 s15, 0x00020000
  s_add_u32 s21, s80, 98304
  s_add_u32 s22, s81, 21504
  s_add_u32 m0, s22, 0
  s_nop 0
  buffer_load_dwordx4 v96, s[12:15], s21 offen lds
  s_add_u32 m0, s22, 1024
  s_nop 0
  buffer_load_dwordx4 v97, s[12:15], s21 offen lds
  s_add_u32 m0, s22, 2048
  s_nop 0
  buffer_load_dwordx4 v98, s[12:15], s21 offen lds
  s_waitcnt vmcnt(63)
  s_mov_b32 s12, s36
  s_mov_b32 s13, s37
  s_mov_b32 s14, 7864320
  s_mov_b32 s15, 0x00020000
  s_add_u32 s21, s80, 1081344
  s_add_u32 s22, s81, 24576
  s_add_u32 m0, s22, 0
  s_nop 0
  buffer_load_dwordx4 v96, s[12:15], s21 offen lds
  s_add_u32 m0, s22, 1024
  s_nop 0
  buffer_load_dwordx4 v97, s[12:15], s21 offen lds
  s_add_u32 m0, s22, 2048
  s_nop 0
  buffer_load_dwordx4 v98, s[12:15], s21 offen lds
  s_waitcnt vmcnt(63)
  s_mov_b32 s12, s36
  s_mov_b32 s13, s37
  s_mov_b32 s14, 7864320
  s_mov_b32 s15, 0x00020000
  s_add_u32 s21, s80, 196608
  s_add_u32 s22, s81, 27648
  s_add_u32 m0, s22, 0
  s_nop 0
  buffer_load_dwordx4 v46, s[12:15], s21 offen lds
  s_add_u32 m0, s22, 1024
  s_nop 0
  buffer_load_dwordx4 v47, s[12:15], s21 offen lds
  s_add_u32 m0, s22, 2048
  s_nop 0
  buffer_load_dwordx4 v48, s[12:15], s21 offen lds
  v_mov_b32 v100, v49
  v_lshlrev_b32 v239, 2, v1
  s_waitcnt vmcnt(51)
  ds_read_b64_tr_b16 v[52:53], v99 offset:0
  ds_read_b64_tr_b16 v[54:55], v99 offset:384
  ds_read_b64_tr_b16 v[56:57], v99 offset:32
  ds_read_b64_tr_b16 v[58:59], v99 offset:416
  ds_read_b64_tr_b16 v[60:61], v99 offset:64
  ds_read_b64_tr_b16 v[62:63], v99 offset:448
  ds_read_b64_tr_b16 v[64:65], v99 offset:3072
  ds_read_b64_tr_b16 v[66:67], v99 offset:3456
  ds_read_b64_tr_b16 v[68:69], v99 offset:3104
  ds_read_b64_tr_b16 v[70:71], v99 offset:3488
  ds_read_b64_tr_b16 v[72:73], v99 offset:3136
  ds_read_b64_tr_b16 v[74:75], v99 offset:3520
  ds_read_b64_tr_b16 v[76:77], v99 offset:6144
  ds_read_b64_tr_b16 v[78:79], v99 offset:6528
  ds_read_b64_tr_b16 v[80:81], v99 offset:6176
  ds_read_b64_tr_b16 v[82:83], v99 offset:6560
  ds_read_b64_tr_b16 v[84:85], v99 offset:6208
  ds_read_b64_tr_b16 v[86:87], v99 offset:6592
  s_waitcnt lgkmcnt(12)
  v_lshlrev_b32 v50, 16, v52
  v_and_b32 v52, 0xffff0000, v52
  v_cvt_pk_f16_f32 v52, v50, v52
  v_accvgpr_write_b32 a60, v52
  v_lshlrev_b32 v50, 16, v53
  v_and_b32 v53, 0xffff0000, v53
  v_cvt_pk_f16_f32 v53, v50, v53
  v_accvgpr_write_b32 a61, v53
  v_lshlrev_b32 v50, 16, v54
  v_and_b32 v54, 0xffff0000, v54
  v_cvt_pk_f16_f32 v54, v50, v54
  v_accvgpr_write_b32 a62, v54
  v_lshlrev_b32 v50, 16, v55
  v_and_b32 v55, 0xffff0000, v55
  v_cvt_pk_f16_f32 v55, v50, v55
  v_accvgpr_write_b32 a63, v55
  v_lshlrev_b32 v50, 16, v56
  v_and_b32 v56, 0xffff0000, v56
  v_cvt_pk_f16_f32 v56, v50, v56
  v_accvgpr_write_b32 a80, v56
  v_lshlrev_b32 v50, 16, v57
  v_and_b32 v57, 0xffff0000, v57
  v_cvt_pk_f16_f32 v57, v50, v57
  v_accvgpr_write_b32 a81, v57
  v_lshlrev_b32 v50, 16, v58
  v_and_b32 v58, 0xffff0000, v58
  v_cvt_pk_f16_f32 v58, v50, v58
  v_accvgpr_write_b32 a82, v58
  v_lshlrev_b32 v50, 16, v59
  v_and_b32 v59, 0xffff0000, v59
  v_cvt_pk_f16_f32 v59, v50, v59
  v_accvgpr_write_b32 a83, v59
  v_lshlrev_b32 v50, 16, v60
  v_and_b32 v60, 0xffff0000, v60
  v_cvt_pk_f16_f32 v60, v50, v60
  v_accvgpr_write_b32 a100, v60
  v_lshlrev_b32 v50, 16, v61
  v_and_b32 v61, 0xffff0000, v61
  v_cvt_pk_f16_f32 v61, v50, v61
  v_accvgpr_write_b32 a101, v61
  v_lshlrev_b32 v50, 16, v62
  v_and_b32 v62, 0xffff0000, v62
  v_cvt_pk_f16_f32 v62, v50, v62
  v_accvgpr_write_b32 a102, v62
  v_lshlrev_b32 v50, 16, v63
  v_and_b32 v63, 0xffff0000, v63
  v_cvt_pk_f16_f32 v63, v50, v63
  v_accvgpr_write_b32 a103, v63
  ds_read_b64_tr_b16 v[52:53], v99 offset:9216
  ds_read_b64_tr_b16 v[54:55], v99 offset:9600
  ds_read_b64_tr_b16 v[56:57], v99 offset:9248
  ds_read_b64_tr_b16 v[58:59], v99 offset:9632
  ds_read_b64_tr_b16 v[60:61], v99 offset:9280
  ds_read_b64_tr_b16 v[62:63], v99 offset:9664
  s_waitcnt lgkmcnt(12)
  v_lshlrev_b32 v50, 16, v64
  v_and_b32 v64, 0xffff0000, v64
  v_cvt_pk_f16_f32 v64, v50, v64
  v_accvgpr_write_b32 a64, v64
  v_lshlrev_b32 v50, 16, v65
  v_and_b32 v65, 0xffff0000, v65
  v_cvt_pk_f16_f32 v65, v50, v65
  v_accvgpr_write_b32 a65, v65
  v_lshlrev_b32 v50, 16, v66
  v_and_b32 v66, 0xffff0000, v66
  v_cvt_pk_f16_f32 v66, v50, v66
  v_accvgpr_write_b32 a66, v66
  v_lshlrev_b32 v50, 16, v67
  v_and_b32 v67, 0xffff0000, v67
  v_cvt_pk_f16_f32 v67, v50, v67
  v_accvgpr_write_b32 a67, v67
  v_lshlrev_b32 v50, 16, v68
  v_and_b32 v68, 0xffff0000, v68
  v_cvt_pk_f16_f32 v68, v50, v68
  v_accvgpr_write_b32 a84, v68
  v_lshlrev_b32 v50, 16, v69
  v_and_b32 v69, 0xffff0000, v69
  v_cvt_pk_f16_f32 v69, v50, v69
  v_accvgpr_write_b32 a85, v69
  v_lshlrev_b32 v50, 16, v70
  v_and_b32 v70, 0xffff0000, v70
  v_cvt_pk_f16_f32 v70, v50, v70
  v_accvgpr_write_b32 a86, v70
  v_lshlrev_b32 v50, 16, v71
  v_and_b32 v71, 0xffff0000, v71
  v_cvt_pk_f16_f32 v71, v50, v71
  v_accvgpr_write_b32 a87, v71
  v_lshlrev_b32 v50, 16, v72
  v_and_b32 v72, 0xffff0000, v72
  v_cvt_pk_f16_f32 v72, v50, v72
  v_accvgpr_write_b32 a104, v72
  v_lshlrev_b32 v50, 16, v73
  v_and_b32 v73, 0xffff0000, v73
  v_cvt_pk_f16_f32 v73, v50, v73
  v_accvgpr_write_b32 a105, v73
  v_lshlrev_b32 v50, 16, v74
  v_and_b32 v74, 0xffff0000, v74
  v_cvt_pk_f16_f32 v74, v50, v74
  v_accvgpr_write_b32 a106, v74
  v_lshlrev_b32 v50, 16, v75
  v_and_b32 v75, 0xffff0000, v75
  v_cvt_pk_f16_f32 v75, v50, v75
  v_accvgpr_write_b32 a107, v75
  ds_read_b64_tr_b16 v[64:65], v99 offset:12288
  ds_read_b64_tr_b16 v[66:67], v99 offset:12672
  ds_read_b64_tr_b16 v[68:69], v99 offset:12320
  ds_read_b64_tr_b16 v[70:71], v99 offset:12704
  ds_read_b64_tr_b16 v[72:73], v99 offset:12352
  ds_read_b64_tr_b16 v[74:75], v99 offset:12736
  s_waitcnt lgkmcnt(12)
  v_lshlrev_b32 v50, 16, v76
  v_and_b32 v76, 0xffff0000, v76
  v_cvt_pk_f16_f32 v76, v50, v76
  v_accvgpr_write_b32 a68, v76
  v_lshlrev_b32 v50, 16, v77
  v_and_b32 v77, 0xffff0000, v77
  v_cvt_pk_f16_f32 v77, v50, v77
  v_accvgpr_write_b32 a69, v77
  v_lshlrev_b32 v50, 16, v78
  v_and_b32 v78, 0xffff0000, v78
  v_cvt_pk_f16_f32 v78, v50, v78
  v_accvgpr_write_b32 a70, v78
  v_lshlrev_b32 v50, 16, v79
  v_and_b32 v79, 0xffff0000, v79
  v_cvt_pk_f16_f32 v79, v50, v79
  v_accvgpr_write_b32 a71, v79
  v_lshlrev_b32 v50, 16, v80
  v_and_b32 v80, 0xffff0000, v80
  v_cvt_pk_f16_f32 v80, v50, v80
  v_accvgpr_write_b32 a88, v80
  v_lshlrev_b32 v50, 16, v81
  v_and_b32 v81, 0xffff0000, v81
  v_cvt_pk_f16_f32 v81, v50, v81
  v_accvgpr_write_b32 a89, v81
  v_lshlrev_b32 v50, 16, v82
  v_and_b32 v82, 0xffff0000, v82
  v_cvt_pk_f16_f32 v82, v50, v82
  v_accvgpr_write_b32 a90, v82
  v_lshlrev_b32 v50, 16, v83
  v_and_b32 v83, 0xffff0000, v83
  v_cvt_pk_f16_f32 v83, v50, v83
  v_accvgpr_write_b32 a91, v83
  v_lshlrev_b32 v50, 16, v84
  v_and_b32 v84, 0xffff0000, v84
  v_cvt_pk_f16_f32 v84, v50, v84
  v_accvgpr_write_b32 a108, v84
  v_lshlrev_b32 v50, 16, v85
  v_and_b32 v85, 0xffff0000, v85
  v_cvt_pk_f16_f32 v85, v50, v85
  v_accvgpr_write_b32 a109, v85
  v_lshlrev_b32 v50, 16, v86
  v_and_b32 v86, 0xffff0000, v86
  v_cvt_pk_f16_f32 v86, v50, v86
  v_accvgpr_write_b32 a110, v86
  v_lshlrev_b32 v50, 16, v87
  v_and_b32 v87, 0xffff0000, v87
  v_cvt_pk_f16_f32 v87, v50, v87
  v_accvgpr_write_b32 a111, v87
  s_waitcnt lgkmcnt(6)
  v_lshlrev_b32 v50, 16, v52
  v_and_b32 v52, 0xffff0000, v52
  v_cvt_pk_f16_f32 v52, v50, v52
  v_accvgpr_write_b32 a72, v52
  v_lshlrev_b32 v50, 16, v53
  v_and_b32 v53, 0xffff0000, v53
  v_cvt_pk_f16_f32 v53, v50, v53
  v_accvgpr_write_b32 a73, v53
  v_lshlrev_b32 v50, 16, v54
  v_and_b32 v54, 0xffff0000, v54
  v_cvt_pk_f16_f32 v54, v50, v54
  v_accvgpr_write_b32 a74, v54
  v_lshlrev_b32 v50, 16, v55
  v_and_b32 v55, 0xffff0000, v55
  v_cvt_pk_f16_f32 v55, v50, v55
  v_accvgpr_write_b32 a75, v55
  v_lshlrev_b32 v50, 16, v56
  v_and_b32 v56, 0xffff0000, v56
  v_cvt_pk_f16_f32 v56, v50, v56
  v_accvgpr_write_b32 a92, v56
  v_lshlrev_b32 v50, 16, v57
  v_and_b32 v57, 0xffff0000, v57
  v_cvt_pk_f16_f32 v57, v50, v57
  v_accvgpr_write_b32 a93, v57
  v_lshlrev_b32 v50, 16, v58
  v_and_b32 v58, 0xffff0000, v58
  v_cvt_pk_f16_f32 v58, v50, v58
  v_accvgpr_write_b32 a94, v58
  v_lshlrev_b32 v50, 16, v59
  v_and_b32 v59, 0xffff0000, v59
  v_cvt_pk_f16_f32 v59, v50, v59
  v_accvgpr_write_b32 a95, v59
  v_lshlrev_b32 v50, 16, v60
  v_and_b32 v60, 0xffff0000, v60
  v_cvt_pk_f16_f32 v60, v50, v60
  v_accvgpr_write_b32 a112, v60
  v_lshlrev_b32 v50, 16, v61
  v_and_b32 v61, 0xffff0000, v61
  v_cvt_pk_f16_f32 v61, v50, v61
  v_accvgpr_write_b32 a113, v61
  v_lshlrev_b32 v50, 16, v62
  v_and_b32 v62, 0xffff0000, v62
  v_cvt_pk_f16_f32 v62, v50, v62
  v_accvgpr_write_b32 a114, v62
  v_lshlrev_b32 v50, 16, v63
  v_and_b32 v63, 0xffff0000, v63
  v_cvt_pk_f16_f32 v63, v50, v63
  v_accvgpr_write_b32 a115, v63
  s_waitcnt lgkmcnt(0)
  v_lshlrev_b32 v50, 16, v64
  v_and_b32 v64, 0xffff0000, v64
  v_cvt_pk_f16_f32 v64, v50, v64
  v_accvgpr_write_b32 a76, v64
  v_lshlrev_b32 v50, 16, v65
  v_and_b32 v65, 0xffff0000, v65
  v_cvt_pk_f16_f32 v65, v50, v65
  v_accvgpr_write_b32 a77, v65
  v_lshlrev_b32 v50, 16, v66
  v_and_b32 v66, 0xffff0000, v66
  v_cvt_pk_f16_f32 v66, v50, v66
  v_accvgpr_write_b32 a78, v66
  v_lshlrev_b32 v50, 16, v67
  v_and_b32 v67, 0xffff0000, v67
  v_cvt_pk_f16_f32 v67, v50, v67
  v_accvgpr_write_b32 a79, v67
  v_lshlrev_b32 v50, 16, v68
  v_and_b32 v68, 0xffff0000, v68
  v_cvt_pk_f16_f32 v68, v50, v68
  v_accvgpr_write_b32 a96, v68
  v_lshlrev_b32 v50, 16, v69
  v_and_b32 v69, 0xffff0000, v69
  v_cvt_pk_f16_f32 v69, v50, v69
  v_accvgpr_write_b32 a97, v69
  v_lshlrev_b32 v50, 16, v70
  v_and_b32 v70, 0xffff0000, v70
  v_cvt_pk_f16_f32 v70, v50, v70
  v_accvgpr_write_b32 a98, v70
  v_lshlrev_b32 v50, 16, v71
  v_and_b32 v71, 0xffff0000, v71
  v_cvt_pk_f16_f32 v71, v50, v71
  v_accvgpr_write_b32 a99, v71
  v_lshlrev_b32 v50, 16, v72
  v_and_b32 v72, 0xffff0000, v72
  v_cvt_pk_f16_f32 v72, v50, v72
  v_accvgpr_write_b32 a116, v72
  v_lshlrev_b32 v50, 16, v73
  v_and_b32 v73, 0xffff0000, v73
  v_cvt_pk_f16_f32 v73, v50, v73
  v_accvgpr_write_b32 a117, v73
  v_lshlrev_b32 v50, 16, v74
  v_and_b32 v74, 0xffff0000, v74
  v_cvt_pk_f16_f32 v74, v50, v74
  v_accvgpr_write_b32 a118, v74
  v_lshlrev_b32 v50, 16, v75
  v_and_b32 v75, 0xffff0000, v75
  v_cvt_pk_f16_f32 v75, v50, v75
  v_accvgpr_write_b32 a119, v75
  s_waitcnt vmcnt(36)
  ds_write_b128 v100, v[128:131] offset:0
  ds_write_b128 v100, v[132:135] offset:1024
  ds_write_b128 v100, v[136:139] offset:2048
  ds_write_b128 v100, v[140:143] offset:3072
  ds_write_b128 v100, v[144:147] offset:4096
  ds_write_b128 v100, v[148:151] offset:5120
  ds_write_b128 v100, v[152:155] offset:6144
  ds_write_b128 v100, v[156:159] offset:7168
  ds_write_b128 v100, v[160:163] offset:8192
  ds_write_b128 v100, v[164:167] offset:9216
  ds_write_b128 v100, v[168:171] offset:10240
  ds_write_b128 v100, v[172:175] offset:11264
  ds_write_b128 v100, v[176:179] offset:12288
  ds_write_b128 v100, v[180:183] offset:13312
  ds_write_b128 v100, v[184:187] offset:14336
  s_waitcnt lgkmcnt(0)
  ds_read_b64_tr_b16 v[52:53], v99 offset:0
  ds_read_b64_tr_b16 v[54:55], v99 offset:384
  ds_read_b64_tr_b16 v[56:57], v99 offset:32
  ds_read_b64_tr_b16 v[58:59], v99 offset:416
  ds_read_b64_tr_b16 v[60:61], v99 offset:64
  ds_read_b64_tr_b16 v[62:63], v99 offset:448
  ds_read_b64_tr_b16 v[64:65], v99 offset:3072
  ds_read_b64_tr_b16 v[66:67], v99 offset:3456
  ds_read_b64_tr_b16 v[68:69], v99 offset:3104
  ds_read_b64_tr_b16 v[70:71], v99 offset:3488
  ds_read_b64_tr_b16 v[72:73], v99 offset:3136
  ds_read_b64_tr_b16 v[74:75], v99 offset:3520
  ds_read_b64_tr_b16 v[76:77], v99 offset:6144
  ds_read_b64_tr_b16 v[78:79], v99 offset:6528
  ds_read_b64_tr_b16 v[80:81], v99 offset:6176
  ds_read_b64_tr_b16 v[82:83], v99 offset:6560
  ds_read_b64_tr_b16 v[84:85], v99 offset:6208
  ds_read_b64_tr_b16 v[86:87], v99 offset:6592
  s_waitcnt lgkmcnt(12)
  v_lshlrev_b32 v50, 16, v52
  v_and_b32 v52, 0xffff0000, v52
  v_cvt_pk_f16_f32 v52, v50, v52
  v_accvgpr_write_b32 a120, v52
  v_lshlrev_b32 v50, 16, v53
  v_and_b32 v53, 0xffff0000, v53
  v_cvt_pk_f16_f32 v53, v50, v53
  v_accvgpr_write_b32 a121, v53
  v_lshlrev_b32 v50, 16, v54
  v_and_b32 v54, 0xffff0000, v54
  v_cvt_pk_f16_f32 v54, v50, v54
  v_accvgpr_write_b32 a122, v54
  v_lshlrev_b32 v50, 16, v55
  v_and_b32 v55, 0xffff0000, v55
  v_cvt_pk_f16_f32 v55, v50, v55
  v_accvgpr_write_b32 a123, v55
  v_lshlrev_b32 v50, 16, v56
  v_and_b32 v56, 0xffff0000, v56
  v_cvt_pk_f16_f32 v56, v50, v56
  v_accvgpr_write_b32 a140, v56
  v_lshlrev_b32 v50, 16, v57
  v_and_b32 v57, 0xffff0000, v57
  v_cvt_pk_f16_f32 v57, v50, v57
  v_accvgpr_write_b32 a141, v57
  v_lshlrev_b32 v50, 16, v58
  v_and_b32 v58, 0xffff0000, v58
  v_cvt_pk_f16_f32 v58, v50, v58
  v_accvgpr_write_b32 a142, v58
  v_lshlrev_b32 v50, 16, v59
  v_and_b32 v59, 0xffff0000, v59
  v_cvt_pk_f16_f32 v59, v50, v59
  v_accvgpr_write_b32 a143, v59
  v_lshlrev_b32 v50, 16, v60
  v_and_b32 v60, 0xffff0000, v60
  v_cvt_pk_f16_f32 v60, v50, v60
  v_accvgpr_write_b32 a160, v60
  v_lshlrev_b32 v50, 16, v61
  v_and_b32 v61, 0xffff0000, v61
  v_cvt_pk_f16_f32 v61, v50, v61
  v_accvgpr_write_b32 a161, v61
  v_lshlrev_b32 v50, 16, v62
  v_and_b32 v62, 0xffff0000, v62
  v_cvt_pk_f16_f32 v62, v50, v62
  v_accvgpr_write_b32 a162, v62
  v_lshlrev_b32 v50, 16, v63
  v_and_b32 v63, 0xffff0000, v63
  v_cvt_pk_f16_f32 v63, v50, v63
  v_accvgpr_write_b32 a163, v63
  ds_read_b64_tr_b16 v[52:53], v99 offset:9216
  ds_read_b64_tr_b16 v[54:55], v99 offset:9600
  ds_read_b64_tr_b16 v[56:57], v99 offset:9248
  ds_read_b64_tr_b16 v[58:59], v99 offset:9632
  ds_read_b64_tr_b16 v[60:61], v99 offset:9280
  ds_read_b64_tr_b16 v[62:63], v99 offset:9664
  s_waitcnt lgkmcnt(12)
  v_lshlrev_b32 v50, 16, v64
  v_and_b32 v64, 0xffff0000, v64
  v_cvt_pk_f16_f32 v64, v50, v64
  v_accvgpr_write_b32 a124, v64
  v_lshlrev_b32 v50, 16, v65
  v_and_b32 v65, 0xffff0000, v65
  v_cvt_pk_f16_f32 v65, v50, v65
  v_accvgpr_write_b32 a125, v65
  v_lshlrev_b32 v50, 16, v66
  v_and_b32 v66, 0xffff0000, v66
  v_cvt_pk_f16_f32 v66, v50, v66
  v_accvgpr_write_b32 a126, v66
  v_lshlrev_b32 v50, 16, v67
  v_and_b32 v67, 0xffff0000, v67
  v_cvt_pk_f16_f32 v67, v50, v67
  v_accvgpr_write_b32 a127, v67
  v_lshlrev_b32 v50, 16, v68
  v_and_b32 v68, 0xffff0000, v68
  v_cvt_pk_f16_f32 v68, v50, v68
  v_accvgpr_write_b32 a144, v68
  v_lshlrev_b32 v50, 16, v69
  v_and_b32 v69, 0xffff0000, v69
  v_cvt_pk_f16_f32 v69, v50, v69
  v_accvgpr_write_b32 a145, v69
  v_lshlrev_b32 v50, 16, v70
  v_and_b32 v70, 0xffff0000, v70
  v_cvt_pk_f16_f32 v70, v50, v70
  v_accvgpr_write_b32 a146, v70
  v_lshlrev_b32 v50, 16, v71
  v_and_b32 v71, 0xffff0000, v71
  v_cvt_pk_f16_f32 v71, v50, v71
  v_accvgpr_write_b32 a147, v71
  v_lshlrev_b32 v50, 16, v72
  v_and_b32 v72, 0xffff0000, v72
  v_cvt_pk_f16_f32 v72, v50, v72
  v_accvgpr_write_b32 a164, v72
  v_lshlrev_b32 v50, 16, v73
  v_and_b32 v73, 0xffff0000, v73
  v_cvt_pk_f16_f32 v73, v50, v73
  v_accvgpr_write_b32 a165, v73
  v_lshlrev_b32 v50, 16, v74
  v_and_b32 v74, 0xffff0000, v74
  v_cvt_pk_f16_f32 v74, v50, v74
  v_accvgpr_write_b32 a166, v74
  v_lshlrev_b32 v50, 16, v75
  v_and_b32 v75, 0xffff0000, v75
  v_cvt_pk_f16_f32 v75, v50, v75
  v_accvgpr_write_b32 a167, v75
  ds_read_b64_tr_b16 v[64:65], v99 offset:12288
  ds_read_b64_tr_b16 v[66:67], v99 offset:12672
  ds_read_b64_tr_b16 v[68:69], v99 offset:12320
  ds_read_b64_tr_b16 v[70:71], v99 offset:12704
  ds_read_b64_tr_b16 v[72:73], v99 offset:12352
  ds_read_b64_tr_b16 v[74:75], v99 offset:12736
  s_waitcnt lgkmcnt(12)
  v_lshlrev_b32 v50, 16, v76
  v_and_b32 v76, 0xffff0000, v76
  v_cvt_pk_f16_f32 v76, v50, v76
  v_accvgpr_write_b32 a128, v76
  v_lshlrev_b32 v50, 16, v77
  v_and_b32 v77, 0xffff0000, v77
  v_cvt_pk_f16_f32 v77, v50, v77
  v_accvgpr_write_b32 a129, v77
  v_lshlrev_b32 v50, 16, v78
  v_and_b32 v78, 0xffff0000, v78
  v_cvt_pk_f16_f32 v78, v50, v78
  v_accvgpr_write_b32 a130, v78
  v_lshlrev_b32 v50, 16, v79
  v_and_b32 v79, 0xffff0000, v79
  v_cvt_pk_f16_f32 v79, v50, v79
  v_accvgpr_write_b32 a131, v79
  v_lshlrev_b32 v50, 16, v80
  v_and_b32 v80, 0xffff0000, v80
  v_cvt_pk_f16_f32 v80, v50, v80
  v_accvgpr_write_b32 a148, v80
  v_lshlrev_b32 v50, 16, v81
  v_and_b32 v81, 0xffff0000, v81
  v_cvt_pk_f16_f32 v81, v50, v81
  v_accvgpr_write_b32 a149, v81
  v_lshlrev_b32 v50, 16, v82
  v_and_b32 v82, 0xffff0000, v82
  v_cvt_pk_f16_f32 v82, v50, v82
  v_accvgpr_write_b32 a150, v82
  v_lshlrev_b32 v50, 16, v83
  v_and_b32 v83, 0xffff0000, v83
  v_cvt_pk_f16_f32 v83, v50, v83
  v_accvgpr_write_b32 a151, v83
  v_lshlrev_b32 v50, 16, v84
  v_and_b32 v84, 0xffff0000, v84
  v_cvt_pk_f16_f32 v84, v50, v84
  v_accvgpr_write_b32 a168, v84
  v_lshlrev_b32 v50, 16, v85
  v_and_b32 v85, 0xffff0000, v85
  v_cvt_pk_f16_f32 v85, v50, v85
  v_accvgpr_write_b32 a169, v85
  v_lshlrev_b32 v50, 16, v86
  v_and_b32 v86, 0xffff0000, v86
  v_cvt_pk_f16_f32 v86, v50, v86
  v_accvgpr_write_b32 a170, v86
  v_lshlrev_b32 v50, 16, v87
  v_and_b32 v87, 0xffff0000, v87
  v_cvt_pk_f16_f32 v87, v50, v87
  v_accvgpr_write_b32 a171, v87
  s_waitcnt lgkmcnt(6)
  v_lshlrev_b32 v50, 16, v52
  v_and_b32 v52, 0xffff0000, v52
  v_cvt_pk_f16_f32 v52, v50, v52
  v_accvgpr_write_b32 a132, v52
  v_lshlrev_b32 v50, 16, v53
  v_and_b32 v53, 0xffff0000, v53
  v_cvt_pk_f16_f32 v53, v50, v53
  v_accvgpr_write_b32 a133, v53
  v_lshlrev_b32 v50, 16, v54
  v_and_b32 v54, 0xffff0000, v54
  v_cvt_pk_f16_f32 v54, v50, v54
  v_accvgpr_write_b32 a134, v54
  v_lshlrev_b32 v50, 16, v55
  v_and_b32 v55, 0xffff0000, v55
  v_cvt_pk_f16_f32 v55, v50, v55
  v_accvgpr_write_b32 a135, v55
  v_lshlrev_b32 v50, 16, v56
  v_and_b32 v56, 0xffff0000, v56
  v_cvt_pk_f16_f32 v56, v50, v56
  v_accvgpr_write_b32 a152, v56
  v_lshlrev_b32 v50, 16, v57
  v_and_b32 v57, 0xffff0000, v57
  v_cvt_pk_f16_f32 v57, v50, v57
  v_accvgpr_write_b32 a153, v57
  v_lshlrev_b32 v50, 16, v58
  v_and_b32 v58, 0xffff0000, v58
  v_cvt_pk_f16_f32 v58, v50, v58
  v_accvgpr_write_b32 a154, v58
  v_lshlrev_b32 v50, 16, v59
  v_and_b32 v59, 0xffff0000, v59
  v_cvt_pk_f16_f32 v59, v50, v59
  v_accvgpr_write_b32 a155, v59
  v_lshlrev_b32 v50, 16, v60
  v_and_b32 v60, 0xffff0000, v60
  v_cvt_pk_f16_f32 v60, v50, v60
  v_accvgpr_write_b32 a172, v60
  v_lshlrev_b32 v50, 16, v61
  v_and_b32 v61, 0xffff0000, v61
  v_cvt_pk_f16_f32 v61, v50, v61
  v_accvgpr_write_b32 a173, v61
  v_lshlrev_b32 v50, 16, v62
  v_and_b32 v62, 0xffff0000, v62
  v_cvt_pk_f16_f32 v62, v50, v62
  v_accvgpr_write_b32 a174, v62
  v_lshlrev_b32 v50, 16, v63
  v_and_b32 v63, 0xffff0000, v63
  v_cvt_pk_f16_f32 v63, v50, v63
  v_accvgpr_write_b32 a175, v63
  s_waitcnt lgkmcnt(0)
  v_lshlrev_b32 v50, 16, v64
  v_and_b32 v64, 0xffff0000, v64
  v_cvt_pk_f16_f32 v64, v50, v64
  v_accvgpr_write_b32 a136, v64
  v_lshlrev_b32 v50, 16, v65
  v_and_b32 v65, 0xffff0000, v65
  v_cvt_pk_f16_f32 v65, v50, v65
  v_accvgpr_write_b32 a137, v65
  v_lshlrev_b32 v50, 16, v66
  v_and_b32 v66, 0xffff0000, v66
  v_cvt_pk_f16_f32 v66, v50, v66
  v_accvgpr_write_b32 a138, v66
  v_lshlrev_b32 v50, 16, v67
  v_and_b32 v67, 0xffff0000, v67
  v_cvt_pk_f16_f32 v67, v50, v67
  v_accvgpr_write_b32 a139, v67
  v_lshlrev_b32 v50, 16, v68
  v_and_b32 v68, 0xffff0000, v68
  v_cvt_pk_f16_f32 v68, v50, v68
  v_accvgpr_write_b32 a156, v68
  v_lshlrev_b32 v50, 16, v69
  v_and_b32 v69, 0xffff0000, v69
  v_cvt_pk_f16_f32 v69, v50, v69
  v_accvgpr_write_b32 a157, v69
  v_lshlrev_b32 v50, 16, v70
  v_and_b32 v70, 0xffff0000, v70
  v_cvt_pk_f16_f32 v70, v50, v70
  v_accvgpr_write_b32 a158, v70
  v_lshlrev_b32 v50, 16, v71
  v_and_b32 v71, 0xffff0000, v71
  v_cvt_pk_f16_f32 v71, v50, v71
  v_accvgpr_write_b32 a159, v71
  v_lshlrev_b32 v50, 16, v72
  v_and_b32 v72, 0xffff0000, v72
  v_cvt_pk_f16_f32 v72, v50, v72
  v_accvgpr_write_b32 a176, v72
  v_lshlrev_b32 v50, 16, v73
  v_and_b32 v73, 0xffff0000, v73
  v_cvt_pk_f16_f32 v73, v50, v73
  v_accvgpr_write_b32 a177, v73
  v_lshlrev_b32 v50, 16, v74
  v_and_b32 v74, 0xffff0000, v74
  v_cvt_pk_f16_f32 v74, v50, v74
  v_accvgpr_write_b32 a178, v74
  v_lshlrev_b32 v50, 16, v75
  v_and_b32 v75, 0xffff0000, v75
  v_cvt_pk_f16_f32 v75, v50, v75
  v_accvgpr_write_b32 a179, v75
  s_waitcnt vmcnt(27)
  s_cmp_lg_u32 s20, 0
  s_cbranch_scc1 ic_7
  buffer_load_dword v238, v239, s[32:35], 0 offen sc1
ic_7:
  ds_write_b128 v100, v[188:191] offset:0
  ds_write_b128 v100, v[192:195] offset:1024
  ds_write_b128 v100, v[196:199] offset:2048
  ds_write_b128 v100, v[200:203] offset:3072
  ds_write_b128 v100, v[204:207] offset:4096
  ds_write_b128 v100, v[208:211] offset:5120
  ds_write_b128 v100, v[212:215] offset:6144
  ds_write_b128 v100, v[216:219] offset:7168
  ds_write_b128 v100, v[220:223] offset:8192
  s_waitcnt lgkmcnt(0)
  ds_read_b64_tr_b16 a[192:193], v99 offset:0
  ds_read_b64_tr_b16 a[194:195], v99 offset:384
  ds_read_b64_tr_b16 a[216:217], v99 offset:32
  ds_read_b64_tr_b16 a[218:219], v99 offset:416
  ds_read_b64_tr_b16 a[240:241], v99 offset:64
  ds_read_b64_tr_b16 a[242:243], v99 offset:448
  ds_read_b64_tr_b16 a[196:197], v99 offset:3072
  ds_read_b64_tr_b16 a[198:199], v99 offset:3456
  ds_read_b64_tr_b16 a[220:221], v99 offset:3104
  ds_read_b64_tr_b16 a[222:223], v99 offset:3488
  ds_read_b64_tr_b16 a[244:245], v99 offset:3136
  ds_read_b64_tr_b16 a[246:247], v99 offset:3520
  ds_read_b64_tr_b16 a[200:201], v99 offset:6144
  ds_read_b64_tr_b16 a[202:203], v99 offset:6528
  ds_read_b64_tr_b16 a[224:225], v99 offset:6176
  ds_read_b64_tr_b16 a[226:227], v99 offset:6560
  ds_read_b64_tr_b16 a[248:249], v99 offset:6208
  ds_read_b64_tr_b16 a[250:251], v99 offset:6592
  s_waitcnt lgkmcnt(0)
  s_waitcnt vmcnt(15)
  ds_read_b64_tr_b16 a[180:181], v99 offset:30720
  ds_read_b64_tr_b16 a[182:183], v99 offset:31104
  ds_read_b64_tr_b16 a[204:205], v99 offset:30752
  ds_read_b64_tr_b16 a[206:207], v99 offset:31136
  ds_read_b64_tr_b16 a[228:229], v99 offset:30784
  ds_read_b64_tr_b16 a[230:231], v99 offset:31168
  ds_read_b64_tr_b16 a[184:185], v99 offset:33792
  ds_read_b64_tr_b16 a[186:187], v99 offset:34176
  ds_read_b64_tr_b16 a[208:209], v99 offset:33824
  ds_read_b64_tr_b16 a[210:211], v99 offset:34208
  ds_read_b64_tr_b16 a[232:233], v99 offset:33856
  ds_read_b64_tr_b16 a[234:235], v99 offset:34240
  ds_read_b64_tr_b16 a[188:189], v99 offset:36864
  ds_read_b64_tr_b16 a[190:191], v99 offset:37248
  ds_read_b64_tr_b16 a[212:213], v99 offset:36896
  ds_read_b64_tr_b16 a[214:215], v99 offset:37280
  ds_read_b64_tr_b16 a[236:237], v99 offset:36928
  ds_read_b64_tr_b16 a[238:239], v99 offset:37312
  s_waitcnt lgkmcnt(0)
  v_lshlrev_b32 v50, 16, v32
  v_and_b32 v32, 0xffff0000, v32
  v_cvt_pk_f16_f32 v32, v50, v32
  v_lshlrev_b32 v50, 16, v33
  v_and_b32 v33, 0xffff0000, v33
  v_cvt_pk_f16_f32 v33, v50, v33
  v_lshlrev_b32 v50, 16, v34
  v_and_b32 v34, 0xffff0000, v34
  v_cvt_pk_f16_f32 v34, v50, v34
  v_lshlrev_b32 v50, 16, v35
  v_and_b32 v35, 0xffff0000, v35
  v_cvt_pk_f16_f32 v35, v50, v35
  v_lshlrev_b32 v50, 16, v36
  v_and_b32 v36, 0xffff0000, v36
  v_cvt_pk_f16_f32 v36, v50, v36
  v_lshlrev_b32 v50, 16, v37
  v_and_b32 v37, 0xffff0000, v37
  v_cvt_pk_f16_f32 v37, v50, v37
  v_lshlrev_b32 v50, 16, v38
  v_and_b32 v38, 0xffff0000, v38
  v_cvt_pk_f16_f32 v38, v50, v38
  v_lshlrev_b32 v50, 16, v39
  v_and_b32 v39, 0xffff0000, v39
  v_cvt_pk_f16_f32 v39, v50, v39
  v_lshlrev_b32 v50, 16, v40
  v_and_b32 v40, 0xffff0000, v40
  v_cvt_pk_f16_f32 v40, v50, v40
  v_lshlrev_b32 v50, 16, v41
  v_and_b32 v41, 0xffff0000, v41
  v_cvt_pk_f16_f32 v41, v50, v41
  v_mov_b32 v174, 0
  v_mov_b32 v175, 0
  v_mov_b32 v218, 0
  v_mov_b32 v219, 0
  v_mov_b32 v234, 0
  v_mov_b32 v235, 0
  v_mov_b32 v220, 0
  v_mov_b32 v221, 0
  v_mov_b32 v222, 0
  v_mov_b32 v223, 0
  v_mov_b32 v224, 0
  v_mov_b32 v225, 0
  v_mov_b32 v226, 0
  v_mov_b32 v227, 0
  s_waitcnt vmcnt(12)
  ds_read_b64_tr_b16 v[52:53], v99 offset:15360
  ds_read_b64_tr_b16 v[54:55], v99 offset:15744
  ds_read_b64_tr_b16 v[56:57], v99 offset:15392
  ds_read_b64_tr_b16 v[58:59], v99 offset:15776
  ds_read_b64_tr_b16 v[60:61], v99 offset:15424
  ds_read_b64_tr_b16 v[62:63], v99 offset:15808
  s_waitcnt lgkmcnt(0)
  v_lshlrev_b32 v50, 16, v52
  v_and_b32 v52, 0xffff0000, v52
  v_cvt_pk_f16_f32 v52, v50, v52
  v_accvgpr_write_b32 a0, v52
  v_lshlrev_b32 v50, 16, v53
  v_and_b32 v53, 0xffff0000, v53
  v_cvt_pk_f16_f32 v53, v50, v53
  v_accvgpr_write_b32 a1, v53
  v_lshlrev_b32 v50, 16, v54
  v_and_b32 v54, 0xffff0000, v54
  v_cvt_pk_f16_f32 v54, v50, v54
  v_accvgpr_write_b32 a2, v54
  v_lshlrev_b32 v50, 16, v55
  v_and_b32 v55, 0xffff0000, v55
  v_cvt_pk_f16_f32 v55, v50, v55
  v_accvgpr_write_b32 a3, v55
  v_lshlrev_b32 v50, 16, v56
  v_and_b32 v56, 0xffff0000, v56
  v_cvt_pk_f16_f32 v56, v50, v56
  v_accvgpr_write_b32 a20, v56
  v_lshlrev_b32 v50, 16, v57
  v_and_b32 v57, 0xffff0000, v57
  v_cvt_pk_f16_f32 v57, v50, v57
  v_accvgpr_write_b32 a21, v57
  v_lshlrev_b32 v50, 16, v58
  v_and_b32 v58, 0xffff0000, v58
  v_cvt_pk_f16_f32 v58, v50, v58
  v_accvgpr_write_b32 a22, v58
  v_lshlrev_b32 v50, 16, v59
  v_and_b32 v59, 0xffff0000, v59
  v_cvt_pk_f16_f32 v59, v50, v59
  v_accvgpr_write_b32 a23, v59
  v_lshlrev_b32 v50, 16, v60
  v_and_b32 v60, 0xffff0000, v60
  v_cvt_pk_f16_f32 v60, v50, v60
  v_accvgpr_write_b32 a40, v60
  v_lshlrev_b32 v50, 16, v61
  v_and_b32 v61, 0xffff0000, v61
  v_cvt_pk_f16_f32 v61, v50, v61
  v_accvgpr_write_b32 a41, v61
  v_lshlrev_b32 v50, 16, v62
  v_and_b32 v62, 0xffff0000, v62
  v_cvt_pk_f16_f32 v62, v50, v62
  v_accvgpr_write_b32 a42, v62
  v_lshlrev_b32 v50, 16, v63
  v_and_b32 v63, 0xffff0000, v63
  v_cvt_pk_f16_f32 v63, v50, v63
  v_accvgpr_write_b32 a43, v63
  s_waitcnt vmcnt(9)
  ds_read_b64_tr_b16 v[64:65], v99 offset:18432
  ds_read_b64_tr_b16 v[66:67], v99 offset:18816
  ds_read_b64_tr_b16 v[68:69], v99 offset:18464
  ds_read_b64_tr_b16 v[70:71], v99 offset:18848
  ds_read_b64_tr_b16 v[72:73], v99 offset:18496
  ds_read_b64_tr_b16 v[74:75], v99 offset:18880
  s_waitcnt lgkmcnt(0)
  v_lshlrev_b32 v50, 16, v64
  v_and_b32 v64, 0xffff0000, v64
  v_cvt_pk_f16_f32 v64, v50, v64
  v_accvgpr_write_b32 a4, v64
  v_lshlrev_b32 v50, 16, v65
  v_and_b32 v65, 0xffff0000, v65
  v_cvt_pk_f16_f32 v65, v50, v65
  v_accvgpr_write_b32 a5, v65
  v_lshlrev_b32 v50, 16, v66
  v_and_b32 v66, 0xffff0000, v66
  v_cvt_pk_f16_f32 v66, v50, v66
  v_accvgpr_write_b32 a6, v66
  v_lshlrev_b32 v50, 16, v67
  v_and_b32 v67, 0xffff0000, v67
  v_cvt_pk_f16_f32 v67, v50, v67
  v_accvgpr_write_b32 a7, v67
  v_lshlrev_b32 v50, 16, v68
  v_and_b32 v68, 0xffff0000, v68
  v_cvt_pk_f16_f32 v68, v50, v68
  v_accvgpr_write_b32 a24, v68
  v_lshlrev_b32 v50, 16, v69
  v_and_b32 v69, 0xffff0000, v69
  v_cvt_pk_f16_f32 v69, v50, v69
  v_accvgpr_write_b32 a25, v69
  v_lshlrev_b32 v50, 16, v70
  v_and_b32 v70, 0xffff0000, v70
  v_cvt_pk_f16_f32 v70, v50, v70
  v_accvgpr_write_b32 a26, v70
  v_lshlrev_b32 v50, 16, v71
  v_and_b32 v71, 0xffff0000, v71
  v_cvt_pk_f16_f32 v71, v50, v71
  v_accvgpr_write_b32 a27, v71
  v_lshlrev_b32 v50, 16, v72
  v_and_b32 v72, 0xffff0000, v72
  v_cvt_pk_f16_f32 v72, v50, v72
  v_accvgpr_write_b32 a44, v72
  v_lshlrev_b32 v50, 16, v73
  v_and_b32 v73, 0xffff0000, v73
  v_cvt_pk_f16_f32 v73, v50, v73
  v_accvgpr_write_b32 a45, v73
  v_lshlrev_b32 v50, 16, v74
  v_and_b32 v74, 0xffff0000, v74
  v_cvt_pk_f16_f32 v74, v50, v74
  v_accvgpr_write_b32 a46, v74
  v_lshlrev_b32 v50, 16, v75
  v_and_b32 v75, 0xffff0000, v75
  v_cvt_pk_f16_f32 v75, v50, v75
  v_accvgpr_write_b32 a47, v75
  s_waitcnt vmcnt(6)
  ds_read_b64_tr_b16 v[76:77], v99 offset:21504
  ds_read_b64_tr_b16 v[78:79], v99 offset:21888
  ds_read_b64_tr_b16 v[80:81], v99 offset:21536
  ds_read_b64_tr_b16 v[82:83], v99 offset:21920
  ds_read_b64_tr_b16 v[84:85], v99 offset:21568
  ds_read_b64_tr_b16 v[86:87], v99 offset:21952
  s_waitcnt lgkmcnt(0)
  v_lshlrev_b32 v50, 16, v76
  v_and_b32 v76, 0xffff0000, v76
  v_cvt_pk_f16_f32 v76, v50, v76
  v_accvgpr_write_b32 a8, v76
  v_lshlrev_b32 v50, 16, v77
  v_and_b32 v77, 0xffff0000, v77
  v_cvt_pk_f16_f32 v77, v50, v77
  v_accvgpr_write_b32 a9, v77
  v_lshlrev_b32 v50, 16, v78
  v_and_b32 v78, 0xffff0000, v78
  v_cvt_pk_f16_f32 v78, v50, v78
  v_accvgpr_write_b32 a10, v78
  v_lshlrev_b32 v50, 16, v79
  v_and_b32 v79, 0xffff0000, v79
  v_cvt_pk_f16_f32 v79, v50, v79
  v_accvgpr_write_b32 a11, v79
  v_lshlrev_b32 v50, 16, v80
  v_and_b32 v80, 0xffff0000, v80
  v_cvt_pk_f16_f32 v80, v50, v80
  v_accvgpr_write_b32 a28, v80
  v_lshlrev_b32 v50, 16, v81
  v_and_b32 v81, 0xffff0000, v81
  v_cvt_pk_f16_f32 v81, v50, v81
  v_accvgpr_write_b32 a29, v81
  v_lshlrev_b32 v50, 16, v82
  v_and_b32 v82, 0xffff0000, v82
  v_cvt_pk_f16_f32 v82, v50, v82
  v_accvgpr_write_b32 a30, v82
  v_lshlrev_b32 v50, 16, v83
  v_and_b32 v83, 0xffff0000, v83
  v_cvt_pk_f16_f32 v83, v50, v83
  v_accvgpr_write_b32 a31, v83
  v_lshlrev_b32 v50, 16, v84
  v_and_b32 v84, 0xffff0000, v84
  v_cvt_pk_f16_f32 v84, v50, v84
  v_accvgpr_write_b32 a48, v84
  v_lshlrev_b32 v50, 16, v85
  v_and_b32 v85, 0xffff0000, v85
  v_cvt_pk_f16_f32 v85, v50, v85
  v_accvgpr_write_b32 a49, v85
  v_lshlrev_b32 v50, 16, v86
  v_and_b32 v86, 0xffff0000, v86
  v_cvt_pk_f16_f32 v86, v50, v86
  v_accvgpr_write_b32 a50, v86
  v_lshlrev_b32 v50, 16, v87
  v_and_b32 v87, 0xffff0000, v87
  v_cvt_pk_f16_f32 v87, v50, v87
  v_accvgpr_write_b32 a51, v87
  s_waitcnt vmcnt(3)
  ds_read_b64_tr_b16 v[52:53], v99 offset:24576
  ds_read_b64_tr_b16 v[54:55], v99 offset:24960
  ds_read_b64_tr_b16 v[56:57], v99 offset:24608
  ds_read_b64_tr_b16 v[58:59], v99 offset:24992
  ds_read_b64_tr_b16 v[60:61], v99 offset:24640
  ds_read_b64_tr_b16 v[62:63], v99 offset:25024
  s_waitcnt lgkmcnt(0)
  v_lshlrev_b32 v50, 16, v52
  v_and_b32 v52, 0xffff0000, v52
  v_cvt_pk_f16_f32 v52, v50, v52
  v_accvgpr_write_b32 a12, v52
  v_lshlrev_b32 v50, 16, v53
  v_and_b32 v53, 0xffff0000, v53
  v_cvt_pk_f16_f32 v53, v50, v53
  v_accvgpr_write_b32 a13, v53
  v_lshlrev_b32 v50, 16, v54
  v_and_b32 v54, 0xffff0000, v54
  v_cvt_pk_f16_f32 v54, v50, v54
  v_accvgpr_write_b32 a14, v54
  v_lshlrev_b32 v50, 16, v55
  v_and_b32 v55, 0xffff0000, v55
  v_cvt_pk_f16_f32 v55, v50, v55
  v_accvgpr_write_b32 a15, v55
  v_lshlrev_b32 v50, 16, v56
  v_and_b32 v56, 0xffff0000, v56
  v_cvt_pk_f16_f32 v56, v50, v56
  v_accvgpr_write_b32 a32, v56
  v_lshlrev_b32 v50, 16, v57
  v_and_b32 v57, 0xffff0000, v57
  v_cvt_pk_f16_f32 v57, v50, v57
  v_accvgpr_write_b32 a33, v57
  v_lshlrev_b32 v50, 16, v58
  v_and_b32 v58, 0xffff0000, v58
  v_cvt_pk_f16_f32 v58, v50, v58
  v_accvgpr_write_b32 a34, v58
  v_lshlrev_b32 v50, 16, v59
  v_and_b32 v59, 0xffff0000, v59
  v_cvt_pk_f16_f32 v59, v50, v59
  v_accvgpr_write_b32 a35, v59
  v_lshlrev_b32 v50, 16, v60
  v_and_b32 v60, 0xffff0000, v60
  v_cvt_pk_f16_f32 v60, v50, v60
  v_accvgpr_write_b32 a52, v60
  v_lshlrev_b32 v50, 16, v61
  v_and_b32 v61, 0xffff0000, v61
  v_cvt_pk_f16_f32 v61, v50, v61
  v_accvgpr_write_b32 a53, v61
  v_lshlrev_b32 v50, 16, v62
  v_and_b32 v62, 0xffff0000, v62
  v_cvt_pk_f16_f32 v62, v50, v62
  v_accvgpr_write_b32 a54, v62
  v_lshlrev_b32 v50, 16, v63
  v_and_b32 v63, 0xffff0000, v63
  v_cvt_pk_f16_f32 v63, v50, v63
  v_accvgpr_write_b32 a55, v63
  s_waitcnt vmcnt(0)
  ds_read_b64_tr_b16 v[64:65], v99 offset:27648
  ds_read_b64_tr_b16 v[66:67], v99 offset:28032
  ds_read_b64_tr_b16 v[68:69], v99 offset:27680
  ds_read_b64_tr_b16 v[70:71], v99 offset:28064
  ds_read_b64_tr_b16 v[72:73], v99 offset:27712
  ds_read_b64_tr_b16 v[74:75], v99 offset:28096
  s_waitcnt lgkmcnt(0)
  v_lshlrev_b32 v50, 16, v64
  v_and_b32 v64, 0xffff0000, v64
  v_cvt_pk_f16_f32 v64, v50, v64
  v_accvgpr_write_b32 a16, v64
  v_lshlrev_b32 v50, 16, v65
  v_and_b32 v65, 0xffff0000, v65
  v_cvt_pk_f16_f32 v65, v50, v65
  v_accvgpr_write_b32 a17, v65
  v_lshlrev_b32 v50, 16, v66
  v_and_b32 v66, 0xffff0000, v66
  v_cvt_pk_f16_f32 v66, v50, v66
  v_accvgpr_write_b32 a18, v66
  v_lshlrev_b32 v50, 16, v67
  v_and_b32 v67, 0xffff0000, v67
  v_cvt_pk_f16_f32 v67, v50, v67
  v_accvgpr_write_b32 a19, v67
  v_lshlrev_b32 v50, 16, v68
  v_and_b32 v68, 0xffff0000, v68
  v_cvt_pk_f16_f32 v68, v50, v68
  v_accvgpr_write_b32 a36, v68
  v_lshlrev_b32 v50, 16, v69
  v_and_b32 v69, 0xffff0000, v69
  v_cvt_pk_f16_f32 v69, v50, v69
  v_accvgpr_write_b32 a37, v69
  v_lshlrev_b32 v50, 16, v70
  v_and_b32 v70, 0xffff0000, v70
  v_cvt_pk_f16_f32 v70, v50, v70
  v_accvgpr_write_b32 a38, v70
  v_lshlrev_b32 v50, 16, v71
  v_and_b32 v71, 0xffff0000, v71
  v_cvt_pk_f16_f32 v71, v50, v71
  v_accvgpr_write_b32 a39, v71
  v_lshlrev_b32 v50, 16, v72
  v_and_b32 v72, 0xffff0000, v72
  v_cvt_pk_f16_f32 v72, v50, v72
  v_accvgpr_write_b32 a56, v72
  v_lshlrev_b32 v50, 16, v73
  v_and_b32 v73, 0xffff0000, v73
  v_cvt_pk_f16_f32 v73, v50, v73
  v_accvgpr_write_b32 a57, v73
  v_lshlrev_b32 v50, 16, v74
  v_and_b32 v74, 0xffff0000, v74
  v_cvt_pk_f16_f32 v74, v50, v74
  v_accvgpr_write_b32 a58, v74
  v_lshlrev_b32 v50, 16, v75
  v_and_b32 v75, 0xffff0000, v75
  v_cvt_pk_f16_f32 v75, v50, v75
  v_accvgpr_write_b32 a59, v75
  s_waitcnt vmcnt(0)
  s_barrier
  s_add_u32 s12, s44, 81068032
  s_addc_u32 s13, s45, 0
  s_mov_b32 s14, 116736
  s_mov_b32 s15, 0x00020000
  s_add_u32 s28, s44, 114294784
  s_addc_u32 s29, s45, 0
  s_mov_b32 s30, 83886080
  s_mov_b32 s31, 0x00020000
  s_mul_i32 s64, s59, 40960
  s_lshl_b32 s21, s87, 10
  s_add_u32 s64, s64, s21
  s_add_u32 s64, s64, 1310720
  s_lshl_b32 s79, s59, 7
  s_and_b32 s21, s51, 12
  s_add_u32 s79, s79, s21
  s_add_u32 s79, s79, 95232
  v_mov_b32 v94, 0
  v_mov_b32 v95, 0
  s_lshl_b32 s90, s58, 7
  s_lshl_b32 s21, s56, 3
  s_add_u32 s90, s90, s21
  s_add_u32 s90, s90, 19456
  s_cmp_eq_u32 s56, 0
  s_cselect_b32 s65, s90, 0x80000000
  s_mov_b32 s69, 0
  v_lshlrev_b32 v88, 3, v1
  s_cmp_lg_u32 s20, 0
  s_cbranch_scc1 fm_9
  s_bfe_u32 s82, s50, 0x10001
  s_lshl_b32 s82, s82, 5
  s_lshr_b32 s21, s50, 2
  s_add_u32 s82, s82, s21
  s_and_b32 s80, s50, 1
  s_lshl_b32 s80, s80, 4
  s_add_u32 s80, s80, 16
  s_mov_b32 s101, 0
  s_branch fm_10
fm_8:
  s_sleep 8
  buffer_load_dword v238, v239, s[32:35], 0 offen sc1
  s_add_u32 s101, s101, 1
  s_cmp_gt_u32 s101, 131072
  s_cbranch_scc1 end0
  s_waitcnt vmcnt(0)
fm_10:
  v_readlane_b32 s22, v238, 0
  v_readlane_b32 s23, v238, 32
  s_add_u32 s22, s22, s23
  v_readlane_b32 s23, v238, 1
  s_add_u32 s22, s22, s23
  v_readlane_b32 s23, v238, 33
  s_add_u32 s22, s22, s23
  v_readlane_b32 s23, v238, 2
  s_add_u32 s22, s22, s23
  v_readlane_b32 s23, v238, 34
  s_add_u32 s22, s22, s23
  v_readlane_b32 s23, v238, 3
  s_add_u32 s22, s22, s23
  v_readlane_b32 s23, v238, 35
  s_add_u32 s22, s22, s23
  v_readlane_b32 s21, v238, 19
  v_readlane_b32 s23, v238, 21
  s_cmp_ge_u32 s22, 256
  s_cselect_b32 s23, s23, 0
  s_cmp_ge_u32 s21, 32
  s_cselect_b32 s23, s23, 0
  s_cmp_eq_u32 s23, 0
  s_cbranch_scc1 fm_8
  v_readlane_b32 s21, v238, s82
  s_cmp_ge_u32 s21, s80
  s_cselect_b32 s81, 1, 0
  s_andn2_b32 s53, s81, s53
  v_mov_b32 v244, s23
  v_mov_b32 v245, s53
  v_mov_b32 v236, 0
  ds_write_b64 v236, v[244:245]
  s_waitcnt lgkmcnt(0)
fm_9:
  s_barrier
  v_mov_b32 v236, 0
  ds_read_b64 v[244:245], v236
  buffer_load_dword v94, v95, s[12:15], s79 offen sc1
  s_and_b32 s21, s51, 3
  s_mul_i32 s21, s21, 540672
  buffer_load_dwordx2 v[96:97], v9, s[8:11], s21 offen sc1
  buffer_load_dwordx4 v[96:99], v8, s[8:11], s21 offen offset:0 sc1
  buffer_load_dwordx4 v[96:99], v8, s[8:11], s21 offen offset:1024 sc1
  buffer_load_dwordx4 v[96:99], v10, s[8:11], s21 offen offset:0 sc1
  buffer_load_dwordx4 v[96:99], v10, s[8:11], s21 offen offset:1024 sc1
  buffer_load_dwordx4 v[96:99], v10, s[8:11], s21 offen offset:2048 sc1
  s_waitcnt lgkmcnt(0)
  v_readfirstlane_b32 s53, v245
  v_add_u32 v237, -1, v244
  v_lshlrev_b32 v237, 13, v237
  v_xor_b32 v237, 0, v237
  v_add_u32 v13, v13, v237
  v_add_u32 v4, v4, v237
  s_lshl_b32 s21, s50, 7
  s_add_u32 s21, s21, 0
  s_cmp_lg_u32 s20, 0
  s_cbranch_scc1 wf_12
  v_mov_b32 v240, 0
  s_mov_b32 s101, 0
wf_11:
  buffer_load_dword v241, v240, s[12:15], s21 offen sc1
  s_add_u32 s101, s101, 1
  s_cmp_gt_u32 s101, 131072
  s_cbranch_scc1 end0
  s_waitcnt vmcnt(0)
  v_readfirstlane_b32 s100, v241
  s_cmp_ge_u32 s100, 8
  s_cbranch_scc1 wf_12
  s_sleep 6
  s_branch wf_11
wf_12:
  s_barrier
  s_cmp_ge_u32 s20, 2
  s_cbranch_scc1 pf_13
  buffer_load_dwordx4 v[168:171], v18, s[16:19], 0 offen sc1
  buffer_load_dwordx2 v[172:173], v20, s[16:19], 0 offen sc1
pf_13:
  s_waitcnt vmcnt(6)
  v_readfirstlane_b32 s21, v94
  s_mov_b32 s87, 1
  s_cmp_eq_u32 s21, 0
  s_cbranch_scc1 pf_14
  s_mov_b32 s87, 0
  s_sub_u32 s21, s64, 1310720
  buffer_load_dwordx4 v[176:179], v16, s[28:31], s21 offen offset:0 sc1
  buffer_load_dwordx4 v[180:183], v16, s[28:31], s21 offen offset:1024 sc1
  buffer_load_dwordx4 v[184:187], v16, s[28:31], s21 offen offset:2048 sc1
pf_14:
  s_lshl_b32 s21, s20, 2
  s_add_u32 s21, s21, 34816
  v_add_u32 v242, s21, v16
  v_bfe_u32 v243, v1, 2, 3
  v_lshlrev_b32 v243, 4, v243
  v_add_u32 v243, 34816, v243
  s_mov_b32 s52, 0
  s_mov_b32 s89, 0x05040100
  v_mov_b32 v52, 0
  v_mov_b32 v53, 0
  v_mov_b32 v54, 0
  v_mov_b32 v55, 0
  v_mov_b32 v56, 0
  v_mov_b32 v57, 0
  v_mov_b32 v58, 0
  v_mov_b32 v59, 0
  v_mov_b32 v60, 0
  v_mov_b32 v61, 0
  v_mov_b32 v62, 0
  v_mov_b32 v63, 0
  v_mov_b32 v64, 0
  v_mov_b32 v65, 0
  v_mov_b32 v66, 0
  v_mov_b32 v67, 0
  v_mov_b32 v68, 0
  v_mov_b32 v69, 0
  v_mov_b32 v70, 0
  v_mov_b32 v71, 0
  v_mov_b32 v72, 0
  v_mov_b32 v73, 0
  v_mov_b32 v74, 0
  v_mov_b32 v75, 0
  v_mov_b32 v76, 0
  v_mov_b32 v77, 0
  v_mov_b32 v78, 0
  v_mov_b32 v79, 0
  v_mov_b32 v80, 0
  v_mov_b32 v81, 0
  v_mov_b32 v82, 0
  v_mov_b32 v83, 0
  v_mov_b32 v84, 0
  v_mov_b32 v85, 0
  v_mov_b32 v86, 0
  v_mov_b32 v87, 0
  v_mov_b32 v156, 0
  v_mov_b32 v157, 0
  v_mov_b32 v158, 0
  v_mov_b32 v159, 0
  s_and_b32 s21, s52, 3
  s_mul_i32 s81, s21, 540672
  s_lshl_b32 s84, s21, 15
  s_add_u32 s21, s52, 2
  s_and_b32 s21, s21, 3
  s_mul_i32 s82, s21, 540672
  s_add_u32 s21, s52, 3
  s_and_b32 s21, s21, 3
  s_lshl_b32 s83, s21, 15
  s_add_u32 s21, s52, 1
  s_and_b32 s22, s21, 3
  s_lshl_b32 s3, s22, 15
  s_mul_i32 s80, s21, 393216
  s_add_u32 s46, s21, 1
  s_min_u32 s46, s46, 64
  s_mul_i32 s85, s52, 98304
  s_mul_i32 s57, s52, 327680
  s_add_u32 s57, s57, 42991616

  s_bfe_u32 s88, s52, 0x10002
  s_add_u32 s78, s81, 278528
  s_max_u32 s21, s52, 1
  s_sub_u32 s21, s21, 1
  s_cmp_lt_u32 s52, 98
  s_cselect_b32 s66, s65, 0x80000000
  s_cselect_b32 s68, 15, 1
  s_cmp_ge_u32 s52, 99
  s_cselect_b32 s66, s90, s66
  s_cselect_b32 s67, s52, s21
  s_cmp_eq_u32 s53, 0
  s_cbranch_scc1 A1_19
  s_cmp_eq_u32 s20, 0
  s_cbranch_scc1 A1_15
  s_cmp_eq_u32 s20, 1
  s_cbranch_scc1 A1_16
  s_cmp_eq_u32 s20, 2
  s_cbranch_scc1 A1_17
  s_cmp_eq_u32 s20, 3
  s_cbranch_scc1 A1_18
  s_branch A1_19
step_20:
  s_add_u32 s21, s52, 2
  s_and_b32 s21, s21, 3
  s_mul_i32 s82, s21, 540672
  s_add_u32 s21, s52, 3
  s_and_b32 s21, s21, 3
  s_lshl_b32 s83, s21, 15
  s_add_u32 s21, s52, 1
  s_and_b32 s22, s21, 3
  s_lshl_b32 s3, s22, 15
  s_mul_i32 s80, s21, 393216
  s_add_u32 s46, s21, 1
  s_min_u32 s46, s46, 64
  s_mul_i32 s85, s52, 98304
  s_mul_i32 s57, s52, 327680
  s_add_u32 s57, s57, 42991616

  s_bfe_u32 s88, s52, 0x10002
  s_add_u32 s78, s81, 278528
  s_max_u32 s21, s52, 1
  s_sub_u32 s21, s21, 1
  s_cmp_lt_u32 s52, 98
  s_cselect_b32 s66, s65, 0x80000000
  s_cselect_b32 s68, 15, 1
  s_cmp_ge_u32 s52, 99
  s_cselect_b32 s66, s90, s66
  s_cselect_b32 s67, s52, s21
  v_mov_b32 v52, 0
  v_mov_b32 v53, 0
  v_mov_b32 v54, 0
  v_mov_b32 v55, 0
  v_mov_b32 v56, 0
  v_mov_b32 v57, 0
  v_mov_b32 v58, 0
  v_mov_b32 v59, 0
  v_mov_b32 v60, 0
  v_mov_b32 v61, 0
  v_mov_b32 v62, 0
  v_mov_b32 v63, 0
  v_mov_b32 v64, 0
  v_mov_b32 v65, 0
  v_mov_b32 v66, 0
  v_mov_b32 v67, 0
  v_mov_b32 v68, 0
  v_mov_b32 v69, 0
  v_mov_b32 v70, 0
  v_mov_b32 v71, 0
  v_mov_b32 v72, 0
  v_mov_b32 v73, 0
  v_mov_b32 v74, 0
  v_mov_b32 v75, 0
  v_mov_b32 v76, 0
  v_mov_b32 v77, 0
  v_mov_b32 v78, 0
  v_mov_b32 v79, 0
  v_mov_b32 v80, 0
  v_mov_b32 v81, 0
  v_mov_b32 v82, 0
  v_mov_b32 v83, 0
  v_mov_b32 v84, 0
  v_mov_b32 v85, 0
  v_mov_b32 v86, 0
  v_mov_b32 v87, 0
  s_sleep 4
  v_readfirstlane_b32 s21, v94
  s_cmp_lt_u32 s21, s46
  s_cselect_b32 s55, s55, 0
  s_cmp_lt_i32 s55, 0
  s_cbranch_scc1 fl_24
fl_25:
  s_mov_b32 s54, 0
  buffer_load_dwordx4 v[32:35], v4, s[4:7], s84 offen offset:0 sc1
  buffer_load_dwordx4 v[36:39], v4, s[4:7], s84 offen offset:1024 sc1
  buffer_load_dwordx4 v[40:43], v4, s[4:7], s84 offen offset:2048 sc1
  s_waitcnt vmcnt(3)
  v_mov_b32 v176, v160
  v_mov_b32 v177, v161
  v_mov_b32 v178, v162
  v_mov_b32 v179, v163
  v_mov_b32 v180, v164
  v_mov_b32 v181, v165
  v_mov_b32 v182, v166
  v_mov_b32 v183, v167
  v_mov_b32 v184, v48
  v_mov_b32 v185, v49
  v_mov_b32 v186, v50
  v_mov_b32 v187, v51
  s_waitcnt vmcnt(0)
  v_bitop3_b32 v27, v35, v39, v43 bitop3:0x80
  v_perm_b32 v35, v39, v35, s89
  v_cmp_gt_u32 vcc, 0x48000000, v27
  v_mov_b32 v39, v42
  s_cbranch_vccnz pm_22
A1_15:
  v_smfmac_f32_16x16x32_f16 v[52:55], v[40:41], a[16:19], v44
  v_smfmac_f32_16x16x32_f16 v[64:67], v[40:41], a[76:79], v44
  v_smfmac_f32_16x16x32_f16 v[56:59], v[40:41], a[36:39], v44
  v_smfmac_f32_16x16x32_f16 v[68:71], v[40:41], a[96:99], v44
  v_smfmac_f32_16x16x64_f16 v[52:55], v[32:35], a[0:7], v44
  v_smfmac_f32_16x16x64_f16 v[52:55], v[36:39], a[8:15], v44
  v_smfmac_f32_16x16x64_f16 v[64:67], v[32:35], a[60:67], v44
  v_smfmac_f32_16x16x64_f16 v[64:67], v[36:39], a[68:75], v44
  v_smfmac_f32_16x16x32_f16 v[60:63], v[40:41], a[56:59], v44
  v_cvt_pk_f16_f32 v52, v52, v53
  v_cvt_pk_f16_f32 v53, v54, v55
  v_smfmac_f32_16x16x32_f16 v[72:75], v[40:41], a[116:119], v44
  v_smfmac_f32_16x16x32_f16 v[76:79], v[40:41], a[136:139], v44
  v_cvt_pk_f16_f32 v64, v64, v65
  v_cvt_pk_f16_f32 v65, v66, v67
  s_nop 0
  v_smfmac_f32_16x16x64_f16 v[56:59], v[32:35], a[20:27], v44
  v_permlane32_swap_b32 v52, v64
  v_smfmac_f32_16x16x64_f16 v[56:59], v[36:39], a[28:35], v44
  v_permlane32_swap_b32 v53, v65
  v_pk_add_f16 v52, v52, v64
  v_smfmac_f32_16x16x64_f16 v[68:71], v[32:35], a[80:87], v44
  v_pk_add_f16 v53, v53, v65
  v_smfmac_f32_16x16x64_f16 v[68:71], v[36:39], a[88:95], v44
  ds_write_b64 v5, v[52:53] offset:0
  v_smfmac_f32_16x16x32_f16 v[80:83], v[40:41], a[156:159], v44
  v_cvt_pk_f16_f32 v56, v56, v57
  v_cvt_pk_f16_f32 v57, v58, v59
  v_smfmac_f32_16x16x32_f16 v[84:87], v[40:41], a[176:179], v44
  v_cvt_pk_f16_f32 v68, v68, v69
  v_cvt_pk_f16_f32 v69, v70, v71
  s_nop 0
  v_smfmac_f32_16x16x64_f16 v[60:63], v[32:35], a[40:47], v44
  v_permlane32_swap_b32 v56, v68
  v_smfmac_f32_16x16x64_f16 v[60:63], v[36:39], a[48:55], v44
  v_permlane32_swap_b32 v57, v69
  v_pk_add_f16 v56, v56, v68
  v_smfmac_f32_16x16x64_f16 v[72:75], v[32:35], a[100:107], v44
  v_pk_add_f16 v57, v57, v69
  v_smfmac_f32_16x16x64_f16 v[72:75], v[36:39], a[108:115], v44
  ds_write_b64 v5, v[56:57] offset:640
  v_smfmac_f32_16x16x64_f16 v[76:79], v[32:35], a[120:127], v44
  v_cvt_pk_f16_f32 v60, v60, v61
  v_cvt_pk_f16_f32 v61, v62, v63
  v_smfmac_f32_16x16x64_f16 v[76:79], v[36:39], a[128:135], v44
  v_cvt_pk_f16_f32 v72, v72, v73
  v_cvt_pk_f16_f32 v73, v74, v75
  s_nop 0
  v_smfmac_f32_16x16x64_f16 v[80:83], v[32:35], a[140:147], v44
  v_permlane32_swap_b32 v60, v72
  v_smfmac_f32_16x16x64_f16 v[80:83], v[36:39], a[148:155], v44
  v_permlane32_swap_b32 v61, v73
  v_pk_add_f16 v60, v60, v72
  v_smfmac_f32_16x16x64_f16 v[84:87], v[32:35], a[160:167], v44
  v_pk_add_f16 v61, v61, v73
  v_smfmac_f32_16x16x64_f16 v[84:87], v[36:39], a[168:175], v44
  ds_write_b64 v5, v[60:61] offset:1280
  v_cvt_pk_f16_f32 v76, v76, v77
  v_cvt_pk_f16_f32 v77, v78, v79
  v_cvt_pk_f16_f32 v80, v80, v81
  v_cvt_pk_f16_f32 v81, v82, v83
  s_nop 0
  v_permlane32_swap_b32 v76, v80
  v_permlane32_swap_b32 v77, v81
  v_pk_add_f16 v76, v76, v80
  v_pk_add_f16 v77, v77, v81
  ds_write_b64 v5, v[76:77] offset:1920
  v_cvt_pk_f16_f32 v84, v84, v85
  v_cvt_pk_f16_f32 v85, v86, v87
  ds_write_b64 v5, v[84:85] offset:2560
  s_waitcnt lgkmcnt(0) vmcnt(0)
  s_barrier
  ds_read_b64_tr_b16 v[104:105], v45 offset:0
  ds_read_b64_tr_b16 v[106:107], v45 offset:3200
  ds_read_b64_tr_b16 v[108:109], v45 offset:640
  ds_read_b64_tr_b16 v[110:111], v45 offset:3840
  ds_read_b64_tr_b16 v[112:113], v45 offset:1280
  ds_read_b64_tr_b16 v[114:115], v45 offset:4480
  s_waitcnt lgkmcnt(4)
  v_fma_mix_f32 v120, v104, 1.0, v106 op_sel:[0,0,0] op_sel_hi:[1,0,1]
  v_fma_mix_f32 v121, v104, 1.0, v106 op_sel:[1,0,1] op_sel_hi:[1,0,1]
  v_fma_mix_f32 v122, v105, 1.0, v107 op_sel:[0,0,0] op_sel_hi:[1,0,1]
  v_fma_mix_f32 v123, v105, 1.0, v107 op_sel:[1,0,1] op_sel_hi:[1,0,1]
  v_add_f32_dpp v124, v120, v120 row_ror:8 row_mask:0xf bank_mask:0xf
  v_add_f32_dpp v125, v121, v121 row_ror:8 row_mask:0xf bank_mask:0xf
  v_add_f32_dpp v126, v122, v122 row_ror:8 row_mask:0xf bank_mask:0xf
  v_add_f32_dpp v127, v123, v123 row_ror:8 row_mask:0xf bank_mask:0xf
  v_cvt_pk_bf16_f32 v212, v124, v125
  v_cvt_pk_bf16_f32 v213, v126, v127
  s_waitcnt lgkmcnt(2)
  v_fma_mix_f32 v120, v108, 1.0, v110 op_sel:[0,0,0] op_sel_hi:[1,0,1]
  v_fma_mix_f32 v121, v108, 1.0, v110 op_sel:[1,0,1] op_sel_hi:[1,0,1]
  v_fma_mix_f32 v122, v109, 1.0, v111 op_sel:[0,0,0] op_sel_hi:[1,0,1]
  v_fma_mix_f32 v123, v109, 1.0, v111 op_sel:[1,0,1] op_sel_hi:[1,0,1]
  v_add_f32_dpp v124, v120, v120 row_ror:8 row_mask:0xf bank_mask:0xf
  v_add_f32_dpp v125, v121, v121 row_ror:8 row_mask:0xf bank_mask:0xf
  v_add_f32_dpp v126, v122, v122 row_ror:8 row_mask:0xf bank_mask:0xf
  v_add_f32_dpp v127, v123, v123 row_ror:8 row_mask:0xf bank_mask:0xf
  v_cvt_pk_bf16_f32 v214, v124, v125
  v_cvt_pk_bf16_f32 v215, v126, v127
  s_waitcnt lgkmcnt(0)
  v_fma_mix_f32 v120, v112, 1.0, v114 op_sel:[0,0,0] op_sel_hi:[1,0,1]
  v_fma_mix_f32 v121, v112, 1.0, v114 op_sel:[1,0,1] op_sel_hi:[1,0,1]
  v_fma_mix_f32 v122, v113, 1.0, v115 op_sel:[0,0,0] op_sel_hi:[1,0,1]
  v_fma_mix_f32 v123, v113, 1.0, v115 op_sel:[1,0,1] op_sel_hi:[1,0,1]
  v_mfma_f32_16x16x32_bf16 v[96:99], v[168:171], v[212:215], 0
  v_add_f32_dpp v124, v120, v120 row_ror:8 row_mask:0xf bank_mask:0xf
  v_add_f32_dpp v125, v121, v121 row_ror:8 row_mask:0xf bank_mask:0xf
  v_add_f32_dpp v126, v122, v122 row_ror:8 row_mask:0xf bank_mask:0xf
  v_add_f32_dpp v127, v123, v123 row_ror:8 row_mask:0xf bank_mask:0xf
  v_cvt_pk_bf16_f32 v216, v124, v125
  v_cvt_pk_bf16_f32 v217, v126, v127
  s_nop 1
  v_mfma_f32_16x16x32_bf16 v[96:99], v[172:175], v[216:219], v[96:99]
  s_mov_b64 exec, s[74:75]
  s_nop 6
  v_cvt_pk_f16_f32 v100, v96, v97
  v_cvt_pk_f16_f32 v101, v98, v99
  v_and_or_b32 v100, v100, -2, s88
  buffer_store_dwordx2 v[100:101], v7, s[8:11], s81 offen
  s_mov_b64 exec, -1
  s_cmp_eq_u32 s52, 63
  s_cbranch_scc1 last_21
  s_sleep 4
  s_nop 7
  s_mov_b32 s54, 0
  buffer_load_dwordx2 v[248:249], v9, s[8:11], s81 offen sc1
  buffer_load_dwordx4 v[112:115], v8, s[8:11], s81 offen offset:0 sc1
  buffer_load_dwordx4 v[116:119], v8, s[8:11], s81 offen offset:1024 sc1
  s_sleep 2
  buffer_load_dwordx4 v[144:147], v10, s[8:11], s81 offen offset:0 sc1
  buffer_load_dwordx4 v[148:151], v10, s[8:11], s81 offen offset:1024 sc1
  buffer_load_dwordx4 v[152:155], v10, s[8:11], s81 offen offset:2048 sc1
  v_mov_b32 v188, 0
  v_mov_b32 v189, 0
  v_mov_b32 v190, 0
  v_mov_b32 v191, 0
  v_mov_b32 v192, 0
  v_mov_b32 v193, 0
  v_mov_b32 v194, 0
  v_mov_b32 v195, 0
  v_mov_b32 v196, 0
  v_mov_b32 v197, 0
  v_mov_b32 v198, 0
  v_mov_b32 v199, 0
  v_readfirstlane_b32 s21, v94
  s_add_u32 s22, s46, 3
  s_min_u32 s22, s22, 64
  s_sub_u32 s55, s21, s22
  s_sub_u32 s56, s21, s46
  s_cmp_lt_i32 s56, 0
  s_cbranch_scc1 kvw_31
kvok_32:
  s_waitcnt vmcnt(5)
  v_xor_b32 v96, s88, v248
  s_nop 0
  v_permlane16_swap_b32 v248, v249
  v_fma_mix_f32 v250, v248, 1.0, v249 op_sel:[0,0,0] op_sel_hi:[1,0,1]
  v_fma_mix_f32 v251, v248, 1.0, v249 op_sel:[1,0,1] op_sel_hi:[1,0,1]
  v_mov_b32 v248, v250
  v_mov_b32 v249, v251
  s_nop 0
  v_permlane32_swap_b32 v248, v250
  v_permlane32_swap_b32 v249, v251
  v_pk_add_f32 v[124:125], v[248:249], v[250:251]
  v_max_f32 v238, v124, v125
  s_waitcnt vmcnt(3)
  v_pk_add_f16 v100, v112, v116
  v_pk_add_f16 v102, v114, v118
  v_pk_add_f16 v101, v113, v117
  v_pk_add_f16 v103, v115, v119
  v_permlane32_swap_b32 v100, v102
  v_bitop3_b32 v97, v112, v114, s88 bitop3:0x7e
  v_permlane32_swap_b32 v101, v103
  v_bitop3_b32 v98, v116, v118, s88 bitop3:0x7e
  v_fma_mix_f32 v120, v100, 1.0, v102 op_sel:[0,0,0] op_sel_hi:[1,0,1]
  v_or3_b32 v27, v96, v97, v98
  v_fma_mix_f32 v121, v100, 1.0, v102 op_sel:[1,0,1] op_sel_hi:[1,0,1]
  v_and_b32 v27, 1, v27
  v_fma_mix_f32 v122, v101, 1.0, v103 op_sel:[0,0,0] op_sel_hi:[1,0,1]
  v_cmp_ne_u32 vcc, 0, v27
  v_fma_mix_f32 v123, v101, 1.0, v103 op_sel:[1,0,1] op_sel_hi:[1,0,1]
  v_max3_f32 v236, v120, v121, v238
  s_cbranch_vccnz psr_28
psj_29:
  v_max3_f32 v236, v236, v122, v123
  s_nop 1
  v_max_f32_dpp v236, v236, v236 row_ror:8 row_mask:0xf bank_mask:0xf
  v_mov_b32 v237, v236
  s_waitcnt vmcnt(0)
  v_max3_u32 v27, v144, v146, v148
  v_permlane32_swap_b32 v236, v237
  v_max_f32 v236, v236, v237
  v_mov_b32 v237, v236
  v_max3_u32 v27, v27, v150, v152
  v_max_u32 v27, v27, v154
  v_permlane16_swap_b32 v236, v237
  v_cmp_eq_u32 vcc, -1, v27
  v_max_f32 v236, v236, v237
  v_mul_f32 v236, s86, v236
  s_cbranch_vccnz pv_27
pvj_30:
  v_smfmac_f32_16x16x64_bf16 v[188:191], v[144:147], a[180:187], v44
  v_fma_f32 v120, v120, s86, -v236
  v_smfmac_f32_16x16x64_bf16 v[188:191], v[148:151], a[188:195], v44
  v_fma_f32 v121, v121, s86, -v236
  v_smfmac_f32_16x16x64_bf16 v[188:191], v[152:155], a[196:203], v44
  buffer_load_dwordx4 v[160:163], v17, s[28:31], s64 offen offset:0 sc1
  v_fma_f32 v122, v122, s86, -v236
  v_smfmac_f32_16x16x64_bf16 v[192:195], v[144:147], a[204:211], v44
  v_fma_f32 v123, v123, s86, -v236
  v_smfmac_f32_16x16x64_bf16 v[192:195], v[148:151], a[212:219], v44
  buffer_load_dwordx4 v[164:167], v16, s[28:31], s64 offen offset:1024 sc1
  v_fma_f32 v124, v124, s86, -v236
  v_smfmac_f32_16x16x64_bf16 v[192:195], v[152:155], a[220:227], v44
  v_fma_f32 v125, v125, s86, -v236
  v_smfmac_f32_16x16x64_bf16 v[196:199], v[144:147], a[228:235], v44
  buffer_load_dwordx4 v[48:51], v26, s[28:31], s64 offen offset:2048 sc1
  v_exp_f32 v120, v120
  v_smfmac_f32_16x16x64_bf16 v[196:199], v[148:151], a[236:243], v44
  v_exp_f32 v121, v121
  v_smfmac_f32_16x16x64_bf16 v[196:199], v[152:155], a[244:251], v44
  buffer_load_dwordx4 v[168:171], v18, s[16:19], s80 offen sc1
  v_exp_f32 v122, v122
  buffer_load_dwordx2 v[172:173], v20, s[16:19], s80 offen sc1
  v_exp_f32 v123, v123
  v_exp_f32 v124, v124
  s_cmp_lt_i32 s55, 0
  s_cbranch_scc1 fl_33
fl_34:
  v_exp_f32 v125, v125
  v_cvt_pk_bf16_f32 v220, v120, v121
  v_cvt_pk_bf16_f32 v221, v122, v123
  v_cvt_pk_bf16_f32 v224, v124, v125
  v_mov_b32_dpp v222, v220 row_ror:8 row_mask:0xf bank_mask:0xf
  v_mov_b32_dpp v223, v221 row_ror:8 row_mask:0xf bank_mask:0xf
  v_mov_b32_dpp v225, v224 row_ror:8 row_mask:0xf bank_mask:0xf
  v_cvt_pk_bf16_f32 v228, v188, v189
  v_mfma_f32_16x16x32_bf16 v[200:203], v[176:179], v[220:223], 0
  v_cvt_pk_bf16_f32 v229, v190, v191
  v_cvt_pk_bf16_f32 v230, v192, v193
  v_mfma_f32_16x16x32_bf16 v[204:207], v[180:183], v[220:223], 0
  v_cvt_pk_bf16_f32 v231, v194, v195
  v_cvt_pk_bf16_f32 v232, v196, v197
  v_mfma_f32_16x16x32_bf16 v[208:211], v[184:187], v[220:223], 0
  v_cvt_pk_bf16_f32 v233, v198, v199
  v_add_f32 v126, v120, v121
  v_mfma_f32_16x16x32_bf16 v[200:203], v[228:231], v[224:227], v[200:203]
  v_add_f32 v127, v122, v123
  v_add_f32 v128, v124, v125
  v_mfma_f32_16x16x32_bf16 v[204:207], v[230:233], v[224:227], v[204:207]
  v_add_f32 v236, v126, v127
  v_fmac_f32 v236, v128, v89
  v_mfma_f32_16x16x32_bf16 v[208:211], v[232:235], v[224:227], v[208:211]
  s_nop 0
  v_add_f32_dpp v236, v236, v236 row_ror:8 row_mask:0xf bank_mask:0xf
  v_mov_b32 v237, v236
  ds_write_b128 v11, v[200:203] offset:0
  s_nop 0
  v_permlane32_swap_b32 v236, v237
  v_add_f32 v236, v236, v237
  v_mov_b32 v237, v236
  ds_write_b128 v11, v[204:207] offset:1024
  s_nop 0
  v_permlane16_swap_b32 v236, v237
  v_add_f32 v236, v236, v237
  v_rcp_f32 v236, v236
  ds_write_b128 v11, v[208:211] offset:2048
  s_mov_b64 exec, 0xff
  ds_write_b32 v242, v236
  s_mov_b64 exec, -1
  s_waitcnt lgkmcnt(0)
  s_barrier
  ds_read_b128 v[104:107], v243
  ds_read_b64 v[96:97], v12 offset:0
  ds_read_b64 v[98:99], v12 offset:3072
  ds_read_b64 v[100:101], v12 offset:6144
  ds_read_b64 v[102:103], v12 offset:9216
  s_waitcnt lgkmcnt(2)
  v_pk_mul_f32 v[96:97], v[96:97], v[104:105] op_sel_hi:[1,0]
  v_pk_fma_f32 v[96:97], v[98:99], v[104:105], v[96:97] op_sel:[0,1,0] op_sel_hi:[1,1,1]
  s_waitcnt lgkmcnt(0)
  v_pk_fma_f32 v[96:97], v[100:101], v[106:107], v[96:97] op_sel_hi:[1,0,1]
  v_pk_fma_f32 v[96:97], v[102:103], v[106:107], v[96:97] op_sel:[0,1,0] op_sel_hi:[1,1,1]
  v_cvt_pk_f16_f32 v100, v96, v97
  v_perm_b32 v100, s91, v100, v14
  buffer_atomic_pk_add_f16 v100, v13, s[4:7], s3 offen
  v_mov_b32 v200, v196
  v_mov_b32 v201, v197
  v_mov_b32 v202, v198
  v_mov_b32 v203, v199
  v_permlane32_swap_b32 v188, v192
  v_permlane32_swap_b32 v189, v193
  v_permlane32_swap_b32 v190, v194
  v_permlane32_swap_b32 v191, v195
  v_permlane32_swap_b32 v196, v200
  v_permlane32_swap_b32 v197, v201
  v_permlane32_swap_b32 v198, v202
  v_permlane32_swap_b32 v199, v203
  v_pk_add_f32 v[188:189], v[188:189], v[192:193]
  v_pk_add_f32 v[190:191], v[190:191], v[194:195]
  v_pk_add_f32 v[196:197], v[196:197], v[200:201]
  v_pk_add_f32 v[198:199], v[198:199], v[202:203]
  v_cvt_pk_bf16_f32 v252, v188, v189
  v_cvt_pk_bf16_f32 v254, v196, v197
  v_cvt_pk_bf16_f32 v253, v190, v191
  v_cvt_pk_bf16_f32 v255, v198, v199
  s_nop 0
  v_permlane16_swap_b32 v252, v254
  v_permlane16_swap_b32 v253, v255
  v_min_u32 v252, -2, v252
  s_mov_b64 exec, s[76:77]
  buffer_store_dwordx4 v[252:255], v15, s[24:27], s57 offen sc1
  s_mov_b64 exec, -1
  s_add_u32 s64, s64, 1310720
  s_add_u32 s52, s52, 1
  s_and_b32 s21, s52, 3
  s_mul_i32 s81, s21, 540672
  s_lshl_b32 s84, s21, 15
  s_branch step_20
fl_24:
  buffer_load_dword v94, v95, s[12:15], s79 offen sc1
  s_branch fl_25
pm_22:
  s_cmp_gt_u32 s52, 3
  s_cbranch_scc1 op_35
  v_readfirstlane_b32 s21, v94
  s_cmp_ge_u32 s21, s46
  s_cbranch_scc1 op_35
  buffer_load_dword v94, v95, s[12:15], s79 offen sc1
  s_waitcnt vmcnt(0)
  v_readfirstlane_b32 s21, v94
  s_add_u32 s22, s46, 3
  s_min_u32 s22, s22, 64
  s_sub_u32 s55, s21, s22
  s_sub_u32 s56, s21, s46
  s_cmp_gt_u32 s21, s52
  s_cselect_b32 s21, s87, 0
  s_cmp_eq_u32 s21, 0
  s_cbranch_scc1 op_35
  s_mov_b32 s87, 0
  s_sub_u32 s21, s64, 1310720
  buffer_load_dwordx4 v[176:179], v16, s[28:31], s21 offen offset:0 sc1
  buffer_load_dwordx4 v[180:183], v16, s[28:31], s21 offen offset:1024 sc1
  buffer_load_dwordx4 v[184:187], v16, s[28:31], s21 offen offset:2048 sc1
op_35:
  buffer_load_dwordx4 v[32:35], v4, s[4:7], s84 offen offset:0 sc1
  buffer_load_dwordx4 v[36:39], v4, s[4:7], s84 offen offset:1024 sc1
  buffer_load_dwordx4 v[40:43], v4, s[4:7], s84 offen offset:2048 sc1
  s_add_u32 s54, s54, 1
  s_cmp_gt_u32 s54, 131072
  s_cbranch_scc1 end0
  s_waitcnt vmcnt(0)
  v_bitop3_b32 v27, v35, v39, v43 bitop3:0x80
  v_perm_b32 v35, v39, v35, s89
  v_cmp_gt_u32 vcc, 0x48000000, v27
  v_mov_b32 v39, v42
  s_cbranch_vccnz pm_22
  s_branch A1_15
pv_27:
  buffer_load_dwordx4 v[144:147], v10, s[8:11], s81 offen offset:0 sc1
  buffer_load_dwordx4 v[148:151], v10, s[8:11], s81 offen offset:1024 sc1
  buffer_load_dwordx4 v[152:155], v10, s[8:11], s81 offen offset:2048 sc1
  s_add_u32 s54, s54, 1
  s_cmp_gt_u32 s54, 131072
  s_cbranch_scc1 end0
  s_waitcnt vmcnt(0)
  v_max3_u32 v27, v144, v146, v148
  v_max3_u32 v27, v27, v150, v152
  v_max3_u32 v27, v27, v154, v154
  v_cmp_eq_u32 vcc, -1, v27
  s_nop 1
  s_cbranch_vccnz pv_27
  s_branch pvj_30
psr_28:
  buffer_load_dwordx2 v[248:249], v9, s[8:11], s81 offen sc1
  buffer_load_dwordx4 v[112:115], v8, s[8:11], s81 offen offset:0 sc1
  buffer_load_dwordx4 v[116:119], v8, s[8:11], s81 offen offset:1024 sc1
  s_add_u32 s54, s54, 1
  s_cmp_gt_u32 s54, 131072
  s_cbranch_scc1 end0
  s_waitcnt vmcnt(2)
  v_xor_b32 v96, s88, v248
  s_nop 0
  v_permlane16_swap_b32 v248, v249
  v_fma_mix_f32 v250, v248, 1.0, v249 op_sel:[0,0,0] op_sel_hi:[1,0,1]
  v_fma_mix_f32 v251, v248, 1.0, v249 op_sel:[1,0,1] op_sel_hi:[1,0,1]
  v_mov_b32 v248, v250
  v_mov_b32 v249, v251
  s_nop 0
  v_permlane32_swap_b32 v248, v250
  v_permlane32_swap_b32 v249, v251
  v_pk_add_f32 v[124:125], v[248:249], v[250:251]
  v_max_f32 v238, v124, v125
  s_waitcnt vmcnt(0)
  v_pk_add_f16 v100, v112, v116
  v_pk_add_f16 v102, v114, v118
  v_pk_add_f16 v101, v113, v117
  v_pk_add_f16 v103, v115, v119
  v_permlane32_swap_b32 v100, v102
  v_bitop3_b32 v97, v112, v114, s88 bitop3:0x7e
  v_permlane32_swap_b32 v101, v103
  v_bitop3_b32 v98, v116, v118, s88 bitop3:0x7e
  v_fma_mix_f32 v120, v100, 1.0, v102 op_sel:[0,0,0] op_sel_hi:[1,0,1]
  v_or3_b32 v27, v96, v97, v98
  v_fma_mix_f32 v121, v100, 1.0, v102 op_sel:[1,0,1] op_sel_hi:[1,0,1]
  v_and_b32 v27, 1, v27
  v_fma_mix_f32 v122, v101, 1.0, v103 op_sel:[0,0,0] op_sel_hi:[1,0,1]
  v_cmp_ne_u32 vcc, 0, v27
  v_fma_mix_f32 v123, v101, 1.0, v103 op_sel:[1,0,1] op_sel_hi:[1,0,1]
  v_max3_f32 v236, v120, v121, v238
  s_cbranch_vccnz psr_28
  s_branch psj_29
kvw_31:
  s_mov_b32 s22, s87
  s_cmp_eq_u32 s52, 0
  s_cselect_b32 s23, s87, s46
  s_cselect_b32 s55, 0, s55
  s_cselect_b32 s87, 1, 0
  s_cmp_eq_u32 s23, 0
  s_cbranch_scc1 kvok_32
  v_mov_b32 v236, 0
  s_mov_b32 s101, 0
wf_36:
  buffer_load_dword v237, v236, s[12:15], s79 offen sc1
  s_add_u32 s101, s101, 1
  s_cmp_gt_u32 s101, 131072
  s_cbranch_scc1 end0
  s_waitcnt vmcnt(0)
  v_readfirstlane_b32 s100, v237
  s_cmp_ge_u32 s100, s23
  s_cbranch_scc1 wf_37
  s_sleep 3
  s_branch wf_36
wf_37:
  s_cmp_eq_u32 s22, 0
  s_cbranch_scc1 kvok_32
  s_sub_u32 s21, s64, 1310720
  buffer_load_dwordx4 v[176:179], v16, s[28:31], s21 offen offset:0 sc1
  buffer_load_dwordx4 v[180:183], v16, s[28:31], s21 offen offset:1024 sc1
  buffer_load_dwordx4 v[184:187], v16, s[28:31], s21 offen offset:2048 sc1
  s_waitcnt vmcnt(0)
  s_branch kvok_32
fl_33:
  buffer_load_dword v94, v95, s[12:15], s79 offen sc1
  s_branch fl_34
last_21:
  v_mov_b32 v188, 0
  v_mov_b32 v189, 0
  v_mov_b32 v190, 0
  v_mov_b32 v191, 0
  v_mov_b32 v192, 0
  v_mov_b32 v193, 0
  v_mov_b32 v194, 0
  v_mov_b32 v195, 0
  v_mov_b32 v196, 0
  v_mov_b32 v197, 0
  v_mov_b32 v198, 0
  v_mov_b32 v199, 0
  s_sleep 4
  s_mov_b32 s54, 0
lv_38:
  buffer_load_dwordx4 v[144:147], v10, s[8:11], s81 offen offset:0 sc1
  buffer_load_dwordx4 v[148:151], v10, s[8:11], s81 offen offset:1024 sc1
  buffer_load_dwordx4 v[152:155], v10, s[8:11], s81 offen offset:2048 sc1
  s_add_u32 s54, s54, 1
  s_cmp_gt_u32 s54, 131072
  s_cbranch_scc1 end0
  s_waitcnt vmcnt(0)
  v_max3_u32 v27, v144, v146, v148
  v_max3_u32 v27, v27, v150, v152
  v_max3_u32 v27, v27, v154, v154
  v_cmp_eq_u32 vcc, -1, v27
  s_nop 1
  s_cbranch_vccnz lv_38
  v_smfmac_f32_16x16x64_bf16 v[188:191], v[144:147], a[180:187], v44
  v_smfmac_f32_16x16x64_bf16 v[192:195], v[144:147], a[204:211], v44
  v_smfmac_f32_16x16x64_bf16 v[196:199], v[144:147], a[228:235], v44
  v_smfmac_f32_16x16x64_bf16 v[188:191], v[148:151], a[188:195], v44
  v_smfmac_f32_16x16x64_bf16 v[192:195], v[148:151], a[212:219], v44
  v_smfmac_f32_16x16x64_bf16 v[196:199], v[148:151], a[236:243], v44
  v_smfmac_f32_16x16x64_bf16 v[188:191], v[152:155], a[196:203], v44
  v_smfmac_f32_16x16x64_bf16 v[192:195], v[152:155], a[220:227], v44
  v_smfmac_f32_16x16x64_bf16 v[196:199], v[152:155], a[244:251], v44
  s_nop 7
  v_mov_b32 v200, v196
  v_mov_b32 v201, v197
  v_mov_b32 v202, v198
  v_mov_b32 v203, v199
  v_permlane32_swap_b32 v188, v192
  v_permlane32_swap_b32 v189, v193
  v_permlane32_swap_b32 v190, v194
  v_permlane32_swap_b32 v191, v195
  v_permlane32_swap_b32 v196, v200
  v_permlane32_swap_b32 v197, v201
  v_permlane32_swap_b32 v198, v202
  v_permlane32_swap_b32 v199, v203
  v_pk_add_f32 v[188:189], v[188:189], v[192:193]
  v_pk_add_f32 v[190:191], v[190:191], v[194:195]
  v_pk_add_f32 v[196:197], v[196:197], v[200:201]
  v_pk_add_f32 v[198:199], v[198:199], v[202:203]
  v_cvt_pk_bf16_f32 v252, v188, v189
  v_cvt_pk_bf16_f32 v254, v196, v197
  v_cvt_pk_bf16_f32 v253, v190, v191
  v_cvt_pk_bf16_f32 v255, v198, v199
  s_nop 0
  v_permlane16_swap_b32 v252, v254
  v_permlane16_swap_b32 v253, v255
  v_min_u32 v252, -2, v252
  s_mov_b64 exec, s[76:77]
  buffer_store_dwordx4 v[252:255], v15, s[24:27], s57 offen sc1
  s_mov_b64 exec, -1
  v_mov_b32 v246, 80
  v_mov_b32 v247, 1
  s_mov_b64 exec, 1
  buffer_atomic_add v247, v246, s[32:35], 0 offen sc0 sc1
  s_mov_b64 exec, -1
clm_39:
  s_branch chain_done
step_40:
  s_add_u32 s21, s52, 2
  s_and_b32 s21, s21, 3
  s_mul_i32 s82, s21, 540672
  s_add_u32 s21, s52, 3
  s_and_b32 s21, s21, 3
  s_lshl_b32 s83, s21, 15
  s_add_u32 s21, s52, 1
  s_and_b32 s22, s21, 3
  s_lshl_b32 s3, s22, 15
  s_mul_i32 s80, s21, 393216
  s_add_u32 s46, s21, 1
  s_min_u32 s46, s46, 64
  s_mul_i32 s85, s52, 98304
  s_mul_i32 s57, s52, 327680
  s_add_u32 s57, s57, 42991616

  s_bfe_u32 s88, s52, 0x10002
  s_add_u32 s78, s81, 278528
  s_max_u32 s21, s52, 1
  s_sub_u32 s21, s21, 1
  s_cmp_lt_u32 s52, 98
  s_cselect_b32 s66, s65, 0x80000000
  s_cselect_b32 s68, 15, 1
  s_cmp_ge_u32 s52, 99
  s_cselect_b32 s66, s90, s66
  s_cselect_b32 s67, s52, s21
  v_mov_b32 v52, 0
  v_mov_b32 v53, 0
  v_mov_b32 v54, 0
  v_mov_b32 v55, 0
  v_mov_b32 v56, 0
  v_mov_b32 v57, 0
  v_mov_b32 v58, 0
  v_mov_b32 v59, 0
  v_mov_b32 v60, 0
  v_mov_b32 v61, 0
  v_mov_b32 v62, 0
  v_mov_b32 v63, 0
  v_mov_b32 v64, 0
  v_mov_b32 v65, 0
  v_mov_b32 v66, 0
  v_mov_b32 v67, 0
  v_mov_b32 v68, 0
  v_mov_b32 v69, 0
  v_mov_b32 v70, 0
  v_mov_b32 v71, 0
  v_mov_b32 v72, 0
  v_mov_b32 v73, 0
  v_mov_b32 v74, 0
  v_mov_b32 v75, 0
  v_mov_b32 v76, 0
  v_mov_b32 v77, 0
  v_mov_b32 v78, 0
  v_mov_b32 v79, 0
  v_mov_b32 v80, 0
  v_mov_b32 v81, 0
  v_mov_b32 v82, 0
  v_mov_b32 v83, 0
  v_mov_b32 v84, 0
  v_mov_b32 v85, 0
  v_mov_b32 v86, 0
  v_mov_b32 v87, 0
  s_sleep 4
  v_readfirstlane_b32 s21, v94
  s_cmp_lt_u32 s21, s46
  s_cselect_b32 s55, s55, 0
  s_cmp_lt_i32 s55, 0
  s_cbranch_scc1 fl_44
fl_45:
  s_mov_b32 s54, 0
  buffer_load_dwordx4 v[32:35], v4, s[4:7], s84 offen offset:0 sc1
  buffer_load_dwordx4 v[36:39], v4, s[4:7], s84 offen offset:1024 sc1
  buffer_load_dwordx4 v[40:43], v4, s[4:7], s84 offen offset:2048 sc1
  s_waitcnt vmcnt(3)
  v_mov_b32 v176, v160
  v_mov_b32 v177, v161
  v_mov_b32 v178, v162
  v_mov_b32 v179, v163
  v_mov_b32 v180, v164
  v_mov_b32 v181, v165
  v_mov_b32 v182, v166
  v_mov_b32 v183, v167
  v_mov_b32 v184, v48
  v_mov_b32 v185, v49
  v_mov_b32 v186, v50
  v_mov_b32 v187, v51
  s_waitcnt vmcnt(0)
  v_bitop3_b32 v27, v35, v39, v43 bitop3:0x80
  v_perm_b32 v35, v39, v35, s89
  v_cmp_gt_u32 vcc, 0x48000000, v27
  v_mov_b32 v39, v42
  s_cbranch_vccnz pm_42
A1_16:
  v_smfmac_f32_16x16x32_f16 v[52:55], v[40:41], a[16:19], v44
  v_smfmac_f32_16x16x32_f16 v[64:67], v[40:41], a[76:79], v44
  v_smfmac_f32_16x16x32_f16 v[56:59], v[40:41], a[36:39], v44
  v_smfmac_f32_16x16x32_f16 v[68:71], v[40:41], a[96:99], v44
  v_smfmac_f32_16x16x64_f16 v[52:55], v[32:35], a[0:7], v44
  v_smfmac_f32_16x16x64_f16 v[52:55], v[36:39], a[8:15], v44
  v_smfmac_f32_16x16x64_f16 v[64:67], v[32:35], a[60:67], v44
  v_smfmac_f32_16x16x64_f16 v[64:67], v[36:39], a[68:75], v44
  v_smfmac_f32_16x16x32_f16 v[60:63], v[40:41], a[56:59], v44
  v_cvt_pk_f16_f32 v52, v52, v53
  v_cvt_pk_f16_f32 v53, v54, v55
  v_smfmac_f32_16x16x32_f16 v[72:75], v[40:41], a[116:119], v44
  v_smfmac_f32_16x16x32_f16 v[76:79], v[40:41], a[136:139], v44
  v_cvt_pk_f16_f32 v64, v64, v65
  v_cvt_pk_f16_f32 v65, v66, v67
  s_nop 0
  v_smfmac_f32_16x16x64_f16 v[56:59], v[32:35], a[20:27], v44
  v_permlane32_swap_b32 v52, v64
  v_smfmac_f32_16x16x64_f16 v[56:59], v[36:39], a[28:35], v44
  v_permlane32_swap_b32 v53, v65
  v_pk_add_f16 v52, v52, v64
  v_smfmac_f32_16x16x64_f16 v[68:71], v[32:35], a[80:87], v44
  v_pk_add_f16 v53, v53, v65
  v_smfmac_f32_16x16x64_f16 v[68:71], v[36:39], a[88:95], v44
  ds_write_b64 v5, v[52:53] offset:0
  v_smfmac_f32_16x16x32_f16 v[80:83], v[40:41], a[156:159], v44
  v_cvt_pk_f16_f32 v56, v56, v57
  v_cvt_pk_f16_f32 v57, v58, v59
  v_smfmac_f32_16x16x32_f16 v[84:87], v[40:41], a[176:179], v44
  v_cvt_pk_f16_f32 v68, v68, v69
  v_cvt_pk_f16_f32 v69, v70, v71
  s_nop 0
  v_smfmac_f32_16x16x64_f16 v[60:63], v[32:35], a[40:47], v44
  v_permlane32_swap_b32 v56, v68
  v_smfmac_f32_16x16x64_f16 v[60:63], v[36:39], a[48:55], v44
  v_permlane32_swap_b32 v57, v69
  v_pk_add_f16 v56, v56, v68
  v_smfmac_f32_16x16x64_f16 v[72:75], v[32:35], a[100:107], v44
  v_pk_add_f16 v57, v57, v69
  v_smfmac_f32_16x16x64_f16 v[72:75], v[36:39], a[108:115], v44
  ds_write_b64 v5, v[56:57] offset:640
  v_smfmac_f32_16x16x64_f16 v[76:79], v[32:35], a[120:127], v44
  v_cvt_pk_f16_f32 v60, v60, v61
  v_cvt_pk_f16_f32 v61, v62, v63
  v_smfmac_f32_16x16x64_f16 v[76:79], v[36:39], a[128:135], v44
  v_cvt_pk_f16_f32 v72, v72, v73
  v_cvt_pk_f16_f32 v73, v74, v75
  s_nop 0
  v_smfmac_f32_16x16x64_f16 v[80:83], v[32:35], a[140:147], v44
  v_permlane32_swap_b32 v60, v72
  v_smfmac_f32_16x16x64_f16 v[80:83], v[36:39], a[148:155], v44
  v_permlane32_swap_b32 v61, v73
  v_pk_add_f16 v60, v60, v72
  v_smfmac_f32_16x16x64_f16 v[84:87], v[32:35], a[160:167], v44
  v_pk_add_f16 v61, v61, v73
  v_smfmac_f32_16x16x64_f16 v[84:87], v[36:39], a[168:175], v44
  ds_write_b64 v5, v[60:61] offset:1280
  v_cvt_pk_f16_f32 v76, v76, v77
  v_cvt_pk_f16_f32 v77, v78, v79
  v_cvt_pk_f16_f32 v80, v80, v81
  v_cvt_pk_f16_f32 v81, v82, v83
  s_nop 0
  v_permlane32_swap_b32 v76, v80
  v_permlane32_swap_b32 v77, v81
  v_pk_add_f16 v76, v76, v80
  v_pk_add_f16 v77, v77, v81
  ds_write_b64 v5, v[76:77] offset:1920
  v_cvt_pk_f16_f32 v84, v84, v85
  v_cvt_pk_f16_f32 v85, v86, v87
  ds_write_b64 v5, v[84:85] offset:2560
  s_waitcnt lgkmcnt(0) vmcnt(0)
  s_barrier
  ds_read_b64_tr_b16 v[104:105], v45 offset:0
  ds_read_b64_tr_b16 v[106:107], v45 offset:3200
  ds_read_b64_tr_b16 v[108:109], v45 offset:640
  ds_read_b64_tr_b16 v[110:111], v45 offset:3840
  ds_read_b64_tr_b16 v[112:113], v45 offset:1280
  ds_read_b64_tr_b16 v[114:115], v45 offset:4480
  s_waitcnt lgkmcnt(4)
  v_fma_mix_f32 v120, v104, 1.0, v106 op_sel:[0,0,0] op_sel_hi:[1,0,1]
  v_fma_mix_f32 v121, v104, 1.0, v106 op_sel:[1,0,1] op_sel_hi:[1,0,1]
  v_fma_mix_f32 v122, v105, 1.0, v107 op_sel:[0,0,0] op_sel_hi:[1,0,1]
  v_fma_mix_f32 v123, v105, 1.0, v107 op_sel:[1,0,1] op_sel_hi:[1,0,1]
  v_add_f32_dpp v124, v120, v120 row_ror:8 row_mask:0xf bank_mask:0xf
  v_add_f32_dpp v125, v121, v121 row_ror:8 row_mask:0xf bank_mask:0xf
  v_add_f32_dpp v126, v122, v122 row_ror:8 row_mask:0xf bank_mask:0xf
  v_add_f32_dpp v127, v123, v123 row_ror:8 row_mask:0xf bank_mask:0xf
  v_cvt_pk_bf16_f32 v212, v124, v125
  v_cvt_pk_bf16_f32 v213, v126, v127
  s_waitcnt lgkmcnt(2)
  v_fma_mix_f32 v120, v108, 1.0, v110 op_sel:[0,0,0] op_sel_hi:[1,0,1]
  v_fma_mix_f32 v121, v108, 1.0, v110 op_sel:[1,0,1] op_sel_hi:[1,0,1]
  v_fma_mix_f32 v122, v109, 1.0, v111 op_sel:[0,0,0] op_sel_hi:[1,0,1]
  v_fma_mix_f32 v123, v109, 1.0, v111 op_sel:[1,0,1] op_sel_hi:[1,0,1]
  v_add_f32_dpp v124, v120, v120 row_ror:8 row_mask:0xf bank_mask:0xf
  v_add_f32_dpp v125, v121, v121 row_ror:8 row_mask:0xf bank_mask:0xf
  v_add_f32_dpp v126, v122, v122 row_ror:8 row_mask:0xf bank_mask:0xf
  v_add_f32_dpp v127, v123, v123 row_ror:8 row_mask:0xf bank_mask:0xf
  v_cvt_pk_bf16_f32 v214, v124, v125
  v_cvt_pk_bf16_f32 v215, v126, v127
  s_waitcnt lgkmcnt(0)
  v_fma_mix_f32 v120, v112, 1.0, v114 op_sel:[0,0,0] op_sel_hi:[1,0,1]
  v_fma_mix_f32 v121, v112, 1.0, v114 op_sel:[1,0,1] op_sel_hi:[1,0,1]
  v_fma_mix_f32 v122, v113, 1.0, v115 op_sel:[0,0,0] op_sel_hi:[1,0,1]
  v_fma_mix_f32 v123, v113, 1.0, v115 op_sel:[1,0,1] op_sel_hi:[1,0,1]
  v_mfma_f32_16x16x32_bf16 v[96:99], v[168:171], v[212:215], 0
  v_add_f32_dpp v124, v120, v120 row_ror:8 row_mask:0xf bank_mask:0xf
  v_add_f32_dpp v125, v121, v121 row_ror:8 row_mask:0xf bank_mask:0xf
  v_add_f32_dpp v126, v122, v122 row_ror:8 row_mask:0xf bank_mask:0xf
  v_add_f32_dpp v127, v123, v123 row_ror:8 row_mask:0xf bank_mask:0xf
  v_cvt_pk_bf16_f32 v216, v124, v125
  v_cvt_pk_bf16_f32 v217, v126, v127
  s_nop 1
  v_mfma_f32_16x16x32_bf16 v[96:99], v[172:175], v[216:219], v[96:99]
  s_mov_b64 exec, s[74:75]
  s_nop 6
  v_cvt_pk_f16_f32 v100, v96, v97
  v_cvt_pk_f16_f32 v101, v98, v99
  v_and_or_b32 v100, v100, -2, s88
  buffer_store_dwordx2 v[100:101], v7, s[8:11], s81 offen
  s_mov_b64 exec, -1
  s_cmp_eq_u32 s52, 63
  s_cbranch_scc1 last_41
  s_sleep 4
  s_nop 7
  s_mov_b32 s54, 0
  buffer_load_dwordx2 v[248:249], v9, s[8:11], s81 offen sc1
  buffer_load_dwordx4 v[112:115], v8, s[8:11], s81 offen offset:0 sc1
  buffer_load_dwordx4 v[116:119], v8, s[8:11], s81 offen offset:1024 sc1
  s_sleep 2
  buffer_load_dwordx4 v[144:147], v10, s[8:11], s81 offen offset:0 sc1
  buffer_load_dwordx4 v[148:151], v10, s[8:11], s81 offen offset:1024 sc1
  buffer_load_dwordx4 v[152:155], v10, s[8:11], s81 offen offset:2048 sc1
  v_mov_b32 v188, 0
  v_mov_b32 v189, 0
  v_mov_b32 v190, 0
  v_mov_b32 v191, 0
  v_mov_b32 v192, 0
  v_mov_b32 v193, 0
  v_mov_b32 v194, 0
  v_mov_b32 v195, 0
  v_mov_b32 v196, 0
  v_mov_b32 v197, 0
  v_mov_b32 v198, 0
  v_mov_b32 v199, 0
  v_readfirstlane_b32 s21, v94
  s_add_u32 s22, s46, 3
  s_min_u32 s22, s22, 64
  s_sub_u32 s55, s21, s22
  s_sub_u32 s56, s21, s46
  s_cmp_lt_i32 s56, 0
  s_cbranch_scc1 kvw_51
kvok_52:
  s_waitcnt vmcnt(5)
  v_xor_b32 v96, s88, v248
  s_nop 0
  v_permlane16_swap_b32 v248, v249
  v_fma_mix_f32 v250, v248, 1.0, v249 op_sel:[0,0,0] op_sel_hi:[1,0,1]
  v_fma_mix_f32 v251, v248, 1.0, v249 op_sel:[1,0,1] op_sel_hi:[1,0,1]
  v_mov_b32 v248, v250
  v_mov_b32 v249, v251
  s_nop 0
  v_permlane32_swap_b32 v248, v250
  v_permlane32_swap_b32 v249, v251
  v_pk_add_f32 v[124:125], v[248:249], v[250:251]
  v_max_f32 v238, v124, v125
  s_waitcnt vmcnt(3)
  v_pk_add_f16 v100, v112, v116
  v_pk_add_f16 v102, v114, v118
  v_pk_add_f16 v101, v113, v117
  v_pk_add_f16 v103, v115, v119
  v_permlane32_swap_b32 v100, v102
  v_bitop3_b32 v97, v112, v114, s88 bitop3:0x7e
  v_permlane32_swap_b32 v101, v103
  v_bitop3_b32 v98, v116, v118, s88 bitop3:0x7e
  v_fma_mix_f32 v120, v100, 1.0, v102 op_sel:[0,0,0] op_sel_hi:[1,0,1]
  v_or3_b32 v27, v96, v97, v98
  v_fma_mix_f32 v121, v100, 1.0, v102 op_sel:[1,0,1] op_sel_hi:[1,0,1]
  v_and_b32 v27, 1, v27
  v_fma_mix_f32 v122, v101, 1.0, v103 op_sel:[0,0,0] op_sel_hi:[1,0,1]
  v_cmp_ne_u32 vcc, 0, v27
  v_fma_mix_f32 v123, v101, 1.0, v103 op_sel:[1,0,1] op_sel_hi:[1,0,1]
  v_max3_f32 v236, v120, v121, v238
  s_cbranch_vccnz psr_48
psj_49:
  v_max3_f32 v236, v236, v122, v123
  s_nop 1
  v_max_f32_dpp v236, v236, v236 row_ror:8 row_mask:0xf bank_mask:0xf
  v_mov_b32 v237, v236
  s_waitcnt vmcnt(0)
  v_max3_u32 v27, v144, v146, v148
  v_permlane32_swap_b32 v236, v237
  v_max_f32 v236, v236, v237
  v_mov_b32 v237, v236
  v_max3_u32 v27, v27, v150, v152
  v_max_u32 v27, v27, v154
  v_permlane16_swap_b32 v236, v237
  v_cmp_eq_u32 vcc, -1, v27
  v_max_f32 v236, v236, v237
  v_mul_f32 v236, s86, v236
  s_cbranch_vccnz pv_47
pvj_50:
  v_smfmac_f32_16x16x64_bf16 v[188:191], v[144:147], a[180:187], v44
  v_fma_f32 v120, v120, s86, -v236
  v_smfmac_f32_16x16x64_bf16 v[188:191], v[148:151], a[188:195], v44
  v_fma_f32 v121, v121, s86, -v236
  v_smfmac_f32_16x16x64_bf16 v[188:191], v[152:155], a[196:203], v44
  buffer_load_dwordx4 v[160:163], v17, s[28:31], s64 offen offset:0 sc1
  v_fma_f32 v122, v122, s86, -v236
  v_smfmac_f32_16x16x64_bf16 v[192:195], v[144:147], a[204:211], v44
  v_fma_f32 v123, v123, s86, -v236
  v_smfmac_f32_16x16x64_bf16 v[192:195], v[148:151], a[212:219], v44
  buffer_load_dwordx4 v[164:167], v16, s[28:31], s64 offen offset:1024 sc1
  v_fma_f32 v124, v124, s86, -v236
  v_smfmac_f32_16x16x64_bf16 v[192:195], v[152:155], a[220:227], v44
  v_fma_f32 v125, v125, s86, -v236
  v_smfmac_f32_16x16x64_bf16 v[196:199], v[144:147], a[228:235], v44
  buffer_load_dwordx4 v[48:51], v26, s[28:31], s64 offen offset:2048 sc1
  v_exp_f32 v120, v120
  v_smfmac_f32_16x16x64_bf16 v[196:199], v[148:151], a[236:243], v44
  v_exp_f32 v121, v121
  v_smfmac_f32_16x16x64_bf16 v[196:199], v[152:155], a[244:251], v44
  buffer_load_dwordx4 v[168:171], v18, s[16:19], s80 offen sc1
  v_exp_f32 v122, v122
  buffer_load_dwordx2 v[172:173], v20, s[16:19], s80 offen sc1
  v_exp_f32 v123, v123
  v_exp_f32 v124, v124
  s_cmp_lt_i32 s55, 0
  s_cbranch_scc1 fl_53
fl_54:
  v_exp_f32 v125, v125
  v_cvt_pk_bf16_f32 v220, v120, v121
  v_cvt_pk_bf16_f32 v221, v122, v123
  v_cvt_pk_bf16_f32 v224, v124, v125
  v_mov_b32_dpp v222, v220 row_ror:8 row_mask:0xf bank_mask:0xf
  v_mov_b32_dpp v223, v221 row_ror:8 row_mask:0xf bank_mask:0xf
  v_mov_b32_dpp v225, v224 row_ror:8 row_mask:0xf bank_mask:0xf
  v_cvt_pk_bf16_f32 v228, v188, v189
  v_mfma_f32_16x16x32_bf16 v[200:203], v[176:179], v[220:223], 0
  v_cvt_pk_bf16_f32 v229, v190, v191
  v_cvt_pk_bf16_f32 v230, v192, v193
  v_mfma_f32_16x16x32_bf16 v[204:207], v[180:183], v[220:223], 0
  v_cvt_pk_bf16_f32 v231, v194, v195
  v_cvt_pk_bf16_f32 v232, v196, v197
  v_mfma_f32_16x16x32_bf16 v[208:211], v[184:187], v[220:223], 0
  v_cvt_pk_bf16_f32 v233, v198, v199
  v_add_f32 v126, v120, v121
  v_mfma_f32_16x16x32_bf16 v[200:203], v[228:231], v[224:227], v[200:203]
  v_add_f32 v127, v122, v123
  v_add_f32 v128, v124, v125
  v_mfma_f32_16x16x32_bf16 v[204:207], v[230:233], v[224:227], v[204:207]
  v_add_f32 v236, v126, v127
  v_fmac_f32 v236, v128, v89
  v_mfma_f32_16x16x32_bf16 v[208:211], v[232:235], v[224:227], v[208:211]
  s_nop 0
  v_add_f32_dpp v236, v236, v236 row_ror:8 row_mask:0xf bank_mask:0xf
  v_mov_b32 v237, v236
  ds_write_b128 v11, v[200:203] offset:0
  s_nop 0
  v_permlane32_swap_b32 v236, v237
  v_add_f32 v236, v236, v237
  v_mov_b32 v237, v236
  ds_write_b128 v11, v[204:207] offset:1024
  s_nop 0
  v_permlane16_swap_b32 v236, v237
  v_add_f32 v236, v236, v237
  v_rcp_f32 v236, v236
  ds_write_b128 v11, v[208:211] offset:2048
  s_mov_b64 exec, 0xff
  ds_write_b32 v242, v236
  s_mov_b64 exec, -1
  s_waitcnt lgkmcnt(0)
  s_barrier
  ds_read_b128 v[104:107], v243
  ds_read_b64 v[96:97], v12 offset:0
  ds_read_b64 v[98:99], v12 offset:3072
  ds_read_b64 v[100:101], v12 offset:6144
  ds_read_b64 v[102:103], v12 offset:9216
  s_waitcnt lgkmcnt(2)
  v_pk_mul_f32 v[96:97], v[96:97], v[104:105] op_sel_hi:[1,0]
  v_pk_fma_f32 v[96:97], v[98:99], v[104:105], v[96:97] op_sel:[0,1,0] op_sel_hi:[1,1,1]
  s_waitcnt lgkmcnt(0)
  v_pk_fma_f32 v[96:97], v[100:101], v[106:107], v[96:97] op_sel_hi:[1,0,1]
  v_pk_fma_f32 v[96:97], v[102:103], v[106:107], v[96:97] op_sel:[0,1,0] op_sel_hi:[1,1,1]
  v_cvt_pk_f16_f32 v100, v96, v97
  v_perm_b32 v100, s91, v100, v14
  buffer_atomic_pk_add_f16 v100, v13, s[4:7], s3 offen
  v_mov_b32 v200, v196
  v_mov_b32 v201, v197
  v_mov_b32 v202, v198
  v_mov_b32 v203, v199
  v_permlane32_swap_b32 v188, v192
  v_permlane32_swap_b32 v189, v193
  v_permlane32_swap_b32 v190, v194
  v_permlane32_swap_b32 v191, v195
  v_permlane32_swap_b32 v196, v200
  v_permlane32_swap_b32 v197, v201
  v_permlane32_swap_b32 v198, v202
  v_permlane32_swap_b32 v199, v203
  v_pk_add_f32 v[188:189], v[188:189], v[192:193]
  v_pk_add_f32 v[190:191], v[190:191], v[194:195]
  v_pk_add_f32 v[196:197], v[196:197], v[200:201]
  v_pk_add_f32 v[198:199], v[198:199], v[202:203]
  v_cvt_pk_bf16_f32 v252, v188, v189
  v_cvt_pk_bf16_f32 v254, v196, v197
  v_cvt_pk_bf16_f32 v253, v190, v191
  v_cvt_pk_bf16_f32 v255, v198, v199
  s_nop 0
  v_permlane16_swap_b32 v252, v254
  v_permlane16_swap_b32 v253, v255
  v_min_u32 v252, -2, v252
  s_mov_b64 exec, s[76:77]
  buffer_store_dwordx4 v[252:255], v15, s[24:27], s57 offen sc1
  s_mov_b64 exec, -1
  s_add_u32 s64, s64, 1310720
  s_add_u32 s52, s52, 1
  s_and_b32 s21, s52, 3
  s_mul_i32 s81, s21, 540672
  s_lshl_b32 s84, s21, 15
  s_branch step_40
fl_44:
  buffer_load_dword v94, v95, s[12:15], s79 offen sc1
  s_branch fl_45
pm_42:
  s_cmp_gt_u32 s52, 3
  s_cbranch_scc1 op_55
  v_readfirstlane_b32 s21, v94
  s_cmp_ge_u32 s21, s46
  s_cbranch_scc1 op_55
  buffer_load_dword v94, v95, s[12:15], s79 offen sc1
  s_waitcnt vmcnt(0)
  v_readfirstlane_b32 s21, v94
  s_add_u32 s22, s46, 3
  s_min_u32 s22, s22, 64
  s_sub_u32 s55, s21, s22
  s_sub_u32 s56, s21, s46
  s_cmp_gt_u32 s21, s52
  s_cselect_b32 s21, s87, 0
  s_cmp_eq_u32 s21, 0
  s_cbranch_scc1 op_55
  s_mov_b32 s87, 0
  s_sub_u32 s21, s64, 1310720
  buffer_load_dwordx4 v[176:179], v16, s[28:31], s21 offen offset:0 sc1
  buffer_load_dwordx4 v[180:183], v16, s[28:31], s21 offen offset:1024 sc1
  buffer_load_dwordx4 v[184:187], v16, s[28:31], s21 offen offset:2048 sc1
op_55:
  buffer_load_dwordx4 v[32:35], v4, s[4:7], s84 offen offset:0 sc1
  buffer_load_dwordx4 v[36:39], v4, s[4:7], s84 offen offset:1024 sc1
  buffer_load_dwordx4 v[40:43], v4, s[4:7], s84 offen offset:2048 sc1
  s_add_u32 s54, s54, 1
  s_cmp_gt_u32 s54, 131072
  s_cbranch_scc1 end0
  s_waitcnt vmcnt(0)
  v_bitop3_b32 v27, v35, v39, v43 bitop3:0x80
  v_perm_b32 v35, v39, v35, s89
  v_cmp_gt_u32 vcc, 0x48000000, v27
  v_mov_b32 v39, v42
  s_cbranch_vccnz pm_42
  s_branch A1_16
pv_47:
  buffer_load_dwordx4 v[144:147], v10, s[8:11], s81 offen offset:0 sc1
  buffer_load_dwordx4 v[148:151], v10, s[8:11], s81 offen offset:1024 sc1
  buffer_load_dwordx4 v[152:155], v10, s[8:11], s81 offen offset:2048 sc1
  s_add_u32 s54, s54, 1
  s_cmp_gt_u32 s54, 131072
  s_cbranch_scc1 end0
  s_waitcnt vmcnt(0)
  v_max3_u32 v27, v144, v146, v148
  v_max3_u32 v27, v27, v150, v152
  v_max3_u32 v27, v27, v154, v154
  v_cmp_eq_u32 vcc, -1, v27
  s_nop 1
  s_cbranch_vccnz pv_47
  s_branch pvj_50
psr_48:
  buffer_load_dwordx2 v[248:249], v9, s[8:11], s81 offen sc1
  buffer_load_dwordx4 v[112:115], v8, s[8:11], s81 offen offset:0 sc1
  buffer_load_dwordx4 v[116:119], v8, s[8:11], s81 offen offset:1024 sc1
  s_add_u32 s54, s54, 1
  s_cmp_gt_u32 s54, 131072
  s_cbranch_scc1 end0
  s_waitcnt vmcnt(2)
  v_xor_b32 v96, s88, v248
  s_nop 0
  v_permlane16_swap_b32 v248, v249
  v_fma_mix_f32 v250, v248, 1.0, v249 op_sel:[0,0,0] op_sel_hi:[1,0,1]
  v_fma_mix_f32 v251, v248, 1.0, v249 op_sel:[1,0,1] op_sel_hi:[1,0,1]
  v_mov_b32 v248, v250
  v_mov_b32 v249, v251
  s_nop 0
  v_permlane32_swap_b32 v248, v250
  v_permlane32_swap_b32 v249, v251
  v_pk_add_f32 v[124:125], v[248:249], v[250:251]
  v_max_f32 v238, v124, v125
  s_waitcnt vmcnt(0)
  v_pk_add_f16 v100, v112, v116
  v_pk_add_f16 v102, v114, v118
  v_pk_add_f16 v101, v113, v117
  v_pk_add_f16 v103, v115, v119
  v_permlane32_swap_b32 v100, v102
  v_bitop3_b32 v97, v112, v114, s88 bitop3:0x7e
  v_permlane32_swap_b32 v101, v103
  v_bitop3_b32 v98, v116, v118, s88 bitop3:0x7e
  v_fma_mix_f32 v120, v100, 1.0, v102 op_sel:[0,0,0] op_sel_hi:[1,0,1]
  v_or3_b32 v27, v96, v97, v98
  v_fma_mix_f32 v121, v100, 1.0, v102 op_sel:[1,0,1] op_sel_hi:[1,0,1]
  v_and_b32 v27, 1, v27
  v_fma_mix_f32 v122, v101, 1.0, v103 op_sel:[0,0,0] op_sel_hi:[1,0,1]
  v_cmp_ne_u32 vcc, 0, v27
  v_fma_mix_f32 v123, v101, 1.0, v103 op_sel:[1,0,1] op_sel_hi:[1,0,1]
  v_max3_f32 v236, v120, v121, v238
  s_cbranch_vccnz psr_48
  s_branch psj_49
kvw_51:
  s_mov_b32 s22, s87
  s_cmp_eq_u32 s52, 0
  s_cselect_b32 s23, s87, s46
  s_cselect_b32 s55, 0, s55
  s_cselect_b32 s87, 1, 0
  s_cmp_eq_u32 s23, 0
  s_cbranch_scc1 kvok_52
  v_mov_b32 v236, 0
  s_mov_b32 s101, 0
wf_56:
  buffer_load_dword v237, v236, s[12:15], s79 offen sc1
  s_add_u32 s101, s101, 1
  s_cmp_gt_u32 s101, 131072
  s_cbranch_scc1 end0
  s_waitcnt vmcnt(0)
  v_readfirstlane_b32 s100, v237
  s_cmp_ge_u32 s100, s23
  s_cbranch_scc1 wf_57
  s_sleep 3
  s_branch wf_56
wf_57:
  s_cmp_eq_u32 s22, 0
  s_cbranch_scc1 kvok_52
  s_sub_u32 s21, s64, 1310720
  buffer_load_dwordx4 v[176:179], v16, s[28:31], s21 offen offset:0 sc1
  buffer_load_dwordx4 v[180:183], v16, s[28:31], s21 offen offset:1024 sc1
  buffer_load_dwordx4 v[184:187], v16, s[28:31], s21 offen offset:2048 sc1
  s_waitcnt vmcnt(0)
  s_branch kvok_52
fl_53:
  buffer_load_dword v94, v95, s[12:15], s79 offen sc1
  s_branch fl_54
last_41:
  v_mov_b32 v188, 0
  v_mov_b32 v189, 0
  v_mov_b32 v190, 0
  v_mov_b32 v191, 0
  v_mov_b32 v192, 0
  v_mov_b32 v193, 0
  v_mov_b32 v194, 0
  v_mov_b32 v195, 0
  v_mov_b32 v196, 0
  v_mov_b32 v197, 0
  v_mov_b32 v198, 0
  v_mov_b32 v199, 0
  s_sleep 4
  s_mov_b32 s54, 0
lv_58:
  buffer_load_dwordx4 v[144:147], v10, s[8:11], s81 offen offset:0 sc1
  buffer_load_dwordx4 v[148:151], v10, s[8:11], s81 offen offset:1024 sc1
  buffer_load_dwordx4 v[152:155], v10, s[8:11], s81 offen offset:2048 sc1
  s_add_u32 s54, s54, 1
  s_cmp_gt_u32 s54, 131072
  s_cbranch_scc1 end0
  s_waitcnt vmcnt(0)
  v_max3_u32 v27, v144, v146, v148
  v_max3_u32 v27, v27, v150, v152
  v_max3_u32 v27, v27, v154, v154
  v_cmp_eq_u32 vcc, -1, v27
  s_nop 1
  s_cbranch_vccnz lv_58
  v_smfmac_f32_16x16x64_bf16 v[188:191], v[144:147], a[180:187], v44
  v_smfmac_f32_16x16x64_bf16 v[192:195], v[144:147], a[204:211], v44
  v_smfmac_f32_16x16x64_bf16 v[196:199], v[144:147], a[228:235], v44
  v_smfmac_f32_16x16x64_bf16 v[188:191], v[148:151], a[188:195], v44
  v_smfmac_f32_16x16x64_bf16 v[192:195], v[148:151], a[212:219], v44
  v_smfmac_f32_16x16x64_bf16 v[196:199], v[148:151], a[236:243], v44
  v_smfmac_f32_16x16x64_bf16 v[188:191], v[152:155], a[196:203], v44
  v_smfmac_f32_16x16x64_bf16 v[192:195], v[152:155], a[220:227], v44
  v_smfmac_f32_16x16x64_bf16 v[196:199], v[152:155], a[244:251], v44
  s_nop 7
  v_mov_b32 v200, v196
  v_mov_b32 v201, v197
  v_mov_b32 v202, v198
  v_mov_b32 v203, v199
  v_permlane32_swap_b32 v188, v192
  v_permlane32_swap_b32 v189, v193
  v_permlane32_swap_b32 v190, v194
  v_permlane32_swap_b32 v191, v195
  v_permlane32_swap_b32 v196, v200
  v_permlane32_swap_b32 v197, v201
  v_permlane32_swap_b32 v198, v202
  v_permlane32_swap_b32 v199, v203
  v_pk_add_f32 v[188:189], v[188:189], v[192:193]
  v_pk_add_f32 v[190:191], v[190:191], v[194:195]
  v_pk_add_f32 v[196:197], v[196:197], v[200:201]
  v_pk_add_f32 v[198:199], v[198:199], v[202:203]
  v_cvt_pk_bf16_f32 v252, v188, v189
  v_cvt_pk_bf16_f32 v254, v196, v197
  v_cvt_pk_bf16_f32 v253, v190, v191
  v_cvt_pk_bf16_f32 v255, v198, v199
  s_nop 0
  v_permlane16_swap_b32 v252, v254
  v_permlane16_swap_b32 v253, v255
  v_min_u32 v252, -2, v252
  s_mov_b64 exec, s[76:77]
  buffer_store_dwordx4 v[252:255], v15, s[24:27], s57 offen sc1
  s_mov_b64 exec, -1
  s_branch chain_done
step_59:
  s_add_u32 s21, s52, 2
  s_and_b32 s21, s21, 3
  s_mul_i32 s82, s21, 540672
  s_add_u32 s21, s52, 3
  s_and_b32 s21, s21, 3
  s_lshl_b32 s83, s21, 15
  s_add_u32 s21, s52, 1
  s_and_b32 s22, s21, 3
  s_lshl_b32 s3, s22, 15
  s_mul_i32 s80, s21, 393216
  s_add_u32 s46, s21, 1
  s_min_u32 s46, s46, 64
  s_mul_i32 s85, s52, 98304
  s_mul_i32 s57, s52, 327680
  s_add_u32 s57, s57, 42991616

  s_bfe_u32 s88, s52, 0x10002
  s_add_u32 s78, s81, 278528
  s_max_u32 s21, s52, 1
  s_sub_u32 s21, s21, 1
  s_cmp_lt_u32 s52, 98
  s_cselect_b32 s66, s65, 0x80000000
  s_cselect_b32 s68, 15, 1
  s_cmp_ge_u32 s52, 99
  s_cselect_b32 s66, s90, s66
  s_cselect_b32 s67, s52, s21
  v_mov_b32 v52, 0
  v_mov_b32 v53, 0
  v_mov_b32 v54, 0
  v_mov_b32 v55, 0
  v_mov_b32 v56, 0
  v_mov_b32 v57, 0
  v_mov_b32 v58, 0
  v_mov_b32 v59, 0
  v_mov_b32 v60, 0
  v_mov_b32 v61, 0
  v_mov_b32 v62, 0
  v_mov_b32 v63, 0
  v_mov_b32 v64, 0
  v_mov_b32 v65, 0
  v_mov_b32 v66, 0
  v_mov_b32 v67, 0
  v_mov_b32 v68, 0
  v_mov_b32 v69, 0
  v_mov_b32 v70, 0
  v_mov_b32 v71, 0
  v_mov_b32 v72, 0
  v_mov_b32 v73, 0
  v_mov_b32 v74, 0
  v_mov_b32 v75, 0
  v_mov_b32 v76, 0
  v_mov_b32 v77, 0
  v_mov_b32 v78, 0
  v_mov_b32 v79, 0
  v_mov_b32 v80, 0
  v_mov_b32 v81, 0
  v_mov_b32 v82, 0
  v_mov_b32 v83, 0
  v_mov_b32 v84, 0
  v_mov_b32 v85, 0
  v_mov_b32 v86, 0
  v_mov_b32 v87, 0
  s_sleep 3
  s_nop 3
  v_readfirstlane_b32 s21, v94
  s_cmp_lt_u32 s21, s46
  s_cselect_b32 s55, s55, 0
  s_cmp_lt_i32 s55, 0
  s_cbranch_scc1 fl_63
fl_64:
  s_mov_b32 s54, 0
  buffer_load_dwordx4 v[32:35], v4, s[4:7], s84 offen offset:0 sc1
  buffer_load_dwordx4 v[36:39], v4, s[4:7], s84 offen offset:1024 sc1
  buffer_load_dwordx4 v[40:43], v4, s[4:7], s84 offen offset:2048 sc1
  s_waitcnt vmcnt(3)
  v_mov_b32 v176, v160
  v_mov_b32 v177, v161
  v_mov_b32 v178, v162
  v_mov_b32 v179, v163
  v_mov_b32 v180, v164
  v_mov_b32 v181, v165
  v_mov_b32 v182, v166
  v_mov_b32 v183, v167
  v_mov_b32 v184, v48
  v_mov_b32 v185, v49
  v_mov_b32 v186, v50
  v_mov_b32 v187, v51
  s_waitcnt vmcnt(0)
  v_bitop3_b32 v27, v35, v39, v43 bitop3:0x80
  v_perm_b32 v35, v39, v35, s89
  v_cmp_gt_u32 vcc, 0x48000000, v27
  v_mov_b32 v39, v42
  s_cbranch_vccnz pm_61
A1_17:
  v_smfmac_f32_16x16x32_f16 v[52:55], v[40:41], a[16:19], v44
  v_smfmac_f32_16x16x32_f16 v[64:67], v[40:41], a[76:79], v44
  v_smfmac_f32_16x16x32_f16 v[56:59], v[40:41], a[36:39], v44
  v_smfmac_f32_16x16x32_f16 v[68:71], v[40:41], a[96:99], v44
  v_smfmac_f32_16x16x64_f16 v[52:55], v[32:35], a[0:7], v44
  v_smfmac_f32_16x16x64_f16 v[52:55], v[36:39], a[8:15], v44
  v_smfmac_f32_16x16x64_f16 v[64:67], v[32:35], a[60:67], v44
  v_smfmac_f32_16x16x64_f16 v[64:67], v[36:39], a[68:75], v44
  v_smfmac_f32_16x16x32_f16 v[60:63], v[40:41], a[56:59], v44
  v_cvt_pk_f16_f32 v52, v52, v53
  v_cvt_pk_f16_f32 v53, v54, v55
  v_smfmac_f32_16x16x32_f16 v[72:75], v[40:41], a[116:119], v44
  v_smfmac_f32_16x16x32_f16 v[76:79], v[40:41], a[136:139], v44
  v_cvt_pk_f16_f32 v64, v64, v65
  v_cvt_pk_f16_f32 v65, v66, v67
  s_nop 0
  v_smfmac_f32_16x16x64_f16 v[56:59], v[32:35], a[20:27], v44
  v_permlane32_swap_b32 v52, v64
  v_smfmac_f32_16x16x64_f16 v[56:59], v[36:39], a[28:35], v44
  v_permlane32_swap_b32 v53, v65
  v_pk_add_f16 v52, v52, v64
  v_smfmac_f32_16x16x64_f16 v[68:71], v[32:35], a[80:87], v44
  v_pk_add_f16 v53, v53, v65
  v_smfmac_f32_16x16x64_f16 v[68:71], v[36:39], a[88:95], v44
  ds_write_b64 v5, v[52:53] offset:0
  v_smfmac_f32_16x16x32_f16 v[80:83], v[40:41], a[156:159], v44
  v_cvt_pk_f16_f32 v56, v56, v57
  v_cvt_pk_f16_f32 v57, v58, v59
  v_smfmac_f32_16x16x32_f16 v[84:87], v[40:41], a[176:179], v44
  v_cvt_pk_f16_f32 v68, v68, v69
  v_cvt_pk_f16_f32 v69, v70, v71
  s_nop 0
  v_smfmac_f32_16x16x64_f16 v[60:63], v[32:35], a[40:47], v44
  v_permlane32_swap_b32 v56, v68
  v_smfmac_f32_16x16x64_f16 v[60:63], v[36:39], a[48:55], v44
  v_permlane32_swap_b32 v57, v69
  v_pk_add_f16 v56, v56, v68
  v_smfmac_f32_16x16x64_f16 v[72:75], v[32:35], a[100:107], v44
  v_pk_add_f16 v57, v57, v69
  v_smfmac_f32_16x16x64_f16 v[72:75], v[36:39], a[108:115], v44
  ds_write_b64 v5, v[56:57] offset:640
  v_smfmac_f32_16x16x64_f16 v[76:79], v[32:35], a[120:127], v44
  v_cvt_pk_f16_f32 v60, v60, v61
  v_cvt_pk_f16_f32 v61, v62, v63
  v_smfmac_f32_16x16x64_f16 v[76:79], v[36:39], a[128:135], v44
  v_cvt_pk_f16_f32 v72, v72, v73
  v_cvt_pk_f16_f32 v73, v74, v75
  s_nop 0
  v_smfmac_f32_16x16x64_f16 v[80:83], v[32:35], a[140:147], v44
  v_permlane32_swap_b32 v60, v72
  v_smfmac_f32_16x16x64_f16 v[80:83], v[36:39], a[148:155], v44
  v_permlane32_swap_b32 v61, v73
  v_pk_add_f16 v60, v60, v72
  v_smfmac_f32_16x16x64_f16 v[84:87], v[32:35], a[160:167], v44
  v_pk_add_f16 v61, v61, v73
  v_smfmac_f32_16x16x64_f16 v[84:87], v[36:39], a[168:175], v44
  ds_write_b64 v5, v[60:61] offset:1280
  v_cvt_pk_f16_f32 v76, v76, v77
  v_cvt_pk_f16_f32 v77, v78, v79
  v_cvt_pk_f16_f32 v80, v80, v81
  v_cvt_pk_f16_f32 v81, v82, v83
  s_nop 0
  v_permlane32_swap_b32 v76, v80
  v_permlane32_swap_b32 v77, v81
  v_pk_add_f16 v76, v76, v80
  v_pk_add_f16 v77, v77, v81
  ds_write_b64 v5, v[76:77] offset:1920
  v_cvt_pk_f16_f32 v84, v84, v85
  v_cvt_pk_f16_f32 v85, v86, v87
  ds_write_b64 v5, v[84:85] offset:2560
  s_waitcnt lgkmcnt(0) vmcnt(0)
  s_barrier
  ds_read_b64_tr_b16 v[104:105], v6 offset:0
  ds_read_b64_tr_b16 v[106:107], v6 offset:3200
  ds_read_b64_tr_b16 v[108:109], v6 offset:6400
  ds_read_b64_tr_b16 v[110:111], v6 offset:9600
  ds_read_b64_tr_b16 v[112:113], v6 offset:640
  ds_read_b64_tr_b16 v[114:115], v6 offset:3840
  ds_read_b64_tr_b16 v[116:117], v6 offset:7040
  ds_read_b64_tr_b16 v[118:119], v6 offset:10240
  ds_read_b64_tr_b16 v[120:121], v6 offset:1280
  ds_read_b64_tr_b16 v[122:123], v6 offset:4480
  ds_read_b64_tr_b16 v[124:125], v6 offset:7680
  ds_read_b64_tr_b16 v[126:127], v6 offset:10880
  s_waitcnt lgkmcnt(8)
  v_pk_add_f16 v104, v104, v106
  v_pk_add_f16 v108, v108, v110
  v_pk_add_f16 v105, v105, v107
  v_pk_add_f16 v109, v109, v111
  v_fma_mix_f32 v128, v104, 1.0, v108 op_sel:[0,0,0] op_sel_hi:[1,0,1]
  v_fma_mix_f32 v129, v104, 1.0, v108 op_sel:[1,0,1] op_sel_hi:[1,0,1]
  v_fma_mix_f32 v130, v105, 1.0, v109 op_sel:[0,0,0] op_sel_hi:[1,0,1]
  v_fma_mix_f32 v131, v105, 1.0, v109 op_sel:[1,0,1] op_sel_hi:[1,0,1]
  v_cvt_pk_bf16_f32 v212, v128, v129
  v_cvt_pk_bf16_f32 v213, v130, v131
  s_waitcnt lgkmcnt(4)
  v_pk_add_f16 v112, v112, v114
  v_pk_add_f16 v116, v116, v118
  v_pk_add_f16 v113, v113, v115
  v_pk_add_f16 v117, v117, v119
  v_fma_mix_f32 v128, v112, 1.0, v116 op_sel:[0,0,0] op_sel_hi:[1,0,1]
  v_fma_mix_f32 v129, v112, 1.0, v116 op_sel:[1,0,1] op_sel_hi:[1,0,1]
  v_fma_mix_f32 v130, v113, 1.0, v117 op_sel:[0,0,0] op_sel_hi:[1,0,1]
  v_fma_mix_f32 v131, v113, 1.0, v117 op_sel:[1,0,1] op_sel_hi:[1,0,1]
  v_cvt_pk_bf16_f32 v214, v128, v129
  v_cvt_pk_bf16_f32 v215, v130, v131
  s_waitcnt lgkmcnt(0)
  v_pk_add_f16 v120, v120, v122
  v_pk_add_f16 v124, v124, v126
  v_pk_add_f16 v121, v121, v123
  v_pk_add_f16 v125, v125, v127
  v_fma_mix_f32 v128, v120, 1.0, v124 op_sel:[0,0,0] op_sel_hi:[1,0,1]
  v_fma_mix_f32 v129, v120, 1.0, v124 op_sel:[1,0,1] op_sel_hi:[1,0,1]
  v_mfma_f32_16x16x32_bf16 v[96:99], v[212:215], v[212:215], 0
  v_fma_mix_f32 v130, v121, 1.0, v125 op_sel:[0,0,0] op_sel_hi:[1,0,1]
  v_fma_mix_f32 v131, v121, 1.0, v125 op_sel:[1,0,1] op_sel_hi:[1,0,1]
  v_cvt_pk_bf16_f32 v216, v128, v129
  v_cvt_pk_bf16_f32 v217, v130, v131
  s_nop 1
  v_mfma_f32_16x16x32_bf16 v[96:99], v[216:219], v[216:219], v[96:99]
  s_mov_b64 exec, s[74:75]
  s_nop 6
  v_cvt_pk_f16_f32 v100, v96, v97
  v_cvt_pk_f16_f32 v101, v98, v99
  v_and_or_b32 v100, v100, -2, s88
  buffer_store_dwordx2 v[100:101], v7, s[8:11], s81 offen
  s_mov_b64 exec, -1
  s_cmp_eq_u32 s52, 63
  s_cbranch_scc1 last_60
  s_sleep 4
  s_nop 7
  s_mov_b32 s54, 0
  buffer_load_dwordx2 v[248:249], v9, s[8:11], s81 offen sc1
  buffer_load_dwordx4 v[112:115], v8, s[8:11], s81 offen offset:0 sc1
  buffer_load_dwordx4 v[116:119], v8, s[8:11], s81 offen offset:1024 sc1
  s_sleep 2
  buffer_load_dwordx4 v[144:147], v10, s[8:11], s81 offen offset:0 sc1
  buffer_load_dwordx4 v[148:151], v10, s[8:11], s81 offen offset:1024 sc1
  buffer_load_dwordx4 v[152:155], v10, s[8:11], s81 offen offset:2048 sc1
  v_mov_b32 v188, 0
  v_mov_b32 v189, 0
  v_mov_b32 v190, 0
  v_mov_b32 v191, 0
  v_mov_b32 v192, 0
  v_mov_b32 v193, 0
  v_mov_b32 v194, 0
  v_mov_b32 v195, 0
  v_mov_b32 v196, 0
  v_mov_b32 v197, 0
  v_mov_b32 v198, 0
  v_mov_b32 v199, 0
  v_readfirstlane_b32 s21, v94
  s_add_u32 s22, s46, 3
  s_min_u32 s22, s22, 64
  s_sub_u32 s55, s21, s22
  s_sub_u32 s56, s21, s46
  s_cmp_lt_i32 s56, 0
  s_cbranch_scc1 kvw_70
kvok_71:
  s_waitcnt vmcnt(5)
  v_xor_b32 v96, s88, v248
  s_nop 0
  v_permlane16_swap_b32 v248, v249
  v_fma_mix_f32 v250, v248, 1.0, v249 op_sel:[0,0,0] op_sel_hi:[1,0,1]
  v_fma_mix_f32 v251, v248, 1.0, v249 op_sel:[1,0,1] op_sel_hi:[1,0,1]
  v_mov_b32 v248, v250
  v_mov_b32 v249, v251
  s_nop 0
  v_permlane32_swap_b32 v248, v250
  v_permlane32_swap_b32 v249, v251
  v_pk_add_f32 v[124:125], v[248:249], v[250:251]
  v_max_f32 v238, v124, v125
  s_waitcnt vmcnt(3)
  v_pk_add_f16 v100, v112, v116
  v_pk_add_f16 v102, v114, v118
  v_pk_add_f16 v101, v113, v117
  v_pk_add_f16 v103, v115, v119
  v_permlane32_swap_b32 v100, v102
  v_bitop3_b32 v97, v112, v114, s88 bitop3:0x7e
  v_permlane32_swap_b32 v101, v103
  v_bitop3_b32 v98, v116, v118, s88 bitop3:0x7e
  v_fma_mix_f32 v120, v100, 1.0, v102 op_sel:[0,0,0] op_sel_hi:[1,0,1]
  v_or3_b32 v27, v96, v97, v98
  v_fma_mix_f32 v121, v100, 1.0, v102 op_sel:[1,0,1] op_sel_hi:[1,0,1]
  v_and_b32 v27, 1, v27
  v_fma_mix_f32 v122, v101, 1.0, v103 op_sel:[0,0,0] op_sel_hi:[1,0,1]
  v_cmp_ne_u32 vcc, 0, v27
  v_fma_mix_f32 v123, v101, 1.0, v103 op_sel:[1,0,1] op_sel_hi:[1,0,1]
  v_max3_f32 v236, v120, v121, v238
  s_cbranch_vccnz psr_67
psj_68:
  v_max3_f32 v236, v236, v122, v123
  s_nop 1
  v_max_f32_dpp v236, v236, v236 row_ror:8 row_mask:0xf bank_mask:0xf
  v_mov_b32 v237, v236
  s_waitcnt vmcnt(0)
  v_max3_u32 v27, v144, v146, v148
  v_permlane32_swap_b32 v236, v237
  v_max_f32 v236, v236, v237
  v_mov_b32 v237, v236
  v_max3_u32 v27, v27, v150, v152
  v_max_u32 v27, v27, v154
  v_permlane16_swap_b32 v236, v237
  v_cmp_eq_u32 vcc, -1, v27
  v_max_f32 v236, v236, v237
  v_mul_f32 v236, s86, v236
  s_cbranch_vccnz pv_66
pvj_69:
  v_smfmac_f32_16x16x64_bf16 v[188:191], v[144:147], a[180:187], v44
  v_fma_f32 v120, v120, s86, -v236
  v_smfmac_f32_16x16x64_bf16 v[188:191], v[148:151], a[188:195], v44
  v_fma_f32 v121, v121, s86, -v236
  v_smfmac_f32_16x16x64_bf16 v[188:191], v[152:155], a[196:203], v44
  buffer_load_dwordx4 v[160:163], v17, s[28:31], s64 offen offset:0 sc1
  v_fma_f32 v122, v122, s86, -v236
  v_smfmac_f32_16x16x64_bf16 v[192:195], v[144:147], a[204:211], v44
  v_fma_f32 v123, v123, s86, -v236
  v_smfmac_f32_16x16x64_bf16 v[192:195], v[148:151], a[212:219], v44
  buffer_load_dwordx4 v[164:167], v16, s[28:31], s64 offen offset:1024 sc1
  v_fma_f32 v124, v124, s86, -v236
  v_smfmac_f32_16x16x64_bf16 v[192:195], v[152:155], a[220:227], v44
  v_fma_f32 v125, v125, s86, -v236
  v_smfmac_f32_16x16x64_bf16 v[196:199], v[144:147], a[228:235], v44
  buffer_load_dwordx4 v[48:51], v26, s[28:31], s64 offen offset:2048 sc1
  v_exp_f32 v120, v120
  v_smfmac_f32_16x16x64_bf16 v[196:199], v[148:151], a[236:243], v44
  v_exp_f32 v121, v121
  v_smfmac_f32_16x16x64_bf16 v[196:199], v[152:155], a[244:251], v44
  v_exp_f32 v122, v122
  v_exp_f32 v123, v123
  v_exp_f32 v124, v124
  s_cmp_lt_i32 s55, 0
  s_cbranch_scc1 fl_72
fl_73:
  v_exp_f32 v125, v125
  v_cvt_pk_bf16_f32 v220, v120, v121
  v_cvt_pk_bf16_f32 v221, v122, v123
  v_cvt_pk_bf16_f32 v224, v124, v125
  v_mov_b32_dpp v222, v220 row_ror:8 row_mask:0xf bank_mask:0xf
  v_mov_b32_dpp v223, v221 row_ror:8 row_mask:0xf bank_mask:0xf
  v_mov_b32_dpp v225, v224 row_ror:8 row_mask:0xf bank_mask:0xf
  v_cvt_pk_bf16_f32 v228, v188, v189
  v_mfma_f32_16x16x32_bf16 v[200:203], v[176:179], v[220:223], 0
  v_cvt_pk_bf16_f32 v229, v190, v191
  v_cvt_pk_bf16_f32 v230, v192, v193
  v_mfma_f32_16x16x32_bf16 v[204:207], v[180:183], v[220:223], 0
  v_cvt_pk_bf16_f32 v231, v194, v195
  v_cvt_pk_bf16_f32 v232, v196, v197
  v_mfma_f32_16x16x32_bf16 v[208:211], v[184:187], v[220:223], 0
  v_cvt_pk_bf16_f32 v233, v198, v199
  v_add_f32 v126, v120, v121
  v_mfma_f32_16x16x32_bf16 v[200:203], v[228:231], v[224:227], v[200:203]
  v_add_f32 v127, v122, v123
  v_add_f32 v128, v124, v125
  v_mfma_f32_16x16x32_bf16 v[204:207], v[230:233], v[224:227], v[204:207]
  v_add_f32 v236, v126, v127
  v_fmac_f32 v236, v128, v89
  v_mfma_f32_16x16x32_bf16 v[208:211], v[232:235], v[224:227], v[208:211]
  s_nop 0
  v_add_f32_dpp v236, v236, v236 row_ror:8 row_mask:0xf bank_mask:0xf
  v_mov_b32 v237, v236
  ds_write_b128 v11, v[200:203] offset:0
  s_nop 0
  v_permlane32_swap_b32 v236, v237
  v_add_f32 v236, v236, v237
  v_mov_b32 v237, v236
  ds_write_b128 v11, v[204:207] offset:1024
  s_nop 0
  v_permlane16_swap_b32 v236, v237
  v_add_f32 v236, v236, v237
  v_rcp_f32 v236, v236
  ds_write_b128 v11, v[208:211] offset:2048
  s_mov_b64 exec, 0xff
  ds_write_b32 v242, v236
  s_mov_b64 exec, -1
  s_waitcnt lgkmcnt(0)
  s_barrier
  ds_read_b128 v[104:107], v243
  ds_read_b64 v[96:97], v12 offset:0
  ds_read_b64 v[98:99], v12 offset:3072
  ds_read_b64 v[100:101], v12 offset:6144
  ds_read_b64 v[102:103], v12 offset:9216
  s_waitcnt lgkmcnt(2)
  v_pk_mul_f32 v[96:97], v[96:97], v[104:105] op_sel_hi:[1,0]
  v_pk_fma_f32 v[96:97], v[98:99], v[104:105], v[96:97] op_sel:[0,1,0] op_sel_hi:[1,1,1]
  s_waitcnt lgkmcnt(0)
  v_pk_fma_f32 v[96:97], v[100:101], v[106:107], v[96:97] op_sel_hi:[1,0,1]
  v_pk_fma_f32 v[96:97], v[102:103], v[106:107], v[96:97] op_sel:[0,1,0] op_sel_hi:[1,1,1]
  v_cvt_pk_f16_f32 v100, v96, v97
  v_perm_b32 v100, s91, v100, v14
  buffer_atomic_pk_add_f16 v100, v13, s[4:7], s3 offen
  s_mov_b64 exec, s[62:63]
  buffer_store_dwordx4 v[212:215], v21, s[24:27], s85 offen sc1
  buffer_store_dwordx2 v[216:217], v23, s[24:27], s85 offen sc1
  s_mov_b64 exec, -1
  v_mov_b32 v200, v196
  v_mov_b32 v201, v197
  v_mov_b32 v202, v198
  v_mov_b32 v203, v199
  v_permlane32_swap_b32 v188, v192
  v_permlane32_swap_b32 v189, v193
  v_permlane32_swap_b32 v190, v194
  v_permlane32_swap_b32 v191, v195
  v_permlane32_swap_b32 v196, v200
  v_permlane32_swap_b32 v197, v201
  v_permlane32_swap_b32 v198, v202
  v_permlane32_swap_b32 v199, v203
  v_pk_add_f32 v[188:189], v[188:189], v[192:193]
  v_pk_add_f32 v[190:191], v[190:191], v[194:195]
  v_pk_add_f32 v[196:197], v[196:197], v[200:201]
  v_pk_add_f32 v[198:199], v[198:199], v[202:203]
  v_cvt_pk_bf16_f32 v252, v188, v189
  v_cvt_pk_bf16_f32 v254, v196, v197
  v_cvt_pk_bf16_f32 v253, v190, v191
  v_cvt_pk_bf16_f32 v255, v198, v199
  s_nop 0
  v_permlane16_swap_b32 v252, v254
  v_permlane16_swap_b32 v253, v255
  v_min_u32 v252, -2, v252
  s_mov_b64 exec, s[76:77]
  buffer_store_dwordx4 v[252:255], v15, s[24:27], s57 offen sc1
  s_mov_b64 exec, -1
  s_add_u32 s64, s64, 1310720
  s_add_u32 s52, s52, 1
  s_and_b32 s21, s52, 3
  s_mul_i32 s81, s21, 540672
  s_lshl_b32 s84, s21, 15
  s_branch step_59
fl_63:
  buffer_load_dword v94, v95, s[12:15], s79 offen sc1
  s_branch fl_64
pm_61:
  s_cmp_gt_u32 s52, 3
  s_cbranch_scc1 op_74
  v_readfirstlane_b32 s21, v94
  s_cmp_ge_u32 s21, s46
  s_cbranch_scc1 op_74
  buffer_load_dword v94, v95, s[12:15], s79 offen sc1
  s_waitcnt vmcnt(0)
  v_readfirstlane_b32 s21, v94
  s_add_u32 s22, s46, 3
  s_min_u32 s22, s22, 64
  s_sub_u32 s55, s21, s22
  s_sub_u32 s56, s21, s46
  s_cmp_gt_u32 s21, s52
  s_cselect_b32 s21, s87, 0
  s_cmp_eq_u32 s21, 0
  s_cbranch_scc1 op_74
  s_mov_b32 s87, 0
  s_sub_u32 s21, s64, 1310720
  buffer_load_dwordx4 v[176:179], v16, s[28:31], s21 offen offset:0 sc1
  buffer_load_dwordx4 v[180:183], v16, s[28:31], s21 offen offset:1024 sc1
  buffer_load_dwordx4 v[184:187], v16, s[28:31], s21 offen offset:2048 sc1
op_74:
  buffer_load_dwordx4 v[32:35], v4, s[4:7], s84 offen offset:0 sc1
  buffer_load_dwordx4 v[36:39], v4, s[4:7], s84 offen offset:1024 sc1
  buffer_load_dwordx4 v[40:43], v4, s[4:7], s84 offen offset:2048 sc1
  s_add_u32 s54, s54, 1
  s_cmp_gt_u32 s54, 131072
  s_cbranch_scc1 end0
  s_waitcnt vmcnt(0)
  v_bitop3_b32 v27, v35, v39, v43 bitop3:0x80
  v_perm_b32 v35, v39, v35, s89
  v_cmp_gt_u32 vcc, 0x48000000, v27
  v_mov_b32 v39, v42
  s_cbranch_vccnz pm_61
  s_branch A1_17
pv_66:
  buffer_load_dwordx4 v[144:147], v10, s[8:11], s81 offen offset:0 sc1
  buffer_load_dwordx4 v[148:151], v10, s[8:11], s81 offen offset:1024 sc1
  buffer_load_dwordx4 v[152:155], v10, s[8:11], s81 offen offset:2048 sc1
  s_add_u32 s54, s54, 1
  s_cmp_gt_u32 s54, 131072
  s_cbranch_scc1 end0
  s_waitcnt vmcnt(0)
  v_max3_u32 v27, v144, v146, v148
  v_max3_u32 v27, v27, v150, v152
  v_max3_u32 v27, v27, v154, v154
  v_cmp_eq_u32 vcc, -1, v27
  s_nop 1
  s_cbranch_vccnz pv_66
  s_branch pvj_69
psr_67:
  buffer_load_dwordx2 v[248:249], v9, s[8:11], s81 offen sc1
  buffer_load_dwordx4 v[112:115], v8, s[8:11], s81 offen offset:0 sc1
  buffer_load_dwordx4 v[116:119], v8, s[8:11], s81 offen offset:1024 sc1
  s_add_u32 s54, s54, 1
  s_cmp_gt_u32 s54, 131072
  s_cbranch_scc1 end0
  s_waitcnt vmcnt(2)
  v_xor_b32 v96, s88, v248
  s_nop 0
  v_permlane16_swap_b32 v248, v249
  v_fma_mix_f32 v250, v248, 1.0, v249 op_sel:[0,0,0] op_sel_hi:[1,0,1]
  v_fma_mix_f32 v251, v248, 1.0, v249 op_sel:[1,0,1] op_sel_hi:[1,0,1]
  v_mov_b32 v248, v250
  v_mov_b32 v249, v251
  s_nop 0
  v_permlane32_swap_b32 v248, v250
  v_permlane32_swap_b32 v249, v251
  v_pk_add_f32 v[124:125], v[248:249], v[250:251]
  v_max_f32 v238, v124, v125
  s_waitcnt vmcnt(0)
  v_pk_add_f16 v100, v112, v116
  v_pk_add_f16 v102, v114, v118
  v_pk_add_f16 v101, v113, v117
  v_pk_add_f16 v103, v115, v119
  v_permlane32_swap_b32 v100, v102
  v_bitop3_b32 v97, v112, v114, s88 bitop3:0x7e
  v_permlane32_swap_b32 v101, v103
  v_bitop3_b32 v98, v116, v118, s88 bitop3:0x7e
  v_fma_mix_f32 v120, v100, 1.0, v102 op_sel:[0,0,0] op_sel_hi:[1,0,1]
  v_or3_b32 v27, v96, v97, v98
  v_fma_mix_f32 v121, v100, 1.0, v102 op_sel:[1,0,1] op_sel_hi:[1,0,1]
  v_and_b32 v27, 1, v27
  v_fma_mix_f32 v122, v101, 1.0, v103 op_sel:[0,0,0] op_sel_hi:[1,0,1]
  v_cmp_ne_u32 vcc, 0, v27
  v_fma_mix_f32 v123, v101, 1.0, v103 op_sel:[1,0,1] op_sel_hi:[1,0,1]
  v_max3_f32 v236, v120, v121, v238
  s_cbranch_vccnz psr_67
  s_branch psj_68
kvw_70:
  s_mov_b32 s22, s87
  s_cmp_eq_u32 s52, 0
  s_cselect_b32 s23, s87, s46
  s_cselect_b32 s55, 0, s55
  s_cselect_b32 s87, 1, 0
  s_cmp_eq_u32 s23, 0
  s_cbranch_scc1 kvok_71
  v_mov_b32 v236, 0
  s_mov_b32 s101, 0
wf_75:
  buffer_load_dword v237, v236, s[12:15], s79 offen sc1
  s_add_u32 s101, s101, 1
  s_cmp_gt_u32 s101, 131072
  s_cbranch_scc1 end0
  s_waitcnt vmcnt(0)
  v_readfirstlane_b32 s100, v237
  s_cmp_ge_u32 s100, s23
  s_cbranch_scc1 wf_76
  s_sleep 3
  s_branch wf_75
wf_76:
  s_cmp_eq_u32 s22, 0
  s_cbranch_scc1 kvok_71
  s_sub_u32 s21, s64, 1310720
  buffer_load_dwordx4 v[176:179], v16, s[28:31], s21 offen offset:0 sc1
  buffer_load_dwordx4 v[180:183], v16, s[28:31], s21 offen offset:1024 sc1
  buffer_load_dwordx4 v[184:187], v16, s[28:31], s21 offen offset:2048 sc1
  s_waitcnt vmcnt(0)
  s_branch kvok_71
fl_72:
  buffer_load_dword v94, v95, s[12:15], s79 offen sc1
  s_branch fl_73
last_60:
  s_mov_b64 exec, s[62:63]
  buffer_store_dwordx4 v[212:215], v21, s[24:27], s85 offen sc1
  buffer_store_dwordx2 v[216:217], v23, s[24:27], s85 offen sc1
  s_mov_b64 exec, -1
  v_mov_b32 v188, 0
  v_mov_b32 v189, 0
  v_mov_b32 v190, 0
  v_mov_b32 v191, 0
  v_mov_b32 v192, 0
  v_mov_b32 v193, 0
  v_mov_b32 v194, 0
  v_mov_b32 v195, 0
  v_mov_b32 v196, 0
  v_mov_b32 v197, 0
  v_mov_b32 v198, 0
  v_mov_b32 v199, 0
  s_sleep 4
  s_mov_b32 s54, 0
lv_77:
  buffer_load_dwordx4 v[144:147], v10, s[8:11], s81 offen offset:0 sc1
  buffer_load_dwordx4 v[148:151], v10, s[8:11], s81 offen offset:1024 sc1
  buffer_load_dwordx4 v[152:155], v10, s[8:11], s81 offen offset:2048 sc1
  s_add_u32 s54, s54, 1
  s_cmp_gt_u32 s54, 131072
  s_cbranch_scc1 end0
  s_waitcnt vmcnt(0)
  v_max3_u32 v27, v144, v146, v148
  v_max3_u32 v27, v27, v150, v152
  v_max3_u32 v27, v27, v154, v154
  v_cmp_eq_u32 vcc, -1, v27
  s_nop 1
  s_cbranch_vccnz lv_77
  v_smfmac_f32_16x16x64_bf16 v[188:191], v[144:147], a[180:187], v44
  v_smfmac_f32_16x16x64_bf16 v[192:195], v[144:147], a[204:211], v44
  v_smfmac_f32_16x16x64_bf16 v[196:199], v[144:147], a[228:235], v44
  v_smfmac_f32_16x16x64_bf16 v[188:191], v[148:151], a[188:195], v44
  v_smfmac_f32_16x16x64_bf16 v[192:195], v[148:151], a[212:219], v44
  v_smfmac_f32_16x16x64_bf16 v[196:199], v[148:151], a[236:243], v44
  v_smfmac_f32_16x16x64_bf16 v[188:191], v[152:155], a[196:203], v44
  v_smfmac_f32_16x16x64_bf16 v[192:195], v[152:155], a[220:227], v44
  v_smfmac_f32_16x16x64_bf16 v[196:199], v[152:155], a[244:251], v44
  s_nop 7
  v_mov_b32 v200, v196
  v_mov_b32 v201, v197
  v_mov_b32 v202, v198
  v_mov_b32 v203, v199
  v_permlane32_swap_b32 v188, v192
  v_permlane32_swap_b32 v189, v193
  v_permlane32_swap_b32 v190, v194
  v_permlane32_swap_b32 v191, v195
  v_permlane32_swap_b32 v196, v200
  v_permlane32_swap_b32 v197, v201
  v_permlane32_swap_b32 v198, v202
  v_permlane32_swap_b32 v199, v203
  v_pk_add_f32 v[188:189], v[188:189], v[192:193]
  v_pk_add_f32 v[190:191], v[190:191], v[194:195]
  v_pk_add_f32 v[196:197], v[196:197], v[200:201]
  v_pk_add_f32 v[198:199], v[198:199], v[202:203]
  v_cvt_pk_bf16_f32 v252, v188, v189
  v_cvt_pk_bf16_f32 v254, v196, v197
  v_cvt_pk_bf16_f32 v253, v190, v191
  v_cvt_pk_bf16_f32 v255, v198, v199
  s_nop 0
  v_permlane16_swap_b32 v252, v254
  v_permlane16_swap_b32 v253, v255
  v_min_u32 v252, -2, v252
  s_mov_b64 exec, s[76:77]
  buffer_store_dwordx4 v[252:255], v15, s[24:27], s57 offen sc1
  s_mov_b64 exec, -1
  s_branch chain_done
step_78:
  s_add_u32 s21, s52, 2
  s_and_b32 s21, s21, 3
  s_mul_i32 s82, s21, 540672
  s_add_u32 s21, s52, 3
  s_and_b32 s21, s21, 3
  s_lshl_b32 s83, s21, 15
  s_add_u32 s21, s52, 1
  s_and_b32 s22, s21, 3
  s_lshl_b32 s3, s22, 15
  s_mul_i32 s80, s21, 393216
  s_add_u32 s46, s21, 1
  s_min_u32 s46, s46, 64
  s_mul_i32 s85, s52, 98304
  s_mul_i32 s57, s52, 327680
  s_add_u32 s57, s57, 42991616

  s_bfe_u32 s88, s52, 0x10002
  s_add_u32 s78, s81, 278528
  s_max_u32 s21, s52, 1
  s_sub_u32 s21, s21, 1
  s_cmp_lt_u32 s52, 98
  s_cselect_b32 s66, s65, 0x80000000
  s_cselect_b32 s68, 15, 1
  s_cmp_ge_u32 s52, 99
  s_cselect_b32 s66, s90, s66
  s_cselect_b32 s67, s52, s21
  v_mov_b32 v52, 0
  v_mov_b32 v53, 0
  v_mov_b32 v54, 0
  v_mov_b32 v55, 0
  v_mov_b32 v56, 0
  v_mov_b32 v57, 0
  v_mov_b32 v58, 0
  v_mov_b32 v59, 0
  v_mov_b32 v60, 0
  v_mov_b32 v61, 0
  v_mov_b32 v62, 0
  v_mov_b32 v63, 0
  v_mov_b32 v64, 0
  v_mov_b32 v65, 0
  v_mov_b32 v66, 0
  v_mov_b32 v67, 0
  v_mov_b32 v68, 0
  v_mov_b32 v69, 0
  v_mov_b32 v70, 0
  v_mov_b32 v71, 0
  v_mov_b32 v72, 0
  v_mov_b32 v73, 0
  v_mov_b32 v74, 0
  v_mov_b32 v75, 0
  v_mov_b32 v76, 0
  v_mov_b32 v77, 0
  v_mov_b32 v78, 0
  v_mov_b32 v79, 0
  v_mov_b32 v80, 0
  v_mov_b32 v81, 0
  v_mov_b32 v82, 0
  v_mov_b32 v83, 0
  v_mov_b32 v84, 0
  v_mov_b32 v85, 0
  v_mov_b32 v86, 0
  v_mov_b32 v87, 0
  s_sleep 4
  s_nop 3
  v_readfirstlane_b32 s21, v94
  s_cmp_lt_u32 s21, s46
  s_cselect_b32 s55, s55, 0
  s_cmp_lt_i32 s55, 0
  s_cbranch_scc1 fl_82
fl_83:
  s_mov_b32 s54, 0
  buffer_load_dwordx4 v[32:35], v4, s[4:7], s84 offen offset:0 sc1
  buffer_load_dwordx4 v[36:39], v4, s[4:7], s84 offen offset:1024 sc1
  buffer_load_dwordx4 v[40:43], v4, s[4:7], s84 offen offset:2048 sc1
  s_waitcnt vmcnt(3)
  v_mov_b32 v176, v160
  v_mov_b32 v177, v161
  v_mov_b32 v178, v162
  v_mov_b32 v179, v163
  v_mov_b32 v180, v164
  v_mov_b32 v181, v165
  v_mov_b32 v182, v166
  v_mov_b32 v183, v167
  v_mov_b32 v184, v48
  v_mov_b32 v185, v49
  v_mov_b32 v186, v50
  v_mov_b32 v187, v51
  s_waitcnt vmcnt(0)
  v_bitop3_b32 v27, v35, v39, v43 bitop3:0x80
  v_perm_b32 v35, v39, v35, s89
  v_cmp_gt_u32 vcc, 0x48000000, v27
  v_mov_b32 v39, v42
  s_cbranch_vccnz pm_80
A1_18:
  v_smfmac_f32_16x16x32_f16 v[52:55], v[40:41], a[16:19], v44
  v_smfmac_f32_16x16x32_f16 v[64:67], v[40:41], a[76:79], v44
  v_smfmac_f32_16x16x32_f16 v[56:59], v[40:41], a[36:39], v44
  v_smfmac_f32_16x16x32_f16 v[68:71], v[40:41], a[96:99], v44
  v_smfmac_f32_16x16x64_f16 v[52:55], v[32:35], a[0:7], v44
  v_smfmac_f32_16x16x64_f16 v[52:55], v[36:39], a[8:15], v44
  v_smfmac_f32_16x16x64_f16 v[64:67], v[32:35], a[60:67], v44
  v_smfmac_f32_16x16x64_f16 v[64:67], v[36:39], a[68:75], v44
  v_smfmac_f32_16x16x32_f16 v[60:63], v[40:41], a[56:59], v44
  v_cvt_pk_f16_f32 v52, v52, v53
  v_cvt_pk_f16_f32 v53, v54, v55
  v_smfmac_f32_16x16x32_f16 v[72:75], v[40:41], a[116:119], v44
  v_smfmac_f32_16x16x32_f16 v[76:79], v[40:41], a[136:139], v44
  v_cvt_pk_f16_f32 v64, v64, v65
  v_cvt_pk_f16_f32 v65, v66, v67
  s_nop 0
  v_smfmac_f32_16x16x64_f16 v[56:59], v[32:35], a[20:27], v44
  v_permlane32_swap_b32 v52, v64
  v_smfmac_f32_16x16x64_f16 v[56:59], v[36:39], a[28:35], v44
  v_permlane32_swap_b32 v53, v65
  v_pk_add_f16 v52, v52, v64
  v_smfmac_f32_16x16x64_f16 v[68:71], v[32:35], a[80:87], v44
  v_pk_add_f16 v53, v53, v65
  v_smfmac_f32_16x16x64_f16 v[68:71], v[36:39], a[88:95], v44
  ds_write_b64 v5, v[52:53] offset:0
  v_smfmac_f32_16x16x32_f16 v[80:83], v[40:41], a[156:159], v44
  v_cvt_pk_f16_f32 v56, v56, v57
  v_cvt_pk_f16_f32 v57, v58, v59
  v_smfmac_f32_16x16x32_f16 v[84:87], v[40:41], a[176:179], v44
  v_cvt_pk_f16_f32 v68, v68, v69
  v_cvt_pk_f16_f32 v69, v70, v71
  s_nop 0
  v_smfmac_f32_16x16x64_f16 v[60:63], v[32:35], a[40:47], v44
  v_permlane32_swap_b32 v56, v68
  v_smfmac_f32_16x16x64_f16 v[60:63], v[36:39], a[48:55], v44
  v_permlane32_swap_b32 v57, v69
  v_pk_add_f16 v56, v56, v68
  v_smfmac_f32_16x16x64_f16 v[72:75], v[32:35], a[100:107], v44
  v_pk_add_f16 v57, v57, v69
  v_smfmac_f32_16x16x64_f16 v[72:75], v[36:39], a[108:115], v44
  ds_write_b64 v5, v[56:57] offset:640
  v_smfmac_f32_16x16x64_f16 v[76:79], v[32:35], a[120:127], v44
  v_cvt_pk_f16_f32 v60, v60, v61
  v_cvt_pk_f16_f32 v61, v62, v63
  v_smfmac_f32_16x16x64_f16 v[76:79], v[36:39], a[128:135], v44
  v_cvt_pk_f16_f32 v72, v72, v73
  v_cvt_pk_f16_f32 v73, v74, v75
  s_nop 0
  v_smfmac_f32_16x16x64_f16 v[80:83], v[32:35], a[140:147], v44
  v_permlane32_swap_b32 v60, v72
  v_smfmac_f32_16x16x64_f16 v[80:83], v[36:39], a[148:155], v44
  v_permlane32_swap_b32 v61, v73
  v_pk_add_f16 v60, v60, v72
  v_smfmac_f32_16x16x64_f16 v[84:87], v[32:35], a[160:167], v44
  v_pk_add_f16 v61, v61, v73
  v_smfmac_f32_16x16x64_f16 v[84:87], v[36:39], a[168:175], v44
  ds_write_b64 v5, v[60:61] offset:1280
  v_cvt_pk_f16_f32 v76, v76, v77
  v_cvt_pk_f16_f32 v77, v78, v79
  v_cvt_pk_f16_f32 v80, v80, v81
  v_cvt_pk_f16_f32 v81, v82, v83
  s_nop 0
  v_permlane32_swap_b32 v76, v80
  v_permlane32_swap_b32 v77, v81
  v_pk_add_f16 v76, v76, v80
  v_pk_add_f16 v77, v77, v81
  ds_write_b64 v5, v[76:77] offset:1920
  v_cvt_pk_f16_f32 v84, v84, v85
  v_cvt_pk_f16_f32 v85, v86, v87
  ds_write_b64 v5, v[84:85] offset:2560
  s_waitcnt lgkmcnt(0) vmcnt(0)
  s_barrier
  ds_read_b64_tr_b16 v[96:97], v6 offset:1920
  ds_read_b64_tr_b16 v[98:99], v6 offset:5120
  ds_read_b64_tr_b16 v[100:101], v6 offset:8320
  ds_read_b64_tr_b16 v[102:103], v6 offset:11520
  ds_read_b64_tr_b16 v[104:105], v6 offset:2560
  ds_read_b64_tr_b16 v[106:107], v6 offset:5760
  ds_read_b64_tr_b16 v[108:109], v6 offset:8960
  ds_read_b64_tr_b16 v[110:111], v6 offset:12160
  s_waitcnt lgkmcnt(4)
  v_pk_add_f16 v96, v96, v98
  v_pk_add_f16 v100, v100, v102
  v_pk_add_f16 v97, v97, v99
  v_pk_add_f16 v101, v101, v103
  v_fma_mix_f32 v112, v96, 1.0, v100 op_sel:[0,0,0] op_sel_hi:[1,0,1]
  v_fma_mix_f32 v113, v96, 1.0, v100 op_sel:[1,0,1] op_sel_hi:[1,0,1]
  v_fma_mix_f32 v114, v97, 1.0, v101 op_sel:[0,0,0] op_sel_hi:[1,0,1]
  v_fma_mix_f32 v115, v97, 1.0, v101 op_sel:[1,0,1] op_sel_hi:[1,0,1]
  v_cvt_pk_bf16_f32 v90, v112, v113
  v_cvt_pk_bf16_f32 v91, v114, v115
  v_min_u32 v90, -2, v90
  buffer_store_dwordx2 v[90:91], v24, s[8:11], s81 offen
  s_waitcnt lgkmcnt(0)
  v_pk_add_f16 v104, v104, v106
  v_pk_add_f16 v108, v108, v110
  v_pk_add_f16 v105, v105, v107
  v_pk_add_f16 v109, v109, v111
  v_fma_mix_f32 v112, v104, 1.0, v108 op_sel:[0,0,0] op_sel_hi:[1,0,1]
  v_fma_mix_f32 v113, v104, 1.0, v108 op_sel:[1,0,1] op_sel_hi:[1,0,1]
  v_fma_mix_f32 v114, v105, 1.0, v109 op_sel:[0,0,0] op_sel_hi:[1,0,1]
  v_fma_mix_f32 v115, v105, 1.0, v109 op_sel:[1,0,1] op_sel_hi:[1,0,1]
  v_add_f32_dpp v116, v112, v112 row_ror:8 row_mask:0xf bank_mask:0xf
  v_add_f32_dpp v117, v113, v113 row_ror:8 row_mask:0xf bank_mask:0xf
  v_add_f32_dpp v118, v114, v114 row_ror:8 row_mask:0xf bank_mask:0xf
  v_add_f32_dpp v119, v115, v115 row_ror:8 row_mask:0xf bank_mask:0xf
  v_cvt_pk_bf16_f32 v92, v116, v117
  v_cvt_pk_bf16_f32 v93, v118, v119
  v_min_u32 v92, -2, v92
  s_mov_b64 exec, s[60:61]
  buffer_store_dwordx2 v[92:93], v23, s[8:11], s78 offen
  s_mov_b64 exec, -1
  s_cmp_eq_u32 s52, 63
  s_cbranch_scc1 last_79
  s_sleep 5
  s_nop 3
  s_mov_b32 s54, 0
  buffer_load_dwordx2 v[248:249], v9, s[8:11], s81 offen sc1
  buffer_load_dwordx4 v[112:115], v8, s[8:11], s81 offen offset:0 sc1
  buffer_load_dwordx4 v[116:119], v8, s[8:11], s81 offen offset:1024 sc1
  s_sleep 2
  buffer_load_dwordx4 v[144:147], v10, s[8:11], s81 offen offset:0 sc1
  buffer_load_dwordx4 v[148:151], v10, s[8:11], s81 offen offset:1024 sc1
  buffer_load_dwordx4 v[152:155], v10, s[8:11], s81 offen offset:2048 sc1
  v_mov_b32 v188, 0
  v_mov_b32 v189, 0
  v_mov_b32 v190, 0
  v_mov_b32 v191, 0
  v_mov_b32 v192, 0
  v_mov_b32 v193, 0
  v_mov_b32 v194, 0
  v_mov_b32 v195, 0
  v_mov_b32 v196, 0
  v_mov_b32 v197, 0
  v_mov_b32 v198, 0
  v_mov_b32 v199, 0
  v_readfirstlane_b32 s21, v94
  s_add_u32 s22, s46, 3
  s_min_u32 s22, s22, 64
  s_sub_u32 s55, s21, s22
  s_sub_u32 s56, s21, s46
  s_cmp_lt_i32 s56, 0
  s_cbranch_scc1 kvw_89
kvok_90:
  s_waitcnt vmcnt(5)
  v_xor_b32 v96, s88, v248
  s_nop 0
  v_permlane16_swap_b32 v248, v249
  v_fma_mix_f32 v250, v248, 1.0, v249 op_sel:[0,0,0] op_sel_hi:[1,0,1]
  v_fma_mix_f32 v251, v248, 1.0, v249 op_sel:[1,0,1] op_sel_hi:[1,0,1]
  v_mov_b32 v248, v250
  v_mov_b32 v249, v251
  s_nop 0
  v_permlane32_swap_b32 v248, v250
  v_permlane32_swap_b32 v249, v251
  v_pk_add_f32 v[124:125], v[248:249], v[250:251]
  v_max_f32 v238, v124, v125
  s_waitcnt vmcnt(3)
  v_pk_add_f16 v100, v112, v116
  v_pk_add_f16 v102, v114, v118
  v_pk_add_f16 v101, v113, v117
  v_pk_add_f16 v103, v115, v119
  v_permlane32_swap_b32 v100, v102
  v_bitop3_b32 v97, v112, v114, s88 bitop3:0x7e
  v_permlane32_swap_b32 v101, v103
  v_bitop3_b32 v98, v116, v118, s88 bitop3:0x7e
  v_fma_mix_f32 v120, v100, 1.0, v102 op_sel:[0,0,0] op_sel_hi:[1,0,1]
  v_or3_b32 v27, v96, v97, v98
  v_fma_mix_f32 v121, v100, 1.0, v102 op_sel:[1,0,1] op_sel_hi:[1,0,1]
  v_and_b32 v27, 1, v27
  v_fma_mix_f32 v122, v101, 1.0, v103 op_sel:[0,0,0] op_sel_hi:[1,0,1]
  v_cmp_ne_u32 vcc, 0, v27
  v_fma_mix_f32 v123, v101, 1.0, v103 op_sel:[1,0,1] op_sel_hi:[1,0,1]
  v_max3_f32 v236, v120, v121, v238
  s_cbranch_vccnz psr_86
psj_87:
  v_max3_f32 v236, v236, v122, v123
  s_nop 1
  v_max_f32_dpp v236, v236, v236 row_ror:8 row_mask:0xf bank_mask:0xf
  v_mov_b32 v237, v236
  s_waitcnt vmcnt(0)
  v_max3_u32 v27, v144, v146, v148
  v_permlane32_swap_b32 v236, v237
  v_max_f32 v236, v236, v237
  v_mov_b32 v237, v236
  v_max3_u32 v27, v27, v150, v152
  v_max_u32 v27, v27, v154
  v_permlane16_swap_b32 v236, v237
  v_cmp_eq_u32 vcc, -1, v27
  v_max_f32 v236, v236, v237
  v_mul_f32 v236, s86, v236
  s_cbranch_vccnz pv_85
pvj_88:
  v_smfmac_f32_16x16x64_bf16 v[188:191], v[144:147], a[180:187], v44
  v_fma_f32 v120, v120, s86, -v236
  v_smfmac_f32_16x16x64_bf16 v[188:191], v[148:151], a[188:195], v44
  v_fma_f32 v121, v121, s86, -v236
  v_smfmac_f32_16x16x64_bf16 v[188:191], v[152:155], a[196:203], v44
  buffer_load_dwordx4 v[160:163], v17, s[28:31], s64 offen offset:0 sc1
  v_fma_f32 v122, v122, s86, -v236
  v_smfmac_f32_16x16x64_bf16 v[192:195], v[144:147], a[204:211], v44
  v_fma_f32 v123, v123, s86, -v236
  v_smfmac_f32_16x16x64_bf16 v[192:195], v[148:151], a[212:219], v44
  buffer_load_dwordx4 v[164:167], v16, s[28:31], s64 offen offset:1024 sc1
  v_fma_f32 v124, v124, s86, -v236
  v_smfmac_f32_16x16x64_bf16 v[192:195], v[152:155], a[220:227], v44
  v_fma_f32 v125, v125, s86, -v236
  v_smfmac_f32_16x16x64_bf16 v[196:199], v[144:147], a[228:235], v44
  buffer_load_dwordx4 v[48:51], v26, s[28:31], s64 offen offset:2048 sc1
  v_exp_f32 v120, v120
  v_smfmac_f32_16x16x64_bf16 v[196:199], v[148:151], a[236:243], v44
  v_exp_f32 v121, v121
  v_smfmac_f32_16x16x64_bf16 v[196:199], v[152:155], a[244:251], v44
  v_exp_f32 v122, v122
  v_exp_f32 v123, v123
  v_mov_b32 v240, s67
  v_mov_b32 v241, s67
  s_mov_b64 exec, s[68:69]
  buffer_store_dwordx2 v[240:241], v88, s[12:15], s66 offen sc1
  s_mov_b64 exec, -1
  v_exp_f32 v124, v124
  s_cmp_lt_i32 s55, 0
  s_cbranch_scc1 fl_91
fl_92:
  v_exp_f32 v125, v125
  v_cvt_pk_bf16_f32 v220, v120, v121
  v_cvt_pk_bf16_f32 v221, v122, v123
  v_cvt_pk_bf16_f32 v224, v124, v125
  v_mov_b32_dpp v222, v220 row_ror:8 row_mask:0xf bank_mask:0xf
  v_mov_b32_dpp v223, v221 row_ror:8 row_mask:0xf bank_mask:0xf
  v_mov_b32_dpp v225, v224 row_ror:8 row_mask:0xf bank_mask:0xf
  v_cvt_pk_bf16_f32 v228, v188, v189
  v_mfma_f32_16x16x32_bf16 v[200:203], v[176:179], v[220:223], 0
  v_cvt_pk_bf16_f32 v229, v190, v191
  v_cvt_pk_bf16_f32 v230, v192, v193
  v_mfma_f32_16x16x32_bf16 v[204:207], v[180:183], v[220:223], 0
  v_cvt_pk_bf16_f32 v231, v194, v195
  v_cvt_pk_bf16_f32 v232, v196, v197
  v_mfma_f32_16x16x32_bf16 v[208:211], v[184:187], v[220:223], 0
  v_cvt_pk_bf16_f32 v233, v198, v199
  v_add_f32 v126, v120, v121
  v_mfma_f32_16x16x32_bf16 v[200:203], v[228:231], v[224:227], v[200:203]
  v_add_f32 v127, v122, v123
  v_add_f32 v128, v124, v125
  v_mfma_f32_16x16x32_bf16 v[204:207], v[230:233], v[224:227], v[204:207]
  v_add_f32 v236, v126, v127
  v_fmac_f32 v236, v128, v89
  v_mfma_f32_16x16x32_bf16 v[208:211], v[232:235], v[224:227], v[208:211]
  s_nop 0
  v_add_f32_dpp v236, v236, v236 row_ror:8 row_mask:0xf bank_mask:0xf
  v_mov_b32 v237, v236
  ds_write_b128 v11, v[200:203] offset:0
  s_nop 0
  v_permlane32_swap_b32 v236, v237
  v_add_f32 v236, v236, v237
  v_mov_b32 v237, v236
  ds_write_b128 v11, v[204:207] offset:1024
  s_nop 0
  v_permlane16_swap_b32 v236, v237
  v_add_f32 v236, v236, v237
  v_rcp_f32 v236, v236
  ds_write_b128 v11, v[208:211] offset:2048
  s_mov_b64 exec, 0xff
  ds_write_b32 v242, v236
  s_mov_b64 exec, -1
  s_waitcnt lgkmcnt(0)
  s_barrier
  v_mov_b32 v28, -1
  v_mov_b32 v29, -1
  buffer_store_dwordx2 v[28:29], v24, s[8:11], s82 offen
  s_mov_b64 exec, s[60:61]
  s_add_u32 s22, s82, 278528
  buffer_store_dwordx2 v[28:29], v23, s[8:11], s22 offen
  s_and_b32 s21, s52, 7
  s_cmp_lg_u32 s21, s50
  s_cbranch_scc1 zm_93
  s_mov_b64 exec, s[70:71]
  buffer_store_dwordx4 v[156:159], v13, s[4:7], s83 offen sc1
zm_93:
  s_mov_b64 exec, -1
  v_mov_b32 v200, v196
  v_mov_b32 v201, v197
  v_mov_b32 v202, v198
  v_mov_b32 v203, v199
  v_permlane32_swap_b32 v188, v192
  v_permlane32_swap_b32 v189, v193
  v_permlane32_swap_b32 v190, v194
  v_permlane32_swap_b32 v191, v195
  v_permlane32_swap_b32 v196, v200
  v_permlane32_swap_b32 v197, v201
  v_permlane32_swap_b32 v198, v202
  v_permlane32_swap_b32 v199, v203
  v_pk_add_f32 v[188:189], v[188:189], v[192:193]
  v_pk_add_f32 v[190:191], v[190:191], v[194:195]
  v_pk_add_f32 v[196:197], v[196:197], v[200:201]
  v_pk_add_f32 v[198:199], v[198:199], v[202:203]
  v_cvt_pk_bf16_f32 v252, v188, v189
  v_cvt_pk_bf16_f32 v254, v196, v197
  v_cvt_pk_bf16_f32 v253, v190, v191
  v_cvt_pk_bf16_f32 v255, v198, v199
  s_nop 0
  v_permlane16_swap_b32 v252, v254
  v_permlane16_swap_b32 v253, v255
  v_min_u32 v252, -2, v252
  s_mov_b64 exec, s[76:77]
  buffer_store_dwordx4 v[252:255], v15, s[24:27], s57 offen sc1
  s_mov_b64 exec, -1
  s_add_u32 s64, s64, 1310720
  s_add_u32 s52, s52, 1
  s_and_b32 s21, s52, 3
  s_mul_i32 s81, s21, 540672
  s_lshl_b32 s84, s21, 15
  s_branch step_78
fl_82:
  buffer_load_dword v94, v95, s[12:15], s79 offen sc1
  s_branch fl_83
pm_80:
  s_cmp_gt_u32 s52, 3
  s_cbranch_scc1 op_94
  v_readfirstlane_b32 s21, v94
  s_cmp_ge_u32 s21, s46
  s_cbranch_scc1 op_94
  buffer_load_dword v94, v95, s[12:15], s79 offen sc1
  s_waitcnt vmcnt(0)
  v_readfirstlane_b32 s21, v94
  s_add_u32 s22, s46, 3
  s_min_u32 s22, s22, 64
  s_sub_u32 s55, s21, s22
  s_sub_u32 s56, s21, s46
  s_cmp_gt_u32 s21, s52
  s_cselect_b32 s21, s87, 0
  s_cmp_eq_u32 s21, 0
  s_cbranch_scc1 op_94
  s_mov_b32 s87, 0
  s_sub_u32 s21, s64, 1310720
  buffer_load_dwordx4 v[176:179], v16, s[28:31], s21 offen offset:0 sc1
  buffer_load_dwordx4 v[180:183], v16, s[28:31], s21 offen offset:1024 sc1
  buffer_load_dwordx4 v[184:187], v16, s[28:31], s21 offen offset:2048 sc1
op_94:
  buffer_load_dwordx4 v[32:35], v4, s[4:7], s84 offen offset:0 sc1
  buffer_load_dwordx4 v[36:39], v4, s[4:7], s84 offen offset:1024 sc1
  buffer_load_dwordx4 v[40:43], v4, s[4:7], s84 offen offset:2048 sc1
  s_add_u32 s54, s54, 1
  s_cmp_gt_u32 s54, 131072
  s_cbranch_scc1 end0
  s_waitcnt vmcnt(0)
  v_bitop3_b32 v27, v35, v39, v43 bitop3:0x80
  v_perm_b32 v35, v39, v35, s89
  v_cmp_gt_u32 vcc, 0x48000000, v27
  v_mov_b32 v39, v42
  s_cbranch_vccnz pm_80
  s_branch A1_18
pv_85:
  buffer_load_dwordx4 v[144:147], v10, s[8:11], s81 offen offset:0 sc1
  buffer_load_dwordx4 v[148:151], v10, s[8:11], s81 offen offset:1024 sc1
  buffer_load_dwordx4 v[152:155], v10, s[8:11], s81 offen offset:2048 sc1
  s_add_u32 s54, s54, 1
  s_cmp_gt_u32 s54, 131072
  s_cbranch_scc1 end0
  s_waitcnt vmcnt(0)
  v_max3_u32 v27, v144, v146, v148
  v_max3_u32 v27, v27, v150, v152
  v_max3_u32 v27, v27, v154, v154
  v_cmp_eq_u32 vcc, -1, v27
  s_nop 1
  s_cbranch_vccnz pv_85
  s_branch pvj_88
psr_86:
  buffer_load_dwordx2 v[248:249], v9, s[8:11], s81 offen sc1
  buffer_load_dwordx4 v[112:115], v8, s[8:11], s81 offen offset:0 sc1
  buffer_load_dwordx4 v[116:119], v8, s[8:11], s81 offen offset:1024 sc1
  s_add_u32 s54, s54, 1
  s_cmp_gt_u32 s54, 131072
  s_cbranch_scc1 end0
  s_waitcnt vmcnt(2)
  v_xor_b32 v96, s88, v248
  s_nop 0
  v_permlane16_swap_b32 v248, v249
  v_fma_mix_f32 v250, v248, 1.0, v249 op_sel:[0,0,0] op_sel_hi:[1,0,1]
  v_fma_mix_f32 v251, v248, 1.0, v249 op_sel:[1,0,1] op_sel_hi:[1,0,1]
  v_mov_b32 v248, v250
  v_mov_b32 v249, v251
  s_nop 0
  v_permlane32_swap_b32 v248, v250
  v_permlane32_swap_b32 v249, v251
  v_pk_add_f32 v[124:125], v[248:249], v[250:251]
  v_max_f32 v238, v124, v125
  s_waitcnt vmcnt(0)
  v_pk_add_f16 v100, v112, v116
  v_pk_add_f16 v102, v114, v118
  v_pk_add_f16 v101, v113, v117
  v_pk_add_f16 v103, v115, v119
  v_permlane32_swap_b32 v100, v102
  v_bitop3_b32 v97, v112, v114, s88 bitop3:0x7e
  v_permlane32_swap_b32 v101, v103
  v_bitop3_b32 v98, v116, v118, s88 bitop3:0x7e
  v_fma_mix_f32 v120, v100, 1.0, v102 op_sel:[0,0,0] op_sel_hi:[1,0,1]
  v_or3_b32 v27, v96, v97, v98
  v_fma_mix_f32 v121, v100, 1.0, v102 op_sel:[1,0,1] op_sel_hi:[1,0,1]
  v_and_b32 v27, 1, v27
  v_fma_mix_f32 v122, v101, 1.0, v103 op_sel:[0,0,0] op_sel_hi:[1,0,1]
  v_cmp_ne_u32 vcc, 0, v27
  v_fma_mix_f32 v123, v101, 1.0, v103 op_sel:[1,0,1] op_sel_hi:[1,0,1]
  v_max3_f32 v236, v120, v121, v238
  s_cbranch_vccnz psr_86
  s_branch psj_87
kvw_89:
  s_mov_b32 s22, s87
  s_cmp_eq_u32 s52, 0
  s_cselect_b32 s23, s87, s46
  s_cselect_b32 s55, 0, s55
  s_cselect_b32 s87, 1, 0
  s_cmp_eq_u32 s23, 0
  s_cbranch_scc1 kvok_90
  v_mov_b32 v236, 0
  s_mov_b32 s101, 0
wf_95:
  buffer_load_dword v237, v236, s[12:15], s79 offen sc1
  s_add_u32 s101, s101, 1
  s_cmp_gt_u32 s101, 131072
  s_cbranch_scc1 end0
  s_waitcnt vmcnt(0)
  v_readfirstlane_b32 s100, v237
  s_cmp_ge_u32 s100, s23
  s_cbranch_scc1 wf_96
  s_sleep 3
  s_branch wf_95
wf_96:
  s_cmp_eq_u32 s22, 0
  s_cbranch_scc1 kvok_90
  s_sub_u32 s21, s64, 1310720
  buffer_load_dwordx4 v[176:179], v16, s[28:31], s21 offen offset:0 sc1
  buffer_load_dwordx4 v[180:183], v16, s[28:31], s21 offen offset:1024 sc1
  buffer_load_dwordx4 v[184:187], v16, s[28:31], s21 offen offset:2048 sc1
  s_waitcnt vmcnt(0)
  s_branch kvok_90
fl_91:
  buffer_load_dword v94, v95, s[12:15], s79 offen sc1
  s_branch fl_92
last_79:
  v_mov_b32 v188, 0
  v_mov_b32 v189, 0
  v_mov_b32 v190, 0
  v_mov_b32 v191, 0
  v_mov_b32 v192, 0
  v_mov_b32 v193, 0
  v_mov_b32 v194, 0
  v_mov_b32 v195, 0
  v_mov_b32 v196, 0
  v_mov_b32 v197, 0
  v_mov_b32 v198, 0
  v_mov_b32 v199, 0
  s_sleep 4
  s_mov_b32 s54, 0
lv_97:
  buffer_load_dwordx4 v[144:147], v10, s[8:11], s81 offen offset:0 sc1
  buffer_load_dwordx4 v[148:151], v10, s[8:11], s81 offen offset:1024 sc1
  buffer_load_dwordx4 v[152:155], v10, s[8:11], s81 offen offset:2048 sc1
  s_add_u32 s54, s54, 1
  s_cmp_gt_u32 s54, 131072
  s_cbranch_scc1 end0
  s_waitcnt vmcnt(0)
  v_max3_u32 v27, v144, v146, v148
  v_max3_u32 v27, v27, v150, v152
  v_max3_u32 v27, v27, v154, v154
  v_cmp_eq_u32 vcc, -1, v27
  s_nop 1
  s_cbranch_vccnz lv_97
  v_smfmac_f32_16x16x64_bf16 v[188:191], v[144:147], a[180:187], v44
  v_smfmac_f32_16x16x64_bf16 v[192:195], v[144:147], a[204:211], v44
  v_smfmac_f32_16x16x64_bf16 v[196:199], v[144:147], a[228:235], v44
  v_smfmac_f32_16x16x64_bf16 v[188:191], v[148:151], a[188:195], v44
  v_smfmac_f32_16x16x64_bf16 v[192:195], v[148:151], a[212:219], v44
  v_smfmac_f32_16x16x64_bf16 v[196:199], v[148:151], a[236:243], v44
  v_smfmac_f32_16x16x64_bf16 v[188:191], v[152:155], a[196:203], v44
  v_smfmac_f32_16x16x64_bf16 v[192:195], v[152:155], a[220:227], v44
  v_smfmac_f32_16x16x64_bf16 v[196:199], v[152:155], a[244:251], v44
  s_nop 7
  v_mov_b32 v200, v196
  v_mov_b32 v201, v197
  v_mov_b32 v202, v198
  v_mov_b32 v203, v199
  v_permlane32_swap_b32 v188, v192
  v_permlane32_swap_b32 v189, v193
  v_permlane32_swap_b32 v190, v194
  v_permlane32_swap_b32 v191, v195
  v_permlane32_swap_b32 v196, v200
  v_permlane32_swap_b32 v197, v201
  v_permlane32_swap_b32 v198, v202
  v_permlane32_swap_b32 v199, v203
  v_pk_add_f32 v[188:189], v[188:189], v[192:193]
  v_pk_add_f32 v[190:191], v[190:191], v[194:195]
  v_pk_add_f32 v[196:197], v[196:197], v[200:201]
  v_pk_add_f32 v[198:199], v[198:199], v[202:203]
  v_cvt_pk_bf16_f32 v252, v188, v189
  v_cvt_pk_bf16_f32 v254, v196, v197
  v_cvt_pk_bf16_f32 v253, v190, v191
  v_cvt_pk_bf16_f32 v255, v198, v199
  s_nop 0
  v_permlane16_swap_b32 v252, v254
  v_permlane16_swap_b32 v253, v255
  v_min_u32 v252, -2, v252
  s_mov_b64 exec, s[76:77]
  buffer_store_dwordx4 v[252:255], v15, s[24:27], s57 offen sc1
  s_mov_b64 exec, -1
  s_branch chain_done
step_98:
  s_add_u32 s21, s52, 2
  s_and_b32 s21, s21, 3
  s_mul_i32 s82, s21, 540672
  s_add_u32 s21, s52, 3
  s_and_b32 s21, s21, 3
  s_lshl_b32 s83, s21, 15
  s_add_u32 s21, s52, 1
  s_and_b32 s22, s21, 3
  s_lshl_b32 s3, s22, 15
  s_mul_i32 s80, s21, 393216
  s_add_u32 s46, s21, 1
  s_min_u32 s46, s46, 64
  s_mul_i32 s85, s52, 98304
  s_mul_i32 s57, s52, 327680
  s_add_u32 s57, s57, 42991616

  s_bfe_u32 s88, s52, 0x10002
  s_add_u32 s78, s81, 278528
  s_max_u32 s21, s52, 1
  s_sub_u32 s21, s21, 1
  s_cmp_lt_u32 s52, 98
  s_cselect_b32 s66, s65, 0x80000000
  s_cselect_b32 s68, 15, 1
  s_cmp_ge_u32 s52, 99
  s_cselect_b32 s66, s90, s66
  s_cselect_b32 s67, s52, s21
  v_mov_b32 v52, 0
  v_mov_b32 v53, 0
  v_mov_b32 v54, 0
  v_mov_b32 v55, 0
  v_mov_b32 v56, 0
  v_mov_b32 v57, 0
  v_mov_b32 v58, 0
  v_mov_b32 v59, 0
  v_mov_b32 v60, 0
  v_mov_b32 v61, 0
  v_mov_b32 v62, 0
  v_mov_b32 v63, 0
  v_mov_b32 v64, 0
  v_mov_b32 v65, 0
  v_mov_b32 v66, 0
  v_mov_b32 v67, 0
  v_mov_b32 v68, 0
  v_mov_b32 v69, 0
  v_mov_b32 v70, 0
  v_mov_b32 v71, 0
  v_mov_b32 v72, 0
  v_mov_b32 v73, 0
  v_mov_b32 v74, 0
  v_mov_b32 v75, 0
  v_mov_b32 v76, 0
  v_mov_b32 v77, 0
  v_mov_b32 v78, 0
  v_mov_b32 v79, 0
  v_mov_b32 v80, 0
  v_mov_b32 v81, 0
  v_mov_b32 v82, 0
  v_mov_b32 v83, 0
  v_mov_b32 v84, 0
  v_mov_b32 v85, 0
  v_mov_b32 v86, 0
  v_mov_b32 v87, 0
  s_sleep 8
  v_readfirstlane_b32 s21, v94
  s_cmp_lt_u32 s21, s46
  s_cselect_b32 s55, s55, 0
  s_cmp_lt_i32 s55, 0
  s_cbranch_scc1 fl_102
fl_103:
  s_mov_b32 s54, 0
  buffer_load_dwordx4 v[32:35], v4, s[4:7], s84 offen offset:0 sc1
  buffer_load_dwordx4 v[36:39], v4, s[4:7], s84 offen offset:1024 sc1
  buffer_load_dwordx4 v[40:43], v4, s[4:7], s84 offen offset:2048 sc1
  s_waitcnt vmcnt(3)
  v_mov_b32 v176, v160
  v_mov_b32 v177, v161
  v_mov_b32 v178, v162
  v_mov_b32 v179, v163
  v_mov_b32 v180, v164
  v_mov_b32 v181, v165
  v_mov_b32 v182, v166
  v_mov_b32 v183, v167
  v_mov_b32 v184, v48
  v_mov_b32 v185, v49
  v_mov_b32 v186, v50
  v_mov_b32 v187, v51
  s_waitcnt vmcnt(0)
  v_bitop3_b32 v27, v35, v39, v43 bitop3:0x80
  v_perm_b32 v35, v39, v35, s89
  v_cmp_gt_u32 vcc, 0x48000000, v27
  v_mov_b32 v39, v42
  s_cbranch_vccnz pm_100
A1_19:
  v_smfmac_f32_16x16x32_f16 v[52:55], v[40:41], a[16:19], v44
  v_smfmac_f32_16x16x32_f16 v[64:67], v[40:41], a[76:79], v44
  v_smfmac_f32_16x16x32_f16 v[56:59], v[40:41], a[36:39], v44
  v_smfmac_f32_16x16x32_f16 v[68:71], v[40:41], a[96:99], v44
  v_smfmac_f32_16x16x64_f16 v[52:55], v[32:35], a[0:7], v44
  v_smfmac_f32_16x16x64_f16 v[52:55], v[36:39], a[8:15], v44
  v_smfmac_f32_16x16x64_f16 v[64:67], v[32:35], a[60:67], v44
  v_smfmac_f32_16x16x64_f16 v[64:67], v[36:39], a[68:75], v44
  v_smfmac_f32_16x16x32_f16 v[60:63], v[40:41], a[56:59], v44
  v_cvt_pk_f16_f32 v52, v52, v53
  v_cvt_pk_f16_f32 v53, v54, v55
  v_smfmac_f32_16x16x32_f16 v[72:75], v[40:41], a[116:119], v44
  v_smfmac_f32_16x16x32_f16 v[76:79], v[40:41], a[136:139], v44
  v_cvt_pk_f16_f32 v64, v64, v65
  v_cvt_pk_f16_f32 v65, v66, v67
  s_nop 0
  v_smfmac_f32_16x16x64_f16 v[56:59], v[32:35], a[20:27], v44
  v_permlane32_swap_b32 v52, v64
  v_smfmac_f32_16x16x64_f16 v[56:59], v[36:39], a[28:35], v44
  v_permlane32_swap_b32 v53, v65
  v_pk_add_f16 v52, v52, v64
  v_smfmac_f32_16x16x64_f16 v[68:71], v[32:35], a[80:87], v44
  v_pk_add_f16 v53, v53, v65
  v_smfmac_f32_16x16x64_f16 v[68:71], v[36:39], a[88:95], v44
  ds_write_b64 v5, v[52:53] offset:0
  v_smfmac_f32_16x16x32_f16 v[80:83], v[40:41], a[156:159], v44
  v_cvt_pk_f16_f32 v56, v56, v57
  v_cvt_pk_f16_f32 v57, v58, v59
  v_smfmac_f32_16x16x32_f16 v[84:87], v[40:41], a[176:179], v44
  v_cvt_pk_f16_f32 v68, v68, v69
  v_cvt_pk_f16_f32 v69, v70, v71
  s_nop 0
  v_smfmac_f32_16x16x64_f16 v[60:63], v[32:35], a[40:47], v44
  v_permlane32_swap_b32 v56, v68
  v_smfmac_f32_16x16x64_f16 v[60:63], v[36:39], a[48:55], v44
  v_permlane32_swap_b32 v57, v69
  v_pk_add_f16 v56, v56, v68
  v_smfmac_f32_16x16x64_f16 v[72:75], v[32:35], a[100:107], v44
  v_pk_add_f16 v57, v57, v69
  v_smfmac_f32_16x16x64_f16 v[72:75], v[36:39], a[108:115], v44
  ds_write_b64 v5, v[56:57] offset:640
  v_smfmac_f32_16x16x64_f16 v[76:79], v[32:35], a[120:127], v44
  v_cvt_pk_f16_f32 v60, v60, v61
  v_cvt_pk_f16_f32 v61, v62, v63
  v_smfmac_f32_16x16x64_f16 v[76:79], v[36:39], a[128:135], v44
  v_cvt_pk_f16_f32 v72, v72, v73
  v_cvt_pk_f16_f32 v73, v74, v75
  s_nop 0
  v_smfmac_f32_16x16x64_f16 v[80:83], v[32:35], a[140:147], v44
  v_permlane32_swap_b32 v60, v72
  v_smfmac_f32_16x16x64_f16 v[80:83], v[36:39], a[148:155], v44
  v_permlane32_swap_b32 v61, v73
  v_pk_add_f16 v60, v60, v72
  v_smfmac_f32_16x16x64_f16 v[84:87], v[32:35], a[160:167], v44
  v_pk_add_f16 v61, v61, v73
  v_smfmac_f32_16x16x64_f16 v[84:87], v[36:39], a[168:175], v44
  ds_write_b64 v5, v[60:61] offset:1280
  v_cvt_pk_f16_f32 v76, v76, v77
  v_cvt_pk_f16_f32 v77, v78, v79
  v_cvt_pk_f16_f32 v80, v80, v81
  v_cvt_pk_f16_f32 v81, v82, v83
  s_nop 0
  v_permlane32_swap_b32 v76, v80
  v_permlane32_swap_b32 v77, v81
  v_pk_add_f16 v76, v76, v80
  v_pk_add_f16 v77, v77, v81
  ds_write_b64 v5, v[76:77] offset:1920
  v_cvt_pk_f16_f32 v84, v84, v85
  v_cvt_pk_f16_f32 v85, v86, v87
  ds_write_b64 v5, v[84:85] offset:2560
  s_waitcnt lgkmcnt(0) vmcnt(0)
  s_barrier
  s_lshr_b32 s21, 3, s20
  s_bitcmp1_b32 s21, 0
  s_cbranch_scc0 bw_106
  ds_read_b64_tr_b16 v[104:105], v45 offset:0
  ds_read_b64_tr_b16 v[106:107], v45 offset:3200
  ds_read_b64_tr_b16 v[108:109], v45 offset:640
  ds_read_b64_tr_b16 v[110:111], v45 offset:3840
  ds_read_b64_tr_b16 v[112:113], v45 offset:1280
  ds_read_b64_tr_b16 v[114:115], v45 offset:4480
  s_waitcnt lgkmcnt(4)
  v_fma_mix_f32 v120, v104, 1.0, v106 op_sel:[0,0,0] op_sel_hi:[1,0,1]
  v_fma_mix_f32 v121, v104, 1.0, v106 op_sel:[1,0,1] op_sel_hi:[1,0,1]
  v_fma_mix_f32 v122, v105, 1.0, v107 op_sel:[0,0,0] op_sel_hi:[1,0,1]
  v_fma_mix_f32 v123, v105, 1.0, v107 op_sel:[1,0,1] op_sel_hi:[1,0,1]
  v_add_f32_dpp v124, v120, v120 row_ror:8 row_mask:0xf bank_mask:0xf
  v_add_f32_dpp v125, v121, v121 row_ror:8 row_mask:0xf bank_mask:0xf
  v_add_f32_dpp v126, v122, v122 row_ror:8 row_mask:0xf bank_mask:0xf
  v_add_f32_dpp v127, v123, v123 row_ror:8 row_mask:0xf bank_mask:0xf
  v_cvt_pk_bf16_f32 v212, v124, v125
  v_cvt_pk_bf16_f32 v213, v126, v127
  s_waitcnt lgkmcnt(2)
  v_fma_mix_f32 v120, v108, 1.0, v110 op_sel:[0,0,0] op_sel_hi:[1,0,1]
  v_fma_mix_f32 v121, v108, 1.0, v110 op_sel:[1,0,1] op_sel_hi:[1,0,1]
  v_fma_mix_f32 v122, v109, 1.0, v111 op_sel:[0,0,0] op_sel_hi:[1,0,1]
  v_fma_mix_f32 v123, v109, 1.0, v111 op_sel:[1,0,1] op_sel_hi:[1,0,1]
  v_add_f32_dpp v124, v120, v120 row_ror:8 row_mask:0xf bank_mask:0xf
  v_add_f32_dpp v125, v121, v121 row_ror:8 row_mask:0xf bank_mask:0xf
  v_add_f32_dpp v126, v122, v122 row_ror:8 row_mask:0xf bank_mask:0xf
  v_add_f32_dpp v127, v123, v123 row_ror:8 row_mask:0xf bank_mask:0xf
  v_cvt_pk_bf16_f32 v214, v124, v125
  v_cvt_pk_bf16_f32 v215, v126, v127
  s_waitcnt lgkmcnt(0)
  v_fma_mix_f32 v120, v112, 1.0, v114 op_sel:[0,0,0] op_sel_hi:[1,0,1]
  v_fma_mix_f32 v121, v112, 1.0, v114 op_sel:[1,0,1] op_sel_hi:[1,0,1]
  v_fma_mix_f32 v122, v113, 1.0, v115 op_sel:[0,0,0] op_sel_hi:[1,0,1]
  v_fma_mix_f32 v123, v113, 1.0, v115 op_sel:[1,0,1] op_sel_hi:[1,0,1]
  v_mfma_f32_16x16x32_bf16 v[96:99], v[168:171], v[212:215], 0
  v_add_f32_dpp v124, v120, v120 row_ror:8 row_mask:0xf bank_mask:0xf
  v_add_f32_dpp v125, v121, v121 row_ror:8 row_mask:0xf bank_mask:0xf
  v_add_f32_dpp v126, v122, v122 row_ror:8 row_mask:0xf bank_mask:0xf
  v_add_f32_dpp v127, v123, v123 row_ror:8 row_mask:0xf bank_mask:0xf
  v_cvt_pk_bf16_f32 v216, v124, v125
  v_cvt_pk_bf16_f32 v217, v126, v127
  s_nop 1
  v_mfma_f32_16x16x32_bf16 v[96:99], v[172:175], v[216:219], v[96:99]
  s_mov_b64 exec, s[74:75]
  s_nop 6
  v_cvt_pk_f16_f32 v100, v96, v97
  v_cvt_pk_f16_f32 v101, v98, v99
  v_and_or_b32 v100, v100, -2, s88
  s_cmp_eq_u32 s53, 1
  s_cbranch_scc1 si_107
  buffer_store_dwordx2 v[100:101], v7, s[8:11], s81 offen sc1
  s_branch si_108
si_107:
  buffer_store_dwordx2 v[100:101], v7, s[8:11], s81 offen
si_108:
  s_mov_b64 exec, -1
  s_branch bw_105
bw_106:
  s_lshr_b32 s21, 4, s20
  s_bitcmp1_b32 s21, 0
  s_cbranch_scc0 bw_109
  ds_read_b64_tr_b16 v[104:105], v6 offset:0
  ds_read_b64_tr_b16 v[106:107], v6 offset:3200
  ds_read_b64_tr_b16 v[108:109], v6 offset:6400
  ds_read_b64_tr_b16 v[110:111], v6 offset:9600
  ds_read_b64_tr_b16 v[112:113], v6 offset:640
  ds_read_b64_tr_b16 v[114:115], v6 offset:3840
  ds_read_b64_tr_b16 v[116:117], v6 offset:7040
  ds_read_b64_tr_b16 v[118:119], v6 offset:10240
  ds_read_b64_tr_b16 v[120:121], v6 offset:1280
  ds_read_b64_tr_b16 v[122:123], v6 offset:4480
  ds_read_b64_tr_b16 v[124:125], v6 offset:7680
  ds_read_b64_tr_b16 v[126:127], v6 offset:10880
  s_waitcnt lgkmcnt(8)
  v_pk_add_f16 v104, v104, v106
  v_pk_add_f16 v108, v108, v110
  v_pk_add_f16 v105, v105, v107
  v_pk_add_f16 v109, v109, v111
  v_fma_mix_f32 v128, v104, 1.0, v108 op_sel:[0,0,0] op_sel_hi:[1,0,1]
  v_fma_mix_f32 v129, v104, 1.0, v108 op_sel:[1,0,1] op_sel_hi:[1,0,1]
  v_fma_mix_f32 v130, v105, 1.0, v109 op_sel:[0,0,0] op_sel_hi:[1,0,1]
  v_fma_mix_f32 v131, v105, 1.0, v109 op_sel:[1,0,1] op_sel_hi:[1,0,1]
  v_cvt_pk_bf16_f32 v212, v128, v129
  v_cvt_pk_bf16_f32 v213, v130, v131
  s_waitcnt lgkmcnt(4)
  v_pk_add_f16 v112, v112, v114
  v_pk_add_f16 v116, v116, v118
  v_pk_add_f16 v113, v113, v115
  v_pk_add_f16 v117, v117, v119
  v_fma_mix_f32 v128, v112, 1.0, v116 op_sel:[0,0,0] op_sel_hi:[1,0,1]
  v_fma_mix_f32 v129, v112, 1.0, v116 op_sel:[1,0,1] op_sel_hi:[1,0,1]
  v_fma_mix_f32 v130, v113, 1.0, v117 op_sel:[0,0,0] op_sel_hi:[1,0,1]
  v_fma_mix_f32 v131, v113, 1.0, v117 op_sel:[1,0,1] op_sel_hi:[1,0,1]
  v_cvt_pk_bf16_f32 v214, v128, v129
  v_cvt_pk_bf16_f32 v215, v130, v131
  s_waitcnt lgkmcnt(0)
  v_pk_add_f16 v120, v120, v122
  v_pk_add_f16 v124, v124, v126
  v_pk_add_f16 v121, v121, v123
  v_pk_add_f16 v125, v125, v127
  v_fma_mix_f32 v128, v120, 1.0, v124 op_sel:[0,0,0] op_sel_hi:[1,0,1]
  v_fma_mix_f32 v129, v120, 1.0, v124 op_sel:[1,0,1] op_sel_hi:[1,0,1]
  v_mfma_f32_16x16x32_bf16 v[96:99], v[212:215], v[212:215], 0
  v_fma_mix_f32 v130, v121, 1.0, v125 op_sel:[0,0,0] op_sel_hi:[1,0,1]
  v_fma_mix_f32 v131, v121, 1.0, v125 op_sel:[1,0,1] op_sel_hi:[1,0,1]
  v_cvt_pk_bf16_f32 v216, v128, v129
  v_cvt_pk_bf16_f32 v217, v130, v131
  s_nop 1
  v_mfma_f32_16x16x32_bf16 v[96:99], v[216:219], v[216:219], v[96:99]
  s_mov_b64 exec, s[74:75]
  s_nop 6
  v_cvt_pk_f16_f32 v100, v96, v97
  v_cvt_pk_f16_f32 v101, v98, v99
  v_and_or_b32 v100, v100, -2, s88
  s_cmp_eq_u32 s53, 1
  s_cbranch_scc1 si_110
  buffer_store_dwordx2 v[100:101], v7, s[8:11], s81 offen sc1
  s_branch si_111
si_110:
  buffer_store_dwordx2 v[100:101], v7, s[8:11], s81 offen
si_111:
  s_mov_b64 exec, -1
  s_branch bw_105
bw_109:
  s_lshr_b32 s21, 8, s20
  s_bitcmp1_b32 s21, 0
  s_cbranch_scc0 bw_112
  ds_read_b64_tr_b16 v[96:97], v6 offset:1920
  ds_read_b64_tr_b16 v[98:99], v6 offset:5120
  ds_read_b64_tr_b16 v[100:101], v6 offset:8320
  ds_read_b64_tr_b16 v[102:103], v6 offset:11520
  ds_read_b64_tr_b16 v[104:105], v6 offset:2560
  ds_read_b64_tr_b16 v[106:107], v6 offset:5760
  ds_read_b64_tr_b16 v[108:109], v6 offset:8960
  ds_read_b64_tr_b16 v[110:111], v6 offset:12160
  s_waitcnt lgkmcnt(4)
  v_pk_add_f16 v96, v96, v98
  v_pk_add_f16 v100, v100, v102
  v_pk_add_f16 v97, v97, v99
  v_pk_add_f16 v101, v101, v103
  v_fma_mix_f32 v112, v96, 1.0, v100 op_sel:[0,0,0] op_sel_hi:[1,0,1]
  v_fma_mix_f32 v113, v96, 1.0, v100 op_sel:[1,0,1] op_sel_hi:[1,0,1]
  v_fma_mix_f32 v114, v97, 1.0, v101 op_sel:[0,0,0] op_sel_hi:[1,0,1]
  v_fma_mix_f32 v115, v97, 1.0, v101 op_sel:[1,0,1] op_sel_hi:[1,0,1]
  v_cvt_pk_bf16_f32 v90, v112, v113
  v_cvt_pk_bf16_f32 v91, v114, v115
  v_min_u32 v90, -2, v90
  s_cmp_eq_u32 s53, 1
  s_cbranch_scc1 si_113
  buffer_store_dwordx2 v[90:91], v24, s[8:11], s81 offen sc1
  s_branch si_114
si_113:
  buffer_store_dwordx2 v[90:91], v24, s[8:11], s81 offen
si_114:
  s_waitcnt lgkmcnt(0)
  v_pk_add_f16 v104, v104, v106
  v_pk_add_f16 v108, v108, v110
  v_pk_add_f16 v105, v105, v107
  v_pk_add_f16 v109, v109, v111
  v_fma_mix_f32 v112, v104, 1.0, v108 op_sel:[0,0,0] op_sel_hi:[1,0,1]
  v_fma_mix_f32 v113, v104, 1.0, v108 op_sel:[1,0,1] op_sel_hi:[1,0,1]
  v_fma_mix_f32 v114, v105, 1.0, v109 op_sel:[0,0,0] op_sel_hi:[1,0,1]
  v_fma_mix_f32 v115, v105, 1.0, v109 op_sel:[1,0,1] op_sel_hi:[1,0,1]
  v_add_f32_dpp v116, v112, v112 row_ror:8 row_mask:0xf bank_mask:0xf
  v_add_f32_dpp v117, v113, v113 row_ror:8 row_mask:0xf bank_mask:0xf
  v_add_f32_dpp v118, v114, v114 row_ror:8 row_mask:0xf bank_mask:0xf
  v_add_f32_dpp v119, v115, v115 row_ror:8 row_mask:0xf bank_mask:0xf
  v_cvt_pk_bf16_f32 v92, v116, v117
  v_cvt_pk_bf16_f32 v93, v118, v119
  v_min_u32 v92, -2, v92
  s_mov_b64 exec, s[60:61]
  s_cmp_eq_u32 s53, 1
  s_cbranch_scc1 si_115
  buffer_store_dwordx2 v[92:93], v23, s[8:11], s78 offen sc1
  s_branch si_116
si_115:
  buffer_store_dwordx2 v[92:93], v23, s[8:11], s78 offen
si_116:
  s_mov_b64 exec, -1
  s_branch bw_105
bw_112:
bw_105:
  s_cmp_eq_u32 s52, 63
  s_cbranch_scc1 last_99
  s_mov_b32 s54, 0
pv_117:
  buffer_load_dwordx4 v[144:147], v10, s[8:11], s81 offen offset:0 sc1
  buffer_load_dwordx4 v[148:151], v10, s[8:11], s81 offen offset:1024 sc1
  buffer_load_dwordx4 v[152:155], v10, s[8:11], s81 offen offset:2048 sc1
  v_mov_b32 v188, 0
  v_mov_b32 v189, 0
  v_mov_b32 v190, 0
  v_mov_b32 v191, 0
  v_mov_b32 v192, 0
  v_mov_b32 v193, 0
  v_mov_b32 v194, 0
  v_mov_b32 v195, 0
  v_mov_b32 v196, 0
  v_mov_b32 v197, 0
  v_mov_b32 v198, 0
  v_mov_b32 v199, 0
  s_add_u32 s54, s54, 1
  s_cmp_gt_u32 s54, 131072
  s_cbranch_scc1 end0
  s_waitcnt vmcnt(0)
  v_max3_u32 v27, v144, v146, v148
  v_max3_u32 v27, v27, v150, v152
  v_max3_u32 v27, v27, v154, v154
  v_cmp_eq_u32 vcc, -1, v27
  s_nop 1
  s_cbranch_vccnz pv_117
  buffer_load_dwordx2 v[248:249], v9, s[8:11], s81 offen sc1
  buffer_load_dwordx4 v[112:115], v8, s[8:11], s81 offen offset:0 sc1
  buffer_load_dwordx4 v[116:119], v8, s[8:11], s81 offen offset:1024 sc1
  v_smfmac_f32_16x16x64_bf16 v[188:191], v[144:147], a[180:187], v44
  v_smfmac_f32_16x16x64_bf16 v[192:195], v[144:147], a[204:211], v44
  v_smfmac_f32_16x16x64_bf16 v[196:199], v[144:147], a[228:235], v44
  v_smfmac_f32_16x16x64_bf16 v[188:191], v[148:151], a[188:195], v44
  v_smfmac_f32_16x16x64_bf16 v[192:195], v[148:151], a[212:219], v44
  v_smfmac_f32_16x16x64_bf16 v[196:199], v[148:151], a[236:243], v44
  v_smfmac_f32_16x16x64_bf16 v[188:191], v[152:155], a[196:203], v44
  v_smfmac_f32_16x16x64_bf16 v[192:195], v[152:155], a[220:227], v44
  v_smfmac_f32_16x16x64_bf16 v[196:199], v[152:155], a[244:251], v44
  v_readfirstlane_b32 s21, v94
  s_add_u32 s22, s46, 3
  s_min_u32 s22, s22, 64
  s_sub_u32 s55, s21, s22
  s_sub_u32 s56, s21, s46
  s_cmp_lt_i32 s56, 0
  s_cbranch_scc1 kvw_120
kvok_121:
  s_waitcnt vmcnt(2)
  v_xor_b32 v96, s88, v248
  s_nop 0
  v_permlane16_swap_b32 v248, v249
  v_fma_mix_f32 v250, v248, 1.0, v249 op_sel:[0,0,0] op_sel_hi:[1,0,1]
  v_fma_mix_f32 v251, v248, 1.0, v249 op_sel:[1,0,1] op_sel_hi:[1,0,1]
  v_mov_b32 v248, v250
  v_mov_b32 v249, v251
  s_nop 0
  v_permlane32_swap_b32 v248, v250
  v_permlane32_swap_b32 v249, v251
  v_pk_add_f32 v[124:125], v[248:249], v[250:251]
  v_max_f32 v238, v124, v125
  s_waitcnt vmcnt(0)
  v_pk_add_f16 v100, v112, v116
  v_pk_add_f16 v102, v114, v118
  v_pk_add_f16 v101, v113, v117
  v_pk_add_f16 v103, v115, v119
  v_permlane32_swap_b32 v100, v102
  v_bitop3_b32 v97, v112, v114, s88 bitop3:0x7e
  v_permlane32_swap_b32 v101, v103
  v_bitop3_b32 v98, v116, v118, s88 bitop3:0x7e
  v_fma_mix_f32 v120, v100, 1.0, v102 op_sel:[0,0,0] op_sel_hi:[1,0,1]
  v_or3_b32 v27, v96, v97, v98
  v_fma_mix_f32 v121, v100, 1.0, v102 op_sel:[1,0,1] op_sel_hi:[1,0,1]
  v_and_b32 v27, 1, v27
  v_fma_mix_f32 v122, v101, 1.0, v103 op_sel:[0,0,0] op_sel_hi:[1,0,1]
  v_cmp_ne_u32 vcc, 0, v27
  v_fma_mix_f32 v123, v101, 1.0, v103 op_sel:[1,0,1] op_sel_hi:[1,0,1]
  v_max3_f32 v236, v120, v121, v238
  s_cbranch_vccnz psr_118
psj_119:
  v_max3_f32 v236, v236, v122, v123
  s_nop 1
  v_max_f32_dpp v236, v236, v236 row_ror:8 row_mask:0xf bank_mask:0xf
  v_mov_b32 v237, v236
  s_nop 1
  v_permlane32_swap_b32 v236, v237
  v_max_f32 v236, v236, v237
  v_mov_b32 v237, v236
  s_nop 1
  v_permlane16_swap_b32 v236, v237
  v_max_f32 v236, v236, v237
  v_mul_f32 v236, s86, v236
  v_fma_f32 v120, v120, s86, -v236
  v_fma_f32 v121, v121, s86, -v236
  buffer_load_dwordx4 v[160:163], v17, s[28:31], s64 offen offset:0 sc1
  v_fma_f32 v122, v122, s86, -v236
  v_fma_f32 v123, v123, s86, -v236
  buffer_load_dwordx4 v[164:167], v16, s[28:31], s64 offen offset:1024 sc1
  v_fma_f32 v124, v124, s86, -v236
  v_fma_f32 v125, v125, s86, -v236
  buffer_load_dwordx4 v[48:51], v26, s[28:31], s64 offen offset:2048 sc1
  v_exp_f32 v120, v120
  v_exp_f32 v121, v121
  s_lshr_b32 s21, 3, s20
  s_bitcmp1_b32 s21, 0
  s_cbranch_scc0 bw_123
  buffer_load_dwordx4 v[168:171], v18, s[16:19], s80 offen sc1
  s_branch bw_122
bw_123:
  s_lshr_b32 s21, 4, s20
  s_bitcmp1_b32 s21, 0
  s_cbranch_scc0 bw_124
  s_branch bw_122
bw_124:
  s_lshr_b32 s21, 8, s20
  s_bitcmp1_b32 s21, 0
  s_cbranch_scc0 bw_125
  s_branch bw_122
bw_125:
bw_122:
  v_exp_f32 v122, v122
  s_lshr_b32 s21, 3, s20
  s_bitcmp1_b32 s21, 0
  s_cbranch_scc0 bw_127
  buffer_load_dwordx2 v[172:173], v20, s[16:19], s80 offen sc1
  s_branch bw_126
bw_127:
  s_lshr_b32 s21, 4, s20
  s_bitcmp1_b32 s21, 0
  s_cbranch_scc0 bw_128
  s_branch bw_126
bw_128:
  s_lshr_b32 s21, 8, s20
  s_bitcmp1_b32 s21, 0
  s_cbranch_scc0 bw_129
  s_branch bw_126
bw_129:
bw_126:
  v_exp_f32 v123, v123
  s_lshr_b32 s21, 3, s20
  s_bitcmp1_b32 s21, 0
  s_cbranch_scc0 bw_131
  s_branch bw_130
bw_131:
  s_lshr_b32 s21, 4, s20
  s_bitcmp1_b32 s21, 0
  s_cbranch_scc0 bw_132
  s_branch bw_130
bw_132:
  s_lshr_b32 s21, 8, s20
  s_bitcmp1_b32 s21, 0
  s_cbranch_scc0 bw_133
  v_mov_b32 v240, s67
  v_mov_b32 v241, s67
  s_mov_b64 exec, s[68:69]
  buffer_store_dwordx2 v[240:241], v88, s[12:15], s66 offen sc1
  s_mov_b64 exec, -1
  s_branch bw_130
bw_133:
bw_130:
  v_exp_f32 v124, v124
  s_cmp_lt_i32 s55, 0
  s_cbranch_scc1 fl_134
fl_135:
  v_exp_f32 v125, v125
  v_cvt_pk_bf16_f32 v220, v120, v121
  v_cvt_pk_bf16_f32 v221, v122, v123
  v_cvt_pk_bf16_f32 v224, v124, v125
  v_mov_b32_dpp v222, v220 row_ror:8 row_mask:0xf bank_mask:0xf
  v_mov_b32_dpp v223, v221 row_ror:8 row_mask:0xf bank_mask:0xf
  v_mov_b32_dpp v225, v224 row_ror:8 row_mask:0xf bank_mask:0xf
  v_cvt_pk_bf16_f32 v228, v188, v189
  v_mfma_f32_16x16x32_bf16 v[200:203], v[176:179], v[220:223], 0
  v_cvt_pk_bf16_f32 v229, v190, v191
  v_cvt_pk_bf16_f32 v230, v192, v193
  v_mfma_f32_16x16x32_bf16 v[204:207], v[180:183], v[220:223], 0
  v_cvt_pk_bf16_f32 v231, v194, v195
  v_cvt_pk_bf16_f32 v232, v196, v197
  v_mfma_f32_16x16x32_bf16 v[208:211], v[184:187], v[220:223], 0
  v_cvt_pk_bf16_f32 v233, v198, v199
  v_add_f32 v126, v120, v121
  v_mfma_f32_16x16x32_bf16 v[200:203], v[228:231], v[224:227], v[200:203]
  v_add_f32 v127, v122, v123
  v_add_f32 v128, v124, v125
  v_mfma_f32_16x16x32_bf16 v[204:207], v[230:233], v[224:227], v[204:207]
  v_add_f32 v236, v126, v127
  v_fmac_f32 v236, v128, v89
  v_mfma_f32_16x16x32_bf16 v[208:211], v[232:235], v[224:227], v[208:211]
  s_nop 0
  v_add_f32_dpp v236, v236, v236 row_ror:8 row_mask:0xf bank_mask:0xf
  v_mov_b32 v237, v236
  ds_write_b128 v11, v[200:203] offset:0
  s_nop 0
  v_permlane32_swap_b32 v236, v237
  v_add_f32 v236, v236, v237
  v_mov_b32 v237, v236
  ds_write_b128 v11, v[204:207] offset:1024
  s_nop 0
  v_permlane16_swap_b32 v236, v237
  v_add_f32 v236, v236, v237
  v_rcp_f32 v236, v236
  ds_write_b128 v11, v[208:211] offset:2048
  s_mov_b64 exec, 0xff
  ds_write_b32 v242, v236
  s_mov_b64 exec, -1
  s_waitcnt lgkmcnt(0)
  s_barrier
  s_lshr_b32 s21, 7, s20
  s_bitcmp1_b32 s21, 0
  s_cbranch_scc0 bw_137
  ds_read_b128 v[104:107], v243
  ds_read_b64 v[96:97], v12 offset:0
  ds_read_b64 v[98:99], v12 offset:3072
  ds_read_b64 v[100:101], v12 offset:6144
  ds_read_b64 v[102:103], v12 offset:9216
  s_waitcnt lgkmcnt(2)
  v_pk_mul_f32 v[96:97], v[96:97], v[104:105] op_sel_hi:[1,0]
  v_pk_fma_f32 v[96:97], v[98:99], v[104:105], v[96:97] op_sel:[0,1,0] op_sel_hi:[1,1,1]
  s_waitcnt lgkmcnt(0)
  v_pk_fma_f32 v[96:97], v[100:101], v[106:107], v[96:97] op_sel_hi:[1,0,1]
  v_pk_fma_f32 v[96:97], v[102:103], v[106:107], v[96:97] op_sel:[0,1,0] op_sel_hi:[1,1,1]
  v_cvt_pk_f16_f32 v100, v96, v97
  v_perm_b32 v100, s91, v100, v14
  buffer_atomic_pk_add_f16 v100, v13, s[4:7], s3 offen
  s_branch bw_136
bw_137:
  s_lshr_b32 s21, 8, s20
  s_bitcmp1_b32 s21, 0
  s_cbranch_scc0 bw_138
  v_mov_b32 v28, -1
  v_mov_b32 v29, -1
  s_cmp_eq_u32 s53, 1
  s_cbranch_scc1 si_139
  buffer_store_dwordx2 v[28:29], v24, s[8:11], s82 offen sc1
  s_branch si_140
si_139:
  buffer_store_dwordx2 v[28:29], v24, s[8:11], s82 offen
si_140:
  s_mov_b64 exec, s[60:61]
  s_add_u32 s22, s82, 278528
  s_cmp_eq_u32 s53, 1
  s_cbranch_scc1 si_141
  buffer_store_dwordx2 v[28:29], v23, s[8:11], s22 offen sc1
  s_branch si_142
si_141:
  buffer_store_dwordx2 v[28:29], v23, s[8:11], s22 offen
si_142:
  s_and_b32 s21, s52, 7
  s_cmp_lg_u32 s21, s50
  s_cbranch_scc1 zm_143
  s_mov_b64 exec, s[70:71]
  buffer_store_dwordx4 v[156:159], v13, s[4:7], s83 offen sc1
zm_143:
  s_mov_b64 exec, -1
  s_branch bw_136
bw_138:
bw_136:
  s_lshr_b32 s21, 4, s20
  s_bitcmp1_b32 s21, 0
  s_cbranch_scc0 bw_145
  s_mov_b64 exec, s[62:63]
  buffer_store_dwordx4 v[212:215], v21, s[24:27], s85 offen sc1
  buffer_store_dwordx2 v[216:217], v23, s[24:27], s85 offen sc1
  s_mov_b64 exec, -1
  s_branch bw_144
bw_145:
bw_144:
  v_mov_b32 v200, v196
  v_mov_b32 v201, v197
  v_mov_b32 v202, v198
  v_mov_b32 v203, v199
  v_permlane32_swap_b32 v188, v192
  v_permlane32_swap_b32 v189, v193
  v_permlane32_swap_b32 v190, v194
  v_permlane32_swap_b32 v191, v195
  v_permlane32_swap_b32 v196, v200
  v_permlane32_swap_b32 v197, v201
  v_permlane32_swap_b32 v198, v202
  v_permlane32_swap_b32 v199, v203
  v_pk_add_f32 v[188:189], v[188:189], v[192:193]
  v_pk_add_f32 v[190:191], v[190:191], v[194:195]
  v_pk_add_f32 v[196:197], v[196:197], v[200:201]
  v_pk_add_f32 v[198:199], v[198:199], v[202:203]
  v_cvt_pk_bf16_f32 v252, v188, v189
  v_cvt_pk_bf16_f32 v254, v196, v197
  v_cvt_pk_bf16_f32 v253, v190, v191
  v_cvt_pk_bf16_f32 v255, v198, v199
  s_nop 0
  v_permlane16_swap_b32 v252, v254
  v_permlane16_swap_b32 v253, v255
  v_min_u32 v252, -2, v252
  s_mov_b64 exec, s[76:77]
  buffer_store_dwordx4 v[252:255], v15, s[24:27], s57 offen sc1
  s_mov_b64 exec, -1
  s_add_u32 s64, s64, 1310720
  s_add_u32 s52, s52, 1
  s_and_b32 s21, s52, 3
  s_mul_i32 s81, s21, 540672
  s_lshl_b32 s84, s21, 15
  s_branch step_98
fl_102:
  buffer_load_dword v94, v95, s[12:15], s79 offen sc1
  s_branch fl_103
pm_100:
  s_cmp_gt_u32 s52, 3
  s_cbranch_scc1 op_146
  v_readfirstlane_b32 s21, v94
  s_cmp_ge_u32 s21, s46
  s_cbranch_scc1 op_146
  buffer_load_dword v94, v95, s[12:15], s79 offen sc1
  s_waitcnt vmcnt(0)
  v_readfirstlane_b32 s21, v94
  s_add_u32 s22, s46, 3
  s_min_u32 s22, s22, 64
  s_sub_u32 s55, s21, s22
  s_sub_u32 s56, s21, s46
  s_cmp_gt_u32 s21, s52
  s_cselect_b32 s21, s87, 0
  s_cmp_eq_u32 s21, 0
  s_cbranch_scc1 op_146
  s_mov_b32 s87, 0
  s_sub_u32 s21, s64, 1310720
  buffer_load_dwordx4 v[176:179], v16, s[28:31], s21 offen offset:0 sc1
  buffer_load_dwordx4 v[180:183], v16, s[28:31], s21 offen offset:1024 sc1
  buffer_load_dwordx4 v[184:187], v16, s[28:31], s21 offen offset:2048 sc1
op_146:
  buffer_load_dwordx4 v[32:35], v4, s[4:7], s84 offen offset:0 sc1
  buffer_load_dwordx4 v[36:39], v4, s[4:7], s84 offen offset:1024 sc1
  buffer_load_dwordx4 v[40:43], v4, s[4:7], s84 offen offset:2048 sc1
  s_add_u32 s54, s54, 1
  s_cmp_gt_u32 s54, 131072
  s_cbranch_scc1 end0
  s_waitcnt vmcnt(0)
  v_bitop3_b32 v27, v35, v39, v43 bitop3:0x80
  v_perm_b32 v35, v39, v35, s89
  v_cmp_gt_u32 vcc, 0x48000000, v27
  v_mov_b32 v39, v42
  s_cbranch_vccnz pm_100
  s_branch A1_19
psr_118:
  buffer_load_dwordx2 v[248:249], v9, s[8:11], s81 offen sc1
  buffer_load_dwordx4 v[112:115], v8, s[8:11], s81 offen offset:0 sc1
  buffer_load_dwordx4 v[116:119], v8, s[8:11], s81 offen offset:1024 sc1
  s_add_u32 s54, s54, 1
  s_cmp_gt_u32 s54, 131072
  s_cbranch_scc1 end0
  s_waitcnt vmcnt(2)
  v_xor_b32 v96, s88, v248
  s_nop 0
  v_permlane16_swap_b32 v248, v249
  v_fma_mix_f32 v250, v248, 1.0, v249 op_sel:[0,0,0] op_sel_hi:[1,0,1]
  v_fma_mix_f32 v251, v248, 1.0, v249 op_sel:[1,0,1] op_sel_hi:[1,0,1]
  v_mov_b32 v248, v250
  v_mov_b32 v249, v251
  s_nop 0
  v_permlane32_swap_b32 v248, v250
  v_permlane32_swap_b32 v249, v251
  v_pk_add_f32 v[124:125], v[248:249], v[250:251]
  v_max_f32 v238, v124, v125
  s_waitcnt vmcnt(0)
  v_pk_add_f16 v100, v112, v116
  v_pk_add_f16 v102, v114, v118
  v_pk_add_f16 v101, v113, v117
  v_pk_add_f16 v103, v115, v119
  v_permlane32_swap_b32 v100, v102
  v_bitop3_b32 v97, v112, v114, s88 bitop3:0x7e
  v_permlane32_swap_b32 v101, v103
  v_bitop3_b32 v98, v116, v118, s88 bitop3:0x7e
  v_fma_mix_f32 v120, v100, 1.0, v102 op_sel:[0,0,0] op_sel_hi:[1,0,1]
  v_or3_b32 v27, v96, v97, v98
  v_fma_mix_f32 v121, v100, 1.0, v102 op_sel:[1,0,1] op_sel_hi:[1,0,1]
  v_and_b32 v27, 1, v27
  v_fma_mix_f32 v122, v101, 1.0, v103 op_sel:[0,0,0] op_sel_hi:[1,0,1]
  v_cmp_ne_u32 vcc, 0, v27
  v_fma_mix_f32 v123, v101, 1.0, v103 op_sel:[1,0,1] op_sel_hi:[1,0,1]
  v_max3_f32 v236, v120, v121, v238
  s_cbranch_vccnz psr_118
  s_branch psj_119
kvw_120:
  s_mov_b32 s22, s87
  s_cmp_eq_u32 s52, 0
  s_cselect_b32 s23, s87, s46
  s_cselect_b32 s55, 0, s55
  s_cselect_b32 s87, 1, 0
  s_cmp_eq_u32 s23, 0
  s_cbranch_scc1 kvok_121
  v_mov_b32 v236, 0
  s_mov_b32 s101, 0
wf_147:
  buffer_load_dword v237, v236, s[12:15], s79 offen sc1
  s_add_u32 s101, s101, 1
  s_cmp_gt_u32 s101, 131072
  s_cbranch_scc1 end0
  s_waitcnt vmcnt(0)
  v_readfirstlane_b32 s100, v237
  s_cmp_ge_u32 s100, s23
  s_cbranch_scc1 wf_148
  s_sleep 3
  s_branch wf_147
wf_148:
  s_cmp_eq_u32 s22, 0
  s_cbranch_scc1 kvok_121
  s_sub_u32 s21, s64, 1310720
  buffer_load_dwordx4 v[176:179], v16, s[28:31], s21 offen offset:0 sc1
  buffer_load_dwordx4 v[180:183], v16, s[28:31], s21 offen offset:1024 sc1
  buffer_load_dwordx4 v[184:187], v16, s[28:31], s21 offen offset:2048 sc1
  s_waitcnt vmcnt(0)
  s_branch kvok_121
fl_134:
  buffer_load_dword v94, v95, s[12:15], s79 offen sc1
  s_branch fl_135
last_99:
  s_lshr_b32 s21, 4, s20
  s_bitcmp1_b32 s21, 0
  s_cbranch_scc0 bw_150
  s_mov_b64 exec, s[62:63]
  buffer_store_dwordx4 v[212:215], v21, s[24:27], s85 offen sc1
  buffer_store_dwordx2 v[216:217], v23, s[24:27], s85 offen sc1
  s_mov_b64 exec, -1
  s_branch bw_149
bw_150:
bw_149:
  v_mov_b32 v188, 0
  v_mov_b32 v189, 0
  v_mov_b32 v190, 0
  v_mov_b32 v191, 0
  v_mov_b32 v192, 0
  v_mov_b32 v193, 0
  v_mov_b32 v194, 0
  v_mov_b32 v195, 0
  v_mov_b32 v196, 0
  v_mov_b32 v197, 0
  v_mov_b32 v198, 0
  v_mov_b32 v199, 0
  s_sleep 4
  s_mov_b32 s54, 0
lv_151:
  buffer_load_dwordx4 v[144:147], v10, s[8:11], s81 offen offset:0 sc1
  buffer_load_dwordx4 v[148:151], v10, s[8:11], s81 offen offset:1024 sc1
  buffer_load_dwordx4 v[152:155], v10, s[8:11], s81 offen offset:2048 sc1
  s_add_u32 s54, s54, 1
  s_cmp_gt_u32 s54, 131072
  s_cbranch_scc1 end0
  s_waitcnt vmcnt(0)
  v_max3_u32 v27, v144, v146, v148
  v_max3_u32 v27, v27, v150, v152
  v_max3_u32 v27, v27, v154, v154
  v_cmp_eq_u32 vcc, -1, v27
  s_nop 1
  s_cbranch_vccnz lv_151
  v_smfmac_f32_16x16x64_bf16 v[188:191], v[144:147], a[180:187], v44
  v_smfmac_f32_16x16x64_bf16 v[192:195], v[144:147], a[204:211], v44
  v_smfmac_f32_16x16x64_bf16 v[196:199], v[144:147], a[228:235], v44
  v_smfmac_f32_16x16x64_bf16 v[188:191], v[148:151], a[188:195], v44
  v_smfmac_f32_16x16x64_bf16 v[192:195], v[148:151], a[212:219], v44
  v_smfmac_f32_16x16x64_bf16 v[196:199], v[148:151], a[236:243], v44
  v_smfmac_f32_16x16x64_bf16 v[188:191], v[152:155], a[196:203], v44
  v_smfmac_f32_16x16x64_bf16 v[192:195], v[152:155], a[220:227], v44
  v_smfmac_f32_16x16x64_bf16 v[196:199], v[152:155], a[244:251], v44
  s_nop 7
  v_mov_b32 v200, v196
  v_mov_b32 v201, v197
  v_mov_b32 v202, v198
  v_mov_b32 v203, v199
  v_permlane32_swap_b32 v188, v192
  v_permlane32_swap_b32 v189, v193
  v_permlane32_swap_b32 v190, v194
  v_permlane32_swap_b32 v191, v195
  v_permlane32_swap_b32 v196, v200
  v_permlane32_swap_b32 v197, v201
  v_permlane32_swap_b32 v198, v202
  v_permlane32_swap_b32 v199, v203
  v_pk_add_f32 v[188:189], v[188:189], v[192:193]
  v_pk_add_f32 v[190:191], v[190:191], v[194:195]
  v_pk_add_f32 v[196:197], v[196:197], v[200:201]
  v_pk_add_f32 v[198:199], v[198:199], v[202:203]
  v_cvt_pk_bf16_f32 v252, v188, v189
  v_cvt_pk_bf16_f32 v254, v196, v197
  v_cvt_pk_bf16_f32 v253, v190, v191
  v_cvt_pk_bf16_f32 v255, v198, v199
  s_nop 0
  v_permlane16_swap_b32 v252, v254
  v_permlane16_swap_b32 v253, v255
  v_min_u32 v252, -2, v252
  s_mov_b64 exec, s[76:77]
  buffer_store_dwordx4 v[252:255], v15, s[24:27], s57 offen sc1
  s_mov_b64 exec, -1
  s_lshr_b32 s21, 1, s20
  s_bitcmp1_b32 s21, 0
  s_cbranch_scc0 bw_153
  v_mov_b32 v246, 80
  v_mov_b32 v247, 1
  s_mov_b64 exec, 1
  buffer_atomic_add v247, v246, s[32:35], 0 offen sc0 sc1
  s_mov_b64 exec, -1
clm_154:
  s_branch bw_152
bw_153:
bw_152:
  s_branch chain_done
chain_done:
  s_waitcnt vmcnt(0) lgkmcnt(0)
  s_barrier
  s_mov_b32 s84, 0
  s_mov_b32 s85, -1
  s_mov_b32 s86, 0
  v_mov_b32 v21, 0
  v_mov_b32 v23, v247
  s_cmp_lg_u32 s20, 0
  s_cbranch_scc1 queue_b
  s_mov_b64 exec, 1
  s_branch queue_a
end0:
  s_endpgm
gemm_side:
  s_bfe_u32 s23, s22, 0x20005
  s_add_u32 s22, s22, 31
  s_and_b32 s22, s22, 31
  s_lshl_b32 s21, s23, 3
  s_add_u32 s2, s21, s22
  s_add_u32 s3, s2, 72
  s_add_u32 s24, s2, 48
  s_add_u32 s2, s2, s21
  s_cmp_lt_u32 s22, 24
  s_cselect_b32 s3, s24, s3
  s_cmp_lt_u32 s22, 16
  s_cselect_b32 s3, s2, s3
  s_mov_b32 s2, s3
  s_cmp_ge_u32 s3, 64
  s_cbranch_scc1 not_kv
  s_load_dwordx2 s[4:5], s[0:1], 0
  s_load_dwordx2 s[6:7], s[0:1], 24
  s_load_dwordx2 s[36:37], s[0:1], 32
  s_load_dwordx2 s[38:39], s[0:1], 104
  s_and_b32 s43, s3, 1
  s_bfe_u32 s42, s3, 0x50001
  s_lshr_b32 s40, s42, 2
  s_waitcnt lgkmcnt(0)
  s_cmp_eq_u32 s43, 1
  s_cselect_b32 s6, s36, s6
  s_cselect_b32 s7, s37, s7
  s_mov_b32 s8, s4
  s_mov_b32 s9, s5
  s_mov_b32 s10, 2621440
  s_mov_b32 s11, 0x00020000
  s_mov_b32 s12, s6
  s_mov_b32 s13, s7
  s_mov_b32 s14, 7864320
  s_mov_b32 s15, 0x00020000
  s_mov_b32 s16, s38
  s_mov_b32 s17, s39
  s_mov_b32 s18, 50331648
  s_mov_b32 s19, 0x00020000
  s_mul_i32 s44, s42, 384
  s_mov_b32 s62, 1024
  s_mov_b32 s24, 0
  s_mov_b32 s25, 81920
  s_mov_b32 s64, s32
  s_mov_b32 s65, s33
  s_mov_b32 s66, s34
  s_mov_b32 s67, s35
  s_load_dwordx2 s[72:73], s[0:1], 104
  s_waitcnt lgkmcnt(0)
  s_add_u32 s72, s72, 81068032
  s_addc_u32 s73, s73, 0
  s_mov_b32 s74, 116736
  s_mov_b32 s75, 0x00020000
  v_mov_b32 v9, 2731
  v_add_u32 v8, 0, v1
  v_mul_u32_u24 v7, v8, v9
  v_lshrrev_b32 v7, 16, v7
  v_mul_u32_u24 v4, 24, v7
  v_sub_u32 v8, v8, v4
  v_and_b32 v4, 2, v7
  v_xor_b32 v8, v8, v4
  v_xor_b32 v5, 4, v8
  s_mov_b32 s21, 12288
  v_mul_lo_u32 v7, v7, s21
  v_lshl_add_u32 v40, v8, 4, v7
  v_lshl_add_u32 v43, v5, 4, v7
  v_add_u32 v8, 64, v1
  v_mul_u32_u24 v7, v8, v9
  v_lshrrev_b32 v7, 16, v7
  v_mul_u32_u24 v4, 24, v7
  v_sub_u32 v8, v8, v4
  v_and_b32 v4, 2, v7
  v_xor_b32 v8, v8, v4
  v_xor_b32 v5, 4, v8
  s_mov_b32 s21, 12288
  v_mul_lo_u32 v7, v7, s21
  v_lshl_add_u32 v41, v8, 4, v7
  v_lshl_add_u32 v44, v5, 4, v7
  v_add_u32 v8, 128, v1
  v_mul_u32_u24 v7, v8, v9
  v_lshrrev_b32 v7, 16, v7
  v_mul_u32_u24 v4, 24, v7
  v_sub_u32 v8, v8, v4
  v_and_b32 v4, 2, v7
  v_xor_b32 v8, v8, v4
  v_xor_b32 v5, 4, v8
  s_mov_b32 s21, 12288
  v_mul_lo_u32 v7, v7, s21
  v_lshl_add_u32 v42, v8, 4, v7
  v_lshl_add_u32 v45, v5, 4, v7
  s_mul_i32 s21, s20, 393216
  s_add_u32 s21, s21, 0
  s_add_u32 s21, s21, s44
  s_mul_i32 s22, s20, 12288
  s_add_u32 s22, s22, 0
  s_add_u32 m0, s22, 0
  s_nop 0
  buffer_load_dwordx4 v40, s[12:15], s21 offen lds
  s_add_u32 m0, s22, 1024
  s_nop 0
  buffer_load_dwordx4 v41, s[12:15], s21 offen lds
  s_add_u32 m0, s22, 2048
  s_nop 0
  buffer_load_dwordx4 v42, s[12:15], s21 offen lds
  s_mul_i32 s21, s20, 393216
  s_add_u32 s21, s21, 98304
  s_add_u32 s21, s21, s44
  s_mul_i32 s22, s20, 12288
  s_add_u32 s22, s22, 3072
  s_add_u32 m0, s22, 0
  s_nop 0
  buffer_load_dwordx4 v43, s[12:15], s21 offen lds
  s_add_u32 m0, s22, 1024
  s_nop 0
  buffer_load_dwordx4 v44, s[12:15], s21 offen lds
  s_add_u32 m0, s22, 2048
  s_nop 0
  buffer_load_dwordx4 v45, s[12:15], s21 offen lds
  s_mul_i32 s21, s20, 393216
  s_add_u32 s21, s21, 196608
  s_add_u32 s21, s21, s44
  s_mul_i32 s22, s20, 12288
  s_add_u32 s22, s22, 6144
  s_add_u32 m0, s22, 0
  s_nop 0
  buffer_load_dwordx4 v40, s[12:15], s21 offen lds
  s_add_u32 m0, s22, 1024
  s_nop 0
  buffer_load_dwordx4 v41, s[12:15], s21 offen lds
  s_add_u32 m0, s22, 2048
  s_nop 0
  buffer_load_dwordx4 v42, s[12:15], s21 offen lds
  s_mul_i32 s21, s20, 393216
  s_add_u32 s21, s21, 294912
  s_add_u32 s21, s21, s44
  s_mul_i32 s22, s20, 12288
  s_add_u32 s22, s22, 9216
  s_add_u32 m0, s22, 0
  s_nop 0
  buffer_load_dwordx4 v43, s[12:15], s21 offen lds
  s_add_u32 m0, s22, 1024
  s_nop 0
  buffer_load_dwordx4 v44, s[12:15], s21 offen lds
  s_add_u32 m0, s22, 2048
  s_nop 0
  buffer_load_dwordx4 v45, s[12:15], s21 offen lds
  v_lshrrev_b32 v11, 3, v1
  v_and_b32 v12, 7, v1
  v_xor_b32 v12, v12, v11
  v_mul_u32_u24 v11, 1280, v11
  v_lshl_add_u32 v10, v12, 4, v11
  s_mul_i32 s46, s20, 20480
  v_add_u32 v10, s46, v10
  s_lshl_b32 s47, s20, 11
  s_add_u32 s47, s47, 98304
  s_add_u32 s46, s47, 57344
  s_mov_b32 s30, s24
  s_add_u32 s32, s47, 0
  v_add_u32 v11, 9216, v10
  s_mov_b32 m0, s32
  s_nop 0
  buffer_load_dwordx4 v10, s[8:11], s30 offen offset:0 lds
  buffer_load_dwordx4 v11, s[8:11], s30 offen offset:1024 lds
  s_add_u32 s30, s30, 128
  s_add_u32 s32, s32, 8192
  s_cmp_lt_u32 s32, s46
  s_cselect_b32 s32, s32, s47
  s_mov_b32 m0, s32
  s_nop 0
  buffer_load_dwordx4 v10, s[8:11], s30 offen offset:0 lds
  buffer_load_dwordx4 v11, s[8:11], s30 offen offset:1024 lds
  s_add_u32 s30, s30, 128
  s_add_u32 s32, s32, 8192
  s_cmp_lt_u32 s32, s46
  s_cselect_b32 s32, s32, s47
  s_mov_b32 m0, s32
  s_nop 0
  buffer_load_dwordx4 v10, s[8:11], s30 offen offset:0 lds
  buffer_load_dwordx4 v11, s[8:11], s30 offen offset:1024 lds
  s_add_u32 s30, s30, 128
  s_add_u32 s32, s32, 8192
  s_cmp_lt_u32 s32, s46
  s_cselect_b32 s32, s32, s47
  s_mov_b32 m0, s32
  s_nop 0
  buffer_load_dwordx4 v10, s[8:11], s30 offen offset:0 lds
  buffer_load_dwordx4 v11, s[8:11], s30 offen offset:1024 lds
  s_add_u32 s30, s30, 128
  s_add_u32 s32, s32, 8192
  s_cmp_lt_u32 s32, s46
  s_cselect_b32 s32, s32, s47
  s_mov_b32 m0, s32
  s_nop 0
  buffer_load_dwordx4 v10, s[8:11], s30 offen offset:0 lds
  buffer_load_dwordx4 v11, s[8:11], s30 offen offset:1024 lds
  s_add_u32 s30, s30, 128
  s_add_u32 s32, s32, 8192
  s_cmp_lt_u32 s32, s46
  s_cselect_b32 s32, s32, s47
  s_mul_i32 s21, s20, 393216
  s_add_u32 s21, s21, 1572864
  s_add_u32 s21, s21, s44
  s_mul_i32 s22, s20, 12288
  s_add_u32 s22, s22, 49152
  s_add_u32 m0, s22, 0
  s_nop 0
  buffer_load_dwordx4 v40, s[12:15], s21 offen lds
  s_add_u32 m0, s22, 1024
  s_nop 0
  buffer_load_dwordx4 v41, s[12:15], s21 offen lds
  s_add_u32 m0, s22, 2048
  s_nop 0
  buffer_load_dwordx4 v42, s[12:15], s21 offen lds
  s_mul_i32 s21, s20, 393216
  s_add_u32 s21, s21, 1671168
  s_add_u32 s21, s21, s44
  s_mul_i32 s22, s20, 12288
  s_add_u32 s22, s22, 52224
  s_add_u32 m0, s22, 0
  s_nop 0
  buffer_load_dwordx4 v43, s[12:15], s21 offen lds
  s_add_u32 m0, s22, 1024
  s_nop 0
  buffer_load_dwordx4 v44, s[12:15], s21 offen lds
  s_add_u32 m0, s22, 2048
  s_nop 0
  buffer_load_dwordx4 v45, s[12:15], s21 offen lds
  s_mul_i32 s21, s20, 393216
  s_add_u32 s21, s21, 1769472
  s_add_u32 s21, s21, s44
  s_mul_i32 s22, s20, 12288
  s_add_u32 s22, s22, 55296
  s_add_u32 m0, s22, 0
  s_nop 0
  buffer_load_dwordx4 v40, s[12:15], s21 offen lds
  s_add_u32 m0, s22, 1024
  s_nop 0
  buffer_load_dwordx4 v41, s[12:15], s21 offen lds
  s_add_u32 m0, s22, 2048
  s_nop 0
  buffer_load_dwordx4 v42, s[12:15], s21 offen lds
  s_mul_i32 s21, s20, 393216
  s_add_u32 s21, s21, 1867776
  s_add_u32 s21, s21, s44
  s_mul_i32 s22, s20, 12288
  s_add_u32 s22, s22, 58368
  s_add_u32 m0, s22, 0
  s_nop 0
  buffer_load_dwordx4 v43, s[12:15], s21 offen lds
  s_add_u32 m0, s22, 1024
  s_nop 0
  buffer_load_dwordx4 v44, s[12:15], s21 offen lds
  s_add_u32 m0, s22, 2048
  s_nop 0
  buffer_load_dwordx4 v45, s[12:15], s21 offen lds
  v_lshrrev_b32 v7, 2, v2
  v_and_b32 v4, 2, v7
  v_and_b32 v5, 1, v3
  v_lshl_or_b32 v4, v5, 2, v4
  v_lshl_add_u32 v7, v3, 3, v7
  v_mul_u32_u24 v7, 384, v7
  v_and_b32 v5, 1, v2
  v_lshl_add_u32 v7, v5, 3, v7
  v_bfe_u32 v8, v2, 1, 1
  s_mul_i32 s21, s20, 6
  v_add_u32 v8, s21, v8
  v_add_u32 v5, 0, v8
  v_xor_b32 v5, v5, v4
  v_lshl_add_u32 v46, v5, 4, v7
  v_add_u32 v49, 49152, v46
  v_add_u32 v5, 2, v8
  v_xor_b32 v5, v5, v4
  v_lshl_add_u32 v47, v5, 4, v7
  v_add_u32 v50, 49152, v47
  v_add_u32 v5, 4, v8
  v_xor_b32 v5, v5, v4
  v_lshl_add_u32 v48, v5, 4, v7
  v_add_u32 v51, 49152, v48
  s_mov_b32 s26, 6
  s_mul_i32 s27, s42, 12288
  s_mul_i32 s21, s43, 25165824
  s_add_u32 s27, s27, s21
  s_mov_b32 s28, 786432
  s_lshl_b32 s60, s40, 7
  s_add_u32 s60, s60, 0
  s_mov_b32 s61, 0
  v_and_b32 v6, 7, v2
  v_add_u32 v4, 0, v3
  v_xor_b32 v4, v4, v6
  v_lshlrev_b32 v4, 4, v4
  v_lshl_add_u32 v14, v2, 7, v4
  v_add_u32 v4, 4, v3
  v_xor_b32 v4, v4, v6
  v_lshlrev_b32 v4, 4, v4
  v_lshl_add_u32 v15, v2, 7, v4
  v_mul_u32_u24 v22, 400, v2
  v_mul_u32_u24 v4, 16, v3
  s_mul_i32 s21, s20, 96
  s_add_u32 s21, s21, 0
  v_add3_u32 v22, v22, v4, s21
  v_lshlrev_b32 v4, 3, v3
  v_sub_u32 v16, v22, v4
  v_mov_b32 v9, 2731
  s_mul_i32 s21, s20, 6400
  s_add_u32 s21, s21, 0
  v_mul_u32_u24 v4, 400, v2
  v_lshlrev_b32 v5, 4, v3
  v_add3_u32 v23, v4, v5, s21
  v_lshlrev_b32 v26, 4, v1
  s_mov_b32 s33, 98304
  s_mov_b32 s48, 0x80000000
  s_mov_b32 m0, s32
  s_nop 0
  buffer_load_dwordx4 v10, s[8:11], s30 offen offset:0 lds
  s_waitcnt vmcnt(21)
  s_barrier
  v_add_u32 v18, s33, v14
  v_add_u32 v19, s33, v15
  s_add_u32 s33, s33, 8192
  s_cmp_lt_u32 s33, 155648
  s_cselect_b32 s33, s33, 98304
  ds_read_b128 v[160:163], v18 offset:0
  ds_read_b128 v[164:167], v18 offset:2048
  ds_read_b128 v[168:171], v18 offset:4096
  ds_read_b128 v[172:175], v18 offset:6144
  s_waitcnt lgkmcnt(0)
  s_waitcnt vmcnt(23)
  s_barrier
  ds_read_b64_tr_b16 a[0:1], v46 offset:0
  ds_read_b64_tr_b16 a[2:3], v46 offset:1536
  ds_read_b64_tr_b16 a[4:5], v47 offset:0
  ds_read_b64_tr_b16 a[6:7], v47 offset:1536
  ds_read_b64_tr_b16 a[8:9], v48 offset:0
  ds_read_b64_tr_b16 a[10:11], v48 offset:1536
  ds_read_b64_tr_b16 a[12:13], v46 offset:12288
  ds_read_b64_tr_b16 a[14:15], v46 offset:13824
  ds_read_b64_tr_b16 a[16:17], v47 offset:12288
  ds_read_b64_tr_b16 a[18:19], v47 offset:13824
  ds_read_b64_tr_b16 a[20:21], v48 offset:12288
  ds_read_b64_tr_b16 a[22:23], v48 offset:13824
  ds_read_b64_tr_b16 a[24:25], v46 offset:24576
  ds_read_b64_tr_b16 a[26:27], v46 offset:26112
  ds_read_b64_tr_b16 a[28:29], v47 offset:24576
  ds_read_b64_tr_b16 a[30:31], v47 offset:26112
  ds_read_b64_tr_b16 a[32:33], v48 offset:24576
  ds_read_b64_tr_b16 a[34:35], v48 offset:26112
  ds_read_b64_tr_b16 a[36:37], v46 offset:36864
  ds_read_b64_tr_b16 a[38:39], v46 offset:38400
  ds_read_b64_tr_b16 a[40:41], v47 offset:36864
  ds_read_b64_tr_b16 a[42:43], v47 offset:38400
  ds_read_b64_tr_b16 a[44:45], v48 offset:36864
  ds_read_b64_tr_b16 a[46:47], v48 offset:38400
  s_waitcnt lgkmcnt(0)
  s_barrier
  s_mov_b32 s23, m0
  s_mul_i32 s21, s20, 393216
  s_add_u32 s21, s21, 3145728
  s_add_u32 s21, s21, s44
  s_mul_i32 s22, s20, 12288
  s_add_u32 s22, s22, 0
  s_add_u32 m0, s22, 0
  s_nop 0
  buffer_load_dwordx4 v40, s[12:15], s21 offen lds
  s_add_u32 m0, s22, 1024
  s_nop 0
  buffer_load_dwordx4 v41, s[12:15], s21 offen lds
  s_add_u32 m0, s22, 2048
  s_nop 0
  buffer_load_dwordx4 v42, s[12:15], s21 offen lds
  s_mul_i32 s21, s20, 393216
  s_add_u32 s21, s21, 3244032
  s_add_u32 s21, s21, s44
  s_mul_i32 s22, s20, 12288
  s_add_u32 s22, s22, 3072
  s_add_u32 m0, s22, 0
  s_nop 0
  buffer_load_dwordx4 v43, s[12:15], s21 offen lds
  s_add_u32 m0, s22, 1024
  s_nop 0
  buffer_load_dwordx4 v44, s[12:15], s21 offen lds
  s_add_u32 m0, s22, 2048
  s_nop 0
  buffer_load_dwordx4 v45, s[12:15], s21 offen lds
  s_mul_i32 s21, s20, 393216
  s_add_u32 s21, s21, 3342336
  s_add_u32 s21, s21, s44
  s_mul_i32 s22, s20, 12288
  s_add_u32 s22, s22, 6144
  s_add_u32 m0, s22, 0
  s_nop 0
  buffer_load_dwordx4 v40, s[12:15], s21 offen lds
  s_add_u32 m0, s22, 1024
  s_nop 0
  buffer_load_dwordx4 v41, s[12:15], s21 offen lds
  s_add_u32 m0, s22, 2048
  s_nop 0
  buffer_load_dwordx4 v42, s[12:15], s21 offen lds
  s_mul_i32 s21, s20, 393216
  s_add_u32 s21, s21, 3440640
  s_add_u32 s21, s21, s44
  s_mul_i32 s22, s20, 12288
  s_add_u32 s22, s22, 9216
  s_add_u32 m0, s22, 0
  s_nop 0
  buffer_load_dwordx4 v43, s[12:15], s21 offen lds
  s_add_u32 m0, s22, 1024
  s_nop 0
  buffer_load_dwordx4 v44, s[12:15], s21 offen lds
  s_add_u32 m0, s22, 2048
  s_nop 0
  buffer_load_dwordx4 v45, s[12:15], s21 offen lds
  s_mov_b32 m0, s23
  v_mfma_f32_16x16x32_bf16 v[64:67], a[0:3], v[160:163], 0
  ds_read_b128 v[192:195], v19 offset:0
  v_mfma_f32_16x16x32_bf16 v[68:71], a[4:7], v[160:163], 0
  v_add_u32 v18, s33, v14
  v_mfma_f32_16x16x32_bf16 v[72:75], a[8:11], v[160:163], 0
  v_mfma_f32_16x16x32_bf16 v[76:79], a[0:3], v[164:167], 0
  ds_read_b128 v[196:199], v19 offset:2048
  v_mfma_f32_16x16x32_bf16 v[80:83], a[4:7], v[164:167], 0
  buffer_load_dwordx4 v11, s[8:11], s30 offen offset:1024 lds
  v_mfma_f32_16x16x32_bf16 v[84:87], a[8:11], v[164:167], 0
  s_add_u32 s30, s30, 128
  v_mfma_f32_16x16x32_bf16 v[88:91], a[0:3], v[168:171], 0
  ds_read_b128 v[200:203], v19 offset:4096
  s_add_u32 m0, m0, 8192
  v_mfma_f32_16x16x32_bf16 v[92:95], a[4:7], v[168:171], 0
  s_cmp_lt_u32 m0, s46
  s_cselect_b32 m0, m0, s47
  v_mfma_f32_16x16x32_bf16 v[96:99], a[8:11], v[168:171], 0
  v_mfma_f32_16x16x32_bf16 v[100:103], a[0:3], v[172:175], 0
  ds_read_b128 v[204:207], v19 offset:6144
  v_mfma_f32_16x16x32_bf16 v[104:107], a[4:7], v[172:175], 0
  v_mfma_f32_16x16x32_bf16 v[108:111], a[8:11], v[172:175], 0
  s_waitcnt vmcnt(32) lgkmcnt(2)
  s_barrier
  v_mfma_f32_16x16x32_bf16 v[64:67], a[12:15], v[192:195], v[64:67]
  ds_read_b128 v[160:163], v18 offset:0
  v_mfma_f32_16x16x32_bf16 v[68:71], a[16:19], v[192:195], v[68:71]
  v_mfma_f32_16x16x32_bf16 v[72:75], a[20:23], v[192:195], v[72:75]
  v_add_u32 v19, s33, v15
  s_add_u32 s33, s33, 8192
  v_mfma_f32_16x16x32_bf16 v[76:79], a[12:15], v[196:199], v[76:79]
  ds_read_b128 v[164:167], v18 offset:2048
  v_mfma_f32_16x16x32_bf16 v[80:83], a[16:19], v[196:199], v[80:83]
  buffer_load_dwordx4 v10, s[8:11], s30 offen offset:0 lds
  v_mfma_f32_16x16x32_bf16 v[84:87], a[20:23], v[196:199], v[84:87]
  s_waitcnt lgkmcnt(2)
  v_mfma_f32_16x16x32_bf16 v[88:91], a[12:15], v[200:203], v[88:91]
  ds_read_b128 v[168:171], v18 offset:4096
  v_mfma_f32_16x16x32_bf16 v[92:95], a[16:19], v[200:203], v[92:95]
  s_cmp_lt_u32 s33, 155648
  s_cselect_b32 s33, s33, 98304
  v_mfma_f32_16x16x32_bf16 v[96:99], a[20:23], v[200:203], v[96:99]
  v_mfma_f32_16x16x32_bf16 v[100:103], a[12:15], v[204:207], v[100:103]
  ds_read_b128 v[172:175], v18 offset:6144
  v_mfma_f32_16x16x32_bf16 v[104:107], a[16:19], v[204:207], v[104:107]
  v_mfma_f32_16x16x32_bf16 v[108:111], a[20:23], v[204:207], v[108:111]
  s_waitcnt lgkmcnt(2)
  v_mfma_f32_16x16x32_bf16 v[64:67], a[24:27], v[160:163], v[64:67]
  ds_read_b128 v[192:195], v19 offset:0
  v_mfma_f32_16x16x32_bf16 v[68:71], a[28:31], v[160:163], v[68:71]
  v_add_u32 v18, s33, v14
  v_mfma_f32_16x16x32_bf16 v[72:75], a[32:35], v[160:163], v[72:75]
  v_mfma_f32_16x16x32_bf16 v[76:79], a[24:27], v[164:167], v[76:79]
  ds_read_b128 v[196:199], v19 offset:2048
  v_mfma_f32_16x16x32_bf16 v[80:83], a[28:31], v[164:167], v[80:83]
  buffer_load_dwordx4 v11, s[8:11], s30 offen offset:1024 lds
  v_mfma_f32_16x16x32_bf16 v[84:87], a[32:35], v[164:167], v[84:87]
  s_waitcnt lgkmcnt(2)
  s_add_u32 s30, s30, 128
  v_mfma_f32_16x16x32_bf16 v[88:91], a[24:27], v[168:171], v[88:91]
  ds_read_b128 v[200:203], v19 offset:4096
  s_add_u32 m0, m0, 8192
  v_mfma_f32_16x16x32_bf16 v[92:95], a[28:31], v[168:171], v[92:95]
  s_cmp_lt_u32 m0, s46
  s_cselect_b32 m0, m0, s47
  v_mfma_f32_16x16x32_bf16 v[96:99], a[32:35], v[168:171], v[96:99]
  v_mfma_f32_16x16x32_bf16 v[100:103], a[24:27], v[172:175], v[100:103]
  ds_read_b128 v[204:207], v19 offset:6144
  v_mfma_f32_16x16x32_bf16 v[104:107], a[28:31], v[172:175], v[104:107]
  v_mfma_f32_16x16x32_bf16 v[108:111], a[32:35], v[172:175], v[108:111]
  s_waitcnt vmcnt(32) lgkmcnt(2)
  s_barrier
  v_mfma_f32_16x16x32_bf16 v[64:67], a[36:39], v[192:195], v[64:67]
  ds_read_b128 v[160:163], v18 offset:0
  v_mfma_f32_16x16x32_bf16 v[68:71], a[40:43], v[192:195], v[68:71]
  v_mfma_f32_16x16x32_bf16 v[72:75], a[44:47], v[192:195], v[72:75]
  v_add_u32 v19, s33, v15
  s_add_u32 s33, s33, 8192
  v_mfma_f32_16x16x32_bf16 v[76:79], a[36:39], v[196:199], v[76:79]
  ds_read_b128 v[164:167], v18 offset:2048
  v_mfma_f32_16x16x32_bf16 v[80:83], a[40:43], v[196:199], v[80:83]
  buffer_load_dwordx4 v10, s[8:11], s30 offen offset:0 lds
  v_mfma_f32_16x16x32_bf16 v[84:87], a[44:47], v[196:199], v[84:87]
  s_waitcnt lgkmcnt(2)
  v_mfma_f32_16x16x32_bf16 v[88:91], a[36:39], v[200:203], v[88:91]
  ds_read_b128 v[168:171], v18 offset:4096
  v_mfma_f32_16x16x32_bf16 v[92:95], a[40:43], v[200:203], v[92:95]
  s_cmp_lt_u32 s33, 155648
  s_cselect_b32 s33, s33, 98304
  v_mfma_f32_16x16x32_bf16 v[96:99], a[44:47], v[200:203], v[96:99]
  v_mfma_f32_16x16x32_bf16 v[100:103], a[36:39], v[204:207], v[100:103]
  ds_read_b128 v[172:175], v18 offset:6144
  v_mfma_f32_16x16x32_bf16 v[104:107], a[40:43], v[204:207], v[104:107]
  v_mfma_f32_16x16x32_bf16 v[108:111], a[44:47], v[204:207], v[108:111]
  s_waitcnt lgkmcnt(2)
  s_waitcnt vmcnt(17)
  s_barrier
  ds_read_b64_tr_b16 a[48:49], v49 offset:0
  ds_read_b64_tr_b16 a[50:51], v49 offset:1536
  ds_read_b64_tr_b16 a[52:53], v50 offset:0
  ds_read_b64_tr_b16 a[54:55], v50 offset:1536
  ds_read_b64_tr_b16 a[56:57], v51 offset:0
  ds_read_b64_tr_b16 a[58:59], v51 offset:1536
  ds_read_b64_tr_b16 a[60:61], v49 offset:12288
  ds_read_b64_tr_b16 a[62:63], v49 offset:13824
  ds_read_b64_tr_b16 a[64:65], v50 offset:12288
  ds_read_b64_tr_b16 a[66:67], v50 offset:13824
  ds_read_b64_tr_b16 a[68:69], v51 offset:12288
  ds_read_b64_tr_b16 a[70:71], v51 offset:13824
  ds_read_b64_tr_b16 a[72:73], v49 offset:24576
  ds_read_b64_tr_b16 a[74:75], v49 offset:26112
  ds_read_b64_tr_b16 a[76:77], v50 offset:24576
  ds_read_b64_tr_b16 a[78:79], v50 offset:26112
  ds_read_b64_tr_b16 a[80:81], v51 offset:24576
  ds_read_b64_tr_b16 a[82:83], v51 offset:26112
  ds_read_b64_tr_b16 a[84:85], v49 offset:36864
  ds_read_b64_tr_b16 a[86:87], v49 offset:38400
  ds_read_b64_tr_b16 a[88:89], v50 offset:36864
  ds_read_b64_tr_b16 a[90:91], v50 offset:38400
  ds_read_b64_tr_b16 a[92:93], v51 offset:36864
  ds_read_b64_tr_b16 a[94:95], v51 offset:38400
  s_waitcnt lgkmcnt(0)
  s_barrier
  s_mov_b32 s23, m0
  s_mul_i32 s21, s20, 393216
  s_add_u32 s21, s21, 4718592
  s_add_u32 s21, s21, s44
  s_mul_i32 s22, s20, 12288
  s_add_u32 s22, s22, 49152
  s_add_u32 m0, s22, 0
  s_nop 0
  buffer_load_dwordx4 v40, s[12:15], s21 offen lds
  s_add_u32 m0, s22, 1024
  s_nop 0
  buffer_load_dwordx4 v41, s[12:15], s21 offen lds
  s_add_u32 m0, s22, 2048
  s_nop 0
  buffer_load_dwordx4 v42, s[12:15], s21 offen lds
  s_mul_i32 s21, s20, 393216
  s_add_u32 s21, s21, 4816896
  s_add_u32 s21, s21, s44
  s_mul_i32 s22, s20, 12288
  s_add_u32 s22, s22, 52224
  s_add_u32 m0, s22, 0
  s_nop 0
  buffer_load_dwordx4 v43, s[12:15], s21 offen lds
  s_add_u32 m0, s22, 1024
  s_nop 0
  buffer_load_dwordx4 v44, s[12:15], s21 offen lds
  s_add_u32 m0, s22, 2048
  s_nop 0
  buffer_load_dwordx4 v45, s[12:15], s21 offen lds
  s_mul_i32 s21, s20, 393216
  s_add_u32 s21, s21, 4915200
  s_add_u32 s21, s21, s44
  s_mul_i32 s22, s20, 12288
  s_add_u32 s22, s22, 55296
  s_add_u32 m0, s22, 0
  s_nop 0
  buffer_load_dwordx4 v40, s[12:15], s21 offen lds
  s_add_u32 m0, s22, 1024
  s_nop 0
  buffer_load_dwordx4 v41, s[12:15], s21 offen lds
  s_add_u32 m0, s22, 2048
  s_nop 0
  buffer_load_dwordx4 v42, s[12:15], s21 offen lds
  s_mul_i32 s21, s20, 393216
  s_add_u32 s21, s21, 5013504
  s_add_u32 s21, s21, s44
  s_mul_i32 s22, s20, 12288
  s_add_u32 s22, s22, 58368
  s_add_u32 m0, s22, 0
  s_nop 0
  buffer_load_dwordx4 v43, s[12:15], s21 offen lds
  s_add_u32 m0, s22, 1024
  s_nop 0
  buffer_load_dwordx4 v44, s[12:15], s21 offen lds
  s_add_u32 m0, s22, 2048
  s_nop 0
  buffer_load_dwordx4 v45, s[12:15], s21 offen lds
  s_mov_b32 m0, s23
  v_mfma_f32_16x16x32_bf16 v[64:67], a[48:51], v[160:163], v[64:67]
  ds_read_b128 v[192:195], v19 offset:0
  v_mfma_f32_16x16x32_bf16 v[68:71], a[52:55], v[160:163], v[68:71]
  v_add_u32 v18, s33, v14
  v_mfma_f32_16x16x32_bf16 v[72:75], a[56:59], v[160:163], v[72:75]
  v_mfma_f32_16x16x32_bf16 v[76:79], a[48:51], v[164:167], v[76:79]
  ds_read_b128 v[196:199], v19 offset:2048
  v_mfma_f32_16x16x32_bf16 v[80:83], a[52:55], v[164:167], v[80:83]
  buffer_load_dwordx4 v11, s[8:11], s30 offen offset:1024 lds
  v_mfma_f32_16x16x32_bf16 v[84:87], a[56:59], v[164:167], v[84:87]
  s_add_u32 s30, s30, 128
  v_mfma_f32_16x16x32_bf16 v[88:91], a[48:51], v[168:171], v[88:91]
  ds_read_b128 v[200:203], v19 offset:4096
  s_add_u32 m0, m0, 8192
  v_mfma_f32_16x16x32_bf16 v[92:95], a[52:55], v[168:171], v[92:95]
  s_cmp_lt_u32 m0, s46
  s_cselect_b32 m0, m0, s47
  v_mfma_f32_16x16x32_bf16 v[96:99], a[56:59], v[168:171], v[96:99]
  v_mfma_f32_16x16x32_bf16 v[100:103], a[48:51], v[172:175], v[100:103]
  ds_read_b128 v[204:207], v19 offset:6144
  v_mfma_f32_16x16x32_bf16 v[104:107], a[52:55], v[172:175], v[104:107]
  v_mfma_f32_16x16x32_bf16 v[108:111], a[56:59], v[172:175], v[108:111]
  s_waitcnt vmcnt(44) lgkmcnt(2)
  s_barrier
  v_mfma_f32_16x16x32_bf16 v[64:67], a[60:63], v[192:195], v[64:67]
  ds_read_b128 v[160:163], v18 offset:0
  v_mfma_f32_16x16x32_bf16 v[68:71], a[64:67], v[192:195], v[68:71]
  v_mfma_f32_16x16x32_bf16 v[72:75], a[68:71], v[192:195], v[72:75]
  v_add_u32 v19, s33, v15
  s_add_u32 s33, s33, 8192
  v_mfma_f32_16x16x32_bf16 v[76:79], a[60:63], v[196:199], v[76:79]
  ds_read_b128 v[164:167], v18 offset:2048
  v_mfma_f32_16x16x32_bf16 v[80:83], a[64:67], v[196:199], v[80:83]
  buffer_load_dwordx4 v10, s[8:11], s30 offen offset:0 lds
  v_mfma_f32_16x16x32_bf16 v[84:87], a[68:71], v[196:199], v[84:87]
  s_waitcnt lgkmcnt(2)
  v_mfma_f32_16x16x32_bf16 v[88:91], a[60:63], v[200:203], v[88:91]
  ds_read_b128 v[168:171], v18 offset:4096
  v_mfma_f32_16x16x32_bf16 v[92:95], a[64:67], v[200:203], v[92:95]
  s_cmp_lt_u32 s33, 155648
  s_cselect_b32 s33, s33, 98304
  v_mfma_f32_16x16x32_bf16 v[96:99], a[68:71], v[200:203], v[96:99]
  v_mfma_f32_16x16x32_bf16 v[100:103], a[60:63], v[204:207], v[100:103]
  ds_read_b128 v[172:175], v18 offset:6144
  v_mfma_f32_16x16x32_bf16 v[104:107], a[64:67], v[204:207], v[104:107]
  v_mfma_f32_16x16x32_bf16 v[108:111], a[68:71], v[204:207], v[108:111]
  s_waitcnt lgkmcnt(2)
  v_mfma_f32_16x16x32_bf16 v[64:67], a[72:75], v[160:163], v[64:67]
  ds_read_b128 v[192:195], v19 offset:0
  v_mfma_f32_16x16x32_bf16 v[68:71], a[76:79], v[160:163], v[68:71]
  v_add_u32 v18, s33, v14
  v_mfma_f32_16x16x32_bf16 v[72:75], a[80:83], v[160:163], v[72:75]
  v_mfma_f32_16x16x32_bf16 v[76:79], a[72:75], v[164:167], v[76:79]
  ds_read_b128 v[196:199], v19 offset:2048
  v_mfma_f32_16x16x32_bf16 v[80:83], a[76:79], v[164:167], v[80:83]
  buffer_load_dwordx4 v11, s[8:11], s30 offen offset:1024 lds
  v_mfma_f32_16x16x32_bf16 v[84:87], a[80:83], v[164:167], v[84:87]
  s_waitcnt lgkmcnt(2)
  s_add_u32 s30, s30, 128
  v_mfma_f32_16x16x32_bf16 v[88:91], a[72:75], v[168:171], v[88:91]
  ds_read_b128 v[200:203], v19 offset:4096
  s_add_u32 m0, m0, 8192
  v_mfma_f32_16x16x32_bf16 v[92:95], a[76:79], v[168:171], v[92:95]
  s_cmp_lt_u32 m0, s46
  s_cselect_b32 m0, m0, s47
  v_mfma_f32_16x16x32_bf16 v[96:99], a[80:83], v[168:171], v[96:99]
  v_mfma_f32_16x16x32_bf16 v[100:103], a[72:75], v[172:175], v[100:103]
  ds_read_b128 v[204:207], v19 offset:6144
  v_mfma_f32_16x16x32_bf16 v[104:107], a[76:79], v[172:175], v[104:107]
  v_mfma_f32_16x16x32_bf16 v[108:111], a[80:83], v[172:175], v[108:111]
  s_waitcnt vmcnt(44) lgkmcnt(2)
  s_barrier
  v_mfma_f32_16x16x32_bf16 v[64:67], a[84:87], v[192:195], v[64:67]
  ds_read_b128 v[160:163], v18 offset:0
  v_mfma_f32_16x16x32_bf16 v[68:71], a[88:91], v[192:195], v[68:71]
  v_mfma_f32_16x16x32_bf16 v[72:75], a[92:95], v[192:195], v[72:75]
  v_add_u32 v19, s33, v15
  s_add_u32 s33, s33, 8192
  v_mfma_f32_16x16x32_bf16 v[76:79], a[84:87], v[196:199], v[76:79]
  ds_read_b128 v[164:167], v18 offset:2048
  v_mfma_f32_16x16x32_bf16 v[80:83], a[88:91], v[196:199], v[80:83]
  buffer_load_dwordx4 v10, s[8:11], s30 offen offset:0 lds
  v_mfma_f32_16x16x32_bf16 v[84:87], a[92:95], v[196:199], v[84:87]
  s_waitcnt lgkmcnt(2)
  v_mfma_f32_16x16x32_bf16 v[88:91], a[84:87], v[200:203], v[88:91]
  ds_read_b128 v[168:171], v18 offset:4096
  v_mfma_f32_16x16x32_bf16 v[92:95], a[88:91], v[200:203], v[92:95]
  s_cmp_lt_u32 s33, 155648
  s_cselect_b32 s33, s33, 98304
  v_mfma_f32_16x16x32_bf16 v[96:99], a[92:95], v[200:203], v[96:99]
  v_mfma_f32_16x16x32_bf16 v[100:103], a[84:87], v[204:207], v[100:103]
  ds_read_b128 v[172:175], v18 offset:6144
  v_mfma_f32_16x16x32_bf16 v[104:107], a[88:91], v[204:207], v[104:107]
  v_mfma_f32_16x16x32_bf16 v[108:111], a[92:95], v[204:207], v[108:111]
  s_waitcnt lgkmcnt(2)
  s_waitcnt vmcnt(20)
  s_barrier
  ds_read_b64_tr_b16 a[96:97], v46 offset:0
  ds_read_b64_tr_b16 a[98:99], v46 offset:1536
  ds_read_b64_tr_b16 a[100:101], v47 offset:0
  ds_read_b64_tr_b16 a[102:103], v47 offset:1536
  ds_read_b64_tr_b16 a[104:105], v48 offset:0
  ds_read_b64_tr_b16 a[106:107], v48 offset:1536
  ds_read_b64_tr_b16 a[108:109], v46 offset:12288
  ds_read_b64_tr_b16 a[110:111], v46 offset:13824
  ds_read_b64_tr_b16 a[112:113], v47 offset:12288
  ds_read_b64_tr_b16 a[114:115], v47 offset:13824
  ds_read_b64_tr_b16 a[116:117], v48 offset:12288
  ds_read_b64_tr_b16 a[118:119], v48 offset:13824
  ds_read_b64_tr_b16 a[120:121], v46 offset:24576
  ds_read_b64_tr_b16 a[122:123], v46 offset:26112
  ds_read_b64_tr_b16 a[124:125], v47 offset:24576
  ds_read_b64_tr_b16 a[126:127], v47 offset:26112
  ds_read_b64_tr_b16 a[128:129], v48 offset:24576
  ds_read_b64_tr_b16 a[130:131], v48 offset:26112
  ds_read_b64_tr_b16 a[132:133], v46 offset:36864
  ds_read_b64_tr_b16 a[134:135], v46 offset:38400
  ds_read_b64_tr_b16 a[136:137], v47 offset:36864
  ds_read_b64_tr_b16 a[138:139], v47 offset:38400
  ds_read_b64_tr_b16 a[140:141], v48 offset:36864
  ds_read_b64_tr_b16 a[142:143], v48 offset:38400
  s_waitcnt lgkmcnt(0)
  s_barrier
  s_mov_b32 s23, m0
  s_mul_i32 s21, s20, 393216
  s_add_u32 s21, s21, 6291456
  s_add_u32 s21, s21, s44
  s_mul_i32 s22, s20, 12288
  s_add_u32 s22, s22, 0
  s_add_u32 m0, s22, 0
  s_nop 0
  buffer_load_dwordx4 v40, s[12:15], s21 offen lds
  s_add_u32 m0, s22, 1024
  s_nop 0
  buffer_load_dwordx4 v41, s[12:15], s21 offen lds
  s_add_u32 m0, s22, 2048
  s_nop 0
  buffer_load_dwordx4 v42, s[12:15], s21 offen lds
  s_mul_i32 s21, s20, 393216
  s_add_u32 s21, s21, 6389760
  s_add_u32 s21, s21, s44
  s_mul_i32 s22, s20, 12288
  s_add_u32 s22, s22, 3072
  s_add_u32 m0, s22, 0
  s_nop 0
  buffer_load_dwordx4 v43, s[12:15], s21 offen lds
  s_add_u32 m0, s22, 1024
  s_nop 0
  buffer_load_dwordx4 v44, s[12:15], s21 offen lds
  s_add_u32 m0, s22, 2048
  s_nop 0
  buffer_load_dwordx4 v45, s[12:15], s21 offen lds
  s_mul_i32 s21, s20, 393216
  s_add_u32 s21, s21, 6488064
  s_add_u32 s21, s21, s44
  s_mul_i32 s22, s20, 12288
  s_add_u32 s22, s22, 6144
  s_add_u32 m0, s22, 0
  s_nop 0
  buffer_load_dwordx4 v40, s[12:15], s21 offen lds
  s_add_u32 m0, s22, 1024
  s_nop 0
  buffer_load_dwordx4 v41, s[12:15], s21 offen lds
  s_add_u32 m0, s22, 2048
  s_nop 0
  buffer_load_dwordx4 v42, s[12:15], s21 offen lds
  s_mul_i32 s21, s20, 393216
  s_add_u32 s21, s21, 6586368
  s_add_u32 s21, s21, s44
  s_mul_i32 s22, s20, 12288
  s_add_u32 s22, s22, 9216
  s_add_u32 m0, s22, 0
  s_nop 0
  buffer_load_dwordx4 v43, s[12:15], s21 offen lds
  s_add_u32 m0, s22, 1024
  s_nop 0
  buffer_load_dwordx4 v44, s[12:15], s21 offen lds
  s_add_u32 m0, s22, 2048
  s_nop 0
  buffer_load_dwordx4 v45, s[12:15], s21 offen lds
  s_mov_b32 m0, s23
  v_mov_b32 v29, 76
  buffer_load_dword v29, v29, s[64:67], 0 offen sc1
  v_mfma_f32_16x16x32_bf16 v[64:67], a[96:99], v[160:163], v[64:67]
  ds_read_b128 v[192:195], v19 offset:0
  v_mfma_f32_16x16x32_bf16 v[68:71], a[100:103], v[160:163], v[68:71]
  v_add_u32 v18, s33, v14
  s_mov_b32 s61, s60
  v_mfma_f32_16x16x32_bf16 v[72:75], a[104:107], v[160:163], v[72:75]
  s_add_u32 s60, s60, s62
  s_lshr_b32 s48, s20, 1
  v_mfma_f32_16x16x32_bf16 v[76:79], a[96:99], v[164:167], v[76:79]
  ds_read_b128 v[196:199], v19 offset:2048
  s_mul_i32 s48, s48, 393216
  v_mfma_f32_16x16x32_bf16 v[80:83], a[100:103], v[164:167], v[80:83]
  buffer_load_dwordx4 v11, s[8:11], s30 offen offset:1024 lds
  v_mfma_f32_16x16x32_bf16 v[84:87], a[104:107], v[164:167], v[84:87]
  s_add_u32 s30, s30, s25
  v_mfma_f32_16x16x32_bf16 v[88:91], a[96:99], v[168:171], v[88:91]
  ds_read_b128 v[200:203], v19 offset:4096
  s_sub_u32 s30, s30, 1152
  v_mfma_f32_16x16x32_bf16 v[92:95], a[100:103], v[168:171], v[92:95]
  s_add_u32 m0, m0, 8192
  s_and_b32 s21, s20, 1
  v_mfma_f32_16x16x32_bf16 v[96:99], a[104:107], v[168:171], v[96:99]
  s_cmp_lt_u32 m0, s46
  s_cselect_b32 m0, m0, s47
  v_mfma_f32_16x16x32_bf16 v[100:103], a[96:99], v[172:175], v[100:103]
  ds_read_b128 v[204:207], v19 offset:6144
  s_mul_i32 s21, s21, 6144
  v_mfma_f32_16x16x32_bf16 v[104:107], a[100:103], v[172:175], v[104:107]
  s_add_u32 s48, s48, s21
  s_add_u32 s48, s48, s27
  v_mfma_f32_16x16x32_bf16 v[108:111], a[104:107], v[172:175], v[108:111]
  s_waitcnt vmcnt(33) lgkmcnt(2)
  s_barrier
  v_mfma_f32_16x16x32_bf16 v[64:67], a[108:111], v[192:195], v[64:67]
  ds_read_b128 v[160:163], v18 offset:0
  s_add_u32 s27, s27, s28
  v_mfma_f32_16x16x32_bf16 v[68:71], a[112:115], v[192:195], v[68:71]
  s_sub_u32 s26, s26, 1
  v_mfma_f32_16x16x32_bf16 v[72:75], a[116:119], v[192:195], v[72:75]
  v_add_u32 v19, s33, v15
  s_add_u32 s33, s33, 8192
  v_mfma_f32_16x16x32_bf16 v[76:79], a[108:111], v[196:199], v[76:79]
  ds_read_b128 v[164:167], v18 offset:2048
  v_mfma_f32_16x16x32_bf16 v[80:83], a[112:115], v[196:199], v[80:83]
  buffer_load_dwordx4 v10, s[8:11], s30 offen offset:0 lds
  v_mfma_f32_16x16x32_bf16 v[84:87], a[116:119], v[196:199], v[84:87]
  s_waitcnt lgkmcnt(2)
  v_mfma_f32_16x16x32_bf16 v[88:91], a[108:111], v[200:203], v[88:91]
  ds_read_b128 v[168:171], v18 offset:4096
  v_mfma_f32_16x16x32_bf16 v[92:95], a[112:115], v[200:203], v[92:95]
  s_cmp_lt_u32 s33, 155648
  s_cselect_b32 s33, s33, 98304
  v_mfma_f32_16x16x32_bf16 v[96:99], a[116:119], v[200:203], v[96:99]
  v_mfma_f32_16x16x32_bf16 v[100:103], a[108:111], v[204:207], v[100:103]
  ds_read_b128 v[172:175], v18 offset:6144
  v_mfma_f32_16x16x32_bf16 v[104:107], a[112:115], v[204:207], v[104:107]
  v_mfma_f32_16x16x32_bf16 v[108:111], a[116:119], v[204:207], v[108:111]
  s_waitcnt lgkmcnt(2)
  v_mfma_f32_16x16x32_bf16 v[64:67], a[120:123], v[160:163], v[64:67]
  ds_read_b128 v[192:195], v19 offset:0
  v_mfma_f32_16x16x32_bf16 v[68:71], a[124:127], v[160:163], v[68:71]
  v_add_u32 v18, s33, v14
  v_mfma_f32_16x16x32_bf16 v[72:75], a[128:131], v[160:163], v[72:75]
  v_mfma_f32_16x16x32_bf16 v[76:79], a[120:123], v[164:167], v[76:79]
  ds_read_b128 v[196:199], v19 offset:2048
  v_mfma_f32_16x16x32_bf16 v[80:83], a[124:127], v[164:167], v[80:83]
  buffer_load_dwordx4 v11, s[8:11], s30 offen offset:1024 lds
  v_mfma_f32_16x16x32_bf16 v[84:87], a[128:131], v[164:167], v[84:87]
  s_waitcnt lgkmcnt(2)
  s_add_u32 s30, s30, 128
  v_mfma_f32_16x16x32_bf16 v[88:91], a[120:123], v[168:171], v[88:91]
  ds_read_b128 v[200:203], v19 offset:4096
  s_add_u32 m0, m0, 8192
  v_mfma_f32_16x16x32_bf16 v[92:95], a[124:127], v[168:171], v[92:95]
  s_cmp_lt_u32 m0, s46
  s_cselect_b32 m0, m0, s47
  v_mfma_f32_16x16x32_bf16 v[96:99], a[128:131], v[168:171], v[96:99]
  v_mfma_f32_16x16x32_bf16 v[100:103], a[120:123], v[172:175], v[100:103]
  ds_read_b128 v[204:207], v19 offset:6144
  v_mfma_f32_16x16x32_bf16 v[104:107], a[124:127], v[172:175], v[104:107]
  v_mfma_f32_16x16x32_bf16 v[108:111], a[128:131], v[172:175], v[108:111]
  s_waitcnt vmcnt(33) lgkmcnt(2)
  s_barrier
  v_mfma_f32_16x16x32_bf16 v[64:67], a[132:135], v[192:195], v[64:67]
  ds_read_b128 v[160:163], v18 offset:0
  v_mfma_f32_16x16x32_bf16 v[68:71], a[136:139], v[192:195], v[68:71]
  v_mfma_f32_16x16x32_bf16 v[72:75], a[140:143], v[192:195], v[72:75]
  v_add_u32 v19, s33, v15
  s_add_u32 s33, s33, 8192
  v_mfma_f32_16x16x32_bf16 v[76:79], a[132:135], v[196:199], v[76:79]
  ds_read_b128 v[164:167], v18 offset:2048
  v_mfma_f32_16x16x32_bf16 v[80:83], a[136:139], v[196:199], v[80:83]
  buffer_load_dwordx4 v10, s[8:11], s30 offen offset:0 lds
  v_mfma_f32_16x16x32_bf16 v[84:87], a[140:143], v[196:199], v[84:87]
  s_waitcnt lgkmcnt(2)
  v_mfma_f32_16x16x32_bf16 v[88:91], a[132:135], v[200:203], v[88:91]
  ds_read_b128 v[168:171], v18 offset:4096
  v_mfma_f32_16x16x32_bf16 v[92:95], a[136:139], v[200:203], v[92:95]
  s_cmp_lt_u32 s33, 155648
  s_cselect_b32 s33, s33, 98304
  v_mfma_f32_16x16x32_bf16 v[96:99], a[140:143], v[200:203], v[96:99]
  v_mfma_f32_16x16x32_bf16 v[100:103], a[132:135], v[204:207], v[100:103]
  ds_read_b128 v[172:175], v18 offset:6144
  v_mfma_f32_16x16x32_bf16 v[104:107], a[136:139], v[204:207], v[104:107]
  v_mfma_f32_16x16x32_bf16 v[108:111], a[140:143], v[204:207], v[108:111]
  s_waitcnt lgkmcnt(2)
  s_waitcnt vmcnt(21)
  s_barrier
  ds_read_b64_tr_b16 a[144:145], v49 offset:0
  ds_read_b64_tr_b16 a[146:147], v49 offset:1536
  ds_read_b64_tr_b16 a[148:149], v50 offset:0
  ds_read_b64_tr_b16 a[150:151], v50 offset:1536
  ds_read_b64_tr_b16 a[152:153], v51 offset:0
  ds_read_b64_tr_b16 a[154:155], v51 offset:1536
  ds_read_b64_tr_b16 a[156:157], v49 offset:12288
  ds_read_b64_tr_b16 a[158:159], v49 offset:13824
  ds_read_b64_tr_b16 a[160:161], v50 offset:12288
  ds_read_b64_tr_b16 a[162:163], v50 offset:13824
  ds_read_b64_tr_b16 a[164:165], v51 offset:12288
  ds_read_b64_tr_b16 a[166:167], v51 offset:13824
  ds_read_b64_tr_b16 a[168:169], v49 offset:24576
  ds_read_b64_tr_b16 a[170:171], v49 offset:26112
  ds_read_b64_tr_b16 a[172:173], v50 offset:24576
  ds_read_b64_tr_b16 a[174:175], v50 offset:26112
  ds_read_b64_tr_b16 a[176:177], v51 offset:24576
  ds_read_b64_tr_b16 a[178:179], v51 offset:26112
  ds_read_b64_tr_b16 a[180:181], v49 offset:36864
  ds_read_b64_tr_b16 a[182:183], v49 offset:38400
  ds_read_b64_tr_b16 a[184:185], v50 offset:36864
  ds_read_b64_tr_b16 a[186:187], v50 offset:38400
  ds_read_b64_tr_b16 a[188:189], v51 offset:36864
  ds_read_b64_tr_b16 a[190:191], v51 offset:38400
  s_waitcnt lgkmcnt(0)
  s_barrier
  v_mfma_f32_16x16x32_bf16 v[64:67], a[144:147], v[160:163], v[64:67]
  ds_read_b128 v[192:195], v19 offset:0
  v_mfma_f32_16x16x32_bf16 v[68:71], a[148:151], v[160:163], v[68:71]
  v_add_u32 v18, s33, v14
  v_mfma_f32_16x16x32_bf16 v[72:75], a[152:155], v[160:163], v[72:75]
  v_mfma_f32_16x16x32_bf16 v[76:79], a[144:147], v[164:167], v[76:79]
  ds_read_b128 v[196:199], v19 offset:2048
  v_mfma_f32_16x16x32_bf16 v[80:83], a[148:151], v[164:167], v[80:83]
  buffer_load_dwordx4 v11, s[8:11], s30 offen offset:1024 lds
  v_mfma_f32_16x16x32_bf16 v[84:87], a[152:155], v[164:167], v[84:87]
  s_add_u32 s30, s30, 128
  v_mfma_f32_16x16x32_bf16 v[88:91], a[144:147], v[168:171], v[88:91]
  ds_read_b128 v[200:203], v19 offset:4096
  s_add_u32 m0, m0, 8192
  v_mfma_f32_16x16x32_bf16 v[92:95], a[148:151], v[168:171], v[92:95]
  s_cmp_lt_u32 m0, s46
  s_cselect_b32 m0, m0, s47
  v_mfma_f32_16x16x32_bf16 v[96:99], a[152:155], v[168:171], v[96:99]
  v_mfma_f32_16x16x32_bf16 v[100:103], a[144:147], v[172:175], v[100:103]
  ds_read_b128 v[204:207], v19 offset:6144
  v_mfma_f32_16x16x32_bf16 v[104:107], a[148:151], v[172:175], v[104:107]
  v_mfma_f32_16x16x32_bf16 v[108:111], a[152:155], v[172:175], v[108:111]
  s_waitcnt vmcnt(21) lgkmcnt(2)
  s_barrier
  v_mfma_f32_16x16x32_bf16 v[64:67], a[156:159], v[192:195], v[64:67]
  ds_read_b128 v[160:163], v18 offset:0
  v_mfma_f32_16x16x32_bf16 v[68:71], a[160:163], v[192:195], v[68:71]
  v_mfma_f32_16x16x32_bf16 v[72:75], a[164:167], v[192:195], v[72:75]
  v_add_u32 v19, s33, v15
  s_add_u32 s33, s33, 8192
  v_mfma_f32_16x16x32_bf16 v[76:79], a[156:159], v[196:199], v[76:79]
  ds_read_b128 v[164:167], v18 offset:2048
  v_mfma_f32_16x16x32_bf16 v[80:83], a[160:163], v[196:199], v[80:83]
  buffer_load_dwordx4 v10, s[8:11], s30 offen offset:0 lds
  v_mfma_f32_16x16x32_bf16 v[84:87], a[164:167], v[196:199], v[84:87]
  s_waitcnt lgkmcnt(2)
  v_mfma_f32_16x16x32_bf16 v[88:91], a[156:159], v[200:203], v[88:91]
  ds_read_b128 v[168:171], v18 offset:4096
  v_mfma_f32_16x16x32_bf16 v[92:95], a[160:163], v[200:203], v[92:95]
  s_cmp_lt_u32 s33, 155648
  s_cselect_b32 s33, s33, 98304
  v_mfma_f32_16x16x32_bf16 v[96:99], a[164:167], v[200:203], v[96:99]
  v_mfma_f32_16x16x32_bf16 v[100:103], a[156:159], v[204:207], v[100:103]
  ds_read_b128 v[172:175], v18 offset:6144
  v_mfma_f32_16x16x32_bf16 v[104:107], a[160:163], v[204:207], v[104:107]
  v_mfma_f32_16x16x32_bf16 v[108:111], a[164:167], v[204:207], v[108:111]
  s_waitcnt lgkmcnt(2)
  v_mfma_f32_16x16x32_bf16 v[64:67], a[168:171], v[160:163], v[64:67]
  ds_read_b128 v[192:195], v19 offset:0
  v_mfma_f32_16x16x32_bf16 v[68:71], a[172:175], v[160:163], v[68:71]
  v_add_u32 v18, s33, v14
  v_mfma_f32_16x16x32_bf16 v[72:75], a[176:179], v[160:163], v[72:75]
  v_mfma_f32_16x16x32_bf16 v[76:79], a[168:171], v[164:167], v[76:79]
  ds_read_b128 v[196:199], v19 offset:2048
  v_mfma_f32_16x16x32_bf16 v[80:83], a[172:175], v[164:167], v[80:83]
  buffer_load_dwordx4 v11, s[8:11], s30 offen offset:1024 lds
  v_mfma_f32_16x16x32_bf16 v[84:87], a[176:179], v[164:167], v[84:87]
  s_waitcnt lgkmcnt(2)
  s_add_u32 s30, s30, 128
  v_mfma_f32_16x16x32_bf16 v[88:91], a[168:171], v[168:171], v[88:91]
  ds_read_b128 v[200:203], v19 offset:4096
  s_add_u32 m0, m0, 8192
  v_mfma_f32_16x16x32_bf16 v[92:95], a[172:175], v[168:171], v[92:95]
  s_cmp_lt_u32 m0, s46
  s_cselect_b32 m0, m0, s47
  v_mfma_f32_16x16x32_bf16 v[96:99], a[176:179], v[168:171], v[96:99]
  v_mfma_f32_16x16x32_bf16 v[100:103], a[168:171], v[172:175], v[100:103]
  ds_read_b128 v[204:207], v19 offset:6144
  v_mfma_f32_16x16x32_bf16 v[104:107], a[172:175], v[172:175], v[104:107]
  v_mfma_f32_16x16x32_bf16 v[108:111], a[176:179], v[172:175], v[108:111]
  s_waitcnt vmcnt(21) lgkmcnt(2)
  s_barrier
  v_mfma_f32_16x16x32_bf16 v[64:67], a[180:183], v[192:195], v[64:67]
  ds_read_b128 v[160:163], v18 offset:0
  v_mfma_f32_16x16x32_bf16 v[68:71], a[184:187], v[192:195], v[68:71]
  v_mfma_f32_16x16x32_bf16 v[72:75], a[188:191], v[192:195], v[72:75]
  v_add_u32 v19, s33, v15
  s_add_u32 s33, s33, 8192
  v_mfma_f32_16x16x32_bf16 v[76:79], a[180:183], v[196:199], v[76:79]
  ds_read_b128 v[164:167], v18 offset:2048
  v_mfma_f32_16x16x32_bf16 v[80:83], a[184:187], v[196:199], v[80:83]
  buffer_load_dwordx4 v10, s[8:11], s30 offen offset:0 lds
  v_mfma_f32_16x16x32_bf16 v[84:87], a[188:191], v[196:199], v[84:87]
  s_waitcnt lgkmcnt(2)
  v_mfma_f32_16x16x32_bf16 v[88:91], a[180:183], v[200:203], v[88:91]
  ds_read_b128 v[168:171], v18 offset:4096
  v_mfma_f32_16x16x32_bf16 v[92:95], a[184:187], v[200:203], v[92:95]
  s_cmp_lt_u32 s33, 155648
  s_cselect_b32 s33, s33, 98304
  v_mfma_f32_16x16x32_bf16 v[96:99], a[188:191], v[200:203], v[96:99]
  v_mfma_f32_16x16x32_bf16 v[100:103], a[180:183], v[204:207], v[100:103]
  ds_read_b128 v[172:175], v18 offset:6144
  v_mfma_f32_16x16x32_bf16 v[104:107], a[184:187], v[204:207], v[104:107]
  v_mfma_f32_16x16x32_bf16 v[108:111], a[188:191], v[204:207], v[108:111]
  s_waitcnt lgkmcnt(2)
  s_waitcnt vmcnt(9)
  s_barrier
  ds_read_b64_tr_b16 a[192:193], v46 offset:0
  ds_read_b64_tr_b16 a[194:195], v46 offset:1536
  ds_read_b64_tr_b16 a[196:197], v47 offset:0
  ds_read_b64_tr_b16 a[198:199], v47 offset:1536
  ds_read_b64_tr_b16 a[200:201], v48 offset:0
  ds_read_b64_tr_b16 a[202:203], v48 offset:1536
  ds_read_b64_tr_b16 a[204:205], v46 offset:12288
  ds_read_b64_tr_b16 a[206:207], v46 offset:13824
  ds_read_b64_tr_b16 a[208:209], v47 offset:12288
  ds_read_b64_tr_b16 a[210:211], v47 offset:13824
  ds_read_b64_tr_b16 a[212:213], v48 offset:12288
  ds_read_b64_tr_b16 a[214:215], v48 offset:13824
  ds_read_b64_tr_b16 a[216:217], v46 offset:24576
  ds_read_b64_tr_b16 a[218:219], v46 offset:26112
  ds_read_b64_tr_b16 a[220:221], v47 offset:24576
  ds_read_b64_tr_b16 a[222:223], v47 offset:26112
  ds_read_b64_tr_b16 a[224:225], v48 offset:24576
  ds_read_b64_tr_b16 a[226:227], v48 offset:26112
  ds_read_b64_tr_b16 a[228:229], v46 offset:36864
  ds_read_b64_tr_b16 a[230:231], v46 offset:38400
  ds_read_b64_tr_b16 a[232:233], v47 offset:36864
  ds_read_b64_tr_b16 a[234:235], v47 offset:38400
  ds_read_b64_tr_b16 a[236:237], v48 offset:36864
  ds_read_b64_tr_b16 a[238:239], v48 offset:38400
  s_waitcnt lgkmcnt(0)
  s_barrier
  v_mfma_f32_16x16x32_bf16 v[64:67], a[192:195], v[160:163], v[64:67]
  ds_read_b128 v[192:195], v19 offset:0
  v_mfma_f32_16x16x32_bf16 v[68:71], a[196:199], v[160:163], v[68:71]
  v_add_u32 v18, s33, v14
  v_mfma_f32_16x16x32_bf16 v[72:75], a[200:203], v[160:163], v[72:75]
  v_mfma_f32_16x16x32_bf16 v[76:79], a[192:195], v[164:167], v[76:79]
  ds_read_b128 v[196:199], v19 offset:2048
  v_mfma_f32_16x16x32_bf16 v[80:83], a[196:199], v[164:167], v[80:83]
  buffer_load_dwordx4 v11, s[8:11], s30 offen offset:1024 lds
  v_mfma_f32_16x16x32_bf16 v[84:87], a[200:203], v[164:167], v[84:87]
  s_add_u32 s30, s30, 128
  v_mfma_f32_16x16x32_bf16 v[88:91], a[192:195], v[168:171], v[88:91]
  ds_read_b128 v[200:203], v19 offset:4096
  s_add_u32 m0, m0, 8192
  v_mfma_f32_16x16x32_bf16 v[92:95], a[196:199], v[168:171], v[92:95]
  s_cmp_lt_u32 m0, s46
  s_cselect_b32 m0, m0, s47
  v_mfma_f32_16x16x32_bf16 v[96:99], a[200:203], v[168:171], v[96:99]
  v_mfma_f32_16x16x32_bf16 v[100:103], a[192:195], v[172:175], v[100:103]
  ds_read_b128 v[204:207], v19 offset:6144
  v_mfma_f32_16x16x32_bf16 v[104:107], a[196:199], v[172:175], v[104:107]
  v_mfma_f32_16x16x32_bf16 v[108:111], a[200:203], v[172:175], v[108:111]
  s_waitcnt vmcnt(8) lgkmcnt(2)
  s_barrier
  v_mfma_f32_16x16x32_bf16 v[64:67], a[204:207], v[192:195], v[64:67]
  ds_read_b128 v[160:163], v18 offset:0
  v_mfma_f32_16x16x32_bf16 v[68:71], a[208:211], v[192:195], v[68:71]
  v_mfma_f32_16x16x32_bf16 v[72:75], a[212:215], v[192:195], v[72:75]
  v_add_u32 v19, s33, v15
  s_add_u32 s33, s33, 8192
  v_mfma_f32_16x16x32_bf16 v[76:79], a[204:207], v[196:199], v[76:79]
  ds_read_b128 v[164:167], v18 offset:2048
  v_mfma_f32_16x16x32_bf16 v[80:83], a[208:211], v[196:199], v[80:83]
  buffer_load_dwordx4 v10, s[8:11], s30 offen offset:0 lds
  v_mfma_f32_16x16x32_bf16 v[84:87], a[212:215], v[196:199], v[84:87]
  s_waitcnt lgkmcnt(2)
  v_mfma_f32_16x16x32_bf16 v[88:91], a[204:207], v[200:203], v[88:91]
  ds_read_b128 v[168:171], v18 offset:4096
  v_mfma_f32_16x16x32_bf16 v[92:95], a[208:211], v[200:203], v[92:95]
  s_cmp_lt_u32 s33, 155648
  s_cselect_b32 s33, s33, 98304
  v_mfma_f32_16x16x32_bf16 v[96:99], a[212:215], v[200:203], v[96:99]
  v_mfma_f32_16x16x32_bf16 v[100:103], a[204:207], v[204:207], v[100:103]
  ds_read_b128 v[172:175], v18 offset:6144
  v_mfma_f32_16x16x32_bf16 v[104:107], a[208:211], v[204:207], v[104:107]
  v_mfma_f32_16x16x32_bf16 v[108:111], a[212:215], v[204:207], v[108:111]
  s_waitcnt lgkmcnt(2)
  v_mfma_f32_16x16x32_bf16 v[64:67], a[216:219], v[160:163], v[64:67]
  ds_read_b128 v[192:195], v19 offset:0
  v_mfma_f32_16x16x32_bf16 v[68:71], a[220:223], v[160:163], v[68:71]
  v_add_u32 v18, s33, v14
  v_mfma_f32_16x16x32_bf16 v[72:75], a[224:227], v[160:163], v[72:75]
  v_mfma_f32_16x16x32_bf16 v[76:79], a[216:219], v[164:167], v[76:79]
  ds_read_b128 v[196:199], v19 offset:2048
  v_mfma_f32_16x16x32_bf16 v[80:83], a[220:223], v[164:167], v[80:83]
  buffer_load_dwordx4 v11, s[8:11], s30 offen offset:1024 lds
  v_mfma_f32_16x16x32_bf16 v[84:87], a[224:227], v[164:167], v[84:87]
  s_waitcnt lgkmcnt(2)
  s_add_u32 s30, s30, 128
  v_mfma_f32_16x16x32_bf16 v[88:91], a[216:219], v[168:171], v[88:91]
  ds_read_b128 v[200:203], v19 offset:4096
  s_add_u32 m0, m0, 8192
  v_mfma_f32_16x16x32_bf16 v[92:95], a[220:223], v[168:171], v[92:95]
  s_cmp_lt_u32 m0, s46
  s_cselect_b32 m0, m0, s47
  v_mfma_f32_16x16x32_bf16 v[96:99], a[224:227], v[168:171], v[96:99]
  v_mfma_f32_16x16x32_bf16 v[100:103], a[216:219], v[172:175], v[100:103]
  ds_read_b128 v[204:207], v19 offset:6144
  v_mfma_f32_16x16x32_bf16 v[104:107], a[220:223], v[172:175], v[104:107]
  v_mfma_f32_16x16x32_bf16 v[108:111], a[224:227], v[172:175], v[108:111]
  s_waitcnt vmcnt(8) lgkmcnt(2)
  s_barrier
  v_mfma_f32_16x16x32_bf16 v[64:67], a[228:231], v[192:195], v[64:67]
  ds_read_b128 v[160:163], v18 offset:0
  v_mfma_f32_16x16x32_bf16 v[68:71], a[232:235], v[192:195], v[68:71]
  v_mfma_f32_16x16x32_bf16 v[72:75], a[236:239], v[192:195], v[72:75]
  v_add_u32 v19, s33, v15
  s_add_u32 s33, s33, 8192
  v_mfma_f32_16x16x32_bf16 v[76:79], a[228:231], v[196:199], v[76:79]
  ds_read_b128 v[164:167], v18 offset:2048
  v_cvt_pk_bf16_f32 v224, v64, v65
  v_cvt_pk_bf16_f32 v225, v66, v67
  v_mfma_f32_16x16x32_bf16 v[80:83], a[232:235], v[196:199], v[80:83]
  buffer_load_dwordx4 v10, s[8:11], s30 offen offset:0 lds
  v_cvt_pk_bf16_f32 v226, v68, v69
  v_cvt_pk_bf16_f32 v227, v70, v71
  v_mfma_f32_16x16x32_bf16 v[84:87], a[236:239], v[196:199], v[84:87]
  s_waitcnt lgkmcnt(2)
  v_cvt_pk_bf16_f32 v228, v72, v73
  v_cvt_pk_bf16_f32 v229, v74, v75
  v_mfma_f32_16x16x32_bf16 v[88:91], a[228:231], v[200:203], v[88:91]
  ds_read_b128 v[168:171], v18 offset:4096
  ds_write_b64 v22, v[224:225] offset:0
  v_mfma_f32_16x16x32_bf16 v[92:95], a[232:235], v[200:203], v[92:95]
  s_cmp_lt_u32 s33, 155648
  s_cselect_b32 s33, s33, 98304
  ds_write_b64 v22, v[226:227] offset:8
  v_mfma_f32_16x16x32_bf16 v[96:99], a[236:239], v[200:203], v[96:99]
  ds_write_b64 v16, v[228:229] offset:64
  v_cvt_pk_bf16_f32 v230, v76, v77
  v_cvt_pk_bf16_f32 v231, v78, v79
  v_mfma_f32_16x16x32_bf16 v[100:103], a[228:231], v[204:207], v[100:103]
  ds_read_b128 v[172:175], v18 offset:6144
  v_cvt_pk_bf16_f32 v232, v80, v81
  v_cvt_pk_bf16_f32 v233, v82, v83
  v_cvt_pk_bf16_f32 v234, v84, v85
  v_mfma_f32_16x16x32_bf16 v[104:107], a[232:235], v[204:207], v[104:107]
  v_cvt_pk_bf16_f32 v235, v86, v87
  ds_write_b64 v22, v[230:231] offset:6400
  v_mfma_f32_16x16x32_bf16 v[108:111], a[236:239], v[204:207], v[108:111]
  ds_write_b64 v22, v[232:233] offset:6408
  ds_write_b64 v16, v[234:235] offset:6464
  v_readfirstlane_b32 s21, v29
  s_cmp_ge_u32 s21, 32
  s_cbranch_scc1 kvz_159
  s_mov_b32 s21, 76
  v_mov_b32 v4, 0
  s_mov_b32 s101, 0
wf_160:
  buffer_load_dword v5, v4, s[64:67], s21 offen sc1
  s_add_u32 s101, s101, 1
  s_cmp_gt_u32 s101, 131072
  s_cbranch_scc1 main_end
  s_waitcnt vmcnt(0)
  v_readfirstlane_b32 s100, v5
  s_cmp_ge_u32 s100, 32
  s_cbranch_scc1 wf_161
  s_sleep 8
  s_branch wf_160
wf_161:
kvz_159:
  s_branch kvm_end_158
kvm_blk_157:
  v_mfma_f32_16x16x32_bf16 v[64:67], a[0:3], v[160:163], 0
  ds_read_b128 v[192:195], v19 offset:0
  v_mfma_f32_16x16x32_bf16 v[68:71], a[4:7], v[160:163], 0
  v_add_u32 v18, s33, v14
  v_mfma_f32_16x16x32_bf16 v[72:75], a[8:11], v[160:163], 0
  v_mfma_f32_16x16x32_bf16 v[76:79], a[0:3], v[164:167], 0
  ds_read_b128 v[196:199], v19 offset:2048
  v_mfma_f32_16x16x32_bf16 v[80:83], a[4:7], v[164:167], 0
  buffer_load_dwordx4 v11, s[8:11], s30 offen offset:1024 lds
  v_mfma_f32_16x16x32_bf16 v[84:87], a[8:11], v[164:167], 0
  s_waitcnt lgkmcnt(11)
  s_add_u32 s30, s30, 128
  v_mfma_f32_16x16x32_bf16 v[88:91], a[0:3], v[168:171], 0
  ds_read_b128 v[200:203], v19 offset:4096
  s_add_u32 m0, m0, 8192
  v_mfma_f32_16x16x32_bf16 v[92:95], a[4:7], v[168:171], 0
  s_cmp_lt_u32 m0, s46
  s_cselect_b32 m0, m0, s47
  v_mfma_f32_16x16x32_bf16 v[96:99], a[8:11], v[168:171], 0
  v_mfma_f32_16x16x32_bf16 v[100:103], a[0:3], v[172:175], 0
  ds_read_b128 v[204:207], v19 offset:6144
  v_mfma_f32_16x16x32_bf16 v[104:107], a[4:7], v[172:175], 0
  v_mfma_f32_16x16x32_bf16 v[108:111], a[8:11], v[172:175], 0
  s_waitcnt vmcnt(14) lgkmcnt(2)
  s_barrier
  v_mfma_f32_16x16x32_bf16 v[64:67], a[12:15], v[192:195], v[64:67]
  ds_read_b128 v[160:163], v18 offset:0
  v_mfma_f32_16x16x32_bf16 v[68:71], a[16:19], v[192:195], v[68:71]
  v_mfma_f32_16x16x32_bf16 v[72:75], a[20:23], v[192:195], v[72:75]
  v_add_u32 v19, s33, v15
  s_add_u32 s33, s33, 8192
  v_mfma_f32_16x16x32_bf16 v[76:79], a[12:15], v[196:199], v[76:79]
  ds_read_b128 v[164:167], v18 offset:2048
  v_mfma_f32_16x16x32_bf16 v[80:83], a[16:19], v[196:199], v[80:83]
  buffer_load_dwordx4 v10, s[8:11], s30 offen offset:0 lds
  v_mfma_f32_16x16x32_bf16 v[84:87], a[20:23], v[196:199], v[84:87]
  s_waitcnt lgkmcnt(2)
  v_mfma_f32_16x16x32_bf16 v[88:91], a[12:15], v[200:203], v[88:91]
  ds_read_b128 v[168:171], v18 offset:4096
  v_mfma_f32_16x16x32_bf16 v[92:95], a[16:19], v[200:203], v[92:95]
  s_cmp_lt_u32 s33, 155648
  s_cselect_b32 s33, s33, 98304
  v_mfma_f32_16x16x32_bf16 v[96:99], a[20:23], v[200:203], v[96:99]
  v_mfma_f32_16x16x32_bf16 v[100:103], a[12:15], v[204:207], v[100:103]
  ds_read_b128 v[172:175], v18 offset:6144
  v_mfma_f32_16x16x32_bf16 v[104:107], a[16:19], v[204:207], v[104:107]
  v_mfma_f32_16x16x32_bf16 v[108:111], a[20:23], v[204:207], v[108:111]
  s_waitcnt lgkmcnt(2)
  v_mfma_f32_16x16x32_bf16 v[64:67], a[24:27], v[160:163], v[64:67]
  ds_read_b128 v[192:195], v19 offset:0
  v_mfma_f32_16x16x32_bf16 v[68:71], a[28:31], v[160:163], v[68:71]
  v_add_u32 v18, s33, v14
  v_mfma_f32_16x16x32_bf16 v[72:75], a[32:35], v[160:163], v[72:75]
  v_mfma_f32_16x16x32_bf16 v[76:79], a[24:27], v[164:167], v[76:79]
  ds_read_b128 v[196:199], v19 offset:2048
  v_mfma_f32_16x16x32_bf16 v[80:83], a[28:31], v[164:167], v[80:83]
  buffer_load_dwordx4 v11, s[8:11], s30 offen offset:1024 lds
  v_mfma_f32_16x16x32_bf16 v[84:87], a[32:35], v[164:167], v[84:87]
  s_waitcnt lgkmcnt(2)
  s_add_u32 s30, s30, 128
  v_mfma_f32_16x16x32_bf16 v[88:91], a[24:27], v[168:171], v[88:91]
  ds_read_b128 v[200:203], v19 offset:4096
  s_add_u32 m0, m0, 8192
  v_mfma_f32_16x16x32_bf16 v[92:95], a[28:31], v[168:171], v[92:95]
  s_cmp_lt_u32 m0, s46
  s_cselect_b32 m0, m0, s47
  v_mfma_f32_16x16x32_bf16 v[96:99], a[32:35], v[168:171], v[96:99]
  v_mfma_f32_16x16x32_bf16 v[100:103], a[24:27], v[172:175], v[100:103]
  ds_read_b128 v[204:207], v19 offset:6144
  v_mfma_f32_16x16x32_bf16 v[104:107], a[28:31], v[172:175], v[104:107]
  v_mfma_f32_16x16x32_bf16 v[108:111], a[32:35], v[172:175], v[108:111]
  s_waitcnt vmcnt(14) lgkmcnt(2)
  s_barrier
  v_mfma_f32_16x16x32_bf16 v[64:67], a[36:39], v[192:195], v[64:67]
  ds_read_b128 v[160:163], v18 offset:0
  v_mfma_f32_16x16x32_bf16 v[68:71], a[40:43], v[192:195], v[68:71]
  v_mfma_f32_16x16x32_bf16 v[72:75], a[44:47], v[192:195], v[72:75]
  v_add_u32 v19, s33, v15
  s_add_u32 s33, s33, 8192
  v_mfma_f32_16x16x32_bf16 v[76:79], a[36:39], v[196:199], v[76:79]
  ds_read_b128 v[164:167], v18 offset:2048
  v_mfma_f32_16x16x32_bf16 v[80:83], a[40:43], v[196:199], v[80:83]
  buffer_load_dwordx4 v10, s[8:11], s30 offen offset:0 lds
  v_mfma_f32_16x16x32_bf16 v[84:87], a[44:47], v[196:199], v[84:87]
  s_waitcnt lgkmcnt(2)
  v_mfma_f32_16x16x32_bf16 v[88:91], a[36:39], v[200:203], v[88:91]
  ds_read_b128 v[168:171], v18 offset:4096
  v_mfma_f32_16x16x32_bf16 v[92:95], a[40:43], v[200:203], v[92:95]
  s_cmp_lt_u32 s33, 155648
  s_cselect_b32 s33, s33, 98304
  v_mfma_f32_16x16x32_bf16 v[96:99], a[44:47], v[200:203], v[96:99]
  v_mfma_f32_16x16x32_bf16 v[100:103], a[36:39], v[204:207], v[100:103]
  ds_read_b128 v[172:175], v18 offset:6144
  v_mfma_f32_16x16x32_bf16 v[104:107], a[40:43], v[204:207], v[104:107]
  v_mfma_f32_16x16x32_bf16 v[108:111], a[44:47], v[204:207], v[108:111]
  s_waitcnt lgkmcnt(2)
  v_mfma_f32_16x16x32_bf16 v[64:67], a[48:51], v[160:163], v[64:67]
  ds_read_b128 v[192:195], v19 offset:0
  v_mfma_f32_16x16x32_bf16 v[68:71], a[52:55], v[160:163], v[68:71]
  v_add_u32 v18, s33, v14
  v_mfma_f32_16x16x32_bf16 v[72:75], a[56:59], v[160:163], v[72:75]
  v_mfma_f32_16x16x32_bf16 v[76:79], a[48:51], v[164:167], v[76:79]
  ds_read_b128 v[196:199], v19 offset:2048
  v_mfma_f32_16x16x32_bf16 v[80:83], a[52:55], v[164:167], v[80:83]
  buffer_load_dwordx4 v11, s[8:11], s30 offen offset:1024 lds
  v_mfma_f32_16x16x32_bf16 v[84:87], a[56:59], v[164:167], v[84:87]
  s_waitcnt lgkmcnt(2)
  s_add_u32 s30, s30, 128
  v_mfma_f32_16x16x32_bf16 v[88:91], a[48:51], v[168:171], v[88:91]
  ds_read_b128 v[200:203], v19 offset:4096
  s_add_u32 m0, m0, 8192
  v_mfma_f32_16x16x32_bf16 v[92:95], a[52:55], v[168:171], v[92:95]
  s_cmp_lt_u32 m0, s46
  s_cselect_b32 m0, m0, s47
  v_mfma_f32_16x16x32_bf16 v[96:99], a[56:59], v[168:171], v[96:99]
  v_mfma_f32_16x16x32_bf16 v[100:103], a[48:51], v[172:175], v[100:103]
  ds_read_b128 v[204:207], v19 offset:6144
  v_mfma_f32_16x16x32_bf16 v[104:107], a[52:55], v[172:175], v[104:107]
  v_mfma_f32_16x16x32_bf16 v[108:111], a[56:59], v[172:175], v[108:111]
  s_waitcnt vmcnt(14) lgkmcnt(2)
  s_barrier
  v_mfma_f32_16x16x32_bf16 v[64:67], a[60:63], v[192:195], v[64:67]
  ds_read_b128 v[160:163], v18 offset:0
  v_mfma_f32_16x16x32_bf16 v[68:71], a[64:67], v[192:195], v[68:71]
  v_mfma_f32_16x16x32_bf16 v[72:75], a[68:71], v[192:195], v[72:75]
  v_add_u32 v19, s33, v15
  s_add_u32 s33, s33, 8192
  v_mfma_f32_16x16x32_bf16 v[76:79], a[60:63], v[196:199], v[76:79]
  ds_read_b128 v[164:167], v18 offset:2048
  v_mfma_f32_16x16x32_bf16 v[80:83], a[64:67], v[196:199], v[80:83]
  buffer_load_dwordx4 v10, s[8:11], s30 offen offset:0 lds
  v_mfma_f32_16x16x32_bf16 v[84:87], a[68:71], v[196:199], v[84:87]
  s_waitcnt lgkmcnt(2)
  v_mfma_f32_16x16x32_bf16 v[88:91], a[60:63], v[200:203], v[88:91]
  ds_read_b128 v[168:171], v18 offset:4096
  v_mfma_f32_16x16x32_bf16 v[92:95], a[64:67], v[200:203], v[92:95]
  s_cmp_lt_u32 s33, 155648
  s_cselect_b32 s33, s33, 98304
  v_mfma_f32_16x16x32_bf16 v[96:99], a[68:71], v[200:203], v[96:99]
  v_mfma_f32_16x16x32_bf16 v[100:103], a[60:63], v[204:207], v[100:103]
  ds_read_b128 v[172:175], v18 offset:6144
  v_mfma_f32_16x16x32_bf16 v[104:107], a[64:67], v[204:207], v[104:107]
  v_mfma_f32_16x16x32_bf16 v[108:111], a[68:71], v[204:207], v[108:111]
  s_waitcnt lgkmcnt(2)
  v_mfma_f32_16x16x32_bf16 v[64:67], a[72:75], v[160:163], v[64:67]
  ds_read_b128 v[192:195], v19 offset:0
  v_mfma_f32_16x16x32_bf16 v[68:71], a[76:79], v[160:163], v[68:71]
  v_add_u32 v18, s33, v14
  v_mfma_f32_16x16x32_bf16 v[72:75], a[80:83], v[160:163], v[72:75]
  v_mfma_f32_16x16x32_bf16 v[76:79], a[72:75], v[164:167], v[76:79]
  ds_read_b128 v[196:199], v19 offset:2048
  v_mfma_f32_16x16x32_bf16 v[80:83], a[76:79], v[164:167], v[80:83]
  buffer_load_dwordx4 v11, s[8:11], s30 offen offset:1024 lds
  v_mfma_f32_16x16x32_bf16 v[84:87], a[80:83], v[164:167], v[84:87]
  s_waitcnt lgkmcnt(2)
  s_add_u32 s30, s30, 128
  v_mfma_f32_16x16x32_bf16 v[88:91], a[72:75], v[168:171], v[88:91]
  ds_read_b128 v[200:203], v19 offset:4096
  s_add_u32 m0, m0, 8192
  v_mfma_f32_16x16x32_bf16 v[92:95], a[76:79], v[168:171], v[92:95]
  s_cmp_lt_u32 m0, s46
  s_cselect_b32 m0, m0, s47
  v_mfma_f32_16x16x32_bf16 v[96:99], a[80:83], v[168:171], v[96:99]
  v_mfma_f32_16x16x32_bf16 v[100:103], a[72:75], v[172:175], v[100:103]
  ds_read_b128 v[204:207], v19 offset:6144
  v_mfma_f32_16x16x32_bf16 v[104:107], a[76:79], v[172:175], v[104:107]
  v_mfma_f32_16x16x32_bf16 v[108:111], a[80:83], v[172:175], v[108:111]
  s_waitcnt vmcnt(7) lgkmcnt(2)
  s_barrier
  v_mfma_f32_16x16x32_bf16 v[64:67], a[84:87], v[192:195], v[64:67]
  ds_read_b128 v[160:163], v18 offset:0
  v_mfma_f32_16x16x32_bf16 v[68:71], a[88:91], v[192:195], v[68:71]
  s_cmp_eq_u32 s48, 0x80000000
  s_cbranch_scc1 kvm_155
  s_cmp_lg_u32 s20, 0
  s_cbranch_scc1 af_156
  v_mov_b32 v4, 0
  v_mov_b32 v5, 1
  s_mov_b64 exec, 1
  buffer_atomic_add v5, v4, s[72:75], s61 offen sc1
  s_mov_b64 exec, -1
  s_nop 1
af_156:
kvm_155:
  v_mfma_f32_16x16x32_bf16 v[72:75], a[92:95], v[192:195], v[72:75]
  v_add_u32 v19, s33, v15
  s_add_u32 s33, s33, 8192
  v_mfma_f32_16x16x32_bf16 v[76:79], a[84:87], v[196:199], v[76:79]
  ds_read_b128 v[164:167], v18 offset:2048
  v_mfma_f32_16x16x32_bf16 v[80:83], a[88:91], v[196:199], v[80:83]
  buffer_load_dwordx4 v10, s[8:11], s30 offen offset:0 lds
  v_mfma_f32_16x16x32_bf16 v[84:87], a[92:95], v[196:199], v[84:87]
  s_waitcnt lgkmcnt(2)
  v_mfma_f32_16x16x32_bf16 v[88:91], a[84:87], v[200:203], v[88:91]
  ds_read_b128 v[168:171], v18 offset:4096
  v_mfma_f32_16x16x32_bf16 v[92:95], a[88:91], v[200:203], v[92:95]
  s_cmp_lt_u32 s33, 155648
  s_cselect_b32 s33, s33, 98304
  v_mfma_f32_16x16x32_bf16 v[96:99], a[92:95], v[200:203], v[96:99]
  v_mfma_f32_16x16x32_bf16 v[100:103], a[84:87], v[204:207], v[100:103]
  ds_read_b128 v[172:175], v18 offset:6144
  v_mfma_f32_16x16x32_bf16 v[104:107], a[88:91], v[204:207], v[104:107]
  v_mfma_f32_16x16x32_bf16 v[108:111], a[92:95], v[204:207], v[108:111]
  s_waitcnt lgkmcnt(2)
  v_mfma_f32_16x16x32_bf16 v[64:67], a[96:99], v[160:163], v[64:67]
  ds_read_b128 v[192:195], v19 offset:0
  v_mfma_f32_16x16x32_bf16 v[68:71], a[100:103], v[160:163], v[68:71]
  v_add_u32 v18, s33, v14
  s_mov_b32 s61, s60
  v_mfma_f32_16x16x32_bf16 v[72:75], a[104:107], v[160:163], v[72:75]
  s_add_u32 s60, s60, s62
  s_lshr_b32 s48, s20, 1
  v_mfma_f32_16x16x32_bf16 v[76:79], a[96:99], v[164:167], v[76:79]
  ds_read_b128 v[196:199], v19 offset:2048
  s_mul_i32 s48, s48, 393216
  v_mfma_f32_16x16x32_bf16 v[80:83], a[100:103], v[164:167], v[80:83]
  buffer_load_dwordx4 v11, s[8:11], s30 offen offset:1024 lds
  v_mfma_f32_16x16x32_bf16 v[84:87], a[104:107], v[164:167], v[84:87]
  s_waitcnt lgkmcnt(2)
  s_add_u32 s30, s30, s25
  v_mfma_f32_16x16x32_bf16 v[88:91], a[96:99], v[168:171], v[88:91]
  ds_read_b128 v[200:203], v19 offset:4096
  s_sub_u32 s30, s30, 1152
  v_mfma_f32_16x16x32_bf16 v[92:95], a[100:103], v[168:171], v[92:95]
  s_add_u32 m0, m0, 8192
  s_and_b32 s21, s20, 1
  v_mfma_f32_16x16x32_bf16 v[96:99], a[104:107], v[168:171], v[96:99]
  s_cmp_lt_u32 m0, s46
  s_cselect_b32 m0, m0, s47
  v_mfma_f32_16x16x32_bf16 v[100:103], a[96:99], v[172:175], v[100:103]
  ds_read_b128 v[204:207], v19 offset:6144
  s_mul_i32 s21, s21, 6144
  v_mfma_f32_16x16x32_bf16 v[104:107], a[100:103], v[172:175], v[104:107]
  s_add_u32 s48, s48, s21
  s_add_u32 s48, s48, s27
  v_mfma_f32_16x16x32_bf16 v[108:111], a[104:107], v[172:175], v[108:111]
  s_waitcnt vmcnt(8) lgkmcnt(2)
  s_barrier
  v_mfma_f32_16x16x32_bf16 v[64:67], a[108:111], v[192:195], v[64:67]
  ds_read_b128 v[160:163], v18 offset:0
  s_add_u32 s27, s27, s28
  v_mfma_f32_16x16x32_bf16 v[68:71], a[112:115], v[192:195], v[68:71]
  s_sub_u32 s26, s26, 1
  v_mfma_f32_16x16x32_bf16 v[72:75], a[116:119], v[192:195], v[72:75]
  v_add_u32 v19, s33, v15
  s_add_u32 s33, s33, 8192
  v_mfma_f32_16x16x32_bf16 v[76:79], a[108:111], v[196:199], v[76:79]
  ds_read_b128 v[164:167], v18 offset:2048
  v_mfma_f32_16x16x32_bf16 v[80:83], a[112:115], v[196:199], v[80:83]
  buffer_load_dwordx4 v10, s[8:11], s30 offen offset:0 lds
  v_mfma_f32_16x16x32_bf16 v[84:87], a[116:119], v[196:199], v[84:87]
  s_waitcnt lgkmcnt(2)
  v_mfma_f32_16x16x32_bf16 v[88:91], a[108:111], v[200:203], v[88:91]
  ds_read_b128 v[168:171], v18 offset:4096
  v_mfma_f32_16x16x32_bf16 v[92:95], a[112:115], v[200:203], v[92:95]
  s_cmp_lt_u32 s33, 155648
  s_cselect_b32 s33, s33, 98304
  v_mfma_f32_16x16x32_bf16 v[96:99], a[116:119], v[200:203], v[96:99]
  v_mfma_f32_16x16x32_bf16 v[100:103], a[108:111], v[204:207], v[100:103]
  ds_read_b128 v[172:175], v18 offset:6144
  v_mfma_f32_16x16x32_bf16 v[104:107], a[112:115], v[204:207], v[104:107]
  v_mfma_f32_16x16x32_bf16 v[108:111], a[116:119], v[204:207], v[108:111]
  s_waitcnt lgkmcnt(2)
  v_mfma_f32_16x16x32_bf16 v[64:67], a[120:123], v[160:163], v[64:67]
  ds_read_b128 v[192:195], v19 offset:0
  v_mfma_f32_16x16x32_bf16 v[68:71], a[124:127], v[160:163], v[68:71]
  v_add_u32 v18, s33, v14
  v_mfma_f32_16x16x32_bf16 v[72:75], a[128:131], v[160:163], v[72:75]
  v_mfma_f32_16x16x32_bf16 v[76:79], a[120:123], v[164:167], v[76:79]
  ds_read_b128 v[196:199], v19 offset:2048
  v_mfma_f32_16x16x32_bf16 v[80:83], a[124:127], v[164:167], v[80:83]
  buffer_load_dwordx4 v11, s[8:11], s30 offen offset:1024 lds
  v_mfma_f32_16x16x32_bf16 v[84:87], a[128:131], v[164:167], v[84:87]
  s_waitcnt lgkmcnt(2)
  s_add_u32 s30, s30, 128
  v_mfma_f32_16x16x32_bf16 v[88:91], a[120:123], v[168:171], v[88:91]
  ds_read_b128 v[200:203], v19 offset:4096
  s_add_u32 m0, m0, 8192
  v_mfma_f32_16x16x32_bf16 v[92:95], a[124:127], v[168:171], v[92:95]
  s_cmp_lt_u32 m0, s46
  s_cselect_b32 m0, m0, s47
  v_mfma_f32_16x16x32_bf16 v[96:99], a[128:131], v[168:171], v[96:99]
  v_mfma_f32_16x16x32_bf16 v[100:103], a[120:123], v[172:175], v[100:103]
  ds_read_b128 v[204:207], v19 offset:6144
  v_mfma_f32_16x16x32_bf16 v[104:107], a[124:127], v[172:175], v[104:107]
  v_mfma_f32_16x16x32_bf16 v[108:111], a[128:131], v[172:175], v[108:111]
  s_waitcnt vmcnt(8) lgkmcnt(2)
  s_barrier
  v_mfma_f32_16x16x32_bf16 v[64:67], a[132:135], v[192:195], v[64:67]
  ds_read_b128 v[160:163], v18 offset:0
  v_mfma_f32_16x16x32_bf16 v[68:71], a[136:139], v[192:195], v[68:71]
  v_mfma_f32_16x16x32_bf16 v[72:75], a[140:143], v[192:195], v[72:75]
  v_add_u32 v19, s33, v15
  s_add_u32 s33, s33, 8192
  v_mfma_f32_16x16x32_bf16 v[76:79], a[132:135], v[196:199], v[76:79]
  ds_read_b128 v[164:167], v18 offset:2048
  v_mfma_f32_16x16x32_bf16 v[80:83], a[136:139], v[196:199], v[80:83]
  buffer_load_dwordx4 v10, s[8:11], s30 offen offset:0 lds
  v_mfma_f32_16x16x32_bf16 v[84:87], a[140:143], v[196:199], v[84:87]
  s_waitcnt lgkmcnt(2)
  v_mfma_f32_16x16x32_bf16 v[88:91], a[132:135], v[200:203], v[88:91]
  ds_read_b128 v[168:171], v18 offset:4096
  v_mfma_f32_16x16x32_bf16 v[92:95], a[136:139], v[200:203], v[92:95]
  s_cmp_lt_u32 s33, 155648
  s_cselect_b32 s33, s33, 98304
  v_mfma_f32_16x16x32_bf16 v[96:99], a[140:143], v[200:203], v[96:99]
  v_mfma_f32_16x16x32_bf16 v[100:103], a[132:135], v[204:207], v[100:103]
  ds_read_b128 v[172:175], v18 offset:6144
  v_mfma_f32_16x16x32_bf16 v[104:107], a[136:139], v[204:207], v[104:107]
  v_mfma_f32_16x16x32_bf16 v[108:111], a[140:143], v[204:207], v[108:111]
  s_waitcnt lgkmcnt(2)
  v_mfma_f32_16x16x32_bf16 v[64:67], a[144:147], v[160:163], v[64:67]
  ds_read_b128 v[192:195], v19 offset:0
  v_mfma_f32_16x16x32_bf16 v[68:71], a[148:151], v[160:163], v[68:71]
  v_add_u32 v18, s33, v14
  v_mfma_f32_16x16x32_bf16 v[72:75], a[152:155], v[160:163], v[72:75]
  v_mfma_f32_16x16x32_bf16 v[76:79], a[144:147], v[164:167], v[76:79]
  ds_read_b128 v[196:199], v19 offset:2048
  v_mfma_f32_16x16x32_bf16 v[80:83], a[148:151], v[164:167], v[80:83]
  buffer_load_dwordx4 v11, s[8:11], s30 offen offset:1024 lds
  v_mfma_f32_16x16x32_bf16 v[84:87], a[152:155], v[164:167], v[84:87]
  s_waitcnt lgkmcnt(2)
  s_add_u32 s30, s30, 128
  v_mfma_f32_16x16x32_bf16 v[88:91], a[144:147], v[168:171], v[88:91]
  ds_read_b128 v[200:203], v19 offset:4096
  s_add_u32 m0, m0, 8192
  v_mfma_f32_16x16x32_bf16 v[92:95], a[148:151], v[168:171], v[92:95]
  s_cmp_lt_u32 m0, s46
  s_cselect_b32 m0, m0, s47
  v_mfma_f32_16x16x32_bf16 v[96:99], a[152:155], v[168:171], v[96:99]
  v_mfma_f32_16x16x32_bf16 v[100:103], a[144:147], v[172:175], v[100:103]
  ds_read_b128 v[204:207], v19 offset:6144
  v_mfma_f32_16x16x32_bf16 v[104:107], a[148:151], v[172:175], v[104:107]
  v_mfma_f32_16x16x32_bf16 v[108:111], a[152:155], v[172:175], v[108:111]
  s_waitcnt vmcnt(8) lgkmcnt(2)
  s_barrier
  v_mfma_f32_16x16x32_bf16 v[64:67], a[156:159], v[192:195], v[64:67]
  ds_read_b128 v[160:163], v18 offset:0
  v_mfma_f32_16x16x32_bf16 v[68:71], a[160:163], v[192:195], v[68:71]
  v_mfma_f32_16x16x32_bf16 v[72:75], a[164:167], v[192:195], v[72:75]
  v_add_u32 v19, s33, v15
  s_add_u32 s33, s33, 8192
  v_mfma_f32_16x16x32_bf16 v[76:79], a[156:159], v[196:199], v[76:79]
  ds_read_b128 v[164:167], v18 offset:2048
  v_mfma_f32_16x16x32_bf16 v[80:83], a[160:163], v[196:199], v[80:83]
  buffer_load_dwordx4 v10, s[8:11], s30 offen offset:0 lds
  v_mfma_f32_16x16x32_bf16 v[84:87], a[164:167], v[196:199], v[84:87]
  s_waitcnt lgkmcnt(2)
  v_mfma_f32_16x16x32_bf16 v[88:91], a[156:159], v[200:203], v[88:91]
  ds_read_b128 v[168:171], v18 offset:4096
  v_mfma_f32_16x16x32_bf16 v[92:95], a[160:163], v[200:203], v[92:95]
  s_cmp_lt_u32 s33, 155648
  s_cselect_b32 s33, s33, 98304
  v_mfma_f32_16x16x32_bf16 v[96:99], a[164:167], v[200:203], v[96:99]
  v_mfma_f32_16x16x32_bf16 v[100:103], a[156:159], v[204:207], v[100:103]
  ds_read_b128 v[172:175], v18 offset:6144
  v_mfma_f32_16x16x32_bf16 v[104:107], a[160:163], v[204:207], v[104:107]
  v_mfma_f32_16x16x32_bf16 v[108:111], a[164:167], v[204:207], v[108:111]
  s_waitcnt lgkmcnt(2)
  v_mfma_f32_16x16x32_bf16 v[64:67], a[168:171], v[160:163], v[64:67]
  ds_read_b128 v[192:195], v19 offset:0
  v_mfma_f32_16x16x32_bf16 v[68:71], a[172:175], v[160:163], v[68:71]
  v_add_u32 v18, s33, v14
  v_mfma_f32_16x16x32_bf16 v[72:75], a[176:179], v[160:163], v[72:75]
  v_mfma_f32_16x16x32_bf16 v[76:79], a[168:171], v[164:167], v[76:79]
  ds_read_b128 v[196:199], v19 offset:2048
  v_mfma_f32_16x16x32_bf16 v[80:83], a[172:175], v[164:167], v[80:83]
  buffer_load_dwordx4 v11, s[8:11], s30 offen offset:1024 lds
  v_mfma_f32_16x16x32_bf16 v[84:87], a[176:179], v[164:167], v[84:87]
  s_waitcnt lgkmcnt(2)
  s_add_u32 s30, s30, 128
  v_mfma_f32_16x16x32_bf16 v[88:91], a[168:171], v[168:171], v[88:91]
  ds_read_b128 v[200:203], v19 offset:4096
  s_add_u32 m0, m0, 8192
  v_mfma_f32_16x16x32_bf16 v[92:95], a[172:175], v[168:171], v[92:95]
  s_cmp_lt_u32 m0, s46
  s_cselect_b32 m0, m0, s47
  v_mfma_f32_16x16x32_bf16 v[96:99], a[176:179], v[168:171], v[96:99]
  v_mfma_f32_16x16x32_bf16 v[100:103], a[168:171], v[172:175], v[100:103]
  ds_read_b128 v[204:207], v19 offset:6144
  v_mfma_f32_16x16x32_bf16 v[104:107], a[172:175], v[172:175], v[104:107]
  v_mfma_f32_16x16x32_bf16 v[108:111], a[176:179], v[172:175], v[108:111]
  s_waitcnt vmcnt(8) lgkmcnt(2)
  s_barrier
  v_mfma_f32_16x16x32_bf16 v[64:67], a[180:183], v[192:195], v[64:67]
  ds_read_b128 v[160:163], v18 offset:0
  v_mfma_f32_16x16x32_bf16 v[68:71], a[184:187], v[192:195], v[68:71]
  v_mfma_f32_16x16x32_bf16 v[72:75], a[188:191], v[192:195], v[72:75]
  v_add_u32 v19, s33, v15
  s_add_u32 s33, s33, 8192
  v_mfma_f32_16x16x32_bf16 v[76:79], a[180:183], v[196:199], v[76:79]
  ds_read_b128 v[164:167], v18 offset:2048
  v_mfma_f32_16x16x32_bf16 v[80:83], a[184:187], v[196:199], v[80:83]
  buffer_load_dwordx4 v10, s[8:11], s30 offen offset:0 lds
  v_mfma_f32_16x16x32_bf16 v[84:87], a[188:191], v[196:199], v[84:87]
  s_waitcnt lgkmcnt(2)
  v_mfma_f32_16x16x32_bf16 v[88:91], a[180:183], v[200:203], v[88:91]
  ds_read_b128 v[168:171], v18 offset:4096
  v_mfma_f32_16x16x32_bf16 v[92:95], a[184:187], v[200:203], v[92:95]
  s_cmp_lt_u32 s33, 155648
  s_cselect_b32 s33, s33, 98304
  v_mfma_f32_16x16x32_bf16 v[96:99], a[188:191], v[200:203], v[96:99]
  v_mfma_f32_16x16x32_bf16 v[100:103], a[180:183], v[204:207], v[100:103]
  ds_read_b128 v[172:175], v18 offset:6144
  v_mfma_f32_16x16x32_bf16 v[104:107], a[184:187], v[204:207], v[104:107]
  v_mfma_f32_16x16x32_bf16 v[108:111], a[188:191], v[204:207], v[108:111]
  s_waitcnt lgkmcnt(2)
  v_mfma_f32_16x16x32_bf16 v[64:67], a[192:195], v[160:163], v[64:67]
  ds_read_b128 v[192:195], v19 offset:0
  v_mfma_f32_16x16x32_bf16 v[68:71], a[196:199], v[160:163], v[68:71]
  v_add_u32 v18, s33, v14
  v_mfma_f32_16x16x32_bf16 v[72:75], a[200:203], v[160:163], v[72:75]
  v_mfma_f32_16x16x32_bf16 v[76:79], a[192:195], v[164:167], v[76:79]
  ds_read_b128 v[196:199], v19 offset:2048
  v_mfma_f32_16x16x32_bf16 v[80:83], a[196:199], v[164:167], v[80:83]
  buffer_load_dwordx4 v11, s[8:11], s30 offen offset:1024 lds
  v_mfma_f32_16x16x32_bf16 v[84:87], a[200:203], v[164:167], v[84:87]
  s_waitcnt lgkmcnt(2)
  s_add_u32 s30, s30, 128
  v_mfma_f32_16x16x32_bf16 v[88:91], a[192:195], v[168:171], v[88:91]
  ds_read_b128 v[200:203], v19 offset:4096
  s_add_u32 m0, m0, 8192
  v_mfma_f32_16x16x32_bf16 v[92:95], a[196:199], v[168:171], v[92:95]
  s_cmp_lt_u32 m0, s46
  s_cselect_b32 m0, m0, s47
  v_mfma_f32_16x16x32_bf16 v[96:99], a[200:203], v[168:171], v[96:99]
  v_mfma_f32_16x16x32_bf16 v[100:103], a[192:195], v[172:175], v[100:103]
  ds_read_b128 v[204:207], v19 offset:6144
  v_mfma_f32_16x16x32_bf16 v[104:107], a[196:199], v[172:175], v[104:107]
  v_mfma_f32_16x16x32_bf16 v[108:111], a[200:203], v[172:175], v[108:111]
  s_waitcnt vmcnt(8) lgkmcnt(2)
  s_barrier
  v_mfma_f32_16x16x32_bf16 v[64:67], a[204:207], v[192:195], v[64:67]
  ds_read_b128 v[160:163], v18 offset:0
  v_mfma_f32_16x16x32_bf16 v[68:71], a[208:211], v[192:195], v[68:71]
  v_mfma_f32_16x16x32_bf16 v[72:75], a[212:215], v[192:195], v[72:75]
  v_add_u32 v19, s33, v15
  s_add_u32 s33, s33, 8192
  v_mfma_f32_16x16x32_bf16 v[76:79], a[204:207], v[196:199], v[76:79]
  ds_read_b128 v[164:167], v18 offset:2048
  v_mfma_f32_16x16x32_bf16 v[80:83], a[208:211], v[196:199], v[80:83]
  buffer_load_dwordx4 v10, s[8:11], s30 offen offset:0 lds
  v_mfma_f32_16x16x32_bf16 v[84:87], a[212:215], v[196:199], v[84:87]
  s_waitcnt lgkmcnt(2)
  v_mfma_f32_16x16x32_bf16 v[88:91], a[204:207], v[200:203], v[88:91]
  ds_read_b128 v[168:171], v18 offset:4096
  v_mfma_f32_16x16x32_bf16 v[92:95], a[208:211], v[200:203], v[92:95]
  s_cmp_lt_u32 s33, 155648
  s_cselect_b32 s33, s33, 98304
  v_mfma_f32_16x16x32_bf16 v[96:99], a[212:215], v[200:203], v[96:99]
  v_mfma_f32_16x16x32_bf16 v[100:103], a[204:207], v[204:207], v[100:103]
  ds_read_b128 v[172:175], v18 offset:6144
  v_mfma_f32_16x16x32_bf16 v[104:107], a[208:211], v[204:207], v[104:107]
  v_mfma_f32_16x16x32_bf16 v[108:111], a[212:215], v[204:207], v[108:111]
  s_waitcnt lgkmcnt(2)
  v_mfma_f32_16x16x32_bf16 v[64:67], a[216:219], v[160:163], v[64:67]
  ds_read_b128 v[192:195], v19 offset:0
  v_mfma_f32_16x16x32_bf16 v[68:71], a[220:223], v[160:163], v[68:71]
  v_add_u32 v18, s33, v14
  v_mfma_f32_16x16x32_bf16 v[72:75], a[224:227], v[160:163], v[72:75]
  v_mfma_f32_16x16x32_bf16 v[76:79], a[216:219], v[164:167], v[76:79]
  ds_read_b128 v[196:199], v19 offset:2048
  v_mfma_f32_16x16x32_bf16 v[80:83], a[220:223], v[164:167], v[80:83]
  buffer_load_dwordx4 v11, s[8:11], s30 offen offset:1024 lds
  v_mfma_f32_16x16x32_bf16 v[84:87], a[224:227], v[164:167], v[84:87]
  s_waitcnt lgkmcnt(2)
  s_add_u32 s30, s30, 128
  v_mfma_f32_16x16x32_bf16 v[88:91], a[216:219], v[168:171], v[88:91]
  ds_read_b128 v[200:203], v19 offset:4096
  s_add_u32 m0, m0, 8192
  v_mfma_f32_16x16x32_bf16 v[92:95], a[220:223], v[168:171], v[92:95]
  s_cmp_lt_u32 m0, s46
  s_cselect_b32 m0, m0, s47
  v_mfma_f32_16x16x32_bf16 v[96:99], a[224:227], v[168:171], v[96:99]
  v_mfma_f32_16x16x32_bf16 v[100:103], a[216:219], v[172:175], v[100:103]
  ds_read_b128 v[204:207], v19 offset:6144
  v_mfma_f32_16x16x32_bf16 v[104:107], a[220:223], v[172:175], v[104:107]
  v_mfma_f32_16x16x32_bf16 v[108:111], a[224:227], v[172:175], v[108:111]
  s_waitcnt vmcnt(8) lgkmcnt(2)
  s_barrier
  v_mfma_f32_16x16x32_bf16 v[64:67], a[228:231], v[192:195], v[64:67]
  ds_read_b128 v[160:163], v18 offset:0
  v_mfma_f32_16x16x32_bf16 v[68:71], a[232:235], v[192:195], v[68:71]
  v_mfma_f32_16x16x32_bf16 v[72:75], a[236:239], v[192:195], v[72:75]
  v_add_u32 v19, s33, v15
  s_add_u32 s33, s33, 8192
  v_mfma_f32_16x16x32_bf16 v[76:79], a[228:231], v[196:199], v[76:79]
  ds_read_b128 v[164:167], v18 offset:2048
  v_cvt_pk_bf16_f32 v224, v64, v65
  v_cvt_pk_bf16_f32 v225, v66, v67
  v_mfma_f32_16x16x32_bf16 v[80:83], a[232:235], v[196:199], v[80:83]
  buffer_load_dwordx4 v10, s[8:11], s30 offen offset:0 lds
  v_cvt_pk_bf16_f32 v226, v68, v69
  v_cvt_pk_bf16_f32 v227, v70, v71
  v_mfma_f32_16x16x32_bf16 v[84:87], a[236:239], v[196:199], v[84:87]
  s_waitcnt lgkmcnt(2)
  v_cvt_pk_bf16_f32 v228, v72, v73
  v_cvt_pk_bf16_f32 v229, v74, v75
  v_mfma_f32_16x16x32_bf16 v[88:91], a[228:231], v[200:203], v[88:91]
  ds_read_b128 v[168:171], v18 offset:4096
  ds_write_b64 v22, v[224:225] offset:0
  v_mfma_f32_16x16x32_bf16 v[92:95], a[232:235], v[200:203], v[92:95]
  s_cmp_lt_u32 s33, 155648
  s_cselect_b32 s33, s33, 98304
  ds_write_b64 v22, v[226:227] offset:8
  v_mfma_f32_16x16x32_bf16 v[96:99], a[236:239], v[200:203], v[96:99]
  ds_write_b64 v16, v[228:229] offset:64
  v_cvt_pk_bf16_f32 v230, v76, v77
  v_cvt_pk_bf16_f32 v231, v78, v79
  v_mfma_f32_16x16x32_bf16 v[100:103], a[228:231], v[204:207], v[100:103]
  ds_read_b128 v[172:175], v18 offset:6144
  v_cvt_pk_bf16_f32 v232, v80, v81
  v_cvt_pk_bf16_f32 v233, v82, v83
  v_cvt_pk_bf16_f32 v234, v84, v85
  v_mfma_f32_16x16x32_bf16 v[104:107], a[232:235], v[204:207], v[104:107]
  v_cvt_pk_bf16_f32 v235, v86, v87
  ds_write_b64 v22, v[230:231] offset:6400
  v_mfma_f32_16x16x32_bf16 v[108:111], a[236:239], v[204:207], v[108:111]
  ds_write_b64 v22, v[232:233] offset:6408
  ds_write_b64 v16, v[234:235] offset:6464
kvm_end_158:
  v_cvt_pk_bf16_f32 v236, v88, v89
  v_cvt_pk_bf16_f32 v237, v90, v91
  v_cvt_pk_bf16_f32 v238, v92, v93
  v_cvt_pk_bf16_f32 v239, v94, v95
  v_cvt_pk_bf16_f32 v240, v96, v97
  v_cvt_pk_bf16_f32 v241, v98, v99
  ds_write_b64 v22, v[236:237] offset:12800
  ds_write_b64 v22, v[238:239] offset:12808
  ds_write_b64 v16, v[240:241] offset:12864
  v_cvt_pk_bf16_f32 v242, v100, v101
  v_cvt_pk_bf16_f32 v243, v102, v103
  v_cvt_pk_bf16_f32 v244, v104, v105
  v_cvt_pk_bf16_f32 v245, v106, v107
  v_cvt_pk_bf16_f32 v246, v108, v109
  v_cvt_pk_bf16_f32 v247, v110, v111
  ds_write_b64 v22, v[242:243] offset:19200
  ds_write_b64 v22, v[244:245] offset:19208
  ds_write_b64 v16, v[246:247] offset:19264
  s_waitcnt lgkmcnt(0)
  s_barrier
  ds_read_b128 v[224:227], v23 offset:0
  ds_read_b128 v[228:231], v23 offset:64
  ds_read_b128 v[232:235], v23 offset:128
  ds_read_b128 v[236:239], v23 offset:192
  ds_read_b128 v[240:243], v23 offset:256
  ds_read_b128 v[244:247], v23 offset:320
  s_waitcnt lgkmcnt(0)
  s_add_u32 s21, s48, 0
  buffer_store_dwordx4 v[224:227], v26, s[16:19], s21 offen offset:0 sc1
  buffer_store_dwordx4 v[228:231], v26, s[16:19], s21 offen offset:1024 sc1
  buffer_store_dwordx4 v[232:235], v26, s[16:19], s21 offen offset:2048 sc1
  buffer_store_dwordx4 v[236:239], v26, s[16:19], s21 offen offset:3072 sc1
  s_add_u32 s21, s48, 4096
  buffer_store_dwordx4 v[240:243], v26, s[16:19], s21 offen offset:0 sc1
  buffer_store_dwordx4 v[244:247], v26, s[16:19], s21 offen offset:1024 sc1
  s_nop 1
  s_cmp_gt_u32 s26, 0
  s_cbranch_scc1 kvm_blk_157
  s_waitcnt vmcnt(6)
  s_barrier
  s_mov_b32 s24, 491520
  s_mov_b32 s25, 163840
  v_lshrrev_b32 v11, 3, v1
  v_and_b32 v12, 7, v1
  v_xor_b32 v12, v12, v11
  v_mul_u32_u24 v11, 1280, v11
  v_lshl_add_u32 v10, v12, 4, v11
  s_mul_i32 s46, s20, 40960
  v_add_u32 v10, s46, v10
  s_lshl_b32 s47, s20, 12
  s_add_u32 s47, s47, 0
  s_add_u32 s46, s47, 98304
  s_mov_b32 s30, s24
  s_add_u32 s32, s47, 32768
  v_add_u32 v11, 9216, v10
  v_add_u32 v12, 18432, v10
  v_add_u32 v13, 27648, v10
  s_mov_b32 m0, s32
  s_nop 0
  buffer_load_dwordx4 v10, s[8:11], s30 offen offset:0 lds
  buffer_load_dwordx4 v11, s[8:11], s30 offen offset:1024 lds
  buffer_load_dwordx4 v12, s[8:11], s30 offen offset:2048 lds
  buffer_load_dwordx4 v13, s[8:11], s30 offen offset:3072 lds
  s_add_u32 s30, s30, 128
  s_add_u32 s32, s32, 16384
  s_cmp_lt_u32 s32, s46
  s_cselect_b32 s32, s32, s47
  s_mov_b32 m0, s32
  s_nop 0
  buffer_load_dwordx4 v10, s[8:11], s30 offen offset:0 lds
  buffer_load_dwordx4 v11, s[8:11], s30 offen offset:1024 lds
  buffer_load_dwordx4 v12, s[8:11], s30 offen offset:2048 lds
  buffer_load_dwordx4 v13, s[8:11], s30 offen offset:3072 lds
  s_add_u32 s30, s30, 128
  s_add_u32 s32, s32, 16384
  s_cmp_lt_u32 s32, s46
  s_cselect_b32 s32, s32, s47
  s_mov_b32 m0, s32
  s_nop 0
  buffer_load_dwordx4 v10, s[8:11], s30 offen offset:0 lds
  buffer_load_dwordx4 v11, s[8:11], s30 offen offset:1024 lds
  buffer_load_dwordx4 v12, s[8:11], s30 offen offset:2048 lds
  buffer_load_dwordx4 v13, s[8:11], s30 offen offset:3072 lds
  s_add_u32 s30, s30, 128
  s_add_u32 s32, s32, 16384
  s_cmp_lt_u32 s32, s46
  s_cselect_b32 s32, s32, s47
  s_mov_b32 m0, s32
  s_nop 0
  buffer_load_dwordx4 v10, s[8:11], s30 offen offset:0 lds
  buffer_load_dwordx4 v11, s[8:11], s30 offen offset:1024 lds
  buffer_load_dwordx4 v12, s[8:11], s30 offen offset:2048 lds
  buffer_load_dwordx4 v13, s[8:11], s30 offen offset:3072 lds
  s_add_u32 s30, s30, 128
  s_add_u32 s32, s32, 16384
  s_cmp_lt_u32 s32, s46
  s_cselect_b32 s32, s32, s47
  s_waitcnt vmcnt(16)
  s_barrier
  s_cmp_lg_u32 s20, 0
  s_cbranch_scc1 af_162
  v_mov_b32 v4, 0
  v_mov_b32 v5, 1
  s_mov_b64 exec, 1
  buffer_atomic_add v5, v4, s[72:75], s61 offen sc1
  s_mov_b64 exec, -1
  s_nop 1
af_162:
  s_mov_b32 s26, 13
  s_mov_b32 s28, 1572864
kv_main:
  v_and_b32 v6, 7, v2
  v_add_u32 v4, 0, v3
  v_xor_b32 v4, v4, v6
  v_lshlrev_b32 v4, 4, v4
  v_lshl_add_u32 v14, v2, 7, v4
  v_add_u32 v4, 4, v3
  v_xor_b32 v4, v4, v6
  v_lshlrev_b32 v4, 4, v4
  v_lshl_add_u32 v15, v2, 7, v4
  v_mul_u32_u24 v22, 400, v2
  v_mul_u32_u24 v4, 16, v3
  s_mul_i32 s21, s20, 96
  s_add_u32 s21, s21, 98304
  v_add3_u32 v22, v22, v4, s21
  v_lshlrev_b32 v4, 3, v3
  v_sub_u32 v16, v22, v4
  v_mov_b32 v9, 2731
  s_mul_i32 s21, s20, 12800
  s_add_u32 s21, s21, 98304
  v_mul_u32_u24 v4, 400, v2
  v_lshlrev_b32 v5, 4, v3
  v_add3_u32 v23, v4, v5, s21
  v_lshlrev_b32 v26, 4, v1
  s_mov_b32 s33, 32768
  s_mov_b32 s48, 0x80000000
  s_mov_b32 m0, s32
  s_nop 0
  buffer_load_dwordx4 v10, s[8:11], s30 offen offset:0 lds
  buffer_load_dwordx4 v11, s[8:11], s30 offen offset:1024 lds
  s_waitcnt vmcnt(14)
  s_barrier
  v_add_u32 v18, s33, v14
  v_add_u32 v19, s33, v15
  s_add_u32 s33, s33, 16384
  s_cmp_lt_u32 s33, 98304
  s_cselect_b32 s33, s33, 0
  ds_read_b128 v[160:163], v18 offset:0
  ds_read_b128 v[164:167], v18 offset:2048
  ds_read_b128 v[168:171], v18 offset:4096
  ds_read_b128 v[172:175], v18 offset:6144
  ds_read_b128 v[176:179], v18 offset:8192
  ds_read_b128 v[180:183], v18 offset:10240
  ds_read_b128 v[184:187], v18 offset:12288
  ds_read_b128 v[188:191], v18 offset:14336
  s_waitcnt lgkmcnt(0)
kv_blk_165:
  v_mfma_f32_16x16x32_bf16 v[64:67], a[0:3], v[160:163], 0
  ds_read_b128 v[192:195], v19 offset:0
  v_mfma_f32_16x16x32_bf16 v[68:71], a[4:7], v[160:163], 0
  v_add_u32 v18, s33, v14
  v_mfma_f32_16x16x32_bf16 v[72:75], a[8:11], v[160:163], 0
  ds_write_b64 v16, v[234:235] offset:6464
  v_mfma_f32_16x16x32_bf16 v[76:79], a[0:3], v[164:167], 0
  ds_read_b128 v[196:199], v19 offset:2048
  v_cvt_pk_bf16_f32 v236, v88, v89
  v_mfma_f32_16x16x32_bf16 v[80:83], a[4:7], v[164:167], 0
  buffer_load_dwordx4 v12, s[8:11], s30 offen offset:2048 lds
  v_mfma_f32_16x16x32_bf16 v[84:87], a[8:11], v[164:167], 0
  v_cvt_pk_bf16_f32 v237, v90, v91
  v_cvt_pk_bf16_f32 v238, v92, v93
  v_mfma_f32_16x16x32_bf16 v[88:91], a[0:3], v[168:171], 0
  ds_read_b128 v[200:203], v19 offset:4096
  v_cvt_pk_bf16_f32 v239, v94, v95
  v_mfma_f32_16x16x32_bf16 v[92:95], a[4:7], v[168:171], 0
  v_cvt_pk_bf16_f32 v240, v96, v97
  v_cvt_pk_bf16_f32 v241, v98, v99
  v_mfma_f32_16x16x32_bf16 v[96:99], a[8:11], v[168:171], 0
  ds_write_b64 v22, v[236:237] offset:12800
  ds_write_b64 v22, v[238:239] offset:12808
  ds_write_b64 v16, v[240:241] offset:12864
  v_cvt_pk_bf16_f32 v242, v100, v101
  v_cvt_pk_bf16_f32 v243, v102, v103
  v_mfma_f32_16x16x32_bf16 v[100:103], a[0:3], v[172:175], 0
  ds_read_b128 v[204:207], v19 offset:6144
  v_cvt_pk_bf16_f32 v244, v104, v105
  v_cvt_pk_bf16_f32 v245, v106, v107
  v_mfma_f32_16x16x32_bf16 v[104:107], a[4:7], v[172:175], 0
  v_cvt_pk_bf16_f32 v246, v108, v109
  v_cvt_pk_bf16_f32 v247, v110, v111
  v_mfma_f32_16x16x32_bf16 v[108:111], a[8:11], v[172:175], 0
  s_waitcnt lgkmcnt(9)
  ds_write_b64 v22, v[242:243] offset:19200
  ds_write_b64 v22, v[244:245] offset:19208
  ds_write_b64 v16, v[246:247] offset:19264
  v_cvt_pk_bf16_f32 v224, v112, v113
  v_cvt_pk_bf16_f32 v225, v114, v115
  v_mfma_f32_16x16x32_bf16 v[112:115], a[0:3], v[176:179], 0
  ds_read_b128 v[208:211], v19 offset:8192
  v_cvt_pk_bf16_f32 v226, v116, v117
  v_cvt_pk_bf16_f32 v227, v118, v119
  v_mfma_f32_16x16x32_bf16 v[116:119], a[4:7], v[176:179], 0
  v_cvt_pk_bf16_f32 v228, v120, v121
  v_cvt_pk_bf16_f32 v229, v122, v123
  v_mfma_f32_16x16x32_bf16 v[120:123], a[8:11], v[176:179], 0
  ds_write_b64 v22, v[224:225] offset:25600
  ds_write_b64 v22, v[226:227] offset:25608
  ds_write_b64 v16, v[228:229] offset:25664
  v_cvt_pk_bf16_f32 v230, v124, v125
  v_cvt_pk_bf16_f32 v231, v126, v127
  v_mfma_f32_16x16x32_bf16 v[124:127], a[0:3], v[180:183], 0
  ds_read_b128 v[212:215], v19 offset:10240
  v_cvt_pk_bf16_f32 v232, v128, v129
  v_cvt_pk_bf16_f32 v233, v130, v131
  v_mfma_f32_16x16x32_bf16 v[128:131], a[4:7], v[180:183], 0
  buffer_load_dwordx4 v13, s[8:11], s30 offen offset:3072 lds
  v_cvt_pk_bf16_f32 v234, v132, v133
  v_cvt_pk_bf16_f32 v235, v134, v135
  v_mfma_f32_16x16x32_bf16 v[132:135], a[8:11], v[180:183], 0
  s_add_u32 s30, s30, 128
  s_add_u32 m0, m0, 16384
  ds_write_b64 v22, v[230:231] offset:32000
  ds_write_b64 v22, v[232:233] offset:32008
  ds_write_b64 v16, v[234:235] offset:32064
  v_cvt_pk_bf16_f32 v236, v136, v137
  v_cvt_pk_bf16_f32 v237, v138, v139
  v_mfma_f32_16x16x32_bf16 v[136:139], a[0:3], v[184:187], 0
  ds_read_b128 v[216:219], v19 offset:12288
  v_cvt_pk_bf16_f32 v238, v140, v141
  v_cvt_pk_bf16_f32 v239, v142, v143
  v_mfma_f32_16x16x32_bf16 v[140:143], a[4:7], v[184:187], 0
  s_cmp_lt_u32 m0, s46
  s_cselect_b32 m0, m0, s47
  v_cvt_pk_bf16_f32 v240, v144, v145
  v_cvt_pk_bf16_f32 v241, v146, v147
  v_mfma_f32_16x16x32_bf16 v[144:147], a[8:11], v[184:187], 0
  ds_write_b64 v22, v[236:237] offset:38400
  ds_write_b64 v22, v[238:239] offset:38408
  ds_write_b64 v16, v[240:241] offset:38464
  v_cvt_pk_bf16_f32 v242, v148, v149
  v_cvt_pk_bf16_f32 v243, v150, v151
  v_mfma_f32_16x16x32_bf16 v[148:151], a[0:3], v[188:191], 0
  ds_read_b128 v[220:223], v19 offset:14336
  v_cvt_pk_bf16_f32 v244, v152, v153
  v_cvt_pk_bf16_f32 v245, v154, v155
  v_mfma_f32_16x16x32_bf16 v[152:155], a[4:7], v[188:191], 0
  v_cvt_pk_bf16_f32 v246, v156, v157
  v_cvt_pk_bf16_f32 v247, v158, v159
  v_mfma_f32_16x16x32_bf16 v[156:159], a[8:11], v[188:191], 0
  s_waitcnt vmcnt(12) lgkmcnt(15)
  s_barrier
  v_mfma_f32_16x16x32_bf16 v[64:67], a[12:15], v[192:195], v[64:67]
  ds_read_b128 v[160:163], v18 offset:0
  v_mfma_f32_16x16x32_bf16 v[68:71], a[16:19], v[192:195], v[68:71]
  ds_write_b64 v22, v[242:243] offset:44800
  v_mfma_f32_16x16x32_bf16 v[72:75], a[20:23], v[192:195], v[72:75]
  v_add_u32 v19, s33, v15
  s_add_u32 s33, s33, 16384
  v_mfma_f32_16x16x32_bf16 v[76:79], a[12:15], v[196:199], v[76:79]
  ds_read_b128 v[164:167], v18 offset:2048
  v_mfma_f32_16x16x32_bf16 v[80:83], a[16:19], v[196:199], v[80:83]
  buffer_load_dwordx4 v10, s[8:11], s30 offen offset:0 lds
  v_mfma_f32_16x16x32_bf16 v[84:87], a[20:23], v[196:199], v[84:87]
  s_cmp_lt_u32 s33, 98304
  s_cselect_b32 s33, s33, 0
  v_mfma_f32_16x16x32_bf16 v[88:91], a[12:15], v[200:203], v[88:91]
  ds_read_b128 v[168:171], v18 offset:4096
  v_mfma_f32_16x16x32_bf16 v[92:95], a[16:19], v[200:203], v[92:95]
  ds_write_b64 v22, v[244:245] offset:44808
  v_mfma_f32_16x16x32_bf16 v[96:99], a[20:23], v[200:203], v[96:99]
  ds_write_b64 v16, v[246:247] offset:44864
  v_mfma_f32_16x16x32_bf16 v[100:103], a[12:15], v[204:207], v[100:103]
  ds_read_b128 v[172:175], v18 offset:6144
  v_mfma_f32_16x16x32_bf16 v[104:107], a[16:19], v[204:207], v[104:107]
  v_mfma_f32_16x16x32_bf16 v[108:111], a[20:23], v[204:207], v[108:111]
  s_waitcnt lgkmcnt(7)
  v_mfma_f32_16x16x32_bf16 v[112:115], a[12:15], v[208:211], v[112:115]
  ds_read_b128 v[176:179], v18 offset:8192
  v_mfma_f32_16x16x32_bf16 v[116:119], a[16:19], v[208:211], v[116:119]
  v_mfma_f32_16x16x32_bf16 v[120:123], a[20:23], v[208:211], v[120:123]
  v_mfma_f32_16x16x32_bf16 v[124:127], a[12:15], v[212:215], v[124:127]
  ds_read_b128 v[180:183], v18 offset:10240
  v_mfma_f32_16x16x32_bf16 v[128:131], a[16:19], v[212:215], v[128:131]
  buffer_load_dwordx4 v11, s[8:11], s30 offen offset:1024 lds
  v_mfma_f32_16x16x32_bf16 v[132:135], a[20:23], v[212:215], v[132:135]
  v_mfma_f32_16x16x32_bf16 v[136:139], a[12:15], v[216:219], v[136:139]
  ds_read_b128 v[184:187], v18 offset:12288
  v_mfma_f32_16x16x32_bf16 v[140:143], a[16:19], v[216:219], v[140:143]
  v_mfma_f32_16x16x32_bf16 v[144:147], a[20:23], v[216:219], v[144:147]
  v_mfma_f32_16x16x32_bf16 v[148:151], a[12:15], v[220:223], v[148:151]
  ds_read_b128 v[188:191], v18 offset:14336
  v_mfma_f32_16x16x32_bf16 v[152:155], a[16:19], v[220:223], v[152:155]
  v_mfma_f32_16x16x32_bf16 v[156:159], a[20:23], v[220:223], v[156:159]
  s_waitcnt lgkmcnt(4)
  v_mfma_f32_16x16x32_bf16 v[64:67], a[24:27], v[160:163], v[64:67]
  ds_read_b128 v[192:195], v19 offset:0
  v_mfma_f32_16x16x32_bf16 v[68:71], a[28:31], v[160:163], v[68:71]
  v_add_u32 v18, s33, v14
  v_mfma_f32_16x16x32_bf16 v[72:75], a[32:35], v[160:163], v[72:75]
  v_mfma_f32_16x16x32_bf16 v[76:79], a[24:27], v[164:167], v[76:79]
  ds_read_b128 v[196:199], v19 offset:2048
  v_mfma_f32_16x16x32_bf16 v[80:83], a[28:31], v[164:167], v[80:83]
  buffer_load_dwordx4 v12, s[8:11], s30 offen offset:2048 lds
  v_mfma_f32_16x16x32_bf16 v[84:87], a[32:35], v[164:167], v[84:87]
  v_mfma_f32_16x16x32_bf16 v[88:91], a[24:27], v[168:171], v[88:91]
  ds_read_b128 v[200:203], v19 offset:4096
  v_mfma_f32_16x16x32_bf16 v[92:95], a[28:31], v[168:171], v[92:95]
  v_mfma_f32_16x16x32_bf16 v[96:99], a[32:35], v[168:171], v[96:99]
  v_mfma_f32_16x16x32_bf16 v[100:103], a[24:27], v[172:175], v[100:103]
  ds_read_b128 v[204:207], v19 offset:6144
  v_mfma_f32_16x16x32_bf16 v[104:107], a[28:31], v[172:175], v[104:107]
  v_mfma_f32_16x16x32_bf16 v[108:111], a[32:35], v[172:175], v[108:111]
  s_waitcnt lgkmcnt(4)
  v_mfma_f32_16x16x32_bf16 v[112:115], a[24:27], v[176:179], v[112:115]
  ds_read_b128 v[208:211], v19 offset:8192
  v_mfma_f32_16x16x32_bf16 v[116:119], a[28:31], v[176:179], v[116:119]
  v_mfma_f32_16x16x32_bf16 v[120:123], a[32:35], v[176:179], v[120:123]
  v_mfma_f32_16x16x32_bf16 v[124:127], a[24:27], v[180:183], v[124:127]
  ds_read_b128 v[212:215], v19 offset:10240
  v_mfma_f32_16x16x32_bf16 v[128:131], a[28:31], v[180:183], v[128:131]
  buffer_load_dwordx4 v13, s[8:11], s30 offen offset:3072 lds
  v_mfma_f32_16x16x32_bf16 v[132:135], a[32:35], v[180:183], v[132:135]
  s_add_u32 s30, s30, 128
  s_add_u32 m0, m0, 16384
  v_mfma_f32_16x16x32_bf16 v[136:139], a[24:27], v[184:187], v[136:139]
  ds_read_b128 v[216:219], v19 offset:12288
  v_mfma_f32_16x16x32_bf16 v[140:143], a[28:31], v[184:187], v[140:143]
  s_cmp_lt_u32 m0, s46
  s_cselect_b32 m0, m0, s47
  v_mfma_f32_16x16x32_bf16 v[144:147], a[32:35], v[184:187], v[144:147]
  v_mfma_f32_16x16x32_bf16 v[148:151], a[24:27], v[188:191], v[148:151]
  ds_read_b128 v[220:223], v19 offset:14336
  v_mfma_f32_16x16x32_bf16 v[152:155], a[28:31], v[188:191], v[152:155]
  v_mfma_f32_16x16x32_bf16 v[156:159], a[32:35], v[188:191], v[156:159]
  s_waitcnt vmcnt(12) lgkmcnt(4)
  s_barrier
  v_mfma_f32_16x16x32_bf16 v[64:67], a[36:39], v[192:195], v[64:67]
  ds_read_b128 v[160:163], v18 offset:0
  v_mfma_f32_16x16x32_bf16 v[68:71], a[40:43], v[192:195], v[68:71]
  v_mfma_f32_16x16x32_bf16 v[72:75], a[44:47], v[192:195], v[72:75]
  v_add_u32 v19, s33, v15
  s_add_u32 s33, s33, 16384
  v_mfma_f32_16x16x32_bf16 v[76:79], a[36:39], v[196:199], v[76:79]
  ds_read_b128 v[164:167], v18 offset:2048
  v_mfma_f32_16x16x32_bf16 v[80:83], a[40:43], v[196:199], v[80:83]
  buffer_load_dwordx4 v10, s[8:11], s30 offen offset:0 lds
  v_mfma_f32_16x16x32_bf16 v[84:87], a[44:47], v[196:199], v[84:87]
  s_cmp_lt_u32 s33, 98304
  s_cselect_b32 s33, s33, 0
  v_mfma_f32_16x16x32_bf16 v[88:91], a[36:39], v[200:203], v[88:91]
  ds_read_b128 v[168:171], v18 offset:4096
  v_mfma_f32_16x16x32_bf16 v[92:95], a[40:43], v[200:203], v[92:95]
  ds_read_b128 v[224:227], v23 offset:0
  v_mfma_f32_16x16x32_bf16 v[96:99], a[44:47], v[200:203], v[96:99]
  v_mfma_f32_16x16x32_bf16 v[100:103], a[36:39], v[204:207], v[100:103]
  ds_read_b128 v[172:175], v18 offset:6144
  v_mfma_f32_16x16x32_bf16 v[104:107], a[40:43], v[204:207], v[104:107]
  v_mfma_f32_16x16x32_bf16 v[108:111], a[44:47], v[204:207], v[108:111]
  s_waitcnt lgkmcnt(5)
  v_mfma_f32_16x16x32_bf16 v[112:115], a[36:39], v[208:211], v[112:115]
  ds_read_b128 v[176:179], v18 offset:8192
  v_mfma_f32_16x16x32_bf16 v[116:119], a[40:43], v[208:211], v[116:119]
  v_mfma_f32_16x16x32_bf16 v[120:123], a[44:47], v[208:211], v[120:123]
  v_mfma_f32_16x16x32_bf16 v[124:127], a[36:39], v[212:215], v[124:127]
  ds_read_b128 v[180:183], v18 offset:10240
  v_mfma_f32_16x16x32_bf16 v[128:131], a[40:43], v[212:215], v[128:131]
  buffer_load_dwordx4 v11, s[8:11], s30 offen offset:1024 lds
  v_mfma_f32_16x16x32_bf16 v[132:135], a[44:47], v[212:215], v[132:135]
  v_mfma_f32_16x16x32_bf16 v[136:139], a[36:39], v[216:219], v[136:139]
  ds_read_b128 v[184:187], v18 offset:12288
  v_mfma_f32_16x16x32_bf16 v[140:143], a[40:43], v[216:219], v[140:143]
  ds_read_b128 v[228:231], v23 offset:64
  v_mfma_f32_16x16x32_bf16 v[144:147], a[44:47], v[216:219], v[144:147]
  v_mfma_f32_16x16x32_bf16 v[148:151], a[36:39], v[220:223], v[148:151]
  ds_read_b128 v[188:191], v18 offset:14336
  v_mfma_f32_16x16x32_bf16 v[152:155], a[40:43], v[220:223], v[152:155]
  v_mfma_f32_16x16x32_bf16 v[156:159], a[44:47], v[220:223], v[156:159]
  s_waitcnt lgkmcnt(5)
  v_mfma_f32_16x16x32_bf16 v[64:67], a[48:51], v[160:163], v[64:67]
  ds_read_b128 v[192:195], v19 offset:0
  v_mfma_f32_16x16x32_bf16 v[68:71], a[52:55], v[160:163], v[68:71]
  v_add_u32 v18, s33, v14
  v_mfma_f32_16x16x32_bf16 v[72:75], a[56:59], v[160:163], v[72:75]
  v_mfma_f32_16x16x32_bf16 v[76:79], a[48:51], v[164:167], v[76:79]
  ds_read_b128 v[196:199], v19 offset:2048
  v_mfma_f32_16x16x32_bf16 v[80:83], a[52:55], v[164:167], v[80:83]
  buffer_load_dwordx4 v12, s[8:11], s30 offen offset:2048 lds
  v_mfma_f32_16x16x32_bf16 v[84:87], a[56:59], v[164:167], v[84:87]
  v_mfma_f32_16x16x32_bf16 v[88:91], a[48:51], v[168:171], v[88:91]
  ds_read_b128 v[200:203], v19 offset:4096
  v_mfma_f32_16x16x32_bf16 v[92:95], a[52:55], v[168:171], v[92:95]
  s_add_u32 s21, s48, 0
  ds_read_b128 v[232:235], v23 offset:128
  v_mfma_f32_16x16x32_bf16 v[96:99], a[56:59], v[168:171], v[96:99]
  v_mfma_f32_16x16x32_bf16 v[100:103], a[48:51], v[172:175], v[100:103]
  ds_read_b128 v[204:207], v19 offset:6144
  v_mfma_f32_16x16x32_bf16 v[104:107], a[52:55], v[172:175], v[104:107]
  buffer_store_dwordx4 v[224:227], v26, s[16:19], s21 offen offset:0 sc1
  v_mfma_f32_16x16x32_bf16 v[108:111], a[56:59], v[172:175], v[108:111]
  s_waitcnt lgkmcnt(5)
  v_mfma_f32_16x16x32_bf16 v[112:115], a[48:51], v[176:179], v[112:115]
  ds_read_b128 v[208:211], v19 offset:8192
  v_mfma_f32_16x16x32_bf16 v[116:119], a[52:55], v[176:179], v[116:119]
  v_mfma_f32_16x16x32_bf16 v[120:123], a[56:59], v[176:179], v[120:123]
  v_mfma_f32_16x16x32_bf16 v[124:127], a[48:51], v[180:183], v[124:127]
  ds_read_b128 v[212:215], v19 offset:10240
  v_mfma_f32_16x16x32_bf16 v[128:131], a[52:55], v[180:183], v[128:131]
  buffer_load_dwordx4 v13, s[8:11], s30 offen offset:3072 lds
  v_mfma_f32_16x16x32_bf16 v[132:135], a[56:59], v[180:183], v[132:135]
  s_add_u32 s30, s30, 128
  s_add_u32 m0, m0, 16384
  v_mfma_f32_16x16x32_bf16 v[136:139], a[48:51], v[184:187], v[136:139]
  ds_read_b128 v[216:219], v19 offset:12288
  v_mfma_f32_16x16x32_bf16 v[140:143], a[52:55], v[184:187], v[140:143]
  s_cmp_lt_u32 m0, s46
  s_cselect_b32 m0, m0, s47
  v_mfma_f32_16x16x32_bf16 v[144:147], a[56:59], v[184:187], v[144:147]
  ds_read_b128 v[236:239], v23 offset:192
  v_mfma_f32_16x16x32_bf16 v[148:151], a[48:51], v[188:191], v[148:151]
  ds_read_b128 v[220:223], v19 offset:14336
  v_mfma_f32_16x16x32_bf16 v[152:155], a[52:55], v[188:191], v[152:155]
  buffer_store_dwordx4 v[228:231], v26, s[16:19], s21 offen offset:1024 sc1
  v_mfma_f32_16x16x32_bf16 v[156:159], a[56:59], v[188:191], v[156:159]
  s_waitcnt vmcnt(14) lgkmcnt(5)
  s_barrier
  v_mfma_f32_16x16x32_bf16 v[64:67], a[60:63], v[192:195], v[64:67]
  ds_read_b128 v[160:163], v18 offset:0
  v_mfma_f32_16x16x32_bf16 v[68:71], a[64:67], v[192:195], v[68:71]
  v_mfma_f32_16x16x32_bf16 v[72:75], a[68:71], v[192:195], v[72:75]
  v_add_u32 v19, s33, v15
  s_add_u32 s33, s33, 16384
  v_mfma_f32_16x16x32_bf16 v[76:79], a[60:63], v[196:199], v[76:79]
  ds_read_b128 v[164:167], v18 offset:2048
  v_mfma_f32_16x16x32_bf16 v[80:83], a[64:67], v[196:199], v[80:83]
  buffer_load_dwordx4 v10, s[8:11], s30 offen offset:0 lds
  v_mfma_f32_16x16x32_bf16 v[84:87], a[68:71], v[196:199], v[84:87]
  s_cmp_lt_u32 s33, 98304
  s_cselect_b32 s33, s33, 0
  v_mfma_f32_16x16x32_bf16 v[88:91], a[60:63], v[200:203], v[88:91]
  ds_read_b128 v[168:171], v18 offset:4096
  v_mfma_f32_16x16x32_bf16 v[92:95], a[64:67], v[200:203], v[92:95]
  ds_read_b128 v[240:243], v23 offset:256
  v_mfma_f32_16x16x32_bf16 v[96:99], a[68:71], v[200:203], v[96:99]
  v_mfma_f32_16x16x32_bf16 v[100:103], a[60:63], v[204:207], v[100:103]
  ds_read_b128 v[172:175], v18 offset:6144
  v_mfma_f32_16x16x32_bf16 v[104:107], a[64:67], v[204:207], v[104:107]
  buffer_store_dwordx4 v[232:235], v26, s[16:19], s21 offen offset:2048 sc1
  v_mfma_f32_16x16x32_bf16 v[108:111], a[68:71], v[204:207], v[108:111]
  s_waitcnt lgkmcnt(5)
  v_mfma_f32_16x16x32_bf16 v[112:115], a[60:63], v[208:211], v[112:115]
  ds_read_b128 v[176:179], v18 offset:8192
  v_mfma_f32_16x16x32_bf16 v[116:119], a[64:67], v[208:211], v[116:119]
  v_mfma_f32_16x16x32_bf16 v[120:123], a[68:71], v[208:211], v[120:123]
  v_mfma_f32_16x16x32_bf16 v[124:127], a[60:63], v[212:215], v[124:127]
  ds_read_b128 v[180:183], v18 offset:10240
  v_mfma_f32_16x16x32_bf16 v[128:131], a[64:67], v[212:215], v[128:131]
  buffer_load_dwordx4 v11, s[8:11], s30 offen offset:1024 lds
  v_mfma_f32_16x16x32_bf16 v[132:135], a[68:71], v[212:215], v[132:135]
  v_mfma_f32_16x16x32_bf16 v[136:139], a[60:63], v[216:219], v[136:139]
  ds_read_b128 v[184:187], v18 offset:12288
  v_mfma_f32_16x16x32_bf16 v[140:143], a[64:67], v[216:219], v[140:143]
  ds_read_b128 v[244:247], v23 offset:320
  v_mfma_f32_16x16x32_bf16 v[144:147], a[68:71], v[216:219], v[144:147]
  v_mfma_f32_16x16x32_bf16 v[148:151], a[60:63], v[220:223], v[148:151]
  ds_read_b128 v[188:191], v18 offset:14336
  v_mfma_f32_16x16x32_bf16 v[152:155], a[64:67], v[220:223], v[152:155]
  buffer_store_dwordx4 v[236:239], v26, s[16:19], s21 offen offset:3072 sc1
  v_mfma_f32_16x16x32_bf16 v[156:159], a[68:71], v[220:223], v[156:159]
  s_waitcnt lgkmcnt(5)
  v_mfma_f32_16x16x32_bf16 v[64:67], a[72:75], v[160:163], v[64:67]
  ds_read_b128 v[192:195], v19 offset:0
  v_mfma_f32_16x16x32_bf16 v[68:71], a[76:79], v[160:163], v[68:71]
  v_add_u32 v18, s33, v14
  v_mfma_f32_16x16x32_bf16 v[72:75], a[80:83], v[160:163], v[72:75]
  v_mfma_f32_16x16x32_bf16 v[76:79], a[72:75], v[164:167], v[76:79]
  ds_read_b128 v[196:199], v19 offset:2048
  v_mfma_f32_16x16x32_bf16 v[80:83], a[76:79], v[164:167], v[80:83]
  buffer_load_dwordx4 v12, s[8:11], s30 offen offset:2048 lds
  v_mfma_f32_16x16x32_bf16 v[84:87], a[80:83], v[164:167], v[84:87]
  v_mfma_f32_16x16x32_bf16 v[88:91], a[72:75], v[168:171], v[88:91]
  ds_read_b128 v[200:203], v19 offset:4096
  v_mfma_f32_16x16x32_bf16 v[92:95], a[76:79], v[168:171], v[92:95]
  s_add_u32 s21, s48, 4096
  ds_read_b128 v[224:227], v23 offset:6400
  v_mfma_f32_16x16x32_bf16 v[96:99], a[80:83], v[168:171], v[96:99]
  v_mfma_f32_16x16x32_bf16 v[100:103], a[72:75], v[172:175], v[100:103]
  ds_read_b128 v[204:207], v19 offset:6144
  v_mfma_f32_16x16x32_bf16 v[104:107], a[76:79], v[172:175], v[104:107]
  buffer_store_dwordx4 v[240:243], v26, s[16:19], s21 offen offset:0 sc1
  v_mfma_f32_16x16x32_bf16 v[108:111], a[80:83], v[172:175], v[108:111]
  s_waitcnt lgkmcnt(5)
  v_mfma_f32_16x16x32_bf16 v[112:115], a[72:75], v[176:179], v[112:115]
  ds_read_b128 v[208:211], v19 offset:8192
  v_mfma_f32_16x16x32_bf16 v[116:119], a[76:79], v[176:179], v[116:119]
  v_mfma_f32_16x16x32_bf16 v[120:123], a[80:83], v[176:179], v[120:123]
  v_mfma_f32_16x16x32_bf16 v[124:127], a[72:75], v[180:183], v[124:127]
  ds_read_b128 v[212:215], v19 offset:10240
  v_mfma_f32_16x16x32_bf16 v[128:131], a[76:79], v[180:183], v[128:131]
  buffer_load_dwordx4 v13, s[8:11], s30 offen offset:3072 lds
  v_mfma_f32_16x16x32_bf16 v[132:135], a[80:83], v[180:183], v[132:135]
  s_add_u32 s30, s30, 128
  s_add_u32 m0, m0, 16384
  v_mfma_f32_16x16x32_bf16 v[136:139], a[72:75], v[184:187], v[136:139]
  ds_read_b128 v[216:219], v19 offset:12288
  v_mfma_f32_16x16x32_bf16 v[140:143], a[76:79], v[184:187], v[140:143]
  s_cmp_lt_u32 m0, s46
  s_cselect_b32 m0, m0, s47
  v_mfma_f32_16x16x32_bf16 v[144:147], a[80:83], v[184:187], v[144:147]
  ds_read_b128 v[228:231], v23 offset:6464
  v_mfma_f32_16x16x32_bf16 v[148:151], a[72:75], v[188:191], v[148:151]
  ds_read_b128 v[220:223], v19 offset:14336
  v_mfma_f32_16x16x32_bf16 v[152:155], a[76:79], v[188:191], v[152:155]
  buffer_store_dwordx4 v[244:247], v26, s[16:19], s21 offen offset:1024 sc1
  v_mfma_f32_16x16x32_bf16 v[156:159], a[80:83], v[188:191], v[156:159]
  s_waitcnt vmcnt(18) lgkmcnt(5)
  s_barrier
  v_mfma_f32_16x16x32_bf16 v[64:67], a[84:87], v[192:195], v[64:67]
  ds_read_b128 v[160:163], v18 offset:0
  v_mfma_f32_16x16x32_bf16 v[68:71], a[88:91], v[192:195], v[68:71]
  v_mfma_f32_16x16x32_bf16 v[72:75], a[92:95], v[192:195], v[72:75]
  v_add_u32 v19, s33, v15
  s_add_u32 s33, s33, 16384
  v_mfma_f32_16x16x32_bf16 v[76:79], a[84:87], v[196:199], v[76:79]
  ds_read_b128 v[164:167], v18 offset:2048
  v_mfma_f32_16x16x32_bf16 v[80:83], a[88:91], v[196:199], v[80:83]
  buffer_load_dwordx4 v10, s[8:11], s30 offen offset:0 lds
  v_mfma_f32_16x16x32_bf16 v[84:87], a[92:95], v[196:199], v[84:87]
  s_cmp_lt_u32 s33, 98304
  s_cselect_b32 s33, s33, 0
  v_mfma_f32_16x16x32_bf16 v[88:91], a[84:87], v[200:203], v[88:91]
  ds_read_b128 v[168:171], v18 offset:4096
  v_mfma_f32_16x16x32_bf16 v[92:95], a[88:91], v[200:203], v[92:95]
  ds_read_b128 v[232:235], v23 offset:6528
  v_mfma_f32_16x16x32_bf16 v[96:99], a[92:95], v[200:203], v[96:99]
  v_mfma_f32_16x16x32_bf16 v[100:103], a[84:87], v[204:207], v[100:103]
  ds_read_b128 v[172:175], v18 offset:6144
  v_mfma_f32_16x16x32_bf16 v[104:107], a[88:91], v[204:207], v[104:107]
  buffer_store_dwordx4 v[224:227], v26, s[16:19], s21 offen offset:2048 sc1
  v_mfma_f32_16x16x32_bf16 v[108:111], a[92:95], v[204:207], v[108:111]
  s_waitcnt lgkmcnt(5)
  v_mfma_f32_16x16x32_bf16 v[112:115], a[84:87], v[208:211], v[112:115]
  ds_read_b128 v[176:179], v18 offset:8192
  v_mfma_f32_16x16x32_bf16 v[116:119], a[88:91], v[208:211], v[116:119]
  v_mfma_f32_16x16x32_bf16 v[120:123], a[92:95], v[208:211], v[120:123]
  v_mfma_f32_16x16x32_bf16 v[124:127], a[84:87], v[212:215], v[124:127]
  ds_read_b128 v[180:183], v18 offset:10240
  v_mfma_f32_16x16x32_bf16 v[128:131], a[88:91], v[212:215], v[128:131]
  buffer_load_dwordx4 v11, s[8:11], s30 offen offset:1024 lds
  v_mfma_f32_16x16x32_bf16 v[132:135], a[92:95], v[212:215], v[132:135]
  v_mfma_f32_16x16x32_bf16 v[136:139], a[84:87], v[216:219], v[136:139]
  ds_read_b128 v[184:187], v18 offset:12288
  v_mfma_f32_16x16x32_bf16 v[140:143], a[88:91], v[216:219], v[140:143]
  ds_read_b128 v[236:239], v23 offset:6592
  v_mfma_f32_16x16x32_bf16 v[144:147], a[92:95], v[216:219], v[144:147]
  v_mfma_f32_16x16x32_bf16 v[148:151], a[84:87], v[220:223], v[148:151]
  ds_read_b128 v[188:191], v18 offset:14336
  v_mfma_f32_16x16x32_bf16 v[152:155], a[88:91], v[220:223], v[152:155]
  buffer_store_dwordx4 v[228:231], v26, s[16:19], s21 offen offset:3072 sc1
  v_mfma_f32_16x16x32_bf16 v[156:159], a[92:95], v[220:223], v[156:159]
  s_waitcnt lgkmcnt(5)
  v_mfma_f32_16x16x32_bf16 v[64:67], a[96:99], v[160:163], v[64:67]
  ds_read_b128 v[192:195], v19 offset:0
  v_mfma_f32_16x16x32_bf16 v[68:71], a[100:103], v[160:163], v[68:71]
  v_add_u32 v18, s33, v14
  v_mfma_f32_16x16x32_bf16 v[72:75], a[104:107], v[160:163], v[72:75]
  v_mfma_f32_16x16x32_bf16 v[76:79], a[96:99], v[164:167], v[76:79]
  ds_read_b128 v[196:199], v19 offset:2048
  v_mfma_f32_16x16x32_bf16 v[80:83], a[100:103], v[164:167], v[80:83]
  buffer_load_dwordx4 v12, s[8:11], s30 offen offset:2048 lds
  v_mfma_f32_16x16x32_bf16 v[84:87], a[104:107], v[164:167], v[84:87]
  v_mfma_f32_16x16x32_bf16 v[88:91], a[96:99], v[168:171], v[88:91]
  ds_read_b128 v[200:203], v19 offset:4096
  v_mfma_f32_16x16x32_bf16 v[92:95], a[100:103], v[168:171], v[92:95]
  s_add_u32 s21, s48, 8192
  ds_read_b128 v[240:243], v23 offset:6656
  v_mfma_f32_16x16x32_bf16 v[96:99], a[104:107], v[168:171], v[96:99]
  v_mfma_f32_16x16x32_bf16 v[100:103], a[96:99], v[172:175], v[100:103]
  ds_read_b128 v[204:207], v19 offset:6144
  v_mfma_f32_16x16x32_bf16 v[104:107], a[100:103], v[172:175], v[104:107]
  buffer_store_dwordx4 v[232:235], v26, s[16:19], s21 offen offset:0 sc1
  v_mfma_f32_16x16x32_bf16 v[108:111], a[104:107], v[172:175], v[108:111]
  s_waitcnt lgkmcnt(5)
  v_mfma_f32_16x16x32_bf16 v[112:115], a[96:99], v[176:179], v[112:115]
  ds_read_b128 v[208:211], v19 offset:8192
  v_mfma_f32_16x16x32_bf16 v[116:119], a[100:103], v[176:179], v[116:119]
  v_mfma_f32_16x16x32_bf16 v[120:123], a[104:107], v[176:179], v[120:123]
  v_mfma_f32_16x16x32_bf16 v[124:127], a[96:99], v[180:183], v[124:127]
  ds_read_b128 v[212:215], v19 offset:10240
  v_mfma_f32_16x16x32_bf16 v[128:131], a[100:103], v[180:183], v[128:131]
  buffer_load_dwordx4 v13, s[8:11], s30 offen offset:3072 lds
  v_mfma_f32_16x16x32_bf16 v[132:135], a[104:107], v[180:183], v[132:135]
  s_add_u32 s30, s30, 128
  s_add_u32 m0, m0, 16384
  v_mfma_f32_16x16x32_bf16 v[136:139], a[96:99], v[184:187], v[136:139]
  ds_read_b128 v[216:219], v19 offset:12288
  v_mfma_f32_16x16x32_bf16 v[140:143], a[100:103], v[184:187], v[140:143]
  s_cmp_lt_u32 m0, s46
  s_cselect_b32 m0, m0, s47
  v_mfma_f32_16x16x32_bf16 v[144:147], a[104:107], v[184:187], v[144:147]
  ds_read_b128 v[244:247], v23 offset:6720
  v_mfma_f32_16x16x32_bf16 v[148:151], a[96:99], v[188:191], v[148:151]
  ds_read_b128 v[220:223], v19 offset:14336
  v_mfma_f32_16x16x32_bf16 v[152:155], a[100:103], v[188:191], v[152:155]
  buffer_store_dwordx4 v[236:239], v26, s[16:19], s21 offen offset:1024 sc1
  v_mfma_f32_16x16x32_bf16 v[156:159], a[104:107], v[188:191], v[156:159]
  s_waitcnt vmcnt(22) lgkmcnt(5)
  s_barrier
  v_mfma_f32_16x16x32_bf16 v[64:67], a[108:111], v[192:195], v[64:67]
  ds_read_b128 v[160:163], v18 offset:0
  v_mfma_f32_16x16x32_bf16 v[68:71], a[112:115], v[192:195], v[68:71]
  v_mfma_f32_16x16x32_bf16 v[72:75], a[116:119], v[192:195], v[72:75]
  v_add_u32 v19, s33, v15
  s_add_u32 s33, s33, 16384
  v_mfma_f32_16x16x32_bf16 v[76:79], a[108:111], v[196:199], v[76:79]
  ds_read_b128 v[164:167], v18 offset:2048
  v_mfma_f32_16x16x32_bf16 v[80:83], a[112:115], v[196:199], v[80:83]
  buffer_load_dwordx4 v10, s[8:11], s30 offen offset:0 lds
  v_mfma_f32_16x16x32_bf16 v[84:87], a[116:119], v[196:199], v[84:87]
  s_cmp_lt_u32 s33, 98304
  s_cselect_b32 s33, s33, 0
  v_mfma_f32_16x16x32_bf16 v[88:91], a[108:111], v[200:203], v[88:91]
  ds_read_b128 v[168:171], v18 offset:4096
  v_mfma_f32_16x16x32_bf16 v[92:95], a[112:115], v[200:203], v[92:95]
  v_mfma_f32_16x16x32_bf16 v[96:99], a[116:119], v[200:203], v[96:99]
  v_mfma_f32_16x16x32_bf16 v[100:103], a[108:111], v[204:207], v[100:103]
  ds_read_b128 v[172:175], v18 offset:6144
  v_mfma_f32_16x16x32_bf16 v[104:107], a[112:115], v[204:207], v[104:107]
  buffer_store_dwordx4 v[240:243], v26, s[16:19], s21 offen offset:2048 sc1
  v_mfma_f32_16x16x32_bf16 v[108:111], a[116:119], v[204:207], v[108:111]
  s_waitcnt lgkmcnt(4)
  v_mfma_f32_16x16x32_bf16 v[112:115], a[108:111], v[208:211], v[112:115]
  ds_read_b128 v[176:179], v18 offset:8192
  v_mfma_f32_16x16x32_bf16 v[116:119], a[112:115], v[208:211], v[116:119]
  v_mfma_f32_16x16x32_bf16 v[120:123], a[116:119], v[208:211], v[120:123]
  v_mfma_f32_16x16x32_bf16 v[124:127], a[108:111], v[212:215], v[124:127]
  ds_read_b128 v[180:183], v18 offset:10240
  v_mfma_f32_16x16x32_bf16 v[128:131], a[112:115], v[212:215], v[128:131]
  buffer_load_dwordx4 v11, s[8:11], s30 offen offset:1024 lds
  v_mfma_f32_16x16x32_bf16 v[132:135], a[116:119], v[212:215], v[132:135]
  v_mfma_f32_16x16x32_bf16 v[136:139], a[108:111], v[216:219], v[136:139]
  ds_read_b128 v[184:187], v18 offset:12288
  v_mfma_f32_16x16x32_bf16 v[140:143], a[112:115], v[216:219], v[140:143]
  v_mfma_f32_16x16x32_bf16 v[144:147], a[116:119], v[216:219], v[144:147]
  v_mfma_f32_16x16x32_bf16 v[148:151], a[108:111], v[220:223], v[148:151]
  ds_read_b128 v[188:191], v18 offset:14336
  v_mfma_f32_16x16x32_bf16 v[152:155], a[112:115], v[220:223], v[152:155]
  buffer_store_dwordx4 v[244:247], v26, s[16:19], s21 offen offset:3072 sc1
  v_mfma_f32_16x16x32_bf16 v[156:159], a[116:119], v[220:223], v[156:159]
  s_waitcnt lgkmcnt(4)
  v_mfma_f32_16x16x32_bf16 v[64:67], a[120:123], v[160:163], v[64:67]
  ds_read_b128 v[192:195], v19 offset:0
  v_mfma_f32_16x16x32_bf16 v[68:71], a[124:127], v[160:163], v[68:71]
  v_add_u32 v18, s33, v14
  v_mfma_f32_16x16x32_bf16 v[72:75], a[128:131], v[160:163], v[72:75]
  v_mfma_f32_16x16x32_bf16 v[76:79], a[120:123], v[164:167], v[76:79]
  ds_read_b128 v[196:199], v19 offset:2048
  v_mfma_f32_16x16x32_bf16 v[80:83], a[124:127], v[164:167], v[80:83]
  buffer_load_dwordx4 v12, s[8:11], s30 offen offset:2048 lds
  v_mfma_f32_16x16x32_bf16 v[84:87], a[128:131], v[164:167], v[84:87]
  v_mfma_f32_16x16x32_bf16 v[88:91], a[120:123], v[168:171], v[88:91]
  ds_read_b128 v[200:203], v19 offset:4096
  v_mfma_f32_16x16x32_bf16 v[92:95], a[124:127], v[168:171], v[92:95]
  v_mfma_f32_16x16x32_bf16 v[96:99], a[128:131], v[168:171], v[96:99]
  v_mfma_f32_16x16x32_bf16 v[100:103], a[120:123], v[172:175], v[100:103]
  ds_read_b128 v[204:207], v19 offset:6144
  v_mfma_f32_16x16x32_bf16 v[104:107], a[124:127], v[172:175], v[104:107]
  v_mfma_f32_16x16x32_bf16 v[108:111], a[128:131], v[172:175], v[108:111]
  s_waitcnt lgkmcnt(4)
  v_mfma_f32_16x16x32_bf16 v[112:115], a[120:123], v[176:179], v[112:115]
  ds_read_b128 v[208:211], v19 offset:8192
  v_mfma_f32_16x16x32_bf16 v[116:119], a[124:127], v[176:179], v[116:119]
  v_mfma_f32_16x16x32_bf16 v[120:123], a[128:131], v[176:179], v[120:123]
  v_mfma_f32_16x16x32_bf16 v[124:127], a[120:123], v[180:183], v[124:127]
  ds_read_b128 v[212:215], v19 offset:10240
  v_mfma_f32_16x16x32_bf16 v[128:131], a[124:127], v[180:183], v[128:131]
  buffer_load_dwordx4 v13, s[8:11], s30 offen offset:3072 lds
  v_mfma_f32_16x16x32_bf16 v[132:135], a[128:131], v[180:183], v[132:135]
  s_add_u32 s30, s30, s25
  s_sub_u32 s30, s30, 1152
  v_mfma_f32_16x16x32_bf16 v[136:139], a[120:123], v[184:187], v[136:139]
  ds_read_b128 v[216:219], v19 offset:12288
  s_add_u32 m0, m0, 16384
  v_mfma_f32_16x16x32_bf16 v[140:143], a[124:127], v[184:187], v[140:143]
  s_cmp_lt_u32 m0, s46
  s_cselect_b32 m0, m0, s47
  v_mfma_f32_16x16x32_bf16 v[144:147], a[128:131], v[184:187], v[144:147]
  v_mfma_f32_16x16x32_bf16 v[148:151], a[120:123], v[188:191], v[148:151]
  ds_read_b128 v[220:223], v19 offset:14336
  v_mfma_f32_16x16x32_bf16 v[152:155], a[124:127], v[188:191], v[152:155]
  v_mfma_f32_16x16x32_bf16 v[156:159], a[128:131], v[188:191], v[156:159]
  s_waitcnt vmcnt(23) lgkmcnt(4)
  s_barrier
  v_mfma_f32_16x16x32_bf16 v[64:67], a[132:135], v[192:195], v[64:67]
  ds_read_b128 v[160:163], v18 offset:0
  v_mfma_f32_16x16x32_bf16 v[68:71], a[136:139], v[192:195], v[68:71]
  v_mfma_f32_16x16x32_bf16 v[72:75], a[140:143], v[192:195], v[72:75]
  v_add_u32 v19, s33, v15
  s_add_u32 s33, s33, 16384
  v_mfma_f32_16x16x32_bf16 v[76:79], a[132:135], v[196:199], v[76:79]
  ds_read_b128 v[164:167], v18 offset:2048
  v_mfma_f32_16x16x32_bf16 v[80:83], a[136:139], v[196:199], v[80:83]
  buffer_load_dwordx4 v10, s[8:11], s30 offen offset:0 lds
  v_mfma_f32_16x16x32_bf16 v[84:87], a[140:143], v[196:199], v[84:87]
  s_cmp_lt_u32 s33, 98304
  s_cselect_b32 s33, s33, 0
  v_mfma_f32_16x16x32_bf16 v[88:91], a[132:135], v[200:203], v[88:91]
  ds_read_b128 v[168:171], v18 offset:4096
  v_mfma_f32_16x16x32_bf16 v[92:95], a[136:139], v[200:203], v[92:95]
  v_mfma_f32_16x16x32_bf16 v[96:99], a[140:143], v[200:203], v[96:99]
  v_mfma_f32_16x16x32_bf16 v[100:103], a[132:135], v[204:207], v[100:103]
  ds_read_b128 v[172:175], v18 offset:6144
  v_mfma_f32_16x16x32_bf16 v[104:107], a[136:139], v[204:207], v[104:107]
  v_mfma_f32_16x16x32_bf16 v[108:111], a[140:143], v[204:207], v[108:111]
  s_waitcnt lgkmcnt(4)
  v_mfma_f32_16x16x32_bf16 v[112:115], a[132:135], v[208:211], v[112:115]
  ds_read_b128 v[176:179], v18 offset:8192
  v_mfma_f32_16x16x32_bf16 v[116:119], a[136:139], v[208:211], v[116:119]
  v_mfma_f32_16x16x32_bf16 v[120:123], a[140:143], v[208:211], v[120:123]
  v_mfma_f32_16x16x32_bf16 v[124:127], a[132:135], v[212:215], v[124:127]
  ds_read_b128 v[180:183], v18 offset:10240
  v_mfma_f32_16x16x32_bf16 v[128:131], a[136:139], v[212:215], v[128:131]
  buffer_load_dwordx4 v11, s[8:11], s30 offen offset:1024 lds
  v_mfma_f32_16x16x32_bf16 v[132:135], a[140:143], v[212:215], v[132:135]
  v_mfma_f32_16x16x32_bf16 v[136:139], a[132:135], v[216:219], v[136:139]
  ds_read_b128 v[184:187], v18 offset:12288
  v_mfma_f32_16x16x32_bf16 v[140:143], a[136:139], v[216:219], v[140:143]
  v_mfma_f32_16x16x32_bf16 v[144:147], a[140:143], v[216:219], v[144:147]
  v_mfma_f32_16x16x32_bf16 v[148:151], a[132:135], v[220:223], v[148:151]
  ds_read_b128 v[188:191], v18 offset:14336
  v_mfma_f32_16x16x32_bf16 v[152:155], a[136:139], v[220:223], v[152:155]
  v_mfma_f32_16x16x32_bf16 v[156:159], a[140:143], v[220:223], v[156:159]
  s_waitcnt lgkmcnt(4)
  v_mfma_f32_16x16x32_bf16 v[64:67], a[144:147], v[160:163], v[64:67]
  ds_read_b128 v[192:195], v19 offset:0
  v_mfma_f32_16x16x32_bf16 v[68:71], a[148:151], v[160:163], v[68:71]
  v_add_u32 v18, s33, v14
  v_mfma_f32_16x16x32_bf16 v[72:75], a[152:155], v[160:163], v[72:75]
  v_mfma_f32_16x16x32_bf16 v[76:79], a[144:147], v[164:167], v[76:79]
  ds_read_b128 v[196:199], v19 offset:2048
  v_mfma_f32_16x16x32_bf16 v[80:83], a[148:151], v[164:167], v[80:83]
  buffer_load_dwordx4 v12, s[8:11], s30 offen offset:2048 lds
  v_mfma_f32_16x16x32_bf16 v[84:87], a[152:155], v[164:167], v[84:87]
  v_mfma_f32_16x16x32_bf16 v[88:91], a[144:147], v[168:171], v[88:91]
  ds_read_b128 v[200:203], v19 offset:4096
  v_mfma_f32_16x16x32_bf16 v[92:95], a[148:151], v[168:171], v[92:95]
  v_mfma_f32_16x16x32_bf16 v[96:99], a[152:155], v[168:171], v[96:99]
  v_mfma_f32_16x16x32_bf16 v[100:103], a[144:147], v[172:175], v[100:103]
  ds_read_b128 v[204:207], v19 offset:6144
  v_mfma_f32_16x16x32_bf16 v[104:107], a[148:151], v[172:175], v[104:107]
  v_mfma_f32_16x16x32_bf16 v[108:111], a[152:155], v[172:175], v[108:111]
  s_waitcnt lgkmcnt(4)
  v_mfma_f32_16x16x32_bf16 v[112:115], a[144:147], v[176:179], v[112:115]
  ds_read_b128 v[208:211], v19 offset:8192
  v_mfma_f32_16x16x32_bf16 v[116:119], a[148:151], v[176:179], v[116:119]
  v_mfma_f32_16x16x32_bf16 v[120:123], a[152:155], v[176:179], v[120:123]
  v_mfma_f32_16x16x32_bf16 v[124:127], a[144:147], v[180:183], v[124:127]
  ds_read_b128 v[212:215], v19 offset:10240
  v_mfma_f32_16x16x32_bf16 v[128:131], a[148:151], v[180:183], v[128:131]
  buffer_load_dwordx4 v13, s[8:11], s30 offen offset:3072 lds
  v_mfma_f32_16x16x32_bf16 v[132:135], a[152:155], v[180:183], v[132:135]
  s_add_u32 s30, s30, 128
  s_add_u32 m0, m0, 16384
  v_mfma_f32_16x16x32_bf16 v[136:139], a[144:147], v[184:187], v[136:139]
  ds_read_b128 v[216:219], v19 offset:12288
  v_mfma_f32_16x16x32_bf16 v[140:143], a[148:151], v[184:187], v[140:143]
  s_cmp_lt_u32 m0, s46
  s_cselect_b32 m0, m0, s47
  v_mfma_f32_16x16x32_bf16 v[144:147], a[152:155], v[184:187], v[144:147]
  v_mfma_f32_16x16x32_bf16 v[148:151], a[144:147], v[188:191], v[148:151]
  ds_read_b128 v[220:223], v19 offset:14336
  v_mfma_f32_16x16x32_bf16 v[152:155], a[148:151], v[188:191], v[152:155]
  v_mfma_f32_16x16x32_bf16 v[156:159], a[152:155], v[188:191], v[156:159]
  s_waitcnt vmcnt(6) lgkmcnt(4)
  s_barrier
  v_mfma_f32_16x16x32_bf16 v[64:67], a[156:159], v[192:195], v[64:67]
  ds_read_b128 v[160:163], v18 offset:0
  v_mfma_f32_16x16x32_bf16 v[68:71], a[160:163], v[192:195], v[68:71]
  s_cmp_eq_u32 s48, 0x80000000
  s_cbranch_scc1 kv_163
  s_cmp_lg_u32 s20, 0
  s_cbranch_scc1 af_164
  v_mov_b32 v4, 0
  v_mov_b32 v5, 1
  s_mov_b64 exec, 1
  buffer_atomic_add v5, v4, s[72:75], s61 offen sc1
  s_mov_b64 exec, -1
  s_nop 1
af_164:
kv_163:
  v_mfma_f32_16x16x32_bf16 v[72:75], a[164:167], v[192:195], v[72:75]
  v_add_u32 v19, s33, v15
  s_add_u32 s33, s33, 16384
  v_mfma_f32_16x16x32_bf16 v[76:79], a[156:159], v[196:199], v[76:79]
  ds_read_b128 v[164:167], v18 offset:2048
  v_mfma_f32_16x16x32_bf16 v[80:83], a[160:163], v[196:199], v[80:83]
  buffer_load_dwordx4 v10, s[8:11], s30 offen offset:0 lds
  v_mfma_f32_16x16x32_bf16 v[84:87], a[164:167], v[196:199], v[84:87]
  s_cmp_lt_u32 s33, 98304
  s_cselect_b32 s33, s33, 0
  v_mfma_f32_16x16x32_bf16 v[88:91], a[156:159], v[200:203], v[88:91]
  ds_read_b128 v[168:171], v18 offset:4096
  v_mfma_f32_16x16x32_bf16 v[92:95], a[160:163], v[200:203], v[92:95]
  v_mfma_f32_16x16x32_bf16 v[96:99], a[164:167], v[200:203], v[96:99]
  v_mfma_f32_16x16x32_bf16 v[100:103], a[156:159], v[204:207], v[100:103]
  ds_read_b128 v[172:175], v18 offset:6144
  v_mfma_f32_16x16x32_bf16 v[104:107], a[160:163], v[204:207], v[104:107]
  v_mfma_f32_16x16x32_bf16 v[108:111], a[164:167], v[204:207], v[108:111]
  s_waitcnt lgkmcnt(4)
  v_mfma_f32_16x16x32_bf16 v[112:115], a[156:159], v[208:211], v[112:115]
  ds_read_b128 v[176:179], v18 offset:8192
  v_mfma_f32_16x16x32_bf16 v[116:119], a[160:163], v[208:211], v[116:119]
  v_mfma_f32_16x16x32_bf16 v[120:123], a[164:167], v[208:211], v[120:123]
  v_mfma_f32_16x16x32_bf16 v[124:127], a[156:159], v[212:215], v[124:127]
  ds_read_b128 v[180:183], v18 offset:10240
  v_mfma_f32_16x16x32_bf16 v[128:131], a[160:163], v[212:215], v[128:131]
  buffer_load_dwordx4 v11, s[8:11], s30 offen offset:1024 lds
  v_mfma_f32_16x16x32_bf16 v[132:135], a[164:167], v[212:215], v[132:135]
  v_mfma_f32_16x16x32_bf16 v[136:139], a[156:159], v[216:219], v[136:139]
  ds_read_b128 v[184:187], v18 offset:12288
  v_mfma_f32_16x16x32_bf16 v[140:143], a[160:163], v[216:219], v[140:143]
  v_mfma_f32_16x16x32_bf16 v[144:147], a[164:167], v[216:219], v[144:147]
  v_mfma_f32_16x16x32_bf16 v[148:151], a[156:159], v[220:223], v[148:151]
  ds_read_b128 v[188:191], v18 offset:14336
  v_mfma_f32_16x16x32_bf16 v[152:155], a[160:163], v[220:223], v[152:155]
  v_mfma_f32_16x16x32_bf16 v[156:159], a[164:167], v[220:223], v[156:159]
  s_waitcnt lgkmcnt(4)
  v_mfma_f32_16x16x32_bf16 v[64:67], a[168:171], v[160:163], v[64:67]
  ds_read_b128 v[192:195], v19 offset:0
  v_mfma_f32_16x16x32_bf16 v[68:71], a[172:175], v[160:163], v[68:71]
  v_add_u32 v18, s33, v14
  s_mov_b32 s61, s60
  v_mfma_f32_16x16x32_bf16 v[72:75], a[176:179], v[160:163], v[72:75]
  s_add_u32 s60, s60, s62
  s_mul_i32 s48, s20, 393216
  v_mfma_f32_16x16x32_bf16 v[76:79], a[168:171], v[164:167], v[76:79]
  ds_read_b128 v[196:199], v19 offset:2048
  s_add_u32 s48, s48, s27
  v_mfma_f32_16x16x32_bf16 v[80:83], a[172:175], v[164:167], v[80:83]
  buffer_load_dwordx4 v12, s[8:11], s30 offen offset:2048 lds
  v_mfma_f32_16x16x32_bf16 v[84:87], a[176:179], v[164:167], v[84:87]
  s_add_u32 s27, s27, s28
  s_sub_u32 s26, s26, 1
  v_mfma_f32_16x16x32_bf16 v[88:91], a[168:171], v[168:171], v[88:91]
  ds_read_b128 v[200:203], v19 offset:4096
  v_mfma_f32_16x16x32_bf16 v[92:95], a[172:175], v[168:171], v[92:95]
  v_mfma_f32_16x16x32_bf16 v[96:99], a[176:179], v[168:171], v[96:99]
  v_mfma_f32_16x16x32_bf16 v[100:103], a[168:171], v[172:175], v[100:103]
  ds_read_b128 v[204:207], v19 offset:6144
  v_mfma_f32_16x16x32_bf16 v[104:107], a[172:175], v[172:175], v[104:107]
  v_mfma_f32_16x16x32_bf16 v[108:111], a[176:179], v[172:175], v[108:111]
  s_waitcnt lgkmcnt(4)
  v_mfma_f32_16x16x32_bf16 v[112:115], a[168:171], v[176:179], v[112:115]
  ds_read_b128 v[208:211], v19 offset:8192
  v_mfma_f32_16x16x32_bf16 v[116:119], a[172:175], v[176:179], v[116:119]
  v_mfma_f32_16x16x32_bf16 v[120:123], a[176:179], v[176:179], v[120:123]
  v_mfma_f32_16x16x32_bf16 v[124:127], a[168:171], v[180:183], v[124:127]
  ds_read_b128 v[212:215], v19 offset:10240
  v_mfma_f32_16x16x32_bf16 v[128:131], a[172:175], v[180:183], v[128:131]
  buffer_load_dwordx4 v13, s[8:11], s30 offen offset:3072 lds
  v_mfma_f32_16x16x32_bf16 v[132:135], a[176:179], v[180:183], v[132:135]
  s_add_u32 s30, s30, 128
  s_add_u32 m0, m0, 16384
  v_mfma_f32_16x16x32_bf16 v[136:139], a[168:171], v[184:187], v[136:139]
  ds_read_b128 v[216:219], v19 offset:12288
  v_mfma_f32_16x16x32_bf16 v[140:143], a[172:175], v[184:187], v[140:143]
  s_cmp_lt_u32 m0, s46
  s_cselect_b32 m0, m0, s47
  v_mfma_f32_16x16x32_bf16 v[144:147], a[176:179], v[184:187], v[144:147]
  v_mfma_f32_16x16x32_bf16 v[148:151], a[168:171], v[188:191], v[148:151]
  ds_read_b128 v[220:223], v19 offset:14336
  v_mfma_f32_16x16x32_bf16 v[152:155], a[172:175], v[188:191], v[152:155]
  v_mfma_f32_16x16x32_bf16 v[156:159], a[176:179], v[188:191], v[156:159]
  s_waitcnt vmcnt(15) lgkmcnt(4)
  s_barrier
  v_mfma_f32_16x16x32_bf16 v[64:67], a[180:183], v[192:195], v[64:67]
  ds_read_b128 v[160:163], v18 offset:0
  v_mfma_f32_16x16x32_bf16 v[68:71], a[184:187], v[192:195], v[68:71]
  v_mfma_f32_16x16x32_bf16 v[72:75], a[188:191], v[192:195], v[72:75]
  v_add_u32 v19, s33, v15
  s_add_u32 s33, s33, 16384
  v_mfma_f32_16x16x32_bf16 v[76:79], a[180:183], v[196:199], v[76:79]
  ds_read_b128 v[164:167], v18 offset:2048
  v_mfma_f32_16x16x32_bf16 v[80:83], a[184:187], v[196:199], v[80:83]
  buffer_load_dwordx4 v10, s[8:11], s30 offen offset:0 lds
  v_mfma_f32_16x16x32_bf16 v[84:87], a[188:191], v[196:199], v[84:87]
  s_cmp_lt_u32 s33, 98304
  s_cselect_b32 s33, s33, 0
  v_mfma_f32_16x16x32_bf16 v[88:91], a[180:183], v[200:203], v[88:91]
  ds_read_b128 v[168:171], v18 offset:4096
  v_mfma_f32_16x16x32_bf16 v[92:95], a[184:187], v[200:203], v[92:95]
  v_mfma_f32_16x16x32_bf16 v[96:99], a[188:191], v[200:203], v[96:99]
  v_mfma_f32_16x16x32_bf16 v[100:103], a[180:183], v[204:207], v[100:103]
  ds_read_b128 v[172:175], v18 offset:6144
  v_mfma_f32_16x16x32_bf16 v[104:107], a[184:187], v[204:207], v[104:107]
  v_mfma_f32_16x16x32_bf16 v[108:111], a[188:191], v[204:207], v[108:111]
  s_waitcnt lgkmcnt(4)
  v_mfma_f32_16x16x32_bf16 v[112:115], a[180:183], v[208:211], v[112:115]
  ds_read_b128 v[176:179], v18 offset:8192
  v_mfma_f32_16x16x32_bf16 v[116:119], a[184:187], v[208:211], v[116:119]
  v_mfma_f32_16x16x32_bf16 v[120:123], a[188:191], v[208:211], v[120:123]
  v_mfma_f32_16x16x32_bf16 v[124:127], a[180:183], v[212:215], v[124:127]
  ds_read_b128 v[180:183], v18 offset:10240
  v_mfma_f32_16x16x32_bf16 v[128:131], a[184:187], v[212:215], v[128:131]
  buffer_load_dwordx4 v11, s[8:11], s30 offen offset:1024 lds
  v_mfma_f32_16x16x32_bf16 v[132:135], a[188:191], v[212:215], v[132:135]
  v_mfma_f32_16x16x32_bf16 v[136:139], a[180:183], v[216:219], v[136:139]
  ds_read_b128 v[184:187], v18 offset:12288
  v_mfma_f32_16x16x32_bf16 v[140:143], a[184:187], v[216:219], v[140:143]
  v_mfma_f32_16x16x32_bf16 v[144:147], a[188:191], v[216:219], v[144:147]
  v_mfma_f32_16x16x32_bf16 v[148:151], a[180:183], v[220:223], v[148:151]
  ds_read_b128 v[188:191], v18 offset:14336
  v_mfma_f32_16x16x32_bf16 v[152:155], a[184:187], v[220:223], v[152:155]
  v_mfma_f32_16x16x32_bf16 v[156:159], a[188:191], v[220:223], v[156:159]
  s_waitcnt lgkmcnt(4)
  v_mfma_f32_16x16x32_bf16 v[64:67], a[192:195], v[160:163], v[64:67]
  ds_read_b128 v[192:195], v19 offset:0
  v_mfma_f32_16x16x32_bf16 v[68:71], a[196:199], v[160:163], v[68:71]
  v_add_u32 v18, s33, v14
  v_mfma_f32_16x16x32_bf16 v[72:75], a[200:203], v[160:163], v[72:75]
  v_mfma_f32_16x16x32_bf16 v[76:79], a[192:195], v[164:167], v[76:79]
  ds_read_b128 v[196:199], v19 offset:2048
  v_mfma_f32_16x16x32_bf16 v[80:83], a[196:199], v[164:167], v[80:83]
  buffer_load_dwordx4 v12, s[8:11], s30 offen offset:2048 lds
  v_mfma_f32_16x16x32_bf16 v[84:87], a[200:203], v[164:167], v[84:87]
  v_mfma_f32_16x16x32_bf16 v[88:91], a[192:195], v[168:171], v[88:91]
  ds_read_b128 v[200:203], v19 offset:4096
  v_mfma_f32_16x16x32_bf16 v[92:95], a[196:199], v[168:171], v[92:95]
  v_mfma_f32_16x16x32_bf16 v[96:99], a[200:203], v[168:171], v[96:99]
  v_mfma_f32_16x16x32_bf16 v[100:103], a[192:195], v[172:175], v[100:103]
  ds_read_b128 v[204:207], v19 offset:6144
  v_mfma_f32_16x16x32_bf16 v[104:107], a[196:199], v[172:175], v[104:107]
  v_mfma_f32_16x16x32_bf16 v[108:111], a[200:203], v[172:175], v[108:111]
  s_waitcnt lgkmcnt(4)
  v_mfma_f32_16x16x32_bf16 v[112:115], a[192:195], v[176:179], v[112:115]
  ds_read_b128 v[208:211], v19 offset:8192
  v_mfma_f32_16x16x32_bf16 v[116:119], a[196:199], v[176:179], v[116:119]
  v_mfma_f32_16x16x32_bf16 v[120:123], a[200:203], v[176:179], v[120:123]
  v_mfma_f32_16x16x32_bf16 v[124:127], a[192:195], v[180:183], v[124:127]
  ds_read_b128 v[212:215], v19 offset:10240
  v_mfma_f32_16x16x32_bf16 v[128:131], a[196:199], v[180:183], v[128:131]
  buffer_load_dwordx4 v13, s[8:11], s30 offen offset:3072 lds
  v_mfma_f32_16x16x32_bf16 v[132:135], a[200:203], v[180:183], v[132:135]
  s_add_u32 s30, s30, 128
  s_add_u32 m0, m0, 16384
  v_mfma_f32_16x16x32_bf16 v[136:139], a[192:195], v[184:187], v[136:139]
  ds_read_b128 v[216:219], v19 offset:12288
  v_mfma_f32_16x16x32_bf16 v[140:143], a[196:199], v[184:187], v[140:143]
  s_cmp_lt_u32 m0, s46
  s_cselect_b32 m0, m0, s47
  v_mfma_f32_16x16x32_bf16 v[144:147], a[200:203], v[184:187], v[144:147]
  v_mfma_f32_16x16x32_bf16 v[148:151], a[192:195], v[188:191], v[148:151]
  ds_read_b128 v[220:223], v19 offset:14336
  v_mfma_f32_16x16x32_bf16 v[152:155], a[196:199], v[188:191], v[152:155]
  v_mfma_f32_16x16x32_bf16 v[156:159], a[200:203], v[188:191], v[156:159]
  s_waitcnt vmcnt(12) lgkmcnt(4)
  s_barrier
  v_mfma_f32_16x16x32_bf16 v[64:67], a[204:207], v[192:195], v[64:67]
  ds_read_b128 v[160:163], v18 offset:0
  v_mfma_f32_16x16x32_bf16 v[68:71], a[208:211], v[192:195], v[68:71]
  v_mfma_f32_16x16x32_bf16 v[72:75], a[212:215], v[192:195], v[72:75]
  v_add_u32 v19, s33, v15
  s_add_u32 s33, s33, 16384
  v_mfma_f32_16x16x32_bf16 v[76:79], a[204:207], v[196:199], v[76:79]
  ds_read_b128 v[164:167], v18 offset:2048
  v_mfma_f32_16x16x32_bf16 v[80:83], a[208:211], v[196:199], v[80:83]
  buffer_load_dwordx4 v10, s[8:11], s30 offen offset:0 lds
  v_mfma_f32_16x16x32_bf16 v[84:87], a[212:215], v[196:199], v[84:87]
  s_cmp_lt_u32 s33, 98304
  s_cselect_b32 s33, s33, 0
  v_mfma_f32_16x16x32_bf16 v[88:91], a[204:207], v[200:203], v[88:91]
  ds_read_b128 v[168:171], v18 offset:4096
  v_mfma_f32_16x16x32_bf16 v[92:95], a[208:211], v[200:203], v[92:95]
  v_mfma_f32_16x16x32_bf16 v[96:99], a[212:215], v[200:203], v[96:99]
  v_mfma_f32_16x16x32_bf16 v[100:103], a[204:207], v[204:207], v[100:103]
  ds_read_b128 v[172:175], v18 offset:6144
  v_mfma_f32_16x16x32_bf16 v[104:107], a[208:211], v[204:207], v[104:107]
  v_mfma_f32_16x16x32_bf16 v[108:111], a[212:215], v[204:207], v[108:111]
  s_waitcnt lgkmcnt(4)
  v_mfma_f32_16x16x32_bf16 v[112:115], a[204:207], v[208:211], v[112:115]
  ds_read_b128 v[176:179], v18 offset:8192
  v_mfma_f32_16x16x32_bf16 v[116:119], a[208:211], v[208:211], v[116:119]
  v_mfma_f32_16x16x32_bf16 v[120:123], a[212:215], v[208:211], v[120:123]
  v_mfma_f32_16x16x32_bf16 v[124:127], a[204:207], v[212:215], v[124:127]
  ds_read_b128 v[180:183], v18 offset:10240
  v_mfma_f32_16x16x32_bf16 v[128:131], a[208:211], v[212:215], v[128:131]
  buffer_load_dwordx4 v11, s[8:11], s30 offen offset:1024 lds
  v_mfma_f32_16x16x32_bf16 v[132:135], a[212:215], v[212:215], v[132:135]
  v_mfma_f32_16x16x32_bf16 v[136:139], a[204:207], v[216:219], v[136:139]
  ds_read_b128 v[184:187], v18 offset:12288
  v_mfma_f32_16x16x32_bf16 v[140:143], a[208:211], v[216:219], v[140:143]
  v_mfma_f32_16x16x32_bf16 v[144:147], a[212:215], v[216:219], v[144:147]
  v_mfma_f32_16x16x32_bf16 v[148:151], a[204:207], v[220:223], v[148:151]
  ds_read_b128 v[188:191], v18 offset:14336
  v_mfma_f32_16x16x32_bf16 v[152:155], a[208:211], v[220:223], v[152:155]
  v_mfma_f32_16x16x32_bf16 v[156:159], a[212:215], v[220:223], v[156:159]
  s_waitcnt lgkmcnt(4)
  v_mfma_f32_16x16x32_bf16 v[64:67], a[216:219], v[160:163], v[64:67]
  ds_read_b128 v[192:195], v19 offset:0
  v_mfma_f32_16x16x32_bf16 v[68:71], a[220:223], v[160:163], v[68:71]
  v_add_u32 v18, s33, v14
  v_mfma_f32_16x16x32_bf16 v[72:75], a[224:227], v[160:163], v[72:75]
  v_mfma_f32_16x16x32_bf16 v[76:79], a[216:219], v[164:167], v[76:79]
  ds_read_b128 v[196:199], v19 offset:2048
  v_mfma_f32_16x16x32_bf16 v[80:83], a[220:223], v[164:167], v[80:83]
  buffer_load_dwordx4 v12, s[8:11], s30 offen offset:2048 lds
  v_mfma_f32_16x16x32_bf16 v[84:87], a[224:227], v[164:167], v[84:87]
  v_mfma_f32_16x16x32_bf16 v[88:91], a[216:219], v[168:171], v[88:91]
  ds_read_b128 v[200:203], v19 offset:4096
  v_mfma_f32_16x16x32_bf16 v[92:95], a[220:223], v[168:171], v[92:95]
  v_mfma_f32_16x16x32_bf16 v[96:99], a[224:227], v[168:171], v[96:99]
  v_mfma_f32_16x16x32_bf16 v[100:103], a[216:219], v[172:175], v[100:103]
  ds_read_b128 v[204:207], v19 offset:6144
  v_mfma_f32_16x16x32_bf16 v[104:107], a[220:223], v[172:175], v[104:107]
  v_mfma_f32_16x16x32_bf16 v[108:111], a[224:227], v[172:175], v[108:111]
  s_waitcnt lgkmcnt(4)
  v_mfma_f32_16x16x32_bf16 v[112:115], a[216:219], v[176:179], v[112:115]
  ds_read_b128 v[208:211], v19 offset:8192
  v_mfma_f32_16x16x32_bf16 v[116:119], a[220:223], v[176:179], v[116:119]
  v_mfma_f32_16x16x32_bf16 v[120:123], a[224:227], v[176:179], v[120:123]
  v_mfma_f32_16x16x32_bf16 v[124:127], a[216:219], v[180:183], v[124:127]
  ds_read_b128 v[212:215], v19 offset:10240
  v_mfma_f32_16x16x32_bf16 v[128:131], a[220:223], v[180:183], v[128:131]
  buffer_load_dwordx4 v13, s[8:11], s30 offen offset:3072 lds
  v_mfma_f32_16x16x32_bf16 v[132:135], a[224:227], v[180:183], v[132:135]
  s_add_u32 s30, s30, 128
  s_add_u32 m0, m0, 16384
  v_mfma_f32_16x16x32_bf16 v[136:139], a[216:219], v[184:187], v[136:139]
  ds_read_b128 v[216:219], v19 offset:12288
  v_mfma_f32_16x16x32_bf16 v[140:143], a[220:223], v[184:187], v[140:143]
  s_cmp_lt_u32 m0, s46
  s_cselect_b32 m0, m0, s47
  v_mfma_f32_16x16x32_bf16 v[144:147], a[224:227], v[184:187], v[144:147]
  v_mfma_f32_16x16x32_bf16 v[148:151], a[216:219], v[188:191], v[148:151]
  ds_read_b128 v[220:223], v19 offset:14336
  v_mfma_f32_16x16x32_bf16 v[152:155], a[220:223], v[188:191], v[152:155]
  v_mfma_f32_16x16x32_bf16 v[156:159], a[224:227], v[188:191], v[156:159]
  s_waitcnt vmcnt(12) lgkmcnt(4)
  s_barrier
  v_mfma_f32_16x16x32_bf16 v[64:67], a[228:231], v[192:195], v[64:67]
  ds_read_b128 v[160:163], v18 offset:0
  v_mfma_f32_16x16x32_bf16 v[68:71], a[232:235], v[192:195], v[68:71]
  v_mfma_f32_16x16x32_bf16 v[72:75], a[236:239], v[192:195], v[72:75]
  v_add_u32 v19, s33, v15
  s_add_u32 s33, s33, 16384
  v_mfma_f32_16x16x32_bf16 v[76:79], a[228:231], v[196:199], v[76:79]
  ds_read_b128 v[164:167], v18 offset:2048
  v_cvt_pk_bf16_f32 v224, v64, v65
  v_mfma_f32_16x16x32_bf16 v[80:83], a[232:235], v[196:199], v[80:83]
  buffer_load_dwordx4 v10, s[8:11], s30 offen offset:0 lds
  v_mfma_f32_16x16x32_bf16 v[84:87], a[236:239], v[196:199], v[84:87]
  s_cmp_lt_u32 s33, 98304
  s_cselect_b32 s33, s33, 0
  v_mfma_f32_16x16x32_bf16 v[88:91], a[228:231], v[200:203], v[88:91]
  ds_read_b128 v[168:171], v18 offset:4096
  v_cvt_pk_bf16_f32 v225, v66, v67
  v_mfma_f32_16x16x32_bf16 v[92:95], a[232:235], v[200:203], v[92:95]
  v_cvt_pk_bf16_f32 v226, v68, v69
  v_cvt_pk_bf16_f32 v227, v70, v71
  v_mfma_f32_16x16x32_bf16 v[96:99], a[236:239], v[200:203], v[96:99]
  v_cvt_pk_bf16_f32 v228, v72, v73
  v_cvt_pk_bf16_f32 v229, v74, v75
  v_mfma_f32_16x16x32_bf16 v[100:103], a[228:231], v[204:207], v[100:103]
  ds_read_b128 v[172:175], v18 offset:6144
  v_mfma_f32_16x16x32_bf16 v[104:107], a[232:235], v[204:207], v[104:107]
  ds_write_b64 v22, v[224:225] offset:0
  v_mfma_f32_16x16x32_bf16 v[108:111], a[236:239], v[204:207], v[108:111]
  s_waitcnt lgkmcnt(5)
  v_mfma_f32_16x16x32_bf16 v[112:115], a[228:231], v[208:211], v[112:115]
  ds_read_b128 v[176:179], v18 offset:8192
  v_mfma_f32_16x16x32_bf16 v[116:119], a[232:235], v[208:211], v[116:119]
  ds_write_b64 v22, v[226:227] offset:8
  v_mfma_f32_16x16x32_bf16 v[120:123], a[236:239], v[208:211], v[120:123]
  ds_write_b64 v16, v[228:229] offset:64
  v_mfma_f32_16x16x32_bf16 v[124:127], a[228:231], v[212:215], v[124:127]
  ds_read_b128 v[180:183], v18 offset:10240
  v_cvt_pk_bf16_f32 v230, v76, v77
  v_mfma_f32_16x16x32_bf16 v[128:131], a[232:235], v[212:215], v[128:131]
  buffer_load_dwordx4 v11, s[8:11], s30 offen offset:1024 lds
  v_mfma_f32_16x16x32_bf16 v[132:135], a[236:239], v[212:215], v[132:135]
  v_cvt_pk_bf16_f32 v231, v78, v79
  v_cvt_pk_bf16_f32 v232, v80, v81
  v_mfma_f32_16x16x32_bf16 v[136:139], a[228:231], v[216:219], v[136:139]
  ds_read_b128 v[184:187], v18 offset:12288
  v_cvt_pk_bf16_f32 v233, v82, v83
  v_mfma_f32_16x16x32_bf16 v[140:143], a[232:235], v[216:219], v[140:143]
  v_cvt_pk_bf16_f32 v234, v84, v85
  v_cvt_pk_bf16_f32 v235, v86, v87
  v_mfma_f32_16x16x32_bf16 v[144:147], a[236:239], v[216:219], v[144:147]
  ds_write_b64 v22, v[230:231] offset:6400
  v_mfma_f32_16x16x32_bf16 v[148:151], a[228:231], v[220:223], v[148:151]
  ds_read_b128 v[188:191], v18 offset:14336
  v_mfma_f32_16x16x32_bf16 v[152:155], a[232:235], v[220:223], v[152:155]
  ds_write_b64 v22, v[232:233] offset:6408
  v_mfma_f32_16x16x32_bf16 v[156:159], a[236:239], v[220:223], v[156:159]
  s_waitcnt lgkmcnt(9)
kv_end_166:
  s_cmp_gt_u32 s26, 0
  s_cbranch_scc1 kv_blk_165
  s_nop 7
  ds_write_b64 v16, v[234:235] offset:6464
  v_cvt_pk_bf16_f32 v236, v88, v89
  v_cvt_pk_bf16_f32 v237, v90, v91
  v_cvt_pk_bf16_f32 v238, v92, v93
  v_cvt_pk_bf16_f32 v239, v94, v95
  v_cvt_pk_bf16_f32 v240, v96, v97
  v_cvt_pk_bf16_f32 v241, v98, v99
  ds_write_b64 v22, v[236:237] offset:12800
  ds_write_b64 v22, v[238:239] offset:12808
  ds_write_b64 v16, v[240:241] offset:12864
  v_cvt_pk_bf16_f32 v242, v100, v101
  v_cvt_pk_bf16_f32 v243, v102, v103
  v_cvt_pk_bf16_f32 v244, v104, v105
  v_cvt_pk_bf16_f32 v245, v106, v107
  v_cvt_pk_bf16_f32 v246, v108, v109
  v_cvt_pk_bf16_f32 v247, v110, v111
  ds_write_b64 v22, v[242:243] offset:19200
  ds_write_b64 v22, v[244:245] offset:19208
  ds_write_b64 v16, v[246:247] offset:19264
  v_cvt_pk_bf16_f32 v224, v112, v113
  v_cvt_pk_bf16_f32 v225, v114, v115
  v_cvt_pk_bf16_f32 v226, v116, v117
  v_cvt_pk_bf16_f32 v227, v118, v119
  v_cvt_pk_bf16_f32 v228, v120, v121
  v_cvt_pk_bf16_f32 v229, v122, v123
  ds_write_b64 v22, v[224:225] offset:25600
  ds_write_b64 v22, v[226:227] offset:25608
  ds_write_b64 v16, v[228:229] offset:25664
  v_cvt_pk_bf16_f32 v230, v124, v125
  v_cvt_pk_bf16_f32 v231, v126, v127
  v_cvt_pk_bf16_f32 v232, v128, v129
  v_cvt_pk_bf16_f32 v233, v130, v131
  v_cvt_pk_bf16_f32 v234, v132, v133
  v_cvt_pk_bf16_f32 v235, v134, v135
  ds_write_b64 v22, v[230:231] offset:32000
  ds_write_b64 v22, v[232:233] offset:32008
  ds_write_b64 v16, v[234:235] offset:32064
  v_cvt_pk_bf16_f32 v236, v136, v137
  v_cvt_pk_bf16_f32 v237, v138, v139
  v_cvt_pk_bf16_f32 v238, v140, v141
  v_cvt_pk_bf16_f32 v239, v142, v143
  v_cvt_pk_bf16_f32 v240, v144, v145
  v_cvt_pk_bf16_f32 v241, v146, v147
  ds_write_b64 v22, v[236:237] offset:38400
  ds_write_b64 v22, v[238:239] offset:38408
  ds_write_b64 v16, v[240:241] offset:38464
  v_cvt_pk_bf16_f32 v242, v148, v149
  v_cvt_pk_bf16_f32 v243, v150, v151
  v_cvt_pk_bf16_f32 v244, v152, v153
  v_cvt_pk_bf16_f32 v245, v154, v155
  v_cvt_pk_bf16_f32 v246, v156, v157
  v_cvt_pk_bf16_f32 v247, v158, v159
  ds_write_b64 v22, v[242:243] offset:44800
  ds_write_b64 v22, v[244:245] offset:44808
  ds_write_b64 v16, v[246:247] offset:44864
  s_waitcnt vmcnt(0) lgkmcnt(0)
  s_barrier
  ds_read_b128 v[224:227], v23 offset:0
  ds_read_b128 v[228:231], v23 offset:64
  ds_read_b128 v[232:235], v23 offset:128
  ds_read_b128 v[236:239], v23 offset:192
  ds_read_b128 v[240:243], v23 offset:256
  ds_read_b128 v[244:247], v23 offset:320
  s_waitcnt lgkmcnt(0)
  s_add_u32 s21, s48, 0
  buffer_store_dwordx4 v[224:227], v26, s[16:19], s21 offen offset:0 sc1
  buffer_store_dwordx4 v[228:231], v26, s[16:19], s21 offen offset:1024 sc1
  buffer_store_dwordx4 v[232:235], v26, s[16:19], s21 offen offset:2048 sc1
  buffer_store_dwordx4 v[236:239], v26, s[16:19], s21 offen offset:3072 sc1
  s_add_u32 s21, s48, 4096
  buffer_store_dwordx4 v[240:243], v26, s[16:19], s21 offen offset:0 sc1
  buffer_store_dwordx4 v[244:247], v26, s[16:19], s21 offen offset:1024 sc1
  s_nop 1
  ds_read_b128 v[224:227], v23 offset:6400
  ds_read_b128 v[228:231], v23 offset:6464
  ds_read_b128 v[232:235], v23 offset:6528
  ds_read_b128 v[236:239], v23 offset:6592
  ds_read_b128 v[240:243], v23 offset:6656
  ds_read_b128 v[244:247], v23 offset:6720
  s_waitcnt lgkmcnt(0)
  buffer_store_dwordx4 v[224:227], v26, s[16:19], s21 offen offset:2048 sc1
  buffer_store_dwordx4 v[228:231], v26, s[16:19], s21 offen offset:3072 sc1
  s_add_u32 s21, s48, 8192
  buffer_store_dwordx4 v[232:235], v26, s[16:19], s21 offen offset:0 sc1
  buffer_store_dwordx4 v[236:239], v26, s[16:19], s21 offen offset:1024 sc1
  buffer_store_dwordx4 v[240:243], v26, s[16:19], s21 offen offset:2048 sc1
  buffer_store_dwordx4 v[244:247], v26, s[16:19], s21 offen offset:3072 sc1
  s_nop 1
  s_waitcnt vmcnt(0)
  s_barrier
  s_cmp_lg_u32 s20, 0
  s_cbranch_scc1 af_167
  v_mov_b32 v4, 0
  v_mov_b32 v5, 1
  s_mov_b64 exec, 1
  buffer_atomic_add v5, v4, s[72:75], s61 offen sc1
  s_mov_b64 exec, -1
  s_nop 1
af_167:
  s_cmp_lg_u32 s43, 0
  s_cbranch_scc1 kv_fin
  s_mov_b32 s87, -2
  s_add_u32 s21, s42, 32
  s_branch do_opb2
kv_help:
  s_waitcnt vmcnt(0) lgkmcnt(0)
  s_barrier
  s_load_dwordx2 s[4:5], s[0:1], 0
  s_load_dwordx2 s[6:7], s[0:1], 24
  s_load_dwordx2 s[36:37], s[0:1], 32
  s_load_dwordx2 s[38:39], s[0:1], 104
  s_and_b32 s43, s3, 1
  s_bfe_u32 s42, s3, 0x50001
  s_lshr_b32 s40, s42, 2
  s_waitcnt lgkmcnt(0)
  s_cmp_eq_u32 s43, 1
  s_cselect_b32 s6, s36, s6
  s_cselect_b32 s7, s37, s7
  s_mov_b32 s8, s4
  s_mov_b32 s9, s5
  s_mov_b32 s10, 2621440
  s_mov_b32 s11, 0x00020000
  s_mov_b32 s12, s6
  s_mov_b32 s13, s7
  s_mov_b32 s14, 7864320
  s_mov_b32 s15, 0x00020000
  s_mov_b32 s16, s38
  s_mov_b32 s17, s39
  s_mov_b32 s18, 50331648
  s_mov_b32 s19, 0x00020000
  s_mul_i32 s44, s42, 384
  s_mov_b32 s28, 1572864
  s_mov_b32 s43, 2
  s_load_dwordx2 s[6:7], s[0:1], 16
  s_waitcnt lgkmcnt(0)
  s_mov_b32 s12, s6
  s_mov_b32 s13, s7
  s_mov_b32 s14, 7864320
  s_mov_b32 s15, 0x00020000
  s_add_u32 s16, s38, 57671680
  s_addc_u32 s17, s39, 0
  s_mov_b32 s18, 3145728
  s_mov_b32 s19, 0x00020000
  s_mov_b32 s24, 2293760
  s_mov_b32 s25, 163840
  v_mov_b32 v9, 2731
  s_and_b32 s22, s20, 1
  s_lshl_b32 s22, s22, 2
  v_add_u32 v8, 0, v1
  v_mul_u32_u24 v7, v8, v9
  v_lshrrev_b32 v7, 16, v7
  v_mul_u32_u24 v4, 24, v7
  v_sub_u32 v8, v8, v4
  v_and_b32 v4, 2, v7
  v_xor_b32 v8, v8, v4
  v_xor_b32 v8, s22, v8
  v_xor_b32 v5, 4, v8
  s_mov_b32 s21, 12288
  v_mul_lo_u32 v7, v7, s21
  v_lshl_add_u32 v40, v8, 4, v7
  v_lshl_add_u32 v43, v5, 4, v7
  v_add_u32 v8, 64, v1
  v_mul_u32_u24 v7, v8, v9
  v_lshrrev_b32 v7, 16, v7
  v_mul_u32_u24 v4, 24, v7
  v_sub_u32 v8, v8, v4
  v_and_b32 v4, 2, v7
  v_xor_b32 v8, v8, v4
  v_xor_b32 v8, s22, v8
  v_xor_b32 v5, 4, v8
  s_mov_b32 s21, 12288
  v_mul_lo_u32 v7, v7, s21
  v_lshl_add_u32 v41, v8, 4, v7
  v_lshl_add_u32 v44, v5, 4, v7
  v_add_u32 v8, 128, v1
  v_mul_u32_u24 v7, v8, v9
  v_lshrrev_b32 v7, 16, v7
  v_mul_u32_u24 v4, 24, v7
  v_sub_u32 v8, v8, v4
  v_and_b32 v4, 2, v7
  v_xor_b32 v8, v8, v4
  v_xor_b32 v8, s22, v8
  v_xor_b32 v5, 4, v8
  s_mov_b32 s21, 12288
  v_mul_lo_u32 v7, v7, s21
  v_lshl_add_u32 v42, v8, 4, v7
  v_lshl_add_u32 v45, v5, 4, v7
  s_mul_i32 s23, s20, 491520
  s_add_u32 s23, s23, s44
  s_mul_i32 s22, s20, 15360
  s_add_u32 s22, s22, 98304
  s_add_u32 s21, s23, 0
  s_add_u32 m0, s22, 0
  s_nop 0
  buffer_load_dwordx4 v40, s[12:15], s21 offen lds
  s_add_u32 m0, s22, 1024
  s_nop 0
  buffer_load_dwordx4 v41, s[12:15], s21 offen lds
  s_add_u32 m0, s22, 2048
  s_nop 0
  buffer_load_dwordx4 v42, s[12:15], s21 offen lds
  s_add_u32 s21, s23, 98304
  s_add_u32 m0, s22, 3072
  s_nop 0
  buffer_load_dwordx4 v43, s[12:15], s21 offen lds
  s_add_u32 m0, s22, 4096
  s_nop 0
  buffer_load_dwordx4 v44, s[12:15], s21 offen lds
  s_add_u32 m0, s22, 5120
  s_nop 0
  buffer_load_dwordx4 v45, s[12:15], s21 offen lds
  s_add_u32 s21, s23, 196608
  s_add_u32 m0, s22, 6144
  s_nop 0
  buffer_load_dwordx4 v40, s[12:15], s21 offen lds
  s_add_u32 m0, s22, 7168
  s_nop 0
  buffer_load_dwordx4 v41, s[12:15], s21 offen lds
  s_add_u32 m0, s22, 8192
  s_nop 0
  buffer_load_dwordx4 v42, s[12:15], s21 offen lds
  s_add_u32 s21, s23, 294912
  s_add_u32 m0, s22, 9216
  s_nop 0
  buffer_load_dwordx4 v43, s[12:15], s21 offen lds
  s_add_u32 m0, s22, 10240
  s_nop 0
  buffer_load_dwordx4 v44, s[12:15], s21 offen lds
  s_add_u32 m0, s22, 11264
  s_nop 0
  buffer_load_dwordx4 v45, s[12:15], s21 offen lds
  s_add_u32 s21, s23, 393216
  s_add_u32 m0, s22, 12288
  s_nop 0
  buffer_load_dwordx4 v40, s[12:15], s21 offen lds
  s_add_u32 m0, s22, 13312
  s_nop 0
  buffer_load_dwordx4 v41, s[12:15], s21 offen lds
  s_add_u32 m0, s22, 14336
  s_nop 0
  buffer_load_dwordx4 v42, s[12:15], s21 offen lds
  s_add_u32 s21, s23, 1966080
  buffer_load_dwordx4 v[64:67], v40, s[12:15], s21 offen
  buffer_load_dwordx4 v[68:71], v41, s[12:15], s21 offen
  buffer_load_dwordx4 v[72:75], v42, s[12:15], s21 offen
  s_add_u32 s21, s23, 2064384
  buffer_load_dwordx4 v[76:79], v43, s[12:15], s21 offen
  buffer_load_dwordx4 v[80:83], v44, s[12:15], s21 offen
  buffer_load_dwordx4 v[84:87], v45, s[12:15], s21 offen
  s_add_u32 s21, s23, 2162688
  buffer_load_dwordx4 v[88:91], v40, s[12:15], s21 offen
  buffer_load_dwordx4 v[92:95], v41, s[12:15], s21 offen
  buffer_load_dwordx4 v[96:99], v42, s[12:15], s21 offen
  s_add_u32 s21, s23, 2260992
  buffer_load_dwordx4 v[100:103], v43, s[12:15], s21 offen
  buffer_load_dwordx4 v[104:107], v44, s[12:15], s21 offen
  buffer_load_dwordx4 v[108:111], v45, s[12:15], s21 offen
  s_add_u32 s21, s23, 2359296
  buffer_load_dwordx4 v[112:115], v40, s[12:15], s21 offen
  buffer_load_dwordx4 v[116:119], v41, s[12:15], s21 offen
  buffer_load_dwordx4 v[120:123], v42, s[12:15], s21 offen
  s_add_u32 s21, s23, 3932160
  buffer_load_dwordx4 v[124:127], v40, s[12:15], s21 offen
  buffer_load_dwordx4 v[128:131], v41, s[12:15], s21 offen
  buffer_load_dwordx4 v[132:135], v42, s[12:15], s21 offen
  s_add_u32 s21, s23, 4030464
  buffer_load_dwordx4 v[136:139], v43, s[12:15], s21 offen
  buffer_load_dwordx4 v[140:143], v44, s[12:15], s21 offen
  buffer_load_dwordx4 v[144:147], v45, s[12:15], s21 offen
  s_add_u32 s21, s23, 4128768
  buffer_load_dwordx4 v[148:151], v40, s[12:15], s21 offen
  buffer_load_dwordx4 v[152:155], v41, s[12:15], s21 offen
  buffer_load_dwordx4 v[156:159], v42, s[12:15], s21 offen
  s_add_u32 s21, s23, 4227072
  buffer_load_dwordx4 v[160:163], v43, s[12:15], s21 offen
  buffer_load_dwordx4 v[164:167], v44, s[12:15], s21 offen
  buffer_load_dwordx4 v[168:171], v45, s[12:15], s21 offen
  s_add_u32 s21, s23, 4325376
  buffer_load_dwordx4 v[172:175], v40, s[12:15], s21 offen
  buffer_load_dwordx4 v[176:179], v41, s[12:15], s21 offen
  buffer_load_dwordx4 v[180:183], v42, s[12:15], s21 offen
  s_add_u32 s21, s23, 5898240
  buffer_load_dwordx4 v[184:187], v40, s[12:15], s21 offen
  buffer_load_dwordx4 v[188:191], v41, s[12:15], s21 offen
  buffer_load_dwordx4 v[192:195], v42, s[12:15], s21 offen
  s_add_u32 s21, s23, 5996544
  buffer_load_dwordx4 v[196:199], v43, s[12:15], s21 offen
  buffer_load_dwordx4 v[200:203], v44, s[12:15], s21 offen
  buffer_load_dwordx4 v[204:207], v45, s[12:15], s21 offen
  s_add_u32 s21, s23, 6094848
  buffer_load_dwordx4 v[208:211], v40, s[12:15], s21 offen
  buffer_load_dwordx4 v[212:215], v41, s[12:15], s21 offen
  buffer_load_dwordx4 v[216:219], v42, s[12:15], s21 offen
  s_add_u32 s21, s23, 6193152
  buffer_load_dwordx4 v[220:223], v43, s[12:15], s21 offen
  buffer_load_dwordx4 v[224:227], v44, s[12:15], s21 offen
  buffer_load_dwordx4 v[228:231], v45, s[12:15], s21 offen
  s_add_u32 s21, s23, 6291456
  buffer_load_dwordx4 v[232:235], v40, s[12:15], s21 offen
  buffer_load_dwordx4 v[236:239], v41, s[12:15], s21 offen
  buffer_load_dwordx4 v[240:243], v42, s[12:15], s21 offen
  v_lshl_add_u32 v49, v1, 4, s22
  v_lshrrev_b32 v7, 2, v2
  v_and_b32 v4, 2, v7
  v_and_b32 v5, 1, v3
  v_lshl_or_b32 v4, v5, 2, v4
  v_lshl_add_u32 v7, v3, 3, v7
  v_mul_u32_u24 v7, 384, v7
  v_and_b32 v5, 1, v2
  v_lshl_add_u32 v7, v5, 3, v7
  v_add_u32 v7, 98304, v7
  v_bfe_u32 v8, v2, 1, 1
  s_mul_i32 s21, s20, 6
  v_add_u32 v8, s21, v8
  v_add_u32 v5, 0, v8
  v_xor_b32 v5, v5, v4
  v_lshl_add_u32 v46, v5, 4, v7
  v_add_u32 v5, 2, v8
  v_xor_b32 v5, v5, v4
  v_lshl_add_u32 v47, v5, 4, v7
  v_add_u32 v5, 4, v8
  v_xor_b32 v5, v5, v4
  v_lshl_add_u32 v48, v5, 4, v7
  s_waitcnt vmcnt(45)
  s_barrier
  ds_read_b64_tr_b16 a[0:1], v46 offset:0
  ds_read_b64_tr_b16 a[2:3], v46 offset:1536
  ds_read_b64_tr_b16 a[4:5], v47 offset:0
  ds_read_b64_tr_b16 a[6:7], v47 offset:1536
  ds_read_b64_tr_b16 a[8:9], v48 offset:0
  ds_read_b64_tr_b16 a[10:11], v48 offset:1536
  ds_read_b64_tr_b16 a[12:13], v46 offset:12288
  ds_read_b64_tr_b16 a[14:15], v46 offset:13824
  ds_read_b64_tr_b16 a[16:17], v47 offset:12288
  ds_read_b64_tr_b16 a[18:19], v47 offset:13824
  ds_read_b64_tr_b16 a[20:21], v48 offset:12288
  ds_read_b64_tr_b16 a[22:23], v48 offset:13824
  ds_read_b64_tr_b16 a[24:25], v46 offset:24576
  ds_read_b64_tr_b16 a[26:27], v46 offset:26112
  ds_read_b64_tr_b16 a[28:29], v47 offset:24576
  ds_read_b64_tr_b16 a[30:31], v47 offset:26112
  ds_read_b64_tr_b16 a[32:33], v48 offset:24576
  ds_read_b64_tr_b16 a[34:35], v48 offset:26112
  ds_read_b64_tr_b16 a[36:37], v46 offset:36864
  ds_read_b64_tr_b16 a[38:39], v46 offset:38400
  ds_read_b64_tr_b16 a[40:41], v47 offset:36864
  ds_read_b64_tr_b16 a[42:43], v47 offset:38400
  ds_read_b64_tr_b16 a[44:45], v48 offset:36864
  ds_read_b64_tr_b16 a[46:47], v48 offset:38400
  ds_read_b64_tr_b16 a[48:49], v46 offset:49152
  ds_read_b64_tr_b16 a[50:51], v46 offset:50688
  ds_read_b64_tr_b16 a[52:53], v47 offset:49152
  ds_read_b64_tr_b16 a[54:55], v47 offset:50688
  ds_read_b64_tr_b16 a[56:57], v48 offset:49152
  ds_read_b64_tr_b16 a[58:59], v48 offset:50688
  v_lshrrev_b32 v11, 3, v1
  v_and_b32 v12, 7, v1
  v_xor_b32 v12, v12, v11
  v_mul_u32_u24 v11, 1280, v11
  v_lshl_add_u32 v10, v12, 4, v11
  s_mul_i32 s46, s20, 40960
  v_add_u32 v10, s46, v10
  s_lshl_b32 s47, s20, 12
  s_add_u32 s47, s47, 0
  s_add_u32 s46, s47, 98304
  s_mov_b32 s30, s24
  s_add_u32 s32, s47, 32768
  v_add_u32 v11, 9216, v10
  v_add_u32 v12, 18432, v10
  v_add_u32 v13, 27648, v10
  s_mov_b32 m0, s32
  s_nop 0
  buffer_load_dwordx4 v10, s[8:11], s30 offen offset:0 lds
  buffer_load_dwordx4 v11, s[8:11], s30 offen offset:1024 lds
  buffer_load_dwordx4 v12, s[8:11], s30 offen offset:2048 lds
  buffer_load_dwordx4 v13, s[8:11], s30 offen offset:3072 lds
  s_add_u32 s30, s30, 128
  s_add_u32 s32, s32, 16384
  s_cmp_lt_u32 s32, s46
  s_cselect_b32 s32, s32, s47
  s_mov_b32 m0, s32
  s_nop 0
  buffer_load_dwordx4 v10, s[8:11], s30 offen offset:0 lds
  buffer_load_dwordx4 v11, s[8:11], s30 offen offset:1024 lds
  buffer_load_dwordx4 v12, s[8:11], s30 offen offset:2048 lds
  buffer_load_dwordx4 v13, s[8:11], s30 offen offset:3072 lds
  s_add_u32 s30, s30, 128
  s_add_u32 s32, s32, 16384
  s_cmp_lt_u32 s32, s46
  s_cselect_b32 s32, s32, s47
  s_mov_b32 m0, s32
  s_nop 0
  buffer_load_dwordx4 v10, s[8:11], s30 offen offset:0 lds
  buffer_load_dwordx4 v11, s[8:11], s30 offen offset:1024 lds
  buffer_load_dwordx4 v12, s[8:11], s30 offen offset:2048 lds
  buffer_load_dwordx4 v13, s[8:11], s30 offen offset:3072 lds
  s_add_u32 s30, s30, 128
  s_add_u32 s32, s32, 16384
  s_cmp_lt_u32 s32, s46
  s_cselect_b32 s32, s32, s47
  s_mov_b32 m0, s32
  s_nop 0
  buffer_load_dwordx4 v10, s[8:11], s30 offen offset:0 lds
  buffer_load_dwordx4 v11, s[8:11], s30 offen offset:1024 lds
  buffer_load_dwordx4 v12, s[8:11], s30 offen offset:2048 lds
  buffer_load_dwordx4 v13, s[8:11], s30 offen offset:3072 lds
  s_add_u32 s30, s30, 128
  s_add_u32 s32, s32, 16384
  s_cmp_lt_u32 s32, s46
  s_cselect_b32 s32, s32, s47
  s_waitcnt lgkmcnt(0)
  s_barrier
  s_waitcnt vmcnt(46)
  ds_write_b128 v49, v[64:67] offset:0
  ds_write_b128 v49, v[68:71] offset:1024
  ds_write_b128 v49, v[72:75] offset:2048
  ds_write_b128 v49, v[76:79] offset:3072
  ds_write_b128 v49, v[80:83] offset:4096
  ds_write_b128 v49, v[84:87] offset:5120
  ds_write_b128 v49, v[88:91] offset:6144
  ds_write_b128 v49, v[92:95] offset:7168
  ds_write_b128 v49, v[96:99] offset:8192
  ds_write_b128 v49, v[100:103] offset:9216
  ds_write_b128 v49, v[104:107] offset:10240
  ds_write_b128 v49, v[108:111] offset:11264
  ds_write_b128 v49, v[112:115] offset:12288
  ds_write_b128 v49, v[116:119] offset:13312
  ds_write_b128 v49, v[120:123] offset:14336
  s_waitcnt lgkmcnt(0)
  s_barrier
  ds_read_b64_tr_b16 a[60:61], v46 offset:0
  ds_read_b64_tr_b16 a[62:63], v46 offset:1536
  ds_read_b64_tr_b16 a[64:65], v47 offset:0
  ds_read_b64_tr_b16 a[66:67], v47 offset:1536
  ds_read_b64_tr_b16 a[68:69], v48 offset:0
  ds_read_b64_tr_b16 a[70:71], v48 offset:1536
  ds_read_b64_tr_b16 a[72:73], v46 offset:12288
  ds_read_b64_tr_b16 a[74:75], v46 offset:13824
  ds_read_b64_tr_b16 a[76:77], v47 offset:12288
  ds_read_b64_tr_b16 a[78:79], v47 offset:13824
  ds_read_b64_tr_b16 a[80:81], v48 offset:12288
  ds_read_b64_tr_b16 a[82:83], v48 offset:13824
  ds_read_b64_tr_b16 a[84:85], v46 offset:24576
  ds_read_b64_tr_b16 a[86:87], v46 offset:26112
  ds_read_b64_tr_b16 a[88:89], v47 offset:24576
  ds_read_b64_tr_b16 a[90:91], v47 offset:26112
  ds_read_b64_tr_b16 a[92:93], v48 offset:24576
  ds_read_b64_tr_b16 a[94:95], v48 offset:26112
  ds_read_b64_tr_b16 a[96:97], v46 offset:36864
  ds_read_b64_tr_b16 a[98:99], v46 offset:38400
  ds_read_b64_tr_b16 a[100:101], v47 offset:36864
  ds_read_b64_tr_b16 a[102:103], v47 offset:38400
  ds_read_b64_tr_b16 a[104:105], v48 offset:36864
  ds_read_b64_tr_b16 a[106:107], v48 offset:38400
  ds_read_b64_tr_b16 a[108:109], v46 offset:49152
  ds_read_b64_tr_b16 a[110:111], v46 offset:50688
  ds_read_b64_tr_b16 a[112:113], v47 offset:49152
  ds_read_b64_tr_b16 a[114:115], v47 offset:50688
  ds_read_b64_tr_b16 a[116:117], v48 offset:49152
  ds_read_b64_tr_b16 a[118:119], v48 offset:50688
  s_waitcnt lgkmcnt(0)
  s_barrier
  s_waitcnt vmcnt(31)
  ds_write_b128 v49, v[124:127] offset:0
  ds_write_b128 v49, v[128:131] offset:1024
  ds_write_b128 v49, v[132:135] offset:2048
  ds_write_b128 v49, v[136:139] offset:3072
  ds_write_b128 v49, v[140:143] offset:4096
  ds_write_b128 v49, v[144:147] offset:5120
  ds_write_b128 v49, v[148:151] offset:6144
  ds_write_b128 v49, v[152:155] offset:7168
  ds_write_b128 v49, v[156:159] offset:8192
  ds_write_b128 v49, v[160:163] offset:9216
  ds_write_b128 v49, v[164:167] offset:10240
  ds_write_b128 v49, v[168:171] offset:11264
  ds_write_b128 v49, v[172:175] offset:12288
  ds_write_b128 v49, v[176:179] offset:13312
  ds_write_b128 v49, v[180:183] offset:14336
  s_waitcnt lgkmcnt(0)
  s_barrier
  ds_read_b64_tr_b16 a[120:121], v46 offset:0
  ds_read_b64_tr_b16 a[122:123], v46 offset:1536
  ds_read_b64_tr_b16 a[124:125], v47 offset:0
  ds_read_b64_tr_b16 a[126:127], v47 offset:1536
  ds_read_b64_tr_b16 a[128:129], v48 offset:0
  ds_read_b64_tr_b16 a[130:131], v48 offset:1536
  ds_read_b64_tr_b16 a[132:133], v46 offset:12288
  ds_read_b64_tr_b16 a[134:135], v46 offset:13824
  ds_read_b64_tr_b16 a[136:137], v47 offset:12288
  ds_read_b64_tr_b16 a[138:139], v47 offset:13824
  ds_read_b64_tr_b16 a[140:141], v48 offset:12288
  ds_read_b64_tr_b16 a[142:143], v48 offset:13824
  ds_read_b64_tr_b16 a[144:145], v46 offset:24576
  ds_read_b64_tr_b16 a[146:147], v46 offset:26112
  ds_read_b64_tr_b16 a[148:149], v47 offset:24576
  ds_read_b64_tr_b16 a[150:151], v47 offset:26112
  ds_read_b64_tr_b16 a[152:153], v48 offset:24576
  ds_read_b64_tr_b16 a[154:155], v48 offset:26112
  ds_read_b64_tr_b16 a[156:157], v46 offset:36864
  ds_read_b64_tr_b16 a[158:159], v46 offset:38400
  ds_read_b64_tr_b16 a[160:161], v47 offset:36864
  ds_read_b64_tr_b16 a[162:163], v47 offset:38400
  ds_read_b64_tr_b16 a[164:165], v48 offset:36864
  ds_read_b64_tr_b16 a[166:167], v48 offset:38400
  ds_read_b64_tr_b16 a[168:169], v46 offset:49152
  ds_read_b64_tr_b16 a[170:171], v46 offset:50688
  ds_read_b64_tr_b16 a[172:173], v47 offset:49152
  ds_read_b64_tr_b16 a[174:175], v47 offset:50688
  ds_read_b64_tr_b16 a[176:177], v48 offset:49152
  ds_read_b64_tr_b16 a[178:179], v48 offset:50688
  s_waitcnt lgkmcnt(0)
  s_barrier
  s_waitcnt vmcnt(16)
  ds_write_b128 v49, v[184:187] offset:0
  ds_write_b128 v49, v[188:191] offset:1024
  ds_write_b128 v49, v[192:195] offset:2048
  ds_write_b128 v49, v[196:199] offset:3072
  ds_write_b128 v49, v[200:203] offset:4096
  ds_write_b128 v49, v[204:207] offset:5120
  ds_write_b128 v49, v[208:211] offset:6144
  ds_write_b128 v49, v[212:215] offset:7168
  ds_write_b128 v49, v[216:219] offset:8192
  ds_write_b128 v49, v[220:223] offset:9216
  ds_write_b128 v49, v[224:227] offset:10240
  ds_write_b128 v49, v[228:231] offset:11264
  ds_write_b128 v49, v[232:235] offset:12288
  ds_write_b128 v49, v[236:239] offset:13312
  ds_write_b128 v49, v[240:243] offset:14336
  s_waitcnt lgkmcnt(0)
  s_barrier
  ds_read_b64_tr_b16 a[180:181], v46 offset:0
  ds_read_b64_tr_b16 a[182:183], v46 offset:1536
  ds_read_b64_tr_b16 a[184:185], v47 offset:0
  ds_read_b64_tr_b16 a[186:187], v47 offset:1536
  ds_read_b64_tr_b16 a[188:189], v48 offset:0
  ds_read_b64_tr_b16 a[190:191], v48 offset:1536
  ds_read_b64_tr_b16 a[192:193], v46 offset:12288
  ds_read_b64_tr_b16 a[194:195], v46 offset:13824
  ds_read_b64_tr_b16 a[196:197], v47 offset:12288
  ds_read_b64_tr_b16 a[198:199], v47 offset:13824
  ds_read_b64_tr_b16 a[200:201], v48 offset:12288
  ds_read_b64_tr_b16 a[202:203], v48 offset:13824
  ds_read_b64_tr_b16 a[204:205], v46 offset:24576
  ds_read_b64_tr_b16 a[206:207], v46 offset:26112
  ds_read_b64_tr_b16 a[208:209], v47 offset:24576
  ds_read_b64_tr_b16 a[210:211], v47 offset:26112
  ds_read_b64_tr_b16 a[212:213], v48 offset:24576
  ds_read_b64_tr_b16 a[214:215], v48 offset:26112
  ds_read_b64_tr_b16 a[216:217], v46 offset:36864
  ds_read_b64_tr_b16 a[218:219], v46 offset:38400
  ds_read_b64_tr_b16 a[220:221], v47 offset:36864
  ds_read_b64_tr_b16 a[222:223], v47 offset:38400
  ds_read_b64_tr_b16 a[224:225], v48 offset:36864
  ds_read_b64_tr_b16 a[226:227], v48 offset:38400
  ds_read_b64_tr_b16 a[228:229], v46 offset:49152
  ds_read_b64_tr_b16 a[230:231], v46 offset:50688
  ds_read_b64_tr_b16 a[232:233], v47 offset:49152
  ds_read_b64_tr_b16 a[234:235], v47 offset:50688
  ds_read_b64_tr_b16 a[236:237], v48 offset:49152
  ds_read_b64_tr_b16 a[238:239], v48 offset:50688
  s_waitcnt lgkmcnt(0)
  s_barrier
  s_mov_b32 s26, 2
  s_mul_i32 s27, s42, 12288
  s_lshl_b32 s60, s42, 7
  s_add_u32 s60, s60, 112640
  s_mov_b32 s62, 0
  s_branch kv_main
kv_fin:
  s_cmp_eq_u32 s43, 2
  s_cbranch_scc1 q_final
  s_branch queue
not_kv:
  s_cmp_ge_u32 s3, 96
  s_cbranch_scc1 not_vw
  s_sub_u32 s2, s3, 64
  s_load_dwordx2 s[72:73], s[0:1], 104
  s_waitcnt lgkmcnt(0)
  s_add_u32 s72, s72, 81068032
  s_addc_u32 s73, s73, 0
  s_mov_b32 s74, 116736
  s_mov_b32 s75, 0x00020000
  s_add_u32 s8, s38, 78643200
  s_addc_u32 s9, s39, 0
  s_mov_b32 s10, 2162688
  s_mov_b32 s11, 0x00020000
  s_add_u32 s12, s38, 50331648
  s_addc_u32 s13, s39, 0
  s_mov_b32 s14, 12582912
  s_mov_b32 s15, 0x00020000
  s_add_u32 s16, s38, 83886079
  s_addc_u32 s17, s39, 0
  s_and_b32 s16, s16, 0xffe00000
  s_mov_b32 s18, 2097152
  s_mov_b32 s19, 0x00020000
  v_lshlrev_b32 v8, 4, v0
  v_lshlrev_b32 v9, 4, v1
  v_mov_b32 v4, 0
  v_mov_b32 v12, -1
  v_mov_b32 v5, 0
  v_mov_b32 v13, -1
  v_mov_b32 v6, 0
  v_mov_b32 v14, -1
  v_mov_b32 v7, 0
  v_mov_b32 v15, -1
  s_lshl_b32 s21, s2, 12
  buffer_store_dwordx4 v[4:7], v8, s[72:75], s21 offen sc1
  s_lshr_b32 s21, s2, 3
  s_lshl_b32 s21, s21, 15
  s_bfe_u32 s22, s2, 0x10002
  s_lshl_b32 s22, s22, 13
  s_add_u32 s21, s21, s22
  s_bfe_u32 s22, s2, 0x10001
  s_lshl_b32 s22, s22, 14
  s_add_u32 s21, s21, s22
  s_and_b32 s22, s2, 1
  s_mul_i32 s22, s22, 3
  s_add_u32 s22, s22, s20
  s_lshl_b32 s22, s22, 10
  s_add_u32 s21, s21, s22
  s_cmp_lt_u32 s20, 3
  s_cselect_b32 s21, s21, 0x80000000
  buffer_store_dwordx4 v[4:7], v9, s[16:19], s21 offen sc1
  s_mul_i32 s23, s20, 540672
  s_lshl_b32 s21, s2, 11
  s_add_u32 s21, s21, s23
  s_add_u32 s21, s21, 81920
  buffer_store_dwordx4 v[12:15], v9, s[8:11], s21 offen sc1
  buffer_store_dwordx4 v[12:15], v9, s[8:11], s21 offen offset:1024 sc1
  s_mul_i32 s21, s2, 3072
  s_add_u32 s21, s21, s23
  s_add_u32 s21, s21, 278528
  buffer_store_dwordx4 v[12:15], v9, s[8:11], s21 offen sc1
  buffer_store_dwordx4 v[12:15], v9, s[8:11], s21 offen offset:1024 sc1
  buffer_store_dwordx4 v[12:15], v9, s[8:11], s21 offen offset:2048 sc1
  s_lshl_b32 s21, s2, 9
  s_add_u32 s21, s21, s23
  s_add_u32 s21, s21, 376832
  s_mov_b64 exec, 0xffffffff
  buffer_store_dwordx4 v[12:15], v9, s[8:11], s21 offen sc1
  s_mov_b64 exec, -1
  s_lshl_b32 s21, s20, 5
  s_add_u32 s21, s21, s2
  s_mul_i32 s21, s21, 3072
  s_cmp_lt_u32 s20, 3
  s_cselect_b32 s21, s21, 0x80000000
  s_add_u32 s22, s21, 6291456
  buffer_store_dwordx4 v[12:15], v9, s[12:15], s21 offen offset:0 sc1
  buffer_store_dwordx4 v[12:15], v9, s[12:15], s22 offen offset:0 sc1
  buffer_store_dwordx4 v[12:15], v9, s[12:15], s21 offen offset:1024 sc1
  buffer_store_dwordx4 v[12:15], v9, s[12:15], s22 offen offset:1024 sc1
  buffer_store_dwordx4 v[12:15], v9, s[12:15], s21 offen offset:2048 sc1
  buffer_store_dwordx4 v[12:15], v9, s[12:15], s22 offen offset:2048 sc1
  s_waitcnt vmcnt(0)
  s_barrier
  s_mov_b32 s21, 76
  s_cmp_lg_u32 s20, 0
  s_cbranch_scc1 af_168
  v_mov_b32 v10, 0
  v_mov_b32 v11, 1
  s_mov_b64 exec, 1
  buffer_atomic_add v11, v10, s[32:35], s21 offen sc1
  s_mov_b64 exec, -1
  s_nop 1
af_168:
  s_load_dwordx2 s[6:7], s[0:1], 40
  s_load_dwordx2 s[38:39], s[0:1], 104
  s_waitcnt lgkmcnt(0)
  s_mov_b32 s12, s6
  s_mov_b32 s13, s7
  s_mov_b32 s14, 7864320
  s_mov_b32 s15, 0x00020000
  s_mov_b32 s16, s38
  s_mov_b32 s17, s39
  s_mov_b32 s18, 50331648
  s_mov_b32 s19, 0x00020000
  s_add_u32 s24, s38, 114294784
  s_addc_u32 s25, s39, 0
  s_mov_b32 s26, 83886080
  s_mov_b32 s27, 0x00020000
  s_load_dwordx2 s[72:73], s[0:1], 104
  s_waitcnt lgkmcnt(0)
  s_add_u32 s72, s72, 81068032
  s_addc_u32 s73, s73, 0
  s_mov_b32 s74, 116736
  s_mov_b32 s75, 0x00020000
  v_mov_b32 v29, 52429
  s_mul_i32 s21, s20, 960
  s_add_u32 s21, s21, 0
  v_add_u32 v21, s21, v1
  v_mul_u32_u24 v22, v21, v29
  v_lshrrev_b32 v22, 22, v22
  v_mul_u32_u24 v23, 80, v22
  v_sub_u32 v21, v21, v23
  v_bfe_u32 v23, v22, 3, 1
  v_and_b32 v24, 3, v22
  v_lshl_add_u32 v23, v23, 2, v24
  v_lshlrev_b32 v23, 1, v23
  v_xor_b32 v21, v21, v23
  v_cmp_gt_u32 vcc, 32, v22
  v_bfe_u32 v26, v22, 3, 2
  v_lshl_add_u32 v25, v26, 2, v24
  v_bfe_u32 v26, v22, 2, 1
  v_lshl_add_u32 v25, v26, 4, v25
  v_cndmask_b32 v25, v22, v25, vcc
  v_mul_u32_u24 v25, 1280, v25
  v_lshl_add_u32 v64, v21, 4, v25
  s_mul_i32 s21, s20, 960
  s_add_u32 s21, s21, 64
  v_add_u32 v21, s21, v1
  v_mul_u32_u24 v22, v21, v29
  v_lshrrev_b32 v22, 22, v22
  v_mul_u32_u24 v23, 80, v22
  v_sub_u32 v21, v21, v23
  v_bfe_u32 v23, v22, 3, 1
  v_and_b32 v24, 3, v22
  v_lshl_add_u32 v23, v23, 2, v24
  v_lshlrev_b32 v23, 1, v23
  v_xor_b32 v21, v21, v23
  v_cmp_gt_u32 vcc, 32, v22
  v_bfe_u32 v26, v22, 3, 2
  v_lshl_add_u32 v25, v26, 2, v24
  v_bfe_u32 v26, v22, 2, 1
  v_lshl_add_u32 v25, v26, 4, v25
  v_cndmask_b32 v25, v22, v25, vcc
  v_mul_u32_u24 v25, 1280, v25
  v_lshl_add_u32 v65, v21, 4, v25
  s_mul_i32 s21, s20, 960
  s_add_u32 s21, s21, 128
  v_add_u32 v21, s21, v1
  v_mul_u32_u24 v22, v21, v29
  v_lshrrev_b32 v22, 22, v22
  v_mul_u32_u24 v23, 80, v22
  v_sub_u32 v21, v21, v23
  v_bfe_u32 v23, v22, 3, 1
  v_and_b32 v24, 3, v22
  v_lshl_add_u32 v23, v23, 2, v24
  v_lshlrev_b32 v23, 1, v23
  v_xor_b32 v21, v21, v23
  v_cmp_gt_u32 vcc, 32, v22
  v_bfe_u32 v26, v22, 3, 2
  v_lshl_add_u32 v25, v26, 2, v24
  v_bfe_u32 v26, v22, 2, 1
  v_lshl_add_u32 v25, v26, 4, v25
  v_cndmask_b32 v25, v22, v25, vcc
  v_mul_u32_u24 v25, 1280, v25
  v_lshl_add_u32 v66, v21, 4, v25
  s_mul_i32 s21, s20, 960
  s_add_u32 s21, s21, 192
  v_add_u32 v21, s21, v1
  v_mul_u32_u24 v22, v21, v29
  v_lshrrev_b32 v22, 22, v22
  v_mul_u32_u24 v23, 80, v22
  v_sub_u32 v21, v21, v23
  v_bfe_u32 v23, v22, 3, 1
  v_and_b32 v24, 3, v22
  v_lshl_add_u32 v23, v23, 2, v24
  v_lshlrev_b32 v23, 1, v23
  v_xor_b32 v21, v21, v23
  v_cmp_gt_u32 vcc, 32, v22
  v_bfe_u32 v26, v22, 3, 2
  v_lshl_add_u32 v25, v26, 2, v24
  v_bfe_u32 v26, v22, 2, 1
  v_lshl_add_u32 v25, v26, 4, v25
  v_cndmask_b32 v25, v22, v25, vcc
  v_mul_u32_u24 v25, 1280, v25
  v_lshl_add_u32 v67, v21, 4, v25
  s_mul_i32 s21, s20, 960
  s_add_u32 s21, s21, 256
  v_add_u32 v21, s21, v1
  v_mul_u32_u24 v22, v21, v29
  v_lshrrev_b32 v22, 22, v22
  v_mul_u32_u24 v23, 80, v22
  v_sub_u32 v21, v21, v23
  v_bfe_u32 v23, v22, 3, 1
  v_and_b32 v24, 3, v22
  v_lshl_add_u32 v23, v23, 2, v24
  v_lshlrev_b32 v23, 1, v23
  v_xor_b32 v21, v21, v23
  v_cmp_gt_u32 vcc, 32, v22
  v_bfe_u32 v26, v22, 3, 2
  v_lshl_add_u32 v25, v26, 2, v24
  v_bfe_u32 v26, v22, 2, 1
  v_lshl_add_u32 v25, v26, 4, v25
  v_cndmask_b32 v25, v22, v25, vcc
  v_mul_u32_u24 v25, 1280, v25
  v_lshl_add_u32 v68, v21, 4, v25
  s_mul_i32 s21, s20, 960
  s_add_u32 s21, s21, 320
  v_add_u32 v21, s21, v1
  v_mul_u32_u24 v22, v21, v29
  v_lshrrev_b32 v22, 22, v22
  v_mul_u32_u24 v23, 80, v22
  v_sub_u32 v21, v21, v23
  v_bfe_u32 v23, v22, 3, 1
  v_and_b32 v24, 3, v22
  v_lshl_add_u32 v23, v23, 2, v24
  v_lshlrev_b32 v23, 1, v23
  v_xor_b32 v21, v21, v23
  v_cmp_gt_u32 vcc, 32, v22
  v_bfe_u32 v26, v22, 3, 2
  v_lshl_add_u32 v25, v26, 2, v24
  v_bfe_u32 v26, v22, 2, 1
  v_lshl_add_u32 v25, v26, 4, v25
  v_cndmask_b32 v25, v22, v25, vcc
  v_mul_u32_u24 v25, 1280, v25
  v_lshl_add_u32 v69, v21, 4, v25
  s_mul_i32 s21, s20, 960
  s_add_u32 s21, s21, 384
  v_add_u32 v21, s21, v1
  v_mul_u32_u24 v22, v21, v29
  v_lshrrev_b32 v22, 22, v22
  v_mul_u32_u24 v23, 80, v22
  v_sub_u32 v21, v21, v23
  v_bfe_u32 v23, v22, 3, 1
  v_and_b32 v24, 3, v22
  v_lshl_add_u32 v23, v23, 2, v24
  v_lshlrev_b32 v23, 1, v23
  v_xor_b32 v21, v21, v23
  v_cmp_gt_u32 vcc, 32, v22
  v_bfe_u32 v26, v22, 3, 2
  v_lshl_add_u32 v25, v26, 2, v24
  v_bfe_u32 v26, v22, 2, 1
  v_lshl_add_u32 v25, v26, 4, v25
  v_cndmask_b32 v25, v22, v25, vcc
  v_mul_u32_u24 v25, 1280, v25
  v_lshl_add_u32 v70, v21, 4, v25
  s_mul_i32 s21, s20, 960
  s_add_u32 s21, s21, 448
  v_add_u32 v21, s21, v1
  v_mul_u32_u24 v22, v21, v29
  v_lshrrev_b32 v22, 22, v22
  v_mul_u32_u24 v23, 80, v22
  v_sub_u32 v21, v21, v23
  v_bfe_u32 v23, v22, 3, 1
  v_and_b32 v24, 3, v22
  v_lshl_add_u32 v23, v23, 2, v24
  v_lshlrev_b32 v23, 1, v23
  v_xor_b32 v21, v21, v23
  v_cmp_gt_u32 vcc, 32, v22
  v_bfe_u32 v26, v22, 3, 2
  v_lshl_add_u32 v25, v26, 2, v24
  v_bfe_u32 v26, v22, 2, 1
  v_lshl_add_u32 v25, v26, 4, v25
  v_cndmask_b32 v25, v22, v25, vcc
  v_mul_u32_u24 v25, 1280, v25
  v_lshl_add_u32 v71, v21, 4, v25
  s_mul_i32 s21, s20, 960
  s_add_u32 s21, s21, 512
  v_add_u32 v21, s21, v1
  v_mul_u32_u24 v22, v21, v29
  v_lshrrev_b32 v22, 22, v22
  v_mul_u32_u24 v23, 80, v22
  v_sub_u32 v21, v21, v23
  v_bfe_u32 v23, v22, 3, 1
  v_and_b32 v24, 3, v22
  v_lshl_add_u32 v23, v23, 2, v24
  v_lshlrev_b32 v23, 1, v23
  v_xor_b32 v21, v21, v23
  v_cmp_gt_u32 vcc, 32, v22
  v_bfe_u32 v26, v22, 3, 2
  v_lshl_add_u32 v25, v26, 2, v24
  v_bfe_u32 v26, v22, 2, 1
  v_lshl_add_u32 v25, v26, 4, v25
  v_cndmask_b32 v25, v22, v25, vcc
  v_mul_u32_u24 v25, 1280, v25
  v_lshl_add_u32 v72, v21, 4, v25
  s_mul_i32 s21, s20, 960
  s_add_u32 s21, s21, 576
  v_add_u32 v21, s21, v1
  v_mul_u32_u24 v22, v21, v29
  v_lshrrev_b32 v22, 22, v22
  v_mul_u32_u24 v23, 80, v22
  v_sub_u32 v21, v21, v23
  v_bfe_u32 v23, v22, 3, 1
  v_and_b32 v24, 3, v22
  v_lshl_add_u32 v23, v23, 2, v24
  v_lshlrev_b32 v23, 1, v23
  v_xor_b32 v21, v21, v23
  v_cmp_gt_u32 vcc, 32, v22
  v_bfe_u32 v26, v22, 3, 2
  v_lshl_add_u32 v25, v26, 2, v24
  v_bfe_u32 v26, v22, 2, 1
  v_lshl_add_u32 v25, v26, 4, v25
  v_cndmask_b32 v25, v22, v25, vcc
  v_mul_u32_u24 v25, 1280, v25
  v_lshl_add_u32 v73, v21, 4, v25
  s_mul_i32 s21, s20, 960
  s_add_u32 s21, s21, 640
  v_add_u32 v21, s21, v1
  v_mul_u32_u24 v22, v21, v29
  v_lshrrev_b32 v22, 22, v22
  v_mul_u32_u24 v23, 80, v22
  v_sub_u32 v21, v21, v23
  v_bfe_u32 v23, v22, 3, 1
  v_and_b32 v24, 3, v22
  v_lshl_add_u32 v23, v23, 2, v24
  v_lshlrev_b32 v23, 1, v23
  v_xor_b32 v21, v21, v23
  v_cmp_gt_u32 vcc, 32, v22
  v_bfe_u32 v26, v22, 3, 2
  v_lshl_add_u32 v25, v26, 2, v24
  v_bfe_u32 v26, v22, 2, 1
  v_lshl_add_u32 v25, v26, 4, v25
  v_cndmask_b32 v25, v22, v25, vcc
  v_mul_u32_u24 v25, 1280, v25
  v_lshl_add_u32 v74, v21, 4, v25
  s_mul_i32 s21, s20, 960
  s_add_u32 s21, s21, 704
  v_add_u32 v21, s21, v1
  v_mul_u32_u24 v22, v21, v29
  v_lshrrev_b32 v22, 22, v22
  v_mul_u32_u24 v23, 80, v22
  v_sub_u32 v21, v21, v23
  v_bfe_u32 v23, v22, 3, 1
  v_and_b32 v24, 3, v22
  v_lshl_add_u32 v23, v23, 2, v24
  v_lshlrev_b32 v23, 1, v23
  v_xor_b32 v21, v21, v23
  v_cmp_gt_u32 vcc, 32, v22
  v_bfe_u32 v26, v22, 3, 2
  v_lshl_add_u32 v25, v26, 2, v24
  v_bfe_u32 v26, v22, 2, 1
  v_lshl_add_u32 v25, v26, 4, v25
  v_cndmask_b32 v25, v22, v25, vcc
  v_mul_u32_u24 v25, 1280, v25
  v_lshl_add_u32 v75, v21, 4, v25
  s_mul_i32 s21, s20, 960
  s_add_u32 s21, s21, 768
  v_add_u32 v21, s21, v1
  v_mul_u32_u24 v22, v21, v29
  v_lshrrev_b32 v22, 22, v22
  v_mul_u32_u24 v23, 80, v22
  v_sub_u32 v21, v21, v23
  v_bfe_u32 v23, v22, 3, 1
  v_and_b32 v24, 3, v22
  v_lshl_add_u32 v23, v23, 2, v24
  v_lshlrev_b32 v23, 1, v23
  v_xor_b32 v21, v21, v23
  v_cmp_gt_u32 vcc, 32, v22
  v_bfe_u32 v26, v22, 3, 2
  v_lshl_add_u32 v25, v26, 2, v24
  v_bfe_u32 v26, v22, 2, 1
  v_lshl_add_u32 v25, v26, 4, v25
  v_cndmask_b32 v25, v22, v25, vcc
  v_mul_u32_u24 v25, 1280, v25
  v_lshl_add_u32 v76, v21, 4, v25
  s_mul_i32 s21, s20, 960
  s_add_u32 s21, s21, 832
  v_add_u32 v21, s21, v1
  v_mul_u32_u24 v22, v21, v29
  v_lshrrev_b32 v22, 22, v22
  v_mul_u32_u24 v23, 80, v22
  v_sub_u32 v21, v21, v23
  v_bfe_u32 v23, v22, 3, 1
  v_and_b32 v24, 3, v22
  v_lshl_add_u32 v23, v23, 2, v24
  v_lshlrev_b32 v23, 1, v23
  v_xor_b32 v21, v21, v23
  v_cmp_gt_u32 vcc, 32, v22
  v_bfe_u32 v26, v22, 3, 2
  v_lshl_add_u32 v25, v26, 2, v24
  v_bfe_u32 v26, v22, 2, 1
  v_lshl_add_u32 v25, v26, 4, v25
  v_cndmask_b32 v25, v22, v25, vcc
  v_mul_u32_u24 v25, 1280, v25
  v_lshl_add_u32 v77, v21, 4, v25
  s_mul_i32 s21, s20, 960
  s_add_u32 s21, s21, 896
  v_add_u32 v21, s21, v1
  v_mul_u32_u24 v22, v21, v29
  v_lshrrev_b32 v22, 22, v22
  v_mul_u32_u24 v23, 80, v22
  v_sub_u32 v21, v21, v23
  v_bfe_u32 v23, v22, 3, 1
  v_and_b32 v24, 3, v22
  v_lshl_add_u32 v23, v23, 2, v24
  v_lshlrev_b32 v23, 1, v23
  v_xor_b32 v21, v21, v23
  v_cmp_gt_u32 vcc, 32, v22
  v_bfe_u32 v26, v22, 3, 2
  v_lshl_add_u32 v25, v26, 2, v24
  v_bfe_u32 v26, v22, 2, 1
  v_lshl_add_u32 v25, v26, 4, v25
  v_cndmask_b32 v25, v22, v25, vcc
  v_mul_u32_u24 v25, 1280, v25
  v_lshl_add_u32 v78, v21, 4, v25
  s_mul_i32 s40, s2, 245760
  s_sleep 32
  s_add_u32 s21, s40, 0
  s_mul_i32 s22, s20, 15360
  s_add_u32 s22, s22, 0
  s_add_u32 m0, s22, 0
  s_nop 0
  buffer_load_dwordx4 v64, s[12:15], s21 offen lds
  s_add_u32 m0, s22, 1024
  s_nop 0
  buffer_load_dwordx4 v65, s[12:15], s21 offen lds
  s_add_u32 m0, s22, 2048
  s_nop 0
  buffer_load_dwordx4 v66, s[12:15], s21 offen lds
  s_add_u32 m0, s22, 3072
  s_nop 0
  buffer_load_dwordx4 v67, s[12:15], s21 offen lds
  s_add_u32 m0, s22, 4096
  s_nop 0
  buffer_load_dwordx4 v68, s[12:15], s21 offen lds
  s_add_u32 m0, s22, 5120
  s_nop 0
  buffer_load_dwordx4 v69, s[12:15], s21 offen lds
  s_add_u32 m0, s22, 6144
  s_nop 0
  buffer_load_dwordx4 v70, s[12:15], s21 offen lds
  s_add_u32 m0, s22, 7168
  s_nop 0
  buffer_load_dwordx4 v71, s[12:15], s21 offen lds
  s_add_u32 m0, s22, 8192
  s_nop 0
  buffer_load_dwordx4 v72, s[12:15], s21 offen lds
  s_add_u32 m0, s22, 9216
  s_nop 0
  buffer_load_dwordx4 v73, s[12:15], s21 offen lds
  s_add_u32 m0, s22, 10240
  s_nop 0
  buffer_load_dwordx4 v74, s[12:15], s21 offen lds
  s_add_u32 m0, s22, 11264
  s_nop 0
  buffer_load_dwordx4 v75, s[12:15], s21 offen lds
  s_add_u32 m0, s22, 12288
  s_nop 0
  buffer_load_dwordx4 v76, s[12:15], s21 offen lds
  s_add_u32 m0, s22, 13312
  s_nop 0
  buffer_load_dwordx4 v77, s[12:15], s21 offen lds
  s_add_u32 m0, s22, 14336
  s_nop 0
  buffer_load_dwordx4 v78, s[12:15], s21 offen lds
  s_add_u32 s21, s40, 61440
  s_mul_i32 s22, s20, 15360
  s_add_u32 s22, s22, 61440
  s_add_u32 m0, s22, 0
  s_nop 0
  buffer_load_dwordx4 v64, s[12:15], s21 offen lds
  s_add_u32 m0, s22, 1024
  s_nop 0
  buffer_load_dwordx4 v65, s[12:15], s21 offen lds
  s_add_u32 m0, s22, 2048
  s_nop 0
  buffer_load_dwordx4 v66, s[12:15], s21 offen lds
  s_add_u32 m0, s22, 3072
  s_nop 0
  buffer_load_dwordx4 v67, s[12:15], s21 offen lds
  s_add_u32 m0, s22, 4096
  s_nop 0
  buffer_load_dwordx4 v68, s[12:15], s21 offen lds
  s_add_u32 m0, s22, 5120
  s_nop 0
  buffer_load_dwordx4 v69, s[12:15], s21 offen lds
  s_add_u32 m0, s22, 6144
  s_nop 0
  buffer_load_dwordx4 v70, s[12:15], s21 offen lds
  s_add_u32 m0, s22, 7168
  s_nop 0
  buffer_load_dwordx4 v71, s[12:15], s21 offen lds
  s_add_u32 m0, s22, 8192
  s_nop 0
  buffer_load_dwordx4 v72, s[12:15], s21 offen lds
  s_add_u32 m0, s22, 9216
  s_nop 0
  buffer_load_dwordx4 v73, s[12:15], s21 offen lds
  s_add_u32 m0, s22, 10240
  s_nop 0
  buffer_load_dwordx4 v74, s[12:15], s21 offen lds
  s_add_u32 m0, s22, 11264
  s_nop 0
  buffer_load_dwordx4 v75, s[12:15], s21 offen lds
  s_add_u32 m0, s22, 12288
  s_nop 0
  buffer_load_dwordx4 v76, s[12:15], s21 offen lds
  s_add_u32 m0, s22, 13312
  s_nop 0
  buffer_load_dwordx4 v77, s[12:15], s21 offen lds
  s_add_u32 m0, s22, 14336
  s_nop 0
  buffer_load_dwordx4 v78, s[12:15], s21 offen lds
  s_add_u32 s21, s40, 122880
  s_mul_i32 s22, s20, 15360
  s_add_u32 s22, s22, 0
  buffer_load_dwordx4 v[80:83], v64, s[12:15], s21 offen
  buffer_load_dwordx4 v[84:87], v65, s[12:15], s21 offen
  buffer_load_dwordx4 v[88:91], v66, s[12:15], s21 offen
  buffer_load_dwordx4 v[92:95], v67, s[12:15], s21 offen
  buffer_load_dwordx4 v[96:99], v68, s[12:15], s21 offen
  buffer_load_dwordx4 v[100:103], v69, s[12:15], s21 offen
  buffer_load_dwordx4 v[104:107], v70, s[12:15], s21 offen
  buffer_load_dwordx4 v[108:111], v71, s[12:15], s21 offen
  buffer_load_dwordx4 v[112:115], v72, s[12:15], s21 offen
  buffer_load_dwordx4 v[116:119], v73, s[12:15], s21 offen
  buffer_load_dwordx4 v[120:123], v74, s[12:15], s21 offen
  buffer_load_dwordx4 v[124:127], v75, s[12:15], s21 offen
  buffer_load_dwordx4 v[128:131], v76, s[12:15], s21 offen
  buffer_load_dwordx4 v[132:135], v77, s[12:15], s21 offen
  buffer_load_dwordx4 v[136:139], v78, s[12:15], s21 offen
  s_add_u32 s21, s40, 184320
  s_mul_i32 s22, s20, 15360
  s_add_u32 s22, s22, 61440
  buffer_load_dwordx4 v[140:143], v64, s[12:15], s21 offen
  buffer_load_dwordx4 v[144:147], v65, s[12:15], s21 offen
  buffer_load_dwordx4 v[148:151], v66, s[12:15], s21 offen
  buffer_load_dwordx4 v[152:155], v67, s[12:15], s21 offen
  buffer_load_dwordx4 v[156:159], v68, s[12:15], s21 offen
  buffer_load_dwordx4 v[160:163], v69, s[12:15], s21 offen
  buffer_load_dwordx4 v[164:167], v70, s[12:15], s21 offen
  buffer_load_dwordx4 v[168:171], v71, s[12:15], s21 offen
  buffer_load_dwordx4 v[172:175], v72, s[12:15], s21 offen
  buffer_load_dwordx4 v[176:179], v73, s[12:15], s21 offen
  buffer_load_dwordx4 v[180:183], v74, s[12:15], s21 offen
  buffer_load_dwordx4 v[184:187], v75, s[12:15], s21 offen
  buffer_load_dwordx4 v[188:191], v76, s[12:15], s21 offen
  buffer_load_dwordx4 v[192:195], v77, s[12:15], s21 offen
  buffer_load_dwordx4 v[196:199], v78, s[12:15], s21 offen
  v_lshrrev_b32 v6, 2, v2
  v_lshl_add_u32 v7, v3, 3, v6
  v_mul_u32_u24 v7, 1280, v7
  v_and_b32 v8, 1, v2
  v_lshl_add_u32 v7, v8, 3, v7
  v_and_b32 v8, 1, v3
  v_lshl_add_u32 v6, v8, 2, v6
  v_lshlrev_b32 v6, 1, v6
  v_bfe_u32 v8, v2, 1, 1
  s_mul_i32 s21, s20, 20
  v_add_u32 v8, s21, v8
  v_add_u32 v5, 0, v8
  v_xor_b32 v5, v5, v6
  v_lshl_add_u32 v200, v5, 4, v7
  v_add_u32 v210, 81920, v200
  v_add_u32 v5, 2, v8
  v_xor_b32 v5, v5, v6
  v_lshl_add_u32 v201, v5, 4, v7
  v_add_u32 v211, 81920, v201
  v_add_u32 v5, 4, v8
  v_xor_b32 v5, v5, v6
  v_lshl_add_u32 v202, v5, 4, v7
  v_add_u32 v212, 81920, v202
  v_add_u32 v5, 6, v8
  v_xor_b32 v5, v5, v6
  v_lshl_add_u32 v203, v5, 4, v7
  v_add_u32 v213, 81920, v203
  v_add_u32 v5, 8, v8
  v_xor_b32 v5, v5, v6
  v_lshl_add_u32 v204, v5, 4, v7
  v_add_u32 v214, 81920, v204
  v_add_u32 v5, 10, v8
  v_xor_b32 v5, v5, v6
  v_lshl_add_u32 v205, v5, 4, v7
  v_add_u32 v215, 81920, v205
  v_add_u32 v5, 12, v8
  v_xor_b32 v5, v5, v6
  v_lshl_add_u32 v206, v5, 4, v7
  v_add_u32 v216, 81920, v206
  v_add_u32 v5, 14, v8
  v_xor_b32 v5, v5, v6
  v_lshl_add_u32 v207, v5, 4, v7
  v_add_u32 v217, 81920, v207
  v_add_u32 v5, 16, v8
  v_xor_b32 v5, v5, v6
  v_lshl_add_u32 v208, v5, 4, v7
  v_add_u32 v218, 81920, v208
  v_add_u32 v5, 18, v8
  v_xor_b32 v5, v5, v6
  v_lshl_add_u32 v209, v5, 4, v7
  v_add_u32 v219, 81920, v209
  s_mul_i32 s22, s20, 15360
  v_lshl_add_u32 v30, v1, 4, s22
  v_add_u32 v31, 61440, v30
  s_waitcnt vmcnt(30)
  s_barrier
  ds_read_b64_tr_b16 a[0:1], v200 offset:0
  ds_read_b64_tr_b16 a[2:3], v200 offset:5120
  ds_read_b64_tr_b16 a[24:25], v201 offset:0
  ds_read_b64_tr_b16 a[26:27], v201 offset:5120
  ds_read_b64_tr_b16 a[48:49], v202 offset:0
  ds_read_b64_tr_b16 a[50:51], v202 offset:5120
  ds_read_b64_tr_b16 a[72:73], v203 offset:0
  ds_read_b64_tr_b16 a[74:75], v203 offset:5120
  ds_read_b64_tr_b16 a[96:97], v204 offset:0
  ds_read_b64_tr_b16 a[98:99], v204 offset:5120
  ds_read_b64_tr_b16 a[120:121], v205 offset:0
  ds_read_b64_tr_b16 a[122:123], v205 offset:5120
  ds_read_b64_tr_b16 a[144:145], v206 offset:0
  ds_read_b64_tr_b16 a[146:147], v206 offset:5120
  ds_read_b64_tr_b16 a[168:169], v207 offset:0
  ds_read_b64_tr_b16 a[170:171], v207 offset:5120
  ds_read_b64_tr_b16 a[192:193], v208 offset:0
  ds_read_b64_tr_b16 a[194:195], v208 offset:5120
  ds_read_b64_tr_b16 a[216:217], v209 offset:0
  ds_read_b64_tr_b16 a[218:219], v209 offset:5120
  ds_read_b64_tr_b16 a[4:5], v200 offset:40960
  ds_read_b64_tr_b16 a[6:7], v200 offset:46080
  ds_read_b64_tr_b16 a[28:29], v201 offset:40960
  ds_read_b64_tr_b16 a[30:31], v201 offset:46080
  ds_read_b64_tr_b16 a[52:53], v202 offset:40960
  ds_read_b64_tr_b16 a[54:55], v202 offset:46080
  ds_read_b64_tr_b16 a[76:77], v203 offset:40960
  ds_read_b64_tr_b16 a[78:79], v203 offset:46080
  ds_read_b64_tr_b16 a[100:101], v204 offset:40960
  ds_read_b64_tr_b16 a[102:103], v204 offset:46080
  ds_read_b64_tr_b16 a[124:125], v205 offset:40960
  ds_read_b64_tr_b16 a[126:127], v205 offset:46080
  ds_read_b64_tr_b16 a[148:149], v206 offset:40960
  ds_read_b64_tr_b16 a[150:151], v206 offset:46080
  ds_read_b64_tr_b16 a[172:173], v207 offset:40960
  ds_read_b64_tr_b16 a[174:175], v207 offset:46080
  ds_read_b64_tr_b16 a[196:197], v208 offset:40960
  ds_read_b64_tr_b16 a[198:199], v208 offset:46080
  ds_read_b64_tr_b16 a[220:221], v209 offset:40960
  ds_read_b64_tr_b16 a[222:223], v209 offset:46080
  ds_read_b64_tr_b16 a[8:9], v210 offset:0
  ds_read_b64_tr_b16 a[10:11], v210 offset:5120
  ds_read_b64_tr_b16 a[32:33], v211 offset:0
  ds_read_b64_tr_b16 a[34:35], v211 offset:5120
  ds_read_b64_tr_b16 a[56:57], v212 offset:0
  ds_read_b64_tr_b16 a[58:59], v212 offset:5120
  ds_read_b64_tr_b16 a[80:81], v213 offset:0
  ds_read_b64_tr_b16 a[82:83], v213 offset:5120
  ds_read_b64_tr_b16 a[104:105], v214 offset:0
  ds_read_b64_tr_b16 a[106:107], v214 offset:5120
  ds_read_b64_tr_b16 a[128:129], v215 offset:0
  ds_read_b64_tr_b16 a[130:131], v215 offset:5120
  ds_read_b64_tr_b16 a[152:153], v216 offset:0
  ds_read_b64_tr_b16 a[154:155], v216 offset:5120
  ds_read_b64_tr_b16 a[176:177], v217 offset:0
  ds_read_b64_tr_b16 a[178:179], v217 offset:5120
  ds_read_b64_tr_b16 a[200:201], v218 offset:0
  ds_read_b64_tr_b16 a[202:203], v218 offset:5120
  ds_read_b64_tr_b16 a[224:225], v219 offset:0
  ds_read_b64_tr_b16 a[226:227], v219 offset:5120
  s_waitcnt lgkmcnt(0)
  s_barrier
  s_waitcnt vmcnt(15)
  ds_write_b128 v30, v[80:83] offset:0
  ds_write_b128 v30, v[84:87] offset:1024
  ds_write_b128 v30, v[88:91] offset:2048
  ds_write_b128 v30, v[92:95] offset:3072
  ds_write_b128 v30, v[96:99] offset:4096
  ds_write_b128 v30, v[100:103] offset:5120
  ds_write_b128 v30, v[104:107] offset:6144
  ds_write_b128 v30, v[108:111] offset:7168
  ds_write_b128 v30, v[112:115] offset:8192
  ds_write_b128 v30, v[116:119] offset:9216
  ds_write_b128 v30, v[120:123] offset:10240
  ds_write_b128 v30, v[124:127] offset:11264
  ds_write_b128 v30, v[128:131] offset:12288
  ds_write_b128 v30, v[132:135] offset:13312
  ds_write_b128 v30, v[136:139] offset:14336
  s_waitcnt vmcnt(0)
  ds_write_b128 v31, v[140:143] offset:0
  ds_write_b128 v31, v[144:147] offset:1024
  ds_write_b128 v31, v[148:151] offset:2048
  ds_write_b128 v31, v[152:155] offset:3072
  ds_write_b128 v31, v[156:159] offset:4096
  ds_write_b128 v31, v[160:163] offset:5120
  ds_write_b128 v31, v[164:167] offset:6144
  ds_write_b128 v31, v[168:171] offset:7168
  ds_write_b128 v31, v[172:175] offset:8192
  ds_write_b128 v31, v[176:179] offset:9216
  ds_write_b128 v31, v[180:183] offset:10240
  ds_write_b128 v31, v[184:187] offset:11264
  ds_write_b128 v31, v[188:191] offset:12288
  ds_write_b128 v31, v[192:195] offset:13312
  ds_write_b128 v31, v[196:199] offset:14336
  s_waitcnt lgkmcnt(0)
  s_barrier
  ds_read_b64_tr_b16 a[12:13], v200 offset:0
  ds_read_b64_tr_b16 a[14:15], v200 offset:5120
  ds_read_b64_tr_b16 a[36:37], v201 offset:0
  ds_read_b64_tr_b16 a[38:39], v201 offset:5120
  ds_read_b64_tr_b16 a[60:61], v202 offset:0
  ds_read_b64_tr_b16 a[62:63], v202 offset:5120
  ds_read_b64_tr_b16 a[84:85], v203 offset:0
  ds_read_b64_tr_b16 a[86:87], v203 offset:5120
  ds_read_b64_tr_b16 a[108:109], v204 offset:0
  ds_read_b64_tr_b16 a[110:111], v204 offset:5120
  ds_read_b64_tr_b16 a[132:133], v205 offset:0
  ds_read_b64_tr_b16 a[134:135], v205 offset:5120
  ds_read_b64_tr_b16 a[156:157], v206 offset:0
  ds_read_b64_tr_b16 a[158:159], v206 offset:5120
  ds_read_b64_tr_b16 a[180:181], v207 offset:0
  ds_read_b64_tr_b16 a[182:183], v207 offset:5120
  ds_read_b64_tr_b16 a[204:205], v208 offset:0
  ds_read_b64_tr_b16 a[206:207], v208 offset:5120
  ds_read_b64_tr_b16 a[228:229], v209 offset:0
  ds_read_b64_tr_b16 a[230:231], v209 offset:5120
  ds_read_b64_tr_b16 a[16:17], v200 offset:40960
  ds_read_b64_tr_b16 a[18:19], v200 offset:46080
  ds_read_b64_tr_b16 a[40:41], v201 offset:40960
  ds_read_b64_tr_b16 a[42:43], v201 offset:46080
  ds_read_b64_tr_b16 a[64:65], v202 offset:40960
  ds_read_b64_tr_b16 a[66:67], v202 offset:46080
  ds_read_b64_tr_b16 a[88:89], v203 offset:40960
  ds_read_b64_tr_b16 a[90:91], v203 offset:46080
  ds_read_b64_tr_b16 a[112:113], v204 offset:40960
  ds_read_b64_tr_b16 a[114:115], v204 offset:46080
  ds_read_b64_tr_b16 a[136:137], v205 offset:40960
  ds_read_b64_tr_b16 a[138:139], v205 offset:46080
  ds_read_b64_tr_b16 a[160:161], v206 offset:40960
  ds_read_b64_tr_b16 a[162:163], v206 offset:46080
  ds_read_b64_tr_b16 a[184:185], v207 offset:40960
  ds_read_b64_tr_b16 a[186:187], v207 offset:46080
  ds_read_b64_tr_b16 a[208:209], v208 offset:40960
  ds_read_b64_tr_b16 a[210:211], v208 offset:46080
  ds_read_b64_tr_b16 a[232:233], v209 offset:40960
  ds_read_b64_tr_b16 a[234:235], v209 offset:46080
  ds_read_b64_tr_b16 a[20:21], v210 offset:0
  ds_read_b64_tr_b16 a[22:23], v210 offset:5120
  ds_read_b64_tr_b16 a[44:45], v211 offset:0
  ds_read_b64_tr_b16 a[46:47], v211 offset:5120
  ds_read_b64_tr_b16 a[68:69], v212 offset:0
  ds_read_b64_tr_b16 a[70:71], v212 offset:5120
  ds_read_b64_tr_b16 a[92:93], v213 offset:0
  ds_read_b64_tr_b16 a[94:95], v213 offset:5120
  ds_read_b64_tr_b16 a[116:117], v214 offset:0
  ds_read_b64_tr_b16 a[118:119], v214 offset:5120
  ds_read_b64_tr_b16 a[140:141], v215 offset:0
  ds_read_b64_tr_b16 a[142:143], v215 offset:5120
  ds_read_b64_tr_b16 a[164:165], v216 offset:0
  ds_read_b64_tr_b16 a[166:167], v216 offset:5120
  ds_read_b64_tr_b16 a[188:189], v217 offset:0
  ds_read_b64_tr_b16 a[190:191], v217 offset:5120
  ds_read_b64_tr_b16 a[212:213], v218 offset:0
  ds_read_b64_tr_b16 a[214:215], v218 offset:5120
  ds_read_b64_tr_b16 a[236:237], v219 offset:0
  ds_read_b64_tr_b16 a[238:239], v219 offset:5120
  s_waitcnt lgkmcnt(0)
  s_barrier
  s_load_dwordx2 s[32:33], s[0:1], 96
  s_waitcnt lgkmcnt(0)
  s_mov_b32 s32, s32
  s_mov_b32 s33, s33
  s_mov_b32 s34, 256
  s_mov_b32 s35, 0x00020000
  s_mov_b32 s21, 76
  s_cmp_lg_u32 s20, 0
  s_cbranch_scc1 wf_170
  v_mov_b32 v4, 0
  s_mov_b32 s101, 0
wf_169:
  buffer_load_dword v5, v4, s[32:35], s21 offen sc1
  s_add_u32 s101, s101, 1
  s_cmp_gt_u32 s101, 131072
  s_cbranch_scc1 main_end
  s_waitcnt vmcnt(0)
  v_readfirstlane_b32 s100, v5
  s_cmp_ge_u32 s100, 32
  s_cbranch_scc1 wf_170
  s_sleep 8
  s_branch wf_169
wf_170:
  s_barrier
  s_mul_i32 s41, s2, 12288
  s_add_u32 s47, s41, 25165824
  s_mov_b32 s41, s47
  s_mul_i32 s21, s20, 10
  s_mul_i32 s47, s2, 5
  s_lshr_b32 s22, s21, 3
  s_add_u32 s47, s47, s22
  s_and_b32 s48, s21, 7
  s_mov_b32 s66, 0
  s_mov_b32 s67, 0
  s_lshr_b32 s43, s2, 2
  s_lshl_b32 s43, s43, 7
  s_add_u32 s43, s43, 0
  s_lshl_b32 s44, s2, 7
  s_lshl_b32 s21, s20, 2
  s_add_u32 s44, s44, s21
  s_add_u32 s44, s44, 95232
  s_mov_b32 s45, 0
  s_mov_b32 s49, 1
  s_mov_b32 s50, 0
  v_mov_b32 v10, 0
  v_mov_b32 v11, 1
  v_lshlrev_b32 v4, 4, v1
  s_add_u32 s76, s38, 56623104
  s_addc_u32 s77, s39, 0
  s_mov_b32 s78, 6291456
  s_mov_b32 s79, 0x00020000
  s_add_u32 s80, s38, 93323264
  s_addc_u32 s81, s39, 0
  s_mov_b32 s82, 20971520
  s_mov_b32 s83, 0x00020000
  v_and_b32 v12, 3, v1
  v_lshlrev_b32 v12, 3, v12
  v_add_u32 v12, 4, v12
  v_and_b32 v13, 7, v2
  v_lshlrev_b32 v13, 4, v13
  v_lshl_add_u32 v13, v3, 7, v13
  v_lshrrev_b32 v14, 3, v2
  v_mul_u32_u24 v14, 98304, v14
  v_add_u32 v14, v14, v13
  v_and_b32 v15, 1, v3
  v_lshlrev_b32 v15, 8, v15
  v_lshl_add_u32 v15, v2, 4, v15
  v_lshrrev_b32 v16, 1, v3
  v_mul_u32_u24 v16, 327680, v16
  v_add_u32 v15, v15, v16
  v_lshlrev_b32 v17, 10, v1
  v_mov_b32 v19, 0
  s_lshl_b32 s53, s2, 7
  s_add_u32 s53, s53, 19456
  s_mov_b32 s55, 0
  s_mov_b32 s56, 0
  s_mov_b32 s58, 0
  s_mov_b32 s59, 0
  s_add_u32 s84, s38, 50331648
  s_addc_u32 s85, s39, 0
  s_mov_b32 s86, 12582912
  s_mov_b32 s87, 0x00020000
  s_and_b32 s21, s2, 3
  s_mul_i32 s51, s2, 3072
  s_cmp_eq_u32 s21, s20
  s_cselect_b32 s51, s51, 6291456
  v_mov_b32 v244, -1
  v_mov_b32 v245, -1
  v_mov_b32 v246, -1
  v_mov_b32 v247, -1
  s_add_u32 s88, s38, 85983232
  s_addc_u32 s89, s39, 0
  s_mov_b32 s90, 5242880
  s_mov_b32 s91, 0x00020000
  s_mul_i32 s21, s20, 3072
  s_add_u32 s41, s41, s21
  s_mov_b32 s64, s21
  s_add_u32 s67, s21, 98304
  s_mov_b32 s71, s21
  s_mov_b32 s46, 0
  s_mov_b32 s47, 0
  s_mov_b32 s65, 0
  s_mul_i32 s42, s2, 40960
  s_mul_i32 s21, s20, 10240
  s_add_u32 s42, s42, s21
  s_mov_b32 s68, 0x80000000
  s_mov_b32 s70, 0
  s_mov_b32 s40, 0
  s_mov_b32 s31, 0
  s_mov_b32 s56, s68
  s_mov_b32 s57, s68
  s_lshl_b32 s59, s20, 1
  s_sub_u32 s59, 8, s59
  s_add_u32 s61, s28, 9216
  v_min_u32 v5, 18, v1
  v_lshlrev_b32 v5, 10, v5
  v_mov_b32 v9, 0
  s_lshl_b32 s21, s20, 2
  s_add_u32 s21, s21, 110592
  v_mov_b32 v6, s21
  v_mov_b32 v7, 110592
  s_mul_i32 s51, s2, 3072
  s_lshl_b32 s21, s20, 10
  s_add_u32 s51, s51, s21
  s_cmp_lt_u32 s20, 3
  s_cselect_b32 s51, s51, 6291456
  s_add_u32 s51, s51, 5701632
  s_cmp_lg_u32 s20, 0
  s_cbranch_scc1 wf_172
  v_mov_b32 v20, 0
  s_mov_b32 s101, 0
wf_171:
  buffer_load_dword v21, v20, s[72:75], s43 offen sc1
  s_add_u32 s101, s101, 1
  s_cmp_gt_u32 s101, 131072
  s_cbranch_scc1 main_end
  s_waitcnt vmcnt(0)
  v_readfirstlane_b32 s100, v21
  s_cmp_ge_u32 s100, 8
  s_cbranch_scc1 wf_172
  s_sleep 4
  s_branch wf_171
wf_172:
  s_barrier
  v_writelane_b32 v9, 8, 0
  v_cmp_gt_u32 vcc, 8, v9
  s_nop 0
  s_bitset1_b64 vcc, 19
  s_ff1_i32_b64 s21, vcc
  s_lshl_b32 s22, s21, 1
  s_lshl_b32 s21, s21, 2
  s_sub_i32 s21, s21, 12
  s_max_i32 s47, s21, s22
  s_cmp_gt_u32 s47, s45
  s_cbranch_scc1 va_173
  s_mov_b32 s101, 0
  s_branch va_176
va_174:
  s_sleep 8
va_176:
  buffer_load_dword v9, v5, s[72:75], s43 offen sc1
  s_add_u32 s101, s101, 1
  s_cmp_gt_u32 s101, 131072
  s_cbranch_scc1 main_end
  s_waitcnt vmcnt(0)
  v_cmp_gt_u32 vcc, 8, v9
  s_nop 0
  s_bitset1_b64 vcc, 19
  s_ff1_i32_b64 s21, vcc
  s_lshl_b32 s22, s21, 1
  s_lshl_b32 s21, s21, 2
  s_sub_i32 s21, s21, 12
  s_max_i32 s47, s21, s22
  s_cmp_gt_u32 s47, s45
  s_cbranch_scc0 va_174
va_173:
  s_add_u32 s22, s45, 6
  s_min_u32 s22, s22, s47
va_175:
  s_cmp_ge_u32 s46, s22
  s_cbranch_scc1 va_177
  s_mov_b32 m0, s64
  s_mov_b32 s66, s41
  buffer_load_dwordx4 v4, s[16:19], s66 offen offset:0 sc1 lds
  buffer_load_dwordx4 v4, s[16:19], s66 offen offset:1024 sc1 lds
  buffer_load_dwordx4 v4, s[16:19], s66 offen offset:2048 sc1 lds
  s_add_u32 s46, s46, 1
  s_add_u32 s41, s41, 393216
  s_add_u32 s64, s64, 12288
  s_cmp_lt_u32 s64, s67
  s_cselect_b32 s64, s64, s71
  s_branch va_175
va_177:
  s_mov_b32 s48, s46
  s_mov_b32 s49, s46
  s_mov_b32 s50, s46
  s_waitcnt vmcnt(0)
  s_barrier
  v_mov_b32 v8, v4
  s_add_u32 s65, s65, 12288
  s_cmp_lt_u32 s65, 98304
  s_cselect_b32 s65, s65, 0
  ds_read_b128 v[144:147], v8 offset:0
  ds_read_b128 v[148:151], v8 offset:1024
  ds_read_b128 v[152:155], v8 offset:2048
  ds_read_b128 v[156:159], v8 offset:3072
  ds_read_b128 v[160:163], v8 offset:4096
  ds_read_b128 v[164:167], v8 offset:5120
  ds_read_b128 v[168:171], v8 offset:6144
  ds_read_b128 v[172:175], v8 offset:7168
  ds_read_b128 v[176:179], v8 offset:8192
  ds_read_b128 v[180:183], v8 offset:9216
  ds_read_b128 v[184:187], v8 offset:10240
  ds_read_b128 v[188:191], v8 offset:11264
vwl_178:
  s_waitcnt lgkmcnt(0)
  v_mfma_f32_16x16x32_bf16 v[64:67], v[144:147], a[0:3], 0
  v_cmp_gt_u32 vcc, 8, v9
  s_nop 0
  v_mfma_f32_16x16x32_bf16 v[72:75], v[144:147], a[24:27], 0
  s_bitset1_b64 vcc, 19
  s_ff1_i32_b64 s21, vcc
  v_mfma_f32_16x16x32_bf16 v[80:83], v[144:147], a[48:51], 0
  s_lshl_b32 s22, s21, 1
  s_lshl_b32 s21, s21, 2
  v_mfma_f32_16x16x32_bf16 v[88:91], v[144:147], a[72:75], 0
  s_sub_i32 s21, s21, 12
  s_max_i32 s47, s21, s22
  v_mfma_f32_16x16x32_bf16 v[96:99], v[144:147], a[96:99], 0
  s_add_u32 s22, s45, 7
  s_min_u32 s22, s22, s47
  v_mfma_f32_16x16x32_bf16 v[68:71], v[168:171], a[0:3], 0
  s_cmp_lt_u32 s46, s22
  s_cselect_b32 s66, s41, 0x80000000
  s_cselect_b32 m0, s64, 98304
  s_cselect_b32 s22, 1, 0
  v_mfma_f32_16x16x32_bf16 v[76:79], v[168:171], a[24:27], 0
  buffer_load_dwordx4 v4, s[16:19], s66 offen offset:0 sc1 lds
  v_mfma_f32_16x16x32_bf16 v[84:87], v[168:171], a[48:51], 0
  v_add_u32 v8, s65, v4
  s_add_u32 s65, s65, 12288
  v_mfma_f32_16x16x32_bf16 v[92:95], v[168:171], a[72:75], 0
  buffer_load_dwordx4 v4, s[16:19], s66 offen offset:1024 sc1 lds
  v_mfma_f32_16x16x32_bf16 v[100:103], v[168:171], a[96:99], 0
  s_cmp_lt_u32 s65, 98304
  s_cselect_b32 s65, s65, 0
  v_mfma_f32_16x16x32_bf16 v[64:67], v[148:151], a[4:7], v[64:67]
  buffer_load_dwordx4 v4, s[16:19], s66 offen offset:2048 sc1 lds
  v_mfma_f32_16x16x32_bf16 v[72:75], v[148:151], a[28:31], v[72:75]
  s_add_u32 s46, s46, s22
  s_mul_i32 s21, s22, 393216
  v_mfma_f32_16x16x32_bf16 v[80:83], v[148:151], a[52:55], v[80:83]
  s_add_u32 s41, s41, s21
  s_mul_i32 s21, s22, 12288
  v_mfma_f32_16x16x32_bf16 v[88:91], v[148:151], a[76:79], v[88:91]
  s_add_u32 s64, s64, s21
  v_cvt_pk_bf16_f32 v44, v104, v105
  v_mfma_f32_16x16x32_bf16 v[96:99], v[148:151], a[100:103], v[96:99]
  s_cmp_lt_u32 s64, s67
  s_cselect_b32 s64, s64, s71
  v_mfma_f32_16x16x32_bf16 v[68:71], v[172:175], a[4:7], v[68:71]
  v_cvt_pk_bf16_f32 v45, v106, v107
  v_cvt_pk_bf16_f32 v46, v108, v109
  v_mfma_f32_16x16x32_bf16 v[76:79], v[172:175], a[28:31], v[76:79]
  v_cvt_pk_bf16_f32 v47, v110, v111
  v_mfma_f32_16x16x32_bf16 v[84:87], v[172:175], a[52:55], v[84:87]
  s_add_u32 s69, s68, 4096
  v_mfma_f32_16x16x32_bf16 v[92:95], v[172:175], a[76:79], v[92:95]
  v_mfma_f32_16x16x32_bf16 v[100:103], v[172:175], a[100:103], v[100:103]
  buffer_store_dwordx4 v[44:47], v4, s[24:27], s69 offen offset:1024 sc1
  v_mfma_f32_16x16x32_bf16 v[64:67], v[152:155], a[8:11], v[64:67]
  v_mfma_f32_16x16x32_bf16 v[72:75], v[152:155], a[32:35], v[72:75]
  v_cvt_pk_bf16_f32 v48, v112, v113
  v_mfma_f32_16x16x32_bf16 v[80:83], v[152:155], a[56:59], v[80:83]
  v_cvt_pk_bf16_f32 v49, v114, v115
  v_mfma_f32_16x16x32_bf16 v[88:91], v[152:155], a[80:83], v[88:91]
  v_mfma_f32_16x16x32_bf16 v[96:99], v[152:155], a[104:107], v[96:99]
  v_cvt_pk_bf16_f32 v50, v116, v117
  v_mfma_f32_16x16x32_bf16 v[68:71], v[176:179], a[8:11], v[68:71]
  v_mfma_f32_16x16x32_bf16 v[76:79], v[176:179], a[32:35], v[76:79]
  v_cvt_pk_bf16_f32 v51, v118, v119
  v_mfma_f32_16x16x32_bf16 v[84:87], v[176:179], a[56:59], v[84:87]
  buffer_store_dwordx4 v[48:51], v4, s[24:27], s69 offen offset:2048 sc1
  v_mfma_f32_16x16x32_bf16 v[92:95], v[176:179], a[80:83], v[92:95]
  v_mfma_f32_16x16x32_bf16 v[100:103], v[176:179], a[104:107], v[100:103]
  v_cvt_pk_bf16_f32 v52, v120, v121
  v_mfma_f32_16x16x32_bf16 v[64:67], v[156:159], a[12:15], v[64:67]
  v_mfma_f32_16x16x32_bf16 v[72:75], v[156:159], a[36:39], v[72:75]
  v_cvt_pk_bf16_f32 v53, v122, v123
  v_mfma_f32_16x16x32_bf16 v[80:83], v[156:159], a[60:63], v[80:83]
  v_cvt_pk_bf16_f32 v54, v124, v125
  v_mfma_f32_16x16x32_bf16 v[88:91], v[156:159], a[84:87], v[88:91]
  v_mfma_f32_16x16x32_bf16 v[96:99], v[156:159], a[108:111], v[96:99]
  v_cvt_pk_bf16_f32 v55, v126, v127
  v_mfma_f32_16x16x32_bf16 v[68:71], v[180:183], a[12:15], v[68:71]
  v_mfma_f32_16x16x32_bf16 v[76:79], v[180:183], a[36:39], v[76:79]
  buffer_store_dwordx4 v[52:55], v4, s[24:27], s69 offen offset:3072 sc1
  v_mfma_f32_16x16x32_bf16 v[84:87], v[180:183], a[60:63], v[84:87]
  v_cvt_pk_bf16_f32 v56, v128, v129
  v_mfma_f32_16x16x32_bf16 v[92:95], v[180:183], a[84:87], v[92:95]
  v_mfma_f32_16x16x32_bf16 v[100:103], v[180:183], a[108:111], v[100:103]
  v_cvt_pk_bf16_f32 v57, v130, v131
  v_mfma_f32_16x16x32_bf16 v[64:67], v[160:163], a[16:19], v[64:67]
  s_cmp_lt_u32 s51, 6291456
  s_cselect_b32 s52, s51, 0x80000000
  v_mfma_f32_16x16x32_bf16 v[72:75], v[160:163], a[40:43], v[72:75]
  buffer_store_dwordx4 v[244:247], v4, s[84:87], s52 offen sc1
  v_mfma_f32_16x16x32_bf16 v[80:83], v[160:163], a[64:67], v[80:83]
  s_add_u32 s51, s51, 98304
  v_cvt_pk_bf16_f32 v58, v132, v133
  v_mfma_f32_16x16x32_bf16 v[88:91], v[160:163], a[88:91], v[88:91]
  v_cvt_pk_bf16_f32 v59, v134, v135
  v_mfma_f32_16x16x32_bf16 v[96:99], v[160:163], a[112:115], v[96:99]
  s_add_u32 s69, s68, 8192
  v_mfma_f32_16x16x32_bf16 v[68:71], v[184:187], a[16:19], v[68:71]
  v_mfma_f32_16x16x32_bf16 v[76:79], v[184:187], a[40:43], v[76:79]
  buffer_store_dwordx4 v[56:59], v4, s[24:27], s69 offen offset:0 sc1
  v_mfma_f32_16x16x32_bf16 v[84:87], v[184:187], a[64:67], v[84:87]
  v_cvt_pk_bf16_f32 v60, v136, v137
  v_mfma_f32_16x16x32_bf16 v[92:95], v[184:187], a[88:91], v[92:95]
  v_mfma_f32_16x16x32_bf16 v[100:103], v[184:187], a[112:115], v[100:103]
  v_cvt_pk_bf16_f32 v61, v138, v139
  v_mfma_f32_16x16x32_bf16 v[64:67], v[164:167], a[20:23], v[64:67]
  v_mfma_f32_16x16x32_bf16 v[72:75], v[164:167], a[44:47], v[72:75]
  v_cvt_pk_bf16_f32 v62, v140, v141
  v_mfma_f32_16x16x32_bf16 v[80:83], v[164:167], a[68:71], v[80:83]
  v_cvt_pk_bf16_f32 v63, v142, v143
  v_mfma_f32_16x16x32_bf16 v[88:91], v[164:167], a[92:95], v[88:91]
  v_mfma_f32_16x16x32_bf16 v[96:99], v[164:167], a[116:119], v[96:99]
  buffer_store_dwordx4 v[60:63], v4, s[24:27], s69 offen offset:1024 sc1
  v_mfma_f32_16x16x32_bf16 v[68:71], v[188:191], a[20:23], v[68:71]
  v_mfma_f32_16x16x32_bf16 v[76:79], v[188:191], a[44:47], v[76:79]
  v_mfma_f32_16x16x32_bf16 v[84:87], v[188:191], a[68:71], v[84:87]
  v_mfma_f32_16x16x32_bf16 v[92:95], v[188:191], a[92:95], v[92:95]
  v_mfma_f32_16x16x32_bf16 v[100:103], v[188:191], a[116:119], v[100:103]
  v_mfma_f32_16x16x32_bf16 v[104:107], v[144:147], a[120:123], 0
  buffer_load_dword v9, v5, s[72:75], s43 offen sc1
  v_mfma_f32_16x16x32_bf16 v[112:115], v[144:147], a[144:147], 0
  v_mfma_f32_16x16x32_bf16 v[120:123], v[144:147], a[168:171], 0
  v_mfma_f32_16x16x32_bf16 v[128:131], v[144:147], a[192:195], 0
  v_cvt_pk_bf16_f32 v24, v64, v65
  v_mfma_f32_16x16x32_bf16 v[136:139], v[144:147], a[216:219], 0
  s_add_u32 s63, s45, 1
  s_min_u32 s63, s63, 63
  v_mfma_f32_16x16x32_bf16 v[108:111], v[168:171], a[120:123], 0
  s_cmp_lt_u32 s63, s46
  s_cselect_b32 s53, 1, 0
  v_mfma_f32_16x16x32_bf16 v[116:119], v[168:171], a[144:147], 0
  v_mov_b32 v21, s53
  ds_write_b32 v6, v21 offset:0
  v_mfma_f32_16x16x32_bf16 v[124:127], v[168:171], a[168:171], 0
  v_cvt_pk_bf16_f32 v25, v66, v67
  v_cvt_pk_bf16_f32 v26, v68, v69
  v_mfma_f32_16x16x32_bf16 v[132:135], v[168:171], a[192:195], 0
  v_cvt_pk_bf16_f32 v27, v70, v71
  v_mfma_f32_16x16x32_bf16 v[140:143], v[168:171], a[216:219], 0
  v_mfma_f32_16x16x32_bf16 v[104:107], v[148:151], a[124:127], v[104:107]
  buffer_store_dwordx4 v[24:27], v4, s[24:27], s42 offen offset:0 sc1
  v_mfma_f32_16x16x32_bf16 v[112:115], v[148:151], a[148:151], v[112:115]
  v_cvt_pk_bf16_f32 v28, v72, v73
  v_mfma_f32_16x16x32_bf16 v[120:123], v[148:151], a[172:175], v[120:123]
  s_cmp_eq_u32 s40, 3
  s_cbranch_scc1 vwm_182
vwm_183:
  v_mfma_f32_16x16x32_bf16 v[128:131], v[148:151], a[196:199], v[128:131]
  v_cvt_pk_bf16_f32 v29, v74, v75
  v_mfma_f32_16x16x32_bf16 v[136:139], v[148:151], a[220:223], v[136:139]
  v_mfma_f32_16x16x32_bf16 v[108:111], v[172:175], a[124:127], v[108:111]
  v_cvt_pk_bf16_f32 v30, v76, v77
  v_mfma_f32_16x16x32_bf16 v[116:119], v[172:175], a[148:151], v[116:119]
  v_mfma_f32_16x16x32_bf16 v[124:127], v[172:175], a[172:175], v[124:127]
  v_cvt_pk_bf16_f32 v31, v78, v79
  v_mfma_f32_16x16x32_bf16 v[132:135], v[172:175], a[196:199], v[132:135]
  buffer_store_dwordx4 v[28:31], v4, s[24:27], s42 offen offset:1024 sc1
  v_mfma_f32_16x16x32_bf16 v[140:143], v[172:175], a[220:223], v[140:143]
  s_cmp_lt_u32 s63, s50
  s_cbranch_scc0 vwx_180
vwx_181:
  v_mfma_f32_16x16x32_bf16 v[104:107], v[152:155], a[128:131], v[104:107]
  s_waitcnt lgkmcnt(0)
  s_barrier
  v_mfma_f32_16x16x32_bf16 v[112:115], v[152:155], a[152:155], v[112:115]
  ds_read_b128 v[240:243], v7 offset:0
  v_cvt_pk_bf16_f32 v32, v80, v81
  v_mfma_f32_16x16x32_bf16 v[120:123], v[152:155], a[176:179], v[120:123]
  ds_read_b128 v[192:195], v8 offset:0
  v_cvt_pk_bf16_f32 v33, v82, v83
  v_mfma_f32_16x16x32_bf16 v[128:131], v[152:155], a[200:203], v[128:131]
  v_mfma_f32_16x16x32_bf16 v[136:139], v[152:155], a[224:227], v[136:139]
  ds_read_b128 v[196:199], v8 offset:1024
  v_cvt_pk_bf16_f32 v34, v84, v85
  v_mfma_f32_16x16x32_bf16 v[108:111], v[176:179], a[128:131], v[108:111]
  v_mfma_f32_16x16x32_bf16 v[116:119], v[176:179], a[152:155], v[116:119]
  v_cvt_pk_bf16_f32 v35, v86, v87
  v_mfma_f32_16x16x32_bf16 v[124:127], v[176:179], a[176:179], v[124:127]
  ds_read_b128 v[200:203], v8 offset:2048
  v_mfma_f32_16x16x32_bf16 v[132:135], v[176:179], a[200:203], v[132:135]
  buffer_store_dwordx4 v[32:35], v4, s[24:27], s42 offen offset:2048 sc1
  v_mfma_f32_16x16x32_bf16 v[140:143], v[176:179], a[224:227], v[140:143]
  ds_read_b128 v[204:207], v8 offset:3072
  v_cvt_pk_bf16_f32 v36, v88, v89
  v_mfma_f32_16x16x32_bf16 v[104:107], v[156:159], a[132:135], v[104:107]
  v_mfma_f32_16x16x32_bf16 v[112:115], v[156:159], a[156:159], v[112:115]
  v_cvt_pk_bf16_f32 v37, v90, v91
  v_mfma_f32_16x16x32_bf16 v[120:123], v[156:159], a[180:183], v[120:123]
  ds_read_b128 v[208:211], v8 offset:4096
  v_mfma_f32_16x16x32_bf16 v[128:131], v[156:159], a[204:207], v[128:131]
  v_cvt_pk_bf16_f32 v38, v92, v93
  v_mfma_f32_16x16x32_bf16 v[136:139], v[156:159], a[228:231], v[136:139]
  ds_read_b128 v[212:215], v8 offset:5120
  s_waitcnt lgkmcnt(4)
  v_mfma_f32_16x16x32_bf16 v[108:111], v[180:183], a[132:135], v[108:111]
  v_bitop3_b32 v240, v240, v241, v242 bitop3:0x80
  v_and_b32 v240, v240, v243
  v_mfma_f32_16x16x32_bf16 v[116:119], v[180:183], a[156:159], v[116:119]
  s_nop 0
  v_readfirstlane_b32 s23, v240
  v_mfma_f32_16x16x32_bf16 v[124:127], v[180:183], a[180:183], v[124:127]
  ds_read_b128 v[216:219], v8 offset:6144
  v_cvt_pk_bf16_f32 v39, v94, v95
  v_mfma_f32_16x16x32_bf16 v[132:135], v[180:183], a[204:207], v[132:135]
  buffer_store_dwordx4 v[36:39], v4, s[24:27], s42 offen offset:3072 sc1
  v_mfma_f32_16x16x32_bf16 v[140:143], v[180:183], a[228:231], v[140:143]
  ds_read_b128 v[220:223], v8 offset:7168
  v_cvt_pk_bf16_f32 v40, v96, v97
  v_mfma_f32_16x16x32_bf16 v[104:107], v[160:163], a[136:139], v[104:107]
  v_cvt_pk_bf16_f32 v41, v98, v99
  v_mfma_f32_16x16x32_bf16 v[112:115], v[160:163], a[160:163], v[112:115]
  v_cvt_pk_bf16_f32 v42, v100, v101
  v_mfma_f32_16x16x32_bf16 v[120:123], v[160:163], a[184:187], v[120:123]
  ds_read_b128 v[224:227], v8 offset:8192
  v_mfma_f32_16x16x32_bf16 v[128:131], v[160:163], a[208:211], v[128:131]
  v_cvt_pk_bf16_f32 v43, v102, v103
  v_mfma_f32_16x16x32_bf16 v[136:139], v[160:163], a[232:235], v[136:139]
  ds_read_b128 v[228:231], v8 offset:9216
  v_mfma_f32_16x16x32_bf16 v[108:111], v[184:187], a[136:139], v[108:111]
  s_add_u32 s69, s42, 4096
  v_mfma_f32_16x16x32_bf16 v[116:119], v[184:187], a[160:163], v[116:119]
  v_mfma_f32_16x16x32_bf16 v[124:127], v[184:187], a[184:187], v[124:127]
  ds_read_b128 v[232:235], v8 offset:10240
  v_mfma_f32_16x16x32_bf16 v[132:135], v[184:187], a[208:211], v[132:135]
  buffer_store_dwordx4 v[40:43], v4, s[24:27], s69 offen offset:0 sc1
  v_mfma_f32_16x16x32_bf16 v[140:143], v[184:187], a[232:235], v[140:143]
  ds_read_b128 v[236:239], v8 offset:11264
  v_mfma_f32_16x16x32_bf16 v[104:107], v[164:167], a[140:143], v[104:107]
  v_mfma_f32_16x16x32_bf16 v[112:115], v[164:167], a[164:167], v[112:115]
  v_mfma_f32_16x16x32_bf16 v[120:123], v[164:167], a[188:191], v[120:123]
  s_waitcnt vmcnt(12)
  s_mov_b32 s50, s46
  s_add_u32 s69, s45, s40
  v_mfma_f32_16x16x32_bf16 v[128:131], v[164:167], a[212:215], v[128:131]
  s_mov_b32 s40, 0
  s_sub_i32 s69, s69, 1
  s_max_i32 s69, s69, s70
  v_mfma_f32_16x16x32_bf16 v[136:139], v[164:167], a[236:239], v[136:139]
  s_add_u32 s45, s45, 1
  s_mov_b32 s68, s42
  s_add_u32 s42, s42, 1310720
  v_mfma_f32_16x16x32_bf16 v[108:111], v[188:191], a[140:143], v[108:111]
  v_mfma_f32_16x16x32_bf16 v[116:119], v[188:191], a[164:167], v[116:119]
  v_mfma_f32_16x16x32_bf16 v[124:127], v[188:191], a[188:191], v[124:127]
  v_mfma_f32_16x16x32_bf16 v[132:135], v[188:191], a[212:215], v[132:135]
  v_mfma_f32_16x16x32_bf16 v[140:143], v[188:191], a[236:239], v[140:143]
  s_mov_b64 exec, 1
  v_mov_b32 v20, s69
  buffer_store_dword v20, v10, s[72:75], s44 offen sc1
  s_mov_b64 exec, -1
  s_cmp_le_u32 s45, 16
  s_cbranch_scc1 vwe_186
vwe_187:
  s_cmp_eq_u32 s23, 0
  s_cbranch_scc1 vws_184
vwb_185:
  s_waitcnt lgkmcnt(0)
  v_mfma_f32_16x16x32_bf16 v[64:67], v[192:195], a[0:3], 0
  v_cmp_gt_u32 vcc, 8, v9
  s_nop 0
  v_mfma_f32_16x16x32_bf16 v[72:75], v[192:195], a[24:27], 0
  s_bitset1_b64 vcc, 19
  s_ff1_i32_b64 s21, vcc
  v_mfma_f32_16x16x32_bf16 v[80:83], v[192:195], a[48:51], 0
  s_lshl_b32 s22, s21, 1
  s_lshl_b32 s21, s21, 2
  v_mfma_f32_16x16x32_bf16 v[88:91], v[192:195], a[72:75], 0
  s_sub_i32 s21, s21, 12
  s_max_i32 s47, s21, s22
  v_mfma_f32_16x16x32_bf16 v[96:99], v[192:195], a[96:99], 0
  s_add_u32 s22, s45, 7
  s_min_u32 s22, s22, s47
  v_mfma_f32_16x16x32_bf16 v[68:71], v[216:219], a[0:3], 0
  s_cmp_lt_u32 s46, s22
  s_cselect_b32 s66, s41, 0x80000000
  s_cselect_b32 m0, s64, 98304
  s_cselect_b32 s22, 1, 0
  v_mfma_f32_16x16x32_bf16 v[76:79], v[216:219], a[24:27], 0
  buffer_load_dwordx4 v4, s[16:19], s66 offen offset:0 sc1 lds
  v_mfma_f32_16x16x32_bf16 v[84:87], v[216:219], a[48:51], 0
  v_add_u32 v8, s65, v4
  s_add_u32 s65, s65, 12288
  v_mfma_f32_16x16x32_bf16 v[92:95], v[216:219], a[72:75], 0
  buffer_load_dwordx4 v4, s[16:19], s66 offen offset:1024 sc1 lds
  v_mfma_f32_16x16x32_bf16 v[100:103], v[216:219], a[96:99], 0
  s_cmp_lt_u32 s65, 98304
  s_cselect_b32 s65, s65, 0
  v_mfma_f32_16x16x32_bf16 v[64:67], v[196:199], a[4:7], v[64:67]
  buffer_load_dwordx4 v4, s[16:19], s66 offen offset:2048 sc1 lds
  v_mfma_f32_16x16x32_bf16 v[72:75], v[196:199], a[28:31], v[72:75]
  s_add_u32 s46, s46, s22
  s_mul_i32 s21, s22, 393216
  v_mfma_f32_16x16x32_bf16 v[80:83], v[196:199], a[52:55], v[80:83]
  s_add_u32 s41, s41, s21
  s_mul_i32 s21, s22, 12288
  v_mfma_f32_16x16x32_bf16 v[88:91], v[196:199], a[76:79], v[88:91]
  s_add_u32 s64, s64, s21
  v_cvt_pk_bf16_f32 v44, v104, v105
  v_mfma_f32_16x16x32_bf16 v[96:99], v[196:199], a[100:103], v[96:99]
  s_cmp_lt_u32 s64, s67
  s_cselect_b32 s64, s64, s71
  v_mfma_f32_16x16x32_bf16 v[68:71], v[220:223], a[4:7], v[68:71]
  v_cvt_pk_bf16_f32 v45, v106, v107
  v_cvt_pk_bf16_f32 v46, v108, v109
  v_mfma_f32_16x16x32_bf16 v[76:79], v[220:223], a[28:31], v[76:79]
  v_cvt_pk_bf16_f32 v47, v110, v111
  v_mfma_f32_16x16x32_bf16 v[84:87], v[220:223], a[52:55], v[84:87]
  s_add_u32 s69, s68, 4096
  v_mfma_f32_16x16x32_bf16 v[92:95], v[220:223], a[76:79], v[92:95]
  v_mfma_f32_16x16x32_bf16 v[100:103], v[220:223], a[100:103], v[100:103]
  buffer_store_dwordx4 v[44:47], v4, s[24:27], s69 offen offset:1024 sc1
  v_mfma_f32_16x16x32_bf16 v[64:67], v[200:203], a[8:11], v[64:67]
  v_mfma_f32_16x16x32_bf16 v[72:75], v[200:203], a[32:35], v[72:75]
  v_cvt_pk_bf16_f32 v48, v112, v113
  v_mfma_f32_16x16x32_bf16 v[80:83], v[200:203], a[56:59], v[80:83]
  v_cvt_pk_bf16_f32 v49, v114, v115
  v_mfma_f32_16x16x32_bf16 v[88:91], v[200:203], a[80:83], v[88:91]
  v_mfma_f32_16x16x32_bf16 v[96:99], v[200:203], a[104:107], v[96:99]
  v_cvt_pk_bf16_f32 v50, v116, v117
  v_mfma_f32_16x16x32_bf16 v[68:71], v[224:227], a[8:11], v[68:71]
  v_mfma_f32_16x16x32_bf16 v[76:79], v[224:227], a[32:35], v[76:79]
  v_cvt_pk_bf16_f32 v51, v118, v119
  v_mfma_f32_16x16x32_bf16 v[84:87], v[224:227], a[56:59], v[84:87]
  buffer_store_dwordx4 v[48:51], v4, s[24:27], s69 offen offset:2048 sc1
  v_mfma_f32_16x16x32_bf16 v[92:95], v[224:227], a[80:83], v[92:95]
  v_mfma_f32_16x16x32_bf16 v[100:103], v[224:227], a[104:107], v[100:103]
  v_cvt_pk_bf16_f32 v52, v120, v121
  v_mfma_f32_16x16x32_bf16 v[64:67], v[204:207], a[12:15], v[64:67]
  v_mfma_f32_16x16x32_bf16 v[72:75], v[204:207], a[36:39], v[72:75]
  v_cvt_pk_bf16_f32 v53, v122, v123
  v_mfma_f32_16x16x32_bf16 v[80:83], v[204:207], a[60:63], v[80:83]
  v_cvt_pk_bf16_f32 v54, v124, v125
  v_mfma_f32_16x16x32_bf16 v[88:91], v[204:207], a[84:87], v[88:91]
  v_mfma_f32_16x16x32_bf16 v[96:99], v[204:207], a[108:111], v[96:99]
  v_cvt_pk_bf16_f32 v55, v126, v127
  v_mfma_f32_16x16x32_bf16 v[68:71], v[228:231], a[12:15], v[68:71]
  v_mfma_f32_16x16x32_bf16 v[76:79], v[228:231], a[36:39], v[76:79]
  buffer_store_dwordx4 v[52:55], v4, s[24:27], s69 offen offset:3072 sc1
  v_mfma_f32_16x16x32_bf16 v[84:87], v[228:231], a[60:63], v[84:87]
  v_cvt_pk_bf16_f32 v56, v128, v129
  v_mfma_f32_16x16x32_bf16 v[92:95], v[228:231], a[84:87], v[92:95]
  v_mfma_f32_16x16x32_bf16 v[100:103], v[228:231], a[108:111], v[100:103]
  v_cvt_pk_bf16_f32 v57, v130, v131
  v_mfma_f32_16x16x32_bf16 v[64:67], v[208:211], a[16:19], v[64:67]
  s_cmp_lt_u32 s51, 6291456
  s_cselect_b32 s52, s51, 0x80000000
  v_mfma_f32_16x16x32_bf16 v[72:75], v[208:211], a[40:43], v[72:75]
  buffer_store_dwordx4 v[244:247], v4, s[84:87], s52 offen sc1
  v_mfma_f32_16x16x32_bf16 v[80:83], v[208:211], a[64:67], v[80:83]
  s_add_u32 s51, s51, 98304
  v_cvt_pk_bf16_f32 v58, v132, v133
  v_mfma_f32_16x16x32_bf16 v[88:91], v[208:211], a[88:91], v[88:91]
  v_cvt_pk_bf16_f32 v59, v134, v135
  v_mfma_f32_16x16x32_bf16 v[96:99], v[208:211], a[112:115], v[96:99]
  s_add_u32 s69, s68, 8192
  v_mfma_f32_16x16x32_bf16 v[68:71], v[232:235], a[16:19], v[68:71]
  v_mfma_f32_16x16x32_bf16 v[76:79], v[232:235], a[40:43], v[76:79]
  buffer_store_dwordx4 v[56:59], v4, s[24:27], s69 offen offset:0 sc1
  v_mfma_f32_16x16x32_bf16 v[84:87], v[232:235], a[64:67], v[84:87]
  v_cvt_pk_bf16_f32 v60, v136, v137
  v_mfma_f32_16x16x32_bf16 v[92:95], v[232:235], a[88:91], v[92:95]
  v_mfma_f32_16x16x32_bf16 v[100:103], v[232:235], a[112:115], v[100:103]
  v_cvt_pk_bf16_f32 v61, v138, v139
  v_mfma_f32_16x16x32_bf16 v[64:67], v[212:215], a[20:23], v[64:67]
  v_mfma_f32_16x16x32_bf16 v[72:75], v[212:215], a[44:47], v[72:75]
  v_cvt_pk_bf16_f32 v62, v140, v141
  v_mfma_f32_16x16x32_bf16 v[80:83], v[212:215], a[68:71], v[80:83]
  v_cvt_pk_bf16_f32 v63, v142, v143
  v_mfma_f32_16x16x32_bf16 v[88:91], v[212:215], a[92:95], v[88:91]
  v_mfma_f32_16x16x32_bf16 v[96:99], v[212:215], a[116:119], v[96:99]
  buffer_store_dwordx4 v[60:63], v4, s[24:27], s69 offen offset:1024 sc1
  v_mfma_f32_16x16x32_bf16 v[68:71], v[236:239], a[20:23], v[68:71]
  v_mfma_f32_16x16x32_bf16 v[76:79], v[236:239], a[44:47], v[76:79]
  v_mfma_f32_16x16x32_bf16 v[84:87], v[236:239], a[68:71], v[84:87]
  v_mfma_f32_16x16x32_bf16 v[92:95], v[236:239], a[92:95], v[92:95]
  v_mfma_f32_16x16x32_bf16 v[100:103], v[236:239], a[116:119], v[100:103]
  v_mfma_f32_16x16x32_bf16 v[104:107], v[192:195], a[120:123], 0
  buffer_load_dword v9, v5, s[72:75], s43 offen sc1
  v_mfma_f32_16x16x32_bf16 v[112:115], v[192:195], a[144:147], 0
  v_mfma_f32_16x16x32_bf16 v[120:123], v[192:195], a[168:171], 0
  v_mfma_f32_16x16x32_bf16 v[128:131], v[192:195], a[192:195], 0
  v_cvt_pk_bf16_f32 v24, v64, v65
  v_mfma_f32_16x16x32_bf16 v[136:139], v[192:195], a[216:219], 0
  s_add_u32 s63, s45, 1
  s_min_u32 s63, s63, 63
  v_mfma_f32_16x16x32_bf16 v[108:111], v[216:219], a[120:123], 0
  s_cmp_lt_u32 s63, s46
  s_cselect_b32 s53, 1, 0
  v_mfma_f32_16x16x32_bf16 v[116:119], v[216:219], a[144:147], 0
  v_mov_b32 v21, s53
  ds_write_b32 v6, v21 offset:16
  v_mfma_f32_16x16x32_bf16 v[124:127], v[216:219], a[168:171], 0
  v_cvt_pk_bf16_f32 v25, v66, v67
  v_cvt_pk_bf16_f32 v26, v68, v69
  v_mfma_f32_16x16x32_bf16 v[132:135], v[216:219], a[192:195], 0
  v_cvt_pk_bf16_f32 v27, v70, v71
  v_mfma_f32_16x16x32_bf16 v[140:143], v[216:219], a[216:219], 0
  v_mfma_f32_16x16x32_bf16 v[104:107], v[196:199], a[124:127], v[104:107]
  buffer_store_dwordx4 v[24:27], v4, s[24:27], s42 offen offset:0 sc1
  v_mfma_f32_16x16x32_bf16 v[112:115], v[196:199], a[148:151], v[112:115]
  v_cvt_pk_bf16_f32 v28, v72, v73
  v_mfma_f32_16x16x32_bf16 v[120:123], v[196:199], a[172:175], v[120:123]
  s_cmp_eq_u32 s40, 3
  s_cbranch_scc1 vwm_192
vwm_193:
  v_mfma_f32_16x16x32_bf16 v[128:131], v[196:199], a[196:199], v[128:131]
  v_cvt_pk_bf16_f32 v29, v74, v75
  v_mfma_f32_16x16x32_bf16 v[136:139], v[196:199], a[220:223], v[136:139]
  v_mfma_f32_16x16x32_bf16 v[108:111], v[220:223], a[124:127], v[108:111]
  v_cvt_pk_bf16_f32 v30, v76, v77
  v_mfma_f32_16x16x32_bf16 v[116:119], v[220:223], a[148:151], v[116:119]
  v_mfma_f32_16x16x32_bf16 v[124:127], v[220:223], a[172:175], v[124:127]
  v_cvt_pk_bf16_f32 v31, v78, v79
  v_mfma_f32_16x16x32_bf16 v[132:135], v[220:223], a[196:199], v[132:135]
  buffer_store_dwordx4 v[28:31], v4, s[24:27], s42 offen offset:1024 sc1
  v_mfma_f32_16x16x32_bf16 v[140:143], v[220:223], a[220:223], v[140:143]
  s_cmp_lt_u32 s63, s50
  s_cbranch_scc0 vwx_190
vwx_191:
  v_mfma_f32_16x16x32_bf16 v[104:107], v[200:203], a[128:131], v[104:107]
  s_waitcnt lgkmcnt(0)
  s_barrier
  v_mfma_f32_16x16x32_bf16 v[112:115], v[200:203], a[152:155], v[112:115]
  ds_read_b128 v[240:243], v7 offset:16
  v_cvt_pk_bf16_f32 v32, v80, v81
  v_mfma_f32_16x16x32_bf16 v[120:123], v[200:203], a[176:179], v[120:123]
  ds_read_b128 v[144:147], v8 offset:0
  v_cvt_pk_bf16_f32 v33, v82, v83
  v_mfma_f32_16x16x32_bf16 v[128:131], v[200:203], a[200:203], v[128:131]
  v_mfma_f32_16x16x32_bf16 v[136:139], v[200:203], a[224:227], v[136:139]
  ds_read_b128 v[148:151], v8 offset:1024
  v_cvt_pk_bf16_f32 v34, v84, v85
  v_mfma_f32_16x16x32_bf16 v[108:111], v[224:227], a[128:131], v[108:111]
  v_mfma_f32_16x16x32_bf16 v[116:119], v[224:227], a[152:155], v[116:119]
  v_cvt_pk_bf16_f32 v35, v86, v87
  v_mfma_f32_16x16x32_bf16 v[124:127], v[224:227], a[176:179], v[124:127]
  ds_read_b128 v[152:155], v8 offset:2048
  v_mfma_f32_16x16x32_bf16 v[132:135], v[224:227], a[200:203], v[132:135]
  buffer_store_dwordx4 v[32:35], v4, s[24:27], s42 offen offset:2048 sc1
  v_mfma_f32_16x16x32_bf16 v[140:143], v[224:227], a[224:227], v[140:143]
  ds_read_b128 v[156:159], v8 offset:3072
  v_cvt_pk_bf16_f32 v36, v88, v89
  v_mfma_f32_16x16x32_bf16 v[104:107], v[204:207], a[132:135], v[104:107]
  v_mfma_f32_16x16x32_bf16 v[112:115], v[204:207], a[156:159], v[112:115]
  v_cvt_pk_bf16_f32 v37, v90, v91
  v_mfma_f32_16x16x32_bf16 v[120:123], v[204:207], a[180:183], v[120:123]
  ds_read_b128 v[160:163], v8 offset:4096
  v_mfma_f32_16x16x32_bf16 v[128:131], v[204:207], a[204:207], v[128:131]
  v_cvt_pk_bf16_f32 v38, v92, v93
  v_mfma_f32_16x16x32_bf16 v[136:139], v[204:207], a[228:231], v[136:139]
  ds_read_b128 v[164:167], v8 offset:5120
  s_waitcnt lgkmcnt(4)
  v_mfma_f32_16x16x32_bf16 v[108:111], v[228:231], a[132:135], v[108:111]
  v_bitop3_b32 v240, v240, v241, v242 bitop3:0x80
  v_and_b32 v240, v240, v243
  v_mfma_f32_16x16x32_bf16 v[116:119], v[228:231], a[156:159], v[116:119]
  s_nop 0
  v_readfirstlane_b32 s23, v240
  v_mfma_f32_16x16x32_bf16 v[124:127], v[228:231], a[180:183], v[124:127]
  ds_read_b128 v[168:171], v8 offset:6144
  v_cvt_pk_bf16_f32 v39, v94, v95
  v_mfma_f32_16x16x32_bf16 v[132:135], v[228:231], a[204:207], v[132:135]
  buffer_store_dwordx4 v[36:39], v4, s[24:27], s42 offen offset:3072 sc1
  v_mfma_f32_16x16x32_bf16 v[140:143], v[228:231], a[228:231], v[140:143]
  ds_read_b128 v[172:175], v8 offset:7168
  v_cvt_pk_bf16_f32 v40, v96, v97
  v_mfma_f32_16x16x32_bf16 v[104:107], v[208:211], a[136:139], v[104:107]
  v_cvt_pk_bf16_f32 v41, v98, v99
  v_mfma_f32_16x16x32_bf16 v[112:115], v[208:211], a[160:163], v[112:115]
  v_cvt_pk_bf16_f32 v42, v100, v101
  v_mfma_f32_16x16x32_bf16 v[120:123], v[208:211], a[184:187], v[120:123]
  ds_read_b128 v[176:179], v8 offset:8192
  v_mfma_f32_16x16x32_bf16 v[128:131], v[208:211], a[208:211], v[128:131]
  v_cvt_pk_bf16_f32 v43, v102, v103
  v_mfma_f32_16x16x32_bf16 v[136:139], v[208:211], a[232:235], v[136:139]
  ds_read_b128 v[180:183], v8 offset:9216
  v_mfma_f32_16x16x32_bf16 v[108:111], v[232:235], a[136:139], v[108:111]
  s_add_u32 s69, s42, 4096
  v_mfma_f32_16x16x32_bf16 v[116:119], v[232:235], a[160:163], v[116:119]
  v_mfma_f32_16x16x32_bf16 v[124:127], v[232:235], a[184:187], v[124:127]
  ds_read_b128 v[184:187], v8 offset:10240
  v_mfma_f32_16x16x32_bf16 v[132:135], v[232:235], a[208:211], v[132:135]
  buffer_store_dwordx4 v[40:43], v4, s[24:27], s69 offen offset:0 sc1
  v_mfma_f32_16x16x32_bf16 v[140:143], v[232:235], a[232:235], v[140:143]
  ds_read_b128 v[188:191], v8 offset:11264
  v_mfma_f32_16x16x32_bf16 v[104:107], v[212:215], a[140:143], v[104:107]
  v_mfma_f32_16x16x32_bf16 v[112:115], v[212:215], a[164:167], v[112:115]
  v_mfma_f32_16x16x32_bf16 v[120:123], v[212:215], a[188:191], v[120:123]
  s_waitcnt vmcnt(12)
  s_mov_b32 s50, s46
  s_add_u32 s69, s45, s40
  v_mfma_f32_16x16x32_bf16 v[128:131], v[212:215], a[212:215], v[128:131]
  s_mov_b32 s40, 0
  s_sub_i32 s69, s69, 1
  s_max_i32 s69, s69, s70
  v_mfma_f32_16x16x32_bf16 v[136:139], v[212:215], a[236:239], v[136:139]
  s_add_u32 s45, s45, 1
  s_mov_b32 s68, s42
  s_add_u32 s42, s42, 1310720
  v_mfma_f32_16x16x32_bf16 v[108:111], v[236:239], a[140:143], v[108:111]
  v_mfma_f32_16x16x32_bf16 v[116:119], v[236:239], a[164:167], v[116:119]
  v_mfma_f32_16x16x32_bf16 v[124:127], v[236:239], a[188:191], v[124:127]
  v_mfma_f32_16x16x32_bf16 v[132:135], v[236:239], a[212:215], v[132:135]
  v_mfma_f32_16x16x32_bf16 v[140:143], v[236:239], a[236:239], v[140:143]
  s_mov_b64 exec, 1
  v_mov_b32 v20, s69
  buffer_store_dword v20, v10, s[72:75], s44 offen sc1
  s_mov_b64 exec, -1
  s_cmp_le_u32 s45, 16
  s_cbranch_scc1 vwe_196
vwe_197:
  s_cmp_lg_u32 s45, 48
  s_cbranch_scc1 arm_200
  s_mul_i32 s21, s2, 10240
  s_mul_i32 s22, s20, 2560
  s_add_u32 s21, s21, s22
  s_add_u32 s21, s21, 18350080
  buffer_store_dwordx4 v[244:247], v15, s[80:83], s21 offen offset:0 sc1
  buffer_store_dwordx4 v[244:247], v15, s[80:83], s21 offen offset:512 sc1
  buffer_store_dwordx4 v[244:247], v15, s[80:83], s21 offen offset:1024 sc1
  buffer_store_dwordx4 v[244:247], v15, s[80:83], s21 offen offset:1536 sc1
  buffer_store_dwordx4 v[244:247], v15, s[80:83], s21 offen offset:2048 sc1
  s_add_u32 s21, s21, 655360
  buffer_store_dwordx4 v[244:247], v15, s[80:83], s21 offen offset:0 sc1
  buffer_store_dwordx4 v[244:247], v15, s[80:83], s21 offen offset:512 sc1
  buffer_store_dwordx4 v[244:247], v15, s[80:83], s21 offen offset:1024 sc1
  buffer_store_dwordx4 v[244:247], v15, s[80:83], s21 offen offset:1536 sc1
  buffer_store_dwordx4 v[244:247], v15, s[80:83], s21 offen offset:2048 sc1
  s_add_u32 s21, s21, 655360
  buffer_store_dwordx4 v[244:247], v15, s[80:83], s21 offen offset:0 sc1
  buffer_store_dwordx4 v[244:247], v15, s[80:83], s21 offen offset:512 sc1
  buffer_store_dwordx4 v[244:247], v15, s[80:83], s21 offen offset:1024 sc1
  buffer_store_dwordx4 v[244:247], v15, s[80:83], s21 offen offset:1536 sc1
  buffer_store_dwordx4 v[244:247], v15, s[80:83], s21 offen offset:2048 sc1
  s_add_u32 s21, s21, 655360
  buffer_store_dwordx4 v[244:247], v15, s[80:83], s21 offen offset:0 sc1
  buffer_store_dwordx4 v[244:247], v15, s[80:83], s21 offen offset:512 sc1
  buffer_store_dwordx4 v[244:247], v15, s[80:83], s21 offen offset:1024 sc1
  buffer_store_dwordx4 v[244:247], v15, s[80:83], s21 offen offset:1536 sc1
  buffer_store_dwordx4 v[244:247], v15, s[80:83], s21 offen offset:2048 sc1
  s_add_u32 s21, s21, 655360
  s_and_b32 s21, s2, 3
  s_cmp_lg_u32 s21, s20
  s_cbranch_scc1 arm_200
  s_mul_i32 s21, s2, 2560
  s_add_u32 s21, s21, 4587520
  v_lshlrev_b32 v21, 3, v1
  buffer_store_dwordx4 v[244:247], v4, s[88:91], s21 offen sc1
  buffer_store_dwordx4 v[244:247], v4, s[88:91], s21 offen offset:1024 sc1
  buffer_store_dwordx2 v[244:245], v21, s[88:91], s21 offen offset:2048 sc1
  s_add_u32 s21, s21, 81920
  buffer_store_dwordx4 v[244:247], v4, s[88:91], s21 offen sc1
  buffer_store_dwordx4 v[244:247], v4, s[88:91], s21 offen offset:1024 sc1
  buffer_store_dwordx2 v[244:245], v21, s[88:91], s21 offen offset:2048 sc1
  s_add_u32 s21, s21, 81920
  buffer_store_dwordx4 v[244:247], v4, s[88:91], s21 offen sc1
  buffer_store_dwordx4 v[244:247], v4, s[88:91], s21 offen offset:1024 sc1
  buffer_store_dwordx2 v[244:245], v21, s[88:91], s21 offen offset:2048 sc1
  s_add_u32 s21, s21, 81920
  buffer_store_dwordx4 v[244:247], v4, s[88:91], s21 offen sc1
  buffer_store_dwordx4 v[244:247], v4, s[88:91], s21 offen offset:1024 sc1
  buffer_store_dwordx2 v[244:245], v21, s[88:91], s21 offen offset:2048 sc1
  s_add_u32 s21, s21, 81920
  buffer_store_dwordx4 v[244:247], v4, s[88:91], s21 offen sc1
  buffer_store_dwordx4 v[244:247], v4, s[88:91], s21 offen offset:1024 sc1
  buffer_store_dwordx2 v[244:245], v21, s[88:91], s21 offen offset:2048 sc1
  s_add_u32 s21, s21, 81920
  buffer_store_dwordx4 v[244:247], v4, s[88:91], s21 offen sc1
  buffer_store_dwordx4 v[244:247], v4, s[88:91], s21 offen offset:1024 sc1
  buffer_store_dwordx2 v[244:245], v21, s[88:91], s21 offen offset:2048 sc1
  s_add_u32 s21, s21, 81920
  buffer_store_dwordx4 v[244:247], v4, s[88:91], s21 offen sc1
  buffer_store_dwordx4 v[244:247], v4, s[88:91], s21 offen offset:1024 sc1
  buffer_store_dwordx2 v[244:245], v21, s[88:91], s21 offen offset:2048 sc1
  s_add_u32 s21, s21, 81920
  buffer_store_dwordx4 v[244:247], v4, s[88:91], s21 offen sc1
  buffer_store_dwordx4 v[244:247], v4, s[88:91], s21 offen offset:1024 sc1
  buffer_store_dwordx2 v[244:245], v21, s[88:91], s21 offen offset:2048 sc1
  s_add_u32 s21, s21, 81920
arm_200:
  s_cmp_ge_u32 s45, 64
  s_cbranch_scc1 vwd_179
  s_cmp_lg_u32 s23, 0
  s_cbranch_scc1 vwl_178
  s_branch vws_194
vws_184:
  v_cmp_gt_u32 vcc, 8, v9
  s_nop 0
  s_bitset1_b64 vcc, 19
  s_ff1_i32_b64 s21, vcc
  s_lshl_b32 s22, s21, 1
  s_lshl_b32 s21, s21, 2
  s_sub_i32 s21, s21, 12
  s_max_i32 s47, s21, s22
  s_cmp_gt_u32 s47, s45
  s_cbranch_scc1 va_202
  s_cmp_eq_u32 s70, s45
  s_cbranch_scc1 va_207
  s_nop 4
  v_cvt_pk_bf16_f32 v44, v104, v105
  v_cvt_pk_bf16_f32 v45, v106, v107
  v_cvt_pk_bf16_f32 v46, v108, v109
  v_cvt_pk_bf16_f32 v47, v110, v111
  s_add_u32 s69, s68, 4096
  buffer_store_dwordx4 v[44:47], v4, s[24:27], s69 offen offset:1024 sc1
  v_cvt_pk_bf16_f32 v48, v112, v113
  v_cvt_pk_bf16_f32 v49, v114, v115
  v_cvt_pk_bf16_f32 v50, v116, v117
  v_cvt_pk_bf16_f32 v51, v118, v119
  buffer_store_dwordx4 v[48:51], v4, s[24:27], s69 offen offset:2048 sc1
  v_cvt_pk_bf16_f32 v52, v120, v121
  v_cvt_pk_bf16_f32 v53, v122, v123
  v_cvt_pk_bf16_f32 v54, v124, v125
  v_cvt_pk_bf16_f32 v55, v126, v127
  buffer_store_dwordx4 v[52:55], v4, s[24:27], s69 offen offset:3072 sc1
  v_cvt_pk_bf16_f32 v56, v128, v129
  v_cvt_pk_bf16_f32 v57, v130, v131
  v_cvt_pk_bf16_f32 v58, v132, v133
  v_cvt_pk_bf16_f32 v59, v134, v135
  s_add_u32 s69, s68, 8192
  buffer_store_dwordx4 v[56:59], v4, s[24:27], s69 offen offset:0 sc1
  v_cvt_pk_bf16_f32 v60, v136, v137
  v_cvt_pk_bf16_f32 v61, v138, v139
  v_cvt_pk_bf16_f32 v62, v140, v141
  v_cvt_pk_bf16_f32 v63, v142, v143
  buffer_store_dwordx4 v[60:63], v4, s[24:27], s69 offen offset:1024 sc1
  s_mov_b32 s68, 0x80000000
  s_mov_b32 s56, s68
  s_mov_b32 s57, s68
  s_waitcnt vmcnt(0)
  s_mov_b64 exec, 1
  v_mov_b32 v20, s45
  buffer_store_dword v20, v10, s[72:75], s44 offen sc1
  s_mov_b64 exec, -1
  s_mov_b32 s70, s45
  s_mov_b32 s40, 0
va_207:
  s_mov_b32 s101, 0
  s_branch va_205
va_203:
  s_sleep 8
va_205:
  buffer_load_dword v9, v5, s[72:75], s43 offen sc1
  s_add_u32 s101, s101, 1
  s_cmp_gt_u32 s101, 131072
  s_cbranch_scc1 main_end
  s_waitcnt vmcnt(0)
  v_cmp_gt_u32 vcc, 8, v9
  s_nop 0
  s_bitset1_b64 vcc, 19
  s_ff1_i32_b64 s21, vcc
  s_lshl_b32 s22, s21, 1
  s_lshl_b32 s21, s21, 2
  s_sub_i32 s21, s21, 12
  s_max_i32 s47, s21, s22
  s_cmp_gt_u32 s47, s45
  s_cbranch_scc0 va_203
va_202:
  s_add_u32 s22, s45, 6
  s_min_u32 s22, s22, s47
va_204:
  s_cmp_ge_u32 s46, s22
  s_cbranch_scc1 va_206
  s_mov_b32 m0, s64
  s_mov_b32 s66, s41
  buffer_load_dwordx4 v4, s[16:19], s66 offen offset:0 sc1 lds
  buffer_load_dwordx4 v4, s[16:19], s66 offen offset:1024 sc1 lds
  buffer_load_dwordx4 v4, s[16:19], s66 offen offset:2048 sc1 lds
  s_add_u32 s46, s46, 1
  s_add_u32 s41, s41, 393216
  s_add_u32 s64, s64, 12288
  s_cmp_lt_u32 s64, s67
  s_cselect_b32 s64, s64, s71
  s_branch va_204
va_206:
  s_mov_b32 s48, s46
  s_mov_b32 s49, s46
  s_mov_b32 s50, s46
  s_waitcnt vmcnt(0)
  s_cmp_eq_u32 s40, 0
  s_cbranch_scc1 va_208
  s_mov_b32 s40, 0
  s_mov_b64 exec, 1
  v_mov_b32 v20, s45
  buffer_store_dword v20, v10, s[72:75], s44 offen sc1
  s_mov_b64 exec, -1
  s_mov_b32 s70, s45
va_208:
  s_barrier
  ds_read_b128 v[192:195], v8 offset:0
  ds_read_b128 v[196:199], v8 offset:1024
  ds_read_b128 v[200:203], v8 offset:2048
  ds_read_b128 v[204:207], v8 offset:3072
  ds_read_b128 v[208:211], v8 offset:4096
  ds_read_b128 v[212:215], v8 offset:5120
  ds_read_b128 v[216:219], v8 offset:6144
  ds_read_b128 v[220:223], v8 offset:7168
  ds_read_b128 v[224:227], v8 offset:8192
  ds_read_b128 v[228:231], v8 offset:9216
  ds_read_b128 v[232:235], v8 offset:10240
  ds_read_b128 v[236:239], v8 offset:11264
  s_branch vwb_185
vws_194:
  v_cmp_gt_u32 vcc, 8, v9
  s_nop 0
  s_bitset1_b64 vcc, 19
  s_ff1_i32_b64 s21, vcc
  s_lshl_b32 s22, s21, 1
  s_lshl_b32 s21, s21, 2
  s_sub_i32 s21, s21, 12
  s_max_i32 s47, s21, s22
  s_cmp_gt_u32 s47, s45
  s_cbranch_scc1 va_209
  s_cmp_eq_u32 s70, s45
  s_cbranch_scc1 va_214
  s_nop 4
  v_cvt_pk_bf16_f32 v44, v104, v105
  v_cvt_pk_bf16_f32 v45, v106, v107
  v_cvt_pk_bf16_f32 v46, v108, v109
  v_cvt_pk_bf16_f32 v47, v110, v111
  s_add_u32 s69, s68, 4096
  buffer_store_dwordx4 v[44:47], v4, s[24:27], s69 offen offset:1024 sc1
  v_cvt_pk_bf16_f32 v48, v112, v113
  v_cvt_pk_bf16_f32 v49, v114, v115
  v_cvt_pk_bf16_f32 v50, v116, v117
  v_cvt_pk_bf16_f32 v51, v118, v119
  buffer_store_dwordx4 v[48:51], v4, s[24:27], s69 offen offset:2048 sc1
  v_cvt_pk_bf16_f32 v52, v120, v121
  v_cvt_pk_bf16_f32 v53, v122, v123
  v_cvt_pk_bf16_f32 v54, v124, v125
  v_cvt_pk_bf16_f32 v55, v126, v127
  buffer_store_dwordx4 v[52:55], v4, s[24:27], s69 offen offset:3072 sc1
  v_cvt_pk_bf16_f32 v56, v128, v129
  v_cvt_pk_bf16_f32 v57, v130, v131
  v_cvt_pk_bf16_f32 v58, v132, v133
  v_cvt_pk_bf16_f32 v59, v134, v135
  s_add_u32 s69, s68, 8192
  buffer_store_dwordx4 v[56:59], v4, s[24:27], s69 offen offset:0 sc1
  v_cvt_pk_bf16_f32 v60, v136, v137
  v_cvt_pk_bf16_f32 v61, v138, v139
  v_cvt_pk_bf16_f32 v62, v140, v141
  v_cvt_pk_bf16_f32 v63, v142, v143
  buffer_store_dwordx4 v[60:63], v4, s[24:27], s69 offen offset:1024 sc1
  s_mov_b32 s68, 0x80000000
  s_mov_b32 s56, s68
  s_mov_b32 s57, s68
  s_waitcnt vmcnt(0)
  s_mov_b64 exec, 1
  v_mov_b32 v20, s45
  buffer_store_dword v20, v10, s[72:75], s44 offen sc1
  s_mov_b64 exec, -1
  s_mov_b32 s70, s45
  s_mov_b32 s40, 0
va_214:
  s_mov_b32 s101, 0
  s_branch va_212
va_210:
  s_sleep 8
va_212:
  buffer_load_dword v9, v5, s[72:75], s43 offen sc1
  s_add_u32 s101, s101, 1
  s_cmp_gt_u32 s101, 131072
  s_cbranch_scc1 main_end
  s_waitcnt vmcnt(0)
  v_cmp_gt_u32 vcc, 8, v9
  s_nop 0
  s_bitset1_b64 vcc, 19
  s_ff1_i32_b64 s21, vcc
  s_lshl_b32 s22, s21, 1
  s_lshl_b32 s21, s21, 2
  s_sub_i32 s21, s21, 12
  s_max_i32 s47, s21, s22
  s_cmp_gt_u32 s47, s45
  s_cbranch_scc0 va_210
va_209:
  s_add_u32 s22, s45, 6
  s_min_u32 s22, s22, s47
va_211:
  s_cmp_ge_u32 s46, s22
  s_cbranch_scc1 va_213
  s_mov_b32 m0, s64
  s_mov_b32 s66, s41
  buffer_load_dwordx4 v4, s[16:19], s66 offen offset:0 sc1 lds
  buffer_load_dwordx4 v4, s[16:19], s66 offen offset:1024 sc1 lds
  buffer_load_dwordx4 v4, s[16:19], s66 offen offset:2048 sc1 lds
  s_add_u32 s46, s46, 1
  s_add_u32 s41, s41, 393216
  s_add_u32 s64, s64, 12288
  s_cmp_lt_u32 s64, s67
  s_cselect_b32 s64, s64, s71
  s_branch va_211
va_213:
  s_mov_b32 s48, s46
  s_mov_b32 s49, s46
  s_mov_b32 s50, s46
  s_waitcnt vmcnt(0)
  s_cmp_eq_u32 s40, 0
  s_cbranch_scc1 va_215
  s_mov_b32 s40, 0
  s_mov_b64 exec, 1
  v_mov_b32 v20, s45
  buffer_store_dword v20, v10, s[72:75], s44 offen sc1
  s_mov_b64 exec, -1
  s_mov_b32 s70, s45
va_215:
  s_barrier
  ds_read_b128 v[144:147], v8 offset:0
  ds_read_b128 v[148:151], v8 offset:1024
  ds_read_b128 v[152:155], v8 offset:2048
  ds_read_b128 v[156:159], v8 offset:3072
  ds_read_b128 v[160:163], v8 offset:4096
  ds_read_b128 v[164:167], v8 offset:5120
  ds_read_b128 v[168:171], v8 offset:6144
  ds_read_b128 v[172:175], v8 offset:7168
  ds_read_b128 v[176:179], v8 offset:8192
  ds_read_b128 v[180:183], v8 offset:9216
  ds_read_b128 v[184:187], v8 offset:10240
  ds_read_b128 v[188:191], v8 offset:11264
  s_branch vwl_178
vwe_186:
  s_nop 4
  v_cvt_pk_bf16_f32 v44, v104, v105
  v_cvt_pk_bf16_f32 v45, v106, v107
  v_cvt_pk_bf16_f32 v46, v108, v109
  v_cvt_pk_bf16_f32 v47, v110, v111
  s_add_u32 s69, s68, 4096
  buffer_store_dwordx4 v[44:47], v4, s[24:27], s69 offen offset:1024 sc1
  v_cvt_pk_bf16_f32 v48, v112, v113
  v_cvt_pk_bf16_f32 v49, v114, v115
  v_cvt_pk_bf16_f32 v50, v116, v117
  v_cvt_pk_bf16_f32 v51, v118, v119
  buffer_store_dwordx4 v[48:51], v4, s[24:27], s69 offen offset:2048 sc1
  v_cvt_pk_bf16_f32 v52, v120, v121
  v_cvt_pk_bf16_f32 v53, v122, v123
  v_cvt_pk_bf16_f32 v54, v124, v125
  v_cvt_pk_bf16_f32 v55, v126, v127
  buffer_store_dwordx4 v[52:55], v4, s[24:27], s69 offen offset:3072 sc1
  v_cvt_pk_bf16_f32 v56, v128, v129
  v_cvt_pk_bf16_f32 v57, v130, v131
  v_cvt_pk_bf16_f32 v58, v132, v133
  v_cvt_pk_bf16_f32 v59, v134, v135
  s_add_u32 s69, s68, 8192
  buffer_store_dwordx4 v[56:59], v4, s[24:27], s69 offen offset:0 sc1
  v_cvt_pk_bf16_f32 v60, v136, v137
  v_cvt_pk_bf16_f32 v61, v138, v139
  v_cvt_pk_bf16_f32 v62, v140, v141
  v_cvt_pk_bf16_f32 v63, v142, v143
  buffer_store_dwordx4 v[60:63], v4, s[24:27], s69 offen offset:1024 sc1
  s_mov_b32 s68, 0x80000000
  s_mov_b32 s56, s68
  s_mov_b32 s57, s68
  s_cmp_le_u32 s45, 4
  s_cselect_b32 s40, 3, 1
  s_branch vwe_187
vwe_196:
  s_nop 4
  v_cvt_pk_bf16_f32 v44, v104, v105
  v_cvt_pk_bf16_f32 v45, v106, v107
  v_cvt_pk_bf16_f32 v46, v108, v109
  v_cvt_pk_bf16_f32 v47, v110, v111
  s_add_u32 s69, s68, 4096
  buffer_store_dwordx4 v[44:47], v4, s[24:27], s69 offen offset:1024 sc1
  v_cvt_pk_bf16_f32 v48, v112, v113
  v_cvt_pk_bf16_f32 v49, v114, v115
  v_cvt_pk_bf16_f32 v50, v116, v117
  v_cvt_pk_bf16_f32 v51, v118, v119
  buffer_store_dwordx4 v[48:51], v4, s[24:27], s69 offen offset:2048 sc1
  v_cvt_pk_bf16_f32 v52, v120, v121
  v_cvt_pk_bf16_f32 v53, v122, v123
  v_cvt_pk_bf16_f32 v54, v124, v125
  v_cvt_pk_bf16_f32 v55, v126, v127
  buffer_store_dwordx4 v[52:55], v4, s[24:27], s69 offen offset:3072 sc1
  v_cvt_pk_bf16_f32 v56, v128, v129
  v_cvt_pk_bf16_f32 v57, v130, v131
  v_cvt_pk_bf16_f32 v58, v132, v133
  v_cvt_pk_bf16_f32 v59, v134, v135
  s_add_u32 s69, s68, 8192
  buffer_store_dwordx4 v[56:59], v4, s[24:27], s69 offen offset:0 sc1
  v_cvt_pk_bf16_f32 v60, v136, v137
  v_cvt_pk_bf16_f32 v61, v138, v139
  v_cvt_pk_bf16_f32 v62, v140, v141
  v_cvt_pk_bf16_f32 v63, v142, v143
  buffer_store_dwordx4 v[60:63], v4, s[24:27], s69 offen offset:1024 sc1
  s_mov_b32 s68, 0x80000000
  s_mov_b32 s56, s68
  s_mov_b32 s57, s68
  s_cmp_le_u32 s45, 4
  s_cselect_b32 s40, 3, 1
  s_branch vwe_197
vwx_180:
  s_waitcnt vmcnt(9)
  s_branch vwx_181
vwx_190:
  s_waitcnt vmcnt(9)
  s_branch vwx_191
vwm_182:
  s_mov_b32 s40, 0
  s_waitcnt vmcnt(11)
  s_mov_b64 exec, 1
  v_mov_b32 v20, s45
  buffer_store_dword v20, v10, s[72:75], s44 offen sc1
  s_mov_b64 exec, -1
  s_mov_b32 s70, s45
  s_branch vwm_183
vwm_192:
  s_mov_b32 s40, 0
  s_waitcnt vmcnt(11)
  s_mov_b64 exec, 1
  v_mov_b32 v20, s45
  buffer_store_dword v20, v10, s[72:75], s44 offen sc1
  s_mov_b64 exec, -1
  s_mov_b32 s70, s45
  s_branch vwm_193
vwd_179:
  s_nop 4
  v_cvt_pk_bf16_f32 v44, v104, v105
  v_cvt_pk_bf16_f32 v45, v106, v107
  v_cvt_pk_bf16_f32 v46, v108, v109
  v_cvt_pk_bf16_f32 v47, v110, v111
  s_add_u32 s69, s68, 4096
  buffer_store_dwordx4 v[44:47], v4, s[24:27], s69 offen offset:1024 sc1
  v_cvt_pk_bf16_f32 v48, v112, v113
  v_cvt_pk_bf16_f32 v49, v114, v115
  v_cvt_pk_bf16_f32 v50, v116, v117
  v_cvt_pk_bf16_f32 v51, v118, v119
  buffer_store_dwordx4 v[48:51], v4, s[24:27], s69 offen offset:2048 sc1
  v_cvt_pk_bf16_f32 v52, v120, v121
  v_cvt_pk_bf16_f32 v53, v122, v123
  v_cvt_pk_bf16_f32 v54, v124, v125
  v_cvt_pk_bf16_f32 v55, v126, v127
  buffer_store_dwordx4 v[52:55], v4, s[24:27], s69 offen offset:3072 sc1
  v_cvt_pk_bf16_f32 v56, v128, v129
  v_cvt_pk_bf16_f32 v57, v130, v131
  v_cvt_pk_bf16_f32 v58, v132, v133
  v_cvt_pk_bf16_f32 v59, v134, v135
  s_add_u32 s69, s68, 8192
  buffer_store_dwordx4 v[56:59], v4, s[24:27], s69 offen offset:0 sc1
  v_cvt_pk_bf16_f32 v60, v136, v137
  v_cvt_pk_bf16_f32 v61, v138, v139
  v_cvt_pk_bf16_f32 v62, v140, v141
  v_cvt_pk_bf16_f32 v63, v142, v143
  buffer_store_dwordx4 v[60:63], v4, s[24:27], s69 offen offset:1024 sc1
  s_waitcnt vmcnt(0)
  s_mov_b64 exec, 1
  v_mov_b32 v20, s45
  buffer_store_dword v20, v10, s[72:75], s44 offen sc1
  s_mov_b64 exec, -1
  s_mov_b32 s84, 0
  s_mov_b32 s85, -1
  s_and_b32 s21, s3, 3
  s_cmp_lt_u32 s21, 1
  s_cbranch_scc1 queue
  s_sub_u32 s22, s21, 1
  s_lshl_b32 s22, s22, 3
  s_bfe_u32 s21, s3, 0x30002
  s_add_u32 s21, s21, s22
  s_add_u32 s87, s21, 366
  s_waitcnt vmcnt(0) lgkmcnt(0)
  s_barrier
  s_branch do_opb2
  s_mov_b32 s84, 0
  s_mov_b32 s85, -1
  s_mov_b32 s86, 0
  s_branch queue
not_vw:
  s_sub_u32 s2, s3, 96
  s_cmp_lg_u32 s2, 31
  s_cbranch_scc1 not_cal
  s_add_u32 s8, s38, 83886079
  s_addc_u32 s9, s39, 0
  s_and_b32 s8, s8, 0xffe00000
  s_mov_b32 s10, 2097152
  s_mov_b32 s11, 0x00020000
  v_lshrrev_b32 v9, 4, v0
  v_mul_u32_u24 v9, 16640, v9
  v_bfe_u32 v10, v0, 3, 1
  v_lshl_add_u32 v9, v10, 13, v9
  v_and_b32 v10, 7, v0
  v_lshl_add_u32 v9, v10, 4, v9
  s_mov_b32 s21, 1048576
  buffer_store_dwordx4 v[4:7], v9, s[8:11], s21 offen sc1
  s_waitcnt vmcnt(0)
  s_barrier
  s_cmp_lg_u32 s20, 3
  s_cbranch_scc1 cal_216
  s_mov_b64 exec, 1
  v_mov_b32 v4, 0
  s_mov_b32 s40, -1
  s_mov_b32 s41, -1
  s_mov_b32 s42, 1048576
  s_mov_b32 s43, 0
  s_waitcnt vmcnt(0)
cal_217:
  s_add_u32 s21, s42, 0
  s_memtime s[98:99]
  s_waitcnt lgkmcnt(0)
  buffer_load_dword v5, v4, s[8:11], s21 offen sc1
  s_waitcnt vmcnt(0)
  s_memtime s[100:101]
  s_waitcnt lgkmcnt(0)
  s_sub_u32 s21, s100, s98
  s_min_u32 s40, s40, s21
  s_add_u32 s21, s42, 8192
  s_memtime s[98:99]
  s_waitcnt lgkmcnt(0)
  buffer_load_dword v5, v4, s[8:11], s21 offen sc1
  s_waitcnt vmcnt(0)
  s_memtime s[100:101]
  s_waitcnt lgkmcnt(0)
  s_sub_u32 s21, s100, s98
  s_min_u32 s41, s41, s21
  s_add_u32 s42, s42, 16640
  s_add_u32 s43, s43, 1
  s_cmp_lt_u32 s43, 4
  s_cbranch_scc1 cal_217
  s_cmp_lt_u32 s41, s40
  s_cselect_b32 s21, 1, 2
  v_mov_b32 v4, s21
  v_mov_b32 v5, s40
  v_mov_b32 v6, s41
  v_mov_b32 v8, 84
  buffer_store_dwordx3 v[4:6], v8, s[32:35], 0 offen sc1
  s_waitcnt vmcnt(0)
  s_mov_b64 exec, -1
cal_216:
  s_barrier
  s_branch armed
not_cal:
  s_sleep 32
  s_sleep 32
  s_sleep 32
  s_sleep 32
  s_sleep 32
armed:
  s_load_dwordx2 s[72:73], s[0:1], 104
  s_waitcnt lgkmcnt(0)
  s_add_u32 s72, s72, 81068032
  s_addc_u32 s73, s73, 0
  s_mov_b32 s74, 116736
  s_mov_b32 s75, 0x00020000
  s_load_dwordx2 s[4:5], s[0:1], 0
  s_load_dwordx2 s[6:7], s[0:1], 64
  s_load_dwordx2 s[38:39], s[0:1], 104
  s_lshr_b32 s41, s2, 1
  s_and_b32 s42, s2, 1
  s_waitcnt lgkmcnt(0)
  s_mov_b32 s8, s4
  s_mov_b32 s9, s5
  s_mov_b32 s10, 2621440
  s_mov_b32 s11, 0x00020000
  s_mov_b32 s12, s6
  s_mov_b32 s13, s7
  s_mov_b32 s14, 2457600
  s_mov_b32 s15, 0x00020000
  s_add_u32 s16, s38, 70713344
  s_addc_u32 s17, s39, 0
  s_mov_b32 s18, 2641920
  s_mov_b32 s19, 0x00020000
  s_add_u32 s72, s38, 81068032
  s_addc_u32 s73, s39, 0
  s_mov_b32 s74, 116736
  s_mov_b32 s75, 0x00020000
  v_lshlrev_b32 v6, 1, v3
  v_add_u32 v6, 0, v6
  v_xor_b32 v6, v6, v2
  v_min_u32 v6, 14, v6
  v_mul_u32_u24 v7, 52, v6
  v_lshrrev_b32 v7, 8, v7
  v_mul_u32_u24 v7, 1200, v7
  v_lshl_add_u32 v7, v6, 4, v7
  v_mul_u32_u24 v6, 3840, v3
  v_add_u32 v4, v6, v7
  v_lshlrev_b32 v6, 1, v3
  v_add_u32 v6, 8, v6
  v_xor_b32 v6, v6, v2
  v_min_u32 v6, 14, v6
  v_mul_u32_u24 v7, 52, v6
  v_lshrrev_b32 v7, 8, v7
  v_mul_u32_u24 v7, 1200, v7
  v_lshl_add_u32 v7, v6, 4, v7
  v_mul_u32_u24 v6, 3840, v3
  v_add_u32 v5, v6, v7
  s_mul_i32 s21, s41, 80
  s_mul_i32 s22, s20, 15360
  s_add_u32 s21, s21, s22
  s_lshl_b32 s22, s20, 10
  s_cmp_ge_u32 s20, 2
  s_cselect_b64 vcc, -1, 0
  v_cndmask_b32 v4, v4, v5, vcc
  s_add_u32 m0, s22, 0
  s_nop 0
  buffer_load_dwordx4 v4, s[12:15], s21 offen lds
  s_add_u32 s21, s21, 61440
  s_add_u32 m0, s22, 4096
  s_nop 0
  buffer_load_dwordx4 v4, s[12:15], s21 offen lds
  s_add_u32 s21, s21, 61440
  s_add_u32 m0, s22, 8192
  s_nop 0
  buffer_load_dwordx4 v4, s[12:15], s21 offen lds
  s_add_u32 s21, s21, 61440
  s_add_u32 m0, s22, 12288
  s_nop 0
  buffer_load_dwordx4 v4, s[12:15], s21 offen lds
  s_add_u32 s21, s21, 61440
  s_add_u32 m0, s22, 16384
  s_nop 0
  buffer_load_dwordx4 v4, s[12:15], s21 offen lds
  s_add_u32 s21, s21, 61440
  s_add_u32 m0, s22, 20480
  s_nop 0
  buffer_load_dwordx4 v4, s[12:15], s21 offen lds
  s_add_u32 s21, s21, 61440
  s_add_u32 m0, s22, 24576
  s_nop 0
  buffer_load_dwordx4 v4, s[12:15], s21 offen lds
  s_add_u32 s21, s21, 61440
  s_add_u32 m0, s22, 28672
  s_nop 0
  buffer_load_dwordx4 v4, s[12:15], s21 offen lds
  s_add_u32 s21, s21, 61440
  s_add_u32 m0, s22, 32768
  s_nop 0
  buffer_load_dwordx4 v4, s[12:15], s21 offen lds
  s_add_u32 s21, s21, 61440
  s_add_u32 m0, s22, 36864
  s_nop 0
  buffer_load_dwordx4 v4, s[12:15], s21 offen lds
  s_add_u32 s21, s21, 61440
  s_add_u32 m0, s22, 40960
  s_nop 0
  buffer_load_dwordx4 v4, s[12:15], s21 offen lds
  s_add_u32 s21, s21, 61440
  s_add_u32 m0, s22, 45056
  s_nop 0
  buffer_load_dwordx4 v4, s[12:15], s21 offen lds
  s_add_u32 s21, s21, 61440
  s_add_u32 m0, s22, 49152
  s_nop 0
  buffer_load_dwordx4 v4, s[12:15], s21 offen lds
  s_add_u32 s21, s21, 61440
  s_add_u32 m0, s22, 53248
  s_nop 0
  buffer_load_dwordx4 v4, s[12:15], s21 offen lds
  s_add_u32 s21, s21, 61440
  s_add_u32 m0, s22, 57344
  s_nop 0
  buffer_load_dwordx4 v4, s[12:15], s21 offen lds
  s_add_u32 s21, s21, 61440
  s_add_u32 m0, s22, 61440
  s_nop 0
  buffer_load_dwordx4 v4, s[12:15], s21 offen lds
  s_add_u32 s21, s21, 61440
  s_add_u32 m0, s22, 65536
  s_nop 0
  buffer_load_dwordx4 v4, s[12:15], s21 offen lds
  s_add_u32 s21, s21, 61440
  s_add_u32 m0, s22, 69632
  s_nop 0
  buffer_load_dwordx4 v4, s[12:15], s21 offen lds
  s_add_u32 s21, s21, 61440
  s_add_u32 m0, s22, 73728
  s_nop 0
  buffer_load_dwordx4 v4, s[12:15], s21 offen lds
  s_add_u32 s21, s21, 61440
  s_add_u32 m0, s22, 77824
  s_nop 0
  buffer_load_dwordx4 v4, s[12:15], s21 offen lds
  s_add_u32 s21, s21, 61440
  s_add_u32 m0, s22, 81920
  s_nop 0
  buffer_load_dwordx4 v4, s[12:15], s21 offen lds
  s_add_u32 s21, s21, 61440
  s_add_u32 m0, s22, 86016
  s_nop 0
  buffer_load_dwordx4 v4, s[12:15], s21 offen lds
  s_add_u32 s21, s21, 61440
  s_add_u32 m0, s22, 90112
  s_nop 0
  buffer_load_dwordx4 v4, s[12:15], s21 offen lds
  s_add_u32 s21, s21, 61440
  s_add_u32 m0, s22, 94208
  s_nop 0
  buffer_load_dwordx4 v4, s[12:15], s21 offen lds
  s_add_u32 s21, s21, 61440
  s_add_u32 m0, s22, 98304
  s_nop 0
  buffer_load_dwordx4 v4, s[12:15], s21 offen lds
  s_add_u32 s21, s21, 61440
  s_add_u32 m0, s22, 102400
  s_nop 0
  buffer_load_dwordx4 v4, s[12:15], s21 offen lds
  s_add_u32 s21, s21, 61440
  s_add_u32 m0, s22, 106496
  s_nop 0
  buffer_load_dwordx4 v4, s[12:15], s21 offen lds
  s_add_u32 s21, s21, 61440
  s_add_u32 m0, s22, 110592
  s_nop 0
  buffer_load_dwordx4 v4, s[12:15], s21 offen lds
  s_add_u32 s21, s21, 61440
  s_add_u32 m0, s22, 114688
  s_nop 0
  buffer_load_dwordx4 v4, s[12:15], s21 offen lds
  s_add_u32 s21, s21, 61440
  s_add_u32 m0, s22, 118784
  s_nop 0
  buffer_load_dwordx4 v4, s[12:15], s21 offen lds
  s_add_u32 s21, s21, 61440
  s_add_u32 m0, s22, 122880
  s_nop 0
  buffer_load_dwordx4 v4, s[12:15], s21 offen lds
  s_add_u32 s21, s21, 61440
  s_add_u32 m0, s22, 126976
  s_nop 0
  buffer_load_dwordx4 v4, s[12:15], s21 offen lds
  s_add_u32 s21, s21, 61440
  s_add_u32 m0, s22, 131072
  s_nop 0
  buffer_load_dwordx4 v4, s[12:15], s21 offen lds
  s_add_u32 s21, s21, 61440
  s_add_u32 m0, s22, 135168
  s_nop 0
  buffer_load_dwordx4 v4, s[12:15], s21 offen lds
  s_add_u32 s21, s21, 61440
  s_add_u32 m0, s22, 139264
  s_nop 0
  buffer_load_dwordx4 v4, s[12:15], s21 offen lds
  s_add_u32 s21, s21, 61440
  s_add_u32 m0, s22, 143360
  s_nop 0
  buffer_load_dwordx4 v4, s[12:15], s21 offen lds
  s_add_u32 s21, s21, 61440
  s_add_u32 m0, s22, 147456
  s_nop 0
  buffer_load_dwordx4 v4, s[12:15], s21 offen lds
  s_add_u32 s21, s21, 61440
  s_add_u32 m0, s22, 151552
  s_nop 0
  buffer_load_dwordx4 v4, s[12:15], s21 offen lds
  s_add_u32 s21, s21, 61440
  s_add_u32 m0, s22, 155648
  s_nop 0
  buffer_load_dwordx4 v4, s[12:15], s21 offen lds
  s_add_u32 s21, s21, 61440
  s_add_u32 m0, s22, 159744
  s_nop 0
  buffer_load_dwordx4 v4, s[12:15], s21 offen lds
  s_add_u32 s21, s21, 61440
  s_lshl_b32 s21, s2, 2
  s_add_u32 s21, s21, s20
  s_mul_i32 s21, s21, 20480
  v_lshlrev_b32 v5, 4, v1
  buffer_load_dwordx4 v[64:67], v5, s[8:11], s21 offen offset:0
  buffer_load_dwordx4 v[64:67], v5, s[8:11], s21 offen offset:1024
  buffer_load_dwordx4 v[64:67], v5, s[8:11], s21 offen offset:2048
  buffer_load_dwordx4 v[64:67], v5, s[8:11], s21 offen offset:3072
  s_add_u32 s21, s21, 4096
  buffer_load_dwordx4 v[64:67], v5, s[8:11], s21 offen offset:0
  buffer_load_dwordx4 v[64:67], v5, s[8:11], s21 offen offset:1024
  buffer_load_dwordx4 v[64:67], v5, s[8:11], s21 offen offset:2048
  buffer_load_dwordx4 v[64:67], v5, s[8:11], s21 offen offset:3072
  s_add_u32 s21, s21, 4096
  buffer_load_dwordx4 v[64:67], v5, s[8:11], s21 offen offset:0
  buffer_load_dwordx4 v[64:67], v5, s[8:11], s21 offen offset:1024
  buffer_load_dwordx4 v[64:67], v5, s[8:11], s21 offen offset:2048
  buffer_load_dwordx4 v[64:67], v5, s[8:11], s21 offen offset:3072
  s_add_u32 s21, s21, 4096
  buffer_load_dwordx4 v[64:67], v5, s[8:11], s21 offen offset:0
  buffer_load_dwordx4 v[64:67], v5, s[8:11], s21 offen offset:1024
  buffer_load_dwordx4 v[64:67], v5, s[8:11], s21 offen offset:2048
  buffer_load_dwordx4 v[64:67], v5, s[8:11], s21 offen offset:3072
  s_add_u32 s21, s21, 4096
  buffer_load_dwordx4 v[64:67], v5, s[8:11], s21 offen offset:0
  buffer_load_dwordx4 v[64:67], v5, s[8:11], s21 offen offset:1024
  buffer_load_dwordx4 v[64:67], v5, s[8:11], s21 offen offset:2048
  buffer_load_dwordx4 v[64:67], v5, s[8:11], s21 offen offset:3072
  v_lshrrev_b32 v6, 2, v2
  v_lshl_add_u32 v7, v3, 3, v6
  v_and_b32 v8, 1, v3
  v_lshl_add_u32 v6, v8, 2, v6
  v_lshlrev_b32 v6, 1, v6
  v_bfe_u32 v8, v2, 1, 1
  s_lshl_b32 s21, s20, 2
  v_add_u32 v8, s21, v8
  v_and_b32 v9, 1, v2
  v_lshlrev_b32 v9, 3, v9
  v_lshl_add_u32 v9, v7, 8, v9
  v_add_u32 v5, 0, v8
  v_xor_b32 v5, v5, v6
  v_lshl_add_u32 v10, v5, 4, v9
  v_add_u32 v11, 65536, v10
  v_add_u32 v12, 131072, v10
  v_add_u32 v5, 2, v8
  v_xor_b32 v5, v5, v6
  v_lshl_add_u32 v13, v5, 4, v9
  v_add_u32 v14, 65536, v13
  v_add_u32 v15, 131072, v13
  s_waitcnt vmcnt(50)
  s_barrier
  ds_read_b64_tr_b16 a[0:1], v10 offset:0
  ds_read_b64_tr_b16 a[2:3], v10 offset:1024
  ds_read_b64_tr_b16 a[4:5], v13 offset:0
  ds_read_b64_tr_b16 a[6:7], v13 offset:1024
  ds_read_b64_tr_b16 a[8:9], v10 offset:8192
  ds_read_b64_tr_b16 a[10:11], v10 offset:9216
  ds_read_b64_tr_b16 a[12:13], v13 offset:8192
  ds_read_b64_tr_b16 a[14:15], v13 offset:9216
  ds_read_b64_tr_b16 a[16:17], v10 offset:16384
  ds_read_b64_tr_b16 a[18:19], v10 offset:17408
  ds_read_b64_tr_b16 a[20:21], v13 offset:16384
  ds_read_b64_tr_b16 a[22:23], v13 offset:17408
  ds_read_b64_tr_b16 a[24:25], v10 offset:24576
  ds_read_b64_tr_b16 a[26:27], v10 offset:25600
  ds_read_b64_tr_b16 a[28:29], v13 offset:24576
  ds_read_b64_tr_b16 a[30:31], v13 offset:25600
  ds_read_b64_tr_b16 a[32:33], v10 offset:32768
  ds_read_b64_tr_b16 a[34:35], v10 offset:33792
  ds_read_b64_tr_b16 a[36:37], v13 offset:32768
  ds_read_b64_tr_b16 a[38:39], v13 offset:33792
  s_waitcnt vmcnt(40)
  s_barrier
  ds_read_b64_tr_b16 a[40:41], v10 offset:40960
  ds_read_b64_tr_b16 a[42:43], v10 offset:41984
  ds_read_b64_tr_b16 a[44:45], v13 offset:40960
  ds_read_b64_tr_b16 a[46:47], v13 offset:41984
  ds_read_b64_tr_b16 a[48:49], v10 offset:49152
  ds_read_b64_tr_b16 a[50:51], v10 offset:50176
  ds_read_b64_tr_b16 a[52:53], v13 offset:49152
  ds_read_b64_tr_b16 a[54:55], v13 offset:50176
  ds_read_b64_tr_b16 a[56:57], v10 offset:57344
  ds_read_b64_tr_b16 a[58:59], v10 offset:58368
  ds_read_b64_tr_b16 a[60:61], v13 offset:57344
  ds_read_b64_tr_b16 a[62:63], v13 offset:58368
  ds_read_b64_tr_b16 a[64:65], v11 offset:0
  ds_read_b64_tr_b16 a[66:67], v11 offset:1024
  ds_read_b64_tr_b16 a[68:69], v14 offset:0
  ds_read_b64_tr_b16 a[70:71], v14 offset:1024
  ds_read_b64_tr_b16 a[72:73], v11 offset:8192
  ds_read_b64_tr_b16 a[74:75], v11 offset:9216
  ds_read_b64_tr_b16 a[76:77], v14 offset:8192
  ds_read_b64_tr_b16 a[78:79], v14 offset:9216
  s_waitcnt vmcnt(30)
  s_barrier
  ds_read_b64_tr_b16 a[80:81], v11 offset:16384
  ds_read_b64_tr_b16 a[82:83], v11 offset:17408
  ds_read_b64_tr_b16 a[84:85], v14 offset:16384
  ds_read_b64_tr_b16 a[86:87], v14 offset:17408
  ds_read_b64_tr_b16 a[88:89], v11 offset:24576
  ds_read_b64_tr_b16 a[90:91], v11 offset:25600
  ds_read_b64_tr_b16 a[92:93], v14 offset:24576
  ds_read_b64_tr_b16 a[94:95], v14 offset:25600
  ds_read_b64_tr_b16 a[96:97], v11 offset:32768
  ds_read_b64_tr_b16 a[98:99], v11 offset:33792
  ds_read_b64_tr_b16 a[100:101], v14 offset:32768
  ds_read_b64_tr_b16 a[102:103], v14 offset:33792
  ds_read_b64_tr_b16 a[104:105], v11 offset:40960
  ds_read_b64_tr_b16 a[106:107], v11 offset:41984
  ds_read_b64_tr_b16 a[108:109], v14 offset:40960
  ds_read_b64_tr_b16 a[110:111], v14 offset:41984
  ds_read_b64_tr_b16 a[112:113], v11 offset:49152
  ds_read_b64_tr_b16 a[114:115], v11 offset:50176
  ds_read_b64_tr_b16 a[116:117], v14 offset:49152
  ds_read_b64_tr_b16 a[118:119], v14 offset:50176
  s_waitcnt vmcnt(20)
  s_barrier
  ds_read_b64_tr_b16 a[120:121], v11 offset:57344
  ds_read_b64_tr_b16 a[122:123], v11 offset:58368
  ds_read_b64_tr_b16 a[124:125], v14 offset:57344
  ds_read_b64_tr_b16 a[126:127], v14 offset:58368
  ds_read_b64_tr_b16 a[128:129], v12 offset:0
  ds_read_b64_tr_b16 a[130:131], v12 offset:1024
  ds_read_b64_tr_b16 a[132:133], v15 offset:0
  ds_read_b64_tr_b16 a[134:135], v15 offset:1024
  ds_read_b64_tr_b16 a[136:137], v12 offset:8192
  ds_read_b64_tr_b16 a[138:139], v12 offset:9216
  ds_read_b64_tr_b16 a[140:141], v15 offset:8192
  ds_read_b64_tr_b16 a[142:143], v15 offset:9216
  ds_read_b64_tr_b16 a[144:145], v12 offset:16384
  ds_read_b64_tr_b16 a[146:147], v12 offset:17408
  ds_read_b64_tr_b16 a[148:149], v15 offset:16384
  ds_read_b64_tr_b16 a[150:151], v15 offset:17408
  ds_read_b64_tr_b16 a[152:153], v12 offset:24576
  ds_read_b64_tr_b16 a[154:155], v12 offset:25600
  ds_read_b64_tr_b16 a[156:157], v15 offset:24576
  ds_read_b64_tr_b16 a[158:159], v15 offset:25600
  s_waitcnt lgkmcnt(0)
  s_barrier
  s_load_dwordx2 s[12:13], s[0:1], 72
  s_lshl_b32 s21, s2, 2
  s_add_u32 s21, s21, s20
  s_mul_i32 s50, s21, 6400
  s_add_u32 s51, s50, 4096
  v_lshlrev_b32 v33, 4, v1
  s_mov_b32 s14, 819200
  s_mov_b32 s64, s32
  s_mov_b32 s65, s33
  s_mov_b32 s66, s34
  s_mov_b32 s67, s35
  v_mov_b32 v32, 76
  s_waitcnt lgkmcnt(0)
  v_and_b32 v4, 31, v1
  s_lshl_b32 s21, s20, 5
  v_add_u32 v36, s21, v4
  v_lshrrev_b32 v5, 5, v1
  v_mul_u32_u24 v6, 264, v36
  v_mul_u32_u24 v7, 40, v5
  s_mov_b32 s21, 114952
  v_add3_u32 v34, v6, v7, s21
  v_lshl_add_u32 v38, v5, 3, v34
  v_lshlrev_b32 v6, 5, v5
  v_sub_u32 v39, v34, v6
  v_lshlrev_b32 v35, 3, v1
  v_add_u32 v35, 114688, v35
  v_mov_b32 v37, 0xf149f2ca
  s_mul_i32 s21, s41, 165120
  s_mul_i32 s22, s42, 16512
  s_add_u32 s21, s21, s22
  v_lshl_add_u32 v7, v36, 4, s21
  v_mul_u32_u24 v6, 99072, v5
  v_add_u32 v29, v6, v7
  v_add_u32 v30, 33024, v29
  v_lshl_add_u32 v31, v5, 3, v7
  v_add_u32 v31, 66048, v31
  v_mov_b32 v8, 0
  v_mov_b32 v9, 0
  ds_write_b64 v35, v[8:9] offset:0
  ds_write_b64 v35, v[8:9] offset:512
  ds_write_b64 v35, v[8:9] offset:1024
  ds_write_b64 v35, v[8:9] offset:1536
  ds_write_b64 v35, v[8:9] offset:2048
  s_mul_i32 s24, s42, 1280
  s_mov_b32 s25, 327680
  s_mov_b32 s26, 8
  s_mov_b32 s27, 0
  s_mov_b32 s60, 0x3e64f92e
  s_mov_b32 s61, 0x3fb8aa3b
  s_mov_b32 s62, 0x05040100
  s_mov_b32 s63, 0x07060302
  v_cmp_le_u32 s[76:77], 0, v36
  v_cmp_le_u32 s[78:79], 1, v36
  v_cmp_le_u32 s[80:81], 2, v36
  v_cmp_le_u32 s[82:83], 3, v36
  v_cmp_le_u32 s[84:85], 4, v36
  v_cmp_le_u32 s[86:87], 5, v36
  v_cmp_le_u32 s[88:89], 6, v36
  v_cmp_le_u32 s[90:91], 7, v36
  v_lshrrev_b32 v11, 3, v1
  v_and_b32 v12, 7, v1
  v_xor_b32 v12, v12, v11
  v_mul_u32_u24 v11, 2560, v11
  v_lshl_add_u32 v10, v12, 4, v11
  s_mul_i32 s46, s20, 81920
  v_add_u32 v10, s46, v10
  s_lshl_b32 s47, s20, 12
  s_add_u32 s47, s47, 0
  s_add_u32 s46, s47, 114688
  s_mov_b32 s30, s24
  s_add_u32 s32, s47, 0
  v_add_u32 v11, 19456, v10
  v_add_u32 v12, 38912, v10
  v_add_u32 v13, 58368, v10
  s_mov_b32 m0, s32
  s_nop 0
  buffer_load_dwordx4 v10, s[8:11], s30 offen offset:0 lds
  buffer_load_dwordx4 v11, s[8:11], s30 offen offset:1024 lds
  buffer_load_dwordx4 v12, s[8:11], s30 offen offset:2048 lds
  buffer_load_dwordx4 v13, s[8:11], s30 offen offset:3072 lds
  s_add_u32 s30, s30, 128
  s_add_u32 s32, s32, 16384
  s_cmp_lt_u32 s32, s46
  s_cselect_b32 s32, s32, s47
  s_mov_b32 m0, s32
  s_nop 0
  buffer_load_dwordx4 v10, s[8:11], s30 offen offset:0 lds
  buffer_load_dwordx4 v11, s[8:11], s30 offen offset:1024 lds
  buffer_load_dwordx4 v12, s[8:11], s30 offen offset:2048 lds
  buffer_load_dwordx4 v13, s[8:11], s30 offen offset:3072 lds
  s_add_u32 s30, s30, 128
  s_add_u32 s32, s32, 16384
  s_cmp_lt_u32 s32, s46
  s_cselect_b32 s32, s32, s47
  s_mov_b32 m0, s32
  s_nop 0
  buffer_load_dwordx4 v10, s[8:11], s30 offen offset:0 lds
  buffer_load_dwordx4 v11, s[8:11], s30 offen offset:1024 lds
  buffer_load_dwordx4 v12, s[8:11], s30 offen offset:2048 lds
  buffer_load_dwordx4 v13, s[8:11], s30 offen offset:3072 lds
  s_add_u32 s30, s30, 128
  s_add_u32 s32, s32, 16384
  s_cmp_lt_u32 s32, s46
  s_cselect_b32 s32, s32, s47
  s_mov_b32 m0, s32
  s_nop 0
  buffer_load_dwordx4 v10, s[8:11], s30 offen offset:0 lds
  buffer_load_dwordx4 v11, s[8:11], s30 offen offset:1024 lds
  buffer_load_dwordx4 v12, s[8:11], s30 offen offset:2048 lds
  buffer_load_dwordx4 v13, s[8:11], s30 offen offset:3072 lds
  s_add_u32 s30, s30, 128
  s_add_u32 s32, s32, 16384
  s_cmp_lt_u32 s32, s46
  s_cselect_b32 s32, s32, s47
  s_mov_b32 m0, s32
  s_nop 0
  buffer_load_dwordx4 v10, s[8:11], s30 offen offset:0 lds
  buffer_load_dwordx4 v11, s[8:11], s30 offen offset:1024 lds
  buffer_load_dwordx4 v12, s[8:11], s30 offen offset:2048 lds
  buffer_load_dwordx4 v13, s[8:11], s30 offen offset:3072 lds
  s_add_u32 s30, s30, 128
  s_add_u32 s32, s32, 16384
  s_cmp_lt_u32 s32, s46
  s_cselect_b32 s32, s32, s47
  v_and_b32 v6, 7, v2
  v_add_u32 v4, 0, v3
  v_xor_b32 v4, v4, v6
  v_lshlrev_b32 v4, 4, v4
  v_lshl_add_u32 v14, v2, 7, v4
  v_add_u32 v4, 4, v3
  v_xor_b32 v4, v4, v6
  v_lshlrev_b32 v4, 4, v4
  v_lshl_add_u32 v15, v2, 7, v4
  v_mul_u32_u24 v22, 264, v2
  v_mul_u32_u24 v4, 8, v3
  s_mul_i32 s21, s20, 64
  s_add_u32 s21, s21, 116800
  v_add3_u32 v22, v22, v4, s21
  v_lshlrev_b32 v4, 3, v3
  v_sub_u32 v16, v22, v4
  v_mov_b32 v9, 2731
  s_mov_b32 s33, 0
  s_mov_b32 s48, 0x80000000
  s_mov_b32 m0, s32
  s_nop 0
  buffer_load_dwordx4 v10, s[8:11], s30 offen offset:0 lds
  buffer_load_dwordx4 v11, s[8:11], s30 offen offset:1024 lds
  s_waitcnt vmcnt(18)
  s_barrier
  v_add_u32 v18, s33, v14
  v_add_u32 v19, s33, v15
  s_add_u32 s33, s33, 16384
  s_cmp_lt_u32 s33, 114688
  s_cselect_b32 s33, s33, 0
  ds_read_b128 v[160:163], v18 offset:0
  ds_read_b128 v[164:167], v18 offset:2048
  ds_read_b128 v[168:171], v18 offset:4096
  ds_read_b128 v[172:175], v18 offset:6144
  ds_read_b128 v[176:179], v18 offset:8192
  ds_read_b128 v[180:183], v18 offset:10240
  ds_read_b128 v[184:187], v18 offset:12288
  ds_read_b128 v[188:191], v18 offset:14336
  s_waitcnt lgkmcnt(0)
bf_blk_218:
  v_mfma_f32_16x16x32_bf16 v[64:67], a[0:3], v[160:163], 0
  ds_read_b128 v[192:195], v19 offset:0
  v_mfma_f32_16x16x32_bf16 v[68:71], a[4:7], v[160:163], 0
  v_add_u32 v18, s33, v14
  v_mfma_f32_16x16x32_bf16 v[72:75], a[0:3], v[164:167], 0
  ds_read_b128 v[196:199], v19 offset:2048
  v_mfma_f32_16x16x32_bf16 v[76:79], a[4:7], v[164:167], 0
  buffer_load_dwordx4 v12, s[8:11], s30 offen offset:2048 lds
  v_mfma_f32_16x16x32_bf16 v[80:83], a[0:3], v[168:171], 0
  ds_read_b128 v[200:203], v19 offset:4096
  v_mfma_f32_16x16x32_bf16 v[84:87], a[4:7], v[168:171], 0
  v_mfma_f32_16x16x32_bf16 v[88:91], a[0:3], v[172:175], 0
  ds_read_b128 v[204:207], v19 offset:6144
  v_mfma_f32_16x16x32_bf16 v[92:95], a[4:7], v[172:175], 0
  s_waitcnt lgkmcnt(14)
  v_mfma_f32_16x16x32_bf16 v[96:99], a[0:3], v[176:179], 0
  ds_read_b128 v[208:211], v19 offset:8192
  v_mfma_f32_16x16x32_bf16 v[100:103], a[4:7], v[176:179], 0
  v_mfma_f32_16x16x32_bf16 v[104:107], a[0:3], v[180:183], 0
  ds_read_b128 v[212:215], v19 offset:10240
  v_mfma_f32_16x16x32_bf16 v[108:111], a[4:7], v[180:183], 0
  buffer_load_dwordx4 v13, s[8:11], s30 offen offset:3072 lds
  v_mfma_f32_16x16x32_bf16 v[112:115], a[0:3], v[184:187], 0
  ds_read_b128 v[216:219], v19 offset:12288
  s_add_u32 s30, s30, 128
  v_mfma_f32_16x16x32_bf16 v[116:119], a[4:7], v[184:187], 0
  s_add_u32 m0, m0, 16384
  v_mfma_f32_16x16x32_bf16 v[120:123], a[0:3], v[188:191], 0
  ds_read_b128 v[220:223], v19 offset:14336
  v_mfma_f32_16x16x32_bf16 v[124:127], a[4:7], v[188:191], 0
  s_waitcnt vmcnt(16) lgkmcnt(4)
  s_barrier
  v_mfma_f32_16x16x32_bf16 v[64:67], a[8:11], v[192:195], v[64:67]
  ds_read_b128 v[160:163], v18 offset:0
  v_mfma_f32_16x16x32_bf16 v[68:71], a[12:15], v[192:195], v[68:71]
  s_cmp_lt_u32 m0, s46
  s_cselect_b32 m0, m0, s47
  v_mfma_f32_16x16x32_bf16 v[72:75], a[8:11], v[196:199], v[72:75]
  ds_read_b128 v[164:167], v18 offset:2048
  v_add_u32 v19, s33, v15
  v_mfma_f32_16x16x32_bf16 v[76:79], a[12:15], v[196:199], v[76:79]
  buffer_load_dwordx4 v10, s[8:11], s30 offen offset:0 lds
  v_mfma_f32_16x16x32_bf16 v[80:83], a[8:11], v[200:203], v[80:83]
  ds_read_b128 v[168:171], v18 offset:4096
  s_add_u32 s33, s33, 16384
  v_mfma_f32_16x16x32_bf16 v[84:87], a[12:15], v[200:203], v[84:87]
  s_cmp_lt_u32 s33, 114688
  s_cselect_b32 s33, s33, 0
  v_mfma_f32_16x16x32_bf16 v[88:91], a[8:11], v[204:207], v[88:91]
  ds_read_b128 v[172:175], v18 offset:6144
  v_mfma_f32_16x16x32_bf16 v[92:95], a[12:15], v[204:207], v[92:95]
  s_waitcnt lgkmcnt(4)
  v_mfma_f32_16x16x32_bf16 v[96:99], a[8:11], v[208:211], v[96:99]
  ds_read_b128 v[176:179], v18 offset:8192
  v_mfma_f32_16x16x32_bf16 v[100:103], a[12:15], v[208:211], v[100:103]
  v_mfma_f32_16x16x32_bf16 v[104:107], a[8:11], v[212:215], v[104:107]
  ds_read_b128 v[180:183], v18 offset:10240
  v_mfma_f32_16x16x32_bf16 v[108:111], a[12:15], v[212:215], v[108:111]
  buffer_load_dwordx4 v11, s[8:11], s30 offen offset:1024 lds
  v_mfma_f32_16x16x32_bf16 v[112:115], a[8:11], v[216:219], v[112:115]
  ds_read_b128 v[184:187], v18 offset:12288
  v_mfma_f32_16x16x32_bf16 v[116:119], a[12:15], v[216:219], v[116:119]
  v_mfma_f32_16x16x32_bf16 v[120:123], a[8:11], v[220:223], v[120:123]
  ds_read_b128 v[188:191], v18 offset:14336
  v_mfma_f32_16x16x32_bf16 v[124:127], a[12:15], v[220:223], v[124:127]
  s_waitcnt lgkmcnt(4)
  v_mfma_f32_16x16x32_bf16 v[64:67], a[16:19], v[160:163], v[64:67]
  ds_read_b128 v[192:195], v19 offset:0
  v_mfma_f32_16x16x32_bf16 v[68:71], a[20:23], v[160:163], v[68:71]
  v_add_u32 v18, s33, v14
  v_mfma_f32_16x16x32_bf16 v[72:75], a[16:19], v[164:167], v[72:75]
  ds_read_b128 v[196:199], v19 offset:2048
  v_mfma_f32_16x16x32_bf16 v[76:79], a[20:23], v[164:167], v[76:79]
  buffer_load_dwordx4 v12, s[8:11], s30 offen offset:2048 lds
  v_mfma_f32_16x16x32_bf16 v[80:83], a[16:19], v[168:171], v[80:83]
  ds_read_b128 v[200:203], v19 offset:4096
  v_mfma_f32_16x16x32_bf16 v[84:87], a[20:23], v[168:171], v[84:87]
  v_mfma_f32_16x16x32_bf16 v[88:91], a[16:19], v[172:175], v[88:91]
  ds_read_b128 v[204:207], v19 offset:6144
  v_mfma_f32_16x16x32_bf16 v[92:95], a[20:23], v[172:175], v[92:95]
  s_waitcnt lgkmcnt(4)
  v_mfma_f32_16x16x32_bf16 v[96:99], a[16:19], v[176:179], v[96:99]
  ds_read_b128 v[208:211], v19 offset:8192
  v_mfma_f32_16x16x32_bf16 v[100:103], a[20:23], v[176:179], v[100:103]
  v_mfma_f32_16x16x32_bf16 v[104:107], a[16:19], v[180:183], v[104:107]
  ds_read_b128 v[212:215], v19 offset:10240
  v_mfma_f32_16x16x32_bf16 v[108:111], a[20:23], v[180:183], v[108:111]
  buffer_load_dwordx4 v13, s[8:11], s30 offen offset:3072 lds
  v_mfma_f32_16x16x32_bf16 v[112:115], a[16:19], v[184:187], v[112:115]
  ds_read_b128 v[216:219], v19 offset:12288
  s_add_u32 s30, s30, 128
  v_mfma_f32_16x16x32_bf16 v[116:119], a[20:23], v[184:187], v[116:119]
  s_add_u32 m0, m0, 16384
  v_mfma_f32_16x16x32_bf16 v[120:123], a[16:19], v[188:191], v[120:123]
  ds_read_b128 v[220:223], v19 offset:14336
  v_mfma_f32_16x16x32_bf16 v[124:127], a[20:23], v[188:191], v[124:127]
  s_waitcnt vmcnt(16) lgkmcnt(4)
  s_barrier
  v_mfma_f32_16x16x32_bf16 v[64:67], a[24:27], v[192:195], v[64:67]
  ds_read_b128 v[160:163], v18 offset:0
  v_mfma_f32_16x16x32_bf16 v[68:71], a[28:31], v[192:195], v[68:71]
  s_cmp_lt_u32 m0, s46
  s_cselect_b32 m0, m0, s47
  v_mfma_f32_16x16x32_bf16 v[72:75], a[24:27], v[196:199], v[72:75]
  ds_read_b128 v[164:167], v18 offset:2048
  v_add_u32 v19, s33, v15
  v_mfma_f32_16x16x32_bf16 v[76:79], a[28:31], v[196:199], v[76:79]
  buffer_load_dwordx4 v10, s[8:11], s30 offen offset:0 lds
  v_mfma_f32_16x16x32_bf16 v[80:83], a[24:27], v[200:203], v[80:83]
  ds_read_b128 v[168:171], v18 offset:4096
  s_add_u32 s33, s33, 16384
  v_mfma_f32_16x16x32_bf16 v[84:87], a[28:31], v[200:203], v[84:87]
  s_cmp_lt_u32 s33, 114688
  s_cselect_b32 s33, s33, 0
  v_mfma_f32_16x16x32_bf16 v[88:91], a[24:27], v[204:207], v[88:91]
  ds_read_b128 v[172:175], v18 offset:6144
  v_mfma_f32_16x16x32_bf16 v[92:95], a[28:31], v[204:207], v[92:95]
  s_waitcnt lgkmcnt(4)
  v_mfma_f32_16x16x32_bf16 v[96:99], a[24:27], v[208:211], v[96:99]
  ds_read_b128 v[176:179], v18 offset:8192
  v_mfma_f32_16x16x32_bf16 v[100:103], a[28:31], v[208:211], v[100:103]
  v_mfma_f32_16x16x32_bf16 v[104:107], a[24:27], v[212:215], v[104:107]
  ds_read_b128 v[180:183], v18 offset:10240
  v_mfma_f32_16x16x32_bf16 v[108:111], a[28:31], v[212:215], v[108:111]
  buffer_load_dwordx4 v11, s[8:11], s30 offen offset:1024 lds
  v_mfma_f32_16x16x32_bf16 v[112:115], a[24:27], v[216:219], v[112:115]
  ds_read_b128 v[184:187], v18 offset:12288
  v_mfma_f32_16x16x32_bf16 v[116:119], a[28:31], v[216:219], v[116:119]
  v_mfma_f32_16x16x32_bf16 v[120:123], a[24:27], v[220:223], v[120:123]
  ds_read_b128 v[188:191], v18 offset:14336
  v_mfma_f32_16x16x32_bf16 v[124:127], a[28:31], v[220:223], v[124:127]
  s_waitcnt lgkmcnt(4)
  v_mfma_f32_16x16x32_bf16 v[64:67], a[32:35], v[160:163], v[64:67]
  ds_read_b128 v[192:195], v19 offset:0
  v_mfma_f32_16x16x32_bf16 v[68:71], a[36:39], v[160:163], v[68:71]
  v_add_u32 v18, s33, v14
  v_mfma_f32_16x16x32_bf16 v[72:75], a[32:35], v[164:167], v[72:75]
  ds_read_b128 v[196:199], v19 offset:2048
  v_mfma_f32_16x16x32_bf16 v[76:79], a[36:39], v[164:167], v[76:79]
  buffer_load_dwordx4 v12, s[8:11], s30 offen offset:2048 lds
  v_mfma_f32_16x16x32_bf16 v[80:83], a[32:35], v[168:171], v[80:83]
  ds_read_b128 v[200:203], v19 offset:4096
  v_mfma_f32_16x16x32_bf16 v[84:87], a[36:39], v[168:171], v[84:87]
  v_mfma_f32_16x16x32_bf16 v[88:91], a[32:35], v[172:175], v[88:91]
  ds_read_b128 v[204:207], v19 offset:6144
  v_mfma_f32_16x16x32_bf16 v[92:95], a[36:39], v[172:175], v[92:95]
  s_waitcnt lgkmcnt(4)
  v_mfma_f32_16x16x32_bf16 v[96:99], a[32:35], v[176:179], v[96:99]
  ds_read_b128 v[208:211], v19 offset:8192
  v_mfma_f32_16x16x32_bf16 v[100:103], a[36:39], v[176:179], v[100:103]
  v_mfma_f32_16x16x32_bf16 v[104:107], a[32:35], v[180:183], v[104:107]
  ds_read_b128 v[212:215], v19 offset:10240
  v_mfma_f32_16x16x32_bf16 v[108:111], a[36:39], v[180:183], v[108:111]
  buffer_load_dwordx4 v13, s[8:11], s30 offen offset:3072 lds
  v_mfma_f32_16x16x32_bf16 v[112:115], a[32:35], v[184:187], v[112:115]
  ds_read_b128 v[216:219], v19 offset:12288
  s_add_u32 s30, s30, 128
  v_mfma_f32_16x16x32_bf16 v[116:119], a[36:39], v[184:187], v[116:119]
  s_add_u32 m0, m0, 16384
  v_mfma_f32_16x16x32_bf16 v[120:123], a[32:35], v[188:191], v[120:123]
  ds_read_b128 v[220:223], v19 offset:14336
  v_mfma_f32_16x16x32_bf16 v[124:127], a[36:39], v[188:191], v[124:127]
  s_waitcnt vmcnt(16) lgkmcnt(4)
  s_barrier
  v_mfma_f32_16x16x32_bf16 v[64:67], a[40:43], v[192:195], v[64:67]
  ds_read_b128 v[160:163], v18 offset:0
  v_mfma_f32_16x16x32_bf16 v[68:71], a[44:47], v[192:195], v[68:71]
  s_cmp_lt_u32 m0, s46
  s_cselect_b32 m0, m0, s47
  v_mfma_f32_16x16x32_bf16 v[72:75], a[40:43], v[196:199], v[72:75]
  ds_read_b128 v[164:167], v18 offset:2048
  v_add_u32 v19, s33, v15
  v_mfma_f32_16x16x32_bf16 v[76:79], a[44:47], v[196:199], v[76:79]
  buffer_load_dwordx4 v10, s[8:11], s30 offen offset:0 lds
  v_mfma_f32_16x16x32_bf16 v[80:83], a[40:43], v[200:203], v[80:83]
  ds_read_b128 v[168:171], v18 offset:4096
  s_add_u32 s33, s33, 16384
  v_mfma_f32_16x16x32_bf16 v[84:87], a[44:47], v[200:203], v[84:87]
  s_cmp_lt_u32 s33, 114688
  s_cselect_b32 s33, s33, 0
  v_mfma_f32_16x16x32_bf16 v[88:91], a[40:43], v[204:207], v[88:91]
  ds_read_b128 v[172:175], v18 offset:6144
  v_mfma_f32_16x16x32_bf16 v[92:95], a[44:47], v[204:207], v[92:95]
  s_waitcnt lgkmcnt(4)
  v_mfma_f32_16x16x32_bf16 v[96:99], a[40:43], v[208:211], v[96:99]
  ds_read_b128 v[176:179], v18 offset:8192
  v_mfma_f32_16x16x32_bf16 v[100:103], a[44:47], v[208:211], v[100:103]
  v_mfma_f32_16x16x32_bf16 v[104:107], a[40:43], v[212:215], v[104:107]
  ds_read_b128 v[180:183], v18 offset:10240
  v_mfma_f32_16x16x32_bf16 v[108:111], a[44:47], v[212:215], v[108:111]
  buffer_load_dwordx4 v11, s[8:11], s30 offen offset:1024 lds
  v_mfma_f32_16x16x32_bf16 v[112:115], a[40:43], v[216:219], v[112:115]
  ds_read_b128 v[184:187], v18 offset:12288
  v_mfma_f32_16x16x32_bf16 v[116:119], a[44:47], v[216:219], v[116:119]
  v_mfma_f32_16x16x32_bf16 v[120:123], a[40:43], v[220:223], v[120:123]
  ds_read_b128 v[188:191], v18 offset:14336
  v_mfma_f32_16x16x32_bf16 v[124:127], a[44:47], v[220:223], v[124:127]
  s_waitcnt lgkmcnt(4)
  v_mfma_f32_16x16x32_bf16 v[64:67], a[48:51], v[160:163], v[64:67]
  ds_read_b128 v[192:195], v19 offset:0
  v_mfma_f32_16x16x32_bf16 v[68:71], a[52:55], v[160:163], v[68:71]
  v_add_u32 v18, s33, v14
  v_mfma_f32_16x16x32_bf16 v[72:75], a[48:51], v[164:167], v[72:75]
  ds_read_b128 v[196:199], v19 offset:2048
  v_mfma_f32_16x16x32_bf16 v[76:79], a[52:55], v[164:167], v[76:79]
  buffer_load_dwordx4 v12, s[8:11], s30 offen offset:2048 lds
  v_mfma_f32_16x16x32_bf16 v[80:83], a[48:51], v[168:171], v[80:83]
  ds_read_b128 v[200:203], v19 offset:4096
  v_mfma_f32_16x16x32_bf16 v[84:87], a[52:55], v[168:171], v[84:87]
  v_mfma_f32_16x16x32_bf16 v[88:91], a[48:51], v[172:175], v[88:91]
  ds_read_b128 v[204:207], v19 offset:6144
  v_mfma_f32_16x16x32_bf16 v[92:95], a[52:55], v[172:175], v[92:95]
  s_waitcnt lgkmcnt(4)
  v_mfma_f32_16x16x32_bf16 v[96:99], a[48:51], v[176:179], v[96:99]
  ds_read_b128 v[208:211], v19 offset:8192
  v_mfma_f32_16x16x32_bf16 v[100:103], a[52:55], v[176:179], v[100:103]
  v_mfma_f32_16x16x32_bf16 v[104:107], a[48:51], v[180:183], v[104:107]
  ds_read_b128 v[212:215], v19 offset:10240
  v_mfma_f32_16x16x32_bf16 v[108:111], a[52:55], v[180:183], v[108:111]
  buffer_load_dwordx4 v13, s[8:11], s30 offen offset:3072 lds
  v_mfma_f32_16x16x32_bf16 v[112:115], a[48:51], v[184:187], v[112:115]
  ds_read_b128 v[216:219], v19 offset:12288
  s_add_u32 s30, s30, 128
  v_mfma_f32_16x16x32_bf16 v[116:119], a[52:55], v[184:187], v[116:119]
  s_add_u32 m0, m0, 16384
  v_mfma_f32_16x16x32_bf16 v[120:123], a[48:51], v[188:191], v[120:123]
  ds_read_b128 v[220:223], v19 offset:14336
  v_mfma_f32_16x16x32_bf16 v[124:127], a[52:55], v[188:191], v[124:127]
  s_waitcnt vmcnt(16) lgkmcnt(4)
  s_barrier
  v_mfma_f32_16x16x32_bf16 v[64:67], a[56:59], v[192:195], v[64:67]
  ds_read_b128 v[160:163], v18 offset:0
  v_mfma_f32_16x16x32_bf16 v[68:71], a[60:63], v[192:195], v[68:71]
  s_cmp_lt_u32 m0, s46
  s_cselect_b32 m0, m0, s47
  v_mfma_f32_16x16x32_bf16 v[72:75], a[56:59], v[196:199], v[72:75]
  ds_read_b128 v[164:167], v18 offset:2048
  v_add_u32 v19, s33, v15
  v_mfma_f32_16x16x32_bf16 v[76:79], a[60:63], v[196:199], v[76:79]
  buffer_load_dwordx4 v10, s[8:11], s30 offen offset:0 lds
  v_mfma_f32_16x16x32_bf16 v[80:83], a[56:59], v[200:203], v[80:83]
  ds_read_b128 v[168:171], v18 offset:4096
  s_add_u32 s33, s33, 16384
  v_mfma_f32_16x16x32_bf16 v[84:87], a[60:63], v[200:203], v[84:87]
  s_cmp_lt_u32 s33, 114688
  s_cselect_b32 s33, s33, 0
  v_mfma_f32_16x16x32_bf16 v[88:91], a[56:59], v[204:207], v[88:91]
  ds_read_b128 v[172:175], v18 offset:6144
  v_mfma_f32_16x16x32_bf16 v[92:95], a[60:63], v[204:207], v[92:95]
  s_waitcnt lgkmcnt(4)
  v_mfma_f32_16x16x32_bf16 v[96:99], a[56:59], v[208:211], v[96:99]
  ds_read_b128 v[176:179], v18 offset:8192
  v_mfma_f32_16x16x32_bf16 v[100:103], a[60:63], v[208:211], v[100:103]
  v_mfma_f32_16x16x32_bf16 v[104:107], a[56:59], v[212:215], v[104:107]
  ds_read_b128 v[180:183], v18 offset:10240
  v_mfma_f32_16x16x32_bf16 v[108:111], a[60:63], v[212:215], v[108:111]
  buffer_load_dwordx4 v11, s[8:11], s30 offen offset:1024 lds
  v_mfma_f32_16x16x32_bf16 v[112:115], a[56:59], v[216:219], v[112:115]
  ds_read_b128 v[184:187], v18 offset:12288
  v_mfma_f32_16x16x32_bf16 v[116:119], a[60:63], v[216:219], v[116:119]
  v_mfma_f32_16x16x32_bf16 v[120:123], a[56:59], v[220:223], v[120:123]
  ds_read_b128 v[188:191], v18 offset:14336
  v_mfma_f32_16x16x32_bf16 v[124:127], a[60:63], v[220:223], v[124:127]
  s_waitcnt lgkmcnt(4)
  v_mfma_f32_16x16x32_bf16 v[64:67], a[64:67], v[160:163], v[64:67]
  ds_read_b128 v[192:195], v19 offset:0
  v_mfma_f32_16x16x32_bf16 v[68:71], a[68:71], v[160:163], v[68:71]
  v_add_u32 v18, s33, v14
  v_mfma_f32_16x16x32_bf16 v[72:75], a[64:67], v[164:167], v[72:75]
  ds_read_b128 v[196:199], v19 offset:2048
  v_mfma_f32_16x16x32_bf16 v[76:79], a[68:71], v[164:167], v[76:79]
  buffer_load_dwordx4 v12, s[8:11], s30 offen offset:2048 lds
  v_mfma_f32_16x16x32_bf16 v[80:83], a[64:67], v[168:171], v[80:83]
  ds_read_b128 v[200:203], v19 offset:4096
  v_mfma_f32_16x16x32_bf16 v[84:87], a[68:71], v[168:171], v[84:87]
  v_mfma_f32_16x16x32_bf16 v[88:91], a[64:67], v[172:175], v[88:91]
  ds_read_b128 v[204:207], v19 offset:6144
  v_mfma_f32_16x16x32_bf16 v[92:95], a[68:71], v[172:175], v[92:95]
  s_waitcnt lgkmcnt(4)
  v_mfma_f32_16x16x32_bf16 v[96:99], a[64:67], v[176:179], v[96:99]
  ds_read_b128 v[208:211], v19 offset:8192
  v_mfma_f32_16x16x32_bf16 v[100:103], a[68:71], v[176:179], v[100:103]
  v_mfma_f32_16x16x32_bf16 v[104:107], a[64:67], v[180:183], v[104:107]
  ds_read_b128 v[212:215], v19 offset:10240
  v_mfma_f32_16x16x32_bf16 v[108:111], a[68:71], v[180:183], v[108:111]
  buffer_load_dwordx4 v13, s[8:11], s30 offen offset:3072 lds
  v_mfma_f32_16x16x32_bf16 v[112:115], a[64:67], v[184:187], v[112:115]
  ds_read_b128 v[216:219], v19 offset:12288
  s_add_u32 s30, s30, s25
  v_mfma_f32_16x16x32_bf16 v[116:119], a[68:71], v[184:187], v[116:119]
  s_sub_u32 s30, s30, 1152
  s_add_u32 m0, m0, 16384
  v_mfma_f32_16x16x32_bf16 v[120:123], a[64:67], v[188:191], v[120:123]
  ds_read_b128 v[220:223], v19 offset:14336
  v_mfma_f32_16x16x32_bf16 v[124:127], a[68:71], v[188:191], v[124:127]
  s_waitcnt vmcnt(16) lgkmcnt(4)
  s_barrier
  v_mfma_f32_16x16x32_bf16 v[64:67], a[72:75], v[192:195], v[64:67]
  ds_read_b128 v[160:163], v18 offset:0
  v_mfma_f32_16x16x32_bf16 v[68:71], a[76:79], v[192:195], v[68:71]
  s_cmp_lt_u32 m0, s46
  s_cselect_b32 m0, m0, s47
  v_mfma_f32_16x16x32_bf16 v[72:75], a[72:75], v[196:199], v[72:75]
  ds_read_b128 v[164:167], v18 offset:2048
  v_add_u32 v19, s33, v15
  v_mfma_f32_16x16x32_bf16 v[76:79], a[76:79], v[196:199], v[76:79]
  buffer_load_dwordx4 v10, s[8:11], s30 offen offset:0 lds
  v_mfma_f32_16x16x32_bf16 v[80:83], a[72:75], v[200:203], v[80:83]
  ds_read_b128 v[168:171], v18 offset:4096
  s_add_u32 s33, s33, 16384
  v_mfma_f32_16x16x32_bf16 v[84:87], a[76:79], v[200:203], v[84:87]
  s_cmp_lt_u32 s33, 114688
  s_cselect_b32 s33, s33, 0
  v_mfma_f32_16x16x32_bf16 v[88:91], a[72:75], v[204:207], v[88:91]
  ds_read_b128 v[172:175], v18 offset:6144
  v_mfma_f32_16x16x32_bf16 v[92:95], a[76:79], v[204:207], v[92:95]
  s_waitcnt lgkmcnt(4)
  v_mfma_f32_16x16x32_bf16 v[96:99], a[72:75], v[208:211], v[96:99]
  ds_read_b128 v[176:179], v18 offset:8192
  v_mfma_f32_16x16x32_bf16 v[100:103], a[76:79], v[208:211], v[100:103]
  v_mfma_f32_16x16x32_bf16 v[104:107], a[72:75], v[212:215], v[104:107]
  ds_read_b128 v[180:183], v18 offset:10240
  v_mfma_f32_16x16x32_bf16 v[108:111], a[76:79], v[212:215], v[108:111]
  buffer_load_dwordx4 v11, s[8:11], s30 offen offset:1024 lds
  v_mfma_f32_16x16x32_bf16 v[112:115], a[72:75], v[216:219], v[112:115]
  ds_read_b128 v[184:187], v18 offset:12288
  v_mfma_f32_16x16x32_bf16 v[116:119], a[76:79], v[216:219], v[116:119]
  v_mfma_f32_16x16x32_bf16 v[120:123], a[72:75], v[220:223], v[120:123]
  ds_read_b128 v[188:191], v18 offset:14336
  v_mfma_f32_16x16x32_bf16 v[124:127], a[76:79], v[220:223], v[124:127]
  s_waitcnt lgkmcnt(4)
  v_mfma_f32_16x16x32_bf16 v[64:67], a[80:83], v[160:163], v[64:67]
  ds_read_b128 v[192:195], v19 offset:0
  v_mfma_f32_16x16x32_bf16 v[68:71], a[84:87], v[160:163], v[68:71]
  v_add_u32 v18, s33, v14
  v_mfma_f32_16x16x32_bf16 v[72:75], a[80:83], v[164:167], v[72:75]
  ds_read_b128 v[196:199], v19 offset:2048
  v_mfma_f32_16x16x32_bf16 v[76:79], a[84:87], v[164:167], v[76:79]
  buffer_load_dwordx4 v12, s[8:11], s30 offen offset:2048 lds
  v_mfma_f32_16x16x32_bf16 v[80:83], a[80:83], v[168:171], v[80:83]
  ds_read_b128 v[200:203], v19 offset:4096
  v_mfma_f32_16x16x32_bf16 v[84:87], a[84:87], v[168:171], v[84:87]
  v_mfma_f32_16x16x32_bf16 v[88:91], a[80:83], v[172:175], v[88:91]
  ds_read_b128 v[204:207], v19 offset:6144
  v_mfma_f32_16x16x32_bf16 v[92:95], a[84:87], v[172:175], v[92:95]
  s_waitcnt lgkmcnt(4)
  v_mfma_f32_16x16x32_bf16 v[96:99], a[80:83], v[176:179], v[96:99]
  ds_read_b128 v[208:211], v19 offset:8192
  v_mfma_f32_16x16x32_bf16 v[100:103], a[84:87], v[176:179], v[100:103]
  v_mfma_f32_16x16x32_bf16 v[104:107], a[80:83], v[180:183], v[104:107]
  ds_read_b128 v[212:215], v19 offset:10240
  v_mfma_f32_16x16x32_bf16 v[108:111], a[84:87], v[180:183], v[108:111]
  buffer_load_dwordx4 v13, s[8:11], s30 offen offset:3072 lds
  v_mfma_f32_16x16x32_bf16 v[112:115], a[80:83], v[184:187], v[112:115]
  ds_read_b128 v[216:219], v19 offset:12288
  s_add_u32 s30, s30, 128
  v_mfma_f32_16x16x32_bf16 v[116:119], a[84:87], v[184:187], v[116:119]
  s_add_u32 m0, m0, 16384
  v_mfma_f32_16x16x32_bf16 v[120:123], a[80:83], v[188:191], v[120:123]
  ds_read_b128 v[220:223], v19 offset:14336
  v_mfma_f32_16x16x32_bf16 v[124:127], a[84:87], v[188:191], v[124:127]
  s_waitcnt vmcnt(16) lgkmcnt(4)
  s_barrier
  v_mfma_f32_16x16x32_bf16 v[64:67], a[88:91], v[192:195], v[64:67]
  ds_read_b128 v[160:163], v18 offset:0
  v_mfma_f32_16x16x32_bf16 v[68:71], a[92:95], v[192:195], v[68:71]
  s_cmp_lt_u32 m0, s46
  s_cselect_b32 m0, m0, s47
  v_mfma_f32_16x16x32_bf16 v[72:75], a[88:91], v[196:199], v[72:75]
  ds_read_b128 v[164:167], v18 offset:2048
  v_add_u32 v19, s33, v15
  v_mfma_f32_16x16x32_bf16 v[76:79], a[92:95], v[196:199], v[76:79]
  buffer_load_dwordx4 v10, s[8:11], s30 offen offset:0 lds
  v_mfma_f32_16x16x32_bf16 v[80:83], a[88:91], v[200:203], v[80:83]
  ds_read_b128 v[168:171], v18 offset:4096
  s_add_u32 s33, s33, 16384
  v_mfma_f32_16x16x32_bf16 v[84:87], a[92:95], v[200:203], v[84:87]
  s_cmp_lt_u32 s33, 114688
  s_cselect_b32 s33, s33, 0
  v_mfma_f32_16x16x32_bf16 v[88:91], a[88:91], v[204:207], v[88:91]
  ds_read_b128 v[172:175], v18 offset:6144
  v_mfma_f32_16x16x32_bf16 v[92:95], a[92:95], v[204:207], v[92:95]
  s_waitcnt lgkmcnt(4)
  v_mfma_f32_16x16x32_bf16 v[96:99], a[88:91], v[208:211], v[96:99]
  ds_read_b128 v[176:179], v18 offset:8192
  v_mfma_f32_16x16x32_bf16 v[100:103], a[92:95], v[208:211], v[100:103]
  v_mfma_f32_16x16x32_bf16 v[104:107], a[88:91], v[212:215], v[104:107]
  ds_read_b128 v[180:183], v18 offset:10240
  v_mfma_f32_16x16x32_bf16 v[108:111], a[92:95], v[212:215], v[108:111]
  buffer_load_dwordx4 v11, s[8:11], s30 offen offset:1024 lds
  v_mfma_f32_16x16x32_bf16 v[112:115], a[88:91], v[216:219], v[112:115]
  ds_read_b128 v[184:187], v18 offset:12288
  v_mfma_f32_16x16x32_bf16 v[116:119], a[92:95], v[216:219], v[116:119]
  v_mfma_f32_16x16x32_bf16 v[120:123], a[88:91], v[220:223], v[120:123]
  ds_read_b128 v[188:191], v18 offset:14336
  v_mfma_f32_16x16x32_bf16 v[124:127], a[92:95], v[220:223], v[124:127]
  s_waitcnt lgkmcnt(4)
  v_mfma_f32_16x16x32_bf16 v[64:67], a[96:99], v[160:163], v[64:67]
  ds_read_b128 v[192:195], v19 offset:0
  v_mfma_f32_16x16x32_bf16 v[68:71], a[100:103], v[160:163], v[68:71]
  v_add_u32 v18, s33, v14
  v_mfma_f32_16x16x32_bf16 v[72:75], a[96:99], v[164:167], v[72:75]
  ds_read_b128 v[196:199], v19 offset:2048
  v_mfma_f32_16x16x32_bf16 v[76:79], a[100:103], v[164:167], v[76:79]
  buffer_load_dwordx4 v12, s[8:11], s30 offen offset:2048 lds
  v_mfma_f32_16x16x32_bf16 v[80:83], a[96:99], v[168:171], v[80:83]
  ds_read_b128 v[200:203], v19 offset:4096
  v_mfma_f32_16x16x32_bf16 v[84:87], a[100:103], v[168:171], v[84:87]
  v_mfma_f32_16x16x32_bf16 v[88:91], a[96:99], v[172:175], v[88:91]
  ds_read_b128 v[204:207], v19 offset:6144
  v_mfma_f32_16x16x32_bf16 v[92:95], a[100:103], v[172:175], v[92:95]
  s_waitcnt lgkmcnt(4)
  v_mfma_f32_16x16x32_bf16 v[96:99], a[96:99], v[176:179], v[96:99]
  ds_read_b128 v[208:211], v19 offset:8192
  v_mfma_f32_16x16x32_bf16 v[100:103], a[100:103], v[176:179], v[100:103]
  v_mfma_f32_16x16x32_bf16 v[104:107], a[96:99], v[180:183], v[104:107]
  ds_read_b128 v[212:215], v19 offset:10240
  v_mfma_f32_16x16x32_bf16 v[108:111], a[100:103], v[180:183], v[108:111]
  buffer_load_dwordx4 v13, s[8:11], s30 offen offset:3072 lds
  v_mfma_f32_16x16x32_bf16 v[112:115], a[96:99], v[184:187], v[112:115]
  ds_read_b128 v[216:219], v19 offset:12288
  s_add_u32 s30, s30, 128
  v_mfma_f32_16x16x32_bf16 v[116:119], a[100:103], v[184:187], v[116:119]
  s_add_u32 m0, m0, 16384
  v_mfma_f32_16x16x32_bf16 v[120:123], a[96:99], v[188:191], v[120:123]
  ds_read_b128 v[220:223], v19 offset:14336
  v_mfma_f32_16x16x32_bf16 v[124:127], a[100:103], v[188:191], v[124:127]
  s_waitcnt vmcnt(16) lgkmcnt(4)
  s_barrier
  v_mfma_f32_16x16x32_bf16 v[64:67], a[104:107], v[192:195], v[64:67]
  ds_read_b128 v[160:163], v18 offset:0
  v_mfma_f32_16x16x32_bf16 v[68:71], a[108:111], v[192:195], v[68:71]
  s_cmp_lt_u32 m0, s46
  s_cselect_b32 m0, m0, s47
  v_mfma_f32_16x16x32_bf16 v[72:75], a[104:107], v[196:199], v[72:75]
  ds_read_b128 v[164:167], v18 offset:2048
  v_add_u32 v19, s33, v15
  v_mfma_f32_16x16x32_bf16 v[76:79], a[108:111], v[196:199], v[76:79]
  buffer_load_dwordx4 v10, s[8:11], s30 offen offset:0 lds
  v_mfma_f32_16x16x32_bf16 v[80:83], a[104:107], v[200:203], v[80:83]
  ds_read_b128 v[168:171], v18 offset:4096
  s_add_u32 s33, s33, 16384
  v_mfma_f32_16x16x32_bf16 v[84:87], a[108:111], v[200:203], v[84:87]
  s_cmp_lt_u32 s33, 114688
  s_cselect_b32 s33, s33, 0
  v_mfma_f32_16x16x32_bf16 v[88:91], a[104:107], v[204:207], v[88:91]
  ds_read_b128 v[172:175], v18 offset:6144
  v_mfma_f32_16x16x32_bf16 v[92:95], a[108:111], v[204:207], v[92:95]
  s_waitcnt lgkmcnt(4)
  v_mfma_f32_16x16x32_bf16 v[96:99], a[104:107], v[208:211], v[96:99]
  ds_read_b128 v[176:179], v18 offset:8192
  v_mfma_f32_16x16x32_bf16 v[100:103], a[108:111], v[208:211], v[100:103]
  v_mfma_f32_16x16x32_bf16 v[104:107], a[104:107], v[212:215], v[104:107]
  ds_read_b128 v[180:183], v18 offset:10240
  v_mfma_f32_16x16x32_bf16 v[108:111], a[108:111], v[212:215], v[108:111]
  buffer_load_dwordx4 v11, s[8:11], s30 offen offset:1024 lds
  v_mfma_f32_16x16x32_bf16 v[112:115], a[104:107], v[216:219], v[112:115]
  ds_read_b128 v[184:187], v18 offset:12288
  v_mfma_f32_16x16x32_bf16 v[116:119], a[108:111], v[216:219], v[116:119]
  v_mfma_f32_16x16x32_bf16 v[120:123], a[104:107], v[220:223], v[120:123]
  ds_read_b128 v[188:191], v18 offset:14336
  v_mfma_f32_16x16x32_bf16 v[124:127], a[108:111], v[220:223], v[124:127]
  s_waitcnt lgkmcnt(4)
  v_mfma_f32_16x16x32_bf16 v[64:67], a[112:115], v[160:163], v[64:67]
  ds_read_b128 v[192:195], v19 offset:0
  v_mfma_f32_16x16x32_bf16 v[68:71], a[116:119], v[160:163], v[68:71]
  v_add_u32 v18, s33, v14
  v_mfma_f32_16x16x32_bf16 v[72:75], a[112:115], v[164:167], v[72:75]
  ds_read_b128 v[196:199], v19 offset:2048
  v_mfma_f32_16x16x32_bf16 v[76:79], a[116:119], v[164:167], v[76:79]
  buffer_load_dwordx4 v12, s[8:11], s30 offen offset:2048 lds
  v_mfma_f32_16x16x32_bf16 v[80:83], a[112:115], v[168:171], v[80:83]
  ds_read_b128 v[200:203], v19 offset:4096
  v_mfma_f32_16x16x32_bf16 v[84:87], a[116:119], v[168:171], v[84:87]
  v_mfma_f32_16x16x32_bf16 v[88:91], a[112:115], v[172:175], v[88:91]
  ds_read_b128 v[204:207], v19 offset:6144
  v_mfma_f32_16x16x32_bf16 v[92:95], a[116:119], v[172:175], v[92:95]
  s_waitcnt lgkmcnt(4)
  v_mfma_f32_16x16x32_bf16 v[96:99], a[112:115], v[176:179], v[96:99]
  ds_read_b128 v[208:211], v19 offset:8192
  v_mfma_f32_16x16x32_bf16 v[100:103], a[116:119], v[176:179], v[100:103]
  v_mfma_f32_16x16x32_bf16 v[104:107], a[112:115], v[180:183], v[104:107]
  ds_read_b128 v[212:215], v19 offset:10240
  v_mfma_f32_16x16x32_bf16 v[108:111], a[116:119], v[180:183], v[108:111]
  buffer_load_dwordx4 v13, s[8:11], s30 offen offset:3072 lds
  v_mfma_f32_16x16x32_bf16 v[112:115], a[112:115], v[184:187], v[112:115]
  ds_read_b128 v[216:219], v19 offset:12288
  s_add_u32 s30, s30, 128
  v_mfma_f32_16x16x32_bf16 v[116:119], a[116:119], v[184:187], v[116:119]
  s_add_u32 m0, m0, 16384
  v_mfma_f32_16x16x32_bf16 v[120:123], a[112:115], v[188:191], v[120:123]
  ds_read_b128 v[220:223], v19 offset:14336
  v_mfma_f32_16x16x32_bf16 v[124:127], a[116:119], v[188:191], v[124:127]
  s_waitcnt vmcnt(16) lgkmcnt(4)
  s_barrier
  v_mfma_f32_16x16x32_bf16 v[64:67], a[120:123], v[192:195], v[64:67]
  ds_read_b128 v[160:163], v18 offset:0
  v_mfma_f32_16x16x32_bf16 v[68:71], a[124:127], v[192:195], v[68:71]
  s_cmp_lt_u32 m0, s46
  s_cselect_b32 m0, m0, s47
  v_mfma_f32_16x16x32_bf16 v[72:75], a[120:123], v[196:199], v[72:75]
  ds_read_b128 v[164:167], v18 offset:2048
  v_add_u32 v19, s33, v15
  v_mfma_f32_16x16x32_bf16 v[76:79], a[124:127], v[196:199], v[76:79]
  buffer_load_dwordx4 v10, s[8:11], s30 offen offset:0 lds
  v_mfma_f32_16x16x32_bf16 v[80:83], a[120:123], v[200:203], v[80:83]
  ds_read_b128 v[168:171], v18 offset:4096
  s_add_u32 s33, s33, 16384
  v_mfma_f32_16x16x32_bf16 v[84:87], a[124:127], v[200:203], v[84:87]
  s_cmp_lt_u32 s33, 114688
  s_cselect_b32 s33, s33, 0
  v_mfma_f32_16x16x32_bf16 v[88:91], a[120:123], v[204:207], v[88:91]
  ds_read_b128 v[172:175], v18 offset:6144
  v_mfma_f32_16x16x32_bf16 v[92:95], a[124:127], v[204:207], v[92:95]
  s_waitcnt lgkmcnt(4)
  v_mfma_f32_16x16x32_bf16 v[96:99], a[120:123], v[208:211], v[96:99]
  ds_read_b128 v[176:179], v18 offset:8192
  v_mfma_f32_16x16x32_bf16 v[100:103], a[124:127], v[208:211], v[100:103]
  v_mfma_f32_16x16x32_bf16 v[104:107], a[120:123], v[212:215], v[104:107]
  ds_read_b128 v[180:183], v18 offset:10240
  v_mfma_f32_16x16x32_bf16 v[108:111], a[124:127], v[212:215], v[108:111]
  buffer_load_dwordx4 v11, s[8:11], s30 offen offset:1024 lds
  v_mfma_f32_16x16x32_bf16 v[112:115], a[120:123], v[216:219], v[112:115]
  ds_read_b128 v[184:187], v18 offset:12288
  v_mfma_f32_16x16x32_bf16 v[116:119], a[124:127], v[216:219], v[116:119]
  v_mfma_f32_16x16x32_bf16 v[120:123], a[120:123], v[220:223], v[120:123]
  ds_read_b128 v[188:191], v18 offset:14336
  v_mfma_f32_16x16x32_bf16 v[124:127], a[124:127], v[220:223], v[124:127]
  s_waitcnt lgkmcnt(4)
  v_mfma_f32_16x16x32_bf16 v[64:67], a[128:131], v[160:163], v[64:67]
  ds_read_b128 v[192:195], v19 offset:0
  v_mfma_f32_16x16x32_bf16 v[68:71], a[132:135], v[160:163], v[68:71]
  v_add_u32 v18, s33, v14
  v_mfma_f32_16x16x32_bf16 v[72:75], a[128:131], v[164:167], v[72:75]
  ds_read_b128 v[196:199], v19 offset:2048
  v_mfma_f32_16x16x32_bf16 v[76:79], a[132:135], v[164:167], v[76:79]
  buffer_load_dwordx4 v12, s[8:11], s30 offen offset:2048 lds
  v_mfma_f32_16x16x32_bf16 v[80:83], a[128:131], v[168:171], v[80:83]
  ds_read_b128 v[200:203], v19 offset:4096
  v_mfma_f32_16x16x32_bf16 v[84:87], a[132:135], v[168:171], v[84:87]
  v_mfma_f32_16x16x32_bf16 v[88:91], a[128:131], v[172:175], v[88:91]
  ds_read_b128 v[204:207], v19 offset:6144
  v_mfma_f32_16x16x32_bf16 v[92:95], a[132:135], v[172:175], v[92:95]
  s_waitcnt lgkmcnt(4)
  v_mfma_f32_16x16x32_bf16 v[96:99], a[128:131], v[176:179], v[96:99]
  ds_read_b128 v[208:211], v19 offset:8192
  v_mfma_f32_16x16x32_bf16 v[100:103], a[132:135], v[176:179], v[100:103]
  v_mfma_f32_16x16x32_bf16 v[104:107], a[128:131], v[180:183], v[104:107]
  ds_read_b128 v[212:215], v19 offset:10240
  v_mfma_f32_16x16x32_bf16 v[108:111], a[132:135], v[180:183], v[108:111]
  buffer_load_dwordx4 v13, s[8:11], s30 offen offset:3072 lds
  v_mfma_f32_16x16x32_bf16 v[112:115], a[128:131], v[184:187], v[112:115]
  ds_read_b128 v[216:219], v19 offset:12288
  s_add_u32 s30, s30, 128
  v_mfma_f32_16x16x32_bf16 v[116:119], a[132:135], v[184:187], v[116:119]
  s_add_u32 m0, m0, 16384
  v_mfma_f32_16x16x32_bf16 v[120:123], a[128:131], v[188:191], v[120:123]
  ds_read_b128 v[220:223], v19 offset:14336
  v_mfma_f32_16x16x32_bf16 v[124:127], a[132:135], v[188:191], v[124:127]
  s_waitcnt vmcnt(16) lgkmcnt(4)
  s_barrier
  v_mfma_f32_16x16x32_bf16 v[64:67], a[136:139], v[192:195], v[64:67]
  ds_read_b128 v[160:163], v18 offset:0
  v_mfma_f32_16x16x32_bf16 v[68:71], a[140:143], v[192:195], v[68:71]
  s_cmp_lt_u32 m0, s46
  s_cselect_b32 m0, m0, s47
  v_mfma_f32_16x16x32_bf16 v[72:75], a[136:139], v[196:199], v[72:75]
  ds_read_b128 v[164:167], v18 offset:2048
  v_add_u32 v19, s33, v15
  v_mfma_f32_16x16x32_bf16 v[76:79], a[140:143], v[196:199], v[76:79]
  buffer_load_dwordx4 v10, s[8:11], s30 offen offset:0 lds
  v_mfma_f32_16x16x32_bf16 v[80:83], a[136:139], v[200:203], v[80:83]
  ds_read_b128 v[168:171], v18 offset:4096
  s_add_u32 s33, s33, 16384
  v_mfma_f32_16x16x32_bf16 v[84:87], a[140:143], v[200:203], v[84:87]
  s_cmp_lt_u32 s33, 114688
  s_cselect_b32 s33, s33, 0
  v_mfma_f32_16x16x32_bf16 v[88:91], a[136:139], v[204:207], v[88:91]
  ds_read_b128 v[172:175], v18 offset:6144
  v_mfma_f32_16x16x32_bf16 v[92:95], a[140:143], v[204:207], v[92:95]
  s_waitcnt lgkmcnt(4)
  v_mfma_f32_16x16x32_bf16 v[96:99], a[136:139], v[208:211], v[96:99]
  ds_read_b128 v[176:179], v18 offset:8192
  v_mfma_f32_16x16x32_bf16 v[100:103], a[140:143], v[208:211], v[100:103]
  v_mfma_f32_16x16x32_bf16 v[104:107], a[136:139], v[212:215], v[104:107]
  ds_read_b128 v[180:183], v18 offset:10240
  v_mfma_f32_16x16x32_bf16 v[108:111], a[140:143], v[212:215], v[108:111]
  buffer_load_dwordx4 v11, s[8:11], s30 offen offset:1024 lds
  v_mfma_f32_16x16x32_bf16 v[112:115], a[136:139], v[216:219], v[112:115]
  ds_read_b128 v[184:187], v18 offset:12288
  v_mfma_f32_16x16x32_bf16 v[116:119], a[140:143], v[216:219], v[116:119]
  v_mfma_f32_16x16x32_bf16 v[120:123], a[136:139], v[220:223], v[120:123]
  ds_read_b128 v[188:191], v18 offset:14336
  v_mfma_f32_16x16x32_bf16 v[124:127], a[140:143], v[220:223], v[124:127]
  s_waitcnt lgkmcnt(4)
  v_mfma_f32_16x16x32_bf16 v[64:67], a[144:147], v[160:163], v[64:67]
  ds_read_b128 v[192:195], v19 offset:0
  v_mfma_f32_16x16x32_bf16 v[68:71], a[148:151], v[160:163], v[68:71]
  v_add_u32 v18, s33, v14
  v_mfma_f32_16x16x32_bf16 v[72:75], a[144:147], v[164:167], v[72:75]
  ds_read_b128 v[196:199], v19 offset:2048
  v_mfma_f32_16x16x32_bf16 v[76:79], a[148:151], v[164:167], v[76:79]
  buffer_load_dwordx4 v12, s[8:11], s30 offen offset:2048 lds
  v_mfma_f32_16x16x32_bf16 v[80:83], a[144:147], v[168:171], v[80:83]
  ds_read_b128 v[200:203], v19 offset:4096
  v_mfma_f32_16x16x32_bf16 v[84:87], a[148:151], v[168:171], v[84:87]
  v_mfma_f32_16x16x32_bf16 v[88:91], a[144:147], v[172:175], v[88:91]
  ds_read_b128 v[204:207], v19 offset:6144
  v_mfma_f32_16x16x32_bf16 v[92:95], a[148:151], v[172:175], v[92:95]
  s_waitcnt lgkmcnt(4)
  v_mfma_f32_16x16x32_bf16 v[96:99], a[144:147], v[176:179], v[96:99]
  ds_read_b128 v[208:211], v19 offset:8192
  v_mfma_f32_16x16x32_bf16 v[100:103], a[148:151], v[176:179], v[100:103]
  v_mfma_f32_16x16x32_bf16 v[104:107], a[144:147], v[180:183], v[104:107]
  ds_read_b128 v[212:215], v19 offset:10240
  v_mfma_f32_16x16x32_bf16 v[108:111], a[148:151], v[180:183], v[108:111]
  buffer_load_dwordx4 v13, s[8:11], s30 offen offset:3072 lds
  v_mfma_f32_16x16x32_bf16 v[112:115], a[144:147], v[184:187], v[112:115]
  ds_read_b128 v[216:219], v19 offset:12288
  s_add_u32 s30, s30, 128
  v_mfma_f32_16x16x32_bf16 v[116:119], a[148:151], v[184:187], v[116:119]
  s_add_u32 m0, m0, 16384
  v_mfma_f32_16x16x32_bf16 v[120:123], a[144:147], v[188:191], v[120:123]
  ds_read_b128 v[220:223], v19 offset:14336
  v_mfma_f32_16x16x32_bf16 v[124:127], a[148:151], v[188:191], v[124:127]
  s_waitcnt vmcnt(16) lgkmcnt(4)
  s_barrier
  v_mfma_f32_16x16x32_bf16 v[64:67], a[152:155], v[192:195], v[64:67]
  ds_read_b128 v[160:163], v18 offset:0
  v_mfma_f32_16x16x32_bf16 v[68:71], a[156:159], v[192:195], v[68:71]
  s_cmp_lt_u32 m0, s46
  s_cselect_b32 m0, m0, s47
  v_mfma_f32_16x16x32_bf16 v[72:75], a[152:155], v[196:199], v[72:75]
  ds_read_b128 v[164:167], v18 offset:2048
  v_add_u32 v19, s33, v15
  v_mfma_f32_16x16x32_bf16 v[76:79], a[156:159], v[196:199], v[76:79]
  buffer_load_dwordx4 v10, s[8:11], s30 offen offset:0 lds
  v_cvt_pk_bf16_f32 v224, v64, v65
  v_cvt_pk_bf16_f32 v225, v66, v67
  v_mfma_f32_16x16x32_bf16 v[80:83], a[152:155], v[200:203], v[80:83]
  ds_read_b128 v[168:171], v18 offset:4096
  s_add_u32 s33, s33, 16384
  v_cvt_pk_bf16_f32 v226, v68, v69
  v_cvt_pk_bf16_f32 v227, v70, v71
  v_mfma_f32_16x16x32_bf16 v[84:87], a[156:159], v[200:203], v[84:87]
  s_cmp_lt_u32 s33, 114688
  s_cselect_b32 s33, s33, 0
  ds_write_b64 v22, v[224:225] offset:0
  v_mfma_f32_16x16x32_bf16 v[88:91], a[152:155], v[204:207], v[88:91]
  ds_read_b128 v[172:175], v18 offset:6144
  ds_write_b64 v22, v[226:227] offset:32
  v_cvt_pk_bf16_f32 v230, v72, v73
  v_mfma_f32_16x16x32_bf16 v[92:95], a[156:159], v[204:207], v[92:95]
  s_waitcnt lgkmcnt(6)
  v_cvt_pk_bf16_f32 v231, v74, v75
  v_cvt_pk_bf16_f32 v232, v76, v77
  v_cvt_pk_bf16_f32 v233, v78, v79
  v_mfma_f32_16x16x32_bf16 v[96:99], a[152:155], v[208:211], v[96:99]
  ds_read_b128 v[176:179], v18 offset:8192
  ds_write_b64 v22, v[230:231] offset:4224
  v_mfma_f32_16x16x32_bf16 v[100:103], a[156:159], v[208:211], v[100:103]
  ds_write_b64 v22, v[232:233] offset:4256
  v_cvt_pk_bf16_f32 v224, v80, v81
  v_cvt_pk_bf16_f32 v225, v82, v83
  v_mfma_f32_16x16x32_bf16 v[104:107], a[152:155], v[212:215], v[104:107]
  ds_read_b128 v[180:183], v18 offset:10240
  v_cvt_pk_bf16_f32 v226, v84, v85
  v_cvt_pk_bf16_f32 v227, v86, v87
  v_mfma_f32_16x16x32_bf16 v[108:111], a[156:159], v[212:215], v[108:111]
  buffer_load_dwordx4 v11, s[8:11], s30 offen offset:1024 lds
  ds_write_b64 v22, v[224:225] offset:8448
  v_mfma_f32_16x16x32_bf16 v[112:115], a[152:155], v[216:219], v[112:115]
  ds_read_b128 v[184:187], v18 offset:12288
  ds_write_b64 v22, v[226:227] offset:8480
  v_cvt_pk_bf16_f32 v230, v88, v89
  v_mfma_f32_16x16x32_bf16 v[116:119], a[156:159], v[216:219], v[116:119]
  v_cvt_pk_bf16_f32 v231, v90, v91
  v_cvt_pk_bf16_f32 v232, v92, v93
  v_cvt_pk_bf16_f32 v233, v94, v95
  v_mfma_f32_16x16x32_bf16 v[120:123], a[152:155], v[220:223], v[120:123]
  ds_read_b128 v[188:191], v18 offset:14336
  ds_write_b64 v22, v[230:231] offset:12672
  v_mfma_f32_16x16x32_bf16 v[124:127], a[156:159], v[220:223], v[124:127]
  ds_write_b64 v22, v[232:233] offset:12704
  v_cvt_pk_bf16_f32 v224, v96, v97
  v_cvt_pk_bf16_f32 v225, v98, v99
bf_end_219:
  v_cvt_pk_bf16_f32 v226, v100, v101
  v_cvt_pk_bf16_f32 v227, v102, v103
  ds_write_b64 v22, v[224:225] offset:16896
  ds_write_b64 v22, v[226:227] offset:16928
  v_cvt_pk_bf16_f32 v230, v104, v105
  v_cvt_pk_bf16_f32 v231, v106, v107
  v_cvt_pk_bf16_f32 v232, v108, v109
  v_cvt_pk_bf16_f32 v233, v110, v111
  ds_write_b64 v22, v[230:231] offset:21120
  ds_write_b64 v22, v[232:233] offset:21152
  v_cvt_pk_bf16_f32 v224, v112, v113
  v_cvt_pk_bf16_f32 v225, v114, v115
  v_cvt_pk_bf16_f32 v226, v116, v117
  v_cvt_pk_bf16_f32 v227, v118, v119
  ds_write_b64 v22, v[224:225] offset:25344
  ds_write_b64 v22, v[226:227] offset:25376
  v_cvt_pk_bf16_f32 v230, v120, v121
  v_cvt_pk_bf16_f32 v231, v122, v123
  v_cvt_pk_bf16_f32 v232, v124, v125
  v_cvt_pk_bf16_f32 v233, v126, v127
  ds_write_b64 v22, v[230:231] offset:29568
  ds_write_b64 v22, v[232:233] offset:29600
  s_cmp_lg_u32 s26, 6
  s_cbranch_scc1 bw_220
  buffer_load_dword v32, v32, s[64:67], 0 offen sc1
  buffer_load_dwordx4 v[40:43], v33, s[12:15], s50 offen offset:0
  buffer_load_dwordx4 v[40:43], v33, s[12:15], s50 offen offset:1024
  buffer_load_dwordx4 v[40:43], v33, s[12:15], s50 offen offset:2048
  buffer_load_dwordx4 v[40:43], v33, s[12:15], s50 offen offset:3072
  buffer_load_dwordx4 v[40:43], v33, s[12:15], s51 offen offset:0
  buffer_load_dwordx4 v[40:43], v33, s[12:15], s51 offen offset:1024
  buffer_load_dwordx4 v[40:43], v33, s[12:15], s51 offen offset:2048
bw_220:
  s_waitcnt lgkmcnt(0)
  s_barrier
  ds_read_b64 v[144:145], v34 offset:1848
  ds_read_b64 v[146:147], v34 offset:1856
  ds_read_b64 v[148:149], v34 offset:1864
  ds_read_b64 v[150:151], v34 offset:1872
  ds_read_b64 v[152:153], v34 offset:1880
  ds_read_b64 v[64:65], v34 offset:1928
  ds_read_b64 v[66:67], v34 offset:1936
  ds_read_b64 v[68:69], v34 offset:1944
  ds_read_b64 v[70:71], v34 offset:1952
  ds_read_b64 v[72:73], v34 offset:1960
  ds_read_b64 v[74:75], v34 offset:1664
  ds_read_b64 v[76:77], v34 offset:1672
  ds_read_b64 v[78:79], v34 offset:1680
  ds_read_b64 v[80:81], v34 offset:1688
  ds_read_b64 v[82:83], v34 offset:1696
  ds_read_b64 v[84:85], v34 offset:1400
  ds_read_b64 v[86:87], v34 offset:1408
  ds_read_b64 v[88:89], v34 offset:1416
  ds_read_b64 v[90:91], v34 offset:1424
  ds_read_b64 v[92:93], v34 offset:1432
  ds_read_b64 v[94:95], v34 offset:1136
  ds_read_b64 v[96:97], v34 offset:1144
  ds_read_b64 v[98:99], v34 offset:1152
  ds_read_b64 v[100:101], v34 offset:1160
  ds_read_b64 v[102:103], v34 offset:1168
  ds_read_b64 v[104:105], v34 offset:872
  ds_read_b64 v[106:107], v34 offset:880
  ds_read_b64 v[108:109], v34 offset:888
  ds_read_b64 v[110:111], v34 offset:896
  ds_read_b64 v[112:113], v34 offset:904
  v_mov_b32 v224, 0
  v_mov_b32 v225, 0
  ds_read_b64 v[114:115], v34 offset:608
  ds_read_b64 v[116:117], v34 offset:616
  ds_read_b64 v[118:119], v34 offset:624
  ds_read_b64 v[120:121], v34 offset:632
  ds_read_b64 v[122:123], v34 offset:640
  v_mov_b32 v226, 0
  v_mov_b32 v227, 0
  ds_read_b64 v[124:125], v34 offset:344
  ds_read_b64 v[126:127], v34 offset:352
  ds_read_b64 v[128:129], v34 offset:360
  ds_read_b64 v[130:131], v34 offset:368
  ds_read_b64 v[132:133], v34 offset:376
  v_mov_b32 v228, 0
  v_mov_b32 v229, 0
  ds_read_b64 v[134:135], v34 offset:80
  ds_read_b64 v[136:137], v34 offset:88
  ds_read_b64 v[138:139], v34 offset:96
  ds_read_b64 v[140:141], v34 offset:104
  ds_read_b64 v[142:143], v34 offset:112
  v_mov_b32 v230, 0
  v_mov_b32 v231, 0
  v_mov_b32 v192, 0
  v_mov_b32 v193, 0
  v_mov_b32 v194, 0
  v_mov_b32 v195, 0
  v_mov_b32 v196, 0
  v_mov_b32 v197, 0
  v_mov_b32 v198, 0
  v_mov_b32 v199, 0
  v_mov_b32 v200, 0
  v_mov_b32 v201, 0
  v_mov_b32 v202, 0
  v_mov_b32 v203, 0
  v_mov_b32 v204, 0
  v_mov_b32 v205, 0
  v_mov_b32 v206, 0
  v_mov_b32 v207, 0
  v_mov_b32 v208, 0
  v_mov_b32 v209, 0
  v_mov_b32 v210, 0
  v_mov_b32 v211, 0
  s_waitcnt lgkmcnt(15)
  v_dot2c_f32_bf16 v224, v64, v144
  v_dot2c_f32_bf16 v225, v74, v144
  v_dot2c_f32_bf16 v226, v84, v144
  v_dot2c_f32_bf16 v227, v94, v144
  v_dot2c_f32_bf16 v228, v104, v144
  v_dot2c_f32_bf16 v224, v65, v145
  v_dot2c_f32_bf16 v225, v75, v145
  v_dot2c_f32_bf16 v226, v85, v145
  v_dot2c_f32_bf16 v227, v95, v145
  v_dot2c_f32_bf16 v228, v105, v145
  v_dot2c_f32_bf16 v224, v66, v146
  v_dot2c_f32_bf16 v225, v76, v146
  v_dot2c_f32_bf16 v226, v86, v146
  v_dot2c_f32_bf16 v227, v96, v146
  v_dot2c_f32_bf16 v228, v106, v146
  v_dot2c_f32_bf16 v224, v67, v147
  v_dot2c_f32_bf16 v225, v77, v147
  v_dot2c_f32_bf16 v226, v87, v147
  v_dot2c_f32_bf16 v227, v97, v147
  v_dot2c_f32_bf16 v228, v107, v147
  v_dot2c_f32_bf16 v224, v68, v148
  v_dot2c_f32_bf16 v225, v78, v148
  v_dot2c_f32_bf16 v226, v88, v148
  v_dot2c_f32_bf16 v227, v98, v148
  v_dot2c_f32_bf16 v228, v108, v148
  v_dot2c_f32_bf16 v224, v69, v149
  v_dot2c_f32_bf16 v225, v79, v149
  v_dot2c_f32_bf16 v226, v89, v149
  v_dot2c_f32_bf16 v227, v99, v149
  v_dot2c_f32_bf16 v228, v109, v149
  v_dot2c_f32_bf16 v224, v70, v150
  v_dot2c_f32_bf16 v225, v80, v150
  v_dot2c_f32_bf16 v226, v90, v150
  v_dot2c_f32_bf16 v227, v100, v150
  v_dot2c_f32_bf16 v228, v110, v150
  v_dot2c_f32_bf16 v224, v71, v151
  v_dot2c_f32_bf16 v225, v81, v151
  v_dot2c_f32_bf16 v226, v91, v151
  v_dot2c_f32_bf16 v227, v101, v151
  v_dot2c_f32_bf16 v228, v111, v151
  v_dot2c_f32_bf16 v224, v72, v152
  v_dot2c_f32_bf16 v225, v82, v152
  v_dot2c_f32_bf16 v226, v92, v152
  v_dot2c_f32_bf16 v227, v102, v152
  v_dot2c_f32_bf16 v228, v112, v152
  v_dot2c_f32_bf16 v224, v73, v153
  v_dot2c_f32_bf16 v225, v83, v153
  v_dot2c_f32_bf16 v226, v93, v153
  v_dot2c_f32_bf16 v227, v103, v153
  v_dot2c_f32_bf16 v228, v113, v153
  s_waitcnt lgkmcnt(0)
  v_dot2c_f32_bf16 v229, v114, v144
  v_dot2c_f32_bf16 v230, v124, v144
  v_dot2c_f32_bf16 v231, v134, v144
  v_dot2c_f32_bf16 v229, v115, v145
  v_dot2c_f32_bf16 v230, v125, v145
  v_dot2c_f32_bf16 v231, v135, v145
  v_dot2c_f32_bf16 v229, v116, v146
  v_dot2c_f32_bf16 v230, v126, v146
  v_dot2c_f32_bf16 v231, v136, v146
  v_dot2c_f32_bf16 v229, v117, v147
  v_dot2c_f32_bf16 v230, v127, v147
  v_dot2c_f32_bf16 v231, v137, v147
  v_dot2c_f32_bf16 v229, v118, v148
  v_dot2c_f32_bf16 v230, v128, v148
  v_dot2c_f32_bf16 v231, v138, v148
  v_dot2c_f32_bf16 v229, v119, v149
  v_dot2c_f32_bf16 v230, v129, v149
  v_dot2c_f32_bf16 v231, v139, v149
  v_dot2c_f32_bf16 v229, v120, v150
  v_dot2c_f32_bf16 v230, v130, v150
  v_dot2c_f32_bf16 v231, v140, v150
  v_dot2c_f32_bf16 v229, v121, v151
  v_dot2c_f32_bf16 v230, v131, v151
  v_dot2c_f32_bf16 v231, v141, v151
  v_dot2c_f32_bf16 v229, v122, v152
  v_dot2c_f32_bf16 v230, v132, v152
  v_dot2c_f32_bf16 v231, v142, v152
  v_dot2c_f32_bf16 v229, v123, v153
  v_dot2c_f32_bf16 v230, v133, v153
  v_dot2c_f32_bf16 v231, v143, v153
  ds_read_b64 v[64:65], v38 offset:2008
  ds_read_b64 v[66:67], v38 offset:2016
  ds_read_b64 v[68:69], v38 offset:2024
  ds_read_b64 v[70:71], v38 offset:2032
  ds_read_b64 v[72:73], v39 offset:2040
  ds_read_b64 v[74:75], v38 offset:1744
  ds_read_b64 v[76:77], v38 offset:1752
  ds_read_b64 v[78:79], v38 offset:1760
  ds_read_b64 v[80:81], v38 offset:1768
  ds_read_b64 v[82:83], v39 offset:1776
  ds_read_b64 v[84:85], v38 offset:1480
  ds_read_b64 v[86:87], v38 offset:1488
  ds_read_b64 v[88:89], v38 offset:1496
  ds_read_b64 v[90:91], v38 offset:1504
  ds_read_b64 v[92:93], v39 offset:1512
  ds_read_b64 v[94:95], v38 offset:1216
  ds_read_b64 v[96:97], v38 offset:1224
  ds_read_b64 v[98:99], v38 offset:1232
  ds_read_b64 v[100:101], v38 offset:1240
  ds_read_b64 v[102:103], v39 offset:1248
  ds_read_b64 v[104:105], v38 offset:952
  ds_read_b64 v[106:107], v38 offset:960
  ds_read_b64 v[108:109], v38 offset:968
  ds_read_b64 v[110:111], v38 offset:976
  ds_read_b64 v[112:113], v39 offset:984
  ds_read_b64 v[114:115], v38 offset:688
  ds_read_b64 v[116:117], v38 offset:696
  ds_read_b64 v[118:119], v38 offset:704
  ds_read_b64 v[120:121], v38 offset:712
  ds_read_b64 v[122:123], v39 offset:720
  ds_read_b64 v[124:125], v38 offset:424
  ds_read_b64 v[126:127], v38 offset:432
  ds_read_b64 v[128:129], v38 offset:440
  ds_read_b64 v[130:131], v38 offset:448
  ds_read_b64 v[132:133], v39 offset:456
  ds_read_b64 v[134:135], v38 offset:160
  ds_read_b64 v[136:137], v38 offset:168
  ds_read_b64 v[138:139], v38 offset:176
  ds_read_b64 v[140:141], v38 offset:184
  ds_read_b64 v[142:143], v39 offset:192
  v_cvt_pk_bf16_f32 v4, v224, v225
  v_lshlrev_b32 v224, 16, v4
  v_and_b32 v225, 0xffff0000, v4
  v_mul_f32 v224, s60, v224
  v_mul_f32 v225, s60, v225
  v_cvt_pk_bf16_f32 v4, v224, v225
  v_lshlrev_b32 v224, 16, v4
  v_and_b32 v225, 0xffff0000, v4
  v_cndmask_b32 v224, v37, v224, s[76:77]
  v_cndmask_b32 v225, v37, v225, s[78:79]
  v_cvt_pk_bf16_f32 v4, v226, v227
  v_lshlrev_b32 v226, 16, v4
  v_and_b32 v227, 0xffff0000, v4
  v_mul_f32 v226, s60, v226
  v_mul_f32 v227, s60, v227
  v_cvt_pk_bf16_f32 v4, v226, v227
  v_lshlrev_b32 v226, 16, v4
  v_and_b32 v227, 0xffff0000, v4
  v_cndmask_b32 v226, v37, v226, s[80:81]
  v_cndmask_b32 v227, v37, v227, s[82:83]
  v_cvt_pk_bf16_f32 v4, v228, v229
  v_lshlrev_b32 v228, 16, v4
  v_and_b32 v229, 0xffff0000, v4
  v_mul_f32 v228, s60, v228
  v_mul_f32 v229, s60, v229
  v_cvt_pk_bf16_f32 v4, v228, v229
  v_lshlrev_b32 v228, 16, v4
  v_and_b32 v229, 0xffff0000, v4
  v_cndmask_b32 v228, v37, v228, s[84:85]
  v_cndmask_b32 v229, v37, v229, s[86:87]
  v_cvt_pk_bf16_f32 v4, v230, v231
  v_lshlrev_b32 v230, 16, v4
  v_and_b32 v231, 0xffff0000, v4
  v_mul_f32 v230, s60, v230
  v_mul_f32 v231, s60, v231
  v_cvt_pk_bf16_f32 v4, v230, v231
  v_lshlrev_b32 v230, 16, v4
  v_and_b32 v231, 0xffff0000, v4
  v_cndmask_b32 v230, v37, v230, s[88:89]
  v_cndmask_b32 v231, v37, v231, s[90:91]
  v_max3_f32 v5, v224, v225, v226
  v_max3_f32 v5, v5, v227, v228
  v_max3_f32 v5, v5, v229, v230
  v_max_f32 v5, v5, v231
  v_sub_f32 v224, v224, v5
  v_mul_f32 v224, s61, v224
  v_exp_f32 v224, v224
  v_sub_f32 v225, v225, v5
  v_mul_f32 v225, s61, v225
  v_exp_f32 v225, v225
  v_sub_f32 v226, v226, v5
  v_mul_f32 v226, s61, v226
  v_exp_f32 v226, v226
  v_sub_f32 v227, v227, v5
  v_mul_f32 v227, s61, v227
  v_exp_f32 v227, v227
  v_sub_f32 v228, v228, v5
  v_mul_f32 v228, s61, v228
  v_exp_f32 v228, v228
  v_sub_f32 v229, v229, v5
  v_mul_f32 v229, s61, v229
  v_exp_f32 v229, v229
  v_sub_f32 v230, v230, v5
  v_mul_f32 v230, s61, v230
  v_exp_f32 v230, v230
  v_sub_f32 v231, v231, v5
  v_mul_f32 v231, s61, v231
  v_exp_f32 v231, v231
  s_nop 0
  v_add_f32 v5, v224, v225
  v_add_f32 v5, v5, v226
  v_add_f32 v5, v5, v227
  v_add_f32 v5, v5, v228
  v_add_f32 v5, v5, v229
  v_add_f32 v5, v5, v230
  v_add_f32 v5, v5, v231
  v_rcp_f32 v5, v5
  s_nop 0
  v_mul_f32 v224, v224, v5
  v_mul_f32 v225, v225, v5
  v_mul_f32 v226, v226, v5
  v_mul_f32 v227, v227, v5
  v_mul_f32 v228, v228, v5
  v_mul_f32 v229, v229, v5
  v_mul_f32 v230, v230, v5
  v_mul_f32 v231, v231, v5
  v_cvt_pk_bf16_f32 v232, v224, v225
  v_cvt_pk_bf16_f32 v233, v226, v227
  v_cvt_pk_bf16_f32 v234, v228, v229
  v_cvt_pk_bf16_f32 v235, v230, v231
  s_waitcnt lgkmcnt(15)
  v_perm_b32 v236, v74, v64, s62
  v_perm_b32 v237, v74, v64, s63
  v_dot2c_f32_bf16 v192, v236, v232
  v_dot2c_f32_bf16 v193, v237, v232
  v_perm_b32 v238, v75, v65, s62
  v_perm_b32 v239, v75, v65, s63
  v_dot2c_f32_bf16 v194, v238, v232
  v_dot2c_f32_bf16 v195, v239, v232
  v_perm_b32 v240, v76, v66, s62
  v_perm_b32 v241, v76, v66, s63
  v_dot2c_f32_bf16 v196, v240, v232
  v_dot2c_f32_bf16 v197, v241, v232
  v_perm_b32 v242, v77, v67, s62
  v_perm_b32 v243, v77, v67, s63
  v_dot2c_f32_bf16 v198, v242, v232
  v_dot2c_f32_bf16 v199, v243, v232
  v_perm_b32 v236, v78, v68, s62
  v_perm_b32 v237, v78, v68, s63
  v_dot2c_f32_bf16 v200, v236, v232
  v_dot2c_f32_bf16 v201, v237, v232
  v_perm_b32 v238, v79, v69, s62
  v_perm_b32 v239, v79, v69, s63
  v_dot2c_f32_bf16 v202, v238, v232
  v_dot2c_f32_bf16 v203, v239, v232
  v_perm_b32 v240, v80, v70, s62
  v_perm_b32 v241, v80, v70, s63
  v_dot2c_f32_bf16 v204, v240, v232
  v_dot2c_f32_bf16 v205, v241, v232
  v_perm_b32 v242, v81, v71, s62
  v_perm_b32 v243, v81, v71, s63
  v_dot2c_f32_bf16 v206, v242, v232
  v_dot2c_f32_bf16 v207, v243, v232
  v_perm_b32 v236, v82, v72, s62
  v_perm_b32 v237, v82, v72, s63
  v_dot2c_f32_bf16 v208, v236, v232
  v_dot2c_f32_bf16 v209, v237, v232
  v_perm_b32 v238, v83, v73, s62
  v_perm_b32 v239, v83, v73, s63
  v_dot2c_f32_bf16 v210, v238, v232
  v_dot2c_f32_bf16 v211, v239, v232
  s_waitcnt lgkmcnt(15)
  v_perm_b32 v236, v94, v84, s62
  v_perm_b32 v237, v94, v84, s63
  v_dot2c_f32_bf16 v192, v236, v233
  v_dot2c_f32_bf16 v193, v237, v233
  v_perm_b32 v238, v95, v85, s62
  v_perm_b32 v239, v95, v85, s63
  v_dot2c_f32_bf16 v194, v238, v233
  v_dot2c_f32_bf16 v195, v239, v233
  v_perm_b32 v240, v96, v86, s62
  v_perm_b32 v241, v96, v86, s63
  v_dot2c_f32_bf16 v196, v240, v233
  v_dot2c_f32_bf16 v197, v241, v233
  v_perm_b32 v242, v97, v87, s62
  v_perm_b32 v243, v97, v87, s63
  v_dot2c_f32_bf16 v198, v242, v233
  v_dot2c_f32_bf16 v199, v243, v233
  v_perm_b32 v236, v98, v88, s62
  v_perm_b32 v237, v98, v88, s63
  v_dot2c_f32_bf16 v200, v236, v233
  v_dot2c_f32_bf16 v201, v237, v233
  v_perm_b32 v238, v99, v89, s62
  v_perm_b32 v239, v99, v89, s63
  v_dot2c_f32_bf16 v202, v238, v233
  v_dot2c_f32_bf16 v203, v239, v233
  v_perm_b32 v240, v100, v90, s62
  v_perm_b32 v241, v100, v90, s63
  v_dot2c_f32_bf16 v204, v240, v233
  v_dot2c_f32_bf16 v205, v241, v233
  v_perm_b32 v242, v101, v91, s62
  v_perm_b32 v243, v101, v91, s63
  v_dot2c_f32_bf16 v206, v242, v233
  v_dot2c_f32_bf16 v207, v243, v233
  v_perm_b32 v236, v102, v92, s62
  v_perm_b32 v237, v102, v92, s63
  v_dot2c_f32_bf16 v208, v236, v233
  v_dot2c_f32_bf16 v209, v237, v233
  v_perm_b32 v238, v103, v93, s62
  v_perm_b32 v239, v103, v93, s63
  v_dot2c_f32_bf16 v210, v238, v233
  v_dot2c_f32_bf16 v211, v239, v233
  s_waitcnt lgkmcnt(10)
  v_perm_b32 v236, v114, v104, s62
  v_perm_b32 v237, v114, v104, s63
  v_dot2c_f32_bf16 v192, v236, v234
  v_dot2c_f32_bf16 v193, v237, v234
  v_perm_b32 v238, v115, v105, s62
  v_perm_b32 v239, v115, v105, s63
  v_dot2c_f32_bf16 v194, v238, v234
  v_dot2c_f32_bf16 v195, v239, v234
  v_perm_b32 v240, v116, v106, s62
  v_perm_b32 v241, v116, v106, s63
  v_dot2c_f32_bf16 v196, v240, v234
  v_dot2c_f32_bf16 v197, v241, v234
  v_perm_b32 v242, v117, v107, s62
  v_perm_b32 v243, v117, v107, s63
  v_dot2c_f32_bf16 v198, v242, v234
  v_dot2c_f32_bf16 v199, v243, v234
  v_perm_b32 v236, v118, v108, s62
  v_perm_b32 v237, v118, v108, s63
  v_dot2c_f32_bf16 v200, v236, v234
  v_dot2c_f32_bf16 v201, v237, v234
  v_perm_b32 v238, v119, v109, s62
  v_perm_b32 v239, v119, v109, s63
  v_dot2c_f32_bf16 v202, v238, v234
  v_dot2c_f32_bf16 v203, v239, v234
  v_perm_b32 v240, v120, v110, s62
  v_perm_b32 v241, v120, v110, s63
  v_dot2c_f32_bf16 v204, v240, v234
  v_dot2c_f32_bf16 v205, v241, v234
  v_perm_b32 v242, v121, v111, s62
  v_perm_b32 v243, v121, v111, s63
  v_dot2c_f32_bf16 v206, v242, v234
  v_dot2c_f32_bf16 v207, v243, v234
  v_perm_b32 v236, v122, v112, s62
  v_perm_b32 v237, v122, v112, s63
  v_dot2c_f32_bf16 v208, v236, v234
  v_dot2c_f32_bf16 v209, v237, v234
  v_perm_b32 v238, v123, v113, s62
  v_perm_b32 v239, v123, v113, s63
  v_dot2c_f32_bf16 v210, v238, v234
  v_dot2c_f32_bf16 v211, v239, v234
  s_waitcnt lgkmcnt(0)
  v_perm_b32 v236, v134, v124, s62
  v_perm_b32 v237, v134, v124, s63
  v_dot2c_f32_bf16 v192, v236, v235
  v_dot2c_f32_bf16 v193, v237, v235
  v_perm_b32 v238, v135, v125, s62
  v_perm_b32 v239, v135, v125, s63
  v_dot2c_f32_bf16 v194, v238, v235
  v_dot2c_f32_bf16 v195, v239, v235
  v_perm_b32 v240, v136, v126, s62
  v_perm_b32 v241, v136, v126, s63
  v_dot2c_f32_bf16 v196, v240, v235
  v_dot2c_f32_bf16 v197, v241, v235
  v_perm_b32 v242, v137, v127, s62
  v_perm_b32 v243, v137, v127, s63
  v_dot2c_f32_bf16 v198, v242, v235
  v_dot2c_f32_bf16 v199, v243, v235
  v_perm_b32 v236, v138, v128, s62
  v_perm_b32 v237, v138, v128, s63
  v_dot2c_f32_bf16 v200, v236, v235
  v_dot2c_f32_bf16 v201, v237, v235
  v_perm_b32 v238, v139, v129, s62
  v_perm_b32 v239, v139, v129, s63
  v_dot2c_f32_bf16 v202, v238, v235
  v_dot2c_f32_bf16 v203, v239, v235
  v_perm_b32 v240, v140, v130, s62
  v_perm_b32 v241, v140, v130, s63
  v_dot2c_f32_bf16 v204, v240, v235
  v_dot2c_f32_bf16 v205, v241, v235
  v_perm_b32 v242, v141, v131, s62
  v_perm_b32 v243, v141, v131, s63
  v_dot2c_f32_bf16 v206, v242, v235
  v_dot2c_f32_bf16 v207, v243, v235
  v_perm_b32 v236, v142, v132, s62
  v_perm_b32 v237, v142, v132, s63
  v_dot2c_f32_bf16 v208, v236, v235
  v_dot2c_f32_bf16 v209, v237, v235
  v_perm_b32 v238, v143, v133, s62
  v_perm_b32 v239, v143, v133, s63
  v_dot2c_f32_bf16 v210, v238, v235
  v_dot2c_f32_bf16 v211, v239, v235
  s_cmp_lg_u32 s20, 0
  s_cbranch_scc1 bh_221
  ds_read_b64 v[64:65], v35 offset:33792
  ds_read_b64 v[66:67], v35 offset:34304
  ds_read_b64 v[68:69], v35 offset:34816
  ds_read_b64 v[70:71], v35 offset:35328
  ds_read_b64 v[72:73], v35 offset:35840
  s_waitcnt lgkmcnt(0)
  ds_write_b64 v35, v[64:65] offset:0
  ds_write_b64 v35, v[66:67] offset:512
  ds_write_b64 v35, v[68:69] offset:1024
  ds_write_b64 v35, v[70:71] offset:1536
  ds_write_b64 v35, v[72:73] offset:2048
bh_221:
  s_nop 1
  v_cvt_pk_bf16_f32 v244, v192, v193
  v_cvt_pk_bf16_f32 v245, v194, v195
  v_cvt_pk_bf16_f32 v246, v196, v197
  v_cvt_pk_bf16_f32 v247, v198, v199
  v_cvt_pk_bf16_f32 v248, v200, v201
  v_cvt_pk_bf16_f32 v249, v202, v203
  v_cvt_pk_bf16_f32 v250, v204, v205
  v_cvt_pk_bf16_f32 v251, v206, v207
  v_cvt_pk_bf16_f32 v252, v208, v209
  v_cvt_pk_bf16_f32 v253, v210, v211
  buffer_store_dwordx4 v[244:247], v29, s[16:19], s27 offen sc1
  buffer_store_dwordx4 v[248:251], v30, s[16:19], s27 offen sc1
  buffer_store_dwordx2 v[252:253], v31, s[16:19], s27 offen sc1
  s_add_u32 s27, s27, 2048
  s_mov_b64 s[78:79], -1
  s_mov_b64 s[80:81], -1
  s_mov_b64 s[82:83], -1
  s_mov_b64 s[84:85], -1
  s_mov_b64 s[86:87], -1
  s_mov_b64 s[88:89], -1
  s_mov_b64 s[90:91], -1
  s_sub_u32 s26, s26, 1
  s_cmp_gt_u32 s26, 0
  s_waitcnt lgkmcnt(0)
  s_cbranch_scc1 bf_blk_218
  s_waitcnt vmcnt(0) lgkmcnt(0)
  s_barrier
  s_mov_b32 s84, 0
  s_mov_b32 s85, -1
  s_load_dwordx2 s[4:5], s[0:1], 0
  s_load_dwordx2 s[6:7], s[0:1], 16
  s_load_dwordx2 s[38:39], s[0:1], 104
  s_mov_b32 s42, s2
  s_mov_b32 s41, 0
  s_waitcnt lgkmcnt(0)
  s_mov_b32 s8, s4
  s_mov_b32 s9, s5
  s_mov_b32 s10, 2621440
  s_mov_b32 s11, 0x00020000
  s_mov_b32 s12, s6
  s_mov_b32 s13, s7
  s_mov_b32 s14, 7864320
  s_mov_b32 s15, 0x00020000
  s_mov_b32 s16, s38
  s_mov_b32 s17, s39
  s_mov_b32 s18, 50331648
  s_mov_b32 s19, 0x00020000
  s_add_u32 s52, s38, 50331648
  s_addc_u32 s53, s39, 0
  s_mov_b32 s54, 6291456
  s_mov_b32 s55, 0x00020000
  s_add_u32 s56, s38, 85983232
  s_addc_u32 s57, s39, 0
  s_mov_b32 s58, 6815744
  s_mov_b32 s59, 0x00020000
  s_load_dwordx2 s[72:73], s[0:1], 104
  s_waitcnt lgkmcnt(0)
  s_add_u32 s72, s72, 81068032
  s_addc_u32 s73, s73, 0
  s_mov_b32 s74, 116736
  s_mov_b32 s75, 0x00020000
  s_mul_i32 s44, s42, 384
  s_mov_b32 s24, 0
  v_mov_b32 v9, 2731
  s_and_b32 s22, s20, 1
  s_lshl_b32 s22, s22, 2
  v_add_u32 v8, 0, v1
  v_mul_u32_u24 v7, v8, v9
  v_lshrrev_b32 v7, 16, v7
  v_mul_u32_u24 v4, 24, v7
  v_sub_u32 v8, v8, v4
  v_and_b32 v4, 2, v7
  v_xor_b32 v8, v8, v4
  v_xor_b32 v8, s22, v8
  v_xor_b32 v5, 4, v8
  s_mov_b32 s21, 12288
  v_mul_lo_u32 v7, v7, s21
  v_lshl_add_u32 v40, v8, 4, v7
  v_lshl_add_u32 v43, v5, 4, v7
  v_add_u32 v8, 64, v1
  v_mul_u32_u24 v7, v8, v9
  v_lshrrev_b32 v7, 16, v7
  v_mul_u32_u24 v4, 24, v7
  v_sub_u32 v8, v8, v4
  v_and_b32 v4, 2, v7
  v_xor_b32 v8, v8, v4
  v_xor_b32 v8, s22, v8
  v_xor_b32 v5, 4, v8
  s_mov_b32 s21, 12288
  v_mul_lo_u32 v7, v7, s21
  v_lshl_add_u32 v41, v8, 4, v7
  v_lshl_add_u32 v44, v5, 4, v7
  v_add_u32 v8, 128, v1
  v_mul_u32_u24 v7, v8, v9
  v_lshrrev_b32 v7, 16, v7
  v_mul_u32_u24 v4, 24, v7
  v_sub_u32 v8, v8, v4
  v_and_b32 v4, 2, v7
  v_xor_b32 v8, v8, v4
  v_xor_b32 v8, s22, v8
  v_xor_b32 v5, 4, v8
  s_mov_b32 s21, 12288
  v_mul_lo_u32 v7, v7, s21
  v_lshl_add_u32 v42, v8, 4, v7
  v_lshl_add_u32 v45, v5, 4, v7
  s_mul_i32 s23, s20, 491520
  s_add_u32 s23, s23, s44
  s_mul_i32 s22, s20, 15360
  s_add_u32 s22, s22, 98304
  s_add_u32 s21, s23, 0
  s_add_u32 m0, s22, 0
  s_nop 0
  buffer_load_dwordx4 v40, s[12:15], s21 offen lds
  s_add_u32 m0, s22, 1024
  s_nop 0
  buffer_load_dwordx4 v41, s[12:15], s21 offen lds
  s_add_u32 m0, s22, 2048
  s_nop 0
  buffer_load_dwordx4 v42, s[12:15], s21 offen lds
  s_add_u32 s21, s23, 98304
  s_add_u32 m0, s22, 3072
  s_nop 0
  buffer_load_dwordx4 v43, s[12:15], s21 offen lds
  s_add_u32 m0, s22, 4096
  s_nop 0
  buffer_load_dwordx4 v44, s[12:15], s21 offen lds
  s_add_u32 m0, s22, 5120
  s_nop 0
  buffer_load_dwordx4 v45, s[12:15], s21 offen lds
  s_add_u32 s21, s23, 196608
  s_add_u32 m0, s22, 6144
  s_nop 0
  buffer_load_dwordx4 v40, s[12:15], s21 offen lds
  s_add_u32 m0, s22, 7168
  s_nop 0
  buffer_load_dwordx4 v41, s[12:15], s21 offen lds
  s_add_u32 m0, s22, 8192
  s_nop 0
  buffer_load_dwordx4 v42, s[12:15], s21 offen lds
  s_add_u32 s21, s23, 294912
  s_add_u32 m0, s22, 9216
  s_nop 0
  buffer_load_dwordx4 v43, s[12:15], s21 offen lds
  s_add_u32 m0, s22, 10240
  s_nop 0
  buffer_load_dwordx4 v44, s[12:15], s21 offen lds
  s_add_u32 m0, s22, 11264
  s_nop 0
  buffer_load_dwordx4 v45, s[12:15], s21 offen lds
  s_add_u32 s21, s23, 393216
  s_add_u32 m0, s22, 12288
  s_nop 0
  buffer_load_dwordx4 v40, s[12:15], s21 offen lds
  s_add_u32 m0, s22, 13312
  s_nop 0
  buffer_load_dwordx4 v41, s[12:15], s21 offen lds
  s_add_u32 m0, s22, 14336
  s_nop 0
  buffer_load_dwordx4 v42, s[12:15], s21 offen lds
  s_add_u32 s21, s23, 1966080
  buffer_load_dwordx4 v[64:67], v40, s[12:15], s21 offen
  buffer_load_dwordx4 v[68:71], v41, s[12:15], s21 offen
  buffer_load_dwordx4 v[72:75], v42, s[12:15], s21 offen
  s_add_u32 s21, s23, 2064384
  buffer_load_dwordx4 v[76:79], v43, s[12:15], s21 offen
  buffer_load_dwordx4 v[80:83], v44, s[12:15], s21 offen
  buffer_load_dwordx4 v[84:87], v45, s[12:15], s21 offen
  s_add_u32 s21, s23, 2162688
  buffer_load_dwordx4 v[88:91], v40, s[12:15], s21 offen
  buffer_load_dwordx4 v[92:95], v41, s[12:15], s21 offen
  buffer_load_dwordx4 v[96:99], v42, s[12:15], s21 offen
  s_add_u32 s21, s23, 2260992
  buffer_load_dwordx4 v[100:103], v43, s[12:15], s21 offen
  buffer_load_dwordx4 v[104:107], v44, s[12:15], s21 offen
  buffer_load_dwordx4 v[108:111], v45, s[12:15], s21 offen
  s_add_u32 s21, s23, 2359296
  buffer_load_dwordx4 v[112:115], v40, s[12:15], s21 offen
  buffer_load_dwordx4 v[116:119], v41, s[12:15], s21 offen
  buffer_load_dwordx4 v[120:123], v42, s[12:15], s21 offen
  s_add_u32 s21, s23, 3932160
  buffer_load_dwordx4 v[124:127], v40, s[12:15], s21 offen
  buffer_load_dwordx4 v[128:131], v41, s[12:15], s21 offen
  buffer_load_dwordx4 v[132:135], v42, s[12:15], s21 offen
  s_add_u32 s21, s23, 4030464
  buffer_load_dwordx4 v[136:139], v43, s[12:15], s21 offen
  buffer_load_dwordx4 v[140:143], v44, s[12:15], s21 offen
  buffer_load_dwordx4 v[144:147], v45, s[12:15], s21 offen
  s_add_u32 s21, s23, 4128768
  buffer_load_dwordx4 v[148:151], v40, s[12:15], s21 offen
  buffer_load_dwordx4 v[152:155], v41, s[12:15], s21 offen
  buffer_load_dwordx4 v[156:159], v42, s[12:15], s21 offen
  s_add_u32 s21, s23, 4227072
  buffer_load_dwordx4 v[160:163], v43, s[12:15], s21 offen
  buffer_load_dwordx4 v[164:167], v44, s[12:15], s21 offen
  buffer_load_dwordx4 v[168:171], v45, s[12:15], s21 offen
  s_add_u32 s21, s23, 4325376
  buffer_load_dwordx4 v[172:175], v40, s[12:15], s21 offen
  buffer_load_dwordx4 v[176:179], v41, s[12:15], s21 offen
  buffer_load_dwordx4 v[180:183], v42, s[12:15], s21 offen
  s_add_u32 s21, s23, 5898240
  buffer_load_dwordx4 v[184:187], v40, s[12:15], s21 offen
  buffer_load_dwordx4 v[188:191], v41, s[12:15], s21 offen
  buffer_load_dwordx4 v[192:195], v42, s[12:15], s21 offen
  s_add_u32 s21, s23, 5996544
  buffer_load_dwordx4 v[196:199], v43, s[12:15], s21 offen
  buffer_load_dwordx4 v[200:203], v44, s[12:15], s21 offen
  buffer_load_dwordx4 v[204:207], v45, s[12:15], s21 offen
  s_add_u32 s21, s23, 6094848
  buffer_load_dwordx4 v[208:211], v40, s[12:15], s21 offen
  buffer_load_dwordx4 v[212:215], v41, s[12:15], s21 offen
  buffer_load_dwordx4 v[216:219], v42, s[12:15], s21 offen
  s_add_u32 s21, s23, 6193152
  buffer_load_dwordx4 v[220:223], v43, s[12:15], s21 offen
  buffer_load_dwordx4 v[224:227], v44, s[12:15], s21 offen
  buffer_load_dwordx4 v[228:231], v45, s[12:15], s21 offen
  s_add_u32 s21, s23, 6291456
  buffer_load_dwordx4 v[232:235], v40, s[12:15], s21 offen
  buffer_load_dwordx4 v[236:239], v41, s[12:15], s21 offen
  buffer_load_dwordx4 v[240:243], v42, s[12:15], s21 offen
  v_lshl_add_u32 v49, v1, 4, s22
  v_lshrrev_b32 v7, 2, v2
  v_and_b32 v4, 2, v7
  v_and_b32 v5, 1, v3
  v_lshl_or_b32 v4, v5, 2, v4
  v_lshl_add_u32 v7, v3, 3, v7
  v_mul_u32_u24 v7, 384, v7
  v_and_b32 v5, 1, v2
  v_lshl_add_u32 v7, v5, 3, v7
  v_add_u32 v7, 98304, v7
  v_bfe_u32 v8, v2, 1, 1
  s_mul_i32 s21, s20, 6
  v_add_u32 v8, s21, v8
  v_add_u32 v5, 0, v8
  v_xor_b32 v5, v5, v4
  v_lshl_add_u32 v46, v5, 4, v7
  v_add_u32 v5, 2, v8
  v_xor_b32 v5, v5, v4
  v_lshl_add_u32 v47, v5, 4, v7
  v_add_u32 v5, 4, v8
  v_xor_b32 v5, v5, v4
  v_lshl_add_u32 v48, v5, 4, v7
  s_waitcnt vmcnt(45)
  s_barrier
  ds_read_b64_tr_b16 a[0:1], v46 offset:0
  ds_read_b64_tr_b16 a[2:3], v46 offset:1536
  ds_read_b64_tr_b16 a[4:5], v47 offset:0
  ds_read_b64_tr_b16 a[6:7], v47 offset:1536
  ds_read_b64_tr_b16 a[8:9], v48 offset:0
  ds_read_b64_tr_b16 a[10:11], v48 offset:1536
  ds_read_b64_tr_b16 a[12:13], v46 offset:12288
  ds_read_b64_tr_b16 a[14:15], v46 offset:13824
  ds_read_b64_tr_b16 a[16:17], v47 offset:12288
  ds_read_b64_tr_b16 a[18:19], v47 offset:13824
  ds_read_b64_tr_b16 a[20:21], v48 offset:12288
  ds_read_b64_tr_b16 a[22:23], v48 offset:13824
  ds_read_b64_tr_b16 a[24:25], v46 offset:24576
  ds_read_b64_tr_b16 a[26:27], v46 offset:26112
  ds_read_b64_tr_b16 a[28:29], v47 offset:24576
  ds_read_b64_tr_b16 a[30:31], v47 offset:26112
  ds_read_b64_tr_b16 a[32:33], v48 offset:24576
  ds_read_b64_tr_b16 a[34:35], v48 offset:26112
  ds_read_b64_tr_b16 a[36:37], v46 offset:36864
  ds_read_b64_tr_b16 a[38:39], v46 offset:38400
  ds_read_b64_tr_b16 a[40:41], v47 offset:36864
  ds_read_b64_tr_b16 a[42:43], v47 offset:38400
  ds_read_b64_tr_b16 a[44:45], v48 offset:36864
  ds_read_b64_tr_b16 a[46:47], v48 offset:38400
  ds_read_b64_tr_b16 a[48:49], v46 offset:49152
  ds_read_b64_tr_b16 a[50:51], v46 offset:50688
  ds_read_b64_tr_b16 a[52:53], v47 offset:49152
  ds_read_b64_tr_b16 a[54:55], v47 offset:50688
  ds_read_b64_tr_b16 a[56:57], v48 offset:49152
  ds_read_b64_tr_b16 a[58:59], v48 offset:50688
  v_lshrrev_b32 v11, 3, v1
  v_and_b32 v12, 7, v1
  v_xor_b32 v12, v12, v11
  v_mul_u32_u24 v11, 1280, v11
  v_lshl_add_u32 v10, v12, 4, v11
  s_mul_i32 s46, s20, 40960
  v_add_u32 v10, s46, v10
  s_lshl_b32 s47, s20, 12
  s_add_u32 s47, s47, 0
  s_add_u32 s46, s47, 98304
  s_mov_b32 s30, s24
  s_add_u32 s32, s47, 0
  v_add_u32 v11, 9216, v10
  v_add_u32 v12, 18432, v10
  v_add_u32 v13, 27648, v10
  s_mov_b32 m0, s32
  s_nop 0
  buffer_load_dwordx4 v10, s[8:11], s30 offen offset:0 lds
  buffer_load_dwordx4 v11, s[8:11], s30 offen offset:1024 lds
  buffer_load_dwordx4 v12, s[8:11], s30 offen offset:2048 lds
  buffer_load_dwordx4 v13, s[8:11], s30 offen offset:3072 lds
  s_add_u32 s30, s30, 128
  s_add_u32 s32, s32, 16384
  s_cmp_lt_u32 s32, s46
  s_cselect_b32 s32, s32, s47
  s_mov_b32 m0, s32
  s_nop 0
  buffer_load_dwordx4 v10, s[8:11], s30 offen offset:0 lds
  buffer_load_dwordx4 v11, s[8:11], s30 offen offset:1024 lds
  buffer_load_dwordx4 v12, s[8:11], s30 offen offset:2048 lds
  buffer_load_dwordx4 v13, s[8:11], s30 offen offset:3072 lds
  s_add_u32 s30, s30, 128
  s_add_u32 s32, s32, 16384
  s_cmp_lt_u32 s32, s46
  s_cselect_b32 s32, s32, s47
  s_mov_b32 m0, s32
  s_nop 0
  buffer_load_dwordx4 v10, s[8:11], s30 offen offset:0 lds
  buffer_load_dwordx4 v11, s[8:11], s30 offen offset:1024 lds
  buffer_load_dwordx4 v12, s[8:11], s30 offen offset:2048 lds
  buffer_load_dwordx4 v13, s[8:11], s30 offen offset:3072 lds
  s_add_u32 s30, s30, 128
  s_add_u32 s32, s32, 16384
  s_cmp_lt_u32 s32, s46
  s_cselect_b32 s32, s32, s47
  s_mov_b32 m0, s32
  s_nop 0
  buffer_load_dwordx4 v10, s[8:11], s30 offen offset:0 lds
  buffer_load_dwordx4 v11, s[8:11], s30 offen offset:1024 lds
  buffer_load_dwordx4 v12, s[8:11], s30 offen offset:2048 lds
  buffer_load_dwordx4 v13, s[8:11], s30 offen offset:3072 lds
  s_add_u32 s30, s30, 128
  s_add_u32 s32, s32, 16384
  s_cmp_lt_u32 s32, s46
  s_cselect_b32 s32, s32, s47
  s_waitcnt lgkmcnt(0)
  s_barrier
  s_waitcnt vmcnt(46)
  ds_write_b128 v49, v[64:67] offset:0
  ds_write_b128 v49, v[68:71] offset:1024
  ds_write_b128 v49, v[72:75] offset:2048
  ds_write_b128 v49, v[76:79] offset:3072
  ds_write_b128 v49, v[80:83] offset:4096
  ds_write_b128 v49, v[84:87] offset:5120
  ds_write_b128 v49, v[88:91] offset:6144
  ds_write_b128 v49, v[92:95] offset:7168
  ds_write_b128 v49, v[96:99] offset:8192
  ds_write_b128 v49, v[100:103] offset:9216
  ds_write_b128 v49, v[104:107] offset:10240
  ds_write_b128 v49, v[108:111] offset:11264
  ds_write_b128 v49, v[112:115] offset:12288
  ds_write_b128 v49, v[116:119] offset:13312
  ds_write_b128 v49, v[120:123] offset:14336
  s_waitcnt lgkmcnt(0)
  s_barrier
  ds_read_b64_tr_b16 a[60:61], v46 offset:0
  ds_read_b64_tr_b16 a[62:63], v46 offset:1536
  ds_read_b64_tr_b16 a[64:65], v47 offset:0
  ds_read_b64_tr_b16 a[66:67], v47 offset:1536
  ds_read_b64_tr_b16 a[68:69], v48 offset:0
  ds_read_b64_tr_b16 a[70:71], v48 offset:1536
  ds_read_b64_tr_b16 a[72:73], v46 offset:12288
  ds_read_b64_tr_b16 a[74:75], v46 offset:13824
  ds_read_b64_tr_b16 a[76:77], v47 offset:12288
  ds_read_b64_tr_b16 a[78:79], v47 offset:13824
  ds_read_b64_tr_b16 a[80:81], v48 offset:12288
  ds_read_b64_tr_b16 a[82:83], v48 offset:13824
  ds_read_b64_tr_b16 a[84:85], v46 offset:24576
  ds_read_b64_tr_b16 a[86:87], v46 offset:26112
  ds_read_b64_tr_b16 a[88:89], v47 offset:24576
  ds_read_b64_tr_b16 a[90:91], v47 offset:26112
  ds_read_b64_tr_b16 a[92:93], v48 offset:24576
  ds_read_b64_tr_b16 a[94:95], v48 offset:26112
  ds_read_b64_tr_b16 a[96:97], v46 offset:36864
  ds_read_b64_tr_b16 a[98:99], v46 offset:38400
  ds_read_b64_tr_b16 a[100:101], v47 offset:36864
  ds_read_b64_tr_b16 a[102:103], v47 offset:38400
  ds_read_b64_tr_b16 a[104:105], v48 offset:36864
  ds_read_b64_tr_b16 a[106:107], v48 offset:38400
  ds_read_b64_tr_b16 a[108:109], v46 offset:49152
  ds_read_b64_tr_b16 a[110:111], v46 offset:50688
  ds_read_b64_tr_b16 a[112:113], v47 offset:49152
  ds_read_b64_tr_b16 a[114:115], v47 offset:50688
  ds_read_b64_tr_b16 a[116:117], v48 offset:49152
  ds_read_b64_tr_b16 a[118:119], v48 offset:50688
  s_waitcnt lgkmcnt(0)
  s_barrier
  s_waitcnt vmcnt(31)
  ds_write_b128 v49, v[124:127] offset:0
  ds_write_b128 v49, v[128:131] offset:1024
  ds_write_b128 v49, v[132:135] offset:2048
  ds_write_b128 v49, v[136:139] offset:3072
  ds_write_b128 v49, v[140:143] offset:4096
  ds_write_b128 v49, v[144:147] offset:5120
  ds_write_b128 v49, v[148:151] offset:6144
  ds_write_b128 v49, v[152:155] offset:7168
  ds_write_b128 v49, v[156:159] offset:8192
  ds_write_b128 v49, v[160:163] offset:9216
  ds_write_b128 v49, v[164:167] offset:10240
  ds_write_b128 v49, v[168:171] offset:11264
  ds_write_b128 v49, v[172:175] offset:12288
  ds_write_b128 v49, v[176:179] offset:13312
  ds_write_b128 v49, v[180:183] offset:14336
  s_waitcnt lgkmcnt(0)
  s_barrier
  ds_read_b64_tr_b16 a[120:121], v46 offset:0
  ds_read_b64_tr_b16 a[122:123], v46 offset:1536
  ds_read_b64_tr_b16 a[124:125], v47 offset:0
  ds_read_b64_tr_b16 a[126:127], v47 offset:1536
  ds_read_b64_tr_b16 a[128:129], v48 offset:0
  ds_read_b64_tr_b16 a[130:131], v48 offset:1536
  ds_read_b64_tr_b16 a[132:133], v46 offset:12288
  ds_read_b64_tr_b16 a[134:135], v46 offset:13824
  ds_read_b64_tr_b16 a[136:137], v47 offset:12288
  ds_read_b64_tr_b16 a[138:139], v47 offset:13824
  ds_read_b64_tr_b16 a[140:141], v48 offset:12288
  ds_read_b64_tr_b16 a[142:143], v48 offset:13824
  ds_read_b64_tr_b16 a[144:145], v46 offset:24576
  ds_read_b64_tr_b16 a[146:147], v46 offset:26112
  ds_read_b64_tr_b16 a[148:149], v47 offset:24576
  ds_read_b64_tr_b16 a[150:151], v47 offset:26112
  ds_read_b64_tr_b16 a[152:153], v48 offset:24576
  ds_read_b64_tr_b16 a[154:155], v48 offset:26112
  ds_read_b64_tr_b16 a[156:157], v46 offset:36864
  ds_read_b64_tr_b16 a[158:159], v46 offset:38400
  ds_read_b64_tr_b16 a[160:161], v47 offset:36864
  ds_read_b64_tr_b16 a[162:163], v47 offset:38400
  ds_read_b64_tr_b16 a[164:165], v48 offset:36864
  ds_read_b64_tr_b16 a[166:167], v48 offset:38400
  ds_read_b64_tr_b16 a[168:169], v46 offset:49152
  ds_read_b64_tr_b16 a[170:171], v46 offset:50688
  ds_read_b64_tr_b16 a[172:173], v47 offset:49152
  ds_read_b64_tr_b16 a[174:175], v47 offset:50688
  ds_read_b64_tr_b16 a[176:177], v48 offset:49152
  ds_read_b64_tr_b16 a[178:179], v48 offset:50688
  s_waitcnt lgkmcnt(0)
  s_barrier
  s_waitcnt vmcnt(16)
  ds_write_b128 v49, v[184:187] offset:0
  ds_write_b128 v49, v[188:191] offset:1024
  ds_write_b128 v49, v[192:195] offset:2048
  ds_write_b128 v49, v[196:199] offset:3072
  ds_write_b128 v49, v[200:203] offset:4096
  ds_write_b128 v49, v[204:207] offset:5120
  ds_write_b128 v49, v[208:211] offset:6144
  ds_write_b128 v49, v[212:215] offset:7168
  ds_write_b128 v49, v[216:219] offset:8192
  ds_write_b128 v49, v[220:223] offset:9216
  ds_write_b128 v49, v[224:227] offset:10240
  ds_write_b128 v49, v[228:231] offset:11264
  ds_write_b128 v49, v[232:235] offset:12288
  ds_write_b128 v49, v[236:239] offset:13312
  ds_write_b128 v49, v[240:243] offset:14336
  s_waitcnt lgkmcnt(0)
  s_barrier
  ds_read_b64_tr_b16 a[180:181], v46 offset:0
  ds_read_b64_tr_b16 a[182:183], v46 offset:1536
  ds_read_b64_tr_b16 a[184:185], v47 offset:0
  ds_read_b64_tr_b16 a[186:187], v47 offset:1536
  ds_read_b64_tr_b16 a[188:189], v48 offset:0
  ds_read_b64_tr_b16 a[190:191], v48 offset:1536
  ds_read_b64_tr_b16 a[192:193], v46 offset:12288
  ds_read_b64_tr_b16 a[194:195], v46 offset:13824
  ds_read_b64_tr_b16 a[196:197], v47 offset:12288
  ds_read_b64_tr_b16 a[198:199], v47 offset:13824
  ds_read_b64_tr_b16 a[200:201], v48 offset:12288
  ds_read_b64_tr_b16 a[202:203], v48 offset:13824
  ds_read_b64_tr_b16 a[204:205], v46 offset:24576
  ds_read_b64_tr_b16 a[206:207], v46 offset:26112
  ds_read_b64_tr_b16 a[208:209], v47 offset:24576
  ds_read_b64_tr_b16 a[210:211], v47 offset:26112
  ds_read_b64_tr_b16 a[212:213], v48 offset:24576
  ds_read_b64_tr_b16 a[214:215], v48 offset:26112
  ds_read_b64_tr_b16 a[216:217], v46 offset:36864
  ds_read_b64_tr_b16 a[218:219], v46 offset:38400
  ds_read_b64_tr_b16 a[220:221], v47 offset:36864
  ds_read_b64_tr_b16 a[222:223], v47 offset:38400
  ds_read_b64_tr_b16 a[224:225], v48 offset:36864
  ds_read_b64_tr_b16 a[226:227], v48 offset:38400
  ds_read_b64_tr_b16 a[228:229], v46 offset:49152
  ds_read_b64_tr_b16 a[230:231], v46 offset:50688
  ds_read_b64_tr_b16 a[232:233], v47 offset:49152
  ds_read_b64_tr_b16 a[234:235], v47 offset:50688
  ds_read_b64_tr_b16 a[236:237], v48 offset:49152
  ds_read_b64_tr_b16 a[238:239], v48 offset:50688
  s_waitcnt lgkmcnt(0)
  s_barrier
  v_readfirstlane_b32 s21, v32
  s_cmp_ge_u32 s21, 32
  s_cbranch_scc1 bt_222
  s_mov_b32 s21, 76
  v_mov_b32 v4, 0
  s_mov_b32 s101, 0
wf_223:
  buffer_load_dword v5, v4, s[64:67], s21 offen sc1
  s_add_u32 s101, s101, 1
  s_cmp_gt_u32 s101, 131072
  s_cbranch_scc1 main_end
  s_waitcnt vmcnt(0)
  v_readfirstlane_b32 s100, v5
  s_cmp_ge_u32 s100, 32
  s_cbranch_scc1 wf_224
  s_sleep 8
  s_branch wf_223
wf_224:
bt_222:
  s_mov_b32 s21, 91136
  s_cmp_lg_u32 s20, 0
  s_cbranch_scc1 af_225
  v_mov_b32 v4, 0
  v_mov_b32 v5, 1
  s_mov_b64 exec, 1
  buffer_atomic_add v5, v4, s[72:75], s21 offen sc1
  s_mov_b64 exec, -1
  s_nop 1
af_225:
  s_mul_i32 s21, s20, 12800
  s_add_u32 s21, s21, 98304
  v_mul_u32_u24 v4, 400, v2
  v_lshlrev_b32 v5, 4, v3
  v_add3_u32 v29, v4, v5, s21
  v_lshlrev_b32 v30, 4, v1
  v_and_b32 v4, 1, v2
  v_bfe_u32 v5, v2, 1, 1
  v_lshl_or_b32 v4, v5, 2, v4
  v_bfe_u32 v5, v2, 2, 1
  v_lshl_or_b32 v4, v5, 1, v4
  v_lshlrev_b32 v4, 4, v4
  v_lshl_add_u32 v31, v3, 7, v4
  v_lshlrev_b32 v32, 3, v1
  v_and_b32 v4, 3, v1
  v_lshlrev_b32 v33, 3, v4
  v_mov_b32 v34, 0xf149f2ca
  v_lshlrev_b32 v4, 2, v3
  v_sub_u32 v35, v2, v4
  v_cmp_gt_u32 s[60:61], 2, v3
  s_mov_b32 s62, 0x3d93cd3a
  s_mov_b32 s63, 0x3fb8aa3b
  s_mov_b32 s83, 0x3dd53b95
  v_cmp_le_i32 s[64:65], 0, v35
  v_cmp_le_i32 s[66:67], 1, v35
  v_cmp_le_i32 s[68:69], 2, v35
  v_cmp_le_i32 s[70:71], 3, v35
  s_mov_b32 s24, 0
  s_mov_b32 s25, 163840
  s_mov_b32 s26, 14
  s_lshl_b32 s49, s41, 2
  s_add_u32 s49, s49, s20
  s_mov_b32 s29, 4
  s_mov_b32 s78, 0
  s_mov_b32 s81, 0x80000000
  s_mov_b32 s82, 0
  s_mul_i32 s21, s49, 393216
  s_mul_i32 s22, s42, 12288
  s_add_u32 s50, s21, s22
  s_mul_i32 s21, s49, 98304
  s_mul_i32 s22, s42, 3072
  s_add_u32 s51, s21, s22
  s_lshr_b32 s22, s49, 1
  s_lshr_b32 s21, s49, 2
  s_add_u32 s21, s21, 3
  s_cmp_lt_u32 s49, 12
  s_cselect_b32 s21, s22, s21
  s_lshl_b32 s21, s21, 3
  s_lshr_b32 s22, s42, 2
  s_add_u32 s21, s21, s22
  s_lshl_b32 s21, s21, 7
  s_add_u32 s76, s21, 0
  s_lshl_b32 s77, s42, 7
  s_add_u32 s77, s77, 19456
  v_mov_b32 v21, 0
  buffer_load_dword v21, v33, s[72:75], s77 offen sc1
  v_and_b32 v6, 7, v2
  v_add_u32 v4, 0, v3
  v_xor_b32 v4, v4, v6
  v_lshlrev_b32 v4, 4, v4
  v_lshl_add_u32 v14, v2, 7, v4
  v_add_u32 v4, 4, v3
  v_xor_b32 v4, v4, v6
  v_lshlrev_b32 v4, 4, v4
  v_lshl_add_u32 v15, v2, 7, v4
  v_mul_u32_u24 v22, 400, v2
  v_mul_u32_u24 v4, 16, v3
  s_mul_i32 s21, s20, 96
  s_add_u32 s21, s21, 98304
  v_add3_u32 v22, v22, v4, s21
  v_lshlrev_b32 v4, 3, v3
  v_sub_u32 v16, v22, v4
  v_mov_b32 v9, 2731
  s_mov_b32 s33, 0
  s_mov_b32 s48, 0x80000000
  s_mov_b32 m0, s32
  s_nop 0
  buffer_load_dwordx4 v10, s[8:11], s30 offen offset:0 lds
  buffer_load_dwordx4 v11, s[8:11], s30 offen offset:1024 lds
  s_waitcnt vmcnt(14)
  s_barrier
  v_add_u32 v18, s33, v14
  v_add_u32 v19, s33, v15
  s_add_u32 s33, s33, 16384
  s_cmp_lt_u32 s33, 98304
  s_cselect_b32 s33, s33, 0
  ds_read_b128 v[160:163], v18 offset:0
  ds_read_b128 v[164:167], v18 offset:2048
  ds_read_b128 v[168:171], v18 offset:4096
  ds_read_b128 v[172:175], v18 offset:6144
  ds_read_b128 v[176:179], v18 offset:8192
  ds_read_b128 v[180:183], v18 offset:10240
  ds_read_b128 v[184:187], v18 offset:12288
  ds_read_b128 v[188:191], v18 offset:14336
  s_waitcnt lgkmcnt(0)
qa_blk_227:
  v_mfma_f32_16x16x32_bf16 v[64:67], a[0:3], v[160:163], 0
  ds_read_b128 v[192:195], v19 offset:0
  v_mfma_f32_16x16x32_bf16 v[68:71], a[4:7], v[160:163], 0
  v_add_u32 v18, s33, v14
  v_cndmask_b32 v36, v34, v36, s[64:65]
  v_mfma_f32_16x16x32_bf16 v[72:75], a[8:11], v[160:163], 0
  v_cndmask_b32 v48, v34, v48, s[64:65]
  v_cndmask_b32 v37, v34, v37, s[66:67]
  v_mfma_f32_16x16x32_bf16 v[76:79], a[0:3], v[164:167], 0
  ds_read_b128 v[196:199], v19 offset:2048
  v_cndmask_b32 v49, v34, v49, s[66:67]
  v_mfma_f32_16x16x32_bf16 v[80:83], a[4:7], v[164:167], 0
  buffer_load_dwordx4 v12, s[8:11], s30 offen offset:2048 lds
  v_mfma_f32_16x16x32_bf16 v[84:87], a[8:11], v[164:167], 0
  v_cndmask_b32 v38, v34, v38, s[68:69]
  v_cndmask_b32 v50, v34, v50, s[68:69]
  v_mfma_f32_16x16x32_bf16 v[88:91], a[0:3], v[168:171], 0
  ds_read_b128 v[200:203], v19 offset:4096
  v_cndmask_b32 v39, v34, v39, s[70:71]
  v_mfma_f32_16x16x32_bf16 v[92:95], a[4:7], v[168:171], 0
  v_cndmask_b32 v51, v34, v51, s[70:71]
  v_max3_f32 v56, v36, v37, v38
  v_mfma_f32_16x16x32_bf16 v[96:99], a[8:11], v[168:171], 0
  v_max3_f32 v56, v56, v39, v40
  v_max3_f32 v56, v56, v41, v42
  v_mfma_f32_16x16x32_bf16 v[100:103], a[0:3], v[172:175], 0
  ds_read_b128 v[204:207], v19 offset:6144
  v_max_f32 v56, v56, v43
  v_mfma_f32_16x16x32_bf16 v[104:107], a[4:7], v[172:175], 0
  v_mov_b32 v57, v56
  v_mfma_f32_16x16x32_bf16 v[108:111], a[8:11], v[172:175], 0
  s_waitcnt lgkmcnt(15)
  v_mfma_f32_16x16x32_bf16 v[112:115], a[0:3], v[176:179], 0
  ds_read_b128 v[208:211], v19 offset:8192
  v_mfma_f32_16x16x32_bf16 v[116:119], a[4:7], v[176:179], 0
  s_nop 1
  v_mfma_f32_16x16x32_bf16 v[120:123], a[8:11], v[176:179], 0
  v_permlane32_swap_b32 v56, v57
  v_mfma_f32_16x16x32_bf16 v[124:127], a[0:3], v[180:183], 0
  ds_read_b128 v[212:215], v19 offset:10240
  v_max_f32 v56, v56, v57
  v_mfma_f32_16x16x32_bf16 v[128:131], a[4:7], v[180:183], 0
  buffer_load_dwordx4 v13, s[8:11], s30 offen offset:3072 lds
  v_mfma_f32_16x16x32_bf16 v[132:135], a[8:11], v[180:183], 0
  s_add_u32 s30, s30, 128
  s_add_u32 m0, m0, 16384
  v_mfma_f32_16x16x32_bf16 v[136:139], a[0:3], v[184:187], 0
  ds_read_b128 v[216:219], v19 offset:12288
  v_mov_b32 v57, v56
  v_mfma_f32_16x16x32_bf16 v[140:143], a[4:7], v[184:187], 0
  s_cmp_lt_u32 m0, s46
  s_cselect_b32 m0, m0, s47
  v_mfma_f32_16x16x32_bf16 v[144:147], a[8:11], v[184:187], 0
  s_nop 1
  v_mfma_f32_16x16x32_bf16 v[148:151], a[0:3], v[188:191], 0
  ds_read_b128 v[220:223], v19 offset:14336
  v_mfma_f32_16x16x32_bf16 v[152:155], a[4:7], v[188:191], 0
  v_permlane16_swap_b32 v56, v57
  v_mfma_f32_16x16x32_bf16 v[156:159], a[8:11], v[188:191], 0
  s_waitcnt vmcnt(12) lgkmcnt(4)
  s_barrier
  v_mfma_f32_16x16x32_bf16 v[64:67], a[12:15], v[192:195], v[64:67]
  ds_read_b128 v[160:163], v18 offset:0
  v_max_f32 v56, v56, v57
  v_mfma_f32_16x16x32_bf16 v[68:71], a[16:19], v[192:195], v[68:71]
  v_mul_f32 v56, s83, v56
  v_fma_f32 v36, v36, s83, -v56
  v_mfma_f32_16x16x32_bf16 v[72:75], a[20:23], v[192:195], v[72:75]
  v_add_u32 v19, s33, v15
  s_add_u32 s33, s33, 16384
  v_mfma_f32_16x16x32_bf16 v[76:79], a[12:15], v[196:199], v[76:79]
  ds_read_b128 v[164:167], v18 offset:2048
  s_mul_i32 s21, s49, 393216
  v_mfma_f32_16x16x32_bf16 v[80:83], a[16:19], v[196:199], v[80:83]
  buffer_load_dwordx4 v10, s[8:11], s30 offen offset:0 lds
  v_mfma_f32_16x16x32_bf16 v[84:87], a[20:23], v[196:199], v[84:87]
  s_cmp_lt_u32 s33, 98304
  s_cselect_b32 s33, s33, 0
  v_mfma_f32_16x16x32_bf16 v[88:91], a[12:15], v[200:203], v[88:91]
  ds_read_b128 v[168:171], v18 offset:4096
  s_mul_i32 s22, s42, 12288
  v_mfma_f32_16x16x32_bf16 v[92:95], a[16:19], v[200:203], v[92:95]
  s_add_u32 s50, s21, s22
  s_lshr_b32 s51, s50, 2
  v_mfma_f32_16x16x32_bf16 v[96:99], a[20:23], v[200:203], v[96:99]
  s_add_u32 s23, s49, 1
  v_cmp_gt_u32 vcc, s23, v21
  v_mfma_f32_16x16x32_bf16 v[100:103], a[12:15], v[204:207], v[100:103]
  ds_read_b128 v[172:175], v18 offset:6144
  v_fma_f32 v37, v37, s83, -v56
  v_mfma_f32_16x16x32_bf16 v[104:107], a[16:19], v[204:207], v[104:107]
  s_cmp_eq_u64 vcc, 0
  s_cselect_b32 s80, 1, 0
  v_mfma_f32_16x16x32_bf16 v[108:111], a[20:23], v[204:207], v[108:111]
  s_waitcnt lgkmcnt(4)
  s_lshl_b32 s79, s80, 3
  v_mfma_f32_16x16x32_bf16 v[112:115], a[12:15], v[208:211], v[112:115]
  ds_read_b128 v[176:179], v18 offset:8192
  v_fma_f32 v38, v38, s83, -v56
  v_mfma_f32_16x16x32_bf16 v[116:119], a[16:19], v[208:211], v[116:119]
  buffer_load_dwordx4 a[240:243], v31, s[52:55], s51 offen offset:0 sc1
  v_mfma_f32_16x16x32_bf16 v[120:123], a[20:23], v[208:211], v[120:123]
  v_fma_f32 v39, v39, s83, -v56
  v_fma_f32 v40, v40, s83, -v56
  v_mfma_f32_16x16x32_bf16 v[124:127], a[12:15], v[212:215], v[124:127]
  ds_read_b128 v[180:183], v18 offset:10240
  v_fma_f32 v41, v41, s83, -v56
  v_mfma_f32_16x16x32_bf16 v[128:131], a[16:19], v[212:215], v[128:131]
  buffer_load_dwordx4 v11, s[8:11], s30 offen offset:1024 lds
  v_mfma_f32_16x16x32_bf16 v[132:135], a[20:23], v[212:215], v[132:135]
  v_fma_f32 v42, v42, s83, -v56
  v_fma_f32 v43, v43, s83, -v56
  v_mfma_f32_16x16x32_bf16 v[136:139], a[12:15], v[216:219], v[136:139]
  ds_read_b128 v[184:187], v18 offset:12288
  v_mfma_f32_16x16x32_bf16 v[140:143], a[16:19], v[216:219], v[140:143]
  v_exp_f32 v36, v36
  v_mfma_f32_16x16x32_bf16 v[144:147], a[20:23], v[216:219], v[144:147]
  v_exp_f32 v37, v37
  v_mfma_f32_16x16x32_bf16 v[148:151], a[12:15], v[220:223], v[148:151]
  ds_read_b128 v[188:191], v18 offset:14336
  v_mfma_f32_16x16x32_bf16 v[152:155], a[16:19], v[220:223], v[152:155]
  v_exp_f32 v38, v38
  v_mfma_f32_16x16x32_bf16 v[156:159], a[20:23], v[220:223], v[156:159]
  s_waitcnt lgkmcnt(4)
  v_mfma_f32_16x16x32_bf16 v[64:67], a[24:27], v[160:163], v[64:67]
  ds_read_b128 v[192:195], v19 offset:0
  v_mfma_f32_16x16x32_bf16 v[68:71], a[28:31], v[160:163], v[68:71]
  v_add_u32 v18, s33, v14
  v_mfma_f32_16x16x32_bf16 v[72:75], a[32:35], v[160:163], v[72:75]
  v_exp_f32 v39, v39
  v_mfma_f32_16x16x32_bf16 v[76:79], a[24:27], v[164:167], v[76:79]
  ds_read_b128 v[196:199], v19 offset:2048
  v_mfma_f32_16x16x32_bf16 v[80:83], a[28:31], v[164:167], v[80:83]
  buffer_load_dwordx4 v12, s[8:11], s30 offen offset:2048 lds
  v_mfma_f32_16x16x32_bf16 v[84:87], a[32:35], v[164:167], v[84:87]
  v_exp_f32 v40, v40
  v_mfma_f32_16x16x32_bf16 v[88:91], a[24:27], v[168:171], v[88:91]
  ds_read_b128 v[200:203], v19 offset:4096
  v_mfma_f32_16x16x32_bf16 v[92:95], a[28:31], v[168:171], v[92:95]
  v_exp_f32 v41, v41
  v_mfma_f32_16x16x32_bf16 v[96:99], a[32:35], v[168:171], v[96:99]
  v_exp_f32 v42, v42
  v_mfma_f32_16x16x32_bf16 v[100:103], a[24:27], v[172:175], v[100:103]
  ds_read_b128 v[204:207], v19 offset:6144
  v_mfma_f32_16x16x32_bf16 v[104:107], a[28:31], v[172:175], v[104:107]
  buffer_load_dwordx4 a[244:247], v31, s[52:55], s51 offen offset:512 sc1
  v_mfma_f32_16x16x32_bf16 v[108:111], a[32:35], v[172:175], v[108:111]
  s_waitcnt lgkmcnt(4)
  v_mfma_f32_16x16x32_bf16 v[112:115], a[24:27], v[176:179], v[112:115]
  ds_read_b128 v[208:211], v19 offset:8192
  v_mfma_f32_16x16x32_bf16 v[116:119], a[28:31], v[176:179], v[116:119]
  v_exp_f32 v43, v43
  v_mfma_f32_16x16x32_bf16 v[120:123], a[32:35], v[176:179], v[120:123]
  s_nop 0
  v_add_f32 v56, v40, v41
  v_mfma_f32_16x16x32_bf16 v[124:127], a[24:27], v[180:183], v[124:127]
  ds_read_b128 v[212:215], v19 offset:10240
  v_add_f32 v56, v56, v42
  v_mfma_f32_16x16x32_bf16 v[128:131], a[28:31], v[180:183], v[128:131]
  buffer_load_dwordx4 v13, s[8:11], s30 offen offset:3072 lds
  v_mfma_f32_16x16x32_bf16 v[132:135], a[32:35], v[180:183], v[132:135]
  s_add_u32 s30, s30, 128
  s_add_u32 m0, m0, 16384
  v_mfma_f32_16x16x32_bf16 v[136:139], a[24:27], v[184:187], v[136:139]
  ds_read_b128 v[216:219], v19 offset:12288
  v_add_f32 v56, v56, v43
  v_mfma_f32_16x16x32_bf16 v[140:143], a[28:31], v[184:187], v[140:143]
  s_cmp_lt_u32 m0, s46
  s_cselect_b32 m0, m0, s47
  v_mfma_f32_16x16x32_bf16 v[144:147], a[32:35], v[184:187], v[144:147]
  v_cndmask_b32 v56, 0, v56, s[60:61]
  v_add_f32 v56, v56, v36
  v_mfma_f32_16x16x32_bf16 v[148:151], a[24:27], v[188:191], v[148:151]
  ds_read_b128 v[220:223], v19 offset:14336
  v_add_f32 v56, v56, v37
  v_mfma_f32_16x16x32_bf16 v[152:155], a[28:31], v[188:191], v[152:155]
  v_add_f32 v56, v56, v38
  v_add_f32 v56, v56, v39
  v_mfma_f32_16x16x32_bf16 v[156:159], a[32:35], v[188:191], v[156:159]
  s_waitcnt vmcnt(14) lgkmcnt(4)
  s_barrier
  v_mfma_f32_16x16x32_bf16 v[64:67], a[36:39], v[192:195], v[64:67]
  ds_read_b128 v[160:163], v18 offset:0
  v_mov_b32 v57, v56
  v_mfma_f32_16x16x32_bf16 v[68:71], a[40:43], v[192:195], v[68:71]
  s_nop 1
  v_mfma_f32_16x16x32_bf16 v[72:75], a[44:47], v[192:195], v[72:75]
  v_add_u32 v19, s33, v15
  s_add_u32 s33, s33, 16384
  v_mfma_f32_16x16x32_bf16 v[76:79], a[36:39], v[196:199], v[76:79]
  ds_read_b128 v[164:167], v18 offset:2048
  v_mfma_f32_16x16x32_bf16 v[80:83], a[40:43], v[196:199], v[80:83]
  buffer_load_dwordx4 v10, s[8:11], s30 offen offset:0 lds
  v_mfma_f32_16x16x32_bf16 v[84:87], a[44:47], v[196:199], v[84:87]
  s_cmp_lt_u32 s33, 98304
  s_cselect_b32 s33, s33, 0
  v_mfma_f32_16x16x32_bf16 v[88:91], a[36:39], v[200:203], v[88:91]
  ds_read_b128 v[168:171], v18 offset:4096
  v_mfma_f32_16x16x32_bf16 v[92:95], a[40:43], v[200:203], v[92:95]
  buffer_load_dwordx4 a[248:251], v31, s[52:55], s51 offen offset:1024 sc1
  v_mfma_f32_16x16x32_bf16 v[96:99], a[44:47], v[200:203], v[96:99]
  v_permlane32_swap_b32 v56, v57
  v_mfma_f32_16x16x32_bf16 v[100:103], a[36:39], v[204:207], v[100:103]
  ds_read_b128 v[172:175], v18 offset:6144
  v_add_f32 v56, v56, v57
  v_mfma_f32_16x16x32_bf16 v[104:107], a[40:43], v[204:207], v[104:107]
  v_mov_b32 v57, v56
  v_mfma_f32_16x16x32_bf16 v[108:111], a[44:47], v[204:207], v[108:111]
  s_waitcnt lgkmcnt(4)
  v_mfma_f32_16x16x32_bf16 v[112:115], a[36:39], v[208:211], v[112:115]
  ds_read_b128 v[176:179], v18 offset:8192
  v_mfma_f32_16x16x32_bf16 v[116:119], a[40:43], v[208:211], v[116:119]
  s_nop 1
  v_mfma_f32_16x16x32_bf16 v[120:123], a[44:47], v[208:211], v[120:123]
  v_permlane16_swap_b32 v56, v57
  v_mfma_f32_16x16x32_bf16 v[124:127], a[36:39], v[212:215], v[124:127]
  ds_read_b128 v[180:183], v18 offset:10240
  v_add_f32 v56, v56, v57
  v_mfma_f32_16x16x32_bf16 v[128:131], a[40:43], v[212:215], v[128:131]
  buffer_load_dwordx4 v11, s[8:11], s30 offen offset:1024 lds
  v_mfma_f32_16x16x32_bf16 v[132:135], a[44:47], v[212:215], v[132:135]
  v_rcp_f32 v56, v56
  v_mfma_f32_16x16x32_bf16 v[136:139], a[36:39], v[216:219], v[136:139]
  ds_read_b128 v[184:187], v18 offset:12288
  s_nop 0
  v_mfma_f32_16x16x32_bf16 v[140:143], a[40:43], v[216:219], v[140:143]
  v_mul_f32 v36, v36, v56
  v_mul_f32 v37, v37, v56
  v_mfma_f32_16x16x32_bf16 v[144:147], a[44:47], v[216:219], v[144:147]
  v_mul_f32 v38, v38, v56
  v_mul_f32 v39, v39, v56
  v_mfma_f32_16x16x32_bf16 v[148:151], a[36:39], v[220:223], v[148:151]
  ds_read_b128 v[188:191], v18 offset:14336
  v_mul_f32 v40, v40, v56
  v_mfma_f32_16x16x32_bf16 v[152:155], a[40:43], v[220:223], v[152:155]
  v_mul_f32 v41, v41, v56
  v_mul_f32 v42, v42, v56
  v_mfma_f32_16x16x32_bf16 v[156:159], a[44:47], v[220:223], v[156:159]
  s_waitcnt lgkmcnt(4)
  v_mul_f32 v43, v43, v56
  v_mfma_f32_16x16x32_bf16 v[64:67], a[48:51], v[160:163], v[64:67]
  ds_read_b128 v[192:195], v19 offset:0
  v_max3_f32 v56, v44, v45, v46
  v_mfma_f32_16x16x32_bf16 v[68:71], a[52:55], v[160:163], v[68:71]
  v_add_u32 v18, s33, v14
  v_max3_f32 v56, v56, v47, v48
  v_mfma_f32_16x16x32_bf16 v[72:75], a[56:59], v[160:163], v[72:75]
  v_max3_f32 v56, v56, v49, v50
  v_max3_f32 v56, v56, v51, v52
  v_mfma_f32_16x16x32_bf16 v[76:79], a[48:51], v[164:167], v[76:79]
  ds_read_b128 v[196:199], v19 offset:2048
  v_max3_f32 v56, v56, v53, v54
  v_mfma_f32_16x16x32_bf16 v[80:83], a[52:55], v[164:167], v[80:83]
  buffer_load_dwordx4 v12, s[8:11], s30 offen offset:2048 lds
  v_mfma_f32_16x16x32_bf16 v[84:87], a[56:59], v[164:167], v[84:87]
  buffer_load_dwordx4 a[252:255], v31, s[52:55], s51 offen offset:1536 sc1
  v_mfma_f32_16x16x32_bf16 v[88:91], a[48:51], v[168:171], v[88:91]
  ds_read_b128 v[200:203], v19 offset:4096
  v_max_f32 v56, v56, v55
  v_mfma_f32_16x16x32_bf16 v[92:95], a[52:55], v[168:171], v[92:95]
  v_mov_b32 v57, v56
  v_mfma_f32_16x16x32_bf16 v[96:99], a[56:59], v[168:171], v[96:99]
  s_nop 1
  v_mfma_f32_16x16x32_bf16 v[100:103], a[48:51], v[172:175], v[100:103]
  ds_read_b128 v[204:207], v19 offset:6144
  v_mfma_f32_16x16x32_bf16 v[104:107], a[52:55], v[172:175], v[104:107]
  v_permlane32_swap_b32 v56, v57
  v_mfma_f32_16x16x32_bf16 v[108:111], a[56:59], v[172:175], v[108:111]
  s_waitcnt lgkmcnt(4)
  v_max_f32 v56, v56, v57
  v_mfma_f32_16x16x32_bf16 v[112:115], a[48:51], v[176:179], v[112:115]
  ds_read_b128 v[208:211], v19 offset:8192
  v_mov_b32 v57, v56
  v_mfma_f32_16x16x32_bf16 v[116:119], a[52:55], v[176:179], v[116:119]
  s_nop 1
  v_mfma_f32_16x16x32_bf16 v[120:123], a[56:59], v[176:179], v[120:123]
  v_permlane16_swap_b32 v56, v57
  v_mfma_f32_16x16x32_bf16 v[124:127], a[48:51], v[180:183], v[124:127]
  ds_read_b128 v[212:215], v19 offset:10240
  v_max_f32 v56, v56, v57
  v_mfma_f32_16x16x32_bf16 v[128:131], a[52:55], v[180:183], v[128:131]
  buffer_load_dwordx4 v13, s[8:11], s30 offen offset:3072 lds
  v_mfma_f32_16x16x32_bf16 v[132:135], a[56:59], v[180:183], v[132:135]
  s_add_u32 s30, s30, 128
  s_add_u32 m0, m0, 16384
  v_mfma_f32_16x16x32_bf16 v[136:139], a[48:51], v[184:187], v[136:139]
  ds_read_b128 v[216:219], v19 offset:12288
  v_mul_f32 v56, s83, v56
  v_mfma_f32_16x16x32_bf16 v[140:143], a[52:55], v[184:187], v[140:143]
  s_cmp_lt_u32 m0, s46
  s_cselect_b32 m0, m0, s47
  v_mfma_f32_16x16x32_bf16 v[144:147], a[56:59], v[184:187], v[144:147]
  v_fma_f32 v44, v44, s83, -v56
  v_fma_f32 v45, v45, s83, -v56
  v_mfma_f32_16x16x32_bf16 v[148:151], a[48:51], v[188:191], v[148:151]
  ds_read_b128 v[220:223], v19 offset:14336
  v_fma_f32 v46, v46, s83, -v56
  v_mfma_f32_16x16x32_bf16 v[152:155], a[52:55], v[188:191], v[152:155]
  v_fma_f32 v47, v47, s83, -v56
  v_fma_f32 v48, v48, s83, -v56
  v_mfma_f32_16x16x32_bf16 v[156:159], a[56:59], v[188:191], v[156:159]
  s_waitcnt vmcnt(16) lgkmcnt(4)
  s_barrier
  v_mfma_f32_16x16x32_bf16 v[64:67], a[60:63], v[192:195], v[64:67]
  ds_read_b128 v[160:163], v18 offset:0
  v_fma_f32 v49, v49, s83, -v56
  v_mfma_f32_16x16x32_bf16 v[68:71], a[64:67], v[192:195], v[68:71]
  buffer_load_dwordx4 v[24:27], v31, s[52:55], s51 offen offset:2048 sc1
  v_mfma_f32_16x16x32_bf16 v[72:75], a[68:71], v[192:195], v[72:75]
  v_add_u32 v19, s33, v15
  s_add_u32 s33, s33, 16384
  v_mfma_f32_16x16x32_bf16 v[76:79], a[60:63], v[196:199], v[76:79]
  ds_read_b128 v[164:167], v18 offset:2048
  v_fma_f32 v50, v50, s83, -v56
  v_mfma_f32_16x16x32_bf16 v[80:83], a[64:67], v[196:199], v[80:83]
  buffer_load_dwordx4 v10, s[8:11], s30 offen offset:0 lds
  v_mfma_f32_16x16x32_bf16 v[84:87], a[68:71], v[196:199], v[84:87]
  s_cmp_lt_u32 s33, 98304
  s_cselect_b32 s33, s33, 0
  v_mfma_f32_16x16x32_bf16 v[88:91], a[60:63], v[200:203], v[88:91]
  ds_read_b128 v[168:171], v18 offset:4096
  v_fma_f32 v51, v51, s83, -v56
  v_mfma_f32_16x16x32_bf16 v[92:95], a[64:67], v[200:203], v[92:95]
  v_fma_f32 v52, v52, s83, -v56
  v_fma_f32 v53, v53, s83, -v56
  v_mfma_f32_16x16x32_bf16 v[96:99], a[68:71], v[200:203], v[96:99]
  v_fma_f32 v54, v54, s83, -v56
  v_fma_f32 v55, v55, s83, -v56
  v_mfma_f32_16x16x32_bf16 v[100:103], a[60:63], v[204:207], v[100:103]
  ds_read_b128 v[172:175], v18 offset:6144
  v_mfma_f32_16x16x32_bf16 v[104:107], a[64:67], v[204:207], v[104:107]
  v_exp_f32 v44, v44
  v_mfma_f32_16x16x32_bf16 v[108:111], a[68:71], v[204:207], v[108:111]
  s_waitcnt lgkmcnt(4)
  v_mfma_f32_16x16x32_bf16 v[112:115], a[60:63], v[208:211], v[112:115]
  ds_read_b128 v[176:179], v18 offset:8192
  v_mfma_f32_16x16x32_bf16 v[116:119], a[64:67], v[208:211], v[116:119]
  v_exp_f32 v45, v45
  v_mfma_f32_16x16x32_bf16 v[120:123], a[68:71], v[208:211], v[120:123]
  v_exp_f32 v46, v46
  v_mfma_f32_16x16x32_bf16 v[124:127], a[60:63], v[212:215], v[124:127]
  ds_read_b128 v[180:183], v18 offset:10240
  v_mfma_f32_16x16x32_bf16 v[128:131], a[64:67], v[212:215], v[128:131]
  buffer_load_dwordx4 v11, s[8:11], s30 offen offset:1024 lds
  v_mfma_f32_16x16x32_bf16 v[132:135], a[68:71], v[212:215], v[132:135]
  v_exp_f32 v47, v47
  v_mfma_f32_16x16x32_bf16 v[136:139], a[60:63], v[216:219], v[136:139]
  ds_read_b128 v[184:187], v18 offset:12288
  v_mfma_f32_16x16x32_bf16 v[140:143], a[64:67], v[216:219], v[140:143]
  v_exp_f32 v48, v48
  v_mfma_f32_16x16x32_bf16 v[144:147], a[68:71], v[216:219], v[144:147]
  v_exp_f32 v49, v49
  v_mfma_f32_16x16x32_bf16 v[148:151], a[60:63], v[220:223], v[148:151]
  ds_read_b128 v[188:191], v18 offset:14336
  v_mfma_f32_16x16x32_bf16 v[152:155], a[64:67], v[220:223], v[152:155]
  buffer_load_dwordx4 v[6:9], v31, s[52:55], s51 offen offset:2560 sc1
  v_mfma_f32_16x16x32_bf16 v[156:159], a[68:71], v[220:223], v[156:159]
  s_waitcnt lgkmcnt(4)
  v_mfma_f32_16x16x32_bf16 v[64:67], a[72:75], v[160:163], v[64:67]
  ds_read_b128 v[192:195], v19 offset:0
  v_mfma_f32_16x16x32_bf16 v[68:71], a[76:79], v[160:163], v[68:71]
  v_add_u32 v18, s33, v14
  v_mfma_f32_16x16x32_bf16 v[72:75], a[80:83], v[160:163], v[72:75]
  v_exp_f32 v50, v50
  v_mfma_f32_16x16x32_bf16 v[76:79], a[72:75], v[164:167], v[76:79]
  ds_read_b128 v[196:199], v19 offset:2048
  v_mfma_f32_16x16x32_bf16 v[80:83], a[76:79], v[164:167], v[80:83]
  buffer_load_dwordx4 v12, s[8:11], s30 offen offset:2048 lds
  v_mfma_f32_16x16x32_bf16 v[84:87], a[80:83], v[164:167], v[84:87]
  v_exp_f32 v51, v51
  v_mfma_f32_16x16x32_bf16 v[88:91], a[72:75], v[168:171], v[88:91]
  ds_read_b128 v[200:203], v19 offset:4096
  v_mfma_f32_16x16x32_bf16 v[92:95], a[76:79], v[168:171], v[92:95]
  v_exp_f32 v52, v52
  v_mfma_f32_16x16x32_bf16 v[96:99], a[80:83], v[168:171], v[96:99]
  v_exp_f32 v53, v53
  v_mfma_f32_16x16x32_bf16 v[100:103], a[72:75], v[172:175], v[100:103]
  ds_read_b128 v[204:207], v19 offset:6144
  v_mfma_f32_16x16x32_bf16 v[104:107], a[76:79], v[172:175], v[104:107]
  v_exp_f32 v54, v54
  v_mfma_f32_16x16x32_bf16 v[108:111], a[80:83], v[172:175], v[108:111]
  s_waitcnt lgkmcnt(4)
  v_mfma_f32_16x16x32_bf16 v[112:115], a[72:75], v[176:179], v[112:115]
  ds_read_b128 v[208:211], v19 offset:8192
  v_mfma_f32_16x16x32_bf16 v[116:119], a[76:79], v[176:179], v[116:119]
  v_exp_f32 v55, v55
  v_mfma_f32_16x16x32_bf16 v[120:123], a[80:83], v[176:179], v[120:123]
  s_nop 0
  v_add_f32 v56, v52, v53
  v_mfma_f32_16x16x32_bf16 v[124:127], a[72:75], v[180:183], v[124:127]
  ds_read_b128 v[212:215], v19 offset:10240
  v_add_f32 v56, v56, v54
  v_mfma_f32_16x16x32_bf16 v[128:131], a[76:79], v[180:183], v[128:131]
  buffer_load_dwordx4 v13, s[8:11], s30 offen offset:3072 lds
  v_mfma_f32_16x16x32_bf16 v[132:135], a[80:83], v[180:183], v[132:135]
  s_add_u32 s30, s30, 128
  s_add_u32 m0, m0, 16384
  v_mfma_f32_16x16x32_bf16 v[136:139], a[72:75], v[184:187], v[136:139]
  ds_read_b128 v[216:219], v19 offset:12288
  s_add_u32 s21, s50, 4096
  v_mfma_f32_16x16x32_bf16 v[140:143], a[76:79], v[184:187], v[140:143]
  s_cmp_lt_u32 m0, s46
  s_cselect_b32 m0, m0, s47
  v_mfma_f32_16x16x32_bf16 v[144:147], a[80:83], v[184:187], v[144:147]
  buffer_load_dwordx4 v[60:63], v30, s[16:19], s21 offen offset:2048 sc1
  v_mfma_f32_16x16x32_bf16 v[148:151], a[72:75], v[188:191], v[148:151]
  ds_read_b128 v[220:223], v19 offset:14336
  v_add_f32 v56, v56, v55
  v_mfma_f32_16x16x32_bf16 v[152:155], a[76:79], v[188:191], v[152:155]
  v_cndmask_b32 v56, 0, v56, s[60:61]
  v_add_f32 v56, v56, v44
  v_mfma_f32_16x16x32_bf16 v[156:159], a[80:83], v[188:191], v[156:159]
  s_waitcnt vmcnt(19) lgkmcnt(4)
  s_barrier
  v_mfma_f32_16x16x32_bf16 v[64:67], a[84:87], v[192:195], v[64:67]
  ds_read_b128 v[160:163], v18 offset:0
  v_add_f32 v56, v56, v45
  v_mfma_f32_16x16x32_bf16 v[68:71], a[88:91], v[192:195], v[68:71]
  v_add_f32 v56, v56, v46
  v_add_f32 v56, v56, v47
  v_mfma_f32_16x16x32_bf16 v[72:75], a[92:95], v[192:195], v[72:75]
  v_add_u32 v19, s33, v15
  s_add_u32 s33, s33, 16384
  v_mfma_f32_16x16x32_bf16 v[76:79], a[84:87], v[196:199], v[76:79]
  ds_read_b128 v[164:167], v18 offset:2048
  v_add_f32 v56, v56, v48
  v_mfma_f32_16x16x32_bf16 v[80:83], a[88:91], v[196:199], v[80:83]
  buffer_load_dwordx4 v10, s[8:11], s30 offen offset:0 lds
  v_mfma_f32_16x16x32_bf16 v[84:87], a[92:95], v[196:199], v[84:87]
  s_cmp_lt_u32 s33, 98304
  s_cselect_b32 s33, s33, 0
  v_mfma_f32_16x16x32_bf16 v[88:91], a[84:87], v[200:203], v[88:91]
  ds_read_b128 v[168:171], v18 offset:4096
  v_add_f32 v56, v56, v49
  v_mfma_f32_16x16x32_bf16 v[92:95], a[88:91], v[200:203], v[92:95]
  v_add_f32 v56, v56, v50
  v_add_f32 v56, v56, v51
  v_mfma_f32_16x16x32_bf16 v[96:99], a[92:95], v[200:203], v[96:99]
  v_mov_b32 v57, v56
  v_mfma_f32_16x16x32_bf16 v[100:103], a[84:87], v[204:207], v[100:103]
  ds_read_b128 v[172:175], v18 offset:6144
  v_mfma_f32_16x16x32_bf16 v[104:107], a[88:91], v[204:207], v[104:107]
  s_nop 1
  v_mfma_f32_16x16x32_bf16 v[108:111], a[92:95], v[204:207], v[108:111]
  s_waitcnt lgkmcnt(4)
  v_mfma_f32_16x16x32_bf16 v[112:115], a[84:87], v[208:211], v[112:115]
  ds_read_b128 v[176:179], v18 offset:8192
  v_mfma_f32_16x16x32_bf16 v[116:119], a[88:91], v[208:211], v[116:119]
  v_permlane32_swap_b32 v56, v57
  v_mfma_f32_16x16x32_bf16 v[120:123], a[92:95], v[208:211], v[120:123]
  v_add_f32 v56, v56, v57
  v_mov_b32 v57, v56
  v_mfma_f32_16x16x32_bf16 v[124:127], a[84:87], v[212:215], v[124:127]
  ds_read_b128 v[180:183], v18 offset:10240
  v_mfma_f32_16x16x32_bf16 v[128:131], a[88:91], v[212:215], v[128:131]
  buffer_load_dwordx4 v11, s[8:11], s30 offen offset:1024 lds
  v_mfma_f32_16x16x32_bf16 v[132:135], a[92:95], v[212:215], v[132:135]
  s_add_u32 s21, s50, 8192
  v_mfma_f32_16x16x32_bf16 v[136:139], a[84:87], v[216:219], v[136:139]
  ds_read_b128 v[184:187], v18 offset:12288
  v_mfma_f32_16x16x32_bf16 v[140:143], a[88:91], v[216:219], v[140:143]
  buffer_load_dwordx4 v[248:251], v30, s[16:19], s21 offen offset:2048 sc1
  v_mfma_f32_16x16x32_bf16 v[144:147], a[92:95], v[216:219], v[144:147]
  s_nop 1
  v_mfma_f32_16x16x32_bf16 v[148:151], a[84:87], v[220:223], v[148:151]
  ds_read_b128 v[188:191], v18 offset:14336
  v_mfma_f32_16x16x32_bf16 v[152:155], a[88:91], v[220:223], v[152:155]
  v_permlane16_swap_b32 v56, v57
  v_mfma_f32_16x16x32_bf16 v[156:159], a[92:95], v[220:223], v[156:159]
  s_waitcnt lgkmcnt(4)
  v_add_f32 v56, v56, v57
  v_mfma_f32_16x16x32_bf16 v[64:67], a[96:99], v[160:163], v[64:67]
  ds_read_b128 v[192:195], v19 offset:0
  v_mfma_f32_16x16x32_bf16 v[68:71], a[100:103], v[160:163], v[68:71]
  v_add_u32 v18, s33, v14
  v_mfma_f32_16x16x32_bf16 v[72:75], a[104:107], v[160:163], v[72:75]
  v_rcp_f32 v56, v56
  v_mfma_f32_16x16x32_bf16 v[76:79], a[96:99], v[164:167], v[76:79]
  ds_read_b128 v[196:199], v19 offset:2048
  s_nop 0
  v_mfma_f32_16x16x32_bf16 v[80:83], a[100:103], v[164:167], v[80:83]
  buffer_load_dwordx4 v12, s[8:11], s30 offen offset:2048 lds
  v_mfma_f32_16x16x32_bf16 v[84:87], a[104:107], v[164:167], v[84:87]
  v_mul_f32 v44, v44, v56
  v_mul_f32 v45, v45, v56
  v_mfma_f32_16x16x32_bf16 v[88:91], a[96:99], v[168:171], v[88:91]
  ds_read_b128 v[200:203], v19 offset:4096
  v_mul_f32 v46, v46, v56
  v_mfma_f32_16x16x32_bf16 v[92:95], a[100:103], v[168:171], v[92:95]
  v_mul_f32 v47, v47, v56
  v_mul_f32 v48, v48, v56
  v_mfma_f32_16x16x32_bf16 v[96:99], a[104:107], v[168:171], v[96:99]
  v_mul_f32 v49, v49, v56
  v_mul_f32 v50, v50, v56
  v_mfma_f32_16x16x32_bf16 v[100:103], a[96:99], v[172:175], v[100:103]
  ds_read_b128 v[204:207], v19 offset:6144
  v_mul_f32 v51, v51, v56
  v_mfma_f32_16x16x32_bf16 v[104:107], a[100:103], v[172:175], v[104:107]
  v_mul_f32 v52, v52, v56
  v_mul_f32 v53, v53, v56
  v_mfma_f32_16x16x32_bf16 v[108:111], a[104:107], v[172:175], v[108:111]
  s_waitcnt lgkmcnt(4)
  v_mul_f32 v54, v54, v56
  v_mfma_f32_16x16x32_bf16 v[112:115], a[96:99], v[176:179], v[112:115]
  ds_read_b128 v[208:211], v19 offset:8192
  v_mul_f32 v55, v55, v56
  v_mfma_f32_16x16x32_bf16 v[116:119], a[100:103], v[176:179], v[116:119]
  v_cvt_pk_bf16_f32 v240, v40, v41
  v_cvt_pk_bf16_f32 v241, v42, v43
  v_mfma_f32_16x16x32_bf16 v[120:123], a[104:107], v[176:179], v[120:123]
  v_cvt_pk_bf16_f32 v242, v52, v53
  v_cvt_pk_bf16_f32 v243, v54, v55
  v_mfma_f32_16x16x32_bf16 v[124:127], a[96:99], v[180:183], v[124:127]
  ds_read_b128 v[212:215], v19 offset:10240
  s_add_u32 s21, s50, 8192
  v_mfma_f32_16x16x32_bf16 v[128:131], a[100:103], v[180:183], v[128:131]
  buffer_load_dwordx4 v13, s[8:11], s30 offen offset:3072 lds
  v_mfma_f32_16x16x32_bf16 v[132:135], a[104:107], v[180:183], v[132:135]
  s_add_u32 s30, s30, 128
  s_add_u32 m0, m0, 16384
  v_mfma_f32_16x16x32_bf16 v[136:139], a[96:99], v[184:187], v[136:139]
  ds_read_b128 v[216:219], v19 offset:12288
  v_cvt_pk_bf16_f32 v236, v44, v45
  v_mfma_f32_16x16x32_bf16 v[140:143], a[100:103], v[184:187], v[140:143]
  s_cmp_lt_u32 m0, s46
  s_cselect_b32 m0, m0, s47
  v_mfma_f32_16x16x32_bf16 v[144:147], a[104:107], v[184:187], v[144:147]
  buffer_load_dwordx4 v[252:255], v30, s[16:19], s21 offen offset:3072 sc1
  v_mfma_f32_16x16x32_bf16 v[148:151], a[96:99], v[188:191], v[148:151]
  ds_read_b128 v[220:223], v19 offset:14336
  v_cvt_pk_bf16_f32 v237, v46, v47
  v_mfma_f32_16x16x32_bf16 v[152:155], a[100:103], v[188:191], v[152:155]
  v_cvt_pk_bf16_f32 v238, v48, v49
  v_cvt_pk_bf16_f32 v239, v50, v51
  v_mfma_f32_16x16x32_bf16 v[156:159], a[104:107], v[188:191], v[156:159]
  s_waitcnt vmcnt(19) lgkmcnt(4)
  s_barrier
  v_mfma_f32_16x16x32_bf16 v[64:67], a[108:111], v[192:195], v[64:67]
  ds_read_b128 v[160:163], v18 offset:0
  v_cvt_pk_bf16_f32 v244, v36, v37
  v_mfma_f32_16x16x32_bf16 v[68:71], a[112:115], v[192:195], v[68:71]
  v_cvt_pk_bf16_f32 v245, v38, v39
  v_mfma_f32_16x16x32_bf16 v[72:75], a[116:119], v[192:195], v[72:75]
  v_add_u32 v19, s33, v15
  s_add_u32 s33, s33, 16384
  v_mfma_f32_16x16x32_bf16 v[76:79], a[108:111], v[196:199], v[76:79]
  ds_read_b128 v[164:167], v18 offset:2048
  v_mfma_f32_16x16x32_bf16 v[80:83], a[112:115], v[196:199], v[80:83]
  buffer_load_dwordx4 v10, s[8:11], s30 offen offset:0 lds
  v_mfma_f32_16x16x32_bf16 v[84:87], a[116:119], v[196:199], v[84:87]
  s_cmp_lt_u32 s33, 98304
  s_cselect_b32 s33, s33, 0
  v_mfma_f32_16x16x32_bf16 v[88:91], a[108:111], v[200:203], v[88:91]
  ds_read_b128 v[168:171], v18 offset:4096
  v_mfma_f32_16x16x32_bf16 v[92:95], a[112:115], v[200:203], v[92:95]
  v_permlane16_swap_b32 v240, v242
  v_mfma_f32_16x16x32_bf16 v[96:99], a[116:119], v[200:203], v[96:99]
  v_permlane16_swap_b32 v241, v243
  v_mfma_f32_16x16x32_bf16 v[100:103], a[108:111], v[204:207], v[100:103]
  ds_read_b128 v[172:175], v18 offset:6144
  v_mfma_f32_16x16x32_bf16 v[104:107], a[112:115], v[204:207], v[104:107]
  v_mfma_f32_16x16x32_bf16 v[108:111], a[116:119], v[204:207], v[108:111]
  s_waitcnt lgkmcnt(4)
  v_mfma_f32_16x16x32_bf16 v[112:115], a[108:111], v[208:211], v[112:115]
  ds_read_b128 v[176:179], v18 offset:8192
  v_mfma_f32_16x16x32_bf16 v[116:119], a[112:115], v[208:211], v[116:119]
  v_mfma_f32_16x16x32_bf16 v[120:123], a[116:119], v[208:211], v[120:123]
  v_mfma_f32_16x16x32_bf16 v[124:127], a[108:111], v[212:215], v[124:127]
  ds_read_b128 v[180:183], v18 offset:10240
  v_mfma_f32_16x16x32_bf16 v[128:131], a[112:115], v[212:215], v[128:131]
  buffer_load_dwordx4 v11, s[8:11], s30 offen offset:1024 lds
  v_mfma_f32_16x16x32_bf16 v[132:135], a[116:119], v[212:215], v[132:135]
  v_mfma_f32_16x16x32_bf16 v[136:139], a[108:111], v[216:219], v[136:139]
  ds_read_b128 v[184:187], v18 offset:12288
  v_mfma_f32_16x16x32_bf16 v[140:143], a[112:115], v[216:219], v[140:143]
  v_mfma_f32_16x16x32_bf16 v[144:147], a[116:119], v[216:219], v[144:147]
  v_mfma_f32_16x16x32_bf16 v[148:151], a[108:111], v[220:223], v[148:151]
  ds_read_b128 v[188:191], v18 offset:14336
  v_mfma_f32_16x16x32_bf16 v[152:155], a[112:115], v[220:223], v[152:155]
  v_mfma_f32_16x16x32_bf16 v[156:159], a[116:119], v[220:223], v[156:159]
  s_waitcnt lgkmcnt(4)
  v_mfma_f32_16x16x32_bf16 v[64:67], a[120:123], v[160:163], v[64:67]
  ds_read_b128 v[192:195], v19 offset:0
  v_mfma_f32_16x16x32_bf16 v[68:71], a[124:127], v[160:163], v[68:71]
  v_add_u32 v18, s33, v14
  v_mfma_f32_16x16x32_bf16 v[72:75], a[128:131], v[160:163], v[72:75]
  v_mfma_f32_16x16x32_bf16 v[76:79], a[120:123], v[164:167], v[76:79]
  ds_read_b128 v[196:199], v19 offset:2048
  v_mfma_f32_16x16x32_bf16 v[80:83], a[124:127], v[164:167], v[80:83]
  buffer_load_dwordx4 v12, s[8:11], s30 offen offset:2048 lds
  v_mfma_f32_16x16x32_bf16 v[84:87], a[128:131], v[164:167], v[84:87]
  v_mfma_f32_16x16x32_bf16 v[88:91], a[120:123], v[168:171], v[88:91]
  ds_read_b128 v[200:203], v19 offset:4096
  v_mfma_f32_16x16x32_bf16 v[92:95], a[124:127], v[168:171], v[92:95]
  v_mfma_f32_16x16x32_bf16 v[96:99], a[128:131], v[168:171], v[96:99]
  v_mfma_f32_16x16x32_bf16 v[100:103], a[120:123], v[172:175], v[100:103]
  ds_read_b128 v[204:207], v19 offset:6144
  v_mfma_f32_16x16x32_bf16 v[104:107], a[124:127], v[172:175], v[104:107]
  v_mfma_f32_16x16x32_bf16 v[108:111], a[128:131], v[172:175], v[108:111]
  s_waitcnt lgkmcnt(4)
  v_mfma_f32_16x16x32_bf16 v[112:115], a[120:123], v[176:179], v[112:115]
  ds_read_b128 v[208:211], v19 offset:8192
  v_mfma_f32_16x16x32_bf16 v[116:119], a[124:127], v[176:179], v[116:119]
  v_mfma_f32_16x16x32_bf16 v[120:123], a[128:131], v[176:179], v[120:123]
  v_mfma_f32_16x16x32_bf16 v[124:127], a[120:123], v[180:183], v[124:127]
  ds_read_b128 v[212:215], v19 offset:10240
  v_mfma_f32_16x16x32_bf16 v[128:131], a[124:127], v[180:183], v[128:131]
  buffer_load_dwordx4 v13, s[8:11], s30 offen offset:3072 lds
  v_mfma_f32_16x16x32_bf16 v[132:135], a[128:131], v[180:183], v[132:135]
  s_add_u32 s30, s30, s25
  s_sub_u32 s30, s30, 1152
  v_mfma_f32_16x16x32_bf16 v[136:139], a[120:123], v[184:187], v[136:139]
  ds_read_b128 v[216:219], v19 offset:12288
  s_mov_b32 s25, 163840
  v_mfma_f32_16x16x32_bf16 v[140:143], a[124:127], v[184:187], v[140:143]
  s_add_u32 m0, m0, 16384
  v_mfma_f32_16x16x32_bf16 v[144:147], a[128:131], v[184:187], v[144:147]
  s_cmp_lt_u32 m0, s46
  s_cselect_b32 m0, m0, s47
  v_mfma_f32_16x16x32_bf16 v[148:151], a[120:123], v[188:191], v[148:151]
  ds_read_b128 v[220:223], v19 offset:14336
  v_mfma_f32_16x16x32_bf16 v[152:155], a[124:127], v[188:191], v[152:155]
  v_mfma_f32_16x16x32_bf16 v[156:159], a[128:131], v[188:191], v[156:159]
  s_waitcnt vmcnt(17) lgkmcnt(4)
  s_barrier
  v_mfma_f32_16x16x32_bf16 v[64:67], a[132:135], v[192:195], v[64:67]
  ds_read_b128 v[160:163], v18 offset:0
  v_mfma_f32_16x16x32_bf16 v[68:71], a[136:139], v[192:195], v[68:71]
  v_mfma_f32_16x16x32_bf16 v[72:75], a[140:143], v[192:195], v[72:75]
  v_add_u32 v19, s33, v15
  s_add_u32 s33, s33, 16384
  v_mfma_f32_16x16x32_bf16 v[76:79], a[132:135], v[196:199], v[76:79]
  ds_read_b128 v[164:167], v18 offset:2048
  v_mfma_f32_16x16x32_bf16 v[80:83], a[136:139], v[196:199], v[80:83]
  buffer_load_dwordx4 v10, s[8:11], s30 offen offset:0 lds
  v_mfma_f32_16x16x32_bf16 v[84:87], a[140:143], v[196:199], v[84:87]
  s_cmp_lt_u32 s33, 98304
  s_cselect_b32 s33, s33, 0
  v_mfma_f32_16x16x32_bf16 v[88:91], a[132:135], v[200:203], v[88:91]
  ds_read_b128 v[168:171], v18 offset:4096
  v_mfma_f32_16x16x32_bf16 v[92:95], a[136:139], v[200:203], v[92:95]
  buffer_store_dwordx4 v[236:239], v30, s[56:59], s81 offen sc1
  v_mfma_f32_16x16x32_bf16 v[96:99], a[140:143], v[200:203], v[96:99]
  v_mfma_f32_16x16x32_bf16 v[100:103], a[132:135], v[204:207], v[100:103]
  ds_read_b128 v[172:175], v18 offset:6144
  v_mfma_f32_16x16x32_bf16 v[104:107], a[136:139], v[204:207], v[104:107]
  v_mfma_f32_16x16x32_bf16 v[108:111], a[140:143], v[204:207], v[108:111]
  s_waitcnt lgkmcnt(4)
  v_mfma_f32_16x16x32_bf16 v[112:115], a[132:135], v[208:211], v[112:115]
  ds_read_b128 v[176:179], v18 offset:8192
  v_mfma_f32_16x16x32_bf16 v[116:119], a[136:139], v[208:211], v[116:119]
  s_mov_b64 exec, 0xffffffff
  buffer_store_dwordx4 v[240:243], v30, s[56:59], s81 offen offset:1024 sc1
  s_mov_b64 exec, -1
  v_mfma_f32_16x16x32_bf16 v[120:123], a[140:143], v[208:211], v[120:123]
  v_mfma_f32_16x16x32_bf16 v[124:127], a[132:135], v[212:215], v[124:127]
  ds_read_b128 v[180:183], v18 offset:10240
  v_mfma_f32_16x16x32_bf16 v[128:131], a[136:139], v[212:215], v[128:131]
  buffer_load_dwordx4 v11, s[8:11], s30 offen offset:1024 lds
  v_mfma_f32_16x16x32_bf16 v[132:135], a[140:143], v[212:215], v[132:135]
  v_mfma_f32_16x16x32_bf16 v[136:139], a[132:135], v[216:219], v[136:139]
  ds_read_b128 v[184:187], v18 offset:12288
  v_mfma_f32_16x16x32_bf16 v[140:143], a[136:139], v[216:219], v[140:143]
  buffer_store_dwordx2 v[244:245], v32, s[56:59], s81 offen offset:2048 sc1
  v_mfma_f32_16x16x32_bf16 v[144:147], a[140:143], v[216:219], v[144:147]
  s_mov_b32 s78, s82
  s_mov_b32 s82, 0
  v_mfma_f32_16x16x32_bf16 v[148:151], a[132:135], v[220:223], v[148:151]
  ds_read_b128 v[188:191], v18 offset:14336
  s_mov_b32 s81, 0x80000000
  v_mfma_f32_16x16x32_bf16 v[152:155], a[136:139], v[220:223], v[152:155]
  v_mfma_f32_16x16x32_bf16 v[156:159], a[140:143], v[220:223], v[156:159]
  s_waitcnt lgkmcnt(4)
  s_add_u32 s21, s50, 0
  v_mfma_f32_16x16x32_bf16 v[64:67], a[144:147], v[160:163], v[64:67]
  ds_read_b128 v[192:195], v19 offset:0
  v_mfma_f32_16x16x32_bf16 v[68:71], a[148:151], v[160:163], v[68:71]
  v_add_u32 v18, s33, v14
  v_mfma_f32_16x16x32_bf16 v[72:75], a[152:155], v[160:163], v[72:75]
  buffer_load_dwordx4 v[36:39], v30, s[16:19], s21 offen offset:0 sc1
  v_mfma_f32_16x16x32_bf16 v[76:79], a[144:147], v[164:167], v[76:79]
  ds_read_b128 v[196:199], v19 offset:2048
  v_mfma_f32_16x16x32_bf16 v[80:83], a[148:151], v[164:167], v[80:83]
  buffer_load_dwordx4 v12, s[8:11], s30 offen offset:2048 lds
  v_mfma_f32_16x16x32_bf16 v[84:87], a[152:155], v[164:167], v[84:87]
  v_mfma_f32_16x16x32_bf16 v[88:91], a[144:147], v[168:171], v[88:91]
  ds_read_b128 v[200:203], v19 offset:4096
  v_mfma_f32_16x16x32_bf16 v[92:95], a[148:151], v[168:171], v[92:95]
  v_mfma_f32_16x16x32_bf16 v[96:99], a[152:155], v[168:171], v[96:99]
  v_mfma_f32_16x16x32_bf16 v[100:103], a[144:147], v[172:175], v[100:103]
  ds_read_b128 v[204:207], v19 offset:6144
  v_mfma_f32_16x16x32_bf16 v[104:107], a[148:151], v[172:175], v[104:107]
  v_mfma_f32_16x16x32_bf16 v[108:111], a[152:155], v[172:175], v[108:111]
  s_waitcnt lgkmcnt(4)
  v_mfma_f32_16x16x32_bf16 v[112:115], a[144:147], v[176:179], v[112:115]
  ds_read_b128 v[208:211], v19 offset:8192
  s_add_u32 s21, s50, 0
  v_mfma_f32_16x16x32_bf16 v[116:119], a[148:151], v[176:179], v[116:119]
  buffer_load_dwordx4 v[40:43], v30, s[16:19], s21 offen offset:1024 sc1
  v_mfma_f32_16x16x32_bf16 v[120:123], a[152:155], v[176:179], v[120:123]
  v_mfma_f32_16x16x32_bf16 v[124:127], a[144:147], v[180:183], v[124:127]
  ds_read_b128 v[212:215], v19 offset:10240
  v_mfma_f32_16x16x32_bf16 v[128:131], a[148:151], v[180:183], v[128:131]
  buffer_load_dwordx4 v13, s[8:11], s30 offen offset:3072 lds
  v_mfma_f32_16x16x32_bf16 v[132:135], a[152:155], v[180:183], v[132:135]
  s_add_u32 s30, s30, 128
  s_add_u32 m0, m0, 16384
  v_mfma_f32_16x16x32_bf16 v[136:139], a[144:147], v[184:187], v[136:139]
  ds_read_b128 v[216:219], v19 offset:12288
  v_mfma_f32_16x16x32_bf16 v[140:143], a[148:151], v[184:187], v[140:143]
  s_cmp_lt_u32 m0, s46
  s_cselect_b32 m0, m0, s47
  v_mfma_f32_16x16x32_bf16 v[144:147], a[152:155], v[184:187], v[144:147]
  v_mfma_f32_16x16x32_bf16 v[148:151], a[144:147], v[188:191], v[148:151]
  ds_read_b128 v[220:223], v19 offset:14336
  v_mfma_f32_16x16x32_bf16 v[152:155], a[148:151], v[188:191], v[152:155]
  v_mfma_f32_16x16x32_bf16 v[156:159], a[152:155], v[188:191], v[156:159]
  s_waitcnt vmcnt(20) lgkmcnt(4)
  s_barrier
  v_mfma_f32_16x16x32_bf16 v[64:67], a[156:159], v[192:195], v[64:67]
  ds_read_b128 v[160:163], v18 offset:0
  s_add_u32 s21, s50, 0
  v_mfma_f32_16x16x32_bf16 v[68:71], a[160:163], v[192:195], v[68:71]
  buffer_load_dwordx4 v[44:47], v30, s[16:19], s21 offen offset:2048 sc1
  v_mfma_f32_16x16x32_bf16 v[72:75], a[164:167], v[192:195], v[72:75]
  v_add_u32 v19, s33, v15
  s_add_u32 s33, s33, 16384
  v_mfma_f32_16x16x32_bf16 v[76:79], a[156:159], v[196:199], v[76:79]
  ds_read_b128 v[164:167], v18 offset:2048
  v_mfma_f32_16x16x32_bf16 v[80:83], a[160:163], v[196:199], v[80:83]
  buffer_load_dwordx4 v10, s[8:11], s30 offen offset:0 lds
  v_mfma_f32_16x16x32_bf16 v[84:87], a[164:167], v[196:199], v[84:87]
  s_cmp_lt_u32 s33, 98304
  s_cselect_b32 s33, s33, 0
  v_mfma_f32_16x16x32_bf16 v[88:91], a[156:159], v[200:203], v[88:91]
  ds_read_b128 v[168:171], v18 offset:4096
  v_mfma_f32_16x16x32_bf16 v[92:95], a[160:163], v[200:203], v[92:95]
  v_mfma_f32_16x16x32_bf16 v[96:99], a[164:167], v[200:203], v[96:99]
  v_mfma_f32_16x16x32_bf16 v[100:103], a[156:159], v[204:207], v[100:103]
  ds_read_b128 v[172:175], v18 offset:6144
  v_mfma_f32_16x16x32_bf16 v[104:107], a[160:163], v[204:207], v[104:107]
  v_mfma_f32_16x16x32_bf16 v[108:111], a[164:167], v[204:207], v[108:111]
  s_waitcnt lgkmcnt(4)
  s_add_u32 s21, s50, 0
  v_mfma_f32_16x16x32_bf16 v[112:115], a[156:159], v[208:211], v[112:115]
  ds_read_b128 v[176:179], v18 offset:8192
  v_mfma_f32_16x16x32_bf16 v[116:119], a[160:163], v[208:211], v[116:119]
  buffer_load_dwordx4 v[48:51], v30, s[16:19], s21 offen offset:3072 sc1
  v_mfma_f32_16x16x32_bf16 v[120:123], a[164:167], v[208:211], v[120:123]
  v_mfma_f32_16x16x32_bf16 v[124:127], a[156:159], v[212:215], v[124:127]
  ds_read_b128 v[180:183], v18 offset:10240
  v_mfma_f32_16x16x32_bf16 v[128:131], a[160:163], v[212:215], v[128:131]
  buffer_load_dwordx4 v11, s[8:11], s30 offen offset:1024 lds
  v_mfma_f32_16x16x32_bf16 v[132:135], a[164:167], v[212:215], v[132:135]
  v_mfma_f32_16x16x32_bf16 v[136:139], a[156:159], v[216:219], v[136:139]
  ds_read_b128 v[184:187], v18 offset:12288
  v_mfma_f32_16x16x32_bf16 v[140:143], a[160:163], v[216:219], v[140:143]
  v_mfma_f32_16x16x32_bf16 v[144:147], a[164:167], v[216:219], v[144:147]
  v_mfma_f32_16x16x32_bf16 v[148:151], a[156:159], v[220:223], v[148:151]
  ds_read_b128 v[188:191], v18 offset:14336
  v_mfma_f32_16x16x32_bf16 v[152:155], a[160:163], v[220:223], v[152:155]
  v_mfma_f32_16x16x32_bf16 v[156:159], a[164:167], v[220:223], v[156:159]
  s_waitcnt lgkmcnt(4)
  s_add_u32 s21, s50, 4096
  v_mfma_f32_16x16x32_bf16 v[64:67], a[168:171], v[160:163], v[64:67]
  ds_read_b128 v[192:195], v19 offset:0
  v_mfma_f32_16x16x32_bf16 v[68:71], a[172:175], v[160:163], v[68:71]
  v_add_u32 v18, s33, v14
  v_mfma_f32_16x16x32_bf16 v[72:75], a[176:179], v[160:163], v[72:75]
  buffer_load_dwordx4 v[52:55], v30, s[16:19], s21 offen offset:0 sc1
  v_mfma_f32_16x16x32_bf16 v[76:79], a[168:171], v[164:167], v[76:79]
  ds_read_b128 v[196:199], v19 offset:2048
  v_mfma_f32_16x16x32_bf16 v[80:83], a[172:175], v[164:167], v[80:83]
  buffer_load_dwordx4 v12, s[8:11], s30 offen offset:2048 lds
  v_mfma_f32_16x16x32_bf16 v[84:87], a[176:179], v[164:167], v[84:87]
  v_mfma_f32_16x16x32_bf16 v[88:91], a[168:171], v[168:171], v[88:91]
  ds_read_b128 v[200:203], v19 offset:4096
  v_mfma_f32_16x16x32_bf16 v[92:95], a[172:175], v[168:171], v[92:95]
  v_mfma_f32_16x16x32_bf16 v[96:99], a[176:179], v[168:171], v[96:99]
  v_mfma_f32_16x16x32_bf16 v[100:103], a[168:171], v[172:175], v[100:103]
  ds_read_b128 v[204:207], v19 offset:6144
  v_mfma_f32_16x16x32_bf16 v[104:107], a[172:175], v[172:175], v[104:107]
  v_mfma_f32_16x16x32_bf16 v[108:111], a[176:179], v[172:175], v[108:111]
  s_waitcnt lgkmcnt(4)
  v_mfma_f32_16x16x32_bf16 v[112:115], a[168:171], v[176:179], v[112:115]
  ds_read_b128 v[208:211], v19 offset:8192
  s_add_u32 s21, s50, 4096
  v_mfma_f32_16x16x32_bf16 v[116:119], a[172:175], v[176:179], v[116:119]
  buffer_load_dwordx4 v[56:59], v30, s[16:19], s21 offen offset:1024 sc1
  v_mfma_f32_16x16x32_bf16 v[120:123], a[176:179], v[176:179], v[120:123]
  v_mfma_f32_16x16x32_bf16 v[124:127], a[168:171], v[180:183], v[124:127]
  ds_read_b128 v[212:215], v19 offset:10240
  v_mfma_f32_16x16x32_bf16 v[128:131], a[172:175], v[180:183], v[128:131]
  buffer_load_dwordx4 v13, s[8:11], s30 offen offset:3072 lds
  v_mfma_f32_16x16x32_bf16 v[132:135], a[176:179], v[180:183], v[132:135]
  s_add_u32 s30, s30, 128
  s_add_u32 m0, m0, 16384
  v_mfma_f32_16x16x32_bf16 v[136:139], a[168:171], v[184:187], v[136:139]
  ds_read_b128 v[216:219], v19 offset:12288
  v_mfma_f32_16x16x32_bf16 v[140:143], a[172:175], v[184:187], v[140:143]
  s_cmp_lt_u32 m0, s46
  s_cselect_b32 m0, m0, s47
  v_mfma_f32_16x16x32_bf16 v[144:147], a[176:179], v[184:187], v[144:147]
  v_mfma_f32_16x16x32_bf16 v[148:151], a[168:171], v[188:191], v[148:151]
  ds_read_b128 v[220:223], v19 offset:14336
  v_mfma_f32_16x16x32_bf16 v[152:155], a[172:175], v[188:191], v[152:155]
  v_mfma_f32_16x16x32_bf16 v[156:159], a[176:179], v[188:191], v[156:159]
  s_waitcnt vmcnt(22) lgkmcnt(4)
  s_barrier
  v_mfma_f32_16x16x32_bf16 v[64:67], a[180:183], v[192:195], v[64:67]
  ds_read_b128 v[160:163], v18 offset:0
  s_add_u32 s21, s50, 4096
  v_mfma_f32_16x16x32_bf16 v[68:71], a[184:187], v[192:195], v[68:71]
  buffer_load_dwordx4 v[236:239], v30, s[16:19], s21 offen offset:3072 sc1
  v_mfma_f32_16x16x32_bf16 v[72:75], a[188:191], v[192:195], v[72:75]
  v_add_u32 v19, s33, v15
  s_add_u32 s33, s33, 16384
  v_mfma_f32_16x16x32_bf16 v[76:79], a[180:183], v[196:199], v[76:79]
  ds_read_b128 v[164:167], v18 offset:2048
  v_mfma_f32_16x16x32_bf16 v[80:83], a[184:187], v[196:199], v[80:83]
  buffer_load_dwordx4 v10, s[8:11], s30 offen offset:0 lds
  v_mfma_f32_16x16x32_bf16 v[84:87], a[188:191], v[196:199], v[84:87]
  s_cmp_lt_u32 s33, 98304
  s_cselect_b32 s33, s33, 0
  v_mfma_f32_16x16x32_bf16 v[88:91], a[180:183], v[200:203], v[88:91]
  ds_read_b128 v[168:171], v18 offset:4096
  v_mfma_f32_16x16x32_bf16 v[92:95], a[184:187], v[200:203], v[92:95]
  v_mfma_f32_16x16x32_bf16 v[96:99], a[188:191], v[200:203], v[96:99]
  v_mfma_f32_16x16x32_bf16 v[100:103], a[180:183], v[204:207], v[100:103]
  ds_read_b128 v[172:175], v18 offset:6144
  v_mfma_f32_16x16x32_bf16 v[104:107], a[184:187], v[204:207], v[104:107]
  v_mfma_f32_16x16x32_bf16 v[108:111], a[188:191], v[204:207], v[108:111]
  s_waitcnt lgkmcnt(4)
  s_add_u32 s21, s50, 8192
  v_mfma_f32_16x16x32_bf16 v[112:115], a[180:183], v[208:211], v[112:115]
  ds_read_b128 v[176:179], v18 offset:8192
  v_mfma_f32_16x16x32_bf16 v[116:119], a[184:187], v[208:211], v[116:119]
  buffer_load_dwordx4 v[240:243], v30, s[16:19], s21 offen offset:0 sc1
  v_mfma_f32_16x16x32_bf16 v[120:123], a[188:191], v[208:211], v[120:123]
  v_mfma_f32_16x16x32_bf16 v[124:127], a[180:183], v[212:215], v[124:127]
  ds_read_b128 v[180:183], v18 offset:10240
  v_mfma_f32_16x16x32_bf16 v[128:131], a[184:187], v[212:215], v[128:131]
  buffer_load_dwordx4 v11, s[8:11], s30 offen offset:1024 lds
  v_mfma_f32_16x16x32_bf16 v[132:135], a[188:191], v[212:215], v[132:135]
  v_mfma_f32_16x16x32_bf16 v[136:139], a[180:183], v[216:219], v[136:139]
  ds_read_b128 v[184:187], v18 offset:12288
  v_mfma_f32_16x16x32_bf16 v[140:143], a[184:187], v[216:219], v[140:143]
  v_mfma_f32_16x16x32_bf16 v[144:147], a[188:191], v[216:219], v[144:147]
  v_mfma_f32_16x16x32_bf16 v[148:151], a[180:183], v[220:223], v[148:151]
  ds_read_b128 v[188:191], v18 offset:14336
  v_mfma_f32_16x16x32_bf16 v[152:155], a[184:187], v[220:223], v[152:155]
  v_mfma_f32_16x16x32_bf16 v[156:159], a[188:191], v[220:223], v[156:159]
  s_waitcnt lgkmcnt(4)
  s_add_u32 s21, s50, 8192
  v_mfma_f32_16x16x32_bf16 v[64:67], a[192:195], v[160:163], v[64:67]
  ds_read_b128 v[192:195], v19 offset:0
  v_mfma_f32_16x16x32_bf16 v[68:71], a[196:199], v[160:163], v[68:71]
  v_add_u32 v18, s33, v14
  v_mfma_f32_16x16x32_bf16 v[72:75], a[200:203], v[160:163], v[72:75]
  buffer_load_dwordx4 v[244:247], v30, s[16:19], s21 offen offset:1024 sc1
  v_mfma_f32_16x16x32_bf16 v[76:79], a[192:195], v[164:167], v[76:79]
  ds_read_b128 v[196:199], v19 offset:2048
  v_mfma_f32_16x16x32_bf16 v[80:83], a[196:199], v[164:167], v[80:83]
  buffer_load_dwordx4 v12, s[8:11], s30 offen offset:2048 lds
  v_mfma_f32_16x16x32_bf16 v[84:87], a[200:203], v[164:167], v[84:87]
  v_mfma_f32_16x16x32_bf16 v[88:91], a[192:195], v[168:171], v[88:91]
  ds_read_b128 v[200:203], v19 offset:4096
  v_mfma_f32_16x16x32_bf16 v[92:95], a[196:199], v[168:171], v[92:95]
  v_mfma_f32_16x16x32_bf16 v[96:99], a[200:203], v[168:171], v[96:99]
  v_mfma_f32_16x16x32_bf16 v[100:103], a[192:195], v[172:175], v[100:103]
  ds_read_b128 v[204:207], v19 offset:6144
  v_mfma_f32_16x16x32_bf16 v[104:107], a[196:199], v[172:175], v[104:107]
  v_mfma_f32_16x16x32_bf16 v[108:111], a[200:203], v[172:175], v[108:111]
  s_waitcnt lgkmcnt(4)
  v_mfma_f32_16x16x32_bf16 v[112:115], a[192:195], v[176:179], v[112:115]
  ds_read_b128 v[208:211], v19 offset:8192
  v_mfma_f32_16x16x32_bf16 v[116:119], a[196:199], v[176:179], v[116:119]
  v_mfma_f32_16x16x32_bf16 v[120:123], a[200:203], v[176:179], v[120:123]
  v_mfma_f32_16x16x32_bf16 v[124:127], a[192:195], v[180:183], v[124:127]
  ds_read_b128 v[212:215], v19 offset:10240
  v_mfma_f32_16x16x32_bf16 v[128:131], a[196:199], v[180:183], v[128:131]
  buffer_load_dwordx4 v13, s[8:11], s30 offen offset:3072 lds
  v_mfma_f32_16x16x32_bf16 v[132:135], a[200:203], v[180:183], v[132:135]
  s_add_u32 s30, s30, 128
  s_add_u32 m0, m0, 16384
  v_mfma_f32_16x16x32_bf16 v[136:139], a[192:195], v[184:187], v[136:139]
  ds_read_b128 v[216:219], v19 offset:12288
  v_mfma_f32_16x16x32_bf16 v[140:143], a[196:199], v[184:187], v[140:143]
  s_cmp_lt_u32 m0, s46
  s_cselect_b32 m0, m0, s47
  v_mfma_f32_16x16x32_bf16 v[144:147], a[200:203], v[184:187], v[144:147]
  v_mfma_f32_16x16x32_bf16 v[148:151], a[192:195], v[188:191], v[148:151]
  ds_read_b128 v[220:223], v19 offset:14336
  v_mfma_f32_16x16x32_bf16 v[152:155], a[196:199], v[188:191], v[152:155]
  v_mfma_f32_16x16x32_bf16 v[156:159], a[200:203], v[188:191], v[156:159]
  s_waitcnt vmcnt(24) lgkmcnt(4)
  s_barrier
  v_mfma_f32_16x16x32_bf16 v[64:67], a[204:207], v[192:195], v[64:67]
  ds_read_b128 v[160:163], v18 offset:0
  v_mfma_f32_16x16x32_bf16 v[68:71], a[208:211], v[192:195], v[68:71]
  v_mfma_f32_16x16x32_bf16 v[72:75], a[212:215], v[192:195], v[72:75]
  v_add_u32 v19, s33, v15
  s_add_u32 s33, s33, 16384
  v_mfma_f32_16x16x32_bf16 v[76:79], a[204:207], v[196:199], v[76:79]
  ds_read_b128 v[164:167], v18 offset:2048
  v_mfma_f32_16x16x32_bf16 v[80:83], a[208:211], v[196:199], v[80:83]
  buffer_load_dwordx4 v10, s[8:11], s30 offen offset:0 lds
  v_mfma_f32_16x16x32_bf16 v[84:87], a[212:215], v[196:199], v[84:87]
  s_cmp_lt_u32 s33, 98304
  s_cselect_b32 s33, s33, 0
  v_mfma_f32_16x16x32_bf16 v[88:91], a[204:207], v[200:203], v[88:91]
  ds_read_b128 v[168:171], v18 offset:4096
  v_mfma_f32_16x16x32_bf16 v[92:95], a[208:211], v[200:203], v[92:95]
  v_mfma_f32_16x16x32_bf16 v[96:99], a[212:215], v[200:203], v[96:99]
  v_mfma_f32_16x16x32_bf16 v[100:103], a[204:207], v[204:207], v[100:103]
  ds_read_b128 v[172:175], v18 offset:6144
  v_mfma_f32_16x16x32_bf16 v[104:107], a[208:211], v[204:207], v[104:107]
  v_mfma_f32_16x16x32_bf16 v[108:111], a[212:215], v[204:207], v[108:111]
  s_waitcnt lgkmcnt(4)
  v_mfma_f32_16x16x32_bf16 v[112:115], a[204:207], v[208:211], v[112:115]
  ds_read_b128 v[176:179], v18 offset:8192
  v_mfma_f32_16x16x32_bf16 v[116:119], a[208:211], v[208:211], v[116:119]
  v_mfma_f32_16x16x32_bf16 v[120:123], a[212:215], v[208:211], v[120:123]
  v_mfma_f32_16x16x32_bf16 v[124:127], a[204:207], v[212:215], v[124:127]
  ds_read_b128 v[180:183], v18 offset:10240
  v_mfma_f32_16x16x32_bf16 v[128:131], a[208:211], v[212:215], v[128:131]
  buffer_load_dwordx4 v11, s[8:11], s30 offen offset:1024 lds
  v_mfma_f32_16x16x32_bf16 v[132:135], a[212:215], v[212:215], v[132:135]
  v_mfma_f32_16x16x32_bf16 v[136:139], a[204:207], v[216:219], v[136:139]
  ds_read_b128 v[184:187], v18 offset:12288
  v_mfma_f32_16x16x32_bf16 v[140:143], a[208:211], v[216:219], v[140:143]
  v_mfma_f32_16x16x32_bf16 v[144:147], a[212:215], v[216:219], v[144:147]
  v_mfma_f32_16x16x32_bf16 v[148:151], a[204:207], v[220:223], v[148:151]
  ds_read_b128 v[188:191], v18 offset:14336
  v_mfma_f32_16x16x32_bf16 v[152:155], a[208:211], v[220:223], v[152:155]
  v_mfma_f32_16x16x32_bf16 v[156:159], a[212:215], v[220:223], v[156:159]
  s_waitcnt lgkmcnt(4)
  v_mfma_f32_16x16x32_bf16 v[64:67], a[216:219], v[160:163], v[64:67]
  ds_read_b128 v[192:195], v19 offset:0
  v_mfma_f32_16x16x32_bf16 v[68:71], a[220:223], v[160:163], v[68:71]
  v_add_u32 v18, s33, v14
  v_mfma_f32_16x16x32_bf16 v[72:75], a[224:227], v[160:163], v[72:75]
  v_mfma_f32_16x16x32_bf16 v[76:79], a[216:219], v[164:167], v[76:79]
  ds_read_b128 v[196:199], v19 offset:2048
  v_mfma_f32_16x16x32_bf16 v[80:83], a[220:223], v[164:167], v[80:83]
  buffer_load_dwordx4 v12, s[8:11], s30 offen offset:2048 lds
  v_mfma_f32_16x16x32_bf16 v[84:87], a[224:227], v[164:167], v[84:87]
  v_mfma_f32_16x16x32_bf16 v[88:91], a[216:219], v[168:171], v[88:91]
  ds_read_b128 v[200:203], v19 offset:4096
  v_mfma_f32_16x16x32_bf16 v[92:95], a[220:223], v[168:171], v[92:95]
  v_mfma_f32_16x16x32_bf16 v[96:99], a[224:227], v[168:171], v[96:99]
  v_mfma_f32_16x16x32_bf16 v[100:103], a[216:219], v[172:175], v[100:103]
  ds_read_b128 v[204:207], v19 offset:6144
  v_mfma_f32_16x16x32_bf16 v[104:107], a[220:223], v[172:175], v[104:107]
  v_mfma_f32_16x16x32_bf16 v[108:111], a[224:227], v[172:175], v[108:111]
  s_waitcnt lgkmcnt(4)
  v_mfma_f32_16x16x32_bf16 v[112:115], a[216:219], v[176:179], v[112:115]
  ds_read_b128 v[208:211], v19 offset:8192
  v_mfma_f32_16x16x32_bf16 v[116:119], a[220:223], v[176:179], v[116:119]
  v_mfma_f32_16x16x32_bf16 v[120:123], a[224:227], v[176:179], v[120:123]
  v_mfma_f32_16x16x32_bf16 v[124:127], a[216:219], v[180:183], v[124:127]
  ds_read_b128 v[212:215], v19 offset:10240
  v_mfma_f32_16x16x32_bf16 v[128:131], a[220:223], v[180:183], v[128:131]
  buffer_load_dwordx4 v13, s[8:11], s30 offen offset:3072 lds
  v_mfma_f32_16x16x32_bf16 v[132:135], a[224:227], v[180:183], v[132:135]
  s_add_u32 s30, s30, 128
  s_add_u32 m0, m0, 16384
  v_mfma_f32_16x16x32_bf16 v[136:139], a[216:219], v[184:187], v[136:139]
  ds_read_b128 v[216:219], v19 offset:12288
  v_mfma_f32_16x16x32_bf16 v[140:143], a[220:223], v[184:187], v[140:143]
  s_cmp_lt_u32 m0, s46
  s_cselect_b32 m0, m0, s47
  v_mfma_f32_16x16x32_bf16 v[144:147], a[224:227], v[184:187], v[144:147]
  v_mfma_f32_16x16x32_bf16 v[148:151], a[216:219], v[188:191], v[148:151]
  ds_read_b128 v[220:223], v19 offset:14336
  v_mfma_f32_16x16x32_bf16 v[152:155], a[220:223], v[188:191], v[152:155]
  v_mfma_f32_16x16x32_bf16 v[156:159], a[224:227], v[188:191], v[156:159]
  s_waitcnt vmcnt(19) lgkmcnt(4)
  s_barrier
  v_mfma_f32_16x16x32_bf16 v[64:67], a[228:231], v[192:195], v[64:67]
  ds_read_b128 v[160:163], v18 offset:0
  v_mfma_f32_16x16x32_bf16 v[68:71], a[232:235], v[192:195], v[68:71]
  s_waitcnt vmcnt(22)
  s_cmp_eq_u32 s78, 0
  s_cbranch_scc1 pf_226
  v_mov_b32 v4, 0
  v_mov_b32 v5, 1
  s_mov_b64 exec, 1
  buffer_atomic_add v5, v4, s[72:75], s78 offen sc1
  s_mov_b64 exec, -1
  s_mov_b32 s78, 0
pf_226:
  buffer_load_dword v21, v33, s[72:75], s77 offen sc1
  v_mfma_f32_16x16x32_bf16 v[72:75], a[236:239], v[192:195], v[72:75]
  v_add_u32 v19, s33, v15
  s_add_u32 s33, s33, 16384
  v_mfma_f32_16x16x32_bf16 v[76:79], a[228:231], v[196:199], v[76:79]
  ds_read_b128 v[164:167], v18 offset:2048
  v_cvt_pk_bf16_f32 v224, v64, v65
  v_cvt_pk_bf16_f32 v225, v66, v67
  v_mfma_f32_16x16x32_bf16 v[80:83], a[232:235], v[196:199], v[80:83]
  buffer_load_dwordx4 v10, s[8:11], s30 offen offset:0 lds
  v_cvt_pk_bf16_f32 v226, v68, v69
  v_cvt_pk_bf16_f32 v227, v70, v71
  v_mfma_f32_16x16x32_bf16 v[84:87], a[236:239], v[196:199], v[84:87]
  s_cmp_lt_u32 s33, 98304
  s_cselect_b32 s33, s33, 0
  v_cvt_pk_bf16_f32 v228, v72, v73
  v_cvt_pk_bf16_f32 v229, v74, v75
  v_mfma_f32_16x16x32_bf16 v[88:91], a[228:231], v[200:203], v[88:91]
  ds_read_b128 v[168:171], v18 offset:4096
  ds_write_b64 v22, v[224:225] offset:0
  v_mfma_f32_16x16x32_bf16 v[92:95], a[232:235], v[200:203], v[92:95]
  ds_write_b64 v22, v[226:227] offset:8
  ds_write_b64 v16, v[228:229] offset:64
  v_mfma_f32_16x16x32_bf16 v[96:99], a[236:239], v[200:203], v[96:99]
  v_cvt_pk_bf16_f32 v230, v76, v77
  v_cvt_pk_bf16_f32 v231, v78, v79
  v_cvt_pk_bf16_f32 v232, v80, v81
  v_cvt_pk_bf16_f32 v233, v82, v83
  v_mfma_f32_16x16x32_bf16 v[100:103], a[228:231], v[204:207], v[100:103]
  ds_read_b128 v[172:175], v18 offset:6144
  v_cvt_pk_bf16_f32 v234, v84, v85
  v_cvt_pk_bf16_f32 v235, v86, v87
  v_mfma_f32_16x16x32_bf16 v[104:107], a[232:235], v[204:207], v[104:107]
  ds_write_b64 v22, v[230:231] offset:6400
  ds_write_b64 v22, v[232:233] offset:6408
  v_mfma_f32_16x16x32_bf16 v[108:111], a[236:239], v[204:207], v[108:111]
  s_waitcnt lgkmcnt(9)
  ds_write_b64 v16, v[234:235] offset:6464
  v_cvt_pk_bf16_f32 v224, v88, v89
  v_mfma_f32_16x16x32_bf16 v[112:115], a[228:231], v[208:211], v[112:115]
  ds_read_b128 v[176:179], v18 offset:8192
  v_cvt_pk_bf16_f32 v225, v90, v91
  v_cvt_pk_bf16_f32 v226, v92, v93
  v_cvt_pk_bf16_f32 v227, v94, v95
  v_mfma_f32_16x16x32_bf16 v[116:119], a[232:235], v[208:211], v[116:119]
  v_cvt_pk_bf16_f32 v228, v96, v97
  v_cvt_pk_bf16_f32 v229, v98, v99
  ds_write_b64 v22, v[224:225] offset:12800
  v_mfma_f32_16x16x32_bf16 v[120:123], a[236:239], v[208:211], v[120:123]
  ds_write_b64 v22, v[226:227] offset:12808
  ds_write_b64 v16, v[228:229] offset:12864
  v_mfma_f32_16x16x32_bf16 v[124:127], a[228:231], v[212:215], v[124:127]
  ds_read_b128 v[180:183], v18 offset:10240
  v_cvt_pk_bf16_f32 v230, v100, v101
  v_cvt_pk_bf16_f32 v231, v102, v103
  v_cvt_pk_bf16_f32 v232, v104, v105
  v_mfma_f32_16x16x32_bf16 v[128:131], a[232:235], v[212:215], v[128:131]
  buffer_load_dwordx4 v11, s[8:11], s30 offen offset:1024 lds
  v_cvt_pk_bf16_f32 v233, v106, v107
  v_cvt_pk_bf16_f32 v234, v108, v109
  v_mfma_f32_16x16x32_bf16 v[132:135], a[236:239], v[212:215], v[132:135]
  v_cvt_pk_bf16_f32 v235, v110, v111
  ds_write_b64 v22, v[230:231] offset:19200
  v_mfma_f32_16x16x32_bf16 v[136:139], a[228:231], v[216:219], v[136:139]
  ds_read_b128 v[184:187], v18 offset:12288
  ds_write_b64 v22, v[232:233] offset:19208
  v_mfma_f32_16x16x32_bf16 v[140:143], a[232:235], v[216:219], v[140:143]
  ds_write_b64 v16, v[234:235] offset:19264
  v_cvt_pk_bf16_f32 v224, v112, v113
  v_cvt_pk_bf16_f32 v225, v114, v115
  v_mfma_f32_16x16x32_bf16 v[144:147], a[236:239], v[216:219], v[144:147]
  v_cvt_pk_bf16_f32 v226, v116, v117
  v_cvt_pk_bf16_f32 v227, v118, v119
  v_cvt_pk_bf16_f32 v228, v120, v121
  v_cvt_pk_bf16_f32 v229, v122, v123
  v_mfma_f32_16x16x32_bf16 v[148:151], a[228:231], v[220:223], v[148:151]
  ds_read_b128 v[188:191], v18 offset:14336
  ds_write_b64 v22, v[224:225] offset:25600
  v_mfma_f32_16x16x32_bf16 v[152:155], a[232:235], v[220:223], v[152:155]
  ds_write_b64 v22, v[226:227] offset:25608
  ds_write_b64 v16, v[228:229] offset:25664
  v_mfma_f32_16x16x32_bf16 v[156:159], a[236:239], v[220:223], v[156:159]
  v_cvt_pk_bf16_f32 v230, v124, v125
  v_cvt_pk_bf16_f32 v231, v126, v127
  v_cvt_pk_bf16_f32 v232, v128, v129
  v_cvt_pk_bf16_f32 v233, v130, v131
qa_end_228:
  v_cvt_pk_bf16_f32 v234, v132, v133
  v_cvt_pk_bf16_f32 v235, v134, v135
  ds_write_b64 v22, v[230:231] offset:32000
  ds_write_b64 v22, v[232:233] offset:32008
  ds_write_b64 v16, v[234:235] offset:32064
  v_cvt_pk_bf16_f32 v224, v136, v137
  v_cvt_pk_bf16_f32 v225, v138, v139
  v_cvt_pk_bf16_f32 v226, v140, v141
  v_cvt_pk_bf16_f32 v227, v142, v143
  v_cvt_pk_bf16_f32 v228, v144, v145
  v_cvt_pk_bf16_f32 v229, v146, v147
  ds_write_b64 v22, v[224:225] offset:38400
  ds_write_b64 v22, v[226:227] offset:38408
  ds_write_b64 v16, v[228:229] offset:38464
  v_cvt_pk_bf16_f32 v230, v148, v149
  v_cvt_pk_bf16_f32 v231, v150, v151
  v_cvt_pk_bf16_f32 v232, v152, v153
  v_cvt_pk_bf16_f32 v233, v154, v155
  v_cvt_pk_bf16_f32 v234, v156, v157
  v_cvt_pk_bf16_f32 v235, v158, v159
  ds_write_b64 v22, v[230:231] offset:44800
  ds_write_b64 v22, v[232:233] offset:44808
  ds_write_b64 v16, v[234:235] offset:44864
  s_cmp_eq_u32 s80, 1
  s_cselect_b32 s21, s79, 0
  s_cmp_ge_u32 s21, 8
  s_cbranch_scc0 qx_231
  s_waitcnt lgkmcnt(0) vmcnt(5)
  s_barrier
  ds_read_b128 v[64:67], v29 offset:0
  ds_read_b128 v[88:91], v29 offset:6400
  ds_read_b128 v[68:71], v29 offset:64
  ds_read_b128 v[92:95], v29 offset:6464
  ds_read_b128 v[72:75], v29 offset:128
  ds_read_b128 v[96:99], v29 offset:6528
  ds_read_b128 v[76:79], v29 offset:192
  ds_read_b128 v[100:103], v29 offset:6592
  ds_read_b128 v[80:83], v29 offset:256
  ds_read_b128 v[104:107], v29 offset:6656
  ds_read_b128 v[84:87], v29 offset:320
  ds_read_b128 v[108:111], v29 offset:6720
  s_waitcnt lgkmcnt(10)
  v_mfma_f32_16x16x32_bf16 v[112:115], v[36:39], v[64:67], 0
  v_mfma_f32_16x16x32_bf16 v[116:119], a[240:243], v[64:67], 0
  v_mfma_f32_16x16x32_bf16 v[120:123], v[36:39], v[88:91], 0
  v_mfma_f32_16x16x32_bf16 v[124:127], v[60:63], v[88:91], 0
  v_mfma_f32_16x16x32_bf16 v[128:131], a[240:243], v[88:91], 0
  s_waitcnt lgkmcnt(8)
  v_mfma_f32_16x16x32_bf16 v[112:115], v[40:43], v[68:71], v[112:115]
  v_mfma_f32_16x16x32_bf16 v[116:119], a[244:247], v[68:71], v[116:119]
  v_mfma_f32_16x16x32_bf16 v[120:123], v[40:43], v[92:95], v[120:123]
  v_mfma_f32_16x16x32_bf16 v[124:127], v[236:239], v[92:95], v[124:127]
  v_mfma_f32_16x16x32_bf16 v[128:131], a[244:247], v[92:95], v[128:131]
  s_waitcnt lgkmcnt(6)
  v_mfma_f32_16x16x32_bf16 v[112:115], v[44:47], v[72:75], v[112:115]
  v_mfma_f32_16x16x32_bf16 v[116:119], a[248:251], v[72:75], v[116:119]
  v_mfma_f32_16x16x32_bf16 v[120:123], v[44:47], v[96:99], v[120:123]
  v_mfma_f32_16x16x32_bf16 v[124:127], v[240:243], v[96:99], v[124:127]
  v_mfma_f32_16x16x32_bf16 v[128:131], a[248:251], v[96:99], v[128:131]
  s_waitcnt lgkmcnt(4)
  v_mfma_f32_16x16x32_bf16 v[112:115], v[48:51], v[76:79], v[112:115]
  v_mfma_f32_16x16x32_bf16 v[116:119], a[252:255], v[76:79], v[116:119]
  v_mfma_f32_16x16x32_bf16 v[120:123], v[48:51], v[100:103], v[120:123]
  v_mfma_f32_16x16x32_bf16 v[124:127], v[244:247], v[100:103], v[124:127]
  v_mfma_f32_16x16x32_bf16 v[128:131], a[252:255], v[100:103], v[128:131]
  s_waitcnt lgkmcnt(2)
  v_mfma_f32_16x16x32_bf16 v[112:115], v[52:55], v[80:83], v[112:115]
  v_mfma_f32_16x16x32_bf16 v[116:119], v[24:27], v[80:83], v[116:119]
  v_mfma_f32_16x16x32_bf16 v[120:123], v[52:55], v[104:107], v[120:123]
  v_mfma_f32_16x16x32_bf16 v[124:127], v[248:251], v[104:107], v[124:127]
  v_mfma_f32_16x16x32_bf16 v[128:131], v[24:27], v[104:107], v[128:131]
  s_waitcnt lgkmcnt(0)
  v_mfma_f32_16x16x32_bf16 v[112:115], v[56:59], v[84:87], v[112:115]
  v_mfma_f32_16x16x32_bf16 v[116:119], v[6:9], v[84:87], v[116:119]
  v_mfma_f32_16x16x32_bf16 v[120:123], v[56:59], v[108:111], v[120:123]
  v_mfma_f32_16x16x32_bf16 v[124:127], v[252:255], v[108:111], v[124:127]
  v_mfma_f32_16x16x32_bf16 v[128:131], v[6:9], v[108:111], v[128:131]
  s_branch qx_230
qx_231:
  buffer_load_dword v21, v33, s[72:75], s77 offen sc1
  s_waitcnt vmcnt(0)
  s_mul_i32 s21, s49, 393216
  s_mul_i32 s22, s42, 12288
  s_add_u32 s50, s21, s22
  s_mul_i32 s21, s49, 98304
  s_mul_i32 s22, s42, 3072
  s_add_u32 s51, s21, s22
  s_lshr_b32 s22, s49, 1
  s_lshr_b32 s21, s49, 2
  s_add_u32 s21, s21, 3
  s_cmp_lt_u32 s49, 12
  s_cselect_b32 s21, s22, s21
  s_lshl_b32 s21, s21, 3
  s_lshr_b32 s22, s42, 2
  s_add_u32 s21, s21, s22
  s_lshl_b32 s21, s21, 7
  s_add_u32 s76, s21, 0
  s_lshl_b32 s77, s42, 7
  s_add_u32 s77, s77, 19456
  s_add_u32 s23, s49, 1
  s_waitcnt vmcnt(6)
  v_cmp_gt_u32 vcc, s23, v21
  s_mov_b32 s80, 0
  s_nop 0
  s_cbranch_vccnz qk_233
  s_mov_b32 s80, 1
  buffer_load_dwordx4 a[240:243], v31, s[52:55], s51 offen offset:0 sc1
  buffer_load_dwordx4 a[244:247], v31, s[52:55], s51 offen offset:512 sc1
  buffer_load_dwordx4 a[248:251], v31, s[52:55], s51 offen offset:1024 sc1
  buffer_load_dwordx4 a[252:255], v31, s[52:55], s51 offen offset:1536 sc1
  buffer_load_dwordx4 v[24:27], v31, s[52:55], s51 offen offset:2048 sc1
  buffer_load_dwordx4 v[6:9], v31, s[52:55], s51 offen offset:2560 sc1
qk_233:
  s_cmp_ge_u32 s79, 8
  s_cbranch_scc1 qk_232
  v_mov_b32 v156, 0
  s_mov_b32 s101, 0
wf_234:
  buffer_load_dword v157, v156, s[72:75], s76 offen sc1
  s_add_u32 s101, s101, 1
  s_cmp_gt_u32 s101, 131072
  s_cbranch_scc1 main_end
  s_waitcnt vmcnt(0)
  v_readfirstlane_b32 s100, v157
  s_cmp_ge_u32 s100, 8
  s_cbranch_scc1 wf_235
  s_sleep 2
  s_branch wf_234
wf_235:
  s_add_u32 s21, s50, 0
  buffer_load_dwordx4 v[36:39], v30, s[16:19], s21 offen offset:0 sc1
  buffer_load_dwordx4 v[40:43], v30, s[16:19], s21 offen offset:1024 sc1
  buffer_load_dwordx4 v[44:47], v30, s[16:19], s21 offen offset:2048 sc1
  buffer_load_dwordx4 v[48:51], v30, s[16:19], s21 offen offset:3072 sc1
  s_add_u32 s21, s50, 4096
  buffer_load_dwordx4 v[52:55], v30, s[16:19], s21 offen offset:0 sc1
  buffer_load_dwordx4 v[56:59], v30, s[16:19], s21 offen offset:1024 sc1
  buffer_load_dwordx4 v[60:63], v30, s[16:19], s21 offen offset:2048 sc1
  buffer_load_dwordx4 v[236:239], v30, s[16:19], s21 offen offset:3072 sc1
  s_add_u32 s21, s50, 8192
  buffer_load_dwordx4 v[240:243], v30, s[16:19], s21 offen offset:0 sc1
  buffer_load_dwordx4 v[244:247], v30, s[16:19], s21 offen offset:1024 sc1
  buffer_load_dwordx4 v[248:251], v30, s[16:19], s21 offen offset:2048 sc1
  buffer_load_dwordx4 v[252:255], v30, s[16:19], s21 offen offset:3072 sc1
qk_232:
  s_waitcnt lgkmcnt(0)
  s_barrier
  ds_read_b128 v[64:67], v29 offset:0
  ds_read_b128 v[68:71], v29 offset:64
  ds_read_b128 v[72:75], v29 offset:128
  ds_read_b128 v[76:79], v29 offset:192
  ds_read_b128 v[80:83], v29 offset:256
  ds_read_b128 v[84:87], v29 offset:320
  ds_read_b128 v[88:91], v29 offset:6400
  ds_read_b128 v[92:95], v29 offset:6464
  ds_read_b128 v[96:99], v29 offset:6528
  ds_read_b128 v[100:103], v29 offset:6592
  ds_read_b128 v[104:107], v29 offset:6656
  ds_read_b128 v[108:111], v29 offset:6720
  s_waitcnt lgkmcnt(0)
  s_cmp_eq_u32 s80, 1
  s_cselect_b32 s21, s79, 0
  s_cmp_ge_u32 s21, 8
  s_cbranch_scc1 qw_236
  s_waitcnt vmcnt(0)
qw_236:
  v_mfma_f32_16x16x32_bf16 v[112:115], v[36:39], v[64:67], 0
  v_mfma_f32_16x16x32_bf16 v[120:123], v[36:39], v[88:91], 0
  v_mfma_f32_16x16x32_bf16 v[124:127], v[60:63], v[88:91], 0
  v_mfma_f32_16x16x32_bf16 v[112:115], v[40:43], v[68:71], v[112:115]
  v_mfma_f32_16x16x32_bf16 v[120:123], v[40:43], v[92:95], v[120:123]
  v_mfma_f32_16x16x32_bf16 v[124:127], v[236:239], v[92:95], v[124:127]
  v_mfma_f32_16x16x32_bf16 v[112:115], v[44:47], v[72:75], v[112:115]
  v_mfma_f32_16x16x32_bf16 v[120:123], v[44:47], v[96:99], v[120:123]
  v_mfma_f32_16x16x32_bf16 v[124:127], v[240:243], v[96:99], v[124:127]
  v_mfma_f32_16x16x32_bf16 v[112:115], v[48:51], v[76:79], v[112:115]
  v_mfma_f32_16x16x32_bf16 v[120:123], v[48:51], v[100:103], v[120:123]
  v_mfma_f32_16x16x32_bf16 v[124:127], v[244:247], v[100:103], v[124:127]
  v_mfma_f32_16x16x32_bf16 v[112:115], v[52:55], v[80:83], v[112:115]
  v_mfma_f32_16x16x32_bf16 v[120:123], v[52:55], v[104:107], v[120:123]
  v_mfma_f32_16x16x32_bf16 v[124:127], v[248:251], v[104:107], v[124:127]
  v_mfma_f32_16x16x32_bf16 v[112:115], v[56:59], v[84:87], v[112:115]
  v_mfma_f32_16x16x32_bf16 v[120:123], v[56:59], v[108:111], v[120:123]
  v_mfma_f32_16x16x32_bf16 v[124:127], v[252:255], v[108:111], v[124:127]
  s_cmp_eq_u32 s80, 1
  s_cbranch_scc1 qm_237
  s_add_u32 s23, s49, 1
  s_mov_b32 s101, 0
wm_238:
  buffer_load_dword v156, v33, s[72:75], s77 offen sc1
  s_add_u32 s101, s101, 1
  s_cmp_gt_u32 s101, 131072
  s_cbranch_scc1 main_end
  s_waitcnt vmcnt(0)
  v_cmp_gt_u32 vcc, s23, v156
  v_readfirstlane_b32 s100, v156
  s_nop 0
  s_cbranch_vccz wm_239
  s_sleep 16
  s_add_u32 s100, s100, 2
  s_cmp_ge_u32 s100, s23
  s_cbranch_scc1 wm_238
  s_sleep 90
  s_branch wm_238
wm_239:
  buffer_load_dwordx4 a[240:243], v31, s[52:55], s51 offen offset:0 sc1
  buffer_load_dwordx4 a[244:247], v31, s[52:55], s51 offen offset:512 sc1
  buffer_load_dwordx4 a[248:251], v31, s[52:55], s51 offen offset:1024 sc1
  buffer_load_dwordx4 a[252:255], v31, s[52:55], s51 offen offset:1536 sc1
  buffer_load_dwordx4 v[24:27], v31, s[52:55], s51 offen offset:2048 sc1
  buffer_load_dwordx4 v[6:9], v31, s[52:55], s51 offen offset:2560 sc1
qm_237:
  s_waitcnt vmcnt(0)
  v_mfma_f32_16x16x32_bf16 v[116:119], a[240:243], v[64:67], 0
  v_mfma_f32_16x16x32_bf16 v[128:131], a[240:243], v[88:91], 0
  v_mfma_f32_16x16x32_bf16 v[116:119], a[244:247], v[68:71], v[116:119]
  v_mfma_f32_16x16x32_bf16 v[128:131], a[244:247], v[92:95], v[128:131]
  v_mfma_f32_16x16x32_bf16 v[116:119], a[248:251], v[72:75], v[116:119]
  v_mfma_f32_16x16x32_bf16 v[128:131], a[248:251], v[96:99], v[128:131]
  v_mfma_f32_16x16x32_bf16 v[116:119], a[252:255], v[76:79], v[116:119]
  v_mfma_f32_16x16x32_bf16 v[128:131], a[252:255], v[100:103], v[128:131]
  v_mfma_f32_16x16x32_bf16 v[116:119], v[24:27], v[80:83], v[116:119]
  v_mfma_f32_16x16x32_bf16 v[128:131], v[24:27], v[104:107], v[128:131]
  v_mfma_f32_16x16x32_bf16 v[116:119], v[6:9], v[84:87], v[116:119]
  v_mfma_f32_16x16x32_bf16 v[128:131], v[6:9], v[108:111], v[128:131]
qx_230:
  s_lshl_b32 s21, s49, 5
  s_add_u32 s21, s21, s42
  s_mul_i32 s81, s21, 2560
  s_lshl_b32 s82, s49, 3
  s_and_b32 s21, s42, 7
  s_add_u32 s82, s82, s21
  s_lshl_b32 s82, s82, 7
  s_add_u32 s82, s82, 23552
  s_cmp_gt_u32 s26, 1
  s_cselect_b32 s21, s80, 0
  s_cmp_eq_u32 s21, 0
  s_cbranch_scc1 qi_241
  v_mov_b32 v36, v112
  v_mov_b32 v37, v113
  v_mov_b32 v38, v114
  v_mov_b32 v39, v115
  v_mov_b32 v40, v116
  v_mov_b32 v41, v117
  v_mov_b32 v42, v118
  v_mov_b32 v43, v119
  v_mov_b32 v44, v120
  v_mov_b32 v45, v121
  v_mov_b32 v46, v122
  v_mov_b32 v47, v123
  v_mov_b32 v48, v124
  v_mov_b32 v49, v125
  v_mov_b32 v50, v126
  v_mov_b32 v51, v127
  v_mov_b32 v52, v128
  v_mov_b32 v53, v129
  v_mov_b32 v54, v130
  v_mov_b32 v55, v131
  s_branch qd_240
qi_241:
  v_cndmask_b32 v112, v34, v112, s[64:65]
  v_cndmask_b32 v124, v34, v124, s[64:65]
  v_cndmask_b32 v113, v34, v113, s[66:67]
  v_cndmask_b32 v125, v34, v125, s[66:67]
  v_cndmask_b32 v114, v34, v114, s[68:69]
  v_cndmask_b32 v126, v34, v126, s[68:69]
  v_cndmask_b32 v115, v34, v115, s[70:71]
  v_cndmask_b32 v127, v34, v127, s[70:71]
  v_max3_f32 v156, v112, v113, v114
  v_max3_f32 v156, v156, v115, v116
  v_max3_f32 v156, v156, v117, v118
  v_max_f32 v156, v156, v119
  v_mov_b32 v157, v156
  s_nop 1
  v_permlane32_swap_b32 v156, v157
  v_max_f32 v156, v156, v157
  v_mov_b32 v157, v156
  s_nop 1
  v_permlane16_swap_b32 v156, v157
  v_max_f32 v156, v156, v157
  v_mul_f32 v156, s83, v156
  v_fma_f32 v112, v112, s83, -v156
  v_fma_f32 v113, v113, s83, -v156
  v_fma_f32 v114, v114, s83, -v156
  v_fma_f32 v115, v115, s83, -v156
  v_fma_f32 v116, v116, s83, -v156
  v_fma_f32 v117, v117, s83, -v156
  v_fma_f32 v118, v118, s83, -v156
  v_fma_f32 v119, v119, s83, -v156
  v_exp_f32 v112, v112
  v_exp_f32 v113, v113
  v_exp_f32 v114, v114
  v_exp_f32 v115, v115
  v_exp_f32 v116, v116
  v_exp_f32 v117, v117
  v_exp_f32 v118, v118
  v_exp_f32 v119, v119
  s_nop 0
  v_add_f32 v156, v116, v117
  v_add_f32 v156, v156, v118
  v_add_f32 v156, v156, v119
  v_cndmask_b32 v156, 0, v156, s[60:61]
  v_add_f32 v156, v156, v112
  v_add_f32 v156, v156, v113
  v_add_f32 v156, v156, v114
  v_add_f32 v156, v156, v115
  v_mov_b32 v157, v156
  s_nop 1
  v_permlane32_swap_b32 v156, v157
  v_add_f32 v156, v156, v157
  v_mov_b32 v157, v156
  s_nop 1
  v_permlane16_swap_b32 v156, v157
  v_add_f32 v156, v156, v157
  v_rcp_f32 v156, v156
  s_nop 0
  v_mul_f32 v112, v112, v156
  v_mul_f32 v113, v113, v156
  v_mul_f32 v114, v114, v156
  v_mul_f32 v115, v115, v156
  v_mul_f32 v116, v116, v156
  v_mul_f32 v117, v117, v156
  v_mul_f32 v118, v118, v156
  v_mul_f32 v119, v119, v156
  v_max3_f32 v156, v120, v121, v122
  v_max3_f32 v156, v156, v123, v124
  v_max3_f32 v156, v156, v125, v126
  v_max3_f32 v156, v156, v127, v128
  v_max3_f32 v156, v156, v129, v130
  v_max_f32 v156, v156, v131
  v_mov_b32 v157, v156
  s_nop 1
  v_permlane32_swap_b32 v156, v157
  v_max_f32 v156, v156, v157
  v_mov_b32 v157, v156
  s_nop 1
  v_permlane16_swap_b32 v156, v157
  v_max_f32 v156, v156, v157
  v_mul_f32 v156, s83, v156
  v_fma_f32 v120, v120, s83, -v156
  v_fma_f32 v121, v121, s83, -v156
  v_fma_f32 v122, v122, s83, -v156
  v_fma_f32 v123, v123, s83, -v156
  v_fma_f32 v124, v124, s83, -v156
  v_fma_f32 v125, v125, s83, -v156
  v_fma_f32 v126, v126, s83, -v156
  v_fma_f32 v127, v127, s83, -v156
  v_fma_f32 v128, v128, s83, -v156
  v_fma_f32 v129, v129, s83, -v156
  v_fma_f32 v130, v130, s83, -v156
  v_fma_f32 v131, v131, s83, -v156
  v_exp_f32 v120, v120
  v_exp_f32 v121, v121
  v_exp_f32 v122, v122
  v_exp_f32 v123, v123
  v_exp_f32 v124, v124
  v_exp_f32 v125, v125
  v_exp_f32 v126, v126
  v_exp_f32 v127, v127
  v_exp_f32 v128, v128
  v_exp_f32 v129, v129
  v_exp_f32 v130, v130
  v_exp_f32 v131, v131
  s_nop 0
  v_add_f32 v156, v128, v129
  v_add_f32 v156, v156, v130
  v_add_f32 v156, v156, v131
  v_cndmask_b32 v156, 0, v156, s[60:61]
  v_add_f32 v156, v156, v120
  v_add_f32 v156, v156, v121
  v_add_f32 v156, v156, v122
  v_add_f32 v156, v156, v123
  v_add_f32 v156, v156, v124
  v_add_f32 v156, v156, v125
  v_add_f32 v156, v156, v126
  v_add_f32 v156, v156, v127
  v_mov_b32 v157, v156
  s_nop 1
  v_permlane32_swap_b32 v156, v157
  v_add_f32 v156, v156, v157
  v_mov_b32 v157, v156
  s_nop 1
  v_permlane16_swap_b32 v156, v157
  v_add_f32 v156, v156, v157
  v_rcp_f32 v156, v156
  s_nop 0
  v_mul_f32 v120, v120, v156
  v_mul_f32 v121, v121, v156
  v_mul_f32 v122, v122, v156
  v_mul_f32 v123, v123, v156
  v_mul_f32 v124, v124, v156
  v_mul_f32 v125, v125, v156
  v_mul_f32 v126, v126, v156
  v_mul_f32 v127, v127, v156
  v_mul_f32 v128, v128, v156
  v_mul_f32 v129, v129, v156
  v_mul_f32 v130, v130, v156
  v_mul_f32 v131, v131, v156
  v_cvt_pk_bf16_f32 v196, v116, v117
  v_cvt_pk_bf16_f32 v197, v118, v119
  v_cvt_pk_bf16_f32 v198, v128, v129
  v_cvt_pk_bf16_f32 v199, v130, v131
  v_cvt_pk_bf16_f32 v192, v120, v121
  v_cvt_pk_bf16_f32 v193, v122, v123
  v_cvt_pk_bf16_f32 v194, v124, v125
  v_cvt_pk_bf16_f32 v195, v126, v127
  v_cvt_pk_bf16_f32 v200, v112, v113
  v_cvt_pk_bf16_f32 v201, v114, v115
  v_permlane16_swap_b32 v196, v198
  v_permlane16_swap_b32 v197, v199
  buffer_store_dwordx4 v[192:195], v30, s[56:59], s81 offen sc1
  s_mov_b64 exec, 0xffffffff
  buffer_store_dwordx4 v[196:199], v30, s[56:59], s81 offen offset:1024 sc1
  s_mov_b64 exec, -1
  buffer_store_dwordx2 v[200:201], v32, s[56:59], s81 offen offset:2048 sc1
  s_mov_b32 s78, s82
  s_mov_b32 s81, 0x80000000
  s_mov_b32 s82, 0
  s_cmp_eq_u32 s80, 1
  s_cbranch_scc1 qd_240
  s_waitcnt vmcnt(0)
  s_cmp_eq_u32 s78, 0
  s_cbranch_scc1 pf_242
  v_mov_b32 v4, 0
  v_mov_b32 v5, 1
  s_mov_b64 exec, 1
  buffer_atomic_add v5, v4, s[72:75], s78 offen sc1
  s_mov_b64 exec, -1
  s_mov_b32 s78, 0
pf_242:
qd_240:
  s_add_u32 s49, s49, s29
qbe_229:
  s_sub_u32 s26, s26, 1
  s_cmp_gt_u32 s26, 0
  s_waitcnt lgkmcnt(0)
  s_cbranch_scc1 qa_blk_227
  s_waitcnt vmcnt(0) lgkmcnt(0)
  s_cmp_eq_u32 s78, 0
  s_cbranch_scc1 pf_243
  v_mov_b32 v4, 0
  v_mov_b32 v5, 1
  s_mov_b64 exec, 1
  buffer_atomic_add v5, v4, s[72:75], s78 offen sc1
  s_mov_b64 exec, -1
  s_mov_b32 s78, 0
pf_243:
  s_branch q_done
q_final:
  s_mov_b32 s16, s38
  s_mov_b32 s17, s39
  s_mov_b32 s18, 50331648
  s_mov_b32 s19, 0x00020000
  s_add_u32 s52, s38, 50331648
  s_addc_u32 s53, s39, 0
  s_mov_b32 s54, 6291456
  s_mov_b32 s55, 0x00020000
  s_add_u32 s56, s38, 85983232
  s_addc_u32 s57, s39, 0
  s_mov_b32 s58, 5242880
  s_mov_b32 s59, 0x00020000
  s_mul_i32 s21, s20, 12800
  s_add_u32 s21, s21, 98304
  v_mul_u32_u24 v4, 400, v2
  v_lshlrev_b32 v5, 4, v3
  v_add3_u32 v29, v4, v5, s21
  v_lshlrev_b32 v30, 4, v1
  v_and_b32 v4, 1, v2
  v_bfe_u32 v5, v2, 1, 1
  v_lshl_or_b32 v4, v5, 2, v4
  v_bfe_u32 v5, v2, 2, 1
  v_lshl_or_b32 v4, v5, 1, v4
  v_lshlrev_b32 v4, 4, v4
  v_lshl_add_u32 v31, v3, 7, v4
  v_lshlrev_b32 v32, 3, v1
  v_and_b32 v4, 3, v1
  v_lshlrev_b32 v33, 3, v4
  v_mov_b32 v34, 0xf149f2ca
  v_lshlrev_b32 v4, 2, v3
  v_sub_u32 v35, v2, v4
  v_cmp_gt_u32 s[60:61], 2, v3
  s_mov_b32 s62, 0x3d93cd3a
  s_mov_b32 s63, 0x3fb8aa3b
  s_mov_b32 s83, 0x3dd53b95
  v_cmp_le_i32 s[64:65], 0, v35
  v_cmp_le_i32 s[66:67], 1, v35
  v_cmp_le_i32 s[68:69], 2, v35
  v_cmp_le_i32 s[70:71], 3, v35
  s_add_u32 s49, s20, 56
  s_mov_b32 s29, 4
  s_mov_b32 s78, 0
  s_add_u32 s12, s38, 57671680
  s_addc_u32 s13, s39, 0
  s_mov_b32 s14, 3145728
  s_mov_b32 s15, 0x00020000
qf_244:
  s_mul_i32 s21, s49, 393216
  s_mul_i32 s22, s42, 12288
  s_add_u32 s50, s21, s22
  s_mul_i32 s21, s49, 98304
  s_mul_i32 s22, s42, 3072
  s_add_u32 s51, s21, s22
  s_lshr_b32 s22, s49, 1
  s_lshr_b32 s21, s49, 2
  s_add_u32 s21, s21, 3
  s_cmp_lt_u32 s49, 12
  s_cselect_b32 s21, s22, s21
  s_lshl_b32 s21, s21, 3
  s_lshr_b32 s22, s42, 2
  s_add_u32 s21, s21, s22
  s_lshl_b32 s21, s21, 7
  s_add_u32 s76, s21, 0
  s_lshl_b32 s77, s42, 7
  s_add_u32 s77, s77, 19456
  s_sub_u32 s43, s50, 22020096
  buffer_load_dword v21, v33, s[72:75], s77 offen sc1
  s_add_u32 s21, s50, 0
  buffer_load_dwordx4 v[36:39], v30, s[16:19], s21 offen offset:0 sc1
  buffer_load_dwordx4 v[40:43], v30, s[16:19], s21 offen offset:1024 sc1
  buffer_load_dwordx4 v[44:47], v30, s[16:19], s21 offen offset:2048 sc1
  buffer_load_dwordx4 v[48:51], v30, s[16:19], s21 offen offset:3072 sc1
  s_add_u32 s21, s50, 4096
  buffer_load_dwordx4 v[52:55], v30, s[16:19], s21 offen offset:0 sc1
  buffer_load_dwordx4 v[56:59], v30, s[16:19], s21 offen offset:1024 sc1
  buffer_load_dwordx4 v[60:63], v30, s[16:19], s21 offen offset:2048 sc1
  buffer_load_dwordx4 v[236:239], v30, s[16:19], s21 offen offset:3072 sc1
  s_add_u32 s21, s50, 8192
  buffer_load_dwordx4 v[240:243], v30, s[16:19], s21 offen offset:0 sc1
  buffer_load_dwordx4 v[244:247], v30, s[16:19], s21 offen offset:1024 sc1
  buffer_load_dwordx4 v[248:251], v30, s[16:19], s21 offen offset:2048 sc1
  buffer_load_dwordx4 v[252:255], v30, s[16:19], s21 offen offset:3072 sc1
  s_add_u32 s21, s43, 0
  buffer_load_dwordx4 v[64:67], v30, s[12:15], s21 offen offset:0 sc1
  buffer_load_dwordx4 v[68:71], v30, s[12:15], s21 offen offset:1024 sc1
  buffer_load_dwordx4 v[72:75], v30, s[12:15], s21 offen offset:2048 sc1
  buffer_load_dwordx4 v[76:79], v30, s[12:15], s21 offen offset:3072 sc1
  s_add_u32 s21, s43, 4096
  buffer_load_dwordx4 v[80:83], v30, s[12:15], s21 offen offset:0 sc1
  buffer_load_dwordx4 v[84:87], v30, s[12:15], s21 offen offset:1024 sc1
  buffer_load_dwordx4 v[88:91], v30, s[12:15], s21 offen offset:2048 sc1
  buffer_load_dwordx4 v[92:95], v30, s[12:15], s21 offen offset:3072 sc1
  s_add_u32 s21, s43, 8192
  buffer_load_dwordx4 v[96:99], v30, s[12:15], s21 offen offset:0 sc1
  buffer_load_dwordx4 v[100:103], v30, s[12:15], s21 offen offset:1024 sc1
  buffer_load_dwordx4 v[104:107], v30, s[12:15], s21 offen offset:2048 sc1
  buffer_load_dwordx4 v[108:111], v30, s[12:15], s21 offen offset:3072 sc1
  s_waitcnt vmcnt(24)
  s_cmp_eq_u32 s78, 0
  s_cbranch_scc1 pf_248
  v_mov_b32 v4, 0
  v_mov_b32 v5, 1
  s_mov_b64 exec, 1
  buffer_atomic_add v5, v4, s[72:75], s78 offen sc1
  s_mov_b64 exec, -1
  s_mov_b32 s78, 0
pf_248:
  s_add_u32 s23, s49, 1
  v_cmp_gt_u32 vcc, s23, v21
  s_mov_b32 s80, 0
  s_nop 0
  s_cbranch_vccnz qk_247
  s_mov_b32 s80, 1
  buffer_load_dwordx4 v[132:135], v31, s[52:55], s51 offen offset:0 sc1
  buffer_load_dwordx4 v[136:139], v31, s[52:55], s51 offen offset:512 sc1
  buffer_load_dwordx4 v[140:143], v31, s[52:55], s51 offen offset:1024 sc1
  buffer_load_dwordx4 v[144:147], v31, s[52:55], s51 offen offset:1536 sc1
  buffer_load_dwordx4 v[148:151], v31, s[52:55], s51 offen offset:2048 sc1
  buffer_load_dwordx4 v[152:155], v31, s[52:55], s51 offen offset:2560 sc1
  s_waitcnt vmcnt(6)
  s_branch qk_247x
qk_247:
  s_waitcnt vmcnt(0)
qk_247x:
  v_mfma_f32_16x16x32_bf16 v[112:115], v[36:39], v[64:67], 0
  v_mfma_f32_16x16x32_bf16 v[120:123], v[36:39], v[88:91], 0
  v_mfma_f32_16x16x32_bf16 v[124:127], v[60:63], v[88:91], 0
  v_mfma_f32_16x16x32_bf16 v[112:115], v[40:43], v[68:71], v[112:115]
  v_mfma_f32_16x16x32_bf16 v[120:123], v[40:43], v[92:95], v[120:123]
  v_mfma_f32_16x16x32_bf16 v[124:127], v[236:239], v[92:95], v[124:127]
  v_mfma_f32_16x16x32_bf16 v[112:115], v[44:47], v[72:75], v[112:115]
  v_mfma_f32_16x16x32_bf16 v[120:123], v[44:47], v[96:99], v[120:123]
  v_mfma_f32_16x16x32_bf16 v[124:127], v[240:243], v[96:99], v[124:127]
  v_mfma_f32_16x16x32_bf16 v[112:115], v[48:51], v[76:79], v[112:115]
  v_mfma_f32_16x16x32_bf16 v[120:123], v[48:51], v[100:103], v[120:123]
  v_mfma_f32_16x16x32_bf16 v[124:127], v[244:247], v[100:103], v[124:127]
  v_mfma_f32_16x16x32_bf16 v[112:115], v[52:55], v[80:83], v[112:115]
  v_mfma_f32_16x16x32_bf16 v[120:123], v[52:55], v[104:107], v[120:123]
  v_mfma_f32_16x16x32_bf16 v[124:127], v[248:251], v[104:107], v[124:127]
  v_mfma_f32_16x16x32_bf16 v[112:115], v[56:59], v[84:87], v[112:115]
  v_mfma_f32_16x16x32_bf16 v[120:123], v[56:59], v[108:111], v[120:123]
  v_mfma_f32_16x16x32_bf16 v[124:127], v[252:255], v[108:111], v[124:127]
  s_cmp_eq_u32 s80, 1
  s_cbranch_scc1 qm_249
  s_add_u32 s23, s49, 1
  s_min_u32 s22, s49, 61
  s_cmp_lt_u32 s49, 58
  s_cselect_b32 s23, s23, s22
  s_mov_b32 s101, 0
wm_250:
  buffer_load_dword v156, v33, s[72:75], s77 offen sc1
  s_add_u32 s101, s101, 1
  s_cmp_gt_u32 s101, 131072
  s_cbranch_scc1 main_end
  s_waitcnt vmcnt(0)
  v_cmp_gt_u32 vcc, s23, v156
  v_readfirstlane_b32 s100, v156
  s_nop 0
  s_cbranch_vccz wm_251
  s_sleep 16
  s_add_u32 s100, s100, 2
  s_cmp_ge_u32 s100, s23
  s_cbranch_scc1 wm_250
  s_sleep 90
  s_branch wm_250
wm_251:
  s_cmp_eq_u32 s49, 63
  s_cselect_b32 s21, s101, 0
  s_cmp_lt_u32 s21, 2
  s_cbranch_scc1 qtz_254
  s_sleep 36
qtz_254:
  s_mov_b32 s101, 0
  s_branch qtp_253
qtp_252:
  s_sleep 3
qtp_253:
  buffer_load_dwordx4 v[132:135], v31, s[52:55], s51 offen offset:0 sc1
  buffer_load_dwordx4 v[136:139], v31, s[52:55], s51 offen offset:512 sc1
  buffer_load_dwordx4 v[140:143], v31, s[52:55], s51 offen offset:1024 sc1
  buffer_load_dwordx4 v[144:147], v31, s[52:55], s51 offen offset:1536 sc1
  buffer_load_dwordx4 v[148:151], v31, s[52:55], s51 offen offset:2048 sc1
  buffer_load_dwordx4 v[152:155], v31, s[52:55], s51 offen offset:2560 sc1
  s_add_u32 s101, s101, 1
  s_cmp_gt_u32 s101, 131072
  s_cbranch_scc1 main_end
  s_waitcnt vmcnt(0)
  v_max3_u32 v156, v132, v134, v136
  v_max3_u32 v156, v156, v138, v140
  v_max3_u32 v156, v156, v142, v144
  v_max3_u32 v156, v156, v146, v148
  v_max3_u32 v156, v156, v150, v152
  v_max3_u32 v156, v156, v154, v154
  v_cmp_eq_u32 vcc, -1, v156
  s_nop 1
  s_cbranch_vccnz qtp_252
qm_249:
  s_waitcnt vmcnt(0)
  v_mfma_f32_16x16x32_bf16 v[116:119], v[132:135], v[64:67], 0
  v_mfma_f32_16x16x32_bf16 v[128:131], v[132:135], v[88:91], 0
  v_mfma_f32_16x16x32_bf16 v[116:119], v[136:139], v[68:71], v[116:119]
  v_mfma_f32_16x16x32_bf16 v[128:131], v[136:139], v[92:95], v[128:131]
  v_mfma_f32_16x16x32_bf16 v[116:119], v[140:143], v[72:75], v[116:119]
  v_mfma_f32_16x16x32_bf16 v[128:131], v[140:143], v[96:99], v[128:131]
  v_mfma_f32_16x16x32_bf16 v[116:119], v[144:147], v[76:79], v[116:119]
  v_mfma_f32_16x16x32_bf16 v[128:131], v[144:147], v[100:103], v[128:131]
  v_mfma_f32_16x16x32_bf16 v[116:119], v[148:151], v[80:83], v[116:119]
  v_mfma_f32_16x16x32_bf16 v[128:131], v[148:151], v[104:107], v[128:131]
  v_mfma_f32_16x16x32_bf16 v[116:119], v[152:155], v[84:87], v[116:119]
  v_mfma_f32_16x16x32_bf16 v[128:131], v[152:155], v[108:111], v[128:131]
qx_246:
  s_lshl_b32 s21, s49, 5
  s_add_u32 s21, s21, s42
  s_mul_i32 s81, s21, 2560
  s_lshl_b32 s82, s49, 3
  s_and_b32 s21, s42, 7
  s_add_u32 s82, s82, s21
  s_lshl_b32 s82, s82, 7
  s_add_u32 s82, s82, 23552
  v_cndmask_b32 v112, v34, v112, s[64:65]
  v_cndmask_b32 v124, v34, v124, s[64:65]
  v_cndmask_b32 v113, v34, v113, s[66:67]
  v_cndmask_b32 v125, v34, v125, s[66:67]
  v_cndmask_b32 v114, v34, v114, s[68:69]
  v_cndmask_b32 v126, v34, v126, s[68:69]
  v_cndmask_b32 v115, v34, v115, s[70:71]
  v_cndmask_b32 v127, v34, v127, s[70:71]
  v_max3_f32 v156, v112, v113, v114
  v_max3_f32 v156, v156, v115, v116
  v_max3_f32 v156, v156, v117, v118
  v_max_f32 v156, v156, v119
  v_mov_b32 v157, v156
  s_nop 1
  v_permlane32_swap_b32 v156, v157
  v_max_f32 v156, v156, v157
  v_mov_b32 v157, v156
  s_nop 1
  v_permlane16_swap_b32 v156, v157
  v_max_f32 v156, v156, v157
  v_mul_f32 v156, s83, v156
  v_fma_f32 v112, v112, s83, -v156
  v_fma_f32 v113, v113, s83, -v156
  v_fma_f32 v114, v114, s83, -v156
  v_fma_f32 v115, v115, s83, -v156
  v_fma_f32 v116, v116, s83, -v156
  v_fma_f32 v117, v117, s83, -v156
  v_fma_f32 v118, v118, s83, -v156
  v_fma_f32 v119, v119, s83, -v156
  v_exp_f32 v112, v112
  v_exp_f32 v113, v113
  v_exp_f32 v114, v114
  v_exp_f32 v115, v115
  v_exp_f32 v116, v116
  v_exp_f32 v117, v117
  v_exp_f32 v118, v118
  v_exp_f32 v119, v119
  s_nop 0
  v_add_f32 v156, v116, v117
  v_add_f32 v156, v156, v118
  v_add_f32 v156, v156, v119
  v_cndmask_b32 v156, 0, v156, s[60:61]
  v_add_f32 v156, v156, v112
  v_add_f32 v156, v156, v113
  v_add_f32 v156, v156, v114
  v_add_f32 v156, v156, v115
  v_mov_b32 v157, v156
  s_nop 1
  v_permlane32_swap_b32 v156, v157
  v_add_f32 v156, v156, v157
  v_mov_b32 v157, v156
  s_nop 1
  v_permlane16_swap_b32 v156, v157
  v_add_f32 v156, v156, v157
  v_rcp_f32 v156, v156
  s_nop 0
  v_mul_f32 v112, v112, v156
  v_mul_f32 v113, v113, v156
  v_mul_f32 v114, v114, v156
  v_mul_f32 v115, v115, v156
  v_mul_f32 v116, v116, v156
  v_mul_f32 v117, v117, v156
  v_mul_f32 v118, v118, v156
  v_mul_f32 v119, v119, v156
  v_max3_f32 v156, v120, v121, v122
  v_max3_f32 v156, v156, v123, v124
  v_max3_f32 v156, v156, v125, v126
  v_max3_f32 v156, v156, v127, v128
  v_max3_f32 v156, v156, v129, v130
  v_max_f32 v156, v156, v131
  v_mov_b32 v157, v156
  s_nop 1
  v_permlane32_swap_b32 v156, v157
  v_max_f32 v156, v156, v157
  v_mov_b32 v157, v156
  s_nop 1
  v_permlane16_swap_b32 v156, v157
  v_max_f32 v156, v156, v157
  v_mul_f32 v156, s83, v156
  v_fma_f32 v120, v120, s83, -v156
  v_fma_f32 v121, v121, s83, -v156
  v_fma_f32 v122, v122, s83, -v156
  v_fma_f32 v123, v123, s83, -v156
  v_fma_f32 v124, v124, s83, -v156
  v_fma_f32 v125, v125, s83, -v156
  v_fma_f32 v126, v126, s83, -v156
  v_fma_f32 v127, v127, s83, -v156
  v_fma_f32 v128, v128, s83, -v156
  v_fma_f32 v129, v129, s83, -v156
  v_fma_f32 v130, v130, s83, -v156
  v_fma_f32 v131, v131, s83, -v156
  v_exp_f32 v120, v120
  v_exp_f32 v121, v121
  v_exp_f32 v122, v122
  v_exp_f32 v123, v123
  v_exp_f32 v124, v124
  v_exp_f32 v125, v125
  v_exp_f32 v126, v126
  v_exp_f32 v127, v127
  v_exp_f32 v128, v128
  v_exp_f32 v129, v129
  v_exp_f32 v130, v130
  v_exp_f32 v131, v131
  s_nop 0
  v_add_f32 v156, v128, v129
  v_add_f32 v156, v156, v130
  v_add_f32 v156, v156, v131
  v_cndmask_b32 v156, 0, v156, s[60:61]
  v_add_f32 v156, v156, v120
  v_add_f32 v156, v156, v121
  v_add_f32 v156, v156, v122
  v_add_f32 v156, v156, v123
  v_add_f32 v156, v156, v124
  v_add_f32 v156, v156, v125
  v_add_f32 v156, v156, v126
  v_add_f32 v156, v156, v127
  v_mov_b32 v157, v156
  s_nop 1
  v_permlane32_swap_b32 v156, v157
  v_add_f32 v156, v156, v157
  v_mov_b32 v157, v156
  s_nop 1
  v_permlane16_swap_b32 v156, v157
  v_add_f32 v156, v156, v157
  v_rcp_f32 v156, v156
  s_nop 0
  v_mul_f32 v120, v120, v156
  v_mul_f32 v121, v121, v156
  v_mul_f32 v122, v122, v156
  v_mul_f32 v123, v123, v156
  v_mul_f32 v124, v124, v156
  v_mul_f32 v125, v125, v156
  v_mul_f32 v126, v126, v156
  v_mul_f32 v127, v127, v156
  v_mul_f32 v128, v128, v156
  v_mul_f32 v129, v129, v156
  v_mul_f32 v130, v130, v156
  v_mul_f32 v131, v131, v156
  v_cvt_pk_bf16_f32 v196, v116, v117
  v_cvt_pk_bf16_f32 v197, v118, v119
  v_cvt_pk_bf16_f32 v198, v128, v129
  v_cvt_pk_bf16_f32 v199, v130, v131
  v_cvt_pk_bf16_f32 v192, v120, v121
  v_cvt_pk_bf16_f32 v193, v122, v123
  v_cvt_pk_bf16_f32 v194, v124, v125
  v_cvt_pk_bf16_f32 v195, v126, v127
  v_cvt_pk_bf16_f32 v200, v112, v113
  v_cvt_pk_bf16_f32 v201, v114, v115
  v_permlane16_swap_b32 v196, v198
  v_permlane16_swap_b32 v197, v199
  buffer_store_dwordx4 v[192:195], v30, s[56:59], s81 offen sc1
  s_mov_b64 exec, 0xffffffff
  buffer_store_dwordx4 v[196:199], v30, s[56:59], s81 offen offset:1024 sc1
  s_mov_b64 exec, -1
  buffer_store_dwordx2 v[200:201], v32, s[56:59], s81 offen offset:2048 sc1
  s_mov_b32 s78, s82
  s_mov_b32 s81, 0x80000000
  s_mov_b32 s82, 0
  s_cmp_eq_u32 s80, 1
  s_cbranch_scc1 qd_255
  s_waitcnt vmcnt(0)
  s_cmp_eq_u32 s78, 0
  s_cbranch_scc1 pf_256
  v_mov_b32 v4, 0
  v_mov_b32 v5, 1
  s_mov_b64 exec, 1
  buffer_atomic_add v5, v4, s[72:75], s78 offen sc1
  s_mov_b64 exec, -1
  s_mov_b32 s78, 0
pf_256:
qd_255:
  s_add_u32 s49, s49, s29
qbe_245:
  s_cmp_lt_u32 s49, 64
  s_cbranch_scc1 qf_244
  s_waitcnt vmcnt(0)
  s_cmp_eq_u32 s78, 0
  s_cbranch_scc1 pf_257
  v_mov_b32 v4, 0
  v_mov_b32 v5, 1
  s_mov_b64 exec, 1
  buffer_atomic_add v5, v4, s[72:75], s78 offen sc1
  s_mov_b64 exec, -1
  s_mov_b32 s78, 0
pf_257:
  s_branch queue
q_done:
  s_and_b32 s21, s3, 3
  s_cmp_lt_u32 s21, 0
  s_cbranch_scc1 queue
  s_sub_u32 s21, s21, 0
  s_lshl_b32 s21, s21, 3
  s_bfe_u32 s22, s3, 0x30002
  s_add_u32 s21, s21, s22
  s_add_u32 s87, s21, 334
  s_branch tail_item
queue:
  s_load_dwordx2 s[4:5], s[0:1], 96
  s_waitcnt lgkmcnt(0)
  s_mov_b32 s32, s4
  s_mov_b32 s33, s5
  s_mov_b32 s34, 256
  s_mov_b32 s35, 0x00020000
  s_waitcnt vmcnt(0) lgkmcnt(0)
  s_barrier
  s_mov_b32 s2, s85
  s_mov_b32 s85, -1
  s_cmp_lg_u32 s2, -1
  s_cbranch_scc1 queue_c
  v_mov_b32 v21, 0
  s_cmp_lg_u32 s20, 0
  s_cbranch_scc1 q_258
  v_mov_b32 v22, 80
  v_mov_b32 v23, 1
  s_mov_b64 exec, 1
  buffer_atomic_add v23, v22, s[32:35], 0 offen sc0 sc1
  s_waitcnt vmcnt(0)
queue_a:
  ds_write_b32 v21, v23
  s_waitcnt lgkmcnt(0)
  s_mov_b64 exec, -1
q_258:
queue_b:
  s_barrier
  ds_read_b32 v23, v21
  s_waitcnt lgkmcnt(0)
  v_readfirstlane_b32 s2, v23
  s_barrier
queue_c:
  s_add_u32 s21, s2, 0
  s_cmp_lt_u32 s2, 270
  s_cbranch_scc1 do_pv
  s_sub_u32 s2, s2, 270
  s_add_u32 s21, s2, 310
  s_cmp_lt_u32 s2, 24
  s_cbranch_scc1 do_pv
  s_sub_u32 s2, s2, 24
  s_add_u32 s21, s2, 270
  s_cmp_lt_u32 s2, 40
  s_cbranch_scc1 do_pv
  s_sub_u32 s2, s2, 40
  s_branch main_fin
do_opb:
  s_mov_b32 s87, -1
do_opb2:
  s_mov_b32 s2, s21
  s_load_dwordx2 s[4:5], s[0:1], 0
  s_load_dwordx4 s[40:43], s[0:1], 72
  s_load_dwordx2 s[38:39], s[0:1], 104
  s_lshl_b32 s59, s2, 2
  s_add_u32 s59, s59, s20
  s_lshl_b32 s59, s59, 3
  v_lshlrev_b32 v4, 4, v1
  v_lshlrev_b32 v5, 2, v1
  s_waitcnt lgkmcnt(0)
  s_mov_b32 s8, s4
  s_mov_b32 s9, s5
  s_mov_b32 s10, 2621440
  s_mov_b32 s11, 0x00020000
  s_mov_b32 s12, s42
  s_mov_b32 s13, s43
  s_mov_b32 s14, 1280
  s_mov_b32 s15, 0x00020000
  s_mov_b32 s24, s40
  s_mov_b32 s25, s41
  s_mov_b32 s26, 819200
  s_mov_b32 s27, 0x00020000
  s_add_u32 s16, s38, 70713344
  s_addc_u32 s17, s39, 0
  s_mov_b32 s18, 2641920
  s_mov_b32 s19, 0x00020000
  s_add_u32 s28, s38, 81002496
  s_addc_u32 s29, s39, 0
  s_mov_b32 s30, 8192
  s_mov_b32 s31, 0x00020000
  s_add_u32 s72, s38, 81068032
  s_addc_u32 s73, s39, 0
  s_mov_b32 s74, 116736
  s_mov_b32 s75, 0x00020000
  s_mov_b32 s21, 91136
  v_mov_b32 v20, 0
  buffer_load_dword v21, v20, s[72:75], s21 offen sc1
  v_mov_b32 v29, 3277
  s_mul_i32 s21, s20, 320
  s_add_u32 s21, s21, 0
  v_add_u32 v22, s21, v1
  v_mul_u32_u24 v23, v22, v29
  v_lshrrev_b32 v23, 16, v23
  v_mul_u32_u24 v24, 20, v23
  v_sub_u32 v22, v22, v24
  v_bfe_u32 v24, v23, 3, 1
  v_lshlrev_b32 v24, 1, v24
  v_xor_b32 v22, v22, v24
  v_mul_u32_u24 v23, 1280, v23
  v_lshl_add_u32 v8, v22, 4, v23
  s_mul_i32 s21, s20, 320
  s_add_u32 s21, s21, 64
  v_add_u32 v22, s21, v1
  v_mul_u32_u24 v23, v22, v29
  v_lshrrev_b32 v23, 16, v23
  v_mul_u32_u24 v24, 20, v23
  v_sub_u32 v22, v22, v24
  v_bfe_u32 v24, v23, 3, 1
  v_lshlrev_b32 v24, 1, v24
  v_xor_b32 v22, v22, v24
  v_mul_u32_u24 v23, 1280, v23
  v_lshl_add_u32 v9, v22, 4, v23
  s_mul_i32 s21, s20, 320
  s_add_u32 s21, s21, 128
  v_add_u32 v22, s21, v1
  v_mul_u32_u24 v23, v22, v29
  v_lshrrev_b32 v23, 16, v23
  v_mul_u32_u24 v24, 20, v23
  v_sub_u32 v22, v22, v24
  v_bfe_u32 v24, v23, 3, 1
  v_lshlrev_b32 v24, 1, v24
  v_xor_b32 v22, v22, v24
  v_mul_u32_u24 v23, 1280, v23
  v_lshl_add_u32 v10, v22, 4, v23
  s_mul_i32 s21, s20, 320
  s_add_u32 s21, s21, 192
  v_add_u32 v22, s21, v1
  v_mul_u32_u24 v23, v22, v29
  v_lshrrev_b32 v23, 16, v23
  v_mul_u32_u24 v24, 20, v23
  v_sub_u32 v22, v22, v24
  v_bfe_u32 v24, v23, 3, 1
  v_lshlrev_b32 v24, 1, v24
  v_xor_b32 v22, v22, v24
  v_mul_u32_u24 v23, 1280, v23
  v_lshl_add_u32 v11, v22, 4, v23
  s_mul_i32 s21, s20, 320
  s_add_u32 s21, s21, 256
  v_add_u32 v22, s21, v1
  v_mul_u32_u24 v23, v22, v29
  v_lshrrev_b32 v23, 16, v23
  v_mul_u32_u24 v24, 20, v23
  v_sub_u32 v22, v22, v24
  v_bfe_u32 v24, v23, 3, 1
  v_lshlrev_b32 v24, 1, v24
  v_xor_b32 v22, v22, v24
  v_mul_u32_u24 v23, 1280, v23
  v_lshl_add_u32 v12, v22, 4, v23
  s_and_b32 s44, s2, 3
  s_mul_i32 s45, s44, 320
  s_mul_i32 s46, s20, 5120
  v_and_b32 v22, 1, v2
  v_mul_u32_u24 v22, 16512, v22
  v_mul_u32_u24 v23, 33024, v3
  v_lshrrev_b32 v24, 1, v2
  v_lshlrev_b32 v24, 4, v24
  v_add3_u32 v6, v22, v23, v24
  s_lshr_b32 s47, s2, 2
  s_lshl_b32 s47, s47, 2
  s_add_u32 s47, s47, s20
  s_lshl_b32 s47, s47, 1
  s_lshl_b32 s48, s47, 7
  v_lshrrev_b32 v22, 2, v2
  v_lshl_add_u32 v22, v3, 3, v22
  v_mul_u32_u24 v22, 320, v22
  v_and_b32 v23, 3, v2
  v_lshl_add_u32 v22, v23, 3, v22
  v_and_b32 v23, 1, v3
  v_lshlrev_b32 v23, 5, v23
  v_add_u32 v14, v22, v23
  v_sub_u32 v15, v22, v23
  v_add_u32 v16, 61440, v14
  v_add_u32 v17, 61440, v15
  v_add_u32 v18, 122880, v14
  v_add_u32 v19, 122880, v15
  s_add_u32 m0, s46, 0
  s_add_u32 s49, s45, 0
  s_nop 0
  buffer_load_dwordx4 v8, s[24:27], s49 offen lds
  s_add_u32 m0, s46, 1024
  s_nop 0
  buffer_load_dwordx4 v9, s[24:27], s49 offen lds
  s_add_u32 m0, s46, 2048
  s_nop 0
  buffer_load_dwordx4 v10, s[24:27], s49 offen lds
  s_add_u32 m0, s46, 3072
  s_nop 0
  buffer_load_dwordx4 v11, s[24:27], s49 offen lds
  s_add_u32 m0, s46, 4096
  s_nop 0
  buffer_load_dwordx4 v12, s[24:27], s49 offen lds
  s_add_u32 m0, s46, 20480
  s_add_u32 s49, s45, 81920
  s_nop 0
  buffer_load_dwordx4 v8, s[24:27], s49 offen lds
  s_add_u32 m0, s46, 21504
  s_nop 0
  buffer_load_dwordx4 v9, s[24:27], s49 offen lds
  s_add_u32 m0, s46, 22528
  s_nop 0
  buffer_load_dwordx4 v10, s[24:27], s49 offen lds
  s_add_u32 m0, s46, 23552
  s_nop 0
  buffer_load_dwordx4 v11, s[24:27], s49 offen lds
  s_add_u32 m0, s46, 24576
  s_nop 0
  buffer_load_dwordx4 v12, s[24:27], s49 offen lds
  s_waitcnt vmcnt(10)
  v_readfirstlane_b32 s21, v21
  s_cmp_ge_u32 s21, 32
  s_cbranch_scc1 o2_259
  s_mov_b32 s21, 91136
  v_mov_b32 v20, 0
  s_mov_b32 s101, 0
wf_260:
  buffer_load_dword v21, v20, s[72:75], s21 offen sc1
  s_add_u32 s101, s101, 1
  s_cmp_gt_u32 s101, 131072
  s_cbranch_scc1 main_end
  s_waitcnt vmcnt(0)
  v_readfirstlane_b32 s100, v21
  s_cmp_ge_u32 s100, 32
  s_cbranch_scc1 wf_261
  s_sleep 32
  s_branch wf_260
wf_261:
o2_259:
  buffer_load_dwordx4 a[0:3], v6, s[16:19], s48 offen offset:0 sc1
  buffer_load_dwordx4 a[4:7], v6, s[16:19], s48 offen offset:128 sc1
  s_add_u32 s48, s48, 132096
  buffer_load_dwordx4 a[8:11], v6, s[16:19], s48 offen offset:0 sc1
  buffer_load_dwordx4 a[12:15], v6, s[16:19], s48 offen offset:128 sc1
  s_add_u32 s48, s48, 132096
  buffer_load_dwordx4 a[16:19], v6, s[16:19], s48 offen offset:0 sc1
  buffer_load_dwordx4 a[20:23], v6, s[16:19], s48 offen offset:128 sc1
  s_add_u32 s48, s48, 132096
  buffer_load_dwordx4 a[24:27], v6, s[16:19], s48 offen offset:0 sc1
  buffer_load_dwordx4 a[28:31], v6, s[16:19], s48 offen offset:128 sc1
  s_add_u32 s48, s48, 132096
  s_add_u32 m0, s46, 40960
  s_add_u32 s49, s45, 163840
  s_nop 0
  buffer_load_dwordx4 v8, s[24:27], s49 offen lds
  s_add_u32 m0, s46, 41984
  s_nop 0
  buffer_load_dwordx4 v9, s[24:27], s49 offen lds
  s_add_u32 m0, s46, 43008
  s_nop 0
  buffer_load_dwordx4 v10, s[24:27], s49 offen lds
  s_add_u32 m0, s46, 44032
  s_nop 0
  buffer_load_dwordx4 v11, s[24:27], s49 offen lds
  s_add_u32 m0, s46, 45056
  s_nop 0
  buffer_load_dwordx4 v12, s[24:27], s49 offen lds
  buffer_load_dwordx4 a[32:35], v6, s[16:19], s48 offen offset:0 sc1
  buffer_load_dwordx4 a[36:39], v6, s[16:19], s48 offen offset:128 sc1
  s_add_u32 s48, s48, 132096
  buffer_load_dwordx4 a[40:43], v6, s[16:19], s48 offen offset:0 sc1
  buffer_load_dwordx4 a[44:47], v6, s[16:19], s48 offen offset:128 sc1
  s_add_u32 s48, s48, 132096
  s_add_u32 m0, s46, 61440
  s_add_u32 s49, s45, 245760
  s_nop 0
  buffer_load_dwordx4 v8, s[24:27], s49 offen lds
  s_add_u32 m0, s46, 62464
  s_nop 0
  buffer_load_dwordx4 v9, s[24:27], s49 offen lds
  s_add_u32 m0, s46, 63488
  s_nop 0
  buffer_load_dwordx4 v10, s[24:27], s49 offen lds
  s_add_u32 m0, s46, 64512
  s_nop 0
  buffer_load_dwordx4 v11, s[24:27], s49 offen lds
  s_add_u32 m0, s46, 65536
  s_nop 0
  buffer_load_dwordx4 v12, s[24:27], s49 offen lds
  buffer_load_dwordx4 a[48:51], v6, s[16:19], s48 offen offset:0 sc1
  buffer_load_dwordx4 a[52:55], v6, s[16:19], s48 offen offset:128 sc1
  s_add_u32 s48, s48, 132096
  buffer_load_dwordx4 a[56:59], v6, s[16:19], s48 offen offset:0 sc1
  buffer_load_dwordx4 a[60:63], v6, s[16:19], s48 offen offset:128 sc1
  s_add_u32 s48, s48, 132096
  s_add_u32 m0, s46, 81920
  s_add_u32 s49, s45, 327680
  s_nop 0
  buffer_load_dwordx4 v8, s[24:27], s49 offen lds
  s_add_u32 m0, s46, 82944
  s_nop 0
  buffer_load_dwordx4 v9, s[24:27], s49 offen lds
  s_add_u32 m0, s46, 83968
  s_nop 0
  buffer_load_dwordx4 v10, s[24:27], s49 offen lds
  s_add_u32 m0, s46, 84992
  s_nop 0
  buffer_load_dwordx4 v11, s[24:27], s49 offen lds
  s_add_u32 m0, s46, 86016
  s_nop 0
  buffer_load_dwordx4 v12, s[24:27], s49 offen lds
  buffer_load_dwordx4 a[64:67], v6, s[16:19], s48 offen offset:0 sc1
  buffer_load_dwordx4 a[68:71], v6, s[16:19], s48 offen offset:128 sc1
  s_add_u32 s48, s48, 132096
  buffer_load_dwordx4 a[72:75], v6, s[16:19], s48 offen offset:0 sc1
  buffer_load_dwordx4 a[76:79], v6, s[16:19], s48 offen offset:128 sc1
  s_add_u32 s48, s48, 132096
  s_add_u32 m0, s46, 102400
  s_add_u32 s49, s45, 409600
  s_nop 0
  buffer_load_dwordx4 v8, s[24:27], s49 offen lds
  s_add_u32 m0, s46, 103424
  s_nop 0
  buffer_load_dwordx4 v9, s[24:27], s49 offen lds
  s_add_u32 m0, s46, 104448
  s_nop 0
  buffer_load_dwordx4 v10, s[24:27], s49 offen lds
  s_add_u32 m0, s46, 105472
  s_nop 0
  buffer_load_dwordx4 v11, s[24:27], s49 offen lds
  s_add_u32 m0, s46, 106496
  s_nop 0
  buffer_load_dwordx4 v12, s[24:27], s49 offen lds
  s_add_u32 m0, s46, 122880
  s_add_u32 s49, s45, 491520
  s_nop 0
  buffer_load_dwordx4 v8, s[24:27], s49 offen lds
  s_add_u32 m0, s46, 123904
  s_nop 0
  buffer_load_dwordx4 v9, s[24:27], s49 offen lds
  s_add_u32 m0, s46, 124928
  s_nop 0
  buffer_load_dwordx4 v10, s[24:27], s49 offen lds
  s_add_u32 m0, s46, 125952
  s_nop 0
  buffer_load_dwordx4 v11, s[24:27], s49 offen lds
  s_add_u32 m0, s46, 126976
  s_nop 0
  buffer_load_dwordx4 v12, s[24:27], s49 offen lds
  s_waitcnt vmcnt(50)
  s_barrier
  ds_read_b64_tr_b16 v[144:145], v14 offset:0
  ds_read_b64_tr_b16 v[146:147], v14 offset:1280
  ds_read_b64_tr_b16 v[148:149], v15 offset:32
  ds_read_b64_tr_b16 v[150:151], v15 offset:1312
  ds_read_b64_tr_b16 v[152:153], v14 offset:64
  ds_read_b64_tr_b16 v[154:155], v14 offset:1344
  ds_read_b64_tr_b16 v[156:157], v15 offset:96
  ds_read_b64_tr_b16 v[158:159], v15 offset:1376
  ds_read_b64_tr_b16 v[160:161], v14 offset:128
  ds_read_b64_tr_b16 v[162:163], v14 offset:1408
  ds_read_b64_tr_b16 v[164:165], v15 offset:160
  ds_read_b64_tr_b16 v[166:167], v15 offset:1440
  ds_read_b64_tr_b16 v[168:169], v14 offset:192
  ds_read_b64_tr_b16 v[170:171], v14 offset:1472
  ds_read_b64_tr_b16 v[172:173], v15 offset:224
  ds_read_b64_tr_b16 v[174:175], v15 offset:1504
  ds_read_b64_tr_b16 v[176:177], v14 offset:256
  ds_read_b64_tr_b16 v[178:179], v14 offset:1536
  ds_read_b64_tr_b16 v[180:181], v15 offset:288
  ds_read_b64_tr_b16 v[182:183], v15 offset:1568
  s_waitcnt lgkmcnt(0) vmcnt(43)
  v_mfma_f32_16x16x32_bf16 v[64:67], v[144:147], a[0:3], 0
  ds_read_b64_tr_b16 v[184:185], v14 offset:10240
  ds_read_b64_tr_b16 v[186:187], v14 offset:11520
  v_mfma_f32_16x16x32_bf16 v[104:107], v[144:147], a[4:7], 0
  ds_read_b64_tr_b16 v[188:189], v15 offset:10272
  v_mfma_f32_16x16x32_bf16 v[68:71], v[148:151], a[0:3], 0
  ds_read_b64_tr_b16 v[190:191], v15 offset:11552
  v_mfma_f32_16x16x32_bf16 v[108:111], v[148:151], a[4:7], 0
  ds_read_b64_tr_b16 v[192:193], v14 offset:10304
  v_mfma_f32_16x16x32_bf16 v[72:75], v[152:155], a[0:3], 0
  ds_read_b64_tr_b16 v[194:195], v14 offset:11584
  v_mfma_f32_16x16x32_bf16 v[112:115], v[152:155], a[4:7], 0
  ds_read_b64_tr_b16 v[196:197], v15 offset:10336
  ds_read_b64_tr_b16 v[198:199], v15 offset:11616
  v_mfma_f32_16x16x32_bf16 v[76:79], v[156:159], a[0:3], 0
  ds_read_b64_tr_b16 v[200:201], v14 offset:10368
  v_mfma_f32_16x16x32_bf16 v[116:119], v[156:159], a[4:7], 0
  ds_read_b64_tr_b16 v[202:203], v14 offset:11648
  v_mfma_f32_16x16x32_bf16 v[80:83], v[160:163], a[0:3], 0
  ds_read_b64_tr_b16 v[204:205], v15 offset:10400
  v_mfma_f32_16x16x32_bf16 v[120:123], v[160:163], a[4:7], 0
  ds_read_b64_tr_b16 v[206:207], v15 offset:11680
  v_mfma_f32_16x16x32_bf16 v[84:87], v[164:167], a[0:3], 0
  ds_read_b64_tr_b16 v[208:209], v14 offset:10432
  v_mfma_f32_16x16x32_bf16 v[124:127], v[164:167], a[4:7], 0
  ds_read_b64_tr_b16 v[210:211], v14 offset:11712
  ds_read_b64_tr_b16 v[212:213], v15 offset:10464
  v_mfma_f32_16x16x32_bf16 v[88:91], v[168:171], a[0:3], 0
  ds_read_b64_tr_b16 v[214:215], v15 offset:11744
  v_mfma_f32_16x16x32_bf16 v[128:131], v[168:171], a[4:7], 0
  buffer_load_dwordx4 a[80:83], v6, s[16:19], s48 offen offset:0 sc1
  ds_read_b64_tr_b16 v[216:217], v14 offset:10496
  v_mfma_f32_16x16x32_bf16 v[92:95], v[172:175], a[0:3], 0
  ds_read_b64_tr_b16 v[218:219], v14 offset:11776
  v_mfma_f32_16x16x32_bf16 v[132:135], v[172:175], a[4:7], 0
  ds_read_b64_tr_b16 v[220:221], v15 offset:10528
  v_mfma_f32_16x16x32_bf16 v[96:99], v[176:179], a[0:3], 0
  ds_read_b64_tr_b16 v[222:223], v15 offset:11808
  v_mfma_f32_16x16x32_bf16 v[136:139], v[176:179], a[4:7], 0
  buffer_load_dwordx4 a[84:87], v6, s[16:19], s48 offen offset:128 sc1
  v_mfma_f32_16x16x32_bf16 v[100:103], v[180:183], a[0:3], 0
  s_add_u32 s48, s48, 132096
  v_mfma_f32_16x16x32_bf16 v[140:143], v[180:183], a[4:7], 0
  s_waitcnt lgkmcnt(0) vmcnt(43)
  s_barrier
  v_mfma_f32_16x16x32_bf16 v[64:67], v[184:187], a[8:11], v[64:67]
  s_add_u32 m0, s46, 0
  ds_read_b64_tr_b16 v[144:145], v14 offset:20480
  ds_read_b64_tr_b16 v[146:147], v14 offset:21760
  v_mfma_f32_16x16x32_bf16 v[104:107], v[184:187], a[12:15], v[104:107]
  s_add_u32 s49, s45, 573440
  ds_read_b64_tr_b16 v[148:149], v15 offset:20512
  v_mfma_f32_16x16x32_bf16 v[68:71], v[188:191], a[8:11], v[68:71]
  buffer_load_dwordx4 v8, s[24:27], s49 offen lds
  ds_read_b64_tr_b16 v[150:151], v15 offset:21792
  v_mfma_f32_16x16x32_bf16 v[108:111], v[188:191], a[12:15], v[108:111]
  s_add_u32 m0, s46, 1024
  ds_read_b64_tr_b16 v[152:153], v14 offset:20544
  v_mfma_f32_16x16x32_bf16 v[72:75], v[192:195], a[8:11], v[72:75]
  buffer_load_dwordx4 v9, s[24:27], s49 offen lds
  ds_read_b64_tr_b16 v[154:155], v14 offset:21824
  v_mfma_f32_16x16x32_bf16 v[112:115], v[192:195], a[12:15], v[112:115]
  s_add_u32 m0, s46, 2048
  ds_read_b64_tr_b16 v[156:157], v15 offset:20576
  ds_read_b64_tr_b16 v[158:159], v15 offset:21856
  v_mfma_f32_16x16x32_bf16 v[76:79], v[196:199], a[8:11], v[76:79]
  buffer_load_dwordx4 v10, s[24:27], s49 offen lds
  ds_read_b64_tr_b16 v[160:161], v14 offset:20608
  v_mfma_f32_16x16x32_bf16 v[116:119], v[196:199], a[12:15], v[116:119]
  s_add_u32 m0, s46, 3072
  ds_read_b64_tr_b16 v[162:163], v14 offset:21888
  v_mfma_f32_16x16x32_bf16 v[80:83], v[200:203], a[8:11], v[80:83]
  buffer_load_dwordx4 v11, s[24:27], s49 offen lds
  ds_read_b64_tr_b16 v[164:165], v15 offset:20640
  v_mfma_f32_16x16x32_bf16 v[120:123], v[200:203], a[12:15], v[120:123]
  s_add_u32 m0, s46, 4096
  ds_read_b64_tr_b16 v[166:167], v15 offset:21920
  v_mfma_f32_16x16x32_bf16 v[84:87], v[204:207], a[8:11], v[84:87]
  buffer_load_dwordx4 v12, s[24:27], s49 offen lds
  ds_read_b64_tr_b16 v[168:169], v14 offset:20672
  v_mfma_f32_16x16x32_bf16 v[124:127], v[204:207], a[12:15], v[124:127]
  ds_read_b64_tr_b16 v[170:171], v14 offset:21952
  ds_read_b64_tr_b16 v[172:173], v15 offset:20704
  v_mfma_f32_16x16x32_bf16 v[88:91], v[208:211], a[8:11], v[88:91]
  ds_read_b64_tr_b16 v[174:175], v15 offset:21984
  v_mfma_f32_16x16x32_bf16 v[128:131], v[208:211], a[12:15], v[128:131]
  buffer_load_dwordx4 a[88:91], v6, s[16:19], s48 offen offset:0 sc1
  ds_read_b64_tr_b16 v[176:177], v14 offset:20736
  v_mfma_f32_16x16x32_bf16 v[92:95], v[212:215], a[8:11], v[92:95]
  ds_read_b64_tr_b16 v[178:179], v14 offset:22016
  v_mfma_f32_16x16x32_bf16 v[132:135], v[212:215], a[12:15], v[132:135]
  ds_read_b64_tr_b16 v[180:181], v15 offset:20768
  v_mfma_f32_16x16x32_bf16 v[96:99], v[216:219], a[8:11], v[96:99]
  ds_read_b64_tr_b16 v[182:183], v15 offset:22048
  v_mfma_f32_16x16x32_bf16 v[136:139], v[216:219], a[12:15], v[136:139]
  buffer_load_dwordx4 a[92:95], v6, s[16:19], s48 offen offset:128 sc1
  v_mfma_f32_16x16x32_bf16 v[100:103], v[220:223], a[8:11], v[100:103]
  s_add_u32 s48, s48, 132096
  v_mfma_f32_16x16x32_bf16 v[140:143], v[220:223], a[12:15], v[140:143]
  s_waitcnt lgkmcnt(0) vmcnt(48)
  v_mfma_f32_16x16x32_bf16 v[64:67], v[144:147], a[16:19], v[64:67]
  ds_read_b64_tr_b16 v[184:185], v14 offset:30720
  ds_read_b64_tr_b16 v[186:187], v14 offset:32000
  v_mfma_f32_16x16x32_bf16 v[104:107], v[144:147], a[20:23], v[104:107]
  ds_read_b64_tr_b16 v[188:189], v15 offset:30752
  v_mfma_f32_16x16x32_bf16 v[68:71], v[148:151], a[16:19], v[68:71]
  ds_read_b64_tr_b16 v[190:191], v15 offset:32032
  v_mfma_f32_16x16x32_bf16 v[108:111], v[148:151], a[20:23], v[108:111]
  ds_read_b64_tr_b16 v[192:193], v14 offset:30784
  v_mfma_f32_16x16x32_bf16 v[72:75], v[152:155], a[16:19], v[72:75]
  ds_read_b64_tr_b16 v[194:195], v14 offset:32064
  v_mfma_f32_16x16x32_bf16 v[112:115], v[152:155], a[20:23], v[112:115]
  ds_read_b64_tr_b16 v[196:197], v15 offset:30816
  ds_read_b64_tr_b16 v[198:199], v15 offset:32096
  v_mfma_f32_16x16x32_bf16 v[76:79], v[156:159], a[16:19], v[76:79]
  ds_read_b64_tr_b16 v[200:201], v14 offset:30848
  v_mfma_f32_16x16x32_bf16 v[116:119], v[156:159], a[20:23], v[116:119]
  ds_read_b64_tr_b16 v[202:203], v14 offset:32128
  v_mfma_f32_16x16x32_bf16 v[80:83], v[160:163], a[16:19], v[80:83]
  ds_read_b64_tr_b16 v[204:205], v15 offset:30880
  v_mfma_f32_16x16x32_bf16 v[120:123], v[160:163], a[20:23], v[120:123]
  ds_read_b64_tr_b16 v[206:207], v15 offset:32160
  v_mfma_f32_16x16x32_bf16 v[84:87], v[164:167], a[16:19], v[84:87]
  ds_read_b64_tr_b16 v[208:209], v14 offset:30912
  v_mfma_f32_16x16x32_bf16 v[124:127], v[164:167], a[20:23], v[124:127]
  ds_read_b64_tr_b16 v[210:211], v14 offset:32192
  ds_read_b64_tr_b16 v[212:213], v15 offset:30944
  v_mfma_f32_16x16x32_bf16 v[88:91], v[168:171], a[16:19], v[88:91]
  ds_read_b64_tr_b16 v[214:215], v15 offset:32224
  v_mfma_f32_16x16x32_bf16 v[128:131], v[168:171], a[20:23], v[128:131]
  buffer_load_dwordx4 a[96:99], v6, s[16:19], s48 offen offset:0 sc1
  ds_read_b64_tr_b16 v[216:217], v14 offset:30976
  v_mfma_f32_16x16x32_bf16 v[92:95], v[172:175], a[16:19], v[92:95]
  ds_read_b64_tr_b16 v[218:219], v14 offset:32256
  v_mfma_f32_16x16x32_bf16 v[132:135], v[172:175], a[20:23], v[132:135]
  ds_read_b64_tr_b16 v[220:221], v15 offset:31008
  v_mfma_f32_16x16x32_bf16 v[96:99], v[176:179], a[16:19], v[96:99]
  ds_read_b64_tr_b16 v[222:223], v15 offset:32288
  v_mfma_f32_16x16x32_bf16 v[136:139], v[176:179], a[20:23], v[136:139]
  buffer_load_dwordx4 a[100:103], v6, s[16:19], s48 offen offset:128 sc1
  v_mfma_f32_16x16x32_bf16 v[100:103], v[180:183], a[16:19], v[100:103]
  s_add_u32 s48, s48, 132096
  v_mfma_f32_16x16x32_bf16 v[140:143], v[180:183], a[20:23], v[140:143]
  s_waitcnt lgkmcnt(0) vmcnt(43)
  s_barrier
  v_mfma_f32_16x16x32_bf16 v[64:67], v[184:187], a[24:27], v[64:67]
  s_add_u32 m0, s46, 20480
  ds_read_b64_tr_b16 v[144:145], v14 offset:40960
  ds_read_b64_tr_b16 v[146:147], v14 offset:42240
  v_mfma_f32_16x16x32_bf16 v[104:107], v[184:187], a[28:31], v[104:107]
  s_add_u32 s49, s45, 655360
  ds_read_b64_tr_b16 v[148:149], v15 offset:40992
  v_mfma_f32_16x16x32_bf16 v[68:71], v[188:191], a[24:27], v[68:71]
  buffer_load_dwordx4 v8, s[24:27], s49 offen lds
  ds_read_b64_tr_b16 v[150:151], v15 offset:42272
  v_mfma_f32_16x16x32_bf16 v[108:111], v[188:191], a[28:31], v[108:111]
  s_add_u32 m0, s46, 21504
  ds_read_b64_tr_b16 v[152:153], v14 offset:41024
  v_mfma_f32_16x16x32_bf16 v[72:75], v[192:195], a[24:27], v[72:75]
  buffer_load_dwordx4 v9, s[24:27], s49 offen lds
  ds_read_b64_tr_b16 v[154:155], v14 offset:42304
  v_mfma_f32_16x16x32_bf16 v[112:115], v[192:195], a[28:31], v[112:115]
  s_add_u32 m0, s46, 22528
  ds_read_b64_tr_b16 v[156:157], v15 offset:41056
  ds_read_b64_tr_b16 v[158:159], v15 offset:42336
  v_mfma_f32_16x16x32_bf16 v[76:79], v[196:199], a[24:27], v[76:79]
  buffer_load_dwordx4 v10, s[24:27], s49 offen lds
  ds_read_b64_tr_b16 v[160:161], v14 offset:41088
  v_mfma_f32_16x16x32_bf16 v[116:119], v[196:199], a[28:31], v[116:119]
  s_add_u32 m0, s46, 23552
  ds_read_b64_tr_b16 v[162:163], v14 offset:42368
  v_mfma_f32_16x16x32_bf16 v[80:83], v[200:203], a[24:27], v[80:83]
  buffer_load_dwordx4 v11, s[24:27], s49 offen lds
  ds_read_b64_tr_b16 v[164:165], v15 offset:41120
  v_mfma_f32_16x16x32_bf16 v[120:123], v[200:203], a[28:31], v[120:123]
  s_add_u32 m0, s46, 24576
  ds_read_b64_tr_b16 v[166:167], v15 offset:42400
  v_mfma_f32_16x16x32_bf16 v[84:87], v[204:207], a[24:27], v[84:87]
  buffer_load_dwordx4 v12, s[24:27], s49 offen lds
  ds_read_b64_tr_b16 v[168:169], v14 offset:41152
  v_mfma_f32_16x16x32_bf16 v[124:127], v[204:207], a[28:31], v[124:127]
  ds_read_b64_tr_b16 v[170:171], v14 offset:42432
  ds_read_b64_tr_b16 v[172:173], v15 offset:41184
  v_mfma_f32_16x16x32_bf16 v[88:91], v[208:211], a[24:27], v[88:91]
  ds_read_b64_tr_b16 v[174:175], v15 offset:42464
  v_mfma_f32_16x16x32_bf16 v[128:131], v[208:211], a[28:31], v[128:131]
  buffer_load_dwordx4 a[104:107], v6, s[16:19], s48 offen offset:0 sc1
  ds_read_b64_tr_b16 v[176:177], v14 offset:41216
  v_mfma_f32_16x16x32_bf16 v[92:95], v[212:215], a[24:27], v[92:95]
  ds_read_b64_tr_b16 v[178:179], v14 offset:42496
  v_mfma_f32_16x16x32_bf16 v[132:135], v[212:215], a[28:31], v[132:135]
  ds_read_b64_tr_b16 v[180:181], v15 offset:41248
  v_mfma_f32_16x16x32_bf16 v[96:99], v[216:219], a[24:27], v[96:99]
  ds_read_b64_tr_b16 v[182:183], v15 offset:42528
  v_mfma_f32_16x16x32_bf16 v[136:139], v[216:219], a[28:31], v[136:139]
  buffer_load_dwordx4 a[108:111], v6, s[16:19], s48 offen offset:128 sc1
  v_mfma_f32_16x16x32_bf16 v[100:103], v[220:223], a[24:27], v[100:103]
  s_add_u32 s48, s48, 132096
  v_mfma_f32_16x16x32_bf16 v[140:143], v[220:223], a[28:31], v[140:143]
  s_waitcnt lgkmcnt(0) vmcnt(48)
  v_mfma_f32_16x16x32_bf16 v[64:67], v[144:147], a[32:35], v[64:67]
  ds_read_b64_tr_b16 v[184:185], v14 offset:51200
  ds_read_b64_tr_b16 v[186:187], v14 offset:52480
  v_mfma_f32_16x16x32_bf16 v[104:107], v[144:147], a[36:39], v[104:107]
  ds_read_b64_tr_b16 v[188:189], v15 offset:51232
  v_mfma_f32_16x16x32_bf16 v[68:71], v[148:151], a[32:35], v[68:71]
  ds_read_b64_tr_b16 v[190:191], v15 offset:52512
  v_mfma_f32_16x16x32_bf16 v[108:111], v[148:151], a[36:39], v[108:111]
  ds_read_b64_tr_b16 v[192:193], v14 offset:51264
  v_mfma_f32_16x16x32_bf16 v[72:75], v[152:155], a[32:35], v[72:75]
  ds_read_b64_tr_b16 v[194:195], v14 offset:52544
  v_mfma_f32_16x16x32_bf16 v[112:115], v[152:155], a[36:39], v[112:115]
  ds_read_b64_tr_b16 v[196:197], v15 offset:51296
  ds_read_b64_tr_b16 v[198:199], v15 offset:52576
  v_mfma_f32_16x16x32_bf16 v[76:79], v[156:159], a[32:35], v[76:79]
  ds_read_b64_tr_b16 v[200:201], v14 offset:51328
  v_mfma_f32_16x16x32_bf16 v[116:119], v[156:159], a[36:39], v[116:119]
  ds_read_b64_tr_b16 v[202:203], v14 offset:52608
  v_mfma_f32_16x16x32_bf16 v[80:83], v[160:163], a[32:35], v[80:83]
  ds_read_b64_tr_b16 v[204:205], v15 offset:51360
  v_mfma_f32_16x16x32_bf16 v[120:123], v[160:163], a[36:39], v[120:123]
  ds_read_b64_tr_b16 v[206:207], v15 offset:52640
  v_mfma_f32_16x16x32_bf16 v[84:87], v[164:167], a[32:35], v[84:87]
  ds_read_b64_tr_b16 v[208:209], v14 offset:51392
  v_mfma_f32_16x16x32_bf16 v[124:127], v[164:167], a[36:39], v[124:127]
  ds_read_b64_tr_b16 v[210:211], v14 offset:52672
  ds_read_b64_tr_b16 v[212:213], v15 offset:51424
  v_mfma_f32_16x16x32_bf16 v[88:91], v[168:171], a[32:35], v[88:91]
  ds_read_b64_tr_b16 v[214:215], v15 offset:52704
  v_mfma_f32_16x16x32_bf16 v[128:131], v[168:171], a[36:39], v[128:131]
  buffer_load_dwordx4 a[112:115], v6, s[16:19], s48 offen offset:0 sc1
  ds_read_b64_tr_b16 v[216:217], v14 offset:51456
  v_mfma_f32_16x16x32_bf16 v[92:95], v[172:175], a[32:35], v[92:95]
  ds_read_b64_tr_b16 v[218:219], v14 offset:52736
  v_mfma_f32_16x16x32_bf16 v[132:135], v[172:175], a[36:39], v[132:135]
  ds_read_b64_tr_b16 v[220:221], v15 offset:51488
  v_mfma_f32_16x16x32_bf16 v[96:99], v[176:179], a[32:35], v[96:99]
  ds_read_b64_tr_b16 v[222:223], v15 offset:52768
  v_mfma_f32_16x16x32_bf16 v[136:139], v[176:179], a[36:39], v[136:139]
  buffer_load_dwordx4 a[116:119], v6, s[16:19], s48 offen offset:128 sc1
  v_mfma_f32_16x16x32_bf16 v[100:103], v[180:183], a[32:35], v[100:103]
  s_add_u32 s48, s48, 132096
  v_mfma_f32_16x16x32_bf16 v[140:143], v[180:183], a[36:39], v[140:143]
  s_waitcnt lgkmcnt(0) vmcnt(43)
  s_barrier
  v_mfma_f32_16x16x32_bf16 v[64:67], v[184:187], a[40:43], v[64:67]
  s_add_u32 m0, s46, 40960
  ds_read_b64_tr_b16 v[144:145], v16 offset:0
  ds_read_b64_tr_b16 v[146:147], v16 offset:1280
  v_mfma_f32_16x16x32_bf16 v[104:107], v[184:187], a[44:47], v[104:107]
  s_add_u32 s49, s45, 737280
  ds_read_b64_tr_b16 v[148:149], v17 offset:32
  v_mfma_f32_16x16x32_bf16 v[68:71], v[188:191], a[40:43], v[68:71]
  buffer_load_dwordx4 v8, s[24:27], s49 offen lds
  ds_read_b64_tr_b16 v[150:151], v17 offset:1312
  v_mfma_f32_16x16x32_bf16 v[108:111], v[188:191], a[44:47], v[108:111]
  s_add_u32 m0, s46, 41984
  ds_read_b64_tr_b16 v[152:153], v16 offset:64
  v_mfma_f32_16x16x32_bf16 v[72:75], v[192:195], a[40:43], v[72:75]
  buffer_load_dwordx4 v9, s[24:27], s49 offen lds
  ds_read_b64_tr_b16 v[154:155], v16 offset:1344
  v_mfma_f32_16x16x32_bf16 v[112:115], v[192:195], a[44:47], v[112:115]
  s_add_u32 m0, s46, 43008
  ds_read_b64_tr_b16 v[156:157], v17 offset:96
  ds_read_b64_tr_b16 v[158:159], v17 offset:1376
  v_mfma_f32_16x16x32_bf16 v[76:79], v[196:199], a[40:43], v[76:79]
  buffer_load_dwordx4 v10, s[24:27], s49 offen lds
  ds_read_b64_tr_b16 v[160:161], v16 offset:128
  v_mfma_f32_16x16x32_bf16 v[116:119], v[196:199], a[44:47], v[116:119]
  s_add_u32 m0, s46, 44032
  ds_read_b64_tr_b16 v[162:163], v16 offset:1408
  v_mfma_f32_16x16x32_bf16 v[80:83], v[200:203], a[40:43], v[80:83]
  buffer_load_dwordx4 v11, s[24:27], s49 offen lds
  ds_read_b64_tr_b16 v[164:165], v17 offset:160
  v_mfma_f32_16x16x32_bf16 v[120:123], v[200:203], a[44:47], v[120:123]
  s_add_u32 m0, s46, 45056
  ds_read_b64_tr_b16 v[166:167], v17 offset:1440
  v_mfma_f32_16x16x32_bf16 v[84:87], v[204:207], a[40:43], v[84:87]
  buffer_load_dwordx4 v12, s[24:27], s49 offen lds
  ds_read_b64_tr_b16 v[168:169], v16 offset:192
  v_mfma_f32_16x16x32_bf16 v[124:127], v[204:207], a[44:47], v[124:127]
  ds_read_b64_tr_b16 v[170:171], v16 offset:1472
  ds_read_b64_tr_b16 v[172:173], v17 offset:224
  v_mfma_f32_16x16x32_bf16 v[88:91], v[208:211], a[40:43], v[88:91]
  ds_read_b64_tr_b16 v[174:175], v17 offset:1504
  v_mfma_f32_16x16x32_bf16 v[128:131], v[208:211], a[44:47], v[128:131]
  buffer_load_dwordx4 a[120:123], v6, s[16:19], s48 offen offset:0 sc1
  ds_read_b64_tr_b16 v[176:177], v16 offset:256
  v_mfma_f32_16x16x32_bf16 v[92:95], v[212:215], a[40:43], v[92:95]
  ds_read_b64_tr_b16 v[178:179], v16 offset:1536
  v_mfma_f32_16x16x32_bf16 v[132:135], v[212:215], a[44:47], v[132:135]
  ds_read_b64_tr_b16 v[180:181], v17 offset:288
  v_mfma_f32_16x16x32_bf16 v[96:99], v[216:219], a[40:43], v[96:99]
  ds_read_b64_tr_b16 v[182:183], v17 offset:1568
  v_mfma_f32_16x16x32_bf16 v[136:139], v[216:219], a[44:47], v[136:139]
  buffer_load_dwordx4 a[124:127], v6, s[16:19], s48 offen offset:128 sc1
  v_mfma_f32_16x16x32_bf16 v[100:103], v[220:223], a[40:43], v[100:103]
  s_add_u32 s48, s48, 132096
  v_mfma_f32_16x16x32_bf16 v[140:143], v[220:223], a[44:47], v[140:143]
  s_waitcnt lgkmcnt(0) vmcnt(48)
  v_mfma_f32_16x16x32_bf16 v[64:67], v[144:147], a[48:51], v[64:67]
  ds_read_b64_tr_b16 v[184:185], v16 offset:10240
  ds_read_b64_tr_b16 v[186:187], v16 offset:11520
  v_mfma_f32_16x16x32_bf16 v[104:107], v[144:147], a[52:55], v[104:107]
  ds_read_b64_tr_b16 v[188:189], v17 offset:10272
  v_mfma_f32_16x16x32_bf16 v[68:71], v[148:151], a[48:51], v[68:71]
  ds_read_b64_tr_b16 v[190:191], v17 offset:11552
  v_mfma_f32_16x16x32_bf16 v[108:111], v[148:151], a[52:55], v[108:111]
  ds_read_b64_tr_b16 v[192:193], v16 offset:10304
  v_mfma_f32_16x16x32_bf16 v[72:75], v[152:155], a[48:51], v[72:75]
  ds_read_b64_tr_b16 v[194:195], v16 offset:11584
  v_mfma_f32_16x16x32_bf16 v[112:115], v[152:155], a[52:55], v[112:115]
  ds_read_b64_tr_b16 v[196:197], v17 offset:10336
  ds_read_b64_tr_b16 v[198:199], v17 offset:11616
  v_mfma_f32_16x16x32_bf16 v[76:79], v[156:159], a[48:51], v[76:79]
  ds_read_b64_tr_b16 v[200:201], v16 offset:10368
  v_mfma_f32_16x16x32_bf16 v[116:119], v[156:159], a[52:55], v[116:119]
  ds_read_b64_tr_b16 v[202:203], v16 offset:11648
  v_mfma_f32_16x16x32_bf16 v[80:83], v[160:163], a[48:51], v[80:83]
  ds_read_b64_tr_b16 v[204:205], v17 offset:10400
  v_mfma_f32_16x16x32_bf16 v[120:123], v[160:163], a[52:55], v[120:123]
  ds_read_b64_tr_b16 v[206:207], v17 offset:11680
  v_mfma_f32_16x16x32_bf16 v[84:87], v[164:167], a[48:51], v[84:87]
  ds_read_b64_tr_b16 v[208:209], v16 offset:10432
  v_mfma_f32_16x16x32_bf16 v[124:127], v[164:167], a[52:55], v[124:127]
  ds_read_b64_tr_b16 v[210:211], v16 offset:11712
  ds_read_b64_tr_b16 v[212:213], v17 offset:10464
  v_mfma_f32_16x16x32_bf16 v[88:91], v[168:171], a[48:51], v[88:91]
  ds_read_b64_tr_b16 v[214:215], v17 offset:11744
  v_mfma_f32_16x16x32_bf16 v[128:131], v[168:171], a[52:55], v[128:131]
  buffer_load_dwordx4 a[128:131], v6, s[16:19], s48 offen offset:0 sc1
  ds_read_b64_tr_b16 v[216:217], v16 offset:10496
  v_mfma_f32_16x16x32_bf16 v[92:95], v[172:175], a[48:51], v[92:95]
  ds_read_b64_tr_b16 v[218:219], v16 offset:11776
  v_mfma_f32_16x16x32_bf16 v[132:135], v[172:175], a[52:55], v[132:135]
  ds_read_b64_tr_b16 v[220:221], v17 offset:10528
  v_mfma_f32_16x16x32_bf16 v[96:99], v[176:179], a[48:51], v[96:99]
  ds_read_b64_tr_b16 v[222:223], v17 offset:11808
  v_mfma_f32_16x16x32_bf16 v[136:139], v[176:179], a[52:55], v[136:139]
  buffer_load_dwordx4 a[132:135], v6, s[16:19], s48 offen offset:128 sc1
  v_mfma_f32_16x16x32_bf16 v[100:103], v[180:183], a[48:51], v[100:103]
  s_add_u32 s48, s48, 132096
  v_mfma_f32_16x16x32_bf16 v[140:143], v[180:183], a[52:55], v[140:143]
  s_waitcnt lgkmcnt(0) vmcnt(43)
  s_barrier
  v_mfma_f32_16x16x32_bf16 v[64:67], v[184:187], a[56:59], v[64:67]
  ds_read_b64_tr_b16 v[144:145], v16 offset:20480
  ds_read_b64_tr_b16 v[146:147], v16 offset:21760
  v_mfma_f32_16x16x32_bf16 v[104:107], v[184:187], a[60:63], v[104:107]
  ds_read_b64_tr_b16 v[148:149], v17 offset:20512
  v_mfma_f32_16x16x32_bf16 v[68:71], v[188:191], a[56:59], v[68:71]
  ds_read_b64_tr_b16 v[150:151], v17 offset:21792
  v_mfma_f32_16x16x32_bf16 v[108:111], v[188:191], a[60:63], v[108:111]
  ds_read_b64_tr_b16 v[152:153], v16 offset:20544
  v_mfma_f32_16x16x32_bf16 v[72:75], v[192:195], a[56:59], v[72:75]
  ds_read_b64_tr_b16 v[154:155], v16 offset:21824
  v_mfma_f32_16x16x32_bf16 v[112:115], v[192:195], a[60:63], v[112:115]
  ds_read_b64_tr_b16 v[156:157], v17 offset:20576
  ds_read_b64_tr_b16 v[158:159], v17 offset:21856
  v_mfma_f32_16x16x32_bf16 v[76:79], v[196:199], a[56:59], v[76:79]
  ds_read_b64_tr_b16 v[160:161], v16 offset:20608
  v_mfma_f32_16x16x32_bf16 v[116:119], v[196:199], a[60:63], v[116:119]
  ds_read_b64_tr_b16 v[162:163], v16 offset:21888
  v_mfma_f32_16x16x32_bf16 v[80:83], v[200:203], a[56:59], v[80:83]
  ds_read_b64_tr_b16 v[164:165], v17 offset:20640
  v_mfma_f32_16x16x32_bf16 v[120:123], v[200:203], a[60:63], v[120:123]
  ds_read_b64_tr_b16 v[166:167], v17 offset:21920
  v_mfma_f32_16x16x32_bf16 v[84:87], v[204:207], a[56:59], v[84:87]
  ds_read_b64_tr_b16 v[168:169], v16 offset:20672
  v_mfma_f32_16x16x32_bf16 v[124:127], v[204:207], a[60:63], v[124:127]
  ds_read_b64_tr_b16 v[170:171], v16 offset:21952
  ds_read_b64_tr_b16 v[172:173], v17 offset:20704
  v_mfma_f32_16x16x32_bf16 v[88:91], v[208:211], a[56:59], v[88:91]
  ds_read_b64_tr_b16 v[174:175], v17 offset:21984
  v_mfma_f32_16x16x32_bf16 v[128:131], v[208:211], a[60:63], v[128:131]
  buffer_load_dwordx4 a[136:139], v6, s[16:19], s48 offen offset:0 sc1
  ds_read_b64_tr_b16 v[176:177], v16 offset:20736
  v_mfma_f32_16x16x32_bf16 v[92:95], v[212:215], a[56:59], v[92:95]
  ds_read_b64_tr_b16 v[178:179], v16 offset:22016
  v_mfma_f32_16x16x32_bf16 v[132:135], v[212:215], a[60:63], v[132:135]
  ds_read_b64_tr_b16 v[180:181], v17 offset:20768
  v_mfma_f32_16x16x32_bf16 v[96:99], v[216:219], a[56:59], v[96:99]
  ds_read_b64_tr_b16 v[182:183], v17 offset:22048
  v_mfma_f32_16x16x32_bf16 v[136:139], v[216:219], a[60:63], v[136:139]
  buffer_load_dwordx4 a[140:143], v6, s[16:19], s48 offen offset:128 sc1
  v_mfma_f32_16x16x32_bf16 v[100:103], v[220:223], a[56:59], v[100:103]
  s_add_u32 s48, s48, 132096
  v_mfma_f32_16x16x32_bf16 v[140:143], v[220:223], a[60:63], v[140:143]
  s_waitcnt lgkmcnt(0) vmcnt(43)
  v_mfma_f32_16x16x32_bf16 v[64:67], v[144:147], a[64:67], v[64:67]
  ds_read_b64_tr_b16 v[184:185], v16 offset:30720
  ds_read_b64_tr_b16 v[186:187], v16 offset:32000
  v_mfma_f32_16x16x32_bf16 v[104:107], v[144:147], a[68:71], v[104:107]
  ds_read_b64_tr_b16 v[188:189], v17 offset:30752
  v_mfma_f32_16x16x32_bf16 v[68:71], v[148:151], a[64:67], v[68:71]
  ds_read_b64_tr_b16 v[190:191], v17 offset:32032
  v_mfma_f32_16x16x32_bf16 v[108:111], v[148:151], a[68:71], v[108:111]
  ds_read_b64_tr_b16 v[192:193], v16 offset:30784
  v_mfma_f32_16x16x32_bf16 v[72:75], v[152:155], a[64:67], v[72:75]
  ds_read_b64_tr_b16 v[194:195], v16 offset:32064
  v_mfma_f32_16x16x32_bf16 v[112:115], v[152:155], a[68:71], v[112:115]
  ds_read_b64_tr_b16 v[196:197], v17 offset:30816
  ds_read_b64_tr_b16 v[198:199], v17 offset:32096
  v_mfma_f32_16x16x32_bf16 v[76:79], v[156:159], a[64:67], v[76:79]
  ds_read_b64_tr_b16 v[200:201], v16 offset:30848
  v_mfma_f32_16x16x32_bf16 v[116:119], v[156:159], a[68:71], v[116:119]
  ds_read_b64_tr_b16 v[202:203], v16 offset:32128
  v_mfma_f32_16x16x32_bf16 v[80:83], v[160:163], a[64:67], v[80:83]
  ds_read_b64_tr_b16 v[204:205], v17 offset:30880
  v_mfma_f32_16x16x32_bf16 v[120:123], v[160:163], a[68:71], v[120:123]
  ds_read_b64_tr_b16 v[206:207], v17 offset:32160
  v_mfma_f32_16x16x32_bf16 v[84:87], v[164:167], a[64:67], v[84:87]
  ds_read_b64_tr_b16 v[208:209], v16 offset:30912
  v_mfma_f32_16x16x32_bf16 v[124:127], v[164:167], a[68:71], v[124:127]
  ds_read_b64_tr_b16 v[210:211], v16 offset:32192
  ds_read_b64_tr_b16 v[212:213], v17 offset:30944
  v_mfma_f32_16x16x32_bf16 v[88:91], v[168:171], a[64:67], v[88:91]
  ds_read_b64_tr_b16 v[214:215], v17 offset:32224
  v_mfma_f32_16x16x32_bf16 v[128:131], v[168:171], a[68:71], v[128:131]
  buffer_load_dwordx4 a[144:147], v6, s[16:19], s48 offen offset:0 sc1
  ds_read_b64_tr_b16 v[216:217], v16 offset:30976
  v_mfma_f32_16x16x32_bf16 v[92:95], v[172:175], a[64:67], v[92:95]
  ds_read_b64_tr_b16 v[218:219], v16 offset:32256
  v_mfma_f32_16x16x32_bf16 v[132:135], v[172:175], a[68:71], v[132:135]
  ds_read_b64_tr_b16 v[220:221], v17 offset:31008
  v_mfma_f32_16x16x32_bf16 v[96:99], v[176:179], a[64:67], v[96:99]
  ds_read_b64_tr_b16 v[222:223], v17 offset:32288
  v_mfma_f32_16x16x32_bf16 v[136:139], v[176:179], a[68:71], v[136:139]
  buffer_load_dwordx4 a[148:151], v6, s[16:19], s48 offen offset:128 sc1
  v_mfma_f32_16x16x32_bf16 v[100:103], v[180:183], a[64:67], v[100:103]
  s_add_u32 s48, s48, 132096
  v_mfma_f32_16x16x32_bf16 v[140:143], v[180:183], a[68:71], v[140:143]
  s_waitcnt lgkmcnt(0) vmcnt(38)
  s_barrier
  v_mfma_f32_16x16x32_bf16 v[64:67], v[184:187], a[72:75], v[64:67]
  ds_read_b64_tr_b16 v[144:145], v16 offset:40960
  ds_read_b64_tr_b16 v[146:147], v16 offset:42240
  v_mfma_f32_16x16x32_bf16 v[104:107], v[184:187], a[76:79], v[104:107]
  ds_read_b64_tr_b16 v[148:149], v17 offset:40992
  v_mfma_f32_16x16x32_bf16 v[68:71], v[188:191], a[72:75], v[68:71]
  ds_read_b64_tr_b16 v[150:151], v17 offset:42272
  v_mfma_f32_16x16x32_bf16 v[108:111], v[188:191], a[76:79], v[108:111]
  ds_read_b64_tr_b16 v[152:153], v16 offset:41024
  v_mfma_f32_16x16x32_bf16 v[72:75], v[192:195], a[72:75], v[72:75]
  ds_read_b64_tr_b16 v[154:155], v16 offset:42304
  v_mfma_f32_16x16x32_bf16 v[112:115], v[192:195], a[76:79], v[112:115]
  ds_read_b64_tr_b16 v[156:157], v17 offset:41056
  ds_read_b64_tr_b16 v[158:159], v17 offset:42336
  v_mfma_f32_16x16x32_bf16 v[76:79], v[196:199], a[72:75], v[76:79]
  ds_read_b64_tr_b16 v[160:161], v16 offset:41088
  v_mfma_f32_16x16x32_bf16 v[116:119], v[196:199], a[76:79], v[116:119]
  ds_read_b64_tr_b16 v[162:163], v16 offset:42368
  v_mfma_f32_16x16x32_bf16 v[80:83], v[200:203], a[72:75], v[80:83]
  ds_read_b64_tr_b16 v[164:165], v17 offset:41120
  v_mfma_f32_16x16x32_bf16 v[120:123], v[200:203], a[76:79], v[120:123]
  ds_read_b64_tr_b16 v[166:167], v17 offset:42400
  v_mfma_f32_16x16x32_bf16 v[84:87], v[204:207], a[72:75], v[84:87]
  ds_read_b64_tr_b16 v[168:169], v16 offset:41152
  v_mfma_f32_16x16x32_bf16 v[124:127], v[204:207], a[76:79], v[124:127]
  ds_read_b64_tr_b16 v[170:171], v16 offset:42432
  ds_read_b64_tr_b16 v[172:173], v17 offset:41184
  v_mfma_f32_16x16x32_bf16 v[88:91], v[208:211], a[72:75], v[88:91]
  ds_read_b64_tr_b16 v[174:175], v17 offset:42464
  v_mfma_f32_16x16x32_bf16 v[128:131], v[208:211], a[76:79], v[128:131]
  buffer_load_dwordx4 a[152:155], v6, s[16:19], s48 offen offset:0 sc1
  ds_read_b64_tr_b16 v[176:177], v16 offset:41216
  v_mfma_f32_16x16x32_bf16 v[92:95], v[212:215], a[72:75], v[92:95]
  ds_read_b64_tr_b16 v[178:179], v16 offset:42496
  v_mfma_f32_16x16x32_bf16 v[132:135], v[212:215], a[76:79], v[132:135]
  ds_read_b64_tr_b16 v[180:181], v17 offset:41248
  v_mfma_f32_16x16x32_bf16 v[96:99], v[216:219], a[72:75], v[96:99]
  ds_read_b64_tr_b16 v[182:183], v17 offset:42528
  v_mfma_f32_16x16x32_bf16 v[136:139], v[216:219], a[76:79], v[136:139]
  buffer_load_dwordx4 a[156:159], v6, s[16:19], s48 offen offset:128 sc1
  v_mfma_f32_16x16x32_bf16 v[100:103], v[220:223], a[72:75], v[100:103]
  s_add_u32 s48, s48, 132096
  v_mfma_f32_16x16x32_bf16 v[140:143], v[220:223], a[76:79], v[140:143]
  s_waitcnt lgkmcnt(0) vmcnt(33)
  v_mfma_f32_16x16x32_bf16 v[64:67], v[144:147], a[80:83], v[64:67]
  ds_read_b64_tr_b16 v[184:185], v16 offset:51200
  ds_read_b64_tr_b16 v[186:187], v16 offset:52480
  v_mfma_f32_16x16x32_bf16 v[104:107], v[144:147], a[84:87], v[104:107]
  ds_read_b64_tr_b16 v[188:189], v17 offset:51232
  v_mfma_f32_16x16x32_bf16 v[68:71], v[148:151], a[80:83], v[68:71]
  ds_read_b64_tr_b16 v[190:191], v17 offset:52512
  v_mfma_f32_16x16x32_bf16 v[108:111], v[148:151], a[84:87], v[108:111]
  ds_read_b64_tr_b16 v[192:193], v16 offset:51264
  v_mfma_f32_16x16x32_bf16 v[72:75], v[152:155], a[80:83], v[72:75]
  ds_read_b64_tr_b16 v[194:195], v16 offset:52544
  v_mfma_f32_16x16x32_bf16 v[112:115], v[152:155], a[84:87], v[112:115]
  ds_read_b64_tr_b16 v[196:197], v17 offset:51296
  ds_read_b64_tr_b16 v[198:199], v17 offset:52576
  v_mfma_f32_16x16x32_bf16 v[76:79], v[156:159], a[80:83], v[76:79]
  ds_read_b64_tr_b16 v[200:201], v16 offset:51328
  v_mfma_f32_16x16x32_bf16 v[116:119], v[156:159], a[84:87], v[116:119]
  ds_read_b64_tr_b16 v[202:203], v16 offset:52608
  v_mfma_f32_16x16x32_bf16 v[80:83], v[160:163], a[80:83], v[80:83]
  ds_read_b64_tr_b16 v[204:205], v17 offset:51360
  v_mfma_f32_16x16x32_bf16 v[120:123], v[160:163], a[84:87], v[120:123]
  ds_read_b64_tr_b16 v[206:207], v17 offset:52640
  v_mfma_f32_16x16x32_bf16 v[84:87], v[164:167], a[80:83], v[84:87]
  ds_read_b64_tr_b16 v[208:209], v16 offset:51392
  v_mfma_f32_16x16x32_bf16 v[124:127], v[164:167], a[84:87], v[124:127]
  ds_read_b64_tr_b16 v[210:211], v16 offset:52672
  ds_read_b64_tr_b16 v[212:213], v17 offset:51424
  v_mfma_f32_16x16x32_bf16 v[88:91], v[168:171], a[80:83], v[88:91]
  ds_read_b64_tr_b16 v[214:215], v17 offset:52704
  v_mfma_f32_16x16x32_bf16 v[128:131], v[168:171], a[84:87], v[128:131]
  buffer_load_dwordx4 v[52:55], v4, s[12:15], 0 offen
  ds_read_b64_tr_b16 v[216:217], v16 offset:51456
  v_mfma_f32_16x16x32_bf16 v[92:95], v[172:175], a[80:83], v[92:95]
  ds_read_b64_tr_b16 v[218:219], v16 offset:52736
  v_mfma_f32_16x16x32_bf16 v[132:135], v[172:175], a[84:87], v[132:135]
  ds_read_b64_tr_b16 v[220:221], v17 offset:51488
  v_mfma_f32_16x16x32_bf16 v[96:99], v[176:179], a[80:83], v[96:99]
  ds_read_b64_tr_b16 v[222:223], v17 offset:52768
  v_mfma_f32_16x16x32_bf16 v[136:139], v[176:179], a[84:87], v[136:139]
  buffer_load_dword v56, v5, s[12:15], 0 offen offset:1024
  v_mfma_f32_16x16x32_bf16 v[100:103], v[180:183], a[80:83], v[100:103]
  s_mul_i32 s50, s59, 1280
  v_mfma_f32_16x16x32_bf16 v[140:143], v[180:183], a[84:87], v[140:143]
  s_waitcnt lgkmcnt(0) vmcnt(28)
  s_barrier
  v_mfma_f32_16x16x32_bf16 v[64:67], v[184:187], a[88:91], v[64:67]
  ds_read_b64_tr_b16 v[144:145], v18 offset:0
  ds_read_b64_tr_b16 v[146:147], v18 offset:1280
  v_mfma_f32_16x16x32_bf16 v[104:107], v[184:187], a[92:95], v[104:107]
  ds_read_b64_tr_b16 v[148:149], v19 offset:32
  v_mfma_f32_16x16x32_bf16 v[68:71], v[188:191], a[88:91], v[68:71]
  ds_read_b64_tr_b16 v[150:151], v19 offset:1312
  v_mfma_f32_16x16x32_bf16 v[108:111], v[188:191], a[92:95], v[108:111]
  ds_read_b64_tr_b16 v[152:153], v18 offset:64
  v_mfma_f32_16x16x32_bf16 v[72:75], v[192:195], a[88:91], v[72:75]
  ds_read_b64_tr_b16 v[154:155], v18 offset:1344
  v_mfma_f32_16x16x32_bf16 v[112:115], v[192:195], a[92:95], v[112:115]
  ds_read_b64_tr_b16 v[156:157], v19 offset:96
  ds_read_b64_tr_b16 v[158:159], v19 offset:1376
  v_mfma_f32_16x16x32_bf16 v[76:79], v[196:199], a[88:91], v[76:79]
  ds_read_b64_tr_b16 v[160:161], v18 offset:128
  v_mfma_f32_16x16x32_bf16 v[116:119], v[196:199], a[92:95], v[116:119]
  ds_read_b64_tr_b16 v[162:163], v18 offset:1408
  v_mfma_f32_16x16x32_bf16 v[80:83], v[200:203], a[88:91], v[80:83]
  ds_read_b64_tr_b16 v[164:165], v19 offset:160
  v_mfma_f32_16x16x32_bf16 v[120:123], v[200:203], a[92:95], v[120:123]
  ds_read_b64_tr_b16 v[166:167], v19 offset:1440
  v_mfma_f32_16x16x32_bf16 v[84:87], v[204:207], a[88:91], v[84:87]
  ds_read_b64_tr_b16 v[168:169], v18 offset:192
  v_mfma_f32_16x16x32_bf16 v[124:127], v[204:207], a[92:95], v[124:127]
  ds_read_b64_tr_b16 v[170:171], v18 offset:1472
  ds_read_b64_tr_b16 v[172:173], v19 offset:224
  v_mfma_f32_16x16x32_bf16 v[88:91], v[208:211], a[88:91], v[88:91]
  ds_read_b64_tr_b16 v[174:175], v19 offset:1504
  v_mfma_f32_16x16x32_bf16 v[128:131], v[208:211], a[92:95], v[128:131]
  buffer_load_dwordx4 v[224:227], v4, s[8:11], s50 offen
  ds_read_b64_tr_b16 v[176:177], v18 offset:256
  v_mfma_f32_16x16x32_bf16 v[92:95], v[212:215], a[88:91], v[92:95]
  ds_read_b64_tr_b16 v[178:179], v18 offset:1536
  v_mfma_f32_16x16x32_bf16 v[132:135], v[212:215], a[92:95], v[132:135]
  ds_read_b64_tr_b16 v[180:181], v19 offset:288
  v_mfma_f32_16x16x32_bf16 v[96:99], v[216:219], a[88:91], v[96:99]
  ds_read_b64_tr_b16 v[182:183], v19 offset:1568
  v_mfma_f32_16x16x32_bf16 v[136:139], v[216:219], a[92:95], v[136:139]
  buffer_load_dword v228, v5, s[8:11], s50 offen offset:1024
  v_mfma_f32_16x16x32_bf16 v[100:103], v[220:223], a[88:91], v[100:103]
  s_add_u32 s50, s50, 1280
  v_mfma_f32_16x16x32_bf16 v[140:143], v[220:223], a[92:95], v[140:143]
  s_waitcnt lgkmcnt(0) vmcnt(28)
  v_mfma_f32_16x16x32_bf16 v[64:67], v[144:147], a[96:99], v[64:67]
  ds_read_b64_tr_b16 v[184:185], v18 offset:10240
  ds_read_b64_tr_b16 v[186:187], v18 offset:11520
  v_mfma_f32_16x16x32_bf16 v[104:107], v[144:147], a[100:103], v[104:107]
  ds_read_b64_tr_b16 v[188:189], v19 offset:10272
  v_mfma_f32_16x16x32_bf16 v[68:71], v[148:151], a[96:99], v[68:71]
  ds_read_b64_tr_b16 v[190:191], v19 offset:11552
  v_mfma_f32_16x16x32_bf16 v[108:111], v[148:151], a[100:103], v[108:111]
  ds_read_b64_tr_b16 v[192:193], v18 offset:10304
  v_mfma_f32_16x16x32_bf16 v[72:75], v[152:155], a[96:99], v[72:75]
  ds_read_b64_tr_b16 v[194:195], v18 offset:11584
  v_mfma_f32_16x16x32_bf16 v[112:115], v[152:155], a[100:103], v[112:115]
  ds_read_b64_tr_b16 v[196:197], v19 offset:10336
  ds_read_b64_tr_b16 v[198:199], v19 offset:11616
  v_mfma_f32_16x16x32_bf16 v[76:79], v[156:159], a[96:99], v[76:79]
  ds_read_b64_tr_b16 v[200:201], v18 offset:10368
  v_mfma_f32_16x16x32_bf16 v[116:119], v[156:159], a[100:103], v[116:119]
  ds_read_b64_tr_b16 v[202:203], v18 offset:11648
  v_mfma_f32_16x16x32_bf16 v[80:83], v[160:163], a[96:99], v[80:83]
  ds_read_b64_tr_b16 v[204:205], v19 offset:10400
  v_mfma_f32_16x16x32_bf16 v[120:123], v[160:163], a[100:103], v[120:123]
  ds_read_b64_tr_b16 v[206:207], v19 offset:11680
  v_mfma_f32_16x16x32_bf16 v[84:87], v[164:167], a[96:99], v[84:87]
  ds_read_b64_tr_b16 v[208:209], v18 offset:10432
  v_mfma_f32_16x16x32_bf16 v[124:127], v[164:167], a[100:103], v[124:127]
  ds_read_b64_tr_b16 v[210:211], v18 offset:11712
  ds_read_b64_tr_b16 v[212:213], v19 offset:10464
  v_mfma_f32_16x16x32_bf16 v[88:91], v[168:171], a[96:99], v[88:91]
  ds_read_b64_tr_b16 v[214:215], v19 offset:11744
  v_mfma_f32_16x16x32_bf16 v[128:131], v[168:171], a[100:103], v[128:131]
  buffer_load_dwordx4 v[230:233], v4, s[8:11], s50 offen
  ds_read_b64_tr_b16 v[216:217], v18 offset:10496
  v_mfma_f32_16x16x32_bf16 v[92:95], v[172:175], a[96:99], v[92:95]
  ds_read_b64_tr_b16 v[218:219], v18 offset:11776
  v_mfma_f32_16x16x32_bf16 v[132:135], v[172:175], a[100:103], v[132:135]
  ds_read_b64_tr_b16 v[220:221], v19 offset:10528
  v_mfma_f32_16x16x32_bf16 v[96:99], v[176:179], a[96:99], v[96:99]
  ds_read_b64_tr_b16 v[222:223], v19 offset:11808
  v_mfma_f32_16x16x32_bf16 v[136:139], v[176:179], a[100:103], v[136:139]
  buffer_load_dword v234, v5, s[8:11], s50 offen offset:1024
  v_mfma_f32_16x16x32_bf16 v[100:103], v[180:183], a[96:99], v[100:103]
  s_add_u32 s50, s50, 1280
  v_mfma_f32_16x16x32_bf16 v[140:143], v[180:183], a[100:103], v[140:143]
  s_waitcnt lgkmcnt(0) vmcnt(23)
  s_barrier
  v_mfma_f32_16x16x32_bf16 v[64:67], v[184:187], a[104:107], v[64:67]
  ds_read_b64_tr_b16 v[144:145], v14 offset:0
  ds_read_b64_tr_b16 v[146:147], v14 offset:1280
  v_mfma_f32_16x16x32_bf16 v[104:107], v[184:187], a[108:111], v[104:107]
  ds_read_b64_tr_b16 v[148:149], v15 offset:32
  v_mfma_f32_16x16x32_bf16 v[68:71], v[188:191], a[104:107], v[68:71]
  ds_read_b64_tr_b16 v[150:151], v15 offset:1312
  v_mfma_f32_16x16x32_bf16 v[108:111], v[188:191], a[108:111], v[108:111]
  ds_read_b64_tr_b16 v[152:153], v14 offset:64
  v_mfma_f32_16x16x32_bf16 v[72:75], v[192:195], a[104:107], v[72:75]
  ds_read_b64_tr_b16 v[154:155], v14 offset:1344
  v_mfma_f32_16x16x32_bf16 v[112:115], v[192:195], a[108:111], v[112:115]
  ds_read_b64_tr_b16 v[156:157], v15 offset:96
  ds_read_b64_tr_b16 v[158:159], v15 offset:1376
  v_mfma_f32_16x16x32_bf16 v[76:79], v[196:199], a[104:107], v[76:79]
  ds_read_b64_tr_b16 v[160:161], v14 offset:128
  v_mfma_f32_16x16x32_bf16 v[116:119], v[196:199], a[108:111], v[116:119]
  ds_read_b64_tr_b16 v[162:163], v14 offset:1408
  v_mfma_f32_16x16x32_bf16 v[80:83], v[200:203], a[104:107], v[80:83]
  ds_read_b64_tr_b16 v[164:165], v15 offset:160
  v_mfma_f32_16x16x32_bf16 v[120:123], v[200:203], a[108:111], v[120:123]
  ds_read_b64_tr_b16 v[166:167], v15 offset:1440
  v_mfma_f32_16x16x32_bf16 v[84:87], v[204:207], a[104:107], v[84:87]
  ds_read_b64_tr_b16 v[168:169], v14 offset:192
  v_mfma_f32_16x16x32_bf16 v[124:127], v[204:207], a[108:111], v[124:127]
  ds_read_b64_tr_b16 v[170:171], v14 offset:1472
  ds_read_b64_tr_b16 v[172:173], v15 offset:224
  v_mfma_f32_16x16x32_bf16 v[88:91], v[208:211], a[104:107], v[88:91]
  ds_read_b64_tr_b16 v[174:175], v15 offset:1504
  v_mfma_f32_16x16x32_bf16 v[128:131], v[208:211], a[108:111], v[128:131]
  buffer_load_dwordx4 v[236:239], v4, s[8:11], s50 offen
  ds_read_b64_tr_b16 v[176:177], v14 offset:256
  v_mfma_f32_16x16x32_bf16 v[92:95], v[212:215], a[104:107], v[92:95]
  ds_read_b64_tr_b16 v[178:179], v14 offset:1536
  v_mfma_f32_16x16x32_bf16 v[132:135], v[212:215], a[108:111], v[132:135]
  ds_read_b64_tr_b16 v[180:181], v15 offset:288
  v_mfma_f32_16x16x32_bf16 v[96:99], v[216:219], a[104:107], v[96:99]
  ds_read_b64_tr_b16 v[182:183], v15 offset:1568
  v_mfma_f32_16x16x32_bf16 v[136:139], v[216:219], a[108:111], v[136:139]
  buffer_load_dword v240, v5, s[8:11], s50 offen offset:1024
  v_mfma_f32_16x16x32_bf16 v[100:103], v[220:223], a[104:107], v[100:103]
  s_add_u32 s50, s50, 1280
  v_mfma_f32_16x16x32_bf16 v[140:143], v[220:223], a[108:111], v[140:143]
  s_waitcnt lgkmcnt(0) vmcnt(23)
  v_mfma_f32_16x16x32_bf16 v[64:67], v[144:147], a[112:115], v[64:67]
  ds_read_b64_tr_b16 v[184:185], v14 offset:10240
  ds_read_b64_tr_b16 v[186:187], v14 offset:11520
  v_mfma_f32_16x16x32_bf16 v[104:107], v[144:147], a[116:119], v[104:107]
  ds_read_b64_tr_b16 v[188:189], v15 offset:10272
  v_mfma_f32_16x16x32_bf16 v[68:71], v[148:151], a[112:115], v[68:71]
  ds_read_b64_tr_b16 v[190:191], v15 offset:11552
  v_mfma_f32_16x16x32_bf16 v[108:111], v[148:151], a[116:119], v[108:111]
  ds_read_b64_tr_b16 v[192:193], v14 offset:10304
  v_mfma_f32_16x16x32_bf16 v[72:75], v[152:155], a[112:115], v[72:75]
  ds_read_b64_tr_b16 v[194:195], v14 offset:11584
  v_mfma_f32_16x16x32_bf16 v[112:115], v[152:155], a[116:119], v[112:115]
  ds_read_b64_tr_b16 v[196:197], v15 offset:10336
  ds_read_b64_tr_b16 v[198:199], v15 offset:11616
  v_mfma_f32_16x16x32_bf16 v[76:79], v[156:159], a[112:115], v[76:79]
  ds_read_b64_tr_b16 v[200:201], v14 offset:10368
  v_mfma_f32_16x16x32_bf16 v[116:119], v[156:159], a[116:119], v[116:119]
  ds_read_b64_tr_b16 v[202:203], v14 offset:11648
  v_mfma_f32_16x16x32_bf16 v[80:83], v[160:163], a[112:115], v[80:83]
  ds_read_b64_tr_b16 v[204:205], v15 offset:10400
  v_mfma_f32_16x16x32_bf16 v[120:123], v[160:163], a[116:119], v[120:123]
  ds_read_b64_tr_b16 v[206:207], v15 offset:11680
  v_mfma_f32_16x16x32_bf16 v[84:87], v[164:167], a[112:115], v[84:87]
  ds_read_b64_tr_b16 v[208:209], v14 offset:10432
  v_mfma_f32_16x16x32_bf16 v[124:127], v[164:167], a[116:119], v[124:127]
  ds_read_b64_tr_b16 v[210:211], v14 offset:11712
  ds_read_b64_tr_b16 v[212:213], v15 offset:10464
  v_mfma_f32_16x16x32_bf16 v[88:91], v[168:171], a[112:115], v[88:91]
  ds_read_b64_tr_b16 v[214:215], v15 offset:11744
  v_mfma_f32_16x16x32_bf16 v[128:131], v[168:171], a[116:119], v[128:131]
  buffer_load_dwordx4 v[242:245], v4, s[8:11], s50 offen
  ds_read_b64_tr_b16 v[216:217], v14 offset:10496
  v_mfma_f32_16x16x32_bf16 v[92:95], v[172:175], a[112:115], v[92:95]
  ds_read_b64_tr_b16 v[218:219], v14 offset:11776
  v_mfma_f32_16x16x32_bf16 v[132:135], v[172:175], a[116:119], v[132:135]
  ds_read_b64_tr_b16 v[220:221], v15 offset:10528
  v_mfma_f32_16x16x32_bf16 v[96:99], v[176:179], a[112:115], v[96:99]
  ds_read_b64_tr_b16 v[222:223], v15 offset:11808
  v_mfma_f32_16x16x32_bf16 v[136:139], v[176:179], a[116:119], v[136:139]
  buffer_load_dword v246, v5, s[8:11], s50 offen offset:1024
  v_mfma_f32_16x16x32_bf16 v[100:103], v[180:183], a[112:115], v[100:103]
  s_add_u32 s50, s50, 1280
  v_mfma_f32_16x16x32_bf16 v[140:143], v[180:183], a[116:119], v[140:143]
  s_waitcnt lgkmcnt(0) vmcnt(18)
  s_barrier
  v_mfma_f32_16x16x32_bf16 v[64:67], v[184:187], a[120:123], v[64:67]
  ds_read_b64_tr_b16 v[144:145], v14 offset:20480
  ds_read_b64_tr_b16 v[146:147], v14 offset:21760
  v_mfma_f32_16x16x32_bf16 v[104:107], v[184:187], a[124:127], v[104:107]
  ds_read_b64_tr_b16 v[148:149], v15 offset:20512
  v_mfma_f32_16x16x32_bf16 v[68:71], v[188:191], a[120:123], v[68:71]
  ds_read_b64_tr_b16 v[150:151], v15 offset:21792
  v_mfma_f32_16x16x32_bf16 v[108:111], v[188:191], a[124:127], v[108:111]
  ds_read_b64_tr_b16 v[152:153], v14 offset:20544
  v_mfma_f32_16x16x32_bf16 v[72:75], v[192:195], a[120:123], v[72:75]
  ds_read_b64_tr_b16 v[154:155], v14 offset:21824
  v_mfma_f32_16x16x32_bf16 v[112:115], v[192:195], a[124:127], v[112:115]
  ds_read_b64_tr_b16 v[156:157], v15 offset:20576
  ds_read_b64_tr_b16 v[158:159], v15 offset:21856
  v_mfma_f32_16x16x32_bf16 v[76:79], v[196:199], a[120:123], v[76:79]
  ds_read_b64_tr_b16 v[160:161], v14 offset:20608
  v_mfma_f32_16x16x32_bf16 v[116:119], v[196:199], a[124:127], v[116:119]
  ds_read_b64_tr_b16 v[162:163], v14 offset:21888
  v_mfma_f32_16x16x32_bf16 v[80:83], v[200:203], a[120:123], v[80:83]
  ds_read_b64_tr_b16 v[164:165], v15 offset:20640
  v_mfma_f32_16x16x32_bf16 v[120:123], v[200:203], a[124:127], v[120:123]
  ds_read_b64_tr_b16 v[166:167], v15 offset:21920
  v_mfma_f32_16x16x32_bf16 v[84:87], v[204:207], a[120:123], v[84:87]
  ds_read_b64_tr_b16 v[168:169], v14 offset:20672
  v_mfma_f32_16x16x32_bf16 v[124:127], v[204:207], a[124:127], v[124:127]
  ds_read_b64_tr_b16 v[170:171], v14 offset:21952
  ds_read_b64_tr_b16 v[172:173], v15 offset:20704
  v_mfma_f32_16x16x32_bf16 v[88:91], v[208:211], a[120:123], v[88:91]
  ds_read_b64_tr_b16 v[174:175], v15 offset:21984
  v_mfma_f32_16x16x32_bf16 v[128:131], v[208:211], a[124:127], v[128:131]
  buffer_load_dwordx4 v[248:251], v4, s[8:11], s50 offen
  ds_read_b64_tr_b16 v[176:177], v14 offset:20736
  v_mfma_f32_16x16x32_bf16 v[92:95], v[212:215], a[120:123], v[92:95]
  ds_read_b64_tr_b16 v[178:179], v14 offset:22016
  v_mfma_f32_16x16x32_bf16 v[132:135], v[212:215], a[124:127], v[132:135]
  ds_read_b64_tr_b16 v[180:181], v15 offset:20768
  v_mfma_f32_16x16x32_bf16 v[96:99], v[216:219], a[120:123], v[96:99]
  ds_read_b64_tr_b16 v[182:183], v15 offset:22048
  v_mfma_f32_16x16x32_bf16 v[136:139], v[216:219], a[124:127], v[136:139]
  buffer_load_dword v252, v5, s[8:11], s50 offen offset:1024
  v_mfma_f32_16x16x32_bf16 v[100:103], v[220:223], a[120:123], v[100:103]
  s_add_u32 s50, s50, 1280
  v_mfma_f32_16x16x32_bf16 v[140:143], v[220:223], a[124:127], v[140:143]
  s_waitcnt lgkmcnt(0) vmcnt(18)
  v_mfma_f32_16x16x32_bf16 v[64:67], v[144:147], a[128:131], v[64:67]
  ds_read_b64_tr_b16 v[184:185], v14 offset:30720
  ds_read_b64_tr_b16 v[186:187], v14 offset:32000
  v_mfma_f32_16x16x32_bf16 v[104:107], v[144:147], a[132:135], v[104:107]
  ds_read_b64_tr_b16 v[188:189], v15 offset:30752
  v_mfma_f32_16x16x32_bf16 v[68:71], v[148:151], a[128:131], v[68:71]
  ds_read_b64_tr_b16 v[190:191], v15 offset:32032
  v_mfma_f32_16x16x32_bf16 v[108:111], v[148:151], a[132:135], v[108:111]
  ds_read_b64_tr_b16 v[192:193], v14 offset:30784
  v_mfma_f32_16x16x32_bf16 v[72:75], v[152:155], a[128:131], v[72:75]
  ds_read_b64_tr_b16 v[194:195], v14 offset:32064
  v_mfma_f32_16x16x32_bf16 v[112:115], v[152:155], a[132:135], v[112:115]
  ds_read_b64_tr_b16 v[196:197], v15 offset:30816
  ds_read_b64_tr_b16 v[198:199], v15 offset:32096
  v_mfma_f32_16x16x32_bf16 v[76:79], v[156:159], a[128:131], v[76:79]
  ds_read_b64_tr_b16 v[200:201], v14 offset:30848
  v_mfma_f32_16x16x32_bf16 v[116:119], v[156:159], a[132:135], v[116:119]
  ds_read_b64_tr_b16 v[202:203], v14 offset:32128
  v_mfma_f32_16x16x32_bf16 v[80:83], v[160:163], a[128:131], v[80:83]
  ds_read_b64_tr_b16 v[204:205], v15 offset:30880
  v_mfma_f32_16x16x32_bf16 v[120:123], v[160:163], a[132:135], v[120:123]
  ds_read_b64_tr_b16 v[206:207], v15 offset:32160
  v_mfma_f32_16x16x32_bf16 v[84:87], v[164:167], a[128:131], v[84:87]
  ds_read_b64_tr_b16 v[208:209], v14 offset:30912
  v_mfma_f32_16x16x32_bf16 v[124:127], v[164:167], a[132:135], v[124:127]
  ds_read_b64_tr_b16 v[210:211], v14 offset:32192
  ds_read_b64_tr_b16 v[212:213], v15 offset:30944
  v_mfma_f32_16x16x32_bf16 v[88:91], v[168:171], a[128:131], v[88:91]
  ds_read_b64_tr_b16 v[214:215], v15 offset:32224
  v_mfma_f32_16x16x32_bf16 v[128:131], v[168:171], a[132:135], v[128:131]
  buffer_load_dwordx4 v[30:33], v4, s[8:11], s50 offen
  ds_read_b64_tr_b16 v[216:217], v14 offset:30976
  v_mfma_f32_16x16x32_bf16 v[92:95], v[172:175], a[128:131], v[92:95]
  ds_read_b64_tr_b16 v[218:219], v14 offset:32256
  v_mfma_f32_16x16x32_bf16 v[132:135], v[172:175], a[132:135], v[132:135]
  ds_read_b64_tr_b16 v[220:221], v15 offset:31008
  v_mfma_f32_16x16x32_bf16 v[96:99], v[176:179], a[128:131], v[96:99]
  ds_read_b64_tr_b16 v[222:223], v15 offset:32288
  v_mfma_f32_16x16x32_bf16 v[136:139], v[176:179], a[132:135], v[136:139]
  buffer_load_dword v34, v5, s[8:11], s50 offen offset:1024
  v_mfma_f32_16x16x32_bf16 v[100:103], v[180:183], a[128:131], v[100:103]
  s_add_u32 s50, s50, 1280
  v_mfma_f32_16x16x32_bf16 v[140:143], v[180:183], a[132:135], v[140:143]
  s_waitcnt lgkmcnt(0) vmcnt(18)
  s_barrier
  v_mfma_f32_16x16x32_bf16 v[64:67], v[184:187], a[136:139], v[64:67]
  ds_read_b64_tr_b16 v[144:145], v14 offset:40960
  ds_read_b64_tr_b16 v[146:147], v14 offset:42240
  v_mfma_f32_16x16x32_bf16 v[104:107], v[184:187], a[140:143], v[104:107]
  ds_read_b64_tr_b16 v[148:149], v15 offset:40992
  v_mfma_f32_16x16x32_bf16 v[68:71], v[188:191], a[136:139], v[68:71]
  ds_read_b64_tr_b16 v[150:151], v15 offset:42272
  v_mfma_f32_16x16x32_bf16 v[108:111], v[188:191], a[140:143], v[108:111]
  ds_read_b64_tr_b16 v[152:153], v14 offset:41024
  v_mfma_f32_16x16x32_bf16 v[72:75], v[192:195], a[136:139], v[72:75]
  ds_read_b64_tr_b16 v[154:155], v14 offset:42304
  v_mfma_f32_16x16x32_bf16 v[112:115], v[192:195], a[140:143], v[112:115]
  ds_read_b64_tr_b16 v[156:157], v15 offset:41056
  ds_read_b64_tr_b16 v[158:159], v15 offset:42336
  v_mfma_f32_16x16x32_bf16 v[76:79], v[196:199], a[136:139], v[76:79]
  ds_read_b64_tr_b16 v[160:161], v14 offset:41088
  v_mfma_f32_16x16x32_bf16 v[116:119], v[196:199], a[140:143], v[116:119]
  ds_read_b64_tr_b16 v[162:163], v14 offset:42368
  v_mfma_f32_16x16x32_bf16 v[80:83], v[200:203], a[136:139], v[80:83]
  ds_read_b64_tr_b16 v[164:165], v15 offset:41120
  v_mfma_f32_16x16x32_bf16 v[120:123], v[200:203], a[140:143], v[120:123]
  ds_read_b64_tr_b16 v[166:167], v15 offset:42400
  v_mfma_f32_16x16x32_bf16 v[84:87], v[204:207], a[136:139], v[84:87]
  ds_read_b64_tr_b16 v[168:169], v14 offset:41152
  v_mfma_f32_16x16x32_bf16 v[124:127], v[204:207], a[140:143], v[124:127]
  ds_read_b64_tr_b16 v[170:171], v14 offset:42432
  ds_read_b64_tr_b16 v[172:173], v15 offset:41184
  v_mfma_f32_16x16x32_bf16 v[88:91], v[208:211], a[136:139], v[88:91]
  ds_read_b64_tr_b16 v[174:175], v15 offset:42464
  v_mfma_f32_16x16x32_bf16 v[128:131], v[208:211], a[140:143], v[128:131]
  buffer_load_dwordx4 v[36:39], v4, s[8:11], s50 offen
  ds_read_b64_tr_b16 v[176:177], v14 offset:41216
  v_mfma_f32_16x16x32_bf16 v[92:95], v[212:215], a[136:139], v[92:95]
  ds_read_b64_tr_b16 v[178:179], v14 offset:42496
  v_mfma_f32_16x16x32_bf16 v[132:135], v[212:215], a[140:143], v[132:135]
  ds_read_b64_tr_b16 v[180:181], v15 offset:41248
  v_mfma_f32_16x16x32_bf16 v[96:99], v[216:219], a[136:139], v[96:99]
  ds_read_b64_tr_b16 v[182:183], v15 offset:42528
  v_mfma_f32_16x16x32_bf16 v[136:139], v[216:219], a[140:143], v[136:139]
  buffer_load_dword v40, v5, s[8:11], s50 offen offset:1024
  v_mfma_f32_16x16x32_bf16 v[100:103], v[220:223], a[136:139], v[100:103]
  s_add_u32 s50, s50, 1280
  v_mfma_f32_16x16x32_bf16 v[140:143], v[220:223], a[140:143], v[140:143]
  s_waitcnt lgkmcnt(0) vmcnt(18)
  v_mfma_f32_16x16x32_bf16 v[64:67], v[144:147], a[144:147], v[64:67]
  ds_read_b64_tr_b16 v[184:185], v14 offset:51200
  ds_read_b64_tr_b16 v[186:187], v14 offset:52480
  v_mfma_f32_16x16x32_bf16 v[104:107], v[144:147], a[148:151], v[104:107]
  ds_read_b64_tr_b16 v[188:189], v15 offset:51232
  v_mfma_f32_16x16x32_bf16 v[68:71], v[148:151], a[144:147], v[68:71]
  ds_read_b64_tr_b16 v[190:191], v15 offset:52512
  v_mfma_f32_16x16x32_bf16 v[108:111], v[148:151], a[148:151], v[108:111]
  ds_read_b64_tr_b16 v[192:193], v14 offset:51264
  v_mfma_f32_16x16x32_bf16 v[72:75], v[152:155], a[144:147], v[72:75]
  ds_read_b64_tr_b16 v[194:195], v14 offset:52544
  v_mfma_f32_16x16x32_bf16 v[112:115], v[152:155], a[148:151], v[112:115]
  ds_read_b64_tr_b16 v[196:197], v15 offset:51296
  ds_read_b64_tr_b16 v[198:199], v15 offset:52576
  v_mfma_f32_16x16x32_bf16 v[76:79], v[156:159], a[144:147], v[76:79]
  ds_read_b64_tr_b16 v[200:201], v14 offset:51328
  v_mfma_f32_16x16x32_bf16 v[116:119], v[156:159], a[148:151], v[116:119]
  ds_read_b64_tr_b16 v[202:203], v14 offset:52608
  v_mfma_f32_16x16x32_bf16 v[80:83], v[160:163], a[144:147], v[80:83]
  ds_read_b64_tr_b16 v[204:205], v15 offset:51360
  v_mfma_f32_16x16x32_bf16 v[120:123], v[160:163], a[148:151], v[120:123]
  ds_read_b64_tr_b16 v[206:207], v15 offset:52640
  v_mfma_f32_16x16x32_bf16 v[84:87], v[164:167], a[144:147], v[84:87]
  ds_read_b64_tr_b16 v[208:209], v14 offset:51392
  v_mfma_f32_16x16x32_bf16 v[124:127], v[164:167], a[148:151], v[124:127]
  ds_read_b64_tr_b16 v[210:211], v14 offset:52672
  ds_read_b64_tr_b16 v[212:213], v15 offset:51424
  v_mfma_f32_16x16x32_bf16 v[88:91], v[168:171], a[144:147], v[88:91]
  ds_read_b64_tr_b16 v[214:215], v15 offset:52704
  v_mfma_f32_16x16x32_bf16 v[128:131], v[168:171], a[148:151], v[128:131]
  buffer_load_dwordx4 v[42:45], v4, s[8:11], s50 offen
  ds_read_b64_tr_b16 v[216:217], v14 offset:51456
  v_mfma_f32_16x16x32_bf16 v[92:95], v[172:175], a[144:147], v[92:95]
  ds_read_b64_tr_b16 v[218:219], v14 offset:52736
  v_mfma_f32_16x16x32_bf16 v[132:135], v[172:175], a[148:151], v[132:135]
  ds_read_b64_tr_b16 v[220:221], v15 offset:51488
  v_mfma_f32_16x16x32_bf16 v[96:99], v[176:179], a[144:147], v[96:99]
  ds_read_b64_tr_b16 v[222:223], v15 offset:52768
  v_mfma_f32_16x16x32_bf16 v[136:139], v[176:179], a[148:151], v[136:139]
  buffer_load_dword v46, v5, s[8:11], s50 offen offset:1024
  v_mfma_f32_16x16x32_bf16 v[100:103], v[180:183], a[144:147], v[100:103]
  s_add_u32 s50, s50, 1280
  v_mfma_f32_16x16x32_bf16 v[140:143], v[180:183], a[148:151], v[140:143]
  s_waitcnt lgkmcnt(0) vmcnt(18)
  v_mfma_f32_16x16x32_bf16 v[64:67], v[184:187], a[152:155], v[64:67]
  v_mfma_f32_16x16x32_bf16 v[104:107], v[184:187], a[156:159], v[104:107]
  v_mfma_f32_16x16x32_bf16 v[68:71], v[188:191], a[152:155], v[68:71]
  v_mfma_f32_16x16x32_bf16 v[108:111], v[188:191], a[156:159], v[108:111]
  v_mfma_f32_16x16x32_bf16 v[72:75], v[192:195], a[152:155], v[72:75]
  v_mfma_f32_16x16x32_bf16 v[112:115], v[192:195], a[156:159], v[112:115]
  v_mfma_f32_16x16x32_bf16 v[76:79], v[196:199], a[152:155], v[76:79]
  v_mfma_f32_16x16x32_bf16 v[116:119], v[196:199], a[156:159], v[116:119]
  v_mfma_f32_16x16x32_bf16 v[80:83], v[200:203], a[152:155], v[80:83]
  v_mfma_f32_16x16x32_bf16 v[120:123], v[200:203], a[156:159], v[120:123]
  v_mfma_f32_16x16x32_bf16 v[84:87], v[204:207], a[152:155], v[84:87]
  v_mfma_f32_16x16x32_bf16 v[124:127], v[204:207], a[156:159], v[124:127]
  v_mfma_f32_16x16x32_bf16 v[88:91], v[208:211], a[152:155], v[88:91]
  v_mfma_f32_16x16x32_bf16 v[128:131], v[208:211], a[156:159], v[128:131]
  v_mfma_f32_16x16x32_bf16 v[92:95], v[212:215], a[152:155], v[92:95]
  v_mfma_f32_16x16x32_bf16 v[132:135], v[212:215], a[156:159], v[132:135]
  v_mfma_f32_16x16x32_bf16 v[96:99], v[216:219], a[152:155], v[96:99]
  v_mfma_f32_16x16x32_bf16 v[136:139], v[216:219], a[156:159], v[136:139]
  v_mfma_f32_16x16x32_bf16 v[100:103], v[220:223], a[152:155], v[100:103]
  v_mfma_f32_16x16x32_bf16 v[140:143], v[220:223], a[156:159], v[140:143]
  s_add_u32 s16, s38, 73400320
  s_addc_u32 s17, s39, 0
  s_mov_b32 s18, 5242880
  s_mov_b32 s19, 0x00020000
  s_nop 3
  s_mul_i32 s21, s47, 40
  s_mul_i32 s22, s44, 10
  s_add_u32 s21, s21, s22
  s_lshl_b32 s21, s21, 10
  s_cmp_lt_u32 s2, 32
  s_cbranch_scc1 om_262
  s_add_u32 s22, s21, 0
  buffer_store_dwordx4 v[64:67], v4, s[16:19], s22 offen offset:0 sc1
  buffer_store_dwordx4 v[68:71], v4, s[16:19], s22 offen offset:1024 sc1
  buffer_store_dwordx4 v[72:75], v4, s[16:19], s22 offen offset:2048 sc1
  buffer_store_dwordx4 v[76:79], v4, s[16:19], s22 offen offset:3072 sc1
  s_add_u32 s22, s21, 4096
  buffer_store_dwordx4 v[80:83], v4, s[16:19], s22 offen offset:0 sc1
  buffer_store_dwordx4 v[84:87], v4, s[16:19], s22 offen offset:1024 sc1
  buffer_store_dwordx4 v[88:91], v4, s[16:19], s22 offen offset:2048 sc1
  buffer_store_dwordx4 v[92:95], v4, s[16:19], s22 offen offset:3072 sc1
  s_add_u32 s22, s21, 8192
  buffer_store_dwordx4 v[96:99], v4, s[16:19], s22 offen offset:0 sc1
  buffer_store_dwordx4 v[100:103], v4, s[16:19], s22 offen offset:1024 sc1
  s_add_u32 s22, s21, 40960
  buffer_store_dwordx4 v[104:107], v4, s[16:19], s22 offen offset:0 sc1
  buffer_store_dwordx4 v[108:111], v4, s[16:19], s22 offen offset:1024 sc1
  buffer_store_dwordx4 v[112:115], v4, s[16:19], s22 offen offset:2048 sc1
  buffer_store_dwordx4 v[116:119], v4, s[16:19], s22 offen offset:3072 sc1
  s_add_u32 s22, s21, 45056
  buffer_store_dwordx4 v[120:123], v4, s[16:19], s22 offen offset:0 sc1
  buffer_store_dwordx4 v[124:127], v4, s[16:19], s22 offen offset:1024 sc1
  buffer_store_dwordx4 v[128:131], v4, s[16:19], s22 offen offset:2048 sc1
  buffer_store_dwordx4 v[132:135], v4, s[16:19], s22 offen offset:3072 sc1
  s_add_u32 s22, s21, 49152
  buffer_store_dwordx4 v[136:139], v4, s[16:19], s22 offen offset:0 sc1
  buffer_store_dwordx4 v[140:143], v4, s[16:19], s22 offen offset:1024 sc1
  s_sub_u32 s50, s50, 1320960
  buffer_load_dwordx4 v[160:163], v4, s[8:11], s50 offen
  buffer_load_dword v164, v5, s[8:11], s50 offen offset:1024
  s_add_u32 s50, s50, 1280
  buffer_load_dwordx4 v[166:169], v4, s[8:11], s50 offen
  buffer_load_dword v170, v5, s[8:11], s50 offen offset:1024
  s_add_u32 s50, s50, 1280
  buffer_load_dwordx4 v[172:175], v4, s[8:11], s50 offen
  buffer_load_dword v176, v5, s[8:11], s50 offen offset:1024
  s_add_u32 s50, s50, 1280
  buffer_load_dwordx4 v[178:181], v4, s[8:11], s50 offen
  buffer_load_dword v182, v5, s[8:11], s50 offen offset:1024
  s_add_u32 s50, s50, 1280
  buffer_load_dwordx4 v[184:187], v4, s[8:11], s50 offen
  buffer_load_dword v188, v5, s[8:11], s50 offen offset:1024
  s_add_u32 s50, s50, 1280
  buffer_load_dwordx4 v[190:193], v4, s[8:11], s50 offen
  buffer_load_dword v194, v5, s[8:11], s50 offen offset:1024
  s_add_u32 s50, s50, 1280
  buffer_load_dwordx4 v[196:199], v4, s[8:11], s50 offen
  buffer_load_dword v200, v5, s[8:11], s50 offen offset:1024
  s_add_u32 s50, s50, 1280
  buffer_load_dwordx4 v[202:205], v4, s[8:11], s50 offen
  buffer_load_dword v206, v5, s[8:11], s50 offen offset:1024
  s_add_u32 s50, s50, 1280
  s_waitcnt vmcnt(36)
  v_lshlrev_b32 v57, 16, v52
  v_and_b32 v52, 0xffff0000, v52
  v_lshlrev_b32 v58, 16, v53
  v_and_b32 v53, 0xffff0000, v53
  v_lshlrev_b32 v59, 16, v54
  v_and_b32 v54, 0xffff0000, v54
  v_lshlrev_b32 v60, 16, v55
  v_and_b32 v55, 0xffff0000, v55
  v_lshlrev_b32 v61, 16, v56
  v_and_b32 v56, 0xffff0000, v56
  v_lshlrev_b32 v25, 16, v224
  v_and_b32 v26, 0xffff0000, v224
  v_mul_f32 v25, v25, v57
  v_mul_f32 v26, v26, v52
  v_cvt_pk_bf16_f32 v25, v25, v26
  v_lshlrev_b32 v26, 16, v25
  v_and_b32 v25, 0xffff0000, v25
  v_add_f32 v144, v25, v26
  v_lshlrev_b32 v25, 16, v225
  v_and_b32 v26, 0xffff0000, v225
  v_mul_f32 v25, v25, v58
  v_mul_f32 v26, v26, v53
  v_cvt_pk_bf16_f32 v25, v25, v26
  v_lshlrev_b32 v26, 16, v25
  v_and_b32 v25, 0xffff0000, v25
  v_add_f32 v144, v144, v26
  v_add_f32 v144, v144, v25
  v_lshlrev_b32 v25, 16, v226
  v_and_b32 v26, 0xffff0000, v226
  v_mul_f32 v25, v25, v59
  v_mul_f32 v26, v26, v54
  v_cvt_pk_bf16_f32 v25, v25, v26
  v_lshlrev_b32 v26, 16, v25
  v_and_b32 v25, 0xffff0000, v25
  v_add_f32 v144, v144, v26
  v_add_f32 v144, v144, v25
  v_lshlrev_b32 v25, 16, v227
  v_and_b32 v26, 0xffff0000, v227
  v_mul_f32 v25, v25, v60
  v_mul_f32 v26, v26, v55
  v_cvt_pk_bf16_f32 v25, v25, v26
  v_lshlrev_b32 v26, 16, v25
  v_and_b32 v25, 0xffff0000, v25
  v_add_f32 v144, v144, v26
  v_add_f32 v144, v144, v25
  v_lshlrev_b32 v25, 16, v228
  v_and_b32 v26, 0xffff0000, v228
  v_mul_f32 v25, v25, v61
  v_mul_f32 v26, v26, v56
  v_cvt_pk_bf16_f32 v25, v25, v26
  v_lshlrev_b32 v26, 16, v25
  v_and_b32 v25, 0xffff0000, v25
  v_add_f32 v144, v144, v26
  v_add_f32 v144, v144, v25
  v_lshlrev_b32 v25, 16, v230
  v_and_b32 v26, 0xffff0000, v230
  v_mul_f32 v25, v25, v57
  v_mul_f32 v26, v26, v52
  v_cvt_pk_bf16_f32 v25, v25, v26
  v_lshlrev_b32 v26, 16, v25
  v_and_b32 v25, 0xffff0000, v25
  v_add_f32 v145, v25, v26
  v_lshlrev_b32 v25, 16, v231
  v_and_b32 v26, 0xffff0000, v231
  v_mul_f32 v25, v25, v58
  v_mul_f32 v26, v26, v53
  v_cvt_pk_bf16_f32 v25, v25, v26
  v_lshlrev_b32 v26, 16, v25
  v_and_b32 v25, 0xffff0000, v25
  v_add_f32 v145, v145, v26
  v_add_f32 v145, v145, v25
  v_lshlrev_b32 v25, 16, v232
  v_and_b32 v26, 0xffff0000, v232
  v_mul_f32 v25, v25, v59
  v_mul_f32 v26, v26, v54
  v_cvt_pk_bf16_f32 v25, v25, v26
  v_lshlrev_b32 v26, 16, v25
  v_and_b32 v25, 0xffff0000, v25
  v_add_f32 v145, v145, v26
  v_add_f32 v145, v145, v25
  v_lshlrev_b32 v25, 16, v233
  v_and_b32 v26, 0xffff0000, v233
  v_mul_f32 v25, v25, v60
  v_mul_f32 v26, v26, v55
  v_cvt_pk_bf16_f32 v25, v25, v26
  v_lshlrev_b32 v26, 16, v25
  v_and_b32 v25, 0xffff0000, v25
  v_add_f32 v145, v145, v26
  v_add_f32 v145, v145, v25
  v_lshlrev_b32 v25, 16, v234
  v_and_b32 v26, 0xffff0000, v234
  v_mul_f32 v25, v25, v61
  v_mul_f32 v26, v26, v56
  v_cvt_pk_bf16_f32 v25, v25, v26
  v_lshlrev_b32 v26, 16, v25
  v_and_b32 v25, 0xffff0000, v25
  v_add_f32 v145, v145, v26
  v_add_f32 v145, v145, v25
  v_lshlrev_b32 v25, 16, v236
  v_and_b32 v26, 0xffff0000, v236
  v_mul_f32 v25, v25, v57
  v_mul_f32 v26, v26, v52
  v_cvt_pk_bf16_f32 v25, v25, v26
  v_lshlrev_b32 v26, 16, v25
  v_and_b32 v25, 0xffff0000, v25
  v_add_f32 v146, v25, v26
  v_lshlrev_b32 v25, 16, v237
  v_and_b32 v26, 0xffff0000, v237
  v_mul_f32 v25, v25, v58
  v_mul_f32 v26, v26, v53
  v_cvt_pk_bf16_f32 v25, v25, v26
  v_lshlrev_b32 v26, 16, v25
  v_and_b32 v25, 0xffff0000, v25
  v_add_f32 v146, v146, v26
  v_add_f32 v146, v146, v25
  v_lshlrev_b32 v25, 16, v238
  v_and_b32 v26, 0xffff0000, v238
  v_mul_f32 v25, v25, v59
  v_mul_f32 v26, v26, v54
  v_cvt_pk_bf16_f32 v25, v25, v26
  v_lshlrev_b32 v26, 16, v25
  v_and_b32 v25, 0xffff0000, v25
  v_add_f32 v146, v146, v26
  v_add_f32 v146, v146, v25
  v_lshlrev_b32 v25, 16, v239
  v_and_b32 v26, 0xffff0000, v239
  v_mul_f32 v25, v25, v60
  v_mul_f32 v26, v26, v55
  v_cvt_pk_bf16_f32 v25, v25, v26
  v_lshlrev_b32 v26, 16, v25
  v_and_b32 v25, 0xffff0000, v25
  v_add_f32 v146, v146, v26
  v_add_f32 v146, v146, v25
  v_lshlrev_b32 v25, 16, v240
  v_and_b32 v26, 0xffff0000, v240
  v_mul_f32 v25, v25, v61
  v_mul_f32 v26, v26, v56
  v_cvt_pk_bf16_f32 v25, v25, v26
  v_lshlrev_b32 v26, 16, v25
  v_and_b32 v25, 0xffff0000, v25
  v_add_f32 v146, v146, v26
  v_add_f32 v146, v146, v25
  v_lshlrev_b32 v25, 16, v242
  v_and_b32 v26, 0xffff0000, v242
  v_mul_f32 v25, v25, v57
  v_mul_f32 v26, v26, v52
  v_cvt_pk_bf16_f32 v25, v25, v26
  v_lshlrev_b32 v26, 16, v25
  v_and_b32 v25, 0xffff0000, v25
  v_add_f32 v147, v25, v26
  v_lshlrev_b32 v25, 16, v243
  v_and_b32 v26, 0xffff0000, v243
  v_mul_f32 v25, v25, v58
  v_mul_f32 v26, v26, v53
  v_cvt_pk_bf16_f32 v25, v25, v26
  v_lshlrev_b32 v26, 16, v25
  v_and_b32 v25, 0xffff0000, v25
  v_add_f32 v147, v147, v26
  v_add_f32 v147, v147, v25
  v_lshlrev_b32 v25, 16, v244
  v_and_b32 v26, 0xffff0000, v244
  v_mul_f32 v25, v25, v59
  v_mul_f32 v26, v26, v54
  v_cvt_pk_bf16_f32 v25, v25, v26
  v_lshlrev_b32 v26, 16, v25
  v_and_b32 v25, 0xffff0000, v25
  v_add_f32 v147, v147, v26
  v_add_f32 v147, v147, v25
  v_lshlrev_b32 v25, 16, v245
  v_and_b32 v26, 0xffff0000, v245
  v_mul_f32 v25, v25, v60
  v_mul_f32 v26, v26, v55
  v_cvt_pk_bf16_f32 v25, v25, v26
  v_lshlrev_b32 v26, 16, v25
  v_and_b32 v25, 0xffff0000, v25
  v_add_f32 v147, v147, v26
  v_add_f32 v147, v147, v25
  v_lshlrev_b32 v25, 16, v246
  v_and_b32 v26, 0xffff0000, v246
  v_mul_f32 v25, v25, v61
  v_mul_f32 v26, v26, v56
  v_cvt_pk_bf16_f32 v25, v25, v26
  v_lshlrev_b32 v26, 16, v25
  v_and_b32 v25, 0xffff0000, v25
  v_add_f32 v147, v147, v26
  v_add_f32 v147, v147, v25
  v_lshlrev_b32 v25, 16, v248
  v_and_b32 v26, 0xffff0000, v248
  v_mul_f32 v25, v25, v57
  v_mul_f32 v26, v26, v52
  v_cvt_pk_bf16_f32 v25, v25, v26
  v_lshlrev_b32 v26, 16, v25
  v_and_b32 v25, 0xffff0000, v25
  v_add_f32 v148, v25, v26
  v_lshlrev_b32 v25, 16, v249
  v_and_b32 v26, 0xffff0000, v249
  v_mul_f32 v25, v25, v58
  v_mul_f32 v26, v26, v53
  v_cvt_pk_bf16_f32 v25, v25, v26
  v_lshlrev_b32 v26, 16, v25
  v_and_b32 v25, 0xffff0000, v25
  v_add_f32 v148, v148, v26
  v_add_f32 v148, v148, v25
  v_lshlrev_b32 v25, 16, v250
  v_and_b32 v26, 0xffff0000, v250
  v_mul_f32 v25, v25, v59
  v_mul_f32 v26, v26, v54
  v_cvt_pk_bf16_f32 v25, v25, v26
  v_lshlrev_b32 v26, 16, v25
  v_and_b32 v25, 0xffff0000, v25
  v_add_f32 v148, v148, v26
  v_add_f32 v148, v148, v25
  v_lshlrev_b32 v25, 16, v251
  v_and_b32 v26, 0xffff0000, v251
  v_mul_f32 v25, v25, v60
  v_mul_f32 v26, v26, v55
  v_cvt_pk_bf16_f32 v25, v25, v26
  v_lshlrev_b32 v26, 16, v25
  v_and_b32 v25, 0xffff0000, v25
  v_add_f32 v148, v148, v26
  v_add_f32 v148, v148, v25
  v_lshlrev_b32 v25, 16, v252
  v_and_b32 v26, 0xffff0000, v252
  v_mul_f32 v25, v25, v61
  v_mul_f32 v26, v26, v56
  v_cvt_pk_bf16_f32 v25, v25, v26
  v_lshlrev_b32 v26, 16, v25
  v_and_b32 v25, 0xffff0000, v25
  v_add_f32 v148, v148, v26
  v_add_f32 v148, v148, v25
  v_lshlrev_b32 v25, 16, v30
  v_and_b32 v26, 0xffff0000, v30
  v_mul_f32 v25, v25, v57
  v_mul_f32 v26, v26, v52
  v_cvt_pk_bf16_f32 v25, v25, v26
  v_lshlrev_b32 v26, 16, v25
  v_and_b32 v25, 0xffff0000, v25
  v_add_f32 v149, v25, v26
  v_lshlrev_b32 v25, 16, v31
  v_and_b32 v26, 0xffff0000, v31
  v_mul_f32 v25, v25, v58
  v_mul_f32 v26, v26, v53
  v_cvt_pk_bf16_f32 v25, v25, v26
  v_lshlrev_b32 v26, 16, v25
  v_and_b32 v25, 0xffff0000, v25
  v_add_f32 v149, v149, v26
  v_add_f32 v149, v149, v25
  v_lshlrev_b32 v25, 16, v32
  v_and_b32 v26, 0xffff0000, v32
  v_mul_f32 v25, v25, v59
  v_mul_f32 v26, v26, v54
  v_cvt_pk_bf16_f32 v25, v25, v26
  v_lshlrev_b32 v26, 16, v25
  v_and_b32 v25, 0xffff0000, v25
  v_add_f32 v149, v149, v26
  v_add_f32 v149, v149, v25
  v_lshlrev_b32 v25, 16, v33
  v_and_b32 v26, 0xffff0000, v33
  v_mul_f32 v25, v25, v60
  v_mul_f32 v26, v26, v55
  v_cvt_pk_bf16_f32 v25, v25, v26
  v_lshlrev_b32 v26, 16, v25
  v_and_b32 v25, 0xffff0000, v25
  v_add_f32 v149, v149, v26
  v_add_f32 v149, v149, v25
  v_lshlrev_b32 v25, 16, v34
  v_and_b32 v26, 0xffff0000, v34
  v_mul_f32 v25, v25, v61
  v_mul_f32 v26, v26, v56
  v_cvt_pk_bf16_f32 v25, v25, v26
  v_lshlrev_b32 v26, 16, v25
  v_and_b32 v25, 0xffff0000, v25
  v_add_f32 v149, v149, v26
  v_add_f32 v149, v149, v25
  v_lshlrev_b32 v25, 16, v36
  v_and_b32 v26, 0xffff0000, v36
  v_mul_f32 v25, v25, v57
  v_mul_f32 v26, v26, v52
  v_cvt_pk_bf16_f32 v25, v25, v26
  v_lshlrev_b32 v26, 16, v25
  v_and_b32 v25, 0xffff0000, v25
  v_add_f32 v150, v25, v26
  v_lshlrev_b32 v25, 16, v37
  v_and_b32 v26, 0xffff0000, v37
  v_mul_f32 v25, v25, v58
  v_mul_f32 v26, v26, v53
  v_cvt_pk_bf16_f32 v25, v25, v26
  v_lshlrev_b32 v26, 16, v25
  v_and_b32 v25, 0xffff0000, v25
  v_add_f32 v150, v150, v26
  v_add_f32 v150, v150, v25
  v_lshlrev_b32 v25, 16, v38
  v_and_b32 v26, 0xffff0000, v38
  v_mul_f32 v25, v25, v59
  v_mul_f32 v26, v26, v54
  v_cvt_pk_bf16_f32 v25, v25, v26
  v_lshlrev_b32 v26, 16, v25
  v_and_b32 v25, 0xffff0000, v25
  v_add_f32 v150, v150, v26
  v_add_f32 v150, v150, v25
  v_lshlrev_b32 v25, 16, v39
  v_and_b32 v26, 0xffff0000, v39
  v_mul_f32 v25, v25, v60
  v_mul_f32 v26, v26, v55
  v_cvt_pk_bf16_f32 v25, v25, v26
  v_lshlrev_b32 v26, 16, v25
  v_and_b32 v25, 0xffff0000, v25
  v_add_f32 v150, v150, v26
  v_add_f32 v150, v150, v25
  v_lshlrev_b32 v25, 16, v40
  v_and_b32 v26, 0xffff0000, v40
  v_mul_f32 v25, v25, v61
  v_mul_f32 v26, v26, v56
  v_cvt_pk_bf16_f32 v25, v25, v26
  v_lshlrev_b32 v26, 16, v25
  v_and_b32 v25, 0xffff0000, v25
  v_add_f32 v150, v150, v26
  v_add_f32 v150, v150, v25
  v_lshlrev_b32 v25, 16, v42
  v_and_b32 v26, 0xffff0000, v42
  v_mul_f32 v25, v25, v57
  v_mul_f32 v26, v26, v52
  v_cvt_pk_bf16_f32 v25, v25, v26
  v_lshlrev_b32 v26, 16, v25
  v_and_b32 v25, 0xffff0000, v25
  v_add_f32 v151, v25, v26
  v_lshlrev_b32 v25, 16, v43
  v_and_b32 v26, 0xffff0000, v43
  v_mul_f32 v25, v25, v58
  v_mul_f32 v26, v26, v53
  v_cvt_pk_bf16_f32 v25, v25, v26
  v_lshlrev_b32 v26, 16, v25
  v_and_b32 v25, 0xffff0000, v25
  v_add_f32 v151, v151, v26
  v_add_f32 v151, v151, v25
  v_lshlrev_b32 v25, 16, v44
  v_and_b32 v26, 0xffff0000, v44
  v_mul_f32 v25, v25, v59
  v_mul_f32 v26, v26, v54
  v_cvt_pk_bf16_f32 v25, v25, v26
  v_lshlrev_b32 v26, 16, v25
  v_and_b32 v25, 0xffff0000, v25
  v_add_f32 v151, v151, v26
  v_add_f32 v151, v151, v25
  v_lshlrev_b32 v25, 16, v45
  v_and_b32 v26, 0xffff0000, v45
  v_mul_f32 v25, v25, v60
  v_mul_f32 v26, v26, v55
  v_cvt_pk_bf16_f32 v25, v25, v26
  v_lshlrev_b32 v26, 16, v25
  v_and_b32 v25, 0xffff0000, v25
  v_add_f32 v151, v151, v26
  v_add_f32 v151, v151, v25
  v_lshlrev_b32 v25, 16, v46
  v_and_b32 v26, 0xffff0000, v46
  v_mul_f32 v25, v25, v61
  v_mul_f32 v26, v26, v56
  v_cvt_pk_bf16_f32 v25, v25, v26
  v_lshlrev_b32 v26, 16, v25
  v_and_b32 v25, 0xffff0000, v25
  v_add_f32 v151, v151, v26
  v_add_f32 v151, v151, v25
  v_add_f32_dpp v144, v144, v144 row_ror:8 row_mask:0xf bank_mask:0xf
  v_add_f32_dpp v145, v145, v145 row_ror:8 row_mask:0xf bank_mask:0xf
  v_add_f32_dpp v146, v146, v146 row_ror:8 row_mask:0xf bank_mask:0xf
  v_add_f32_dpp v147, v147, v147 row_ror:8 row_mask:0xf bank_mask:0xf
  v_add_f32_dpp v148, v148, v148 row_ror:8 row_mask:0xf bank_mask:0xf
  v_add_f32_dpp v149, v149, v149 row_ror:8 row_mask:0xf bank_mask:0xf
  v_add_f32_dpp v150, v150, v150 row_ror:8 row_mask:0xf bank_mask:0xf
  v_add_f32_dpp v151, v151, v151 row_ror:8 row_mask:0xf bank_mask:0xf
  v_add_f32_dpp v144, v144, v144 row_ror:4 row_mask:0xf bank_mask:0xf
  v_add_f32_dpp v145, v145, v145 row_ror:4 row_mask:0xf bank_mask:0xf
  v_add_f32_dpp v146, v146, v146 row_ror:4 row_mask:0xf bank_mask:0xf
  v_add_f32_dpp v147, v147, v147 row_ror:4 row_mask:0xf bank_mask:0xf
  v_add_f32_dpp v148, v148, v148 row_ror:4 row_mask:0xf bank_mask:0xf
  v_add_f32_dpp v149, v149, v149 row_ror:4 row_mask:0xf bank_mask:0xf
  v_add_f32_dpp v150, v150, v150 row_ror:4 row_mask:0xf bank_mask:0xf
  v_add_f32_dpp v151, v151, v151 row_ror:4 row_mask:0xf bank_mask:0xf
  v_add_f32_dpp v144, v144, v144 row_ror:2 row_mask:0xf bank_mask:0xf
  v_add_f32_dpp v145, v145, v145 row_ror:2 row_mask:0xf bank_mask:0xf
  v_add_f32_dpp v146, v146, v146 row_ror:2 row_mask:0xf bank_mask:0xf
  v_add_f32_dpp v147, v147, v147 row_ror:2 row_mask:0xf bank_mask:0xf
  v_add_f32_dpp v148, v148, v148 row_ror:2 row_mask:0xf bank_mask:0xf
  v_add_f32_dpp v149, v149, v149 row_ror:2 row_mask:0xf bank_mask:0xf
  v_add_f32_dpp v150, v150, v150 row_ror:2 row_mask:0xf bank_mask:0xf
  v_add_f32_dpp v151, v151, v151 row_ror:2 row_mask:0xf bank_mask:0xf
  v_add_f32_dpp v144, v144, v144 row_ror:1 row_mask:0xf bank_mask:0xf
  v_add_f32_dpp v145, v145, v145 row_ror:1 row_mask:0xf bank_mask:0xf
  v_add_f32_dpp v146, v146, v146 row_ror:1 row_mask:0xf bank_mask:0xf
  v_add_f32_dpp v147, v147, v147 row_ror:1 row_mask:0xf bank_mask:0xf
  v_add_f32_dpp v148, v148, v148 row_ror:1 row_mask:0xf bank_mask:0xf
  v_add_f32_dpp v149, v149, v149 row_ror:1 row_mask:0xf bank_mask:0xf
  v_add_f32_dpp v150, v150, v150 row_ror:1 row_mask:0xf bank_mask:0xf
  v_add_f32_dpp v151, v151, v151 row_ror:1 row_mask:0xf bank_mask:0xf
  v_mov_b32 v152, v144
  v_mov_b32 v153, v145
  v_mov_b32 v154, v146
  v_mov_b32 v155, v147
  v_mov_b32 v156, v148
  v_mov_b32 v157, v149
  v_mov_b32 v158, v150
  v_mov_b32 v159, v151
  v_permlane32_swap_b32 v144, v152
  v_permlane32_swap_b32 v145, v153
  v_permlane32_swap_b32 v146, v154
  v_permlane32_swap_b32 v147, v155
  v_permlane32_swap_b32 v148, v156
  v_permlane32_swap_b32 v149, v157
  v_permlane32_swap_b32 v150, v158
  v_permlane32_swap_b32 v151, v159
  v_add_f32 v144, v144, v152
  v_add_f32 v145, v145, v153
  v_add_f32 v146, v146, v154
  v_add_f32 v147, v147, v155
  v_add_f32 v148, v148, v156
  v_add_f32 v149, v149, v157
  v_add_f32 v150, v150, v158
  v_add_f32 v151, v151, v159
  v_mov_b32 v152, v144
  v_mov_b32 v153, v145
  v_mov_b32 v154, v146
  v_mov_b32 v155, v147
  v_mov_b32 v156, v148
  v_mov_b32 v157, v149
  v_mov_b32 v158, v150
  v_mov_b32 v159, v151
  v_permlane16_swap_b32 v144, v152
  v_permlane16_swap_b32 v145, v153
  v_permlane16_swap_b32 v146, v154
  v_permlane16_swap_b32 v147, v155
  v_permlane16_swap_b32 v148, v156
  v_permlane16_swap_b32 v149, v157
  v_permlane16_swap_b32 v150, v158
  v_permlane16_swap_b32 v151, v159
  v_add_f32 v144, v144, v152
  v_add_f32 v145, v145, v153
  v_add_f32 v146, v146, v154
  v_add_f32 v147, v147, v155
  v_add_f32 v148, v148, v156
  v_add_f32 v149, v149, v157
  v_add_f32 v150, v150, v158
  v_add_f32 v151, v151, v159
  v_mov_b32 v24, v144
  v_cmp_eq_u32 vcc, 1, v1
  s_nop 1
  v_cndmask_b32 v24, v24, v145, vcc
  v_cmp_eq_u32 vcc, 2, v1
  s_nop 1
  v_cndmask_b32 v24, v24, v146, vcc
  v_cmp_eq_u32 vcc, 3, v1
  s_nop 1
  v_cndmask_b32 v24, v24, v147, vcc
  v_cmp_eq_u32 vcc, 4, v1
  s_nop 1
  v_cndmask_b32 v24, v24, v148, vcc
  v_cmp_eq_u32 vcc, 5, v1
  s_nop 1
  v_cndmask_b32 v24, v24, v149, vcc
  v_cmp_eq_u32 vcc, 6, v1
  s_nop 1
  v_cndmask_b32 v24, v24, v150, vcc
  v_cmp_eq_u32 vcc, 7, v1
  s_nop 1
  v_cndmask_b32 v24, v24, v151, vcc
  v_cvt_pk_bf16_f32 v25, v24, v24
  v_lshlrev_b32 v24, 16, v25
  v_mul_f32 v24, 0xbfb8aa3b, v24
  v_exp_f32 v24, v24
  s_nop 0
  v_add_f32 v24, 1.0, v24
  v_rcp_f32 v24, v24
  s_nop 0
  v_cvt_pk_bf16_f32 v25, v24, v24
  v_lshlrev_b32 v24, 16, v25
  s_lshl_b32 s21, s59, 2
  s_mov_b64 exec, 0xff
  buffer_store_dword v24, v5, s[28:31], s21 offen sc1
  s_mov_b64 exec, -1
  s_sub_u32 s59, s59, 1024
  s_waitcnt vmcnt(1)
  v_lshlrev_b32 v25, 16, v160
  v_and_b32 v26, 0xffff0000, v160
  v_mul_f32 v25, v25, v57
  v_mul_f32 v26, v26, v52
  v_cvt_pk_bf16_f32 v25, v25, v26
  v_lshlrev_b32 v26, 16, v25
  v_and_b32 v25, 0xffff0000, v25
  v_add_f32 v144, v25, v26
  v_lshlrev_b32 v25, 16, v161
  v_and_b32 v26, 0xffff0000, v161
  v_mul_f32 v25, v25, v58
  v_mul_f32 v26, v26, v53
  v_cvt_pk_bf16_f32 v25, v25, v26
  v_lshlrev_b32 v26, 16, v25
  v_and_b32 v25, 0xffff0000, v25
  v_add_f32 v144, v144, v26
  v_add_f32 v144, v144, v25
  v_lshlrev_b32 v25, 16, v162
  v_and_b32 v26, 0xffff0000, v162
  v_mul_f32 v25, v25, v59
  v_mul_f32 v26, v26, v54
  v_cvt_pk_bf16_f32 v25, v25, v26
  v_lshlrev_b32 v26, 16, v25
  v_and_b32 v25, 0xffff0000, v25
  v_add_f32 v144, v144, v26
  v_add_f32 v144, v144, v25
  v_lshlrev_b32 v25, 16, v163
  v_and_b32 v26, 0xffff0000, v163
  v_mul_f32 v25, v25, v60
  v_mul_f32 v26, v26, v55
  v_cvt_pk_bf16_f32 v25, v25, v26
  v_lshlrev_b32 v26, 16, v25
  v_and_b32 v25, 0xffff0000, v25
  v_add_f32 v144, v144, v26
  v_add_f32 v144, v144, v25
  v_lshlrev_b32 v25, 16, v164
  v_and_b32 v26, 0xffff0000, v164
  v_mul_f32 v25, v25, v61
  v_mul_f32 v26, v26, v56
  v_cvt_pk_bf16_f32 v25, v25, v26
  v_lshlrev_b32 v26, 16, v25
  v_and_b32 v25, 0xffff0000, v25
  v_add_f32 v144, v144, v26
  v_add_f32 v144, v144, v25
  v_lshlrev_b32 v25, 16, v166
  v_and_b32 v26, 0xffff0000, v166
  v_mul_f32 v25, v25, v57
  v_mul_f32 v26, v26, v52
  v_cvt_pk_bf16_f32 v25, v25, v26
  v_lshlrev_b32 v26, 16, v25
  v_and_b32 v25, 0xffff0000, v25
  v_add_f32 v145, v25, v26
  v_lshlrev_b32 v25, 16, v167
  v_and_b32 v26, 0xffff0000, v167
  v_mul_f32 v25, v25, v58
  v_mul_f32 v26, v26, v53
  v_cvt_pk_bf16_f32 v25, v25, v26
  v_lshlrev_b32 v26, 16, v25
  v_and_b32 v25, 0xffff0000, v25
  v_add_f32 v145, v145, v26
  v_add_f32 v145, v145, v25
  v_lshlrev_b32 v25, 16, v168
  v_and_b32 v26, 0xffff0000, v168
  v_mul_f32 v25, v25, v59
  v_mul_f32 v26, v26, v54
  v_cvt_pk_bf16_f32 v25, v25, v26
  v_lshlrev_b32 v26, 16, v25
  v_and_b32 v25, 0xffff0000, v25
  v_add_f32 v145, v145, v26
  v_add_f32 v145, v145, v25
  v_lshlrev_b32 v25, 16, v169
  v_and_b32 v26, 0xffff0000, v169
  v_mul_f32 v25, v25, v60
  v_mul_f32 v26, v26, v55
  v_cvt_pk_bf16_f32 v25, v25, v26
  v_lshlrev_b32 v26, 16, v25
  v_and_b32 v25, 0xffff0000, v25
  v_add_f32 v145, v145, v26
  v_add_f32 v145, v145, v25
  v_lshlrev_b32 v25, 16, v170
  v_and_b32 v26, 0xffff0000, v170
  v_mul_f32 v25, v25, v61
  v_mul_f32 v26, v26, v56
  v_cvt_pk_bf16_f32 v25, v25, v26
  v_lshlrev_b32 v26, 16, v25
  v_and_b32 v25, 0xffff0000, v25
  v_add_f32 v145, v145, v26
  v_add_f32 v145, v145, v25
  v_lshlrev_b32 v25, 16, v172
  v_and_b32 v26, 0xffff0000, v172
  v_mul_f32 v25, v25, v57
  v_mul_f32 v26, v26, v52
  v_cvt_pk_bf16_f32 v25, v25, v26
  v_lshlrev_b32 v26, 16, v25
  v_and_b32 v25, 0xffff0000, v25
  v_add_f32 v146, v25, v26
  v_lshlrev_b32 v25, 16, v173
  v_and_b32 v26, 0xffff0000, v173
  v_mul_f32 v25, v25, v58
  v_mul_f32 v26, v26, v53
  v_cvt_pk_bf16_f32 v25, v25, v26
  v_lshlrev_b32 v26, 16, v25
  v_and_b32 v25, 0xffff0000, v25
  v_add_f32 v146, v146, v26
  v_add_f32 v146, v146, v25
  v_lshlrev_b32 v25, 16, v174
  v_and_b32 v26, 0xffff0000, v174
  v_mul_f32 v25, v25, v59
  v_mul_f32 v26, v26, v54
  v_cvt_pk_bf16_f32 v25, v25, v26
  v_lshlrev_b32 v26, 16, v25
  v_and_b32 v25, 0xffff0000, v25
  v_add_f32 v146, v146, v26
  v_add_f32 v146, v146, v25
  v_lshlrev_b32 v25, 16, v175
  v_and_b32 v26, 0xffff0000, v175
  v_mul_f32 v25, v25, v60
  v_mul_f32 v26, v26, v55
  v_cvt_pk_bf16_f32 v25, v25, v26
  v_lshlrev_b32 v26, 16, v25
  v_and_b32 v25, 0xffff0000, v25
  v_add_f32 v146, v146, v26
  v_add_f32 v146, v146, v25
  v_lshlrev_b32 v25, 16, v176
  v_and_b32 v26, 0xffff0000, v176
  v_mul_f32 v25, v25, v61
  v_mul_f32 v26, v26, v56
  v_cvt_pk_bf16_f32 v25, v25, v26
  v_lshlrev_b32 v26, 16, v25
  v_and_b32 v25, 0xffff0000, v25
  v_add_f32 v146, v146, v26
  v_add_f32 v146, v146, v25
  v_lshlrev_b32 v25, 16, v178
  v_and_b32 v26, 0xffff0000, v178
  v_mul_f32 v25, v25, v57
  v_mul_f32 v26, v26, v52
  v_cvt_pk_bf16_f32 v25, v25, v26
  v_lshlrev_b32 v26, 16, v25
  v_and_b32 v25, 0xffff0000, v25
  v_add_f32 v147, v25, v26
  v_lshlrev_b32 v25, 16, v179
  v_and_b32 v26, 0xffff0000, v179
  v_mul_f32 v25, v25, v58
  v_mul_f32 v26, v26, v53
  v_cvt_pk_bf16_f32 v25, v25, v26
  v_lshlrev_b32 v26, 16, v25
  v_and_b32 v25, 0xffff0000, v25
  v_add_f32 v147, v147, v26
  v_add_f32 v147, v147, v25
  v_lshlrev_b32 v25, 16, v180
  v_and_b32 v26, 0xffff0000, v180
  v_mul_f32 v25, v25, v59
  v_mul_f32 v26, v26, v54
  v_cvt_pk_bf16_f32 v25, v25, v26
  v_lshlrev_b32 v26, 16, v25
  v_and_b32 v25, 0xffff0000, v25
  v_add_f32 v147, v147, v26
  v_add_f32 v147, v147, v25
  v_lshlrev_b32 v25, 16, v181
  v_and_b32 v26, 0xffff0000, v181
  v_mul_f32 v25, v25, v60
  v_mul_f32 v26, v26, v55
  v_cvt_pk_bf16_f32 v25, v25, v26
  v_lshlrev_b32 v26, 16, v25
  v_and_b32 v25, 0xffff0000, v25
  v_add_f32 v147, v147, v26
  v_add_f32 v147, v147, v25
  v_lshlrev_b32 v25, 16, v182
  v_and_b32 v26, 0xffff0000, v182
  v_mul_f32 v25, v25, v61
  v_mul_f32 v26, v26, v56
  v_cvt_pk_bf16_f32 v25, v25, v26
  v_lshlrev_b32 v26, 16, v25
  v_and_b32 v25, 0xffff0000, v25
  v_add_f32 v147, v147, v26
  v_add_f32 v147, v147, v25
  v_lshlrev_b32 v25, 16, v184
  v_and_b32 v26, 0xffff0000, v184
  v_mul_f32 v25, v25, v57
  v_mul_f32 v26, v26, v52
  v_cvt_pk_bf16_f32 v25, v25, v26
  v_lshlrev_b32 v26, 16, v25
  v_and_b32 v25, 0xffff0000, v25
  v_add_f32 v148, v25, v26
  v_lshlrev_b32 v25, 16, v185
  v_and_b32 v26, 0xffff0000, v185
  v_mul_f32 v25, v25, v58
  v_mul_f32 v26, v26, v53
  v_cvt_pk_bf16_f32 v25, v25, v26
  v_lshlrev_b32 v26, 16, v25
  v_and_b32 v25, 0xffff0000, v25
  v_add_f32 v148, v148, v26
  v_add_f32 v148, v148, v25
  v_lshlrev_b32 v25, 16, v186
  v_and_b32 v26, 0xffff0000, v186
  v_mul_f32 v25, v25, v59
  v_mul_f32 v26, v26, v54
  v_cvt_pk_bf16_f32 v25, v25, v26
  v_lshlrev_b32 v26, 16, v25
  v_and_b32 v25, 0xffff0000, v25
  v_add_f32 v148, v148, v26
  v_add_f32 v148, v148, v25
  v_lshlrev_b32 v25, 16, v187
  v_and_b32 v26, 0xffff0000, v187
  v_mul_f32 v25, v25, v60
  v_mul_f32 v26, v26, v55
  v_cvt_pk_bf16_f32 v25, v25, v26
  v_lshlrev_b32 v26, 16, v25
  v_and_b32 v25, 0xffff0000, v25
  v_add_f32 v148, v148, v26
  v_add_f32 v148, v148, v25
  v_lshlrev_b32 v25, 16, v188
  v_and_b32 v26, 0xffff0000, v188
  v_mul_f32 v25, v25, v61
  v_mul_f32 v26, v26, v56
  v_cvt_pk_bf16_f32 v25, v25, v26
  v_lshlrev_b32 v26, 16, v25
  v_and_b32 v25, 0xffff0000, v25
  v_add_f32 v148, v148, v26
  v_add_f32 v148, v148, v25
  v_lshlrev_b32 v25, 16, v190
  v_and_b32 v26, 0xffff0000, v190
  v_mul_f32 v25, v25, v57
  v_mul_f32 v26, v26, v52
  v_cvt_pk_bf16_f32 v25, v25, v26
  v_lshlrev_b32 v26, 16, v25
  v_and_b32 v25, 0xffff0000, v25
  v_add_f32 v149, v25, v26
  v_lshlrev_b32 v25, 16, v191
  v_and_b32 v26, 0xffff0000, v191
  v_mul_f32 v25, v25, v58
  v_mul_f32 v26, v26, v53
  v_cvt_pk_bf16_f32 v25, v25, v26
  v_lshlrev_b32 v26, 16, v25
  v_and_b32 v25, 0xffff0000, v25
  v_add_f32 v149, v149, v26
  v_add_f32 v149, v149, v25
  v_lshlrev_b32 v25, 16, v192
  v_and_b32 v26, 0xffff0000, v192
  v_mul_f32 v25, v25, v59
  v_mul_f32 v26, v26, v54
  v_cvt_pk_bf16_f32 v25, v25, v26
  v_lshlrev_b32 v26, 16, v25
  v_and_b32 v25, 0xffff0000, v25
  v_add_f32 v149, v149, v26
  v_add_f32 v149, v149, v25
  v_lshlrev_b32 v25, 16, v193
  v_and_b32 v26, 0xffff0000, v193
  v_mul_f32 v25, v25, v60
  v_mul_f32 v26, v26, v55
  v_cvt_pk_bf16_f32 v25, v25, v26
  v_lshlrev_b32 v26, 16, v25
  v_and_b32 v25, 0xffff0000, v25
  v_add_f32 v149, v149, v26
  v_add_f32 v149, v149, v25
  v_lshlrev_b32 v25, 16, v194
  v_and_b32 v26, 0xffff0000, v194
  v_mul_f32 v25, v25, v61
  v_mul_f32 v26, v26, v56
  v_cvt_pk_bf16_f32 v25, v25, v26
  v_lshlrev_b32 v26, 16, v25
  v_and_b32 v25, 0xffff0000, v25
  v_add_f32 v149, v149, v26
  v_add_f32 v149, v149, v25
  v_lshlrev_b32 v25, 16, v196
  v_and_b32 v26, 0xffff0000, v196
  v_mul_f32 v25, v25, v57
  v_mul_f32 v26, v26, v52
  v_cvt_pk_bf16_f32 v25, v25, v26
  v_lshlrev_b32 v26, 16, v25
  v_and_b32 v25, 0xffff0000, v25
  v_add_f32 v150, v25, v26
  v_lshlrev_b32 v25, 16, v197
  v_and_b32 v26, 0xffff0000, v197
  v_mul_f32 v25, v25, v58
  v_mul_f32 v26, v26, v53
  v_cvt_pk_bf16_f32 v25, v25, v26
  v_lshlrev_b32 v26, 16, v25
  v_and_b32 v25, 0xffff0000, v25
  v_add_f32 v150, v150, v26
  v_add_f32 v150, v150, v25
  v_lshlrev_b32 v25, 16, v198
  v_and_b32 v26, 0xffff0000, v198
  v_mul_f32 v25, v25, v59
  v_mul_f32 v26, v26, v54
  v_cvt_pk_bf16_f32 v25, v25, v26
  v_lshlrev_b32 v26, 16, v25
  v_and_b32 v25, 0xffff0000, v25
  v_add_f32 v150, v150, v26
  v_add_f32 v150, v150, v25
  v_lshlrev_b32 v25, 16, v199
  v_and_b32 v26, 0xffff0000, v199
  v_mul_f32 v25, v25, v60
  v_mul_f32 v26, v26, v55
  v_cvt_pk_bf16_f32 v25, v25, v26
  v_lshlrev_b32 v26, 16, v25
  v_and_b32 v25, 0xffff0000, v25
  v_add_f32 v150, v150, v26
  v_add_f32 v150, v150, v25
  v_lshlrev_b32 v25, 16, v200
  v_and_b32 v26, 0xffff0000, v200
  v_mul_f32 v25, v25, v61
  v_mul_f32 v26, v26, v56
  v_cvt_pk_bf16_f32 v25, v25, v26
  v_lshlrev_b32 v26, 16, v25
  v_and_b32 v25, 0xffff0000, v25
  v_add_f32 v150, v150, v26
  v_add_f32 v150, v150, v25
  v_lshlrev_b32 v25, 16, v202
  v_and_b32 v26, 0xffff0000, v202
  v_mul_f32 v25, v25, v57
  v_mul_f32 v26, v26, v52
  v_cvt_pk_bf16_f32 v25, v25, v26
  v_lshlrev_b32 v26, 16, v25
  v_and_b32 v25, 0xffff0000, v25
  v_add_f32 v151, v25, v26
  v_lshlrev_b32 v25, 16, v203
  v_and_b32 v26, 0xffff0000, v203
  v_mul_f32 v25, v25, v58
  v_mul_f32 v26, v26, v53
  v_cvt_pk_bf16_f32 v25, v25, v26
  v_lshlrev_b32 v26, 16, v25
  v_and_b32 v25, 0xffff0000, v25
  v_add_f32 v151, v151, v26
  v_add_f32 v151, v151, v25
  v_lshlrev_b32 v25, 16, v204
  v_and_b32 v26, 0xffff0000, v204
  v_mul_f32 v25, v25, v59
  v_mul_f32 v26, v26, v54
  v_cvt_pk_bf16_f32 v25, v25, v26
  v_lshlrev_b32 v26, 16, v25
  v_and_b32 v25, 0xffff0000, v25
  v_add_f32 v151, v151, v26
  v_add_f32 v151, v151, v25
  v_lshlrev_b32 v25, 16, v205
  v_and_b32 v26, 0xffff0000, v205
  v_mul_f32 v25, v25, v60
  v_mul_f32 v26, v26, v55
  v_cvt_pk_bf16_f32 v25, v25, v26
  v_lshlrev_b32 v26, 16, v25
  v_and_b32 v25, 0xffff0000, v25
  v_add_f32 v151, v151, v26
  v_add_f32 v151, v151, v25
  v_lshlrev_b32 v25, 16, v206
  v_and_b32 v26, 0xffff0000, v206
  v_mul_f32 v25, v25, v61
  v_mul_f32 v26, v26, v56
  v_cvt_pk_bf16_f32 v25, v25, v26
  v_lshlrev_b32 v26, 16, v25
  v_and_b32 v25, 0xffff0000, v25
  v_add_f32 v151, v151, v26
  v_add_f32 v151, v151, v25
  v_add_f32_dpp v144, v144, v144 row_ror:8 row_mask:0xf bank_mask:0xf
  v_add_f32_dpp v145, v145, v145 row_ror:8 row_mask:0xf bank_mask:0xf
  v_add_f32_dpp v146, v146, v146 row_ror:8 row_mask:0xf bank_mask:0xf
  v_add_f32_dpp v147, v147, v147 row_ror:8 row_mask:0xf bank_mask:0xf
  v_add_f32_dpp v148, v148, v148 row_ror:8 row_mask:0xf bank_mask:0xf
  v_add_f32_dpp v149, v149, v149 row_ror:8 row_mask:0xf bank_mask:0xf
  v_add_f32_dpp v150, v150, v150 row_ror:8 row_mask:0xf bank_mask:0xf
  v_add_f32_dpp v151, v151, v151 row_ror:8 row_mask:0xf bank_mask:0xf
  v_add_f32_dpp v144, v144, v144 row_ror:4 row_mask:0xf bank_mask:0xf
  v_add_f32_dpp v145, v145, v145 row_ror:4 row_mask:0xf bank_mask:0xf
  v_add_f32_dpp v146, v146, v146 row_ror:4 row_mask:0xf bank_mask:0xf
  v_add_f32_dpp v147, v147, v147 row_ror:4 row_mask:0xf bank_mask:0xf
  v_add_f32_dpp v148, v148, v148 row_ror:4 row_mask:0xf bank_mask:0xf
  v_add_f32_dpp v149, v149, v149 row_ror:4 row_mask:0xf bank_mask:0xf
  v_add_f32_dpp v150, v150, v150 row_ror:4 row_mask:0xf bank_mask:0xf
  v_add_f32_dpp v151, v151, v151 row_ror:4 row_mask:0xf bank_mask:0xf
  v_add_f32_dpp v144, v144, v144 row_ror:2 row_mask:0xf bank_mask:0xf
  v_add_f32_dpp v145, v145, v145 row_ror:2 row_mask:0xf bank_mask:0xf
  v_add_f32_dpp v146, v146, v146 row_ror:2 row_mask:0xf bank_mask:0xf
  v_add_f32_dpp v147, v147, v147 row_ror:2 row_mask:0xf bank_mask:0xf
  v_add_f32_dpp v148, v148, v148 row_ror:2 row_mask:0xf bank_mask:0xf
  v_add_f32_dpp v149, v149, v149 row_ror:2 row_mask:0xf bank_mask:0xf
  v_add_f32_dpp v150, v150, v150 row_ror:2 row_mask:0xf bank_mask:0xf
  v_add_f32_dpp v151, v151, v151 row_ror:2 row_mask:0xf bank_mask:0xf
  v_add_f32_dpp v144, v144, v144 row_ror:1 row_mask:0xf bank_mask:0xf
  v_add_f32_dpp v145, v145, v145 row_ror:1 row_mask:0xf bank_mask:0xf
  v_add_f32_dpp v146, v146, v146 row_ror:1 row_mask:0xf bank_mask:0xf
  v_add_f32_dpp v147, v147, v147 row_ror:1 row_mask:0xf bank_mask:0xf
  v_add_f32_dpp v148, v148, v148 row_ror:1 row_mask:0xf bank_mask:0xf
  v_add_f32_dpp v149, v149, v149 row_ror:1 row_mask:0xf bank_mask:0xf
  v_add_f32_dpp v150, v150, v150 row_ror:1 row_mask:0xf bank_mask:0xf
  v_add_f32_dpp v151, v151, v151 row_ror:1 row_mask:0xf bank_mask:0xf
  v_mov_b32 v152, v144
  v_mov_b32 v153, v145
  v_mov_b32 v154, v146
  v_mov_b32 v155, v147
  v_mov_b32 v156, v148
  v_mov_b32 v157, v149
  v_mov_b32 v158, v150
  v_mov_b32 v159, v151
  v_permlane32_swap_b32 v144, v152
  v_permlane32_swap_b32 v145, v153
  v_permlane32_swap_b32 v146, v154
  v_permlane32_swap_b32 v147, v155
  v_permlane32_swap_b32 v148, v156
  v_permlane32_swap_b32 v149, v157
  v_permlane32_swap_b32 v150, v158
  v_permlane32_swap_b32 v151, v159
  v_add_f32 v144, v144, v152
  v_add_f32 v145, v145, v153
  v_add_f32 v146, v146, v154
  v_add_f32 v147, v147, v155
  v_add_f32 v148, v148, v156
  v_add_f32 v149, v149, v157
  v_add_f32 v150, v150, v158
  v_add_f32 v151, v151, v159
  v_mov_b32 v152, v144
  v_mov_b32 v153, v145
  v_mov_b32 v154, v146
  v_mov_b32 v155, v147
  v_mov_b32 v156, v148
  v_mov_b32 v157, v149
  v_mov_b32 v158, v150
  v_mov_b32 v159, v151
  v_permlane16_swap_b32 v144, v152
  v_permlane16_swap_b32 v145, v153
  v_permlane16_swap_b32 v146, v154
  v_permlane16_swap_b32 v147, v155
  v_permlane16_swap_b32 v148, v156
  v_permlane16_swap_b32 v149, v157
  v_permlane16_swap_b32 v150, v158
  v_permlane16_swap_b32 v151, v159
  v_add_f32 v144, v144, v152
  v_add_f32 v145, v145, v153
  v_add_f32 v146, v146, v154
  v_add_f32 v147, v147, v155
  v_add_f32 v148, v148, v156
  v_add_f32 v149, v149, v157
  v_add_f32 v150, v150, v158
  v_add_f32 v151, v151, v159
  v_mov_b32 v24, v144
  v_cmp_eq_u32 vcc, 1, v1
  s_nop 1
  v_cndmask_b32 v24, v24, v145, vcc
  v_cmp_eq_u32 vcc, 2, v1
  s_nop 1
  v_cndmask_b32 v24, v24, v146, vcc
  v_cmp_eq_u32 vcc, 3, v1
  s_nop 1
  v_cndmask_b32 v24, v24, v147, vcc
  v_cmp_eq_u32 vcc, 4, v1
  s_nop 1
  v_cndmask_b32 v24, v24, v148, vcc
  v_cmp_eq_u32 vcc, 5, v1
  s_nop 1
  v_cndmask_b32 v24, v24, v149, vcc
  v_cmp_eq_u32 vcc, 6, v1
  s_nop 1
  v_cndmask_b32 v24, v24, v150, vcc
  v_cmp_eq_u32 vcc, 7, v1
  s_nop 1
  v_cndmask_b32 v24, v24, v151, vcc
  v_cvt_pk_bf16_f32 v25, v24, v24
  v_lshlrev_b32 v24, 16, v25
  v_mul_f32 v24, 0xbfb8aa3b, v24
  v_exp_f32 v24, v24
  s_nop 0
  v_add_f32 v24, 1.0, v24
  v_rcp_f32 v24, v24
  s_nop 0
  v_cvt_pk_bf16_f32 v25, v24, v24
  v_lshlrev_b32 v24, 16, v25
  s_lshl_b32 s21, s59, 2
  s_mov_b64 exec, 0xff
  buffer_store_dword v24, v5, s[28:31], s21 offen sc1
  s_mov_b64 exec, -1
  s_waitcnt vmcnt(0)
  s_barrier
  s_lshr_b32 s21, s2, 2
  s_lshl_b32 s21, s21, 7
  s_add_u32 s21, s21, 93184
  s_cmp_lg_u32 s20, 0
  s_cbranch_scc1 af_264
  v_mov_b32 v10, 0
  v_mov_b32 v11, 1
  s_mov_b64 exec, 1
  buffer_atomic_add v11, v10, s[72:75], s21 offen sc1
  s_mov_b64 exec, -1
  s_nop 1
af_264:
  s_branch om_263
om_262:
  s_load_dwordx2 s[8:9], s[0:1], 88
  s_mov_b32 s51, s21
  s_lshr_b32 s52, s2, 2
  s_lshl_b32 s52, s52, 7
  s_add_u32 s21, s52, 94208
  s_cmp_lg_u32 s20, 0
  s_cbranch_scc1 wf_266
  v_mov_b32 v20, 0
  s_mov_b32 s101, 0
wf_265:
  buffer_load_dword v21, v20, s[72:75], s21 offen sc1
  s_add_u32 s101, s101, 1
  s_cmp_gt_u32 s101, 131072
  s_cbranch_scc1 main_end
  s_waitcnt vmcnt(0)
  v_readfirstlane_b32 s100, v21
  s_cmp_ge_u32 s100, 4
  s_cbranch_scc1 wf_266
  s_sleep 32
  s_branch wf_265
wf_266:
  s_barrier
  s_add_u32 s21, s52, 104448
  s_cmp_lg_u32 s20, 0
  s_cbranch_scc1 wf_268
  v_mov_b32 v20, 0
  s_mov_b32 s101, 0
wf_267:
  buffer_load_dword v21, v20, s[72:75], s21 offen sc1
  s_add_u32 s101, s101, 1
  s_cmp_gt_u32 s101, 131072
  s_cbranch_scc1 main_end
  s_waitcnt vmcnt(0)
  v_readfirstlane_b32 s100, v21
  s_cmp_ge_u32 s100, 80
  s_cbranch_scc1 wf_268
  s_sleep 32
  s_branch wf_267
wf_268:
  s_barrier
  v_lshlrev_b32 v6, 2, v2
  s_lshl_b32 s22, s47, 6
  buffer_load_dword v30, v6, s[28:31], s22 offen sc1
  buffer_load_dword v31, v6, s[28:31], s22 offen offset:64 sc1
  s_add_u32 s22, s51, 0
  buffer_load_dwordx4 v[144:147], v4, s[16:19], s22 offen offset:0 sc1
  buffer_load_dwordx4 v[148:151], v4, s[16:19], s22 offen offset:1024 sc1
  buffer_load_dwordx4 v[152:155], v4, s[16:19], s22 offen offset:2048 sc1
  buffer_load_dwordx4 v[156:159], v4, s[16:19], s22 offen offset:3072 sc1
  s_add_u32 s22, s51, 4096
  buffer_load_dwordx4 v[160:163], v4, s[16:19], s22 offen offset:0 sc1
  buffer_load_dwordx4 v[164:167], v4, s[16:19], s22 offen offset:1024 sc1
  buffer_load_dwordx4 v[168:171], v4, s[16:19], s22 offen offset:2048 sc1
  buffer_load_dwordx4 v[172:175], v4, s[16:19], s22 offen offset:3072 sc1
  s_add_u32 s22, s51, 8192
  buffer_load_dwordx4 v[176:179], v4, s[16:19], s22 offen offset:0 sc1
  buffer_load_dwordx4 v[180:183], v4, s[16:19], s22 offen offset:1024 sc1
  s_add_u32 s22, s51, 40960
  buffer_load_dwordx4 v[184:187], v4, s[16:19], s22 offen offset:0 sc1
  buffer_load_dwordx4 v[188:191], v4, s[16:19], s22 offen offset:1024 sc1
  buffer_load_dwordx4 v[192:195], v4, s[16:19], s22 offen offset:2048 sc1
  buffer_load_dwordx4 v[196:199], v4, s[16:19], s22 offen offset:3072 sc1
  s_add_u32 s22, s51, 45056
  buffer_load_dwordx4 v[200:203], v4, s[16:19], s22 offen offset:0 sc1
  buffer_load_dwordx4 v[204:207], v4, s[16:19], s22 offen offset:1024 sc1
  buffer_load_dwordx4 v[208:211], v4, s[16:19], s22 offen offset:2048 sc1
  buffer_load_dwordx4 v[212:215], v4, s[16:19], s22 offen offset:3072 sc1
  s_add_u32 s22, s51, 49152
  buffer_load_dwordx4 v[216:219], v4, s[16:19], s22 offen offset:0 sc1
  buffer_load_dwordx4 v[220:223], v4, s[16:19], s22 offen offset:1024 sc1
  v_mul_u32_u24 v9, 1280, v2
  v_lshl_add_u32 v9, v3, 3, v9
  s_mul_i32 s22, s47, 20480
  s_add_u32 s22, s22, s45
  s_add_u32 s23, s22, 20480
  s_waitcnt vmcnt(20) lgkmcnt(0)
  v_sub_f32 v32, 1.0, v30
  v_sub_f32 v33, 1.0, v31
  v_cvt_pk_bf16_f32 v26, v32, v33
  v_lshlrev_b32 v32, 16, v26
  v_and_b32 v33, 0xffff0000, v26
  v_cvt_pk_bf16_f32 v26, v64, v65
  v_lshlrev_b32 v64, 16, v26
  v_and_b32 v65, 0xffff0000, v26
  v_mul_f32 v64, v64, v32
  v_mul_f32 v65, v65, v32
  v_cvt_pk_bf16_f32 v26, v64, v65
  v_lshlrev_b32 v64, 16, v26
  v_and_b32 v65, 0xffff0000, v26
  v_cvt_pk_bf16_f32 v26, v66, v67
  v_lshlrev_b32 v66, 16, v26
  v_and_b32 v67, 0xffff0000, v26
  v_mul_f32 v66, v66, v32
  v_mul_f32 v67, v67, v32
  v_cvt_pk_bf16_f32 v26, v66, v67
  v_lshlrev_b32 v66, 16, v26
  v_and_b32 v67, 0xffff0000, v26
  v_cvt_pk_bf16_f32 v26, v68, v69
  v_lshlrev_b32 v68, 16, v26
  v_and_b32 v69, 0xffff0000, v26
  v_mul_f32 v68, v68, v32
  v_mul_f32 v69, v69, v32
  v_cvt_pk_bf16_f32 v26, v68, v69
  v_lshlrev_b32 v68, 16, v26
  v_and_b32 v69, 0xffff0000, v26
  v_cvt_pk_bf16_f32 v26, v70, v71
  v_lshlrev_b32 v70, 16, v26
  v_and_b32 v71, 0xffff0000, v26
  v_mul_f32 v70, v70, v32
  v_mul_f32 v71, v71, v32
  v_cvt_pk_bf16_f32 v26, v70, v71
  v_lshlrev_b32 v70, 16, v26
  v_and_b32 v71, 0xffff0000, v26
  v_cvt_pk_bf16_f32 v26, v72, v73
  v_lshlrev_b32 v72, 16, v26
  v_and_b32 v73, 0xffff0000, v26
  v_mul_f32 v72, v72, v32
  v_mul_f32 v73, v73, v32
  v_cvt_pk_bf16_f32 v26, v72, v73
  v_lshlrev_b32 v72, 16, v26
  v_and_b32 v73, 0xffff0000, v26
  v_cvt_pk_bf16_f32 v26, v74, v75
  v_lshlrev_b32 v74, 16, v26
  v_and_b32 v75, 0xffff0000, v26
  v_mul_f32 v74, v74, v32
  v_mul_f32 v75, v75, v32
  v_cvt_pk_bf16_f32 v26, v74, v75
  v_lshlrev_b32 v74, 16, v26
  v_and_b32 v75, 0xffff0000, v26
  v_cvt_pk_bf16_f32 v26, v76, v77
  v_lshlrev_b32 v76, 16, v26
  v_and_b32 v77, 0xffff0000, v26
  v_mul_f32 v76, v76, v32
  v_mul_f32 v77, v77, v32
  v_cvt_pk_bf16_f32 v26, v76, v77
  v_lshlrev_b32 v76, 16, v26
  v_and_b32 v77, 0xffff0000, v26
  v_cvt_pk_bf16_f32 v26, v78, v79
  v_lshlrev_b32 v78, 16, v26
  v_and_b32 v79, 0xffff0000, v26
  v_mul_f32 v78, v78, v32
  v_mul_f32 v79, v79, v32
  v_cvt_pk_bf16_f32 v26, v78, v79
  v_lshlrev_b32 v78, 16, v26
  v_and_b32 v79, 0xffff0000, v26
  v_cvt_pk_bf16_f32 v26, v80, v81
  v_lshlrev_b32 v80, 16, v26
  v_and_b32 v81, 0xffff0000, v26
  v_mul_f32 v80, v80, v32
  v_mul_f32 v81, v81, v32
  v_cvt_pk_bf16_f32 v26, v80, v81
  v_lshlrev_b32 v80, 16, v26
  v_and_b32 v81, 0xffff0000, v26
  v_cvt_pk_bf16_f32 v26, v82, v83
  v_lshlrev_b32 v82, 16, v26
  v_and_b32 v83, 0xffff0000, v26
  v_mul_f32 v82, v82, v32
  v_mul_f32 v83, v83, v32
  v_cvt_pk_bf16_f32 v26, v82, v83
  v_lshlrev_b32 v82, 16, v26
  v_and_b32 v83, 0xffff0000, v26
  v_cvt_pk_bf16_f32 v26, v84, v85
  v_lshlrev_b32 v84, 16, v26
  v_and_b32 v85, 0xffff0000, v26
  v_mul_f32 v84, v84, v32
  v_mul_f32 v85, v85, v32
  v_cvt_pk_bf16_f32 v26, v84, v85
  v_lshlrev_b32 v84, 16, v26
  v_and_b32 v85, 0xffff0000, v26
  v_cvt_pk_bf16_f32 v26, v86, v87
  v_lshlrev_b32 v86, 16, v26
  v_and_b32 v87, 0xffff0000, v26
  v_mul_f32 v86, v86, v32
  v_mul_f32 v87, v87, v32
  v_cvt_pk_bf16_f32 v26, v86, v87
  v_lshlrev_b32 v86, 16, v26
  v_and_b32 v87, 0xffff0000, v26
  v_cvt_pk_bf16_f32 v26, v88, v89
  v_lshlrev_b32 v88, 16, v26
  v_and_b32 v89, 0xffff0000, v26
  v_mul_f32 v88, v88, v32
  v_mul_f32 v89, v89, v32
  v_cvt_pk_bf16_f32 v26, v88, v89
  v_lshlrev_b32 v88, 16, v26
  v_and_b32 v89, 0xffff0000, v26
  v_cvt_pk_bf16_f32 v26, v90, v91
  v_lshlrev_b32 v90, 16, v26
  v_and_b32 v91, 0xffff0000, v26
  v_mul_f32 v90, v90, v32
  v_mul_f32 v91, v91, v32
  v_cvt_pk_bf16_f32 v26, v90, v91
  v_lshlrev_b32 v90, 16, v26
  v_and_b32 v91, 0xffff0000, v26
  v_cvt_pk_bf16_f32 v26, v92, v93
  v_lshlrev_b32 v92, 16, v26
  v_and_b32 v93, 0xffff0000, v26
  v_mul_f32 v92, v92, v32
  v_mul_f32 v93, v93, v32
  v_cvt_pk_bf16_f32 v26, v92, v93
  v_lshlrev_b32 v92, 16, v26
  v_and_b32 v93, 0xffff0000, v26
  v_cvt_pk_bf16_f32 v26, v94, v95
  v_lshlrev_b32 v94, 16, v26
  v_and_b32 v95, 0xffff0000, v26
  v_mul_f32 v94, v94, v32
  v_mul_f32 v95, v95, v32
  v_cvt_pk_bf16_f32 v26, v94, v95
  v_lshlrev_b32 v94, 16, v26
  v_and_b32 v95, 0xffff0000, v26
  v_cvt_pk_bf16_f32 v26, v96, v97
  v_lshlrev_b32 v96, 16, v26
  v_and_b32 v97, 0xffff0000, v26
  v_mul_f32 v96, v96, v32
  v_mul_f32 v97, v97, v32
  v_cvt_pk_bf16_f32 v26, v96, v97
  v_lshlrev_b32 v96, 16, v26
  v_and_b32 v97, 0xffff0000, v26
  v_cvt_pk_bf16_f32 v26, v98, v99
  v_lshlrev_b32 v98, 16, v26
  v_and_b32 v99, 0xffff0000, v26
  v_mul_f32 v98, v98, v32
  v_mul_f32 v99, v99, v32
  v_cvt_pk_bf16_f32 v26, v98, v99
  v_lshlrev_b32 v98, 16, v26
  v_and_b32 v99, 0xffff0000, v26
  v_cvt_pk_bf16_f32 v26, v100, v101
  v_lshlrev_b32 v100, 16, v26
  v_and_b32 v101, 0xffff0000, v26
  v_mul_f32 v100, v100, v32
  v_mul_f32 v101, v101, v32
  v_cvt_pk_bf16_f32 v26, v100, v101
  v_lshlrev_b32 v100, 16, v26
  v_and_b32 v101, 0xffff0000, v26
  v_cvt_pk_bf16_f32 v26, v102, v103
  v_lshlrev_b32 v102, 16, v26
  v_and_b32 v103, 0xffff0000, v26
  v_mul_f32 v102, v102, v32
  v_mul_f32 v103, v103, v32
  v_cvt_pk_bf16_f32 v26, v102, v103
  v_lshlrev_b32 v102, 16, v26
  v_and_b32 v103, 0xffff0000, v26
  v_cvt_pk_bf16_f32 v26, v104, v105
  v_lshlrev_b32 v104, 16, v26
  v_and_b32 v105, 0xffff0000, v26
  v_mul_f32 v104, v104, v33
  v_mul_f32 v105, v105, v33
  v_cvt_pk_bf16_f32 v26, v104, v105
  v_lshlrev_b32 v104, 16, v26
  v_and_b32 v105, 0xffff0000, v26
  v_cvt_pk_bf16_f32 v26, v106, v107
  v_lshlrev_b32 v106, 16, v26
  v_and_b32 v107, 0xffff0000, v26
  v_mul_f32 v106, v106, v33
  v_mul_f32 v107, v107, v33
  v_cvt_pk_bf16_f32 v26, v106, v107
  v_lshlrev_b32 v106, 16, v26
  v_and_b32 v107, 0xffff0000, v26
  v_cvt_pk_bf16_f32 v26, v108, v109
  v_lshlrev_b32 v108, 16, v26
  v_and_b32 v109, 0xffff0000, v26
  v_mul_f32 v108, v108, v33
  v_mul_f32 v109, v109, v33
  v_cvt_pk_bf16_f32 v26, v108, v109
  v_lshlrev_b32 v108, 16, v26
  v_and_b32 v109, 0xffff0000, v26
  v_cvt_pk_bf16_f32 v26, v110, v111
  v_lshlrev_b32 v110, 16, v26
  v_and_b32 v111, 0xffff0000, v26
  v_mul_f32 v110, v110, v33
  v_mul_f32 v111, v111, v33
  v_cvt_pk_bf16_f32 v26, v110, v111
  v_lshlrev_b32 v110, 16, v26
  v_and_b32 v111, 0xffff0000, v26
  v_cvt_pk_bf16_f32 v26, v112, v113
  v_lshlrev_b32 v112, 16, v26
  v_and_b32 v113, 0xffff0000, v26
  v_mul_f32 v112, v112, v33
  v_mul_f32 v113, v113, v33
  v_cvt_pk_bf16_f32 v26, v112, v113
  v_lshlrev_b32 v112, 16, v26
  v_and_b32 v113, 0xffff0000, v26
  v_cvt_pk_bf16_f32 v26, v114, v115
  v_lshlrev_b32 v114, 16, v26
  v_and_b32 v115, 0xffff0000, v26
  v_mul_f32 v114, v114, v33
  v_mul_f32 v115, v115, v33
  v_cvt_pk_bf16_f32 v26, v114, v115
  v_lshlrev_b32 v114, 16, v26
  v_and_b32 v115, 0xffff0000, v26
  v_cvt_pk_bf16_f32 v26, v116, v117
  v_lshlrev_b32 v116, 16, v26
  v_and_b32 v117, 0xffff0000, v26
  v_mul_f32 v116, v116, v33
  v_mul_f32 v117, v117, v33
  v_cvt_pk_bf16_f32 v26, v116, v117
  v_lshlrev_b32 v116, 16, v26
  v_and_b32 v117, 0xffff0000, v26
  v_cvt_pk_bf16_f32 v26, v118, v119
  v_lshlrev_b32 v118, 16, v26
  v_and_b32 v119, 0xffff0000, v26
  v_mul_f32 v118, v118, v33
  v_mul_f32 v119, v119, v33
  v_cvt_pk_bf16_f32 v26, v118, v119
  v_lshlrev_b32 v118, 16, v26
  v_and_b32 v119, 0xffff0000, v26
  v_cvt_pk_bf16_f32 v26, v120, v121
  v_lshlrev_b32 v120, 16, v26
  v_and_b32 v121, 0xffff0000, v26
  v_mul_f32 v120, v120, v33
  v_mul_f32 v121, v121, v33
  v_cvt_pk_bf16_f32 v26, v120, v121
  v_lshlrev_b32 v120, 16, v26
  v_and_b32 v121, 0xffff0000, v26
  v_cvt_pk_bf16_f32 v26, v122, v123
  v_lshlrev_b32 v122, 16, v26
  v_and_b32 v123, 0xffff0000, v26
  v_mul_f32 v122, v122, v33
  v_mul_f32 v123, v123, v33
  v_cvt_pk_bf16_f32 v26, v122, v123
  v_lshlrev_b32 v122, 16, v26
  v_and_b32 v123, 0xffff0000, v26
  v_cvt_pk_bf16_f32 v26, v124, v125
  v_lshlrev_b32 v124, 16, v26
  v_and_b32 v125, 0xffff0000, v26
  v_mul_f32 v124, v124, v33
  v_mul_f32 v125, v125, v33
  v_cvt_pk_bf16_f32 v26, v124, v125
  v_lshlrev_b32 v124, 16, v26
  v_and_b32 v125, 0xffff0000, v26
  v_cvt_pk_bf16_f32 v26, v126, v127
  v_lshlrev_b32 v126, 16, v26
  v_and_b32 v127, 0xffff0000, v26
  v_mul_f32 v126, v126, v33
  v_mul_f32 v127, v127, v33
  v_cvt_pk_bf16_f32 v26, v126, v127
  v_lshlrev_b32 v126, 16, v26
  v_and_b32 v127, 0xffff0000, v26
  v_cvt_pk_bf16_f32 v26, v128, v129
  v_lshlrev_b32 v128, 16, v26
  v_and_b32 v129, 0xffff0000, v26
  v_mul_f32 v128, v128, v33
  v_mul_f32 v129, v129, v33
  v_cvt_pk_bf16_f32 v26, v128, v129
  v_lshlrev_b32 v128, 16, v26
  v_and_b32 v129, 0xffff0000, v26
  v_cvt_pk_bf16_f32 v26, v130, v131
  v_lshlrev_b32 v130, 16, v26
  v_and_b32 v131, 0xffff0000, v26
  v_mul_f32 v130, v130, v33
  v_mul_f32 v131, v131, v33
  v_cvt_pk_bf16_f32 v26, v130, v131
  v_lshlrev_b32 v130, 16, v26
  v_and_b32 v131, 0xffff0000, v26
  v_cvt_pk_bf16_f32 v26, v132, v133
  v_lshlrev_b32 v132, 16, v26
  v_and_b32 v133, 0xffff0000, v26
  v_mul_f32 v132, v132, v33
  v_mul_f32 v133, v133, v33
  v_cvt_pk_bf16_f32 v26, v132, v133
  v_lshlrev_b32 v132, 16, v26
  v_and_b32 v133, 0xffff0000, v26
  v_cvt_pk_bf16_f32 v26, v134, v135
  v_lshlrev_b32 v134, 16, v26
  v_and_b32 v135, 0xffff0000, v26
  v_mul_f32 v134, v134, v33
  v_mul_f32 v135, v135, v33
  v_cvt_pk_bf16_f32 v26, v134, v135
  v_lshlrev_b32 v134, 16, v26
  v_and_b32 v135, 0xffff0000, v26
  v_cvt_pk_bf16_f32 v26, v136, v137
  v_lshlrev_b32 v136, 16, v26
  v_and_b32 v137, 0xffff0000, v26
  v_mul_f32 v136, v136, v33
  v_mul_f32 v137, v137, v33
  v_cvt_pk_bf16_f32 v26, v136, v137
  v_lshlrev_b32 v136, 16, v26
  v_and_b32 v137, 0xffff0000, v26
  v_cvt_pk_bf16_f32 v26, v138, v139
  v_lshlrev_b32 v138, 16, v26
  v_and_b32 v139, 0xffff0000, v26
  v_mul_f32 v138, v138, v33
  v_mul_f32 v139, v139, v33
  v_cvt_pk_bf16_f32 v26, v138, v139
  v_lshlrev_b32 v138, 16, v26
  v_and_b32 v139, 0xffff0000, v26
  v_cvt_pk_bf16_f32 v26, v140, v141
  v_lshlrev_b32 v140, 16, v26
  v_and_b32 v141, 0xffff0000, v26
  v_mul_f32 v140, v140, v33
  v_mul_f32 v141, v141, v33
  v_cvt_pk_bf16_f32 v26, v140, v141
  v_lshlrev_b32 v140, 16, v26
  v_and_b32 v141, 0xffff0000, v26
  v_cvt_pk_bf16_f32 v26, v142, v143
  v_lshlrev_b32 v142, 16, v26
  v_and_b32 v143, 0xffff0000, v26
  v_mul_f32 v142, v142, v33
  v_mul_f32 v143, v143, v33
  v_cvt_pk_bf16_f32 v26, v142, v143
  v_lshlrev_b32 v142, 16, v26
  v_and_b32 v143, 0xffff0000, v26
  s_waitcnt vmcnt(19)
  v_cvt_pk_bf16_f32 v26, v144, v145
  v_lshlrev_b32 v144, 16, v26
  v_and_b32 v145, 0xffff0000, v26
  v_mul_f32 v144, v144, v30
  v_mul_f32 v145, v145, v30
  v_cvt_pk_bf16_f32 v26, v144, v145
  v_lshlrev_b32 v144, 16, v26
  v_and_b32 v145, 0xffff0000, v26
  v_add_f32 v144, v144, v64
  v_add_f32 v145, v145, v65
  v_cvt_pk_bf16_f32 v64, v144, v145
  v_cvt_pk_bf16_f32 v26, v146, v147
  v_lshlrev_b32 v146, 16, v26
  v_and_b32 v147, 0xffff0000, v26
  v_mul_f32 v146, v146, v30
  v_mul_f32 v147, v147, v30
  v_cvt_pk_bf16_f32 v26, v146, v147
  v_lshlrev_b32 v146, 16, v26
  v_and_b32 v147, 0xffff0000, v26
  v_add_f32 v146, v146, v66
  v_add_f32 v147, v147, v67
  v_cvt_pk_bf16_f32 v65, v146, v147
  buffer_store_dwordx2 v[64:65], v9, s[8:11], s22 offen offset:0
  s_waitcnt vmcnt(19)
  v_cvt_pk_bf16_f32 v26, v148, v149
  v_lshlrev_b32 v148, 16, v26
  v_and_b32 v149, 0xffff0000, v26
  v_mul_f32 v148, v148, v30
  v_mul_f32 v149, v149, v30
  v_cvt_pk_bf16_f32 v26, v148, v149
  v_lshlrev_b32 v148, 16, v26
  v_and_b32 v149, 0xffff0000, v26
  v_add_f32 v148, v148, v68
  v_add_f32 v149, v149, v69
  v_cvt_pk_bf16_f32 v68, v148, v149
  v_cvt_pk_bf16_f32 v26, v150, v151
  v_lshlrev_b32 v150, 16, v26
  v_and_b32 v151, 0xffff0000, v26
  v_mul_f32 v150, v150, v30
  v_mul_f32 v151, v151, v30
  v_cvt_pk_bf16_f32 v26, v150, v151
  v_lshlrev_b32 v150, 16, v26
  v_and_b32 v151, 0xffff0000, v26
  v_add_f32 v150, v150, v70
  v_add_f32 v151, v151, v71
  v_cvt_pk_bf16_f32 v69, v150, v151
  buffer_store_dwordx2 v[68:69], v9, s[8:11], s22 offen offset:32
  s_waitcnt vmcnt(19)
  v_cvt_pk_bf16_f32 v26, v152, v153
  v_lshlrev_b32 v152, 16, v26
  v_and_b32 v153, 0xffff0000, v26
  v_mul_f32 v152, v152, v30
  v_mul_f32 v153, v153, v30
  v_cvt_pk_bf16_f32 v26, v152, v153
  v_lshlrev_b32 v152, 16, v26
  v_and_b32 v153, 0xffff0000, v26
  v_add_f32 v152, v152, v72
  v_add_f32 v153, v153, v73
  v_cvt_pk_bf16_f32 v72, v152, v153
  v_cvt_pk_bf16_f32 v26, v154, v155
  v_lshlrev_b32 v154, 16, v26
  v_and_b32 v155, 0xffff0000, v26
  v_mul_f32 v154, v154, v30
  v_mul_f32 v155, v155, v30
  v_cvt_pk_bf16_f32 v26, v154, v155
  v_lshlrev_b32 v154, 16, v26
  v_and_b32 v155, 0xffff0000, v26
  v_add_f32 v154, v154, v74
  v_add_f32 v155, v155, v75
  v_cvt_pk_bf16_f32 v73, v154, v155
  buffer_store_dwordx2 v[72:73], v9, s[8:11], s22 offen offset:64
  s_waitcnt vmcnt(19)
  v_cvt_pk_bf16_f32 v26, v156, v157
  v_lshlrev_b32 v156, 16, v26
  v_and_b32 v157, 0xffff0000, v26
  v_mul_f32 v156, v156, v30
  v_mul_f32 v157, v157, v30
  v_cvt_pk_bf16_f32 v26, v156, v157
  v_lshlrev_b32 v156, 16, v26
  v_and_b32 v157, 0xffff0000, v26
  v_add_f32 v156, v156, v76
  v_add_f32 v157, v157, v77
  v_cvt_pk_bf16_f32 v76, v156, v157
  v_cvt_pk_bf16_f32 v26, v158, v159
  v_lshlrev_b32 v158, 16, v26
  v_and_b32 v159, 0xffff0000, v26
  v_mul_f32 v158, v158, v30
  v_mul_f32 v159, v159, v30
  v_cvt_pk_bf16_f32 v26, v158, v159
  v_lshlrev_b32 v158, 16, v26
  v_and_b32 v159, 0xffff0000, v26
  v_add_f32 v158, v158, v78
  v_add_f32 v159, v159, v79
  v_cvt_pk_bf16_f32 v77, v158, v159
  buffer_store_dwordx2 v[76:77], v9, s[8:11], s22 offen offset:96
  s_waitcnt vmcnt(19)
  v_cvt_pk_bf16_f32 v26, v160, v161
  v_lshlrev_b32 v160, 16, v26
  v_and_b32 v161, 0xffff0000, v26
  v_mul_f32 v160, v160, v30
  v_mul_f32 v161, v161, v30
  v_cvt_pk_bf16_f32 v26, v160, v161
  v_lshlrev_b32 v160, 16, v26
  v_and_b32 v161, 0xffff0000, v26
  v_add_f32 v160, v160, v80
  v_add_f32 v161, v161, v81
  v_cvt_pk_bf16_f32 v80, v160, v161
  v_cvt_pk_bf16_f32 v26, v162, v163
  v_lshlrev_b32 v162, 16, v26
  v_and_b32 v163, 0xffff0000, v26
  v_mul_f32 v162, v162, v30
  v_mul_f32 v163, v163, v30
  v_cvt_pk_bf16_f32 v26, v162, v163
  v_lshlrev_b32 v162, 16, v26
  v_and_b32 v163, 0xffff0000, v26
  v_add_f32 v162, v162, v82
  v_add_f32 v163, v163, v83
  v_cvt_pk_bf16_f32 v81, v162, v163
  buffer_store_dwordx2 v[80:81], v9, s[8:11], s22 offen offset:128
  s_waitcnt vmcnt(19)
  v_cvt_pk_bf16_f32 v26, v164, v165
  v_lshlrev_b32 v164, 16, v26
  v_and_b32 v165, 0xffff0000, v26
  v_mul_f32 v164, v164, v30
  v_mul_f32 v165, v165, v30
  v_cvt_pk_bf16_f32 v26, v164, v165
  v_lshlrev_b32 v164, 16, v26
  v_and_b32 v165, 0xffff0000, v26
  v_add_f32 v164, v164, v84
  v_add_f32 v165, v165, v85
  v_cvt_pk_bf16_f32 v84, v164, v165
  v_cvt_pk_bf16_f32 v26, v166, v167
  v_lshlrev_b32 v166, 16, v26
  v_and_b32 v167, 0xffff0000, v26
  v_mul_f32 v166, v166, v30
  v_mul_f32 v167, v167, v30
  v_cvt_pk_bf16_f32 v26, v166, v167
  v_lshlrev_b32 v166, 16, v26
  v_and_b32 v167, 0xffff0000, v26
  v_add_f32 v166, v166, v86
  v_add_f32 v167, v167, v87
  v_cvt_pk_bf16_f32 v85, v166, v167
  buffer_store_dwordx2 v[84:85], v9, s[8:11], s22 offen offset:160
  s_waitcnt vmcnt(19)
  v_cvt_pk_bf16_f32 v26, v168, v169
  v_lshlrev_b32 v168, 16, v26
  v_and_b32 v169, 0xffff0000, v26
  v_mul_f32 v168, v168, v30
  v_mul_f32 v169, v169, v30
  v_cvt_pk_bf16_f32 v26, v168, v169
  v_lshlrev_b32 v168, 16, v26
  v_and_b32 v169, 0xffff0000, v26
  v_add_f32 v168, v168, v88
  v_add_f32 v169, v169, v89
  v_cvt_pk_bf16_f32 v88, v168, v169
  v_cvt_pk_bf16_f32 v26, v170, v171
  v_lshlrev_b32 v170, 16, v26
  v_and_b32 v171, 0xffff0000, v26
  v_mul_f32 v170, v170, v30
  v_mul_f32 v171, v171, v30
  v_cvt_pk_bf16_f32 v26, v170, v171
  v_lshlrev_b32 v170, 16, v26
  v_and_b32 v171, 0xffff0000, v26
  v_add_f32 v170, v170, v90
  v_add_f32 v171, v171, v91
  v_cvt_pk_bf16_f32 v89, v170, v171
  buffer_store_dwordx2 v[88:89], v9, s[8:11], s22 offen offset:192
  s_waitcnt vmcnt(19)
  v_cvt_pk_bf16_f32 v26, v172, v173
  v_lshlrev_b32 v172, 16, v26
  v_and_b32 v173, 0xffff0000, v26
  v_mul_f32 v172, v172, v30
  v_mul_f32 v173, v173, v30
  v_cvt_pk_bf16_f32 v26, v172, v173
  v_lshlrev_b32 v172, 16, v26
  v_and_b32 v173, 0xffff0000, v26
  v_add_f32 v172, v172, v92
  v_add_f32 v173, v173, v93
  v_cvt_pk_bf16_f32 v92, v172, v173
  v_cvt_pk_bf16_f32 v26, v174, v175
  v_lshlrev_b32 v174, 16, v26
  v_and_b32 v175, 0xffff0000, v26
  v_mul_f32 v174, v174, v30
  v_mul_f32 v175, v175, v30
  v_cvt_pk_bf16_f32 v26, v174, v175
  v_lshlrev_b32 v174, 16, v26
  v_and_b32 v175, 0xffff0000, v26
  v_add_f32 v174, v174, v94
  v_add_f32 v175, v175, v95
  v_cvt_pk_bf16_f32 v93, v174, v175
  buffer_store_dwordx2 v[92:93], v9, s[8:11], s22 offen offset:224
  s_waitcnt vmcnt(19)
  v_cvt_pk_bf16_f32 v26, v176, v177
  v_lshlrev_b32 v176, 16, v26
  v_and_b32 v177, 0xffff0000, v26
  v_mul_f32 v176, v176, v30
  v_mul_f32 v177, v177, v30
  v_cvt_pk_bf16_f32 v26, v176, v177
  v_lshlrev_b32 v176, 16, v26
  v_and_b32 v177, 0xffff0000, v26
  v_add_f32 v176, v176, v96
  v_add_f32 v177, v177, v97
  v_cvt_pk_bf16_f32 v96, v176, v177
  v_cvt_pk_bf16_f32 v26, v178, v179
  v_lshlrev_b32 v178, 16, v26
  v_and_b32 v179, 0xffff0000, v26
  v_mul_f32 v178, v178, v30
  v_mul_f32 v179, v179, v30
  v_cvt_pk_bf16_f32 v26, v178, v179
  v_lshlrev_b32 v178, 16, v26
  v_and_b32 v179, 0xffff0000, v26
  v_add_f32 v178, v178, v98
  v_add_f32 v179, v179, v99
  v_cvt_pk_bf16_f32 v97, v178, v179
  buffer_store_dwordx2 v[96:97], v9, s[8:11], s22 offen offset:256
  s_waitcnt vmcnt(19)
  v_cvt_pk_bf16_f32 v26, v180, v181
  v_lshlrev_b32 v180, 16, v26
  v_and_b32 v181, 0xffff0000, v26
  v_mul_f32 v180, v180, v30
  v_mul_f32 v181, v181, v30
  v_cvt_pk_bf16_f32 v26, v180, v181
  v_lshlrev_b32 v180, 16, v26
  v_and_b32 v181, 0xffff0000, v26
  v_add_f32 v180, v180, v100
  v_add_f32 v181, v181, v101
  v_cvt_pk_bf16_f32 v100, v180, v181
  v_cvt_pk_bf16_f32 v26, v182, v183
  v_lshlrev_b32 v182, 16, v26
  v_and_b32 v183, 0xffff0000, v26
  v_mul_f32 v182, v182, v30
  v_mul_f32 v183, v183, v30
  v_cvt_pk_bf16_f32 v26, v182, v183
  v_lshlrev_b32 v182, 16, v26
  v_and_b32 v183, 0xffff0000, v26
  v_add_f32 v182, v182, v102
  v_add_f32 v183, v183, v103
  v_cvt_pk_bf16_f32 v101, v182, v183
  buffer_store_dwordx2 v[100:101], v9, s[8:11], s22 offen offset:288
  s_waitcnt vmcnt(19)
  v_cvt_pk_bf16_f32 v26, v184, v185
  v_lshlrev_b32 v184, 16, v26
  v_and_b32 v185, 0xffff0000, v26
  v_mul_f32 v184, v184, v31
  v_mul_f32 v185, v185, v31
  v_cvt_pk_bf16_f32 v26, v184, v185
  v_lshlrev_b32 v184, 16, v26
  v_and_b32 v185, 0xffff0000, v26
  v_add_f32 v184, v184, v104
  v_add_f32 v185, v185, v105
  v_cvt_pk_bf16_f32 v104, v184, v185
  v_cvt_pk_bf16_f32 v26, v186, v187
  v_lshlrev_b32 v186, 16, v26
  v_and_b32 v187, 0xffff0000, v26
  v_mul_f32 v186, v186, v31
  v_mul_f32 v187, v187, v31
  v_cvt_pk_bf16_f32 v26, v186, v187
  v_lshlrev_b32 v186, 16, v26
  v_and_b32 v187, 0xffff0000, v26
  v_add_f32 v186, v186, v106
  v_add_f32 v187, v187, v107
  v_cvt_pk_bf16_f32 v105, v186, v187
  buffer_store_dwordx2 v[104:105], v9, s[8:11], s23 offen offset:0
  s_waitcnt vmcnt(19)
  v_cvt_pk_bf16_f32 v26, v188, v189
  v_lshlrev_b32 v188, 16, v26
  v_and_b32 v189, 0xffff0000, v26
  v_mul_f32 v188, v188, v31
  v_mul_f32 v189, v189, v31
  v_cvt_pk_bf16_f32 v26, v188, v189
  v_lshlrev_b32 v188, 16, v26
  v_and_b32 v189, 0xffff0000, v26
  v_add_f32 v188, v188, v108
  v_add_f32 v189, v189, v109
  v_cvt_pk_bf16_f32 v108, v188, v189
  v_cvt_pk_bf16_f32 v26, v190, v191
  v_lshlrev_b32 v190, 16, v26
  v_and_b32 v191, 0xffff0000, v26
  v_mul_f32 v190, v190, v31
  v_mul_f32 v191, v191, v31
  v_cvt_pk_bf16_f32 v26, v190, v191
  v_lshlrev_b32 v190, 16, v26
  v_and_b32 v191, 0xffff0000, v26
  v_add_f32 v190, v190, v110
  v_add_f32 v191, v191, v111
  v_cvt_pk_bf16_f32 v109, v190, v191
  buffer_store_dwordx2 v[108:109], v9, s[8:11], s23 offen offset:32
  s_waitcnt vmcnt(19)
  v_cvt_pk_bf16_f32 v26, v192, v193
  v_lshlrev_b32 v192, 16, v26
  v_and_b32 v193, 0xffff0000, v26
  v_mul_f32 v192, v192, v31
  v_mul_f32 v193, v193, v31
  v_cvt_pk_bf16_f32 v26, v192, v193
  v_lshlrev_b32 v192, 16, v26
  v_and_b32 v193, 0xffff0000, v26
  v_add_f32 v192, v192, v112
  v_add_f32 v193, v193, v113
  v_cvt_pk_bf16_f32 v112, v192, v193
  v_cvt_pk_bf16_f32 v26, v194, v195
  v_lshlrev_b32 v194, 16, v26
  v_and_b32 v195, 0xffff0000, v26
  v_mul_f32 v194, v194, v31
  v_mul_f32 v195, v195, v31
  v_cvt_pk_bf16_f32 v26, v194, v195
  v_lshlrev_b32 v194, 16, v26
  v_and_b32 v195, 0xffff0000, v26
  v_add_f32 v194, v194, v114
  v_add_f32 v195, v195, v115
  v_cvt_pk_bf16_f32 v113, v194, v195
  buffer_store_dwordx2 v[112:113], v9, s[8:11], s23 offen offset:64
  s_waitcnt vmcnt(19)
  v_cvt_pk_bf16_f32 v26, v196, v197
  v_lshlrev_b32 v196, 16, v26
  v_and_b32 v197, 0xffff0000, v26
  v_mul_f32 v196, v196, v31
  v_mul_f32 v197, v197, v31
  v_cvt_pk_bf16_f32 v26, v196, v197
  v_lshlrev_b32 v196, 16, v26
  v_and_b32 v197, 0xffff0000, v26
  v_add_f32 v196, v196, v116
  v_add_f32 v197, v197, v117
  v_cvt_pk_bf16_f32 v116, v196, v197
  v_cvt_pk_bf16_f32 v26, v198, v199
  v_lshlrev_b32 v198, 16, v26
  v_and_b32 v199, 0xffff0000, v26
  v_mul_f32 v198, v198, v31
  v_mul_f32 v199, v199, v31
  v_cvt_pk_bf16_f32 v26, v198, v199
  v_lshlrev_b32 v198, 16, v26
  v_and_b32 v199, 0xffff0000, v26
  v_add_f32 v198, v198, v118
  v_add_f32 v199, v199, v119
  v_cvt_pk_bf16_f32 v117, v198, v199
  buffer_store_dwordx2 v[116:117], v9, s[8:11], s23 offen offset:96
  s_waitcnt vmcnt(19)
  v_cvt_pk_bf16_f32 v26, v200, v201
  v_lshlrev_b32 v200, 16, v26
  v_and_b32 v201, 0xffff0000, v26
  v_mul_f32 v200, v200, v31
  v_mul_f32 v201, v201, v31
  v_cvt_pk_bf16_f32 v26, v200, v201
  v_lshlrev_b32 v200, 16, v26
  v_and_b32 v201, 0xffff0000, v26
  v_add_f32 v200, v200, v120
  v_add_f32 v201, v201, v121
  v_cvt_pk_bf16_f32 v120, v200, v201
  v_cvt_pk_bf16_f32 v26, v202, v203
  v_lshlrev_b32 v202, 16, v26
  v_and_b32 v203, 0xffff0000, v26
  v_mul_f32 v202, v202, v31
  v_mul_f32 v203, v203, v31
  v_cvt_pk_bf16_f32 v26, v202, v203
  v_lshlrev_b32 v202, 16, v26
  v_and_b32 v203, 0xffff0000, v26
  v_add_f32 v202, v202, v122
  v_add_f32 v203, v203, v123
  v_cvt_pk_bf16_f32 v121, v202, v203
  buffer_store_dwordx2 v[120:121], v9, s[8:11], s23 offen offset:128
  s_waitcnt vmcnt(19)
  v_cvt_pk_bf16_f32 v26, v204, v205
  v_lshlrev_b32 v204, 16, v26
  v_and_b32 v205, 0xffff0000, v26
  v_mul_f32 v204, v204, v31
  v_mul_f32 v205, v205, v31
  v_cvt_pk_bf16_f32 v26, v204, v205
  v_lshlrev_b32 v204, 16, v26
  v_and_b32 v205, 0xffff0000, v26
  v_add_f32 v204, v204, v124
  v_add_f32 v205, v205, v125
  v_cvt_pk_bf16_f32 v124, v204, v205
  v_cvt_pk_bf16_f32 v26, v206, v207
  v_lshlrev_b32 v206, 16, v26
  v_and_b32 v207, 0xffff0000, v26
  v_mul_f32 v206, v206, v31
  v_mul_f32 v207, v207, v31
  v_cvt_pk_bf16_f32 v26, v206, v207
  v_lshlrev_b32 v206, 16, v26
  v_and_b32 v207, 0xffff0000, v26
  v_add_f32 v206, v206, v126
  v_add_f32 v207, v207, v127
  v_cvt_pk_bf16_f32 v125, v206, v207
  buffer_store_dwordx2 v[124:125], v9, s[8:11], s23 offen offset:160
  s_waitcnt vmcnt(19)
  v_cvt_pk_bf16_f32 v26, v208, v209
  v_lshlrev_b32 v208, 16, v26
  v_and_b32 v209, 0xffff0000, v26
  v_mul_f32 v208, v208, v31
  v_mul_f32 v209, v209, v31
  v_cvt_pk_bf16_f32 v26, v208, v209
  v_lshlrev_b32 v208, 16, v26
  v_and_b32 v209, 0xffff0000, v26
  v_add_f32 v208, v208, v128
  v_add_f32 v209, v209, v129
  v_cvt_pk_bf16_f32 v128, v208, v209
  v_cvt_pk_bf16_f32 v26, v210, v211
  v_lshlrev_b32 v210, 16, v26
  v_and_b32 v211, 0xffff0000, v26
  v_mul_f32 v210, v210, v31
  v_mul_f32 v211, v211, v31
  v_cvt_pk_bf16_f32 v26, v210, v211
  v_lshlrev_b32 v210, 16, v26
  v_and_b32 v211, 0xffff0000, v26
  v_add_f32 v210, v210, v130
  v_add_f32 v211, v211, v131
  v_cvt_pk_bf16_f32 v129, v210, v211
  buffer_store_dwordx2 v[128:129], v9, s[8:11], s23 offen offset:192
  s_waitcnt vmcnt(19)
  v_cvt_pk_bf16_f32 v26, v212, v213
  v_lshlrev_b32 v212, 16, v26
  v_and_b32 v213, 0xffff0000, v26
  v_mul_f32 v212, v212, v31
  v_mul_f32 v213, v213, v31
  v_cvt_pk_bf16_f32 v26, v212, v213
  v_lshlrev_b32 v212, 16, v26
  v_and_b32 v213, 0xffff0000, v26
  v_add_f32 v212, v212, v132
  v_add_f32 v213, v213, v133
  v_cvt_pk_bf16_f32 v132, v212, v213
  v_cvt_pk_bf16_f32 v26, v214, v215
  v_lshlrev_b32 v214, 16, v26
  v_and_b32 v215, 0xffff0000, v26
  v_mul_f32 v214, v214, v31
  v_mul_f32 v215, v215, v31
  v_cvt_pk_bf16_f32 v26, v214, v215
  v_lshlrev_b32 v214, 16, v26
  v_and_b32 v215, 0xffff0000, v26
  v_add_f32 v214, v214, v134
  v_add_f32 v215, v215, v135
  v_cvt_pk_bf16_f32 v133, v214, v215
  buffer_store_dwordx2 v[132:133], v9, s[8:11], s23 offen offset:224
  s_waitcnt vmcnt(19)
  v_cvt_pk_bf16_f32 v26, v216, v217
  v_lshlrev_b32 v216, 16, v26
  v_and_b32 v217, 0xffff0000, v26
  v_mul_f32 v216, v216, v31
  v_mul_f32 v217, v217, v31
  v_cvt_pk_bf16_f32 v26, v216, v217
  v_lshlrev_b32 v216, 16, v26
  v_and_b32 v217, 0xffff0000, v26
  v_add_f32 v216, v216, v136
  v_add_f32 v217, v217, v137
  v_cvt_pk_bf16_f32 v136, v216, v217
  v_cvt_pk_bf16_f32 v26, v218, v219
  v_lshlrev_b32 v218, 16, v26
  v_and_b32 v219, 0xffff0000, v26
  v_mul_f32 v218, v218, v31
  v_mul_f32 v219, v219, v31
  v_cvt_pk_bf16_f32 v26, v218, v219
  v_lshlrev_b32 v218, 16, v26
  v_and_b32 v219, 0xffff0000, v26
  v_add_f32 v218, v218, v138
  v_add_f32 v219, v219, v139
  v_cvt_pk_bf16_f32 v137, v218, v219
  buffer_store_dwordx2 v[136:137], v9, s[8:11], s23 offen offset:256
  s_waitcnt vmcnt(19)
  v_cvt_pk_bf16_f32 v26, v220, v221
  v_lshlrev_b32 v220, 16, v26
  v_and_b32 v221, 0xffff0000, v26
  v_mul_f32 v220, v220, v31
  v_mul_f32 v221, v221, v31
  v_cvt_pk_bf16_f32 v26, v220, v221
  v_lshlrev_b32 v220, 16, v26
  v_and_b32 v221, 0xffff0000, v26
  v_add_f32 v220, v220, v140
  v_add_f32 v221, v221, v141
  v_cvt_pk_bf16_f32 v140, v220, v221
  v_cvt_pk_bf16_f32 v26, v222, v223
  v_lshlrev_b32 v222, 16, v26
  v_and_b32 v223, 0xffff0000, v26
  v_mul_f32 v222, v222, v31
  v_mul_f32 v223, v223, v31
  v_cvt_pk_bf16_f32 v26, v222, v223
  v_lshlrev_b32 v222, 16, v26
  v_and_b32 v223, 0xffff0000, v26
  v_add_f32 v222, v222, v142
  v_add_f32 v223, v223, v143
  v_cvt_pk_bf16_f32 v141, v222, v223
  buffer_store_dwordx2 v[140:141], v9, s[8:11], s23 offen offset:288
om_263:
  s_cmp_eq_u32 s87, -2
  s_cbranch_scc1 kv_help
  s_waitcnt vmcnt(0) lgkmcnt(0)
  s_barrier
  s_add_u32 s21, s2, 24
  s_cmp_lt_u32 s21, 32
  s_cbranch_scc1 do_opb2
  s_cmp_eq_u32 s87, -1
  s_cbranch_scc1 queue
tail_item:
  s_load_dwordx2 s[4:5], s[0:1], 96
  s_waitcnt lgkmcnt(0)
  s_mov_b32 s32, s4
  s_mov_b32 s33, s5
  s_mov_b32 s34, 256
  s_mov_b32 s35, 0x00020000
  s_waitcnt vmcnt(0)
  s_barrier
  s_mov_b32 s21, s87
do_pv:
  s_mov_b32 s2, s21
  s_load_dwordx2 s[4:5], s[0:1], 88
  s_load_dwordx2 s[38:39], s[0:1], 104
  s_waitcnt lgkmcnt(0)
  s_mov_b32 s8, s4
  s_mov_b32 s9, s5
  s_mov_b32 s10, 2621440
  s_mov_b32 s11, 0x00020000
  s_add_u32 s12, s38, 114294784
  s_addc_u32 s13, s39, 0
  s_mov_b32 s14, 83886080
  s_mov_b32 s15, 0x00020000
  s_mov_b32 s59, 0
  s_mov_b32 s60, 0
  s_add_u32 s16, s38, 85983232
  s_addc_u32 s17, s39, 0
  s_mov_b32 s18, 28311552
  s_mov_b32 s19, 0x00020000
  s_add_u32 s24, s38, 73400320
  s_addc_u32 s25, s39, 0
  s_mov_b32 s26, 5242880
  s_mov_b32 s27, 0x00020000
  s_add_u32 s28, s38, 81002496
  s_addc_u32 s29, s39, 0
  s_mov_b32 s30, 8192
  s_mov_b32 s31, 0x00020000
  s_add_u32 s72, s38, 81068032
  s_addc_u32 s73, s39, 0
  s_mov_b32 s74, 116736
  s_mov_b32 s75, 0x00020000
  v_lshlrev_b32 v4, 4, v1
  v_lshlrev_b32 v5, 3, v1
  v_lshlrev_b32 v6, 2, v2
  v_and_b32 v7, 7, v1
  v_lshlrev_b32 v7, 7, v7
  v_lshrrev_b32 v31, 3, v1
  v_lshl_add_u32 v208, v31, 10, v7
  v_bfe_u32 v31, v1, 3, 2
  v_lshl_add_u32 v31, v31, 2, v7
  s_lshl_b32 s21, s20, 10
  s_add_u32 s21, s21, 95232
  buffer_load_dword v8, v31, s[72:75], s21 offen sc1
  v_lshlrev_b32 v25, 7, v2
  s_mov_b32 s21, 93184
  buffer_load_dword v26, v25, s[72:75], s21 offen sc1
  s_mov_b32 s63, 1
  v_mul_u32_u24 v9, 1280, v2
  v_lshl_add_u32 v9, v3, 3, v9
  s_lshl_b32 s21, s20, 13
  v_add_u32 v10, s21, v4
  s_lshl_b32 s21, s20, 10
  v_add_u32 v11, s21, v4
  v_lshrrev_b32 v20, 5, v1
  v_mul_u32_u24 v21, 2560, v20
  v_add_u32 v21, v21, v4
  v_and_b32 v22, 31, v1
  v_lshlrev_b32 v22, 4, v22
  v_mul_u32_u24 v20, 10240, v20
  v_add_u32 v22, v22, v20
  v_mul_u32_u24 v21, 2560, v3
  v_lshl_add_u32 v21, v2, 4, v21
  v_mul_u32_u24 v22, 10240, v3
  v_lshl_add_u32 v22, v2, 4, v22
  v_mov_b32 v28, 80
  v_mov_b32 v30, 32768
  s_mov_b32 s50, 0
  s_mov_b32 s71, 0
  s_mov_b32 s51, 0
  s_and_b32 s43, s20, 1
  s_lshr_b32 s44, s20, 1
  v_mov_b32 v70, 0
  v_mov_b32 v71, 0
  v_mov_b32 v78, 0
  v_mov_b32 v79, 0
  v_mov_b32 v86, 0
  v_mov_b32 v87, 0
  v_mov_b32 v94, 0
  v_mov_b32 v95, 0
  v_mov_b32 v102, 0
  v_mov_b32 v103, 0
  v_mov_b32 v110, 0
  v_mov_b32 v111, 0
  v_mov_b32 v118, 0
  v_mov_b32 v119, 0
  v_mov_b32 v126, 0
  v_mov_b32 v127, 0
  s_mov_b32 s21, s2
pv_loop:
  s_mul_i32 s2, s21, 2
  s_add_u32 s22, s21, 250
  s_cmp_lt_u32 s21, 250
  s_cselect_b32 s2, s2, s22
  s_cselect_b32 s65, 1, 0
  s_mul_hi_u32 s40, s2, 0x1999999a
  s_mul_i32 s21, s40, 10
  s_sub_u32 s41, s2, s21
  s_lshl_b32 s52, s40, 10
  s_add_u32 s52, s52, 23552
  buffer_load_dword v27, v7, s[72:75], s52 offen sc1
  s_cmp_lg_u32 s20, 0
  s_cbranch_scc1 pv_277
  s_sub_u32 s21, s2, 400
  s_cmp_lt_u32 s21, 240
  s_cbranch_scc1 pv_277
  v_mov_b32 v29, 1
  s_mov_b64 exec, 1
  buffer_atomic_add v29, v28, s[32:35], 0 offen sc0 sc1
  s_mov_b64 exec, -1
pv_277:
  s_lshl_b32 s42, s40, 5
  s_lshl_b32 s21, s20, 3
  s_add_u32 s42, s42, s21
  s_mul_i32 s61, s21, 5
  s_lshr_b32 s22, s41, 1
  s_add_u32 s61, s61, s22
  s_and_b32 s62, s41, 1
  s_lshl_b32 s62, s62, 12
  s_mul_i32 s53, s42, 40960
  s_lshl_b32 s22, s41, 12
  s_add_u32 s53, s53, s22
  s_lshl_b32 s21, s40, 1
  s_add_u32 s21, s21, s43
  s_lshl_b32 s45, s21, 6
  s_mul_i32 s46, s21, 20480
  s_mul_i32 s21, s21, 40
  s_lshl_b32 s22, s41, 2
  s_add_u32 s22, s22, s44
  s_add_u32 s21, s21, s22
  s_lshl_b32 s54, s21, 10
  s_lshl_b32 s22, s22, 5
  s_add_u32 s46, s46, s22
  s_mul_i32 s47, s42, 2560
  s_mul_i32 s48, s42, 10240
  s_lshl_b32 s22, s41, 10
  s_add_u32 s48, s48, s22
  s_add_u32 s48, s48, 7340032
  s_add_u32 s23, s40, 1
  s_cmp_ge_u32 s50, s23
  s_cbranch_scc1 pv_270
  s_cmp_eq_u32 s63, 0
  s_cbranch_scc1 pv_273
  s_mov_b32 s63, 0
  s_waitcnt vmcnt(1)
  v_cmp_le_u32 vcc, 4, v26
  s_mov_b32 s51, vcc_lo
  v_cmp_gt_u32 vcc, s23, v8
  s_nop 1
  s_cbranch_vccz pv_274
pv_273:
  s_lshl_b32 s21, s20, 10
  s_add_u32 s21, s21, 95232
  s_mov_b32 s101, 0
wm_278:
  buffer_load_dword v8, v31, s[72:75], s21 offen sc1
  s_add_u32 s101, s101, 1
  s_cmp_gt_u32 s101, 131072
  s_cbranch_scc1 main_end
  s_waitcnt vmcnt(0)
  v_cmp_gt_u32 vcc, s23, v8
  v_readfirstlane_b32 s100, v8
  s_nop 0
  s_cbranch_vccz wm_279
  s_sleep 8
  s_add_u32 s100, s100, 2
  s_cmp_ge_u32 s100, s23
  s_cbranch_scc1 wm_278
  s_sleep 60
  s_branch wm_278
wm_279:
pv_274:
  v_readlane_b32 s50, v8, 0
  v_readlane_b32 s21, v8, 1
  s_min_u32 s50, s50, s21
  v_readlane_b32 s21, v8, 2
  s_min_u32 s50, s50, s21
  v_readlane_b32 s21, v8, 3
  s_min_u32 s50, s50, s21
  v_readlane_b32 s21, v8, 4
  s_min_u32 s50, s50, s21
  v_readlane_b32 s21, v8, 5
  s_min_u32 s50, s50, s21
  v_readlane_b32 s21, v8, 6
  s_min_u32 s50, s50, s21
  v_readlane_b32 s21, v8, 7
  s_min_u32 s50, s50, s21
  v_readlane_b32 s21, v8, 8
  s_min_u32 s50, s50, s21
  v_readlane_b32 s21, v8, 9
  s_min_u32 s50, s50, s21
  v_readlane_b32 s21, v8, 10
  s_min_u32 s50, s50, s21
  v_readlane_b32 s21, v8, 11
  s_min_u32 s50, s50, s21
  v_readlane_b32 s21, v8, 12
  s_min_u32 s50, s50, s21
  v_readlane_b32 s21, v8, 13
  s_min_u32 s50, s50, s21
  v_readlane_b32 s21, v8, 14
  s_min_u32 s50, s50, s21
  v_readlane_b32 s21, v8, 15
  s_min_u32 s50, s50, s21
  v_readlane_b32 s21, v8, 16
  s_min_u32 s50, s50, s21
  v_readlane_b32 s21, v8, 17
  s_min_u32 s50, s50, s21
  v_readlane_b32 s21, v8, 18
  s_min_u32 s50, s50, s21
  v_readlane_b32 s21, v8, 19
  s_min_u32 s50, s50, s21
  v_readlane_b32 s21, v8, 20
  s_min_u32 s50, s50, s21
  v_readlane_b32 s21, v8, 21
  s_min_u32 s50, s50, s21
  v_readlane_b32 s21, v8, 22
  s_min_u32 s50, s50, s21
  v_readlane_b32 s21, v8, 23
  s_min_u32 s50, s50, s21
  v_readlane_b32 s21, v8, 24
  s_min_u32 s50, s50, s21
  v_readlane_b32 s21, v8, 25
  s_min_u32 s50, s50, s21
  v_readlane_b32 s21, v8, 26
  s_min_u32 s50, s50, s21
  v_readlane_b32 s21, v8, 27
  s_min_u32 s50, s50, s21
  v_readlane_b32 s21, v8, 28
  s_min_u32 s50, s50, s21
  v_readlane_b32 s21, v8, 29
  s_min_u32 s50, s50, s21
  v_readlane_b32 s21, v8, 30
  s_min_u32 s50, s50, s21
  v_readlane_b32 s21, v8, 31
  s_min_u32 s50, s50, s21
pv_270:
  s_lshr_b32 s22, s40, 2
  s_cmp_lt_u32 s40, 32
  s_cbranch_scc1 pv_271
  s_bitcmp1_b32 s51, s22
  s_cbranch_scc1 pv_271
  s_mov_b32 s21, 93184
  v_lshlrev_b32 v25, 7, v2
  s_mov_b32 s101, 0
pv_272:
  buffer_load_dword v26, v25, s[72:75], s21 offen sc1
  s_add_u32 s101, s101, 1
  s_cmp_gt_u32 s101, 131072
  s_cbranch_scc1 main_end
  s_waitcnt vmcnt(0)
  v_cmp_le_u32 vcc, 4, v26
  s_mov_b32 s51, vcc_lo
  s_bitcmp1_b32 s51, s22
  s_cbranch_scc1 pv_271
  s_sleep 8
  s_branch pv_272
pv_271:
  buffer_load_dwordx4 a[0:3], v4, s[12:15], s53 offen offset:0 sc1
  buffer_load_dwordx4 a[4:7], v4, s[12:15], s53 offen offset:1024 sc1
  buffer_load_dwordx4 a[8:11], v4, s[12:15], s53 offen offset:2048 sc1
  buffer_load_dwordx4 a[12:15], v4, s[12:15], s53 offen offset:3072 sc1
  s_add_u32 s53, s53, 40960
  buffer_load_dwordx4 a[16:19], v4, s[12:15], s53 offen offset:0 sc1
  buffer_load_dwordx4 a[20:23], v4, s[12:15], s53 offen offset:1024 sc1
  buffer_load_dwordx4 a[24:27], v4, s[12:15], s53 offen offset:2048 sc1
  buffer_load_dwordx4 a[28:31], v4, s[12:15], s53 offen offset:3072 sc1
  s_add_u32 s53, s53, 40960
  buffer_load_dwordx4 a[32:35], v4, s[12:15], s53 offen offset:0 sc1
  buffer_load_dwordx4 a[36:39], v4, s[12:15], s53 offen offset:1024 sc1
  buffer_load_dwordx4 a[40:43], v4, s[12:15], s53 offen offset:2048 sc1
  buffer_load_dwordx4 a[44:47], v4, s[12:15], s53 offen offset:3072 sc1
  s_add_u32 s53, s53, 40960
  buffer_load_dwordx4 a[48:51], v4, s[12:15], s53 offen offset:0 sc1
  buffer_load_dwordx4 a[52:55], v4, s[12:15], s53 offen offset:1024 sc1
  buffer_load_dwordx4 a[56:59], v4, s[12:15], s53 offen offset:2048 sc1
  buffer_load_dwordx4 a[60:63], v4, s[12:15], s53 offen offset:3072 sc1
  s_add_u32 s53, s53, 40960
  buffer_load_dwordx4 a[64:67], v4, s[12:15], s53 offen offset:0 sc1
  buffer_load_dwordx4 a[68:71], v4, s[12:15], s53 offen offset:1024 sc1
  buffer_load_dwordx4 a[72:75], v4, s[12:15], s53 offen offset:2048 sc1
  buffer_load_dwordx4 a[76:79], v4, s[12:15], s53 offen offset:3072 sc1
  s_add_u32 s53, s53, 40960
  buffer_load_dwordx4 a[80:83], v4, s[12:15], s53 offen offset:0 sc1
  buffer_load_dwordx4 a[84:87], v4, s[12:15], s53 offen offset:1024 sc1
  buffer_load_dwordx4 a[88:91], v4, s[12:15], s53 offen offset:2048 sc1
  buffer_load_dwordx4 a[92:95], v4, s[12:15], s53 offen offset:3072 sc1
  s_add_u32 s53, s53, 40960
  buffer_load_dwordx4 a[96:99], v4, s[12:15], s53 offen offset:0 sc1
  buffer_load_dwordx4 a[100:103], v4, s[12:15], s53 offen offset:1024 sc1
  buffer_load_dwordx4 a[104:107], v4, s[12:15], s53 offen offset:2048 sc1
  buffer_load_dwordx4 a[108:111], v4, s[12:15], s53 offen offset:3072 sc1
  s_add_u32 s53, s53, 40960
  buffer_load_dwordx4 a[112:115], v4, s[12:15], s53 offen offset:0 sc1
  buffer_load_dwordx4 a[116:119], v4, s[12:15], s53 offen offset:1024 sc1
  buffer_load_dwordx4 a[120:123], v4, s[12:15], s53 offen offset:2048 sc1
  buffer_load_dwordx4 a[124:127], v4, s[12:15], s53 offen offset:3072 sc1
  s_cmp_lt_u32 s40, 32
  s_cselect_b32 s70, 0x80000000, s54
  buffer_load_dwordx4 v[12:15], v4, s[24:27], s70 offen sc1
  buffer_load_dwordx4 v[16:19], v4, s[24:27], s70 offen offset:2048 sc1
  buffer_load_dword v24, v6, s[28:31], s45 offen sc1
  s_waitcnt vmcnt(35)
  s_cmp_eq_u32 s71, 0
  s_cbranch_scc1 paf_282
  v_mov_b32 v25, 0
  v_mov_b32 v26, 1
  s_mov_b64 exec, 1
  buffer_atomic_add v26, v25, s[72:75], s71 offen sc1
  s_mov_b64 exec, -1
  s_mov_b32 s71, 0
paf_282:
  v_cmp_le_u32 s[68:69], 4, v27
  s_nop 1
  s_and_b32 s21, s68, 255
  s_cmp_lg_u32 s21, 255
  s_cbranch_scc1 pvw_275
  s_mov_b32 s56, s47
  s_mov_b32 s57, s48
  buffer_load_dwordx4 v[64:67], v4, s[16:19], s56 offen sc1
  buffer_load_dwordx2 v[68:69], v5, s[16:19], s56 offen offset:2048 sc1
  buffer_load_dwordx4 v[128:131], v21, s[16:19], s56 offen offset:1024 sc1
  buffer_load_dwordx4 v[132:135], v21, s[16:19], s56 offen offset:1280 sc1
  s_add_u32 s56, s56, 2560
  buffer_load_dwordx4 v[72:75], v4, s[16:19], s56 offen sc1
  buffer_load_dwordx2 v[76:77], v5, s[16:19], s56 offen offset:2048 sc1
  s_add_u32 s56, s56, 2560
  buffer_load_dwordx4 v[80:83], v4, s[16:19], s56 offen sc1
  buffer_load_dwordx2 v[84:85], v5, s[16:19], s56 offen offset:2048 sc1
  s_add_u32 s56, s56, 2560
  buffer_load_dwordx4 v[88:91], v4, s[16:19], s56 offen sc1
  buffer_load_dwordx2 v[92:93], v5, s[16:19], s56 offen offset:2048 sc1
  s_add_u32 s56, s56, 2560
  buffer_load_dwordx4 v[32:35], v22, s[16:19], s57 offen offset:0 sc1
  buffer_load_dwordx4 v[36:39], v22, s[16:19], s57 offen offset:256 sc1
  buffer_load_dwordx4 v[40:43], v22, s[16:19], s57 offen offset:512 sc1
  buffer_load_dwordx4 v[44:47], v22, s[16:19], s57 offen offset:768 sc1
  s_add_u32 s57, s57, 40960
  buffer_load_dwordx4 v[96:99], v4, s[16:19], s56 offen sc1
  buffer_load_dwordx2 v[100:101], v5, s[16:19], s56 offen offset:2048 sc1
  buffer_load_dwordx4 v[136:139], v21, s[16:19], s56 offen offset:1024 sc1
  buffer_load_dwordx4 v[140:143], v21, s[16:19], s56 offen offset:1280 sc1
  s_add_u32 s56, s56, 2560
  buffer_load_dwordx4 v[104:107], v4, s[16:19], s56 offen sc1
  buffer_load_dwordx2 v[108:109], v5, s[16:19], s56 offen offset:2048 sc1
  s_add_u32 s56, s56, 2560
  buffer_load_dwordx4 v[112:115], v4, s[16:19], s56 offen sc1
  buffer_load_dwordx2 v[116:117], v5, s[16:19], s56 offen offset:2048 sc1
  s_add_u32 s56, s56, 2560
  buffer_load_dwordx4 v[120:123], v4, s[16:19], s56 offen sc1
  buffer_load_dwordx2 v[124:125], v5, s[16:19], s56 offen offset:2048 sc1
  s_add_u32 s56, s56, 2560
  buffer_load_dwordx4 v[48:51], v22, s[16:19], s57 offen offset:0 sc1
  buffer_load_dwordx4 v[52:55], v22, s[16:19], s57 offen offset:256 sc1
  buffer_load_dwordx4 v[56:59], v22, s[16:19], s57 offen offset:512 sc1
  buffer_load_dwordx4 v[60:63], v22, s[16:19], s57 offen offset:768 sc1
  s_add_u32 s57, s57, 40960
  s_barrier
  s_waitcnt vmcnt(28)
  v_sub_f32 v25, 1.0, v24
  v_cvt_pk_bf16_f32 v26, v25, v25
  v_lshlrev_b32 v25, 16, v26
  v_cvt_pk_bf16_f32 v26, v12, v12
  v_lshlrev_b32 v12, 16, v26
  v_cvt_pk_bf16_f32 v26, v13, v13
  v_lshlrev_b32 v13, 16, v26
  v_cvt_pk_bf16_f32 v26, v14, v14
  v_lshlrev_b32 v14, 16, v26
  v_cvt_pk_bf16_f32 v26, v15, v15
  v_lshlrev_b32 v15, 16, v26
  v_cvt_pk_bf16_f32 v26, v16, v16
  v_lshlrev_b32 v16, 16, v26
  v_cvt_pk_bf16_f32 v26, v17, v17
  v_lshlrev_b32 v17, 16, v26
  v_cvt_pk_bf16_f32 v26, v18, v18
  v_lshlrev_b32 v18, 16, v26
  v_cvt_pk_bf16_f32 v26, v19, v19
  v_lshlrev_b32 v19, 16, v26
  v_mul_f32 v12, v12, v25
  v_cvt_pk_bf16_f32 v26, v12, v12
  v_lshlrev_b32 v12, 16, v26
  v_mul_f32 v13, v13, v25
  v_cvt_pk_bf16_f32 v26, v13, v13
  v_lshlrev_b32 v13, 16, v26
  v_mul_f32 v14, v14, v25
  v_cvt_pk_bf16_f32 v26, v14, v14
  v_lshlrev_b32 v14, 16, v26
  v_mul_f32 v15, v15, v25
  v_cvt_pk_bf16_f32 v26, v15, v15
  v_lshlrev_b32 v15, 16, v26
  v_mul_f32 v16, v16, v25
  v_cvt_pk_bf16_f32 v26, v16, v16
  v_lshlrev_b32 v16, 16, v26
  v_mul_f32 v17, v17, v25
  v_cvt_pk_bf16_f32 v26, v17, v17
  v_lshlrev_b32 v17, 16, v26
  v_mul_f32 v18, v18, v25
  v_cvt_pk_bf16_f32 v26, v18, v18
  v_lshlrev_b32 v18, 16, v26
  v_mul_f32 v19, v19, v25
  v_cvt_pk_bf16_f32 v26, v19, v19
  v_lshlrev_b32 v19, 16, v26
  s_cmp_ge_u32 s40, 56
  s_cbranch_scc1 pvc_281
  s_branch pvg_280
pvw_275:
  s_waitcnt vmcnt(0)
  v_sub_f32 v25, 1.0, v24
  v_cvt_pk_bf16_f32 v26, v25, v25
  v_lshlrev_b32 v25, 16, v26
  v_cvt_pk_bf16_f32 v26, v12, v12
  v_lshlrev_b32 v12, 16, v26
  v_cvt_pk_bf16_f32 v26, v13, v13
  v_lshlrev_b32 v13, 16, v26
  v_cvt_pk_bf16_f32 v26, v14, v14
  v_lshlrev_b32 v14, 16, v26
  v_cvt_pk_bf16_f32 v26, v15, v15
  v_lshlrev_b32 v15, 16, v26
  v_cvt_pk_bf16_f32 v26, v16, v16
  v_lshlrev_b32 v16, 16, v26
  v_cvt_pk_bf16_f32 v26, v17, v17
  v_lshlrev_b32 v17, 16, v26
  v_cvt_pk_bf16_f32 v26, v18, v18
  v_lshlrev_b32 v18, 16, v26
  v_cvt_pk_bf16_f32 v26, v19, v19
  v_lshlrev_b32 v19, 16, v26
  v_mul_f32 v12, v12, v25
  v_cvt_pk_bf16_f32 v26, v12, v12
  v_lshlrev_b32 v12, 16, v26
  v_mul_f32 v13, v13, v25
  v_cvt_pk_bf16_f32 v26, v13, v13
  v_lshlrev_b32 v13, 16, v26
  v_mul_f32 v14, v14, v25
  v_cvt_pk_bf16_f32 v26, v14, v14
  v_lshlrev_b32 v14, 16, v26
  v_mul_f32 v15, v15, v25
  v_cvt_pk_bf16_f32 v26, v15, v15
  v_lshlrev_b32 v15, 16, v26
  v_mul_f32 v16, v16, v25
  v_cvt_pk_bf16_f32 v26, v16, v16
  v_lshlrev_b32 v16, 16, v26
  v_mul_f32 v17, v17, v25
  v_cvt_pk_bf16_f32 v26, v17, v17
  v_lshlrev_b32 v17, 16, v26
  v_mul_f32 v18, v18, v25
  v_cvt_pk_bf16_f32 v26, v18, v18
  v_lshlrev_b32 v18, 16, v26
  v_mul_f32 v19, v19, v25
  v_cvt_pk_bf16_f32 v26, v19, v19
  v_lshlrev_b32 v19, 16, v26
  s_cmp_ge_u32 s40, 56
  s_cbranch_scc1 pvt_283
  s_cmp_lg_u32 s20, 0
  s_cbranch_scc1 wm_285
  s_mov_b32 s101, 0
wm_284:
  buffer_load_dword v26, v7, s[72:75], s52 offen sc1
  s_add_u32 s101, s101, 1
  s_cmp_gt_u32 s101, 131072
  s_cbranch_scc1 main_end
  s_waitcnt vmcnt(0)
  v_cmp_gt_u32 vcc, 4, v26
  v_readfirstlane_b32 s100, v26
  s_nop 0
  s_cbranch_vccz wm_285
  s_sleep 2
  s_add_u32 s100, s100, 3
  s_cmp_ge_u32 s100, 4
  s_cbranch_scc1 wm_284
  s_sleep 24
  s_branch wm_284
wm_285:
  s_barrier
  buffer_load_dwordx4 v[64:67], v4, s[16:19], s47 offen sc1
  buffer_load_dwordx2 v[68:69], v5, s[16:19], s47 offen offset:2048 sc1
  buffer_load_dwordx4 v[128:131], v21, s[16:19], s47 offen offset:1024 sc1
  buffer_load_dwordx4 v[132:135], v21, s[16:19], s47 offen offset:1280 sc1
  s_add_u32 s47, s47, 2560
  buffer_load_dwordx4 v[72:75], v4, s[16:19], s47 offen sc1
  buffer_load_dwordx2 v[76:77], v5, s[16:19], s47 offen offset:2048 sc1
  s_add_u32 s47, s47, 2560
  buffer_load_dwordx4 v[80:83], v4, s[16:19], s47 offen sc1
  buffer_load_dwordx2 v[84:85], v5, s[16:19], s47 offen offset:2048 sc1
  s_add_u32 s47, s47, 2560
  buffer_load_dwordx4 v[88:91], v4, s[16:19], s47 offen sc1
  buffer_load_dwordx2 v[92:93], v5, s[16:19], s47 offen offset:2048 sc1
  s_add_u32 s47, s47, 2560
  buffer_load_dwordx4 v[32:35], v22, s[16:19], s48 offen offset:0 sc1
  buffer_load_dwordx4 v[36:39], v22, s[16:19], s48 offen offset:256 sc1
  buffer_load_dwordx4 v[40:43], v22, s[16:19], s48 offen offset:512 sc1
  buffer_load_dwordx4 v[44:47], v22, s[16:19], s48 offen offset:768 sc1
  s_add_u32 s48, s48, 40960
  buffer_load_dwordx4 v[96:99], v4, s[16:19], s47 offen sc1
  buffer_load_dwordx2 v[100:101], v5, s[16:19], s47 offen offset:2048 sc1
  buffer_load_dwordx4 v[136:139], v21, s[16:19], s47 offen offset:1024 sc1
  buffer_load_dwordx4 v[140:143], v21, s[16:19], s47 offen offset:1280 sc1
  s_add_u32 s47, s47, 2560
  buffer_load_dwordx4 v[104:107], v4, s[16:19], s47 offen sc1
  buffer_load_dwordx2 v[108:109], v5, s[16:19], s47 offen offset:2048 sc1
  s_add_u32 s47, s47, 2560
  buffer_load_dwordx4 v[112:115], v4, s[16:19], s47 offen sc1
  buffer_load_dwordx2 v[116:117], v5, s[16:19], s47 offen offset:2048 sc1
  s_add_u32 s47, s47, 2560
  buffer_load_dwordx4 v[120:123], v4, s[16:19], s47 offen sc1
  buffer_load_dwordx2 v[124:125], v5, s[16:19], s47 offen offset:2048 sc1
  s_add_u32 s47, s47, 2560
  buffer_load_dwordx4 v[48:51], v22, s[16:19], s48 offen offset:0 sc1
  buffer_load_dwordx4 v[52:55], v22, s[16:19], s48 offen offset:256 sc1
  buffer_load_dwordx4 v[56:59], v22, s[16:19], s48 offen offset:512 sc1
  buffer_load_dwordx4 v[60:63], v22, s[16:19], s48 offen offset:768 sc1
  s_add_u32 s48, s48, 40960
pvg_280:
  s_waitcnt vmcnt(26)
  v_mfma_f32_16x16x32_bf16 v[148:151], a[0:3], v[64:67], 0
  v_mfma_f32_16x16x32_bf16 v[144:147], a[0:3], v[68:71], 0
  v_mfma_f32_16x16x32_bf16 v[156:159], a[4:7], v[64:67], 0
  v_mfma_f32_16x16x32_bf16 v[152:155], a[4:7], v[68:71], 0
  v_mfma_f32_16x16x32_bf16 v[164:167], a[8:11], v[64:67], 0
  v_mfma_f32_16x16x32_bf16 v[160:163], a[8:11], v[68:71], 0
  v_mfma_f32_16x16x32_bf16 v[172:175], a[12:15], v[64:67], 0
  v_mfma_f32_16x16x32_bf16 v[168:171], a[12:15], v[68:71], 0
  s_waitcnt vmcnt(22)
  v_mfma_f32_16x16x32_bf16 v[148:151], a[16:19], v[72:75], v[148:151]
  v_mfma_f32_16x16x32_bf16 v[144:147], a[16:19], v[76:79], v[144:147]
  v_mfma_f32_16x16x32_bf16 v[156:159], a[20:23], v[72:75], v[156:159]
  v_mfma_f32_16x16x32_bf16 v[152:155], a[20:23], v[76:79], v[152:155]
  v_mfma_f32_16x16x32_bf16 v[164:167], a[24:27], v[72:75], v[164:167]
  v_mfma_f32_16x16x32_bf16 v[160:163], a[24:27], v[76:79], v[160:163]
  v_mfma_f32_16x16x32_bf16 v[172:175], a[28:31], v[72:75], v[172:175]
  v_mfma_f32_16x16x32_bf16 v[168:171], a[28:31], v[76:79], v[168:171]
  s_waitcnt vmcnt(20)
  v_mfma_f32_16x16x32_bf16 v[148:151], a[32:35], v[80:83], v[148:151]
  v_mfma_f32_16x16x32_bf16 v[144:147], a[32:35], v[84:87], v[144:147]
  v_mfma_f32_16x16x32_bf16 v[156:159], a[36:39], v[80:83], v[156:159]
  v_mfma_f32_16x16x32_bf16 v[152:155], a[36:39], v[84:87], v[152:155]
  v_mfma_f32_16x16x32_bf16 v[164:167], a[40:43], v[80:83], v[164:167]
  v_mfma_f32_16x16x32_bf16 v[160:163], a[40:43], v[84:87], v[160:163]
  v_mfma_f32_16x16x32_bf16 v[172:175], a[44:47], v[80:83], v[172:175]
  v_mfma_f32_16x16x32_bf16 v[168:171], a[44:47], v[84:87], v[168:171]
  s_waitcnt vmcnt(18)
  v_mfma_f32_16x16x32_bf16 v[148:151], a[48:51], v[88:91], v[148:151]
  v_mfma_f32_16x16x32_bf16 v[144:147], a[48:51], v[92:95], v[144:147]
  v_mfma_f32_16x16x32_bf16 v[156:159], a[52:55], v[88:91], v[156:159]
  v_mfma_f32_16x16x32_bf16 v[152:155], a[52:55], v[92:95], v[152:155]
  v_mfma_f32_16x16x32_bf16 v[164:167], a[56:59], v[88:91], v[164:167]
  v_mfma_f32_16x16x32_bf16 v[160:163], a[56:59], v[92:95], v[160:163]
  v_mfma_f32_16x16x32_bf16 v[172:175], a[60:63], v[88:91], v[172:175]
  v_mfma_f32_16x16x32_bf16 v[168:171], a[60:63], v[92:95], v[168:171]
  s_waitcnt vmcnt(14)
  s_nop 1
  v_mfma_f32_16x16x32_bf16 v[144:147], v[32:35], v[128:131], v[144:147]
  v_mfma_f32_16x16x32_bf16 v[148:151], v[32:35], v[132:135], v[148:151]
  v_mfma_f32_16x16x32_bf16 v[152:155], v[36:39], v[128:131], v[152:155]
  v_mfma_f32_16x16x32_bf16 v[156:159], v[36:39], v[132:135], v[156:159]
  v_mfma_f32_16x16x32_bf16 v[160:163], v[40:43], v[128:131], v[160:163]
  v_mfma_f32_16x16x32_bf16 v[164:167], v[40:43], v[132:135], v[164:167]
  v_mfma_f32_16x16x32_bf16 v[168:171], v[44:47], v[128:131], v[168:171]
  v_mfma_f32_16x16x32_bf16 v[172:175], v[44:47], v[132:135], v[172:175]
  s_waitcnt vmcnt(12)
  v_mfma_f32_16x16x32_bf16 v[148:151], a[64:67], v[96:99], v[148:151]
  v_mfma_f32_16x16x32_bf16 v[144:147], a[64:67], v[100:103], v[144:147]
  v_mfma_f32_16x16x32_bf16 v[156:159], a[68:71], v[96:99], v[156:159]
  v_mfma_f32_16x16x32_bf16 v[152:155], a[68:71], v[100:103], v[152:155]
  v_mfma_f32_16x16x32_bf16 v[164:167], a[72:75], v[96:99], v[164:167]
  v_mfma_f32_16x16x32_bf16 v[160:163], a[72:75], v[100:103], v[160:163]
  v_mfma_f32_16x16x32_bf16 v[172:175], a[76:79], v[96:99], v[172:175]
  v_mfma_f32_16x16x32_bf16 v[168:171], a[76:79], v[100:103], v[168:171]
  s_waitcnt vmcnt(8)
  v_mfma_f32_16x16x32_bf16 v[148:151], a[80:83], v[104:107], v[148:151]
  v_mfma_f32_16x16x32_bf16 v[144:147], a[80:83], v[108:111], v[144:147]
  v_mfma_f32_16x16x32_bf16 v[156:159], a[84:87], v[104:107], v[156:159]
  v_mfma_f32_16x16x32_bf16 v[152:155], a[84:87], v[108:111], v[152:155]
  v_mfma_f32_16x16x32_bf16 v[164:167], a[88:91], v[104:107], v[164:167]
  v_mfma_f32_16x16x32_bf16 v[160:163], a[88:91], v[108:111], v[160:163]
  v_mfma_f32_16x16x32_bf16 v[172:175], a[92:95], v[104:107], v[172:175]
  v_mfma_f32_16x16x32_bf16 v[168:171], a[92:95], v[108:111], v[168:171]
  s_waitcnt vmcnt(6)
  v_mfma_f32_16x16x32_bf16 v[148:151], a[96:99], v[112:115], v[148:151]
  v_mfma_f32_16x16x32_bf16 v[144:147], a[96:99], v[116:119], v[144:147]
  v_mfma_f32_16x16x32_bf16 v[156:159], a[100:103], v[112:115], v[156:159]
  v_mfma_f32_16x16x32_bf16 v[152:155], a[100:103], v[116:119], v[152:155]
  v_mfma_f32_16x16x32_bf16 v[164:167], a[104:107], v[112:115], v[164:167]
  v_mfma_f32_16x16x32_bf16 v[160:163], a[104:107], v[116:119], v[160:163]
  v_mfma_f32_16x16x32_bf16 v[172:175], a[108:111], v[112:115], v[172:175]
  v_mfma_f32_16x16x32_bf16 v[168:171], a[108:111], v[116:119], v[168:171]
  s_waitcnt vmcnt(4)
  v_mfma_f32_16x16x32_bf16 v[148:151], a[112:115], v[120:123], v[148:151]
  v_mfma_f32_16x16x32_bf16 v[144:147], a[112:115], v[124:127], v[144:147]
  v_mfma_f32_16x16x32_bf16 v[156:159], a[116:119], v[120:123], v[156:159]
  v_mfma_f32_16x16x32_bf16 v[152:155], a[116:119], v[124:127], v[152:155]
  v_mfma_f32_16x16x32_bf16 v[164:167], a[120:123], v[120:123], v[164:167]
  v_mfma_f32_16x16x32_bf16 v[160:163], a[120:123], v[124:127], v[160:163]
  v_mfma_f32_16x16x32_bf16 v[172:175], a[124:127], v[120:123], v[172:175]
  v_mfma_f32_16x16x32_bf16 v[168:171], a[124:127], v[124:127], v[168:171]
  s_waitcnt vmcnt(0)
  s_nop 1
  v_mfma_f32_16x16x32_bf16 v[144:147], v[48:51], v[136:139], v[144:147]
  v_mfma_f32_16x16x32_bf16 v[148:151], v[48:51], v[140:143], v[148:151]
  v_mfma_f32_16x16x32_bf16 v[152:155], v[52:55], v[136:139], v[152:155]
  v_mfma_f32_16x16x32_bf16 v[156:159], v[52:55], v[140:143], v[156:159]
  v_mfma_f32_16x16x32_bf16 v[160:163], v[56:59], v[136:139], v[160:163]
  v_mfma_f32_16x16x32_bf16 v[164:167], v[56:59], v[140:143], v[164:167]
  v_mfma_f32_16x16x32_bf16 v[168:171], v[60:63], v[136:139], v[168:171]
  v_mfma_f32_16x16x32_bf16 v[172:175], v[60:63], v[140:143], v[172:175]
  s_branch pve_276
pvt_283:
  s_sub_u32 s55, s52, 2048
  s_cmp_lg_u32 s20, 0
  s_cbranch_scc1 wm_287
  s_mov_b32 s101, 0
wm_286:
  buffer_load_dword v26, v7, s[72:75], s55 offen sc1
  s_add_u32 s101, s101, 1
  s_cmp_gt_u32 s101, 131072
  s_cbranch_scc1 main_end
  s_waitcnt vmcnt(0)
  v_cmp_gt_u32 vcc, 4, v26
  v_readfirstlane_b32 s100, v26
  s_nop 0
  s_cbranch_vccz wm_287
  s_sleep 4
  s_add_u32 s100, s100, 3
  s_cmp_ge_u32 s100, 4
  s_cbranch_scc1 wm_286
  s_sleep 24
  s_branch wm_286
wm_287:
  s_barrier
  s_mov_b32 s56, s47
  s_mov_b32 s57, s48
  buffer_load_dwordx4 v[64:67], v4, s[16:19], s56 offen sc1
  buffer_load_dwordx2 v[68:69], v5, s[16:19], s56 offen offset:2048 sc1
  buffer_load_dwordx4 v[128:131], v21, s[16:19], s56 offen offset:1024 sc1
  buffer_load_dwordx4 v[132:135], v21, s[16:19], s56 offen offset:1280 sc1
  s_add_u32 s56, s56, 2560
  buffer_load_dwordx4 v[72:75], v4, s[16:19], s56 offen sc1
  buffer_load_dwordx2 v[76:77], v5, s[16:19], s56 offen offset:2048 sc1
  s_add_u32 s56, s56, 2560
  buffer_load_dwordx4 v[80:83], v4, s[16:19], s56 offen sc1
  buffer_load_dwordx2 v[84:85], v5, s[16:19], s56 offen offset:2048 sc1
  s_add_u32 s56, s56, 2560
  buffer_load_dwordx4 v[88:91], v4, s[16:19], s56 offen sc1
  buffer_load_dwordx2 v[92:93], v5, s[16:19], s56 offen offset:2048 sc1
  s_add_u32 s56, s56, 2560
  buffer_load_dwordx4 v[32:35], v22, s[16:19], s57 offen offset:0 sc1
  buffer_load_dwordx4 v[36:39], v22, s[16:19], s57 offen offset:256 sc1
  buffer_load_dwordx4 v[40:43], v22, s[16:19], s57 offen offset:512 sc1
  buffer_load_dwordx4 v[44:47], v22, s[16:19], s57 offen offset:768 sc1
  s_add_u32 s57, s57, 40960
  buffer_load_dwordx4 v[96:99], v4, s[16:19], s56 offen sc1
  buffer_load_dwordx2 v[100:101], v5, s[16:19], s56 offen offset:2048 sc1
  buffer_load_dwordx4 v[136:139], v21, s[16:19], s56 offen offset:1024 sc1
  buffer_load_dwordx4 v[140:143], v21, s[16:19], s56 offen offset:1280 sc1
  s_add_u32 s56, s56, 2560
  buffer_load_dwordx4 v[104:107], v4, s[16:19], s56 offen sc1
  buffer_load_dwordx2 v[108:109], v5, s[16:19], s56 offen offset:2048 sc1
  s_add_u32 s56, s56, 2560
  buffer_load_dwordx4 v[112:115], v4, s[16:19], s56 offen sc1
  buffer_load_dwordx2 v[116:117], v5, s[16:19], s56 offen offset:2048 sc1
  s_add_u32 s56, s56, 2560
  buffer_load_dwordx4 v[120:123], v4, s[16:19], s56 offen sc1
  buffer_load_dwordx2 v[124:125], v5, s[16:19], s56 offen offset:2048 sc1
  s_add_u32 s56, s56, 2560
  buffer_load_dwordx4 v[48:51], v22, s[16:19], s57 offen offset:0 sc1
  buffer_load_dwordx4 v[52:55], v22, s[16:19], s57 offen offset:256 sc1
  buffer_load_dwordx4 v[56:59], v22, s[16:19], s57 offen offset:512 sc1
  buffer_load_dwordx4 v[60:63], v22, s[16:19], s57 offen offset:768 sc1
  s_add_u32 s57, s57, 40960
pvc_281:
  s_mov_b32 s101, 0
  s_waitcnt vmcnt(14)
  s_branch pvr_289
pvr_288:
  s_sleep 2
  s_add_u32 s56, s47, 0
  s_add_u32 s57, s48, 0
  buffer_load_dwordx4 v[64:67], v4, s[16:19], s56 offen sc1
  buffer_load_dwordx2 v[68:69], v5, s[16:19], s56 offen offset:2048 sc1
  buffer_load_dwordx4 v[128:131], v21, s[16:19], s56 offen offset:1024 sc1
  buffer_load_dwordx4 v[132:135], v21, s[16:19], s56 offen offset:1280 sc1
  s_add_u32 s56, s56, 2560
  buffer_load_dwordx4 v[72:75], v4, s[16:19], s56 offen sc1
  buffer_load_dwordx2 v[76:77], v5, s[16:19], s56 offen offset:2048 sc1
  s_add_u32 s56, s56, 2560
  buffer_load_dwordx4 v[80:83], v4, s[16:19], s56 offen sc1
  buffer_load_dwordx2 v[84:85], v5, s[16:19], s56 offen offset:2048 sc1
  s_add_u32 s56, s56, 2560
  buffer_load_dwordx4 v[88:91], v4, s[16:19], s56 offen sc1
  buffer_load_dwordx2 v[92:93], v5, s[16:19], s56 offen offset:2048 sc1
  s_add_u32 s56, s56, 2560
  buffer_load_dwordx4 v[32:35], v22, s[16:19], s57 offen offset:0 sc1
  buffer_load_dwordx4 v[36:39], v22, s[16:19], s57 offen offset:256 sc1
  buffer_load_dwordx4 v[40:43], v22, s[16:19], s57 offen offset:512 sc1
  buffer_load_dwordx4 v[44:47], v22, s[16:19], s57 offen offset:768 sc1
  s_add_u32 s57, s57, 40960
  s_add_u32 s101, s101, 1
  s_cmp_gt_u32 s101, 131072
  s_cbranch_scc1 main_end
  s_waitcnt vmcnt(0)
pvr_289:
  v_max3_u32 v26, v64, v68, v72
  v_max3_u32 v26, v26, v76, v80
  v_max3_u32 v26, v26, v84, v88
  v_max3_u32 v26, v26, v92, v128
  v_max3_u32 v26, v26, v132, v32
  v_max3_u32 v26, v26, v36, v40
  v_max3_u32 v26, v26, v44, v44
  v_cmp_eq_u32 vcc, -1, v26
  s_nop 1
  s_cbranch_vccnz pvr_288
  v_mfma_f32_16x16x32_bf16 v[148:151], a[0:3], v[64:67], 0
  v_mfma_f32_16x16x32_bf16 v[144:147], a[0:3], v[68:71], 0
  v_mfma_f32_16x16x32_bf16 v[156:159], a[4:7], v[64:67], 0
  v_mfma_f32_16x16x32_bf16 v[152:155], a[4:7], v[68:71], 0
  v_mfma_f32_16x16x32_bf16 v[164:167], a[8:11], v[64:67], 0
  v_mfma_f32_16x16x32_bf16 v[160:163], a[8:11], v[68:71], 0
  v_mfma_f32_16x16x32_bf16 v[172:175], a[12:15], v[64:67], 0
  v_mfma_f32_16x16x32_bf16 v[168:171], a[12:15], v[68:71], 0
  v_mfma_f32_16x16x32_bf16 v[148:151], a[16:19], v[72:75], v[148:151]
  v_mfma_f32_16x16x32_bf16 v[144:147], a[16:19], v[76:79], v[144:147]
  v_mfma_f32_16x16x32_bf16 v[156:159], a[20:23], v[72:75], v[156:159]
  v_mfma_f32_16x16x32_bf16 v[152:155], a[20:23], v[76:79], v[152:155]
  v_mfma_f32_16x16x32_bf16 v[164:167], a[24:27], v[72:75], v[164:167]
  v_mfma_f32_16x16x32_bf16 v[160:163], a[24:27], v[76:79], v[160:163]
  v_mfma_f32_16x16x32_bf16 v[172:175], a[28:31], v[72:75], v[172:175]
  v_mfma_f32_16x16x32_bf16 v[168:171], a[28:31], v[76:79], v[168:171]
  v_mfma_f32_16x16x32_bf16 v[148:151], a[32:35], v[80:83], v[148:151]
  v_mfma_f32_16x16x32_bf16 v[144:147], a[32:35], v[84:87], v[144:147]
  v_mfma_f32_16x16x32_bf16 v[156:159], a[36:39], v[80:83], v[156:159]
  v_mfma_f32_16x16x32_bf16 v[152:155], a[36:39], v[84:87], v[152:155]
  v_mfma_f32_16x16x32_bf16 v[164:167], a[40:43], v[80:83], v[164:167]
  v_mfma_f32_16x16x32_bf16 v[160:163], a[40:43], v[84:87], v[160:163]
  v_mfma_f32_16x16x32_bf16 v[172:175], a[44:47], v[80:83], v[172:175]
  v_mfma_f32_16x16x32_bf16 v[168:171], a[44:47], v[84:87], v[168:171]
  v_mfma_f32_16x16x32_bf16 v[148:151], a[48:51], v[88:91], v[148:151]
  v_mfma_f32_16x16x32_bf16 v[144:147], a[48:51], v[92:95], v[144:147]
  v_mfma_f32_16x16x32_bf16 v[156:159], a[52:55], v[88:91], v[156:159]
  v_mfma_f32_16x16x32_bf16 v[152:155], a[52:55], v[92:95], v[152:155]
  v_mfma_f32_16x16x32_bf16 v[164:167], a[56:59], v[88:91], v[164:167]
  v_mfma_f32_16x16x32_bf16 v[160:163], a[56:59], v[92:95], v[160:163]
  v_mfma_f32_16x16x32_bf16 v[172:175], a[60:63], v[88:91], v[172:175]
  v_mfma_f32_16x16x32_bf16 v[168:171], a[60:63], v[92:95], v[168:171]
  s_nop 1
  v_mfma_f32_16x16x32_bf16 v[144:147], v[32:35], v[128:131], v[144:147]
  v_mfma_f32_16x16x32_bf16 v[148:151], v[32:35], v[132:135], v[148:151]
  v_mfma_f32_16x16x32_bf16 v[152:155], v[36:39], v[128:131], v[152:155]
  v_mfma_f32_16x16x32_bf16 v[156:159], v[36:39], v[132:135], v[156:159]
  v_mfma_f32_16x16x32_bf16 v[160:163], v[40:43], v[128:131], v[160:163]
  v_mfma_f32_16x16x32_bf16 v[164:167], v[40:43], v[132:135], v[164:167]
  v_mfma_f32_16x16x32_bf16 v[168:171], v[44:47], v[128:131], v[168:171]
  v_mfma_f32_16x16x32_bf16 v[172:175], v[44:47], v[132:135], v[172:175]
  s_mov_b32 s101, 0
  s_waitcnt vmcnt(0)
  s_branch pvr_291
pvr_290:
  s_sleep 2
  s_add_u32 s56, s47, 10240
  s_add_u32 s57, s48, 40960
  buffer_load_dwordx4 v[96:99], v4, s[16:19], s56 offen sc1
  buffer_load_dwordx2 v[100:101], v5, s[16:19], s56 offen offset:2048 sc1
  buffer_load_dwordx4 v[136:139], v21, s[16:19], s56 offen offset:1024 sc1
  buffer_load_dwordx4 v[140:143], v21, s[16:19], s56 offen offset:1280 sc1
  s_add_u32 s56, s56, 2560
  buffer_load_dwordx4 v[104:107], v4, s[16:19], s56 offen sc1
  buffer_load_dwordx2 v[108:109], v5, s[16:19], s56 offen offset:2048 sc1
  s_add_u32 s56, s56, 2560
  buffer_load_dwordx4 v[112:115], v4, s[16:19], s56 offen sc1
  buffer_load_dwordx2 v[116:117], v5, s[16:19], s56 offen offset:2048 sc1
  s_add_u32 s56, s56, 2560
  buffer_load_dwordx4 v[120:123], v4, s[16:19], s56 offen sc1
  buffer_load_dwordx2 v[124:125], v5, s[16:19], s56 offen offset:2048 sc1
  s_add_u32 s56, s56, 2560
  buffer_load_dwordx4 v[48:51], v22, s[16:19], s57 offen offset:0 sc1
  buffer_load_dwordx4 v[52:55], v22, s[16:19], s57 offen offset:256 sc1
  buffer_load_dwordx4 v[56:59], v22, s[16:19], s57 offen offset:512 sc1
  buffer_load_dwordx4 v[60:63], v22, s[16:19], s57 offen offset:768 sc1
  s_add_u32 s57, s57, 40960
  s_add_u32 s101, s101, 1
  s_cmp_gt_u32 s101, 131072
  s_cbranch_scc1 main_end
  s_waitcnt vmcnt(0)
pvr_291:
  v_max3_u32 v26, v96, v100, v104
  v_max3_u32 v26, v26, v108, v112
  v_max3_u32 v26, v26, v116, v120
  v_max3_u32 v26, v26, v124, v136
  v_max3_u32 v26, v26, v140, v48
  v_max3_u32 v26, v26, v52, v56
  v_max3_u32 v26, v26, v60, v60
  v_cmp_eq_u32 vcc, -1, v26
  s_nop 1
  s_cbranch_vccnz pvr_290
  v_mfma_f32_16x16x32_bf16 v[148:151], a[64:67], v[96:99], v[148:151]
  v_mfma_f32_16x16x32_bf16 v[144:147], a[64:67], v[100:103], v[144:147]
  v_mfma_f32_16x16x32_bf16 v[156:159], a[68:71], v[96:99], v[156:159]
  v_mfma_f32_16x16x32_bf16 v[152:155], a[68:71], v[100:103], v[152:155]
  v_mfma_f32_16x16x32_bf16 v[164:167], a[72:75], v[96:99], v[164:167]
  v_mfma_f32_16x16x32_bf16 v[160:163], a[72:75], v[100:103], v[160:163]
  v_mfma_f32_16x16x32_bf16 v[172:175], a[76:79], v[96:99], v[172:175]
  v_mfma_f32_16x16x32_bf16 v[168:171], a[76:79], v[100:103], v[168:171]
  v_mfma_f32_16x16x32_bf16 v[148:151], a[80:83], v[104:107], v[148:151]
  v_mfma_f32_16x16x32_bf16 v[144:147], a[80:83], v[108:111], v[144:147]
  v_mfma_f32_16x16x32_bf16 v[156:159], a[84:87], v[104:107], v[156:159]
  v_mfma_f32_16x16x32_bf16 v[152:155], a[84:87], v[108:111], v[152:155]
  v_mfma_f32_16x16x32_bf16 v[164:167], a[88:91], v[104:107], v[164:167]
  v_mfma_f32_16x16x32_bf16 v[160:163], a[88:91], v[108:111], v[160:163]
  v_mfma_f32_16x16x32_bf16 v[172:175], a[92:95], v[104:107], v[172:175]
  v_mfma_f32_16x16x32_bf16 v[168:171], a[92:95], v[108:111], v[168:171]
  v_mfma_f32_16x16x32_bf16 v[148:151], a[96:99], v[112:115], v[148:151]
  v_mfma_f32_16x16x32_bf16 v[144:147], a[96:99], v[116:119], v[144:147]
  v_mfma_f32_16x16x32_bf16 v[156:159], a[100:103], v[112:115], v[156:159]
  v_mfma_f32_16x16x32_bf16 v[152:155], a[100:103], v[116:119], v[152:155]
  v_mfma_f32_16x16x32_bf16 v[164:167], a[104:107], v[112:115], v[164:167]
  v_mfma_f32_16x16x32_bf16 v[160:163], a[104:107], v[116:119], v[160:163]
  v_mfma_f32_16x16x32_bf16 v[172:175], a[108:111], v[112:115], v[172:175]
  v_mfma_f32_16x16x32_bf16 v[168:171], a[108:111], v[116:119], v[168:171]
  v_mfma_f32_16x16x32_bf16 v[148:151], a[112:115], v[120:123], v[148:151]
  v_mfma_f32_16x16x32_bf16 v[144:147], a[112:115], v[124:127], v[144:147]
  v_mfma_f32_16x16x32_bf16 v[156:159], a[116:119], v[120:123], v[156:159]
  v_mfma_f32_16x16x32_bf16 v[152:155], a[116:119], v[124:127], v[152:155]
  v_mfma_f32_16x16x32_bf16 v[164:167], a[120:123], v[120:123], v[164:167]
  v_mfma_f32_16x16x32_bf16 v[160:163], a[120:123], v[124:127], v[160:163]
  v_mfma_f32_16x16x32_bf16 v[172:175], a[124:127], v[120:123], v[172:175]
  v_mfma_f32_16x16x32_bf16 v[168:171], a[124:127], v[124:127], v[168:171]
  s_nop 1
  v_mfma_f32_16x16x32_bf16 v[144:147], v[48:51], v[136:139], v[144:147]
  v_mfma_f32_16x16x32_bf16 v[148:151], v[48:51], v[140:143], v[148:151]
  v_mfma_f32_16x16x32_bf16 v[152:155], v[52:55], v[136:139], v[152:155]
  v_mfma_f32_16x16x32_bf16 v[156:159], v[52:55], v[140:143], v[156:159]
  v_mfma_f32_16x16x32_bf16 v[160:163], v[56:59], v[136:139], v[160:163]
  v_mfma_f32_16x16x32_bf16 v[164:167], v[56:59], v[140:143], v[164:167]
  v_mfma_f32_16x16x32_bf16 v[168:171], v[60:63], v[136:139], v[168:171]
  v_mfma_f32_16x16x32_bf16 v[172:175], v[60:63], v[140:143], v[172:175]
pve_276:
  s_nop 0
  s_cmp_eq_u32 s65, 0
  s_cbranch_scc1 pvx_292
  s_add_u32 s41, s41, 1
  s_mul_i32 s53, s42, 40960
  s_lshl_b32 s22, s41, 12
  s_add_u32 s53, s53, s22
  s_mul_i32 s48, s42, 10240
  s_lshl_b32 s22, s41, 10
  s_add_u32 s48, s48, s22
  s_add_u32 s48, s48, 7340032
  buffer_load_dwordx4 v[32:35], v22, s[16:19], s48 offen offset:0 sc1
  buffer_load_dwordx4 v[36:39], v22, s[16:19], s48 offen offset:256 sc1
  buffer_load_dwordx4 v[40:43], v22, s[16:19], s48 offen offset:512 sc1
  buffer_load_dwordx4 v[44:47], v22, s[16:19], s48 offen offset:768 sc1
  s_add_u32 s48, s48, 40960
  buffer_load_dwordx4 v[48:51], v22, s[16:19], s48 offen offset:0 sc1
  buffer_load_dwordx4 v[52:55], v22, s[16:19], s48 offen offset:256 sc1
  buffer_load_dwordx4 v[56:59], v22, s[16:19], s48 offen offset:512 sc1
  buffer_load_dwordx4 v[60:63], v22, s[16:19], s48 offen offset:768 sc1
  s_add_u32 s48, s48, 40960
  buffer_load_dwordx4 a[0:3], v4, s[12:15], s53 offen offset:0 sc1
  buffer_load_dwordx4 a[4:7], v4, s[12:15], s53 offen offset:1024 sc1
  buffer_load_dwordx4 a[8:11], v4, s[12:15], s53 offen offset:2048 sc1
  buffer_load_dwordx4 a[12:15], v4, s[12:15], s53 offen offset:3072 sc1
  s_add_u32 s53, s53, 40960
  buffer_load_dwordx4 a[16:19], v4, s[12:15], s53 offen offset:0 sc1
  buffer_load_dwordx4 a[20:23], v4, s[12:15], s53 offen offset:1024 sc1
  buffer_load_dwordx4 a[24:27], v4, s[12:15], s53 offen offset:2048 sc1
  buffer_load_dwordx4 a[28:31], v4, s[12:15], s53 offen offset:3072 sc1
  s_add_u32 s53, s53, 40960
  buffer_load_dwordx4 a[32:35], v4, s[12:15], s53 offen offset:0 sc1
  buffer_load_dwordx4 a[36:39], v4, s[12:15], s53 offen offset:1024 sc1
  buffer_load_dwordx4 a[40:43], v4, s[12:15], s53 offen offset:2048 sc1
  buffer_load_dwordx4 a[44:47], v4, s[12:15], s53 offen offset:3072 sc1
  s_add_u32 s53, s53, 40960
  buffer_load_dwordx4 a[48:51], v4, s[12:15], s53 offen offset:0 sc1
  buffer_load_dwordx4 a[52:55], v4, s[12:15], s53 offen offset:1024 sc1
  buffer_load_dwordx4 a[56:59], v4, s[12:15], s53 offen offset:2048 sc1
  buffer_load_dwordx4 a[60:63], v4, s[12:15], s53 offen offset:3072 sc1
  s_add_u32 s53, s53, 40960
  buffer_load_dwordx4 a[64:67], v4, s[12:15], s53 offen offset:0 sc1
  buffer_load_dwordx4 a[68:71], v4, s[12:15], s53 offen offset:1024 sc1
  buffer_load_dwordx4 a[72:75], v4, s[12:15], s53 offen offset:2048 sc1
  buffer_load_dwordx4 a[76:79], v4, s[12:15], s53 offen offset:3072 sc1
  s_add_u32 s53, s53, 40960
  buffer_load_dwordx4 a[80:83], v4, s[12:15], s53 offen offset:0 sc1
  buffer_load_dwordx4 a[84:87], v4, s[12:15], s53 offen offset:1024 sc1
  buffer_load_dwordx4 a[88:91], v4, s[12:15], s53 offen offset:2048 sc1
  buffer_load_dwordx4 a[92:95], v4, s[12:15], s53 offen offset:3072 sc1
  s_add_u32 s53, s53, 40960
  buffer_load_dwordx4 a[96:99], v4, s[12:15], s53 offen offset:0 sc1
  buffer_load_dwordx4 a[100:103], v4, s[12:15], s53 offen offset:1024 sc1
  buffer_load_dwordx4 a[104:107], v4, s[12:15], s53 offen offset:2048 sc1
  buffer_load_dwordx4 a[108:111], v4, s[12:15], s53 offen offset:3072 sc1
  s_add_u32 s53, s53, 40960
  buffer_load_dwordx4 a[112:115], v4, s[12:15], s53 offen offset:0 sc1
  buffer_load_dwordx4 a[116:119], v4, s[12:15], s53 offen offset:1024 sc1
  buffer_load_dwordx4 a[120:123], v4, s[12:15], s53 offen offset:2048 sc1
  buffer_load_dwordx4 a[124:127], v4, s[12:15], s53 offen offset:3072 sc1
pvx_292:
  s_cmp_lg_u32 s20, 0
  s_cbranch_scc1 lc_293
  s_sub_u32 s21, s2, 400
  s_cmp_ge_u32 s21, 240
  s_cbranch_scc1 lc_293
  v_mov_b32 v29, 1
  s_mov_b64 exec, 1
  buffer_atomic_add v29, v28, s[32:35], 0 offen sc0 sc1
  s_mov_b64 exec, -1
lc_293:
  ds_write_b128 v10, v[144:147] offset:0
  ds_write_b128 v10, v[148:151] offset:1024
  ds_write_b128 v10, v[152:155] offset:2048
  ds_write_b128 v10, v[156:159] offset:3072
  ds_write_b128 v10, v[160:163] offset:4096
  ds_write_b128 v10, v[164:167] offset:5120
  ds_write_b128 v10, v[168:171] offset:6144
  ds_write_b128 v10, v[172:175] offset:7168
  s_cmp_lg_u32 s20, 0
  s_cbranch_scc1 pvq_296
  v_readfirstlane_b32 s21, v29
  s_mov_b32 s23, -1
  v_mov_b32 v213, s23
  s_mov_b64 exec, 1
  ds_write_b32 v30, v29
  ds_write_b32 v30, v213 offset:8
  s_mov_b64 exec, -1
pvq_296:
  s_waitcnt lgkmcnt(0)
  s_barrier
  ds_read_b128 v[176:179], v11 offset:0
  ds_read_b128 v[180:183], v11 offset:8192
  ds_read_b128 v[184:187], v11 offset:16384
  ds_read_b128 v[188:191], v11 offset:24576
  ds_read_b128 v[192:195], v11 offset:4096
  ds_read_b128 v[196:199], v11 offset:12288
  ds_read_b128 v[200:203], v11 offset:20480
  ds_read_b128 v[204:207], v11 offset:28672
  ds_read_b32 v23, v30
  ds_read_b32 v213, v30 offset:8
  s_cmp_ge_u32 s40, 32
  s_cbranch_scc1 pvr_299
  s_waitcnt lgkmcnt(6)
  v_pk_add_f32 v[176:177], v[176:177], v[180:181]
  v_pk_add_f32 v[184:185], v[184:185], v[188:189]
  v_pk_add_f32 v[178:179], v[178:179], v[182:183]
  v_pk_add_f32 v[186:187], v[186:187], v[190:191]
  v_pk_add_f32 v[176:177], v[176:177], v[184:185]
  v_pk_add_f32 v[178:179], v[178:179], v[186:187]
  buffer_store_dwordx4 v[176:179], v4, s[24:27], s54 offen offset:0 sc1
  s_waitcnt lgkmcnt(2)
  v_pk_add_f32 v[192:193], v[192:193], v[196:197]
  v_pk_add_f32 v[200:201], v[200:201], v[204:205]
  v_pk_add_f32 v[194:195], v[194:195], v[198:199]
  v_pk_add_f32 v[202:203], v[202:203], v[206:207]
  v_pk_add_f32 v[192:193], v[192:193], v[200:201]
  v_pk_add_f32 v[194:195], v[194:195], v[202:203]
  buffer_store_dwordx4 v[192:195], v4, s[24:27], s54 offen offset:2048 sc1
  s_lshr_b32 s71, s40, 2
  s_lshl_b32 s71, s71, 7
  s_add_u32 s71, s71, 104448
  s_branch pvr_300
pvr_299:
  s_waitcnt lgkmcnt(6)
  v_pk_add_f32 v[176:177], v[176:177], v[180:181]
  v_pk_add_f32 v[184:185], v[184:185], v[188:189]
  v_pk_add_f32 v[178:179], v[178:179], v[182:183]
  v_pk_add_f32 v[186:187], v[186:187], v[190:191]
  v_pk_add_f32 v[176:177], v[176:177], v[184:185]
  v_pk_add_f32 v[178:179], v[178:179], v[186:187]
  v_cvt_pk_bf16_f32 v26, v176, v177
  v_lshlrev_b32 v176, 16, v26
  v_and_b32 v177, 0xffff0000, v26
  v_mul_f32 v176, v176, v24
  v_mul_f32 v177, v177, v24
  v_cvt_pk_bf16_f32 v26, v176, v177
  v_lshlrev_b32 v176, 16, v26
  v_and_b32 v177, 0xffff0000, v26
  v_add_f32 v176, v176, v12
  v_add_f32 v177, v177, v13
  v_cvt_pk_bf16_f32 v180, v176, v177
  v_cvt_pk_bf16_f32 v26, v178, v179
  v_lshlrev_b32 v178, 16, v26
  v_and_b32 v179, 0xffff0000, v26
  v_mul_f32 v178, v178, v24
  v_mul_f32 v179, v179, v24
  v_cvt_pk_bf16_f32 v26, v178, v179
  v_lshlrev_b32 v178, 16, v26
  v_and_b32 v179, 0xffff0000, v26
  v_add_f32 v178, v178, v14
  v_add_f32 v179, v179, v15
  v_cvt_pk_bf16_f32 v181, v178, v179
  buffer_store_dwordx2 v[180:181], v9, s[8:11], s46 offen offset:0
  s_waitcnt lgkmcnt(2)
  v_pk_add_f32 v[192:193], v[192:193], v[196:197]
  v_pk_add_f32 v[200:201], v[200:201], v[204:205]
  v_pk_add_f32 v[194:195], v[194:195], v[198:199]
  v_pk_add_f32 v[202:203], v[202:203], v[206:207]
  v_pk_add_f32 v[192:193], v[192:193], v[200:201]
  v_pk_add_f32 v[194:195], v[194:195], v[202:203]
  v_cvt_pk_bf16_f32 v26, v192, v193
  v_lshlrev_b32 v192, 16, v26
  v_and_b32 v193, 0xffff0000, v26
  v_mul_f32 v192, v192, v24
  v_mul_f32 v193, v193, v24
  v_cvt_pk_bf16_f32 v26, v192, v193
  v_lshlrev_b32 v192, 16, v26
  v_and_b32 v193, 0xffff0000, v26
  v_add_f32 v192, v192, v16
  v_add_f32 v193, v193, v17
  v_cvt_pk_bf16_f32 v196, v192, v193
  v_cvt_pk_bf16_f32 v26, v194, v195
  v_lshlrev_b32 v194, 16, v26
  v_and_b32 v195, 0xffff0000, v26
  v_mul_f32 v194, v194, v24
  v_mul_f32 v195, v195, v24
  v_cvt_pk_bf16_f32 v26, v194, v195
  v_lshlrev_b32 v194, 16, v26
  v_and_b32 v195, 0xffff0000, v26
  v_add_f32 v194, v194, v18
  v_add_f32 v195, v195, v19
  v_cvt_pk_bf16_f32 v197, v194, v195
  buffer_store_dwordx2 v[196:197], v9, s[8:11], s46 offen offset:64
pvr_300:
pvy_301:
  s_cmp_eq_u32 s65, 0
  s_cbranch_scc1 pvy_302
  s_sub_u32 s65, s65, 1
  s_add_u32 s46, s46, 128
  s_add_u32 s54, s54, 4096
  s_cmp_lt_u32 s40, 32
  s_cselect_b32 s70, 0x80000000, s54
  buffer_load_dwordx4 v[12:15], v4, s[24:27], s70 offen sc1
  buffer_load_dwordx4 v[16:19], v4, s[24:27], s70 offen offset:2048 sc1
  buffer_load_dword v24, v6, s[28:31], s45 offen sc1
  s_waitcnt vmcnt(37) lgkmcnt(0)
  s_barrier
  s_nop 1
  v_mfma_f32_16x16x32_bf16 v[144:147], v[32:35], v[128:131], 0
  v_mfma_f32_16x16x32_bf16 v[148:151], v[32:35], v[132:135], 0
  v_mfma_f32_16x16x32_bf16 v[152:155], v[36:39], v[128:131], 0
  v_mfma_f32_16x16x32_bf16 v[156:159], v[36:39], v[132:135], 0
  v_mfma_f32_16x16x32_bf16 v[160:163], v[40:43], v[128:131], 0
  v_mfma_f32_16x16x32_bf16 v[164:167], v[40:43], v[132:135], 0
  v_mfma_f32_16x16x32_bf16 v[168:171], v[44:47], v[128:131], 0
  v_mfma_f32_16x16x32_bf16 v[172:175], v[44:47], v[132:135], 0
  v_mfma_f32_16x16x32_bf16 v[144:147], v[48:51], v[136:139], v[144:147]
  v_mfma_f32_16x16x32_bf16 v[148:151], v[48:51], v[140:143], v[148:151]
  v_mfma_f32_16x16x32_bf16 v[152:155], v[52:55], v[136:139], v[152:155]
  v_mfma_f32_16x16x32_bf16 v[156:159], v[52:55], v[140:143], v[156:159]
  v_mfma_f32_16x16x32_bf16 v[160:163], v[56:59], v[136:139], v[160:163]
  v_mfma_f32_16x16x32_bf16 v[164:167], v[56:59], v[140:143], v[164:167]
  v_mfma_f32_16x16x32_bf16 v[168:171], v[60:63], v[136:139], v[168:171]
  v_mfma_f32_16x16x32_bf16 v[172:175], v[60:63], v[140:143], v[172:175]
  s_waitcnt vmcnt(33)
  v_mfma_f32_16x16x32_bf16 v[148:151], a[0:3], v[64:67], v[148:151]
  v_mfma_f32_16x16x32_bf16 v[144:147], a[0:3], v[68:71], v[144:147]
  v_mfma_f32_16x16x32_bf16 v[156:159], a[4:7], v[64:67], v[156:159]
  v_mfma_f32_16x16x32_bf16 v[152:155], a[4:7], v[68:71], v[152:155]
  v_mfma_f32_16x16x32_bf16 v[164:167], a[8:11], v[64:67], v[164:167]
  v_mfma_f32_16x16x32_bf16 v[160:163], a[8:11], v[68:71], v[160:163]
  v_mfma_f32_16x16x32_bf16 v[172:175], a[12:15], v[64:67], v[172:175]
  v_mfma_f32_16x16x32_bf16 v[168:171], a[12:15], v[68:71], v[168:171]
  s_waitcnt vmcnt(29)
  v_mfma_f32_16x16x32_bf16 v[148:151], a[16:19], v[72:75], v[148:151]
  v_mfma_f32_16x16x32_bf16 v[144:147], a[16:19], v[76:79], v[144:147]
  v_mfma_f32_16x16x32_bf16 v[156:159], a[20:23], v[72:75], v[156:159]
  v_mfma_f32_16x16x32_bf16 v[152:155], a[20:23], v[76:79], v[152:155]
  v_mfma_f32_16x16x32_bf16 v[164:167], a[24:27], v[72:75], v[164:167]
  v_mfma_f32_16x16x32_bf16 v[160:163], a[24:27], v[76:79], v[160:163]
  v_mfma_f32_16x16x32_bf16 v[172:175], a[28:31], v[72:75], v[172:175]
  v_mfma_f32_16x16x32_bf16 v[168:171], a[28:31], v[76:79], v[168:171]
  s_waitcnt vmcnt(25)
  v_mfma_f32_16x16x32_bf16 v[148:151], a[32:35], v[80:83], v[148:151]
  v_mfma_f32_16x16x32_bf16 v[144:147], a[32:35], v[84:87], v[144:147]
  v_mfma_f32_16x16x32_bf16 v[156:159], a[36:39], v[80:83], v[156:159]
  v_mfma_f32_16x16x32_bf16 v[152:155], a[36:39], v[84:87], v[152:155]
  v_mfma_f32_16x16x32_bf16 v[164:167], a[40:43], v[80:83], v[164:167]
  v_mfma_f32_16x16x32_bf16 v[160:163], a[40:43], v[84:87], v[160:163]
  v_mfma_f32_16x16x32_bf16 v[172:175], a[44:47], v[80:83], v[172:175]
  v_mfma_f32_16x16x32_bf16 v[168:171], a[44:47], v[84:87], v[168:171]
  s_waitcnt vmcnt(21)
  v_mfma_f32_16x16x32_bf16 v[148:151], a[48:51], v[88:91], v[148:151]
  v_mfma_f32_16x16x32_bf16 v[144:147], a[48:51], v[92:95], v[144:147]
  v_mfma_f32_16x16x32_bf16 v[156:159], a[52:55], v[88:91], v[156:159]
  v_mfma_f32_16x16x32_bf16 v[152:155], a[52:55], v[92:95], v[152:155]
  v_mfma_f32_16x16x32_bf16 v[164:167], a[56:59], v[88:91], v[164:167]
  v_mfma_f32_16x16x32_bf16 v[160:163], a[56:59], v[92:95], v[160:163]
  v_mfma_f32_16x16x32_bf16 v[172:175], a[60:63], v[88:91], v[172:175]
  v_mfma_f32_16x16x32_bf16 v[168:171], a[60:63], v[92:95], v[168:171]
  s_waitcnt vmcnt(17)
  v_mfma_f32_16x16x32_bf16 v[148:151], a[64:67], v[96:99], v[148:151]
  v_mfma_f32_16x16x32_bf16 v[144:147], a[64:67], v[100:103], v[144:147]
  v_mfma_f32_16x16x32_bf16 v[156:159], a[68:71], v[96:99], v[156:159]
  v_mfma_f32_16x16x32_bf16 v[152:155], a[68:71], v[100:103], v[152:155]
  v_mfma_f32_16x16x32_bf16 v[164:167], a[72:75], v[96:99], v[164:167]
  v_mfma_f32_16x16x32_bf16 v[160:163], a[72:75], v[100:103], v[160:163]
  v_mfma_f32_16x16x32_bf16 v[172:175], a[76:79], v[96:99], v[172:175]
  v_mfma_f32_16x16x32_bf16 v[168:171], a[76:79], v[100:103], v[168:171]
  s_waitcnt vmcnt(13)
  v_mfma_f32_16x16x32_bf16 v[148:151], a[80:83], v[104:107], v[148:151]
  v_mfma_f32_16x16x32_bf16 v[144:147], a[80:83], v[108:111], v[144:147]
  v_mfma_f32_16x16x32_bf16 v[156:159], a[84:87], v[104:107], v[156:159]
  v_mfma_f32_16x16x32_bf16 v[152:155], a[84:87], v[108:111], v[152:155]
  v_mfma_f32_16x16x32_bf16 v[164:167], a[88:91], v[104:107], v[164:167]
  v_mfma_f32_16x16x32_bf16 v[160:163], a[88:91], v[108:111], v[160:163]
  v_mfma_f32_16x16x32_bf16 v[172:175], a[92:95], v[104:107], v[172:175]
  v_mfma_f32_16x16x32_bf16 v[168:171], a[92:95], v[108:111], v[168:171]
  s_waitcnt vmcnt(9)
  v_mfma_f32_16x16x32_bf16 v[148:151], a[96:99], v[112:115], v[148:151]
  v_mfma_f32_16x16x32_bf16 v[144:147], a[96:99], v[116:119], v[144:147]
  v_mfma_f32_16x16x32_bf16 v[156:159], a[100:103], v[112:115], v[156:159]
  v_mfma_f32_16x16x32_bf16 v[152:155], a[100:103], v[116:119], v[152:155]
  v_mfma_f32_16x16x32_bf16 v[164:167], a[104:107], v[112:115], v[164:167]
  v_mfma_f32_16x16x32_bf16 v[160:163], a[104:107], v[116:119], v[160:163]
  v_mfma_f32_16x16x32_bf16 v[172:175], a[108:111], v[112:115], v[172:175]
  v_mfma_f32_16x16x32_bf16 v[168:171], a[108:111], v[116:119], v[168:171]
  s_waitcnt vmcnt(5)
  v_mfma_f32_16x16x32_bf16 v[148:151], a[112:115], v[120:123], v[148:151]
  v_mfma_f32_16x16x32_bf16 v[144:147], a[112:115], v[124:127], v[144:147]
  v_mfma_f32_16x16x32_bf16 v[156:159], a[116:119], v[120:123], v[156:159]
  v_mfma_f32_16x16x32_bf16 v[152:155], a[116:119], v[124:127], v[152:155]
  v_mfma_f32_16x16x32_bf16 v[164:167], a[120:123], v[120:123], v[164:167]
  v_mfma_f32_16x16x32_bf16 v[160:163], a[120:123], v[124:127], v[160:163]
  v_mfma_f32_16x16x32_bf16 v[172:175], a[124:127], v[120:123], v[172:175]
  v_mfma_f32_16x16x32_bf16 v[168:171], a[124:127], v[124:127], v[168:171]
  s_waitcnt vmcnt(0)
  v_sub_f32 v25, 1.0, v24
  v_cvt_pk_bf16_f32 v26, v25, v25
  v_lshlrev_b32 v25, 16, v26
  v_cvt_pk_bf16_f32 v26, v12, v12
  v_lshlrev_b32 v12, 16, v26
  v_cvt_pk_bf16_f32 v26, v13, v13
  v_lshlrev_b32 v13, 16, v26
  v_cvt_pk_bf16_f32 v26, v14, v14
  v_lshlrev_b32 v14, 16, v26
  v_cvt_pk_bf16_f32 v26, v15, v15
  v_lshlrev_b32 v15, 16, v26
  v_cvt_pk_bf16_f32 v26, v16, v16
  v_lshlrev_b32 v16, 16, v26
  v_cvt_pk_bf16_f32 v26, v17, v17
  v_lshlrev_b32 v17, 16, v26
  v_cvt_pk_bf16_f32 v26, v18, v18
  v_lshlrev_b32 v18, 16, v26
  v_cvt_pk_bf16_f32 v26, v19, v19
  v_lshlrev_b32 v19, 16, v26
  v_mul_f32 v12, v12, v25
  v_cvt_pk_bf16_f32 v26, v12, v12
  v_lshlrev_b32 v12, 16, v26
  v_mul_f32 v13, v13, v25
  v_cvt_pk_bf16_f32 v26, v13, v13
  v_lshlrev_b32 v13, 16, v26
  v_mul_f32 v14, v14, v25
  v_cvt_pk_bf16_f32 v26, v14, v14
  v_lshlrev_b32 v14, 16, v26
  v_mul_f32 v15, v15, v25
  v_cvt_pk_bf16_f32 v26, v15, v15
  v_lshlrev_b32 v15, 16, v26
  v_mul_f32 v16, v16, v25
  v_cvt_pk_bf16_f32 v26, v16, v16
  v_lshlrev_b32 v16, 16, v26
  v_mul_f32 v17, v17, v25
  v_cvt_pk_bf16_f32 v26, v17, v17
  v_lshlrev_b32 v17, 16, v26
  v_mul_f32 v18, v18, v25
  v_cvt_pk_bf16_f32 v26, v18, v18
  v_lshlrev_b32 v18, 16, v26
  v_mul_f32 v19, v19, v25
  v_cvt_pk_bf16_f32 v26, v19, v19
  v_lshlrev_b32 v19, 16, v26
  s_cmp_eq_u32 s65, 0
  s_cbranch_scc1 pvx_303
  s_add_u32 s41, s41, 1
  s_mul_i32 s53, s42, 40960
  s_lshl_b32 s22, s41, 12
  s_add_u32 s53, s53, s22
  s_mul_i32 s48, s42, 10240
  s_lshl_b32 s22, s41, 10
  s_add_u32 s48, s48, s22
  s_add_u32 s48, s48, 7340032
  buffer_load_dwordx4 v[32:35], v22, s[16:19], s48 offen offset:0 sc1
  buffer_load_dwordx4 v[36:39], v22, s[16:19], s48 offen offset:256 sc1
  buffer_load_dwordx4 v[40:43], v22, s[16:19], s48 offen offset:512 sc1
  buffer_load_dwordx4 v[44:47], v22, s[16:19], s48 offen offset:768 sc1
  s_add_u32 s48, s48, 40960
  buffer_load_dwordx4 v[48:51], v22, s[16:19], s48 offen offset:0 sc1
  buffer_load_dwordx4 v[52:55], v22, s[16:19], s48 offen offset:256 sc1
  buffer_load_dwordx4 v[56:59], v22, s[16:19], s48 offen offset:512 sc1
  buffer_load_dwordx4 v[60:63], v22, s[16:19], s48 offen offset:768 sc1
  s_add_u32 s48, s48, 40960
  buffer_load_dwordx4 a[0:3], v4, s[12:15], s53 offen offset:0 sc1
  buffer_load_dwordx4 a[4:7], v4, s[12:15], s53 offen offset:1024 sc1
  buffer_load_dwordx4 a[8:11], v4, s[12:15], s53 offen offset:2048 sc1
  buffer_load_dwordx4 a[12:15], v4, s[12:15], s53 offen offset:3072 sc1
  s_add_u32 s53, s53, 40960
  buffer_load_dwordx4 a[16:19], v4, s[12:15], s53 offen offset:0 sc1
  buffer_load_dwordx4 a[20:23], v4, s[12:15], s53 offen offset:1024 sc1
  buffer_load_dwordx4 a[24:27], v4, s[12:15], s53 offen offset:2048 sc1
  buffer_load_dwordx4 a[28:31], v4, s[12:15], s53 offen offset:3072 sc1
  s_add_u32 s53, s53, 40960
  buffer_load_dwordx4 a[32:35], v4, s[12:15], s53 offen offset:0 sc1
  buffer_load_dwordx4 a[36:39], v4, s[12:15], s53 offen offset:1024 sc1
  buffer_load_dwordx4 a[40:43], v4, s[12:15], s53 offen offset:2048 sc1
  buffer_load_dwordx4 a[44:47], v4, s[12:15], s53 offen offset:3072 sc1
  s_add_u32 s53, s53, 40960
  buffer_load_dwordx4 a[48:51], v4, s[12:15], s53 offen offset:0 sc1
  buffer_load_dwordx4 a[52:55], v4, s[12:15], s53 offen offset:1024 sc1
  buffer_load_dwordx4 a[56:59], v4, s[12:15], s53 offen offset:2048 sc1
  buffer_load_dwordx4 a[60:63], v4, s[12:15], s53 offen offset:3072 sc1
  s_add_u32 s53, s53, 40960
  buffer_load_dwordx4 a[64:67], v4, s[12:15], s53 offen offset:0 sc1
  buffer_load_dwordx4 a[68:71], v4, s[12:15], s53 offen offset:1024 sc1
  buffer_load_dwordx4 a[72:75], v4, s[12:15], s53 offen offset:2048 sc1
  buffer_load_dwordx4 a[76:79], v4, s[12:15], s53 offen offset:3072 sc1
  s_add_u32 s53, s53, 40960
  buffer_load_dwordx4 a[80:83], v4, s[12:15], s53 offen offset:0 sc1
  buffer_load_dwordx4 a[84:87], v4, s[12:15], s53 offen offset:1024 sc1
  buffer_load_dwordx4 a[88:91], v4, s[12:15], s53 offen offset:2048 sc1
  buffer_load_dwordx4 a[92:95], v4, s[12:15], s53 offen offset:3072 sc1
  s_add_u32 s53, s53, 40960
  buffer_load_dwordx4 a[96:99], v4, s[12:15], s53 offen offset:0 sc1
  buffer_load_dwordx4 a[100:103], v4, s[12:15], s53 offen offset:1024 sc1
  buffer_load_dwordx4 a[104:107], v4, s[12:15], s53 offen offset:2048 sc1
  buffer_load_dwordx4 a[108:111], v4, s[12:15], s53 offen offset:3072 sc1
  s_add_u32 s53, s53, 40960
  buffer_load_dwordx4 a[112:115], v4, s[12:15], s53 offen offset:0 sc1
  buffer_load_dwordx4 a[116:119], v4, s[12:15], s53 offen offset:1024 sc1
  buffer_load_dwordx4 a[120:123], v4, s[12:15], s53 offen offset:2048 sc1
  buffer_load_dwordx4 a[124:127], v4, s[12:15], s53 offen offset:3072 sc1
pvx_303:
  ds_write_b128 v10, v[144:147] offset:0
  ds_write_b128 v10, v[148:151] offset:1024
  ds_write_b128 v10, v[152:155] offset:2048
  ds_write_b128 v10, v[156:159] offset:3072
  ds_write_b128 v10, v[160:163] offset:4096
  ds_write_b128 v10, v[164:167] offset:5120
  ds_write_b128 v10, v[168:171] offset:6144
  ds_write_b128 v10, v[172:175] offset:7168
  s_waitcnt lgkmcnt(0)
  s_barrier
  ds_read_b128 v[176:179], v11 offset:0
  ds_read_b128 v[180:183], v11 offset:8192
  ds_read_b128 v[184:187], v11 offset:16384
  ds_read_b128 v[188:191], v11 offset:24576
  ds_read_b128 v[192:195], v11 offset:4096
  ds_read_b128 v[196:199], v11 offset:12288
  ds_read_b128 v[200:203], v11 offset:20480
  ds_read_b128 v[204:207], v11 offset:28672
  s_cmp_ge_u32 s40, 32
  s_cbranch_scc1 pvr_304
  s_waitcnt lgkmcnt(4)
  v_pk_add_f32 v[176:177], v[176:177], v[180:181]
  v_pk_add_f32 v[184:185], v[184:185], v[188:189]
  v_pk_add_f32 v[178:179], v[178:179], v[182:183]
  v_pk_add_f32 v[186:187], v[186:187], v[190:191]
  v_pk_add_f32 v[176:177], v[176:177], v[184:185]
  v_pk_add_f32 v[178:179], v[178:179], v[186:187]
  buffer_store_dwordx4 v[176:179], v4, s[24:27], s54 offen offset:0 sc1
  s_waitcnt lgkmcnt(0)
  v_pk_add_f32 v[192:193], v[192:193], v[196:197]
  v_pk_add_f32 v[200:201], v[200:201], v[204:205]
  v_pk_add_f32 v[194:195], v[194:195], v[198:199]
  v_pk_add_f32 v[202:203], v[202:203], v[206:207]
  v_pk_add_f32 v[192:193], v[192:193], v[200:201]
  v_pk_add_f32 v[194:195], v[194:195], v[202:203]
  buffer_store_dwordx4 v[192:195], v4, s[24:27], s54 offen offset:2048 sc1
  s_lshr_b32 s71, s40, 2
  s_lshl_b32 s71, s71, 7
  s_add_u32 s71, s71, 104448
  s_branch pvr_305
pvr_304:
  s_waitcnt lgkmcnt(4)
  v_pk_add_f32 v[176:177], v[176:177], v[180:181]
  v_pk_add_f32 v[184:185], v[184:185], v[188:189]
  v_pk_add_f32 v[178:179], v[178:179], v[182:183]
  v_pk_add_f32 v[186:187], v[186:187], v[190:191]
  v_pk_add_f32 v[176:177], v[176:177], v[184:185]
  v_pk_add_f32 v[178:179], v[178:179], v[186:187]
  v_cvt_pk_bf16_f32 v26, v176, v177
  v_lshlrev_b32 v176, 16, v26
  v_and_b32 v177, 0xffff0000, v26
  v_mul_f32 v176, v176, v24
  v_mul_f32 v177, v177, v24
  v_cvt_pk_bf16_f32 v26, v176, v177
  v_lshlrev_b32 v176, 16, v26
  v_and_b32 v177, 0xffff0000, v26
  v_add_f32 v176, v176, v12
  v_add_f32 v177, v177, v13
  v_cvt_pk_bf16_f32 v180, v176, v177
  v_cvt_pk_bf16_f32 v26, v178, v179
  v_lshlrev_b32 v178, 16, v26
  v_and_b32 v179, 0xffff0000, v26
  v_mul_f32 v178, v178, v24
  v_mul_f32 v179, v179, v24
  v_cvt_pk_bf16_f32 v26, v178, v179
  v_lshlrev_b32 v178, 16, v26
  v_and_b32 v179, 0xffff0000, v26
  v_add_f32 v178, v178, v14
  v_add_f32 v179, v179, v15
  v_cvt_pk_bf16_f32 v181, v178, v179
  buffer_store_dwordx2 v[180:181], v9, s[8:11], s46 offen offset:0
  s_waitcnt lgkmcnt(0)
  v_pk_add_f32 v[192:193], v[192:193], v[196:197]
  v_pk_add_f32 v[200:201], v[200:201], v[204:205]
  v_pk_add_f32 v[194:195], v[194:195], v[198:199]
  v_pk_add_f32 v[202:203], v[202:203], v[206:207]
  v_pk_add_f32 v[192:193], v[192:193], v[200:201]
  v_pk_add_f32 v[194:195], v[194:195], v[202:203]
  v_cvt_pk_bf16_f32 v26, v192, v193
  v_lshlrev_b32 v192, 16, v26
  v_and_b32 v193, 0xffff0000, v26
  v_mul_f32 v192, v192, v24
  v_mul_f32 v193, v193, v24
  v_cvt_pk_bf16_f32 v26, v192, v193
  v_lshlrev_b32 v192, 16, v26
  v_and_b32 v193, 0xffff0000, v26
  v_add_f32 v192, v192, v16
  v_add_f32 v193, v193, v17
  v_cvt_pk_bf16_f32 v196, v192, v193
  v_cvt_pk_bf16_f32 v26, v194, v195
  v_lshlrev_b32 v194, 16, v26
  v_and_b32 v195, 0xffff0000, v26
  v_mul_f32 v194, v194, v24
  v_mul_f32 v195, v195, v24
  v_cvt_pk_bf16_f32 v26, v194, v195
  v_lshlrev_b32 v194, 16, v26
  v_and_b32 v195, 0xffff0000, v26
  v_add_f32 v194, v194, v18
  v_add_f32 v195, v195, v19
  v_cvt_pk_bf16_f32 v197, v194, v195
  buffer_store_dwordx2 v[196:197], v9, s[8:11], s46 offen offset:64
pvr_305:
  s_branch pvy_301
pvy_302:
  s_sub_u32 s21, s2, 400
  s_cmp_ge_u32 s21, 240
  s_cbranch_scc1 lc_306
  s_cmp_lg_u32 s20, 0
  s_cbranch_scc1 lc_306x
  s_waitcnt vmcnt(2)
  s_mov_b64 exec, 1
  ds_write_b32 v30, v29 offset:12
  s_mov_b64 exec, -1
lc_306x:
  s_waitcnt lgkmcnt(0)
  s_barrier
  ds_read_b32 v23, v30 offset:12
lc_306:
  s_waitcnt lgkmcnt(0)
  v_readfirstlane_b32 s2, v23
  v_readfirstlane_b32 s67, v213
  s_barrier
  s_cmp_lt_u32 s2, 334
  s_cbranch_scc1 pae_307
  s_waitcnt vmcnt(0)
  s_cmp_eq_u32 s71, 0
  s_cbranch_scc1 paf_308
  v_mov_b32 v25, 0
  v_mov_b32 v26, 1
  s_mov_b64 exec, 1
  buffer_atomic_add v26, v25, s[72:75], s71 offen sc1
  s_mov_b64 exec, -1
  s_mov_b32 s71, 0
paf_308:
pae_307:
  s_add_u32 s21, s2, 0
  s_cmp_lt_u32 s2, 270
  s_cbranch_scc1 pv_loop
  s_sub_u32 s2, s2, 270
  s_add_u32 s21, s2, 310
  s_cmp_lt_u32 s2, 24
  s_cbranch_scc1 pv_loop
  s_sub_u32 s2, s2, 24
  s_add_u32 s21, s2, 270
  s_cmp_lt_u32 s2, 40
  s_cbranch_scc1 pv_loop
  s_sub_u32 s2, s2, 40
  s_branch main_fin
  s_branch queue
main_fin:
  s_waitcnt vmcnt(0)
main_end:
  s_endpgm
code_end:
.section .rodata,"a"
.p2align 6
.amdhsa_kernel gated_mix__memory_aug_recurrent_mem_tr__sliding_local_dilated__prompt_kernel
  .amdhsa_next_free_vgpr 512
  .amdhsa_next_free_sgpr 102
  .amdhsa_accum_offset 256
  .amdhsa_group_segment_fixed_size 0
  .amdhsa_kernarg_size 112
  .amdhsa_user_sgpr_count 2
  .amdhsa_user_sgpr_kernarg_segment_ptr 1
  .amdhsa_system_sgpr_workgroup_id_x 1
.end_amdhsa_kernel
.text
```

```asm
; @launch kernel=gated_mix__memory_aug_recurrent_mem_tr__sliding_local_dilated__prompt_kernel grid=(256,1,1) block=(256,1,1) lds=163840
.amdgcn_target "amdgcn-amd-amdhsa--gfx950"
.text
.globl gated_mix__memory_aug_recurrent_mem_tr__sliding_local_dilated__prompt_kernel
.p2align 8
.type gated_mix__memory_aug_recurrent_mem_tr__sliding_local_dilated__prompt_kernel,@function
gated_mix__memory_aug_recurrent_mem_tr__sliding_local_dilated__prompt_kernel:
  s_cmp_ge_u32 s2, 256
  s_cbranch_scc1 end0
  s_load_dwordx2 s[4:5], s[0:1], 96
  s_load_dwordx2 s[38:39], s[0:1], 104
  v_lshrrev_b32 v1, 6, v0
  v_and_b32 v2, 15, v0
  v_readfirstlane_b32 s20, v1
  v_and_b32 v1, 63, v0
  v_lshrrev_b32 v3, 4, v1
  s_getreg_b32 s50, hwreg(HW_REG_XCC_ID)
  s_and_b32 s50, s50, 7
  s_waitcnt lgkmcnt(0)
  s_mov_b32 s32, s4
  s_mov_b32 s33, s5
  s_mov_b32 s34, 256
  s_mov_b32 s35, 0x00020000
  s_getpc_b64 s[6:7]
cpf_pc:
  s_sub_u32 s6, s6, cpf_pc - gated_mix__memory_aug_recurrent_mem_tr__sliding_local_dilated__prompt_kernel
  s_subb_u32 s7, s7, 0
  s_lshr_b32 s21, s2, 3
  s_lshl_b32 s21, s21, 12
  v_lshl_add_u32 v28, v0, 4, s21
  v_min_u32 v28, code_end - gated_mix__memory_aug_recurrent_mem_tr__sliding_local_dilated__prompt_kernel - 16, v28
  global_load_dwordx4 a[252:255], v28, s[6:7]
  v_mov_b32 v21, 0
  s_cmp_lg_u32 s20, 0
  s_cbranch_scc1 rk_1
  s_and_b32 s21, s50, 1
  s_lshl_b32 s21, s21, 7
  s_lshl_b32 s22, s50, 1
  s_and_b32 s22, s22, 12
  s_add_u32 s21, s21, s22
  v_mov_b32 v22, s21
  v_mov_b32 v23, 1
  s_mov_b64 exec, 1
  buffer_atomic_add v23, v22, s[32:35], 0 offen sc0 sc1
  s_waitcnt vmcnt(0)
  v_readfirstlane_b32 s51, v23
  s_lshl_b32 s22, s50, 5
  s_add_u32 s22, s22, s51
  s_cmp_lt_u32 s51, 32
  s_cbranch_scc1 rk_2
  v_mov_b32 v24, 72
  v_mov_b32 v25, 1
  buffer_atomic_add v25, v24, s[32:35], 0 offen sc0 sc1
  s_waitcnt vmcnt(0)
  v_readfirstlane_b32 s23, v25
  s_mov_b32 s101, 0
  s_mov_b64 exec, -1
  v_lshlrev_b32 v24, 2, v1
rk_3:
  s_sleep 8
  buffer_load_dword v25, v24, s[32:35], 0 offen sc1
  s_add_u32 s101, s101, 1
  s_cmp_gt_u32 s101, 131072
  s_cbranch_scc1 end0
  s_waitcnt vmcnt(0)
  v_readlane_b32 s21, v25, 0
  v_readlane_b32 s22, v25, 32
  s_add_u32 s21, s21, s22
  v_readlane_b32 s22, v25, 1
  s_add_u32 s21, s21, s22
  v_readlane_b32 s22, v25, 33
  s_add_u32 s21, s21, s22
  v_readlane_b32 s22, v25, 2
  s_add_u32 s21, s21, s22
  v_readlane_b32 s22, v25, 34
  s_add_u32 s21, s21, s22
  v_readlane_b32 s22, v25, 3
  s_add_u32 s21, s21, s22
  v_readlane_b32 s22, v25, 35
  s_add_u32 s21, s21, s22
  s_cmp_lt_u32 s21, 256
  s_cbranch_scc1 rk_3
  s_mov_b64 exec, 1
  s_mov_b32 s24, 0
rk_5:
  s_and_b32 s21, s24, 1
  s_lshl_b32 s21, s21, 5
  s_lshr_b32 s22, s24, 1
  s_add_u32 s21, s21, s22
  v_readlane_b32 s21, v25, s21
  s_min_u32 s21, s21, 32
  s_sub_u32 s25, 32, s21
  s_cmp_lt_u32 s23, s25
  s_cbranch_scc1 rk_4
  s_sub_u32 s23, s23, s25
  s_add_u32 s24, s24, 1
  s_cmp_lt_u32 s24, 8
  s_cbranch_scc1 rk_5
  s_branch end0
rk_4:
  s_lshl_b32 s22, s24, 5
  s_add_u32 s22, s22, s21
  s_add_u32 s22, s22, s23
  s_or_b32 s22, s22, 0x100
rk_2:
  v_mov_b32 v23, s22
  ds_write_b32 v21, v23
  s_waitcnt lgkmcnt(0)
  s_mov_b64 exec, -1
rk_1:
  s_barrier
  ds_read_b32 v23, v21
  s_waitcnt lgkmcnt(0)
  v_readfirstlane_b32 s22, v23
  s_barrier
  s_mov_b32 s84, 0
  s_mov_b32 s85, -1

  s_lshr_b32 s53, s22, 8
  s_and_b32 s22, s22, 255
  s_cmp_ge_u32 s22, 128
  s_cbranch_scc1 gemm_side
  s_lshr_b32 s50, s22, 4
  s_and_b32 s51, s22, 15
  s_mov_b32 s86, 0x3dd53b95
  s_load_dwordx2 s[4:5], s[0:1], 8
  s_load_dwordx4 s[36:39], s[0:1], 16
  s_load_dwordx4 s[40:43], s[0:1], 32
  s_load_dwordx2 s[44:45], s[0:1], 104
  s_lshr_b32 s55, s51, 2
  s_and_b32 s56, s51, 3
  s_lshl_b32 s57, s50, 2
  s_add_u32 s58, s57, s55
  s_add_u32 s59, s57, s20
  s_lshr_b32 s21, s51, 1
  s_xor_b32 s21, s21, s55
  s_andn2_b32 s21, 1, s21
  s_xor_b32 s85, s51, s21
  s_xor_b32 s84, s56, 1
  s_mul_i32 s87, s85, 5
  s_lshr_b32 s87, s87, 1
  s_and_b32 s79, s85, 1
  s_waitcnt lgkmcnt(0)
  s_add_u32 s8, s44, 78643200
  s_addc_u32 s9, s45, 0
  s_mov_b32 s10, 2162688
  s_mov_b32 s11, 0x00020000
  s_mov_b32 s16, s44
  s_mov_b32 s17, s45
  s_mov_b32 s18, 50331648
  s_mov_b32 s19, 0x00020000
  s_add_u32 s24, s44, 50331648
  s_addc_u32 s25, s45, 0
  s_mov_b32 s26, 72351744
  s_mov_b32 s27, 0x00020000
  s_mov_b32 s28, s4
  s_mov_b32 s29, s5
  s_mov_b32 s30, 10240
  s_mov_b32 s31, 0x00020000
  s_add_u32 s4, s44, 83886079
  s_addc_u32 s5, s45, 0
  s_and_b32 s4, s4, 0xffe00000
  s_mov_b32 s6, 2097152
  s_mov_b32 s7, 0x00020000
  v_mov_b32 v27, 10923
  v_add_u32 v103, 0, v1
  v_mul_u32_u24 v102, v103, v27
  v_lshrrev_b32 v102, 16, v102
  v_mul_u32_u24 v101, 6, v102
  v_sub_u32 v103, v103, v101
  v_bfe_u32 v101, v102, 1, 1
  v_mul_u32_u24 v101, 20, v101
  v_and_b32 v100, 1, v102
  v_add_u32 v101, v101, v100
  v_lshrrev_b32 v100, 3, v102
  v_mul_u32_u24 v100, 40, v100
  v_bfe_u32 v99, v102, 2, 1
  v_lshl_add_u32 v100, v99, 1, v100
  v_add_u32 v100, v100, v101
  v_mul_u32_u24 v100, 12288, v100
  v_lshl_add_u32 v46, v103, 4, v100
  v_lshrrev_b32 v100, 4, v102
  v_mul_u32_u24 v100, 40, v100
  v_bfe_u32 v99, v102, 2, 2
  v_lshl_add_u32 v100, v99, 1, v100
  v_add_u32 v100, v100, v101
  v_mul_u32_u24 v100, 12288, v100
  v_lshl_add_u32 v96, v103, 4, v100
  v_add_u32 v103, 64, v1
  v_mul_u32_u24 v102, v103, v27
  v_lshrrev_b32 v102, 16, v102
  v_mul_u32_u24 v101, 6, v102
  v_sub_u32 v103, v103, v101
  v_bfe_u32 v101, v102, 1, 1
  v_mul_u32_u24 v101, 20, v101
  v_and_b32 v100, 1, v102
  v_add_u32 v101, v101, v100
  v_lshrrev_b32 v100, 3, v102
  v_mul_u32_u24 v100, 40, v100
  v_bfe_u32 v99, v102, 2, 1
  v_lshl_add_u32 v100, v99, 1, v100
  v_add_u32 v100, v100, v101
  v_mul_u32_u24 v100, 12288, v100
  v_lshl_add_u32 v47, v103, 4, v100
  v_lshrrev_b32 v100, 4, v102
  v_mul_u32_u24 v100, 40, v100
  v_bfe_u32 v99, v102, 2, 2
  v_lshl_add_u32 v100, v99, 1, v100
  v_add_u32 v100, v100, v101
  v_mul_u32_u24 v100, 12288, v100
  v_lshl_add_u32 v97, v103, 4, v100
  v_add_u32 v103, 128, v1
  v_mul_u32_u24 v102, v103, v27
  v_lshrrev_b32 v102, 16, v102
  v_mul_u32_u24 v101, 6, v102
  v_sub_u32 v103, v103, v101
  v_bfe_u32 v101, v102, 1, 1
  v_mul_u32_u24 v101, 20, v101
  v_and_b32 v100, 1, v102
  v_add_u32 v101, v101, v100
  v_lshrrev_b32 v100, 3, v102
  v_mul_u32_u24 v100, 40, v100
  v_bfe_u32 v99, v102, 2, 1
  v_lshl_add_u32 v100, v99, 1, v100
  v_add_u32 v100, v100, v101
  v_mul_u32_u24 v100, 12288, v100
  v_lshl_add_u32 v48, v103, 4, v100
  v_lshrrev_b32 v100, 4, v102
  v_mul_u32_u24 v100, 40, v100
  v_bfe_u32 v99, v102, 2, 2
  v_lshl_add_u32 v100, v99, 1, v100
  v_add_u32 v100, v100, v101
  v_mul_u32_u24 v100, 12288, v100
  v_lshl_add_u32 v98, v103, 4, v100
  s_mul_i32 s80, s58, 384
  s_mul_i32 s22, s56, 96
  s_add_u32 s80, s80, s22
  s_mul_i32 s22, s20, 1966080
  s_add_u32 s80, s80, s22
  s_mul_i32 s88, s84, 96
  s_mul_i32 s21, s56, 96
  s_sub_u32 s88, s88, s21
  s_add_u32 s88, s88, s80
  s_mul_i32 s81, s20, 40448

  s_mul_i32 s82, s59, 245760
  s_lshl_b32 s22, s87, 5
  s_add_u32 s82, s82, s22
  s_mov_b32 s12, s38
  s_mov_b32 s13, s39
  s_mov_b32 s14, 7864320
  s_mov_b32 s15, 0x00020000
  s_add_u32 s21, s80, 0
  s_add_u32 s22, s81, 0
  s_add_u32 m0, s22, 0
  s_nop 0
  buffer_load_dwordx4 v96, s[12:15], s21 offen lds
  s_add_u32 m0, s22, 1024
  s_nop 0
  buffer_load_dwordx4 v97, s[12:15], s21 offen lds
  s_add_u32 m0, s22, 2048
  s_nop 0
  buffer_load_dwordx4 v98, s[12:15], s21 offen lds
  s_add_u32 s21, s80, 983040
  s_add_u32 s22, s81, 3072
  s_add_u32 m0, s22, 0
  s_nop 0
  buffer_load_dwordx4 v96, s[12:15], s21 offen lds
  s_add_u32 m0, s22, 1024
  s_nop 0
  buffer_load_dwordx4 v97, s[12:15], s21 offen lds
  s_add_u32 m0, s22, 2048
  s_nop 0
  buffer_load_dwordx4 v98, s[12:15], s21 offen lds
  s_add_u32 s21, s80, 98304
  s_add_u32 s22, s81, 6144
  s_add_u32 m0, s22, 0
  s_nop 0
  buffer_load_dwordx4 v96, s[12:15], s21 offen lds
  s_add_u32 m0, s22, 1024
  s_nop 0
  buffer_load_dwordx4 v97, s[12:15], s21 offen lds
  s_add_u32 m0, s22, 2048
  s_nop 0
  buffer_load_dwordx4 v98, s[12:15], s21 offen lds
  s_add_u32 s21, s80, 1081344
  s_add_u32 s22, s81, 9216
  s_add_u32 m0, s22, 0
  s_nop 0
  buffer_load_dwordx4 v96, s[12:15], s21 offen lds
  s_add_u32 m0, s22, 1024
  s_nop 0
  buffer_load_dwordx4 v97, s[12:15], s21 offen lds
  s_add_u32 m0, s22, 2048
  s_nop 0
  buffer_load_dwordx4 v98, s[12:15], s21 offen lds
  s_add_u32 s21, s80, 196608
  s_add_u32 s22, s81, 12288
  s_add_u32 m0, s22, 0
  s_nop 0
  buffer_load_dwordx4 v46, s[12:15], s21 offen lds
  s_add_u32 m0, s22, 1024
  s_nop 0
  buffer_load_dwordx4 v47, s[12:15], s21 offen lds
  s_add_u32 m0, s22, 2048
  s_nop 0
  buffer_load_dwordx4 v48, s[12:15], s21 offen lds
  s_mov_b32 s12, s40
  s_mov_b32 s13, s41
  s_mov_b32 s14, 7864320
  s_mov_b32 s15, 0x00020000
  s_add_u32 s21, s88, 0
  s_add_u32 s22, s81, 0
  buffer_load_dwordx4 v[128:131], v96, s[12:15], s21 offen
  buffer_load_dwordx4 v[132:135], v97, s[12:15], s21 offen
  buffer_load_dwordx4 v[136:139], v98, s[12:15], s21 offen
  s_add_u32 s21, s88, 983040
  s_add_u32 s22, s81, 3072
  buffer_load_dwordx4 v[140:143], v96, s[12:15], s21 offen
  buffer_load_dwordx4 v[144:147], v97, s[12:15], s21 offen
  buffer_load_dwordx4 v[148:151], v98, s[12:15], s21 offen
  s_add_u32 s21, s88, 98304
  s_add_u32 s22, s81, 6144
  buffer_load_dwordx4 v[152:155], v96, s[12:15], s21 offen
  buffer_load_dwordx4 v[156:159], v97, s[12:15], s21 offen
  buffer_load_dwordx4 v[160:163], v98, s[12:15], s21 offen
  s_add_u32 s21, s88, 1081344
  s_add_u32 s22, s81, 9216
  buffer_load_dwordx4 v[164:167], v96, s[12:15], s21 offen
  buffer_load_dwordx4 v[168:171], v97, s[12:15], s21 offen
  buffer_load_dwordx4 v[172:175], v98, s[12:15], s21 offen
  s_add_u32 s21, s88, 196608
  s_add_u32 s22, s81, 12288
  buffer_load_dwordx4 v[176:179], v46, s[12:15], s21 offen
  buffer_load_dwordx4 v[180:183], v47, s[12:15], s21 offen
  buffer_load_dwordx4 v[184:187], v48, s[12:15], s21 offen
  v_lshrrev_b32 v99, 2, v2
  v_lshl_add_u32 v99, v3, 3, v99
  v_mul_u32_u24 v99, 96, v99
  v_and_b32 v100, 3, v2
  v_lshlrev_b32 v100, 3, v100
  v_add3_u32 v99, v99, v100, s81
  v_lshlrev_b32 v100, 4, v1
  v_add_u32 v100, s81, v100
  v_and_b32 v236, 7, v2
  v_lshrrev_b32 v237, 3, v2
  v_lshlrev_b32 v238, 7, v3
  v_lshl_add_u32 v238, v236, 4, v238
  v_lshlrev_b32 v16, 4, v1
  v_mul_u32_u24 v244, 1280, v236
  s_mul_i32 s21, s20, 320
  v_add_u32 v244, s21, v244
  v_lshrrev_b32 v245, 3, v1
  v_mul_u32_u24 v245, 40, v245
  v_add_u32 v244, v244, v245
  s_lshr_b32 s21, s20, 1
  s_lshl_b32 s21, s21, 14
  s_and_b32 s22, s20, 1
  s_mul_i32 s22, s22, 3072
  s_add_u32 s21, s21, s22
  v_add_u32 v4, s21, v16
  v_mov_b32 v239, 0x4444
  v_mov_b32 v240, 0xeeee
  v_cmp_eq_u32 vcc, 1, v237
  s_nop 1
  v_cndmask_b32 v44, v239, v240, vcc
  v_cmp_gt_u32 vcc, 2, v3
  s_nop 1
  v_cndmask_b32 v89, 0, 1.0, vcc
  v_mul_u32_u24 v239, 40, v2
  v_lshl_add_u32 v239, v3, 3, v239
  s_mul_i32 s21, s20, 3200
  v_add_u32 v5, s21, v239
  v_lshrrev_b32 v239, 2, v1
  v_mul_u32_u24 v239, 40, v239
  v_and_b32 v240, 3, v1
  v_lshl_add_u32 v6, v240, 3, v239
  v_bfe_u32 v240, v1, 1, 1
  v_mul_u32_u24 v240, 6384, v240
  v_add_u32 v45, v6, v240
  s_lshl_b32 s21, s50, 4
  s_add_u32 s21, s21, s51
  s_lshl_b32 s21, s21, 9
  s_lshl_b32 s22, s20, 7
  s_add_u32 s21, s21, s22
  s_add_u32 s21, s21, 81920
  v_and_b32 v239, 1, v3
  v_lshlrev_b32 v239, 8, v239
  v_lshl_add_u32 v239, v236, 4, v239
  v_lshrrev_b32 v240, 1, v3
  v_lshl_add_u32 v239, v240, 3, v239
  v_add_u32 v7, s21, v239
  s_lshl_b32 s22, s58, 9
  s_lshl_b32 s23, s56, 7
  s_add_u32 s22, s22, s23
  s_add_u32 s22, s22, 376704
  v_lshlrev_b32 v239, 6, v3
  v_lshl_add_u32 v239, v236, 3, v239
  v_add_u32 v239, s22, v239
  s_cmp_eq_u32 s20, 2
  s_cselect_b64 vcc, -1, 0
  v_cndmask_b32 v7, v7, v239, vcc
  s_lshl_b32 s21, s59, 11
  s_add_u32 s21, s21, 81920
  v_add_u32 v8, s21, v16
  s_lshl_b32 s21, s59, 9
  s_add_u32 s21, s21, 376832
  v_lshl_add_u32 v9, v1, 3, s21
  s_mul_i32 s21, s59, 3072
  s_add_u32 s21, s21, 278528
  v_and_b32 v239, 0x39, v1
  v_bfe_u32 v240, v1, 1, 1
  v_lshl_or_b32 v239, v240, 2, v239
  v_bfe_u32 v240, v1, 2, 1
  v_lshl_or_b32 v239, v240, 1, v239
  v_lshl_add_u32 v10, v239, 4, s21
  s_cmp_eq_u32 s20, 3
  s_cselect_b32 s22, s84, s56
  s_mul_i32 s22, s22, 12
  v_add_u32 v239, s22, v3
  v_add3_u32 v240, 0, v239, v3
  v_lshrrev_b32 v241, 1, v240
  v_and_b32 v240, 1, v240
  v_lshlrev_b32 v240, 3, v240
  v_lshl_add_u32 v242, v241, 7, v240
  v_lshl_add_u32 v242, v236, 4, v242
  s_mul_i32 s21, s58, 3072
  v_add_u32 v21, s21, v242
  v_lshl_add_u32 v242, v241, 8, v240
  v_lshl_add_u32 v242, v2, 4, v242
  s_mul_i32 s21, s58, 12288
  s_and_b32 s22, s20, 1
  s_mul_i32 s22, s22, 6144
  s_add_u32 s21, s21, s22
  v_add_u32 v18, s21, v242
  v_add3_u32 v240, 1, v239, v3
  v_lshrrev_b32 v241, 1, v240
  v_and_b32 v240, 1, v240
  v_lshlrev_b32 v240, 3, v240
  v_lshl_add_u32 v242, v241, 7, v240
  v_lshl_add_u32 v242, v236, 4, v242
  s_mul_i32 s21, s58, 3072
  v_add_u32 v22, s21, v242
  v_lshl_add_u32 v242, v241, 8, v240
  v_lshl_add_u32 v242, v2, 4, v242
  s_mul_i32 s21, s58, 12288
  s_and_b32 s22, s20, 1
  s_mul_i32 s22, s22, 6144
  s_add_u32 s21, s21, s22
  v_add_u32 v19, s21, v242
  v_add_u32 v240, 8, v239
  v_lshrrev_b32 v241, 1, v240
  v_and_b32 v240, 1, v240
  v_lshlrev_b32 v240, 3, v240
  v_lshl_add_u32 v242, v241, 7, v240
  v_lshl_add_u32 v242, v236, 4, v242
  s_mul_i32 s21, s58, 3072
  v_add_u32 v23, s21, v242
  v_lshl_add_u32 v242, v241, 8, v240
  v_lshl_add_u32 v242, v2, 4, v242
  s_mul_i32 s21, s58, 12288
  s_and_b32 s22, s20, 1
  s_mul_i32 s22, s22, 6144
  s_add_u32 s21, s21, s22
  v_add_u32 v20, s21, v242
  v_cmp_eq_u32 vcc, 1, v237
  s_nop 1
  v_cndmask_b32 v25, v21, v22, vcc
  v_add_u32 v24, 278528, v25
  s_mul_i32 s21, s20, 3072
  s_add_u32 s21, s21, 22528
  v_add_u32 v11, s21, v16
  v_and_b32 v239, 3, v1
  s_lshl_b32 s21, s20, 2
  v_add_u32 v240, s21, v239
  v_cmp_eq_u32 vcc, 10, v240
  s_nop 1
  v_cndmask_b32 v240, v240, 7, vcc
  v_cmp_eq_u32 vcc, 3, v239
  v_lshrrev_b32 v241, 5, v1
  v_mul_u32_u24 v241, 10, v241
  v_cndmask_b32 v240, v240, 3, vcc
  s_lshl_b32 s21, s79, 2
  v_add3_u32 v240, v240, v241, s21
  v_lshrrev_b32 v241, 1, v240
  v_lshlrev_b32 v241, 8, v241
  v_and_b32 v240, 1, v240
  v_lshl_add_u32 v241, v240, 3, v241
  v_bfe_u32 v240, v1, 2, 3
  v_lshl_add_u32 v241, v240, 4, v241
  v_add_u32 v12, 22528, v241
  s_mov_b32 s21, 0x07060100
  s_cmp_eq_u32 s20, 1
  s_cselect_b32 s21, 0x07060302, s21
  s_cmp_eq_u32 s20, 2
  s_cselect_b32 s21, 0x07060c0c, s21
  v_mov_b32 v240, s21
  v_mov_b32 v241, 0x03020100
  v_cndmask_b32 v14, v241, v240, vcc
  s_lshr_b32 s21, s85, 3
  s_lshl_b32 s21, s21, 14
  s_bfe_u32 s22, s85, 0x10002
  s_mul_i32 s22, s22, 3072
  s_add_u32 s21, s21, s22
  s_and_b32 s22, s85, 3
  s_lshl_b32 s22, s22, 8
  s_add_u32 s21, s21, s22
  s_lshl_b32 s22, s20, 10
  s_add_u32 s22, s22, s21
  v_lshl_add_u32 v13, v1, 2, s22
  v_lshlrev_b32 v240, 10, v3
  v_lshl_add_u32 v240, v2, 4, v240
  v_add_u32 v240, s21, v240
  s_cmp_eq_u32 s20, 3
  s_cselect_b64 vcc, -1, 0
  v_cndmask_b32 v13, v13, v240, vcc
  s_mov_b32 s91, 0x3c000000
  v_and_b32 v240, 1, v3
  v_lshrrev_b32 v241, 1, v3
  v_lshl_add_u32 v240, v240, 1, v241
  v_lshlrev_b32 v240, 8, v240
  v_lshl_add_u32 v240, v2, 4, v240
  s_mul_i32 s21, s59, 10240
  s_lshl_b32 s22, s87, 8
  s_add_u32 s21, s21, s22
  v_add_u32 v15, s21, v240
  s_lshl_b32 s21, s79, 4
  s_lshl_b32 s76, -1, s21
  s_mov_b32 s77, 0xffff
  s_lshl_b32 s21, s79, 7
  v_or_b32 v17, s21, v16
  s_or_b32 s21, s21, 0xffffff7f
  v_and_b32 v26, s21, v16
  v_mov_b32 v243, 0
  s_mul_i32 s89, s59, 12288
  s_add_u32 s89, s89, 25165824
  v_cmp_gt_u32 s[60:61], 8, v2
  v_cmp_le_u32 s[62:63], 8, v2
  v_cmp_le_u32 s[72:73], 2, v3
  v_cmp_gt_u32 s[70:71], 48, v1
  s_nop 1
  s_and_b64 s[64:65], s[60:61], s[72:73]
  s_cmp_eq_u32 s20, 2
  s_cselect_b64 s[74:75], s[64:65], s[60:61]
  s_mul_i32 s89, s59, 12288
  s_add_u32 s89, s89, 25165824
  s_not_b64 s[48:49], s[72:73]
  v_mov_b32 v27, 10923
  v_mov_b32 v49, v100
  v_add_u32 v113, 576, v1
  v_mul_u32_u24 v103, v113, v27
  v_lshrrev_b32 v103, 16, v103
  v_mul_u32_u24 v102, 6, v103
  v_sub_u32 v113, v113, v102
  v_bfe_u32 v102, v103, 1, 1
  v_lshlrev_b32 v102, 3, v102
  v_and_b32 v127, 12, v103
  v_lshrrev_b32 v127, 1, v127
  v_and_b32 v103, 0xfffffff1, v103
  v_or3_b32 v103, v103, v102, v127
  v_mul_u32_u24 v102, 1366, v103
  v_lshrrev_b32 v102, 16, v102
  v_mul_u32_u24 v100, 48, v102
  v_sub_u32 v103, v103, v100
  v_cmp_gt_u32 vcc, 32, v103
  v_bfe_u32 v101, v103, 3, 2
  v_and_b32 v126, 3, v103
  v_lshl_add_u32 v126, v101, 2, v126
  v_bfe_u32 v101, v103, 2, 1
  v_lshl_add_u32 v126, v101, 4, v126
  v_cndmask_b32 v103, v103, v126, vcc
  v_add_u32 v100, v100, v103
  v_mul_u32_u24 v100, 1280, v100
  v_lshl_add_u32 v113, v113, 4, v100
  v_add_u32 v114, 640, v1
  v_mul_u32_u24 v103, v114, v27
  v_lshrrev_b32 v103, 16, v103
  v_mul_u32_u24 v102, 6, v103
  v_sub_u32 v114, v114, v102
  v_bfe_u32 v102, v103, 1, 1
  v_lshlrev_b32 v102, 3, v102
  v_and_b32 v127, 12, v103
  v_lshrrev_b32 v127, 1, v127
  v_and_b32 v103, 0xfffffff1, v103
  v_or3_b32 v103, v103, v102, v127
  v_mul_u32_u24 v102, 1366, v103
  v_lshrrev_b32 v102, 16, v102
  v_mul_u32_u24 v100, 48, v102
  v_sub_u32 v103, v103, v100
  v_cmp_gt_u32 vcc, 32, v103
  v_bfe_u32 v101, v103, 3, 2
  v_and_b32 v126, 3, v103
  v_lshl_add_u32 v126, v101, 2, v126
  v_bfe_u32 v101, v103, 2, 1
  v_lshl_add_u32 v126, v101, 4, v126
  v_cndmask_b32 v103, v103, v126, vcc
  v_add_u32 v100, v100, v103
  v_mul_u32_u24 v100, 1280, v100
  v_lshl_add_u32 v114, v114, 4, v100
  v_add_u32 v115, 704, v1
  v_mul_u32_u24 v103, v115, v27
  v_lshrrev_b32 v103, 16, v103
  v_mul_u32_u24 v102, 6, v103
  v_sub_u32 v115, v115, v102
  v_bfe_u32 v102, v103, 1, 1
  v_lshlrev_b32 v102, 3, v102
  v_and_b32 v127, 12, v103
  v_lshrrev_b32 v127, 1, v127
  v_and_b32 v103, 0xfffffff1, v103
  v_or3_b32 v103, v103, v102, v127
  v_mul_u32_u24 v102, 1366, v103
  v_lshrrev_b32 v102, 16, v102
  v_mul_u32_u24 v100, 48, v102
  v_sub_u32 v103, v103, v100
  v_cmp_gt_u32 vcc, 32, v103
  v_bfe_u32 v101, v103, 3, 2
  v_and_b32 v126, 3, v103
  v_lshl_add_u32 v126, v101, 2, v126
  v_bfe_u32 v101, v103, 2, 1
  v_lshl_add_u32 v126, v101, 4, v126
  v_cndmask_b32 v103, v103, v126, vcc
  v_add_u32 v100, v100, v103
  v_mul_u32_u24 v100, 1280, v100
  v_lshl_add_u32 v115, v115, 4, v100
  v_add_u32 v116, 768, v1
  v_mul_u32_u24 v103, v116, v27
  v_lshrrev_b32 v103, 16, v103
  v_mul_u32_u24 v102, 6, v103
  v_sub_u32 v116, v116, v102
  v_bfe_u32 v102, v103, 1, 1
  v_lshlrev_b32 v102, 3, v102
  v_and_b32 v127, 12, v103
  v_lshrrev_b32 v127, 1, v127
  v_and_b32 v103, 0xfffffff1, v103
  v_or3_b32 v103, v103, v102, v127
  v_mul_u32_u24 v102, 1366, v103
  v_lshrrev_b32 v102, 16, v102
  v_mul_u32_u24 v100, 48, v102
  v_sub_u32 v103, v103, v100
  v_cmp_gt_u32 vcc, 32, v103
  v_bfe_u32 v101, v103, 3, 2
  v_and_b32 v126, 3, v103
  v_lshl_add_u32 v126, v101, 2, v126
  v_bfe_u32 v101, v103, 2, 1
  v_lshl_add_u32 v126, v101, 4, v126
  v_cndmask_b32 v103, v103, v126, vcc
  v_add_u32 v100, v100, v103
  v_mul_u32_u24 v100, 1280, v100
  v_lshl_add_u32 v116, v116, 4, v100
  v_add_u32 v117, 832, v1
  v_mul_u32_u24 v103, v117, v27
  v_lshrrev_b32 v103, 16, v103
  v_mul_u32_u24 v102, 6, v103
  v_sub_u32 v117, v117, v102
  v_bfe_u32 v102, v103, 1, 1
  v_lshlrev_b32 v102, 3, v102
  v_and_b32 v127, 12, v103
  v_lshrrev_b32 v127, 1, v127
  v_and_b32 v103, 0xfffffff1, v103
  v_or3_b32 v103, v103, v102, v127
  v_mul_u32_u24 v102, 1366, v103
  v_lshrrev_b32 v102, 16, v102
  v_mul_u32_u24 v100, 48, v102
  v_sub_u32 v103, v103, v100
  v_cmp_gt_u32 vcc, 32, v103
  v_bfe_u32 v101, v103, 3, 2
  v_and_b32 v126, 3, v103
  v_lshl_add_u32 v126, v101, 2, v126
  v_bfe_u32 v101, v103, 2, 1
  v_lshl_add_u32 v126, v101, 4, v126
  v_cndmask_b32 v103, v103, v126, vcc
  v_add_u32 v100, v100, v103
  v_mul_u32_u24 v100, 1280, v100
  v_lshl_add_u32 v117, v117, 4, v100
  v_add_u32 v118, 896, v1
  v_mul_u32_u24 v103, v118, v27
  v_lshrrev_b32 v103, 16, v103
  v_mul_u32_u24 v102, 6, v103
  v_sub_u32 v118, v118, v102
  v_bfe_u32 v102, v103, 1, 1
  v_lshlrev_b32 v102, 3, v102
  v_and_b32 v127, 12, v103
  v_lshrrev_b32 v127, 1, v127
  v_and_b32 v103, 0xfffffff1, v103
  v_or3_b32 v103, v103, v102, v127
  v_mul_u32_u24 v102, 1366, v103
  v_lshrrev_b32 v102, 16, v102
  v_mul_u32_u24 v100, 48, v102
  v_sub_u32 v103, v103, v100
  v_cmp_gt_u32 vcc, 32, v103
  v_bfe_u32 v101, v103, 3, 2
  v_and_b32 v126, 3, v103
  v_lshl_add_u32 v126, v101, 2, v126
  v_bfe_u32 v101, v103, 2, 1
  v_lshl_add_u32 v126, v101, 4, v126
  v_cndmask_b32 v103, v103, v126, vcc
  v_add_u32 v100, v100, v103
  v_mul_u32_u24 v100, 1280, v100
  v_lshl_add_u32 v118, v118, 4, v100
  v_add_u32 v119, 960, v1
  v_mul_u32_u24 v103, v119, v27
  v_lshrrev_b32 v103, 16, v103
  v_mul_u32_u24 v102, 6, v103
  v_sub_u32 v119, v119, v102
  v_bfe_u32 v102, v103, 1, 1
  v_lshlrev_b32 v102, 3, v102
  v_and_b32 v127, 12, v103
  v_lshrrev_b32 v127, 1, v127
  v_and_b32 v103, 0xfffffff1, v103
  v_or3_b32 v103, v103, v102, v127
  v_mul_u32_u24 v102, 1366, v103
  v_lshrrev_b32 v102, 16, v102
  v_mul_u32_u24 v100, 48, v102
  v_sub_u32 v103, v103, v100
  v_cmp_gt_u32 vcc, 32, v103
  v_bfe_u32 v101, v103, 3, 2
  v_and_b32 v126, 3, v103
  v_lshl_add_u32 v126, v101, 2, v126
  v_bfe_u32 v101, v103, 2, 1
  v_lshl_add_u32 v126, v101, 4, v126
  v_cndmask_b32 v103, v103, v126, vcc
  v_add_u32 v100, v100, v103
  v_mul_u32_u24 v100, 1280, v100
  v_lshl_add_u32 v119, v119, 4, v100
  v_add_u32 v120, 1024, v1
  v_mul_u32_u24 v103, v120, v27
  v_lshrrev_b32 v103, 16, v103
  v_mul_u32_u24 v102, 6, v103
  v_sub_u32 v120, v120, v102
  v_bfe_u32 v102, v103, 1, 1
  v_lshlrev_b32 v102, 3, v102
  v_and_b32 v127, 12, v103
  v_lshrrev_b32 v127, 1, v127
  v_and_b32 v103, 0xfffffff1, v103
  v_or3_b32 v103, v103, v102, v127
  v_mul_u32_u24 v102, 1366, v103
  v_lshrrev_b32 v102, 16, v102
  v_mul_u32_u24 v100, 48, v102
  v_sub_u32 v103, v103, v100
  v_cmp_gt_u32 vcc, 32, v103
  v_bfe_u32 v101, v103, 3, 2
  v_and_b32 v126, 3, v103
  v_lshl_add_u32 v126, v101, 2, v126
  v_bfe_u32 v101, v103, 2, 1
  v_lshl_add_u32 v126, v101, 4, v126
  v_cndmask_b32 v103, v103, v126, vcc
  v_add_u32 v100, v100, v103
  v_mul_u32_u24 v100, 1280, v100
  v_lshl_add_u32 v120, v120, 4, v100
  v_add_u32 v121, 1088, v1
  v_mul_u32_u24 v103, v121, v27
  v_lshrrev_b32 v103, 16, v103
  v_mul_u32_u24 v102, 6, v103
  v_sub_u32 v121, v121, v102
  v_bfe_u32 v102, v103, 1, 1
  v_lshlrev_b32 v102, 3, v102
  v_and_b32 v127, 12, v103
  v_lshrrev_b32 v127, 1, v127
  v_and_b32 v103, 0xfffffff1, v103
  v_or3_b32 v103, v103, v102, v127
  v_mul_u32_u24 v102, 1366, v103
  v_lshrrev_b32 v102, 16, v102
  v_mul_u32_u24 v100, 48, v102
  v_sub_u32 v103, v103, v100
  v_cmp_gt_u32 vcc, 32, v103
  v_bfe_u32 v101, v103, 3, 2
  v_and_b32 v126, 3, v103
  v_lshl_add_u32 v126, v101, 2, v126
  v_bfe_u32 v101, v103, 2, 1
  v_lshl_add_u32 v126, v101, 4, v126
  v_cndmask_b32 v103, v103, v126, vcc
  v_add_u32 v100, v100, v103
  v_mul_u32_u24 v100, 1280, v100
  v_lshl_add_u32 v121, v121, 4, v100
  s_waitcnt vmcnt(63)
  s_mov_b32 s12, s42
  s_mov_b32 s13, s43
  s_mov_b32 s14, 7864320
  s_mov_b32 s15, 0x00020000
  buffer_load_dwordx4 v[188:191], v113, s[12:15], s82 offen
  buffer_load_dwordx4 v[192:195], v114, s[12:15], s82 offen
  buffer_load_dwordx4 v[196:199], v115, s[12:15], s82 offen
  buffer_load_dwordx4 v[200:203], v116, s[12:15], s82 offen
  buffer_load_dwordx4 v[204:207], v117, s[12:15], s82 offen
  buffer_load_dwordx4 v[208:211], v118, s[12:15], s82 offen
  buffer_load_dwordx4 v[212:215], v119, s[12:15], s82 offen
  buffer_load_dwordx4 v[216:219], v120, s[12:15], s82 offen
  buffer_load_dwordx4 v[220:223], v121, s[12:15], s82 offen
  v_add_u32 v104, 0, v1
  v_mul_u32_u24 v103, v104, v27
  v_lshrrev_b32 v103, 16, v103
  v_mul_u32_u24 v102, 6, v103
  v_sub_u32 v104, v104, v102
  v_bfe_u32 v102, v103, 1, 1
  v_lshlrev_b32 v102, 3, v102
  v_and_b32 v127, 12, v103
  v_lshrrev_b32 v127, 1, v127
  v_and_b32 v103, 0xfffffff1, v103
  v_or3_b32 v103, v103, v102, v127
  v_mul_u32_u24 v102, 1366, v103
  v_lshrrev_b32 v102, 16, v102
  v_mul_u32_u24 v100, 48, v102
  v_sub_u32 v103, v103, v100
  v_cmp_gt_u32 vcc, 32, v103
  v_bfe_u32 v101, v103, 3, 2
  v_and_b32 v126, 3, v103
  v_lshl_add_u32 v126, v101, 2, v126
  v_bfe_u32 v101, v103, 2, 1
  v_lshl_add_u32 v126, v101, 4, v126
  v_cndmask_b32 v103, v103, v126, vcc
  v_add_u32 v100, v100, v103
  v_mul_u32_u24 v100, 1280, v100
  v_lshl_add_u32 v104, v104, 4, v100
  v_add_u32 v105, 64, v1
  v_mul_u32_u24 v103, v105, v27
  v_lshrrev_b32 v103, 16, v103
  v_mul_u32_u24 v102, 6, v103
  v_sub_u32 v105, v105, v102
  v_bfe_u32 v102, v103, 1, 1
  v_lshlrev_b32 v102, 3, v102
  v_and_b32 v127, 12, v103
  v_lshrrev_b32 v127, 1, v127
  v_and_b32 v103, 0xfffffff1, v103
  v_or3_b32 v103, v103, v102, v127
  v_mul_u32_u24 v102, 1366, v103
  v_lshrrev_b32 v102, 16, v102
  v_mul_u32_u24 v100, 48, v102
  v_sub_u32 v103, v103, v100
  v_cmp_gt_u32 vcc, 32, v103
  v_bfe_u32 v101, v103, 3, 2
  v_and_b32 v126, 3, v103
  v_lshl_add_u32 v126, v101, 2, v126
  v_bfe_u32 v101, v103, 2, 1
  v_lshl_add_u32 v126, v101, 4, v126
  v_cndmask_b32 v103, v103, v126, vcc
  v_add_u32 v100, v100, v103
  v_mul_u32_u24 v100, 1280, v100
  v_lshl_add_u32 v105, v105, 4, v100
  v_add_u32 v106, 128, v1
  v_mul_u32_u24 v103, v106, v27
  v_lshrrev_b32 v103, 16, v103
  v_mul_u32_u24 v102, 6, v103
  v_sub_u32 v106, v106, v102
  v_bfe_u32 v102, v103, 1, 1
  v_lshlrev_b32 v102, 3, v102
  v_and_b32 v127, 12, v103
  v_lshrrev_b32 v127, 1, v127
  v_and_b32 v103, 0xfffffff1, v103
  v_or3_b32 v103, v103, v102, v127
  v_mul_u32_u24 v102, 1366, v103
  v_lshrrev_b32 v102, 16, v102
  v_mul_u32_u24 v100, 48, v102
  v_sub_u32 v103, v103, v100
  v_cmp_gt_u32 vcc, 32, v103
  v_bfe_u32 v101, v103, 3, 2
  v_and_b32 v126, 3, v103
  v_lshl_add_u32 v126, v101, 2, v126
  v_bfe_u32 v101, v103, 2, 1
  v_lshl_add_u32 v126, v101, 4, v126
  v_cndmask_b32 v103, v103, v126, vcc
  v_add_u32 v100, v100, v103
  v_mul_u32_u24 v100, 1280, v100
  v_lshl_add_u32 v106, v106, 4, v100
  v_add_u32 v107, 192, v1
  v_mul_u32_u24 v103, v107, v27
  v_lshrrev_b32 v103, 16, v103
  v_mul_u32_u24 v102, 6, v103
  v_sub_u32 v107, v107, v102
  v_bfe_u32 v102, v103, 1, 1
  v_lshlrev_b32 v102, 3, v102
  v_and_b32 v127, 12, v103
  v_lshrrev_b32 v127, 1, v127
  v_and_b32 v103, 0xfffffff1, v103
  v_or3_b32 v103, v103, v102, v127
  v_mul_u32_u24 v102, 1366, v103
  v_lshrrev_b32 v102, 16, v102
  v_mul_u32_u24 v100, 48, v102
  v_sub_u32 v103, v103, v100
  v_cmp_gt_u32 vcc, 32, v103
  v_bfe_u32 v101, v103, 3, 2
  v_and_b32 v126, 3, v103
  v_lshl_add_u32 v126, v101, 2, v126
  v_bfe_u32 v101, v103, 2, 1
  v_lshl_add_u32 v126, v101, 4, v126
  v_cndmask_b32 v103, v103, v126, vcc
  v_add_u32 v100, v100, v103
  v_mul_u32_u24 v100, 1280, v100
  v_lshl_add_u32 v107, v107, 4, v100
  v_add_u32 v108, 256, v1
  v_mul_u32_u24 v103, v108, v27
  v_lshrrev_b32 v103, 16, v103
  v_mul_u32_u24 v102, 6, v103
  v_sub_u32 v108, v108, v102
  v_bfe_u32 v102, v103, 1, 1
  v_lshlrev_b32 v102, 3, v102
  v_and_b32 v127, 12, v103
  v_lshrrev_b32 v127, 1, v127
  v_and_b32 v103, 0xfffffff1, v103
  v_or3_b32 v103, v103, v102, v127
  v_mul_u32_u24 v102, 1366, v103
  v_lshrrev_b32 v102, 16, v102
  v_mul_u32_u24 v100, 48, v102
  v_sub_u32 v103, v103, v100
  v_cmp_gt_u32 vcc, 32, v103
  v_bfe_u32 v101, v103, 3, 2
  v_and_b32 v126, 3, v103
  v_lshl_add_u32 v126, v101, 2, v126
  v_bfe_u32 v101, v103, 2, 1
  v_lshl_add_u32 v126, v101, 4, v126
  v_cndmask_b32 v103, v103, v126, vcc
  v_add_u32 v100, v100, v103
  v_mul_u32_u24 v100, 1280, v100
  v_lshl_add_u32 v108, v108, 4, v100
  v_add_u32 v109, 320, v1
  v_mul_u32_u24 v103, v109, v27
  v_lshrrev_b32 v103, 16, v103
  v_mul_u32_u24 v102, 6, v103
  v_sub_u32 v109, v109, v102
  v_bfe_u32 v102, v103, 1, 1
  v_lshlrev_b32 v102, 3, v102
  v_and_b32 v127, 12, v103
  v_lshrrev_b32 v127, 1, v127
  v_and_b32 v103, 0xfffffff1, v103
  v_or3_b32 v103, v103, v102, v127
  v_mul_u32_u24 v102, 1366, v103
  v_lshrrev_b32 v102, 16, v102
  v_mul_u32_u24 v100, 48, v102
  v_sub_u32 v103, v103, v100
  v_cmp_gt_u32 vcc, 32, v103
  v_bfe_u32 v101, v103, 3, 2
  v_and_b32 v126, 3, v103
  v_lshl_add_u32 v126, v101, 2, v126
  v_bfe_u32 v101, v103, 2, 1
  v_lshl_add_u32 v126, v101, 4, v126
  v_cndmask_b32 v103, v103, v126, vcc
  v_add_u32 v100, v100, v103
  v_mul_u32_u24 v100, 1280, v100
  v_lshl_add_u32 v109, v109, 4, v100
  v_add_u32 v110, 384, v1
  v_mul_u32_u24 v103, v110, v27
  v_lshrrev_b32 v103, 16, v103
  v_mul_u32_u24 v102, 6, v103
  v_sub_u32 v110, v110, v102
  v_bfe_u32 v102, v103, 1, 1
  v_lshlrev_b32 v102, 3, v102
  v_and_b32 v127, 12, v103
  v_lshrrev_b32 v127, 1, v127
  v_and_b32 v103, 0xfffffff1, v103
  v_or3_b32 v103, v103, v102, v127
  v_mul_u32_u24 v102, 1366, v103
  v_lshrrev_b32 v102, 16, v102
  v_mul_u32_u24 v100, 48, v102
  v_sub_u32 v103, v103, v100
  v_cmp_gt_u32 vcc, 32, v103
  v_bfe_u32 v101, v103, 3, 2
  v_and_b32 v126, 3, v103
  v_lshl_add_u32 v126, v101, 2, v126
  v_bfe_u32 v101, v103, 2, 1
  v_lshl_add_u32 v126, v101, 4, v126
  v_cndmask_b32 v103, v103, v126, vcc
  v_add_u32 v100, v100, v103
  v_mul_u32_u24 v100, 1280, v100
  v_lshl_add_u32 v110, v110, 4, v100
  v_add_u32 v111, 448, v1
  v_mul_u32_u24 v103, v111, v27
  v_lshrrev_b32 v103, 16, v103
  v_mul_u32_u24 v102, 6, v103
  v_sub_u32 v111, v111, v102
  v_bfe_u32 v102, v103, 1, 1
  v_lshlrev_b32 v102, 3, v102
  v_and_b32 v127, 12, v103
  v_lshrrev_b32 v127, 1, v127
  v_and_b32 v103, 0xfffffff1, v103
  v_or3_b32 v103, v103, v102, v127
  v_mul_u32_u24 v102, 1366, v103
  v_lshrrev_b32 v102, 16, v102
  v_mul_u32_u24 v100, 48, v102
  v_sub_u32 v103, v103, v100
  v_cmp_gt_u32 vcc, 32, v103
  v_bfe_u32 v101, v103, 3, 2
  v_and_b32 v126, 3, v103
  v_lshl_add_u32 v126, v101, 2, v126
  v_bfe_u32 v101, v103, 2, 1
  v_lshl_add_u32 v126, v101, 4, v126
  v_cndmask_b32 v103, v103, v126, vcc
  v_add_u32 v100, v100, v103
  v_mul_u32_u24 v100, 1280, v100
  v_lshl_add_u32 v111, v111, 4, v100
  v_add_u32 v112, 512, v1
  v_mul_u32_u24 v103, v112, v27
  v_lshrrev_b32 v103, 16, v103
  v_mul_u32_u24 v102, 6, v103
  v_sub_u32 v112, v112, v102
  v_bfe_u32 v102, v103, 1, 1
  v_lshlrev_b32 v102, 3, v102
  v_and_b32 v127, 12, v103
  v_lshrrev_b32 v127, 1, v127
  v_and_b32 v103, 0xfffffff1, v103
  v_or3_b32 v103, v103, v102, v127
  v_mul_u32_u24 v102, 1366, v103
  v_lshrrev_b32 v102, 16, v102
  v_mul_u32_u24 v100, 48, v102
  v_sub_u32 v103, v103, v100
  v_cmp_gt_u32 vcc, 32, v103
  v_bfe_u32 v101, v103, 3, 2
  v_and_b32 v126, 3, v103
  v_lshl_add_u32 v126, v101, 2, v126
  v_bfe_u32 v101, v103, 2, 1
  v_lshl_add_u32 v126, v101, 4, v126
  v_cndmask_b32 v103, v103, v126, vcc
  v_add_u32 v100, v100, v103
  v_mul_u32_u24 v100, 1280, v100
  v_lshl_add_u32 v112, v112, 4, v100
  s_waitcnt vmcnt(63)
  s_mov_b32 s12, s42
  s_mov_b32 s13, s43
  s_mov_b32 s14, 7864320
  s_mov_b32 s15, 0x00020000
  s_add_u32 m0, s81, 30720
  s_nop 0
  buffer_load_dwordx4 v104, s[12:15], s82 offen lds
  s_add_u32 m0, s81, 31744
  s_nop 0
  buffer_load_dwordx4 v105, s[12:15], s82 offen lds
  s_add_u32 m0, s81, 32768
  s_nop 0
  buffer_load_dwordx4 v106, s[12:15], s82 offen lds
  s_add_u32 m0, s81, 33792
  s_nop 0
  buffer_load_dwordx4 v107, s[12:15], s82 offen lds
  s_add_u32 m0, s81, 34816
  s_nop 0
  buffer_load_dwordx4 v108, s[12:15], s82 offen lds
  s_add_u32 m0, s81, 35840
  s_nop 0
  buffer_load_dwordx4 v109, s[12:15], s82 offen lds
  s_add_u32 m0, s81, 36864
  s_nop 0
  buffer_load_dwordx4 v110, s[12:15], s82 offen lds
  s_add_u32 m0, s81, 37888
  s_nop 0
  buffer_load_dwordx4 v111, s[12:15], s82 offen lds
  s_add_u32 m0, s81, 38912
  s_nop 0
  buffer_load_dwordx4 v112, s[12:15], s82 offen lds
  buffer_load_dwordx4 v[32:35], v244, s[28:31], 0 offen offset:0
  buffer_load_dwordx4 v[36:39], v244, s[28:31], 0 offen offset:16
  buffer_load_dwordx2 v[40:41], v244, s[28:31], 0 offen offset:32
  s_waitcnt vmcnt(63)
  s_mov_b32 s12, s36
  s_mov_b32 s13, s37
  s_mov_b32 s14, 7864320
  s_mov_b32 s15, 0x00020000
  s_add_u32 s21, s80, 0
  s_add_u32 s22, s81, 15360
  s_add_u32 m0, s22, 0
  s_nop 0
  buffer_load_dwordx4 v96, s[12:15], s21 offen lds
  s_add_u32 m0, s22, 1024
  s_nop 0
  buffer_load_dwordx4 v97, s[12:15], s21 offen lds
  s_add_u32 m0, s22, 2048
  s_nop 0
  buffer_load_dwordx4 v98, s[12:15], s21 offen lds
  s_waitcnt vmcnt(63)
  s_mov_b32 s12, s36
  s_mov_b32 s13, s37
  s_mov_b32 s14, 7864320
  s_mov_b32 s15, 0x00020000
  s_add_u32 s21, s80, 983040
  s_add_u32 s22, s81, 18432
  s_add_u32 m0, s22, 0
  s_nop 0
  buffer_load_dwordx4 v96, s[12:15], s21 offen lds
  s_add_u32 m0, s22, 1024
  s_nop 0
  buffer_load_dwordx4 v97, s[12:15], s21 offen lds
  s_add_u32 m0, s22, 2048
  s_nop 0
  buffer_load_dwordx4 v98, s[12:15], s21 offen lds
  s_waitcnt vmcnt(63)
  s_mov_b32 s12, s36
  s_mov_b32 s13, s37
  s_mov_b32 s14, 7864320
  s_mov_b32 s15, 0x00020000
  s_add_u32 s21, s80, 98304
  s_add_u32 s22, s81, 21504
  s_add_u32 m0, s22, 0
  s_nop 0
  buffer_load_dwordx4 v96, s[12:15], s21 offen lds
  s_add_u32 m0, s22, 1024
  s_nop 0
  buffer_load_dwordx4 v97, s[12:15], s21 offen lds
  s_add_u32 m0, s22, 2048
  s_nop 0
  buffer_load_dwordx4 v98, s[12:15], s21 offen lds
  s_waitcnt vmcnt(63)
  s_mov_b32 s12, s36
  s_mov_b32 s13, s37
  s_mov_b32 s14, 7864320
  s_mov_b32 s15, 0x00020000
  s_add_u32 s21, s80, 1081344
  s_add_u32 s22, s81, 24576
  s_add_u32 m0, s22, 0
  s_nop 0
  buffer_load_dwordx4 v96, s[12:15], s21 offen lds
  s_add_u32 m0, s22, 1024
  s_nop 0
  buffer_load_dwordx4 v97, s[12:15], s21 offen lds
  s_add_u32 m0, s22, 2048
  s_nop 0
  buffer_load_dwordx4 v98, s[12:15], s21 offen lds
  s_waitcnt vmcnt(63)
  s_mov_b32 s12, s36
  s_mov_b32 s13, s37
  s_mov_b32 s14, 7864320
  s_mov_b32 s15, 0x00020000
  s_add_u32 s21, s80, 196608
  s_add_u32 s22, s81, 27648
  s_add_u32 m0, s22, 0
  s_nop 0
  buffer_load_dwordx4 v46, s[12:15], s21 offen lds
  s_add_u32 m0, s22, 1024
  s_nop 0
  buffer_load_dwordx4 v47, s[12:15], s21 offen lds
  s_add_u32 m0, s22, 2048
  s_nop 0
  buffer_load_dwordx4 v48, s[12:15], s21 offen lds
  v_mov_b32 v100, v49
  v_lshlrev_b32 v239, 2, v1
  s_waitcnt vmcnt(51)
  ds_read_b64_tr_b16 v[52:53], v99 offset:0
  ds_read_b64_tr_b16 v[54:55], v99 offset:384
  ds_read_b64_tr_b16 v[56:57], v99 offset:32
  ds_read_b64_tr_b16 v[58:59], v99 offset:416
  ds_read_b64_tr_b16 v[60:61], v99 offset:64
  ds_read_b64_tr_b16 v[62:63], v99 offset:448
  ds_read_b64_tr_b16 v[64:65], v99 offset:3072
  ds_read_b64_tr_b16 v[66:67], v99 offset:3456
  ds_read_b64_tr_b16 v[68:69], v99 offset:3104
  ds_read_b64_tr_b16 v[70:71], v99 offset:3488
  ds_read_b64_tr_b16 v[72:73], v99 offset:3136
  ds_read_b64_tr_b16 v[74:75], v99 offset:3520
  ds_read_b64_tr_b16 v[76:77], v99 offset:6144
  ds_read_b64_tr_b16 v[78:79], v99 offset:6528
  ds_read_b64_tr_b16 v[80:81], v99 offset:6176
  ds_read_b64_tr_b16 v[82:83], v99 offset:6560
  ds_read_b64_tr_b16 v[84:85], v99 offset:6208
  ds_read_b64_tr_b16 v[86:87], v99 offset:6592
  s_waitcnt lgkmcnt(12)
  v_lshlrev_b32 v50, 16, v52
  v_and_b32 v52, 0xffff0000, v52
  v_cvt_pk_f16_f32 v52, v50, v52
  v_accvgpr_write_b32 a60, v52
  v_lshlrev_b32 v50, 16, v53
  v_and_b32 v53, 0xffff0000, v53
  v_cvt_pk_f16_f32 v53, v50, v53
  v_accvgpr_write_b32 a61, v53
  v_lshlrev_b32 v50, 16, v54
  v_and_b32 v54, 0xffff0000, v54
  v_cvt_pk_f16_f32 v54, v50, v54
  v_accvgpr_write_b32 a62, v54
  v_lshlrev_b32 v50, 16, v55
  v_and_b32 v55, 0xffff0000, v55
  v_cvt_pk_f16_f32 v55, v50, v55
  v_accvgpr_write_b32 a63, v55
  v_lshlrev_b32 v50, 16, v56
  v_and_b32 v56, 0xffff0000, v56
  v_cvt_pk_f16_f32 v56, v50, v56
  v_accvgpr_write_b32 a80, v56
  v_lshlrev_b32 v50, 16, v57
  v_and_b32 v57, 0xffff0000, v57
  v_cvt_pk_f16_f32 v57, v50, v57
  v_accvgpr_write_b32 a81, v57
  v_lshlrev_b32 v50, 16, v58
  v_and_b32 v58, 0xffff0000, v58
  v_cvt_pk_f16_f32 v58, v50, v58
  v_accvgpr_write_b32 a82, v58
  v_lshlrev_b32 v50, 16, v59
  v_and_b32 v59, 0xffff0000, v59
  v_cvt_pk_f16_f32 v59, v50, v59
  v_accvgpr_write_b32 a83, v59
  v_lshlrev_b32 v50, 16, v60
  v_and_b32 v60, 0xffff0000, v60
  v_cvt_pk_f16_f32 v60, v50, v60
  v_accvgpr_write_b32 a100, v60
  v_lshlrev_b32 v50, 16, v61
  v_and_b32 v61, 0xffff0000, v61
  v_cvt_pk_f16_f32 v61, v50, v61
  v_accvgpr_write_b32 a101, v61
  v_lshlrev_b32 v50, 16, v62
  v_and_b32 v62, 0xffff0000, v62
  v_cvt_pk_f16_f32 v62, v50, v62
  v_accvgpr_write_b32 a102, v62
  v_lshlrev_b32 v50, 16, v63
  v_and_b32 v63, 0xffff0000, v63
  v_cvt_pk_f16_f32 v63, v50, v63
  v_accvgpr_write_b32 a103, v63
  ds_read_b64_tr_b16 v[52:53], v99 offset:9216
  ds_read_b64_tr_b16 v[54:55], v99 offset:9600
  ds_read_b64_tr_b16 v[56:57], v99 offset:9248
  ds_read_b64_tr_b16 v[58:59], v99 offset:9632
  ds_read_b64_tr_b16 v[60:61], v99 offset:9280
  ds_read_b64_tr_b16 v[62:63], v99 offset:9664
  s_waitcnt lgkmcnt(12)
  v_lshlrev_b32 v50, 16, v64
  v_and_b32 v64, 0xffff0000, v64
  v_cvt_pk_f16_f32 v64, v50, v64
  v_accvgpr_write_b32 a64, v64
  v_lshlrev_b32 v50, 16, v65
  v_and_b32 v65, 0xffff0000, v65
  v_cvt_pk_f16_f32 v65, v50, v65
  v_accvgpr_write_b32 a65, v65
  v_lshlrev_b32 v50, 16, v66
  v_and_b32 v66, 0xffff0000, v66
  v_cvt_pk_f16_f32 v66, v50, v66
  v_accvgpr_write_b32 a66, v66
  v_lshlrev_b32 v50, 16, v67
  v_and_b32 v67, 0xffff0000, v67
  v_cvt_pk_f16_f32 v67, v50, v67
  v_accvgpr_write_b32 a67, v67
  v_lshlrev_b32 v50, 16, v68
  v_and_b32 v68, 0xffff0000, v68
  v_cvt_pk_f16_f32 v68, v50, v68
  v_accvgpr_write_b32 a84, v68
  v_lshlrev_b32 v50, 16, v69
  v_and_b32 v69, 0xffff0000, v69
  v_cvt_pk_f16_f32 v69, v50, v69
  v_accvgpr_write_b32 a85, v69
  v_lshlrev_b32 v50, 16, v70
  v_and_b32 v70, 0xffff0000, v70
  v_cvt_pk_f16_f32 v70, v50, v70
  v_accvgpr_write_b32 a86, v70
  v_lshlrev_b32 v50, 16, v71
  v_and_b32 v71, 0xffff0000, v71
  v_cvt_pk_f16_f32 v71, v50, v71
  v_accvgpr_write_b32 a87, v71
  v_lshlrev_b32 v50, 16, v72
  v_and_b32 v72, 0xffff0000, v72
  v_cvt_pk_f16_f32 v72, v50, v72
  v_accvgpr_write_b32 a104, v72
  v_lshlrev_b32 v50, 16, v73
  v_and_b32 v73, 0xffff0000, v73
  v_cvt_pk_f16_f32 v73, v50, v73
  v_accvgpr_write_b32 a105, v73
  v_lshlrev_b32 v50, 16, v74
  v_and_b32 v74, 0xffff0000, v74
  v_cvt_pk_f16_f32 v74, v50, v74
  v_accvgpr_write_b32 a106, v74
  v_lshlrev_b32 v50, 16, v75
  v_and_b32 v75, 0xffff0000, v75
  v_cvt_pk_f16_f32 v75, v50, v75
  v_accvgpr_write_b32 a107, v75
  ds_read_b64_tr_b16 v[64:65], v99 offset:12288
  ds_read_b64_tr_b16 v[66:67], v99 offset:12672
  ds_read_b64_tr_b16 v[68:69], v99 offset:12320
  ds_read_b64_tr_b16 v[70:71], v99 offset:12704
  ds_read_b64_tr_b16 v[72:73], v99 offset:12352
  ds_read_b64_tr_b16 v[74:75], v99 offset:12736
  s_waitcnt lgkmcnt(12)
  v_lshlrev_b32 v50, 16, v76
  v_and_b32 v76, 0xffff0000, v76
  v_cvt_pk_f16_f32 v76, v50, v76
  v_accvgpr_write_b32 a68, v76
  v_lshlrev_b32 v50, 16, v77
  v_and_b32 v77, 0xffff0000, v77
  v_cvt_pk_f16_f32 v77, v50, v77
  v_accvgpr_write_b32 a69, v77
  v_lshlrev_b32 v50, 16, v78
  v_and_b32 v78, 0xffff0000, v78
  v_cvt_pk_f16_f32 v78, v50, v78
  v_accvgpr_write_b32 a70, v78
  v_lshlrev_b32 v50, 16, v79
  v_and_b32 v79, 0xffff0000, v79
  v_cvt_pk_f16_f32 v79, v50, v79
  v_accvgpr_write_b32 a71, v79
  v_lshlrev_b32 v50, 16, v80
  v_and_b32 v80, 0xffff0000, v80
  v_cvt_pk_f16_f32 v80, v50, v80
  v_accvgpr_write_b32 a88, v80
  v_lshlrev_b32 v50, 16, v81
  v_and_b32 v81, 0xffff0000, v81
  v_cvt_pk_f16_f32 v81, v50, v81
  v_accvgpr_write_b32 a89, v81
  v_lshlrev_b32 v50, 16, v82
  v_and_b32 v82, 0xffff0000, v82
  v_cvt_pk_f16_f32 v82, v50, v82
  v_accvgpr_write_b32 a90, v82
  v_lshlrev_b32 v50, 16, v83
  v_and_b32 v83, 0xffff0000, v83
  v_cvt_pk_f16_f32 v83, v50, v83
  v_accvgpr_write_b32 a91, v83
  v_lshlrev_b32 v50, 16, v84
  v_and_b32 v84, 0xffff0000, v84
  v_cvt_pk_f16_f32 v84, v50, v84
  v_accvgpr_write_b32 a108, v84
  v_lshlrev_b32 v50, 16, v85
  v_and_b32 v85, 0xffff0000, v85
  v_cvt_pk_f16_f32 v85, v50, v85
  v_accvgpr_write_b32 a109, v85
  v_lshlrev_b32 v50, 16, v86
  v_and_b32 v86, 0xffff0000, v86
  v_cvt_pk_f16_f32 v86, v50, v86
  v_accvgpr_write_b32 a110, v86
  v_lshlrev_b32 v50, 16, v87
  v_and_b32 v87, 0xffff0000, v87
  v_cvt_pk_f16_f32 v87, v50, v87
  v_accvgpr_write_b32 a111, v87
  s_waitcnt lgkmcnt(6)
  v_lshlrev_b32 v50, 16, v52
  v_and_b32 v52, 0xffff0000, v52
  v_cvt_pk_f16_f32 v52, v50, v52
  v_accvgpr_write_b32 a72, v52
  v_lshlrev_b32 v50, 16, v53
  v_and_b32 v53, 0xffff0000, v53
  v_cvt_pk_f16_f32 v53, v50, v53
  v_accvgpr_write_b32 a73, v53
  v_lshlrev_b32 v50, 16, v54
  v_and_b32 v54, 0xffff0000, v54
  v_cvt_pk_f16_f32 v54, v50, v54
  v_accvgpr_write_b32 a74, v54
  v_lshlrev_b32 v50, 16, v55
  v_and_b32 v55, 0xffff0000, v55
  v_cvt_pk_f16_f32 v55, v50, v55
  v_accvgpr_write_b32 a75, v55
  v_lshlrev_b32 v50, 16, v56
  v_and_b32 v56, 0xffff0000, v56
  v_cvt_pk_f16_f32 v56, v50, v56
  v_accvgpr_write_b32 a92, v56
  v_lshlrev_b32 v50, 16, v57
  v_and_b32 v57, 0xffff0000, v57
  v_cvt_pk_f16_f32 v57, v50, v57
  v_accvgpr_write_b32 a93, v57
  v_lshlrev_b32 v50, 16, v58
  v_and_b32 v58, 0xffff0000, v58
  v_cvt_pk_f16_f32 v58, v50, v58
  v_accvgpr_write_b32 a94, v58
  v_lshlrev_b32 v50, 16, v59
  v_and_b32 v59, 0xffff0000, v59
  v_cvt_pk_f16_f32 v59, v50, v59
  v_accvgpr_write_b32 a95, v59
  v_lshlrev_b32 v50, 16, v60
  v_and_b32 v60, 0xffff0000, v60
  v_cvt_pk_f16_f32 v60, v50, v60
  v_accvgpr_write_b32 a112, v60
  v_lshlrev_b32 v50, 16, v61
  v_and_b32 v61, 0xffff0000, v61
  v_cvt_pk_f16_f32 v61, v50, v61
  v_accvgpr_write_b32 a113, v61
  v_lshlrev_b32 v50, 16, v62
  v_and_b32 v62, 0xffff0000, v62
  v_cvt_pk_f16_f32 v62, v50, v62
  v_accvgpr_write_b32 a114, v62
  v_lshlrev_b32 v50, 16, v63
  v_and_b32 v63, 0xffff0000, v63
  v_cvt_pk_f16_f32 v63, v50, v63
  v_accvgpr_write_b32 a115, v63
  s_waitcnt lgkmcnt(0)
  v_lshlrev_b32 v50, 16, v64
  v_and_b32 v64, 0xffff0000, v64
  v_cvt_pk_f16_f32 v64, v50, v64
  v_accvgpr_write_b32 a76, v64
  v_lshlrev_b32 v50, 16, v65
  v_and_b32 v65, 0xffff0000, v65
  v_cvt_pk_f16_f32 v65, v50, v65
  v_accvgpr_write_b32 a77, v65
  v_lshlrev_b32 v50, 16, v66
  v_and_b32 v66, 0xffff0000, v66
  v_cvt_pk_f16_f32 v66, v50, v66
  v_accvgpr_write_b32 a78, v66
  v_lshlrev_b32 v50, 16, v67
  v_and_b32 v67, 0xffff0000, v67
  v_cvt_pk_f16_f32 v67, v50, v67
  v_accvgpr_write_b32 a79, v67
  v_lshlrev_b32 v50, 16, v68
  v_and_b32 v68, 0xffff0000, v68
  v_cvt_pk_f16_f32 v68, v50, v68
  v_accvgpr_write_b32 a96, v68
  v_lshlrev_b32 v50, 16, v69
  v_and_b32 v69, 0xffff0000, v69
  v_cvt_pk_f16_f32 v69, v50, v69
  v_accvgpr_write_b32 a97, v69
  v_lshlrev_b32 v50, 16, v70
  v_and_b32 v70, 0xffff0000, v70
  v_cvt_pk_f16_f32 v70, v50, v70
  v_accvgpr_write_b32 a98, v70
  v_lshlrev_b32 v50, 16, v71
  v_and_b32 v71, 0xffff0000, v71
  v_cvt_pk_f16_f32 v71, v50, v71
  v_accvgpr_write_b32 a99, v71
  v_lshlrev_b32 v50, 16, v72
  v_and_b32 v72, 0xffff0000, v72
  v_cvt_pk_f16_f32 v72, v50, v72
  v_accvgpr_write_b32 a116, v72
  v_lshlrev_b32 v50, 16, v73
  v_and_b32 v73, 0xffff0000, v73
  v_cvt_pk_f16_f32 v73, v50, v73
  v_accvgpr_write_b32 a117, v73
  v_lshlrev_b32 v50, 16, v74
  v_and_b32 v74, 0xffff0000, v74
  v_cvt_pk_f16_f32 v74, v50, v74
  v_accvgpr_write_b32 a118, v74
  v_lshlrev_b32 v50, 16, v75
  v_and_b32 v75, 0xffff0000, v75
  v_cvt_pk_f16_f32 v75, v50, v75
  v_accvgpr_write_b32 a119, v75
  s_waitcnt vmcnt(36)
  ds_write_b128 v100, v[128:131] offset:0
  ds_write_b128 v100, v[132:135] offset:1024
  ds_write_b128 v100, v[136:139] offset:2048
  ds_write_b128 v100, v[140:143] offset:3072
  ds_write_b128 v100, v[144:147] offset:4096
  ds_write_b128 v100, v[148:151] offset:5120
  ds_write_b128 v100, v[152:155] offset:6144
  ds_write_b128 v100, v[156:159] offset:7168
  ds_write_b128 v100, v[160:163] offset:8192
  ds_write_b128 v100, v[164:167] offset:9216
  ds_write_b128 v100, v[168:171] offset:10240
  ds_write_b128 v100, v[172:175] offset:11264
  ds_write_b128 v100, v[176:179] offset:12288
  ds_write_b128 v100, v[180:183] offset:13312
  ds_write_b128 v100, v[184:187] offset:14336
  s_waitcnt lgkmcnt(0)
  ds_read_b64_tr_b16 v[52:53], v99 offset:0
  ds_read_b64_tr_b16 v[54:55], v99 offset:384
  ds_read_b64_tr_b16 v[56:57], v99 offset:32
  ds_read_b64_tr_b16 v[58:59], v99 offset:416
  ds_read_b64_tr_b16 v[60:61], v99 offset:64
  ds_read_b64_tr_b16 v[62:63], v99 offset:448
  ds_read_b64_tr_b16 v[64:65], v99 offset:3072
  ds_read_b64_tr_b16 v[66:67], v99 offset:3456
  ds_read_b64_tr_b16 v[68:69], v99 offset:3104
  ds_read_b64_tr_b16 v[70:71], v99 offset:3488
  ds_read_b64_tr_b16 v[72:73], v99 offset:3136
  ds_read_b64_tr_b16 v[74:75], v99 offset:3520
  ds_read_b64_tr_b16 v[76:77], v99 offset:6144
  ds_read_b64_tr_b16 v[78:79], v99 offset:6528
  ds_read_b64_tr_b16 v[80:81], v99 offset:6176
  ds_read_b64_tr_b16 v[82:83], v99 offset:6560
  ds_read_b64_tr_b16 v[84:85], v99 offset:6208
  ds_read_b64_tr_b16 v[86:87], v99 offset:6592
  s_waitcnt lgkmcnt(12)
  v_lshlrev_b32 v50, 16, v52
  v_and_b32 v52, 0xffff0000, v52
  v_cvt_pk_f16_f32 v52, v50, v52
  v_accvgpr_write_b32 a120, v52
  v_lshlrev_b32 v50, 16, v53
  v_and_b32 v53, 0xffff0000, v53
  v_cvt_pk_f16_f32 v53, v50, v53
  v_accvgpr_write_b32 a121, v53
  v_lshlrev_b32 v50, 16, v54
  v_and_b32 v54, 0xffff0000, v54
  v_cvt_pk_f16_f32 v54, v50, v54
  v_accvgpr_write_b32 a122, v54
  v_lshlrev_b32 v50, 16, v55
  v_and_b32 v55, 0xffff0000, v55
  v_cvt_pk_f16_f32 v55, v50, v55
  v_accvgpr_write_b32 a123, v55
  v_lshlrev_b32 v50, 16, v56
  v_and_b32 v56, 0xffff0000, v56
  v_cvt_pk_f16_f32 v56, v50, v56
  v_accvgpr_write_b32 a140, v56
  v_lshlrev_b32 v50, 16, v57
  v_and_b32 v57, 0xffff0000, v57
  v_cvt_pk_f16_f32 v57, v50, v57
  v_accvgpr_write_b32 a141, v57
  v_lshlrev_b32 v50, 16, v58
  v_and_b32 v58, 0xffff0000, v58
  v_cvt_pk_f16_f32 v58, v50, v58
  v_accvgpr_write_b32 a142, v58
  v_lshlrev_b32 v50, 16, v59
  v_and_b32 v59, 0xffff0000, v59
  v_cvt_pk_f16_f32 v59, v50, v59
  v_accvgpr_write_b32 a143, v59
  v_lshlrev_b32 v50, 16, v60
  v_and_b32 v60, 0xffff0000, v60
  v_cvt_pk_f16_f32 v60, v50, v60
  v_accvgpr_write_b32 a160, v60
  v_lshlrev_b32 v50, 16, v61
  v_and_b32 v61, 0xffff0000, v61
  v_cvt_pk_f16_f32 v61, v50, v61
  v_accvgpr_write_b32 a161, v61
  v_lshlrev_b32 v50, 16, v62
  v_and_b32 v62, 0xffff0000, v62
  v_cvt_pk_f16_f32 v62, v50, v62
  v_accvgpr_write_b32 a162, v62
  v_lshlrev_b32 v50, 16, v63
  v_and_b32 v63, 0xffff0000, v63
  v_cvt_pk_f16_f32 v63, v50, v63
  v_accvgpr_write_b32 a163, v63
  ds_read_b64_tr_b16 v[52:53], v99 offset:9216
  ds_read_b64_tr_b16 v[54:55], v99 offset:9600
  ds_read_b64_tr_b16 v[56:57], v99 offset:9248
  ds_read_b64_tr_b16 v[58:59], v99 offset:9632
  ds_read_b64_tr_b16 v[60:61], v99 offset:9280
  ds_read_b64_tr_b16 v[62:63], v99 offset:9664
  s_waitcnt lgkmcnt(12)
  v_lshlrev_b32 v50, 16, v64
  v_and_b32 v64, 0xffff0000, v64
  v_cvt_pk_f16_f32 v64, v50, v64
  v_accvgpr_write_b32 a124, v64
  v_lshlrev_b32 v50, 16, v65
  v_and_b32 v65, 0xffff0000, v65
  v_cvt_pk_f16_f32 v65, v50, v65
  v_accvgpr_write_b32 a125, v65
  v_lshlrev_b32 v50, 16, v66
  v_and_b32 v66, 0xffff0000, v66
  v_cvt_pk_f16_f32 v66, v50, v66
  v_accvgpr_write_b32 a126, v66
  v_lshlrev_b32 v50, 16, v67
  v_and_b32 v67, 0xffff0000, v67
  v_cvt_pk_f16_f32 v67, v50, v67
  v_accvgpr_write_b32 a127, v67
  v_lshlrev_b32 v50, 16, v68
  v_and_b32 v68, 0xffff0000, v68
  v_cvt_pk_f16_f32 v68, v50, v68
  v_accvgpr_write_b32 a144, v68
  v_lshlrev_b32 v50, 16, v69
  v_and_b32 v69, 0xffff0000, v69
  v_cvt_pk_f16_f32 v69, v50, v69
  v_accvgpr_write_b32 a145, v69
  v_lshlrev_b32 v50, 16, v70
  v_and_b32 v70, 0xffff0000, v70
  v_cvt_pk_f16_f32 v70, v50, v70
  v_accvgpr_write_b32 a146, v70
  v_lshlrev_b32 v50, 16, v71
  v_and_b32 v71, 0xffff0000, v71
  v_cvt_pk_f16_f32 v71, v50, v71
  v_accvgpr_write_b32 a147, v71
  v_lshlrev_b32 v50, 16, v72
  v_and_b32 v72, 0xffff0000, v72
  v_cvt_pk_f16_f32 v72, v50, v72
  v_accvgpr_write_b32 a164, v72
  v_lshlrev_b32 v50, 16, v73
  v_and_b32 v73, 0xffff0000, v73
  v_cvt_pk_f16_f32 v73, v50, v73
  v_accvgpr_write_b32 a165, v73
  v_lshlrev_b32 v50, 16, v74
  v_and_b32 v74, 0xffff0000, v74
  v_cvt_pk_f16_f32 v74, v50, v74
  v_accvgpr_write_b32 a166, v74
  v_lshlrev_b32 v50, 16, v75
  v_and_b32 v75, 0xffff0000, v75
  v_cvt_pk_f16_f32 v75, v50, v75
  v_accvgpr_write_b32 a167, v75
  ds_read_b64_tr_b16 v[64:65], v99 offset:12288
  ds_read_b64_tr_b16 v[66:67], v99 offset:12672
  ds_read_b64_tr_b16 v[68:69], v99 offset:12320
  ds_read_b64_tr_b16 v[70:71], v99 offset:12704
  ds_read_b64_tr_b16 v[72:73], v99 offset:12352
  ds_read_b64_tr_b16 v[74:75], v99 offset:12736
  s_waitcnt lgkmcnt(12)
  v_lshlrev_b32 v50, 16, v76
  v_and_b32 v76, 0xffff0000, v76
  v_cvt_pk_f16_f32 v76, v50, v76
  v_accvgpr_write_b32 a128, v76
  v_lshlrev_b32 v50, 16, v77
  v_and_b32 v77, 0xffff0000, v77
  v_cvt_pk_f16_f32 v77, v50, v77
  v_accvgpr_write_b32 a129, v77
  v_lshlrev_b32 v50, 16, v78
  v_and_b32 v78, 0xffff0000, v78
  v_cvt_pk_f16_f32 v78, v50, v78
  v_accvgpr_write_b32 a130, v78
  v_lshlrev_b32 v50, 16, v79
  v_and_b32 v79, 0xffff0000, v79
  v_cvt_pk_f16_f32 v79, v50, v79
  v_accvgpr_write_b32 a131, v79
  v_lshlrev_b32 v50, 16, v80
  v_and_b32 v80, 0xffff0000, v80
  v_cvt_pk_f16_f32 v80, v50, v80
  v_accvgpr_write_b32 a148, v80
  v_lshlrev_b32 v50, 16, v81
  v_and_b32 v81, 0xffff0000, v81
  v_cvt_pk_f16_f32 v81, v50, v81
  v_accvgpr_write_b32 a149, v81
  v_lshlrev_b32 v50, 16, v82
  v_and_b32 v82, 0xffff0000, v82
  v_cvt_pk_f16_f32 v82, v50, v82
  v_accvgpr_write_b32 a150, v82
  v_lshlrev_b32 v50, 16, v83
  v_and_b32 v83, 0xffff0000, v83
  v_cvt_pk_f16_f32 v83, v50, v83
  v_accvgpr_write_b32 a151, v83
  v_lshlrev_b32 v50, 16, v84
  v_and_b32 v84, 0xffff0000, v84
  v_cvt_pk_f16_f32 v84, v50, v84
  v_accvgpr_write_b32 a168, v84
  v_lshlrev_b32 v50, 16, v85
  v_and_b32 v85, 0xffff0000, v85
  v_cvt_pk_f16_f32 v85, v50, v85
  v_accvgpr_write_b32 a169, v85
  v_lshlrev_b32 v50, 16, v86
  v_and_b32 v86, 0xffff0000, v86
  v_cvt_pk_f16_f32 v86, v50, v86
  v_accvgpr_write_b32 a170, v86
  v_lshlrev_b32 v50, 16, v87
  v_and_b32 v87, 0xffff0000, v87
  v_cvt_pk_f16_f32 v87, v50, v87
  v_accvgpr_write_b32 a171, v87
  s_waitcnt lgkmcnt(6)
  v_lshlrev_b32 v50, 16, v52
  v_and_b32 v52, 0xffff0000, v52
  v_cvt_pk_f16_f32 v52, v50, v52
  v_accvgpr_write_b32 a132, v52
  v_lshlrev_b32 v50, 16, v53
  v_and_b32 v53, 0xffff0000, v53
  v_cvt_pk_f16_f32 v53, v50, v53
  v_accvgpr_write_b32 a133, v53
  v_lshlrev_b32 v50, 16, v54
  v_and_b32 v54, 0xffff0000, v54
  v_cvt_pk_f16_f32 v54, v50, v54
  v_accvgpr_write_b32 a134, v54
  v_lshlrev_b32 v50, 16, v55
  v_and_b32 v55, 0xffff0000, v55
  v_cvt_pk_f16_f32 v55, v50, v55
  v_accvgpr_write_b32 a135, v55
  v_lshlrev_b32 v50, 16, v56
  v_and_b32 v56, 0xffff0000, v56
  v_cvt_pk_f16_f32 v56, v50, v56
  v_accvgpr_write_b32 a152, v56
  v_lshlrev_b32 v50, 16, v57
  v_and_b32 v57, 0xffff0000, v57
  v_cvt_pk_f16_f32 v57, v50, v57
  v_accvgpr_write_b32 a153, v57
  v_lshlrev_b32 v50, 16, v58
  v_and_b32 v58, 0xffff0000, v58
  v_cvt_pk_f16_f32 v58, v50, v58
  v_accvgpr_write_b32 a154, v58
  v_lshlrev_b32 v50, 16, v59
  v_and_b32 v59, 0xffff0000, v59
  v_cvt_pk_f16_f32 v59, v50, v59
  v_accvgpr_write_b32 a155, v59
  v_lshlrev_b32 v50, 16, v60
  v_and_b32 v60, 0xffff0000, v60
  v_cvt_pk_f16_f32 v60, v50, v60
  v_accvgpr_write_b32 a172, v60
  v_lshlrev_b32 v50, 16, v61
  v_and_b32 v61, 0xffff0000, v61
  v_cvt_pk_f16_f32 v61, v50, v61
  v_accvgpr_write_b32 a173, v61
  v_lshlrev_b32 v50, 16, v62
  v_and_b32 v62, 0xffff0000, v62
  v_cvt_pk_f16_f32 v62, v50, v62
  v_accvgpr_write_b32 a174, v62
  v_lshlrev_b32 v50, 16, v63
  v_and_b32 v63, 0xffff0000, v63
  v_cvt_pk_f16_f32 v63, v50, v63
  v_accvgpr_write_b32 a175, v63
  s_waitcnt lgkmcnt(0)
  v_lshlrev_b32 v50, 16, v64
  v_and_b32 v64, 0xffff0000, v64
  v_cvt_pk_f16_f32 v64, v50, v64
  v_accvgpr_write_b32 a136, v64
  v_lshlrev_b32 v50, 16, v65
  v_and_b32 v65, 0xffff0000, v65
  v_cvt_pk_f16_f32 v65, v50, v65
  v_accvgpr_write_b32 a137, v65
  v_lshlrev_b32 v50, 16, v66
  v_and_b32 v66, 0xffff0000, v66
  v_cvt_pk_f16_f32 v66, v50, v66
  v_accvgpr_write_b32 a138, v66
  v_lshlrev_b32 v50, 16, v67
  v_and_b32 v67, 0xffff0000, v67
  v_cvt_pk_f16_f32 v67, v50, v67
  v_accvgpr_write_b32 a139, v67
  v_lshlrev_b32 v50, 16, v68
  v_and_b32 v68, 0xffff0000, v68
  v_cvt_pk_f16_f32 v68, v50, v68
  v_accvgpr_write_b32 a156, v68
  v_lshlrev_b32 v50, 16, v69
  v_and_b32 v69, 0xffff0000, v69
  v_cvt_pk_f16_f32 v69, v50, v69
  v_accvgpr_write_b32 a157, v69
  v_lshlrev_b32 v50, 16, v70
  v_and_b32 v70, 0xffff0000, v70
  v_cvt_pk_f16_f32 v70, v50, v70
  v_accvgpr_write_b32 a158, v70
  v_lshlrev_b32 v50, 16, v71
  v_and_b32 v71, 0xffff0000, v71
  v_cvt_pk_f16_f32 v71, v50, v71
  v_accvgpr_write_b32 a159, v71
  v_lshlrev_b32 v50, 16, v72
  v_and_b32 v72, 0xffff0000, v72
  v_cvt_pk_f16_f32 v72, v50, v72
  v_accvgpr_write_b32 a176, v72
  v_lshlrev_b32 v50, 16, v73
  v_and_b32 v73, 0xffff0000, v73
  v_cvt_pk_f16_f32 v73, v50, v73
  v_accvgpr_write_b32 a177, v73
  v_lshlrev_b32 v50, 16, v74
  v_and_b32 v74, 0xffff0000, v74
  v_cvt_pk_f16_f32 v74, v50, v74
  v_accvgpr_write_b32 a178, v74
  v_lshlrev_b32 v50, 16, v75
  v_and_b32 v75, 0xffff0000, v75
  v_cvt_pk_f16_f32 v75, v50, v75
  v_accvgpr_write_b32 a179, v75
  s_waitcnt vmcnt(27)
  s_cmp_lg_u32 s20, 0
  s_cbranch_scc1 ic_7
  buffer_load_dword v238, v239, s[32:35], 0 offen sc1
ic_7:
  ds_write_b128 v100, v[188:191] offset:0
  ds_write_b128 v100, v[192:195] offset:1024
  ds_write_b128 v100, v[196:199] offset:2048
  ds_write_b128 v100, v[200:203] offset:3072
  ds_write_b128 v100, v[204:207] offset:4096
  ds_write_b128 v100, v[208:211] offset:5120
  ds_write_b128 v100, v[212:215] offset:6144
  ds_write_b128 v100, v[216:219] offset:7168
  ds_write_b128 v100, v[220:223] offset:8192
  s_waitcnt lgkmcnt(0)
  ds_read_b64_tr_b16 a[192:193], v99 offset:0
  ds_read_b64_tr_b16 a[194:195], v99 offset:384
  ds_read_b64_tr_b16 a[216:217], v99 offset:32
  ds_read_b64_tr_b16 a[218:219], v99 offset:416
  ds_read_b64_tr_b16 a[240:241], v99 offset:64
  ds_read_b64_tr_b16 a[242:243], v99 offset:448
  ds_read_b64_tr_b16 a[196:197], v99 offset:3072
  ds_read_b64_tr_b16 a[198:199], v99 offset:3456
  ds_read_b64_tr_b16 a[220:221], v99 offset:3104
  ds_read_b64_tr_b16 a[222:223], v99 offset:3488
  ds_read_b64_tr_b16 a[244:245], v99 offset:3136
  ds_read_b64_tr_b16 a[246:247], v99 offset:3520
  ds_read_b64_tr_b16 a[200:201], v99 offset:6144
  ds_read_b64_tr_b16 a[202:203], v99 offset:6528
  ds_read_b64_tr_b16 a[224:225], v99 offset:6176
  ds_read_b64_tr_b16 a[226:227], v99 offset:6560
  ds_read_b64_tr_b16 a[248:249], v99 offset:6208
  ds_read_b64_tr_b16 a[250:251], v99 offset:6592
  s_waitcnt lgkmcnt(0)
  s_waitcnt vmcnt(15)
  ds_read_b64_tr_b16 a[180:181], v99 offset:30720
  ds_read_b64_tr_b16 a[182:183], v99 offset:31104
  ds_read_b64_tr_b16 a[204:205], v99 offset:30752
  ds_read_b64_tr_b16 a[206:207], v99 offset:31136
  ds_read_b64_tr_b16 a[228:229], v99 offset:30784
  ds_read_b64_tr_b16 a[230:231], v99 offset:31168
  ds_read_b64_tr_b16 a[184:185], v99 offset:33792
  ds_read_b64_tr_b16 a[186:187], v99 offset:34176
  ds_read_b64_tr_b16 a[208:209], v99 offset:33824
  ds_read_b64_tr_b16 a[210:211], v99 offset:34208
  ds_read_b64_tr_b16 a[232:233], v99 offset:33856
  ds_read_b64_tr_b16 a[234:235], v99 offset:34240
  ds_read_b64_tr_b16 a[188:189], v99 offset:36864
  ds_read_b64_tr_b16 a[190:191], v99 offset:37248
  ds_read_b64_tr_b16 a[212:213], v99 offset:36896
  ds_read_b64_tr_b16 a[214:215], v99 offset:37280
  ds_read_b64_tr_b16 a[236:237], v99 offset:36928
  ds_read_b64_tr_b16 a[238:239], v99 offset:37312
  s_waitcnt lgkmcnt(0)
  v_lshlrev_b32 v50, 16, v32
  v_and_b32 v32, 0xffff0000, v32
  v_cvt_pk_f16_f32 v32, v50, v32
  v_lshlrev_b32 v50, 16, v33
  v_and_b32 v33, 0xffff0000, v33
  v_cvt_pk_f16_f32 v33, v50, v33
  v_lshlrev_b32 v50, 16, v34
  v_and_b32 v34, 0xffff0000, v34
  v_cvt_pk_f16_f32 v34, v50, v34
  v_lshlrev_b32 v50, 16, v35
  v_and_b32 v35, 0xffff0000, v35
  v_cvt_pk_f16_f32 v35, v50, v35
  v_lshlrev_b32 v50, 16, v36
  v_and_b32 v36, 0xffff0000, v36
  v_cvt_pk_f16_f32 v36, v50, v36
  v_lshlrev_b32 v50, 16, v37
  v_and_b32 v37, 0xffff0000, v37
  v_cvt_pk_f16_f32 v37, v50, v37
  v_lshlrev_b32 v50, 16, v38
  v_and_b32 v38, 0xffff0000, v38
  v_cvt_pk_f16_f32 v38, v50, v38
  v_lshlrev_b32 v50, 16, v39
  v_and_b32 v39, 0xffff0000, v39
  v_cvt_pk_f16_f32 v39, v50, v39
  v_lshlrev_b32 v50, 16, v40
  v_and_b32 v40, 0xffff0000, v40
  v_cvt_pk_f16_f32 v40, v50, v40
  v_lshlrev_b32 v50, 16, v41
  v_and_b32 v41, 0xffff0000, v41
  v_cvt_pk_f16_f32 v41, v50, v41
  v_mov_b32 v174, 0
  v_mov_b32 v175, 0
  v_mov_b32 v218, 0
  v_mov_b32 v219, 0
  v_mov_b32 v234, 0
  v_mov_b32 v235, 0
  v_mov_b32 v220, 0
  v_mov_b32 v221, 0
  v_mov_b32 v222, 0
  v_mov_b32 v223, 0
  v_mov_b32 v224, 0
  v_mov_b32 v225, 0
  v_mov_b32 v226, 0
  v_mov_b32 v227, 0
  s_waitcnt vmcnt(12)
  ds_read_b64_tr_b16 v[52:53], v99 offset:15360
  ds_read_b64_tr_b16 v[54:55], v99 offset:15744
  ds_read_b64_tr_b16 v[56:57], v99 offset:15392
  ds_read_b64_tr_b16 v[58:59], v99 offset:15776
  ds_read_b64_tr_b16 v[60:61], v99 offset:15424
  ds_read_b64_tr_b16 v[62:63], v99 offset:15808
  s_waitcnt lgkmcnt(0)
  v_lshlrev_b32 v50, 16, v52
  v_and_b32 v52, 0xffff0000, v52
  v_cvt_pk_f16_f32 v52, v50, v52
  v_accvgpr_write_b32 a0, v52
  v_lshlrev_b32 v50, 16, v53
  v_and_b32 v53, 0xffff0000, v53
  v_cvt_pk_f16_f32 v53, v50, v53
  v_accvgpr_write_b32 a1, v53
  v_lshlrev_b32 v50, 16, v54
  v_and_b32 v54, 0xffff0000, v54
  v_cvt_pk_f16_f32 v54, v50, v54
  v_accvgpr_write_b32 a2, v54
  v_lshlrev_b32 v50, 16, v55
  v_and_b32 v55, 0xffff0000, v55
  v_cvt_pk_f16_f32 v55, v50, v55
  v_accvgpr_write_b32 a3, v55
  v_lshlrev_b32 v50, 16, v56
  v_and_b32 v56, 0xffff0000, v56
  v_cvt_pk_f16_f32 v56, v50, v56
  v_accvgpr_write_b32 a20, v56
  v_lshlrev_b32 v50, 16, v57
  v_and_b32 v57, 0xffff0000, v57
  v_cvt_pk_f16_f32 v57, v50, v57
  v_accvgpr_write_b32 a21, v57
  v_lshlrev_b32 v50, 16, v58
  v_and_b32 v58, 0xffff0000, v58
  v_cvt_pk_f16_f32 v58, v50, v58
  v_accvgpr_write_b32 a22, v58
  v_lshlrev_b32 v50, 16, v59
  v_and_b32 v59, 0xffff0000, v59
  v_cvt_pk_f16_f32 v59, v50, v59
  v_accvgpr_write_b32 a23, v59
  v_lshlrev_b32 v50, 16, v60
  v_and_b32 v60, 0xffff0000, v60
  v_cvt_pk_f16_f32 v60, v50, v60
  v_accvgpr_write_b32 a40, v60
  v_lshlrev_b32 v50, 16, v61
  v_and_b32 v61, 0xffff0000, v61
  v_cvt_pk_f16_f32 v61, v50, v61
  v_accvgpr_write_b32 a41, v61
  v_lshlrev_b32 v50, 16, v62
  v_and_b32 v62, 0xffff0000, v62
  v_cvt_pk_f16_f32 v62, v50, v62
  v_accvgpr_write_b32 a42, v62
  v_lshlrev_b32 v50, 16, v63
  v_and_b32 v63, 0xffff0000, v63
  v_cvt_pk_f16_f32 v63, v50, v63
  v_accvgpr_write_b32 a43, v63
  s_waitcnt vmcnt(9)
  ds_read_b64_tr_b16 v[64:65], v99 offset:18432
  ds_read_b64_tr_b16 v[66:67], v99 offset:18816
  ds_read_b64_tr_b16 v[68:69], v99 offset:18464
  ds_read_b64_tr_b16 v[70:71], v99 offset:18848
  ds_read_b64_tr_b16 v[72:73], v99 offset:18496
  ds_read_b64_tr_b16 v[74:75], v99 offset:18880
  s_waitcnt lgkmcnt(0)
  v_lshlrev_b32 v50, 16, v64
  v_and_b32 v64, 0xffff0000, v64
  v_cvt_pk_f16_f32 v64, v50, v64
  v_accvgpr_write_b32 a4, v64
  v_lshlrev_b32 v50, 16, v65
  v_and_b32 v65, 0xffff0000, v65
  v_cvt_pk_f16_f32 v65, v50, v65
  v_accvgpr_write_b32 a5, v65
  v_lshlrev_b32 v50, 16, v66
  v_and_b32 v66, 0xffff0000, v66
  v_cvt_pk_f16_f32 v66, v50, v66
  v_accvgpr_write_b32 a6, v66
  v_lshlrev_b32 v50, 16, v67
  v_and_b32 v67, 0xffff0000, v67
  v_cvt_pk_f16_f32 v67, v50, v67
  v_accvgpr_write_b32 a7, v67
  v_lshlrev_b32 v50, 16, v68
  v_and_b32 v68, 0xffff0000, v68
  v_cvt_pk_f16_f32 v68, v50, v68
  v_accvgpr_write_b32 a24, v68
  v_lshlrev_b32 v50, 16, v69
  v_and_b32 v69, 0xffff0000, v69
  v_cvt_pk_f16_f32 v69, v50, v69
  v_accvgpr_write_b32 a25, v69
  v_lshlrev_b32 v50, 16, v70
  v_and_b32 v70, 0xffff0000, v70
  v_cvt_pk_f16_f32 v70, v50, v70
  v_accvgpr_write_b32 a26, v70
  v_lshlrev_b32 v50, 16, v71
  v_and_b32 v71, 0xffff0000, v71
  v_cvt_pk_f16_f32 v71, v50, v71
  v_accvgpr_write_b32 a27, v71
  v_lshlrev_b32 v50, 16, v72
  v_and_b32 v72, 0xffff0000, v72
  v_cvt_pk_f16_f32 v72, v50, v72
  v_accvgpr_write_b32 a44, v72
  v_lshlrev_b32 v50, 16, v73
  v_and_b32 v73, 0xffff0000, v73
  v_cvt_pk_f16_f32 v73, v50, v73
  v_accvgpr_write_b32 a45, v73
  v_lshlrev_b32 v50, 16, v74
  v_and_b32 v74, 0xffff0000, v74
  v_cvt_pk_f16_f32 v74, v50, v74
  v_accvgpr_write_b32 a46, v74
  v_lshlrev_b32 v50, 16, v75
  v_and_b32 v75, 0xffff0000, v75
  v_cvt_pk_f16_f32 v75, v50, v75
  v_accvgpr_write_b32 a47, v75
  s_waitcnt vmcnt(6)
  ds_read_b64_tr_b16 v[76:77], v99 offset:21504
  ds_read_b64_tr_b16 v[78:79], v99 offset:21888
  ds_read_b64_tr_b16 v[80:81], v99 offset:21536
  ds_read_b64_tr_b16 v[82:83], v99 offset:21920
  ds_read_b64_tr_b16 v[84:85], v99 offset:21568
  ds_read_b64_tr_b16 v[86:87], v99 offset:21952
  s_waitcnt lgkmcnt(0)
  v_lshlrev_b32 v50, 16, v76
  v_and_b32 v76, 0xffff0000, v76
  v_cvt_pk_f16_f32 v76, v50, v76
  v_accvgpr_write_b32 a8, v76
  v_lshlrev_b32 v50, 16, v77
  v_and_b32 v77, 0xffff0000, v77
  v_cvt_pk_f16_f32 v77, v50, v77
  v_accvgpr_write_b32 a9, v77
  v_lshlrev_b32 v50, 16, v78
  v_and_b32 v78, 0xffff0000, v78
  v_cvt_pk_f16_f32 v78, v50, v78
  v_accvgpr_write_b32 a10, v78
  v_lshlrev_b32 v50, 16, v79
  v_and_b32 v79, 0xffff0000, v79
  v_cvt_pk_f16_f32 v79, v50, v79
  v_accvgpr_write_b32 a11, v79
  v_lshlrev_b32 v50, 16, v80
  v_and_b32 v80, 0xffff0000, v80
  v_cvt_pk_f16_f32 v80, v50, v80
  v_accvgpr_write_b32 a28, v80
  v_lshlrev_b32 v50, 16, v81
  v_and_b32 v81, 0xffff0000, v81
  v_cvt_pk_f16_f32 v81, v50, v81
  v_accvgpr_write_b32 a29, v81
  v_lshlrev_b32 v50, 16, v82
  v_and_b32 v82, 0xffff0000, v82
  v_cvt_pk_f16_f32 v82, v50, v82
  v_accvgpr_write_b32 a30, v82
  v_lshlrev_b32 v50, 16, v83
  v_and_b32 v83, 0xffff0000, v83
  v_cvt_pk_f16_f32 v83, v50, v83
  v_accvgpr_write_b32 a31, v83
  v_lshlrev_b32 v50, 16, v84
  v_and_b32 v84, 0xffff0000, v84
  v_cvt_pk_f16_f32 v84, v50, v84
  v_accvgpr_write_b32 a48, v84
  v_lshlrev_b32 v50, 16, v85
  v_and_b32 v85, 0xffff0000, v85
  v_cvt_pk_f16_f32 v85, v50, v85
  v_accvgpr_write_b32 a49, v85
  v_lshlrev_b32 v50, 16, v86
  v_and_b32 v86, 0xffff0000, v86
  v_cvt_pk_f16_f32 v86, v50, v86
  v_accvgpr_write_b32 a50, v86
  v_lshlrev_b32 v50, 16, v87
  v_and_b32 v87, 0xffff0000, v87
  v_cvt_pk_f16_f32 v87, v50, v87
  v_accvgpr_write_b32 a51, v87
  s_waitcnt vmcnt(3)
  ds_read_b64_tr_b16 v[52:53], v99 offset:24576
  ds_read_b64_tr_b16 v[54:55], v99 offset:24960
  ds_read_b64_tr_b16 v[56:57], v99 offset:24608
  ds_read_b64_tr_b16 v[58:59], v99 offset:24992
  ds_read_b64_tr_b16 v[60:61], v99 offset:24640
  ds_read_b64_tr_b16 v[62:63], v99 offset:25024
  s_waitcnt lgkmcnt(0)
  v_lshlrev_b32 v50, 16, v52
  v_and_b32 v52, 0xffff0000, v52
  v_cvt_pk_f16_f32 v52, v50, v52
  v_accvgpr_write_b32 a12, v52
  v_lshlrev_b32 v50, 16, v53
  v_and_b32 v53, 0xffff0000, v53
  v_cvt_pk_f16_f32 v53, v50, v53
  v_accvgpr_write_b32 a13, v53
  v_lshlrev_b32 v50, 16, v54
  v_and_b32 v54, 0xffff0000, v54
  v_cvt_pk_f16_f32 v54, v50, v54
  v_accvgpr_write_b32 a14, v54
  v_lshlrev_b32 v50, 16, v55
  v_and_b32 v55, 0xffff0000, v55
  v_cvt_pk_f16_f32 v55, v50, v55
  v_accvgpr_write_b32 a15, v55
  v_lshlrev_b32 v50, 16, v56
  v_and_b32 v56, 0xffff0000, v56
  v_cvt_pk_f16_f32 v56, v50, v56
  v_accvgpr_write_b32 a32, v56
  v_lshlrev_b32 v50, 16, v57
  v_and_b32 v57, 0xffff0000, v57
  v_cvt_pk_f16_f32 v57, v50, v57
  v_accvgpr_write_b32 a33, v57
  v_lshlrev_b32 v50, 16, v58
  v_and_b32 v58, 0xffff0000, v58
  v_cvt_pk_f16_f32 v58, v50, v58
  v_accvgpr_write_b32 a34, v58
  v_lshlrev_b32 v50, 16, v59
  v_and_b32 v59, 0xffff0000, v59
  v_cvt_pk_f16_f32 v59, v50, v59
  v_accvgpr_write_b32 a35, v59
  v_lshlrev_b32 v50, 16, v60
  v_and_b32 v60, 0xffff0000, v60
  v_cvt_pk_f16_f32 v60, v50, v60
  v_accvgpr_write_b32 a52, v60
  v_lshlrev_b32 v50, 16, v61
  v_and_b32 v61, 0xffff0000, v61
  v_cvt_pk_f16_f32 v61, v50, v61
  v_accvgpr_write_b32 a53, v61
  v_lshlrev_b32 v50, 16, v62
  v_and_b32 v62, 0xffff0000, v62
  v_cvt_pk_f16_f32 v62, v50, v62
  v_accvgpr_write_b32 a54, v62
  v_lshlrev_b32 v50, 16, v63
  v_and_b32 v63, 0xffff0000, v63
  v_cvt_pk_f16_f32 v63, v50, v63
  v_accvgpr_write_b32 a55, v63
  s_waitcnt vmcnt(0)
  ds_read_b64_tr_b16 v[64:65], v99 offset:27648
  ds_read_b64_tr_b16 v[66:67], v99 offset:28032
  ds_read_b64_tr_b16 v[68:69], v99 offset:27680
  ds_read_b64_tr_b16 v[70:71], v99 offset:28064
  ds_read_b64_tr_b16 v[72:73], v99 offset:27712
  ds_read_b64_tr_b16 v[74:75], v99 offset:28096
  s_waitcnt lgkmcnt(0)
  v_lshlrev_b32 v50, 16, v64
  v_and_b32 v64, 0xffff0000, v64
  v_cvt_pk_f16_f32 v64, v50, v64
  v_accvgpr_write_b32 a16, v64
  v_lshlrev_b32 v50, 16, v65
  v_and_b32 v65, 0xffff0000, v65
  v_cvt_pk_f16_f32 v65, v50, v65
  v_accvgpr_write_b32 a17, v65
  v_lshlrev_b32 v50, 16, v66
  v_and_b32 v66, 0xffff0000, v66
  v_cvt_pk_f16_f32 v66, v50, v66
  v_accvgpr_write_b32 a18, v66
  v_lshlrev_b32 v50, 16, v67
  v_and_b32 v67, 0xffff0000, v67
  v_cvt_pk_f16_f32 v67, v50, v67
  v_accvgpr_write_b32 a19, v67
  v_lshlrev_b32 v50, 16, v68
  v_and_b32 v68, 0xffff0000, v68
  v_cvt_pk_f16_f32 v68, v50, v68
  v_accvgpr_write_b32 a36, v68
  v_lshlrev_b32 v50, 16, v69
  v_and_b32 v69, 0xffff0000, v69
  v_cvt_pk_f16_f32 v69, v50, v69
  v_accvgpr_write_b32 a37, v69
  v_lshlrev_b32 v50, 16, v70
  v_and_b32 v70, 0xffff0000, v70
  v_cvt_pk_f16_f32 v70, v50, v70
  v_accvgpr_write_b32 a38, v70
  v_lshlrev_b32 v50, 16, v71
  v_and_b32 v71, 0xffff0000, v71
  v_cvt_pk_f16_f32 v71, v50, v71
  v_accvgpr_write_b32 a39, v71
  v_lshlrev_b32 v50, 16, v72
  v_and_b32 v72, 0xffff0000, v72
  v_cvt_pk_f16_f32 v72, v50, v72
  v_accvgpr_write_b32 a56, v72
  v_lshlrev_b32 v50, 16, v73
  v_and_b32 v73, 0xffff0000, v73
  v_cvt_pk_f16_f32 v73, v50, v73
  v_accvgpr_write_b32 a57, v73
  v_lshlrev_b32 v50, 16, v74
  v_and_b32 v74, 0xffff0000, v74
  v_cvt_pk_f16_f32 v74, v50, v74
  v_accvgpr_write_b32 a58, v74
  v_lshlrev_b32 v50, 16, v75
  v_and_b32 v75, 0xffff0000, v75
  v_cvt_pk_f16_f32 v75, v50, v75
  v_accvgpr_write_b32 a59, v75
  s_waitcnt vmcnt(0)
  s_barrier
  s_add_u32 s12, s44, 81068032
  s_addc_u32 s13, s45, 0
  s_mov_b32 s14, 116736
  s_mov_b32 s15, 0x00020000
  s_add_u32 s28, s44, 122683392
  s_addc_u32 s29, s45, 0
  s_mov_b32 s30, 83886080
  s_mov_b32 s31, 0x00020000
  s_mul_i32 s64, s59, 40960
  s_lshl_b32 s21, s87, 10
  s_add_u32 s64, s64, s21
  s_add_u32 s64, s64, 1310720
  s_lshl_b32 s79, s59, 7
  s_and_b32 s21, s51, 12
  s_add_u32 s79, s79, s21
  s_add_u32 s79, s79, 95232
  v_mov_b32 v94, 0
  v_mov_b32 v95, 0
  s_lshl_b32 s90, s58, 7
  s_lshl_b32 s21, s56, 3
  s_add_u32 s90, s90, s21
  s_add_u32 s90, s90, 19456
  s_cmp_eq_u32 s56, 0
  s_cselect_b32 s65, s90, 0x80000000
  s_mov_b32 s69, 0
  v_lshlrev_b32 v88, 3, v1
  s_cmp_lg_u32 s20, 0
  s_cbranch_scc1 fm_9
  s_bfe_u32 s82, s50, 0x10001
  s_lshl_b32 s82, s82, 5
  s_lshr_b32 s21, s50, 2
  s_add_u32 s82, s82, s21
  s_and_b32 s80, s50, 1
  s_lshl_b32 s80, s80, 4
  s_add_u32 s80, s80, 16
  s_mov_b32 s101, 0
  s_branch fm_10
fm_8:
  s_sleep 8
  buffer_load_dword v238, v239, s[32:35], 0 offen sc1
  s_add_u32 s101, s101, 1
  s_cmp_gt_u32 s101, 131072
  s_cbranch_scc1 end0
  s_waitcnt vmcnt(0)
fm_10:
  v_readlane_b32 s22, v238, 0
  v_readlane_b32 s23, v238, 32
  s_add_u32 s22, s22, s23
  v_readlane_b32 s23, v238, 1
  s_add_u32 s22, s22, s23
  v_readlane_b32 s23, v238, 33
  s_add_u32 s22, s22, s23
  v_readlane_b32 s23, v238, 2
  s_add_u32 s22, s22, s23
  v_readlane_b32 s23, v238, 34
  s_add_u32 s22, s22, s23
  v_readlane_b32 s23, v238, 3
  s_add_u32 s22, s22, s23
  v_readlane_b32 s23, v238, 35
  s_add_u32 s22, s22, s23
  v_readlane_b32 s21, v238, 19
  v_readlane_b32 s23, v238, 21
  s_cmp_ge_u32 s22, 256
  s_cselect_b32 s23, s23, 0
  s_cmp_ge_u32 s21, 32
  s_cselect_b32 s23, s23, 0
  s_cmp_eq_u32 s23, 0
  s_cbranch_scc1 fm_8
  v_readlane_b32 s21, v238, s82
  s_cmp_ge_u32 s21, s80
  s_cselect_b32 s81, 1, 0
  s_andn2_b32 s53, s81, s53
  v_mov_b32 v244, s23
  v_mov_b32 v245, s53
  v_mov_b32 v236, 0
  ds_write_b64 v236, v[244:245]
  s_waitcnt lgkmcnt(0)
fm_9:
  s_barrier
  v_mov_b32 v236, 0
  ds_read_b64 v[244:245], v236
  buffer_load_dword v94, v95, s[12:15], s79 offen sc1
  s_and_b32 s21, s51, 3
  s_mul_i32 s21, s21, 540672
  buffer_load_dwordx2 v[96:97], v9, s[8:11], s21 offen sc1
  buffer_load_dwordx4 v[96:99], v8, s[8:11], s21 offen offset:0 sc1
  buffer_load_dwordx4 v[96:99], v8, s[8:11], s21 offen offset:1024 sc1
  buffer_load_dwordx4 v[96:99], v10, s[8:11], s21 offen offset:0 sc1
  buffer_load_dwordx4 v[96:99], v10, s[8:11], s21 offen offset:1024 sc1
  buffer_load_dwordx4 v[96:99], v10, s[8:11], s21 offen offset:2048 sc1
  s_waitcnt lgkmcnt(0)
  v_readfirstlane_b32 s53, v245
  v_add_u32 v237, -1, v244
  v_lshlrev_b32 v237, 13, v237
  v_xor_b32 v237, 0, v237
  v_add_u32 v13, v13, v237
  v_add_u32 v4, v4, v237
  s_lshl_b32 s21, s50, 7
  s_add_u32 s21, s21, 0
  s_cmp_lg_u32 s20, 0
  s_cbranch_scc1 wf_12
  v_mov_b32 v240, 0
  s_mov_b32 s101, 0
wf_11:
  buffer_load_dword v241, v240, s[12:15], s21 offen sc1
  s_add_u32 s101, s101, 1
  s_cmp_gt_u32 s101, 131072
  s_cbranch_scc1 end0
  s_waitcnt vmcnt(0)
  v_readfirstlane_b32 s100, v241
  s_cmp_ge_u32 s100, 8
  s_cbranch_scc1 wf_12
  s_sleep 6
  s_branch wf_11
wf_12:
  s_barrier
  s_cmp_ge_u32 s20, 2
  s_cbranch_scc1 pf_13
  buffer_load_dwordx4 v[168:171], v18, s[16:19], 0 offen sc1
  buffer_load_dwordx2 v[172:173], v20, s[16:19], 0 offen sc1
pf_13:
  s_waitcnt vmcnt(6)
  v_readfirstlane_b32 s21, v94
  s_mov_b32 s87, 1
  s_cmp_eq_u32 s21, 0
  s_cbranch_scc1 pf_14
  s_mov_b32 s87, 0
  s_sub_u32 s21, s64, 1310720
  buffer_load_dwordx4 v[176:179], v16, s[28:31], s21 offen offset:0 sc1
  buffer_load_dwordx4 v[180:183], v16, s[28:31], s21 offen offset:1024 sc1
  buffer_load_dwordx4 v[184:187], v16, s[28:31], s21 offen offset:2048 sc1
pf_14:
  s_lshl_b32 s21, s20, 2
  s_add_u32 s21, s21, 34816
  v_add_u32 v242, s21, v16
  v_bfe_u32 v243, v1, 2, 3
  v_lshlrev_b32 v243, 4, v243
  v_add_u32 v243, 34816, v243
  s_mov_b32 s52, 0
  s_mov_b32 s89, 0x05040100
  v_mov_b32 v52, 0
  v_mov_b32 v53, 0
  v_mov_b32 v54, 0
  v_mov_b32 v55, 0
  v_mov_b32 v56, 0
  v_mov_b32 v57, 0
  v_mov_b32 v58, 0
  v_mov_b32 v59, 0
  v_mov_b32 v60, 0
  v_mov_b32 v61, 0
  v_mov_b32 v62, 0
  v_mov_b32 v63, 0
  v_mov_b32 v64, 0
  v_mov_b32 v65, 0
  v_mov_b32 v66, 0
  v_mov_b32 v67, 0
  v_mov_b32 v68, 0
  v_mov_b32 v69, 0
  v_mov_b32 v70, 0
  v_mov_b32 v71, 0
  v_mov_b32 v72, 0
  v_mov_b32 v73, 0
  v_mov_b32 v74, 0
  v_mov_b32 v75, 0
  v_mov_b32 v76, 0
  v_mov_b32 v77, 0
  v_mov_b32 v78, 0
  v_mov_b32 v79, 0
  v_mov_b32 v80, 0
  v_mov_b32 v81, 0
  v_mov_b32 v82, 0
  v_mov_b32 v83, 0
  v_mov_b32 v84, 0
  v_mov_b32 v85, 0
  v_mov_b32 v86, 0
  v_mov_b32 v87, 0
  v_mov_b32 v156, 0
  v_mov_b32 v157, 0
  v_mov_b32 v158, 0
  v_mov_b32 v159, 0
  s_and_b32 s21, s52, 3
  s_mul_i32 s81, s21, 540672
  s_lshl_b32 s84, s21, 15
  s_add_u32 s21, s52, 2
  s_and_b32 s21, s21, 3
  s_mul_i32 s82, s21, 540672
  s_add_u32 s21, s52, 3
  s_and_b32 s21, s21, 3
  s_lshl_b32 s83, s21, 15
  s_add_u32 s21, s52, 1
  s_and_b32 s22, s21, 3
  s_lshl_b32 s3, s22, 15
  s_mul_i32 s80, s21, 393216
  s_add_u32 s46, s21, 1
  s_min_u32 s46, s46, 64
  s_mul_i32 s85, s52, 98304
  s_mul_i32 s57, s52, 327680
  s_add_u32 s57, s57, 51380224

  s_bfe_u32 s88, s52, 0x10002
  s_add_u32 s78, s81, 278528
  s_max_u32 s21, s52, 1
  s_sub_u32 s21, s21, 1
  s_cmp_lt_u32 s52, 98
  s_cselect_b32 s66, s65, 0x80000000
  s_cselect_b32 s68, 15, 1
  s_cmp_ge_u32 s52, 99
  s_cselect_b32 s66, s90, s66
  s_cselect_b32 s67, s52, s21
  s_cmp_eq_u32 s53, 0
  s_cbranch_scc1 A1_19
  s_cmp_eq_u32 s20, 0
  s_cbranch_scc1 A1_15
  s_cmp_eq_u32 s20, 1
  s_cbranch_scc1 A1_16
  s_cmp_eq_u32 s20, 2
  s_cbranch_scc1 A1_17
  s_cmp_eq_u32 s20, 3
  s_cbranch_scc1 A1_18
  s_branch A1_19
step_20:
  s_add_u32 s21, s52, 2
  s_and_b32 s21, s21, 3
  s_mul_i32 s82, s21, 540672
  s_add_u32 s21, s52, 3
  s_and_b32 s21, s21, 3
  s_lshl_b32 s83, s21, 15
  s_add_u32 s21, s52, 1
  s_and_b32 s22, s21, 3
  s_lshl_b32 s3, s22, 15
  s_mul_i32 s80, s21, 393216
  s_add_u32 s46, s21, 1
  s_min_u32 s46, s46, 64
  s_mul_i32 s85, s52, 98304
  s_mul_i32 s57, s52, 327680
  s_add_u32 s57, s57, 51380224

  s_bfe_u32 s88, s52, 0x10002
  s_add_u32 s78, s81, 278528
  s_max_u32 s21, s52, 1
  s_sub_u32 s21, s21, 1
  s_cmp_lt_u32 s52, 98
  s_cselect_b32 s66, s65, 0x80000000
  s_cselect_b32 s68, 15, 1
  s_cmp_ge_u32 s52, 99
  s_cselect_b32 s66, s90, s66
  s_cselect_b32 s67, s52, s21
  v_mov_b32 v52, 0
  v_mov_b32 v53, 0
  v_mov_b32 v54, 0
  v_mov_b32 v55, 0
  v_mov_b32 v56, 0
  v_mov_b32 v57, 0
  v_mov_b32 v58, 0
  v_mov_b32 v59, 0
  v_mov_b32 v60, 0
  v_mov_b32 v61, 0
  v_mov_b32 v62, 0
  v_mov_b32 v63, 0
  v_mov_b32 v64, 0
  v_mov_b32 v65, 0
  v_mov_b32 v66, 0
  v_mov_b32 v67, 0
  v_mov_b32 v68, 0
  v_mov_b32 v69, 0
  v_mov_b32 v70, 0
  v_mov_b32 v71, 0
  v_mov_b32 v72, 0
  v_mov_b32 v73, 0
  v_mov_b32 v74, 0
  v_mov_b32 v75, 0
  v_mov_b32 v76, 0
  v_mov_b32 v77, 0
  v_mov_b32 v78, 0
  v_mov_b32 v79, 0
  v_mov_b32 v80, 0
  v_mov_b32 v81, 0
  v_mov_b32 v82, 0
  v_mov_b32 v83, 0
  v_mov_b32 v84, 0
  v_mov_b32 v85, 0
  v_mov_b32 v86, 0
  v_mov_b32 v87, 0
  s_sleep 4
  v_readfirstlane_b32 s21, v94
  s_cmp_lt_u32 s21, s46
  s_cselect_b32 s55, s55, 0
  s_cmp_lt_i32 s55, 0
  s_cbranch_scc1 fl_24
fl_25:
  s_mov_b32 s54, 0
  buffer_load_dwordx4 v[40:43], v4, s[4:7], s84 offen offset:2048 sc1
  buffer_load_dwordx4 v[32:35], v4, s[4:7], s84 offen offset:0 sc1
  buffer_load_dwordx4 v[36:39], v4, s[4:7], s84 offen offset:1024 sc1
  s_waitcnt vmcnt(3)
  v_mov_b32 v176, v160
  v_mov_b32 v177, v161
  v_mov_b32 v178, v162
  v_mov_b32 v179, v163
  v_mov_b32 v180, v164
  v_mov_b32 v181, v165
  v_mov_b32 v182, v166
  v_mov_b32 v183, v167
  v_mov_b32 v184, v48
  v_mov_b32 v185, v49
  v_mov_b32 v186, v50
  v_mov_b32 v187, v51
lm_27:
  s_waitcnt vmcnt(2)
  v_smfmac_f32_16x16x32_f16 v[52:55], v[40:41], a[16:19], v44
  v_smfmac_f32_16x16x32_f16 v[64:67], v[40:41], a[76:79], v44
  v_smfmac_f32_16x16x32_f16 v[56:59], v[40:41], a[36:39], v44
  s_waitcnt vmcnt(0)
  v_bitop3_b32 v27, v35, v39, v43 bitop3:0x80
  v_perm_b32 v35, v39, v35, s89
  v_cmp_gt_u32 vcc, 0x48000000, v27
  v_mov_b32 v39, v42
  v_smfmac_f32_16x16x32_f16 v[68:71], v[40:41], a[96:99], v44
  s_cbranch_vccnz pm_30
A2_29:
  v_smfmac_f32_16x16x64_f16 v[52:55], v[32:35], a[0:7], v44
  v_smfmac_f32_16x16x64_f16 v[52:55], v[36:39], a[8:15], v44
  v_smfmac_f32_16x16x64_f16 v[64:67], v[32:35], a[60:67], v44
  v_smfmac_f32_16x16x64_f16 v[64:67], v[36:39], a[68:75], v44
  v_smfmac_f32_16x16x32_f16 v[60:63], v[40:41], a[56:59], v44
  v_cvt_pk_f16_f32 v52, v52, v53
  v_cvt_pk_f16_f32 v53, v54, v55
  v_smfmac_f32_16x16x32_f16 v[72:75], v[40:41], a[116:119], v44
  v_smfmac_f32_16x16x32_f16 v[76:79], v[40:41], a[136:139], v44
  v_cvt_pk_f16_f32 v64, v64, v65
  v_cvt_pk_f16_f32 v65, v66, v67
  s_nop 0
  v_smfmac_f32_16x16x64_f16 v[56:59], v[32:35], a[20:27], v44
  v_permlane32_swap_b32 v52, v64
  v_smfmac_f32_16x16x64_f16 v[56:59], v[36:39], a[28:35], v44
  v_permlane32_swap_b32 v53, v65
  v_pk_add_f16 v52, v52, v64
  v_smfmac_f32_16x16x64_f16 v[68:71], v[32:35], a[80:87], v44
  v_pk_add_f16 v53, v53, v65
  v_smfmac_f32_16x16x64_f16 v[68:71], v[36:39], a[88:95], v44
  ds_write_b64 v5, v[52:53] offset:0
  v_smfmac_f32_16x16x32_f16 v[80:83], v[40:41], a[156:159], v44
  v_cvt_pk_f16_f32 v56, v56, v57
  v_cvt_pk_f16_f32 v57, v58, v59
  v_smfmac_f32_16x16x32_f16 v[84:87], v[40:41], a[176:179], v44
  v_cvt_pk_f16_f32 v68, v68, v69
  v_cvt_pk_f16_f32 v69, v70, v71
  s_nop 0
  v_smfmac_f32_16x16x64_f16 v[60:63], v[32:35], a[40:47], v44
  v_permlane32_swap_b32 v56, v68
  v_smfmac_f32_16x16x64_f16 v[60:63], v[36:39], a[48:55], v44
  v_permlane32_swap_b32 v57, v69
  v_pk_add_f16 v56, v56, v68
  v_smfmac_f32_16x16x64_f16 v[72:75], v[32:35], a[100:107], v44
  v_pk_add_f16 v57, v57, v69
  v_smfmac_f32_16x16x64_f16 v[72:75], v[36:39], a[108:115], v44
  ds_write_b64 v5, v[56:57] offset:640
  v_smfmac_f32_16x16x64_f16 v[76:79], v[32:35], a[120:127], v44
  v_cvt_pk_f16_f32 v60, v60, v61
  v_cvt_pk_f16_f32 v61, v62, v63
  v_smfmac_f32_16x16x64_f16 v[76:79], v[36:39], a[128:135], v44
  v_cvt_pk_f16_f32 v72, v72, v73
  v_cvt_pk_f16_f32 v73, v74, v75
  s_nop 0
  v_smfmac_f32_16x16x64_f16 v[80:83], v[32:35], a[140:147], v44
  v_permlane32_swap_b32 v60, v72
  v_smfmac_f32_16x16x64_f16 v[80:83], v[36:39], a[148:155], v44
  v_permlane32_swap_b32 v61, v73
  v_pk_add_f16 v60, v60, v72
  v_smfmac_f32_16x16x64_f16 v[84:87], v[32:35], a[160:167], v44
  v_pk_add_f16 v61, v61, v73
  v_smfmac_f32_16x16x64_f16 v[84:87], v[36:39], a[168:175], v44
  ds_write_b64 v5, v[60:61] offset:1280
  v_cvt_pk_f16_f32 v76, v76, v77
  v_cvt_pk_f16_f32 v77, v78, v79
  v_cvt_pk_f16_f32 v80, v80, v81
  v_cvt_pk_f16_f32 v81, v82, v83
  s_nop 0
  v_permlane32_swap_b32 v76, v80
  v_permlane32_swap_b32 v77, v81
  v_pk_add_f16 v76, v76, v80
  v_pk_add_f16 v77, v77, v81
  ds_write_b64 v5, v[76:77] offset:1920
  v_cvt_pk_f16_f32 v84, v84, v85
  v_cvt_pk_f16_f32 v85, v86, v87
  ds_write_b64 v5, v[84:85] offset:2560
  s_waitcnt lgkmcnt(0) vmcnt(0)
  s_barrier
  ds_read_b64_tr_b16 v[104:105], v45 offset:0
  ds_read_b64_tr_b16 v[106:107], v45 offset:3200
  ds_read_b64_tr_b16 v[108:109], v45 offset:640
  ds_read_b64_tr_b16 v[110:111], v45 offset:3840
  ds_read_b64_tr_b16 v[112:113], v45 offset:1280
  ds_read_b64_tr_b16 v[114:115], v45 offset:4480
  s_waitcnt lgkmcnt(4)
  v_fma_mix_f32 v120, v104, 1.0, v106 op_sel:[0,0,0] op_sel_hi:[1,0,1]
  v_fma_mix_f32 v121, v104, 1.0, v106 op_sel:[1,0,1] op_sel_hi:[1,0,1]
  v_fma_mix_f32 v122, v105, 1.0, v107 op_sel:[0,0,0] op_sel_hi:[1,0,1]
  v_fma_mix_f32 v123, v105, 1.0, v107 op_sel:[1,0,1] op_sel_hi:[1,0,1]
  v_add_f32_dpp v124, v120, v120 row_ror:8 row_mask:0xf bank_mask:0xf
  v_add_f32_dpp v125, v121, v121 row_ror:8 row_mask:0xf bank_mask:0xf
  v_add_f32_dpp v126, v122, v122 row_ror:8 row_mask:0xf bank_mask:0xf
  v_add_f32_dpp v127, v123, v123 row_ror:8 row_mask:0xf bank_mask:0xf
  v_cvt_pk_bf16_f32 v212, v124, v125
  v_cvt_pk_bf16_f32 v213, v126, v127
  s_waitcnt lgkmcnt(2)
  v_fma_mix_f32 v120, v108, 1.0, v110 op_sel:[0,0,0] op_sel_hi:[1,0,1]
  v_fma_mix_f32 v121, v108, 1.0, v110 op_sel:[1,0,1] op_sel_hi:[1,0,1]
  v_fma_mix_f32 v122, v109, 1.0, v111 op_sel:[0,0,0] op_sel_hi:[1,0,1]
  v_fma_mix_f32 v123, v109, 1.0, v111 op_sel:[1,0,1] op_sel_hi:[1,0,1]
  v_add_f32_dpp v124, v120, v120 row_ror:8 row_mask:0xf bank_mask:0xf
  v_add_f32_dpp v125, v121, v121 row_ror:8 row_mask:0xf bank_mask:0xf
  v_add_f32_dpp v126, v122, v122 row_ror:8 row_mask:0xf bank_mask:0xf
  v_add_f32_dpp v127, v123, v123 row_ror:8 row_mask:0xf bank_mask:0xf
  v_cvt_pk_bf16_f32 v214, v124, v125
  v_cvt_pk_bf16_f32 v215, v126, v127
  s_waitcnt lgkmcnt(0)
  v_fma_mix_f32 v120, v112, 1.0, v114 op_sel:[0,0,0] op_sel_hi:[1,0,1]
  v_fma_mix_f32 v121, v112, 1.0, v114 op_sel:[1,0,1] op_sel_hi:[1,0,1]
  v_fma_mix_f32 v122, v113, 1.0, v115 op_sel:[0,0,0] op_sel_hi:[1,0,1]
  v_fma_mix_f32 v123, v113, 1.0, v115 op_sel:[1,0,1] op_sel_hi:[1,0,1]
  v_mfma_f32_16x16x32_bf16 v[96:99], v[168:171], v[212:215], 0
  v_add_f32_dpp v124, v120, v120 row_ror:8 row_mask:0xf bank_mask:0xf
  v_add_f32_dpp v125, v121, v121 row_ror:8 row_mask:0xf bank_mask:0xf
  v_add_f32_dpp v126, v122, v122 row_ror:8 row_mask:0xf bank_mask:0xf
  v_add_f32_dpp v127, v123, v123 row_ror:8 row_mask:0xf bank_mask:0xf
  v_cvt_pk_bf16_f32 v216, v124, v125
  v_cvt_pk_bf16_f32 v217, v126, v127
  s_nop 1
  v_mfma_f32_16x16x32_bf16 v[96:99], v[172:175], v[216:219], v[96:99]
  s_mov_b64 exec, s[74:75]
  s_nop 6
  v_cvt_pk_f16_f32 v100, v96, v97
  v_cvt_pk_f16_f32 v101, v98, v99
  v_and_or_b32 v100, v100, -2, s88
  buffer_store_dwordx2 v[100:101], v7, s[8:11], s81 offen
  s_mov_b64 exec, -1
  s_cmp_eq_u32 s52, 63
  s_cbranch_scc1 last_21
  s_sleep 4
  s_nop 7
  s_mov_b32 s54, 0
  buffer_load_dwordx2 v[248:249], v9, s[8:11], s81 offen sc1
  buffer_load_dwordx4 v[112:115], v8, s[8:11], s81 offen offset:0 sc1
  buffer_load_dwordx4 v[116:119], v8, s[8:11], s81 offen offset:1024 sc1
  s_sleep 2
  buffer_load_dwordx4 v[144:147], v10, s[8:11], s81 offen offset:0 sc1
  buffer_load_dwordx4 v[148:151], v10, s[8:11], s81 offen offset:1024 sc1
  buffer_load_dwordx4 v[152:155], v10, s[8:11], s81 offen offset:2048 sc1
  v_mov_b32 v188, 0
  v_mov_b32 v189, 0
  v_mov_b32 v190, 0
  v_mov_b32 v191, 0
  v_mov_b32 v192, 0
  v_mov_b32 v193, 0
  v_mov_b32 v194, 0
  v_mov_b32 v195, 0
  v_mov_b32 v196, 0
  v_mov_b32 v197, 0
  v_mov_b32 v198, 0
  v_mov_b32 v199, 0
  v_readfirstlane_b32 s21, v94
  s_add_u32 s22, s46, 3
  s_min_u32 s22, s22, 64
  s_sub_u32 s55, s21, s22
  s_sub_u32 s56, s21, s46
  s_cmp_lt_i32 s56, 0
  s_cbranch_scc1 kvw_35
kvok_36:
  s_waitcnt vmcnt(5)
  v_xor_b32 v96, s88, v248
  s_nop 0
  v_permlane16_swap_b32 v248, v249
  v_fma_mix_f32 v250, v248, 1.0, v249 op_sel:[0,0,0] op_sel_hi:[1,0,1]
  v_fma_mix_f32 v251, v248, 1.0, v249 op_sel:[1,0,1] op_sel_hi:[1,0,1]
  v_mov_b32 v248, v250
  v_mov_b32 v249, v251
  s_nop 0
  v_permlane32_swap_b32 v248, v250
  v_permlane32_swap_b32 v249, v251
  v_pk_add_f32 v[124:125], v[248:249], v[250:251]
  v_max_f32 v238, v124, v125
  s_waitcnt vmcnt(3)
  v_pk_add_f16 v100, v112, v116
  v_pk_add_f16 v102, v114, v118
  v_pk_add_f16 v101, v113, v117
  v_pk_add_f16 v103, v115, v119
  v_permlane32_swap_b32 v100, v102
  v_bitop3_b32 v97, v112, v114, s88 bitop3:0x7e
  v_permlane32_swap_b32 v101, v103
  v_bitop3_b32 v98, v116, v118, s88 bitop3:0x7e
  v_fma_mix_f32 v120, v100, 1.0, v102 op_sel:[0,0,0] op_sel_hi:[1,0,1]
  v_or3_b32 v27, v96, v97, v98
  v_fma_mix_f32 v121, v100, 1.0, v102 op_sel:[1,0,1] op_sel_hi:[1,0,1]
  v_and_b32 v27, 1, v27
  v_fma_mix_f32 v122, v101, 1.0, v103 op_sel:[0,0,0] op_sel_hi:[1,0,1]
  v_cmp_ne_u32 vcc, 0, v27
  v_fma_mix_f32 v123, v101, 1.0, v103 op_sel:[1,0,1] op_sel_hi:[1,0,1]
  v_max3_f32 v236, v120, v121, v238
  s_cbranch_vccnz psr_32
psj_33:
  v_max3_f32 v236, v236, v122, v123
  s_nop 1
  v_max_f32_dpp v236, v236, v236 row_ror:8 row_mask:0xf bank_mask:0xf
  v_mov_b32 v237, v236
  s_waitcnt vmcnt(0)
  v_max3_u32 v27, v144, v146, v148
  v_permlane32_swap_b32 v236, v237
  v_max_f32 v236, v236, v237
  v_mov_b32 v237, v236
  v_max3_u32 v27, v27, v150, v152
  v_max_u32 v27, v27, v154
  v_permlane16_swap_b32 v236, v237
  v_cmp_eq_u32 vcc, -1, v27
  v_max_f32 v236, v236, v237
  v_mul_f32 v236, s86, v236
  s_cbranch_vccnz pv_31
pvj_34:
  v_smfmac_f32_16x16x64_bf16 v[188:191], v[144:147], a[180:187], v44
  v_fma_f32 v120, v120, s86, -v236
  v_smfmac_f32_16x16x64_bf16 v[188:191], v[148:151], a[188:195], v44
  v_fma_f32 v121, v121, s86, -v236
  v_smfmac_f32_16x16x64_bf16 v[188:191], v[152:155], a[196:203], v44
  buffer_load_dwordx4 v[160:163], v17, s[28:31], s64 offen offset:0 sc1
  v_fma_f32 v122, v122, s86, -v236
  v_smfmac_f32_16x16x64_bf16 v[192:195], v[144:147], a[204:211], v44
  v_fma_f32 v123, v123, s86, -v236
  v_smfmac_f32_16x16x64_bf16 v[192:195], v[148:151], a[212:219], v44
  buffer_load_dwordx4 v[164:167], v16, s[28:31], s64 offen offset:1024 sc1
  v_fma_f32 v124, v124, s86, -v236
  v_smfmac_f32_16x16x64_bf16 v[192:195], v[152:155], a[220:227], v44
  v_fma_f32 v125, v125, s86, -v236
  v_smfmac_f32_16x16x64_bf16 v[196:199], v[144:147], a[228:235], v44
  buffer_load_dwordx4 v[48:51], v26, s[28:31], s64 offen offset:2048 sc1
  v_exp_f32 v120, v120
  v_smfmac_f32_16x16x64_bf16 v[196:199], v[148:151], a[236:243], v44
  v_exp_f32 v121, v121
  v_smfmac_f32_16x16x64_bf16 v[196:199], v[152:155], a[244:251], v44
  buffer_load_dwordx4 v[168:171], v18, s[16:19], s80 offen sc1
  v_exp_f32 v122, v122
  buffer_load_dwordx2 v[172:173], v20, s[16:19], s80 offen sc1
  v_exp_f32 v123, v123
  v_exp_f32 v124, v124
  s_cmp_lt_i32 s55, 0
  s_cbranch_scc1 fl_37
fl_38:
  v_exp_f32 v125, v125
  v_cvt_pk_bf16_f32 v220, v120, v121
  v_cvt_pk_bf16_f32 v221, v122, v123
  v_cvt_pk_bf16_f32 v224, v124, v125
  v_mov_b32_dpp v222, v220 row_ror:8 row_mask:0xf bank_mask:0xf
  v_mov_b32_dpp v223, v221 row_ror:8 row_mask:0xf bank_mask:0xf
  v_mov_b32_dpp v225, v224 row_ror:8 row_mask:0xf bank_mask:0xf
  v_cvt_pk_bf16_f32 v228, v188, v189
  v_mfma_f32_16x16x32_bf16 v[200:203], v[176:179], v[220:223], 0
  v_cvt_pk_bf16_f32 v229, v190, v191
  v_cvt_pk_bf16_f32 v230, v192, v193
  v_mfma_f32_16x16x32_bf16 v[204:207], v[180:183], v[220:223], 0
  v_cvt_pk_bf16_f32 v231, v194, v195
  v_cvt_pk_bf16_f32 v232, v196, v197
  v_mfma_f32_16x16x32_bf16 v[208:211], v[184:187], v[220:223], 0
  v_cvt_pk_bf16_f32 v233, v198, v199
  v_add_f32 v126, v120, v121
  v_mfma_f32_16x16x32_bf16 v[200:203], v[228:231], v[224:227], v[200:203]
  v_add_f32 v127, v122, v123
  v_add_f32 v128, v124, v125
  v_mfma_f32_16x16x32_bf16 v[204:207], v[230:233], v[224:227], v[204:207]
  v_add_f32 v236, v126, v127
  v_fmac_f32 v236, v128, v89
  v_mfma_f32_16x16x32_bf16 v[208:211], v[232:235], v[224:227], v[208:211]
  s_nop 0
  v_add_f32_dpp v236, v236, v236 row_ror:8 row_mask:0xf bank_mask:0xf
  v_mov_b32 v237, v236
  ds_write_b128 v11, v[200:203] offset:0
  s_nop 0
  v_permlane32_swap_b32 v236, v237
  v_add_f32 v236, v236, v237
  v_mov_b32 v237, v236
  ds_write_b128 v11, v[204:207] offset:1024
  s_nop 0
  v_permlane16_swap_b32 v236, v237
  v_add_f32 v236, v236, v237
  v_rcp_f32 v236, v236
  ds_write_b128 v11, v[208:211] offset:2048
  s_mov_b64 exec, 0xff
  ds_write_b32 v242, v236
  s_mov_b64 exec, -1
  s_waitcnt lgkmcnt(0)
  s_barrier
  ds_read_b128 v[104:107], v243
  ds_read_b64 v[96:97], v12 offset:0
  ds_read_b64 v[98:99], v12 offset:3072
  ds_read_b64 v[100:101], v12 offset:6144
  ds_read_b64 v[102:103], v12 offset:9216
  s_waitcnt lgkmcnt(2)
  v_pk_mul_f32 v[96:97], v[96:97], v[104:105] op_sel_hi:[1,0]
  v_pk_fma_f32 v[96:97], v[98:99], v[104:105], v[96:97] op_sel:[0,1,0] op_sel_hi:[1,1,1]
  s_waitcnt lgkmcnt(0)
  v_pk_fma_f32 v[96:97], v[100:101], v[106:107], v[96:97] op_sel_hi:[1,0,1]
  v_pk_fma_f32 v[96:97], v[102:103], v[106:107], v[96:97] op_sel:[0,1,0] op_sel_hi:[1,1,1]
  v_cvt_pk_f16_f32 v100, v96, v97
  v_perm_b32 v100, s91, v100, v14
  buffer_atomic_pk_add_f16 v100, v13, s[4:7], s3 offen
  v_mov_b32 v200, v196
  v_mov_b32 v201, v197
  v_mov_b32 v202, v198
  v_mov_b32 v203, v199
  v_permlane32_swap_b32 v188, v192
  v_permlane32_swap_b32 v189, v193
  v_permlane32_swap_b32 v190, v194
  v_permlane32_swap_b32 v191, v195
  v_permlane32_swap_b32 v196, v200
  v_permlane32_swap_b32 v197, v201
  v_permlane32_swap_b32 v198, v202
  v_permlane32_swap_b32 v199, v203
  v_pk_add_f32 v[188:189], v[188:189], v[192:193]
  v_pk_add_f32 v[190:191], v[190:191], v[194:195]
  v_pk_add_f32 v[196:197], v[196:197], v[200:201]
  v_pk_add_f32 v[198:199], v[198:199], v[202:203]
  v_cvt_pk_bf16_f32 v252, v188, v189
  v_cvt_pk_bf16_f32 v254, v196, v197
  v_cvt_pk_bf16_f32 v253, v190, v191
  v_cvt_pk_bf16_f32 v255, v198, v199
  s_nop 0
  v_permlane16_swap_b32 v252, v254
  v_permlane16_swap_b32 v253, v255
  v_min_u32 v252, -2, v252
  s_mov_b64 exec, s[76:77]
  buffer_store_dwordx4 v[252:255], v15, s[24:27], s57 offen sc1
  s_mov_b64 exec, -1
  s_add_u32 s64, s64, 1310720
  s_add_u32 s52, s52, 1
  s_and_b32 s21, s52, 3
  s_mul_i32 s81, s21, 540672
  s_lshl_b32 s84, s21, 15
  s_branch step_20
fl_24:
  buffer_load_dword v94, v95, s[12:15], s79 offen sc1
  s_branch fl_25
A1_15:
  v_smfmac_f32_16x16x32_f16 v[52:55], v[40:41], a[16:19], v44
  v_smfmac_f32_16x16x32_f16 v[64:67], v[40:41], a[76:79], v44
  v_smfmac_f32_16x16x32_f16 v[56:59], v[40:41], a[36:39], v44
  v_smfmac_f32_16x16x32_f16 v[68:71], v[40:41], a[96:99], v44
  s_branch A2_29
pm_30:
  buffer_load_dwordx4 v[40:43], v4, s[4:7], s84 offen offset:2048 sc1
  buffer_load_dwordx4 v[32:35], v4, s[4:7], s84 offen offset:0 sc1
  buffer_load_dwordx4 v[36:39], v4, s[4:7], s84 offen offset:1024 sc1
  s_nop 7
  v_mov_b32 v52, 0
  v_mov_b32 v53, 0
  v_mov_b32 v54, 0
  v_mov_b32 v55, 0
  v_mov_b32 v64, 0
  v_mov_b32 v65, 0
  v_mov_b32 v66, 0
  v_mov_b32 v67, 0
  v_mov_b32 v56, 0
  v_mov_b32 v57, 0
  v_mov_b32 v58, 0
  v_mov_b32 v59, 0
  v_mov_b32 v68, 0
  v_mov_b32 v69, 0
  v_mov_b32 v70, 0
  v_mov_b32 v71, 0
  s_waitcnt vmcnt(0)
  v_bitop3_b32 v27, v35, v39, v43 bitop3:0x80
  v_perm_b32 v35, v39, v35, s89
  v_cmp_gt_u32 vcc, 0x48000000, v27
  v_mov_b32 v39, v42
  s_cbranch_vccz A1_15
pm_22:
  s_cmp_gt_u32 s52, 3
  s_cbranch_scc1 op_39
  v_readfirstlane_b32 s21, v94
  s_cmp_ge_u32 s21, s46
  s_cbranch_scc1 op_39
  buffer_load_dword v94, v95, s[12:15], s79 offen sc1
  s_waitcnt vmcnt(0)
  v_readfirstlane_b32 s21, v94
  s_add_u32 s22, s46, 3
  s_min_u32 s22, s22, 64
  s_sub_u32 s55, s21, s22
  s_sub_u32 s56, s21, s46
  s_cmp_gt_u32 s21, s52
  s_cselect_b32 s21, s87, 0
  s_cmp_eq_u32 s21, 0
  s_cbranch_scc1 op_39
  s_mov_b32 s87, 0
  s_sub_u32 s21, s64, 1310720
  buffer_load_dwordx4 v[176:179], v16, s[28:31], s21 offen offset:0 sc1
  buffer_load_dwordx4 v[180:183], v16, s[28:31], s21 offen offset:1024 sc1
  buffer_load_dwordx4 v[184:187], v16, s[28:31], s21 offen offset:2048 sc1
op_39:
  buffer_load_dwordx4 v[40:43], v4, s[4:7], s84 offen offset:2048 sc1
  buffer_load_dwordx4 v[32:35], v4, s[4:7], s84 offen offset:0 sc1
  buffer_load_dwordx4 v[36:39], v4, s[4:7], s84 offen offset:1024 sc1
  s_add_u32 s54, s54, 1
  s_cmp_gt_u32 s54, 131072
  s_cbranch_scc1 end0
  s_waitcnt vmcnt(0)
  v_bitop3_b32 v27, v35, v39, v43 bitop3:0x80
  v_perm_b32 v35, v39, v35, s89
  v_cmp_gt_u32 vcc, 0x48000000, v27
  v_mov_b32 v39, v42
  s_cbranch_vccnz pm_22
  s_branch A1_15
pv_31:
  buffer_load_dwordx4 v[144:147], v10, s[8:11], s81 offen offset:0 sc1
  buffer_load_dwordx4 v[148:151], v10, s[8:11], s81 offen offset:1024 sc1
  buffer_load_dwordx4 v[152:155], v10, s[8:11], s81 offen offset:2048 sc1
  s_add_u32 s54, s54, 1
  s_cmp_gt_u32 s54, 131072
  s_cbranch_scc1 end0
  s_waitcnt vmcnt(0)
  v_max3_u32 v27, v144, v146, v148
  v_max3_u32 v27, v27, v150, v152
  v_max3_u32 v27, v27, v154, v154
  v_cmp_eq_u32 vcc, -1, v27
  s_nop 1
  s_cbranch_vccnz pv_31
  s_branch pvj_34
psr_32:
  buffer_load_dwordx2 v[248:249], v9, s[8:11], s81 offen sc1
  buffer_load_dwordx4 v[112:115], v8, s[8:11], s81 offen offset:0 sc1
  buffer_load_dwordx4 v[116:119], v8, s[8:11], s81 offen offset:1024 sc1
  s_add_u32 s54, s54, 1
  s_cmp_gt_u32 s54, 131072
  s_cbranch_scc1 end0
  s_waitcnt vmcnt(2)
  v_xor_b32 v96, s88, v248
  s_nop 0
  v_permlane16_swap_b32 v248, v249
  v_fma_mix_f32 v250, v248, 1.0, v249 op_sel:[0,0,0] op_sel_hi:[1,0,1]
  v_fma_mix_f32 v251, v248, 1.0, v249 op_sel:[1,0,1] op_sel_hi:[1,0,1]
  v_mov_b32 v248, v250
  v_mov_b32 v249, v251
  s_nop 0
  v_permlane32_swap_b32 v248, v250
  v_permlane32_swap_b32 v249, v251
  v_pk_add_f32 v[124:125], v[248:249], v[250:251]
  v_max_f32 v238, v124, v125
  s_waitcnt vmcnt(0)
  v_pk_add_f16 v100, v112, v116
  v_pk_add_f16 v102, v114, v118
  v_pk_add_f16 v101, v113, v117
  v_pk_add_f16 v103, v115, v119
  v_permlane32_swap_b32 v100, v102
  v_bitop3_b32 v97, v112, v114, s88 bitop3:0x7e
  v_permlane32_swap_b32 v101, v103
  v_bitop3_b32 v98, v116, v118, s88 bitop3:0x7e
  v_fma_mix_f32 v120, v100, 1.0, v102 op_sel:[0,0,0] op_sel_hi:[1,0,1]
  v_or3_b32 v27, v96, v97, v98
  v_fma_mix_f32 v121, v100, 1.0, v102 op_sel:[1,0,1] op_sel_hi:[1,0,1]
  v_and_b32 v27, 1, v27
  v_fma_mix_f32 v122, v101, 1.0, v103 op_sel:[0,0,0] op_sel_hi:[1,0,1]
  v_cmp_ne_u32 vcc, 0, v27
  v_fma_mix_f32 v123, v101, 1.0, v103 op_sel:[1,0,1] op_sel_hi:[1,0,1]
  v_max3_f32 v236, v120, v121, v238
  s_cbranch_vccnz psr_32
  s_branch psj_33
kvw_35:
  s_mov_b32 s22, s87
  s_cmp_eq_u32 s52, 0
  s_cselect_b32 s23, s87, s46
  s_cselect_b32 s55, 0, s55
  s_cselect_b32 s87, 1, 0
  s_cmp_eq_u32 s23, 0
  s_cbranch_scc1 kvok_36
  v_mov_b32 v236, 0
  s_mov_b32 s101, 0
wf_40:
  buffer_load_dword v237, v236, s[12:15], s79 offen sc1
  s_add_u32 s101, s101, 1
  s_cmp_gt_u32 s101, 131072
  s_cbranch_scc1 end0
  s_waitcnt vmcnt(0)
  v_readfirstlane_b32 s100, v237
  s_cmp_ge_u32 s100, s23
  s_cbranch_scc1 wf_41
  s_sleep 3
  s_branch wf_40
wf_41:
  s_cmp_eq_u32 s22, 0
  s_cbranch_scc1 kvok_36
  s_sub_u32 s21, s64, 1310720
  buffer_load_dwordx4 v[176:179], v16, s[28:31], s21 offen offset:0 sc1
  buffer_load_dwordx4 v[180:183], v16, s[28:31], s21 offen offset:1024 sc1
  buffer_load_dwordx4 v[184:187], v16, s[28:31], s21 offen offset:2048 sc1
  s_waitcnt vmcnt(0)
  s_branch kvok_36
fl_37:
  buffer_load_dword v94, v95, s[12:15], s79 offen sc1
  s_branch fl_38
last_21:
  v_mov_b32 v188, 0
  v_mov_b32 v189, 0
  v_mov_b32 v190, 0
  v_mov_b32 v191, 0
  v_mov_b32 v192, 0
  v_mov_b32 v193, 0
  v_mov_b32 v194, 0
  v_mov_b32 v195, 0
  v_mov_b32 v196, 0
  v_mov_b32 v197, 0
  v_mov_b32 v198, 0
  v_mov_b32 v199, 0
  s_sleep 4
  s_mov_b32 s54, 0
lv_42:
  buffer_load_dwordx4 v[144:147], v10, s[8:11], s81 offen offset:0 sc1
  buffer_load_dwordx4 v[148:151], v10, s[8:11], s81 offen offset:1024 sc1
  buffer_load_dwordx4 v[152:155], v10, s[8:11], s81 offen offset:2048 sc1
  s_add_u32 s54, s54, 1
  s_cmp_gt_u32 s54, 131072
  s_cbranch_scc1 end0
  s_waitcnt vmcnt(0)
  v_max3_u32 v27, v144, v146, v148
  v_max3_u32 v27, v27, v150, v152
  v_max3_u32 v27, v27, v154, v154
  v_cmp_eq_u32 vcc, -1, v27
  s_nop 1
  s_cbranch_vccnz lv_42
  v_smfmac_f32_16x16x64_bf16 v[188:191], v[144:147], a[180:187], v44
  v_smfmac_f32_16x16x64_bf16 v[192:195], v[144:147], a[204:211], v44
  v_smfmac_f32_16x16x64_bf16 v[196:199], v[144:147], a[228:235], v44
  v_smfmac_f32_16x16x64_bf16 v[188:191], v[148:151], a[188:195], v44
  v_smfmac_f32_16x16x64_bf16 v[192:195], v[148:151], a[212:219], v44
  v_smfmac_f32_16x16x64_bf16 v[196:199], v[148:151], a[236:243], v44
  v_smfmac_f32_16x16x64_bf16 v[188:191], v[152:155], a[196:203], v44
  v_smfmac_f32_16x16x64_bf16 v[192:195], v[152:155], a[220:227], v44
  v_smfmac_f32_16x16x64_bf16 v[196:199], v[152:155], a[244:251], v44
  s_nop 7
  v_mov_b32 v200, v196
  v_mov_b32 v201, v197
  v_mov_b32 v202, v198
  v_mov_b32 v203, v199
  v_permlane32_swap_b32 v188, v192
  v_permlane32_swap_b32 v189, v193
  v_permlane32_swap_b32 v190, v194
  v_permlane32_swap_b32 v191, v195
  v_permlane32_swap_b32 v196, v200
  v_permlane32_swap_b32 v197, v201
  v_permlane32_swap_b32 v198, v202
  v_permlane32_swap_b32 v199, v203
  v_pk_add_f32 v[188:189], v[188:189], v[192:193]
  v_pk_add_f32 v[190:191], v[190:191], v[194:195]
  v_pk_add_f32 v[196:197], v[196:197], v[200:201]
  v_pk_add_f32 v[198:199], v[198:199], v[202:203]
  v_cvt_pk_bf16_f32 v252, v188, v189
  v_cvt_pk_bf16_f32 v254, v196, v197
  v_cvt_pk_bf16_f32 v253, v190, v191
  v_cvt_pk_bf16_f32 v255, v198, v199
  s_nop 0
  v_permlane16_swap_b32 v252, v254
  v_permlane16_swap_b32 v253, v255
  v_min_u32 v252, -2, v252
  s_mov_b64 exec, s[76:77]
  buffer_store_dwordx4 v[252:255], v15, s[24:27], s57 offen sc1
  s_mov_b64 exec, -1
  v_mov_b32 v246, 80
  v_mov_b32 v247, 1
  s_mov_b64 exec, 1
  buffer_atomic_add v247, v246, s[32:35], 0 offen sc0 sc1
  s_mov_b64 exec, -1
clm_43:
  s_branch chain_done
step_44:
  s_add_u32 s21, s52, 2
  s_and_b32 s21, s21, 3
  s_mul_i32 s82, s21, 540672
  s_add_u32 s21, s52, 3
  s_and_b32 s21, s21, 3
  s_lshl_b32 s83, s21, 15
  s_add_u32 s21, s52, 1
  s_and_b32 s22, s21, 3
  s_lshl_b32 s3, s22, 15
  s_mul_i32 s80, s21, 393216
  s_add_u32 s46, s21, 1
  s_min_u32 s46, s46, 64
  s_mul_i32 s85, s52, 98304
  s_mul_i32 s57, s52, 327680
  s_add_u32 s57, s57, 51380224

  s_bfe_u32 s88, s52, 0x10002
  s_add_u32 s78, s81, 278528
  s_max_u32 s21, s52, 1
  s_sub_u32 s21, s21, 1
  s_cmp_lt_u32 s52, 98
  s_cselect_b32 s66, s65, 0x80000000
  s_cselect_b32 s68, 15, 1
  s_cmp_ge_u32 s52, 99
  s_cselect_b32 s66, s90, s66
  s_cselect_b32 s67, s52, s21
  v_mov_b32 v52, 0
  v_mov_b32 v53, 0
  v_mov_b32 v54, 0
  v_mov_b32 v55, 0
  v_mov_b32 v56, 0
  v_mov_b32 v57, 0
  v_mov_b32 v58, 0
  v_mov_b32 v59, 0
  v_mov_b32 v60, 0
  v_mov_b32 v61, 0
  v_mov_b32 v62, 0
  v_mov_b32 v63, 0
  v_mov_b32 v64, 0
  v_mov_b32 v65, 0
  v_mov_b32 v66, 0
  v_mov_b32 v67, 0
  v_mov_b32 v68, 0
  v_mov_b32 v69, 0
  v_mov_b32 v70, 0
  v_mov_b32 v71, 0
  v_mov_b32 v72, 0
  v_mov_b32 v73, 0
  v_mov_b32 v74, 0
  v_mov_b32 v75, 0
  v_mov_b32 v76, 0
  v_mov_b32 v77, 0
  v_mov_b32 v78, 0
  v_mov_b32 v79, 0
  v_mov_b32 v80, 0
  v_mov_b32 v81, 0
  v_mov_b32 v82, 0
  v_mov_b32 v83, 0
  v_mov_b32 v84, 0
  v_mov_b32 v85, 0
  v_mov_b32 v86, 0
  v_mov_b32 v87, 0
  s_sleep 4
  v_readfirstlane_b32 s21, v94
  s_cmp_lt_u32 s21, s46
  s_cselect_b32 s55, s55, 0
  s_cmp_lt_i32 s55, 0
  s_cbranch_scc1 fl_48
fl_49:
  s_mov_b32 s54, 0
  buffer_load_dwordx4 v[40:43], v4, s[4:7], s84 offen offset:2048 sc1
  buffer_load_dwordx4 v[32:35], v4, s[4:7], s84 offen offset:0 sc1
  buffer_load_dwordx4 v[36:39], v4, s[4:7], s84 offen offset:1024 sc1
  s_waitcnt vmcnt(3)
  v_mov_b32 v176, v160
  v_mov_b32 v177, v161
  v_mov_b32 v178, v162
  v_mov_b32 v179, v163
  v_mov_b32 v180, v164
  v_mov_b32 v181, v165
  v_mov_b32 v182, v166
  v_mov_b32 v183, v167
  v_mov_b32 v184, v48
  v_mov_b32 v185, v49
  v_mov_b32 v186, v50
  v_mov_b32 v187, v51
lm_51:
  s_waitcnt vmcnt(2)
  v_smfmac_f32_16x16x32_f16 v[52:55], v[40:41], a[16:19], v44
  v_smfmac_f32_16x16x32_f16 v[64:67], v[40:41], a[76:79], v44
  v_smfmac_f32_16x16x32_f16 v[56:59], v[40:41], a[36:39], v44
  s_waitcnt vmcnt(0)
  v_bitop3_b32 v27, v35, v39, v43 bitop3:0x80
  v_perm_b32 v35, v39, v35, s89
  v_cmp_gt_u32 vcc, 0x48000000, v27
  v_mov_b32 v39, v42
  v_smfmac_f32_16x16x32_f16 v[68:71], v[40:41], a[96:99], v44
  s_cbranch_vccnz pm_54
A2_53:
  v_smfmac_f32_16x16x64_f16 v[52:55], v[32:35], a[0:7], v44
  v_smfmac_f32_16x16x64_f16 v[52:55], v[36:39], a[8:15], v44
  v_smfmac_f32_16x16x64_f16 v[64:67], v[32:35], a[60:67], v44
  v_smfmac_f32_16x16x64_f16 v[64:67], v[36:39], a[68:75], v44
  v_smfmac_f32_16x16x32_f16 v[60:63], v[40:41], a[56:59], v44
  v_cvt_pk_f16_f32 v52, v52, v53
  v_cvt_pk_f16_f32 v53, v54, v55
  v_smfmac_f32_16x16x32_f16 v[72:75], v[40:41], a[116:119], v44
  v_smfmac_f32_16x16x32_f16 v[76:79], v[40:41], a[136:139], v44
  v_cvt_pk_f16_f32 v64, v64, v65
  v_cvt_pk_f16_f32 v65, v66, v67
  s_nop 0
  v_smfmac_f32_16x16x64_f16 v[56:59], v[32:35], a[20:27], v44
  v_permlane32_swap_b32 v52, v64
  v_smfmac_f32_16x16x64_f16 v[56:59], v[36:39], a[28:35], v44
  v_permlane32_swap_b32 v53, v65
  v_pk_add_f16 v52, v52, v64
  v_smfmac_f32_16x16x64_f16 v[68:71], v[32:35], a[80:87], v44
  v_pk_add_f16 v53, v53, v65
  v_smfmac_f32_16x16x64_f16 v[68:71], v[36:39], a[88:95], v44
  ds_write_b64 v5, v[52:53] offset:0
  v_smfmac_f32_16x16x32_f16 v[80:83], v[40:41], a[156:159], v44
  v_cvt_pk_f16_f32 v56, v56, v57
  v_cvt_pk_f16_f32 v57, v58, v59
  v_smfmac_f32_16x16x32_f16 v[84:87], v[40:41], a[176:179], v44
  v_cvt_pk_f16_f32 v68, v68, v69
  v_cvt_pk_f16_f32 v69, v70, v71
  s_nop 0
  v_smfmac_f32_16x16x64_f16 v[60:63], v[32:35], a[40:47], v44
  v_permlane32_swap_b32 v56, v68
  v_smfmac_f32_16x16x64_f16 v[60:63], v[36:39], a[48:55], v44
  v_permlane32_swap_b32 v57, v69
  v_pk_add_f16 v56, v56, v68
  v_smfmac_f32_16x16x64_f16 v[72:75], v[32:35], a[100:107], v44
  v_pk_add_f16 v57, v57, v69
  v_smfmac_f32_16x16x64_f16 v[72:75], v[36:39], a[108:115], v44
  ds_write_b64 v5, v[56:57] offset:640
  v_smfmac_f32_16x16x64_f16 v[76:79], v[32:35], a[120:127], v44
  v_cvt_pk_f16_f32 v60, v60, v61
  v_cvt_pk_f16_f32 v61, v62, v63
  v_smfmac_f32_16x16x64_f16 v[76:79], v[36:39], a[128:135], v44
  v_cvt_pk_f16_f32 v72, v72, v73
  v_cvt_pk_f16_f32 v73, v74, v75
  s_nop 0
  v_smfmac_f32_16x16x64_f16 v[80:83], v[32:35], a[140:147], v44
  v_permlane32_swap_b32 v60, v72
  v_smfmac_f32_16x16x64_f16 v[80:83], v[36:39], a[148:155], v44
  v_permlane32_swap_b32 v61, v73
  v_pk_add_f16 v60, v60, v72
  v_smfmac_f32_16x16x64_f16 v[84:87], v[32:35], a[160:167], v44
  v_pk_add_f16 v61, v61, v73
  v_smfmac_f32_16x16x64_f16 v[84:87], v[36:39], a[168:175], v44
  ds_write_b64 v5, v[60:61] offset:1280
  v_cvt_pk_f16_f32 v76, v76, v77
  v_cvt_pk_f16_f32 v77, v78, v79
  v_cvt_pk_f16_f32 v80, v80, v81
  v_cvt_pk_f16_f32 v81, v82, v83
  s_nop 0
  v_permlane32_swap_b32 v76, v80
  v_permlane32_swap_b32 v77, v81
  v_pk_add_f16 v76, v76, v80
  v_pk_add_f16 v77, v77, v81
  ds_write_b64 v5, v[76:77] offset:1920
  v_cvt_pk_f16_f32 v84, v84, v85
  v_cvt_pk_f16_f32 v85, v86, v87
  ds_write_b64 v5, v[84:85] offset:2560
  s_waitcnt lgkmcnt(0) vmcnt(0)
  s_barrier
  ds_read_b64_tr_b16 v[104:105], v45 offset:0
  ds_read_b64_tr_b16 v[106:107], v45 offset:3200
  ds_read_b64_tr_b16 v[108:109], v45 offset:640
  ds_read_b64_tr_b16 v[110:111], v45 offset:3840
  ds_read_b64_tr_b16 v[112:113], v45 offset:1280
  ds_read_b64_tr_b16 v[114:115], v45 offset:4480
  s_waitcnt lgkmcnt(4)
  v_fma_mix_f32 v120, v104, 1.0, v106 op_sel:[0,0,0] op_sel_hi:[1,0,1]
  v_fma_mix_f32 v121, v104, 1.0, v106 op_sel:[1,0,1] op_sel_hi:[1,0,1]
  v_fma_mix_f32 v122, v105, 1.0, v107 op_sel:[0,0,0] op_sel_hi:[1,0,1]
  v_fma_mix_f32 v123, v105, 1.0, v107 op_sel:[1,0,1] op_sel_hi:[1,0,1]
  v_add_f32_dpp v124, v120, v120 row_ror:8 row_mask:0xf bank_mask:0xf
  v_add_f32_dpp v125, v121, v121 row_ror:8 row_mask:0xf bank_mask:0xf
  v_add_f32_dpp v126, v122, v122 row_ror:8 row_mask:0xf bank_mask:0xf
  v_add_f32_dpp v127, v123, v123 row_ror:8 row_mask:0xf bank_mask:0xf
  v_cvt_pk_bf16_f32 v212, v124, v125
  v_cvt_pk_bf16_f32 v213, v126, v127
  s_waitcnt lgkmcnt(2)
  v_fma_mix_f32 v120, v108, 1.0, v110 op_sel:[0,0,0] op_sel_hi:[1,0,1]
  v_fma_mix_f32 v121, v108, 1.0, v110 op_sel:[1,0,1] op_sel_hi:[1,0,1]
  v_fma_mix_f32 v122, v109, 1.0, v111 op_sel:[0,0,0] op_sel_hi:[1,0,1]
  v_fma_mix_f32 v123, v109, 1.0, v111 op_sel:[1,0,1] op_sel_hi:[1,0,1]
  v_add_f32_dpp v124, v120, v120 row_ror:8 row_mask:0xf bank_mask:0xf
  v_add_f32_dpp v125, v121, v121 row_ror:8 row_mask:0xf bank_mask:0xf
  v_add_f32_dpp v126, v122, v122 row_ror:8 row_mask:0xf bank_mask:0xf
  v_add_f32_dpp v127, v123, v123 row_ror:8 row_mask:0xf bank_mask:0xf
  v_cvt_pk_bf16_f32 v214, v124, v125
  v_cvt_pk_bf16_f32 v215, v126, v127
  s_waitcnt lgkmcnt(0)
  v_fma_mix_f32 v120, v112, 1.0, v114 op_sel:[0,0,0] op_sel_hi:[1,0,1]
  v_fma_mix_f32 v121, v112, 1.0, v114 op_sel:[1,0,1] op_sel_hi:[1,0,1]
  v_fma_mix_f32 v122, v113, 1.0, v115 op_sel:[0,0,0] op_sel_hi:[1,0,1]
  v_fma_mix_f32 v123, v113, 1.0, v115 op_sel:[1,0,1] op_sel_hi:[1,0,1]
  v_mfma_f32_16x16x32_bf16 v[96:99], v[168:171], v[212:215], 0
  v_add_f32_dpp v124, v120, v120 row_ror:8 row_mask:0xf bank_mask:0xf
  v_add_f32_dpp v125, v121, v121 row_ror:8 row_mask:0xf bank_mask:0xf
  v_add_f32_dpp v126, v122, v122 row_ror:8 row_mask:0xf bank_mask:0xf
  v_add_f32_dpp v127, v123, v123 row_ror:8 row_mask:0xf bank_mask:0xf
  v_cvt_pk_bf16_f32 v216, v124, v125
  v_cvt_pk_bf16_f32 v217, v126, v127
  s_nop 1
  v_mfma_f32_16x16x32_bf16 v[96:99], v[172:175], v[216:219], v[96:99]
  s_mov_b64 exec, s[74:75]
  s_nop 6
  v_cvt_pk_f16_f32 v100, v96, v97
  v_cvt_pk_f16_f32 v101, v98, v99
  v_and_or_b32 v100, v100, -2, s88
  buffer_store_dwordx2 v[100:101], v7, s[8:11], s81 offen
  s_mov_b64 exec, -1
  s_cmp_eq_u32 s52, 63
  s_cbranch_scc1 last_45
  s_sleep 4
  s_nop 7
  s_mov_b32 s54, 0
  buffer_load_dwordx2 v[248:249], v9, s[8:11], s81 offen sc1
  buffer_load_dwordx4 v[112:115], v8, s[8:11], s81 offen offset:0 sc1
  buffer_load_dwordx4 v[116:119], v8, s[8:11], s81 offen offset:1024 sc1
  s_sleep 2
  buffer_load_dwordx4 v[144:147], v10, s[8:11], s81 offen offset:0 sc1
  buffer_load_dwordx4 v[148:151], v10, s[8:11], s81 offen offset:1024 sc1
  buffer_load_dwordx4 v[152:155], v10, s[8:11], s81 offen offset:2048 sc1
  v_mov_b32 v188, 0
  v_mov_b32 v189, 0
  v_mov_b32 v190, 0
  v_mov_b32 v191, 0
  v_mov_b32 v192, 0
  v_mov_b32 v193, 0
  v_mov_b32 v194, 0
  v_mov_b32 v195, 0
  v_mov_b32 v196, 0
  v_mov_b32 v197, 0
  v_mov_b32 v198, 0
  v_mov_b32 v199, 0
  v_readfirstlane_b32 s21, v94
  s_add_u32 s22, s46, 3
  s_min_u32 s22, s22, 64
  s_sub_u32 s55, s21, s22
  s_sub_u32 s56, s21, s46
  s_cmp_lt_i32 s56, 0
  s_cbranch_scc1 kvw_59
kvok_60:
  s_waitcnt vmcnt(5)
  v_xor_b32 v96, s88, v248
  s_nop 0
  v_permlane16_swap_b32 v248, v249
  v_fma_mix_f32 v250, v248, 1.0, v249 op_sel:[0,0,0] op_sel_hi:[1,0,1]
  v_fma_mix_f32 v251, v248, 1.0, v249 op_sel:[1,0,1] op_sel_hi:[1,0,1]
  v_mov_b32 v248, v250
  v_mov_b32 v249, v251
  s_nop 0
  v_permlane32_swap_b32 v248, v250
  v_permlane32_swap_b32 v249, v251
  v_pk_add_f32 v[124:125], v[248:249], v[250:251]
  v_max_f32 v238, v124, v125
  s_waitcnt vmcnt(3)
  v_pk_add_f16 v100, v112, v116
  v_pk_add_f16 v102, v114, v118
  v_pk_add_f16 v101, v113, v117
  v_pk_add_f16 v103, v115, v119
  v_permlane32_swap_b32 v100, v102
  v_bitop3_b32 v97, v112, v114, s88 bitop3:0x7e
  v_permlane32_swap_b32 v101, v103
  v_bitop3_b32 v98, v116, v118, s88 bitop3:0x7e
  v_fma_mix_f32 v120, v100, 1.0, v102 op_sel:[0,0,0] op_sel_hi:[1,0,1]
  v_or3_b32 v27, v96, v97, v98
  v_fma_mix_f32 v121, v100, 1.0, v102 op_sel:[1,0,1] op_sel_hi:[1,0,1]
  v_and_b32 v27, 1, v27
  v_fma_mix_f32 v122, v101, 1.0, v103 op_sel:[0,0,0] op_sel_hi:[1,0,1]
  v_cmp_ne_u32 vcc, 0, v27
  v_fma_mix_f32 v123, v101, 1.0, v103 op_sel:[1,0,1] op_sel_hi:[1,0,1]
  v_max3_f32 v236, v120, v121, v238
  s_cbranch_vccnz psr_56
psj_57:
  v_max3_f32 v236, v236, v122, v123
  s_nop 1
  v_max_f32_dpp v236, v236, v236 row_ror:8 row_mask:0xf bank_mask:0xf
  v_mov_b32 v237, v236
  s_waitcnt vmcnt(0)
  v_max3_u32 v27, v144, v146, v148
  v_permlane32_swap_b32 v236, v237
  v_max_f32 v236, v236, v237
  v_mov_b32 v237, v236
  v_max3_u32 v27, v27, v150, v152
  v_max_u32 v27, v27, v154
  v_permlane16_swap_b32 v236, v237
  v_cmp_eq_u32 vcc, -1, v27
  v_max_f32 v236, v236, v237
  v_mul_f32 v236, s86, v236
  s_cbranch_vccnz pv_55
pvj_58:
  v_smfmac_f32_16x16x64_bf16 v[188:191], v[144:147], a[180:187], v44
  v_fma_f32 v120, v120, s86, -v236
  v_smfmac_f32_16x16x64_bf16 v[188:191], v[148:151], a[188:195], v44
  v_fma_f32 v121, v121, s86, -v236
  v_smfmac_f32_16x16x64_bf16 v[188:191], v[152:155], a[196:203], v44
  buffer_load_dwordx4 v[160:163], v17, s[28:31], s64 offen offset:0 sc1
  v_fma_f32 v122, v122, s86, -v236
  v_smfmac_f32_16x16x64_bf16 v[192:195], v[144:147], a[204:211], v44
  v_fma_f32 v123, v123, s86, -v236
  v_smfmac_f32_16x16x64_bf16 v[192:195], v[148:151], a[212:219], v44
  buffer_load_dwordx4 v[164:167], v16, s[28:31], s64 offen offset:1024 sc1
  v_fma_f32 v124, v124, s86, -v236
  v_smfmac_f32_16x16x64_bf16 v[192:195], v[152:155], a[220:227], v44
  v_fma_f32 v125, v125, s86, -v236
  v_smfmac_f32_16x16x64_bf16 v[196:199], v[144:147], a[228:235], v44
  buffer_load_dwordx4 v[48:51], v26, s[28:31], s64 offen offset:2048 sc1
  v_exp_f32 v120, v120
  v_smfmac_f32_16x16x64_bf16 v[196:199], v[148:151], a[236:243], v44
  v_exp_f32 v121, v121
  v_smfmac_f32_16x16x64_bf16 v[196:199], v[152:155], a[244:251], v44
  buffer_load_dwordx4 v[168:171], v18, s[16:19], s80 offen sc1
  v_exp_f32 v122, v122
  buffer_load_dwordx2 v[172:173], v20, s[16:19], s80 offen sc1
  v_exp_f32 v123, v123
  v_exp_f32 v124, v124
  s_cmp_lt_i32 s55, 0
  s_cbranch_scc1 fl_61
fl_62:
  v_exp_f32 v125, v125
  v_cvt_pk_bf16_f32 v220, v120, v121
  v_cvt_pk_bf16_f32 v221, v122, v123
  v_cvt_pk_bf16_f32 v224, v124, v125
  v_mov_b32_dpp v222, v220 row_ror:8 row_mask:0xf bank_mask:0xf
  v_mov_b32_dpp v223, v221 row_ror:8 row_mask:0xf bank_mask:0xf
  v_mov_b32_dpp v225, v224 row_ror:8 row_mask:0xf bank_mask:0xf
  v_cvt_pk_bf16_f32 v228, v188, v189
  v_mfma_f32_16x16x32_bf16 v[200:203], v[176:179], v[220:223], 0
  v_cvt_pk_bf16_f32 v229, v190, v191
  v_cvt_pk_bf16_f32 v230, v192, v193
  v_mfma_f32_16x16x32_bf16 v[204:207], v[180:183], v[220:223], 0
  v_cvt_pk_bf16_f32 v231, v194, v195
  v_cvt_pk_bf16_f32 v232, v196, v197
  v_mfma_f32_16x16x32_bf16 v[208:211], v[184:187], v[220:223], 0
  v_cvt_pk_bf16_f32 v233, v198, v199
  v_add_f32 v126, v120, v121
  v_mfma_f32_16x16x32_bf16 v[200:203], v[228:231], v[224:227], v[200:203]
  v_add_f32 v127, v122, v123
  v_add_f32 v128, v124, v125
  v_mfma_f32_16x16x32_bf16 v[204:207], v[230:233], v[224:227], v[204:207]
  v_add_f32 v236, v126, v127
  v_fmac_f32 v236, v128, v89
  v_mfma_f32_16x16x32_bf16 v[208:211], v[232:235], v[224:227], v[208:211]
  s_nop 0
  v_add_f32_dpp v236, v236, v236 row_ror:8 row_mask:0xf bank_mask:0xf
  v_mov_b32 v237, v236
  ds_write_b128 v11, v[200:203] offset:0
  s_nop 0
  v_permlane32_swap_b32 v236, v237
  v_add_f32 v236, v236, v237
  v_mov_b32 v237, v236
  ds_write_b128 v11, v[204:207] offset:1024
  s_nop 0
  v_permlane16_swap_b32 v236, v237
  v_add_f32 v236, v236, v237
  v_rcp_f32 v236, v236
  ds_write_b128 v11, v[208:211] offset:2048
  s_mov_b64 exec, 0xff
  ds_write_b32 v242, v236
  s_mov_b64 exec, -1
  s_waitcnt lgkmcnt(0)
  s_barrier
  ds_read_b128 v[104:107], v243
  ds_read_b64 v[96:97], v12 offset:0
  ds_read_b64 v[98:99], v12 offset:3072
  ds_read_b64 v[100:101], v12 offset:6144
  ds_read_b64 v[102:103], v12 offset:9216
  s_waitcnt lgkmcnt(2)
  v_pk_mul_f32 v[96:97], v[96:97], v[104:105] op_sel_hi:[1,0]
  v_pk_fma_f32 v[96:97], v[98:99], v[104:105], v[96:97] op_sel:[0,1,0] op_sel_hi:[1,1,1]
  s_waitcnt lgkmcnt(0)
  v_pk_fma_f32 v[96:97], v[100:101], v[106:107], v[96:97] op_sel_hi:[1,0,1]
  v_pk_fma_f32 v[96:97], v[102:103], v[106:107], v[96:97] op_sel:[0,1,0] op_sel_hi:[1,1,1]
  v_cvt_pk_f16_f32 v100, v96, v97
  v_perm_b32 v100, s91, v100, v14
  buffer_atomic_pk_add_f16 v100, v13, s[4:7], s3 offen
  v_mov_b32 v200, v196
  v_mov_b32 v201, v197
  v_mov_b32 v202, v198
  v_mov_b32 v203, v199
  v_permlane32_swap_b32 v188, v192
  v_permlane32_swap_b32 v189, v193
  v_permlane32_swap_b32 v190, v194
  v_permlane32_swap_b32 v191, v195
  v_permlane32_swap_b32 v196, v200
  v_permlane32_swap_b32 v197, v201
  v_permlane32_swap_b32 v198, v202
  v_permlane32_swap_b32 v199, v203
  v_pk_add_f32 v[188:189], v[188:189], v[192:193]
  v_pk_add_f32 v[190:191], v[190:191], v[194:195]
  v_pk_add_f32 v[196:197], v[196:197], v[200:201]
  v_pk_add_f32 v[198:199], v[198:199], v[202:203]
  v_cvt_pk_bf16_f32 v252, v188, v189
  v_cvt_pk_bf16_f32 v254, v196, v197
  v_cvt_pk_bf16_f32 v253, v190, v191
  v_cvt_pk_bf16_f32 v255, v198, v199
  s_nop 0
  v_permlane16_swap_b32 v252, v254
  v_permlane16_swap_b32 v253, v255
  v_min_u32 v252, -2, v252
  s_mov_b64 exec, s[76:77]
  buffer_store_dwordx4 v[252:255], v15, s[24:27], s57 offen sc1
  s_mov_b64 exec, -1
  s_add_u32 s64, s64, 1310720
  s_add_u32 s52, s52, 1
  s_and_b32 s21, s52, 3
  s_mul_i32 s81, s21, 540672
  s_lshl_b32 s84, s21, 15
  s_branch step_44
fl_48:
  buffer_load_dword v94, v95, s[12:15], s79 offen sc1
  s_branch fl_49
A1_16:
  v_smfmac_f32_16x16x32_f16 v[52:55], v[40:41], a[16:19], v44
  v_smfmac_f32_16x16x32_f16 v[64:67], v[40:41], a[76:79], v44
  v_smfmac_f32_16x16x32_f16 v[56:59], v[40:41], a[36:39], v44
  v_smfmac_f32_16x16x32_f16 v[68:71], v[40:41], a[96:99], v44
  s_branch A2_53
pm_54:
  buffer_load_dwordx4 v[40:43], v4, s[4:7], s84 offen offset:2048 sc1
  buffer_load_dwordx4 v[32:35], v4, s[4:7], s84 offen offset:0 sc1
  buffer_load_dwordx4 v[36:39], v4, s[4:7], s84 offen offset:1024 sc1
  s_nop 7
  v_mov_b32 v52, 0
  v_mov_b32 v53, 0
  v_mov_b32 v54, 0
  v_mov_b32 v55, 0
  v_mov_b32 v64, 0
  v_mov_b32 v65, 0
  v_mov_b32 v66, 0
  v_mov_b32 v67, 0
  v_mov_b32 v56, 0
  v_mov_b32 v57, 0
  v_mov_b32 v58, 0
  v_mov_b32 v59, 0
  v_mov_b32 v68, 0
  v_mov_b32 v69, 0
  v_mov_b32 v70, 0
  v_mov_b32 v71, 0
  s_waitcnt vmcnt(0)
  v_bitop3_b32 v27, v35, v39, v43 bitop3:0x80
  v_perm_b32 v35, v39, v35, s89
  v_cmp_gt_u32 vcc, 0x48000000, v27
  v_mov_b32 v39, v42
  s_cbranch_vccz A1_16
pm_46:
  s_cmp_gt_u32 s52, 3
  s_cbranch_scc1 op_63
  v_readfirstlane_b32 s21, v94
  s_cmp_ge_u32 s21, s46
  s_cbranch_scc1 op_63
  buffer_load_dword v94, v95, s[12:15], s79 offen sc1
  s_waitcnt vmcnt(0)
  v_readfirstlane_b32 s21, v94
  s_add_u32 s22, s46, 3
  s_min_u32 s22, s22, 64
  s_sub_u32 s55, s21, s22
  s_sub_u32 s56, s21, s46
  s_cmp_gt_u32 s21, s52
  s_cselect_b32 s21, s87, 0
  s_cmp_eq_u32 s21, 0
  s_cbranch_scc1 op_63
  s_mov_b32 s87, 0
  s_sub_u32 s21, s64, 1310720
  buffer_load_dwordx4 v[176:179], v16, s[28:31], s21 offen offset:0 sc1
  buffer_load_dwordx4 v[180:183], v16, s[28:31], s21 offen offset:1024 sc1
  buffer_load_dwordx4 v[184:187], v16, s[28:31], s21 offen offset:2048 sc1
op_63:
  buffer_load_dwordx4 v[40:43], v4, s[4:7], s84 offen offset:2048 sc1
  buffer_load_dwordx4 v[32:35], v4, s[4:7], s84 offen offset:0 sc1
  buffer_load_dwordx4 v[36:39], v4, s[4:7], s84 offen offset:1024 sc1
  s_add_u32 s54, s54, 1
  s_cmp_gt_u32 s54, 131072
  s_cbranch_scc1 end0
  s_waitcnt vmcnt(0)
  v_bitop3_b32 v27, v35, v39, v43 bitop3:0x80
  v_perm_b32 v35, v39, v35, s89
  v_cmp_gt_u32 vcc, 0x48000000, v27
  v_mov_b32 v39, v42
  s_cbranch_vccnz pm_46
  s_branch A1_16
pv_55:
  buffer_load_dwordx4 v[144:147], v10, s[8:11], s81 offen offset:0 sc1
  buffer_load_dwordx4 v[148:151], v10, s[8:11], s81 offen offset:1024 sc1
  buffer_load_dwordx4 v[152:155], v10, s[8:11], s81 offen offset:2048 sc1
  s_add_u32 s54, s54, 1
  s_cmp_gt_u32 s54, 131072
  s_cbranch_scc1 end0
  s_waitcnt vmcnt(0)
  v_max3_u32 v27, v144, v146, v148
  v_max3_u32 v27, v27, v150, v152
  v_max3_u32 v27, v27, v154, v154
  v_cmp_eq_u32 vcc, -1, v27
  s_nop 1
  s_cbranch_vccnz pv_55
  s_branch pvj_58
psr_56:
  buffer_load_dwordx2 v[248:249], v9, s[8:11], s81 offen sc1
  buffer_load_dwordx4 v[112:115], v8, s[8:11], s81 offen offset:0 sc1
  buffer_load_dwordx4 v[116:119], v8, s[8:11], s81 offen offset:1024 sc1
  s_add_u32 s54, s54, 1
  s_cmp_gt_u32 s54, 131072
  s_cbranch_scc1 end0
  s_waitcnt vmcnt(2)
  v_xor_b32 v96, s88, v248
  s_nop 0
  v_permlane16_swap_b32 v248, v249
  v_fma_mix_f32 v250, v248, 1.0, v249 op_sel:[0,0,0] op_sel_hi:[1,0,1]
  v_fma_mix_f32 v251, v248, 1.0, v249 op_sel:[1,0,1] op_sel_hi:[1,0,1]
  v_mov_b32 v248, v250
  v_mov_b32 v249, v251
  s_nop 0
  v_permlane32_swap_b32 v248, v250
  v_permlane32_swap_b32 v249, v251
  v_pk_add_f32 v[124:125], v[248:249], v[250:251]
  v_max_f32 v238, v124, v125
  s_waitcnt vmcnt(0)
  v_pk_add_f16 v100, v112, v116
  v_pk_add_f16 v102, v114, v118
  v_pk_add_f16 v101, v113, v117
  v_pk_add_f16 v103, v115, v119
  v_permlane32_swap_b32 v100, v102
  v_bitop3_b32 v97, v112, v114, s88 bitop3:0x7e
  v_permlane32_swap_b32 v101, v103
  v_bitop3_b32 v98, v116, v118, s88 bitop3:0x7e
  v_fma_mix_f32 v120, v100, 1.0, v102 op_sel:[0,0,0] op_sel_hi:[1,0,1]
  v_or3_b32 v27, v96, v97, v98
  v_fma_mix_f32 v121, v100, 1.0, v102 op_sel:[1,0,1] op_sel_hi:[1,0,1]
  v_and_b32 v27, 1, v27
  v_fma_mix_f32 v122, v101, 1.0, v103 op_sel:[0,0,0] op_sel_hi:[1,0,1]
  v_cmp_ne_u32 vcc, 0, v27
  v_fma_mix_f32 v123, v101, 1.0, v103 op_sel:[1,0,1] op_sel_hi:[1,0,1]
  v_max3_f32 v236, v120, v121, v238
  s_cbranch_vccnz psr_56
  s_branch psj_57
kvw_59:
  s_mov_b32 s22, s87
  s_cmp_eq_u32 s52, 0
  s_cselect_b32 s23, s87, s46
  s_cselect_b32 s55, 0, s55
  s_cselect_b32 s87, 1, 0
  s_cmp_eq_u32 s23, 0
  s_cbranch_scc1 kvok_60
  v_mov_b32 v236, 0
  s_mov_b32 s101, 0
wf_64:
  buffer_load_dword v237, v236, s[12:15], s79 offen sc1
  s_add_u32 s101, s101, 1
  s_cmp_gt_u32 s101, 131072
  s_cbranch_scc1 end0
  s_waitcnt vmcnt(0)
  v_readfirstlane_b32 s100, v237
  s_cmp_ge_u32 s100, s23
  s_cbranch_scc1 wf_65
  s_sleep 3
  s_branch wf_64
wf_65:
  s_cmp_eq_u32 s22, 0
  s_cbranch_scc1 kvok_60
  s_sub_u32 s21, s64, 1310720
  buffer_load_dwordx4 v[176:179], v16, s[28:31], s21 offen offset:0 sc1
  buffer_load_dwordx4 v[180:183], v16, s[28:31], s21 offen offset:1024 sc1
  buffer_load_dwordx4 v[184:187], v16, s[28:31], s21 offen offset:2048 sc1
  s_waitcnt vmcnt(0)
  s_branch kvok_60
fl_61:
  buffer_load_dword v94, v95, s[12:15], s79 offen sc1
  s_branch fl_62
last_45:
  v_mov_b32 v188, 0
  v_mov_b32 v189, 0
  v_mov_b32 v190, 0
  v_mov_b32 v191, 0
  v_mov_b32 v192, 0
  v_mov_b32 v193, 0
  v_mov_b32 v194, 0
  v_mov_b32 v195, 0
  v_mov_b32 v196, 0
  v_mov_b32 v197, 0
  v_mov_b32 v198, 0
  v_mov_b32 v199, 0
  s_sleep 4
  s_mov_b32 s54, 0
lv_66:
  buffer_load_dwordx4 v[144:147], v10, s[8:11], s81 offen offset:0 sc1
  buffer_load_dwordx4 v[148:151], v10, s[8:11], s81 offen offset:1024 sc1
  buffer_load_dwordx4 v[152:155], v10, s[8:11], s81 offen offset:2048 sc1
  s_add_u32 s54, s54, 1
  s_cmp_gt_u32 s54, 131072
  s_cbranch_scc1 end0
  s_waitcnt vmcnt(0)
  v_max3_u32 v27, v144, v146, v148
  v_max3_u32 v27, v27, v150, v152
  v_max3_u32 v27, v27, v154, v154
  v_cmp_eq_u32 vcc, -1, v27
  s_nop 1
  s_cbranch_vccnz lv_66
  v_smfmac_f32_16x16x64_bf16 v[188:191], v[144:147], a[180:187], v44
  v_smfmac_f32_16x16x64_bf16 v[192:195], v[144:147], a[204:211], v44
  v_smfmac_f32_16x16x64_bf16 v[196:199], v[144:147], a[228:235], v44
  v_smfmac_f32_16x16x64_bf16 v[188:191], v[148:151], a[188:195], v44
  v_smfmac_f32_16x16x64_bf16 v[192:195], v[148:151], a[212:219], v44
  v_smfmac_f32_16x16x64_bf16 v[196:199], v[148:151], a[236:243], v44
  v_smfmac_f32_16x16x64_bf16 v[188:191], v[152:155], a[196:203], v44
  v_smfmac_f32_16x16x64_bf16 v[192:195], v[152:155], a[220:227], v44
  v_smfmac_f32_16x16x64_bf16 v[196:199], v[152:155], a[244:251], v44
  s_nop 7
  v_mov_b32 v200, v196
  v_mov_b32 v201, v197
  v_mov_b32 v202, v198
  v_mov_b32 v203, v199
  v_permlane32_swap_b32 v188, v192
  v_permlane32_swap_b32 v189, v193
  v_permlane32_swap_b32 v190, v194
  v_permlane32_swap_b32 v191, v195
  v_permlane32_swap_b32 v196, v200
  v_permlane32_swap_b32 v197, v201
  v_permlane32_swap_b32 v198, v202
  v_permlane32_swap_b32 v199, v203
  v_pk_add_f32 v[188:189], v[188:189], v[192:193]
  v_pk_add_f32 v[190:191], v[190:191], v[194:195]
  v_pk_add_f32 v[196:197], v[196:197], v[200:201]
  v_pk_add_f32 v[198:199], v[198:199], v[202:203]
  v_cvt_pk_bf16_f32 v252, v188, v189
  v_cvt_pk_bf16_f32 v254, v196, v197
  v_cvt_pk_bf16_f32 v253, v190, v191
  v_cvt_pk_bf16_f32 v255, v198, v199
  s_nop 0
  v_permlane16_swap_b32 v252, v254
  v_permlane16_swap_b32 v253, v255
  v_min_u32 v252, -2, v252
  s_mov_b64 exec, s[76:77]
  buffer_store_dwordx4 v[252:255], v15, s[24:27], s57 offen sc1
  s_mov_b64 exec, -1
  s_branch chain_done
step_67:
  s_add_u32 s21, s52, 2
  s_and_b32 s21, s21, 3
  s_mul_i32 s82, s21, 540672
  s_add_u32 s21, s52, 3
  s_and_b32 s21, s21, 3
  s_lshl_b32 s83, s21, 15
  s_add_u32 s21, s52, 1
  s_and_b32 s22, s21, 3
  s_lshl_b32 s3, s22, 15
  s_mul_i32 s80, s21, 393216
  s_add_u32 s46, s21, 1
  s_min_u32 s46, s46, 64
  s_mul_i32 s85, s52, 98304
  s_mul_i32 s57, s52, 327680
  s_add_u32 s57, s57, 51380224

  s_bfe_u32 s88, s52, 0x10002
  s_add_u32 s78, s81, 278528
  s_max_u32 s21, s52, 1
  s_sub_u32 s21, s21, 1
  s_cmp_lt_u32 s52, 98
  s_cselect_b32 s66, s65, 0x80000000
  s_cselect_b32 s68, 15, 1
  s_cmp_ge_u32 s52, 99
  s_cselect_b32 s66, s90, s66
  s_cselect_b32 s67, s52, s21
  v_mov_b32 v52, 0
  v_mov_b32 v53, 0
  v_mov_b32 v54, 0
  v_mov_b32 v55, 0
  v_mov_b32 v56, 0
  v_mov_b32 v57, 0
  v_mov_b32 v58, 0
  v_mov_b32 v59, 0
  v_mov_b32 v60, 0
  v_mov_b32 v61, 0
  v_mov_b32 v62, 0
  v_mov_b32 v63, 0
  v_mov_b32 v64, 0
  v_mov_b32 v65, 0
  v_mov_b32 v66, 0
  v_mov_b32 v67, 0
  v_mov_b32 v68, 0
  v_mov_b32 v69, 0
  v_mov_b32 v70, 0
  v_mov_b32 v71, 0
  v_mov_b32 v72, 0
  v_mov_b32 v73, 0
  v_mov_b32 v74, 0
  v_mov_b32 v75, 0
  v_mov_b32 v76, 0
  v_mov_b32 v77, 0
  v_mov_b32 v78, 0
  v_mov_b32 v79, 0
  v_mov_b32 v80, 0
  v_mov_b32 v81, 0
  v_mov_b32 v82, 0
  v_mov_b32 v83, 0
  v_mov_b32 v84, 0
  v_mov_b32 v85, 0
  v_mov_b32 v86, 0
  v_mov_b32 v87, 0
  s_sleep 3
  s_nop 3
  v_readfirstlane_b32 s21, v94
  s_cmp_lt_u32 s21, s46
  s_cselect_b32 s55, s55, 0
  s_cmp_lt_i32 s55, 0
  s_cbranch_scc1 fl_71
fl_72:
  s_mov_b32 s54, 0
  buffer_load_dwordx4 v[40:43], v4, s[4:7], s84 offen offset:2048 sc1
  buffer_load_dwordx4 v[32:35], v4, s[4:7], s84 offen offset:0 sc1
  buffer_load_dwordx4 v[36:39], v4, s[4:7], s84 offen offset:1024 sc1
  s_waitcnt vmcnt(3)
  v_mov_b32 v176, v160
  v_mov_b32 v177, v161
  v_mov_b32 v178, v162
  v_mov_b32 v179, v163
  v_mov_b32 v180, v164
  v_mov_b32 v181, v165
  v_mov_b32 v182, v166
  v_mov_b32 v183, v167
  v_mov_b32 v184, v48
  v_mov_b32 v185, v49
  v_mov_b32 v186, v50
  v_mov_b32 v187, v51
lm_74:
  s_waitcnt vmcnt(2)
  v_smfmac_f32_16x16x32_f16 v[52:55], v[40:41], a[16:19], v44
  v_smfmac_f32_16x16x32_f16 v[64:67], v[40:41], a[76:79], v44
  v_smfmac_f32_16x16x32_f16 v[56:59], v[40:41], a[36:39], v44
  s_waitcnt vmcnt(0)
  v_bitop3_b32 v27, v35, v39, v43 bitop3:0x80
  v_perm_b32 v35, v39, v35, s89
  v_cmp_gt_u32 vcc, 0x48000000, v27
  v_mov_b32 v39, v42
  v_smfmac_f32_16x16x32_f16 v[68:71], v[40:41], a[96:99], v44
  s_cbranch_vccnz pm_77
A2_76:
  v_smfmac_f32_16x16x64_f16 v[52:55], v[32:35], a[0:7], v44
  v_smfmac_f32_16x16x64_f16 v[52:55], v[36:39], a[8:15], v44
  v_smfmac_f32_16x16x64_f16 v[64:67], v[32:35], a[60:67], v44
  v_smfmac_f32_16x16x64_f16 v[64:67], v[36:39], a[68:75], v44
  v_smfmac_f32_16x16x32_f16 v[60:63], v[40:41], a[56:59], v44
  v_cvt_pk_f16_f32 v52, v52, v53
  v_cvt_pk_f16_f32 v53, v54, v55
  v_smfmac_f32_16x16x32_f16 v[72:75], v[40:41], a[116:119], v44
  v_smfmac_f32_16x16x32_f16 v[76:79], v[40:41], a[136:139], v44
  v_cvt_pk_f16_f32 v64, v64, v65
  v_cvt_pk_f16_f32 v65, v66, v67
  s_nop 0
  v_smfmac_f32_16x16x64_f16 v[56:59], v[32:35], a[20:27], v44
  v_permlane32_swap_b32 v52, v64
  v_smfmac_f32_16x16x64_f16 v[56:59], v[36:39], a[28:35], v44
  v_permlane32_swap_b32 v53, v65
  v_pk_add_f16 v52, v52, v64
  v_smfmac_f32_16x16x64_f16 v[68:71], v[32:35], a[80:87], v44
  v_pk_add_f16 v53, v53, v65
  v_smfmac_f32_16x16x64_f16 v[68:71], v[36:39], a[88:95], v44
  ds_write_b64 v5, v[52:53] offset:0
  v_smfmac_f32_16x16x32_f16 v[80:83], v[40:41], a[156:159], v44
  v_cvt_pk_f16_f32 v56, v56, v57
  v_cvt_pk_f16_f32 v57, v58, v59
  v_smfmac_f32_16x16x32_f16 v[84:87], v[40:41], a[176:179], v44
  v_cvt_pk_f16_f32 v68, v68, v69
  v_cvt_pk_f16_f32 v69, v70, v71
  s_nop 0
  v_smfmac_f32_16x16x64_f16 v[60:63], v[32:35], a[40:47], v44
  v_permlane32_swap_b32 v56, v68
  v_smfmac_f32_16x16x64_f16 v[60:63], v[36:39], a[48:55], v44
  v_permlane32_swap_b32 v57, v69
  v_pk_add_f16 v56, v56, v68
  v_smfmac_f32_16x16x64_f16 v[72:75], v[32:35], a[100:107], v44
  v_pk_add_f16 v57, v57, v69
  v_smfmac_f32_16x16x64_f16 v[72:75], v[36:39], a[108:115], v44
  ds_write_b64 v5, v[56:57] offset:640
  v_smfmac_f32_16x16x64_f16 v[76:79], v[32:35], a[120:127], v44
  v_cvt_pk_f16_f32 v60, v60, v61
  v_cvt_pk_f16_f32 v61, v62, v63
  v_smfmac_f32_16x16x64_f16 v[76:79], v[36:39], a[128:135], v44
  v_cvt_pk_f16_f32 v72, v72, v73
  v_cvt_pk_f16_f32 v73, v74, v75
  s_nop 0
  v_smfmac_f32_16x16x64_f16 v[80:83], v[32:35], a[140:147], v44
  v_permlane32_swap_b32 v60, v72
  v_smfmac_f32_16x16x64_f16 v[80:83], v[36:39], a[148:155], v44
  v_permlane32_swap_b32 v61, v73
  v_pk_add_f16 v60, v60, v72
  v_smfmac_f32_16x16x64_f16 v[84:87], v[32:35], a[160:167], v44
  v_pk_add_f16 v61, v61, v73
  v_smfmac_f32_16x16x64_f16 v[84:87], v[36:39], a[168:175], v44
  ds_write_b64 v5, v[60:61] offset:1280
  v_cvt_pk_f16_f32 v76, v76, v77
  v_cvt_pk_f16_f32 v77, v78, v79
  v_cvt_pk_f16_f32 v80, v80, v81
  v_cvt_pk_f16_f32 v81, v82, v83
  s_nop 0
  v_permlane32_swap_b32 v76, v80
  v_permlane32_swap_b32 v77, v81
  v_pk_add_f16 v76, v76, v80
  v_pk_add_f16 v77, v77, v81
  ds_write_b64 v5, v[76:77] offset:1920
  v_cvt_pk_f16_f32 v84, v84, v85
  v_cvt_pk_f16_f32 v85, v86, v87
  ds_write_b64 v5, v[84:85] offset:2560
  s_waitcnt lgkmcnt(0) vmcnt(0)
  s_barrier
  ds_read_b64_tr_b16 v[104:105], v6 offset:0
  ds_read_b64_tr_b16 v[106:107], v6 offset:3200
  ds_read_b64_tr_b16 v[108:109], v6 offset:6400
  ds_read_b64_tr_b16 v[110:111], v6 offset:9600
  ds_read_b64_tr_b16 v[112:113], v6 offset:640
  ds_read_b64_tr_b16 v[114:115], v6 offset:3840
  ds_read_b64_tr_b16 v[116:117], v6 offset:7040
  ds_read_b64_tr_b16 v[118:119], v6 offset:10240
  ds_read_b64_tr_b16 v[120:121], v6 offset:1280
  ds_read_b64_tr_b16 v[122:123], v6 offset:4480
  ds_read_b64_tr_b16 v[124:125], v6 offset:7680
  ds_read_b64_tr_b16 v[126:127], v6 offset:10880
  s_waitcnt lgkmcnt(8)
  v_pk_add_f16 v104, v104, v106
  v_pk_add_f16 v108, v108, v110
  v_pk_add_f16 v105, v105, v107
  v_pk_add_f16 v109, v109, v111
  v_fma_mix_f32 v128, v104, 1.0, v108 op_sel:[0,0,0] op_sel_hi:[1,0,1]
  v_fma_mix_f32 v129, v104, 1.0, v108 op_sel:[1,0,1] op_sel_hi:[1,0,1]
  v_fma_mix_f32 v130, v105, 1.0, v109 op_sel:[0,0,0] op_sel_hi:[1,0,1]
  v_fma_mix_f32 v131, v105, 1.0, v109 op_sel:[1,0,1] op_sel_hi:[1,0,1]
  v_cvt_pk_bf16_f32 v212, v128, v129
  v_cvt_pk_bf16_f32 v213, v130, v131
  s_waitcnt lgkmcnt(4)
  v_pk_add_f16 v112, v112, v114
  v_pk_add_f16 v116, v116, v118
  v_pk_add_f16 v113, v113, v115
  v_pk_add_f16 v117, v117, v119
  v_fma_mix_f32 v128, v112, 1.0, v116 op_sel:[0,0,0] op_sel_hi:[1,0,1]
  v_fma_mix_f32 v129, v112, 1.0, v116 op_sel:[1,0,1] op_sel_hi:[1,0,1]
  v_fma_mix_f32 v130, v113, 1.0, v117 op_sel:[0,0,0] op_sel_hi:[1,0,1]
  v_fma_mix_f32 v131, v113, 1.0, v117 op_sel:[1,0,1] op_sel_hi:[1,0,1]
  v_cvt_pk_bf16_f32 v214, v128, v129
  v_cvt_pk_bf16_f32 v215, v130, v131
  s_waitcnt lgkmcnt(0)
  v_pk_add_f16 v120, v120, v122
  v_pk_add_f16 v124, v124, v126
  v_pk_add_f16 v121, v121, v123
  v_pk_add_f16 v125, v125, v127
  v_fma_mix_f32 v128, v120, 1.0, v124 op_sel:[0,0,0] op_sel_hi:[1,0,1]
  v_fma_mix_f32 v129, v120, 1.0, v124 op_sel:[1,0,1] op_sel_hi:[1,0,1]
  v_mfma_f32_16x16x32_bf16 v[96:99], v[212:215], v[212:215], 0
  v_fma_mix_f32 v130, v121, 1.0, v125 op_sel:[0,0,0] op_sel_hi:[1,0,1]
  v_fma_mix_f32 v131, v121, 1.0, v125 op_sel:[1,0,1] op_sel_hi:[1,0,1]
  v_cvt_pk_bf16_f32 v216, v128, v129
  v_cvt_pk_bf16_f32 v217, v130, v131
  s_nop 1
  v_mfma_f32_16x16x32_bf16 v[96:99], v[216:219], v[216:219], v[96:99]
  s_mov_b64 exec, s[74:75]
  s_nop 6
  v_cvt_pk_f16_f32 v100, v96, v97
  v_cvt_pk_f16_f32 v101, v98, v99
  v_and_or_b32 v100, v100, -2, s88
  buffer_store_dwordx2 v[100:101], v7, s[8:11], s81 offen
  s_mov_b64 exec, -1
  s_cmp_eq_u32 s52, 63
  s_cbranch_scc1 last_68
  s_sleep 4
  s_nop 7
  s_mov_b32 s54, 0
  buffer_load_dwordx2 v[248:249], v9, s[8:11], s81 offen sc1
  buffer_load_dwordx4 v[112:115], v8, s[8:11], s81 offen offset:0 sc1
  buffer_load_dwordx4 v[116:119], v8, s[8:11], s81 offen offset:1024 sc1
  s_sleep 2
  buffer_load_dwordx4 v[144:147], v10, s[8:11], s81 offen offset:0 sc1
  buffer_load_dwordx4 v[148:151], v10, s[8:11], s81 offen offset:1024 sc1
  buffer_load_dwordx4 v[152:155], v10, s[8:11], s81 offen offset:2048 sc1
  v_mov_b32 v188, 0
  v_mov_b32 v189, 0
  v_mov_b32 v190, 0
  v_mov_b32 v191, 0
  v_mov_b32 v192, 0
  v_mov_b32 v193, 0
  v_mov_b32 v194, 0
  v_mov_b32 v195, 0
  v_mov_b32 v196, 0
  v_mov_b32 v197, 0
  v_mov_b32 v198, 0
  v_mov_b32 v199, 0
  v_readfirstlane_b32 s21, v94
  s_add_u32 s22, s46, 3
  s_min_u32 s22, s22, 64
  s_sub_u32 s55, s21, s22
  s_sub_u32 s56, s21, s46
  s_cmp_lt_i32 s56, 0
  s_cbranch_scc1 kvw_82
kvok_83:
  s_waitcnt vmcnt(5)
  v_xor_b32 v96, s88, v248
  s_nop 0
  v_permlane16_swap_b32 v248, v249
  v_fma_mix_f32 v250, v248, 1.0, v249 op_sel:[0,0,0] op_sel_hi:[1,0,1]
  v_fma_mix_f32 v251, v248, 1.0, v249 op_sel:[1,0,1] op_sel_hi:[1,0,1]
  v_mov_b32 v248, v250
  v_mov_b32 v249, v251
  s_nop 0
  v_permlane32_swap_b32 v248, v250
  v_permlane32_swap_b32 v249, v251
  v_pk_add_f32 v[124:125], v[248:249], v[250:251]
  v_max_f32 v238, v124, v125
  s_waitcnt vmcnt(3)
  v_pk_add_f16 v100, v112, v116
  v_pk_add_f16 v102, v114, v118
  v_pk_add_f16 v101, v113, v117
  v_pk_add_f16 v103, v115, v119
  v_permlane32_swap_b32 v100, v102
  v_bitop3_b32 v97, v112, v114, s88 bitop3:0x7e
  v_permlane32_swap_b32 v101, v103
  v_bitop3_b32 v98, v116, v118, s88 bitop3:0x7e
  v_fma_mix_f32 v120, v100, 1.0, v102 op_sel:[0,0,0] op_sel_hi:[1,0,1]
  v_or3_b32 v27, v96, v97, v98
  v_fma_mix_f32 v121, v100, 1.0, v102 op_sel:[1,0,1] op_sel_hi:[1,0,1]
  v_and_b32 v27, 1, v27
  v_fma_mix_f32 v122, v101, 1.0, v103 op_sel:[0,0,0] op_sel_hi:[1,0,1]
  v_cmp_ne_u32 vcc, 0, v27
  v_fma_mix_f32 v123, v101, 1.0, v103 op_sel:[1,0,1] op_sel_hi:[1,0,1]
  v_max3_f32 v236, v120, v121, v238
  s_cbranch_vccnz psr_79
psj_80:
  v_max3_f32 v236, v236, v122, v123
  s_nop 1
  v_max_f32_dpp v236, v236, v236 row_ror:8 row_mask:0xf bank_mask:0xf
  v_mov_b32 v237, v236
  s_waitcnt vmcnt(0)
  v_max3_u32 v27, v144, v146, v148
  v_permlane32_swap_b32 v236, v237
  v_max_f32 v236, v236, v237
  v_mov_b32 v237, v236
  v_max3_u32 v27, v27, v150, v152
  v_max_u32 v27, v27, v154
  v_permlane16_swap_b32 v236, v237
  v_cmp_eq_u32 vcc, -1, v27
  v_max_f32 v236, v236, v237
  v_mul_f32 v236, s86, v236
  s_cbranch_vccnz pv_78
pvj_81:
  v_smfmac_f32_16x16x64_bf16 v[188:191], v[144:147], a[180:187], v44
  v_fma_f32 v120, v120, s86, -v236
  v_smfmac_f32_16x16x64_bf16 v[188:191], v[148:151], a[188:195], v44
  v_fma_f32 v121, v121, s86, -v236
  v_smfmac_f32_16x16x64_bf16 v[188:191], v[152:155], a[196:203], v44
  buffer_load_dwordx4 v[160:163], v17, s[28:31], s64 offen offset:0 sc1
  v_fma_f32 v122, v122, s86, -v236
  v_smfmac_f32_16x16x64_bf16 v[192:195], v[144:147], a[204:211], v44
  v_fma_f32 v123, v123, s86, -v236
  v_smfmac_f32_16x16x64_bf16 v[192:195], v[148:151], a[212:219], v44
  buffer_load_dwordx4 v[164:167], v16, s[28:31], s64 offen offset:1024 sc1
  v_fma_f32 v124, v124, s86, -v236
  v_smfmac_f32_16x16x64_bf16 v[192:195], v[152:155], a[220:227], v44
  v_fma_f32 v125, v125, s86, -v236
  v_smfmac_f32_16x16x64_bf16 v[196:199], v[144:147], a[228:235], v44
  buffer_load_dwordx4 v[48:51], v26, s[28:31], s64 offen offset:2048 sc1
  v_exp_f32 v120, v120
  v_smfmac_f32_16x16x64_bf16 v[196:199], v[148:151], a[236:243], v44
  v_exp_f32 v121, v121
  v_smfmac_f32_16x16x64_bf16 v[196:199], v[152:155], a[244:251], v44
  v_exp_f32 v122, v122
  v_exp_f32 v123, v123
  v_exp_f32 v124, v124
  s_cmp_lt_i32 s55, 0
  s_cbranch_scc1 fl_84
fl_85:
  v_exp_f32 v125, v125
  v_cvt_pk_bf16_f32 v220, v120, v121
  v_cvt_pk_bf16_f32 v221, v122, v123
  v_cvt_pk_bf16_f32 v224, v124, v125
  v_mov_b32_dpp v222, v220 row_ror:8 row_mask:0xf bank_mask:0xf
  v_mov_b32_dpp v223, v221 row_ror:8 row_mask:0xf bank_mask:0xf
  v_mov_b32_dpp v225, v224 row_ror:8 row_mask:0xf bank_mask:0xf
  v_cvt_pk_bf16_f32 v228, v188, v189
  v_mfma_f32_16x16x32_bf16 v[200:203], v[176:179], v[220:223], 0
  v_cvt_pk_bf16_f32 v229, v190, v191
  v_cvt_pk_bf16_f32 v230, v192, v193
  v_mfma_f32_16x16x32_bf16 v[204:207], v[180:183], v[220:223], 0
  v_cvt_pk_bf16_f32 v231, v194, v195
  v_cvt_pk_bf16_f32 v232, v196, v197
  v_mfma_f32_16x16x32_bf16 v[208:211], v[184:187], v[220:223], 0
  v_cvt_pk_bf16_f32 v233, v198, v199
  v_add_f32 v126, v120, v121
  v_mfma_f32_16x16x32_bf16 v[200:203], v[228:231], v[224:227], v[200:203]
  v_add_f32 v127, v122, v123
  v_add_f32 v128, v124, v125
  v_mfma_f32_16x16x32_bf16 v[204:207], v[230:233], v[224:227], v[204:207]
  v_add_f32 v236, v126, v127
  v_fmac_f32 v236, v128, v89
  v_mfma_f32_16x16x32_bf16 v[208:211], v[232:235], v[224:227], v[208:211]
  s_nop 0
  v_add_f32_dpp v236, v236, v236 row_ror:8 row_mask:0xf bank_mask:0xf
  v_mov_b32 v237, v236
  ds_write_b128 v11, v[200:203] offset:0
  s_nop 0
  v_permlane32_swap_b32 v236, v237
  v_add_f32 v236, v236, v237
  v_mov_b32 v237, v236
  ds_write_b128 v11, v[204:207] offset:1024
  s_nop 0
  v_permlane16_swap_b32 v236, v237
  v_add_f32 v236, v236, v237
  v_rcp_f32 v236, v236
  ds_write_b128 v11, v[208:211] offset:2048
  s_mov_b64 exec, 0xff
  ds_write_b32 v242, v236
  s_mov_b64 exec, -1
  s_waitcnt lgkmcnt(0)
  s_barrier
  ds_read_b128 v[104:107], v243
  ds_read_b64 v[96:97], v12 offset:0
  ds_read_b64 v[98:99], v12 offset:3072
  ds_read_b64 v[100:101], v12 offset:6144
  ds_read_b64 v[102:103], v12 offset:9216
  s_waitcnt lgkmcnt(2)
  v_pk_mul_f32 v[96:97], v[96:97], v[104:105] op_sel_hi:[1,0]
  v_pk_fma_f32 v[96:97], v[98:99], v[104:105], v[96:97] op_sel:[0,1,0] op_sel_hi:[1,1,1]
  s_waitcnt lgkmcnt(0)
  v_pk_fma_f32 v[96:97], v[100:101], v[106:107], v[96:97] op_sel_hi:[1,0,1]
  v_pk_fma_f32 v[96:97], v[102:103], v[106:107], v[96:97] op_sel:[0,1,0] op_sel_hi:[1,1,1]
  v_cvt_pk_f16_f32 v100, v96, v97
  v_perm_b32 v100, s91, v100, v14
  buffer_atomic_pk_add_f16 v100, v13, s[4:7], s3 offen
  s_mov_b64 exec, s[62:63]
  buffer_store_dwordx4 v[212:215], v21, s[24:27], s85 offen sc1
  buffer_store_dwordx2 v[216:217], v23, s[24:27], s85 offen sc1
  s_mov_b64 exec, -1
  v_mov_b32 v200, v196
  v_mov_b32 v201, v197
  v_mov_b32 v202, v198
  v_mov_b32 v203, v199
  v_permlane32_swap_b32 v188, v192
  v_permlane32_swap_b32 v189, v193
  v_permlane32_swap_b32 v190, v194
  v_permlane32_swap_b32 v191, v195
  v_permlane32_swap_b32 v196, v200
  v_permlane32_swap_b32 v197, v201
  v_permlane32_swap_b32 v198, v202
  v_permlane32_swap_b32 v199, v203
  v_pk_add_f32 v[188:189], v[188:189], v[192:193]
  v_pk_add_f32 v[190:191], v[190:191], v[194:195]
  v_pk_add_f32 v[196:197], v[196:197], v[200:201]
  v_pk_add_f32 v[198:199], v[198:199], v[202:203]
  v_cvt_pk_bf16_f32 v252, v188, v189
  v_cvt_pk_bf16_f32 v254, v196, v197
  v_cvt_pk_bf16_f32 v253, v190, v191
  v_cvt_pk_bf16_f32 v255, v198, v199
  s_nop 0
  v_permlane16_swap_b32 v252, v254
  v_permlane16_swap_b32 v253, v255
  v_min_u32 v252, -2, v252
  s_mov_b64 exec, s[76:77]
  buffer_store_dwordx4 v[252:255], v15, s[24:27], s57 offen sc1
  s_mov_b64 exec, -1
  s_add_u32 s64, s64, 1310720
  s_add_u32 s52, s52, 1
  s_and_b32 s21, s52, 3
  s_mul_i32 s81, s21, 540672
  s_lshl_b32 s84, s21, 15
  s_branch step_67
fl_71:
  buffer_load_dword v94, v95, s[12:15], s79 offen sc1
  s_branch fl_72
A1_17:
  v_smfmac_f32_16x16x32_f16 v[52:55], v[40:41], a[16:19], v44
  v_smfmac_f32_16x16x32_f16 v[64:67], v[40:41], a[76:79], v44
  v_smfmac_f32_16x16x32_f16 v[56:59], v[40:41], a[36:39], v44
  v_smfmac_f32_16x16x32_f16 v[68:71], v[40:41], a[96:99], v44
  s_branch A2_76
pm_77:
  buffer_load_dwordx4 v[40:43], v4, s[4:7], s84 offen offset:2048 sc1
  buffer_load_dwordx4 v[32:35], v4, s[4:7], s84 offen offset:0 sc1
  buffer_load_dwordx4 v[36:39], v4, s[4:7], s84 offen offset:1024 sc1
  s_nop 7
  v_mov_b32 v52, 0
  v_mov_b32 v53, 0
  v_mov_b32 v54, 0
  v_mov_b32 v55, 0
  v_mov_b32 v64, 0
  v_mov_b32 v65, 0
  v_mov_b32 v66, 0
  v_mov_b32 v67, 0
  v_mov_b32 v56, 0
  v_mov_b32 v57, 0
  v_mov_b32 v58, 0
  v_mov_b32 v59, 0
  v_mov_b32 v68, 0
  v_mov_b32 v69, 0
  v_mov_b32 v70, 0
  v_mov_b32 v71, 0
  s_waitcnt vmcnt(0)
  v_bitop3_b32 v27, v35, v39, v43 bitop3:0x80
  v_perm_b32 v35, v39, v35, s89
  v_cmp_gt_u32 vcc, 0x48000000, v27
  v_mov_b32 v39, v42
  s_cbranch_vccz A1_17
pm_69:
  s_cmp_gt_u32 s52, 3
  s_cbranch_scc1 op_86
  v_readfirstlane_b32 s21, v94
  s_cmp_ge_u32 s21, s46
  s_cbranch_scc1 op_86
  buffer_load_dword v94, v95, s[12:15], s79 offen sc1
  s_waitcnt vmcnt(0)
  v_readfirstlane_b32 s21, v94
  s_add_u32 s22, s46, 3
  s_min_u32 s22, s22, 64
  s_sub_u32 s55, s21, s22
  s_sub_u32 s56, s21, s46
  s_cmp_gt_u32 s21, s52
  s_cselect_b32 s21, s87, 0
  s_cmp_eq_u32 s21, 0
  s_cbranch_scc1 op_86
  s_mov_b32 s87, 0
  s_sub_u32 s21, s64, 1310720
  buffer_load_dwordx4 v[176:179], v16, s[28:31], s21 offen offset:0 sc1
  buffer_load_dwordx4 v[180:183], v16, s[28:31], s21 offen offset:1024 sc1
  buffer_load_dwordx4 v[184:187], v16, s[28:31], s21 offen offset:2048 sc1
op_86:
  buffer_load_dwordx4 v[40:43], v4, s[4:7], s84 offen offset:2048 sc1
  buffer_load_dwordx4 v[32:35], v4, s[4:7], s84 offen offset:0 sc1
  buffer_load_dwordx4 v[36:39], v4, s[4:7], s84 offen offset:1024 sc1
  s_add_u32 s54, s54, 1
  s_cmp_gt_u32 s54, 131072
  s_cbranch_scc1 end0
  s_waitcnt vmcnt(0)
  v_bitop3_b32 v27, v35, v39, v43 bitop3:0x80
  v_perm_b32 v35, v39, v35, s89
  v_cmp_gt_u32 vcc, 0x48000000, v27
  v_mov_b32 v39, v42
  s_cbranch_vccnz pm_69
  s_branch A1_17
pv_78:
  buffer_load_dwordx4 v[144:147], v10, s[8:11], s81 offen offset:0 sc1
  buffer_load_dwordx4 v[148:151], v10, s[8:11], s81 offen offset:1024 sc1
  buffer_load_dwordx4 v[152:155], v10, s[8:11], s81 offen offset:2048 sc1
  s_add_u32 s54, s54, 1
  s_cmp_gt_u32 s54, 131072
  s_cbranch_scc1 end0
  s_waitcnt vmcnt(0)
  v_max3_u32 v27, v144, v146, v148
  v_max3_u32 v27, v27, v150, v152
  v_max3_u32 v27, v27, v154, v154
  v_cmp_eq_u32 vcc, -1, v27
  s_nop 1
  s_cbranch_vccnz pv_78
  s_branch pvj_81
psr_79:
  buffer_load_dwordx2 v[248:249], v9, s[8:11], s81 offen sc1
  buffer_load_dwordx4 v[112:115], v8, s[8:11], s81 offen offset:0 sc1
  buffer_load_dwordx4 v[116:119], v8, s[8:11], s81 offen offset:1024 sc1
  s_add_u32 s54, s54, 1
  s_cmp_gt_u32 s54, 131072
  s_cbranch_scc1 end0
  s_waitcnt vmcnt(2)
  v_xor_b32 v96, s88, v248
  s_nop 0
  v_permlane16_swap_b32 v248, v249
  v_fma_mix_f32 v250, v248, 1.0, v249 op_sel:[0,0,0] op_sel_hi:[1,0,1]
  v_fma_mix_f32 v251, v248, 1.0, v249 op_sel:[1,0,1] op_sel_hi:[1,0,1]
  v_mov_b32 v248, v250
  v_mov_b32 v249, v251
  s_nop 0
  v_permlane32_swap_b32 v248, v250
  v_permlane32_swap_b32 v249, v251
  v_pk_add_f32 v[124:125], v[248:249], v[250:251]
  v_max_f32 v238, v124, v125
  s_waitcnt vmcnt(0)
  v_pk_add_f16 v100, v112, v116
  v_pk_add_f16 v102, v114, v118
  v_pk_add_f16 v101, v113, v117
  v_pk_add_f16 v103, v115, v119
  v_permlane32_swap_b32 v100, v102
  v_bitop3_b32 v97, v112, v114, s88 bitop3:0x7e
  v_permlane32_swap_b32 v101, v103
  v_bitop3_b32 v98, v116, v118, s88 bitop3:0x7e
  v_fma_mix_f32 v120, v100, 1.0, v102 op_sel:[0,0,0] op_sel_hi:[1,0,1]
  v_or3_b32 v27, v96, v97, v98
  v_fma_mix_f32 v121, v100, 1.0, v102 op_sel:[1,0,1] op_sel_hi:[1,0,1]
  v_and_b32 v27, 1, v27
  v_fma_mix_f32 v122, v101, 1.0, v103 op_sel:[0,0,0] op_sel_hi:[1,0,1]
  v_cmp_ne_u32 vcc, 0, v27
  v_fma_mix_f32 v123, v101, 1.0, v103 op_sel:[1,0,1] op_sel_hi:[1,0,1]
  v_max3_f32 v236, v120, v121, v238
  s_cbranch_vccnz psr_79
  s_branch psj_80
kvw_82:
  s_mov_b32 s22, s87
  s_cmp_eq_u32 s52, 0
  s_cselect_b32 s23, s87, s46
  s_cselect_b32 s55, 0, s55
  s_cselect_b32 s87, 1, 0
  s_cmp_eq_u32 s23, 0
  s_cbranch_scc1 kvok_83
  v_mov_b32 v236, 0
  s_mov_b32 s101, 0
wf_87:
  buffer_load_dword v237, v236, s[12:15], s79 offen sc1
  s_add_u32 s101, s101, 1
  s_cmp_gt_u32 s101, 131072
  s_cbranch_scc1 end0
  s_waitcnt vmcnt(0)
  v_readfirstlane_b32 s100, v237
  s_cmp_ge_u32 s100, s23
  s_cbranch_scc1 wf_88
  s_sleep 3
  s_branch wf_87
wf_88:
  s_cmp_eq_u32 s22, 0
  s_cbranch_scc1 kvok_83
  s_sub_u32 s21, s64, 1310720
  buffer_load_dwordx4 v[176:179], v16, s[28:31], s21 offen offset:0 sc1
  buffer_load_dwordx4 v[180:183], v16, s[28:31], s21 offen offset:1024 sc1
  buffer_load_dwordx4 v[184:187], v16, s[28:31], s21 offen offset:2048 sc1
  s_waitcnt vmcnt(0)
  s_branch kvok_83
fl_84:
  buffer_load_dword v94, v95, s[12:15], s79 offen sc1
  s_branch fl_85
last_68:
  s_mov_b64 exec, s[62:63]
  buffer_store_dwordx4 v[212:215], v21, s[24:27], s85 offen sc1
  buffer_store_dwordx2 v[216:217], v23, s[24:27], s85 offen sc1
  s_mov_b64 exec, -1
  v_mov_b32 v188, 0
  v_mov_b32 v189, 0
  v_mov_b32 v190, 0
  v_mov_b32 v191, 0
  v_mov_b32 v192, 0
  v_mov_b32 v193, 0
  v_mov_b32 v194, 0
  v_mov_b32 v195, 0
  v_mov_b32 v196, 0
  v_mov_b32 v197, 0
  v_mov_b32 v198, 0
  v_mov_b32 v199, 0
  s_sleep 4
  s_mov_b32 s54, 0
lv_89:
  buffer_load_dwordx4 v[144:147], v10, s[8:11], s81 offen offset:0 sc1
  buffer_load_dwordx4 v[148:151], v10, s[8:11], s81 offen offset:1024 sc1
  buffer_load_dwordx4 v[152:155], v10, s[8:11], s81 offen offset:2048 sc1
  s_add_u32 s54, s54, 1
  s_cmp_gt_u32 s54, 131072
  s_cbranch_scc1 end0
  s_waitcnt vmcnt(0)
  v_max3_u32 v27, v144, v146, v148
  v_max3_u32 v27, v27, v150, v152
  v_max3_u32 v27, v27, v154, v154
  v_cmp_eq_u32 vcc, -1, v27
  s_nop 1
  s_cbranch_vccnz lv_89
  v_smfmac_f32_16x16x64_bf16 v[188:191], v[144:147], a[180:187], v44
  v_smfmac_f32_16x16x64_bf16 v[192:195], v[144:147], a[204:211], v44
  v_smfmac_f32_16x16x64_bf16 v[196:199], v[144:147], a[228:235], v44
  v_smfmac_f32_16x16x64_bf16 v[188:191], v[148:151], a[188:195], v44
  v_smfmac_f32_16x16x64_bf16 v[192:195], v[148:151], a[212:219], v44
  v_smfmac_f32_16x16x64_bf16 v[196:199], v[148:151], a[236:243], v44
  v_smfmac_f32_16x16x64_bf16 v[188:191], v[152:155], a[196:203], v44
  v_smfmac_f32_16x16x64_bf16 v[192:195], v[152:155], a[220:227], v44
  v_smfmac_f32_16x16x64_bf16 v[196:199], v[152:155], a[244:251], v44
  s_nop 7
  v_mov_b32 v200, v196
  v_mov_b32 v201, v197
  v_mov_b32 v202, v198
  v_mov_b32 v203, v199
  v_permlane32_swap_b32 v188, v192
  v_permlane32_swap_b32 v189, v193
  v_permlane32_swap_b32 v190, v194
  v_permlane32_swap_b32 v191, v195
  v_permlane32_swap_b32 v196, v200
  v_permlane32_swap_b32 v197, v201
  v_permlane32_swap_b32 v198, v202
  v_permlane32_swap_b32 v199, v203
  v_pk_add_f32 v[188:189], v[188:189], v[192:193]
  v_pk_add_f32 v[190:191], v[190:191], v[194:195]
  v_pk_add_f32 v[196:197], v[196:197], v[200:201]
  v_pk_add_f32 v[198:199], v[198:199], v[202:203]
  v_cvt_pk_bf16_f32 v252, v188, v189
  v_cvt_pk_bf16_f32 v254, v196, v197
  v_cvt_pk_bf16_f32 v253, v190, v191
  v_cvt_pk_bf16_f32 v255, v198, v199
  s_nop 0
  v_permlane16_swap_b32 v252, v254
  v_permlane16_swap_b32 v253, v255
  v_min_u32 v252, -2, v252
  s_mov_b64 exec, s[76:77]
  buffer_store_dwordx4 v[252:255], v15, s[24:27], s57 offen sc1
  s_mov_b64 exec, -1
  s_branch chain_done
step_90:
  s_add_u32 s21, s52, 2
  s_and_b32 s21, s21, 3
  s_mul_i32 s82, s21, 540672
  s_add_u32 s21, s52, 3
  s_and_b32 s21, s21, 3
  s_lshl_b32 s83, s21, 15
  s_add_u32 s21, s52, 1
  s_and_b32 s22, s21, 3
  s_lshl_b32 s3, s22, 15
  s_mul_i32 s80, s21, 393216
  s_add_u32 s46, s21, 1
  s_min_u32 s46, s46, 64
  s_mul_i32 s85, s52, 98304
  s_mul_i32 s57, s52, 327680
  s_add_u32 s57, s57, 51380224

  s_bfe_u32 s88, s52, 0x10002
  s_add_u32 s78, s81, 278528
  s_max_u32 s21, s52, 1
  s_sub_u32 s21, s21, 1
  s_cmp_lt_u32 s52, 98
  s_cselect_b32 s66, s65, 0x80000000
  s_cselect_b32 s68, 15, 1
  s_cmp_ge_u32 s52, 99
  s_cselect_b32 s66, s90, s66
  s_cselect_b32 s67, s52, s21
  v_mov_b32 v52, 0
  v_mov_b32 v53, 0
  v_mov_b32 v54, 0
  v_mov_b32 v55, 0
  v_mov_b32 v56, 0
  v_mov_b32 v57, 0
  v_mov_b32 v58, 0
  v_mov_b32 v59, 0
  v_mov_b32 v60, 0
  v_mov_b32 v61, 0
  v_mov_b32 v62, 0
  v_mov_b32 v63, 0
  v_mov_b32 v64, 0
  v_mov_b32 v65, 0
  v_mov_b32 v66, 0
  v_mov_b32 v67, 0
  v_mov_b32 v68, 0
  v_mov_b32 v69, 0
  v_mov_b32 v70, 0
  v_mov_b32 v71, 0
  v_mov_b32 v72, 0
  v_mov_b32 v73, 0
  v_mov_b32 v74, 0
  v_mov_b32 v75, 0
  v_mov_b32 v76, 0
  v_mov_b32 v77, 0
  v_mov_b32 v78, 0
  v_mov_b32 v79, 0
  v_mov_b32 v80, 0
  v_mov_b32 v81, 0
  v_mov_b32 v82, 0
  v_mov_b32 v83, 0
  v_mov_b32 v84, 0
  v_mov_b32 v85, 0
  v_mov_b32 v86, 0
  v_mov_b32 v87, 0
  s_sleep 4
  s_nop 3
  v_readfirstlane_b32 s21, v94
  s_cmp_lt_u32 s21, s46
  s_cselect_b32 s55, s55, 0
  s_cmp_lt_i32 s55, 0
  s_cbranch_scc1 fl_94
fl_95:
  s_mov_b32 s54, 0
  buffer_load_dwordx4 v[40:43], v4, s[4:7], s84 offen offset:2048 sc1
  buffer_load_dwordx4 v[32:35], v4, s[4:7], s84 offen offset:0 sc1
  buffer_load_dwordx4 v[36:39], v4, s[4:7], s84 offen offset:1024 sc1
  s_waitcnt vmcnt(3)
  v_mov_b32 v176, v160
  v_mov_b32 v177, v161
  v_mov_b32 v178, v162
  v_mov_b32 v179, v163
  v_mov_b32 v180, v164
  v_mov_b32 v181, v165
  v_mov_b32 v182, v166
  v_mov_b32 v183, v167
  v_mov_b32 v184, v48
  v_mov_b32 v185, v49
  v_mov_b32 v186, v50
  v_mov_b32 v187, v51
lm_97:
  s_waitcnt vmcnt(2)
  v_smfmac_f32_16x16x32_f16 v[52:55], v[40:41], a[16:19], v44
  v_smfmac_f32_16x16x32_f16 v[64:67], v[40:41], a[76:79], v44
  v_smfmac_f32_16x16x32_f16 v[56:59], v[40:41], a[36:39], v44
  s_waitcnt vmcnt(0)
  v_bitop3_b32 v27, v35, v39, v43 bitop3:0x80
  v_perm_b32 v35, v39, v35, s89
  v_cmp_gt_u32 vcc, 0x48000000, v27
  v_mov_b32 v39, v42
  v_smfmac_f32_16x16x32_f16 v[68:71], v[40:41], a[96:99], v44
  s_cbranch_vccnz pm_100
A2_99:
  v_smfmac_f32_16x16x64_f16 v[52:55], v[32:35], a[0:7], v44
  v_smfmac_f32_16x16x64_f16 v[52:55], v[36:39], a[8:15], v44
  v_smfmac_f32_16x16x64_f16 v[64:67], v[32:35], a[60:67], v44
  v_smfmac_f32_16x16x64_f16 v[64:67], v[36:39], a[68:75], v44
  v_smfmac_f32_16x16x32_f16 v[60:63], v[40:41], a[56:59], v44
  v_cvt_pk_f16_f32 v52, v52, v53
  v_cvt_pk_f16_f32 v53, v54, v55
  v_smfmac_f32_16x16x32_f16 v[72:75], v[40:41], a[116:119], v44
  v_smfmac_f32_16x16x32_f16 v[76:79], v[40:41], a[136:139], v44
  v_cvt_pk_f16_f32 v64, v64, v65
  v_cvt_pk_f16_f32 v65, v66, v67
  s_nop 0
  v_smfmac_f32_16x16x64_f16 v[56:59], v[32:35], a[20:27], v44
  v_permlane32_swap_b32 v52, v64
  v_smfmac_f32_16x16x64_f16 v[56:59], v[36:39], a[28:35], v44
  v_permlane32_swap_b32 v53, v65
  v_pk_add_f16 v52, v52, v64
  v_smfmac_f32_16x16x64_f16 v[68:71], v[32:35], a[80:87], v44
  v_pk_add_f16 v53, v53, v65
  v_smfmac_f32_16x16x64_f16 v[68:71], v[36:39], a[88:95], v44
  ds_write_b64 v5, v[52:53] offset:0
  v_smfmac_f32_16x16x32_f16 v[80:83], v[40:41], a[156:159], v44
  v_cvt_pk_f16_f32 v56, v56, v57
  v_cvt_pk_f16_f32 v57, v58, v59
  v_smfmac_f32_16x16x32_f16 v[84:87], v[40:41], a[176:179], v44
  v_cvt_pk_f16_f32 v68, v68, v69
  v_cvt_pk_f16_f32 v69, v70, v71
  s_nop 0
  v_smfmac_f32_16x16x64_f16 v[60:63], v[32:35], a[40:47], v44
  v_permlane32_swap_b32 v56, v68
  v_smfmac_f32_16x16x64_f16 v[60:63], v[36:39], a[48:55], v44
  v_permlane32_swap_b32 v57, v69
  v_pk_add_f16 v56, v56, v68
  v_smfmac_f32_16x16x64_f16 v[72:75], v[32:35], a[100:107], v44
  v_pk_add_f16 v57, v57, v69
  v_smfmac_f32_16x16x64_f16 v[72:75], v[36:39], a[108:115], v44
  ds_write_b64 v5, v[56:57] offset:640
  v_smfmac_f32_16x16x64_f16 v[76:79], v[32:35], a[120:127], v44
  v_cvt_pk_f16_f32 v60, v60, v61
  v_cvt_pk_f16_f32 v61, v62, v63
  v_smfmac_f32_16x16x64_f16 v[76:79], v[36:39], a[128:135], v44
  v_cvt_pk_f16_f32 v72, v72, v73
  v_cvt_pk_f16_f32 v73, v74, v75
  s_nop 0
  v_smfmac_f32_16x16x64_f16 v[80:83], v[32:35], a[140:147], v44
  v_permlane32_swap_b32 v60, v72
  v_smfmac_f32_16x16x64_f16 v[80:83], v[36:39], a[148:155], v44
  v_permlane32_swap_b32 v61, v73
  v_pk_add_f16 v60, v60, v72
  v_smfmac_f32_16x16x64_f16 v[84:87], v[32:35], a[160:167], v44
  v_pk_add_f16 v61, v61, v73
  v_smfmac_f32_16x16x64_f16 v[84:87], v[36:39], a[168:175], v44
  ds_write_b64 v5, v[60:61] offset:1280
  v_cvt_pk_f16_f32 v76, v76, v77
  v_cvt_pk_f16_f32 v77, v78, v79
  v_cvt_pk_f16_f32 v80, v80, v81
  v_cvt_pk_f16_f32 v81, v82, v83
  s_nop 0
  v_permlane32_swap_b32 v76, v80
  v_permlane32_swap_b32 v77, v81
  v_pk_add_f16 v76, v76, v80
  v_pk_add_f16 v77, v77, v81
  ds_write_b64 v5, v[76:77] offset:1920
  v_cvt_pk_f16_f32 v84, v84, v85
  v_cvt_pk_f16_f32 v85, v86, v87
  ds_write_b64 v5, v[84:85] offset:2560
  s_waitcnt lgkmcnt(0) vmcnt(0)
  s_barrier
  ds_read_b64_tr_b16 v[96:97], v6 offset:1920
  ds_read_b64_tr_b16 v[98:99], v6 offset:5120
  ds_read_b64_tr_b16 v[100:101], v6 offset:8320
  ds_read_b64_tr_b16 v[102:103], v6 offset:11520
  ds_read_b64_tr_b16 v[104:105], v6 offset:2560
  ds_read_b64_tr_b16 v[106:107], v6 offset:5760
  ds_read_b64_tr_b16 v[108:109], v6 offset:8960
  ds_read_b64_tr_b16 v[110:111], v6 offset:12160
  s_waitcnt lgkmcnt(4)
  v_pk_add_f16 v96, v96, v98
  v_pk_add_f16 v100, v100, v102
  v_pk_add_f16 v97, v97, v99
  v_pk_add_f16 v101, v101, v103
  v_fma_mix_f32 v112, v96, 1.0, v100 op_sel:[0,0,0] op_sel_hi:[1,0,1]
  v_fma_mix_f32 v113, v96, 1.0, v100 op_sel:[1,0,1] op_sel_hi:[1,0,1]
  v_fma_mix_f32 v114, v97, 1.0, v101 op_sel:[0,0,0] op_sel_hi:[1,0,1]
  v_fma_mix_f32 v115, v97, 1.0, v101 op_sel:[1,0,1] op_sel_hi:[1,0,1]
  v_cvt_pk_bf16_f32 v90, v112, v113
  v_cvt_pk_bf16_f32 v91, v114, v115
  v_min_u32 v90, -2, v90
  buffer_store_dwordx2 v[90:91], v24, s[8:11], s81 offen
  s_waitcnt lgkmcnt(0)
  v_pk_add_f16 v104, v104, v106
  v_pk_add_f16 v108, v108, v110
  v_pk_add_f16 v105, v105, v107
  v_pk_add_f16 v109, v109, v111
  v_fma_mix_f32 v112, v104, 1.0, v108 op_sel:[0,0,0] op_sel_hi:[1,0,1]
  v_fma_mix_f32 v113, v104, 1.0, v108 op_sel:[1,0,1] op_sel_hi:[1,0,1]
  v_fma_mix_f32 v114, v105, 1.0, v109 op_sel:[0,0,0] op_sel_hi:[1,0,1]
  v_fma_mix_f32 v115, v105, 1.0, v109 op_sel:[1,0,1] op_sel_hi:[1,0,1]
  v_add_f32_dpp v116, v112, v112 row_ror:8 row_mask:0xf bank_mask:0xf
  v_add_f32_dpp v117, v113, v113 row_ror:8 row_mask:0xf bank_mask:0xf
  v_add_f32_dpp v118, v114, v114 row_ror:8 row_mask:0xf bank_mask:0xf
  v_add_f32_dpp v119, v115, v115 row_ror:8 row_mask:0xf bank_mask:0xf
  v_cvt_pk_bf16_f32 v92, v116, v117
  v_cvt_pk_bf16_f32 v93, v118, v119
  v_min_u32 v92, -2, v92
  s_mov_b64 exec, s[60:61]
  buffer_store_dwordx2 v[92:93], v23, s[8:11], s78 offen
  s_mov_b64 exec, -1
  s_cmp_eq_u32 s52, 63
  s_cbranch_scc1 last_91
  s_sleep 5
  s_nop 3
  s_mov_b32 s54, 0
  buffer_load_dwordx2 v[248:249], v9, s[8:11], s81 offen sc1
  buffer_load_dwordx4 v[112:115], v8, s[8:11], s81 offen offset:0 sc1
  buffer_load_dwordx4 v[116:119], v8, s[8:11], s81 offen offset:1024 sc1
  s_sleep 2
  buffer_load_dwordx4 v[144:147], v10, s[8:11], s81 offen offset:0 sc1
  buffer_load_dwordx4 v[148:151], v10, s[8:11], s81 offen offset:1024 sc1
  buffer_load_dwordx4 v[152:155], v10, s[8:11], s81 offen offset:2048 sc1
  v_mov_b32 v188, 0
  v_mov_b32 v189, 0
  v_mov_b32 v190, 0
  v_mov_b32 v191, 0
  v_mov_b32 v192, 0
  v_mov_b32 v193, 0
  v_mov_b32 v194, 0
  v_mov_b32 v195, 0
  v_mov_b32 v196, 0
  v_mov_b32 v197, 0
  v_mov_b32 v198, 0
  v_mov_b32 v199, 0
  v_readfirstlane_b32 s21, v94
  s_add_u32 s22, s46, 3
  s_min_u32 s22, s22, 64
  s_sub_u32 s55, s21, s22
  s_sub_u32 s56, s21, s46
  s_cmp_lt_i32 s56, 0
  s_cbranch_scc1 kvw_105
kvok_106:
  s_waitcnt vmcnt(5)
  v_xor_b32 v96, s88, v248
  s_nop 0
  v_permlane16_swap_b32 v248, v249
  v_fma_mix_f32 v250, v248, 1.0, v249 op_sel:[0,0,0] op_sel_hi:[1,0,1]
  v_fma_mix_f32 v251, v248, 1.0, v249 op_sel:[1,0,1] op_sel_hi:[1,0,1]
  v_mov_b32 v248, v250
  v_mov_b32 v249, v251
  s_nop 0
  v_permlane32_swap_b32 v248, v250
  v_permlane32_swap_b32 v249, v251
  v_pk_add_f32 v[124:125], v[248:249], v[250:251]
  v_max_f32 v238, v124, v125
  s_waitcnt vmcnt(3)
  v_pk_add_f16 v100, v112, v116
  v_pk_add_f16 v102, v114, v118
  v_pk_add_f16 v101, v113, v117
  v_pk_add_f16 v103, v115, v119
  v_permlane32_swap_b32 v100, v102
  v_bitop3_b32 v97, v112, v114, s88 bitop3:0x7e
  v_permlane32_swap_b32 v101, v103
  v_bitop3_b32 v98, v116, v118, s88 bitop3:0x7e
  v_fma_mix_f32 v120, v100, 1.0, v102 op_sel:[0,0,0] op_sel_hi:[1,0,1]
  v_or3_b32 v27, v96, v97, v98
  v_fma_mix_f32 v121, v100, 1.0, v102 op_sel:[1,0,1] op_sel_hi:[1,0,1]
  v_and_b32 v27, 1, v27
  v_fma_mix_f32 v122, v101, 1.0, v103 op_sel:[0,0,0] op_sel_hi:[1,0,1]
  v_cmp_ne_u32 vcc, 0, v27
  v_fma_mix_f32 v123, v101, 1.0, v103 op_sel:[1,0,1] op_sel_hi:[1,0,1]
  v_max3_f32 v236, v120, v121, v238
  s_cbranch_vccnz psr_102
psj_103:
  v_max3_f32 v236, v236, v122, v123
  s_nop 1
  v_max_f32_dpp v236, v236, v236 row_ror:8 row_mask:0xf bank_mask:0xf
  v_mov_b32 v237, v236
  s_waitcnt vmcnt(0)
  v_max3_u32 v27, v144, v146, v148
  v_permlane32_swap_b32 v236, v237
  v_max_f32 v236, v236, v237
  v_mov_b32 v237, v236
  v_max3_u32 v27, v27, v150, v152
  v_max_u32 v27, v27, v154
  v_permlane16_swap_b32 v236, v237
  v_cmp_eq_u32 vcc, -1, v27
  v_max_f32 v236, v236, v237
  v_mul_f32 v236, s86, v236
  s_cbranch_vccnz pv_101
pvj_104:
  v_smfmac_f32_16x16x64_bf16 v[188:191], v[144:147], a[180:187], v44
  v_fma_f32 v120, v120, s86, -v236
  v_smfmac_f32_16x16x64_bf16 v[188:191], v[148:151], a[188:195], v44
  v_fma_f32 v121, v121, s86, -v236
  v_smfmac_f32_16x16x64_bf16 v[188:191], v[152:155], a[196:203], v44
  buffer_load_dwordx4 v[160:163], v17, s[28:31], s64 offen offset:0 sc1
  v_fma_f32 v122, v122, s86, -v236
  v_smfmac_f32_16x16x64_bf16 v[192:195], v[144:147], a[204:211], v44
  v_fma_f32 v123, v123, s86, -v236
  v_smfmac_f32_16x16x64_bf16 v[192:195], v[148:151], a[212:219], v44
  buffer_load_dwordx4 v[164:167], v16, s[28:31], s64 offen offset:1024 sc1
  v_fma_f32 v124, v124, s86, -v236
  v_smfmac_f32_16x16x64_bf16 v[192:195], v[152:155], a[220:227], v44
  v_fma_f32 v125, v125, s86, -v236
  v_smfmac_f32_16x16x64_bf16 v[196:199], v[144:147], a[228:235], v44
  buffer_load_dwordx4 v[48:51], v26, s[28:31], s64 offen offset:2048 sc1
  v_exp_f32 v120, v120
  v_smfmac_f32_16x16x64_bf16 v[196:199], v[148:151], a[236:243], v44
  v_exp_f32 v121, v121
  v_smfmac_f32_16x16x64_bf16 v[196:199], v[152:155], a[244:251], v44
  v_exp_f32 v122, v122
  v_exp_f32 v123, v123
  v_mov_b32 v240, s67
  v_mov_b32 v241, s67
  s_mov_b64 exec, s[68:69]
  buffer_store_dwordx2 v[240:241], v88, s[12:15], s66 offen sc1
  s_mov_b64 exec, -1
  v_exp_f32 v124, v124
  s_cmp_lt_i32 s55, 0
  s_cbranch_scc1 fl_107
fl_108:
  v_exp_f32 v125, v125
  v_cvt_pk_bf16_f32 v220, v120, v121
  v_cvt_pk_bf16_f32 v221, v122, v123
  v_cvt_pk_bf16_f32 v224, v124, v125
  v_mov_b32_dpp v222, v220 row_ror:8 row_mask:0xf bank_mask:0xf
  v_mov_b32_dpp v223, v221 row_ror:8 row_mask:0xf bank_mask:0xf
  v_mov_b32_dpp v225, v224 row_ror:8 row_mask:0xf bank_mask:0xf
  v_cvt_pk_bf16_f32 v228, v188, v189
  v_mfma_f32_16x16x32_bf16 v[200:203], v[176:179], v[220:223], 0
  v_cvt_pk_bf16_f32 v229, v190, v191
  v_cvt_pk_bf16_f32 v230, v192, v193
  v_mfma_f32_16x16x32_bf16 v[204:207], v[180:183], v[220:223], 0
  v_cvt_pk_bf16_f32 v231, v194, v195
  v_cvt_pk_bf16_f32 v232, v196, v197
  v_mfma_f32_16x16x32_bf16 v[208:211], v[184:187], v[220:223], 0
  v_cvt_pk_bf16_f32 v233, v198, v199
  v_add_f32 v126, v120, v121
  v_mfma_f32_16x16x32_bf16 v[200:203], v[228:231], v[224:227], v[200:203]
  v_add_f32 v127, v122, v123
  v_add_f32 v128, v124, v125
  v_mfma_f32_16x16x32_bf16 v[204:207], v[230:233], v[224:227], v[204:207]
  v_add_f32 v236, v126, v127
  v_fmac_f32 v236, v128, v89
  v_mfma_f32_16x16x32_bf16 v[208:211], v[232:235], v[224:227], v[208:211]
  s_nop 0
  v_add_f32_dpp v236, v236, v236 row_ror:8 row_mask:0xf bank_mask:0xf
  v_mov_b32 v237, v236
  ds_write_b128 v11, v[200:203] offset:0
  s_nop 0
  v_permlane32_swap_b32 v236, v237
  v_add_f32 v236, v236, v237
  v_mov_b32 v237, v236
  ds_write_b128 v11, v[204:207] offset:1024
  s_nop 0
  v_permlane16_swap_b32 v236, v237
  v_add_f32 v236, v236, v237
  v_rcp_f32 v236, v236
  ds_write_b128 v11, v[208:211] offset:2048
  s_mov_b64 exec, 0xff
  ds_write_b32 v242, v236
  s_mov_b64 exec, -1
  s_waitcnt lgkmcnt(0)
  s_barrier
  v_mov_b32 v28, -1
  v_mov_b32 v29, -1
  buffer_store_dwordx2 v[28:29], v24, s[8:11], s82 offen
  s_mov_b64 exec, s[60:61]
  s_add_u32 s22, s82, 278528
  buffer_store_dwordx2 v[28:29], v23, s[8:11], s22 offen
  s_and_b32 s21, s52, 7
  s_cmp_lg_u32 s21, s50
  s_cbranch_scc1 zm_109
  s_mov_b64 exec, s[70:71]
  buffer_store_dwordx4 v[156:159], v13, s[4:7], s83 offen sc1
zm_109:
  s_mov_b64 exec, -1
  v_mov_b32 v200, v196
  v_mov_b32 v201, v197
  v_mov_b32 v202, v198
  v_mov_b32 v203, v199
  v_permlane32_swap_b32 v188, v192
  v_permlane32_swap_b32 v189, v193
  v_permlane32_swap_b32 v190, v194
  v_permlane32_swap_b32 v191, v195
  v_permlane32_swap_b32 v196, v200
  v_permlane32_swap_b32 v197, v201
  v_permlane32_swap_b32 v198, v202
  v_permlane32_swap_b32 v199, v203
  v_pk_add_f32 v[188:189], v[188:189], v[192:193]
  v_pk_add_f32 v[190:191], v[190:191], v[194:195]
  v_pk_add_f32 v[196:197], v[196:197], v[200:201]
  v_pk_add_f32 v[198:199], v[198:199], v[202:203]
  v_cvt_pk_bf16_f32 v252, v188, v189
  v_cvt_pk_bf16_f32 v254, v196, v197
  v_cvt_pk_bf16_f32 v253, v190, v191
  v_cvt_pk_bf16_f32 v255, v198, v199
  s_nop 0
  v_permlane16_swap_b32 v252, v254
  v_permlane16_swap_b32 v253, v255
  v_min_u32 v252, -2, v252
  s_mov_b64 exec, s[76:77]
  buffer_store_dwordx4 v[252:255], v15, s[24:27], s57 offen sc1
  s_mov_b64 exec, -1
  s_add_u32 s64, s64, 1310720
  s_add_u32 s52, s52, 1
  s_and_b32 s21, s52, 3
  s_mul_i32 s81, s21, 540672
  s_lshl_b32 s84, s21, 15
  s_branch step_90
fl_94:
  buffer_load_dword v94, v95, s[12:15], s79 offen sc1
  s_branch fl_95
A1_18:
  v_smfmac_f32_16x16x32_f16 v[52:55], v[40:41], a[16:19], v44
  v_smfmac_f32_16x16x32_f16 v[64:67], v[40:41], a[76:79], v44
  v_smfmac_f32_16x16x32_f16 v[56:59], v[40:41], a[36:39], v44
  v_smfmac_f32_16x16x32_f16 v[68:71], v[40:41], a[96:99], v44
  s_branch A2_99
pm_100:
  buffer_load_dwordx4 v[40:43], v4, s[4:7], s84 offen offset:2048 sc1
  buffer_load_dwordx4 v[32:35], v4, s[4:7], s84 offen offset:0 sc1
  buffer_load_dwordx4 v[36:39], v4, s[4:7], s84 offen offset:1024 sc1
  s_nop 7
  v_mov_b32 v52, 0
  v_mov_b32 v53, 0
  v_mov_b32 v54, 0
  v_mov_b32 v55, 0
  v_mov_b32 v64, 0
  v_mov_b32 v65, 0
  v_mov_b32 v66, 0
  v_mov_b32 v67, 0
  v_mov_b32 v56, 0
  v_mov_b32 v57, 0
  v_mov_b32 v58, 0
  v_mov_b32 v59, 0
  v_mov_b32 v68, 0
  v_mov_b32 v69, 0
  v_mov_b32 v70, 0
  v_mov_b32 v71, 0
  s_waitcnt vmcnt(0)
  v_bitop3_b32 v27, v35, v39, v43 bitop3:0x80
  v_perm_b32 v35, v39, v35, s89
  v_cmp_gt_u32 vcc, 0x48000000, v27
  v_mov_b32 v39, v42
  s_cbranch_vccz A1_18
pm_92:
  s_cmp_gt_u32 s52, 3
  s_cbranch_scc1 op_110
  v_readfirstlane_b32 s21, v94
  s_cmp_ge_u32 s21, s46
  s_cbranch_scc1 op_110
  buffer_load_dword v94, v95, s[12:15], s79 offen sc1
  s_waitcnt vmcnt(0)
  v_readfirstlane_b32 s21, v94
  s_add_u32 s22, s46, 3
  s_min_u32 s22, s22, 64
  s_sub_u32 s55, s21, s22
  s_sub_u32 s56, s21, s46
  s_cmp_gt_u32 s21, s52
  s_cselect_b32 s21, s87, 0
  s_cmp_eq_u32 s21, 0
  s_cbranch_scc1 op_110
  s_mov_b32 s87, 0
  s_sub_u32 s21, s64, 1310720
  buffer_load_dwordx4 v[176:179], v16, s[28:31], s21 offen offset:0 sc1
  buffer_load_dwordx4 v[180:183], v16, s[28:31], s21 offen offset:1024 sc1
  buffer_load_dwordx4 v[184:187], v16, s[28:31], s21 offen offset:2048 sc1
op_110:
  buffer_load_dwordx4 v[40:43], v4, s[4:7], s84 offen offset:2048 sc1
  buffer_load_dwordx4 v[32:35], v4, s[4:7], s84 offen offset:0 sc1
  buffer_load_dwordx4 v[36:39], v4, s[4:7], s84 offen offset:1024 sc1
  s_add_u32 s54, s54, 1
  s_cmp_gt_u32 s54, 131072
  s_cbranch_scc1 end0
  s_waitcnt vmcnt(0)
  v_bitop3_b32 v27, v35, v39, v43 bitop3:0x80
  v_perm_b32 v35, v39, v35, s89
  v_cmp_gt_u32 vcc, 0x48000000, v27
  v_mov_b32 v39, v42
  s_cbranch_vccnz pm_92
  s_branch A1_18
pv_101:
  buffer_load_dwordx4 v[144:147], v10, s[8:11], s81 offen offset:0 sc1
  buffer_load_dwordx4 v[148:151], v10, s[8:11], s81 offen offset:1024 sc1
  buffer_load_dwordx4 v[152:155], v10, s[8:11], s81 offen offset:2048 sc1
  s_add_u32 s54, s54, 1
  s_cmp_gt_u32 s54, 131072
  s_cbranch_scc1 end0
  s_waitcnt vmcnt(0)
  v_max3_u32 v27, v144, v146, v148
  v_max3_u32 v27, v27, v150, v152
  v_max3_u32 v27, v27, v154, v154
  v_cmp_eq_u32 vcc, -1, v27
  s_nop 1
  s_cbranch_vccnz pv_101
  s_branch pvj_104
psr_102:
  buffer_load_dwordx2 v[248:249], v9, s[8:11], s81 offen sc1
  buffer_load_dwordx4 v[112:115], v8, s[8:11], s81 offen offset:0 sc1
  buffer_load_dwordx4 v[116:119], v8, s[8:11], s81 offen offset:1024 sc1
  s_add_u32 s54, s54, 1
  s_cmp_gt_u32 s54, 131072
  s_cbranch_scc1 end0
  s_waitcnt vmcnt(2)
  v_xor_b32 v96, s88, v248
  s_nop 0
  v_permlane16_swap_b32 v248, v249
  v_fma_mix_f32 v250, v248, 1.0, v249 op_sel:[0,0,0] op_sel_hi:[1,0,1]
  v_fma_mix_f32 v251, v248, 1.0, v249 op_sel:[1,0,1] op_sel_hi:[1,0,1]
  v_mov_b32 v248, v250
  v_mov_b32 v249, v251
  s_nop 0
  v_permlane32_swap_b32 v248, v250
  v_permlane32_swap_b32 v249, v251
  v_pk_add_f32 v[124:125], v[248:249], v[250:251]
  v_max_f32 v238, v124, v125
  s_waitcnt vmcnt(0)
  v_pk_add_f16 v100, v112, v116
  v_pk_add_f16 v102, v114, v118
  v_pk_add_f16 v101, v113, v117
  v_pk_add_f16 v103, v115, v119
  v_permlane32_swap_b32 v100, v102
  v_bitop3_b32 v97, v112, v114, s88 bitop3:0x7e
  v_permlane32_swap_b32 v101, v103
  v_bitop3_b32 v98, v116, v118, s88 bitop3:0x7e
  v_fma_mix_f32 v120, v100, 1.0, v102 op_sel:[0,0,0] op_sel_hi:[1,0,1]
  v_or3_b32 v27, v96, v97, v98
  v_fma_mix_f32 v121, v100, 1.0, v102 op_sel:[1,0,1] op_sel_hi:[1,0,1]
  v_and_b32 v27, 1, v27
  v_fma_mix_f32 v122, v101, 1.0, v103 op_sel:[0,0,0] op_sel_hi:[1,0,1]
  v_cmp_ne_u32 vcc, 0, v27
  v_fma_mix_f32 v123, v101, 1.0, v103 op_sel:[1,0,1] op_sel_hi:[1,0,1]
  v_max3_f32 v236, v120, v121, v238
  s_cbranch_vccnz psr_102
  s_branch psj_103
kvw_105:
  s_mov_b32 s22, s87
  s_cmp_eq_u32 s52, 0
  s_cselect_b32 s23, s87, s46
  s_cselect_b32 s55, 0, s55
  s_cselect_b32 s87, 1, 0
  s_cmp_eq_u32 s23, 0
  s_cbranch_scc1 kvok_106
  v_mov_b32 v236, 0
  s_mov_b32 s101, 0
wf_111:
  buffer_load_dword v237, v236, s[12:15], s79 offen sc1
  s_add_u32 s101, s101, 1
  s_cmp_gt_u32 s101, 131072
  s_cbranch_scc1 end0
  s_waitcnt vmcnt(0)
  v_readfirstlane_b32 s100, v237
  s_cmp_ge_u32 s100, s23
  s_cbranch_scc1 wf_112
  s_sleep 3
  s_branch wf_111
wf_112:
  s_cmp_eq_u32 s22, 0
  s_cbranch_scc1 kvok_106
  s_sub_u32 s21, s64, 1310720
  buffer_load_dwordx4 v[176:179], v16, s[28:31], s21 offen offset:0 sc1
  buffer_load_dwordx4 v[180:183], v16, s[28:31], s21 offen offset:1024 sc1
  buffer_load_dwordx4 v[184:187], v16, s[28:31], s21 offen offset:2048 sc1
  s_waitcnt vmcnt(0)
  s_branch kvok_106
fl_107:
  buffer_load_dword v94, v95, s[12:15], s79 offen sc1
  s_branch fl_108
last_91:
  v_mov_b32 v188, 0
  v_mov_b32 v189, 0
  v_mov_b32 v190, 0
  v_mov_b32 v191, 0
  v_mov_b32 v192, 0
  v_mov_b32 v193, 0
  v_mov_b32 v194, 0
  v_mov_b32 v195, 0
  v_mov_b32 v196, 0
  v_mov_b32 v197, 0
  v_mov_b32 v198, 0
  v_mov_b32 v199, 0
  s_sleep 4
  s_mov_b32 s54, 0
lv_113:
  buffer_load_dwordx4 v[144:147], v10, s[8:11], s81 offen offset:0 sc1
  buffer_load_dwordx4 v[148:151], v10, s[8:11], s81 offen offset:1024 sc1
  buffer_load_dwordx4 v[152:155], v10, s[8:11], s81 offen offset:2048 sc1
  s_add_u32 s54, s54, 1
  s_cmp_gt_u32 s54, 131072
  s_cbranch_scc1 end0
  s_waitcnt vmcnt(0)
  v_max3_u32 v27, v144, v146, v148
  v_max3_u32 v27, v27, v150, v152
  v_max3_u32 v27, v27, v154, v154
  v_cmp_eq_u32 vcc, -1, v27
  s_nop 1
  s_cbranch_vccnz lv_113
  v_smfmac_f32_16x16x64_bf16 v[188:191], v[144:147], a[180:187], v44
  v_smfmac_f32_16x16x64_bf16 v[192:195], v[144:147], a[204:211], v44
  v_smfmac_f32_16x16x64_bf16 v[196:199], v[144:147], a[228:235], v44
  v_smfmac_f32_16x16x64_bf16 v[188:191], v[148:151], a[188:195], v44
  v_smfmac_f32_16x16x64_bf16 v[192:195], v[148:151], a[212:219], v44
  v_smfmac_f32_16x16x64_bf16 v[196:199], v[148:151], a[236:243], v44
  v_smfmac_f32_16x16x64_bf16 v[188:191], v[152:155], a[196:203], v44
  v_smfmac_f32_16x16x64_bf16 v[192:195], v[152:155], a[220:227], v44
  v_smfmac_f32_16x16x64_bf16 v[196:199], v[152:155], a[244:251], v44
  s_nop 7
  v_mov_b32 v200, v196
  v_mov_b32 v201, v197
  v_mov_b32 v202, v198
  v_mov_b32 v203, v199
  v_permlane32_swap_b32 v188, v192
  v_permlane32_swap_b32 v189, v193
  v_permlane32_swap_b32 v190, v194
  v_permlane32_swap_b32 v191, v195
  v_permlane32_swap_b32 v196, v200
  v_permlane32_swap_b32 v197, v201
  v_permlane32_swap_b32 v198, v202
  v_permlane32_swap_b32 v199, v203
  v_pk_add_f32 v[188:189], v[188:189], v[192:193]
  v_pk_add_f32 v[190:191], v[190:191], v[194:195]
  v_pk_add_f32 v[196:197], v[196:197], v[200:201]
  v_pk_add_f32 v[198:199], v[198:199], v[202:203]
  v_cvt_pk_bf16_f32 v252, v188, v189
  v_cvt_pk_bf16_f32 v254, v196, v197
  v_cvt_pk_bf16_f32 v253, v190, v191
  v_cvt_pk_bf16_f32 v255, v198, v199
  s_nop 0
  v_permlane16_swap_b32 v252, v254
  v_permlane16_swap_b32 v253, v255
  v_min_u32 v252, -2, v252
  s_mov_b64 exec, s[76:77]
  buffer_store_dwordx4 v[252:255], v15, s[24:27], s57 offen sc1
  s_mov_b64 exec, -1
  s_branch chain_done
step_114:
  s_add_u32 s21, s52, 2
  s_and_b32 s21, s21, 3
  s_mul_i32 s82, s21, 540672
  s_add_u32 s21, s52, 3
  s_and_b32 s21, s21, 3
  s_lshl_b32 s83, s21, 15
  s_add_u32 s21, s52, 1
  s_and_b32 s22, s21, 3
  s_lshl_b32 s3, s22, 15
  s_mul_i32 s80, s21, 393216
  s_add_u32 s46, s21, 1
  s_min_u32 s46, s46, 64
  s_mul_i32 s85, s52, 98304
  s_mul_i32 s57, s52, 327680
  s_add_u32 s57, s57, 51380224

  s_bfe_u32 s88, s52, 0x10002
  s_add_u32 s78, s81, 278528
  s_max_u32 s21, s52, 1
  s_sub_u32 s21, s21, 1
  s_cmp_lt_u32 s52, 98
  s_cselect_b32 s66, s65, 0x80000000
  s_cselect_b32 s68, 15, 1
  s_cmp_ge_u32 s52, 99
  s_cselect_b32 s66, s90, s66
  s_cselect_b32 s67, s52, s21
  v_mov_b32 v52, 0
  v_mov_b32 v53, 0
  v_mov_b32 v54, 0
  v_mov_b32 v55, 0
  v_mov_b32 v56, 0
  v_mov_b32 v57, 0
  v_mov_b32 v58, 0
  v_mov_b32 v59, 0
  v_mov_b32 v60, 0
  v_mov_b32 v61, 0
  v_mov_b32 v62, 0
  v_mov_b32 v63, 0
  v_mov_b32 v64, 0
  v_mov_b32 v65, 0
  v_mov_b32 v66, 0
  v_mov_b32 v67, 0
  v_mov_b32 v68, 0
  v_mov_b32 v69, 0
  v_mov_b32 v70, 0
  v_mov_b32 v71, 0
  v_mov_b32 v72, 0
  v_mov_b32 v73, 0
  v_mov_b32 v74, 0
  v_mov_b32 v75, 0
  v_mov_b32 v76, 0
  v_mov_b32 v77, 0
  v_mov_b32 v78, 0
  v_mov_b32 v79, 0
  v_mov_b32 v80, 0
  v_mov_b32 v81, 0
  v_mov_b32 v82, 0
  v_mov_b32 v83, 0
  v_mov_b32 v84, 0
  v_mov_b32 v85, 0
  v_mov_b32 v86, 0
  v_mov_b32 v87, 0
  s_sleep 8
  v_readfirstlane_b32 s21, v94
  s_cmp_lt_u32 s21, s46
  s_cselect_b32 s55, s55, 0
  s_cmp_lt_i32 s55, 0
  s_cbranch_scc1 fl_118
fl_119:
  s_mov_b32 s54, 0
  buffer_load_dwordx4 v[40:43], v4, s[4:7], s84 offen offset:2048 sc1
  buffer_load_dwordx4 v[32:35], v4, s[4:7], s84 offen offset:0 sc1
  buffer_load_dwordx4 v[36:39], v4, s[4:7], s84 offen offset:1024 sc1
  s_waitcnt vmcnt(3)
  v_mov_b32 v176, v160
  v_mov_b32 v177, v161
  v_mov_b32 v178, v162
  v_mov_b32 v179, v163
  v_mov_b32 v180, v164
  v_mov_b32 v181, v165
  v_mov_b32 v182, v166
  v_mov_b32 v183, v167
  v_mov_b32 v184, v48
  v_mov_b32 v185, v49
  v_mov_b32 v186, v50
  v_mov_b32 v187, v51
lm_121:
  s_waitcnt vmcnt(2)
  v_smfmac_f32_16x16x32_f16 v[52:55], v[40:41], a[16:19], v44
  v_smfmac_f32_16x16x32_f16 v[64:67], v[40:41], a[76:79], v44
  v_smfmac_f32_16x16x32_f16 v[56:59], v[40:41], a[36:39], v44
  s_waitcnt vmcnt(0)
  v_bitop3_b32 v27, v35, v39, v43 bitop3:0x80
  v_perm_b32 v35, v39, v35, s89
  v_cmp_gt_u32 vcc, 0x48000000, v27
  v_mov_b32 v39, v42
  v_smfmac_f32_16x16x32_f16 v[68:71], v[40:41], a[96:99], v44
  s_cbranch_vccnz pm_124
A2_123:
  v_smfmac_f32_16x16x64_f16 v[52:55], v[32:35], a[0:7], v44
  v_smfmac_f32_16x16x64_f16 v[52:55], v[36:39], a[8:15], v44
  v_smfmac_f32_16x16x64_f16 v[64:67], v[32:35], a[60:67], v44
  v_smfmac_f32_16x16x64_f16 v[64:67], v[36:39], a[68:75], v44
  v_smfmac_f32_16x16x32_f16 v[60:63], v[40:41], a[56:59], v44
  v_cvt_pk_f16_f32 v52, v52, v53
  v_cvt_pk_f16_f32 v53, v54, v55
  v_smfmac_f32_16x16x32_f16 v[72:75], v[40:41], a[116:119], v44
  v_smfmac_f32_16x16x32_f16 v[76:79], v[40:41], a[136:139], v44
  v_cvt_pk_f16_f32 v64, v64, v65
  v_cvt_pk_f16_f32 v65, v66, v67
  s_nop 0
  v_smfmac_f32_16x16x64_f16 v[56:59], v[32:35], a[20:27], v44
  v_permlane32_swap_b32 v52, v64
  v_smfmac_f32_16x16x64_f16 v[56:59], v[36:39], a[28:35], v44
  v_permlane32_swap_b32 v53, v65
  v_pk_add_f16 v52, v52, v64
  v_smfmac_f32_16x16x64_f16 v[68:71], v[32:35], a[80:87], v44
  v_pk_add_f16 v53, v53, v65
  v_smfmac_f32_16x16x64_f16 v[68:71], v[36:39], a[88:95], v44
  ds_write_b64 v5, v[52:53] offset:0
  v_smfmac_f32_16x16x32_f16 v[80:83], v[40:41], a[156:159], v44
  v_cvt_pk_f16_f32 v56, v56, v57
  v_cvt_pk_f16_f32 v57, v58, v59
  v_smfmac_f32_16x16x32_f16 v[84:87], v[40:41], a[176:179], v44
  v_cvt_pk_f16_f32 v68, v68, v69
  v_cvt_pk_f16_f32 v69, v70, v71
  s_nop 0
  v_smfmac_f32_16x16x64_f16 v[60:63], v[32:35], a[40:47], v44
  v_permlane32_swap_b32 v56, v68
  v_smfmac_f32_16x16x64_f16 v[60:63], v[36:39], a[48:55], v44
  v_permlane32_swap_b32 v57, v69
  v_pk_add_f16 v56, v56, v68
  v_smfmac_f32_16x16x64_f16 v[72:75], v[32:35], a[100:107], v44
  v_pk_add_f16 v57, v57, v69
  v_smfmac_f32_16x16x64_f16 v[72:75], v[36:39], a[108:115], v44
  ds_write_b64 v5, v[56:57] offset:640
  v_smfmac_f32_16x16x64_f16 v[76:79], v[32:35], a[120:127], v44
  v_cvt_pk_f16_f32 v60, v60, v61
  v_cvt_pk_f16_f32 v61, v62, v63
  v_smfmac_f32_16x16x64_f16 v[76:79], v[36:39], a[128:135], v44
  v_cvt_pk_f16_f32 v72, v72, v73
  v_cvt_pk_f16_f32 v73, v74, v75
  s_nop 0
  v_smfmac_f32_16x16x64_f16 v[80:83], v[32:35], a[140:147], v44
  v_permlane32_swap_b32 v60, v72
  v_smfmac_f32_16x16x64_f16 v[80:83], v[36:39], a[148:155], v44
  v_permlane32_swap_b32 v61, v73
  v_pk_add_f16 v60, v60, v72
  v_smfmac_f32_16x16x64_f16 v[84:87], v[32:35], a[160:167], v44
  v_pk_add_f16 v61, v61, v73
  v_smfmac_f32_16x16x64_f16 v[84:87], v[36:39], a[168:175], v44
  ds_write_b64 v5, v[60:61] offset:1280
  v_cvt_pk_f16_f32 v76, v76, v77
  v_cvt_pk_f16_f32 v77, v78, v79
  v_cvt_pk_f16_f32 v80, v80, v81
  v_cvt_pk_f16_f32 v81, v82, v83
  s_nop 0
  v_permlane32_swap_b32 v76, v80
  v_permlane32_swap_b32 v77, v81
  v_pk_add_f16 v76, v76, v80
  v_pk_add_f16 v77, v77, v81
  ds_write_b64 v5, v[76:77] offset:1920
  v_cvt_pk_f16_f32 v84, v84, v85
  v_cvt_pk_f16_f32 v85, v86, v87
  ds_write_b64 v5, v[84:85] offset:2560
  s_waitcnt lgkmcnt(0) vmcnt(0)
  s_barrier
  s_lshr_b32 s21, 3, s20
  s_bitcmp1_b32 s21, 0
  s_cbranch_scc0 bw_126
  ds_read_b64_tr_b16 v[104:105], v45 offset:0
  ds_read_b64_tr_b16 v[106:107], v45 offset:3200
  ds_read_b64_tr_b16 v[108:109], v45 offset:640
  ds_read_b64_tr_b16 v[110:111], v45 offset:3840
  ds_read_b64_tr_b16 v[112:113], v45 offset:1280
  ds_read_b64_tr_b16 v[114:115], v45 offset:4480
  s_waitcnt lgkmcnt(4)
  v_fma_mix_f32 v120, v104, 1.0, v106 op_sel:[0,0,0] op_sel_hi:[1,0,1]
  v_fma_mix_f32 v121, v104, 1.0, v106 op_sel:[1,0,1] op_sel_hi:[1,0,1]
  v_fma_mix_f32 v122, v105, 1.0, v107 op_sel:[0,0,0] op_sel_hi:[1,0,1]
  v_fma_mix_f32 v123, v105, 1.0, v107 op_sel:[1,0,1] op_sel_hi:[1,0,1]
  v_add_f32_dpp v124, v120, v120 row_ror:8 row_mask:0xf bank_mask:0xf
  v_add_f32_dpp v125, v121, v121 row_ror:8 row_mask:0xf bank_mask:0xf
  v_add_f32_dpp v126, v122, v122 row_ror:8 row_mask:0xf bank_mask:0xf
  v_add_f32_dpp v127, v123, v123 row_ror:8 row_mask:0xf bank_mask:0xf
  v_cvt_pk_bf16_f32 v212, v124, v125
  v_cvt_pk_bf16_f32 v213, v126, v127
  s_waitcnt lgkmcnt(2)
  v_fma_mix_f32 v120, v108, 1.0, v110 op_sel:[0,0,0] op_sel_hi:[1,0,1]
  v_fma_mix_f32 v121, v108, 1.0, v110 op_sel:[1,0,1] op_sel_hi:[1,0,1]
  v_fma_mix_f32 v122, v109, 1.0, v111 op_sel:[0,0,0] op_sel_hi:[1,0,1]
  v_fma_mix_f32 v123, v109, 1.0, v111 op_sel:[1,0,1] op_sel_hi:[1,0,1]
  v_add_f32_dpp v124, v120, v120 row_ror:8 row_mask:0xf bank_mask:0xf
  v_add_f32_dpp v125, v121, v121 row_ror:8 row_mask:0xf bank_mask:0xf
  v_add_f32_dpp v126, v122, v122 row_ror:8 row_mask:0xf bank_mask:0xf
  v_add_f32_dpp v127, v123, v123 row_ror:8 row_mask:0xf bank_mask:0xf
  v_cvt_pk_bf16_f32 v214, v124, v125
  v_cvt_pk_bf16_f32 v215, v126, v127
  s_waitcnt lgkmcnt(0)
  v_fma_mix_f32 v120, v112, 1.0, v114 op_sel:[0,0,0] op_sel_hi:[1,0,1]
  v_fma_mix_f32 v121, v112, 1.0, v114 op_sel:[1,0,1] op_sel_hi:[1,0,1]
  v_fma_mix_f32 v122, v113, 1.0, v115 op_sel:[0,0,0] op_sel_hi:[1,0,1]
  v_fma_mix_f32 v123, v113, 1.0, v115 op_sel:[1,0,1] op_sel_hi:[1,0,1]
  v_mfma_f32_16x16x32_bf16 v[96:99], v[168:171], v[212:215], 0
  v_add_f32_dpp v124, v120, v120 row_ror:8 row_mask:0xf bank_mask:0xf
  v_add_f32_dpp v125, v121, v121 row_ror:8 row_mask:0xf bank_mask:0xf
  v_add_f32_dpp v126, v122, v122 row_ror:8 row_mask:0xf bank_mask:0xf
  v_add_f32_dpp v127, v123, v123 row_ror:8 row_mask:0xf bank_mask:0xf
  v_cvt_pk_bf16_f32 v216, v124, v125
  v_cvt_pk_bf16_f32 v217, v126, v127
  s_nop 1
  v_mfma_f32_16x16x32_bf16 v[96:99], v[172:175], v[216:219], v[96:99]
  s_mov_b64 exec, s[74:75]
  s_nop 6
  v_cvt_pk_f16_f32 v100, v96, v97
  v_cvt_pk_f16_f32 v101, v98, v99
  v_and_or_b32 v100, v100, -2, s88
  s_cmp_eq_u32 s53, 1
  s_cbranch_scc1 si_127
  buffer_store_dwordx2 v[100:101], v7, s[8:11], s81 offen sc1
  s_branch si_128
si_127:
  buffer_store_dwordx2 v[100:101], v7, s[8:11], s81 offen
si_128:
  s_mov_b64 exec, -1
  s_branch bw_125
bw_126:
  s_lshr_b32 s21, 4, s20
  s_bitcmp1_b32 s21, 0
  s_cbranch_scc0 bw_129
  ds_read_b64_tr_b16 v[104:105], v6 offset:0
  ds_read_b64_tr_b16 v[106:107], v6 offset:3200
  ds_read_b64_tr_b16 v[108:109], v6 offset:6400
  ds_read_b64_tr_b16 v[110:111], v6 offset:9600
  ds_read_b64_tr_b16 v[112:113], v6 offset:640
  ds_read_b64_tr_b16 v[114:115], v6 offset:3840
  ds_read_b64_tr_b16 v[116:117], v6 offset:7040
  ds_read_b64_tr_b16 v[118:119], v6 offset:10240
  ds_read_b64_tr_b16 v[120:121], v6 offset:1280
  ds_read_b64_tr_b16 v[122:123], v6 offset:4480
  ds_read_b64_tr_b16 v[124:125], v6 offset:7680
  ds_read_b64_tr_b16 v[126:127], v6 offset:10880
  s_waitcnt lgkmcnt(8)
  v_pk_add_f16 v104, v104, v106
  v_pk_add_f16 v108, v108, v110
  v_pk_add_f16 v105, v105, v107
  v_pk_add_f16 v109, v109, v111
  v_fma_mix_f32 v128, v104, 1.0, v108 op_sel:[0,0,0] op_sel_hi:[1,0,1]
  v_fma_mix_f32 v129, v104, 1.0, v108 op_sel:[1,0,1] op_sel_hi:[1,0,1]
  v_fma_mix_f32 v130, v105, 1.0, v109 op_sel:[0,0,0] op_sel_hi:[1,0,1]
  v_fma_mix_f32 v131, v105, 1.0, v109 op_sel:[1,0,1] op_sel_hi:[1,0,1]
  v_cvt_pk_bf16_f32 v212, v128, v129
  v_cvt_pk_bf16_f32 v213, v130, v131
  s_waitcnt lgkmcnt(4)
  v_pk_add_f16 v112, v112, v114
  v_pk_add_f16 v116, v116, v118
  v_pk_add_f16 v113, v113, v115
  v_pk_add_f16 v117, v117, v119
  v_fma_mix_f32 v128, v112, 1.0, v116 op_sel:[0,0,0] op_sel_hi:[1,0,1]
  v_fma_mix_f32 v129, v112, 1.0, v116 op_sel:[1,0,1] op_sel_hi:[1,0,1]
  v_fma_mix_f32 v130, v113, 1.0, v117 op_sel:[0,0,0] op_sel_hi:[1,0,1]
  v_fma_mix_f32 v131, v113, 1.0, v117 op_sel:[1,0,1] op_sel_hi:[1,0,1]
  v_cvt_pk_bf16_f32 v214, v128, v129
  v_cvt_pk_bf16_f32 v215, v130, v131
  s_waitcnt lgkmcnt(0)
  v_pk_add_f16 v120, v120, v122
  v_pk_add_f16 v124, v124, v126
  v_pk_add_f16 v121, v121, v123
  v_pk_add_f16 v125, v125, v127
  v_fma_mix_f32 v128, v120, 1.0, v124 op_sel:[0,0,0] op_sel_hi:[1,0,1]
  v_fma_mix_f32 v129, v120, 1.0, v124 op_sel:[1,0,1] op_sel_hi:[1,0,1]
  v_mfma_f32_16x16x32_bf16 v[96:99], v[212:215], v[212:215], 0
  v_fma_mix_f32 v130, v121, 1.0, v125 op_sel:[0,0,0] op_sel_hi:[1,0,1]
  v_fma_mix_f32 v131, v121, 1.0, v125 op_sel:[1,0,1] op_sel_hi:[1,0,1]
  v_cvt_pk_bf16_f32 v216, v128, v129
  v_cvt_pk_bf16_f32 v217, v130, v131
  s_nop 1
  v_mfma_f32_16x16x32_bf16 v[96:99], v[216:219], v[216:219], v[96:99]
  s_mov_b64 exec, s[74:75]
  s_nop 6
  v_cvt_pk_f16_f32 v100, v96, v97
  v_cvt_pk_f16_f32 v101, v98, v99
  v_and_or_b32 v100, v100, -2, s88
  s_cmp_eq_u32 s53, 1
  s_cbranch_scc1 si_130
  buffer_store_dwordx2 v[100:101], v7, s[8:11], s81 offen sc1
  s_branch si_131
si_130:
  buffer_store_dwordx2 v[100:101], v7, s[8:11], s81 offen
si_131:
  s_mov_b64 exec, -1
  s_branch bw_125
bw_129:
  s_lshr_b32 s21, 8, s20
  s_bitcmp1_b32 s21, 0
  s_cbranch_scc0 bw_132
  ds_read_b64_tr_b16 v[96:97], v6 offset:1920
  ds_read_b64_tr_b16 v[98:99], v6 offset:5120
  ds_read_b64_tr_b16 v[100:101], v6 offset:8320
  ds_read_b64_tr_b16 v[102:103], v6 offset:11520
  ds_read_b64_tr_b16 v[104:105], v6 offset:2560
  ds_read_b64_tr_b16 v[106:107], v6 offset:5760
  ds_read_b64_tr_b16 v[108:109], v6 offset:8960
  ds_read_b64_tr_b16 v[110:111], v6 offset:12160
  s_waitcnt lgkmcnt(4)
  v_pk_add_f16 v96, v96, v98
  v_pk_add_f16 v100, v100, v102
  v_pk_add_f16 v97, v97, v99
  v_pk_add_f16 v101, v101, v103
  v_fma_mix_f32 v112, v96, 1.0, v100 op_sel:[0,0,0] op_sel_hi:[1,0,1]
  v_fma_mix_f32 v113, v96, 1.0, v100 op_sel:[1,0,1] op_sel_hi:[1,0,1]
  v_fma_mix_f32 v114, v97, 1.0, v101 op_sel:[0,0,0] op_sel_hi:[1,0,1]
  v_fma_mix_f32 v115, v97, 1.0, v101 op_sel:[1,0,1] op_sel_hi:[1,0,1]
  v_cvt_pk_bf16_f32 v90, v112, v113
  v_cvt_pk_bf16_f32 v91, v114, v115
  v_min_u32 v90, -2, v90
  s_cmp_eq_u32 s53, 1
  s_cbranch_scc1 si_133
  buffer_store_dwordx2 v[90:91], v24, s[8:11], s81 offen sc1
  s_branch si_134
si_133:
  buffer_store_dwordx2 v[90:91], v24, s[8:11], s81 offen
si_134:
  s_waitcnt lgkmcnt(0)
  v_pk_add_f16 v104, v104, v106
  v_pk_add_f16 v108, v108, v110
  v_pk_add_f16 v105, v105, v107
  v_pk_add_f16 v109, v109, v111
  v_fma_mix_f32 v112, v104, 1.0, v108 op_sel:[0,0,0] op_sel_hi:[1,0,1]
  v_fma_mix_f32 v113, v104, 1.0, v108 op_sel:[1,0,1] op_sel_hi:[1,0,1]
  v_fma_mix_f32 v114, v105, 1.0, v109 op_sel:[0,0,0] op_sel_hi:[1,0,1]
  v_fma_mix_f32 v115, v105, 1.0, v109 op_sel:[1,0,1] op_sel_hi:[1,0,1]
  v_add_f32_dpp v116, v112, v112 row_ror:8 row_mask:0xf bank_mask:0xf
  v_add_f32_dpp v117, v113, v113 row_ror:8 row_mask:0xf bank_mask:0xf
  v_add_f32_dpp v118, v114, v114 row_ror:8 row_mask:0xf bank_mask:0xf
  v_add_f32_dpp v119, v115, v115 row_ror:8 row_mask:0xf bank_mask:0xf
  v_cvt_pk_bf16_f32 v92, v116, v117
  v_cvt_pk_bf16_f32 v93, v118, v119
  v_min_u32 v92, -2, v92
  s_mov_b64 exec, s[60:61]
  s_cmp_eq_u32 s53, 1
  s_cbranch_scc1 si_135
  buffer_store_dwordx2 v[92:93], v23, s[8:11], s78 offen sc1
  s_branch si_136
si_135:
  buffer_store_dwordx2 v[92:93], v23, s[8:11], s78 offen
si_136:
  s_mov_b64 exec, -1
  s_branch bw_125
bw_132:
bw_125:
  s_cmp_eq_u32 s52, 63
  s_cbranch_scc1 last_115
  s_mov_b32 s54, 0
pv_137:
  buffer_load_dwordx4 v[144:147], v10, s[8:11], s81 offen offset:0 sc1
  buffer_load_dwordx4 v[148:151], v10, s[8:11], s81 offen offset:1024 sc1
  buffer_load_dwordx4 v[152:155], v10, s[8:11], s81 offen offset:2048 sc1
  v_mov_b32 v188, 0
  v_mov_b32 v189, 0
  v_mov_b32 v190, 0
  v_mov_b32 v191, 0
  v_mov_b32 v192, 0
  v_mov_b32 v193, 0
  v_mov_b32 v194, 0
  v_mov_b32 v195, 0
  v_mov_b32 v196, 0
  v_mov_b32 v197, 0
  v_mov_b32 v198, 0
  v_mov_b32 v199, 0
  s_add_u32 s54, s54, 1
  s_cmp_gt_u32 s54, 131072
  s_cbranch_scc1 end0
  s_waitcnt vmcnt(0)
  v_max3_u32 v27, v144, v146, v148
  v_max3_u32 v27, v27, v150, v152
  v_max3_u32 v27, v27, v154, v154
  v_cmp_eq_u32 vcc, -1, v27
  s_nop 1
  s_cbranch_vccnz pv_137
  buffer_load_dwordx2 v[248:249], v9, s[8:11], s81 offen sc1
  buffer_load_dwordx4 v[112:115], v8, s[8:11], s81 offen offset:0 sc1
  buffer_load_dwordx4 v[116:119], v8, s[8:11], s81 offen offset:1024 sc1
  v_smfmac_f32_16x16x64_bf16 v[188:191], v[144:147], a[180:187], v44
  v_smfmac_f32_16x16x64_bf16 v[192:195], v[144:147], a[204:211], v44
  v_smfmac_f32_16x16x64_bf16 v[196:199], v[144:147], a[228:235], v44
  v_smfmac_f32_16x16x64_bf16 v[188:191], v[148:151], a[188:195], v44
  v_smfmac_f32_16x16x64_bf16 v[192:195], v[148:151], a[212:219], v44
  v_smfmac_f32_16x16x64_bf16 v[196:199], v[148:151], a[236:243], v44
  v_smfmac_f32_16x16x64_bf16 v[188:191], v[152:155], a[196:203], v44
  v_smfmac_f32_16x16x64_bf16 v[192:195], v[152:155], a[220:227], v44
  v_smfmac_f32_16x16x64_bf16 v[196:199], v[152:155], a[244:251], v44
  v_readfirstlane_b32 s21, v94
  s_add_u32 s22, s46, 3
  s_min_u32 s22, s22, 64
  s_sub_u32 s55, s21, s22
  s_sub_u32 s56, s21, s46
  s_cmp_lt_i32 s56, 0
  s_cbranch_scc1 kvw_140
kvok_141:
  s_waitcnt vmcnt(2)
  v_xor_b32 v96, s88, v248
  s_nop 0
  v_permlane16_swap_b32 v248, v249
  v_fma_mix_f32 v250, v248, 1.0, v249 op_sel:[0,0,0] op_sel_hi:[1,0,1]
  v_fma_mix_f32 v251, v248, 1.0, v249 op_sel:[1,0,1] op_sel_hi:[1,0,1]
  v_mov_b32 v248, v250
  v_mov_b32 v249, v251
  s_nop 0
  v_permlane32_swap_b32 v248, v250
  v_permlane32_swap_b32 v249, v251
  v_pk_add_f32 v[124:125], v[248:249], v[250:251]
  v_max_f32 v238, v124, v125
  s_waitcnt vmcnt(0)
  v_pk_add_f16 v100, v112, v116
  v_pk_add_f16 v102, v114, v118
  v_pk_add_f16 v101, v113, v117
  v_pk_add_f16 v103, v115, v119
  v_permlane32_swap_b32 v100, v102
  v_bitop3_b32 v97, v112, v114, s88 bitop3:0x7e
  v_permlane32_swap_b32 v101, v103
  v_bitop3_b32 v98, v116, v118, s88 bitop3:0x7e
  v_fma_mix_f32 v120, v100, 1.0, v102 op_sel:[0,0,0] op_sel_hi:[1,0,1]
  v_or3_b32 v27, v96, v97, v98
  v_fma_mix_f32 v121, v100, 1.0, v102 op_sel:[1,0,1] op_sel_hi:[1,0,1]
  v_and_b32 v27, 1, v27
  v_fma_mix_f32 v122, v101, 1.0, v103 op_sel:[0,0,0] op_sel_hi:[1,0,1]
  v_cmp_ne_u32 vcc, 0, v27
  v_fma_mix_f32 v123, v101, 1.0, v103 op_sel:[1,0,1] op_sel_hi:[1,0,1]
  v_max3_f32 v236, v120, v121, v238
  s_cbranch_vccnz psr_138
psj_139:
  v_max3_f32 v236, v236, v122, v123
  s_nop 1
  v_max_f32_dpp v236, v236, v236 row_ror:8 row_mask:0xf bank_mask:0xf
  v_mov_b32 v237, v236
  s_nop 1
  v_permlane32_swap_b32 v236, v237
  v_max_f32 v236, v236, v237
  v_mov_b32 v237, v236
  s_nop 1
  v_permlane16_swap_b32 v236, v237
  v_max_f32 v236, v236, v237
  v_mul_f32 v236, s86, v236
  v_fma_f32 v120, v120, s86, -v236
  v_fma_f32 v121, v121, s86, -v236
  buffer_load_dwordx4 v[160:163], v17, s[28:31], s64 offen offset:0 sc1
  v_fma_f32 v122, v122, s86, -v236
  v_fma_f32 v123, v123, s86, -v236
  buffer_load_dwordx4 v[164:167], v16, s[28:31], s64 offen offset:1024 sc1
  v_fma_f32 v124, v124, s86, -v236
  v_fma_f32 v125, v125, s86, -v236
  buffer_load_dwordx4 v[48:51], v26, s[28:31], s64 offen offset:2048 sc1
  v_exp_f32 v120, v120
  v_exp_f32 v121, v121
  s_lshr_b32 s21, 3, s20
  s_bitcmp1_b32 s21, 0
  s_cbranch_scc0 bw_143
  buffer_load_dwordx4 v[168:171], v18, s[16:19], s80 offen sc1
  s_branch bw_142
bw_143:
  s_lshr_b32 s21, 4, s20
  s_bitcmp1_b32 s21, 0
  s_cbranch_scc0 bw_144
  s_branch bw_142
bw_144:
  s_lshr_b32 s21, 8, s20
  s_bitcmp1_b32 s21, 0
  s_cbranch_scc0 bw_145
  s_branch bw_142
bw_145:
bw_142:
  v_exp_f32 v122, v122
  s_lshr_b32 s21, 3, s20
  s_bitcmp1_b32 s21, 0
  s_cbranch_scc0 bw_147
  buffer_load_dwordx2 v[172:173], v20, s[16:19], s80 offen sc1
  s_branch bw_146
bw_147:
  s_lshr_b32 s21, 4, s20
  s_bitcmp1_b32 s21, 0
  s_cbranch_scc0 bw_148
  s_branch bw_146
bw_148:
  s_lshr_b32 s21, 8, s20
  s_bitcmp1_b32 s21, 0
  s_cbranch_scc0 bw_149
  s_branch bw_146
bw_149:
bw_146:
  v_exp_f32 v123, v123
  s_lshr_b32 s21, 3, s20
  s_bitcmp1_b32 s21, 0
  s_cbranch_scc0 bw_151
  s_branch bw_150
bw_151:
  s_lshr_b32 s21, 4, s20
  s_bitcmp1_b32 s21, 0
  s_cbranch_scc0 bw_152
  s_branch bw_150
bw_152:
  s_lshr_b32 s21, 8, s20
  s_bitcmp1_b32 s21, 0
  s_cbranch_scc0 bw_153
  v_mov_b32 v240, s67
  v_mov_b32 v241, s67
  s_mov_b64 exec, s[68:69]
  buffer_store_dwordx2 v[240:241], v88, s[12:15], s66 offen sc1
  s_mov_b64 exec, -1
  s_branch bw_150
bw_153:
bw_150:
  v_exp_f32 v124, v124
  s_cmp_lt_i32 s55, 0
  s_cbranch_scc1 fl_154
fl_155:
  v_exp_f32 v125, v125
  v_cvt_pk_bf16_f32 v220, v120, v121
  v_cvt_pk_bf16_f32 v221, v122, v123
  v_cvt_pk_bf16_f32 v224, v124, v125
  v_mov_b32_dpp v222, v220 row_ror:8 row_mask:0xf bank_mask:0xf
  v_mov_b32_dpp v223, v221 row_ror:8 row_mask:0xf bank_mask:0xf
  v_mov_b32_dpp v225, v224 row_ror:8 row_mask:0xf bank_mask:0xf
  v_cvt_pk_bf16_f32 v228, v188, v189
  v_mfma_f32_16x16x32_bf16 v[200:203], v[176:179], v[220:223], 0
  v_cvt_pk_bf16_f32 v229, v190, v191
  v_cvt_pk_bf16_f32 v230, v192, v193
  v_mfma_f32_16x16x32_bf16 v[204:207], v[180:183], v[220:223], 0
  v_cvt_pk_bf16_f32 v231, v194, v195
  v_cvt_pk_bf16_f32 v232, v196, v197
  v_mfma_f32_16x16x32_bf16 v[208:211], v[184:187], v[220:223], 0
  v_cvt_pk_bf16_f32 v233, v198, v199
  v_add_f32 v126, v120, v121
  v_mfma_f32_16x16x32_bf16 v[200:203], v[228:231], v[224:227], v[200:203]
  v_add_f32 v127, v122, v123
  v_add_f32 v128, v124, v125
  v_mfma_f32_16x16x32_bf16 v[204:207], v[230:233], v[224:227], v[204:207]
  v_add_f32 v236, v126, v127
  v_fmac_f32 v236, v128, v89
  v_mfma_f32_16x16x32_bf16 v[208:211], v[232:235], v[224:227], v[208:211]
  s_nop 0
  v_add_f32_dpp v236, v236, v236 row_ror:8 row_mask:0xf bank_mask:0xf
  v_mov_b32 v237, v236
  ds_write_b128 v11, v[200:203] offset:0
  s_nop 0
  v_permlane32_swap_b32 v236, v237
  v_add_f32 v236, v236, v237
  v_mov_b32 v237, v236
  ds_write_b128 v11, v[204:207] offset:1024
  s_nop 0
  v_permlane16_swap_b32 v236, v237
  v_add_f32 v236, v236, v237
  v_rcp_f32 v236, v236
  ds_write_b128 v11, v[208:211] offset:2048
  s_mov_b64 exec, 0xff
  ds_write_b32 v242, v236
  s_mov_b64 exec, -1
  s_waitcnt lgkmcnt(0)
  s_barrier
  s_lshr_b32 s21, 7, s20
  s_bitcmp1_b32 s21, 0
  s_cbranch_scc0 bw_157
  ds_read_b128 v[104:107], v243
  ds_read_b64 v[96:97], v12 offset:0
  ds_read_b64 v[98:99], v12 offset:3072
  ds_read_b64 v[100:101], v12 offset:6144
  ds_read_b64 v[102:103], v12 offset:9216
  s_waitcnt lgkmcnt(2)
  v_pk_mul_f32 v[96:97], v[96:97], v[104:105] op_sel_hi:[1,0]
  v_pk_fma_f32 v[96:97], v[98:99], v[104:105], v[96:97] op_sel:[0,1,0] op_sel_hi:[1,1,1]
  s_waitcnt lgkmcnt(0)
  v_pk_fma_f32 v[96:97], v[100:101], v[106:107], v[96:97] op_sel_hi:[1,0,1]
  v_pk_fma_f32 v[96:97], v[102:103], v[106:107], v[96:97] op_sel:[0,1,0] op_sel_hi:[1,1,1]
  v_cvt_pk_f16_f32 v100, v96, v97
  v_perm_b32 v100, s91, v100, v14
  buffer_atomic_pk_add_f16 v100, v13, s[4:7], s3 offen
  s_branch bw_156
bw_157:
  s_lshr_b32 s21, 8, s20
  s_bitcmp1_b32 s21, 0
  s_cbranch_scc0 bw_158
  v_mov_b32 v28, -1
  v_mov_b32 v29, -1
  s_cmp_eq_u32 s53, 1
  s_cbranch_scc1 si_159
  buffer_store_dwordx2 v[28:29], v24, s[8:11], s82 offen sc1
  s_branch si_160
si_159:
  buffer_store_dwordx2 v[28:29], v24, s[8:11], s82 offen
si_160:
  s_mov_b64 exec, s[60:61]
  s_add_u32 s22, s82, 278528
  s_cmp_eq_u32 s53, 1
  s_cbranch_scc1 si_161
  buffer_store_dwordx2 v[28:29], v23, s[8:11], s22 offen sc1
  s_branch si_162
si_161:
  buffer_store_dwordx2 v[28:29], v23, s[8:11], s22 offen
si_162:
  s_and_b32 s21, s52, 7
  s_cmp_lg_u32 s21, s50
  s_cbranch_scc1 zm_163
  s_mov_b64 exec, s[70:71]
  buffer_store_dwordx4 v[156:159], v13, s[4:7], s83 offen sc1
zm_163:
  s_mov_b64 exec, -1
  s_branch bw_156
bw_158:
bw_156:
  s_lshr_b32 s21, 4, s20
  s_bitcmp1_b32 s21, 0
  s_cbranch_scc0 bw_165
  s_mov_b64 exec, s[62:63]
  buffer_store_dwordx4 v[212:215], v21, s[24:27], s85 offen sc1
  buffer_store_dwordx2 v[216:217], v23, s[24:27], s85 offen sc1
  s_mov_b64 exec, -1
  s_branch bw_164
bw_165:
bw_164:
  v_mov_b32 v200, v196
  v_mov_b32 v201, v197
  v_mov_b32 v202, v198
  v_mov_b32 v203, v199
  v_permlane32_swap_b32 v188, v192
  v_permlane32_swap_b32 v189, v193
  v_permlane32_swap_b32 v190, v194
  v_permlane32_swap_b32 v191, v195
  v_permlane32_swap_b32 v196, v200
  v_permlane32_swap_b32 v197, v201
  v_permlane32_swap_b32 v198, v202
  v_permlane32_swap_b32 v199, v203
  v_pk_add_f32 v[188:189], v[188:189], v[192:193]
  v_pk_add_f32 v[190:191], v[190:191], v[194:195]
  v_pk_add_f32 v[196:197], v[196:197], v[200:201]
  v_pk_add_f32 v[198:199], v[198:199], v[202:203]
  v_cvt_pk_bf16_f32 v252, v188, v189
  v_cvt_pk_bf16_f32 v254, v196, v197
  v_cvt_pk_bf16_f32 v253, v190, v191
  v_cvt_pk_bf16_f32 v255, v198, v199
  s_nop 0
  v_permlane16_swap_b32 v252, v254
  v_permlane16_swap_b32 v253, v255
  v_min_u32 v252, -2, v252
  s_mov_b64 exec, s[76:77]
  buffer_store_dwordx4 v[252:255], v15, s[24:27], s57 offen sc1
  s_mov_b64 exec, -1
  s_add_u32 s64, s64, 1310720
  s_add_u32 s52, s52, 1
  s_and_b32 s21, s52, 3
  s_mul_i32 s81, s21, 540672
  s_lshl_b32 s84, s21, 15
  s_branch step_114
fl_118:
  buffer_load_dword v94, v95, s[12:15], s79 offen sc1
  s_branch fl_119
A1_19:
  v_smfmac_f32_16x16x32_f16 v[52:55], v[40:41], a[16:19], v44
  v_smfmac_f32_16x16x32_f16 v[64:67], v[40:41], a[76:79], v44
  v_smfmac_f32_16x16x32_f16 v[56:59], v[40:41], a[36:39], v44
  v_smfmac_f32_16x16x32_f16 v[68:71], v[40:41], a[96:99], v44
  s_branch A2_123
pm_124:
  buffer_load_dwordx4 v[40:43], v4, s[4:7], s84 offen offset:2048 sc1
  buffer_load_dwordx4 v[32:35], v4, s[4:7], s84 offen offset:0 sc1
  buffer_load_dwordx4 v[36:39], v4, s[4:7], s84 offen offset:1024 sc1
  s_nop 7
  v_mov_b32 v52, 0
  v_mov_b32 v53, 0
  v_mov_b32 v54, 0
  v_mov_b32 v55, 0
  v_mov_b32 v64, 0
  v_mov_b32 v65, 0
  v_mov_b32 v66, 0
  v_mov_b32 v67, 0
  v_mov_b32 v56, 0
  v_mov_b32 v57, 0
  v_mov_b32 v58, 0
  v_mov_b32 v59, 0
  v_mov_b32 v68, 0
  v_mov_b32 v69, 0
  v_mov_b32 v70, 0
  v_mov_b32 v71, 0
  s_waitcnt vmcnt(0)
  v_bitop3_b32 v27, v35, v39, v43 bitop3:0x80
  v_perm_b32 v35, v39, v35, s89
  v_cmp_gt_u32 vcc, 0x48000000, v27
  v_mov_b32 v39, v42
  s_cbranch_vccz A1_19
pm_116:
  s_cmp_gt_u32 s52, 3
  s_cbranch_scc1 op_166
  v_readfirstlane_b32 s21, v94
  s_cmp_ge_u32 s21, s46
  s_cbranch_scc1 op_166
  buffer_load_dword v94, v95, s[12:15], s79 offen sc1
  s_waitcnt vmcnt(0)
  v_readfirstlane_b32 s21, v94
  s_add_u32 s22, s46, 3
  s_min_u32 s22, s22, 64
  s_sub_u32 s55, s21, s22
  s_sub_u32 s56, s21, s46
  s_cmp_gt_u32 s21, s52
  s_cselect_b32 s21, s87, 0
  s_cmp_eq_u32 s21, 0
  s_cbranch_scc1 op_166
  s_mov_b32 s87, 0
  s_sub_u32 s21, s64, 1310720
  buffer_load_dwordx4 v[176:179], v16, s[28:31], s21 offen offset:0 sc1
  buffer_load_dwordx4 v[180:183], v16, s[28:31], s21 offen offset:1024 sc1
  buffer_load_dwordx4 v[184:187], v16, s[28:31], s21 offen offset:2048 sc1
op_166:
  buffer_load_dwordx4 v[40:43], v4, s[4:7], s84 offen offset:2048 sc1
  buffer_load_dwordx4 v[32:35], v4, s[4:7], s84 offen offset:0 sc1
  buffer_load_dwordx4 v[36:39], v4, s[4:7], s84 offen offset:1024 sc1
  s_add_u32 s54, s54, 1
  s_cmp_gt_u32 s54, 131072
  s_cbranch_scc1 end0
  s_waitcnt vmcnt(0)
  v_bitop3_b32 v27, v35, v39, v43 bitop3:0x80
  v_perm_b32 v35, v39, v35, s89
  v_cmp_gt_u32 vcc, 0x48000000, v27
  v_mov_b32 v39, v42
  s_cbranch_vccnz pm_116
  s_branch A1_19
psr_138:
  buffer_load_dwordx2 v[248:249], v9, s[8:11], s81 offen sc1
  buffer_load_dwordx4 v[112:115], v8, s[8:11], s81 offen offset:0 sc1
  buffer_load_dwordx4 v[116:119], v8, s[8:11], s81 offen offset:1024 sc1
  s_add_u32 s54, s54, 1
  s_cmp_gt_u32 s54, 131072
  s_cbranch_scc1 end0
  s_waitcnt vmcnt(2)
  v_xor_b32 v96, s88, v248
  s_nop 0
  v_permlane16_swap_b32 v248, v249
  v_fma_mix_f32 v250, v248, 1.0, v249 op_sel:[0,0,0] op_sel_hi:[1,0,1]
  v_fma_mix_f32 v251, v248, 1.0, v249 op_sel:[1,0,1] op_sel_hi:[1,0,1]
  v_mov_b32 v248, v250
  v_mov_b32 v249, v251
  s_nop 0
  v_permlane32_swap_b32 v248, v250
  v_permlane32_swap_b32 v249, v251
  v_pk_add_f32 v[124:125], v[248:249], v[250:251]
  v_max_f32 v238, v124, v125
  s_waitcnt vmcnt(0)
  v_pk_add_f16 v100, v112, v116
  v_pk_add_f16 v102, v114, v118
  v_pk_add_f16 v101, v113, v117
  v_pk_add_f16 v103, v115, v119
  v_permlane32_swap_b32 v100, v102
  v_bitop3_b32 v97, v112, v114, s88 bitop3:0x7e
  v_permlane32_swap_b32 v101, v103
  v_bitop3_b32 v98, v116, v118, s88 bitop3:0x7e
  v_fma_mix_f32 v120, v100, 1.0, v102 op_sel:[0,0,0] op_sel_hi:[1,0,1]
  v_or3_b32 v27, v96, v97, v98
  v_fma_mix_f32 v121, v100, 1.0, v102 op_sel:[1,0,1] op_sel_hi:[1,0,1]
  v_and_b32 v27, 1, v27
  v_fma_mix_f32 v122, v101, 1.0, v103 op_sel:[0,0,0] op_sel_hi:[1,0,1]
  v_cmp_ne_u32 vcc, 0, v27
  v_fma_mix_f32 v123, v101, 1.0, v103 op_sel:[1,0,1] op_sel_hi:[1,0,1]
  v_max3_f32 v236, v120, v121, v238
  s_cbranch_vccnz psr_138
  s_branch psj_139
kvw_140:
  s_mov_b32 s22, s87
  s_cmp_eq_u32 s52, 0
  s_cselect_b32 s23, s87, s46
  s_cselect_b32 s55, 0, s55
  s_cselect_b32 s87, 1, 0
  s_cmp_eq_u32 s23, 0
  s_cbranch_scc1 kvok_141
  v_mov_b32 v236, 0
  s_mov_b32 s101, 0
wf_167:
  buffer_load_dword v237, v236, s[12:15], s79 offen sc1
  s_add_u32 s101, s101, 1
  s_cmp_gt_u32 s101, 131072
  s_cbranch_scc1 end0
  s_waitcnt vmcnt(0)
  v_readfirstlane_b32 s100, v237
  s_cmp_ge_u32 s100, s23
  s_cbranch_scc1 wf_168
  s_sleep 3
  s_branch wf_167
wf_168:
  s_cmp_eq_u32 s22, 0
  s_cbranch_scc1 kvok_141
  s_sub_u32 s21, s64, 1310720
  buffer_load_dwordx4 v[176:179], v16, s[28:31], s21 offen offset:0 sc1
  buffer_load_dwordx4 v[180:183], v16, s[28:31], s21 offen offset:1024 sc1
  buffer_load_dwordx4 v[184:187], v16, s[28:31], s21 offen offset:2048 sc1
  s_waitcnt vmcnt(0)
  s_branch kvok_141
fl_154:
  buffer_load_dword v94, v95, s[12:15], s79 offen sc1
  s_branch fl_155
last_115:
  s_lshr_b32 s21, 4, s20
  s_bitcmp1_b32 s21, 0
  s_cbranch_scc0 bw_170
  s_mov_b64 exec, s[62:63]
  buffer_store_dwordx4 v[212:215], v21, s[24:27], s85 offen sc1
  buffer_store_dwordx2 v[216:217], v23, s[24:27], s85 offen sc1
  s_mov_b64 exec, -1
  s_branch bw_169
bw_170:
bw_169:
  v_mov_b32 v188, 0
  v_mov_b32 v189, 0
  v_mov_b32 v190, 0
  v_mov_b32 v191, 0
  v_mov_b32 v192, 0
  v_mov_b32 v193, 0
  v_mov_b32 v194, 0
  v_mov_b32 v195, 0
  v_mov_b32 v196, 0
  v_mov_b32 v197, 0
  v_mov_b32 v198, 0
  v_mov_b32 v199, 0
  s_sleep 4
  s_mov_b32 s54, 0
lv_171:
  buffer_load_dwordx4 v[144:147], v10, s[8:11], s81 offen offset:0 sc1
  buffer_load_dwordx4 v[148:151], v10, s[8:11], s81 offen offset:1024 sc1
  buffer_load_dwordx4 v[152:155], v10, s[8:11], s81 offen offset:2048 sc1
  s_add_u32 s54, s54, 1
  s_cmp_gt_u32 s54, 131072
  s_cbranch_scc1 end0
  s_waitcnt vmcnt(0)
  v_max3_u32 v27, v144, v146, v148
  v_max3_u32 v27, v27, v150, v152
  v_max3_u32 v27, v27, v154, v154
  v_cmp_eq_u32 vcc, -1, v27
  s_nop 1
  s_cbranch_vccnz lv_171
  v_smfmac_f32_16x16x64_bf16 v[188:191], v[144:147], a[180:187], v44
  v_smfmac_f32_16x16x64_bf16 v[192:195], v[144:147], a[204:211], v44
  v_smfmac_f32_16x16x64_bf16 v[196:199], v[144:147], a[228:235], v44
  v_smfmac_f32_16x16x64_bf16 v[188:191], v[148:151], a[188:195], v44
  v_smfmac_f32_16x16x64_bf16 v[192:195], v[148:151], a[212:219], v44
  v_smfmac_f32_16x16x64_bf16 v[196:199], v[148:151], a[236:243], v44
  v_smfmac_f32_16x16x64_bf16 v[188:191], v[152:155], a[196:203], v44
  v_smfmac_f32_16x16x64_bf16 v[192:195], v[152:155], a[220:227], v44
  v_smfmac_f32_16x16x64_bf16 v[196:199], v[152:155], a[244:251], v44
  s_nop 7
  v_mov_b32 v200, v196
  v_mov_b32 v201, v197
  v_mov_b32 v202, v198
  v_mov_b32 v203, v199
  v_permlane32_swap_b32 v188, v192
  v_permlane32_swap_b32 v189, v193
  v_permlane32_swap_b32 v190, v194
  v_permlane32_swap_b32 v191, v195
  v_permlane32_swap_b32 v196, v200
  v_permlane32_swap_b32 v197, v201
  v_permlane32_swap_b32 v198, v202
  v_permlane32_swap_b32 v199, v203
  v_pk_add_f32 v[188:189], v[188:189], v[192:193]
  v_pk_add_f32 v[190:191], v[190:191], v[194:195]
  v_pk_add_f32 v[196:197], v[196:197], v[200:201]
  v_pk_add_f32 v[198:199], v[198:199], v[202:203]
  v_cvt_pk_bf16_f32 v252, v188, v189
  v_cvt_pk_bf16_f32 v254, v196, v197
  v_cvt_pk_bf16_f32 v253, v190, v191
  v_cvt_pk_bf16_f32 v255, v198, v199
  s_nop 0
  v_permlane16_swap_b32 v252, v254
  v_permlane16_swap_b32 v253, v255
  v_min_u32 v252, -2, v252
  s_mov_b64 exec, s[76:77]
  buffer_store_dwordx4 v[252:255], v15, s[24:27], s57 offen sc1
  s_mov_b64 exec, -1
  s_lshr_b32 s21, 1, s20
  s_bitcmp1_b32 s21, 0
  s_cbranch_scc0 bw_173
  v_mov_b32 v246, 80
  v_mov_b32 v247, 1
  s_mov_b64 exec, 1
  buffer_atomic_add v247, v246, s[32:35], 0 offen sc0 sc1
  s_mov_b64 exec, -1
clm_174:
  s_branch bw_172
bw_173:
bw_172:
  s_branch chain_done
chain_done:
  s_waitcnt vmcnt(0) lgkmcnt(0)
  s_barrier
  s_mov_b32 s84, 0
  s_mov_b32 s85, -1
  s_mov_b32 s86, 0
  v_mov_b32 v21, 0
  v_mov_b32 v23, v247
  s_cmp_lg_u32 s20, 0
  s_cbranch_scc1 queue_b
  s_mov_b64 exec, 1
  s_branch queue_a
end0:
  s_endpgm
gemm_side:
  s_bfe_u32 s23, s22, 0x20005
  s_add_u32 s22, s22, 31
  s_and_b32 s22, s22, 31
  s_lshl_b32 s21, s23, 3
  s_add_u32 s2, s21, s22
  s_add_u32 s3, s2, 72
  s_add_u32 s24, s2, 48
  s_add_u32 s2, s2, s21
  s_cmp_lt_u32 s22, 24
  s_cselect_b32 s3, s24, s3
  s_cmp_lt_u32 s22, 16
  s_cselect_b32 s3, s2, s3
  s_mov_b32 s2, s3
  s_cmp_ge_u32 s3, 64
  s_cbranch_scc1 not_kv
  s_load_dwordx2 s[4:5], s[0:1], 0
  s_load_dwordx2 s[6:7], s[0:1], 24
  s_load_dwordx2 s[36:37], s[0:1], 32
  s_load_dwordx2 s[38:39], s[0:1], 104
  s_and_b32 s43, s3, 1
  s_bfe_u32 s42, s3, 0x50001
  s_lshr_b32 s40, s42, 2
  s_waitcnt lgkmcnt(0)
  s_cmp_eq_u32 s43, 1
  s_cselect_b32 s6, s36, s6
  s_cselect_b32 s7, s37, s7
  s_mov_b32 s8, s4
  s_mov_b32 s9, s5
  s_mov_b32 s10, 2621440
  s_mov_b32 s11, 0x00020000
  s_mov_b32 s12, s6
  s_mov_b32 s13, s7
  s_mov_b32 s14, 7864320
  s_mov_b32 s15, 0x00020000
  s_mov_b32 s16, s38
  s_mov_b32 s17, s39
  s_mov_b32 s18, 50331648
  s_mov_b32 s19, 0x00020000
  s_mul_i32 s44, s42, 384
  s_mov_b32 s62, 1024
  s_mov_b32 s24, 0
  s_mov_b32 s25, 81920
  s_mov_b32 s64, s32
  s_mov_b32 s65, s33
  s_mov_b32 s66, s34
  s_mov_b32 s67, s35
  s_load_dwordx2 s[72:73], s[0:1], 104
  s_waitcnt lgkmcnt(0)
  s_add_u32 s72, s72, 81068032
  s_addc_u32 s73, s73, 0
  s_mov_b32 s74, 116736
  s_mov_b32 s75, 0x00020000
  v_mov_b32 v9, 2731
  v_add_u32 v8, 0, v1
  v_mul_u32_u24 v7, v8, v9
  v_lshrrev_b32 v7, 16, v7
  v_mul_u32_u24 v4, 24, v7
  v_sub_u32 v8, v8, v4
  v_and_b32 v4, 2, v7
  v_xor_b32 v8, v8, v4
  v_xor_b32 v5, 4, v8
  s_mov_b32 s21, 12288
  v_mul_lo_u32 v7, v7, s21
  v_lshl_add_u32 v40, v8, 4, v7
  v_lshl_add_u32 v43, v5, 4, v7
  v_add_u32 v8, 64, v1
  v_mul_u32_u24 v7, v8, v9
  v_lshrrev_b32 v7, 16, v7
  v_mul_u32_u24 v4, 24, v7
  v_sub_u32 v8, v8, v4
  v_and_b32 v4, 2, v7
  v_xor_b32 v8, v8, v4
  v_xor_b32 v5, 4, v8
  s_mov_b32 s21, 12288
  v_mul_lo_u32 v7, v7, s21
  v_lshl_add_u32 v41, v8, 4, v7
  v_lshl_add_u32 v44, v5, 4, v7
  v_add_u32 v8, 128, v1
  v_mul_u32_u24 v7, v8, v9
  v_lshrrev_b32 v7, 16, v7
  v_mul_u32_u24 v4, 24, v7
  v_sub_u32 v8, v8, v4
  v_and_b32 v4, 2, v7
  v_xor_b32 v8, v8, v4
  v_xor_b32 v5, 4, v8
  s_mov_b32 s21, 12288
  v_mul_lo_u32 v7, v7, s21
  v_lshl_add_u32 v42, v8, 4, v7
  v_lshl_add_u32 v45, v5, 4, v7
  s_mul_i32 s21, s20, 393216
  s_add_u32 s21, s21, 0
  s_add_u32 s21, s21, s44
  s_mul_i32 s22, s20, 12288
  s_add_u32 s22, s22, 0
  s_add_u32 m0, s22, 0
  s_nop 0
  buffer_load_dwordx4 v40, s[12:15], s21 offen lds
  s_add_u32 m0, s22, 1024
  s_nop 0
  buffer_load_dwordx4 v41, s[12:15], s21 offen lds
  s_add_u32 m0, s22, 2048
  s_nop 0
  buffer_load_dwordx4 v42, s[12:15], s21 offen lds
  s_mul_i32 s21, s20, 393216
  s_add_u32 s21, s21, 98304
  s_add_u32 s21, s21, s44
  s_mul_i32 s22, s20, 12288
  s_add_u32 s22, s22, 3072
  s_add_u32 m0, s22, 0
  s_nop 0
  buffer_load_dwordx4 v43, s[12:15], s21 offen lds
  s_add_u32 m0, s22, 1024
  s_nop 0
  buffer_load_dwordx4 v44, s[12:15], s21 offen lds
  s_add_u32 m0, s22, 2048
  s_nop 0
  buffer_load_dwordx4 v45, s[12:15], s21 offen lds
  s_mul_i32 s21, s20, 393216
  s_add_u32 s21, s21, 196608
  s_add_u32 s21, s21, s44
  s_mul_i32 s22, s20, 12288
  s_add_u32 s22, s22, 6144
  s_add_u32 m0, s22, 0
  s_nop 0
  buffer_load_dwordx4 v40, s[12:15], s21 offen lds
  s_add_u32 m0, s22, 1024
  s_nop 0
  buffer_load_dwordx4 v41, s[12:15], s21 offen lds
  s_add_u32 m0, s22, 2048
  s_nop 0
  buffer_load_dwordx4 v42, s[12:15], s21 offen lds
  s_mul_i32 s21, s20, 393216
  s_add_u32 s21, s21, 294912
  s_add_u32 s21, s21, s44
  s_mul_i32 s22, s20, 12288
  s_add_u32 s22, s22, 9216
  s_add_u32 m0, s22, 0
  s_nop 0
  buffer_load_dwordx4 v43, s[12:15], s21 offen lds
  s_add_u32 m0, s22, 1024
  s_nop 0
  buffer_load_dwordx4 v44, s[12:15], s21 offen lds
  s_add_u32 m0, s22, 2048
  s_nop 0
  buffer_load_dwordx4 v45, s[12:15], s21 offen lds
  v_lshrrev_b32 v11, 3, v1
  v_and_b32 v12, 7, v1
  v_xor_b32 v12, v12, v11
  v_mul_u32_u24 v11, 1280, v11
  v_lshl_add_u32 v10, v12, 4, v11
  s_mul_i32 s46, s20, 20480
  v_add_u32 v10, s46, v10
  s_lshl_b32 s47, s20, 11
  s_add_u32 s47, s47, 98304
  s_add_u32 s46, s47, 57344
  s_mov_b32 s30, s24
  s_add_u32 s32, s47, 0
  v_add_u32 v11, 9216, v10
  s_mov_b32 m0, s32
  s_nop 0
  buffer_load_dwordx4 v10, s[8:11], s30 offen offset:0 lds
  buffer_load_dwordx4 v11, s[8:11], s30 offen offset:1024 lds
  s_add_u32 s30, s30, 128
  s_add_u32 s32, s32, 8192
  s_cmp_lt_u32 s32, s46
  s_cselect_b32 s32, s32, s47
  s_mov_b32 m0, s32
  s_nop 0
  buffer_load_dwordx4 v10, s[8:11], s30 offen offset:0 lds
  buffer_load_dwordx4 v11, s[8:11], s30 offen offset:1024 lds
  s_add_u32 s30, s30, 128
  s_add_u32 s32, s32, 8192
  s_cmp_lt_u32 s32, s46
  s_cselect_b32 s32, s32, s47
  s_mov_b32 m0, s32
  s_nop 0
  buffer_load_dwordx4 v10, s[8:11], s30 offen offset:0 lds
  buffer_load_dwordx4 v11, s[8:11], s30 offen offset:1024 lds
  s_add_u32 s30, s30, 128
  s_add_u32 s32, s32, 8192
  s_cmp_lt_u32 s32, s46
  s_cselect_b32 s32, s32, s47
  s_mov_b32 m0, s32
  s_nop 0
  buffer_load_dwordx4 v10, s[8:11], s30 offen offset:0 lds
  buffer_load_dwordx4 v11, s[8:11], s30 offen offset:1024 lds
  s_add_u32 s30, s30, 128
  s_add_u32 s32, s32, 8192
  s_cmp_lt_u32 s32, s46
  s_cselect_b32 s32, s32, s47
  s_mov_b32 m0, s32
  s_nop 0
  buffer_load_dwordx4 v10, s[8:11], s30 offen offset:0 lds
  buffer_load_dwordx4 v11, s[8:11], s30 offen offset:1024 lds
  s_add_u32 s30, s30, 128
  s_add_u32 s32, s32, 8192
  s_cmp_lt_u32 s32, s46
  s_cselect_b32 s32, s32, s47
  s_mul_i32 s21, s20, 393216
  s_add_u32 s21, s21, 1572864
  s_add_u32 s21, s21, s44
  s_mul_i32 s22, s20, 12288
  s_add_u32 s22, s22, 49152
  s_add_u32 m0, s22, 0
  s_nop 0
  buffer_load_dwordx4 v40, s[12:15], s21 offen lds
  s_add_u32 m0, s22, 1024
  s_nop 0
  buffer_load_dwordx4 v41, s[12:15], s21 offen lds
  s_add_u32 m0, s22, 2048
  s_nop 0
  buffer_load_dwordx4 v42, s[12:15], s21 offen lds
  s_mul_i32 s21, s20, 393216
  s_add_u32 s21, s21, 1671168
  s_add_u32 s21, s21, s44
  s_mul_i32 s22, s20, 12288
  s_add_u32 s22, s22, 52224
  s_add_u32 m0, s22, 0
  s_nop 0
  buffer_load_dwordx4 v43, s[12:15], s21 offen lds
  s_add_u32 m0, s22, 1024
  s_nop 0
  buffer_load_dwordx4 v44, s[12:15], s21 offen lds
  s_add_u32 m0, s22, 2048
  s_nop 0
  buffer_load_dwordx4 v45, s[12:15], s21 offen lds
  s_mul_i32 s21, s20, 393216
  s_add_u32 s21, s21, 1769472
  s_add_u32 s21, s21, s44
  s_mul_i32 s22, s20, 12288
  s_add_u32 s22, s22, 55296
  s_add_u32 m0, s22, 0
  s_nop 0
  buffer_load_dwordx4 v40, s[12:15], s21 offen lds
  s_add_u32 m0, s22, 1024
  s_nop 0
  buffer_load_dwordx4 v41, s[12:15], s21 offen lds
  s_add_u32 m0, s22, 2048
  s_nop 0
  buffer_load_dwordx4 v42, s[12:15], s21 offen lds
  s_mul_i32 s21, s20, 393216
  s_add_u32 s21, s21, 1867776
  s_add_u32 s21, s21, s44
  s_mul_i32 s22, s20, 12288
  s_add_u32 s22, s22, 58368
  s_add_u32 m0, s22, 0
  s_nop 0
  buffer_load_dwordx4 v43, s[12:15], s21 offen lds
  s_add_u32 m0, s22, 1024
  s_nop 0
  buffer_load_dwordx4 v44, s[12:15], s21 offen lds
  s_add_u32 m0, s22, 2048
  s_nop 0
  buffer_load_dwordx4 v45, s[12:15], s21 offen lds
  v_lshrrev_b32 v7, 2, v2
  v_and_b32 v4, 2, v7
  v_and_b32 v5, 1, v3
  v_lshl_or_b32 v4, v5, 2, v4
  v_lshl_add_u32 v7, v3, 3, v7
  v_mul_u32_u24 v7, 384, v7
  v_and_b32 v5, 1, v2
  v_lshl_add_u32 v7, v5, 3, v7
  v_bfe_u32 v8, v2, 1, 1
  s_mul_i32 s21, s20, 6
  v_add_u32 v8, s21, v8
  v_add_u32 v5, 0, v8
  v_xor_b32 v5, v5, v4
  v_lshl_add_u32 v46, v5, 4, v7
  v_add_u32 v49, 49152, v46
  v_add_u32 v5, 2, v8
  v_xor_b32 v5, v5, v4
  v_lshl_add_u32 v47, v5, 4, v7
  v_add_u32 v50, 49152, v47
  v_add_u32 v5, 4, v8
  v_xor_b32 v5, v5, v4
  v_lshl_add_u32 v48, v5, 4, v7
  v_add_u32 v51, 49152, v48
  s_mov_b32 s26, 6
  s_mul_i32 s27, s42, 12288
  s_mul_i32 s21, s43, 25165824
  s_add_u32 s27, s27, s21
  s_mov_b32 s28, 786432
  s_lshl_b32 s60, s40, 7
  s_add_u32 s60, s60, 0
  s_mov_b32 s61, 0
  v_and_b32 v6, 7, v2
  v_add_u32 v4, 0, v3
  v_xor_b32 v4, v4, v6
  v_lshlrev_b32 v4, 4, v4
  v_lshl_add_u32 v14, v2, 7, v4
  v_add_u32 v4, 4, v3
  v_xor_b32 v4, v4, v6
  v_lshlrev_b32 v4, 4, v4
  v_lshl_add_u32 v15, v2, 7, v4
  v_mul_u32_u24 v22, 400, v2
  v_mul_u32_u24 v4, 16, v3
  s_mul_i32 s21, s20, 96
  s_add_u32 s21, s21, 0
  v_add3_u32 v22, v22, v4, s21
  v_lshlrev_b32 v4, 3, v3
  v_sub_u32 v16, v22, v4
  v_mov_b32 v9, 2731
  s_mul_i32 s21, s20, 6400
  s_add_u32 s21, s21, 0
  v_mul_u32_u24 v4, 400, v2
  v_lshlrev_b32 v5, 4, v3
  v_add3_u32 v23, v4, v5, s21
  v_lshlrev_b32 v26, 4, v1
  s_mov_b32 s33, 98304
  s_mov_b32 s48, 0x80000000
  s_mov_b32 m0, s32
  s_nop 0
  buffer_load_dwordx4 v10, s[8:11], s30 offen offset:0 lds
  s_waitcnt vmcnt(21)
  s_barrier
  v_add_u32 v18, s33, v14
  v_add_u32 v19, s33, v15
  s_add_u32 s33, s33, 8192
  s_cmp_lt_u32 s33, 155648
  s_cselect_b32 s33, s33, 98304
  ds_read_b128 v[160:163], v18 offset:0
  ds_read_b128 v[164:167], v18 offset:2048
  ds_read_b128 v[168:171], v18 offset:4096
  ds_read_b128 v[172:175], v18 offset:6144
  s_waitcnt lgkmcnt(0)
  s_waitcnt vmcnt(23)
  s_barrier
  ds_read_b64_tr_b16 a[0:1], v46 offset:0
  ds_read_b64_tr_b16 a[2:3], v46 offset:1536
  ds_read_b64_tr_b16 a[4:5], v47 offset:0
  ds_read_b64_tr_b16 a[6:7], v47 offset:1536
  ds_read_b64_tr_b16 a[8:9], v48 offset:0
  ds_read_b64_tr_b16 a[10:11], v48 offset:1536
  ds_read_b64_tr_b16 a[12:13], v46 offset:12288
  ds_read_b64_tr_b16 a[14:15], v46 offset:13824
  ds_read_b64_tr_b16 a[16:17], v47 offset:12288
  ds_read_b64_tr_b16 a[18:19], v47 offset:13824
  ds_read_b64_tr_b16 a[20:21], v48 offset:12288
  ds_read_b64_tr_b16 a[22:23], v48 offset:13824
  ds_read_b64_tr_b16 a[24:25], v46 offset:24576
  ds_read_b64_tr_b16 a[26:27], v46 offset:26112
  ds_read_b64_tr_b16 a[28:29], v47 offset:24576
  ds_read_b64_tr_b16 a[30:31], v47 offset:26112
  ds_read_b64_tr_b16 a[32:33], v48 offset:24576
  ds_read_b64_tr_b16 a[34:35], v48 offset:26112
  ds_read_b64_tr_b16 a[36:37], v46 offset:36864
  ds_read_b64_tr_b16 a[38:39], v46 offset:38400
  ds_read_b64_tr_b16 a[40:41], v47 offset:36864
  ds_read_b64_tr_b16 a[42:43], v47 offset:38400
  ds_read_b64_tr_b16 a[44:45], v48 offset:36864
  ds_read_b64_tr_b16 a[46:47], v48 offset:38400
  s_waitcnt lgkmcnt(0)
  s_barrier
  s_mov_b32 s23, m0
  s_mul_i32 s21, s20, 393216
  s_add_u32 s21, s21, 3145728
  s_add_u32 s21, s21, s44
  s_mul_i32 s22, s20, 12288
  s_add_u32 s22, s22, 0
  s_add_u32 m0, s22, 0
  s_nop 0
  buffer_load_dwordx4 v40, s[12:15], s21 offen lds
  s_add_u32 m0, s22, 1024
  s_nop 0
  buffer_load_dwordx4 v41, s[12:15], s21 offen lds
  s_add_u32 m0, s22, 2048
  s_nop 0
  buffer_load_dwordx4 v42, s[12:15], s21 offen lds
  s_mul_i32 s21, s20, 393216
  s_add_u32 s21, s21, 3244032
  s_add_u32 s21, s21, s44
  s_mul_i32 s22, s20, 12288
  s_add_u32 s22, s22, 3072
  s_add_u32 m0, s22, 0
  s_nop 0
  buffer_load_dwordx4 v43, s[12:15], s21 offen lds
  s_add_u32 m0, s22, 1024
  s_nop 0
  buffer_load_dwordx4 v44, s[12:15], s21 offen lds
  s_add_u32 m0, s22, 2048
  s_nop 0
  buffer_load_dwordx4 v45, s[12:15], s21 offen lds
  s_mul_i32 s21, s20, 393216
  s_add_u32 s21, s21, 3342336
  s_add_u32 s21, s21, s44
  s_mul_i32 s22, s20, 12288
  s_add_u32 s22, s22, 6144
  s_add_u32 m0, s22, 0
  s_nop 0
  buffer_load_dwordx4 v40, s[12:15], s21 offen lds
  s_add_u32 m0, s22, 1024
  s_nop 0
  buffer_load_dwordx4 v41, s[12:15], s21 offen lds
  s_add_u32 m0, s22, 2048
  s_nop 0
  buffer_load_dwordx4 v42, s[12:15], s21 offen lds
  s_mul_i32 s21, s20, 393216
  s_add_u32 s21, s21, 3440640
  s_add_u32 s21, s21, s44
  s_mul_i32 s22, s20, 12288
  s_add_u32 s22, s22, 9216
  s_add_u32 m0, s22, 0
  s_nop 0
  buffer_load_dwordx4 v43, s[12:15], s21 offen lds
  s_add_u32 m0, s22, 1024
  s_nop 0
  buffer_load_dwordx4 v44, s[12:15], s21 offen lds
  s_add_u32 m0, s22, 2048
  s_nop 0
  buffer_load_dwordx4 v45, s[12:15], s21 offen lds
  s_mov_b32 m0, s23
  v_mfma_f32_16x16x32_bf16 v[64:67], a[0:3], v[160:163], 0
  ds_read_b128 v[192:195], v19 offset:0
  v_mfma_f32_16x16x32_bf16 v[68:71], a[4:7], v[160:163], 0
  v_add_u32 v18, s33, v14
  v_mfma_f32_16x16x32_bf16 v[72:75], a[8:11], v[160:163], 0
  v_mfma_f32_16x16x32_bf16 v[76:79], a[0:3], v[164:167], 0
  ds_read_b128 v[196:199], v19 offset:2048
  v_mfma_f32_16x16x32_bf16 v[80:83], a[4:7], v[164:167], 0
  buffer_load_dwordx4 v11, s[8:11], s30 offen offset:1024 lds
  v_mfma_f32_16x16x32_bf16 v[84:87], a[8:11], v[164:167], 0
  s_add_u32 s30, s30, 128
  v_mfma_f32_16x16x32_bf16 v[88:91], a[0:3], v[168:171], 0
  ds_read_b128 v[200:203], v19 offset:4096
  s_add_u32 m0, m0, 8192
  v_mfma_f32_16x16x32_bf16 v[92:95], a[4:7], v[168:171], 0
  s_cmp_lt_u32 m0, s46
  s_cselect_b32 m0, m0, s47
  v_mfma_f32_16x16x32_bf16 v[96:99], a[8:11], v[168:171], 0
  v_mfma_f32_16x16x32_bf16 v[100:103], a[0:3], v[172:175], 0
  ds_read_b128 v[204:207], v19 offset:6144
  v_mfma_f32_16x16x32_bf16 v[104:107], a[4:7], v[172:175], 0
  v_mfma_f32_16x16x32_bf16 v[108:111], a[8:11], v[172:175], 0
  s_waitcnt vmcnt(32) lgkmcnt(2)
  s_barrier
  v_mfma_f32_16x16x32_bf16 v[64:67], a[12:15], v[192:195], v[64:67]
  ds_read_b128 v[160:163], v18 offset:0
  v_mfma_f32_16x16x32_bf16 v[68:71], a[16:19], v[192:195], v[68:71]
  v_mfma_f32_16x16x32_bf16 v[72:75], a[20:23], v[192:195], v[72:75]
  v_add_u32 v19, s33, v15
  s_add_u32 s33, s33, 8192
  v_mfma_f32_16x16x32_bf16 v[76:79], a[12:15], v[196:199], v[76:79]
  ds_read_b128 v[164:167], v18 offset:2048
  v_mfma_f32_16x16x32_bf16 v[80:83], a[16:19], v[196:199], v[80:83]
  buffer_load_dwordx4 v10, s[8:11], s30 offen offset:0 lds
  v_mfma_f32_16x16x32_bf16 v[84:87], a[20:23], v[196:199], v[84:87]
  s_waitcnt lgkmcnt(2)
  v_mfma_f32_16x16x32_bf16 v[88:91], a[12:15], v[200:203], v[88:91]
  ds_read_b128 v[168:171], v18 offset:4096
  v_mfma_f32_16x16x32_bf16 v[92:95], a[16:19], v[200:203], v[92:95]
  s_cmp_lt_u32 s33, 155648
  s_cselect_b32 s33, s33, 98304
  v_mfma_f32_16x16x32_bf16 v[96:99], a[20:23], v[200:203], v[96:99]
  v_mfma_f32_16x16x32_bf16 v[100:103], a[12:15], v[204:207], v[100:103]
  ds_read_b128 v[172:175], v18 offset:6144
  v_mfma_f32_16x16x32_bf16 v[104:107], a[16:19], v[204:207], v[104:107]
  v_mfma_f32_16x16x32_bf16 v[108:111], a[20:23], v[204:207], v[108:111]
  s_waitcnt lgkmcnt(2)
  v_mfma_f32_16x16x32_bf16 v[64:67], a[24:27], v[160:163], v[64:67]
  ds_read_b128 v[192:195], v19 offset:0
  v_mfma_f32_16x16x32_bf16 v[68:71], a[28:31], v[160:163], v[68:71]
  v_add_u32 v18, s33, v14
  v_mfma_f32_16x16x32_bf16 v[72:75], a[32:35], v[160:163], v[72:75]
  v_mfma_f32_16x16x32_bf16 v[76:79], a[24:27], v[164:167], v[76:79]
  ds_read_b128 v[196:199], v19 offset:2048
  v_mfma_f32_16x16x32_bf16 v[80:83], a[28:31], v[164:167], v[80:83]
  buffer_load_dwordx4 v11, s[8:11], s30 offen offset:1024 lds
  v_mfma_f32_16x16x32_bf16 v[84:87], a[32:35], v[164:167], v[84:87]
  s_waitcnt lgkmcnt(2)
  s_add_u32 s30, s30, 128
  v_mfma_f32_16x16x32_bf16 v[88:91], a[24:27], v[168:171], v[88:91]
  ds_read_b128 v[200:203], v19 offset:4096
  s_add_u32 m0, m0, 8192
  v_mfma_f32_16x16x32_bf16 v[92:95], a[28:31], v[168:171], v[92:95]
  s_cmp_lt_u32 m0, s46
  s_cselect_b32 m0, m0, s47
  v_mfma_f32_16x16x32_bf16 v[96:99], a[32:35], v[168:171], v[96:99]
  v_mfma_f32_16x16x32_bf16 v[100:103], a[24:27], v[172:175], v[100:103]
  ds_read_b128 v[204:207], v19 offset:6144
  v_mfma_f32_16x16x32_bf16 v[104:107], a[28:31], v[172:175], v[104:107]
  v_mfma_f32_16x16x32_bf16 v[108:111], a[32:35], v[172:175], v[108:111]
  s_waitcnt vmcnt(32) lgkmcnt(2)
  s_barrier
  v_mfma_f32_16x16x32_bf16 v[64:67], a[36:39], v[192:195], v[64:67]
  ds_read_b128 v[160:163], v18 offset:0
  v_mfma_f32_16x16x32_bf16 v[68:71], a[40:43], v[192:195], v[68:71]
  v_mfma_f32_16x16x32_bf16 v[72:75], a[44:47], v[192:195], v[72:75]
  v_add_u32 v19, s33, v15
  s_add_u32 s33, s33, 8192
  v_mfma_f32_16x16x32_bf16 v[76:79], a[36:39], v[196:199], v[76:79]
  ds_read_b128 v[164:167], v18 offset:2048
  v_mfma_f32_16x16x32_bf16 v[80:83], a[40:43], v[196:199], v[80:83]
  buffer_load_dwordx4 v10, s[8:11], s30 offen offset:0 lds
  v_mfma_f32_16x16x32_bf16 v[84:87], a[44:47], v[196:199], v[84:87]
  s_waitcnt lgkmcnt(2)
  v_mfma_f32_16x16x32_bf16 v[88:91], a[36:39], v[200:203], v[88:91]
  ds_read_b128 v[168:171], v18 offset:4096
  v_mfma_f32_16x16x32_bf16 v[92:95], a[40:43], v[200:203], v[92:95]
  s_cmp_lt_u32 s33, 155648
  s_cselect_b32 s33, s33, 98304
  v_mfma_f32_16x16x32_bf16 v[96:99], a[44:47], v[200:203], v[96:99]
  v_mfma_f32_16x16x32_bf16 v[100:103], a[36:39], v[204:207], v[100:103]
  ds_read_b128 v[172:175], v18 offset:6144
  v_mfma_f32_16x16x32_bf16 v[104:107], a[40:43], v[204:207], v[104:107]
  v_mfma_f32_16x16x32_bf16 v[108:111], a[44:47], v[204:207], v[108:111]
  s_waitcnt lgkmcnt(2)
  s_waitcnt vmcnt(17)
  s_barrier
  ds_read_b64_tr_b16 a[48:49], v49 offset:0
  ds_read_b64_tr_b16 a[50:51], v49 offset:1536
  ds_read_b64_tr_b16 a[52:53], v50 offset:0
  ds_read_b64_tr_b16 a[54:55], v50 offset:1536
  ds_read_b64_tr_b16 a[56:57], v51 offset:0
  ds_read_b64_tr_b16 a[58:59], v51 offset:1536
  ds_read_b64_tr_b16 a[60:61], v49 offset:12288
  ds_read_b64_tr_b16 a[62:63], v49 offset:13824
  ds_read_b64_tr_b16 a[64:65], v50 offset:12288
  ds_read_b64_tr_b16 a[66:67], v50 offset:13824
  ds_read_b64_tr_b16 a[68:69], v51 offset:12288
  ds_read_b64_tr_b16 a[70:71], v51 offset:13824
  ds_read_b64_tr_b16 a[72:73], v49 offset:24576
  ds_read_b64_tr_b16 a[74:75], v49 offset:26112
  ds_read_b64_tr_b16 a[76:77], v50 offset:24576
  ds_read_b64_tr_b16 a[78:79], v50 offset:26112
  ds_read_b64_tr_b16 a[80:81], v51 offset:24576
  ds_read_b64_tr_b16 a[82:83], v51 offset:26112
  ds_read_b64_tr_b16 a[84:85], v49 offset:36864
  ds_read_b64_tr_b16 a[86:87], v49 offset:38400
  ds_read_b64_tr_b16 a[88:89], v50 offset:36864
  ds_read_b64_tr_b16 a[90:91], v50 offset:38400
  ds_read_b64_tr_b16 a[92:93], v51 offset:36864
  ds_read_b64_tr_b16 a[94:95], v51 offset:38400
  s_waitcnt lgkmcnt(0)
  s_barrier
  s_mov_b32 s23, m0
  s_mul_i32 s21, s20, 393216
  s_add_u32 s21, s21, 4718592
  s_add_u32 s21, s21, s44
  s_mul_i32 s22, s20, 12288
  s_add_u32 s22, s22, 49152
  s_add_u32 m0, s22, 0
  s_nop 0
  buffer_load_dwordx4 v40, s[12:15], s21 offen lds
  s_add_u32 m0, s22, 1024
  s_nop 0
  buffer_load_dwordx4 v41, s[12:15], s21 offen lds
  s_add_u32 m0, s22, 2048
  s_nop 0
  buffer_load_dwordx4 v42, s[12:15], s21 offen lds
  s_mul_i32 s21, s20, 393216
  s_add_u32 s21, s21, 4816896
  s_add_u32 s21, s21, s44
  s_mul_i32 s22, s20, 12288
  s_add_u32 s22, s22, 52224
  s_add_u32 m0, s22, 0
  s_nop 0
  buffer_load_dwordx4 v43, s[12:15], s21 offen lds
  s_add_u32 m0, s22, 1024
  s_nop 0
  buffer_load_dwordx4 v44, s[12:15], s21 offen lds
  s_add_u32 m0, s22, 2048
  s_nop 0
  buffer_load_dwordx4 v45, s[12:15], s21 offen lds
  s_mul_i32 s21, s20, 393216
  s_add_u32 s21, s21, 4915200
  s_add_u32 s21, s21, s44
  s_mul_i32 s22, s20, 12288
  s_add_u32 s22, s22, 55296
  s_add_u32 m0, s22, 0
  s_nop 0
  buffer_load_dwordx4 v40, s[12:15], s21 offen lds
  s_add_u32 m0, s22, 1024
  s_nop 0
  buffer_load_dwordx4 v41, s[12:15], s21 offen lds
  s_add_u32 m0, s22, 2048
  s_nop 0
  buffer_load_dwordx4 v42, s[12:15], s21 offen lds
  s_mul_i32 s21, s20, 393216
  s_add_u32 s21, s21, 5013504
  s_add_u32 s21, s21, s44
  s_mul_i32 s22, s20, 12288
  s_add_u32 s22, s22, 58368
  s_add_u32 m0, s22, 0
  s_nop 0
  buffer_load_dwordx4 v43, s[12:15], s21 offen lds
  s_add_u32 m0, s22, 1024
  s_nop 0
  buffer_load_dwordx4 v44, s[12:15], s21 offen lds
  s_add_u32 m0, s22, 2048
  s_nop 0
  buffer_load_dwordx4 v45, s[12:15], s21 offen lds
  s_mov_b32 m0, s23
  v_mfma_f32_16x16x32_bf16 v[64:67], a[48:51], v[160:163], v[64:67]
  ds_read_b128 v[192:195], v19 offset:0
  v_mfma_f32_16x16x32_bf16 v[68:71], a[52:55], v[160:163], v[68:71]
  v_add_u32 v18, s33, v14
  v_mfma_f32_16x16x32_bf16 v[72:75], a[56:59], v[160:163], v[72:75]
  v_mfma_f32_16x16x32_bf16 v[76:79], a[48:51], v[164:167], v[76:79]
  ds_read_b128 v[196:199], v19 offset:2048
  v_mfma_f32_16x16x32_bf16 v[80:83], a[52:55], v[164:167], v[80:83]
  buffer_load_dwordx4 v11, s[8:11], s30 offen offset:1024 lds
  v_mfma_f32_16x16x32_bf16 v[84:87], a[56:59], v[164:167], v[84:87]
  s_add_u32 s30, s30, 128
  v_mfma_f32_16x16x32_bf16 v[88:91], a[48:51], v[168:171], v[88:91]
  ds_read_b128 v[200:203], v19 offset:4096
  s_add_u32 m0, m0, 8192
  v_mfma_f32_16x16x32_bf16 v[92:95], a[52:55], v[168:171], v[92:95]
  s_cmp_lt_u32 m0, s46
  s_cselect_b32 m0, m0, s47
  v_mfma_f32_16x16x32_bf16 v[96:99], a[56:59], v[168:171], v[96:99]
  v_mfma_f32_16x16x32_bf16 v[100:103], a[48:51], v[172:175], v[100:103]
  ds_read_b128 v[204:207], v19 offset:6144
  v_mfma_f32_16x16x32_bf16 v[104:107], a[52:55], v[172:175], v[104:107]
  v_mfma_f32_16x16x32_bf16 v[108:111], a[56:59], v[172:175], v[108:111]
  s_waitcnt vmcnt(44) lgkmcnt(2)
  s_barrier
  v_mfma_f32_16x16x32_bf16 v[64:67], a[60:63], v[192:195], v[64:67]
  ds_read_b128 v[160:163], v18 offset:0
  v_mfma_f32_16x16x32_bf16 v[68:71], a[64:67], v[192:195], v[68:71]
  v_mfma_f32_16x16x32_bf16 v[72:75], a[68:71], v[192:195], v[72:75]
  v_add_u32 v19, s33, v15
  s_add_u32 s33, s33, 8192
  v_mfma_f32_16x16x32_bf16 v[76:79], a[60:63], v[196:199], v[76:79]
  ds_read_b128 v[164:167], v18 offset:2048
  v_mfma_f32_16x16x32_bf16 v[80:83], a[64:67], v[196:199], v[80:83]
  buffer_load_dwordx4 v10, s[8:11], s30 offen offset:0 lds
  v_mfma_f32_16x16x32_bf16 v[84:87], a[68:71], v[196:199], v[84:87]
  s_waitcnt lgkmcnt(2)
  v_mfma_f32_16x16x32_bf16 v[88:91], a[60:63], v[200:203], v[88:91]
  ds_read_b128 v[168:171], v18 offset:4096
  v_mfma_f32_16x16x32_bf16 v[92:95], a[64:67], v[200:203], v[92:95]
  s_cmp_lt_u32 s33, 155648
  s_cselect_b32 s33, s33, 98304
  v_mfma_f32_16x16x32_bf16 v[96:99], a[68:71], v[200:203], v[96:99]
  v_mfma_f32_16x16x32_bf16 v[100:103], a[60:63], v[204:207], v[100:103]
  ds_read_b128 v[172:175], v18 offset:6144
  v_mfma_f32_16x16x32_bf16 v[104:107], a[64:67], v[204:207], v[104:107]
  v_mfma_f32_16x16x32_bf16 v[108:111], a[68:71], v[204:207], v[108:111]
  s_waitcnt lgkmcnt(2)
  v_mfma_f32_16x16x32_bf16 v[64:67], a[72:75], v[160:163], v[64:67]
  ds_read_b128 v[192:195], v19 offset:0
  v_mfma_f32_16x16x32_bf16 v[68:71], a[76:79], v[160:163], v[68:71]
  v_add_u32 v18, s33, v14
  v_mfma_f32_16x16x32_bf16 v[72:75], a[80:83], v[160:163], v[72:75]
  v_mfma_f32_16x16x32_bf16 v[76:79], a[72:75], v[164:167], v[76:79]
  ds_read_b128 v[196:199], v19 offset:2048
  v_mfma_f32_16x16x32_bf16 v[80:83], a[76:79], v[164:167], v[80:83]
  buffer_load_dwordx4 v11, s[8:11], s30 offen offset:1024 lds
  v_mfma_f32_16x16x32_bf16 v[84:87], a[80:83], v[164:167], v[84:87]
  s_waitcnt lgkmcnt(2)
  s_add_u32 s30, s30, 128
  v_mfma_f32_16x16x32_bf16 v[88:91], a[72:75], v[168:171], v[88:91]
  ds_read_b128 v[200:203], v19 offset:4096
  s_add_u32 m0, m0, 8192
  v_mfma_f32_16x16x32_bf16 v[92:95], a[76:79], v[168:171], v[92:95]
  s_cmp_lt_u32 m0, s46
  s_cselect_b32 m0, m0, s47
  v_mfma_f32_16x16x32_bf16 v[96:99], a[80:83], v[168:171], v[96:99]
  v_mfma_f32_16x16x32_bf16 v[100:103], a[72:75], v[172:175], v[100:103]
  ds_read_b128 v[204:207], v19 offset:6144
  v_mfma_f32_16x16x32_bf16 v[104:107], a[76:79], v[172:175], v[104:107]
  v_mfma_f32_16x16x32_bf16 v[108:111], a[80:83], v[172:175], v[108:111]
  s_waitcnt vmcnt(44) lgkmcnt(2)
  s_barrier
  v_mfma_f32_16x16x32_bf16 v[64:67], a[84:87], v[192:195], v[64:67]
  ds_read_b128 v[160:163], v18 offset:0
  v_mfma_f32_16x16x32_bf16 v[68:71], a[88:91], v[192:195], v[68:71]
  v_mfma_f32_16x16x32_bf16 v[72:75], a[92:95], v[192:195], v[72:75]
  v_add_u32 v19, s33, v15
  s_add_u32 s33, s33, 8192
  v_mfma_f32_16x16x32_bf16 v[76:79], a[84:87], v[196:199], v[76:79]
  ds_read_b128 v[164:167], v18 offset:2048
  v_mfma_f32_16x16x32_bf16 v[80:83], a[88:91], v[196:199], v[80:83]
  buffer_load_dwordx4 v10, s[8:11], s30 offen offset:0 lds
  v_mfma_f32_16x16x32_bf16 v[84:87], a[92:95], v[196:199], v[84:87]
  s_waitcnt lgkmcnt(2)
  v_mfma_f32_16x16x32_bf16 v[88:91], a[84:87], v[200:203], v[88:91]
  ds_read_b128 v[168:171], v18 offset:4096
  v_mfma_f32_16x16x32_bf16 v[92:95], a[88:91], v[200:203], v[92:95]
  s_cmp_lt_u32 s33, 155648
  s_cselect_b32 s33, s33, 98304
  v_mfma_f32_16x16x32_bf16 v[96:99], a[92:95], v[200:203], v[96:99]
  v_mfma_f32_16x16x32_bf16 v[100:103], a[84:87], v[204:207], v[100:103]
  ds_read_b128 v[172:175], v18 offset:6144
  v_mfma_f32_16x16x32_bf16 v[104:107], a[88:91], v[204:207], v[104:107]
  v_mfma_f32_16x16x32_bf16 v[108:111], a[92:95], v[204:207], v[108:111]
  s_waitcnt lgkmcnt(2)
  s_waitcnt vmcnt(20)
  s_barrier
  ds_read_b64_tr_b16 a[96:97], v46 offset:0
  ds_read_b64_tr_b16 a[98:99], v46 offset:1536
  ds_read_b64_tr_b16 a[100:101], v47 offset:0
  ds_read_b64_tr_b16 a[102:103], v47 offset:1536
  ds_read_b64_tr_b16 a[104:105], v48 offset:0
  ds_read_b64_tr_b16 a[106:107], v48 offset:1536
  ds_read_b64_tr_b16 a[108:109], v46 offset:12288
  ds_read_b64_tr_b16 a[110:111], v46 offset:13824
  ds_read_b64_tr_b16 a[112:113], v47 offset:12288
  ds_read_b64_tr_b16 a[114:115], v47 offset:13824
  ds_read_b64_tr_b16 a[116:117], v48 offset:12288
  ds_read_b64_tr_b16 a[118:119], v48 offset:13824
  ds_read_b64_tr_b16 a[120:121], v46 offset:24576
  ds_read_b64_tr_b16 a[122:123], v46 offset:26112
  ds_read_b64_tr_b16 a[124:125], v47 offset:24576
  ds_read_b64_tr_b16 a[126:127], v47 offset:26112
  ds_read_b64_tr_b16 a[128:129], v48 offset:24576
  ds_read_b64_tr_b16 a[130:131], v48 offset:26112
  ds_read_b64_tr_b16 a[132:133], v46 offset:36864
  ds_read_b64_tr_b16 a[134:135], v46 offset:38400
  ds_read_b64_tr_b16 a[136:137], v47 offset:36864
  ds_read_b64_tr_b16 a[138:139], v47 offset:38400
  ds_read_b64_tr_b16 a[140:141], v48 offset:36864
  ds_read_b64_tr_b16 a[142:143], v48 offset:38400
  s_waitcnt lgkmcnt(0)
  s_barrier
  s_mov_b32 s23, m0
  s_mul_i32 s21, s20, 393216
  s_add_u32 s21, s21, 6291456
  s_add_u32 s21, s21, s44
  s_mul_i32 s22, s20, 12288
  s_add_u32 s22, s22, 0
  s_add_u32 m0, s22, 0
  s_nop 0
  buffer_load_dwordx4 v40, s[12:15], s21 offen lds
  s_add_u32 m0, s22, 1024
  s_nop 0
  buffer_load_dwordx4 v41, s[12:15], s21 offen lds
  s_add_u32 m0, s22, 2048
  s_nop 0
  buffer_load_dwordx4 v42, s[12:15], s21 offen lds
  s_mul_i32 s21, s20, 393216
  s_add_u32 s21, s21, 6389760
  s_add_u32 s21, s21, s44
  s_mul_i32 s22, s20, 12288
  s_add_u32 s22, s22, 3072
  s_add_u32 m0, s22, 0
  s_nop 0
  buffer_load_dwordx4 v43, s[12:15], s21 offen lds
  s_add_u32 m0, s22, 1024
  s_nop 0
  buffer_load_dwordx4 v44, s[12:15], s21 offen lds
  s_add_u32 m0, s22, 2048
  s_nop 0
  buffer_load_dwordx4 v45, s[12:15], s21 offen lds
  s_mul_i32 s21, s20, 393216
  s_add_u32 s21, s21, 6488064
  s_add_u32 s21, s21, s44
  s_mul_i32 s22, s20, 12288
  s_add_u32 s22, s22, 6144
  s_add_u32 m0, s22, 0
  s_nop 0
  buffer_load_dwordx4 v40, s[12:15], s21 offen lds
  s_add_u32 m0, s22, 1024
  s_nop 0
  buffer_load_dwordx4 v41, s[12:15], s21 offen lds
  s_add_u32 m0, s22, 2048
  s_nop 0
  buffer_load_dwordx4 v42, s[12:15], s21 offen lds
  s_mul_i32 s21, s20, 393216
  s_add_u32 s21, s21, 6586368
  s_add_u32 s21, s21, s44
  s_mul_i32 s22, s20, 12288
  s_add_u32 s22, s22, 9216
  s_add_u32 m0, s22, 0
  s_nop 0
  buffer_load_dwordx4 v43, s[12:15], s21 offen lds
  s_add_u32 m0, s22, 1024
  s_nop 0
  buffer_load_dwordx4 v44, s[12:15], s21 offen lds
  s_add_u32 m0, s22, 2048
  s_nop 0
  buffer_load_dwordx4 v45, s[12:15], s21 offen lds
  s_mov_b32 m0, s23
  v_mov_b32 v29, 76
  buffer_load_dword v29, v29, s[64:67], 0 offen sc1
  v_mfma_f32_16x16x32_bf16 v[64:67], a[96:99], v[160:163], v[64:67]
  ds_read_b128 v[192:195], v19 offset:0
  v_mfma_f32_16x16x32_bf16 v[68:71], a[100:103], v[160:163], v[68:71]
  v_add_u32 v18, s33, v14
  s_mov_b32 s61, s60
  v_mfma_f32_16x16x32_bf16 v[72:75], a[104:107], v[160:163], v[72:75]
  s_add_u32 s60, s60, s62
  s_lshr_b32 s48, s20, 1
  v_mfma_f32_16x16x32_bf16 v[76:79], a[96:99], v[164:167], v[76:79]
  ds_read_b128 v[196:199], v19 offset:2048
  s_mul_i32 s48, s48, 393216
  v_mfma_f32_16x16x32_bf16 v[80:83], a[100:103], v[164:167], v[80:83]
  buffer_load_dwordx4 v11, s[8:11], s30 offen offset:1024 lds
  v_mfma_f32_16x16x32_bf16 v[84:87], a[104:107], v[164:167], v[84:87]
  s_add_u32 s30, s30, s25
  v_mfma_f32_16x16x32_bf16 v[88:91], a[96:99], v[168:171], v[88:91]
  ds_read_b128 v[200:203], v19 offset:4096
  s_sub_u32 s30, s30, 1152
  v_mfma_f32_16x16x32_bf16 v[92:95], a[100:103], v[168:171], v[92:95]
  s_add_u32 m0, m0, 8192
  s_and_b32 s21, s20, 1
  v_mfma_f32_16x16x32_bf16 v[96:99], a[104:107], v[168:171], v[96:99]
  s_cmp_lt_u32 m0, s46
  s_cselect_b32 m0, m0, s47
  v_mfma_f32_16x16x32_bf16 v[100:103], a[96:99], v[172:175], v[100:103]
  ds_read_b128 v[204:207], v19 offset:6144
  s_mul_i32 s21, s21, 6144
  v_mfma_f32_16x16x32_bf16 v[104:107], a[100:103], v[172:175], v[104:107]
  s_add_u32 s48, s48, s21
  s_add_u32 s48, s48, s27
  v_mfma_f32_16x16x32_bf16 v[108:111], a[104:107], v[172:175], v[108:111]
  s_waitcnt vmcnt(33) lgkmcnt(2)
  s_barrier
  v_mfma_f32_16x16x32_bf16 v[64:67], a[108:111], v[192:195], v[64:67]
  ds_read_b128 v[160:163], v18 offset:0
  s_add_u32 s27, s27, s28
  v_mfma_f32_16x16x32_bf16 v[68:71], a[112:115], v[192:195], v[68:71]
  s_sub_u32 s26, s26, 1
  v_mfma_f32_16x16x32_bf16 v[72:75], a[116:119], v[192:195], v[72:75]
  v_add_u32 v19, s33, v15
  s_add_u32 s33, s33, 8192
  v_mfma_f32_16x16x32_bf16 v[76:79], a[108:111], v[196:199], v[76:79]
  ds_read_b128 v[164:167], v18 offset:2048
  v_mfma_f32_16x16x32_bf16 v[80:83], a[112:115], v[196:199], v[80:83]
  buffer_load_dwordx4 v10, s[8:11], s30 offen offset:0 lds
  v_mfma_f32_16x16x32_bf16 v[84:87], a[116:119], v[196:199], v[84:87]
  s_waitcnt lgkmcnt(2)
  v_mfma_f32_16x16x32_bf16 v[88:91], a[108:111], v[200:203], v[88:91]
  ds_read_b128 v[168:171], v18 offset:4096
  v_mfma_f32_16x16x32_bf16 v[92:95], a[112:115], v[200:203], v[92:95]
  s_cmp_lt_u32 s33, 155648
  s_cselect_b32 s33, s33, 98304
  v_mfma_f32_16x16x32_bf16 v[96:99], a[116:119], v[200:203], v[96:99]
  v_mfma_f32_16x16x32_bf16 v[100:103], a[108:111], v[204:207], v[100:103]
  ds_read_b128 v[172:175], v18 offset:6144
  v_mfma_f32_16x16x32_bf16 v[104:107], a[112:115], v[204:207], v[104:107]
  v_mfma_f32_16x16x32_bf16 v[108:111], a[116:119], v[204:207], v[108:111]
  s_waitcnt lgkmcnt(2)
  v_mfma_f32_16x16x32_bf16 v[64:67], a[120:123], v[160:163], v[64:67]
  ds_read_b128 v[192:195], v19 offset:0
  v_mfma_f32_16x16x32_bf16 v[68:71], a[124:127], v[160:163], v[68:71]
  v_add_u32 v18, s33, v14
  v_mfma_f32_16x16x32_bf16 v[72:75], a[128:131], v[160:163], v[72:75]
  v_mfma_f32_16x16x32_bf16 v[76:79], a[120:123], v[164:167], v[76:79]
  ds_read_b128 v[196:199], v19 offset:2048
  v_mfma_f32_16x16x32_bf16 v[80:83], a[124:127], v[164:167], v[80:83]
  buffer_load_dwordx4 v11, s[8:11], s30 offen offset:1024 lds
  v_mfma_f32_16x16x32_bf16 v[84:87], a[128:131], v[164:167], v[84:87]
  s_waitcnt lgkmcnt(2)
  s_add_u32 s30, s30, 128
  v_mfma_f32_16x16x32_bf16 v[88:91], a[120:123], v[168:171], v[88:91]
  ds_read_b128 v[200:203], v19 offset:4096
  s_add_u32 m0, m0, 8192
  v_mfma_f32_16x16x32_bf16 v[92:95], a[124:127], v[168:171], v[92:95]
  s_cmp_lt_u32 m0, s46
  s_cselect_b32 m0, m0, s47
  v_mfma_f32_16x16x32_bf16 v[96:99], a[128:131], v[168:171], v[96:99]
  v_mfma_f32_16x16x32_bf16 v[100:103], a[120:123], v[172:175], v[100:103]
  ds_read_b128 v[204:207], v19 offset:6144
  v_mfma_f32_16x16x32_bf16 v[104:107], a[124:127], v[172:175], v[104:107]
  v_mfma_f32_16x16x32_bf16 v[108:111], a[128:131], v[172:175], v[108:111]
  s_waitcnt vmcnt(33) lgkmcnt(2)
  s_barrier
  v_mfma_f32_16x16x32_bf16 v[64:67], a[132:135], v[192:195], v[64:67]
  ds_read_b128 v[160:163], v18 offset:0
  v_mfma_f32_16x16x32_bf16 v[68:71], a[136:139], v[192:195], v[68:71]
  v_mfma_f32_16x16x32_bf16 v[72:75], a[140:143], v[192:195], v[72:75]
  v_add_u32 v19, s33, v15
  s_add_u32 s33, s33, 8192
  v_mfma_f32_16x16x32_bf16 v[76:79], a[132:135], v[196:199], v[76:79]
  ds_read_b128 v[164:167], v18 offset:2048
  v_mfma_f32_16x16x32_bf16 v[80:83], a[136:139], v[196:199], v[80:83]
  buffer_load_dwordx4 v10, s[8:11], s30 offen offset:0 lds
  v_mfma_f32_16x16x32_bf16 v[84:87], a[140:143], v[196:199], v[84:87]
  s_waitcnt lgkmcnt(2)
  v_mfma_f32_16x16x32_bf16 v[88:91], a[132:135], v[200:203], v[88:91]
  ds_read_b128 v[168:171], v18 offset:4096
  v_mfma_f32_16x16x32_bf16 v[92:95], a[136:139], v[200:203], v[92:95]
  s_cmp_lt_u32 s33, 155648
  s_cselect_b32 s33, s33, 98304
  v_mfma_f32_16x16x32_bf16 v[96:99], a[140:143], v[200:203], v[96:99]
  v_mfma_f32_16x16x32_bf16 v[100:103], a[132:135], v[204:207], v[100:103]
  ds_read_b128 v[172:175], v18 offset:6144
  v_mfma_f32_16x16x32_bf16 v[104:107], a[136:139], v[204:207], v[104:107]
  v_mfma_f32_16x16x32_bf16 v[108:111], a[140:143], v[204:207], v[108:111]
  s_waitcnt lgkmcnt(2)
  s_waitcnt vmcnt(21)
  s_barrier
  ds_read_b64_tr_b16 a[144:145], v49 offset:0
  ds_read_b64_tr_b16 a[146:147], v49 offset:1536
  ds_read_b64_tr_b16 a[148:149], v50 offset:0
  ds_read_b64_tr_b16 a[150:151], v50 offset:1536
  ds_read_b64_tr_b16 a[152:153], v51 offset:0
  ds_read_b64_tr_b16 a[154:155], v51 offset:1536
  ds_read_b64_tr_b16 a[156:157], v49 offset:12288
  ds_read_b64_tr_b16 a[158:159], v49 offset:13824
  ds_read_b64_tr_b16 a[160:161], v50 offset:12288
  ds_read_b64_tr_b16 a[162:163], v50 offset:13824
  ds_read_b64_tr_b16 a[164:165], v51 offset:12288
  ds_read_b64_tr_b16 a[166:167], v51 offset:13824
  ds_read_b64_tr_b16 a[168:169], v49 offset:24576
  ds_read_b64_tr_b16 a[170:171], v49 offset:26112
  ds_read_b64_tr_b16 a[172:173], v50 offset:24576
  ds_read_b64_tr_b16 a[174:175], v50 offset:26112
  ds_read_b64_tr_b16 a[176:177], v51 offset:24576
  ds_read_b64_tr_b16 a[178:179], v51 offset:26112
  ds_read_b64_tr_b16 a[180:181], v49 offset:36864
  ds_read_b64_tr_b16 a[182:183], v49 offset:38400
  ds_read_b64_tr_b16 a[184:185], v50 offset:36864
  ds_read_b64_tr_b16 a[186:187], v50 offset:38400
  ds_read_b64_tr_b16 a[188:189], v51 offset:36864
  ds_read_b64_tr_b16 a[190:191], v51 offset:38400
  s_waitcnt lgkmcnt(0)
  s_barrier
  v_mfma_f32_16x16x32_bf16 v[64:67], a[144:147], v[160:163], v[64:67]
  ds_read_b128 v[192:195], v19 offset:0
  v_mfma_f32_16x16x32_bf16 v[68:71], a[148:151], v[160:163], v[68:71]
  v_add_u32 v18, s33, v14
  v_mfma_f32_16x16x32_bf16 v[72:75], a[152:155], v[160:163], v[72:75]
  v_mfma_f32_16x16x32_bf16 v[76:79], a[144:147], v[164:167], v[76:79]
  ds_read_b128 v[196:199], v19 offset:2048
  v_mfma_f32_16x16x32_bf16 v[80:83], a[148:151], v[164:167], v[80:83]
  buffer_load_dwordx4 v11, s[8:11], s30 offen offset:1024 lds
  v_mfma_f32_16x16x32_bf16 v[84:87], a[152:155], v[164:167], v[84:87]
  s_add_u32 s30, s30, 128
  v_mfma_f32_16x16x32_bf16 v[88:91], a[144:147], v[168:171], v[88:91]
  ds_read_b128 v[200:203], v19 offset:4096
  s_add_u32 m0, m0, 8192
  v_mfma_f32_16x16x32_bf16 v[92:95], a[148:151], v[168:171], v[92:95]
  s_cmp_lt_u32 m0, s46
  s_cselect_b32 m0, m0, s47
  v_mfma_f32_16x16x32_bf16 v[96:99], a[152:155], v[168:171], v[96:99]
  v_mfma_f32_16x16x32_bf16 v[100:103], a[144:147], v[172:175], v[100:103]
  ds_read_b128 v[204:207], v19 offset:6144
  v_mfma_f32_16x16x32_bf16 v[104:107], a[148:151], v[172:175], v[104:107]
  v_mfma_f32_16x16x32_bf16 v[108:111], a[152:155], v[172:175], v[108:111]
  s_waitcnt vmcnt(21) lgkmcnt(2)
  s_barrier
  v_mfma_f32_16x16x32_bf16 v[64:67], a[156:159], v[192:195], v[64:67]
  ds_read_b128 v[160:163], v18 offset:0
  v_mfma_f32_16x16x32_bf16 v[68:71], a[160:163], v[192:195], v[68:71]
  v_mfma_f32_16x16x32_bf16 v[72:75], a[164:167], v[192:195], v[72:75]
  v_add_u32 v19, s33, v15
  s_add_u32 s33, s33, 8192
  v_mfma_f32_16x16x32_bf16 v[76:79], a[156:159], v[196:199], v[76:79]
  ds_read_b128 v[164:167], v18 offset:2048
  v_mfma_f32_16x16x32_bf16 v[80:83], a[160:163], v[196:199], v[80:83]
  buffer_load_dwordx4 v10, s[8:11], s30 offen offset:0 lds
  v_mfma_f32_16x16x32_bf16 v[84:87], a[164:167], v[196:199], v[84:87]
  s_waitcnt lgkmcnt(2)
  v_mfma_f32_16x16x32_bf16 v[88:91], a[156:159], v[200:203], v[88:91]
  ds_read_b128 v[168:171], v18 offset:4096
  v_mfma_f32_16x16x32_bf16 v[92:95], a[160:163], v[200:203], v[92:95]
  s_cmp_lt_u32 s33, 155648
  s_cselect_b32 s33, s33, 98304
  v_mfma_f32_16x16x32_bf16 v[96:99], a[164:167], v[200:203], v[96:99]
  v_mfma_f32_16x16x32_bf16 v[100:103], a[156:159], v[204:207], v[100:103]
  ds_read_b128 v[172:175], v18 offset:6144
  v_mfma_f32_16x16x32_bf16 v[104:107], a[160:163], v[204:207], v[104:107]
  v_mfma_f32_16x16x32_bf16 v[108:111], a[164:167], v[204:207], v[108:111]
  s_waitcnt lgkmcnt(2)
  v_mfma_f32_16x16x32_bf16 v[64:67], a[168:171], v[160:163], v[64:67]
  ds_read_b128 v[192:195], v19 offset:0
  v_mfma_f32_16x16x32_bf16 v[68:71], a[172:175], v[160:163], v[68:71]
  v_add_u32 v18, s33, v14
  v_mfma_f32_16x16x32_bf16 v[72:75], a[176:179], v[160:163], v[72:75]
  v_mfma_f32_16x16x32_bf16 v[76:79], a[168:171], v[164:167], v[76:79]
  ds_read_b128 v[196:199], v19 offset:2048
  v_mfma_f32_16x16x32_bf16 v[80:83], a[172:175], v[164:167], v[80:83]
  buffer_load_dwordx4 v11, s[8:11], s30 offen offset:1024 lds
  v_mfma_f32_16x16x32_bf16 v[84:87], a[176:179], v[164:167], v[84:87]
  s_waitcnt lgkmcnt(2)
  s_add_u32 s30, s30, 128
  v_mfma_f32_16x16x32_bf16 v[88:91], a[168:171], v[168:171], v[88:91]
  ds_read_b128 v[200:203], v19 offset:4096
  s_add_u32 m0, m0, 8192
  v_mfma_f32_16x16x32_bf16 v[92:95], a[172:175], v[168:171], v[92:95]
  s_cmp_lt_u32 m0, s46
  s_cselect_b32 m0, m0, s47
  v_mfma_f32_16x16x32_bf16 v[96:99], a[176:179], v[168:171], v[96:99]
  v_mfma_f32_16x16x32_bf16 v[100:103], a[168:171], v[172:175], v[100:103]
  ds_read_b128 v[204:207], v19 offset:6144
  v_mfma_f32_16x16x32_bf16 v[104:107], a[172:175], v[172:175], v[104:107]
  v_mfma_f32_16x16x32_bf16 v[108:111], a[176:179], v[172:175], v[108:111]
  s_waitcnt vmcnt(21) lgkmcnt(2)
  s_barrier
  v_mfma_f32_16x16x32_bf16 v[64:67], a[180:183], v[192:195], v[64:67]
  ds_read_b128 v[160:163], v18 offset:0
  v_mfma_f32_16x16x32_bf16 v[68:71], a[184:187], v[192:195], v[68:71]
  v_mfma_f32_16x16x32_bf16 v[72:75], a[188:191], v[192:195], v[72:75]
  v_add_u32 v19, s33, v15
  s_add_u32 s33, s33, 8192
  v_mfma_f32_16x16x32_bf16 v[76:79], a[180:183], v[196:199], v[76:79]
  ds_read_b128 v[164:167], v18 offset:2048
  v_mfma_f32_16x16x32_bf16 v[80:83], a[184:187], v[196:199], v[80:83]
  buffer_load_dwordx4 v10, s[8:11], s30 offen offset:0 lds
  v_mfma_f32_16x16x32_bf16 v[84:87], a[188:191], v[196:199], v[84:87]
  s_waitcnt lgkmcnt(2)
  v_mfma_f32_16x16x32_bf16 v[88:91], a[180:183], v[200:203], v[88:91]
  ds_read_b128 v[168:171], v18 offset:4096
  v_mfma_f32_16x16x32_bf16 v[92:95], a[184:187], v[200:203], v[92:95]
  s_cmp_lt_u32 s33, 155648
  s_cselect_b32 s33, s33, 98304
  v_mfma_f32_16x16x32_bf16 v[96:99], a[188:191], v[200:203], v[96:99]
  v_mfma_f32_16x16x32_bf16 v[100:103], a[180:183], v[204:207], v[100:103]
  ds_read_b128 v[172:175], v18 offset:6144
  v_mfma_f32_16x16x32_bf16 v[104:107], a[184:187], v[204:207], v[104:107]
  v_mfma_f32_16x16x32_bf16 v[108:111], a[188:191], v[204:207], v[108:111]
  s_waitcnt lgkmcnt(2)
  s_waitcnt vmcnt(9)
  s_barrier
  ds_read_b64_tr_b16 a[192:193], v46 offset:0
  ds_read_b64_tr_b16 a[194:195], v46 offset:1536
  ds_read_b64_tr_b16 a[196:197], v47 offset:0
  ds_read_b64_tr_b16 a[198:199], v47 offset:1536
  ds_read_b64_tr_b16 a[200:201], v48 offset:0
  ds_read_b64_tr_b16 a[202:203], v48 offset:1536
  ds_read_b64_tr_b16 a[204:205], v46 offset:12288
  ds_read_b64_tr_b16 a[206:207], v46 offset:13824
  ds_read_b64_tr_b16 a[208:209], v47 offset:12288
  ds_read_b64_tr_b16 a[210:211], v47 offset:13824
  ds_read_b64_tr_b16 a[212:213], v48 offset:12288
  ds_read_b64_tr_b16 a[214:215], v48 offset:13824
  ds_read_b64_tr_b16 a[216:217], v46 offset:24576
  ds_read_b64_tr_b16 a[218:219], v46 offset:26112
  ds_read_b64_tr_b16 a[220:221], v47 offset:24576
  ds_read_b64_tr_b16 a[222:223], v47 offset:26112
  ds_read_b64_tr_b16 a[224:225], v48 offset:24576
  ds_read_b64_tr_b16 a[226:227], v48 offset:26112
  ds_read_b64_tr_b16 a[228:229], v46 offset:36864
  ds_read_b64_tr_b16 a[230:231], v46 offset:38400
  ds_read_b64_tr_b16 a[232:233], v47 offset:36864
  ds_read_b64_tr_b16 a[234:235], v47 offset:38400
  ds_read_b64_tr_b16 a[236:237], v48 offset:36864
  ds_read_b64_tr_b16 a[238:239], v48 offset:38400
  s_waitcnt lgkmcnt(0)
  s_barrier
  v_mfma_f32_16x16x32_bf16 v[64:67], a[192:195], v[160:163], v[64:67]
  ds_read_b128 v[192:195], v19 offset:0
  v_mfma_f32_16x16x32_bf16 v[68:71], a[196:199], v[160:163], v[68:71]
  v_add_u32 v18, s33, v14
  v_mfma_f32_16x16x32_bf16 v[72:75], a[200:203], v[160:163], v[72:75]
  v_mfma_f32_16x16x32_bf16 v[76:79], a[192:195], v[164:167], v[76:79]
  ds_read_b128 v[196:199], v19 offset:2048
  v_mfma_f32_16x16x32_bf16 v[80:83], a[196:199], v[164:167], v[80:83]
  buffer_load_dwordx4 v11, s[8:11], s30 offen offset:1024 lds
  v_mfma_f32_16x16x32_bf16 v[84:87], a[200:203], v[164:167], v[84:87]
  s_add_u32 s30, s30, 128
  v_mfma_f32_16x16x32_bf16 v[88:91], a[192:195], v[168:171], v[88:91]
  ds_read_b128 v[200:203], v19 offset:4096
  s_add_u32 m0, m0, 8192
  v_mfma_f32_16x16x32_bf16 v[92:95], a[196:199], v[168:171], v[92:95]
  s_cmp_lt_u32 m0, s46
  s_cselect_b32 m0, m0, s47
  v_mfma_f32_16x16x32_bf16 v[96:99], a[200:203], v[168:171], v[96:99]
  v_mfma_f32_16x16x32_bf16 v[100:103], a[192:195], v[172:175], v[100:103]
  ds_read_b128 v[204:207], v19 offset:6144
  v_mfma_f32_16x16x32_bf16 v[104:107], a[196:199], v[172:175], v[104:107]
  v_mfma_f32_16x16x32_bf16 v[108:111], a[200:203], v[172:175], v[108:111]
  s_waitcnt vmcnt(8) lgkmcnt(2)
  s_barrier
  v_mfma_f32_16x16x32_bf16 v[64:67], a[204:207], v[192:195], v[64:67]
  ds_read_b128 v[160:163], v18 offset:0
  v_mfma_f32_16x16x32_bf16 v[68:71], a[208:211], v[192:195], v[68:71]
  v_mfma_f32_16x16x32_bf16 v[72:75], a[212:215], v[192:195], v[72:75]
  v_add_u32 v19, s33, v15
  s_add_u32 s33, s33, 8192
  v_mfma_f32_16x16x32_bf16 v[76:79], a[204:207], v[196:199], v[76:79]
  ds_read_b128 v[164:167], v18 offset:2048
  v_mfma_f32_16x16x32_bf16 v[80:83], a[208:211], v[196:199], v[80:83]
  buffer_load_dwordx4 v10, s[8:11], s30 offen offset:0 lds
  v_mfma_f32_16x16x32_bf16 v[84:87], a[212:215], v[196:199], v[84:87]
  s_waitcnt lgkmcnt(2)
  v_mfma_f32_16x16x32_bf16 v[88:91], a[204:207], v[200:203], v[88:91]
  ds_read_b128 v[168:171], v18 offset:4096
  v_mfma_f32_16x16x32_bf16 v[92:95], a[208:211], v[200:203], v[92:95]
  s_cmp_lt_u32 s33, 155648
  s_cselect_b32 s33, s33, 98304
  v_mfma_f32_16x16x32_bf16 v[96:99], a[212:215], v[200:203], v[96:99]
  v_mfma_f32_16x16x32_bf16 v[100:103], a[204:207], v[204:207], v[100:103]
  ds_read_b128 v[172:175], v18 offset:6144
  v_mfma_f32_16x16x32_bf16 v[104:107], a[208:211], v[204:207], v[104:107]
  v_mfma_f32_16x16x32_bf16 v[108:111], a[212:215], v[204:207], v[108:111]
  s_waitcnt lgkmcnt(2)
  v_mfma_f32_16x16x32_bf16 v[64:67], a[216:219], v[160:163], v[64:67]
  ds_read_b128 v[192:195], v19 offset:0
  v_mfma_f32_16x16x32_bf16 v[68:71], a[220:223], v[160:163], v[68:71]
  v_add_u32 v18, s33, v14
  v_mfma_f32_16x16x32_bf16 v[72:75], a[224:227], v[160:163], v[72:75]
  v_mfma_f32_16x16x32_bf16 v[76:79], a[216:219], v[164:167], v[76:79]
  ds_read_b128 v[196:199], v19 offset:2048
  v_mfma_f32_16x16x32_bf16 v[80:83], a[220:223], v[164:167], v[80:83]
  buffer_load_dwordx4 v11, s[8:11], s30 offen offset:1024 lds
  v_mfma_f32_16x16x32_bf16 v[84:87], a[224:227], v[164:167], v[84:87]
  s_waitcnt lgkmcnt(2)
  s_add_u32 s30, s30, 128
  v_mfma_f32_16x16x32_bf16 v[88:91], a[216:219], v[168:171], v[88:91]
  ds_read_b128 v[200:203], v19 offset:4096
  s_add_u32 m0, m0, 8192
  v_mfma_f32_16x16x32_bf16 v[92:95], a[220:223], v[168:171], v[92:95]
  s_cmp_lt_u32 m0, s46
  s_cselect_b32 m0, m0, s47
  v_mfma_f32_16x16x32_bf16 v[96:99], a[224:227], v[168:171], v[96:99]
  v_mfma_f32_16x16x32_bf16 v[100:103], a[216:219], v[172:175], v[100:103]
  ds_read_b128 v[204:207], v19 offset:6144
  v_mfma_f32_16x16x32_bf16 v[104:107], a[220:223], v[172:175], v[104:107]
  v_mfma_f32_16x16x32_bf16 v[108:111], a[224:227], v[172:175], v[108:111]
  s_waitcnt vmcnt(8) lgkmcnt(2)
  s_barrier
  v_mfma_f32_16x16x32_bf16 v[64:67], a[228:231], v[192:195], v[64:67]
  ds_read_b128 v[160:163], v18 offset:0
  v_mfma_f32_16x16x32_bf16 v[68:71], a[232:235], v[192:195], v[68:71]
  v_mfma_f32_16x16x32_bf16 v[72:75], a[236:239], v[192:195], v[72:75]
  v_add_u32 v19, s33, v15
  s_add_u32 s33, s33, 8192
  v_mfma_f32_16x16x32_bf16 v[76:79], a[228:231], v[196:199], v[76:79]
  ds_read_b128 v[164:167], v18 offset:2048
  v_cvt_pk_bf16_f32 v224, v64, v65
  v_cvt_pk_bf16_f32 v225, v66, v67
  v_mfma_f32_16x16x32_bf16 v[80:83], a[232:235], v[196:199], v[80:83]
  buffer_load_dwordx4 v10, s[8:11], s30 offen offset:0 lds
  v_cvt_pk_bf16_f32 v226, v68, v69
  v_cvt_pk_bf16_f32 v227, v70, v71
  v_mfma_f32_16x16x32_bf16 v[84:87], a[236:239], v[196:199], v[84:87]
  s_waitcnt lgkmcnt(2)
  v_cvt_pk_bf16_f32 v228, v72, v73
  v_cvt_pk_bf16_f32 v229, v74, v75
  v_mfma_f32_16x16x32_bf16 v[88:91], a[228:231], v[200:203], v[88:91]
  ds_read_b128 v[168:171], v18 offset:4096
  ds_write_b64 v22, v[224:225] offset:0
  v_mfma_f32_16x16x32_bf16 v[92:95], a[232:235], v[200:203], v[92:95]
  s_cmp_lt_u32 s33, 155648
  s_cselect_b32 s33, s33, 98304
  ds_write_b64 v22, v[226:227] offset:8
  v_mfma_f32_16x16x32_bf16 v[96:99], a[236:239], v[200:203], v[96:99]
  ds_write_b64 v16, v[228:229] offset:64
  v_cvt_pk_bf16_f32 v230, v76, v77
  v_cvt_pk_bf16_f32 v231, v78, v79
  v_mfma_f32_16x16x32_bf16 v[100:103], a[228:231], v[204:207], v[100:103]
  ds_read_b128 v[172:175], v18 offset:6144
  v_cvt_pk_bf16_f32 v232, v80, v81
  v_cvt_pk_bf16_f32 v233, v82, v83
  v_cvt_pk_bf16_f32 v234, v84, v85
  v_mfma_f32_16x16x32_bf16 v[104:107], a[232:235], v[204:207], v[104:107]
  v_cvt_pk_bf16_f32 v235, v86, v87
  ds_write_b64 v22, v[230:231] offset:6400
  v_mfma_f32_16x16x32_bf16 v[108:111], a[236:239], v[204:207], v[108:111]
  ds_write_b64 v22, v[232:233] offset:6408
  ds_write_b64 v16, v[234:235] offset:6464
  v_readfirstlane_b32 s21, v29
  s_cmp_ge_u32 s21, 32
  s_cbranch_scc1 kvz_179
  s_mov_b32 s21, 76
  v_mov_b32 v4, 0
  s_mov_b32 s101, 0
wf_180:
  buffer_load_dword v5, v4, s[64:67], s21 offen sc1
  s_add_u32 s101, s101, 1
  s_cmp_gt_u32 s101, 131072
  s_cbranch_scc1 main_end
  s_waitcnt vmcnt(0)
  v_readfirstlane_b32 s100, v5
  s_cmp_ge_u32 s100, 32
  s_cbranch_scc1 wf_181
  s_sleep 8
  s_branch wf_180
wf_181:
kvz_179:
  s_branch kvm_end_178
kvm_blk_177:
  v_mfma_f32_16x16x32_bf16 v[64:67], a[0:3], v[160:163], 0
  ds_read_b128 v[192:195], v19 offset:0
  v_mfma_f32_16x16x32_bf16 v[68:71], a[4:7], v[160:163], 0
  v_add_u32 v18, s33, v14
  v_mfma_f32_16x16x32_bf16 v[72:75], a[8:11], v[160:163], 0
  v_mfma_f32_16x16x32_bf16 v[76:79], a[0:3], v[164:167], 0
  ds_read_b128 v[196:199], v19 offset:2048
  v_mfma_f32_16x16x32_bf16 v[80:83], a[4:7], v[164:167], 0
  buffer_load_dwordx4 v11, s[8:11], s30 offen offset:1024 lds
  v_mfma_f32_16x16x32_bf16 v[84:87], a[8:11], v[164:167], 0
  s_waitcnt lgkmcnt(11)
  s_add_u32 s30, s30, 128
  v_mfma_f32_16x16x32_bf16 v[88:91], a[0:3], v[168:171], 0
  ds_read_b128 v[200:203], v19 offset:4096
  s_add_u32 m0, m0, 8192
  v_mfma_f32_16x16x32_bf16 v[92:95], a[4:7], v[168:171], 0
  s_cmp_lt_u32 m0, s46
  s_cselect_b32 m0, m0, s47
  v_mfma_f32_16x16x32_bf16 v[96:99], a[8:11], v[168:171], 0
  v_mfma_f32_16x16x32_bf16 v[100:103], a[0:3], v[172:175], 0
  ds_read_b128 v[204:207], v19 offset:6144
  v_mfma_f32_16x16x32_bf16 v[104:107], a[4:7], v[172:175], 0
  v_mfma_f32_16x16x32_bf16 v[108:111], a[8:11], v[172:175], 0
  s_waitcnt vmcnt(14) lgkmcnt(2)
  s_barrier
  v_mfma_f32_16x16x32_bf16 v[64:67], a[12:15], v[192:195], v[64:67]
  ds_read_b128 v[160:163], v18 offset:0
  v_mfma_f32_16x16x32_bf16 v[68:71], a[16:19], v[192:195], v[68:71]
  v_mfma_f32_16x16x32_bf16 v[72:75], a[20:23], v[192:195], v[72:75]
  v_add_u32 v19, s33, v15
  s_add_u32 s33, s33, 8192
  v_mfma_f32_16x16x32_bf16 v[76:79], a[12:15], v[196:199], v[76:79]
  ds_read_b128 v[164:167], v18 offset:2048
  v_mfma_f32_16x16x32_bf16 v[80:83], a[16:19], v[196:199], v[80:83]
  buffer_load_dwordx4 v10, s[8:11], s30 offen offset:0 lds
  v_mfma_f32_16x16x32_bf16 v[84:87], a[20:23], v[196:199], v[84:87]
  s_waitcnt lgkmcnt(2)
  v_mfma_f32_16x16x32_bf16 v[88:91], a[12:15], v[200:203], v[88:91]
  ds_read_b128 v[168:171], v18 offset:4096
  v_mfma_f32_16x16x32_bf16 v[92:95], a[16:19], v[200:203], v[92:95]
  s_cmp_lt_u32 s33, 155648
  s_cselect_b32 s33, s33, 98304
  v_mfma_f32_16x16x32_bf16 v[96:99], a[20:23], v[200:203], v[96:99]
  v_mfma_f32_16x16x32_bf16 v[100:103], a[12:15], v[204:207], v[100:103]
  ds_read_b128 v[172:175], v18 offset:6144
  v_mfma_f32_16x16x32_bf16 v[104:107], a[16:19], v[204:207], v[104:107]
  v_mfma_f32_16x16x32_bf16 v[108:111], a[20:23], v[204:207], v[108:111]
  s_waitcnt lgkmcnt(2)
  v_mfma_f32_16x16x32_bf16 v[64:67], a[24:27], v[160:163], v[64:67]
  ds_read_b128 v[192:195], v19 offset:0
  v_mfma_f32_16x16x32_bf16 v[68:71], a[28:31], v[160:163], v[68:71]
  v_add_u32 v18, s33, v14
  v_mfma_f32_16x16x32_bf16 v[72:75], a[32:35], v[160:163], v[72:75]
  v_mfma_f32_16x16x32_bf16 v[76:79], a[24:27], v[164:167], v[76:79]
  ds_read_b128 v[196:199], v19 offset:2048
  v_mfma_f32_16x16x32_bf16 v[80:83], a[28:31], v[164:167], v[80:83]
  buffer_load_dwordx4 v11, s[8:11], s30 offen offset:1024 lds
  v_mfma_f32_16x16x32_bf16 v[84:87], a[32:35], v[164:167], v[84:87]
  s_waitcnt lgkmcnt(2)
  s_add_u32 s30, s30, 128
  v_mfma_f32_16x16x32_bf16 v[88:91], a[24:27], v[168:171], v[88:91]
  ds_read_b128 v[200:203], v19 offset:4096
  s_add_u32 m0, m0, 8192
  v_mfma_f32_16x16x32_bf16 v[92:95], a[28:31], v[168:171], v[92:95]
  s_cmp_lt_u32 m0, s46
  s_cselect_b32 m0, m0, s47
  v_mfma_f32_16x16x32_bf16 v[96:99], a[32:35], v[168:171], v[96:99]
  v_mfma_f32_16x16x32_bf16 v[100:103], a[24:27], v[172:175], v[100:103]
  ds_read_b128 v[204:207], v19 offset:6144
  v_mfma_f32_16x16x32_bf16 v[104:107], a[28:31], v[172:175], v[104:107]
  v_mfma_f32_16x16x32_bf16 v[108:111], a[32:35], v[172:175], v[108:111]
  s_waitcnt vmcnt(14) lgkmcnt(2)
  s_barrier
  v_mfma_f32_16x16x32_bf16 v[64:67], a[36:39], v[192:195], v[64:67]
  ds_read_b128 v[160:163], v18 offset:0
  v_mfma_f32_16x16x32_bf16 v[68:71], a[40:43], v[192:195], v[68:71]
  v_mfma_f32_16x16x32_bf16 v[72:75], a[44:47], v[192:195], v[72:75]
  v_add_u32 v19, s33, v15
  s_add_u32 s33, s33, 8192
  v_mfma_f32_16x16x32_bf16 v[76:79], a[36:39], v[196:199], v[76:79]
  ds_read_b128 v[164:167], v18 offset:2048
  v_mfma_f32_16x16x32_bf16 v[80:83], a[40:43], v[196:199], v[80:83]
  buffer_load_dwordx4 v10, s[8:11], s30 offen offset:0 lds
  v_mfma_f32_16x16x32_bf16 v[84:87], a[44:47], v[196:199], v[84:87]
  s_waitcnt lgkmcnt(2)
  v_mfma_f32_16x16x32_bf16 v[88:91], a[36:39], v[200:203], v[88:91]
  ds_read_b128 v[168:171], v18 offset:4096
  v_mfma_f32_16x16x32_bf16 v[92:95], a[40:43], v[200:203], v[92:95]
  s_cmp_lt_u32 s33, 155648
  s_cselect_b32 s33, s33, 98304
  v_mfma_f32_16x16x32_bf16 v[96:99], a[44:47], v[200:203], v[96:99]
  v_mfma_f32_16x16x32_bf16 v[100:103], a[36:39], v[204:207], v[100:103]
  ds_read_b128 v[172:175], v18 offset:6144
  v_mfma_f32_16x16x32_bf16 v[104:107], a[40:43], v[204:207], v[104:107]
  v_mfma_f32_16x16x32_bf16 v[108:111], a[44:47], v[204:207], v[108:111]
  s_waitcnt lgkmcnt(2)
  v_mfma_f32_16x16x32_bf16 v[64:67], a[48:51], v[160:163], v[64:67]
  ds_read_b128 v[192:195], v19 offset:0
  v_mfma_f32_16x16x32_bf16 v[68:71], a[52:55], v[160:163], v[68:71]
  v_add_u32 v18, s33, v14
  v_mfma_f32_16x16x32_bf16 v[72:75], a[56:59], v[160:163], v[72:75]
  v_mfma_f32_16x16x32_bf16 v[76:79], a[48:51], v[164:167], v[76:79]
  ds_read_b128 v[196:199], v19 offset:2048
  v_mfma_f32_16x16x32_bf16 v[80:83], a[52:55], v[164:167], v[80:83]
  buffer_load_dwordx4 v11, s[8:11], s30 offen offset:1024 lds
  v_mfma_f32_16x16x32_bf16 v[84:87], a[56:59], v[164:167], v[84:87]
  s_waitcnt lgkmcnt(2)
  s_add_u32 s30, s30, 128
  v_mfma_f32_16x16x32_bf16 v[88:91], a[48:51], v[168:171], v[88:91]
  ds_read_b128 v[200:203], v19 offset:4096
  s_add_u32 m0, m0, 8192
  v_mfma_f32_16x16x32_bf16 v[92:95], a[52:55], v[168:171], v[92:95]
  s_cmp_lt_u32 m0, s46
  s_cselect_b32 m0, m0, s47
  v_mfma_f32_16x16x32_bf16 v[96:99], a[56:59], v[168:171], v[96:99]
  v_mfma_f32_16x16x32_bf16 v[100:103], a[48:51], v[172:175], v[100:103]
  ds_read_b128 v[204:207], v19 offset:6144
  v_mfma_f32_16x16x32_bf16 v[104:107], a[52:55], v[172:175], v[104:107]
  v_mfma_f32_16x16x32_bf16 v[108:111], a[56:59], v[172:175], v[108:111]
  s_waitcnt vmcnt(14) lgkmcnt(2)
  s_barrier
  v_mfma_f32_16x16x32_bf16 v[64:67], a[60:63], v[192:195], v[64:67]
  ds_read_b128 v[160:163], v18 offset:0
  v_mfma_f32_16x16x32_bf16 v[68:71], a[64:67], v[192:195], v[68:71]
  v_mfma_f32_16x16x32_bf16 v[72:75], a[68:71], v[192:195], v[72:75]
  v_add_u32 v19, s33, v15
  s_add_u32 s33, s33, 8192
  v_mfma_f32_16x16x32_bf16 v[76:79], a[60:63], v[196:199], v[76:79]
  ds_read_b128 v[164:167], v18 offset:2048
  v_mfma_f32_16x16x32_bf16 v[80:83], a[64:67], v[196:199], v[80:83]
  buffer_load_dwordx4 v10, s[8:11], s30 offen offset:0 lds
  v_mfma_f32_16x16x32_bf16 v[84:87], a[68:71], v[196:199], v[84:87]
  s_waitcnt lgkmcnt(2)
  v_mfma_f32_16x16x32_bf16 v[88:91], a[60:63], v[200:203], v[88:91]
  ds_read_b128 v[168:171], v18 offset:4096
  v_mfma_f32_16x16x32_bf16 v[92:95], a[64:67], v[200:203], v[92:95]
  s_cmp_lt_u32 s33, 155648
  s_cselect_b32 s33, s33, 98304
  v_mfma_f32_16x16x32_bf16 v[96:99], a[68:71], v[200:203], v[96:99]
  v_mfma_f32_16x16x32_bf16 v[100:103], a[60:63], v[204:207], v[100:103]
  ds_read_b128 v[172:175], v18 offset:6144
  v_mfma_f32_16x16x32_bf16 v[104:107], a[64:67], v[204:207], v[104:107]
  v_mfma_f32_16x16x32_bf16 v[108:111], a[68:71], v[204:207], v[108:111]
  s_waitcnt lgkmcnt(2)
  v_mfma_f32_16x16x32_bf16 v[64:67], a[72:75], v[160:163], v[64:67]
  ds_read_b128 v[192:195], v19 offset:0
  v_mfma_f32_16x16x32_bf16 v[68:71], a[76:79], v[160:163], v[68:71]
  v_add_u32 v18, s33, v14
  v_mfma_f32_16x16x32_bf16 v[72:75], a[80:83], v[160:163], v[72:75]
  v_mfma_f32_16x16x32_bf16 v[76:79], a[72:75], v[164:167], v[76:79]
  ds_read_b128 v[196:199], v19 offset:2048
  v_mfma_f32_16x16x32_bf16 v[80:83], a[76:79], v[164:167], v[80:83]
  buffer_load_dwordx4 v11, s[8:11], s30 offen offset:1024 lds
  v_mfma_f32_16x16x32_bf16 v[84:87], a[80:83], v[164:167], v[84:87]
  s_waitcnt lgkmcnt(2)
  s_add_u32 s30, s30, 128
  v_mfma_f32_16x16x32_bf16 v[88:91], a[72:75], v[168:171], v[88:91]
  ds_read_b128 v[200:203], v19 offset:4096
  s_add_u32 m0, m0, 8192
  v_mfma_f32_16x16x32_bf16 v[92:95], a[76:79], v[168:171], v[92:95]
  s_cmp_lt_u32 m0, s46
  s_cselect_b32 m0, m0, s47
  v_mfma_f32_16x16x32_bf16 v[96:99], a[80:83], v[168:171], v[96:99]
  v_mfma_f32_16x16x32_bf16 v[100:103], a[72:75], v[172:175], v[100:103]
  ds_read_b128 v[204:207], v19 offset:6144
  v_mfma_f32_16x16x32_bf16 v[104:107], a[76:79], v[172:175], v[104:107]
  v_mfma_f32_16x16x32_bf16 v[108:111], a[80:83], v[172:175], v[108:111]
  s_waitcnt vmcnt(7) lgkmcnt(2)
  s_barrier
  v_mfma_f32_16x16x32_bf16 v[64:67], a[84:87], v[192:195], v[64:67]
  ds_read_b128 v[160:163], v18 offset:0
  v_mfma_f32_16x16x32_bf16 v[68:71], a[88:91], v[192:195], v[68:71]
  s_cmp_eq_u32 s48, 0x80000000
  s_cbranch_scc1 kvm_175
  s_cmp_lg_u32 s20, 0
  s_cbranch_scc1 af_176
  v_mov_b32 v4, 0
  v_mov_b32 v5, 1
  s_mov_b64 exec, 1
  buffer_atomic_add v5, v4, s[72:75], s61 offen sc1
  s_mov_b64 exec, -1
  s_nop 1
af_176:
kvm_175:
  v_mfma_f32_16x16x32_bf16 v[72:75], a[92:95], v[192:195], v[72:75]
  v_add_u32 v19, s33, v15
  s_add_u32 s33, s33, 8192
  v_mfma_f32_16x16x32_bf16 v[76:79], a[84:87], v[196:199], v[76:79]
  ds_read_b128 v[164:167], v18 offset:2048
  v_mfma_f32_16x16x32_bf16 v[80:83], a[88:91], v[196:199], v[80:83]
  buffer_load_dwordx4 v10, s[8:11], s30 offen offset:0 lds
  v_mfma_f32_16x16x32_bf16 v[84:87], a[92:95], v[196:199], v[84:87]
  s_waitcnt lgkmcnt(2)
  v_mfma_f32_16x16x32_bf16 v[88:91], a[84:87], v[200:203], v[88:91]
  ds_read_b128 v[168:171], v18 offset:4096
  v_mfma_f32_16x16x32_bf16 v[92:95], a[88:91], v[200:203], v[92:95]
  s_cmp_lt_u32 s33, 155648
  s_cselect_b32 s33, s33, 98304
  v_mfma_f32_16x16x32_bf16 v[96:99], a[92:95], v[200:203], v[96:99]
  v_mfma_f32_16x16x32_bf16 v[100:103], a[84:87], v[204:207], v[100:103]
  ds_read_b128 v[172:175], v18 offset:6144
  v_mfma_f32_16x16x32_bf16 v[104:107], a[88:91], v[204:207], v[104:107]
  v_mfma_f32_16x16x32_bf16 v[108:111], a[92:95], v[204:207], v[108:111]
  s_waitcnt lgkmcnt(2)
  v_mfma_f32_16x16x32_bf16 v[64:67], a[96:99], v[160:163], v[64:67]
  ds_read_b128 v[192:195], v19 offset:0
  v_mfma_f32_16x16x32_bf16 v[68:71], a[100:103], v[160:163], v[68:71]
  v_add_u32 v18, s33, v14
  s_mov_b32 s61, s60
  v_mfma_f32_16x16x32_bf16 v[72:75], a[104:107], v[160:163], v[72:75]
  s_add_u32 s60, s60, s62
  s_lshr_b32 s48, s20, 1
  v_mfma_f32_16x16x32_bf16 v[76:79], a[96:99], v[164:167], v[76:79]
  ds_read_b128 v[196:199], v19 offset:2048
  s_mul_i32 s48, s48, 393216
  v_mfma_f32_16x16x32_bf16 v[80:83], a[100:103], v[164:167], v[80:83]
  buffer_load_dwordx4 v11, s[8:11], s30 offen offset:1024 lds
  v_mfma_f32_16x16x32_bf16 v[84:87], a[104:107], v[164:167], v[84:87]
  s_waitcnt lgkmcnt(2)
  s_add_u32 s30, s30, s25
  v_mfma_f32_16x16x32_bf16 v[88:91], a[96:99], v[168:171], v[88:91]
  ds_read_b128 v[200:203], v19 offset:4096
  s_sub_u32 s30, s30, 1152
  v_mfma_f32_16x16x32_bf16 v[92:95], a[100:103], v[168:171], v[92:95]
  s_add_u32 m0, m0, 8192
  s_and_b32 s21, s20, 1
  v_mfma_f32_16x16x32_bf16 v[96:99], a[104:107], v[168:171], v[96:99]
  s_cmp_lt_u32 m0, s46
  s_cselect_b32 m0, m0, s47
  v_mfma_f32_16x16x32_bf16 v[100:103], a[96:99], v[172:175], v[100:103]
  ds_read_b128 v[204:207], v19 offset:6144
  s_mul_i32 s21, s21, 6144
  v_mfma_f32_16x16x32_bf16 v[104:107], a[100:103], v[172:175], v[104:107]
  s_add_u32 s48, s48, s21
  s_add_u32 s48, s48, s27
  v_mfma_f32_16x16x32_bf16 v[108:111], a[104:107], v[172:175], v[108:111]
  s_waitcnt vmcnt(8) lgkmcnt(2)
  s_barrier
  v_mfma_f32_16x16x32_bf16 v[64:67], a[108:111], v[192:195], v[64:67]
  ds_read_b128 v[160:163], v18 offset:0
  s_add_u32 s27, s27, s28
  v_mfma_f32_16x16x32_bf16 v[68:71], a[112:115], v[192:195], v[68:71]
  s_sub_u32 s26, s26, 1
  v_mfma_f32_16x16x32_bf16 v[72:75], a[116:119], v[192:195], v[72:75]
  v_add_u32 v19, s33, v15
  s_add_u32 s33, s33, 8192
  v_mfma_f32_16x16x32_bf16 v[76:79], a[108:111], v[196:199], v[76:79]
  ds_read_b128 v[164:167], v18 offset:2048
  v_mfma_f32_16x16x32_bf16 v[80:83], a[112:115], v[196:199], v[80:83]
  buffer_load_dwordx4 v10, s[8:11], s30 offen offset:0 lds
  v_mfma_f32_16x16x32_bf16 v[84:87], a[116:119], v[196:199], v[84:87]
  s_waitcnt lgkmcnt(2)
  v_mfma_f32_16x16x32_bf16 v[88:91], a[108:111], v[200:203], v[88:91]
  ds_read_b128 v[168:171], v18 offset:4096
  v_mfma_f32_16x16x32_bf16 v[92:95], a[112:115], v[200:203], v[92:95]
  s_cmp_lt_u32 s33, 155648
  s_cselect_b32 s33, s33, 98304
  v_mfma_f32_16x16x32_bf16 v[96:99], a[116:119], v[200:203], v[96:99]
  v_mfma_f32_16x16x32_bf16 v[100:103], a[108:111], v[204:207], v[100:103]
  ds_read_b128 v[172:175], v18 offset:6144
  v_mfma_f32_16x16x32_bf16 v[104:107], a[112:115], v[204:207], v[104:107]
  v_mfma_f32_16x16x32_bf16 v[108:111], a[116:119], v[204:207], v[108:111]
  s_waitcnt lgkmcnt(2)
  v_mfma_f32_16x16x32_bf16 v[64:67], a[120:123], v[160:163], v[64:67]
  ds_read_b128 v[192:195], v19 offset:0
  v_mfma_f32_16x16x32_bf16 v[68:71], a[124:127], v[160:163], v[68:71]
  v_add_u32 v18, s33, v14
  v_mfma_f32_16x16x32_bf16 v[72:75], a[128:131], v[160:163], v[72:75]
  v_mfma_f32_16x16x32_bf16 v[76:79], a[120:123], v[164:167], v[76:79]
  ds_read_b128 v[196:199], v19 offset:2048
  v_mfma_f32_16x16x32_bf16 v[80:83], a[124:127], v[164:167], v[80:83]
  buffer_load_dwordx4 v11, s[8:11], s30 offen offset:1024 lds
  v_mfma_f32_16x16x32_bf16 v[84:87], a[128:131], v[164:167], v[84:87]
  s_waitcnt lgkmcnt(2)
  s_add_u32 s30, s30, 128
  v_mfma_f32_16x16x32_bf16 v[88:91], a[120:123], v[168:171], v[88:91]
  ds_read_b128 v[200:203], v19 offset:4096
  s_add_u32 m0, m0, 8192
  v_mfma_f32_16x16x32_bf16 v[92:95], a[124:127], v[168:171], v[92:95]
  s_cmp_lt_u32 m0, s46
  s_cselect_b32 m0, m0, s47
  v_mfma_f32_16x16x32_bf16 v[96:99], a[128:131], v[168:171], v[96:99]
  v_mfma_f32_16x16x32_bf16 v[100:103], a[120:123], v[172:175], v[100:103]
  ds_read_b128 v[204:207], v19 offset:6144
  v_mfma_f32_16x16x32_bf16 v[104:107], a[124:127], v[172:175], v[104:107]
  v_mfma_f32_16x16x32_bf16 v[108:111], a[128:131], v[172:175], v[108:111]
  s_waitcnt vmcnt(8) lgkmcnt(2)
  s_barrier
  v_mfma_f32_16x16x32_bf16 v[64:67], a[132:135], v[192:195], v[64:67]
  ds_read_b128 v[160:163], v18 offset:0
  v_mfma_f32_16x16x32_bf16 v[68:71], a[136:139], v[192:195], v[68:71]
  v_mfma_f32_16x16x32_bf16 v[72:75], a[140:143], v[192:195], v[72:75]
  v_add_u32 v19, s33, v15
  s_add_u32 s33, s33, 8192
  v_mfma_f32_16x16x32_bf16 v[76:79], a[132:135], v[196:199], v[76:79]
  ds_read_b128 v[164:167], v18 offset:2048
  v_mfma_f32_16x16x32_bf16 v[80:83], a[136:139], v[196:199], v[80:83]
  buffer_load_dwordx4 v10, s[8:11], s30 offen offset:0 lds
  v_mfma_f32_16x16x32_bf16 v[84:87], a[140:143], v[196:199], v[84:87]
  s_waitcnt lgkmcnt(2)
  v_mfma_f32_16x16x32_bf16 v[88:91], a[132:135], v[200:203], v[88:91]
  ds_read_b128 v[168:171], v18 offset:4096
  v_mfma_f32_16x16x32_bf16 v[92:95], a[136:139], v[200:203], v[92:95]
  s_cmp_lt_u32 s33, 155648
  s_cselect_b32 s33, s33, 98304
  v_mfma_f32_16x16x32_bf16 v[96:99], a[140:143], v[200:203], v[96:99]
  v_mfma_f32_16x16x32_bf16 v[100:103], a[132:135], v[204:207], v[100:103]
  ds_read_b128 v[172:175], v18 offset:6144
  v_mfma_f32_16x16x32_bf16 v[104:107], a[136:139], v[204:207], v[104:107]
  v_mfma_f32_16x16x32_bf16 v[108:111], a[140:143], v[204:207], v[108:111]
  s_waitcnt lgkmcnt(2)
  v_mfma_f32_16x16x32_bf16 v[64:67], a[144:147], v[160:163], v[64:67]
  ds_read_b128 v[192:195], v19 offset:0
  v_mfma_f32_16x16x32_bf16 v[68:71], a[148:151], v[160:163], v[68:71]
  v_add_u32 v18, s33, v14
  v_mfma_f32_16x16x32_bf16 v[72:75], a[152:155], v[160:163], v[72:75]
  v_mfma_f32_16x16x32_bf16 v[76:79], a[144:147], v[164:167], v[76:79]
  ds_read_b128 v[196:199], v19 offset:2048
  v_mfma_f32_16x16x32_bf16 v[80:83], a[148:151], v[164:167], v[80:83]
  buffer_load_dwordx4 v11, s[8:11], s30 offen offset:1024 lds
  v_mfma_f32_16x16x32_bf16 v[84:87], a[152:155], v[164:167], v[84:87]
  s_waitcnt lgkmcnt(2)
  s_add_u32 s30, s30, 128
  v_mfma_f32_16x16x32_bf16 v[88:91], a[144:147], v[168:171], v[88:91]
  ds_read_b128 v[200:203], v19 offset:4096
  s_add_u32 m0, m0, 8192
  v_mfma_f32_16x16x32_bf16 v[92:95], a[148:151], v[168:171], v[92:95]
  s_cmp_lt_u32 m0, s46
  s_cselect_b32 m0, m0, s47
  v_mfma_f32_16x16x32_bf16 v[96:99], a[152:155], v[168:171], v[96:99]
  v_mfma_f32_16x16x32_bf16 v[100:103], a[144:147], v[172:175], v[100:103]
  ds_read_b128 v[204:207], v19 offset:6144
  v_mfma_f32_16x16x32_bf16 v[104:107], a[148:151], v[172:175], v[104:107]
  v_mfma_f32_16x16x32_bf16 v[108:111], a[152:155], v[172:175], v[108:111]
  s_waitcnt vmcnt(8) lgkmcnt(2)
  s_barrier
  v_mfma_f32_16x16x32_bf16 v[64:67], a[156:159], v[192:195], v[64:67]
  ds_read_b128 v[160:163], v18 offset:0
  v_mfma_f32_16x16x32_bf16 v[68:71], a[160:163], v[192:195], v[68:71]
  v_mfma_f32_16x16x32_bf16 v[72:75], a[164:167], v[192:195], v[72:75]
  v_add_u32 v19, s33, v15
  s_add_u32 s33, s33, 8192
  v_mfma_f32_16x16x32_bf16 v[76:79], a[156:159], v[196:199], v[76:79]
  ds_read_b128 v[164:167], v18 offset:2048
  v_mfma_f32_16x16x32_bf16 v[80:83], a[160:163], v[196:199], v[80:83]
  buffer_load_dwordx4 v10, s[8:11], s30 offen offset:0 lds
  v_mfma_f32_16x16x32_bf16 v[84:87], a[164:167], v[196:199], v[84:87]
  s_waitcnt lgkmcnt(2)
  v_mfma_f32_16x16x32_bf16 v[88:91], a[156:159], v[200:203], v[88:91]
  ds_read_b128 v[168:171], v18 offset:4096
  v_mfma_f32_16x16x32_bf16 v[92:95], a[160:163], v[200:203], v[92:95]
  s_cmp_lt_u32 s33, 155648
  s_cselect_b32 s33, s33, 98304
  v_mfma_f32_16x16x32_bf16 v[96:99], a[164:167], v[200:203], v[96:99]
  v_mfma_f32_16x16x32_bf16 v[100:103], a[156:159], v[204:207], v[100:103]
  ds_read_b128 v[172:175], v18 offset:6144
  v_mfma_f32_16x16x32_bf16 v[104:107], a[160:163], v[204:207], v[104:107]
  v_mfma_f32_16x16x32_bf16 v[108:111], a[164:167], v[204:207], v[108:111]
  s_waitcnt lgkmcnt(2)
  v_mfma_f32_16x16x32_bf16 v[64:67], a[168:171], v[160:163], v[64:67]
  ds_read_b128 v[192:195], v19 offset:0
  v_mfma_f32_16x16x32_bf16 v[68:71], a[172:175], v[160:163], v[68:71]
  v_add_u32 v18, s33, v14
  v_mfma_f32_16x16x32_bf16 v[72:75], a[176:179], v[160:163], v[72:75]
  v_mfma_f32_16x16x32_bf16 v[76:79], a[168:171], v[164:167], v[76:79]
  ds_read_b128 v[196:199], v19 offset:2048
  v_mfma_f32_16x16x32_bf16 v[80:83], a[172:175], v[164:167], v[80:83]
  buffer_load_dwordx4 v11, s[8:11], s30 offen offset:1024 lds
  v_mfma_f32_16x16x32_bf16 v[84:87], a[176:179], v[164:167], v[84:87]
  s_waitcnt lgkmcnt(2)
  s_add_u32 s30, s30, 128
  v_mfma_f32_16x16x32_bf16 v[88:91], a[168:171], v[168:171], v[88:91]
  ds_read_b128 v[200:203], v19 offset:4096
  s_add_u32 m0, m0, 8192
  v_mfma_f32_16x16x32_bf16 v[92:95], a[172:175], v[168:171], v[92:95]
  s_cmp_lt_u32 m0, s46
  s_cselect_b32 m0, m0, s47
  v_mfma_f32_16x16x32_bf16 v[96:99], a[176:179], v[168:171], v[96:99]
  v_mfma_f32_16x16x32_bf16 v[100:103], a[168:171], v[172:175], v[100:103]
  ds_read_b128 v[204:207], v19 offset:6144
  v_mfma_f32_16x16x32_bf16 v[104:107], a[172:175], v[172:175], v[104:107]
  v_mfma_f32_16x16x32_bf16 v[108:111], a[176:179], v[172:175], v[108:111]
  s_waitcnt vmcnt(8) lgkmcnt(2)
  s_barrier
  v_mfma_f32_16x16x32_bf16 v[64:67], a[180:183], v[192:195], v[64:67]
  ds_read_b128 v[160:163], v18 offset:0
  v_mfma_f32_16x16x32_bf16 v[68:71], a[184:187], v[192:195], v[68:71]
  v_mfma_f32_16x16x32_bf16 v[72:75], a[188:191], v[192:195], v[72:75]
  v_add_u32 v19, s33, v15
  s_add_u32 s33, s33, 8192
  v_mfma_f32_16x16x32_bf16 v[76:79], a[180:183], v[196:199], v[76:79]
  ds_read_b128 v[164:167], v18 offset:2048
  v_mfma_f32_16x16x32_bf16 v[80:83], a[184:187], v[196:199], v[80:83]
  buffer_load_dwordx4 v10, s[8:11], s30 offen offset:0 lds
  v_mfma_f32_16x16x32_bf16 v[84:87], a[188:191], v[196:199], v[84:87]
  s_waitcnt lgkmcnt(2)
  v_mfma_f32_16x16x32_bf16 v[88:91], a[180:183], v[200:203], v[88:91]
  ds_read_b128 v[168:171], v18 offset:4096
  v_mfma_f32_16x16x32_bf16 v[92:95], a[184:187], v[200:203], v[92:95]
  s_cmp_lt_u32 s33, 155648
  s_cselect_b32 s33, s33, 98304
  v_mfma_f32_16x16x32_bf16 v[96:99], a[188:191], v[200:203], v[96:99]
  v_mfma_f32_16x16x32_bf16 v[100:103], a[180:183], v[204:207], v[100:103]
  ds_read_b128 v[172:175], v18 offset:6144
  v_mfma_f32_16x16x32_bf16 v[104:107], a[184:187], v[204:207], v[104:107]
  v_mfma_f32_16x16x32_bf16 v[108:111], a[188:191], v[204:207], v[108:111]
  s_waitcnt lgkmcnt(2)
  v_mfma_f32_16x16x32_bf16 v[64:67], a[192:195], v[160:163], v[64:67]
  ds_read_b128 v[192:195], v19 offset:0
  v_mfma_f32_16x16x32_bf16 v[68:71], a[196:199], v[160:163], v[68:71]
  v_add_u32 v18, s33, v14
  v_mfma_f32_16x16x32_bf16 v[72:75], a[200:203], v[160:163], v[72:75]
  v_mfma_f32_16x16x32_bf16 v[76:79], a[192:195], v[164:167], v[76:79]
  ds_read_b128 v[196:199], v19 offset:2048
  v_mfma_f32_16x16x32_bf16 v[80:83], a[196:199], v[164:167], v[80:83]
  buffer_load_dwordx4 v11, s[8:11], s30 offen offset:1024 lds
  v_mfma_f32_16x16x32_bf16 v[84:87], a[200:203], v[164:167], v[84:87]
  s_waitcnt lgkmcnt(2)
  s_add_u32 s30, s30, 128
  v_mfma_f32_16x16x32_bf16 v[88:91], a[192:195], v[168:171], v[88:91]
  ds_read_b128 v[200:203], v19 offset:4096
  s_add_u32 m0, m0, 8192
  v_mfma_f32_16x16x32_bf16 v[92:95], a[196:199], v[168:171], v[92:95]
  s_cmp_lt_u32 m0, s46
  s_cselect_b32 m0, m0, s47
  v_mfma_f32_16x16x32_bf16 v[96:99], a[200:203], v[168:171], v[96:99]
  v_mfma_f32_16x16x32_bf16 v[100:103], a[192:195], v[172:175], v[100:103]
  ds_read_b128 v[204:207], v19 offset:6144
  v_mfma_f32_16x16x32_bf16 v[104:107], a[196:199], v[172:175], v[104:107]
  v_mfma_f32_16x16x32_bf16 v[108:111], a[200:203], v[172:175], v[108:111]
  s_waitcnt vmcnt(8) lgkmcnt(2)
  s_barrier
  v_mfma_f32_16x16x32_bf16 v[64:67], a[204:207], v[192:195], v[64:67]
  ds_read_b128 v[160:163], v18 offset:0
  v_mfma_f32_16x16x32_bf16 v[68:71], a[208:211], v[192:195], v[68:71]
  v_mfma_f32_16x16x32_bf16 v[72:75], a[212:215], v[192:195], v[72:75]
  v_add_u32 v19, s33, v15
  s_add_u32 s33, s33, 8192
  v_mfma_f32_16x16x32_bf16 v[76:79], a[204:207], v[196:199], v[76:79]
  ds_read_b128 v[164:167], v18 offset:2048
  v_mfma_f32_16x16x32_bf16 v[80:83], a[208:211], v[196:199], v[80:83]
  buffer_load_dwordx4 v10, s[8:11], s30 offen offset:0 lds
  v_mfma_f32_16x16x32_bf16 v[84:87], a[212:215], v[196:199], v[84:87]
  s_waitcnt lgkmcnt(2)
  v_mfma_f32_16x16x32_bf16 v[88:91], a[204:207], v[200:203], v[88:91]
  ds_read_b128 v[168:171], v18 offset:4096
  v_mfma_f32_16x16x32_bf16 v[92:95], a[208:211], v[200:203], v[92:95]
  s_cmp_lt_u32 s33, 155648
  s_cselect_b32 s33, s33, 98304
  v_mfma_f32_16x16x32_bf16 v[96:99], a[212:215], v[200:203], v[96:99]
  v_mfma_f32_16x16x32_bf16 v[100:103], a[204:207], v[204:207], v[100:103]
  ds_read_b128 v[172:175], v18 offset:6144
  v_mfma_f32_16x16x32_bf16 v[104:107], a[208:211], v[204:207], v[104:107]
  v_mfma_f32_16x16x32_bf16 v[108:111], a[212:215], v[204:207], v[108:111]
  s_waitcnt lgkmcnt(2)
  v_mfma_f32_16x16x32_bf16 v[64:67], a[216:219], v[160:163], v[64:67]
  ds_read_b128 v[192:195], v19 offset:0
  v_mfma_f32_16x16x32_bf16 v[68:71], a[220:223], v[160:163], v[68:71]
  v_add_u32 v18, s33, v14
  v_mfma_f32_16x16x32_bf16 v[72:75], a[224:227], v[160:163], v[72:75]
  v_mfma_f32_16x16x32_bf16 v[76:79], a[216:219], v[164:167], v[76:79]
  ds_read_b128 v[196:199], v19 offset:2048
  v_mfma_f32_16x16x32_bf16 v[80:83], a[220:223], v[164:167], v[80:83]
  buffer_load_dwordx4 v11, s[8:11], s30 offen offset:1024 lds
  v_mfma_f32_16x16x32_bf16 v[84:87], a[224:227], v[164:167], v[84:87]
  s_waitcnt lgkmcnt(2)
  s_add_u32 s30, s30, 128
  v_mfma_f32_16x16x32_bf16 v[88:91], a[216:219], v[168:171], v[88:91]
  ds_read_b128 v[200:203], v19 offset:4096
  s_add_u32 m0, m0, 8192
  v_mfma_f32_16x16x32_bf16 v[92:95], a[220:223], v[168:171], v[92:95]
  s_cmp_lt_u32 m0, s46
  s_cselect_b32 m0, m0, s47
  v_mfma_f32_16x16x32_bf16 v[96:99], a[224:227], v[168:171], v[96:99]
  v_mfma_f32_16x16x32_bf16 v[100:103], a[216:219], v[172:175], v[100:103]
  ds_read_b128 v[204:207], v19 offset:6144
  v_mfma_f32_16x16x32_bf16 v[104:107], a[220:223], v[172:175], v[104:107]
  v_mfma_f32_16x16x32_bf16 v[108:111], a[224:227], v[172:175], v[108:111]
  s_waitcnt vmcnt(8) lgkmcnt(2)
  s_barrier
  v_mfma_f32_16x16x32_bf16 v[64:67], a[228:231], v[192:195], v[64:67]
  ds_read_b128 v[160:163], v18 offset:0
  v_mfma_f32_16x16x32_bf16 v[68:71], a[232:235], v[192:195], v[68:71]
  v_mfma_f32_16x16x32_bf16 v[72:75], a[236:239], v[192:195], v[72:75]
  v_add_u32 v19, s33, v15
  s_add_u32 s33, s33, 8192
  v_mfma_f32_16x16x32_bf16 v[76:79], a[228:231], v[196:199], v[76:79]
  ds_read_b128 v[164:167], v18 offset:2048
  v_cvt_pk_bf16_f32 v224, v64, v65
  v_cvt_pk_bf16_f32 v225, v66, v67
  v_mfma_f32_16x16x32_bf16 v[80:83], a[232:235], v[196:199], v[80:83]
  buffer_load_dwordx4 v10, s[8:11], s30 offen offset:0 lds
  v_cvt_pk_bf16_f32 v226, v68, v69
  v_cvt_pk_bf16_f32 v227, v70, v71
  v_mfma_f32_16x16x32_bf16 v[84:87], a[236:239], v[196:199], v[84:87]
  s_waitcnt lgkmcnt(2)
  v_cvt_pk_bf16_f32 v228, v72, v73
  v_cvt_pk_bf16_f32 v229, v74, v75
  v_mfma_f32_16x16x32_bf16 v[88:91], a[228:231], v[200:203], v[88:91]
  ds_read_b128 v[168:171], v18 offset:4096
  ds_write_b64 v22, v[224:225] offset:0
  v_mfma_f32_16x16x32_bf16 v[92:95], a[232:235], v[200:203], v[92:95]
  s_cmp_lt_u32 s33, 155648
  s_cselect_b32 s33, s33, 98304
  ds_write_b64 v22, v[226:227] offset:8
  v_mfma_f32_16x16x32_bf16 v[96:99], a[236:239], v[200:203], v[96:99]
  ds_write_b64 v16, v[228:229] offset:64
  v_cvt_pk_bf16_f32 v230, v76, v77
  v_cvt_pk_bf16_f32 v231, v78, v79
  v_mfma_f32_16x16x32_bf16 v[100:103], a[228:231], v[204:207], v[100:103]
  ds_read_b128 v[172:175], v18 offset:6144
  v_cvt_pk_bf16_f32 v232, v80, v81
  v_cvt_pk_bf16_f32 v233, v82, v83
  v_cvt_pk_bf16_f32 v234, v84, v85
  v_mfma_f32_16x16x32_bf16 v[104:107], a[232:235], v[204:207], v[104:107]
  v_cvt_pk_bf16_f32 v235, v86, v87
  ds_write_b64 v22, v[230:231] offset:6400
  v_mfma_f32_16x16x32_bf16 v[108:111], a[236:239], v[204:207], v[108:111]
  ds_write_b64 v22, v[232:233] offset:6408
  ds_write_b64 v16, v[234:235] offset:6464
kvm_end_178:
  v_cvt_pk_bf16_f32 v236, v88, v89
  v_cvt_pk_bf16_f32 v237, v90, v91
  v_cvt_pk_bf16_f32 v238, v92, v93
  v_cvt_pk_bf16_f32 v239, v94, v95
  v_cvt_pk_bf16_f32 v240, v96, v97
  v_cvt_pk_bf16_f32 v241, v98, v99
  ds_write_b64 v22, v[236:237] offset:12800
  ds_write_b64 v22, v[238:239] offset:12808
  ds_write_b64 v16, v[240:241] offset:12864
  v_cvt_pk_bf16_f32 v242, v100, v101
  v_cvt_pk_bf16_f32 v243, v102, v103
  v_cvt_pk_bf16_f32 v244, v104, v105
  v_cvt_pk_bf16_f32 v245, v106, v107
  v_cvt_pk_bf16_f32 v246, v108, v109
  v_cvt_pk_bf16_f32 v247, v110, v111
  ds_write_b64 v22, v[242:243] offset:19200
  ds_write_b64 v22, v[244:245] offset:19208
  ds_write_b64 v16, v[246:247] offset:19264
  s_waitcnt lgkmcnt(0)
  s_barrier
  ds_read_b128 v[224:227], v23 offset:0
  ds_read_b128 v[228:231], v23 offset:64
  ds_read_b128 v[232:235], v23 offset:128
  ds_read_b128 v[236:239], v23 offset:192
  ds_read_b128 v[240:243], v23 offset:256
  ds_read_b128 v[244:247], v23 offset:320
  s_waitcnt lgkmcnt(0)
  s_add_u32 s21, s48, 0
  buffer_store_dwordx4 v[224:227], v26, s[16:19], s21 offen offset:0 sc1
  buffer_store_dwordx4 v[228:231], v26, s[16:19], s21 offen offset:1024 sc1
  buffer_store_dwordx4 v[232:235], v26, s[16:19], s21 offen offset:2048 sc1
  buffer_store_dwordx4 v[236:239], v26, s[16:19], s21 offen offset:3072 sc1
  s_add_u32 s21, s48, 4096
  buffer_store_dwordx4 v[240:243], v26, s[16:19], s21 offen offset:0 sc1
  buffer_store_dwordx4 v[244:247], v26, s[16:19], s21 offen offset:1024 sc1
  s_nop 1
  s_cmp_gt_u32 s26, 0
  s_cbranch_scc1 kvm_blk_177
  s_waitcnt vmcnt(6)
  s_barrier
  s_mov_b32 s24, 491520
  s_mov_b32 s25, 163840
  v_lshrrev_b32 v11, 3, v1
  v_and_b32 v12, 7, v1
  v_xor_b32 v12, v12, v11
  v_mul_u32_u24 v11, 1280, v11
  v_lshl_add_u32 v10, v12, 4, v11
  s_mul_i32 s46, s20, 40960
  v_add_u32 v10, s46, v10
  s_lshl_b32 s47, s20, 12
  s_add_u32 s47, s47, 0
  s_add_u32 s46, s47, 98304
  s_mov_b32 s30, s24
  s_add_u32 s32, s47, 32768
  v_add_u32 v11, 9216, v10
  v_add_u32 v12, 18432, v10
  v_add_u32 v13, 27648, v10
  s_mov_b32 m0, s32
  s_nop 0
  buffer_load_dwordx4 v10, s[8:11], s30 offen offset:0 lds
  buffer_load_dwordx4 v11, s[8:11], s30 offen offset:1024 lds
  buffer_load_dwordx4 v12, s[8:11], s30 offen offset:2048 lds
  buffer_load_dwordx4 v13, s[8:11], s30 offen offset:3072 lds
  s_add_u32 s30, s30, 128
  s_add_u32 s32, s32, 16384
  s_cmp_lt_u32 s32, s46
  s_cselect_b32 s32, s32, s47
  s_mov_b32 m0, s32
  s_nop 0
  buffer_load_dwordx4 v10, s[8:11], s30 offen offset:0 lds
  buffer_load_dwordx4 v11, s[8:11], s30 offen offset:1024 lds
  buffer_load_dwordx4 v12, s[8:11], s30 offen offset:2048 lds
  buffer_load_dwordx4 v13, s[8:11], s30 offen offset:3072 lds
  s_add_u32 s30, s30, 128
  s_add_u32 s32, s32, 16384
  s_cmp_lt_u32 s32, s46
  s_cselect_b32 s32, s32, s47
  s_mov_b32 m0, s32
  s_nop 0
  buffer_load_dwordx4 v10, s[8:11], s30 offen offset:0 lds
  buffer_load_dwordx4 v11, s[8:11], s30 offen offset:1024 lds
  buffer_load_dwordx4 v12, s[8:11], s30 offen offset:2048 lds
  buffer_load_dwordx4 v13, s[8:11], s30 offen offset:3072 lds
  s_add_u32 s30, s30, 128
  s_add_u32 s32, s32, 16384
  s_cmp_lt_u32 s32, s46
  s_cselect_b32 s32, s32, s47
  s_mov_b32 m0, s32
  s_nop 0
  buffer_load_dwordx4 v10, s[8:11], s30 offen offset:0 lds
  buffer_load_dwordx4 v11, s[8:11], s30 offen offset:1024 lds
  buffer_load_dwordx4 v12, s[8:11], s30 offen offset:2048 lds
  buffer_load_dwordx4 v13, s[8:11], s30 offen offset:3072 lds
  s_add_u32 s30, s30, 128
  s_add_u32 s32, s32, 16384
  s_cmp_lt_u32 s32, s46
  s_cselect_b32 s32, s32, s47
  s_waitcnt vmcnt(16)
  s_barrier
  s_cmp_lg_u32 s20, 0
  s_cbranch_scc1 af_182
  v_mov_b32 v4, 0
  v_mov_b32 v5, 1
  s_mov_b64 exec, 1
  buffer_atomic_add v5, v4, s[72:75], s61 offen sc1
  s_mov_b64 exec, -1
  s_nop 1
af_182:
  s_mov_b32 s26, 13
  s_mov_b32 s28, 1572864
kv_main:
  v_and_b32 v6, 7, v2
  v_add_u32 v4, 0, v3
  v_xor_b32 v4, v4, v6
  v_lshlrev_b32 v4, 4, v4
  v_lshl_add_u32 v14, v2, 7, v4
  v_add_u32 v4, 4, v3
  v_xor_b32 v4, v4, v6
  v_lshlrev_b32 v4, 4, v4
  v_lshl_add_u32 v15, v2, 7, v4
  v_mul_u32_u24 v22, 400, v2
  v_mul_u32_u24 v4, 16, v3
  s_mul_i32 s21, s20, 96
  s_add_u32 s21, s21, 98304
  v_add3_u32 v22, v22, v4, s21
  v_lshlrev_b32 v4, 3, v3
  v_sub_u32 v16, v22, v4
  v_mov_b32 v9, 2731
  s_mul_i32 s21, s20, 12800
  s_add_u32 s21, s21, 98304
  v_mul_u32_u24 v4, 400, v2
  v_lshlrev_b32 v5, 4, v3
  v_add3_u32 v23, v4, v5, s21
  v_lshlrev_b32 v26, 4, v1
  s_mov_b32 s33, 32768
  s_mov_b32 s48, 0x80000000
  s_mov_b32 m0, s32
  s_nop 0
  buffer_load_dwordx4 v10, s[8:11], s30 offen offset:0 lds
  buffer_load_dwordx4 v11, s[8:11], s30 offen offset:1024 lds
  s_waitcnt vmcnt(14)
  s_barrier
  v_add_u32 v18, s33, v14
  v_add_u32 v19, s33, v15
  s_add_u32 s33, s33, 16384
  s_cmp_lt_u32 s33, 98304
  s_cselect_b32 s33, s33, 0
  ds_read_b128 v[160:163], v18 offset:0
  ds_read_b128 v[164:167], v18 offset:2048
  ds_read_b128 v[168:171], v18 offset:4096
  ds_read_b128 v[172:175], v18 offset:6144
  ds_read_b128 v[176:179], v18 offset:8192
  ds_read_b128 v[180:183], v18 offset:10240
  ds_read_b128 v[184:187], v18 offset:12288
  ds_read_b128 v[188:191], v18 offset:14336
  s_waitcnt lgkmcnt(0)
kv_blk_185:
  v_mfma_f32_16x16x32_bf16 v[64:67], a[0:3], v[160:163], 0
  ds_read_b128 v[192:195], v19 offset:0
  v_mfma_f32_16x16x32_bf16 v[68:71], a[4:7], v[160:163], 0
  v_add_u32 v18, s33, v14
  v_mfma_f32_16x16x32_bf16 v[72:75], a[8:11], v[160:163], 0
  ds_write_b64 v16, v[234:235] offset:6464
  v_mfma_f32_16x16x32_bf16 v[76:79], a[0:3], v[164:167], 0
  ds_read_b128 v[196:199], v19 offset:2048
  v_cvt_pk_bf16_f32 v236, v88, v89
  v_mfma_f32_16x16x32_bf16 v[80:83], a[4:7], v[164:167], 0
  buffer_load_dwordx4 v12, s[8:11], s30 offen offset:2048 lds
  v_mfma_f32_16x16x32_bf16 v[84:87], a[8:11], v[164:167], 0
  v_cvt_pk_bf16_f32 v237, v90, v91
  v_cvt_pk_bf16_f32 v238, v92, v93
  v_mfma_f32_16x16x32_bf16 v[88:91], a[0:3], v[168:171], 0
  ds_read_b128 v[200:203], v19 offset:4096
  v_cvt_pk_bf16_f32 v239, v94, v95
  v_mfma_f32_16x16x32_bf16 v[92:95], a[4:7], v[168:171], 0
  v_cvt_pk_bf16_f32 v240, v96, v97
  v_cvt_pk_bf16_f32 v241, v98, v99
  v_mfma_f32_16x16x32_bf16 v[96:99], a[8:11], v[168:171], 0
  ds_write_b64 v22, v[236:237] offset:12800
  ds_write_b64 v22, v[238:239] offset:12808
  ds_write_b64 v16, v[240:241] offset:12864
  v_cvt_pk_bf16_f32 v242, v100, v101
  v_cvt_pk_bf16_f32 v243, v102, v103
  v_mfma_f32_16x16x32_bf16 v[100:103], a[0:3], v[172:175], 0
  ds_read_b128 v[204:207], v19 offset:6144
  v_cvt_pk_bf16_f32 v244, v104, v105
  v_cvt_pk_bf16_f32 v245, v106, v107
  v_mfma_f32_16x16x32_bf16 v[104:107], a[4:7], v[172:175], 0
  v_cvt_pk_bf16_f32 v246, v108, v109
  v_cvt_pk_bf16_f32 v247, v110, v111
  v_mfma_f32_16x16x32_bf16 v[108:111], a[8:11], v[172:175], 0
  s_waitcnt lgkmcnt(9)
  ds_write_b64 v22, v[242:243] offset:19200
  ds_write_b64 v22, v[244:245] offset:19208
  ds_write_b64 v16, v[246:247] offset:19264
  v_cvt_pk_bf16_f32 v224, v112, v113
  v_cvt_pk_bf16_f32 v225, v114, v115
  v_mfma_f32_16x16x32_bf16 v[112:115], a[0:3], v[176:179], 0
  ds_read_b128 v[208:211], v19 offset:8192
  v_cvt_pk_bf16_f32 v226, v116, v117
  v_cvt_pk_bf16_f32 v227, v118, v119
  v_mfma_f32_16x16x32_bf16 v[116:119], a[4:7], v[176:179], 0
  v_cvt_pk_bf16_f32 v228, v120, v121
  v_cvt_pk_bf16_f32 v229, v122, v123
  v_mfma_f32_16x16x32_bf16 v[120:123], a[8:11], v[176:179], 0
  ds_write_b64 v22, v[224:225] offset:25600
  ds_write_b64 v22, v[226:227] offset:25608
  ds_write_b64 v16, v[228:229] offset:25664
  v_cvt_pk_bf16_f32 v230, v124, v125
  v_cvt_pk_bf16_f32 v231, v126, v127
  v_mfma_f32_16x16x32_bf16 v[124:127], a[0:3], v[180:183], 0
  ds_read_b128 v[212:215], v19 offset:10240
  v_cvt_pk_bf16_f32 v232, v128, v129
  v_cvt_pk_bf16_f32 v233, v130, v131
  v_mfma_f32_16x16x32_bf16 v[128:131], a[4:7], v[180:183], 0
  buffer_load_dwordx4 v13, s[8:11], s30 offen offset:3072 lds
  v_cvt_pk_bf16_f32 v234, v132, v133
  v_cvt_pk_bf16_f32 v235, v134, v135
  v_mfma_f32_16x16x32_bf16 v[132:135], a[8:11], v[180:183], 0
  s_add_u32 s30, s30, 128
  s_add_u32 m0, m0, 16384
  ds_write_b64 v22, v[230:231] offset:32000
  ds_write_b64 v22, v[232:233] offset:32008
  ds_write_b64 v16, v[234:235] offset:32064
  v_cvt_pk_bf16_f32 v236, v136, v137
  v_cvt_pk_bf16_f32 v237, v138, v139
  v_mfma_f32_16x16x32_bf16 v[136:139], a[0:3], v[184:187], 0
  ds_read_b128 v[216:219], v19 offset:12288
  v_cvt_pk_bf16_f32 v238, v140, v141
  v_cvt_pk_bf16_f32 v239, v142, v143
  v_mfma_f32_16x16x32_bf16 v[140:143], a[4:7], v[184:187], 0
  s_cmp_lt_u32 m0, s46
  s_cselect_b32 m0, m0, s47
  v_cvt_pk_bf16_f32 v240, v144, v145
  v_cvt_pk_bf16_f32 v241, v146, v147
  v_mfma_f32_16x16x32_bf16 v[144:147], a[8:11], v[184:187], 0
  ds_write_b64 v22, v[236:237] offset:38400
  ds_write_b64 v22, v[238:239] offset:38408
  ds_write_b64 v16, v[240:241] offset:38464
  v_cvt_pk_bf16_f32 v242, v148, v149
  v_cvt_pk_bf16_f32 v243, v150, v151
  v_mfma_f32_16x16x32_bf16 v[148:151], a[0:3], v[188:191], 0
  ds_read_b128 v[220:223], v19 offset:14336
  v_cvt_pk_bf16_f32 v244, v152, v153
  v_cvt_pk_bf16_f32 v245, v154, v155
  v_mfma_f32_16x16x32_bf16 v[152:155], a[4:7], v[188:191], 0
  v_cvt_pk_bf16_f32 v246, v156, v157
  v_cvt_pk_bf16_f32 v247, v158, v159
  v_mfma_f32_16x16x32_bf16 v[156:159], a[8:11], v[188:191], 0
  s_waitcnt vmcnt(12) lgkmcnt(15)
  s_barrier
  v_mfma_f32_16x16x32_bf16 v[64:67], a[12:15], v[192:195], v[64:67]
  ds_read_b128 v[160:163], v18 offset:0
  v_mfma_f32_16x16x32_bf16 v[68:71], a[16:19], v[192:195], v[68:71]
  ds_write_b64 v22, v[242:243] offset:44800
  v_mfma_f32_16x16x32_bf16 v[72:75], a[20:23], v[192:195], v[72:75]
  v_add_u32 v19, s33, v15
  s_add_u32 s33, s33, 16384
  v_mfma_f32_16x16x32_bf16 v[76:79], a[12:15], v[196:199], v[76:79]
  ds_read_b128 v[164:167], v18 offset:2048
  v_mfma_f32_16x16x32_bf16 v[80:83], a[16:19], v[196:199], v[80:83]
  buffer_load_dwordx4 v10, s[8:11], s30 offen offset:0 lds
  v_mfma_f32_16x16x32_bf16 v[84:87], a[20:23], v[196:199], v[84:87]
  s_cmp_lt_u32 s33, 98304
  s_cselect_b32 s33, s33, 0
  v_mfma_f32_16x16x32_bf16 v[88:91], a[12:15], v[200:203], v[88:91]
  ds_read_b128 v[168:171], v18 offset:4096
  v_mfma_f32_16x16x32_bf16 v[92:95], a[16:19], v[200:203], v[92:95]
  ds_write_b64 v22, v[244:245] offset:44808
  v_mfma_f32_16x16x32_bf16 v[96:99], a[20:23], v[200:203], v[96:99]
  ds_write_b64 v16, v[246:247] offset:44864
  v_mfma_f32_16x16x32_bf16 v[100:103], a[12:15], v[204:207], v[100:103]
  ds_read_b128 v[172:175], v18 offset:6144
  v_mfma_f32_16x16x32_bf16 v[104:107], a[16:19], v[204:207], v[104:107]
  v_mfma_f32_16x16x32_bf16 v[108:111], a[20:23], v[204:207], v[108:111]
  s_waitcnt lgkmcnt(7)
  v_mfma_f32_16x16x32_bf16 v[112:115], a[12:15], v[208:211], v[112:115]
  ds_read_b128 v[176:179], v18 offset:8192
  v_mfma_f32_16x16x32_bf16 v[116:119], a[16:19], v[208:211], v[116:119]
  v_mfma_f32_16x16x32_bf16 v[120:123], a[20:23], v[208:211], v[120:123]
  v_mfma_f32_16x16x32_bf16 v[124:127], a[12:15], v[212:215], v[124:127]
  ds_read_b128 v[180:183], v18 offset:10240
  v_mfma_f32_16x16x32_bf16 v[128:131], a[16:19], v[212:215], v[128:131]
  buffer_load_dwordx4 v11, s[8:11], s30 offen offset:1024 lds
  v_mfma_f32_16x16x32_bf16 v[132:135], a[20:23], v[212:215], v[132:135]
  v_mfma_f32_16x16x32_bf16 v[136:139], a[12:15], v[216:219], v[136:139]
  ds_read_b128 v[184:187], v18 offset:12288
  v_mfma_f32_16x16x32_bf16 v[140:143], a[16:19], v[216:219], v[140:143]
  v_mfma_f32_16x16x32_bf16 v[144:147], a[20:23], v[216:219], v[144:147]
  v_mfma_f32_16x16x32_bf16 v[148:151], a[12:15], v[220:223], v[148:151]
  ds_read_b128 v[188:191], v18 offset:14336
  v_mfma_f32_16x16x32_bf16 v[152:155], a[16:19], v[220:223], v[152:155]
  v_mfma_f32_16x16x32_bf16 v[156:159], a[20:23], v[220:223], v[156:159]
  s_waitcnt lgkmcnt(4)
  v_mfma_f32_16x16x32_bf16 v[64:67], a[24:27], v[160:163], v[64:67]
  ds_read_b128 v[192:195], v19 offset:0
  v_mfma_f32_16x16x32_bf16 v[68:71], a[28:31], v[160:163], v[68:71]
  v_add_u32 v18, s33, v14
  v_mfma_f32_16x16x32_bf16 v[72:75], a[32:35], v[160:163], v[72:75]
  v_mfma_f32_16x16x32_bf16 v[76:79], a[24:27], v[164:167], v[76:79]
  ds_read_b128 v[196:199], v19 offset:2048
  v_mfma_f32_16x16x32_bf16 v[80:83], a[28:31], v[164:167], v[80:83]
  buffer_load_dwordx4 v12, s[8:11], s30 offen offset:2048 lds
  v_mfma_f32_16x16x32_bf16 v[84:87], a[32:35], v[164:167], v[84:87]
  v_mfma_f32_16x16x32_bf16 v[88:91], a[24:27], v[168:171], v[88:91]
  ds_read_b128 v[200:203], v19 offset:4096
  v_mfma_f32_16x16x32_bf16 v[92:95], a[28:31], v[168:171], v[92:95]
  v_mfma_f32_16x16x32_bf16 v[96:99], a[32:35], v[168:171], v[96:99]
  v_mfma_f32_16x16x32_bf16 v[100:103], a[24:27], v[172:175], v[100:103]
  ds_read_b128 v[204:207], v19 offset:6144
  v_mfma_f32_16x16x32_bf16 v[104:107], a[28:31], v[172:175], v[104:107]
  v_mfma_f32_16x16x32_bf16 v[108:111], a[32:35], v[172:175], v[108:111]
  s_waitcnt lgkmcnt(4)
  v_mfma_f32_16x16x32_bf16 v[112:115], a[24:27], v[176:179], v[112:115]
  ds_read_b128 v[208:211], v19 offset:8192
  v_mfma_f32_16x16x32_bf16 v[116:119], a[28:31], v[176:179], v[116:119]
  v_mfma_f32_16x16x32_bf16 v[120:123], a[32:35], v[176:179], v[120:123]
  v_mfma_f32_16x16x32_bf16 v[124:127], a[24:27], v[180:183], v[124:127]
  ds_read_b128 v[212:215], v19 offset:10240
  v_mfma_f32_16x16x32_bf16 v[128:131], a[28:31], v[180:183], v[128:131]
  buffer_load_dwordx4 v13, s[8:11], s30 offen offset:3072 lds
  v_mfma_f32_16x16x32_bf16 v[132:135], a[32:35], v[180:183], v[132:135]
  s_add_u32 s30, s30, 128
  s_add_u32 m0, m0, 16384
  v_mfma_f32_16x16x32_bf16 v[136:139], a[24:27], v[184:187], v[136:139]
  ds_read_b128 v[216:219], v19 offset:12288
  v_mfma_f32_16x16x32_bf16 v[140:143], a[28:31], v[184:187], v[140:143]
  s_cmp_lt_u32 m0, s46
  s_cselect_b32 m0, m0, s47
  v_mfma_f32_16x16x32_bf16 v[144:147], a[32:35], v[184:187], v[144:147]
  v_mfma_f32_16x16x32_bf16 v[148:151], a[24:27], v[188:191], v[148:151]
  ds_read_b128 v[220:223], v19 offset:14336
  v_mfma_f32_16x16x32_bf16 v[152:155], a[28:31], v[188:191], v[152:155]
  v_mfma_f32_16x16x32_bf16 v[156:159], a[32:35], v[188:191], v[156:159]
  s_waitcnt vmcnt(12) lgkmcnt(4)
  s_barrier
  v_mfma_f32_16x16x32_bf16 v[64:67], a[36:39], v[192:195], v[64:67]
  ds_read_b128 v[160:163], v18 offset:0
  v_mfma_f32_16x16x32_bf16 v[68:71], a[40:43], v[192:195], v[68:71]
  v_mfma_f32_16x16x32_bf16 v[72:75], a[44:47], v[192:195], v[72:75]
  v_add_u32 v19, s33, v15
  s_add_u32 s33, s33, 16384
  v_mfma_f32_16x16x32_bf16 v[76:79], a[36:39], v[196:199], v[76:79]
  ds_read_b128 v[164:167], v18 offset:2048
  v_mfma_f32_16x16x32_bf16 v[80:83], a[40:43], v[196:199], v[80:83]
  buffer_load_dwordx4 v10, s[8:11], s30 offen offset:0 lds
  v_mfma_f32_16x16x32_bf16 v[84:87], a[44:47], v[196:199], v[84:87]
  s_cmp_lt_u32 s33, 98304
  s_cselect_b32 s33, s33, 0
  v_mfma_f32_16x16x32_bf16 v[88:91], a[36:39], v[200:203], v[88:91]
  ds_read_b128 v[168:171], v18 offset:4096
  v_mfma_f32_16x16x32_bf16 v[92:95], a[40:43], v[200:203], v[92:95]
  ds_read_b128 v[224:227], v23 offset:0
  v_mfma_f32_16x16x32_bf16 v[96:99], a[44:47], v[200:203], v[96:99]
  v_mfma_f32_16x16x32_bf16 v[100:103], a[36:39], v[204:207], v[100:103]
  ds_read_b128 v[172:175], v18 offset:6144
  v_mfma_f32_16x16x32_bf16 v[104:107], a[40:43], v[204:207], v[104:107]
  v_mfma_f32_16x16x32_bf16 v[108:111], a[44:47], v[204:207], v[108:111]
  s_waitcnt lgkmcnt(5)
  v_mfma_f32_16x16x32_bf16 v[112:115], a[36:39], v[208:211], v[112:115]
  ds_read_b128 v[176:179], v18 offset:8192
  v_mfma_f32_16x16x32_bf16 v[116:119], a[40:43], v[208:211], v[116:119]
  v_mfma_f32_16x16x32_bf16 v[120:123], a[44:47], v[208:211], v[120:123]
  v_mfma_f32_16x16x32_bf16 v[124:127], a[36:39], v[212:215], v[124:127]
  ds_read_b128 v[180:183], v18 offset:10240
  v_mfma_f32_16x16x32_bf16 v[128:131], a[40:43], v[212:215], v[128:131]
  buffer_load_dwordx4 v11, s[8:11], s30 offen offset:1024 lds
  v_mfma_f32_16x16x32_bf16 v[132:135], a[44:47], v[212:215], v[132:135]
  v_mfma_f32_16x16x32_bf16 v[136:139], a[36:39], v[216:219], v[136:139]
  ds_read_b128 v[184:187], v18 offset:12288
  v_mfma_f32_16x16x32_bf16 v[140:143], a[40:43], v[216:219], v[140:143]
  ds_read_b128 v[228:231], v23 offset:64
  v_mfma_f32_16x16x32_bf16 v[144:147], a[44:47], v[216:219], v[144:147]
  v_mfma_f32_16x16x32_bf16 v[148:151], a[36:39], v[220:223], v[148:151]
  ds_read_b128 v[188:191], v18 offset:14336
  v_mfma_f32_16x16x32_bf16 v[152:155], a[40:43], v[220:223], v[152:155]
  v_mfma_f32_16x16x32_bf16 v[156:159], a[44:47], v[220:223], v[156:159]
  s_waitcnt lgkmcnt(5)
  v_mfma_f32_16x16x32_bf16 v[64:67], a[48:51], v[160:163], v[64:67]
  ds_read_b128 v[192:195], v19 offset:0
  v_mfma_f32_16x16x32_bf16 v[68:71], a[52:55], v[160:163], v[68:71]
  v_add_u32 v18, s33, v14
  v_mfma_f32_16x16x32_bf16 v[72:75], a[56:59], v[160:163], v[72:75]
  v_mfma_f32_16x16x32_bf16 v[76:79], a[48:51], v[164:167], v[76:79]
  ds_read_b128 v[196:199], v19 offset:2048
  v_mfma_f32_16x16x32_bf16 v[80:83], a[52:55], v[164:167], v[80:83]
  buffer_load_dwordx4 v12, s[8:11], s30 offen offset:2048 lds
  v_mfma_f32_16x16x32_bf16 v[84:87], a[56:59], v[164:167], v[84:87]
  v_mfma_f32_16x16x32_bf16 v[88:91], a[48:51], v[168:171], v[88:91]
  ds_read_b128 v[200:203], v19 offset:4096
  v_mfma_f32_16x16x32_bf16 v[92:95], a[52:55], v[168:171], v[92:95]
  s_add_u32 s21, s48, 0
  ds_read_b128 v[232:235], v23 offset:128
  v_mfma_f32_16x16x32_bf16 v[96:99], a[56:59], v[168:171], v[96:99]
  v_mfma_f32_16x16x32_bf16 v[100:103], a[48:51], v[172:175], v[100:103]
  ds_read_b128 v[204:207], v19 offset:6144
  v_mfma_f32_16x16x32_bf16 v[104:107], a[52:55], v[172:175], v[104:107]
  buffer_store_dwordx4 v[224:227], v26, s[16:19], s21 offen offset:0 sc1
  v_mfma_f32_16x16x32_bf16 v[108:111], a[56:59], v[172:175], v[108:111]
  s_waitcnt lgkmcnt(5)
  v_mfma_f32_16x16x32_bf16 v[112:115], a[48:51], v[176:179], v[112:115]
  ds_read_b128 v[208:211], v19 offset:8192
  v_mfma_f32_16x16x32_bf16 v[116:119], a[52:55], v[176:179], v[116:119]
  v_mfma_f32_16x16x32_bf16 v[120:123], a[56:59], v[176:179], v[120:123]
  v_mfma_f32_16x16x32_bf16 v[124:127], a[48:51], v[180:183], v[124:127]
  ds_read_b128 v[212:215], v19 offset:10240
  v_mfma_f32_16x16x32_bf16 v[128:131], a[52:55], v[180:183], v[128:131]
  buffer_load_dwordx4 v13, s[8:11], s30 offen offset:3072 lds
  v_mfma_f32_16x16x32_bf16 v[132:135], a[56:59], v[180:183], v[132:135]
  s_add_u32 s30, s30, 128
  s_add_u32 m0, m0, 16384
  v_mfma_f32_16x16x32_bf16 v[136:139], a[48:51], v[184:187], v[136:139]
  ds_read_b128 v[216:219], v19 offset:12288
  v_mfma_f32_16x16x32_bf16 v[140:143], a[52:55], v[184:187], v[140:143]
  s_cmp_lt_u32 m0, s46
  s_cselect_b32 m0, m0, s47
  v_mfma_f32_16x16x32_bf16 v[144:147], a[56:59], v[184:187], v[144:147]
  ds_read_b128 v[236:239], v23 offset:192
  v_mfma_f32_16x16x32_bf16 v[148:151], a[48:51], v[188:191], v[148:151]
  ds_read_b128 v[220:223], v19 offset:14336
  v_mfma_f32_16x16x32_bf16 v[152:155], a[52:55], v[188:191], v[152:155]
  buffer_store_dwordx4 v[228:231], v26, s[16:19], s21 offen offset:1024 sc1
  v_mfma_f32_16x16x32_bf16 v[156:159], a[56:59], v[188:191], v[156:159]
  s_waitcnt vmcnt(14) lgkmcnt(5)
  s_barrier
  v_mfma_f32_16x16x32_bf16 v[64:67], a[60:63], v[192:195], v[64:67]
  ds_read_b128 v[160:163], v18 offset:0
  v_mfma_f32_16x16x32_bf16 v[68:71], a[64:67], v[192:195], v[68:71]
  v_mfma_f32_16x16x32_bf16 v[72:75], a[68:71], v[192:195], v[72:75]
  v_add_u32 v19, s33, v15
  s_add_u32 s33, s33, 16384
  v_mfma_f32_16x16x32_bf16 v[76:79], a[60:63], v[196:199], v[76:79]
  ds_read_b128 v[164:167], v18 offset:2048
  v_mfma_f32_16x16x32_bf16 v[80:83], a[64:67], v[196:199], v[80:83]
  buffer_load_dwordx4 v10, s[8:11], s30 offen offset:0 lds
  v_mfma_f32_16x16x32_bf16 v[84:87], a[68:71], v[196:199], v[84:87]
  s_cmp_lt_u32 s33, 98304
  s_cselect_b32 s33, s33, 0
  v_mfma_f32_16x16x32_bf16 v[88:91], a[60:63], v[200:203], v[88:91]
  ds_read_b128 v[168:171], v18 offset:4096
  v_mfma_f32_16x16x32_bf16 v[92:95], a[64:67], v[200:203], v[92:95]
  ds_read_b128 v[240:243], v23 offset:256
  v_mfma_f32_16x16x32_bf16 v[96:99], a[68:71], v[200:203], v[96:99]
  v_mfma_f32_16x16x32_bf16 v[100:103], a[60:63], v[204:207], v[100:103]
  ds_read_b128 v[172:175], v18 offset:6144
  v_mfma_f32_16x16x32_bf16 v[104:107], a[64:67], v[204:207], v[104:107]
  buffer_store_dwordx4 v[232:235], v26, s[16:19], s21 offen offset:2048 sc1
  v_mfma_f32_16x16x32_bf16 v[108:111], a[68:71], v[204:207], v[108:111]
  s_waitcnt lgkmcnt(5)
  v_mfma_f32_16x16x32_bf16 v[112:115], a[60:63], v[208:211], v[112:115]
  ds_read_b128 v[176:179], v18 offset:8192
  v_mfma_f32_16x16x32_bf16 v[116:119], a[64:67], v[208:211], v[116:119]
  v_mfma_f32_16x16x32_bf16 v[120:123], a[68:71], v[208:211], v[120:123]
  v_mfma_f32_16x16x32_bf16 v[124:127], a[60:63], v[212:215], v[124:127]
  ds_read_b128 v[180:183], v18 offset:10240
  v_mfma_f32_16x16x32_bf16 v[128:131], a[64:67], v[212:215], v[128:131]
  buffer_load_dwordx4 v11, s[8:11], s30 offen offset:1024 lds
  v_mfma_f32_16x16x32_bf16 v[132:135], a[68:71], v[212:215], v[132:135]
  v_mfma_f32_16x16x32_bf16 v[136:139], a[60:63], v[216:219], v[136:139]
  ds_read_b128 v[184:187], v18 offset:12288
  v_mfma_f32_16x16x32_bf16 v[140:143], a[64:67], v[216:219], v[140:143]
  ds_read_b128 v[244:247], v23 offset:320
  v_mfma_f32_16x16x32_bf16 v[144:147], a[68:71], v[216:219], v[144:147]
  v_mfma_f32_16x16x32_bf16 v[148:151], a[60:63], v[220:223], v[148:151]
  ds_read_b128 v[188:191], v18 offset:14336
  v_mfma_f32_16x16x32_bf16 v[152:155], a[64:67], v[220:223], v[152:155]
  buffer_store_dwordx4 v[236:239], v26, s[16:19], s21 offen offset:3072 sc1
  v_mfma_f32_16x16x32_bf16 v[156:159], a[68:71], v[220:223], v[156:159]
  s_waitcnt lgkmcnt(5)
  v_mfma_f32_16x16x32_bf16 v[64:67], a[72:75], v[160:163], v[64:67]
  ds_read_b128 v[192:195], v19 offset:0
  v_mfma_f32_16x16x32_bf16 v[68:71], a[76:79], v[160:163], v[68:71]
  v_add_u32 v18, s33, v14
  v_mfma_f32_16x16x32_bf16 v[72:75], a[80:83], v[160:163], v[72:75]
  v_mfma_f32_16x16x32_bf16 v[76:79], a[72:75], v[164:167], v[76:79]
  ds_read_b128 v[196:199], v19 offset:2048
  v_mfma_f32_16x16x32_bf16 v[80:83], a[76:79], v[164:167], v[80:83]
  buffer_load_dwordx4 v12, s[8:11], s30 offen offset:2048 lds
  v_mfma_f32_16x16x32_bf16 v[84:87], a[80:83], v[164:167], v[84:87]
  v_mfma_f32_16x16x32_bf16 v[88:91], a[72:75], v[168:171], v[88:91]
  ds_read_b128 v[200:203], v19 offset:4096
  v_mfma_f32_16x16x32_bf16 v[92:95], a[76:79], v[168:171], v[92:95]
  s_add_u32 s21, s48, 4096
  ds_read_b128 v[224:227], v23 offset:6400
  v_mfma_f32_16x16x32_bf16 v[96:99], a[80:83], v[168:171], v[96:99]
  v_mfma_f32_16x16x32_bf16 v[100:103], a[72:75], v[172:175], v[100:103]
  ds_read_b128 v[204:207], v19 offset:6144
  v_mfma_f32_16x16x32_bf16 v[104:107], a[76:79], v[172:175], v[104:107]
  buffer_store_dwordx4 v[240:243], v26, s[16:19], s21 offen offset:0 sc1
  v_mfma_f32_16x16x32_bf16 v[108:111], a[80:83], v[172:175], v[108:111]
  s_waitcnt lgkmcnt(5)
  v_mfma_f32_16x16x32_bf16 v[112:115], a[72:75], v[176:179], v[112:115]
  ds_read_b128 v[208:211], v19 offset:8192
  v_mfma_f32_16x16x32_bf16 v[116:119], a[76:79], v[176:179], v[116:119]
  v_mfma_f32_16x16x32_bf16 v[120:123], a[80:83], v[176:179], v[120:123]
  v_mfma_f32_16x16x32_bf16 v[124:127], a[72:75], v[180:183], v[124:127]
  ds_read_b128 v[212:215], v19 offset:10240
  v_mfma_f32_16x16x32_bf16 v[128:131], a[76:79], v[180:183], v[128:131]
  buffer_load_dwordx4 v13, s[8:11], s30 offen offset:3072 lds
  v_mfma_f32_16x16x32_bf16 v[132:135], a[80:83], v[180:183], v[132:135]
  s_add_u32 s30, s30, 128
  s_add_u32 m0, m0, 16384
  v_mfma_f32_16x16x32_bf16 v[136:139], a[72:75], v[184:187], v[136:139]
  ds_read_b128 v[216:219], v19 offset:12288
  v_mfma_f32_16x16x32_bf16 v[140:143], a[76:79], v[184:187], v[140:143]
  s_cmp_lt_u32 m0, s46
  s_cselect_b32 m0, m0, s47
  v_mfma_f32_16x16x32_bf16 v[144:147], a[80:83], v[184:187], v[144:147]
  ds_read_b128 v[228:231], v23 offset:6464
  v_mfma_f32_16x16x32_bf16 v[148:151], a[72:75], v[188:191], v[148:151]
  ds_read_b128 v[220:223], v19 offset:14336
  v_mfma_f32_16x16x32_bf16 v[152:155], a[76:79], v[188:191], v[152:155]
  buffer_store_dwordx4 v[244:247], v26, s[16:19], s21 offen offset:1024 sc1
  v_mfma_f32_16x16x32_bf16 v[156:159], a[80:83], v[188:191], v[156:159]
  s_waitcnt vmcnt(18) lgkmcnt(5)
  s_barrier
  v_mfma_f32_16x16x32_bf16 v[64:67], a[84:87], v[192:195], v[64:67]
  ds_read_b128 v[160:163], v18 offset:0
  v_mfma_f32_16x16x32_bf16 v[68:71], a[88:91], v[192:195], v[68:71]
  v_mfma_f32_16x16x32_bf16 v[72:75], a[92:95], v[192:195], v[72:75]
  v_add_u32 v19, s33, v15
  s_add_u32 s33, s33, 16384
  v_mfma_f32_16x16x32_bf16 v[76:79], a[84:87], v[196:199], v[76:79]
  ds_read_b128 v[164:167], v18 offset:2048
  v_mfma_f32_16x16x32_bf16 v[80:83], a[88:91], v[196:199], v[80:83]
  buffer_load_dwordx4 v10, s[8:11], s30 offen offset:0 lds
  v_mfma_f32_16x16x32_bf16 v[84:87], a[92:95], v[196:199], v[84:87]
  s_cmp_lt_u32 s33, 98304
  s_cselect_b32 s33, s33, 0
  v_mfma_f32_16x16x32_bf16 v[88:91], a[84:87], v[200:203], v[88:91]
  ds_read_b128 v[168:171], v18 offset:4096
  v_mfma_f32_16x16x32_bf16 v[92:95], a[88:91], v[200:203], v[92:95]
  ds_read_b128 v[232:235], v23 offset:6528
  v_mfma_f32_16x16x32_bf16 v[96:99], a[92:95], v[200:203], v[96:99]
  v_mfma_f32_16x16x32_bf16 v[100:103], a[84:87], v[204:207], v[100:103]
  ds_read_b128 v[172:175], v18 offset:6144
  v_mfma_f32_16x16x32_bf16 v[104:107], a[88:91], v[204:207], v[104:107]
  buffer_store_dwordx4 v[224:227], v26, s[16:19], s21 offen offset:2048 sc1
  v_mfma_f32_16x16x32_bf16 v[108:111], a[92:95], v[204:207], v[108:111]
  s_waitcnt lgkmcnt(5)
  v_mfma_f32_16x16x32_bf16 v[112:115], a[84:87], v[208:211], v[112:115]
  ds_read_b128 v[176:179], v18 offset:8192
  v_mfma_f32_16x16x32_bf16 v[116:119], a[88:91], v[208:211], v[116:119]
  v_mfma_f32_16x16x32_bf16 v[120:123], a[92:95], v[208:211], v[120:123]
  v_mfma_f32_16x16x32_bf16 v[124:127], a[84:87], v[212:215], v[124:127]
  ds_read_b128 v[180:183], v18 offset:10240
  v_mfma_f32_16x16x32_bf16 v[128:131], a[88:91], v[212:215], v[128:131]
  buffer_load_dwordx4 v11, s[8:11], s30 offen offset:1024 lds
  v_mfma_f32_16x16x32_bf16 v[132:135], a[92:95], v[212:215], v[132:135]
  v_mfma_f32_16x16x32_bf16 v[136:139], a[84:87], v[216:219], v[136:139]
  ds_read_b128 v[184:187], v18 offset:12288
  v_mfma_f32_16x16x32_bf16 v[140:143], a[88:91], v[216:219], v[140:143]
  ds_read_b128 v[236:239], v23 offset:6592
  v_mfma_f32_16x16x32_bf16 v[144:147], a[92:95], v[216:219], v[144:147]
  v_mfma_f32_16x16x32_bf16 v[148:151], a[84:87], v[220:223], v[148:151]
  ds_read_b128 v[188:191], v18 offset:14336
  v_mfma_f32_16x16x32_bf16 v[152:155], a[88:91], v[220:223], v[152:155]
  buffer_store_dwordx4 v[228:231], v26, s[16:19], s21 offen offset:3072 sc1
  v_mfma_f32_16x16x32_bf16 v[156:159], a[92:95], v[220:223], v[156:159]
  s_waitcnt lgkmcnt(5)
  v_mfma_f32_16x16x32_bf16 v[64:67], a[96:99], v[160:163], v[64:67]
  ds_read_b128 v[192:195], v19 offset:0
  v_mfma_f32_16x16x32_bf16 v[68:71], a[100:103], v[160:163], v[68:71]
  v_add_u32 v18, s33, v14
  v_mfma_f32_16x16x32_bf16 v[72:75], a[104:107], v[160:163], v[72:75]
  v_mfma_f32_16x16x32_bf16 v[76:79], a[96:99], v[164:167], v[76:79]
  ds_read_b128 v[196:199], v19 offset:2048
  v_mfma_f32_16x16x32_bf16 v[80:83], a[100:103], v[164:167], v[80:83]
  buffer_load_dwordx4 v12, s[8:11], s30 offen offset:2048 lds
  v_mfma_f32_16x16x32_bf16 v[84:87], a[104:107], v[164:167], v[84:87]
  v_mfma_f32_16x16x32_bf16 v[88:91], a[96:99], v[168:171], v[88:91]
  ds_read_b128 v[200:203], v19 offset:4096
  v_mfma_f32_16x16x32_bf16 v[92:95], a[100:103], v[168:171], v[92:95]
  s_add_u32 s21, s48, 8192
  ds_read_b128 v[240:243], v23 offset:6656
  v_mfma_f32_16x16x32_bf16 v[96:99], a[104:107], v[168:171], v[96:99]
  v_mfma_f32_16x16x32_bf16 v[100:103], a[96:99], v[172:175], v[100:103]
  ds_read_b128 v[204:207], v19 offset:6144
  v_mfma_f32_16x16x32_bf16 v[104:107], a[100:103], v[172:175], v[104:107]
  buffer_store_dwordx4 v[232:235], v26, s[16:19], s21 offen offset:0 sc1
  v_mfma_f32_16x16x32_bf16 v[108:111], a[104:107], v[172:175], v[108:111]
  s_waitcnt lgkmcnt(5)
  v_mfma_f32_16x16x32_bf16 v[112:115], a[96:99], v[176:179], v[112:115]
  ds_read_b128 v[208:211], v19 offset:8192
  v_mfma_f32_16x16x32_bf16 v[116:119], a[100:103], v[176:179], v[116:119]
  v_mfma_f32_16x16x32_bf16 v[120:123], a[104:107], v[176:179], v[120:123]
  v_mfma_f32_16x16x32_bf16 v[124:127], a[96:99], v[180:183], v[124:127]
  ds_read_b128 v[212:215], v19 offset:10240
  v_mfma_f32_16x16x32_bf16 v[128:131], a[100:103], v[180:183], v[128:131]
  buffer_load_dwordx4 v13, s[8:11], s30 offen offset:3072 lds
  v_mfma_f32_16x16x32_bf16 v[132:135], a[104:107], v[180:183], v[132:135]
  s_add_u32 s30, s30, 128
  s_add_u32 m0, m0, 16384
  v_mfma_f32_16x16x32_bf16 v[136:139], a[96:99], v[184:187], v[136:139]
  ds_read_b128 v[216:219], v19 offset:12288
  v_mfma_f32_16x16x32_bf16 v[140:143], a[100:103], v[184:187], v[140:143]
  s_cmp_lt_u32 m0, s46
  s_cselect_b32 m0, m0, s47
  v_mfma_f32_16x16x32_bf16 v[144:147], a[104:107], v[184:187], v[144:147]
  ds_read_b128 v[244:247], v23 offset:6720
  v_mfma_f32_16x16x32_bf16 v[148:151], a[96:99], v[188:191], v[148:151]
  ds_read_b128 v[220:223], v19 offset:14336
  v_mfma_f32_16x16x32_bf16 v[152:155], a[100:103], v[188:191], v[152:155]
  buffer_store_dwordx4 v[236:239], v26, s[16:19], s21 offen offset:1024 sc1
  v_mfma_f32_16x16x32_bf16 v[156:159], a[104:107], v[188:191], v[156:159]
  s_waitcnt vmcnt(22) lgkmcnt(5)
  s_barrier
  v_mfma_f32_16x16x32_bf16 v[64:67], a[108:111], v[192:195], v[64:67]
  ds_read_b128 v[160:163], v18 offset:0
  v_mfma_f32_16x16x32_bf16 v[68:71], a[112:115], v[192:195], v[68:71]
  v_mfma_f32_16x16x32_bf16 v[72:75], a[116:119], v[192:195], v[72:75]
  v_add_u32 v19, s33, v15
  s_add_u32 s33, s33, 16384
  v_mfma_f32_16x16x32_bf16 v[76:79], a[108:111], v[196:199], v[76:79]
  ds_read_b128 v[164:167], v18 offset:2048
  v_mfma_f32_16x16x32_bf16 v[80:83], a[112:115], v[196:199], v[80:83]
  buffer_load_dwordx4 v10, s[8:11], s30 offen offset:0 lds
  v_mfma_f32_16x16x32_bf16 v[84:87], a[116:119], v[196:199], v[84:87]
  s_cmp_lt_u32 s33, 98304
  s_cselect_b32 s33, s33, 0
  v_mfma_f32_16x16x32_bf16 v[88:91], a[108:111], v[200:203], v[88:91]
  ds_read_b128 v[168:171], v18 offset:4096
  v_mfma_f32_16x16x32_bf16 v[92:95], a[112:115], v[200:203], v[92:95]
  v_mfma_f32_16x16x32_bf16 v[96:99], a[116:119], v[200:203], v[96:99]
  v_mfma_f32_16x16x32_bf16 v[100:103], a[108:111], v[204:207], v[100:103]
  ds_read_b128 v[172:175], v18 offset:6144
  v_mfma_f32_16x16x32_bf16 v[104:107], a[112:115], v[204:207], v[104:107]
  buffer_store_dwordx4 v[240:243], v26, s[16:19], s21 offen offset:2048 sc1
  v_mfma_f32_16x16x32_bf16 v[108:111], a[116:119], v[204:207], v[108:111]
  s_waitcnt lgkmcnt(4)
  v_mfma_f32_16x16x32_bf16 v[112:115], a[108:111], v[208:211], v[112:115]
  ds_read_b128 v[176:179], v18 offset:8192
  v_mfma_f32_16x16x32_bf16 v[116:119], a[112:115], v[208:211], v[116:119]
  v_mfma_f32_16x16x32_bf16 v[120:123], a[116:119], v[208:211], v[120:123]
  v_mfma_f32_16x16x32_bf16 v[124:127], a[108:111], v[212:215], v[124:127]
  ds_read_b128 v[180:183], v18 offset:10240
  v_mfma_f32_16x16x32_bf16 v[128:131], a[112:115], v[212:215], v[128:131]
  buffer_load_dwordx4 v11, s[8:11], s30 offen offset:1024 lds
  v_mfma_f32_16x16x32_bf16 v[132:135], a[116:119], v[212:215], v[132:135]
  v_mfma_f32_16x16x32_bf16 v[136:139], a[108:111], v[216:219], v[136:139]
  ds_read_b128 v[184:187], v18 offset:12288
  v_mfma_f32_16x16x32_bf16 v[140:143], a[112:115], v[216:219], v[140:143]
  v_mfma_f32_16x16x32_bf16 v[144:147], a[116:119], v[216:219], v[144:147]
  v_mfma_f32_16x16x32_bf16 v[148:151], a[108:111], v[220:223], v[148:151]
  ds_read_b128 v[188:191], v18 offset:14336
  v_mfma_f32_16x16x32_bf16 v[152:155], a[112:115], v[220:223], v[152:155]
  buffer_store_dwordx4 v[244:247], v26, s[16:19], s21 offen offset:3072 sc1
  v_mfma_f32_16x16x32_bf16 v[156:159], a[116:119], v[220:223], v[156:159]
  s_waitcnt lgkmcnt(4)
  v_mfma_f32_16x16x32_bf16 v[64:67], a[120:123], v[160:163], v[64:67]
  ds_read_b128 v[192:195], v19 offset:0
  v_mfma_f32_16x16x32_bf16 v[68:71], a[124:127], v[160:163], v[68:71]
  v_add_u32 v18, s33, v14
  v_mfma_f32_16x16x32_bf16 v[72:75], a[128:131], v[160:163], v[72:75]
  v_mfma_f32_16x16x32_bf16 v[76:79], a[120:123], v[164:167], v[76:79]
  ds_read_b128 v[196:199], v19 offset:2048
  v_mfma_f32_16x16x32_bf16 v[80:83], a[124:127], v[164:167], v[80:83]
  buffer_load_dwordx4 v12, s[8:11], s30 offen offset:2048 lds
  v_mfma_f32_16x16x32_bf16 v[84:87], a[128:131], v[164:167], v[84:87]
  v_mfma_f32_16x16x32_bf16 v[88:91], a[120:123], v[168:171], v[88:91]
  ds_read_b128 v[200:203], v19 offset:4096
  v_mfma_f32_16x16x32_bf16 v[92:95], a[124:127], v[168:171], v[92:95]
  v_mfma_f32_16x16x32_bf16 v[96:99], a[128:131], v[168:171], v[96:99]
  v_mfma_f32_16x16x32_bf16 v[100:103], a[120:123], v[172:175], v[100:103]
  ds_read_b128 v[204:207], v19 offset:6144
  v_mfma_f32_16x16x32_bf16 v[104:107], a[124:127], v[172:175], v[104:107]
  v_mfma_f32_16x16x32_bf16 v[108:111], a[128:131], v[172:175], v[108:111]
  s_waitcnt lgkmcnt(4)
  v_mfma_f32_16x16x32_bf16 v[112:115], a[120:123], v[176:179], v[112:115]
  ds_read_b128 v[208:211], v19 offset:8192
  v_mfma_f32_16x16x32_bf16 v[116:119], a[124:127], v[176:179], v[116:119]
  v_mfma_f32_16x16x32_bf16 v[120:123], a[128:131], v[176:179], v[120:123]
  v_mfma_f32_16x16x32_bf16 v[124:127], a[120:123], v[180:183], v[124:127]
  ds_read_b128 v[212:215], v19 offset:10240
  v_mfma_f32_16x16x32_bf16 v[128:131], a[124:127], v[180:183], v[128:131]
  buffer_load_dwordx4 v13, s[8:11], s30 offen offset:3072 lds
  v_mfma_f32_16x16x32_bf16 v[132:135], a[128:131], v[180:183], v[132:135]
  s_add_u32 s30, s30, s25
  s_sub_u32 s30, s30, 1152
  v_mfma_f32_16x16x32_bf16 v[136:139], a[120:123], v[184:187], v[136:139]
  ds_read_b128 v[216:219], v19 offset:12288
  s_add_u32 m0, m0, 16384
  v_mfma_f32_16x16x32_bf16 v[140:143], a[124:127], v[184:187], v[140:143]
  s_cmp_lt_u32 m0, s46
  s_cselect_b32 m0, m0, s47
  v_mfma_f32_16x16x32_bf16 v[144:147], a[128:131], v[184:187], v[144:147]
  v_mfma_f32_16x16x32_bf16 v[148:151], a[120:123], v[188:191], v[148:151]
  ds_read_b128 v[220:223], v19 offset:14336
  v_mfma_f32_16x16x32_bf16 v[152:155], a[124:127], v[188:191], v[152:155]
  v_mfma_f32_16x16x32_bf16 v[156:159], a[128:131], v[188:191], v[156:159]
  s_waitcnt vmcnt(23) lgkmcnt(4)
  s_barrier
  v_mfma_f32_16x16x32_bf16 v[64:67], a[132:135], v[192:195], v[64:67]
  ds_read_b128 v[160:163], v18 offset:0
  v_mfma_f32_16x16x32_bf16 v[68:71], a[136:139], v[192:195], v[68:71]
  v_mfma_f32_16x16x32_bf16 v[72:75], a[140:143], v[192:195], v[72:75]
  v_add_u32 v19, s33, v15
  s_add_u32 s33, s33, 16384
  v_mfma_f32_16x16x32_bf16 v[76:79], a[132:135], v[196:199], v[76:79]
  ds_read_b128 v[164:167], v18 offset:2048
  v_mfma_f32_16x16x32_bf16 v[80:83], a[136:139], v[196:199], v[80:83]
  buffer_load_dwordx4 v10, s[8:11], s30 offen offset:0 lds
  v_mfma_f32_16x16x32_bf16 v[84:87], a[140:143], v[196:199], v[84:87]
  s_cmp_lt_u32 s33, 98304
  s_cselect_b32 s33, s33, 0
  v_mfma_f32_16x16x32_bf16 v[88:91], a[132:135], v[200:203], v[88:91]
  ds_read_b128 v[168:171], v18 offset:4096
  v_mfma_f32_16x16x32_bf16 v[92:95], a[136:139], v[200:203], v[92:95]
  v_mfma_f32_16x16x32_bf16 v[96:99], a[140:143], v[200:203], v[96:99]
  v_mfma_f32_16x16x32_bf16 v[100:103], a[132:135], v[204:207], v[100:103]
  ds_read_b128 v[172:175], v18 offset:6144
  v_mfma_f32_16x16x32_bf16 v[104:107], a[136:139], v[204:207], v[104:107]
  v_mfma_f32_16x16x32_bf16 v[108:111], a[140:143], v[204:207], v[108:111]
  s_waitcnt lgkmcnt(4)
  v_mfma_f32_16x16x32_bf16 v[112:115], a[132:135], v[208:211], v[112:115]
  ds_read_b128 v[176:179], v18 offset:8192
  v_mfma_f32_16x16x32_bf16 v[116:119], a[136:139], v[208:211], v[116:119]
  v_mfma_f32_16x16x32_bf16 v[120:123], a[140:143], v[208:211], v[120:123]
  v_mfma_f32_16x16x32_bf16 v[124:127], a[132:135], v[212:215], v[124:127]
  ds_read_b128 v[180:183], v18 offset:10240
  v_mfma_f32_16x16x32_bf16 v[128:131], a[136:139], v[212:215], v[128:131]
  buffer_load_dwordx4 v11, s[8:11], s30 offen offset:1024 lds
  v_mfma_f32_16x16x32_bf16 v[132:135], a[140:143], v[212:215], v[132:135]
  v_mfma_f32_16x16x32_bf16 v[136:139], a[132:135], v[216:219], v[136:139]
  ds_read_b128 v[184:187], v18 offset:12288
  v_mfma_f32_16x16x32_bf16 v[140:143], a[136:139], v[216:219], v[140:143]
  v_mfma_f32_16x16x32_bf16 v[144:147], a[140:143], v[216:219], v[144:147]
  v_mfma_f32_16x16x32_bf16 v[148:151], a[132:135], v[220:223], v[148:151]
  ds_read_b128 v[188:191], v18 offset:14336
  v_mfma_f32_16x16x32_bf16 v[152:155], a[136:139], v[220:223], v[152:155]
  v_mfma_f32_16x16x32_bf16 v[156:159], a[140:143], v[220:223], v[156:159]
  s_waitcnt lgkmcnt(4)
  v_mfma_f32_16x16x32_bf16 v[64:67], a[144:147], v[160:163], v[64:67]
  ds_read_b128 v[192:195], v19 offset:0
  v_mfma_f32_16x16x32_bf16 v[68:71], a[148:151], v[160:163], v[68:71]
  v_add_u32 v18, s33, v14
  v_mfma_f32_16x16x32_bf16 v[72:75], a[152:155], v[160:163], v[72:75]
  v_mfma_f32_16x16x32_bf16 v[76:79], a[144:147], v[164:167], v[76:79]
  ds_read_b128 v[196:199], v19 offset:2048
  v_mfma_f32_16x16x32_bf16 v[80:83], a[148:151], v[164:167], v[80:83]
  buffer_load_dwordx4 v12, s[8:11], s30 offen offset:2048 lds
  v_mfma_f32_16x16x32_bf16 v[84:87], a[152:155], v[164:167], v[84:87]
  v_mfma_f32_16x16x32_bf16 v[88:91], a[144:147], v[168:171], v[88:91]
  ds_read_b128 v[200:203], v19 offset:4096
  v_mfma_f32_16x16x32_bf16 v[92:95], a[148:151], v[168:171], v[92:95]
  v_mfma_f32_16x16x32_bf16 v[96:99], a[152:155], v[168:171], v[96:99]
  v_mfma_f32_16x16x32_bf16 v[100:103], a[144:147], v[172:175], v[100:103]
  ds_read_b128 v[204:207], v19 offset:6144
  v_mfma_f32_16x16x32_bf16 v[104:107], a[148:151], v[172:175], v[104:107]
  v_mfma_f32_16x16x32_bf16 v[108:111], a[152:155], v[172:175], v[108:111]
  s_waitcnt lgkmcnt(4)
  v_mfma_f32_16x16x32_bf16 v[112:115], a[144:147], v[176:179], v[112:115]
  ds_read_b128 v[208:211], v19 offset:8192
  v_mfma_f32_16x16x32_bf16 v[116:119], a[148:151], v[176:179], v[116:119]
  v_mfma_f32_16x16x32_bf16 v[120:123], a[152:155], v[176:179], v[120:123]
  v_mfma_f32_16x16x32_bf16 v[124:127], a[144:147], v[180:183], v[124:127]
  ds_read_b128 v[212:215], v19 offset:10240
  v_mfma_f32_16x16x32_bf16 v[128:131], a[148:151], v[180:183], v[128:131]
  buffer_load_dwordx4 v13, s[8:11], s30 offen offset:3072 lds
  v_mfma_f32_16x16x32_bf16 v[132:135], a[152:155], v[180:183], v[132:135]
  s_add_u32 s30, s30, 128
  s_add_u32 m0, m0, 16384
  v_mfma_f32_16x16x32_bf16 v[136:139], a[144:147], v[184:187], v[136:139]
  ds_read_b128 v[216:219], v19 offset:12288
  v_mfma_f32_16x16x32_bf16 v[140:143], a[148:151], v[184:187], v[140:143]
  s_cmp_lt_u32 m0, s46
  s_cselect_b32 m0, m0, s47
  v_mfma_f32_16x16x32_bf16 v[144:147], a[152:155], v[184:187], v[144:147]
  v_mfma_f32_16x16x32_bf16 v[148:151], a[144:147], v[188:191], v[148:151]
  ds_read_b128 v[220:223], v19 offset:14336
  v_mfma_f32_16x16x32_bf16 v[152:155], a[148:151], v[188:191], v[152:155]
  v_mfma_f32_16x16x32_bf16 v[156:159], a[152:155], v[188:191], v[156:159]
  s_waitcnt vmcnt(6) lgkmcnt(4)
  s_barrier
  v_mfma_f32_16x16x32_bf16 v[64:67], a[156:159], v[192:195], v[64:67]
  ds_read_b128 v[160:163], v18 offset:0
  v_mfma_f32_16x16x32_bf16 v[68:71], a[160:163], v[192:195], v[68:71]
  s_cmp_eq_u32 s48, 0x80000000
  s_cbranch_scc1 kv_183
  s_cmp_lg_u32 s20, 0
  s_cbranch_scc1 af_184
  v_mov_b32 v4, 0
  v_mov_b32 v5, 1
  s_mov_b64 exec, 1
  buffer_atomic_add v5, v4, s[72:75], s61 offen sc1
  s_mov_b64 exec, -1
  s_nop 1
af_184:
kv_183:
  v_mfma_f32_16x16x32_bf16 v[72:75], a[164:167], v[192:195], v[72:75]
  v_add_u32 v19, s33, v15
  s_add_u32 s33, s33, 16384
  v_mfma_f32_16x16x32_bf16 v[76:79], a[156:159], v[196:199], v[76:79]
  ds_read_b128 v[164:167], v18 offset:2048
  v_mfma_f32_16x16x32_bf16 v[80:83], a[160:163], v[196:199], v[80:83]
  buffer_load_dwordx4 v10, s[8:11], s30 offen offset:0 lds
  v_mfma_f32_16x16x32_bf16 v[84:87], a[164:167], v[196:199], v[84:87]
  s_cmp_lt_u32 s33, 98304
  s_cselect_b32 s33, s33, 0
  v_mfma_f32_16x16x32_bf16 v[88:91], a[156:159], v[200:203], v[88:91]
  ds_read_b128 v[168:171], v18 offset:4096
  v_mfma_f32_16x16x32_bf16 v[92:95], a[160:163], v[200:203], v[92:95]
  v_mfma_f32_16x16x32_bf16 v[96:99], a[164:167], v[200:203], v[96:99]
  v_mfma_f32_16x16x32_bf16 v[100:103], a[156:159], v[204:207], v[100:103]
  ds_read_b128 v[172:175], v18 offset:6144
  v_mfma_f32_16x16x32_bf16 v[104:107], a[160:163], v[204:207], v[104:107]
  v_mfma_f32_16x16x32_bf16 v[108:111], a[164:167], v[204:207], v[108:111]
  s_waitcnt lgkmcnt(4)
  v_mfma_f32_16x16x32_bf16 v[112:115], a[156:159], v[208:211], v[112:115]
  ds_read_b128 v[176:179], v18 offset:8192
  v_mfma_f32_16x16x32_bf16 v[116:119], a[160:163], v[208:211], v[116:119]
  v_mfma_f32_16x16x32_bf16 v[120:123], a[164:167], v[208:211], v[120:123]
  v_mfma_f32_16x16x32_bf16 v[124:127], a[156:159], v[212:215], v[124:127]
  ds_read_b128 v[180:183], v18 offset:10240
  v_mfma_f32_16x16x32_bf16 v[128:131], a[160:163], v[212:215], v[128:131]
  buffer_load_dwordx4 v11, s[8:11], s30 offen offset:1024 lds
  v_mfma_f32_16x16x32_bf16 v[132:135], a[164:167], v[212:215], v[132:135]
  v_mfma_f32_16x16x32_bf16 v[136:139], a[156:159], v[216:219], v[136:139]
  ds_read_b128 v[184:187], v18 offset:12288
  v_mfma_f32_16x16x32_bf16 v[140:143], a[160:163], v[216:219], v[140:143]
  v_mfma_f32_16x16x32_bf16 v[144:147], a[164:167], v[216:219], v[144:147]
  v_mfma_f32_16x16x32_bf16 v[148:151], a[156:159], v[220:223], v[148:151]
  ds_read_b128 v[188:191], v18 offset:14336
  v_mfma_f32_16x16x32_bf16 v[152:155], a[160:163], v[220:223], v[152:155]
  v_mfma_f32_16x16x32_bf16 v[156:159], a[164:167], v[220:223], v[156:159]
  s_waitcnt lgkmcnt(4)
  v_mfma_f32_16x16x32_bf16 v[64:67], a[168:171], v[160:163], v[64:67]
  ds_read_b128 v[192:195], v19 offset:0
  v_mfma_f32_16x16x32_bf16 v[68:71], a[172:175], v[160:163], v[68:71]
  v_add_u32 v18, s33, v14
  s_mov_b32 s61, s60
  v_mfma_f32_16x16x32_bf16 v[72:75], a[176:179], v[160:163], v[72:75]
  s_add_u32 s60, s60, s62
  s_mul_i32 s48, s20, 393216
  v_mfma_f32_16x16x32_bf16 v[76:79], a[168:171], v[164:167], v[76:79]
  ds_read_b128 v[196:199], v19 offset:2048
  s_add_u32 s48, s48, s27
  v_mfma_f32_16x16x32_bf16 v[80:83], a[172:175], v[164:167], v[80:83]
  buffer_load_dwordx4 v12, s[8:11], s30 offen offset:2048 lds
  v_mfma_f32_16x16x32_bf16 v[84:87], a[176:179], v[164:167], v[84:87]
  s_add_u32 s27, s27, s28
  s_sub_u32 s26, s26, 1
  v_mfma_f32_16x16x32_bf16 v[88:91], a[168:171], v[168:171], v[88:91]
  ds_read_b128 v[200:203], v19 offset:4096
  v_mfma_f32_16x16x32_bf16 v[92:95], a[172:175], v[168:171], v[92:95]
  v_mfma_f32_16x16x32_bf16 v[96:99], a[176:179], v[168:171], v[96:99]
  v_mfma_f32_16x16x32_bf16 v[100:103], a[168:171], v[172:175], v[100:103]
  ds_read_b128 v[204:207], v19 offset:6144
  v_mfma_f32_16x16x32_bf16 v[104:107], a[172:175], v[172:175], v[104:107]
  v_mfma_f32_16x16x32_bf16 v[108:111], a[176:179], v[172:175], v[108:111]
  s_waitcnt lgkmcnt(4)
  v_mfma_f32_16x16x32_bf16 v[112:115], a[168:171], v[176:179], v[112:115]
  ds_read_b128 v[208:211], v19 offset:8192
  v_mfma_f32_16x16x32_bf16 v[116:119], a[172:175], v[176:179], v[116:119]
  v_mfma_f32_16x16x32_bf16 v[120:123], a[176:179], v[176:179], v[120:123]
  v_mfma_f32_16x16x32_bf16 v[124:127], a[168:171], v[180:183], v[124:127]
  ds_read_b128 v[212:215], v19 offset:10240
  v_mfma_f32_16x16x32_bf16 v[128:131], a[172:175], v[180:183], v[128:131]
  buffer_load_dwordx4 v13, s[8:11], s30 offen offset:3072 lds
  v_mfma_f32_16x16x32_bf16 v[132:135], a[176:179], v[180:183], v[132:135]
  s_add_u32 s30, s30, 128
  s_add_u32 m0, m0, 16384
  v_mfma_f32_16x16x32_bf16 v[136:139], a[168:171], v[184:187], v[136:139]
  ds_read_b128 v[216:219], v19 offset:12288
  v_mfma_f32_16x16x32_bf16 v[140:143], a[172:175], v[184:187], v[140:143]
  s_cmp_lt_u32 m0, s46
  s_cselect_b32 m0, m0, s47
  v_mfma_f32_16x16x32_bf16 v[144:147], a[176:179], v[184:187], v[144:147]
  v_mfma_f32_16x16x32_bf16 v[148:151], a[168:171], v[188:191], v[148:151]
  ds_read_b128 v[220:223], v19 offset:14336
  v_mfma_f32_16x16x32_bf16 v[152:155], a[172:175], v[188:191], v[152:155]
  v_mfma_f32_16x16x32_bf16 v[156:159], a[176:179], v[188:191], v[156:159]
  s_waitcnt vmcnt(15) lgkmcnt(4)
  s_barrier
  v_mfma_f32_16x16x32_bf16 v[64:67], a[180:183], v[192:195], v[64:67]
  ds_read_b128 v[160:163], v18 offset:0
  v_mfma_f32_16x16x32_bf16 v[68:71], a[184:187], v[192:195], v[68:71]
  v_mfma_f32_16x16x32_bf16 v[72:75], a[188:191], v[192:195], v[72:75]
  v_add_u32 v19, s33, v15
  s_add_u32 s33, s33, 16384
  v_mfma_f32_16x16x32_bf16 v[76:79], a[180:183], v[196:199], v[76:79]
  ds_read_b128 v[164:167], v18 offset:2048
  v_mfma_f32_16x16x32_bf16 v[80:83], a[184:187], v[196:199], v[80:83]
  buffer_load_dwordx4 v10, s[8:11], s30 offen offset:0 lds
  v_mfma_f32_16x16x32_bf16 v[84:87], a[188:191], v[196:199], v[84:87]
  s_cmp_lt_u32 s33, 98304
  s_cselect_b32 s33, s33, 0
  v_mfma_f32_16x16x32_bf16 v[88:91], a[180:183], v[200:203], v[88:91]
  ds_read_b128 v[168:171], v18 offset:4096
  v_mfma_f32_16x16x32_bf16 v[92:95], a[184:187], v[200:203], v[92:95]
  v_mfma_f32_16x16x32_bf16 v[96:99], a[188:191], v[200:203], v[96:99]
  v_mfma_f32_16x16x32_bf16 v[100:103], a[180:183], v[204:207], v[100:103]
  ds_read_b128 v[172:175], v18 offset:6144
  v_mfma_f32_16x16x32_bf16 v[104:107], a[184:187], v[204:207], v[104:107]
  v_mfma_f32_16x16x32_bf16 v[108:111], a[188:191], v[204:207], v[108:111]
  s_waitcnt lgkmcnt(4)
  v_mfma_f32_16x16x32_bf16 v[112:115], a[180:183], v[208:211], v[112:115]
  ds_read_b128 v[176:179], v18 offset:8192
  v_mfma_f32_16x16x32_bf16 v[116:119], a[184:187], v[208:211], v[116:119]
  v_mfma_f32_16x16x32_bf16 v[120:123], a[188:191], v[208:211], v[120:123]
  v_mfma_f32_16x16x32_bf16 v[124:127], a[180:183], v[212:215], v[124:127]
  ds_read_b128 v[180:183], v18 offset:10240
  v_mfma_f32_16x16x32_bf16 v[128:131], a[184:187], v[212:215], v[128:131]
  buffer_load_dwordx4 v11, s[8:11], s30 offen offset:1024 lds
  v_mfma_f32_16x16x32_bf16 v[132:135], a[188:191], v[212:215], v[132:135]
  v_mfma_f32_16x16x32_bf16 v[136:139], a[180:183], v[216:219], v[136:139]
  ds_read_b128 v[184:187], v18 offset:12288
  v_mfma_f32_16x16x32_bf16 v[140:143], a[184:187], v[216:219], v[140:143]
  v_mfma_f32_16x16x32_bf16 v[144:147], a[188:191], v[216:219], v[144:147]
  v_mfma_f32_16x16x32_bf16 v[148:151], a[180:183], v[220:223], v[148:151]
  ds_read_b128 v[188:191], v18 offset:14336
  v_mfma_f32_16x16x32_bf16 v[152:155], a[184:187], v[220:223], v[152:155]
  v_mfma_f32_16x16x32_bf16 v[156:159], a[188:191], v[220:223], v[156:159]
  s_waitcnt lgkmcnt(4)
  v_mfma_f32_16x16x32_bf16 v[64:67], a[192:195], v[160:163], v[64:67]
  ds_read_b128 v[192:195], v19 offset:0
  v_mfma_f32_16x16x32_bf16 v[68:71], a[196:199], v[160:163], v[68:71]
  v_add_u32 v18, s33, v14
  v_mfma_f32_16x16x32_bf16 v[72:75], a[200:203], v[160:163], v[72:75]
  v_mfma_f32_16x16x32_bf16 v[76:79], a[192:195], v[164:167], v[76:79]
  ds_read_b128 v[196:199], v19 offset:2048
  v_mfma_f32_16x16x32_bf16 v[80:83], a[196:199], v[164:167], v[80:83]
  buffer_load_dwordx4 v12, s[8:11], s30 offen offset:2048 lds
  v_mfma_f32_16x16x32_bf16 v[84:87], a[200:203], v[164:167], v[84:87]
  v_mfma_f32_16x16x32_bf16 v[88:91], a[192:195], v[168:171], v[88:91]
  ds_read_b128 v[200:203], v19 offset:4096
  v_mfma_f32_16x16x32_bf16 v[92:95], a[196:199], v[168:171], v[92:95]
  v_mfma_f32_16x16x32_bf16 v[96:99], a[200:203], v[168:171], v[96:99]
  v_mfma_f32_16x16x32_bf16 v[100:103], a[192:195], v[172:175], v[100:103]
  ds_read_b128 v[204:207], v19 offset:6144
  v_mfma_f32_16x16x32_bf16 v[104:107], a[196:199], v[172:175], v[104:107]
  v_mfma_f32_16x16x32_bf16 v[108:111], a[200:203], v[172:175], v[108:111]
  s_waitcnt lgkmcnt(4)
  v_mfma_f32_16x16x32_bf16 v[112:115], a[192:195], v[176:179], v[112:115]
  ds_read_b128 v[208:211], v19 offset:8192
  v_mfma_f32_16x16x32_bf16 v[116:119], a[196:199], v[176:179], v[116:119]
  v_mfma_f32_16x16x32_bf16 v[120:123], a[200:203], v[176:179], v[120:123]
  v_mfma_f32_16x16x32_bf16 v[124:127], a[192:195], v[180:183], v[124:127]
  ds_read_b128 v[212:215], v19 offset:10240
  v_mfma_f32_16x16x32_bf16 v[128:131], a[196:199], v[180:183], v[128:131]
  buffer_load_dwordx4 v13, s[8:11], s30 offen offset:3072 lds
  v_mfma_f32_16x16x32_bf16 v[132:135], a[200:203], v[180:183], v[132:135]
  s_add_u32 s30, s30, 128
  s_add_u32 m0, m0, 16384
  v_mfma_f32_16x16x32_bf16 v[136:139], a[192:195], v[184:187], v[136:139]
  ds_read_b128 v[216:219], v19 offset:12288
  v_mfma_f32_16x16x32_bf16 v[140:143], a[196:199], v[184:187], v[140:143]
  s_cmp_lt_u32 m0, s46
  s_cselect_b32 m0, m0, s47
  v_mfma_f32_16x16x32_bf16 v[144:147], a[200:203], v[184:187], v[144:147]
  v_mfma_f32_16x16x32_bf16 v[148:151], a[192:195], v[188:191], v[148:151]
  ds_read_b128 v[220:223], v19 offset:14336
  v_mfma_f32_16x16x32_bf16 v[152:155], a[196:199], v[188:191], v[152:155]
  v_mfma_f32_16x16x32_bf16 v[156:159], a[200:203], v[188:191], v[156:159]
  s_waitcnt vmcnt(12) lgkmcnt(4)
  s_barrier
  v_mfma_f32_16x16x32_bf16 v[64:67], a[204:207], v[192:195], v[64:67]
  ds_read_b128 v[160:163], v18 offset:0
  v_mfma_f32_16x16x32_bf16 v[68:71], a[208:211], v[192:195], v[68:71]
  v_mfma_f32_16x16x32_bf16 v[72:75], a[212:215], v[192:195], v[72:75]
  v_add_u32 v19, s33, v15
  s_add_u32 s33, s33, 16384
  v_mfma_f32_16x16x32_bf16 v[76:79], a[204:207], v[196:199], v[76:79]
  ds_read_b128 v[164:167], v18 offset:2048
  v_mfma_f32_16x16x32_bf16 v[80:83], a[208:211], v[196:199], v[80:83]
  buffer_load_dwordx4 v10, s[8:11], s30 offen offset:0 lds
  v_mfma_f32_16x16x32_bf16 v[84:87], a[212:215], v[196:199], v[84:87]
  s_cmp_lt_u32 s33, 98304
  s_cselect_b32 s33, s33, 0
  v_mfma_f32_16x16x32_bf16 v[88:91], a[204:207], v[200:203], v[88:91]
  ds_read_b128 v[168:171], v18 offset:4096
  v_mfma_f32_16x16x32_bf16 v[92:95], a[208:211], v[200:203], v[92:95]
  v_mfma_f32_16x16x32_bf16 v[96:99], a[212:215], v[200:203], v[96:99]
  v_mfma_f32_16x16x32_bf16 v[100:103], a[204:207], v[204:207], v[100:103]
  ds_read_b128 v[172:175], v18 offset:6144
  v_mfma_f32_16x16x32_bf16 v[104:107], a[208:211], v[204:207], v[104:107]
  v_mfma_f32_16x16x32_bf16 v[108:111], a[212:215], v[204:207], v[108:111]
  s_waitcnt lgkmcnt(4)
  v_mfma_f32_16x16x32_bf16 v[112:115], a[204:207], v[208:211], v[112:115]
  ds_read_b128 v[176:179], v18 offset:8192
  v_mfma_f32_16x16x32_bf16 v[116:119], a[208:211], v[208:211], v[116:119]
  v_mfma_f32_16x16x32_bf16 v[120:123], a[212:215], v[208:211], v[120:123]
  v_mfma_f32_16x16x32_bf16 v[124:127], a[204:207], v[212:215], v[124:127]
  ds_read_b128 v[180:183], v18 offset:10240
  v_mfma_f32_16x16x32_bf16 v[128:131], a[208:211], v[212:215], v[128:131]
  buffer_load_dwordx4 v11, s[8:11], s30 offen offset:1024 lds
  v_mfma_f32_16x16x32_bf16 v[132:135], a[212:215], v[212:215], v[132:135]
  v_mfma_f32_16x16x32_bf16 v[136:139], a[204:207], v[216:219], v[136:139]
  ds_read_b128 v[184:187], v18 offset:12288
  v_mfma_f32_16x16x32_bf16 v[140:143], a[208:211], v[216:219], v[140:143]
  v_mfma_f32_16x16x32_bf16 v[144:147], a[212:215], v[216:219], v[144:147]
  v_mfma_f32_16x16x32_bf16 v[148:151], a[204:207], v[220:223], v[148:151]
  ds_read_b128 v[188:191], v18 offset:14336
  v_mfma_f32_16x16x32_bf16 v[152:155], a[208:211], v[220:223], v[152:155]
  v_mfma_f32_16x16x32_bf16 v[156:159], a[212:215], v[220:223], v[156:159]
  s_waitcnt lgkmcnt(4)
  v_mfma_f32_16x16x32_bf16 v[64:67], a[216:219], v[160:163], v[64:67]
  ds_read_b128 v[192:195], v19 offset:0
  v_mfma_f32_16x16x32_bf16 v[68:71], a[220:223], v[160:163], v[68:71]
  v_add_u32 v18, s33, v14
  v_mfma_f32_16x16x32_bf16 v[72:75], a[224:227], v[160:163], v[72:75]
  v_mfma_f32_16x16x32_bf16 v[76:79], a[216:219], v[164:167], v[76:79]
  ds_read_b128 v[196:199], v19 offset:2048
  v_mfma_f32_16x16x32_bf16 v[80:83], a[220:223], v[164:167], v[80:83]
  buffer_load_dwordx4 v12, s[8:11], s30 offen offset:2048 lds
  v_mfma_f32_16x16x32_bf16 v[84:87], a[224:227], v[164:167], v[84:87]
  v_mfma_f32_16x16x32_bf16 v[88:91], a[216:219], v[168:171], v[88:91]
  ds_read_b128 v[200:203], v19 offset:4096
  v_mfma_f32_16x16x32_bf16 v[92:95], a[220:223], v[168:171], v[92:95]
  v_mfma_f32_16x16x32_bf16 v[96:99], a[224:227], v[168:171], v[96:99]
  v_mfma_f32_16x16x32_bf16 v[100:103], a[216:219], v[172:175], v[100:103]
  ds_read_b128 v[204:207], v19 offset:6144
  v_mfma_f32_16x16x32_bf16 v[104:107], a[220:223], v[172:175], v[104:107]
  v_mfma_f32_16x16x32_bf16 v[108:111], a[224:227], v[172:175], v[108:111]
  s_waitcnt lgkmcnt(4)
  v_mfma_f32_16x16x32_bf16 v[112:115], a[216:219], v[176:179], v[112:115]
  ds_read_b128 v[208:211], v19 offset:8192
  v_mfma_f32_16x16x32_bf16 v[116:119], a[220:223], v[176:179], v[116:119]
  v_mfma_f32_16x16x32_bf16 v[120:123], a[224:227], v[176:179], v[120:123]
  v_mfma_f32_16x16x32_bf16 v[124:127], a[216:219], v[180:183], v[124:127]
  ds_read_b128 v[212:215], v19 offset:10240
  v_mfma_f32_16x16x32_bf16 v[128:131], a[220:223], v[180:183], v[128:131]
  buffer_load_dwordx4 v13, s[8:11], s30 offen offset:3072 lds
  v_mfma_f32_16x16x32_bf16 v[132:135], a[224:227], v[180:183], v[132:135]
  s_add_u32 s30, s30, 128
  s_add_u32 m0, m0, 16384
  v_mfma_f32_16x16x32_bf16 v[136:139], a[216:219], v[184:187], v[136:139]
  ds_read_b128 v[216:219], v19 offset:12288
  v_mfma_f32_16x16x32_bf16 v[140:143], a[220:223], v[184:187], v[140:143]
  s_cmp_lt_u32 m0, s46
  s_cselect_b32 m0, m0, s47
  v_mfma_f32_16x16x32_bf16 v[144:147], a[224:227], v[184:187], v[144:147]
  v_mfma_f32_16x16x32_bf16 v[148:151], a[216:219], v[188:191], v[148:151]
  ds_read_b128 v[220:223], v19 offset:14336
  v_mfma_f32_16x16x32_bf16 v[152:155], a[220:223], v[188:191], v[152:155]
  v_mfma_f32_16x16x32_bf16 v[156:159], a[224:227], v[188:191], v[156:159]
  s_waitcnt vmcnt(12) lgkmcnt(4)
  s_barrier
  v_mfma_f32_16x16x32_bf16 v[64:67], a[228:231], v[192:195], v[64:67]
  ds_read_b128 v[160:163], v18 offset:0
  v_mfma_f32_16x16x32_bf16 v[68:71], a[232:235], v[192:195], v[68:71]
  v_mfma_f32_16x16x32_bf16 v[72:75], a[236:239], v[192:195], v[72:75]
  v_add_u32 v19, s33, v15
  s_add_u32 s33, s33, 16384
  v_mfma_f32_16x16x32_bf16 v[76:79], a[228:231], v[196:199], v[76:79]
  ds_read_b128 v[164:167], v18 offset:2048
  v_cvt_pk_bf16_f32 v224, v64, v65
  v_mfma_f32_16x16x32_bf16 v[80:83], a[232:235], v[196:199], v[80:83]
  buffer_load_dwordx4 v10, s[8:11], s30 offen offset:0 lds
  v_mfma_f32_16x16x32_bf16 v[84:87], a[236:239], v[196:199], v[84:87]
  s_cmp_lt_u32 s33, 98304
  s_cselect_b32 s33, s33, 0
  v_mfma_f32_16x16x32_bf16 v[88:91], a[228:231], v[200:203], v[88:91]
  ds_read_b128 v[168:171], v18 offset:4096
  v_cvt_pk_bf16_f32 v225, v66, v67
  v_mfma_f32_16x16x32_bf16 v[92:95], a[232:235], v[200:203], v[92:95]
  v_cvt_pk_bf16_f32 v226, v68, v69
  v_cvt_pk_bf16_f32 v227, v70, v71
  v_mfma_f32_16x16x32_bf16 v[96:99], a[236:239], v[200:203], v[96:99]
  v_cvt_pk_bf16_f32 v228, v72, v73
  v_cvt_pk_bf16_f32 v229, v74, v75
  v_mfma_f32_16x16x32_bf16 v[100:103], a[228:231], v[204:207], v[100:103]
  ds_read_b128 v[172:175], v18 offset:6144
  v_mfma_f32_16x16x32_bf16 v[104:107], a[232:235], v[204:207], v[104:107]
  ds_write_b64 v22, v[224:225] offset:0
  v_mfma_f32_16x16x32_bf16 v[108:111], a[236:239], v[204:207], v[108:111]
  s_waitcnt lgkmcnt(5)
  v_mfma_f32_16x16x32_bf16 v[112:115], a[228:231], v[208:211], v[112:115]
  ds_read_b128 v[176:179], v18 offset:8192
  v_mfma_f32_16x16x32_bf16 v[116:119], a[232:235], v[208:211], v[116:119]
  ds_write_b64 v22, v[226:227] offset:8
  v_mfma_f32_16x16x32_bf16 v[120:123], a[236:239], v[208:211], v[120:123]
  ds_write_b64 v16, v[228:229] offset:64
  v_mfma_f32_16x16x32_bf16 v[124:127], a[228:231], v[212:215], v[124:127]
  ds_read_b128 v[180:183], v18 offset:10240
  v_cvt_pk_bf16_f32 v230, v76, v77
  v_mfma_f32_16x16x32_bf16 v[128:131], a[232:235], v[212:215], v[128:131]
  buffer_load_dwordx4 v11, s[8:11], s30 offen offset:1024 lds
  v_mfma_f32_16x16x32_bf16 v[132:135], a[236:239], v[212:215], v[132:135]
  v_cvt_pk_bf16_f32 v231, v78, v79
  v_cvt_pk_bf16_f32 v232, v80, v81
  v_mfma_f32_16x16x32_bf16 v[136:139], a[228:231], v[216:219], v[136:139]
  ds_read_b128 v[184:187], v18 offset:12288
  v_cvt_pk_bf16_f32 v233, v82, v83
  v_mfma_f32_16x16x32_bf16 v[140:143], a[232:235], v[216:219], v[140:143]
  v_cvt_pk_bf16_f32 v234, v84, v85
  v_cvt_pk_bf16_f32 v235, v86, v87
  v_mfma_f32_16x16x32_bf16 v[144:147], a[236:239], v[216:219], v[144:147]
  ds_write_b64 v22, v[230:231] offset:6400
  v_mfma_f32_16x16x32_bf16 v[148:151], a[228:231], v[220:223], v[148:151]
  ds_read_b128 v[188:191], v18 offset:14336
  v_mfma_f32_16x16x32_bf16 v[152:155], a[232:235], v[220:223], v[152:155]
  ds_write_b64 v22, v[232:233] offset:6408
  v_mfma_f32_16x16x32_bf16 v[156:159], a[236:239], v[220:223], v[156:159]
  s_waitcnt lgkmcnt(9)
kv_end_186:
  s_cmp_gt_u32 s26, 0
  s_cbranch_scc1 kv_blk_185
  s_nop 7
  ds_write_b64 v16, v[234:235] offset:6464
  v_cvt_pk_bf16_f32 v236, v88, v89
  v_cvt_pk_bf16_f32 v237, v90, v91
  v_cvt_pk_bf16_f32 v238, v92, v93
  v_cvt_pk_bf16_f32 v239, v94, v95
  v_cvt_pk_bf16_f32 v240, v96, v97
  v_cvt_pk_bf16_f32 v241, v98, v99
  ds_write_b64 v22, v[236:237] offset:12800
  ds_write_b64 v22, v[238:239] offset:12808
  ds_write_b64 v16, v[240:241] offset:12864
  v_cvt_pk_bf16_f32 v242, v100, v101
  v_cvt_pk_bf16_f32 v243, v102, v103
  v_cvt_pk_bf16_f32 v244, v104, v105
  v_cvt_pk_bf16_f32 v245, v106, v107
  v_cvt_pk_bf16_f32 v246, v108, v109
  v_cvt_pk_bf16_f32 v247, v110, v111
  ds_write_b64 v22, v[242:243] offset:19200
  ds_write_b64 v22, v[244:245] offset:19208
  ds_write_b64 v16, v[246:247] offset:19264
  v_cvt_pk_bf16_f32 v224, v112, v113
  v_cvt_pk_bf16_f32 v225, v114, v115
  v_cvt_pk_bf16_f32 v226, v116, v117
  v_cvt_pk_bf16_f32 v227, v118, v119
  v_cvt_pk_bf16_f32 v228, v120, v121
  v_cvt_pk_bf16_f32 v229, v122, v123
  ds_write_b64 v22, v[224:225] offset:25600
  ds_write_b64 v22, v[226:227] offset:25608
  ds_write_b64 v16, v[228:229] offset:25664
  v_cvt_pk_bf16_f32 v230, v124, v125
  v_cvt_pk_bf16_f32 v231, v126, v127
  v_cvt_pk_bf16_f32 v232, v128, v129
  v_cvt_pk_bf16_f32 v233, v130, v131
  v_cvt_pk_bf16_f32 v234, v132, v133
  v_cvt_pk_bf16_f32 v235, v134, v135
  ds_write_b64 v22, v[230:231] offset:32000
  ds_write_b64 v22, v[232:233] offset:32008
  ds_write_b64 v16, v[234:235] offset:32064
  v_cvt_pk_bf16_f32 v236, v136, v137
  v_cvt_pk_bf16_f32 v237, v138, v139
  v_cvt_pk_bf16_f32 v238, v140, v141
  v_cvt_pk_bf16_f32 v239, v142, v143
  v_cvt_pk_bf16_f32 v240, v144, v145
  v_cvt_pk_bf16_f32 v241, v146, v147
  ds_write_b64 v22, v[236:237] offset:38400
  ds_write_b64 v22, v[238:239] offset:38408
  ds_write_b64 v16, v[240:241] offset:38464
  v_cvt_pk_bf16_f32 v242, v148, v149
  v_cvt_pk_bf16_f32 v243, v150, v151
  v_cvt_pk_bf16_f32 v244, v152, v153
  v_cvt_pk_bf16_f32 v245, v154, v155
  v_cvt_pk_bf16_f32 v246, v156, v157
  v_cvt_pk_bf16_f32 v247, v158, v159
  ds_write_b64 v22, v[242:243] offset:44800
  ds_write_b64 v22, v[244:245] offset:44808
  ds_write_b64 v16, v[246:247] offset:44864
  s_waitcnt vmcnt(0) lgkmcnt(0)
  s_barrier
  ds_read_b128 v[224:227], v23 offset:0
  ds_read_b128 v[228:231], v23 offset:64
  ds_read_b128 v[232:235], v23 offset:128
  ds_read_b128 v[236:239], v23 offset:192
  ds_read_b128 v[240:243], v23 offset:256
  ds_read_b128 v[244:247], v23 offset:320
  s_waitcnt lgkmcnt(0)
  s_add_u32 s21, s48, 0
  buffer_store_dwordx4 v[224:227], v26, s[16:19], s21 offen offset:0 sc1
  buffer_store_dwordx4 v[228:231], v26, s[16:19], s21 offen offset:1024 sc1
  buffer_store_dwordx4 v[232:235], v26, s[16:19], s21 offen offset:2048 sc1
  buffer_store_dwordx4 v[236:239], v26, s[16:19], s21 offen offset:3072 sc1
  s_add_u32 s21, s48, 4096
  buffer_store_dwordx4 v[240:243], v26, s[16:19], s21 offen offset:0 sc1
  buffer_store_dwordx4 v[244:247], v26, s[16:19], s21 offen offset:1024 sc1
  s_nop 1
  ds_read_b128 v[224:227], v23 offset:6400
  ds_read_b128 v[228:231], v23 offset:6464
  ds_read_b128 v[232:235], v23 offset:6528
  ds_read_b128 v[236:239], v23 offset:6592
  ds_read_b128 v[240:243], v23 offset:6656
  ds_read_b128 v[244:247], v23 offset:6720
  s_waitcnt lgkmcnt(0)
  buffer_store_dwordx4 v[224:227], v26, s[16:19], s21 offen offset:2048 sc1
  buffer_store_dwordx4 v[228:231], v26, s[16:19], s21 offen offset:3072 sc1
  s_add_u32 s21, s48, 8192
  buffer_store_dwordx4 v[232:235], v26, s[16:19], s21 offen offset:0 sc1
  buffer_store_dwordx4 v[236:239], v26, s[16:19], s21 offen offset:1024 sc1
  buffer_store_dwordx4 v[240:243], v26, s[16:19], s21 offen offset:2048 sc1
  buffer_store_dwordx4 v[244:247], v26, s[16:19], s21 offen offset:3072 sc1
  s_nop 1
  s_waitcnt vmcnt(0)
  s_barrier
  s_cmp_lg_u32 s20, 0
  s_cbranch_scc1 af_187
  v_mov_b32 v4, 0
  v_mov_b32 v5, 1
  s_mov_b64 exec, 1
  buffer_atomic_add v5, v4, s[72:75], s61 offen sc1
  s_mov_b64 exec, -1
  s_nop 1
af_187:
  s_cmp_lg_u32 s43, 0
  s_cbranch_scc1 kv_fin
  s_mov_b32 s87, -2
  s_add_u32 s21, s42, 32
  s_branch do_opb2
kv_help:
  s_waitcnt vmcnt(0) lgkmcnt(0)
  s_barrier
  s_load_dwordx2 s[4:5], s[0:1], 0
  s_load_dwordx2 s[6:7], s[0:1], 24
  s_load_dwordx2 s[36:37], s[0:1], 32
  s_load_dwordx2 s[38:39], s[0:1], 104
  s_and_b32 s43, s3, 1
  s_bfe_u32 s42, s3, 0x50001
  s_lshr_b32 s40, s42, 2
  s_waitcnt lgkmcnt(0)
  s_cmp_eq_u32 s43, 1
  s_cselect_b32 s6, s36, s6
  s_cselect_b32 s7, s37, s7
  s_mov_b32 s8, s4
  s_mov_b32 s9, s5
  s_mov_b32 s10, 2621440
  s_mov_b32 s11, 0x00020000
  s_mov_b32 s12, s6
  s_mov_b32 s13, s7
  s_mov_b32 s14, 7864320
  s_mov_b32 s15, 0x00020000
  s_mov_b32 s16, s38
  s_mov_b32 s17, s39
  s_mov_b32 s18, 50331648
  s_mov_b32 s19, 0x00020000
  s_mul_i32 s44, s42, 384
  s_mov_b32 s28, 1572864
  s_mov_b32 s43, 2
  s_load_dwordx2 s[6:7], s[0:1], 16
  s_waitcnt lgkmcnt(0)
  s_mov_b32 s12, s6
  s_mov_b32 s13, s7
  s_mov_b32 s14, 7864320
  s_mov_b32 s15, 0x00020000
  s_add_u32 s16, s38, 57671680
  s_addc_u32 s17, s39, 0
  s_mov_b32 s18, 4718592
  s_mov_b32 s19, 0x00020000
  s_mov_b32 s24, 2129920
  s_mov_b32 s25, 163840
  v_mov_b32 v9, 2731
  s_and_b32 s22, s20, 1
  s_lshl_b32 s22, s22, 2
  v_add_u32 v8, 0, v1
  v_mul_u32_u24 v7, v8, v9
  v_lshrrev_b32 v7, 16, v7
  v_mul_u32_u24 v4, 24, v7
  v_sub_u32 v8, v8, v4
  v_and_b32 v4, 2, v7
  v_xor_b32 v8, v8, v4
  v_xor_b32 v8, s22, v8
  v_xor_b32 v5, 4, v8
  s_mov_b32 s21, 12288
  v_mul_lo_u32 v7, v7, s21
  v_lshl_add_u32 v40, v8, 4, v7
  v_lshl_add_u32 v43, v5, 4, v7
  v_add_u32 v8, 64, v1
  v_mul_u32_u24 v7, v8, v9
  v_lshrrev_b32 v7, 16, v7
  v_mul_u32_u24 v4, 24, v7
  v_sub_u32 v8, v8, v4
  v_and_b32 v4, 2, v7
  v_xor_b32 v8, v8, v4
  v_xor_b32 v8, s22, v8
  v_xor_b32 v5, 4, v8
  s_mov_b32 s21, 12288
  v_mul_lo_u32 v7, v7, s21
  v_lshl_add_u32 v41, v8, 4, v7
  v_lshl_add_u32 v44, v5, 4, v7
  v_add_u32 v8, 128, v1
  v_mul_u32_u24 v7, v8, v9
  v_lshrrev_b32 v7, 16, v7
  v_mul_u32_u24 v4, 24, v7
  v_sub_u32 v8, v8, v4
  v_and_b32 v4, 2, v7
  v_xor_b32 v8, v8, v4
  v_xor_b32 v8, s22, v8
  v_xor_b32 v5, 4, v8
  s_mov_b32 s21, 12288
  v_mul_lo_u32 v7, v7, s21
  v_lshl_add_u32 v42, v8, 4, v7
  v_lshl_add_u32 v45, v5, 4, v7
  s_mul_i32 s23, s20, 491520
  s_add_u32 s23, s23, s44
  s_mul_i32 s22, s20, 15360
  s_add_u32 s22, s22, 98304
  s_add_u32 s21, s23, 0
  s_add_u32 m0, s22, 0
  s_nop 0
  buffer_load_dwordx4 v40, s[12:15], s21 offen lds
  s_add_u32 m0, s22, 1024
  s_nop 0
  buffer_load_dwordx4 v41, s[12:15], s21 offen lds
  s_add_u32 m0, s22, 2048
  s_nop 0
  buffer_load_dwordx4 v42, s[12:15], s21 offen lds
  s_add_u32 s21, s23, 98304
  s_add_u32 m0, s22, 3072
  s_nop 0
  buffer_load_dwordx4 v43, s[12:15], s21 offen lds
  s_add_u32 m0, s22, 4096
  s_nop 0
  buffer_load_dwordx4 v44, s[12:15], s21 offen lds
  s_add_u32 m0, s22, 5120
  s_nop 0
  buffer_load_dwordx4 v45, s[12:15], s21 offen lds
  s_add_u32 s21, s23, 196608
  s_add_u32 m0, s22, 6144
  s_nop 0
  buffer_load_dwordx4 v40, s[12:15], s21 offen lds
  s_add_u32 m0, s22, 7168
  s_nop 0
  buffer_load_dwordx4 v41, s[12:15], s21 offen lds
  s_add_u32 m0, s22, 8192
  s_nop 0
  buffer_load_dwordx4 v42, s[12:15], s21 offen lds
  s_add_u32 s21, s23, 294912
  s_add_u32 m0, s22, 9216
  s_nop 0
  buffer_load_dwordx4 v43, s[12:15], s21 offen lds
  s_add_u32 m0, s22, 10240
  s_nop 0
  buffer_load_dwordx4 v44, s[12:15], s21 offen lds
  s_add_u32 m0, s22, 11264
  s_nop 0
  buffer_load_dwordx4 v45, s[12:15], s21 offen lds
  s_add_u32 s21, s23, 393216
  s_add_u32 m0, s22, 12288
  s_nop 0
  buffer_load_dwordx4 v40, s[12:15], s21 offen lds
  s_add_u32 m0, s22, 13312
  s_nop 0
  buffer_load_dwordx4 v41, s[12:15], s21 offen lds
  s_add_u32 m0, s22, 14336
  s_nop 0
  buffer_load_dwordx4 v42, s[12:15], s21 offen lds
  s_add_u32 s21, s23, 1966080
  buffer_load_dwordx4 v[64:67], v40, s[12:15], s21 offen
  buffer_load_dwordx4 v[68:71], v41, s[12:15], s21 offen
  buffer_load_dwordx4 v[72:75], v42, s[12:15], s21 offen
  s_add_u32 s21, s23, 2064384
  buffer_load_dwordx4 v[76:79], v43, s[12:15], s21 offen
  buffer_load_dwordx4 v[80:83], v44, s[12:15], s21 offen
  buffer_load_dwordx4 v[84:87], v45, s[12:15], s21 offen
  s_add_u32 s21, s23, 2162688
  buffer_load_dwordx4 v[88:91], v40, s[12:15], s21 offen
  buffer_load_dwordx4 v[92:95], v41, s[12:15], s21 offen
  buffer_load_dwordx4 v[96:99], v42, s[12:15], s21 offen
  s_add_u32 s21, s23, 2260992
  buffer_load_dwordx4 v[100:103], v43, s[12:15], s21 offen
  buffer_load_dwordx4 v[104:107], v44, s[12:15], s21 offen
  buffer_load_dwordx4 v[108:111], v45, s[12:15], s21 offen
  s_add_u32 s21, s23, 2359296
  buffer_load_dwordx4 v[112:115], v40, s[12:15], s21 offen
  buffer_load_dwordx4 v[116:119], v41, s[12:15], s21 offen
  buffer_load_dwordx4 v[120:123], v42, s[12:15], s21 offen
  s_add_u32 s21, s23, 3932160
  buffer_load_dwordx4 v[124:127], v40, s[12:15], s21 offen
  buffer_load_dwordx4 v[128:131], v41, s[12:15], s21 offen
  buffer_load_dwordx4 v[132:135], v42, s[12:15], s21 offen
  s_add_u32 s21, s23, 4030464
  buffer_load_dwordx4 v[136:139], v43, s[12:15], s21 offen
  buffer_load_dwordx4 v[140:143], v44, s[12:15], s21 offen
  buffer_load_dwordx4 v[144:147], v45, s[12:15], s21 offen
  s_add_u32 s21, s23, 4128768
  buffer_load_dwordx4 v[148:151], v40, s[12:15], s21 offen
  buffer_load_dwordx4 v[152:155], v41, s[12:15], s21 offen
  buffer_load_dwordx4 v[156:159], v42, s[12:15], s21 offen
  s_add_u32 s21, s23, 4227072
  buffer_load_dwordx4 v[160:163], v43, s[12:15], s21 offen
  buffer_load_dwordx4 v[164:167], v44, s[12:15], s21 offen
  buffer_load_dwordx4 v[168:171], v45, s[12:15], s21 offen
  s_add_u32 s21, s23, 4325376
  buffer_load_dwordx4 v[172:175], v40, s[12:15], s21 offen
  buffer_load_dwordx4 v[176:179], v41, s[12:15], s21 offen
  buffer_load_dwordx4 v[180:183], v42, s[12:15], s21 offen
  s_add_u32 s21, s23, 5898240
  buffer_load_dwordx4 v[184:187], v40, s[12:15], s21 offen
  buffer_load_dwordx4 v[188:191], v41, s[12:15], s21 offen
  buffer_load_dwordx4 v[192:195], v42, s[12:15], s21 offen
  s_add_u32 s21, s23, 5996544
  buffer_load_dwordx4 v[196:199], v43, s[12:15], s21 offen
  buffer_load_dwordx4 v[200:203], v44, s[12:15], s21 offen
  buffer_load_dwordx4 v[204:207], v45, s[12:15], s21 offen
  s_add_u32 s21, s23, 6094848
  buffer_load_dwordx4 v[208:211], v40, s[12:15], s21 offen
  buffer_load_dwordx4 v[212:215], v41, s[12:15], s21 offen
  buffer_load_dwordx4 v[216:219], v42, s[12:15], s21 offen
  s_add_u32 s21, s23, 6193152
  buffer_load_dwordx4 v[220:223], v43, s[12:15], s21 offen
  buffer_load_dwordx4 v[224:227], v44, s[12:15], s21 offen
  buffer_load_dwordx4 v[228:231], v45, s[12:15], s21 offen
  s_add_u32 s21, s23, 6291456
  buffer_load_dwordx4 v[232:235], v40, s[12:15], s21 offen
  buffer_load_dwordx4 v[236:239], v41, s[12:15], s21 offen
  buffer_load_dwordx4 v[240:243], v42, s[12:15], s21 offen
  v_lshl_add_u32 v49, v1, 4, s22
  v_lshrrev_b32 v7, 2, v2
  v_and_b32 v4, 2, v7
  v_and_b32 v5, 1, v3
  v_lshl_or_b32 v4, v5, 2, v4
  v_lshl_add_u32 v7, v3, 3, v7
  v_mul_u32_u24 v7, 384, v7
  v_and_b32 v5, 1, v2
  v_lshl_add_u32 v7, v5, 3, v7
  v_add_u32 v7, 98304, v7
  v_bfe_u32 v8, v2, 1, 1
  s_mul_i32 s21, s20, 6
  v_add_u32 v8, s21, v8
  v_add_u32 v5, 0, v8
  v_xor_b32 v5, v5, v4
  v_lshl_add_u32 v46, v5, 4, v7
  v_add_u32 v5, 2, v8
  v_xor_b32 v5, v5, v4
  v_lshl_add_u32 v47, v5, 4, v7
  v_add_u32 v5, 4, v8
  v_xor_b32 v5, v5, v4
  v_lshl_add_u32 v48, v5, 4, v7
  s_waitcnt vmcnt(45)
  s_barrier
  ds_read_b64_tr_b16 a[0:1], v46 offset:0
  ds_read_b64_tr_b16 a[2:3], v46 offset:1536
  ds_read_b64_tr_b16 a[4:5], v47 offset:0
  ds_read_b64_tr_b16 a[6:7], v47 offset:1536
  ds_read_b64_tr_b16 a[8:9], v48 offset:0
  ds_read_b64_tr_b16 a[10:11], v48 offset:1536
  ds_read_b64_tr_b16 a[12:13], v46 offset:12288
  ds_read_b64_tr_b16 a[14:15], v46 offset:13824
  ds_read_b64_tr_b16 a[16:17], v47 offset:12288
  ds_read_b64_tr_b16 a[18:19], v47 offset:13824
  ds_read_b64_tr_b16 a[20:21], v48 offset:12288
  ds_read_b64_tr_b16 a[22:23], v48 offset:13824
  ds_read_b64_tr_b16 a[24:25], v46 offset:24576
  ds_read_b64_tr_b16 a[26:27], v46 offset:26112
  ds_read_b64_tr_b16 a[28:29], v47 offset:24576
  ds_read_b64_tr_b16 a[30:31], v47 offset:26112
  ds_read_b64_tr_b16 a[32:33], v48 offset:24576
  ds_read_b64_tr_b16 a[34:35], v48 offset:26112
  ds_read_b64_tr_b16 a[36:37], v46 offset:36864
  ds_read_b64_tr_b16 a[38:39], v46 offset:38400
  ds_read_b64_tr_b16 a[40:41], v47 offset:36864
  ds_read_b64_tr_b16 a[42:43], v47 offset:38400
  ds_read_b64_tr_b16 a[44:45], v48 offset:36864
  ds_read_b64_tr_b16 a[46:47], v48 offset:38400
  ds_read_b64_tr_b16 a[48:49], v46 offset:49152
  ds_read_b64_tr_b16 a[50:51], v46 offset:50688
  ds_read_b64_tr_b16 a[52:53], v47 offset:49152
  ds_read_b64_tr_b16 a[54:55], v47 offset:50688
  ds_read_b64_tr_b16 a[56:57], v48 offset:49152
  ds_read_b64_tr_b16 a[58:59], v48 offset:50688
  v_lshrrev_b32 v11, 3, v1
  v_and_b32 v12, 7, v1
  v_xor_b32 v12, v12, v11
  v_mul_u32_u24 v11, 1280, v11
  v_lshl_add_u32 v10, v12, 4, v11
  s_mul_i32 s46, s20, 40960
  v_add_u32 v10, s46, v10
  s_lshl_b32 s47, s20, 12
  s_add_u32 s47, s47, 0
  s_add_u32 s46, s47, 98304
  s_mov_b32 s30, s24
  s_add_u32 s32, s47, 32768
  v_add_u32 v11, 9216, v10
  v_add_u32 v12, 18432, v10
  v_add_u32 v13, 27648, v10
  s_mov_b32 m0, s32
  s_nop 0
  buffer_load_dwordx4 v10, s[8:11], s30 offen offset:0 lds
  buffer_load_dwordx4 v11, s[8:11], s30 offen offset:1024 lds
  buffer_load_dwordx4 v12, s[8:11], s30 offen offset:2048 lds
  buffer_load_dwordx4 v13, s[8:11], s30 offen offset:3072 lds
  s_add_u32 s30, s30, 128
  s_add_u32 s32, s32, 16384
  s_cmp_lt_u32 s32, s46
  s_cselect_b32 s32, s32, s47
  s_mov_b32 m0, s32
  s_nop 0
  buffer_load_dwordx4 v10, s[8:11], s30 offen offset:0 lds
  buffer_load_dwordx4 v11, s[8:11], s30 offen offset:1024 lds
  buffer_load_dwordx4 v12, s[8:11], s30 offen offset:2048 lds
  buffer_load_dwordx4 v13, s[8:11], s30 offen offset:3072 lds
  s_add_u32 s30, s30, 128
  s_add_u32 s32, s32, 16384
  s_cmp_lt_u32 s32, s46
  s_cselect_b32 s32, s32, s47
  s_mov_b32 m0, s32
  s_nop 0
  buffer_load_dwordx4 v10, s[8:11], s30 offen offset:0 lds
  buffer_load_dwordx4 v11, s[8:11], s30 offen offset:1024 lds
  buffer_load_dwordx4 v12, s[8:11], s30 offen offset:2048 lds
  buffer_load_dwordx4 v13, s[8:11], s30 offen offset:3072 lds
  s_add_u32 s30, s30, 128
  s_add_u32 s32, s32, 16384
  s_cmp_lt_u32 s32, s46
  s_cselect_b32 s32, s32, s47
  s_mov_b32 m0, s32
  s_nop 0
  buffer_load_dwordx4 v10, s[8:11], s30 offen offset:0 lds
  buffer_load_dwordx4 v11, s[8:11], s30 offen offset:1024 lds
  buffer_load_dwordx4 v12, s[8:11], s30 offen offset:2048 lds
  buffer_load_dwordx4 v13, s[8:11], s30 offen offset:3072 lds
  s_add_u32 s30, s30, 128
  s_add_u32 s32, s32, 16384
  s_cmp_lt_u32 s32, s46
  s_cselect_b32 s32, s32, s47
  s_waitcnt lgkmcnt(0)
  s_barrier
  s_waitcnt vmcnt(46)
  ds_write_b128 v49, v[64:67] offset:0
  ds_write_b128 v49, v[68:71] offset:1024
  ds_write_b128 v49, v[72:75] offset:2048
  ds_write_b128 v49, v[76:79] offset:3072
  ds_write_b128 v49, v[80:83] offset:4096
  ds_write_b128 v49, v[84:87] offset:5120
  ds_write_b128 v49, v[88:91] offset:6144
  ds_write_b128 v49, v[92:95] offset:7168
  ds_write_b128 v49, v[96:99] offset:8192
  ds_write_b128 v49, v[100:103] offset:9216
  ds_write_b128 v49, v[104:107] offset:10240
  ds_write_b128 v49, v[108:111] offset:11264
  ds_write_b128 v49, v[112:115] offset:12288
  ds_write_b128 v49, v[116:119] offset:13312
  ds_write_b128 v49, v[120:123] offset:14336
  s_waitcnt lgkmcnt(0)
  s_barrier
  ds_read_b64_tr_b16 a[60:61], v46 offset:0
  ds_read_b64_tr_b16 a[62:63], v46 offset:1536
  ds_read_b64_tr_b16 a[64:65], v47 offset:0
  ds_read_b64_tr_b16 a[66:67], v47 offset:1536
  ds_read_b64_tr_b16 a[68:69], v48 offset:0
  ds_read_b64_tr_b16 a[70:71], v48 offset:1536
  ds_read_b64_tr_b16 a[72:73], v46 offset:12288
  ds_read_b64_tr_b16 a[74:75], v46 offset:13824
  ds_read_b64_tr_b16 a[76:77], v47 offset:12288
  ds_read_b64_tr_b16 a[78:79], v47 offset:13824
  ds_read_b64_tr_b16 a[80:81], v48 offset:12288
  ds_read_b64_tr_b16 a[82:83], v48 offset:13824
  ds_read_b64_tr_b16 a[84:85], v46 offset:24576
  ds_read_b64_tr_b16 a[86:87], v46 offset:26112
  ds_read_b64_tr_b16 a[88:89], v47 offset:24576
  ds_read_b64_tr_b16 a[90:91], v47 offset:26112
  ds_read_b64_tr_b16 a[92:93], v48 offset:24576
  ds_read_b64_tr_b16 a[94:95], v48 offset:26112
  ds_read_b64_tr_b16 a[96:97], v46 offset:36864
  ds_read_b64_tr_b16 a[98:99], v46 offset:38400
  ds_read_b64_tr_b16 a[100:101], v47 offset:36864
  ds_read_b64_tr_b16 a[102:103], v47 offset:38400
  ds_read_b64_tr_b16 a[104:105], v48 offset:36864
  ds_read_b64_tr_b16 a[106:107], v48 offset:38400
  ds_read_b64_tr_b16 a[108:109], v46 offset:49152
  ds_read_b64_tr_b16 a[110:111], v46 offset:50688
  ds_read_b64_tr_b16 a[112:113], v47 offset:49152
  ds_read_b64_tr_b16 a[114:115], v47 offset:50688
  ds_read_b64_tr_b16 a[116:117], v48 offset:49152
  ds_read_b64_tr_b16 a[118:119], v48 offset:50688
  s_waitcnt lgkmcnt(0)
  s_barrier
  s_waitcnt vmcnt(31)
  ds_write_b128 v49, v[124:127] offset:0
  ds_write_b128 v49, v[128:131] offset:1024
  ds_write_b128 v49, v[132:135] offset:2048
  ds_write_b128 v49, v[136:139] offset:3072
  ds_write_b128 v49, v[140:143] offset:4096
  ds_write_b128 v49, v[144:147] offset:5120
  ds_write_b128 v49, v[148:151] offset:6144
  ds_write_b128 v49, v[152:155] offset:7168
  ds_write_b128 v49, v[156:159] offset:8192
  ds_write_b128 v49, v[160:163] offset:9216
  ds_write_b128 v49, v[164:167] offset:10240
  ds_write_b128 v49, v[168:171] offset:11264
  ds_write_b128 v49, v[172:175] offset:12288
  ds_write_b128 v49, v[176:179] offset:13312
  ds_write_b128 v49, v[180:183] offset:14336
  s_waitcnt lgkmcnt(0)
  s_barrier
  ds_read_b64_tr_b16 a[120:121], v46 offset:0
  ds_read_b64_tr_b16 a[122:123], v46 offset:1536
  ds_read_b64_tr_b16 a[124:125], v47 offset:0
  ds_read_b64_tr_b16 a[126:127], v47 offset:1536
  ds_read_b64_tr_b16 a[128:129], v48 offset:0
  ds_read_b64_tr_b16 a[130:131], v48 offset:1536
  ds_read_b64_tr_b16 a[132:133], v46 offset:12288
  ds_read_b64_tr_b16 a[134:135], v46 offset:13824
  ds_read_b64_tr_b16 a[136:137], v47 offset:12288
  ds_read_b64_tr_b16 a[138:139], v47 offset:13824
  ds_read_b64_tr_b16 a[140:141], v48 offset:12288
  ds_read_b64_tr_b16 a[142:143], v48 offset:13824
  ds_read_b64_tr_b16 a[144:145], v46 offset:24576
  ds_read_b64_tr_b16 a[146:147], v46 offset:26112
  ds_read_b64_tr_b16 a[148:149], v47 offset:24576
  ds_read_b64_tr_b16 a[150:151], v47 offset:26112
  ds_read_b64_tr_b16 a[152:153], v48 offset:24576
  ds_read_b64_tr_b16 a[154:155], v48 offset:26112
  ds_read_b64_tr_b16 a[156:157], v46 offset:36864
  ds_read_b64_tr_b16 a[158:159], v46 offset:38400
  ds_read_b64_tr_b16 a[160:161], v47 offset:36864
  ds_read_b64_tr_b16 a[162:163], v47 offset:38400
  ds_read_b64_tr_b16 a[164:165], v48 offset:36864
  ds_read_b64_tr_b16 a[166:167], v48 offset:38400
  ds_read_b64_tr_b16 a[168:169], v46 offset:49152
  ds_read_b64_tr_b16 a[170:171], v46 offset:50688
  ds_read_b64_tr_b16 a[172:173], v47 offset:49152
  ds_read_b64_tr_b16 a[174:175], v47 offset:50688
  ds_read_b64_tr_b16 a[176:177], v48 offset:49152
  ds_read_b64_tr_b16 a[178:179], v48 offset:50688
  s_waitcnt lgkmcnt(0)
  s_barrier
  s_waitcnt vmcnt(16)
  ds_write_b128 v49, v[184:187] offset:0
  ds_write_b128 v49, v[188:191] offset:1024
  ds_write_b128 v49, v[192:195] offset:2048
  ds_write_b128 v49, v[196:199] offset:3072
  ds_write_b128 v49, v[200:203] offset:4096
  ds_write_b128 v49, v[204:207] offset:5120
  ds_write_b128 v49, v[208:211] offset:6144
  ds_write_b128 v49, v[212:215] offset:7168
  ds_write_b128 v49, v[216:219] offset:8192
  ds_write_b128 v49, v[220:223] offset:9216
  ds_write_b128 v49, v[224:227] offset:10240
  ds_write_b128 v49, v[228:231] offset:11264
  ds_write_b128 v49, v[232:235] offset:12288
  ds_write_b128 v49, v[236:239] offset:13312
  ds_write_b128 v49, v[240:243] offset:14336
  s_waitcnt lgkmcnt(0)
  s_barrier
  ds_read_b64_tr_b16 a[180:181], v46 offset:0
  ds_read_b64_tr_b16 a[182:183], v46 offset:1536
  ds_read_b64_tr_b16 a[184:185], v47 offset:0
  ds_read_b64_tr_b16 a[186:187], v47 offset:1536
  ds_read_b64_tr_b16 a[188:189], v48 offset:0
  ds_read_b64_tr_b16 a[190:191], v48 offset:1536
  ds_read_b64_tr_b16 a[192:193], v46 offset:12288
  ds_read_b64_tr_b16 a[194:195], v46 offset:13824
  ds_read_b64_tr_b16 a[196:197], v47 offset:12288
  ds_read_b64_tr_b16 a[198:199], v47 offset:13824
  ds_read_b64_tr_b16 a[200:201], v48 offset:12288
  ds_read_b64_tr_b16 a[202:203], v48 offset:13824
  ds_read_b64_tr_b16 a[204:205], v46 offset:24576
  ds_read_b64_tr_b16 a[206:207], v46 offset:26112
  ds_read_b64_tr_b16 a[208:209], v47 offset:24576
  ds_read_b64_tr_b16 a[210:211], v47 offset:26112
  ds_read_b64_tr_b16 a[212:213], v48 offset:24576
  ds_read_b64_tr_b16 a[214:215], v48 offset:26112
  ds_read_b64_tr_b16 a[216:217], v46 offset:36864
  ds_read_b64_tr_b16 a[218:219], v46 offset:38400
  ds_read_b64_tr_b16 a[220:221], v47 offset:36864
  ds_read_b64_tr_b16 a[222:223], v47 offset:38400
  ds_read_b64_tr_b16 a[224:225], v48 offset:36864
  ds_read_b64_tr_b16 a[226:227], v48 offset:38400
  ds_read_b64_tr_b16 a[228:229], v46 offset:49152
  ds_read_b64_tr_b16 a[230:231], v46 offset:50688
  ds_read_b64_tr_b16 a[232:233], v47 offset:49152
  ds_read_b64_tr_b16 a[234:235], v47 offset:50688
  ds_read_b64_tr_b16 a[236:237], v48 offset:49152
  ds_read_b64_tr_b16 a[238:239], v48 offset:50688
  s_waitcnt lgkmcnt(0)
  s_barrier
  s_mov_b32 s26, 3
  s_mul_i32 s27, s42, 12288
  s_lshl_b32 s60, s42, 7
  s_add_u32 s60, s60, 112640
  s_mov_b32 s62, 0
  s_branch kv_main
kv_fin:
  s_cmp_eq_u32 s43, 2
  s_cbranch_scc1 q_final
  s_branch queue
not_kv:
  s_cmp_ge_u32 s3, 96
  s_cbranch_scc1 not_vw
  s_sub_u32 s2, s3, 64
  s_load_dwordx2 s[72:73], s[0:1], 104
  s_waitcnt lgkmcnt(0)
  s_add_u32 s72, s72, 81068032
  s_addc_u32 s73, s73, 0
  s_mov_b32 s74, 116736
  s_mov_b32 s75, 0x00020000
  s_add_u32 s8, s38, 78643200
  s_addc_u32 s9, s39, 0
  s_mov_b32 s10, 2162688
  s_mov_b32 s11, 0x00020000
  s_add_u32 s12, s38, 50331648
  s_addc_u32 s13, s39, 0
  s_mov_b32 s14, 12582912
  s_mov_b32 s15, 0x00020000
  s_add_u32 s16, s38, 83886079
  s_addc_u32 s17, s39, 0
  s_and_b32 s16, s16, 0xffe00000
  s_mov_b32 s18, 2097152
  s_mov_b32 s19, 0x00020000
  v_lshlrev_b32 v8, 4, v0
  v_lshlrev_b32 v9, 4, v1
  v_mov_b32 v4, 0
  v_mov_b32 v12, -1
  v_mov_b32 v5, 0
  v_mov_b32 v13, -1
  v_mov_b32 v6, 0
  v_mov_b32 v14, -1
  v_mov_b32 v7, 0
  v_mov_b32 v15, -1
  s_lshl_b32 s21, s2, 12
  buffer_store_dwordx4 v[4:7], v8, s[72:75], s21 offen sc1
  s_lshr_b32 s21, s2, 3
  s_lshl_b32 s21, s21, 15
  s_bfe_u32 s22, s2, 0x10002
  s_lshl_b32 s22, s22, 13
  s_add_u32 s21, s21, s22
  s_bfe_u32 s22, s2, 0x10001
  s_lshl_b32 s22, s22, 14
  s_add_u32 s21, s21, s22
  s_and_b32 s22, s2, 1
  s_mul_i32 s22, s22, 3
  s_add_u32 s22, s22, s20
  s_lshl_b32 s22, s22, 10
  s_add_u32 s21, s21, s22
  s_cmp_lt_u32 s20, 3
  s_cselect_b32 s21, s21, 0x80000000
  buffer_store_dwordx4 v[4:7], v9, s[16:19], s21 offen sc1
  s_mul_i32 s23, s20, 540672
  s_lshl_b32 s21, s2, 11
  s_add_u32 s21, s21, s23
  s_add_u32 s21, s21, 81920
  buffer_store_dwordx4 v[12:15], v9, s[8:11], s21 offen sc1
  buffer_store_dwordx4 v[12:15], v9, s[8:11], s21 offen offset:1024 sc1
  s_mul_i32 s21, s2, 3072
  s_add_u32 s21, s21, s23
  s_add_u32 s21, s21, 278528
  buffer_store_dwordx4 v[12:15], v9, s[8:11], s21 offen sc1
  buffer_store_dwordx4 v[12:15], v9, s[8:11], s21 offen offset:1024 sc1
  buffer_store_dwordx4 v[12:15], v9, s[8:11], s21 offen offset:2048 sc1
  s_lshl_b32 s21, s2, 9
  s_add_u32 s21, s21, s23
  s_add_u32 s21, s21, 376832
  s_mov_b64 exec, 0xffffffff
  buffer_store_dwordx4 v[12:15], v9, s[8:11], s21 offen sc1
  s_mov_b64 exec, -1
  s_lshl_b32 s21, s20, 5
  s_add_u32 s21, s21, s2
  s_mul_i32 s21, s21, 3072
  s_cmp_lt_u32 s20, 3
  s_cselect_b32 s21, s21, 0x80000000
  s_add_u32 s22, s21, 6291456
  buffer_store_dwordx4 v[12:15], v9, s[12:15], s21 offen offset:0 sc1
  buffer_store_dwordx4 v[12:15], v9, s[12:15], s22 offen offset:0 sc1
  buffer_store_dwordx4 v[12:15], v9, s[12:15], s21 offen offset:1024 sc1
  buffer_store_dwordx4 v[12:15], v9, s[12:15], s22 offen offset:1024 sc1
  buffer_store_dwordx4 v[12:15], v9, s[12:15], s21 offen offset:2048 sc1
  buffer_store_dwordx4 v[12:15], v9, s[12:15], s22 offen offset:2048 sc1
  s_waitcnt vmcnt(0)
  s_barrier
  s_mov_b32 s21, 76
  s_cmp_lg_u32 s20, 0
  s_cbranch_scc1 af_188
  v_mov_b32 v10, 0
  v_mov_b32 v11, 1
  s_mov_b64 exec, 1
  buffer_atomic_add v11, v10, s[32:35], s21 offen sc1
  s_mov_b64 exec, -1
  s_nop 1
af_188:
  s_load_dwordx2 s[6:7], s[0:1], 40
  s_load_dwordx2 s[38:39], s[0:1], 104
  s_waitcnt lgkmcnt(0)
  s_mov_b32 s12, s6
  s_mov_b32 s13, s7
  s_mov_b32 s14, 7864320
  s_mov_b32 s15, 0x00020000
  s_mov_b32 s16, s38
  s_mov_b32 s17, s39
  s_mov_b32 s18, 50331648
  s_mov_b32 s19, 0x00020000
  s_add_u32 s24, s38, 122683392
  s_addc_u32 s25, s39, 0
  s_mov_b32 s26, 83886080
  s_mov_b32 s27, 0x00020000
  s_load_dwordx2 s[72:73], s[0:1], 104
  s_waitcnt lgkmcnt(0)
  s_add_u32 s72, s72, 81068032
  s_addc_u32 s73, s73, 0
  s_mov_b32 s74, 116736
  s_mov_b32 s75, 0x00020000
  v_mov_b32 v29, 52429
  s_mul_i32 s21, s20, 960
  s_add_u32 s21, s21, 0
  v_add_u32 v21, s21, v1
  v_mul_u32_u24 v22, v21, v29
  v_lshrrev_b32 v22, 22, v22
  v_mul_u32_u24 v23, 80, v22
  v_sub_u32 v21, v21, v23
  v_bfe_u32 v23, v22, 3, 1
  v_and_b32 v24, 3, v22
  v_lshl_add_u32 v23, v23, 2, v24
  v_lshlrev_b32 v23, 1, v23
  v_xor_b32 v21, v21, v23
  v_cmp_gt_u32 vcc, 32, v22
  v_bfe_u32 v26, v22, 3, 2
  v_lshl_add_u32 v25, v26, 2, v24
  v_bfe_u32 v26, v22, 2, 1
  v_lshl_add_u32 v25, v26, 4, v25
  v_cndmask_b32 v25, v22, v25, vcc
  v_mul_u32_u24 v25, 1280, v25
  v_lshl_add_u32 v64, v21, 4, v25
  s_mul_i32 s21, s20, 960
  s_add_u32 s21, s21, 64
  v_add_u32 v21, s21, v1
  v_mul_u32_u24 v22, v21, v29
  v_lshrrev_b32 v22, 22, v22
  v_mul_u32_u24 v23, 80, v22
  v_sub_u32 v21, v21, v23
  v_bfe_u32 v23, v22, 3, 1
  v_and_b32 v24, 3, v22
  v_lshl_add_u32 v23, v23, 2, v24
  v_lshlrev_b32 v23, 1, v23
  v_xor_b32 v21, v21, v23
  v_cmp_gt_u32 vcc, 32, v22
  v_bfe_u32 v26, v22, 3, 2
  v_lshl_add_u32 v25, v26, 2, v24
  v_bfe_u32 v26, v22, 2, 1
  v_lshl_add_u32 v25, v26, 4, v25
  v_cndmask_b32 v25, v22, v25, vcc
  v_mul_u32_u24 v25, 1280, v25
  v_lshl_add_u32 v65, v21, 4, v25
  s_mul_i32 s21, s20, 960
  s_add_u32 s21, s21, 128
  v_add_u32 v21, s21, v1
  v_mul_u32_u24 v22, v21, v29
  v_lshrrev_b32 v22, 22, v22
  v_mul_u32_u24 v23, 80, v22
  v_sub_u32 v21, v21, v23
  v_bfe_u32 v23, v22, 3, 1
  v_and_b32 v24, 3, v22
  v_lshl_add_u32 v23, v23, 2, v24
  v_lshlrev_b32 v23, 1, v23
  v_xor_b32 v21, v21, v23
  v_cmp_gt_u32 vcc, 32, v22
  v_bfe_u32 v26, v22, 3, 2
  v_lshl_add_u32 v25, v26, 2, v24
  v_bfe_u32 v26, v22, 2, 1
  v_lshl_add_u32 v25, v26, 4, v25
  v_cndmask_b32 v25, v22, v25, vcc
  v_mul_u32_u24 v25, 1280, v25
  v_lshl_add_u32 v66, v21, 4, v25
  s_mul_i32 s21, s20, 960
  s_add_u32 s21, s21, 192
  v_add_u32 v21, s21, v1
  v_mul_u32_u24 v22, v21, v29
  v_lshrrev_b32 v22, 22, v22
  v_mul_u32_u24 v23, 80, v22
  v_sub_u32 v21, v21, v23
  v_bfe_u32 v23, v22, 3, 1
  v_and_b32 v24, 3, v22
  v_lshl_add_u32 v23, v23, 2, v24
  v_lshlrev_b32 v23, 1, v23
  v_xor_b32 v21, v21, v23
  v_cmp_gt_u32 vcc, 32, v22
  v_bfe_u32 v26, v22, 3, 2
  v_lshl_add_u32 v25, v26, 2, v24
  v_bfe_u32 v26, v22, 2, 1
  v_lshl_add_u32 v25, v26, 4, v25
  v_cndmask_b32 v25, v22, v25, vcc
  v_mul_u32_u24 v25, 1280, v25
  v_lshl_add_u32 v67, v21, 4, v25
  s_mul_i32 s21, s20, 960
  s_add_u32 s21, s21, 256
  v_add_u32 v21, s21, v1
  v_mul_u32_u24 v22, v21, v29
  v_lshrrev_b32 v22, 22, v22
  v_mul_u32_u24 v23, 80, v22
  v_sub_u32 v21, v21, v23
  v_bfe_u32 v23, v22, 3, 1
  v_and_b32 v24, 3, v22
  v_lshl_add_u32 v23, v23, 2, v24
  v_lshlrev_b32 v23, 1, v23
  v_xor_b32 v21, v21, v23
  v_cmp_gt_u32 vcc, 32, v22
  v_bfe_u32 v26, v22, 3, 2
  v_lshl_add_u32 v25, v26, 2, v24
  v_bfe_u32 v26, v22, 2, 1
  v_lshl_add_u32 v25, v26, 4, v25
  v_cndmask_b32 v25, v22, v25, vcc
  v_mul_u32_u24 v25, 1280, v25
  v_lshl_add_u32 v68, v21, 4, v25
  s_mul_i32 s21, s20, 960
  s_add_u32 s21, s21, 320
  v_add_u32 v21, s21, v1
  v_mul_u32_u24 v22, v21, v29
  v_lshrrev_b32 v22, 22, v22
  v_mul_u32_u24 v23, 80, v22
  v_sub_u32 v21, v21, v23
  v_bfe_u32 v23, v22, 3, 1
  v_and_b32 v24, 3, v22
  v_lshl_add_u32 v23, v23, 2, v24
  v_lshlrev_b32 v23, 1, v23
  v_xor_b32 v21, v21, v23
  v_cmp_gt_u32 vcc, 32, v22
  v_bfe_u32 v26, v22, 3, 2
  v_lshl_add_u32 v25, v26, 2, v24
  v_bfe_u32 v26, v22, 2, 1
  v_lshl_add_u32 v25, v26, 4, v25
  v_cndmask_b32 v25, v22, v25, vcc
  v_mul_u32_u24 v25, 1280, v25
  v_lshl_add_u32 v69, v21, 4, v25
  s_mul_i32 s21, s20, 960
  s_add_u32 s21, s21, 384
  v_add_u32 v21, s21, v1
  v_mul_u32_u24 v22, v21, v29
  v_lshrrev_b32 v22, 22, v22
  v_mul_u32_u24 v23, 80, v22
  v_sub_u32 v21, v21, v23
  v_bfe_u32 v23, v22, 3, 1
  v_and_b32 v24, 3, v22
  v_lshl_add_u32 v23, v23, 2, v24
  v_lshlrev_b32 v23, 1, v23
  v_xor_b32 v21, v21, v23
  v_cmp_gt_u32 vcc, 32, v22
  v_bfe_u32 v26, v22, 3, 2
  v_lshl_add_u32 v25, v26, 2, v24
  v_bfe_u32 v26, v22, 2, 1
  v_lshl_add_u32 v25, v26, 4, v25
  v_cndmask_b32 v25, v22, v25, vcc
  v_mul_u32_u24 v25, 1280, v25
  v_lshl_add_u32 v70, v21, 4, v25
  s_mul_i32 s21, s20, 960
  s_add_u32 s21, s21, 448
  v_add_u32 v21, s21, v1
  v_mul_u32_u24 v22, v21, v29
  v_lshrrev_b32 v22, 22, v22
  v_mul_u32_u24 v23, 80, v22
  v_sub_u32 v21, v21, v23
  v_bfe_u32 v23, v22, 3, 1
  v_and_b32 v24, 3, v22
  v_lshl_add_u32 v23, v23, 2, v24
  v_lshlrev_b32 v23, 1, v23
  v_xor_b32 v21, v21, v23
  v_cmp_gt_u32 vcc, 32, v22
  v_bfe_u32 v26, v22, 3, 2
  v_lshl_add_u32 v25, v26, 2, v24
  v_bfe_u32 v26, v22, 2, 1
  v_lshl_add_u32 v25, v26, 4, v25
  v_cndmask_b32 v25, v22, v25, vcc
  v_mul_u32_u24 v25, 1280, v25
  v_lshl_add_u32 v71, v21, 4, v25
  s_mul_i32 s21, s20, 960
  s_add_u32 s21, s21, 512
  v_add_u32 v21, s21, v1
  v_mul_u32_u24 v22, v21, v29
  v_lshrrev_b32 v22, 22, v22
  v_mul_u32_u24 v23, 80, v22
  v_sub_u32 v21, v21, v23
  v_bfe_u32 v23, v22, 3, 1
  v_and_b32 v24, 3, v22
  v_lshl_add_u32 v23, v23, 2, v24
  v_lshlrev_b32 v23, 1, v23
  v_xor_b32 v21, v21, v23
  v_cmp_gt_u32 vcc, 32, v22
  v_bfe_u32 v26, v22, 3, 2
  v_lshl_add_u32 v25, v26, 2, v24
  v_bfe_u32 v26, v22, 2, 1
  v_lshl_add_u32 v25, v26, 4, v25
  v_cndmask_b32 v25, v22, v25, vcc
  v_mul_u32_u24 v25, 1280, v25
  v_lshl_add_u32 v72, v21, 4, v25
  s_mul_i32 s21, s20, 960
  s_add_u32 s21, s21, 576
  v_add_u32 v21, s21, v1
  v_mul_u32_u24 v22, v21, v29
  v_lshrrev_b32 v22, 22, v22
  v_mul_u32_u24 v23, 80, v22
  v_sub_u32 v21, v21, v23
  v_bfe_u32 v23, v22, 3, 1
  v_and_b32 v24, 3, v22
  v_lshl_add_u32 v23, v23, 2, v24
  v_lshlrev_b32 v23, 1, v23
  v_xor_b32 v21, v21, v23
  v_cmp_gt_u32 vcc, 32, v22
  v_bfe_u32 v26, v22, 3, 2
  v_lshl_add_u32 v25, v26, 2, v24
  v_bfe_u32 v26, v22, 2, 1
  v_lshl_add_u32 v25, v26, 4, v25
  v_cndmask_b32 v25, v22, v25, vcc
  v_mul_u32_u24 v25, 1280, v25
  v_lshl_add_u32 v73, v21, 4, v25
  s_mul_i32 s21, s20, 960
  s_add_u32 s21, s21, 640
  v_add_u32 v21, s21, v1
  v_mul_u32_u24 v22, v21, v29
  v_lshrrev_b32 v22, 22, v22
  v_mul_u32_u24 v23, 80, v22
  v_sub_u32 v21, v21, v23
  v_bfe_u32 v23, v22, 3, 1
  v_and_b32 v24, 3, v22
  v_lshl_add_u32 v23, v23, 2, v24
  v_lshlrev_b32 v23, 1, v23
  v_xor_b32 v21, v21, v23
  v_cmp_gt_u32 vcc, 32, v22
  v_bfe_u32 v26, v22, 3, 2
  v_lshl_add_u32 v25, v26, 2, v24
  v_bfe_u32 v26, v22, 2, 1
  v_lshl_add_u32 v25, v26, 4, v25
  v_cndmask_b32 v25, v22, v25, vcc
  v_mul_u32_u24 v25, 1280, v25
  v_lshl_add_u32 v74, v21, 4, v25
  s_mul_i32 s21, s20, 960
  s_add_u32 s21, s21, 704
  v_add_u32 v21, s21, v1
  v_mul_u32_u24 v22, v21, v29
  v_lshrrev_b32 v22, 22, v22
  v_mul_u32_u24 v23, 80, v22
  v_sub_u32 v21, v21, v23
  v_bfe_u32 v23, v22, 3, 1
  v_and_b32 v24, 3, v22
  v_lshl_add_u32 v23, v23, 2, v24
  v_lshlrev_b32 v23, 1, v23
  v_xor_b32 v21, v21, v23
  v_cmp_gt_u32 vcc, 32, v22
  v_bfe_u32 v26, v22, 3, 2
  v_lshl_add_u32 v25, v26, 2, v24
  v_bfe_u32 v26, v22, 2, 1
  v_lshl_add_u32 v25, v26, 4, v25
  v_cndmask_b32 v25, v22, v25, vcc
  v_mul_u32_u24 v25, 1280, v25
  v_lshl_add_u32 v75, v21, 4, v25
  s_mul_i32 s21, s20, 960
  s_add_u32 s21, s21, 768
  v_add_u32 v21, s21, v1
  v_mul_u32_u24 v22, v21, v29
  v_lshrrev_b32 v22, 22, v22
  v_mul_u32_u24 v23, 80, v22
  v_sub_u32 v21, v21, v23
  v_bfe_u32 v23, v22, 3, 1
  v_and_b32 v24, 3, v22
  v_lshl_add_u32 v23, v23, 2, v24
  v_lshlrev_b32 v23, 1, v23
  v_xor_b32 v21, v21, v23
  v_cmp_gt_u32 vcc, 32, v22
  v_bfe_u32 v26, v22, 3, 2
  v_lshl_add_u32 v25, v26, 2, v24
  v_bfe_u32 v26, v22, 2, 1
  v_lshl_add_u32 v25, v26, 4, v25
  v_cndmask_b32 v25, v22, v25, vcc
  v_mul_u32_u24 v25, 1280, v25
  v_lshl_add_u32 v76, v21, 4, v25
  s_mul_i32 s21, s20, 960
  s_add_u32 s21, s21, 832
  v_add_u32 v21, s21, v1
  v_mul_u32_u24 v22, v21, v29
  v_lshrrev_b32 v22, 22, v22
  v_mul_u32_u24 v23, 80, v22
  v_sub_u32 v21, v21, v23
  v_bfe_u32 v23, v22, 3, 1
  v_and_b32 v24, 3, v22
  v_lshl_add_u32 v23, v23, 2, v24
  v_lshlrev_b32 v23, 1, v23
  v_xor_b32 v21, v21, v23
  v_cmp_gt_u32 vcc, 32, v22
  v_bfe_u32 v26, v22, 3, 2
  v_lshl_add_u32 v25, v26, 2, v24
  v_bfe_u32 v26, v22, 2, 1
  v_lshl_add_u32 v25, v26, 4, v25
  v_cndmask_b32 v25, v22, v25, vcc
  v_mul_u32_u24 v25, 1280, v25
  v_lshl_add_u32 v77, v21, 4, v25
  s_mul_i32 s21, s20, 960
  s_add_u32 s21, s21, 896
  v_add_u32 v21, s21, v1
  v_mul_u32_u24 v22, v21, v29
  v_lshrrev_b32 v22, 22, v22
  v_mul_u32_u24 v23, 80, v22
  v_sub_u32 v21, v21, v23
  v_bfe_u32 v23, v22, 3, 1
  v_and_b32 v24, 3, v22
  v_lshl_add_u32 v23, v23, 2, v24
  v_lshlrev_b32 v23, 1, v23
  v_xor_b32 v21, v21, v23
  v_cmp_gt_u32 vcc, 32, v22
  v_bfe_u32 v26, v22, 3, 2
  v_lshl_add_u32 v25, v26, 2, v24
  v_bfe_u32 v26, v22, 2, 1
  v_lshl_add_u32 v25, v26, 4, v25
  v_cndmask_b32 v25, v22, v25, vcc
  v_mul_u32_u24 v25, 1280, v25
  v_lshl_add_u32 v78, v21, 4, v25
  s_mul_i32 s40, s2, 245760
  s_sleep 32
  s_add_u32 s21, s40, 0
  s_mul_i32 s22, s20, 15360
  s_add_u32 s22, s22, 0
  s_add_u32 m0, s22, 0
  s_nop 0
  buffer_load_dwordx4 v64, s[12:15], s21 offen lds
  s_add_u32 m0, s22, 1024
  s_nop 0
  buffer_load_dwordx4 v65, s[12:15], s21 offen lds
  s_add_u32 m0, s22, 2048
  s_nop 0
  buffer_load_dwordx4 v66, s[12:15], s21 offen lds
  s_add_u32 m0, s22, 3072
  s_nop 0
  buffer_load_dwordx4 v67, s[12:15], s21 offen lds
  s_add_u32 m0, s22, 4096
  s_nop 0
  buffer_load_dwordx4 v68, s[12:15], s21 offen lds
  s_add_u32 m0, s22, 5120
  s_nop 0
  buffer_load_dwordx4 v69, s[12:15], s21 offen lds
  s_add_u32 m0, s22, 6144
  s_nop 0
  buffer_load_dwordx4 v70, s[12:15], s21 offen lds
  s_add_u32 m0, s22, 7168
  s_nop 0
  buffer_load_dwordx4 v71, s[12:15], s21 offen lds
  s_add_u32 m0, s22, 8192
  s_nop 0
  buffer_load_dwordx4 v72, s[12:15], s21 offen lds
  s_add_u32 m0, s22, 9216
  s_nop 0
  buffer_load_dwordx4 v73, s[12:15], s21 offen lds
  s_add_u32 m0, s22, 10240
  s_nop 0
  buffer_load_dwordx4 v74, s[12:15], s21 offen lds
  s_add_u32 m0, s22, 11264
  s_nop 0
  buffer_load_dwordx4 v75, s[12:15], s21 offen lds
  s_add_u32 m0, s22, 12288
  s_nop 0
  buffer_load_dwordx4 v76, s[12:15], s21 offen lds
  s_add_u32 m0, s22, 13312
  s_nop 0
  buffer_load_dwordx4 v77, s[12:15], s21 offen lds
  s_add_u32 m0, s22, 14336
  s_nop 0
  buffer_load_dwordx4 v78, s[12:15], s21 offen lds
  s_add_u32 s21, s40, 61440
  s_mul_i32 s22, s20, 15360
  s_add_u32 s22, s22, 61440
  s_add_u32 m0, s22, 0
  s_nop 0
  buffer_load_dwordx4 v64, s[12:15], s21 offen lds
  s_add_u32 m0, s22, 1024
  s_nop 0
  buffer_load_dwordx4 v65, s[12:15], s21 offen lds
  s_add_u32 m0, s22, 2048
  s_nop 0
  buffer_load_dwordx4 v66, s[12:15], s21 offen lds
  s_add_u32 m0, s22, 3072
  s_nop 0
  buffer_load_dwordx4 v67, s[12:15], s21 offen lds
  s_add_u32 m0, s22, 4096
  s_nop 0
  buffer_load_dwordx4 v68, s[12:15], s21 offen lds
  s_add_u32 m0, s22, 5120
  s_nop 0
  buffer_load_dwordx4 v69, s[12:15], s21 offen lds
  s_add_u32 m0, s22, 6144
  s_nop 0
  buffer_load_dwordx4 v70, s[12:15], s21 offen lds
  s_add_u32 m0, s22, 7168
  s_nop 0
  buffer_load_dwordx4 v71, s[12:15], s21 offen lds
  s_add_u32 m0, s22, 8192
  s_nop 0
  buffer_load_dwordx4 v72, s[12:15], s21 offen lds
  s_add_u32 m0, s22, 9216
  s_nop 0
  buffer_load_dwordx4 v73, s[12:15], s21 offen lds
  s_add_u32 m0, s22, 10240
  s_nop 0
  buffer_load_dwordx4 v74, s[12:15], s21 offen lds
  s_add_u32 m0, s22, 11264
  s_nop 0
  buffer_load_dwordx4 v75, s[12:15], s21 offen lds
  s_add_u32 m0, s22, 12288
  s_nop 0
  buffer_load_dwordx4 v76, s[12:15], s21 offen lds
  s_add_u32 m0, s22, 13312
  s_nop 0
  buffer_load_dwordx4 v77, s[12:15], s21 offen lds
  s_add_u32 m0, s22, 14336
  s_nop 0
  buffer_load_dwordx4 v78, s[12:15], s21 offen lds
  s_add_u32 s21, s40, 122880
  s_mul_i32 s22, s20, 15360
  s_add_u32 s22, s22, 0
  buffer_load_dwordx4 v[80:83], v64, s[12:15], s21 offen
  buffer_load_dwordx4 v[84:87], v65, s[12:15], s21 offen
  buffer_load_dwordx4 v[88:91], v66, s[12:15], s21 offen
  buffer_load_dwordx4 v[92:95], v67, s[12:15], s21 offen
  buffer_load_dwordx4 v[96:99], v68, s[12:15], s21 offen
  buffer_load_dwordx4 v[100:103], v69, s[12:15], s21 offen
  buffer_load_dwordx4 v[104:107], v70, s[12:15], s21 offen
  buffer_load_dwordx4 v[108:111], v71, s[12:15], s21 offen
  buffer_load_dwordx4 v[112:115], v72, s[12:15], s21 offen
  buffer_load_dwordx4 v[116:119], v73, s[12:15], s21 offen
  buffer_load_dwordx4 v[120:123], v74, s[12:15], s21 offen
  buffer_load_dwordx4 v[124:127], v75, s[12:15], s21 offen
  buffer_load_dwordx4 v[128:131], v76, s[12:15], s21 offen
  buffer_load_dwordx4 v[132:135], v77, s[12:15], s21 offen
  buffer_load_dwordx4 v[136:139], v78, s[12:15], s21 offen
  s_add_u32 s21, s40, 184320
  s_mul_i32 s22, s20, 15360
  s_add_u32 s22, s22, 61440
  buffer_load_dwordx4 v[140:143], v64, s[12:15], s21 offen
  buffer_load_dwordx4 v[144:147], v65, s[12:15], s21 offen
  buffer_load_dwordx4 v[148:151], v66, s[12:15], s21 offen
  buffer_load_dwordx4 v[152:155], v67, s[12:15], s21 offen
  buffer_load_dwordx4 v[156:159], v68, s[12:15], s21 offen
  buffer_load_dwordx4 v[160:163], v69, s[12:15], s21 offen
  buffer_load_dwordx4 v[164:167], v70, s[12:15], s21 offen
  buffer_load_dwordx4 v[168:171], v71, s[12:15], s21 offen
  buffer_load_dwordx4 v[172:175], v72, s[12:15], s21 offen
  buffer_load_dwordx4 v[176:179], v73, s[12:15], s21 offen
  buffer_load_dwordx4 v[180:183], v74, s[12:15], s21 offen
  buffer_load_dwordx4 v[184:187], v75, s[12:15], s21 offen
  buffer_load_dwordx4 v[188:191], v76, s[12:15], s21 offen
  buffer_load_dwordx4 v[192:195], v77, s[12:15], s21 offen
  buffer_load_dwordx4 v[196:199], v78, s[12:15], s21 offen
  v_lshrrev_b32 v6, 2, v2
  v_lshl_add_u32 v7, v3, 3, v6
  v_mul_u32_u24 v7, 1280, v7
  v_and_b32 v8, 1, v2
  v_lshl_add_u32 v7, v8, 3, v7
  v_and_b32 v8, 1, v3
  v_lshl_add_u32 v6, v8, 2, v6
  v_lshlrev_b32 v6, 1, v6
  v_bfe_u32 v8, v2, 1, 1
  s_mul_i32 s21, s20, 20
  v_add_u32 v8, s21, v8
  v_add_u32 v5, 0, v8
  v_xor_b32 v5, v5, v6
  v_lshl_add_u32 v200, v5, 4, v7
  v_add_u32 v210, 81920, v200
  v_add_u32 v5, 2, v8
  v_xor_b32 v5, v5, v6
  v_lshl_add_u32 v201, v5, 4, v7
  v_add_u32 v211, 81920, v201
  v_add_u32 v5, 4, v8
  v_xor_b32 v5, v5, v6
  v_lshl_add_u32 v202, v5, 4, v7
  v_add_u32 v212, 81920, v202
  v_add_u32 v5, 6, v8
  v_xor_b32 v5, v5, v6
  v_lshl_add_u32 v203, v5, 4, v7
  v_add_u32 v213, 81920, v203
  v_add_u32 v5, 8, v8
  v_xor_b32 v5, v5, v6
  v_lshl_add_u32 v204, v5, 4, v7
  v_add_u32 v214, 81920, v204
  v_add_u32 v5, 10, v8
  v_xor_b32 v5, v5, v6
  v_lshl_add_u32 v205, v5, 4, v7
  v_add_u32 v215, 81920, v205
  v_add_u32 v5, 12, v8
  v_xor_b32 v5, v5, v6
  v_lshl_add_u32 v206, v5, 4, v7
  v_add_u32 v216, 81920, v206
  v_add_u32 v5, 14, v8
  v_xor_b32 v5, v5, v6
  v_lshl_add_u32 v207, v5, 4, v7
  v_add_u32 v217, 81920, v207
  v_add_u32 v5, 16, v8
  v_xor_b32 v5, v5, v6
  v_lshl_add_u32 v208, v5, 4, v7
  v_add_u32 v218, 81920, v208
  v_add_u32 v5, 18, v8
  v_xor_b32 v5, v5, v6
  v_lshl_add_u32 v209, v5, 4, v7
  v_add_u32 v219, 81920, v209
  s_mul_i32 s22, s20, 15360
  v_lshl_add_u32 v30, v1, 4, s22
  v_add_u32 v31, 61440, v30
  s_waitcnt vmcnt(30)
  s_barrier
  ds_read_b64_tr_b16 a[0:1], v200 offset:0
  ds_read_b64_tr_b16 a[2:3], v200 offset:5120
  ds_read_b64_tr_b16 a[24:25], v201 offset:0
  ds_read_b64_tr_b16 a[26:27], v201 offset:5120
  ds_read_b64_tr_b16 a[48:49], v202 offset:0
  ds_read_b64_tr_b16 a[50:51], v202 offset:5120
  ds_read_b64_tr_b16 a[72:73], v203 offset:0
  ds_read_b64_tr_b16 a[74:75], v203 offset:5120
  ds_read_b64_tr_b16 a[96:97], v204 offset:0
  ds_read_b64_tr_b16 a[98:99], v204 offset:5120
  ds_read_b64_tr_b16 a[120:121], v205 offset:0
  ds_read_b64_tr_b16 a[122:123], v205 offset:5120
  ds_read_b64_tr_b16 a[144:145], v206 offset:0
  ds_read_b64_tr_b16 a[146:147], v206 offset:5120
  ds_read_b64_tr_b16 a[168:169], v207 offset:0
  ds_read_b64_tr_b16 a[170:171], v207 offset:5120
  ds_read_b64_tr_b16 a[192:193], v208 offset:0
  ds_read_b64_tr_b16 a[194:195], v208 offset:5120
  ds_read_b64_tr_b16 a[216:217], v209 offset:0
  ds_read_b64_tr_b16 a[218:219], v209 offset:5120
  ds_read_b64_tr_b16 a[4:5], v200 offset:40960
  ds_read_b64_tr_b16 a[6:7], v200 offset:46080
  ds_read_b64_tr_b16 a[28:29], v201 offset:40960
  ds_read_b64_tr_b16 a[30:31], v201 offset:46080
  ds_read_b64_tr_b16 a[52:53], v202 offset:40960
  ds_read_b64_tr_b16 a[54:55], v202 offset:46080
  ds_read_b64_tr_b16 a[76:77], v203 offset:40960
  ds_read_b64_tr_b16 a[78:79], v203 offset:46080
  ds_read_b64_tr_b16 a[100:101], v204 offset:40960
  ds_read_b64_tr_b16 a[102:103], v204 offset:46080
  ds_read_b64_tr_b16 a[124:125], v205 offset:40960
  ds_read_b64_tr_b16 a[126:127], v205 offset:46080
  ds_read_b64_tr_b16 a[148:149], v206 offset:40960
  ds_read_b64_tr_b16 a[150:151], v206 offset:46080
  ds_read_b64_tr_b16 a[172:173], v207 offset:40960
  ds_read_b64_tr_b16 a[174:175], v207 offset:46080
  ds_read_b64_tr_b16 a[196:197], v208 offset:40960
  ds_read_b64_tr_b16 a[198:199], v208 offset:46080
  ds_read_b64_tr_b16 a[220:221], v209 offset:40960
  ds_read_b64_tr_b16 a[222:223], v209 offset:46080
  ds_read_b64_tr_b16 a[8:9], v210 offset:0
  ds_read_b64_tr_b16 a[10:11], v210 offset:5120
  ds_read_b64_tr_b16 a[32:33], v211 offset:0
  ds_read_b64_tr_b16 a[34:35], v211 offset:5120
  ds_read_b64_tr_b16 a[56:57], v212 offset:0
  ds_read_b64_tr_b16 a[58:59], v212 offset:5120
  ds_read_b64_tr_b16 a[80:81], v213 offset:0
  ds_read_b64_tr_b16 a[82:83], v213 offset:5120
  ds_read_b64_tr_b16 a[104:105], v214 offset:0
  ds_read_b64_tr_b16 a[106:107], v214 offset:5120
  ds_read_b64_tr_b16 a[128:129], v215 offset:0
  ds_read_b64_tr_b16 a[130:131], v215 offset:5120
  ds_read_b64_tr_b16 a[152:153], v216 offset:0
  ds_read_b64_tr_b16 a[154:155], v216 offset:5120
  ds_read_b64_tr_b16 a[176:177], v217 offset:0
  ds_read_b64_tr_b16 a[178:179], v217 offset:5120
  ds_read_b64_tr_b16 a[200:201], v218 offset:0
  ds_read_b64_tr_b16 a[202:203], v218 offset:5120
  ds_read_b64_tr_b16 a[224:225], v219 offset:0
  ds_read_b64_tr_b16 a[226:227], v219 offset:5120
  s_waitcnt lgkmcnt(0)
  s_barrier
  s_waitcnt vmcnt(15)
  ds_write_b128 v30, v[80:83] offset:0
  ds_write_b128 v30, v[84:87] offset:1024
  ds_write_b128 v30, v[88:91] offset:2048
  ds_write_b128 v30, v[92:95] offset:3072
  ds_write_b128 v30, v[96:99] offset:4096
  ds_write_b128 v30, v[100:103] offset:5120
  ds_write_b128 v30, v[104:107] offset:6144
  ds_write_b128 v30, v[108:111] offset:7168
  ds_write_b128 v30, v[112:115] offset:8192
  ds_write_b128 v30, v[116:119] offset:9216
  ds_write_b128 v30, v[120:123] offset:10240
  ds_write_b128 v30, v[124:127] offset:11264
  ds_write_b128 v30, v[128:131] offset:12288
  ds_write_b128 v30, v[132:135] offset:13312
  ds_write_b128 v30, v[136:139] offset:14336
  s_waitcnt vmcnt(0)
  ds_write_b128 v31, v[140:143] offset:0
  ds_write_b128 v31, v[144:147] offset:1024
  ds_write_b128 v31, v[148:151] offset:2048
  ds_write_b128 v31, v[152:155] offset:3072
  ds_write_b128 v31, v[156:159] offset:4096
  ds_write_b128 v31, v[160:163] offset:5120
  ds_write_b128 v31, v[164:167] offset:6144
  ds_write_b128 v31, v[168:171] offset:7168
  ds_write_b128 v31, v[172:175] offset:8192
  ds_write_b128 v31, v[176:179] offset:9216
  ds_write_b128 v31, v[180:183] offset:10240
  ds_write_b128 v31, v[184:187] offset:11264
  ds_write_b128 v31, v[188:191] offset:12288
  ds_write_b128 v31, v[192:195] offset:13312
  ds_write_b128 v31, v[196:199] offset:14336
  s_waitcnt lgkmcnt(0)
  s_barrier
  ds_read_b64_tr_b16 a[12:13], v200 offset:0
  ds_read_b64_tr_b16 a[14:15], v200 offset:5120
  ds_read_b64_tr_b16 a[36:37], v201 offset:0
  ds_read_b64_tr_b16 a[38:39], v201 offset:5120
  ds_read_b64_tr_b16 a[60:61], v202 offset:0
  ds_read_b64_tr_b16 a[62:63], v202 offset:5120
  ds_read_b64_tr_b16 a[84:85], v203 offset:0
  ds_read_b64_tr_b16 a[86:87], v203 offset:5120
  ds_read_b64_tr_b16 a[108:109], v204 offset:0
  ds_read_b64_tr_b16 a[110:111], v204 offset:5120
  ds_read_b64_tr_b16 a[132:133], v205 offset:0
  ds_read_b64_tr_b16 a[134:135], v205 offset:5120
  ds_read_b64_tr_b16 a[156:157], v206 offset:0
  ds_read_b64_tr_b16 a[158:159], v206 offset:5120
  ds_read_b64_tr_b16 a[180:181], v207 offset:0
  ds_read_b64_tr_b16 a[182:183], v207 offset:5120
  ds_read_b64_tr_b16 a[204:205], v208 offset:0
  ds_read_b64_tr_b16 a[206:207], v208 offset:5120
  ds_read_b64_tr_b16 a[228:229], v209 offset:0
  ds_read_b64_tr_b16 a[230:231], v209 offset:5120
  ds_read_b64_tr_b16 a[16:17], v200 offset:40960
  ds_read_b64_tr_b16 a[18:19], v200 offset:46080
  ds_read_b64_tr_b16 a[40:41], v201 offset:40960
  ds_read_b64_tr_b16 a[42:43], v201 offset:46080
  ds_read_b64_tr_b16 a[64:65], v202 offset:40960
  ds_read_b64_tr_b16 a[66:67], v202 offset:46080
  ds_read_b64_tr_b16 a[88:89], v203 offset:40960
  ds_read_b64_tr_b16 a[90:91], v203 offset:46080
  ds_read_b64_tr_b16 a[112:113], v204 offset:40960
  ds_read_b64_tr_b16 a[114:115], v204 offset:46080
  ds_read_b64_tr_b16 a[136:137], v205 offset:40960
  ds_read_b64_tr_b16 a[138:139], v205 offset:46080
  ds_read_b64_tr_b16 a[160:161], v206 offset:40960
  ds_read_b64_tr_b16 a[162:163], v206 offset:46080
  ds_read_b64_tr_b16 a[184:185], v207 offset:40960
  ds_read_b64_tr_b16 a[186:187], v207 offset:46080
  ds_read_b64_tr_b16 a[208:209], v208 offset:40960
  ds_read_b64_tr_b16 a[210:211], v208 offset:46080
  ds_read_b64_tr_b16 a[232:233], v209 offset:40960
  ds_read_b64_tr_b16 a[234:235], v209 offset:46080
  ds_read_b64_tr_b16 a[20:21], v210 offset:0
  ds_read_b64_tr_b16 a[22:23], v210 offset:5120
  ds_read_b64_tr_b16 a[44:45], v211 offset:0
  ds_read_b64_tr_b16 a[46:47], v211 offset:5120
  ds_read_b64_tr_b16 a[68:69], v212 offset:0
  ds_read_b64_tr_b16 a[70:71], v212 offset:5120
  ds_read_b64_tr_b16 a[92:93], v213 offset:0
  ds_read_b64_tr_b16 a[94:95], v213 offset:5120
  ds_read_b64_tr_b16 a[116:117], v214 offset:0
  ds_read_b64_tr_b16 a[118:119], v214 offset:5120
  ds_read_b64_tr_b16 a[140:141], v215 offset:0
  ds_read_b64_tr_b16 a[142:143], v215 offset:5120
  ds_read_b64_tr_b16 a[164:165], v216 offset:0
  ds_read_b64_tr_b16 a[166:167], v216 offset:5120
  ds_read_b64_tr_b16 a[188:189], v217 offset:0
  ds_read_b64_tr_b16 a[190:191], v217 offset:5120
  ds_read_b64_tr_b16 a[212:213], v218 offset:0
  ds_read_b64_tr_b16 a[214:215], v218 offset:5120
  ds_read_b64_tr_b16 a[236:237], v219 offset:0
  ds_read_b64_tr_b16 a[238:239], v219 offset:5120
  s_waitcnt lgkmcnt(0)
  s_barrier
  s_load_dwordx2 s[32:33], s[0:1], 96
  s_waitcnt lgkmcnt(0)
  s_mov_b32 s32, s32
  s_mov_b32 s33, s33
  s_mov_b32 s34, 256
  s_mov_b32 s35, 0x00020000
  s_mov_b32 s21, 76
  s_cmp_lg_u32 s20, 0
  s_cbranch_scc1 wf_190
  v_mov_b32 v4, 0
  s_mov_b32 s101, 0
wf_189:
  buffer_load_dword v5, v4, s[32:35], s21 offen sc1
  s_add_u32 s101, s101, 1
  s_cmp_gt_u32 s101, 131072
  s_cbranch_scc1 main_end
  s_waitcnt vmcnt(0)
  v_readfirstlane_b32 s100, v5
  s_cmp_ge_u32 s100, 32
  s_cbranch_scc1 wf_190
  s_sleep 8
  s_branch wf_189
wf_190:
  s_barrier
  s_mul_i32 s41, s2, 12288
  s_add_u32 s47, s41, 25165824
  s_mov_b32 s41, s47
  s_mul_i32 s21, s20, 10
  s_mul_i32 s47, s2, 5
  s_lshr_b32 s22, s21, 3
  s_add_u32 s47, s47, s22
  s_and_b32 s48, s21, 7
  s_mov_b32 s66, 0
  s_mov_b32 s67, 0
  s_lshr_b32 s43, s2, 2
  s_lshl_b32 s43, s43, 7
  s_add_u32 s43, s43, 0
  s_lshl_b32 s44, s2, 7
  s_lshl_b32 s21, s20, 2
  s_add_u32 s44, s44, s21
  s_add_u32 s44, s44, 95232
  s_mov_b32 s45, 0
  s_mov_b32 s49, 1
  s_mov_b32 s50, 0
  v_mov_b32 v10, 0
  v_mov_b32 v11, 1
  v_lshlrev_b32 v4, 4, v1
  s_add_u32 s76, s38, 56623104
  s_addc_u32 s77, s39, 0
  s_mov_b32 s78, 6291456
  s_mov_b32 s79, 0x00020000
  s_add_u32 s80, s38, 101711872
  s_addc_u32 s81, s39, 0
  s_mov_b32 s82, 20971520
  s_mov_b32 s83, 0x00020000
  v_and_b32 v12, 3, v1
  v_lshlrev_b32 v12, 3, v12
  v_add_u32 v12, 4, v12
  v_and_b32 v13, 7, v2
  v_lshlrev_b32 v13, 4, v13
  v_lshl_add_u32 v13, v3, 7, v13
  v_lshrrev_b32 v14, 3, v2
  v_mul_u32_u24 v14, 98304, v14
  v_add_u32 v14, v14, v13
  v_and_b32 v15, 1, v3
  v_lshlrev_b32 v15, 8, v15
  v_lshl_add_u32 v15, v2, 4, v15
  v_lshrrev_b32 v16, 1, v3
  v_mul_u32_u24 v16, 327680, v16
  v_add_u32 v15, v15, v16
  v_lshlrev_b32 v17, 10, v1
  v_mov_b32 v19, 0
  s_lshl_b32 s53, s2, 7
  s_add_u32 s53, s53, 19456
  s_mov_b32 s55, 0
  s_mov_b32 s56, 0
  s_mov_b32 s58, 0
  s_mov_b32 s59, 0
  s_add_u32 s84, s38, 50331648
  s_addc_u32 s85, s39, 0
  s_mov_b32 s86, 12582912
  s_mov_b32 s87, 0x00020000
  s_and_b32 s21, s2, 3
  s_mul_i32 s51, s2, 3072
  s_cmp_eq_u32 s21, s20
  s_cselect_b32 s51, s51, 6291456
  v_mov_b32 v244, -1
  v_mov_b32 v245, -1
  v_mov_b32 v246, -1
  v_mov_b32 v247, -1
  s_add_u32 s88, s38, 85983232
  s_addc_u32 s89, s39, 0
  s_mov_b32 s90, 5242880
  s_mov_b32 s91, 0x00020000
  s_mul_i32 s21, s20, 3072
  s_add_u32 s41, s41, s21
  s_mov_b32 s64, s21
  s_add_u32 s67, s21, 98304
  s_mov_b32 s71, s21
  s_mov_b32 s46, 0
  s_mov_b32 s47, 0
  s_mov_b32 s65, 0
  s_mul_i32 s42, s2, 40960
  s_mul_i32 s21, s20, 10240
  s_add_u32 s42, s42, s21
  s_mov_b32 s68, 0x80000000
  s_mov_b32 s70, 0
  s_mov_b32 s40, 0
  s_mov_b32 s31, 0
  s_mov_b32 s56, s68
  s_mov_b32 s57, s68
  s_lshl_b32 s59, s20, 1
  s_sub_u32 s59, 8, s59
  s_add_u32 s61, s28, 9216
  v_min_u32 v5, 18, v1
  v_lshlrev_b32 v5, 10, v5
  v_mov_b32 v9, 0
  s_lshl_b32 s21, s20, 2
  s_add_u32 s21, s21, 110592
  v_mov_b32 v6, s21
  v_mov_b32 v7, 110592
  s_mul_i32 s51, s2, 3072
  s_lshl_b32 s21, s20, 10
  s_add_u32 s51, s51, s21
  s_cmp_lt_u32 s20, 3
  s_cselect_b32 s51, s51, 6291456
  s_add_u32 s51, s51, 5701632
  s_cmp_lg_u32 s20, 0
  s_cbranch_scc1 wf_192
  v_mov_b32 v20, 0
  s_mov_b32 s101, 0
wf_191:
  buffer_load_dword v21, v20, s[72:75], s43 offen sc1
  s_add_u32 s101, s101, 1
  s_cmp_gt_u32 s101, 131072
  s_cbranch_scc1 main_end
  s_waitcnt vmcnt(0)
  v_readfirstlane_b32 s100, v21
  s_cmp_ge_u32 s100, 8
  s_cbranch_scc1 wf_192
  s_sleep 4
  s_branch wf_191
wf_192:
  s_barrier
  v_writelane_b32 v9, 8, 0
  v_cmp_gt_u32 vcc, 8, v9
  s_nop 0
  s_bitset1_b64 vcc, 19
  s_ff1_i32_b64 s21, vcc
  s_lshl_b32 s22, s21, 1
  s_lshl_b32 s21, s21, 2
  s_sub_i32 s21, s21, 12
  s_max_i32 s47, s21, s22
  s_cmp_gt_u32 s47, s45
  s_cbranch_scc1 va_193
  s_mov_b32 s101, 0
  s_branch va_196
va_194:
  s_sleep 8
va_196:
  buffer_load_dword v9, v5, s[72:75], s43 offen sc1
  s_add_u32 s101, s101, 1
  s_cmp_gt_u32 s101, 131072
  s_cbranch_scc1 main_end
  s_waitcnt vmcnt(0)
  v_cmp_gt_u32 vcc, 8, v9
  s_nop 0
  s_bitset1_b64 vcc, 19
  s_ff1_i32_b64 s21, vcc
  s_lshl_b32 s22, s21, 1
  s_lshl_b32 s21, s21, 2
  s_sub_i32 s21, s21, 12
  s_max_i32 s47, s21, s22
  s_cmp_gt_u32 s47, s45
  s_cbranch_scc0 va_194
va_193:
  s_add_u32 s22, s45, 6
  s_min_u32 s22, s22, s47
va_195:
  s_cmp_ge_u32 s46, s22
  s_cbranch_scc1 va_197
  s_mov_b32 m0, s64
  s_mov_b32 s66, s41
  buffer_load_dwordx4 v4, s[16:19], s66 offen offset:0 sc1 lds
  buffer_load_dwordx4 v4, s[16:19], s66 offen offset:1024 sc1 lds
  buffer_load_dwordx4 v4, s[16:19], s66 offen offset:2048 sc1 lds
  s_add_u32 s46, s46, 1
  s_add_u32 s41, s41, 393216

  s_add_u32 s64, s64, 12288
  s_cmp_lt_u32 s64, s67
  s_cselect_b32 s64, s64, s71
  s_branch va_195
va_197:
  s_mov_b32 s48, s46
  s_mov_b32 s49, s46
  s_mov_b32 s50, s46
  s_waitcnt vmcnt(0)
  s_barrier
  v_mov_b32 v8, v4
  s_add_u32 s65, s65, 12288
  s_cmp_lt_u32 s65, 98304
  s_cselect_b32 s65, s65, 0
  ds_read_b128 v[144:147], v8 offset:0
  ds_read_b128 v[148:151], v8 offset:1024
  ds_read_b128 v[152:155], v8 offset:2048
  ds_read_b128 v[156:159], v8 offset:3072
  ds_read_b128 v[160:163], v8 offset:4096
  ds_read_b128 v[164:167], v8 offset:5120
  ds_read_b128 v[168:171], v8 offset:6144
  ds_read_b128 v[172:175], v8 offset:7168
  ds_read_b128 v[176:179], v8 offset:8192
  ds_read_b128 v[180:183], v8 offset:9216
  ds_read_b128 v[184:187], v8 offset:10240
  ds_read_b128 v[188:191], v8 offset:11264
vwl_198:
  s_waitcnt lgkmcnt(0)
  v_mfma_f32_16x16x32_bf16 v[64:67], v[144:147], a[0:3], 0
  v_cmp_gt_u32 vcc, 8, v9
  s_nop 0
  v_mfma_f32_16x16x32_bf16 v[72:75], v[144:147], a[24:27], 0
  s_bitset1_b64 vcc, 19
  s_ff1_i32_b64 s21, vcc
  v_mfma_f32_16x16x32_bf16 v[80:83], v[144:147], a[48:51], 0
  s_lshl_b32 s22, s21, 1
  s_lshl_b32 s21, s21, 2
  v_mfma_f32_16x16x32_bf16 v[88:91], v[144:147], a[72:75], 0
  s_sub_i32 s21, s21, 12
  s_max_i32 s47, s21, s22
  v_mfma_f32_16x16x32_bf16 v[96:99], v[144:147], a[96:99], 0
  s_add_u32 s22, s45, 7
  s_min_u32 s22, s22, s47
  v_mfma_f32_16x16x32_bf16 v[68:71], v[168:171], a[0:3], 0
  s_cmp_lt_u32 s46, s22
  s_cselect_b32 s66, s41, 0x80000000
  s_cselect_b32 m0, s64, 98304
  s_cselect_b32 s22, 1, 0
  v_mfma_f32_16x16x32_bf16 v[76:79], v[168:171], a[24:27], 0
  buffer_load_dwordx4 v4, s[16:19], s66 offen offset:0 sc1 lds
  v_mfma_f32_16x16x32_bf16 v[84:87], v[168:171], a[48:51], 0
  v_add_u32 v8, s65, v4
  s_add_u32 s65, s65, 12288
  v_mfma_f32_16x16x32_bf16 v[92:95], v[168:171], a[72:75], 0
  buffer_load_dwordx4 v4, s[16:19], s66 offen offset:1024 sc1 lds
  v_mfma_f32_16x16x32_bf16 v[100:103], v[168:171], a[96:99], 0
  s_cmp_lt_u32 s65, 98304
  s_cselect_b32 s65, s65, 0
  v_mfma_f32_16x16x32_bf16 v[64:67], v[148:151], a[4:7], v[64:67]
  buffer_load_dwordx4 v4, s[16:19], s66 offen offset:2048 sc1 lds
  v_mfma_f32_16x16x32_bf16 v[72:75], v[148:151], a[28:31], v[72:75]
  s_add_u32 s46, s46, s22
  s_mul_i32 s21, s22, 393216
  v_mfma_f32_16x16x32_bf16 v[80:83], v[148:151], a[52:55], v[80:83]
  s_add_u32 s41, s41, s21
  s_mul_i32 s21, s22, 12288
  v_mfma_f32_16x16x32_bf16 v[88:91], v[148:151], a[76:79], v[88:91]
  s_add_u32 s64, s64, s21
  v_cvt_pk_bf16_f32 v44, v104, v105
  v_mfma_f32_16x16x32_bf16 v[96:99], v[148:151], a[100:103], v[96:99]
  s_cmp_lt_u32 s64, s67
  s_cselect_b32 s64, s64, s71
  v_mfma_f32_16x16x32_bf16 v[68:71], v[172:175], a[4:7], v[68:71]
  v_cvt_pk_bf16_f32 v45, v106, v107
  v_cvt_pk_bf16_f32 v46, v108, v109
  v_mfma_f32_16x16x32_bf16 v[76:79], v[172:175], a[28:31], v[76:79]
  v_cvt_pk_bf16_f32 v47, v110, v111
  v_mfma_f32_16x16x32_bf16 v[84:87], v[172:175], a[52:55], v[84:87]
  s_add_u32 s69, s68, 4096
  v_mfma_f32_16x16x32_bf16 v[92:95], v[172:175], a[76:79], v[92:95]
  v_mfma_f32_16x16x32_bf16 v[100:103], v[172:175], a[100:103], v[100:103]
  buffer_store_dwordx4 v[44:47], v4, s[24:27], s69 offen offset:1024 sc1
  v_mfma_f32_16x16x32_bf16 v[64:67], v[152:155], a[8:11], v[64:67]
  v_mfma_f32_16x16x32_bf16 v[72:75], v[152:155], a[32:35], v[72:75]
  v_cvt_pk_bf16_f32 v48, v112, v113
  v_mfma_f32_16x16x32_bf16 v[80:83], v[152:155], a[56:59], v[80:83]
  v_cvt_pk_bf16_f32 v49, v114, v115
  v_mfma_f32_16x16x32_bf16 v[88:91], v[152:155], a[80:83], v[88:91]
  v_mfma_f32_16x16x32_bf16 v[96:99], v[152:155], a[104:107], v[96:99]
  v_cvt_pk_bf16_f32 v50, v116, v117
  v_mfma_f32_16x16x32_bf16 v[68:71], v[176:179], a[8:11], v[68:71]
  v_mfma_f32_16x16x32_bf16 v[76:79], v[176:179], a[32:35], v[76:79]
  v_cvt_pk_bf16_f32 v51, v118, v119
  v_mfma_f32_16x16x32_bf16 v[84:87], v[176:179], a[56:59], v[84:87]
  buffer_store_dwordx4 v[48:51], v4, s[24:27], s69 offen offset:2048 sc1
  v_mfma_f32_16x16x32_bf16 v[92:95], v[176:179], a[80:83], v[92:95]
  v_mfma_f32_16x16x32_bf16 v[100:103], v[176:179], a[104:107], v[100:103]
  v_cvt_pk_bf16_f32 v52, v120, v121
  v_mfma_f32_16x16x32_bf16 v[64:67], v[156:159], a[12:15], v[64:67]
  v_mfma_f32_16x16x32_bf16 v[72:75], v[156:159], a[36:39], v[72:75]
  v_cvt_pk_bf16_f32 v53, v122, v123
  v_mfma_f32_16x16x32_bf16 v[80:83], v[156:159], a[60:63], v[80:83]
  v_cvt_pk_bf16_f32 v54, v124, v125
  v_mfma_f32_16x16x32_bf16 v[88:91], v[156:159], a[84:87], v[88:91]
  v_mfma_f32_16x16x32_bf16 v[96:99], v[156:159], a[108:111], v[96:99]
  v_cvt_pk_bf16_f32 v55, v126, v127
  v_mfma_f32_16x16x32_bf16 v[68:71], v[180:183], a[12:15], v[68:71]
  v_mfma_f32_16x16x32_bf16 v[76:79], v[180:183], a[36:39], v[76:79]
  buffer_store_dwordx4 v[52:55], v4, s[24:27], s69 offen offset:3072 sc1
  v_mfma_f32_16x16x32_bf16 v[84:87], v[180:183], a[60:63], v[84:87]
  v_cvt_pk_bf16_f32 v56, v128, v129
  v_mfma_f32_16x16x32_bf16 v[92:95], v[180:183], a[84:87], v[92:95]
  v_mfma_f32_16x16x32_bf16 v[100:103], v[180:183], a[108:111], v[100:103]
  v_cvt_pk_bf16_f32 v57, v130, v131
  v_mfma_f32_16x16x32_bf16 v[64:67], v[160:163], a[16:19], v[64:67]
  s_cmp_lt_u32 s51, 6291456
  s_cselect_b32 s52, s51, 0x80000000
  v_mfma_f32_16x16x32_bf16 v[72:75], v[160:163], a[40:43], v[72:75]
  buffer_store_dwordx4 v[244:247], v4, s[84:87], s52 offen sc1
  v_mfma_f32_16x16x32_bf16 v[80:83], v[160:163], a[64:67], v[80:83]
  s_add_u32 s51, s51, 98304
  v_cvt_pk_bf16_f32 v58, v132, v133
  v_mfma_f32_16x16x32_bf16 v[88:91], v[160:163], a[88:91], v[88:91]
  v_cvt_pk_bf16_f32 v59, v134, v135
  v_mfma_f32_16x16x32_bf16 v[96:99], v[160:163], a[112:115], v[96:99]
  s_add_u32 s69, s68, 8192
  v_mfma_f32_16x16x32_bf16 v[68:71], v[184:187], a[16:19], v[68:71]
  v_mfma_f32_16x16x32_bf16 v[76:79], v[184:187], a[40:43], v[76:79]
  buffer_store_dwordx4 v[56:59], v4, s[24:27], s69 offen offset:0 sc1
  v_mfma_f32_16x16x32_bf16 v[84:87], v[184:187], a[64:67], v[84:87]
  v_cvt_pk_bf16_f32 v60, v136, v137
  v_mfma_f32_16x16x32_bf16 v[92:95], v[184:187], a[88:91], v[92:95]
  v_mfma_f32_16x16x32_bf16 v[100:103], v[184:187], a[112:115], v[100:103]
  v_cvt_pk_bf16_f32 v61, v138, v139
  v_mfma_f32_16x16x32_bf16 v[64:67], v[164:167], a[20:23], v[64:67]
  v_mfma_f32_16x16x32_bf16 v[72:75], v[164:167], a[44:47], v[72:75]
  v_cvt_pk_bf16_f32 v62, v140, v141
  v_mfma_f32_16x16x32_bf16 v[80:83], v[164:167], a[68:71], v[80:83]
  v_cvt_pk_bf16_f32 v63, v142, v143
  v_mfma_f32_16x16x32_bf16 v[88:91], v[164:167], a[92:95], v[88:91]
  v_mfma_f32_16x16x32_bf16 v[96:99], v[164:167], a[116:119], v[96:99]
  buffer_store_dwordx4 v[60:63], v4, s[24:27], s69 offen offset:1024 sc1
  v_mfma_f32_16x16x32_bf16 v[68:71], v[188:191], a[20:23], v[68:71]
  v_mfma_f32_16x16x32_bf16 v[76:79], v[188:191], a[44:47], v[76:79]
  v_mfma_f32_16x16x32_bf16 v[84:87], v[188:191], a[68:71], v[84:87]
  v_mfma_f32_16x16x32_bf16 v[92:95], v[188:191], a[92:95], v[92:95]
  v_mfma_f32_16x16x32_bf16 v[100:103], v[188:191], a[116:119], v[100:103]
  v_mfma_f32_16x16x32_bf16 v[104:107], v[144:147], a[120:123], 0
  buffer_load_dword v9, v5, s[72:75], s43 offen sc1
  v_mfma_f32_16x16x32_bf16 v[112:115], v[144:147], a[144:147], 0
  v_mfma_f32_16x16x32_bf16 v[120:123], v[144:147], a[168:171], 0
  v_mfma_f32_16x16x32_bf16 v[128:131], v[144:147], a[192:195], 0
  v_cvt_pk_bf16_f32 v24, v64, v65
  v_mfma_f32_16x16x32_bf16 v[136:139], v[144:147], a[216:219], 0
  s_add_u32 s63, s45, 1
  s_min_u32 s63, s63, 63
  v_mfma_f32_16x16x32_bf16 v[108:111], v[168:171], a[120:123], 0
  s_cmp_lt_u32 s63, s46
  s_cselect_b32 s53, 1, 0
  v_mfma_f32_16x16x32_bf16 v[116:119], v[168:171], a[144:147], 0
  v_mov_b32 v21, s53
  ds_write_b32 v6, v21 offset:0
  v_mfma_f32_16x16x32_bf16 v[124:127], v[168:171], a[168:171], 0
  v_cvt_pk_bf16_f32 v25, v66, v67
  v_cvt_pk_bf16_f32 v26, v68, v69
  v_mfma_f32_16x16x32_bf16 v[132:135], v[168:171], a[192:195], 0
  v_cvt_pk_bf16_f32 v27, v70, v71
  v_mfma_f32_16x16x32_bf16 v[140:143], v[168:171], a[216:219], 0
  v_mfma_f32_16x16x32_bf16 v[104:107], v[148:151], a[124:127], v[104:107]
  buffer_store_dwordx4 v[24:27], v4, s[24:27], s42 offen offset:0 sc1
  v_mfma_f32_16x16x32_bf16 v[112:115], v[148:151], a[148:151], v[112:115]
  v_cvt_pk_bf16_f32 v28, v72, v73
  v_mfma_f32_16x16x32_bf16 v[120:123], v[148:151], a[172:175], v[120:123]
  s_cmp_eq_u32 s40, 3
  s_cbranch_scc1 vwm_202
vwm_203:
  v_mfma_f32_16x16x32_bf16 v[128:131], v[148:151], a[196:199], v[128:131]
  v_cvt_pk_bf16_f32 v29, v74, v75
  v_mfma_f32_16x16x32_bf16 v[136:139], v[148:151], a[220:223], v[136:139]
  v_mfma_f32_16x16x32_bf16 v[108:111], v[172:175], a[124:127], v[108:111]
  v_cvt_pk_bf16_f32 v30, v76, v77
  v_mfma_f32_16x16x32_bf16 v[116:119], v[172:175], a[148:151], v[116:119]
  v_mfma_f32_16x16x32_bf16 v[124:127], v[172:175], a[172:175], v[124:127]
  v_cvt_pk_bf16_f32 v31, v78, v79
  v_mfma_f32_16x16x32_bf16 v[132:135], v[172:175], a[196:199], v[132:135]
  buffer_store_dwordx4 v[28:31], v4, s[24:27], s42 offen offset:1024 sc1
  v_mfma_f32_16x16x32_bf16 v[140:143], v[172:175], a[220:223], v[140:143]
  s_cmp_lt_u32 s63, s50
  s_cbranch_scc0 vwx_200
vwx_201:
  v_mfma_f32_16x16x32_bf16 v[104:107], v[152:155], a[128:131], v[104:107]
  s_waitcnt lgkmcnt(0)
  s_barrier
  v_mfma_f32_16x16x32_bf16 v[112:115], v[152:155], a[152:155], v[112:115]
  ds_read_b128 v[240:243], v7 offset:0
  v_cvt_pk_bf16_f32 v32, v80, v81
  v_mfma_f32_16x16x32_bf16 v[120:123], v[152:155], a[176:179], v[120:123]
  ds_read_b128 v[192:195], v8 offset:0
  v_cvt_pk_bf16_f32 v33, v82, v83
  v_mfma_f32_16x16x32_bf16 v[128:131], v[152:155], a[200:203], v[128:131]
  v_mfma_f32_16x16x32_bf16 v[136:139], v[152:155], a[224:227], v[136:139]
  ds_read_b128 v[196:199], v8 offset:1024
  v_cvt_pk_bf16_f32 v34, v84, v85
  v_mfma_f32_16x16x32_bf16 v[108:111], v[176:179], a[128:131], v[108:111]
  v_mfma_f32_16x16x32_bf16 v[116:119], v[176:179], a[152:155], v[116:119]
  v_cvt_pk_bf16_f32 v35, v86, v87
  v_mfma_f32_16x16x32_bf16 v[124:127], v[176:179], a[176:179], v[124:127]
  ds_read_b128 v[200:203], v8 offset:2048
  v_mfma_f32_16x16x32_bf16 v[132:135], v[176:179], a[200:203], v[132:135]
  buffer_store_dwordx4 v[32:35], v4, s[24:27], s42 offen offset:2048 sc1
  v_mfma_f32_16x16x32_bf16 v[140:143], v[176:179], a[224:227], v[140:143]
  ds_read_b128 v[204:207], v8 offset:3072
  v_cvt_pk_bf16_f32 v36, v88, v89
  v_mfma_f32_16x16x32_bf16 v[104:107], v[156:159], a[132:135], v[104:107]
  v_mfma_f32_16x16x32_bf16 v[112:115], v[156:159], a[156:159], v[112:115]
  v_cvt_pk_bf16_f32 v37, v90, v91
  v_mfma_f32_16x16x32_bf16 v[120:123], v[156:159], a[180:183], v[120:123]
  ds_read_b128 v[208:211], v8 offset:4096
  v_mfma_f32_16x16x32_bf16 v[128:131], v[156:159], a[204:207], v[128:131]
  v_cvt_pk_bf16_f32 v38, v92, v93
  v_mfma_f32_16x16x32_bf16 v[136:139], v[156:159], a[228:231], v[136:139]
  ds_read_b128 v[212:215], v8 offset:5120
  s_waitcnt lgkmcnt(4)
  v_mfma_f32_16x16x32_bf16 v[108:111], v[180:183], a[132:135], v[108:111]
  v_bitop3_b32 v240, v240, v241, v242 bitop3:0x80
  v_and_b32 v240, v240, v243
  v_mfma_f32_16x16x32_bf16 v[116:119], v[180:183], a[156:159], v[116:119]
  s_nop 0
  v_readfirstlane_b32 s23, v240
  v_mfma_f32_16x16x32_bf16 v[124:127], v[180:183], a[180:183], v[124:127]
  ds_read_b128 v[216:219], v8 offset:6144
  v_cvt_pk_bf16_f32 v39, v94, v95
  v_mfma_f32_16x16x32_bf16 v[132:135], v[180:183], a[204:207], v[132:135]
  buffer_store_dwordx4 v[36:39], v4, s[24:27], s42 offen offset:3072 sc1
  v_mfma_f32_16x16x32_bf16 v[140:143], v[180:183], a[228:231], v[140:143]
  ds_read_b128 v[220:223], v8 offset:7168
  v_cvt_pk_bf16_f32 v40, v96, v97
  v_mfma_f32_16x16x32_bf16 v[104:107], v[160:163], a[136:139], v[104:107]
  v_cvt_pk_bf16_f32 v41, v98, v99
  v_mfma_f32_16x16x32_bf16 v[112:115], v[160:163], a[160:163], v[112:115]
  v_cvt_pk_bf16_f32 v42, v100, v101
  v_mfma_f32_16x16x32_bf16 v[120:123], v[160:163], a[184:187], v[120:123]
  ds_read_b128 v[224:227], v8 offset:8192
  v_mfma_f32_16x16x32_bf16 v[128:131], v[160:163], a[208:211], v[128:131]
  v_cvt_pk_bf16_f32 v43, v102, v103
  v_mfma_f32_16x16x32_bf16 v[136:139], v[160:163], a[232:235], v[136:139]
  ds_read_b128 v[228:231], v8 offset:9216
  v_mfma_f32_16x16x32_bf16 v[108:111], v[184:187], a[136:139], v[108:111]
  s_add_u32 s69, s42, 4096
  v_mfma_f32_16x16x32_bf16 v[116:119], v[184:187], a[160:163], v[116:119]
  v_mfma_f32_16x16x32_bf16 v[124:127], v[184:187], a[184:187], v[124:127]
  ds_read_b128 v[232:235], v8 offset:10240
  v_mfma_f32_16x16x32_bf16 v[132:135], v[184:187], a[208:211], v[132:135]
  buffer_store_dwordx4 v[40:43], v4, s[24:27], s69 offen offset:0 sc1
  v_mfma_f32_16x16x32_bf16 v[140:143], v[184:187], a[232:235], v[140:143]
  ds_read_b128 v[236:239], v8 offset:11264
  v_mfma_f32_16x16x32_bf16 v[104:107], v[164:167], a[140:143], v[104:107]
  v_mfma_f32_16x16x32_bf16 v[112:115], v[164:167], a[164:167], v[112:115]
  v_mfma_f32_16x16x32_bf16 v[120:123], v[164:167], a[188:191], v[120:123]
  s_waitcnt vmcnt(12)
  s_mov_b32 s50, s46
  s_add_u32 s69, s45, s40
  v_mfma_f32_16x16x32_bf16 v[128:131], v[164:167], a[212:215], v[128:131]
  s_mov_b32 s40, 0
  s_sub_i32 s69, s69, 1
  s_max_i32 s69, s69, s70
  v_mfma_f32_16x16x32_bf16 v[136:139], v[164:167], a[236:239], v[136:139]
  s_add_u32 s45, s45, 1
  s_mov_b32 s68, s42
  s_add_u32 s42, s42, 1310720
  v_mfma_f32_16x16x32_bf16 v[108:111], v[188:191], a[140:143], v[108:111]
  v_mfma_f32_16x16x32_bf16 v[116:119], v[188:191], a[164:167], v[116:119]
  v_mfma_f32_16x16x32_bf16 v[124:127], v[188:191], a[188:191], v[124:127]
  v_mfma_f32_16x16x32_bf16 v[132:135], v[188:191], a[212:215], v[132:135]
  v_mfma_f32_16x16x32_bf16 v[140:143], v[188:191], a[236:239], v[140:143]
  s_mov_b64 exec, 1
  v_mov_b32 v20, s69
  buffer_store_dword v20, v10, s[72:75], s44 offen sc1
  s_mov_b64 exec, -1
  s_cmp_le_u32 s45, 16
  s_cbranch_scc1 vwe_206
vwe_207:
  s_cmp_eq_u32 s23, 0
  s_cbranch_scc1 vws_204
vwb_205:
  s_waitcnt lgkmcnt(0)
  v_mfma_f32_16x16x32_bf16 v[64:67], v[192:195], a[0:3], 0
  v_cmp_gt_u32 vcc, 8, v9
  s_nop 0
  v_mfma_f32_16x16x32_bf16 v[72:75], v[192:195], a[24:27], 0
  s_bitset1_b64 vcc, 19
  s_ff1_i32_b64 s21, vcc
  v_mfma_f32_16x16x32_bf16 v[80:83], v[192:195], a[48:51], 0
  s_lshl_b32 s22, s21, 1
  s_lshl_b32 s21, s21, 2
  v_mfma_f32_16x16x32_bf16 v[88:91], v[192:195], a[72:75], 0
  s_sub_i32 s21, s21, 12
  s_max_i32 s47, s21, s22
  v_mfma_f32_16x16x32_bf16 v[96:99], v[192:195], a[96:99], 0
  s_add_u32 s22, s45, 7
  s_min_u32 s22, s22, s47
  v_mfma_f32_16x16x32_bf16 v[68:71], v[216:219], a[0:3], 0
  s_cmp_lt_u32 s46, s22
  s_cselect_b32 s66, s41, 0x80000000
  s_cselect_b32 m0, s64, 98304
  s_cselect_b32 s22, 1, 0
  v_mfma_f32_16x16x32_bf16 v[76:79], v[216:219], a[24:27], 0
  buffer_load_dwordx4 v4, s[16:19], s66 offen offset:0 sc1 lds
  v_mfma_f32_16x16x32_bf16 v[84:87], v[216:219], a[48:51], 0
  v_add_u32 v8, s65, v4
  s_add_u32 s65, s65, 12288
  v_mfma_f32_16x16x32_bf16 v[92:95], v[216:219], a[72:75], 0
  buffer_load_dwordx4 v4, s[16:19], s66 offen offset:1024 sc1 lds
  v_mfma_f32_16x16x32_bf16 v[100:103], v[216:219], a[96:99], 0
  s_cmp_lt_u32 s65, 98304
  s_cselect_b32 s65, s65, 0
  v_mfma_f32_16x16x32_bf16 v[64:67], v[196:199], a[4:7], v[64:67]
  buffer_load_dwordx4 v4, s[16:19], s66 offen offset:2048 sc1 lds
  v_mfma_f32_16x16x32_bf16 v[72:75], v[196:199], a[28:31], v[72:75]
  s_add_u32 s46, s46, s22
  s_mul_i32 s21, s22, 393216
  v_mfma_f32_16x16x32_bf16 v[80:83], v[196:199], a[52:55], v[80:83]
  s_add_u32 s41, s41, s21
  s_mul_i32 s21, s22, 12288
  v_mfma_f32_16x16x32_bf16 v[88:91], v[196:199], a[76:79], v[88:91]
  s_add_u32 s64, s64, s21
  v_cvt_pk_bf16_f32 v44, v104, v105
  v_mfma_f32_16x16x32_bf16 v[96:99], v[196:199], a[100:103], v[96:99]
  s_cmp_lt_u32 s64, s67
  s_cselect_b32 s64, s64, s71
  v_mfma_f32_16x16x32_bf16 v[68:71], v[220:223], a[4:7], v[68:71]
  v_cvt_pk_bf16_f32 v45, v106, v107
  v_cvt_pk_bf16_f32 v46, v108, v109
  v_mfma_f32_16x16x32_bf16 v[76:79], v[220:223], a[28:31], v[76:79]
  v_cvt_pk_bf16_f32 v47, v110, v111
  v_mfma_f32_16x16x32_bf16 v[84:87], v[220:223], a[52:55], v[84:87]
  s_add_u32 s69, s68, 4096
  v_mfma_f32_16x16x32_bf16 v[92:95], v[220:223], a[76:79], v[92:95]
  v_mfma_f32_16x16x32_bf16 v[100:103], v[220:223], a[100:103], v[100:103]
  buffer_store_dwordx4 v[44:47], v4, s[24:27], s69 offen offset:1024 sc1
  v_mfma_f32_16x16x32_bf16 v[64:67], v[200:203], a[8:11], v[64:67]
  v_mfma_f32_16x16x32_bf16 v[72:75], v[200:203], a[32:35], v[72:75]
  v_cvt_pk_bf16_f32 v48, v112, v113
  v_mfma_f32_16x16x32_bf16 v[80:83], v[200:203], a[56:59], v[80:83]
  v_cvt_pk_bf16_f32 v49, v114, v115
  v_mfma_f32_16x16x32_bf16 v[88:91], v[200:203], a[80:83], v[88:91]
  v_mfma_f32_16x16x32_bf16 v[96:99], v[200:203], a[104:107], v[96:99]
  v_cvt_pk_bf16_f32 v50, v116, v117
  v_mfma_f32_16x16x32_bf16 v[68:71], v[224:227], a[8:11], v[68:71]
  v_mfma_f32_16x16x32_bf16 v[76:79], v[224:227], a[32:35], v[76:79]
  v_cvt_pk_bf16_f32 v51, v118, v119
  v_mfma_f32_16x16x32_bf16 v[84:87], v[224:227], a[56:59], v[84:87]
  buffer_store_dwordx4 v[48:51], v4, s[24:27], s69 offen offset:2048 sc1
  v_mfma_f32_16x16x32_bf16 v[92:95], v[224:227], a[80:83], v[92:95]
  v_mfma_f32_16x16x32_bf16 v[100:103], v[224:227], a[104:107], v[100:103]
  v_cvt_pk_bf16_f32 v52, v120, v121
  v_mfma_f32_16x16x32_bf16 v[64:67], v[204:207], a[12:15], v[64:67]
  v_mfma_f32_16x16x32_bf16 v[72:75], v[204:207], a[36:39], v[72:75]
  v_cvt_pk_bf16_f32 v53, v122, v123
  v_mfma_f32_16x16x32_bf16 v[80:83], v[204:207], a[60:63], v[80:83]
  v_cvt_pk_bf16_f32 v54, v124, v125
  v_mfma_f32_16x16x32_bf16 v[88:91], v[204:207], a[84:87], v[88:91]
  v_mfma_f32_16x16x32_bf16 v[96:99], v[204:207], a[108:111], v[96:99]
  v_cvt_pk_bf16_f32 v55, v126, v127
  v_mfma_f32_16x16x32_bf16 v[68:71], v[228:231], a[12:15], v[68:71]
  v_mfma_f32_16x16x32_bf16 v[76:79], v[228:231], a[36:39], v[76:79]
  buffer_store_dwordx4 v[52:55], v4, s[24:27], s69 offen offset:3072 sc1
  v_mfma_f32_16x16x32_bf16 v[84:87], v[228:231], a[60:63], v[84:87]
  v_cvt_pk_bf16_f32 v56, v128, v129
  v_mfma_f32_16x16x32_bf16 v[92:95], v[228:231], a[84:87], v[92:95]
  v_mfma_f32_16x16x32_bf16 v[100:103], v[228:231], a[108:111], v[100:103]
  v_cvt_pk_bf16_f32 v57, v130, v131
  v_mfma_f32_16x16x32_bf16 v[64:67], v[208:211], a[16:19], v[64:67]
  s_cmp_lt_u32 s51, 6291456
  s_cselect_b32 s52, s51, 0x80000000
  v_mfma_f32_16x16x32_bf16 v[72:75], v[208:211], a[40:43], v[72:75]
  buffer_store_dwordx4 v[244:247], v4, s[84:87], s52 offen sc1
  v_mfma_f32_16x16x32_bf16 v[80:83], v[208:211], a[64:67], v[80:83]
  s_add_u32 s51, s51, 98304
  v_cvt_pk_bf16_f32 v58, v132, v133
  v_mfma_f32_16x16x32_bf16 v[88:91], v[208:211], a[88:91], v[88:91]
  v_cvt_pk_bf16_f32 v59, v134, v135
  v_mfma_f32_16x16x32_bf16 v[96:99], v[208:211], a[112:115], v[96:99]
  s_add_u32 s69, s68, 8192
  v_mfma_f32_16x16x32_bf16 v[68:71], v[232:235], a[16:19], v[68:71]
  v_mfma_f32_16x16x32_bf16 v[76:79], v[232:235], a[40:43], v[76:79]
  buffer_store_dwordx4 v[56:59], v4, s[24:27], s69 offen offset:0 sc1
  v_mfma_f32_16x16x32_bf16 v[84:87], v[232:235], a[64:67], v[84:87]
  v_cvt_pk_bf16_f32 v60, v136, v137
  v_mfma_f32_16x16x32_bf16 v[92:95], v[232:235], a[88:91], v[92:95]
  v_mfma_f32_16x16x32_bf16 v[100:103], v[232:235], a[112:115], v[100:103]
  v_cvt_pk_bf16_f32 v61, v138, v139
  v_mfma_f32_16x16x32_bf16 v[64:67], v[212:215], a[20:23], v[64:67]
  v_mfma_f32_16x16x32_bf16 v[72:75], v[212:215], a[44:47], v[72:75]
  v_cvt_pk_bf16_f32 v62, v140, v141
  v_mfma_f32_16x16x32_bf16 v[80:83], v[212:215], a[68:71], v[80:83]
  v_cvt_pk_bf16_f32 v63, v142, v143
  v_mfma_f32_16x16x32_bf16 v[88:91], v[212:215], a[92:95], v[88:91]
  v_mfma_f32_16x16x32_bf16 v[96:99], v[212:215], a[116:119], v[96:99]
  buffer_store_dwordx4 v[60:63], v4, s[24:27], s69 offen offset:1024 sc1
  v_mfma_f32_16x16x32_bf16 v[68:71], v[236:239], a[20:23], v[68:71]
  v_mfma_f32_16x16x32_bf16 v[76:79], v[236:239], a[44:47], v[76:79]
  v_mfma_f32_16x16x32_bf16 v[84:87], v[236:239], a[68:71], v[84:87]
  v_mfma_f32_16x16x32_bf16 v[92:95], v[236:239], a[92:95], v[92:95]
  v_mfma_f32_16x16x32_bf16 v[100:103], v[236:239], a[116:119], v[100:103]
  v_mfma_f32_16x16x32_bf16 v[104:107], v[192:195], a[120:123], 0
  buffer_load_dword v9, v5, s[72:75], s43 offen sc1
  v_mfma_f32_16x16x32_bf16 v[112:115], v[192:195], a[144:147], 0
  v_mfma_f32_16x16x32_bf16 v[120:123], v[192:195], a[168:171], 0
  v_mfma_f32_16x16x32_bf16 v[128:131], v[192:195], a[192:195], 0
  v_cvt_pk_bf16_f32 v24, v64, v65
  v_mfma_f32_16x16x32_bf16 v[136:139], v[192:195], a[216:219], 0
  s_add_u32 s63, s45, 1
  s_min_u32 s63, s63, 63
  v_mfma_f32_16x16x32_bf16 v[108:111], v[216:219], a[120:123], 0
  s_cmp_lt_u32 s63, s46
  s_cselect_b32 s53, 1, 0
  v_mfma_f32_16x16x32_bf16 v[116:119], v[216:219], a[144:147], 0
  v_mov_b32 v21, s53
  ds_write_b32 v6, v21 offset:16
  v_mfma_f32_16x16x32_bf16 v[124:127], v[216:219], a[168:171], 0
  v_cvt_pk_bf16_f32 v25, v66, v67
  v_cvt_pk_bf16_f32 v26, v68, v69
  v_mfma_f32_16x16x32_bf16 v[132:135], v[216:219], a[192:195], 0
  v_cvt_pk_bf16_f32 v27, v70, v71
  v_mfma_f32_16x16x32_bf16 v[140:143], v[216:219], a[216:219], 0
  v_mfma_f32_16x16x32_bf16 v[104:107], v[196:199], a[124:127], v[104:107]
  buffer_store_dwordx4 v[24:27], v4, s[24:27], s42 offen offset:0 sc1
  v_mfma_f32_16x16x32_bf16 v[112:115], v[196:199], a[148:151], v[112:115]
  v_cvt_pk_bf16_f32 v28, v72, v73
  v_mfma_f32_16x16x32_bf16 v[120:123], v[196:199], a[172:175], v[120:123]
  s_cmp_eq_u32 s40, 3
  s_cbranch_scc1 vwm_212
vwm_213:
  v_mfma_f32_16x16x32_bf16 v[128:131], v[196:199], a[196:199], v[128:131]
  v_cvt_pk_bf16_f32 v29, v74, v75
  v_mfma_f32_16x16x32_bf16 v[136:139], v[196:199], a[220:223], v[136:139]
  v_mfma_f32_16x16x32_bf16 v[108:111], v[220:223], a[124:127], v[108:111]
  v_cvt_pk_bf16_f32 v30, v76, v77
  v_mfma_f32_16x16x32_bf16 v[116:119], v[220:223], a[148:151], v[116:119]
  v_mfma_f32_16x16x32_bf16 v[124:127], v[220:223], a[172:175], v[124:127]
  v_cvt_pk_bf16_f32 v31, v78, v79
  v_mfma_f32_16x16x32_bf16 v[132:135], v[220:223], a[196:199], v[132:135]
  buffer_store_dwordx4 v[28:31], v4, s[24:27], s42 offen offset:1024 sc1
  v_mfma_f32_16x16x32_bf16 v[140:143], v[220:223], a[220:223], v[140:143]
  s_cmp_lt_u32 s63, s50
  s_cbranch_scc0 vwx_210
vwx_211:
  v_mfma_f32_16x16x32_bf16 v[104:107], v[200:203], a[128:131], v[104:107]
  s_waitcnt lgkmcnt(0)
  s_barrier
  v_mfma_f32_16x16x32_bf16 v[112:115], v[200:203], a[152:155], v[112:115]
  ds_read_b128 v[240:243], v7 offset:16
  v_cvt_pk_bf16_f32 v32, v80, v81
  v_mfma_f32_16x16x32_bf16 v[120:123], v[200:203], a[176:179], v[120:123]
  ds_read_b128 v[144:147], v8 offset:0
  v_cvt_pk_bf16_f32 v33, v82, v83
  v_mfma_f32_16x16x32_bf16 v[128:131], v[200:203], a[200:203], v[128:131]
  v_mfma_f32_16x16x32_bf16 v[136:139], v[200:203], a[224:227], v[136:139]
  ds_read_b128 v[148:151], v8 offset:1024
  v_cvt_pk_bf16_f32 v34, v84, v85
  v_mfma_f32_16x16x32_bf16 v[108:111], v[224:227], a[128:131], v[108:111]
  v_mfma_f32_16x16x32_bf16 v[116:119], v[224:227], a[152:155], v[116:119]
  v_cvt_pk_bf16_f32 v35, v86, v87
  v_mfma_f32_16x16x32_bf16 v[124:127], v[224:227], a[176:179], v[124:127]
  ds_read_b128 v[152:155], v8 offset:2048
  v_mfma_f32_16x16x32_bf16 v[132:135], v[224:227], a[200:203], v[132:135]
  buffer_store_dwordx4 v[32:35], v4, s[24:27], s42 offen offset:2048 sc1
  v_mfma_f32_16x16x32_bf16 v[140:143], v[224:227], a[224:227], v[140:143]
  ds_read_b128 v[156:159], v8 offset:3072
  v_cvt_pk_bf16_f32 v36, v88, v89
  v_mfma_f32_16x16x32_bf16 v[104:107], v[204:207], a[132:135], v[104:107]
  v_mfma_f32_16x16x32_bf16 v[112:115], v[204:207], a[156:159], v[112:115]
  v_cvt_pk_bf16_f32 v37, v90, v91
  v_mfma_f32_16x16x32_bf16 v[120:123], v[204:207], a[180:183], v[120:123]
  ds_read_b128 v[160:163], v8 offset:4096
  v_mfma_f32_16x16x32_bf16 v[128:131], v[204:207], a[204:207], v[128:131]
  v_cvt_pk_bf16_f32 v38, v92, v93
  v_mfma_f32_16x16x32_bf16 v[136:139], v[204:207], a[228:231], v[136:139]
  ds_read_b128 v[164:167], v8 offset:5120
  s_waitcnt lgkmcnt(4)
  v_mfma_f32_16x16x32_bf16 v[108:111], v[228:231], a[132:135], v[108:111]
  v_bitop3_b32 v240, v240, v241, v242 bitop3:0x80
  v_and_b32 v240, v240, v243
  v_mfma_f32_16x16x32_bf16 v[116:119], v[228:231], a[156:159], v[116:119]
  s_nop 0
  v_readfirstlane_b32 s23, v240
  v_mfma_f32_16x16x32_bf16 v[124:127], v[228:231], a[180:183], v[124:127]
  ds_read_b128 v[168:171], v8 offset:6144
  v_cvt_pk_bf16_f32 v39, v94, v95
  v_mfma_f32_16x16x32_bf16 v[132:135], v[228:231], a[204:207], v[132:135]
  buffer_store_dwordx4 v[36:39], v4, s[24:27], s42 offen offset:3072 sc1
  v_mfma_f32_16x16x32_bf16 v[140:143], v[228:231], a[228:231], v[140:143]
  ds_read_b128 v[172:175], v8 offset:7168
  v_cvt_pk_bf16_f32 v40, v96, v97
  v_mfma_f32_16x16x32_bf16 v[104:107], v[208:211], a[136:139], v[104:107]
  v_cvt_pk_bf16_f32 v41, v98, v99
  v_mfma_f32_16x16x32_bf16 v[112:115], v[208:211], a[160:163], v[112:115]
  v_cvt_pk_bf16_f32 v42, v100, v101
  v_mfma_f32_16x16x32_bf16 v[120:123], v[208:211], a[184:187], v[120:123]
  ds_read_b128 v[176:179], v8 offset:8192
  v_mfma_f32_16x16x32_bf16 v[128:131], v[208:211], a[208:211], v[128:131]
  v_cvt_pk_bf16_f32 v43, v102, v103
  v_mfma_f32_16x16x32_bf16 v[136:139], v[208:211], a[232:235], v[136:139]
  ds_read_b128 v[180:183], v8 offset:9216
  v_mfma_f32_16x16x32_bf16 v[108:111], v[232:235], a[136:139], v[108:111]
  s_add_u32 s69, s42, 4096
  v_mfma_f32_16x16x32_bf16 v[116:119], v[232:235], a[160:163], v[116:119]
  v_mfma_f32_16x16x32_bf16 v[124:127], v[232:235], a[184:187], v[124:127]
  ds_read_b128 v[184:187], v8 offset:10240
  v_mfma_f32_16x16x32_bf16 v[132:135], v[232:235], a[208:211], v[132:135]
  buffer_store_dwordx4 v[40:43], v4, s[24:27], s69 offen offset:0 sc1
  v_mfma_f32_16x16x32_bf16 v[140:143], v[232:235], a[232:235], v[140:143]
  ds_read_b128 v[188:191], v8 offset:11264
  v_mfma_f32_16x16x32_bf16 v[104:107], v[212:215], a[140:143], v[104:107]
  v_mfma_f32_16x16x32_bf16 v[112:115], v[212:215], a[164:167], v[112:115]
  v_mfma_f32_16x16x32_bf16 v[120:123], v[212:215], a[188:191], v[120:123]
  s_waitcnt vmcnt(12)
  s_mov_b32 s50, s46
  s_add_u32 s69, s45, s40
  v_mfma_f32_16x16x32_bf16 v[128:131], v[212:215], a[212:215], v[128:131]
  s_mov_b32 s40, 0
  s_sub_i32 s69, s69, 1
  s_max_i32 s69, s69, s70
  v_mfma_f32_16x16x32_bf16 v[136:139], v[212:215], a[236:239], v[136:139]
  s_add_u32 s45, s45, 1
  s_mov_b32 s68, s42
  s_add_u32 s42, s42, 1310720
  v_mfma_f32_16x16x32_bf16 v[108:111], v[236:239], a[140:143], v[108:111]
  v_mfma_f32_16x16x32_bf16 v[116:119], v[236:239], a[164:167], v[116:119]
  v_mfma_f32_16x16x32_bf16 v[124:127], v[236:239], a[188:191], v[124:127]
  v_mfma_f32_16x16x32_bf16 v[132:135], v[236:239], a[212:215], v[132:135]
  v_mfma_f32_16x16x32_bf16 v[140:143], v[236:239], a[236:239], v[140:143]
  s_mov_b64 exec, 1
  v_mov_b32 v20, s69
  buffer_store_dword v20, v10, s[72:75], s44 offen sc1
  s_mov_b64 exec, -1
  s_cmp_le_u32 s45, 16
  s_cbranch_scc1 vwe_216
vwe_217:
  s_cmp_lg_u32 s45, 44
  s_cbranch_scc1 arm_220
  s_mul_i32 s21, s2, 10240
  s_mul_i32 s22, s20, 2560
  s_add_u32 s21, s21, s22
  s_add_u32 s21, s21, 17039360
  buffer_store_dwordx4 v[244:247], v15, s[80:83], s21 offen offset:0 sc1
  buffer_store_dwordx4 v[244:247], v15, s[80:83], s21 offen offset:512 sc1
  buffer_store_dwordx4 v[244:247], v15, s[80:83], s21 offen offset:1024 sc1
  buffer_store_dwordx4 v[244:247], v15, s[80:83], s21 offen offset:1536 sc1
  buffer_store_dwordx4 v[244:247], v15, s[80:83], s21 offen offset:2048 sc1
  s_add_u32 s21, s21, 655360
  buffer_store_dwordx4 v[244:247], v15, s[80:83], s21 offen offset:0 sc1
  buffer_store_dwordx4 v[244:247], v15, s[80:83], s21 offen offset:512 sc1
  buffer_store_dwordx4 v[244:247], v15, s[80:83], s21 offen offset:1024 sc1
  buffer_store_dwordx4 v[244:247], v15, s[80:83], s21 offen offset:1536 sc1
  buffer_store_dwordx4 v[244:247], v15, s[80:83], s21 offen offset:2048 sc1
  s_add_u32 s21, s21, 655360
  buffer_store_dwordx4 v[244:247], v15, s[80:83], s21 offen offset:0 sc1
  buffer_store_dwordx4 v[244:247], v15, s[80:83], s21 offen offset:512 sc1
  buffer_store_dwordx4 v[244:247], v15, s[80:83], s21 offen offset:1024 sc1
  buffer_store_dwordx4 v[244:247], v15, s[80:83], s21 offen offset:1536 sc1
  buffer_store_dwordx4 v[244:247], v15, s[80:83], s21 offen offset:2048 sc1
  s_add_u32 s21, s21, 655360
  buffer_store_dwordx4 v[244:247], v15, s[80:83], s21 offen offset:0 sc1
  buffer_store_dwordx4 v[244:247], v15, s[80:83], s21 offen offset:512 sc1
  buffer_store_dwordx4 v[244:247], v15, s[80:83], s21 offen offset:1024 sc1
  buffer_store_dwordx4 v[244:247], v15, s[80:83], s21 offen offset:1536 sc1
  buffer_store_dwordx4 v[244:247], v15, s[80:83], s21 offen offset:2048 sc1
  s_add_u32 s21, s21, 655360
  buffer_store_dwordx4 v[244:247], v15, s[80:83], s21 offen offset:0 sc1
  buffer_store_dwordx4 v[244:247], v15, s[80:83], s21 offen offset:512 sc1
  buffer_store_dwordx4 v[244:247], v15, s[80:83], s21 offen offset:1024 sc1
  buffer_store_dwordx4 v[244:247], v15, s[80:83], s21 offen offset:1536 sc1
  buffer_store_dwordx4 v[244:247], v15, s[80:83], s21 offen offset:2048 sc1
  s_add_u32 s21, s21, 655360
  buffer_store_dwordx4 v[244:247], v15, s[80:83], s21 offen offset:0 sc1
  buffer_store_dwordx4 v[244:247], v15, s[80:83], s21 offen offset:512 sc1
  buffer_store_dwordx4 v[244:247], v15, s[80:83], s21 offen offset:1024 sc1
  buffer_store_dwordx4 v[244:247], v15, s[80:83], s21 offen offset:1536 sc1
  buffer_store_dwordx4 v[244:247], v15, s[80:83], s21 offen offset:2048 sc1
  s_add_u32 s21, s21, 655360
  s_and_b32 s21, s2, 3
  s_cmp_lg_u32 s21, s20
  s_cbranch_scc1 arm_220
  s_mul_i32 s21, s2, 2560
  s_add_u32 s21, s21, 4259840
  v_lshlrev_b32 v21, 3, v1
  buffer_store_dwordx4 v[244:247], v4, s[88:91], s21 offen sc1
  buffer_store_dwordx4 v[244:247], v4, s[88:91], s21 offen offset:1024 sc1
  buffer_store_dwordx2 v[244:245], v21, s[88:91], s21 offen offset:2048 sc1
  s_add_u32 s21, s21, 81920
  buffer_store_dwordx4 v[244:247], v4, s[88:91], s21 offen sc1
  buffer_store_dwordx4 v[244:247], v4, s[88:91], s21 offen offset:1024 sc1
  buffer_store_dwordx2 v[244:245], v21, s[88:91], s21 offen offset:2048 sc1
  s_add_u32 s21, s21, 81920
  buffer_store_dwordx4 v[244:247], v4, s[88:91], s21 offen sc1
  buffer_store_dwordx4 v[244:247], v4, s[88:91], s21 offen offset:1024 sc1
  buffer_store_dwordx2 v[244:245], v21, s[88:91], s21 offen offset:2048 sc1
  s_add_u32 s21, s21, 81920
  buffer_store_dwordx4 v[244:247], v4, s[88:91], s21 offen sc1
  buffer_store_dwordx4 v[244:247], v4, s[88:91], s21 offen offset:1024 sc1
  buffer_store_dwordx2 v[244:245], v21, s[88:91], s21 offen offset:2048 sc1
  s_add_u32 s21, s21, 81920
  buffer_store_dwordx4 v[244:247], v4, s[88:91], s21 offen sc1
  buffer_store_dwordx4 v[244:247], v4, s[88:91], s21 offen offset:1024 sc1
  buffer_store_dwordx2 v[244:245], v21, s[88:91], s21 offen offset:2048 sc1
  s_add_u32 s21, s21, 81920
  buffer_store_dwordx4 v[244:247], v4, s[88:91], s21 offen sc1
  buffer_store_dwordx4 v[244:247], v4, s[88:91], s21 offen offset:1024 sc1
  buffer_store_dwordx2 v[244:245], v21, s[88:91], s21 offen offset:2048 sc1
  s_add_u32 s21, s21, 81920
  buffer_store_dwordx4 v[244:247], v4, s[88:91], s21 offen sc1
  buffer_store_dwordx4 v[244:247], v4, s[88:91], s21 offen offset:1024 sc1
  buffer_store_dwordx2 v[244:245], v21, s[88:91], s21 offen offset:2048 sc1
  s_add_u32 s21, s21, 81920
  buffer_store_dwordx4 v[244:247], v4, s[88:91], s21 offen sc1
  buffer_store_dwordx4 v[244:247], v4, s[88:91], s21 offen offset:1024 sc1
  buffer_store_dwordx2 v[244:245], v21, s[88:91], s21 offen offset:2048 sc1
  s_add_u32 s21, s21, 81920
  buffer_store_dwordx4 v[244:247], v4, s[88:91], s21 offen sc1
  buffer_store_dwordx4 v[244:247], v4, s[88:91], s21 offen offset:1024 sc1
  buffer_store_dwordx2 v[244:245], v21, s[88:91], s21 offen offset:2048 sc1
  s_add_u32 s21, s21, 81920
  buffer_store_dwordx4 v[244:247], v4, s[88:91], s21 offen sc1
  buffer_store_dwordx4 v[244:247], v4, s[88:91], s21 offen offset:1024 sc1
  buffer_store_dwordx2 v[244:245], v21, s[88:91], s21 offen offset:2048 sc1
  s_add_u32 s21, s21, 81920
  buffer_store_dwordx4 v[244:247], v4, s[88:91], s21 offen sc1
  buffer_store_dwordx4 v[244:247], v4, s[88:91], s21 offen offset:1024 sc1
  buffer_store_dwordx2 v[244:245], v21, s[88:91], s21 offen offset:2048 sc1
  s_add_u32 s21, s21, 81920
  buffer_store_dwordx4 v[244:247], v4, s[88:91], s21 offen sc1
  buffer_store_dwordx4 v[244:247], v4, s[88:91], s21 offen offset:1024 sc1
  buffer_store_dwordx2 v[244:245], v21, s[88:91], s21 offen offset:2048 sc1
  s_add_u32 s21, s21, 81920
arm_220:
  s_cmp_ge_u32 s45, 64
  s_cbranch_scc1 vwd_199
  s_cmp_lg_u32 s23, 0
  s_cbranch_scc1 vwl_198
  s_branch vws_214
vws_204:
  v_cmp_gt_u32 vcc, 8, v9
  s_nop 0
  s_bitset1_b64 vcc, 19
  s_ff1_i32_b64 s21, vcc
  s_lshl_b32 s22, s21, 1
  s_lshl_b32 s21, s21, 2
  s_sub_i32 s21, s21, 12
  s_max_i32 s47, s21, s22
  s_cmp_gt_u32 s47, s45
  s_cbranch_scc1 va_222
  s_cmp_eq_u32 s70, s45
  s_cbranch_scc1 va_227
  s_nop 4
  v_cvt_pk_bf16_f32 v44, v104, v105
  v_cvt_pk_bf16_f32 v45, v106, v107
  v_cvt_pk_bf16_f32 v46, v108, v109
  v_cvt_pk_bf16_f32 v47, v110, v111
  s_add_u32 s69, s68, 4096
  buffer_store_dwordx4 v[44:47], v4, s[24:27], s69 offen offset:1024 sc1
  v_cvt_pk_bf16_f32 v48, v112, v113
  v_cvt_pk_bf16_f32 v49, v114, v115
  v_cvt_pk_bf16_f32 v50, v116, v117
  v_cvt_pk_bf16_f32 v51, v118, v119
  buffer_store_dwordx4 v[48:51], v4, s[24:27], s69 offen offset:2048 sc1
  v_cvt_pk_bf16_f32 v52, v120, v121
  v_cvt_pk_bf16_f32 v53, v122, v123
  v_cvt_pk_bf16_f32 v54, v124, v125
  v_cvt_pk_bf16_f32 v55, v126, v127
  buffer_store_dwordx4 v[52:55], v4, s[24:27], s69 offen offset:3072 sc1
  v_cvt_pk_bf16_f32 v56, v128, v129
  v_cvt_pk_bf16_f32 v57, v130, v131
  v_cvt_pk_bf16_f32 v58, v132, v133
  v_cvt_pk_bf16_f32 v59, v134, v135
  s_add_u32 s69, s68, 8192
  buffer_store_dwordx4 v[56:59], v4, s[24:27], s69 offen offset:0 sc1
  v_cvt_pk_bf16_f32 v60, v136, v137
  v_cvt_pk_bf16_f32 v61, v138, v139
  v_cvt_pk_bf16_f32 v62, v140, v141
  v_cvt_pk_bf16_f32 v63, v142, v143
  buffer_store_dwordx4 v[60:63], v4, s[24:27], s69 offen offset:1024 sc1
  s_mov_b32 s68, 0x80000000
  s_mov_b32 s56, s68
  s_mov_b32 s57, s68
  s_waitcnt vmcnt(0)
  s_mov_b64 exec, 1
  v_mov_b32 v20, s45
  buffer_store_dword v20, v10, s[72:75], s44 offen sc1
  s_mov_b64 exec, -1
  s_mov_b32 s70, s45
  s_mov_b32 s40, 0
va_227:
  s_mov_b32 s101, 0
  s_branch va_225
va_223:
  s_sleep 8
va_225:
  buffer_load_dword v9, v5, s[72:75], s43 offen sc1
  s_add_u32 s101, s101, 1
  s_cmp_gt_u32 s101, 131072
  s_cbranch_scc1 main_end
  s_waitcnt vmcnt(0)
  v_cmp_gt_u32 vcc, 8, v9
  s_nop 0
  s_bitset1_b64 vcc, 19
  s_ff1_i32_b64 s21, vcc
  s_lshl_b32 s22, s21, 1
  s_lshl_b32 s21, s21, 2
  s_sub_i32 s21, s21, 12
  s_max_i32 s47, s21, s22
  s_cmp_gt_u32 s47, s45
  s_cbranch_scc0 va_223
va_222:
  s_add_u32 s22, s45, 6
  s_min_u32 s22, s22, s47
va_224:
  s_cmp_ge_u32 s46, s22
  s_cbranch_scc1 va_226
  s_mov_b32 m0, s64
  s_mov_b32 s66, s41
  buffer_load_dwordx4 v4, s[16:19], s66 offen offset:0 sc1 lds
  buffer_load_dwordx4 v4, s[16:19], s66 offen offset:1024 sc1 lds
  buffer_load_dwordx4 v4, s[16:19], s66 offen offset:2048 sc1 lds
  s_add_u32 s46, s46, 1
  s_add_u32 s41, s41, 393216

  s_add_u32 s64, s64, 12288
  s_cmp_lt_u32 s64, s67
  s_cselect_b32 s64, s64, s71
  s_branch va_224
va_226:
  s_mov_b32 s48, s46
  s_mov_b32 s49, s46
  s_mov_b32 s50, s46
  s_waitcnt vmcnt(0)
  s_cmp_eq_u32 s40, 0
  s_cbranch_scc1 va_228
  s_mov_b32 s40, 0
  s_mov_b64 exec, 1
  v_mov_b32 v20, s45
  buffer_store_dword v20, v10, s[72:75], s44 offen sc1
  s_mov_b64 exec, -1
  s_mov_b32 s70, s45
va_228:
  s_barrier
  ds_read_b128 v[192:195], v8 offset:0
  ds_read_b128 v[196:199], v8 offset:1024
  ds_read_b128 v[200:203], v8 offset:2048
  ds_read_b128 v[204:207], v8 offset:3072
  ds_read_b128 v[208:211], v8 offset:4096
  ds_read_b128 v[212:215], v8 offset:5120
  ds_read_b128 v[216:219], v8 offset:6144
  ds_read_b128 v[220:223], v8 offset:7168
  ds_read_b128 v[224:227], v8 offset:8192
  ds_read_b128 v[228:231], v8 offset:9216
  ds_read_b128 v[232:235], v8 offset:10240
  ds_read_b128 v[236:239], v8 offset:11264
  s_branch vwb_205
vws_214:
  v_cmp_gt_u32 vcc, 8, v9
  s_nop 0
  s_bitset1_b64 vcc, 19
  s_ff1_i32_b64 s21, vcc
  s_lshl_b32 s22, s21, 1
  s_lshl_b32 s21, s21, 2
  s_sub_i32 s21, s21, 12
  s_max_i32 s47, s21, s22
  s_cmp_gt_u32 s47, s45
  s_cbranch_scc1 va_229
  s_cmp_eq_u32 s70, s45
  s_cbranch_scc1 va_234
  s_nop 4
  v_cvt_pk_bf16_f32 v44, v104, v105
  v_cvt_pk_bf16_f32 v45, v106, v107
  v_cvt_pk_bf16_f32 v46, v108, v109
  v_cvt_pk_bf16_f32 v47, v110, v111
  s_add_u32 s69, s68, 4096
  buffer_store_dwordx4 v[44:47], v4, s[24:27], s69 offen offset:1024 sc1
  v_cvt_pk_bf16_f32 v48, v112, v113
  v_cvt_pk_bf16_f32 v49, v114, v115
  v_cvt_pk_bf16_f32 v50, v116, v117
  v_cvt_pk_bf16_f32 v51, v118, v119
  buffer_store_dwordx4 v[48:51], v4, s[24:27], s69 offen offset:2048 sc1
  v_cvt_pk_bf16_f32 v52, v120, v121
  v_cvt_pk_bf16_f32 v53, v122, v123
  v_cvt_pk_bf16_f32 v54, v124, v125
  v_cvt_pk_bf16_f32 v55, v126, v127
  buffer_store_dwordx4 v[52:55], v4, s[24:27], s69 offen offset:3072 sc1
  v_cvt_pk_bf16_f32 v56, v128, v129
  v_cvt_pk_bf16_f32 v57, v130, v131
  v_cvt_pk_bf16_f32 v58, v132, v133
  v_cvt_pk_bf16_f32 v59, v134, v135
  s_add_u32 s69, s68, 8192
  buffer_store_dwordx4 v[56:59], v4, s[24:27], s69 offen offset:0 sc1
  v_cvt_pk_bf16_f32 v60, v136, v137
  v_cvt_pk_bf16_f32 v61, v138, v139
  v_cvt_pk_bf16_f32 v62, v140, v141
  v_cvt_pk_bf16_f32 v63, v142, v143
  buffer_store_dwordx4 v[60:63], v4, s[24:27], s69 offen offset:1024 sc1
  s_mov_b32 s68, 0x80000000
  s_mov_b32 s56, s68
  s_mov_b32 s57, s68
  s_waitcnt vmcnt(0)
  s_mov_b64 exec, 1
  v_mov_b32 v20, s45
  buffer_store_dword v20, v10, s[72:75], s44 offen sc1
  s_mov_b64 exec, -1
  s_mov_b32 s70, s45
  s_mov_b32 s40, 0
va_234:
  s_mov_b32 s101, 0
  s_branch va_232
va_230:
  s_sleep 8
va_232:
  buffer_load_dword v9, v5, s[72:75], s43 offen sc1
  s_add_u32 s101, s101, 1
  s_cmp_gt_u32 s101, 131072
  s_cbranch_scc1 main_end
  s_waitcnt vmcnt(0)
  v_cmp_gt_u32 vcc, 8, v9
  s_nop 0
  s_bitset1_b64 vcc, 19
  s_ff1_i32_b64 s21, vcc
  s_lshl_b32 s22, s21, 1
  s_lshl_b32 s21, s21, 2
  s_sub_i32 s21, s21, 12
  s_max_i32 s47, s21, s22
  s_cmp_gt_u32 s47, s45
  s_cbranch_scc0 va_230
va_229:
  s_add_u32 s22, s45, 6
  s_min_u32 s22, s22, s47
va_231:
  s_cmp_ge_u32 s46, s22
  s_cbranch_scc1 va_233
  s_mov_b32 m0, s64
  s_mov_b32 s66, s41
  buffer_load_dwordx4 v4, s[16:19], s66 offen offset:0 sc1 lds
  buffer_load_dwordx4 v4, s[16:19], s66 offen offset:1024 sc1 lds
  buffer_load_dwordx4 v4, s[16:19], s66 offen offset:2048 sc1 lds
  s_add_u32 s46, s46, 1
  s_add_u32 s41, s41, 393216

  s_add_u32 s64, s64, 12288
  s_cmp_lt_u32 s64, s67
  s_cselect_b32 s64, s64, s71
  s_branch va_231
va_233:
  s_mov_b32 s48, s46
  s_mov_b32 s49, s46
  s_mov_b32 s50, s46
  s_waitcnt vmcnt(0)
  s_cmp_eq_u32 s40, 0
  s_cbranch_scc1 va_235
  s_mov_b32 s40, 0
  s_mov_b64 exec, 1
  v_mov_b32 v20, s45
  buffer_store_dword v20, v10, s[72:75], s44 offen sc1
  s_mov_b64 exec, -1
  s_mov_b32 s70, s45
va_235:
  s_barrier
  ds_read_b128 v[144:147], v8 offset:0
  ds_read_b128 v[148:151], v8 offset:1024
  ds_read_b128 v[152:155], v8 offset:2048
  ds_read_b128 v[156:159], v8 offset:3072
  ds_read_b128 v[160:163], v8 offset:4096
  ds_read_b128 v[164:167], v8 offset:5120
  ds_read_b128 v[168:171], v8 offset:6144
  ds_read_b128 v[172:175], v8 offset:7168
  ds_read_b128 v[176:179], v8 offset:8192
  ds_read_b128 v[180:183], v8 offset:9216
  ds_read_b128 v[184:187], v8 offset:10240
  ds_read_b128 v[188:191], v8 offset:11264
  s_branch vwl_198
vwe_206:
  s_nop 4
  v_cvt_pk_bf16_f32 v44, v104, v105
  v_cvt_pk_bf16_f32 v45, v106, v107
  v_cvt_pk_bf16_f32 v46, v108, v109
  v_cvt_pk_bf16_f32 v47, v110, v111
  s_add_u32 s69, s68, 4096
  buffer_store_dwordx4 v[44:47], v4, s[24:27], s69 offen offset:1024 sc1
  v_cvt_pk_bf16_f32 v48, v112, v113
  v_cvt_pk_bf16_f32 v49, v114, v115
  v_cvt_pk_bf16_f32 v50, v116, v117
  v_cvt_pk_bf16_f32 v51, v118, v119
  buffer_store_dwordx4 v[48:51], v4, s[24:27], s69 offen offset:2048 sc1
  v_cvt_pk_bf16_f32 v52, v120, v121
  v_cvt_pk_bf16_f32 v53, v122, v123
  v_cvt_pk_bf16_f32 v54, v124, v125
  v_cvt_pk_bf16_f32 v55, v126, v127
  buffer_store_dwordx4 v[52:55], v4, s[24:27], s69 offen offset:3072 sc1
  v_cvt_pk_bf16_f32 v56, v128, v129
  v_cvt_pk_bf16_f32 v57, v130, v131
  v_cvt_pk_bf16_f32 v58, v132, v133
  v_cvt_pk_bf16_f32 v59, v134, v135
  s_add_u32 s69, s68, 8192
  buffer_store_dwordx4 v[56:59], v4, s[24:27], s69 offen offset:0 sc1
  v_cvt_pk_bf16_f32 v60, v136, v137
  v_cvt_pk_bf16_f32 v61, v138, v139
  v_cvt_pk_bf16_f32 v62, v140, v141
  v_cvt_pk_bf16_f32 v63, v142, v143
  buffer_store_dwordx4 v[60:63], v4, s[24:27], s69 offen offset:1024 sc1
  s_mov_b32 s68, 0x80000000
  s_mov_b32 s56, s68
  s_mov_b32 s57, s68
  s_cmp_le_u32 s45, 4
  s_cselect_b32 s40, 3, 1
  s_branch vwe_207
vwe_216:
  s_nop 4
  v_cvt_pk_bf16_f32 v44, v104, v105
  v_cvt_pk_bf16_f32 v45, v106, v107
  v_cvt_pk_bf16_f32 v46, v108, v109
  v_cvt_pk_bf16_f32 v47, v110, v111
  s_add_u32 s69, s68, 4096
  buffer_store_dwordx4 v[44:47], v4, s[24:27], s69 offen offset:1024 sc1
  v_cvt_pk_bf16_f32 v48, v112, v113
  v_cvt_pk_bf16_f32 v49, v114, v115
  v_cvt_pk_bf16_f32 v50, v116, v117
  v_cvt_pk_bf16_f32 v51, v118, v119
  buffer_store_dwordx4 v[48:51], v4, s[24:27], s69 offen offset:2048 sc1
  v_cvt_pk_bf16_f32 v52, v120, v121
  v_cvt_pk_bf16_f32 v53, v122, v123
  v_cvt_pk_bf16_f32 v54, v124, v125
  v_cvt_pk_bf16_f32 v55, v126, v127
  buffer_store_dwordx4 v[52:55], v4, s[24:27], s69 offen offset:3072 sc1
  v_cvt_pk_bf16_f32 v56, v128, v129
  v_cvt_pk_bf16_f32 v57, v130, v131
  v_cvt_pk_bf16_f32 v58, v132, v133
  v_cvt_pk_bf16_f32 v59, v134, v135
  s_add_u32 s69, s68, 8192
  buffer_store_dwordx4 v[56:59], v4, s[24:27], s69 offen offset:0 sc1
  v_cvt_pk_bf16_f32 v60, v136, v137
  v_cvt_pk_bf16_f32 v61, v138, v139
  v_cvt_pk_bf16_f32 v62, v140, v141
  v_cvt_pk_bf16_f32 v63, v142, v143
  buffer_store_dwordx4 v[60:63], v4, s[24:27], s69 offen offset:1024 sc1
  s_mov_b32 s68, 0x80000000
  s_mov_b32 s56, s68
  s_mov_b32 s57, s68
  s_cmp_le_u32 s45, 4
  s_cselect_b32 s40, 3, 1
  s_branch vwe_217
vwx_200:
  s_waitcnt vmcnt(9)
  s_branch vwx_201
vwx_210:
  s_waitcnt vmcnt(9)
  s_branch vwx_211
vwm_202:
  s_mov_b32 s40, 0
  s_waitcnt vmcnt(11)
  s_mov_b64 exec, 1
  v_mov_b32 v20, s45
  buffer_store_dword v20, v10, s[72:75], s44 offen sc1
  s_mov_b64 exec, -1
  s_mov_b32 s70, s45
  s_branch vwm_203
vwm_212:
  s_mov_b32 s40, 0
  s_waitcnt vmcnt(11)
  s_mov_b64 exec, 1
  v_mov_b32 v20, s45
  buffer_store_dword v20, v10, s[72:75], s44 offen sc1
  s_mov_b64 exec, -1
  s_mov_b32 s70, s45
  s_branch vwm_213
vwd_199:
  s_nop 4
  v_cvt_pk_bf16_f32 v44, v104, v105
  v_cvt_pk_bf16_f32 v45, v106, v107
  v_cvt_pk_bf16_f32 v46, v108, v109
  v_cvt_pk_bf16_f32 v47, v110, v111
  s_add_u32 s69, s68, 4096
  buffer_store_dwordx4 v[44:47], v4, s[24:27], s69 offen offset:1024 sc1
  v_cvt_pk_bf16_f32 v48, v112, v113
  v_cvt_pk_bf16_f32 v49, v114, v115
  v_cvt_pk_bf16_f32 v50, v116, v117
  v_cvt_pk_bf16_f32 v51, v118, v119
  buffer_store_dwordx4 v[48:51], v4, s[24:27], s69 offen offset:2048 sc1
  v_cvt_pk_bf16_f32 v52, v120, v121
  v_cvt_pk_bf16_f32 v53, v122, v123
  v_cvt_pk_bf16_f32 v54, v124, v125
  v_cvt_pk_bf16_f32 v55, v126, v127
  buffer_store_dwordx4 v[52:55], v4, s[24:27], s69 offen offset:3072 sc1
  v_cvt_pk_bf16_f32 v56, v128, v129
  v_cvt_pk_bf16_f32 v57, v130, v131
  v_cvt_pk_bf16_f32 v58, v132, v133
  v_cvt_pk_bf16_f32 v59, v134, v135
  s_add_u32 s69, s68, 8192
  buffer_store_dwordx4 v[56:59], v4, s[24:27], s69 offen offset:0 sc1
  v_cvt_pk_bf16_f32 v60, v136, v137
  v_cvt_pk_bf16_f32 v61, v138, v139
  v_cvt_pk_bf16_f32 v62, v140, v141
  v_cvt_pk_bf16_f32 v63, v142, v143
  buffer_store_dwordx4 v[60:63], v4, s[24:27], s69 offen offset:1024 sc1
  s_waitcnt vmcnt(0)
  s_mov_b64 exec, 1
  v_mov_b32 v20, s45
  buffer_store_dword v20, v10, s[72:75], s44 offen sc1
  s_mov_b64 exec, -1
  s_mov_b32 s84, 0
  s_mov_b32 s85, -1
  s_and_b32 s21, s3, 3
  s_sub_u32 s22, s21, 0
  s_lshl_b32 s22, s22, 3
  s_bfe_u32 s87, s3, 0x30002
  s_add_u32 s87, s87, s22
  s_add_u32 s87, s87, 252
  s_cmp_lt_u32 s21, 0
  s_cselect_b32 s87, -1, s87
  s_sub_u32 s21, s3, 64
  s_waitcnt vmcnt(0) lgkmcnt(0)
  s_barrier
  s_branch do_opb2
  s_mov_b32 s84, 0
  s_mov_b32 s85, -1
  s_mov_b32 s86, 0
  s_branch queue
not_vw:
  s_sub_u32 s2, s3, 96
  s_cmp_lg_u32 s2, 31
  s_cbranch_scc1 not_cal
  s_add_u32 s8, s38, 83886079
  s_addc_u32 s9, s39, 0
  s_and_b32 s8, s8, 0xffe00000
  s_mov_b32 s10, 2097152
  s_mov_b32 s11, 0x00020000
  v_lshrrev_b32 v9, 4, v0
  v_mul_u32_u24 v9, 16640, v9
  v_bfe_u32 v10, v0, 3, 1
  v_lshl_add_u32 v9, v10, 13, v9
  v_and_b32 v10, 7, v0
  v_lshl_add_u32 v9, v10, 4, v9
  s_mov_b32 s21, 1048576
  buffer_store_dwordx4 v[4:7], v9, s[8:11], s21 offen sc1
  s_waitcnt vmcnt(0)
  s_barrier
  s_cmp_lg_u32 s20, 3
  s_cbranch_scc1 cal_236
  s_mov_b64 exec, 1
  v_mov_b32 v4, 0
  s_mov_b32 s40, -1
  s_mov_b32 s41, -1
  s_mov_b32 s42, 1048576
  s_mov_b32 s43, 0
  s_waitcnt vmcnt(0)
cal_237:
  s_add_u32 s21, s42, 0
  s_memtime s[98:99]
  s_waitcnt lgkmcnt(0)
  buffer_load_dword v5, v4, s[8:11], s21 offen sc1
  s_waitcnt vmcnt(0)
  s_memtime s[100:101]
  s_waitcnt lgkmcnt(0)
  s_sub_u32 s21, s100, s98
  s_min_u32 s40, s40, s21
  s_add_u32 s21, s42, 8192
  s_memtime s[98:99]
  s_waitcnt lgkmcnt(0)
  buffer_load_dword v5, v4, s[8:11], s21 offen sc1
  s_waitcnt vmcnt(0)
  s_memtime s[100:101]
  s_waitcnt lgkmcnt(0)
  s_sub_u32 s21, s100, s98
  s_min_u32 s41, s41, s21
  s_add_u32 s42, s42, 16640
  s_add_u32 s43, s43, 1
  s_cmp_lt_u32 s43, 4
  s_cbranch_scc1 cal_237
  s_cmp_lt_u32 s41, s40
  s_cselect_b32 s21, 1, 2
  v_mov_b32 v4, s21
  v_mov_b32 v5, s40
  v_mov_b32 v6, s41
  v_mov_b32 v8, 84
  buffer_store_dwordx3 v[4:6], v8, s[32:35], 0 offen sc1
  s_waitcnt vmcnt(0)
  s_mov_b64 exec, -1
cal_236:
  s_barrier
  s_branch armed
not_cal:
  s_sleep 32
  s_sleep 32
  s_sleep 32
armed:
  s_load_dwordx2 s[72:73], s[0:1], 104
  s_waitcnt lgkmcnt(0)
  s_add_u32 s72, s72, 81068032
  s_addc_u32 s73, s73, 0
  s_mov_b32 s74, 116736
  s_mov_b32 s75, 0x00020000
  s_load_dwordx2 s[4:5], s[0:1], 0
  s_load_dwordx2 s[6:7], s[0:1], 64
  s_load_dwordx2 s[38:39], s[0:1], 104
  s_mov_b32 s64, s32
  s_mov_b32 s65, s33
  s_mov_b32 s66, s34
  s_mov_b32 s67, s35
  s_lshr_b32 s41, s2, 1
  s_and_b32 s42, s2, 1
  s_waitcnt lgkmcnt(0)
  s_mov_b32 s8, s4
  s_mov_b32 s9, s5
  s_mov_b32 s10, 2621440
  s_mov_b32 s11, 0x00020000
  s_mov_b32 s12, s6
  s_mov_b32 s13, s7
  s_mov_b32 s14, 2457600
  s_mov_b32 s15, 0x00020000
  s_add_u32 s16, s38, 70713344
  s_addc_u32 s17, s39, 0
  s_mov_b32 s18, 2641920
  s_mov_b32 s19, 0x00020000
  s_add_u32 s72, s38, 81068032
  s_addc_u32 s73, s39, 0
  s_mov_b32 s74, 116736
  s_mov_b32 s75, 0x00020000
  s_lshl_b32 s21, s2, 2
  s_add_u32 s21, s21, s20
  s_mul_i32 s21, s21, 19200
  v_lshlrev_b32 v5, 4, v1
  buffer_load_dwordx4 v[64:67], v5, s[12:15], s21 offen offset:0
  buffer_load_dwordx4 v[64:67], v5, s[12:15], s21 offen offset:1024
  buffer_load_dwordx4 v[64:67], v5, s[12:15], s21 offen offset:2048
  buffer_load_dwordx4 v[64:67], v5, s[12:15], s21 offen offset:3072
  s_add_u32 s21, s21, 4096
  buffer_load_dwordx4 v[64:67], v5, s[12:15], s21 offen offset:0
  buffer_load_dwordx4 v[64:67], v5, s[12:15], s21 offen offset:1024
  buffer_load_dwordx4 v[64:67], v5, s[12:15], s21 offen offset:2048
  buffer_load_dwordx4 v[64:67], v5, s[12:15], s21 offen offset:3072
  s_add_u32 s21, s21, 4096
  buffer_load_dwordx4 v[64:67], v5, s[12:15], s21 offen offset:0
  buffer_load_dwordx4 v[64:67], v5, s[12:15], s21 offen offset:1024
  buffer_load_dwordx4 v[64:67], v5, s[12:15], s21 offen offset:2048
  buffer_load_dwordx4 v[64:67], v5, s[12:15], s21 offen offset:3072
  s_add_u32 s21, s21, 4096
  buffer_load_dwordx4 v[64:67], v5, s[12:15], s21 offen offset:0
  buffer_load_dwordx4 v[64:67], v5, s[12:15], s21 offen offset:1024
  buffer_load_dwordx4 v[64:67], v5, s[12:15], s21 offen offset:2048
  buffer_load_dwordx4 v[64:67], v5, s[12:15], s21 offen offset:3072
  s_add_u32 s21, s21, 4096
  buffer_load_dwordx4 v[64:67], v5, s[12:15], s21 offen offset:0
  buffer_load_dwordx4 v[64:67], v5, s[12:15], s21 offen offset:1024
  buffer_load_dwordx4 v[64:67], v5, s[12:15], s21 offen offset:2048
  s_waitcnt vmcnt(0)
  v_lshlrev_b32 v6, 1, v3
  v_add_u32 v6, 0, v6
  v_xor_b32 v6, v6, v2
  v_min_u32 v6, 14, v6
  v_mul_u32_u24 v7, 52, v6
  v_lshrrev_b32 v7, 8, v7
  v_mul_u32_u24 v7, 1200, v7
  v_lshl_add_u32 v7, v6, 4, v7
  v_mul_u32_u24 v6, 3840, v3
  v_add_u32 v4, v6, v7
  v_lshlrev_b32 v6, 1, v3
  v_add_u32 v6, 8, v6
  v_xor_b32 v6, v6, v2
  v_min_u32 v6, 14, v6
  v_mul_u32_u24 v7, 52, v6
  v_lshrrev_b32 v7, 8, v7
  v_mul_u32_u24 v7, 1200, v7
  v_lshl_add_u32 v7, v6, 4, v7
  v_mul_u32_u24 v6, 3840, v3
  v_add_u32 v5, v6, v7
  s_mul_i32 s21, s41, 80
  s_mul_i32 s22, s20, 15360
  s_add_u32 s21, s21, s22
  s_lshl_b32 s22, s20, 10
  s_cmp_ge_u32 s20, 2
  s_cselect_b64 vcc, -1, 0
  v_cndmask_b32 v4, v4, v5, vcc
  s_add_u32 m0, s22, 0
  s_nop 0
  buffer_load_dwordx4 v4, s[12:15], s21 offen lds
  s_add_u32 s21, s21, 61440
  s_add_u32 m0, s22, 4096
  s_nop 0
  buffer_load_dwordx4 v4, s[12:15], s21 offen lds
  s_add_u32 s21, s21, 61440
  s_add_u32 m0, s22, 8192
  s_nop 0
  buffer_load_dwordx4 v4, s[12:15], s21 offen lds
  s_add_u32 s21, s21, 61440
  s_add_u32 m0, s22, 12288
  s_nop 0
  buffer_load_dwordx4 v4, s[12:15], s21 offen lds
  s_add_u32 s21, s21, 61440
  s_add_u32 m0, s22, 16384
  s_nop 0
  buffer_load_dwordx4 v4, s[12:15], s21 offen lds
  s_add_u32 s21, s21, 61440
  s_add_u32 m0, s22, 20480
  s_nop 0
  buffer_load_dwordx4 v4, s[12:15], s21 offen lds
  s_add_u32 s21, s21, 61440
  s_add_u32 m0, s22, 24576
  s_nop 0
  buffer_load_dwordx4 v4, s[12:15], s21 offen lds
  s_add_u32 s21, s21, 61440
  s_add_u32 m0, s22, 28672
  s_nop 0
  buffer_load_dwordx4 v4, s[12:15], s21 offen lds
  s_add_u32 s21, s21, 61440
  s_add_u32 m0, s22, 32768
  s_nop 0
  buffer_load_dwordx4 v4, s[12:15], s21 offen lds
  s_add_u32 s21, s21, 61440
  s_add_u32 m0, s22, 36864
  s_nop 0
  buffer_load_dwordx4 v4, s[12:15], s21 offen lds
  s_add_u32 s21, s21, 61440
  s_add_u32 m0, s22, 40960
  s_nop 0
  buffer_load_dwordx4 v4, s[12:15], s21 offen lds
  s_add_u32 s21, s21, 61440
  s_add_u32 m0, s22, 45056
  s_nop 0
  buffer_load_dwordx4 v4, s[12:15], s21 offen lds
  s_add_u32 s21, s21, 61440
  s_add_u32 m0, s22, 49152
  s_nop 0
  buffer_load_dwordx4 v4, s[12:15], s21 offen lds
  s_add_u32 s21, s21, 61440
  s_add_u32 m0, s22, 53248
  s_nop 0
  buffer_load_dwordx4 v4, s[12:15], s21 offen lds
  s_add_u32 s21, s21, 61440
  s_add_u32 m0, s22, 57344
  s_nop 0
  buffer_load_dwordx4 v4, s[12:15], s21 offen lds
  s_add_u32 s21, s21, 61440
  s_add_u32 m0, s22, 61440
  s_nop 0
  buffer_load_dwordx4 v4, s[12:15], s21 offen lds
  s_add_u32 s21, s21, 61440
  s_add_u32 m0, s22, 65536
  s_nop 0
  buffer_load_dwordx4 v4, s[12:15], s21 offen lds
  s_add_u32 s21, s21, 61440
  s_add_u32 m0, s22, 69632
  s_nop 0
  buffer_load_dwordx4 v4, s[12:15], s21 offen lds
  s_add_u32 s21, s21, 61440
  s_add_u32 m0, s22, 73728
  s_nop 0
  buffer_load_dwordx4 v4, s[12:15], s21 offen lds
  s_add_u32 s21, s21, 61440
  s_add_u32 m0, s22, 77824
  s_nop 0
  buffer_load_dwordx4 v4, s[12:15], s21 offen lds
  s_add_u32 s21, s21, 61440
  s_add_u32 m0, s22, 81920
  s_nop 0
  buffer_load_dwordx4 v4, s[12:15], s21 offen lds
  s_add_u32 s21, s21, 61440
  s_add_u32 m0, s22, 86016
  s_nop 0
  buffer_load_dwordx4 v4, s[12:15], s21 offen lds
  s_add_u32 s21, s21, 61440
  s_add_u32 m0, s22, 90112
  s_nop 0
  buffer_load_dwordx4 v4, s[12:15], s21 offen lds
  s_add_u32 s21, s21, 61440
  s_add_u32 m0, s22, 94208
  s_nop 0
  buffer_load_dwordx4 v4, s[12:15], s21 offen lds
  s_add_u32 s21, s21, 61440
  s_add_u32 m0, s22, 98304
  s_nop 0
  buffer_load_dwordx4 v4, s[12:15], s21 offen lds
  s_add_u32 s21, s21, 61440
  s_add_u32 m0, s22, 102400
  s_nop 0
  buffer_load_dwordx4 v4, s[12:15], s21 offen lds
  s_add_u32 s21, s21, 61440
  s_add_u32 m0, s22, 106496
  s_nop 0
  buffer_load_dwordx4 v4, s[12:15], s21 offen lds
  s_add_u32 s21, s21, 61440
  s_add_u32 m0, s22, 110592
  s_nop 0
  buffer_load_dwordx4 v4, s[12:15], s21 offen lds
  s_add_u32 s21, s21, 61440
  s_add_u32 m0, s22, 114688
  s_nop 0
  buffer_load_dwordx4 v4, s[12:15], s21 offen lds
  s_add_u32 s21, s21, 61440
  s_add_u32 m0, s22, 118784
  s_nop 0
  buffer_load_dwordx4 v4, s[12:15], s21 offen lds
  s_add_u32 s21, s21, 61440
  s_add_u32 m0, s22, 122880
  s_nop 0
  buffer_load_dwordx4 v4, s[12:15], s21 offen lds
  s_add_u32 s21, s21, 61440
  s_add_u32 m0, s22, 126976
  s_nop 0
  buffer_load_dwordx4 v4, s[12:15], s21 offen lds
  s_add_u32 s21, s21, 61440
  s_add_u32 m0, s22, 131072
  s_nop 0
  buffer_load_dwordx4 v4, s[12:15], s21 offen lds
  s_add_u32 s21, s21, 61440
  s_add_u32 m0, s22, 135168
  s_nop 0
  buffer_load_dwordx4 v4, s[12:15], s21 offen lds
  s_add_u32 s21, s21, 61440
  s_add_u32 m0, s22, 139264
  s_nop 0
  buffer_load_dwordx4 v4, s[12:15], s21 offen lds
  s_add_u32 s21, s21, 61440
  s_add_u32 m0, s22, 143360
  s_nop 0
  buffer_load_dwordx4 v4, s[12:15], s21 offen lds
  s_add_u32 s21, s21, 61440
  s_add_u32 m0, s22, 147456
  s_nop 0
  buffer_load_dwordx4 v4, s[12:15], s21 offen lds
  s_add_u32 s21, s21, 61440
  s_add_u32 m0, s22, 151552
  s_nop 0
  buffer_load_dwordx4 v4, s[12:15], s21 offen lds
  s_add_u32 s21, s21, 61440
  s_add_u32 m0, s22, 155648
  s_nop 0
  buffer_load_dwordx4 v4, s[12:15], s21 offen lds
  s_add_u32 s21, s21, 61440
  s_add_u32 m0, s22, 159744
  s_nop 0
  buffer_load_dwordx4 v4, s[12:15], s21 offen lds
  s_add_u32 s21, s21, 61440
  s_lshl_b32 s21, s2, 2
  s_add_u32 s21, s21, s20
  s_mul_i32 s21, s21, 20480
  v_lshlrev_b32 v5, 4, v1
  buffer_load_dwordx4 v[64:67], v5, s[8:11], s21 offen offset:0
  buffer_load_dwordx4 v[64:67], v5, s[8:11], s21 offen offset:1024
  buffer_load_dwordx4 v[64:67], v5, s[8:11], s21 offen offset:2048
  buffer_load_dwordx4 v[64:67], v5, s[8:11], s21 offen offset:3072
  s_add_u32 s21, s21, 4096
  buffer_load_dwordx4 v[64:67], v5, s[8:11], s21 offen offset:0
  buffer_load_dwordx4 v[64:67], v5, s[8:11], s21 offen offset:1024
  buffer_load_dwordx4 v[64:67], v5, s[8:11], s21 offen offset:2048
  buffer_load_dwordx4 v[64:67], v5, s[8:11], s21 offen offset:3072
  s_add_u32 s21, s21, 4096
  buffer_load_dwordx4 v[64:67], v5, s[8:11], s21 offen offset:0
  buffer_load_dwordx4 v[64:67], v5, s[8:11], s21 offen offset:1024
  buffer_load_dwordx4 v[64:67], v5, s[8:11], s21 offen offset:2048
  buffer_load_dwordx4 v[64:67], v5, s[8:11], s21 offen offset:3072
  s_add_u32 s21, s21, 4096
  buffer_load_dwordx4 v[64:67], v5, s[8:11], s21 offen offset:0
  buffer_load_dwordx4 v[64:67], v5, s[8:11], s21 offen offset:1024
  buffer_load_dwordx4 v[64:67], v5, s[8:11], s21 offen offset:2048
  buffer_load_dwordx4 v[64:67], v5, s[8:11], s21 offen offset:3072
  s_add_u32 s21, s21, 4096
  buffer_load_dwordx4 v[64:67], v5, s[8:11], s21 offen offset:0
  buffer_load_dwordx4 v[64:67], v5, s[8:11], s21 offen offset:1024
  buffer_load_dwordx4 v[64:67], v5, s[8:11], s21 offen offset:2048
  buffer_load_dwordx4 v[64:67], v5, s[8:11], s21 offen offset:3072
  v_lshrrev_b32 v6, 2, v2
  v_lshl_add_u32 v7, v3, 3, v6
  v_and_b32 v8, 1, v3
  v_lshl_add_u32 v6, v8, 2, v6
  v_lshlrev_b32 v6, 1, v6
  v_bfe_u32 v8, v2, 1, 1
  s_lshl_b32 s21, s20, 2
  v_add_u32 v8, s21, v8
  v_and_b32 v9, 1, v2
  v_lshlrev_b32 v9, 3, v9
  v_lshl_add_u32 v9, v7, 8, v9
  v_add_u32 v5, 0, v8
  v_xor_b32 v5, v5, v6
  v_lshl_add_u32 v44, v5, 4, v9
  v_add_u32 v45, 65536, v44
  v_add_u32 v46, 131072, v44
  v_add_u32 v5, 2, v8
  v_xor_b32 v5, v5, v6
  v_lshl_add_u32 v47, v5, 4, v9
  v_add_u32 v48, 65536, v47
  v_add_u32 v49, 131072, v47
  s_waitcnt vmcnt(50) lgkmcnt(0)
  s_barrier
  ds_read_b64_tr_b16 a[0:1], v44 offset:0
  ds_read_b64_tr_b16 a[2:3], v44 offset:1024
  ds_read_b64_tr_b16 a[4:5], v47 offset:0
  ds_read_b64_tr_b16 a[6:7], v47 offset:1024
  ds_read_b64_tr_b16 a[8:9], v44 offset:8192
  ds_read_b64_tr_b16 a[10:11], v44 offset:9216
  ds_read_b64_tr_b16 a[12:13], v47 offset:8192
  ds_read_b64_tr_b16 a[14:15], v47 offset:9216
  ds_read_b64_tr_b16 a[16:17], v44 offset:16384
  ds_read_b64_tr_b16 a[18:19], v44 offset:17408
  ds_read_b64_tr_b16 a[20:21], v47 offset:16384
  ds_read_b64_tr_b16 a[22:23], v47 offset:17408
  ds_read_b64_tr_b16 a[24:25], v44 offset:24576
  ds_read_b64_tr_b16 a[26:27], v44 offset:25600
  ds_read_b64_tr_b16 a[28:29], v47 offset:24576
  ds_read_b64_tr_b16 a[30:31], v47 offset:25600
  ds_read_b64_tr_b16 a[32:33], v44 offset:32768
  ds_read_b64_tr_b16 a[34:35], v44 offset:33792
  ds_read_b64_tr_b16 a[36:37], v47 offset:32768
  ds_read_b64_tr_b16 a[38:39], v47 offset:33792
  s_waitcnt vmcnt(40) lgkmcnt(0)
  s_barrier
  ds_read_b64_tr_b16 a[40:41], v44 offset:40960
  ds_read_b64_tr_b16 a[42:43], v44 offset:41984
  ds_read_b64_tr_b16 a[44:45], v47 offset:40960
  ds_read_b64_tr_b16 a[46:47], v47 offset:41984
  ds_read_b64_tr_b16 a[48:49], v44 offset:49152
  ds_read_b64_tr_b16 a[50:51], v44 offset:50176
  ds_read_b64_tr_b16 a[52:53], v47 offset:49152
  ds_read_b64_tr_b16 a[54:55], v47 offset:50176
  ds_read_b64_tr_b16 a[56:57], v44 offset:57344
  ds_read_b64_tr_b16 a[58:59], v44 offset:58368
  ds_read_b64_tr_b16 a[60:61], v47 offset:57344
  ds_read_b64_tr_b16 a[62:63], v47 offset:58368
  ds_read_b64_tr_b16 a[64:65], v45 offset:0
  ds_read_b64_tr_b16 a[66:67], v45 offset:1024
  ds_read_b64_tr_b16 a[68:69], v48 offset:0
  ds_read_b64_tr_b16 a[70:71], v48 offset:1024
  ds_read_b64_tr_b16 a[72:73], v45 offset:8192
  ds_read_b64_tr_b16 a[74:75], v45 offset:9216
  ds_read_b64_tr_b16 a[76:77], v48 offset:8192
  ds_read_b64_tr_b16 a[78:79], v48 offset:9216
  s_waitcnt vmcnt(30) lgkmcnt(0)
  s_barrier
  s_mul_i32 s24, s42, 1280
  v_lshrrev_b32 v11, 3, v1
  v_and_b32 v12, 7, v1
  v_xor_b32 v12, v12, v11
  v_mul_u32_u24 v11, 2560, v11
  v_lshl_add_u32 v10, v12, 4, v11
  s_mul_i32 s46, s20, 81920
  v_add_u32 v10, s46, v10
  s_lshl_b32 s47, s20, 12
  s_add_u32 s47, s47, 0
  s_add_u32 s46, s47, 114688
  s_mov_b32 s30, s24
  s_add_u32 s32, s47, 0
  v_add_u32 v11, 19456, v10
  v_add_u32 v12, 38912, v10
  v_add_u32 v13, 58368, v10
  s_mov_b32 m0, s32
  s_nop 0
  buffer_load_dwordx4 v10, s[8:11], s30 offen offset:0 lds
  buffer_load_dwordx4 v11, s[8:11], s30 offen offset:1024 lds
  buffer_load_dwordx4 v12, s[8:11], s30 offen offset:2048 lds
  buffer_load_dwordx4 v13, s[8:11], s30 offen offset:3072 lds
  s_add_u32 s30, s30, 128
  s_add_u32 s32, s32, 16384
  s_cmp_lt_u32 s32, s46
  s_cselect_b32 s32, s32, s47
  s_mov_b32 m0, s32
  s_nop 0
  buffer_load_dwordx4 v10, s[8:11], s30 offen offset:0 lds
  buffer_load_dwordx4 v11, s[8:11], s30 offen offset:1024 lds
  buffer_load_dwordx4 v12, s[8:11], s30 offen offset:2048 lds
  buffer_load_dwordx4 v13, s[8:11], s30 offen offset:3072 lds
  s_add_u32 s30, s30, 128
  s_add_u32 s32, s32, 16384
  s_cmp_lt_u32 s32, s46
  s_cselect_b32 s32, s32, s47
  s_mov_b32 m0, s32
  s_nop 0
  buffer_load_dwordx4 v10, s[8:11], s30 offen offset:0 lds
  buffer_load_dwordx4 v11, s[8:11], s30 offen offset:1024 lds
  buffer_load_dwordx4 v12, s[8:11], s30 offen offset:2048 lds
  buffer_load_dwordx4 v13, s[8:11], s30 offen offset:3072 lds
  s_add_u32 s30, s30, 128
  s_add_u32 s32, s32, 16384
  s_cmp_lt_u32 s32, s46
  s_cselect_b32 s32, s32, s47
  s_mov_b32 m0, s32
  s_nop 0
  buffer_load_dwordx4 v10, s[8:11], s30 offen offset:0 lds
  buffer_load_dwordx4 v11, s[8:11], s30 offen offset:1024 lds
  buffer_load_dwordx4 v12, s[8:11], s30 offen offset:2048 lds
  buffer_load_dwordx4 v13, s[8:11], s30 offen offset:3072 lds
  s_add_u32 s30, s30, 128
  s_add_u32 s32, s32, 16384
  s_cmp_lt_u32 s32, s46
  s_cselect_b32 s32, s32, s47
  s_mov_b32 m0, s32
  s_nop 0
  buffer_load_dwordx4 v10, s[8:11], s30 offen offset:0 lds
  buffer_load_dwordx4 v11, s[8:11], s30 offen offset:1024 lds
  buffer_load_dwordx4 v12, s[8:11], s30 offen offset:2048 lds
  buffer_load_dwordx4 v13, s[8:11], s30 offen offset:3072 lds
  s_add_u32 s30, s30, 128
  s_add_u32 s32, s32, 16384
  s_cmp_lt_u32 s32, s46
  s_cselect_b32 s32, s32, s47
  ds_read_b64_tr_b16 a[80:81], v45 offset:16384
  ds_read_b64_tr_b16 a[82:83], v45 offset:17408
  ds_read_b64_tr_b16 a[84:85], v48 offset:16384
  ds_read_b64_tr_b16 a[86:87], v48 offset:17408
  ds_read_b64_tr_b16 a[88:89], v45 offset:24576
  ds_read_b64_tr_b16 a[90:91], v45 offset:25600
  ds_read_b64_tr_b16 a[92:93], v48 offset:24576
  ds_read_b64_tr_b16 a[94:95], v48 offset:25600
  ds_read_b64_tr_b16 a[96:97], v45 offset:32768
  ds_read_b64_tr_b16 a[98:99], v45 offset:33792
  ds_read_b64_tr_b16 a[100:101], v48 offset:32768
  ds_read_b64_tr_b16 a[102:103], v48 offset:33792
  ds_read_b64_tr_b16 a[104:105], v45 offset:40960
  ds_read_b64_tr_b16 a[106:107], v45 offset:41984
  ds_read_b64_tr_b16 a[108:109], v48 offset:40960
  ds_read_b64_tr_b16 a[110:111], v48 offset:41984
  ds_read_b64_tr_b16 a[112:113], v45 offset:49152
  ds_read_b64_tr_b16 a[114:115], v45 offset:50176
  ds_read_b64_tr_b16 a[116:117], v48 offset:49152
  ds_read_b64_tr_b16 a[118:119], v48 offset:50176
  s_waitcnt vmcnt(40) lgkmcnt(0)
  s_barrier
  ds_read_b64_tr_b16 a[120:121], v45 offset:57344
  ds_read_b64_tr_b16 a[122:123], v45 offset:58368
  ds_read_b64_tr_b16 a[124:125], v48 offset:57344
  ds_read_b64_tr_b16 a[126:127], v48 offset:58368
  ds_read_b64_tr_b16 a[128:129], v46 offset:0
  ds_read_b64_tr_b16 a[130:131], v46 offset:1024
  ds_read_b64_tr_b16 a[132:133], v49 offset:0
  ds_read_b64_tr_b16 a[134:135], v49 offset:1024
  ds_read_b64_tr_b16 a[136:137], v46 offset:8192
  ds_read_b64_tr_b16 a[138:139], v46 offset:9216
  ds_read_b64_tr_b16 a[140:141], v49 offset:8192
  ds_read_b64_tr_b16 a[142:143], v49 offset:9216
  ds_read_b64_tr_b16 a[144:145], v46 offset:16384
  ds_read_b64_tr_b16 a[146:147], v46 offset:17408
  ds_read_b64_tr_b16 a[148:149], v49 offset:16384
  ds_read_b64_tr_b16 a[150:151], v49 offset:17408
  ds_read_b64_tr_b16 a[152:153], v46 offset:24576
  ds_read_b64_tr_b16 a[154:155], v46 offset:25600
  ds_read_b64_tr_b16 a[156:157], v49 offset:24576
  ds_read_b64_tr_b16 a[158:159], v49 offset:25600
  s_waitcnt lgkmcnt(0)
  s_barrier
  s_load_dwordx2 s[12:13], s[0:1], 72
  s_lshl_b32 s21, s2, 2
  s_add_u32 s21, s21, s20
  s_mul_i32 s50, s21, 6400
  s_add_u32 s51, s50, 4096
  v_lshlrev_b32 v33, 4, v1
  s_mov_b32 s14, 819200
  v_mov_b32 v32, 76
  s_waitcnt lgkmcnt(0)
  v_and_b32 v4, 31, v1
  s_lshl_b32 s21, s20, 5
  v_add_u32 v36, s21, v4
  v_lshrrev_b32 v5, 5, v1
  v_mul_u32_u24 v6, 264, v36
  v_mul_u32_u24 v7, 40, v5
  s_mov_b32 s21, 114952
  v_add3_u32 v34, v6, v7, s21
  v_lshl_add_u32 v38, v5, 3, v34
  v_lshlrev_b32 v6, 5, v5
  v_sub_u32 v39, v34, v6
  v_lshlrev_b32 v35, 3, v1
  v_add_u32 v35, 114688, v35
  v_mov_b32 v37, 0xf149f2ca
  s_mul_i32 s21, s41, 165120
  s_mul_i32 s22, s42, 16512
  s_add_u32 s21, s21, s22
  v_lshl_add_u32 v7, v36, 4, s21
  v_mul_u32_u24 v6, 99072, v5
  v_add_u32 v29, v6, v7
  v_add_u32 v30, 33024, v29
  v_lshl_add_u32 v31, v5, 3, v7
  v_add_u32 v31, 66048, v31
  v_mov_b32 v8, 0
  v_mov_b32 v9, 0
  ds_write_b64 v35, v[8:9] offset:0
  ds_write_b64 v35, v[8:9] offset:512
  ds_write_b64 v35, v[8:9] offset:1024
  ds_write_b64 v35, v[8:9] offset:1536
  ds_write_b64 v35, v[8:9] offset:2048
  s_mul_i32 s24, s42, 1280
  s_mov_b32 s25, 327680
  s_mov_b32 s26, 8
  s_mov_b32 s27, 0
  s_mov_b32 s60, 0x3e64f92e
  s_mov_b32 s61, 0x3fb8aa3b
  s_mov_b32 s62, 0x05040100
  s_mov_b32 s63, 0x07060302
  v_cmp_le_u32 s[76:77], 0, v36
  v_cmp_le_u32 s[78:79], 1, v36
  v_cmp_le_u32 s[80:81], 2, v36
  v_cmp_le_u32 s[82:83], 3, v36
  v_cmp_le_u32 s[84:85], 4, v36
  v_cmp_le_u32 s[86:87], 5, v36
  v_cmp_le_u32 s[88:89], 6, v36
  v_cmp_le_u32 s[90:91], 7, v36
  v_and_b32 v6, 7, v2
  v_add_u32 v4, 0, v3
  v_xor_b32 v4, v4, v6
  v_lshlrev_b32 v4, 4, v4
  v_lshl_add_u32 v14, v2, 7, v4
  v_add_u32 v4, 4, v3
  v_xor_b32 v4, v4, v6
  v_lshlrev_b32 v4, 4, v4
  v_lshl_add_u32 v15, v2, 7, v4
  v_mul_u32_u24 v22, 264, v2
  v_mul_u32_u24 v4, 8, v3
  s_mul_i32 s21, s20, 64
  s_add_u32 s21, s21, 116800
  v_add3_u32 v22, v22, v4, s21
  v_lshlrev_b32 v4, 3, v3
  v_sub_u32 v16, v22, v4
  v_mov_b32 v9, 2731
  s_mov_b32 s33, 0
  s_mov_b32 s48, 0x80000000
  s_mov_b32 m0, s32
  s_nop 0
  buffer_load_dwordx4 v10, s[8:11], s30 offen offset:0 lds
  buffer_load_dwordx4 v11, s[8:11], s30 offen offset:1024 lds
  s_waitcnt vmcnt(18)
  s_barrier
  v_add_u32 v18, s33, v14
  v_add_u32 v19, s33, v15
  s_add_u32 s33, s33, 16384
  s_cmp_lt_u32 s33, 114688
  s_cselect_b32 s33, s33, 0
  ds_read_b128 v[160:163], v18 offset:0
  ds_read_b128 v[164:167], v18 offset:2048
  ds_read_b128 v[168:171], v18 offset:4096
  ds_read_b128 v[172:175], v18 offset:6144
  ds_read_b128 v[176:179], v18 offset:8192
  ds_read_b128 v[180:183], v18 offset:10240
  ds_read_b128 v[184:187], v18 offset:12288
  ds_read_b128 v[188:191], v18 offset:14336
  s_waitcnt lgkmcnt(0)
bf_blk_238:
  v_mfma_f32_16x16x32_bf16 v[64:67], a[0:3], v[160:163], 0
  ds_read_b128 v[192:195], v19 offset:0
  v_mfma_f32_16x16x32_bf16 v[68:71], a[4:7], v[160:163], 0
  v_add_u32 v18, s33, v14
  v_mfma_f32_16x16x32_bf16 v[72:75], a[0:3], v[164:167], 0
  ds_read_b128 v[196:199], v19 offset:2048
  v_mfma_f32_16x16x32_bf16 v[76:79], a[4:7], v[164:167], 0
  buffer_load_dwordx4 v12, s[8:11], s30 offen offset:2048 lds
  v_mfma_f32_16x16x32_bf16 v[80:83], a[0:3], v[168:171], 0
  ds_read_b128 v[200:203], v19 offset:4096
  v_mfma_f32_16x16x32_bf16 v[84:87], a[4:7], v[168:171], 0
  v_mfma_f32_16x16x32_bf16 v[88:91], a[0:3], v[172:175], 0
  ds_read_b128 v[204:207], v19 offset:6144
  v_mfma_f32_16x16x32_bf16 v[92:95], a[4:7], v[172:175], 0
  s_waitcnt lgkmcnt(14)
  v_mfma_f32_16x16x32_bf16 v[96:99], a[0:3], v[176:179], 0
  ds_read_b128 v[208:211], v19 offset:8192
  v_mfma_f32_16x16x32_bf16 v[100:103], a[4:7], v[176:179], 0
  v_mfma_f32_16x16x32_bf16 v[104:107], a[0:3], v[180:183], 0
  ds_read_b128 v[212:215], v19 offset:10240
  v_mfma_f32_16x16x32_bf16 v[108:111], a[4:7], v[180:183], 0
  buffer_load_dwordx4 v13, s[8:11], s30 offen offset:3072 lds
  v_mfma_f32_16x16x32_bf16 v[112:115], a[0:3], v[184:187], 0
  ds_read_b128 v[216:219], v19 offset:12288
  s_add_u32 s30, s30, 128
  v_mfma_f32_16x16x32_bf16 v[116:119], a[4:7], v[184:187], 0
  s_add_u32 m0, m0, 16384
  v_mfma_f32_16x16x32_bf16 v[120:123], a[0:3], v[188:191], 0
  ds_read_b128 v[220:223], v19 offset:14336
  v_mfma_f32_16x16x32_bf16 v[124:127], a[4:7], v[188:191], 0
  s_waitcnt vmcnt(16) lgkmcnt(4)
  s_barrier
  v_mfma_f32_16x16x32_bf16 v[64:67], a[8:11], v[192:195], v[64:67]
  ds_read_b128 v[160:163], v18 offset:0
  v_mfma_f32_16x16x32_bf16 v[68:71], a[12:15], v[192:195], v[68:71]
  s_cmp_lt_u32 m0, s46
  s_cselect_b32 m0, m0, s47
  v_mfma_f32_16x16x32_bf16 v[72:75], a[8:11], v[196:199], v[72:75]
  ds_read_b128 v[164:167], v18 offset:2048
  v_add_u32 v19, s33, v15
  v_mfma_f32_16x16x32_bf16 v[76:79], a[12:15], v[196:199], v[76:79]
  buffer_load_dwordx4 v10, s[8:11], s30 offen offset:0 lds
  v_mfma_f32_16x16x32_bf16 v[80:83], a[8:11], v[200:203], v[80:83]
  ds_read_b128 v[168:171], v18 offset:4096
  s_add_u32 s33, s33, 16384
  v_mfma_f32_16x16x32_bf16 v[84:87], a[12:15], v[200:203], v[84:87]
  s_cmp_lt_u32 s33, 114688
  s_cselect_b32 s33, s33, 0
  v_mfma_f32_16x16x32_bf16 v[88:91], a[8:11], v[204:207], v[88:91]
  ds_read_b128 v[172:175], v18 offset:6144
  v_mfma_f32_16x16x32_bf16 v[92:95], a[12:15], v[204:207], v[92:95]
  s_waitcnt lgkmcnt(4)
  v_mfma_f32_16x16x32_bf16 v[96:99], a[8:11], v[208:211], v[96:99]
  ds_read_b128 v[176:179], v18 offset:8192
  v_mfma_f32_16x16x32_bf16 v[100:103], a[12:15], v[208:211], v[100:103]
  v_mfma_f32_16x16x32_bf16 v[104:107], a[8:11], v[212:215], v[104:107]
  ds_read_b128 v[180:183], v18 offset:10240
  v_mfma_f32_16x16x32_bf16 v[108:111], a[12:15], v[212:215], v[108:111]
  buffer_load_dwordx4 v11, s[8:11], s30 offen offset:1024 lds
  v_mfma_f32_16x16x32_bf16 v[112:115], a[8:11], v[216:219], v[112:115]
  ds_read_b128 v[184:187], v18 offset:12288
  v_mfma_f32_16x16x32_bf16 v[116:119], a[12:15], v[216:219], v[116:119]
  v_mfma_f32_16x16x32_bf16 v[120:123], a[8:11], v[220:223], v[120:123]
  ds_read_b128 v[188:191], v18 offset:14336
  v_mfma_f32_16x16x32_bf16 v[124:127], a[12:15], v[220:223], v[124:127]
  s_waitcnt lgkmcnt(4)
  v_mfma_f32_16x16x32_bf16 v[64:67], a[16:19], v[160:163], v[64:67]
  ds_read_b128 v[192:195], v19 offset:0
  v_mfma_f32_16x16x32_bf16 v[68:71], a[20:23], v[160:163], v[68:71]
  v_add_u32 v18, s33, v14
  v_mfma_f32_16x16x32_bf16 v[72:75], a[16:19], v[164:167], v[72:75]
  ds_read_b128 v[196:199], v19 offset:2048
  v_mfma_f32_16x16x32_bf16 v[76:79], a[20:23], v[164:167], v[76:79]
  buffer_load_dwordx4 v12, s[8:11], s30 offen offset:2048 lds
  v_mfma_f32_16x16x32_bf16 v[80:83], a[16:19], v[168:171], v[80:83]
  ds_read_b128 v[200:203], v19 offset:4096
  v_mfma_f32_16x16x32_bf16 v[84:87], a[20:23], v[168:171], v[84:87]
  v_mfma_f32_16x16x32_bf16 v[88:91], a[16:19], v[172:175], v[88:91]
  ds_read_b128 v[204:207], v19 offset:6144
  v_mfma_f32_16x16x32_bf16 v[92:95], a[20:23], v[172:175], v[92:95]
  s_waitcnt lgkmcnt(4)
  v_mfma_f32_16x16x32_bf16 v[96:99], a[16:19], v[176:179], v[96:99]
  ds_read_b128 v[208:211], v19 offset:8192
  v_mfma_f32_16x16x32_bf16 v[100:103], a[20:23], v[176:179], v[100:103]
  v_mfma_f32_16x16x32_bf16 v[104:107], a[16:19], v[180:183], v[104:107]
  ds_read_b128 v[212:215], v19 offset:10240
  v_mfma_f32_16x16x32_bf16 v[108:111], a[20:23], v[180:183], v[108:111]
  buffer_load_dwordx4 v13, s[8:11], s30 offen offset:3072 lds
  v_mfma_f32_16x16x32_bf16 v[112:115], a[16:19], v[184:187], v[112:115]
  ds_read_b128 v[216:219], v19 offset:12288
  s_add_u32 s30, s30, 128
  v_mfma_f32_16x16x32_bf16 v[116:119], a[20:23], v[184:187], v[116:119]
  s_add_u32 m0, m0, 16384
  v_mfma_f32_16x16x32_bf16 v[120:123], a[16:19], v[188:191], v[120:123]
  ds_read_b128 v[220:223], v19 offset:14336
  v_mfma_f32_16x16x32_bf16 v[124:127], a[20:23], v[188:191], v[124:127]
  s_waitcnt vmcnt(16) lgkmcnt(4)
  s_barrier
  v_mfma_f32_16x16x32_bf16 v[64:67], a[24:27], v[192:195], v[64:67]
  ds_read_b128 v[160:163], v18 offset:0
  v_mfma_f32_16x16x32_bf16 v[68:71], a[28:31], v[192:195], v[68:71]
  s_cmp_lt_u32 m0, s46
  s_cselect_b32 m0, m0, s47
  v_mfma_f32_16x16x32_bf16 v[72:75], a[24:27], v[196:199], v[72:75]
  ds_read_b128 v[164:167], v18 offset:2048
  v_add_u32 v19, s33, v15
  v_mfma_f32_16x16x32_bf16 v[76:79], a[28:31], v[196:199], v[76:79]
  buffer_load_dwordx4 v10, s[8:11], s30 offen offset:0 lds
  v_mfma_f32_16x16x32_bf16 v[80:83], a[24:27], v[200:203], v[80:83]
  ds_read_b128 v[168:171], v18 offset:4096
  s_add_u32 s33, s33, 16384
  v_mfma_f32_16x16x32_bf16 v[84:87], a[28:31], v[200:203], v[84:87]
  s_cmp_lt_u32 s33, 114688
  s_cselect_b32 s33, s33, 0
  v_mfma_f32_16x16x32_bf16 v[88:91], a[24:27], v[204:207], v[88:91]
  ds_read_b128 v[172:175], v18 offset:6144
  v_mfma_f32_16x16x32_bf16 v[92:95], a[28:31], v[204:207], v[92:95]
  s_waitcnt lgkmcnt(4)
  v_mfma_f32_16x16x32_bf16 v[96:99], a[24:27], v[208:211], v[96:99]
  ds_read_b128 v[176:179], v18 offset:8192
  v_mfma_f32_16x16x32_bf16 v[100:103], a[28:31], v[208:211], v[100:103]
  v_mfma_f32_16x16x32_bf16 v[104:107], a[24:27], v[212:215], v[104:107]
  ds_read_b128 v[180:183], v18 offset:10240
  v_mfma_f32_16x16x32_bf16 v[108:111], a[28:31], v[212:215], v[108:111]
  buffer_load_dwordx4 v11, s[8:11], s30 offen offset:1024 lds
  v_mfma_f32_16x16x32_bf16 v[112:115], a[24:27], v[216:219], v[112:115]
  ds_read_b128 v[184:187], v18 offset:12288
  v_mfma_f32_16x16x32_bf16 v[116:119], a[28:31], v[216:219], v[116:119]
  v_mfma_f32_16x16x32_bf16 v[120:123], a[24:27], v[220:223], v[120:123]
  ds_read_b128 v[188:191], v18 offset:14336
  v_mfma_f32_16x16x32_bf16 v[124:127], a[28:31], v[220:223], v[124:127]
  s_waitcnt lgkmcnt(4)
  v_mfma_f32_16x16x32_bf16 v[64:67], a[32:35], v[160:163], v[64:67]
  ds_read_b128 v[192:195], v19 offset:0
  v_mfma_f32_16x16x32_bf16 v[68:71], a[36:39], v[160:163], v[68:71]
  v_add_u32 v18, s33, v14
  v_mfma_f32_16x16x32_bf16 v[72:75], a[32:35], v[164:167], v[72:75]
  ds_read_b128 v[196:199], v19 offset:2048
  v_mfma_f32_16x16x32_bf16 v[76:79], a[36:39], v[164:167], v[76:79]
  buffer_load_dwordx4 v12, s[8:11], s30 offen offset:2048 lds
  v_mfma_f32_16x16x32_bf16 v[80:83], a[32:35], v[168:171], v[80:83]
  ds_read_b128 v[200:203], v19 offset:4096
  v_mfma_f32_16x16x32_bf16 v[84:87], a[36:39], v[168:171], v[84:87]
  v_mfma_f32_16x16x32_bf16 v[88:91], a[32:35], v[172:175], v[88:91]
  ds_read_b128 v[204:207], v19 offset:6144
  v_mfma_f32_16x16x32_bf16 v[92:95], a[36:39], v[172:175], v[92:95]
  s_waitcnt lgkmcnt(4)
  v_mfma_f32_16x16x32_bf16 v[96:99], a[32:35], v[176:179], v[96:99]
  ds_read_b128 v[208:211], v19 offset:8192
  v_mfma_f32_16x16x32_bf16 v[100:103], a[36:39], v[176:179], v[100:103]
  v_mfma_f32_16x16x32_bf16 v[104:107], a[32:35], v[180:183], v[104:107]
  ds_read_b128 v[212:215], v19 offset:10240
  v_mfma_f32_16x16x32_bf16 v[108:111], a[36:39], v[180:183], v[108:111]
  buffer_load_dwordx4 v13, s[8:11], s30 offen offset:3072 lds
  v_mfma_f32_16x16x32_bf16 v[112:115], a[32:35], v[184:187], v[112:115]
  ds_read_b128 v[216:219], v19 offset:12288
  s_add_u32 s30, s30, 128
  v_mfma_f32_16x16x32_bf16 v[116:119], a[36:39], v[184:187], v[116:119]
  s_add_u32 m0, m0, 16384
  v_mfma_f32_16x16x32_bf16 v[120:123], a[32:35], v[188:191], v[120:123]
  ds_read_b128 v[220:223], v19 offset:14336
  v_mfma_f32_16x16x32_bf16 v[124:127], a[36:39], v[188:191], v[124:127]
  s_waitcnt vmcnt(16) lgkmcnt(4)
  s_barrier
  v_mfma_f32_16x16x32_bf16 v[64:67], a[40:43], v[192:195], v[64:67]
  ds_read_b128 v[160:163], v18 offset:0
  v_mfma_f32_16x16x32_bf16 v[68:71], a[44:47], v[192:195], v[68:71]
  s_cmp_lt_u32 m0, s46
  s_cselect_b32 m0, m0, s47
  v_mfma_f32_16x16x32_bf16 v[72:75], a[40:43], v[196:199], v[72:75]
  ds_read_b128 v[164:167], v18 offset:2048
  v_add_u32 v19, s33, v15
  v_mfma_f32_16x16x32_bf16 v[76:79], a[44:47], v[196:199], v[76:79]
  buffer_load_dwordx4 v10, s[8:11], s30 offen offset:0 lds
  v_mfma_f32_16x16x32_bf16 v[80:83], a[40:43], v[200:203], v[80:83]
  ds_read_b128 v[168:171], v18 offset:4096
  s_add_u32 s33, s33, 16384
  v_mfma_f32_16x16x32_bf16 v[84:87], a[44:47], v[200:203], v[84:87]
  s_cmp_lt_u32 s33, 114688
  s_cselect_b32 s33, s33, 0
  v_mfma_f32_16x16x32_bf16 v[88:91], a[40:43], v[204:207], v[88:91]
  ds_read_b128 v[172:175], v18 offset:6144
  v_mfma_f32_16x16x32_bf16 v[92:95], a[44:47], v[204:207], v[92:95]
  s_waitcnt lgkmcnt(4)
  v_mfma_f32_16x16x32_bf16 v[96:99], a[40:43], v[208:211], v[96:99]
  ds_read_b128 v[176:179], v18 offset:8192
  v_mfma_f32_16x16x32_bf16 v[100:103], a[44:47], v[208:211], v[100:103]
  v_mfma_f32_16x16x32_bf16 v[104:107], a[40:43], v[212:215], v[104:107]
  ds_read_b128 v[180:183], v18 offset:10240
  v_mfma_f32_16x16x32_bf16 v[108:111], a[44:47], v[212:215], v[108:111]
  buffer_load_dwordx4 v11, s[8:11], s30 offen offset:1024 lds
  v_mfma_f32_16x16x32_bf16 v[112:115], a[40:43], v[216:219], v[112:115]
  ds_read_b128 v[184:187], v18 offset:12288
  v_mfma_f32_16x16x32_bf16 v[116:119], a[44:47], v[216:219], v[116:119]
  v_mfma_f32_16x16x32_bf16 v[120:123], a[40:43], v[220:223], v[120:123]
  ds_read_b128 v[188:191], v18 offset:14336
  v_mfma_f32_16x16x32_bf16 v[124:127], a[44:47], v[220:223], v[124:127]
  s_waitcnt lgkmcnt(4)
  v_mfma_f32_16x16x32_bf16 v[64:67], a[48:51], v[160:163], v[64:67]
  ds_read_b128 v[192:195], v19 offset:0
  v_mfma_f32_16x16x32_bf16 v[68:71], a[52:55], v[160:163], v[68:71]
  v_add_u32 v18, s33, v14
  v_mfma_f32_16x16x32_bf16 v[72:75], a[48:51], v[164:167], v[72:75]
  ds_read_b128 v[196:199], v19 offset:2048
  v_mfma_f32_16x16x32_bf16 v[76:79], a[52:55], v[164:167], v[76:79]
  buffer_load_dwordx4 v12, s[8:11], s30 offen offset:2048 lds
  v_mfma_f32_16x16x32_bf16 v[80:83], a[48:51], v[168:171], v[80:83]
  ds_read_b128 v[200:203], v19 offset:4096
  v_mfma_f32_16x16x32_bf16 v[84:87], a[52:55], v[168:171], v[84:87]
  v_mfma_f32_16x16x32_bf16 v[88:91], a[48:51], v[172:175], v[88:91]
  ds_read_b128 v[204:207], v19 offset:6144
  v_mfma_f32_16x16x32_bf16 v[92:95], a[52:55], v[172:175], v[92:95]
  s_waitcnt lgkmcnt(4)
  v_mfma_f32_16x16x32_bf16 v[96:99], a[48:51], v[176:179], v[96:99]
  ds_read_b128 v[208:211], v19 offset:8192
  v_mfma_f32_16x16x32_bf16 v[100:103], a[52:55], v[176:179], v[100:103]
  v_mfma_f32_16x16x32_bf16 v[104:107], a[48:51], v[180:183], v[104:107]
  ds_read_b128 v[212:215], v19 offset:10240
  v_mfma_f32_16x16x32_bf16 v[108:111], a[52:55], v[180:183], v[108:111]
  buffer_load_dwordx4 v13, s[8:11], s30 offen offset:3072 lds
  v_mfma_f32_16x16x32_bf16 v[112:115], a[48:51], v[184:187], v[112:115]
  ds_read_b128 v[216:219], v19 offset:12288
  s_add_u32 s30, s30, 128
  v_mfma_f32_16x16x32_bf16 v[116:119], a[52:55], v[184:187], v[116:119]
  s_add_u32 m0, m0, 16384
  v_mfma_f32_16x16x32_bf16 v[120:123], a[48:51], v[188:191], v[120:123]
  ds_read_b128 v[220:223], v19 offset:14336
  v_mfma_f32_16x16x32_bf16 v[124:127], a[52:55], v[188:191], v[124:127]
  s_waitcnt vmcnt(16) lgkmcnt(4)
  s_barrier
  v_mfma_f32_16x16x32_bf16 v[64:67], a[56:59], v[192:195], v[64:67]
  ds_read_b128 v[160:163], v18 offset:0
  v_mfma_f32_16x16x32_bf16 v[68:71], a[60:63], v[192:195], v[68:71]
  s_cmp_lt_u32 m0, s46
  s_cselect_b32 m0, m0, s47
  v_mfma_f32_16x16x32_bf16 v[72:75], a[56:59], v[196:199], v[72:75]
  ds_read_b128 v[164:167], v18 offset:2048
  v_add_u32 v19, s33, v15
  v_mfma_f32_16x16x32_bf16 v[76:79], a[60:63], v[196:199], v[76:79]
  buffer_load_dwordx4 v10, s[8:11], s30 offen offset:0 lds
  v_mfma_f32_16x16x32_bf16 v[80:83], a[56:59], v[200:203], v[80:83]
  ds_read_b128 v[168:171], v18 offset:4096
  s_add_u32 s33, s33, 16384
  v_mfma_f32_16x16x32_bf16 v[84:87], a[60:63], v[200:203], v[84:87]
  s_cmp_lt_u32 s33, 114688
  s_cselect_b32 s33, s33, 0
  v_mfma_f32_16x16x32_bf16 v[88:91], a[56:59], v[204:207], v[88:91]
  ds_read_b128 v[172:175], v18 offset:6144
  v_mfma_f32_16x16x32_bf16 v[92:95], a[60:63], v[204:207], v[92:95]
  s_waitcnt lgkmcnt(4)
  v_mfma_f32_16x16x32_bf16 v[96:99], a[56:59], v[208:211], v[96:99]
  ds_read_b128 v[176:179], v18 offset:8192
  v_mfma_f32_16x16x32_bf16 v[100:103], a[60:63], v[208:211], v[100:103]
  v_mfma_f32_16x16x32_bf16 v[104:107], a[56:59], v[212:215], v[104:107]
  ds_read_b128 v[180:183], v18 offset:10240
  v_mfma_f32_16x16x32_bf16 v[108:111], a[60:63], v[212:215], v[108:111]
  buffer_load_dwordx4 v11, s[8:11], s30 offen offset:1024 lds
  v_mfma_f32_16x16x32_bf16 v[112:115], a[56:59], v[216:219], v[112:115]
  ds_read_b128 v[184:187], v18 offset:12288
  v_mfma_f32_16x16x32_bf16 v[116:119], a[60:63], v[216:219], v[116:119]
  v_mfma_f32_16x16x32_bf16 v[120:123], a[56:59], v[220:223], v[120:123]
  ds_read_b128 v[188:191], v18 offset:14336
  v_mfma_f32_16x16x32_bf16 v[124:127], a[60:63], v[220:223], v[124:127]
  s_waitcnt lgkmcnt(4)
  v_mfma_f32_16x16x32_bf16 v[64:67], a[64:67], v[160:163], v[64:67]
  ds_read_b128 v[192:195], v19 offset:0
  v_mfma_f32_16x16x32_bf16 v[68:71], a[68:71], v[160:163], v[68:71]
  v_add_u32 v18, s33, v14
  v_mfma_f32_16x16x32_bf16 v[72:75], a[64:67], v[164:167], v[72:75]
  ds_read_b128 v[196:199], v19 offset:2048
  v_mfma_f32_16x16x32_bf16 v[76:79], a[68:71], v[164:167], v[76:79]
  buffer_load_dwordx4 v12, s[8:11], s30 offen offset:2048 lds
  v_mfma_f32_16x16x32_bf16 v[80:83], a[64:67], v[168:171], v[80:83]
  ds_read_b128 v[200:203], v19 offset:4096
  v_mfma_f32_16x16x32_bf16 v[84:87], a[68:71], v[168:171], v[84:87]
  v_mfma_f32_16x16x32_bf16 v[88:91], a[64:67], v[172:175], v[88:91]
  ds_read_b128 v[204:207], v19 offset:6144
  v_mfma_f32_16x16x32_bf16 v[92:95], a[68:71], v[172:175], v[92:95]
  s_waitcnt lgkmcnt(4)
  v_mfma_f32_16x16x32_bf16 v[96:99], a[64:67], v[176:179], v[96:99]
  ds_read_b128 v[208:211], v19 offset:8192
  v_mfma_f32_16x16x32_bf16 v[100:103], a[68:71], v[176:179], v[100:103]
  v_mfma_f32_16x16x32_bf16 v[104:107], a[64:67], v[180:183], v[104:107]
  ds_read_b128 v[212:215], v19 offset:10240
  v_mfma_f32_16x16x32_bf16 v[108:111], a[68:71], v[180:183], v[108:111]
  buffer_load_dwordx4 v13, s[8:11], s30 offen offset:3072 lds
  v_mfma_f32_16x16x32_bf16 v[112:115], a[64:67], v[184:187], v[112:115]
  ds_read_b128 v[216:219], v19 offset:12288
  s_add_u32 s30, s30, s25
  v_mfma_f32_16x16x32_bf16 v[116:119], a[68:71], v[184:187], v[116:119]
  s_sub_u32 s30, s30, 1152
  s_add_u32 m0, m0, 16384
  v_mfma_f32_16x16x32_bf16 v[120:123], a[64:67], v[188:191], v[120:123]
  ds_read_b128 v[220:223], v19 offset:14336
  v_mfma_f32_16x16x32_bf16 v[124:127], a[68:71], v[188:191], v[124:127]
  s_waitcnt vmcnt(16) lgkmcnt(4)
  s_barrier
  v_mfma_f32_16x16x32_bf16 v[64:67], a[72:75], v[192:195], v[64:67]
  ds_read_b128 v[160:163], v18 offset:0
  v_mfma_f32_16x16x32_bf16 v[68:71], a[76:79], v[192:195], v[68:71]
  s_cmp_lt_u32 m0, s46
  s_cselect_b32 m0, m0, s47
  v_mfma_f32_16x16x32_bf16 v[72:75], a[72:75], v[196:199], v[72:75]
  ds_read_b128 v[164:167], v18 offset:2048
  v_add_u32 v19, s33, v15
  v_mfma_f32_16x16x32_bf16 v[76:79], a[76:79], v[196:199], v[76:79]
  buffer_load_dwordx4 v10, s[8:11], s30 offen offset:0 lds
  v_mfma_f32_16x16x32_bf16 v[80:83], a[72:75], v[200:203], v[80:83]
  ds_read_b128 v[168:171], v18 offset:4096
  s_add_u32 s33, s33, 16384
  v_mfma_f32_16x16x32_bf16 v[84:87], a[76:79], v[200:203], v[84:87]
  s_cmp_lt_u32 s33, 114688
  s_cselect_b32 s33, s33, 0
  v_mfma_f32_16x16x32_bf16 v[88:91], a[72:75], v[204:207], v[88:91]
  ds_read_b128 v[172:175], v18 offset:6144
  v_mfma_f32_16x16x32_bf16 v[92:95], a[76:79], v[204:207], v[92:95]
  s_waitcnt lgkmcnt(4)
  v_mfma_f32_16x16x32_bf16 v[96:99], a[72:75], v[208:211], v[96:99]
  ds_read_b128 v[176:179], v18 offset:8192
  v_mfma_f32_16x16x32_bf16 v[100:103], a[76:79], v[208:211], v[100:103]
  v_mfma_f32_16x16x32_bf16 v[104:107], a[72:75], v[212:215], v[104:107]
  ds_read_b128 v[180:183], v18 offset:10240
  v_mfma_f32_16x16x32_bf16 v[108:111], a[76:79], v[212:215], v[108:111]
  buffer_load_dwordx4 v11, s[8:11], s30 offen offset:1024 lds
  v_mfma_f32_16x16x32_bf16 v[112:115], a[72:75], v[216:219], v[112:115]
  ds_read_b128 v[184:187], v18 offset:12288
  v_mfma_f32_16x16x32_bf16 v[116:119], a[76:79], v[216:219], v[116:119]
  v_mfma_f32_16x16x32_bf16 v[120:123], a[72:75], v[220:223], v[120:123]
  ds_read_b128 v[188:191], v18 offset:14336
  v_mfma_f32_16x16x32_bf16 v[124:127], a[76:79], v[220:223], v[124:127]
  s_waitcnt lgkmcnt(4)
  v_mfma_f32_16x16x32_bf16 v[64:67], a[80:83], v[160:163], v[64:67]
  ds_read_b128 v[192:195], v19 offset:0
  v_mfma_f32_16x16x32_bf16 v[68:71], a[84:87], v[160:163], v[68:71]
  v_add_u32 v18, s33, v14
  v_mfma_f32_16x16x32_bf16 v[72:75], a[80:83], v[164:167], v[72:75]
  ds_read_b128 v[196:199], v19 offset:2048
  v_mfma_f32_16x16x32_bf16 v[76:79], a[84:87], v[164:167], v[76:79]
  buffer_load_dwordx4 v12, s[8:11], s30 offen offset:2048 lds
  v_mfma_f32_16x16x32_bf16 v[80:83], a[80:83], v[168:171], v[80:83]
  ds_read_b128 v[200:203], v19 offset:4096
  v_mfma_f32_16x16x32_bf16 v[84:87], a[84:87], v[168:171], v[84:87]
  v_mfma_f32_16x16x32_bf16 v[88:91], a[80:83], v[172:175], v[88:91]
  ds_read_b128 v[204:207], v19 offset:6144
  v_mfma_f32_16x16x32_bf16 v[92:95], a[84:87], v[172:175], v[92:95]
  s_waitcnt lgkmcnt(4)
  v_mfma_f32_16x16x32_bf16 v[96:99], a[80:83], v[176:179], v[96:99]
  ds_read_b128 v[208:211], v19 offset:8192
  v_mfma_f32_16x16x32_bf16 v[100:103], a[84:87], v[176:179], v[100:103]
  v_mfma_f32_16x16x32_bf16 v[104:107], a[80:83], v[180:183], v[104:107]
  ds_read_b128 v[212:215], v19 offset:10240
  v_mfma_f32_16x16x32_bf16 v[108:111], a[84:87], v[180:183], v[108:111]
  buffer_load_dwordx4 v13, s[8:11], s30 offen offset:3072 lds
  v_mfma_f32_16x16x32_bf16 v[112:115], a[80:83], v[184:187], v[112:115]
  ds_read_b128 v[216:219], v19 offset:12288
  s_add_u32 s30, s30, 128
  v_mfma_f32_16x16x32_bf16 v[116:119], a[84:87], v[184:187], v[116:119]
  s_add_u32 m0, m0, 16384
  v_mfma_f32_16x16x32_bf16 v[120:123], a[80:83], v[188:191], v[120:123]
  ds_read_b128 v[220:223], v19 offset:14336
  v_mfma_f32_16x16x32_bf16 v[124:127], a[84:87], v[188:191], v[124:127]
  s_waitcnt vmcnt(16) lgkmcnt(4)
  s_barrier
  v_mfma_f32_16x16x32_bf16 v[64:67], a[88:91], v[192:195], v[64:67]
  ds_read_b128 v[160:163], v18 offset:0
  v_mfma_f32_16x16x32_bf16 v[68:71], a[92:95], v[192:195], v[68:71]
  s_cmp_lt_u32 m0, s46
  s_cselect_b32 m0, m0, s47
  v_mfma_f32_16x16x32_bf16 v[72:75], a[88:91], v[196:199], v[72:75]
  ds_read_b128 v[164:167], v18 offset:2048
  v_add_u32 v19, s33, v15
  v_mfma_f32_16x16x32_bf16 v[76:79], a[92:95], v[196:199], v[76:79]
  buffer_load_dwordx4 v10, s[8:11], s30 offen offset:0 lds
  v_mfma_f32_16x16x32_bf16 v[80:83], a[88:91], v[200:203], v[80:83]
  ds_read_b128 v[168:171], v18 offset:4096
  s_add_u32 s33, s33, 16384
  v_mfma_f32_16x16x32_bf16 v[84:87], a[92:95], v[200:203], v[84:87]
  s_cmp_lt_u32 s33, 114688
  s_cselect_b32 s33, s33, 0
  v_mfma_f32_16x16x32_bf16 v[88:91], a[88:91], v[204:207], v[88:91]
  ds_read_b128 v[172:175], v18 offset:6144
  v_mfma_f32_16x16x32_bf16 v[92:95], a[92:95], v[204:207], v[92:95]
  s_waitcnt lgkmcnt(4)
  v_mfma_f32_16x16x32_bf16 v[96:99], a[88:91], v[208:211], v[96:99]
  ds_read_b128 v[176:179], v18 offset:8192
  v_mfma_f32_16x16x32_bf16 v[100:103], a[92:95], v[208:211], v[100:103]
  v_mfma_f32_16x16x32_bf16 v[104:107], a[88:91], v[212:215], v[104:107]
  ds_read_b128 v[180:183], v18 offset:10240
  v_mfma_f32_16x16x32_bf16 v[108:111], a[92:95], v[212:215], v[108:111]
  buffer_load_dwordx4 v11, s[8:11], s30 offen offset:1024 lds
  v_mfma_f32_16x16x32_bf16 v[112:115], a[88:91], v[216:219], v[112:115]
  ds_read_b128 v[184:187], v18 offset:12288
  v_mfma_f32_16x16x32_bf16 v[116:119], a[92:95], v[216:219], v[116:119]
  v_mfma_f32_16x16x32_bf16 v[120:123], a[88:91], v[220:223], v[120:123]
  ds_read_b128 v[188:191], v18 offset:14336
  v_mfma_f32_16x16x32_bf16 v[124:127], a[92:95], v[220:223], v[124:127]
  s_waitcnt lgkmcnt(4)
  v_mfma_f32_16x16x32_bf16 v[64:67], a[96:99], v[160:163], v[64:67]
  ds_read_b128 v[192:195], v19 offset:0
  v_mfma_f32_16x16x32_bf16 v[68:71], a[100:103], v[160:163], v[68:71]
  v_add_u32 v18, s33, v14
  v_mfma_f32_16x16x32_bf16 v[72:75], a[96:99], v[164:167], v[72:75]
  ds_read_b128 v[196:199], v19 offset:2048
  v_mfma_f32_16x16x32_bf16 v[76:79], a[100:103], v[164:167], v[76:79]
  buffer_load_dwordx4 v12, s[8:11], s30 offen offset:2048 lds
  v_mfma_f32_16x16x32_bf16 v[80:83], a[96:99], v[168:171], v[80:83]
  ds_read_b128 v[200:203], v19 offset:4096
  v_mfma_f32_16x16x32_bf16 v[84:87], a[100:103], v[168:171], v[84:87]
  v_mfma_f32_16x16x32_bf16 v[88:91], a[96:99], v[172:175], v[88:91]
  ds_read_b128 v[204:207], v19 offset:6144
  v_mfma_f32_16x16x32_bf16 v[92:95], a[100:103], v[172:175], v[92:95]
  s_waitcnt lgkmcnt(4)
  v_mfma_f32_16x16x32_bf16 v[96:99], a[96:99], v[176:179], v[96:99]
  ds_read_b128 v[208:211], v19 offset:8192
  v_mfma_f32_16x16x32_bf16 v[100:103], a[100:103], v[176:179], v[100:103]
  v_mfma_f32_16x16x32_bf16 v[104:107], a[96:99], v[180:183], v[104:107]
  ds_read_b128 v[212:215], v19 offset:10240
  v_mfma_f32_16x16x32_bf16 v[108:111], a[100:103], v[180:183], v[108:111]
  buffer_load_dwordx4 v13, s[8:11], s30 offen offset:3072 lds
  v_mfma_f32_16x16x32_bf16 v[112:115], a[96:99], v[184:187], v[112:115]
  ds_read_b128 v[216:219], v19 offset:12288
  s_add_u32 s30, s30, 128
  v_mfma_f32_16x16x32_bf16 v[116:119], a[100:103], v[184:187], v[116:119]
  s_add_u32 m0, m0, 16384
  v_mfma_f32_16x16x32_bf16 v[120:123], a[96:99], v[188:191], v[120:123]
  ds_read_b128 v[220:223], v19 offset:14336
  v_mfma_f32_16x16x32_bf16 v[124:127], a[100:103], v[188:191], v[124:127]
  s_waitcnt vmcnt(16) lgkmcnt(4)
  s_barrier
  v_mfma_f32_16x16x32_bf16 v[64:67], a[104:107], v[192:195], v[64:67]
  ds_read_b128 v[160:163], v18 offset:0
  v_mfma_f32_16x16x32_bf16 v[68:71], a[108:111], v[192:195], v[68:71]
  s_cmp_lt_u32 m0, s46
  s_cselect_b32 m0, m0, s47
  v_mfma_f32_16x16x32_bf16 v[72:75], a[104:107], v[196:199], v[72:75]
  ds_read_b128 v[164:167], v18 offset:2048
  v_add_u32 v19, s33, v15
  v_mfma_f32_16x16x32_bf16 v[76:79], a[108:111], v[196:199], v[76:79]
  buffer_load_dwordx4 v10, s[8:11], s30 offen offset:0 lds
  v_mfma_f32_16x16x32_bf16 v[80:83], a[104:107], v[200:203], v[80:83]
  ds_read_b128 v[168:171], v18 offset:4096
  s_add_u32 s33, s33, 16384
  v_mfma_f32_16x16x32_bf16 v[84:87], a[108:111], v[200:203], v[84:87]
  s_cmp_lt_u32 s33, 114688
  s_cselect_b32 s33, s33, 0
  v_mfma_f32_16x16x32_bf16 v[88:91], a[104:107], v[204:207], v[88:91]
  ds_read_b128 v[172:175], v18 offset:6144
  v_mfma_f32_16x16x32_bf16 v[92:95], a[108:111], v[204:207], v[92:95]
  s_waitcnt lgkmcnt(4)
  v_mfma_f32_16x16x32_bf16 v[96:99], a[104:107], v[208:211], v[96:99]
  ds_read_b128 v[176:179], v18 offset:8192
  v_mfma_f32_16x16x32_bf16 v[100:103], a[108:111], v[208:211], v[100:103]
  v_mfma_f32_16x16x32_bf16 v[104:107], a[104:107], v[212:215], v[104:107]
  ds_read_b128 v[180:183], v18 offset:10240
  v_mfma_f32_16x16x32_bf16 v[108:111], a[108:111], v[212:215], v[108:111]
  buffer_load_dwordx4 v11, s[8:11], s30 offen offset:1024 lds
  v_mfma_f32_16x16x32_bf16 v[112:115], a[104:107], v[216:219], v[112:115]
  ds_read_b128 v[184:187], v18 offset:12288
  v_mfma_f32_16x16x32_bf16 v[116:119], a[108:111], v[216:219], v[116:119]
  v_mfma_f32_16x16x32_bf16 v[120:123], a[104:107], v[220:223], v[120:123]
  ds_read_b128 v[188:191], v18 offset:14336
  v_mfma_f32_16x16x32_bf16 v[124:127], a[108:111], v[220:223], v[124:127]
  s_waitcnt lgkmcnt(4)
  v_mfma_f32_16x16x32_bf16 v[64:67], a[112:115], v[160:163], v[64:67]
  ds_read_b128 v[192:195], v19 offset:0
  v_mfma_f32_16x16x32_bf16 v[68:71], a[116:119], v[160:163], v[68:71]
  v_add_u32 v18, s33, v14
  v_mfma_f32_16x16x32_bf16 v[72:75], a[112:115], v[164:167], v[72:75]
  ds_read_b128 v[196:199], v19 offset:2048
  v_mfma_f32_16x16x32_bf16 v[76:79], a[116:119], v[164:167], v[76:79]
  buffer_load_dwordx4 v12, s[8:11], s30 offen offset:2048 lds
  v_mfma_f32_16x16x32_bf16 v[80:83], a[112:115], v[168:171], v[80:83]
  ds_read_b128 v[200:203], v19 offset:4096
  v_mfma_f32_16x16x32_bf16 v[84:87], a[116:119], v[168:171], v[84:87]
  v_mfma_f32_16x16x32_bf16 v[88:91], a[112:115], v[172:175], v[88:91]
  ds_read_b128 v[204:207], v19 offset:6144
  v_mfma_f32_16x16x32_bf16 v[92:95], a[116:119], v[172:175], v[92:95]
  s_waitcnt lgkmcnt(4)
  v_mfma_f32_16x16x32_bf16 v[96:99], a[112:115], v[176:179], v[96:99]
  ds_read_b128 v[208:211], v19 offset:8192
  v_mfma_f32_16x16x32_bf16 v[100:103], a[116:119], v[176:179], v[100:103]
  v_mfma_f32_16x16x32_bf16 v[104:107], a[112:115], v[180:183], v[104:107]
  ds_read_b128 v[212:215], v19 offset:10240
  v_mfma_f32_16x16x32_bf16 v[108:111], a[116:119], v[180:183], v[108:111]
  buffer_load_dwordx4 v13, s[8:11], s30 offen offset:3072 lds
  v_mfma_f32_16x16x32_bf16 v[112:115], a[112:115], v[184:187], v[112:115]
  ds_read_b128 v[216:219], v19 offset:12288
  s_add_u32 s30, s30, 128
  v_mfma_f32_16x16x32_bf16 v[116:119], a[116:119], v[184:187], v[116:119]
  s_add_u32 m0, m0, 16384
  v_mfma_f32_16x16x32_bf16 v[120:123], a[112:115], v[188:191], v[120:123]
  ds_read_b128 v[220:223], v19 offset:14336
  v_mfma_f32_16x16x32_bf16 v[124:127], a[116:119], v[188:191], v[124:127]
  s_waitcnt vmcnt(16) lgkmcnt(4)
  s_barrier
  v_mfma_f32_16x16x32_bf16 v[64:67], a[120:123], v[192:195], v[64:67]
  ds_read_b128 v[160:163], v18 offset:0
  v_mfma_f32_16x16x32_bf16 v[68:71], a[124:127], v[192:195], v[68:71]
  s_cmp_lt_u32 m0, s46
  s_cselect_b32 m0, m0, s47
  v_mfma_f32_16x16x32_bf16 v[72:75], a[120:123], v[196:199], v[72:75]
  ds_read_b128 v[164:167], v18 offset:2048
  v_add_u32 v19, s33, v15
  v_mfma_f32_16x16x32_bf16 v[76:79], a[124:127], v[196:199], v[76:79]
  buffer_load_dwordx4 v10, s[8:11], s30 offen offset:0 lds
  v_mfma_f32_16x16x32_bf16 v[80:83], a[120:123], v[200:203], v[80:83]
  ds_read_b128 v[168:171], v18 offset:4096
  s_add_u32 s33, s33, 16384
  v_mfma_f32_16x16x32_bf16 v[84:87], a[124:127], v[200:203], v[84:87]
  s_cmp_lt_u32 s33, 114688
  s_cselect_b32 s33, s33, 0
  v_mfma_f32_16x16x32_bf16 v[88:91], a[120:123], v[204:207], v[88:91]
  ds_read_b128 v[172:175], v18 offset:6144
  v_mfma_f32_16x16x32_bf16 v[92:95], a[124:127], v[204:207], v[92:95]
  s_waitcnt lgkmcnt(4)
  v_mfma_f32_16x16x32_bf16 v[96:99], a[120:123], v[208:211], v[96:99]
  ds_read_b128 v[176:179], v18 offset:8192
  v_mfma_f32_16x16x32_bf16 v[100:103], a[124:127], v[208:211], v[100:103]
  v_mfma_f32_16x16x32_bf16 v[104:107], a[120:123], v[212:215], v[104:107]
  ds_read_b128 v[180:183], v18 offset:10240
  v_mfma_f32_16x16x32_bf16 v[108:111], a[124:127], v[212:215], v[108:111]
  buffer_load_dwordx4 v11, s[8:11], s30 offen offset:1024 lds
  v_mfma_f32_16x16x32_bf16 v[112:115], a[120:123], v[216:219], v[112:115]
  ds_read_b128 v[184:187], v18 offset:12288
  v_mfma_f32_16x16x32_bf16 v[116:119], a[124:127], v[216:219], v[116:119]
  v_mfma_f32_16x16x32_bf16 v[120:123], a[120:123], v[220:223], v[120:123]
  ds_read_b128 v[188:191], v18 offset:14336
  v_mfma_f32_16x16x32_bf16 v[124:127], a[124:127], v[220:223], v[124:127]
  s_waitcnt lgkmcnt(4)
  v_mfma_f32_16x16x32_bf16 v[64:67], a[128:131], v[160:163], v[64:67]
  ds_read_b128 v[192:195], v19 offset:0
  v_mfma_f32_16x16x32_bf16 v[68:71], a[132:135], v[160:163], v[68:71]
  v_add_u32 v18, s33, v14
  v_mfma_f32_16x16x32_bf16 v[72:75], a[128:131], v[164:167], v[72:75]
  ds_read_b128 v[196:199], v19 offset:2048
  v_mfma_f32_16x16x32_bf16 v[76:79], a[132:135], v[164:167], v[76:79]
  buffer_load_dwordx4 v12, s[8:11], s30 offen offset:2048 lds
  v_mfma_f32_16x16x32_bf16 v[80:83], a[128:131], v[168:171], v[80:83]
  ds_read_b128 v[200:203], v19 offset:4096
  v_mfma_f32_16x16x32_bf16 v[84:87], a[132:135], v[168:171], v[84:87]
  v_mfma_f32_16x16x32_bf16 v[88:91], a[128:131], v[172:175], v[88:91]
  ds_read_b128 v[204:207], v19 offset:6144
  v_mfma_f32_16x16x32_bf16 v[92:95], a[132:135], v[172:175], v[92:95]
  s_waitcnt lgkmcnt(4)
  v_mfma_f32_16x16x32_bf16 v[96:99], a[128:131], v[176:179], v[96:99]
  ds_read_b128 v[208:211], v19 offset:8192
  v_mfma_f32_16x16x32_bf16 v[100:103], a[132:135], v[176:179], v[100:103]
  v_mfma_f32_16x16x32_bf16 v[104:107], a[128:131], v[180:183], v[104:107]
  ds_read_b128 v[212:215], v19 offset:10240
  v_mfma_f32_16x16x32_bf16 v[108:111], a[132:135], v[180:183], v[108:111]
  buffer_load_dwordx4 v13, s[8:11], s30 offen offset:3072 lds
  v_mfma_f32_16x16x32_bf16 v[112:115], a[128:131], v[184:187], v[112:115]
  ds_read_b128 v[216:219], v19 offset:12288
  s_add_u32 s30, s30, 128
  v_mfma_f32_16x16x32_bf16 v[116:119], a[132:135], v[184:187], v[116:119]
  s_add_u32 m0, m0, 16384
  v_mfma_f32_16x16x32_bf16 v[120:123], a[128:131], v[188:191], v[120:123]
  ds_read_b128 v[220:223], v19 offset:14336
  v_mfma_f32_16x16x32_bf16 v[124:127], a[132:135], v[188:191], v[124:127]
  s_waitcnt vmcnt(16) lgkmcnt(4)
  s_barrier
  v_mfma_f32_16x16x32_bf16 v[64:67], a[136:139], v[192:195], v[64:67]
  ds_read_b128 v[160:163], v18 offset:0
  v_mfma_f32_16x16x32_bf16 v[68:71], a[140:143], v[192:195], v[68:71]
  s_cmp_lt_u32 m0, s46
  s_cselect_b32 m0, m0, s47
  v_mfma_f32_16x16x32_bf16 v[72:75], a[136:139], v[196:199], v[72:75]
  ds_read_b128 v[164:167], v18 offset:2048
  v_add_u32 v19, s33, v15
  v_mfma_f32_16x16x32_bf16 v[76:79], a[140:143], v[196:199], v[76:79]
  buffer_load_dwordx4 v10, s[8:11], s30 offen offset:0 lds
  v_mfma_f32_16x16x32_bf16 v[80:83], a[136:139], v[200:203], v[80:83]
  ds_read_b128 v[168:171], v18 offset:4096
  s_add_u32 s33, s33, 16384
  v_mfma_f32_16x16x32_bf16 v[84:87], a[140:143], v[200:203], v[84:87]
  s_cmp_lt_u32 s33, 114688
  s_cselect_b32 s33, s33, 0
  v_mfma_f32_16x16x32_bf16 v[88:91], a[136:139], v[204:207], v[88:91]
  ds_read_b128 v[172:175], v18 offset:6144
  v_mfma_f32_16x16x32_bf16 v[92:95], a[140:143], v[204:207], v[92:95]
  s_waitcnt lgkmcnt(4)
  v_mfma_f32_16x16x32_bf16 v[96:99], a[136:139], v[208:211], v[96:99]
  ds_read_b128 v[176:179], v18 offset:8192
  v_mfma_f32_16x16x32_bf16 v[100:103], a[140:143], v[208:211], v[100:103]
  v_mfma_f32_16x16x32_bf16 v[104:107], a[136:139], v[212:215], v[104:107]
  ds_read_b128 v[180:183], v18 offset:10240
  v_mfma_f32_16x16x32_bf16 v[108:111], a[140:143], v[212:215], v[108:111]
  buffer_load_dwordx4 v11, s[8:11], s30 offen offset:1024 lds
  v_mfma_f32_16x16x32_bf16 v[112:115], a[136:139], v[216:219], v[112:115]
  ds_read_b128 v[184:187], v18 offset:12288
  v_mfma_f32_16x16x32_bf16 v[116:119], a[140:143], v[216:219], v[116:119]
  v_mfma_f32_16x16x32_bf16 v[120:123], a[136:139], v[220:223], v[120:123]
  ds_read_b128 v[188:191], v18 offset:14336
  v_mfma_f32_16x16x32_bf16 v[124:127], a[140:143], v[220:223], v[124:127]
  s_waitcnt lgkmcnt(4)
  v_mfma_f32_16x16x32_bf16 v[64:67], a[144:147], v[160:163], v[64:67]
  ds_read_b128 v[192:195], v19 offset:0
  v_mfma_f32_16x16x32_bf16 v[68:71], a[148:151], v[160:163], v[68:71]
  v_add_u32 v18, s33, v14
  v_mfma_f32_16x16x32_bf16 v[72:75], a[144:147], v[164:167], v[72:75]
  ds_read_b128 v[196:199], v19 offset:2048
  v_mfma_f32_16x16x32_bf16 v[76:79], a[148:151], v[164:167], v[76:79]
  buffer_load_dwordx4 v12, s[8:11], s30 offen offset:2048 lds
  v_mfma_f32_16x16x32_bf16 v[80:83], a[144:147], v[168:171], v[80:83]
  ds_read_b128 v[200:203], v19 offset:4096
  v_mfma_f32_16x16x32_bf16 v[84:87], a[148:151], v[168:171], v[84:87]
  v_mfma_f32_16x16x32_bf16 v[88:91], a[144:147], v[172:175], v[88:91]
  ds_read_b128 v[204:207], v19 offset:6144
  v_mfma_f32_16x16x32_bf16 v[92:95], a[148:151], v[172:175], v[92:95]
  s_waitcnt lgkmcnt(4)
  v_mfma_f32_16x16x32_bf16 v[96:99], a[144:147], v[176:179], v[96:99]
  ds_read_b128 v[208:211], v19 offset:8192
  v_mfma_f32_16x16x32_bf16 v[100:103], a[148:151], v[176:179], v[100:103]
  v_mfma_f32_16x16x32_bf16 v[104:107], a[144:147], v[180:183], v[104:107]
  ds_read_b128 v[212:215], v19 offset:10240
  v_mfma_f32_16x16x32_bf16 v[108:111], a[148:151], v[180:183], v[108:111]
  buffer_load_dwordx4 v13, s[8:11], s30 offen offset:3072 lds
  v_mfma_f32_16x16x32_bf16 v[112:115], a[144:147], v[184:187], v[112:115]
  ds_read_b128 v[216:219], v19 offset:12288
  s_add_u32 s30, s30, 128
  v_mfma_f32_16x16x32_bf16 v[116:119], a[148:151], v[184:187], v[116:119]
  s_add_u32 m0, m0, 16384
  v_mfma_f32_16x16x32_bf16 v[120:123], a[144:147], v[188:191], v[120:123]
  ds_read_b128 v[220:223], v19 offset:14336
  v_mfma_f32_16x16x32_bf16 v[124:127], a[148:151], v[188:191], v[124:127]
  s_waitcnt vmcnt(16) lgkmcnt(4)
  s_barrier
  v_mfma_f32_16x16x32_bf16 v[64:67], a[152:155], v[192:195], v[64:67]
  ds_read_b128 v[160:163], v18 offset:0
  v_mfma_f32_16x16x32_bf16 v[68:71], a[156:159], v[192:195], v[68:71]
  s_cmp_lt_u32 m0, s46
  s_cselect_b32 m0, m0, s47
  v_mfma_f32_16x16x32_bf16 v[72:75], a[152:155], v[196:199], v[72:75]
  ds_read_b128 v[164:167], v18 offset:2048
  v_add_u32 v19, s33, v15
  v_mfma_f32_16x16x32_bf16 v[76:79], a[156:159], v[196:199], v[76:79]
  buffer_load_dwordx4 v10, s[8:11], s30 offen offset:0 lds
  v_cvt_pk_bf16_f32 v224, v64, v65
  v_cvt_pk_bf16_f32 v225, v66, v67
  v_mfma_f32_16x16x32_bf16 v[80:83], a[152:155], v[200:203], v[80:83]
  ds_read_b128 v[168:171], v18 offset:4096
  s_add_u32 s33, s33, 16384
  v_cvt_pk_bf16_f32 v226, v68, v69
  v_cvt_pk_bf16_f32 v227, v70, v71
  v_mfma_f32_16x16x32_bf16 v[84:87], a[156:159], v[200:203], v[84:87]
  s_cmp_lt_u32 s33, 114688
  s_cselect_b32 s33, s33, 0
  ds_write_b64 v22, v[224:225] offset:0
  v_mfma_f32_16x16x32_bf16 v[88:91], a[152:155], v[204:207], v[88:91]
  ds_read_b128 v[172:175], v18 offset:6144
  ds_write_b64 v22, v[226:227] offset:32
  v_cvt_pk_bf16_f32 v230, v72, v73
  v_mfma_f32_16x16x32_bf16 v[92:95], a[156:159], v[204:207], v[92:95]
  s_waitcnt lgkmcnt(6)
  v_cvt_pk_bf16_f32 v231, v74, v75
  v_cvt_pk_bf16_f32 v232, v76, v77
  v_cvt_pk_bf16_f32 v233, v78, v79
  v_mfma_f32_16x16x32_bf16 v[96:99], a[152:155], v[208:211], v[96:99]
  ds_read_b128 v[176:179], v18 offset:8192
  ds_write_b64 v22, v[230:231] offset:4224
  v_mfma_f32_16x16x32_bf16 v[100:103], a[156:159], v[208:211], v[100:103]
  ds_write_b64 v22, v[232:233] offset:4256
  v_cvt_pk_bf16_f32 v224, v80, v81
  v_cvt_pk_bf16_f32 v225, v82, v83
  v_mfma_f32_16x16x32_bf16 v[104:107], a[152:155], v[212:215], v[104:107]
  ds_read_b128 v[180:183], v18 offset:10240
  v_cvt_pk_bf16_f32 v226, v84, v85
  v_cvt_pk_bf16_f32 v227, v86, v87
  v_mfma_f32_16x16x32_bf16 v[108:111], a[156:159], v[212:215], v[108:111]
  buffer_load_dwordx4 v11, s[8:11], s30 offen offset:1024 lds
  ds_write_b64 v22, v[224:225] offset:8448
  v_mfma_f32_16x16x32_bf16 v[112:115], a[152:155], v[216:219], v[112:115]
  ds_read_b128 v[184:187], v18 offset:12288
  ds_write_b64 v22, v[226:227] offset:8480
  v_cvt_pk_bf16_f32 v230, v88, v89
  v_mfma_f32_16x16x32_bf16 v[116:119], a[156:159], v[216:219], v[116:119]
  v_cvt_pk_bf16_f32 v231, v90, v91
  v_cvt_pk_bf16_f32 v232, v92, v93
  v_cvt_pk_bf16_f32 v233, v94, v95
  v_mfma_f32_16x16x32_bf16 v[120:123], a[152:155], v[220:223], v[120:123]
  ds_read_b128 v[188:191], v18 offset:14336
  ds_write_b64 v22, v[230:231] offset:12672
  v_mfma_f32_16x16x32_bf16 v[124:127], a[156:159], v[220:223], v[124:127]
  ds_write_b64 v22, v[232:233] offset:12704
  v_cvt_pk_bf16_f32 v224, v96, v97
  v_cvt_pk_bf16_f32 v225, v98, v99
bf_end_239:
  v_cvt_pk_bf16_f32 v226, v100, v101
  v_cvt_pk_bf16_f32 v227, v102, v103
  ds_write_b64 v22, v[224:225] offset:16896
  ds_write_b64 v22, v[226:227] offset:16928
  v_cvt_pk_bf16_f32 v230, v104, v105
  v_cvt_pk_bf16_f32 v231, v106, v107
  v_cvt_pk_bf16_f32 v232, v108, v109
  v_cvt_pk_bf16_f32 v233, v110, v111
  ds_write_b64 v22, v[230:231] offset:21120
  ds_write_b64 v22, v[232:233] offset:21152
  v_cvt_pk_bf16_f32 v224, v112, v113
  v_cvt_pk_bf16_f32 v225, v114, v115
  v_cvt_pk_bf16_f32 v226, v116, v117
  v_cvt_pk_bf16_f32 v227, v118, v119
  ds_write_b64 v22, v[224:225] offset:25344
  ds_write_b64 v22, v[226:227] offset:25376
  v_cvt_pk_bf16_f32 v230, v120, v121
  v_cvt_pk_bf16_f32 v231, v122, v123
  v_cvt_pk_bf16_f32 v232, v124, v125
  v_cvt_pk_bf16_f32 v233, v126, v127
  ds_write_b64 v22, v[230:231] offset:29568
  ds_write_b64 v22, v[232:233] offset:29600
  s_cmp_lg_u32 s26, 6
  s_cbranch_scc1 bw_240
  buffer_load_dword v32, v32, s[64:67], 0 offen sc1
  buffer_load_dwordx4 v[40:43], v33, s[12:15], s50 offen offset:0
  buffer_load_dwordx4 v[40:43], v33, s[12:15], s50 offen offset:1024
  buffer_load_dwordx4 v[40:43], v33, s[12:15], s50 offen offset:2048
  buffer_load_dwordx4 v[40:43], v33, s[12:15], s50 offen offset:3072
  buffer_load_dwordx4 v[40:43], v33, s[12:15], s51 offen offset:0
  buffer_load_dwordx4 v[40:43], v33, s[12:15], s51 offen offset:1024
  buffer_load_dwordx4 v[40:43], v33, s[12:15], s51 offen offset:2048
bw_240:
  s_waitcnt lgkmcnt(0)
  s_barrier
  ds_read_b64 v[144:145], v34 offset:1848
  ds_read_b64 v[146:147], v34 offset:1856
  ds_read_b64 v[148:149], v34 offset:1864
  ds_read_b64 v[150:151], v34 offset:1872
  ds_read_b64 v[152:153], v34 offset:1880
  ds_read_b64 v[64:65], v34 offset:1928
  ds_read_b64 v[66:67], v34 offset:1936
  ds_read_b64 v[68:69], v34 offset:1944
  ds_read_b64 v[70:71], v34 offset:1952
  ds_read_b64 v[72:73], v34 offset:1960
  ds_read_b64 v[74:75], v34 offset:1664
  ds_read_b64 v[76:77], v34 offset:1672
  ds_read_b64 v[78:79], v34 offset:1680
  ds_read_b64 v[80:81], v34 offset:1688
  ds_read_b64 v[82:83], v34 offset:1696
  ds_read_b64 v[84:85], v34 offset:1400
  ds_read_b64 v[86:87], v34 offset:1408
  ds_read_b64 v[88:89], v34 offset:1416
  ds_read_b64 v[90:91], v34 offset:1424
  ds_read_b64 v[92:93], v34 offset:1432
  ds_read_b64 v[94:95], v34 offset:1136
  ds_read_b64 v[96:97], v34 offset:1144
  ds_read_b64 v[98:99], v34 offset:1152
  ds_read_b64 v[100:101], v34 offset:1160
  ds_read_b64 v[102:103], v34 offset:1168
  ds_read_b64 v[104:105], v34 offset:872
  ds_read_b64 v[106:107], v34 offset:880
  ds_read_b64 v[108:109], v34 offset:888
  ds_read_b64 v[110:111], v34 offset:896
  ds_read_b64 v[112:113], v34 offset:904
  ds_read_b64 v[114:115], v34 offset:608
  ds_read_b64 v[116:117], v34 offset:616
  ds_read_b64 v[118:119], v34 offset:624
  ds_read_b64 v[120:121], v34 offset:632
  ds_read_b64 v[122:123], v34 offset:640
  ds_read_b64 v[124:125], v34 offset:344
  ds_read_b64 v[126:127], v34 offset:352
  ds_read_b64 v[128:129], v34 offset:360
  ds_read_b64 v[130:131], v34 offset:368
  ds_read_b64 v[132:133], v34 offset:376
  ds_read_b64 v[134:135], v34 offset:80
  ds_read_b64 v[136:137], v34 offset:88
  ds_read_b64 v[138:139], v34 offset:96
  ds_read_b64 v[140:141], v34 offset:104
  ds_read_b64 v[142:143], v34 offset:112
  v_mov_b32 v224, 0
  v_mov_b32 v225, 0
  v_mov_b32 v226, 0
  v_mov_b32 v227, 0
  v_mov_b32 v228, 0
  v_mov_b32 v229, 0
  v_mov_b32 v230, 0
  v_mov_b32 v231, 0
  s_waitcnt lgkmcnt(15)
  v_dot2c_f32_bf16 v224, v64, v144
  v_dot2c_f32_bf16 v225, v74, v144
  v_dot2c_f32_bf16 v226, v84, v144
  v_dot2c_f32_bf16 v227, v94, v144
  v_dot2c_f32_bf16 v224, v65, v145
  v_dot2c_f32_bf16 v225, v75, v145
  v_dot2c_f32_bf16 v226, v85, v145
  v_dot2c_f32_bf16 v227, v95, v145
  v_dot2c_f32_bf16 v224, v66, v146
  v_dot2c_f32_bf16 v225, v76, v146
  v_dot2c_f32_bf16 v226, v86, v146
  v_dot2c_f32_bf16 v227, v96, v146
  v_dot2c_f32_bf16 v224, v67, v147
  v_dot2c_f32_bf16 v225, v77, v147
  v_dot2c_f32_bf16 v226, v87, v147
  v_dot2c_f32_bf16 v227, v97, v147
  v_dot2c_f32_bf16 v224, v68, v148
  v_dot2c_f32_bf16 v225, v78, v148
  v_dot2c_f32_bf16 v226, v88, v148
  v_dot2c_f32_bf16 v227, v98, v148
  v_dot2c_f32_bf16 v224, v69, v149
  v_dot2c_f32_bf16 v225, v79, v149
  v_dot2c_f32_bf16 v226, v89, v149
  v_dot2c_f32_bf16 v227, v99, v149
  v_dot2c_f32_bf16 v224, v70, v150
  v_dot2c_f32_bf16 v225, v80, v150
  v_dot2c_f32_bf16 v226, v90, v150
  v_dot2c_f32_bf16 v227, v100, v150
  v_dot2c_f32_bf16 v224, v71, v151
  v_dot2c_f32_bf16 v225, v81, v151
  v_dot2c_f32_bf16 v226, v91, v151
  v_dot2c_f32_bf16 v227, v101, v151
  v_dot2c_f32_bf16 v224, v72, v152
  v_dot2c_f32_bf16 v225, v82, v152
  v_dot2c_f32_bf16 v226, v92, v152
  v_dot2c_f32_bf16 v227, v102, v152
  v_dot2c_f32_bf16 v224, v73, v153
  v_dot2c_f32_bf16 v225, v83, v153
  v_dot2c_f32_bf16 v226, v93, v153
  v_dot2c_f32_bf16 v227, v103, v153
  s_waitcnt lgkmcnt(0)
  v_dot2c_f32_bf16 v228, v104, v144
  v_dot2c_f32_bf16 v229, v114, v144
  v_dot2c_f32_bf16 v230, v124, v144
  v_dot2c_f32_bf16 v231, v134, v144
  v_dot2c_f32_bf16 v228, v105, v145
  v_dot2c_f32_bf16 v229, v115, v145
  v_dot2c_f32_bf16 v230, v125, v145
  v_dot2c_f32_bf16 v231, v135, v145
  v_dot2c_f32_bf16 v228, v106, v146
  v_dot2c_f32_bf16 v229, v116, v146
  v_dot2c_f32_bf16 v230, v126, v146
  v_dot2c_f32_bf16 v231, v136, v146
  v_dot2c_f32_bf16 v228, v107, v147
  v_dot2c_f32_bf16 v229, v117, v147
  v_dot2c_f32_bf16 v230, v127, v147
  v_dot2c_f32_bf16 v231, v137, v147
  v_dot2c_f32_bf16 v228, v108, v148
  v_dot2c_f32_bf16 v229, v118, v148
  v_dot2c_f32_bf16 v230, v128, v148
  v_dot2c_f32_bf16 v231, v138, v148
  v_dot2c_f32_bf16 v228, v109, v149
  v_dot2c_f32_bf16 v229, v119, v149
  v_dot2c_f32_bf16 v230, v129, v149
  v_dot2c_f32_bf16 v231, v139, v149
  v_dot2c_f32_bf16 v228, v110, v150
  v_dot2c_f32_bf16 v229, v120, v150
  v_dot2c_f32_bf16 v230, v130, v150
  v_dot2c_f32_bf16 v231, v140, v150
  v_dot2c_f32_bf16 v228, v111, v151
  v_dot2c_f32_bf16 v229, v121, v151
  v_dot2c_f32_bf16 v230, v131, v151
  v_dot2c_f32_bf16 v231, v141, v151
  v_dot2c_f32_bf16 v228, v112, v152
  v_dot2c_f32_bf16 v229, v122, v152
  v_dot2c_f32_bf16 v230, v132, v152
  v_dot2c_f32_bf16 v231, v142, v152
  v_dot2c_f32_bf16 v228, v113, v153
  v_dot2c_f32_bf16 v229, v123, v153
  v_dot2c_f32_bf16 v230, v133, v153
  v_dot2c_f32_bf16 v231, v143, v153
  ds_read_b64 v[64:65], v38 offset:2008
  ds_read_b64 v[66:67], v38 offset:2016
  ds_read_b64 v[68:69], v38 offset:2024
  ds_read_b64 v[70:71], v38 offset:2032
  ds_read_b64 v[72:73], v39 offset:2040
  ds_read_b64 v[74:75], v38 offset:1744
  ds_read_b64 v[76:77], v38 offset:1752
  ds_read_b64 v[78:79], v38 offset:1760
  ds_read_b64 v[80:81], v38 offset:1768
  ds_read_b64 v[82:83], v39 offset:1776
  ds_read_b64 v[84:85], v38 offset:1480
  ds_read_b64 v[86:87], v38 offset:1488
  ds_read_b64 v[88:89], v38 offset:1496
  ds_read_b64 v[90:91], v38 offset:1504
  ds_read_b64 v[92:93], v39 offset:1512
  ds_read_b64 v[94:95], v38 offset:1216
  ds_read_b64 v[96:97], v38 offset:1224
  ds_read_b64 v[98:99], v38 offset:1232
  ds_read_b64 v[100:101], v38 offset:1240
  ds_read_b64 v[102:103], v39 offset:1248
  ds_read_b64 v[104:105], v38 offset:952
  ds_read_b64 v[106:107], v38 offset:960
  ds_read_b64 v[108:109], v38 offset:968
  ds_read_b64 v[110:111], v38 offset:976
  ds_read_b64 v[112:113], v39 offset:984
  ds_read_b64 v[114:115], v38 offset:688
  ds_read_b64 v[116:117], v38 offset:696
  ds_read_b64 v[118:119], v38 offset:704
  ds_read_b64 v[120:121], v38 offset:712
  ds_read_b64 v[122:123], v39 offset:720
  ds_read_b64 v[124:125], v38 offset:424
  ds_read_b64 v[126:127], v38 offset:432
  ds_read_b64 v[128:129], v38 offset:440
  ds_read_b64 v[130:131], v38 offset:448
  ds_read_b64 v[132:133], v39 offset:456
  ds_read_b64 v[134:135], v38 offset:160
  ds_read_b64 v[136:137], v38 offset:168
  ds_read_b64 v[138:139], v38 offset:176
  ds_read_b64 v[140:141], v38 offset:184
  ds_read_b64 v[142:143], v39 offset:192
  v_cvt_pk_bf16_f32 v4, v224, v225
  v_lshlrev_b32 v224, 16, v4
  v_and_b32 v225, 0xffff0000, v4
  v_mul_f32 v224, s60, v224
  v_mul_f32 v225, s60, v225
  v_cvt_pk_bf16_f32 v4, v224, v225
  v_lshlrev_b32 v224, 16, v4
  v_and_b32 v225, 0xffff0000, v4
  v_cndmask_b32 v224, v37, v224, s[76:77]
  v_cndmask_b32 v225, v37, v225, s[78:79]
  v_cvt_pk_bf16_f32 v4, v226, v227
  v_lshlrev_b32 v226, 16, v4
  v_and_b32 v227, 0xffff0000, v4
  v_mul_f32 v226, s60, v226
  v_mul_f32 v227, s60, v227
  v_cvt_pk_bf16_f32 v4, v226, v227
  v_lshlrev_b32 v226, 16, v4
  v_and_b32 v227, 0xffff0000, v4
  v_cndmask_b32 v226, v37, v226, s[80:81]
  v_cndmask_b32 v227, v37, v227, s[82:83]
  v_cvt_pk_bf16_f32 v4, v228, v229
  v_lshlrev_b32 v228, 16, v4
  v_and_b32 v229, 0xffff0000, v4
  v_mul_f32 v228, s60, v228
  v_mul_f32 v229, s60, v229
  v_cvt_pk_bf16_f32 v4, v228, v229
  v_lshlrev_b32 v228, 16, v4
  v_and_b32 v229, 0xffff0000, v4
  v_cndmask_b32 v228, v37, v228, s[84:85]
  v_cndmask_b32 v229, v37, v229, s[86:87]
  v_cvt_pk_bf16_f32 v4, v230, v231
  v_lshlrev_b32 v230, 16, v4
  v_and_b32 v231, 0xffff0000, v4
  v_mul_f32 v230, s60, v230
  v_mul_f32 v231, s60, v231
  v_cvt_pk_bf16_f32 v4, v230, v231
  v_lshlrev_b32 v230, 16, v4
  v_and_b32 v231, 0xffff0000, v4
  v_cndmask_b32 v230, v37, v230, s[88:89]
  v_cndmask_b32 v231, v37, v231, s[90:91]
  v_max3_f32 v5, v224, v225, v226
  v_max3_f32 v5, v5, v227, v228
  v_max3_f32 v5, v5, v229, v230
  v_max_f32 v5, v5, v231
  v_sub_f32 v224, v224, v5
  v_mul_f32 v224, s61, v224
  v_exp_f32 v224, v224
  v_sub_f32 v225, v225, v5
  v_mul_f32 v225, s61, v225
  v_exp_f32 v225, v225
  v_sub_f32 v226, v226, v5
  v_mul_f32 v226, s61, v226
  v_exp_f32 v226, v226
  v_sub_f32 v227, v227, v5
  v_mul_f32 v227, s61, v227
  v_exp_f32 v227, v227
  v_sub_f32 v228, v228, v5
  v_mul_f32 v228, s61, v228
  v_exp_f32 v228, v228
  v_sub_f32 v229, v229, v5
  v_mul_f32 v229, s61, v229
  v_exp_f32 v229, v229
  v_sub_f32 v230, v230, v5
  v_mul_f32 v230, s61, v230
  v_exp_f32 v230, v230
  v_sub_f32 v231, v231, v5
  v_mul_f32 v231, s61, v231
  v_exp_f32 v231, v231
  s_nop 0
  v_add_f32 v5, v224, v225
  v_add_f32 v5, v5, v226
  v_add_f32 v5, v5, v227
  v_add_f32 v5, v5, v228
  v_add_f32 v5, v5, v229
  v_add_f32 v5, v5, v230
  v_add_f32 v5, v5, v231
  v_rcp_f32 v5, v5
  s_nop 0
  v_mul_f32 v224, v224, v5
  v_mul_f32 v225, v225, v5
  v_mul_f32 v226, v226, v5
  v_mul_f32 v227, v227, v5
  v_mul_f32 v228, v228, v5
  v_mul_f32 v229, v229, v5
  v_mul_f32 v230, v230, v5
  v_mul_f32 v231, v231, v5
  v_cvt_pk_bf16_f32 v232, v224, v225
  v_cvt_pk_bf16_f32 v233, v226, v227
  v_cvt_pk_bf16_f32 v234, v228, v229
  v_cvt_pk_bf16_f32 v235, v230, v231
  s_waitcnt lgkmcnt(15)
  v_perm_b32 v144, v74, v64, s62
  v_perm_b32 v145, v74, v64, s63
  v_perm_b32 v146, v75, v65, s62
  v_perm_b32 v147, v75, v65, s63
  v_perm_b32 v148, v76, v66, s62
  v_perm_b32 v149, v76, v66, s63
  v_perm_b32 v150, v77, v67, s62
  v_perm_b32 v151, v77, v67, s63
  v_perm_b32 v152, v78, v68, s62
  v_perm_b32 v153, v78, v68, s63
  v_perm_b32 v154, v79, v69, s62
  v_perm_b32 v155, v79, v69, s63
  v_perm_b32 v156, v80, v70, s62
  v_perm_b32 v157, v80, v70, s63
  v_perm_b32 v158, v81, v71, s62
  v_perm_b32 v159, v81, v71, s63
  v_perm_b32 v212, v82, v72, s62
  v_perm_b32 v213, v82, v72, s63
  v_perm_b32 v214, v83, v73, s62
  v_perm_b32 v215, v83, v73, s63
  v_dot2_f32_bf16 v192, v144, v232, 0
  v_dot2_f32_bf16 v193, v145, v232, 0
  v_dot2_f32_bf16 v194, v146, v232, 0
  v_dot2_f32_bf16 v195, v147, v232, 0
  v_dot2_f32_bf16 v196, v148, v232, 0
  v_dot2_f32_bf16 v197, v149, v232, 0
  v_dot2_f32_bf16 v198, v150, v232, 0
  v_dot2_f32_bf16 v199, v151, v232, 0
  v_dot2_f32_bf16 v200, v152, v232, 0
  v_dot2_f32_bf16 v201, v153, v232, 0
  v_dot2_f32_bf16 v202, v154, v232, 0
  v_dot2_f32_bf16 v203, v155, v232, 0
  v_dot2_f32_bf16 v204, v156, v232, 0
  v_dot2_f32_bf16 v205, v157, v232, 0
  v_dot2_f32_bf16 v206, v158, v232, 0
  v_dot2_f32_bf16 v207, v159, v232, 0
  v_dot2_f32_bf16 v208, v212, v232, 0
  v_dot2_f32_bf16 v209, v213, v232, 0
  v_dot2_f32_bf16 v210, v214, v232, 0
  v_dot2_f32_bf16 v211, v215, v232, 0
  s_waitcnt lgkmcnt(15)
  v_perm_b32 v144, v94, v84, s62
  v_perm_b32 v145, v94, v84, s63
  v_perm_b32 v146, v95, v85, s62
  v_perm_b32 v147, v95, v85, s63
  v_perm_b32 v148, v96, v86, s62
  v_perm_b32 v149, v96, v86, s63
  v_perm_b32 v150, v97, v87, s62
  v_perm_b32 v151, v97, v87, s63
  v_perm_b32 v152, v98, v88, s62
  v_perm_b32 v153, v98, v88, s63
  v_perm_b32 v154, v99, v89, s62
  v_perm_b32 v155, v99, v89, s63
  v_perm_b32 v156, v100, v90, s62
  v_perm_b32 v157, v100, v90, s63
  v_perm_b32 v158, v101, v91, s62
  v_perm_b32 v159, v101, v91, s63
  v_perm_b32 v212, v102, v92, s62
  v_perm_b32 v213, v102, v92, s63
  v_perm_b32 v214, v103, v93, s62
  v_perm_b32 v215, v103, v93, s63
  v_dot2c_f32_bf16 v192, v144, v233
  v_dot2c_f32_bf16 v193, v145, v233
  v_dot2c_f32_bf16 v194, v146, v233
  v_dot2c_f32_bf16 v195, v147, v233
  v_dot2c_f32_bf16 v196, v148, v233
  v_dot2c_f32_bf16 v197, v149, v233
  v_dot2c_f32_bf16 v198, v150, v233
  v_dot2c_f32_bf16 v199, v151, v233
  v_dot2c_f32_bf16 v200, v152, v233
  v_dot2c_f32_bf16 v201, v153, v233
  v_dot2c_f32_bf16 v202, v154, v233
  v_dot2c_f32_bf16 v203, v155, v233
  v_dot2c_f32_bf16 v204, v156, v233
  v_dot2c_f32_bf16 v205, v157, v233
  v_dot2c_f32_bf16 v206, v158, v233
  v_dot2c_f32_bf16 v207, v159, v233
  v_dot2c_f32_bf16 v208, v212, v233
  v_dot2c_f32_bf16 v209, v213, v233
  v_dot2c_f32_bf16 v210, v214, v233
  v_dot2c_f32_bf16 v211, v215, v233
  s_waitcnt lgkmcnt(10)
  v_perm_b32 v144, v114, v104, s62
  v_perm_b32 v145, v114, v104, s63
  v_perm_b32 v146, v115, v105, s62
  v_perm_b32 v147, v115, v105, s63
  v_perm_b32 v148, v116, v106, s62
  v_perm_b32 v149, v116, v106, s63
  v_perm_b32 v150, v117, v107, s62
  v_perm_b32 v151, v117, v107, s63
  v_perm_b32 v152, v118, v108, s62
  v_perm_b32 v153, v118, v108, s63
  v_perm_b32 v154, v119, v109, s62
  v_perm_b32 v155, v119, v109, s63
  v_perm_b32 v156, v120, v110, s62
  v_perm_b32 v157, v120, v110, s63
  v_perm_b32 v158, v121, v111, s62
  v_perm_b32 v159, v121, v111, s63
  v_perm_b32 v212, v122, v112, s62
  v_perm_b32 v213, v122, v112, s63
  v_perm_b32 v214, v123, v113, s62
  v_perm_b32 v215, v123, v113, s63
  v_dot2c_f32_bf16 v192, v144, v234
  v_dot2c_f32_bf16 v193, v145, v234
  v_dot2c_f32_bf16 v194, v146, v234
  v_dot2c_f32_bf16 v195, v147, v234
  v_dot2c_f32_bf16 v196, v148, v234
  v_dot2c_f32_bf16 v197, v149, v234
  v_dot2c_f32_bf16 v198, v150, v234
  v_dot2c_f32_bf16 v199, v151, v234
  v_dot2c_f32_bf16 v200, v152, v234
  v_dot2c_f32_bf16 v201, v153, v234
  v_dot2c_f32_bf16 v202, v154, v234
  v_dot2c_f32_bf16 v203, v155, v234
  v_dot2c_f32_bf16 v204, v156, v234
  v_dot2c_f32_bf16 v205, v157, v234
  v_dot2c_f32_bf16 v206, v158, v234
  v_dot2c_f32_bf16 v207, v159, v234
  v_dot2c_f32_bf16 v208, v212, v234
  v_dot2c_f32_bf16 v209, v213, v234
  v_dot2c_f32_bf16 v210, v214, v234
  v_dot2c_f32_bf16 v211, v215, v234
  s_waitcnt lgkmcnt(0)
  v_perm_b32 v144, v134, v124, s62
  v_perm_b32 v145, v134, v124, s63
  v_perm_b32 v146, v135, v125, s62
  v_perm_b32 v147, v135, v125, s63
  v_perm_b32 v148, v136, v126, s62
  v_perm_b32 v149, v136, v126, s63
  v_perm_b32 v150, v137, v127, s62
  v_perm_b32 v151, v137, v127, s63
  v_perm_b32 v152, v138, v128, s62
  v_perm_b32 v153, v138, v128, s63
  v_perm_b32 v154, v139, v129, s62
  v_perm_b32 v155, v139, v129, s63
  v_perm_b32 v156, v140, v130, s62
  v_perm_b32 v157, v140, v130, s63
  v_perm_b32 v158, v141, v131, s62
  v_perm_b32 v159, v141, v131, s63
  v_perm_b32 v212, v142, v132, s62
  v_perm_b32 v213, v142, v132, s63
  v_perm_b32 v214, v143, v133, s62
  v_perm_b32 v215, v143, v133, s63
  v_dot2c_f32_bf16 v192, v144, v235
  v_dot2c_f32_bf16 v193, v145, v235
  v_dot2c_f32_bf16 v194, v146, v235
  v_dot2c_f32_bf16 v195, v147, v235
  v_dot2c_f32_bf16 v196, v148, v235
  v_dot2c_f32_bf16 v197, v149, v235
  v_dot2c_f32_bf16 v198, v150, v235
  v_dot2c_f32_bf16 v199, v151, v235
  v_dot2c_f32_bf16 v200, v152, v235
  v_dot2c_f32_bf16 v201, v153, v235
  v_dot2c_f32_bf16 v202, v154, v235
  v_dot2c_f32_bf16 v203, v155, v235
  v_dot2c_f32_bf16 v204, v156, v235
  v_dot2c_f32_bf16 v205, v157, v235
  v_dot2c_f32_bf16 v206, v158, v235
  v_dot2c_f32_bf16 v207, v159, v235
  v_dot2c_f32_bf16 v208, v212, v235
  v_dot2c_f32_bf16 v209, v213, v235
  v_dot2c_f32_bf16 v210, v214, v235
  v_dot2c_f32_bf16 v211, v215, v235
  s_cmp_lg_u32 s20, 0
  s_cbranch_scc1 bh_241
  ds_read_b64 v[64:65], v35 offset:33792
  ds_read_b64 v[66:67], v35 offset:34304
  ds_read_b64 v[68:69], v35 offset:34816
  ds_read_b64 v[70:71], v35 offset:35328
  ds_read_b64 v[72:73], v35 offset:35840
  s_waitcnt lgkmcnt(0)
  ds_write_b64 v35, v[64:65] offset:0
  ds_write_b64 v35, v[66:67] offset:512
  ds_write_b64 v35, v[68:69] offset:1024
  ds_write_b64 v35, v[70:71] offset:1536
  ds_write_b64 v35, v[72:73] offset:2048
bh_241:
  s_nop 1
  v_cvt_pk_bf16_f32 v244, v192, v193
  v_cvt_pk_bf16_f32 v245, v194, v195
  v_cvt_pk_bf16_f32 v246, v196, v197
  v_cvt_pk_bf16_f32 v247, v198, v199
  v_cvt_pk_bf16_f32 v248, v200, v201
  v_cvt_pk_bf16_f32 v249, v202, v203
  v_cvt_pk_bf16_f32 v250, v204, v205
  v_cvt_pk_bf16_f32 v251, v206, v207
  v_cvt_pk_bf16_f32 v252, v208, v209
  v_cvt_pk_bf16_f32 v253, v210, v211
  buffer_store_dwordx4 v[244:247], v29, s[16:19], s27 offen sc1
  buffer_store_dwordx4 v[248:251], v30, s[16:19], s27 offen sc1
  buffer_store_dwordx2 v[252:253], v31, s[16:19], s27 offen sc1
  s_add_u32 s27, s27, 2048
  s_mov_b64 s[78:79], -1
  s_mov_b64 s[80:81], -1
  s_mov_b64 s[82:83], -1
  s_mov_b64 s[84:85], -1
  s_mov_b64 s[86:87], -1
  s_mov_b64 s[88:89], -1
  s_mov_b64 s[90:91], -1
  s_sub_u32 s26, s26, 1
  s_cmp_gt_u32 s26, 0
  s_waitcnt lgkmcnt(0)
  s_cbranch_scc1 bf_blk_238
  s_waitcnt vmcnt(0) lgkmcnt(0)
  s_barrier
  s_mov_b32 s84, 0
  s_mov_b32 s85, -1
  s_load_dwordx2 s[4:5], s[0:1], 0
  s_load_dwordx2 s[6:7], s[0:1], 16
  s_load_dwordx2 s[38:39], s[0:1], 104
  s_mov_b32 s42, s2
  s_mov_b32 s41, 0
  s_waitcnt lgkmcnt(0)
  s_mov_b32 s8, s4
  s_mov_b32 s9, s5
  s_mov_b32 s10, 2621440
  s_mov_b32 s11, 0x00020000
  s_mov_b32 s12, s6
  s_mov_b32 s13, s7
  s_mov_b32 s14, 7864320
  s_mov_b32 s15, 0x00020000
  s_mov_b32 s16, s38
  s_mov_b32 s17, s39
  s_mov_b32 s18, 50331648
  s_mov_b32 s19, 0x00020000
  s_add_u32 s52, s38, 50331648
  s_addc_u32 s53, s39, 0
  s_mov_b32 s54, 6291456
  s_mov_b32 s55, 0x00020000
  s_add_u32 s56, s38, 85983232
  s_addc_u32 s57, s39, 0
  s_mov_b32 s58, 6815744
  s_mov_b32 s59, 0x00020000
  s_load_dwordx2 s[72:73], s[0:1], 104
  s_waitcnt lgkmcnt(0)
  s_add_u32 s72, s72, 81068032
  s_addc_u32 s73, s73, 0
  s_mov_b32 s74, 116736
  s_mov_b32 s75, 0x00020000
  s_mul_i32 s44, s42, 384
  s_mov_b32 s24, 0
  v_mov_b32 v9, 2731
  s_and_b32 s22, s20, 1
  s_lshl_b32 s22, s22, 2
  v_add_u32 v8, 0, v1
  v_mul_u32_u24 v7, v8, v9
  v_lshrrev_b32 v7, 16, v7
  v_mul_u32_u24 v4, 24, v7
  v_sub_u32 v8, v8, v4
  v_and_b32 v4, 2, v7
  v_xor_b32 v8, v8, v4
  v_xor_b32 v8, s22, v8
  v_xor_b32 v5, 4, v8
  s_mov_b32 s21, 12288
  v_mul_lo_u32 v7, v7, s21
  v_lshl_add_u32 v40, v8, 4, v7
  v_lshl_add_u32 v43, v5, 4, v7
  v_add_u32 v8, 64, v1
  v_mul_u32_u24 v7, v8, v9
  v_lshrrev_b32 v7, 16, v7
  v_mul_u32_u24 v4, 24, v7
  v_sub_u32 v8, v8, v4
  v_and_b32 v4, 2, v7
  v_xor_b32 v8, v8, v4
  v_xor_b32 v8, s22, v8
  v_xor_b32 v5, 4, v8
  s_mov_b32 s21, 12288
  v_mul_lo_u32 v7, v7, s21
  v_lshl_add_u32 v41, v8, 4, v7
  v_lshl_add_u32 v44, v5, 4, v7
  v_add_u32 v8, 128, v1
  v_mul_u32_u24 v7, v8, v9
  v_lshrrev_b32 v7, 16, v7
  v_mul_u32_u24 v4, 24, v7
  v_sub_u32 v8, v8, v4
  v_and_b32 v4, 2, v7
  v_xor_b32 v8, v8, v4
  v_xor_b32 v8, s22, v8
  v_xor_b32 v5, 4, v8
  s_mov_b32 s21, 12288
  v_mul_lo_u32 v7, v7, s21
  v_lshl_add_u32 v42, v8, 4, v7
  v_lshl_add_u32 v45, v5, 4, v7
  s_mul_i32 s23, s20, 491520
  s_add_u32 s23, s23, s44
  s_mul_i32 s22, s20, 15360
  s_add_u32 s22, s22, 98304
  s_add_u32 s21, s23, 0
  s_add_u32 m0, s22, 0
  s_nop 0
  buffer_load_dwordx4 v40, s[12:15], s21 offen lds
  s_add_u32 m0, s22, 1024
  s_nop 0
  buffer_load_dwordx4 v41, s[12:15], s21 offen lds
  s_add_u32 m0, s22, 2048
  s_nop 0
  buffer_load_dwordx4 v42, s[12:15], s21 offen lds
  s_add_u32 s21, s23, 98304
  s_add_u32 m0, s22, 3072
  s_nop 0
  buffer_load_dwordx4 v43, s[12:15], s21 offen lds
  s_add_u32 m0, s22, 4096
  s_nop 0
  buffer_load_dwordx4 v44, s[12:15], s21 offen lds
  s_add_u32 m0, s22, 5120
  s_nop 0
  buffer_load_dwordx4 v45, s[12:15], s21 offen lds
  s_add_u32 s21, s23, 196608
  s_add_u32 m0, s22, 6144
  s_nop 0
  buffer_load_dwordx4 v40, s[12:15], s21 offen lds
  s_add_u32 m0, s22, 7168
  s_nop 0
  buffer_load_dwordx4 v41, s[12:15], s21 offen lds
  s_add_u32 m0, s22, 8192
  s_nop 0
  buffer_load_dwordx4 v42, s[12:15], s21 offen lds
  s_add_u32 s21, s23, 294912
  s_add_u32 m0, s22, 9216
  s_nop 0
  buffer_load_dwordx4 v43, s[12:15], s21 offen lds
  s_add_u32 m0, s22, 10240
  s_nop 0
  buffer_load_dwordx4 v44, s[12:15], s21 offen lds
  s_add_u32 m0, s22, 11264
  s_nop 0
  buffer_load_dwordx4 v45, s[12:15], s21 offen lds
  s_add_u32 s21, s23, 393216
  s_add_u32 m0, s22, 12288
  s_nop 0
  buffer_load_dwordx4 v40, s[12:15], s21 offen lds
  s_add_u32 m0, s22, 13312
  s_nop 0
  buffer_load_dwordx4 v41, s[12:15], s21 offen lds
  s_add_u32 m0, s22, 14336
  s_nop 0
  buffer_load_dwordx4 v42, s[12:15], s21 offen lds
  s_add_u32 s21, s23, 1966080
  buffer_load_dwordx4 v[64:67], v40, s[12:15], s21 offen
  buffer_load_dwordx4 v[68:71], v41, s[12:15], s21 offen
  buffer_load_dwordx4 v[72:75], v42, s[12:15], s21 offen
  s_add_u32 s21, s23, 2064384
  buffer_load_dwordx4 v[76:79], v43, s[12:15], s21 offen
  buffer_load_dwordx4 v[80:83], v44, s[12:15], s21 offen
  buffer_load_dwordx4 v[84:87], v45, s[12:15], s21 offen
  s_add_u32 s21, s23, 2162688
  buffer_load_dwordx4 v[88:91], v40, s[12:15], s21 offen
  buffer_load_dwordx4 v[92:95], v41, s[12:15], s21 offen
  buffer_load_dwordx4 v[96:99], v42, s[12:15], s21 offen
  s_add_u32 s21, s23, 2260992
  buffer_load_dwordx4 v[100:103], v43, s[12:15], s21 offen
  buffer_load_dwordx4 v[104:107], v44, s[12:15], s21 offen
  buffer_load_dwordx4 v[108:111], v45, s[12:15], s21 offen
  s_add_u32 s21, s23, 2359296
  buffer_load_dwordx4 v[112:115], v40, s[12:15], s21 offen
  buffer_load_dwordx4 v[116:119], v41, s[12:15], s21 offen
  buffer_load_dwordx4 v[120:123], v42, s[12:15], s21 offen
  s_add_u32 s21, s23, 3932160
  buffer_load_dwordx4 v[124:127], v40, s[12:15], s21 offen
  buffer_load_dwordx4 v[128:131], v41, s[12:15], s21 offen
  buffer_load_dwordx4 v[132:135], v42, s[12:15], s21 offen
  s_add_u32 s21, s23, 4030464
  buffer_load_dwordx4 v[136:139], v43, s[12:15], s21 offen
  buffer_load_dwordx4 v[140:143], v44, s[12:15], s21 offen
  buffer_load_dwordx4 v[144:147], v45, s[12:15], s21 offen
  s_add_u32 s21, s23, 4128768
  buffer_load_dwordx4 v[148:151], v40, s[12:15], s21 offen
  buffer_load_dwordx4 v[152:155], v41, s[12:15], s21 offen
  buffer_load_dwordx4 v[156:159], v42, s[12:15], s21 offen
  s_add_u32 s21, s23, 4227072
  buffer_load_dwordx4 v[160:163], v43, s[12:15], s21 offen
  buffer_load_dwordx4 v[164:167], v44, s[12:15], s21 offen
  buffer_load_dwordx4 v[168:171], v45, s[12:15], s21 offen
  s_add_u32 s21, s23, 4325376
  buffer_load_dwordx4 v[172:175], v40, s[12:15], s21 offen
  buffer_load_dwordx4 v[176:179], v41, s[12:15], s21 offen
  buffer_load_dwordx4 v[180:183], v42, s[12:15], s21 offen
  s_add_u32 s21, s23, 5898240
  buffer_load_dwordx4 v[184:187], v40, s[12:15], s21 offen
  buffer_load_dwordx4 v[188:191], v41, s[12:15], s21 offen
  buffer_load_dwordx4 v[192:195], v42, s[12:15], s21 offen
  s_add_u32 s21, s23, 5996544
  buffer_load_dwordx4 v[196:199], v43, s[12:15], s21 offen
  buffer_load_dwordx4 v[200:203], v44, s[12:15], s21 offen
  buffer_load_dwordx4 v[204:207], v45, s[12:15], s21 offen
  s_add_u32 s21, s23, 6094848
  buffer_load_dwordx4 v[208:211], v40, s[12:15], s21 offen
  buffer_load_dwordx4 v[212:215], v41, s[12:15], s21 offen
  buffer_load_dwordx4 v[216:219], v42, s[12:15], s21 offen
  s_add_u32 s21, s23, 6193152
  buffer_load_dwordx4 v[220:223], v43, s[12:15], s21 offen
  buffer_load_dwordx4 v[224:227], v44, s[12:15], s21 offen
  buffer_load_dwordx4 v[228:231], v45, s[12:15], s21 offen
  s_add_u32 s21, s23, 6291456
  buffer_load_dwordx4 v[232:235], v40, s[12:15], s21 offen
  buffer_load_dwordx4 v[236:239], v41, s[12:15], s21 offen
  buffer_load_dwordx4 v[240:243], v42, s[12:15], s21 offen
  v_lshl_add_u32 v49, v1, 4, s22
  v_lshrrev_b32 v7, 2, v2
  v_and_b32 v4, 2, v7
  v_and_b32 v5, 1, v3
  v_lshl_or_b32 v4, v5, 2, v4
  v_lshl_add_u32 v7, v3, 3, v7
  v_mul_u32_u24 v7, 384, v7
  v_and_b32 v5, 1, v2
  v_lshl_add_u32 v7, v5, 3, v7
  v_add_u32 v7, 98304, v7
  v_bfe_u32 v8, v2, 1, 1
  s_mul_i32 s21, s20, 6
  v_add_u32 v8, s21, v8
  v_add_u32 v5, 0, v8
  v_xor_b32 v5, v5, v4
  v_lshl_add_u32 v46, v5, 4, v7
  v_add_u32 v5, 2, v8
  v_xor_b32 v5, v5, v4
  v_lshl_add_u32 v47, v5, 4, v7
  v_add_u32 v5, 4, v8
  v_xor_b32 v5, v5, v4
  v_lshl_add_u32 v48, v5, 4, v7
  s_waitcnt vmcnt(45)
  s_barrier
  ds_read_b64_tr_b16 a[0:1], v46 offset:0
  ds_read_b64_tr_b16 a[2:3], v46 offset:1536
  ds_read_b64_tr_b16 a[4:5], v47 offset:0
  ds_read_b64_tr_b16 a[6:7], v47 offset:1536
  ds_read_b64_tr_b16 a[8:9], v48 offset:0
  ds_read_b64_tr_b16 a[10:11], v48 offset:1536
  ds_read_b64_tr_b16 a[12:13], v46 offset:12288
  ds_read_b64_tr_b16 a[14:15], v46 offset:13824
  ds_read_b64_tr_b16 a[16:17], v47 offset:12288
  ds_read_b64_tr_b16 a[18:19], v47 offset:13824
  ds_read_b64_tr_b16 a[20:21], v48 offset:12288
  ds_read_b64_tr_b16 a[22:23], v48 offset:13824
  ds_read_b64_tr_b16 a[24:25], v46 offset:24576
  ds_read_b64_tr_b16 a[26:27], v46 offset:26112
  ds_read_b64_tr_b16 a[28:29], v47 offset:24576
  ds_read_b64_tr_b16 a[30:31], v47 offset:26112
  ds_read_b64_tr_b16 a[32:33], v48 offset:24576
  ds_read_b64_tr_b16 a[34:35], v48 offset:26112
  ds_read_b64_tr_b16 a[36:37], v46 offset:36864
  ds_read_b64_tr_b16 a[38:39], v46 offset:38400
  ds_read_b64_tr_b16 a[40:41], v47 offset:36864
  ds_read_b64_tr_b16 a[42:43], v47 offset:38400
  ds_read_b64_tr_b16 a[44:45], v48 offset:36864
  ds_read_b64_tr_b16 a[46:47], v48 offset:38400
  ds_read_b64_tr_b16 a[48:49], v46 offset:49152
  ds_read_b64_tr_b16 a[50:51], v46 offset:50688
  ds_read_b64_tr_b16 a[52:53], v47 offset:49152
  ds_read_b64_tr_b16 a[54:55], v47 offset:50688
  ds_read_b64_tr_b16 a[56:57], v48 offset:49152
  ds_read_b64_tr_b16 a[58:59], v48 offset:50688
  v_lshrrev_b32 v11, 3, v1
  v_and_b32 v12, 7, v1
  v_xor_b32 v12, v12, v11
  v_mul_u32_u24 v11, 1280, v11
  v_lshl_add_u32 v10, v12, 4, v11
  s_mul_i32 s46, s20, 40960
  v_add_u32 v10, s46, v10
  s_lshl_b32 s47, s20, 12
  s_add_u32 s47, s47, 0
  s_add_u32 s46, s47, 98304
  s_mov_b32 s30, s24
  s_add_u32 s32, s47, 0
  v_add_u32 v11, 9216, v10
  v_add_u32 v12, 18432, v10
  v_add_u32 v13, 27648, v10
  s_mov_b32 m0, s32
  s_nop 0
  buffer_load_dwordx4 v10, s[8:11], s30 offen offset:0 lds
  buffer_load_dwordx4 v11, s[8:11], s30 offen offset:1024 lds
  buffer_load_dwordx4 v12, s[8:11], s30 offen offset:2048 lds
  buffer_load_dwordx4 v13, s[8:11], s30 offen offset:3072 lds
  s_add_u32 s30, s30, 128
  s_add_u32 s32, s32, 16384
  s_cmp_lt_u32 s32, s46
  s_cselect_b32 s32, s32, s47
  s_mov_b32 m0, s32
  s_nop 0
  buffer_load_dwordx4 v10, s[8:11], s30 offen offset:0 lds
  buffer_load_dwordx4 v11, s[8:11], s30 offen offset:1024 lds
  buffer_load_dwordx4 v12, s[8:11], s30 offen offset:2048 lds
  buffer_load_dwordx4 v13, s[8:11], s30 offen offset:3072 lds
  s_add_u32 s30, s30, 128
  s_add_u32 s32, s32, 16384
  s_cmp_lt_u32 s32, s46
  s_cselect_b32 s32, s32, s47
  s_mov_b32 m0, s32
  s_nop 0
  buffer_load_dwordx4 v10, s[8:11], s30 offen offset:0 lds
  buffer_load_dwordx4 v11, s[8:11], s30 offen offset:1024 lds
  buffer_load_dwordx4 v12, s[8:11], s30 offen offset:2048 lds
  buffer_load_dwordx4 v13, s[8:11], s30 offen offset:3072 lds
  s_add_u32 s30, s30, 128
  s_add_u32 s32, s32, 16384
  s_cmp_lt_u32 s32, s46
  s_cselect_b32 s32, s32, s47
  s_mov_b32 m0, s32
  s_nop 0
  buffer_load_dwordx4 v10, s[8:11], s30 offen offset:0 lds
  buffer_load_dwordx4 v11, s[8:11], s30 offen offset:1024 lds
  buffer_load_dwordx4 v12, s[8:11], s30 offen offset:2048 lds
  buffer_load_dwordx4 v13, s[8:11], s30 offen offset:3072 lds
  s_add_u32 s30, s30, 128
  s_add_u32 s32, s32, 16384
  s_cmp_lt_u32 s32, s46
  s_cselect_b32 s32, s32, s47
  s_waitcnt lgkmcnt(0)
  s_barrier
  s_waitcnt vmcnt(46)
  ds_write_b128 v49, v[64:67] offset:0
  ds_write_b128 v49, v[68:71] offset:1024
  ds_write_b128 v49, v[72:75] offset:2048
  ds_write_b128 v49, v[76:79] offset:3072
  ds_write_b128 v49, v[80:83] offset:4096
  ds_write_b128 v49, v[84:87] offset:5120
  ds_write_b128 v49, v[88:91] offset:6144
  ds_write_b128 v49, v[92:95] offset:7168
  ds_write_b128 v49, v[96:99] offset:8192
  ds_write_b128 v49, v[100:103] offset:9216
  ds_write_b128 v49, v[104:107] offset:10240
  ds_write_b128 v49, v[108:111] offset:11264
  ds_write_b128 v49, v[112:115] offset:12288
  ds_write_b128 v49, v[116:119] offset:13312
  ds_write_b128 v49, v[120:123] offset:14336
  s_waitcnt lgkmcnt(0)
  s_barrier
  ds_read_b64_tr_b16 a[60:61], v46 offset:0
  ds_read_b64_tr_b16 a[62:63], v46 offset:1536
  ds_read_b64_tr_b16 a[64:65], v47 offset:0
  ds_read_b64_tr_b16 a[66:67], v47 offset:1536
  ds_read_b64_tr_b16 a[68:69], v48 offset:0
  ds_read_b64_tr_b16 a[70:71], v48 offset:1536
  ds_read_b64_tr_b16 a[72:73], v46 offset:12288
  ds_read_b64_tr_b16 a[74:75], v46 offset:13824
  ds_read_b64_tr_b16 a[76:77], v47 offset:12288
  ds_read_b64_tr_b16 a[78:79], v47 offset:13824
  ds_read_b64_tr_b16 a[80:81], v48 offset:12288
  ds_read_b64_tr_b16 a[82:83], v48 offset:13824
  ds_read_b64_tr_b16 a[84:85], v46 offset:24576
  ds_read_b64_tr_b16 a[86:87], v46 offset:26112
  ds_read_b64_tr_b16 a[88:89], v47 offset:24576
  ds_read_b64_tr_b16 a[90:91], v47 offset:26112
  ds_read_b64_tr_b16 a[92:93], v48 offset:24576
  ds_read_b64_tr_b16 a[94:95], v48 offset:26112
  ds_read_b64_tr_b16 a[96:97], v46 offset:36864
  ds_read_b64_tr_b16 a[98:99], v46 offset:38400
  ds_read_b64_tr_b16 a[100:101], v47 offset:36864
  ds_read_b64_tr_b16 a[102:103], v47 offset:38400
  ds_read_b64_tr_b16 a[104:105], v48 offset:36864
  ds_read_b64_tr_b16 a[106:107], v48 offset:38400
  ds_read_b64_tr_b16 a[108:109], v46 offset:49152
  ds_read_b64_tr_b16 a[110:111], v46 offset:50688
  ds_read_b64_tr_b16 a[112:113], v47 offset:49152
  ds_read_b64_tr_b16 a[114:115], v47 offset:50688
  ds_read_b64_tr_b16 a[116:117], v48 offset:49152
  ds_read_b64_tr_b16 a[118:119], v48 offset:50688
  s_waitcnt lgkmcnt(0)
  s_barrier
  s_waitcnt vmcnt(31)
  ds_write_b128 v49, v[124:127] offset:0
  ds_write_b128 v49, v[128:131] offset:1024
  ds_write_b128 v49, v[132:135] offset:2048
  ds_write_b128 v49, v[136:139] offset:3072
  ds_write_b128 v49, v[140:143] offset:4096
  ds_write_b128 v49, v[144:147] offset:5120
  ds_write_b128 v49, v[148:151] offset:6144
  ds_write_b128 v49, v[152:155] offset:7168
  ds_write_b128 v49, v[156:159] offset:8192
  ds_write_b128 v49, v[160:163] offset:9216
  ds_write_b128 v49, v[164:167] offset:10240
  ds_write_b128 v49, v[168:171] offset:11264
  ds_write_b128 v49, v[172:175] offset:12288
  ds_write_b128 v49, v[176:179] offset:13312
  ds_write_b128 v49, v[180:183] offset:14336
  s_waitcnt lgkmcnt(0)
  s_barrier
  ds_read_b64_tr_b16 a[120:121], v46 offset:0
  ds_read_b64_tr_b16 a[122:123], v46 offset:1536
  ds_read_b64_tr_b16 a[124:125], v47 offset:0
  ds_read_b64_tr_b16 a[126:127], v47 offset:1536
  ds_read_b64_tr_b16 a[128:129], v48 offset:0
  ds_read_b64_tr_b16 a[130:131], v48 offset:1536
  ds_read_b64_tr_b16 a[132:133], v46 offset:12288
  ds_read_b64_tr_b16 a[134:135], v46 offset:13824
  ds_read_b64_tr_b16 a[136:137], v47 offset:12288
  ds_read_b64_tr_b16 a[138:139], v47 offset:13824
  ds_read_b64_tr_b16 a[140:141], v48 offset:12288
  ds_read_b64_tr_b16 a[142:143], v48 offset:13824
  ds_read_b64_tr_b16 a[144:145], v46 offset:24576
  ds_read_b64_tr_b16 a[146:147], v46 offset:26112
  ds_read_b64_tr_b16 a[148:149], v47 offset:24576
  ds_read_b64_tr_b16 a[150:151], v47 offset:26112
  ds_read_b64_tr_b16 a[152:153], v48 offset:24576
  ds_read_b64_tr_b16 a[154:155], v48 offset:26112
  ds_read_b64_tr_b16 a[156:157], v46 offset:36864
  ds_read_b64_tr_b16 a[158:159], v46 offset:38400
  ds_read_b64_tr_b16 a[160:161], v47 offset:36864
  ds_read_b64_tr_b16 a[162:163], v47 offset:38400
  ds_read_b64_tr_b16 a[164:165], v48 offset:36864
  ds_read_b64_tr_b16 a[166:167], v48 offset:38400
  ds_read_b64_tr_b16 a[168:169], v46 offset:49152
  ds_read_b64_tr_b16 a[170:171], v46 offset:50688
  ds_read_b64_tr_b16 a[172:173], v47 offset:49152
  ds_read_b64_tr_b16 a[174:175], v47 offset:50688
  ds_read_b64_tr_b16 a[176:177], v48 offset:49152
  ds_read_b64_tr_b16 a[178:179], v48 offset:50688
  s_waitcnt lgkmcnt(0)
  s_barrier
  s_waitcnt vmcnt(16)
  ds_write_b128 v49, v[184:187] offset:0
  ds_write_b128 v49, v[188:191] offset:1024
  ds_write_b128 v49, v[192:195] offset:2048
  ds_write_b128 v49, v[196:199] offset:3072
  ds_write_b128 v49, v[200:203] offset:4096
  ds_write_b128 v49, v[204:207] offset:5120
  ds_write_b128 v49, v[208:211] offset:6144
  ds_write_b128 v49, v[212:215] offset:7168
  ds_write_b128 v49, v[216:219] offset:8192
  ds_write_b128 v49, v[220:223] offset:9216
  ds_write_b128 v49, v[224:227] offset:10240
  ds_write_b128 v49, v[228:231] offset:11264
  ds_write_b128 v49, v[232:235] offset:12288
  ds_write_b128 v49, v[236:239] offset:13312
  ds_write_b128 v49, v[240:243] offset:14336
  s_waitcnt lgkmcnt(0)
  s_barrier
  ds_read_b64_tr_b16 a[180:181], v46 offset:0
  ds_read_b64_tr_b16 a[182:183], v46 offset:1536
  ds_read_b64_tr_b16 a[184:185], v47 offset:0
  ds_read_b64_tr_b16 a[186:187], v47 offset:1536
  ds_read_b64_tr_b16 a[188:189], v48 offset:0
  ds_read_b64_tr_b16 a[190:191], v48 offset:1536
  ds_read_b64_tr_b16 a[192:193], v46 offset:12288
  ds_read_b64_tr_b16 a[194:195], v46 offset:13824
  ds_read_b64_tr_b16 a[196:197], v47 offset:12288
  ds_read_b64_tr_b16 a[198:199], v47 offset:13824
  ds_read_b64_tr_b16 a[200:201], v48 offset:12288
  ds_read_b64_tr_b16 a[202:203], v48 offset:13824
  ds_read_b64_tr_b16 a[204:205], v46 offset:24576
  ds_read_b64_tr_b16 a[206:207], v46 offset:26112
  ds_read_b64_tr_b16 a[208:209], v47 offset:24576
  ds_read_b64_tr_b16 a[210:211], v47 offset:26112
  ds_read_b64_tr_b16 a[212:213], v48 offset:24576
  ds_read_b64_tr_b16 a[214:215], v48 offset:26112
  ds_read_b64_tr_b16 a[216:217], v46 offset:36864
  ds_read_b64_tr_b16 a[218:219], v46 offset:38400
  ds_read_b64_tr_b16 a[220:221], v47 offset:36864
  ds_read_b64_tr_b16 a[222:223], v47 offset:38400
  ds_read_b64_tr_b16 a[224:225], v48 offset:36864
  ds_read_b64_tr_b16 a[226:227], v48 offset:38400
  ds_read_b64_tr_b16 a[228:229], v46 offset:49152
  ds_read_b64_tr_b16 a[230:231], v46 offset:50688
  ds_read_b64_tr_b16 a[232:233], v47 offset:49152
  ds_read_b64_tr_b16 a[234:235], v47 offset:50688
  ds_read_b64_tr_b16 a[236:237], v48 offset:49152
  ds_read_b64_tr_b16 a[238:239], v48 offset:50688
  s_waitcnt lgkmcnt(0)
  s_barrier
  v_readfirstlane_b32 s21, v32
  s_cmp_ge_u32 s21, 32
  s_cbranch_scc1 bt_242
  s_mov_b32 s21, 76
  v_mov_b32 v4, 0
  s_mov_b32 s101, 0
wf_243:
  buffer_load_dword v5, v4, s[64:67], s21 offen sc1
  s_add_u32 s101, s101, 1
  s_cmp_gt_u32 s101, 131072
  s_cbranch_scc1 main_end
  s_waitcnt vmcnt(0)
  v_readfirstlane_b32 s100, v5
  s_cmp_ge_u32 s100, 32
  s_cbranch_scc1 wf_244
  s_sleep 8
  s_branch wf_243
wf_244:
bt_242:
  s_mov_b32 s21, 91136
  s_cmp_lg_u32 s20, 0
  s_cbranch_scc1 af_245
  v_mov_b32 v4, 0
  v_mov_b32 v5, 1
  s_mov_b64 exec, 1
  buffer_atomic_add v5, v4, s[72:75], s21 offen sc1
  s_mov_b64 exec, -1
  s_nop 1
af_245:
  s_mul_i32 s21, s20, 12800
  s_add_u32 s21, s21, 98304
  v_mul_u32_u24 v4, 400, v2
  v_lshlrev_b32 v5, 4, v3
  v_add3_u32 v29, v4, v5, s21
  v_lshlrev_b32 v30, 4, v1
  v_and_b32 v4, 1, v2
  v_bfe_u32 v5, v2, 1, 1
  v_lshl_or_b32 v4, v5, 2, v4
  v_bfe_u32 v5, v2, 2, 1
  v_lshl_or_b32 v4, v5, 1, v4
  v_lshlrev_b32 v4, 4, v4
  v_lshl_add_u32 v31, v3, 7, v4
  v_lshlrev_b32 v32, 3, v1
  v_and_b32 v4, 3, v1
  v_lshlrev_b32 v33, 3, v4
  v_mov_b32 v34, 0xf149f2ca
  v_lshlrev_b32 v4, 2, v3
  v_sub_u32 v35, v2, v4
  v_cmp_gt_u32 s[60:61], 2, v3
  s_mov_b32 s62, 0x3d93cd3a
  s_mov_b32 s63, 0x3fb8aa3b
  s_mov_b32 s83, 0x3dd53b95
  v_cmp_le_i32 s[64:65], 0, v35
  v_cmp_le_i32 s[66:67], 1, v35
  v_cmp_le_i32 s[68:69], 2, v35
  v_cmp_le_i32 s[70:71], 3, v35
  s_mov_b32 s24, 0
  s_mov_b32 s25, 163840
  s_mov_b32 s26, 13
  s_lshl_b32 s49, s41, 2
  s_add_u32 s49, s49, s20
  s_mov_b32 s29, 4
  s_mov_b32 s78, 0
  s_mov_b32 s81, 0x80000000
  s_mov_b32 s82, 0
  s_mul_i32 s21, s49, 393216
  s_mul_i32 s22, s42, 12288
  s_add_u32 s50, s21, s22
  s_mul_i32 s21, s49, 98304
  s_mul_i32 s22, s42, 3072
  s_add_u32 s51, s21, s22
  s_lshr_b32 s22, s49, 1
  s_lshr_b32 s21, s49, 2
  s_add_u32 s21, s21, 3
  s_cmp_lt_u32 s49, 12
  s_cselect_b32 s21, s22, s21
  s_lshl_b32 s21, s21, 3
  s_lshr_b32 s22, s42, 2
  s_add_u32 s21, s21, s22
  s_lshl_b32 s21, s21, 7
  s_add_u32 s76, s21, 0
  s_lshl_b32 s77, s42, 7
  s_add_u32 s77, s77, 19456
  v_mov_b32 v21, 0
  buffer_load_dword v21, v33, s[72:75], s77 offen sc1
  v_and_b32 v6, 7, v2
  v_add_u32 v4, 0, v3
  v_xor_b32 v4, v4, v6
  v_lshlrev_b32 v4, 4, v4
  v_lshl_add_u32 v14, v2, 7, v4
  v_add_u32 v4, 4, v3
  v_xor_b32 v4, v4, v6
  v_lshlrev_b32 v4, 4, v4
  v_lshl_add_u32 v15, v2, 7, v4
  v_mul_u32_u24 v22, 400, v2
  v_mul_u32_u24 v4, 16, v3
  s_mul_i32 s21, s20, 96
  s_add_u32 s21, s21, 98304
  v_add3_u32 v22, v22, v4, s21
  v_lshlrev_b32 v4, 3, v3
  v_sub_u32 v16, v22, v4
  v_mov_b32 v9, 2731
  s_mov_b32 s33, 0
  s_mov_b32 s48, 0x80000000
  s_mov_b32 m0, s32
  s_nop 0
  buffer_load_dwordx4 v10, s[8:11], s30 offen offset:0 lds
  buffer_load_dwordx4 v11, s[8:11], s30 offen offset:1024 lds
  s_waitcnt vmcnt(14)
  s_barrier
  v_add_u32 v18, s33, v14
  v_add_u32 v19, s33, v15
  s_add_u32 s33, s33, 16384
  s_cmp_lt_u32 s33, 98304
  s_cselect_b32 s33, s33, 0
  ds_read_b128 v[160:163], v18 offset:0
  ds_read_b128 v[164:167], v18 offset:2048
  ds_read_b128 v[168:171], v18 offset:4096
  ds_read_b128 v[172:175], v18 offset:6144
  ds_read_b128 v[176:179], v18 offset:8192
  ds_read_b128 v[180:183], v18 offset:10240
  ds_read_b128 v[184:187], v18 offset:12288
  ds_read_b128 v[188:191], v18 offset:14336
  s_waitcnt lgkmcnt(0)
qa_blk_247:
  v_mfma_f32_16x16x32_bf16 v[64:67], a[0:3], v[160:163], 0
  ds_read_b128 v[192:195], v19 offset:0
  v_mfma_f32_16x16x32_bf16 v[68:71], a[4:7], v[160:163], 0
  v_add_u32 v18, s33, v14
  v_cndmask_b32 v36, v34, v36, s[64:65]
  v_mfma_f32_16x16x32_bf16 v[72:75], a[8:11], v[160:163], 0
  v_cndmask_b32 v48, v34, v48, s[64:65]
  v_cndmask_b32 v37, v34, v37, s[66:67]
  v_mfma_f32_16x16x32_bf16 v[76:79], a[0:3], v[164:167], 0
  ds_read_b128 v[196:199], v19 offset:2048
  v_cndmask_b32 v49, v34, v49, s[66:67]
  v_mfma_f32_16x16x32_bf16 v[80:83], a[4:7], v[164:167], 0
  buffer_load_dwordx4 v12, s[8:11], s30 offen offset:2048 lds
  v_mfma_f32_16x16x32_bf16 v[84:87], a[8:11], v[164:167], 0
  v_cndmask_b32 v38, v34, v38, s[68:69]
  v_cndmask_b32 v50, v34, v50, s[68:69]
  v_mfma_f32_16x16x32_bf16 v[88:91], a[0:3], v[168:171], 0
  ds_read_b128 v[200:203], v19 offset:4096
  v_cndmask_b32 v39, v34, v39, s[70:71]
  v_mfma_f32_16x16x32_bf16 v[92:95], a[4:7], v[168:171], 0
  v_cndmask_b32 v51, v34, v51, s[70:71]
  v_max3_f32 v56, v36, v37, v38
  v_mfma_f32_16x16x32_bf16 v[96:99], a[8:11], v[168:171], 0
  v_max3_f32 v56, v56, v39, v40
  v_max3_f32 v56, v56, v41, v42
  v_mfma_f32_16x16x32_bf16 v[100:103], a[0:3], v[172:175], 0
  ds_read_b128 v[204:207], v19 offset:6144
  v_max_f32 v56, v56, v43
  v_mfma_f32_16x16x32_bf16 v[104:107], a[4:7], v[172:175], 0
  v_mov_b32 v57, v56
  v_mfma_f32_16x16x32_bf16 v[108:111], a[8:11], v[172:175], 0
  s_waitcnt lgkmcnt(15)
  v_mfma_f32_16x16x32_bf16 v[112:115], a[0:3], v[176:179], 0
  ds_read_b128 v[208:211], v19 offset:8192
  v_mfma_f32_16x16x32_bf16 v[116:119], a[4:7], v[176:179], 0
  s_nop 1
  v_mfma_f32_16x16x32_bf16 v[120:123], a[8:11], v[176:179], 0
  v_permlane32_swap_b32 v56, v57
  v_mfma_f32_16x16x32_bf16 v[124:127], a[0:3], v[180:183], 0
  ds_read_b128 v[212:215], v19 offset:10240
  v_max_f32 v56, v56, v57
  v_mfma_f32_16x16x32_bf16 v[128:131], a[4:7], v[180:183], 0
  buffer_load_dwordx4 v13, s[8:11], s30 offen offset:3072 lds
  v_mfma_f32_16x16x32_bf16 v[132:135], a[8:11], v[180:183], 0
  s_add_u32 s30, s30, 128
  s_add_u32 m0, m0, 16384
  v_mfma_f32_16x16x32_bf16 v[136:139], a[0:3], v[184:187], 0
  ds_read_b128 v[216:219], v19 offset:12288
  v_mov_b32 v57, v56
  v_mfma_f32_16x16x32_bf16 v[140:143], a[4:7], v[184:187], 0
  s_cmp_lt_u32 m0, s46
  s_cselect_b32 m0, m0, s47
  v_mfma_f32_16x16x32_bf16 v[144:147], a[8:11], v[184:187], 0
  s_nop 1
  v_mfma_f32_16x16x32_bf16 v[148:151], a[0:3], v[188:191], 0
  ds_read_b128 v[220:223], v19 offset:14336
  v_mfma_f32_16x16x32_bf16 v[152:155], a[4:7], v[188:191], 0
  v_permlane16_swap_b32 v56, v57
  v_mfma_f32_16x16x32_bf16 v[156:159], a[8:11], v[188:191], 0
  s_waitcnt vmcnt(12) lgkmcnt(4)
  s_barrier
  v_mfma_f32_16x16x32_bf16 v[64:67], a[12:15], v[192:195], v[64:67]
  ds_read_b128 v[160:163], v18 offset:0
  v_max_f32 v56, v56, v57
  v_mfma_f32_16x16x32_bf16 v[68:71], a[16:19], v[192:195], v[68:71]
  v_mul_f32 v56, s83, v56
  v_fma_f32 v36, v36, s83, -v56
  v_mfma_f32_16x16x32_bf16 v[72:75], a[20:23], v[192:195], v[72:75]
  v_add_u32 v19, s33, v15
  s_add_u32 s33, s33, 16384
  v_mfma_f32_16x16x32_bf16 v[76:79], a[12:15], v[196:199], v[76:79]
  ds_read_b128 v[164:167], v18 offset:2048
  s_mul_i32 s21, s49, 393216
  v_mfma_f32_16x16x32_bf16 v[80:83], a[16:19], v[196:199], v[80:83]
  buffer_load_dwordx4 v10, s[8:11], s30 offen offset:0 lds
  v_mfma_f32_16x16x32_bf16 v[84:87], a[20:23], v[196:199], v[84:87]
  s_cmp_lt_u32 s33, 98304
  s_cselect_b32 s33, s33, 0
  v_mfma_f32_16x16x32_bf16 v[88:91], a[12:15], v[200:203], v[88:91]
  ds_read_b128 v[168:171], v18 offset:4096
  s_mul_i32 s22, s42, 12288
  v_mfma_f32_16x16x32_bf16 v[92:95], a[16:19], v[200:203], v[92:95]
  s_add_u32 s50, s21, s22
  s_lshr_b32 s51, s50, 2
  v_mfma_f32_16x16x32_bf16 v[96:99], a[20:23], v[200:203], v[96:99]
  s_add_u32 s23, s49, 1
  v_cmp_gt_u32 vcc, s23, v21
  v_mfma_f32_16x16x32_bf16 v[100:103], a[12:15], v[204:207], v[100:103]
  ds_read_b128 v[172:175], v18 offset:6144
  v_fma_f32 v37, v37, s83, -v56
  v_mfma_f32_16x16x32_bf16 v[104:107], a[16:19], v[204:207], v[104:107]
  s_cmp_eq_u64 vcc, 0
  s_cselect_b32 s80, 1, 0
  v_mfma_f32_16x16x32_bf16 v[108:111], a[20:23], v[204:207], v[108:111]
  s_waitcnt lgkmcnt(4)
  s_lshl_b32 s79, s80, 3
  v_mfma_f32_16x16x32_bf16 v[112:115], a[12:15], v[208:211], v[112:115]
  ds_read_b128 v[176:179], v18 offset:8192
  v_fma_f32 v38, v38, s83, -v56
  v_mfma_f32_16x16x32_bf16 v[116:119], a[16:19], v[208:211], v[116:119]
  buffer_load_dwordx4 a[240:243], v31, s[52:55], s51 offen offset:0 sc1
  v_mfma_f32_16x16x32_bf16 v[120:123], a[20:23], v[208:211], v[120:123]
  v_fma_f32 v39, v39, s83, -v56
  v_fma_f32 v40, v40, s83, -v56
  v_mfma_f32_16x16x32_bf16 v[124:127], a[12:15], v[212:215], v[124:127]
  ds_read_b128 v[180:183], v18 offset:10240
  v_fma_f32 v41, v41, s83, -v56
  v_mfma_f32_16x16x32_bf16 v[128:131], a[16:19], v[212:215], v[128:131]
  buffer_load_dwordx4 v11, s[8:11], s30 offen offset:1024 lds
  v_mfma_f32_16x16x32_bf16 v[132:135], a[20:23], v[212:215], v[132:135]
  v_fma_f32 v42, v42, s83, -v56
  v_fma_f32 v43, v43, s83, -v56
  v_mfma_f32_16x16x32_bf16 v[136:139], a[12:15], v[216:219], v[136:139]
  ds_read_b128 v[184:187], v18 offset:12288
  v_mfma_f32_16x16x32_bf16 v[140:143], a[16:19], v[216:219], v[140:143]
  v_exp_f32 v36, v36
  v_mfma_f32_16x16x32_bf16 v[144:147], a[20:23], v[216:219], v[144:147]
  v_exp_f32 v37, v37
  v_mfma_f32_16x16x32_bf16 v[148:151], a[12:15], v[220:223], v[148:151]
  ds_read_b128 v[188:191], v18 offset:14336
  v_mfma_f32_16x16x32_bf16 v[152:155], a[16:19], v[220:223], v[152:155]
  v_exp_f32 v38, v38
  v_mfma_f32_16x16x32_bf16 v[156:159], a[20:23], v[220:223], v[156:159]
  s_waitcnt lgkmcnt(4)
  v_mfma_f32_16x16x32_bf16 v[64:67], a[24:27], v[160:163], v[64:67]
  ds_read_b128 v[192:195], v19 offset:0
  v_mfma_f32_16x16x32_bf16 v[68:71], a[28:31], v[160:163], v[68:71]
  v_add_u32 v18, s33, v14
  v_mfma_f32_16x16x32_bf16 v[72:75], a[32:35], v[160:163], v[72:75]
  v_exp_f32 v39, v39
  v_mfma_f32_16x16x32_bf16 v[76:79], a[24:27], v[164:167], v[76:79]
  ds_read_b128 v[196:199], v19 offset:2048
  v_mfma_f32_16x16x32_bf16 v[80:83], a[28:31], v[164:167], v[80:83]
  buffer_load_dwordx4 v12, s[8:11], s30 offen offset:2048 lds
  v_mfma_f32_16x16x32_bf16 v[84:87], a[32:35], v[164:167], v[84:87]
  v_exp_f32 v40, v40
  v_mfma_f32_16x16x32_bf16 v[88:91], a[24:27], v[168:171], v[88:91]
  ds_read_b128 v[200:203], v19 offset:4096
  v_mfma_f32_16x16x32_bf16 v[92:95], a[28:31], v[168:171], v[92:95]
  v_exp_f32 v41, v41
  v_mfma_f32_16x16x32_bf16 v[96:99], a[32:35], v[168:171], v[96:99]
  v_exp_f32 v42, v42
  v_mfma_f32_16x16x32_bf16 v[100:103], a[24:27], v[172:175], v[100:103]
  ds_read_b128 v[204:207], v19 offset:6144
  v_mfma_f32_16x16x32_bf16 v[104:107], a[28:31], v[172:175], v[104:107]
  buffer_load_dwordx4 a[244:247], v31, s[52:55], s51 offen offset:512 sc1
  v_mfma_f32_16x16x32_bf16 v[108:111], a[32:35], v[172:175], v[108:111]
  s_waitcnt lgkmcnt(4)
  v_mfma_f32_16x16x32_bf16 v[112:115], a[24:27], v[176:179], v[112:115]
  ds_read_b128 v[208:211], v19 offset:8192
  v_mfma_f32_16x16x32_bf16 v[116:119], a[28:31], v[176:179], v[116:119]
  v_exp_f32 v43, v43
  v_mfma_f32_16x16x32_bf16 v[120:123], a[32:35], v[176:179], v[120:123]
  s_nop 0
  v_add_f32 v56, v40, v41
  v_mfma_f32_16x16x32_bf16 v[124:127], a[24:27], v[180:183], v[124:127]
  ds_read_b128 v[212:215], v19 offset:10240
  v_add_f32 v56, v56, v42
  v_mfma_f32_16x16x32_bf16 v[128:131], a[28:31], v[180:183], v[128:131]
  buffer_load_dwordx4 v13, s[8:11], s30 offen offset:3072 lds
  v_mfma_f32_16x16x32_bf16 v[132:135], a[32:35], v[180:183], v[132:135]
  s_add_u32 s30, s30, 128
  s_add_u32 m0, m0, 16384
  v_mfma_f32_16x16x32_bf16 v[136:139], a[24:27], v[184:187], v[136:139]
  ds_read_b128 v[216:219], v19 offset:12288
  v_add_f32 v56, v56, v43
  v_mfma_f32_16x16x32_bf16 v[140:143], a[28:31], v[184:187], v[140:143]
  s_cmp_lt_u32 m0, s46
  s_cselect_b32 m0, m0, s47
  v_mfma_f32_16x16x32_bf16 v[144:147], a[32:35], v[184:187], v[144:147]
  v_cndmask_b32 v56, 0, v56, s[60:61]
  v_add_f32 v56, v56, v36
  v_mfma_f32_16x16x32_bf16 v[148:151], a[24:27], v[188:191], v[148:151]
  ds_read_b128 v[220:223], v19 offset:14336
  v_add_f32 v56, v56, v37
  v_mfma_f32_16x16x32_bf16 v[152:155], a[28:31], v[188:191], v[152:155]
  v_add_f32 v56, v56, v38
  v_add_f32 v56, v56, v39
  v_mfma_f32_16x16x32_bf16 v[156:159], a[32:35], v[188:191], v[156:159]
  s_waitcnt vmcnt(14) lgkmcnt(4)
  s_barrier
  v_mfma_f32_16x16x32_bf16 v[64:67], a[36:39], v[192:195], v[64:67]
  ds_read_b128 v[160:163], v18 offset:0
  v_mov_b32 v57, v56
  v_mfma_f32_16x16x32_bf16 v[68:71], a[40:43], v[192:195], v[68:71]
  s_nop 1
  v_mfma_f32_16x16x32_bf16 v[72:75], a[44:47], v[192:195], v[72:75]
  v_add_u32 v19, s33, v15
  s_add_u32 s33, s33, 16384
  v_mfma_f32_16x16x32_bf16 v[76:79], a[36:39], v[196:199], v[76:79]
  ds_read_b128 v[164:167], v18 offset:2048
  v_mfma_f32_16x16x32_bf16 v[80:83], a[40:43], v[196:199], v[80:83]
  buffer_load_dwordx4 v10, s[8:11], s30 offen offset:0 lds
  v_mfma_f32_16x16x32_bf16 v[84:87], a[44:47], v[196:199], v[84:87]
  s_cmp_lt_u32 s33, 98304
  s_cselect_b32 s33, s33, 0
  v_mfma_f32_16x16x32_bf16 v[88:91], a[36:39], v[200:203], v[88:91]
  ds_read_b128 v[168:171], v18 offset:4096
  v_mfma_f32_16x16x32_bf16 v[92:95], a[40:43], v[200:203], v[92:95]
  buffer_load_dwordx4 a[248:251], v31, s[52:55], s51 offen offset:1024 sc1
  v_mfma_f32_16x16x32_bf16 v[96:99], a[44:47], v[200:203], v[96:99]
  v_permlane32_swap_b32 v56, v57
  v_mfma_f32_16x16x32_bf16 v[100:103], a[36:39], v[204:207], v[100:103]
  ds_read_b128 v[172:175], v18 offset:6144
  v_add_f32 v56, v56, v57
  v_mfma_f32_16x16x32_bf16 v[104:107], a[40:43], v[204:207], v[104:107]
  v_mov_b32 v57, v56
  v_mfma_f32_16x16x32_bf16 v[108:111], a[44:47], v[204:207], v[108:111]
  s_waitcnt lgkmcnt(4)
  v_mfma_f32_16x16x32_bf16 v[112:115], a[36:39], v[208:211], v[112:115]
  ds_read_b128 v[176:179], v18 offset:8192
  v_mfma_f32_16x16x32_bf16 v[116:119], a[40:43], v[208:211], v[116:119]
  s_nop 1
  v_mfma_f32_16x16x32_bf16 v[120:123], a[44:47], v[208:211], v[120:123]
  v_permlane16_swap_b32 v56, v57
  v_mfma_f32_16x16x32_bf16 v[124:127], a[36:39], v[212:215], v[124:127]
  ds_read_b128 v[180:183], v18 offset:10240
  v_add_f32 v56, v56, v57
  v_mfma_f32_16x16x32_bf16 v[128:131], a[40:43], v[212:215], v[128:131]
  buffer_load_dwordx4 v11, s[8:11], s30 offen offset:1024 lds
  v_mfma_f32_16x16x32_bf16 v[132:135], a[44:47], v[212:215], v[132:135]
  v_rcp_f32 v56, v56
  v_mfma_f32_16x16x32_bf16 v[136:139], a[36:39], v[216:219], v[136:139]
  ds_read_b128 v[184:187], v18 offset:12288
  s_nop 0
  v_mfma_f32_16x16x32_bf16 v[140:143], a[40:43], v[216:219], v[140:143]
  v_mul_f32 v36, v36, v56
  v_mul_f32 v37, v37, v56
  v_mfma_f32_16x16x32_bf16 v[144:147], a[44:47], v[216:219], v[144:147]
  v_mul_f32 v38, v38, v56
  v_mul_f32 v39, v39, v56
  v_mfma_f32_16x16x32_bf16 v[148:151], a[36:39], v[220:223], v[148:151]
  ds_read_b128 v[188:191], v18 offset:14336
  v_mul_f32 v40, v40, v56
  v_mfma_f32_16x16x32_bf16 v[152:155], a[40:43], v[220:223], v[152:155]
  v_mul_f32 v41, v41, v56
  v_mul_f32 v42, v42, v56
  v_mfma_f32_16x16x32_bf16 v[156:159], a[44:47], v[220:223], v[156:159]
  s_waitcnt lgkmcnt(4)
  v_mul_f32 v43, v43, v56
  v_mfma_f32_16x16x32_bf16 v[64:67], a[48:51], v[160:163], v[64:67]
  ds_read_b128 v[192:195], v19 offset:0
  v_max3_f32 v56, v44, v45, v46
  v_mfma_f32_16x16x32_bf16 v[68:71], a[52:55], v[160:163], v[68:71]
  v_add_u32 v18, s33, v14
  v_max3_f32 v56, v56, v47, v48
  v_mfma_f32_16x16x32_bf16 v[72:75], a[56:59], v[160:163], v[72:75]
  v_max3_f32 v56, v56, v49, v50
  v_max3_f32 v56, v56, v51, v52
  v_mfma_f32_16x16x32_bf16 v[76:79], a[48:51], v[164:167], v[76:79]
  ds_read_b128 v[196:199], v19 offset:2048
  v_max3_f32 v56, v56, v53, v54
  v_mfma_f32_16x16x32_bf16 v[80:83], a[52:55], v[164:167], v[80:83]
  buffer_load_dwordx4 v12, s[8:11], s30 offen offset:2048 lds
  v_mfma_f32_16x16x32_bf16 v[84:87], a[56:59], v[164:167], v[84:87]
  buffer_load_dwordx4 a[252:255], v31, s[52:55], s51 offen offset:1536 sc1
  v_mfma_f32_16x16x32_bf16 v[88:91], a[48:51], v[168:171], v[88:91]
  ds_read_b128 v[200:203], v19 offset:4096
  v_max_f32 v56, v56, v55
  v_mfma_f32_16x16x32_bf16 v[92:95], a[52:55], v[168:171], v[92:95]
  v_mov_b32 v57, v56
  v_mfma_f32_16x16x32_bf16 v[96:99], a[56:59], v[168:171], v[96:99]
  s_nop 1
  v_mfma_f32_16x16x32_bf16 v[100:103], a[48:51], v[172:175], v[100:103]
  ds_read_b128 v[204:207], v19 offset:6144
  v_mfma_f32_16x16x32_bf16 v[104:107], a[52:55], v[172:175], v[104:107]
  v_permlane32_swap_b32 v56, v57
  v_mfma_f32_16x16x32_bf16 v[108:111], a[56:59], v[172:175], v[108:111]
  s_waitcnt lgkmcnt(4)
  v_max_f32 v56, v56, v57
  v_mfma_f32_16x16x32_bf16 v[112:115], a[48:51], v[176:179], v[112:115]
  ds_read_b128 v[208:211], v19 offset:8192
  v_mov_b32 v57, v56
  v_mfma_f32_16x16x32_bf16 v[116:119], a[52:55], v[176:179], v[116:119]
  s_nop 1
  v_mfma_f32_16x16x32_bf16 v[120:123], a[56:59], v[176:179], v[120:123]
  v_permlane16_swap_b32 v56, v57
  v_mfma_f32_16x16x32_bf16 v[124:127], a[48:51], v[180:183], v[124:127]
  ds_read_b128 v[212:215], v19 offset:10240
  v_max_f32 v56, v56, v57
  v_mfma_f32_16x16x32_bf16 v[128:131], a[52:55], v[180:183], v[128:131]
  buffer_load_dwordx4 v13, s[8:11], s30 offen offset:3072 lds
  v_mfma_f32_16x16x32_bf16 v[132:135], a[56:59], v[180:183], v[132:135]
  s_add_u32 s30, s30, 128
  s_add_u32 m0, m0, 16384
  v_mfma_f32_16x16x32_bf16 v[136:139], a[48:51], v[184:187], v[136:139]
  ds_read_b128 v[216:219], v19 offset:12288
  v_mul_f32 v56, s83, v56
  v_mfma_f32_16x16x32_bf16 v[140:143], a[52:55], v[184:187], v[140:143]
  s_cmp_lt_u32 m0, s46
  s_cselect_b32 m0, m0, s47
  v_mfma_f32_16x16x32_bf16 v[144:147], a[56:59], v[184:187], v[144:147]
  v_fma_f32 v44, v44, s83, -v56
  v_fma_f32 v45, v45, s83, -v56
  v_mfma_f32_16x16x32_bf16 v[148:151], a[48:51], v[188:191], v[148:151]
  ds_read_b128 v[220:223], v19 offset:14336
  v_fma_f32 v46, v46, s83, -v56
  v_mfma_f32_16x16x32_bf16 v[152:155], a[52:55], v[188:191], v[152:155]
  v_fma_f32 v47, v47, s83, -v56
  v_fma_f32 v48, v48, s83, -v56
  v_mfma_f32_16x16x32_bf16 v[156:159], a[56:59], v[188:191], v[156:159]
  s_waitcnt vmcnt(16) lgkmcnt(4)
  s_barrier
  v_mfma_f32_16x16x32_bf16 v[64:67], a[60:63], v[192:195], v[64:67]
  ds_read_b128 v[160:163], v18 offset:0
  v_fma_f32 v49, v49, s83, -v56
  v_mfma_f32_16x16x32_bf16 v[68:71], a[64:67], v[192:195], v[68:71]
  buffer_load_dwordx4 v[24:27], v31, s[52:55], s51 offen offset:2048 sc1
  v_mfma_f32_16x16x32_bf16 v[72:75], a[68:71], v[192:195], v[72:75]
  v_add_u32 v19, s33, v15
  s_add_u32 s33, s33, 16384
  v_mfma_f32_16x16x32_bf16 v[76:79], a[60:63], v[196:199], v[76:79]
  ds_read_b128 v[164:167], v18 offset:2048
  v_fma_f32 v50, v50, s83, -v56
  v_mfma_f32_16x16x32_bf16 v[80:83], a[64:67], v[196:199], v[80:83]
  buffer_load_dwordx4 v10, s[8:11], s30 offen offset:0 lds
  v_mfma_f32_16x16x32_bf16 v[84:87], a[68:71], v[196:199], v[84:87]
  s_cmp_lt_u32 s33, 98304
  s_cselect_b32 s33, s33, 0
  v_mfma_f32_16x16x32_bf16 v[88:91], a[60:63], v[200:203], v[88:91]
  ds_read_b128 v[168:171], v18 offset:4096
  v_fma_f32 v51, v51, s83, -v56
  v_mfma_f32_16x16x32_bf16 v[92:95], a[64:67], v[200:203], v[92:95]
  v_fma_f32 v52, v52, s83, -v56
  v_fma_f32 v53, v53, s83, -v56
  v_mfma_f32_16x16x32_bf16 v[96:99], a[68:71], v[200:203], v[96:99]
  v_fma_f32 v54, v54, s83, -v56
  v_fma_f32 v55, v55, s83, -v56
  v_mfma_f32_16x16x32_bf16 v[100:103], a[60:63], v[204:207], v[100:103]
  ds_read_b128 v[172:175], v18 offset:6144
  v_mfma_f32_16x16x32_bf16 v[104:107], a[64:67], v[204:207], v[104:107]
  v_exp_f32 v44, v44
  v_mfma_f32_16x16x32_bf16 v[108:111], a[68:71], v[204:207], v[108:111]
  s_waitcnt lgkmcnt(4)
  v_mfma_f32_16x16x32_bf16 v[112:115], a[60:63], v[208:211], v[112:115]
  ds_read_b128 v[176:179], v18 offset:8192
  v_mfma_f32_16x16x32_bf16 v[116:119], a[64:67], v[208:211], v[116:119]
  v_exp_f32 v45, v45
  v_mfma_f32_16x16x32_bf16 v[120:123], a[68:71], v[208:211], v[120:123]
  v_exp_f32 v46, v46
  v_mfma_f32_16x16x32_bf16 v[124:127], a[60:63], v[212:215], v[124:127]
  ds_read_b128 v[180:183], v18 offset:10240
  v_mfma_f32_16x16x32_bf16 v[128:131], a[64:67], v[212:215], v[128:131]
  buffer_load_dwordx4 v11, s[8:11], s30 offen offset:1024 lds
  v_mfma_f32_16x16x32_bf16 v[132:135], a[68:71], v[212:215], v[132:135]
  v_exp_f32 v47, v47
  v_mfma_f32_16x16x32_bf16 v[136:139], a[60:63], v[216:219], v[136:139]
  ds_read_b128 v[184:187], v18 offset:12288
  v_mfma_f32_16x16x32_bf16 v[140:143], a[64:67], v[216:219], v[140:143]
  v_exp_f32 v48, v48
  v_mfma_f32_16x16x32_bf16 v[144:147], a[68:71], v[216:219], v[144:147]
  v_exp_f32 v49, v49
  v_mfma_f32_16x16x32_bf16 v[148:151], a[60:63], v[220:223], v[148:151]
  ds_read_b128 v[188:191], v18 offset:14336
  v_mfma_f32_16x16x32_bf16 v[152:155], a[64:67], v[220:223], v[152:155]
  buffer_load_dwordx4 v[6:9], v31, s[52:55], s51 offen offset:2560 sc1
  v_mfma_f32_16x16x32_bf16 v[156:159], a[68:71], v[220:223], v[156:159]
  s_waitcnt lgkmcnt(4)
  v_mfma_f32_16x16x32_bf16 v[64:67], a[72:75], v[160:163], v[64:67]
  ds_read_b128 v[192:195], v19 offset:0
  v_mfma_f32_16x16x32_bf16 v[68:71], a[76:79], v[160:163], v[68:71]
  v_add_u32 v18, s33, v14
  v_mfma_f32_16x16x32_bf16 v[72:75], a[80:83], v[160:163], v[72:75]
  v_exp_f32 v50, v50
  v_mfma_f32_16x16x32_bf16 v[76:79], a[72:75], v[164:167], v[76:79]
  ds_read_b128 v[196:199], v19 offset:2048
  v_mfma_f32_16x16x32_bf16 v[80:83], a[76:79], v[164:167], v[80:83]
  buffer_load_dwordx4 v12, s[8:11], s30 offen offset:2048 lds
  v_mfma_f32_16x16x32_bf16 v[84:87], a[80:83], v[164:167], v[84:87]
  v_exp_f32 v51, v51
  v_mfma_f32_16x16x32_bf16 v[88:91], a[72:75], v[168:171], v[88:91]
  ds_read_b128 v[200:203], v19 offset:4096
  v_mfma_f32_16x16x32_bf16 v[92:95], a[76:79], v[168:171], v[92:95]
  v_exp_f32 v52, v52
  v_mfma_f32_16x16x32_bf16 v[96:99], a[80:83], v[168:171], v[96:99]
  v_exp_f32 v53, v53
  v_mfma_f32_16x16x32_bf16 v[100:103], a[72:75], v[172:175], v[100:103]
  ds_read_b128 v[204:207], v19 offset:6144
  v_mfma_f32_16x16x32_bf16 v[104:107], a[76:79], v[172:175], v[104:107]
  v_exp_f32 v54, v54
  v_mfma_f32_16x16x32_bf16 v[108:111], a[80:83], v[172:175], v[108:111]
  s_waitcnt lgkmcnt(4)
  v_mfma_f32_16x16x32_bf16 v[112:115], a[72:75], v[176:179], v[112:115]
  ds_read_b128 v[208:211], v19 offset:8192
  v_mfma_f32_16x16x32_bf16 v[116:119], a[76:79], v[176:179], v[116:119]
  v_exp_f32 v55, v55
  v_mfma_f32_16x16x32_bf16 v[120:123], a[80:83], v[176:179], v[120:123]
  s_nop 0
  v_add_f32 v56, v52, v53
  v_mfma_f32_16x16x32_bf16 v[124:127], a[72:75], v[180:183], v[124:127]
  ds_read_b128 v[212:215], v19 offset:10240
  v_add_f32 v56, v56, v54
  v_mfma_f32_16x16x32_bf16 v[128:131], a[76:79], v[180:183], v[128:131]
  buffer_load_dwordx4 v13, s[8:11], s30 offen offset:3072 lds
  v_mfma_f32_16x16x32_bf16 v[132:135], a[80:83], v[180:183], v[132:135]
  s_add_u32 s30, s30, 128
  s_add_u32 m0, m0, 16384
  v_mfma_f32_16x16x32_bf16 v[136:139], a[72:75], v[184:187], v[136:139]
  ds_read_b128 v[216:219], v19 offset:12288
  s_add_u32 s21, s50, 4096
  v_mfma_f32_16x16x32_bf16 v[140:143], a[76:79], v[184:187], v[140:143]
  s_cmp_lt_u32 m0, s46
  s_cselect_b32 m0, m0, s47
  v_mfma_f32_16x16x32_bf16 v[144:147], a[80:83], v[184:187], v[144:147]
  buffer_load_dwordx4 v[60:63], v30, s[16:19], s21 offen offset:2048 sc1
  v_mfma_f32_16x16x32_bf16 v[148:151], a[72:75], v[188:191], v[148:151]
  ds_read_b128 v[220:223], v19 offset:14336
  v_add_f32 v56, v56, v55
  v_mfma_f32_16x16x32_bf16 v[152:155], a[76:79], v[188:191], v[152:155]
  v_cndmask_b32 v56, 0, v56, s[60:61]
  v_add_f32 v56, v56, v44
  v_mfma_f32_16x16x32_bf16 v[156:159], a[80:83], v[188:191], v[156:159]
  s_waitcnt vmcnt(19) lgkmcnt(4)
  s_barrier
  v_mfma_f32_16x16x32_bf16 v[64:67], a[84:87], v[192:195], v[64:67]
  ds_read_b128 v[160:163], v18 offset:0
  v_add_f32 v56, v56, v45
  v_mfma_f32_16x16x32_bf16 v[68:71], a[88:91], v[192:195], v[68:71]
  v_add_f32 v56, v56, v46
  v_add_f32 v56, v56, v47
  v_mfma_f32_16x16x32_bf16 v[72:75], a[92:95], v[192:195], v[72:75]
  v_add_u32 v19, s33, v15
  s_add_u32 s33, s33, 16384
  v_mfma_f32_16x16x32_bf16 v[76:79], a[84:87], v[196:199], v[76:79]
  ds_read_b128 v[164:167], v18 offset:2048
  v_add_f32 v56, v56, v48
  v_mfma_f32_16x16x32_bf16 v[80:83], a[88:91], v[196:199], v[80:83]
  buffer_load_dwordx4 v10, s[8:11], s30 offen offset:0 lds
  v_mfma_f32_16x16x32_bf16 v[84:87], a[92:95], v[196:199], v[84:87]
  s_cmp_lt_u32 s33, 98304
  s_cselect_b32 s33, s33, 0
  v_mfma_f32_16x16x32_bf16 v[88:91], a[84:87], v[200:203], v[88:91]
  ds_read_b128 v[168:171], v18 offset:4096
  v_add_f32 v56, v56, v49
  v_mfma_f32_16x16x32_bf16 v[92:95], a[88:91], v[200:203], v[92:95]
  v_add_f32 v56, v56, v50
  v_add_f32 v56, v56, v51
  v_mfma_f32_16x16x32_bf16 v[96:99], a[92:95], v[200:203], v[96:99]
  v_mov_b32 v57, v56
  v_mfma_f32_16x16x32_bf16 v[100:103], a[84:87], v[204:207], v[100:103]
  ds_read_b128 v[172:175], v18 offset:6144
  v_mfma_f32_16x16x32_bf16 v[104:107], a[88:91], v[204:207], v[104:107]
  s_nop 1
  v_mfma_f32_16x16x32_bf16 v[108:111], a[92:95], v[204:207], v[108:111]
  s_waitcnt lgkmcnt(4)
  v_mfma_f32_16x16x32_bf16 v[112:115], a[84:87], v[208:211], v[112:115]
  ds_read_b128 v[176:179], v18 offset:8192
  v_mfma_f32_16x16x32_bf16 v[116:119], a[88:91], v[208:211], v[116:119]
  v_permlane32_swap_b32 v56, v57
  v_mfma_f32_16x16x32_bf16 v[120:123], a[92:95], v[208:211], v[120:123]
  v_add_f32 v56, v56, v57
  v_mov_b32 v57, v56
  v_mfma_f32_16x16x32_bf16 v[124:127], a[84:87], v[212:215], v[124:127]
  ds_read_b128 v[180:183], v18 offset:10240
  v_mfma_f32_16x16x32_bf16 v[128:131], a[88:91], v[212:215], v[128:131]
  buffer_load_dwordx4 v11, s[8:11], s30 offen offset:1024 lds
  v_mfma_f32_16x16x32_bf16 v[132:135], a[92:95], v[212:215], v[132:135]
  s_add_u32 s21, s50, 8192
  v_mfma_f32_16x16x32_bf16 v[136:139], a[84:87], v[216:219], v[136:139]
  ds_read_b128 v[184:187], v18 offset:12288
  v_mfma_f32_16x16x32_bf16 v[140:143], a[88:91], v[216:219], v[140:143]
  buffer_load_dwordx4 v[248:251], v30, s[16:19], s21 offen offset:2048 sc1
  v_mfma_f32_16x16x32_bf16 v[144:147], a[92:95], v[216:219], v[144:147]
  s_nop 1
  v_mfma_f32_16x16x32_bf16 v[148:151], a[84:87], v[220:223], v[148:151]
  ds_read_b128 v[188:191], v18 offset:14336
  v_mfma_f32_16x16x32_bf16 v[152:155], a[88:91], v[220:223], v[152:155]
  v_permlane16_swap_b32 v56, v57
  v_mfma_f32_16x16x32_bf16 v[156:159], a[92:95], v[220:223], v[156:159]
  s_waitcnt lgkmcnt(4)
  v_add_f32 v56, v56, v57
  v_mfma_f32_16x16x32_bf16 v[64:67], a[96:99], v[160:163], v[64:67]
  ds_read_b128 v[192:195], v19 offset:0
  v_mfma_f32_16x16x32_bf16 v[68:71], a[100:103], v[160:163], v[68:71]
  v_add_u32 v18, s33, v14
  v_mfma_f32_16x16x32_bf16 v[72:75], a[104:107], v[160:163], v[72:75]
  v_rcp_f32 v56, v56
  v_mfma_f32_16x16x32_bf16 v[76:79], a[96:99], v[164:167], v[76:79]
  ds_read_b128 v[196:199], v19 offset:2048
  s_nop 0
  v_mfma_f32_16x16x32_bf16 v[80:83], a[100:103], v[164:167], v[80:83]
  buffer_load_dwordx4 v12, s[8:11], s30 offen offset:2048 lds
  v_mfma_f32_16x16x32_bf16 v[84:87], a[104:107], v[164:167], v[84:87]
  v_mul_f32 v44, v44, v56
  v_mul_f32 v45, v45, v56
  v_mfma_f32_16x16x32_bf16 v[88:91], a[96:99], v[168:171], v[88:91]
  ds_read_b128 v[200:203], v19 offset:4096
  v_mul_f32 v46, v46, v56
  v_mfma_f32_16x16x32_bf16 v[92:95], a[100:103], v[168:171], v[92:95]
  v_mul_f32 v47, v47, v56
  v_mul_f32 v48, v48, v56
  v_mfma_f32_16x16x32_bf16 v[96:99], a[104:107], v[168:171], v[96:99]
  v_mul_f32 v49, v49, v56
  v_mul_f32 v50, v50, v56
  v_mfma_f32_16x16x32_bf16 v[100:103], a[96:99], v[172:175], v[100:103]
  ds_read_b128 v[204:207], v19 offset:6144
  v_mul_f32 v51, v51, v56
  v_mfma_f32_16x16x32_bf16 v[104:107], a[100:103], v[172:175], v[104:107]
  v_mul_f32 v52, v52, v56
  v_mul_f32 v53, v53, v56
  v_mfma_f32_16x16x32_bf16 v[108:111], a[104:107], v[172:175], v[108:111]
  s_waitcnt lgkmcnt(4)
  v_mul_f32 v54, v54, v56
  v_mfma_f32_16x16x32_bf16 v[112:115], a[96:99], v[176:179], v[112:115]
  ds_read_b128 v[208:211], v19 offset:8192
  v_mul_f32 v55, v55, v56
  v_mfma_f32_16x16x32_bf16 v[116:119], a[100:103], v[176:179], v[116:119]
  v_cvt_pk_bf16_f32 v240, v40, v41
  v_cvt_pk_bf16_f32 v241, v42, v43
  v_mfma_f32_16x16x32_bf16 v[120:123], a[104:107], v[176:179], v[120:123]
  v_cvt_pk_bf16_f32 v242, v52, v53
  v_cvt_pk_bf16_f32 v243, v54, v55
  v_mfma_f32_16x16x32_bf16 v[124:127], a[96:99], v[180:183], v[124:127]
  ds_read_b128 v[212:215], v19 offset:10240
  s_add_u32 s21, s50, 8192
  v_mfma_f32_16x16x32_bf16 v[128:131], a[100:103], v[180:183], v[128:131]
  buffer_load_dwordx4 v13, s[8:11], s30 offen offset:3072 lds
  v_mfma_f32_16x16x32_bf16 v[132:135], a[104:107], v[180:183], v[132:135]
  s_add_u32 s30, s30, 128
  s_add_u32 m0, m0, 16384
  v_mfma_f32_16x16x32_bf16 v[136:139], a[96:99], v[184:187], v[136:139]
  ds_read_b128 v[216:219], v19 offset:12288
  v_cvt_pk_bf16_f32 v236, v44, v45
  v_mfma_f32_16x16x32_bf16 v[140:143], a[100:103], v[184:187], v[140:143]
  s_cmp_lt_u32 m0, s46
  s_cselect_b32 m0, m0, s47
  v_mfma_f32_16x16x32_bf16 v[144:147], a[104:107], v[184:187], v[144:147]
  buffer_load_dwordx4 v[252:255], v30, s[16:19], s21 offen offset:3072 sc1
  v_mfma_f32_16x16x32_bf16 v[148:151], a[96:99], v[188:191], v[148:151]
  ds_read_b128 v[220:223], v19 offset:14336
  v_cvt_pk_bf16_f32 v237, v46, v47
  v_mfma_f32_16x16x32_bf16 v[152:155], a[100:103], v[188:191], v[152:155]
  v_cvt_pk_bf16_f32 v238, v48, v49
  v_cvt_pk_bf16_f32 v239, v50, v51
  v_mfma_f32_16x16x32_bf16 v[156:159], a[104:107], v[188:191], v[156:159]
  s_waitcnt vmcnt(19) lgkmcnt(4)
  s_barrier
  v_mfma_f32_16x16x32_bf16 v[64:67], a[108:111], v[192:195], v[64:67]
  ds_read_b128 v[160:163], v18 offset:0
  v_cvt_pk_bf16_f32 v244, v36, v37
  v_mfma_f32_16x16x32_bf16 v[68:71], a[112:115], v[192:195], v[68:71]
  v_cvt_pk_bf16_f32 v245, v38, v39
  v_mfma_f32_16x16x32_bf16 v[72:75], a[116:119], v[192:195], v[72:75]
  v_add_u32 v19, s33, v15
  s_add_u32 s33, s33, 16384
  v_mfma_f32_16x16x32_bf16 v[76:79], a[108:111], v[196:199], v[76:79]
  ds_read_b128 v[164:167], v18 offset:2048
  v_mfma_f32_16x16x32_bf16 v[80:83], a[112:115], v[196:199], v[80:83]
  buffer_load_dwordx4 v10, s[8:11], s30 offen offset:0 lds
  v_mfma_f32_16x16x32_bf16 v[84:87], a[116:119], v[196:199], v[84:87]
  s_cmp_lt_u32 s33, 98304
  s_cselect_b32 s33, s33, 0
  v_mfma_f32_16x16x32_bf16 v[88:91], a[108:111], v[200:203], v[88:91]
  ds_read_b128 v[168:171], v18 offset:4096
  v_mfma_f32_16x16x32_bf16 v[92:95], a[112:115], v[200:203], v[92:95]
  v_permlane16_swap_b32 v240, v242
  v_mfma_f32_16x16x32_bf16 v[96:99], a[116:119], v[200:203], v[96:99]
  v_permlane16_swap_b32 v241, v243
  v_mfma_f32_16x16x32_bf16 v[100:103], a[108:111], v[204:207], v[100:103]
  ds_read_b128 v[172:175], v18 offset:6144
  v_mfma_f32_16x16x32_bf16 v[104:107], a[112:115], v[204:207], v[104:107]
  v_mfma_f32_16x16x32_bf16 v[108:111], a[116:119], v[204:207], v[108:111]
  s_waitcnt lgkmcnt(4)
  v_mfma_f32_16x16x32_bf16 v[112:115], a[108:111], v[208:211], v[112:115]
  ds_read_b128 v[176:179], v18 offset:8192
  v_mfma_f32_16x16x32_bf16 v[116:119], a[112:115], v[208:211], v[116:119]
  v_mfma_f32_16x16x32_bf16 v[120:123], a[116:119], v[208:211], v[120:123]
  v_mfma_f32_16x16x32_bf16 v[124:127], a[108:111], v[212:215], v[124:127]
  ds_read_b128 v[180:183], v18 offset:10240
  v_mfma_f32_16x16x32_bf16 v[128:131], a[112:115], v[212:215], v[128:131]
  buffer_load_dwordx4 v11, s[8:11], s30 offen offset:1024 lds
  v_mfma_f32_16x16x32_bf16 v[132:135], a[116:119], v[212:215], v[132:135]
  v_mfma_f32_16x16x32_bf16 v[136:139], a[108:111], v[216:219], v[136:139]
  ds_read_b128 v[184:187], v18 offset:12288
  v_mfma_f32_16x16x32_bf16 v[140:143], a[112:115], v[216:219], v[140:143]
  v_mfma_f32_16x16x32_bf16 v[144:147], a[116:119], v[216:219], v[144:147]
  v_mfma_f32_16x16x32_bf16 v[148:151], a[108:111], v[220:223], v[148:151]
  ds_read_b128 v[188:191], v18 offset:14336
  v_mfma_f32_16x16x32_bf16 v[152:155], a[112:115], v[220:223], v[152:155]
  v_mfma_f32_16x16x32_bf16 v[156:159], a[116:119], v[220:223], v[156:159]
  s_waitcnt lgkmcnt(4)
  v_mfma_f32_16x16x32_bf16 v[64:67], a[120:123], v[160:163], v[64:67]
  ds_read_b128 v[192:195], v19 offset:0
  v_mfma_f32_16x16x32_bf16 v[68:71], a[124:127], v[160:163], v[68:71]
  v_add_u32 v18, s33, v14
  v_mfma_f32_16x16x32_bf16 v[72:75], a[128:131], v[160:163], v[72:75]
  v_mfma_f32_16x16x32_bf16 v[76:79], a[120:123], v[164:167], v[76:79]
  ds_read_b128 v[196:199], v19 offset:2048
  v_mfma_f32_16x16x32_bf16 v[80:83], a[124:127], v[164:167], v[80:83]
  buffer_load_dwordx4 v12, s[8:11], s30 offen offset:2048 lds
  v_mfma_f32_16x16x32_bf16 v[84:87], a[128:131], v[164:167], v[84:87]
  v_mfma_f32_16x16x32_bf16 v[88:91], a[120:123], v[168:171], v[88:91]
  ds_read_b128 v[200:203], v19 offset:4096
  v_mfma_f32_16x16x32_bf16 v[92:95], a[124:127], v[168:171], v[92:95]
  v_mfma_f32_16x16x32_bf16 v[96:99], a[128:131], v[168:171], v[96:99]
  v_mfma_f32_16x16x32_bf16 v[100:103], a[120:123], v[172:175], v[100:103]
  ds_read_b128 v[204:207], v19 offset:6144
  v_mfma_f32_16x16x32_bf16 v[104:107], a[124:127], v[172:175], v[104:107]
  v_mfma_f32_16x16x32_bf16 v[108:111], a[128:131], v[172:175], v[108:111]
  s_waitcnt lgkmcnt(4)
  v_mfma_f32_16x16x32_bf16 v[112:115], a[120:123], v[176:179], v[112:115]
  ds_read_b128 v[208:211], v19 offset:8192
  v_mfma_f32_16x16x32_bf16 v[116:119], a[124:127], v[176:179], v[116:119]
  v_mfma_f32_16x16x32_bf16 v[120:123], a[128:131], v[176:179], v[120:123]
  v_mfma_f32_16x16x32_bf16 v[124:127], a[120:123], v[180:183], v[124:127]
  ds_read_b128 v[212:215], v19 offset:10240
  v_mfma_f32_16x16x32_bf16 v[128:131], a[124:127], v[180:183], v[128:131]
  buffer_load_dwordx4 v13, s[8:11], s30 offen offset:3072 lds
  v_mfma_f32_16x16x32_bf16 v[132:135], a[128:131], v[180:183], v[132:135]
  s_add_u32 s30, s30, s25
  s_sub_u32 s30, s30, 1152
  v_mfma_f32_16x16x32_bf16 v[136:139], a[120:123], v[184:187], v[136:139]
  ds_read_b128 v[216:219], v19 offset:12288
  s_mov_b32 s25, 163840
  v_mfma_f32_16x16x32_bf16 v[140:143], a[124:127], v[184:187], v[140:143]
  s_add_u32 m0, m0, 16384
  v_mfma_f32_16x16x32_bf16 v[144:147], a[128:131], v[184:187], v[144:147]
  s_cmp_lt_u32 m0, s46
  s_cselect_b32 m0, m0, s47
  v_mfma_f32_16x16x32_bf16 v[148:151], a[120:123], v[188:191], v[148:151]
  ds_read_b128 v[220:223], v19 offset:14336
  v_mfma_f32_16x16x32_bf16 v[152:155], a[124:127], v[188:191], v[152:155]
  v_mfma_f32_16x16x32_bf16 v[156:159], a[128:131], v[188:191], v[156:159]
  s_waitcnt vmcnt(17) lgkmcnt(4)
  s_barrier
  v_mfma_f32_16x16x32_bf16 v[64:67], a[132:135], v[192:195], v[64:67]
  ds_read_b128 v[160:163], v18 offset:0
  v_mfma_f32_16x16x32_bf16 v[68:71], a[136:139], v[192:195], v[68:71]
  v_mfma_f32_16x16x32_bf16 v[72:75], a[140:143], v[192:195], v[72:75]
  v_add_u32 v19, s33, v15
  s_add_u32 s33, s33, 16384
  v_mfma_f32_16x16x32_bf16 v[76:79], a[132:135], v[196:199], v[76:79]
  ds_read_b128 v[164:167], v18 offset:2048
  v_mfma_f32_16x16x32_bf16 v[80:83], a[136:139], v[196:199], v[80:83]
  buffer_load_dwordx4 v10, s[8:11], s30 offen offset:0 lds
  v_mfma_f32_16x16x32_bf16 v[84:87], a[140:143], v[196:199], v[84:87]
  s_cmp_lt_u32 s33, 98304
  s_cselect_b32 s33, s33, 0
  v_mfma_f32_16x16x32_bf16 v[88:91], a[132:135], v[200:203], v[88:91]
  ds_read_b128 v[168:171], v18 offset:4096
  v_mfma_f32_16x16x32_bf16 v[92:95], a[136:139], v[200:203], v[92:95]
  buffer_store_dwordx4 v[236:239], v30, s[56:59], s81 offen sc1
  v_mfma_f32_16x16x32_bf16 v[96:99], a[140:143], v[200:203], v[96:99]
  v_mfma_f32_16x16x32_bf16 v[100:103], a[132:135], v[204:207], v[100:103]
  ds_read_b128 v[172:175], v18 offset:6144
  v_mfma_f32_16x16x32_bf16 v[104:107], a[136:139], v[204:207], v[104:107]
  v_mfma_f32_16x16x32_bf16 v[108:111], a[140:143], v[204:207], v[108:111]
  s_waitcnt lgkmcnt(4)
  v_mfma_f32_16x16x32_bf16 v[112:115], a[132:135], v[208:211], v[112:115]
  ds_read_b128 v[176:179], v18 offset:8192
  v_mfma_f32_16x16x32_bf16 v[116:119], a[136:139], v[208:211], v[116:119]
  s_mov_b64 exec, 0xffffffff
  buffer_store_dwordx4 v[240:243], v30, s[56:59], s81 offen offset:1024 sc1
  s_mov_b64 exec, -1
  v_mfma_f32_16x16x32_bf16 v[120:123], a[140:143], v[208:211], v[120:123]
  v_mfma_f32_16x16x32_bf16 v[124:127], a[132:135], v[212:215], v[124:127]
  ds_read_b128 v[180:183], v18 offset:10240
  v_mfma_f32_16x16x32_bf16 v[128:131], a[136:139], v[212:215], v[128:131]
  buffer_load_dwordx4 v11, s[8:11], s30 offen offset:1024 lds
  v_mfma_f32_16x16x32_bf16 v[132:135], a[140:143], v[212:215], v[132:135]
  v_mfma_f32_16x16x32_bf16 v[136:139], a[132:135], v[216:219], v[136:139]
  ds_read_b128 v[184:187], v18 offset:12288
  v_mfma_f32_16x16x32_bf16 v[140:143], a[136:139], v[216:219], v[140:143]
  buffer_store_dwordx2 v[244:245], v32, s[56:59], s81 offen offset:2048 sc1
  v_mfma_f32_16x16x32_bf16 v[144:147], a[140:143], v[216:219], v[144:147]
  s_mov_b32 s78, s82
  s_mov_b32 s82, 0
  v_mfma_f32_16x16x32_bf16 v[148:151], a[132:135], v[220:223], v[148:151]
  ds_read_b128 v[188:191], v18 offset:14336
  s_mov_b32 s81, 0x80000000
  v_mfma_f32_16x16x32_bf16 v[152:155], a[136:139], v[220:223], v[152:155]
  v_mfma_f32_16x16x32_bf16 v[156:159], a[140:143], v[220:223], v[156:159]
  s_waitcnt lgkmcnt(4)
  s_add_u32 s21, s50, 0
  v_mfma_f32_16x16x32_bf16 v[64:67], a[144:147], v[160:163], v[64:67]
  ds_read_b128 v[192:195], v19 offset:0
  v_mfma_f32_16x16x32_bf16 v[68:71], a[148:151], v[160:163], v[68:71]
  v_add_u32 v18, s33, v14
  v_mfma_f32_16x16x32_bf16 v[72:75], a[152:155], v[160:163], v[72:75]
  buffer_load_dwordx4 v[36:39], v30, s[16:19], s21 offen offset:0 sc1
  v_mfma_f32_16x16x32_bf16 v[76:79], a[144:147], v[164:167], v[76:79]
  ds_read_b128 v[196:199], v19 offset:2048
  v_mfma_f32_16x16x32_bf16 v[80:83], a[148:151], v[164:167], v[80:83]
  buffer_load_dwordx4 v12, s[8:11], s30 offen offset:2048 lds
  v_mfma_f32_16x16x32_bf16 v[84:87], a[152:155], v[164:167], v[84:87]
  v_mfma_f32_16x16x32_bf16 v[88:91], a[144:147], v[168:171], v[88:91]
  ds_read_b128 v[200:203], v19 offset:4096
  v_mfma_f32_16x16x32_bf16 v[92:95], a[148:151], v[168:171], v[92:95]
  v_mfma_f32_16x16x32_bf16 v[96:99], a[152:155], v[168:171], v[96:99]
  v_mfma_f32_16x16x32_bf16 v[100:103], a[144:147], v[172:175], v[100:103]
  ds_read_b128 v[204:207], v19 offset:6144
  v_mfma_f32_16x16x32_bf16 v[104:107], a[148:151], v[172:175], v[104:107]
  v_mfma_f32_16x16x32_bf16 v[108:111], a[152:155], v[172:175], v[108:111]
  s_waitcnt lgkmcnt(4)
  v_mfma_f32_16x16x32_bf16 v[112:115], a[144:147], v[176:179], v[112:115]
  ds_read_b128 v[208:211], v19 offset:8192
  s_add_u32 s21, s50, 0
  v_mfma_f32_16x16x32_bf16 v[116:119], a[148:151], v[176:179], v[116:119]
  buffer_load_dwordx4 v[40:43], v30, s[16:19], s21 offen offset:1024 sc1
  v_mfma_f32_16x16x32_bf16 v[120:123], a[152:155], v[176:179], v[120:123]
  v_mfma_f32_16x16x32_bf16 v[124:127], a[144:147], v[180:183], v[124:127]
  ds_read_b128 v[212:215], v19 offset:10240
  v_mfma_f32_16x16x32_bf16 v[128:131], a[148:151], v[180:183], v[128:131]
  buffer_load_dwordx4 v13, s[8:11], s30 offen offset:3072 lds
  v_mfma_f32_16x16x32_bf16 v[132:135], a[152:155], v[180:183], v[132:135]
  s_add_u32 s30, s30, 128
  s_add_u32 m0, m0, 16384
  v_mfma_f32_16x16x32_bf16 v[136:139], a[144:147], v[184:187], v[136:139]
  ds_read_b128 v[216:219], v19 offset:12288
  v_mfma_f32_16x16x32_bf16 v[140:143], a[148:151], v[184:187], v[140:143]
  s_cmp_lt_u32 m0, s46
  s_cselect_b32 m0, m0, s47
  v_mfma_f32_16x16x32_bf16 v[144:147], a[152:155], v[184:187], v[144:147]
  v_mfma_f32_16x16x32_bf16 v[148:151], a[144:147], v[188:191], v[148:151]
  ds_read_b128 v[220:223], v19 offset:14336
  v_mfma_f32_16x16x32_bf16 v[152:155], a[148:151], v[188:191], v[152:155]
  v_mfma_f32_16x16x32_bf16 v[156:159], a[152:155], v[188:191], v[156:159]
  s_waitcnt vmcnt(20) lgkmcnt(4)
  s_barrier
  v_mfma_f32_16x16x32_bf16 v[64:67], a[156:159], v[192:195], v[64:67]
  ds_read_b128 v[160:163], v18 offset:0
  s_add_u32 s21, s50, 0
  v_mfma_f32_16x16x32_bf16 v[68:71], a[160:163], v[192:195], v[68:71]
  buffer_load_dwordx4 v[44:47], v30, s[16:19], s21 offen offset:2048 sc1
  v_mfma_f32_16x16x32_bf16 v[72:75], a[164:167], v[192:195], v[72:75]
  v_add_u32 v19, s33, v15
  s_add_u32 s33, s33, 16384
  v_mfma_f32_16x16x32_bf16 v[76:79], a[156:159], v[196:199], v[76:79]
  ds_read_b128 v[164:167], v18 offset:2048
  v_mfma_f32_16x16x32_bf16 v[80:83], a[160:163], v[196:199], v[80:83]
  buffer_load_dwordx4 v10, s[8:11], s30 offen offset:0 lds
  v_mfma_f32_16x16x32_bf16 v[84:87], a[164:167], v[196:199], v[84:87]
  s_cmp_lt_u32 s33, 98304
  s_cselect_b32 s33, s33, 0
  v_mfma_f32_16x16x32_bf16 v[88:91], a[156:159], v[200:203], v[88:91]
  ds_read_b128 v[168:171], v18 offset:4096
  v_mfma_f32_16x16x32_bf16 v[92:95], a[160:163], v[200:203], v[92:95]
  v_mfma_f32_16x16x32_bf16 v[96:99], a[164:167], v[200:203], v[96:99]
  v_mfma_f32_16x16x32_bf16 v[100:103], a[156:159], v[204:207], v[100:103]
  ds_read_b128 v[172:175], v18 offset:6144
  v_mfma_f32_16x16x32_bf16 v[104:107], a[160:163], v[204:207], v[104:107]
  v_mfma_f32_16x16x32_bf16 v[108:111], a[164:167], v[204:207], v[108:111]
  s_waitcnt lgkmcnt(4)
  s_add_u32 s21, s50, 0
  v_mfma_f32_16x16x32_bf16 v[112:115], a[156:159], v[208:211], v[112:115]
  ds_read_b128 v[176:179], v18 offset:8192
  v_mfma_f32_16x16x32_bf16 v[116:119], a[160:163], v[208:211], v[116:119]
  buffer_load_dwordx4 v[48:51], v30, s[16:19], s21 offen offset:3072 sc1
  v_mfma_f32_16x16x32_bf16 v[120:123], a[164:167], v[208:211], v[120:123]
  v_mfma_f32_16x16x32_bf16 v[124:127], a[156:159], v[212:215], v[124:127]
  ds_read_b128 v[180:183], v18 offset:10240
  v_mfma_f32_16x16x32_bf16 v[128:131], a[160:163], v[212:215], v[128:131]
  buffer_load_dwordx4 v11, s[8:11], s30 offen offset:1024 lds
  v_mfma_f32_16x16x32_bf16 v[132:135], a[164:167], v[212:215], v[132:135]
  v_mfma_f32_16x16x32_bf16 v[136:139], a[156:159], v[216:219], v[136:139]
  ds_read_b128 v[184:187], v18 offset:12288
  v_mfma_f32_16x16x32_bf16 v[140:143], a[160:163], v[216:219], v[140:143]
  v_mfma_f32_16x16x32_bf16 v[144:147], a[164:167], v[216:219], v[144:147]
  v_mfma_f32_16x16x32_bf16 v[148:151], a[156:159], v[220:223], v[148:151]
  ds_read_b128 v[188:191], v18 offset:14336
  v_mfma_f32_16x16x32_bf16 v[152:155], a[160:163], v[220:223], v[152:155]
  v_mfma_f32_16x16x32_bf16 v[156:159], a[164:167], v[220:223], v[156:159]
  s_waitcnt lgkmcnt(4)
  s_add_u32 s21, s50, 4096
  v_mfma_f32_16x16x32_bf16 v[64:67], a[168:171], v[160:163], v[64:67]
  ds_read_b128 v[192:195], v19 offset:0
  v_mfma_f32_16x16x32_bf16 v[68:71], a[172:175], v[160:163], v[68:71]
  v_add_u32 v18, s33, v14
  v_mfma_f32_16x16x32_bf16 v[72:75], a[176:179], v[160:163], v[72:75]
  buffer_load_dwordx4 v[52:55], v30, s[16:19], s21 offen offset:0 sc1
  v_mfma_f32_16x16x32_bf16 v[76:79], a[168:171], v[164:167], v[76:79]
  ds_read_b128 v[196:199], v19 offset:2048
  v_mfma_f32_16x16x32_bf16 v[80:83], a[172:175], v[164:167], v[80:83]
  buffer_load_dwordx4 v12, s[8:11], s30 offen offset:2048 lds
  v_mfma_f32_16x16x32_bf16 v[84:87], a[176:179], v[164:167], v[84:87]
  v_mfma_f32_16x16x32_bf16 v[88:91], a[168:171], v[168:171], v[88:91]
  ds_read_b128 v[200:203], v19 offset:4096
  v_mfma_f32_16x16x32_bf16 v[92:95], a[172:175], v[168:171], v[92:95]
  v_mfma_f32_16x16x32_bf16 v[96:99], a[176:179], v[168:171], v[96:99]
  v_mfma_f32_16x16x32_bf16 v[100:103], a[168:171], v[172:175], v[100:103]
  ds_read_b128 v[204:207], v19 offset:6144
  v_mfma_f32_16x16x32_bf16 v[104:107], a[172:175], v[172:175], v[104:107]
  v_mfma_f32_16x16x32_bf16 v[108:111], a[176:179], v[172:175], v[108:111]
  s_waitcnt lgkmcnt(4)
  v_mfma_f32_16x16x32_bf16 v[112:115], a[168:171], v[176:179], v[112:115]
  ds_read_b128 v[208:211], v19 offset:8192
  s_add_u32 s21, s50, 4096
  v_mfma_f32_16x16x32_bf16 v[116:119], a[172:175], v[176:179], v[116:119]
  buffer_load_dwordx4 v[56:59], v30, s[16:19], s21 offen offset:1024 sc1
  v_mfma_f32_16x16x32_bf16 v[120:123], a[176:179], v[176:179], v[120:123]
  v_mfma_f32_16x16x32_bf16 v[124:127], a[168:171], v[180:183], v[124:127]
  ds_read_b128 v[212:215], v19 offset:10240
  v_mfma_f32_16x16x32_bf16 v[128:131], a[172:175], v[180:183], v[128:131]
  buffer_load_dwordx4 v13, s[8:11], s30 offen offset:3072 lds
  v_mfma_f32_16x16x32_bf16 v[132:135], a[176:179], v[180:183], v[132:135]
  s_add_u32 s30, s30, 128
  s_add_u32 m0, m0, 16384
  v_mfma_f32_16x16x32_bf16 v[136:139], a[168:171], v[184:187], v[136:139]
  ds_read_b128 v[216:219], v19 offset:12288
  v_mfma_f32_16x16x32_bf16 v[140:143], a[172:175], v[184:187], v[140:143]
  s_cmp_lt_u32 m0, s46
  s_cselect_b32 m0, m0, s47
  v_mfma_f32_16x16x32_bf16 v[144:147], a[176:179], v[184:187], v[144:147]
  v_mfma_f32_16x16x32_bf16 v[148:151], a[168:171], v[188:191], v[148:151]
  ds_read_b128 v[220:223], v19 offset:14336
  v_mfma_f32_16x16x32_bf16 v[152:155], a[172:175], v[188:191], v[152:155]
  v_mfma_f32_16x16x32_bf16 v[156:159], a[176:179], v[188:191], v[156:159]
  s_waitcnt vmcnt(22) lgkmcnt(4)
  s_barrier
  v_mfma_f32_16x16x32_bf16 v[64:67], a[180:183], v[192:195], v[64:67]
  ds_read_b128 v[160:163], v18 offset:0
  s_add_u32 s21, s50, 4096
  v_mfma_f32_16x16x32_bf16 v[68:71], a[184:187], v[192:195], v[68:71]
  buffer_load_dwordx4 v[236:239], v30, s[16:19], s21 offen offset:3072 sc1
  v_mfma_f32_16x16x32_bf16 v[72:75], a[188:191], v[192:195], v[72:75]
  v_add_u32 v19, s33, v15
  s_add_u32 s33, s33, 16384
  v_mfma_f32_16x16x32_bf16 v[76:79], a[180:183], v[196:199], v[76:79]
  ds_read_b128 v[164:167], v18 offset:2048
  v_mfma_f32_16x16x32_bf16 v[80:83], a[184:187], v[196:199], v[80:83]
  buffer_load_dwordx4 v10, s[8:11], s30 offen offset:0 lds
  v_mfma_f32_16x16x32_bf16 v[84:87], a[188:191], v[196:199], v[84:87]
  s_cmp_lt_u32 s33, 98304
  s_cselect_b32 s33, s33, 0
  v_mfma_f32_16x16x32_bf16 v[88:91], a[180:183], v[200:203], v[88:91]
  ds_read_b128 v[168:171], v18 offset:4096
  v_mfma_f32_16x16x32_bf16 v[92:95], a[184:187], v[200:203], v[92:95]
  v_mfma_f32_16x16x32_bf16 v[96:99], a[188:191], v[200:203], v[96:99]
  v_mfma_f32_16x16x32_bf16 v[100:103], a[180:183], v[204:207], v[100:103]
  ds_read_b128 v[172:175], v18 offset:6144
  v_mfma_f32_16x16x32_bf16 v[104:107], a[184:187], v[204:207], v[104:107]
  v_mfma_f32_16x16x32_bf16 v[108:111], a[188:191], v[204:207], v[108:111]
  s_waitcnt lgkmcnt(4)
  s_add_u32 s21, s50, 8192
  v_mfma_f32_16x16x32_bf16 v[112:115], a[180:183], v[208:211], v[112:115]
  ds_read_b128 v[176:179], v18 offset:8192
  v_mfma_f32_16x16x32_bf16 v[116:119], a[184:187], v[208:211], v[116:119]
  buffer_load_dwordx4 v[240:243], v30, s[16:19], s21 offen offset:0 sc1
  v_mfma_f32_16x16x32_bf16 v[120:123], a[188:191], v[208:211], v[120:123]
  v_mfma_f32_16x16x32_bf16 v[124:127], a[180:183], v[212:215], v[124:127]
  ds_read_b128 v[180:183], v18 offset:10240
  v_mfma_f32_16x16x32_bf16 v[128:131], a[184:187], v[212:215], v[128:131]
  buffer_load_dwordx4 v11, s[8:11], s30 offen offset:1024 lds
  v_mfma_f32_16x16x32_bf16 v[132:135], a[188:191], v[212:215], v[132:135]
  v_mfma_f32_16x16x32_bf16 v[136:139], a[180:183], v[216:219], v[136:139]
  ds_read_b128 v[184:187], v18 offset:12288
  v_mfma_f32_16x16x32_bf16 v[140:143], a[184:187], v[216:219], v[140:143]
  v_mfma_f32_16x16x32_bf16 v[144:147], a[188:191], v[216:219], v[144:147]
  v_mfma_f32_16x16x32_bf16 v[148:151], a[180:183], v[220:223], v[148:151]
  ds_read_b128 v[188:191], v18 offset:14336
  v_mfma_f32_16x16x32_bf16 v[152:155], a[184:187], v[220:223], v[152:155]
  v_mfma_f32_16x16x32_bf16 v[156:159], a[188:191], v[220:223], v[156:159]
  s_waitcnt lgkmcnt(4)
  s_add_u32 s21, s50, 8192
  v_mfma_f32_16x16x32_bf16 v[64:67], a[192:195], v[160:163], v[64:67]
  ds_read_b128 v[192:195], v19 offset:0
  v_mfma_f32_16x16x32_bf16 v[68:71], a[196:199], v[160:163], v[68:71]
  v_add_u32 v18, s33, v14
  v_mfma_f32_16x16x32_bf16 v[72:75], a[200:203], v[160:163], v[72:75]
  buffer_load_dwordx4 v[244:247], v30, s[16:19], s21 offen offset:1024 sc1
  v_mfma_f32_16x16x32_bf16 v[76:79], a[192:195], v[164:167], v[76:79]
  ds_read_b128 v[196:199], v19 offset:2048
  v_mfma_f32_16x16x32_bf16 v[80:83], a[196:199], v[164:167], v[80:83]
  buffer_load_dwordx4 v12, s[8:11], s30 offen offset:2048 lds
  v_mfma_f32_16x16x32_bf16 v[84:87], a[200:203], v[164:167], v[84:87]
  v_mfma_f32_16x16x32_bf16 v[88:91], a[192:195], v[168:171], v[88:91]
  ds_read_b128 v[200:203], v19 offset:4096
  v_mfma_f32_16x16x32_bf16 v[92:95], a[196:199], v[168:171], v[92:95]
  v_mfma_f32_16x16x32_bf16 v[96:99], a[200:203], v[168:171], v[96:99]
  v_mfma_f32_16x16x32_bf16 v[100:103], a[192:195], v[172:175], v[100:103]
  ds_read_b128 v[204:207], v19 offset:6144
  v_mfma_f32_16x16x32_bf16 v[104:107], a[196:199], v[172:175], v[104:107]
  v_mfma_f32_16x16x32_bf16 v[108:111], a[200:203], v[172:175], v[108:111]
  s_waitcnt lgkmcnt(4)
  v_mfma_f32_16x16x32_bf16 v[112:115], a[192:195], v[176:179], v[112:115]
  ds_read_b128 v[208:211], v19 offset:8192
  v_mfma_f32_16x16x32_bf16 v[116:119], a[196:199], v[176:179], v[116:119]
  v_mfma_f32_16x16x32_bf16 v[120:123], a[200:203], v[176:179], v[120:123]
  v_mfma_f32_16x16x32_bf16 v[124:127], a[192:195], v[180:183], v[124:127]
  ds_read_b128 v[212:215], v19 offset:10240
  v_mfma_f32_16x16x32_bf16 v[128:131], a[196:199], v[180:183], v[128:131]
  buffer_load_dwordx4 v13, s[8:11], s30 offen offset:3072 lds
  v_mfma_f32_16x16x32_bf16 v[132:135], a[200:203], v[180:183], v[132:135]
  s_add_u32 s30, s30, 128
  s_add_u32 m0, m0, 16384
  v_mfma_f32_16x16x32_bf16 v[136:139], a[192:195], v[184:187], v[136:139]
  ds_read_b128 v[216:219], v19 offset:12288
  v_mfma_f32_16x16x32_bf16 v[140:143], a[196:199], v[184:187], v[140:143]
  s_cmp_lt_u32 m0, s46
  s_cselect_b32 m0, m0, s47
  v_mfma_f32_16x16x32_bf16 v[144:147], a[200:203], v[184:187], v[144:147]
  v_mfma_f32_16x16x32_bf16 v[148:151], a[192:195], v[188:191], v[148:151]
  ds_read_b128 v[220:223], v19 offset:14336
  v_mfma_f32_16x16x32_bf16 v[152:155], a[196:199], v[188:191], v[152:155]
  v_mfma_f32_16x16x32_bf16 v[156:159], a[200:203], v[188:191], v[156:159]
  s_waitcnt vmcnt(24) lgkmcnt(4)
  s_barrier
  v_mfma_f32_16x16x32_bf16 v[64:67], a[204:207], v[192:195], v[64:67]
  ds_read_b128 v[160:163], v18 offset:0
  v_mfma_f32_16x16x32_bf16 v[68:71], a[208:211], v[192:195], v[68:71]
  v_mfma_f32_16x16x32_bf16 v[72:75], a[212:215], v[192:195], v[72:75]
  v_add_u32 v19, s33, v15
  s_add_u32 s33, s33, 16384
  v_mfma_f32_16x16x32_bf16 v[76:79], a[204:207], v[196:199], v[76:79]
  ds_read_b128 v[164:167], v18 offset:2048
  v_mfma_f32_16x16x32_bf16 v[80:83], a[208:211], v[196:199], v[80:83]
  buffer_load_dwordx4 v10, s[8:11], s30 offen offset:0 lds
  v_mfma_f32_16x16x32_bf16 v[84:87], a[212:215], v[196:199], v[84:87]
  s_cmp_lt_u32 s33, 98304
  s_cselect_b32 s33, s33, 0
  v_mfma_f32_16x16x32_bf16 v[88:91], a[204:207], v[200:203], v[88:91]
  ds_read_b128 v[168:171], v18 offset:4096
  v_mfma_f32_16x16x32_bf16 v[92:95], a[208:211], v[200:203], v[92:95]
  v_mfma_f32_16x16x32_bf16 v[96:99], a[212:215], v[200:203], v[96:99]
  v_mfma_f32_16x16x32_bf16 v[100:103], a[204:207], v[204:207], v[100:103]
  ds_read_b128 v[172:175], v18 offset:6144
  v_mfma_f32_16x16x32_bf16 v[104:107], a[208:211], v[204:207], v[104:107]
  v_mfma_f32_16x16x32_bf16 v[108:111], a[212:215], v[204:207], v[108:111]
  s_waitcnt lgkmcnt(4)
  v_mfma_f32_16x16x32_bf16 v[112:115], a[204:207], v[208:211], v[112:115]
  ds_read_b128 v[176:179], v18 offset:8192
  v_mfma_f32_16x16x32_bf16 v[116:119], a[208:211], v[208:211], v[116:119]
  v_mfma_f32_16x16x32_bf16 v[120:123], a[212:215], v[208:211], v[120:123]
  v_mfma_f32_16x16x32_bf16 v[124:127], a[204:207], v[212:215], v[124:127]
  ds_read_b128 v[180:183], v18 offset:10240
  v_mfma_f32_16x16x32_bf16 v[128:131], a[208:211], v[212:215], v[128:131]
  buffer_load_dwordx4 v11, s[8:11], s30 offen offset:1024 lds
  v_mfma_f32_16x16x32_bf16 v[132:135], a[212:215], v[212:215], v[132:135]
  v_mfma_f32_16x16x32_bf16 v[136:139], a[204:207], v[216:219], v[136:139]
  ds_read_b128 v[184:187], v18 offset:12288
  v_mfma_f32_16x16x32_bf16 v[140:143], a[208:211], v[216:219], v[140:143]
  v_mfma_f32_16x16x32_bf16 v[144:147], a[212:215], v[216:219], v[144:147]
  v_mfma_f32_16x16x32_bf16 v[148:151], a[204:207], v[220:223], v[148:151]
  ds_read_b128 v[188:191], v18 offset:14336
  v_mfma_f32_16x16x32_bf16 v[152:155], a[208:211], v[220:223], v[152:155]
  v_mfma_f32_16x16x32_bf16 v[156:159], a[212:215], v[220:223], v[156:159]
  s_waitcnt lgkmcnt(4)
  v_mfma_f32_16x16x32_bf16 v[64:67], a[216:219], v[160:163], v[64:67]
  ds_read_b128 v[192:195], v19 offset:0
  v_mfma_f32_16x16x32_bf16 v[68:71], a[220:223], v[160:163], v[68:71]
  v_add_u32 v18, s33, v14
  v_mfma_f32_16x16x32_bf16 v[72:75], a[224:227], v[160:163], v[72:75]
  v_mfma_f32_16x16x32_bf16 v[76:79], a[216:219], v[164:167], v[76:79]
  ds_read_b128 v[196:199], v19 offset:2048
  v_mfma_f32_16x16x32_bf16 v[80:83], a[220:223], v[164:167], v[80:83]
  buffer_load_dwordx4 v12, s[8:11], s30 offen offset:2048 lds
  v_mfma_f32_16x16x32_bf16 v[84:87], a[224:227], v[164:167], v[84:87]
  v_mfma_f32_16x16x32_bf16 v[88:91], a[216:219], v[168:171], v[88:91]
  ds_read_b128 v[200:203], v19 offset:4096
  v_mfma_f32_16x16x32_bf16 v[92:95], a[220:223], v[168:171], v[92:95]
  v_mfma_f32_16x16x32_bf16 v[96:99], a[224:227], v[168:171], v[96:99]
  v_mfma_f32_16x16x32_bf16 v[100:103], a[216:219], v[172:175], v[100:103]
  ds_read_b128 v[204:207], v19 offset:6144
  v_mfma_f32_16x16x32_bf16 v[104:107], a[220:223], v[172:175], v[104:107]
  v_mfma_f32_16x16x32_bf16 v[108:111], a[224:227], v[172:175], v[108:111]
  s_waitcnt lgkmcnt(4)
  v_mfma_f32_16x16x32_bf16 v[112:115], a[216:219], v[176:179], v[112:115]
  ds_read_b128 v[208:211], v19 offset:8192
  v_mfma_f32_16x16x32_bf16 v[116:119], a[220:223], v[176:179], v[116:119]
  v_mfma_f32_16x16x32_bf16 v[120:123], a[224:227], v[176:179], v[120:123]
  v_mfma_f32_16x16x32_bf16 v[124:127], a[216:219], v[180:183], v[124:127]
  ds_read_b128 v[212:215], v19 offset:10240
  v_mfma_f32_16x16x32_bf16 v[128:131], a[220:223], v[180:183], v[128:131]
  buffer_load_dwordx4 v13, s[8:11], s30 offen offset:3072 lds
  v_mfma_f32_16x16x32_bf16 v[132:135], a[224:227], v[180:183], v[132:135]
  s_add_u32 s30, s30, 128
  s_add_u32 m0, m0, 16384
  v_mfma_f32_16x16x32_bf16 v[136:139], a[216:219], v[184:187], v[136:139]
  ds_read_b128 v[216:219], v19 offset:12288
  v_mfma_f32_16x16x32_bf16 v[140:143], a[220:223], v[184:187], v[140:143]
  s_cmp_lt_u32 m0, s46
  s_cselect_b32 m0, m0, s47
  v_mfma_f32_16x16x32_bf16 v[144:147], a[224:227], v[184:187], v[144:147]
  v_mfma_f32_16x16x32_bf16 v[148:151], a[216:219], v[188:191], v[148:151]
  ds_read_b128 v[220:223], v19 offset:14336
  v_mfma_f32_16x16x32_bf16 v[152:155], a[220:223], v[188:191], v[152:155]
  v_mfma_f32_16x16x32_bf16 v[156:159], a[224:227], v[188:191], v[156:159]
  s_waitcnt vmcnt(19) lgkmcnt(4)
  s_barrier
  v_mfma_f32_16x16x32_bf16 v[64:67], a[228:231], v[192:195], v[64:67]
  ds_read_b128 v[160:163], v18 offset:0
  v_mfma_f32_16x16x32_bf16 v[68:71], a[232:235], v[192:195], v[68:71]
  s_waitcnt vmcnt(22)
  s_cmp_eq_u32 s78, 0
  s_cbranch_scc1 pf_246
  v_mov_b32 v4, 0
  v_mov_b32 v5, 1
  s_mov_b64 exec, 1
  buffer_atomic_add v5, v4, s[72:75], s78 offen sc1
  s_mov_b64 exec, -1
  s_mov_b32 s78, 0
pf_246:
  buffer_load_dword v21, v33, s[72:75], s77 offen sc1
  v_mfma_f32_16x16x32_bf16 v[72:75], a[236:239], v[192:195], v[72:75]
  v_add_u32 v19, s33, v15
  s_add_u32 s33, s33, 16384
  v_mfma_f32_16x16x32_bf16 v[76:79], a[228:231], v[196:199], v[76:79]
  ds_read_b128 v[164:167], v18 offset:2048
  v_cvt_pk_bf16_f32 v224, v64, v65
  v_cvt_pk_bf16_f32 v225, v66, v67
  v_mfma_f32_16x16x32_bf16 v[80:83], a[232:235], v[196:199], v[80:83]
  buffer_load_dwordx4 v10, s[8:11], s30 offen offset:0 lds
  v_cvt_pk_bf16_f32 v226, v68, v69
  v_cvt_pk_bf16_f32 v227, v70, v71
  v_mfma_f32_16x16x32_bf16 v[84:87], a[236:239], v[196:199], v[84:87]
  s_cmp_lt_u32 s33, 98304
  s_cselect_b32 s33, s33, 0
  v_cvt_pk_bf16_f32 v228, v72, v73
  v_cvt_pk_bf16_f32 v229, v74, v75
  v_mfma_f32_16x16x32_bf16 v[88:91], a[228:231], v[200:203], v[88:91]
  ds_read_b128 v[168:171], v18 offset:4096
  ds_write_b64 v22, v[224:225] offset:0
  v_mfma_f32_16x16x32_bf16 v[92:95], a[232:235], v[200:203], v[92:95]
  ds_write_b64 v22, v[226:227] offset:8
  ds_write_b64 v16, v[228:229] offset:64
  v_mfma_f32_16x16x32_bf16 v[96:99], a[236:239], v[200:203], v[96:99]
  v_cvt_pk_bf16_f32 v230, v76, v77
  v_cvt_pk_bf16_f32 v231, v78, v79
  v_cvt_pk_bf16_f32 v232, v80, v81
  v_cvt_pk_bf16_f32 v233, v82, v83
  v_mfma_f32_16x16x32_bf16 v[100:103], a[228:231], v[204:207], v[100:103]
  ds_read_b128 v[172:175], v18 offset:6144
  v_cvt_pk_bf16_f32 v234, v84, v85
  v_cvt_pk_bf16_f32 v235, v86, v87
  v_mfma_f32_16x16x32_bf16 v[104:107], a[232:235], v[204:207], v[104:107]
  ds_write_b64 v22, v[230:231] offset:6400
  ds_write_b64 v22, v[232:233] offset:6408
  v_mfma_f32_16x16x32_bf16 v[108:111], a[236:239], v[204:207], v[108:111]
  s_waitcnt lgkmcnt(9)
  ds_write_b64 v16, v[234:235] offset:6464
  v_cvt_pk_bf16_f32 v224, v88, v89
  v_mfma_f32_16x16x32_bf16 v[112:115], a[228:231], v[208:211], v[112:115]
  ds_read_b128 v[176:179], v18 offset:8192
  v_cvt_pk_bf16_f32 v225, v90, v91
  v_cvt_pk_bf16_f32 v226, v92, v93
  v_cvt_pk_bf16_f32 v227, v94, v95
  v_mfma_f32_16x16x32_bf16 v[116:119], a[232:235], v[208:211], v[116:119]
  v_cvt_pk_bf16_f32 v228, v96, v97
  v_cvt_pk_bf16_f32 v229, v98, v99
  ds_write_b64 v22, v[224:225] offset:12800
  v_mfma_f32_16x16x32_bf16 v[120:123], a[236:239], v[208:211], v[120:123]
  ds_write_b64 v22, v[226:227] offset:12808
  ds_write_b64 v16, v[228:229] offset:12864
  v_mfma_f32_16x16x32_bf16 v[124:127], a[228:231], v[212:215], v[124:127]
  ds_read_b128 v[180:183], v18 offset:10240
  v_cvt_pk_bf16_f32 v230, v100, v101
  v_cvt_pk_bf16_f32 v231, v102, v103
  v_cvt_pk_bf16_f32 v232, v104, v105
  v_mfma_f32_16x16x32_bf16 v[128:131], a[232:235], v[212:215], v[128:131]
  buffer_load_dwordx4 v11, s[8:11], s30 offen offset:1024 lds
  v_cvt_pk_bf16_f32 v233, v106, v107
  v_cvt_pk_bf16_f32 v234, v108, v109
  v_mfma_f32_16x16x32_bf16 v[132:135], a[236:239], v[212:215], v[132:135]
  v_cvt_pk_bf16_f32 v235, v110, v111
  ds_write_b64 v22, v[230:231] offset:19200
  v_mfma_f32_16x16x32_bf16 v[136:139], a[228:231], v[216:219], v[136:139]
  ds_read_b128 v[184:187], v18 offset:12288
  ds_write_b64 v22, v[232:233] offset:19208
  v_mfma_f32_16x16x32_bf16 v[140:143], a[232:235], v[216:219], v[140:143]
  ds_write_b64 v16, v[234:235] offset:19264
  v_cvt_pk_bf16_f32 v224, v112, v113
  v_cvt_pk_bf16_f32 v225, v114, v115
  v_mfma_f32_16x16x32_bf16 v[144:147], a[236:239], v[216:219], v[144:147]
  v_cvt_pk_bf16_f32 v226, v116, v117
  v_cvt_pk_bf16_f32 v227, v118, v119
  v_cvt_pk_bf16_f32 v228, v120, v121
  v_cvt_pk_bf16_f32 v229, v122, v123
  v_mfma_f32_16x16x32_bf16 v[148:151], a[228:231], v[220:223], v[148:151]
  ds_read_b128 v[188:191], v18 offset:14336
  ds_write_b64 v22, v[224:225] offset:25600
  v_mfma_f32_16x16x32_bf16 v[152:155], a[232:235], v[220:223], v[152:155]
  ds_write_b64 v22, v[226:227] offset:25608
  ds_write_b64 v16, v[228:229] offset:25664
  v_mfma_f32_16x16x32_bf16 v[156:159], a[236:239], v[220:223], v[156:159]
  v_cvt_pk_bf16_f32 v230, v124, v125
  v_cvt_pk_bf16_f32 v231, v126, v127
  v_cvt_pk_bf16_f32 v232, v128, v129
  v_cvt_pk_bf16_f32 v233, v130, v131
qa_end_248:
  v_cvt_pk_bf16_f32 v234, v132, v133
  v_cvt_pk_bf16_f32 v235, v134, v135
  ds_write_b64 v22, v[230:231] offset:32000
  ds_write_b64 v22, v[232:233] offset:32008
  ds_write_b64 v16, v[234:235] offset:32064
  v_cvt_pk_bf16_f32 v224, v136, v137
  v_cvt_pk_bf16_f32 v225, v138, v139
  v_cvt_pk_bf16_f32 v226, v140, v141
  v_cvt_pk_bf16_f32 v227, v142, v143
  v_cvt_pk_bf16_f32 v228, v144, v145
  v_cvt_pk_bf16_f32 v229, v146, v147
  ds_write_b64 v22, v[224:225] offset:38400
  ds_write_b64 v22, v[226:227] offset:38408
  ds_write_b64 v16, v[228:229] offset:38464
  v_cvt_pk_bf16_f32 v230, v148, v149
  v_cvt_pk_bf16_f32 v231, v150, v151
  v_cvt_pk_bf16_f32 v232, v152, v153
  v_cvt_pk_bf16_f32 v233, v154, v155
  v_cvt_pk_bf16_f32 v234, v156, v157
  v_cvt_pk_bf16_f32 v235, v158, v159
  ds_write_b64 v22, v[230:231] offset:44800
  ds_write_b64 v22, v[232:233] offset:44808
  ds_write_b64 v16, v[234:235] offset:44864
  s_cmp_eq_u32 s80, 1
  s_cselect_b32 s21, s79, 0
  s_cmp_ge_u32 s21, 8
  s_cbranch_scc0 qx_251
  s_waitcnt lgkmcnt(0) vmcnt(5)
  s_barrier
  ds_read_b128 v[64:67], v29 offset:0
  ds_read_b128 v[88:91], v29 offset:6400
  ds_read_b128 v[68:71], v29 offset:64
  ds_read_b128 v[92:95], v29 offset:6464
  ds_read_b128 v[72:75], v29 offset:128
  ds_read_b128 v[96:99], v29 offset:6528
  ds_read_b128 v[76:79], v29 offset:192
  ds_read_b128 v[100:103], v29 offset:6592
  ds_read_b128 v[80:83], v29 offset:256
  ds_read_b128 v[104:107], v29 offset:6656
  ds_read_b128 v[84:87], v29 offset:320
  ds_read_b128 v[108:111], v29 offset:6720
  s_waitcnt lgkmcnt(10)
  v_mfma_f32_16x16x32_bf16 v[112:115], v[36:39], v[64:67], 0
  v_mfma_f32_16x16x32_bf16 v[116:119], a[240:243], v[64:67], 0
  v_mfma_f32_16x16x32_bf16 v[120:123], v[36:39], v[88:91], 0
  v_mfma_f32_16x16x32_bf16 v[124:127], v[60:63], v[88:91], 0
  v_mfma_f32_16x16x32_bf16 v[128:131], a[240:243], v[88:91], 0
  s_waitcnt lgkmcnt(8)
  v_mfma_f32_16x16x32_bf16 v[112:115], v[40:43], v[68:71], v[112:115]
  v_mfma_f32_16x16x32_bf16 v[116:119], a[244:247], v[68:71], v[116:119]
  v_mfma_f32_16x16x32_bf16 v[120:123], v[40:43], v[92:95], v[120:123]
  v_mfma_f32_16x16x32_bf16 v[124:127], v[236:239], v[92:95], v[124:127]
  v_mfma_f32_16x16x32_bf16 v[128:131], a[244:247], v[92:95], v[128:131]
  s_waitcnt lgkmcnt(6)
  v_mfma_f32_16x16x32_bf16 v[112:115], v[44:47], v[72:75], v[112:115]
  v_mfma_f32_16x16x32_bf16 v[116:119], a[248:251], v[72:75], v[116:119]
  v_mfma_f32_16x16x32_bf16 v[120:123], v[44:47], v[96:99], v[120:123]
  v_mfma_f32_16x16x32_bf16 v[124:127], v[240:243], v[96:99], v[124:127]
  v_mfma_f32_16x16x32_bf16 v[128:131], a[248:251], v[96:99], v[128:131]
  s_waitcnt lgkmcnt(4)
  v_mfma_f32_16x16x32_bf16 v[112:115], v[48:51], v[76:79], v[112:115]
  v_mfma_f32_16x16x32_bf16 v[116:119], a[252:255], v[76:79], v[116:119]
  v_mfma_f32_16x16x32_bf16 v[120:123], v[48:51], v[100:103], v[120:123]
  v_mfma_f32_16x16x32_bf16 v[124:127], v[244:247], v[100:103], v[124:127]
  v_mfma_f32_16x16x32_bf16 v[128:131], a[252:255], v[100:103], v[128:131]
  s_waitcnt lgkmcnt(2)
  v_mfma_f32_16x16x32_bf16 v[112:115], v[52:55], v[80:83], v[112:115]
  v_mfma_f32_16x16x32_bf16 v[116:119], v[24:27], v[80:83], v[116:119]
  v_mfma_f32_16x16x32_bf16 v[120:123], v[52:55], v[104:107], v[120:123]
  v_mfma_f32_16x16x32_bf16 v[124:127], v[248:251], v[104:107], v[124:127]
  v_mfma_f32_16x16x32_bf16 v[128:131], v[24:27], v[104:107], v[128:131]
  s_waitcnt lgkmcnt(0)
  v_mfma_f32_16x16x32_bf16 v[112:115], v[56:59], v[84:87], v[112:115]
  v_mfma_f32_16x16x32_bf16 v[116:119], v[6:9], v[84:87], v[116:119]
  v_mfma_f32_16x16x32_bf16 v[120:123], v[56:59], v[108:111], v[120:123]
  v_mfma_f32_16x16x32_bf16 v[124:127], v[252:255], v[108:111], v[124:127]
  v_mfma_f32_16x16x32_bf16 v[128:131], v[6:9], v[108:111], v[128:131]
  s_branch qx_250
qx_251:
  buffer_load_dword v21, v33, s[72:75], s77 offen sc1
  s_waitcnt vmcnt(0)
  s_mul_i32 s21, s49, 393216
  s_mul_i32 s22, s42, 12288
  s_add_u32 s50, s21, s22
  s_mul_i32 s21, s49, 98304
  s_mul_i32 s22, s42, 3072
  s_add_u32 s51, s21, s22
  s_lshr_b32 s22, s49, 1
  s_lshr_b32 s21, s49, 2
  s_add_u32 s21, s21, 3
  s_cmp_lt_u32 s49, 12
  s_cselect_b32 s21, s22, s21
  s_lshl_b32 s21, s21, 3
  s_lshr_b32 s22, s42, 2
  s_add_u32 s21, s21, s22
  s_lshl_b32 s21, s21, 7
  s_add_u32 s76, s21, 0
  s_lshl_b32 s77, s42, 7
  s_add_u32 s77, s77, 19456
  s_add_u32 s23, s49, 1
  s_waitcnt vmcnt(6)
  v_cmp_gt_u32 vcc, s23, v21
  s_mov_b32 s80, 0
  s_nop 0
  s_cbranch_vccnz qk_253
  s_mov_b32 s80, 1
  buffer_load_dwordx4 a[240:243], v31, s[52:55], s51 offen offset:0 sc1
  buffer_load_dwordx4 a[244:247], v31, s[52:55], s51 offen offset:512 sc1
  buffer_load_dwordx4 a[248:251], v31, s[52:55], s51 offen offset:1024 sc1
  buffer_load_dwordx4 a[252:255], v31, s[52:55], s51 offen offset:1536 sc1
  buffer_load_dwordx4 v[24:27], v31, s[52:55], s51 offen offset:2048 sc1
  buffer_load_dwordx4 v[6:9], v31, s[52:55], s51 offen offset:2560 sc1
qk_253:
  s_cmp_ge_u32 s79, 8
  s_cbranch_scc1 qk_252
  v_mov_b32 v156, 0
  s_mov_b32 s101, 0
wf_254:
  buffer_load_dword v157, v156, s[72:75], s76 offen sc1
  s_add_u32 s101, s101, 1
  s_cmp_gt_u32 s101, 131072
  s_cbranch_scc1 main_end
  s_waitcnt vmcnt(0)
  v_readfirstlane_b32 s100, v157
  s_cmp_ge_u32 s100, 8
  s_cbranch_scc1 wf_255
  s_sleep 2
  s_branch wf_254
wf_255:
  s_add_u32 s21, s50, 0
  buffer_load_dwordx4 v[36:39], v30, s[16:19], s21 offen offset:0 sc1
  buffer_load_dwordx4 v[40:43], v30, s[16:19], s21 offen offset:1024 sc1
  buffer_load_dwordx4 v[44:47], v30, s[16:19], s21 offen offset:2048 sc1
  buffer_load_dwordx4 v[48:51], v30, s[16:19], s21 offen offset:3072 sc1
  s_add_u32 s21, s50, 4096
  buffer_load_dwordx4 v[52:55], v30, s[16:19], s21 offen offset:0 sc1
  buffer_load_dwordx4 v[56:59], v30, s[16:19], s21 offen offset:1024 sc1
  buffer_load_dwordx4 v[60:63], v30, s[16:19], s21 offen offset:2048 sc1
  buffer_load_dwordx4 v[236:239], v30, s[16:19], s21 offen offset:3072 sc1
  s_add_u32 s21, s50, 8192
  buffer_load_dwordx4 v[240:243], v30, s[16:19], s21 offen offset:0 sc1
  buffer_load_dwordx4 v[244:247], v30, s[16:19], s21 offen offset:1024 sc1
  buffer_load_dwordx4 v[248:251], v30, s[16:19], s21 offen offset:2048 sc1
  buffer_load_dwordx4 v[252:255], v30, s[16:19], s21 offen offset:3072 sc1
qk_252:
  s_waitcnt lgkmcnt(0)
  s_barrier
  ds_read_b128 v[64:67], v29 offset:0
  ds_read_b128 v[68:71], v29 offset:64
  ds_read_b128 v[72:75], v29 offset:128
  ds_read_b128 v[76:79], v29 offset:192
  ds_read_b128 v[80:83], v29 offset:256
  ds_read_b128 v[84:87], v29 offset:320
  ds_read_b128 v[88:91], v29 offset:6400
  ds_read_b128 v[92:95], v29 offset:6464
  ds_read_b128 v[96:99], v29 offset:6528
  ds_read_b128 v[100:103], v29 offset:6592
  ds_read_b128 v[104:107], v29 offset:6656
  ds_read_b128 v[108:111], v29 offset:6720
  s_waitcnt lgkmcnt(0)
  s_cmp_eq_u32 s80, 1
  s_cselect_b32 s21, s79, 0
  s_cmp_ge_u32 s21, 8
  s_cbranch_scc1 qw_256
  s_waitcnt vmcnt(0)
qw_256:
  v_mfma_f32_16x16x32_bf16 v[112:115], v[36:39], v[64:67], 0
  v_mfma_f32_16x16x32_bf16 v[120:123], v[36:39], v[88:91], 0
  v_mfma_f32_16x16x32_bf16 v[124:127], v[60:63], v[88:91], 0
  v_mfma_f32_16x16x32_bf16 v[112:115], v[40:43], v[68:71], v[112:115]
  v_mfma_f32_16x16x32_bf16 v[120:123], v[40:43], v[92:95], v[120:123]
  v_mfma_f32_16x16x32_bf16 v[124:127], v[236:239], v[92:95], v[124:127]
  v_mfma_f32_16x16x32_bf16 v[112:115], v[44:47], v[72:75], v[112:115]
  v_mfma_f32_16x16x32_bf16 v[120:123], v[44:47], v[96:99], v[120:123]
  v_mfma_f32_16x16x32_bf16 v[124:127], v[240:243], v[96:99], v[124:127]
  v_mfma_f32_16x16x32_bf16 v[112:115], v[48:51], v[76:79], v[112:115]
  v_mfma_f32_16x16x32_bf16 v[120:123], v[48:51], v[100:103], v[120:123]
  v_mfma_f32_16x16x32_bf16 v[124:127], v[244:247], v[100:103], v[124:127]
  v_mfma_f32_16x16x32_bf16 v[112:115], v[52:55], v[80:83], v[112:115]
  v_mfma_f32_16x16x32_bf16 v[120:123], v[52:55], v[104:107], v[120:123]
  v_mfma_f32_16x16x32_bf16 v[124:127], v[248:251], v[104:107], v[124:127]
  v_mfma_f32_16x16x32_bf16 v[112:115], v[56:59], v[84:87], v[112:115]
  v_mfma_f32_16x16x32_bf16 v[120:123], v[56:59], v[108:111], v[120:123]
  v_mfma_f32_16x16x32_bf16 v[124:127], v[252:255], v[108:111], v[124:127]
  s_cmp_eq_u32 s80, 1
  s_cbranch_scc1 qm_257
  s_add_u32 s23, s49, 1
  s_mov_b32 s101, 0
wm_258:
  buffer_load_dword v156, v33, s[72:75], s77 offen sc1
  s_add_u32 s101, s101, 1
  s_cmp_gt_u32 s101, 131072
  s_cbranch_scc1 main_end
  s_waitcnt vmcnt(0)
  v_cmp_gt_u32 vcc, s23, v156
  v_readfirstlane_b32 s100, v156
  s_nop 0
  s_cbranch_vccz wm_259
  s_sleep 16
  s_add_u32 s100, s100, 2
  s_cmp_ge_u32 s100, s23
  s_cbranch_scc1 wm_258
  s_sleep 90
  s_branch wm_258
wm_259:
  buffer_load_dwordx4 a[240:243], v31, s[52:55], s51 offen offset:0 sc1
  buffer_load_dwordx4 a[244:247], v31, s[52:55], s51 offen offset:512 sc1
  buffer_load_dwordx4 a[248:251], v31, s[52:55], s51 offen offset:1024 sc1
  buffer_load_dwordx4 a[252:255], v31, s[52:55], s51 offen offset:1536 sc1
  buffer_load_dwordx4 v[24:27], v31, s[52:55], s51 offen offset:2048 sc1
  buffer_load_dwordx4 v[6:9], v31, s[52:55], s51 offen offset:2560 sc1
qm_257:
  s_waitcnt vmcnt(0)
  v_mfma_f32_16x16x32_bf16 v[116:119], a[240:243], v[64:67], 0
  v_mfma_f32_16x16x32_bf16 v[128:131], a[240:243], v[88:91], 0
  v_mfma_f32_16x16x32_bf16 v[116:119], a[244:247], v[68:71], v[116:119]
  v_mfma_f32_16x16x32_bf16 v[128:131], a[244:247], v[92:95], v[128:131]
  v_mfma_f32_16x16x32_bf16 v[116:119], a[248:251], v[72:75], v[116:119]
  v_mfma_f32_16x16x32_bf16 v[128:131], a[248:251], v[96:99], v[128:131]
  v_mfma_f32_16x16x32_bf16 v[116:119], a[252:255], v[76:79], v[116:119]
  v_mfma_f32_16x16x32_bf16 v[128:131], a[252:255], v[100:103], v[128:131]
  v_mfma_f32_16x16x32_bf16 v[116:119], v[24:27], v[80:83], v[116:119]
  v_mfma_f32_16x16x32_bf16 v[128:131], v[24:27], v[104:107], v[128:131]
  v_mfma_f32_16x16x32_bf16 v[116:119], v[6:9], v[84:87], v[116:119]
  v_mfma_f32_16x16x32_bf16 v[128:131], v[6:9], v[108:111], v[128:131]
qx_250:
  s_lshl_b32 s21, s49, 5
  s_add_u32 s21, s21, s42
  s_mul_i32 s81, s21, 2560
  s_lshl_b32 s82, s49, 3
  s_and_b32 s21, s42, 7
  s_add_u32 s82, s82, s21
  s_lshl_b32 s82, s82, 7
  s_add_u32 s82, s82, 23552
  s_cmp_gt_u32 s26, 1
  s_cselect_b32 s21, s80, 0
  s_cmp_eq_u32 s21, 0
  s_cbranch_scc1 qi_261
  v_mov_b32 v36, v112
  v_mov_b32 v37, v113
  v_mov_b32 v38, v114
  v_mov_b32 v39, v115
  v_mov_b32 v40, v116
  v_mov_b32 v41, v117
  v_mov_b32 v42, v118
  v_mov_b32 v43, v119
  v_mov_b32 v44, v120
  v_mov_b32 v45, v121
  v_mov_b32 v46, v122
  v_mov_b32 v47, v123
  v_mov_b32 v48, v124
  v_mov_b32 v49, v125
  v_mov_b32 v50, v126
  v_mov_b32 v51, v127
  v_mov_b32 v52, v128
  v_mov_b32 v53, v129
  v_mov_b32 v54, v130
  v_mov_b32 v55, v131
  s_branch qd_260
qi_261:
  v_cndmask_b32 v112, v34, v112, s[64:65]
  v_cndmask_b32 v124, v34, v124, s[64:65]
  v_cndmask_b32 v113, v34, v113, s[66:67]
  v_cndmask_b32 v125, v34, v125, s[66:67]
  v_cndmask_b32 v114, v34, v114, s[68:69]
  v_cndmask_b32 v126, v34, v126, s[68:69]
  v_cndmask_b32 v115, v34, v115, s[70:71]
  v_cndmask_b32 v127, v34, v127, s[70:71]
  v_max3_f32 v156, v112, v113, v114
  v_max3_f32 v156, v156, v115, v116
  v_max3_f32 v156, v156, v117, v118
  v_max_f32 v156, v156, v119
  v_mov_b32 v157, v156
  s_nop 1
  v_permlane32_swap_b32 v156, v157
  v_max_f32 v156, v156, v157
  v_mov_b32 v157, v156
  s_nop 1
  v_permlane16_swap_b32 v156, v157
  v_max_f32 v156, v156, v157
  v_mul_f32 v156, s83, v156
  v_fma_f32 v112, v112, s83, -v156
  v_fma_f32 v113, v113, s83, -v156
  v_fma_f32 v114, v114, s83, -v156
  v_fma_f32 v115, v115, s83, -v156
  v_fma_f32 v116, v116, s83, -v156
  v_fma_f32 v117, v117, s83, -v156
  v_fma_f32 v118, v118, s83, -v156
  v_fma_f32 v119, v119, s83, -v156
  v_exp_f32 v112, v112
  v_exp_f32 v113, v113
  v_exp_f32 v114, v114
  v_exp_f32 v115, v115
  v_exp_f32 v116, v116
  v_exp_f32 v117, v117
  v_exp_f32 v118, v118
  v_exp_f32 v119, v119
  s_nop 0
  v_add_f32 v156, v116, v117
  v_add_f32 v156, v156, v118
  v_add_f32 v156, v156, v119
  v_cndmask_b32 v156, 0, v156, s[60:61]
  v_add_f32 v156, v156, v112
  v_add_f32 v156, v156, v113
  v_add_f32 v156, v156, v114
  v_add_f32 v156, v156, v115
  v_mov_b32 v157, v156
  s_nop 1
  v_permlane32_swap_b32 v156, v157
  v_add_f32 v156, v156, v157
  v_mov_b32 v157, v156
  s_nop 1
  v_permlane16_swap_b32 v156, v157
  v_add_f32 v156, v156, v157
  v_rcp_f32 v156, v156
  s_nop 0
  v_mul_f32 v112, v112, v156
  v_mul_f32 v113, v113, v156
  v_mul_f32 v114, v114, v156
  v_mul_f32 v115, v115, v156
  v_mul_f32 v116, v116, v156
  v_mul_f32 v117, v117, v156
  v_mul_f32 v118, v118, v156
  v_mul_f32 v119, v119, v156
  v_max3_f32 v156, v120, v121, v122
  v_max3_f32 v156, v156, v123, v124
  v_max3_f32 v156, v156, v125, v126
  v_max3_f32 v156, v156, v127, v128
  v_max3_f32 v156, v156, v129, v130
  v_max_f32 v156, v156, v131
  v_mov_b32 v157, v156
  s_nop 1
  v_permlane32_swap_b32 v156, v157
  v_max_f32 v156, v156, v157
  v_mov_b32 v157, v156
  s_nop 1
  v_permlane16_swap_b32 v156, v157
  v_max_f32 v156, v156, v157
  v_mul_f32 v156, s83, v156
  v_fma_f32 v120, v120, s83, -v156
  v_fma_f32 v121, v121, s83, -v156
  v_fma_f32 v122, v122, s83, -v156
  v_fma_f32 v123, v123, s83, -v156
  v_fma_f32 v124, v124, s83, -v156
  v_fma_f32 v125, v125, s83, -v156
  v_fma_f32 v126, v126, s83, -v156
  v_fma_f32 v127, v127, s83, -v156
  v_fma_f32 v128, v128, s83, -v156
  v_fma_f32 v129, v129, s83, -v156
  v_fma_f32 v130, v130, s83, -v156
  v_fma_f32 v131, v131, s83, -v156
  v_exp_f32 v120, v120
  v_exp_f32 v121, v121
  v_exp_f32 v122, v122
  v_exp_f32 v123, v123
  v_exp_f32 v124, v124
  v_exp_f32 v125, v125
  v_exp_f32 v126, v126
  v_exp_f32 v127, v127
  v_exp_f32 v128, v128
  v_exp_f32 v129, v129
  v_exp_f32 v130, v130
  v_exp_f32 v131, v131
  s_nop 0
  v_add_f32 v156, v128, v129
  v_add_f32 v156, v156, v130
  v_add_f32 v156, v156, v131
  v_cndmask_b32 v156, 0, v156, s[60:61]
  v_add_f32 v156, v156, v120
  v_add_f32 v156, v156, v121
  v_add_f32 v156, v156, v122
  v_add_f32 v156, v156, v123
  v_add_f32 v156, v156, v124
  v_add_f32 v156, v156, v125
  v_add_f32 v156, v156, v126
  v_add_f32 v156, v156, v127
  v_mov_b32 v157, v156
  s_nop 1
  v_permlane32_swap_b32 v156, v157
  v_add_f32 v156, v156, v157
  v_mov_b32 v157, v156
  s_nop 1
  v_permlane16_swap_b32 v156, v157
  v_add_f32 v156, v156, v157
  v_rcp_f32 v156, v156
  s_nop 0
  v_mul_f32 v120, v120, v156
  v_mul_f32 v121, v121, v156
  v_mul_f32 v122, v122, v156
  v_mul_f32 v123, v123, v156
  v_mul_f32 v124, v124, v156
  v_mul_f32 v125, v125, v156
  v_mul_f32 v126, v126, v156
  v_mul_f32 v127, v127, v156
  v_mul_f32 v128, v128, v156
  v_mul_f32 v129, v129, v156
  v_mul_f32 v130, v130, v156
  v_mul_f32 v131, v131, v156
  v_cvt_pk_bf16_f32 v196, v116, v117
  v_cvt_pk_bf16_f32 v197, v118, v119
  v_cvt_pk_bf16_f32 v198, v128, v129
  v_cvt_pk_bf16_f32 v199, v130, v131
  v_cvt_pk_bf16_f32 v192, v120, v121
  v_cvt_pk_bf16_f32 v193, v122, v123
  v_cvt_pk_bf16_f32 v194, v124, v125
  v_cvt_pk_bf16_f32 v195, v126, v127
  v_cvt_pk_bf16_f32 v200, v112, v113
  v_cvt_pk_bf16_f32 v201, v114, v115
  v_permlane16_swap_b32 v196, v198
  v_permlane16_swap_b32 v197, v199
  buffer_store_dwordx4 v[192:195], v30, s[56:59], s81 offen sc1
  s_mov_b64 exec, 0xffffffff
  buffer_store_dwordx4 v[196:199], v30, s[56:59], s81 offen offset:1024 sc1
  s_mov_b64 exec, -1
  buffer_store_dwordx2 v[200:201], v32, s[56:59], s81 offen offset:2048 sc1
  s_mov_b32 s78, s82
  s_mov_b32 s81, 0x80000000
  s_mov_b32 s82, 0
  s_cmp_eq_u32 s80, 1
  s_cbranch_scc1 qd_260
  s_waitcnt vmcnt(0)
  s_cmp_eq_u32 s78, 0
  s_cbranch_scc1 pf_262
  v_mov_b32 v4, 0
  v_mov_b32 v5, 1
  s_mov_b64 exec, 1
  buffer_atomic_add v5, v4, s[72:75], s78 offen sc1
  s_mov_b64 exec, -1
  s_mov_b32 s78, 0
pf_262:
qd_260:
  s_add_u32 s49, s49, s29
qbe_249:
  s_sub_u32 s26, s26, 1
  s_cmp_gt_u32 s26, 0
  s_waitcnt lgkmcnt(0)
  s_cbranch_scc1 qa_blk_247
  s_waitcnt vmcnt(0) lgkmcnt(0)
  s_cmp_eq_u32 s78, 0
  s_cbranch_scc1 pf_263
  v_mov_b32 v4, 0
  v_mov_b32 v5, 1
  s_mov_b64 exec, 1
  buffer_atomic_add v5, v4, s[72:75], s78 offen sc1
  s_mov_b64 exec, -1
  s_mov_b32 s78, 0
pf_263:
  s_branch q_done
q_final:
  s_mov_b32 s16, s38
  s_mov_b32 s17, s39
  s_mov_b32 s18, 50331648
  s_mov_b32 s19, 0x00020000
  s_add_u32 s52, s38, 50331648
  s_addc_u32 s53, s39, 0
  s_mov_b32 s54, 6291456
  s_mov_b32 s55, 0x00020000
  s_add_u32 s56, s38, 85983232
  s_addc_u32 s57, s39, 0
  s_mov_b32 s58, 5242880
  s_mov_b32 s59, 0x00020000
  s_mul_i32 s21, s20, 12800
  s_add_u32 s21, s21, 98304
  v_mul_u32_u24 v4, 400, v2
  v_lshlrev_b32 v5, 4, v3
  v_add3_u32 v29, v4, v5, s21
  v_lshlrev_b32 v30, 4, v1
  v_and_b32 v4, 1, v2
  v_bfe_u32 v5, v2, 1, 1
  v_lshl_or_b32 v4, v5, 2, v4
  v_bfe_u32 v5, v2, 2, 1
  v_lshl_or_b32 v4, v5, 1, v4
  v_lshlrev_b32 v4, 4, v4
  v_lshl_add_u32 v31, v3, 7, v4
  v_lshlrev_b32 v32, 3, v1
  v_and_b32 v4, 3, v1
  v_lshlrev_b32 v33, 3, v4
  v_mov_b32 v34, 0xf149f2ca
  v_lshlrev_b32 v4, 2, v3
  v_sub_u32 v35, v2, v4
  v_cmp_gt_u32 s[60:61], 2, v3
  s_mov_b32 s62, 0x3d93cd3a
  s_mov_b32 s63, 0x3fb8aa3b
  s_mov_b32 s83, 0x3dd53b95
  v_cmp_le_i32 s[64:65], 0, v35
  v_cmp_le_i32 s[66:67], 1, v35
  v_cmp_le_i32 s[68:69], 2, v35
  v_cmp_le_i32 s[70:71], 3, v35
  s_add_u32 s49, s20, 52
  s_mov_b32 s29, 4
  s_mov_b32 s78, 0
  s_add_u32 s12, s38, 57671680
  s_addc_u32 s13, s39, 0
  s_mov_b32 s14, 4718592
  s_mov_b32 s15, 0x00020000
qf_264:
  s_mul_i32 s21, s49, 393216
  s_mul_i32 s22, s42, 12288
  s_add_u32 s50, s21, s22
  s_mul_i32 s21, s49, 98304
  s_mul_i32 s22, s42, 3072
  s_add_u32 s51, s21, s22
  s_lshr_b32 s22, s49, 1
  s_lshr_b32 s21, s49, 2
  s_add_u32 s21, s21, 3
  s_cmp_lt_u32 s49, 12
  s_cselect_b32 s21, s22, s21
  s_lshl_b32 s21, s21, 3
  s_lshr_b32 s22, s42, 2
  s_add_u32 s21, s21, s22
  s_lshl_b32 s21, s21, 7
  s_add_u32 s76, s21, 0
  s_lshl_b32 s77, s42, 7
  s_add_u32 s77, s77, 19456
  s_sub_u32 s43, s50, 20447232
  buffer_load_dword v21, v33, s[72:75], s77 offen sc1
  s_add_u32 s21, s50, 0
  buffer_load_dwordx4 v[36:39], v30, s[16:19], s21 offen offset:0 sc1
  buffer_load_dwordx4 v[40:43], v30, s[16:19], s21 offen offset:1024 sc1
  buffer_load_dwordx4 v[44:47], v30, s[16:19], s21 offen offset:2048 sc1
  buffer_load_dwordx4 v[48:51], v30, s[16:19], s21 offen offset:3072 sc1
  s_add_u32 s21, s50, 4096
  buffer_load_dwordx4 v[52:55], v30, s[16:19], s21 offen offset:0 sc1
  buffer_load_dwordx4 v[56:59], v30, s[16:19], s21 offen offset:1024 sc1
  buffer_load_dwordx4 v[60:63], v30, s[16:19], s21 offen offset:2048 sc1
  buffer_load_dwordx4 v[236:239], v30, s[16:19], s21 offen offset:3072 sc1
  s_add_u32 s21, s50, 8192
  buffer_load_dwordx4 v[240:243], v30, s[16:19], s21 offen offset:0 sc1
  buffer_load_dwordx4 v[244:247], v30, s[16:19], s21 offen offset:1024 sc1
  buffer_load_dwordx4 v[248:251], v30, s[16:19], s21 offen offset:2048 sc1
  buffer_load_dwordx4 v[252:255], v30, s[16:19], s21 offen offset:3072 sc1
  s_add_u32 s21, s43, 0
  buffer_load_dwordx4 v[64:67], v30, s[12:15], s21 offen offset:0 sc1
  buffer_load_dwordx4 v[68:71], v30, s[12:15], s21 offen offset:1024 sc1
  buffer_load_dwordx4 v[72:75], v30, s[12:15], s21 offen offset:2048 sc1
  buffer_load_dwordx4 v[76:79], v30, s[12:15], s21 offen offset:3072 sc1
  s_add_u32 s21, s43, 4096
  buffer_load_dwordx4 v[80:83], v30, s[12:15], s21 offen offset:0 sc1
  buffer_load_dwordx4 v[84:87], v30, s[12:15], s21 offen offset:1024 sc1
  buffer_load_dwordx4 v[88:91], v30, s[12:15], s21 offen offset:2048 sc1
  buffer_load_dwordx4 v[92:95], v30, s[12:15], s21 offen offset:3072 sc1
  s_add_u32 s21, s43, 8192
  buffer_load_dwordx4 v[96:99], v30, s[12:15], s21 offen offset:0 sc1
  buffer_load_dwordx4 v[100:103], v30, s[12:15], s21 offen offset:1024 sc1
  buffer_load_dwordx4 v[104:107], v30, s[12:15], s21 offen offset:2048 sc1
  buffer_load_dwordx4 v[108:111], v30, s[12:15], s21 offen offset:3072 sc1
  s_waitcnt vmcnt(24)
  s_cmp_eq_u32 s78, 0
  s_cbranch_scc1 pf_268
  v_mov_b32 v4, 0
  v_mov_b32 v5, 1
  s_mov_b64 exec, 1
  buffer_atomic_add v5, v4, s[72:75], s78 offen sc1
  s_mov_b64 exec, -1
  s_mov_b32 s78, 0
pf_268:
  s_add_u32 s23, s49, 1
  v_cmp_gt_u32 vcc, s23, v21
  s_mov_b32 s80, 0
  s_nop 0
  s_cbranch_vccnz qk_267
  s_mov_b32 s80, 1
  buffer_load_dwordx4 v[132:135], v31, s[52:55], s51 offen offset:0 sc1
  buffer_load_dwordx4 v[136:139], v31, s[52:55], s51 offen offset:512 sc1
  buffer_load_dwordx4 v[140:143], v31, s[52:55], s51 offen offset:1024 sc1
  buffer_load_dwordx4 v[144:147], v31, s[52:55], s51 offen offset:1536 sc1
  buffer_load_dwordx4 v[148:151], v31, s[52:55], s51 offen offset:2048 sc1
  buffer_load_dwordx4 v[152:155], v31, s[52:55], s51 offen offset:2560 sc1
  s_waitcnt vmcnt(6)
  s_branch qk_267x
qk_267:
  s_waitcnt vmcnt(0)
qk_267x:
  v_mfma_f32_16x16x32_bf16 v[112:115], v[36:39], v[64:67], 0
  v_mfma_f32_16x16x32_bf16 v[120:123], v[36:39], v[88:91], 0
  v_mfma_f32_16x16x32_bf16 v[124:127], v[60:63], v[88:91], 0
  v_mfma_f32_16x16x32_bf16 v[112:115], v[40:43], v[68:71], v[112:115]
  v_mfma_f32_16x16x32_bf16 v[120:123], v[40:43], v[92:95], v[120:123]
  v_mfma_f32_16x16x32_bf16 v[124:127], v[236:239], v[92:95], v[124:127]
  v_mfma_f32_16x16x32_bf16 v[112:115], v[44:47], v[72:75], v[112:115]
  v_mfma_f32_16x16x32_bf16 v[120:123], v[44:47], v[96:99], v[120:123]
  v_mfma_f32_16x16x32_bf16 v[124:127], v[240:243], v[96:99], v[124:127]
  v_mfma_f32_16x16x32_bf16 v[112:115], v[48:51], v[76:79], v[112:115]
  v_mfma_f32_16x16x32_bf16 v[120:123], v[48:51], v[100:103], v[120:123]
  v_mfma_f32_16x16x32_bf16 v[124:127], v[244:247], v[100:103], v[124:127]
  v_mfma_f32_16x16x32_bf16 v[112:115], v[52:55], v[80:83], v[112:115]
  v_mfma_f32_16x16x32_bf16 v[120:123], v[52:55], v[104:107], v[120:123]
  v_mfma_f32_16x16x32_bf16 v[124:127], v[248:251], v[104:107], v[124:127]
  v_mfma_f32_16x16x32_bf16 v[112:115], v[56:59], v[84:87], v[112:115]
  v_mfma_f32_16x16x32_bf16 v[120:123], v[56:59], v[108:111], v[120:123]
  v_mfma_f32_16x16x32_bf16 v[124:127], v[252:255], v[108:111], v[124:127]
  s_cmp_eq_u32 s80, 1
  s_cbranch_scc1 qm_269
  s_add_u32 s23, s49, 1
  s_min_u32 s22, s49, 61
  s_cmp_lt_u32 s49, 58
  s_cselect_b32 s23, s23, s22
  s_mov_b32 s101, 0
wm_270:
  buffer_load_dword v156, v33, s[72:75], s77 offen sc1
  s_add_u32 s101, s101, 1
  s_cmp_gt_u32 s101, 131072
  s_cbranch_scc1 main_end
  s_waitcnt vmcnt(0)
  v_cmp_gt_u32 vcc, s23, v156
  v_readfirstlane_b32 s100, v156
  s_nop 0
  s_cbranch_vccz wm_271
  s_sleep 16
  s_add_u32 s100, s100, 2
  s_cmp_ge_u32 s100, s23
  s_cbranch_scc1 wm_270
  s_sleep 90
  s_branch wm_270
wm_271:
  s_cmp_eq_u32 s49, 63
  s_cselect_b32 s21, s101, 0
  s_cmp_lt_u32 s21, 2
  s_cbranch_scc1 qtz_274
  s_sleep 36
qtz_274:
  s_mov_b32 s101, 0
  s_branch qtp_273
qtp_272:
  s_sleep 3
qtp_273:
  buffer_load_dwordx4 v[132:135], v31, s[52:55], s51 offen offset:0 sc1
  buffer_load_dwordx4 v[136:139], v31, s[52:55], s51 offen offset:512 sc1
  buffer_load_dwordx4 v[140:143], v31, s[52:55], s51 offen offset:1024 sc1
  buffer_load_dwordx4 v[144:147], v31, s[52:55], s51 offen offset:1536 sc1
  buffer_load_dwordx4 v[148:151], v31, s[52:55], s51 offen offset:2048 sc1
  buffer_load_dwordx4 v[152:155], v31, s[52:55], s51 offen offset:2560 sc1
  s_add_u32 s101, s101, 1
  s_cmp_gt_u32 s101, 131072
  s_cbranch_scc1 main_end
  s_waitcnt vmcnt(0)
  v_max3_u32 v156, v132, v134, v136
  v_max3_u32 v156, v156, v138, v140
  v_max3_u32 v156, v156, v142, v144
  v_max3_u32 v156, v156, v146, v148
  v_max3_u32 v156, v156, v150, v152
  v_max3_u32 v156, v156, v154, v154
  v_cmp_eq_u32 vcc, -1, v156
  s_nop 1
  s_cbranch_vccnz qtp_272
qm_269:
  s_waitcnt vmcnt(0)
  v_mfma_f32_16x16x32_bf16 v[116:119], v[132:135], v[64:67], 0
  v_mfma_f32_16x16x32_bf16 v[128:131], v[132:135], v[88:91], 0
  v_mfma_f32_16x16x32_bf16 v[116:119], v[136:139], v[68:71], v[116:119]
  v_mfma_f32_16x16x32_bf16 v[128:131], v[136:139], v[92:95], v[128:131]
  v_mfma_f32_16x16x32_bf16 v[116:119], v[140:143], v[72:75], v[116:119]
  v_mfma_f32_16x16x32_bf16 v[128:131], v[140:143], v[96:99], v[128:131]
  v_mfma_f32_16x16x32_bf16 v[116:119], v[144:147], v[76:79], v[116:119]
  v_mfma_f32_16x16x32_bf16 v[128:131], v[144:147], v[100:103], v[128:131]
  v_mfma_f32_16x16x32_bf16 v[116:119], v[148:151], v[80:83], v[116:119]
  v_mfma_f32_16x16x32_bf16 v[128:131], v[148:151], v[104:107], v[128:131]
  v_mfma_f32_16x16x32_bf16 v[116:119], v[152:155], v[84:87], v[116:119]
  v_mfma_f32_16x16x32_bf16 v[128:131], v[152:155], v[108:111], v[128:131]
qx_266:
  s_lshl_b32 s21, s49, 5
  s_add_u32 s21, s21, s42
  s_mul_i32 s81, s21, 2560
  s_lshl_b32 s82, s49, 3
  s_and_b32 s21, s42, 7
  s_add_u32 s82, s82, s21
  s_lshl_b32 s82, s82, 7
  s_add_u32 s82, s82, 23552
  v_cndmask_b32 v112, v34, v112, s[64:65]
  v_cndmask_b32 v124, v34, v124, s[64:65]
  v_cndmask_b32 v113, v34, v113, s[66:67]
  v_cndmask_b32 v125, v34, v125, s[66:67]
  v_cndmask_b32 v114, v34, v114, s[68:69]
  v_cndmask_b32 v126, v34, v126, s[68:69]
  v_cndmask_b32 v115, v34, v115, s[70:71]
  v_cndmask_b32 v127, v34, v127, s[70:71]
  v_max3_f32 v156, v112, v113, v114
  v_max3_f32 v156, v156, v115, v116
  v_max3_f32 v156, v156, v117, v118
  v_max_f32 v156, v156, v119
  v_mov_b32 v157, v156
  s_nop 1
  v_permlane32_swap_b32 v156, v157
  v_max_f32 v156, v156, v157
  v_mov_b32 v157, v156
  s_nop 1
  v_permlane16_swap_b32 v156, v157
  v_max_f32 v156, v156, v157
  v_mul_f32 v156, s83, v156
  v_fma_f32 v112, v112, s83, -v156
  v_fma_f32 v113, v113, s83, -v156
  v_fma_f32 v114, v114, s83, -v156
  v_fma_f32 v115, v115, s83, -v156
  v_fma_f32 v116, v116, s83, -v156
  v_fma_f32 v117, v117, s83, -v156
  v_fma_f32 v118, v118, s83, -v156
  v_fma_f32 v119, v119, s83, -v156
  v_exp_f32 v112, v112
  v_exp_f32 v113, v113
  v_exp_f32 v114, v114
  v_exp_f32 v115, v115
  v_exp_f32 v116, v116
  v_exp_f32 v117, v117
  v_exp_f32 v118, v118
  v_exp_f32 v119, v119
  s_nop 0
  v_add_f32 v156, v116, v117
  v_add_f32 v156, v156, v118
  v_add_f32 v156, v156, v119
  v_cndmask_b32 v156, 0, v156, s[60:61]
  v_add_f32 v156, v156, v112
  v_add_f32 v156, v156, v113
  v_add_f32 v156, v156, v114
  v_add_f32 v156, v156, v115
  v_mov_b32 v157, v156
  s_nop 1
  v_permlane32_swap_b32 v156, v157
  v_add_f32 v156, v156, v157
  v_mov_b32 v157, v156
  s_nop 1
  v_permlane16_swap_b32 v156, v157
  v_add_f32 v156, v156, v157
  v_rcp_f32 v156, v156
  s_nop 0
  v_mul_f32 v112, v112, v156
  v_mul_f32 v113, v113, v156
  v_mul_f32 v114, v114, v156
  v_mul_f32 v115, v115, v156
  v_mul_f32 v116, v116, v156
  v_mul_f32 v117, v117, v156
  v_mul_f32 v118, v118, v156
  v_mul_f32 v119, v119, v156
  v_max3_f32 v156, v120, v121, v122
  v_max3_f32 v156, v156, v123, v124
  v_max3_f32 v156, v156, v125, v126
  v_max3_f32 v156, v156, v127, v128
  v_max3_f32 v156, v156, v129, v130
  v_max_f32 v156, v156, v131
  v_mov_b32 v157, v156
  s_nop 1
  v_permlane32_swap_b32 v156, v157
  v_max_f32 v156, v156, v157
  v_mov_b32 v157, v156
  s_nop 1
  v_permlane16_swap_b32 v156, v157
  v_max_f32 v156, v156, v157
  v_mul_f32 v156, s83, v156
  v_fma_f32 v120, v120, s83, -v156
  v_fma_f32 v121, v121, s83, -v156
  v_fma_f32 v122, v122, s83, -v156
  v_fma_f32 v123, v123, s83, -v156
  v_fma_f32 v124, v124, s83, -v156
  v_fma_f32 v125, v125, s83, -v156
  v_fma_f32 v126, v126, s83, -v156
  v_fma_f32 v127, v127, s83, -v156
  v_fma_f32 v128, v128, s83, -v156
  v_fma_f32 v129, v129, s83, -v156
  v_fma_f32 v130, v130, s83, -v156
  v_fma_f32 v131, v131, s83, -v156
  v_exp_f32 v120, v120
  v_exp_f32 v121, v121
  v_exp_f32 v122, v122
  v_exp_f32 v123, v123
  v_exp_f32 v124, v124
  v_exp_f32 v125, v125
  v_exp_f32 v126, v126
  v_exp_f32 v127, v127
  v_exp_f32 v128, v128
  v_exp_f32 v129, v129
  v_exp_f32 v130, v130
  v_exp_f32 v131, v131
  s_nop 0
  v_add_f32 v156, v128, v129
  v_add_f32 v156, v156, v130
  v_add_f32 v156, v156, v131
  v_cndmask_b32 v156, 0, v156, s[60:61]
  v_add_f32 v156, v156, v120
  v_add_f32 v156, v156, v121
  v_add_f32 v156, v156, v122
  v_add_f32 v156, v156, v123
  v_add_f32 v156, v156, v124
  v_add_f32 v156, v156, v125
  v_add_f32 v156, v156, v126
  v_add_f32 v156, v156, v127
  v_mov_b32 v157, v156
  s_nop 1
  v_permlane32_swap_b32 v156, v157
  v_add_f32 v156, v156, v157
  v_mov_b32 v157, v156
  s_nop 1
  v_permlane16_swap_b32 v156, v157
  v_add_f32 v156, v156, v157
  v_rcp_f32 v156, v156
  s_nop 0
  v_mul_f32 v120, v120, v156
  v_mul_f32 v121, v121, v156
  v_mul_f32 v122, v122, v156
  v_mul_f32 v123, v123, v156
  v_mul_f32 v124, v124, v156
  v_mul_f32 v125, v125, v156
  v_mul_f32 v126, v126, v156
  v_mul_f32 v127, v127, v156
  v_mul_f32 v128, v128, v156
  v_mul_f32 v129, v129, v156
  v_mul_f32 v130, v130, v156
  v_mul_f32 v131, v131, v156
  v_cvt_pk_bf16_f32 v196, v116, v117
  v_cvt_pk_bf16_f32 v197, v118, v119
  v_cvt_pk_bf16_f32 v198, v128, v129
  v_cvt_pk_bf16_f32 v199, v130, v131
  v_cvt_pk_bf16_f32 v192, v120, v121
  v_cvt_pk_bf16_f32 v193, v122, v123
  v_cvt_pk_bf16_f32 v194, v124, v125
  v_cvt_pk_bf16_f32 v195, v126, v127
  v_cvt_pk_bf16_f32 v200, v112, v113
  v_cvt_pk_bf16_f32 v201, v114, v115
  v_permlane16_swap_b32 v196, v198
  v_permlane16_swap_b32 v197, v199
  buffer_store_dwordx4 v[192:195], v30, s[56:59], s81 offen sc1
  s_mov_b64 exec, 0xffffffff
  buffer_store_dwordx4 v[196:199], v30, s[56:59], s81 offen offset:1024 sc1
  s_mov_b64 exec, -1
  buffer_store_dwordx2 v[200:201], v32, s[56:59], s81 offen offset:2048 sc1
  s_mov_b32 s78, s82
  s_mov_b32 s81, 0x80000000
  s_mov_b32 s82, 0
  s_cmp_eq_u32 s80, 1
  s_cbranch_scc1 qd_275
  s_waitcnt vmcnt(0)
  s_cmp_eq_u32 s78, 0
  s_cbranch_scc1 pf_276
  v_mov_b32 v4, 0
  v_mov_b32 v5, 1
  s_mov_b64 exec, 1
  buffer_atomic_add v5, v4, s[72:75], s78 offen sc1
  s_mov_b64 exec, -1
  s_mov_b32 s78, 0
pf_276:
qd_275:
  s_add_u32 s49, s49, s29
qbe_265:
  s_cmp_lt_u32 s49, 64
  s_cbranch_scc1 qf_264
  s_waitcnt vmcnt(0)
  s_cmp_eq_u32 s78, 0
  s_cbranch_scc1 pf_277
  v_mov_b32 v4, 0
  v_mov_b32 v5, 1
  s_mov_b64 exec, 1
  buffer_atomic_add v5, v4, s[72:75], s78 offen sc1
  s_mov_b64 exec, -1
  s_mov_b32 s78, 0
pf_277:
  s_branch queue
q_done:
  s_and_b32 s21, s3, 3
  s_cmp_lt_u32 s21, 2
  s_cbranch_scc1 queue
  s_sub_u32 s21, s21, 2
  s_lshl_b32 s21, s21, 3
  s_bfe_u32 s22, s3, 0x30002
  s_add_u32 s21, s21, s22
  s_add_u32 s87, s21, 236
  s_branch tail_item
queue:
  s_load_dwordx2 s[4:5], s[0:1], 96
  s_waitcnt lgkmcnt(0)
  s_mov_b32 s32, s4
  s_mov_b32 s33, s5
  s_mov_b32 s34, 256
  s_mov_b32 s35, 0x00020000
  s_waitcnt vmcnt(0) lgkmcnt(0)
  s_barrier
  s_mov_b32 s2, s85
  s_mov_b32 s85, -1
  s_cmp_lg_u32 s2, -1
  s_cbranch_scc1 queue_c
  v_mov_b32 v21, 0
  s_cmp_lg_u32 s20, 0
  s_cbranch_scc1 q_278
  v_mov_b32 v22, 80
  v_mov_b32 v23, 1
  s_mov_b64 exec, 1
  buffer_atomic_add v23, v22, s[32:35], 0 offen sc0 sc1
  s_waitcnt vmcnt(0)
queue_a:
  ds_write_b32 v21, v23
  s_waitcnt lgkmcnt(0)
  s_mov_b64 exec, -1
q_278:
queue_b:
  s_barrier
  ds_read_b32 v23, v21
  s_waitcnt lgkmcnt(0)
  v_readfirstlane_b32 s2, v23
  s_barrier
queue_c:
  s_add_u32 s21, s2, 0
  s_cmp_lt_u32 s2, 144
  s_cbranch_scc1 do_pv
  s_sub_u32 s2, s2, 144
  s_add_u32 s21, s2, 164
  s_cmp_lt_u32 s2, 40
  s_cbranch_scc1 do_pv
  s_sub_u32 s2, s2, 40
  s_add_u32 s21, s2, 144
  s_cmp_lt_u32 s2, 20
  s_cbranch_scc1 do_pv
  s_sub_u32 s2, s2, 20
  s_add_u32 s21, s2, 204
  s_cmp_lt_u32 s2, 32
  s_cbranch_scc1 do_pv
  s_sub_u32 s2, s2, 32
  s_branch main_fin
do_opb:
  s_mov_b32 s87, -1
do_opb2:
  s_mov_b32 s2, s21
  s_load_dwordx2 s[4:5], s[0:1], 0
  s_load_dwordx4 s[40:43], s[0:1], 72
  s_load_dwordx2 s[38:39], s[0:1], 104
  s_lshl_b32 s59, s2, 2
  s_add_u32 s59, s59, s20
  s_lshl_b32 s59, s59, 3
  v_lshlrev_b32 v4, 4, v1
  v_lshlrev_b32 v5, 2, v1
  s_waitcnt lgkmcnt(0)
  s_mov_b32 s8, s4
  s_mov_b32 s9, s5
  s_mov_b32 s10, 2621440
  s_mov_b32 s11, 0x00020000
  s_mov_b32 s12, s42
  s_mov_b32 s13, s43
  s_mov_b32 s14, 1280
  s_mov_b32 s15, 0x00020000
  s_mov_b32 s24, s40
  s_mov_b32 s25, s41
  s_mov_b32 s26, 819200
  s_mov_b32 s27, 0x00020000
  s_add_u32 s16, s38, 70713344
  s_addc_u32 s17, s39, 0
  s_mov_b32 s18, 2641920
  s_mov_b32 s19, 0x00020000
  s_add_u32 s28, s38, 81002496
  s_addc_u32 s29, s39, 0
  s_mov_b32 s30, 8192
  s_mov_b32 s31, 0x00020000
  s_add_u32 s72, s38, 81068032
  s_addc_u32 s73, s39, 0
  s_mov_b32 s74, 116736
  s_mov_b32 s75, 0x00020000
  s_mov_b32 s21, 91136
  v_mov_b32 v20, 0
  buffer_load_dword v21, v20, s[72:75], s21 offen sc1
  v_mov_b32 v29, 3277
  s_mul_i32 s21, s20, 320
  s_add_u32 s21, s21, 0
  v_add_u32 v22, s21, v1
  v_mul_u32_u24 v23, v22, v29
  v_lshrrev_b32 v23, 16, v23
  v_mul_u32_u24 v24, 20, v23
  v_sub_u32 v22, v22, v24
  v_bfe_u32 v24, v23, 3, 1
  v_lshlrev_b32 v24, 1, v24
  v_xor_b32 v22, v22, v24
  v_mul_u32_u24 v23, 1280, v23
  v_lshl_add_u32 v8, v22, 4, v23
  s_mul_i32 s21, s20, 320
  s_add_u32 s21, s21, 64
  v_add_u32 v22, s21, v1
  v_mul_u32_u24 v23, v22, v29
  v_lshrrev_b32 v23, 16, v23
  v_mul_u32_u24 v24, 20, v23
  v_sub_u32 v22, v22, v24
  v_bfe_u32 v24, v23, 3, 1
  v_lshlrev_b32 v24, 1, v24
  v_xor_b32 v22, v22, v24
  v_mul_u32_u24 v23, 1280, v23
  v_lshl_add_u32 v9, v22, 4, v23
  s_mul_i32 s21, s20, 320
  s_add_u32 s21, s21, 128
  v_add_u32 v22, s21, v1
  v_mul_u32_u24 v23, v22, v29
  v_lshrrev_b32 v23, 16, v23
  v_mul_u32_u24 v24, 20, v23
  v_sub_u32 v22, v22, v24
  v_bfe_u32 v24, v23, 3, 1
  v_lshlrev_b32 v24, 1, v24
  v_xor_b32 v22, v22, v24
  v_mul_u32_u24 v23, 1280, v23
  v_lshl_add_u32 v10, v22, 4, v23
  s_mul_i32 s21, s20, 320
  s_add_u32 s21, s21, 192
  v_add_u32 v22, s21, v1
  v_mul_u32_u24 v23, v22, v29
  v_lshrrev_b32 v23, 16, v23
  v_mul_u32_u24 v24, 20, v23
  v_sub_u32 v22, v22, v24
  v_bfe_u32 v24, v23, 3, 1
  v_lshlrev_b32 v24, 1, v24
  v_xor_b32 v22, v22, v24
  v_mul_u32_u24 v23, 1280, v23
  v_lshl_add_u32 v11, v22, 4, v23
  s_mul_i32 s21, s20, 320
  s_add_u32 s21, s21, 256
  v_add_u32 v22, s21, v1
  v_mul_u32_u24 v23, v22, v29
  v_lshrrev_b32 v23, 16, v23
  v_mul_u32_u24 v24, 20, v23
  v_sub_u32 v22, v22, v24
  v_bfe_u32 v24, v23, 3, 1
  v_lshlrev_b32 v24, 1, v24
  v_xor_b32 v22, v22, v24
  v_mul_u32_u24 v23, 1280, v23
  v_lshl_add_u32 v12, v22, 4, v23
  s_and_b32 s44, s2, 3
  s_mul_i32 s45, s44, 320
  s_mul_i32 s46, s20, 5120
  v_and_b32 v22, 1, v2
  v_mul_u32_u24 v22, 16512, v22
  v_mul_u32_u24 v23, 33024, v3
  v_lshrrev_b32 v24, 1, v2
  v_lshlrev_b32 v24, 4, v24
  v_add3_u32 v6, v22, v23, v24
  s_lshr_b32 s47, s2, 2
  s_lshl_b32 s47, s47, 2
  s_add_u32 s47, s47, s20
  s_lshl_b32 s47, s47, 1
  s_lshl_b32 s48, s47, 7
  v_lshrrev_b32 v22, 2, v2
  v_lshl_add_u32 v22, v3, 3, v22
  v_mul_u32_u24 v22, 320, v22
  v_and_b32 v23, 3, v2
  v_lshl_add_u32 v22, v23, 3, v22
  v_and_b32 v23, 1, v3
  v_lshlrev_b32 v23, 5, v23
  v_add_u32 v14, v22, v23
  v_sub_u32 v15, v22, v23
  v_add_u32 v16, 61440, v14
  v_add_u32 v17, 61440, v15
  v_add_u32 v18, 122880, v14
  v_add_u32 v19, 122880, v15
  s_add_u32 m0, s46, 0
  s_add_u32 s49, s45, 0
  s_nop 0
  buffer_load_dwordx4 v8, s[24:27], s49 offen lds
  s_add_u32 m0, s46, 1024
  s_nop 0
  buffer_load_dwordx4 v9, s[24:27], s49 offen lds
  s_add_u32 m0, s46, 2048
  s_nop 0
  buffer_load_dwordx4 v10, s[24:27], s49 offen lds
  s_add_u32 m0, s46, 3072
  s_nop 0
  buffer_load_dwordx4 v11, s[24:27], s49 offen lds
  s_add_u32 m0, s46, 4096
  s_nop 0
  buffer_load_dwordx4 v12, s[24:27], s49 offen lds
  s_add_u32 m0, s46, 20480
  s_add_u32 s49, s45, 81920
  s_nop 0
  buffer_load_dwordx4 v8, s[24:27], s49 offen lds
  s_add_u32 m0, s46, 21504
  s_nop 0
  buffer_load_dwordx4 v9, s[24:27], s49 offen lds
  s_add_u32 m0, s46, 22528
  s_nop 0
  buffer_load_dwordx4 v10, s[24:27], s49 offen lds
  s_add_u32 m0, s46, 23552
  s_nop 0
  buffer_load_dwordx4 v11, s[24:27], s49 offen lds
  s_add_u32 m0, s46, 24576
  s_nop 0
  buffer_load_dwordx4 v12, s[24:27], s49 offen lds
  s_waitcnt vmcnt(10)
  v_readfirstlane_b32 s21, v21
  s_cmp_ge_u32 s21, 32
  s_cbranch_scc1 o2_279
  s_mov_b32 s21, 91136
  v_mov_b32 v20, 0
  s_mov_b32 s101, 0
wf_280:
  buffer_load_dword v21, v20, s[72:75], s21 offen sc1
  s_add_u32 s101, s101, 1
  s_cmp_gt_u32 s101, 131072
  s_cbranch_scc1 main_end
  s_waitcnt vmcnt(0)
  v_readfirstlane_b32 s100, v21
  s_cmp_ge_u32 s100, 32
  s_cbranch_scc1 wf_281
  s_sleep 32
  s_branch wf_280
wf_281:
o2_279:
  buffer_load_dwordx4 a[0:3], v6, s[16:19], s48 offen offset:0 sc1
  buffer_load_dwordx4 a[4:7], v6, s[16:19], s48 offen offset:128 sc1
  s_add_u32 s48, s48, 132096
  buffer_load_dwordx4 a[8:11], v6, s[16:19], s48 offen offset:0 sc1
  buffer_load_dwordx4 a[12:15], v6, s[16:19], s48 offen offset:128 sc1
  s_add_u32 s48, s48, 132096
  buffer_load_dwordx4 a[16:19], v6, s[16:19], s48 offen offset:0 sc1
  buffer_load_dwordx4 a[20:23], v6, s[16:19], s48 offen offset:128 sc1
  s_add_u32 s48, s48, 132096
  buffer_load_dwordx4 a[24:27], v6, s[16:19], s48 offen offset:0 sc1
  buffer_load_dwordx4 a[28:31], v6, s[16:19], s48 offen offset:128 sc1
  s_add_u32 s48, s48, 132096
  s_add_u32 m0, s46, 40960
  s_add_u32 s49, s45, 163840
  s_nop 0
  buffer_load_dwordx4 v8, s[24:27], s49 offen lds
  s_add_u32 m0, s46, 41984
  s_nop 0
  buffer_load_dwordx4 v9, s[24:27], s49 offen lds
  s_add_u32 m0, s46, 43008
  s_nop 0
  buffer_load_dwordx4 v10, s[24:27], s49 offen lds
  s_add_u32 m0, s46, 44032
  s_nop 0
  buffer_load_dwordx4 v11, s[24:27], s49 offen lds
  s_add_u32 m0, s46, 45056
  s_nop 0
  buffer_load_dwordx4 v12, s[24:27], s49 offen lds
  buffer_load_dwordx4 a[32:35], v6, s[16:19], s48 offen offset:0 sc1
  buffer_load_dwordx4 a[36:39], v6, s[16:19], s48 offen offset:128 sc1
  s_add_u32 s48, s48, 132096
  buffer_load_dwordx4 a[40:43], v6, s[16:19], s48 offen offset:0 sc1
  buffer_load_dwordx4 a[44:47], v6, s[16:19], s48 offen offset:128 sc1
  s_add_u32 s48, s48, 132096
  s_add_u32 m0, s46, 61440
  s_add_u32 s49, s45, 245760
  s_nop 0
  buffer_load_dwordx4 v8, s[24:27], s49 offen lds
  s_add_u32 m0, s46, 62464
  s_nop 0
  buffer_load_dwordx4 v9, s[24:27], s49 offen lds
  s_add_u32 m0, s46, 63488
  s_nop 0
  buffer_load_dwordx4 v10, s[24:27], s49 offen lds
  s_add_u32 m0, s46, 64512
  s_nop 0
  buffer_load_dwordx4 v11, s[24:27], s49 offen lds
  s_add_u32 m0, s46, 65536
  s_nop 0
  buffer_load_dwordx4 v12, s[24:27], s49 offen lds
  buffer_load_dwordx4 a[48:51], v6, s[16:19], s48 offen offset:0 sc1
  buffer_load_dwordx4 a[52:55], v6, s[16:19], s48 offen offset:128 sc1
  s_add_u32 s48, s48, 132096
  buffer_load_dwordx4 a[56:59], v6, s[16:19], s48 offen offset:0 sc1
  buffer_load_dwordx4 a[60:63], v6, s[16:19], s48 offen offset:128 sc1
  s_add_u32 s48, s48, 132096
  s_add_u32 m0, s46, 81920
  s_add_u32 s49, s45, 327680
  s_nop 0
  buffer_load_dwordx4 v8, s[24:27], s49 offen lds
  s_add_u32 m0, s46, 82944
  s_nop 0
  buffer_load_dwordx4 v9, s[24:27], s49 offen lds
  s_add_u32 m0, s46, 83968
  s_nop 0
  buffer_load_dwordx4 v10, s[24:27], s49 offen lds
  s_add_u32 m0, s46, 84992
  s_nop 0
  buffer_load_dwordx4 v11, s[24:27], s49 offen lds
  s_add_u32 m0, s46, 86016
  s_nop 0
  buffer_load_dwordx4 v12, s[24:27], s49 offen lds
  buffer_load_dwordx4 a[64:67], v6, s[16:19], s48 offen offset:0 sc1
  buffer_load_dwordx4 a[68:71], v6, s[16:19], s48 offen offset:128 sc1
  s_add_u32 s48, s48, 132096
  buffer_load_dwordx4 a[72:75], v6, s[16:19], s48 offen offset:0 sc1
  buffer_load_dwordx4 a[76:79], v6, s[16:19], s48 offen offset:128 sc1
  s_add_u32 s48, s48, 132096
  s_add_u32 m0, s46, 102400
  s_add_u32 s49, s45, 409600
  s_nop 0
  buffer_load_dwordx4 v8, s[24:27], s49 offen lds
  s_add_u32 m0, s46, 103424
  s_nop 0
  buffer_load_dwordx4 v9, s[24:27], s49 offen lds
  s_add_u32 m0, s46, 104448
  s_nop 0
  buffer_load_dwordx4 v10, s[24:27], s49 offen lds
  s_add_u32 m0, s46, 105472
  s_nop 0
  buffer_load_dwordx4 v11, s[24:27], s49 offen lds
  s_add_u32 m0, s46, 106496
  s_nop 0
  buffer_load_dwordx4 v12, s[24:27], s49 offen lds
  s_add_u32 m0, s46, 122880
  s_add_u32 s49, s45, 491520
  s_nop 0
  buffer_load_dwordx4 v8, s[24:27], s49 offen lds
  s_add_u32 m0, s46, 123904
  s_nop 0
  buffer_load_dwordx4 v9, s[24:27], s49 offen lds
  s_add_u32 m0, s46, 124928
  s_nop 0
  buffer_load_dwordx4 v10, s[24:27], s49 offen lds
  s_add_u32 m0, s46, 125952
  s_nop 0
  buffer_load_dwordx4 v11, s[24:27], s49 offen lds
  s_add_u32 m0, s46, 126976
  s_nop 0
  buffer_load_dwordx4 v12, s[24:27], s49 offen lds
  s_waitcnt vmcnt(50)
  s_barrier
  ds_read_b64_tr_b16 v[144:145], v14 offset:0
  ds_read_b64_tr_b16 v[146:147], v14 offset:1280
  ds_read_b64_tr_b16 v[148:149], v15 offset:32
  ds_read_b64_tr_b16 v[150:151], v15 offset:1312
  ds_read_b64_tr_b16 v[152:153], v14 offset:64
  ds_read_b64_tr_b16 v[154:155], v14 offset:1344
  ds_read_b64_tr_b16 v[156:157], v15 offset:96
  ds_read_b64_tr_b16 v[158:159], v15 offset:1376
  ds_read_b64_tr_b16 v[160:161], v14 offset:128
  ds_read_b64_tr_b16 v[162:163], v14 offset:1408
  ds_read_b64_tr_b16 v[164:165], v15 offset:160
  ds_read_b64_tr_b16 v[166:167], v15 offset:1440
  ds_read_b64_tr_b16 v[168:169], v14 offset:192
  ds_read_b64_tr_b16 v[170:171], v14 offset:1472
  ds_read_b64_tr_b16 v[172:173], v15 offset:224
  ds_read_b64_tr_b16 v[174:175], v15 offset:1504
  ds_read_b64_tr_b16 v[176:177], v14 offset:256
  ds_read_b64_tr_b16 v[178:179], v14 offset:1536
  ds_read_b64_tr_b16 v[180:181], v15 offset:288
  ds_read_b64_tr_b16 v[182:183], v15 offset:1568
  s_waitcnt lgkmcnt(0) vmcnt(43)
  v_mfma_f32_16x16x32_bf16 v[64:67], v[144:147], a[0:3], 0
  ds_read_b64_tr_b16 v[184:185], v14 offset:10240
  ds_read_b64_tr_b16 v[186:187], v14 offset:11520
  v_mfma_f32_16x16x32_bf16 v[104:107], v[144:147], a[4:7], 0
  ds_read_b64_tr_b16 v[188:189], v15 offset:10272
  v_mfma_f32_16x16x32_bf16 v[68:71], v[148:151], a[0:3], 0
  ds_read_b64_tr_b16 v[190:191], v15 offset:11552
  v_mfma_f32_16x16x32_bf16 v[108:111], v[148:151], a[4:7], 0
  ds_read_b64_tr_b16 v[192:193], v14 offset:10304
  v_mfma_f32_16x16x32_bf16 v[72:75], v[152:155], a[0:3], 0
  ds_read_b64_tr_b16 v[194:195], v14 offset:11584
  v_mfma_f32_16x16x32_bf16 v[112:115], v[152:155], a[4:7], 0
  ds_read_b64_tr_b16 v[196:197], v15 offset:10336
  ds_read_b64_tr_b16 v[198:199], v15 offset:11616
  v_mfma_f32_16x16x32_bf16 v[76:79], v[156:159], a[0:3], 0
  ds_read_b64_tr_b16 v[200:201], v14 offset:10368
  v_mfma_f32_16x16x32_bf16 v[116:119], v[156:159], a[4:7], 0
  ds_read_b64_tr_b16 v[202:203], v14 offset:11648
  v_mfma_f32_16x16x32_bf16 v[80:83], v[160:163], a[0:3], 0
  ds_read_b64_tr_b16 v[204:205], v15 offset:10400
  v_mfma_f32_16x16x32_bf16 v[120:123], v[160:163], a[4:7], 0
  ds_read_b64_tr_b16 v[206:207], v15 offset:11680
  v_mfma_f32_16x16x32_bf16 v[84:87], v[164:167], a[0:3], 0
  ds_read_b64_tr_b16 v[208:209], v14 offset:10432
  v_mfma_f32_16x16x32_bf16 v[124:127], v[164:167], a[4:7], 0
  ds_read_b64_tr_b16 v[210:211], v14 offset:11712
  ds_read_b64_tr_b16 v[212:213], v15 offset:10464
  v_mfma_f32_16x16x32_bf16 v[88:91], v[168:171], a[0:3], 0
  ds_read_b64_tr_b16 v[214:215], v15 offset:11744
  v_mfma_f32_16x16x32_bf16 v[128:131], v[168:171], a[4:7], 0
  buffer_load_dwordx4 a[80:83], v6, s[16:19], s48 offen offset:0 sc1
  ds_read_b64_tr_b16 v[216:217], v14 offset:10496
  v_mfma_f32_16x16x32_bf16 v[92:95], v[172:175], a[0:3], 0
  ds_read_b64_tr_b16 v[218:219], v14 offset:11776
  v_mfma_f32_16x16x32_bf16 v[132:135], v[172:175], a[4:7], 0
  ds_read_b64_tr_b16 v[220:221], v15 offset:10528
  v_mfma_f32_16x16x32_bf16 v[96:99], v[176:179], a[0:3], 0
  ds_read_b64_tr_b16 v[222:223], v15 offset:11808
  v_mfma_f32_16x16x32_bf16 v[136:139], v[176:179], a[4:7], 0
  buffer_load_dwordx4 a[84:87], v6, s[16:19], s48 offen offset:128 sc1
  v_mfma_f32_16x16x32_bf16 v[100:103], v[180:183], a[0:3], 0
  s_add_u32 s48, s48, 132096
  v_mfma_f32_16x16x32_bf16 v[140:143], v[180:183], a[4:7], 0
  s_waitcnt lgkmcnt(0) vmcnt(43)
  s_barrier
  v_mfma_f32_16x16x32_bf16 v[64:67], v[184:187], a[8:11], v[64:67]
  s_add_u32 m0, s46, 0
  ds_read_b64_tr_b16 v[144:145], v14 offset:20480
  ds_read_b64_tr_b16 v[146:147], v14 offset:21760
  v_mfma_f32_16x16x32_bf16 v[104:107], v[184:187], a[12:15], v[104:107]
  s_add_u32 s49, s45, 573440
  ds_read_b64_tr_b16 v[148:149], v15 offset:20512
  v_mfma_f32_16x16x32_bf16 v[68:71], v[188:191], a[8:11], v[68:71]
  buffer_load_dwordx4 v8, s[24:27], s49 offen lds
  ds_read_b64_tr_b16 v[150:151], v15 offset:21792
  v_mfma_f32_16x16x32_bf16 v[108:111], v[188:191], a[12:15], v[108:111]
  s_add_u32 m0, s46, 1024
  ds_read_b64_tr_b16 v[152:153], v14 offset:20544
  v_mfma_f32_16x16x32_bf16 v[72:75], v[192:195], a[8:11], v[72:75]
  buffer_load_dwordx4 v9, s[24:27], s49 offen lds
  ds_read_b64_tr_b16 v[154:155], v14 offset:21824
  v_mfma_f32_16x16x32_bf16 v[112:115], v[192:195], a[12:15], v[112:115]
  s_add_u32 m0, s46, 2048
  ds_read_b64_tr_b16 v[156:157], v15 offset:20576
  ds_read_b64_tr_b16 v[158:159], v15 offset:21856
  v_mfma_f32_16x16x32_bf16 v[76:79], v[196:199], a[8:11], v[76:79]
  buffer_load_dwordx4 v10, s[24:27], s49 offen lds
  ds_read_b64_tr_b16 v[160:161], v14 offset:20608
  v_mfma_f32_16x16x32_bf16 v[116:119], v[196:199], a[12:15], v[116:119]
  s_add_u32 m0, s46, 3072
  ds_read_b64_tr_b16 v[162:163], v14 offset:21888
  v_mfma_f32_16x16x32_bf16 v[80:83], v[200:203], a[8:11], v[80:83]
  buffer_load_dwordx4 v11, s[24:27], s49 offen lds
  ds_read_b64_tr_b16 v[164:165], v15 offset:20640
  v_mfma_f32_16x16x32_bf16 v[120:123], v[200:203], a[12:15], v[120:123]
  s_add_u32 m0, s46, 4096
  ds_read_b64_tr_b16 v[166:167], v15 offset:21920
  v_mfma_f32_16x16x32_bf16 v[84:87], v[204:207], a[8:11], v[84:87]
  buffer_load_dwordx4 v12, s[24:27], s49 offen lds
  ds_read_b64_tr_b16 v[168:169], v14 offset:20672
  v_mfma_f32_16x16x32_bf16 v[124:127], v[204:207], a[12:15], v[124:127]
  ds_read_b64_tr_b16 v[170:171], v14 offset:21952
  ds_read_b64_tr_b16 v[172:173], v15 offset:20704
  v_mfma_f32_16x16x32_bf16 v[88:91], v[208:211], a[8:11], v[88:91]
  ds_read_b64_tr_b16 v[174:175], v15 offset:21984
  v_mfma_f32_16x16x32_bf16 v[128:131], v[208:211], a[12:15], v[128:131]
  buffer_load_dwordx4 a[88:91], v6, s[16:19], s48 offen offset:0 sc1
  ds_read_b64_tr_b16 v[176:177], v14 offset:20736
  v_mfma_f32_16x16x32_bf16 v[92:95], v[212:215], a[8:11], v[92:95]
  ds_read_b64_tr_b16 v[178:179], v14 offset:22016
  v_mfma_f32_16x16x32_bf16 v[132:135], v[212:215], a[12:15], v[132:135]
  ds_read_b64_tr_b16 v[180:181], v15 offset:20768
  v_mfma_f32_16x16x32_bf16 v[96:99], v[216:219], a[8:11], v[96:99]
  ds_read_b64_tr_b16 v[182:183], v15 offset:22048
  v_mfma_f32_16x16x32_bf16 v[136:139], v[216:219], a[12:15], v[136:139]
  buffer_load_dwordx4 a[92:95], v6, s[16:19], s48 offen offset:128 sc1
  v_mfma_f32_16x16x32_bf16 v[100:103], v[220:223], a[8:11], v[100:103]
  s_add_u32 s48, s48, 132096
  v_mfma_f32_16x16x32_bf16 v[140:143], v[220:223], a[12:15], v[140:143]
  s_waitcnt lgkmcnt(0) vmcnt(48)
  v_mfma_f32_16x16x32_bf16 v[64:67], v[144:147], a[16:19], v[64:67]
  ds_read_b64_tr_b16 v[184:185], v14 offset:30720
  ds_read_b64_tr_b16 v[186:187], v14 offset:32000
  v_mfma_f32_16x16x32_bf16 v[104:107], v[144:147], a[20:23], v[104:107]
  ds_read_b64_tr_b16 v[188:189], v15 offset:30752
  v_mfma_f32_16x16x32_bf16 v[68:71], v[148:151], a[16:19], v[68:71]
  ds_read_b64_tr_b16 v[190:191], v15 offset:32032
  v_mfma_f32_16x16x32_bf16 v[108:111], v[148:151], a[20:23], v[108:111]
  ds_read_b64_tr_b16 v[192:193], v14 offset:30784
  v_mfma_f32_16x16x32_bf16 v[72:75], v[152:155], a[16:19], v[72:75]
  ds_read_b64_tr_b16 v[194:195], v14 offset:32064
  v_mfma_f32_16x16x32_bf16 v[112:115], v[152:155], a[20:23], v[112:115]
  ds_read_b64_tr_b16 v[196:197], v15 offset:30816
  ds_read_b64_tr_b16 v[198:199], v15 offset:32096
  v_mfma_f32_16x16x32_bf16 v[76:79], v[156:159], a[16:19], v[76:79]
  ds_read_b64_tr_b16 v[200:201], v14 offset:30848
  v_mfma_f32_16x16x32_bf16 v[116:119], v[156:159], a[20:23], v[116:119]
  ds_read_b64_tr_b16 v[202:203], v14 offset:32128
  v_mfma_f32_16x16x32_bf16 v[80:83], v[160:163], a[16:19], v[80:83]
  ds_read_b64_tr_b16 v[204:205], v15 offset:30880
  v_mfma_f32_16x16x32_bf16 v[120:123], v[160:163], a[20:23], v[120:123]
  ds_read_b64_tr_b16 v[206:207], v15 offset:32160
  v_mfma_f32_16x16x32_bf16 v[84:87], v[164:167], a[16:19], v[84:87]
  ds_read_b64_tr_b16 v[208:209], v14 offset:30912
  v_mfma_f32_16x16x32_bf16 v[124:127], v[164:167], a[20:23], v[124:127]
  ds_read_b64_tr_b16 v[210:211], v14 offset:32192
  ds_read_b64_tr_b16 v[212:213], v15 offset:30944
  v_mfma_f32_16x16x32_bf16 v[88:91], v[168:171], a[16:19], v[88:91]
  ds_read_b64_tr_b16 v[214:215], v15 offset:32224
  v_mfma_f32_16x16x32_bf16 v[128:131], v[168:171], a[20:23], v[128:131]
  buffer_load_dwordx4 a[96:99], v6, s[16:19], s48 offen offset:0 sc1
  ds_read_b64_tr_b16 v[216:217], v14 offset:30976
  v_mfma_f32_16x16x32_bf16 v[92:95], v[172:175], a[16:19], v[92:95]
  ds_read_b64_tr_b16 v[218:219], v14 offset:32256
  v_mfma_f32_16x16x32_bf16 v[132:135], v[172:175], a[20:23], v[132:135]
  ds_read_b64_tr_b16 v[220:221], v15 offset:31008
  v_mfma_f32_16x16x32_bf16 v[96:99], v[176:179], a[16:19], v[96:99]
  ds_read_b64_tr_b16 v[222:223], v15 offset:32288
  v_mfma_f32_16x16x32_bf16 v[136:139], v[176:179], a[20:23], v[136:139]
  buffer_load_dwordx4 a[100:103], v6, s[16:19], s48 offen offset:128 sc1
  v_mfma_f32_16x16x32_bf16 v[100:103], v[180:183], a[16:19], v[100:103]
  s_add_u32 s48, s48, 132096
  v_mfma_f32_16x16x32_bf16 v[140:143], v[180:183], a[20:23], v[140:143]
  s_waitcnt lgkmcnt(0) vmcnt(43)
  s_barrier
  v_mfma_f32_16x16x32_bf16 v[64:67], v[184:187], a[24:27], v[64:67]
  s_add_u32 m0, s46, 20480
  ds_read_b64_tr_b16 v[144:145], v14 offset:40960
  ds_read_b64_tr_b16 v[146:147], v14 offset:42240
  v_mfma_f32_16x16x32_bf16 v[104:107], v[184:187], a[28:31], v[104:107]
  s_add_u32 s49, s45, 655360
  ds_read_b64_tr_b16 v[148:149], v15 offset:40992
  v_mfma_f32_16x16x32_bf16 v[68:71], v[188:191], a[24:27], v[68:71]
  buffer_load_dwordx4 v8, s[24:27], s49 offen lds
  ds_read_b64_tr_b16 v[150:151], v15 offset:42272
  v_mfma_f32_16x16x32_bf16 v[108:111], v[188:191], a[28:31], v[108:111]
  s_add_u32 m0, s46, 21504
  ds_read_b64_tr_b16 v[152:153], v14 offset:41024
  v_mfma_f32_16x16x32_bf16 v[72:75], v[192:195], a[24:27], v[72:75]
  buffer_load_dwordx4 v9, s[24:27], s49 offen lds
  ds_read_b64_tr_b16 v[154:155], v14 offset:42304
  v_mfma_f32_16x16x32_bf16 v[112:115], v[192:195], a[28:31], v[112:115]
  s_add_u32 m0, s46, 22528
  ds_read_b64_tr_b16 v[156:157], v15 offset:41056
  ds_read_b64_tr_b16 v[158:159], v15 offset:42336
  v_mfma_f32_16x16x32_bf16 v[76:79], v[196:199], a[24:27], v[76:79]
  buffer_load_dwordx4 v10, s[24:27], s49 offen lds
  ds_read_b64_tr_b16 v[160:161], v14 offset:41088
  v_mfma_f32_16x16x32_bf16 v[116:119], v[196:199], a[28:31], v[116:119]
  s_add_u32 m0, s46, 23552
  ds_read_b64_tr_b16 v[162:163], v14 offset:42368
  v_mfma_f32_16x16x32_bf16 v[80:83], v[200:203], a[24:27], v[80:83]
  buffer_load_dwordx4 v11, s[24:27], s49 offen lds
  ds_read_b64_tr_b16 v[164:165], v15 offset:41120
  v_mfma_f32_16x16x32_bf16 v[120:123], v[200:203], a[28:31], v[120:123]
  s_add_u32 m0, s46, 24576
  ds_read_b64_tr_b16 v[166:167], v15 offset:42400
  v_mfma_f32_16x16x32_bf16 v[84:87], v[204:207], a[24:27], v[84:87]
  buffer_load_dwordx4 v12, s[24:27], s49 offen lds
  ds_read_b64_tr_b16 v[168:169], v14 offset:41152
  v_mfma_f32_16x16x32_bf16 v[124:127], v[204:207], a[28:31], v[124:127]
  ds_read_b64_tr_b16 v[170:171], v14 offset:42432
  ds_read_b64_tr_b16 v[172:173], v15 offset:41184
  v_mfma_f32_16x16x32_bf16 v[88:91], v[208:211], a[24:27], v[88:91]
  ds_read_b64_tr_b16 v[174:175], v15 offset:42464
  v_mfma_f32_16x16x32_bf16 v[128:131], v[208:211], a[28:31], v[128:131]
  buffer_load_dwordx4 a[104:107], v6, s[16:19], s48 offen offset:0 sc1
  ds_read_b64_tr_b16 v[176:177], v14 offset:41216
  v_mfma_f32_16x16x32_bf16 v[92:95], v[212:215], a[24:27], v[92:95]
  ds_read_b64_tr_b16 v[178:179], v14 offset:42496
  v_mfma_f32_16x16x32_bf16 v[132:135], v[212:215], a[28:31], v[132:135]
  ds_read_b64_tr_b16 v[180:181], v15 offset:41248
  v_mfma_f32_16x16x32_bf16 v[96:99], v[216:219], a[24:27], v[96:99]
  ds_read_b64_tr_b16 v[182:183], v15 offset:42528
  v_mfma_f32_16x16x32_bf16 v[136:139], v[216:219], a[28:31], v[136:139]
  buffer_load_dwordx4 a[108:111], v6, s[16:19], s48 offen offset:128 sc1
  v_mfma_f32_16x16x32_bf16 v[100:103], v[220:223], a[24:27], v[100:103]
  s_add_u32 s48, s48, 132096
  v_mfma_f32_16x16x32_bf16 v[140:143], v[220:223], a[28:31], v[140:143]
  s_waitcnt lgkmcnt(0) vmcnt(48)
  v_mfma_f32_16x16x32_bf16 v[64:67], v[144:147], a[32:35], v[64:67]
  ds_read_b64_tr_b16 v[184:185], v14 offset:51200
  ds_read_b64_tr_b16 v[186:187], v14 offset:52480
  v_mfma_f32_16x16x32_bf16 v[104:107], v[144:147], a[36:39], v[104:107]
  ds_read_b64_tr_b16 v[188:189], v15 offset:51232
  v_mfma_f32_16x16x32_bf16 v[68:71], v[148:151], a[32:35], v[68:71]
  ds_read_b64_tr_b16 v[190:191], v15 offset:52512
  v_mfma_f32_16x16x32_bf16 v[108:111], v[148:151], a[36:39], v[108:111]
  ds_read_b64_tr_b16 v[192:193], v14 offset:51264
  v_mfma_f32_16x16x32_bf16 v[72:75], v[152:155], a[32:35], v[72:75]
  ds_read_b64_tr_b16 v[194:195], v14 offset:52544
  v_mfma_f32_16x16x32_bf16 v[112:115], v[152:155], a[36:39], v[112:115]
  ds_read_b64_tr_b16 v[196:197], v15 offset:51296
  ds_read_b64_tr_b16 v[198:199], v15 offset:52576
  v_mfma_f32_16x16x32_bf16 v[76:79], v[156:159], a[32:35], v[76:79]
  ds_read_b64_tr_b16 v[200:201], v14 offset:51328
  v_mfma_f32_16x16x32_bf16 v[116:119], v[156:159], a[36:39], v[116:119]
  ds_read_b64_tr_b16 v[202:203], v14 offset:52608
  v_mfma_f32_16x16x32_bf16 v[80:83], v[160:163], a[32:35], v[80:83]
  ds_read_b64_tr_b16 v[204:205], v15 offset:51360
  v_mfma_f32_16x16x32_bf16 v[120:123], v[160:163], a[36:39], v[120:123]
  ds_read_b64_tr_b16 v[206:207], v15 offset:52640
  v_mfma_f32_16x16x32_bf16 v[84:87], v[164:167], a[32:35], v[84:87]
  ds_read_b64_tr_b16 v[208:209], v14 offset:51392
  v_mfma_f32_16x16x32_bf16 v[124:127], v[164:167], a[36:39], v[124:127]
  ds_read_b64_tr_b16 v[210:211], v14 offset:52672
  ds_read_b64_tr_b16 v[212:213], v15 offset:51424
  v_mfma_f32_16x16x32_bf16 v[88:91], v[168:171], a[32:35], v[88:91]
  ds_read_b64_tr_b16 v[214:215], v15 offset:52704
  v_mfma_f32_16x16x32_bf16 v[128:131], v[168:171], a[36:39], v[128:131]
  buffer_load_dwordx4 a[112:115], v6, s[16:19], s48 offen offset:0 sc1
  ds_read_b64_tr_b16 v[216:217], v14 offset:51456
  v_mfma_f32_16x16x32_bf16 v[92:95], v[172:175], a[32:35], v[92:95]
  ds_read_b64_tr_b16 v[218:219], v14 offset:52736
  v_mfma_f32_16x16x32_bf16 v[132:135], v[172:175], a[36:39], v[132:135]
  ds_read_b64_tr_b16 v[220:221], v15 offset:51488
  v_mfma_f32_16x16x32_bf16 v[96:99], v[176:179], a[32:35], v[96:99]
  ds_read_b64_tr_b16 v[222:223], v15 offset:52768
  v_mfma_f32_16x16x32_bf16 v[136:139], v[176:179], a[36:39], v[136:139]
  buffer_load_dwordx4 a[116:119], v6, s[16:19], s48 offen offset:128 sc1
  v_mfma_f32_16x16x32_bf16 v[100:103], v[180:183], a[32:35], v[100:103]
  s_add_u32 s48, s48, 132096
  v_mfma_f32_16x16x32_bf16 v[140:143], v[180:183], a[36:39], v[140:143]
  s_waitcnt lgkmcnt(0) vmcnt(43)
  s_barrier
  v_mfma_f32_16x16x32_bf16 v[64:67], v[184:187], a[40:43], v[64:67]
  s_add_u32 m0, s46, 40960
  ds_read_b64_tr_b16 v[144:145], v16 offset:0
  ds_read_b64_tr_b16 v[146:147], v16 offset:1280
  v_mfma_f32_16x16x32_bf16 v[104:107], v[184:187], a[44:47], v[104:107]
  s_add_u32 s49, s45, 737280
  ds_read_b64_tr_b16 v[148:149], v17 offset:32
  v_mfma_f32_16x16x32_bf16 v[68:71], v[188:191], a[40:43], v[68:71]
  buffer_load_dwordx4 v8, s[24:27], s49 offen lds
  ds_read_b64_tr_b16 v[150:151], v17 offset:1312
  v_mfma_f32_16x16x32_bf16 v[108:111], v[188:191], a[44:47], v[108:111]
  s_add_u32 m0, s46, 41984
  ds_read_b64_tr_b16 v[152:153], v16 offset:64
  v_mfma_f32_16x16x32_bf16 v[72:75], v[192:195], a[40:43], v[72:75]
  buffer_load_dwordx4 v9, s[24:27], s49 offen lds
  ds_read_b64_tr_b16 v[154:155], v16 offset:1344
  v_mfma_f32_16x16x32_bf16 v[112:115], v[192:195], a[44:47], v[112:115]
  s_add_u32 m0, s46, 43008
  ds_read_b64_tr_b16 v[156:157], v17 offset:96
  ds_read_b64_tr_b16 v[158:159], v17 offset:1376
  v_mfma_f32_16x16x32_bf16 v[76:79], v[196:199], a[40:43], v[76:79]
  buffer_load_dwordx4 v10, s[24:27], s49 offen lds
  ds_read_b64_tr_b16 v[160:161], v16 offset:128
  v_mfma_f32_16x16x32_bf16 v[116:119], v[196:199], a[44:47], v[116:119]
  s_add_u32 m0, s46, 44032
  ds_read_b64_tr_b16 v[162:163], v16 offset:1408
  v_mfma_f32_16x16x32_bf16 v[80:83], v[200:203], a[40:43], v[80:83]
  buffer_load_dwordx4 v11, s[24:27], s49 offen lds
  ds_read_b64_tr_b16 v[164:165], v17 offset:160
  v_mfma_f32_16x16x32_bf16 v[120:123], v[200:203], a[44:47], v[120:123]
  s_add_u32 m0, s46, 45056
  ds_read_b64_tr_b16 v[166:167], v17 offset:1440
  v_mfma_f32_16x16x32_bf16 v[84:87], v[204:207], a[40:43], v[84:87]
  buffer_load_dwordx4 v12, s[24:27], s49 offen lds
  ds_read_b64_tr_b16 v[168:169], v16 offset:192
  v_mfma_f32_16x16x32_bf16 v[124:127], v[204:207], a[44:47], v[124:127]
  ds_read_b64_tr_b16 v[170:171], v16 offset:1472
  ds_read_b64_tr_b16 v[172:173], v17 offset:224
  v_mfma_f32_16x16x32_bf16 v[88:91], v[208:211], a[40:43], v[88:91]
  ds_read_b64_tr_b16 v[174:175], v17 offset:1504
  v_mfma_f32_16x16x32_bf16 v[128:131], v[208:211], a[44:47], v[128:131]
  buffer_load_dwordx4 a[120:123], v6, s[16:19], s48 offen offset:0 sc1
  ds_read_b64_tr_b16 v[176:177], v16 offset:256
  v_mfma_f32_16x16x32_bf16 v[92:95], v[212:215], a[40:43], v[92:95]
  ds_read_b64_tr_b16 v[178:179], v16 offset:1536
  v_mfma_f32_16x16x32_bf16 v[132:135], v[212:215], a[44:47], v[132:135]
  ds_read_b64_tr_b16 v[180:181], v17 offset:288
  v_mfma_f32_16x16x32_bf16 v[96:99], v[216:219], a[40:43], v[96:99]
  ds_read_b64_tr_b16 v[182:183], v17 offset:1568
  v_mfma_f32_16x16x32_bf16 v[136:139], v[216:219], a[44:47], v[136:139]
  buffer_load_dwordx4 a[124:127], v6, s[16:19], s48 offen offset:128 sc1
  v_mfma_f32_16x16x32_bf16 v[100:103], v[220:223], a[40:43], v[100:103]
  s_add_u32 s48, s48, 132096
  v_mfma_f32_16x16x32_bf16 v[140:143], v[220:223], a[44:47], v[140:143]
  s_waitcnt lgkmcnt(0) vmcnt(48)
  v_mfma_f32_16x16x32_bf16 v[64:67], v[144:147], a[48:51], v[64:67]
  ds_read_b64_tr_b16 v[184:185], v16 offset:10240
  ds_read_b64_tr_b16 v[186:187], v16 offset:11520
  v_mfma_f32_16x16x32_bf16 v[104:107], v[144:147], a[52:55], v[104:107]
  ds_read_b64_tr_b16 v[188:189], v17 offset:10272
  v_mfma_f32_16x16x32_bf16 v[68:71], v[148:151], a[48:51], v[68:71]
  ds_read_b64_tr_b16 v[190:191], v17 offset:11552
  v_mfma_f32_16x16x32_bf16 v[108:111], v[148:151], a[52:55], v[108:111]
  ds_read_b64_tr_b16 v[192:193], v16 offset:10304
  v_mfma_f32_16x16x32_bf16 v[72:75], v[152:155], a[48:51], v[72:75]
  ds_read_b64_tr_b16 v[194:195], v16 offset:11584
  v_mfma_f32_16x16x32_bf16 v[112:115], v[152:155], a[52:55], v[112:115]
  ds_read_b64_tr_b16 v[196:197], v17 offset:10336
  ds_read_b64_tr_b16 v[198:199], v17 offset:11616
  v_mfma_f32_16x16x32_bf16 v[76:79], v[156:159], a[48:51], v[76:79]
  ds_read_b64_tr_b16 v[200:201], v16 offset:10368
  v_mfma_f32_16x16x32_bf16 v[116:119], v[156:159], a[52:55], v[116:119]
  ds_read_b64_tr_b16 v[202:203], v16 offset:11648
  v_mfma_f32_16x16x32_bf16 v[80:83], v[160:163], a[48:51], v[80:83]
  ds_read_b64_tr_b16 v[204:205], v17 offset:10400
  v_mfma_f32_16x16x32_bf16 v[120:123], v[160:163], a[52:55], v[120:123]
  ds_read_b64_tr_b16 v[206:207], v17 offset:11680
  v_mfma_f32_16x16x32_bf16 v[84:87], v[164:167], a[48:51], v[84:87]
  ds_read_b64_tr_b16 v[208:209], v16 offset:10432
  v_mfma_f32_16x16x32_bf16 v[124:127], v[164:167], a[52:55], v[124:127]
  ds_read_b64_tr_b16 v[210:211], v16 offset:11712
  ds_read_b64_tr_b16 v[212:213], v17 offset:10464
  v_mfma_f32_16x16x32_bf16 v[88:91], v[168:171], a[48:51], v[88:91]
  ds_read_b64_tr_b16 v[214:215], v17 offset:11744
  v_mfma_f32_16x16x32_bf16 v[128:131], v[168:171], a[52:55], v[128:131]
  buffer_load_dwordx4 a[128:131], v6, s[16:19], s48 offen offset:0 sc1
  ds_read_b64_tr_b16 v[216:217], v16 offset:10496
  v_mfma_f32_16x16x32_bf16 v[92:95], v[172:175], a[48:51], v[92:95]
  ds_read_b64_tr_b16 v[218:219], v16 offset:11776
  v_mfma_f32_16x16x32_bf16 v[132:135], v[172:175], a[52:55], v[132:135]
  ds_read_b64_tr_b16 v[220:221], v17 offset:10528
  v_mfma_f32_16x16x32_bf16 v[96:99], v[176:179], a[48:51], v[96:99]
  ds_read_b64_tr_b16 v[222:223], v17 offset:11808
  v_mfma_f32_16x16x32_bf16 v[136:139], v[176:179], a[52:55], v[136:139]
  buffer_load_dwordx4 a[132:135], v6, s[16:19], s48 offen offset:128 sc1
  v_mfma_f32_16x16x32_bf16 v[100:103], v[180:183], a[48:51], v[100:103]
  s_add_u32 s48, s48, 132096
  v_mfma_f32_16x16x32_bf16 v[140:143], v[180:183], a[52:55], v[140:143]
  s_waitcnt lgkmcnt(0) vmcnt(43)
  s_barrier
  v_mfma_f32_16x16x32_bf16 v[64:67], v[184:187], a[56:59], v[64:67]
  ds_read_b64_tr_b16 v[144:145], v16 offset:20480
  ds_read_b64_tr_b16 v[146:147], v16 offset:21760
  v_mfma_f32_16x16x32_bf16 v[104:107], v[184:187], a[60:63], v[104:107]
  ds_read_b64_tr_b16 v[148:149], v17 offset:20512
  v_mfma_f32_16x16x32_bf16 v[68:71], v[188:191], a[56:59], v[68:71]
  ds_read_b64_tr_b16 v[150:151], v17 offset:21792
  v_mfma_f32_16x16x32_bf16 v[108:111], v[188:191], a[60:63], v[108:111]
  ds_read_b64_tr_b16 v[152:153], v16 offset:20544
  v_mfma_f32_16x16x32_bf16 v[72:75], v[192:195], a[56:59], v[72:75]
  ds_read_b64_tr_b16 v[154:155], v16 offset:21824
  v_mfma_f32_16x16x32_bf16 v[112:115], v[192:195], a[60:63], v[112:115]
  ds_read_b64_tr_b16 v[156:157], v17 offset:20576
  ds_read_b64_tr_b16 v[158:159], v17 offset:21856
  v_mfma_f32_16x16x32_bf16 v[76:79], v[196:199], a[56:59], v[76:79]
  ds_read_b64_tr_b16 v[160:161], v16 offset:20608
  v_mfma_f32_16x16x32_bf16 v[116:119], v[196:199], a[60:63], v[116:119]
  ds_read_b64_tr_b16 v[162:163], v16 offset:21888
  v_mfma_f32_16x16x32_bf16 v[80:83], v[200:203], a[56:59], v[80:83]
  ds_read_b64_tr_b16 v[164:165], v17 offset:20640
  v_mfma_f32_16x16x32_bf16 v[120:123], v[200:203], a[60:63], v[120:123]
  ds_read_b64_tr_b16 v[166:167], v17 offset:21920
  v_mfma_f32_16x16x32_bf16 v[84:87], v[204:207], a[56:59], v[84:87]
  ds_read_b64_tr_b16 v[168:169], v16 offset:20672
  v_mfma_f32_16x16x32_bf16 v[124:127], v[204:207], a[60:63], v[124:127]
  ds_read_b64_tr_b16 v[170:171], v16 offset:21952
  ds_read_b64_tr_b16 v[172:173], v17 offset:20704
  v_mfma_f32_16x16x32_bf16 v[88:91], v[208:211], a[56:59], v[88:91]
  ds_read_b64_tr_b16 v[174:175], v17 offset:21984
  v_mfma_f32_16x16x32_bf16 v[128:131], v[208:211], a[60:63], v[128:131]
  buffer_load_dwordx4 a[136:139], v6, s[16:19], s48 offen offset:0 sc1
  ds_read_b64_tr_b16 v[176:177], v16 offset:20736
  v_mfma_f32_16x16x32_bf16 v[92:95], v[212:215], a[56:59], v[92:95]
  ds_read_b64_tr_b16 v[178:179], v16 offset:22016
  v_mfma_f32_16x16x32_bf16 v[132:135], v[212:215], a[60:63], v[132:135]
  ds_read_b64_tr_b16 v[180:181], v17 offset:20768
  v_mfma_f32_16x16x32_bf16 v[96:99], v[216:219], a[56:59], v[96:99]
  ds_read_b64_tr_b16 v[182:183], v17 offset:22048
  v_mfma_f32_16x16x32_bf16 v[136:139], v[216:219], a[60:63], v[136:139]
  buffer_load_dwordx4 a[140:143], v6, s[16:19], s48 offen offset:128 sc1
  v_mfma_f32_16x16x32_bf16 v[100:103], v[220:223], a[56:59], v[100:103]
  s_add_u32 s48, s48, 132096
  v_mfma_f32_16x16x32_bf16 v[140:143], v[220:223], a[60:63], v[140:143]
  s_waitcnt lgkmcnt(0) vmcnt(43)
  v_mfma_f32_16x16x32_bf16 v[64:67], v[144:147], a[64:67], v[64:67]
  ds_read_b64_tr_b16 v[184:185], v16 offset:30720
  ds_read_b64_tr_b16 v[186:187], v16 offset:32000
  v_mfma_f32_16x16x32_bf16 v[104:107], v[144:147], a[68:71], v[104:107]
  ds_read_b64_tr_b16 v[188:189], v17 offset:30752
  v_mfma_f32_16x16x32_bf16 v[68:71], v[148:151], a[64:67], v[68:71]
  ds_read_b64_tr_b16 v[190:191], v17 offset:32032
  v_mfma_f32_16x16x32_bf16 v[108:111], v[148:151], a[68:71], v[108:111]
  ds_read_b64_tr_b16 v[192:193], v16 offset:30784
  v_mfma_f32_16x16x32_bf16 v[72:75], v[152:155], a[64:67], v[72:75]
  ds_read_b64_tr_b16 v[194:195], v16 offset:32064
  v_mfma_f32_16x16x32_bf16 v[112:115], v[152:155], a[68:71], v[112:115]
  ds_read_b64_tr_b16 v[196:197], v17 offset:30816
  ds_read_b64_tr_b16 v[198:199], v17 offset:32096
  v_mfma_f32_16x16x32_bf16 v[76:79], v[156:159], a[64:67], v[76:79]
  ds_read_b64_tr_b16 v[200:201], v16 offset:30848
  v_mfma_f32_16x16x32_bf16 v[116:119], v[156:159], a[68:71], v[116:119]
  ds_read_b64_tr_b16 v[202:203], v16 offset:32128
  v_mfma_f32_16x16x32_bf16 v[80:83], v[160:163], a[64:67], v[80:83]
  ds_read_b64_tr_b16 v[204:205], v17 offset:30880
  v_mfma_f32_16x16x32_bf16 v[120:123], v[160:163], a[68:71], v[120:123]
  ds_read_b64_tr_b16 v[206:207], v17 offset:32160
  v_mfma_f32_16x16x32_bf16 v[84:87], v[164:167], a[64:67], v[84:87]
  ds_read_b64_tr_b16 v[208:209], v16 offset:30912
  v_mfma_f32_16x16x32_bf16 v[124:127], v[164:167], a[68:71], v[124:127]
  ds_read_b64_tr_b16 v[210:211], v16 offset:32192
  ds_read_b64_tr_b16 v[212:213], v17 offset:30944
  v_mfma_f32_16x16x32_bf16 v[88:91], v[168:171], a[64:67], v[88:91]
  ds_read_b64_tr_b16 v[214:215], v17 offset:32224
  v_mfma_f32_16x16x32_bf16 v[128:131], v[168:171], a[68:71], v[128:131]
  buffer_load_dwordx4 a[144:147], v6, s[16:19], s48 offen offset:0 sc1
  ds_read_b64_tr_b16 v[216:217], v16 offset:30976
  v_mfma_f32_16x16x32_bf16 v[92:95], v[172:175], a[64:67], v[92:95]
  ds_read_b64_tr_b16 v[218:219], v16 offset:32256
  v_mfma_f32_16x16x32_bf16 v[132:135], v[172:175], a[68:71], v[132:135]
  ds_read_b64_tr_b16 v[220:221], v17 offset:31008
  v_mfma_f32_16x16x32_bf16 v[96:99], v[176:179], a[64:67], v[96:99]
  ds_read_b64_tr_b16 v[222:223], v17 offset:32288
  v_mfma_f32_16x16x32_bf16 v[136:139], v[176:179], a[68:71], v[136:139]
  buffer_load_dwordx4 a[148:151], v6, s[16:19], s48 offen offset:128 sc1
  v_mfma_f32_16x16x32_bf16 v[100:103], v[180:183], a[64:67], v[100:103]
  s_add_u32 s48, s48, 132096
  v_mfma_f32_16x16x32_bf16 v[140:143], v[180:183], a[68:71], v[140:143]
  s_waitcnt lgkmcnt(0) vmcnt(38)
  s_barrier
  v_mfma_f32_16x16x32_bf16 v[64:67], v[184:187], a[72:75], v[64:67]
  ds_read_b64_tr_b16 v[144:145], v16 offset:40960
  ds_read_b64_tr_b16 v[146:147], v16 offset:42240
  v_mfma_f32_16x16x32_bf16 v[104:107], v[184:187], a[76:79], v[104:107]
  ds_read_b64_tr_b16 v[148:149], v17 offset:40992
  v_mfma_f32_16x16x32_bf16 v[68:71], v[188:191], a[72:75], v[68:71]
  ds_read_b64_tr_b16 v[150:151], v17 offset:42272
  v_mfma_f32_16x16x32_bf16 v[108:111], v[188:191], a[76:79], v[108:111]
  ds_read_b64_tr_b16 v[152:153], v16 offset:41024
  v_mfma_f32_16x16x32_bf16 v[72:75], v[192:195], a[72:75], v[72:75]
  ds_read_b64_tr_b16 v[154:155], v16 offset:42304
  v_mfma_f32_16x16x32_bf16 v[112:115], v[192:195], a[76:79], v[112:115]
  ds_read_b64_tr_b16 v[156:157], v17 offset:41056
  ds_read_b64_tr_b16 v[158:159], v17 offset:42336
  v_mfma_f32_16x16x32_bf16 v[76:79], v[196:199], a[72:75], v[76:79]
  ds_read_b64_tr_b16 v[160:161], v16 offset:41088
  v_mfma_f32_16x16x32_bf16 v[116:119], v[196:199], a[76:79], v[116:119]
  ds_read_b64_tr_b16 v[162:163], v16 offset:42368
  v_mfma_f32_16x16x32_bf16 v[80:83], v[200:203], a[72:75], v[80:83]
  ds_read_b64_tr_b16 v[164:165], v17 offset:41120
  v_mfma_f32_16x16x32_bf16 v[120:123], v[200:203], a[76:79], v[120:123]
  ds_read_b64_tr_b16 v[166:167], v17 offset:42400
  v_mfma_f32_16x16x32_bf16 v[84:87], v[204:207], a[72:75], v[84:87]
  ds_read_b64_tr_b16 v[168:169], v16 offset:41152
  v_mfma_f32_16x16x32_bf16 v[124:127], v[204:207], a[76:79], v[124:127]
  ds_read_b64_tr_b16 v[170:171], v16 offset:42432
  ds_read_b64_tr_b16 v[172:173], v17 offset:41184
  v_mfma_f32_16x16x32_bf16 v[88:91], v[208:211], a[72:75], v[88:91]
  ds_read_b64_tr_b16 v[174:175], v17 offset:42464
  v_mfma_f32_16x16x32_bf16 v[128:131], v[208:211], a[76:79], v[128:131]
  buffer_load_dwordx4 a[152:155], v6, s[16:19], s48 offen offset:0 sc1
  ds_read_b64_tr_b16 v[176:177], v16 offset:41216
  v_mfma_f32_16x16x32_bf16 v[92:95], v[212:215], a[72:75], v[92:95]
  ds_read_b64_tr_b16 v[178:179], v16 offset:42496
  v_mfma_f32_16x16x32_bf16 v[132:135], v[212:215], a[76:79], v[132:135]
  ds_read_b64_tr_b16 v[180:181], v17 offset:41248
  v_mfma_f32_16x16x32_bf16 v[96:99], v[216:219], a[72:75], v[96:99]
  ds_read_b64_tr_b16 v[182:183], v17 offset:42528
  v_mfma_f32_16x16x32_bf16 v[136:139], v[216:219], a[76:79], v[136:139]
  buffer_load_dwordx4 a[156:159], v6, s[16:19], s48 offen offset:128 sc1
  v_mfma_f32_16x16x32_bf16 v[100:103], v[220:223], a[72:75], v[100:103]
  s_add_u32 s48, s48, 132096
  v_mfma_f32_16x16x32_bf16 v[140:143], v[220:223], a[76:79], v[140:143]
  s_waitcnt lgkmcnt(0) vmcnt(33)
  v_mfma_f32_16x16x32_bf16 v[64:67], v[144:147], a[80:83], v[64:67]
  ds_read_b64_tr_b16 v[184:185], v16 offset:51200
  ds_read_b64_tr_b16 v[186:187], v16 offset:52480
  v_mfma_f32_16x16x32_bf16 v[104:107], v[144:147], a[84:87], v[104:107]
  ds_read_b64_tr_b16 v[188:189], v17 offset:51232
  v_mfma_f32_16x16x32_bf16 v[68:71], v[148:151], a[80:83], v[68:71]
  ds_read_b64_tr_b16 v[190:191], v17 offset:52512
  v_mfma_f32_16x16x32_bf16 v[108:111], v[148:151], a[84:87], v[108:111]
  ds_read_b64_tr_b16 v[192:193], v16 offset:51264
  v_mfma_f32_16x16x32_bf16 v[72:75], v[152:155], a[80:83], v[72:75]
  ds_read_b64_tr_b16 v[194:195], v16 offset:52544
  v_mfma_f32_16x16x32_bf16 v[112:115], v[152:155], a[84:87], v[112:115]
  ds_read_b64_tr_b16 v[196:197], v17 offset:51296
  ds_read_b64_tr_b16 v[198:199], v17 offset:52576
  v_mfma_f32_16x16x32_bf16 v[76:79], v[156:159], a[80:83], v[76:79]
  ds_read_b64_tr_b16 v[200:201], v16 offset:51328
  v_mfma_f32_16x16x32_bf16 v[116:119], v[156:159], a[84:87], v[116:119]
  ds_read_b64_tr_b16 v[202:203], v16 offset:52608
  v_mfma_f32_16x16x32_bf16 v[80:83], v[160:163], a[80:83], v[80:83]
  ds_read_b64_tr_b16 v[204:205], v17 offset:51360
  v_mfma_f32_16x16x32_bf16 v[120:123], v[160:163], a[84:87], v[120:123]
  ds_read_b64_tr_b16 v[206:207], v17 offset:52640
  v_mfma_f32_16x16x32_bf16 v[84:87], v[164:167], a[80:83], v[84:87]
  ds_read_b64_tr_b16 v[208:209], v16 offset:51392
  v_mfma_f32_16x16x32_bf16 v[124:127], v[164:167], a[84:87], v[124:127]
  ds_read_b64_tr_b16 v[210:211], v16 offset:52672
  ds_read_b64_tr_b16 v[212:213], v17 offset:51424
  v_mfma_f32_16x16x32_bf16 v[88:91], v[168:171], a[80:83], v[88:91]
  ds_read_b64_tr_b16 v[214:215], v17 offset:52704
  v_mfma_f32_16x16x32_bf16 v[128:131], v[168:171], a[84:87], v[128:131]
  buffer_load_dwordx4 v[52:55], v4, s[12:15], 0 offen
  ds_read_b64_tr_b16 v[216:217], v16 offset:51456
  v_mfma_f32_16x16x32_bf16 v[92:95], v[172:175], a[80:83], v[92:95]
  ds_read_b64_tr_b16 v[218:219], v16 offset:52736
  v_mfma_f32_16x16x32_bf16 v[132:135], v[172:175], a[84:87], v[132:135]
  ds_read_b64_tr_b16 v[220:221], v17 offset:51488
  v_mfma_f32_16x16x32_bf16 v[96:99], v[176:179], a[80:83], v[96:99]
  ds_read_b64_tr_b16 v[222:223], v17 offset:52768
  v_mfma_f32_16x16x32_bf16 v[136:139], v[176:179], a[84:87], v[136:139]
  buffer_load_dword v56, v5, s[12:15], 0 offen offset:1024
  v_mfma_f32_16x16x32_bf16 v[100:103], v[180:183], a[80:83], v[100:103]
  s_mul_i32 s50, s59, 1280
  v_mfma_f32_16x16x32_bf16 v[140:143], v[180:183], a[84:87], v[140:143]
  s_waitcnt lgkmcnt(0) vmcnt(28)
  s_barrier
  v_mfma_f32_16x16x32_bf16 v[64:67], v[184:187], a[88:91], v[64:67]
  ds_read_b64_tr_b16 v[144:145], v18 offset:0
  ds_read_b64_tr_b16 v[146:147], v18 offset:1280
  v_mfma_f32_16x16x32_bf16 v[104:107], v[184:187], a[92:95], v[104:107]
  ds_read_b64_tr_b16 v[148:149], v19 offset:32
  v_mfma_f32_16x16x32_bf16 v[68:71], v[188:191], a[88:91], v[68:71]
  ds_read_b64_tr_b16 v[150:151], v19 offset:1312
  v_mfma_f32_16x16x32_bf16 v[108:111], v[188:191], a[92:95], v[108:111]
  ds_read_b64_tr_b16 v[152:153], v18 offset:64
  v_mfma_f32_16x16x32_bf16 v[72:75], v[192:195], a[88:91], v[72:75]
  ds_read_b64_tr_b16 v[154:155], v18 offset:1344
  v_mfma_f32_16x16x32_bf16 v[112:115], v[192:195], a[92:95], v[112:115]
  ds_read_b64_tr_b16 v[156:157], v19 offset:96
  ds_read_b64_tr_b16 v[158:159], v19 offset:1376
  v_mfma_f32_16x16x32_bf16 v[76:79], v[196:199], a[88:91], v[76:79]
  ds_read_b64_tr_b16 v[160:161], v18 offset:128
  v_mfma_f32_16x16x32_bf16 v[116:119], v[196:199], a[92:95], v[116:119]
  ds_read_b64_tr_b16 v[162:163], v18 offset:1408
  v_mfma_f32_16x16x32_bf16 v[80:83], v[200:203], a[88:91], v[80:83]
  ds_read_b64_tr_b16 v[164:165], v19 offset:160
  v_mfma_f32_16x16x32_bf16 v[120:123], v[200:203], a[92:95], v[120:123]
  ds_read_b64_tr_b16 v[166:167], v19 offset:1440
  v_mfma_f32_16x16x32_bf16 v[84:87], v[204:207], a[88:91], v[84:87]
  ds_read_b64_tr_b16 v[168:169], v18 offset:192
  v_mfma_f32_16x16x32_bf16 v[124:127], v[204:207], a[92:95], v[124:127]
  ds_read_b64_tr_b16 v[170:171], v18 offset:1472
  ds_read_b64_tr_b16 v[172:173], v19 offset:224
  v_mfma_f32_16x16x32_bf16 v[88:91], v[208:211], a[88:91], v[88:91]
  ds_read_b64_tr_b16 v[174:175], v19 offset:1504
  v_mfma_f32_16x16x32_bf16 v[128:131], v[208:211], a[92:95], v[128:131]
  buffer_load_dwordx4 v[224:227], v4, s[8:11], s50 offen
  ds_read_b64_tr_b16 v[176:177], v18 offset:256
  v_mfma_f32_16x16x32_bf16 v[92:95], v[212:215], a[88:91], v[92:95]
  ds_read_b64_tr_b16 v[178:179], v18 offset:1536
  v_mfma_f32_16x16x32_bf16 v[132:135], v[212:215], a[92:95], v[132:135]
  ds_read_b64_tr_b16 v[180:181], v19 offset:288
  v_mfma_f32_16x16x32_bf16 v[96:99], v[216:219], a[88:91], v[96:99]
  ds_read_b64_tr_b16 v[182:183], v19 offset:1568
  v_mfma_f32_16x16x32_bf16 v[136:139], v[216:219], a[92:95], v[136:139]
  buffer_load_dword v228, v5, s[8:11], s50 offen offset:1024
  v_mfma_f32_16x16x32_bf16 v[100:103], v[220:223], a[88:91], v[100:103]
  s_add_u32 s50, s50, 1280
  v_mfma_f32_16x16x32_bf16 v[140:143], v[220:223], a[92:95], v[140:143]
  s_waitcnt lgkmcnt(0) vmcnt(28)
  v_mfma_f32_16x16x32_bf16 v[64:67], v[144:147], a[96:99], v[64:67]
  ds_read_b64_tr_b16 v[184:185], v18 offset:10240
  ds_read_b64_tr_b16 v[186:187], v18 offset:11520
  v_mfma_f32_16x16x32_bf16 v[104:107], v[144:147], a[100:103], v[104:107]
  ds_read_b64_tr_b16 v[188:189], v19 offset:10272
  v_mfma_f32_16x16x32_bf16 v[68:71], v[148:151], a[96:99], v[68:71]
  ds_read_b64_tr_b16 v[190:191], v19 offset:11552
  v_mfma_f32_16x16x32_bf16 v[108:111], v[148:151], a[100:103], v[108:111]
  ds_read_b64_tr_b16 v[192:193], v18 offset:10304
  v_mfma_f32_16x16x32_bf16 v[72:75], v[152:155], a[96:99], v[72:75]
  ds_read_b64_tr_b16 v[194:195], v18 offset:11584
  v_mfma_f32_16x16x32_bf16 v[112:115], v[152:155], a[100:103], v[112:115]
  ds_read_b64_tr_b16 v[196:197], v19 offset:10336
  ds_read_b64_tr_b16 v[198:199], v19 offset:11616
  v_mfma_f32_16x16x32_bf16 v[76:79], v[156:159], a[96:99], v[76:79]
  ds_read_b64_tr_b16 v[200:201], v18 offset:10368
  v_mfma_f32_16x16x32_bf16 v[116:119], v[156:159], a[100:103], v[116:119]
  ds_read_b64_tr_b16 v[202:203], v18 offset:11648
  v_mfma_f32_16x16x32_bf16 v[80:83], v[160:163], a[96:99], v[80:83]
  ds_read_b64_tr_b16 v[204:205], v19 offset:10400
  v_mfma_f32_16x16x32_bf16 v[120:123], v[160:163], a[100:103], v[120:123]
  ds_read_b64_tr_b16 v[206:207], v19 offset:11680
  v_mfma_f32_16x16x32_bf16 v[84:87], v[164:167], a[96:99], v[84:87]
  ds_read_b64_tr_b16 v[208:209], v18 offset:10432
  v_mfma_f32_16x16x32_bf16 v[124:127], v[164:167], a[100:103], v[124:127]
  ds_read_b64_tr_b16 v[210:211], v18 offset:11712
  ds_read_b64_tr_b16 v[212:213], v19 offset:10464
  v_mfma_f32_16x16x32_bf16 v[88:91], v[168:171], a[96:99], v[88:91]
  ds_read_b64_tr_b16 v[214:215], v19 offset:11744
  v_mfma_f32_16x16x32_bf16 v[128:131], v[168:171], a[100:103], v[128:131]
  buffer_load_dwordx4 v[230:233], v4, s[8:11], s50 offen
  ds_read_b64_tr_b16 v[216:217], v18 offset:10496
  v_mfma_f32_16x16x32_bf16 v[92:95], v[172:175], a[96:99], v[92:95]
  ds_read_b64_tr_b16 v[218:219], v18 offset:11776
  v_mfma_f32_16x16x32_bf16 v[132:135], v[172:175], a[100:103], v[132:135]
  ds_read_b64_tr_b16 v[220:221], v19 offset:10528
  v_mfma_f32_16x16x32_bf16 v[96:99], v[176:179], a[96:99], v[96:99]
  ds_read_b64_tr_b16 v[222:223], v19 offset:11808
  v_mfma_f32_16x16x32_bf16 v[136:139], v[176:179], a[100:103], v[136:139]
  buffer_load_dword v234, v5, s[8:11], s50 offen offset:1024
  v_mfma_f32_16x16x32_bf16 v[100:103], v[180:183], a[96:99], v[100:103]
  s_add_u32 s50, s50, 1280
  v_mfma_f32_16x16x32_bf16 v[140:143], v[180:183], a[100:103], v[140:143]
  s_waitcnt lgkmcnt(0) vmcnt(23)
  s_barrier
  v_mfma_f32_16x16x32_bf16 v[64:67], v[184:187], a[104:107], v[64:67]
  ds_read_b64_tr_b16 v[144:145], v14 offset:0
  ds_read_b64_tr_b16 v[146:147], v14 offset:1280
  v_mfma_f32_16x16x32_bf16 v[104:107], v[184:187], a[108:111], v[104:107]
  ds_read_b64_tr_b16 v[148:149], v15 offset:32
  v_mfma_f32_16x16x32_bf16 v[68:71], v[188:191], a[104:107], v[68:71]
  ds_read_b64_tr_b16 v[150:151], v15 offset:1312
  v_mfma_f32_16x16x32_bf16 v[108:111], v[188:191], a[108:111], v[108:111]
  ds_read_b64_tr_b16 v[152:153], v14 offset:64
  v_mfma_f32_16x16x32_bf16 v[72:75], v[192:195], a[104:107], v[72:75]
  ds_read_b64_tr_b16 v[154:155], v14 offset:1344
  v_mfma_f32_16x16x32_bf16 v[112:115], v[192:195], a[108:111], v[112:115]
  ds_read_b64_tr_b16 v[156:157], v15 offset:96
  ds_read_b64_tr_b16 v[158:159], v15 offset:1376
  v_mfma_f32_16x16x32_bf16 v[76:79], v[196:199], a[104:107], v[76:79]
  ds_read_b64_tr_b16 v[160:161], v14 offset:128
  v_mfma_f32_16x16x32_bf16 v[116:119], v[196:199], a[108:111], v[116:119]
  ds_read_b64_tr_b16 v[162:163], v14 offset:1408
  v_mfma_f32_16x16x32_bf16 v[80:83], v[200:203], a[104:107], v[80:83]
  ds_read_b64_tr_b16 v[164:165], v15 offset:160
  v_mfma_f32_16x16x32_bf16 v[120:123], v[200:203], a[108:111], v[120:123]
  ds_read_b64_tr_b16 v[166:167], v15 offset:1440
  v_mfma_f32_16x16x32_bf16 v[84:87], v[204:207], a[104:107], v[84:87]
  ds_read_b64_tr_b16 v[168:169], v14 offset:192
  v_mfma_f32_16x16x32_bf16 v[124:127], v[204:207], a[108:111], v[124:127]
  ds_read_b64_tr_b16 v[170:171], v14 offset:1472
  ds_read_b64_tr_b16 v[172:173], v15 offset:224
  v_mfma_f32_16x16x32_bf16 v[88:91], v[208:211], a[104:107], v[88:91]
  ds_read_b64_tr_b16 v[174:175], v15 offset:1504
  v_mfma_f32_16x16x32_bf16 v[128:131], v[208:211], a[108:111], v[128:131]
  buffer_load_dwordx4 v[236:239], v4, s[8:11], s50 offen
  ds_read_b64_tr_b16 v[176:177], v14 offset:256
  v_mfma_f32_16x16x32_bf16 v[92:95], v[212:215], a[104:107], v[92:95]
  ds_read_b64_tr_b16 v[178:179], v14 offset:1536
  v_mfma_f32_16x16x32_bf16 v[132:135], v[212:215], a[108:111], v[132:135]
  ds_read_b64_tr_b16 v[180:181], v15 offset:288
  v_mfma_f32_16x16x32_bf16 v[96:99], v[216:219], a[104:107], v[96:99]
  ds_read_b64_tr_b16 v[182:183], v15 offset:1568
  v_mfma_f32_16x16x32_bf16 v[136:139], v[216:219], a[108:111], v[136:139]
  buffer_load_dword v240, v5, s[8:11], s50 offen offset:1024
  v_mfma_f32_16x16x32_bf16 v[100:103], v[220:223], a[104:107], v[100:103]
  s_add_u32 s50, s50, 1280
  v_mfma_f32_16x16x32_bf16 v[140:143], v[220:223], a[108:111], v[140:143]
  s_waitcnt lgkmcnt(0) vmcnt(23)
  v_mfma_f32_16x16x32_bf16 v[64:67], v[144:147], a[112:115], v[64:67]
  ds_read_b64_tr_b16 v[184:185], v14 offset:10240
  ds_read_b64_tr_b16 v[186:187], v14 offset:11520
  v_mfma_f32_16x16x32_bf16 v[104:107], v[144:147], a[116:119], v[104:107]
  ds_read_b64_tr_b16 v[188:189], v15 offset:10272
  v_mfma_f32_16x16x32_bf16 v[68:71], v[148:151], a[112:115], v[68:71]
  ds_read_b64_tr_b16 v[190:191], v15 offset:11552
  v_mfma_f32_16x16x32_bf16 v[108:111], v[148:151], a[116:119], v[108:111]
  ds_read_b64_tr_b16 v[192:193], v14 offset:10304
  v_mfma_f32_16x16x32_bf16 v[72:75], v[152:155], a[112:115], v[72:75]
  ds_read_b64_tr_b16 v[194:195], v14 offset:11584
  v_mfma_f32_16x16x32_bf16 v[112:115], v[152:155], a[116:119], v[112:115]
  ds_read_b64_tr_b16 v[196:197], v15 offset:10336
  ds_read_b64_tr_b16 v[198:199], v15 offset:11616
  v_mfma_f32_16x16x32_bf16 v[76:79], v[156:159], a[112:115], v[76:79]
  ds_read_b64_tr_b16 v[200:201], v14 offset:10368
  v_mfma_f32_16x16x32_bf16 v[116:119], v[156:159], a[116:119], v[116:119]
  ds_read_b64_tr_b16 v[202:203], v14 offset:11648
  v_mfma_f32_16x16x32_bf16 v[80:83], v[160:163], a[112:115], v[80:83]
  ds_read_b64_tr_b16 v[204:205], v15 offset:10400
  v_mfma_f32_16x16x32_bf16 v[120:123], v[160:163], a[116:119], v[120:123]
  ds_read_b64_tr_b16 v[206:207], v15 offset:11680
  v_mfma_f32_16x16x32_bf16 v[84:87], v[164:167], a[112:115], v[84:87]
  ds_read_b64_tr_b16 v[208:209], v14 offset:10432
  v_mfma_f32_16x16x32_bf16 v[124:127], v[164:167], a[116:119], v[124:127]
  ds_read_b64_tr_b16 v[210:211], v14 offset:11712
  ds_read_b64_tr_b16 v[212:213], v15 offset:10464
  v_mfma_f32_16x16x32_bf16 v[88:91], v[168:171], a[112:115], v[88:91]
  ds_read_b64_tr_b16 v[214:215], v15 offset:11744
  v_mfma_f32_16x16x32_bf16 v[128:131], v[168:171], a[116:119], v[128:131]
  buffer_load_dwordx4 v[242:245], v4, s[8:11], s50 offen
  ds_read_b64_tr_b16 v[216:217], v14 offset:10496
  v_mfma_f32_16x16x32_bf16 v[92:95], v[172:175], a[112:115], v[92:95]
  ds_read_b64_tr_b16 v[218:219], v14 offset:11776
  v_mfma_f32_16x16x32_bf16 v[132:135], v[172:175], a[116:119], v[132:135]
  ds_read_b64_tr_b16 v[220:221], v15 offset:10528
  v_mfma_f32_16x16x32_bf16 v[96:99], v[176:179], a[112:115], v[96:99]
  ds_read_b64_tr_b16 v[222:223], v15 offset:11808
  v_mfma_f32_16x16x32_bf16 v[136:139], v[176:179], a[116:119], v[136:139]
  buffer_load_dword v246, v5, s[8:11], s50 offen offset:1024
  v_mfma_f32_16x16x32_bf16 v[100:103], v[180:183], a[112:115], v[100:103]
  s_add_u32 s50, s50, 1280
  v_mfma_f32_16x16x32_bf16 v[140:143], v[180:183], a[116:119], v[140:143]
  s_waitcnt lgkmcnt(0) vmcnt(18)
  s_barrier
  v_mfma_f32_16x16x32_bf16 v[64:67], v[184:187], a[120:123], v[64:67]
  ds_read_b64_tr_b16 v[144:145], v14 offset:20480
  ds_read_b64_tr_b16 v[146:147], v14 offset:21760
  v_mfma_f32_16x16x32_bf16 v[104:107], v[184:187], a[124:127], v[104:107]
  ds_read_b64_tr_b16 v[148:149], v15 offset:20512
  v_mfma_f32_16x16x32_bf16 v[68:71], v[188:191], a[120:123], v[68:71]
  ds_read_b64_tr_b16 v[150:151], v15 offset:21792
  v_mfma_f32_16x16x32_bf16 v[108:111], v[188:191], a[124:127], v[108:111]
  ds_read_b64_tr_b16 v[152:153], v14 offset:20544
  v_mfma_f32_16x16x32_bf16 v[72:75], v[192:195], a[120:123], v[72:75]
  ds_read_b64_tr_b16 v[154:155], v14 offset:21824
  v_mfma_f32_16x16x32_bf16 v[112:115], v[192:195], a[124:127], v[112:115]
  ds_read_b64_tr_b16 v[156:157], v15 offset:20576
  ds_read_b64_tr_b16 v[158:159], v15 offset:21856
  v_mfma_f32_16x16x32_bf16 v[76:79], v[196:199], a[120:123], v[76:79]
  ds_read_b64_tr_b16 v[160:161], v14 offset:20608
  v_mfma_f32_16x16x32_bf16 v[116:119], v[196:199], a[124:127], v[116:119]
  ds_read_b64_tr_b16 v[162:163], v14 offset:21888
  v_mfma_f32_16x16x32_bf16 v[80:83], v[200:203], a[120:123], v[80:83]
  ds_read_b64_tr_b16 v[164:165], v15 offset:20640
  v_mfma_f32_16x16x32_bf16 v[120:123], v[200:203], a[124:127], v[120:123]
  ds_read_b64_tr_b16 v[166:167], v15 offset:21920
  v_mfma_f32_16x16x32_bf16 v[84:87], v[204:207], a[120:123], v[84:87]
  ds_read_b64_tr_b16 v[168:169], v14 offset:20672
  v_mfma_f32_16x16x32_bf16 v[124:127], v[204:207], a[124:127], v[124:127]
  ds_read_b64_tr_b16 v[170:171], v14 offset:21952
  ds_read_b64_tr_b16 v[172:173], v15 offset:20704
  v_mfma_f32_16x16x32_bf16 v[88:91], v[208:211], a[120:123], v[88:91]
  ds_read_b64_tr_b16 v[174:175], v15 offset:21984
  v_mfma_f32_16x16x32_bf16 v[128:131], v[208:211], a[124:127], v[128:131]
  buffer_load_dwordx4 v[248:251], v4, s[8:11], s50 offen
  ds_read_b64_tr_b16 v[176:177], v14 offset:20736
  v_mfma_f32_16x16x32_bf16 v[92:95], v[212:215], a[120:123], v[92:95]
  ds_read_b64_tr_b16 v[178:179], v14 offset:22016
  v_mfma_f32_16x16x32_bf16 v[132:135], v[212:215], a[124:127], v[132:135]
  ds_read_b64_tr_b16 v[180:181], v15 offset:20768
  v_mfma_f32_16x16x32_bf16 v[96:99], v[216:219], a[120:123], v[96:99]
  ds_read_b64_tr_b16 v[182:183], v15 offset:22048
  v_mfma_f32_16x16x32_bf16 v[136:139], v[216:219], a[124:127], v[136:139]
  buffer_load_dword v252, v5, s[8:11], s50 offen offset:1024
  v_mfma_f32_16x16x32_bf16 v[100:103], v[220:223], a[120:123], v[100:103]
  s_add_u32 s50, s50, 1280
  v_mfma_f32_16x16x32_bf16 v[140:143], v[220:223], a[124:127], v[140:143]
  s_waitcnt lgkmcnt(0) vmcnt(18)
  v_mfma_f32_16x16x32_bf16 v[64:67], v[144:147], a[128:131], v[64:67]
  ds_read_b64_tr_b16 v[184:185], v14 offset:30720
  ds_read_b64_tr_b16 v[186:187], v14 offset:32000
  v_mfma_f32_16x16x32_bf16 v[104:107], v[144:147], a[132:135], v[104:107]
  ds_read_b64_tr_b16 v[188:189], v15 offset:30752
  v_mfma_f32_16x16x32_bf16 v[68:71], v[148:151], a[128:131], v[68:71]
  ds_read_b64_tr_b16 v[190:191], v15 offset:32032
  v_mfma_f32_16x16x32_bf16 v[108:111], v[148:151], a[132:135], v[108:111]
  ds_read_b64_tr_b16 v[192:193], v14 offset:30784
  v_mfma_f32_16x16x32_bf16 v[72:75], v[152:155], a[128:131], v[72:75]
  ds_read_b64_tr_b16 v[194:195], v14 offset:32064
  v_mfma_f32_16x16x32_bf16 v[112:115], v[152:155], a[132:135], v[112:115]
  ds_read_b64_tr_b16 v[196:197], v15 offset:30816
  ds_read_b64_tr_b16 v[198:199], v15 offset:32096
  v_mfma_f32_16x16x32_bf16 v[76:79], v[156:159], a[128:131], v[76:79]
  ds_read_b64_tr_b16 v[200:201], v14 offset:30848
  v_mfma_f32_16x16x32_bf16 v[116:119], v[156:159], a[132:135], v[116:119]
  ds_read_b64_tr_b16 v[202:203], v14 offset:32128
  v_mfma_f32_16x16x32_bf16 v[80:83], v[160:163], a[128:131], v[80:83]
  ds_read_b64_tr_b16 v[204:205], v15 offset:30880
  v_mfma_f32_16x16x32_bf16 v[120:123], v[160:163], a[132:135], v[120:123]
  ds_read_b64_tr_b16 v[206:207], v15 offset:32160
  v_mfma_f32_16x16x32_bf16 v[84:87], v[164:167], a[128:131], v[84:87]
  ds_read_b64_tr_b16 v[208:209], v14 offset:30912
  v_mfma_f32_16x16x32_bf16 v[124:127], v[164:167], a[132:135], v[124:127]
  ds_read_b64_tr_b16 v[210:211], v14 offset:32192
  ds_read_b64_tr_b16 v[212:213], v15 offset:30944
  v_mfma_f32_16x16x32_bf16 v[88:91], v[168:171], a[128:131], v[88:91]
  ds_read_b64_tr_b16 v[214:215], v15 offset:32224
  v_mfma_f32_16x16x32_bf16 v[128:131], v[168:171], a[132:135], v[128:131]
  buffer_load_dwordx4 v[30:33], v4, s[8:11], s50 offen
  ds_read_b64_tr_b16 v[216:217], v14 offset:30976
  v_mfma_f32_16x16x32_bf16 v[92:95], v[172:175], a[128:131], v[92:95]
  ds_read_b64_tr_b16 v[218:219], v14 offset:32256
  v_mfma_f32_16x16x32_bf16 v[132:135], v[172:175], a[132:135], v[132:135]
  ds_read_b64_tr_b16 v[220:221], v15 offset:31008
  v_mfma_f32_16x16x32_bf16 v[96:99], v[176:179], a[128:131], v[96:99]
  ds_read_b64_tr_b16 v[222:223], v15 offset:32288
  v_mfma_f32_16x16x32_bf16 v[136:139], v[176:179], a[132:135], v[136:139]
  buffer_load_dword v34, v5, s[8:11], s50 offen offset:1024
  v_mfma_f32_16x16x32_bf16 v[100:103], v[180:183], a[128:131], v[100:103]
  s_add_u32 s50, s50, 1280
  v_mfma_f32_16x16x32_bf16 v[140:143], v[180:183], a[132:135], v[140:143]
  s_waitcnt lgkmcnt(0) vmcnt(18)
  s_barrier
  v_mfma_f32_16x16x32_bf16 v[64:67], v[184:187], a[136:139], v[64:67]
  ds_read_b64_tr_b16 v[144:145], v14 offset:40960
  ds_read_b64_tr_b16 v[146:147], v14 offset:42240
  v_mfma_f32_16x16x32_bf16 v[104:107], v[184:187], a[140:143], v[104:107]
  ds_read_b64_tr_b16 v[148:149], v15 offset:40992
  v_mfma_f32_16x16x32_bf16 v[68:71], v[188:191], a[136:139], v[68:71]
  ds_read_b64_tr_b16 v[150:151], v15 offset:42272
  v_mfma_f32_16x16x32_bf16 v[108:111], v[188:191], a[140:143], v[108:111]
  ds_read_b64_tr_b16 v[152:153], v14 offset:41024
  v_mfma_f32_16x16x32_bf16 v[72:75], v[192:195], a[136:139], v[72:75]
  ds_read_b64_tr_b16 v[154:155], v14 offset:42304
  v_mfma_f32_16x16x32_bf16 v[112:115], v[192:195], a[140:143], v[112:115]
  ds_read_b64_tr_b16 v[156:157], v15 offset:41056
  ds_read_b64_tr_b16 v[158:159], v15 offset:42336
  v_mfma_f32_16x16x32_bf16 v[76:79], v[196:199], a[136:139], v[76:79]
  ds_read_b64_tr_b16 v[160:161], v14 offset:41088
  v_mfma_f32_16x16x32_bf16 v[116:119], v[196:199], a[140:143], v[116:119]
  ds_read_b64_tr_b16 v[162:163], v14 offset:42368
  v_mfma_f32_16x16x32_bf16 v[80:83], v[200:203], a[136:139], v[80:83]
  ds_read_b64_tr_b16 v[164:165], v15 offset:41120
  v_mfma_f32_16x16x32_bf16 v[120:123], v[200:203], a[140:143], v[120:123]
  ds_read_b64_tr_b16 v[166:167], v15 offset:42400
  v_mfma_f32_16x16x32_bf16 v[84:87], v[204:207], a[136:139], v[84:87]
  ds_read_b64_tr_b16 v[168:169], v14 offset:41152
  v_mfma_f32_16x16x32_bf16 v[124:127], v[204:207], a[140:143], v[124:127]
  ds_read_b64_tr_b16 v[170:171], v14 offset:42432
  ds_read_b64_tr_b16 v[172:173], v15 offset:41184
  v_mfma_f32_16x16x32_bf16 v[88:91], v[208:211], a[136:139], v[88:91]
  ds_read_b64_tr_b16 v[174:175], v15 offset:42464
  v_mfma_f32_16x16x32_bf16 v[128:131], v[208:211], a[140:143], v[128:131]
  buffer_load_dwordx4 v[36:39], v4, s[8:11], s50 offen
  ds_read_b64_tr_b16 v[176:177], v14 offset:41216
  v_mfma_f32_16x16x32_bf16 v[92:95], v[212:215], a[136:139], v[92:95]
  ds_read_b64_tr_b16 v[178:179], v14 offset:42496
  v_mfma_f32_16x16x32_bf16 v[132:135], v[212:215], a[140:143], v[132:135]
  ds_read_b64_tr_b16 v[180:181], v15 offset:41248
  v_mfma_f32_16x16x32_bf16 v[96:99], v[216:219], a[136:139], v[96:99]
  ds_read_b64_tr_b16 v[182:183], v15 offset:42528
  v_mfma_f32_16x16x32_bf16 v[136:139], v[216:219], a[140:143], v[136:139]
  buffer_load_dword v40, v5, s[8:11], s50 offen offset:1024
  v_mfma_f32_16x16x32_bf16 v[100:103], v[220:223], a[136:139], v[100:103]
  s_add_u32 s50, s50, 1280
  v_mfma_f32_16x16x32_bf16 v[140:143], v[220:223], a[140:143], v[140:143]
  s_waitcnt lgkmcnt(0) vmcnt(18)
  v_mfma_f32_16x16x32_bf16 v[64:67], v[144:147], a[144:147], v[64:67]
  ds_read_b64_tr_b16 v[184:185], v14 offset:51200
  ds_read_b64_tr_b16 v[186:187], v14 offset:52480
  v_mfma_f32_16x16x32_bf16 v[104:107], v[144:147], a[148:151], v[104:107]
  ds_read_b64_tr_b16 v[188:189], v15 offset:51232
  v_mfma_f32_16x16x32_bf16 v[68:71], v[148:151], a[144:147], v[68:71]
  ds_read_b64_tr_b16 v[190:191], v15 offset:52512
  v_mfma_f32_16x16x32_bf16 v[108:111], v[148:151], a[148:151], v[108:111]
  ds_read_b64_tr_b16 v[192:193], v14 offset:51264
  v_mfma_f32_16x16x32_bf16 v[72:75], v[152:155], a[144:147], v[72:75]
  ds_read_b64_tr_b16 v[194:195], v14 offset:52544
  v_mfma_f32_16x16x32_bf16 v[112:115], v[152:155], a[148:151], v[112:115]
  ds_read_b64_tr_b16 v[196:197], v15 offset:51296
  ds_read_b64_tr_b16 v[198:199], v15 offset:52576
  v_mfma_f32_16x16x32_bf16 v[76:79], v[156:159], a[144:147], v[76:79]
  ds_read_b64_tr_b16 v[200:201], v14 offset:51328
  v_mfma_f32_16x16x32_bf16 v[116:119], v[156:159], a[148:151], v[116:119]
  ds_read_b64_tr_b16 v[202:203], v14 offset:52608
  v_mfma_f32_16x16x32_bf16 v[80:83], v[160:163], a[144:147], v[80:83]
  ds_read_b64_tr_b16 v[204:205], v15 offset:51360
  v_mfma_f32_16x16x32_bf16 v[120:123], v[160:163], a[148:151], v[120:123]
  ds_read_b64_tr_b16 v[206:207], v15 offset:52640
  v_mfma_f32_16x16x32_bf16 v[84:87], v[164:167], a[144:147], v[84:87]
  ds_read_b64_tr_b16 v[208:209], v14 offset:51392
  v_mfma_f32_16x16x32_bf16 v[124:127], v[164:167], a[148:151], v[124:127]
  ds_read_b64_tr_b16 v[210:211], v14 offset:52672
  ds_read_b64_tr_b16 v[212:213], v15 offset:51424
  v_mfma_f32_16x16x32_bf16 v[88:91], v[168:171], a[144:147], v[88:91]
  ds_read_b64_tr_b16 v[214:215], v15 offset:52704
  v_mfma_f32_16x16x32_bf16 v[128:131], v[168:171], a[148:151], v[128:131]
  buffer_load_dwordx4 v[42:45], v4, s[8:11], s50 offen
  ds_read_b64_tr_b16 v[216:217], v14 offset:51456
  v_mfma_f32_16x16x32_bf16 v[92:95], v[172:175], a[144:147], v[92:95]
  ds_read_b64_tr_b16 v[218:219], v14 offset:52736
  v_mfma_f32_16x16x32_bf16 v[132:135], v[172:175], a[148:151], v[132:135]
  ds_read_b64_tr_b16 v[220:221], v15 offset:51488
  v_mfma_f32_16x16x32_bf16 v[96:99], v[176:179], a[144:147], v[96:99]
  ds_read_b64_tr_b16 v[222:223], v15 offset:52768
  v_mfma_f32_16x16x32_bf16 v[136:139], v[176:179], a[148:151], v[136:139]
  buffer_load_dword v46, v5, s[8:11], s50 offen offset:1024
  v_mfma_f32_16x16x32_bf16 v[100:103], v[180:183], a[144:147], v[100:103]
  s_add_u32 s50, s50, 1280
  v_mfma_f32_16x16x32_bf16 v[140:143], v[180:183], a[148:151], v[140:143]
  s_waitcnt lgkmcnt(0) vmcnt(18)
  v_mfma_f32_16x16x32_bf16 v[64:67], v[184:187], a[152:155], v[64:67]
  v_mfma_f32_16x16x32_bf16 v[104:107], v[184:187], a[156:159], v[104:107]
  v_mfma_f32_16x16x32_bf16 v[68:71], v[188:191], a[152:155], v[68:71]
  v_mfma_f32_16x16x32_bf16 v[108:111], v[188:191], a[156:159], v[108:111]
  v_mfma_f32_16x16x32_bf16 v[72:75], v[192:195], a[152:155], v[72:75]
  v_mfma_f32_16x16x32_bf16 v[112:115], v[192:195], a[156:159], v[112:115]
  v_mfma_f32_16x16x32_bf16 v[76:79], v[196:199], a[152:155], v[76:79]
  v_mfma_f32_16x16x32_bf16 v[116:119], v[196:199], a[156:159], v[116:119]
  v_mfma_f32_16x16x32_bf16 v[80:83], v[200:203], a[152:155], v[80:83]
  v_mfma_f32_16x16x32_bf16 v[120:123], v[200:203], a[156:159], v[120:123]
  v_mfma_f32_16x16x32_bf16 v[84:87], v[204:207], a[152:155], v[84:87]
  v_mfma_f32_16x16x32_bf16 v[124:127], v[204:207], a[156:159], v[124:127]
  v_mfma_f32_16x16x32_bf16 v[88:91], v[208:211], a[152:155], v[88:91]
  v_mfma_f32_16x16x32_bf16 v[128:131], v[208:211], a[156:159], v[128:131]
  v_mfma_f32_16x16x32_bf16 v[92:95], v[212:215], a[152:155], v[92:95]
  v_mfma_f32_16x16x32_bf16 v[132:135], v[212:215], a[156:159], v[132:135]
  v_mfma_f32_16x16x32_bf16 v[96:99], v[216:219], a[152:155], v[96:99]
  v_mfma_f32_16x16x32_bf16 v[136:139], v[216:219], a[156:159], v[136:139]
  v_mfma_f32_16x16x32_bf16 v[100:103], v[220:223], a[152:155], v[100:103]
  v_mfma_f32_16x16x32_bf16 v[140:143], v[220:223], a[156:159], v[140:143]
  s_add_u32 s16, s38, 73400320
  s_addc_u32 s17, s39, 0
  s_mov_b32 s18, 5242880
  s_mov_b32 s19, 0x00020000
  s_nop 3
  s_mul_i32 s21, s47, 40
  s_mul_i32 s22, s44, 10
  s_add_u32 s21, s21, s22
  s_lshl_b32 s21, s21, 10
  s_cmp_lt_u32 s2, 32
  s_cbranch_scc1 om_282
  s_add_u32 s22, s21, 0
  buffer_store_dwordx4 v[64:67], v4, s[16:19], s22 offen offset:0 sc1
  buffer_store_dwordx4 v[68:71], v4, s[16:19], s22 offen offset:1024 sc1
  buffer_store_dwordx4 v[72:75], v4, s[16:19], s22 offen offset:2048 sc1
  buffer_store_dwordx4 v[76:79], v4, s[16:19], s22 offen offset:3072 sc1
  s_add_u32 s22, s21, 4096
  buffer_store_dwordx4 v[80:83], v4, s[16:19], s22 offen offset:0 sc1
  buffer_store_dwordx4 v[84:87], v4, s[16:19], s22 offen offset:1024 sc1
  buffer_store_dwordx4 v[88:91], v4, s[16:19], s22 offen offset:2048 sc1
  buffer_store_dwordx4 v[92:95], v4, s[16:19], s22 offen offset:3072 sc1
  s_add_u32 s22, s21, 8192
  buffer_store_dwordx4 v[96:99], v4, s[16:19], s22 offen offset:0 sc1
  buffer_store_dwordx4 v[100:103], v4, s[16:19], s22 offen offset:1024 sc1
  s_add_u32 s22, s21, 40960
  buffer_store_dwordx4 v[104:107], v4, s[16:19], s22 offen offset:0 sc1
  buffer_store_dwordx4 v[108:111], v4, s[16:19], s22 offen offset:1024 sc1
  buffer_store_dwordx4 v[112:115], v4, s[16:19], s22 offen offset:2048 sc1
  buffer_store_dwordx4 v[116:119], v4, s[16:19], s22 offen offset:3072 sc1
  s_add_u32 s22, s21, 45056
  buffer_store_dwordx4 v[120:123], v4, s[16:19], s22 offen offset:0 sc1
  buffer_store_dwordx4 v[124:127], v4, s[16:19], s22 offen offset:1024 sc1
  buffer_store_dwordx4 v[128:131], v4, s[16:19], s22 offen offset:2048 sc1
  buffer_store_dwordx4 v[132:135], v4, s[16:19], s22 offen offset:3072 sc1
  s_add_u32 s22, s21, 49152
  buffer_store_dwordx4 v[136:139], v4, s[16:19], s22 offen offset:0 sc1
  buffer_store_dwordx4 v[140:143], v4, s[16:19], s22 offen offset:1024 sc1
  s_sub_u32 s50, s50, 1320960
  buffer_load_dwordx4 v[160:163], v4, s[8:11], s50 offen
  buffer_load_dword v164, v5, s[8:11], s50 offen offset:1024
  s_add_u32 s50, s50, 1280
  buffer_load_dwordx4 v[166:169], v4, s[8:11], s50 offen
  buffer_load_dword v170, v5, s[8:11], s50 offen offset:1024
  s_add_u32 s50, s50, 1280
  buffer_load_dwordx4 v[172:175], v4, s[8:11], s50 offen
  buffer_load_dword v176, v5, s[8:11], s50 offen offset:1024
  s_add_u32 s50, s50, 1280
  buffer_load_dwordx4 v[178:181], v4, s[8:11], s50 offen
  buffer_load_dword v182, v5, s[8:11], s50 offen offset:1024
  s_add_u32 s50, s50, 1280
  buffer_load_dwordx4 v[184:187], v4, s[8:11], s50 offen
  buffer_load_dword v188, v5, s[8:11], s50 offen offset:1024
  s_add_u32 s50, s50, 1280
  buffer_load_dwordx4 v[190:193], v4, s[8:11], s50 offen
  buffer_load_dword v194, v5, s[8:11], s50 offen offset:1024
  s_add_u32 s50, s50, 1280
  buffer_load_dwordx4 v[196:199], v4, s[8:11], s50 offen
  buffer_load_dword v200, v5, s[8:11], s50 offen offset:1024
  s_add_u32 s50, s50, 1280
  buffer_load_dwordx4 v[202:205], v4, s[8:11], s50 offen
  buffer_load_dword v206, v5, s[8:11], s50 offen offset:1024
  s_add_u32 s50, s50, 1280
  s_waitcnt vmcnt(36)
  v_lshlrev_b32 v57, 16, v52
  v_and_b32 v52, 0xffff0000, v52
  v_lshlrev_b32 v58, 16, v53
  v_and_b32 v53, 0xffff0000, v53
  v_lshlrev_b32 v59, 16, v54
  v_and_b32 v54, 0xffff0000, v54
  v_lshlrev_b32 v60, 16, v55
  v_and_b32 v55, 0xffff0000, v55
  v_lshlrev_b32 v61, 16, v56
  v_and_b32 v56, 0xffff0000, v56
  v_lshlrev_b32 v25, 16, v224
  v_and_b32 v26, 0xffff0000, v224
  v_mul_f32 v25, v25, v57
  v_mul_f32 v26, v26, v52
  v_cvt_pk_bf16_f32 v25, v25, v26
  v_lshlrev_b32 v26, 16, v25
  v_and_b32 v25, 0xffff0000, v25
  v_add_f32 v144, v25, v26
  v_lshlrev_b32 v25, 16, v225
  v_and_b32 v26, 0xffff0000, v225
  v_mul_f32 v25, v25, v58
  v_mul_f32 v26, v26, v53
  v_cvt_pk_bf16_f32 v25, v25, v26
  v_lshlrev_b32 v26, 16, v25
  v_and_b32 v25, 0xffff0000, v25
  v_add_f32 v144, v144, v26
  v_add_f32 v144, v144, v25
  v_lshlrev_b32 v25, 16, v226
  v_and_b32 v26, 0xffff0000, v226
  v_mul_f32 v25, v25, v59
  v_mul_f32 v26, v26, v54
  v_cvt_pk_bf16_f32 v25, v25, v26
  v_lshlrev_b32 v26, 16, v25
  v_and_b32 v25, 0xffff0000, v25
  v_add_f32 v144, v144, v26
  v_add_f32 v144, v144, v25
  v_lshlrev_b32 v25, 16, v227
  v_and_b32 v26, 0xffff0000, v227
  v_mul_f32 v25, v25, v60
  v_mul_f32 v26, v26, v55
  v_cvt_pk_bf16_f32 v25, v25, v26
  v_lshlrev_b32 v26, 16, v25
  v_and_b32 v25, 0xffff0000, v25
  v_add_f32 v144, v144, v26
  v_add_f32 v144, v144, v25
  v_lshlrev_b32 v25, 16, v228
  v_and_b32 v26, 0xffff0000, v228
  v_mul_f32 v25, v25, v61
  v_mul_f32 v26, v26, v56
  v_cvt_pk_bf16_f32 v25, v25, v26
  v_lshlrev_b32 v26, 16, v25
  v_and_b32 v25, 0xffff0000, v25
  v_add_f32 v144, v144, v26
  v_add_f32 v144, v144, v25
  v_lshlrev_b32 v25, 16, v230
  v_and_b32 v26, 0xffff0000, v230
  v_mul_f32 v25, v25, v57
  v_mul_f32 v26, v26, v52
  v_cvt_pk_bf16_f32 v25, v25, v26
  v_lshlrev_b32 v26, 16, v25
  v_and_b32 v25, 0xffff0000, v25
  v_add_f32 v145, v25, v26
  v_lshlrev_b32 v25, 16, v231
  v_and_b32 v26, 0xffff0000, v231
  v_mul_f32 v25, v25, v58
  v_mul_f32 v26, v26, v53
  v_cvt_pk_bf16_f32 v25, v25, v26
  v_lshlrev_b32 v26, 16, v25
  v_and_b32 v25, 0xffff0000, v25
  v_add_f32 v145, v145, v26
  v_add_f32 v145, v145, v25
  v_lshlrev_b32 v25, 16, v232
  v_and_b32 v26, 0xffff0000, v232
  v_mul_f32 v25, v25, v59
  v_mul_f32 v26, v26, v54
  v_cvt_pk_bf16_f32 v25, v25, v26
  v_lshlrev_b32 v26, 16, v25
  v_and_b32 v25, 0xffff0000, v25
  v_add_f32 v145, v145, v26
  v_add_f32 v145, v145, v25
  v_lshlrev_b32 v25, 16, v233
  v_and_b32 v26, 0xffff0000, v233
  v_mul_f32 v25, v25, v60
  v_mul_f32 v26, v26, v55
  v_cvt_pk_bf16_f32 v25, v25, v26
  v_lshlrev_b32 v26, 16, v25
  v_and_b32 v25, 0xffff0000, v25
  v_add_f32 v145, v145, v26
  v_add_f32 v145, v145, v25
  v_lshlrev_b32 v25, 16, v234
  v_and_b32 v26, 0xffff0000, v234
  v_mul_f32 v25, v25, v61
  v_mul_f32 v26, v26, v56
  v_cvt_pk_bf16_f32 v25, v25, v26
  v_lshlrev_b32 v26, 16, v25
  v_and_b32 v25, 0xffff0000, v25
  v_add_f32 v145, v145, v26
  v_add_f32 v145, v145, v25
  v_lshlrev_b32 v25, 16, v236
  v_and_b32 v26, 0xffff0000, v236
  v_mul_f32 v25, v25, v57
  v_mul_f32 v26, v26, v52
  v_cvt_pk_bf16_f32 v25, v25, v26
  v_lshlrev_b32 v26, 16, v25
  v_and_b32 v25, 0xffff0000, v25
  v_add_f32 v146, v25, v26
  v_lshlrev_b32 v25, 16, v237
  v_and_b32 v26, 0xffff0000, v237
  v_mul_f32 v25, v25, v58
  v_mul_f32 v26, v26, v53
  v_cvt_pk_bf16_f32 v25, v25, v26
  v_lshlrev_b32 v26, 16, v25
  v_and_b32 v25, 0xffff0000, v25
  v_add_f32 v146, v146, v26
  v_add_f32 v146, v146, v25
  v_lshlrev_b32 v25, 16, v238
  v_and_b32 v26, 0xffff0000, v238
  v_mul_f32 v25, v25, v59
  v_mul_f32 v26, v26, v54
  v_cvt_pk_bf16_f32 v25, v25, v26
  v_lshlrev_b32 v26, 16, v25
  v_and_b32 v25, 0xffff0000, v25
  v_add_f32 v146, v146, v26
  v_add_f32 v146, v146, v25
  v_lshlrev_b32 v25, 16, v239
  v_and_b32 v26, 0xffff0000, v239
  v_mul_f32 v25, v25, v60
  v_mul_f32 v26, v26, v55
  v_cvt_pk_bf16_f32 v25, v25, v26
  v_lshlrev_b32 v26, 16, v25
  v_and_b32 v25, 0xffff0000, v25
  v_add_f32 v146, v146, v26
  v_add_f32 v146, v146, v25
  v_lshlrev_b32 v25, 16, v240
  v_and_b32 v26, 0xffff0000, v240
  v_mul_f32 v25, v25, v61
  v_mul_f32 v26, v26, v56
  v_cvt_pk_bf16_f32 v25, v25, v26
  v_lshlrev_b32 v26, 16, v25
  v_and_b32 v25, 0xffff0000, v25
  v_add_f32 v146, v146, v26
  v_add_f32 v146, v146, v25
  v_lshlrev_b32 v25, 16, v242
  v_and_b32 v26, 0xffff0000, v242
  v_mul_f32 v25, v25, v57
  v_mul_f32 v26, v26, v52
  v_cvt_pk_bf16_f32 v25, v25, v26
  v_lshlrev_b32 v26, 16, v25
  v_and_b32 v25, 0xffff0000, v25
  v_add_f32 v147, v25, v26
  v_lshlrev_b32 v25, 16, v243
  v_and_b32 v26, 0xffff0000, v243
  v_mul_f32 v25, v25, v58
  v_mul_f32 v26, v26, v53
  v_cvt_pk_bf16_f32 v25, v25, v26
  v_lshlrev_b32 v26, 16, v25
  v_and_b32 v25, 0xffff0000, v25
  v_add_f32 v147, v147, v26
  v_add_f32 v147, v147, v25
  v_lshlrev_b32 v25, 16, v244
  v_and_b32 v26, 0xffff0000, v244
  v_mul_f32 v25, v25, v59
  v_mul_f32 v26, v26, v54
  v_cvt_pk_bf16_f32 v25, v25, v26
  v_lshlrev_b32 v26, 16, v25
  v_and_b32 v25, 0xffff0000, v25
  v_add_f32 v147, v147, v26
  v_add_f32 v147, v147, v25
  v_lshlrev_b32 v25, 16, v245
  v_and_b32 v26, 0xffff0000, v245
  v_mul_f32 v25, v25, v60
  v_mul_f32 v26, v26, v55
  v_cvt_pk_bf16_f32 v25, v25, v26
  v_lshlrev_b32 v26, 16, v25
  v_and_b32 v25, 0xffff0000, v25
  v_add_f32 v147, v147, v26
  v_add_f32 v147, v147, v25
  v_lshlrev_b32 v25, 16, v246
  v_and_b32 v26, 0xffff0000, v246
  v_mul_f32 v25, v25, v61
  v_mul_f32 v26, v26, v56
  v_cvt_pk_bf16_f32 v25, v25, v26
  v_lshlrev_b32 v26, 16, v25
  v_and_b32 v25, 0xffff0000, v25
  v_add_f32 v147, v147, v26
  v_add_f32 v147, v147, v25
  v_lshlrev_b32 v25, 16, v248
  v_and_b32 v26, 0xffff0000, v248
  v_mul_f32 v25, v25, v57
  v_mul_f32 v26, v26, v52
  v_cvt_pk_bf16_f32 v25, v25, v26
  v_lshlrev_b32 v26, 16, v25
  v_and_b32 v25, 0xffff0000, v25
  v_add_f32 v148, v25, v26
  v_lshlrev_b32 v25, 16, v249
  v_and_b32 v26, 0xffff0000, v249
  v_mul_f32 v25, v25, v58
  v_mul_f32 v26, v26, v53
  v_cvt_pk_bf16_f32 v25, v25, v26
  v_lshlrev_b32 v26, 16, v25
  v_and_b32 v25, 0xffff0000, v25
  v_add_f32 v148, v148, v26
  v_add_f32 v148, v148, v25
  v_lshlrev_b32 v25, 16, v250
  v_and_b32 v26, 0xffff0000, v250
  v_mul_f32 v25, v25, v59
  v_mul_f32 v26, v26, v54
  v_cvt_pk_bf16_f32 v25, v25, v26
  v_lshlrev_b32 v26, 16, v25
  v_and_b32 v25, 0xffff0000, v25
  v_add_f32 v148, v148, v26
  v_add_f32 v148, v148, v25
  v_lshlrev_b32 v25, 16, v251
  v_and_b32 v26, 0xffff0000, v251
  v_mul_f32 v25, v25, v60
  v_mul_f32 v26, v26, v55
  v_cvt_pk_bf16_f32 v25, v25, v26
  v_lshlrev_b32 v26, 16, v25
  v_and_b32 v25, 0xffff0000, v25
  v_add_f32 v148, v148, v26
  v_add_f32 v148, v148, v25
  v_lshlrev_b32 v25, 16, v252
  v_and_b32 v26, 0xffff0000, v252
  v_mul_f32 v25, v25, v61
  v_mul_f32 v26, v26, v56
  v_cvt_pk_bf16_f32 v25, v25, v26
  v_lshlrev_b32 v26, 16, v25
  v_and_b32 v25, 0xffff0000, v25
  v_add_f32 v148, v148, v26
  v_add_f32 v148, v148, v25
  v_lshlrev_b32 v25, 16, v30
  v_and_b32 v26, 0xffff0000, v30
  v_mul_f32 v25, v25, v57
  v_mul_f32 v26, v26, v52
  v_cvt_pk_bf16_f32 v25, v25, v26
  v_lshlrev_b32 v26, 16, v25
  v_and_b32 v25, 0xffff0000, v25
  v_add_f32 v149, v25, v26
  v_lshlrev_b32 v25, 16, v31
  v_and_b32 v26, 0xffff0000, v31
  v_mul_f32 v25, v25, v58
  v_mul_f32 v26, v26, v53
  v_cvt_pk_bf16_f32 v25, v25, v26
  v_lshlrev_b32 v26, 16, v25
  v_and_b32 v25, 0xffff0000, v25
  v_add_f32 v149, v149, v26
  v_add_f32 v149, v149, v25
  v_lshlrev_b32 v25, 16, v32
  v_and_b32 v26, 0xffff0000, v32
  v_mul_f32 v25, v25, v59
  v_mul_f32 v26, v26, v54
  v_cvt_pk_bf16_f32 v25, v25, v26
  v_lshlrev_b32 v26, 16, v25
  v_and_b32 v25, 0xffff0000, v25
  v_add_f32 v149, v149, v26
  v_add_f32 v149, v149, v25
  v_lshlrev_b32 v25, 16, v33
  v_and_b32 v26, 0xffff0000, v33
  v_mul_f32 v25, v25, v60
  v_mul_f32 v26, v26, v55
  v_cvt_pk_bf16_f32 v25, v25, v26
  v_lshlrev_b32 v26, 16, v25
  v_and_b32 v25, 0xffff0000, v25
  v_add_f32 v149, v149, v26
  v_add_f32 v149, v149, v25
  v_lshlrev_b32 v25, 16, v34
  v_and_b32 v26, 0xffff0000, v34
  v_mul_f32 v25, v25, v61
  v_mul_f32 v26, v26, v56
  v_cvt_pk_bf16_f32 v25, v25, v26
  v_lshlrev_b32 v26, 16, v25
  v_and_b32 v25, 0xffff0000, v25
  v_add_f32 v149, v149, v26
  v_add_f32 v149, v149, v25
  v_lshlrev_b32 v25, 16, v36
  v_and_b32 v26, 0xffff0000, v36
  v_mul_f32 v25, v25, v57
  v_mul_f32 v26, v26, v52
  v_cvt_pk_bf16_f32 v25, v25, v26
  v_lshlrev_b32 v26, 16, v25
  v_and_b32 v25, 0xffff0000, v25
  v_add_f32 v150, v25, v26
  v_lshlrev_b32 v25, 16, v37
  v_and_b32 v26, 0xffff0000, v37
  v_mul_f32 v25, v25, v58
  v_mul_f32 v26, v26, v53
  v_cvt_pk_bf16_f32 v25, v25, v26
  v_lshlrev_b32 v26, 16, v25
  v_and_b32 v25, 0xffff0000, v25
  v_add_f32 v150, v150, v26
  v_add_f32 v150, v150, v25
  v_lshlrev_b32 v25, 16, v38
  v_and_b32 v26, 0xffff0000, v38
  v_mul_f32 v25, v25, v59
  v_mul_f32 v26, v26, v54
  v_cvt_pk_bf16_f32 v25, v25, v26
  v_lshlrev_b32 v26, 16, v25
  v_and_b32 v25, 0xffff0000, v25
  v_add_f32 v150, v150, v26
  v_add_f32 v150, v150, v25
  v_lshlrev_b32 v25, 16, v39
  v_and_b32 v26, 0xffff0000, v39
  v_mul_f32 v25, v25, v60
  v_mul_f32 v26, v26, v55
  v_cvt_pk_bf16_f32 v25, v25, v26
  v_lshlrev_b32 v26, 16, v25
  v_and_b32 v25, 0xffff0000, v25
  v_add_f32 v150, v150, v26
  v_add_f32 v150, v150, v25
  v_lshlrev_b32 v25, 16, v40
  v_and_b32 v26, 0xffff0000, v40
  v_mul_f32 v25, v25, v61
  v_mul_f32 v26, v26, v56
  v_cvt_pk_bf16_f32 v25, v25, v26
  v_lshlrev_b32 v26, 16, v25
  v_and_b32 v25, 0xffff0000, v25
  v_add_f32 v150, v150, v26
  v_add_f32 v150, v150, v25
  v_lshlrev_b32 v25, 16, v42
  v_and_b32 v26, 0xffff0000, v42
  v_mul_f32 v25, v25, v57
  v_mul_f32 v26, v26, v52
  v_cvt_pk_bf16_f32 v25, v25, v26
  v_lshlrev_b32 v26, 16, v25
  v_and_b32 v25, 0xffff0000, v25
  v_add_f32 v151, v25, v26
  v_lshlrev_b32 v25, 16, v43
  v_and_b32 v26, 0xffff0000, v43
  v_mul_f32 v25, v25, v58
  v_mul_f32 v26, v26, v53
  v_cvt_pk_bf16_f32 v25, v25, v26
  v_lshlrev_b32 v26, 16, v25
  v_and_b32 v25, 0xffff0000, v25
  v_add_f32 v151, v151, v26
  v_add_f32 v151, v151, v25
  v_lshlrev_b32 v25, 16, v44
  v_and_b32 v26, 0xffff0000, v44
  v_mul_f32 v25, v25, v59
  v_mul_f32 v26, v26, v54
  v_cvt_pk_bf16_f32 v25, v25, v26
  v_lshlrev_b32 v26, 16, v25
  v_and_b32 v25, 0xffff0000, v25
  v_add_f32 v151, v151, v26
  v_add_f32 v151, v151, v25
  v_lshlrev_b32 v25, 16, v45
  v_and_b32 v26, 0xffff0000, v45
  v_mul_f32 v25, v25, v60
  v_mul_f32 v26, v26, v55
  v_cvt_pk_bf16_f32 v25, v25, v26
  v_lshlrev_b32 v26, 16, v25
  v_and_b32 v25, 0xffff0000, v25
  v_add_f32 v151, v151, v26
  v_add_f32 v151, v151, v25
  v_lshlrev_b32 v25, 16, v46
  v_and_b32 v26, 0xffff0000, v46
  v_mul_f32 v25, v25, v61
  v_mul_f32 v26, v26, v56
  v_cvt_pk_bf16_f32 v25, v25, v26
  v_lshlrev_b32 v26, 16, v25
  v_and_b32 v25, 0xffff0000, v25
  v_add_f32 v151, v151, v26
  v_add_f32 v151, v151, v25
  v_add_f32_dpp v144, v144, v144 row_ror:8 row_mask:0xf bank_mask:0xf
  v_add_f32_dpp v145, v145, v145 row_ror:8 row_mask:0xf bank_mask:0xf
  v_add_f32_dpp v146, v146, v146 row_ror:8 row_mask:0xf bank_mask:0xf
  v_add_f32_dpp v147, v147, v147 row_ror:8 row_mask:0xf bank_mask:0xf
  v_add_f32_dpp v148, v148, v148 row_ror:8 row_mask:0xf bank_mask:0xf
  v_add_f32_dpp v149, v149, v149 row_ror:8 row_mask:0xf bank_mask:0xf
  v_add_f32_dpp v150, v150, v150 row_ror:8 row_mask:0xf bank_mask:0xf
  v_add_f32_dpp v151, v151, v151 row_ror:8 row_mask:0xf bank_mask:0xf
  v_add_f32_dpp v144, v144, v144 row_ror:4 row_mask:0xf bank_mask:0xf
  v_add_f32_dpp v145, v145, v145 row_ror:4 row_mask:0xf bank_mask:0xf
  v_add_f32_dpp v146, v146, v146 row_ror:4 row_mask:0xf bank_mask:0xf
  v_add_f32_dpp v147, v147, v147 row_ror:4 row_mask:0xf bank_mask:0xf
  v_add_f32_dpp v148, v148, v148 row_ror:4 row_mask:0xf bank_mask:0xf
  v_add_f32_dpp v149, v149, v149 row_ror:4 row_mask:0xf bank_mask:0xf
  v_add_f32_dpp v150, v150, v150 row_ror:4 row_mask:0xf bank_mask:0xf
  v_add_f32_dpp v151, v151, v151 row_ror:4 row_mask:0xf bank_mask:0xf
  v_add_f32_dpp v144, v144, v144 row_ror:2 row_mask:0xf bank_mask:0xf
  v_add_f32_dpp v145, v145, v145 row_ror:2 row_mask:0xf bank_mask:0xf
  v_add_f32_dpp v146, v146, v146 row_ror:2 row_mask:0xf bank_mask:0xf
  v_add_f32_dpp v147, v147, v147 row_ror:2 row_mask:0xf bank_mask:0xf
  v_add_f32_dpp v148, v148, v148 row_ror:2 row_mask:0xf bank_mask:0xf
  v_add_f32_dpp v149, v149, v149 row_ror:2 row_mask:0xf bank_mask:0xf
  v_add_f32_dpp v150, v150, v150 row_ror:2 row_mask:0xf bank_mask:0xf
  v_add_f32_dpp v151, v151, v151 row_ror:2 row_mask:0xf bank_mask:0xf
  v_add_f32_dpp v144, v144, v144 row_ror:1 row_mask:0xf bank_mask:0xf
  v_add_f32_dpp v145, v145, v145 row_ror:1 row_mask:0xf bank_mask:0xf
  v_add_f32_dpp v146, v146, v146 row_ror:1 row_mask:0xf bank_mask:0xf
  v_add_f32_dpp v147, v147, v147 row_ror:1 row_mask:0xf bank_mask:0xf
  v_add_f32_dpp v148, v148, v148 row_ror:1 row_mask:0xf bank_mask:0xf
  v_add_f32_dpp v149, v149, v149 row_ror:1 row_mask:0xf bank_mask:0xf
  v_add_f32_dpp v150, v150, v150 row_ror:1 row_mask:0xf bank_mask:0xf
  v_add_f32_dpp v151, v151, v151 row_ror:1 row_mask:0xf bank_mask:0xf
  v_mov_b32 v152, v144
  v_mov_b32 v153, v145
  v_mov_b32 v154, v146
  v_mov_b32 v155, v147
  v_mov_b32 v156, v148
  v_mov_b32 v157, v149
  v_mov_b32 v158, v150
  v_mov_b32 v159, v151
  v_permlane32_swap_b32 v144, v152
  v_permlane32_swap_b32 v145, v153
  v_permlane32_swap_b32 v146, v154
  v_permlane32_swap_b32 v147, v155
  v_permlane32_swap_b32 v148, v156
  v_permlane32_swap_b32 v149, v157
  v_permlane32_swap_b32 v150, v158
  v_permlane32_swap_b32 v151, v159
  v_add_f32 v144, v144, v152
  v_add_f32 v145, v145, v153
  v_add_f32 v146, v146, v154
  v_add_f32 v147, v147, v155
  v_add_f32 v148, v148, v156
  v_add_f32 v149, v149, v157
  v_add_f32 v150, v150, v158
  v_add_f32 v151, v151, v159
  v_mov_b32 v152, v144
  v_mov_b32 v153, v145
  v_mov_b32 v154, v146
  v_mov_b32 v155, v147
  v_mov_b32 v156, v148
  v_mov_b32 v157, v149
  v_mov_b32 v158, v150
  v_mov_b32 v159, v151
  v_permlane16_swap_b32 v144, v152
  v_permlane16_swap_b32 v145, v153
  v_permlane16_swap_b32 v146, v154
  v_permlane16_swap_b32 v147, v155
  v_permlane16_swap_b32 v148, v156
  v_permlane16_swap_b32 v149, v157
  v_permlane16_swap_b32 v150, v158
  v_permlane16_swap_b32 v151, v159
  v_add_f32 v144, v144, v152
  v_add_f32 v145, v145, v153
  v_add_f32 v146, v146, v154
  v_add_f32 v147, v147, v155
  v_add_f32 v148, v148, v156
  v_add_f32 v149, v149, v157
  v_add_f32 v150, v150, v158
  v_add_f32 v151, v151, v159
  v_mov_b32 v24, v144
  v_cmp_eq_u32 vcc, 1, v1
  s_nop 1
  v_cndmask_b32 v24, v24, v145, vcc
  v_cmp_eq_u32 vcc, 2, v1
  s_nop 1
  v_cndmask_b32 v24, v24, v146, vcc
  v_cmp_eq_u32 vcc, 3, v1
  s_nop 1
  v_cndmask_b32 v24, v24, v147, vcc
  v_cmp_eq_u32 vcc, 4, v1
  s_nop 1
  v_cndmask_b32 v24, v24, v148, vcc
  v_cmp_eq_u32 vcc, 5, v1
  s_nop 1
  v_cndmask_b32 v24, v24, v149, vcc
  v_cmp_eq_u32 vcc, 6, v1
  s_nop 1
  v_cndmask_b32 v24, v24, v150, vcc
  v_cmp_eq_u32 vcc, 7, v1
  s_nop 1
  v_cndmask_b32 v24, v24, v151, vcc
  v_cvt_pk_bf16_f32 v25, v24, v24
  v_lshlrev_b32 v24, 16, v25
  v_mul_f32 v24, 0xbfb8aa3b, v24
  v_exp_f32 v24, v24
  s_nop 0
  v_add_f32 v24, 1.0, v24
  v_rcp_f32 v24, v24
  s_nop 0
  v_cvt_pk_bf16_f32 v25, v24, v24
  v_lshlrev_b32 v24, 16, v25
  s_lshl_b32 s21, s59, 2
  s_mov_b64 exec, 0xff
  buffer_store_dword v24, v5, s[28:31], s21 offen sc1
  s_mov_b64 exec, -1
  s_sub_u32 s59, s59, 1024
  s_waitcnt vmcnt(1)
  v_lshlrev_b32 v25, 16, v160
  v_and_b32 v26, 0xffff0000, v160
  v_mul_f32 v25, v25, v57
  v_mul_f32 v26, v26, v52
  v_cvt_pk_bf16_f32 v25, v25, v26
  v_lshlrev_b32 v26, 16, v25
  v_and_b32 v25, 0xffff0000, v25
  v_add_f32 v144, v25, v26
  v_lshlrev_b32 v25, 16, v161
  v_and_b32 v26, 0xffff0000, v161
  v_mul_f32 v25, v25, v58
  v_mul_f32 v26, v26, v53
  v_cvt_pk_bf16_f32 v25, v25, v26
  v_lshlrev_b32 v26, 16, v25
  v_and_b32 v25, 0xffff0000, v25
  v_add_f32 v144, v144, v26
  v_add_f32 v144, v144, v25
  v_lshlrev_b32 v25, 16, v162
  v_and_b32 v26, 0xffff0000, v162
  v_mul_f32 v25, v25, v59
  v_mul_f32 v26, v26, v54
  v_cvt_pk_bf16_f32 v25, v25, v26
  v_lshlrev_b32 v26, 16, v25
  v_and_b32 v25, 0xffff0000, v25
  v_add_f32 v144, v144, v26
  v_add_f32 v144, v144, v25
  v_lshlrev_b32 v25, 16, v163
  v_and_b32 v26, 0xffff0000, v163
  v_mul_f32 v25, v25, v60
  v_mul_f32 v26, v26, v55
  v_cvt_pk_bf16_f32 v25, v25, v26
  v_lshlrev_b32 v26, 16, v25
  v_and_b32 v25, 0xffff0000, v25
  v_add_f32 v144, v144, v26
  v_add_f32 v144, v144, v25
  v_lshlrev_b32 v25, 16, v164
  v_and_b32 v26, 0xffff0000, v164
  v_mul_f32 v25, v25, v61
  v_mul_f32 v26, v26, v56
  v_cvt_pk_bf16_f32 v25, v25, v26
  v_lshlrev_b32 v26, 16, v25
  v_and_b32 v25, 0xffff0000, v25
  v_add_f32 v144, v144, v26
  v_add_f32 v144, v144, v25
  v_lshlrev_b32 v25, 16, v166
  v_and_b32 v26, 0xffff0000, v166
  v_mul_f32 v25, v25, v57
  v_mul_f32 v26, v26, v52
  v_cvt_pk_bf16_f32 v25, v25, v26
  v_lshlrev_b32 v26, 16, v25
  v_and_b32 v25, 0xffff0000, v25
  v_add_f32 v145, v25, v26
  v_lshlrev_b32 v25, 16, v167
  v_and_b32 v26, 0xffff0000, v167
  v_mul_f32 v25, v25, v58
  v_mul_f32 v26, v26, v53
  v_cvt_pk_bf16_f32 v25, v25, v26
  v_lshlrev_b32 v26, 16, v25
  v_and_b32 v25, 0xffff0000, v25
  v_add_f32 v145, v145, v26
  v_add_f32 v145, v145, v25
  v_lshlrev_b32 v25, 16, v168
  v_and_b32 v26, 0xffff0000, v168
  v_mul_f32 v25, v25, v59
  v_mul_f32 v26, v26, v54
  v_cvt_pk_bf16_f32 v25, v25, v26
  v_lshlrev_b32 v26, 16, v25
  v_and_b32 v25, 0xffff0000, v25
  v_add_f32 v145, v145, v26
  v_add_f32 v145, v145, v25
  v_lshlrev_b32 v25, 16, v169
  v_and_b32 v26, 0xffff0000, v169
  v_mul_f32 v25, v25, v60
  v_mul_f32 v26, v26, v55
  v_cvt_pk_bf16_f32 v25, v25, v26
  v_lshlrev_b32 v26, 16, v25
  v_and_b32 v25, 0xffff0000, v25
  v_add_f32 v145, v145, v26
  v_add_f32 v145, v145, v25
  v_lshlrev_b32 v25, 16, v170
  v_and_b32 v26, 0xffff0000, v170
  v_mul_f32 v25, v25, v61
  v_mul_f32 v26, v26, v56
  v_cvt_pk_bf16_f32 v25, v25, v26
  v_lshlrev_b32 v26, 16, v25
  v_and_b32 v25, 0xffff0000, v25
  v_add_f32 v145, v145, v26
  v_add_f32 v145, v145, v25
  v_lshlrev_b32 v25, 16, v172
  v_and_b32 v26, 0xffff0000, v172
  v_mul_f32 v25, v25, v57
  v_mul_f32 v26, v26, v52
  v_cvt_pk_bf16_f32 v25, v25, v26
  v_lshlrev_b32 v26, 16, v25
  v_and_b32 v25, 0xffff0000, v25
  v_add_f32 v146, v25, v26
  v_lshlrev_b32 v25, 16, v173
  v_and_b32 v26, 0xffff0000, v173
  v_mul_f32 v25, v25, v58
  v_mul_f32 v26, v26, v53
  v_cvt_pk_bf16_f32 v25, v25, v26
  v_lshlrev_b32 v26, 16, v25
  v_and_b32 v25, 0xffff0000, v25
  v_add_f32 v146, v146, v26
  v_add_f32 v146, v146, v25
  v_lshlrev_b32 v25, 16, v174
  v_and_b32 v26, 0xffff0000, v174
  v_mul_f32 v25, v25, v59
  v_mul_f32 v26, v26, v54
  v_cvt_pk_bf16_f32 v25, v25, v26
  v_lshlrev_b32 v26, 16, v25
  v_and_b32 v25, 0xffff0000, v25
  v_add_f32 v146, v146, v26
  v_add_f32 v146, v146, v25
  v_lshlrev_b32 v25, 16, v175
  v_and_b32 v26, 0xffff0000, v175
  v_mul_f32 v25, v25, v60
  v_mul_f32 v26, v26, v55
  v_cvt_pk_bf16_f32 v25, v25, v26
  v_lshlrev_b32 v26, 16, v25
  v_and_b32 v25, 0xffff0000, v25
  v_add_f32 v146, v146, v26
  v_add_f32 v146, v146, v25
  v_lshlrev_b32 v25, 16, v176
  v_and_b32 v26, 0xffff0000, v176
  v_mul_f32 v25, v25, v61
  v_mul_f32 v26, v26, v56
  v_cvt_pk_bf16_f32 v25, v25, v26
  v_lshlrev_b32 v26, 16, v25
  v_and_b32 v25, 0xffff0000, v25
  v_add_f32 v146, v146, v26
  v_add_f32 v146, v146, v25
  v_lshlrev_b32 v25, 16, v178
  v_and_b32 v26, 0xffff0000, v178
  v_mul_f32 v25, v25, v57
  v_mul_f32 v26, v26, v52
  v_cvt_pk_bf16_f32 v25, v25, v26
  v_lshlrev_b32 v26, 16, v25
  v_and_b32 v25, 0xffff0000, v25
  v_add_f32 v147, v25, v26
  v_lshlrev_b32 v25, 16, v179
  v_and_b32 v26, 0xffff0000, v179
  v_mul_f32 v25, v25, v58
  v_mul_f32 v26, v26, v53
  v_cvt_pk_bf16_f32 v25, v25, v26
  v_lshlrev_b32 v26, 16, v25
  v_and_b32 v25, 0xffff0000, v25
  v_add_f32 v147, v147, v26
  v_add_f32 v147, v147, v25
  v_lshlrev_b32 v25, 16, v180
  v_and_b32 v26, 0xffff0000, v180
  v_mul_f32 v25, v25, v59
  v_mul_f32 v26, v26, v54
  v_cvt_pk_bf16_f32 v25, v25, v26
  v_lshlrev_b32 v26, 16, v25
  v_and_b32 v25, 0xffff0000, v25
  v_add_f32 v147, v147, v26
  v_add_f32 v147, v147, v25
  v_lshlrev_b32 v25, 16, v181
  v_and_b32 v26, 0xffff0000, v181
  v_mul_f32 v25, v25, v60
  v_mul_f32 v26, v26, v55
  v_cvt_pk_bf16_f32 v25, v25, v26
  v_lshlrev_b32 v26, 16, v25
  v_and_b32 v25, 0xffff0000, v25
  v_add_f32 v147, v147, v26
  v_add_f32 v147, v147, v25
  v_lshlrev_b32 v25, 16, v182
  v_and_b32 v26, 0xffff0000, v182
  v_mul_f32 v25, v25, v61
  v_mul_f32 v26, v26, v56
  v_cvt_pk_bf16_f32 v25, v25, v26
  v_lshlrev_b32 v26, 16, v25
  v_and_b32 v25, 0xffff0000, v25
  v_add_f32 v147, v147, v26
  v_add_f32 v147, v147, v25
  v_lshlrev_b32 v25, 16, v184
  v_and_b32 v26, 0xffff0000, v184
  v_mul_f32 v25, v25, v57
  v_mul_f32 v26, v26, v52
  v_cvt_pk_bf16_f32 v25, v25, v26
  v_lshlrev_b32 v26, 16, v25
  v_and_b32 v25, 0xffff0000, v25
  v_add_f32 v148, v25, v26
  v_lshlrev_b32 v25, 16, v185
  v_and_b32 v26, 0xffff0000, v185
  v_mul_f32 v25, v25, v58
  v_mul_f32 v26, v26, v53
  v_cvt_pk_bf16_f32 v25, v25, v26
  v_lshlrev_b32 v26, 16, v25
  v_and_b32 v25, 0xffff0000, v25
  v_add_f32 v148, v148, v26
  v_add_f32 v148, v148, v25
  v_lshlrev_b32 v25, 16, v186
  v_and_b32 v26, 0xffff0000, v186
  v_mul_f32 v25, v25, v59
  v_mul_f32 v26, v26, v54
  v_cvt_pk_bf16_f32 v25, v25, v26
  v_lshlrev_b32 v26, 16, v25
  v_and_b32 v25, 0xffff0000, v25
  v_add_f32 v148, v148, v26
  v_add_f32 v148, v148, v25
  v_lshlrev_b32 v25, 16, v187
  v_and_b32 v26, 0xffff0000, v187
  v_mul_f32 v25, v25, v60
  v_mul_f32 v26, v26, v55
  v_cvt_pk_bf16_f32 v25, v25, v26
  v_lshlrev_b32 v26, 16, v25
  v_and_b32 v25, 0xffff0000, v25
  v_add_f32 v148, v148, v26
  v_add_f32 v148, v148, v25
  v_lshlrev_b32 v25, 16, v188
  v_and_b32 v26, 0xffff0000, v188
  v_mul_f32 v25, v25, v61
  v_mul_f32 v26, v26, v56
  v_cvt_pk_bf16_f32 v25, v25, v26
  v_lshlrev_b32 v26, 16, v25
  v_and_b32 v25, 0xffff0000, v25
  v_add_f32 v148, v148, v26
  v_add_f32 v148, v148, v25
  v_lshlrev_b32 v25, 16, v190
  v_and_b32 v26, 0xffff0000, v190
  v_mul_f32 v25, v25, v57
  v_mul_f32 v26, v26, v52
  v_cvt_pk_bf16_f32 v25, v25, v26
  v_lshlrev_b32 v26, 16, v25
  v_and_b32 v25, 0xffff0000, v25
  v_add_f32 v149, v25, v26
  v_lshlrev_b32 v25, 16, v191
  v_and_b32 v26, 0xffff0000, v191
  v_mul_f32 v25, v25, v58
  v_mul_f32 v26, v26, v53
  v_cvt_pk_bf16_f32 v25, v25, v26
  v_lshlrev_b32 v26, 16, v25
  v_and_b32 v25, 0xffff0000, v25
  v_add_f32 v149, v149, v26
  v_add_f32 v149, v149, v25
  v_lshlrev_b32 v25, 16, v192
  v_and_b32 v26, 0xffff0000, v192
  v_mul_f32 v25, v25, v59
  v_mul_f32 v26, v26, v54
  v_cvt_pk_bf16_f32 v25, v25, v26
  v_lshlrev_b32 v26, 16, v25
  v_and_b32 v25, 0xffff0000, v25
  v_add_f32 v149, v149, v26
  v_add_f32 v149, v149, v25
  v_lshlrev_b32 v25, 16, v193
  v_and_b32 v26, 0xffff0000, v193
  v_mul_f32 v25, v25, v60
  v_mul_f32 v26, v26, v55
  v_cvt_pk_bf16_f32 v25, v25, v26
  v_lshlrev_b32 v26, 16, v25
  v_and_b32 v25, 0xffff0000, v25
  v_add_f32 v149, v149, v26
  v_add_f32 v149, v149, v25
  v_lshlrev_b32 v25, 16, v194
  v_and_b32 v26, 0xffff0000, v194
  v_mul_f32 v25, v25, v61
  v_mul_f32 v26, v26, v56
  v_cvt_pk_bf16_f32 v25, v25, v26
  v_lshlrev_b32 v26, 16, v25
  v_and_b32 v25, 0xffff0000, v25
  v_add_f32 v149, v149, v26
  v_add_f32 v149, v149, v25
  v_lshlrev_b32 v25, 16, v196
  v_and_b32 v26, 0xffff0000, v196
  v_mul_f32 v25, v25, v57
  v_mul_f32 v26, v26, v52
  v_cvt_pk_bf16_f32 v25, v25, v26
  v_lshlrev_b32 v26, 16, v25
  v_and_b32 v25, 0xffff0000, v25
  v_add_f32 v150, v25, v26
  v_lshlrev_b32 v25, 16, v197
  v_and_b32 v26, 0xffff0000, v197
  v_mul_f32 v25, v25, v58
  v_mul_f32 v26, v26, v53
  v_cvt_pk_bf16_f32 v25, v25, v26
  v_lshlrev_b32 v26, 16, v25
  v_and_b32 v25, 0xffff0000, v25
  v_add_f32 v150, v150, v26
  v_add_f32 v150, v150, v25
  v_lshlrev_b32 v25, 16, v198
  v_and_b32 v26, 0xffff0000, v198
  v_mul_f32 v25, v25, v59
  v_mul_f32 v26, v26, v54
  v_cvt_pk_bf16_f32 v25, v25, v26
  v_lshlrev_b32 v26, 16, v25
  v_and_b32 v25, 0xffff0000, v25
  v_add_f32 v150, v150, v26
  v_add_f32 v150, v150, v25
  v_lshlrev_b32 v25, 16, v199
  v_and_b32 v26, 0xffff0000, v199
  v_mul_f32 v25, v25, v60
  v_mul_f32 v26, v26, v55
  v_cvt_pk_bf16_f32 v25, v25, v26
  v_lshlrev_b32 v26, 16, v25
  v_and_b32 v25, 0xffff0000, v25
  v_add_f32 v150, v150, v26
  v_add_f32 v150, v150, v25
  v_lshlrev_b32 v25, 16, v200
  v_and_b32 v26, 0xffff0000, v200
  v_mul_f32 v25, v25, v61
  v_mul_f32 v26, v26, v56
  v_cvt_pk_bf16_f32 v25, v25, v26
  v_lshlrev_b32 v26, 16, v25
  v_and_b32 v25, 0xffff0000, v25
  v_add_f32 v150, v150, v26
  v_add_f32 v150, v150, v25
  v_lshlrev_b32 v25, 16, v202
  v_and_b32 v26, 0xffff0000, v202
  v_mul_f32 v25, v25, v57
  v_mul_f32 v26, v26, v52
  v_cvt_pk_bf16_f32 v25, v25, v26
  v_lshlrev_b32 v26, 16, v25
  v_and_b32 v25, 0xffff0000, v25
  v_add_f32 v151, v25, v26
  v_lshlrev_b32 v25, 16, v203
  v_and_b32 v26, 0xffff0000, v203
  v_mul_f32 v25, v25, v58
  v_mul_f32 v26, v26, v53
  v_cvt_pk_bf16_f32 v25, v25, v26
  v_lshlrev_b32 v26, 16, v25
  v_and_b32 v25, 0xffff0000, v25
  v_add_f32 v151, v151, v26
  v_add_f32 v151, v151, v25
  v_lshlrev_b32 v25, 16, v204
  v_and_b32 v26, 0xffff0000, v204
  v_mul_f32 v25, v25, v59
  v_mul_f32 v26, v26, v54
  v_cvt_pk_bf16_f32 v25, v25, v26
  v_lshlrev_b32 v26, 16, v25
  v_and_b32 v25, 0xffff0000, v25
  v_add_f32 v151, v151, v26
  v_add_f32 v151, v151, v25
  v_lshlrev_b32 v25, 16, v205
  v_and_b32 v26, 0xffff0000, v205
  v_mul_f32 v25, v25, v60
  v_mul_f32 v26, v26, v55
  v_cvt_pk_bf16_f32 v25, v25, v26
  v_lshlrev_b32 v26, 16, v25
  v_and_b32 v25, 0xffff0000, v25
  v_add_f32 v151, v151, v26
  v_add_f32 v151, v151, v25
  v_lshlrev_b32 v25, 16, v206
  v_and_b32 v26, 0xffff0000, v206
  v_mul_f32 v25, v25, v61
  v_mul_f32 v26, v26, v56
  v_cvt_pk_bf16_f32 v25, v25, v26
  v_lshlrev_b32 v26, 16, v25
  v_and_b32 v25, 0xffff0000, v25
  v_add_f32 v151, v151, v26
  v_add_f32 v151, v151, v25
  v_add_f32_dpp v144, v144, v144 row_ror:8 row_mask:0xf bank_mask:0xf
  v_add_f32_dpp v145, v145, v145 row_ror:8 row_mask:0xf bank_mask:0xf
  v_add_f32_dpp v146, v146, v146 row_ror:8 row_mask:0xf bank_mask:0xf
  v_add_f32_dpp v147, v147, v147 row_ror:8 row_mask:0xf bank_mask:0xf
  v_add_f32_dpp v148, v148, v148 row_ror:8 row_mask:0xf bank_mask:0xf
  v_add_f32_dpp v149, v149, v149 row_ror:8 row_mask:0xf bank_mask:0xf
  v_add_f32_dpp v150, v150, v150 row_ror:8 row_mask:0xf bank_mask:0xf
  v_add_f32_dpp v151, v151, v151 row_ror:8 row_mask:0xf bank_mask:0xf
  v_add_f32_dpp v144, v144, v144 row_ror:4 row_mask:0xf bank_mask:0xf
  v_add_f32_dpp v145, v145, v145 row_ror:4 row_mask:0xf bank_mask:0xf
  v_add_f32_dpp v146, v146, v146 row_ror:4 row_mask:0xf bank_mask:0xf
  v_add_f32_dpp v147, v147, v147 row_ror:4 row_mask:0xf bank_mask:0xf
  v_add_f32_dpp v148, v148, v148 row_ror:4 row_mask:0xf bank_mask:0xf
  v_add_f32_dpp v149, v149, v149 row_ror:4 row_mask:0xf bank_mask:0xf
  v_add_f32_dpp v150, v150, v150 row_ror:4 row_mask:0xf bank_mask:0xf
  v_add_f32_dpp v151, v151, v151 row_ror:4 row_mask:0xf bank_mask:0xf
  v_add_f32_dpp v144, v144, v144 row_ror:2 row_mask:0xf bank_mask:0xf
  v_add_f32_dpp v145, v145, v145 row_ror:2 row_mask:0xf bank_mask:0xf
  v_add_f32_dpp v146, v146, v146 row_ror:2 row_mask:0xf bank_mask:0xf
  v_add_f32_dpp v147, v147, v147 row_ror:2 row_mask:0xf bank_mask:0xf
  v_add_f32_dpp v148, v148, v148 row_ror:2 row_mask:0xf bank_mask:0xf
  v_add_f32_dpp v149, v149, v149 row_ror:2 row_mask:0xf bank_mask:0xf
  v_add_f32_dpp v150, v150, v150 row_ror:2 row_mask:0xf bank_mask:0xf
  v_add_f32_dpp v151, v151, v151 row_ror:2 row_mask:0xf bank_mask:0xf
  v_add_f32_dpp v144, v144, v144 row_ror:1 row_mask:0xf bank_mask:0xf
  v_add_f32_dpp v145, v145, v145 row_ror:1 row_mask:0xf bank_mask:0xf
  v_add_f32_dpp v146, v146, v146 row_ror:1 row_mask:0xf bank_mask:0xf
  v_add_f32_dpp v147, v147, v147 row_ror:1 row_mask:0xf bank_mask:0xf
  v_add_f32_dpp v148, v148, v148 row_ror:1 row_mask:0xf bank_mask:0xf
  v_add_f32_dpp v149, v149, v149 row_ror:1 row_mask:0xf bank_mask:0xf
  v_add_f32_dpp v150, v150, v150 row_ror:1 row_mask:0xf bank_mask:0xf
  v_add_f32_dpp v151, v151, v151 row_ror:1 row_mask:0xf bank_mask:0xf
  v_mov_b32 v152, v144
  v_mov_b32 v153, v145
  v_mov_b32 v154, v146
  v_mov_b32 v155, v147
  v_mov_b32 v156, v148
  v_mov_b32 v157, v149
  v_mov_b32 v158, v150
  v_mov_b32 v159, v151
  v_permlane32_swap_b32 v144, v152
  v_permlane32_swap_b32 v145, v153
  v_permlane32_swap_b32 v146, v154
  v_permlane32_swap_b32 v147, v155
  v_permlane32_swap_b32 v148, v156
  v_permlane32_swap_b32 v149, v157
  v_permlane32_swap_b32 v150, v158
  v_permlane32_swap_b32 v151, v159
  v_add_f32 v144, v144, v152
  v_add_f32 v145, v145, v153
  v_add_f32 v146, v146, v154
  v_add_f32 v147, v147, v155
  v_add_f32 v148, v148, v156
  v_add_f32 v149, v149, v157
  v_add_f32 v150, v150, v158
  v_add_f32 v151, v151, v159
  v_mov_b32 v152, v144
  v_mov_b32 v153, v145
  v_mov_b32 v154, v146
  v_mov_b32 v155, v147
  v_mov_b32 v156, v148
  v_mov_b32 v157, v149
  v_mov_b32 v158, v150
  v_mov_b32 v159, v151
  v_permlane16_swap_b32 v144, v152
  v_permlane16_swap_b32 v145, v153
  v_permlane16_swap_b32 v146, v154
  v_permlane16_swap_b32 v147, v155
  v_permlane16_swap_b32 v148, v156
  v_permlane16_swap_b32 v149, v157
  v_permlane16_swap_b32 v150, v158
  v_permlane16_swap_b32 v151, v159
  v_add_f32 v144, v144, v152
  v_add_f32 v145, v145, v153
  v_add_f32 v146, v146, v154
  v_add_f32 v147, v147, v155
  v_add_f32 v148, v148, v156
  v_add_f32 v149, v149, v157
  v_add_f32 v150, v150, v158
  v_add_f32 v151, v151, v159
  v_mov_b32 v24, v144
  v_cmp_eq_u32 vcc, 1, v1
  s_nop 1
  v_cndmask_b32 v24, v24, v145, vcc
  v_cmp_eq_u32 vcc, 2, v1
  s_nop 1
  v_cndmask_b32 v24, v24, v146, vcc
  v_cmp_eq_u32 vcc, 3, v1
  s_nop 1
  v_cndmask_b32 v24, v24, v147, vcc
  v_cmp_eq_u32 vcc, 4, v1
  s_nop 1
  v_cndmask_b32 v24, v24, v148, vcc
  v_cmp_eq_u32 vcc, 5, v1
  s_nop 1
  v_cndmask_b32 v24, v24, v149, vcc
  v_cmp_eq_u32 vcc, 6, v1
  s_nop 1
  v_cndmask_b32 v24, v24, v150, vcc
  v_cmp_eq_u32 vcc, 7, v1
  s_nop 1
  v_cndmask_b32 v24, v24, v151, vcc
  v_cvt_pk_bf16_f32 v25, v24, v24
  v_lshlrev_b32 v24, 16, v25
  v_mul_f32 v24, 0xbfb8aa3b, v24
  v_exp_f32 v24, v24
  s_nop 0
  v_add_f32 v24, 1.0, v24
  v_rcp_f32 v24, v24
  s_nop 0
  v_cvt_pk_bf16_f32 v25, v24, v24
  v_lshlrev_b32 v24, 16, v25
  s_lshl_b32 s21, s59, 2
  s_mov_b64 exec, 0xff
  buffer_store_dword v24, v5, s[28:31], s21 offen sc1
  s_mov_b64 exec, -1
  s_waitcnt vmcnt(0)
  s_barrier
  s_lshr_b32 s21, s2, 2
  s_lshl_b32 s21, s21, 7
  s_add_u32 s21, s21, 93184
  s_cmp_lg_u32 s20, 0
  s_cbranch_scc1 af_284
  v_mov_b32 v10, 0
  v_mov_b32 v11, 1
  s_mov_b64 exec, 1
  buffer_atomic_add v11, v10, s[72:75], s21 offen sc1
  s_mov_b64 exec, -1
  s_nop 1
af_284:
  s_branch om_283
om_282:
  s_load_dwordx2 s[8:9], s[0:1], 88
  s_mov_b32 s51, s21
  s_lshr_b32 s52, s2, 2
  s_lshl_b32 s52, s52, 7
  s_add_u32 s21, s52, 94208
  s_cmp_lg_u32 s20, 0
  s_cbranch_scc1 wf_286
  v_mov_b32 v20, 0
  s_mov_b32 s101, 0
wf_285:
  buffer_load_dword v21, v20, s[72:75], s21 offen sc1
  s_add_u32 s101, s101, 1
  s_cmp_gt_u32 s101, 131072
  s_cbranch_scc1 main_end
  s_waitcnt vmcnt(0)
  v_readfirstlane_b32 s100, v21
  s_cmp_ge_u32 s100, 4
  s_cbranch_scc1 wf_286
  s_sleep 32
  s_branch wf_285
wf_286:
  s_barrier
  s_add_u32 s21, s52, 104448
  s_cmp_lg_u32 s20, 0
  s_cbranch_scc1 wf_288
  v_mov_b32 v20, 0
  s_mov_b32 s101, 0
wf_287:
  buffer_load_dword v21, v20, s[72:75], s21 offen sc1
  s_add_u32 s101, s101, 1
  s_cmp_gt_u32 s101, 131072
  s_cbranch_scc1 main_end
  s_waitcnt vmcnt(0)
  v_readfirstlane_b32 s100, v21
  s_cmp_ge_u32 s100, 32
  s_cbranch_scc1 wf_288
  s_sleep 32
  s_branch wf_287
wf_288:
  s_barrier
  v_lshlrev_b32 v6, 2, v2
  s_lshl_b32 s22, s47, 6
  buffer_load_dword v30, v6, s[28:31], s22 offen sc1
  buffer_load_dword v31, v6, s[28:31], s22 offen offset:64 sc1
  s_add_u32 s22, s51, 0
  buffer_load_dwordx4 v[144:147], v4, s[16:19], s22 offen offset:0 sc1
  buffer_load_dwordx4 v[148:151], v4, s[16:19], s22 offen offset:1024 sc1
  buffer_load_dwordx4 v[152:155], v4, s[16:19], s22 offen offset:2048 sc1
  buffer_load_dwordx4 v[156:159], v4, s[16:19], s22 offen offset:3072 sc1
  s_add_u32 s22, s51, 4096
  buffer_load_dwordx4 v[160:163], v4, s[16:19], s22 offen offset:0 sc1
  buffer_load_dwordx4 v[164:167], v4, s[16:19], s22 offen offset:1024 sc1
  buffer_load_dwordx4 v[168:171], v4, s[16:19], s22 offen offset:2048 sc1
  buffer_load_dwordx4 v[172:175], v4, s[16:19], s22 offen offset:3072 sc1
  s_add_u32 s22, s51, 8192
  buffer_load_dwordx4 v[176:179], v4, s[16:19], s22 offen offset:0 sc1
  buffer_load_dwordx4 v[180:183], v4, s[16:19], s22 offen offset:1024 sc1
  s_add_u32 s22, s51, 40960
  buffer_load_dwordx4 v[184:187], v4, s[16:19], s22 offen offset:0 sc1
  buffer_load_dwordx4 v[188:191], v4, s[16:19], s22 offen offset:1024 sc1
  buffer_load_dwordx4 v[192:195], v4, s[16:19], s22 offen offset:2048 sc1
  buffer_load_dwordx4 v[196:199], v4, s[16:19], s22 offen offset:3072 sc1
  s_add_u32 s22, s51, 45056
  buffer_load_dwordx4 v[200:203], v4, s[16:19], s22 offen offset:0 sc1
  buffer_load_dwordx4 v[204:207], v4, s[16:19], s22 offen offset:1024 sc1
  buffer_load_dwordx4 v[208:211], v4, s[16:19], s22 offen offset:2048 sc1
  buffer_load_dwordx4 v[212:215], v4, s[16:19], s22 offen offset:3072 sc1
  s_add_u32 s22, s51, 49152
  buffer_load_dwordx4 v[216:219], v4, s[16:19], s22 offen offset:0 sc1
  buffer_load_dwordx4 v[220:223], v4, s[16:19], s22 offen offset:1024 sc1
  v_mul_u32_u24 v9, 1280, v2
  v_lshl_add_u32 v9, v3, 3, v9
  s_mul_i32 s22, s47, 20480
  s_add_u32 s22, s22, s45
  s_add_u32 s23, s22, 20480
  s_waitcnt vmcnt(20) lgkmcnt(0)
  v_sub_f32 v32, 1.0, v30
  v_sub_f32 v33, 1.0, v31
  v_cvt_pk_bf16_f32 v26, v32, v33
  v_lshlrev_b32 v32, 16, v26
  v_and_b32 v33, 0xffff0000, v26
  v_cvt_pk_bf16_f32 v26, v64, v65
  v_lshlrev_b32 v64, 16, v26
  v_and_b32 v65, 0xffff0000, v26
  v_mul_f32 v64, v64, v32
  v_mul_f32 v65, v65, v32
  v_cvt_pk_bf16_f32 v26, v64, v65
  v_lshlrev_b32 v64, 16, v26
  v_and_b32 v65, 0xffff0000, v26
  v_cvt_pk_bf16_f32 v26, v66, v67
  v_lshlrev_b32 v66, 16, v26
  v_and_b32 v67, 0xffff0000, v26
  v_mul_f32 v66, v66, v32
  v_mul_f32 v67, v67, v32
  v_cvt_pk_bf16_f32 v26, v66, v67
  v_lshlrev_b32 v66, 16, v26
  v_and_b32 v67, 0xffff0000, v26
  v_cvt_pk_bf16_f32 v26, v68, v69
  v_lshlrev_b32 v68, 16, v26
  v_and_b32 v69, 0xffff0000, v26
  v_mul_f32 v68, v68, v32
  v_mul_f32 v69, v69, v32
  v_cvt_pk_bf16_f32 v26, v68, v69
  v_lshlrev_b32 v68, 16, v26
  v_and_b32 v69, 0xffff0000, v26
  v_cvt_pk_bf16_f32 v26, v70, v71
  v_lshlrev_b32 v70, 16, v26
  v_and_b32 v71, 0xffff0000, v26
  v_mul_f32 v70, v70, v32
  v_mul_f32 v71, v71, v32
  v_cvt_pk_bf16_f32 v26, v70, v71
  v_lshlrev_b32 v70, 16, v26
  v_and_b32 v71, 0xffff0000, v26
  v_cvt_pk_bf16_f32 v26, v72, v73
  v_lshlrev_b32 v72, 16, v26
  v_and_b32 v73, 0xffff0000, v26
  v_mul_f32 v72, v72, v32
  v_mul_f32 v73, v73, v32
  v_cvt_pk_bf16_f32 v26, v72, v73
  v_lshlrev_b32 v72, 16, v26
  v_and_b32 v73, 0xffff0000, v26
  v_cvt_pk_bf16_f32 v26, v74, v75
  v_lshlrev_b32 v74, 16, v26
  v_and_b32 v75, 0xffff0000, v26
  v_mul_f32 v74, v74, v32
  v_mul_f32 v75, v75, v32
  v_cvt_pk_bf16_f32 v26, v74, v75
  v_lshlrev_b32 v74, 16, v26
  v_and_b32 v75, 0xffff0000, v26
  v_cvt_pk_bf16_f32 v26, v76, v77
  v_lshlrev_b32 v76, 16, v26
  v_and_b32 v77, 0xffff0000, v26
  v_mul_f32 v76, v76, v32
  v_mul_f32 v77, v77, v32
  v_cvt_pk_bf16_f32 v26, v76, v77
  v_lshlrev_b32 v76, 16, v26
  v_and_b32 v77, 0xffff0000, v26
  v_cvt_pk_bf16_f32 v26, v78, v79
  v_lshlrev_b32 v78, 16, v26
  v_and_b32 v79, 0xffff0000, v26
  v_mul_f32 v78, v78, v32
  v_mul_f32 v79, v79, v32
  v_cvt_pk_bf16_f32 v26, v78, v79
  v_lshlrev_b32 v78, 16, v26
  v_and_b32 v79, 0xffff0000, v26
  v_cvt_pk_bf16_f32 v26, v80, v81
  v_lshlrev_b32 v80, 16, v26
  v_and_b32 v81, 0xffff0000, v26
  v_mul_f32 v80, v80, v32
  v_mul_f32 v81, v81, v32
  v_cvt_pk_bf16_f32 v26, v80, v81
  v_lshlrev_b32 v80, 16, v26
  v_and_b32 v81, 0xffff0000, v26
  v_cvt_pk_bf16_f32 v26, v82, v83
  v_lshlrev_b32 v82, 16, v26
  v_and_b32 v83, 0xffff0000, v26
  v_mul_f32 v82, v82, v32
  v_mul_f32 v83, v83, v32
  v_cvt_pk_bf16_f32 v26, v82, v83
  v_lshlrev_b32 v82, 16, v26
  v_and_b32 v83, 0xffff0000, v26
  v_cvt_pk_bf16_f32 v26, v84, v85
  v_lshlrev_b32 v84, 16, v26
  v_and_b32 v85, 0xffff0000, v26
  v_mul_f32 v84, v84, v32
  v_mul_f32 v85, v85, v32
  v_cvt_pk_bf16_f32 v26, v84, v85
  v_lshlrev_b32 v84, 16, v26
  v_and_b32 v85, 0xffff0000, v26
  v_cvt_pk_bf16_f32 v26, v86, v87
  v_lshlrev_b32 v86, 16, v26
  v_and_b32 v87, 0xffff0000, v26
  v_mul_f32 v86, v86, v32
  v_mul_f32 v87, v87, v32
  v_cvt_pk_bf16_f32 v26, v86, v87
  v_lshlrev_b32 v86, 16, v26
  v_and_b32 v87, 0xffff0000, v26
  v_cvt_pk_bf16_f32 v26, v88, v89
  v_lshlrev_b32 v88, 16, v26
  v_and_b32 v89, 0xffff0000, v26
  v_mul_f32 v88, v88, v32
  v_mul_f32 v89, v89, v32
  v_cvt_pk_bf16_f32 v26, v88, v89
  v_lshlrev_b32 v88, 16, v26
  v_and_b32 v89, 0xffff0000, v26
  v_cvt_pk_bf16_f32 v26, v90, v91
  v_lshlrev_b32 v90, 16, v26
  v_and_b32 v91, 0xffff0000, v26
  v_mul_f32 v90, v90, v32
  v_mul_f32 v91, v91, v32
  v_cvt_pk_bf16_f32 v26, v90, v91
  v_lshlrev_b32 v90, 16, v26
  v_and_b32 v91, 0xffff0000, v26
  v_cvt_pk_bf16_f32 v26, v92, v93
  v_lshlrev_b32 v92, 16, v26
  v_and_b32 v93, 0xffff0000, v26
  v_mul_f32 v92, v92, v32
  v_mul_f32 v93, v93, v32
  v_cvt_pk_bf16_f32 v26, v92, v93
  v_lshlrev_b32 v92, 16, v26
  v_and_b32 v93, 0xffff0000, v26
  v_cvt_pk_bf16_f32 v26, v94, v95
  v_lshlrev_b32 v94, 16, v26
  v_and_b32 v95, 0xffff0000, v26
  v_mul_f32 v94, v94, v32
  v_mul_f32 v95, v95, v32
  v_cvt_pk_bf16_f32 v26, v94, v95
  v_lshlrev_b32 v94, 16, v26
  v_and_b32 v95, 0xffff0000, v26
  v_cvt_pk_bf16_f32 v26, v96, v97
  v_lshlrev_b32 v96, 16, v26
  v_and_b32 v97, 0xffff0000, v26
  v_mul_f32 v96, v96, v32
  v_mul_f32 v97, v97, v32
  v_cvt_pk_bf16_f32 v26, v96, v97
  v_lshlrev_b32 v96, 16, v26
  v_and_b32 v97, 0xffff0000, v26
  v_cvt_pk_bf16_f32 v26, v98, v99
  v_lshlrev_b32 v98, 16, v26
  v_and_b32 v99, 0xffff0000, v26
  v_mul_f32 v98, v98, v32
  v_mul_f32 v99, v99, v32
  v_cvt_pk_bf16_f32 v26, v98, v99
  v_lshlrev_b32 v98, 16, v26
  v_and_b32 v99, 0xffff0000, v26
  v_cvt_pk_bf16_f32 v26, v100, v101
  v_lshlrev_b32 v100, 16, v26
  v_and_b32 v101, 0xffff0000, v26
  v_mul_f32 v100, v100, v32
  v_mul_f32 v101, v101, v32
  v_cvt_pk_bf16_f32 v26, v100, v101
  v_lshlrev_b32 v100, 16, v26
  v_and_b32 v101, 0xffff0000, v26
  v_cvt_pk_bf16_f32 v26, v102, v103
  v_lshlrev_b32 v102, 16, v26
  v_and_b32 v103, 0xffff0000, v26
  v_mul_f32 v102, v102, v32
  v_mul_f32 v103, v103, v32
  v_cvt_pk_bf16_f32 v26, v102, v103
  v_lshlrev_b32 v102, 16, v26
  v_and_b32 v103, 0xffff0000, v26
  v_cvt_pk_bf16_f32 v26, v104, v105
  v_lshlrev_b32 v104, 16, v26
  v_and_b32 v105, 0xffff0000, v26
  v_mul_f32 v104, v104, v33
  v_mul_f32 v105, v105, v33
  v_cvt_pk_bf16_f32 v26, v104, v105
  v_lshlrev_b32 v104, 16, v26
  v_and_b32 v105, 0xffff0000, v26
  v_cvt_pk_bf16_f32 v26, v106, v107
  v_lshlrev_b32 v106, 16, v26
  v_and_b32 v107, 0xffff0000, v26
  v_mul_f32 v106, v106, v33
  v_mul_f32 v107, v107, v33
  v_cvt_pk_bf16_f32 v26, v106, v107
  v_lshlrev_b32 v106, 16, v26
  v_and_b32 v107, 0xffff0000, v26
  v_cvt_pk_bf16_f32 v26, v108, v109
  v_lshlrev_b32 v108, 16, v26
  v_and_b32 v109, 0xffff0000, v26
  v_mul_f32 v108, v108, v33
  v_mul_f32 v109, v109, v33
  v_cvt_pk_bf16_f32 v26, v108, v109
  v_lshlrev_b32 v108, 16, v26
  v_and_b32 v109, 0xffff0000, v26
  v_cvt_pk_bf16_f32 v26, v110, v111
  v_lshlrev_b32 v110, 16, v26
  v_and_b32 v111, 0xffff0000, v26
  v_mul_f32 v110, v110, v33
  v_mul_f32 v111, v111, v33
  v_cvt_pk_bf16_f32 v26, v110, v111
  v_lshlrev_b32 v110, 16, v26
  v_and_b32 v111, 0xffff0000, v26
  v_cvt_pk_bf16_f32 v26, v112, v113
  v_lshlrev_b32 v112, 16, v26
  v_and_b32 v113, 0xffff0000, v26
  v_mul_f32 v112, v112, v33
  v_mul_f32 v113, v113, v33
  v_cvt_pk_bf16_f32 v26, v112, v113
  v_lshlrev_b32 v112, 16, v26
  v_and_b32 v113, 0xffff0000, v26
  v_cvt_pk_bf16_f32 v26, v114, v115
  v_lshlrev_b32 v114, 16, v26
  v_and_b32 v115, 0xffff0000, v26
  v_mul_f32 v114, v114, v33
  v_mul_f32 v115, v115, v33
  v_cvt_pk_bf16_f32 v26, v114, v115
  v_lshlrev_b32 v114, 16, v26
  v_and_b32 v115, 0xffff0000, v26
  v_cvt_pk_bf16_f32 v26, v116, v117
  v_lshlrev_b32 v116, 16, v26
  v_and_b32 v117, 0xffff0000, v26
  v_mul_f32 v116, v116, v33
  v_mul_f32 v117, v117, v33
  v_cvt_pk_bf16_f32 v26, v116, v117
  v_lshlrev_b32 v116, 16, v26
  v_and_b32 v117, 0xffff0000, v26
  v_cvt_pk_bf16_f32 v26, v118, v119
  v_lshlrev_b32 v118, 16, v26
  v_and_b32 v119, 0xffff0000, v26
  v_mul_f32 v118, v118, v33
  v_mul_f32 v119, v119, v33
  v_cvt_pk_bf16_f32 v26, v118, v119
  v_lshlrev_b32 v118, 16, v26
  v_and_b32 v119, 0xffff0000, v26
  v_cvt_pk_bf16_f32 v26, v120, v121
  v_lshlrev_b32 v120, 16, v26
  v_and_b32 v121, 0xffff0000, v26
  v_mul_f32 v120, v120, v33
  v_mul_f32 v121, v121, v33
  v_cvt_pk_bf16_f32 v26, v120, v121
  v_lshlrev_b32 v120, 16, v26
  v_and_b32 v121, 0xffff0000, v26
  v_cvt_pk_bf16_f32 v26, v122, v123
  v_lshlrev_b32 v122, 16, v26
  v_and_b32 v123, 0xffff0000, v26
  v_mul_f32 v122, v122, v33
  v_mul_f32 v123, v123, v33
  v_cvt_pk_bf16_f32 v26, v122, v123
  v_lshlrev_b32 v122, 16, v26
  v_and_b32 v123, 0xffff0000, v26
  v_cvt_pk_bf16_f32 v26, v124, v125
  v_lshlrev_b32 v124, 16, v26
  v_and_b32 v125, 0xffff0000, v26
  v_mul_f32 v124, v124, v33
  v_mul_f32 v125, v125, v33
  v_cvt_pk_bf16_f32 v26, v124, v125
  v_lshlrev_b32 v124, 16, v26
  v_and_b32 v125, 0xffff0000, v26
  v_cvt_pk_bf16_f32 v26, v126, v127
  v_lshlrev_b32 v126, 16, v26
  v_and_b32 v127, 0xffff0000, v26
  v_mul_f32 v126, v126, v33
  v_mul_f32 v127, v127, v33
  v_cvt_pk_bf16_f32 v26, v126, v127
  v_lshlrev_b32 v126, 16, v26
  v_and_b32 v127, 0xffff0000, v26
  v_cvt_pk_bf16_f32 v26, v128, v129
  v_lshlrev_b32 v128, 16, v26
  v_and_b32 v129, 0xffff0000, v26
  v_mul_f32 v128, v128, v33
  v_mul_f32 v129, v129, v33
  v_cvt_pk_bf16_f32 v26, v128, v129
  v_lshlrev_b32 v128, 16, v26
  v_and_b32 v129, 0xffff0000, v26
  v_cvt_pk_bf16_f32 v26, v130, v131
  v_lshlrev_b32 v130, 16, v26
  v_and_b32 v131, 0xffff0000, v26
  v_mul_f32 v130, v130, v33
  v_mul_f32 v131, v131, v33
  v_cvt_pk_bf16_f32 v26, v130, v131
  v_lshlrev_b32 v130, 16, v26
  v_and_b32 v131, 0xffff0000, v26
  v_cvt_pk_bf16_f32 v26, v132, v133
  v_lshlrev_b32 v132, 16, v26
  v_and_b32 v133, 0xffff0000, v26
  v_mul_f32 v132, v132, v33
  v_mul_f32 v133, v133, v33
  v_cvt_pk_bf16_f32 v26, v132, v133
  v_lshlrev_b32 v132, 16, v26
  v_and_b32 v133, 0xffff0000, v26
  v_cvt_pk_bf16_f32 v26, v134, v135
  v_lshlrev_b32 v134, 16, v26
  v_and_b32 v135, 0xffff0000, v26
  v_mul_f32 v134, v134, v33
  v_mul_f32 v135, v135, v33
  v_cvt_pk_bf16_f32 v26, v134, v135
  v_lshlrev_b32 v134, 16, v26
  v_and_b32 v135, 0xffff0000, v26
  v_cvt_pk_bf16_f32 v26, v136, v137
  v_lshlrev_b32 v136, 16, v26
  v_and_b32 v137, 0xffff0000, v26
  v_mul_f32 v136, v136, v33
  v_mul_f32 v137, v137, v33
  v_cvt_pk_bf16_f32 v26, v136, v137
  v_lshlrev_b32 v136, 16, v26
  v_and_b32 v137, 0xffff0000, v26
  v_cvt_pk_bf16_f32 v26, v138, v139
  v_lshlrev_b32 v138, 16, v26
  v_and_b32 v139, 0xffff0000, v26
  v_mul_f32 v138, v138, v33
  v_mul_f32 v139, v139, v33
  v_cvt_pk_bf16_f32 v26, v138, v139
  v_lshlrev_b32 v138, 16, v26
  v_and_b32 v139, 0xffff0000, v26
  v_cvt_pk_bf16_f32 v26, v140, v141
  v_lshlrev_b32 v140, 16, v26
  v_and_b32 v141, 0xffff0000, v26
  v_mul_f32 v140, v140, v33
  v_mul_f32 v141, v141, v33
  v_cvt_pk_bf16_f32 v26, v140, v141
  v_lshlrev_b32 v140, 16, v26
  v_and_b32 v141, 0xffff0000, v26
  v_cvt_pk_bf16_f32 v26, v142, v143
  v_lshlrev_b32 v142, 16, v26
  v_and_b32 v143, 0xffff0000, v26
  v_mul_f32 v142, v142, v33
  v_mul_f32 v143, v143, v33
  v_cvt_pk_bf16_f32 v26, v142, v143
  v_lshlrev_b32 v142, 16, v26
  v_and_b32 v143, 0xffff0000, v26
  s_waitcnt vmcnt(19)
  v_cvt_pk_bf16_f32 v26, v144, v145
  v_lshlrev_b32 v144, 16, v26
  v_and_b32 v145, 0xffff0000, v26
  v_mul_f32 v144, v144, v30
  v_mul_f32 v145, v145, v30
  v_cvt_pk_bf16_f32 v26, v144, v145
  v_lshlrev_b32 v144, 16, v26
  v_and_b32 v145, 0xffff0000, v26
  v_add_f32 v144, v144, v64
  v_add_f32 v145, v145, v65
  v_cvt_pk_bf16_f32 v64, v144, v145
  v_cvt_pk_bf16_f32 v26, v146, v147
  v_lshlrev_b32 v146, 16, v26
  v_and_b32 v147, 0xffff0000, v26
  v_mul_f32 v146, v146, v30
  v_mul_f32 v147, v147, v30
  v_cvt_pk_bf16_f32 v26, v146, v147
  v_lshlrev_b32 v146, 16, v26
  v_and_b32 v147, 0xffff0000, v26
  v_add_f32 v146, v146, v66
  v_add_f32 v147, v147, v67
  v_cvt_pk_bf16_f32 v65, v146, v147
  buffer_store_dwordx2 v[64:65], v9, s[8:11], s22 offen offset:0
  s_waitcnt vmcnt(19)
  v_cvt_pk_bf16_f32 v26, v148, v149
  v_lshlrev_b32 v148, 16, v26
  v_and_b32 v149, 0xffff0000, v26
  v_mul_f32 v148, v148, v30
  v_mul_f32 v149, v149, v30
  v_cvt_pk_bf16_f32 v26, v148, v149
  v_lshlrev_b32 v148, 16, v26
  v_and_b32 v149, 0xffff0000, v26
  v_add_f32 v148, v148, v68
  v_add_f32 v149, v149, v69
  v_cvt_pk_bf16_f32 v68, v148, v149
  v_cvt_pk_bf16_f32 v26, v150, v151
  v_lshlrev_b32 v150, 16, v26
  v_and_b32 v151, 0xffff0000, v26
  v_mul_f32 v150, v150, v30
  v_mul_f32 v151, v151, v30
  v_cvt_pk_bf16_f32 v26, v150, v151
  v_lshlrev_b32 v150, 16, v26
  v_and_b32 v151, 0xffff0000, v26
  v_add_f32 v150, v150, v70
  v_add_f32 v151, v151, v71
  v_cvt_pk_bf16_f32 v69, v150, v151
  buffer_store_dwordx2 v[68:69], v9, s[8:11], s22 offen offset:32
  s_waitcnt vmcnt(19)
  v_cvt_pk_bf16_f32 v26, v152, v153
  v_lshlrev_b32 v152, 16, v26
  v_and_b32 v153, 0xffff0000, v26
  v_mul_f32 v152, v152, v30
  v_mul_f32 v153, v153, v30
  v_cvt_pk_bf16_f32 v26, v152, v153
  v_lshlrev_b32 v152, 16, v26
  v_and_b32 v153, 0xffff0000, v26
  v_add_f32 v152, v152, v72
  v_add_f32 v153, v153, v73
  v_cvt_pk_bf16_f32 v72, v152, v153
  v_cvt_pk_bf16_f32 v26, v154, v155
  v_lshlrev_b32 v154, 16, v26
  v_and_b32 v155, 0xffff0000, v26
  v_mul_f32 v154, v154, v30
  v_mul_f32 v155, v155, v30
  v_cvt_pk_bf16_f32 v26, v154, v155
  v_lshlrev_b32 v154, 16, v26
  v_and_b32 v155, 0xffff0000, v26
  v_add_f32 v154, v154, v74
  v_add_f32 v155, v155, v75
  v_cvt_pk_bf16_f32 v73, v154, v155
  buffer_store_dwordx2 v[72:73], v9, s[8:11], s22 offen offset:64
  s_waitcnt vmcnt(19)
  v_cvt_pk_bf16_f32 v26, v156, v157
  v_lshlrev_b32 v156, 16, v26
  v_and_b32 v157, 0xffff0000, v26
  v_mul_f32 v156, v156, v30
  v_mul_f32 v157, v157, v30
  v_cvt_pk_bf16_f32 v26, v156, v157
  v_lshlrev_b32 v156, 16, v26
  v_and_b32 v157, 0xffff0000, v26
  v_add_f32 v156, v156, v76
  v_add_f32 v157, v157, v77
  v_cvt_pk_bf16_f32 v76, v156, v157
  v_cvt_pk_bf16_f32 v26, v158, v159
  v_lshlrev_b32 v158, 16, v26
  v_and_b32 v159, 0xffff0000, v26
  v_mul_f32 v158, v158, v30
  v_mul_f32 v159, v159, v30
  v_cvt_pk_bf16_f32 v26, v158, v159
  v_lshlrev_b32 v158, 16, v26
  v_and_b32 v159, 0xffff0000, v26
  v_add_f32 v158, v158, v78
  v_add_f32 v159, v159, v79
  v_cvt_pk_bf16_f32 v77, v158, v159
  buffer_store_dwordx2 v[76:77], v9, s[8:11], s22 offen offset:96
  s_waitcnt vmcnt(19)
  v_cvt_pk_bf16_f32 v26, v160, v161
  v_lshlrev_b32 v160, 16, v26
  v_and_b32 v161, 0xffff0000, v26
  v_mul_f32 v160, v160, v30
  v_mul_f32 v161, v161, v30
  v_cvt_pk_bf16_f32 v26, v160, v161
  v_lshlrev_b32 v160, 16, v26
  v_and_b32 v161, 0xffff0000, v26
  v_add_f32 v160, v160, v80
  v_add_f32 v161, v161, v81
  v_cvt_pk_bf16_f32 v80, v160, v161
  v_cvt_pk_bf16_f32 v26, v162, v163
  v_lshlrev_b32 v162, 16, v26
  v_and_b32 v163, 0xffff0000, v26
  v_mul_f32 v162, v162, v30
  v_mul_f32 v163, v163, v30
  v_cvt_pk_bf16_f32 v26, v162, v163
  v_lshlrev_b32 v162, 16, v26
  v_and_b32 v163, 0xffff0000, v26
  v_add_f32 v162, v162, v82
  v_add_f32 v163, v163, v83
  v_cvt_pk_bf16_f32 v81, v162, v163
  buffer_store_dwordx2 v[80:81], v9, s[8:11], s22 offen offset:128
  s_waitcnt vmcnt(19)
  v_cvt_pk_bf16_f32 v26, v164, v165
  v_lshlrev_b32 v164, 16, v26
  v_and_b32 v165, 0xffff0000, v26
  v_mul_f32 v164, v164, v30
  v_mul_f32 v165, v165, v30
  v_cvt_pk_bf16_f32 v26, v164, v165
  v_lshlrev_b32 v164, 16, v26
  v_and_b32 v165, 0xffff0000, v26
  v_add_f32 v164, v164, v84
  v_add_f32 v165, v165, v85
  v_cvt_pk_bf16_f32 v84, v164, v165
  v_cvt_pk_bf16_f32 v26, v166, v167
  v_lshlrev_b32 v166, 16, v26
  v_and_b32 v167, 0xffff0000, v26
  v_mul_f32 v166, v166, v30
  v_mul_f32 v167, v167, v30
  v_cvt_pk_bf16_f32 v26, v166, v167
  v_lshlrev_b32 v166, 16, v26
  v_and_b32 v167, 0xffff0000, v26
  v_add_f32 v166, v166, v86
  v_add_f32 v167, v167, v87
  v_cvt_pk_bf16_f32 v85, v166, v167
  buffer_store_dwordx2 v[84:85], v9, s[8:11], s22 offen offset:160
  s_waitcnt vmcnt(19)
  v_cvt_pk_bf16_f32 v26, v168, v169
  v_lshlrev_b32 v168, 16, v26
  v_and_b32 v169, 0xffff0000, v26
  v_mul_f32 v168, v168, v30
  v_mul_f32 v169, v169, v30
  v_cvt_pk_bf16_f32 v26, v168, v169
  v_lshlrev_b32 v168, 16, v26
  v_and_b32 v169, 0xffff0000, v26
  v_add_f32 v168, v168, v88
  v_add_f32 v169, v169, v89
  v_cvt_pk_bf16_f32 v88, v168, v169
  v_cvt_pk_bf16_f32 v26, v170, v171
  v_lshlrev_b32 v170, 16, v26
  v_and_b32 v171, 0xffff0000, v26
  v_mul_f32 v170, v170, v30
  v_mul_f32 v171, v171, v30
  v_cvt_pk_bf16_f32 v26, v170, v171
  v_lshlrev_b32 v170, 16, v26
  v_and_b32 v171, 0xffff0000, v26
  v_add_f32 v170, v170, v90
  v_add_f32 v171, v171, v91
  v_cvt_pk_bf16_f32 v89, v170, v171
  buffer_store_dwordx2 v[88:89], v9, s[8:11], s22 offen offset:192
  s_waitcnt vmcnt(19)
  v_cvt_pk_bf16_f32 v26, v172, v173
  v_lshlrev_b32 v172, 16, v26
  v_and_b32 v173, 0xffff0000, v26
  v_mul_f32 v172, v172, v30
  v_mul_f32 v173, v173, v30
  v_cvt_pk_bf16_f32 v26, v172, v173
  v_lshlrev_b32 v172, 16, v26
  v_and_b32 v173, 0xffff0000, v26
  v_add_f32 v172, v172, v92
  v_add_f32 v173, v173, v93
  v_cvt_pk_bf16_f32 v92, v172, v173
  v_cvt_pk_bf16_f32 v26, v174, v175
  v_lshlrev_b32 v174, 16, v26
  v_and_b32 v175, 0xffff0000, v26
  v_mul_f32 v174, v174, v30
  v_mul_f32 v175, v175, v30
  v_cvt_pk_bf16_f32 v26, v174, v175
  v_lshlrev_b32 v174, 16, v26
  v_and_b32 v175, 0xffff0000, v26
  v_add_f32 v174, v174, v94
  v_add_f32 v175, v175, v95
  v_cvt_pk_bf16_f32 v93, v174, v175
  buffer_store_dwordx2 v[92:93], v9, s[8:11], s22 offen offset:224
  s_waitcnt vmcnt(19)
  v_cvt_pk_bf16_f32 v26, v176, v177
  v_lshlrev_b32 v176, 16, v26
  v_and_b32 v177, 0xffff0000, v26
  v_mul_f32 v176, v176, v30
  v_mul_f32 v177, v177, v30
  v_cvt_pk_bf16_f32 v26, v176, v177
  v_lshlrev_b32 v176, 16, v26
  v_and_b32 v177, 0xffff0000, v26
  v_add_f32 v176, v176, v96
  v_add_f32 v177, v177, v97
  v_cvt_pk_bf16_f32 v96, v176, v177
  v_cvt_pk_bf16_f32 v26, v178, v179
  v_lshlrev_b32 v178, 16, v26
  v_and_b32 v179, 0xffff0000, v26
  v_mul_f32 v178, v178, v30
  v_mul_f32 v179, v179, v30
  v_cvt_pk_bf16_f32 v26, v178, v179
  v_lshlrev_b32 v178, 16, v26
  v_and_b32 v179, 0xffff0000, v26
  v_add_f32 v178, v178, v98
  v_add_f32 v179, v179, v99
  v_cvt_pk_bf16_f32 v97, v178, v179
  buffer_store_dwordx2 v[96:97], v9, s[8:11], s22 offen offset:256
  s_waitcnt vmcnt(19)
  v_cvt_pk_bf16_f32 v26, v180, v181
  v_lshlrev_b32 v180, 16, v26
  v_and_b32 v181, 0xffff0000, v26
  v_mul_f32 v180, v180, v30
  v_mul_f32 v181, v181, v30
  v_cvt_pk_bf16_f32 v26, v180, v181
  v_lshlrev_b32 v180, 16, v26
  v_and_b32 v181, 0xffff0000, v26
  v_add_f32 v180, v180, v100
  v_add_f32 v181, v181, v101
  v_cvt_pk_bf16_f32 v100, v180, v181
  v_cvt_pk_bf16_f32 v26, v182, v183
  v_lshlrev_b32 v182, 16, v26
  v_and_b32 v183, 0xffff0000, v26
  v_mul_f32 v182, v182, v30
  v_mul_f32 v183, v183, v30
  v_cvt_pk_bf16_f32 v26, v182, v183
  v_lshlrev_b32 v182, 16, v26
  v_and_b32 v183, 0xffff0000, v26
  v_add_f32 v182, v182, v102
  v_add_f32 v183, v183, v103
  v_cvt_pk_bf16_f32 v101, v182, v183
  buffer_store_dwordx2 v[100:101], v9, s[8:11], s22 offen offset:288
  s_waitcnt vmcnt(19)
  v_cvt_pk_bf16_f32 v26, v184, v185
  v_lshlrev_b32 v184, 16, v26
  v_and_b32 v185, 0xffff0000, v26
  v_mul_f32 v184, v184, v31
  v_mul_f32 v185, v185, v31
  v_cvt_pk_bf16_f32 v26, v184, v185
  v_lshlrev_b32 v184, 16, v26
  v_and_b32 v185, 0xffff0000, v26
  v_add_f32 v184, v184, v104
  v_add_f32 v185, v185, v105
  v_cvt_pk_bf16_f32 v104, v184, v185
  v_cvt_pk_bf16_f32 v26, v186, v187
  v_lshlrev_b32 v186, 16, v26
  v_and_b32 v187, 0xffff0000, v26
  v_mul_f32 v186, v186, v31
  v_mul_f32 v187, v187, v31
  v_cvt_pk_bf16_f32 v26, v186, v187
  v_lshlrev_b32 v186, 16, v26
  v_and_b32 v187, 0xffff0000, v26
  v_add_f32 v186, v186, v106
  v_add_f32 v187, v187, v107
  v_cvt_pk_bf16_f32 v105, v186, v187
  buffer_store_dwordx2 v[104:105], v9, s[8:11], s23 offen offset:0
  s_waitcnt vmcnt(19)
  v_cvt_pk_bf16_f32 v26, v188, v189
  v_lshlrev_b32 v188, 16, v26
  v_and_b32 v189, 0xffff0000, v26
  v_mul_f32 v188, v188, v31
  v_mul_f32 v189, v189, v31
  v_cvt_pk_bf16_f32 v26, v188, v189
  v_lshlrev_b32 v188, 16, v26
  v_and_b32 v189, 0xffff0000, v26
  v_add_f32 v188, v188, v108
  v_add_f32 v189, v189, v109
  v_cvt_pk_bf16_f32 v108, v188, v189
  v_cvt_pk_bf16_f32 v26, v190, v191
  v_lshlrev_b32 v190, 16, v26
  v_and_b32 v191, 0xffff0000, v26
  v_mul_f32 v190, v190, v31
  v_mul_f32 v191, v191, v31
  v_cvt_pk_bf16_f32 v26, v190, v191
  v_lshlrev_b32 v190, 16, v26
  v_and_b32 v191, 0xffff0000, v26
  v_add_f32 v190, v190, v110
  v_add_f32 v191, v191, v111
  v_cvt_pk_bf16_f32 v109, v190, v191
  buffer_store_dwordx2 v[108:109], v9, s[8:11], s23 offen offset:32
  s_waitcnt vmcnt(19)
  v_cvt_pk_bf16_f32 v26, v192, v193
  v_lshlrev_b32 v192, 16, v26
  v_and_b32 v193, 0xffff0000, v26
  v_mul_f32 v192, v192, v31
  v_mul_f32 v193, v193, v31
  v_cvt_pk_bf16_f32 v26, v192, v193
  v_lshlrev_b32 v192, 16, v26
  v_and_b32 v193, 0xffff0000, v26
  v_add_f32 v192, v192, v112
  v_add_f32 v193, v193, v113
  v_cvt_pk_bf16_f32 v112, v192, v193
  v_cvt_pk_bf16_f32 v26, v194, v195
  v_lshlrev_b32 v194, 16, v26
  v_and_b32 v195, 0xffff0000, v26
  v_mul_f32 v194, v194, v31
  v_mul_f32 v195, v195, v31
  v_cvt_pk_bf16_f32 v26, v194, v195
  v_lshlrev_b32 v194, 16, v26
  v_and_b32 v195, 0xffff0000, v26
  v_add_f32 v194, v194, v114
  v_add_f32 v195, v195, v115
  v_cvt_pk_bf16_f32 v113, v194, v195
  buffer_store_dwordx2 v[112:113], v9, s[8:11], s23 offen offset:64
  s_waitcnt vmcnt(19)
  v_cvt_pk_bf16_f32 v26, v196, v197
  v_lshlrev_b32 v196, 16, v26
  v_and_b32 v197, 0xffff0000, v26
  v_mul_f32 v196, v196, v31
  v_mul_f32 v197, v197, v31
  v_cvt_pk_bf16_f32 v26, v196, v197
  v_lshlrev_b32 v196, 16, v26
  v_and_b32 v197, 0xffff0000, v26
  v_add_f32 v196, v196, v116
  v_add_f32 v197, v197, v117
  v_cvt_pk_bf16_f32 v116, v196, v197
  v_cvt_pk_bf16_f32 v26, v198, v199
  v_lshlrev_b32 v198, 16, v26
  v_and_b32 v199, 0xffff0000, v26
  v_mul_f32 v198, v198, v31
  v_mul_f32 v199, v199, v31
  v_cvt_pk_bf16_f32 v26, v198, v199
  v_lshlrev_b32 v198, 16, v26
  v_and_b32 v199, 0xffff0000, v26
  v_add_f32 v198, v198, v118
  v_add_f32 v199, v199, v119
  v_cvt_pk_bf16_f32 v117, v198, v199
  buffer_store_dwordx2 v[116:117], v9, s[8:11], s23 offen offset:96
  s_waitcnt vmcnt(19)
  v_cvt_pk_bf16_f32 v26, v200, v201
  v_lshlrev_b32 v200, 16, v26
  v_and_b32 v201, 0xffff0000, v26
  v_mul_f32 v200, v200, v31
  v_mul_f32 v201, v201, v31
  v_cvt_pk_bf16_f32 v26, v200, v201
  v_lshlrev_b32 v200, 16, v26
  v_and_b32 v201, 0xffff0000, v26
  v_add_f32 v200, v200, v120
  v_add_f32 v201, v201, v121
  v_cvt_pk_bf16_f32 v120, v200, v201
  v_cvt_pk_bf16_f32 v26, v202, v203
  v_lshlrev_b32 v202, 16, v26
  v_and_b32 v203, 0xffff0000, v26
  v_mul_f32 v202, v202, v31
  v_mul_f32 v203, v203, v31
  v_cvt_pk_bf16_f32 v26, v202, v203
  v_lshlrev_b32 v202, 16, v26
  v_and_b32 v203, 0xffff0000, v26
  v_add_f32 v202, v202, v122
  v_add_f32 v203, v203, v123
  v_cvt_pk_bf16_f32 v121, v202, v203
  buffer_store_dwordx2 v[120:121], v9, s[8:11], s23 offen offset:128
  s_waitcnt vmcnt(19)
  v_cvt_pk_bf16_f32 v26, v204, v205
  v_lshlrev_b32 v204, 16, v26
  v_and_b32 v205, 0xffff0000, v26
  v_mul_f32 v204, v204, v31
  v_mul_f32 v205, v205, v31
  v_cvt_pk_bf16_f32 v26, v204, v205
  v_lshlrev_b32 v204, 16, v26
  v_and_b32 v205, 0xffff0000, v26
  v_add_f32 v204, v204, v124
  v_add_f32 v205, v205, v125
  v_cvt_pk_bf16_f32 v124, v204, v205
  v_cvt_pk_bf16_f32 v26, v206, v207
  v_lshlrev_b32 v206, 16, v26
  v_and_b32 v207, 0xffff0000, v26
  v_mul_f32 v206, v206, v31
  v_mul_f32 v207, v207, v31
  v_cvt_pk_bf16_f32 v26, v206, v207
  v_lshlrev_b32 v206, 16, v26
  v_and_b32 v207, 0xffff0000, v26
  v_add_f32 v206, v206, v126
  v_add_f32 v207, v207, v127
  v_cvt_pk_bf16_f32 v125, v206, v207
  buffer_store_dwordx2 v[124:125], v9, s[8:11], s23 offen offset:160
  s_waitcnt vmcnt(19)
  v_cvt_pk_bf16_f32 v26, v208, v209
  v_lshlrev_b32 v208, 16, v26
  v_and_b32 v209, 0xffff0000, v26
  v_mul_f32 v208, v208, v31
  v_mul_f32 v209, v209, v31
  v_cvt_pk_bf16_f32 v26, v208, v209
  v_lshlrev_b32 v208, 16, v26
  v_and_b32 v209, 0xffff0000, v26
  v_add_f32 v208, v208, v128
  v_add_f32 v209, v209, v129
  v_cvt_pk_bf16_f32 v128, v208, v209
  v_cvt_pk_bf16_f32 v26, v210, v211
  v_lshlrev_b32 v210, 16, v26
  v_and_b32 v211, 0xffff0000, v26
  v_mul_f32 v210, v210, v31
  v_mul_f32 v211, v211, v31
  v_cvt_pk_bf16_f32 v26, v210, v211
  v_lshlrev_b32 v210, 16, v26
  v_and_b32 v211, 0xffff0000, v26
  v_add_f32 v210, v210, v130
  v_add_f32 v211, v211, v131
  v_cvt_pk_bf16_f32 v129, v210, v211
  buffer_store_dwordx2 v[128:129], v9, s[8:11], s23 offen offset:192
  s_waitcnt vmcnt(19)
  v_cvt_pk_bf16_f32 v26, v212, v213
  v_lshlrev_b32 v212, 16, v26
  v_and_b32 v213, 0xffff0000, v26
  v_mul_f32 v212, v212, v31
  v_mul_f32 v213, v213, v31
  v_cvt_pk_bf16_f32 v26, v212, v213
  v_lshlrev_b32 v212, 16, v26
  v_and_b32 v213, 0xffff0000, v26
  v_add_f32 v212, v212, v132
  v_add_f32 v213, v213, v133
  v_cvt_pk_bf16_f32 v132, v212, v213
  v_cvt_pk_bf16_f32 v26, v214, v215
  v_lshlrev_b32 v214, 16, v26
  v_and_b32 v215, 0xffff0000, v26
  v_mul_f32 v214, v214, v31
  v_mul_f32 v215, v215, v31
  v_cvt_pk_bf16_f32 v26, v214, v215
  v_lshlrev_b32 v214, 16, v26
  v_and_b32 v215, 0xffff0000, v26
  v_add_f32 v214, v214, v134
  v_add_f32 v215, v215, v135
  v_cvt_pk_bf16_f32 v133, v214, v215
  buffer_store_dwordx2 v[132:133], v9, s[8:11], s23 offen offset:224
  s_waitcnt vmcnt(19)
  v_cvt_pk_bf16_f32 v26, v216, v217
  v_lshlrev_b32 v216, 16, v26
  v_and_b32 v217, 0xffff0000, v26
  v_mul_f32 v216, v216, v31
  v_mul_f32 v217, v217, v31
  v_cvt_pk_bf16_f32 v26, v216, v217
  v_lshlrev_b32 v216, 16, v26
  v_and_b32 v217, 0xffff0000, v26
  v_add_f32 v216, v216, v136
  v_add_f32 v217, v217, v137
  v_cvt_pk_bf16_f32 v136, v216, v217
  v_cvt_pk_bf16_f32 v26, v218, v219
  v_lshlrev_b32 v218, 16, v26
  v_and_b32 v219, 0xffff0000, v26
  v_mul_f32 v218, v218, v31
  v_mul_f32 v219, v219, v31
  v_cvt_pk_bf16_f32 v26, v218, v219
  v_lshlrev_b32 v218, 16, v26
  v_and_b32 v219, 0xffff0000, v26
  v_add_f32 v218, v218, v138
  v_add_f32 v219, v219, v139
  v_cvt_pk_bf16_f32 v137, v218, v219
  buffer_store_dwordx2 v[136:137], v9, s[8:11], s23 offen offset:256
  s_waitcnt vmcnt(19)
  v_cvt_pk_bf16_f32 v26, v220, v221
  v_lshlrev_b32 v220, 16, v26
  v_and_b32 v221, 0xffff0000, v26
  v_mul_f32 v220, v220, v31
  v_mul_f32 v221, v221, v31
  v_cvt_pk_bf16_f32 v26, v220, v221
  v_lshlrev_b32 v220, 16, v26
  v_and_b32 v221, 0xffff0000, v26
  v_add_f32 v220, v220, v140
  v_add_f32 v221, v221, v141
  v_cvt_pk_bf16_f32 v140, v220, v221
  v_cvt_pk_bf16_f32 v26, v222, v223
  v_lshlrev_b32 v222, 16, v26
  v_and_b32 v223, 0xffff0000, v26
  v_mul_f32 v222, v222, v31
  v_mul_f32 v223, v223, v31
  v_cvt_pk_bf16_f32 v26, v222, v223
  v_lshlrev_b32 v222, 16, v26
  v_and_b32 v223, 0xffff0000, v26
  v_add_f32 v222, v222, v142
  v_add_f32 v223, v223, v143
  v_cvt_pk_bf16_f32 v141, v222, v223
  buffer_store_dwordx2 v[140:141], v9, s[8:11], s23 offen offset:288
om_283:
  s_cmp_eq_u32 s87, -2
  s_cbranch_scc1 kv_help
  s_cmp_eq_u32 s87, -1
  s_cbranch_scc1 queue
tail_item:
  s_load_dwordx2 s[4:5], s[0:1], 96
  s_waitcnt lgkmcnt(0)
  s_mov_b32 s32, s4
  s_mov_b32 s33, s5
  s_mov_b32 s34, 256
  s_mov_b32 s35, 0x00020000
  s_waitcnt vmcnt(0)
  s_barrier
  s_mov_b32 s21, s87
do_pv:
  s_mov_b32 s2, s21
  s_load_dwordx2 s[4:5], s[0:1], 88
  s_load_dwordx2 s[38:39], s[0:1], 104
  s_waitcnt lgkmcnt(0)
  s_mov_b32 s8, s4
  s_mov_b32 s9, s5
  s_mov_b32 s10, 2621440
  s_mov_b32 s11, 0x00020000
  s_add_u32 s12, s38, 122683392
  s_addc_u32 s13, s39, 0
  s_mov_b32 s14, 83886080
  s_mov_b32 s15, 0x00020000
  s_mov_b32 s59, 0
  s_mov_b32 s60, 0
  s_add_u32 s16, s38, 85983232
  s_addc_u32 s17, s39, 0
  s_mov_b32 s18, 36700160
  s_mov_b32 s19, 0x00020000
  s_add_u32 s24, s38, 73400320
  s_addc_u32 s25, s39, 0
  s_mov_b32 s26, 5242880
  s_mov_b32 s27, 0x00020000
  s_add_u32 s28, s38, 81002496
  s_addc_u32 s29, s39, 0
  s_mov_b32 s30, 8192
  s_mov_b32 s31, 0x00020000
  s_add_u32 s72, s38, 81068032
  s_addc_u32 s73, s39, 0
  s_mov_b32 s74, 116736
  s_mov_b32 s75, 0x00020000
  v_lshlrev_b32 v4, 4, v1
  v_lshlrev_b32 v5, 3, v1
  v_lshlrev_b32 v6, 2, v2
  v_and_b32 v7, 7, v1
  v_lshlrev_b32 v7, 7, v7
  v_lshrrev_b32 v31, 3, v1
  v_lshl_add_u32 v208, v31, 10, v7
  v_bfe_u32 v31, v1, 3, 2
  v_lshl_add_u32 v31, v31, 2, v7
  s_lshl_b32 s21, s20, 10
  s_add_u32 s21, s21, 95232
  buffer_load_dword v8, v31, s[72:75], s21 offen sc1
  v_lshlrev_b32 v25, 7, v2
  s_mov_b32 s21, 93184
  buffer_load_dword v26, v25, s[72:75], s21 offen sc1
  s_mov_b32 s63, 1
  v_mul_u32_u24 v9, 1280, v2
  v_lshl_add_u32 v9, v3, 3, v9
  s_lshl_b32 s21, s20, 13
  v_add_u32 v10, s21, v4
  s_lshl_b32 s21, s20, 10
  v_add_u32 v11, s21, v4
  v_lshrrev_b32 v20, 5, v1
  v_mul_u32_u24 v21, 2560, v20
  v_add_u32 v21, v21, v4
  v_and_b32 v22, 31, v1
  v_lshlrev_b32 v22, 4, v22
  v_mul_u32_u24 v20, 10240, v20
  v_add_u32 v22, v22, v20
  v_mul_u32_u24 v21, 2560, v3
  v_lshl_add_u32 v21, v2, 4, v21
  v_mul_u32_u24 v22, 10240, v3
  v_lshl_add_u32 v22, v2, 4, v22
  v_mov_b32 v28, 80
  v_mov_b32 v30, 32768
  s_mov_b32 s50, 0
  s_mov_b32 s71, 0
  s_mov_b32 s51, 0
  s_and_b32 s43, s20, 1
  s_lshr_b32 s44, s20, 1
  v_mov_b32 v70, 0
  v_mov_b32 v71, 0
  v_mov_b32 v78, 0
  v_mov_b32 v79, 0
  v_mov_b32 v86, 0
  v_mov_b32 v87, 0
  v_mov_b32 v94, 0
  v_mov_b32 v95, 0
  v_mov_b32 v102, 0
  v_mov_b32 v103, 0
  v_mov_b32 v110, 0
  v_mov_b32 v111, 0
  v_mov_b32 v118, 0
  v_mov_b32 v119, 0
  v_mov_b32 v126, 0
  v_mov_b32 v127, 0
  s_mov_b32 s21, s2
pv_loop:
  s_mul_i32 s2, s21, 2
  s_add_u32 s2, s2, 192
  s_add_u32 s22, s21, 356
  s_cmp_lt_u32 s21, 164
  s_cselect_b32 s2, s2, s22
  s_cselect_b32 s65, 1, 0
  s_mul_i32 s22, s21, 5
  s_cmp_lt_u32 s21, 64
  s_cselect_b32 s2, s22, s2
  s_cselect_b32 s65, 4, s65
  s_mul_hi_u32 s40, s2, 0x1999999a
  s_mul_i32 s21, s40, 10
  s_sub_u32 s41, s2, s21
  s_lshl_b32 s52, s40, 10
  s_add_u32 s52, s52, 23552
  buffer_load_dword v27, v7, s[72:75], s52 offen sc1
  s_cmp_lg_u32 s20, 0
  s_cbranch_scc1 pv_297
  s_sub_u32 s21, s2, 0
  s_cmp_lt_u32 s21, 640
  s_cbranch_scc1 pv_297
  v_mov_b32 v29, 1
  s_mov_b64 exec, 1
  buffer_atomic_add v29, v28, s[32:35], 0 offen sc0 sc1
  s_mov_b64 exec, -1
pv_297:
  s_lshl_b32 s42, s40, 5
  s_lshl_b32 s21, s20, 3
  s_add_u32 s42, s42, s21
  s_mul_i32 s61, s21, 5
  s_lshr_b32 s22, s41, 1
  s_add_u32 s61, s61, s22
  s_and_b32 s62, s41, 1
  s_lshl_b32 s62, s62, 12
  s_mul_i32 s53, s42, 40960
  s_lshl_b32 s22, s41, 12
  s_add_u32 s53, s53, s22
  s_lshl_b32 s21, s40, 1
  s_add_u32 s21, s21, s43
  s_lshl_b32 s45, s21, 6
  s_mul_i32 s46, s21, 20480
  s_mul_i32 s21, s21, 40
  s_lshl_b32 s22, s41, 2
  s_add_u32 s22, s22, s44
  s_add_u32 s21, s21, s22
  s_lshl_b32 s54, s21, 10
  s_lshl_b32 s22, s22, 5
  s_add_u32 s46, s46, s22
  s_mul_i32 s47, s42, 2560
  s_mul_i32 s48, s42, 10240
  s_lshl_b32 s22, s41, 10
  s_add_u32 s48, s48, s22
  s_add_u32 s48, s48, 15728640
  s_add_u32 s23, s40, 1
  s_cmp_ge_u32 s50, s23
  s_cbranch_scc1 pv_290
  s_cmp_eq_u32 s63, 0
  s_cbranch_scc1 pv_293
  s_mov_b32 s63, 0
  s_waitcnt vmcnt(1)
  v_cmp_le_u32 vcc, 4, v26
  s_mov_b32 s51, vcc_lo
  v_cmp_gt_u32 vcc, s23, v8
  s_nop 1
  s_cbranch_vccz pv_294
pv_293:
  s_lshl_b32 s21, s20, 10
  s_add_u32 s21, s21, 95232
  s_mov_b32 s101, 0
wm_298:
  buffer_load_dword v8, v31, s[72:75], s21 offen sc1
  s_add_u32 s101, s101, 1
  s_cmp_gt_u32 s101, 131072
  s_cbranch_scc1 main_end
  s_waitcnt vmcnt(0)
  v_cmp_gt_u32 vcc, s23, v8
  v_readfirstlane_b32 s100, v8
  s_nop 0
  s_cbranch_vccz wm_299
  s_sleep 8
  s_add_u32 s100, s100, 2
  s_cmp_ge_u32 s100, s23
  s_cbranch_scc1 wm_298
  s_sleep 60
  s_branch wm_298
wm_299:
pv_294:
  v_readlane_b32 s50, v8, 0
  v_readlane_b32 s21, v8, 1
  s_min_u32 s50, s50, s21
  v_readlane_b32 s21, v8, 2
  s_min_u32 s50, s50, s21
  v_readlane_b32 s21, v8, 3
  s_min_u32 s50, s50, s21
  v_readlane_b32 s21, v8, 4
  s_min_u32 s50, s50, s21
  v_readlane_b32 s21, v8, 5
  s_min_u32 s50, s50, s21
  v_readlane_b32 s21, v8, 6
  s_min_u32 s50, s50, s21
  v_readlane_b32 s21, v8, 7
  s_min_u32 s50, s50, s21
  v_readlane_b32 s21, v8, 8
  s_min_u32 s50, s50, s21
  v_readlane_b32 s21, v8, 9
  s_min_u32 s50, s50, s21
  v_readlane_b32 s21, v8, 10
  s_min_u32 s50, s50, s21
  v_readlane_b32 s21, v8, 11
  s_min_u32 s50, s50, s21
  v_readlane_b32 s21, v8, 12
  s_min_u32 s50, s50, s21
  v_readlane_b32 s21, v8, 13
  s_min_u32 s50, s50, s21
  v_readlane_b32 s21, v8, 14
  s_min_u32 s50, s50, s21
  v_readlane_b32 s21, v8, 15
  s_min_u32 s50, s50, s21
  v_readlane_b32 s21, v8, 16
  s_min_u32 s50, s50, s21
  v_readlane_b32 s21, v8, 17
  s_min_u32 s50, s50, s21
  v_readlane_b32 s21, v8, 18
  s_min_u32 s50, s50, s21
  v_readlane_b32 s21, v8, 19
  s_min_u32 s50, s50, s21
  v_readlane_b32 s21, v8, 20
  s_min_u32 s50, s50, s21
  v_readlane_b32 s21, v8, 21
  s_min_u32 s50, s50, s21
  v_readlane_b32 s21, v8, 22
  s_min_u32 s50, s50, s21
  v_readlane_b32 s21, v8, 23
  s_min_u32 s50, s50, s21
  v_readlane_b32 s21, v8, 24
  s_min_u32 s50, s50, s21
  v_readlane_b32 s21, v8, 25
  s_min_u32 s50, s50, s21
  v_readlane_b32 s21, v8, 26
  s_min_u32 s50, s50, s21
  v_readlane_b32 s21, v8, 27
  s_min_u32 s50, s50, s21
  v_readlane_b32 s21, v8, 28
  s_min_u32 s50, s50, s21
  v_readlane_b32 s21, v8, 29
  s_min_u32 s50, s50, s21
  v_readlane_b32 s21, v8, 30
  s_min_u32 s50, s50, s21
  v_readlane_b32 s21, v8, 31
  s_min_u32 s50, s50, s21
pv_290:
  s_lshr_b32 s22, s40, 2
  s_cmp_lt_u32 s40, 32
  s_cbranch_scc1 pv_291
  s_bitcmp1_b32 s51, s22
  s_cbranch_scc1 pv_291
  s_mov_b32 s21, 93184
  v_lshlrev_b32 v25, 7, v2
  s_mov_b32 s101, 0
pv_292:
  buffer_load_dword v26, v25, s[72:75], s21 offen sc1
  s_add_u32 s101, s101, 1
  s_cmp_gt_u32 s101, 131072
  s_cbranch_scc1 main_end
  s_waitcnt vmcnt(0)
  v_cmp_le_u32 vcc, 4, v26
  s_mov_b32 s51, vcc_lo
  s_bitcmp1_b32 s51, s22
  s_cbranch_scc1 pv_291
  s_sleep 8
  s_branch pv_292
pv_291:
  buffer_load_dwordx4 a[0:3], v4, s[12:15], s53 offen offset:0 sc1
  buffer_load_dwordx4 a[4:7], v4, s[12:15], s53 offen offset:1024 sc1
  buffer_load_dwordx4 a[8:11], v4, s[12:15], s53 offen offset:2048 sc1
  buffer_load_dwordx4 a[12:15], v4, s[12:15], s53 offen offset:3072 sc1
  s_add_u32 s53, s53, 40960
  buffer_load_dwordx4 a[16:19], v4, s[12:15], s53 offen offset:0 sc1
  buffer_load_dwordx4 a[20:23], v4, s[12:15], s53 offen offset:1024 sc1
  buffer_load_dwordx4 a[24:27], v4, s[12:15], s53 offen offset:2048 sc1
  buffer_load_dwordx4 a[28:31], v4, s[12:15], s53 offen offset:3072 sc1
  s_add_u32 s53, s53, 40960
  buffer_load_dwordx4 a[32:35], v4, s[12:15], s53 offen offset:0 sc1
  buffer_load_dwordx4 a[36:39], v4, s[12:15], s53 offen offset:1024 sc1
  buffer_load_dwordx4 a[40:43], v4, s[12:15], s53 offen offset:2048 sc1
  buffer_load_dwordx4 a[44:47], v4, s[12:15], s53 offen offset:3072 sc1
  s_add_u32 s53, s53, 40960
  buffer_load_dwordx4 a[48:51], v4, s[12:15], s53 offen offset:0 sc1
  buffer_load_dwordx4 a[52:55], v4, s[12:15], s53 offen offset:1024 sc1
  buffer_load_dwordx4 a[56:59], v4, s[12:15], s53 offen offset:2048 sc1
  buffer_load_dwordx4 a[60:63], v4, s[12:15], s53 offen offset:3072 sc1
  s_add_u32 s53, s53, 40960
  buffer_load_dwordx4 a[64:67], v4, s[12:15], s53 offen offset:0 sc1
  buffer_load_dwordx4 a[68:71], v4, s[12:15], s53 offen offset:1024 sc1
  buffer_load_dwordx4 a[72:75], v4, s[12:15], s53 offen offset:2048 sc1
  buffer_load_dwordx4 a[76:79], v4, s[12:15], s53 offen offset:3072 sc1
  s_add_u32 s53, s53, 40960
  buffer_load_dwordx4 a[80:83], v4, s[12:15], s53 offen offset:0 sc1
  buffer_load_dwordx4 a[84:87], v4, s[12:15], s53 offen offset:1024 sc1
  buffer_load_dwordx4 a[88:91], v4, s[12:15], s53 offen offset:2048 sc1
  buffer_load_dwordx4 a[92:95], v4, s[12:15], s53 offen offset:3072 sc1
  s_add_u32 s53, s53, 40960
  buffer_load_dwordx4 a[96:99], v4, s[12:15], s53 offen offset:0 sc1
  buffer_load_dwordx4 a[100:103], v4, s[12:15], s53 offen offset:1024 sc1
  buffer_load_dwordx4 a[104:107], v4, s[12:15], s53 offen offset:2048 sc1
  buffer_load_dwordx4 a[108:111], v4, s[12:15], s53 offen offset:3072 sc1
  s_add_u32 s53, s53, 40960
  buffer_load_dwordx4 a[112:115], v4, s[12:15], s53 offen offset:0 sc1
  buffer_load_dwordx4 a[116:119], v4, s[12:15], s53 offen offset:1024 sc1
  buffer_load_dwordx4 a[120:123], v4, s[12:15], s53 offen offset:2048 sc1
  buffer_load_dwordx4 a[124:127], v4, s[12:15], s53 offen offset:3072 sc1
  s_cmp_lt_u32 s40, 32
  s_cselect_b32 s70, 0x80000000, s54
  buffer_load_dwordx4 v[12:15], v4, s[24:27], s70 offen sc1
  buffer_load_dwordx4 v[16:19], v4, s[24:27], s70 offen offset:2048 sc1
  buffer_load_dword v24, v6, s[28:31], s45 offen sc1
  s_waitcnt vmcnt(35)
  s_cmp_eq_u32 s71, 0
  s_cbranch_scc1 paf_302
  v_mov_b32 v25, 0
  v_mov_b32 v26, 1
  s_mov_b64 exec, 1
  buffer_atomic_add v26, v25, s[72:75], s71 offen sc1
  s_mov_b64 exec, -1
  s_mov_b32 s71, 0
paf_302:
  v_cmp_le_u32 s[68:69], 4, v27
  s_nop 1
  s_and_b32 s21, s68, 255
  s_cmp_lg_u32 s21, 255
  s_cbranch_scc1 pvw_295
  s_mov_b32 s56, s47
  s_mov_b32 s57, s48
  buffer_load_dwordx4 v[64:67], v4, s[16:19], s56 offen sc1
  buffer_load_dwordx2 v[68:69], v5, s[16:19], s56 offen offset:2048 sc1
  buffer_load_dwordx4 v[128:131], v21, s[16:19], s56 offen offset:1024 sc1
  buffer_load_dwordx4 v[132:135], v21, s[16:19], s56 offen offset:1280 sc1
  s_add_u32 s56, s56, 2560
  buffer_load_dwordx4 v[72:75], v4, s[16:19], s56 offen sc1
  buffer_load_dwordx2 v[76:77], v5, s[16:19], s56 offen offset:2048 sc1
  s_add_u32 s56, s56, 2560
  buffer_load_dwordx4 v[80:83], v4, s[16:19], s56 offen sc1
  buffer_load_dwordx2 v[84:85], v5, s[16:19], s56 offen offset:2048 sc1
  s_add_u32 s56, s56, 2560
  buffer_load_dwordx4 v[88:91], v4, s[16:19], s56 offen sc1
  buffer_load_dwordx2 v[92:93], v5, s[16:19], s56 offen offset:2048 sc1
  s_add_u32 s56, s56, 2560
  buffer_load_dwordx4 v[32:35], v22, s[16:19], s57 offen offset:0 sc1
  buffer_load_dwordx4 v[36:39], v22, s[16:19], s57 offen offset:256 sc1
  buffer_load_dwordx4 v[40:43], v22, s[16:19], s57 offen offset:512 sc1
  buffer_load_dwordx4 v[44:47], v22, s[16:19], s57 offen offset:768 sc1
  s_add_u32 s57, s57, 40960
  buffer_load_dwordx4 v[96:99], v4, s[16:19], s56 offen sc1
  buffer_load_dwordx2 v[100:101], v5, s[16:19], s56 offen offset:2048 sc1
  buffer_load_dwordx4 v[136:139], v21, s[16:19], s56 offen offset:1024 sc1
  buffer_load_dwordx4 v[140:143], v21, s[16:19], s56 offen offset:1280 sc1
  s_add_u32 s56, s56, 2560
  buffer_load_dwordx4 v[104:107], v4, s[16:19], s56 offen sc1
  buffer_load_dwordx2 v[108:109], v5, s[16:19], s56 offen offset:2048 sc1
  s_add_u32 s56, s56, 2560
  buffer_load_dwordx4 v[112:115], v4, s[16:19], s56 offen sc1
  buffer_load_dwordx2 v[116:117], v5, s[16:19], s56 offen offset:2048 sc1
  s_add_u32 s56, s56, 2560
  buffer_load_dwordx4 v[120:123], v4, s[16:19], s56 offen sc1
  buffer_load_dwordx2 v[124:125], v5, s[16:19], s56 offen offset:2048 sc1
  s_add_u32 s56, s56, 2560
  buffer_load_dwordx4 v[48:51], v22, s[16:19], s57 offen offset:0 sc1
  buffer_load_dwordx4 v[52:55], v22, s[16:19], s57 offen offset:256 sc1
  buffer_load_dwordx4 v[56:59], v22, s[16:19], s57 offen offset:512 sc1
  buffer_load_dwordx4 v[60:63], v22, s[16:19], s57 offen offset:768 sc1
  s_add_u32 s57, s57, 40960
  s_barrier
  s_waitcnt vmcnt(28)
  v_sub_f32 v25, 1.0, v24
  v_cvt_pk_bf16_f32 v26, v25, v25
  v_lshlrev_b32 v25, 16, v26
  v_cvt_pk_bf16_f32 v26, v12, v12
  v_lshlrev_b32 v12, 16, v26
  v_cvt_pk_bf16_f32 v26, v13, v13
  v_lshlrev_b32 v13, 16, v26
  v_cvt_pk_bf16_f32 v26, v14, v14
  v_lshlrev_b32 v14, 16, v26
  v_cvt_pk_bf16_f32 v26, v15, v15
  v_lshlrev_b32 v15, 16, v26
  v_cvt_pk_bf16_f32 v26, v16, v16
  v_lshlrev_b32 v16, 16, v26
  v_cvt_pk_bf16_f32 v26, v17, v17
  v_lshlrev_b32 v17, 16, v26
  v_cvt_pk_bf16_f32 v26, v18, v18
  v_lshlrev_b32 v18, 16, v26
  v_cvt_pk_bf16_f32 v26, v19, v19
  v_lshlrev_b32 v19, 16, v26
  v_mul_f32 v12, v12, v25
  v_cvt_pk_bf16_f32 v26, v12, v12
  v_lshlrev_b32 v12, 16, v26
  v_mul_f32 v13, v13, v25
  v_cvt_pk_bf16_f32 v26, v13, v13
  v_lshlrev_b32 v13, 16, v26
  v_mul_f32 v14, v14, v25
  v_cvt_pk_bf16_f32 v26, v14, v14
  v_lshlrev_b32 v14, 16, v26
  v_mul_f32 v15, v15, v25
  v_cvt_pk_bf16_f32 v26, v15, v15
  v_lshlrev_b32 v15, 16, v26
  v_mul_f32 v16, v16, v25
  v_cvt_pk_bf16_f32 v26, v16, v16
  v_lshlrev_b32 v16, 16, v26
  v_mul_f32 v17, v17, v25
  v_cvt_pk_bf16_f32 v26, v17, v17
  v_lshlrev_b32 v17, 16, v26
  v_mul_f32 v18, v18, v25
  v_cvt_pk_bf16_f32 v26, v18, v18
  v_lshlrev_b32 v18, 16, v26
  v_mul_f32 v19, v19, v25
  v_cvt_pk_bf16_f32 v26, v19, v19
  v_lshlrev_b32 v19, 16, v26
  s_cmp_ge_u32 s40, 52
  s_cbranch_scc1 pvc_301
  s_branch pvg_300
pvw_295:
  s_waitcnt vmcnt(0)
  v_sub_f32 v25, 1.0, v24
  v_cvt_pk_bf16_f32 v26, v25, v25
  v_lshlrev_b32 v25, 16, v26
  v_cvt_pk_bf16_f32 v26, v12, v12
  v_lshlrev_b32 v12, 16, v26
  v_cvt_pk_bf16_f32 v26, v13, v13
  v_lshlrev_b32 v13, 16, v26
  v_cvt_pk_bf16_f32 v26, v14, v14
  v_lshlrev_b32 v14, 16, v26
  v_cvt_pk_bf16_f32 v26, v15, v15
  v_lshlrev_b32 v15, 16, v26
  v_cvt_pk_bf16_f32 v26, v16, v16
  v_lshlrev_b32 v16, 16, v26
  v_cvt_pk_bf16_f32 v26, v17, v17
  v_lshlrev_b32 v17, 16, v26
  v_cvt_pk_bf16_f32 v26, v18, v18
  v_lshlrev_b32 v18, 16, v26
  v_cvt_pk_bf16_f32 v26, v19, v19
  v_lshlrev_b32 v19, 16, v26
  v_mul_f32 v12, v12, v25
  v_cvt_pk_bf16_f32 v26, v12, v12
  v_lshlrev_b32 v12, 16, v26
  v_mul_f32 v13, v13, v25
  v_cvt_pk_bf16_f32 v26, v13, v13
  v_lshlrev_b32 v13, 16, v26
  v_mul_f32 v14, v14, v25
  v_cvt_pk_bf16_f32 v26, v14, v14
  v_lshlrev_b32 v14, 16, v26
  v_mul_f32 v15, v15, v25
  v_cvt_pk_bf16_f32 v26, v15, v15
  v_lshlrev_b32 v15, 16, v26
  v_mul_f32 v16, v16, v25
  v_cvt_pk_bf16_f32 v26, v16, v16
  v_lshlrev_b32 v16, 16, v26
  v_mul_f32 v17, v17, v25
  v_cvt_pk_bf16_f32 v26, v17, v17
  v_lshlrev_b32 v17, 16, v26
  v_mul_f32 v18, v18, v25
  v_cvt_pk_bf16_f32 v26, v18, v18
  v_lshlrev_b32 v18, 16, v26
  v_mul_f32 v19, v19, v25
  v_cvt_pk_bf16_f32 v26, v19, v19
  v_lshlrev_b32 v19, 16, v26
  s_cmp_ge_u32 s40, 52
  s_cbranch_scc1 pvt_303
  s_cmp_lg_u32 s20, 0
  s_cbranch_scc1 wm_305
  s_mov_b32 s101, 0
wm_304:
  buffer_load_dword v26, v7, s[72:75], s52 offen sc1
  s_add_u32 s101, s101, 1
  s_cmp_gt_u32 s101, 131072
  s_cbranch_scc1 main_end
  s_waitcnt vmcnt(0)
  v_cmp_gt_u32 vcc, 4, v26
  v_readfirstlane_b32 s100, v26
  s_nop 0
  s_cbranch_vccz wm_305
  s_sleep 2
  s_add_u32 s100, s100, 3
  s_cmp_ge_u32 s100, 4
  s_cbranch_scc1 wm_304
  s_sleep 24
  s_branch wm_304
wm_305:
  s_barrier
  buffer_load_dwordx4 v[64:67], v4, s[16:19], s47 offen sc1
  buffer_load_dwordx2 v[68:69], v5, s[16:19], s47 offen offset:2048 sc1
  buffer_load_dwordx4 v[128:131], v21, s[16:19], s47 offen offset:1024 sc1
  buffer_load_dwordx4 v[132:135], v21, s[16:19], s47 offen offset:1280 sc1
  s_add_u32 s47, s47, 2560
  buffer_load_dwordx4 v[72:75], v4, s[16:19], s47 offen sc1
  buffer_load_dwordx2 v[76:77], v5, s[16:19], s47 offen offset:2048 sc1
  s_add_u32 s47, s47, 2560
  buffer_load_dwordx4 v[80:83], v4, s[16:19], s47 offen sc1
  buffer_load_dwordx2 v[84:85], v5, s[16:19], s47 offen offset:2048 sc1
  s_add_u32 s47, s47, 2560
  buffer_load_dwordx4 v[88:91], v4, s[16:19], s47 offen sc1
  buffer_load_dwordx2 v[92:93], v5, s[16:19], s47 offen offset:2048 sc1
  s_add_u32 s47, s47, 2560
  buffer_load_dwordx4 v[32:35], v22, s[16:19], s48 offen offset:0 sc1
  buffer_load_dwordx4 v[36:39], v22, s[16:19], s48 offen offset:256 sc1
  buffer_load_dwordx4 v[40:43], v22, s[16:19], s48 offen offset:512 sc1
  buffer_load_dwordx4 v[44:47], v22, s[16:19], s48 offen offset:768 sc1
  s_add_u32 s48, s48, 40960
  buffer_load_dwordx4 v[96:99], v4, s[16:19], s47 offen sc1
  buffer_load_dwordx2 v[100:101], v5, s[16:19], s47 offen offset:2048 sc1
  buffer_load_dwordx4 v[136:139], v21, s[16:19], s47 offen offset:1024 sc1
  buffer_load_dwordx4 v[140:143], v21, s[16:19], s47 offen offset:1280 sc1
  s_add_u32 s47, s47, 2560
  buffer_load_dwordx4 v[104:107], v4, s[16:19], s47 offen sc1
  buffer_load_dwordx2 v[108:109], v5, s[16:19], s47 offen offset:2048 sc1
  s_add_u32 s47, s47, 2560
  buffer_load_dwordx4 v[112:115], v4, s[16:19], s47 offen sc1
  buffer_load_dwordx2 v[116:117], v5, s[16:19], s47 offen offset:2048 sc1
  s_add_u32 s47, s47, 2560
  buffer_load_dwordx4 v[120:123], v4, s[16:19], s47 offen sc1
  buffer_load_dwordx2 v[124:125], v5, s[16:19], s47 offen offset:2048 sc1
  s_add_u32 s47, s47, 2560
  buffer_load_dwordx4 v[48:51], v22, s[16:19], s48 offen offset:0 sc1
  buffer_load_dwordx4 v[52:55], v22, s[16:19], s48 offen offset:256 sc1
  buffer_load_dwordx4 v[56:59], v22, s[16:19], s48 offen offset:512 sc1
  buffer_load_dwordx4 v[60:63], v22, s[16:19], s48 offen offset:768 sc1
  s_add_u32 s48, s48, 40960
pvg_300:
  s_add_u32 s41, s41, 1
  s_mul_i32 s53, s42, 40960
  s_lshl_b32 s22, s41, 12
  s_add_u32 s53, s53, s22
  s_mul_i32 s48, s42, 10240
  s_lshl_b32 s22, s41, 10
  s_add_u32 s48, s48, s22
  s_add_u32 s48, s48, 15728640
  s_waitcnt vmcnt(26)
  v_mfma_f32_16x16x32_bf16 v[148:151], a[0:3], v[64:67], 0
  v_mfma_f32_16x16x32_bf16 v[144:147], a[0:3], v[68:71], 0
  v_mfma_f32_16x16x32_bf16 v[156:159], a[4:7], v[64:67], 0
  v_mfma_f32_16x16x32_bf16 v[152:155], a[4:7], v[68:71], 0
  v_mfma_f32_16x16x32_bf16 v[164:167], a[8:11], v[64:67], 0
  v_mfma_f32_16x16x32_bf16 v[160:163], a[8:11], v[68:71], 0
  v_mfma_f32_16x16x32_bf16 v[172:175], a[12:15], v[64:67], 0
  v_mfma_f32_16x16x32_bf16 v[168:171], a[12:15], v[68:71], 0
  buffer_load_dwordx4 a[0:3], v4, s[12:15], s53 offen offset:0 sc1
  buffer_load_dwordx4 a[4:7], v4, s[12:15], s53 offen offset:1024 sc1
  buffer_load_dwordx4 a[8:11], v4, s[12:15], s53 offen offset:2048 sc1
  buffer_load_dwordx4 a[12:15], v4, s[12:15], s53 offen offset:3072 sc1
  s_waitcnt vmcnt(26)
  v_mfma_f32_16x16x32_bf16 v[148:151], a[16:19], v[72:75], v[148:151]
  v_mfma_f32_16x16x32_bf16 v[144:147], a[16:19], v[76:79], v[144:147]
  v_mfma_f32_16x16x32_bf16 v[156:159], a[20:23], v[72:75], v[156:159]
  v_mfma_f32_16x16x32_bf16 v[152:155], a[20:23], v[76:79], v[152:155]
  v_mfma_f32_16x16x32_bf16 v[164:167], a[24:27], v[72:75], v[164:167]
  v_mfma_f32_16x16x32_bf16 v[160:163], a[24:27], v[76:79], v[160:163]
  v_mfma_f32_16x16x32_bf16 v[172:175], a[28:31], v[72:75], v[172:175]
  v_mfma_f32_16x16x32_bf16 v[168:171], a[28:31], v[76:79], v[168:171]
  s_add_u32 s53, s53, 40960
  buffer_load_dwordx4 a[16:19], v4, s[12:15], s53 offen offset:0 sc1
  buffer_load_dwordx4 a[20:23], v4, s[12:15], s53 offen offset:1024 sc1
  buffer_load_dwordx4 a[24:27], v4, s[12:15], s53 offen offset:2048 sc1
  buffer_load_dwordx4 a[28:31], v4, s[12:15], s53 offen offset:3072 sc1
  s_waitcnt vmcnt(28)
  v_mfma_f32_16x16x32_bf16 v[148:151], a[32:35], v[80:83], v[148:151]
  v_mfma_f32_16x16x32_bf16 v[144:147], a[32:35], v[84:87], v[144:147]
  v_mfma_f32_16x16x32_bf16 v[156:159], a[36:39], v[80:83], v[156:159]
  v_mfma_f32_16x16x32_bf16 v[152:155], a[36:39], v[84:87], v[152:155]
  v_mfma_f32_16x16x32_bf16 v[164:167], a[40:43], v[80:83], v[164:167]
  v_mfma_f32_16x16x32_bf16 v[160:163], a[40:43], v[84:87], v[160:163]
  v_mfma_f32_16x16x32_bf16 v[172:175], a[44:47], v[80:83], v[172:175]
  v_mfma_f32_16x16x32_bf16 v[168:171], a[44:47], v[84:87], v[168:171]
  s_add_u32 s53, s53, 40960
  buffer_load_dwordx4 a[32:35], v4, s[12:15], s53 offen offset:0 sc1
  buffer_load_dwordx4 a[36:39], v4, s[12:15], s53 offen offset:1024 sc1
  buffer_load_dwordx4 a[40:43], v4, s[12:15], s53 offen offset:2048 sc1
  buffer_load_dwordx4 a[44:47], v4, s[12:15], s53 offen offset:3072 sc1
  s_waitcnt vmcnt(30)
  v_mfma_f32_16x16x32_bf16 v[148:151], a[48:51], v[88:91], v[148:151]
  v_mfma_f32_16x16x32_bf16 v[144:147], a[48:51], v[92:95], v[144:147]
  v_mfma_f32_16x16x32_bf16 v[156:159], a[52:55], v[88:91], v[156:159]
  v_mfma_f32_16x16x32_bf16 v[152:155], a[52:55], v[92:95], v[152:155]
  v_mfma_f32_16x16x32_bf16 v[164:167], a[56:59], v[88:91], v[164:167]
  v_mfma_f32_16x16x32_bf16 v[160:163], a[56:59], v[92:95], v[160:163]
  v_mfma_f32_16x16x32_bf16 v[172:175], a[60:63], v[88:91], v[172:175]
  v_mfma_f32_16x16x32_bf16 v[168:171], a[60:63], v[92:95], v[168:171]
  s_add_u32 s53, s53, 40960
  buffer_load_dwordx4 a[48:51], v4, s[12:15], s53 offen offset:0 sc1
  buffer_load_dwordx4 a[52:55], v4, s[12:15], s53 offen offset:1024 sc1
  buffer_load_dwordx4 a[56:59], v4, s[12:15], s53 offen offset:2048 sc1
  buffer_load_dwordx4 a[60:63], v4, s[12:15], s53 offen offset:3072 sc1
  s_waitcnt vmcnt(30)
  v_mfma_f32_16x16x32_bf16 v[144:147], v[32:35], v[128:131], v[144:147]
  v_mfma_f32_16x16x32_bf16 v[148:151], v[32:35], v[132:135], v[148:151]
  v_mfma_f32_16x16x32_bf16 v[152:155], v[36:39], v[128:131], v[152:155]
  v_mfma_f32_16x16x32_bf16 v[156:159], v[36:39], v[132:135], v[156:159]
  v_mfma_f32_16x16x32_bf16 v[160:163], v[40:43], v[128:131], v[160:163]
  v_mfma_f32_16x16x32_bf16 v[164:167], v[40:43], v[132:135], v[164:167]
  v_mfma_f32_16x16x32_bf16 v[168:171], v[44:47], v[128:131], v[168:171]
  v_mfma_f32_16x16x32_bf16 v[172:175], v[44:47], v[132:135], v[172:175]
  buffer_load_dwordx4 v[32:35], v22, s[16:19], s48 offen offset:0 sc1
  buffer_load_dwordx4 v[36:39], v22, s[16:19], s48 offen offset:256 sc1
  buffer_load_dwordx4 v[40:43], v22, s[16:19], s48 offen offset:512 sc1
  buffer_load_dwordx4 v[44:47], v22, s[16:19], s48 offen offset:768 sc1
  s_add_u32 s48, s48, 40960
  s_waitcnt vmcnt(32)
  v_mfma_f32_16x16x32_bf16 v[148:151], a[64:67], v[96:99], v[148:151]
  v_mfma_f32_16x16x32_bf16 v[144:147], a[64:67], v[100:103], v[144:147]
  v_mfma_f32_16x16x32_bf16 v[156:159], a[68:71], v[96:99], v[156:159]
  v_mfma_f32_16x16x32_bf16 v[152:155], a[68:71], v[100:103], v[152:155]
  v_mfma_f32_16x16x32_bf16 v[164:167], a[72:75], v[96:99], v[164:167]
  v_mfma_f32_16x16x32_bf16 v[160:163], a[72:75], v[100:103], v[160:163]
  v_mfma_f32_16x16x32_bf16 v[172:175], a[76:79], v[96:99], v[172:175]
  v_mfma_f32_16x16x32_bf16 v[168:171], a[76:79], v[100:103], v[168:171]
  s_add_u32 s53, s53, 40960
  buffer_load_dwordx4 a[64:67], v4, s[12:15], s53 offen offset:0 sc1
  buffer_load_dwordx4 a[68:71], v4, s[12:15], s53 offen offset:1024 sc1
  buffer_load_dwordx4 a[72:75], v4, s[12:15], s53 offen offset:2048 sc1
  buffer_load_dwordx4 a[76:79], v4, s[12:15], s53 offen offset:3072 sc1
  s_waitcnt vmcnt(32)
  v_mfma_f32_16x16x32_bf16 v[148:151], a[80:83], v[104:107], v[148:151]
  v_mfma_f32_16x16x32_bf16 v[144:147], a[80:83], v[108:111], v[144:147]
  v_mfma_f32_16x16x32_bf16 v[156:159], a[84:87], v[104:107], v[156:159]
  v_mfma_f32_16x16x32_bf16 v[152:155], a[84:87], v[108:111], v[152:155]
  v_mfma_f32_16x16x32_bf16 v[164:167], a[88:91], v[104:107], v[164:167]
  v_mfma_f32_16x16x32_bf16 v[160:163], a[88:91], v[108:111], v[160:163]
  v_mfma_f32_16x16x32_bf16 v[172:175], a[92:95], v[104:107], v[172:175]
  v_mfma_f32_16x16x32_bf16 v[168:171], a[92:95], v[108:111], v[168:171]
  s_add_u32 s53, s53, 40960
  buffer_load_dwordx4 a[80:83], v4, s[12:15], s53 offen offset:0 sc1
  buffer_load_dwordx4 a[84:87], v4, s[12:15], s53 offen offset:1024 sc1
  buffer_load_dwordx4 a[88:91], v4, s[12:15], s53 offen offset:2048 sc1
  buffer_load_dwordx4 a[92:95], v4, s[12:15], s53 offen offset:3072 sc1
  s_waitcnt vmcnt(34)
  v_mfma_f32_16x16x32_bf16 v[148:151], a[96:99], v[112:115], v[148:151]
  v_mfma_f32_16x16x32_bf16 v[144:147], a[96:99], v[116:119], v[144:147]
  v_mfma_f32_16x16x32_bf16 v[156:159], a[100:103], v[112:115], v[156:159]
  v_mfma_f32_16x16x32_bf16 v[152:155], a[100:103], v[116:119], v[152:155]
  v_mfma_f32_16x16x32_bf16 v[164:167], a[104:107], v[112:115], v[164:167]
  v_mfma_f32_16x16x32_bf16 v[160:163], a[104:107], v[116:119], v[160:163]
  v_mfma_f32_16x16x32_bf16 v[172:175], a[108:111], v[112:115], v[172:175]
  v_mfma_f32_16x16x32_bf16 v[168:171], a[108:111], v[116:119], v[168:171]
  s_add_u32 s53, s53, 40960
  buffer_load_dwordx4 a[96:99], v4, s[12:15], s53 offen offset:0 sc1
  buffer_load_dwordx4 a[100:103], v4, s[12:15], s53 offen offset:1024 sc1
  buffer_load_dwordx4 a[104:107], v4, s[12:15], s53 offen offset:2048 sc1
  buffer_load_dwordx4 a[108:111], v4, s[12:15], s53 offen offset:3072 sc1
  s_waitcnt vmcnt(36)
  v_mfma_f32_16x16x32_bf16 v[148:151], a[112:115], v[120:123], v[148:151]
  v_mfma_f32_16x16x32_bf16 v[144:147], a[112:115], v[124:127], v[144:147]
  v_mfma_f32_16x16x32_bf16 v[156:159], a[116:119], v[120:123], v[156:159]
  v_mfma_f32_16x16x32_bf16 v[152:155], a[116:119], v[124:127], v[152:155]
  v_mfma_f32_16x16x32_bf16 v[164:167], a[120:123], v[120:123], v[164:167]
  v_mfma_f32_16x16x32_bf16 v[160:163], a[120:123], v[124:127], v[160:163]
  v_mfma_f32_16x16x32_bf16 v[172:175], a[124:127], v[120:123], v[172:175]
  v_mfma_f32_16x16x32_bf16 v[168:171], a[124:127], v[124:127], v[168:171]
  s_add_u32 s53, s53, 40960
  buffer_load_dwordx4 a[112:115], v4, s[12:15], s53 offen offset:0 sc1
  buffer_load_dwordx4 a[116:119], v4, s[12:15], s53 offen offset:1024 sc1
  buffer_load_dwordx4 a[120:123], v4, s[12:15], s53 offen offset:2048 sc1
  buffer_load_dwordx4 a[124:127], v4, s[12:15], s53 offen offset:3072 sc1
  s_waitcnt vmcnt(36)
  v_mfma_f32_16x16x32_bf16 v[144:147], v[48:51], v[136:139], v[144:147]
  v_mfma_f32_16x16x32_bf16 v[148:151], v[48:51], v[140:143], v[148:151]
  v_mfma_f32_16x16x32_bf16 v[152:155], v[52:55], v[136:139], v[152:155]
  v_mfma_f32_16x16x32_bf16 v[156:159], v[52:55], v[140:143], v[156:159]
  v_mfma_f32_16x16x32_bf16 v[160:163], v[56:59], v[136:139], v[160:163]
  v_mfma_f32_16x16x32_bf16 v[164:167], v[56:59], v[140:143], v[164:167]
  v_mfma_f32_16x16x32_bf16 v[168:171], v[60:63], v[136:139], v[168:171]
  v_mfma_f32_16x16x32_bf16 v[172:175], v[60:63], v[140:143], v[172:175]
  buffer_load_dwordx4 v[48:51], v22, s[16:19], s48 offen offset:0 sc1
  buffer_load_dwordx4 v[52:55], v22, s[16:19], s48 offen offset:256 sc1
  buffer_load_dwordx4 v[56:59], v22, s[16:19], s48 offen offset:512 sc1
  buffer_load_dwordx4 v[60:63], v22, s[16:19], s48 offen offset:768 sc1
  s_add_u32 s48, s48, 40960
  s_branch pve_296
pvt_303:
  s_sub_u32 s55, s52, 2048
  s_cmp_lg_u32 s20, 0
  s_cbranch_scc1 wm_307
  s_mov_b32 s101, 0
wm_306:
  buffer_load_dword v26, v7, s[72:75], s55 offen sc1
  s_add_u32 s101, s101, 1
  s_cmp_gt_u32 s101, 131072
  s_cbranch_scc1 main_end
  s_waitcnt vmcnt(0)
  v_cmp_gt_u32 vcc, 4, v26
  v_readfirstlane_b32 s100, v26
  s_nop 0
  s_cbranch_vccz wm_307
  s_sleep 4
  s_add_u32 s100, s100, 3
  s_cmp_ge_u32 s100, 4
  s_cbranch_scc1 wm_306
  s_sleep 24
  s_branch wm_306
wm_307:
  s_barrier
  s_mov_b32 s56, s47
  s_mov_b32 s57, s48
  buffer_load_dwordx4 v[64:67], v4, s[16:19], s56 offen sc1
  buffer_load_dwordx2 v[68:69], v5, s[16:19], s56 offen offset:2048 sc1
  buffer_load_dwordx4 v[128:131], v21, s[16:19], s56 offen offset:1024 sc1
  buffer_load_dwordx4 v[132:135], v21, s[16:19], s56 offen offset:1280 sc1
  s_add_u32 s56, s56, 2560
  buffer_load_dwordx4 v[72:75], v4, s[16:19], s56 offen sc1
  buffer_load_dwordx2 v[76:77], v5, s[16:19], s56 offen offset:2048 sc1
  s_add_u32 s56, s56, 2560
  buffer_load_dwordx4 v[80:83], v4, s[16:19], s56 offen sc1
  buffer_load_dwordx2 v[84:85], v5, s[16:19], s56 offen offset:2048 sc1
  s_add_u32 s56, s56, 2560
  buffer_load_dwordx4 v[88:91], v4, s[16:19], s56 offen sc1
  buffer_load_dwordx2 v[92:93], v5, s[16:19], s56 offen offset:2048 sc1
  s_add_u32 s56, s56, 2560
  buffer_load_dwordx4 v[32:35], v22, s[16:19], s57 offen offset:0 sc1
  buffer_load_dwordx4 v[36:39], v22, s[16:19], s57 offen offset:256 sc1
  buffer_load_dwordx4 v[40:43], v22, s[16:19], s57 offen offset:512 sc1
  buffer_load_dwordx4 v[44:47], v22, s[16:19], s57 offen offset:768 sc1
  s_add_u32 s57, s57, 40960
  buffer_load_dwordx4 v[96:99], v4, s[16:19], s56 offen sc1
  buffer_load_dwordx2 v[100:101], v5, s[16:19], s56 offen offset:2048 sc1
  buffer_load_dwordx4 v[136:139], v21, s[16:19], s56 offen offset:1024 sc1
  buffer_load_dwordx4 v[140:143], v21, s[16:19], s56 offen offset:1280 sc1
  s_add_u32 s56, s56, 2560
  buffer_load_dwordx4 v[104:107], v4, s[16:19], s56 offen sc1
  buffer_load_dwordx2 v[108:109], v5, s[16:19], s56 offen offset:2048 sc1
  s_add_u32 s56, s56, 2560
  buffer_load_dwordx4 v[112:115], v4, s[16:19], s56 offen sc1
  buffer_load_dwordx2 v[116:117], v5, s[16:19], s56 offen offset:2048 sc1
  s_add_u32 s56, s56, 2560
  buffer_load_dwordx4 v[120:123], v4, s[16:19], s56 offen sc1
  buffer_load_dwordx2 v[124:125], v5, s[16:19], s56 offen offset:2048 sc1
  s_add_u32 s56, s56, 2560
  buffer_load_dwordx4 v[48:51], v22, s[16:19], s57 offen offset:0 sc1
  buffer_load_dwordx4 v[52:55], v22, s[16:19], s57 offen offset:256 sc1
  buffer_load_dwordx4 v[56:59], v22, s[16:19], s57 offen offset:512 sc1
  buffer_load_dwordx4 v[60:63], v22, s[16:19], s57 offen offset:768 sc1
  s_add_u32 s57, s57, 40960
pvc_301:
  s_mov_b32 s101, 0
  s_waitcnt vmcnt(14)
  s_branch pvr_309
pvr_308:
  s_sleep 2
  s_add_u32 s56, s47, 0
  s_add_u32 s57, s48, 0
  buffer_load_dwordx4 v[64:67], v4, s[16:19], s56 offen sc1
  buffer_load_dwordx2 v[68:69], v5, s[16:19], s56 offen offset:2048 sc1
  buffer_load_dwordx4 v[128:131], v21, s[16:19], s56 offen offset:1024 sc1
  buffer_load_dwordx4 v[132:135], v21, s[16:19], s56 offen offset:1280 sc1
  s_add_u32 s56, s56, 2560
  buffer_load_dwordx4 v[72:75], v4, s[16:19], s56 offen sc1
  buffer_load_dwordx2 v[76:77], v5, s[16:19], s56 offen offset:2048 sc1
  s_add_u32 s56, s56, 2560
  buffer_load_dwordx4 v[80:83], v4, s[16:19], s56 offen sc1
  buffer_load_dwordx2 v[84:85], v5, s[16:19], s56 offen offset:2048 sc1
  s_add_u32 s56, s56, 2560
  buffer_load_dwordx4 v[88:91], v4, s[16:19], s56 offen sc1
  buffer_load_dwordx2 v[92:93], v5, s[16:19], s56 offen offset:2048 sc1
  s_add_u32 s56, s56, 2560
  buffer_load_dwordx4 v[32:35], v22, s[16:19], s57 offen offset:0 sc1
  buffer_load_dwordx4 v[36:39], v22, s[16:19], s57 offen offset:256 sc1
  buffer_load_dwordx4 v[40:43], v22, s[16:19], s57 offen offset:512 sc1
  buffer_load_dwordx4 v[44:47], v22, s[16:19], s57 offen offset:768 sc1
  s_add_u32 s57, s57, 40960
  s_add_u32 s101, s101, 1
  s_cmp_gt_u32 s101, 131072
  s_cbranch_scc1 main_end
  s_waitcnt vmcnt(0)
pvr_309:
  v_max3_u32 v26, v64, v68, v72
  v_max3_u32 v26, v26, v76, v80
  v_max3_u32 v26, v26, v84, v88
  v_max3_u32 v26, v26, v92, v128
  v_max3_u32 v26, v26, v132, v32
  v_max3_u32 v26, v26, v36, v40
  v_max3_u32 v26, v26, v44, v44
  v_cmp_eq_u32 vcc, -1, v26
  s_nop 1
  s_cbranch_vccnz pvr_308
  v_mfma_f32_16x16x32_bf16 v[148:151], a[0:3], v[64:67], 0
  v_mfma_f32_16x16x32_bf16 v[144:147], a[0:3], v[68:71], 0
  v_mfma_f32_16x16x32_bf16 v[156:159], a[4:7], v[64:67], 0
  v_mfma_f32_16x16x32_bf16 v[152:155], a[4:7], v[68:71], 0
  v_mfma_f32_16x16x32_bf16 v[164:167], a[8:11], v[64:67], 0
  v_mfma_f32_16x16x32_bf16 v[160:163], a[8:11], v[68:71], 0
  v_mfma_f32_16x16x32_bf16 v[172:175], a[12:15], v[64:67], 0
  v_mfma_f32_16x16x32_bf16 v[168:171], a[12:15], v[68:71], 0
  v_mfma_f32_16x16x32_bf16 v[148:151], a[16:19], v[72:75], v[148:151]
  v_mfma_f32_16x16x32_bf16 v[144:147], a[16:19], v[76:79], v[144:147]
  v_mfma_f32_16x16x32_bf16 v[156:159], a[20:23], v[72:75], v[156:159]
  v_mfma_f32_16x16x32_bf16 v[152:155], a[20:23], v[76:79], v[152:155]
  v_mfma_f32_16x16x32_bf16 v[164:167], a[24:27], v[72:75], v[164:167]
  v_mfma_f32_16x16x32_bf16 v[160:163], a[24:27], v[76:79], v[160:163]
  v_mfma_f32_16x16x32_bf16 v[172:175], a[28:31], v[72:75], v[172:175]
  v_mfma_f32_16x16x32_bf16 v[168:171], a[28:31], v[76:79], v[168:171]
  v_mfma_f32_16x16x32_bf16 v[148:151], a[32:35], v[80:83], v[148:151]
  v_mfma_f32_16x16x32_bf16 v[144:147], a[32:35], v[84:87], v[144:147]
  v_mfma_f32_16x16x32_bf16 v[156:159], a[36:39], v[80:83], v[156:159]
  v_mfma_f32_16x16x32_bf16 v[152:155], a[36:39], v[84:87], v[152:155]
  v_mfma_f32_16x16x32_bf16 v[164:167], a[40:43], v[80:83], v[164:167]
  v_mfma_f32_16x16x32_bf16 v[160:163], a[40:43], v[84:87], v[160:163]
  v_mfma_f32_16x16x32_bf16 v[172:175], a[44:47], v[80:83], v[172:175]
  v_mfma_f32_16x16x32_bf16 v[168:171], a[44:47], v[84:87], v[168:171]
  v_mfma_f32_16x16x32_bf16 v[148:151], a[48:51], v[88:91], v[148:151]
  v_mfma_f32_16x16x32_bf16 v[144:147], a[48:51], v[92:95], v[144:147]
  v_mfma_f32_16x16x32_bf16 v[156:159], a[52:55], v[88:91], v[156:159]
  v_mfma_f32_16x16x32_bf16 v[152:155], a[52:55], v[92:95], v[152:155]
  v_mfma_f32_16x16x32_bf16 v[164:167], a[56:59], v[88:91], v[164:167]
  v_mfma_f32_16x16x32_bf16 v[160:163], a[56:59], v[92:95], v[160:163]
  v_mfma_f32_16x16x32_bf16 v[172:175], a[60:63], v[88:91], v[172:175]
  v_mfma_f32_16x16x32_bf16 v[168:171], a[60:63], v[92:95], v[168:171]
  s_nop 1
  v_mfma_f32_16x16x32_bf16 v[144:147], v[32:35], v[128:131], v[144:147]
  v_mfma_f32_16x16x32_bf16 v[148:151], v[32:35], v[132:135], v[148:151]
  v_mfma_f32_16x16x32_bf16 v[152:155], v[36:39], v[128:131], v[152:155]
  v_mfma_f32_16x16x32_bf16 v[156:159], v[36:39], v[132:135], v[156:159]
  v_mfma_f32_16x16x32_bf16 v[160:163], v[40:43], v[128:131], v[160:163]
  v_mfma_f32_16x16x32_bf16 v[164:167], v[40:43], v[132:135], v[164:167]
  v_mfma_f32_16x16x32_bf16 v[168:171], v[44:47], v[128:131], v[168:171]
  v_mfma_f32_16x16x32_bf16 v[172:175], v[44:47], v[132:135], v[172:175]
  s_mov_b32 s101, 0
  s_waitcnt vmcnt(0)
  s_branch pvr_311
pvr_310:
  s_sleep 2
  s_add_u32 s56, s47, 10240
  s_add_u32 s57, s48, 40960
  buffer_load_dwordx4 v[96:99], v4, s[16:19], s56 offen sc1
  buffer_load_dwordx2 v[100:101], v5, s[16:19], s56 offen offset:2048 sc1
  buffer_load_dwordx4 v[136:139], v21, s[16:19], s56 offen offset:1024 sc1
  buffer_load_dwordx4 v[140:143], v21, s[16:19], s56 offen offset:1280 sc1
  s_add_u32 s56, s56, 2560
  buffer_load_dwordx4 v[104:107], v4, s[16:19], s56 offen sc1
  buffer_load_dwordx2 v[108:109], v5, s[16:19], s56 offen offset:2048 sc1
  s_add_u32 s56, s56, 2560
  buffer_load_dwordx4 v[112:115], v4, s[16:19], s56 offen sc1
  buffer_load_dwordx2 v[116:117], v5, s[16:19], s56 offen offset:2048 sc1
  s_add_u32 s56, s56, 2560
  buffer_load_dwordx4 v[120:123], v4, s[16:19], s56 offen sc1
  buffer_load_dwordx2 v[124:125], v5, s[16:19], s56 offen offset:2048 sc1
  s_add_u32 s56, s56, 2560
  buffer_load_dwordx4 v[48:51], v22, s[16:19], s57 offen offset:0 sc1
  buffer_load_dwordx4 v[52:55], v22, s[16:19], s57 offen offset:256 sc1
  buffer_load_dwordx4 v[56:59], v22, s[16:19], s57 offen offset:512 sc1
  buffer_load_dwordx4 v[60:63], v22, s[16:19], s57 offen offset:768 sc1
  s_add_u32 s57, s57, 40960
  s_add_u32 s101, s101, 1
  s_cmp_gt_u32 s101, 131072
  s_cbranch_scc1 main_end
  s_waitcnt vmcnt(0)
pvr_311:
  v_max3_u32 v26, v96, v100, v104
  v_max3_u32 v26, v26, v108, v112
  v_max3_u32 v26, v26, v116, v120
  v_max3_u32 v26, v26, v124, v136
  v_max3_u32 v26, v26, v140, v48
  v_max3_u32 v26, v26, v52, v56
  v_max3_u32 v26, v26, v60, v60
  v_cmp_eq_u32 vcc, -1, v26
  s_nop 1
  s_cbranch_vccnz pvr_310
  v_mfma_f32_16x16x32_bf16 v[148:151], a[64:67], v[96:99], v[148:151]
  v_mfma_f32_16x16x32_bf16 v[144:147], a[64:67], v[100:103], v[144:147]
  v_mfma_f32_16x16x32_bf16 v[156:159], a[68:71], v[96:99], v[156:159]
  v_mfma_f32_16x16x32_bf16 v[152:155], a[68:71], v[100:103], v[152:155]
  v_mfma_f32_16x16x32_bf16 v[164:167], a[72:75], v[96:99], v[164:167]
  v_mfma_f32_16x16x32_bf16 v[160:163], a[72:75], v[100:103], v[160:163]
  v_mfma_f32_16x16x32_bf16 v[172:175], a[76:79], v[96:99], v[172:175]
  v_mfma_f32_16x16x32_bf16 v[168:171], a[76:79], v[100:103], v[168:171]
  v_mfma_f32_16x16x32_bf16 v[148:151], a[80:83], v[104:107], v[148:151]
  v_mfma_f32_16x16x32_bf16 v[144:147], a[80:83], v[108:111], v[144:147]
  v_mfma_f32_16x16x32_bf16 v[156:159], a[84:87], v[104:107], v[156:159]
  v_mfma_f32_16x16x32_bf16 v[152:155], a[84:87], v[108:111], v[152:155]
  v_mfma_f32_16x16x32_bf16 v[164:167], a[88:91], v[104:107], v[164:167]
  v_mfma_f32_16x16x32_bf16 v[160:163], a[88:91], v[108:111], v[160:163]
  v_mfma_f32_16x16x32_bf16 v[172:175], a[92:95], v[104:107], v[172:175]
  v_mfma_f32_16x16x32_bf16 v[168:171], a[92:95], v[108:111], v[168:171]
  v_mfma_f32_16x16x32_bf16 v[148:151], a[96:99], v[112:115], v[148:151]
  v_mfma_f32_16x16x32_bf16 v[144:147], a[96:99], v[116:119], v[144:147]
  v_mfma_f32_16x16x32_bf16 v[156:159], a[100:103], v[112:115], v[156:159]
  v_mfma_f32_16x16x32_bf16 v[152:155], a[100:103], v[116:119], v[152:155]
  v_mfma_f32_16x16x32_bf16 v[164:167], a[104:107], v[112:115], v[164:167]
  v_mfma_f32_16x16x32_bf16 v[160:163], a[104:107], v[116:119], v[160:163]
  v_mfma_f32_16x16x32_bf16 v[172:175], a[108:111], v[112:115], v[172:175]
  v_mfma_f32_16x16x32_bf16 v[168:171], a[108:111], v[116:119], v[168:171]
  v_mfma_f32_16x16x32_bf16 v[148:151], a[112:115], v[120:123], v[148:151]
  v_mfma_f32_16x16x32_bf16 v[144:147], a[112:115], v[124:127], v[144:147]
  v_mfma_f32_16x16x32_bf16 v[156:159], a[116:119], v[120:123], v[156:159]
  v_mfma_f32_16x16x32_bf16 v[152:155], a[116:119], v[124:127], v[152:155]
  v_mfma_f32_16x16x32_bf16 v[164:167], a[120:123], v[120:123], v[164:167]
  v_mfma_f32_16x16x32_bf16 v[160:163], a[120:123], v[124:127], v[160:163]
  v_mfma_f32_16x16x32_bf16 v[172:175], a[124:127], v[120:123], v[172:175]
  v_mfma_f32_16x16x32_bf16 v[168:171], a[124:127], v[124:127], v[168:171]
  s_nop 1
  v_mfma_f32_16x16x32_bf16 v[144:147], v[48:51], v[136:139], v[144:147]
  v_mfma_f32_16x16x32_bf16 v[148:151], v[48:51], v[140:143], v[148:151]
  v_mfma_f32_16x16x32_bf16 v[152:155], v[52:55], v[136:139], v[152:155]
  v_mfma_f32_16x16x32_bf16 v[156:159], v[52:55], v[140:143], v[156:159]
  v_mfma_f32_16x16x32_bf16 v[160:163], v[56:59], v[136:139], v[160:163]
  v_mfma_f32_16x16x32_bf16 v[164:167], v[56:59], v[140:143], v[164:167]
  v_mfma_f32_16x16x32_bf16 v[168:171], v[60:63], v[136:139], v[168:171]
  v_mfma_f32_16x16x32_bf16 v[172:175], v[60:63], v[140:143], v[172:175]
pve_296:
  s_nop 0
  s_cmp_lg_u32 s20, 0
  s_cbranch_scc1 lc_312
  s_sub_u32 s21, s2, 0
  s_cmp_ge_u32 s21, 640
  s_cbranch_scc1 lc_312
  v_mov_b32 v29, 1
  s_mov_b64 exec, 1
  buffer_atomic_add v29, v28, s[32:35], 0 offen sc0 sc1
  s_mov_b64 exec, -1
lc_312:
  ds_write_b128 v10, v[144:147] offset:0
  ds_write_b128 v10, v[148:151] offset:1024
  ds_write_b128 v10, v[152:155] offset:2048
  ds_write_b128 v10, v[156:159] offset:3072
  ds_write_b128 v10, v[160:163] offset:4096
  ds_write_b128 v10, v[164:167] offset:5120
  ds_write_b128 v10, v[168:171] offset:6144
  ds_write_b128 v10, v[172:175] offset:7168
  s_cmp_lg_u32 s20, 0
  s_cbranch_scc1 pvq_315
  v_readfirstlane_b32 s21, v29
  s_mov_b32 s23, -1
  v_mov_b32 v213, s23
  s_mov_b64 exec, 1
  ds_write_b32 v30, v29
  ds_write_b32 v30, v213 offset:8
  s_mov_b64 exec, -1
pvq_315:
  s_waitcnt lgkmcnt(0)
  s_barrier
  ds_read_b128 v[176:179], v11 offset:0
  ds_read_b128 v[180:183], v11 offset:8192
  ds_read_b128 v[184:187], v11 offset:16384
  ds_read_b128 v[188:191], v11 offset:24576
  ds_read_b128 v[192:195], v11 offset:4096
  ds_read_b128 v[196:199], v11 offset:12288
  ds_read_b128 v[200:203], v11 offset:20480
  ds_read_b128 v[204:207], v11 offset:28672
  ds_read_b32 v23, v30
  ds_read_b32 v213, v30 offset:8
  s_cmp_ge_u32 s40, 32
  s_cbranch_scc1 pvr_318
  s_waitcnt lgkmcnt(6)
  v_pk_add_f32 v[176:177], v[176:177], v[180:181]
  v_pk_add_f32 v[184:185], v[184:185], v[188:189]
  v_pk_add_f32 v[178:179], v[178:179], v[182:183]
  v_pk_add_f32 v[186:187], v[186:187], v[190:191]
  v_pk_add_f32 v[176:177], v[176:177], v[184:185]
  v_pk_add_f32 v[178:179], v[178:179], v[186:187]
  buffer_store_dwordx4 v[176:179], v4, s[24:27], s54 offen offset:0 sc1
  s_waitcnt lgkmcnt(2)
  v_pk_add_f32 v[192:193], v[192:193], v[196:197]
  v_pk_add_f32 v[200:201], v[200:201], v[204:205]
  v_pk_add_f32 v[194:195], v[194:195], v[198:199]
  v_pk_add_f32 v[202:203], v[202:203], v[206:207]
  v_pk_add_f32 v[192:193], v[192:193], v[200:201]
  v_pk_add_f32 v[194:195], v[194:195], v[202:203]
  buffer_store_dwordx4 v[192:195], v4, s[24:27], s54 offen offset:2048 sc1
  s_lshr_b32 s71, s40, 2
  s_lshl_b32 s71, s71, 7
  s_add_u32 s71, s71, 104448
  s_branch pvr_319
pvr_318:
  s_waitcnt lgkmcnt(6)
  v_pk_add_f32 v[176:177], v[176:177], v[180:181]
  v_pk_add_f32 v[184:185], v[184:185], v[188:189]
  v_pk_add_f32 v[178:179], v[178:179], v[182:183]
  v_pk_add_f32 v[186:187], v[186:187], v[190:191]
  v_pk_add_f32 v[176:177], v[176:177], v[184:185]
  v_pk_add_f32 v[178:179], v[178:179], v[186:187]
  v_cvt_pk_bf16_f32 v26, v176, v177
  v_lshlrev_b32 v176, 16, v26
  v_and_b32 v177, 0xffff0000, v26
  v_mul_f32 v176, v176, v24
  v_mul_f32 v177, v177, v24
  v_cvt_pk_bf16_f32 v26, v176, v177
  v_lshlrev_b32 v176, 16, v26
  v_and_b32 v177, 0xffff0000, v26
  v_add_f32 v176, v176, v12
  v_add_f32 v177, v177, v13
  v_cvt_pk_bf16_f32 v180, v176, v177
  v_cvt_pk_bf16_f32 v26, v178, v179
  v_lshlrev_b32 v178, 16, v26
  v_and_b32 v179, 0xffff0000, v26
  v_mul_f32 v178, v178, v24
  v_mul_f32 v179, v179, v24
  v_cvt_pk_bf16_f32 v26, v178, v179
  v_lshlrev_b32 v178, 16, v26
  v_and_b32 v179, 0xffff0000, v26
  v_add_f32 v178, v178, v14
  v_add_f32 v179, v179, v15
  v_cvt_pk_bf16_f32 v181, v178, v179
  buffer_store_dwordx2 v[180:181], v9, s[8:11], s46 offen offset:0
  s_waitcnt lgkmcnt(2)
  v_pk_add_f32 v[192:193], v[192:193], v[196:197]
  v_pk_add_f32 v[200:201], v[200:201], v[204:205]
  v_pk_add_f32 v[194:195], v[194:195], v[198:199]
  v_pk_add_f32 v[202:203], v[202:203], v[206:207]
  v_pk_add_f32 v[192:193], v[192:193], v[200:201]
  v_pk_add_f32 v[194:195], v[194:195], v[202:203]
  v_cvt_pk_bf16_f32 v26, v192, v193
  v_lshlrev_b32 v192, 16, v26
  v_and_b32 v193, 0xffff0000, v26
  v_mul_f32 v192, v192, v24
  v_mul_f32 v193, v193, v24
  v_cvt_pk_bf16_f32 v26, v192, v193
  v_lshlrev_b32 v192, 16, v26
  v_and_b32 v193, 0xffff0000, v26
  v_add_f32 v192, v192, v16
  v_add_f32 v193, v193, v17
  v_cvt_pk_bf16_f32 v196, v192, v193
  v_cvt_pk_bf16_f32 v26, v194, v195
  v_lshlrev_b32 v194, 16, v26
  v_and_b32 v195, 0xffff0000, v26
  v_mul_f32 v194, v194, v24
  v_mul_f32 v195, v195, v24
  v_cvt_pk_bf16_f32 v26, v194, v195
  v_lshlrev_b32 v194, 16, v26
  v_and_b32 v195, 0xffff0000, v26
  v_add_f32 v194, v194, v18
  v_add_f32 v195, v195, v19
  v_cvt_pk_bf16_f32 v197, v194, v195
  buffer_store_dwordx2 v[196:197], v9, s[8:11], s46 offen offset:64
pvr_319:
pvy_320:
  s_cmp_eq_u32 s65, 0
  s_cbranch_scc1 pvy_321
  s_sub_u32 s65, s65, 1
  s_add_u32 s46, s46, 128
  s_add_u32 s54, s54, 4096
  s_cmp_lt_u32 s40, 32
  s_cselect_b32 s70, 0x80000000, s54
  buffer_load_dwordx4 v[12:15], v4, s[24:27], s70 offen sc1
  buffer_load_dwordx4 v[16:19], v4, s[24:27], s70 offen offset:2048 sc1
  buffer_load_dword v24, v6, s[28:31], s45 offen sc1
  s_waitcnt lgkmcnt(0)
  s_barrier
  s_cmp_eq_u32 s65, 0
  s_cbranch_scc1 pvy_322
  s_add_u32 s41, s41, 1
  s_mul_i32 s53, s42, 40960
  s_lshl_b32 s22, s41, 12
  s_add_u32 s53, s53, s22
  s_mul_i32 s48, s42, 10240
  s_lshl_b32 s22, s41, 10
  s_add_u32 s48, s48, s22
  s_add_u32 s48, s48, 15728640
  s_waitcnt vmcnt(41)
  v_mfma_f32_16x16x32_bf16 v[148:151], a[0:3], v[64:67], 0
  v_mfma_f32_16x16x32_bf16 v[144:147], a[0:3], v[68:71], 0
  v_mfma_f32_16x16x32_bf16 v[156:159], a[4:7], v[64:67], 0
  v_mfma_f32_16x16x32_bf16 v[152:155], a[4:7], v[68:71], 0
  v_mfma_f32_16x16x32_bf16 v[164:167], a[8:11], v[64:67], 0
  v_mfma_f32_16x16x32_bf16 v[160:163], a[8:11], v[68:71], 0
  v_mfma_f32_16x16x32_bf16 v[172:175], a[12:15], v[64:67], 0
  v_mfma_f32_16x16x32_bf16 v[168:171], a[12:15], v[68:71], 0
  buffer_load_dwordx4 a[0:3], v4, s[12:15], s53 offen offset:0 sc1
  buffer_load_dwordx4 a[4:7], v4, s[12:15], s53 offen offset:1024 sc1
  buffer_load_dwordx4 a[8:11], v4, s[12:15], s53 offen offset:2048 sc1
  buffer_load_dwordx4 a[12:15], v4, s[12:15], s53 offen offset:3072 sc1
  s_waitcnt vmcnt(41)
  v_mfma_f32_16x16x32_bf16 v[148:151], a[16:19], v[72:75], v[148:151]
  v_mfma_f32_16x16x32_bf16 v[144:147], a[16:19], v[76:79], v[144:147]
  v_mfma_f32_16x16x32_bf16 v[156:159], a[20:23], v[72:75], v[156:159]
  v_mfma_f32_16x16x32_bf16 v[152:155], a[20:23], v[76:79], v[152:155]
  v_mfma_f32_16x16x32_bf16 v[164:167], a[24:27], v[72:75], v[164:167]
  v_mfma_f32_16x16x32_bf16 v[160:163], a[24:27], v[76:79], v[160:163]
  v_mfma_f32_16x16x32_bf16 v[172:175], a[28:31], v[72:75], v[172:175]
  v_mfma_f32_16x16x32_bf16 v[168:171], a[28:31], v[76:79], v[168:171]
  s_add_u32 s53, s53, 40960
  buffer_load_dwordx4 a[16:19], v4, s[12:15], s53 offen offset:0 sc1
  buffer_load_dwordx4 a[20:23], v4, s[12:15], s53 offen offset:1024 sc1
  buffer_load_dwordx4 a[24:27], v4, s[12:15], s53 offen offset:2048 sc1
  buffer_load_dwordx4 a[28:31], v4, s[12:15], s53 offen offset:3072 sc1
  s_waitcnt vmcnt(41)
  v_mfma_f32_16x16x32_bf16 v[148:151], a[32:35], v[80:83], v[148:151]
  v_mfma_f32_16x16x32_bf16 v[144:147], a[32:35], v[84:87], v[144:147]
  v_mfma_f32_16x16x32_bf16 v[156:159], a[36:39], v[80:83], v[156:159]
  v_mfma_f32_16x16x32_bf16 v[152:155], a[36:39], v[84:87], v[152:155]
  v_mfma_f32_16x16x32_bf16 v[164:167], a[40:43], v[80:83], v[164:167]
  v_mfma_f32_16x16x32_bf16 v[160:163], a[40:43], v[84:87], v[160:163]
  v_mfma_f32_16x16x32_bf16 v[172:175], a[44:47], v[80:83], v[172:175]
  v_mfma_f32_16x16x32_bf16 v[168:171], a[44:47], v[84:87], v[168:171]
  s_add_u32 s53, s53, 40960
  buffer_load_dwordx4 a[32:35], v4, s[12:15], s53 offen offset:0 sc1
  buffer_load_dwordx4 a[36:39], v4, s[12:15], s53 offen offset:1024 sc1
  buffer_load_dwordx4 a[40:43], v4, s[12:15], s53 offen offset:2048 sc1
  buffer_load_dwordx4 a[44:47], v4, s[12:15], s53 offen offset:3072 sc1
  s_waitcnt vmcnt(41)
  v_mfma_f32_16x16x32_bf16 v[148:151], a[48:51], v[88:91], v[148:151]
  v_mfma_f32_16x16x32_bf16 v[144:147], a[48:51], v[92:95], v[144:147]
  v_mfma_f32_16x16x32_bf16 v[156:159], a[52:55], v[88:91], v[156:159]
  v_mfma_f32_16x16x32_bf16 v[152:155], a[52:55], v[92:95], v[152:155]
  v_mfma_f32_16x16x32_bf16 v[164:167], a[56:59], v[88:91], v[164:167]
  v_mfma_f32_16x16x32_bf16 v[160:163], a[56:59], v[92:95], v[160:163]
  v_mfma_f32_16x16x32_bf16 v[172:175], a[60:63], v[88:91], v[172:175]
  v_mfma_f32_16x16x32_bf16 v[168:171], a[60:63], v[92:95], v[168:171]
  s_add_u32 s53, s53, 40960
  buffer_load_dwordx4 a[48:51], v4, s[12:15], s53 offen offset:0 sc1
  buffer_load_dwordx4 a[52:55], v4, s[12:15], s53 offen offset:1024 sc1
  buffer_load_dwordx4 a[56:59], v4, s[12:15], s53 offen offset:2048 sc1
  buffer_load_dwordx4 a[60:63], v4, s[12:15], s53 offen offset:3072 sc1
  s_waitcnt vmcnt(41)
  v_mfma_f32_16x16x32_bf16 v[144:147], v[32:35], v[128:131], v[144:147]
  v_mfma_f32_16x16x32_bf16 v[148:151], v[32:35], v[132:135], v[148:151]
  v_mfma_f32_16x16x32_bf16 v[152:155], v[36:39], v[128:131], v[152:155]
  v_mfma_f32_16x16x32_bf16 v[156:159], v[36:39], v[132:135], v[156:159]
  v_mfma_f32_16x16x32_bf16 v[160:163], v[40:43], v[128:131], v[160:163]
  v_mfma_f32_16x16x32_bf16 v[164:167], v[40:43], v[132:135], v[164:167]
  v_mfma_f32_16x16x32_bf16 v[168:171], v[44:47], v[128:131], v[168:171]
  v_mfma_f32_16x16x32_bf16 v[172:175], v[44:47], v[132:135], v[172:175]
  buffer_load_dwordx4 v[32:35], v22, s[16:19], s48 offen offset:0 sc1
  buffer_load_dwordx4 v[36:39], v22, s[16:19], s48 offen offset:256 sc1
  buffer_load_dwordx4 v[40:43], v22, s[16:19], s48 offen offset:512 sc1
  buffer_load_dwordx4 v[44:47], v22, s[16:19], s48 offen offset:768 sc1
  s_add_u32 s48, s48, 40960
  s_waitcnt vmcnt(41)
  v_mfma_f32_16x16x32_bf16 v[148:151], a[64:67], v[96:99], v[148:151]
  v_mfma_f32_16x16x32_bf16 v[144:147], a[64:67], v[100:103], v[144:147]
  v_mfma_f32_16x16x32_bf16 v[156:159], a[68:71], v[96:99], v[156:159]
  v_mfma_f32_16x16x32_bf16 v[152:155], a[68:71], v[100:103], v[152:155]
  v_mfma_f32_16x16x32_bf16 v[164:167], a[72:75], v[96:99], v[164:167]
  v_mfma_f32_16x16x32_bf16 v[160:163], a[72:75], v[100:103], v[160:163]
  v_mfma_f32_16x16x32_bf16 v[172:175], a[76:79], v[96:99], v[172:175]
  v_mfma_f32_16x16x32_bf16 v[168:171], a[76:79], v[100:103], v[168:171]
  s_add_u32 s53, s53, 40960
  buffer_load_dwordx4 a[64:67], v4, s[12:15], s53 offen offset:0 sc1
  buffer_load_dwordx4 a[68:71], v4, s[12:15], s53 offen offset:1024 sc1
  buffer_load_dwordx4 a[72:75], v4, s[12:15], s53 offen offset:2048 sc1
  buffer_load_dwordx4 a[76:79], v4, s[12:15], s53 offen offset:3072 sc1
  s_waitcnt vmcnt(41)
  v_mfma_f32_16x16x32_bf16 v[148:151], a[80:83], v[104:107], v[148:151]
  v_mfma_f32_16x16x32_bf16 v[144:147], a[80:83], v[108:111], v[144:147]
  v_mfma_f32_16x16x32_bf16 v[156:159], a[84:87], v[104:107], v[156:159]
  v_mfma_f32_16x16x32_bf16 v[152:155], a[84:87], v[108:111], v[152:155]
  v_mfma_f32_16x16x32_bf16 v[164:167], a[88:91], v[104:107], v[164:167]
  v_mfma_f32_16x16x32_bf16 v[160:163], a[88:91], v[108:111], v[160:163]
  v_mfma_f32_16x16x32_bf16 v[172:175], a[92:95], v[104:107], v[172:175]
  v_mfma_f32_16x16x32_bf16 v[168:171], a[92:95], v[108:111], v[168:171]
  s_add_u32 s53, s53, 40960
  buffer_load_dwordx4 a[80:83], v4, s[12:15], s53 offen offset:0 sc1
  buffer_load_dwordx4 a[84:87], v4, s[12:15], s53 offen offset:1024 sc1
  buffer_load_dwordx4 a[88:91], v4, s[12:15], s53 offen offset:2048 sc1
  buffer_load_dwordx4 a[92:95], v4, s[12:15], s53 offen offset:3072 sc1
  s_waitcnt vmcnt(41)
  v_mfma_f32_16x16x32_bf16 v[148:151], a[96:99], v[112:115], v[148:151]
  v_mfma_f32_16x16x32_bf16 v[144:147], a[96:99], v[116:119], v[144:147]
  v_mfma_f32_16x16x32_bf16 v[156:159], a[100:103], v[112:115], v[156:159]
  v_mfma_f32_16x16x32_bf16 v[152:155], a[100:103], v[116:119], v[152:155]
  v_mfma_f32_16x16x32_bf16 v[164:167], a[104:107], v[112:115], v[164:167]
  v_mfma_f32_16x16x32_bf16 v[160:163], a[104:107], v[116:119], v[160:163]
  v_mfma_f32_16x16x32_bf16 v[172:175], a[108:111], v[112:115], v[172:175]
  v_mfma_f32_16x16x32_bf16 v[168:171], a[108:111], v[116:119], v[168:171]
  s_add_u32 s53, s53, 40960
  buffer_load_dwordx4 a[96:99], v4, s[12:15], s53 offen offset:0 sc1
  buffer_load_dwordx4 a[100:103], v4, s[12:15], s53 offen offset:1024 sc1
  buffer_load_dwordx4 a[104:107], v4, s[12:15], s53 offen offset:2048 sc1
  buffer_load_dwordx4 a[108:111], v4, s[12:15], s53 offen offset:3072 sc1
  s_waitcnt vmcnt(41)
  v_mfma_f32_16x16x32_bf16 v[148:151], a[112:115], v[120:123], v[148:151]
  v_mfma_f32_16x16x32_bf16 v[144:147], a[112:115], v[124:127], v[144:147]
  v_mfma_f32_16x16x32_bf16 v[156:159], a[116:119], v[120:123], v[156:159]
  v_mfma_f32_16x16x32_bf16 v[152:155], a[116:119], v[124:127], v[152:155]
  v_mfma_f32_16x16x32_bf16 v[164:167], a[120:123], v[120:123], v[164:167]
  v_mfma_f32_16x16x32_bf16 v[160:163], a[120:123], v[124:127], v[160:163]
  v_mfma_f32_16x16x32_bf16 v[172:175], a[124:127], v[120:123], v[172:175]
  v_mfma_f32_16x16x32_bf16 v[168:171], a[124:127], v[124:127], v[168:171]
  s_add_u32 s53, s53, 40960
  buffer_load_dwordx4 a[112:115], v4, s[12:15], s53 offen offset:0 sc1
  buffer_load_dwordx4 a[116:119], v4, s[12:15], s53 offen offset:1024 sc1
  buffer_load_dwordx4 a[120:123], v4, s[12:15], s53 offen offset:2048 sc1
  buffer_load_dwordx4 a[124:127], v4, s[12:15], s53 offen offset:3072 sc1
  s_waitcnt vmcnt(41)
  v_mfma_f32_16x16x32_bf16 v[144:147], v[48:51], v[136:139], v[144:147]
  v_mfma_f32_16x16x32_bf16 v[148:151], v[48:51], v[140:143], v[148:151]
  v_mfma_f32_16x16x32_bf16 v[152:155], v[52:55], v[136:139], v[152:155]
  v_mfma_f32_16x16x32_bf16 v[156:159], v[52:55], v[140:143], v[156:159]
  v_mfma_f32_16x16x32_bf16 v[160:163], v[56:59], v[136:139], v[160:163]
  v_mfma_f32_16x16x32_bf16 v[164:167], v[56:59], v[140:143], v[164:167]
  v_mfma_f32_16x16x32_bf16 v[168:171], v[60:63], v[136:139], v[168:171]
  v_mfma_f32_16x16x32_bf16 v[172:175], v[60:63], v[140:143], v[172:175]
  buffer_load_dwordx4 v[48:51], v22, s[16:19], s48 offen offset:0 sc1
  buffer_load_dwordx4 v[52:55], v22, s[16:19], s48 offen offset:256 sc1
  buffer_load_dwordx4 v[56:59], v22, s[16:19], s48 offen offset:512 sc1
  buffer_load_dwordx4 v[60:63], v22, s[16:19], s48 offen offset:768 sc1
  s_add_u32 s48, s48, 40960
  s_waitcnt vmcnt(40)
  s_branch pvy_323
pvy_322:
  s_waitcnt vmcnt(41)
  v_mfma_f32_16x16x32_bf16 v[148:151], a[0:3], v[64:67], 0
  v_mfma_f32_16x16x32_bf16 v[144:147], a[0:3], v[68:71], 0
  v_mfma_f32_16x16x32_bf16 v[156:159], a[4:7], v[64:67], 0
  v_mfma_f32_16x16x32_bf16 v[152:155], a[4:7], v[68:71], 0
  v_mfma_f32_16x16x32_bf16 v[164:167], a[8:11], v[64:67], 0
  v_mfma_f32_16x16x32_bf16 v[160:163], a[8:11], v[68:71], 0
  v_mfma_f32_16x16x32_bf16 v[172:175], a[12:15], v[64:67], 0
  v_mfma_f32_16x16x32_bf16 v[168:171], a[12:15], v[68:71], 0
  s_waitcnt vmcnt(37)
  v_mfma_f32_16x16x32_bf16 v[148:151], a[16:19], v[72:75], v[148:151]
  v_mfma_f32_16x16x32_bf16 v[144:147], a[16:19], v[76:79], v[144:147]
  v_mfma_f32_16x16x32_bf16 v[156:159], a[20:23], v[72:75], v[156:159]
  v_mfma_f32_16x16x32_bf16 v[152:155], a[20:23], v[76:79], v[152:155]
  v_mfma_f32_16x16x32_bf16 v[164:167], a[24:27], v[72:75], v[164:167]
  v_mfma_f32_16x16x32_bf16 v[160:163], a[24:27], v[76:79], v[160:163]
  v_mfma_f32_16x16x32_bf16 v[172:175], a[28:31], v[72:75], v[172:175]
  v_mfma_f32_16x16x32_bf16 v[168:171], a[28:31], v[76:79], v[168:171]
  s_waitcnt vmcnt(33)
  v_mfma_f32_16x16x32_bf16 v[148:151], a[32:35], v[80:83], v[148:151]
  v_mfma_f32_16x16x32_bf16 v[144:147], a[32:35], v[84:87], v[144:147]
  v_mfma_f32_16x16x32_bf16 v[156:159], a[36:39], v[80:83], v[156:159]
  v_mfma_f32_16x16x32_bf16 v[152:155], a[36:39], v[84:87], v[152:155]
  v_mfma_f32_16x16x32_bf16 v[164:167], a[40:43], v[80:83], v[164:167]
  v_mfma_f32_16x16x32_bf16 v[160:163], a[40:43], v[84:87], v[160:163]
  v_mfma_f32_16x16x32_bf16 v[172:175], a[44:47], v[80:83], v[172:175]
  v_mfma_f32_16x16x32_bf16 v[168:171], a[44:47], v[84:87], v[168:171]
  s_waitcnt vmcnt(29)
  v_mfma_f32_16x16x32_bf16 v[148:151], a[48:51], v[88:91], v[148:151]
  v_mfma_f32_16x16x32_bf16 v[144:147], a[48:51], v[92:95], v[144:147]
  v_mfma_f32_16x16x32_bf16 v[156:159], a[52:55], v[88:91], v[156:159]
  v_mfma_f32_16x16x32_bf16 v[152:155], a[52:55], v[92:95], v[152:155]
  v_mfma_f32_16x16x32_bf16 v[164:167], a[56:59], v[88:91], v[164:167]
  v_mfma_f32_16x16x32_bf16 v[160:163], a[56:59], v[92:95], v[160:163]
  v_mfma_f32_16x16x32_bf16 v[172:175], a[60:63], v[88:91], v[172:175]
  v_mfma_f32_16x16x32_bf16 v[168:171], a[60:63], v[92:95], v[168:171]
  s_waitcnt vmcnt(25)
  v_mfma_f32_16x16x32_bf16 v[144:147], v[32:35], v[128:131], v[144:147]
  v_mfma_f32_16x16x32_bf16 v[148:151], v[32:35], v[132:135], v[148:151]
  v_mfma_f32_16x16x32_bf16 v[152:155], v[36:39], v[128:131], v[152:155]
  v_mfma_f32_16x16x32_bf16 v[156:159], v[36:39], v[132:135], v[156:159]
  v_mfma_f32_16x16x32_bf16 v[160:163], v[40:43], v[128:131], v[160:163]
  v_mfma_f32_16x16x32_bf16 v[164:167], v[40:43], v[132:135], v[164:167]
  v_mfma_f32_16x16x32_bf16 v[168:171], v[44:47], v[128:131], v[168:171]
  v_mfma_f32_16x16x32_bf16 v[172:175], v[44:47], v[132:135], v[172:175]
  s_waitcnt vmcnt(21)
  v_mfma_f32_16x16x32_bf16 v[148:151], a[64:67], v[96:99], v[148:151]
  v_mfma_f32_16x16x32_bf16 v[144:147], a[64:67], v[100:103], v[144:147]
  v_mfma_f32_16x16x32_bf16 v[156:159], a[68:71], v[96:99], v[156:159]
  v_mfma_f32_16x16x32_bf16 v[152:155], a[68:71], v[100:103], v[152:155]
  v_mfma_f32_16x16x32_bf16 v[164:167], a[72:75], v[96:99], v[164:167]
  v_mfma_f32_16x16x32_bf16 v[160:163], a[72:75], v[100:103], v[160:163]
  v_mfma_f32_16x16x32_bf16 v[172:175], a[76:79], v[96:99], v[172:175]
  v_mfma_f32_16x16x32_bf16 v[168:171], a[76:79], v[100:103], v[168:171]
  s_waitcnt vmcnt(17)
  v_mfma_f32_16x16x32_bf16 v[148:151], a[80:83], v[104:107], v[148:151]
  v_mfma_f32_16x16x32_bf16 v[144:147], a[80:83], v[108:111], v[144:147]
  v_mfma_f32_16x16x32_bf16 v[156:159], a[84:87], v[104:107], v[156:159]
  v_mfma_f32_16x16x32_bf16 v[152:155], a[84:87], v[108:111], v[152:155]
  v_mfma_f32_16x16x32_bf16 v[164:167], a[88:91], v[104:107], v[164:167]
  v_mfma_f32_16x16x32_bf16 v[160:163], a[88:91], v[108:111], v[160:163]
  v_mfma_f32_16x16x32_bf16 v[172:175], a[92:95], v[104:107], v[172:175]
  v_mfma_f32_16x16x32_bf16 v[168:171], a[92:95], v[108:111], v[168:171]
  s_waitcnt vmcnt(13)
  v_mfma_f32_16x16x32_bf16 v[148:151], a[96:99], v[112:115], v[148:151]
  v_mfma_f32_16x16x32_bf16 v[144:147], a[96:99], v[116:119], v[144:147]
  v_mfma_f32_16x16x32_bf16 v[156:159], a[100:103], v[112:115], v[156:159]
  v_mfma_f32_16x16x32_bf16 v[152:155], a[100:103], v[116:119], v[152:155]
  v_mfma_f32_16x16x32_bf16 v[164:167], a[104:107], v[112:115], v[164:167]
  v_mfma_f32_16x16x32_bf16 v[160:163], a[104:107], v[116:119], v[160:163]
  v_mfma_f32_16x16x32_bf16 v[172:175], a[108:111], v[112:115], v[172:175]
  v_mfma_f32_16x16x32_bf16 v[168:171], a[108:111], v[116:119], v[168:171]
  s_waitcnt vmcnt(9)
  v_mfma_f32_16x16x32_bf16 v[148:151], a[112:115], v[120:123], v[148:151]
  v_mfma_f32_16x16x32_bf16 v[144:147], a[112:115], v[124:127], v[144:147]
  v_mfma_f32_16x16x32_bf16 v[156:159], a[116:119], v[120:123], v[156:159]
  v_mfma_f32_16x16x32_bf16 v[152:155], a[116:119], v[124:127], v[152:155]
  v_mfma_f32_16x16x32_bf16 v[164:167], a[120:123], v[120:123], v[164:167]
  v_mfma_f32_16x16x32_bf16 v[160:163], a[120:123], v[124:127], v[160:163]
  v_mfma_f32_16x16x32_bf16 v[172:175], a[124:127], v[120:123], v[172:175]
  v_mfma_f32_16x16x32_bf16 v[168:171], a[124:127], v[124:127], v[168:171]
  s_waitcnt vmcnt(5)
  v_mfma_f32_16x16x32_bf16 v[144:147], v[48:51], v[136:139], v[144:147]
  v_mfma_f32_16x16x32_bf16 v[148:151], v[48:51], v[140:143], v[148:151]
  v_mfma_f32_16x16x32_bf16 v[152:155], v[52:55], v[136:139], v[152:155]
  v_mfma_f32_16x16x32_bf16 v[156:159], v[52:55], v[140:143], v[156:159]
  v_mfma_f32_16x16x32_bf16 v[160:163], v[56:59], v[136:139], v[160:163]
  v_mfma_f32_16x16x32_bf16 v[164:167], v[56:59], v[140:143], v[164:167]
  v_mfma_f32_16x16x32_bf16 v[168:171], v[60:63], v[136:139], v[168:171]
  v_mfma_f32_16x16x32_bf16 v[172:175], v[60:63], v[140:143], v[172:175]
  s_waitcnt vmcnt(0)
pvy_323:
  v_sub_f32 v25, 1.0, v24
  v_cvt_pk_bf16_f32 v26, v25, v25
  v_lshlrev_b32 v25, 16, v26
  v_cvt_pk_bf16_f32 v26, v12, v12
  v_lshlrev_b32 v12, 16, v26
  v_cvt_pk_bf16_f32 v26, v13, v13
  v_lshlrev_b32 v13, 16, v26
  v_cvt_pk_bf16_f32 v26, v14, v14
  v_lshlrev_b32 v14, 16, v26
  v_cvt_pk_bf16_f32 v26, v15, v15
  v_lshlrev_b32 v15, 16, v26
  v_cvt_pk_bf16_f32 v26, v16, v16
  v_lshlrev_b32 v16, 16, v26
  v_cvt_pk_bf16_f32 v26, v17, v17
  v_lshlrev_b32 v17, 16, v26
  v_cvt_pk_bf16_f32 v26, v18, v18
  v_lshlrev_b32 v18, 16, v26
  v_cvt_pk_bf16_f32 v26, v19, v19
  v_lshlrev_b32 v19, 16, v26
  v_mul_f32 v12, v12, v25
  v_cvt_pk_bf16_f32 v26, v12, v12
  v_lshlrev_b32 v12, 16, v26
  v_mul_f32 v13, v13, v25
  v_cvt_pk_bf16_f32 v26, v13, v13
  v_lshlrev_b32 v13, 16, v26
  v_mul_f32 v14, v14, v25
  v_cvt_pk_bf16_f32 v26, v14, v14
  v_lshlrev_b32 v14, 16, v26
  v_mul_f32 v15, v15, v25
  v_cvt_pk_bf16_f32 v26, v15, v15
  v_lshlrev_b32 v15, 16, v26
  v_mul_f32 v16, v16, v25
  v_cvt_pk_bf16_f32 v26, v16, v16
  v_lshlrev_b32 v16, 16, v26
  v_mul_f32 v17, v17, v25
  v_cvt_pk_bf16_f32 v26, v17, v17
  v_lshlrev_b32 v17, 16, v26
  v_mul_f32 v18, v18, v25
  v_cvt_pk_bf16_f32 v26, v18, v18
  v_lshlrev_b32 v18, 16, v26
  v_mul_f32 v19, v19, v25
  v_cvt_pk_bf16_f32 v26, v19, v19
  v_lshlrev_b32 v19, 16, v26
  ds_write_b128 v10, v[144:147] offset:0
  ds_write_b128 v10, v[148:151] offset:1024
  ds_write_b128 v10, v[152:155] offset:2048
  ds_write_b128 v10, v[156:159] offset:3072
  ds_write_b128 v10, v[160:163] offset:4096
  ds_write_b128 v10, v[164:167] offset:5120
  ds_write_b128 v10, v[168:171] offset:6144
  ds_write_b128 v10, v[172:175] offset:7168
  s_waitcnt lgkmcnt(0)
  s_barrier
  ds_read_b128 v[176:179], v11 offset:0
  ds_read_b128 v[180:183], v11 offset:8192
  ds_read_b128 v[184:187], v11 offset:16384
  ds_read_b128 v[188:191], v11 offset:24576
  ds_read_b128 v[192:195], v11 offset:4096
  ds_read_b128 v[196:199], v11 offset:12288
  ds_read_b128 v[200:203], v11 offset:20480
  ds_read_b128 v[204:207], v11 offset:28672
  s_cmp_ge_u32 s40, 32
  s_cbranch_scc1 pvr_324
  s_waitcnt lgkmcnt(4)
  v_pk_add_f32 v[176:177], v[176:177], v[180:181]
  v_pk_add_f32 v[184:185], v[184:185], v[188:189]
  v_pk_add_f32 v[178:179], v[178:179], v[182:183]
  v_pk_add_f32 v[186:187], v[186:187], v[190:191]
  v_pk_add_f32 v[176:177], v[176:177], v[184:185]
  v_pk_add_f32 v[178:179], v[178:179], v[186:187]
  buffer_store_dwordx4 v[176:179], v4, s[24:27], s54 offen offset:0 sc1
  s_waitcnt lgkmcnt(0)
  v_pk_add_f32 v[192:193], v[192:193], v[196:197]
  v_pk_add_f32 v[200:201], v[200:201], v[204:205]
  v_pk_add_f32 v[194:195], v[194:195], v[198:199]
  v_pk_add_f32 v[202:203], v[202:203], v[206:207]
  v_pk_add_f32 v[192:193], v[192:193], v[200:201]
  v_pk_add_f32 v[194:195], v[194:195], v[202:203]
  buffer_store_dwordx4 v[192:195], v4, s[24:27], s54 offen offset:2048 sc1
  s_lshr_b32 s71, s40, 2
  s_lshl_b32 s71, s71, 7
  s_add_u32 s71, s71, 104448
  s_branch pvr_325
pvr_324:
  s_waitcnt lgkmcnt(4)
  v_pk_add_f32 v[176:177], v[176:177], v[180:181]
  v_pk_add_f32 v[184:185], v[184:185], v[188:189]
  v_pk_add_f32 v[178:179], v[178:179], v[182:183]
  v_pk_add_f32 v[186:187], v[186:187], v[190:191]
  v_pk_add_f32 v[176:177], v[176:177], v[184:185]
  v_pk_add_f32 v[178:179], v[178:179], v[186:187]
  v_cvt_pk_bf16_f32 v26, v176, v177
  v_lshlrev_b32 v176, 16, v26
  v_and_b32 v177, 0xffff0000, v26
  v_mul_f32 v176, v176, v24
  v_mul_f32 v177, v177, v24
  v_cvt_pk_bf16_f32 v26, v176, v177
  v_lshlrev_b32 v176, 16, v26
  v_and_b32 v177, 0xffff0000, v26
  v_add_f32 v176, v176, v12
  v_add_f32 v177, v177, v13
  v_cvt_pk_bf16_f32 v180, v176, v177
  v_cvt_pk_bf16_f32 v26, v178, v179
  v_lshlrev_b32 v178, 16, v26
  v_and_b32 v179, 0xffff0000, v26
  v_mul_f32 v178, v178, v24
  v_mul_f32 v179, v179, v24
  v_cvt_pk_bf16_f32 v26, v178, v179
  v_lshlrev_b32 v178, 16, v26
  v_and_b32 v179, 0xffff0000, v26
  v_add_f32 v178, v178, v14
  v_add_f32 v179, v179, v15
  v_cvt_pk_bf16_f32 v181, v178, v179
  buffer_store_dwordx2 v[180:181], v9, s[8:11], s46 offen offset:0
  s_waitcnt lgkmcnt(0)
  v_pk_add_f32 v[192:193], v[192:193], v[196:197]
  v_pk_add_f32 v[200:201], v[200:201], v[204:205]
  v_pk_add_f32 v[194:195], v[194:195], v[198:199]
  v_pk_add_f32 v[202:203], v[202:203], v[206:207]
  v_pk_add_f32 v[192:193], v[192:193], v[200:201]
  v_pk_add_f32 v[194:195], v[194:195], v[202:203]
  v_cvt_pk_bf16_f32 v26, v192, v193
  v_lshlrev_b32 v192, 16, v26
  v_and_b32 v193, 0xffff0000, v26
  v_mul_f32 v192, v192, v24
  v_mul_f32 v193, v193, v24
  v_cvt_pk_bf16_f32 v26, v192, v193
  v_lshlrev_b32 v192, 16, v26
  v_and_b32 v193, 0xffff0000, v26
  v_add_f32 v192, v192, v16
  v_add_f32 v193, v193, v17
  v_cvt_pk_bf16_f32 v196, v192, v193
  v_cvt_pk_bf16_f32 v26, v194, v195
  v_lshlrev_b32 v194, 16, v26
  v_and_b32 v195, 0xffff0000, v26
  v_mul_f32 v194, v194, v24
  v_mul_f32 v195, v195, v24
  v_cvt_pk_bf16_f32 v26, v194, v195
  v_lshlrev_b32 v194, 16, v26
  v_and_b32 v195, 0xffff0000, v26
  v_add_f32 v194, v194, v18
  v_add_f32 v195, v195, v19
  v_cvt_pk_bf16_f32 v197, v194, v195
  buffer_store_dwordx2 v[196:197], v9, s[8:11], s46 offen offset:64
pvr_325:
  s_branch pvy_320
pvy_321:
  s_sub_u32 s21, s2, 0
  s_cmp_ge_u32 s21, 640
  s_cbranch_scc1 lc_326
  s_cmp_lg_u32 s20, 0
  s_cbranch_scc1 lc_326x
  s_waitcnt vmcnt(2)
  s_mov_b64 exec, 1
  ds_write_b32 v30, v29 offset:12
  s_mov_b64 exec, -1
lc_326x:
  s_waitcnt lgkmcnt(0)
  s_barrier
  ds_read_b32 v23, v30 offset:12
lc_326:
  s_waitcnt lgkmcnt(0)
  v_readfirstlane_b32 s2, v23
  v_readfirstlane_b32 s67, v213
  s_barrier
  s_cmp_lt_u32 s2, 236
  s_cbranch_scc1 pae_327
  s_waitcnt vmcnt(0)
  s_cmp_eq_u32 s71, 0
  s_cbranch_scc1 paf_328
  v_mov_b32 v25, 0
  v_mov_b32 v26, 1
  s_mov_b64 exec, 1
  buffer_atomic_add v26, v25, s[72:75], s71 offen sc1
  s_mov_b64 exec, -1
  s_mov_b32 s71, 0
paf_328:
pae_327:
  s_add_u32 s21, s2, 0
  s_cmp_lt_u32 s2, 144
  s_cbranch_scc1 pv_loop
  s_sub_u32 s2, s2, 144
  s_add_u32 s21, s2, 164
  s_cmp_lt_u32 s2, 40
  s_cbranch_scc1 pv_loop
  s_sub_u32 s2, s2, 40
  s_add_u32 s21, s2, 144
  s_cmp_lt_u32 s2, 20
  s_cbranch_scc1 pv_loop
  s_sub_u32 s2, s2, 20
  s_add_u32 s21, s2, 204
  s_cmp_lt_u32 s2, 32
  s_cbranch_scc1 pv_loop
  s_sub_u32 s2, s2, 32
  s_branch main_fin
  s_branch queue
main_fin:
  s_waitcnt vmcnt(0)
main_end:
  s_endpgm
code_end:
.section .rodata,"a"
.p2align 6
.amdhsa_kernel gated_mix__memory_aug_recurrent_mem_tr__sliding_local_dilated__prompt_kernel
  .amdhsa_next_free_vgpr 512
  .amdhsa_next_free_sgpr 102
  .amdhsa_accum_offset 256
  .amdhsa_group_segment_fixed_size 0
  .amdhsa_kernarg_size 112
  .amdhsa_user_sgpr_count 2
  .amdhsa_user_sgpr_kernarg_segment_ptr 1
  .amdhsa_system_sgpr_workgroup_id_x 1
.end_amdhsa_kernel
.text
```

```asm
; @launch kernel=gated_mix__memory_aug_recurrent_mem_tr__sliding_local_dilated__prompt_kernel grid=(256,1,1) block=(256,1,1) lds=163840
.amdgcn_target "amdgcn-amd-amdhsa--gfx950"
.text
.globl gated_mix__memory_aug_recurrent_mem_tr__sliding_local_dilated__prompt_kernel
.p2align 8
.type gated_mix__memory_aug_recurrent_mem_tr__sliding_local_dilated__prompt_kernel,@function
gated_mix__memory_aug_recurrent_mem_tr__sliding_local_dilated__prompt_kernel:
 s_cmp_ge_u32 s2, 256
 s_cbranch_scc1 end0
 s_load_dwordx2 s[4:5], s[0:1], 96
 s_load_dwordx2 s[38:39], s[0:1], 104
 v_lshrrev_b32 v1, 6, v0
 v_and_b32 v2, 15, v0
 v_readfirstlane_b32 s20, v1
 v_and_b32 v1, 63, v0
 v_lshrrev_b32 v3, 4, v1
 s_getreg_b32 s50, hwreg(HW_REG_XCC_ID)
 s_and_b32 s50, s50, 7
 s_waitcnt lgkmcnt(0)
 s_mov_b32 s32, s4
 s_mov_b32 s33, s5
 s_mov_b32 s34, 256
 s_mov_b32 s35, 0x00020000
 s_getpc_b64 s[6:7]
cpf_pc:
 s_sub_u32 s6, s6, cpf_pc - gated_mix__memory_aug_recurrent_mem_tr__sliding_local_dilated__prompt_kernel
 s_subb_u32 s7, s7, 0
 s_lshr_b32 s21, s2, 3
 s_lshl_b32 s21, s21, 12
 v_lshl_add_u32 v28, v0, 4, s21
 v_min_u32 v28, code_end - gated_mix__memory_aug_recurrent_mem_tr__sliding_local_dilated__prompt_kernel - 16, v28
 global_load_dwordx4 a[252:255], v28, s[6:7]
 v_lshl_add_u32 v28, v0, 4, s21
 v_add_u32 v28, 0x20000, v28
 v_min_u32 v28, code_end - gated_mix__memory_aug_recurrent_mem_tr__sliding_local_dilated__prompt_kernel - 16, v28
 global_load_dwordx4 a[252:255], v28, s[6:7]
 v_mov_b32 v21, 0
 s_cmp_lg_u32 s20, 0
 s_cbranch_scc1 rk_1
 s_and_b32 s21, s50, 1
 s_lshl_b32 s21, s21, 7
 s_lshl_b32 s22, s50, 1
 s_and_b32 s22, s22, 12
 s_add_u32 s21, s21, s22
 v_mov_b32 v22, s21
 v_mov_b32 v23, 1
 s_mov_b64 exec, 1
 buffer_atomic_add v23, v22, s[32:35], 0 offen sc0 sc1
 s_waitcnt vmcnt(0)
 v_readfirstlane_b32 s51, v23
 s_lshl_b32 s22, s50, 5
 s_add_u32 s22, s22, s51
 s_cmp_lt_u32 s51, 32
 s_cbranch_scc1 rk_2
 v_mov_b32 v24, 72
 v_mov_b32 v25, 1
 buffer_atomic_add v25, v24, s[32:35], 0 offen sc0 sc1
 s_waitcnt vmcnt(0)
 v_readfirstlane_b32 s23, v25
 s_mov_b32 s101, 0
 s_mov_b64 exec, -1
 v_lshlrev_b32 v24, 2, v1
rk_3:
 s_sleep 8
 buffer_load_dword v25, v24, s[32:35], 0 offen sc1
 s_add_u32 s101, s101, 1
 s_cmp_gt_u32 s101, 131072
 s_cbranch_scc1 end0
 s_waitcnt vmcnt(0)
 v_readlane_b32 s21, v25, 0
 v_readlane_b32 s22, v25, 32
 s_add_u32 s21, s21, s22
 v_readlane_b32 s22, v25, 1
 s_add_u32 s21, s21, s22
 v_readlane_b32 s22, v25, 33
 s_add_u32 s21, s21, s22
 v_readlane_b32 s22, v25, 2
 s_add_u32 s21, s21, s22
 v_readlane_b32 s22, v25, 34
 s_add_u32 s21, s21, s22
 v_readlane_b32 s22, v25, 3
 s_add_u32 s21, s21, s22
 v_readlane_b32 s22, v25, 35
 s_add_u32 s21, s21, s22
 s_cmp_lt_u32 s21, 256
 s_cbranch_scc1 rk_3
 s_mov_b64 exec, 1
 s_mov_b32 s24, 0
rk_5:
 s_and_b32 s21, s24, 1
 s_lshl_b32 s21, s21, 5
 s_lshr_b32 s22, s24, 1
 s_add_u32 s21, s21, s22
 v_readlane_b32 s21, v25, s21
 s_min_u32 s21, s21, 32
 s_sub_u32 s25, 32, s21
 s_cmp_lt_u32 s23, s25
 s_cbranch_scc1 rk_4
 s_sub_u32 s23, s23, s25
 s_add_u32 s24, s24, 1
 s_cmp_lt_u32 s24, 8
 s_cbranch_scc1 rk_5
 s_branch end0
rk_4:
 s_lshl_b32 s22, s24, 5
 s_add_u32 s22, s22, s21
 s_add_u32 s22, s22, s23
 s_or_b32 s22, s22, 0x100
rk_2:
 v_mov_b32 v23, s22
 ds_write_b32 v21, v23
 s_waitcnt lgkmcnt(0)
 s_mov_b64 exec, -1
rk_1:
 s_barrier
 ds_read_b32 v23, v21
 s_waitcnt lgkmcnt(0)
 v_readfirstlane_b32 s22, v23
 s_barrier
 s_mov_b32 s84, 0
 s_mov_b32 s85, -1
 s_lshr_b32 s53, s22, 8
 s_and_b32 s22, s22, 255
 s_cmp_ge_u32 s22, 128
 s_cbranch_scc1 gemm_side
 s_lshr_b32 s50, s22, 4
 s_and_b32 s51, s22, 15
 s_mov_b32 s86, 0x3dd53b95
 s_load_dwordx2 s[4:5], s[0:1], 8
 s_load_dwordx4 s[36:39], s[0:1], 16
 s_load_dwordx4 s[40:43], s[0:1], 32
 s_load_dwordx2 s[44:45], s[0:1], 104
 s_lshr_b32 s55, s51, 2
 s_and_b32 s56, s51, 3
 s_lshl_b32 s57, s50, 2
 s_add_u32 s58, s57, s55
 s_add_u32 s59, s57, s20
 s_lshr_b32 s21, s51, 1
 s_xor_b32 s21, s21, s55
 s_andn2_b32 s21, 1, s21
 s_xor_b32 s85, s51, s21
 s_mul_i32 s87, s85, 5
 s_lshr_b32 s87, s87, 1
 s_and_b32 s79, s85, 1
 s_waitcnt lgkmcnt(0)
 s_add_u32 s8, s44, 78643200
 s_addc_u32 s9, s45, 0
 s_mov_b32 s10, 2162688
 s_mov_b32 s11, 0x00020000
 s_mov_b32 s16, s44
 s_mov_b32 s17, s45
 s_mov_b32 s18, 50331648
 s_mov_b32 s19, 0x00020000
 s_add_u32 s24, s44, 50331648
 s_addc_u32 s25, s45, 0
 s_mov_b32 s26, 72351744
 s_mov_b32 s27, 0x00020000
 s_mov_b32 s28, s4
 s_mov_b32 s29, s5
 s_mov_b32 s30, 10240
 s_mov_b32 s31, 0x00020000
 s_add_u32 s4, s44, 83886079
 s_addc_u32 s5, s45, 0
 s_and_b32 s4, s4, 0xffe00000
 s_mov_b32 s6, 2097152
 s_mov_b32 s7, 0x00020000
 v_mov_b32 v27, 10923
 v_add_u32 v54, 0, v1
 v_mul_u32_u24 v53, v54, v27
 v_lshrrev_b32 v53, 16, v53
 v_mul_u32_u24 v52, 6, v53
 v_sub_u32 v54, v54, v52
 v_mul_u32_u24 v52, 1280, v53
 v_lshl_add_u32 v46, v54, 4, v52
 v_bfe_u32 v52, v53, 1, 1
 v_mul_u32_u24 v52, 20, v52
 v_and_b32 v51, 1, v53
 v_add_u32 v52, v52, v51
 v_lshrrev_b32 v51, 3, v53
 v_mul_u32_u24 v51, 40, v51
 v_bfe_u32 v50, v53, 2, 1
 v_lshl_add_u32 v51, v50, 1, v51
 v_add_u32 v51, v51, v52
 v_mul_u32_u24 v51, 12288, v51
 v_lshl_add_u32 v247, v54, 4, v51
 v_lshrrev_b32 v51, 4, v53
 v_mul_u32_u24 v51, 40, v51
 v_bfe_u32 v50, v53, 2, 2
 v_lshl_add_u32 v51, v50, 1, v51
 v_add_u32 v51, v51, v52
 v_mul_u32_u24 v51, 12288, v51
 v_lshl_add_u32 v244, v54, 4, v51
 v_add_u32 v54, 64, v1
 v_mul_u32_u24 v53, v54, v27
 v_lshrrev_b32 v53, 16, v53
 v_mul_u32_u24 v52, 6, v53
 v_sub_u32 v54, v54, v52
 v_mul_u32_u24 v52, 1280, v53
 v_lshl_add_u32 v47, v54, 4, v52
 v_bfe_u32 v52, v53, 1, 1
 v_mul_u32_u24 v52, 20, v52
 v_and_b32 v51, 1, v53
 v_add_u32 v52, v52, v51
 v_lshrrev_b32 v51, 3, v53
 v_mul_u32_u24 v51, 40, v51
 v_bfe_u32 v50, v53, 2, 1
 v_lshl_add_u32 v51, v50, 1, v51
 v_add_u32 v51, v51, v52
 v_mul_u32_u24 v51, 12288, v51
 v_lshl_add_u32 v248, v54, 4, v51
 v_lshrrev_b32 v51, 4, v53
 v_mul_u32_u24 v51, 40, v51
 v_bfe_u32 v50, v53, 2, 2
 v_lshl_add_u32 v51, v50, 1, v51
 v_add_u32 v51, v51, v52
 v_mul_u32_u24 v51, 12288, v51
 v_lshl_add_u32 v245, v54, 4, v51
 v_add_u32 v54, 128, v1
 v_mul_u32_u24 v53, v54, v27
 v_lshrrev_b32 v53, 16, v53
 v_mul_u32_u24 v52, 6, v53
 v_sub_u32 v54, v54, v52
 v_mul_u32_u24 v52, 1280, v53
 v_lshl_add_u32 v48, v54, 4, v52
 v_bfe_u32 v52, v53, 1, 1
 v_mul_u32_u24 v52, 20, v52
 v_and_b32 v51, 1, v53
 v_add_u32 v52, v52, v51
 v_lshrrev_b32 v51, 3, v53
 v_mul_u32_u24 v51, 40, v51
 v_bfe_u32 v50, v53, 2, 1
 v_lshl_add_u32 v51, v50, 1, v51
 v_add_u32 v51, v51, v52
 v_mul_u32_u24 v51, 12288, v51
 v_lshl_add_u32 v249, v54, 4, v51
 v_lshrrev_b32 v51, 4, v53
 v_mul_u32_u24 v51, 40, v51
 v_bfe_u32 v50, v53, 2, 2
 v_lshl_add_u32 v51, v50, 1, v51
 v_add_u32 v51, v51, v52
 v_mul_u32_u24 v51, 12288, v51
 v_lshl_add_u32 v246, v54, 4, v51
 s_mul_i32 s80, s58, 384
 s_mul_i32 s22, s56, 96
 s_add_u32 s80, s80, s22
 s_mul_i32 s22, s20, 1966080
 s_add_u32 s80, s80, s22
 s_mul_i32 s81, s20, 40448
 s_mul_i32 s82, s59, 245760
 s_lshl_b32 s22, s87, 5
 s_add_u32 s82, s82, s22
 s_mul_i32 s88, s59, 384
 s_mov_b32 s12, s42
 s_mov_b32 s13, s43
 s_mov_b32 s14, 7864320
 s_mov_b32 s15, 0x00020000
 s_add_u32 s21, s82, 0
 s_add_u32 m0, s81, 12288
 s_nop 0
 buffer_load_dwordx4 v46, s[12:15], s21 offen lds
 s_add_u32 m0, s81, 13312
 s_nop 0
 buffer_load_dwordx4 v47, s[12:15], s21 offen lds
 s_add_u32 m0, s81, 14336
 s_nop 0
 buffer_load_dwordx4 v48, s[12:15], s21 offen lds
 s_add_u32 s21, s82, 40960
 s_add_u32 m0, s81, 15360
 s_nop 0
 buffer_load_dwordx4 v46, s[12:15], s21 offen lds
 s_add_u32 m0, s81, 16384
 s_nop 0
 buffer_load_dwordx4 v47, s[12:15], s21 offen lds
 s_add_u32 m0, s81, 17408
 s_nop 0
 buffer_load_dwordx4 v48, s[12:15], s21 offen lds
 s_add_u32 s21, s82, 81920
 s_add_u32 m0, s81, 18432
 s_nop 0
 buffer_load_dwordx4 v46, s[12:15], s21 offen lds
 s_add_u32 m0, s81, 19456
 s_nop 0
 buffer_load_dwordx4 v47, s[12:15], s21 offen lds
 s_add_u32 m0, s81, 20480
 s_nop 0
 buffer_load_dwordx4 v48, s[12:15], s21 offen lds
 s_add_u32 s21, s82, 122880
 s_add_u32 m0, s81, 21504
 s_nop 0
 buffer_load_dwordx4 v46, s[12:15], s21 offen lds
 s_add_u32 m0, s81, 22528
 s_nop 0
 buffer_load_dwordx4 v47, s[12:15], s21 offen lds
 s_add_u32 m0, s81, 23552
 s_nop 0
 buffer_load_dwordx4 v48, s[12:15], s21 offen lds
 s_add_u32 s21, s82, 163840
 s_add_u32 m0, s81, 24576
 s_nop 0
 buffer_load_dwordx4 v46, s[12:15], s21 offen lds
 s_add_u32 m0, s81, 25600
 s_nop 0
 buffer_load_dwordx4 v47, s[12:15], s21 offen lds
 s_add_u32 m0, s81, 26624
 s_nop 0
 buffer_load_dwordx4 v48, s[12:15], s21 offen lds
 s_add_u32 s21, s82, 204800
 s_add_u32 m0, s81, 27648
 s_nop 0
 buffer_load_dwordx4 v46, s[12:15], s21 offen lds
 s_add_u32 m0, s81, 28672
 s_nop 0
 buffer_load_dwordx4 v47, s[12:15], s21 offen lds
 s_add_u32 m0, s81, 29696
 s_nop 0
 buffer_load_dwordx4 v48, s[12:15], s21 offen lds
 s_mov_b32 s12, s40
 s_mov_b32 s13, s41
 s_mov_b32 s14, 7864320
 s_mov_b32 s15, 0x00020000
 s_mov_b32 s40, s38
 s_mov_b32 s41, s39
 s_mov_b32 s38, 7864320
 s_mov_b32 s39, 0x00020000
 s_mov_b32 s42, s38
 s_mov_b32 s43, s39
 v_lshrrev_b32 v250, 2, v2
 v_lshl_add_u32 v250, v3, 3, v250
 v_mul_u32_u24 v250, 96, v250
 v_and_b32 v251, 3, v2
 v_lshlrev_b32 v251, 3, v251
 v_add3_u32 v250, v250, v251, s81
 v_lshlrev_b32 v251, 4, v1
 v_add_u32 v251, s81, v251
 v_lshlrev_b32 v26, 2, v1
 v_mov_b32 v27, 2731
 v_add_u32 v54, 0, v1
 v_mul_u32_u24 v53, v54, v27
 v_lshrrev_b32 v53, 16, v53
 v_mul_u32_u24 v52, 24, v53
 v_sub_u32 v54, v54, v52
 v_bfe_u32 v52, v53, 1, 1
 v_xor_b32 v54, v54, v52
 v_mul_u32_u24 v52, 20, v52
 v_and_b32 v51, 1, v53
 v_add_u32 v52, v52, v51
 v_lshrrev_b32 v51, 2, v53
 v_lshl_add_u32 v52, v51, 1, v52
 v_mul_u32_u24 v52, 12288, v52
 v_subrev_u32 v52, 0, v52
 v_lshl_add_u32 v28, v54, 4, v52
 v_xor_b32 v31, 32, v28
 v_xor_b32 v34, 64, v28
 v_xor_b32 v37, 96, v28
 v_add_u32 v54, 64, v1
 v_mul_u32_u24 v53, v54, v27
 v_lshrrev_b32 v53, 16, v53
 v_mul_u32_u24 v52, 24, v53
 v_sub_u32 v54, v54, v52
 v_bfe_u32 v52, v53, 1, 1
 v_xor_b32 v54, v54, v52
 v_mul_u32_u24 v52, 20, v52
 v_and_b32 v51, 1, v53
 v_add_u32 v52, v52, v51
 v_lshrrev_b32 v51, 2, v53
 v_lshl_add_u32 v52, v51, 1, v52
 v_mul_u32_u24 v52, 12288, v52
 v_subrev_u32 v52, 1024, v52
 v_lshl_add_u32 v29, v54, 4, v52
 v_xor_b32 v32, 32, v29
 v_xor_b32 v35, 64, v29
 v_xor_b32 v38, 96, v29
 v_add_u32 v54, 128, v1
 v_mul_u32_u24 v53, v54, v27
 v_lshrrev_b32 v53, 16, v53
 v_mul_u32_u24 v52, 24, v53
 v_sub_u32 v54, v54, v52
 v_bfe_u32 v52, v53, 1, 1
 v_xor_b32 v54, v54, v52
 v_mul_u32_u24 v52, 20, v52
 v_and_b32 v51, 1, v53
 v_add_u32 v52, v52, v51
 v_lshrrev_b32 v51, 2, v53
 v_lshl_add_u32 v52, v51, 1, v52
 v_mul_u32_u24 v52, 12288, v52
 v_subrev_u32 v52, 2048, v52
 v_lshl_add_u32 v30, v54, 4, v52
 v_xor_b32 v33, 32, v30
 v_xor_b32 v36, 64, v30
 v_xor_b32 v39, 96, v30
 s_add_u32 m0, s81, 0
 s_add_u32 s21, s88, 0
 buffer_load_dwordx4 v28, s[12:15], s21 offen offset:0 lds
 buffer_load_dwordx4 v29, s[12:15], s21 offen offset:1024 lds
 buffer_load_dwordx4 v30, s[12:15], s21 offen offset:2048 lds
 s_add_u32 m0, s81, 3072
 s_add_u32 s21, s88, 49152
 buffer_load_dwordx4 v31, s[12:15], s21 offen offset:0 lds
 buffer_load_dwordx4 v32, s[12:15], s21 offen offset:1024 lds
 buffer_load_dwordx4 v33, s[12:15], s21 offen offset:2048 lds
 s_add_u32 m0, s81, 6144
 s_add_u32 s21, s88, 491520
 buffer_load_dwordx4 v34, s[12:15], s21 offen offset:0 lds
 buffer_load_dwordx4 v35, s[12:15], s21 offen offset:1024 lds
 buffer_load_dwordx4 v36, s[12:15], s21 offen offset:2048 lds
 s_add_u32 m0, s81, 9216
 s_add_u32 s21, s88, 540672
 buffer_load_dwordx4 v37, s[12:15], s21 offen offset:0 lds
 buffer_load_dwordx4 v38, s[12:15], s21 offen offset:1024 lds
 buffer_load_dwordx4 v39, s[12:15], s21 offen offset:2048 lds
 s_add_u32 s22, s80, 0
 buffer_load_dwordx4 v[172:175], v244, s[40:43], s22 offen
 buffer_load_dwordx4 v[176:179], v245, s[40:43], s22 offen
 buffer_load_dwordx4 v[180:183], v246, s[40:43], s22 offen
 s_add_u32 s22, s80, 983040
 buffer_load_dwordx4 v[184:187], v244, s[40:43], s22 offen
 buffer_load_dwordx4 v[188:191], v245, s[40:43], s22 offen
 buffer_load_dwordx4 v[192:195], v246, s[40:43], s22 offen
 v_and_b32 v56, 7, v2
 v_lshrrev_b32 v57, 3, v2
 v_lshlrev_b32 v16, 4, v1
 s_lshr_b32 s21, s20, 1
 s_lshl_b32 s21, s21, 14
 s_and_b32 s22, s20, 1
 s_mul_i32 s22, s22, 3072
 s_add_u32 s21, s21, s22
 v_add_u32 v4, s21, v16
 v_mov_b32 v58, 0x4444
 v_mov_b32 v59, 0xeeee
 v_cmp_eq_u32 vcc, 1, v57
 s_nop 1
 v_cndmask_b32 v25, v58, v59, vcc
 v_mul_u32_u24 v58, 40, v2
 v_lshl_add_u32 v58, v3, 3, v58
 s_mul_i32 s21, s20, 1920
 v_add_u32 v5, s21, v58
 v_lshrrev_b32 v58, 2, v1
 v_mul_u32_u24 v58, 40, v58
 v_and_b32 v59, 3, v1
 v_lshl_add_u32 v6, v59, 3, v58
 v_bfe_u32 v59, v1, 1, 1
 v_mul_u32_u24 v59, 3824, v59
 v_add_u32 v21, v6, v59
 s_lshl_b32 s21, s50, 4
 s_add_u32 s21, s21, s51
 s_lshl_b32 s21, s21, 9
 s_lshl_b32 s22, s20, 7
 s_add_u32 s21, s21, s22
 s_add_u32 s21, s21, 81920
 v_and_b32 v58, 1, v3
 v_lshlrev_b32 v58, 8, v58
 v_lshl_add_u32 v58, v56, 4, v58
 v_lshrrev_b32 v59, 1, v3
 v_lshl_add_u32 v58, v59, 3, v58
 v_add_u32 v7, s21, v58
 s_lshl_b32 s22, s58, 9
 s_lshl_b32 s23, s56, 7
 s_add_u32 s22, s22, s23
 s_add_u32 s22, s22, 376704
 v_lshlrev_b32 v58, 6, v3
 v_lshl_add_u32 v58, v56, 3, v58
 v_add_u32 v58, s22, v58
 s_cmp_eq_u32 s20, 2
 s_cselect_b64 vcc, -1, 0
 v_cndmask_b32 v7, v7, v58, vcc
 s_lshl_b32 s21, s59, 11
 s_add_u32 s21, s21, 81920
 v_add_u32 v8, s21, v16
 s_lshl_b32 s21, s59, 9
 s_add_u32 s21, s21, 376832
 v_lshl_add_u32 v9, v1, 3, s21
 s_mul_i32 s21, s20, 3072
 s_add_u32 s21, s21, 24576
 v_and_b32 v58, 0x39, v1
 v_bfe_u32 v59, v1, 1, 1
 v_lshl_or_b32 v58, v59, 2, v58
 v_bfe_u32 v59, v1, 2, 1
 v_lshl_or_b32 v58, v59, 1, v58
 v_lshl_add_u32 v10, v58, 4, s21
 s_mul_i32 s22, s56, 12
 s_cmp_eq_u32 s20, 2
 s_cselect_b64 vcc, -1, 0
 v_add_u32 v58, s22, v3
 v_add3_u32 v59, 0, v58, v3
 v_lshrrev_b32 v60, 1, v59
 v_and_b32 v59, 1, v59
 v_lshlrev_b32 v59, 3, v59
 v_lshl_add_u32 v61, v60, 7, v59
 v_lshl_add_u32 v61, v56, 4, v61
 s_mul_i32 s21, s58, 3072
 v_add_u32 v62, s21, v61
 v_lshl_add_u32 v61, v60, 8, v59
 v_lshl_add_u32 v61, v2, 4, v61
 s_mul_i32 s21, s58, 12288
 s_and_b32 s22, s20, 1
 s_mul_i32 s22, s22, 6144
 s_add_u32 s21, s21, s22
 v_add_u32 v61, s21, v61
 v_cndmask_b32 v18, v61, v62, vcc
 v_add_u32 v59, 8, v58
 v_lshrrev_b32 v60, 1, v59
 v_and_b32 v59, 1, v59
 v_lshlrev_b32 v59, 3, v59
 v_lshl_add_u32 v61, v60, 7, v59
 v_lshl_add_u32 v61, v56, 4, v61
 s_mul_i32 s21, s58, 3072
 v_add_u32 v62, s21, v61
 v_lshl_add_u32 v61, v60, 8, v59
 v_lshl_add_u32 v61, v2, 4, v61
 s_mul_i32 s21, s58, 12288
 s_and_b32 s22, s20, 1
 s_mul_i32 s22, s22, 6144
 s_add_u32 s21, s21, s22
 v_add_u32 v61, s21, v61
 v_cndmask_b32 v19, v61, v62, vcc
 s_mul_i32 s21, s20, 3072
 s_add_u32 s21, s21, 8192
 v_add_u32 v11, s21, v16
 v_and_b32 v58, 3, v1
 s_lshl_b32 s21, s20, 2
 v_add_u32 v59, s21, v58
 v_cmp_eq_u32 vcc, 10, v59
 s_nop 1
 v_cndmask_b32 v59, v59, 7, vcc
 v_cmp_eq_u32 vcc, 3, v58
 v_lshrrev_b32 v60, 5, v1
 v_mul_u32_u24 v60, 10, v60
 v_cndmask_b32 v59, v59, 3, vcc
 s_lshl_b32 s21, s79, 2
 v_add3_u32 v59, v59, v60, s21
 v_lshrrev_b32 v60, 1, v59
 v_lshlrev_b32 v60, 8, v60
 v_and_b32 v59, 1, v59
 v_lshl_add_u32 v60, v59, 3, v60
 v_bfe_u32 v59, v1, 2, 3
 v_lshl_add_u32 v60, v59, 4, v60
 v_add_u32 v12, 8192, v60
 s_mov_b32 s21, 0x07060100
 s_cmp_eq_u32 s20, 1
 s_cselect_b32 s21, 0x07060302, s21
 s_cmp_eq_u32 s20, 2
 s_cselect_b32 s21, 0x07060c0c, s21
 v_mov_b32 v59, s21
 v_mov_b32 v60, 0x03020100
 v_cndmask_b32 v14, v60, v59, vcc
 s_lshr_b32 s21, s85, 3
 s_lshl_b32 s21, s21, 14
 s_bfe_u32 s22, s85, 0x10002
 s_mul_i32 s22, s22, 3072
 s_add_u32 s21, s21, s22
 s_and_b32 s22, s85, 3
 s_lshl_b32 s22, s22, 8
 s_add_u32 s21, s21, s22
 s_lshl_b32 s22, s20, 10
 s_add_u32 s22, s22, s21
 v_lshl_add_u32 v13, v1, 2, s22
 v_lshlrev_b32 v59, 10, v3
 v_lshl_add_u32 v59, v2, 4, v59
 v_add_u32 v59, s21, v59
 s_cmp_eq_u32 s20, 3
 s_cselect_b64 vcc, -1, 0
 v_cndmask_b32 v13, v13, v59, vcc
 s_mov_b32 s91, 0x3c000000
 v_and_b32 v59, 1, v3
 v_lshrrev_b32 v60, 1, v3
 v_lshl_add_u32 v59, v59, 1, v60
 v_lshlrev_b32 v59, 8, v59
 v_lshl_add_u32 v59, v2, 4, v59
 s_mul_i32 s21, s59, 10240
 s_lshl_b32 s22, s87, 8
 s_add_u32 s21, s21, s22
 v_add_u32 v15, s21, v59
 s_lshl_b32 s21, s79, 4
 s_lshl_b32 s76, -1, s21
 s_mov_b32 s77, 0xffff
 s_lshl_b32 s21, s79, 7
 v_or_b32 v17, s21, v16
 s_or_b32 s21, s21, 0xffffff7f
 v_and_b32 v20, s21, v16
 v_lshlrev_b32 v24, 3, v1
 v_cmp_gt_u32 s[60:61], 8, v2
 v_cmp_le_u32 s[62:63], 8, v2
 v_cmp_le_u32 s[72:73], 2, v3
 v_cmp_gt_u32 s[70:71], 48, v1
 s_nop 1
 s_and_b64 s[64:65], s[60:61], s[72:73]
 s_cmp_eq_u32 s20, 2
 s_cselect_b64 s[74:75], s[64:65], s[60:61]
 s_waitcnt vmcnt(18)
 ds_read_b64_tr_b16 v[64:65], v250 offset:12288
 ds_read_b64_tr_b16 v[66:67], v250 offset:12672
 ds_read_b64_tr_b16 v[88:89], v250 offset:12320
 ds_read_b64_tr_b16 v[90:91], v250 offset:12704
 ds_read_b64_tr_b16 v[112:113], v250 offset:12352
 ds_read_b64_tr_b16 v[114:115], v250 offset:12736
 ds_read_b64_tr_b16 v[68:69], v250 offset:15360
 ds_read_b64_tr_b16 v[70:71], v250 offset:15744
 ds_read_b64_tr_b16 v[92:93], v250 offset:15392
 ds_read_b64_tr_b16 v[94:95], v250 offset:15776
 ds_read_b64_tr_b16 v[116:117], v250 offset:15424
 ds_read_b64_tr_b16 v[118:119], v250 offset:15808
 ds_read_b64_tr_b16 v[72:73], v250 offset:18432
 ds_read_b64_tr_b16 v[74:75], v250 offset:18816
 ds_read_b64_tr_b16 v[96:97], v250 offset:18464
 ds_read_b64_tr_b16 v[98:99], v250 offset:18848
 ds_read_b64_tr_b16 v[120:121], v250 offset:18496
 ds_read_b64_tr_b16 v[122:123], v250 offset:18880
 ds_read_b64_tr_b16 v[76:77], v250 offset:21504
 ds_read_b64_tr_b16 v[78:79], v250 offset:21888
 ds_read_b64_tr_b16 v[100:101], v250 offset:21536
 ds_read_b64_tr_b16 v[102:103], v250 offset:21920
 ds_read_b64_tr_b16 v[124:125], v250 offset:21568
 ds_read_b64_tr_b16 v[126:127], v250 offset:21952
 ds_read_b64_tr_b16 v[80:81], v250 offset:24576
 ds_read_b64_tr_b16 v[82:83], v250 offset:24960
 ds_read_b64_tr_b16 v[104:105], v250 offset:24608
 ds_read_b64_tr_b16 v[106:107], v250 offset:24992
 ds_read_b64_tr_b16 v[128:129], v250 offset:24640
 ds_read_b64_tr_b16 v[130:131], v250 offset:25024
 ds_read_b64_tr_b16 v[84:85], v250 offset:27648
 ds_read_b64_tr_b16 v[86:87], v250 offset:28032
 ds_read_b64_tr_b16 v[108:109], v250 offset:27680
 ds_read_b64_tr_b16 v[110:111], v250 offset:28064
 ds_read_b64_tr_b16 v[132:133], v250 offset:27712
 ds_read_b64_tr_b16 v[134:135], v250 offset:28096
 s_waitcnt lgkmcnt(0)
 s_add_u32 m0, s81, 12288
 s_add_u32 s21, s88, 983040
 buffer_load_dwordx4 v28, s[12:15], s21 offen offset:0 lds
 buffer_load_dwordx4 v29, s[12:15], s21 offen offset:1024 lds
 buffer_load_dwordx4 v30, s[12:15], s21 offen offset:2048 lds
 s_add_u32 m0, s81, 15360
 s_add_u32 s21, s88, 1032192
 buffer_load_dwordx4 v31, s[12:15], s21 offen offset:0 lds
 buffer_load_dwordx4 v32, s[12:15], s21 offen offset:1024 lds
 buffer_load_dwordx4 v33, s[12:15], s21 offen offset:2048 lds
 s_add_u32 m0, s81, 18432
 s_add_u32 s21, s88, 1474560
 buffer_load_dwordx4 v34, s[12:15], s21 offen offset:0 lds
 buffer_load_dwordx4 v35, s[12:15], s21 offen offset:1024 lds
 buffer_load_dwordx4 v36, s[12:15], s21 offen offset:2048 lds
 s_add_u32 m0, s81, 21504
 s_add_u32 s21, s88, 1523712
 buffer_load_dwordx4 v37, s[12:15], s21 offen offset:0 lds
 buffer_load_dwordx4 v38, s[12:15], s21 offen offset:1024 lds
 buffer_load_dwordx4 v39, s[12:15], s21 offen offset:2048 lds
 s_add_u32 m0, s81, 24576
 s_add_u32 s21, s88, 98304
 buffer_load_dwordx4 v28, s[12:15], s21 offen offset:0 lds
 buffer_load_dwordx4 v29, s[12:15], s21 offen offset:1024 lds
 buffer_load_dwordx4 v30, s[12:15], s21 offen offset:2048 lds
 s_add_u32 m0, s81, 27648
 s_add_u32 s21, s88, 147456
 buffer_load_dwordx4 v31, s[12:15], s21 offen offset:0 lds
 buffer_load_dwordx4 v32, s[12:15], s21 offen offset:1024 lds
 buffer_load_dwordx4 v33, s[12:15], s21 offen offset:2048 lds
 s_add_u32 m0, s81, 30720
 s_add_u32 s21, s88, 589824
 buffer_load_dwordx4 v34, s[12:15], s21 offen offset:0 lds
 buffer_load_dwordx4 v35, s[12:15], s21 offen offset:1024 lds
 buffer_load_dwordx4 v36, s[12:15], s21 offen offset:2048 lds
 s_add_u32 m0, s81, 33792
 s_add_u32 s21, s88, 638976
 buffer_load_dwordx4 v37, s[12:15], s21 offen offset:0 lds
 buffer_load_dwordx4 v38, s[12:15], s21 offen offset:1024 lds
 buffer_load_dwordx4 v39, s[12:15], s21 offen offset:2048 lds
 v_lshrrev_b32 v40, 2, v2
 v_and_b32 v41, 3, v2
 v_lshl_add_u32 v41, v40, 3, v41
 v_mul_u32_u24 v41, 384, v41
 v_add_u32 v41, s81, v41
 v_lshrrev_b32 v40, 1, v2
 v_xor_b32 v40, v40, v3
 v_lshl_add_u32 v22, v40, 4, v41
 v_xor_b32 v40, 4, v40
 v_lshl_add_u32 v23, v40, 4, v41
 s_mul_i32 s64, s59, 40960
 s_lshl_b32 s21, s87, 10
 s_add_u32 s64, s64, s21
 s_add_u32 s64, s64, 1310720
 s_lshl_b32 s79, s59, 7
 s_and_b32 s21, s51, 12
 s_lshl_b32 s21, s21, 10
 s_add_u32 s79, s79, s21
 s_add_u32 s79, s79, 94208
 s_lshl_b32 s90, s58, 7
 s_add_u32 s90, s90, 18432
 s_cmp_eq_u32 s56, 0
 s_cselect_b32 s66, s90, 0x80000000
 s_bfe_u32 s82, s50, 0x10001
 s_lshl_b32 s82, s82, 5
 s_lshr_b32 s21, s50, 2
 s_add_u32 s82, s82, s21
 s_and_b32 s83, s50, 1
 s_lshl_b32 s83, s83, 4
 s_add_u32 s83, s83, 16
 s_waitcnt vmcnt(30)
 ds_read_b128 v[136:139], v22 offset:0
 ds_read_b128 v[140:143], v22 offset:1536
 s_waitcnt vmcnt(27)
 ds_write_b128 v251, v[172:175] offset:36864
 ds_write_b128 v251, v[176:179] offset:37888
 ds_write_b128 v251, v[180:183] offset:38912
 ds_read_b64_tr_b16 v[160:161], v250 offset:36864
 ds_read_b64_tr_b16 v[162:163], v250 offset:37248
 ds_read_b64_tr_b16 v[164:165], v250 offset:36896
 ds_read_b64_tr_b16 v[166:167], v250 offset:37280
 ds_read_b64_tr_b16 v[168:169], v250 offset:36928
 ds_read_b64_tr_b16 v[170:171], v250 offset:37312
 ds_read_b128 v[144:147], v23 offset:0
 ds_read_b128 v[148:151], v23 offset:1536
 s_waitcnt lgkmcnt(2)
 v_mfma_f32_16x16x32_bf16 v[40:43], v[136:139], v[64:67], 0
 s_add_u32 s22, s80, 98304
 v_mfma_f32_16x16x32_bf16 v[48:51], v[136:139], v[88:91], 0
 buffer_load_dwordx4 v[196:199], v244, s[40:43], s22 offen
 v_mfma_f32_16x16x32_bf16 v[56:59], v[136:139], v[112:115], 0
 buffer_load_dwordx4 v[200:203], v245, s[40:43], s22 offen
 v_mfma_f32_16x16x32_bf16 v[44:47], v[140:143], v[64:67], 0
 buffer_load_dwordx4 v[204:207], v246, s[40:43], s22 offen
 v_mfma_f32_16x16x32_bf16 v[52:55], v[140:143], v[88:91], 0
 v_lshlrev_b32 v27, 16, v160
 v_and_b32 v160, 0xffff0000, v160
 v_mfma_f32_16x16x32_bf16 v[60:63], v[140:143], v[112:115], 0
 v_cvt_pk_f16_f32 v160, v27, v160
 v_accvgpr_write_b32 a60, v160
 ds_read_b128 v[136:139], v22 offset:128
 ds_read_b128 v[140:143], v22 offset:1664
 s_waitcnt lgkmcnt(2)
 v_mfma_f32_16x16x32_bf16 v[40:43], v[144:147], v[68:71], v[40:43]
 v_lshlrev_b32 v27, 16, v161
 v_and_b32 v161, 0xffff0000, v161
 v_mfma_f32_16x16x32_bf16 v[48:51], v[144:147], v[92:95], v[48:51]
 v_cvt_pk_f16_f32 v161, v27, v161
 v_accvgpr_write_b32 a61, v161
 v_mfma_f32_16x16x32_bf16 v[56:59], v[144:147], v[116:119], v[56:59]
 v_lshlrev_b32 v27, 16, v162
 v_and_b32 v162, 0xffff0000, v162
 v_mfma_f32_16x16x32_bf16 v[44:47], v[148:151], v[68:71], v[44:47]
 v_cvt_pk_f16_f32 v162, v27, v162
 v_accvgpr_write_b32 a62, v162
 v_mfma_f32_16x16x32_bf16 v[52:55], v[148:151], v[92:95], v[52:55]
 v_lshlrev_b32 v27, 16, v163
 v_and_b32 v163, 0xffff0000, v163
 v_mfma_f32_16x16x32_bf16 v[60:63], v[148:151], v[116:119], v[60:63]
 v_cvt_pk_f16_f32 v163, v27, v163
 v_accvgpr_write_b32 a63, v163
 ds_read_b128 v[144:147], v23 offset:128
 ds_read_b128 v[148:151], v23 offset:1664
 s_waitcnt lgkmcnt(2)
 v_mfma_f32_16x16x32_bf16 v[40:43], v[136:139], v[72:75], v[40:43]
 v_lshlrev_b32 v27, 16, v164
 v_and_b32 v164, 0xffff0000, v164
 v_mfma_f32_16x16x32_bf16 v[48:51], v[136:139], v[96:99], v[48:51]
 v_cvt_pk_f16_f32 v164, v27, v164
 v_accvgpr_write_b32 a80, v164
 v_mfma_f32_16x16x32_bf16 v[56:59], v[136:139], v[120:123], v[56:59]
 v_lshlrev_b32 v27, 16, v165
 v_and_b32 v165, 0xffff0000, v165
 v_mfma_f32_16x16x32_bf16 v[44:47], v[140:143], v[72:75], v[44:47]
 v_cvt_pk_f16_f32 v165, v27, v165
 v_accvgpr_write_b32 a81, v165
 v_mfma_f32_16x16x32_bf16 v[52:55], v[140:143], v[96:99], v[52:55]
 v_lshlrev_b32 v27, 16, v166
 v_and_b32 v166, 0xffff0000, v166
 v_mfma_f32_16x16x32_bf16 v[60:63], v[140:143], v[120:123], v[60:63]
 v_cvt_pk_f16_f32 v166, v27, v166
 v_accvgpr_write_b32 a82, v166
 ds_read_b128 v[136:139], v22 offset:256
 ds_read_b128 v[140:143], v22 offset:1792
 s_waitcnt lgkmcnt(2)
 v_mfma_f32_16x16x32_bf16 v[40:43], v[144:147], v[76:79], v[40:43]
 v_lshlrev_b32 v27, 16, v167
 v_and_b32 v167, 0xffff0000, v167
 v_mfma_f32_16x16x32_bf16 v[48:51], v[144:147], v[100:103], v[48:51]
 v_cvt_pk_f16_f32 v167, v27, v167
 v_accvgpr_write_b32 a83, v167
 v_mfma_f32_16x16x32_bf16 v[56:59], v[144:147], v[124:127], v[56:59]
 v_lshlrev_b32 v27, 16, v168
 v_and_b32 v168, 0xffff0000, v168
 v_mfma_f32_16x16x32_bf16 v[44:47], v[148:151], v[76:79], v[44:47]
 v_cvt_pk_f16_f32 v168, v27, v168
 v_accvgpr_write_b32 a100, v168
 v_mfma_f32_16x16x32_bf16 v[52:55], v[148:151], v[100:103], v[52:55]
 v_lshlrev_b32 v27, 16, v169
 v_and_b32 v169, 0xffff0000, v169
 v_mfma_f32_16x16x32_bf16 v[60:63], v[148:151], v[124:127], v[60:63]
 v_cvt_pk_f16_f32 v169, v27, v169
 v_accvgpr_write_b32 a101, v169
 ds_read_b128 v[144:147], v23 offset:256
 ds_read_b128 v[148:151], v23 offset:1792
 s_waitcnt lgkmcnt(2)
 v_mfma_f32_16x16x32_bf16 v[40:43], v[136:139], v[80:83], v[40:43]
 v_lshlrev_b32 v27, 16, v170
 v_and_b32 v170, 0xffff0000, v170
 v_mfma_f32_16x16x32_bf16 v[48:51], v[136:139], v[104:107], v[48:51]
 v_cvt_pk_f16_f32 v170, v27, v170
 v_accvgpr_write_b32 a102, v170
 v_mfma_f32_16x16x32_bf16 v[56:59], v[136:139], v[128:131], v[56:59]
 v_lshlrev_b32 v27, 16, v171
 v_and_b32 v171, 0xffff0000, v171
 v_mfma_f32_16x16x32_bf16 v[44:47], v[140:143], v[80:83], v[44:47]
 v_cvt_pk_f16_f32 v171, v27, v171
 v_accvgpr_write_b32 a103, v171
 v_mfma_f32_16x16x32_bf16 v[52:55], v[140:143], v[104:107], v[52:55]
 v_mfma_f32_16x16x32_bf16 v[60:63], v[140:143], v[128:131], v[60:63]
 s_waitcnt vmcnt(15)
 ds_read_b128 v[136:139], v22 offset:12288
 ds_read_b128 v[140:143], v22 offset:13824
 s_waitcnt lgkmcnt(2)
 v_mfma_f32_16x16x32_bf16 v[40:43], v[144:147], v[84:87], v[40:43]
 s_add_u32 m0, s81, 0
 s_add_u32 s21, s88, 1081344
 v_mfma_f32_16x16x32_bf16 v[48:51], v[144:147], v[108:111], v[48:51]
 buffer_load_dwordx4 v28, s[12:15], s21 offen offset:0 lds
 buffer_load_dwordx4 v29, s[12:15], s21 offen offset:1024 lds
 v_mfma_f32_16x16x32_bf16 v[56:59], v[144:147], v[132:135], v[56:59]
 buffer_load_dwordx4 v30, s[12:15], s21 offen offset:2048 lds
 s_add_u32 m0, s81, 3072
 v_mfma_f32_16x16x32_bf16 v[44:47], v[148:151], v[84:87], v[44:47]
 s_add_u32 s21, s88, 1130496
 buffer_load_dwordx4 v31, s[12:15], s21 offen offset:0 lds
 v_mfma_f32_16x16x32_bf16 v[52:55], v[148:151], v[108:111], v[52:55]
 buffer_load_dwordx4 v32, s[12:15], s21 offen offset:1024 lds
 buffer_load_dwordx4 v33, s[12:15], s21 offen offset:2048 lds
 v_mfma_f32_16x16x32_bf16 v[60:63], v[148:151], v[132:135], v[60:63]
 s_add_u32 m0, s81, 6144
 s_add_u32 s21, s88, 1572864
 s_nop 1
 v_cvt_pk_f16_f32 v40, v40, v41
 v_accvgpr_write_b32 a120, v40
 buffer_load_dwordx4 v34, s[12:15], s21 offen offset:0 lds
 v_cvt_pk_f16_f32 v42, v42, v43
 v_accvgpr_write_b32 a121, v42
 buffer_load_dwordx4 v35, s[12:15], s21 offen offset:1024 lds
 v_cvt_pk_f16_f32 v48, v48, v49
 v_accvgpr_write_b32 a128, v48
 buffer_load_dwordx4 v36, s[12:15], s21 offen offset:2048 lds
 v_cvt_pk_f16_f32 v50, v50, v51
 v_accvgpr_write_b32 a129, v50
 s_add_u32 m0, s81, 9216
 v_cvt_pk_f16_f32 v56, v56, v57
 v_accvgpr_write_b32 a136, v56
 s_add_u32 s21, s88, 1622016
 v_cvt_pk_f16_f32 v58, v58, v59
 v_accvgpr_write_b32 a137, v58
 buffer_load_dwordx4 v37, s[12:15], s21 offen offset:0 lds
 s_nop 3
 v_cvt_pk_f16_f32 v44, v44, v45
 v_accvgpr_write_b32 a122, v44
 buffer_load_dwordx4 v38, s[12:15], s21 offen offset:1024 lds
 v_cvt_pk_f16_f32 v46, v46, v47
 v_accvgpr_write_b32 a123, v46
 buffer_load_dwordx4 v39, s[12:15], s21 offen offset:2048 lds
 v_cvt_pk_f16_f32 v52, v52, v53
 v_accvgpr_write_b32 a130, v52
 v_cvt_pk_f16_f32 v54, v54, v55
 v_accvgpr_write_b32 a131, v54
 v_cvt_pk_f16_f32 v60, v60, v61
 v_accvgpr_write_b32 a138, v60
 v_cvt_pk_f16_f32 v62, v62, v63
 v_accvgpr_write_b32 a139, v62
 s_waitcnt vmcnt(39)
 ds_write_b128 v251, v[184:187] offset:36864
 ds_write_b128 v251, v[188:191] offset:37888
 ds_write_b128 v251, v[192:195] offset:38912
 ds_read_b64_tr_b16 v[160:161], v250 offset:36864
 ds_read_b64_tr_b16 v[162:163], v250 offset:37248
 ds_read_b64_tr_b16 v[164:165], v250 offset:36896
 ds_read_b64_tr_b16 v[166:167], v250 offset:37280
 ds_read_b64_tr_b16 v[168:169], v250 offset:36928
 ds_read_b64_tr_b16 v[170:171], v250 offset:37312
 ds_read_b128 v[144:147], v23 offset:12288
 ds_read_b128 v[148:151], v23 offset:13824
 s_waitcnt lgkmcnt(2)
 v_mfma_f32_16x16x32_bf16 v[40:43], v[136:139], v[64:67], 0
 s_add_u32 s22, s80, 1081344
 v_mfma_f32_16x16x32_bf16 v[48:51], v[136:139], v[88:91], 0
 buffer_load_dwordx4 v[208:211], v244, s[40:43], s22 offen
 v_mfma_f32_16x16x32_bf16 v[56:59], v[136:139], v[112:115], 0
 buffer_load_dwordx4 v[212:215], v245, s[40:43], s22 offen
 v_mfma_f32_16x16x32_bf16 v[44:47], v[140:143], v[64:67], 0
 buffer_load_dwordx4 v[216:219], v246, s[40:43], s22 offen
 v_mfma_f32_16x16x32_bf16 v[52:55], v[140:143], v[88:91], 0
 v_lshlrev_b32 v27, 16, v160
 v_and_b32 v160, 0xffff0000, v160
 v_mfma_f32_16x16x32_bf16 v[60:63], v[140:143], v[112:115], 0
 v_cvt_pk_f16_f32 v160, v27, v160
 v_accvgpr_write_b32 a64, v160
 ds_read_b128 v[136:139], v22 offset:12416
 ds_read_b128 v[140:143], v22 offset:13952
 s_waitcnt lgkmcnt(2)
 v_mfma_f32_16x16x32_bf16 v[40:43], v[144:147], v[68:71], v[40:43]
 v_lshlrev_b32 v27, 16, v161
 v_and_b32 v161, 0xffff0000, v161
 v_mfma_f32_16x16x32_bf16 v[48:51], v[144:147], v[92:95], v[48:51]
 v_cvt_pk_f16_f32 v161, v27, v161
 v_accvgpr_write_b32 a65, v161
 v_mfma_f32_16x16x32_bf16 v[56:59], v[144:147], v[116:119], v[56:59]
 v_lshlrev_b32 v27, 16, v162
 v_and_b32 v162, 0xffff0000, v162
 v_mfma_f32_16x16x32_bf16 v[44:47], v[148:151], v[68:71], v[44:47]
 v_cvt_pk_f16_f32 v162, v27, v162
 v_accvgpr_write_b32 a66, v162
 v_mfma_f32_16x16x32_bf16 v[52:55], v[148:151], v[92:95], v[52:55]
 v_lshlrev_b32 v27, 16, v163
 v_and_b32 v163, 0xffff0000, v163
 v_mfma_f32_16x16x32_bf16 v[60:63], v[148:151], v[116:119], v[60:63]
 v_cvt_pk_f16_f32 v163, v27, v163
 v_accvgpr_write_b32 a67, v163
 ds_read_b128 v[144:147], v23 offset:12416
 ds_read_b128 v[148:151], v23 offset:13952
 s_waitcnt lgkmcnt(2)
 v_mfma_f32_16x16x32_bf16 v[40:43], v[136:139], v[72:75], v[40:43]
 v_lshlrev_b32 v27, 16, v164
 v_and_b32 v164, 0xffff0000, v164
 v_mfma_f32_16x16x32_bf16 v[48:51], v[136:139], v[96:99], v[48:51]
 v_cvt_pk_f16_f32 v164, v27, v164
 v_accvgpr_write_b32 a84, v164
 v_mfma_f32_16x16x32_bf16 v[56:59], v[136:139], v[120:123], v[56:59]
 v_lshlrev_b32 v27, 16, v165
 v_and_b32 v165, 0xffff0000, v165
 v_mfma_f32_16x16x32_bf16 v[44:47], v[140:143], v[72:75], v[44:47]
 v_cvt_pk_f16_f32 v165, v27, v165
 v_accvgpr_write_b32 a85, v165
 v_mfma_f32_16x16x32_bf16 v[52:55], v[140:143], v[96:99], v[52:55]
 v_lshlrev_b32 v27, 16, v166
 v_and_b32 v166, 0xffff0000, v166
 v_mfma_f32_16x16x32_bf16 v[60:63], v[140:143], v[120:123], v[60:63]
 v_cvt_pk_f16_f32 v166, v27, v166
 v_accvgpr_write_b32 a86, v166
 ds_read_b128 v[136:139], v22 offset:12544
 ds_read_b128 v[140:143], v22 offset:14080
 s_waitcnt lgkmcnt(2)
 v_mfma_f32_16x16x32_bf16 v[40:43], v[144:147], v[76:79], v[40:43]
 v_lshlrev_b32 v27, 16, v167
 v_and_b32 v167, 0xffff0000, v167
 v_mfma_f32_16x16x32_bf16 v[48:51], v[144:147], v[100:103], v[48:51]
 v_cvt_pk_f16_f32 v167, v27, v167
 v_accvgpr_write_b32 a87, v167
 v_mfma_f32_16x16x32_bf16 v[56:59], v[144:147], v[124:127], v[56:59]
 v_lshlrev_b32 v27, 16, v168
 v_and_b32 v168, 0xffff0000, v168
 v_mfma_f32_16x16x32_bf16 v[44:47], v[148:151], v[76:79], v[44:47]
 v_cvt_pk_f16_f32 v168, v27, v168
 v_accvgpr_write_b32 a104, v168
 v_mfma_f32_16x16x32_bf16 v[52:55], v[148:151], v[100:103], v[52:55]
 v_lshlrev_b32 v27, 16, v169
 v_and_b32 v169, 0xffff0000, v169
 v_mfma_f32_16x16x32_bf16 v[60:63], v[148:151], v[124:127], v[60:63]
 v_cvt_pk_f16_f32 v169, v27, v169
 v_accvgpr_write_b32 a105, v169
 ds_read_b128 v[144:147], v23 offset:12544
 ds_read_b128 v[148:151], v23 offset:14080
 s_waitcnt lgkmcnt(2)
 v_mfma_f32_16x16x32_bf16 v[40:43], v[136:139], v[80:83], v[40:43]
 v_lshlrev_b32 v27, 16, v170
 v_and_b32 v170, 0xffff0000, v170
 v_mfma_f32_16x16x32_bf16 v[48:51], v[136:139], v[104:107], v[48:51]
 v_cvt_pk_f16_f32 v170, v27, v170
 v_accvgpr_write_b32 a106, v170
 v_mfma_f32_16x16x32_bf16 v[56:59], v[136:139], v[128:131], v[56:59]
 v_lshlrev_b32 v27, 16, v171
 v_and_b32 v171, 0xffff0000, v171
 v_mfma_f32_16x16x32_bf16 v[44:47], v[140:143], v[80:83], v[44:47]
 v_cvt_pk_f16_f32 v171, v27, v171
 v_accvgpr_write_b32 a107, v171
 v_mfma_f32_16x16x32_bf16 v[52:55], v[140:143], v[104:107], v[52:55]
 v_mfma_f32_16x16x32_bf16 v[60:63], v[140:143], v[128:131], v[60:63]
 s_waitcnt vmcnt(18)
 ds_read_b128 v[136:139], v22 offset:24576
 ds_read_b128 v[140:143], v22 offset:26112
 s_waitcnt lgkmcnt(2)
 v_mfma_f32_16x16x32_bf16 v[40:43], v[144:147], v[84:87], v[40:43]
 s_add_u32 m0, s81, 12288
 s_add_u32 s21, s88, 1966080
 v_mfma_f32_16x16x32_bf16 v[48:51], v[144:147], v[108:111], v[48:51]
 buffer_load_dwordx4 v28, s[12:15], s21 offen offset:0 lds
 buffer_load_dwordx4 v29, s[12:15], s21 offen offset:1024 lds
 v_mfma_f32_16x16x32_bf16 v[56:59], v[144:147], v[132:135], v[56:59]
 buffer_load_dwordx4 v30, s[12:15], s21 offen offset:2048 lds
 s_add_u32 m0, s81, 15360
 v_mfma_f32_16x16x32_bf16 v[44:47], v[148:151], v[84:87], v[44:47]
 s_add_u32 s21, s88, 2015232
 buffer_load_dwordx4 v31, s[12:15], s21 offen offset:0 lds
 v_mfma_f32_16x16x32_bf16 v[52:55], v[148:151], v[108:111], v[52:55]
 buffer_load_dwordx4 v32, s[12:15], s21 offen offset:1024 lds
 buffer_load_dwordx4 v33, s[12:15], s21 offen offset:2048 lds
 v_mfma_f32_16x16x32_bf16 v[60:63], v[148:151], v[132:135], v[60:63]
 s_add_u32 m0, s81, 18432
 s_add_u32 s21, s88, 2457600
 s_nop 1
 v_cvt_pk_f16_f32 v40, v40, v41
 v_accvgpr_write_b32 a124, v40
 buffer_load_dwordx4 v34, s[12:15], s21 offen offset:0 lds
 v_cvt_pk_f16_f32 v42, v42, v43
 v_accvgpr_write_b32 a125, v42
 buffer_load_dwordx4 v35, s[12:15], s21 offen offset:1024 lds
 v_cvt_pk_f16_f32 v48, v48, v49
 v_accvgpr_write_b32 a132, v48
 buffer_load_dwordx4 v36, s[12:15], s21 offen offset:2048 lds
 v_cvt_pk_f16_f32 v50, v50, v51
 v_accvgpr_write_b32 a133, v50
 s_add_u32 m0, s81, 21504
 v_cvt_pk_f16_f32 v56, v56, v57
 v_accvgpr_write_b32 a140, v56
 s_add_u32 s21, s88, 2506752
 v_cvt_pk_f16_f32 v58, v58, v59
 v_accvgpr_write_b32 a141, v58
 buffer_load_dwordx4 v37, s[12:15], s21 offen offset:0 lds
 s_nop 3
 v_cvt_pk_f16_f32 v44, v44, v45
 v_accvgpr_write_b32 a126, v44
 buffer_load_dwordx4 v38, s[12:15], s21 offen offset:1024 lds
 v_cvt_pk_f16_f32 v46, v46, v47
 v_accvgpr_write_b32 a127, v46
 buffer_load_dwordx4 v39, s[12:15], s21 offen offset:2048 lds
 v_cvt_pk_f16_f32 v52, v52, v53
 v_accvgpr_write_b32 a134, v52
 v_cvt_pk_f16_f32 v54, v54, v55
 v_accvgpr_write_b32 a135, v54
 v_cvt_pk_f16_f32 v60, v60, v61
 v_accvgpr_write_b32 a142, v60
 v_cvt_pk_f16_f32 v62, v62, v63
 v_accvgpr_write_b32 a143, v62
 s_waitcnt vmcnt(27)
 ds_write_b128 v251, v[196:199] offset:36864
 ds_write_b128 v251, v[200:203] offset:37888
 ds_write_b128 v251, v[204:207] offset:38912
 ds_read_b64_tr_b16 v[160:161], v250 offset:36864
 ds_read_b64_tr_b16 v[162:163], v250 offset:37248
 ds_read_b64_tr_b16 v[164:165], v250 offset:36896
 ds_read_b64_tr_b16 v[166:167], v250 offset:37280
 ds_read_b64_tr_b16 v[168:169], v250 offset:36928
 ds_read_b64_tr_b16 v[170:171], v250 offset:37312
 ds_read_b128 v[144:147], v23 offset:24576
 ds_read_b128 v[148:151], v23 offset:26112
 s_waitcnt lgkmcnt(2)
 v_mfma_f32_16x16x32_bf16 v[40:43], v[136:139], v[64:67], 0
 s_add_u32 s22, s80, 196608
 v_mfma_f32_16x16x32_bf16 v[48:51], v[136:139], v[88:91], 0
 buffer_load_dwordx4 v[220:223], v247, s[40:43], s22 offen
 v_mfma_f32_16x16x32_bf16 v[56:59], v[136:139], v[112:115], 0
 buffer_load_dwordx4 v[224:227], v248, s[40:43], s22 offen
 v_mfma_f32_16x16x32_bf16 v[44:47], v[140:143], v[64:67], 0
 buffer_load_dwordx4 v[228:231], v249, s[40:43], s22 offen
 v_mfma_f32_16x16x32_bf16 v[52:55], v[140:143], v[88:91], 0
 v_lshlrev_b32 v27, 16, v160
 v_and_b32 v160, 0xffff0000, v160
 v_mfma_f32_16x16x32_bf16 v[60:63], v[140:143], v[112:115], 0
 v_cvt_pk_f16_f32 v160, v27, v160
 v_accvgpr_write_b32 a68, v160
 ds_read_b128 v[136:139], v22 offset:24704
 ds_read_b128 v[140:143], v22 offset:26240
 s_waitcnt lgkmcnt(2)
 v_mfma_f32_16x16x32_bf16 v[40:43], v[144:147], v[68:71], v[40:43]
 v_lshlrev_b32 v27, 16, v161
 v_and_b32 v161, 0xffff0000, v161
 v_mfma_f32_16x16x32_bf16 v[48:51], v[144:147], v[92:95], v[48:51]
 v_cvt_pk_f16_f32 v161, v27, v161
 v_accvgpr_write_b32 a69, v161
 v_mfma_f32_16x16x32_bf16 v[56:59], v[144:147], v[116:119], v[56:59]
 v_lshlrev_b32 v27, 16, v162
 v_and_b32 v162, 0xffff0000, v162
 v_mfma_f32_16x16x32_bf16 v[44:47], v[148:151], v[68:71], v[44:47]
 v_cvt_pk_f16_f32 v162, v27, v162
 v_accvgpr_write_b32 a70, v162
 v_mfma_f32_16x16x32_bf16 v[52:55], v[148:151], v[92:95], v[52:55]
 v_lshlrev_b32 v27, 16, v163
 v_and_b32 v163, 0xffff0000, v163
 v_mfma_f32_16x16x32_bf16 v[60:63], v[148:151], v[116:119], v[60:63]
 v_cvt_pk_f16_f32 v163, v27, v163
 v_accvgpr_write_b32 a71, v163
 ds_read_b128 v[144:147], v23 offset:24704
 ds_read_b128 v[148:151], v23 offset:26240
 s_waitcnt lgkmcnt(2)
 v_mfma_f32_16x16x32_bf16 v[40:43], v[136:139], v[72:75], v[40:43]
 v_lshlrev_b32 v27, 16, v164
 v_and_b32 v164, 0xffff0000, v164
 v_mfma_f32_16x16x32_bf16 v[48:51], v[136:139], v[96:99], v[48:51]
 v_cvt_pk_f16_f32 v164, v27, v164
 v_accvgpr_write_b32 a88, v164
 v_mfma_f32_16x16x32_bf16 v[56:59], v[136:139], v[120:123], v[56:59]
 v_lshlrev_b32 v27, 16, v165
 v_and_b32 v165, 0xffff0000, v165
 v_mfma_f32_16x16x32_bf16 v[44:47], v[140:143], v[72:75], v[44:47]
 v_cvt_pk_f16_f32 v165, v27, v165
 v_accvgpr_write_b32 a89, v165
 v_mfma_f32_16x16x32_bf16 v[52:55], v[140:143], v[96:99], v[52:55]
 v_lshlrev_b32 v27, 16, v166
 v_and_b32 v166, 0xffff0000, v166
 v_mfma_f32_16x16x32_bf16 v[60:63], v[140:143], v[120:123], v[60:63]
 v_cvt_pk_f16_f32 v166, v27, v166
 v_accvgpr_write_b32 a90, v166
 ds_read_b128 v[136:139], v22 offset:24832
 ds_read_b128 v[140:143], v22 offset:26368
 s_waitcnt lgkmcnt(2)
 v_mfma_f32_16x16x32_bf16 v[40:43], v[144:147], v[76:79], v[40:43]
 v_lshlrev_b32 v27, 16, v167
 v_and_b32 v167, 0xffff0000, v167
 v_mfma_f32_16x16x32_bf16 v[48:51], v[144:147], v[100:103], v[48:51]
 v_cvt_pk_f16_f32 v167, v27, v167
 v_accvgpr_write_b32 a91, v167
 v_mfma_f32_16x16x32_bf16 v[56:59], v[144:147], v[124:127], v[56:59]
 v_lshlrev_b32 v27, 16, v168
 v_and_b32 v168, 0xffff0000, v168
 v_mfma_f32_16x16x32_bf16 v[44:47], v[148:151], v[76:79], v[44:47]
 v_cvt_pk_f16_f32 v168, v27, v168
 v_accvgpr_write_b32 a108, v168
 v_mfma_f32_16x16x32_bf16 v[52:55], v[148:151], v[100:103], v[52:55]
 v_lshlrev_b32 v27, 16, v169
 v_and_b32 v169, 0xffff0000, v169
 v_mfma_f32_16x16x32_bf16 v[60:63], v[148:151], v[124:127], v[60:63]
 v_cvt_pk_f16_f32 v169, v27, v169
 v_accvgpr_write_b32 a109, v169
 ds_read_b128 v[144:147], v23 offset:24832
 ds_read_b128 v[148:151], v23 offset:26368
 s_waitcnt lgkmcnt(2)
 v_mfma_f32_16x16x32_bf16 v[40:43], v[136:139], v[80:83], v[40:43]
 v_lshlrev_b32 v27, 16, v170
 v_and_b32 v170, 0xffff0000, v170
 v_mfma_f32_16x16x32_bf16 v[48:51], v[136:139], v[104:107], v[48:51]
 v_cvt_pk_f16_f32 v170, v27, v170
 v_accvgpr_write_b32 a110, v170
 v_mfma_f32_16x16x32_bf16 v[56:59], v[136:139], v[128:131], v[56:59]
 v_lshlrev_b32 v27, 16, v171
 v_and_b32 v171, 0xffff0000, v171
 v_mfma_f32_16x16x32_bf16 v[44:47], v[140:143], v[80:83], v[44:47]
 v_cvt_pk_f16_f32 v171, v27, v171
 v_accvgpr_write_b32 a111, v171
 v_mfma_f32_16x16x32_bf16 v[52:55], v[140:143], v[104:107], v[52:55]
 v_mfma_f32_16x16x32_bf16 v[60:63], v[140:143], v[128:131], v[60:63]
 s_waitcnt vmcnt(18)
 ds_read_b128 v[136:139], v22 offset:0
 ds_read_b128 v[140:143], v22 offset:1536
 s_waitcnt lgkmcnt(2)
 v_mfma_f32_16x16x32_bf16 v[40:43], v[144:147], v[84:87], v[40:43]
 s_add_u32 m0, s81, 24576
 s_add_u32 s21, s88, 2949120
 v_mfma_f32_16x16x32_bf16 v[48:51], v[144:147], v[108:111], v[48:51]
 buffer_load_dwordx4 v28, s[12:15], s21 offen offset:0 lds
 buffer_load_dwordx4 v29, s[12:15], s21 offen offset:1024 lds
 v_mfma_f32_16x16x32_bf16 v[56:59], v[144:147], v[132:135], v[56:59]
 buffer_load_dwordx4 v30, s[12:15], s21 offen offset:2048 lds
 s_add_u32 m0, s81, 27648
 v_mfma_f32_16x16x32_bf16 v[44:47], v[148:151], v[84:87], v[44:47]
 s_add_u32 s21, s88, 2998272
 buffer_load_dwordx4 v31, s[12:15], s21 offen offset:0 lds
 v_mfma_f32_16x16x32_bf16 v[52:55], v[148:151], v[108:111], v[52:55]
 buffer_load_dwordx4 v32, s[12:15], s21 offen offset:1024 lds
 buffer_load_dwordx4 v33, s[12:15], s21 offen offset:2048 lds
 v_mfma_f32_16x16x32_bf16 v[60:63], v[148:151], v[132:135], v[60:63]
 s_add_u32 m0, s81, 30720
 s_add_u32 s21, s88, 3440640
 s_nop 1
 v_cvt_pk_f16_f32 v40, v40, v41
 v_accvgpr_write_b32 a144, v40
 buffer_load_dwordx4 v34, s[12:15], s21 offen offset:0 lds
 v_cvt_pk_f16_f32 v42, v42, v43
 v_accvgpr_write_b32 a145, v42
 buffer_load_dwordx4 v35, s[12:15], s21 offen offset:1024 lds
 v_cvt_pk_f16_f32 v48, v48, v49
 v_accvgpr_write_b32 a152, v48
 buffer_load_dwordx4 v36, s[12:15], s21 offen offset:2048 lds
 v_cvt_pk_f16_f32 v50, v50, v51
 v_accvgpr_write_b32 a153, v50
 s_add_u32 m0, s81, 33792
 v_cvt_pk_f16_f32 v56, v56, v57
 v_accvgpr_write_b32 a160, v56
 s_add_u32 s21, s88, 3489792
 v_cvt_pk_f16_f32 v58, v58, v59
 v_accvgpr_write_b32 a161, v58
 buffer_load_dwordx4 v37, s[12:15], s21 offen offset:0 lds
 s_nop 3
 v_cvt_pk_f16_f32 v44, v44, v45
 v_accvgpr_write_b32 a146, v44
 buffer_load_dwordx4 v38, s[12:15], s21 offen offset:1024 lds
 v_cvt_pk_f16_f32 v46, v46, v47
 v_accvgpr_write_b32 a147, v46
 buffer_load_dwordx4 v39, s[12:15], s21 offen offset:2048 lds
 v_cvt_pk_f16_f32 v52, v52, v53
 v_accvgpr_write_b32 a154, v52
 v_cvt_pk_f16_f32 v54, v54, v55
 v_accvgpr_write_b32 a155, v54
 v_cvt_pk_f16_f32 v60, v60, v61
 v_accvgpr_write_b32 a162, v60
 v_cvt_pk_f16_f32 v62, v62, v63
 v_accvgpr_write_b32 a163, v62
 s_waitcnt vmcnt(27)
 ds_write_b128 v251, v[208:211] offset:36864
 ds_write_b128 v251, v[212:215] offset:37888
 ds_write_b128 v251, v[216:219] offset:38912
 ds_read_b64_tr_b16 v[160:161], v250 offset:36864
 ds_read_b64_tr_b16 v[162:163], v250 offset:37248
 ds_read_b64_tr_b16 v[164:165], v250 offset:36896
 ds_read_b64_tr_b16 v[166:167], v250 offset:37280
 ds_read_b64_tr_b16 v[168:169], v250 offset:36928
 ds_read_b64_tr_b16 v[170:171], v250 offset:37312
 ds_read_b128 v[144:147], v23 offset:0
 ds_read_b128 v[148:151], v23 offset:1536
 s_waitcnt lgkmcnt(2)
 v_mfma_f32_16x16x32_bf16 v[40:43], v[136:139], v[64:67], 0
 s_add_u32 s22, s80, 0
 v_mfma_f32_16x16x32_bf16 v[48:51], v[136:139], v[88:91], 0
 buffer_load_dwordx4 v[232:235], v244, s[36:39], s22 offen
 v_mfma_f32_16x16x32_bf16 v[56:59], v[136:139], v[112:115], 0
 buffer_load_dwordx4 v[236:239], v245, s[36:39], s22 offen
 v_mfma_f32_16x16x32_bf16 v[44:47], v[140:143], v[64:67], 0
 buffer_load_dwordx4 v[240:243], v246, s[36:39], s22 offen
 v_mfma_f32_16x16x32_bf16 v[52:55], v[140:143], v[88:91], 0
 v_lshlrev_b32 v27, 16, v160
 v_and_b32 v160, 0xffff0000, v160
 v_mfma_f32_16x16x32_bf16 v[60:63], v[140:143], v[112:115], 0
 v_cvt_pk_f16_f32 v160, v27, v160
 v_accvgpr_write_b32 a72, v160
 ds_read_b128 v[136:139], v22 offset:128
 ds_read_b128 v[140:143], v22 offset:1664
 s_waitcnt lgkmcnt(2)
 v_mfma_f32_16x16x32_bf16 v[40:43], v[144:147], v[68:71], v[40:43]
 v_lshlrev_b32 v27, 16, v161
 v_and_b32 v161, 0xffff0000, v161
 v_mfma_f32_16x16x32_bf16 v[48:51], v[144:147], v[92:95], v[48:51]
 v_cvt_pk_f16_f32 v161, v27, v161
 v_accvgpr_write_b32 a73, v161
 v_mfma_f32_16x16x32_bf16 v[56:59], v[144:147], v[116:119], v[56:59]
 v_lshlrev_b32 v27, 16, v162
 v_and_b32 v162, 0xffff0000, v162
 v_mfma_f32_16x16x32_bf16 v[44:47], v[148:151], v[68:71], v[44:47]
 v_cvt_pk_f16_f32 v162, v27, v162
 v_accvgpr_write_b32 a74, v162
 v_mfma_f32_16x16x32_bf16 v[52:55], v[148:151], v[92:95], v[52:55]
 v_lshlrev_b32 v27, 16, v163
 v_and_b32 v163, 0xffff0000, v163
 v_mfma_f32_16x16x32_bf16 v[60:63], v[148:151], v[116:119], v[60:63]
 v_cvt_pk_f16_f32 v163, v27, v163
 v_accvgpr_write_b32 a75, v163
 ds_read_b128 v[144:147], v23 offset:128
 ds_read_b128 v[148:151], v23 offset:1664
 s_waitcnt lgkmcnt(2)
 v_mfma_f32_16x16x32_bf16 v[40:43], v[136:139], v[72:75], v[40:43]
 v_lshlrev_b32 v27, 16, v164
 v_and_b32 v164, 0xffff0000, v164
 v_mfma_f32_16x16x32_bf16 v[48:51], v[136:139], v[96:99], v[48:51]
 v_cvt_pk_f16_f32 v164, v27, v164
 v_accvgpr_write_b32 a92, v164
 v_mfma_f32_16x16x32_bf16 v[56:59], v[136:139], v[120:123], v[56:59]
 v_lshlrev_b32 v27, 16, v165
 v_and_b32 v165, 0xffff0000, v165
 v_mfma_f32_16x16x32_bf16 v[44:47], v[140:143], v[72:75], v[44:47]
 v_cvt_pk_f16_f32 v165, v27, v165
 v_accvgpr_write_b32 a93, v165
 v_mfma_f32_16x16x32_bf16 v[52:55], v[140:143], v[96:99], v[52:55]
 v_lshlrev_b32 v27, 16, v166
 v_and_b32 v166, 0xffff0000, v166
 v_mfma_f32_16x16x32_bf16 v[60:63], v[140:143], v[120:123], v[60:63]
 v_cvt_pk_f16_f32 v166, v27, v166
 v_accvgpr_write_b32 a94, v166
 ds_read_b128 v[136:139], v22 offset:256
 ds_read_b128 v[140:143], v22 offset:1792
 s_waitcnt lgkmcnt(2)
 v_mfma_f32_16x16x32_bf16 v[40:43], v[144:147], v[76:79], v[40:43]
 v_lshlrev_b32 v27, 16, v167
 v_and_b32 v167, 0xffff0000, v167
 v_mfma_f32_16x16x32_bf16 v[48:51], v[144:147], v[100:103], v[48:51]
 v_cvt_pk_f16_f32 v167, v27, v167
 v_accvgpr_write_b32 a95, v167
 v_mfma_f32_16x16x32_bf16 v[56:59], v[144:147], v[124:127], v[56:59]
 v_lshlrev_b32 v27, 16, v168
 v_and_b32 v168, 0xffff0000, v168
 v_mfma_f32_16x16x32_bf16 v[44:47], v[148:151], v[76:79], v[44:47]
 v_cvt_pk_f16_f32 v168, v27, v168
 v_accvgpr_write_b32 a112, v168
 v_mfma_f32_16x16x32_bf16 v[52:55], v[148:151], v[100:103], v[52:55]
 v_lshlrev_b32 v27, 16, v169
 v_and_b32 v169, 0xffff0000, v169
 v_mfma_f32_16x16x32_bf16 v[60:63], v[148:151], v[124:127], v[60:63]
 v_cvt_pk_f16_f32 v169, v27, v169
 v_accvgpr_write_b32 a113, v169
 ds_read_b128 v[144:147], v23 offset:256
 ds_read_b128 v[148:151], v23 offset:1792
 s_waitcnt lgkmcnt(2)
 v_mfma_f32_16x16x32_bf16 v[40:43], v[136:139], v[80:83], v[40:43]
 v_lshlrev_b32 v27, 16, v170
 v_and_b32 v170, 0xffff0000, v170
 v_mfma_f32_16x16x32_bf16 v[48:51], v[136:139], v[104:107], v[48:51]
 v_cvt_pk_f16_f32 v170, v27, v170
 v_accvgpr_write_b32 a114, v170
 v_mfma_f32_16x16x32_bf16 v[56:59], v[136:139], v[128:131], v[56:59]
 v_lshlrev_b32 v27, 16, v171
 v_and_b32 v171, 0xffff0000, v171
 v_mfma_f32_16x16x32_bf16 v[44:47], v[140:143], v[80:83], v[44:47]
 v_cvt_pk_f16_f32 v171, v27, v171
 v_accvgpr_write_b32 a115, v171
 v_mfma_f32_16x16x32_bf16 v[52:55], v[140:143], v[104:107], v[52:55]
 v_mfma_f32_16x16x32_bf16 v[60:63], v[140:143], v[128:131], v[60:63]
 s_waitcnt vmcnt(18)
 ds_read_b128 v[136:139], v22 offset:12288
 ds_read_b128 v[140:143], v22 offset:13824
 s_waitcnt lgkmcnt(2)
 v_mfma_f32_16x16x32_bf16 v[40:43], v[144:147], v[84:87], v[40:43]
 s_add_u32 m0, s81, 0
 s_add_u32 s21, s88, 2064384
 v_mfma_f32_16x16x32_bf16 v[48:51], v[144:147], v[108:111], v[48:51]
 buffer_load_dwordx4 v28, s[12:15], s21 offen offset:0 lds
 buffer_load_dwordx4 v29, s[12:15], s21 offen offset:1024 lds
 v_mfma_f32_16x16x32_bf16 v[56:59], v[144:147], v[132:135], v[56:59]
 buffer_load_dwordx4 v30, s[12:15], s21 offen offset:2048 lds
 s_add_u32 m0, s81, 3072
 v_mfma_f32_16x16x32_bf16 v[44:47], v[148:151], v[84:87], v[44:47]
 s_add_u32 s21, s88, 2113536
 buffer_load_dwordx4 v31, s[12:15], s21 offen offset:0 lds
 v_mfma_f32_16x16x32_bf16 v[52:55], v[148:151], v[108:111], v[52:55]
 buffer_load_dwordx4 v32, s[12:15], s21 offen offset:1024 lds
 buffer_load_dwordx4 v33, s[12:15], s21 offen offset:2048 lds
 v_mfma_f32_16x16x32_bf16 v[60:63], v[148:151], v[132:135], v[60:63]
 s_add_u32 m0, s81, 6144
 s_add_u32 s21, s88, 2555904
 s_nop 1
 v_cvt_pk_f16_f32 v40, v40, v41
 v_accvgpr_write_b32 a148, v40
 buffer_load_dwordx4 v34, s[12:15], s21 offen offset:0 lds
 v_cvt_pk_f16_f32 v42, v42, v43
 v_accvgpr_write_b32 a149, v42
 buffer_load_dwordx4 v35, s[12:15], s21 offen offset:1024 lds
 v_cvt_pk_f16_f32 v48, v48, v49
 v_accvgpr_write_b32 a156, v48
 buffer_load_dwordx4 v36, s[12:15], s21 offen offset:2048 lds
 v_cvt_pk_f16_f32 v50, v50, v51
 v_accvgpr_write_b32 a157, v50
 s_add_u32 m0, s81, 9216
 v_cvt_pk_f16_f32 v56, v56, v57
 v_accvgpr_write_b32 a164, v56
 s_add_u32 s21, s88, 2605056
 v_cvt_pk_f16_f32 v58, v58, v59
 v_accvgpr_write_b32 a165, v58
 buffer_load_dwordx4 v37, s[12:15], s21 offen offset:0 lds
 s_nop 3
 v_cvt_pk_f16_f32 v44, v44, v45
 v_accvgpr_write_b32 a150, v44
 buffer_load_dwordx4 v38, s[12:15], s21 offen offset:1024 lds
 v_cvt_pk_f16_f32 v46, v46, v47
 v_accvgpr_write_b32 a151, v46
 buffer_load_dwordx4 v39, s[12:15], s21 offen offset:2048 lds
 v_cvt_pk_f16_f32 v52, v52, v53
 v_accvgpr_write_b32 a158, v52
 v_cvt_pk_f16_f32 v54, v54, v55
 v_accvgpr_write_b32 a159, v54
 v_cvt_pk_f16_f32 v60, v60, v61
 v_accvgpr_write_b32 a166, v60
 v_cvt_pk_f16_f32 v62, v62, v63
 v_accvgpr_write_b32 a167, v62
 s_waitcnt vmcnt(27)
 ds_write_b128 v251, v[220:223] offset:36864
 ds_write_b128 v251, v[224:227] offset:37888
 ds_write_b128 v251, v[228:231] offset:38912
 ds_read_b64_tr_b16 v[160:161], v250 offset:36864
 ds_read_b64_tr_b16 v[162:163], v250 offset:37248
 ds_read_b64_tr_b16 v[164:165], v250 offset:36896
 ds_read_b64_tr_b16 v[166:167], v250 offset:37280
 ds_read_b64_tr_b16 v[168:169], v250 offset:36928
 ds_read_b64_tr_b16 v[170:171], v250 offset:37312
 ds_read_b128 v[144:147], v23 offset:12288
 ds_read_b128 v[148:151], v23 offset:13824
 s_waitcnt lgkmcnt(2)
 v_mfma_f32_16x16x32_bf16 v[40:43], v[136:139], v[64:67], 0
 s_add_u32 s22, s80, 983040
 v_mfma_f32_16x16x32_bf16 v[48:51], v[136:139], v[88:91], 0
 buffer_load_dwordx4 v[172:175], v244, s[36:39], s22 offen
 v_mfma_f32_16x16x32_bf16 v[56:59], v[136:139], v[112:115], 0
 buffer_load_dwordx4 v[176:179], v245, s[36:39], s22 offen
 v_mfma_f32_16x16x32_bf16 v[44:47], v[140:143], v[64:67], 0
 buffer_load_dwordx4 v[180:183], v246, s[36:39], s22 offen
 v_mfma_f32_16x16x32_bf16 v[52:55], v[140:143], v[88:91], 0
 v_lshlrev_b32 v27, 16, v160
 v_and_b32 v160, 0xffff0000, v160
 v_mfma_f32_16x16x32_bf16 v[60:63], v[140:143], v[112:115], 0
 v_cvt_pk_f16_f32 v160, v27, v160
 v_accvgpr_write_b32 a76, v160
 ds_read_b128 v[136:139], v22 offset:12416
 ds_read_b128 v[140:143], v22 offset:13952
 s_waitcnt lgkmcnt(2)
 v_mfma_f32_16x16x32_bf16 v[40:43], v[144:147], v[68:71], v[40:43]
 v_lshlrev_b32 v27, 16, v161
 v_and_b32 v161, 0xffff0000, v161
 v_mfma_f32_16x16x32_bf16 v[48:51], v[144:147], v[92:95], v[48:51]
 v_cvt_pk_f16_f32 v161, v27, v161
 v_accvgpr_write_b32 a77, v161
 v_mfma_f32_16x16x32_bf16 v[56:59], v[144:147], v[116:119], v[56:59]
 v_lshlrev_b32 v27, 16, v162
 v_and_b32 v162, 0xffff0000, v162
 v_mfma_f32_16x16x32_bf16 v[44:47], v[148:151], v[68:71], v[44:47]
 v_cvt_pk_f16_f32 v162, v27, v162
 v_accvgpr_write_b32 a78, v162
 v_mfma_f32_16x16x32_bf16 v[52:55], v[148:151], v[92:95], v[52:55]
 v_lshlrev_b32 v27, 16, v163
 v_and_b32 v163, 0xffff0000, v163
 v_mfma_f32_16x16x32_bf16 v[60:63], v[148:151], v[116:119], v[60:63]
 v_cvt_pk_f16_f32 v163, v27, v163
 v_accvgpr_write_b32 a79, v163
 ds_read_b128 v[144:147], v23 offset:12416
 ds_read_b128 v[148:151], v23 offset:13952
 s_waitcnt lgkmcnt(2)
 v_mfma_f32_16x16x32_bf16 v[40:43], v[136:139], v[72:75], v[40:43]
 v_lshlrev_b32 v27, 16, v164
 v_and_b32 v164, 0xffff0000, v164
 v_mfma_f32_16x16x32_bf16 v[48:51], v[136:139], v[96:99], v[48:51]
 v_cvt_pk_f16_f32 v164, v27, v164
 v_accvgpr_write_b32 a96, v164
 v_mfma_f32_16x16x32_bf16 v[56:59], v[136:139], v[120:123], v[56:59]
 v_lshlrev_b32 v27, 16, v165
 v_and_b32 v165, 0xffff0000, v165
 v_mfma_f32_16x16x32_bf16 v[44:47], v[140:143], v[72:75], v[44:47]
 v_cvt_pk_f16_f32 v165, v27, v165
 v_accvgpr_write_b32 a97, v165
 v_mfma_f32_16x16x32_bf16 v[52:55], v[140:143], v[96:99], v[52:55]
 v_lshlrev_b32 v27, 16, v166
 v_and_b32 v166, 0xffff0000, v166
 v_mfma_f32_16x16x32_bf16 v[60:63], v[140:143], v[120:123], v[60:63]
 v_cvt_pk_f16_f32 v166, v27, v166
 v_accvgpr_write_b32 a98, v166
 ds_read_b128 v[136:139], v22 offset:12544
 ds_read_b128 v[140:143], v22 offset:14080
 s_waitcnt lgkmcnt(2)
 v_mfma_f32_16x16x32_bf16 v[40:43], v[144:147], v[76:79], v[40:43]
 v_lshlrev_b32 v27, 16, v167
 v_and_b32 v167, 0xffff0000, v167
 v_mfma_f32_16x16x32_bf16 v[48:51], v[144:147], v[100:103], v[48:51]
 v_cvt_pk_f16_f32 v167, v27, v167
 v_accvgpr_write_b32 a99, v167
 v_mfma_f32_16x16x32_bf16 v[56:59], v[144:147], v[124:127], v[56:59]
 v_lshlrev_b32 v27, 16, v168
 v_and_b32 v168, 0xffff0000, v168
 v_mfma_f32_16x16x32_bf16 v[44:47], v[148:151], v[76:79], v[44:47]
 v_cvt_pk_f16_f32 v168, v27, v168
 v_accvgpr_write_b32 a116, v168
 v_mfma_f32_16x16x32_bf16 v[52:55], v[148:151], v[100:103], v[52:55]
 v_lshlrev_b32 v27, 16, v169
 v_and_b32 v169, 0xffff0000, v169
 v_mfma_f32_16x16x32_bf16 v[60:63], v[148:151], v[124:127], v[60:63]
 v_cvt_pk_f16_f32 v169, v27, v169
 v_accvgpr_write_b32 a117, v169
 ds_read_b128 v[144:147], v23 offset:12544
 ds_read_b128 v[148:151], v23 offset:14080
 s_waitcnt lgkmcnt(2)
 v_mfma_f32_16x16x32_bf16 v[40:43], v[136:139], v[80:83], v[40:43]
 v_lshlrev_b32 v27, 16, v170
 v_and_b32 v170, 0xffff0000, v170
 v_mfma_f32_16x16x32_bf16 v[48:51], v[136:139], v[104:107], v[48:51]
 v_cvt_pk_f16_f32 v170, v27, v170
 v_accvgpr_write_b32 a118, v170
 v_mfma_f32_16x16x32_bf16 v[56:59], v[136:139], v[128:131], v[56:59]
 v_lshlrev_b32 v27, 16, v171
 v_and_b32 v171, 0xffff0000, v171
 v_mfma_f32_16x16x32_bf16 v[44:47], v[140:143], v[80:83], v[44:47]
 v_cvt_pk_f16_f32 v171, v27, v171
 v_accvgpr_write_b32 a119, v171
 v_mfma_f32_16x16x32_bf16 v[52:55], v[140:143], v[104:107], v[52:55]
 v_mfma_f32_16x16x32_bf16 v[60:63], v[140:143], v[128:131], v[60:63]
 s_waitcnt vmcnt(18)
 ds_read_b128 v[136:139], v22 offset:24576
 ds_read_b128 v[140:143], v22 offset:26112
 s_waitcnt lgkmcnt(2)
 v_mfma_f32_16x16x32_bf16 v[40:43], v[144:147], v[84:87], v[40:43]
 s_add_u32 m0, s81, 12288
 s_add_u32 s21, s88, 3047424
 v_mfma_f32_16x16x32_bf16 v[48:51], v[144:147], v[108:111], v[48:51]
 buffer_load_dwordx4 v28, s[12:15], s21 offen offset:0 lds
 buffer_load_dwordx4 v29, s[12:15], s21 offen offset:1024 lds
 v_mfma_f32_16x16x32_bf16 v[56:59], v[144:147], v[132:135], v[56:59]
 buffer_load_dwordx4 v30, s[12:15], s21 offen offset:2048 lds
 s_add_u32 m0, s81, 15360
 v_mfma_f32_16x16x32_bf16 v[44:47], v[148:151], v[84:87], v[44:47]
 s_add_u32 s21, s88, 3096576
 buffer_load_dwordx4 v31, s[12:15], s21 offen offset:0 lds
 v_mfma_f32_16x16x32_bf16 v[52:55], v[148:151], v[108:111], v[52:55]
 buffer_load_dwordx4 v32, s[12:15], s21 offen offset:1024 lds
 buffer_load_dwordx4 v33, s[12:15], s21 offen offset:2048 lds
 v_mfma_f32_16x16x32_bf16 v[60:63], v[148:151], v[132:135], v[60:63]
 s_add_u32 m0, s81, 18432
 s_add_u32 s21, s88, 3538944
 s_nop 1
 v_cvt_pk_f16_f32 v40, v40, v41
 v_accvgpr_write_b32 a168, v40
 buffer_load_dwordx4 v34, s[12:15], s21 offen offset:0 lds
 v_cvt_pk_f16_f32 v42, v42, v43
 v_accvgpr_write_b32 a169, v42
 buffer_load_dwordx4 v35, s[12:15], s21 offen offset:1024 lds
 v_cvt_pk_f16_f32 v48, v48, v49
 v_accvgpr_write_b32 a176, v48
 buffer_load_dwordx4 v36, s[12:15], s21 offen offset:2048 lds
 v_cvt_pk_f16_f32 v50, v50, v51
 v_accvgpr_write_b32 a177, v50
 s_add_u32 m0, s81, 21504
 v_cvt_pk_f16_f32 v56, v56, v57
 v_accvgpr_write_b32 a184, v56
 s_add_u32 s21, s88, 3588096
 v_cvt_pk_f16_f32 v58, v58, v59
 v_accvgpr_write_b32 a185, v58
 buffer_load_dwordx4 v37, s[12:15], s21 offen offset:0 lds
 s_nop 3
 v_cvt_pk_f16_f32 v44, v44, v45
 v_accvgpr_write_b32 a170, v44
 buffer_load_dwordx4 v38, s[12:15], s21 offen offset:1024 lds
 v_cvt_pk_f16_f32 v46, v46, v47
 v_accvgpr_write_b32 a171, v46
 buffer_load_dwordx4 v39, s[12:15], s21 offen offset:2048 lds
 v_cvt_pk_f16_f32 v52, v52, v53
 v_accvgpr_write_b32 a178, v52
 v_cvt_pk_f16_f32 v54, v54, v55
 v_accvgpr_write_b32 a179, v54
 v_cvt_pk_f16_f32 v60, v60, v61
 v_accvgpr_write_b32 a186, v60
 v_cvt_pk_f16_f32 v62, v62, v63
 v_accvgpr_write_b32 a187, v62
 s_waitcnt vmcnt(27)
 ds_write_b128 v251, v[232:235] offset:36864
 ds_write_b128 v251, v[236:239] offset:37888
 ds_write_b128 v251, v[240:243] offset:38912
 ds_read_b64_tr_b16 v[160:161], v250 offset:36864
 ds_read_b64_tr_b16 v[162:163], v250 offset:37248
 ds_read_b64_tr_b16 v[164:165], v250 offset:36896
 ds_read_b64_tr_b16 v[166:167], v250 offset:37280
 ds_read_b64_tr_b16 v[168:169], v250 offset:36928
 ds_read_b64_tr_b16 v[170:171], v250 offset:37312
 ds_read_b128 v[144:147], v23 offset:24576
 ds_read_b128 v[148:151], v23 offset:26112
 s_waitcnt lgkmcnt(2)
 v_mfma_f32_16x16x32_bf16 v[40:43], v[136:139], v[64:67], 0
 s_add_u32 s22, s80, 98304
 v_mfma_f32_16x16x32_bf16 v[48:51], v[136:139], v[88:91], 0
 buffer_load_dwordx4 v[184:187], v244, s[36:39], s22 offen
 v_mfma_f32_16x16x32_bf16 v[56:59], v[136:139], v[112:115], 0
 buffer_load_dwordx4 v[188:191], v245, s[36:39], s22 offen
 v_mfma_f32_16x16x32_bf16 v[44:47], v[140:143], v[64:67], 0
 buffer_load_dwordx4 v[192:195], v246, s[36:39], s22 offen
 v_mfma_f32_16x16x32_bf16 v[52:55], v[140:143], v[88:91], 0
 v_lshlrev_b32 v27, 16, v160
 v_and_b32 v160, 0xffff0000, v160
 v_mfma_f32_16x16x32_bf16 v[60:63], v[140:143], v[112:115], 0
 v_cvt_pk_f16_f32 v160, v27, v160
 v_accvgpr_write_b32 a0, v160
 ds_read_b128 v[136:139], v22 offset:24704
 ds_read_b128 v[140:143], v22 offset:26240
 s_waitcnt lgkmcnt(2)
 v_mfma_f32_16x16x32_bf16 v[40:43], v[144:147], v[68:71], v[40:43]
 v_lshlrev_b32 v27, 16, v161
 v_and_b32 v161, 0xffff0000, v161
 v_mfma_f32_16x16x32_bf16 v[48:51], v[144:147], v[92:95], v[48:51]
 v_cvt_pk_f16_f32 v161, v27, v161
 v_accvgpr_write_b32 a1, v161
 v_mfma_f32_16x16x32_bf16 v[56:59], v[144:147], v[116:119], v[56:59]
 v_lshlrev_b32 v27, 16, v162
 v_and_b32 v162, 0xffff0000, v162
 v_mfma_f32_16x16x32_bf16 v[44:47], v[148:151], v[68:71], v[44:47]
 v_cvt_pk_f16_f32 v162, v27, v162
 v_accvgpr_write_b32 a2, v162
 v_mfma_f32_16x16x32_bf16 v[52:55], v[148:151], v[92:95], v[52:55]
 v_lshlrev_b32 v27, 16, v163
 v_and_b32 v163, 0xffff0000, v163
 v_mfma_f32_16x16x32_bf16 v[60:63], v[148:151], v[116:119], v[60:63]
 v_cvt_pk_f16_f32 v163, v27, v163
 v_accvgpr_write_b32 a3, v163
 ds_read_b128 v[144:147], v23 offset:24704
 ds_read_b128 v[148:151], v23 offset:26240
 s_waitcnt lgkmcnt(2)
 v_mfma_f32_16x16x32_bf16 v[40:43], v[136:139], v[72:75], v[40:43]
 v_lshlrev_b32 v27, 16, v164
 v_and_b32 v164, 0xffff0000, v164
 v_mfma_f32_16x16x32_bf16 v[48:51], v[136:139], v[96:99], v[48:51]
 v_cvt_pk_f16_f32 v164, v27, v164
 v_accvgpr_write_b32 a20, v164
 v_mfma_f32_16x16x32_bf16 v[56:59], v[136:139], v[120:123], v[56:59]
 v_lshlrev_b32 v27, 16, v165
 v_and_b32 v165, 0xffff0000, v165
 v_mfma_f32_16x16x32_bf16 v[44:47], v[140:143], v[72:75], v[44:47]
 v_cvt_pk_f16_f32 v165, v27, v165
 v_accvgpr_write_b32 a21, v165
 v_mfma_f32_16x16x32_bf16 v[52:55], v[140:143], v[96:99], v[52:55]
 v_lshlrev_b32 v27, 16, v166
 v_and_b32 v166, 0xffff0000, v166
 v_mfma_f32_16x16x32_bf16 v[60:63], v[140:143], v[120:123], v[60:63]
 v_cvt_pk_f16_f32 v166, v27, v166
 v_accvgpr_write_b32 a22, v166
 ds_read_b128 v[136:139], v22 offset:24832
 ds_read_b128 v[140:143], v22 offset:26368
 s_waitcnt lgkmcnt(2)
 v_mfma_f32_16x16x32_bf16 v[40:43], v[144:147], v[76:79], v[40:43]
 v_lshlrev_b32 v27, 16, v167
 v_and_b32 v167, 0xffff0000, v167
 v_mfma_f32_16x16x32_bf16 v[48:51], v[144:147], v[100:103], v[48:51]
 v_cvt_pk_f16_f32 v167, v27, v167
 v_accvgpr_write_b32 a23, v167
 v_mfma_f32_16x16x32_bf16 v[56:59], v[144:147], v[124:127], v[56:59]
 v_lshlrev_b32 v27, 16, v168
 v_and_b32 v168, 0xffff0000, v168
 v_mfma_f32_16x16x32_bf16 v[44:47], v[148:151], v[76:79], v[44:47]
 v_cvt_pk_f16_f32 v168, v27, v168
 v_accvgpr_write_b32 a40, v168
 v_mfma_f32_16x16x32_bf16 v[52:55], v[148:151], v[100:103], v[52:55]
 v_lshlrev_b32 v27, 16, v169
 v_and_b32 v169, 0xffff0000, v169
 v_mfma_f32_16x16x32_bf16 v[60:63], v[148:151], v[124:127], v[60:63]
 v_cvt_pk_f16_f32 v169, v27, v169
 v_accvgpr_write_b32 a41, v169
 ds_read_b128 v[144:147], v23 offset:24832
 ds_read_b128 v[148:151], v23 offset:26368
 s_waitcnt lgkmcnt(2)
 v_mfma_f32_16x16x32_bf16 v[40:43], v[136:139], v[80:83], v[40:43]
 v_lshlrev_b32 v27, 16, v170
 v_and_b32 v170, 0xffff0000, v170
 v_mfma_f32_16x16x32_bf16 v[48:51], v[136:139], v[104:107], v[48:51]
 v_cvt_pk_f16_f32 v170, v27, v170
 v_accvgpr_write_b32 a42, v170
 v_mfma_f32_16x16x32_bf16 v[56:59], v[136:139], v[128:131], v[56:59]
 v_lshlrev_b32 v27, 16, v171
 v_and_b32 v171, 0xffff0000, v171
 v_mfma_f32_16x16x32_bf16 v[44:47], v[140:143], v[80:83], v[44:47]
 v_cvt_pk_f16_f32 v171, v27, v171
 v_accvgpr_write_b32 a43, v171
 v_mfma_f32_16x16x32_bf16 v[52:55], v[140:143], v[104:107], v[52:55]
 v_mfma_f32_16x16x32_bf16 v[60:63], v[140:143], v[128:131], v[60:63]
 s_waitcnt vmcnt(18)
 ds_read_b128 v[136:139], v22 offset:0
 ds_read_b128 v[140:143], v22 offset:1536
 s_waitcnt lgkmcnt(2)
 v_mfma_f32_16x16x32_bf16 v[40:43], v[144:147], v[84:87], v[40:43]
 s_add_u32 m0, s81, 24576
 s_add_u32 s21, s88, 3932160
 v_mfma_f32_16x16x32_bf16 v[48:51], v[144:147], v[108:111], v[48:51]
 buffer_load_dwordx4 v28, s[12:15], s21 offen offset:0 lds
 buffer_load_dwordx4 v29, s[12:15], s21 offen offset:1024 lds
 v_mfma_f32_16x16x32_bf16 v[56:59], v[144:147], v[132:135], v[56:59]
 buffer_load_dwordx4 v30, s[12:15], s21 offen offset:2048 lds
 s_add_u32 m0, s81, 27648
 v_mfma_f32_16x16x32_bf16 v[44:47], v[148:151], v[84:87], v[44:47]
 s_add_u32 s21, s88, 3981312
 buffer_load_dwordx4 v31, s[12:15], s21 offen offset:0 lds
 v_mfma_f32_16x16x32_bf16 v[52:55], v[148:151], v[108:111], v[52:55]
 buffer_load_dwordx4 v32, s[12:15], s21 offen offset:1024 lds
 buffer_load_dwordx4 v33, s[12:15], s21 offen offset:2048 lds
 v_mfma_f32_16x16x32_bf16 v[60:63], v[148:151], v[132:135], v[60:63]
 s_add_u32 m0, s81, 30720
 s_add_u32 s21, s88, 4423680
 s_nop 1
 v_cvt_pk_f16_f32 v40, v40, v41
 v_accvgpr_write_b32 a172, v40
 buffer_load_dwordx4 v34, s[12:15], s21 offen offset:0 lds
 v_cvt_pk_f16_f32 v42, v42, v43
 v_accvgpr_write_b32 a173, v42
 buffer_load_dwordx4 v35, s[12:15], s21 offen offset:1024 lds
 v_cvt_pk_f16_f32 v48, v48, v49
 v_accvgpr_write_b32 a180, v48
 buffer_load_dwordx4 v36, s[12:15], s21 offen offset:2048 lds
 v_cvt_pk_f16_f32 v50, v50, v51
 v_accvgpr_write_b32 a181, v50
 s_add_u32 m0, s81, 33792
 v_cvt_pk_f16_f32 v56, v56, v57
 v_accvgpr_write_b32 a188, v56
 s_add_u32 s21, s88, 4472832
 v_cvt_pk_f16_f32 v58, v58, v59
 v_accvgpr_write_b32 a189, v58
 buffer_load_dwordx4 v37, s[12:15], s21 offen offset:0 lds
 s_nop 3
 v_cvt_pk_f16_f32 v44, v44, v45
 v_accvgpr_write_b32 a174, v44
 buffer_load_dwordx4 v38, s[12:15], s21 offen offset:1024 lds
 v_cvt_pk_f16_f32 v46, v46, v47
 v_accvgpr_write_b32 a175, v46
 buffer_load_dwordx4 v39, s[12:15], s21 offen offset:2048 lds
 v_cvt_pk_f16_f32 v52, v52, v53
 v_accvgpr_write_b32 a182, v52
 v_cvt_pk_f16_f32 v54, v54, v55
 v_accvgpr_write_b32 a183, v54
 v_cvt_pk_f16_f32 v60, v60, v61
 v_accvgpr_write_b32 a190, v60
 v_cvt_pk_f16_f32 v62, v62, v63
 v_accvgpr_write_b32 a191, v62
 s_waitcnt vmcnt(27)
 ds_write_b128 v251, v[172:175] offset:36864
 ds_write_b128 v251, v[176:179] offset:37888
 ds_write_b128 v251, v[180:183] offset:38912
 ds_read_b64_tr_b16 v[160:161], v250 offset:36864
 ds_read_b64_tr_b16 v[162:163], v250 offset:37248
 ds_read_b64_tr_b16 v[164:165], v250 offset:36896
 ds_read_b64_tr_b16 v[166:167], v250 offset:37280
 ds_read_b64_tr_b16 v[168:169], v250 offset:36928
 ds_read_b64_tr_b16 v[170:171], v250 offset:37312
 ds_read_b128 v[144:147], v23 offset:0
 ds_read_b128 v[148:151], v23 offset:1536
 s_waitcnt lgkmcnt(2)
 v_mfma_f32_16x16x32_bf16 v[40:43], v[136:139], v[64:67], 0
 s_add_u32 s22, s80, 1081344
 v_mfma_f32_16x16x32_bf16 v[48:51], v[136:139], v[88:91], 0
 buffer_load_dwordx4 v[196:199], v244, s[36:39], s22 offen
 v_mfma_f32_16x16x32_bf16 v[56:59], v[136:139], v[112:115], 0
 buffer_load_dwordx4 v[200:203], v245, s[36:39], s22 offen
 v_mfma_f32_16x16x32_bf16 v[44:47], v[140:143], v[64:67], 0
 buffer_load_dwordx4 v[204:207], v246, s[36:39], s22 offen
 v_mfma_f32_16x16x32_bf16 v[52:55], v[140:143], v[88:91], 0
 v_lshlrev_b32 v27, 16, v160
 v_and_b32 v160, 0xffff0000, v160
 v_mfma_f32_16x16x32_bf16 v[60:63], v[140:143], v[112:115], 0
 v_cvt_pk_f16_f32 v160, v27, v160
 v_accvgpr_write_b32 a4, v160
 ds_read_b128 v[136:139], v22 offset:128
 ds_read_b128 v[140:143], v22 offset:1664
 s_waitcnt lgkmcnt(2)
 v_mfma_f32_16x16x32_bf16 v[40:43], v[144:147], v[68:71], v[40:43]
 v_lshlrev_b32 v27, 16, v161
 v_and_b32 v161, 0xffff0000, v161
 v_mfma_f32_16x16x32_bf16 v[48:51], v[144:147], v[92:95], v[48:51]
 v_cvt_pk_f16_f32 v161, v27, v161
 v_accvgpr_write_b32 a5, v161
 v_mfma_f32_16x16x32_bf16 v[56:59], v[144:147], v[116:119], v[56:59]
 v_lshlrev_b32 v27, 16, v162
 v_and_b32 v162, 0xffff0000, v162
 v_mfma_f32_16x16x32_bf16 v[44:47], v[148:151], v[68:71], v[44:47]
 v_cvt_pk_f16_f32 v162, v27, v162
 v_accvgpr_write_b32 a6, v162
 v_mfma_f32_16x16x32_bf16 v[52:55], v[148:151], v[92:95], v[52:55]
 v_lshlrev_b32 v27, 16, v163
 v_and_b32 v163, 0xffff0000, v163
 v_mfma_f32_16x16x32_bf16 v[60:63], v[148:151], v[116:119], v[60:63]
 v_cvt_pk_f16_f32 v163, v27, v163
 v_accvgpr_write_b32 a7, v163
 ds_read_b128 v[144:147], v23 offset:128
 ds_read_b128 v[148:151], v23 offset:1664
 s_waitcnt lgkmcnt(2)
 v_mfma_f32_16x16x32_bf16 v[40:43], v[136:139], v[72:75], v[40:43]
 v_lshlrev_b32 v27, 16, v164
 v_and_b32 v164, 0xffff0000, v164
 v_mfma_f32_16x16x32_bf16 v[48:51], v[136:139], v[96:99], v[48:51]
 v_cvt_pk_f16_f32 v164, v27, v164
 v_accvgpr_write_b32 a24, v164
 v_mfma_f32_16x16x32_bf16 v[56:59], v[136:139], v[120:123], v[56:59]
 v_lshlrev_b32 v27, 16, v165
 v_and_b32 v165, 0xffff0000, v165
 v_mfma_f32_16x16x32_bf16 v[44:47], v[140:143], v[72:75], v[44:47]
 v_cvt_pk_f16_f32 v165, v27, v165
 v_accvgpr_write_b32 a25, v165
 v_mfma_f32_16x16x32_bf16 v[52:55], v[140:143], v[96:99], v[52:55]
 v_lshlrev_b32 v27, 16, v166
 v_and_b32 v166, 0xffff0000, v166
 v_mfma_f32_16x16x32_bf16 v[60:63], v[140:143], v[120:123], v[60:63]
 v_cvt_pk_f16_f32 v166, v27, v166
 v_accvgpr_write_b32 a26, v166
 ds_read_b128 v[136:139], v22 offset:256
 ds_read_b128 v[140:143], v22 offset:1792
 s_waitcnt lgkmcnt(2)
 v_mfma_f32_16x16x32_bf16 v[40:43], v[144:147], v[76:79], v[40:43]
 v_lshlrev_b32 v27, 16, v167
 v_and_b32 v167, 0xffff0000, v167
 v_mfma_f32_16x16x32_bf16 v[48:51], v[144:147], v[100:103], v[48:51]
 v_cvt_pk_f16_f32 v167, v27, v167
 v_accvgpr_write_b32 a27, v167
 v_mfma_f32_16x16x32_bf16 v[56:59], v[144:147], v[124:127], v[56:59]
 v_lshlrev_b32 v27, 16, v168
 v_and_b32 v168, 0xffff0000, v168
 v_mfma_f32_16x16x32_bf16 v[44:47], v[148:151], v[76:79], v[44:47]
 v_cvt_pk_f16_f32 v168, v27, v168
 v_accvgpr_write_b32 a44, v168
 v_mfma_f32_16x16x32_bf16 v[52:55], v[148:151], v[100:103], v[52:55]
 v_lshlrev_b32 v27, 16, v169
 v_and_b32 v169, 0xffff0000, v169
 v_mfma_f32_16x16x32_bf16 v[60:63], v[148:151], v[124:127], v[60:63]
 v_cvt_pk_f16_f32 v169, v27, v169
 v_accvgpr_write_b32 a45, v169
 ds_read_b128 v[144:147], v23 offset:256
 ds_read_b128 v[148:151], v23 offset:1792
 s_waitcnt lgkmcnt(2)
 v_mfma_f32_16x16x32_bf16 v[40:43], v[136:139], v[80:83], v[40:43]
 v_lshlrev_b32 v27, 16, v170
 v_and_b32 v170, 0xffff0000, v170
 v_mfma_f32_16x16x32_bf16 v[48:51], v[136:139], v[104:107], v[48:51]
 v_cvt_pk_f16_f32 v170, v27, v170
 v_accvgpr_write_b32 a46, v170
 v_mfma_f32_16x16x32_bf16 v[56:59], v[136:139], v[128:131], v[56:59]
 v_lshlrev_b32 v27, 16, v171
 v_and_b32 v171, 0xffff0000, v171
 v_mfma_f32_16x16x32_bf16 v[44:47], v[140:143], v[80:83], v[44:47]
 v_cvt_pk_f16_f32 v171, v27, v171
 v_accvgpr_write_b32 a47, v171
 v_mfma_f32_16x16x32_bf16 v[52:55], v[140:143], v[104:107], v[52:55]
 v_mfma_f32_16x16x32_bf16 v[60:63], v[140:143], v[128:131], v[60:63]
 s_waitcnt vmcnt(18)
 ds_read_b128 v[136:139], v22 offset:12288
 ds_read_b128 v[140:143], v22 offset:13824
 s_waitcnt lgkmcnt(2)
 v_mfma_f32_16x16x32_bf16 v[40:43], v[144:147], v[84:87], v[40:43]
 s_add_u32 m0, s81, 0
 s_add_u32 s21, s88, 4915200
 v_mfma_f32_16x16x32_bf16 v[48:51], v[144:147], v[108:111], v[48:51]
 buffer_load_dwordx4 v28, s[12:15], s21 offen offset:0 lds
 buffer_load_dwordx4 v29, s[12:15], s21 offen offset:1024 lds
 v_mfma_f32_16x16x32_bf16 v[56:59], v[144:147], v[132:135], v[56:59]
 buffer_load_dwordx4 v30, s[12:15], s21 offen offset:2048 lds
 s_add_u32 m0, s81, 3072
 v_mfma_f32_16x16x32_bf16 v[44:47], v[148:151], v[84:87], v[44:47]
 s_add_u32 s21, s88, 4964352
 buffer_load_dwordx4 v31, s[12:15], s21 offen offset:0 lds
 v_mfma_f32_16x16x32_bf16 v[52:55], v[148:151], v[108:111], v[52:55]
 buffer_load_dwordx4 v32, s[12:15], s21 offen offset:1024 lds
 buffer_load_dwordx4 v33, s[12:15], s21 offen offset:2048 lds
 v_mfma_f32_16x16x32_bf16 v[60:63], v[148:151], v[132:135], v[60:63]
 s_add_u32 m0, s81, 6144
 s_add_u32 s21, s88, 5406720
 s_nop 1
 v_cvt_pk_f16_f32 v40, v40, v41
 v_accvgpr_write_b32 a192, v40
 buffer_load_dwordx4 v34, s[12:15], s21 offen offset:0 lds
 v_cvt_pk_f16_f32 v42, v42, v43
 v_accvgpr_write_b32 a193, v42
 buffer_load_dwordx4 v35, s[12:15], s21 offen offset:1024 lds
 v_cvt_pk_f16_f32 v48, v48, v49
 v_accvgpr_write_b32 a200, v48
 buffer_load_dwordx4 v36, s[12:15], s21 offen offset:2048 lds
 v_cvt_pk_f16_f32 v50, v50, v51
 v_accvgpr_write_b32 a201, v50
 s_add_u32 m0, s81, 9216
 v_cvt_pk_f16_f32 v56, v56, v57
 v_accvgpr_write_b32 a208, v56
 s_add_u32 s21, s88, 5455872
 v_cvt_pk_f16_f32 v58, v58, v59
 v_accvgpr_write_b32 a209, v58
 buffer_load_dwordx4 v37, s[12:15], s21 offen offset:0 lds
 s_nop 3
 v_cvt_pk_f16_f32 v44, v44, v45
 v_accvgpr_write_b32 a194, v44
 buffer_load_dwordx4 v38, s[12:15], s21 offen offset:1024 lds
 v_cvt_pk_f16_f32 v46, v46, v47
 v_accvgpr_write_b32 a195, v46
 buffer_load_dwordx4 v39, s[12:15], s21 offen offset:2048 lds
 v_cvt_pk_f16_f32 v52, v52, v53
 v_accvgpr_write_b32 a202, v52
 v_cvt_pk_f16_f32 v54, v54, v55
 v_accvgpr_write_b32 a203, v54
 v_cvt_pk_f16_f32 v60, v60, v61
 v_accvgpr_write_b32 a210, v60
 v_cvt_pk_f16_f32 v62, v62, v63
 v_accvgpr_write_b32 a211, v62
 s_waitcnt vmcnt(27)
 ds_write_b128 v251, v[184:187] offset:36864
 ds_write_b128 v251, v[188:191] offset:37888
 ds_write_b128 v251, v[192:195] offset:38912
 ds_read_b64_tr_b16 v[160:161], v250 offset:36864
 ds_read_b64_tr_b16 v[162:163], v250 offset:37248
 ds_read_b64_tr_b16 v[164:165], v250 offset:36896
 ds_read_b64_tr_b16 v[166:167], v250 offset:37280
 ds_read_b64_tr_b16 v[168:169], v250 offset:36928
 ds_read_b64_tr_b16 v[170:171], v250 offset:37312
 ds_read_b128 v[144:147], v23 offset:12288
 ds_read_b128 v[148:151], v23 offset:13824
 s_waitcnt lgkmcnt(2)
 v_mfma_f32_16x16x32_bf16 v[40:43], v[136:139], v[64:67], 0
 s_add_u32 s22, s80, 196608
 v_mfma_f32_16x16x32_bf16 v[48:51], v[136:139], v[88:91], 0
 buffer_load_dwordx4 v[208:211], v247, s[36:39], s22 offen
 v_mfma_f32_16x16x32_bf16 v[56:59], v[136:139], v[112:115], 0
 buffer_load_dwordx4 v[212:215], v248, s[36:39], s22 offen
 v_mfma_f32_16x16x32_bf16 v[44:47], v[140:143], v[64:67], 0
 buffer_load_dwordx4 v[216:219], v249, s[36:39], s22 offen
 v_mfma_f32_16x16x32_bf16 v[52:55], v[140:143], v[88:91], 0
 v_lshlrev_b32 v27, 16, v160
 v_and_b32 v160, 0xffff0000, v160
 v_mfma_f32_16x16x32_bf16 v[60:63], v[140:143], v[112:115], 0
 v_cvt_pk_f16_f32 v160, v27, v160
 v_accvgpr_write_b32 a8, v160
 ds_read_b128 v[136:139], v22 offset:12416
 ds_read_b128 v[140:143], v22 offset:13952
 s_waitcnt lgkmcnt(2)
 v_mfma_f32_16x16x32_bf16 v[40:43], v[144:147], v[68:71], v[40:43]
 v_lshlrev_b32 v27, 16, v161
 v_and_b32 v161, 0xffff0000, v161
 v_mfma_f32_16x16x32_bf16 v[48:51], v[144:147], v[92:95], v[48:51]
 v_cvt_pk_f16_f32 v161, v27, v161
 v_accvgpr_write_b32 a9, v161
 v_mfma_f32_16x16x32_bf16 v[56:59], v[144:147], v[116:119], v[56:59]
 v_lshlrev_b32 v27, 16, v162
 v_and_b32 v162, 0xffff0000, v162
 v_mfma_f32_16x16x32_bf16 v[44:47], v[148:151], v[68:71], v[44:47]
 v_cvt_pk_f16_f32 v162, v27, v162
 v_accvgpr_write_b32 a10, v162
 v_mfma_f32_16x16x32_bf16 v[52:55], v[148:151], v[92:95], v[52:55]
 v_lshlrev_b32 v27, 16, v163
 v_and_b32 v163, 0xffff0000, v163
 v_mfma_f32_16x16x32_bf16 v[60:63], v[148:151], v[116:119], v[60:63]
 v_cvt_pk_f16_f32 v163, v27, v163
 v_accvgpr_write_b32 a11, v163
 ds_read_b128 v[144:147], v23 offset:12416
 ds_read_b128 v[148:151], v23 offset:13952
 s_waitcnt lgkmcnt(2)
 v_mfma_f32_16x16x32_bf16 v[40:43], v[136:139], v[72:75], v[40:43]
 v_lshlrev_b32 v27, 16, v164
 v_and_b32 v164, 0xffff0000, v164
 v_mfma_f32_16x16x32_bf16 v[48:51], v[136:139], v[96:99], v[48:51]
 v_cvt_pk_f16_f32 v164, v27, v164
 v_accvgpr_write_b32 a28, v164
 v_mfma_f32_16x16x32_bf16 v[56:59], v[136:139], v[120:123], v[56:59]
 v_lshlrev_b32 v27, 16, v165
 v_and_b32 v165, 0xffff0000, v165
 v_mfma_f32_16x16x32_bf16 v[44:47], v[140:143], v[72:75], v[44:47]
 v_cvt_pk_f16_f32 v165, v27, v165
 v_accvgpr_write_b32 a29, v165
 v_mfma_f32_16x16x32_bf16 v[52:55], v[140:143], v[96:99], v[52:55]
 v_lshlrev_b32 v27, 16, v166
 v_and_b32 v166, 0xffff0000, v166
 v_mfma_f32_16x16x32_bf16 v[60:63], v[140:143], v[120:123], v[60:63]
 v_cvt_pk_f16_f32 v166, v27, v166
 v_accvgpr_write_b32 a30, v166
 ds_read_b128 v[136:139], v22 offset:12544
 ds_read_b128 v[140:143], v22 offset:14080
 s_waitcnt lgkmcnt(2)
 v_mfma_f32_16x16x32_bf16 v[40:43], v[144:147], v[76:79], v[40:43]
 v_lshlrev_b32 v27, 16, v167
 v_and_b32 v167, 0xffff0000, v167
 v_mfma_f32_16x16x32_bf16 v[48:51], v[144:147], v[100:103], v[48:51]
 v_cvt_pk_f16_f32 v167, v27, v167
 v_accvgpr_write_b32 a31, v167
 v_mfma_f32_16x16x32_bf16 v[56:59], v[144:147], v[124:127], v[56:59]
 v_lshlrev_b32 v27, 16, v168
 v_and_b32 v168, 0xffff0000, v168
 v_mfma_f32_16x16x32_bf16 v[44:47], v[148:151], v[76:79], v[44:47]
 v_cvt_pk_f16_f32 v168, v27, v168
 v_accvgpr_write_b32 a48, v168
 v_mfma_f32_16x16x32_bf16 v[52:55], v[148:151], v[100:103], v[52:55]
 v_lshlrev_b32 v27, 16, v169
 v_and_b32 v169, 0xffff0000, v169
 v_mfma_f32_16x16x32_bf16 v[60:63], v[148:151], v[124:127], v[60:63]
 v_cvt_pk_f16_f32 v169, v27, v169
 v_accvgpr_write_b32 a49, v169
 ds_read_b128 v[144:147], v23 offset:12544
 ds_read_b128 v[148:151], v23 offset:14080
 s_waitcnt lgkmcnt(2)
 v_mfma_f32_16x16x32_bf16 v[40:43], v[136:139], v[80:83], v[40:43]
 v_lshlrev_b32 v27, 16, v170
 v_and_b32 v170, 0xffff0000, v170
 v_mfma_f32_16x16x32_bf16 v[48:51], v[136:139], v[104:107], v[48:51]
 v_cvt_pk_f16_f32 v170, v27, v170
 v_accvgpr_write_b32 a50, v170
 v_mfma_f32_16x16x32_bf16 v[56:59], v[136:139], v[128:131], v[56:59]
 v_lshlrev_b32 v27, 16, v171
 v_and_b32 v171, 0xffff0000, v171
 v_mfma_f32_16x16x32_bf16 v[44:47], v[140:143], v[80:83], v[44:47]
 v_cvt_pk_f16_f32 v171, v27, v171
 v_accvgpr_write_b32 a51, v171
 v_mfma_f32_16x16x32_bf16 v[52:55], v[140:143], v[104:107], v[52:55]
 v_mfma_f32_16x16x32_bf16 v[60:63], v[140:143], v[128:131], v[60:63]
 s_waitcnt vmcnt(18)
 ds_read_b128 v[136:139], v22 offset:24576
 ds_read_b128 v[140:143], v22 offset:26112
 s_waitcnt lgkmcnt(2)
 v_mfma_f32_16x16x32_bf16 v[40:43], v[144:147], v[84:87], v[40:43]
 s_add_u32 m0, s81, 12288
 s_add_u32 s21, s88, 4030464
 v_mfma_f32_16x16x32_bf16 v[48:51], v[144:147], v[108:111], v[48:51]
 buffer_load_dwordx4 v28, s[12:15], s21 offen offset:0 lds
 buffer_load_dwordx4 v29, s[12:15], s21 offen offset:1024 lds
 v_mfma_f32_16x16x32_bf16 v[56:59], v[144:147], v[132:135], v[56:59]
 buffer_load_dwordx4 v30, s[12:15], s21 offen offset:2048 lds
 s_add_u32 m0, s81, 15360
 v_mfma_f32_16x16x32_bf16 v[44:47], v[148:151], v[84:87], v[44:47]
 s_add_u32 s21, s88, 4079616
 buffer_load_dwordx4 v31, s[12:15], s21 offen offset:0 lds
 v_mfma_f32_16x16x32_bf16 v[52:55], v[148:151], v[108:111], v[52:55]
 buffer_load_dwordx4 v32, s[12:15], s21 offen offset:1024 lds
 buffer_load_dwordx4 v33, s[12:15], s21 offen offset:2048 lds
 v_mfma_f32_16x16x32_bf16 v[60:63], v[148:151], v[132:135], v[60:63]
 s_add_u32 m0, s81, 18432
 s_add_u32 s21, s88, 4521984
 s_nop 1
 v_cvt_pk_f16_f32 v40, v40, v41
 v_accvgpr_write_b32 a196, v40
 buffer_load_dwordx4 v34, s[12:15], s21 offen offset:0 lds
 v_cvt_pk_f16_f32 v42, v42, v43
 v_accvgpr_write_b32 a197, v42
 buffer_load_dwordx4 v35, s[12:15], s21 offen offset:1024 lds
 v_cvt_pk_f16_f32 v48, v48, v49
 v_accvgpr_write_b32 a204, v48
 buffer_load_dwordx4 v36, s[12:15], s21 offen offset:2048 lds
 v_cvt_pk_f16_f32 v50, v50, v51
 v_accvgpr_write_b32 a205, v50
 s_add_u32 m0, s81, 21504
 v_cvt_pk_f16_f32 v56, v56, v57
 v_accvgpr_write_b32 a212, v56
 s_add_u32 s21, s88, 4571136
 v_cvt_pk_f16_f32 v58, v58, v59
 v_accvgpr_write_b32 a213, v58
 buffer_load_dwordx4 v37, s[12:15], s21 offen offset:0 lds
 s_nop 3
 v_cvt_pk_f16_f32 v44, v44, v45
 v_accvgpr_write_b32 a198, v44
 buffer_load_dwordx4 v38, s[12:15], s21 offen offset:1024 lds
 v_cvt_pk_f16_f32 v46, v46, v47
 v_accvgpr_write_b32 a199, v46
 buffer_load_dwordx4 v39, s[12:15], s21 offen offset:2048 lds
 v_cvt_pk_f16_f32 v52, v52, v53
 v_accvgpr_write_b32 a206, v52
 v_cvt_pk_f16_f32 v54, v54, v55
 v_accvgpr_write_b32 a207, v54
 v_cvt_pk_f16_f32 v60, v60, v61
 v_accvgpr_write_b32 a214, v60
 v_cvt_pk_f16_f32 v62, v62, v63
 v_accvgpr_write_b32 a215, v62
 s_waitcnt vmcnt(27)
 ds_write_b128 v251, v[196:199] offset:36864
 ds_write_b128 v251, v[200:203] offset:37888
 ds_write_b128 v251, v[204:207] offset:38912
 ds_read_b64_tr_b16 v[160:161], v250 offset:36864
 ds_read_b64_tr_b16 v[162:163], v250 offset:37248
 ds_read_b64_tr_b16 v[164:165], v250 offset:36896
 ds_read_b64_tr_b16 v[166:167], v250 offset:37280
 ds_read_b64_tr_b16 v[168:169], v250 offset:36928
 ds_read_b64_tr_b16 v[170:171], v250 offset:37312
 ds_read_b128 v[144:147], v23 offset:24576
 ds_read_b128 v[148:151], v23 offset:26112
 s_waitcnt lgkmcnt(2)
 v_mfma_f32_16x16x32_bf16 v[40:43], v[136:139], v[64:67], 0
 buffer_load_dword v0, v26, s[32:35], 0 offen sc1
 v_mfma_f32_16x16x32_bf16 v[48:51], v[136:139], v[88:91], 0
 v_lshlrev_b32 v27, 16, v160
 v_and_b32 v160, 0xffff0000, v160
 v_mfma_f32_16x16x32_bf16 v[56:59], v[136:139], v[112:115], 0
 v_cvt_pk_f16_f32 v160, v27, v160
 v_accvgpr_write_b32 a12, v160
 v_mfma_f32_16x16x32_bf16 v[44:47], v[140:143], v[64:67], 0
 v_lshlrev_b32 v27, 16, v161
 v_and_b32 v161, 0xffff0000, v161
 v_mfma_f32_16x16x32_bf16 v[52:55], v[140:143], v[88:91], 0
 v_cvt_pk_f16_f32 v161, v27, v161
 v_accvgpr_write_b32 a13, v161
 v_mfma_f32_16x16x32_bf16 v[60:63], v[140:143], v[112:115], 0
 v_lshlrev_b32 v27, 16, v162
 v_and_b32 v162, 0xffff0000, v162
 ds_read_b128 v[136:139], v22 offset:24704
 ds_read_b128 v[140:143], v22 offset:26240
 s_waitcnt lgkmcnt(2)
 v_mfma_f32_16x16x32_bf16 v[40:43], v[144:147], v[68:71], v[40:43]
 v_cvt_pk_f16_f32 v162, v27, v162
 v_accvgpr_write_b32 a14, v162
 v_mfma_f32_16x16x32_bf16 v[48:51], v[144:147], v[92:95], v[48:51]
 v_lshlrev_b32 v27, 16, v163
 v_and_b32 v163, 0xffff0000, v163
 v_mfma_f32_16x16x32_bf16 v[56:59], v[144:147], v[116:119], v[56:59]
 v_cvt_pk_f16_f32 v163, v27, v163
 v_accvgpr_write_b32 a15, v163
 v_mfma_f32_16x16x32_bf16 v[44:47], v[148:151], v[68:71], v[44:47]
 v_lshlrev_b32 v27, 16, v164
 v_and_b32 v164, 0xffff0000, v164
 v_mfma_f32_16x16x32_bf16 v[52:55], v[148:151], v[92:95], v[52:55]
 v_cvt_pk_f16_f32 v164, v27, v164
 v_accvgpr_write_b32 a32, v164
 v_mfma_f32_16x16x32_bf16 v[60:63], v[148:151], v[116:119], v[60:63]
 v_lshlrev_b32 v27, 16, v165
 v_and_b32 v165, 0xffff0000, v165
 ds_read_b128 v[144:147], v23 offset:24704
 ds_read_b128 v[148:151], v23 offset:26240
 s_waitcnt lgkmcnt(2)
 v_mfma_f32_16x16x32_bf16 v[40:43], v[136:139], v[72:75], v[40:43]
 v_cvt_pk_f16_f32 v165, v27, v165
 v_accvgpr_write_b32 a33, v165
 v_mfma_f32_16x16x32_bf16 v[48:51], v[136:139], v[96:99], v[48:51]
 v_lshlrev_b32 v27, 16, v166
 v_and_b32 v166, 0xffff0000, v166
 v_mfma_f32_16x16x32_bf16 v[56:59], v[136:139], v[120:123], v[56:59]
 v_cvt_pk_f16_f32 v166, v27, v166
 v_accvgpr_write_b32 a34, v166
 v_mfma_f32_16x16x32_bf16 v[44:47], v[140:143], v[72:75], v[44:47]
 v_lshlrev_b32 v27, 16, v167
 v_and_b32 v167, 0xffff0000, v167
 v_mfma_f32_16x16x32_bf16 v[52:55], v[140:143], v[96:99], v[52:55]
 v_cvt_pk_f16_f32 v167, v27, v167
 v_accvgpr_write_b32 a35, v167
 v_mfma_f32_16x16x32_bf16 v[60:63], v[140:143], v[120:123], v[60:63]
 v_lshlrev_b32 v27, 16, v168
 v_and_b32 v168, 0xffff0000, v168
 ds_read_b128 v[136:139], v22 offset:24832
 ds_read_b128 v[140:143], v22 offset:26368
 s_waitcnt lgkmcnt(2)
 v_mfma_f32_16x16x32_bf16 v[40:43], v[144:147], v[76:79], v[40:43]
 v_cvt_pk_f16_f32 v168, v27, v168
 v_accvgpr_write_b32 a52, v168
 v_mfma_f32_16x16x32_bf16 v[48:51], v[144:147], v[100:103], v[48:51]
 v_lshlrev_b32 v27, 16, v169
 v_and_b32 v169, 0xffff0000, v169
 v_mfma_f32_16x16x32_bf16 v[56:59], v[144:147], v[124:127], v[56:59]
 v_cvt_pk_f16_f32 v169, v27, v169
 v_accvgpr_write_b32 a53, v169
 v_mfma_f32_16x16x32_bf16 v[44:47], v[148:151], v[76:79], v[44:47]
 v_lshlrev_b32 v27, 16, v170
 v_and_b32 v170, 0xffff0000, v170
 v_mfma_f32_16x16x32_bf16 v[52:55], v[148:151], v[100:103], v[52:55]
 v_cvt_pk_f16_f32 v170, v27, v170
 v_accvgpr_write_b32 a54, v170
 v_mfma_f32_16x16x32_bf16 v[60:63], v[148:151], v[124:127], v[60:63]
 v_lshlrev_b32 v27, 16, v171
 v_and_b32 v171, 0xffff0000, v171
 ds_read_b128 v[144:147], v23 offset:24832
 ds_read_b128 v[148:151], v23 offset:26368
 s_waitcnt lgkmcnt(2)
 v_mfma_f32_16x16x32_bf16 v[40:43], v[136:139], v[80:83], v[40:43]
 v_cvt_pk_f16_f32 v171, v27, v171
 v_accvgpr_write_b32 a55, v171
 v_mfma_f32_16x16x32_bf16 v[48:51], v[136:139], v[104:107], v[48:51]
 v_mfma_f32_16x16x32_bf16 v[56:59], v[136:139], v[128:131], v[56:59]
 v_mfma_f32_16x16x32_bf16 v[44:47], v[140:143], v[80:83], v[44:47]
 v_mfma_f32_16x16x32_bf16 v[52:55], v[140:143], v[104:107], v[52:55]
 v_mfma_f32_16x16x32_bf16 v[60:63], v[140:143], v[128:131], v[60:63]
 s_waitcnt vmcnt(16)
 ds_read_b128 v[136:139], v22 offset:0
 ds_read_b128 v[140:143], v22 offset:1536
 s_waitcnt lgkmcnt(2)
 v_mfma_f32_16x16x32_bf16 v[40:43], v[144:147], v[84:87], v[40:43]
 s_add_u32 m0, s81, 24576
 s_add_u32 s21, s88, 5013504
 v_mfma_f32_16x16x32_bf16 v[48:51], v[144:147], v[108:111], v[48:51]
 buffer_load_dwordx4 v28, s[12:15], s21 offen offset:0 lds
 buffer_load_dwordx4 v29, s[12:15], s21 offen offset:1024 lds
 v_mfma_f32_16x16x32_bf16 v[56:59], v[144:147], v[132:135], v[56:59]
 buffer_load_dwordx4 v30, s[12:15], s21 offen offset:2048 lds
 s_add_u32 m0, s81, 27648
 v_mfma_f32_16x16x32_bf16 v[44:47], v[148:151], v[84:87], v[44:47]
 s_add_u32 s21, s88, 5062656
 buffer_load_dwordx4 v31, s[12:15], s21 offen offset:0 lds
 v_mfma_f32_16x16x32_bf16 v[52:55], v[148:151], v[108:111], v[52:55]
 buffer_load_dwordx4 v32, s[12:15], s21 offen offset:1024 lds
 buffer_load_dwordx4 v33, s[12:15], s21 offen offset:2048 lds
 v_mfma_f32_16x16x32_bf16 v[60:63], v[148:151], v[132:135], v[60:63]
 s_add_u32 m0, s81, 30720
 s_add_u32 s21, s88, 5505024
 s_nop 1
 v_cvt_pk_f16_f32 v40, v40, v41
 v_accvgpr_write_b32 a216, v40
 buffer_load_dwordx4 v34, s[12:15], s21 offen offset:0 lds
 v_cvt_pk_f16_f32 v42, v42, v43
 v_accvgpr_write_b32 a217, v42
 buffer_load_dwordx4 v35, s[12:15], s21 offen offset:1024 lds
 v_cvt_pk_f16_f32 v48, v48, v49
 v_accvgpr_write_b32 a224, v48
 buffer_load_dwordx4 v36, s[12:15], s21 offen offset:2048 lds
 v_cvt_pk_f16_f32 v50, v50, v51
 v_accvgpr_write_b32 a225, v50
 s_add_u32 m0, s81, 33792
 v_cvt_pk_f16_f32 v56, v56, v57
 v_accvgpr_write_b32 a232, v56
 s_add_u32 s21, s88, 5554176
 v_cvt_pk_f16_f32 v58, v58, v59
 v_accvgpr_write_b32 a233, v58
 buffer_load_dwordx4 v37, s[12:15], s21 offen offset:0 lds
 s_nop 3
 v_cvt_pk_f16_f32 v44, v44, v45
 v_accvgpr_write_b32 a218, v44
 buffer_load_dwordx4 v38, s[12:15], s21 offen offset:1024 lds
 v_cvt_pk_f16_f32 v46, v46, v47
 v_accvgpr_write_b32 a219, v46
 buffer_load_dwordx4 v39, s[12:15], s21 offen offset:2048 lds
 v_cvt_pk_f16_f32 v52, v52, v53
 v_accvgpr_write_b32 a226, v52
 v_cvt_pk_f16_f32 v54, v54, v55
 v_accvgpr_write_b32 a227, v54
 v_cvt_pk_f16_f32 v60, v60, v61
 v_accvgpr_write_b32 a234, v60
 v_cvt_pk_f16_f32 v62, v62, v63
 v_accvgpr_write_b32 a235, v62
 s_waitcnt vmcnt(25)
 ds_write_b128 v251, v[208:211] offset:36864
 ds_write_b128 v251, v[212:215] offset:37888
 ds_write_b128 v251, v[216:219] offset:38912
 ds_read_b64_tr_b16 v[160:161], v250 offset:36864
 ds_read_b64_tr_b16 v[162:163], v250 offset:37248
 ds_read_b64_tr_b16 v[164:165], v250 offset:36896
 ds_read_b64_tr_b16 v[166:167], v250 offset:37280
 ds_read_b64_tr_b16 v[168:169], v250 offset:36928
 ds_read_b64_tr_b16 v[170:171], v250 offset:37312
 ds_read_b128 v[144:147], v23 offset:0
 ds_read_b128 v[148:151], v23 offset:1536
 s_waitcnt lgkmcnt(2)
 v_mfma_f32_16x16x32_bf16 v[40:43], v[136:139], v[64:67], 0
 v_lshlrev_b32 v27, 16, v160
 v_and_b32 v160, 0xffff0000, v160
 v_mfma_f32_16x16x32_bf16 v[48:51], v[136:139], v[88:91], 0
 v_cvt_pk_f16_f32 v160, v27, v160
 v_accvgpr_write_b32 a16, v160
 v_mfma_f32_16x16x32_bf16 v[56:59], v[136:139], v[112:115], 0
 v_lshlrev_b32 v27, 16, v161
 v_and_b32 v161, 0xffff0000, v161
 v_mfma_f32_16x16x32_bf16 v[44:47], v[140:143], v[64:67], 0
 v_cvt_pk_f16_f32 v161, v27, v161
 v_accvgpr_write_b32 a17, v161
 v_mfma_f32_16x16x32_bf16 v[52:55], v[140:143], v[88:91], 0
 v_lshlrev_b32 v27, 16, v162
 v_and_b32 v162, 0xffff0000, v162
 v_mfma_f32_16x16x32_bf16 v[60:63], v[140:143], v[112:115], 0
 v_cvt_pk_f16_f32 v162, v27, v162
 v_accvgpr_write_b32 a18, v162
 ds_read_b128 v[136:139], v22 offset:128
 ds_read_b128 v[140:143], v22 offset:1664
 s_waitcnt lgkmcnt(2)
 v_mfma_f32_16x16x32_bf16 v[40:43], v[144:147], v[68:71], v[40:43]
 v_lshlrev_b32 v27, 16, v163
 v_and_b32 v163, 0xffff0000, v163
 v_mfma_f32_16x16x32_bf16 v[48:51], v[144:147], v[92:95], v[48:51]
 v_cvt_pk_f16_f32 v163, v27, v163
 v_accvgpr_write_b32 a19, v163
 v_mfma_f32_16x16x32_bf16 v[56:59], v[144:147], v[116:119], v[56:59]
 v_lshlrev_b32 v27, 16, v164
 v_and_b32 v164, 0xffff0000, v164
 v_mfma_f32_16x16x32_bf16 v[44:47], v[148:151], v[68:71], v[44:47]
 v_cvt_pk_f16_f32 v164, v27, v164
 v_accvgpr_write_b32 a36, v164
 v_mfma_f32_16x16x32_bf16 v[52:55], v[148:151], v[92:95], v[52:55]
 v_lshlrev_b32 v27, 16, v165
 v_and_b32 v165, 0xffff0000, v165
 v_mfma_f32_16x16x32_bf16 v[60:63], v[148:151], v[116:119], v[60:63]
 v_cvt_pk_f16_f32 v165, v27, v165
 v_accvgpr_write_b32 a37, v165
 ds_read_b128 v[144:147], v23 offset:128
 ds_read_b128 v[148:151], v23 offset:1664
 s_waitcnt lgkmcnt(2)
 v_mfma_f32_16x16x32_bf16 v[40:43], v[136:139], v[72:75], v[40:43]
 v_lshlrev_b32 v27, 16, v166
 v_and_b32 v166, 0xffff0000, v166
 v_mfma_f32_16x16x32_bf16 v[48:51], v[136:139], v[96:99], v[48:51]
 v_cvt_pk_f16_f32 v166, v27, v166
 v_accvgpr_write_b32 a38, v166
 v_mfma_f32_16x16x32_bf16 v[56:59], v[136:139], v[120:123], v[56:59]
 v_lshlrev_b32 v27, 16, v167
 v_and_b32 v167, 0xffff0000, v167
 v_mfma_f32_16x16x32_bf16 v[44:47], v[140:143], v[72:75], v[44:47]
 v_cvt_pk_f16_f32 v167, v27, v167
 v_accvgpr_write_b32 a39, v167
 v_mfma_f32_16x16x32_bf16 v[52:55], v[140:143], v[96:99], v[52:55]
 v_lshlrev_b32 v27, 16, v168
 v_and_b32 v168, 0xffff0000, v168
 v_mfma_f32_16x16x32_bf16 v[60:63], v[140:143], v[120:123], v[60:63]
 v_cvt_pk_f16_f32 v168, v27, v168
 v_accvgpr_write_b32 a56, v168
 ds_read_b128 v[136:139], v22 offset:256
 ds_read_b128 v[140:143], v22 offset:1792
 s_waitcnt lgkmcnt(2)
 v_mfma_f32_16x16x32_bf16 v[40:43], v[144:147], v[76:79], v[40:43]
 v_lshlrev_b32 v27, 16, v169
 v_and_b32 v169, 0xffff0000, v169
 v_mfma_f32_16x16x32_bf16 v[48:51], v[144:147], v[100:103], v[48:51]
 v_cvt_pk_f16_f32 v169, v27, v169
 v_accvgpr_write_b32 a57, v169
 v_mfma_f32_16x16x32_bf16 v[56:59], v[144:147], v[124:127], v[56:59]
 v_lshlrev_b32 v27, 16, v170
 v_and_b32 v170, 0xffff0000, v170
 v_mfma_f32_16x16x32_bf16 v[44:47], v[148:151], v[76:79], v[44:47]
 v_cvt_pk_f16_f32 v170, v27, v170
 v_accvgpr_write_b32 a58, v170
 v_mfma_f32_16x16x32_bf16 v[52:55], v[148:151], v[100:103], v[52:55]
 v_lshlrev_b32 v27, 16, v171
 v_and_b32 v171, 0xffff0000, v171
 v_mfma_f32_16x16x32_bf16 v[60:63], v[148:151], v[124:127], v[60:63]
 v_cvt_pk_f16_f32 v171, v27, v171
 v_accvgpr_write_b32 a59, v171
 ds_read_b128 v[144:147], v23 offset:256
 ds_read_b128 v[148:151], v23 offset:1792
 s_waitcnt lgkmcnt(2)
 v_mfma_f32_16x16x32_bf16 v[40:43], v[136:139], v[80:83], v[40:43]
 v_mfma_f32_16x16x32_bf16 v[48:51], v[136:139], v[104:107], v[48:51]
 v_mfma_f32_16x16x32_bf16 v[56:59], v[136:139], v[128:131], v[56:59]
 v_mfma_f32_16x16x32_bf16 v[44:47], v[140:143], v[80:83], v[44:47]
 v_mfma_f32_16x16x32_bf16 v[52:55], v[140:143], v[104:107], v[52:55]
 v_mfma_f32_16x16x32_bf16 v[60:63], v[140:143], v[128:131], v[60:63]
 s_waitcnt vmcnt(13)
 ds_read_b128 v[136:139], v22 offset:12288
 ds_read_b128 v[140:143], v22 offset:13824
 s_waitcnt lgkmcnt(2)
 v_mfma_f32_16x16x32_bf16 v[40:43], v[144:147], v[84:87], v[40:43]
 s_add_u32 m0, s81, 0
 s_add_u32 s21, s88, 5898240
 v_mfma_f32_16x16x32_bf16 v[48:51], v[144:147], v[108:111], v[48:51]
 buffer_load_dwordx4 v28, s[12:15], s21 offen offset:0 lds
 buffer_load_dwordx4 v29, s[12:15], s21 offen offset:1024 lds
 v_mfma_f32_16x16x32_bf16 v[56:59], v[144:147], v[132:135], v[56:59]
 buffer_load_dwordx4 v30, s[12:15], s21 offen offset:2048 lds
 s_add_u32 m0, s81, 3072
 v_mfma_f32_16x16x32_bf16 v[44:47], v[148:151], v[84:87], v[44:47]
 s_add_u32 s21, s88, 5947392
 buffer_load_dwordx4 v31, s[12:15], s21 offen offset:0 lds
 v_mfma_f32_16x16x32_bf16 v[52:55], v[148:151], v[108:111], v[52:55]
 buffer_load_dwordx4 v32, s[12:15], s21 offen offset:1024 lds
 buffer_load_dwordx4 v33, s[12:15], s21 offen offset:2048 lds
 v_mfma_f32_16x16x32_bf16 v[60:63], v[148:151], v[132:135], v[60:63]
 s_add_u32 m0, s81, 6144
 s_add_u32 s21, s88, 6389760
 s_nop 1
 v_cvt_pk_f16_f32 v40, v40, v41
 v_accvgpr_write_b32 a220, v40
 buffer_load_dwordx4 v34, s[12:15], s21 offen offset:0 lds
 v_cvt_pk_f16_f32 v42, v42, v43
 v_accvgpr_write_b32 a221, v42
 buffer_load_dwordx4 v35, s[12:15], s21 offen offset:1024 lds
 v_cvt_pk_f16_f32 v48, v48, v49
 v_accvgpr_write_b32 a228, v48
 buffer_load_dwordx4 v36, s[12:15], s21 offen offset:2048 lds
 v_cvt_pk_f16_f32 v50, v50, v51
 v_accvgpr_write_b32 a229, v50
 s_add_u32 m0, s81, 9216
 v_cvt_pk_f16_f32 v56, v56, v57
 v_accvgpr_write_b32 a236, v56
 s_add_u32 s21, s88, 6438912
 v_cvt_pk_f16_f32 v58, v58, v59
 v_accvgpr_write_b32 a237, v58
 buffer_load_dwordx4 v37, s[12:15], s21 offen offset:0 lds
 s_nop 3
 v_cvt_pk_f16_f32 v44, v44, v45
 v_accvgpr_write_b32 a222, v44
 buffer_load_dwordx4 v38, s[12:15], s21 offen offset:1024 lds
 v_cvt_pk_f16_f32 v46, v46, v47
 v_accvgpr_write_b32 a223, v46
 buffer_load_dwordx4 v39, s[12:15], s21 offen offset:2048 lds
 v_cvt_pk_f16_f32 v52, v52, v53
 v_accvgpr_write_b32 a230, v52
 v_cvt_pk_f16_f32 v54, v54, v55
 v_accvgpr_write_b32 a231, v54
 v_cvt_pk_f16_f32 v60, v60, v61
 v_accvgpr_write_b32 a238, v60
 v_cvt_pk_f16_f32 v62, v62, v63
 v_accvgpr_write_b32 a239, v62
 ds_read_b128 v[144:147], v23 offset:12288
 ds_read_b128 v[148:151], v23 offset:13824
 s_waitcnt lgkmcnt(2)
 v_mfma_f32_16x16x32_bf16 v[40:43], v[136:139], v[64:67], 0
 v_mfma_f32_16x16x32_bf16 v[48:51], v[136:139], v[88:91], 0
 v_mfma_f32_16x16x32_bf16 v[56:59], v[136:139], v[112:115], 0
 v_mfma_f32_16x16x32_bf16 v[44:47], v[140:143], v[64:67], 0
 v_mfma_f32_16x16x32_bf16 v[52:55], v[140:143], v[88:91], 0
 v_mfma_f32_16x16x32_bf16 v[60:63], v[140:143], v[112:115], 0
 ds_read_b128 v[136:139], v22 offset:12416
 ds_read_b128 v[140:143], v22 offset:13952
 s_waitcnt lgkmcnt(2)
 v_mfma_f32_16x16x32_bf16 v[40:43], v[144:147], v[68:71], v[40:43]
 v_mfma_f32_16x16x32_bf16 v[48:51], v[144:147], v[92:95], v[48:51]
 v_mfma_f32_16x16x32_bf16 v[56:59], v[144:147], v[116:119], v[56:59]
 v_mfma_f32_16x16x32_bf16 v[44:47], v[148:151], v[68:71], v[44:47]
 v_mfma_f32_16x16x32_bf16 v[52:55], v[148:151], v[92:95], v[52:55]
 v_mfma_f32_16x16x32_bf16 v[60:63], v[148:151], v[116:119], v[60:63]
 ds_read_b128 v[144:147], v23 offset:12416
 ds_read_b128 v[148:151], v23 offset:13952
 s_waitcnt lgkmcnt(2)
 v_mfma_f32_16x16x32_bf16 v[40:43], v[136:139], v[72:75], v[40:43]
 v_mfma_f32_16x16x32_bf16 v[48:51], v[136:139], v[96:99], v[48:51]
 v_mfma_f32_16x16x32_bf16 v[56:59], v[136:139], v[120:123], v[56:59]
 v_mfma_f32_16x16x32_bf16 v[44:47], v[140:143], v[72:75], v[44:47]
 v_mfma_f32_16x16x32_bf16 v[52:55], v[140:143], v[96:99], v[52:55]
 v_mfma_f32_16x16x32_bf16 v[60:63], v[140:143], v[120:123], v[60:63]
 ds_read_b128 v[136:139], v22 offset:12544
 ds_read_b128 v[140:143], v22 offset:14080
 s_waitcnt lgkmcnt(2)
 v_mfma_f32_16x16x32_bf16 v[40:43], v[144:147], v[76:79], v[40:43]
 v_mfma_f32_16x16x32_bf16 v[48:51], v[144:147], v[100:103], v[48:51]
 v_mfma_f32_16x16x32_bf16 v[56:59], v[144:147], v[124:127], v[56:59]
 v_mfma_f32_16x16x32_bf16 v[44:47], v[148:151], v[76:79], v[44:47]
 v_mfma_f32_16x16x32_bf16 v[52:55], v[148:151], v[100:103], v[52:55]
 v_mfma_f32_16x16x32_bf16 v[60:63], v[148:151], v[124:127], v[60:63]
 ds_read_b128 v[144:147], v23 offset:12544
 ds_read_b128 v[148:151], v23 offset:14080
 s_waitcnt lgkmcnt(2)
 v_mfma_f32_16x16x32_bf16 v[40:43], v[136:139], v[80:83], v[40:43]
 v_mfma_f32_16x16x32_bf16 v[48:51], v[136:139], v[104:107], v[48:51]
 v_mfma_f32_16x16x32_bf16 v[56:59], v[136:139], v[128:131], v[56:59]
 v_mfma_f32_16x16x32_bf16 v[44:47], v[140:143], v[80:83], v[44:47]
 v_mfma_f32_16x16x32_bf16 v[52:55], v[140:143], v[104:107], v[52:55]
 v_mfma_f32_16x16x32_bf16 v[60:63], v[140:143], v[128:131], v[60:63]
 s_waitcnt vmcnt(12)
 ds_read_b128 v[136:139], v22 offset:24576
 ds_read_b128 v[140:143], v22 offset:26112
 s_waitcnt lgkmcnt(2)
 v_mfma_f32_16x16x32_bf16 v[40:43], v[144:147], v[84:87], v[40:43]
 s_add_u32 m0, s81, 12288
 s_add_u32 s21, s88, 6881280
 v_mfma_f32_16x16x32_bf16 v[48:51], v[144:147], v[108:111], v[48:51]
 buffer_load_dwordx4 v28, s[12:15], s21 offen offset:0 lds
 buffer_load_dwordx4 v29, s[12:15], s21 offen offset:1024 lds
 v_mfma_f32_16x16x32_bf16 v[56:59], v[144:147], v[132:135], v[56:59]
 buffer_load_dwordx4 v30, s[12:15], s21 offen offset:2048 lds
 s_add_u32 m0, s81, 15360
 v_mfma_f32_16x16x32_bf16 v[44:47], v[148:151], v[84:87], v[44:47]
 s_add_u32 s21, s88, 6930432
 buffer_load_dwordx4 v31, s[12:15], s21 offen offset:0 lds
 v_mfma_f32_16x16x32_bf16 v[52:55], v[148:151], v[108:111], v[52:55]
 buffer_load_dwordx4 v32, s[12:15], s21 offen offset:1024 lds
 buffer_load_dwordx4 v33, s[12:15], s21 offen offset:2048 lds
 v_mfma_f32_16x16x32_bf16 v[60:63], v[148:151], v[132:135], v[60:63]
 s_add_u32 m0, s81, 18432
 s_add_u32 s21, s88, 7372800
 s_nop 1
 v_cvt_pk_f16_f32 v40, v40, v41
 v_accvgpr_write_b32 a240, v40
 buffer_load_dwordx4 v34, s[12:15], s21 offen offset:0 lds
 v_cvt_pk_f16_f32 v42, v42, v43
 v_accvgpr_write_b32 a241, v42
 buffer_load_dwordx4 v35, s[12:15], s21 offen offset:1024 lds
 v_cvt_pk_f16_f32 v48, v48, v49
 v_accvgpr_write_b32 a248, v48
 buffer_load_dwordx4 v36, s[12:15], s21 offen offset:2048 lds
 v_cvt_pk_f16_f32 v50, v50, v51
 v_accvgpr_write_b32 a249, v50
 s_add_u32 m0, s81, 21504
 v_cvt_pk_f16_f32 v152, v56, v57
 s_add_u32 s21, s88, 7421952
 v_cvt_pk_f16_f32 v153, v58, v59
 buffer_load_dwordx4 v37, s[12:15], s21 offen offset:0 lds
 s_nop 3
 v_cvt_pk_f16_f32 v44, v44, v45
 v_accvgpr_write_b32 a242, v44
 buffer_load_dwordx4 v38, s[12:15], s21 offen offset:1024 lds
 v_cvt_pk_f16_f32 v46, v46, v47
 v_accvgpr_write_b32 a243, v46
 buffer_load_dwordx4 v39, s[12:15], s21 offen offset:2048 lds
 v_cvt_pk_f16_f32 v52, v52, v53
 v_accvgpr_write_b32 a250, v52
 v_cvt_pk_f16_f32 v54, v54, v55
 v_accvgpr_write_b32 a251, v54
 v_cvt_pk_f16_f32 v154, v60, v61
 v_cvt_pk_f16_f32 v155, v62, v63
 ds_read_b128 v[144:147], v23 offset:24576
 ds_read_b128 v[148:151], v23 offset:26112
 s_waitcnt lgkmcnt(2)
 v_mfma_f32_16x16x32_bf16 v[40:43], v[136:139], v[64:67], 0
 v_mfma_f32_16x16x32_bf16 v[48:51], v[136:139], v[88:91], 0
 v_mfma_f32_16x16x32_bf16 v[56:59], v[136:139], v[112:115], 0
 v_mfma_f32_16x16x32_bf16 v[44:47], v[140:143], v[64:67], 0
 v_mfma_f32_16x16x32_bf16 v[52:55], v[140:143], v[88:91], 0
 v_mfma_f32_16x16x32_bf16 v[60:63], v[140:143], v[112:115], 0
 ds_read_b128 v[136:139], v22 offset:24704
 ds_read_b128 v[140:143], v22 offset:26240
 s_waitcnt lgkmcnt(2)
 v_mfma_f32_16x16x32_bf16 v[40:43], v[144:147], v[68:71], v[40:43]
 v_mfma_f32_16x16x32_bf16 v[48:51], v[144:147], v[92:95], v[48:51]
 v_mfma_f32_16x16x32_bf16 v[56:59], v[144:147], v[116:119], v[56:59]
 v_mfma_f32_16x16x32_bf16 v[44:47], v[148:151], v[68:71], v[44:47]
 v_mfma_f32_16x16x32_bf16 v[52:55], v[148:151], v[92:95], v[52:55]
 v_mfma_f32_16x16x32_bf16 v[60:63], v[148:151], v[116:119], v[60:63]
 ds_read_b128 v[144:147], v23 offset:24704
 ds_read_b128 v[148:151], v23 offset:26240
 s_waitcnt lgkmcnt(2)
 v_mfma_f32_16x16x32_bf16 v[40:43], v[136:139], v[72:75], v[40:43]
 v_mfma_f32_16x16x32_bf16 v[48:51], v[136:139], v[96:99], v[48:51]
 v_mfma_f32_16x16x32_bf16 v[56:59], v[136:139], v[120:123], v[56:59]
 v_mfma_f32_16x16x32_bf16 v[44:47], v[140:143], v[72:75], v[44:47]
 v_mfma_f32_16x16x32_bf16 v[52:55], v[140:143], v[96:99], v[52:55]
 v_mfma_f32_16x16x32_bf16 v[60:63], v[140:143], v[120:123], v[60:63]
 ds_read_b128 v[136:139], v22 offset:24832
 ds_read_b128 v[140:143], v22 offset:26368
 s_waitcnt lgkmcnt(2)
 v_mfma_f32_16x16x32_bf16 v[40:43], v[144:147], v[76:79], v[40:43]
 v_mfma_f32_16x16x32_bf16 v[48:51], v[144:147], v[100:103], v[48:51]
 v_mfma_f32_16x16x32_bf16 v[56:59], v[144:147], v[124:127], v[56:59]
 v_mfma_f32_16x16x32_bf16 v[44:47], v[148:151], v[76:79], v[44:47]
 v_mfma_f32_16x16x32_bf16 v[52:55], v[148:151], v[100:103], v[52:55]
 v_mfma_f32_16x16x32_bf16 v[60:63], v[148:151], v[124:127], v[60:63]
 ds_read_b128 v[144:147], v23 offset:24832
 ds_read_b128 v[148:151], v23 offset:26368
 s_waitcnt lgkmcnt(2)
 v_mfma_f32_16x16x32_bf16 v[40:43], v[136:139], v[80:83], v[40:43]
 v_mfma_f32_16x16x32_bf16 v[48:51], v[136:139], v[104:107], v[48:51]
 v_mfma_f32_16x16x32_bf16 v[56:59], v[136:139], v[128:131], v[56:59]
 v_mfma_f32_16x16x32_bf16 v[44:47], v[140:143], v[80:83], v[44:47]
 v_mfma_f32_16x16x32_bf16 v[52:55], v[140:143], v[104:107], v[52:55]
 v_mfma_f32_16x16x32_bf16 v[60:63], v[140:143], v[128:131], v[60:63]
 s_waitcnt vmcnt(12)
 ds_read_b128 v[136:139], v22 offset:0
 ds_read_b128 v[140:143], v22 offset:1536
 s_waitcnt lgkmcnt(2)
 v_mfma_f32_16x16x32_bf16 v[40:43], v[144:147], v[84:87], v[40:43]
 s_add_u32 m0, s81, 24576
 s_add_u32 s21, s88, 5996544
 v_mfma_f32_16x16x32_bf16 v[48:51], v[144:147], v[108:111], v[48:51]
 buffer_load_dwordx4 v28, s[12:15], s21 offen offset:0 lds
 buffer_load_dwordx4 v29, s[12:15], s21 offen offset:1024 lds
 v_mfma_f32_16x16x32_bf16 v[56:59], v[144:147], v[132:135], v[56:59]
 buffer_load_dwordx4 v30, s[12:15], s21 offen offset:2048 lds
 s_add_u32 m0, s81, 27648
 v_mfma_f32_16x16x32_bf16 v[44:47], v[148:151], v[84:87], v[44:47]
 s_add_u32 s21, s88, 6045696
 buffer_load_dwordx4 v31, s[12:15], s21 offen offset:0 lds
 v_mfma_f32_16x16x32_bf16 v[52:55], v[148:151], v[108:111], v[52:55]
 buffer_load_dwordx4 v32, s[12:15], s21 offen offset:1024 lds
 buffer_load_dwordx4 v33, s[12:15], s21 offen offset:2048 lds
 v_mfma_f32_16x16x32_bf16 v[60:63], v[148:151], v[132:135], v[60:63]
 s_add_u32 m0, s81, 30720
 s_add_u32 s21, s88, 6488064
 s_nop 1
 v_cvt_pk_f16_f32 v40, v40, v41
 v_accvgpr_write_b32 a244, v40
 buffer_load_dwordx4 v34, s[12:15], s21 offen offset:0 lds
 v_cvt_pk_f16_f32 v42, v42, v43
 v_accvgpr_write_b32 a245, v42
 buffer_load_dwordx4 v35, s[12:15], s21 offen offset:1024 lds
 v_cvt_pk_f16_f32 v48, v48, v49
 v_accvgpr_write_b32 a252, v48
 buffer_load_dwordx4 v36, s[12:15], s21 offen offset:2048 lds
 v_cvt_pk_f16_f32 v50, v50, v51
 v_accvgpr_write_b32 a253, v50
 s_add_u32 m0, s81, 33792
 v_cvt_pk_f16_f32 v156, v56, v57
 s_add_u32 s21, s88, 6537216
 v_cvt_pk_f16_f32 v157, v58, v59
 buffer_load_dwordx4 v37, s[12:15], s21 offen offset:0 lds
 s_nop 3
 v_cvt_pk_f16_f32 v44, v44, v45
 v_accvgpr_write_b32 a246, v44
 buffer_load_dwordx4 v38, s[12:15], s21 offen offset:1024 lds
 v_cvt_pk_f16_f32 v46, v46, v47
 v_accvgpr_write_b32 a247, v46
 buffer_load_dwordx4 v39, s[12:15], s21 offen offset:2048 lds
 v_cvt_pk_f16_f32 v52, v52, v53
 v_accvgpr_write_b32 a254, v52
 v_cvt_pk_f16_f32 v54, v54, v55
 v_accvgpr_write_b32 a255, v54
 v_cvt_pk_f16_f32 v158, v60, v61
 v_cvt_pk_f16_f32 v159, v62, v63
 ds_read_b128 v[144:147], v23 offset:0
 ds_read_b128 v[148:151], v23 offset:1536
 s_waitcnt lgkmcnt(2)
 v_mfma_f32_16x16x32_bf16 v[40:43], v[136:139], v[64:67], 0
 v_mfma_f32_16x16x32_bf16 v[48:51], v[136:139], v[88:91], 0
 v_mfma_f32_16x16x32_bf16 v[56:59], v[136:139], v[112:115], 0
 v_mfma_f32_16x16x32_bf16 v[44:47], v[140:143], v[64:67], 0
 v_mfma_f32_16x16x32_bf16 v[52:55], v[140:143], v[88:91], 0
 v_mfma_f32_16x16x32_bf16 v[60:63], v[140:143], v[112:115], 0
 ds_read_b128 v[136:139], v22 offset:128
 ds_read_b128 v[140:143], v22 offset:1664
 s_waitcnt lgkmcnt(2)
 v_mfma_f32_16x16x32_bf16 v[40:43], v[144:147], v[68:71], v[40:43]
 v_mfma_f32_16x16x32_bf16 v[48:51], v[144:147], v[92:95], v[48:51]
 v_mfma_f32_16x16x32_bf16 v[56:59], v[144:147], v[116:119], v[56:59]
 v_mfma_f32_16x16x32_bf16 v[44:47], v[148:151], v[68:71], v[44:47]
 v_mfma_f32_16x16x32_bf16 v[52:55], v[148:151], v[92:95], v[52:55]
 v_mfma_f32_16x16x32_bf16 v[60:63], v[148:151], v[116:119], v[60:63]
 ds_read_b128 v[144:147], v23 offset:128
 ds_read_b128 v[148:151], v23 offset:1664
 s_waitcnt lgkmcnt(2)
 v_mfma_f32_16x16x32_bf16 v[40:43], v[136:139], v[72:75], v[40:43]
 v_mfma_f32_16x16x32_bf16 v[48:51], v[136:139], v[96:99], v[48:51]
 v_mfma_f32_16x16x32_bf16 v[56:59], v[136:139], v[120:123], v[56:59]
 v_mfma_f32_16x16x32_bf16 v[44:47], v[140:143], v[72:75], v[44:47]
 v_mfma_f32_16x16x32_bf16 v[52:55], v[140:143], v[96:99], v[52:55]
 v_mfma_f32_16x16x32_bf16 v[60:63], v[140:143], v[120:123], v[60:63]
 ds_read_b128 v[136:139], v22 offset:256
 ds_read_b128 v[140:143], v22 offset:1792
 s_waitcnt lgkmcnt(2)
 v_mfma_f32_16x16x32_bf16 v[40:43], v[144:147], v[76:79], v[40:43]
 v_mfma_f32_16x16x32_bf16 v[48:51], v[144:147], v[100:103], v[48:51]
 v_mfma_f32_16x16x32_bf16 v[56:59], v[144:147], v[124:127], v[56:59]
 v_mfma_f32_16x16x32_bf16 v[44:47], v[148:151], v[76:79], v[44:47]
 v_mfma_f32_16x16x32_bf16 v[52:55], v[148:151], v[100:103], v[52:55]
 v_mfma_f32_16x16x32_bf16 v[60:63], v[148:151], v[124:127], v[60:63]
 ds_read_b128 v[144:147], v23 offset:256
 ds_read_b128 v[148:151], v23 offset:1792
 s_waitcnt lgkmcnt(2)
 v_mfma_f32_16x16x32_bf16 v[40:43], v[136:139], v[80:83], v[40:43]
 v_mfma_f32_16x16x32_bf16 v[48:51], v[136:139], v[104:107], v[48:51]
 v_mfma_f32_16x16x32_bf16 v[56:59], v[136:139], v[128:131], v[56:59]
 v_mfma_f32_16x16x32_bf16 v[44:47], v[140:143], v[80:83], v[44:47]
 v_mfma_f32_16x16x32_bf16 v[52:55], v[140:143], v[104:107], v[52:55]
 v_mfma_f32_16x16x32_bf16 v[60:63], v[140:143], v[128:131], v[60:63]
 s_waitcnt vmcnt(12)
 ds_read_b128 v[136:139], v22 offset:12288
 ds_read_b128 v[140:143], v22 offset:13824
 s_waitcnt lgkmcnt(2)
 v_mfma_f32_16x16x32_bf16 v[40:43], v[144:147], v[84:87], v[40:43]
 s_add_u32 m0, s81, 0
 s_add_u32 s21, s88, 6979584
 v_mfma_f32_16x16x32_bf16 v[48:51], v[144:147], v[108:111], v[48:51]
 buffer_load_dwordx4 v28, s[12:15], s21 offen offset:0 lds
 buffer_load_dwordx4 v29, s[12:15], s21 offen offset:1024 lds
 v_mfma_f32_16x16x32_bf16 v[56:59], v[144:147], v[132:135], v[56:59]
 buffer_load_dwordx4 v30, s[12:15], s21 offen offset:2048 lds
 s_add_u32 m0, s81, 3072
 v_mfma_f32_16x16x32_bf16 v[44:47], v[148:151], v[84:87], v[44:47]
 s_add_u32 s21, s88, 7028736
 buffer_load_dwordx4 v31, s[12:15], s21 offen offset:0 lds
 v_mfma_f32_16x16x32_bf16 v[52:55], v[148:151], v[108:111], v[52:55]
 buffer_load_dwordx4 v32, s[12:15], s21 offen offset:1024 lds
 buffer_load_dwordx4 v33, s[12:15], s21 offen offset:2048 lds
 v_mfma_f32_16x16x32_bf16 v[60:63], v[148:151], v[132:135], v[60:63]
 s_add_u32 m0, s81, 6144
 s_add_u32 s21, s88, 7471104
 s_nop 1
 v_cvt_pk_f16_f32 v160, v40, v41
 buffer_load_dwordx4 v34, s[12:15], s21 offen offset:0 lds
 v_cvt_pk_f16_f32 v161, v42, v43
 buffer_load_dwordx4 v35, s[12:15], s21 offen offset:1024 lds
 v_cvt_pk_f16_f32 v168, v48, v49
 buffer_load_dwordx4 v36, s[12:15], s21 offen offset:2048 lds
 v_cvt_pk_f16_f32 v169, v50, v51
 s_add_u32 m0, s81, 9216
 v_cvt_pk_f16_f32 v176, v56, v57
 s_add_u32 s21, s88, 7520256
 v_cvt_pk_f16_f32 v177, v58, v59
 buffer_load_dwordx4 v37, s[12:15], s21 offen offset:0 lds
 s_nop 3
 v_cvt_pk_f16_f32 v162, v44, v45
 buffer_load_dwordx4 v38, s[12:15], s21 offen offset:1024 lds
 v_cvt_pk_f16_f32 v163, v46, v47
 buffer_load_dwordx4 v39, s[12:15], s21 offen offset:2048 lds
 v_cvt_pk_f16_f32 v170, v52, v53
 v_cvt_pk_f16_f32 v171, v54, v55
 v_cvt_pk_f16_f32 v178, v60, v61
 v_cvt_pk_f16_f32 v179, v62, v63
 s_mov_b32 s101, 0
 s_branch fm_8
fm_7:
 s_sleep 8
 buffer_load_dword v0, v26, s[32:35], 0 offen sc1
 s_add_u32 s101, s101, 1
 s_cmp_gt_u32 s101, 131072
 s_cbranch_scc1 end0
 s_waitcnt vmcnt(0)
fm_8:
 v_readlane_b32 s22, v0, 0
 v_readlane_b32 s23, v0, 32
 s_add_u32 s22, s22, s23
 v_readlane_b32 s23, v0, 1
 s_add_u32 s22, s22, s23
 v_readlane_b32 s23, v0, 33
 s_add_u32 s22, s22, s23
 v_readlane_b32 s23, v0, 2
 s_add_u32 s22, s22, s23
 v_readlane_b32 s23, v0, 34
 s_add_u32 s22, s22, s23
 v_readlane_b32 s23, v0, 3
 s_add_u32 s22, s22, s23
 v_readlane_b32 s23, v0, 35
 s_add_u32 s22, s22, s23
 v_readlane_b32 s21, v0, 19
 v_readlane_b32 s23, v0, 21
 s_cmp_ge_u32 s22, 256
 s_cselect_b32 s23, s23, 0
 s_cmp_ge_u32 s21, 32
 s_cselect_b32 s23, s23, 0
 s_cmp_eq_u32 s23, 0
 s_cbranch_scc1 fm_7
 v_readlane_b32 s21, v0, s82
 s_cmp_ge_u32 s21, s83
 s_cselect_b32 s21, 1, 0
 s_andn2_b32 s53, s21, s53
 s_sub_u32 s23, s23, 1
 s_lshl_b32 s23, s23, 13
 v_add_u32 v13, s23, v13
 v_add_u32 v4, s23, v4
 ds_read_b128 v[144:147], v23 offset:12288
 ds_read_b128 v[148:151], v23 offset:13824
 s_waitcnt lgkmcnt(2)
 v_mfma_f32_16x16x32_bf16 v[40:43], v[136:139], v[64:67], 0
 v_mfma_f32_16x16x32_bf16 v[48:51], v[136:139], v[88:91], 0
 v_mfma_f32_16x16x32_bf16 v[56:59], v[136:139], v[112:115], 0
 v_mfma_f32_16x16x32_bf16 v[44:47], v[140:143], v[64:67], 0
 v_mfma_f32_16x16x32_bf16 v[52:55], v[140:143], v[88:91], 0
 v_mfma_f32_16x16x32_bf16 v[60:63], v[140:143], v[112:115], 0
 ds_read_b128 v[136:139], v22 offset:12416
 ds_read_b128 v[140:143], v22 offset:13952
 s_waitcnt lgkmcnt(2)
 v_mfma_f32_16x16x32_bf16 v[40:43], v[144:147], v[68:71], v[40:43]
 v_mfma_f32_16x16x32_bf16 v[48:51], v[144:147], v[92:95], v[48:51]
 v_mfma_f32_16x16x32_bf16 v[56:59], v[144:147], v[116:119], v[56:59]
 v_mfma_f32_16x16x32_bf16 v[44:47], v[148:151], v[68:71], v[44:47]
 v_mfma_f32_16x16x32_bf16 v[52:55], v[148:151], v[92:95], v[52:55]
 v_mfma_f32_16x16x32_bf16 v[60:63], v[148:151], v[116:119], v[60:63]
 ds_read_b128 v[144:147], v23 offset:12416
 ds_read_b128 v[148:151], v23 offset:13952
 s_waitcnt lgkmcnt(2)
 v_mfma_f32_16x16x32_bf16 v[40:43], v[136:139], v[72:75], v[40:43]
 v_mfma_f32_16x16x32_bf16 v[48:51], v[136:139], v[96:99], v[48:51]
 v_mfma_f32_16x16x32_bf16 v[56:59], v[136:139], v[120:123], v[56:59]
 v_mfma_f32_16x16x32_bf16 v[44:47], v[140:143], v[72:75], v[44:47]
 v_mfma_f32_16x16x32_bf16 v[52:55], v[140:143], v[96:99], v[52:55]
 v_mfma_f32_16x16x32_bf16 v[60:63], v[140:143], v[120:123], v[60:63]
 ds_read_b128 v[136:139], v22 offset:12544
 ds_read_b128 v[140:143], v22 offset:14080
 s_waitcnt lgkmcnt(2)
 v_mfma_f32_16x16x32_bf16 v[40:43], v[144:147], v[76:79], v[40:43]
 v_mfma_f32_16x16x32_bf16 v[48:51], v[144:147], v[100:103], v[48:51]
 v_mfma_f32_16x16x32_bf16 v[56:59], v[144:147], v[124:127], v[56:59]
 v_mfma_f32_16x16x32_bf16 v[44:47], v[148:151], v[76:79], v[44:47]
 v_mfma_f32_16x16x32_bf16 v[52:55], v[148:151], v[100:103], v[52:55]
 v_mfma_f32_16x16x32_bf16 v[60:63], v[148:151], v[124:127], v[60:63]
 ds_read_b128 v[144:147], v23 offset:12544
 ds_read_b128 v[148:151], v23 offset:14080
 s_waitcnt lgkmcnt(2)
 v_mfma_f32_16x16x32_bf16 v[40:43], v[136:139], v[80:83], v[40:43]
 v_mfma_f32_16x16x32_bf16 v[48:51], v[136:139], v[104:107], v[48:51]
 v_mfma_f32_16x16x32_bf16 v[56:59], v[136:139], v[128:131], v[56:59]
 v_mfma_f32_16x16x32_bf16 v[44:47], v[140:143], v[80:83], v[44:47]
 v_mfma_f32_16x16x32_bf16 v[52:55], v[140:143], v[104:107], v[52:55]
 v_mfma_f32_16x16x32_bf16 v[60:63], v[140:143], v[128:131], v[60:63]
 s_waitcnt vmcnt(12)
 ds_read_b128 v[136:139], v22 offset:24576
 ds_read_b128 v[140:143], v22 offset:26112
 s_waitcnt lgkmcnt(2)
 v_mfma_f32_16x16x32_bf16 v[40:43], v[144:147], v[84:87], v[40:43]
 s_add_u32 m0, s81, 12288
 s_add_u32 s21, s88, 196608
 v_mfma_f32_16x16x32_bf16 v[48:51], v[144:147], v[108:111], v[48:51]
 buffer_load_dwordx4 v28, s[12:15], s21 offen offset:0 lds
 buffer_load_dwordx4 v29, s[12:15], s21 offen offset:1024 lds
 v_mfma_f32_16x16x32_bf16 v[56:59], v[144:147], v[132:135], v[56:59]
 buffer_load_dwordx4 v30, s[12:15], s21 offen offset:2048 lds
 s_add_u32 m0, s81, 15360
 v_mfma_f32_16x16x32_bf16 v[44:47], v[148:151], v[84:87], v[44:47]
 s_add_u32 s21, s88, 2162688
 buffer_load_dwordx4 v31, s[12:15], s21 offen offset:0 lds
 v_mfma_f32_16x16x32_bf16 v[52:55], v[148:151], v[108:111], v[52:55]
 buffer_load_dwordx4 v32, s[12:15], s21 offen offset:1024 lds
 buffer_load_dwordx4 v33, s[12:15], s21 offen offset:2048 lds
 v_mfma_f32_16x16x32_bf16 v[60:63], v[148:151], v[132:135], v[60:63]
 s_add_u32 m0, s81, 18432
 s_add_u32 s21, s88, 688128
 s_nop 1
 v_cvt_pk_f16_f32 v164, v40, v41
 buffer_load_dwordx4 v34, s[12:15], s21 offen offset:0 lds
 v_cvt_pk_f16_f32 v165, v42, v43
 buffer_load_dwordx4 v35, s[12:15], s21 offen offset:1024 lds
 v_cvt_pk_f16_f32 v172, v48, v49
 buffer_load_dwordx4 v36, s[12:15], s21 offen offset:2048 lds
 v_cvt_pk_f16_f32 v173, v50, v51
 s_add_u32 m0, s81, 21504
 v_cvt_pk_f16_f32 v180, v56, v57
 s_add_u32 s21, s88, 2654208
 v_cvt_pk_f16_f32 v181, v58, v59
 buffer_load_dwordx4 v37, s[12:15], s21 offen offset:0 lds
 s_nop 3
 v_cvt_pk_f16_f32 v166, v44, v45
 buffer_load_dwordx4 v38, s[12:15], s21 offen offset:1024 lds
 v_cvt_pk_f16_f32 v167, v46, v47
 buffer_load_dwordx4 v39, s[12:15], s21 offen offset:2048 lds
 v_cvt_pk_f16_f32 v174, v52, v53
 v_cvt_pk_f16_f32 v175, v54, v55
 v_cvt_pk_f16_f32 v182, v60, v61
 v_cvt_pk_f16_f32 v183, v62, v63
 ds_read_b128 v[144:147], v23 offset:24576
 ds_read_b128 v[148:151], v23 offset:26112
 s_waitcnt lgkmcnt(2)
 v_mfma_f32_16x16x32_bf16 v[40:43], v[136:139], v[64:67], 0
 v_mfma_f32_16x16x32_bf16 v[48:51], v[136:139], v[88:91], 0
 v_mfma_f32_16x16x32_bf16 v[56:59], v[136:139], v[112:115], 0
 v_mfma_f32_16x16x32_bf16 v[44:47], v[140:143], v[64:67], 0
 v_mfma_f32_16x16x32_bf16 v[52:55], v[140:143], v[88:91], 0
 v_mfma_f32_16x16x32_bf16 v[60:63], v[140:143], v[112:115], 0
 ds_read_b128 v[136:139], v22 offset:24704
 ds_read_b128 v[140:143], v22 offset:26240
 s_waitcnt lgkmcnt(2)
 v_mfma_f32_16x16x32_bf16 v[40:43], v[144:147], v[68:71], v[40:43]
 v_mfma_f32_16x16x32_bf16 v[48:51], v[144:147], v[92:95], v[48:51]
 v_mfma_f32_16x16x32_bf16 v[56:59], v[144:147], v[116:119], v[56:59]
 v_mfma_f32_16x16x32_bf16 v[44:47], v[148:151], v[68:71], v[44:47]
 v_mfma_f32_16x16x32_bf16 v[52:55], v[148:151], v[92:95], v[52:55]
 v_mfma_f32_16x16x32_bf16 v[60:63], v[148:151], v[116:119], v[60:63]
 ds_read_b128 v[144:147], v23 offset:24704
 ds_read_b128 v[148:151], v23 offset:26240
 s_waitcnt lgkmcnt(2)
 v_mfma_f32_16x16x32_bf16 v[40:43], v[136:139], v[72:75], v[40:43]
 v_mfma_f32_16x16x32_bf16 v[48:51], v[136:139], v[96:99], v[48:51]
 v_mfma_f32_16x16x32_bf16 v[56:59], v[136:139], v[120:123], v[56:59]
 v_mfma_f32_16x16x32_bf16 v[44:47], v[140:143], v[72:75], v[44:47]
 v_mfma_f32_16x16x32_bf16 v[52:55], v[140:143], v[96:99], v[52:55]
 v_mfma_f32_16x16x32_bf16 v[60:63], v[140:143], v[120:123], v[60:63]
 ds_read_b128 v[136:139], v22 offset:24832
 ds_read_b128 v[140:143], v22 offset:26368
 s_waitcnt lgkmcnt(2)
 v_mfma_f32_16x16x32_bf16 v[40:43], v[144:147], v[76:79], v[40:43]
 v_mfma_f32_16x16x32_bf16 v[48:51], v[144:147], v[100:103], v[48:51]
 v_mfma_f32_16x16x32_bf16 v[56:59], v[144:147], v[124:127], v[56:59]
 v_mfma_f32_16x16x32_bf16 v[44:47], v[148:151], v[76:79], v[44:47]
 v_mfma_f32_16x16x32_bf16 v[52:55], v[148:151], v[100:103], v[52:55]
 v_mfma_f32_16x16x32_bf16 v[60:63], v[148:151], v[124:127], v[60:63]
 ds_read_b128 v[144:147], v23 offset:24832
 ds_read_b128 v[148:151], v23 offset:26368
 s_waitcnt lgkmcnt(2)
 v_mfma_f32_16x16x32_bf16 v[40:43], v[136:139], v[80:83], v[40:43]
 v_mfma_f32_16x16x32_bf16 v[48:51], v[136:139], v[104:107], v[48:51]
 v_mfma_f32_16x16x32_bf16 v[56:59], v[136:139], v[128:131], v[56:59]
 v_mfma_f32_16x16x32_bf16 v[44:47], v[140:143], v[80:83], v[44:47]
 v_mfma_f32_16x16x32_bf16 v[52:55], v[140:143], v[104:107], v[52:55]
 v_mfma_f32_16x16x32_bf16 v[60:63], v[140:143], v[128:131], v[60:63]
 s_waitcnt vmcnt(12)
 ds_read_b128 v[136:139], v22 offset:0
 ds_read_b128 v[140:143], v22 offset:1536
 s_waitcnt lgkmcnt(2)
 v_mfma_f32_16x16x32_bf16 v[40:43], v[144:147], v[84:87], v[40:43]
 s_add_u32 m0, s81, 24576
 s_add_u32 s21, s88, 1179648
 v_mfma_f32_16x16x32_bf16 v[48:51], v[144:147], v[108:111], v[48:51]
 buffer_load_dwordx4 v28, s[12:15], s21 offen offset:0 lds
 buffer_load_dwordx4 v29, s[12:15], s21 offen offset:1024 lds
 v_mfma_f32_16x16x32_bf16 v[56:59], v[144:147], v[132:135], v[56:59]
 buffer_load_dwordx4 v30, s[12:15], s21 offen offset:2048 lds
 s_add_u32 m0, s81, 27648
 v_mfma_f32_16x16x32_bf16 v[44:47], v[148:151], v[84:87], v[44:47]
 s_add_u32 s21, s88, 3145728
 buffer_load_dwordx4 v31, s[12:15], s21 offen offset:0 lds
 v_mfma_f32_16x16x32_bf16 v[52:55], v[148:151], v[108:111], v[52:55]
 buffer_load_dwordx4 v32, s[12:15], s21 offen offset:1024 lds
 buffer_load_dwordx4 v33, s[12:15], s21 offen offset:2048 lds
 v_mfma_f32_16x16x32_bf16 v[60:63], v[148:151], v[132:135], v[60:63]
 s_add_u32 m0, s81, 30720
 s_add_u32 s21, s88, 1671168
 s_nop 1
 v_cvt_pk_f16_f32 v184, v40, v41
 buffer_load_dwordx4 v34, s[12:15], s21 offen offset:0 lds
 v_cvt_pk_f16_f32 v185, v42, v43
 buffer_load_dwordx4 v35, s[12:15], s21 offen offset:1024 lds
 v_cvt_pk_f16_f32 v192, v48, v49
 buffer_load_dwordx4 v36, s[12:15], s21 offen offset:2048 lds
 v_cvt_pk_f16_f32 v193, v50, v51
 s_add_u32 m0, s81, 33792
 v_cvt_pk_f16_f32 v200, v56, v57
 s_add_u32 s21, s88, 3637248
 v_cvt_pk_f16_f32 v201, v58, v59
 buffer_load_dwordx4 v37, s[12:15], s21 offen offset:0 lds
 s_nop 3
 v_cvt_pk_f16_f32 v186, v44, v45
 buffer_load_dwordx4 v38, s[12:15], s21 offen offset:1024 lds
 v_cvt_pk_f16_f32 v187, v46, v47
 buffer_load_dwordx4 v39, s[12:15], s21 offen offset:2048 lds
 v_cvt_pk_f16_f32 v194, v52, v53
 v_cvt_pk_f16_f32 v195, v54, v55
 v_cvt_pk_f16_f32 v202, v60, v61
 v_cvt_pk_f16_f32 v203, v62, v63
 ds_read_b128 v[144:147], v23 offset:0
 ds_read_b128 v[148:151], v23 offset:1536
 s_waitcnt lgkmcnt(2)
 v_mfma_f32_16x16x32_bf16 v[40:43], v[136:139], v[64:67], 0
 v_mfma_f32_16x16x32_bf16 v[48:51], v[136:139], v[88:91], 0
 v_mfma_f32_16x16x32_bf16 v[56:59], v[136:139], v[112:115], 0
 v_mfma_f32_16x16x32_bf16 v[44:47], v[140:143], v[64:67], 0
 v_mfma_f32_16x16x32_bf16 v[52:55], v[140:143], v[88:91], 0
 v_mfma_f32_16x16x32_bf16 v[60:63], v[140:143], v[112:115], 0
 ds_read_b128 v[136:139], v22 offset:128
 ds_read_b128 v[140:143], v22 offset:1664
 s_waitcnt lgkmcnt(2)
 v_mfma_f32_16x16x32_bf16 v[40:43], v[144:147], v[68:71], v[40:43]
 v_mfma_f32_16x16x32_bf16 v[48:51], v[144:147], v[92:95], v[48:51]
 v_mfma_f32_16x16x32_bf16 v[56:59], v[144:147], v[116:119], v[56:59]
 v_mfma_f32_16x16x32_bf16 v[44:47], v[148:151], v[68:71], v[44:47]
 v_mfma_f32_16x16x32_bf16 v[52:55], v[148:151], v[92:95], v[52:55]
 v_mfma_f32_16x16x32_bf16 v[60:63], v[148:151], v[116:119], v[60:63]
 ds_read_b128 v[144:147], v23 offset:128
 ds_read_b128 v[148:151], v23 offset:1664
 s_waitcnt lgkmcnt(2)
 v_mfma_f32_16x16x32_bf16 v[40:43], v[136:139], v[72:75], v[40:43]
 v_mfma_f32_16x16x32_bf16 v[48:51], v[136:139], v[96:99], v[48:51]
 v_mfma_f32_16x16x32_bf16 v[56:59], v[136:139], v[120:123], v[56:59]
 v_mfma_f32_16x16x32_bf16 v[44:47], v[140:143], v[72:75], v[44:47]
 v_mfma_f32_16x16x32_bf16 v[52:55], v[140:143], v[96:99], v[52:55]
 v_mfma_f32_16x16x32_bf16 v[60:63], v[140:143], v[120:123], v[60:63]
 ds_read_b128 v[136:139], v22 offset:256
 ds_read_b128 v[140:143], v22 offset:1792
 s_waitcnt lgkmcnt(2)
 v_mfma_f32_16x16x32_bf16 v[40:43], v[144:147], v[76:79], v[40:43]
 v_mfma_f32_16x16x32_bf16 v[48:51], v[144:147], v[100:103], v[48:51]
 v_mfma_f32_16x16x32_bf16 v[56:59], v[144:147], v[124:127], v[56:59]
 v_mfma_f32_16x16x32_bf16 v[44:47], v[148:151], v[76:79], v[44:47]
 v_mfma_f32_16x16x32_bf16 v[52:55], v[148:151], v[100:103], v[52:55]
 v_mfma_f32_16x16x32_bf16 v[60:63], v[148:151], v[124:127], v[60:63]
 ds_read_b128 v[144:147], v23 offset:256
 ds_read_b128 v[148:151], v23 offset:1792
 s_waitcnt lgkmcnt(2)
 v_mfma_f32_16x16x32_bf16 v[40:43], v[136:139], v[80:83], v[40:43]
 v_mfma_f32_16x16x32_bf16 v[48:51], v[136:139], v[104:107], v[48:51]
 v_mfma_f32_16x16x32_bf16 v[56:59], v[136:139], v[128:131], v[56:59]
 v_mfma_f32_16x16x32_bf16 v[44:47], v[140:143], v[80:83], v[44:47]
 v_mfma_f32_16x16x32_bf16 v[52:55], v[140:143], v[104:107], v[52:55]
 v_mfma_f32_16x16x32_bf16 v[60:63], v[140:143], v[128:131], v[60:63]
 s_waitcnt vmcnt(12)
 ds_read_b128 v[136:139], v22 offset:12288
 ds_read_b128 v[140:143], v22 offset:13824
 s_waitcnt lgkmcnt(2)
 v_mfma_f32_16x16x32_bf16 v[40:43], v[144:147], v[84:87], v[40:43]
 s_add_u32 m0, s81, 0
 s_add_u32 s21, s88, 4128768
 v_mfma_f32_16x16x32_bf16 v[48:51], v[144:147], v[108:111], v[48:51]
 buffer_load_dwordx4 v28, s[12:15], s21 offen offset:0 lds
 buffer_load_dwordx4 v29, s[12:15], s21 offen offset:1024 lds
 v_mfma_f32_16x16x32_bf16 v[56:59], v[144:147], v[132:135], v[56:59]
 buffer_load_dwordx4 v30, s[12:15], s21 offen offset:2048 lds
 s_add_u32 m0, s81, 3072
 v_mfma_f32_16x16x32_bf16 v[44:47], v[148:151], v[84:87], v[44:47]
 s_add_u32 s21, s88, 6094848
 buffer_load_dwordx4 v31, s[12:15], s21 offen offset:0 lds
 v_mfma_f32_16x16x32_bf16 v[52:55], v[148:151], v[108:111], v[52:55]
 buffer_load_dwordx4 v32, s[12:15], s21 offen offset:1024 lds
 buffer_load_dwordx4 v33, s[12:15], s21 offen offset:2048 lds
 v_mfma_f32_16x16x32_bf16 v[60:63], v[148:151], v[132:135], v[60:63]
 s_add_u32 m0, s81, 6144
 s_add_u32 s21, s88, 4620288
 s_nop 1
 v_cvt_pk_f16_f32 v188, v40, v41
 buffer_load_dwordx4 v34, s[12:15], s21 offen offset:0 lds
 v_cvt_pk_f16_f32 v189, v42, v43
 buffer_load_dwordx4 v35, s[12:15], s21 offen offset:1024 lds
 v_cvt_pk_f16_f32 v196, v48, v49
 buffer_load_dwordx4 v36, s[12:15], s21 offen offset:2048 lds
 v_cvt_pk_f16_f32 v197, v50, v51
 s_add_u32 m0, s81, 9216
 v_cvt_pk_f16_f32 v204, v56, v57
 s_add_u32 s21, s88, 6586368
 v_cvt_pk_f16_f32 v205, v58, v59
 buffer_load_dwordx4 v37, s[12:15], s21 offen offset:0 lds
 s_nop 3
 v_cvt_pk_f16_f32 v190, v44, v45
 buffer_load_dwordx4 v38, s[12:15], s21 offen offset:1024 lds
 v_cvt_pk_f16_f32 v191, v46, v47
 buffer_load_dwordx4 v39, s[12:15], s21 offen offset:2048 lds
 v_cvt_pk_f16_f32 v198, v52, v53
 v_cvt_pk_f16_f32 v199, v54, v55
 v_cvt_pk_f16_f32 v206, v60, v61
 v_cvt_pk_f16_f32 v207, v62, v63
 ds_read_b128 v[144:147], v23 offset:12288
 ds_read_b128 v[148:151], v23 offset:13824
 s_waitcnt lgkmcnt(2)
 v_mfma_f32_16x16x32_bf16 v[40:43], v[136:139], v[64:67], 0
 v_mfma_f32_16x16x32_bf16 v[48:51], v[136:139], v[88:91], 0
 v_mfma_f32_16x16x32_bf16 v[56:59], v[136:139], v[112:115], 0
 v_mfma_f32_16x16x32_bf16 v[44:47], v[140:143], v[64:67], 0
 v_mfma_f32_16x16x32_bf16 v[52:55], v[140:143], v[88:91], 0
 v_mfma_f32_16x16x32_bf16 v[60:63], v[140:143], v[112:115], 0
 ds_read_b128 v[136:139], v22 offset:12416
 ds_read_b128 v[140:143], v22 offset:13952
 s_waitcnt lgkmcnt(2)
 v_mfma_f32_16x16x32_bf16 v[40:43], v[144:147], v[68:71], v[40:43]
 v_mfma_f32_16x16x32_bf16 v[48:51], v[144:147], v[92:95], v[48:51]
 v_mfma_f32_16x16x32_bf16 v[56:59], v[144:147], v[116:119], v[56:59]
 v_mfma_f32_16x16x32_bf16 v[44:47], v[148:151], v[68:71], v[44:47]
 v_mfma_f32_16x16x32_bf16 v[52:55], v[148:151], v[92:95], v[52:55]
 v_mfma_f32_16x16x32_bf16 v[60:63], v[148:151], v[116:119], v[60:63]
 ds_read_b128 v[144:147], v23 offset:12416
 ds_read_b128 v[148:151], v23 offset:13952
 s_waitcnt lgkmcnt(2)
 v_mfma_f32_16x16x32_bf16 v[40:43], v[136:139], v[72:75], v[40:43]
 v_mfma_f32_16x16x32_bf16 v[48:51], v[136:139], v[96:99], v[48:51]
 v_mfma_f32_16x16x32_bf16 v[56:59], v[136:139], v[120:123], v[56:59]
 v_mfma_f32_16x16x32_bf16 v[44:47], v[140:143], v[72:75], v[44:47]
 v_mfma_f32_16x16x32_bf16 v[52:55], v[140:143], v[96:99], v[52:55]
 v_mfma_f32_16x16x32_bf16 v[60:63], v[140:143], v[120:123], v[60:63]
 ds_read_b128 v[136:139], v22 offset:12544
 ds_read_b128 v[140:143], v22 offset:14080
 s_waitcnt lgkmcnt(2)
 v_mfma_f32_16x16x32_bf16 v[40:43], v[144:147], v[76:79], v[40:43]
 v_mfma_f32_16x16x32_bf16 v[48:51], v[144:147], v[100:103], v[48:51]
 v_mfma_f32_16x16x32_bf16 v[56:59], v[144:147], v[124:127], v[56:59]
 v_mfma_f32_16x16x32_bf16 v[44:47], v[148:151], v[76:79], v[44:47]
 v_mfma_f32_16x16x32_bf16 v[52:55], v[148:151], v[100:103], v[52:55]
 v_mfma_f32_16x16x32_bf16 v[60:63], v[148:151], v[124:127], v[60:63]
 ds_read_b128 v[144:147], v23 offset:12544
 ds_read_b128 v[148:151], v23 offset:14080
 s_waitcnt lgkmcnt(2)
 v_mfma_f32_16x16x32_bf16 v[40:43], v[136:139], v[80:83], v[40:43]
 v_mfma_f32_16x16x32_bf16 v[48:51], v[136:139], v[104:107], v[48:51]
 v_mfma_f32_16x16x32_bf16 v[56:59], v[136:139], v[128:131], v[56:59]
 v_mfma_f32_16x16x32_bf16 v[44:47], v[140:143], v[80:83], v[44:47]
 v_mfma_f32_16x16x32_bf16 v[52:55], v[140:143], v[104:107], v[52:55]
 v_mfma_f32_16x16x32_bf16 v[60:63], v[140:143], v[128:131], v[60:63]
 s_waitcnt vmcnt(12)
 ds_read_b128 v[136:139], v22 offset:24576
 ds_read_b128 v[140:143], v22 offset:26112
 s_waitcnt lgkmcnt(2)
 v_mfma_f32_16x16x32_bf16 v[40:43], v[144:147], v[84:87], v[40:43]
 s_add_u32 m0, s81, 12288
 s_add_u32 s21, s88, 5111808
 v_mfma_f32_16x16x32_bf16 v[48:51], v[144:147], v[108:111], v[48:51]
 buffer_load_dwordx4 v28, s[12:15], s21 offen offset:0 lds
 buffer_load_dwordx4 v29, s[12:15], s21 offen offset:1024 lds
 v_mfma_f32_16x16x32_bf16 v[56:59], v[144:147], v[132:135], v[56:59]
 buffer_load_dwordx4 v30, s[12:15], s21 offen offset:2048 lds
 s_add_u32 m0, s81, 15360
 v_mfma_f32_16x16x32_bf16 v[44:47], v[148:151], v[84:87], v[44:47]
 s_add_u32 s21, s88, 7077888
 buffer_load_dwordx4 v31, s[12:15], s21 offen offset:0 lds
 v_mfma_f32_16x16x32_bf16 v[52:55], v[148:151], v[108:111], v[52:55]
 buffer_load_dwordx4 v32, s[12:15], s21 offen offset:1024 lds
 buffer_load_dwordx4 v33, s[12:15], s21 offen offset:2048 lds
 v_mfma_f32_16x16x32_bf16 v[60:63], v[148:151], v[132:135], v[60:63]
 s_add_u32 m0, s81, 18432
 s_add_u32 s21, s88, 5603328
 s_nop 1
 v_cvt_pk_f16_f32 v208, v40, v41
 buffer_load_dwordx4 v34, s[12:15], s21 offen offset:0 lds
 v_cvt_pk_f16_f32 v209, v42, v43
 buffer_load_dwordx4 v35, s[12:15], s21 offen offset:1024 lds
 v_cvt_pk_f16_f32 v216, v48, v49
 buffer_load_dwordx4 v36, s[12:15], s21 offen offset:2048 lds
 v_cvt_pk_f16_f32 v217, v50, v51
 s_add_u32 m0, s81, 21504
 v_cvt_pk_f16_f32 v224, v56, v57
 s_add_u32 s21, s88, 7569408
 v_cvt_pk_f16_f32 v225, v58, v59
 buffer_load_dwordx4 v37, s[12:15], s21 offen offset:0 lds
 s_nop 3
 v_cvt_pk_f16_f32 v210, v44, v45
 buffer_load_dwordx4 v38, s[12:15], s21 offen offset:1024 lds
 v_cvt_pk_f16_f32 v211, v46, v47
 buffer_load_dwordx4 v39, s[12:15], s21 offen offset:2048 lds
 v_cvt_pk_f16_f32 v218, v52, v53
 v_cvt_pk_f16_f32 v219, v54, v55
 v_cvt_pk_f16_f32 v226, v60, v61
 v_cvt_pk_f16_f32 v227, v62, v63
 s_add_u32 s12, s44, 81068032
 s_addc_u32 s13, s45, 0
 s_mov_b32 s14, 128000
 s_mov_b32 s15, 0x00020000
 v_and_b32 v27, 7, v2
 v_mul_u32_u24 v27, 1280, v27
 v_lshrrev_b32 v39, 3, v1
 v_mul_u32_u24 v39, 40, v39
 s_mul_i32 s21, s20, 320
 v_add3_u32 v27, v27, v39, s21
 buffer_load_dwordx4 v[28:31], v27, s[28:31], 0 offen offset:0
 buffer_load_dwordx4 v[32:35], v27, s[28:31], 0 offen offset:16
 buffer_load_dwordx2 v[36:37], v27, s[28:31], 0 offen offset:32
 s_and_b32 s21, s51, 3
 s_mul_i32 s21, s21, 540672
 buffer_load_dword v38, v9, s[8:11], s21 offen sc1
 buffer_load_dword v38, v8, s[8:11], s21 offen offset:0 sc1
 buffer_load_dword v38, v8, s[8:11], s21 offen offset:1024 sc1
 ds_read_b128 v[144:147], v23 offset:24576
 ds_read_b128 v[148:151], v23 offset:26112
 s_waitcnt lgkmcnt(2)
 v_mfma_f32_16x16x32_bf16 v[40:43], v[136:139], v[64:67], 0
 v_mfma_f32_16x16x32_bf16 v[48:51], v[136:139], v[88:91], 0
 v_mfma_f32_16x16x32_bf16 v[56:59], v[136:139], v[112:115], 0
 v_mfma_f32_16x16x32_bf16 v[44:47], v[140:143], v[64:67], 0
 v_mfma_f32_16x16x32_bf16 v[52:55], v[140:143], v[88:91], 0
 v_mfma_f32_16x16x32_bf16 v[60:63], v[140:143], v[112:115], 0
 ds_read_b128 v[136:139], v22 offset:24704
 ds_read_b128 v[140:143], v22 offset:26240
 s_waitcnt lgkmcnt(2)
 v_mfma_f32_16x16x32_bf16 v[40:43], v[144:147], v[68:71], v[40:43]
 v_mfma_f32_16x16x32_bf16 v[48:51], v[144:147], v[92:95], v[48:51]
 v_mfma_f32_16x16x32_bf16 v[56:59], v[144:147], v[116:119], v[56:59]
 v_mfma_f32_16x16x32_bf16 v[44:47], v[148:151], v[68:71], v[44:47]
 v_mfma_f32_16x16x32_bf16 v[52:55], v[148:151], v[92:95], v[52:55]
 v_mfma_f32_16x16x32_bf16 v[60:63], v[148:151], v[116:119], v[60:63]
 ds_read_b128 v[144:147], v23 offset:24704
 ds_read_b128 v[148:151], v23 offset:26240
 s_waitcnt lgkmcnt(2)
 v_mfma_f32_16x16x32_bf16 v[40:43], v[136:139], v[72:75], v[40:43]
 v_mfma_f32_16x16x32_bf16 v[48:51], v[136:139], v[96:99], v[48:51]
 v_mfma_f32_16x16x32_bf16 v[56:59], v[136:139], v[120:123], v[56:59]
 v_mfma_f32_16x16x32_bf16 v[44:47], v[140:143], v[72:75], v[44:47]
 v_mfma_f32_16x16x32_bf16 v[52:55], v[140:143], v[96:99], v[52:55]
 v_mfma_f32_16x16x32_bf16 v[60:63], v[140:143], v[120:123], v[60:63]
 ds_read_b128 v[136:139], v22 offset:24832
 ds_read_b128 v[140:143], v22 offset:26368
 s_waitcnt lgkmcnt(2)
 v_mfma_f32_16x16x32_bf16 v[40:43], v[144:147], v[76:79], v[40:43]
 v_mfma_f32_16x16x32_bf16 v[48:51], v[144:147], v[100:103], v[48:51]
 v_mfma_f32_16x16x32_bf16 v[56:59], v[144:147], v[124:127], v[56:59]
 v_mfma_f32_16x16x32_bf16 v[44:47], v[148:151], v[76:79], v[44:47]
 v_mfma_f32_16x16x32_bf16 v[52:55], v[148:151], v[100:103], v[52:55]
 v_mfma_f32_16x16x32_bf16 v[60:63], v[148:151], v[124:127], v[60:63]
 ds_read_b128 v[144:147], v23 offset:24832
 ds_read_b128 v[148:151], v23 offset:26368
 s_waitcnt lgkmcnt(2)
 v_mfma_f32_16x16x32_bf16 v[40:43], v[136:139], v[80:83], v[40:43]
 v_mfma_f32_16x16x32_bf16 v[48:51], v[136:139], v[104:107], v[48:51]
 v_mfma_f32_16x16x32_bf16 v[56:59], v[136:139], v[128:131], v[56:59]
 v_mfma_f32_16x16x32_bf16 v[44:47], v[140:143], v[80:83], v[44:47]
 v_mfma_f32_16x16x32_bf16 v[52:55], v[140:143], v[104:107], v[52:55]
 v_mfma_f32_16x16x32_bf16 v[60:63], v[140:143], v[128:131], v[60:63]
 s_waitcnt vmcnt(18)
 ds_read_b128 v[136:139], v22 offset:0
 ds_read_b128 v[140:143], v22 offset:1536
 s_waitcnt lgkmcnt(2)
 v_mfma_f32_16x16x32_bf16 v[40:43], v[144:147], v[84:87], v[40:43]
 v_mfma_f32_16x16x32_bf16 v[48:51], v[144:147], v[108:111], v[48:51]
 v_mfma_f32_16x16x32_bf16 v[56:59], v[144:147], v[132:135], v[56:59]
 v_mfma_f32_16x16x32_bf16 v[44:47], v[148:151], v[84:87], v[44:47]
 v_mfma_f32_16x16x32_bf16 v[52:55], v[148:151], v[108:111], v[52:55]
 v_mfma_f32_16x16x32_bf16 v[60:63], v[148:151], v[132:135], v[60:63]
 s_nop 1
 v_cvt_pk_f16_f32 v212, v40, v41
 v_cvt_pk_f16_f32 v213, v42, v43
 v_cvt_pk_f16_f32 v220, v48, v49
 v_cvt_pk_f16_f32 v221, v50, v51
 v_cvt_pk_f16_f32 v228, v56, v57
 v_cvt_pk_f16_f32 v229, v58, v59
 s_nop 3
 v_cvt_pk_f16_f32 v214, v44, v45
 v_cvt_pk_f16_f32 v215, v46, v47
 v_cvt_pk_f16_f32 v222, v52, v53
 v_cvt_pk_f16_f32 v223, v54, v55
 v_cvt_pk_f16_f32 v230, v60, v61
 v_cvt_pk_f16_f32 v231, v62, v63
 ds_read_b128 v[144:147], v23 offset:0
 ds_read_b128 v[148:151], v23 offset:1536
 s_waitcnt lgkmcnt(2)
 v_mfma_f32_16x16x32_bf16 v[40:43], v[136:139], v[64:67], 0
 v_mfma_f32_16x16x32_bf16 v[48:51], v[136:139], v[88:91], 0
 v_mfma_f32_16x16x32_bf16 v[56:59], v[136:139], v[112:115], 0
 v_mfma_f32_16x16x32_bf16 v[44:47], v[140:143], v[64:67], 0
 v_mfma_f32_16x16x32_bf16 v[52:55], v[140:143], v[88:91], 0
 v_mfma_f32_16x16x32_bf16 v[60:63], v[140:143], v[112:115], 0
 ds_read_b128 v[136:139], v22 offset:128
 ds_read_b128 v[140:143], v22 offset:1664
 s_waitcnt lgkmcnt(2)
 v_mfma_f32_16x16x32_bf16 v[40:43], v[144:147], v[68:71], v[40:43]
 v_mfma_f32_16x16x32_bf16 v[48:51], v[144:147], v[92:95], v[48:51]
 v_mfma_f32_16x16x32_bf16 v[56:59], v[144:147], v[116:119], v[56:59]
 v_mfma_f32_16x16x32_bf16 v[44:47], v[148:151], v[68:71], v[44:47]
 v_mfma_f32_16x16x32_bf16 v[52:55], v[148:151], v[92:95], v[52:55]
 v_mfma_f32_16x16x32_bf16 v[60:63], v[148:151], v[116:119], v[60:63]
 ds_read_b128 v[144:147], v23 offset:128
 ds_read_b128 v[148:151], v23 offset:1664
 s_waitcnt lgkmcnt(2)
 v_mfma_f32_16x16x32_bf16 v[40:43], v[136:139], v[72:75], v[40:43]
 v_mfma_f32_16x16x32_bf16 v[48:51], v[136:139], v[96:99], v[48:51]
 v_mfma_f32_16x16x32_bf16 v[56:59], v[136:139], v[120:123], v[56:59]
 v_mfma_f32_16x16x32_bf16 v[44:47], v[140:143], v[72:75], v[44:47]
 v_mfma_f32_16x16x32_bf16 v[52:55], v[140:143], v[96:99], v[52:55]
 v_mfma_f32_16x16x32_bf16 v[60:63], v[140:143], v[120:123], v[60:63]
 ds_read_b128 v[136:139], v22 offset:256
 ds_read_b128 v[140:143], v22 offset:1792
 s_waitcnt lgkmcnt(2)
 v_mfma_f32_16x16x32_bf16 v[40:43], v[144:147], v[76:79], v[40:43]
 v_mfma_f32_16x16x32_bf16 v[48:51], v[144:147], v[100:103], v[48:51]
 v_mfma_f32_16x16x32_bf16 v[56:59], v[144:147], v[124:127], v[56:59]
 v_mfma_f32_16x16x32_bf16 v[44:47], v[148:151], v[76:79], v[44:47]
 v_mfma_f32_16x16x32_bf16 v[52:55], v[148:151], v[100:103], v[52:55]
 v_mfma_f32_16x16x32_bf16 v[60:63], v[148:151], v[124:127], v[60:63]
 ds_read_b128 v[144:147], v23 offset:256
 ds_read_b128 v[148:151], v23 offset:1792
 s_waitcnt lgkmcnt(2)
 v_mfma_f32_16x16x32_bf16 v[40:43], v[136:139], v[80:83], v[40:43]
 v_mfma_f32_16x16x32_bf16 v[48:51], v[136:139], v[104:107], v[48:51]
 v_mfma_f32_16x16x32_bf16 v[56:59], v[136:139], v[128:131], v[56:59]
 v_mfma_f32_16x16x32_bf16 v[44:47], v[140:143], v[80:83], v[44:47]
 v_mfma_f32_16x16x32_bf16 v[52:55], v[140:143], v[104:107], v[52:55]
 v_mfma_f32_16x16x32_bf16 v[60:63], v[140:143], v[128:131], v[60:63]
 s_waitcnt vmcnt(6)
 ds_read_b128 v[136:139], v22 offset:12288
 ds_read_b128 v[140:143], v22 offset:13824
 s_waitcnt lgkmcnt(2)
 v_mfma_f32_16x16x32_bf16 v[40:43], v[144:147], v[84:87], v[40:43]
 v_mfma_f32_16x16x32_bf16 v[48:51], v[144:147], v[108:111], v[48:51]
 v_mfma_f32_16x16x32_bf16 v[56:59], v[144:147], v[132:135], v[56:59]
 v_mfma_f32_16x16x32_bf16 v[44:47], v[148:151], v[84:87], v[44:47]
 v_mfma_f32_16x16x32_bf16 v[52:55], v[148:151], v[108:111], v[52:55]
 v_mfma_f32_16x16x32_bf16 v[60:63], v[148:151], v[132:135], v[60:63]
 s_nop 1
 v_cvt_pk_f16_f32 v232, v40, v41
 v_cvt_pk_f16_f32 v233, v42, v43
 v_cvt_pk_f16_f32 v240, v48, v49
 v_cvt_pk_f16_f32 v241, v50, v51
 v_cvt_pk_f16_f32 v248, v56, v57
 v_cvt_pk_f16_f32 v249, v58, v59
 s_nop 3
 v_cvt_pk_f16_f32 v234, v44, v45
 v_cvt_pk_f16_f32 v235, v46, v47
 v_cvt_pk_f16_f32 v242, v52, v53
 v_cvt_pk_f16_f32 v243, v54, v55
 v_cvt_pk_f16_f32 v250, v60, v61
 v_cvt_pk_f16_f32 v251, v62, v63
 buffer_load_dword v0, off, s[12:15], s79 sc1
 ds_read_b128 v[144:147], v23 offset:12288
 ds_read_b128 v[148:151], v23 offset:13824
 s_waitcnt lgkmcnt(2)
 v_mfma_f32_16x16x32_bf16 v[40:43], v[136:139], v[64:67], 0
 v_mfma_f32_16x16x32_bf16 v[48:51], v[136:139], v[88:91], 0
 v_mfma_f32_16x16x32_bf16 v[56:59], v[136:139], v[112:115], 0
 v_mfma_f32_16x16x32_bf16 v[44:47], v[140:143], v[64:67], 0
 v_mfma_f32_16x16x32_bf16 v[52:55], v[140:143], v[88:91], 0
 v_mfma_f32_16x16x32_bf16 v[60:63], v[140:143], v[112:115], 0
 ds_read_b128 v[136:139], v22 offset:12416
 ds_read_b128 v[140:143], v22 offset:13952
 s_waitcnt lgkmcnt(2)
 v_mfma_f32_16x16x32_bf16 v[40:43], v[144:147], v[68:71], v[40:43]
 v_mfma_f32_16x16x32_bf16 v[48:51], v[144:147], v[92:95], v[48:51]
 v_mfma_f32_16x16x32_bf16 v[56:59], v[144:147], v[116:119], v[56:59]
 v_mfma_f32_16x16x32_bf16 v[44:47], v[148:151], v[68:71], v[44:47]
 v_mfma_f32_16x16x32_bf16 v[52:55], v[148:151], v[92:95], v[52:55]
 v_mfma_f32_16x16x32_bf16 v[60:63], v[148:151], v[116:119], v[60:63]
 ds_read_b128 v[144:147], v23 offset:12416
 ds_read_b128 v[148:151], v23 offset:13952
 s_waitcnt lgkmcnt(2)
 v_mfma_f32_16x16x32_bf16 v[40:43], v[136:139], v[72:75], v[40:43]
 v_mfma_f32_16x16x32_bf16 v[48:51], v[136:139], v[96:99], v[48:51]
 v_mfma_f32_16x16x32_bf16 v[56:59], v[136:139], v[120:123], v[56:59]
 v_mfma_f32_16x16x32_bf16 v[44:47], v[140:143], v[72:75], v[44:47]
 v_mfma_f32_16x16x32_bf16 v[52:55], v[140:143], v[96:99], v[52:55]
 v_mfma_f32_16x16x32_bf16 v[60:63], v[140:143], v[120:123], v[60:63]
 ds_read_b128 v[136:139], v22 offset:12544
 ds_read_b128 v[140:143], v22 offset:14080
 s_waitcnt lgkmcnt(2)
 v_mfma_f32_16x16x32_bf16 v[40:43], v[144:147], v[76:79], v[40:43]
 v_mfma_f32_16x16x32_bf16 v[48:51], v[144:147], v[100:103], v[48:51]
 v_mfma_f32_16x16x32_bf16 v[56:59], v[144:147], v[124:127], v[56:59]
 v_mfma_f32_16x16x32_bf16 v[44:47], v[148:151], v[76:79], v[44:47]
 v_mfma_f32_16x16x32_bf16 v[52:55], v[148:151], v[100:103], v[52:55]
 v_mfma_f32_16x16x32_bf16 v[60:63], v[148:151], v[124:127], v[60:63]
 ds_read_b128 v[144:147], v23 offset:12544
 ds_read_b128 v[148:151], v23 offset:14080
 s_waitcnt lgkmcnt(2)
 v_mfma_f32_16x16x32_bf16 v[40:43], v[136:139], v[80:83], v[40:43]
 v_mfma_f32_16x16x32_bf16 v[48:51], v[136:139], v[104:107], v[48:51]
 v_mfma_f32_16x16x32_bf16 v[56:59], v[136:139], v[128:131], v[56:59]
 v_mfma_f32_16x16x32_bf16 v[44:47], v[140:143], v[80:83], v[44:47]
 v_mfma_f32_16x16x32_bf16 v[52:55], v[140:143], v[104:107], v[52:55]
 v_mfma_f32_16x16x32_bf16 v[60:63], v[140:143], v[128:131], v[60:63]
 s_waitcnt lgkmcnt(0)
 v_mfma_f32_16x16x32_bf16 v[40:43], v[144:147], v[84:87], v[40:43]
 v_mfma_f32_16x16x32_bf16 v[48:51], v[144:147], v[108:111], v[48:51]
 v_mfma_f32_16x16x32_bf16 v[56:59], v[144:147], v[132:135], v[56:59]
 v_mfma_f32_16x16x32_bf16 v[44:47], v[148:151], v[84:87], v[44:47]
 v_mfma_f32_16x16x32_bf16 v[52:55], v[148:151], v[108:111], v[52:55]
 v_mfma_f32_16x16x32_bf16 v[60:63], v[148:151], v[132:135], v[60:63]
 s_nop 1
 v_cvt_pk_f16_f32 v236, v40, v41
 v_cvt_pk_f16_f32 v237, v42, v43
 v_cvt_pk_f16_f32 v244, v48, v49
 v_cvt_pk_f16_f32 v245, v50, v51
 v_cvt_pk_f16_f32 v252, v56, v57
 v_cvt_pk_f16_f32 v253, v58, v59
 s_nop 3
 v_cvt_pk_f16_f32 v238, v44, v45
 v_cvt_pk_f16_f32 v239, v46, v47
 v_cvt_pk_f16_f32 v246, v52, v53
 v_cvt_pk_f16_f32 v247, v54, v55
 v_cvt_pk_f16_f32 v254, v60, v61
 v_cvt_pk_f16_f32 v255, v62, v63
 s_add_u32 s28, s44, 122683392
 s_addc_u32 s29, s45, 0
 s_mov_b32 s30, 83886080
 s_mov_b32 s31, 0x00020000
 s_waitcnt vmcnt(0)
 v_readfirstlane_b32 s21, v0
 s_cmp_lg_u32 s21, 0
 s_cbranch_scc1 pf_10
 v_mov_b32 v62, 0
 s_mov_b32 s101, 0
wf_11:
 buffer_load_dword v63, v62, s[12:15], s79 offen sc1
 s_add_u32 s101, s101, 1
 s_cmp_gt_u32 s101, 131072
 s_cbranch_scc1 end0
 s_waitcnt vmcnt(0)
 v_readfirstlane_b32 s100, v63
 s_cmp_ge_u32 s100, 1
 s_cbranch_scc1 wf_12
 s_sleep 4
 s_branch wf_11
wf_12:
 v_mov_b32 v0, s100
pf_10:
 s_mov_b32 s87, 0
 s_sub_u32 s21, s64, 1310720
 s_cmp_ge_u32 s20, 2
 s_cbranch_scc1 pf_9
 buffer_load_dwordx4 v[112:115], v18, s[16:19], 0 offen sc1
 buffer_load_dwordx2 v[116:117], v19, s[16:19], 0 offen sc1
pf_9:
 buffer_load_dwordx4 v[126:129], v16, s[28:31], s21 offen offset:0 sc1
 buffer_load_dwordx4 v[130:133], v16, s[28:31], s21 offen offset:1024 sc1
 buffer_load_dwordx4 v[134:137], v16, s[28:31], s21 offen offset:2048 sc1
 v_lshlrev_b32 v27, 16, v28
 v_and_b32 v28, 0xffff0000, v28
 v_cvt_pk_f16_f32 v28, v27, v28
 v_lshlrev_b32 v27, 16, v29
 v_and_b32 v29, 0xffff0000, v29
 v_cvt_pk_f16_f32 v29, v27, v29
 v_lshlrev_b32 v27, 16, v30
 v_and_b32 v30, 0xffff0000, v30
 v_cvt_pk_f16_f32 v30, v27, v30
 v_lshlrev_b32 v27, 16, v31
 v_and_b32 v31, 0xffff0000, v31
 v_cvt_pk_f16_f32 v31, v27, v31
 v_lshlrev_b32 v27, 16, v32
 v_and_b32 v32, 0xffff0000, v32
 v_cvt_pk_f16_f32 v32, v27, v32
 v_lshlrev_b32 v27, 16, v33
 v_and_b32 v33, 0xffff0000, v33
 v_cvt_pk_f16_f32 v33, v27, v33
 v_lshlrev_b32 v27, 16, v34
 v_and_b32 v34, 0xffff0000, v34
 v_cvt_pk_f16_f32 v34, v27, v34
 v_lshlrev_b32 v27, 16, v35
 v_and_b32 v35, 0xffff0000, v35
 v_cvt_pk_f16_f32 v35, v27, v35
 v_lshlrev_b32 v27, 16, v36
 v_and_b32 v36, 0xffff0000, v36
 v_cvt_pk_f16_f32 v36, v27, v36
 v_lshlrev_b32 v27, 16, v37
 v_and_b32 v37, 0xffff0000, v37
 v_cvt_pk_f16_f32 v37, v27, v37
 s_lshl_b32 s21, s20, 2
 s_add_u32 s21, s21, 20480
 v_add_u32 v22, s21, v16
 v_bfe_u32 v23, v1, 2, 3
 v_lshlrev_b32 v23, 4, v23
 v_add_u32 v23, 20480, v23
 v_cmp_gt_u32 vcc, 2, v3
 s_mov_b32 s52, 0
 s_mov_b32 s89, 0x05040100
 v_cndmask_b32 v26, 0, 1.0, vcc
 v_mov_b32 v124, 0
 v_mov_b32 v125, 0
 v_mov_b32 v144, 0
 v_mov_b32 v145, 0
 v_mov_b32 v40, 0
 v_mov_b32 v41, 0
 v_mov_b32 v42, 0
 v_mov_b32 v43, 0
 v_mov_b32 v44, 0
 v_mov_b32 v45, 0
 v_mov_b32 v46, 0
 v_mov_b32 v47, 0
 v_mov_b32 v48, 0
 v_mov_b32 v49, 0
 v_mov_b32 v50, 0
 v_mov_b32 v51, 0
 v_mov_b32 v52, 0
 v_mov_b32 v53, 0
 v_mov_b32 v54, 0
 v_mov_b32 v55, 0
 v_mov_b32 v56, 0
 v_mov_b32 v57, 0
 v_mov_b32 v58, 0
 v_mov_b32 v59, 0
 v_mov_b32 v60, 0
 v_mov_b32 v61, 0
 v_mov_b32 v62, 0
 v_mov_b32 v63, 0
 v_mov_b32 v100, 0
 v_mov_b32 v101, 0
 v_mov_b32 v102, 0
 v_mov_b32 v103, 0
 v_mov_b32 v104, 0
 v_mov_b32 v105, 0
 v_mov_b32 v106, 0
 v_mov_b32 v107, 0
 v_mov_b32 v108, 0
 v_mov_b32 v109, 0
 v_mov_b32 v110, 0
 v_mov_b32 v111, 0
 s_barrier
 s_and_b32 s21, s52, 3
 s_mul_i32 s81, s21, 540672
 s_lshl_b32 s84, s21, 15
 s_add_u32 s21, s52, 3
 s_and_b32 s21, s21, 3
 s_lshl_b32 s83, s21, 15
 s_add_u32 s21, s52, 1
 s_and_b32 s22, s21, 3
 s_lshl_b32 s3, s22, 15
 s_mul_i32 s80, s21, 393216
 s_add_u32 s46, s21, 1
 s_min_u32 s46, s46, 64
 s_mul_i32 s85, s52, 98304
 s_mul_i32 s57, s52, 327680
 s_add_u32 s57, s57, 51380224
 s_bfe_u32 s88, s52, 0x10002
 s_max_u32 s67, s52, 1
 s_sub_u32 s67, s67, 1
 s_cmp_eq_u32 s53, 0
 s_cbranch_scc1 A1_17
 s_cmp_eq_u32 s20, 0
 s_cbranch_scc1 A1_13
 s_cmp_eq_u32 s20, 1
 s_cbranch_scc1 A1_14
 s_cmp_eq_u32 s20, 2
 s_cbranch_scc1 A1_15
 s_cmp_eq_u32 s20, 3
 s_cbranch_scc1 A1_16
 s_branch A1_17
step_18:
 s_and_b32 s21, s52, 3
 s_mul_i32 s81, s21, 540672
 s_lshl_b32 s84, s21, 15
 s_add_u32 s21, s52, 3
 s_and_b32 s21, s21, 3
 s_lshl_b32 s83, s21, 15
 s_add_u32 s21, s52, 1
 s_and_b32 s22, s21, 3
 s_lshl_b32 s3, s22, 15
 s_mul_i32 s80, s21, 393216
 s_add_u32 s46, s21, 1
 s_min_u32 s46, s46, 64
 s_mul_i32 s85, s52, 98304
 s_mul_i32 s57, s52, 327680
 s_add_u32 s57, s57, 51380224
 s_bfe_u32 s88, s52, 0x10002
 s_max_u32 s67, s52, 1
 s_sub_u32 s67, s67, 1
 v_mov_b32 v40, 0
 v_mov_b32 v41, 0
 v_mov_b32 v42, 0
 v_mov_b32 v43, 0
 v_mov_b32 v44, 0
 v_mov_b32 v45, 0
 v_mov_b32 v46, 0
 v_mov_b32 v47, 0
 v_mov_b32 v48, 0
 v_mov_b32 v49, 0
 v_mov_b32 v50, 0
 v_mov_b32 v51, 0
 v_mov_b32 v52, 0
 v_mov_b32 v53, 0
 v_mov_b32 v54, 0
 v_mov_b32 v55, 0
 v_mov_b32 v56, 0
 v_mov_b32 v57, 0
 v_mov_b32 v58, 0
 v_mov_b32 v59, 0
 v_mov_b32 v60, 0
 v_mov_b32 v61, 0
 v_mov_b32 v62, 0
 v_mov_b32 v63, 0
 v_mov_b32 v100, 0
 v_mov_b32 v101, 0
 v_mov_b32 v102, 0
 v_mov_b32 v103, 0
 v_mov_b32 v104, 0
 v_mov_b32 v105, 0
 v_mov_b32 v106, 0
 v_mov_b32 v107, 0
 v_mov_b32 v108, 0
 v_mov_b32 v109, 0
 v_mov_b32 v110, 0
 v_mov_b32 v111, 0
 s_sleep 5
 v_readfirstlane_b32 s21, v0
 s_cmp_lt_u32 s21, s46
 s_cselect_b32 s55, s55, 0
 s_cmp_lt_i32 s55, 0
 s_cbranch_scc1 fl_23
fl_24:
 s_mov_b32 s54, 0
 buffer_load_dwordx4 v[36:39], v4, s[4:7], s84 offen offset:2048 sc1
 buffer_load_dwordx4 v[28:31], v4, s[4:7], s84 offen offset:0 sc1
 buffer_load_dwordx4 v[32:35], v4, s[4:7], s84 offen offset:1024 sc1
 s_waitcnt vmcnt(3)
 v_mov_b32 v126, v88
 v_mov_b32 v127, v89
 v_mov_b32 v128, v90
 v_mov_b32 v129, v91
 v_mov_b32 v130, v92
 v_mov_b32 v131, v93
 v_mov_b32 v132, v94
 v_mov_b32 v133, v95
 v_mov_b32 v134, v96
 v_mov_b32 v135, v97
 v_mov_b32 v136, v98
 v_mov_b32 v137, v99
 s_waitcnt vmcnt(2)
 v_smfmac_f32_16x16x32_f16 v[40:43], v[36:37], a[16:19], v25
 v_smfmac_f32_16x16x32_f16 v[52:55], v[36:37], a[76:79], v25
 v_smfmac_f32_16x16x32_f16 v[44:47], v[36:37], a[36:39], v25
 s_waitcnt vmcnt(0)
 v_bitop3_b32 v27, v31, v35, v39 bitop3:0x80
 v_perm_b32 v31, v35, v31, s89
 v_cmp_gt_u32 vcc, 0x48000000, v27
 v_mov_b32 v35, v38
 v_smfmac_f32_16x16x32_f16 v[56:59], v[36:37], a[96:99], v25
 s_cbranch_vccnz pm_21
A2_22:
 v_smfmac_f32_16x16x64_f16 v[40:43], v[28:31], a[0:7], v25
 ds_write_b128 v10, v[28:31]
 v_smfmac_f32_16x16x64_f16 v[40:43], v[32:35], a[8:15], v25
 ds_write_b128 v10, v[32:35] offset:1024
 v_smfmac_f32_16x16x64_f16 v[52:55], v[28:31], a[60:67], v25
 ds_write_b64 v10, v[36:37] offset:2048
 v_smfmac_f32_16x16x64_f16 v[52:55], v[32:35], a[68:75], v25
 v_cvt_pk_f16_f32 v40, v40, v41
 v_cvt_pk_f16_f32 v41, v42, v43
 v_smfmac_f32_16x16x32_f16 v[48:51], v[36:37], a[56:59], v25
 v_smfmac_f32_16x16x32_f16 v[60:63], v[36:37], a[116:119], v25
 v_smfmac_f32_16x16x64_f16 v[44:47], v[28:31], a[20:27], v25
 v_cvt_pk_f16_f32 v52, v52, v53
 v_cvt_pk_f16_f32 v53, v54, v55
 s_nop 0
 v_smfmac_f32_16x16x64_f16 v[44:47], v[32:35], a[28:35], v25
 v_permlane32_swap_b32 v40, v52
 v_smfmac_f32_16x16x64_f16 v[56:59], v[28:31], a[80:87], v25
 v_permlane32_swap_b32 v41, v53
 v_pk_add_f16 v40, v40, v52
 v_smfmac_f32_16x16x64_f16 v[56:59], v[32:35], a[88:95], v25
 v_pk_add_f16 v41, v41, v53
 v_smfmac_f32_16x16x64_f16 v[48:51], v[28:31], a[40:47], v25
 ds_write_b64 v5, v[40:41] offset:0
 v_smfmac_f32_16x16x64_f16 v[48:51], v[32:35], a[48:55], v25
 v_cvt_pk_f16_f32 v44, v44, v45
 v_cvt_pk_f16_f32 v45, v46, v47
 v_cvt_pk_f16_f32 v56, v56, v57
 v_smfmac_f32_16x16x64_f16 v[60:63], v[28:31], a[100:107], v25
 v_cvt_pk_f16_f32 v57, v58, v59
 s_nop 0
 v_smfmac_f32_16x16x64_f16 v[60:63], v[32:35], a[108:115], v25
 v_permlane32_swap_b32 v44, v56
 v_permlane32_swap_b32 v45, v57
 v_pk_add_f16 v44, v44, v56
 v_pk_add_f16 v45, v45, v57
 ds_write_b64 v5, v[44:45] offset:640
 v_cvt_pk_f16_f32 v48, v48, v49
 v_cvt_pk_f16_f32 v49, v50, v51
 v_cvt_pk_f16_f32 v60, v60, v61
 v_cvt_pk_f16_f32 v61, v62, v63
 s_nop 0
 v_permlane32_swap_b32 v48, v60
 v_permlane32_swap_b32 v49, v61
 v_pk_add_f16 v48, v48, v60
 v_pk_add_f16 v49, v49, v61
 ds_write_b64 v5, v[48:49] offset:1280
 s_waitcnt lgkmcnt(0) vmcnt(0)
 s_barrier
 ds_read_b64_tr_b16 v[40:41], v21 offset:0
 ds_read_b64_tr_b16 v[42:43], v21 offset:1920
 ds_read_b64_tr_b16 v[44:45], v21 offset:640
 ds_read_b64_tr_b16 v[46:47], v21 offset:2560
 ds_read_b64_tr_b16 v[48:49], v21 offset:1280
 ds_read_b64_tr_b16 v[50:51], v21 offset:3200
 s_waitcnt lgkmcnt(4)
 v_fma_mix_f32 v52, v40, 1.0, v42 op_sel:[0,0,0] op_sel_hi:[1,0,1]
 v_fma_mix_f32 v53, v40, 1.0, v42 op_sel:[1,0,1] op_sel_hi:[1,0,1]
 v_fma_mix_f32 v54, v41, 1.0, v43 op_sel:[0,0,0] op_sel_hi:[1,0,1]
 v_fma_mix_f32 v55, v41, 1.0, v43 op_sel:[1,0,1] op_sel_hi:[1,0,1]
 v_add_f32_dpp v56, v52, v52 row_ror:8 row_mask:0xf bank_mask:0xf
 v_add_f32_dpp v57, v53, v53 row_ror:8 row_mask:0xf bank_mask:0xf
 v_add_f32_dpp v58, v54, v54 row_ror:8 row_mask:0xf bank_mask:0xf
 v_add_f32_dpp v59, v55, v55 row_ror:8 row_mask:0xf bank_mask:0xf
 v_cvt_pk_bf16_f32 v118, v56, v57
 v_cvt_pk_bf16_f32 v119, v58, v59
 s_waitcnt lgkmcnt(2)
 v_fma_mix_f32 v52, v44, 1.0, v46 op_sel:[0,0,0] op_sel_hi:[1,0,1]
 v_fma_mix_f32 v53, v44, 1.0, v46 op_sel:[1,0,1] op_sel_hi:[1,0,1]
 v_fma_mix_f32 v54, v45, 1.0, v47 op_sel:[0,0,0] op_sel_hi:[1,0,1]
 v_fma_mix_f32 v55, v45, 1.0, v47 op_sel:[1,0,1] op_sel_hi:[1,0,1]
 v_add_f32_dpp v56, v52, v52 row_ror:8 row_mask:0xf bank_mask:0xf
 v_add_f32_dpp v57, v53, v53 row_ror:8 row_mask:0xf bank_mask:0xf
 v_add_f32_dpp v58, v54, v54 row_ror:8 row_mask:0xf bank_mask:0xf
 v_add_f32_dpp v59, v55, v55 row_ror:8 row_mask:0xf bank_mask:0xf
 v_cvt_pk_bf16_f32 v120, v56, v57
 v_cvt_pk_bf16_f32 v121, v58, v59
 s_waitcnt lgkmcnt(0)
 v_fma_mix_f32 v52, v48, 1.0, v50 op_sel:[0,0,0] op_sel_hi:[1,0,1]
 v_fma_mix_f32 v53, v48, 1.0, v50 op_sel:[1,0,1] op_sel_hi:[1,0,1]
 v_fma_mix_f32 v54, v49, 1.0, v51 op_sel:[0,0,0] op_sel_hi:[1,0,1]
 v_fma_mix_f32 v55, v49, 1.0, v51 op_sel:[1,0,1] op_sel_hi:[1,0,1]
 v_mfma_f32_16x16x32_bf16 v[40:43], v[112:115], v[118:121], 0
 v_add_f32_dpp v56, v52, v52 row_ror:8 row_mask:0xf bank_mask:0xf
 v_add_f32_dpp v57, v53, v53 row_ror:8 row_mask:0xf bank_mask:0xf
 v_add_f32_dpp v58, v54, v54 row_ror:8 row_mask:0xf bank_mask:0xf
 v_add_f32_dpp v59, v55, v55 row_ror:8 row_mask:0xf bank_mask:0xf
 v_cvt_pk_bf16_f32 v122, v56, v57
 v_cvt_pk_bf16_f32 v123, v58, v59
 s_nop 1
 v_mfma_f32_16x16x32_bf16 v[40:43], v[116:119], v[122:125], v[40:43]
 ds_read_b128 v[28:31], v16 offset:24576
 ds_read_b128 v[32:35], v16 offset:25600
 ds_read_b128 v[64:67], v16 offset:27648
 ds_read_b128 v[68:71], v16 offset:28672
 ds_read_b128 v[72:75], v16 offset:30720
 ds_read_b128 v[76:79], v16 offset:31744
 s_nop 0
 s_mov_b64 exec, s[74:75]
 v_cvt_pk_f16_f32 v44, v40, v41
 v_cvt_pk_f16_f32 v45, v42, v43
 v_and_or_b32 v44, v44, -2, s88
 buffer_store_dwordx2 v[44:45], v7, s[8:11], s81 offen
 s_mov_b64 exec, -1
 ds_read_b128 v[80:83], v16 offset:33792
 ds_read_b128 v[84:87], v16 offset:34816
 ds_read_b64 v[88:89], v16 offset:26624
 ds_read_b64 v[90:91], v16 offset:29696
 ds_read_b64 v[92:93], v16 offset:32768
 ds_read_b64 v[94:95], v16 offset:35840
 s_cmp_eq_u32 s52, 63
 s_cbranch_scc1 last_19
 s_waitcnt lgkmcnt(10)
 v_smfmac_f32_16x16x64_f16 v[100:103], v[28:31], a[120:127], v25
 v_smfmac_f32_16x16x64_f16 v[104:107], v[28:31], a[128:135], v25
 v_smfmac_f32_16x16x64_f16 v[108:111], v[28:31], a[136:143], v25
 s_mov_b32 s54, 0
 v_smfmac_f32_16x16x64_f16 v[100:103], v[32:35], a[144:151], v25
 v_readfirstlane_b32 s21, v0
 v_smfmac_f32_16x16x64_f16 v[104:107], v[32:35], a[152:159], v25
 s_add_u32 s22, s46, 3
 v_smfmac_f32_16x16x64_f16 v[108:111], v[32:35], a[160:167], v25
 s_min_u32 s22, s22, 64
 s_waitcnt lgkmcnt(7)
 v_smfmac_f32_16x16x64_f16 v[100:103], v[64:67], a[168:175], v25
 s_sub_u32 s55, s21, s22
 v_smfmac_f32_16x16x64_f16 v[104:107], v[64:67], a[176:183], v25
 s_sub_u32 s56, s21, s46
 v_smfmac_f32_16x16x64_f16 v[108:111], v[64:67], a[184:191], v25
 v_smfmac_f32_16x16x64_f16 v[100:103], v[68:71], a[192:199], v25
 v_smfmac_f32_16x16x64_f16 v[104:107], v[68:71], a[200:207], v25
 v_smfmac_f32_16x16x64_f16 v[108:111], v[68:71], a[208:215], v25
 v_smfmac_f32_16x16x64_f16 v[100:103], v[72:75], a[216:223], v25
 v_smfmac_f32_16x16x64_f16 v[104:107], v[72:75], a[224:231], v25
 v_smfmac_f32_16x16x64_f16 v[108:111], v[72:75], a[232:239], v25
 s_waitcnt lgkmcnt(4)
 v_smfmac_f32_16x16x64_f16 v[100:103], v[76:79], a[240:247], v25
 v_smfmac_f32_16x16x64_f16 v[104:107], v[76:79], a[248:255], v25
 v_smfmac_f32_16x16x64_f16 v[108:111], v[76:79], v[152:159], v25
 v_smfmac_f32_16x16x64_f16 v[100:103], v[80:83], v[160:167], v25
 v_smfmac_f32_16x16x64_f16 v[104:107], v[80:83], v[168:175], v25
 buffer_load_dwordx2 v[58:59], v9, s[8:11], s81 offen sc1
 buffer_load_dwordx4 v[40:43], v8, s[8:11], s81 offen offset:0 sc1
 buffer_load_dwordx4 v[44:47], v8, s[8:11], s81 offen offset:1024 sc1
 v_smfmac_f32_16x16x64_f16 v[108:111], v[80:83], v[176:183], v25
 v_smfmac_f32_16x16x64_f16 v[100:103], v[84:87], v[184:191], v25
 v_smfmac_f32_16x16x64_f16 v[104:107], v[84:87], v[192:199], v25
 v_smfmac_f32_16x16x64_f16 v[108:111], v[84:87], v[200:207], v25
 s_waitcnt lgkmcnt(0)
 v_smfmac_f32_16x16x64_f16 v[100:103], v[88:91], v[208:215], v25
 v_smfmac_f32_16x16x64_f16 v[104:107], v[88:91], v[216:223], v25
 v_smfmac_f32_16x16x64_f16 v[108:111], v[88:91], v[224:231], v25
 v_smfmac_f32_16x16x64_f16 v[100:103], v[92:95], v[232:239], v25
 v_smfmac_f32_16x16x64_f16 v[104:107], v[92:95], v[240:247], v25
 v_smfmac_f32_16x16x64_f16 v[108:111], v[92:95], v[248:255], v25
 s_cmp_lt_i32 s56, 0
 s_cbranch_scc1 kvw_27
kvok_28:
 s_waitcnt vmcnt(2)
 v_xor_b32 v76, s88, v58
 s_nop 0
 v_permlane16_swap_b32 v58, v59
 v_fma_mix_f32 v60, v58, 1.0, v59 op_sel:[0,0,0] op_sel_hi:[1,0,1]
 v_fma_mix_f32 v61, v58, 1.0, v59 op_sel:[1,0,1] op_sel_hi:[1,0,1]
 v_mov_b32 v58, v60
 v_mov_b32 v59, v61
 s_nop 0
 v_permlane32_swap_b32 v58, v60
 v_permlane32_swap_b32 v59, v61
 v_add_f32 v52, v58, v60
 v_add_f32 v53, v59, v61
 v_max_f32 v79, v52, v53
 s_waitcnt vmcnt(0)
 v_pk_add_f16 v80, v40, v44
 v_pk_add_f16 v82, v42, v46
 v_pk_add_f16 v81, v41, v45
 v_pk_add_f16 v83, v43, v47
 v_permlane32_swap_b32 v80, v82
 v_bitop3_b32 v77, v40, v42, s88 bitop3:0x7e
 v_permlane32_swap_b32 v81, v83
 v_bitop3_b32 v78, v44, v46, s88 bitop3:0x7e
 v_fma_mix_f32 v48, v80, 1.0, v82 op_sel:[0,0,0] op_sel_hi:[1,0,1]
 v_or3_b32 v27, v76, v77, v78
 v_fma_mix_f32 v49, v80, 1.0, v82 op_sel:[1,0,1] op_sel_hi:[1,0,1]
 v_and_b32 v27, 1, v27
 v_fma_mix_f32 v50, v81, 1.0, v83 op_sel:[0,0,0] op_sel_hi:[1,0,1]
 v_cmp_ne_u32 vcc, 0, v27
 v_fma_mix_f32 v51, v81, 1.0, v83 op_sel:[1,0,1] op_sel_hi:[1,0,1]
 v_max3_f32 v62, v48, v49, v79
 s_cbranch_vccnz psr_25
psj_26:
 v_max3_f32 v62, v62, v50, v51
 v_cvt_pk_bf16_f32 v146, v100, v101
 v_cvt_pk_bf16_f32 v147, v102, v103
 v_max_f32_dpp v62, v62, v62 row_ror:8 row_mask:0xf bank_mask:0xf
 v_mov_b32 v63, v62
 v_cvt_pk_bf16_f32 v148, v104, v105
 v_cvt_pk_bf16_f32 v149, v106, v107
 v_permlane32_swap_b32 v62, v63
 v_max_f32 v62, v62, v63
 v_mov_b32 v63, v62
 v_cvt_pk_bf16_f32 v150, v108, v109
 v_cvt_pk_bf16_f32 v151, v110, v111
 v_permlane16_swap_b32 v62, v63
 v_max_f32 v62, v62, v63
 v_mul_f32 v62, s86, v62
 v_fma_f32 v48, v48, s86, -v62
 v_fma_f32 v49, v49, s86, -v62
 v_fma_f32 v50, v50, s86, -v62
 v_fma_f32 v51, v51, s86, -v62
 v_fma_f32 v52, v52, s86, -v62
 v_fma_f32 v53, v53, s86, -v62
 v_exp_f32 v48, v48
 v_exp_f32 v49, v49
 buffer_load_dwordx4 v[88:91], v17, s[28:31], s64 offen offset:0 sc1
 v_exp_f32 v50, v50
 v_exp_f32 v51, v51
 buffer_load_dwordx4 v[92:95], v16, s[28:31], s64 offen offset:1024 sc1
 v_exp_f32 v52, v52
 v_exp_f32 v53, v53
 buffer_load_dwordx4 v[96:99], v20, s[28:31], s64 offen offset:2048 sc1
 v_cvt_pk_bf16_f32 v138, v48, v49
 v_cvt_pk_bf16_f32 v139, v50, v51
 v_cvt_pk_bf16_f32 v142, v52, v53
 v_mov_b32_dpp v140, v138 row_ror:8 row_mask:0xf bank_mask:0xf
 v_mov_b32_dpp v141, v139 row_ror:8 row_mask:0xf bank_mask:0xf
 v_mov_b32_dpp v143, v142 row_ror:8 row_mask:0xf bank_mask:0xf
 buffer_load_dwordx4 v[112:115], v18, s[16:19], s80 offen sc1
 v_add_f32 v54, v48, v49
 v_mfma_f32_16x16x32_bf16 v[64:67], v[126:129], v[138:141], 0
 v_add_f32 v55, v50, v51
 v_add_f32 v56, v52, v53
 v_mfma_f32_16x16x32_bf16 v[64:67], v[146:149], v[142:145], v[64:67]
 v_add_f32 v62, v54, v55
 v_fmac_f32 v62, v56, v26
 v_mfma_f32_16x16x32_bf16 v[68:71], v[130:133], v[138:141], 0
 buffer_load_dwordx2 v[116:117], v19, s[16:19], s80 offen sc1
 v_add_f32_dpp v62, v62, v62 row_ror:8 row_mask:0xf bank_mask:0xf
 v_mfma_f32_16x16x32_bf16 v[68:71], v[148:151], v[142:145], v[68:71]
 v_mov_b32 v63, v62
 s_cmp_lt_i32 s55, 0
 s_cbranch_scc1 fl_29
fl_30:
 v_mfma_f32_16x16x32_bf16 v[72:75], v[134:137], v[138:141], 0
 v_permlane32_swap_b32 v62, v63
 v_mfma_f32_16x16x32_bf16 v[72:75], v[150:153], v[142:145], v[72:75]
 v_add_f32 v62, v62, v63
 v_mov_b32 v63, v62
 ds_write_b128 v11, v[64:67] offset:0
 s_nop 0
 v_permlane16_swap_b32 v62, v63
 v_add_f32 v62, v62, v63
 v_rcp_f32 v62, v62
 ds_write_b128 v11, v[68:71] offset:1024
 s_mov_b64 exec, 0xff
 ds_write_b32 v22, v62
 s_mov_b64 exec, -1
 ds_write_b128 v11, v[72:75] offset:2048
 s_waitcnt lgkmcnt(0)
 s_barrier
 ds_read_b128 v[72:75], v23
 ds_read_b64 v[64:65], v12 offset:0
 ds_read_b64 v[66:67], v12 offset:3072
 ds_read_b64 v[68:69], v12 offset:6144
 ds_read_b64 v[70:71], v12 offset:9216
 s_waitcnt lgkmcnt(2)
 v_pk_mul_f32 v[64:65], v[64:65], v[72:73] op_sel_hi:[1,0]
 v_pk_fma_f32 v[64:65], v[66:67], v[72:73], v[64:65] op_sel:[0,1,0] op_sel_hi:[1,1,1]
 s_waitcnt lgkmcnt(0)
 v_pk_fma_f32 v[64:65], v[68:69], v[74:75], v[64:65] op_sel_hi:[1,0,1]
 v_pk_fma_f32 v[64:65], v[70:71], v[74:75], v[64:65] op_sel:[0,1,0] op_sel_hi:[1,1,1]
 v_cvt_pk_f16_f32 v68, v64, v65
 v_perm_b32 v68, s91, v68, v14
 buffer_atomic_pk_add_f16 v68, v13, s[4:7], s3 offen
 v_mov_b32 v76, v108
 v_mov_b32 v77, v109
 v_mov_b32 v78, v110
 v_mov_b32 v79, v111
 v_permlane32_swap_b32 v100, v104
 v_permlane32_swap_b32 v101, v105
 v_permlane32_swap_b32 v102, v106
 v_permlane32_swap_b32 v103, v107
 v_permlane32_swap_b32 v108, v76
 v_permlane32_swap_b32 v109, v77
 v_permlane32_swap_b32 v110, v78
 v_permlane32_swap_b32 v111, v79
 v_pk_add_f32 v[100:101], v[100:101], v[104:105]
 v_pk_add_f32 v[102:103], v[102:103], v[106:107]
 v_pk_add_f32 v[108:109], v[108:109], v[76:77]
 v_pk_add_f32 v[110:111], v[110:111], v[78:79]
 v_cvt_pk_bf16_f32 v80, v100, v101
 v_cvt_pk_bf16_f32 v82, v108, v109
 v_cvt_pk_bf16_f32 v81, v102, v103
 v_cvt_pk_bf16_f32 v83, v110, v111
 s_nop 0
 v_permlane16_swap_b32 v80, v82
 v_permlane16_swap_b32 v81, v83
 v_min_u32 v80, -2, v80
 s_mov_b64 exec, s[76:77]
 buffer_store_dwordx4 v[80:83], v15, s[24:27], s57 offen sc1
 s_mov_b64 exec, -1
 s_add_u32 s64, s64, 1310720
 s_add_u32 s52, s52, 1
 s_branch step_18
fl_23:
 buffer_load_dword v0, off, s[12:15], s79 sc1
 s_branch fl_24
A1_13:
 v_smfmac_f32_16x16x32_f16 v[40:43], v[36:37], a[16:19], v25
 v_smfmac_f32_16x16x32_f16 v[52:55], v[36:37], a[76:79], v25
 v_smfmac_f32_16x16x32_f16 v[44:47], v[36:37], a[36:39], v25
 v_smfmac_f32_16x16x32_f16 v[56:59], v[36:37], a[96:99], v25
 s_branch A2_22
pm_21:
 buffer_load_dwordx4 v[36:39], v4, s[4:7], s84 offen offset:2048 sc1
 buffer_load_dwordx4 v[28:31], v4, s[4:7], s84 offen offset:0 sc1
 buffer_load_dwordx4 v[32:35], v4, s[4:7], s84 offen offset:1024 sc1
 s_nop 7
 v_mov_b32 v40, 0
 v_mov_b32 v41, 0
 v_mov_b32 v42, 0
 v_mov_b32 v43, 0
 v_mov_b32 v52, 0
 v_mov_b32 v53, 0
 v_mov_b32 v54, 0
 v_mov_b32 v55, 0
 v_mov_b32 v44, 0
 v_mov_b32 v45, 0
 v_mov_b32 v46, 0
 v_mov_b32 v47, 0
 v_mov_b32 v56, 0
 v_mov_b32 v57, 0
 v_mov_b32 v58, 0
 v_mov_b32 v59, 0
 s_waitcnt vmcnt(0)
 v_bitop3_b32 v27, v31, v35, v39 bitop3:0x80
 v_perm_b32 v31, v35, v31, s89
 v_cmp_gt_u32 vcc, 0x48000000, v27
 v_mov_b32 v35, v38
 s_cbranch_vccz A1_13
pm_20:
 s_cmp_gt_u32 s52, 3
 s_cbranch_scc1 op_31
 v_readfirstlane_b32 s21, v0
 s_cmp_ge_u32 s21, s46
 s_cbranch_scc1 op_31
 buffer_load_dword v0, off, s[12:15], s79 sc1
 s_waitcnt vmcnt(0)
 v_readfirstlane_b32 s21, v0
 s_cmp_gt_u32 s21, s52
 s_cselect_b32 s21, s87, 0
 s_cmp_eq_u32 s21, 0
 s_cbranch_scc1 op_31
 s_mov_b32 s87, 0
 s_sub_u32 s21, s64, 1310720
 buffer_load_dwordx4 v[126:129], v16, s[28:31], s21 offen offset:0 sc1
 buffer_load_dwordx4 v[130:133], v16, s[28:31], s21 offen offset:1024 sc1
 buffer_load_dwordx4 v[134:137], v16, s[28:31], s21 offen offset:2048 sc1
op_31:
 buffer_load_dwordx4 v[36:39], v4, s[4:7], s84 offen offset:2048 sc1
 buffer_load_dwordx4 v[28:31], v4, s[4:7], s84 offen offset:0 sc1
 buffer_load_dwordx4 v[32:35], v4, s[4:7], s84 offen offset:1024 sc1
 s_add_u32 s54, s54, 1
 s_cmp_gt_u32 s54, 131072
 s_cbranch_scc1 end0
 s_waitcnt vmcnt(0)
 v_bitop3_b32 v27, v31, v35, v39 bitop3:0x80
 v_perm_b32 v31, v35, v31, s89
 v_cmp_gt_u32 vcc, 0x48000000, v27
 v_mov_b32 v35, v38
 s_cbranch_vccnz pm_20
 s_branch A1_13
psr_25:
 buffer_load_dwordx2 v[58:59], v9, s[8:11], s81 offen sc1
 buffer_load_dwordx4 v[40:43], v8, s[8:11], s81 offen offset:0 sc1
 buffer_load_dwordx4 v[44:47], v8, s[8:11], s81 offen offset:1024 sc1
 s_add_u32 s54, s54, 1
 s_cmp_gt_u32 s54, 131072
 s_cbranch_scc1 end0
 s_waitcnt vmcnt(2)
 v_xor_b32 v76, s88, v58
 s_nop 0
 v_permlane16_swap_b32 v58, v59
 v_fma_mix_f32 v60, v58, 1.0, v59 op_sel:[0,0,0] op_sel_hi:[1,0,1]
 v_fma_mix_f32 v61, v58, 1.0, v59 op_sel:[1,0,1] op_sel_hi:[1,0,1]
 v_mov_b32 v58, v60
 v_mov_b32 v59, v61
 s_nop 0
 v_permlane32_swap_b32 v58, v60
 v_permlane32_swap_b32 v59, v61
 v_add_f32 v52, v58, v60
 v_add_f32 v53, v59, v61
 v_max_f32 v79, v52, v53
 s_waitcnt vmcnt(0)
 v_pk_add_f16 v80, v40, v44
 v_pk_add_f16 v82, v42, v46
 v_pk_add_f16 v81, v41, v45
 v_pk_add_f16 v83, v43, v47
 v_permlane32_swap_b32 v80, v82
 v_bitop3_b32 v77, v40, v42, s88 bitop3:0x7e
 v_permlane32_swap_b32 v81, v83
 v_bitop3_b32 v78, v44, v46, s88 bitop3:0x7e
 v_fma_mix_f32 v48, v80, 1.0, v82 op_sel:[0,0,0] op_sel_hi:[1,0,1]
 v_or3_b32 v27, v76, v77, v78
 v_fma_mix_f32 v49, v80, 1.0, v82 op_sel:[1,0,1] op_sel_hi:[1,0,1]
 v_and_b32 v27, 1, v27
 v_fma_mix_f32 v50, v81, 1.0, v83 op_sel:[0,0,0] op_sel_hi:[1,0,1]
 v_cmp_ne_u32 vcc, 0, v27
 v_fma_mix_f32 v51, v81, 1.0, v83 op_sel:[1,0,1] op_sel_hi:[1,0,1]
 v_max3_f32 v62, v48, v49, v79
 s_cbranch_vccnz psr_25
 s_branch psj_26
kvw_27:
 s_mov_b32 s22, s87
 s_cmp_eq_u32 s52, 0
 s_cselect_b32 s55, 0, s55
 s_cselect_b32 s87, 1, 0
 s_cbranch_scc1 kvok_28
 v_mov_b32 v62, 0
 s_mov_b32 s101, 0
wf_32:
 buffer_load_dword v63, v62, s[12:15], s79 offen sc1
 s_add_u32 s101, s101, 1
 s_cmp_gt_u32 s101, 131072
 s_cbranch_scc1 end0
 s_waitcnt vmcnt(0)
 v_readfirstlane_b32 s100, v63
 s_cmp_ge_u32 s100, s46
 s_cbranch_scc1 wf_33
 s_sleep 3
 s_branch wf_32
wf_33:
 s_cmp_eq_u32 s22, 0
 s_cbranch_scc1 kvok_28
 s_sub_u32 s21, s64, 1310720
 buffer_load_dwordx4 v[126:129], v16, s[28:31], s21 offen offset:0 sc1
 buffer_load_dwordx4 v[130:133], v16, s[28:31], s21 offen offset:1024 sc1
 buffer_load_dwordx4 v[134:137], v16, s[28:31], s21 offen offset:2048 sc1
 s_waitcnt vmcnt(0)
 s_branch kvok_28
fl_29:
 buffer_load_dword v0, off, s[12:15], s79 sc1
 s_branch fl_30
last_19:
 s_waitcnt lgkmcnt(10)
 v_smfmac_f32_16x16x64_f16 v[100:103], v[28:31], a[120:127], v25
 v_smfmac_f32_16x16x64_f16 v[104:107], v[28:31], a[128:135], v25
 v_smfmac_f32_16x16x64_f16 v[108:111], v[28:31], a[136:143], v25
 v_smfmac_f32_16x16x64_f16 v[100:103], v[32:35], a[144:151], v25
 v_smfmac_f32_16x16x64_f16 v[104:107], v[32:35], a[152:159], v25
 v_smfmac_f32_16x16x64_f16 v[108:111], v[32:35], a[160:167], v25
 s_waitcnt lgkmcnt(7)
 v_smfmac_f32_16x16x64_f16 v[100:103], v[64:67], a[168:175], v25
 v_smfmac_f32_16x16x64_f16 v[104:107], v[64:67], a[176:183], v25
 v_smfmac_f32_16x16x64_f16 v[108:111], v[64:67], a[184:191], v25
 v_smfmac_f32_16x16x64_f16 v[100:103], v[68:71], a[192:199], v25
 v_smfmac_f32_16x16x64_f16 v[104:107], v[68:71], a[200:207], v25
 v_smfmac_f32_16x16x64_f16 v[108:111], v[68:71], a[208:215], v25
 v_smfmac_f32_16x16x64_f16 v[100:103], v[72:75], a[216:223], v25
 v_smfmac_f32_16x16x64_f16 v[104:107], v[72:75], a[224:231], v25
 v_smfmac_f32_16x16x64_f16 v[108:111], v[72:75], a[232:239], v25
 s_waitcnt lgkmcnt(4)
 v_smfmac_f32_16x16x64_f16 v[100:103], v[76:79], a[240:247], v25
 v_smfmac_f32_16x16x64_f16 v[104:107], v[76:79], a[248:255], v25
 v_smfmac_f32_16x16x64_f16 v[108:111], v[76:79], v[152:159], v25
 v_smfmac_f32_16x16x64_f16 v[100:103], v[80:83], v[160:167], v25
 v_smfmac_f32_16x16x64_f16 v[104:107], v[80:83], v[168:175], v25
 v_smfmac_f32_16x16x64_f16 v[108:111], v[80:83], v[176:183], v25
 v_smfmac_f32_16x16x64_f16 v[100:103], v[84:87], v[184:191], v25
 v_smfmac_f32_16x16x64_f16 v[104:107], v[84:87], v[192:199], v25
 v_smfmac_f32_16x16x64_f16 v[108:111], v[84:87], v[200:207], v25
 s_waitcnt lgkmcnt(0)
 v_smfmac_f32_16x16x64_f16 v[100:103], v[88:91], v[208:215], v25
 v_smfmac_f32_16x16x64_f16 v[104:107], v[88:91], v[216:223], v25
 v_smfmac_f32_16x16x64_f16 v[108:111], v[88:91], v[224:231], v25
 v_smfmac_f32_16x16x64_f16 v[100:103], v[92:95], v[232:239], v25
 v_smfmac_f32_16x16x64_f16 v[104:107], v[92:95], v[240:247], v25
 v_smfmac_f32_16x16x64_f16 v[108:111], v[92:95], v[248:255], v25
 s_nop 7
 v_mov_b32 v76, v108
 v_mov_b32 v77, v109
 v_mov_b32 v78, v110
 v_mov_b32 v79, v111
 v_permlane32_swap_b32 v100, v104
 v_permlane32_swap_b32 v101, v105
 v_permlane32_swap_b32 v102, v106
 v_permlane32_swap_b32 v103, v107
 v_permlane32_swap_b32 v108, v76
 v_permlane32_swap_b32 v109, v77
 v_permlane32_swap_b32 v110, v78
 v_permlane32_swap_b32 v111, v79
 v_pk_add_f32 v[100:101], v[100:101], v[104:105]
 v_pk_add_f32 v[102:103], v[102:103], v[106:107]
 v_pk_add_f32 v[108:109], v[108:109], v[76:77]
 v_pk_add_f32 v[110:111], v[110:111], v[78:79]
 v_cvt_pk_bf16_f32 v80, v100, v101
 v_cvt_pk_bf16_f32 v82, v108, v109
 v_cvt_pk_bf16_f32 v81, v102, v103
 v_cvt_pk_bf16_f32 v83, v110, v111
 s_nop 0
 v_permlane16_swap_b32 v80, v82
 v_permlane16_swap_b32 v81, v83
 v_min_u32 v80, -2, v80
 s_mov_b64 exec, s[76:77]
 buffer_store_dwordx4 v[80:83], v15, s[24:27], s57 offen sc1
 s_mov_b64 exec, -1
 v_mov_b32 v246, 80
 v_mov_b32 v247, 1
 s_mov_b64 exec, 1
 buffer_atomic_add v247, v246, s[32:35], 0 offen sc0 sc1
 s_mov_b64 exec, -1
 s_branch chain_done
step_34:
 s_and_b32 s21, s52, 3
 s_mul_i32 s81, s21, 540672
 s_lshl_b32 s84, s21, 15
 s_add_u32 s21, s52, 3
 s_and_b32 s21, s21, 3
 s_lshl_b32 s83, s21, 15
 s_add_u32 s21, s52, 1
 s_and_b32 s22, s21, 3
 s_lshl_b32 s3, s22, 15
 s_mul_i32 s80, s21, 393216
 s_add_u32 s46, s21, 1
 s_min_u32 s46, s46, 64
 s_mul_i32 s85, s52, 98304
 s_mul_i32 s57, s52, 327680
 s_add_u32 s57, s57, 51380224
 s_bfe_u32 s88, s52, 0x10002
 s_max_u32 s67, s52, 1
 s_sub_u32 s67, s67, 1
 v_mov_b32 v40, 0
 v_mov_b32 v41, 0
 v_mov_b32 v42, 0
 v_mov_b32 v43, 0
 v_mov_b32 v44, 0
 v_mov_b32 v45, 0
 v_mov_b32 v46, 0
 v_mov_b32 v47, 0
 v_mov_b32 v48, 0
 v_mov_b32 v49, 0
 v_mov_b32 v50, 0
 v_mov_b32 v51, 0
 v_mov_b32 v52, 0
 v_mov_b32 v53, 0
 v_mov_b32 v54, 0
 v_mov_b32 v55, 0
 v_mov_b32 v56, 0
 v_mov_b32 v57, 0
 v_mov_b32 v58, 0
 v_mov_b32 v59, 0
 v_mov_b32 v60, 0
 v_mov_b32 v61, 0
 v_mov_b32 v62, 0
 v_mov_b32 v63, 0
 v_mov_b32 v100, 0
 v_mov_b32 v101, 0
 v_mov_b32 v102, 0
 v_mov_b32 v103, 0
 v_mov_b32 v104, 0
 v_mov_b32 v105, 0
 v_mov_b32 v106, 0
 v_mov_b32 v107, 0
 v_mov_b32 v108, 0
 v_mov_b32 v109, 0
 v_mov_b32 v110, 0
 v_mov_b32 v111, 0
 s_sleep 5
 v_readfirstlane_b32 s21, v0
 s_cmp_lt_u32 s21, s46
 s_cselect_b32 s55, s55, 0
 s_cmp_lt_i32 s55, 0
 s_cbranch_scc1 fl_39
fl_40:
 s_mov_b32 s54, 0
 buffer_load_dwordx4 v[36:39], v4, s[4:7], s84 offen offset:2048 sc1
 buffer_load_dwordx4 v[28:31], v4, s[4:7], s84 offen offset:0 sc1
 buffer_load_dwordx4 v[32:35], v4, s[4:7], s84 offen offset:1024 sc1
 s_waitcnt vmcnt(3)
 v_mov_b32 v126, v88
 v_mov_b32 v127, v89
 v_mov_b32 v128, v90
 v_mov_b32 v129, v91
 v_mov_b32 v130, v92
 v_mov_b32 v131, v93
 v_mov_b32 v132, v94
 v_mov_b32 v133, v95
 v_mov_b32 v134, v96
 v_mov_b32 v135, v97
 v_mov_b32 v136, v98
 v_mov_b32 v137, v99
 s_waitcnt vmcnt(2)
 v_smfmac_f32_16x16x32_f16 v[40:43], v[36:37], a[16:19], v25
 v_smfmac_f32_16x16x32_f16 v[52:55], v[36:37], a[76:79], v25
 v_smfmac_f32_16x16x32_f16 v[44:47], v[36:37], a[36:39], v25
 s_waitcnt vmcnt(0)
 v_bitop3_b32 v27, v31, v35, v39 bitop3:0x80
 v_perm_b32 v31, v35, v31, s89
 v_cmp_gt_u32 vcc, 0x48000000, v27
 v_mov_b32 v35, v38
 v_smfmac_f32_16x16x32_f16 v[56:59], v[36:37], a[96:99], v25
 s_cbranch_vccnz pm_37
A2_38:
 v_smfmac_f32_16x16x64_f16 v[40:43], v[28:31], a[0:7], v25
 ds_write_b128 v10, v[28:31]
 v_smfmac_f32_16x16x64_f16 v[40:43], v[32:35], a[8:15], v25
 ds_write_b128 v10, v[32:35] offset:1024
 v_smfmac_f32_16x16x64_f16 v[52:55], v[28:31], a[60:67], v25
 ds_write_b64 v10, v[36:37] offset:2048
 v_smfmac_f32_16x16x64_f16 v[52:55], v[32:35], a[68:75], v25
 v_cvt_pk_f16_f32 v40, v40, v41
 v_cvt_pk_f16_f32 v41, v42, v43
 v_smfmac_f32_16x16x32_f16 v[48:51], v[36:37], a[56:59], v25
 v_smfmac_f32_16x16x32_f16 v[60:63], v[36:37], a[116:119], v25
 v_smfmac_f32_16x16x64_f16 v[44:47], v[28:31], a[20:27], v25
 v_cvt_pk_f16_f32 v52, v52, v53
 v_cvt_pk_f16_f32 v53, v54, v55
 s_nop 0
 v_smfmac_f32_16x16x64_f16 v[44:47], v[32:35], a[28:35], v25
 v_permlane32_swap_b32 v40, v52
 v_smfmac_f32_16x16x64_f16 v[56:59], v[28:31], a[80:87], v25
 v_permlane32_swap_b32 v41, v53
 v_pk_add_f16 v40, v40, v52
 v_smfmac_f32_16x16x64_f16 v[56:59], v[32:35], a[88:95], v25
 v_pk_add_f16 v41, v41, v53
 v_smfmac_f32_16x16x64_f16 v[48:51], v[28:31], a[40:47], v25
 ds_write_b64 v5, v[40:41] offset:0
 v_smfmac_f32_16x16x64_f16 v[48:51], v[32:35], a[48:55], v25
 v_cvt_pk_f16_f32 v44, v44, v45
 v_cvt_pk_f16_f32 v45, v46, v47
 v_cvt_pk_f16_f32 v56, v56, v57
 v_smfmac_f32_16x16x64_f16 v[60:63], v[28:31], a[100:107], v25
 v_cvt_pk_f16_f32 v57, v58, v59
 s_nop 0
 v_smfmac_f32_16x16x64_f16 v[60:63], v[32:35], a[108:115], v25
 v_permlane32_swap_b32 v44, v56
 v_permlane32_swap_b32 v45, v57
 v_pk_add_f16 v44, v44, v56
 v_pk_add_f16 v45, v45, v57
 ds_write_b64 v5, v[44:45] offset:640
 v_cvt_pk_f16_f32 v48, v48, v49
 v_cvt_pk_f16_f32 v49, v50, v51
 v_cvt_pk_f16_f32 v60, v60, v61
 v_cvt_pk_f16_f32 v61, v62, v63
 s_nop 0
 v_permlane32_swap_b32 v48, v60
 v_permlane32_swap_b32 v49, v61
 v_pk_add_f16 v48, v48, v60
 v_pk_add_f16 v49, v49, v61
 ds_write_b64 v5, v[48:49] offset:1280
 s_waitcnt lgkmcnt(0) vmcnt(0)
 s_barrier
 ds_read_b64_tr_b16 v[40:41], v21 offset:0
 ds_read_b64_tr_b16 v[42:43], v21 offset:1920
 ds_read_b64_tr_b16 v[44:45], v21 offset:640
 ds_read_b64_tr_b16 v[46:47], v21 offset:2560
 ds_read_b64_tr_b16 v[48:49], v21 offset:1280
 ds_read_b64_tr_b16 v[50:51], v21 offset:3200
 s_waitcnt lgkmcnt(4)
 v_fma_mix_f32 v52, v40, 1.0, v42 op_sel:[0,0,0] op_sel_hi:[1,0,1]
 v_fma_mix_f32 v53, v40, 1.0, v42 op_sel:[1,0,1] op_sel_hi:[1,0,1]
 v_fma_mix_f32 v54, v41, 1.0, v43 op_sel:[0,0,0] op_sel_hi:[1,0,1]
 v_fma_mix_f32 v55, v41, 1.0, v43 op_sel:[1,0,1] op_sel_hi:[1,0,1]
 v_add_f32_dpp v56, v52, v52 row_ror:8 row_mask:0xf bank_mask:0xf
 v_add_f32_dpp v57, v53, v53 row_ror:8 row_mask:0xf bank_mask:0xf
 v_add_f32_dpp v58, v54, v54 row_ror:8 row_mask:0xf bank_mask:0xf
 v_add_f32_dpp v59, v55, v55 row_ror:8 row_mask:0xf bank_mask:0xf
 v_cvt_pk_bf16_f32 v118, v56, v57
 v_cvt_pk_bf16_f32 v119, v58, v59
 s_waitcnt lgkmcnt(2)
 v_fma_mix_f32 v52, v44, 1.0, v46 op_sel:[0,0,0] op_sel_hi:[1,0,1]
 v_fma_mix_f32 v53, v44, 1.0, v46 op_sel:[1,0,1] op_sel_hi:[1,0,1]
 v_fma_mix_f32 v54, v45, 1.0, v47 op_sel:[0,0,0] op_sel_hi:[1,0,1]
 v_fma_mix_f32 v55, v45, 1.0, v47 op_sel:[1,0,1] op_sel_hi:[1,0,1]
 v_add_f32_dpp v56, v52, v52 row_ror:8 row_mask:0xf bank_mask:0xf
 v_add_f32_dpp v57, v53, v53 row_ror:8 row_mask:0xf bank_mask:0xf
 v_add_f32_dpp v58, v54, v54 row_ror:8 row_mask:0xf bank_mask:0xf
 v_add_f32_dpp v59, v55, v55 row_ror:8 row_mask:0xf bank_mask:0xf
 v_cvt_pk_bf16_f32 v120, v56, v57
 v_cvt_pk_bf16_f32 v121, v58, v59
 s_waitcnt lgkmcnt(0)
 v_fma_mix_f32 v52, v48, 1.0, v50 op_sel:[0,0,0] op_sel_hi:[1,0,1]
 v_fma_mix_f32 v53, v48, 1.0, v50 op_sel:[1,0,1] op_sel_hi:[1,0,1]
 v_fma_mix_f32 v54, v49, 1.0, v51 op_sel:[0,0,0] op_sel_hi:[1,0,1]
 v_fma_mix_f32 v55, v49, 1.0, v51 op_sel:[1,0,1] op_sel_hi:[1,0,1]
 v_mfma_f32_16x16x32_bf16 v[40:43], v[112:115], v[118:121], 0
 v_add_f32_dpp v56, v52, v52 row_ror:8 row_mask:0xf bank_mask:0xf
 v_add_f32_dpp v57, v53, v53 row_ror:8 row_mask:0xf bank_mask:0xf
 v_add_f32_dpp v58, v54, v54 row_ror:8 row_mask:0xf bank_mask:0xf
 v_add_f32_dpp v59, v55, v55 row_ror:8 row_mask:0xf bank_mask:0xf
 v_cvt_pk_bf16_f32 v122, v56, v57
 v_cvt_pk_bf16_f32 v123, v58, v59
 s_nop 1
 v_mfma_f32_16x16x32_bf16 v[40:43], v[116:119], v[122:125], v[40:43]
 ds_read_b128 v[28:31], v16 offset:24576
 ds_read_b128 v[32:35], v16 offset:25600
 ds_read_b128 v[64:67], v16 offset:27648
 ds_read_b128 v[68:71], v16 offset:28672
 ds_read_b128 v[72:75], v16 offset:30720
 ds_read_b128 v[76:79], v16 offset:31744
 s_nop 0
 s_mov_b64 exec, s[74:75]
 v_cvt_pk_f16_f32 v44, v40, v41
 v_cvt_pk_f16_f32 v45, v42, v43
 v_and_or_b32 v44, v44, -2, s88
 buffer_store_dwordx2 v[44:45], v7, s[8:11], s81 offen
 s_mov_b64 exec, -1
 ds_read_b128 v[80:83], v16 offset:33792
 ds_read_b128 v[84:87], v16 offset:34816
 ds_read_b64 v[88:89], v16 offset:26624
 ds_read_b64 v[90:91], v16 offset:29696
 ds_read_b64 v[92:93], v16 offset:32768
 ds_read_b64 v[94:95], v16 offset:35840
 s_cmp_eq_u32 s52, 63
 s_cbranch_scc1 last_35
 s_waitcnt lgkmcnt(10)
 v_smfmac_f32_16x16x64_f16 v[100:103], v[28:31], a[120:127], v25
 v_smfmac_f32_16x16x64_f16 v[104:107], v[28:31], a[128:135], v25
 v_smfmac_f32_16x16x64_f16 v[108:111], v[28:31], a[136:143], v25
 s_mov_b32 s54, 0
 v_smfmac_f32_16x16x64_f16 v[100:103], v[32:35], a[144:151], v25
 v_readfirstlane_b32 s21, v0
 v_smfmac_f32_16x16x64_f16 v[104:107], v[32:35], a[152:159], v25
 s_add_u32 s22, s46, 3
 v_smfmac_f32_16x16x64_f16 v[108:111], v[32:35], a[160:167], v25
 s_min_u32 s22, s22, 64
 s_waitcnt lgkmcnt(7)
 v_smfmac_f32_16x16x64_f16 v[100:103], v[64:67], a[168:175], v25
 s_sub_u32 s55, s21, s22
 v_smfmac_f32_16x16x64_f16 v[104:107], v[64:67], a[176:183], v25
 s_sub_u32 s56, s21, s46
 v_smfmac_f32_16x16x64_f16 v[108:111], v[64:67], a[184:191], v25
 v_smfmac_f32_16x16x64_f16 v[100:103], v[68:71], a[192:199], v25
 v_smfmac_f32_16x16x64_f16 v[104:107], v[68:71], a[200:207], v25
 v_smfmac_f32_16x16x64_f16 v[108:111], v[68:71], a[208:215], v25
 v_smfmac_f32_16x16x64_f16 v[100:103], v[72:75], a[216:223], v25
 v_smfmac_f32_16x16x64_f16 v[104:107], v[72:75], a[224:231], v25
 v_smfmac_f32_16x16x64_f16 v[108:111], v[72:75], a[232:239], v25
 s_waitcnt lgkmcnt(4)
 v_smfmac_f32_16x16x64_f16 v[100:103], v[76:79], a[240:247], v25
 v_smfmac_f32_16x16x64_f16 v[104:107], v[76:79], a[248:255], v25
 v_smfmac_f32_16x16x64_f16 v[108:111], v[76:79], v[152:159], v25
 v_smfmac_f32_16x16x64_f16 v[100:103], v[80:83], v[160:167], v25
 v_smfmac_f32_16x16x64_f16 v[104:107], v[80:83], v[168:175], v25
 buffer_load_dwordx2 v[58:59], v9, s[8:11], s81 offen sc1
 buffer_load_dwordx4 v[40:43], v8, s[8:11], s81 offen offset:0 sc1
 buffer_load_dwordx4 v[44:47], v8, s[8:11], s81 offen offset:1024 sc1
 v_smfmac_f32_16x16x64_f16 v[108:111], v[80:83], v[176:183], v25
 v_smfmac_f32_16x16x64_f16 v[100:103], v[84:87], v[184:191], v25
 v_smfmac_f32_16x16x64_f16 v[104:107], v[84:87], v[192:199], v25
 v_smfmac_f32_16x16x64_f16 v[108:111], v[84:87], v[200:207], v25
 s_waitcnt lgkmcnt(0)
 v_smfmac_f32_16x16x64_f16 v[100:103], v[88:91], v[208:215], v25
 v_smfmac_f32_16x16x64_f16 v[104:107], v[88:91], v[216:223], v25
 v_smfmac_f32_16x16x64_f16 v[108:111], v[88:91], v[224:231], v25
 v_smfmac_f32_16x16x64_f16 v[100:103], v[92:95], v[232:239], v25
 v_smfmac_f32_16x16x64_f16 v[104:107], v[92:95], v[240:247], v25
 v_smfmac_f32_16x16x64_f16 v[108:111], v[92:95], v[248:255], v25
 s_cmp_lt_i32 s56, 0
 s_cbranch_scc1 kvw_43
kvok_44:
 s_waitcnt vmcnt(2)
 v_xor_b32 v76, s88, v58
 s_nop 0
 v_permlane16_swap_b32 v58, v59
 v_fma_mix_f32 v60, v58, 1.0, v59 op_sel:[0,0,0] op_sel_hi:[1,0,1]
 v_fma_mix_f32 v61, v58, 1.0, v59 op_sel:[1,0,1] op_sel_hi:[1,0,1]
 v_mov_b32 v58, v60
 v_mov_b32 v59, v61
 s_nop 0
 v_permlane32_swap_b32 v58, v60
 v_permlane32_swap_b32 v59, v61
 v_add_f32 v52, v58, v60
 v_add_f32 v53, v59, v61
 v_max_f32 v79, v52, v53
 s_waitcnt vmcnt(0)
 v_pk_add_f16 v80, v40, v44
 v_pk_add_f16 v82, v42, v46
 v_pk_add_f16 v81, v41, v45
 v_pk_add_f16 v83, v43, v47
 v_permlane32_swap_b32 v80, v82
 v_bitop3_b32 v77, v40, v42, s88 bitop3:0x7e
 v_permlane32_swap_b32 v81, v83
 v_bitop3_b32 v78, v44, v46, s88 bitop3:0x7e
 v_fma_mix_f32 v48, v80, 1.0, v82 op_sel:[0,0,0] op_sel_hi:[1,0,1]
 v_or3_b32 v27, v76, v77, v78
 v_fma_mix_f32 v49, v80, 1.0, v82 op_sel:[1,0,1] op_sel_hi:[1,0,1]
 v_and_b32 v27, 1, v27
 v_fma_mix_f32 v50, v81, 1.0, v83 op_sel:[0,0,0] op_sel_hi:[1,0,1]
 v_cmp_ne_u32 vcc, 0, v27
 v_fma_mix_f32 v51, v81, 1.0, v83 op_sel:[1,0,1] op_sel_hi:[1,0,1]
 v_max3_f32 v62, v48, v49, v79
 s_cbranch_vccnz psr_41
psj_42:
 v_max3_f32 v62, v62, v50, v51
 v_cvt_pk_bf16_f32 v146, v100, v101
 v_cvt_pk_bf16_f32 v147, v102, v103
 v_max_f32_dpp v62, v62, v62 row_ror:8 row_mask:0xf bank_mask:0xf
 v_mov_b32 v63, v62
 v_cvt_pk_bf16_f32 v148, v104, v105
 v_cvt_pk_bf16_f32 v149, v106, v107
 v_permlane32_swap_b32 v62, v63
 v_max_f32 v62, v62, v63
 v_mov_b32 v63, v62
 v_cvt_pk_bf16_f32 v150, v108, v109
 v_cvt_pk_bf16_f32 v151, v110, v111
 v_permlane16_swap_b32 v62, v63
 v_max_f32 v62, v62, v63
 v_mul_f32 v62, s86, v62
 v_fma_f32 v48, v48, s86, -v62
 v_fma_f32 v49, v49, s86, -v62
 v_fma_f32 v50, v50, s86, -v62
 v_fma_f32 v51, v51, s86, -v62
 v_fma_f32 v52, v52, s86, -v62
 v_fma_f32 v53, v53, s86, -v62
 v_exp_f32 v48, v48
 v_exp_f32 v49, v49
 buffer_load_dwordx4 v[88:91], v17, s[28:31], s64 offen offset:0 sc1
 v_exp_f32 v50, v50
 v_exp_f32 v51, v51
 buffer_load_dwordx4 v[92:95], v16, s[28:31], s64 offen offset:1024 sc1
 v_exp_f32 v52, v52
 v_exp_f32 v53, v53
 buffer_load_dwordx4 v[96:99], v20, s[28:31], s64 offen offset:2048 sc1
 v_cvt_pk_bf16_f32 v138, v48, v49
 v_cvt_pk_bf16_f32 v139, v50, v51
 v_cvt_pk_bf16_f32 v142, v52, v53
 v_mov_b32_dpp v140, v138 row_ror:8 row_mask:0xf bank_mask:0xf
 v_mov_b32_dpp v141, v139 row_ror:8 row_mask:0xf bank_mask:0xf
 v_mov_b32_dpp v143, v142 row_ror:8 row_mask:0xf bank_mask:0xf
 buffer_load_dwordx4 v[112:115], v18, s[16:19], s80 offen sc1
 v_add_f32 v54, v48, v49
 v_mfma_f32_16x16x32_bf16 v[64:67], v[126:129], v[138:141], 0
 v_add_f32 v55, v50, v51
 v_add_f32 v56, v52, v53
 v_mfma_f32_16x16x32_bf16 v[64:67], v[146:149], v[142:145], v[64:67]
 v_add_f32 v62, v54, v55
 v_fmac_f32 v62, v56, v26
 v_mfma_f32_16x16x32_bf16 v[68:71], v[130:133], v[138:141], 0
 buffer_load_dwordx2 v[116:117], v19, s[16:19], s80 offen sc1
 v_add_f32_dpp v62, v62, v62 row_ror:8 row_mask:0xf bank_mask:0xf
 v_mfma_f32_16x16x32_bf16 v[68:71], v[148:151], v[142:145], v[68:71]
 v_mov_b32 v63, v62
 s_cmp_lt_i32 s55, 0
 s_cbranch_scc1 fl_45
fl_46:
 v_mfma_f32_16x16x32_bf16 v[72:75], v[134:137], v[138:141], 0
 v_permlane32_swap_b32 v62, v63
 v_mfma_f32_16x16x32_bf16 v[72:75], v[150:153], v[142:145], v[72:75]
 v_add_f32 v62, v62, v63
 v_mov_b32 v63, v62
 ds_write_b128 v11, v[64:67] offset:0
 s_nop 0
 v_permlane16_swap_b32 v62, v63
 v_add_f32 v62, v62, v63
 v_rcp_f32 v62, v62
 ds_write_b128 v11, v[68:71] offset:1024
 s_mov_b64 exec, 0xff
 ds_write_b32 v22, v62
 s_mov_b64 exec, -1
 ds_write_b128 v11, v[72:75] offset:2048
 s_waitcnt lgkmcnt(0)
 s_barrier
 ds_read_b128 v[72:75], v23
 ds_read_b64 v[64:65], v12 offset:0
 ds_read_b64 v[66:67], v12 offset:3072
 ds_read_b64 v[68:69], v12 offset:6144
 ds_read_b64 v[70:71], v12 offset:9216
 s_waitcnt lgkmcnt(2)
 v_pk_mul_f32 v[64:65], v[64:65], v[72:73] op_sel_hi:[1,0]
 v_pk_fma_f32 v[64:65], v[66:67], v[72:73], v[64:65] op_sel:[0,1,0] op_sel_hi:[1,1,1]
 s_waitcnt lgkmcnt(0)
 v_pk_fma_f32 v[64:65], v[68:69], v[74:75], v[64:65] op_sel_hi:[1,0,1]
 v_pk_fma_f32 v[64:65], v[70:71], v[74:75], v[64:65] op_sel:[0,1,0] op_sel_hi:[1,1,1]
 v_cvt_pk_f16_f32 v68, v64, v65
 v_perm_b32 v68, s91, v68, v14
 buffer_atomic_pk_add_f16 v68, v13, s[4:7], s3 offen
 v_mov_b32 v76, v108
 v_mov_b32 v77, v109
 v_mov_b32 v78, v110
 v_mov_b32 v79, v111
 v_permlane32_swap_b32 v100, v104
 v_permlane32_swap_b32 v101, v105
 v_permlane32_swap_b32 v102, v106
 v_permlane32_swap_b32 v103, v107
 v_permlane32_swap_b32 v108, v76
 v_permlane32_swap_b32 v109, v77
 v_permlane32_swap_b32 v110, v78
 v_permlane32_swap_b32 v111, v79
 v_pk_add_f32 v[100:101], v[100:101], v[104:105]
 v_pk_add_f32 v[102:103], v[102:103], v[106:107]
 v_pk_add_f32 v[108:109], v[108:109], v[76:77]
 v_pk_add_f32 v[110:111], v[110:111], v[78:79]
 v_cvt_pk_bf16_f32 v80, v100, v101
 v_cvt_pk_bf16_f32 v82, v108, v109
 v_cvt_pk_bf16_f32 v81, v102, v103
 v_cvt_pk_bf16_f32 v83, v110, v111
 s_nop 0
 v_permlane16_swap_b32 v80, v82
 v_permlane16_swap_b32 v81, v83
 v_min_u32 v80, -2, v80
 s_mov_b64 exec, s[76:77]
 buffer_store_dwordx4 v[80:83], v15, s[24:27], s57 offen sc1
 s_mov_b64 exec, -1
 s_add_u32 s64, s64, 1310720
 s_add_u32 s52, s52, 1
 s_branch step_34
fl_39:
 buffer_load_dword v0, off, s[12:15], s79 sc1
 s_branch fl_40
A1_14:
 v_smfmac_f32_16x16x32_f16 v[40:43], v[36:37], a[16:19], v25
 v_smfmac_f32_16x16x32_f16 v[52:55], v[36:37], a[76:79], v25
 v_smfmac_f32_16x16x32_f16 v[44:47], v[36:37], a[36:39], v25
 v_smfmac_f32_16x16x32_f16 v[56:59], v[36:37], a[96:99], v25
 s_branch A2_38
pm_37:
 buffer_load_dwordx4 v[36:39], v4, s[4:7], s84 offen offset:2048 sc1
 buffer_load_dwordx4 v[28:31], v4, s[4:7], s84 offen offset:0 sc1
 buffer_load_dwordx4 v[32:35], v4, s[4:7], s84 offen offset:1024 sc1
 s_nop 7
 v_mov_b32 v40, 0
 v_mov_b32 v41, 0
 v_mov_b32 v42, 0
 v_mov_b32 v43, 0
 v_mov_b32 v52, 0
 v_mov_b32 v53, 0
 v_mov_b32 v54, 0
 v_mov_b32 v55, 0
 v_mov_b32 v44, 0
 v_mov_b32 v45, 0
 v_mov_b32 v46, 0
 v_mov_b32 v47, 0
 v_mov_b32 v56, 0
 v_mov_b32 v57, 0
 v_mov_b32 v58, 0
 v_mov_b32 v59, 0
 s_waitcnt vmcnt(0)
 v_bitop3_b32 v27, v31, v35, v39 bitop3:0x80
 v_perm_b32 v31, v35, v31, s89
 v_cmp_gt_u32 vcc, 0x48000000, v27
 v_mov_b32 v35, v38
 s_cbranch_vccz A1_14
pm_36:
 s_cmp_gt_u32 s52, 3
 s_cbranch_scc1 op_47
 v_readfirstlane_b32 s21, v0
 s_cmp_ge_u32 s21, s46
 s_cbranch_scc1 op_47
 buffer_load_dword v0, off, s[12:15], s79 sc1
 s_waitcnt vmcnt(0)
 v_readfirstlane_b32 s21, v0
 s_cmp_gt_u32 s21, s52
 s_cselect_b32 s21, s87, 0
 s_cmp_eq_u32 s21, 0
 s_cbranch_scc1 op_47
 s_mov_b32 s87, 0
 s_sub_u32 s21, s64, 1310720
 buffer_load_dwordx4 v[126:129], v16, s[28:31], s21 offen offset:0 sc1
 buffer_load_dwordx4 v[130:133], v16, s[28:31], s21 offen offset:1024 sc1
 buffer_load_dwordx4 v[134:137], v16, s[28:31], s21 offen offset:2048 sc1
op_47:
 buffer_load_dwordx4 v[36:39], v4, s[4:7], s84 offen offset:2048 sc1
 buffer_load_dwordx4 v[28:31], v4, s[4:7], s84 offen offset:0 sc1
 buffer_load_dwordx4 v[32:35], v4, s[4:7], s84 offen offset:1024 sc1
 s_add_u32 s54, s54, 1
 s_cmp_gt_u32 s54, 131072
 s_cbranch_scc1 end0
 s_waitcnt vmcnt(0)
 v_bitop3_b32 v27, v31, v35, v39 bitop3:0x80
 v_perm_b32 v31, v35, v31, s89
 v_cmp_gt_u32 vcc, 0x48000000, v27
 v_mov_b32 v35, v38
 s_cbranch_vccnz pm_36
 s_branch A1_14
psr_41:
 buffer_load_dwordx2 v[58:59], v9, s[8:11], s81 offen sc1
 buffer_load_dwordx4 v[40:43], v8, s[8:11], s81 offen offset:0 sc1
 buffer_load_dwordx4 v[44:47], v8, s[8:11], s81 offen offset:1024 sc1
 s_add_u32 s54, s54, 1
 s_cmp_gt_u32 s54, 131072
 s_cbranch_scc1 end0
 s_waitcnt vmcnt(2)
 v_xor_b32 v76, s88, v58
 s_nop 0
 v_permlane16_swap_b32 v58, v59
 v_fma_mix_f32 v60, v58, 1.0, v59 op_sel:[0,0,0] op_sel_hi:[1,0,1]
 v_fma_mix_f32 v61, v58, 1.0, v59 op_sel:[1,0,1] op_sel_hi:[1,0,1]
 v_mov_b32 v58, v60
 v_mov_b32 v59, v61
 s_nop 0
 v_permlane32_swap_b32 v58, v60
 v_permlane32_swap_b32 v59, v61
 v_add_f32 v52, v58, v60
 v_add_f32 v53, v59, v61
 v_max_f32 v79, v52, v53
 s_waitcnt vmcnt(0)
 v_pk_add_f16 v80, v40, v44
 v_pk_add_f16 v82, v42, v46
 v_pk_add_f16 v81, v41, v45
 v_pk_add_f16 v83, v43, v47
 v_permlane32_swap_b32 v80, v82
 v_bitop3_b32 v77, v40, v42, s88 bitop3:0x7e
 v_permlane32_swap_b32 v81, v83
 v_bitop3_b32 v78, v44, v46, s88 bitop3:0x7e
 v_fma_mix_f32 v48, v80, 1.0, v82 op_sel:[0,0,0] op_sel_hi:[1,0,1]
 v_or3_b32 v27, v76, v77, v78
 v_fma_mix_f32 v49, v80, 1.0, v82 op_sel:[1,0,1] op_sel_hi:[1,0,1]
 v_and_b32 v27, 1, v27
 v_fma_mix_f32 v50, v81, 1.0, v83 op_sel:[0,0,0] op_sel_hi:[1,0,1]
 v_cmp_ne_u32 vcc, 0, v27
 v_fma_mix_f32 v51, v81, 1.0, v83 op_sel:[1,0,1] op_sel_hi:[1,0,1]
 v_max3_f32 v62, v48, v49, v79
 s_cbranch_vccnz psr_41
 s_branch psj_42
kvw_43:
 s_mov_b32 s22, s87
 s_cmp_eq_u32 s52, 0
 s_cselect_b32 s55, 0, s55
 s_cselect_b32 s87, 1, 0
 s_cbranch_scc1 kvok_44
 v_mov_b32 v62, 0
 s_mov_b32 s101, 0
wf_48:
 buffer_load_dword v63, v62, s[12:15], s79 offen sc1
 s_add_u32 s101, s101, 1
 s_cmp_gt_u32 s101, 131072
 s_cbranch_scc1 end0
 s_waitcnt vmcnt(0)
 v_readfirstlane_b32 s100, v63
 s_cmp_ge_u32 s100, s46
 s_cbranch_scc1 wf_49
 s_sleep 3
 s_branch wf_48
wf_49:
 s_cmp_eq_u32 s22, 0
 s_cbranch_scc1 kvok_44
 s_sub_u32 s21, s64, 1310720
 buffer_load_dwordx4 v[126:129], v16, s[28:31], s21 offen offset:0 sc1
 buffer_load_dwordx4 v[130:133], v16, s[28:31], s21 offen offset:1024 sc1
 buffer_load_dwordx4 v[134:137], v16, s[28:31], s21 offen offset:2048 sc1
 s_waitcnt vmcnt(0)
 s_branch kvok_44
fl_45:
 buffer_load_dword v0, off, s[12:15], s79 sc1
 s_branch fl_46
last_35:
 s_waitcnt lgkmcnt(10)
 v_smfmac_f32_16x16x64_f16 v[100:103], v[28:31], a[120:127], v25
 v_smfmac_f32_16x16x64_f16 v[104:107], v[28:31], a[128:135], v25
 v_smfmac_f32_16x16x64_f16 v[108:111], v[28:31], a[136:143], v25
 v_smfmac_f32_16x16x64_f16 v[100:103], v[32:35], a[144:151], v25
 v_smfmac_f32_16x16x64_f16 v[104:107], v[32:35], a[152:159], v25
 v_smfmac_f32_16x16x64_f16 v[108:111], v[32:35], a[160:167], v25
 s_waitcnt lgkmcnt(7)
 v_smfmac_f32_16x16x64_f16 v[100:103], v[64:67], a[168:175], v25
 v_smfmac_f32_16x16x64_f16 v[104:107], v[64:67], a[176:183], v25
 v_smfmac_f32_16x16x64_f16 v[108:111], v[64:67], a[184:191], v25
 v_smfmac_f32_16x16x64_f16 v[100:103], v[68:71], a[192:199], v25
 v_smfmac_f32_16x16x64_f16 v[104:107], v[68:71], a[200:207], v25
 v_smfmac_f32_16x16x64_f16 v[108:111], v[68:71], a[208:215], v25
 v_smfmac_f32_16x16x64_f16 v[100:103], v[72:75], a[216:223], v25
 v_smfmac_f32_16x16x64_f16 v[104:107], v[72:75], a[224:231], v25
 v_smfmac_f32_16x16x64_f16 v[108:111], v[72:75], a[232:239], v25
 s_waitcnt lgkmcnt(4)
 v_smfmac_f32_16x16x64_f16 v[100:103], v[76:79], a[240:247], v25
 v_smfmac_f32_16x16x64_f16 v[104:107], v[76:79], a[248:255], v25
 v_smfmac_f32_16x16x64_f16 v[108:111], v[76:79], v[152:159], v25
 v_smfmac_f32_16x16x64_f16 v[100:103], v[80:83], v[160:167], v25
 v_smfmac_f32_16x16x64_f16 v[104:107], v[80:83], v[168:175], v25
 v_smfmac_f32_16x16x64_f16 v[108:111], v[80:83], v[176:183], v25
 v_smfmac_f32_16x16x64_f16 v[100:103], v[84:87], v[184:191], v25
 v_smfmac_f32_16x16x64_f16 v[104:107], v[84:87], v[192:199], v25
 v_smfmac_f32_16x16x64_f16 v[108:111], v[84:87], v[200:207], v25
 s_waitcnt lgkmcnt(0)
 v_smfmac_f32_16x16x64_f16 v[100:103], v[88:91], v[208:215], v25
 v_smfmac_f32_16x16x64_f16 v[104:107], v[88:91], v[216:223], v25
 v_smfmac_f32_16x16x64_f16 v[108:111], v[88:91], v[224:231], v25
 v_smfmac_f32_16x16x64_f16 v[100:103], v[92:95], v[232:239], v25
 v_smfmac_f32_16x16x64_f16 v[104:107], v[92:95], v[240:247], v25
 v_smfmac_f32_16x16x64_f16 v[108:111], v[92:95], v[248:255], v25
 s_nop 7
 v_mov_b32 v76, v108
 v_mov_b32 v77, v109
 v_mov_b32 v78, v110
 v_mov_b32 v79, v111
 v_permlane32_swap_b32 v100, v104
 v_permlane32_swap_b32 v101, v105
 v_permlane32_swap_b32 v102, v106
 v_permlane32_swap_b32 v103, v107
 v_permlane32_swap_b32 v108, v76
 v_permlane32_swap_b32 v109, v77
 v_permlane32_swap_b32 v110, v78
 v_permlane32_swap_b32 v111, v79
 v_pk_add_f32 v[100:101], v[100:101], v[104:105]
 v_pk_add_f32 v[102:103], v[102:103], v[106:107]
 v_pk_add_f32 v[108:109], v[108:109], v[76:77]
 v_pk_add_f32 v[110:111], v[110:111], v[78:79]
 v_cvt_pk_bf16_f32 v80, v100, v101
 v_cvt_pk_bf16_f32 v82, v108, v109
 v_cvt_pk_bf16_f32 v81, v102, v103
 v_cvt_pk_bf16_f32 v83, v110, v111
 s_nop 0
 v_permlane16_swap_b32 v80, v82
 v_permlane16_swap_b32 v81, v83
 v_min_u32 v80, -2, v80
 s_mov_b64 exec, s[76:77]
 buffer_store_dwordx4 v[80:83], v15, s[24:27], s57 offen sc1
 s_mov_b64 exec, -1
 s_branch chain_done
step_50:
 s_and_b32 s21, s52, 3
 s_mul_i32 s81, s21, 540672
 s_lshl_b32 s84, s21, 15
 s_add_u32 s21, s52, 3
 s_and_b32 s21, s21, 3
 s_lshl_b32 s83, s21, 15
 s_add_u32 s21, s52, 1
 s_and_b32 s22, s21, 3
 s_lshl_b32 s3, s22, 15
 s_mul_i32 s80, s21, 393216
 s_add_u32 s46, s21, 1
 s_min_u32 s46, s46, 64
 s_mul_i32 s85, s52, 98304
 s_mul_i32 s57, s52, 327680
 s_add_u32 s57, s57, 51380224
 s_bfe_u32 s88, s52, 0x10002
 s_max_u32 s67, s52, 1
 s_sub_u32 s67, s67, 1
 v_mov_b32 v40, 0
 v_mov_b32 v41, 0
 v_mov_b32 v42, 0
 v_mov_b32 v43, 0
 v_mov_b32 v44, 0
 v_mov_b32 v45, 0
 v_mov_b32 v46, 0
 v_mov_b32 v47, 0
 v_mov_b32 v48, 0
 v_mov_b32 v49, 0
 v_mov_b32 v50, 0
 v_mov_b32 v51, 0
 v_mov_b32 v52, 0
 v_mov_b32 v53, 0
 v_mov_b32 v54, 0
 v_mov_b32 v55, 0
 v_mov_b32 v56, 0
 v_mov_b32 v57, 0
 v_mov_b32 v58, 0
 v_mov_b32 v59, 0
 v_mov_b32 v60, 0
 v_mov_b32 v61, 0
 v_mov_b32 v62, 0
 v_mov_b32 v63, 0
 v_mov_b32 v100, 0
 v_mov_b32 v101, 0
 v_mov_b32 v102, 0
 v_mov_b32 v103, 0
 v_mov_b32 v104, 0
 v_mov_b32 v105, 0
 v_mov_b32 v106, 0
 v_mov_b32 v107, 0
 v_mov_b32 v108, 0
 v_mov_b32 v109, 0
 v_mov_b32 v110, 0
 v_mov_b32 v111, 0
 s_sleep 4
 s_nop 3
 v_readfirstlane_b32 s21, v0
 s_cmp_lt_u32 s21, s46
 s_cselect_b32 s55, s55, 0
 s_cmp_lt_i32 s55, 0
 s_cbranch_scc1 fl_55
fl_56:
 s_mov_b32 s54, 0
 buffer_load_dwordx4 v[36:39], v4, s[4:7], s84 offen offset:2048 sc1
 buffer_load_dwordx4 v[28:31], v4, s[4:7], s84 offen offset:0 sc1
 buffer_load_dwordx4 v[32:35], v4, s[4:7], s84 offen offset:1024 sc1
 s_waitcnt vmcnt(3)
 v_mov_b32 v126, v88
 v_mov_b32 v127, v89
 v_mov_b32 v128, v90
 v_mov_b32 v129, v91
 v_mov_b32 v130, v92
 v_mov_b32 v131, v93
 v_mov_b32 v132, v94
 v_mov_b32 v133, v95
 v_mov_b32 v134, v96
 v_mov_b32 v135, v97
 v_mov_b32 v136, v98
 v_mov_b32 v137, v99
 s_waitcnt vmcnt(2)
 v_smfmac_f32_16x16x32_f16 v[40:43], v[36:37], a[16:19], v25
 v_smfmac_f32_16x16x32_f16 v[52:55], v[36:37], a[76:79], v25
 v_smfmac_f32_16x16x32_f16 v[44:47], v[36:37], a[36:39], v25
 s_waitcnt vmcnt(0)
 v_bitop3_b32 v27, v31, v35, v39 bitop3:0x80
 v_perm_b32 v31, v35, v31, s89
 v_cmp_gt_u32 vcc, 0x48000000, v27
 v_mov_b32 v35, v38
 v_smfmac_f32_16x16x32_f16 v[56:59], v[36:37], a[96:99], v25
 s_cbranch_vccnz pm_53
A2_54:
 v_smfmac_f32_16x16x64_f16 v[40:43], v[28:31], a[0:7], v25
 ds_write_b128 v10, v[28:31]
 v_smfmac_f32_16x16x64_f16 v[40:43], v[32:35], a[8:15], v25
 ds_write_b128 v10, v[32:35] offset:1024
 v_smfmac_f32_16x16x64_f16 v[52:55], v[28:31], a[60:67], v25
 ds_write_b64 v10, v[36:37] offset:2048
 v_smfmac_f32_16x16x64_f16 v[52:55], v[32:35], a[68:75], v25
 v_cvt_pk_f16_f32 v40, v40, v41
 v_cvt_pk_f16_f32 v41, v42, v43
 v_smfmac_f32_16x16x32_f16 v[48:51], v[36:37], a[56:59], v25
 v_smfmac_f32_16x16x32_f16 v[60:63], v[36:37], a[116:119], v25
 v_smfmac_f32_16x16x64_f16 v[44:47], v[28:31], a[20:27], v25
 v_cvt_pk_f16_f32 v52, v52, v53
 v_cvt_pk_f16_f32 v53, v54, v55
 s_nop 0
 v_smfmac_f32_16x16x64_f16 v[44:47], v[32:35], a[28:35], v25
 v_permlane32_swap_b32 v40, v52
 v_smfmac_f32_16x16x64_f16 v[56:59], v[28:31], a[80:87], v25
 v_permlane32_swap_b32 v41, v53
 v_pk_add_f16 v40, v40, v52
 v_smfmac_f32_16x16x64_f16 v[56:59], v[32:35], a[88:95], v25
 v_pk_add_f16 v41, v41, v53
 v_smfmac_f32_16x16x64_f16 v[48:51], v[28:31], a[40:47], v25
 ds_write_b64 v5, v[40:41] offset:0
 v_smfmac_f32_16x16x64_f16 v[48:51], v[32:35], a[48:55], v25
 v_cvt_pk_f16_f32 v44, v44, v45
 v_cvt_pk_f16_f32 v45, v46, v47
 v_cvt_pk_f16_f32 v56, v56, v57
 v_smfmac_f32_16x16x64_f16 v[60:63], v[28:31], a[100:107], v25
 v_cvt_pk_f16_f32 v57, v58, v59
 s_nop 0
 v_smfmac_f32_16x16x64_f16 v[60:63], v[32:35], a[108:115], v25
 v_permlane32_swap_b32 v44, v56
 v_permlane32_swap_b32 v45, v57
 v_pk_add_f16 v44, v44, v56
 v_pk_add_f16 v45, v45, v57
 ds_write_b64 v5, v[44:45] offset:640
 v_cvt_pk_f16_f32 v48, v48, v49
 v_cvt_pk_f16_f32 v49, v50, v51
 v_cvt_pk_f16_f32 v60, v60, v61
 v_cvt_pk_f16_f32 v61, v62, v63
 s_nop 0
 v_permlane32_swap_b32 v48, v60
 v_permlane32_swap_b32 v49, v61
 v_pk_add_f16 v48, v48, v60
 v_pk_add_f16 v49, v49, v61
 ds_write_b64 v5, v[48:49] offset:1280
 s_waitcnt lgkmcnt(0) vmcnt(0)
 s_barrier
 ds_read_b64_tr_b16 v[40:41], v6 offset:0
 ds_read_b64_tr_b16 v[42:43], v6 offset:1920
 ds_read_b64_tr_b16 v[44:45], v6 offset:3840
 ds_read_b64_tr_b16 v[46:47], v6 offset:5760
 ds_read_b64_tr_b16 v[48:49], v6 offset:640
 ds_read_b64_tr_b16 v[50:51], v6 offset:2560
 ds_read_b64_tr_b16 v[52:53], v6 offset:4480
 ds_read_b64_tr_b16 v[54:55], v6 offset:6400
 ds_read_b64_tr_b16 v[56:57], v6 offset:1280
 ds_read_b64_tr_b16 v[58:59], v6 offset:3200
 ds_read_b64_tr_b16 v[60:61], v6 offset:5120
 ds_read_b64_tr_b16 v[62:63], v6 offset:7040
 s_waitcnt lgkmcnt(8)
 v_pk_add_f16 v40, v40, v42
 v_pk_add_f16 v44, v44, v46
 v_pk_add_f16 v41, v41, v43
 v_pk_add_f16 v45, v45, v47
 v_fma_mix_f32 v146, v40, 1.0, v44 op_sel:[0,0,0] op_sel_hi:[1,0,1]
 v_fma_mix_f32 v147, v40, 1.0, v44 op_sel:[1,0,1] op_sel_hi:[1,0,1]
 v_fma_mix_f32 v148, v41, 1.0, v45 op_sel:[0,0,0] op_sel_hi:[1,0,1]
 v_fma_mix_f32 v149, v41, 1.0, v45 op_sel:[1,0,1] op_sel_hi:[1,0,1]
 v_cvt_pk_bf16_f32 v118, v146, v147
 v_cvt_pk_bf16_f32 v119, v148, v149
 s_waitcnt lgkmcnt(4)
 v_pk_add_f16 v48, v48, v50
 v_pk_add_f16 v52, v52, v54
 v_pk_add_f16 v49, v49, v51
 v_pk_add_f16 v53, v53, v55
 v_fma_mix_f32 v146, v48, 1.0, v52 op_sel:[0,0,0] op_sel_hi:[1,0,1]
 v_fma_mix_f32 v147, v48, 1.0, v52 op_sel:[1,0,1] op_sel_hi:[1,0,1]
 v_fma_mix_f32 v148, v49, 1.0, v53 op_sel:[0,0,0] op_sel_hi:[1,0,1]
 v_fma_mix_f32 v149, v49, 1.0, v53 op_sel:[1,0,1] op_sel_hi:[1,0,1]
 v_cvt_pk_bf16_f32 v120, v146, v147
 v_cvt_pk_bf16_f32 v121, v148, v149
 s_waitcnt lgkmcnt(0)
 v_pk_add_f16 v56, v56, v58
 v_pk_add_f16 v60, v60, v62
 v_pk_add_f16 v57, v57, v59
 v_pk_add_f16 v61, v61, v63
 v_fma_mix_f32 v146, v56, 1.0, v60 op_sel:[0,0,0] op_sel_hi:[1,0,1]
 v_fma_mix_f32 v147, v56, 1.0, v60 op_sel:[1,0,1] op_sel_hi:[1,0,1]
 v_mfma_f32_16x16x32_bf16 v[40:43], v[118:121], v[118:121], 0
 v_fma_mix_f32 v148, v57, 1.0, v61 op_sel:[0,0,0] op_sel_hi:[1,0,1]
 v_fma_mix_f32 v149, v57, 1.0, v61 op_sel:[1,0,1] op_sel_hi:[1,0,1]
 v_cvt_pk_bf16_f32 v122, v146, v147
 v_cvt_pk_bf16_f32 v123, v148, v149
 s_nop 1
 v_mfma_f32_16x16x32_bf16 v[40:43], v[122:125], v[122:125], v[40:43]
 ds_read_b128 v[28:31], v16 offset:24576
 ds_read_b128 v[32:35], v16 offset:25600
 ds_read_b128 v[64:67], v16 offset:27648
 ds_read_b128 v[68:71], v16 offset:28672
 ds_read_b128 v[72:75], v16 offset:30720
 ds_read_b128 v[76:79], v16 offset:31744
 s_nop 0
 s_mov_b64 exec, s[74:75]
 v_cvt_pk_f16_f32 v44, v40, v41
 v_cvt_pk_f16_f32 v45, v42, v43
 v_and_or_b32 v44, v44, -2, s88
 buffer_store_dwordx2 v[44:45], v7, s[8:11], s81 offen
 s_mov_b64 exec, -1
 ds_read_b128 v[80:83], v16 offset:33792
 ds_read_b128 v[84:87], v16 offset:34816
 ds_read_b64 v[88:89], v16 offset:26624
 ds_read_b64 v[90:91], v16 offset:29696
 ds_read_b64 v[92:93], v16 offset:32768
 ds_read_b64 v[94:95], v16 offset:35840
 s_cmp_eq_u32 s52, 63
 s_cbranch_scc1 last_51
 s_waitcnt lgkmcnt(10)
 v_smfmac_f32_16x16x64_f16 v[100:103], v[28:31], a[120:127], v25
 v_smfmac_f32_16x16x64_f16 v[104:107], v[28:31], a[128:135], v25
 v_smfmac_f32_16x16x64_f16 v[108:111], v[28:31], a[136:143], v25
 s_mov_b32 s54, 0
 v_smfmac_f32_16x16x64_f16 v[100:103], v[32:35], a[144:151], v25
 v_readfirstlane_b32 s21, v0
 v_smfmac_f32_16x16x64_f16 v[104:107], v[32:35], a[152:159], v25
 s_add_u32 s22, s46, 3
 v_smfmac_f32_16x16x64_f16 v[108:111], v[32:35], a[160:167], v25
 s_min_u32 s22, s22, 64
 s_waitcnt lgkmcnt(7)
 v_smfmac_f32_16x16x64_f16 v[100:103], v[64:67], a[168:175], v25
 s_sub_u32 s55, s21, s22
 v_smfmac_f32_16x16x64_f16 v[104:107], v[64:67], a[176:183], v25
 s_sub_u32 s56, s21, s46
 v_smfmac_f32_16x16x64_f16 v[108:111], v[64:67], a[184:191], v25
 v_smfmac_f32_16x16x64_f16 v[100:103], v[68:71], a[192:199], v25
 v_smfmac_f32_16x16x64_f16 v[104:107], v[68:71], a[200:207], v25
 v_smfmac_f32_16x16x64_f16 v[108:111], v[68:71], a[208:215], v25
 v_smfmac_f32_16x16x64_f16 v[100:103], v[72:75], a[216:223], v25
 v_smfmac_f32_16x16x64_f16 v[104:107], v[72:75], a[224:231], v25
 v_smfmac_f32_16x16x64_f16 v[108:111], v[72:75], a[232:239], v25
 s_waitcnt lgkmcnt(4)
 v_smfmac_f32_16x16x64_f16 v[100:103], v[76:79], a[240:247], v25
 v_smfmac_f32_16x16x64_f16 v[104:107], v[76:79], a[248:255], v25
 v_smfmac_f32_16x16x64_f16 v[108:111], v[76:79], v[152:159], v25
 buffer_load_dwordx2 v[58:59], v9, s[8:11], s81 offen sc1
 buffer_load_dwordx4 v[40:43], v8, s[8:11], s81 offen offset:0 sc1
 buffer_load_dwordx4 v[44:47], v8, s[8:11], s81 offen offset:1024 sc1
 v_smfmac_f32_16x16x64_f16 v[100:103], v[80:83], v[160:167], v25
 v_smfmac_f32_16x16x64_f16 v[104:107], v[80:83], v[168:175], v25
 v_smfmac_f32_16x16x64_f16 v[108:111], v[80:83], v[176:183], v25
 v_smfmac_f32_16x16x64_f16 v[100:103], v[84:87], v[184:191], v25
 v_smfmac_f32_16x16x64_f16 v[104:107], v[84:87], v[192:199], v25
 v_smfmac_f32_16x16x64_f16 v[108:111], v[84:87], v[200:207], v25
 s_waitcnt lgkmcnt(0)
 v_smfmac_f32_16x16x64_f16 v[100:103], v[88:91], v[208:215], v25
 v_smfmac_f32_16x16x64_f16 v[104:107], v[88:91], v[216:223], v25
 v_smfmac_f32_16x16x64_f16 v[108:111], v[88:91], v[224:231], v25
 v_smfmac_f32_16x16x64_f16 v[100:103], v[92:95], v[232:239], v25
 v_smfmac_f32_16x16x64_f16 v[104:107], v[92:95], v[240:247], v25
 v_smfmac_f32_16x16x64_f16 v[108:111], v[92:95], v[248:255], v25
 s_cmp_lt_i32 s56, 0
 s_cbranch_scc1 kvw_59
kvok_60:
 s_waitcnt vmcnt(2)
 v_xor_b32 v76, s88, v58
 s_nop 0
 v_permlane16_swap_b32 v58, v59
 v_fma_mix_f32 v60, v58, 1.0, v59 op_sel:[0,0,0] op_sel_hi:[1,0,1]
 v_fma_mix_f32 v61, v58, 1.0, v59 op_sel:[1,0,1] op_sel_hi:[1,0,1]
 v_mov_b32 v58, v60
 v_mov_b32 v59, v61
 s_nop 0
 v_permlane32_swap_b32 v58, v60
 v_permlane32_swap_b32 v59, v61
 v_add_f32 v52, v58, v60
 v_add_f32 v53, v59, v61
 v_max_f32 v79, v52, v53
 s_waitcnt vmcnt(0)
 v_pk_add_f16 v80, v40, v44
 v_pk_add_f16 v82, v42, v46
 v_pk_add_f16 v81, v41, v45
 v_pk_add_f16 v83, v43, v47
 v_permlane32_swap_b32 v80, v82
 v_bitop3_b32 v77, v40, v42, s88 bitop3:0x7e
 v_permlane32_swap_b32 v81, v83
 v_bitop3_b32 v78, v44, v46, s88 bitop3:0x7e
 v_fma_mix_f32 v48, v80, 1.0, v82 op_sel:[0,0,0] op_sel_hi:[1,0,1]
 v_or3_b32 v27, v76, v77, v78
 v_fma_mix_f32 v49, v80, 1.0, v82 op_sel:[1,0,1] op_sel_hi:[1,0,1]
 v_and_b32 v27, 1, v27
 v_fma_mix_f32 v50, v81, 1.0, v83 op_sel:[0,0,0] op_sel_hi:[1,0,1]
 v_cmp_ne_u32 vcc, 0, v27
 v_fma_mix_f32 v51, v81, 1.0, v83 op_sel:[1,0,1] op_sel_hi:[1,0,1]
 v_max3_f32 v62, v48, v49, v79
 s_cbranch_vccnz psr_57
psj_58:
 v_max3_f32 v62, v62, v50, v51
 v_cvt_pk_bf16_f32 v146, v100, v101
 v_cvt_pk_bf16_f32 v147, v102, v103
 v_max_f32_dpp v62, v62, v62 row_ror:8 row_mask:0xf bank_mask:0xf
 v_mov_b32 v63, v62
 v_cvt_pk_bf16_f32 v148, v104, v105
 v_cvt_pk_bf16_f32 v149, v106, v107
 v_permlane32_swap_b32 v62, v63
 v_max_f32 v62, v62, v63
 v_mov_b32 v63, v62
 v_cvt_pk_bf16_f32 v150, v108, v109
 v_cvt_pk_bf16_f32 v151, v110, v111
 v_permlane16_swap_b32 v62, v63
 v_max_f32 v62, v62, v63
 v_mul_f32 v62, s86, v62
 v_fma_f32 v48, v48, s86, -v62
 v_fma_f32 v49, v49, s86, -v62
 v_fma_f32 v50, v50, s86, -v62
 v_fma_f32 v51, v51, s86, -v62
 v_fma_f32 v52, v52, s86, -v62
 v_fma_f32 v53, v53, s86, -v62
 v_exp_f32 v48, v48
 v_exp_f32 v49, v49
 buffer_load_dwordx4 v[88:91], v17, s[28:31], s64 offen offset:0 sc1
 v_exp_f32 v50, v50
 v_exp_f32 v51, v51
 buffer_load_dwordx4 v[92:95], v16, s[28:31], s64 offen offset:1024 sc1
 v_exp_f32 v52, v52
 v_exp_f32 v53, v53
 buffer_load_dwordx4 v[96:99], v20, s[28:31], s64 offen offset:2048 sc1
 v_cvt_pk_bf16_f32 v138, v48, v49
 v_cvt_pk_bf16_f32 v139, v50, v51
 v_cvt_pk_bf16_f32 v142, v52, v53
 v_mov_b32_dpp v140, v138 row_ror:8 row_mask:0xf bank_mask:0xf
 v_mov_b32_dpp v141, v139 row_ror:8 row_mask:0xf bank_mask:0xf
 v_mov_b32_dpp v143, v142 row_ror:8 row_mask:0xf bank_mask:0xf
 v_add_f32 v54, v48, v49
 v_mfma_f32_16x16x32_bf16 v[64:67], v[126:129], v[138:141], 0
 v_add_f32 v55, v50, v51
 v_add_f32 v56, v52, v53
 v_mfma_f32_16x16x32_bf16 v[64:67], v[146:149], v[142:145], v[64:67]
 v_add_f32 v62, v54, v55
 v_fmac_f32 v62, v56, v26
 v_mfma_f32_16x16x32_bf16 v[68:71], v[130:133], v[138:141], 0
 s_nop 0
 v_add_f32_dpp v62, v62, v62 row_ror:8 row_mask:0xf bank_mask:0xf
 v_mfma_f32_16x16x32_bf16 v[68:71], v[148:151], v[142:145], v[68:71]
 v_mov_b32 v63, v62
 s_cmp_lt_i32 s55, 0
 s_cbranch_scc1 fl_61
fl_62:
 v_mfma_f32_16x16x32_bf16 v[72:75], v[134:137], v[138:141], 0
 v_permlane32_swap_b32 v62, v63
 v_mfma_f32_16x16x32_bf16 v[72:75], v[150:153], v[142:145], v[72:75]
 v_add_f32 v62, v62, v63
 v_mov_b32 v63, v62
 ds_write_b128 v11, v[64:67] offset:0
 s_nop 0
 v_permlane16_swap_b32 v62, v63
 v_add_f32 v62, v62, v63
 v_rcp_f32 v62, v62
 ds_write_b128 v11, v[68:71] offset:1024
 s_mov_b64 exec, 0xff
 ds_write_b32 v22, v62
 s_mov_b64 exec, -1
 ds_write_b128 v11, v[72:75] offset:2048
 s_waitcnt lgkmcnt(0)
 s_barrier
 ds_read_b128 v[72:75], v23
 ds_read_b64 v[64:65], v12 offset:0
 ds_read_b64 v[66:67], v12 offset:3072
 ds_read_b64 v[68:69], v12 offset:6144
 ds_read_b64 v[70:71], v12 offset:9216
 s_waitcnt lgkmcnt(2)
 v_pk_mul_f32 v[64:65], v[64:65], v[72:73] op_sel_hi:[1,0]
 v_pk_fma_f32 v[64:65], v[66:67], v[72:73], v[64:65] op_sel:[0,1,0] op_sel_hi:[1,1,1]
 s_waitcnt lgkmcnt(0)
 v_pk_fma_f32 v[64:65], v[68:69], v[74:75], v[64:65] op_sel_hi:[1,0,1]
 v_pk_fma_f32 v[64:65], v[70:71], v[74:75], v[64:65] op_sel:[0,1,0] op_sel_hi:[1,1,1]
 v_cvt_pk_f16_f32 v68, v64, v65
 v_perm_b32 v68, s91, v68, v14
 buffer_atomic_pk_add_f16 v68, v13, s[4:7], s3 offen
 s_mov_b64 exec, s[62:63]
 buffer_store_dwordx4 v[118:121], v18, s[24:27], s85 offen sc1
 buffer_store_dwordx2 v[122:123], v19, s[24:27], s85 offen sc1
 s_mov_b64 exec, -1
 v_mov_b32 v76, v108
 v_mov_b32 v77, v109
 v_mov_b32 v78, v110
 v_mov_b32 v79, v111
 v_permlane32_swap_b32 v100, v104
 v_permlane32_swap_b32 v101, v105
 v_permlane32_swap_b32 v102, v106
 v_permlane32_swap_b32 v103, v107
 v_permlane32_swap_b32 v108, v76
 v_permlane32_swap_b32 v109, v77
 v_permlane32_swap_b32 v110, v78
 v_permlane32_swap_b32 v111, v79
 v_pk_add_f32 v[100:101], v[100:101], v[104:105]
 v_pk_add_f32 v[102:103], v[102:103], v[106:107]
 v_pk_add_f32 v[108:109], v[108:109], v[76:77]
 v_pk_add_f32 v[110:111], v[110:111], v[78:79]
 v_cvt_pk_bf16_f32 v80, v100, v101
 v_cvt_pk_bf16_f32 v82, v108, v109
 v_cvt_pk_bf16_f32 v81, v102, v103
 v_cvt_pk_bf16_f32 v83, v110, v111
 s_nop 0
 v_permlane16_swap_b32 v80, v82
 v_permlane16_swap_b32 v81, v83
 v_min_u32 v80, -2, v80
 s_mov_b64 exec, s[76:77]
 buffer_store_dwordx4 v[80:83], v15, s[24:27], s57 offen sc1
 s_mov_b64 exec, -1
 s_add_u32 s64, s64, 1310720
 s_add_u32 s52, s52, 1
 s_branch step_50
fl_55:
 buffer_load_dword v0, off, s[12:15], s79 sc1
 s_branch fl_56
A1_15:
 v_smfmac_f32_16x16x32_f16 v[40:43], v[36:37], a[16:19], v25
 v_smfmac_f32_16x16x32_f16 v[52:55], v[36:37], a[76:79], v25
 v_smfmac_f32_16x16x32_f16 v[44:47], v[36:37], a[36:39], v25
 v_smfmac_f32_16x16x32_f16 v[56:59], v[36:37], a[96:99], v25
 s_branch A2_54
pm_53:
 buffer_load_dwordx4 v[36:39], v4, s[4:7], s84 offen offset:2048 sc1
 buffer_load_dwordx4 v[28:31], v4, s[4:7], s84 offen offset:0 sc1
 buffer_load_dwordx4 v[32:35], v4, s[4:7], s84 offen offset:1024 sc1
 s_nop 7
 v_mov_b32 v40, 0
 v_mov_b32 v41, 0
 v_mov_b32 v42, 0
 v_mov_b32 v43, 0
 v_mov_b32 v52, 0
 v_mov_b32 v53, 0
 v_mov_b32 v54, 0
 v_mov_b32 v55, 0
 v_mov_b32 v44, 0
 v_mov_b32 v45, 0
 v_mov_b32 v46, 0
 v_mov_b32 v47, 0
 v_mov_b32 v56, 0
 v_mov_b32 v57, 0
 v_mov_b32 v58, 0
 v_mov_b32 v59, 0
 s_waitcnt vmcnt(0)
 v_bitop3_b32 v27, v31, v35, v39 bitop3:0x80
 v_perm_b32 v31, v35, v31, s89
 v_cmp_gt_u32 vcc, 0x48000000, v27
 v_mov_b32 v35, v38
 s_cbranch_vccz A1_15
pm_52:
 s_cmp_gt_u32 s52, 3
 s_cbranch_scc1 op_63
 v_readfirstlane_b32 s21, v0
 s_cmp_ge_u32 s21, s46
 s_cbranch_scc1 op_63
 buffer_load_dword v0, off, s[12:15], s79 sc1
 s_waitcnt vmcnt(0)
 v_readfirstlane_b32 s21, v0
 s_cmp_gt_u32 s21, s52
 s_cselect_b32 s21, s87, 0
 s_cmp_eq_u32 s21, 0
 s_cbranch_scc1 op_63
 s_mov_b32 s87, 0
 s_sub_u32 s21, s64, 1310720
 buffer_load_dwordx4 v[126:129], v16, s[28:31], s21 offen offset:0 sc1
 buffer_load_dwordx4 v[130:133], v16, s[28:31], s21 offen offset:1024 sc1
 buffer_load_dwordx4 v[134:137], v16, s[28:31], s21 offen offset:2048 sc1
op_63:
 buffer_load_dwordx4 v[36:39], v4, s[4:7], s84 offen offset:2048 sc1
 buffer_load_dwordx4 v[28:31], v4, s[4:7], s84 offen offset:0 sc1
 buffer_load_dwordx4 v[32:35], v4, s[4:7], s84 offen offset:1024 sc1
 s_add_u32 s54, s54, 1
 s_cmp_gt_u32 s54, 131072
 s_cbranch_scc1 end0
 s_waitcnt vmcnt(0)
 v_bitop3_b32 v27, v31, v35, v39 bitop3:0x80
 v_perm_b32 v31, v35, v31, s89
 v_cmp_gt_u32 vcc, 0x48000000, v27
 v_mov_b32 v35, v38
 s_cbranch_vccnz pm_52
 s_branch A1_15
psr_57:
 buffer_load_dwordx2 v[58:59], v9, s[8:11], s81 offen sc1
 buffer_load_dwordx4 v[40:43], v8, s[8:11], s81 offen offset:0 sc1
 buffer_load_dwordx4 v[44:47], v8, s[8:11], s81 offen offset:1024 sc1
 s_add_u32 s54, s54, 1
 s_cmp_gt_u32 s54, 131072
 s_cbranch_scc1 end0
 s_waitcnt vmcnt(2)
 v_xor_b32 v76, s88, v58
 s_nop 0
 v_permlane16_swap_b32 v58, v59
 v_fma_mix_f32 v60, v58, 1.0, v59 op_sel:[0,0,0] op_sel_hi:[1,0,1]
 v_fma_mix_f32 v61, v58, 1.0, v59 op_sel:[1,0,1] op_sel_hi:[1,0,1]
 v_mov_b32 v58, v60
 v_mov_b32 v59, v61
 s_nop 0
 v_permlane32_swap_b32 v58, v60
 v_permlane32_swap_b32 v59, v61
 v_add_f32 v52, v58, v60
 v_add_f32 v53, v59, v61
 v_max_f32 v79, v52, v53
 s_waitcnt vmcnt(0)
 v_pk_add_f16 v80, v40, v44
 v_pk_add_f16 v82, v42, v46
 v_pk_add_f16 v81, v41, v45
 v_pk_add_f16 v83, v43, v47
 v_permlane32_swap_b32 v80, v82
 v_bitop3_b32 v77, v40, v42, s88 bitop3:0x7e
 v_permlane32_swap_b32 v81, v83
 v_bitop3_b32 v78, v44, v46, s88 bitop3:0x7e
 v_fma_mix_f32 v48, v80, 1.0, v82 op_sel:[0,0,0] op_sel_hi:[1,0,1]
 v_or3_b32 v27, v76, v77, v78
 v_fma_mix_f32 v49, v80, 1.0, v82 op_sel:[1,0,1] op_sel_hi:[1,0,1]
 v_and_b32 v27, 1, v27
 v_fma_mix_f32 v50, v81, 1.0, v83 op_sel:[0,0,0] op_sel_hi:[1,0,1]
 v_cmp_ne_u32 vcc, 0, v27
 v_fma_mix_f32 v51, v81, 1.0, v83 op_sel:[1,0,1] op_sel_hi:[1,0,1]
 v_max3_f32 v62, v48, v49, v79
 s_cbranch_vccnz psr_57
 s_branch psj_58
kvw_59:
 s_mov_b32 s22, s87
 s_cmp_eq_u32 s52, 0
 s_cselect_b32 s55, 0, s55
 s_cselect_b32 s87, 1, 0
 s_cbranch_scc1 kvok_60
 v_mov_b32 v62, 0
 s_mov_b32 s101, 0
wf_64:
 buffer_load_dword v63, v62, s[12:15], s79 offen sc1
 s_add_u32 s101, s101, 1
 s_cmp_gt_u32 s101, 131072
 s_cbranch_scc1 end0
 s_waitcnt vmcnt(0)
 v_readfirstlane_b32 s100, v63
 s_cmp_ge_u32 s100, s46
 s_cbranch_scc1 wf_65
 s_sleep 3
 s_branch wf_64
wf_65:
 s_cmp_eq_u32 s22, 0
 s_cbranch_scc1 kvok_60
 s_sub_u32 s21, s64, 1310720
 buffer_load_dwordx4 v[126:129], v16, s[28:31], s21 offen offset:0 sc1
 buffer_load_dwordx4 v[130:133], v16, s[28:31], s21 offen offset:1024 sc1
 buffer_load_dwordx4 v[134:137], v16, s[28:31], s21 offen offset:2048 sc1
 s_waitcnt vmcnt(0)
 s_branch kvok_60
fl_61:
 buffer_load_dword v0, off, s[12:15], s79 sc1
 s_branch fl_62
last_51:
 s_mov_b64 exec, s[62:63]
 buffer_store_dwordx4 v[118:121], v18, s[24:27], s85 offen sc1
 buffer_store_dwordx2 v[122:123], v19, s[24:27], s85 offen sc1
 s_mov_b64 exec, -1
 s_waitcnt lgkmcnt(10)
 v_smfmac_f32_16x16x64_f16 v[100:103], v[28:31], a[120:127], v25
 v_smfmac_f32_16x16x64_f16 v[104:107], v[28:31], a[128:135], v25
 v_smfmac_f32_16x16x64_f16 v[108:111], v[28:31], a[136:143], v25
 v_smfmac_f32_16x16x64_f16 v[100:103], v[32:35], a[144:151], v25
 v_smfmac_f32_16x16x64_f16 v[104:107], v[32:35], a[152:159], v25
 v_smfmac_f32_16x16x64_f16 v[108:111], v[32:35], a[160:167], v25
 s_waitcnt lgkmcnt(7)
 v_smfmac_f32_16x16x64_f16 v[100:103], v[64:67], a[168:175], v25
 v_smfmac_f32_16x16x64_f16 v[104:107], v[64:67], a[176:183], v25
 v_smfmac_f32_16x16x64_f16 v[108:111], v[64:67], a[184:191], v25
 v_smfmac_f32_16x16x64_f16 v[100:103], v[68:71], a[192:199], v25
 v_smfmac_f32_16x16x64_f16 v[104:107], v[68:71], a[200:207], v25
 v_smfmac_f32_16x16x64_f16 v[108:111], v[68:71], a[208:215], v25
 v_smfmac_f32_16x16x64_f16 v[100:103], v[72:75], a[216:223], v25
 v_smfmac_f32_16x16x64_f16 v[104:107], v[72:75], a[224:231], v25
 v_smfmac_f32_16x16x64_f16 v[108:111], v[72:75], a[232:239], v25
 s_waitcnt lgkmcnt(4)
 v_smfmac_f32_16x16x64_f16 v[100:103], v[76:79], a[240:247], v25
 v_smfmac_f32_16x16x64_f16 v[104:107], v[76:79], a[248:255], v25
 v_smfmac_f32_16x16x64_f16 v[108:111], v[76:79], v[152:159], v25
 v_smfmac_f32_16x16x64_f16 v[100:103], v[80:83], v[160:167], v25
 v_smfmac_f32_16x16x64_f16 v[104:107], v[80:83], v[168:175], v25
 v_smfmac_f32_16x16x64_f16 v[108:111], v[80:83], v[176:183], v25
 v_smfmac_f32_16x16x64_f16 v[100:103], v[84:87], v[184:191], v25
 v_smfmac_f32_16x16x64_f16 v[104:107], v[84:87], v[192:199], v25
 v_smfmac_f32_16x16x64_f16 v[108:111], v[84:87], v[200:207], v25
 s_waitcnt lgkmcnt(0)
 v_smfmac_f32_16x16x64_f16 v[100:103], v[88:91], v[208:215], v25
 v_smfmac_f32_16x16x64_f16 v[104:107], v[88:91], v[216:223], v25
 v_smfmac_f32_16x16x64_f16 v[108:111], v[88:91], v[224:231], v25
 v_smfmac_f32_16x16x64_f16 v[100:103], v[92:95], v[232:239], v25
 v_smfmac_f32_16x16x64_f16 v[104:107], v[92:95], v[240:247], v25
 v_smfmac_f32_16x16x64_f16 v[108:111], v[92:95], v[248:255], v25
 s_nop 7
 v_mov_b32 v76, v108
 v_mov_b32 v77, v109
 v_mov_b32 v78, v110
 v_mov_b32 v79, v111
 v_permlane32_swap_b32 v100, v104
 v_permlane32_swap_b32 v101, v105
 v_permlane32_swap_b32 v102, v106
 v_permlane32_swap_b32 v103, v107
 v_permlane32_swap_b32 v108, v76
 v_permlane32_swap_b32 v109, v77
 v_permlane32_swap_b32 v110, v78
 v_permlane32_swap_b32 v111, v79
 v_pk_add_f32 v[100:101], v[100:101], v[104:105]
 v_pk_add_f32 v[102:103], v[102:103], v[106:107]
 v_pk_add_f32 v[108:109], v[108:109], v[76:77]
 v_pk_add_f32 v[110:111], v[110:111], v[78:79]
 v_cvt_pk_bf16_f32 v80, v100, v101
 v_cvt_pk_bf16_f32 v82, v108, v109
 v_cvt_pk_bf16_f32 v81, v102, v103
 v_cvt_pk_bf16_f32 v83, v110, v111
 s_nop 0
 v_permlane16_swap_b32 v80, v82
 v_permlane16_swap_b32 v81, v83
 v_min_u32 v80, -2, v80
 s_mov_b64 exec, s[76:77]
 buffer_store_dwordx4 v[80:83], v15, s[24:27], s57 offen sc1
 s_mov_b64 exec, -1
 s_branch chain_done
step_66:
 s_and_b32 s21, s52, 3
 s_mul_i32 s81, s21, 540672
 s_lshl_b32 s84, s21, 15
 s_add_u32 s21, s52, 3
 s_and_b32 s21, s21, 3
 s_lshl_b32 s83, s21, 15
 s_add_u32 s21, s52, 1
 s_and_b32 s22, s21, 3
 s_lshl_b32 s3, s22, 15
 s_mul_i32 s80, s21, 393216
 s_add_u32 s46, s21, 1
 s_min_u32 s46, s46, 64
 s_mul_i32 s85, s52, 98304
 s_mul_i32 s57, s52, 327680
 s_add_u32 s57, s57, 51380224
 s_bfe_u32 s88, s52, 0x10002
 s_max_u32 s67, s52, 1
 s_sub_u32 s67, s67, 1
 v_mov_b32 v40, 0
 v_mov_b32 v41, 0
 v_mov_b32 v42, 0
 v_mov_b32 v43, 0
 v_mov_b32 v44, 0
 v_mov_b32 v45, 0
 v_mov_b32 v46, 0
 v_mov_b32 v47, 0
 v_mov_b32 v48, 0
 v_mov_b32 v49, 0
 v_mov_b32 v50, 0
 v_mov_b32 v51, 0
 v_mov_b32 v52, 0
 v_mov_b32 v53, 0
 v_mov_b32 v54, 0
 v_mov_b32 v55, 0
 v_mov_b32 v56, 0
 v_mov_b32 v57, 0
 v_mov_b32 v58, 0
 v_mov_b32 v59, 0
 v_mov_b32 v60, 0
 v_mov_b32 v61, 0
 v_mov_b32 v62, 0
 v_mov_b32 v63, 0
 v_mov_b32 v100, 0
 v_mov_b32 v101, 0
 v_mov_b32 v102, 0
 v_mov_b32 v103, 0
 v_mov_b32 v104, 0
 v_mov_b32 v105, 0
 v_mov_b32 v106, 0
 v_mov_b32 v107, 0
 v_mov_b32 v108, 0
 v_mov_b32 v109, 0
 v_mov_b32 v110, 0
 v_mov_b32 v111, 0
 s_sleep 6
 v_readfirstlane_b32 s21, v0
 s_cmp_lt_u32 s21, s46
 s_cselect_b32 s55, s55, 0
 s_cmp_lt_i32 s55, 0
 s_cbranch_scc1 fl_71
fl_72:
 s_mov_b32 s54, 0
 buffer_load_dwordx4 v[36:39], v4, s[4:7], s84 offen offset:2048 sc1
 buffer_load_dwordx4 v[28:31], v4, s[4:7], s84 offen offset:0 sc1
 buffer_load_dwordx4 v[32:35], v4, s[4:7], s84 offen offset:1024 sc1
 s_waitcnt vmcnt(3)
 v_mov_b32 v126, v88
 v_mov_b32 v127, v89
 v_mov_b32 v128, v90
 v_mov_b32 v129, v91
 v_mov_b32 v130, v92
 v_mov_b32 v131, v93
 v_mov_b32 v132, v94
 v_mov_b32 v133, v95
 v_mov_b32 v134, v96
 v_mov_b32 v135, v97
 v_mov_b32 v136, v98
 v_mov_b32 v137, v99
 s_waitcnt vmcnt(2)
 v_smfmac_f32_16x16x32_f16 v[40:43], v[36:37], a[16:19], v25
 v_smfmac_f32_16x16x32_f16 v[52:55], v[36:37], a[76:79], v25
 v_smfmac_f32_16x16x32_f16 v[44:47], v[36:37], a[36:39], v25
 s_waitcnt vmcnt(0)
 v_bitop3_b32 v27, v31, v35, v39 bitop3:0x80
 v_perm_b32 v31, v35, v31, s89
 v_cmp_gt_u32 vcc, 0x48000000, v27
 v_mov_b32 v35, v38
 v_smfmac_f32_16x16x32_f16 v[56:59], v[36:37], a[96:99], v25
 s_cbranch_vccnz pm_69
A2_70:
 v_smfmac_f32_16x16x64_f16 v[40:43], v[28:31], a[0:7], v25
 ds_write_b128 v10, v[28:31]
 v_smfmac_f32_16x16x64_f16 v[40:43], v[32:35], a[8:15], v25
 ds_write_b128 v10, v[32:35] offset:1024
 v_smfmac_f32_16x16x64_f16 v[52:55], v[28:31], a[60:67], v25
 ds_write_b64 v10, v[36:37] offset:2048
 v_smfmac_f32_16x16x64_f16 v[52:55], v[32:35], a[68:75], v25
 v_cvt_pk_f16_f32 v40, v40, v41
 v_cvt_pk_f16_f32 v41, v42, v43
 v_smfmac_f32_16x16x32_f16 v[48:51], v[36:37], a[56:59], v25
 v_smfmac_f32_16x16x32_f16 v[60:63], v[36:37], a[116:119], v25
 v_smfmac_f32_16x16x64_f16 v[44:47], v[28:31], a[20:27], v25
 v_cvt_pk_f16_f32 v52, v52, v53
 v_cvt_pk_f16_f32 v53, v54, v55
 s_nop 0
 v_smfmac_f32_16x16x64_f16 v[44:47], v[32:35], a[28:35], v25
 v_permlane32_swap_b32 v40, v52
 v_smfmac_f32_16x16x64_f16 v[56:59], v[28:31], a[80:87], v25
 v_permlane32_swap_b32 v41, v53
 v_pk_add_f16 v40, v40, v52
 v_smfmac_f32_16x16x64_f16 v[56:59], v[32:35], a[88:95], v25
 v_pk_add_f16 v41, v41, v53
 v_smfmac_f32_16x16x64_f16 v[48:51], v[28:31], a[40:47], v25
 ds_write_b64 v5, v[40:41] offset:0
 v_smfmac_f32_16x16x64_f16 v[48:51], v[32:35], a[48:55], v25
 v_cvt_pk_f16_f32 v44, v44, v45
 v_cvt_pk_f16_f32 v45, v46, v47
 v_cvt_pk_f16_f32 v56, v56, v57
 v_smfmac_f32_16x16x64_f16 v[60:63], v[28:31], a[100:107], v25
 v_cvt_pk_f16_f32 v57, v58, v59
 s_nop 0
 v_smfmac_f32_16x16x64_f16 v[60:63], v[32:35], a[108:115], v25
 v_permlane32_swap_b32 v44, v56
 v_permlane32_swap_b32 v45, v57
 v_pk_add_f16 v44, v44, v56
 v_pk_add_f16 v45, v45, v57
 ds_write_b64 v5, v[44:45] offset:640
 v_cvt_pk_f16_f32 v48, v48, v49
 v_cvt_pk_f16_f32 v49, v50, v51
 v_cvt_pk_f16_f32 v60, v60, v61
 v_cvt_pk_f16_f32 v61, v62, v63
 s_nop 0
 v_permlane32_swap_b32 v48, v60
 v_permlane32_swap_b32 v49, v61
 v_pk_add_f16 v48, v48, v60
 v_pk_add_f16 v49, v49, v61
 ds_write_b64 v5, v[48:49] offset:1280
 s_waitcnt lgkmcnt(0) vmcnt(0)
 s_barrier
 ds_read_b128 v[28:31], v16 offset:24576
 ds_read_b128 v[32:35], v16 offset:25600
 ds_read_b128 v[64:67], v16 offset:27648
 ds_read_b128 v[68:71], v16 offset:28672
 ds_read_b128 v[72:75], v16 offset:30720
 ds_read_b128 v[76:79], v16 offset:31744
 ds_read_b128 v[80:83], v16 offset:33792
 ds_read_b128 v[84:87], v16 offset:34816
 ds_read_b64 v[88:89], v16 offset:26624
 ds_read_b64 v[90:91], v16 offset:29696
 ds_read_b64 v[92:93], v16 offset:32768
 ds_read_b64 v[94:95], v16 offset:35840
 s_cmp_eq_u32 s52, 63
 s_cbranch_scc1 last_67
 s_waitcnt lgkmcnt(10)
 v_smfmac_f32_16x16x64_f16 v[100:103], v[28:31], a[120:127], v25
 v_smfmac_f32_16x16x64_f16 v[104:107], v[28:31], a[128:135], v25
 v_smfmac_f32_16x16x64_f16 v[108:111], v[28:31], a[136:143], v25
 s_mov_b32 s54, 0
 v_smfmac_f32_16x16x64_f16 v[100:103], v[32:35], a[144:151], v25
 v_readfirstlane_b32 s21, v0
 v_smfmac_f32_16x16x64_f16 v[104:107], v[32:35], a[152:159], v25
 s_add_u32 s22, s46, 3
 v_smfmac_f32_16x16x64_f16 v[108:111], v[32:35], a[160:167], v25
 s_min_u32 s22, s22, 64
 s_waitcnt lgkmcnt(7)
 v_smfmac_f32_16x16x64_f16 v[100:103], v[64:67], a[168:175], v25
 s_sub_u32 s55, s21, s22
 v_smfmac_f32_16x16x64_f16 v[104:107], v[64:67], a[176:183], v25
 s_sub_u32 s56, s21, s46
 v_smfmac_f32_16x16x64_f16 v[108:111], v[64:67], a[184:191], v25
 v_smfmac_f32_16x16x64_f16 v[100:103], v[68:71], a[192:199], v25
 v_smfmac_f32_16x16x64_f16 v[104:107], v[68:71], a[200:207], v25
 v_smfmac_f32_16x16x64_f16 v[108:111], v[68:71], a[208:215], v25
 v_smfmac_f32_16x16x64_f16 v[100:103], v[72:75], a[216:223], v25
 v_smfmac_f32_16x16x64_f16 v[104:107], v[72:75], a[224:231], v25
 v_smfmac_f32_16x16x64_f16 v[108:111], v[72:75], a[232:239], v25
 s_waitcnt lgkmcnt(4)
 v_smfmac_f32_16x16x64_f16 v[100:103], v[76:79], a[240:247], v25
 v_smfmac_f32_16x16x64_f16 v[104:107], v[76:79], a[248:255], v25
 v_smfmac_f32_16x16x64_f16 v[108:111], v[76:79], v[152:159], v25
 v_smfmac_f32_16x16x64_f16 v[100:103], v[80:83], v[160:167], v25
 v_smfmac_f32_16x16x64_f16 v[104:107], v[80:83], v[168:175], v25
 v_smfmac_f32_16x16x64_f16 v[108:111], v[80:83], v[176:183], v25
 v_smfmac_f32_16x16x64_f16 v[100:103], v[84:87], v[184:191], v25
 v_smfmac_f32_16x16x64_f16 v[104:107], v[84:87], v[192:199], v25
 v_smfmac_f32_16x16x64_f16 v[108:111], v[84:87], v[200:207], v25
 s_waitcnt lgkmcnt(0)
 v_smfmac_f32_16x16x64_f16 v[100:103], v[88:91], v[208:215], v25
 v_smfmac_f32_16x16x64_f16 v[104:107], v[88:91], v[216:223], v25
 v_smfmac_f32_16x16x64_f16 v[108:111], v[88:91], v[224:231], v25
 v_smfmac_f32_16x16x64_f16 v[100:103], v[92:95], v[232:239], v25
 v_smfmac_f32_16x16x64_f16 v[104:107], v[92:95], v[240:247], v25
 v_smfmac_f32_16x16x64_f16 v[108:111], v[92:95], v[248:255], v25
 s_sleep 2
 buffer_load_dwordx2 v[58:59], v9, s[8:11], s81 offen sc1
 buffer_load_dwordx4 v[40:43], v8, s[8:11], s81 offen offset:0 sc1
 buffer_load_dwordx4 v[44:47], v8, s[8:11], s81 offen offset:1024 sc1
 s_cmp_lt_i32 s56, 0
 s_cbranch_scc1 kvw_75
kvok_76:
 s_waitcnt vmcnt(2)
 v_xor_b32 v76, s88, v58
 s_nop 0
 v_permlane16_swap_b32 v58, v59
 v_fma_mix_f32 v60, v58, 1.0, v59 op_sel:[0,0,0] op_sel_hi:[1,0,1]
 v_fma_mix_f32 v61, v58, 1.0, v59 op_sel:[1,0,1] op_sel_hi:[1,0,1]
 v_mov_b32 v58, v60
 v_mov_b32 v59, v61
 s_nop 0
 v_permlane32_swap_b32 v58, v60
 v_permlane32_swap_b32 v59, v61
 v_add_f32 v52, v58, v60
 v_add_f32 v53, v59, v61
 v_max_f32 v79, v52, v53
 s_waitcnt vmcnt(0)
 v_pk_add_f16 v80, v40, v44
 v_pk_add_f16 v82, v42, v46
 v_pk_add_f16 v81, v41, v45
 v_pk_add_f16 v83, v43, v47
 v_permlane32_swap_b32 v80, v82
 v_bitop3_b32 v77, v40, v42, s88 bitop3:0x7e
 v_permlane32_swap_b32 v81, v83
 v_bitop3_b32 v78, v44, v46, s88 bitop3:0x7e
 v_fma_mix_f32 v48, v80, 1.0, v82 op_sel:[0,0,0] op_sel_hi:[1,0,1]
 v_or3_b32 v27, v76, v77, v78
 v_fma_mix_f32 v49, v80, 1.0, v82 op_sel:[1,0,1] op_sel_hi:[1,0,1]
 v_and_b32 v27, 1, v27
 v_fma_mix_f32 v50, v81, 1.0, v83 op_sel:[0,0,0] op_sel_hi:[1,0,1]
 v_cmp_ne_u32 vcc, 0, v27
 v_fma_mix_f32 v51, v81, 1.0, v83 op_sel:[1,0,1] op_sel_hi:[1,0,1]
 v_max3_f32 v62, v48, v49, v79
 s_cbranch_vccnz psr_73
psj_74:
 v_max3_f32 v62, v62, v50, v51
 v_cvt_pk_bf16_f32 v146, v100, v101
 v_cvt_pk_bf16_f32 v147, v102, v103
 v_max_f32_dpp v62, v62, v62 row_ror:8 row_mask:0xf bank_mask:0xf
 v_mov_b32 v63, v62
 v_cvt_pk_bf16_f32 v148, v104, v105
 v_cvt_pk_bf16_f32 v149, v106, v107
 v_permlane32_swap_b32 v62, v63
 v_max_f32 v62, v62, v63
 v_mov_b32 v63, v62
 v_cvt_pk_bf16_f32 v150, v108, v109
 v_cvt_pk_bf16_f32 v151, v110, v111
 v_permlane16_swap_b32 v62, v63
 v_max_f32 v62, v62, v63
 v_mul_f32 v62, s86, v62
 v_fma_f32 v48, v48, s86, -v62
 v_fma_f32 v49, v49, s86, -v62
 v_fma_f32 v50, v50, s86, -v62
 v_fma_f32 v51, v51, s86, -v62
 v_fma_f32 v52, v52, s86, -v62
 v_fma_f32 v53, v53, s86, -v62
 v_exp_f32 v48, v48
 v_exp_f32 v49, v49
 buffer_load_dwordx4 v[88:91], v17, s[28:31], s64 offen offset:0 sc1
 v_exp_f32 v50, v50
 v_exp_f32 v51, v51
 buffer_load_dwordx4 v[92:95], v16, s[28:31], s64 offen offset:1024 sc1
 v_exp_f32 v52, v52
 v_exp_f32 v53, v53
 buffer_load_dwordx4 v[96:99], v20, s[28:31], s64 offen offset:2048 sc1
 v_cvt_pk_bf16_f32 v138, v48, v49
 v_cvt_pk_bf16_f32 v139, v50, v51
 v_cvt_pk_bf16_f32 v142, v52, v53
 v_mov_b32_dpp v140, v138 row_ror:8 row_mask:0xf bank_mask:0xf
 v_mov_b32_dpp v141, v139 row_ror:8 row_mask:0xf bank_mask:0xf
 v_mov_b32_dpp v143, v142 row_ror:8 row_mask:0xf bank_mask:0xf
 v_mov_b32 v84, s67
 v_mov_b32 v85, s67
 s_mov_b64 exec, 15
 buffer_store_dwordx2 v[84:85], v24, s[12:15], s66 offen sc1
 s_mov_b64 exec, -1
 v_add_f32 v54, v48, v49
 v_mfma_f32_16x16x32_bf16 v[64:67], v[126:129], v[138:141], 0
 v_add_f32 v55, v50, v51
 v_add_f32 v56, v52, v53
 v_mfma_f32_16x16x32_bf16 v[64:67], v[146:149], v[142:145], v[64:67]
 v_add_f32 v62, v54, v55
 v_fmac_f32 v62, v56, v26
 v_mfma_f32_16x16x32_bf16 v[68:71], v[130:133], v[138:141], 0
 s_nop 0
 v_add_f32_dpp v62, v62, v62 row_ror:8 row_mask:0xf bank_mask:0xf
 v_mfma_f32_16x16x32_bf16 v[68:71], v[148:151], v[142:145], v[68:71]
 v_mov_b32 v63, v62
 s_cmp_lt_i32 s55, 0
 s_cbranch_scc1 fl_77
fl_78:
 v_mfma_f32_16x16x32_bf16 v[72:75], v[134:137], v[138:141], 0
 v_permlane32_swap_b32 v62, v63
 v_mfma_f32_16x16x32_bf16 v[72:75], v[150:153], v[142:145], v[72:75]
 v_add_f32 v62, v62, v63
 v_mov_b32 v63, v62
 ds_write_b128 v11, v[64:67] offset:0
 s_nop 0
 v_permlane16_swap_b32 v62, v63
 v_add_f32 v62, v62, v63
 v_rcp_f32 v62, v62
 ds_write_b128 v11, v[68:71] offset:1024
 s_mov_b64 exec, 0xff
 ds_write_b32 v22, v62
 s_mov_b64 exec, -1
 ds_write_b128 v11, v[72:75] offset:2048
 s_waitcnt lgkmcnt(0)
 s_barrier
 s_and_b32 s21, s52, 7
 s_cmp_lg_u32 s21, s50
 s_cbranch_scc1 zm_79
 v_mov_b32 v64, 0
 v_mov_b32 v65, 0
 v_mov_b32 v66, 0
 v_mov_b32 v67, 0
 s_mov_b64 exec, s[70:71]
 buffer_store_dwordx4 v[64:67], v13, s[4:7], s83 offen sc1
 s_mov_b64 exec, -1
zm_79:
 v_mov_b32 v76, v108
 v_mov_b32 v77, v109
 v_mov_b32 v78, v110
 v_mov_b32 v79, v111
 v_permlane32_swap_b32 v100, v104
 v_permlane32_swap_b32 v101, v105
 v_permlane32_swap_b32 v102, v106
 v_permlane32_swap_b32 v103, v107
 v_permlane32_swap_b32 v108, v76
 v_permlane32_swap_b32 v109, v77
 v_permlane32_swap_b32 v110, v78
 v_permlane32_swap_b32 v111, v79
 v_pk_add_f32 v[100:101], v[100:101], v[104:105]
 v_pk_add_f32 v[102:103], v[102:103], v[106:107]
 v_pk_add_f32 v[108:109], v[108:109], v[76:77]
 v_pk_add_f32 v[110:111], v[110:111], v[78:79]
 v_cvt_pk_bf16_f32 v80, v100, v101
 v_cvt_pk_bf16_f32 v82, v108, v109
 v_cvt_pk_bf16_f32 v81, v102, v103
 v_cvt_pk_bf16_f32 v83, v110, v111
 s_nop 0
 v_permlane16_swap_b32 v80, v82
 v_permlane16_swap_b32 v81, v83
 v_min_u32 v80, -2, v80
 s_mov_b64 exec, s[76:77]
 buffer_store_dwordx4 v[80:83], v15, s[24:27], s57 offen sc1
 s_mov_b64 exec, -1
 s_add_u32 s64, s64, 1310720
 s_add_u32 s52, s52, 1
 s_branch step_66
fl_71:
 buffer_load_dword v0, off, s[12:15], s79 sc1
 s_branch fl_72
A1_16:
 v_smfmac_f32_16x16x32_f16 v[40:43], v[36:37], a[16:19], v25
 v_smfmac_f32_16x16x32_f16 v[52:55], v[36:37], a[76:79], v25
 v_smfmac_f32_16x16x32_f16 v[44:47], v[36:37], a[36:39], v25
 v_smfmac_f32_16x16x32_f16 v[56:59], v[36:37], a[96:99], v25
 s_branch A2_70
pm_69:
 buffer_load_dwordx4 v[36:39], v4, s[4:7], s84 offen offset:2048 sc1
 buffer_load_dwordx4 v[28:31], v4, s[4:7], s84 offen offset:0 sc1
 buffer_load_dwordx4 v[32:35], v4, s[4:7], s84 offen offset:1024 sc1
 s_nop 7
 v_mov_b32 v40, 0
 v_mov_b32 v41, 0
 v_mov_b32 v42, 0
 v_mov_b32 v43, 0
 v_mov_b32 v52, 0
 v_mov_b32 v53, 0
 v_mov_b32 v54, 0
 v_mov_b32 v55, 0
 v_mov_b32 v44, 0
 v_mov_b32 v45, 0
 v_mov_b32 v46, 0
 v_mov_b32 v47, 0
 v_mov_b32 v56, 0
 v_mov_b32 v57, 0
 v_mov_b32 v58, 0
 v_mov_b32 v59, 0
 s_waitcnt vmcnt(0)
 v_bitop3_b32 v27, v31, v35, v39 bitop3:0x80
 v_perm_b32 v31, v35, v31, s89
 v_cmp_gt_u32 vcc, 0x48000000, v27
 v_mov_b32 v35, v38
 s_cbranch_vccz A1_16
pm_68:
 s_cmp_gt_u32 s52, 3
 s_cbranch_scc1 op_80
 v_readfirstlane_b32 s21, v0
 s_cmp_ge_u32 s21, s46
 s_cbranch_scc1 op_80
 buffer_load_dword v0, off, s[12:15], s79 sc1
 s_waitcnt vmcnt(0)
 v_readfirstlane_b32 s21, v0
 s_cmp_gt_u32 s21, s52
 s_cselect_b32 s21, s87, 0
 s_cmp_eq_u32 s21, 0
 s_cbranch_scc1 op_80
 s_mov_b32 s87, 0
 s_sub_u32 s21, s64, 1310720
 buffer_load_dwordx4 v[126:129], v16, s[28:31], s21 offen offset:0 sc1
 buffer_load_dwordx4 v[130:133], v16, s[28:31], s21 offen offset:1024 sc1
 buffer_load_dwordx4 v[134:137], v16, s[28:31], s21 offen offset:2048 sc1
op_80:
 buffer_load_dwordx4 v[36:39], v4, s[4:7], s84 offen offset:2048 sc1
 buffer_load_dwordx4 v[28:31], v4, s[4:7], s84 offen offset:0 sc1
 buffer_load_dwordx4 v[32:35], v4, s[4:7], s84 offen offset:1024 sc1
 s_add_u32 s54, s54, 1
 s_cmp_gt_u32 s54, 131072
 s_cbranch_scc1 end0
 s_waitcnt vmcnt(0)
 v_bitop3_b32 v27, v31, v35, v39 bitop3:0x80
 v_perm_b32 v31, v35, v31, s89
 v_cmp_gt_u32 vcc, 0x48000000, v27
 v_mov_b32 v35, v38
 s_cbranch_vccnz pm_68
 s_branch A1_16
psr_73:
 buffer_load_dwordx2 v[58:59], v9, s[8:11], s81 offen sc1
 buffer_load_dwordx4 v[40:43], v8, s[8:11], s81 offen offset:0 sc1
 buffer_load_dwordx4 v[44:47], v8, s[8:11], s81 offen offset:1024 sc1
 s_add_u32 s54, s54, 1
 s_cmp_gt_u32 s54, 131072
 s_cbranch_scc1 end0
 s_waitcnt vmcnt(2)
 v_xor_b32 v76, s88, v58
 s_nop 0
 v_permlane16_swap_b32 v58, v59
 v_fma_mix_f32 v60, v58, 1.0, v59 op_sel:[0,0,0] op_sel_hi:[1,0,1]
 v_fma_mix_f32 v61, v58, 1.0, v59 op_sel:[1,0,1] op_sel_hi:[1,0,1]
 v_mov_b32 v58, v60
 v_mov_b32 v59, v61
 s_nop 0
 v_permlane32_swap_b32 v58, v60
 v_permlane32_swap_b32 v59, v61
 v_add_f32 v52, v58, v60
 v_add_f32 v53, v59, v61
 v_max_f32 v79, v52, v53
 s_waitcnt vmcnt(0)
 v_pk_add_f16 v80, v40, v44
 v_pk_add_f16 v82, v42, v46
 v_pk_add_f16 v81, v41, v45
 v_pk_add_f16 v83, v43, v47
 v_permlane32_swap_b32 v80, v82
 v_bitop3_b32 v77, v40, v42, s88 bitop3:0x7e
 v_permlane32_swap_b32 v81, v83
 v_bitop3_b32 v78, v44, v46, s88 bitop3:0x7e
 v_fma_mix_f32 v48, v80, 1.0, v82 op_sel:[0,0,0] op_sel_hi:[1,0,1]
 v_or3_b32 v27, v76, v77, v78
 v_fma_mix_f32 v49, v80, 1.0, v82 op_sel:[1,0,1] op_sel_hi:[1,0,1]
 v_and_b32 v27, 1, v27
 v_fma_mix_f32 v50, v81, 1.0, v83 op_sel:[0,0,0] op_sel_hi:[1,0,1]
 v_cmp_ne_u32 vcc, 0, v27
 v_fma_mix_f32 v51, v81, 1.0, v83 op_sel:[1,0,1] op_sel_hi:[1,0,1]
 v_max3_f32 v62, v48, v49, v79
 s_cbranch_vccnz psr_73
 s_branch psj_74
kvw_75:
 s_mov_b32 s22, s87
 s_cmp_eq_u32 s52, 0
 s_cselect_b32 s55, 0, s55
 s_cselect_b32 s87, 1, 0
 s_cbranch_scc1 kvok_76
 v_mov_b32 v62, 0
 s_mov_b32 s101, 0
wf_81:
 buffer_load_dword v63, v62, s[12:15], s79 offen sc1
 s_add_u32 s101, s101, 1
 s_cmp_gt_u32 s101, 131072
 s_cbranch_scc1 end0
 s_waitcnt vmcnt(0)
 v_readfirstlane_b32 s100, v63
 s_cmp_ge_u32 s100, s46
 s_cbranch_scc1 wf_82
 s_sleep 3
 s_branch wf_81
wf_82:
 s_cmp_eq_u32 s22, 0
 s_cbranch_scc1 kvok_76
 s_sub_u32 s21, s64, 1310720
 buffer_load_dwordx4 v[126:129], v16, s[28:31], s21 offen offset:0 sc1
 buffer_load_dwordx4 v[130:133], v16, s[28:31], s21 offen offset:1024 sc1
 buffer_load_dwordx4 v[134:137], v16, s[28:31], s21 offen offset:2048 sc1
 s_waitcnt vmcnt(0)
 s_branch kvok_76
fl_77:
 buffer_load_dword v0, off, s[12:15], s79 sc1
 s_branch fl_78
last_67:
 s_waitcnt lgkmcnt(10)
 v_smfmac_f32_16x16x64_f16 v[100:103], v[28:31], a[120:127], v25
 v_smfmac_f32_16x16x64_f16 v[104:107], v[28:31], a[128:135], v25
 v_smfmac_f32_16x16x64_f16 v[108:111], v[28:31], a[136:143], v25
 v_smfmac_f32_16x16x64_f16 v[100:103], v[32:35], a[144:151], v25
 v_smfmac_f32_16x16x64_f16 v[104:107], v[32:35], a[152:159], v25
 v_smfmac_f32_16x16x64_f16 v[108:111], v[32:35], a[160:167], v25
 s_waitcnt lgkmcnt(7)
 v_smfmac_f32_16x16x64_f16 v[100:103], v[64:67], a[168:175], v25
 v_smfmac_f32_16x16x64_f16 v[104:107], v[64:67], a[176:183], v25
 v_smfmac_f32_16x16x64_f16 v[108:111], v[64:67], a[184:191], v25
 v_smfmac_f32_16x16x64_f16 v[100:103], v[68:71], a[192:199], v25
 v_smfmac_f32_16x16x64_f16 v[104:107], v[68:71], a[200:207], v25
 v_smfmac_f32_16x16x64_f16 v[108:111], v[68:71], a[208:215], v25
 v_smfmac_f32_16x16x64_f16 v[100:103], v[72:75], a[216:223], v25
 v_smfmac_f32_16x16x64_f16 v[104:107], v[72:75], a[224:231], v25
 v_smfmac_f32_16x16x64_f16 v[108:111], v[72:75], a[232:239], v25
 s_waitcnt lgkmcnt(4)
 v_smfmac_f32_16x16x64_f16 v[100:103], v[76:79], a[240:247], v25
 v_smfmac_f32_16x16x64_f16 v[104:107], v[76:79], a[248:255], v25
 v_smfmac_f32_16x16x64_f16 v[108:111], v[76:79], v[152:159], v25
 v_smfmac_f32_16x16x64_f16 v[100:103], v[80:83], v[160:167], v25
 v_smfmac_f32_16x16x64_f16 v[104:107], v[80:83], v[168:175], v25
 v_smfmac_f32_16x16x64_f16 v[108:111], v[80:83], v[176:183], v25
 v_smfmac_f32_16x16x64_f16 v[100:103], v[84:87], v[184:191], v25
 v_smfmac_f32_16x16x64_f16 v[104:107], v[84:87], v[192:199], v25
 v_smfmac_f32_16x16x64_f16 v[108:111], v[84:87], v[200:207], v25
 s_waitcnt lgkmcnt(0)
 v_smfmac_f32_16x16x64_f16 v[100:103], v[88:91], v[208:215], v25
 v_smfmac_f32_16x16x64_f16 v[104:107], v[88:91], v[216:223], v25
 v_smfmac_f32_16x16x64_f16 v[108:111], v[88:91], v[224:231], v25
 v_smfmac_f32_16x16x64_f16 v[100:103], v[92:95], v[232:239], v25
 v_smfmac_f32_16x16x64_f16 v[104:107], v[92:95], v[240:247], v25
 v_smfmac_f32_16x16x64_f16 v[108:111], v[92:95], v[248:255], v25
 s_nop 7
 v_mov_b32 v76, v108
 v_mov_b32 v77, v109
 v_mov_b32 v78, v110
 v_mov_b32 v79, v111
 v_permlane32_swap_b32 v100, v104
 v_permlane32_swap_b32 v101, v105
 v_permlane32_swap_b32 v102, v106
 v_permlane32_swap_b32 v103, v107
 v_permlane32_swap_b32 v108, v76
 v_permlane32_swap_b32 v109, v77
 v_permlane32_swap_b32 v110, v78
 v_permlane32_swap_b32 v111, v79
 v_pk_add_f32 v[100:101], v[100:101], v[104:105]
 v_pk_add_f32 v[102:103], v[102:103], v[106:107]
 v_pk_add_f32 v[108:109], v[108:109], v[76:77]
 v_pk_add_f32 v[110:111], v[110:111], v[78:79]
 v_cvt_pk_bf16_f32 v80, v100, v101
 v_cvt_pk_bf16_f32 v82, v108, v109
 v_cvt_pk_bf16_f32 v81, v102, v103
 v_cvt_pk_bf16_f32 v83, v110, v111
 s_nop 0
 v_permlane16_swap_b32 v80, v82
 v_permlane16_swap_b32 v81, v83
 v_min_u32 v80, -2, v80
 s_mov_b64 exec, s[76:77]
 buffer_store_dwordx4 v[80:83], v15, s[24:27], s57 offen sc1
 s_mov_b64 exec, -1
 s_branch chain_done
step_83:
 s_and_b32 s21, s52, 3
 s_mul_i32 s81, s21, 540672
 s_lshl_b32 s84, s21, 15
 s_add_u32 s21, s52, 3
 s_and_b32 s21, s21, 3
 s_lshl_b32 s83, s21, 15
 s_add_u32 s21, s52, 1
 s_and_b32 s22, s21, 3
 s_lshl_b32 s3, s22, 15
 s_mul_i32 s80, s21, 393216
 s_add_u32 s46, s21, 1
 s_min_u32 s46, s46, 64
 s_mul_i32 s85, s52, 98304
 s_mul_i32 s57, s52, 327680
 s_add_u32 s57, s57, 51380224
 s_bfe_u32 s88, s52, 0x10002
 s_max_u32 s67, s52, 1
 s_sub_u32 s67, s67, 1
 v_mov_b32 v40, 0
 v_mov_b32 v41, 0
 v_mov_b32 v42, 0
 v_mov_b32 v43, 0
 v_mov_b32 v44, 0
 v_mov_b32 v45, 0
 v_mov_b32 v46, 0
 v_mov_b32 v47, 0
 v_mov_b32 v48, 0
 v_mov_b32 v49, 0
 v_mov_b32 v50, 0
 v_mov_b32 v51, 0
 v_mov_b32 v52, 0
 v_mov_b32 v53, 0
 v_mov_b32 v54, 0
 v_mov_b32 v55, 0
 v_mov_b32 v56, 0
 v_mov_b32 v57, 0
 v_mov_b32 v58, 0
 v_mov_b32 v59, 0
 v_mov_b32 v60, 0
 v_mov_b32 v61, 0
 v_mov_b32 v62, 0
 v_mov_b32 v63, 0
 v_mov_b32 v100, 0
 v_mov_b32 v101, 0
 v_mov_b32 v102, 0
 v_mov_b32 v103, 0
 v_mov_b32 v104, 0
 v_mov_b32 v105, 0
 v_mov_b32 v106, 0
 v_mov_b32 v107, 0
 v_mov_b32 v108, 0
 v_mov_b32 v109, 0
 v_mov_b32 v110, 0
 v_mov_b32 v111, 0
 s_sleep 8
 v_readfirstlane_b32 s21, v0
 s_cmp_lt_u32 s21, s46
 s_cselect_b32 s55, s55, 0
 s_cmp_lt_i32 s55, 0
 s_cbranch_scc1 fl_88
fl_89:
 s_mov_b32 s54, 0
 buffer_load_dwordx4 v[36:39], v4, s[4:7], s84 offen offset:2048 sc1
 buffer_load_dwordx4 v[28:31], v4, s[4:7], s84 offen offset:0 sc1
 buffer_load_dwordx4 v[32:35], v4, s[4:7], s84 offen offset:1024 sc1
 s_waitcnt vmcnt(3)
 v_mov_b32 v126, v88
 v_mov_b32 v127, v89
 v_mov_b32 v128, v90
 v_mov_b32 v129, v91
 v_mov_b32 v130, v92
 v_mov_b32 v131, v93
 v_mov_b32 v132, v94
 v_mov_b32 v133, v95
 v_mov_b32 v134, v96
 v_mov_b32 v135, v97
 v_mov_b32 v136, v98
 v_mov_b32 v137, v99
 s_waitcnt vmcnt(2)
 v_smfmac_f32_16x16x32_f16 v[40:43], v[36:37], a[16:19], v25
 v_smfmac_f32_16x16x32_f16 v[52:55], v[36:37], a[76:79], v25
 v_smfmac_f32_16x16x32_f16 v[44:47], v[36:37], a[36:39], v25
 s_waitcnt vmcnt(0)
 v_bitop3_b32 v27, v31, v35, v39 bitop3:0x80
 v_perm_b32 v31, v35, v31, s89
 v_cmp_gt_u32 vcc, 0x48000000, v27
 v_mov_b32 v35, v38
 v_smfmac_f32_16x16x32_f16 v[56:59], v[36:37], a[96:99], v25
 s_cbranch_vccnz pm_86
A2_87:
 v_smfmac_f32_16x16x64_f16 v[40:43], v[28:31], a[0:7], v25
 ds_write_b128 v10, v[28:31]
 v_smfmac_f32_16x16x64_f16 v[40:43], v[32:35], a[8:15], v25
 ds_write_b128 v10, v[32:35] offset:1024
 v_smfmac_f32_16x16x64_f16 v[52:55], v[28:31], a[60:67], v25
 ds_write_b64 v10, v[36:37] offset:2048
 v_smfmac_f32_16x16x64_f16 v[52:55], v[32:35], a[68:75], v25
 v_cvt_pk_f16_f32 v40, v40, v41
 v_cvt_pk_f16_f32 v41, v42, v43
 v_smfmac_f32_16x16x32_f16 v[48:51], v[36:37], a[56:59], v25
 v_smfmac_f32_16x16x32_f16 v[60:63], v[36:37], a[116:119], v25
 v_smfmac_f32_16x16x64_f16 v[44:47], v[28:31], a[20:27], v25
 v_cvt_pk_f16_f32 v52, v52, v53
 v_cvt_pk_f16_f32 v53, v54, v55
 s_nop 0
 v_smfmac_f32_16x16x64_f16 v[44:47], v[32:35], a[28:35], v25
 v_permlane32_swap_b32 v40, v52
 v_smfmac_f32_16x16x64_f16 v[56:59], v[28:31], a[80:87], v25
 v_permlane32_swap_b32 v41, v53
 v_pk_add_f16 v40, v40, v52
 v_smfmac_f32_16x16x64_f16 v[56:59], v[32:35], a[88:95], v25
 v_pk_add_f16 v41, v41, v53
 v_smfmac_f32_16x16x64_f16 v[48:51], v[28:31], a[40:47], v25
 ds_write_b64 v5, v[40:41] offset:0
 v_smfmac_f32_16x16x64_f16 v[48:51], v[32:35], a[48:55], v25
 v_cvt_pk_f16_f32 v44, v44, v45
 v_cvt_pk_f16_f32 v45, v46, v47
 v_cvt_pk_f16_f32 v56, v56, v57
 v_smfmac_f32_16x16x64_f16 v[60:63], v[28:31], a[100:107], v25
 v_cvt_pk_f16_f32 v57, v58, v59
 s_nop 0
 v_smfmac_f32_16x16x64_f16 v[60:63], v[32:35], a[108:115], v25
 v_permlane32_swap_b32 v44, v56
 v_permlane32_swap_b32 v45, v57
 v_pk_add_f16 v44, v44, v56
 v_pk_add_f16 v45, v45, v57
 ds_write_b64 v5, v[44:45] offset:640
 v_cvt_pk_f16_f32 v48, v48, v49
 v_cvt_pk_f16_f32 v49, v50, v51
 v_cvt_pk_f16_f32 v60, v60, v61
 v_cvt_pk_f16_f32 v61, v62, v63
 s_nop 0
 v_permlane32_swap_b32 v48, v60
 v_permlane32_swap_b32 v49, v61
 v_pk_add_f16 v48, v48, v60
 v_pk_add_f16 v49, v49, v61
 ds_write_b64 v5, v[48:49] offset:1280
 s_waitcnt lgkmcnt(0) vmcnt(0)
 s_barrier
 s_lshr_b32 s21, 3, s20
 s_bitcmp1_b32 s21, 0
 s_cbranch_scc0 bw_91
 ds_read_b64_tr_b16 v[40:41], v21 offset:0
 ds_read_b64_tr_b16 v[42:43], v21 offset:1920
 ds_read_b64_tr_b16 v[44:45], v21 offset:640
 ds_read_b64_tr_b16 v[46:47], v21 offset:2560
 ds_read_b64_tr_b16 v[48:49], v21 offset:1280
 ds_read_b64_tr_b16 v[50:51], v21 offset:3200
 s_waitcnt lgkmcnt(4)
 v_fma_mix_f32 v52, v40, 1.0, v42 op_sel:[0,0,0] op_sel_hi:[1,0,1]
 v_fma_mix_f32 v53, v40, 1.0, v42 op_sel:[1,0,1] op_sel_hi:[1,0,1]
 v_fma_mix_f32 v54, v41, 1.0, v43 op_sel:[0,0,0] op_sel_hi:[1,0,1]
 v_fma_mix_f32 v55, v41, 1.0, v43 op_sel:[1,0,1] op_sel_hi:[1,0,1]
 v_add_f32_dpp v56, v52, v52 row_ror:8 row_mask:0xf bank_mask:0xf
 v_add_f32_dpp v57, v53, v53 row_ror:8 row_mask:0xf bank_mask:0xf
 v_add_f32_dpp v58, v54, v54 row_ror:8 row_mask:0xf bank_mask:0xf
 v_add_f32_dpp v59, v55, v55 row_ror:8 row_mask:0xf bank_mask:0xf
 v_cvt_pk_bf16_f32 v118, v56, v57
 v_cvt_pk_bf16_f32 v119, v58, v59
 s_waitcnt lgkmcnt(2)
 v_fma_mix_f32 v52, v44, 1.0, v46 op_sel:[0,0,0] op_sel_hi:[1,0,1]
 v_fma_mix_f32 v53, v44, 1.0, v46 op_sel:[1,0,1] op_sel_hi:[1,0,1]
 v_fma_mix_f32 v54, v45, 1.0, v47 op_sel:[0,0,0] op_sel_hi:[1,0,1]
 v_fma_mix_f32 v55, v45, 1.0, v47 op_sel:[1,0,1] op_sel_hi:[1,0,1]
 v_add_f32_dpp v56, v52, v52 row_ror:8 row_mask:0xf bank_mask:0xf
 v_add_f32_dpp v57, v53, v53 row_ror:8 row_mask:0xf bank_mask:0xf
 v_add_f32_dpp v58, v54, v54 row_ror:8 row_mask:0xf bank_mask:0xf
 v_add_f32_dpp v59, v55, v55 row_ror:8 row_mask:0xf bank_mask:0xf
 v_cvt_pk_bf16_f32 v120, v56, v57
 v_cvt_pk_bf16_f32 v121, v58, v59
 s_waitcnt lgkmcnt(0)
 v_fma_mix_f32 v52, v48, 1.0, v50 op_sel:[0,0,0] op_sel_hi:[1,0,1]
 v_fma_mix_f32 v53, v48, 1.0, v50 op_sel:[1,0,1] op_sel_hi:[1,0,1]
 v_fma_mix_f32 v54, v49, 1.0, v51 op_sel:[0,0,0] op_sel_hi:[1,0,1]
 v_fma_mix_f32 v55, v49, 1.0, v51 op_sel:[1,0,1] op_sel_hi:[1,0,1]
 v_mfma_f32_16x16x32_bf16 v[40:43], v[112:115], v[118:121], 0
 v_add_f32_dpp v56, v52, v52 row_ror:8 row_mask:0xf bank_mask:0xf
 v_add_f32_dpp v57, v53, v53 row_ror:8 row_mask:0xf bank_mask:0xf
 v_add_f32_dpp v58, v54, v54 row_ror:8 row_mask:0xf bank_mask:0xf
 v_add_f32_dpp v59, v55, v55 row_ror:8 row_mask:0xf bank_mask:0xf
 v_cvt_pk_bf16_f32 v122, v56, v57
 v_cvt_pk_bf16_f32 v123, v58, v59
 s_nop 1
 v_mfma_f32_16x16x32_bf16 v[40:43], v[116:119], v[122:125], v[40:43]
 ds_read_b128 v[28:31], v16 offset:24576
 ds_read_b128 v[32:35], v16 offset:25600
 ds_read_b128 v[64:67], v16 offset:27648
 ds_read_b128 v[68:71], v16 offset:28672
 ds_read_b128 v[72:75], v16 offset:30720
 ds_read_b128 v[76:79], v16 offset:31744
 s_nop 0
 s_mov_b64 exec, s[74:75]
 v_cvt_pk_f16_f32 v44, v40, v41
 v_cvt_pk_f16_f32 v45, v42, v43
 v_and_or_b32 v44, v44, -2, s88
 s_cmp_eq_u32 s53, 1
 s_cbranch_scc1 si_92
 buffer_store_dwordx2 v[44:45], v7, s[8:11], s81 offen sc1
 s_branch si_93
si_92:
 buffer_store_dwordx2 v[44:45], v7, s[8:11], s81 offen
si_93:
 s_mov_b64 exec, -1
 s_branch bw_90
bw_91:
 s_lshr_b32 s21, 4, s20
 s_bitcmp1_b32 s21, 0
 s_cbranch_scc0 bw_94
 ds_read_b64_tr_b16 v[40:41], v6 offset:0
 ds_read_b64_tr_b16 v[42:43], v6 offset:1920
 ds_read_b64_tr_b16 v[44:45], v6 offset:3840
 ds_read_b64_tr_b16 v[46:47], v6 offset:5760
 ds_read_b64_tr_b16 v[48:49], v6 offset:640
 ds_read_b64_tr_b16 v[50:51], v6 offset:2560
 ds_read_b64_tr_b16 v[52:53], v6 offset:4480
 ds_read_b64_tr_b16 v[54:55], v6 offset:6400
 ds_read_b64_tr_b16 v[56:57], v6 offset:1280
 ds_read_b64_tr_b16 v[58:59], v6 offset:3200
 ds_read_b64_tr_b16 v[60:61], v6 offset:5120
 ds_read_b64_tr_b16 v[62:63], v6 offset:7040
 s_waitcnt lgkmcnt(8)
 v_pk_add_f16 v40, v40, v42
 v_pk_add_f16 v44, v44, v46
 v_pk_add_f16 v41, v41, v43
 v_pk_add_f16 v45, v45, v47
 v_fma_mix_f32 v146, v40, 1.0, v44 op_sel:[0,0,0] op_sel_hi:[1,0,1]
 v_fma_mix_f32 v147, v40, 1.0, v44 op_sel:[1,0,1] op_sel_hi:[1,0,1]
 v_fma_mix_f32 v148, v41, 1.0, v45 op_sel:[0,0,0] op_sel_hi:[1,0,1]
 v_fma_mix_f32 v149, v41, 1.0, v45 op_sel:[1,0,1] op_sel_hi:[1,0,1]
 v_cvt_pk_bf16_f32 v118, v146, v147
 v_cvt_pk_bf16_f32 v119, v148, v149
 s_waitcnt lgkmcnt(4)
 v_pk_add_f16 v48, v48, v50
 v_pk_add_f16 v52, v52, v54
 v_pk_add_f16 v49, v49, v51
 v_pk_add_f16 v53, v53, v55
 v_fma_mix_f32 v146, v48, 1.0, v52 op_sel:[0,0,0] op_sel_hi:[1,0,1]
 v_fma_mix_f32 v147, v48, 1.0, v52 op_sel:[1,0,1] op_sel_hi:[1,0,1]
 v_fma_mix_f32 v148, v49, 1.0, v53 op_sel:[0,0,0] op_sel_hi:[1,0,1]
 v_fma_mix_f32 v149, v49, 1.0, v53 op_sel:[1,0,1] op_sel_hi:[1,0,1]
 v_cvt_pk_bf16_f32 v120, v146, v147
 v_cvt_pk_bf16_f32 v121, v148, v149
 s_waitcnt lgkmcnt(0)
 v_pk_add_f16 v56, v56, v58
 v_pk_add_f16 v60, v60, v62
 v_pk_add_f16 v57, v57, v59
 v_pk_add_f16 v61, v61, v63
 v_fma_mix_f32 v146, v56, 1.0, v60 op_sel:[0,0,0] op_sel_hi:[1,0,1]
 v_fma_mix_f32 v147, v56, 1.0, v60 op_sel:[1,0,1] op_sel_hi:[1,0,1]
 v_mfma_f32_16x16x32_bf16 v[40:43], v[118:121], v[118:121], 0
 v_fma_mix_f32 v148, v57, 1.0, v61 op_sel:[0,0,0] op_sel_hi:[1,0,1]
 v_fma_mix_f32 v149, v57, 1.0, v61 op_sel:[1,0,1] op_sel_hi:[1,0,1]
 v_cvt_pk_bf16_f32 v122, v146, v147
 v_cvt_pk_bf16_f32 v123, v148, v149
 s_nop 1
 v_mfma_f32_16x16x32_bf16 v[40:43], v[122:125], v[122:125], v[40:43]
 ds_read_b128 v[28:31], v16 offset:24576
 ds_read_b128 v[32:35], v16 offset:25600
 ds_read_b128 v[64:67], v16 offset:27648
 ds_read_b128 v[68:71], v16 offset:28672
 ds_read_b128 v[72:75], v16 offset:30720
 ds_read_b128 v[76:79], v16 offset:31744
 s_nop 0
 s_mov_b64 exec, s[74:75]
 v_cvt_pk_f16_f32 v44, v40, v41
 v_cvt_pk_f16_f32 v45, v42, v43
 v_and_or_b32 v44, v44, -2, s88
 s_cmp_eq_u32 s53, 1
 s_cbranch_scc1 si_95
 buffer_store_dwordx2 v[44:45], v7, s[8:11], s81 offen sc1
 s_branch si_96
si_95:
 buffer_store_dwordx2 v[44:45], v7, s[8:11], s81 offen
si_96:
 s_mov_b64 exec, -1
 s_branch bw_90
bw_94:
 s_lshr_b32 s21, 8, s20
 s_bitcmp1_b32 s21, 0
 s_cbranch_scc0 bw_97
 ds_read_b128 v[28:31], v16 offset:24576
 ds_read_b128 v[32:35], v16 offset:25600
 ds_read_b128 v[64:67], v16 offset:27648
 ds_read_b128 v[68:71], v16 offset:28672
 ds_read_b128 v[72:75], v16 offset:30720
 ds_read_b128 v[76:79], v16 offset:31744
 s_branch bw_90
bw_97:
bw_90:
 ds_read_b128 v[80:83], v16 offset:33792
 ds_read_b128 v[84:87], v16 offset:34816
 ds_read_b64 v[88:89], v16 offset:26624
 ds_read_b64 v[90:91], v16 offset:29696
 ds_read_b64 v[92:93], v16 offset:32768
 ds_read_b64 v[94:95], v16 offset:35840
 s_cmp_eq_u32 s52, 63
 s_cbranch_scc1 last_84
 s_waitcnt lgkmcnt(10)
 v_smfmac_f32_16x16x64_f16 v[100:103], v[28:31], a[120:127], v25
 v_smfmac_f32_16x16x64_f16 v[104:107], v[28:31], a[128:135], v25
 v_smfmac_f32_16x16x64_f16 v[108:111], v[28:31], a[136:143], v25
 s_mov_b32 s54, 0
 v_smfmac_f32_16x16x64_f16 v[100:103], v[32:35], a[144:151], v25
 v_readfirstlane_b32 s21, v0
 v_smfmac_f32_16x16x64_f16 v[104:107], v[32:35], a[152:159], v25
 s_add_u32 s22, s46, 3
 v_smfmac_f32_16x16x64_f16 v[108:111], v[32:35], a[160:167], v25
 s_min_u32 s22, s22, 64
 s_waitcnt lgkmcnt(7)
 v_smfmac_f32_16x16x64_f16 v[100:103], v[64:67], a[168:175], v25
 s_sub_u32 s55, s21, s22
 v_smfmac_f32_16x16x64_f16 v[104:107], v[64:67], a[176:183], v25
 s_sub_u32 s56, s21, s46
 v_smfmac_f32_16x16x64_f16 v[108:111], v[64:67], a[184:191], v25
 v_smfmac_f32_16x16x64_f16 v[100:103], v[68:71], a[192:199], v25
 v_smfmac_f32_16x16x64_f16 v[104:107], v[68:71], a[200:207], v25
 v_smfmac_f32_16x16x64_f16 v[108:111], v[68:71], a[208:215], v25
 v_smfmac_f32_16x16x64_f16 v[100:103], v[72:75], a[216:223], v25
 v_smfmac_f32_16x16x64_f16 v[104:107], v[72:75], a[224:231], v25
 v_smfmac_f32_16x16x64_f16 v[108:111], v[72:75], a[232:239], v25
 s_waitcnt lgkmcnt(4)
 v_smfmac_f32_16x16x64_f16 v[100:103], v[76:79], a[240:247], v25
 v_smfmac_f32_16x16x64_f16 v[104:107], v[76:79], a[248:255], v25
 v_smfmac_f32_16x16x64_f16 v[108:111], v[76:79], v[152:159], v25
 v_smfmac_f32_16x16x64_f16 v[100:103], v[80:83], v[160:167], v25
 v_smfmac_f32_16x16x64_f16 v[104:107], v[80:83], v[168:175], v25
 v_smfmac_f32_16x16x64_f16 v[108:111], v[80:83], v[176:183], v25
 v_smfmac_f32_16x16x64_f16 v[100:103], v[84:87], v[184:191], v25
 v_smfmac_f32_16x16x64_f16 v[104:107], v[84:87], v[192:199], v25
 v_smfmac_f32_16x16x64_f16 v[108:111], v[84:87], v[200:207], v25
 s_waitcnt lgkmcnt(0)
 v_smfmac_f32_16x16x64_f16 v[100:103], v[88:91], v[208:215], v25
 v_smfmac_f32_16x16x64_f16 v[104:107], v[88:91], v[216:223], v25
 v_smfmac_f32_16x16x64_f16 v[108:111], v[88:91], v[224:231], v25
 v_smfmac_f32_16x16x64_f16 v[100:103], v[92:95], v[232:239], v25
 v_smfmac_f32_16x16x64_f16 v[104:107], v[92:95], v[240:247], v25
 v_smfmac_f32_16x16x64_f16 v[108:111], v[92:95], v[248:255], v25
 buffer_load_dwordx2 v[58:59], v9, s[8:11], s81 offen sc1
 buffer_load_dwordx4 v[40:43], v8, s[8:11], s81 offen offset:0 sc1
 buffer_load_dwordx4 v[44:47], v8, s[8:11], s81 offen offset:1024 sc1
 s_cmp_lt_i32 s56, 0
 s_cbranch_scc1 kvw_100
kvok_101:
 s_waitcnt vmcnt(2)
 v_xor_b32 v76, s88, v58
 s_nop 0
 v_permlane16_swap_b32 v58, v59
 v_fma_mix_f32 v60, v58, 1.0, v59 op_sel:[0,0,0] op_sel_hi:[1,0,1]
 v_fma_mix_f32 v61, v58, 1.0, v59 op_sel:[1,0,1] op_sel_hi:[1,0,1]
 v_mov_b32 v58, v60
 v_mov_b32 v59, v61
 s_nop 0
 v_permlane32_swap_b32 v58, v60
 v_permlane32_swap_b32 v59, v61
 v_add_f32 v52, v58, v60
 v_add_f32 v53, v59, v61
 v_max_f32 v79, v52, v53
 s_waitcnt vmcnt(0)
 v_pk_add_f16 v80, v40, v44
 v_pk_add_f16 v82, v42, v46
 v_pk_add_f16 v81, v41, v45
 v_pk_add_f16 v83, v43, v47
 v_permlane32_swap_b32 v80, v82
 v_bitop3_b32 v77, v40, v42, s88 bitop3:0x7e
 v_permlane32_swap_b32 v81, v83
 v_bitop3_b32 v78, v44, v46, s88 bitop3:0x7e
 v_fma_mix_f32 v48, v80, 1.0, v82 op_sel:[0,0,0] op_sel_hi:[1,0,1]
 v_or3_b32 v27, v76, v77, v78
 v_fma_mix_f32 v49, v80, 1.0, v82 op_sel:[1,0,1] op_sel_hi:[1,0,1]
 v_and_b32 v27, 1, v27
 v_fma_mix_f32 v50, v81, 1.0, v83 op_sel:[0,0,0] op_sel_hi:[1,0,1]
 v_cmp_ne_u32 vcc, 0, v27
 v_fma_mix_f32 v51, v81, 1.0, v83 op_sel:[1,0,1] op_sel_hi:[1,0,1]
 v_max3_f32 v62, v48, v49, v79
 s_cbranch_vccnz psr_98
psj_99:
 v_max3_f32 v62, v62, v50, v51
 v_cvt_pk_bf16_f32 v146, v100, v101
 v_cvt_pk_bf16_f32 v147, v102, v103
 v_max_f32_dpp v62, v62, v62 row_ror:8 row_mask:0xf bank_mask:0xf
 v_mov_b32 v63, v62
 v_cvt_pk_bf16_f32 v148, v104, v105
 v_cvt_pk_bf16_f32 v149, v106, v107
 v_permlane32_swap_b32 v62, v63
 v_max_f32 v62, v62, v63
 v_mov_b32 v63, v62
 v_cvt_pk_bf16_f32 v150, v108, v109
 v_cvt_pk_bf16_f32 v151, v110, v111
 v_permlane16_swap_b32 v62, v63
 v_max_f32 v62, v62, v63
 v_mul_f32 v62, s86, v62
 v_fma_f32 v48, v48, s86, -v62
 v_fma_f32 v49, v49, s86, -v62
 v_fma_f32 v50, v50, s86, -v62
 v_fma_f32 v51, v51, s86, -v62
 v_fma_f32 v52, v52, s86, -v62
 v_fma_f32 v53, v53, s86, -v62
 v_exp_f32 v48, v48
 v_exp_f32 v49, v49
 buffer_load_dwordx4 v[88:91], v17, s[28:31], s64 offen offset:0 sc1
 v_exp_f32 v50, v50
 v_exp_f32 v51, v51
 buffer_load_dwordx4 v[92:95], v16, s[28:31], s64 offen offset:1024 sc1
 v_exp_f32 v52, v52
 v_exp_f32 v53, v53
 buffer_load_dwordx4 v[96:99], v20, s[28:31], s64 offen offset:2048 sc1
 v_cvt_pk_bf16_f32 v138, v48, v49
 v_cvt_pk_bf16_f32 v139, v50, v51
 v_cvt_pk_bf16_f32 v142, v52, v53
 v_mov_b32_dpp v140, v138 row_ror:8 row_mask:0xf bank_mask:0xf
 v_mov_b32_dpp v141, v139 row_ror:8 row_mask:0xf bank_mask:0xf
 v_mov_b32_dpp v143, v142 row_ror:8 row_mask:0xf bank_mask:0xf
 s_lshr_b32 s21, 3, s20
 s_bitcmp1_b32 s21, 0
 s_cbranch_scc0 bw_103
 buffer_load_dwordx4 v[112:115], v18, s[16:19], s80 offen sc1
 s_branch bw_102
bw_103:
 s_lshr_b32 s21, 8, s20
 s_bitcmp1_b32 s21, 0
 s_cbranch_scc0 bw_104
 v_mov_b32 v84, s67
 v_mov_b32 v85, s67
 s_mov_b64 exec, 15
 buffer_store_dwordx2 v[84:85], v24, s[12:15], s66 offen sc1
 s_mov_b64 exec, -1
 s_branch bw_102
bw_104:
bw_102:
 v_add_f32 v54, v48, v49
 v_mfma_f32_16x16x32_bf16 v[64:67], v[126:129], v[138:141], 0
 v_add_f32 v55, v50, v51
 v_add_f32 v56, v52, v53
 v_mfma_f32_16x16x32_bf16 v[64:67], v[146:149], v[142:145], v[64:67]
 v_add_f32 v62, v54, v55
 v_fmac_f32 v62, v56, v26
 v_mfma_f32_16x16x32_bf16 v[68:71], v[130:133], v[138:141], 0
 s_lshr_b32 s21, 3, s20
 s_bitcmp1_b32 s21, 0
 s_cbranch_scc0 bw_106
 buffer_load_dwordx2 v[116:117], v19, s[16:19], s80 offen sc1
 s_branch bw_105
bw_106:
bw_105:
 v_add_f32_dpp v62, v62, v62 row_ror:8 row_mask:0xf bank_mask:0xf
 v_mfma_f32_16x16x32_bf16 v[68:71], v[148:151], v[142:145], v[68:71]
 v_mov_b32 v63, v62
 s_cmp_lt_i32 s55, 0
 s_cbranch_scc1 fl_107
fl_108:
 v_mfma_f32_16x16x32_bf16 v[72:75], v[134:137], v[138:141], 0
 v_permlane32_swap_b32 v62, v63
 v_mfma_f32_16x16x32_bf16 v[72:75], v[150:153], v[142:145], v[72:75]
 v_add_f32 v62, v62, v63
 v_mov_b32 v63, v62
 ds_write_b128 v11, v[64:67] offset:0
 s_nop 0
 v_permlane16_swap_b32 v62, v63
 v_add_f32 v62, v62, v63
 v_rcp_f32 v62, v62
 ds_write_b128 v11, v[68:71] offset:1024
 s_mov_b64 exec, 0xff
 ds_write_b32 v22, v62
 s_mov_b64 exec, -1
 ds_write_b128 v11, v[72:75] offset:2048
 s_waitcnt lgkmcnt(0)
 s_barrier
 s_lshr_b32 s21, 7, s20
 s_bitcmp1_b32 s21, 0
 s_cbranch_scc0 bw_110
 ds_read_b128 v[72:75], v23
 ds_read_b64 v[64:65], v12 offset:0
 ds_read_b64 v[66:67], v12 offset:3072
 ds_read_b64 v[68:69], v12 offset:6144
 ds_read_b64 v[70:71], v12 offset:9216
 s_waitcnt lgkmcnt(2)
 v_pk_mul_f32 v[64:65], v[64:65], v[72:73] op_sel_hi:[1,0]
 v_pk_fma_f32 v[64:65], v[66:67], v[72:73], v[64:65] op_sel:[0,1,0] op_sel_hi:[1,1,1]
 s_waitcnt lgkmcnt(0)
 v_pk_fma_f32 v[64:65], v[68:69], v[74:75], v[64:65] op_sel_hi:[1,0,1]
 v_pk_fma_f32 v[64:65], v[70:71], v[74:75], v[64:65] op_sel:[0,1,0] op_sel_hi:[1,1,1]
 v_cvt_pk_f16_f32 v68, v64, v65
 v_perm_b32 v68, s91, v68, v14
 buffer_atomic_pk_add_f16 v68, v13, s[4:7], s3 offen
 s_branch bw_109
bw_110:
 s_lshr_b32 s21, 8, s20
 s_bitcmp1_b32 s21, 0
 s_cbranch_scc0 bw_111
 s_and_b32 s21, s52, 7
 s_cmp_lg_u32 s21, s50
 s_cbranch_scc1 zm_112
 v_mov_b32 v64, 0
 v_mov_b32 v65, 0
 v_mov_b32 v66, 0
 v_mov_b32 v67, 0
 s_mov_b64 exec, s[70:71]
 buffer_store_dwordx4 v[64:67], v13, s[4:7], s83 offen sc1
 s_mov_b64 exec, -1
zm_112:
 s_branch bw_109
bw_111:
bw_109:
 s_lshr_b32 s21, 4, s20
 s_bitcmp1_b32 s21, 0
 s_cbranch_scc0 bw_114
 s_mov_b64 exec, s[62:63]
 buffer_store_dwordx4 v[118:121], v18, s[24:27], s85 offen sc1
 buffer_store_dwordx2 v[122:123], v19, s[24:27], s85 offen sc1
 s_mov_b64 exec, -1
 s_branch bw_113
bw_114:
bw_113:
 v_mov_b32 v76, v108
 v_mov_b32 v77, v109
 v_mov_b32 v78, v110
 v_mov_b32 v79, v111
 v_permlane32_swap_b32 v100, v104
 v_permlane32_swap_b32 v101, v105
 v_permlane32_swap_b32 v102, v106
 v_permlane32_swap_b32 v103, v107
 v_permlane32_swap_b32 v108, v76
 v_permlane32_swap_b32 v109, v77
 v_permlane32_swap_b32 v110, v78
 v_permlane32_swap_b32 v111, v79
 v_pk_add_f32 v[100:101], v[100:101], v[104:105]
 v_pk_add_f32 v[102:103], v[102:103], v[106:107]
 v_pk_add_f32 v[108:109], v[108:109], v[76:77]
 v_pk_add_f32 v[110:111], v[110:111], v[78:79]
 v_cvt_pk_bf16_f32 v80, v100, v101
 v_cvt_pk_bf16_f32 v82, v108, v109
 v_cvt_pk_bf16_f32 v81, v102, v103
 v_cvt_pk_bf16_f32 v83, v110, v111
 s_nop 0
 v_permlane16_swap_b32 v80, v82
 v_permlane16_swap_b32 v81, v83
 v_min_u32 v80, -2, v80
 s_mov_b64 exec, s[76:77]
 buffer_store_dwordx4 v[80:83], v15, s[24:27], s57 offen sc1
 s_mov_b64 exec, -1
 s_add_u32 s64, s64, 1310720
 s_add_u32 s52, s52, 1
 s_branch step_83
fl_88:
 buffer_load_dword v0, off, s[12:15], s79 sc1
 s_branch fl_89
A1_17:
 v_smfmac_f32_16x16x32_f16 v[40:43], v[36:37], a[16:19], v25
 v_smfmac_f32_16x16x32_f16 v[52:55], v[36:37], a[76:79], v25
 v_smfmac_f32_16x16x32_f16 v[44:47], v[36:37], a[36:39], v25
 v_smfmac_f32_16x16x32_f16 v[56:59], v[36:37], a[96:99], v25
 s_branch A2_87
pm_86:
 buffer_load_dwordx4 v[36:39], v4, s[4:7], s84 offen offset:2048 sc1
 buffer_load_dwordx4 v[28:31], v4, s[4:7], s84 offen offset:0 sc1
 buffer_load_dwordx4 v[32:35], v4, s[4:7], s84 offen offset:1024 sc1
 s_nop 7
 v_mov_b32 v40, 0
 v_mov_b32 v41, 0
 v_mov_b32 v42, 0
 v_mov_b32 v43, 0
 v_mov_b32 v52, 0
 v_mov_b32 v53, 0
 v_mov_b32 v54, 0
 v_mov_b32 v55, 0
 v_mov_b32 v44, 0
 v_mov_b32 v45, 0
 v_mov_b32 v46, 0
 v_mov_b32 v47, 0
 v_mov_b32 v56, 0
 v_mov_b32 v57, 0
 v_mov_b32 v58, 0
 v_mov_b32 v59, 0
 s_waitcnt vmcnt(0)
 v_bitop3_b32 v27, v31, v35, v39 bitop3:0x80
 v_perm_b32 v31, v35, v31, s89
 v_cmp_gt_u32 vcc, 0x48000000, v27
 v_mov_b32 v35, v38
 s_cbranch_vccz A1_17
pm_85:
 s_cmp_gt_u32 s52, 3
 s_cbranch_scc1 op_115
 v_readfirstlane_b32 s21, v0
 s_cmp_ge_u32 s21, s46
 s_cbranch_scc1 op_115
 buffer_load_dword v0, off, s[12:15], s79 sc1
 s_waitcnt vmcnt(0)
 v_readfirstlane_b32 s21, v0
 s_cmp_gt_u32 s21, s52
 s_cselect_b32 s21, s87, 0
 s_cmp_eq_u32 s21, 0
 s_cbranch_scc1 op_115
 s_mov_b32 s87, 0
 s_sub_u32 s21, s64, 1310720
 buffer_load_dwordx4 v[126:129], v16, s[28:31], s21 offen offset:0 sc1
 buffer_load_dwordx4 v[130:133], v16, s[28:31], s21 offen offset:1024 sc1
 buffer_load_dwordx4 v[134:137], v16, s[28:31], s21 offen offset:2048 sc1
op_115:
 buffer_load_dwordx4 v[36:39], v4, s[4:7], s84 offen offset:2048 sc1
 buffer_load_dwordx4 v[28:31], v4, s[4:7], s84 offen offset:0 sc1
 buffer_load_dwordx4 v[32:35], v4, s[4:7], s84 offen offset:1024 sc1
 s_add_u32 s54, s54, 1
 s_cmp_gt_u32 s54, 131072
 s_cbranch_scc1 end0
 s_waitcnt vmcnt(0)
 v_bitop3_b32 v27, v31, v35, v39 bitop3:0x80
 v_perm_b32 v31, v35, v31, s89
 v_cmp_gt_u32 vcc, 0x48000000, v27
 v_mov_b32 v35, v38
 s_cbranch_vccnz pm_85
 s_branch A1_17
psr_98:
 buffer_load_dwordx2 v[58:59], v9, s[8:11], s81 offen sc1
 buffer_load_dwordx4 v[40:43], v8, s[8:11], s81 offen offset:0 sc1
 buffer_load_dwordx4 v[44:47], v8, s[8:11], s81 offen offset:1024 sc1
 s_add_u32 s54, s54, 1
 s_cmp_gt_u32 s54, 131072
 s_cbranch_scc1 end0
 s_waitcnt vmcnt(2)
 v_xor_b32 v76, s88, v58
 s_nop 0
 v_permlane16_swap_b32 v58, v59
 v_fma_mix_f32 v60, v58, 1.0, v59 op_sel:[0,0,0] op_sel_hi:[1,0,1]
 v_fma_mix_f32 v61, v58, 1.0, v59 op_sel:[1,0,1] op_sel_hi:[1,0,1]
 v_mov_b32 v58, v60
 v_mov_b32 v59, v61
 s_nop 0
 v_permlane32_swap_b32 v58, v60
 v_permlane32_swap_b32 v59, v61
 v_add_f32 v52, v58, v60
 v_add_f32 v53, v59, v61
 v_max_f32 v79, v52, v53
 s_waitcnt vmcnt(0)
 v_pk_add_f16 v80, v40, v44
 v_pk_add_f16 v82, v42, v46
 v_pk_add_f16 v81, v41, v45
 v_pk_add_f16 v83, v43, v47
 v_permlane32_swap_b32 v80, v82
 v_bitop3_b32 v77, v40, v42, s88 bitop3:0x7e
 v_permlane32_swap_b32 v81, v83
 v_bitop3_b32 v78, v44, v46, s88 bitop3:0x7e
 v_fma_mix_f32 v48, v80, 1.0, v82 op_sel:[0,0,0] op_sel_hi:[1,0,1]
 v_or3_b32 v27, v76, v77, v78
 v_fma_mix_f32 v49, v80, 1.0, v82 op_sel:[1,0,1] op_sel_hi:[1,0,1]
 v_and_b32 v27, 1, v27
 v_fma_mix_f32 v50, v81, 1.0, v83 op_sel:[0,0,0] op_sel_hi:[1,0,1]
 v_cmp_ne_u32 vcc, 0, v27
 v_fma_mix_f32 v51, v81, 1.0, v83 op_sel:[1,0,1] op_sel_hi:[1,0,1]
 v_max3_f32 v62, v48, v49, v79
 s_cbranch_vccnz psr_98
 s_branch psj_99
kvw_100:
 s_mov_b32 s22, s87
 s_cmp_eq_u32 s52, 0
 s_cselect_b32 s55, 0, s55
 s_cselect_b32 s87, 1, 0
 s_cbranch_scc1 kvok_101
 v_mov_b32 v62, 0
 s_mov_b32 s101, 0
wf_116:
 buffer_load_dword v63, v62, s[12:15], s79 offen sc1
 s_add_u32 s101, s101, 1
 s_cmp_gt_u32 s101, 131072
 s_cbranch_scc1 end0
 s_waitcnt vmcnt(0)
 v_readfirstlane_b32 s100, v63
 s_cmp_ge_u32 s100, s46
 s_cbranch_scc1 wf_117
 s_sleep 3
 s_branch wf_116
wf_117:
 s_cmp_eq_u32 s22, 0
 s_cbranch_scc1 kvok_101
 s_sub_u32 s21, s64, 1310720
 buffer_load_dwordx4 v[126:129], v16, s[28:31], s21 offen offset:0 sc1
 buffer_load_dwordx4 v[130:133], v16, s[28:31], s21 offen offset:1024 sc1
 buffer_load_dwordx4 v[134:137], v16, s[28:31], s21 offen offset:2048 sc1
 s_waitcnt vmcnt(0)
 s_branch kvok_101
fl_107:
 buffer_load_dword v0, off, s[12:15], s79 sc1
 s_branch fl_108
last_84:
 s_lshr_b32 s21, 4, s20
 s_bitcmp1_b32 s21, 0
 s_cbranch_scc0 bw_119
 s_mov_b64 exec, s[62:63]
 buffer_store_dwordx4 v[118:121], v18, s[24:27], s85 offen sc1
 buffer_store_dwordx2 v[122:123], v19, s[24:27], s85 offen sc1
 s_mov_b64 exec, -1
 s_branch bw_118
bw_119:
bw_118:
 s_waitcnt lgkmcnt(10)
 v_smfmac_f32_16x16x64_f16 v[100:103], v[28:31], a[120:127], v25
 v_smfmac_f32_16x16x64_f16 v[104:107], v[28:31], a[128:135], v25
 v_smfmac_f32_16x16x64_f16 v[108:111], v[28:31], a[136:143], v25
 v_smfmac_f32_16x16x64_f16 v[100:103], v[32:35], a[144:151], v25
 v_smfmac_f32_16x16x64_f16 v[104:107], v[32:35], a[152:159], v25
 v_smfmac_f32_16x16x64_f16 v[108:111], v[32:35], a[160:167], v25
 s_waitcnt lgkmcnt(7)
 v_smfmac_f32_16x16x64_f16 v[100:103], v[64:67], a[168:175], v25
 v_smfmac_f32_16x16x64_f16 v[104:107], v[64:67], a[176:183], v25
 v_smfmac_f32_16x16x64_f16 v[108:111], v[64:67], a[184:191], v25
 v_smfmac_f32_16x16x64_f16 v[100:103], v[68:71], a[192:199], v25
 v_smfmac_f32_16x16x64_f16 v[104:107], v[68:71], a[200:207], v25
 v_smfmac_f32_16x16x64_f16 v[108:111], v[68:71], a[208:215], v25
 v_smfmac_f32_16x16x64_f16 v[100:103], v[72:75], a[216:223], v25
 v_smfmac_f32_16x16x64_f16 v[104:107], v[72:75], a[224:231], v25
 v_smfmac_f32_16x16x64_f16 v[108:111], v[72:75], a[232:239], v25
 s_waitcnt lgkmcnt(4)
 v_smfmac_f32_16x16x64_f16 v[100:103], v[76:79], a[240:247], v25
 v_smfmac_f32_16x16x64_f16 v[104:107], v[76:79], a[248:255], v25
 v_smfmac_f32_16x16x64_f16 v[108:111], v[76:79], v[152:159], v25
 v_smfmac_f32_16x16x64_f16 v[100:103], v[80:83], v[160:167], v25
 v_smfmac_f32_16x16x64_f16 v[104:107], v[80:83], v[168:175], v25
 v_smfmac_f32_16x16x64_f16 v[108:111], v[80:83], v[176:183], v25
 v_smfmac_f32_16x16x64_f16 v[100:103], v[84:87], v[184:191], v25
 v_smfmac_f32_16x16x64_f16 v[104:107], v[84:87], v[192:199], v25
 v_smfmac_f32_16x16x64_f16 v[108:111], v[84:87], v[200:207], v25
 s_waitcnt lgkmcnt(0)
 v_smfmac_f32_16x16x64_f16 v[100:103], v[88:91], v[208:215], v25
 v_smfmac_f32_16x16x64_f16 v[104:107], v[88:91], v[216:223], v25
 v_smfmac_f32_16x16x64_f16 v[108:111], v[88:91], v[224:231], v25
 v_smfmac_f32_16x16x64_f16 v[100:103], v[92:95], v[232:239], v25
 v_smfmac_f32_16x16x64_f16 v[104:107], v[92:95], v[240:247], v25
 v_smfmac_f32_16x16x64_f16 v[108:111], v[92:95], v[248:255], v25
 s_nop 7
 v_mov_b32 v76, v108
 v_mov_b32 v77, v109
 v_mov_b32 v78, v110
 v_mov_b32 v79, v111
 v_permlane32_swap_b32 v100, v104
 v_permlane32_swap_b32 v101, v105
 v_permlane32_swap_b32 v102, v106
 v_permlane32_swap_b32 v103, v107
 v_permlane32_swap_b32 v108, v76
 v_permlane32_swap_b32 v109, v77
 v_permlane32_swap_b32 v110, v78
 v_permlane32_swap_b32 v111, v79
 v_pk_add_f32 v[100:101], v[100:101], v[104:105]
 v_pk_add_f32 v[102:103], v[102:103], v[106:107]
 v_pk_add_f32 v[108:109], v[108:109], v[76:77]
 v_pk_add_f32 v[110:111], v[110:111], v[78:79]
 v_cvt_pk_bf16_f32 v80, v100, v101
 v_cvt_pk_bf16_f32 v82, v108, v109
 v_cvt_pk_bf16_f32 v81, v102, v103
 v_cvt_pk_bf16_f32 v83, v110, v111
 s_nop 0
 v_permlane16_swap_b32 v80, v82
 v_permlane16_swap_b32 v81, v83
 v_min_u32 v80, -2, v80
 s_mov_b64 exec, s[76:77]
 buffer_store_dwordx4 v[80:83], v15, s[24:27], s57 offen sc1
 s_mov_b64 exec, -1
 s_lshr_b32 s21, 1, s20
 s_bitcmp1_b32 s21, 0
 s_cbranch_scc0 bw_121
 v_mov_b32 v246, 80
 v_mov_b32 v247, 1
 s_mov_b64 exec, 1
 buffer_atomic_add v247, v246, s[32:35], 0 offen sc0 sc1
 s_mov_b64 exec, -1
 s_branch bw_120
bw_121:
bw_120:
 s_branch chain_done
chain_done:
 s_waitcnt vmcnt(0) lgkmcnt(0)
 s_barrier
 s_mov_b32 s84, 0
 s_mov_b32 s85, -1
 s_mov_b32 s86, 0
 v_mov_b32 v21, 0
 v_mov_b32 v23, v247
 s_cmp_lg_u32 s20, 0
 s_cbranch_scc1 queue_b
 s_mov_b64 exec, 1
 s_branch queue_a
end0:
 s_endpgm
gemm_side:
 s_bfe_u32 s23, s22, 0x20005
 s_add_u32 s22, s22, 31
 s_and_b32 s22, s22, 31
 s_lshl_b32 s21, s23, 3
 s_add_u32 s2, s21, s22
 s_add_u32 s3, s2, 72
 s_add_u32 s24, s2, 48
 s_add_u32 s2, s2, s21
 s_cmp_lt_u32 s22, 24
 s_cselect_b32 s3, s24, s3
 s_cmp_lt_u32 s22, 16
 s_cselect_b32 s3, s2, s3
 s_mov_b32 s2, s3
gemm_roles:
 s_cmp_ge_u32 s3, 64
 s_cbranch_scc1 not_kv
 s_load_dwordx2 s[4:5], s[0:1], 0
 s_load_dwordx2 s[6:7], s[0:1], 24
 s_load_dwordx2 s[36:37], s[0:1], 32
 s_load_dwordx2 s[38:39], s[0:1], 104
 s_and_b32 s43, s3, 1
 s_bfe_u32 s42, s3, 0x50001
 s_lshr_b32 s40, s42, 2
 s_waitcnt lgkmcnt(0)
 s_cmp_eq_u32 s43, 1
 s_cselect_b32 s6, s36, s6
 s_cselect_b32 s7, s37, s7
 s_mov_b32 s8, s4
 s_mov_b32 s9, s5
 s_mov_b32 s10, 2621440
 s_mov_b32 s11, 0x00020000
 s_mov_b32 s12, s6
 s_mov_b32 s13, s7
 s_mov_b32 s14, 7864320
 s_mov_b32 s15, 0x00020000
 s_mov_b32 s16, s38
 s_mov_b32 s17, s39
 s_mov_b32 s18, 50331648
 s_mov_b32 s19, 0x00020000
 s_mul_i32 s44, s42, 384
 s_mov_b32 s62, 1024
 s_mov_b32 s24, 0
 s_mov_b32 s25, 81920
 s_mov_b32 s64, s32
 s_mov_b32 s65, s33
 s_mov_b32 s66, s34
 s_mov_b32 s67, s35
 s_load_dwordx2 s[72:73], s[0:1], 104
 s_waitcnt lgkmcnt(0)
 s_add_u32 s72, s72, 81068032
 s_addc_u32 s73, s73, 0
 s_mov_b32 s74, 128000
 s_mov_b32 s75, 0x00020000
 v_mov_b32 v9, 2731
 v_add_u32 v8, 0, v1
 v_mul_u32_u24 v7, v8, v9
 v_lshrrev_b32 v7, 16, v7
 v_mul_u32_u24 v4, 24, v7
 v_sub_u32 v8, v8, v4
 v_and_b32 v4, 2, v7
 v_xor_b32 v8, v8, v4
 v_xor_b32 v5, 4, v8
 s_mov_b32 s21, 12288
 v_mul_lo_u32 v7, v7, s21
 v_lshl_add_u32 v40, v8, 4, v7
 v_lshl_add_u32 v43, v5, 4, v7
 v_add_u32 v8, 64, v1
 v_mul_u32_u24 v7, v8, v9
 v_lshrrev_b32 v7, 16, v7
 v_mul_u32_u24 v4, 24, v7
 v_sub_u32 v8, v8, v4
 v_and_b32 v4, 2, v7
 v_xor_b32 v8, v8, v4
 v_xor_b32 v5, 4, v8
 s_mov_b32 s21, 12288
 v_mul_lo_u32 v7, v7, s21
 v_lshl_add_u32 v41, v8, 4, v7
 v_lshl_add_u32 v44, v5, 4, v7
 v_add_u32 v8, 128, v1
 v_mul_u32_u24 v7, v8, v9
 v_lshrrev_b32 v7, 16, v7
 v_mul_u32_u24 v4, 24, v7
 v_sub_u32 v8, v8, v4
 v_and_b32 v4, 2, v7
 v_xor_b32 v8, v8, v4
 v_xor_b32 v5, 4, v8
 s_mov_b32 s21, 12288
 v_mul_lo_u32 v7, v7, s21
 v_lshl_add_u32 v42, v8, 4, v7
 v_lshl_add_u32 v45, v5, 4, v7
 s_mul_i32 s21, s20, 393216
 s_add_u32 s21, s21, 0
 s_add_u32 s21, s21, s44
 s_mul_i32 s22, s20, 12288
 s_add_u32 s22, s22, 0
 s_add_u32 m0, s22, 0
 s_nop 0
 buffer_load_dwordx4 v40, s[12:15], s21 offen lds
 s_add_u32 m0, s22, 1024
 s_nop 0
 buffer_load_dwordx4 v41, s[12:15], s21 offen lds
 s_add_u32 m0, s22, 2048
 s_nop 0
 buffer_load_dwordx4 v42, s[12:15], s21 offen lds
 s_mul_i32 s21, s20, 393216
 s_add_u32 s21, s21, 98304
 s_add_u32 s21, s21, s44
 s_mul_i32 s22, s20, 12288
 s_add_u32 s22, s22, 3072
 s_add_u32 m0, s22, 0
 s_nop 0
 buffer_load_dwordx4 v43, s[12:15], s21 offen lds
 s_add_u32 m0, s22, 1024
 s_nop 0
 buffer_load_dwordx4 v44, s[12:15], s21 offen lds
 s_add_u32 m0, s22, 2048
 s_nop 0
 buffer_load_dwordx4 v45, s[12:15], s21 offen lds
 s_mul_i32 s21, s20, 393216
 s_add_u32 s21, s21, 196608
 s_add_u32 s21, s21, s44
 s_mul_i32 s22, s20, 12288
 s_add_u32 s22, s22, 6144
 s_add_u32 m0, s22, 0
 s_nop 0
 buffer_load_dwordx4 v40, s[12:15], s21 offen lds
 s_add_u32 m0, s22, 1024
 s_nop 0
 buffer_load_dwordx4 v41, s[12:15], s21 offen lds
 s_add_u32 m0, s22, 2048
 s_nop 0
 buffer_load_dwordx4 v42, s[12:15], s21 offen lds
 s_mul_i32 s21, s20, 393216
 s_add_u32 s21, s21, 294912
 s_add_u32 s21, s21, s44
 s_mul_i32 s22, s20, 12288
 s_add_u32 s22, s22, 9216
 s_add_u32 m0, s22, 0
 s_nop 0
 buffer_load_dwordx4 v43, s[12:15], s21 offen lds
 s_add_u32 m0, s22, 1024
 s_nop 0
 buffer_load_dwordx4 v44, s[12:15], s21 offen lds
 s_add_u32 m0, s22, 2048
 s_nop 0
 buffer_load_dwordx4 v45, s[12:15], s21 offen lds
 v_lshrrev_b32 v11, 3, v1
 v_and_b32 v12, 7, v1
 v_xor_b32 v12, v12, v11
 v_mul_u32_u24 v11, 1280, v11
 v_lshl_add_u32 v10, v12, 4, v11
 s_mul_i32 s46, s20, 20480
 v_add_u32 v10, s46, v10
 s_lshl_b32 s47, s20, 11
 s_add_u32 s47, s47, 98304
 s_add_u32 s46, s47, 57344
 s_mov_b32 s30, s24
 s_add_u32 s32, s47, 0
 v_add_u32 v11, 9216, v10
 s_mov_b32 m0, s32
 s_nop 0
 buffer_load_dwordx4 v10, s[8:11], s30 offen offset:0 lds
 buffer_load_dwordx4 v11, s[8:11], s30 offen offset:1024 lds
 s_add_u32 s30, s30, 128
 s_add_u32 s32, s32, 8192
 s_cmp_lt_u32 s32, s46
 s_cselect_b32 s32, s32, s47
 s_mov_b32 m0, s32
 s_nop 0
 buffer_load_dwordx4 v10, s[8:11], s30 offen offset:0 lds
 buffer_load_dwordx4 v11, s[8:11], s30 offen offset:1024 lds
 s_add_u32 s30, s30, 128
 s_add_u32 s32, s32, 8192
 s_cmp_lt_u32 s32, s46
 s_cselect_b32 s32, s32, s47
 s_mov_b32 m0, s32
 s_nop 0
 buffer_load_dwordx4 v10, s[8:11], s30 offen offset:0 lds
 buffer_load_dwordx4 v11, s[8:11], s30 offen offset:1024 lds
 s_add_u32 s30, s30, 128
 s_add_u32 s32, s32, 8192
 s_cmp_lt_u32 s32, s46
 s_cselect_b32 s32, s32, s47
 s_mov_b32 m0, s32
 s_nop 0
 buffer_load_dwordx4 v10, s[8:11], s30 offen offset:0 lds
 buffer_load_dwordx4 v11, s[8:11], s30 offen offset:1024 lds
 s_add_u32 s30, s30, 128
 s_add_u32 s32, s32, 8192
 s_cmp_lt_u32 s32, s46
 s_cselect_b32 s32, s32, s47
 s_mov_b32 m0, s32
 s_nop 0
 buffer_load_dwordx4 v10, s[8:11], s30 offen offset:0 lds
 buffer_load_dwordx4 v11, s[8:11], s30 offen offset:1024 lds
 s_add_u32 s30, s30, 128
 s_add_u32 s32, s32, 8192
 s_cmp_lt_u32 s32, s46
 s_cselect_b32 s32, s32, s47
 s_mul_i32 s21, s20, 393216
 s_add_u32 s21, s21, 1572864
 s_add_u32 s21, s21, s44
 s_mul_i32 s22, s20, 12288
 s_add_u32 s22, s22, 49152
 s_add_u32 m0, s22, 0
 s_nop 0
 buffer_load_dwordx4 v40, s[12:15], s21 offen lds
 s_add_u32 m0, s22, 1024
 s_nop 0
 buffer_load_dwordx4 v41, s[12:15], s21 offen lds
 s_add_u32 m0, s22, 2048
 s_nop 0
 buffer_load_dwordx4 v42, s[12:15], s21 offen lds
 s_mul_i32 s21, s20, 393216
 s_add_u32 s21, s21, 1671168
 s_add_u32 s21, s21, s44
 s_mul_i32 s22, s20, 12288
 s_add_u32 s22, s22, 52224
 s_add_u32 m0, s22, 0
 s_nop 0
 buffer_load_dwordx4 v43, s[12:15], s21 offen lds
 s_add_u32 m0, s22, 1024
 s_nop 0
 buffer_load_dwordx4 v44, s[12:15], s21 offen lds
 s_add_u32 m0, s22, 2048
 s_nop 0
 buffer_load_dwordx4 v45, s[12:15], s21 offen lds
 s_mul_i32 s21, s20, 393216
 s_add_u32 s21, s21, 1769472
 s_add_u32 s21, s21, s44
 s_mul_i32 s22, s20, 12288
 s_add_u32 s22, s22, 55296
 s_add_u32 m0, s22, 0
 s_nop 0
 buffer_load_dwordx4 v40, s[12:15], s21 offen lds
 s_add_u32 m0, s22, 1024
 s_nop 0
 buffer_load_dwordx4 v41, s[12:15], s21 offen lds
 s_add_u32 m0, s22, 2048
 s_nop 0
 buffer_load_dwordx4 v42, s[12:15], s21 offen lds
 s_mul_i32 s21, s20, 393216
 s_add_u32 s21, s21, 1867776
 s_add_u32 s21, s21, s44
 s_mul_i32 s22, s20, 12288
 s_add_u32 s22, s22, 58368
 s_add_u32 m0, s22, 0
 s_nop 0
 buffer_load_dwordx4 v43, s[12:15], s21 offen lds
 s_add_u32 m0, s22, 1024
 s_nop 0
 buffer_load_dwordx4 v44, s[12:15], s21 offen lds
 s_add_u32 m0, s22, 2048
 s_nop 0
 buffer_load_dwordx4 v45, s[12:15], s21 offen lds
 v_lshrrev_b32 v7, 2, v2
 v_and_b32 v4, 2, v7
 v_and_b32 v5, 1, v3
 v_lshl_or_b32 v4, v5, 2, v4
 v_lshl_add_u32 v7, v3, 3, v7
 v_mul_u32_u24 v7, 384, v7
 v_and_b32 v5, 1, v2
 v_lshl_add_u32 v7, v5, 3, v7
 v_bfe_u32 v8, v2, 1, 1
 s_mul_i32 s21, s20, 6
 v_add_u32 v8, s21, v8
 v_add_u32 v5, 0, v8
 v_xor_b32 v5, v5, v4
 v_lshl_add_u32 v46, v5, 4, v7
 v_add_u32 v49, 49152, v46
 v_add_u32 v5, 2, v8
 v_xor_b32 v5, v5, v4
 v_lshl_add_u32 v47, v5, 4, v7
 v_add_u32 v50, 49152, v47
 v_add_u32 v5, 4, v8
 v_xor_b32 v5, v5, v4
 v_lshl_add_u32 v48, v5, 4, v7
 v_add_u32 v51, 49152, v48
 s_mov_b32 s26, 4
 s_mul_i32 s27, s42, 12288
 s_mul_i32 s21, s43, 25165824
 s_add_u32 s27, s27, s21
 s_mov_b32 s28, 786432
 s_lshl_b32 s60, s40, 7
 s_add_u32 s60, s60, 0
 s_mov_b32 s61, 0
 v_and_b32 v6, 7, v2
 v_add_u32 v4, 0, v3
 v_xor_b32 v4, v4, v6
 v_lshlrev_b32 v4, 4, v4
 v_lshl_add_u32 v14, v2, 7, v4
 v_add_u32 v4, 4, v3
 v_xor_b32 v4, v4, v6
 v_lshlrev_b32 v4, 4, v4
 v_lshl_add_u32 v15, v2, 7, v4
 v_mul_u32_u24 v22, 400, v2
 v_mul_u32_u24 v4, 16, v3
 s_mul_i32 s21, s20, 96
 s_add_u32 s21, s21, 0
 v_add3_u32 v22, v22, v4, s21
 v_lshlrev_b32 v4, 3, v3
 v_sub_u32 v16, v22, v4
 v_mov_b32 v9, 2731
 s_mul_i32 s21, s20, 6400
 s_add_u32 s21, s21, 0
 v_mul_u32_u24 v4, 400, v2
 v_lshlrev_b32 v5, 4, v3
 v_add3_u32 v23, v4, v5, s21
 v_lshlrev_b32 v26, 4, v1
 s_mov_b32 s33, 98304
 s_mov_b32 s48, 0x80000000
 s_mov_b32 m0, s32
 s_nop 0
 buffer_load_dwordx4 v10, s[8:11], s30 offen offset:0 lds
 s_waitcnt vmcnt(21)
 s_barrier
 v_add_u32 v18, s33, v14
 v_add_u32 v19, s33, v15
 s_add_u32 s33, s33, 8192
 s_cmp_lt_u32 s33, 155648
 s_cselect_b32 s33, s33, 98304
 ds_read_b128 v[160:163], v18 offset:0
 ds_read_b128 v[164:167], v18 offset:2048
 ds_read_b128 v[168:171], v18 offset:4096
 ds_read_b128 v[172:175], v18 offset:6144
 s_waitcnt lgkmcnt(0)
 s_waitcnt vmcnt(23)
 s_barrier
 ds_read_b64_tr_b16 a[0:1], v46 offset:0
 ds_read_b64_tr_b16 a[2:3], v46 offset:1536
 ds_read_b64_tr_b16 a[4:5], v47 offset:0
 ds_read_b64_tr_b16 a[6:7], v47 offset:1536
 ds_read_b64_tr_b16 a[8:9], v48 offset:0
 ds_read_b64_tr_b16 a[10:11], v48 offset:1536
 ds_read_b64_tr_b16 a[12:13], v46 offset:12288
 ds_read_b64_tr_b16 a[14:15], v46 offset:13824
 ds_read_b64_tr_b16 a[16:17], v47 offset:12288
 ds_read_b64_tr_b16 a[18:19], v47 offset:13824
 ds_read_b64_tr_b16 a[20:21], v48 offset:12288
 ds_read_b64_tr_b16 a[22:23], v48 offset:13824
 ds_read_b64_tr_b16 a[24:25], v46 offset:24576
 ds_read_b64_tr_b16 a[26:27], v46 offset:26112
 ds_read_b64_tr_b16 a[28:29], v47 offset:24576
 ds_read_b64_tr_b16 a[30:31], v47 offset:26112
 ds_read_b64_tr_b16 a[32:33], v48 offset:24576
 ds_read_b64_tr_b16 a[34:35], v48 offset:26112
 ds_read_b64_tr_b16 a[36:37], v46 offset:36864
 ds_read_b64_tr_b16 a[38:39], v46 offset:38400
 ds_read_b64_tr_b16 a[40:41], v47 offset:36864
 ds_read_b64_tr_b16 a[42:43], v47 offset:38400
 ds_read_b64_tr_b16 a[44:45], v48 offset:36864
 ds_read_b64_tr_b16 a[46:47], v48 offset:38400
 s_waitcnt lgkmcnt(0)
 s_barrier
 s_mov_b32 s23, m0
 s_mul_i32 s21, s20, 393216
 s_add_u32 s21, s21, 3145728
 s_add_u32 s21, s21, s44
 s_mul_i32 s22, s20, 12288
 s_add_u32 s22, s22, 0
 s_add_u32 m0, s22, 0
 s_nop 0
 buffer_load_dwordx4 v40, s[12:15], s21 offen lds
 s_add_u32 m0, s22, 1024
 s_nop 0
 buffer_load_dwordx4 v41, s[12:15], s21 offen lds
 s_add_u32 m0, s22, 2048
 s_nop 0
 buffer_load_dwordx4 v42, s[12:15], s21 offen lds
 s_mul_i32 s21, s20, 393216
 s_add_u32 s21, s21, 3244032
 s_add_u32 s21, s21, s44
 s_mul_i32 s22, s20, 12288
 s_add_u32 s22, s22, 3072
 s_add_u32 m0, s22, 0
 s_nop 0
 buffer_load_dwordx4 v43, s[12:15], s21 offen lds
 s_add_u32 m0, s22, 1024
 s_nop 0
 buffer_load_dwordx4 v44, s[12:15], s21 offen lds
 s_add_u32 m0, s22, 2048
 s_nop 0
 buffer_load_dwordx4 v45, s[12:15], s21 offen lds
 s_mul_i32 s21, s20, 393216
 s_add_u32 s21, s21, 3342336
 s_add_u32 s21, s21, s44
 s_mul_i32 s22, s20, 12288
 s_add_u32 s22, s22, 6144
 s_add_u32 m0, s22, 0
 s_nop 0
 buffer_load_dwordx4 v40, s[12:15], s21 offen lds
 s_add_u32 m0, s22, 1024
 s_nop 0
 buffer_load_dwordx4 v41, s[12:15], s21 offen lds
 s_add_u32 m0, s22, 2048
 s_nop 0
 buffer_load_dwordx4 v42, s[12:15], s21 offen lds
 s_mul_i32 s21, s20, 393216
 s_add_u32 s21, s21, 3440640
 s_add_u32 s21, s21, s44
 s_mul_i32 s22, s20, 12288
 s_add_u32 s22, s22, 9216
 s_add_u32 m0, s22, 0
 s_nop 0
 buffer_load_dwordx4 v43, s[12:15], s21 offen lds
 s_add_u32 m0, s22, 1024
 s_nop 0
 buffer_load_dwordx4 v44, s[12:15], s21 offen lds
 s_add_u32 m0, s22, 2048
 s_nop 0
 buffer_load_dwordx4 v45, s[12:15], s21 offen lds
 s_mov_b32 m0, s23
 v_mfma_f32_16x16x32_bf16 v[64:67], a[0:3], v[160:163], 0
 ds_read_b128 v[192:195], v19 offset:0
 v_mfma_f32_16x16x32_bf16 v[68:71], a[4:7], v[160:163], 0
 v_add_u32 v18, s33, v14
 v_mfma_f32_16x16x32_bf16 v[72:75], a[8:11], v[160:163], 0
 v_mfma_f32_16x16x32_bf16 v[76:79], a[0:3], v[164:167], 0
 ds_read_b128 v[196:199], v19 offset:2048
 v_mfma_f32_16x16x32_bf16 v[80:83], a[4:7], v[164:167], 0
 buffer_load_dwordx4 v11, s[8:11], s30 offen offset:1024 lds
 v_mfma_f32_16x16x32_bf16 v[84:87], a[8:11], v[164:167], 0
 s_add_u32 s30, s30, 128
 v_mfma_f32_16x16x32_bf16 v[88:91], a[0:3], v[168:171], 0
 ds_read_b128 v[200:203], v19 offset:4096
 s_add_u32 m0, m0, 8192
 v_mfma_f32_16x16x32_bf16 v[92:95], a[4:7], v[168:171], 0
 s_cmp_lt_u32 m0, s46
 s_cselect_b32 m0, m0, s47
 v_mfma_f32_16x16x32_bf16 v[96:99], a[8:11], v[168:171], 0
 v_mfma_f32_16x16x32_bf16 v[100:103], a[0:3], v[172:175], 0
 ds_read_b128 v[204:207], v19 offset:6144
 v_mfma_f32_16x16x32_bf16 v[104:107], a[4:7], v[172:175], 0
 v_mfma_f32_16x16x32_bf16 v[108:111], a[8:11], v[172:175], 0
 s_waitcnt vmcnt(32) lgkmcnt(2)
 s_barrier
 v_mfma_f32_16x16x32_bf16 v[64:67], a[12:15], v[192:195], v[64:67]
 ds_read_b128 v[160:163], v18 offset:0
 v_mfma_f32_16x16x32_bf16 v[68:71], a[16:19], v[192:195], v[68:71]
 v_mfma_f32_16x16x32_bf16 v[72:75], a[20:23], v[192:195], v[72:75]
 v_add_u32 v19, s33, v15
 s_add_u32 s33, s33, 8192
 v_mfma_f32_16x16x32_bf16 v[76:79], a[12:15], v[196:199], v[76:79]
 ds_read_b128 v[164:167], v18 offset:2048
 v_mfma_f32_16x16x32_bf16 v[80:83], a[16:19], v[196:199], v[80:83]
 buffer_load_dwordx4 v10, s[8:11], s30 offen offset:0 lds
 v_mfma_f32_16x16x32_bf16 v[84:87], a[20:23], v[196:199], v[84:87]
 s_waitcnt lgkmcnt(2)
 v_mfma_f32_16x16x32_bf16 v[88:91], a[12:15], v[200:203], v[88:91]
 ds_read_b128 v[168:171], v18 offset:4096
 v_mfma_f32_16x16x32_bf16 v[92:95], a[16:19], v[200:203], v[92:95]
 s_cmp_lt_u32 s33, 155648
 s_cselect_b32 s33, s33, 98304
 v_mfma_f32_16x16x32_bf16 v[96:99], a[20:23], v[200:203], v[96:99]
 v_mfma_f32_16x16x32_bf16 v[100:103], a[12:15], v[204:207], v[100:103]
 ds_read_b128 v[172:175], v18 offset:6144
 v_mfma_f32_16x16x32_bf16 v[104:107], a[16:19], v[204:207], v[104:107]
 v_mfma_f32_16x16x32_bf16 v[108:111], a[20:23], v[204:207], v[108:111]
 s_waitcnt lgkmcnt(2)
 v_mfma_f32_16x16x32_bf16 v[64:67], a[24:27], v[160:163], v[64:67]
 ds_read_b128 v[192:195], v19 offset:0
 v_mfma_f32_16x16x32_bf16 v[68:71], a[28:31], v[160:163], v[68:71]
 v_add_u32 v18, s33, v14
 v_mfma_f32_16x16x32_bf16 v[72:75], a[32:35], v[160:163], v[72:75]
 v_mfma_f32_16x16x32_bf16 v[76:79], a[24:27], v[164:167], v[76:79]
 ds_read_b128 v[196:199], v19 offset:2048
 v_mfma_f32_16x16x32_bf16 v[80:83], a[28:31], v[164:167], v[80:83]
 buffer_load_dwordx4 v11, s[8:11], s30 offen offset:1024 lds
 v_mfma_f32_16x16x32_bf16 v[84:87], a[32:35], v[164:167], v[84:87]
 s_waitcnt lgkmcnt(2)
 s_add_u32 s30, s30, 128
 v_mfma_f32_16x16x32_bf16 v[88:91], a[24:27], v[168:171], v[88:91]
 ds_read_b128 v[200:203], v19 offset:4096
 s_add_u32 m0, m0, 8192
 v_mfma_f32_16x16x32_bf16 v[92:95], a[28:31], v[168:171], v[92:95]
 s_cmp_lt_u32 m0, s46
 s_cselect_b32 m0, m0, s47
 v_mfma_f32_16x16x32_bf16 v[96:99], a[32:35], v[168:171], v[96:99]
 v_mfma_f32_16x16x32_bf16 v[100:103], a[24:27], v[172:175], v[100:103]
 ds_read_b128 v[204:207], v19 offset:6144
 v_mfma_f32_16x16x32_bf16 v[104:107], a[28:31], v[172:175], v[104:107]
 v_mfma_f32_16x16x32_bf16 v[108:111], a[32:35], v[172:175], v[108:111]
 s_waitcnt vmcnt(32) lgkmcnt(2)
 s_barrier
 v_mfma_f32_16x16x32_bf16 v[64:67], a[36:39], v[192:195], v[64:67]
 ds_read_b128 v[160:163], v18 offset:0
 v_mfma_f32_16x16x32_bf16 v[68:71], a[40:43], v[192:195], v[68:71]
 v_mfma_f32_16x16x32_bf16 v[72:75], a[44:47], v[192:195], v[72:75]
 v_add_u32 v19, s33, v15
 s_add_u32 s33, s33, 8192
 v_mfma_f32_16x16x32_bf16 v[76:79], a[36:39], v[196:199], v[76:79]
 ds_read_b128 v[164:167], v18 offset:2048
 v_mfma_f32_16x16x32_bf16 v[80:83], a[40:43], v[196:199], v[80:83]
 buffer_load_dwordx4 v10, s[8:11], s30 offen offset:0 lds
 v_mfma_f32_16x16x32_bf16 v[84:87], a[44:47], v[196:199], v[84:87]
 s_waitcnt lgkmcnt(2)
 v_mfma_f32_16x16x32_bf16 v[88:91], a[36:39], v[200:203], v[88:91]
 ds_read_b128 v[168:171], v18 offset:4096
 v_mfma_f32_16x16x32_bf16 v[92:95], a[40:43], v[200:203], v[92:95]
 s_cmp_lt_u32 s33, 155648
 s_cselect_b32 s33, s33, 98304
 v_mfma_f32_16x16x32_bf16 v[96:99], a[44:47], v[200:203], v[96:99]
 v_mfma_f32_16x16x32_bf16 v[100:103], a[36:39], v[204:207], v[100:103]
 ds_read_b128 v[172:175], v18 offset:6144
 v_mfma_f32_16x16x32_bf16 v[104:107], a[40:43], v[204:207], v[104:107]
 v_mfma_f32_16x16x32_bf16 v[108:111], a[44:47], v[204:207], v[108:111]
 s_waitcnt lgkmcnt(2)
 s_waitcnt vmcnt(17)
 s_barrier
 ds_read_b64_tr_b16 a[48:49], v49 offset:0
 ds_read_b64_tr_b16 a[50:51], v49 offset:1536
 ds_read_b64_tr_b16 a[52:53], v50 offset:0
 ds_read_b64_tr_b16 a[54:55], v50 offset:1536
 ds_read_b64_tr_b16 a[56:57], v51 offset:0
 ds_read_b64_tr_b16 a[58:59], v51 offset:1536
 ds_read_b64_tr_b16 a[60:61], v49 offset:12288
 ds_read_b64_tr_b16 a[62:63], v49 offset:13824
 ds_read_b64_tr_b16 a[64:65], v50 offset:12288
 ds_read_b64_tr_b16 a[66:67], v50 offset:13824
 ds_read_b64_tr_b16 a[68:69], v51 offset:12288
 ds_read_b64_tr_b16 a[70:71], v51 offset:13824
 ds_read_b64_tr_b16 a[72:73], v49 offset:24576
 ds_read_b64_tr_b16 a[74:75], v49 offset:26112
 ds_read_b64_tr_b16 a[76:77], v50 offset:24576
 ds_read_b64_tr_b16 a[78:79], v50 offset:26112
 ds_read_b64_tr_b16 a[80:81], v51 offset:24576
 ds_read_b64_tr_b16 a[82:83], v51 offset:26112
 ds_read_b64_tr_b16 a[84:85], v49 offset:36864
 ds_read_b64_tr_b16 a[86:87], v49 offset:38400
 ds_read_b64_tr_b16 a[88:89], v50 offset:36864
 ds_read_b64_tr_b16 a[90:91], v50 offset:38400
 ds_read_b64_tr_b16 a[92:93], v51 offset:36864
 ds_read_b64_tr_b16 a[94:95], v51 offset:38400
 s_waitcnt lgkmcnt(0)
 s_barrier
 s_mov_b32 s23, m0
 s_mul_i32 s21, s20, 393216
 s_add_u32 s21, s21, 4718592
 s_add_u32 s21, s21, s44
 s_mul_i32 s22, s20, 12288
 s_add_u32 s22, s22, 49152
 s_add_u32 m0, s22, 0
 s_nop 0
 buffer_load_dwordx4 v40, s[12:15], s21 offen lds
 s_add_u32 m0, s22, 1024
 s_nop 0
 buffer_load_dwordx4 v41, s[12:15], s21 offen lds
 s_add_u32 m0, s22, 2048
 s_nop 0
 buffer_load_dwordx4 v42, s[12:15], s21 offen lds
 s_mul_i32 s21, s20, 393216
 s_add_u32 s21, s21, 4816896
 s_add_u32 s21, s21, s44
 s_mul_i32 s22, s20, 12288
 s_add_u32 s22, s22, 52224
 s_add_u32 m0, s22, 0
 s_nop 0
 buffer_load_dwordx4 v43, s[12:15], s21 offen lds
 s_add_u32 m0, s22, 1024
 s_nop 0
 buffer_load_dwordx4 v44, s[12:15], s21 offen lds
 s_add_u32 m0, s22, 2048
 s_nop 0
 buffer_load_dwordx4 v45, s[12:15], s21 offen lds
 s_mul_i32 s21, s20, 393216
 s_add_u32 s21, s21, 4915200
 s_add_u32 s21, s21, s44
 s_mul_i32 s22, s20, 12288
 s_add_u32 s22, s22, 55296
 s_add_u32 m0, s22, 0
 s_nop 0
 buffer_load_dwordx4 v40, s[12:15], s21 offen lds
 s_add_u32 m0, s22, 1024
 s_nop 0
 buffer_load_dwordx4 v41, s[12:15], s21 offen lds
 s_add_u32 m0, s22, 2048
 s_nop 0
 buffer_load_dwordx4 v42, s[12:15], s21 offen lds
 s_mul_i32 s21, s20, 393216
 s_add_u32 s21, s21, 5013504
 s_add_u32 s21, s21, s44
 s_mul_i32 s22, s20, 12288
 s_add_u32 s22, s22, 58368
 s_add_u32 m0, s22, 0
 s_nop 0
 buffer_load_dwordx4 v43, s[12:15], s21 offen lds
 s_add_u32 m0, s22, 1024
 s_nop 0
 buffer_load_dwordx4 v44, s[12:15], s21 offen lds
 s_add_u32 m0, s22, 2048
 s_nop 0
 buffer_load_dwordx4 v45, s[12:15], s21 offen lds
 s_mov_b32 m0, s23
 v_mfma_f32_16x16x32_bf16 v[64:67], a[48:51], v[160:163], v[64:67]
 ds_read_b128 v[192:195], v19 offset:0
 v_mfma_f32_16x16x32_bf16 v[68:71], a[52:55], v[160:163], v[68:71]
 v_add_u32 v18, s33, v14
 v_mfma_f32_16x16x32_bf16 v[72:75], a[56:59], v[160:163], v[72:75]
 v_mfma_f32_16x16x32_bf16 v[76:79], a[48:51], v[164:167], v[76:79]
 ds_read_b128 v[196:199], v19 offset:2048
 v_mfma_f32_16x16x32_bf16 v[80:83], a[52:55], v[164:167], v[80:83]
 buffer_load_dwordx4 v11, s[8:11], s30 offen offset:1024 lds
 v_mfma_f32_16x16x32_bf16 v[84:87], a[56:59], v[164:167], v[84:87]
 s_add_u32 s30, s30, 128
 v_mfma_f32_16x16x32_bf16 v[88:91], a[48:51], v[168:171], v[88:91]
 ds_read_b128 v[200:203], v19 offset:4096
 s_add_u32 m0, m0, 8192
 v_mfma_f32_16x16x32_bf16 v[92:95], a[52:55], v[168:171], v[92:95]
 s_cmp_lt_u32 m0, s46
 s_cselect_b32 m0, m0, s47
 v_mfma_f32_16x16x32_bf16 v[96:99], a[56:59], v[168:171], v[96:99]
 v_mfma_f32_16x16x32_bf16 v[100:103], a[48:51], v[172:175], v[100:103]
 ds_read_b128 v[204:207], v19 offset:6144
 v_mfma_f32_16x16x32_bf16 v[104:107], a[52:55], v[172:175], v[104:107]
 v_mfma_f32_16x16x32_bf16 v[108:111], a[56:59], v[172:175], v[108:111]
 s_waitcnt vmcnt(44) lgkmcnt(2)
 s_barrier
 v_mfma_f32_16x16x32_bf16 v[64:67], a[60:63], v[192:195], v[64:67]
 ds_read_b128 v[160:163], v18 offset:0
 v_mfma_f32_16x16x32_bf16 v[68:71], a[64:67], v[192:195], v[68:71]
 v_mfma_f32_16x16x32_bf16 v[72:75], a[68:71], v[192:195], v[72:75]
 v_add_u32 v19, s33, v15
 s_add_u32 s33, s33, 8192
 v_mfma_f32_16x16x32_bf16 v[76:79], a[60:63], v[196:199], v[76:79]
 ds_read_b128 v[164:167], v18 offset:2048
 v_mfma_f32_16x16x32_bf16 v[80:83], a[64:67], v[196:199], v[80:83]
 buffer_load_dwordx4 v10, s[8:11], s30 offen offset:0 lds
 v_mfma_f32_16x16x32_bf16 v[84:87], a[68:71], v[196:199], v[84:87]
 s_waitcnt lgkmcnt(2)
 v_mfma_f32_16x16x32_bf16 v[88:91], a[60:63], v[200:203], v[88:91]
 ds_read_b128 v[168:171], v18 offset:4096
 v_mfma_f32_16x16x32_bf16 v[92:95], a[64:67], v[200:203], v[92:95]
 s_cmp_lt_u32 s33, 155648
 s_cselect_b32 s33, s33, 98304
 v_mfma_f32_16x16x32_bf16 v[96:99], a[68:71], v[200:203], v[96:99]
 v_mfma_f32_16x16x32_bf16 v[100:103], a[60:63], v[204:207], v[100:103]
 ds_read_b128 v[172:175], v18 offset:6144
 v_mfma_f32_16x16x32_bf16 v[104:107], a[64:67], v[204:207], v[104:107]
 v_mfma_f32_16x16x32_bf16 v[108:111], a[68:71], v[204:207], v[108:111]
 s_waitcnt lgkmcnt(2)
 v_mfma_f32_16x16x32_bf16 v[64:67], a[72:75], v[160:163], v[64:67]
 ds_read_b128 v[192:195], v19 offset:0
 v_mfma_f32_16x16x32_bf16 v[68:71], a[76:79], v[160:163], v[68:71]
 v_add_u32 v18, s33, v14
 v_mfma_f32_16x16x32_bf16 v[72:75], a[80:83], v[160:163], v[72:75]
 v_mfma_f32_16x16x32_bf16 v[76:79], a[72:75], v[164:167], v[76:79]
 ds_read_b128 v[196:199], v19 offset:2048
 v_mfma_f32_16x16x32_bf16 v[80:83], a[76:79], v[164:167], v[80:83]
 buffer_load_dwordx4 v11, s[8:11], s30 offen offset:1024 lds
 v_mfma_f32_16x16x32_bf16 v[84:87], a[80:83], v[164:167], v[84:87]
 s_waitcnt lgkmcnt(2)
 s_add_u32 s30, s30, 128
 v_mfma_f32_16x16x32_bf16 v[88:91], a[72:75], v[168:171], v[88:91]
 ds_read_b128 v[200:203], v19 offset:4096
 s_add_u32 m0, m0, 8192
 v_mfma_f32_16x16x32_bf16 v[92:95], a[76:79], v[168:171], v[92:95]
 s_cmp_lt_u32 m0, s46
 s_cselect_b32 m0, m0, s47
 v_mfma_f32_16x16x32_bf16 v[96:99], a[80:83], v[168:171], v[96:99]
 v_mfma_f32_16x16x32_bf16 v[100:103], a[72:75], v[172:175], v[100:103]
 ds_read_b128 v[204:207], v19 offset:6144
 v_mfma_f32_16x16x32_bf16 v[104:107], a[76:79], v[172:175], v[104:107]
 v_mfma_f32_16x16x32_bf16 v[108:111], a[80:83], v[172:175], v[108:111]
 s_waitcnt vmcnt(44) lgkmcnt(2)
 s_barrier
 v_mfma_f32_16x16x32_bf16 v[64:67], a[84:87], v[192:195], v[64:67]
 ds_read_b128 v[160:163], v18 offset:0
 v_mfma_f32_16x16x32_bf16 v[68:71], a[88:91], v[192:195], v[68:71]
 v_mfma_f32_16x16x32_bf16 v[72:75], a[92:95], v[192:195], v[72:75]
 v_add_u32 v19, s33, v15
 s_add_u32 s33, s33, 8192
 v_mfma_f32_16x16x32_bf16 v[76:79], a[84:87], v[196:199], v[76:79]
 ds_read_b128 v[164:167], v18 offset:2048
 v_mfma_f32_16x16x32_bf16 v[80:83], a[88:91], v[196:199], v[80:83]
 buffer_load_dwordx4 v10, s[8:11], s30 offen offset:0 lds
 v_mfma_f32_16x16x32_bf16 v[84:87], a[92:95], v[196:199], v[84:87]
 s_waitcnt lgkmcnt(2)
 v_mfma_f32_16x16x32_bf16 v[88:91], a[84:87], v[200:203], v[88:91]
 ds_read_b128 v[168:171], v18 offset:4096
 v_mfma_f32_16x16x32_bf16 v[92:95], a[88:91], v[200:203], v[92:95]
 s_cmp_lt_u32 s33, 155648
 s_cselect_b32 s33, s33, 98304
 v_mfma_f32_16x16x32_bf16 v[96:99], a[92:95], v[200:203], v[96:99]
 v_mfma_f32_16x16x32_bf16 v[100:103], a[84:87], v[204:207], v[100:103]
 ds_read_b128 v[172:175], v18 offset:6144
 v_mfma_f32_16x16x32_bf16 v[104:107], a[88:91], v[204:207], v[104:107]
 v_mfma_f32_16x16x32_bf16 v[108:111], a[92:95], v[204:207], v[108:111]
 s_waitcnt lgkmcnt(2)
 s_waitcnt vmcnt(20)
 s_barrier
 ds_read_b64_tr_b16 a[96:97], v46 offset:0
 ds_read_b64_tr_b16 a[98:99], v46 offset:1536
 ds_read_b64_tr_b16 a[100:101], v47 offset:0
 ds_read_b64_tr_b16 a[102:103], v47 offset:1536
 ds_read_b64_tr_b16 a[104:105], v48 offset:0
 ds_read_b64_tr_b16 a[106:107], v48 offset:1536
 ds_read_b64_tr_b16 a[108:109], v46 offset:12288
 ds_read_b64_tr_b16 a[110:111], v46 offset:13824
 ds_read_b64_tr_b16 a[112:113], v47 offset:12288
 ds_read_b64_tr_b16 a[114:115], v47 offset:13824
 ds_read_b64_tr_b16 a[116:117], v48 offset:12288
 ds_read_b64_tr_b16 a[118:119], v48 offset:13824
 ds_read_b64_tr_b16 a[120:121], v46 offset:24576
 ds_read_b64_tr_b16 a[122:123], v46 offset:26112
 ds_read_b64_tr_b16 a[124:125], v47 offset:24576
 ds_read_b64_tr_b16 a[126:127], v47 offset:26112
 ds_read_b64_tr_b16 a[128:129], v48 offset:24576
 ds_read_b64_tr_b16 a[130:131], v48 offset:26112
 ds_read_b64_tr_b16 a[132:133], v46 offset:36864
 ds_read_b64_tr_b16 a[134:135], v46 offset:38400
 ds_read_b64_tr_b16 a[136:137], v47 offset:36864
 ds_read_b64_tr_b16 a[138:139], v47 offset:38400
 ds_read_b64_tr_b16 a[140:141], v48 offset:36864
 ds_read_b64_tr_b16 a[142:143], v48 offset:38400
 s_waitcnt lgkmcnt(0)
 s_barrier
 s_mov_b32 s23, m0
 s_mul_i32 s21, s20, 393216
 s_add_u32 s21, s21, 6291456
 s_add_u32 s21, s21, s44
 s_mul_i32 s22, s20, 12288
 s_add_u32 s22, s22, 0
 s_add_u32 m0, s22, 0
 s_nop 0
 buffer_load_dwordx4 v40, s[12:15], s21 offen lds
 s_add_u32 m0, s22, 1024
 s_nop 0
 buffer_load_dwordx4 v41, s[12:15], s21 offen lds
 s_add_u32 m0, s22, 2048
 s_nop 0
 buffer_load_dwordx4 v42, s[12:15], s21 offen lds
 s_mul_i32 s21, s20, 393216
 s_add_u32 s21, s21, 6389760
 s_add_u32 s21, s21, s44
 s_mul_i32 s22, s20, 12288
 s_add_u32 s22, s22, 3072
 s_add_u32 m0, s22, 0
 s_nop 0
 buffer_load_dwordx4 v43, s[12:15], s21 offen lds
 s_add_u32 m0, s22, 1024
 s_nop 0
 buffer_load_dwordx4 v44, s[12:15], s21 offen lds
 s_add_u32 m0, s22, 2048
 s_nop 0
 buffer_load_dwordx4 v45, s[12:15], s21 offen lds
 s_mul_i32 s21, s20, 393216
 s_add_u32 s21, s21, 6488064
 s_add_u32 s21, s21, s44
 s_mul_i32 s22, s20, 12288
 s_add_u32 s22, s22, 6144
 s_add_u32 m0, s22, 0
 s_nop 0
 buffer_load_dwordx4 v40, s[12:15], s21 offen lds
 s_add_u32 m0, s22, 1024
 s_nop 0
 buffer_load_dwordx4 v41, s[12:15], s21 offen lds
 s_add_u32 m0, s22, 2048
 s_nop 0
 buffer_load_dwordx4 v42, s[12:15], s21 offen lds
 s_mul_i32 s21, s20, 393216
 s_add_u32 s21, s21, 6586368
 s_add_u32 s21, s21, s44
 s_mul_i32 s22, s20, 12288
 s_add_u32 s22, s22, 9216
 s_add_u32 m0, s22, 0
 s_nop 0
 buffer_load_dwordx4 v43, s[12:15], s21 offen lds
 s_add_u32 m0, s22, 1024
 s_nop 0
 buffer_load_dwordx4 v44, s[12:15], s21 offen lds
 s_add_u32 m0, s22, 2048
 s_nop 0
 buffer_load_dwordx4 v45, s[12:15], s21 offen lds
 s_mov_b32 m0, s23
 v_mov_b32 v29, 76
 buffer_load_dword v29, v29, s[64:67], 0 offen sc1
 v_mfma_f32_16x16x32_bf16 v[64:67], a[96:99], v[160:163], v[64:67]
 ds_read_b128 v[192:195], v19 offset:0
 v_mfma_f32_16x16x32_bf16 v[68:71], a[100:103], v[160:163], v[68:71]
 v_add_u32 v18, s33, v14
 s_mov_b32 s61, s60
 v_mfma_f32_16x16x32_bf16 v[72:75], a[104:107], v[160:163], v[72:75]
 s_add_u32 s60, s60, s62
 s_lshr_b32 s48, s20, 1
 v_mfma_f32_16x16x32_bf16 v[76:79], a[96:99], v[164:167], v[76:79]
 ds_read_b128 v[196:199], v19 offset:2048
 s_mul_i32 s48, s48, 393216
 v_mfma_f32_16x16x32_bf16 v[80:83], a[100:103], v[164:167], v[80:83]
 buffer_load_dwordx4 v11, s[8:11], s30 offen offset:1024 lds
 v_mfma_f32_16x16x32_bf16 v[84:87], a[104:107], v[164:167], v[84:87]
 s_add_u32 s30, s30, s25
 v_mfma_f32_16x16x32_bf16 v[88:91], a[96:99], v[168:171], v[88:91]
 ds_read_b128 v[200:203], v19 offset:4096
 s_sub_u32 s30, s30, 1152
 v_mfma_f32_16x16x32_bf16 v[92:95], a[100:103], v[168:171], v[92:95]
 s_add_u32 m0, m0, 8192
 s_and_b32 s21, s20, 1
 v_mfma_f32_16x16x32_bf16 v[96:99], a[104:107], v[168:171], v[96:99]
 s_cmp_lt_u32 m0, s46
 s_cselect_b32 m0, m0, s47
 v_mfma_f32_16x16x32_bf16 v[100:103], a[96:99], v[172:175], v[100:103]
 ds_read_b128 v[204:207], v19 offset:6144
 s_mul_i32 s21, s21, 6144
 v_mfma_f32_16x16x32_bf16 v[104:107], a[100:103], v[172:175], v[104:107]
 s_add_u32 s48, s48, s21
 s_add_u32 s48, s48, s27
 v_mfma_f32_16x16x32_bf16 v[108:111], a[104:107], v[172:175], v[108:111]
 s_waitcnt vmcnt(33) lgkmcnt(2)
 s_barrier
 v_mfma_f32_16x16x32_bf16 v[64:67], a[108:111], v[192:195], v[64:67]
 ds_read_b128 v[160:163], v18 offset:0
 s_add_u32 s27, s27, s28
 v_mfma_f32_16x16x32_bf16 v[68:71], a[112:115], v[192:195], v[68:71]
 s_sub_u32 s26, s26, 1
 v_mfma_f32_16x16x32_bf16 v[72:75], a[116:119], v[192:195], v[72:75]
 v_add_u32 v19, s33, v15
 s_add_u32 s33, s33, 8192
 v_mfma_f32_16x16x32_bf16 v[76:79], a[108:111], v[196:199], v[76:79]
 ds_read_b128 v[164:167], v18 offset:2048
 v_mfma_f32_16x16x32_bf16 v[80:83], a[112:115], v[196:199], v[80:83]
 buffer_load_dwordx4 v10, s[8:11], s30 offen offset:0 lds
 v_mfma_f32_16x16x32_bf16 v[84:87], a[116:119], v[196:199], v[84:87]
 s_waitcnt lgkmcnt(2)
 v_mfma_f32_16x16x32_bf16 v[88:91], a[108:111], v[200:203], v[88:91]
 ds_read_b128 v[168:171], v18 offset:4096
 v_mfma_f32_16x16x32_bf16 v[92:95], a[112:115], v[200:203], v[92:95]
 s_cmp_lt_u32 s33, 155648
 s_cselect_b32 s33, s33, 98304
 v_mfma_f32_16x16x32_bf16 v[96:99], a[116:119], v[200:203], v[96:99]
 v_mfma_f32_16x16x32_bf16 v[100:103], a[108:111], v[204:207], v[100:103]
 ds_read_b128 v[172:175], v18 offset:6144
 v_mfma_f32_16x16x32_bf16 v[104:107], a[112:115], v[204:207], v[104:107]
 v_mfma_f32_16x16x32_bf16 v[108:111], a[116:119], v[204:207], v[108:111]
 s_waitcnt lgkmcnt(2)
 v_mfma_f32_16x16x32_bf16 v[64:67], a[120:123], v[160:163], v[64:67]
 ds_read_b128 v[192:195], v19 offset:0
 v_mfma_f32_16x16x32_bf16 v[68:71], a[124:127], v[160:163], v[68:71]
 v_add_u32 v18, s33, v14
 v_mfma_f32_16x16x32_bf16 v[72:75], a[128:131], v[160:163], v[72:75]
 v_mfma_f32_16x16x32_bf16 v[76:79], a[120:123], v[164:167], v[76:79]
 ds_read_b128 v[196:199], v19 offset:2048
 v_mfma_f32_16x16x32_bf16 v[80:83], a[124:127], v[164:167], v[80:83]
 buffer_load_dwordx4 v11, s[8:11], s30 offen offset:1024 lds
 v_mfma_f32_16x16x32_bf16 v[84:87], a[128:131], v[164:167], v[84:87]
 s_waitcnt lgkmcnt(2)
 s_add_u32 s30, s30, 128
 v_mfma_f32_16x16x32_bf16 v[88:91], a[120:123], v[168:171], v[88:91]
 ds_read_b128 v[200:203], v19 offset:4096
 s_add_u32 m0, m0, 8192
 v_mfma_f32_16x16x32_bf16 v[92:95], a[124:127], v[168:171], v[92:95]
 s_cmp_lt_u32 m0, s46
 s_cselect_b32 m0, m0, s47
 v_mfma_f32_16x16x32_bf16 v[96:99], a[128:131], v[168:171], v[96:99]
 v_mfma_f32_16x16x32_bf16 v[100:103], a[120:123], v[172:175], v[100:103]
 ds_read_b128 v[204:207], v19 offset:6144
 v_mfma_f32_16x16x32_bf16 v[104:107], a[124:127], v[172:175], v[104:107]
 v_mfma_f32_16x16x32_bf16 v[108:111], a[128:131], v[172:175], v[108:111]
 s_waitcnt vmcnt(33) lgkmcnt(2)
 s_barrier
 v_mfma_f32_16x16x32_bf16 v[64:67], a[132:135], v[192:195], v[64:67]
 ds_read_b128 v[160:163], v18 offset:0
 v_mfma_f32_16x16x32_bf16 v[68:71], a[136:139], v[192:195], v[68:71]
 v_mfma_f32_16x16x32_bf16 v[72:75], a[140:143], v[192:195], v[72:75]
 v_add_u32 v19, s33, v15
 s_add_u32 s33, s33, 8192
 v_mfma_f32_16x16x32_bf16 v[76:79], a[132:135], v[196:199], v[76:79]
 ds_read_b128 v[164:167], v18 offset:2048
 v_mfma_f32_16x16x32_bf16 v[80:83], a[136:139], v[196:199], v[80:83]
 buffer_load_dwordx4 v10, s[8:11], s30 offen offset:0 lds
 v_mfma_f32_16x16x32_bf16 v[84:87], a[140:143], v[196:199], v[84:87]
 s_waitcnt lgkmcnt(2)
 v_mfma_f32_16x16x32_bf16 v[88:91], a[132:135], v[200:203], v[88:91]
 ds_read_b128 v[168:171], v18 offset:4096
 v_mfma_f32_16x16x32_bf16 v[92:95], a[136:139], v[200:203], v[92:95]
 s_cmp_lt_u32 s33, 155648
 s_cselect_b32 s33, s33, 98304
 v_mfma_f32_16x16x32_bf16 v[96:99], a[140:143], v[200:203], v[96:99]
 v_mfma_f32_16x16x32_bf16 v[100:103], a[132:135], v[204:207], v[100:103]
 ds_read_b128 v[172:175], v18 offset:6144
 v_mfma_f32_16x16x32_bf16 v[104:107], a[136:139], v[204:207], v[104:107]
 v_mfma_f32_16x16x32_bf16 v[108:111], a[140:143], v[204:207], v[108:111]
 s_waitcnt lgkmcnt(2)
 s_waitcnt vmcnt(21)
 s_barrier
 ds_read_b64_tr_b16 a[144:145], v49 offset:0
 ds_read_b64_tr_b16 a[146:147], v49 offset:1536
 ds_read_b64_tr_b16 a[148:149], v50 offset:0
 ds_read_b64_tr_b16 a[150:151], v50 offset:1536
 ds_read_b64_tr_b16 a[152:153], v51 offset:0
 ds_read_b64_tr_b16 a[154:155], v51 offset:1536
 ds_read_b64_tr_b16 a[156:157], v49 offset:12288
 ds_read_b64_tr_b16 a[158:159], v49 offset:13824
 ds_read_b64_tr_b16 a[160:161], v50 offset:12288
 ds_read_b64_tr_b16 a[162:163], v50 offset:13824
 ds_read_b64_tr_b16 a[164:165], v51 offset:12288
 ds_read_b64_tr_b16 a[166:167], v51 offset:13824
 ds_read_b64_tr_b16 a[168:169], v49 offset:24576
 ds_read_b64_tr_b16 a[170:171], v49 offset:26112
 ds_read_b64_tr_b16 a[172:173], v50 offset:24576
 ds_read_b64_tr_b16 a[174:175], v50 offset:26112
 ds_read_b64_tr_b16 a[176:177], v51 offset:24576
 ds_read_b64_tr_b16 a[178:179], v51 offset:26112
 ds_read_b64_tr_b16 a[180:181], v49 offset:36864
 ds_read_b64_tr_b16 a[182:183], v49 offset:38400
 ds_read_b64_tr_b16 a[184:185], v50 offset:36864
 ds_read_b64_tr_b16 a[186:187], v50 offset:38400
 ds_read_b64_tr_b16 a[188:189], v51 offset:36864
 ds_read_b64_tr_b16 a[190:191], v51 offset:38400
 s_waitcnt lgkmcnt(0)
 s_barrier
 v_mfma_f32_16x16x32_bf16 v[64:67], a[144:147], v[160:163], v[64:67]
 ds_read_b128 v[192:195], v19 offset:0
 v_mfma_f32_16x16x32_bf16 v[68:71], a[148:151], v[160:163], v[68:71]
 v_add_u32 v18, s33, v14
 v_mfma_f32_16x16x32_bf16 v[72:75], a[152:155], v[160:163], v[72:75]
 v_mfma_f32_16x16x32_bf16 v[76:79], a[144:147], v[164:167], v[76:79]
 ds_read_b128 v[196:199], v19 offset:2048
 v_mfma_f32_16x16x32_bf16 v[80:83], a[148:151], v[164:167], v[80:83]
 buffer_load_dwordx4 v11, s[8:11], s30 offen offset:1024 lds
 v_mfma_f32_16x16x32_bf16 v[84:87], a[152:155], v[164:167], v[84:87]
 s_add_u32 s30, s30, 128
 v_mfma_f32_16x16x32_bf16 v[88:91], a[144:147], v[168:171], v[88:91]
 ds_read_b128 v[200:203], v19 offset:4096
 s_add_u32 m0, m0, 8192
 v_mfma_f32_16x16x32_bf16 v[92:95], a[148:151], v[168:171], v[92:95]
 s_cmp_lt_u32 m0, s46
 s_cselect_b32 m0, m0, s47
 v_mfma_f32_16x16x32_bf16 v[96:99], a[152:155], v[168:171], v[96:99]
 v_mfma_f32_16x16x32_bf16 v[100:103], a[144:147], v[172:175], v[100:103]
 ds_read_b128 v[204:207], v19 offset:6144
 v_mfma_f32_16x16x32_bf16 v[104:107], a[148:151], v[172:175], v[104:107]
 v_mfma_f32_16x16x32_bf16 v[108:111], a[152:155], v[172:175], v[108:111]
 s_waitcnt vmcnt(21) lgkmcnt(2)
 s_barrier
 v_mfma_f32_16x16x32_bf16 v[64:67], a[156:159], v[192:195], v[64:67]
 ds_read_b128 v[160:163], v18 offset:0
 v_mfma_f32_16x16x32_bf16 v[68:71], a[160:163], v[192:195], v[68:71]
 v_mfma_f32_16x16x32_bf16 v[72:75], a[164:167], v[192:195], v[72:75]
 v_add_u32 v19, s33, v15
 s_add_u32 s33, s33, 8192
 v_mfma_f32_16x16x32_bf16 v[76:79], a[156:159], v[196:199], v[76:79]
 ds_read_b128 v[164:167], v18 offset:2048
 v_mfma_f32_16x16x32_bf16 v[80:83], a[160:163], v[196:199], v[80:83]
 buffer_load_dwordx4 v10, s[8:11], s30 offen offset:0 lds
 v_mfma_f32_16x16x32_bf16 v[84:87], a[164:167], v[196:199], v[84:87]
 s_waitcnt lgkmcnt(2)
 v_mfma_f32_16x16x32_bf16 v[88:91], a[156:159], v[200:203], v[88:91]
 ds_read_b128 v[168:171], v18 offset:4096
 v_mfma_f32_16x16x32_bf16 v[92:95], a[160:163], v[200:203], v[92:95]
 s_cmp_lt_u32 s33, 155648
 s_cselect_b32 s33, s33, 98304
 v_mfma_f32_16x16x32_bf16 v[96:99], a[164:167], v[200:203], v[96:99]
 v_mfma_f32_16x16x32_bf16 v[100:103], a[156:159], v[204:207], v[100:103]
 ds_read_b128 v[172:175], v18 offset:6144
 v_mfma_f32_16x16x32_bf16 v[104:107], a[160:163], v[204:207], v[104:107]
 v_mfma_f32_16x16x32_bf16 v[108:111], a[164:167], v[204:207], v[108:111]
 s_waitcnt lgkmcnt(2)
 v_mfma_f32_16x16x32_bf16 v[64:67], a[168:171], v[160:163], v[64:67]
 ds_read_b128 v[192:195], v19 offset:0
 v_mfma_f32_16x16x32_bf16 v[68:71], a[172:175], v[160:163], v[68:71]
 v_add_u32 v18, s33, v14
 v_mfma_f32_16x16x32_bf16 v[72:75], a[176:179], v[160:163], v[72:75]
 v_mfma_f32_16x16x32_bf16 v[76:79], a[168:171], v[164:167], v[76:79]
 ds_read_b128 v[196:199], v19 offset:2048
 v_mfma_f32_16x16x32_bf16 v[80:83], a[172:175], v[164:167], v[80:83]
 buffer_load_dwordx4 v11, s[8:11], s30 offen offset:1024 lds
 v_mfma_f32_16x16x32_bf16 v[84:87], a[176:179], v[164:167], v[84:87]
 s_waitcnt lgkmcnt(2)
 s_add_u32 s30, s30, 128
 v_mfma_f32_16x16x32_bf16 v[88:91], a[168:171], v[168:171], v[88:91]
 ds_read_b128 v[200:203], v19 offset:4096
 s_add_u32 m0, m0, 8192
 v_mfma_f32_16x16x32_bf16 v[92:95], a[172:175], v[168:171], v[92:95]
 s_cmp_lt_u32 m0, s46
 s_cselect_b32 m0, m0, s47
 v_mfma_f32_16x16x32_bf16 v[96:99], a[176:179], v[168:171], v[96:99]
 v_mfma_f32_16x16x32_bf16 v[100:103], a[168:171], v[172:175], v[100:103]
 ds_read_b128 v[204:207], v19 offset:6144
 v_mfma_f32_16x16x32_bf16 v[104:107], a[172:175], v[172:175], v[104:107]
 v_mfma_f32_16x16x32_bf16 v[108:111], a[176:179], v[172:175], v[108:111]
 s_waitcnt vmcnt(21) lgkmcnt(2)
 s_barrier
 v_mfma_f32_16x16x32_bf16 v[64:67], a[180:183], v[192:195], v[64:67]
 ds_read_b128 v[160:163], v18 offset:0
 v_mfma_f32_16x16x32_bf16 v[68:71], a[184:187], v[192:195], v[68:71]
 v_mfma_f32_16x16x32_bf16 v[72:75], a[188:191], v[192:195], v[72:75]
 v_add_u32 v19, s33, v15
 s_add_u32 s33, s33, 8192
 v_mfma_f32_16x16x32_bf16 v[76:79], a[180:183], v[196:199], v[76:79]
 ds_read_b128 v[164:167], v18 offset:2048
 v_mfma_f32_16x16x32_bf16 v[80:83], a[184:187], v[196:199], v[80:83]
 buffer_load_dwordx4 v10, s[8:11], s30 offen offset:0 lds
 v_mfma_f32_16x16x32_bf16 v[84:87], a[188:191], v[196:199], v[84:87]
 s_waitcnt lgkmcnt(2)
 v_mfma_f32_16x16x32_bf16 v[88:91], a[180:183], v[200:203], v[88:91]
 ds_read_b128 v[168:171], v18 offset:4096
 v_mfma_f32_16x16x32_bf16 v[92:95], a[184:187], v[200:203], v[92:95]
 s_cmp_lt_u32 s33, 155648
 s_cselect_b32 s33, s33, 98304
 v_mfma_f32_16x16x32_bf16 v[96:99], a[188:191], v[200:203], v[96:99]
 v_mfma_f32_16x16x32_bf16 v[100:103], a[180:183], v[204:207], v[100:103]
 ds_read_b128 v[172:175], v18 offset:6144
 v_mfma_f32_16x16x32_bf16 v[104:107], a[184:187], v[204:207], v[104:107]
 v_mfma_f32_16x16x32_bf16 v[108:111], a[188:191], v[204:207], v[108:111]
 s_waitcnt lgkmcnt(2)
 s_waitcnt vmcnt(9)
 s_barrier
 ds_read_b64_tr_b16 a[192:193], v46 offset:0
 ds_read_b64_tr_b16 a[194:195], v46 offset:1536
 ds_read_b64_tr_b16 a[196:197], v47 offset:0
 ds_read_b64_tr_b16 a[198:199], v47 offset:1536
 ds_read_b64_tr_b16 a[200:201], v48 offset:0
 ds_read_b64_tr_b16 a[202:203], v48 offset:1536
 ds_read_b64_tr_b16 a[204:205], v46 offset:12288
 ds_read_b64_tr_b16 a[206:207], v46 offset:13824
 ds_read_b64_tr_b16 a[208:209], v47 offset:12288
 ds_read_b64_tr_b16 a[210:211], v47 offset:13824
 ds_read_b64_tr_b16 a[212:213], v48 offset:12288
 ds_read_b64_tr_b16 a[214:215], v48 offset:13824
 ds_read_b64_tr_b16 a[216:217], v46 offset:24576
 ds_read_b64_tr_b16 a[218:219], v46 offset:26112
 ds_read_b64_tr_b16 a[220:221], v47 offset:24576
 ds_read_b64_tr_b16 a[222:223], v47 offset:26112
 ds_read_b64_tr_b16 a[224:225], v48 offset:24576
 ds_read_b64_tr_b16 a[226:227], v48 offset:26112
 ds_read_b64_tr_b16 a[228:229], v46 offset:36864
 ds_read_b64_tr_b16 a[230:231], v46 offset:38400
 ds_read_b64_tr_b16 a[232:233], v47 offset:36864
 ds_read_b64_tr_b16 a[234:235], v47 offset:38400
 ds_read_b64_tr_b16 a[236:237], v48 offset:36864
 ds_read_b64_tr_b16 a[238:239], v48 offset:38400
 s_waitcnt lgkmcnt(0)
 s_barrier
 v_mfma_f32_16x16x32_bf16 v[64:67], a[192:195], v[160:163], v[64:67]
 ds_read_b128 v[192:195], v19 offset:0
 v_mfma_f32_16x16x32_bf16 v[68:71], a[196:199], v[160:163], v[68:71]
 v_add_u32 v18, s33, v14
 v_mfma_f32_16x16x32_bf16 v[72:75], a[200:203], v[160:163], v[72:75]
 v_mfma_f32_16x16x32_bf16 v[76:79], a[192:195], v[164:167], v[76:79]
 ds_read_b128 v[196:199], v19 offset:2048
 v_mfma_f32_16x16x32_bf16 v[80:83], a[196:199], v[164:167], v[80:83]
 buffer_load_dwordx4 v11, s[8:11], s30 offen offset:1024 lds
 v_mfma_f32_16x16x32_bf16 v[84:87], a[200:203], v[164:167], v[84:87]
 s_add_u32 s30, s30, 128
 v_mfma_f32_16x16x32_bf16 v[88:91], a[192:195], v[168:171], v[88:91]
 ds_read_b128 v[200:203], v19 offset:4096
 s_add_u32 m0, m0, 8192
 v_mfma_f32_16x16x32_bf16 v[92:95], a[196:199], v[168:171], v[92:95]
 s_cmp_lt_u32 m0, s46
 s_cselect_b32 m0, m0, s47
 v_mfma_f32_16x16x32_bf16 v[96:99], a[200:203], v[168:171], v[96:99]
 v_mfma_f32_16x16x32_bf16 v[100:103], a[192:195], v[172:175], v[100:103]
 ds_read_b128 v[204:207], v19 offset:6144
 v_mfma_f32_16x16x32_bf16 v[104:107], a[196:199], v[172:175], v[104:107]
 v_mfma_f32_16x16x32_bf16 v[108:111], a[200:203], v[172:175], v[108:111]
 s_waitcnt vmcnt(8) lgkmcnt(2)
 s_barrier
 v_mfma_f32_16x16x32_bf16 v[64:67], a[204:207], v[192:195], v[64:67]
 ds_read_b128 v[160:163], v18 offset:0
 v_mfma_f32_16x16x32_bf16 v[68:71], a[208:211], v[192:195], v[68:71]
 v_mfma_f32_16x16x32_bf16 v[72:75], a[212:215], v[192:195], v[72:75]
 v_add_u32 v19, s33, v15
 s_add_u32 s33, s33, 8192
 v_mfma_f32_16x16x32_bf16 v[76:79], a[204:207], v[196:199], v[76:79]
 ds_read_b128 v[164:167], v18 offset:2048
 v_mfma_f32_16x16x32_bf16 v[80:83], a[208:211], v[196:199], v[80:83]
 buffer_load_dwordx4 v10, s[8:11], s30 offen offset:0 lds
 v_mfma_f32_16x16x32_bf16 v[84:87], a[212:215], v[196:199], v[84:87]
 s_waitcnt lgkmcnt(2)
 v_mfma_f32_16x16x32_bf16 v[88:91], a[204:207], v[200:203], v[88:91]
 ds_read_b128 v[168:171], v18 offset:4096
 v_mfma_f32_16x16x32_bf16 v[92:95], a[208:211], v[200:203], v[92:95]
 s_cmp_lt_u32 s33, 155648
 s_cselect_b32 s33, s33, 98304
 v_mfma_f32_16x16x32_bf16 v[96:99], a[212:215], v[200:203], v[96:99]
 v_mfma_f32_16x16x32_bf16 v[100:103], a[204:207], v[204:207], v[100:103]
 ds_read_b128 v[172:175], v18 offset:6144
 v_mfma_f32_16x16x32_bf16 v[104:107], a[208:211], v[204:207], v[104:107]
 v_mfma_f32_16x16x32_bf16 v[108:111], a[212:215], v[204:207], v[108:111]
 s_waitcnt lgkmcnt(2)
 v_mfma_f32_16x16x32_bf16 v[64:67], a[216:219], v[160:163], v[64:67]
 ds_read_b128 v[192:195], v19 offset:0
 v_mfma_f32_16x16x32_bf16 v[68:71], a[220:223], v[160:163], v[68:71]
 v_add_u32 v18, s33, v14
 v_mfma_f32_16x16x32_bf16 v[72:75], a[224:227], v[160:163], v[72:75]
 v_mfma_f32_16x16x32_bf16 v[76:79], a[216:219], v[164:167], v[76:79]
 ds_read_b128 v[196:199], v19 offset:2048
 v_mfma_f32_16x16x32_bf16 v[80:83], a[220:223], v[164:167], v[80:83]
 buffer_load_dwordx4 v11, s[8:11], s30 offen offset:1024 lds
 v_mfma_f32_16x16x32_bf16 v[84:87], a[224:227], v[164:167], v[84:87]
 s_waitcnt lgkmcnt(2)
 s_add_u32 s30, s30, 128
 v_mfma_f32_16x16x32_bf16 v[88:91], a[216:219], v[168:171], v[88:91]
 ds_read_b128 v[200:203], v19 offset:4096
 s_add_u32 m0, m0, 8192
 v_mfma_f32_16x16x32_bf16 v[92:95], a[220:223], v[168:171], v[92:95]
 s_cmp_lt_u32 m0, s46
 s_cselect_b32 m0, m0, s47
 v_mfma_f32_16x16x32_bf16 v[96:99], a[224:227], v[168:171], v[96:99]
 v_mfma_f32_16x16x32_bf16 v[100:103], a[216:219], v[172:175], v[100:103]
 ds_read_b128 v[204:207], v19 offset:6144
 v_mfma_f32_16x16x32_bf16 v[104:107], a[220:223], v[172:175], v[104:107]
 v_mfma_f32_16x16x32_bf16 v[108:111], a[224:227], v[172:175], v[108:111]
 s_waitcnt vmcnt(8) lgkmcnt(2)
 s_barrier
 v_mfma_f32_16x16x32_bf16 v[64:67], a[228:231], v[192:195], v[64:67]
 ds_read_b128 v[160:163], v18 offset:0
 v_mfma_f32_16x16x32_bf16 v[68:71], a[232:235], v[192:195], v[68:71]
 v_mfma_f32_16x16x32_bf16 v[72:75], a[236:239], v[192:195], v[72:75]
 v_add_u32 v19, s33, v15
 s_add_u32 s33, s33, 8192
 v_mfma_f32_16x16x32_bf16 v[76:79], a[228:231], v[196:199], v[76:79]
 ds_read_b128 v[164:167], v18 offset:2048
 v_cvt_pk_bf16_f32 v224, v64, v65
 v_cvt_pk_bf16_f32 v225, v66, v67
 v_mfma_f32_16x16x32_bf16 v[80:83], a[232:235], v[196:199], v[80:83]
 buffer_load_dwordx4 v10, s[8:11], s30 offen offset:0 lds
 v_cvt_pk_bf16_f32 v226, v68, v69
 v_cvt_pk_bf16_f32 v227, v70, v71
 v_mfma_f32_16x16x32_bf16 v[84:87], a[236:239], v[196:199], v[84:87]
 s_waitcnt lgkmcnt(2)
 v_cvt_pk_bf16_f32 v228, v72, v73
 v_cvt_pk_bf16_f32 v229, v74, v75
 v_mfma_f32_16x16x32_bf16 v[88:91], a[228:231], v[200:203], v[88:91]
 ds_read_b128 v[168:171], v18 offset:4096
 ds_write_b64 v22, v[224:225] offset:0
 v_mfma_f32_16x16x32_bf16 v[92:95], a[232:235], v[200:203], v[92:95]
 s_cmp_lt_u32 s33, 155648
 s_cselect_b32 s33, s33, 98304
 ds_write_b64 v22, v[226:227] offset:8
 v_mfma_f32_16x16x32_bf16 v[96:99], a[236:239], v[200:203], v[96:99]
 ds_write_b64 v16, v[228:229] offset:64
 v_cvt_pk_bf16_f32 v230, v76, v77
 v_cvt_pk_bf16_f32 v231, v78, v79
 v_mfma_f32_16x16x32_bf16 v[100:103], a[228:231], v[204:207], v[100:103]
 ds_read_b128 v[172:175], v18 offset:6144
 v_cvt_pk_bf16_f32 v232, v80, v81
 v_cvt_pk_bf16_f32 v233, v82, v83
 v_cvt_pk_bf16_f32 v234, v84, v85
 v_mfma_f32_16x16x32_bf16 v[104:107], a[232:235], v[204:207], v[104:107]
 v_cvt_pk_bf16_f32 v235, v86, v87
 ds_write_b64 v22, v[230:231] offset:6400
 v_mfma_f32_16x16x32_bf16 v[108:111], a[236:239], v[204:207], v[108:111]
 ds_write_b64 v22, v[232:233] offset:6408
 ds_write_b64 v16, v[234:235] offset:6464
 v_readfirstlane_b32 s21, v29
 s_cmp_ge_u32 s21, 32
 s_cbranch_scc1 kvz_126
 s_mov_b32 s21, 76
 v_mov_b32 v4, 0
 s_mov_b32 s101, 0
wf_127:
 buffer_load_dword v5, v4, s[64:67], s21 offen sc1
 s_add_u32 s101, s101, 1
 s_cmp_gt_u32 s101, 131072
 s_cbranch_scc1 main_end
 s_waitcnt vmcnt(0)
 v_readfirstlane_b32 s100, v5
 s_cmp_ge_u32 s100, 32
 s_cbranch_scc1 wf_128
 s_sleep 8
 s_branch wf_127
wf_128:
kvz_126:
 s_branch kvm_end_125
kvm_blk_124:
 v_mfma_f32_16x16x32_bf16 v[64:67], a[0:3], v[160:163], 0
 ds_read_b128 v[192:195], v19 offset:0
 v_mfma_f32_16x16x32_bf16 v[68:71], a[4:7], v[160:163], 0
 v_add_u32 v18, s33, v14
 v_mfma_f32_16x16x32_bf16 v[72:75], a[8:11], v[160:163], 0
 v_mfma_f32_16x16x32_bf16 v[76:79], a[0:3], v[164:167], 0
 ds_read_b128 v[196:199], v19 offset:2048
 v_mfma_f32_16x16x32_bf16 v[80:83], a[4:7], v[164:167], 0
 buffer_load_dwordx4 v11, s[8:11], s30 offen offset:1024 lds
 v_mfma_f32_16x16x32_bf16 v[84:87], a[8:11], v[164:167], 0
 s_waitcnt lgkmcnt(11)
 s_add_u32 s30, s30, 128
 v_mfma_f32_16x16x32_bf16 v[88:91], a[0:3], v[168:171], 0
 ds_read_b128 v[200:203], v19 offset:4096
 s_add_u32 m0, m0, 8192
 v_mfma_f32_16x16x32_bf16 v[92:95], a[4:7], v[168:171], 0
 s_cmp_lt_u32 m0, s46
 s_cselect_b32 m0, m0, s47
 v_mfma_f32_16x16x32_bf16 v[96:99], a[8:11], v[168:171], 0
 v_mfma_f32_16x16x32_bf16 v[100:103], a[0:3], v[172:175], 0
 ds_read_b128 v[204:207], v19 offset:6144
 v_mfma_f32_16x16x32_bf16 v[104:107], a[4:7], v[172:175], 0
 v_mfma_f32_16x16x32_bf16 v[108:111], a[8:11], v[172:175], 0
 s_waitcnt vmcnt(14) lgkmcnt(2)
 s_barrier
 v_mfma_f32_16x16x32_bf16 v[64:67], a[12:15], v[192:195], v[64:67]
 ds_read_b128 v[160:163], v18 offset:0
 v_mfma_f32_16x16x32_bf16 v[68:71], a[16:19], v[192:195], v[68:71]
 v_mfma_f32_16x16x32_bf16 v[72:75], a[20:23], v[192:195], v[72:75]
 v_add_u32 v19, s33, v15
 s_add_u32 s33, s33, 8192
 v_mfma_f32_16x16x32_bf16 v[76:79], a[12:15], v[196:199], v[76:79]
 ds_read_b128 v[164:167], v18 offset:2048
 v_mfma_f32_16x16x32_bf16 v[80:83], a[16:19], v[196:199], v[80:83]
 buffer_load_dwordx4 v10, s[8:11], s30 offen offset:0 lds
 v_mfma_f32_16x16x32_bf16 v[84:87], a[20:23], v[196:199], v[84:87]
 s_waitcnt lgkmcnt(2)
 v_mfma_f32_16x16x32_bf16 v[88:91], a[12:15], v[200:203], v[88:91]
 ds_read_b128 v[168:171], v18 offset:4096
 v_mfma_f32_16x16x32_bf16 v[92:95], a[16:19], v[200:203], v[92:95]
 s_cmp_lt_u32 s33, 155648
 s_cselect_b32 s33, s33, 98304
 v_mfma_f32_16x16x32_bf16 v[96:99], a[20:23], v[200:203], v[96:99]
 v_mfma_f32_16x16x32_bf16 v[100:103], a[12:15], v[204:207], v[100:103]
 ds_read_b128 v[172:175], v18 offset:6144
 v_mfma_f32_16x16x32_bf16 v[104:107], a[16:19], v[204:207], v[104:107]
 v_mfma_f32_16x16x32_bf16 v[108:111], a[20:23], v[204:207], v[108:111]
 s_waitcnt lgkmcnt(2)
 v_mfma_f32_16x16x32_bf16 v[64:67], a[24:27], v[160:163], v[64:67]
 ds_read_b128 v[192:195], v19 offset:0
 v_mfma_f32_16x16x32_bf16 v[68:71], a[28:31], v[160:163], v[68:71]
 v_add_u32 v18, s33, v14
 v_mfma_f32_16x16x32_bf16 v[72:75], a[32:35], v[160:163], v[72:75]
 v_mfma_f32_16x16x32_bf16 v[76:79], a[24:27], v[164:167], v[76:79]
 ds_read_b128 v[196:199], v19 offset:2048
 v_mfma_f32_16x16x32_bf16 v[80:83], a[28:31], v[164:167], v[80:83]
 buffer_load_dwordx4 v11, s[8:11], s30 offen offset:1024 lds
 v_mfma_f32_16x16x32_bf16 v[84:87], a[32:35], v[164:167], v[84:87]
 s_waitcnt lgkmcnt(2)
 s_add_u32 s30, s30, 128
 v_mfma_f32_16x16x32_bf16 v[88:91], a[24:27], v[168:171], v[88:91]
 ds_read_b128 v[200:203], v19 offset:4096
 s_add_u32 m0, m0, 8192
 v_mfma_f32_16x16x32_bf16 v[92:95], a[28:31], v[168:171], v[92:95]
 s_cmp_lt_u32 m0, s46
 s_cselect_b32 m0, m0, s47
 v_mfma_f32_16x16x32_bf16 v[96:99], a[32:35], v[168:171], v[96:99]
 v_mfma_f32_16x16x32_bf16 v[100:103], a[24:27], v[172:175], v[100:103]
 ds_read_b128 v[204:207], v19 offset:6144
 v_mfma_f32_16x16x32_bf16 v[104:107], a[28:31], v[172:175], v[104:107]
 v_mfma_f32_16x16x32_bf16 v[108:111], a[32:35], v[172:175], v[108:111]
 s_waitcnt vmcnt(14) lgkmcnt(2)
 s_barrier
 v_mfma_f32_16x16x32_bf16 v[64:67], a[36:39], v[192:195], v[64:67]
 ds_read_b128 v[160:163], v18 offset:0
 v_mfma_f32_16x16x32_bf16 v[68:71], a[40:43], v[192:195], v[68:71]
 v_mfma_f32_16x16x32_bf16 v[72:75], a[44:47], v[192:195], v[72:75]
 v_add_u32 v19, s33, v15
 s_add_u32 s33, s33, 8192
 v_mfma_f32_16x16x32_bf16 v[76:79], a[36:39], v[196:199], v[76:79]
 ds_read_b128 v[164:167], v18 offset:2048
 v_mfma_f32_16x16x32_bf16 v[80:83], a[40:43], v[196:199], v[80:83]
 buffer_load_dwordx4 v10, s[8:11], s30 offen offset:0 lds
 v_mfma_f32_16x16x32_bf16 v[84:87], a[44:47], v[196:199], v[84:87]
 s_waitcnt lgkmcnt(2)
 v_mfma_f32_16x16x32_bf16 v[88:91], a[36:39], v[200:203], v[88:91]
 ds_read_b128 v[168:171], v18 offset:4096
 v_mfma_f32_16x16x32_bf16 v[92:95], a[40:43], v[200:203], v[92:95]
 s_cmp_lt_u32 s33, 155648
 s_cselect_b32 s33, s33, 98304
 v_mfma_f32_16x16x32_bf16 v[96:99], a[44:47], v[200:203], v[96:99]
 v_mfma_f32_16x16x32_bf16 v[100:103], a[36:39], v[204:207], v[100:103]
 ds_read_b128 v[172:175], v18 offset:6144
 v_mfma_f32_16x16x32_bf16 v[104:107], a[40:43], v[204:207], v[104:107]
 v_mfma_f32_16x16x32_bf16 v[108:111], a[44:47], v[204:207], v[108:111]
 s_waitcnt lgkmcnt(2)
 v_mfma_f32_16x16x32_bf16 v[64:67], a[48:51], v[160:163], v[64:67]
 ds_read_b128 v[192:195], v19 offset:0
 v_mfma_f32_16x16x32_bf16 v[68:71], a[52:55], v[160:163], v[68:71]
 v_add_u32 v18, s33, v14
 v_mfma_f32_16x16x32_bf16 v[72:75], a[56:59], v[160:163], v[72:75]
 v_mfma_f32_16x16x32_bf16 v[76:79], a[48:51], v[164:167], v[76:79]
 ds_read_b128 v[196:199], v19 offset:2048
 v_mfma_f32_16x16x32_bf16 v[80:83], a[52:55], v[164:167], v[80:83]
 buffer_load_dwordx4 v11, s[8:11], s30 offen offset:1024 lds
 v_mfma_f32_16x16x32_bf16 v[84:87], a[56:59], v[164:167], v[84:87]
 s_waitcnt lgkmcnt(2)
 s_add_u32 s30, s30, 128
 v_mfma_f32_16x16x32_bf16 v[88:91], a[48:51], v[168:171], v[88:91]
 ds_read_b128 v[200:203], v19 offset:4096
 s_add_u32 m0, m0, 8192
 v_mfma_f32_16x16x32_bf16 v[92:95], a[52:55], v[168:171], v[92:95]
 s_cmp_lt_u32 m0, s46
 s_cselect_b32 m0, m0, s47
 v_mfma_f32_16x16x32_bf16 v[96:99], a[56:59], v[168:171], v[96:99]
 v_mfma_f32_16x16x32_bf16 v[100:103], a[48:51], v[172:175], v[100:103]
 ds_read_b128 v[204:207], v19 offset:6144
 v_mfma_f32_16x16x32_bf16 v[104:107], a[52:55], v[172:175], v[104:107]
 v_mfma_f32_16x16x32_bf16 v[108:111], a[56:59], v[172:175], v[108:111]
 s_waitcnt vmcnt(14) lgkmcnt(2)
 s_barrier
 v_mfma_f32_16x16x32_bf16 v[64:67], a[60:63], v[192:195], v[64:67]
 ds_read_b128 v[160:163], v18 offset:0
 v_mfma_f32_16x16x32_bf16 v[68:71], a[64:67], v[192:195], v[68:71]
 v_mfma_f32_16x16x32_bf16 v[72:75], a[68:71], v[192:195], v[72:75]
 v_add_u32 v19, s33, v15
 s_add_u32 s33, s33, 8192
 v_mfma_f32_16x16x32_bf16 v[76:79], a[60:63], v[196:199], v[76:79]
 ds_read_b128 v[164:167], v18 offset:2048
 v_mfma_f32_16x16x32_bf16 v[80:83], a[64:67], v[196:199], v[80:83]
 buffer_load_dwordx4 v10, s[8:11], s30 offen offset:0 lds
 v_mfma_f32_16x16x32_bf16 v[84:87], a[68:71], v[196:199], v[84:87]
 s_waitcnt lgkmcnt(2)
 v_mfma_f32_16x16x32_bf16 v[88:91], a[60:63], v[200:203], v[88:91]
 ds_read_b128 v[168:171], v18 offset:4096
 v_mfma_f32_16x16x32_bf16 v[92:95], a[64:67], v[200:203], v[92:95]
 s_cmp_lt_u32 s33, 155648
 s_cselect_b32 s33, s33, 98304
 v_mfma_f32_16x16x32_bf16 v[96:99], a[68:71], v[200:203], v[96:99]
 v_mfma_f32_16x16x32_bf16 v[100:103], a[60:63], v[204:207], v[100:103]
 ds_read_b128 v[172:175], v18 offset:6144
 v_mfma_f32_16x16x32_bf16 v[104:107], a[64:67], v[204:207], v[104:107]
 v_mfma_f32_16x16x32_bf16 v[108:111], a[68:71], v[204:207], v[108:111]
 s_waitcnt lgkmcnt(2)
 v_mfma_f32_16x16x32_bf16 v[64:67], a[72:75], v[160:163], v[64:67]
 ds_read_b128 v[192:195], v19 offset:0
 v_mfma_f32_16x16x32_bf16 v[68:71], a[76:79], v[160:163], v[68:71]
 v_add_u32 v18, s33, v14
 v_mfma_f32_16x16x32_bf16 v[72:75], a[80:83], v[160:163], v[72:75]
 v_mfma_f32_16x16x32_bf16 v[76:79], a[72:75], v[164:167], v[76:79]
 ds_read_b128 v[196:199], v19 offset:2048
 v_mfma_f32_16x16x32_bf16 v[80:83], a[76:79], v[164:167], v[80:83]
 buffer_load_dwordx4 v11, s[8:11], s30 offen offset:1024 lds
 v_mfma_f32_16x16x32_bf16 v[84:87], a[80:83], v[164:167], v[84:87]
 s_waitcnt lgkmcnt(2)
 s_add_u32 s30, s30, 128
 v_mfma_f32_16x16x32_bf16 v[88:91], a[72:75], v[168:171], v[88:91]
 ds_read_b128 v[200:203], v19 offset:4096
 s_add_u32 m0, m0, 8192
 v_mfma_f32_16x16x32_bf16 v[92:95], a[76:79], v[168:171], v[92:95]
 s_cmp_lt_u32 m0, s46
 s_cselect_b32 m0, m0, s47
 v_mfma_f32_16x16x32_bf16 v[96:99], a[80:83], v[168:171], v[96:99]
 v_mfma_f32_16x16x32_bf16 v[100:103], a[72:75], v[172:175], v[100:103]
 ds_read_b128 v[204:207], v19 offset:6144
 v_mfma_f32_16x16x32_bf16 v[104:107], a[76:79], v[172:175], v[104:107]
 v_mfma_f32_16x16x32_bf16 v[108:111], a[80:83], v[172:175], v[108:111]
 s_waitcnt vmcnt(7) lgkmcnt(2)
 s_barrier
 v_mfma_f32_16x16x32_bf16 v[64:67], a[84:87], v[192:195], v[64:67]
 ds_read_b128 v[160:163], v18 offset:0
 v_mfma_f32_16x16x32_bf16 v[68:71], a[88:91], v[192:195], v[68:71]
 s_cmp_eq_u32 s48, 0x80000000
 s_cbranch_scc1 kvm_122
 s_cmp_lg_u32 s20, 0
 s_cbranch_scc1 af_123
 v_mov_b32 v4, 0
 v_mov_b32 v5, 1
 s_mov_b64 exec, 1
 buffer_atomic_add v5, v4, s[72:75], s61 offen sc1
 s_mov_b64 exec, -1
 s_nop 1
af_123:
kvm_122:
 v_mfma_f32_16x16x32_bf16 v[72:75], a[92:95], v[192:195], v[72:75]
 v_add_u32 v19, s33, v15
 s_add_u32 s33, s33, 8192
 v_mfma_f32_16x16x32_bf16 v[76:79], a[84:87], v[196:199], v[76:79]
 ds_read_b128 v[164:167], v18 offset:2048
 v_mfma_f32_16x16x32_bf16 v[80:83], a[88:91], v[196:199], v[80:83]
 buffer_load_dwordx4 v10, s[8:11], s30 offen offset:0 lds
 v_mfma_f32_16x16x32_bf16 v[84:87], a[92:95], v[196:199], v[84:87]
 s_waitcnt lgkmcnt(2)
 v_mfma_f32_16x16x32_bf16 v[88:91], a[84:87], v[200:203], v[88:91]
 ds_read_b128 v[168:171], v18 offset:4096
 v_mfma_f32_16x16x32_bf16 v[92:95], a[88:91], v[200:203], v[92:95]
 s_cmp_lt_u32 s33, 155648
 s_cselect_b32 s33, s33, 98304
 v_mfma_f32_16x16x32_bf16 v[96:99], a[92:95], v[200:203], v[96:99]
 v_mfma_f32_16x16x32_bf16 v[100:103], a[84:87], v[204:207], v[100:103]
 ds_read_b128 v[172:175], v18 offset:6144
 v_mfma_f32_16x16x32_bf16 v[104:107], a[88:91], v[204:207], v[104:107]
 v_mfma_f32_16x16x32_bf16 v[108:111], a[92:95], v[204:207], v[108:111]
 s_waitcnt lgkmcnt(2)
 v_mfma_f32_16x16x32_bf16 v[64:67], a[96:99], v[160:163], v[64:67]
 ds_read_b128 v[192:195], v19 offset:0
 v_mfma_f32_16x16x32_bf16 v[68:71], a[100:103], v[160:163], v[68:71]
 v_add_u32 v18, s33, v14
 s_mov_b32 s61, s60
 v_mfma_f32_16x16x32_bf16 v[72:75], a[104:107], v[160:163], v[72:75]
 s_add_u32 s60, s60, s62
 s_lshr_b32 s48, s20, 1
 v_mfma_f32_16x16x32_bf16 v[76:79], a[96:99], v[164:167], v[76:79]
 ds_read_b128 v[196:199], v19 offset:2048
 s_mul_i32 s48, s48, 393216
 v_mfma_f32_16x16x32_bf16 v[80:83], a[100:103], v[164:167], v[80:83]
 buffer_load_dwordx4 v11, s[8:11], s30 offen offset:1024 lds
 v_mfma_f32_16x16x32_bf16 v[84:87], a[104:107], v[164:167], v[84:87]
 s_waitcnt lgkmcnt(2)
 s_add_u32 s30, s30, s25
 v_mfma_f32_16x16x32_bf16 v[88:91], a[96:99], v[168:171], v[88:91]
 ds_read_b128 v[200:203], v19 offset:4096
 s_sub_u32 s30, s30, 1152
 v_mfma_f32_16x16x32_bf16 v[92:95], a[100:103], v[168:171], v[92:95]
 s_add_u32 m0, m0, 8192
 s_and_b32 s21, s20, 1
 v_mfma_f32_16x16x32_bf16 v[96:99], a[104:107], v[168:171], v[96:99]
 s_cmp_lt_u32 m0, s46
 s_cselect_b32 m0, m0, s47
 v_mfma_f32_16x16x32_bf16 v[100:103], a[96:99], v[172:175], v[100:103]
 ds_read_b128 v[204:207], v19 offset:6144
 s_mul_i32 s21, s21, 6144
 v_mfma_f32_16x16x32_bf16 v[104:107], a[100:103], v[172:175], v[104:107]
 s_add_u32 s48, s48, s21
 s_add_u32 s48, s48, s27
 v_mfma_f32_16x16x32_bf16 v[108:111], a[104:107], v[172:175], v[108:111]
 s_waitcnt vmcnt(8) lgkmcnt(2)
 s_barrier
 v_mfma_f32_16x16x32_bf16 v[64:67], a[108:111], v[192:195], v[64:67]
 ds_read_b128 v[160:163], v18 offset:0
 s_add_u32 s27, s27, s28
 v_mfma_f32_16x16x32_bf16 v[68:71], a[112:115], v[192:195], v[68:71]
 s_sub_u32 s26, s26, 1
 v_mfma_f32_16x16x32_bf16 v[72:75], a[116:119], v[192:195], v[72:75]
 v_add_u32 v19, s33, v15
 s_add_u32 s33, s33, 8192
 v_mfma_f32_16x16x32_bf16 v[76:79], a[108:111], v[196:199], v[76:79]
 ds_read_b128 v[164:167], v18 offset:2048
 v_mfma_f32_16x16x32_bf16 v[80:83], a[112:115], v[196:199], v[80:83]
 buffer_load_dwordx4 v10, s[8:11], s30 offen offset:0 lds
 v_mfma_f32_16x16x32_bf16 v[84:87], a[116:119], v[196:199], v[84:87]
 s_waitcnt lgkmcnt(2)
 v_mfma_f32_16x16x32_bf16 v[88:91], a[108:111], v[200:203], v[88:91]
 ds_read_b128 v[168:171], v18 offset:4096
 v_mfma_f32_16x16x32_bf16 v[92:95], a[112:115], v[200:203], v[92:95]
 s_cmp_lt_u32 s33, 155648
 s_cselect_b32 s33, s33, 98304
 v_mfma_f32_16x16x32_bf16 v[96:99], a[116:119], v[200:203], v[96:99]
 v_mfma_f32_16x16x32_bf16 v[100:103], a[108:111], v[204:207], v[100:103]
 ds_read_b128 v[172:175], v18 offset:6144
 v_mfma_f32_16x16x32_bf16 v[104:107], a[112:115], v[204:207], v[104:107]
 v_mfma_f32_16x16x32_bf16 v[108:111], a[116:119], v[204:207], v[108:111]
 s_waitcnt lgkmcnt(2)
 v_mfma_f32_16x16x32_bf16 v[64:67], a[120:123], v[160:163], v[64:67]
 ds_read_b128 v[192:195], v19 offset:0
 v_mfma_f32_16x16x32_bf16 v[68:71], a[124:127], v[160:163], v[68:71]
 v_add_u32 v18, s33, v14
 v_mfma_f32_16x16x32_bf16 v[72:75], a[128:131], v[160:163], v[72:75]
 v_mfma_f32_16x16x32_bf16 v[76:79], a[120:123], v[164:167], v[76:79]
 ds_read_b128 v[196:199], v19 offset:2048
 v_mfma_f32_16x16x32_bf16 v[80:83], a[124:127], v[164:167], v[80:83]
 buffer_load_dwordx4 v11, s[8:11], s30 offen offset:1024 lds
 v_mfma_f32_16x16x32_bf16 v[84:87], a[128:131], v[164:167], v[84:87]
 s_waitcnt lgkmcnt(2)
 s_add_u32 s30, s30, 128
 v_mfma_f32_16x16x32_bf16 v[88:91], a[120:123], v[168:171], v[88:91]
 ds_read_b128 v[200:203], v19 offset:4096
 s_add_u32 m0, m0, 8192
 v_mfma_f32_16x16x32_bf16 v[92:95], a[124:127], v[168:171], v[92:95]
 s_cmp_lt_u32 m0, s46
 s_cselect_b32 m0, m0, s47
 v_mfma_f32_16x16x32_bf16 v[96:99], a[128:131], v[168:171], v[96:99]
 v_mfma_f32_16x16x32_bf16 v[100:103], a[120:123], v[172:175], v[100:103]
 ds_read_b128 v[204:207], v19 offset:6144
 v_mfma_f32_16x16x32_bf16 v[104:107], a[124:127], v[172:175], v[104:107]
 v_mfma_f32_16x16x32_bf16 v[108:111], a[128:131], v[172:175], v[108:111]
 s_waitcnt vmcnt(8) lgkmcnt(2)
 s_barrier
 v_mfma_f32_16x16x32_bf16 v[64:67], a[132:135], v[192:195], v[64:67]
 ds_read_b128 v[160:163], v18 offset:0
 v_mfma_f32_16x16x32_bf16 v[68:71], a[136:139], v[192:195], v[68:71]
 v_mfma_f32_16x16x32_bf16 v[72:75], a[140:143], v[192:195], v[72:75]
 v_add_u32 v19, s33, v15
 s_add_u32 s33, s33, 8192
 v_mfma_f32_16x16x32_bf16 v[76:79], a[132:135], v[196:199], v[76:79]
 ds_read_b128 v[164:167], v18 offset:2048
 v_mfma_f32_16x16x32_bf16 v[80:83], a[136:139], v[196:199], v[80:83]
 buffer_load_dwordx4 v10, s[8:11], s30 offen offset:0 lds
 v_mfma_f32_16x16x32_bf16 v[84:87], a[140:143], v[196:199], v[84:87]
 s_waitcnt lgkmcnt(2)
 v_mfma_f32_16x16x32_bf16 v[88:91], a[132:135], v[200:203], v[88:91]
 ds_read_b128 v[168:171], v18 offset:4096
 v_mfma_f32_16x16x32_bf16 v[92:95], a[136:139], v[200:203], v[92:95]
 s_cmp_lt_u32 s33, 155648
 s_cselect_b32 s33, s33, 98304
 v_mfma_f32_16x16x32_bf16 v[96:99], a[140:143], v[200:203], v[96:99]
 v_mfma_f32_16x16x32_bf16 v[100:103], a[132:135], v[204:207], v[100:103]
 ds_read_b128 v[172:175], v18 offset:6144
 v_mfma_f32_16x16x32_bf16 v[104:107], a[136:139], v[204:207], v[104:107]
 v_mfma_f32_16x16x32_bf16 v[108:111], a[140:143], v[204:207], v[108:111]
 s_waitcnt lgkmcnt(2)
 v_mfma_f32_16x16x32_bf16 v[64:67], a[144:147], v[160:163], v[64:67]
 ds_read_b128 v[192:195], v19 offset:0
 v_mfma_f32_16x16x32_bf16 v[68:71], a[148:151], v[160:163], v[68:71]
 v_add_u32 v18, s33, v14
 v_mfma_f32_16x16x32_bf16 v[72:75], a[152:155], v[160:163], v[72:75]
 v_mfma_f32_16x16x32_bf16 v[76:79], a[144:147], v[164:167], v[76:79]
 ds_read_b128 v[196:199], v19 offset:2048
 v_mfma_f32_16x16x32_bf16 v[80:83], a[148:151], v[164:167], v[80:83]
 buffer_load_dwordx4 v11, s[8:11], s30 offen offset:1024 lds
 v_mfma_f32_16x16x32_bf16 v[84:87], a[152:155], v[164:167], v[84:87]
 s_waitcnt lgkmcnt(2)
 s_add_u32 s30, s30, 128
 v_mfma_f32_16x16x32_bf16 v[88:91], a[144:147], v[168:171], v[88:91]
 ds_read_b128 v[200:203], v19 offset:4096
 s_add_u32 m0, m0, 8192
 v_mfma_f32_16x16x32_bf16 v[92:95], a[148:151], v[168:171], v[92:95]
 s_cmp_lt_u32 m0, s46
 s_cselect_b32 m0, m0, s47
 v_mfma_f32_16x16x32_bf16 v[96:99], a[152:155], v[168:171], v[96:99]
 v_mfma_f32_16x16x32_bf16 v[100:103], a[144:147], v[172:175], v[100:103]
 ds_read_b128 v[204:207], v19 offset:6144
 v_mfma_f32_16x16x32_bf16 v[104:107], a[148:151], v[172:175], v[104:107]
 v_mfma_f32_16x16x32_bf16 v[108:111], a[152:155], v[172:175], v[108:111]
 s_waitcnt vmcnt(8) lgkmcnt(2)
 s_barrier
 v_mfma_f32_16x16x32_bf16 v[64:67], a[156:159], v[192:195], v[64:67]
 ds_read_b128 v[160:163], v18 offset:0
 v_mfma_f32_16x16x32_bf16 v[68:71], a[160:163], v[192:195], v[68:71]
 v_mfma_f32_16x16x32_bf16 v[72:75], a[164:167], v[192:195], v[72:75]
 v_add_u32 v19, s33, v15
 s_add_u32 s33, s33, 8192
 v_mfma_f32_16x16x32_bf16 v[76:79], a[156:159], v[196:199], v[76:79]
 ds_read_b128 v[164:167], v18 offset:2048
 v_mfma_f32_16x16x32_bf16 v[80:83], a[160:163], v[196:199], v[80:83]
 buffer_load_dwordx4 v10, s[8:11], s30 offen offset:0 lds
 v_mfma_f32_16x16x32_bf16 v[84:87], a[164:167], v[196:199], v[84:87]
 s_waitcnt lgkmcnt(2)
 v_mfma_f32_16x16x32_bf16 v[88:91], a[156:159], v[200:203], v[88:91]
 ds_read_b128 v[168:171], v18 offset:4096
 v_mfma_f32_16x16x32_bf16 v[92:95], a[160:163], v[200:203], v[92:95]
 s_cmp_lt_u32 s33, 155648
 s_cselect_b32 s33, s33, 98304
 v_mfma_f32_16x16x32_bf16 v[96:99], a[164:167], v[200:203], v[96:99]
 v_mfma_f32_16x16x32_bf16 v[100:103], a[156:159], v[204:207], v[100:103]
 ds_read_b128 v[172:175], v18 offset:6144
 v_mfma_f32_16x16x32_bf16 v[104:107], a[160:163], v[204:207], v[104:107]
 v_mfma_f32_16x16x32_bf16 v[108:111], a[164:167], v[204:207], v[108:111]
 s_waitcnt lgkmcnt(2)
 v_mfma_f32_16x16x32_bf16 v[64:67], a[168:171], v[160:163], v[64:67]
 ds_read_b128 v[192:195], v19 offset:0
 v_mfma_f32_16x16x32_bf16 v[68:71], a[172:175], v[160:163], v[68:71]
 v_add_u32 v18, s33, v14
 v_mfma_f32_16x16x32_bf16 v[72:75], a[176:179], v[160:163], v[72:75]
 v_mfma_f32_16x16x32_bf16 v[76:79], a[168:171], v[164:167], v[76:79]
 ds_read_b128 v[196:199], v19 offset:2048
 v_mfma_f32_16x16x32_bf16 v[80:83], a[172:175], v[164:167], v[80:83]
 buffer_load_dwordx4 v11, s[8:11], s30 offen offset:1024 lds
 v_mfma_f32_16x16x32_bf16 v[84:87], a[176:179], v[164:167], v[84:87]
 s_waitcnt lgkmcnt(2)
 s_add_u32 s30, s30, 128
 v_mfma_f32_16x16x32_bf16 v[88:91], a[168:171], v[168:171], v[88:91]
 ds_read_b128 v[200:203], v19 offset:4096
 s_add_u32 m0, m0, 8192
 v_mfma_f32_16x16x32_bf16 v[92:95], a[172:175], v[168:171], v[92:95]
 s_cmp_lt_u32 m0, s46
 s_cselect_b32 m0, m0, s47
 v_mfma_f32_16x16x32_bf16 v[96:99], a[176:179], v[168:171], v[96:99]
 v_mfma_f32_16x16x32_bf16 v[100:103], a[168:171], v[172:175], v[100:103]
 ds_read_b128 v[204:207], v19 offset:6144
 v_mfma_f32_16x16x32_bf16 v[104:107], a[172:175], v[172:175], v[104:107]
 v_mfma_f32_16x16x32_bf16 v[108:111], a[176:179], v[172:175], v[108:111]
 s_waitcnt vmcnt(8) lgkmcnt(2)
 s_barrier
 v_mfma_f32_16x16x32_bf16 v[64:67], a[180:183], v[192:195], v[64:67]
 ds_read_b128 v[160:163], v18 offset:0
 v_mfma_f32_16x16x32_bf16 v[68:71], a[184:187], v[192:195], v[68:71]
 v_mfma_f32_16x16x32_bf16 v[72:75], a[188:191], v[192:195], v[72:75]
 v_add_u32 v19, s33, v15
 s_add_u32 s33, s33, 8192
 v_mfma_f32_16x16x32_bf16 v[76:79], a[180:183], v[196:199], v[76:79]
 ds_read_b128 v[164:167], v18 offset:2048
 v_mfma_f32_16x16x32_bf16 v[80:83], a[184:187], v[196:199], v[80:83]
 buffer_load_dwordx4 v10, s[8:11], s30 offen offset:0 lds
 v_mfma_f32_16x16x32_bf16 v[84:87], a[188:191], v[196:199], v[84:87]
 s_waitcnt lgkmcnt(2)
 v_mfma_f32_16x16x32_bf16 v[88:91], a[180:183], v[200:203], v[88:91]
 ds_read_b128 v[168:171], v18 offset:4096
 v_mfma_f32_16x16x32_bf16 v[92:95], a[184:187], v[200:203], v[92:95]
 s_cmp_lt_u32 s33, 155648
 s_cselect_b32 s33, s33, 98304
 v_mfma_f32_16x16x32_bf16 v[96:99], a[188:191], v[200:203], v[96:99]
 v_mfma_f32_16x16x32_bf16 v[100:103], a[180:183], v[204:207], v[100:103]
 ds_read_b128 v[172:175], v18 offset:6144
 v_mfma_f32_16x16x32_bf16 v[104:107], a[184:187], v[204:207], v[104:107]
 v_mfma_f32_16x16x32_bf16 v[108:111], a[188:191], v[204:207], v[108:111]
 s_waitcnt lgkmcnt(2)
 v_mfma_f32_16x16x32_bf16 v[64:67], a[192:195], v[160:163], v[64:67]
 ds_read_b128 v[192:195], v19 offset:0
 v_mfma_f32_16x16x32_bf16 v[68:71], a[196:199], v[160:163], v[68:71]
 v_add_u32 v18, s33, v14
 v_mfma_f32_16x16x32_bf16 v[72:75], a[200:203], v[160:163], v[72:75]
 v_mfma_f32_16x16x32_bf16 v[76:79], a[192:195], v[164:167], v[76:79]
 ds_read_b128 v[196:199], v19 offset:2048
 v_mfma_f32_16x16x32_bf16 v[80:83], a[196:199], v[164:167], v[80:83]
 buffer_load_dwordx4 v11, s[8:11], s30 offen offset:1024 lds
 v_mfma_f32_16x16x32_bf16 v[84:87], a[200:203], v[164:167], v[84:87]
 s_waitcnt lgkmcnt(2)
 s_add_u32 s30, s30, 128
 v_mfma_f32_16x16x32_bf16 v[88:91], a[192:195], v[168:171], v[88:91]
 ds_read_b128 v[200:203], v19 offset:4096
 s_add_u32 m0, m0, 8192
 v_mfma_f32_16x16x32_bf16 v[92:95], a[196:199], v[168:171], v[92:95]
 s_cmp_lt_u32 m0, s46
 s_cselect_b32 m0, m0, s47
 v_mfma_f32_16x16x32_bf16 v[96:99], a[200:203], v[168:171], v[96:99]
 v_mfma_f32_16x16x32_bf16 v[100:103], a[192:195], v[172:175], v[100:103]
 ds_read_b128 v[204:207], v19 offset:6144
 v_mfma_f32_16x16x32_bf16 v[104:107], a[196:199], v[172:175], v[104:107]
 v_mfma_f32_16x16x32_bf16 v[108:111], a[200:203], v[172:175], v[108:111]
 s_waitcnt vmcnt(8) lgkmcnt(2)
 s_barrier
 v_mfma_f32_16x16x32_bf16 v[64:67], a[204:207], v[192:195], v[64:67]
 ds_read_b128 v[160:163], v18 offset:0
 v_mfma_f32_16x16x32_bf16 v[68:71], a[208:211], v[192:195], v[68:71]
 v_mfma_f32_16x16x32_bf16 v[72:75], a[212:215], v[192:195], v[72:75]
 v_add_u32 v19, s33, v15
 s_add_u32 s33, s33, 8192
 v_mfma_f32_16x16x32_bf16 v[76:79], a[204:207], v[196:199], v[76:79]
 ds_read_b128 v[164:167], v18 offset:2048
 v_mfma_f32_16x16x32_bf16 v[80:83], a[208:211], v[196:199], v[80:83]
 buffer_load_dwordx4 v10, s[8:11], s30 offen offset:0 lds
 v_mfma_f32_16x16x32_bf16 v[84:87], a[212:215], v[196:199], v[84:87]
 s_waitcnt lgkmcnt(2)
 v_mfma_f32_16x16x32_bf16 v[88:91], a[204:207], v[200:203], v[88:91]
 ds_read_b128 v[168:171], v18 offset:4096
 v_mfma_f32_16x16x32_bf16 v[92:95], a[208:211], v[200:203], v[92:95]
 s_cmp_lt_u32 s33, 155648
 s_cselect_b32 s33, s33, 98304
 v_mfma_f32_16x16x32_bf16 v[96:99], a[212:215], v[200:203], v[96:99]
 v_mfma_f32_16x16x32_bf16 v[100:103], a[204:207], v[204:207], v[100:103]
 ds_read_b128 v[172:175], v18 offset:6144
 v_mfma_f32_16x16x32_bf16 v[104:107], a[208:211], v[204:207], v[104:107]
 v_mfma_f32_16x16x32_bf16 v[108:111], a[212:215], v[204:207], v[108:111]
 s_waitcnt lgkmcnt(2)
 v_mfma_f32_16x16x32_bf16 v[64:67], a[216:219], v[160:163], v[64:67]
 ds_read_b128 v[192:195], v19 offset:0
 v_mfma_f32_16x16x32_bf16 v[68:71], a[220:223], v[160:163], v[68:71]
 v_add_u32 v18, s33, v14
 v_mfma_f32_16x16x32_bf16 v[72:75], a[224:227], v[160:163], v[72:75]
 v_mfma_f32_16x16x32_bf16 v[76:79], a[216:219], v[164:167], v[76:79]
 ds_read_b128 v[196:199], v19 offset:2048
 v_mfma_f32_16x16x32_bf16 v[80:83], a[220:223], v[164:167], v[80:83]
 buffer_load_dwordx4 v11, s[8:11], s30 offen offset:1024 lds
 v_mfma_f32_16x16x32_bf16 v[84:87], a[224:227], v[164:167], v[84:87]
 s_waitcnt lgkmcnt(2)
 s_add_u32 s30, s30, 128
 v_mfma_f32_16x16x32_bf16 v[88:91], a[216:219], v[168:171], v[88:91]
 ds_read_b128 v[200:203], v19 offset:4096
 s_add_u32 m0, m0, 8192
 v_mfma_f32_16x16x32_bf16 v[92:95], a[220:223], v[168:171], v[92:95]
 s_cmp_lt_u32 m0, s46
 s_cselect_b32 m0, m0, s47
 v_mfma_f32_16x16x32_bf16 v[96:99], a[224:227], v[168:171], v[96:99]
 v_mfma_f32_16x16x32_bf16 v[100:103], a[216:219], v[172:175], v[100:103]
 ds_read_b128 v[204:207], v19 offset:6144
 v_mfma_f32_16x16x32_bf16 v[104:107], a[220:223], v[172:175], v[104:107]
 v_mfma_f32_16x16x32_bf16 v[108:111], a[224:227], v[172:175], v[108:111]
 s_waitcnt vmcnt(8) lgkmcnt(2)
 s_barrier
 v_mfma_f32_16x16x32_bf16 v[64:67], a[228:231], v[192:195], v[64:67]
 ds_read_b128 v[160:163], v18 offset:0
 v_mfma_f32_16x16x32_bf16 v[68:71], a[232:235], v[192:195], v[68:71]
 v_mfma_f32_16x16x32_bf16 v[72:75], a[236:239], v[192:195], v[72:75]
 v_add_u32 v19, s33, v15
 s_add_u32 s33, s33, 8192
 v_mfma_f32_16x16x32_bf16 v[76:79], a[228:231], v[196:199], v[76:79]
 ds_read_b128 v[164:167], v18 offset:2048
 v_cvt_pk_bf16_f32 v224, v64, v65
 v_cvt_pk_bf16_f32 v225, v66, v67
 v_mfma_f32_16x16x32_bf16 v[80:83], a[232:235], v[196:199], v[80:83]
 buffer_load_dwordx4 v10, s[8:11], s30 offen offset:0 lds
 v_cvt_pk_bf16_f32 v226, v68, v69
 v_cvt_pk_bf16_f32 v227, v70, v71
 v_mfma_f32_16x16x32_bf16 v[84:87], a[236:239], v[196:199], v[84:87]
 s_waitcnt lgkmcnt(2)
 v_cvt_pk_bf16_f32 v228, v72, v73
 v_cvt_pk_bf16_f32 v229, v74, v75
 v_mfma_f32_16x16x32_bf16 v[88:91], a[228:231], v[200:203], v[88:91]
 ds_read_b128 v[168:171], v18 offset:4096
 ds_write_b64 v22, v[224:225] offset:0
 v_mfma_f32_16x16x32_bf16 v[92:95], a[232:235], v[200:203], v[92:95]
 s_cmp_lt_u32 s33, 155648
 s_cselect_b32 s33, s33, 98304
 ds_write_b64 v22, v[226:227] offset:8
 v_mfma_f32_16x16x32_bf16 v[96:99], a[236:239], v[200:203], v[96:99]
 ds_write_b64 v16, v[228:229] offset:64
 v_cvt_pk_bf16_f32 v230, v76, v77
 v_cvt_pk_bf16_f32 v231, v78, v79
 v_mfma_f32_16x16x32_bf16 v[100:103], a[228:231], v[204:207], v[100:103]
 ds_read_b128 v[172:175], v18 offset:6144
 v_cvt_pk_bf16_f32 v232, v80, v81
 v_cvt_pk_bf16_f32 v233, v82, v83
 v_cvt_pk_bf16_f32 v234, v84, v85
 v_mfma_f32_16x16x32_bf16 v[104:107], a[232:235], v[204:207], v[104:107]
 v_cvt_pk_bf16_f32 v235, v86, v87
 ds_write_b64 v22, v[230:231] offset:6400
 v_mfma_f32_16x16x32_bf16 v[108:111], a[236:239], v[204:207], v[108:111]
 ds_write_b64 v22, v[232:233] offset:6408
 ds_write_b64 v16, v[234:235] offset:6464
kvm_end_125:
 v_cvt_pk_bf16_f32 v236, v88, v89
 v_cvt_pk_bf16_f32 v237, v90, v91
 v_cvt_pk_bf16_f32 v238, v92, v93
 v_cvt_pk_bf16_f32 v239, v94, v95
 v_cvt_pk_bf16_f32 v240, v96, v97
 v_cvt_pk_bf16_f32 v241, v98, v99
 ds_write_b64 v22, v[236:237] offset:12800
 ds_write_b64 v22, v[238:239] offset:12808
 ds_write_b64 v16, v[240:241] offset:12864
 v_cvt_pk_bf16_f32 v242, v100, v101
 v_cvt_pk_bf16_f32 v243, v102, v103
 v_cvt_pk_bf16_f32 v244, v104, v105
 v_cvt_pk_bf16_f32 v245, v106, v107
 v_cvt_pk_bf16_f32 v246, v108, v109
 v_cvt_pk_bf16_f32 v247, v110, v111
 ds_write_b64 v22, v[242:243] offset:19200
 ds_write_b64 v22, v[244:245] offset:19208
 ds_write_b64 v16, v[246:247] offset:19264
 s_waitcnt lgkmcnt(0)
 s_barrier
 ds_read_b128 v[224:227], v23 offset:0
 ds_read_b128 v[228:231], v23 offset:64
 ds_read_b128 v[232:235], v23 offset:128
 ds_read_b128 v[236:239], v23 offset:192
 ds_read_b128 v[240:243], v23 offset:256
 ds_read_b128 v[244:247], v23 offset:320
 s_waitcnt lgkmcnt(0)
 s_add_u32 s21, s48, 0
 buffer_store_dwordx4 v[224:227], v26, s[16:19], s21 offen offset:0 sc1
 buffer_store_dwordx4 v[228:231], v26, s[16:19], s21 offen offset:1024 sc1
 buffer_store_dwordx4 v[232:235], v26, s[16:19], s21 offen offset:2048 sc1
 buffer_store_dwordx4 v[236:239], v26, s[16:19], s21 offen offset:3072 sc1
 s_add_u32 s21, s48, 4096
 buffer_store_dwordx4 v[240:243], v26, s[16:19], s21 offen offset:0 sc1
 buffer_store_dwordx4 v[244:247], v26, s[16:19], s21 offen offset:1024 sc1
 s_nop 1
 s_cmp_gt_u32 s26, 0
 s_cbranch_scc1 kvm_blk_124
 s_waitcnt vmcnt(6)
 s_barrier
 s_mov_b32 s24, 327680
 s_mov_b32 s25, 163840
 v_lshrrev_b32 v11, 3, v1
 v_and_b32 v12, 7, v1
 v_xor_b32 v12, v12, v11
 v_mul_u32_u24 v11, 1280, v11
 v_lshl_add_u32 v10, v12, 4, v11
 s_mul_i32 s46, s20, 40960
 v_add_u32 v10, s46, v10
 s_lshl_b32 s47, s20, 12
 s_add_u32 s47, s47, 0
 s_add_u32 s46, s47, 98304
 s_mov_b32 s30, s24
 s_add_u32 s32, s47, 32768
 v_add_u32 v11, 9216, v10
 v_add_u32 v12, 18432, v10
 v_add_u32 v13, 27648, v10
 s_mov_b32 m0, s32
 s_nop 0
 buffer_load_dwordx4 v10, s[8:11], s30 offen offset:0 lds
 buffer_load_dwordx4 v11, s[8:11], s30 offen offset:1024 lds
 buffer_load_dwordx4 v12, s[8:11], s30 offen offset:2048 lds
 buffer_load_dwordx4 v13, s[8:11], s30 offen offset:3072 lds
 s_add_u32 s30, s30, 128
 s_add_u32 s32, s32, 16384
 s_cmp_lt_u32 s32, s46
 s_cselect_b32 s32, s32, s47
 s_mov_b32 m0, s32
 s_nop 0
 buffer_load_dwordx4 v10, s[8:11], s30 offen offset:0 lds
 buffer_load_dwordx4 v11, s[8:11], s30 offen offset:1024 lds
 buffer_load_dwordx4 v12, s[8:11], s30 offen offset:2048 lds
 buffer_load_dwordx4 v13, s[8:11], s30 offen offset:3072 lds
 s_add_u32 s30, s30, 128
 s_add_u32 s32, s32, 16384
 s_cmp_lt_u32 s32, s46
 s_cselect_b32 s32, s32, s47
 s_mov_b32 m0, s32
 s_nop 0
 buffer_load_dwordx4 v10, s[8:11], s30 offen offset:0 lds
 buffer_load_dwordx4 v11, s[8:11], s30 offen offset:1024 lds
 buffer_load_dwordx4 v12, s[8:11], s30 offen offset:2048 lds
 buffer_load_dwordx4 v13, s[8:11], s30 offen offset:3072 lds
 s_add_u32 s30, s30, 128
 s_add_u32 s32, s32, 16384
 s_cmp_lt_u32 s32, s46
 s_cselect_b32 s32, s32, s47
 s_mov_b32 m0, s32
 s_nop 0
 buffer_load_dwordx4 v10, s[8:11], s30 offen offset:0 lds
 buffer_load_dwordx4 v11, s[8:11], s30 offen offset:1024 lds
 buffer_load_dwordx4 v12, s[8:11], s30 offen offset:2048 lds
 buffer_load_dwordx4 v13, s[8:11], s30 offen offset:3072 lds
 s_add_u32 s30, s30, 128
 s_add_u32 s32, s32, 16384
 s_cmp_lt_u32 s32, s46
 s_cselect_b32 s32, s32, s47
 s_waitcnt vmcnt(16)
 s_barrier
 s_cmp_lg_u32 s20, 0
 s_cbranch_scc1 af_129
 v_mov_b32 v4, 0
 v_mov_b32 v5, 1
 s_mov_b64 exec, 1
 buffer_atomic_add v5, v4, s[72:75], s61 offen sc1
 s_mov_b64 exec, -1
 s_nop 1
af_129:
 s_mov_b32 s26, 14
 s_mov_b32 s28, 1572864
kv_main:
 v_and_b32 v6, 7, v2
 v_add_u32 v4, 0, v3
 v_xor_b32 v4, v4, v6
 v_lshlrev_b32 v4, 4, v4
 v_lshl_add_u32 v14, v2, 7, v4
 v_add_u32 v4, 4, v3
 v_xor_b32 v4, v4, v6
 v_lshlrev_b32 v4, 4, v4
 v_lshl_add_u32 v15, v2, 7, v4
 v_mul_u32_u24 v22, 400, v2
 v_mul_u32_u24 v4, 16, v3
 s_mul_i32 s21, s20, 96
 s_add_u32 s21, s21, 98304
 v_add3_u32 v22, v22, v4, s21
 v_lshlrev_b32 v4, 3, v3
 v_sub_u32 v16, v22, v4
 v_mov_b32 v9, 2731
 s_mul_i32 s21, s20, 12800
 s_add_u32 s21, s21, 98304
 v_mul_u32_u24 v4, 400, v2
 v_lshlrev_b32 v5, 4, v3
 v_add3_u32 v23, v4, v5, s21
 v_lshlrev_b32 v26, 4, v1
 s_mov_b32 s33, 32768
 s_mov_b32 s48, 0x80000000
 s_mov_b32 m0, s32
 s_nop 0
 buffer_load_dwordx4 v10, s[8:11], s30 offen offset:0 lds
 buffer_load_dwordx4 v11, s[8:11], s30 offen offset:1024 lds
 s_waitcnt vmcnt(14)
 s_barrier
 v_add_u32 v18, s33, v14
 v_add_u32 v19, s33, v15
 s_add_u32 s33, s33, 16384
 s_cmp_lt_u32 s33, 98304
 s_cselect_b32 s33, s33, 0
 ds_read_b128 v[160:163], v18 offset:0
 ds_read_b128 v[164:167], v18 offset:2048
 ds_read_b128 v[168:171], v18 offset:4096
 ds_read_b128 v[172:175], v18 offset:6144
 ds_read_b128 v[176:179], v18 offset:8192
 ds_read_b128 v[180:183], v18 offset:10240
 ds_read_b128 v[184:187], v18 offset:12288
 ds_read_b128 v[188:191], v18 offset:14336
 s_waitcnt lgkmcnt(0)
kv_blk_132:
 v_mfma_f32_16x16x32_bf16 v[64:67], a[0:3], v[160:163], 0
 ds_read_b128 v[192:195], v19 offset:0
 v_mfma_f32_16x16x32_bf16 v[68:71], a[4:7], v[160:163], 0
 v_add_u32 v18, s33, v14
 v_mfma_f32_16x16x32_bf16 v[72:75], a[8:11], v[160:163], 0
 ds_write_b64 v16, v[234:235] offset:6464
 v_mfma_f32_16x16x32_bf16 v[76:79], a[0:3], v[164:167], 0
 ds_read_b128 v[196:199], v19 offset:2048
 v_cvt_pk_bf16_f32 v236, v88, v89
 v_mfma_f32_16x16x32_bf16 v[80:83], a[4:7], v[164:167], 0
 buffer_load_dwordx4 v12, s[8:11], s30 offen offset:2048 lds
 v_mfma_f32_16x16x32_bf16 v[84:87], a[8:11], v[164:167], 0
 v_cvt_pk_bf16_f32 v237, v90, v91
 v_cvt_pk_bf16_f32 v238, v92, v93
 v_mfma_f32_16x16x32_bf16 v[88:91], a[0:3], v[168:171], 0
 ds_read_b128 v[200:203], v19 offset:4096
 v_cvt_pk_bf16_f32 v239, v94, v95
 v_mfma_f32_16x16x32_bf16 v[92:95], a[4:7], v[168:171], 0
 v_cvt_pk_bf16_f32 v240, v96, v97
 v_cvt_pk_bf16_f32 v241, v98, v99
 v_mfma_f32_16x16x32_bf16 v[96:99], a[8:11], v[168:171], 0
 ds_write_b64 v22, v[236:237] offset:12800
 ds_write_b64 v22, v[238:239] offset:12808
 ds_write_b64 v16, v[240:241] offset:12864
 v_cvt_pk_bf16_f32 v242, v100, v101
 v_cvt_pk_bf16_f32 v243, v102, v103
 v_mfma_f32_16x16x32_bf16 v[100:103], a[0:3], v[172:175], 0
 ds_read_b128 v[204:207], v19 offset:6144
 v_cvt_pk_bf16_f32 v244, v104, v105
 v_cvt_pk_bf16_f32 v245, v106, v107
 v_mfma_f32_16x16x32_bf16 v[104:107], a[4:7], v[172:175], 0
 v_cvt_pk_bf16_f32 v246, v108, v109
 v_cvt_pk_bf16_f32 v247, v110, v111
 v_mfma_f32_16x16x32_bf16 v[108:111], a[8:11], v[172:175], 0
 s_waitcnt lgkmcnt(9)
 ds_write_b64 v22, v[242:243] offset:19200
 ds_write_b64 v22, v[244:245] offset:19208
 ds_write_b64 v16, v[246:247] offset:19264
 v_cvt_pk_bf16_f32 v224, v112, v113
 v_cvt_pk_bf16_f32 v225, v114, v115
 v_mfma_f32_16x16x32_bf16 v[112:115], a[0:3], v[176:179], 0
 ds_read_b128 v[208:211], v19 offset:8192
 v_cvt_pk_bf16_f32 v226, v116, v117
 v_cvt_pk_bf16_f32 v227, v118, v119
 v_mfma_f32_16x16x32_bf16 v[116:119], a[4:7], v[176:179], 0
 v_cvt_pk_bf16_f32 v228, v120, v121
 v_cvt_pk_bf16_f32 v229, v122, v123
 v_mfma_f32_16x16x32_bf16 v[120:123], a[8:11], v[176:179], 0
 ds_write_b64 v22, v[224:225] offset:25600
 ds_write_b64 v22, v[226:227] offset:25608
 ds_write_b64 v16, v[228:229] offset:25664
 v_cvt_pk_bf16_f32 v230, v124, v125
 v_cvt_pk_bf16_f32 v231, v126, v127
 v_mfma_f32_16x16x32_bf16 v[124:127], a[0:3], v[180:183], 0
 ds_read_b128 v[212:215], v19 offset:10240
 v_cvt_pk_bf16_f32 v232, v128, v129
 v_cvt_pk_bf16_f32 v233, v130, v131
 v_mfma_f32_16x16x32_bf16 v[128:131], a[4:7], v[180:183], 0
 buffer_load_dwordx4 v13, s[8:11], s30 offen offset:3072 lds
 v_cvt_pk_bf16_f32 v234, v132, v133
 v_cvt_pk_bf16_f32 v235, v134, v135
 v_mfma_f32_16x16x32_bf16 v[132:135], a[8:11], v[180:183], 0
 s_add_u32 s30, s30, 128
 s_add_u32 m0, m0, 16384
 ds_write_b64 v22, v[230:231] offset:32000
 ds_write_b64 v22, v[232:233] offset:32008
 ds_write_b64 v16, v[234:235] offset:32064
 v_cvt_pk_bf16_f32 v236, v136, v137
 v_cvt_pk_bf16_f32 v237, v138, v139
 v_mfma_f32_16x16x32_bf16 v[136:139], a[0:3], v[184:187], 0
 ds_read_b128 v[216:219], v19 offset:12288
 v_cvt_pk_bf16_f32 v238, v140, v141
 v_cvt_pk_bf16_f32 v239, v142, v143
 v_mfma_f32_16x16x32_bf16 v[140:143], a[4:7], v[184:187], 0
 s_cmp_lt_u32 m0, s46
 s_cselect_b32 m0, m0, s47
 v_cvt_pk_bf16_f32 v240, v144, v145
 v_cvt_pk_bf16_f32 v241, v146, v147
 v_mfma_f32_16x16x32_bf16 v[144:147], a[8:11], v[184:187], 0
 ds_write_b64 v22, v[236:237] offset:38400
 ds_write_b64 v22, v[238:239] offset:38408
 ds_write_b64 v16, v[240:241] offset:38464
 v_cvt_pk_bf16_f32 v242, v148, v149
 v_cvt_pk_bf16_f32 v243, v150, v151
 v_mfma_f32_16x16x32_bf16 v[148:151], a[0:3], v[188:191], 0
 ds_read_b128 v[220:223], v19 offset:14336
 v_cvt_pk_bf16_f32 v244, v152, v153
 v_cvt_pk_bf16_f32 v245, v154, v155
 v_mfma_f32_16x16x32_bf16 v[152:155], a[4:7], v[188:191], 0
 v_cvt_pk_bf16_f32 v246, v156, v157
 v_cvt_pk_bf16_f32 v247, v158, v159
 v_mfma_f32_16x16x32_bf16 v[156:159], a[8:11], v[188:191], 0
 s_waitcnt vmcnt(12) lgkmcnt(15)
 s_barrier
 v_mfma_f32_16x16x32_bf16 v[64:67], a[12:15], v[192:195], v[64:67]
 ds_read_b128 v[160:163], v18 offset:0
 v_mfma_f32_16x16x32_bf16 v[68:71], a[16:19], v[192:195], v[68:71]
 ds_write_b64 v22, v[242:243] offset:44800
 v_mfma_f32_16x16x32_bf16 v[72:75], a[20:23], v[192:195], v[72:75]
 v_add_u32 v19, s33, v15
 s_add_u32 s33, s33, 16384
 v_mfma_f32_16x16x32_bf16 v[76:79], a[12:15], v[196:199], v[76:79]
 ds_read_b128 v[164:167], v18 offset:2048
 v_mfma_f32_16x16x32_bf16 v[80:83], a[16:19], v[196:199], v[80:83]
 buffer_load_dwordx4 v10, s[8:11], s30 offen offset:0 lds
 v_mfma_f32_16x16x32_bf16 v[84:87], a[20:23], v[196:199], v[84:87]
 s_cmp_lt_u32 s33, 98304
 s_cselect_b32 s33, s33, 0
 v_mfma_f32_16x16x32_bf16 v[88:91], a[12:15], v[200:203], v[88:91]
 ds_read_b128 v[168:171], v18 offset:4096
 v_mfma_f32_16x16x32_bf16 v[92:95], a[16:19], v[200:203], v[92:95]
 ds_write_b64 v22, v[244:245] offset:44808
 v_mfma_f32_16x16x32_bf16 v[96:99], a[20:23], v[200:203], v[96:99]
 ds_write_b64 v16, v[246:247] offset:44864
 v_mfma_f32_16x16x32_bf16 v[100:103], a[12:15], v[204:207], v[100:103]
 ds_read_b128 v[172:175], v18 offset:6144
 v_mfma_f32_16x16x32_bf16 v[104:107], a[16:19], v[204:207], v[104:107]
 v_mfma_f32_16x16x32_bf16 v[108:111], a[20:23], v[204:207], v[108:111]
 s_waitcnt lgkmcnt(7)
 v_mfma_f32_16x16x32_bf16 v[112:115], a[12:15], v[208:211], v[112:115]
 ds_read_b128 v[176:179], v18 offset:8192
 v_mfma_f32_16x16x32_bf16 v[116:119], a[16:19], v[208:211], v[116:119]
 v_mfma_f32_16x16x32_bf16 v[120:123], a[20:23], v[208:211], v[120:123]
 v_mfma_f32_16x16x32_bf16 v[124:127], a[12:15], v[212:215], v[124:127]
 ds_read_b128 v[180:183], v18 offset:10240
 v_mfma_f32_16x16x32_bf16 v[128:131], a[16:19], v[212:215], v[128:131]
 buffer_load_dwordx4 v11, s[8:11], s30 offen offset:1024 lds
 v_mfma_f32_16x16x32_bf16 v[132:135], a[20:23], v[212:215], v[132:135]
 v_mfma_f32_16x16x32_bf16 v[136:139], a[12:15], v[216:219], v[136:139]
 ds_read_b128 v[184:187], v18 offset:12288
 v_mfma_f32_16x16x32_bf16 v[140:143], a[16:19], v[216:219], v[140:143]
 v_mfma_f32_16x16x32_bf16 v[144:147], a[20:23], v[216:219], v[144:147]
 v_mfma_f32_16x16x32_bf16 v[148:151], a[12:15], v[220:223], v[148:151]
 ds_read_b128 v[188:191], v18 offset:14336
 v_mfma_f32_16x16x32_bf16 v[152:155], a[16:19], v[220:223], v[152:155]
 v_mfma_f32_16x16x32_bf16 v[156:159], a[20:23], v[220:223], v[156:159]
 s_waitcnt lgkmcnt(4)
 v_mfma_f32_16x16x32_bf16 v[64:67], a[24:27], v[160:163], v[64:67]
 ds_read_b128 v[192:195], v19 offset:0
 v_mfma_f32_16x16x32_bf16 v[68:71], a[28:31], v[160:163], v[68:71]
 v_add_u32 v18, s33, v14
 v_mfma_f32_16x16x32_bf16 v[72:75], a[32:35], v[160:163], v[72:75]
 v_mfma_f32_16x16x32_bf16 v[76:79], a[24:27], v[164:167], v[76:79]
 ds_read_b128 v[196:199], v19 offset:2048
 v_mfma_f32_16x16x32_bf16 v[80:83], a[28:31], v[164:167], v[80:83]
 buffer_load_dwordx4 v12, s[8:11], s30 offen offset:2048 lds
 v_mfma_f32_16x16x32_bf16 v[84:87], a[32:35], v[164:167], v[84:87]
 v_mfma_f32_16x16x32_bf16 v[88:91], a[24:27], v[168:171], v[88:91]
 ds_read_b128 v[200:203], v19 offset:4096
 v_mfma_f32_16x16x32_bf16 v[92:95], a[28:31], v[168:171], v[92:95]
 v_mfma_f32_16x16x32_bf16 v[96:99], a[32:35], v[168:171], v[96:99]
 v_mfma_f32_16x16x32_bf16 v[100:103], a[24:27], v[172:175], v[100:103]
 ds_read_b128 v[204:207], v19 offset:6144
 v_mfma_f32_16x16x32_bf16 v[104:107], a[28:31], v[172:175], v[104:107]
 v_mfma_f32_16x16x32_bf16 v[108:111], a[32:35], v[172:175], v[108:111]
 s_waitcnt lgkmcnt(4)
 v_mfma_f32_16x16x32_bf16 v[112:115], a[24:27], v[176:179], v[112:115]
 ds_read_b128 v[208:211], v19 offset:8192
 v_mfma_f32_16x16x32_bf16 v[116:119], a[28:31], v[176:179], v[116:119]
 v_mfma_f32_16x16x32_bf16 v[120:123], a[32:35], v[176:179], v[120:123]
 v_mfma_f32_16x16x32_bf16 v[124:127], a[24:27], v[180:183], v[124:127]
 ds_read_b128 v[212:215], v19 offset:10240
 v_mfma_f32_16x16x32_bf16 v[128:131], a[28:31], v[180:183], v[128:131]
 buffer_load_dwordx4 v13, s[8:11], s30 offen offset:3072 lds
 v_mfma_f32_16x16x32_bf16 v[132:135], a[32:35], v[180:183], v[132:135]
 s_add_u32 s30, s30, 128
 s_add_u32 m0, m0, 16384
 v_mfma_f32_16x16x32_bf16 v[136:139], a[24:27], v[184:187], v[136:139]
 ds_read_b128 v[216:219], v19 offset:12288
 v_mfma_f32_16x16x32_bf16 v[140:143], a[28:31], v[184:187], v[140:143]
 s_cmp_lt_u32 m0, s46
 s_cselect_b32 m0, m0, s47
 v_mfma_f32_16x16x32_bf16 v[144:147], a[32:35], v[184:187], v[144:147]
 v_mfma_f32_16x16x32_bf16 v[148:151], a[24:27], v[188:191], v[148:151]
 ds_read_b128 v[220:223], v19 offset:14336
 v_mfma_f32_16x16x32_bf16 v[152:155], a[28:31], v[188:191], v[152:155]
 v_mfma_f32_16x16x32_bf16 v[156:159], a[32:35], v[188:191], v[156:159]
 s_waitcnt vmcnt(12) lgkmcnt(4)
 s_barrier
 v_mfma_f32_16x16x32_bf16 v[64:67], a[36:39], v[192:195], v[64:67]
 ds_read_b128 v[160:163], v18 offset:0
 v_mfma_f32_16x16x32_bf16 v[68:71], a[40:43], v[192:195], v[68:71]
 v_mfma_f32_16x16x32_bf16 v[72:75], a[44:47], v[192:195], v[72:75]
 v_add_u32 v19, s33, v15
 s_add_u32 s33, s33, 16384
 v_mfma_f32_16x16x32_bf16 v[76:79], a[36:39], v[196:199], v[76:79]
 ds_read_b128 v[164:167], v18 offset:2048
 v_mfma_f32_16x16x32_bf16 v[80:83], a[40:43], v[196:199], v[80:83]
 buffer_load_dwordx4 v10, s[8:11], s30 offen offset:0 lds
 v_mfma_f32_16x16x32_bf16 v[84:87], a[44:47], v[196:199], v[84:87]
 s_cmp_lt_u32 s33, 98304
 s_cselect_b32 s33, s33, 0
 v_mfma_f32_16x16x32_bf16 v[88:91], a[36:39], v[200:203], v[88:91]
 ds_read_b128 v[168:171], v18 offset:4096
 v_mfma_f32_16x16x32_bf16 v[92:95], a[40:43], v[200:203], v[92:95]
 ds_read_b128 v[224:227], v23 offset:0
 v_mfma_f32_16x16x32_bf16 v[96:99], a[44:47], v[200:203], v[96:99]
 v_mfma_f32_16x16x32_bf16 v[100:103], a[36:39], v[204:207], v[100:103]
 ds_read_b128 v[172:175], v18 offset:6144
 v_mfma_f32_16x16x32_bf16 v[104:107], a[40:43], v[204:207], v[104:107]
 v_mfma_f32_16x16x32_bf16 v[108:111], a[44:47], v[204:207], v[108:111]
 s_waitcnt lgkmcnt(5)
 v_mfma_f32_16x16x32_bf16 v[112:115], a[36:39], v[208:211], v[112:115]
 ds_read_b128 v[176:179], v18 offset:8192
 v_mfma_f32_16x16x32_bf16 v[116:119], a[40:43], v[208:211], v[116:119]
 v_mfma_f32_16x16x32_bf16 v[120:123], a[44:47], v[208:211], v[120:123]
 v_mfma_f32_16x16x32_bf16 v[124:127], a[36:39], v[212:215], v[124:127]
 ds_read_b128 v[180:183], v18 offset:10240
 v_mfma_f32_16x16x32_bf16 v[128:131], a[40:43], v[212:215], v[128:131]
 buffer_load_dwordx4 v11, s[8:11], s30 offen offset:1024 lds
 v_mfma_f32_16x16x32_bf16 v[132:135], a[44:47], v[212:215], v[132:135]
 v_mfma_f32_16x16x32_bf16 v[136:139], a[36:39], v[216:219], v[136:139]
 ds_read_b128 v[184:187], v18 offset:12288
 v_mfma_f32_16x16x32_bf16 v[140:143], a[40:43], v[216:219], v[140:143]
 ds_read_b128 v[228:231], v23 offset:64
 v_mfma_f32_16x16x32_bf16 v[144:147], a[44:47], v[216:219], v[144:147]
 v_mfma_f32_16x16x32_bf16 v[148:151], a[36:39], v[220:223], v[148:151]
 ds_read_b128 v[188:191], v18 offset:14336
 v_mfma_f32_16x16x32_bf16 v[152:155], a[40:43], v[220:223], v[152:155]
 v_mfma_f32_16x16x32_bf16 v[156:159], a[44:47], v[220:223], v[156:159]
 s_waitcnt lgkmcnt(5)
 v_mfma_f32_16x16x32_bf16 v[64:67], a[48:51], v[160:163], v[64:67]
 ds_read_b128 v[192:195], v19 offset:0
 v_mfma_f32_16x16x32_bf16 v[68:71], a[52:55], v[160:163], v[68:71]
 v_add_u32 v18, s33, v14
 v_mfma_f32_16x16x32_bf16 v[72:75], a[56:59], v[160:163], v[72:75]
 v_mfma_f32_16x16x32_bf16 v[76:79], a[48:51], v[164:167], v[76:79]
 ds_read_b128 v[196:199], v19 offset:2048
 v_mfma_f32_16x16x32_bf16 v[80:83], a[52:55], v[164:167], v[80:83]
 buffer_load_dwordx4 v12, s[8:11], s30 offen offset:2048 lds
 v_mfma_f32_16x16x32_bf16 v[84:87], a[56:59], v[164:167], v[84:87]
 v_mfma_f32_16x16x32_bf16 v[88:91], a[48:51], v[168:171], v[88:91]
 ds_read_b128 v[200:203], v19 offset:4096
 v_mfma_f32_16x16x32_bf16 v[92:95], a[52:55], v[168:171], v[92:95]
 s_add_u32 s21, s48, 0
 ds_read_b128 v[232:235], v23 offset:128
 v_mfma_f32_16x16x32_bf16 v[96:99], a[56:59], v[168:171], v[96:99]
 v_mfma_f32_16x16x32_bf16 v[100:103], a[48:51], v[172:175], v[100:103]
 ds_read_b128 v[204:207], v19 offset:6144
 v_mfma_f32_16x16x32_bf16 v[104:107], a[52:55], v[172:175], v[104:107]
 buffer_store_dwordx4 v[224:227], v26, s[16:19], s21 offen offset:0 sc1
 v_mfma_f32_16x16x32_bf16 v[108:111], a[56:59], v[172:175], v[108:111]
 s_waitcnt lgkmcnt(5)
 v_mfma_f32_16x16x32_bf16 v[112:115], a[48:51], v[176:179], v[112:115]
 ds_read_b128 v[208:211], v19 offset:8192
 v_mfma_f32_16x16x32_bf16 v[116:119], a[52:55], v[176:179], v[116:119]
 v_mfma_f32_16x16x32_bf16 v[120:123], a[56:59], v[176:179], v[120:123]
 v_mfma_f32_16x16x32_bf16 v[124:127], a[48:51], v[180:183], v[124:127]
 ds_read_b128 v[212:215], v19 offset:10240
 v_mfma_f32_16x16x32_bf16 v[128:131], a[52:55], v[180:183], v[128:131]
 buffer_load_dwordx4 v13, s[8:11], s30 offen offset:3072 lds
 v_mfma_f32_16x16x32_bf16 v[132:135], a[56:59], v[180:183], v[132:135]
 s_add_u32 s30, s30, 128
 s_add_u32 m0, m0, 16384
 v_mfma_f32_16x16x32_bf16 v[136:139], a[48:51], v[184:187], v[136:139]
 ds_read_b128 v[216:219], v19 offset:12288
 v_mfma_f32_16x16x32_bf16 v[140:143], a[52:55], v[184:187], v[140:143]
 s_cmp_lt_u32 m0, s46
 s_cselect_b32 m0, m0, s47
 v_mfma_f32_16x16x32_bf16 v[144:147], a[56:59], v[184:187], v[144:147]
 ds_read_b128 v[236:239], v23 offset:192
 v_mfma_f32_16x16x32_bf16 v[148:151], a[48:51], v[188:191], v[148:151]
 ds_read_b128 v[220:223], v19 offset:14336
 v_mfma_f32_16x16x32_bf16 v[152:155], a[52:55], v[188:191], v[152:155]
 buffer_store_dwordx4 v[228:231], v26, s[16:19], s21 offen offset:1024 sc1
 v_mfma_f32_16x16x32_bf16 v[156:159], a[56:59], v[188:191], v[156:159]
 s_waitcnt vmcnt(14) lgkmcnt(5)
 s_barrier
 v_mfma_f32_16x16x32_bf16 v[64:67], a[60:63], v[192:195], v[64:67]
 ds_read_b128 v[160:163], v18 offset:0
 v_mfma_f32_16x16x32_bf16 v[68:71], a[64:67], v[192:195], v[68:71]
 v_mfma_f32_16x16x32_bf16 v[72:75], a[68:71], v[192:195], v[72:75]
 v_add_u32 v19, s33, v15
 s_add_u32 s33, s33, 16384
 v_mfma_f32_16x16x32_bf16 v[76:79], a[60:63], v[196:199], v[76:79]
 ds_read_b128 v[164:167], v18 offset:2048
 v_mfma_f32_16x16x32_bf16 v[80:83], a[64:67], v[196:199], v[80:83]
 buffer_load_dwordx4 v10, s[8:11], s30 offen offset:0 lds
 v_mfma_f32_16x16x32_bf16 v[84:87], a[68:71], v[196:199], v[84:87]
 s_cmp_lt_u32 s33, 98304
 s_cselect_b32 s33, s33, 0
 v_mfma_f32_16x16x32_bf16 v[88:91], a[60:63], v[200:203], v[88:91]
 ds_read_b128 v[168:171], v18 offset:4096
 v_mfma_f32_16x16x32_bf16 v[92:95], a[64:67], v[200:203], v[92:95]
 ds_read_b128 v[240:243], v23 offset:256
 v_mfma_f32_16x16x32_bf16 v[96:99], a[68:71], v[200:203], v[96:99]
 v_mfma_f32_16x16x32_bf16 v[100:103], a[60:63], v[204:207], v[100:103]
 ds_read_b128 v[172:175], v18 offset:6144
 v_mfma_f32_16x16x32_bf16 v[104:107], a[64:67], v[204:207], v[104:107]
 buffer_store_dwordx4 v[232:235], v26, s[16:19], s21 offen offset:2048 sc1
 v_mfma_f32_16x16x32_bf16 v[108:111], a[68:71], v[204:207], v[108:111]
 s_waitcnt lgkmcnt(5)
 v_mfma_f32_16x16x32_bf16 v[112:115], a[60:63], v[208:211], v[112:115]
 ds_read_b128 v[176:179], v18 offset:8192
 v_mfma_f32_16x16x32_bf16 v[116:119], a[64:67], v[208:211], v[116:119]
 v_mfma_f32_16x16x32_bf16 v[120:123], a[68:71], v[208:211], v[120:123]
 v_mfma_f32_16x16x32_bf16 v[124:127], a[60:63], v[212:215], v[124:127]
 ds_read_b128 v[180:183], v18 offset:10240
 v_mfma_f32_16x16x32_bf16 v[128:131], a[64:67], v[212:215], v[128:131]
 buffer_load_dwordx4 v11, s[8:11], s30 offen offset:1024 lds
 v_mfma_f32_16x16x32_bf16 v[132:135], a[68:71], v[212:215], v[132:135]
 v_mfma_f32_16x16x32_bf16 v[136:139], a[60:63], v[216:219], v[136:139]
 ds_read_b128 v[184:187], v18 offset:12288
 v_mfma_f32_16x16x32_bf16 v[140:143], a[64:67], v[216:219], v[140:143]
 ds_read_b128 v[244:247], v23 offset:320
 v_mfma_f32_16x16x32_bf16 v[144:147], a[68:71], v[216:219], v[144:147]
 v_mfma_f32_16x16x32_bf16 v[148:151], a[60:63], v[220:223], v[148:151]
 ds_read_b128 v[188:191], v18 offset:14336
 v_mfma_f32_16x16x32_bf16 v[152:155], a[64:67], v[220:223], v[152:155]
 buffer_store_dwordx4 v[236:239], v26, s[16:19], s21 offen offset:3072 sc1
 v_mfma_f32_16x16x32_bf16 v[156:159], a[68:71], v[220:223], v[156:159]
 s_waitcnt lgkmcnt(5)
 v_mfma_f32_16x16x32_bf16 v[64:67], a[72:75], v[160:163], v[64:67]
 ds_read_b128 v[192:195], v19 offset:0
 v_mfma_f32_16x16x32_bf16 v[68:71], a[76:79], v[160:163], v[68:71]
 v_add_u32 v18, s33, v14
 v_mfma_f32_16x16x32_bf16 v[72:75], a[80:83], v[160:163], v[72:75]
 v_mfma_f32_16x16x32_bf16 v[76:79], a[72:75], v[164:167], v[76:79]
 ds_read_b128 v[196:199], v19 offset:2048
 v_mfma_f32_16x16x32_bf16 v[80:83], a[76:79], v[164:167], v[80:83]
 buffer_load_dwordx4 v12, s[8:11], s30 offen offset:2048 lds
 v_mfma_f32_16x16x32_bf16 v[84:87], a[80:83], v[164:167], v[84:87]
 v_mfma_f32_16x16x32_bf16 v[88:91], a[72:75], v[168:171], v[88:91]
 ds_read_b128 v[200:203], v19 offset:4096
 v_mfma_f32_16x16x32_bf16 v[92:95], a[76:79], v[168:171], v[92:95]
 s_add_u32 s21, s48, 4096
 ds_read_b128 v[224:227], v23 offset:6400
 v_mfma_f32_16x16x32_bf16 v[96:99], a[80:83], v[168:171], v[96:99]
 v_mfma_f32_16x16x32_bf16 v[100:103], a[72:75], v[172:175], v[100:103]
 ds_read_b128 v[204:207], v19 offset:6144
 v_mfma_f32_16x16x32_bf16 v[104:107], a[76:79], v[172:175], v[104:107]
 buffer_store_dwordx4 v[240:243], v26, s[16:19], s21 offen offset:0 sc1
 v_mfma_f32_16x16x32_bf16 v[108:111], a[80:83], v[172:175], v[108:111]
 s_waitcnt lgkmcnt(5)
 v_mfma_f32_16x16x32_bf16 v[112:115], a[72:75], v[176:179], v[112:115]
 ds_read_b128 v[208:211], v19 offset:8192
 v_mfma_f32_16x16x32_bf16 v[116:119], a[76:79], v[176:179], v[116:119]
 v_mfma_f32_16x16x32_bf16 v[120:123], a[80:83], v[176:179], v[120:123]
 v_mfma_f32_16x16x32_bf16 v[124:127], a[72:75], v[180:183], v[124:127]
 ds_read_b128 v[212:215], v19 offset:10240
 v_mfma_f32_16x16x32_bf16 v[128:131], a[76:79], v[180:183], v[128:131]
 buffer_load_dwordx4 v13, s[8:11], s30 offen offset:3072 lds
 v_mfma_f32_16x16x32_bf16 v[132:135], a[80:83], v[180:183], v[132:135]
 s_add_u32 s30, s30, 128
 s_add_u32 m0, m0, 16384
 v_mfma_f32_16x16x32_bf16 v[136:139], a[72:75], v[184:187], v[136:139]
 ds_read_b128 v[216:219], v19 offset:12288
 v_mfma_f32_16x16x32_bf16 v[140:143], a[76:79], v[184:187], v[140:143]
 s_cmp_lt_u32 m0, s46
 s_cselect_b32 m0, m0, s47
 v_mfma_f32_16x16x32_bf16 v[144:147], a[80:83], v[184:187], v[144:147]
 ds_read_b128 v[228:231], v23 offset:6464
 v_mfma_f32_16x16x32_bf16 v[148:151], a[72:75], v[188:191], v[148:151]
 ds_read_b128 v[220:223], v19 offset:14336
 v_mfma_f32_16x16x32_bf16 v[152:155], a[76:79], v[188:191], v[152:155]
 buffer_store_dwordx4 v[244:247], v26, s[16:19], s21 offen offset:1024 sc1
 v_mfma_f32_16x16x32_bf16 v[156:159], a[80:83], v[188:191], v[156:159]
 s_waitcnt vmcnt(18) lgkmcnt(5)
 s_barrier
 v_mfma_f32_16x16x32_bf16 v[64:67], a[84:87], v[192:195], v[64:67]
 ds_read_b128 v[160:163], v18 offset:0
 v_mfma_f32_16x16x32_bf16 v[68:71], a[88:91], v[192:195], v[68:71]
 v_mfma_f32_16x16x32_bf16 v[72:75], a[92:95], v[192:195], v[72:75]
 v_add_u32 v19, s33, v15
 s_add_u32 s33, s33, 16384
 v_mfma_f32_16x16x32_bf16 v[76:79], a[84:87], v[196:199], v[76:79]
 ds_read_b128 v[164:167], v18 offset:2048
 v_mfma_f32_16x16x32_bf16 v[80:83], a[88:91], v[196:199], v[80:83]
 buffer_load_dwordx4 v10, s[8:11], s30 offen offset:0 lds
 v_mfma_f32_16x16x32_bf16 v[84:87], a[92:95], v[196:199], v[84:87]
 s_cmp_lt_u32 s33, 98304
 s_cselect_b32 s33, s33, 0
 v_mfma_f32_16x16x32_bf16 v[88:91], a[84:87], v[200:203], v[88:91]
 ds_read_b128 v[168:171], v18 offset:4096
 v_mfma_f32_16x16x32_bf16 v[92:95], a[88:91], v[200:203], v[92:95]
 ds_read_b128 v[232:235], v23 offset:6528
 v_mfma_f32_16x16x32_bf16 v[96:99], a[92:95], v[200:203], v[96:99]
 v_mfma_f32_16x16x32_bf16 v[100:103], a[84:87], v[204:207], v[100:103]
 ds_read_b128 v[172:175], v18 offset:6144
 v_mfma_f32_16x16x32_bf16 v[104:107], a[88:91], v[204:207], v[104:107]
 buffer_store_dwordx4 v[224:227], v26, s[16:19], s21 offen offset:2048 sc1
 v_mfma_f32_16x16x32_bf16 v[108:111], a[92:95], v[204:207], v[108:111]
 s_waitcnt lgkmcnt(5)
 v_mfma_f32_16x16x32_bf16 v[112:115], a[84:87], v[208:211], v[112:115]
 ds_read_b128 v[176:179], v18 offset:8192
 v_mfma_f32_16x16x32_bf16 v[116:119], a[88:91], v[208:211], v[116:119]
 v_mfma_f32_16x16x32_bf16 v[120:123], a[92:95], v[208:211], v[120:123]
 v_mfma_f32_16x16x32_bf16 v[124:127], a[84:87], v[212:215], v[124:127]
 ds_read_b128 v[180:183], v18 offset:10240
 v_mfma_f32_16x16x32_bf16 v[128:131], a[88:91], v[212:215], v[128:131]
 buffer_load_dwordx4 v11, s[8:11], s30 offen offset:1024 lds
 v_mfma_f32_16x16x32_bf16 v[132:135], a[92:95], v[212:215], v[132:135]
 v_mfma_f32_16x16x32_bf16 v[136:139], a[84:87], v[216:219], v[136:139]
 ds_read_b128 v[184:187], v18 offset:12288
 v_mfma_f32_16x16x32_bf16 v[140:143], a[88:91], v[216:219], v[140:143]
 ds_read_b128 v[236:239], v23 offset:6592
 v_mfma_f32_16x16x32_bf16 v[144:147], a[92:95], v[216:219], v[144:147]
 v_mfma_f32_16x16x32_bf16 v[148:151], a[84:87], v[220:223], v[148:151]
 ds_read_b128 v[188:191], v18 offset:14336
 v_mfma_f32_16x16x32_bf16 v[152:155], a[88:91], v[220:223], v[152:155]
 buffer_store_dwordx4 v[228:231], v26, s[16:19], s21 offen offset:3072 sc1
 v_mfma_f32_16x16x32_bf16 v[156:159], a[92:95], v[220:223], v[156:159]
 s_waitcnt lgkmcnt(5)
 v_mfma_f32_16x16x32_bf16 v[64:67], a[96:99], v[160:163], v[64:67]
 ds_read_b128 v[192:195], v19 offset:0
 v_mfma_f32_16x16x32_bf16 v[68:71], a[100:103], v[160:163], v[68:71]
 v_add_u32 v18, s33, v14
 v_mfma_f32_16x16x32_bf16 v[72:75], a[104:107], v[160:163], v[72:75]
 v_mfma_f32_16x16x32_bf16 v[76:79], a[96:99], v[164:167], v[76:79]
 ds_read_b128 v[196:199], v19 offset:2048
 v_mfma_f32_16x16x32_bf16 v[80:83], a[100:103], v[164:167], v[80:83]
 buffer_load_dwordx4 v12, s[8:11], s30 offen offset:2048 lds
 v_mfma_f32_16x16x32_bf16 v[84:87], a[104:107], v[164:167], v[84:87]
 v_mfma_f32_16x16x32_bf16 v[88:91], a[96:99], v[168:171], v[88:91]
 ds_read_b128 v[200:203], v19 offset:4096
 v_mfma_f32_16x16x32_bf16 v[92:95], a[100:103], v[168:171], v[92:95]
 s_add_u32 s21, s48, 8192
 ds_read_b128 v[240:243], v23 offset:6656
 v_mfma_f32_16x16x32_bf16 v[96:99], a[104:107], v[168:171], v[96:99]
 v_mfma_f32_16x16x32_bf16 v[100:103], a[96:99], v[172:175], v[100:103]
 ds_read_b128 v[204:207], v19 offset:6144
 v_mfma_f32_16x16x32_bf16 v[104:107], a[100:103], v[172:175], v[104:107]
 buffer_store_dwordx4 v[232:235], v26, s[16:19], s21 offen offset:0 sc1
 v_mfma_f32_16x16x32_bf16 v[108:111], a[104:107], v[172:175], v[108:111]
 s_waitcnt lgkmcnt(5)
 v_mfma_f32_16x16x32_bf16 v[112:115], a[96:99], v[176:179], v[112:115]
 ds_read_b128 v[208:211], v19 offset:8192
 v_mfma_f32_16x16x32_bf16 v[116:119], a[100:103], v[176:179], v[116:119]
 v_mfma_f32_16x16x32_bf16 v[120:123], a[104:107], v[176:179], v[120:123]
 v_mfma_f32_16x16x32_bf16 v[124:127], a[96:99], v[180:183], v[124:127]
 ds_read_b128 v[212:215], v19 offset:10240
 v_mfma_f32_16x16x32_bf16 v[128:131], a[100:103], v[180:183], v[128:131]
 buffer_load_dwordx4 v13, s[8:11], s30 offen offset:3072 lds
 v_mfma_f32_16x16x32_bf16 v[132:135], a[104:107], v[180:183], v[132:135]
 s_add_u32 s30, s30, 128
 s_add_u32 m0, m0, 16384
 v_mfma_f32_16x16x32_bf16 v[136:139], a[96:99], v[184:187], v[136:139]
 ds_read_b128 v[216:219], v19 offset:12288
 v_mfma_f32_16x16x32_bf16 v[140:143], a[100:103], v[184:187], v[140:143]
 s_cmp_lt_u32 m0, s46
 s_cselect_b32 m0, m0, s47
 v_mfma_f32_16x16x32_bf16 v[144:147], a[104:107], v[184:187], v[144:147]
 ds_read_b128 v[244:247], v23 offset:6720
 v_mfma_f32_16x16x32_bf16 v[148:151], a[96:99], v[188:191], v[148:151]
 ds_read_b128 v[220:223], v19 offset:14336
 v_mfma_f32_16x16x32_bf16 v[152:155], a[100:103], v[188:191], v[152:155]
 buffer_store_dwordx4 v[236:239], v26, s[16:19], s21 offen offset:1024 sc1
 v_mfma_f32_16x16x32_bf16 v[156:159], a[104:107], v[188:191], v[156:159]
 s_waitcnt vmcnt(22) lgkmcnt(5)
 s_barrier
 v_mfma_f32_16x16x32_bf16 v[64:67], a[108:111], v[192:195], v[64:67]
 ds_read_b128 v[160:163], v18 offset:0
 v_mfma_f32_16x16x32_bf16 v[68:71], a[112:115], v[192:195], v[68:71]
 v_mfma_f32_16x16x32_bf16 v[72:75], a[116:119], v[192:195], v[72:75]
 v_add_u32 v19, s33, v15
 s_add_u32 s33, s33, 16384
 v_mfma_f32_16x16x32_bf16 v[76:79], a[108:111], v[196:199], v[76:79]
 ds_read_b128 v[164:167], v18 offset:2048
 v_mfma_f32_16x16x32_bf16 v[80:83], a[112:115], v[196:199], v[80:83]
 buffer_load_dwordx4 v10, s[8:11], s30 offen offset:0 lds
 v_mfma_f32_16x16x32_bf16 v[84:87], a[116:119], v[196:199], v[84:87]
 s_cmp_lt_u32 s33, 98304
 s_cselect_b32 s33, s33, 0
 v_mfma_f32_16x16x32_bf16 v[88:91], a[108:111], v[200:203], v[88:91]
 ds_read_b128 v[168:171], v18 offset:4096
 v_mfma_f32_16x16x32_bf16 v[92:95], a[112:115], v[200:203], v[92:95]
 v_mfma_f32_16x16x32_bf16 v[96:99], a[116:119], v[200:203], v[96:99]
 v_mfma_f32_16x16x32_bf16 v[100:103], a[108:111], v[204:207], v[100:103]
 ds_read_b128 v[172:175], v18 offset:6144
 v_mfma_f32_16x16x32_bf16 v[104:107], a[112:115], v[204:207], v[104:107]
 buffer_store_dwordx4 v[240:243], v26, s[16:19], s21 offen offset:2048 sc1
 v_mfma_f32_16x16x32_bf16 v[108:111], a[116:119], v[204:207], v[108:111]
 s_waitcnt lgkmcnt(4)
 v_mfma_f32_16x16x32_bf16 v[112:115], a[108:111], v[208:211], v[112:115]
 ds_read_b128 v[176:179], v18 offset:8192
 v_mfma_f32_16x16x32_bf16 v[116:119], a[112:115], v[208:211], v[116:119]
 v_mfma_f32_16x16x32_bf16 v[120:123], a[116:119], v[208:211], v[120:123]
 v_mfma_f32_16x16x32_bf16 v[124:127], a[108:111], v[212:215], v[124:127]
 ds_read_b128 v[180:183], v18 offset:10240
 v_mfma_f32_16x16x32_bf16 v[128:131], a[112:115], v[212:215], v[128:131]
 buffer_load_dwordx4 v11, s[8:11], s30 offen offset:1024 lds
 v_mfma_f32_16x16x32_bf16 v[132:135], a[116:119], v[212:215], v[132:135]
 v_mfma_f32_16x16x32_bf16 v[136:139], a[108:111], v[216:219], v[136:139]
 ds_read_b128 v[184:187], v18 offset:12288
 v_mfma_f32_16x16x32_bf16 v[140:143], a[112:115], v[216:219], v[140:143]
 v_mfma_f32_16x16x32_bf16 v[144:147], a[116:119], v[216:219], v[144:147]
 v_mfma_f32_16x16x32_bf16 v[148:151], a[108:111], v[220:223], v[148:151]
 ds_read_b128 v[188:191], v18 offset:14336
 v_mfma_f32_16x16x32_bf16 v[152:155], a[112:115], v[220:223], v[152:155]
 buffer_store_dwordx4 v[244:247], v26, s[16:19], s21 offen offset:3072 sc1
 v_mfma_f32_16x16x32_bf16 v[156:159], a[116:119], v[220:223], v[156:159]
 s_waitcnt lgkmcnt(4)
 v_mfma_f32_16x16x32_bf16 v[64:67], a[120:123], v[160:163], v[64:67]
 ds_read_b128 v[192:195], v19 offset:0
 v_mfma_f32_16x16x32_bf16 v[68:71], a[124:127], v[160:163], v[68:71]
 v_add_u32 v18, s33, v14
 v_mfma_f32_16x16x32_bf16 v[72:75], a[128:131], v[160:163], v[72:75]
 v_mfma_f32_16x16x32_bf16 v[76:79], a[120:123], v[164:167], v[76:79]
 ds_read_b128 v[196:199], v19 offset:2048
 v_mfma_f32_16x16x32_bf16 v[80:83], a[124:127], v[164:167], v[80:83]
 buffer_load_dwordx4 v12, s[8:11], s30 offen offset:2048 lds
 v_mfma_f32_16x16x32_bf16 v[84:87], a[128:131], v[164:167], v[84:87]
 v_mfma_f32_16x16x32_bf16 v[88:91], a[120:123], v[168:171], v[88:91]
 ds_read_b128 v[200:203], v19 offset:4096
 v_mfma_f32_16x16x32_bf16 v[92:95], a[124:127], v[168:171], v[92:95]
 v_mfma_f32_16x16x32_bf16 v[96:99], a[128:131], v[168:171], v[96:99]
 v_mfma_f32_16x16x32_bf16 v[100:103], a[120:123], v[172:175], v[100:103]
 ds_read_b128 v[204:207], v19 offset:6144
 v_mfma_f32_16x16x32_bf16 v[104:107], a[124:127], v[172:175], v[104:107]
 v_mfma_f32_16x16x32_bf16 v[108:111], a[128:131], v[172:175], v[108:111]
 s_waitcnt lgkmcnt(4)
 v_mfma_f32_16x16x32_bf16 v[112:115], a[120:123], v[176:179], v[112:115]
 ds_read_b128 v[208:211], v19 offset:8192
 v_mfma_f32_16x16x32_bf16 v[116:119], a[124:127], v[176:179], v[116:119]
 v_mfma_f32_16x16x32_bf16 v[120:123], a[128:131], v[176:179], v[120:123]
 v_mfma_f32_16x16x32_bf16 v[124:127], a[120:123], v[180:183], v[124:127]
 ds_read_b128 v[212:215], v19 offset:10240
 v_mfma_f32_16x16x32_bf16 v[128:131], a[124:127], v[180:183], v[128:131]
 buffer_load_dwordx4 v13, s[8:11], s30 offen offset:3072 lds
 v_mfma_f32_16x16x32_bf16 v[132:135], a[128:131], v[180:183], v[132:135]
 s_add_u32 s30, s30, s25
 s_sub_u32 s30, s30, 1152
 v_mfma_f32_16x16x32_bf16 v[136:139], a[120:123], v[184:187], v[136:139]
 ds_read_b128 v[216:219], v19 offset:12288
 s_add_u32 m0, m0, 16384
 v_mfma_f32_16x16x32_bf16 v[140:143], a[124:127], v[184:187], v[140:143]
 s_cmp_lt_u32 m0, s46
 s_cselect_b32 m0, m0, s47
 v_mfma_f32_16x16x32_bf16 v[144:147], a[128:131], v[184:187], v[144:147]
 v_mfma_f32_16x16x32_bf16 v[148:151], a[120:123], v[188:191], v[148:151]
 ds_read_b128 v[220:223], v19 offset:14336
 v_mfma_f32_16x16x32_bf16 v[152:155], a[124:127], v[188:191], v[152:155]
 v_mfma_f32_16x16x32_bf16 v[156:159], a[128:131], v[188:191], v[156:159]
 s_waitcnt vmcnt(23) lgkmcnt(4)
 s_barrier
 v_mfma_f32_16x16x32_bf16 v[64:67], a[132:135], v[192:195], v[64:67]
 ds_read_b128 v[160:163], v18 offset:0
 v_mfma_f32_16x16x32_bf16 v[68:71], a[136:139], v[192:195], v[68:71]
 v_mfma_f32_16x16x32_bf16 v[72:75], a[140:143], v[192:195], v[72:75]
 v_add_u32 v19, s33, v15
 s_add_u32 s33, s33, 16384
 v_mfma_f32_16x16x32_bf16 v[76:79], a[132:135], v[196:199], v[76:79]
 ds_read_b128 v[164:167], v18 offset:2048
 v_mfma_f32_16x16x32_bf16 v[80:83], a[136:139], v[196:199], v[80:83]
 buffer_load_dwordx4 v10, s[8:11], s30 offen offset:0 lds
 v_mfma_f32_16x16x32_bf16 v[84:87], a[140:143], v[196:199], v[84:87]
 s_cmp_lt_u32 s33, 98304
 s_cselect_b32 s33, s33, 0
 v_mfma_f32_16x16x32_bf16 v[88:91], a[132:135], v[200:203], v[88:91]
 ds_read_b128 v[168:171], v18 offset:4096
 v_mfma_f32_16x16x32_bf16 v[92:95], a[136:139], v[200:203], v[92:95]
 v_mfma_f32_16x16x32_bf16 v[96:99], a[140:143], v[200:203], v[96:99]
 v_mfma_f32_16x16x32_bf16 v[100:103], a[132:135], v[204:207], v[100:103]
 ds_read_b128 v[172:175], v18 offset:6144
 v_mfma_f32_16x16x32_bf16 v[104:107], a[136:139], v[204:207], v[104:107]
 v_mfma_f32_16x16x32_bf16 v[108:111], a[140:143], v[204:207], v[108:111]
 s_waitcnt lgkmcnt(4)
 v_mfma_f32_16x16x32_bf16 v[112:115], a[132:135], v[208:211], v[112:115]
 ds_read_b128 v[176:179], v18 offset:8192
 v_mfma_f32_16x16x32_bf16 v[116:119], a[136:139], v[208:211], v[116:119]
 v_mfma_f32_16x16x32_bf16 v[120:123], a[140:143], v[208:211], v[120:123]
 v_mfma_f32_16x16x32_bf16 v[124:127], a[132:135], v[212:215], v[124:127]
 ds_read_b128 v[180:183], v18 offset:10240
 v_mfma_f32_16x16x32_bf16 v[128:131], a[136:139], v[212:215], v[128:131]
 buffer_load_dwordx4 v11, s[8:11], s30 offen offset:1024 lds
 v_mfma_f32_16x16x32_bf16 v[132:135], a[140:143], v[212:215], v[132:135]
 v_mfma_f32_16x16x32_bf16 v[136:139], a[132:135], v[216:219], v[136:139]
 ds_read_b128 v[184:187], v18 offset:12288
 v_mfma_f32_16x16x32_bf16 v[140:143], a[136:139], v[216:219], v[140:143]
 v_mfma_f32_16x16x32_bf16 v[144:147], a[140:143], v[216:219], v[144:147]
 v_mfma_f32_16x16x32_bf16 v[148:151], a[132:135], v[220:223], v[148:151]
 ds_read_b128 v[188:191], v18 offset:14336
 v_mfma_f32_16x16x32_bf16 v[152:155], a[136:139], v[220:223], v[152:155]
 v_mfma_f32_16x16x32_bf16 v[156:159], a[140:143], v[220:223], v[156:159]
 s_waitcnt lgkmcnt(4)
 v_mfma_f32_16x16x32_bf16 v[64:67], a[144:147], v[160:163], v[64:67]
 ds_read_b128 v[192:195], v19 offset:0
 v_mfma_f32_16x16x32_bf16 v[68:71], a[148:151], v[160:163], v[68:71]
 v_add_u32 v18, s33, v14
 v_mfma_f32_16x16x32_bf16 v[72:75], a[152:155], v[160:163], v[72:75]
 v_mfma_f32_16x16x32_bf16 v[76:79], a[144:147], v[164:167], v[76:79]
 ds_read_b128 v[196:199], v19 offset:2048
 v_mfma_f32_16x16x32_bf16 v[80:83], a[148:151], v[164:167], v[80:83]
 buffer_load_dwordx4 v12, s[8:11], s30 offen offset:2048 lds
 v_mfma_f32_16x16x32_bf16 v[84:87], a[152:155], v[164:167], v[84:87]
 v_mfma_f32_16x16x32_bf16 v[88:91], a[144:147], v[168:171], v[88:91]
 ds_read_b128 v[200:203], v19 offset:4096
 v_mfma_f32_16x16x32_bf16 v[92:95], a[148:151], v[168:171], v[92:95]
 v_mfma_f32_16x16x32_bf16 v[96:99], a[152:155], v[168:171], v[96:99]
 v_mfma_f32_16x16x32_bf16 v[100:103], a[144:147], v[172:175], v[100:103]
 ds_read_b128 v[204:207], v19 offset:6144
 v_mfma_f32_16x16x32_bf16 v[104:107], a[148:151], v[172:175], v[104:107]
 v_mfma_f32_16x16x32_bf16 v[108:111], a[152:155], v[172:175], v[108:111]
 s_waitcnt lgkmcnt(4)
 v_mfma_f32_16x16x32_bf16 v[112:115], a[144:147], v[176:179], v[112:115]
 ds_read_b128 v[208:211], v19 offset:8192
 v_mfma_f32_16x16x32_bf16 v[116:119], a[148:151], v[176:179], v[116:119]
 v_mfma_f32_16x16x32_bf16 v[120:123], a[152:155], v[176:179], v[120:123]
 v_mfma_f32_16x16x32_bf16 v[124:127], a[144:147], v[180:183], v[124:127]
 ds_read_b128 v[212:215], v19 offset:10240
 v_mfma_f32_16x16x32_bf16 v[128:131], a[148:151], v[180:183], v[128:131]
 buffer_load_dwordx4 v13, s[8:11], s30 offen offset:3072 lds
 v_mfma_f32_16x16x32_bf16 v[132:135], a[152:155], v[180:183], v[132:135]
 s_add_u32 s30, s30, 128
 s_add_u32 m0, m0, 16384
 v_mfma_f32_16x16x32_bf16 v[136:139], a[144:147], v[184:187], v[136:139]
 ds_read_b128 v[216:219], v19 offset:12288
 v_mfma_f32_16x16x32_bf16 v[140:143], a[148:151], v[184:187], v[140:143]
 s_cmp_lt_u32 m0, s46
 s_cselect_b32 m0, m0, s47
 v_mfma_f32_16x16x32_bf16 v[144:147], a[152:155], v[184:187], v[144:147]
 v_mfma_f32_16x16x32_bf16 v[148:151], a[144:147], v[188:191], v[148:151]
 ds_read_b128 v[220:223], v19 offset:14336
 v_mfma_f32_16x16x32_bf16 v[152:155], a[148:151], v[188:191], v[152:155]
 v_mfma_f32_16x16x32_bf16 v[156:159], a[152:155], v[188:191], v[156:159]
 s_waitcnt vmcnt(6) lgkmcnt(4)
 s_barrier
 v_mfma_f32_16x16x32_bf16 v[64:67], a[156:159], v[192:195], v[64:67]
 ds_read_b128 v[160:163], v18 offset:0
 v_mfma_f32_16x16x32_bf16 v[68:71], a[160:163], v[192:195], v[68:71]
 s_cmp_eq_u32 s48, 0x80000000
 s_cbranch_scc1 kv_130
 s_cmp_lg_u32 s20, 0
 s_cbranch_scc1 af_131
 v_mov_b32 v4, 0
 v_mov_b32 v5, 1
 s_mov_b64 exec, 1
 buffer_atomic_add v5, v4, s[72:75], s61 offen sc1
 s_mov_b64 exec, -1
 s_nop 1
af_131:
kv_130:
 v_mfma_f32_16x16x32_bf16 v[72:75], a[164:167], v[192:195], v[72:75]
 v_add_u32 v19, s33, v15
 s_add_u32 s33, s33, 16384
 v_mfma_f32_16x16x32_bf16 v[76:79], a[156:159], v[196:199], v[76:79]
 ds_read_b128 v[164:167], v18 offset:2048
 v_mfma_f32_16x16x32_bf16 v[80:83], a[160:163], v[196:199], v[80:83]
 buffer_load_dwordx4 v10, s[8:11], s30 offen offset:0 lds
 v_mfma_f32_16x16x32_bf16 v[84:87], a[164:167], v[196:199], v[84:87]
 s_cmp_lt_u32 s33, 98304
 s_cselect_b32 s33, s33, 0
 v_mfma_f32_16x16x32_bf16 v[88:91], a[156:159], v[200:203], v[88:91]
 ds_read_b128 v[168:171], v18 offset:4096
 v_mfma_f32_16x16x32_bf16 v[92:95], a[160:163], v[200:203], v[92:95]
 v_mfma_f32_16x16x32_bf16 v[96:99], a[164:167], v[200:203], v[96:99]
 v_mfma_f32_16x16x32_bf16 v[100:103], a[156:159], v[204:207], v[100:103]
 ds_read_b128 v[172:175], v18 offset:6144
 v_mfma_f32_16x16x32_bf16 v[104:107], a[160:163], v[204:207], v[104:107]
 v_mfma_f32_16x16x32_bf16 v[108:111], a[164:167], v[204:207], v[108:111]
 s_waitcnt lgkmcnt(4)
 v_mfma_f32_16x16x32_bf16 v[112:115], a[156:159], v[208:211], v[112:115]
 ds_read_b128 v[176:179], v18 offset:8192
 v_mfma_f32_16x16x32_bf16 v[116:119], a[160:163], v[208:211], v[116:119]
 v_mfma_f32_16x16x32_bf16 v[120:123], a[164:167], v[208:211], v[120:123]
 v_mfma_f32_16x16x32_bf16 v[124:127], a[156:159], v[212:215], v[124:127]
 ds_read_b128 v[180:183], v18 offset:10240
 v_mfma_f32_16x16x32_bf16 v[128:131], a[160:163], v[212:215], v[128:131]
 buffer_load_dwordx4 v11, s[8:11], s30 offen offset:1024 lds
 v_mfma_f32_16x16x32_bf16 v[132:135], a[164:167], v[212:215], v[132:135]
 v_mfma_f32_16x16x32_bf16 v[136:139], a[156:159], v[216:219], v[136:139]
 ds_read_b128 v[184:187], v18 offset:12288
 v_mfma_f32_16x16x32_bf16 v[140:143], a[160:163], v[216:219], v[140:143]
 v_mfma_f32_16x16x32_bf16 v[144:147], a[164:167], v[216:219], v[144:147]
 v_mfma_f32_16x16x32_bf16 v[148:151], a[156:159], v[220:223], v[148:151]
 ds_read_b128 v[188:191], v18 offset:14336
 v_mfma_f32_16x16x32_bf16 v[152:155], a[160:163], v[220:223], v[152:155]
 v_mfma_f32_16x16x32_bf16 v[156:159], a[164:167], v[220:223], v[156:159]
 s_waitcnt lgkmcnt(4)
 v_mfma_f32_16x16x32_bf16 v[64:67], a[168:171], v[160:163], v[64:67]
 ds_read_b128 v[192:195], v19 offset:0
 v_mfma_f32_16x16x32_bf16 v[68:71], a[172:175], v[160:163], v[68:71]
 v_add_u32 v18, s33, v14
 s_mov_b32 s61, s60
 v_mfma_f32_16x16x32_bf16 v[72:75], a[176:179], v[160:163], v[72:75]
 s_add_u32 s60, s60, s62
 s_mul_i32 s48, s20, 393216
 v_mfma_f32_16x16x32_bf16 v[76:79], a[168:171], v[164:167], v[76:79]
 ds_read_b128 v[196:199], v19 offset:2048
 s_add_u32 s48, s48, s27
 v_mfma_f32_16x16x32_bf16 v[80:83], a[172:175], v[164:167], v[80:83]
 buffer_load_dwordx4 v12, s[8:11], s30 offen offset:2048 lds
 v_mfma_f32_16x16x32_bf16 v[84:87], a[176:179], v[164:167], v[84:87]
 s_add_u32 s27, s27, s28
 s_sub_u32 s26, s26, 1
 v_mfma_f32_16x16x32_bf16 v[88:91], a[168:171], v[168:171], v[88:91]
 ds_read_b128 v[200:203], v19 offset:4096
 v_mfma_f32_16x16x32_bf16 v[92:95], a[172:175], v[168:171], v[92:95]
 v_mfma_f32_16x16x32_bf16 v[96:99], a[176:179], v[168:171], v[96:99]
 v_mfma_f32_16x16x32_bf16 v[100:103], a[168:171], v[172:175], v[100:103]
 ds_read_b128 v[204:207], v19 offset:6144
 v_mfma_f32_16x16x32_bf16 v[104:107], a[172:175], v[172:175], v[104:107]
 v_mfma_f32_16x16x32_bf16 v[108:111], a[176:179], v[172:175], v[108:111]
 s_waitcnt lgkmcnt(4)
 v_mfma_f32_16x16x32_bf16 v[112:115], a[168:171], v[176:179], v[112:115]
 ds_read_b128 v[208:211], v19 offset:8192
 v_mfma_f32_16x16x32_bf16 v[116:119], a[172:175], v[176:179], v[116:119]
 v_mfma_f32_16x16x32_bf16 v[120:123], a[176:179], v[176:179], v[120:123]
 v_mfma_f32_16x16x32_bf16 v[124:127], a[168:171], v[180:183], v[124:127]
 ds_read_b128 v[212:215], v19 offset:10240
 v_mfma_f32_16x16x32_bf16 v[128:131], a[172:175], v[180:183], v[128:131]
 buffer_load_dwordx4 v13, s[8:11], s30 offen offset:3072 lds
 v_mfma_f32_16x16x32_bf16 v[132:135], a[176:179], v[180:183], v[132:135]
 s_add_u32 s30, s30, 128
 s_add_u32 m0, m0, 16384
 v_mfma_f32_16x16x32_bf16 v[136:139], a[168:171], v[184:187], v[136:139]
 ds_read_b128 v[216:219], v19 offset:12288
 v_mfma_f32_16x16x32_bf16 v[140:143], a[172:175], v[184:187], v[140:143]
 s_cmp_lt_u32 m0, s46
 s_cselect_b32 m0, m0, s47
 v_mfma_f32_16x16x32_bf16 v[144:147], a[176:179], v[184:187], v[144:147]
 v_mfma_f32_16x16x32_bf16 v[148:151], a[168:171], v[188:191], v[148:151]
 ds_read_b128 v[220:223], v19 offset:14336
 v_mfma_f32_16x16x32_bf16 v[152:155], a[172:175], v[188:191], v[152:155]
 v_mfma_f32_16x16x32_bf16 v[156:159], a[176:179], v[188:191], v[156:159]
 s_waitcnt vmcnt(15) lgkmcnt(4)
 s_barrier
 v_mfma_f32_16x16x32_bf16 v[64:67], a[180:183], v[192:195], v[64:67]
 ds_read_b128 v[160:163], v18 offset:0
 v_mfma_f32_16x16x32_bf16 v[68:71], a[184:187], v[192:195], v[68:71]
 v_mfma_f32_16x16x32_bf16 v[72:75], a[188:191], v[192:195], v[72:75]
 v_add_u32 v19, s33, v15
 s_add_u32 s33, s33, 16384
 v_mfma_f32_16x16x32_bf16 v[76:79], a[180:183], v[196:199], v[76:79]
 ds_read_b128 v[164:167], v18 offset:2048
 v_mfma_f32_16x16x32_bf16 v[80:83], a[184:187], v[196:199], v[80:83]
 buffer_load_dwordx4 v10, s[8:11], s30 offen offset:0 lds
 v_mfma_f32_16x16x32_bf16 v[84:87], a[188:191], v[196:199], v[84:87]
 s_cmp_lt_u32 s33, 98304
 s_cselect_b32 s33, s33, 0
 v_mfma_f32_16x16x32_bf16 v[88:91], a[180:183], v[200:203], v[88:91]
 ds_read_b128 v[168:171], v18 offset:4096
 v_mfma_f32_16x16x32_bf16 v[92:95], a[184:187], v[200:203], v[92:95]
 v_mfma_f32_16x16x32_bf16 v[96:99], a[188:191], v[200:203], v[96:99]
 v_mfma_f32_16x16x32_bf16 v[100:103], a[180:183], v[204:207], v[100:103]
 ds_read_b128 v[172:175], v18 offset:6144
 v_mfma_f32_16x16x32_bf16 v[104:107], a[184:187], v[204:207], v[104:107]
 v_mfma_f32_16x16x32_bf16 v[108:111], a[188:191], v[204:207], v[108:111]
 s_waitcnt lgkmcnt(4)
 v_mfma_f32_16x16x32_bf16 v[112:115], a[180:183], v[208:211], v[112:115]
 ds_read_b128 v[176:179], v18 offset:8192
 v_mfma_f32_16x16x32_bf16 v[116:119], a[184:187], v[208:211], v[116:119]
 v_mfma_f32_16x16x32_bf16 v[120:123], a[188:191], v[208:211], v[120:123]
 v_mfma_f32_16x16x32_bf16 v[124:127], a[180:183], v[212:215], v[124:127]
 ds_read_b128 v[180:183], v18 offset:10240
 v_mfma_f32_16x16x32_bf16 v[128:131], a[184:187], v[212:215], v[128:131]
 buffer_load_dwordx4 v11, s[8:11], s30 offen offset:1024 lds
 v_mfma_f32_16x16x32_bf16 v[132:135], a[188:191], v[212:215], v[132:135]
 v_mfma_f32_16x16x32_bf16 v[136:139], a[180:183], v[216:219], v[136:139]
 ds_read_b128 v[184:187], v18 offset:12288
 v_mfma_f32_16x16x32_bf16 v[140:143], a[184:187], v[216:219], v[140:143]
 v_mfma_f32_16x16x32_bf16 v[144:147], a[188:191], v[216:219], v[144:147]
 v_mfma_f32_16x16x32_bf16 v[148:151], a[180:183], v[220:223], v[148:151]
 ds_read_b128 v[188:191], v18 offset:14336
 v_mfma_f32_16x16x32_bf16 v[152:155], a[184:187], v[220:223], v[152:155]
 v_mfma_f32_16x16x32_bf16 v[156:159], a[188:191], v[220:223], v[156:159]
 s_waitcnt lgkmcnt(4)
 v_mfma_f32_16x16x32_bf16 v[64:67], a[192:195], v[160:163], v[64:67]
 ds_read_b128 v[192:195], v19 offset:0
 v_mfma_f32_16x16x32_bf16 v[68:71], a[196:199], v[160:163], v[68:71]
 v_add_u32 v18, s33, v14
 v_mfma_f32_16x16x32_bf16 v[72:75], a[200:203], v[160:163], v[72:75]
 v_mfma_f32_16x16x32_bf16 v[76:79], a[192:195], v[164:167], v[76:79]
 ds_read_b128 v[196:199], v19 offset:2048
 v_mfma_f32_16x16x32_bf16 v[80:83], a[196:199], v[164:167], v[80:83]
 buffer_load_dwordx4 v12, s[8:11], s30 offen offset:2048 lds
 v_mfma_f32_16x16x32_bf16 v[84:87], a[200:203], v[164:167], v[84:87]
 v_mfma_f32_16x16x32_bf16 v[88:91], a[192:195], v[168:171], v[88:91]
 ds_read_b128 v[200:203], v19 offset:4096
 v_mfma_f32_16x16x32_bf16 v[92:95], a[196:199], v[168:171], v[92:95]
 v_mfma_f32_16x16x32_bf16 v[96:99], a[200:203], v[168:171], v[96:99]
 v_mfma_f32_16x16x32_bf16 v[100:103], a[192:195], v[172:175], v[100:103]
 ds_read_b128 v[204:207], v19 offset:6144
 v_mfma_f32_16x16x32_bf16 v[104:107], a[196:199], v[172:175], v[104:107]
 v_mfma_f32_16x16x32_bf16 v[108:111], a[200:203], v[172:175], v[108:111]
 s_waitcnt lgkmcnt(4)
 v_mfma_f32_16x16x32_bf16 v[112:115], a[192:195], v[176:179], v[112:115]
 ds_read_b128 v[208:211], v19 offset:8192
 v_mfma_f32_16x16x32_bf16 v[116:119], a[196:199], v[176:179], v[116:119]
 v_mfma_f32_16x16x32_bf16 v[120:123], a[200:203], v[176:179], v[120:123]
 v_mfma_f32_16x16x32_bf16 v[124:127], a[192:195], v[180:183], v[124:127]
 ds_read_b128 v[212:215], v19 offset:10240
 v_mfma_f32_16x16x32_bf16 v[128:131], a[196:199], v[180:183], v[128:131]
 buffer_load_dwordx4 v13, s[8:11], s30 offen offset:3072 lds
 v_mfma_f32_16x16x32_bf16 v[132:135], a[200:203], v[180:183], v[132:135]
 s_add_u32 s30, s30, 128
 s_add_u32 m0, m0, 16384
 v_mfma_f32_16x16x32_bf16 v[136:139], a[192:195], v[184:187], v[136:139]
 ds_read_b128 v[216:219], v19 offset:12288
 v_mfma_f32_16x16x32_bf16 v[140:143], a[196:199], v[184:187], v[140:143]
 s_cmp_lt_u32 m0, s46
 s_cselect_b32 m0, m0, s47
 v_mfma_f32_16x16x32_bf16 v[144:147], a[200:203], v[184:187], v[144:147]
 v_mfma_f32_16x16x32_bf16 v[148:151], a[192:195], v[188:191], v[148:151]
 ds_read_b128 v[220:223], v19 offset:14336
 v_mfma_f32_16x16x32_bf16 v[152:155], a[196:199], v[188:191], v[152:155]
 v_mfma_f32_16x16x32_bf16 v[156:159], a[200:203], v[188:191], v[156:159]
 s_waitcnt vmcnt(12) lgkmcnt(4)
 s_barrier
 v_mfma_f32_16x16x32_bf16 v[64:67], a[204:207], v[192:195], v[64:67]
 ds_read_b128 v[160:163], v18 offset:0
 v_mfma_f32_16x16x32_bf16 v[68:71], a[208:211], v[192:195], v[68:71]
 v_mfma_f32_16x16x32_bf16 v[72:75], a[212:215], v[192:195], v[72:75]
 v_add_u32 v19, s33, v15
 s_add_u32 s33, s33, 16384
 v_mfma_f32_16x16x32_bf16 v[76:79], a[204:207], v[196:199], v[76:79]
 ds_read_b128 v[164:167], v18 offset:2048
 v_mfma_f32_16x16x32_bf16 v[80:83], a[208:211], v[196:199], v[80:83]
 buffer_load_dwordx4 v10, s[8:11], s30 offen offset:0 lds
 v_mfma_f32_16x16x32_bf16 v[84:87], a[212:215], v[196:199], v[84:87]
 s_cmp_lt_u32 s33, 98304
 s_cselect_b32 s33, s33, 0
 v_mfma_f32_16x16x32_bf16 v[88:91], a[204:207], v[200:203], v[88:91]
 ds_read_b128 v[168:171], v18 offset:4096
 v_mfma_f32_16x16x32_bf16 v[92:95], a[208:211], v[200:203], v[92:95]
 v_mfma_f32_16x16x32_bf16 v[96:99], a[212:215], v[200:203], v[96:99]
 v_mfma_f32_16x16x32_bf16 v[100:103], a[204:207], v[204:207], v[100:103]
 ds_read_b128 v[172:175], v18 offset:6144
 v_mfma_f32_16x16x32_bf16 v[104:107], a[208:211], v[204:207], v[104:107]
 v_mfma_f32_16x16x32_bf16 v[108:111], a[212:215], v[204:207], v[108:111]
 s_waitcnt lgkmcnt(4)
 v_mfma_f32_16x16x32_bf16 v[112:115], a[204:207], v[208:211], v[112:115]
 ds_read_b128 v[176:179], v18 offset:8192
 v_mfma_f32_16x16x32_bf16 v[116:119], a[208:211], v[208:211], v[116:119]
 v_mfma_f32_16x16x32_bf16 v[120:123], a[212:215], v[208:211], v[120:123]
 v_mfma_f32_16x16x32_bf16 v[124:127], a[204:207], v[212:215], v[124:127]
 ds_read_b128 v[180:183], v18 offset:10240
 v_mfma_f32_16x16x32_bf16 v[128:131], a[208:211], v[212:215], v[128:131]
 buffer_load_dwordx4 v11, s[8:11], s30 offen offset:1024 lds
 v_mfma_f32_16x16x32_bf16 v[132:135], a[212:215], v[212:215], v[132:135]
 v_mfma_f32_16x16x32_bf16 v[136:139], a[204:207], v[216:219], v[136:139]
 ds_read_b128 v[184:187], v18 offset:12288
 v_mfma_f32_16x16x32_bf16 v[140:143], a[208:211], v[216:219], v[140:143]
 v_mfma_f32_16x16x32_bf16 v[144:147], a[212:215], v[216:219], v[144:147]
 v_mfma_f32_16x16x32_bf16 v[148:151], a[204:207], v[220:223], v[148:151]
 ds_read_b128 v[188:191], v18 offset:14336
 v_mfma_f32_16x16x32_bf16 v[152:155], a[208:211], v[220:223], v[152:155]
 v_mfma_f32_16x16x32_bf16 v[156:159], a[212:215], v[220:223], v[156:159]
 s_waitcnt lgkmcnt(4)
 v_mfma_f32_16x16x32_bf16 v[64:67], a[216:219], v[160:163], v[64:67]
 ds_read_b128 v[192:195], v19 offset:0
 v_mfma_f32_16x16x32_bf16 v[68:71], a[220:223], v[160:163], v[68:71]
 v_add_u32 v18, s33, v14
 v_mfma_f32_16x16x32_bf16 v[72:75], a[224:227], v[160:163], v[72:75]
 v_mfma_f32_16x16x32_bf16 v[76:79], a[216:219], v[164:167], v[76:79]
 ds_read_b128 v[196:199], v19 offset:2048
 v_mfma_f32_16x16x32_bf16 v[80:83], a[220:223], v[164:167], v[80:83]
 buffer_load_dwordx4 v12, s[8:11], s30 offen offset:2048 lds
 v_mfma_f32_16x16x32_bf16 v[84:87], a[224:227], v[164:167], v[84:87]
 v_mfma_f32_16x16x32_bf16 v[88:91], a[216:219], v[168:171], v[88:91]
 ds_read_b128 v[200:203], v19 offset:4096
 v_mfma_f32_16x16x32_bf16 v[92:95], a[220:223], v[168:171], v[92:95]
 v_mfma_f32_16x16x32_bf16 v[96:99], a[224:227], v[168:171], v[96:99]
 v_mfma_f32_16x16x32_bf16 v[100:103], a[216:219], v[172:175], v[100:103]
 ds_read_b128 v[204:207], v19 offset:6144
 v_mfma_f32_16x16x32_bf16 v[104:107], a[220:223], v[172:175], v[104:107]
 v_mfma_f32_16x16x32_bf16 v[108:111], a[224:227], v[172:175], v[108:111]
 s_waitcnt lgkmcnt(4)
 v_mfma_f32_16x16x32_bf16 v[112:115], a[216:219], v[176:179], v[112:115]
 ds_read_b128 v[208:211], v19 offset:8192
 v_mfma_f32_16x16x32_bf16 v[116:119], a[220:223], v[176:179], v[116:119]
 v_mfma_f32_16x16x32_bf16 v[120:123], a[224:227], v[176:179], v[120:123]
 v_mfma_f32_16x16x32_bf16 v[124:127], a[216:219], v[180:183], v[124:127]
 ds_read_b128 v[212:215], v19 offset:10240
 v_mfma_f32_16x16x32_bf16 v[128:131], a[220:223], v[180:183], v[128:131]
 buffer_load_dwordx4 v13, s[8:11], s30 offen offset:3072 lds
 v_mfma_f32_16x16x32_bf16 v[132:135], a[224:227], v[180:183], v[132:135]
 s_add_u32 s30, s30, 128
 s_add_u32 m0, m0, 16384
 v_mfma_f32_16x16x32_bf16 v[136:139], a[216:219], v[184:187], v[136:139]
 ds_read_b128 v[216:219], v19 offset:12288
 v_mfma_f32_16x16x32_bf16 v[140:143], a[220:223], v[184:187], v[140:143]
 s_cmp_lt_u32 m0, s46
 s_cselect_b32 m0, m0, s47
 v_mfma_f32_16x16x32_bf16 v[144:147], a[224:227], v[184:187], v[144:147]
 v_mfma_f32_16x16x32_bf16 v[148:151], a[216:219], v[188:191], v[148:151]
 ds_read_b128 v[220:223], v19 offset:14336
 v_mfma_f32_16x16x32_bf16 v[152:155], a[220:223], v[188:191], v[152:155]
 v_mfma_f32_16x16x32_bf16 v[156:159], a[224:227], v[188:191], v[156:159]
 s_waitcnt vmcnt(12) lgkmcnt(4)
 s_barrier
 v_mfma_f32_16x16x32_bf16 v[64:67], a[228:231], v[192:195], v[64:67]
 ds_read_b128 v[160:163], v18 offset:0
 v_mfma_f32_16x16x32_bf16 v[68:71], a[232:235], v[192:195], v[68:71]
 v_mfma_f32_16x16x32_bf16 v[72:75], a[236:239], v[192:195], v[72:75]
 v_add_u32 v19, s33, v15
 s_add_u32 s33, s33, 16384
 v_mfma_f32_16x16x32_bf16 v[76:79], a[228:231], v[196:199], v[76:79]
 ds_read_b128 v[164:167], v18 offset:2048
 v_cvt_pk_bf16_f32 v224, v64, v65
 v_mfma_f32_16x16x32_bf16 v[80:83], a[232:235], v[196:199], v[80:83]
 buffer_load_dwordx4 v10, s[8:11], s30 offen offset:0 lds
 v_mfma_f32_16x16x32_bf16 v[84:87], a[236:239], v[196:199], v[84:87]
 s_cmp_lt_u32 s33, 98304
 s_cselect_b32 s33, s33, 0
 v_mfma_f32_16x16x32_bf16 v[88:91], a[228:231], v[200:203], v[88:91]
 ds_read_b128 v[168:171], v18 offset:4096
 v_cvt_pk_bf16_f32 v225, v66, v67
 v_mfma_f32_16x16x32_bf16 v[92:95], a[232:235], v[200:203], v[92:95]
 v_cvt_pk_bf16_f32 v226, v68, v69
 v_cvt_pk_bf16_f32 v227, v70, v71
 v_mfma_f32_16x16x32_bf16 v[96:99], a[236:239], v[200:203], v[96:99]
 v_cvt_pk_bf16_f32 v228, v72, v73
 v_cvt_pk_bf16_f32 v229, v74, v75
 v_mfma_f32_16x16x32_bf16 v[100:103], a[228:231], v[204:207], v[100:103]
 ds_read_b128 v[172:175], v18 offset:6144
 v_mfma_f32_16x16x32_bf16 v[104:107], a[232:235], v[204:207], v[104:107]
 ds_write_b64 v22, v[224:225] offset:0
 v_mfma_f32_16x16x32_bf16 v[108:111], a[236:239], v[204:207], v[108:111]
 s_waitcnt lgkmcnt(5)
 v_mfma_f32_16x16x32_bf16 v[112:115], a[228:231], v[208:211], v[112:115]
 ds_read_b128 v[176:179], v18 offset:8192
 v_mfma_f32_16x16x32_bf16 v[116:119], a[232:235], v[208:211], v[116:119]
 ds_write_b64 v22, v[226:227] offset:8
 v_mfma_f32_16x16x32_bf16 v[120:123], a[236:239], v[208:211], v[120:123]
 ds_write_b64 v16, v[228:229] offset:64
 v_mfma_f32_16x16x32_bf16 v[124:127], a[228:231], v[212:215], v[124:127]
 ds_read_b128 v[180:183], v18 offset:10240
 v_cvt_pk_bf16_f32 v230, v76, v77
 v_mfma_f32_16x16x32_bf16 v[128:131], a[232:235], v[212:215], v[128:131]
 buffer_load_dwordx4 v11, s[8:11], s30 offen offset:1024 lds
 v_mfma_f32_16x16x32_bf16 v[132:135], a[236:239], v[212:215], v[132:135]
 v_cvt_pk_bf16_f32 v231, v78, v79
 v_cvt_pk_bf16_f32 v232, v80, v81
 v_mfma_f32_16x16x32_bf16 v[136:139], a[228:231], v[216:219], v[136:139]
 ds_read_b128 v[184:187], v18 offset:12288
 v_cvt_pk_bf16_f32 v233, v82, v83
 v_mfma_f32_16x16x32_bf16 v[140:143], a[232:235], v[216:219], v[140:143]
 v_cvt_pk_bf16_f32 v234, v84, v85
 v_cvt_pk_bf16_f32 v235, v86, v87
 v_mfma_f32_16x16x32_bf16 v[144:147], a[236:239], v[216:219], v[144:147]
 ds_write_b64 v22, v[230:231] offset:6400
 v_mfma_f32_16x16x32_bf16 v[148:151], a[228:231], v[220:223], v[148:151]
 ds_read_b128 v[188:191], v18 offset:14336
 v_mfma_f32_16x16x32_bf16 v[152:155], a[232:235], v[220:223], v[152:155]
 ds_write_b64 v22, v[232:233] offset:6408
 v_mfma_f32_16x16x32_bf16 v[156:159], a[236:239], v[220:223], v[156:159]
 s_waitcnt lgkmcnt(9)
kv_end_133:
 s_cmp_gt_u32 s26, 0
 s_cbranch_scc1 kv_blk_132
 s_nop 7
 ds_write_b64 v16, v[234:235] offset:6464
 v_cvt_pk_bf16_f32 v236, v88, v89
 v_cvt_pk_bf16_f32 v237, v90, v91
 v_cvt_pk_bf16_f32 v238, v92, v93
 v_cvt_pk_bf16_f32 v239, v94, v95
 v_cvt_pk_bf16_f32 v240, v96, v97
 v_cvt_pk_bf16_f32 v241, v98, v99
 ds_write_b64 v22, v[236:237] offset:12800
 ds_write_b64 v22, v[238:239] offset:12808
 ds_write_b64 v16, v[240:241] offset:12864
 v_cvt_pk_bf16_f32 v242, v100, v101
 v_cvt_pk_bf16_f32 v243, v102, v103
 v_cvt_pk_bf16_f32 v244, v104, v105
 v_cvt_pk_bf16_f32 v245, v106, v107
 v_cvt_pk_bf16_f32 v246, v108, v109
 v_cvt_pk_bf16_f32 v247, v110, v111
 ds_write_b64 v22, v[242:243] offset:19200
 ds_write_b64 v22, v[244:245] offset:19208
 ds_write_b64 v16, v[246:247] offset:19264
 v_cvt_pk_bf16_f32 v224, v112, v113
 v_cvt_pk_bf16_f32 v225, v114, v115
 v_cvt_pk_bf16_f32 v226, v116, v117
 v_cvt_pk_bf16_f32 v227, v118, v119
 v_cvt_pk_bf16_f32 v228, v120, v121
 v_cvt_pk_bf16_f32 v229, v122, v123
 ds_write_b64 v22, v[224:225] offset:25600
 ds_write_b64 v22, v[226:227] offset:25608
 ds_write_b64 v16, v[228:229] offset:25664
 v_cvt_pk_bf16_f32 v230, v124, v125
 v_cvt_pk_bf16_f32 v231, v126, v127
 v_cvt_pk_bf16_f32 v232, v128, v129
 v_cvt_pk_bf16_f32 v233, v130, v131
 v_cvt_pk_bf16_f32 v234, v132, v133
 v_cvt_pk_bf16_f32 v235, v134, v135
 ds_write_b64 v22, v[230:231] offset:32000
 ds_write_b64 v22, v[232:233] offset:32008
 ds_write_b64 v16, v[234:235] offset:32064
 v_cvt_pk_bf16_f32 v236, v136, v137
 v_cvt_pk_bf16_f32 v237, v138, v139
 v_cvt_pk_bf16_f32 v238, v140, v141
 v_cvt_pk_bf16_f32 v239, v142, v143
 v_cvt_pk_bf16_f32 v240, v144, v145
 v_cvt_pk_bf16_f32 v241, v146, v147
 ds_write_b64 v22, v[236:237] offset:38400
 ds_write_b64 v22, v[238:239] offset:38408
 ds_write_b64 v16, v[240:241] offset:38464
 v_cvt_pk_bf16_f32 v242, v148, v149
 v_cvt_pk_bf16_f32 v243, v150, v151
 v_cvt_pk_bf16_f32 v244, v152, v153
 v_cvt_pk_bf16_f32 v245, v154, v155
 v_cvt_pk_bf16_f32 v246, v156, v157
 v_cvt_pk_bf16_f32 v247, v158, v159
 ds_write_b64 v22, v[242:243] offset:44800
 ds_write_b64 v22, v[244:245] offset:44808
 ds_write_b64 v16, v[246:247] offset:44864
 s_waitcnt vmcnt(0) lgkmcnt(0)
 s_barrier
 ds_read_b128 v[224:227], v23 offset:0
 ds_read_b128 v[228:231], v23 offset:64
 ds_read_b128 v[232:235], v23 offset:128
 ds_read_b128 v[236:239], v23 offset:192
 ds_read_b128 v[240:243], v23 offset:256
 ds_read_b128 v[244:247], v23 offset:320
 s_waitcnt lgkmcnt(0)
 s_add_u32 s21, s48, 0
 buffer_store_dwordx4 v[224:227], v26, s[16:19], s21 offen offset:0 sc1
 buffer_store_dwordx4 v[228:231], v26, s[16:19], s21 offen offset:1024 sc1
 buffer_store_dwordx4 v[232:235], v26, s[16:19], s21 offen offset:2048 sc1
 buffer_store_dwordx4 v[236:239], v26, s[16:19], s21 offen offset:3072 sc1
 s_add_u32 s21, s48, 4096
 buffer_store_dwordx4 v[240:243], v26, s[16:19], s21 offen offset:0 sc1
 buffer_store_dwordx4 v[244:247], v26, s[16:19], s21 offen offset:1024 sc1
 s_nop 1
 ds_read_b128 v[224:227], v23 offset:6400
 ds_read_b128 v[228:231], v23 offset:6464
 ds_read_b128 v[232:235], v23 offset:6528
 ds_read_b128 v[236:239], v23 offset:6592
 ds_read_b128 v[240:243], v23 offset:6656
 ds_read_b128 v[244:247], v23 offset:6720
 s_waitcnt lgkmcnt(0)
 buffer_store_dwordx4 v[224:227], v26, s[16:19], s21 offen offset:2048 sc1
 buffer_store_dwordx4 v[228:231], v26, s[16:19], s21 offen offset:3072 sc1
 s_add_u32 s21, s48, 8192
 buffer_store_dwordx4 v[232:235], v26, s[16:19], s21 offen offset:0 sc1
 buffer_store_dwordx4 v[236:239], v26, s[16:19], s21 offen offset:1024 sc1
 buffer_store_dwordx4 v[240:243], v26, s[16:19], s21 offen offset:2048 sc1
 buffer_store_dwordx4 v[244:247], v26, s[16:19], s21 offen offset:3072 sc1
 s_nop 1
 s_waitcnt vmcnt(0)
 s_barrier
 s_cmp_lg_u32 s20, 0
 s_cbranch_scc1 af_134
 v_mov_b32 v4, 0
 v_mov_b32 v5, 1
 s_mov_b64 exec, 1
 buffer_atomic_add v5, v4, s[72:75], s61 offen sc1
 s_mov_b64 exec, -1
 s_nop 1
af_134:
 s_cmp_lg_u32 s43, 0
 s_cbranch_scc1 kv_fin
 s_mov_b32 s87, -2
 s_add_u32 s21, s42, 32
 s_branch do_opb2
kv_help:
 s_waitcnt vmcnt(0) lgkmcnt(0)
 s_barrier
 s_load_dwordx2 s[4:5], s[0:1], 0
 s_load_dwordx2 s[6:7], s[0:1], 24
 s_load_dwordx2 s[36:37], s[0:1], 32
 s_load_dwordx2 s[38:39], s[0:1], 104
 s_and_b32 s43, s3, 1
 s_bfe_u32 s42, s3, 0x50001
 s_lshr_b32 s40, s42, 2
 s_waitcnt lgkmcnt(0)
 s_cmp_eq_u32 s43, 1
 s_cselect_b32 s6, s36, s6
 s_cselect_b32 s7, s37, s7
 s_mov_b32 s8, s4
 s_mov_b32 s9, s5
 s_mov_b32 s10, 2621440
 s_mov_b32 s11, 0x00020000
 s_mov_b32 s12, s6
 s_mov_b32 s13, s7
 s_mov_b32 s14, 7864320
 s_mov_b32 s15, 0x00020000
 s_mov_b32 s16, s38
 s_mov_b32 s17, s39
 s_mov_b32 s18, 50331648
 s_mov_b32 s19, 0x00020000
 s_mul_i32 s44, s42, 384
 s_mov_b32 s28, 1572864
 s_mov_b32 s43, 2
 s_load_dwordx2 s[6:7], s[0:1], 16
 s_waitcnt lgkmcnt(0)
 s_mov_b32 s12, s6
 s_mov_b32 s13, s7
 s_mov_b32 s14, 7864320
 s_mov_b32 s15, 0x00020000
 s_add_u32 s16, s38, 57671680
 s_addc_u32 s17, s39, 0
 s_mov_b32 s18, 3145728
 s_mov_b32 s19, 0x00020000
 s_mov_b32 s24, 2293760
 s_mov_b32 s25, 163840
 v_mov_b32 v9, 2731
 s_and_b32 s22, s20, 1
 s_lshl_b32 s22, s22, 2
 v_add_u32 v8, 0, v1
 v_mul_u32_u24 v7, v8, v9
 v_lshrrev_b32 v7, 16, v7
 v_mul_u32_u24 v4, 24, v7
 v_sub_u32 v8, v8, v4
 v_and_b32 v4, 2, v7
 v_xor_b32 v8, v8, v4
 v_xor_b32 v8, s22, v8
 v_xor_b32 v5, 4, v8
 s_mov_b32 s21, 12288
 v_mul_lo_u32 v7, v7, s21
 v_lshl_add_u32 v40, v8, 4, v7
 v_lshl_add_u32 v43, v5, 4, v7
 v_add_u32 v8, 64, v1
 v_mul_u32_u24 v7, v8, v9
 v_lshrrev_b32 v7, 16, v7
 v_mul_u32_u24 v4, 24, v7
 v_sub_u32 v8, v8, v4
 v_and_b32 v4, 2, v7
 v_xor_b32 v8, v8, v4
 v_xor_b32 v8, s22, v8
 v_xor_b32 v5, 4, v8
 s_mov_b32 s21, 12288
 v_mul_lo_u32 v7, v7, s21
 v_lshl_add_u32 v41, v8, 4, v7
 v_lshl_add_u32 v44, v5, 4, v7
 v_add_u32 v8, 128, v1
 v_mul_u32_u24 v7, v8, v9
 v_lshrrev_b32 v7, 16, v7
 v_mul_u32_u24 v4, 24, v7
 v_sub_u32 v8, v8, v4
 v_and_b32 v4, 2, v7
 v_xor_b32 v8, v8, v4
 v_xor_b32 v8, s22, v8
 v_xor_b32 v5, 4, v8
 s_mov_b32 s21, 12288
 v_mul_lo_u32 v7, v7, s21
 v_lshl_add_u32 v42, v8, 4, v7
 v_lshl_add_u32 v45, v5, 4, v7
 s_mul_i32 s23, s20, 491520
 s_add_u32 s23, s23, s44
 s_mul_i32 s22, s20, 15360
 s_add_u32 s22, s22, 98304
 s_add_u32 s21, s23, 0
 s_waitcnt vmcnt(3)
 s_add_u32 m0, s22, 0
 s_nop 0
 buffer_load_dwordx4 v40, s[12:15], s21 offen lds
 s_add_u32 m0, s22, 1024
 s_nop 0
 buffer_load_dwordx4 v41, s[12:15], s21 offen lds
 s_add_u32 m0, s22, 2048
 s_nop 0
 buffer_load_dwordx4 v42, s[12:15], s21 offen lds
 s_add_u32 s21, s23, 98304
 s_waitcnt vmcnt(3)
 s_add_u32 m0, s22, 3072
 s_nop 0
 buffer_load_dwordx4 v43, s[12:15], s21 offen lds
 s_add_u32 m0, s22, 4096
 s_nop 0
 buffer_load_dwordx4 v44, s[12:15], s21 offen lds
 s_add_u32 m0, s22, 5120
 s_nop 0
 buffer_load_dwordx4 v45, s[12:15], s21 offen lds
 s_add_u32 s21, s23, 196608
 s_waitcnt vmcnt(3)
 s_add_u32 m0, s22, 6144
 s_nop 0
 buffer_load_dwordx4 v40, s[12:15], s21 offen lds
 s_add_u32 m0, s22, 7168
 s_nop 0
 buffer_load_dwordx4 v41, s[12:15], s21 offen lds
 s_add_u32 m0, s22, 8192
 s_nop 0
 buffer_load_dwordx4 v42, s[12:15], s21 offen lds
 s_add_u32 s21, s23, 294912
 s_waitcnt vmcnt(3)
 s_add_u32 m0, s22, 9216
 s_nop 0
 buffer_load_dwordx4 v43, s[12:15], s21 offen lds
 s_add_u32 m0, s22, 10240
 s_nop 0
 buffer_load_dwordx4 v44, s[12:15], s21 offen lds
 s_add_u32 m0, s22, 11264
 s_nop 0
 buffer_load_dwordx4 v45, s[12:15], s21 offen lds
 s_add_u32 s21, s23, 393216
 s_waitcnt vmcnt(3)
 s_add_u32 m0, s22, 12288
 s_nop 0
 buffer_load_dwordx4 v40, s[12:15], s21 offen lds
 s_add_u32 m0, s22, 13312
 s_nop 0
 buffer_load_dwordx4 v41, s[12:15], s21 offen lds
 s_add_u32 m0, s22, 14336
 s_nop 0
 buffer_load_dwordx4 v42, s[12:15], s21 offen lds
 s_add_u32 s21, s23, 1966080
 s_waitcnt vmcnt(3)
 buffer_load_dwordx4 v[64:67], v40, s[12:15], s21 offen
 buffer_load_dwordx4 v[68:71], v41, s[12:15], s21 offen
 buffer_load_dwordx4 v[72:75], v42, s[12:15], s21 offen
 s_add_u32 s21, s23, 2064384
 s_waitcnt vmcnt(3)
 buffer_load_dwordx4 v[76:79], v43, s[12:15], s21 offen
 buffer_load_dwordx4 v[80:83], v44, s[12:15], s21 offen
 buffer_load_dwordx4 v[84:87], v45, s[12:15], s21 offen
 s_add_u32 s21, s23, 2162688
 s_waitcnt vmcnt(3)
 buffer_load_dwordx4 v[88:91], v40, s[12:15], s21 offen
 buffer_load_dwordx4 v[92:95], v41, s[12:15], s21 offen
 buffer_load_dwordx4 v[96:99], v42, s[12:15], s21 offen
 s_add_u32 s21, s23, 2260992
 s_waitcnt vmcnt(3)
 buffer_load_dwordx4 v[100:103], v43, s[12:15], s21 offen
 buffer_load_dwordx4 v[104:107], v44, s[12:15], s21 offen
 buffer_load_dwordx4 v[108:111], v45, s[12:15], s21 offen
 s_add_u32 s21, s23, 2359296
 s_waitcnt vmcnt(3)
 buffer_load_dwordx4 v[112:115], v40, s[12:15], s21 offen
 buffer_load_dwordx4 v[116:119], v41, s[12:15], s21 offen
 buffer_load_dwordx4 v[120:123], v42, s[12:15], s21 offen
 s_add_u32 s21, s23, 3932160
 s_waitcnt vmcnt(3)
 buffer_load_dwordx4 v[124:127], v40, s[12:15], s21 offen
 buffer_load_dwordx4 v[128:131], v41, s[12:15], s21 offen
 buffer_load_dwordx4 v[132:135], v42, s[12:15], s21 offen
 s_add_u32 s21, s23, 4030464
 s_waitcnt vmcnt(3)
 buffer_load_dwordx4 v[136:139], v43, s[12:15], s21 offen
 buffer_load_dwordx4 v[140:143], v44, s[12:15], s21 offen
 buffer_load_dwordx4 v[144:147], v45, s[12:15], s21 offen
 s_add_u32 s21, s23, 4128768
 s_waitcnt vmcnt(3)
 buffer_load_dwordx4 v[148:151], v40, s[12:15], s21 offen
 buffer_load_dwordx4 v[152:155], v41, s[12:15], s21 offen
 buffer_load_dwordx4 v[156:159], v42, s[12:15], s21 offen
 s_add_u32 s21, s23, 4227072
 s_waitcnt vmcnt(3)
 buffer_load_dwordx4 v[160:163], v43, s[12:15], s21 offen
 buffer_load_dwordx4 v[164:167], v44, s[12:15], s21 offen
 buffer_load_dwordx4 v[168:171], v45, s[12:15], s21 offen
 s_add_u32 s21, s23, 4325376
 s_waitcnt vmcnt(3)
 buffer_load_dwordx4 v[172:175], v40, s[12:15], s21 offen
 buffer_load_dwordx4 v[176:179], v41, s[12:15], s21 offen
 buffer_load_dwordx4 v[180:183], v42, s[12:15], s21 offen
 s_add_u32 s21, s23, 5898240
 s_waitcnt vmcnt(3)
 buffer_load_dwordx4 v[184:187], v40, s[12:15], s21 offen
 buffer_load_dwordx4 v[188:191], v41, s[12:15], s21 offen
 buffer_load_dwordx4 v[192:195], v42, s[12:15], s21 offen
 s_add_u32 s21, s23, 5996544
 s_waitcnt vmcnt(3)
 buffer_load_dwordx4 v[196:199], v43, s[12:15], s21 offen
 buffer_load_dwordx4 v[200:203], v44, s[12:15], s21 offen
 buffer_load_dwordx4 v[204:207], v45, s[12:15], s21 offen
 s_add_u32 s21, s23, 6094848
 s_waitcnt vmcnt(3)
 buffer_load_dwordx4 v[208:211], v40, s[12:15], s21 offen
 buffer_load_dwordx4 v[212:215], v41, s[12:15], s21 offen
 buffer_load_dwordx4 v[216:219], v42, s[12:15], s21 offen
 s_add_u32 s21, s23, 6193152
 s_waitcnt vmcnt(3)
 buffer_load_dwordx4 v[220:223], v43, s[12:15], s21 offen
 buffer_load_dwordx4 v[224:227], v44, s[12:15], s21 offen
 buffer_load_dwordx4 v[228:231], v45, s[12:15], s21 offen
 s_add_u32 s21, s23, 6291456
 s_waitcnt vmcnt(3)
 buffer_load_dwordx4 v[232:235], v40, s[12:15], s21 offen
 buffer_load_dwordx4 v[236:239], v41, s[12:15], s21 offen
 buffer_load_dwordx4 v[240:243], v42, s[12:15], s21 offen
 v_lshl_add_u32 v49, v1, 4, s22
 v_lshrrev_b32 v7, 2, v2
 v_and_b32 v4, 2, v7
 v_and_b32 v5, 1, v3
 v_lshl_or_b32 v4, v5, 2, v4
 v_lshl_add_u32 v7, v3, 3, v7
 v_mul_u32_u24 v7, 384, v7
 v_and_b32 v5, 1, v2
 v_lshl_add_u32 v7, v5, 3, v7
 v_add_u32 v7, 98304, v7
 v_bfe_u32 v8, v2, 1, 1
 s_mul_i32 s21, s20, 6
 v_add_u32 v8, s21, v8
 v_add_u32 v5, 0, v8
 v_xor_b32 v5, v5, v4
 v_lshl_add_u32 v46, v5, 4, v7
 v_add_u32 v5, 2, v8
 v_xor_b32 v5, v5, v4
 v_lshl_add_u32 v47, v5, 4, v7
 v_add_u32 v5, 4, v8
 v_xor_b32 v5, v5, v4
 v_lshl_add_u32 v48, v5, 4, v7
 s_waitcnt vmcnt(45)
 s_barrier
 ds_read_b64_tr_b16 a[0:1], v46 offset:0
 ds_read_b64_tr_b16 a[2:3], v46 offset:1536
 ds_read_b64_tr_b16 a[4:5], v47 offset:0
 ds_read_b64_tr_b16 a[6:7], v47 offset:1536
 ds_read_b64_tr_b16 a[8:9], v48 offset:0
 ds_read_b64_tr_b16 a[10:11], v48 offset:1536
 ds_read_b64_tr_b16 a[12:13], v46 offset:12288
 ds_read_b64_tr_b16 a[14:15], v46 offset:13824
 ds_read_b64_tr_b16 a[16:17], v47 offset:12288
 ds_read_b64_tr_b16 a[18:19], v47 offset:13824
 ds_read_b64_tr_b16 a[20:21], v48 offset:12288
 ds_read_b64_tr_b16 a[22:23], v48 offset:13824
 ds_read_b64_tr_b16 a[24:25], v46 offset:24576
 ds_read_b64_tr_b16 a[26:27], v46 offset:26112
 ds_read_b64_tr_b16 a[28:29], v47 offset:24576
 ds_read_b64_tr_b16 a[30:31], v47 offset:26112
 ds_read_b64_tr_b16 a[32:33], v48 offset:24576
 ds_read_b64_tr_b16 a[34:35], v48 offset:26112
 ds_read_b64_tr_b16 a[36:37], v46 offset:36864
 ds_read_b64_tr_b16 a[38:39], v46 offset:38400
 ds_read_b64_tr_b16 a[40:41], v47 offset:36864
 ds_read_b64_tr_b16 a[42:43], v47 offset:38400
 ds_read_b64_tr_b16 a[44:45], v48 offset:36864
 ds_read_b64_tr_b16 a[46:47], v48 offset:38400
 ds_read_b64_tr_b16 a[48:49], v46 offset:49152
 ds_read_b64_tr_b16 a[50:51], v46 offset:50688
 ds_read_b64_tr_b16 a[52:53], v47 offset:49152
 ds_read_b64_tr_b16 a[54:55], v47 offset:50688
 ds_read_b64_tr_b16 a[56:57], v48 offset:49152
 ds_read_b64_tr_b16 a[58:59], v48 offset:50688
 v_lshrrev_b32 v11, 3, v1
 v_and_b32 v12, 7, v1
 v_xor_b32 v12, v12, v11
 v_mul_u32_u24 v11, 1280, v11
 v_lshl_add_u32 v10, v12, 4, v11
 s_mul_i32 s46, s20, 40960
 v_add_u32 v10, s46, v10
 s_lshl_b32 s47, s20, 12
 s_add_u32 s47, s47, 0
 s_add_u32 s46, s47, 98304
 s_mov_b32 s30, s24
 s_add_u32 s32, s47, 32768
 v_add_u32 v11, 9216, v10
 v_add_u32 v12, 18432, v10
 v_add_u32 v13, 27648, v10
 s_mov_b32 m0, s32
 s_nop 0
 buffer_load_dwordx4 v10, s[8:11], s30 offen offset:0 lds
 buffer_load_dwordx4 v11, s[8:11], s30 offen offset:1024 lds
 buffer_load_dwordx4 v12, s[8:11], s30 offen offset:2048 lds
 buffer_load_dwordx4 v13, s[8:11], s30 offen offset:3072 lds
 s_add_u32 s30, s30, 128
 s_add_u32 s32, s32, 16384
 s_cmp_lt_u32 s32, s46
 s_cselect_b32 s32, s32, s47
 s_mov_b32 m0, s32
 s_nop 0
 buffer_load_dwordx4 v10, s[8:11], s30 offen offset:0 lds
 buffer_load_dwordx4 v11, s[8:11], s30 offen offset:1024 lds
 buffer_load_dwordx4 v12, s[8:11], s30 offen offset:2048 lds
 buffer_load_dwordx4 v13, s[8:11], s30 offen offset:3072 lds
 s_add_u32 s30, s30, 128
 s_add_u32 s32, s32, 16384
 s_cmp_lt_u32 s32, s46
 s_cselect_b32 s32, s32, s47
 s_mov_b32 m0, s32
 s_nop 0
 buffer_load_dwordx4 v10, s[8:11], s30 offen offset:0 lds
 buffer_load_dwordx4 v11, s[8:11], s30 offen offset:1024 lds
 buffer_load_dwordx4 v12, s[8:11], s30 offen offset:2048 lds
 buffer_load_dwordx4 v13, s[8:11], s30 offen offset:3072 lds
 s_add_u32 s30, s30, 128
 s_add_u32 s32, s32, 16384
 s_cmp_lt_u32 s32, s46
 s_cselect_b32 s32, s32, s47
 s_mov_b32 m0, s32
 s_nop 0
 buffer_load_dwordx4 v10, s[8:11], s30 offen offset:0 lds
 buffer_load_dwordx4 v11, s[8:11], s30 offen offset:1024 lds
 buffer_load_dwordx4 v12, s[8:11], s30 offen offset:2048 lds
 buffer_load_dwordx4 v13, s[8:11], s30 offen offset:3072 lds
 s_add_u32 s30, s30, 128
 s_add_u32 s32, s32, 16384
 s_cmp_lt_u32 s32, s46
 s_cselect_b32 s32, s32, s47
 s_waitcnt lgkmcnt(0)
 s_barrier
 s_waitcnt vmcnt(46)
 ds_write_b128 v49, v[64:67] offset:0
 ds_write_b128 v49, v[68:71] offset:1024
 ds_write_b128 v49, v[72:75] offset:2048
 ds_write_b128 v49, v[76:79] offset:3072
 ds_write_b128 v49, v[80:83] offset:4096
 ds_write_b128 v49, v[84:87] offset:5120
 ds_write_b128 v49, v[88:91] offset:6144
 ds_write_b128 v49, v[92:95] offset:7168
 ds_write_b128 v49, v[96:99] offset:8192
 ds_write_b128 v49, v[100:103] offset:9216
 ds_write_b128 v49, v[104:107] offset:10240
 ds_write_b128 v49, v[108:111] offset:11264
 ds_write_b128 v49, v[112:115] offset:12288
 ds_write_b128 v49, v[116:119] offset:13312
 ds_write_b128 v49, v[120:123] offset:14336
 s_waitcnt lgkmcnt(0)
 s_barrier
 ds_read_b64_tr_b16 a[60:61], v46 offset:0
 ds_read_b64_tr_b16 a[62:63], v46 offset:1536
 ds_read_b64_tr_b16 a[64:65], v47 offset:0
 ds_read_b64_tr_b16 a[66:67], v47 offset:1536
 ds_read_b64_tr_b16 a[68:69], v48 offset:0
 ds_read_b64_tr_b16 a[70:71], v48 offset:1536
 ds_read_b64_tr_b16 a[72:73], v46 offset:12288
 ds_read_b64_tr_b16 a[74:75], v46 offset:13824
 ds_read_b64_tr_b16 a[76:77], v47 offset:12288
 ds_read_b64_tr_b16 a[78:79], v47 offset:13824
 ds_read_b64_tr_b16 a[80:81], v48 offset:12288
 ds_read_b64_tr_b16 a[82:83], v48 offset:13824
 ds_read_b64_tr_b16 a[84:85], v46 offset:24576
 ds_read_b64_tr_b16 a[86:87], v46 offset:26112
 ds_read_b64_tr_b16 a[88:89], v47 offset:24576
 ds_read_b64_tr_b16 a[90:91], v47 offset:26112
 ds_read_b64_tr_b16 a[92:93], v48 offset:24576
 ds_read_b64_tr_b16 a[94:95], v48 offset:26112
 ds_read_b64_tr_b16 a[96:97], v46 offset:36864
 ds_read_b64_tr_b16 a[98:99], v46 offset:38400
 ds_read_b64_tr_b16 a[100:101], v47 offset:36864
 ds_read_b64_tr_b16 a[102:103], v47 offset:38400
 ds_read_b64_tr_b16 a[104:105], v48 offset:36864
 ds_read_b64_tr_b16 a[106:107], v48 offset:38400
 ds_read_b64_tr_b16 a[108:109], v46 offset:49152
 ds_read_b64_tr_b16 a[110:111], v46 offset:50688
 ds_read_b64_tr_b16 a[112:113], v47 offset:49152
 ds_read_b64_tr_b16 a[114:115], v47 offset:50688
 ds_read_b64_tr_b16 a[116:117], v48 offset:49152
 ds_read_b64_tr_b16 a[118:119], v48 offset:50688
 s_waitcnt lgkmcnt(0)
 s_barrier
 s_waitcnt vmcnt(31)
 ds_write_b128 v49, v[124:127] offset:0
 ds_write_b128 v49, v[128:131] offset:1024
 ds_write_b128 v49, v[132:135] offset:2048
 ds_write_b128 v49, v[136:139] offset:3072
 ds_write_b128 v49, v[140:143] offset:4096
 ds_write_b128 v49, v[144:147] offset:5120
 ds_write_b128 v49, v[148:151] offset:6144
 ds_write_b128 v49, v[152:155] offset:7168
 ds_write_b128 v49, v[156:159] offset:8192
 ds_write_b128 v49, v[160:163] offset:9216
 ds_write_b128 v49, v[164:167] offset:10240
 ds_write_b128 v49, v[168:171] offset:11264
 ds_write_b128 v49, v[172:175] offset:12288
 ds_write_b128 v49, v[176:179] offset:13312
 ds_write_b128 v49, v[180:183] offset:14336
 s_waitcnt lgkmcnt(0)
 s_barrier
 ds_read_b64_tr_b16 a[120:121], v46 offset:0
 ds_read_b64_tr_b16 a[122:123], v46 offset:1536
 ds_read_b64_tr_b16 a[124:125], v47 offset:0
 ds_read_b64_tr_b16 a[126:127], v47 offset:1536
 ds_read_b64_tr_b16 a[128:129], v48 offset:0
 ds_read_b64_tr_b16 a[130:131], v48 offset:1536
 ds_read_b64_tr_b16 a[132:133], v46 offset:12288
 ds_read_b64_tr_b16 a[134:135], v46 offset:13824
 ds_read_b64_tr_b16 a[136:137], v47 offset:12288
 ds_read_b64_tr_b16 a[138:139], v47 offset:13824
 ds_read_b64_tr_b16 a[140:141], v48 offset:12288
 ds_read_b64_tr_b16 a[142:143], v48 offset:13824
 ds_read_b64_tr_b16 a[144:145], v46 offset:24576
 ds_read_b64_tr_b16 a[146:147], v46 offset:26112
 ds_read_b64_tr_b16 a[148:149], v47 offset:24576
 ds_read_b64_tr_b16 a[150:151], v47 offset:26112
 ds_read_b64_tr_b16 a[152:153], v48 offset:24576
 ds_read_b64_tr_b16 a[154:155], v48 offset:26112
 ds_read_b64_tr_b16 a[156:157], v46 offset:36864
 ds_read_b64_tr_b16 a[158:159], v46 offset:38400
 ds_read_b64_tr_b16 a[160:161], v47 offset:36864
 ds_read_b64_tr_b16 a[162:163], v47 offset:38400
 ds_read_b64_tr_b16 a[164:165], v48 offset:36864
 ds_read_b64_tr_b16 a[166:167], v48 offset:38400
 ds_read_b64_tr_b16 a[168:169], v46 offset:49152
 ds_read_b64_tr_b16 a[170:171], v46 offset:50688
 ds_read_b64_tr_b16 a[172:173], v47 offset:49152
 ds_read_b64_tr_b16 a[174:175], v47 offset:50688
 ds_read_b64_tr_b16 a[176:177], v48 offset:49152
 ds_read_b64_tr_b16 a[178:179], v48 offset:50688
 s_waitcnt lgkmcnt(0)
 s_barrier
 s_waitcnt vmcnt(16)
 ds_write_b128 v49, v[184:187] offset:0
 ds_write_b128 v49, v[188:191] offset:1024
 ds_write_b128 v49, v[192:195] offset:2048
 ds_write_b128 v49, v[196:199] offset:3072
 ds_write_b128 v49, v[200:203] offset:4096
 ds_write_b128 v49, v[204:207] offset:5120
 ds_write_b128 v49, v[208:211] offset:6144
 ds_write_b128 v49, v[212:215] offset:7168
 ds_write_b128 v49, v[216:219] offset:8192
 ds_write_b128 v49, v[220:223] offset:9216
 ds_write_b128 v49, v[224:227] offset:10240
 ds_write_b128 v49, v[228:231] offset:11264
 ds_write_b128 v49, v[232:235] offset:12288
 ds_write_b128 v49, v[236:239] offset:13312
 ds_write_b128 v49, v[240:243] offset:14336
 s_waitcnt lgkmcnt(0)
 s_barrier
 ds_read_b64_tr_b16 a[180:181], v46 offset:0
 ds_read_b64_tr_b16 a[182:183], v46 offset:1536
 ds_read_b64_tr_b16 a[184:185], v47 offset:0
 ds_read_b64_tr_b16 a[186:187], v47 offset:1536
 ds_read_b64_tr_b16 a[188:189], v48 offset:0
 ds_read_b64_tr_b16 a[190:191], v48 offset:1536
 ds_read_b64_tr_b16 a[192:193], v46 offset:12288
 ds_read_b64_tr_b16 a[194:195], v46 offset:13824
 ds_read_b64_tr_b16 a[196:197], v47 offset:12288
 ds_read_b64_tr_b16 a[198:199], v47 offset:13824
 ds_read_b64_tr_b16 a[200:201], v48 offset:12288
 ds_read_b64_tr_b16 a[202:203], v48 offset:13824
 ds_read_b64_tr_b16 a[204:205], v46 offset:24576
 ds_read_b64_tr_b16 a[206:207], v46 offset:26112
 ds_read_b64_tr_b16 a[208:209], v47 offset:24576
 ds_read_b64_tr_b16 a[210:211], v47 offset:26112
 ds_read_b64_tr_b16 a[212:213], v48 offset:24576
 ds_read_b64_tr_b16 a[214:215], v48 offset:26112
 ds_read_b64_tr_b16 a[216:217], v46 offset:36864
 ds_read_b64_tr_b16 a[218:219], v46 offset:38400
 ds_read_b64_tr_b16 a[220:221], v47 offset:36864
 ds_read_b64_tr_b16 a[222:223], v47 offset:38400
 ds_read_b64_tr_b16 a[224:225], v48 offset:36864
 ds_read_b64_tr_b16 a[226:227], v48 offset:38400
 ds_read_b64_tr_b16 a[228:229], v46 offset:49152
 ds_read_b64_tr_b16 a[230:231], v46 offset:50688
 ds_read_b64_tr_b16 a[232:233], v47 offset:49152
 ds_read_b64_tr_b16 a[234:235], v47 offset:50688
 ds_read_b64_tr_b16 a[236:237], v48 offset:49152
 ds_read_b64_tr_b16 a[238:239], v48 offset:50688
 s_waitcnt lgkmcnt(0)
 s_barrier
 s_mov_b32 s26, 2
 s_mul_i32 s27, s42, 12288
 s_lshl_b32 s60, s42, 7
 s_add_u32 s60, s60, 123904
 s_mov_b32 s62, 0
 s_branch kv_main
kv_fin:
 s_cmp_eq_u32 s43, 2
 s_cbranch_scc1 q_final
 s_branch queue
not_kv:
 s_cmp_ge_u32 s3, 96
 s_cbranch_scc1 not_vw
 s_sub_u32 s2, s3, 64
 s_load_dwordx2 s[72:73], s[0:1], 104
 s_waitcnt lgkmcnt(0)
 s_add_u32 s72, s72, 81068032
 s_addc_u32 s73, s73, 0
 s_mov_b32 s74, 128000
 s_mov_b32 s75, 0x00020000
 s_add_u32 s8, s38, 78643200
 s_addc_u32 s9, s39, 0
 s_mov_b32 s10, 2162688
 s_mov_b32 s11, 0x00020000
 s_add_u32 s12, s38, 50331648
 s_addc_u32 s13, s39, 0
 s_mov_b32 s14, 12582912
 s_mov_b32 s15, 0x00020000
 s_add_u32 s16, s38, 83886079
 s_addc_u32 s17, s39, 0
 s_and_b32 s16, s16, 0xffe00000
 s_mov_b32 s18, 2097152
 s_mov_b32 s19, 0x00020000
 v_lshlrev_b32 v8, 4, v0
 v_lshlrev_b32 v9, 4, v1
 v_mov_b32 v4, 0
 v_mov_b32 v12, -1
 v_mov_b32 v5, 0
 v_mov_b32 v13, -1
 v_mov_b32 v6, 0
 v_mov_b32 v14, -1
 v_mov_b32 v7, 0
 v_mov_b32 v15, -1
 s_lshl_b32 s21, s2, 12
 buffer_store_dwordx4 v[4:7], v8, s[72:75], s21 offen sc1
 s_lshr_b32 s21, s2, 3
 s_lshl_b32 s21, s21, 15
 s_bfe_u32 s22, s2, 0x10002
 s_lshl_b32 s22, s22, 13
 s_add_u32 s21, s21, s22
 s_bfe_u32 s22, s2, 0x10001
 s_lshl_b32 s22, s22, 14
 s_add_u32 s21, s21, s22
 s_and_b32 s22, s2, 1
 s_mul_i32 s22, s22, 3
 s_add_u32 s22, s22, s20
 s_lshl_b32 s22, s22, 10
 s_add_u32 s21, s21, s22
 s_cmp_lt_u32 s20, 3
 s_cselect_b32 s21, s21, 0x80000000
 buffer_store_dwordx4 v[4:7], v9, s[16:19], s21 offen sc1
 s_mul_i32 s23, s20, 540672
 s_lshl_b32 s21, s2, 11
 s_add_u32 s21, s21, s23
 s_add_u32 s21, s21, 81920
 buffer_store_dwordx4 v[12:15], v9, s[8:11], s21 offen sc1
 buffer_store_dwordx4 v[12:15], v9, s[8:11], s21 offen offset:1024 sc1
 s_mul_i32 s21, s2, 3072
 s_add_u32 s21, s21, s23
 s_add_u32 s21, s21, 278528
 buffer_store_dwordx4 v[12:15], v9, s[8:11], s21 offen sc1
 buffer_store_dwordx4 v[12:15], v9, s[8:11], s21 offen offset:1024 sc1
 buffer_store_dwordx4 v[12:15], v9, s[8:11], s21 offen offset:2048 sc1
 s_lshl_b32 s21, s2, 9
 s_add_u32 s21, s21, s23
 s_add_u32 s21, s21, 376832
 s_mov_b64 exec, 0xffffffff
 buffer_store_dwordx4 v[12:15], v9, s[8:11], s21 offen sc1
 s_mov_b64 exec, -1
 s_lshl_b32 s21, s20, 5
 s_add_u32 s21, s21, s2
 s_mul_i32 s21, s21, 3072
 s_cmp_lt_u32 s20, 3
 s_cselect_b32 s21, s21, 0x80000000
 s_add_u32 s22, s21, 6291456
 buffer_store_dwordx4 v[12:15], v9, s[12:15], s21 offen offset:0 sc1
 buffer_store_dwordx4 v[12:15], v9, s[12:15], s22 offen offset:0 sc1
 buffer_store_dwordx4 v[12:15], v9, s[12:15], s21 offen offset:1024 sc1
 buffer_store_dwordx4 v[12:15], v9, s[12:15], s22 offen offset:1024 sc1
 buffer_store_dwordx4 v[12:15], v9, s[12:15], s21 offen offset:2048 sc1
 buffer_store_dwordx4 v[12:15], v9, s[12:15], s22 offen offset:2048 sc1
 s_waitcnt vmcnt(0)
 s_barrier
 s_mov_b32 s21, 76
 s_cmp_lg_u32 s20, 0
 s_cbranch_scc1 af_135
 v_mov_b32 v10, 0
 v_mov_b32 v11, 1
 s_mov_b64 exec, 1
 buffer_atomic_add v11, v10, s[32:35], s21 offen sc1
 s_mov_b64 exec, -1
 s_nop 1
af_135:
 s_load_dwordx2 s[6:7], s[0:1], 40
 s_load_dwordx2 s[38:39], s[0:1], 104
 s_waitcnt lgkmcnt(0)
 s_mov_b32 s12, s6
 s_mov_b32 s13, s7
 s_mov_b32 s14, 7864320
 s_mov_b32 s15, 0x00020000
 s_mov_b32 s16, s38
 s_mov_b32 s17, s39
 s_mov_b32 s18, 50331648
 s_mov_b32 s19, 0x00020000
 s_add_u32 s24, s38, 122683392
 s_addc_u32 s25, s39, 0
 s_mov_b32 s26, 83886080
 s_mov_b32 s27, 0x00020000
 s_load_dwordx2 s[72:73], s[0:1], 104
 s_waitcnt lgkmcnt(0)
 s_add_u32 s72, s72, 81068032
 s_addc_u32 s73, s73, 0
 s_mov_b32 s74, 128000
 s_mov_b32 s75, 0x00020000
 v_mov_b32 v29, 52429
 s_mul_i32 s21, s20, 960
 s_add_u32 s21, s21, 0
 v_add_u32 v21, s21, v1
 v_mul_u32_u24 v22, v21, v29
 v_lshrrev_b32 v22, 22, v22
 v_mul_u32_u24 v23, 80, v22
 v_sub_u32 v21, v21, v23
 v_bfe_u32 v23, v22, 3, 1
 v_and_b32 v24, 3, v22
 v_lshl_add_u32 v23, v23, 2, v24
 v_lshlrev_b32 v23, 1, v23
 v_xor_b32 v21, v21, v23
 v_cmp_gt_u32 vcc, 32, v22
 v_bfe_u32 v26, v22, 3, 2
 v_lshl_add_u32 v25, v26, 2, v24
 v_bfe_u32 v26, v22, 2, 1
 v_lshl_add_u32 v25, v26, 4, v25
 v_cndmask_b32 v25, v22, v25, vcc
 v_mul_u32_u24 v25, 1280, v25
 v_lshl_add_u32 v64, v21, 4, v25
 s_mul_i32 s21, s20, 960
 s_add_u32 s21, s21, 64
 v_add_u32 v21, s21, v1
 v_mul_u32_u24 v22, v21, v29
 v_lshrrev_b32 v22, 22, v22
 v_mul_u32_u24 v23, 80, v22
 v_sub_u32 v21, v21, v23
 v_bfe_u32 v23, v22, 3, 1
 v_and_b32 v24, 3, v22
 v_lshl_add_u32 v23, v23, 2, v24
 v_lshlrev_b32 v23, 1, v23
 v_xor_b32 v21, v21, v23
 v_cmp_gt_u32 vcc, 32, v22
 v_bfe_u32 v26, v22, 3, 2
 v_lshl_add_u32 v25, v26, 2, v24
 v_bfe_u32 v26, v22, 2, 1
 v_lshl_add_u32 v25, v26, 4, v25
 v_cndmask_b32 v25, v22, v25, vcc
 v_mul_u32_u24 v25, 1280, v25
 v_lshl_add_u32 v65, v21, 4, v25
 s_mul_i32 s21, s20, 960
 s_add_u32 s21, s21, 128
 v_add_u32 v21, s21, v1
 v_mul_u32_u24 v22, v21, v29
 v_lshrrev_b32 v22, 22, v22
 v_mul_u32_u24 v23, 80, v22
 v_sub_u32 v21, v21, v23
 v_bfe_u32 v23, v22, 3, 1
 v_and_b32 v24, 3, v22
 v_lshl_add_u32 v23, v23, 2, v24
 v_lshlrev_b32 v23, 1, v23
 v_xor_b32 v21, v21, v23
 v_cmp_gt_u32 vcc, 32, v22
 v_bfe_u32 v26, v22, 3, 2
 v_lshl_add_u32 v25, v26, 2, v24
 v_bfe_u32 v26, v22, 2, 1
 v_lshl_add_u32 v25, v26, 4, v25
 v_cndmask_b32 v25, v22, v25, vcc
 v_mul_u32_u24 v25, 1280, v25
 v_lshl_add_u32 v66, v21, 4, v25
 s_mul_i32 s21, s20, 960
 s_add_u32 s21, s21, 192
 v_add_u32 v21, s21, v1
 v_mul_u32_u24 v22, v21, v29
 v_lshrrev_b32 v22, 22, v22
 v_mul_u32_u24 v23, 80, v22
 v_sub_u32 v21, v21, v23
 v_bfe_u32 v23, v22, 3, 1
 v_and_b32 v24, 3, v22
 v_lshl_add_u32 v23, v23, 2, v24
 v_lshlrev_b32 v23, 1, v23
 v_xor_b32 v21, v21, v23
 v_cmp_gt_u32 vcc, 32, v22
 v_bfe_u32 v26, v22, 3, 2
 v_lshl_add_u32 v25, v26, 2, v24
 v_bfe_u32 v26, v22, 2, 1
 v_lshl_add_u32 v25, v26, 4, v25
 v_cndmask_b32 v25, v22, v25, vcc
 v_mul_u32_u24 v25, 1280, v25
 v_lshl_add_u32 v67, v21, 4, v25
 s_mul_i32 s21, s20, 960
 s_add_u32 s21, s21, 256
 v_add_u32 v21, s21, v1
 v_mul_u32_u24 v22, v21, v29
 v_lshrrev_b32 v22, 22, v22
 v_mul_u32_u24 v23, 80, v22
 v_sub_u32 v21, v21, v23
 v_bfe_u32 v23, v22, 3, 1
 v_and_b32 v24, 3, v22
 v_lshl_add_u32 v23, v23, 2, v24
 v_lshlrev_b32 v23, 1, v23
 v_xor_b32 v21, v21, v23
 v_cmp_gt_u32 vcc, 32, v22
 v_bfe_u32 v26, v22, 3, 2
 v_lshl_add_u32 v25, v26, 2, v24
 v_bfe_u32 v26, v22, 2, 1
 v_lshl_add_u32 v25, v26, 4, v25
 v_cndmask_b32 v25, v22, v25, vcc
 v_mul_u32_u24 v25, 1280, v25
 v_lshl_add_u32 v68, v21, 4, v25
 s_mul_i32 s21, s20, 960
 s_add_u32 s21, s21, 320
 v_add_u32 v21, s21, v1
 v_mul_u32_u24 v22, v21, v29
 v_lshrrev_b32 v22, 22, v22
 v_mul_u32_u24 v23, 80, v22
 v_sub_u32 v21, v21, v23
 v_bfe_u32 v23, v22, 3, 1
 v_and_b32 v24, 3, v22
 v_lshl_add_u32 v23, v23, 2, v24
 v_lshlrev_b32 v23, 1, v23
 v_xor_b32 v21, v21, v23
 v_cmp_gt_u32 vcc, 32, v22
 v_bfe_u32 v26, v22, 3, 2
 v_lshl_add_u32 v25, v26, 2, v24
 v_bfe_u32 v26, v22, 2, 1
 v_lshl_add_u32 v25, v26, 4, v25
 v_cndmask_b32 v25, v22, v25, vcc
 v_mul_u32_u24 v25, 1280, v25
 v_lshl_add_u32 v69, v21, 4, v25
 s_mul_i32 s21, s20, 960
 s_add_u32 s21, s21, 384
 v_add_u32 v21, s21, v1
 v_mul_u32_u24 v22, v21, v29
 v_lshrrev_b32 v22, 22, v22
 v_mul_u32_u24 v23, 80, v22
 v_sub_u32 v21, v21, v23
 v_bfe_u32 v23, v22, 3, 1
 v_and_b32 v24, 3, v22
 v_lshl_add_u32 v23, v23, 2, v24
 v_lshlrev_b32 v23, 1, v23
 v_xor_b32 v21, v21, v23
 v_cmp_gt_u32 vcc, 32, v22
 v_bfe_u32 v26, v22, 3, 2
 v_lshl_add_u32 v25, v26, 2, v24
 v_bfe_u32 v26, v22, 2, 1
 v_lshl_add_u32 v25, v26, 4, v25
 v_cndmask_b32 v25, v22, v25, vcc
 v_mul_u32_u24 v25, 1280, v25
 v_lshl_add_u32 v70, v21, 4, v25
 s_mul_i32 s21, s20, 960
 s_add_u32 s21, s21, 448
 v_add_u32 v21, s21, v1
 v_mul_u32_u24 v22, v21, v29
 v_lshrrev_b32 v22, 22, v22
 v_mul_u32_u24 v23, 80, v22
 v_sub_u32 v21, v21, v23
 v_bfe_u32 v23, v22, 3, 1
 v_and_b32 v24, 3, v22
 v_lshl_add_u32 v23, v23, 2, v24
 v_lshlrev_b32 v23, 1, v23
 v_xor_b32 v21, v21, v23
 v_cmp_gt_u32 vcc, 32, v22
 v_bfe_u32 v26, v22, 3, 2
 v_lshl_add_u32 v25, v26, 2, v24
 v_bfe_u32 v26, v22, 2, 1
 v_lshl_add_u32 v25, v26, 4, v25
 v_cndmask_b32 v25, v22, v25, vcc
 v_mul_u32_u24 v25, 1280, v25
 v_lshl_add_u32 v71, v21, 4, v25
 s_mul_i32 s21, s20, 960
 s_add_u32 s21, s21, 512
 v_add_u32 v21, s21, v1
 v_mul_u32_u24 v22, v21, v29
 v_lshrrev_b32 v22, 22, v22
 v_mul_u32_u24 v23, 80, v22
 v_sub_u32 v21, v21, v23
 v_bfe_u32 v23, v22, 3, 1
 v_and_b32 v24, 3, v22
 v_lshl_add_u32 v23, v23, 2, v24
 v_lshlrev_b32 v23, 1, v23
 v_xor_b32 v21, v21, v23
 v_cmp_gt_u32 vcc, 32, v22
 v_bfe_u32 v26, v22, 3, 2
 v_lshl_add_u32 v25, v26, 2, v24
 v_bfe_u32 v26, v22, 2, 1
 v_lshl_add_u32 v25, v26, 4, v25
 v_cndmask_b32 v25, v22, v25, vcc
 v_mul_u32_u24 v25, 1280, v25
 v_lshl_add_u32 v72, v21, 4, v25
 s_mul_i32 s21, s20, 960
 s_add_u32 s21, s21, 576
 v_add_u32 v21, s21, v1
 v_mul_u32_u24 v22, v21, v29
 v_lshrrev_b32 v22, 22, v22
 v_mul_u32_u24 v23, 80, v22
 v_sub_u32 v21, v21, v23
 v_bfe_u32 v23, v22, 3, 1
 v_and_b32 v24, 3, v22
 v_lshl_add_u32 v23, v23, 2, v24
 v_lshlrev_b32 v23, 1, v23
 v_xor_b32 v21, v21, v23
 v_cmp_gt_u32 vcc, 32, v22
 v_bfe_u32 v26, v22, 3, 2
 v_lshl_add_u32 v25, v26, 2, v24
 v_bfe_u32 v26, v22, 2, 1
 v_lshl_add_u32 v25, v26, 4, v25
 v_cndmask_b32 v25, v22, v25, vcc
 v_mul_u32_u24 v25, 1280, v25
 v_lshl_add_u32 v73, v21, 4, v25
 s_mul_i32 s21, s20, 960
 s_add_u32 s21, s21, 640
 v_add_u32 v21, s21, v1
 v_mul_u32_u24 v22, v21, v29
 v_lshrrev_b32 v22, 22, v22
 v_mul_u32_u24 v23, 80, v22
 v_sub_u32 v21, v21, v23
 v_bfe_u32 v23, v22, 3, 1
 v_and_b32 v24, 3, v22
 v_lshl_add_u32 v23, v23, 2, v24
 v_lshlrev_b32 v23, 1, v23
 v_xor_b32 v21, v21, v23
 v_cmp_gt_u32 vcc, 32, v22
 v_bfe_u32 v26, v22, 3, 2
 v_lshl_add_u32 v25, v26, 2, v24
 v_bfe_u32 v26, v22, 2, 1
 v_lshl_add_u32 v25, v26, 4, v25
 v_cndmask_b32 v25, v22, v25, vcc
 v_mul_u32_u24 v25, 1280, v25
 v_lshl_add_u32 v74, v21, 4, v25
 s_mul_i32 s21, s20, 960
 s_add_u32 s21, s21, 704
 v_add_u32 v21, s21, v1
 v_mul_u32_u24 v22, v21, v29
 v_lshrrev_b32 v22, 22, v22
 v_mul_u32_u24 v23, 80, v22
 v_sub_u32 v21, v21, v23
 v_bfe_u32 v23, v22, 3, 1
 v_and_b32 v24, 3, v22
 v_lshl_add_u32 v23, v23, 2, v24
 v_lshlrev_b32 v23, 1, v23
 v_xor_b32 v21, v21, v23
 v_cmp_gt_u32 vcc, 32, v22
 v_bfe_u32 v26, v22, 3, 2
 v_lshl_add_u32 v25, v26, 2, v24
 v_bfe_u32 v26, v22, 2, 1
 v_lshl_add_u32 v25, v26, 4, v25
 v_cndmask_b32 v25, v22, v25, vcc
 v_mul_u32_u24 v25, 1280, v25
 v_lshl_add_u32 v75, v21, 4, v25
 s_mul_i32 s21, s20, 960
 s_add_u32 s21, s21, 768
 v_add_u32 v21, s21, v1
 v_mul_u32_u24 v22, v21, v29
 v_lshrrev_b32 v22, 22, v22
 v_mul_u32_u24 v23, 80, v22
 v_sub_u32 v21, v21, v23
 v_bfe_u32 v23, v22, 3, 1
 v_and_b32 v24, 3, v22
 v_lshl_add_u32 v23, v23, 2, v24
 v_lshlrev_b32 v23, 1, v23
 v_xor_b32 v21, v21, v23
 v_cmp_gt_u32 vcc, 32, v22
 v_bfe_u32 v26, v22, 3, 2
 v_lshl_add_u32 v25, v26, 2, v24
 v_bfe_u32 v26, v22, 2, 1
 v_lshl_add_u32 v25, v26, 4, v25
 v_cndmask_b32 v25, v22, v25, vcc
 v_mul_u32_u24 v25, 1280, v25
 v_lshl_add_u32 v76, v21, 4, v25
 s_mul_i32 s21, s20, 960
 s_add_u32 s21, s21, 832
 v_add_u32 v21, s21, v1
 v_mul_u32_u24 v22, v21, v29
 v_lshrrev_b32 v22, 22, v22
 v_mul_u32_u24 v23, 80, v22
 v_sub_u32 v21, v21, v23
 v_bfe_u32 v23, v22, 3, 1
 v_and_b32 v24, 3, v22
 v_lshl_add_u32 v23, v23, 2, v24
 v_lshlrev_b32 v23, 1, v23
 v_xor_b32 v21, v21, v23
 v_cmp_gt_u32 vcc, 32, v22
 v_bfe_u32 v26, v22, 3, 2
 v_lshl_add_u32 v25, v26, 2, v24
 v_bfe_u32 v26, v22, 2, 1
 v_lshl_add_u32 v25, v26, 4, v25
 v_cndmask_b32 v25, v22, v25, vcc
 v_mul_u32_u24 v25, 1280, v25
 v_lshl_add_u32 v77, v21, 4, v25
 s_mul_i32 s21, s20, 960
 s_add_u32 s21, s21, 896
 v_add_u32 v21, s21, v1
 v_mul_u32_u24 v22, v21, v29
 v_lshrrev_b32 v22, 22, v22
 v_mul_u32_u24 v23, 80, v22
 v_sub_u32 v21, v21, v23
 v_bfe_u32 v23, v22, 3, 1
 v_and_b32 v24, 3, v22
 v_lshl_add_u32 v23, v23, 2, v24
 v_lshlrev_b32 v23, 1, v23
 v_xor_b32 v21, v21, v23
 v_cmp_gt_u32 vcc, 32, v22
 v_bfe_u32 v26, v22, 3, 2
 v_lshl_add_u32 v25, v26, 2, v24
 v_bfe_u32 v26, v22, 2, 1
 v_lshl_add_u32 v25, v26, 4, v25
 v_cndmask_b32 v25, v22, v25, vcc
 v_mul_u32_u24 v25, 1280, v25
 v_lshl_add_u32 v78, v21, 4, v25
 s_mul_i32 s40, s2, 245760
 s_add_u32 s21, s40, 0
 s_mul_i32 s22, s20, 15360
 s_add_u32 s22, s22, 0
 s_add_u32 m0, s22, 0
 s_nop 0
 buffer_load_dwordx4 v64, s[12:15], s21 offen lds
 s_add_u32 m0, s22, 1024
 s_nop 0
 buffer_load_dwordx4 v65, s[12:15], s21 offen lds
 s_add_u32 m0, s22, 2048
 s_nop 0
 buffer_load_dwordx4 v66, s[12:15], s21 offen lds
 s_add_u32 m0, s22, 3072
 s_nop 0
 buffer_load_dwordx4 v67, s[12:15], s21 offen lds
 s_add_u32 m0, s22, 4096
 s_nop 0
 buffer_load_dwordx4 v68, s[12:15], s21 offen lds
 s_add_u32 m0, s22, 5120
 s_nop 0
 buffer_load_dwordx4 v69, s[12:15], s21 offen lds
 s_add_u32 m0, s22, 6144
 s_nop 0
 buffer_load_dwordx4 v70, s[12:15], s21 offen lds
 s_add_u32 m0, s22, 7168
 s_nop 0
 buffer_load_dwordx4 v71, s[12:15], s21 offen lds
 s_add_u32 m0, s22, 8192
 s_nop 0
 buffer_load_dwordx4 v72, s[12:15], s21 offen lds
 s_add_u32 m0, s22, 9216
 s_nop 0
 buffer_load_dwordx4 v73, s[12:15], s21 offen lds
 s_add_u32 m0, s22, 10240
 s_nop 0
 buffer_load_dwordx4 v74, s[12:15], s21 offen lds
 s_add_u32 m0, s22, 11264
 s_nop 0
 buffer_load_dwordx4 v75, s[12:15], s21 offen lds
 s_add_u32 m0, s22, 12288
 s_nop 0
 buffer_load_dwordx4 v76, s[12:15], s21 offen lds
 s_add_u32 m0, s22, 13312
 s_nop 0
 buffer_load_dwordx4 v77, s[12:15], s21 offen lds
 s_add_u32 m0, s22, 14336
 s_nop 0
 buffer_load_dwordx4 v78, s[12:15], s21 offen lds
 s_add_u32 s21, s40, 61440
 s_mul_i32 s22, s20, 15360
 s_add_u32 s22, s22, 61440
 s_add_u32 m0, s22, 0
 s_nop 0
 buffer_load_dwordx4 v64, s[12:15], s21 offen lds
 s_add_u32 m0, s22, 1024
 s_nop 0
 buffer_load_dwordx4 v65, s[12:15], s21 offen lds
 s_add_u32 m0, s22, 2048
 s_nop 0
 buffer_load_dwordx4 v66, s[12:15], s21 offen lds
 s_add_u32 m0, s22, 3072
 s_nop 0
 buffer_load_dwordx4 v67, s[12:15], s21 offen lds
 s_add_u32 m0, s22, 4096
 s_nop 0
 buffer_load_dwordx4 v68, s[12:15], s21 offen lds
 s_add_u32 m0, s22, 5120
 s_nop 0
 buffer_load_dwordx4 v69, s[12:15], s21 offen lds
 s_add_u32 m0, s22, 6144
 s_nop 0
 buffer_load_dwordx4 v70, s[12:15], s21 offen lds
 s_add_u32 m0, s22, 7168
 s_nop 0
 buffer_load_dwordx4 v71, s[12:15], s21 offen lds
 s_add_u32 m0, s22, 8192
 s_nop 0
 buffer_load_dwordx4 v72, s[12:15], s21 offen lds
 s_add_u32 m0, s22, 9216
 s_nop 0
 buffer_load_dwordx4 v73, s[12:15], s21 offen lds
 s_add_u32 m0, s22, 10240
 s_nop 0
 buffer_load_dwordx4 v74, s[12:15], s21 offen lds
 s_add_u32 m0, s22, 11264
 s_nop 0
 buffer_load_dwordx4 v75, s[12:15], s21 offen lds
 s_add_u32 m0, s22, 12288
 s_nop 0
 buffer_load_dwordx4 v76, s[12:15], s21 offen lds
 s_add_u32 m0, s22, 13312
 s_nop 0
 buffer_load_dwordx4 v77, s[12:15], s21 offen lds
 s_add_u32 m0, s22, 14336
 s_nop 0
 buffer_load_dwordx4 v78, s[12:15], s21 offen lds
 s_add_u32 s21, s40, 122880
 s_mul_i32 s22, s20, 15360
 s_add_u32 s22, s22, 0
 buffer_load_dwordx4 v[80:83], v64, s[12:15], s21 offen
 buffer_load_dwordx4 v[84:87], v65, s[12:15], s21 offen
 buffer_load_dwordx4 v[88:91], v66, s[12:15], s21 offen
 buffer_load_dwordx4 v[92:95], v67, s[12:15], s21 offen
 buffer_load_dwordx4 v[96:99], v68, s[12:15], s21 offen
 buffer_load_dwordx4 v[100:103], v69, s[12:15], s21 offen
 buffer_load_dwordx4 v[104:107], v70, s[12:15], s21 offen
 buffer_load_dwordx4 v[108:111], v71, s[12:15], s21 offen
 buffer_load_dwordx4 v[112:115], v72, s[12:15], s21 offen
 buffer_load_dwordx4 v[116:119], v73, s[12:15], s21 offen
 buffer_load_dwordx4 v[120:123], v74, s[12:15], s21 offen
 buffer_load_dwordx4 v[124:127], v75, s[12:15], s21 offen
 buffer_load_dwordx4 v[128:131], v76, s[12:15], s21 offen
 buffer_load_dwordx4 v[132:135], v77, s[12:15], s21 offen
 buffer_load_dwordx4 v[136:139], v78, s[12:15], s21 offen
 s_add_u32 s21, s40, 184320
 s_mul_i32 s22, s20, 15360
 s_add_u32 s22, s22, 61440
 buffer_load_dwordx4 v[140:143], v64, s[12:15], s21 offen
 buffer_load_dwordx4 v[144:147], v65, s[12:15], s21 offen
 buffer_load_dwordx4 v[148:151], v66, s[12:15], s21 offen
 buffer_load_dwordx4 v[152:155], v67, s[12:15], s21 offen
 buffer_load_dwordx4 v[156:159], v68, s[12:15], s21 offen
 buffer_load_dwordx4 v[160:163], v69, s[12:15], s21 offen
 buffer_load_dwordx4 v[164:167], v70, s[12:15], s21 offen
 buffer_load_dwordx4 v[168:171], v71, s[12:15], s21 offen
 buffer_load_dwordx4 v[172:175], v72, s[12:15], s21 offen
 buffer_load_dwordx4 v[176:179], v73, s[12:15], s21 offen
 buffer_load_dwordx4 v[180:183], v74, s[12:15], s21 offen
 buffer_load_dwordx4 v[184:187], v75, s[12:15], s21 offen
 buffer_load_dwordx4 v[188:191], v76, s[12:15], s21 offen
 buffer_load_dwordx4 v[192:195], v77, s[12:15], s21 offen
 buffer_load_dwordx4 v[196:199], v78, s[12:15], s21 offen
 v_lshrrev_b32 v6, 2, v2
 v_lshl_add_u32 v7, v3, 3, v6
 v_mul_u32_u24 v7, 1280, v7
 v_and_b32 v8, 1, v2
 v_lshl_add_u32 v7, v8, 3, v7
 v_and_b32 v8, 1, v3
 v_lshl_add_u32 v6, v8, 2, v6
 v_lshlrev_b32 v6, 1, v6
 v_bfe_u32 v8, v2, 1, 1
 s_mul_i32 s21, s20, 20
 v_add_u32 v8, s21, v8
 v_add_u32 v5, 0, v8
 v_xor_b32 v5, v5, v6
 v_lshl_add_u32 v200, v5, 4, v7
 v_add_u32 v210, 81920, v200
 v_add_u32 v5, 2, v8
 v_xor_b32 v5, v5, v6
 v_lshl_add_u32 v201, v5, 4, v7
 v_add_u32 v211, 81920, v201
 v_add_u32 v5, 4, v8
 v_xor_b32 v5, v5, v6
 v_lshl_add_u32 v202, v5, 4, v7
 v_add_u32 v212, 81920, v202
 v_add_u32 v5, 6, v8
 v_xor_b32 v5, v5, v6
 v_lshl_add_u32 v203, v5, 4, v7
 v_add_u32 v213, 81920, v203
 v_add_u32 v5, 8, v8
 v_xor_b32 v5, v5, v6
 v_lshl_add_u32 v204, v5, 4, v7
 v_add_u32 v214, 81920, v204
 v_add_u32 v5, 10, v8
 v_xor_b32 v5, v5, v6
 v_lshl_add_u32 v205, v5, 4, v7
 v_add_u32 v215, 81920, v205
 v_add_u32 v5, 12, v8
 v_xor_b32 v5, v5, v6
 v_lshl_add_u32 v206, v5, 4, v7
 v_add_u32 v216, 81920, v206
 v_add_u32 v5, 14, v8
 v_xor_b32 v5, v5, v6
 v_lshl_add_u32 v207, v5, 4, v7
 v_add_u32 v217, 81920, v207
 v_add_u32 v5, 16, v8
 v_xor_b32 v5, v5, v6
 v_lshl_add_u32 v208, v5, 4, v7
 v_add_u32 v218, 81920, v208
 v_add_u32 v5, 18, v8
 v_xor_b32 v5, v5, v6
 v_lshl_add_u32 v209, v5, 4, v7
 v_add_u32 v219, 81920, v209
 s_mul_i32 s22, s20, 15360
 v_lshl_add_u32 v30, v1, 4, s22
 v_add_u32 v31, 61440, v30
 s_waitcnt vmcnt(30)
 s_barrier
 ds_read_b64_tr_b16 a[0:1], v200 offset:0
 ds_read_b64_tr_b16 a[2:3], v200 offset:5120
 ds_read_b64_tr_b16 a[24:25], v201 offset:0
 ds_read_b64_tr_b16 a[26:27], v201 offset:5120
 ds_read_b64_tr_b16 a[48:49], v202 offset:0
 ds_read_b64_tr_b16 a[50:51], v202 offset:5120
 ds_read_b64_tr_b16 a[72:73], v203 offset:0
 ds_read_b64_tr_b16 a[74:75], v203 offset:5120
 ds_read_b64_tr_b16 a[96:97], v204 offset:0
 ds_read_b64_tr_b16 a[98:99], v204 offset:5120
 ds_read_b64_tr_b16 a[120:121], v205 offset:0
 ds_read_b64_tr_b16 a[122:123], v205 offset:5120
 ds_read_b64_tr_b16 a[144:145], v206 offset:0
 ds_read_b64_tr_b16 a[146:147], v206 offset:5120
 ds_read_b64_tr_b16 a[168:169], v207 offset:0
 ds_read_b64_tr_b16 a[170:171], v207 offset:5120
 ds_read_b64_tr_b16 a[192:193], v208 offset:0
 ds_read_b64_tr_b16 a[194:195], v208 offset:5120
 ds_read_b64_tr_b16 a[216:217], v209 offset:0
 ds_read_b64_tr_b16 a[218:219], v209 offset:5120
 ds_read_b64_tr_b16 a[4:5], v200 offset:40960
 ds_read_b64_tr_b16 a[6:7], v200 offset:46080
 ds_read_b64_tr_b16 a[28:29], v201 offset:40960
 ds_read_b64_tr_b16 a[30:31], v201 offset:46080
 ds_read_b64_tr_b16 a[52:53], v202 offset:40960
 ds_read_b64_tr_b16 a[54:55], v202 offset:46080
 ds_read_b64_tr_b16 a[76:77], v203 offset:40960
 ds_read_b64_tr_b16 a[78:79], v203 offset:46080
 ds_read_b64_tr_b16 a[100:101], v204 offset:40960
 ds_read_b64_tr_b16 a[102:103], v204 offset:46080
 ds_read_b64_tr_b16 a[124:125], v205 offset:40960
 ds_read_b64_tr_b16 a[126:127], v205 offset:46080
 ds_read_b64_tr_b16 a[148:149], v206 offset:40960
 ds_read_b64_tr_b16 a[150:151], v206 offset:46080
 ds_read_b64_tr_b16 a[172:173], v207 offset:40960
 ds_read_b64_tr_b16 a[174:175], v207 offset:46080
 ds_read_b64_tr_b16 a[196:197], v208 offset:40960
 ds_read_b64_tr_b16 a[198:199], v208 offset:46080
 ds_read_b64_tr_b16 a[220:221], v209 offset:40960
 ds_read_b64_tr_b16 a[222:223], v209 offset:46080
 ds_read_b64_tr_b16 a[8:9], v210 offset:0
 ds_read_b64_tr_b16 a[10:11], v210 offset:5120
 ds_read_b64_tr_b16 a[32:33], v211 offset:0
 ds_read_b64_tr_b16 a[34:35], v211 offset:5120
 ds_read_b64_tr_b16 a[56:57], v212 offset:0
 ds_read_b64_tr_b16 a[58:59], v212 offset:5120
 ds_read_b64_tr_b16 a[80:81], v213 offset:0
 ds_read_b64_tr_b16 a[82:83], v213 offset:5120
 ds_read_b64_tr_b16 a[104:105], v214 offset:0
 ds_read_b64_tr_b16 a[106:107], v214 offset:5120
 ds_read_b64_tr_b16 a[128:129], v215 offset:0
 ds_read_b64_tr_b16 a[130:131], v215 offset:5120
 ds_read_b64_tr_b16 a[152:153], v216 offset:0
 ds_read_b64_tr_b16 a[154:155], v216 offset:5120
 ds_read_b64_tr_b16 a[176:177], v217 offset:0
 ds_read_b64_tr_b16 a[178:179], v217 offset:5120
 ds_read_b64_tr_b16 a[200:201], v218 offset:0
 ds_read_b64_tr_b16 a[202:203], v218 offset:5120
 ds_read_b64_tr_b16 a[224:225], v219 offset:0
 ds_read_b64_tr_b16 a[226:227], v219 offset:5120
 s_waitcnt lgkmcnt(0)
 s_barrier
 s_waitcnt vmcnt(15)
 ds_write_b128 v30, v[80:83] offset:0
 ds_write_b128 v30, v[84:87] offset:1024
 ds_write_b128 v30, v[88:91] offset:2048
 ds_write_b128 v30, v[92:95] offset:3072
 ds_write_b128 v30, v[96:99] offset:4096
 ds_write_b128 v30, v[100:103] offset:5120
 ds_write_b128 v30, v[104:107] offset:6144
 ds_write_b128 v30, v[108:111] offset:7168
 ds_write_b128 v30, v[112:115] offset:8192
 ds_write_b128 v30, v[116:119] offset:9216
 ds_write_b128 v30, v[120:123] offset:10240
 ds_write_b128 v30, v[124:127] offset:11264
 ds_write_b128 v30, v[128:131] offset:12288
 ds_write_b128 v30, v[132:135] offset:13312
 ds_write_b128 v30, v[136:139] offset:14336
 s_waitcnt vmcnt(0)
 ds_write_b128 v31, v[140:143] offset:0
 ds_write_b128 v31, v[144:147] offset:1024
 ds_write_b128 v31, v[148:151] offset:2048
 ds_write_b128 v31, v[152:155] offset:3072
 ds_write_b128 v31, v[156:159] offset:4096
 ds_write_b128 v31, v[160:163] offset:5120
 ds_write_b128 v31, v[164:167] offset:6144
 ds_write_b128 v31, v[168:171] offset:7168
 ds_write_b128 v31, v[172:175] offset:8192
 ds_write_b128 v31, v[176:179] offset:9216
 ds_write_b128 v31, v[180:183] offset:10240
 ds_write_b128 v31, v[184:187] offset:11264
 ds_write_b128 v31, v[188:191] offset:12288
 ds_write_b128 v31, v[192:195] offset:13312
 ds_write_b128 v31, v[196:199] offset:14336
 s_waitcnt lgkmcnt(0)
 s_barrier
 ds_read_b64_tr_b16 a[12:13], v200 offset:0
 ds_read_b64_tr_b16 a[14:15], v200 offset:5120
 ds_read_b64_tr_b16 a[36:37], v201 offset:0
 ds_read_b64_tr_b16 a[38:39], v201 offset:5120
 ds_read_b64_tr_b16 a[60:61], v202 offset:0
 ds_read_b64_tr_b16 a[62:63], v202 offset:5120
 ds_read_b64_tr_b16 a[84:85], v203 offset:0
 ds_read_b64_tr_b16 a[86:87], v203 offset:5120
 ds_read_b64_tr_b16 a[108:109], v204 offset:0
 ds_read_b64_tr_b16 a[110:111], v204 offset:5120
 ds_read_b64_tr_b16 a[132:133], v205 offset:0
 ds_read_b64_tr_b16 a[134:135], v205 offset:5120
 ds_read_b64_tr_b16 a[156:157], v206 offset:0
 ds_read_b64_tr_b16 a[158:159], v206 offset:5120
 ds_read_b64_tr_b16 a[180:181], v207 offset:0
 ds_read_b64_tr_b16 a[182:183], v207 offset:5120
 ds_read_b64_tr_b16 a[204:205], v208 offset:0
 ds_read_b64_tr_b16 a[206:207], v208 offset:5120
 ds_read_b64_tr_b16 a[228:229], v209 offset:0
 ds_read_b64_tr_b16 a[230:231], v209 offset:5120
 ds_read_b64_tr_b16 a[16:17], v200 offset:40960
 ds_read_b64_tr_b16 a[18:19], v200 offset:46080
 ds_read_b64_tr_b16 a[40:41], v201 offset:40960
 ds_read_b64_tr_b16 a[42:43], v201 offset:46080
 ds_read_b64_tr_b16 a[64:65], v202 offset:40960
 ds_read_b64_tr_b16 a[66:67], v202 offset:46080
 ds_read_b64_tr_b16 a[88:89], v203 offset:40960
 ds_read_b64_tr_b16 a[90:91], v203 offset:46080
 ds_read_b64_tr_b16 a[112:113], v204 offset:40960
 ds_read_b64_tr_b16 a[114:115], v204 offset:46080
 ds_read_b64_tr_b16 a[136:137], v205 offset:40960
 ds_read_b64_tr_b16 a[138:139], v205 offset:46080
 ds_read_b64_tr_b16 a[160:161], v206 offset:40960
 ds_read_b64_tr_b16 a[162:163], v206 offset:46080
 ds_read_b64_tr_b16 a[184:185], v207 offset:40960
 ds_read_b64_tr_b16 a[186:187], v207 offset:46080
 ds_read_b64_tr_b16 a[208:209], v208 offset:40960
 ds_read_b64_tr_b16 a[210:211], v208 offset:46080
 ds_read_b64_tr_b16 a[232:233], v209 offset:40960
 ds_read_b64_tr_b16 a[234:235], v209 offset:46080
 ds_read_b64_tr_b16 a[20:21], v210 offset:0
 ds_read_b64_tr_b16 a[22:23], v210 offset:5120
 ds_read_b64_tr_b16 a[44:45], v211 offset:0
 ds_read_b64_tr_b16 a[46:47], v211 offset:5120
 ds_read_b64_tr_b16 a[68:69], v212 offset:0
 ds_read_b64_tr_b16 a[70:71], v212 offset:5120
 ds_read_b64_tr_b16 a[92:93], v213 offset:0
 ds_read_b64_tr_b16 a[94:95], v213 offset:5120
 ds_read_b64_tr_b16 a[116:117], v214 offset:0
 ds_read_b64_tr_b16 a[118:119], v214 offset:5120
 ds_read_b64_tr_b16 a[140:141], v215 offset:0
 ds_read_b64_tr_b16 a[142:143], v215 offset:5120
 ds_read_b64_tr_b16 a[164:165], v216 offset:0
 ds_read_b64_tr_b16 a[166:167], v216 offset:5120
 ds_read_b64_tr_b16 a[188:189], v217 offset:0
 ds_read_b64_tr_b16 a[190:191], v217 offset:5120
 ds_read_b64_tr_b16 a[212:213], v218 offset:0
 ds_read_b64_tr_b16 a[214:215], v218 offset:5120
 ds_read_b64_tr_b16 a[236:237], v219 offset:0
 ds_read_b64_tr_b16 a[238:239], v219 offset:5120
 s_waitcnt lgkmcnt(0)
 s_barrier
 s_load_dwordx2 s[32:33], s[0:1], 96
 s_waitcnt lgkmcnt(0)
 s_mov_b32 s32, s32
 s_mov_b32 s33, s33
 s_mov_b32 s34, 256
 s_mov_b32 s35, 0x00020000
 s_mov_b32 s21, 76
 s_cmp_lg_u32 s20, 0
 s_cbranch_scc1 wf_137
 v_mov_b32 v4, 0
 s_mov_b32 s101, 0
wf_136:
 buffer_load_dword v5, v4, s[32:35], s21 offen sc1
 s_add_u32 s101, s101, 1
 s_cmp_gt_u32 s101, 131072
 s_cbranch_scc1 main_end
 s_waitcnt vmcnt(0)
 v_readfirstlane_b32 s100, v5
 s_cmp_ge_u32 s100, 32
 s_cbranch_scc1 wf_137
 s_sleep 8
 s_branch wf_136
wf_137:
 s_barrier
 s_mul_i32 s41, s2, 12288
 s_add_u32 s47, s41, 25165824
 s_mov_b32 s41, s47
 s_mul_i32 s21, s20, 10
 s_mul_i32 s47, s2, 5
 s_lshr_b32 s22, s21, 3
 s_add_u32 s47, s47, s22
 s_and_b32 s48, s21, 7
 s_mov_b32 s66, 0
 s_mov_b32 s67, 0
 s_lshr_b32 s43, s2, 2
 s_lshl_b32 s43, s43, 7
 s_add_u32 s43, s43, 0
 s_lshl_b32 s44, s2, 7
 s_lshl_b32 s21, s20, 12
 s_add_u32 s44, s44, s21
 s_add_u32 s44, s44, 94208
 s_mov_b32 s45, 0
 s_mov_b32 s49, 1
 s_mov_b32 s50, 0
 v_mov_b32 v10, 0
 v_mov_b32 v11, 1
 v_lshlrev_b32 v4, 4, v1
 s_add_u32 s76, s38, 56623104
 s_addc_u32 s77, s39, 0
 s_mov_b32 s78, 6291456
 s_mov_b32 s79, 0x00020000
 s_add_u32 s80, s38, 101711872
 s_addc_u32 s81, s39, 0
 s_mov_b32 s82, 20971520
 s_mov_b32 s83, 0x00020000
 v_and_b32 v12, 3, v1
 v_lshlrev_b32 v12, 3, v12
 v_add_u32 v12, 4, v12
 v_and_b32 v13, 7, v2
 v_lshlrev_b32 v13, 4, v13
 v_lshl_add_u32 v13, v3, 7, v13
 v_lshrrev_b32 v14, 3, v2
 v_mul_u32_u24 v14, 98304, v14
 v_add_u32 v14, v14, v13
 v_and_b32 v15, 1, v3
 v_lshlrev_b32 v15, 8, v15
 v_lshl_add_u32 v15, v2, 4, v15
 v_lshrrev_b32 v16, 1, v3
 v_mul_u32_u24 v16, 327680, v16
 v_add_u32 v15, v15, v16
 v_lshlrev_b32 v17, 10, v1
 v_mov_b32 v19, 0
 s_lshl_b32 s53, s2, 7
 s_add_u32 s53, s53, 18432
 s_mov_b32 s55, 0
 s_mov_b32 s56, 0
 s_mov_b32 s58, 0
 s_mov_b32 s59, 0
 s_add_u32 s84, s38, 50331648
 s_addc_u32 s85, s39, 0
 s_mov_b32 s86, 12582912
 s_mov_b32 s87, 0x00020000
 s_and_b32 s21, s2, 3
 s_mul_i32 s51, s2, 3072
 s_cmp_eq_u32 s21, s20
 s_cselect_b32 s51, s51, 6291456
 v_mov_b32 v244, -1
 v_mov_b32 v245, -1
 v_mov_b32 v246, -1
 v_mov_b32 v247, -1
 s_add_u32 s88, s38, 85983232
 s_addc_u32 s89, s39, 0
 s_mov_b32 s90, 5242880
 s_mov_b32 s91, 0x00020000
 s_mul_i32 s21, s20, 3072
 s_add_u32 s41, s41, s21
 s_mov_b32 s64, s21
 s_add_u32 s67, s21, 98304
 s_mov_b32 s71, s21
 s_mov_b32 s46, 0
 s_mov_b32 s47, 0
 s_mov_b32 s65, 0
 s_mul_i32 s42, s2, 40960
 s_mul_i32 s21, s20, 10240
 s_add_u32 s42, s42, s21
 s_mov_b32 s68, 0x80000000
 s_mov_b32 s70, 0
 s_mov_b32 s40, 0
 s_mov_b32 s31, 0
 s_mov_b32 s56, s68
 s_mov_b32 s57, s68
 s_lshl_b32 s59, s20, 1
 s_sub_u32 s59, 8, s59
 s_add_u32 s61, s28, 9216
 v_min_u32 v5, 17, v1
 v_lshlrev_b32 v5, 10, v5
 v_mov_b32 v9, 0
 s_lshl_b32 s21, s20, 2
 s_add_u32 s21, s21, 110592
 v_mov_b32 v6, s21
 v_mov_b32 v7, 110592
 s_mul_i32 s51, s2, 3072
 s_lshl_b32 s21, s20, 10
 s_add_u32 s51, s51, s21
 s_cmp_lt_u32 s20, 3
 s_cselect_b32 s51, s51, 6291456
 s_add_u32 s51, s51, 5701632
 s_cmp_lg_u32 s20, 0
 s_cbranch_scc1 wf_139
 v_mov_b32 v20, 0
 s_mov_b32 s101, 0
wf_138:
 buffer_load_dword v21, v20, s[72:75], s43 offen sc1
 s_add_u32 s101, s101, 1
 s_cmp_gt_u32 s101, 131072
 s_cbranch_scc1 main_end
 s_waitcnt vmcnt(0)
 v_readfirstlane_b32 s100, v21
 s_cmp_ge_u32 s100, 8
 s_cbranch_scc1 wf_139
 s_sleep 4
 s_branch wf_138
wf_139:
 s_barrier
 v_writelane_b32 v9, 8, 0
 v_cmp_gt_u32 vcc, 8, v9
 s_nop 0
 s_bitset1_b64 vcc, 18
 s_ff1_i32_b64 s21, vcc
 s_lshl_b32 s22, s21, 1
 s_lshl_b32 s21, s21, 2
 s_sub_i32 s21, s21, 8
 s_max_i32 s47, s21, s22
 s_cmp_gt_u32 s47, s45
 s_cbranch_scc1 va_140
 s_mov_b32 s101, 0
 s_branch va_143
va_141:
 s_sleep 8
va_143:
 buffer_load_dword v9, v5, s[72:75], s43 offen sc1
 s_add_u32 s101, s101, 1
 s_cmp_gt_u32 s101, 131072
 s_cbranch_scc1 main_end
 s_waitcnt vmcnt(0)
 v_cmp_gt_u32 vcc, 8, v9
 s_nop 0
 s_bitset1_b64 vcc, 18
 s_ff1_i32_b64 s21, vcc
 s_lshl_b32 s22, s21, 1
 s_lshl_b32 s21, s21, 2
 s_sub_i32 s21, s21, 8
 s_max_i32 s47, s21, s22
 s_cmp_gt_u32 s47, s45
 s_cbranch_scc0 va_141
va_140:
 s_add_u32 s22, s45, 6
 s_min_u32 s22, s22, s47
va_142:
 s_cmp_ge_u32 s46, s22
 s_cbranch_scc1 va_144
 s_mov_b32 m0, s64
 s_mov_b32 s66, s41
 buffer_load_dwordx4 v4, s[16:19], s66 offen offset:0 sc1 lds
 buffer_load_dwordx4 v4, s[16:19], s66 offen offset:1024 sc1 lds
 buffer_load_dwordx4 v4, s[16:19], s66 offen offset:2048 sc1 lds
 s_add_u32 s46, s46, 1
 s_add_u32 s41, s41, 393216
 s_add_u32 s64, s64, 12288
 s_cmp_lt_u32 s64, s67
 s_cselect_b32 s64, s64, s71
 s_branch va_142
va_144:
 s_mov_b32 s48, s46
 s_mov_b32 s49, s46
 s_mov_b32 s50, s46
 s_waitcnt vmcnt(0)
 s_barrier
 v_mov_b32 v8, v4
 s_add_u32 s65, s65, 12288
 s_cmp_lt_u32 s65, 98304
 s_cselect_b32 s65, s65, 0
 ds_read_b128 v[144:147], v8 offset:0
 ds_read_b128 v[148:151], v8 offset:1024
 ds_read_b128 v[152:155], v8 offset:2048
 ds_read_b128 v[156:159], v8 offset:3072
 ds_read_b128 v[160:163], v8 offset:4096
 ds_read_b128 v[164:167], v8 offset:5120
 ds_read_b128 v[168:171], v8 offset:6144
 ds_read_b128 v[172:175], v8 offset:7168
 ds_read_b128 v[176:179], v8 offset:8192
 ds_read_b128 v[180:183], v8 offset:9216
 ds_read_b128 v[184:187], v8 offset:10240
 ds_read_b128 v[188:191], v8 offset:11264
vwl_145:
 s_waitcnt lgkmcnt(0)
 v_mfma_f32_16x16x32_bf16 v[64:67], v[144:147], a[0:3], 0
 v_cmp_gt_u32 vcc, 8, v9
 s_nop 0
 v_mfma_f32_16x16x32_bf16 v[72:75], v[144:147], a[24:27], 0
 s_bitset1_b64 vcc, 18
 s_ff1_i32_b64 s21, vcc
 v_mfma_f32_16x16x32_bf16 v[80:83], v[144:147], a[48:51], 0
 s_lshl_b32 s22, s21, 1
 s_lshl_b32 s21, s21, 2
 v_mfma_f32_16x16x32_bf16 v[88:91], v[144:147], a[72:75], 0
 s_sub_i32 s21, s21, 8
 s_max_i32 s47, s21, s22
 v_mfma_f32_16x16x32_bf16 v[96:99], v[144:147], a[96:99], 0
 s_add_u32 s22, s45, 7
 s_min_u32 s22, s22, s47
 v_mfma_f32_16x16x32_bf16 v[68:71], v[168:171], a[0:3], 0
 s_cmp_lt_u32 s46, s22
 s_cselect_b32 s66, s41, 0x80000000
 s_cselect_b32 m0, s64, 98304
 s_cselect_b32 s22, 1, 0
 v_mfma_f32_16x16x32_bf16 v[76:79], v[168:171], a[24:27], 0
 buffer_load_dwordx4 v4, s[16:19], s66 offen offset:0 sc1 lds
 v_mfma_f32_16x16x32_bf16 v[84:87], v[168:171], a[48:51], 0
 v_add_u32 v8, s65, v4
 s_add_u32 s65, s65, 12288
 v_mfma_f32_16x16x32_bf16 v[92:95], v[168:171], a[72:75], 0
 buffer_load_dwordx4 v4, s[16:19], s66 offen offset:1024 sc1 lds
 v_mfma_f32_16x16x32_bf16 v[100:103], v[168:171], a[96:99], 0
 s_cmp_lt_u32 s65, 98304
 s_cselect_b32 s65, s65, 0
 v_mfma_f32_16x16x32_bf16 v[64:67], v[148:151], a[4:7], v[64:67]
 buffer_load_dwordx4 v4, s[16:19], s66 offen offset:2048 sc1 lds
 v_mfma_f32_16x16x32_bf16 v[72:75], v[148:151], a[28:31], v[72:75]
 s_add_u32 s46, s46, s22
 s_mul_i32 s21, s22, 393216
 v_mfma_f32_16x16x32_bf16 v[80:83], v[148:151], a[52:55], v[80:83]
 s_add_u32 s41, s41, s21
 s_mul_i32 s21, s22, 12288
 v_mfma_f32_16x16x32_bf16 v[88:91], v[148:151], a[76:79], v[88:91]
 s_add_u32 s64, s64, s21
 v_cvt_pk_bf16_f32 v44, v104, v105
 v_mfma_f32_16x16x32_bf16 v[96:99], v[148:151], a[100:103], v[96:99]
 s_cmp_lt_u32 s64, s67
 s_cselect_b32 s64, s64, s71
 v_mfma_f32_16x16x32_bf16 v[68:71], v[172:175], a[4:7], v[68:71]
 v_cvt_pk_bf16_f32 v45, v106, v107
 v_cvt_pk_bf16_f32 v46, v108, v109
 v_mfma_f32_16x16x32_bf16 v[76:79], v[172:175], a[28:31], v[76:79]
 v_cvt_pk_bf16_f32 v47, v110, v111
 v_mfma_f32_16x16x32_bf16 v[84:87], v[172:175], a[52:55], v[84:87]
 s_add_u32 s69, s68, 4096
 v_mfma_f32_16x16x32_bf16 v[92:95], v[172:175], a[76:79], v[92:95]
 v_mfma_f32_16x16x32_bf16 v[100:103], v[172:175], a[100:103], v[100:103]
 buffer_store_dwordx4 v[44:47], v4, s[24:27], s69 offen offset:1024 sc1
 v_mfma_f32_16x16x32_bf16 v[64:67], v[152:155], a[8:11], v[64:67]
 v_mfma_f32_16x16x32_bf16 v[72:75], v[152:155], a[32:35], v[72:75]
 v_cvt_pk_bf16_f32 v48, v112, v113
 v_mfma_f32_16x16x32_bf16 v[80:83], v[152:155], a[56:59], v[80:83]
 v_cvt_pk_bf16_f32 v49, v114, v115
 v_mfma_f32_16x16x32_bf16 v[88:91], v[152:155], a[80:83], v[88:91]
 v_mfma_f32_16x16x32_bf16 v[96:99], v[152:155], a[104:107], v[96:99]
 v_cvt_pk_bf16_f32 v50, v116, v117
 v_mfma_f32_16x16x32_bf16 v[68:71], v[176:179], a[8:11], v[68:71]
 v_mfma_f32_16x16x32_bf16 v[76:79], v[176:179], a[32:35], v[76:79]
 v_cvt_pk_bf16_f32 v51, v118, v119
 v_mfma_f32_16x16x32_bf16 v[84:87], v[176:179], a[56:59], v[84:87]
 buffer_store_dwordx4 v[48:51], v4, s[24:27], s69 offen offset:2048 sc1
 v_mfma_f32_16x16x32_bf16 v[92:95], v[176:179], a[80:83], v[92:95]
 v_mfma_f32_16x16x32_bf16 v[100:103], v[176:179], a[104:107], v[100:103]
 v_cvt_pk_bf16_f32 v52, v120, v121
 v_mfma_f32_16x16x32_bf16 v[64:67], v[156:159], a[12:15], v[64:67]
 v_mfma_f32_16x16x32_bf16 v[72:75], v[156:159], a[36:39], v[72:75]
 v_cvt_pk_bf16_f32 v53, v122, v123
 v_mfma_f32_16x16x32_bf16 v[80:83], v[156:159], a[60:63], v[80:83]
 v_cvt_pk_bf16_f32 v54, v124, v125
 v_mfma_f32_16x16x32_bf16 v[88:91], v[156:159], a[84:87], v[88:91]
 v_mfma_f32_16x16x32_bf16 v[96:99], v[156:159], a[108:111], v[96:99]
 v_cvt_pk_bf16_f32 v55, v126, v127
 v_mfma_f32_16x16x32_bf16 v[68:71], v[180:183], a[12:15], v[68:71]
 v_mfma_f32_16x16x32_bf16 v[76:79], v[180:183], a[36:39], v[76:79]
 buffer_store_dwordx4 v[52:55], v4, s[24:27], s69 offen offset:3072 sc1
 v_mfma_f32_16x16x32_bf16 v[84:87], v[180:183], a[60:63], v[84:87]
 v_cvt_pk_bf16_f32 v56, v128, v129
 v_mfma_f32_16x16x32_bf16 v[92:95], v[180:183], a[84:87], v[92:95]
 v_mfma_f32_16x16x32_bf16 v[100:103], v[180:183], a[108:111], v[100:103]
 v_cvt_pk_bf16_f32 v57, v130, v131
 v_mfma_f32_16x16x32_bf16 v[64:67], v[160:163], a[16:19], v[64:67]
 s_cmp_lt_u32 s51, 6291456
 s_cselect_b32 s52, s51, 0x80000000
 v_mfma_f32_16x16x32_bf16 v[72:75], v[160:163], a[40:43], v[72:75]
 buffer_store_dwordx4 v[244:247], v4, s[84:87], s52 offen sc1
 v_mfma_f32_16x16x32_bf16 v[80:83], v[160:163], a[64:67], v[80:83]
 s_add_u32 s51, s51, 98304
 v_cvt_pk_bf16_f32 v58, v132, v133
 v_mfma_f32_16x16x32_bf16 v[88:91], v[160:163], a[88:91], v[88:91]
 v_cvt_pk_bf16_f32 v59, v134, v135
 v_mfma_f32_16x16x32_bf16 v[96:99], v[160:163], a[112:115], v[96:99]
 s_add_u32 s69, s68, 8192
 v_mfma_f32_16x16x32_bf16 v[68:71], v[184:187], a[16:19], v[68:71]
 v_mfma_f32_16x16x32_bf16 v[76:79], v[184:187], a[40:43], v[76:79]
 buffer_store_dwordx4 v[56:59], v4, s[24:27], s69 offen offset:0 sc1
 v_mfma_f32_16x16x32_bf16 v[84:87], v[184:187], a[64:67], v[84:87]
 v_cvt_pk_bf16_f32 v60, v136, v137
 v_mfma_f32_16x16x32_bf16 v[92:95], v[184:187], a[88:91], v[92:95]
 v_mfma_f32_16x16x32_bf16 v[100:103], v[184:187], a[112:115], v[100:103]
 v_cvt_pk_bf16_f32 v61, v138, v139
 v_mfma_f32_16x16x32_bf16 v[64:67], v[164:167], a[20:23], v[64:67]
 v_mfma_f32_16x16x32_bf16 v[72:75], v[164:167], a[44:47], v[72:75]
 v_cvt_pk_bf16_f32 v62, v140, v141
 v_mfma_f32_16x16x32_bf16 v[80:83], v[164:167], a[68:71], v[80:83]
 v_cvt_pk_bf16_f32 v63, v142, v143
 v_mfma_f32_16x16x32_bf16 v[88:91], v[164:167], a[92:95], v[88:91]
 v_mfma_f32_16x16x32_bf16 v[96:99], v[164:167], a[116:119], v[96:99]
 buffer_store_dwordx4 v[60:63], v4, s[24:27], s69 offen offset:1024 sc1
 v_mfma_f32_16x16x32_bf16 v[68:71], v[188:191], a[20:23], v[68:71]
 v_mfma_f32_16x16x32_bf16 v[76:79], v[188:191], a[44:47], v[76:79]
 v_mfma_f32_16x16x32_bf16 v[84:87], v[188:191], a[68:71], v[84:87]
 v_mfma_f32_16x16x32_bf16 v[92:95], v[188:191], a[92:95], v[92:95]
 v_mfma_f32_16x16x32_bf16 v[100:103], v[188:191], a[116:119], v[100:103]
 v_mfma_f32_16x16x32_bf16 v[104:107], v[144:147], a[120:123], 0
 buffer_load_dword v9, v5, s[72:75], s43 offen sc1
 v_mfma_f32_16x16x32_bf16 v[112:115], v[144:147], a[144:147], 0
 v_mfma_f32_16x16x32_bf16 v[120:123], v[144:147], a[168:171], 0
 v_mfma_f32_16x16x32_bf16 v[128:131], v[144:147], a[192:195], 0
 v_cvt_pk_bf16_f32 v24, v64, v65
 v_mfma_f32_16x16x32_bf16 v[136:139], v[144:147], a[216:219], 0
 s_add_u32 s63, s45, 1
 s_min_u32 s63, s63, 63
 v_mfma_f32_16x16x32_bf16 v[108:111], v[168:171], a[120:123], 0
 s_cmp_lt_u32 s63, s46
 s_cselect_b32 s53, 1, 0
 v_mfma_f32_16x16x32_bf16 v[116:119], v[168:171], a[144:147], 0
 v_mov_b32 v21, s53
 ds_write_b32 v6, v21 offset:0
 v_mfma_f32_16x16x32_bf16 v[124:127], v[168:171], a[168:171], 0
 v_cvt_pk_bf16_f32 v25, v66, v67
 v_cvt_pk_bf16_f32 v26, v68, v69
 v_mfma_f32_16x16x32_bf16 v[132:135], v[168:171], a[192:195], 0
 v_cvt_pk_bf16_f32 v27, v70, v71
 v_mfma_f32_16x16x32_bf16 v[140:143], v[168:171], a[216:219], 0
 v_mfma_f32_16x16x32_bf16 v[104:107], v[148:151], a[124:127], v[104:107]
 buffer_store_dwordx4 v[24:27], v4, s[24:27], s42 offen offset:0 sc1
 v_mfma_f32_16x16x32_bf16 v[112:115], v[148:151], a[148:151], v[112:115]
 v_cvt_pk_bf16_f32 v28, v72, v73
 v_mfma_f32_16x16x32_bf16 v[120:123], v[148:151], a[172:175], v[120:123]
 s_cmp_eq_u32 s40, 3
 s_cbranch_scc1 vwm_149
vwm_150:
 v_mfma_f32_16x16x32_bf16 v[128:131], v[148:151], a[196:199], v[128:131]
 v_cvt_pk_bf16_f32 v29, v74, v75
 v_mfma_f32_16x16x32_bf16 v[136:139], v[148:151], a[220:223], v[136:139]
 v_mfma_f32_16x16x32_bf16 v[108:111], v[172:175], a[124:127], v[108:111]
 v_cvt_pk_bf16_f32 v30, v76, v77
 v_mfma_f32_16x16x32_bf16 v[116:119], v[172:175], a[148:151], v[116:119]
 v_mfma_f32_16x16x32_bf16 v[124:127], v[172:175], a[172:175], v[124:127]
 v_cvt_pk_bf16_f32 v31, v78, v79
 v_mfma_f32_16x16x32_bf16 v[132:135], v[172:175], a[196:199], v[132:135]
 buffer_store_dwordx4 v[28:31], v4, s[24:27], s42 offen offset:1024 sc1
 v_mfma_f32_16x16x32_bf16 v[140:143], v[172:175], a[220:223], v[140:143]
 s_cmp_lt_u32 s63, s50
 s_cbranch_scc0 vwx_147
vwx_148:
 v_mfma_f32_16x16x32_bf16 v[104:107], v[152:155], a[128:131], v[104:107]
 s_waitcnt lgkmcnt(0)
 s_barrier
 v_mfma_f32_16x16x32_bf16 v[112:115], v[152:155], a[152:155], v[112:115]
 ds_read_b128 v[240:243], v7 offset:0
 v_cvt_pk_bf16_f32 v32, v80, v81
 v_mfma_f32_16x16x32_bf16 v[120:123], v[152:155], a[176:179], v[120:123]
 ds_read_b128 v[192:195], v8 offset:0
 v_cvt_pk_bf16_f32 v33, v82, v83
 v_mfma_f32_16x16x32_bf16 v[128:131], v[152:155], a[200:203], v[128:131]
 v_mfma_f32_16x16x32_bf16 v[136:139], v[152:155], a[224:227], v[136:139]
 ds_read_b128 v[196:199], v8 offset:1024
 v_cvt_pk_bf16_f32 v34, v84, v85
 v_mfma_f32_16x16x32_bf16 v[108:111], v[176:179], a[128:131], v[108:111]
 v_mfma_f32_16x16x32_bf16 v[116:119], v[176:179], a[152:155], v[116:119]
 v_cvt_pk_bf16_f32 v35, v86, v87
 v_mfma_f32_16x16x32_bf16 v[124:127], v[176:179], a[176:179], v[124:127]
 ds_read_b128 v[200:203], v8 offset:2048
 v_mfma_f32_16x16x32_bf16 v[132:135], v[176:179], a[200:203], v[132:135]
 buffer_store_dwordx4 v[32:35], v4, s[24:27], s42 offen offset:2048 sc1
 v_mfma_f32_16x16x32_bf16 v[140:143], v[176:179], a[224:227], v[140:143]
 ds_read_b128 v[204:207], v8 offset:3072
 v_cvt_pk_bf16_f32 v36, v88, v89
 v_mfma_f32_16x16x32_bf16 v[104:107], v[156:159], a[132:135], v[104:107]
 v_mfma_f32_16x16x32_bf16 v[112:115], v[156:159], a[156:159], v[112:115]
 v_cvt_pk_bf16_f32 v37, v90, v91
 v_mfma_f32_16x16x32_bf16 v[120:123], v[156:159], a[180:183], v[120:123]
 ds_read_b128 v[208:211], v8 offset:4096
 v_mfma_f32_16x16x32_bf16 v[128:131], v[156:159], a[204:207], v[128:131]
 v_cvt_pk_bf16_f32 v38, v92, v93
 v_mfma_f32_16x16x32_bf16 v[136:139], v[156:159], a[228:231], v[136:139]
 ds_read_b128 v[212:215], v8 offset:5120
 s_waitcnt lgkmcnt(4)
 v_mfma_f32_16x16x32_bf16 v[108:111], v[180:183], a[132:135], v[108:111]
 v_bitop3_b32 v240, v240, v241, v242 bitop3:0x80
 v_and_b32 v240, v240, v243
 v_mfma_f32_16x16x32_bf16 v[116:119], v[180:183], a[156:159], v[116:119]
 s_nop 0
 v_readfirstlane_b32 s23, v240
 v_mfma_f32_16x16x32_bf16 v[124:127], v[180:183], a[180:183], v[124:127]
 ds_read_b128 v[216:219], v8 offset:6144
 v_cvt_pk_bf16_f32 v39, v94, v95
 v_mfma_f32_16x16x32_bf16 v[132:135], v[180:183], a[204:207], v[132:135]
 buffer_store_dwordx4 v[36:39], v4, s[24:27], s42 offen offset:3072 sc1
 v_mfma_f32_16x16x32_bf16 v[140:143], v[180:183], a[228:231], v[140:143]
 ds_read_b128 v[220:223], v8 offset:7168
 v_cvt_pk_bf16_f32 v40, v96, v97
 v_mfma_f32_16x16x32_bf16 v[104:107], v[160:163], a[136:139], v[104:107]
 v_cvt_pk_bf16_f32 v41, v98, v99
 v_mfma_f32_16x16x32_bf16 v[112:115], v[160:163], a[160:163], v[112:115]
 v_cvt_pk_bf16_f32 v42, v100, v101
 v_mfma_f32_16x16x32_bf16 v[120:123], v[160:163], a[184:187], v[120:123]
 ds_read_b128 v[224:227], v8 offset:8192
 v_mfma_f32_16x16x32_bf16 v[128:131], v[160:163], a[208:211], v[128:131]
 v_cvt_pk_bf16_f32 v43, v102, v103
 v_mfma_f32_16x16x32_bf16 v[136:139], v[160:163], a[232:235], v[136:139]
 ds_read_b128 v[228:231], v8 offset:9216
 v_mfma_f32_16x16x32_bf16 v[108:111], v[184:187], a[136:139], v[108:111]
 s_add_u32 s69, s42, 4096
 v_mfma_f32_16x16x32_bf16 v[116:119], v[184:187], a[160:163], v[116:119]
 v_mfma_f32_16x16x32_bf16 v[124:127], v[184:187], a[184:187], v[124:127]
 ds_read_b128 v[232:235], v8 offset:10240
 v_mfma_f32_16x16x32_bf16 v[132:135], v[184:187], a[208:211], v[132:135]
 buffer_store_dwordx4 v[40:43], v4, s[24:27], s69 offen offset:0 sc1
 v_mfma_f32_16x16x32_bf16 v[140:143], v[184:187], a[232:235], v[140:143]
 ds_read_b128 v[236:239], v8 offset:11264
 v_mfma_f32_16x16x32_bf16 v[104:107], v[164:167], a[140:143], v[104:107]
 v_mfma_f32_16x16x32_bf16 v[112:115], v[164:167], a[164:167], v[112:115]
 v_mfma_f32_16x16x32_bf16 v[120:123], v[164:167], a[188:191], v[120:123]
 s_waitcnt vmcnt(12)
 s_mov_b32 s50, s46
 s_add_u32 s69, s45, s40
 v_mfma_f32_16x16x32_bf16 v[128:131], v[164:167], a[212:215], v[128:131]
 s_mov_b32 s40, 0
 s_sub_i32 s69, s69, 1
 s_max_i32 s69, s69, s70
 v_mfma_f32_16x16x32_bf16 v[136:139], v[164:167], a[236:239], v[136:139]
 s_add_u32 s45, s45, 1
 s_mov_b32 s68, s42
 s_add_u32 s42, s42, 1310720
 v_mfma_f32_16x16x32_bf16 v[108:111], v[188:191], a[140:143], v[108:111]
 v_mfma_f32_16x16x32_bf16 v[116:119], v[188:191], a[164:167], v[116:119]
 v_mfma_f32_16x16x32_bf16 v[124:127], v[188:191], a[188:191], v[124:127]
 v_mfma_f32_16x16x32_bf16 v[132:135], v[188:191], a[212:215], v[132:135]
 v_mfma_f32_16x16x32_bf16 v[140:143], v[188:191], a[236:239], v[140:143]
 s_mov_b64 exec, 1
 v_mov_b32 v20, s69
 buffer_store_dword v20, v10, s[72:75], s44 offen sc1
 s_mov_b64 exec, -1
 s_cmp_le_u32 s45, 16
 s_cbranch_scc1 vwe_153
vwe_154:
 s_cmp_eq_u32 s23, 0
 s_cbranch_scc1 vws_151
vwb_152:
 s_waitcnt lgkmcnt(0)
 v_mfma_f32_16x16x32_bf16 v[64:67], v[192:195], a[0:3], 0
 v_cmp_gt_u32 vcc, 8, v9
 s_nop 0
 v_mfma_f32_16x16x32_bf16 v[72:75], v[192:195], a[24:27], 0
 s_bitset1_b64 vcc, 18
 s_ff1_i32_b64 s21, vcc
 v_mfma_f32_16x16x32_bf16 v[80:83], v[192:195], a[48:51], 0
 s_lshl_b32 s22, s21, 1
 s_lshl_b32 s21, s21, 2
 v_mfma_f32_16x16x32_bf16 v[88:91], v[192:195], a[72:75], 0
 s_sub_i32 s21, s21, 8
 s_max_i32 s47, s21, s22
 v_mfma_f32_16x16x32_bf16 v[96:99], v[192:195], a[96:99], 0
 s_add_u32 s22, s45, 7
 s_min_u32 s22, s22, s47
 v_mfma_f32_16x16x32_bf16 v[68:71], v[216:219], a[0:3], 0
 s_cmp_lt_u32 s46, s22
 s_cselect_b32 s66, s41, 0x80000000
 s_cselect_b32 m0, s64, 98304
 s_cselect_b32 s22, 1, 0
 v_mfma_f32_16x16x32_bf16 v[76:79], v[216:219], a[24:27], 0
 buffer_load_dwordx4 v4, s[16:19], s66 offen offset:0 sc1 lds
 v_mfma_f32_16x16x32_bf16 v[84:87], v[216:219], a[48:51], 0
 v_add_u32 v8, s65, v4
 s_add_u32 s65, s65, 12288
 v_mfma_f32_16x16x32_bf16 v[92:95], v[216:219], a[72:75], 0
 buffer_load_dwordx4 v4, s[16:19], s66 offen offset:1024 sc1 lds
 v_mfma_f32_16x16x32_bf16 v[100:103], v[216:219], a[96:99], 0
 s_cmp_lt_u32 s65, 98304
 s_cselect_b32 s65, s65, 0
 v_mfma_f32_16x16x32_bf16 v[64:67], v[196:199], a[4:7], v[64:67]
 buffer_load_dwordx4 v4, s[16:19], s66 offen offset:2048 sc1 lds
 v_mfma_f32_16x16x32_bf16 v[72:75], v[196:199], a[28:31], v[72:75]
 s_add_u32 s46, s46, s22
 s_mul_i32 s21, s22, 393216
 v_mfma_f32_16x16x32_bf16 v[80:83], v[196:199], a[52:55], v[80:83]
 s_add_u32 s41, s41, s21
 s_mul_i32 s21, s22, 12288
 v_mfma_f32_16x16x32_bf16 v[88:91], v[196:199], a[76:79], v[88:91]
 s_add_u32 s64, s64, s21
 v_cvt_pk_bf16_f32 v44, v104, v105
 v_mfma_f32_16x16x32_bf16 v[96:99], v[196:199], a[100:103], v[96:99]
 s_cmp_lt_u32 s64, s67
 s_cselect_b32 s64, s64, s71
 v_mfma_f32_16x16x32_bf16 v[68:71], v[220:223], a[4:7], v[68:71]
 v_cvt_pk_bf16_f32 v45, v106, v107
 v_cvt_pk_bf16_f32 v46, v108, v109
 v_mfma_f32_16x16x32_bf16 v[76:79], v[220:223], a[28:31], v[76:79]
 v_cvt_pk_bf16_f32 v47, v110, v111
 v_mfma_f32_16x16x32_bf16 v[84:87], v[220:223], a[52:55], v[84:87]
 s_add_u32 s69, s68, 4096
 v_mfma_f32_16x16x32_bf16 v[92:95], v[220:223], a[76:79], v[92:95]
 v_mfma_f32_16x16x32_bf16 v[100:103], v[220:223], a[100:103], v[100:103]
 buffer_store_dwordx4 v[44:47], v4, s[24:27], s69 offen offset:1024 sc1
 v_mfma_f32_16x16x32_bf16 v[64:67], v[200:203], a[8:11], v[64:67]
 v_mfma_f32_16x16x32_bf16 v[72:75], v[200:203], a[32:35], v[72:75]
 v_cvt_pk_bf16_f32 v48, v112, v113
 v_mfma_f32_16x16x32_bf16 v[80:83], v[200:203], a[56:59], v[80:83]
 v_cvt_pk_bf16_f32 v49, v114, v115
 v_mfma_f32_16x16x32_bf16 v[88:91], v[200:203], a[80:83], v[88:91]
 v_mfma_f32_16x16x32_bf16 v[96:99], v[200:203], a[104:107], v[96:99]
 v_cvt_pk_bf16_f32 v50, v116, v117
 v_mfma_f32_16x16x32_bf16 v[68:71], v[224:227], a[8:11], v[68:71]
 v_mfma_f32_16x16x32_bf16 v[76:79], v[224:227], a[32:35], v[76:79]
 v_cvt_pk_bf16_f32 v51, v118, v119
 v_mfma_f32_16x16x32_bf16 v[84:87], v[224:227], a[56:59], v[84:87]
 buffer_store_dwordx4 v[48:51], v4, s[24:27], s69 offen offset:2048 sc1
 v_mfma_f32_16x16x32_bf16 v[92:95], v[224:227], a[80:83], v[92:95]
 v_mfma_f32_16x16x32_bf16 v[100:103], v[224:227], a[104:107], v[100:103]
 v_cvt_pk_bf16_f32 v52, v120, v121
 v_mfma_f32_16x16x32_bf16 v[64:67], v[204:207], a[12:15], v[64:67]
 v_mfma_f32_16x16x32_bf16 v[72:75], v[204:207], a[36:39], v[72:75]
 v_cvt_pk_bf16_f32 v53, v122, v123
 v_mfma_f32_16x16x32_bf16 v[80:83], v[204:207], a[60:63], v[80:83]
 v_cvt_pk_bf16_f32 v54, v124, v125
 v_mfma_f32_16x16x32_bf16 v[88:91], v[204:207], a[84:87], v[88:91]
 v_mfma_f32_16x16x32_bf16 v[96:99], v[204:207], a[108:111], v[96:99]
 v_cvt_pk_bf16_f32 v55, v126, v127
 v_mfma_f32_16x16x32_bf16 v[68:71], v[228:231], a[12:15], v[68:71]
 v_mfma_f32_16x16x32_bf16 v[76:79], v[228:231], a[36:39], v[76:79]
 buffer_store_dwordx4 v[52:55], v4, s[24:27], s69 offen offset:3072 sc1
 v_mfma_f32_16x16x32_bf16 v[84:87], v[228:231], a[60:63], v[84:87]
 v_cvt_pk_bf16_f32 v56, v128, v129
 v_mfma_f32_16x16x32_bf16 v[92:95], v[228:231], a[84:87], v[92:95]
 v_mfma_f32_16x16x32_bf16 v[100:103], v[228:231], a[108:111], v[100:103]
 v_cvt_pk_bf16_f32 v57, v130, v131
 v_mfma_f32_16x16x32_bf16 v[64:67], v[208:211], a[16:19], v[64:67]
 s_cmp_lt_u32 s51, 6291456
 s_cselect_b32 s52, s51, 0x80000000
 v_mfma_f32_16x16x32_bf16 v[72:75], v[208:211], a[40:43], v[72:75]
 buffer_store_dwordx4 v[244:247], v4, s[84:87], s52 offen sc1
 v_mfma_f32_16x16x32_bf16 v[80:83], v[208:211], a[64:67], v[80:83]
 s_add_u32 s51, s51, 98304
 v_cvt_pk_bf16_f32 v58, v132, v133
 v_mfma_f32_16x16x32_bf16 v[88:91], v[208:211], a[88:91], v[88:91]
 v_cvt_pk_bf16_f32 v59, v134, v135
 v_mfma_f32_16x16x32_bf16 v[96:99], v[208:211], a[112:115], v[96:99]
 s_add_u32 s69, s68, 8192
 v_mfma_f32_16x16x32_bf16 v[68:71], v[232:235], a[16:19], v[68:71]
 v_mfma_f32_16x16x32_bf16 v[76:79], v[232:235], a[40:43], v[76:79]
 buffer_store_dwordx4 v[56:59], v4, s[24:27], s69 offen offset:0 sc1
 v_mfma_f32_16x16x32_bf16 v[84:87], v[232:235], a[64:67], v[84:87]
 v_cvt_pk_bf16_f32 v60, v136, v137
 v_mfma_f32_16x16x32_bf16 v[92:95], v[232:235], a[88:91], v[92:95]
 v_mfma_f32_16x16x32_bf16 v[100:103], v[232:235], a[112:115], v[100:103]
 v_cvt_pk_bf16_f32 v61, v138, v139
 v_mfma_f32_16x16x32_bf16 v[64:67], v[212:215], a[20:23], v[64:67]
 v_mfma_f32_16x16x32_bf16 v[72:75], v[212:215], a[44:47], v[72:75]
 v_cvt_pk_bf16_f32 v62, v140, v141
 v_mfma_f32_16x16x32_bf16 v[80:83], v[212:215], a[68:71], v[80:83]
 v_cvt_pk_bf16_f32 v63, v142, v143
 v_mfma_f32_16x16x32_bf16 v[88:91], v[212:215], a[92:95], v[88:91]
 v_mfma_f32_16x16x32_bf16 v[96:99], v[212:215], a[116:119], v[96:99]
 buffer_store_dwordx4 v[60:63], v4, s[24:27], s69 offen offset:1024 sc1
 v_mfma_f32_16x16x32_bf16 v[68:71], v[236:239], a[20:23], v[68:71]
 v_mfma_f32_16x16x32_bf16 v[76:79], v[236:239], a[44:47], v[76:79]
 v_mfma_f32_16x16x32_bf16 v[84:87], v[236:239], a[68:71], v[84:87]
 v_mfma_f32_16x16x32_bf16 v[92:95], v[236:239], a[92:95], v[92:95]
 v_mfma_f32_16x16x32_bf16 v[100:103], v[236:239], a[116:119], v[100:103]
 v_mfma_f32_16x16x32_bf16 v[104:107], v[192:195], a[120:123], 0
 buffer_load_dword v9, v5, s[72:75], s43 offen sc1
 v_mfma_f32_16x16x32_bf16 v[112:115], v[192:195], a[144:147], 0
 v_mfma_f32_16x16x32_bf16 v[120:123], v[192:195], a[168:171], 0
 v_mfma_f32_16x16x32_bf16 v[128:131], v[192:195], a[192:195], 0
 v_cvt_pk_bf16_f32 v24, v64, v65
 v_mfma_f32_16x16x32_bf16 v[136:139], v[192:195], a[216:219], 0
 s_add_u32 s63, s45, 1
 s_min_u32 s63, s63, 63
 v_mfma_f32_16x16x32_bf16 v[108:111], v[216:219], a[120:123], 0
 s_cmp_lt_u32 s63, s46
 s_cselect_b32 s53, 1, 0
 v_mfma_f32_16x16x32_bf16 v[116:119], v[216:219], a[144:147], 0
 v_mov_b32 v21, s53
 ds_write_b32 v6, v21 offset:16
 v_mfma_f32_16x16x32_bf16 v[124:127], v[216:219], a[168:171], 0
 v_cvt_pk_bf16_f32 v25, v66, v67
 v_cvt_pk_bf16_f32 v26, v68, v69
 v_mfma_f32_16x16x32_bf16 v[132:135], v[216:219], a[192:195], 0
 v_cvt_pk_bf16_f32 v27, v70, v71
 v_mfma_f32_16x16x32_bf16 v[140:143], v[216:219], a[216:219], 0
 v_mfma_f32_16x16x32_bf16 v[104:107], v[196:199], a[124:127], v[104:107]
 buffer_store_dwordx4 v[24:27], v4, s[24:27], s42 offen offset:0 sc1
 v_mfma_f32_16x16x32_bf16 v[112:115], v[196:199], a[148:151], v[112:115]
 v_cvt_pk_bf16_f32 v28, v72, v73
 v_mfma_f32_16x16x32_bf16 v[120:123], v[196:199], a[172:175], v[120:123]
 s_cmp_eq_u32 s40, 3
 s_cbranch_scc1 vwm_159
vwm_160:
 v_mfma_f32_16x16x32_bf16 v[128:131], v[196:199], a[196:199], v[128:131]
 v_cvt_pk_bf16_f32 v29, v74, v75
 v_mfma_f32_16x16x32_bf16 v[136:139], v[196:199], a[220:223], v[136:139]
 v_mfma_f32_16x16x32_bf16 v[108:111], v[220:223], a[124:127], v[108:111]
 v_cvt_pk_bf16_f32 v30, v76, v77
 v_mfma_f32_16x16x32_bf16 v[116:119], v[220:223], a[148:151], v[116:119]
 v_mfma_f32_16x16x32_bf16 v[124:127], v[220:223], a[172:175], v[124:127]
 v_cvt_pk_bf16_f32 v31, v78, v79
 v_mfma_f32_16x16x32_bf16 v[132:135], v[220:223], a[196:199], v[132:135]
 buffer_store_dwordx4 v[28:31], v4, s[24:27], s42 offen offset:1024 sc1
 v_mfma_f32_16x16x32_bf16 v[140:143], v[220:223], a[220:223], v[140:143]
 s_cmp_lt_u32 s63, s50
 s_cbranch_scc0 vwx_157
vwx_158:
 v_mfma_f32_16x16x32_bf16 v[104:107], v[200:203], a[128:131], v[104:107]
 s_waitcnt lgkmcnt(0)
 s_barrier
 v_mfma_f32_16x16x32_bf16 v[112:115], v[200:203], a[152:155], v[112:115]
 ds_read_b128 v[240:243], v7 offset:16
 v_cvt_pk_bf16_f32 v32, v80, v81
 v_mfma_f32_16x16x32_bf16 v[120:123], v[200:203], a[176:179], v[120:123]
 ds_read_b128 v[144:147], v8 offset:0
 v_cvt_pk_bf16_f32 v33, v82, v83
 v_mfma_f32_16x16x32_bf16 v[128:131], v[200:203], a[200:203], v[128:131]
 v_mfma_f32_16x16x32_bf16 v[136:139], v[200:203], a[224:227], v[136:139]
 ds_read_b128 v[148:151], v8 offset:1024
 v_cvt_pk_bf16_f32 v34, v84, v85
 v_mfma_f32_16x16x32_bf16 v[108:111], v[224:227], a[128:131], v[108:111]
 v_mfma_f32_16x16x32_bf16 v[116:119], v[224:227], a[152:155], v[116:119]
 v_cvt_pk_bf16_f32 v35, v86, v87
 v_mfma_f32_16x16x32_bf16 v[124:127], v[224:227], a[176:179], v[124:127]
 ds_read_b128 v[152:155], v8 offset:2048
 v_mfma_f32_16x16x32_bf16 v[132:135], v[224:227], a[200:203], v[132:135]
 buffer_store_dwordx4 v[32:35], v4, s[24:27], s42 offen offset:2048 sc1
 v_mfma_f32_16x16x32_bf16 v[140:143], v[224:227], a[224:227], v[140:143]
 ds_read_b128 v[156:159], v8 offset:3072
 v_cvt_pk_bf16_f32 v36, v88, v89
 v_mfma_f32_16x16x32_bf16 v[104:107], v[204:207], a[132:135], v[104:107]
 v_mfma_f32_16x16x32_bf16 v[112:115], v[204:207], a[156:159], v[112:115]
 v_cvt_pk_bf16_f32 v37, v90, v91
 v_mfma_f32_16x16x32_bf16 v[120:123], v[204:207], a[180:183], v[120:123]
 ds_read_b128 v[160:163], v8 offset:4096
 v_mfma_f32_16x16x32_bf16 v[128:131], v[204:207], a[204:207], v[128:131]
 v_cvt_pk_bf16_f32 v38, v92, v93
 v_mfma_f32_16x16x32_bf16 v[136:139], v[204:207], a[228:231], v[136:139]
 ds_read_b128 v[164:167], v8 offset:5120
 s_waitcnt lgkmcnt(4)
 v_mfma_f32_16x16x32_bf16 v[108:111], v[228:231], a[132:135], v[108:111]
 v_bitop3_b32 v240, v240, v241, v242 bitop3:0x80
 v_and_b32 v240, v240, v243
 v_mfma_f32_16x16x32_bf16 v[116:119], v[228:231], a[156:159], v[116:119]
 s_nop 0
 v_readfirstlane_b32 s23, v240
 v_mfma_f32_16x16x32_bf16 v[124:127], v[228:231], a[180:183], v[124:127]
 ds_read_b128 v[168:171], v8 offset:6144
 v_cvt_pk_bf16_f32 v39, v94, v95
 v_mfma_f32_16x16x32_bf16 v[132:135], v[228:231], a[204:207], v[132:135]
 buffer_store_dwordx4 v[36:39], v4, s[24:27], s42 offen offset:3072 sc1
 v_mfma_f32_16x16x32_bf16 v[140:143], v[228:231], a[228:231], v[140:143]
 ds_read_b128 v[172:175], v8 offset:7168
 v_cvt_pk_bf16_f32 v40, v96, v97
 v_mfma_f32_16x16x32_bf16 v[104:107], v[208:211], a[136:139], v[104:107]
 v_cvt_pk_bf16_f32 v41, v98, v99
 v_mfma_f32_16x16x32_bf16 v[112:115], v[208:211], a[160:163], v[112:115]
 v_cvt_pk_bf16_f32 v42, v100, v101
 v_mfma_f32_16x16x32_bf16 v[120:123], v[208:211], a[184:187], v[120:123]
 ds_read_b128 v[176:179], v8 offset:8192
 v_mfma_f32_16x16x32_bf16 v[128:131], v[208:211], a[208:211], v[128:131]
 v_cvt_pk_bf16_f32 v43, v102, v103
 v_mfma_f32_16x16x32_bf16 v[136:139], v[208:211], a[232:235], v[136:139]
 ds_read_b128 v[180:183], v8 offset:9216
 v_mfma_f32_16x16x32_bf16 v[108:111], v[232:235], a[136:139], v[108:111]
 s_add_u32 s69, s42, 4096
 v_mfma_f32_16x16x32_bf16 v[116:119], v[232:235], a[160:163], v[116:119]
 v_mfma_f32_16x16x32_bf16 v[124:127], v[232:235], a[184:187], v[124:127]
 ds_read_b128 v[184:187], v8 offset:10240
 v_mfma_f32_16x16x32_bf16 v[132:135], v[232:235], a[208:211], v[132:135]
 buffer_store_dwordx4 v[40:43], v4, s[24:27], s69 offen offset:0 sc1
 v_mfma_f32_16x16x32_bf16 v[140:143], v[232:235], a[232:235], v[140:143]
 ds_read_b128 v[188:191], v8 offset:11264
 v_mfma_f32_16x16x32_bf16 v[104:107], v[212:215], a[140:143], v[104:107]
 v_mfma_f32_16x16x32_bf16 v[112:115], v[212:215], a[164:167], v[112:115]
 v_mfma_f32_16x16x32_bf16 v[120:123], v[212:215], a[188:191], v[120:123]
 s_waitcnt vmcnt(12)
 s_mov_b32 s50, s46
 s_add_u32 s69, s45, s40
 v_mfma_f32_16x16x32_bf16 v[128:131], v[212:215], a[212:215], v[128:131]
 s_mov_b32 s40, 0
 s_sub_i32 s69, s69, 1
 s_max_i32 s69, s69, s70
 v_mfma_f32_16x16x32_bf16 v[136:139], v[212:215], a[236:239], v[136:139]
 s_add_u32 s45, s45, 1
 s_mov_b32 s68, s42
 s_add_u32 s42, s42, 1310720
 v_mfma_f32_16x16x32_bf16 v[108:111], v[236:239], a[140:143], v[108:111]
 v_mfma_f32_16x16x32_bf16 v[116:119], v[236:239], a[164:167], v[116:119]
 v_mfma_f32_16x16x32_bf16 v[124:127], v[236:239], a[188:191], v[124:127]
 v_mfma_f32_16x16x32_bf16 v[132:135], v[236:239], a[212:215], v[132:135]
 v_mfma_f32_16x16x32_bf16 v[140:143], v[236:239], a[236:239], v[140:143]
 s_mov_b64 exec, 1
 v_mov_b32 v20, s69
 buffer_store_dword v20, v10, s[72:75], s44 offen sc1
 s_mov_b64 exec, -1
 s_cmp_le_u32 s45, 16
 s_cbranch_scc1 vwe_163
vwe_164:
 s_cmp_lg_u32 s45, 44
 s_cbranch_scc1 arm_167
 s_mul_i32 s21, s2, 10240
 s_mul_i32 s22, s20, 2560
 s_add_u32 s21, s21, s22
 s_add_u32 s21, s21, 17039360
 buffer_store_dwordx4 v[244:247], v15, s[80:83], s21 offen offset:0 sc1
 buffer_store_dwordx4 v[244:247], v15, s[80:83], s21 offen offset:512 sc1
 buffer_store_dwordx4 v[244:247], v15, s[80:83], s21 offen offset:1024 sc1
 buffer_store_dwordx4 v[244:247], v15, s[80:83], s21 offen offset:1536 sc1
 buffer_store_dwordx4 v[244:247], v15, s[80:83], s21 offen offset:2048 sc1
 s_add_u32 s21, s21, 655360
 buffer_store_dwordx4 v[244:247], v15, s[80:83], s21 offen offset:0 sc1
 buffer_store_dwordx4 v[244:247], v15, s[80:83], s21 offen offset:512 sc1
 buffer_store_dwordx4 v[244:247], v15, s[80:83], s21 offen offset:1024 sc1
 buffer_store_dwordx4 v[244:247], v15, s[80:83], s21 offen offset:1536 sc1
 buffer_store_dwordx4 v[244:247], v15, s[80:83], s21 offen offset:2048 sc1
 s_add_u32 s21, s21, 655360
 buffer_store_dwordx4 v[244:247], v15, s[80:83], s21 offen offset:0 sc1
 buffer_store_dwordx4 v[244:247], v15, s[80:83], s21 offen offset:512 sc1
 buffer_store_dwordx4 v[244:247], v15, s[80:83], s21 offen offset:1024 sc1
 buffer_store_dwordx4 v[244:247], v15, s[80:83], s21 offen offset:1536 sc1
 buffer_store_dwordx4 v[244:247], v15, s[80:83], s21 offen offset:2048 sc1
 s_add_u32 s21, s21, 655360
 buffer_store_dwordx4 v[244:247], v15, s[80:83], s21 offen offset:0 sc1
 buffer_store_dwordx4 v[244:247], v15, s[80:83], s21 offen offset:512 sc1
 buffer_store_dwordx4 v[244:247], v15, s[80:83], s21 offen offset:1024 sc1
 buffer_store_dwordx4 v[244:247], v15, s[80:83], s21 offen offset:1536 sc1
 buffer_store_dwordx4 v[244:247], v15, s[80:83], s21 offen offset:2048 sc1
 s_add_u32 s21, s21, 655360
 buffer_store_dwordx4 v[244:247], v15, s[80:83], s21 offen offset:0 sc1
 buffer_store_dwordx4 v[244:247], v15, s[80:83], s21 offen offset:512 sc1
 buffer_store_dwordx4 v[244:247], v15, s[80:83], s21 offen offset:1024 sc1
 buffer_store_dwordx4 v[244:247], v15, s[80:83], s21 offen offset:1536 sc1
 buffer_store_dwordx4 v[244:247], v15, s[80:83], s21 offen offset:2048 sc1
 s_add_u32 s21, s21, 655360
 buffer_store_dwordx4 v[244:247], v15, s[80:83], s21 offen offset:0 sc1
 buffer_store_dwordx4 v[244:247], v15, s[80:83], s21 offen offset:512 sc1
 buffer_store_dwordx4 v[244:247], v15, s[80:83], s21 offen offset:1024 sc1
 buffer_store_dwordx4 v[244:247], v15, s[80:83], s21 offen offset:1536 sc1
 buffer_store_dwordx4 v[244:247], v15, s[80:83], s21 offen offset:2048 sc1
 s_add_u32 s21, s21, 655360
 s_and_b32 s21, s2, 3
 s_cmp_lg_u32 s21, s20
 s_cbranch_scc1 arm_167
 s_mul_i32 s21, s2, 2560
 s_add_u32 s21, s21, 4259840
 v_lshlrev_b32 v21, 3, v1
 buffer_store_dwordx4 v[244:247], v4, s[88:91], s21 offen sc1
 buffer_store_dwordx4 v[244:247], v4, s[88:91], s21 offen offset:1024 sc1
 buffer_store_dwordx2 v[244:245], v21, s[88:91], s21 offen offset:2048 sc1
 s_add_u32 s21, s21, 81920
 buffer_store_dwordx4 v[244:247], v4, s[88:91], s21 offen sc1
 buffer_store_dwordx4 v[244:247], v4, s[88:91], s21 offen offset:1024 sc1
 buffer_store_dwordx2 v[244:245], v21, s[88:91], s21 offen offset:2048 sc1
 s_add_u32 s21, s21, 81920
 buffer_store_dwordx4 v[244:247], v4, s[88:91], s21 offen sc1
 buffer_store_dwordx4 v[244:247], v4, s[88:91], s21 offen offset:1024 sc1
 buffer_store_dwordx2 v[244:245], v21, s[88:91], s21 offen offset:2048 sc1
 s_add_u32 s21, s21, 81920
 buffer_store_dwordx4 v[244:247], v4, s[88:91], s21 offen sc1
 buffer_store_dwordx4 v[244:247], v4, s[88:91], s21 offen offset:1024 sc1
 buffer_store_dwordx2 v[244:245], v21, s[88:91], s21 offen offset:2048 sc1
 s_add_u32 s21, s21, 81920
 buffer_store_dwordx4 v[244:247], v4, s[88:91], s21 offen sc1
 buffer_store_dwordx4 v[244:247], v4, s[88:91], s21 offen offset:1024 sc1
 buffer_store_dwordx2 v[244:245], v21, s[88:91], s21 offen offset:2048 sc1
 s_add_u32 s21, s21, 81920
 buffer_store_dwordx4 v[244:247], v4, s[88:91], s21 offen sc1
 buffer_store_dwordx4 v[244:247], v4, s[88:91], s21 offen offset:1024 sc1
 buffer_store_dwordx2 v[244:245], v21, s[88:91], s21 offen offset:2048 sc1
 s_add_u32 s21, s21, 81920
 buffer_store_dwordx4 v[244:247], v4, s[88:91], s21 offen sc1
 buffer_store_dwordx4 v[244:247], v4, s[88:91], s21 offen offset:1024 sc1
 buffer_store_dwordx2 v[244:245], v21, s[88:91], s21 offen offset:2048 sc1
 s_add_u32 s21, s21, 81920
 buffer_store_dwordx4 v[244:247], v4, s[88:91], s21 offen sc1
 buffer_store_dwordx4 v[244:247], v4, s[88:91], s21 offen offset:1024 sc1
 buffer_store_dwordx2 v[244:245], v21, s[88:91], s21 offen offset:2048 sc1
 s_add_u32 s21, s21, 81920
 buffer_store_dwordx4 v[244:247], v4, s[88:91], s21 offen sc1
 buffer_store_dwordx4 v[244:247], v4, s[88:91], s21 offen offset:1024 sc1
 buffer_store_dwordx2 v[244:245], v21, s[88:91], s21 offen offset:2048 sc1
 s_add_u32 s21, s21, 81920
 buffer_store_dwordx4 v[244:247], v4, s[88:91], s21 offen sc1
 buffer_store_dwordx4 v[244:247], v4, s[88:91], s21 offen offset:1024 sc1
 buffer_store_dwordx2 v[244:245], v21, s[88:91], s21 offen offset:2048 sc1
 s_add_u32 s21, s21, 81920
 buffer_store_dwordx4 v[244:247], v4, s[88:91], s21 offen sc1
 buffer_store_dwordx4 v[244:247], v4, s[88:91], s21 offen offset:1024 sc1
 buffer_store_dwordx2 v[244:245], v21, s[88:91], s21 offen offset:2048 sc1
 s_add_u32 s21, s21, 81920
 buffer_store_dwordx4 v[244:247], v4, s[88:91], s21 offen sc1
 buffer_store_dwordx4 v[244:247], v4, s[88:91], s21 offen offset:1024 sc1
 buffer_store_dwordx2 v[244:245], v21, s[88:91], s21 offen offset:2048 sc1
 s_add_u32 s21, s21, 81920
arm_167:
 s_cmp_ge_u32 s45, 64
 s_cbranch_scc1 vwd_146
 s_cmp_lg_u32 s23, 0
 s_cbranch_scc1 vwl_145
 s_branch vws_161
vws_151:
 v_cmp_gt_u32 vcc, 8, v9
 s_nop 0
 s_bitset1_b64 vcc, 18
 s_ff1_i32_b64 s21, vcc
 s_lshl_b32 s22, s21, 1
 s_lshl_b32 s21, s21, 2
 s_sub_i32 s21, s21, 8
 s_max_i32 s47, s21, s22
 s_cmp_gt_u32 s47, s45
 s_cbranch_scc1 va_169
 s_cmp_eq_u32 s70, s45
 s_cbranch_scc1 va_174
 s_nop 4
 v_cvt_pk_bf16_f32 v44, v104, v105
 v_cvt_pk_bf16_f32 v45, v106, v107
 v_cvt_pk_bf16_f32 v46, v108, v109
 v_cvt_pk_bf16_f32 v47, v110, v111
 s_add_u32 s69, s68, 4096
 buffer_store_dwordx4 v[44:47], v4, s[24:27], s69 offen offset:1024 sc1
 v_cvt_pk_bf16_f32 v48, v112, v113
 v_cvt_pk_bf16_f32 v49, v114, v115
 v_cvt_pk_bf16_f32 v50, v116, v117
 v_cvt_pk_bf16_f32 v51, v118, v119
 buffer_store_dwordx4 v[48:51], v4, s[24:27], s69 offen offset:2048 sc1
 v_cvt_pk_bf16_f32 v52, v120, v121
 v_cvt_pk_bf16_f32 v53, v122, v123
 v_cvt_pk_bf16_f32 v54, v124, v125
 v_cvt_pk_bf16_f32 v55, v126, v127
 buffer_store_dwordx4 v[52:55], v4, s[24:27], s69 offen offset:3072 sc1
 v_cvt_pk_bf16_f32 v56, v128, v129
 v_cvt_pk_bf16_f32 v57, v130, v131
 v_cvt_pk_bf16_f32 v58, v132, v133
 v_cvt_pk_bf16_f32 v59, v134, v135
 s_add_u32 s69, s68, 8192
 buffer_store_dwordx4 v[56:59], v4, s[24:27], s69 offen offset:0 sc1
 v_cvt_pk_bf16_f32 v60, v136, v137
 v_cvt_pk_bf16_f32 v61, v138, v139
 v_cvt_pk_bf16_f32 v62, v140, v141
 v_cvt_pk_bf16_f32 v63, v142, v143
 buffer_store_dwordx4 v[60:63], v4, s[24:27], s69 offen offset:1024 sc1
 s_mov_b32 s68, 0x80000000
 s_mov_b32 s56, s68
 s_mov_b32 s57, s68
 s_waitcnt vmcnt(0)
 s_mov_b64 exec, 1
 v_mov_b32 v20, s45
 buffer_store_dword v20, v10, s[72:75], s44 offen sc1
 s_mov_b64 exec, -1
 s_mov_b32 s70, s45
 s_mov_b32 s40, 0
va_174:
 s_mov_b32 s101, 0
 s_branch va_172
va_170:
 s_sleep 8
va_172:
 buffer_load_dword v9, v5, s[72:75], s43 offen sc1
 s_add_u32 s101, s101, 1
 s_cmp_gt_u32 s101, 131072
 s_cbranch_scc1 main_end
 s_waitcnt vmcnt(0)
 v_cmp_gt_u32 vcc, 8, v9
 s_nop 0
 s_bitset1_b64 vcc, 18
 s_ff1_i32_b64 s21, vcc
 s_lshl_b32 s22, s21, 1
 s_lshl_b32 s21, s21, 2
 s_sub_i32 s21, s21, 8
 s_max_i32 s47, s21, s22
 s_cmp_gt_u32 s47, s45
 s_cbranch_scc0 va_170
va_169:
 s_add_u32 s22, s45, 6
 s_min_u32 s22, s22, s47
va_171:
 s_cmp_ge_u32 s46, s22
 s_cbranch_scc1 va_173
 s_mov_b32 m0, s64
 s_mov_b32 s66, s41
 buffer_load_dwordx4 v4, s[16:19], s66 offen offset:0 sc1 lds
 buffer_load_dwordx4 v4, s[16:19], s66 offen offset:1024 sc1 lds
 buffer_load_dwordx4 v4, s[16:19], s66 offen offset:2048 sc1 lds
 s_add_u32 s46, s46, 1
 s_add_u32 s41, s41, 393216
 s_add_u32 s64, s64, 12288
 s_cmp_lt_u32 s64, s67
 s_cselect_b32 s64, s64, s71
 s_branch va_171
va_173:
 s_mov_b32 s48, s46
 s_mov_b32 s49, s46
 s_mov_b32 s50, s46
 s_waitcnt vmcnt(0)
 s_cmp_eq_u32 s40, 0
 s_cbranch_scc1 va_175
 s_mov_b32 s40, 0
 s_mov_b64 exec, 1
 v_mov_b32 v20, s45
 buffer_store_dword v20, v10, s[72:75], s44 offen sc1
 s_mov_b64 exec, -1
 s_mov_b32 s70, s45
va_175:
 s_barrier
 ds_read_b128 v[192:195], v8 offset:0
 ds_read_b128 v[196:199], v8 offset:1024
 ds_read_b128 v[200:203], v8 offset:2048
 ds_read_b128 v[204:207], v8 offset:3072
 ds_read_b128 v[208:211], v8 offset:4096
 ds_read_b128 v[212:215], v8 offset:5120
 ds_read_b128 v[216:219], v8 offset:6144
 ds_read_b128 v[220:223], v8 offset:7168
 ds_read_b128 v[224:227], v8 offset:8192
 ds_read_b128 v[228:231], v8 offset:9216
 ds_read_b128 v[232:235], v8 offset:10240
 ds_read_b128 v[236:239], v8 offset:11264
 s_branch vwb_152
vws_161:
 v_cmp_gt_u32 vcc, 8, v9
 s_nop 0
 s_bitset1_b64 vcc, 18
 s_ff1_i32_b64 s21, vcc
 s_lshl_b32 s22, s21, 1
 s_lshl_b32 s21, s21, 2
 s_sub_i32 s21, s21, 8
 s_max_i32 s47, s21, s22
 s_cmp_gt_u32 s47, s45
 s_cbranch_scc1 va_176
 s_cmp_eq_u32 s70, s45
 s_cbranch_scc1 va_181
 s_nop 4
 v_cvt_pk_bf16_f32 v44, v104, v105
 v_cvt_pk_bf16_f32 v45, v106, v107
 v_cvt_pk_bf16_f32 v46, v108, v109
 v_cvt_pk_bf16_f32 v47, v110, v111
 s_add_u32 s69, s68, 4096
 buffer_store_dwordx4 v[44:47], v4, s[24:27], s69 offen offset:1024 sc1
 v_cvt_pk_bf16_f32 v48, v112, v113
 v_cvt_pk_bf16_f32 v49, v114, v115
 v_cvt_pk_bf16_f32 v50, v116, v117
 v_cvt_pk_bf16_f32 v51, v118, v119
 buffer_store_dwordx4 v[48:51], v4, s[24:27], s69 offen offset:2048 sc1
 v_cvt_pk_bf16_f32 v52, v120, v121
 v_cvt_pk_bf16_f32 v53, v122, v123
 v_cvt_pk_bf16_f32 v54, v124, v125
 v_cvt_pk_bf16_f32 v55, v126, v127
 buffer_store_dwordx4 v[52:55], v4, s[24:27], s69 offen offset:3072 sc1
 v_cvt_pk_bf16_f32 v56, v128, v129
 v_cvt_pk_bf16_f32 v57, v130, v131
 v_cvt_pk_bf16_f32 v58, v132, v133
 v_cvt_pk_bf16_f32 v59, v134, v135
 s_add_u32 s69, s68, 8192
 buffer_store_dwordx4 v[56:59], v4, s[24:27], s69 offen offset:0 sc1
 v_cvt_pk_bf16_f32 v60, v136, v137
 v_cvt_pk_bf16_f32 v61, v138, v139
 v_cvt_pk_bf16_f32 v62, v140, v141
 v_cvt_pk_bf16_f32 v63, v142, v143
 buffer_store_dwordx4 v[60:63], v4, s[24:27], s69 offen offset:1024 sc1
 s_mov_b32 s68, 0x80000000
 s_mov_b32 s56, s68
 s_mov_b32 s57, s68
 s_waitcnt vmcnt(0)
 s_mov_b64 exec, 1
 v_mov_b32 v20, s45
 buffer_store_dword v20, v10, s[72:75], s44 offen sc1
 s_mov_b64 exec, -1
 s_mov_b32 s70, s45
 s_mov_b32 s40, 0
va_181:
 s_mov_b32 s101, 0
 s_branch va_179
va_177:
 s_sleep 8
va_179:
 buffer_load_dword v9, v5, s[72:75], s43 offen sc1
 s_add_u32 s101, s101, 1
 s_cmp_gt_u32 s101, 131072
 s_cbranch_scc1 main_end
 s_waitcnt vmcnt(0)
 v_cmp_gt_u32 vcc, 8, v9
 s_nop 0
 s_bitset1_b64 vcc, 18
 s_ff1_i32_b64 s21, vcc
 s_lshl_b32 s22, s21, 1
 s_lshl_b32 s21, s21, 2
 s_sub_i32 s21, s21, 8
 s_max_i32 s47, s21, s22
 s_cmp_gt_u32 s47, s45
 s_cbranch_scc0 va_177
va_176:
 s_add_u32 s22, s45, 6
 s_min_u32 s22, s22, s47
va_178:
 s_cmp_ge_u32 s46, s22
 s_cbranch_scc1 va_180
 s_mov_b32 m0, s64
 s_mov_b32 s66, s41
 buffer_load_dwordx4 v4, s[16:19], s66 offen offset:0 sc1 lds
 buffer_load_dwordx4 v4, s[16:19], s66 offen offset:1024 sc1 lds
 buffer_load_dwordx4 v4, s[16:19], s66 offen offset:2048 sc1 lds
 s_add_u32 s46, s46, 1
 s_add_u32 s41, s41, 393216
 s_add_u32 s64, s64, 12288
 s_cmp_lt_u32 s64, s67
 s_cselect_b32 s64, s64, s71
 s_branch va_178
va_180:
 s_mov_b32 s48, s46
 s_mov_b32 s49, s46
 s_mov_b32 s50, s46
 s_waitcnt vmcnt(0)
 s_cmp_eq_u32 s40, 0
 s_cbranch_scc1 va_182
 s_mov_b32 s40, 0
 s_mov_b64 exec, 1
 v_mov_b32 v20, s45
 buffer_store_dword v20, v10, s[72:75], s44 offen sc1
 s_mov_b64 exec, -1
 s_mov_b32 s70, s45
va_182:
 s_barrier
 ds_read_b128 v[144:147], v8 offset:0
 ds_read_b128 v[148:151], v8 offset:1024
 ds_read_b128 v[152:155], v8 offset:2048
 ds_read_b128 v[156:159], v8 offset:3072
 ds_read_b128 v[160:163], v8 offset:4096
 ds_read_b128 v[164:167], v8 offset:5120
 ds_read_b128 v[168:171], v8 offset:6144
 ds_read_b128 v[172:175], v8 offset:7168
 ds_read_b128 v[176:179], v8 offset:8192
 ds_read_b128 v[180:183], v8 offset:9216
 ds_read_b128 v[184:187], v8 offset:10240
 ds_read_b128 v[188:191], v8 offset:11264
 s_branch vwl_145
vwe_153:
 s_nop 4
 v_cvt_pk_bf16_f32 v44, v104, v105
 v_cvt_pk_bf16_f32 v45, v106, v107
 v_cvt_pk_bf16_f32 v46, v108, v109
 v_cvt_pk_bf16_f32 v47, v110, v111
 s_add_u32 s69, s68, 4096
 buffer_store_dwordx4 v[44:47], v4, s[24:27], s69 offen offset:1024 sc1
 v_cvt_pk_bf16_f32 v48, v112, v113
 v_cvt_pk_bf16_f32 v49, v114, v115
 v_cvt_pk_bf16_f32 v50, v116, v117
 v_cvt_pk_bf16_f32 v51, v118, v119
 buffer_store_dwordx4 v[48:51], v4, s[24:27], s69 offen offset:2048 sc1
 v_cvt_pk_bf16_f32 v52, v120, v121
 v_cvt_pk_bf16_f32 v53, v122, v123
 v_cvt_pk_bf16_f32 v54, v124, v125
 v_cvt_pk_bf16_f32 v55, v126, v127
 buffer_store_dwordx4 v[52:55], v4, s[24:27], s69 offen offset:3072 sc1
 v_cvt_pk_bf16_f32 v56, v128, v129
 v_cvt_pk_bf16_f32 v57, v130, v131
 v_cvt_pk_bf16_f32 v58, v132, v133
 v_cvt_pk_bf16_f32 v59, v134, v135
 s_add_u32 s69, s68, 8192
 buffer_store_dwordx4 v[56:59], v4, s[24:27], s69 offen offset:0 sc1
 v_cvt_pk_bf16_f32 v60, v136, v137
 v_cvt_pk_bf16_f32 v61, v138, v139
 v_cvt_pk_bf16_f32 v62, v140, v141
 v_cvt_pk_bf16_f32 v63, v142, v143
 buffer_store_dwordx4 v[60:63], v4, s[24:27], s69 offen offset:1024 sc1
 s_mov_b32 s68, 0x80000000
 s_mov_b32 s56, s68
 s_mov_b32 s57, s68
 s_cmp_le_u32 s45, 4
 s_cselect_b32 s40, 3, 1
 s_branch vwe_154
vwe_163:
 s_nop 4
 v_cvt_pk_bf16_f32 v44, v104, v105
 v_cvt_pk_bf16_f32 v45, v106, v107
 v_cvt_pk_bf16_f32 v46, v108, v109
 v_cvt_pk_bf16_f32 v47, v110, v111
 s_add_u32 s69, s68, 4096
 buffer_store_dwordx4 v[44:47], v4, s[24:27], s69 offen offset:1024 sc1
 v_cvt_pk_bf16_f32 v48, v112, v113
 v_cvt_pk_bf16_f32 v49, v114, v115
 v_cvt_pk_bf16_f32 v50, v116, v117
 v_cvt_pk_bf16_f32 v51, v118, v119
 buffer_store_dwordx4 v[48:51], v4, s[24:27], s69 offen offset:2048 sc1
 v_cvt_pk_bf16_f32 v52, v120, v121
 v_cvt_pk_bf16_f32 v53, v122, v123
 v_cvt_pk_bf16_f32 v54, v124, v125
 v_cvt_pk_bf16_f32 v55, v126, v127
 buffer_store_dwordx4 v[52:55], v4, s[24:27], s69 offen offset:3072 sc1
 v_cvt_pk_bf16_f32 v56, v128, v129
 v_cvt_pk_bf16_f32 v57, v130, v131
 v_cvt_pk_bf16_f32 v58, v132, v133
 v_cvt_pk_bf16_f32 v59, v134, v135
 s_add_u32 s69, s68, 8192
 buffer_store_dwordx4 v[56:59], v4, s[24:27], s69 offen offset:0 sc1
 v_cvt_pk_bf16_f32 v60, v136, v137
 v_cvt_pk_bf16_f32 v61, v138, v139
 v_cvt_pk_bf16_f32 v62, v140, v141
 v_cvt_pk_bf16_f32 v63, v142, v143
 buffer_store_dwordx4 v[60:63], v4, s[24:27], s69 offen offset:1024 sc1
 s_mov_b32 s68, 0x80000000
 s_mov_b32 s56, s68
 s_mov_b32 s57, s68
 s_cmp_le_u32 s45, 4
 s_cselect_b32 s40, 3, 1
 s_branch vwe_164
vwx_147:
 s_waitcnt vmcnt(9)
 s_branch vwx_148
vwx_157:
 s_waitcnt vmcnt(9)
 s_branch vwx_158
vwm_149:
 s_mov_b32 s40, 0
 s_waitcnt vmcnt(11)
 s_mov_b64 exec, 1
 v_mov_b32 v20, s45
 buffer_store_dword v20, v10, s[72:75], s44 offen sc1
 s_mov_b64 exec, -1
 s_mov_b32 s70, s45
 s_branch vwm_150
vwm_159:
 s_mov_b32 s40, 0
 s_waitcnt vmcnt(11)
 s_mov_b64 exec, 1
 v_mov_b32 v20, s45
 buffer_store_dword v20, v10, s[72:75], s44 offen sc1
 s_mov_b64 exec, -1
 s_mov_b32 s70, s45
 s_branch vwm_160
vwd_146:
 s_nop 4
 v_cvt_pk_bf16_f32 v44, v104, v105
 v_cvt_pk_bf16_f32 v45, v106, v107
 v_cvt_pk_bf16_f32 v46, v108, v109
 v_cvt_pk_bf16_f32 v47, v110, v111
 s_add_u32 s69, s68, 4096
 buffer_store_dwordx4 v[44:47], v4, s[24:27], s69 offen offset:1024 sc1
 v_cvt_pk_bf16_f32 v48, v112, v113
 v_cvt_pk_bf16_f32 v49, v114, v115
 v_cvt_pk_bf16_f32 v50, v116, v117
 v_cvt_pk_bf16_f32 v51, v118, v119
 buffer_store_dwordx4 v[48:51], v4, s[24:27], s69 offen offset:2048 sc1
 v_cvt_pk_bf16_f32 v52, v120, v121
 v_cvt_pk_bf16_f32 v53, v122, v123
 v_cvt_pk_bf16_f32 v54, v124, v125
 v_cvt_pk_bf16_f32 v55, v126, v127
 buffer_store_dwordx4 v[52:55], v4, s[24:27], s69 offen offset:3072 sc1
 v_cvt_pk_bf16_f32 v56, v128, v129
 v_cvt_pk_bf16_f32 v57, v130, v131
 v_cvt_pk_bf16_f32 v58, v132, v133
 v_cvt_pk_bf16_f32 v59, v134, v135
 s_add_u32 s69, s68, 8192
 buffer_store_dwordx4 v[56:59], v4, s[24:27], s69 offen offset:0 sc1
 v_cvt_pk_bf16_f32 v60, v136, v137
 v_cvt_pk_bf16_f32 v61, v138, v139
 v_cvt_pk_bf16_f32 v62, v140, v141
 v_cvt_pk_bf16_f32 v63, v142, v143
 buffer_store_dwordx4 v[60:63], v4, s[24:27], s69 offen offset:1024 sc1
 s_waitcnt vmcnt(0)
 s_mov_b64 exec, 1
 v_mov_b32 v20, s45
 buffer_store_dword v20, v10, s[72:75], s44 offen sc1
 s_mov_b64 exec, -1
 s_mov_b32 s84, 0
 s_mov_b32 s85, -1
 s_and_b32 s21, s3, 3
 s_sub_u32 s22, s21, 0
 s_lshl_b32 s22, s22, 3
 s_bfe_u32 s87, s3, 0x30002
 s_add_u32 s87, s87, s22
 s_add_u32 s87, s87, 252
 s_cmp_lt_u32 s21, 0
 s_cselect_b32 s87, -1, s87
 s_sub_u32 s21, s3, 64
 s_waitcnt vmcnt(0) lgkmcnt(0)
 s_barrier
 s_branch do_opb2
 s_mov_b32 s84, 0
 s_mov_b32 s85, -1
 s_mov_b32 s86, 0
 s_branch queue
not_vw:
 s_sub_u32 s2, s3, 96
 s_cmp_lg_u32 s2, 31
 s_cbranch_scc1 not_cal
 s_add_u32 s8, s38, 83886079
 s_addc_u32 s9, s39, 0
 s_and_b32 s8, s8, 0xffe00000
 s_mov_b32 s10, 2097152
 s_mov_b32 s11, 0x00020000
 v_lshrrev_b32 v9, 4, v0
 v_mul_u32_u24 v9, 16640, v9
 v_bfe_u32 v10, v0, 3, 1
 v_lshl_add_u32 v9, v10, 13, v9
 v_and_b32 v10, 7, v0
 v_lshl_add_u32 v9, v10, 4, v9
 s_mov_b32 s21, 1048576
 buffer_store_dwordx4 v[4:7], v9, s[8:11], s21 offen sc1
 s_waitcnt vmcnt(0)
 s_barrier
 s_cmp_lg_u32 s20, 3
 s_cbranch_scc1 cal_183
 s_mov_b64 exec, 1
 v_mov_b32 v4, 0
 s_mov_b32 s40, -1
 s_mov_b32 s41, -1
 s_mov_b32 s42, 1048576
 s_mov_b32 s43, 0
 s_waitcnt vmcnt(0)
cal_184:
 s_add_u32 s21, s42, 0
 s_memtime s[98:99]
 s_waitcnt lgkmcnt(0)
 buffer_load_dword v5, v4, s[8:11], s21 offen sc1
 s_waitcnt vmcnt(0)
 s_memtime s[100:101]
 s_waitcnt lgkmcnt(0)
 s_sub_u32 s21, s100, s98
 s_min_u32 s40, s40, s21
 s_add_u32 s21, s42, 8192
 s_memtime s[98:99]
 s_waitcnt lgkmcnt(0)
 buffer_load_dword v5, v4, s[8:11], s21 offen sc1
 s_waitcnt vmcnt(0)
 s_memtime s[100:101]
 s_waitcnt lgkmcnt(0)
 s_sub_u32 s21, s100, s98
 s_min_u32 s41, s41, s21
 s_add_u32 s42, s42, 16640
 s_add_u32 s43, s43, 1
 s_cmp_lt_u32 s43, 4
 s_cbranch_scc1 cal_184
 s_cmp_lt_u32 s41, s40
 s_cselect_b32 s21, 1, 2
 v_mov_b32 v4, s21
 v_mov_b32 v5, s40
 v_mov_b32 v6, s41
 v_mov_b32 v8, 84
 buffer_store_dwordx3 v[4:6], v8, s[32:35], 0 offen sc1
 s_waitcnt vmcnt(0)
 s_mov_b64 exec, -1
cal_183:
 s_barrier
 s_branch armed
not_cal:
armed:
 s_load_dwordx2 s[72:73], s[0:1], 104
 s_waitcnt lgkmcnt(0)
 s_add_u32 s72, s72, 81068032
 s_addc_u32 s73, s73, 0
 s_mov_b32 s74, 128000
 s_mov_b32 s75, 0x00020000
 s_load_dwordx2 s[4:5], s[0:1], 0
 s_load_dwordx2 s[6:7], s[0:1], 64
 s_load_dwordx2 s[38:39], s[0:1], 104
 s_mov_b32 s64, s32
 s_mov_b32 s65, s33
 s_mov_b32 s66, s34
 s_mov_b32 s67, s35
 s_lshr_b32 s41, s2, 1
 s_and_b32 s42, s2, 1
 s_waitcnt lgkmcnt(0)
 s_mov_b32 s8, s4
 s_mov_b32 s9, s5
 s_mov_b32 s10, 2621440
 s_mov_b32 s11, 0x00020000
 s_mov_b32 s12, s6
 s_mov_b32 s13, s7
 s_mov_b32 s14, 2457600
 s_mov_b32 s15, 0x00020000
 s_add_u32 s16, s38, 70713344
 s_addc_u32 s17, s39, 0
 s_mov_b32 s18, 2641920
 s_mov_b32 s19, 0x00020000
 s_add_u32 s72, s38, 81068032
 s_addc_u32 s73, s39, 0
 s_mov_b32 s74, 128000
 s_mov_b32 s75, 0x00020000
 s_lshl_b32 s21, s2, 2
 s_add_u32 s21, s21, s20
 s_mul_i32 s21, s21, 19200
 v_lshlrev_b32 v5, 4, v1
 buffer_load_dwordx4 v[64:67], v5, s[12:15], s21 offen offset:0
 buffer_load_dwordx4 v[64:67], v5, s[12:15], s21 offen offset:1024
 buffer_load_dwordx4 v[64:67], v5, s[12:15], s21 offen offset:2048
 buffer_load_dwordx4 v[64:67], v5, s[12:15], s21 offen offset:3072
 s_add_u32 s21, s21, 4096
 buffer_load_dwordx4 v[64:67], v5, s[12:15], s21 offen offset:0
 buffer_load_dwordx4 v[64:67], v5, s[12:15], s21 offen offset:1024
 buffer_load_dwordx4 v[64:67], v5, s[12:15], s21 offen offset:2048
 buffer_load_dwordx4 v[64:67], v5, s[12:15], s21 offen offset:3072
 s_add_u32 s21, s21, 4096
 buffer_load_dwordx4 v[64:67], v5, s[12:15], s21 offen offset:0
 buffer_load_dwordx4 v[64:67], v5, s[12:15], s21 offen offset:1024
 buffer_load_dwordx4 v[64:67], v5, s[12:15], s21 offen offset:2048
 buffer_load_dwordx4 v[64:67], v5, s[12:15], s21 offen offset:3072
 s_add_u32 s21, s21, 4096
 buffer_load_dwordx4 v[64:67], v5, s[12:15], s21 offen offset:0
 buffer_load_dwordx4 v[64:67], v5, s[12:15], s21 offen offset:1024
 buffer_load_dwordx4 v[64:67], v5, s[12:15], s21 offen offset:2048
 buffer_load_dwordx4 v[64:67], v5, s[12:15], s21 offen offset:3072
 s_add_u32 s21, s21, 4096
 buffer_load_dwordx4 v[64:67], v5, s[12:15], s21 offen offset:0
 buffer_load_dwordx4 v[64:67], v5, s[12:15], s21 offen offset:1024
 buffer_load_dwordx4 v[64:67], v5, s[12:15], s21 offen offset:2048
 s_waitcnt vmcnt(0)
 v_lshlrev_b32 v6, 1, v3
 v_add_u32 v6, 0, v6
 v_xor_b32 v6, v6, v2
 v_min_u32 v6, 14, v6
 v_mul_u32_u24 v7, 52, v6
 v_lshrrev_b32 v7, 8, v7
 v_mul_u32_u24 v7, 1200, v7
 v_lshl_add_u32 v7, v6, 4, v7
 v_mul_u32_u24 v6, 3840, v3
 v_add_u32 v4, v6, v7
 v_lshlrev_b32 v6, 1, v3
 v_add_u32 v6, 8, v6
 v_xor_b32 v6, v6, v2
 v_min_u32 v6, 14, v6
 v_mul_u32_u24 v7, 52, v6
 v_lshrrev_b32 v7, 8, v7
 v_mul_u32_u24 v7, 1200, v7
 v_lshl_add_u32 v7, v6, 4, v7
 v_mul_u32_u24 v6, 3840, v3
 v_add_u32 v5, v6, v7
 s_mul_i32 s21, s41, 80
 s_mul_i32 s22, s20, 15360
 s_add_u32 s21, s21, s22
 s_lshl_b32 s22, s20, 10
 s_cmp_ge_u32 s20, 2
 s_cselect_b64 vcc, -1, 0
 v_cndmask_b32 v4, v4, v5, vcc
 s_add_u32 m0, s22, 0
 s_nop 0
 buffer_load_dwordx4 v4, s[12:15], s21 offen lds
 s_add_u32 s21, s21, 61440
 s_add_u32 m0, s22, 4096
 s_nop 0
 buffer_load_dwordx4 v4, s[12:15], s21 offen lds
 s_add_u32 s21, s21, 61440
 s_add_u32 m0, s22, 8192
 s_nop 0
 buffer_load_dwordx4 v4, s[12:15], s21 offen lds
 s_add_u32 s21, s21, 61440
 s_add_u32 m0, s22, 12288
 s_nop 0
 buffer_load_dwordx4 v4, s[12:15], s21 offen lds
 s_add_u32 s21, s21, 61440
 s_add_u32 m0, s22, 16384
 s_nop 0
 buffer_load_dwordx4 v4, s[12:15], s21 offen lds
 s_add_u32 s21, s21, 61440
 s_add_u32 m0, s22, 20480
 s_nop 0
 buffer_load_dwordx4 v4, s[12:15], s21 offen lds
 s_add_u32 s21, s21, 61440
 s_add_u32 m0, s22, 24576
 s_nop 0
 buffer_load_dwordx4 v4, s[12:15], s21 offen lds
 s_add_u32 s21, s21, 61440
 s_add_u32 m0, s22, 28672
 s_nop 0
 buffer_load_dwordx4 v4, s[12:15], s21 offen lds
 s_add_u32 s21, s21, 61440
 s_add_u32 m0, s22, 32768
 s_nop 0
 buffer_load_dwordx4 v4, s[12:15], s21 offen lds
 s_add_u32 s21, s21, 61440
 s_add_u32 m0, s22, 36864
 s_nop 0
 buffer_load_dwordx4 v4, s[12:15], s21 offen lds
 s_add_u32 s21, s21, 61440
 s_add_u32 m0, s22, 40960
 s_nop 0
 buffer_load_dwordx4 v4, s[12:15], s21 offen lds
 s_add_u32 s21, s21, 61440
 s_add_u32 m0, s22, 45056
 s_nop 0
 buffer_load_dwordx4 v4, s[12:15], s21 offen lds
 s_add_u32 s21, s21, 61440
 s_add_u32 m0, s22, 49152
 s_nop 0
 buffer_load_dwordx4 v4, s[12:15], s21 offen lds
 s_add_u32 s21, s21, 61440
 s_add_u32 m0, s22, 53248
 s_nop 0
 buffer_load_dwordx4 v4, s[12:15], s21 offen lds
 s_add_u32 s21, s21, 61440
 s_add_u32 m0, s22, 57344
 s_nop 0
 buffer_load_dwordx4 v4, s[12:15], s21 offen lds
 s_add_u32 s21, s21, 61440
 s_add_u32 m0, s22, 61440
 s_nop 0
 buffer_load_dwordx4 v4, s[12:15], s21 offen lds
 s_add_u32 s21, s21, 61440
 s_add_u32 m0, s22, 65536
 s_nop 0
 buffer_load_dwordx4 v4, s[12:15], s21 offen lds
 s_add_u32 s21, s21, 61440
 s_add_u32 m0, s22, 69632
 s_nop 0
 buffer_load_dwordx4 v4, s[12:15], s21 offen lds
 s_add_u32 s21, s21, 61440
 s_add_u32 m0, s22, 73728
 s_nop 0
 buffer_load_dwordx4 v4, s[12:15], s21 offen lds
 s_add_u32 s21, s21, 61440
 s_add_u32 m0, s22, 77824
 s_nop 0
 buffer_load_dwordx4 v4, s[12:15], s21 offen lds
 s_add_u32 s21, s21, 61440
 s_add_u32 m0, s22, 81920
 s_nop 0
 buffer_load_dwordx4 v4, s[12:15], s21 offen lds
 s_add_u32 s21, s21, 61440
 s_add_u32 m0, s22, 86016
 s_nop 0
 buffer_load_dwordx4 v4, s[12:15], s21 offen lds
 s_add_u32 s21, s21, 61440
 s_add_u32 m0, s22, 90112
 s_nop 0
 buffer_load_dwordx4 v4, s[12:15], s21 offen lds
 s_add_u32 s21, s21, 61440
 s_add_u32 m0, s22, 94208
 s_nop 0
 buffer_load_dwordx4 v4, s[12:15], s21 offen lds
 s_add_u32 s21, s21, 61440
 s_add_u32 m0, s22, 98304
 s_nop 0
 buffer_load_dwordx4 v4, s[12:15], s21 offen lds
 s_add_u32 s21, s21, 61440
 s_add_u32 m0, s22, 102400
 s_nop 0
 buffer_load_dwordx4 v4, s[12:15], s21 offen lds
 s_add_u32 s21, s21, 61440
 s_add_u32 m0, s22, 106496
 s_nop 0
 buffer_load_dwordx4 v4, s[12:15], s21 offen lds
 s_add_u32 s21, s21, 61440
 s_add_u32 m0, s22, 110592
 s_nop 0
 buffer_load_dwordx4 v4, s[12:15], s21 offen lds
 s_add_u32 s21, s21, 61440
 s_add_u32 m0, s22, 114688
 s_nop 0
 buffer_load_dwordx4 v4, s[12:15], s21 offen lds
 s_add_u32 s21, s21, 61440
 s_add_u32 m0, s22, 118784
 s_nop 0
 buffer_load_dwordx4 v4, s[12:15], s21 offen lds
 s_add_u32 s21, s21, 61440
 s_add_u32 m0, s22, 122880
 s_nop 0
 buffer_load_dwordx4 v4, s[12:15], s21 offen lds
 s_add_u32 s21, s21, 61440
 s_add_u32 m0, s22, 126976
 s_nop 0
 buffer_load_dwordx4 v4, s[12:15], s21 offen lds
 s_add_u32 s21, s21, 61440
 s_add_u32 m0, s22, 131072
 s_nop 0
 buffer_load_dwordx4 v4, s[12:15], s21 offen lds
 s_add_u32 s21, s21, 61440
 s_add_u32 m0, s22, 135168
 s_nop 0
 buffer_load_dwordx4 v4, s[12:15], s21 offen lds
 s_add_u32 s21, s21, 61440
 s_add_u32 m0, s22, 139264
 s_nop 0
 buffer_load_dwordx4 v4, s[12:15], s21 offen lds
 s_add_u32 s21, s21, 61440
 s_add_u32 m0, s22, 143360
 s_nop 0
 buffer_load_dwordx4 v4, s[12:15], s21 offen lds
 s_add_u32 s21, s21, 61440
 s_add_u32 m0, s22, 147456
 s_nop 0
 buffer_load_dwordx4 v4, s[12:15], s21 offen lds
 s_add_u32 s21, s21, 61440
 s_add_u32 m0, s22, 151552
 s_nop 0
 buffer_load_dwordx4 v4, s[12:15], s21 offen lds
 s_add_u32 s21, s21, 61440
 s_add_u32 m0, s22, 155648
 s_nop 0
 buffer_load_dwordx4 v4, s[12:15], s21 offen lds
 s_add_u32 s21, s21, 61440
 s_add_u32 m0, s22, 159744
 s_nop 0
 buffer_load_dwordx4 v4, s[12:15], s21 offen lds
 s_add_u32 s21, s21, 61440
 s_lshl_b32 s21, s2, 2
 s_add_u32 s21, s21, s20
 s_mul_i32 s21, s21, 20480
 v_lshlrev_b32 v5, 4, v1
 buffer_load_dwordx4 v[64:67], v5, s[8:11], s21 offen offset:0
 buffer_load_dwordx4 v[64:67], v5, s[8:11], s21 offen offset:1024
 buffer_load_dwordx4 v[64:67], v5, s[8:11], s21 offen offset:2048
 buffer_load_dwordx4 v[64:67], v5, s[8:11], s21 offen offset:3072
 s_add_u32 s21, s21, 4096
 buffer_load_dwordx4 v[64:67], v5, s[8:11], s21 offen offset:0
 buffer_load_dwordx4 v[64:67], v5, s[8:11], s21 offen offset:1024
 buffer_load_dwordx4 v[64:67], v5, s[8:11], s21 offen offset:2048
 buffer_load_dwordx4 v[64:67], v5, s[8:11], s21 offen offset:3072
 s_add_u32 s21, s21, 4096
 buffer_load_dwordx4 v[64:67], v5, s[8:11], s21 offen offset:0
 buffer_load_dwordx4 v[64:67], v5, s[8:11], s21 offen offset:1024
 buffer_load_dwordx4 v[64:67], v5, s[8:11], s21 offen offset:2048
 buffer_load_dwordx4 v[64:67], v5, s[8:11], s21 offen offset:3072
 s_add_u32 s21, s21, 4096
 buffer_load_dwordx4 v[64:67], v5, s[8:11], s21 offen offset:0
 buffer_load_dwordx4 v[64:67], v5, s[8:11], s21 offen offset:1024
 buffer_load_dwordx4 v[64:67], v5, s[8:11], s21 offen offset:2048
 buffer_load_dwordx4 v[64:67], v5, s[8:11], s21 offen offset:3072
 s_add_u32 s21, s21, 4096
 buffer_load_dwordx4 v[64:67], v5, s[8:11], s21 offen offset:0
 buffer_load_dwordx4 v[64:67], v5, s[8:11], s21 offen offset:1024
 buffer_load_dwordx4 v[64:67], v5, s[8:11], s21 offen offset:2048
 buffer_load_dwordx4 v[64:67], v5, s[8:11], s21 offen offset:3072
 v_lshrrev_b32 v6, 2, v2
 v_lshl_add_u32 v7, v3, 3, v6
 v_and_b32 v8, 1, v3
 v_lshl_add_u32 v6, v8, 2, v6
 v_lshlrev_b32 v6, 1, v6
 v_bfe_u32 v8, v2, 1, 1
 s_lshl_b32 s21, s20, 2
 v_add_u32 v8, s21, v8
 v_and_b32 v9, 1, v2
 v_lshlrev_b32 v9, 3, v9
 v_lshl_add_u32 v9, v7, 8, v9
 v_add_u32 v5, 0, v8
 v_xor_b32 v5, v5, v6
 v_lshl_add_u32 v44, v5, 4, v9
 v_add_u32 v45, 65536, v44
 v_add_u32 v46, 131072, v44
 v_add_u32 v5, 2, v8
 v_xor_b32 v5, v5, v6
 v_lshl_add_u32 v47, v5, 4, v9
 v_add_u32 v48, 65536, v47
 v_add_u32 v49, 131072, v47
 s_waitcnt vmcnt(50) lgkmcnt(0)
 s_barrier
 ds_read_b64_tr_b16 a[0:1], v44 offset:0
 ds_read_b64_tr_b16 a[2:3], v44 offset:1024
 ds_read_b64_tr_b16 a[4:5], v47 offset:0
 ds_read_b64_tr_b16 a[6:7], v47 offset:1024
 ds_read_b64_tr_b16 a[8:9], v44 offset:8192
 ds_read_b64_tr_b16 a[10:11], v44 offset:9216
 ds_read_b64_tr_b16 a[12:13], v47 offset:8192
 ds_read_b64_tr_b16 a[14:15], v47 offset:9216
 ds_read_b64_tr_b16 a[16:17], v44 offset:16384
 ds_read_b64_tr_b16 a[18:19], v44 offset:17408
 ds_read_b64_tr_b16 a[20:21], v47 offset:16384
 ds_read_b64_tr_b16 a[22:23], v47 offset:17408
 ds_read_b64_tr_b16 a[24:25], v44 offset:24576
 ds_read_b64_tr_b16 a[26:27], v44 offset:25600
 ds_read_b64_tr_b16 a[28:29], v47 offset:24576
 ds_read_b64_tr_b16 a[30:31], v47 offset:25600
 ds_read_b64_tr_b16 a[32:33], v44 offset:32768
 ds_read_b64_tr_b16 a[34:35], v44 offset:33792
 ds_read_b64_tr_b16 a[36:37], v47 offset:32768
 ds_read_b64_tr_b16 a[38:39], v47 offset:33792
 s_waitcnt vmcnt(40) lgkmcnt(0)
 s_barrier
 ds_read_b64_tr_b16 a[40:41], v44 offset:40960
 ds_read_b64_tr_b16 a[42:43], v44 offset:41984
 ds_read_b64_tr_b16 a[44:45], v47 offset:40960
 ds_read_b64_tr_b16 a[46:47], v47 offset:41984
 ds_read_b64_tr_b16 a[48:49], v44 offset:49152
 ds_read_b64_tr_b16 a[50:51], v44 offset:50176
 ds_read_b64_tr_b16 a[52:53], v47 offset:49152
 ds_read_b64_tr_b16 a[54:55], v47 offset:50176
 ds_read_b64_tr_b16 a[56:57], v44 offset:57344
 ds_read_b64_tr_b16 a[58:59], v44 offset:58368
 ds_read_b64_tr_b16 a[60:61], v47 offset:57344
 ds_read_b64_tr_b16 a[62:63], v47 offset:58368
 ds_read_b64_tr_b16 a[64:65], v45 offset:0
 ds_read_b64_tr_b16 a[66:67], v45 offset:1024
 ds_read_b64_tr_b16 a[68:69], v48 offset:0
 ds_read_b64_tr_b16 a[70:71], v48 offset:1024
 ds_read_b64_tr_b16 a[72:73], v45 offset:8192
 ds_read_b64_tr_b16 a[74:75], v45 offset:9216
 ds_read_b64_tr_b16 a[76:77], v48 offset:8192
 ds_read_b64_tr_b16 a[78:79], v48 offset:9216
 s_waitcnt vmcnt(30) lgkmcnt(0)
 s_barrier
 s_mul_i32 s24, s42, 1280
 v_lshrrev_b32 v11, 3, v1
 v_and_b32 v12, 7, v1
 v_xor_b32 v12, v12, v11
 v_mul_u32_u24 v11, 2560, v11
 v_lshl_add_u32 v10, v12, 4, v11
 s_mul_i32 s46, s20, 81920
 v_add_u32 v10, s46, v10
 s_lshl_b32 s47, s20, 12
 s_add_u32 s47, s47, 0
 s_add_u32 s46, s47, 114688
 s_mov_b32 s30, s24
 s_add_u32 s32, s47, 0
 v_add_u32 v11, 19456, v10
 v_add_u32 v12, 38912, v10
 v_add_u32 v13, 58368, v10
 s_mov_b32 m0, s32
 s_nop 0
 buffer_load_dwordx4 v10, s[8:11], s30 offen offset:0 lds
 buffer_load_dwordx4 v11, s[8:11], s30 offen offset:1024 lds
 buffer_load_dwordx4 v12, s[8:11], s30 offen offset:2048 lds
 buffer_load_dwordx4 v13, s[8:11], s30 offen offset:3072 lds
 s_add_u32 s30, s30, 128
 s_add_u32 s32, s32, 16384
 s_cmp_lt_u32 s32, s46
 s_cselect_b32 s32, s32, s47
 s_mov_b32 m0, s32
 s_nop 0
 buffer_load_dwordx4 v10, s[8:11], s30 offen offset:0 lds
 buffer_load_dwordx4 v11, s[8:11], s30 offen offset:1024 lds
 buffer_load_dwordx4 v12, s[8:11], s30 offen offset:2048 lds
 buffer_load_dwordx4 v13, s[8:11], s30 offen offset:3072 lds
 s_add_u32 s30, s30, 128
 s_add_u32 s32, s32, 16384
 s_cmp_lt_u32 s32, s46
 s_cselect_b32 s32, s32, s47
 s_mov_b32 m0, s32
 s_nop 0
 buffer_load_dwordx4 v10, s[8:11], s30 offen offset:0 lds
 buffer_load_dwordx4 v11, s[8:11], s30 offen offset:1024 lds
 buffer_load_dwordx4 v12, s[8:11], s30 offen offset:2048 lds
 buffer_load_dwordx4 v13, s[8:11], s30 offen offset:3072 lds
 s_add_u32 s30, s30, 128
 s_add_u32 s32, s32, 16384
 s_cmp_lt_u32 s32, s46
 s_cselect_b32 s32, s32, s47
 s_mov_b32 m0, s32
 s_nop 0
 buffer_load_dwordx4 v10, s[8:11], s30 offen offset:0 lds
 buffer_load_dwordx4 v11, s[8:11], s30 offen offset:1024 lds
 buffer_load_dwordx4 v12, s[8:11], s30 offen offset:2048 lds
 buffer_load_dwordx4 v13, s[8:11], s30 offen offset:3072 lds
 s_add_u32 s30, s30, 128
 s_add_u32 s32, s32, 16384
 s_cmp_lt_u32 s32, s46
 s_cselect_b32 s32, s32, s47
 s_mov_b32 m0, s32
 s_nop 0
 buffer_load_dwordx4 v10, s[8:11], s30 offen offset:0 lds
 buffer_load_dwordx4 v11, s[8:11], s30 offen offset:1024 lds
 buffer_load_dwordx4 v12, s[8:11], s30 offen offset:2048 lds
 buffer_load_dwordx4 v13, s[8:11], s30 offen offset:3072 lds
 s_add_u32 s30, s30, 128
 s_add_u32 s32, s32, 16384
 s_cmp_lt_u32 s32, s46
 s_cselect_b32 s32, s32, s47
 ds_read_b64_tr_b16 a[80:81], v45 offset:16384
 ds_read_b64_tr_b16 a[82:83], v45 offset:17408
 ds_read_b64_tr_b16 a[84:85], v48 offset:16384
 ds_read_b64_tr_b16 a[86:87], v48 offset:17408
 ds_read_b64_tr_b16 a[88:89], v45 offset:24576
 ds_read_b64_tr_b16 a[90:91], v45 offset:25600
 ds_read_b64_tr_b16 a[92:93], v48 offset:24576
 ds_read_b64_tr_b16 a[94:95], v48 offset:25600
 ds_read_b64_tr_b16 a[96:97], v45 offset:32768
 ds_read_b64_tr_b16 a[98:99], v45 offset:33792
 ds_read_b64_tr_b16 a[100:101], v48 offset:32768
 ds_read_b64_tr_b16 a[102:103], v48 offset:33792
 ds_read_b64_tr_b16 a[104:105], v45 offset:40960
 ds_read_b64_tr_b16 a[106:107], v45 offset:41984
 ds_read_b64_tr_b16 a[108:109], v48 offset:40960
 ds_read_b64_tr_b16 a[110:111], v48 offset:41984
 ds_read_b64_tr_b16 a[112:113], v45 offset:49152
 ds_read_b64_tr_b16 a[114:115], v45 offset:50176
 ds_read_b64_tr_b16 a[116:117], v48 offset:49152
 ds_read_b64_tr_b16 a[118:119], v48 offset:50176
 s_waitcnt vmcnt(40) lgkmcnt(0)
 s_barrier
 ds_read_b64_tr_b16 a[120:121], v45 offset:57344
 ds_read_b64_tr_b16 a[122:123], v45 offset:58368
 ds_read_b64_tr_b16 a[124:125], v48 offset:57344
 ds_read_b64_tr_b16 a[126:127], v48 offset:58368
 ds_read_b64_tr_b16 a[128:129], v46 offset:0
 ds_read_b64_tr_b16 a[130:131], v46 offset:1024
 ds_read_b64_tr_b16 a[132:133], v49 offset:0
 ds_read_b64_tr_b16 a[134:135], v49 offset:1024
 ds_read_b64_tr_b16 a[136:137], v46 offset:8192
 ds_read_b64_tr_b16 a[138:139], v46 offset:9216
 ds_read_b64_tr_b16 a[140:141], v49 offset:8192
 ds_read_b64_tr_b16 a[142:143], v49 offset:9216
 ds_read_b64_tr_b16 a[144:145], v46 offset:16384
 ds_read_b64_tr_b16 a[146:147], v46 offset:17408
 ds_read_b64_tr_b16 a[148:149], v49 offset:16384
 ds_read_b64_tr_b16 a[150:151], v49 offset:17408
 ds_read_b64_tr_b16 a[152:153], v46 offset:24576
 ds_read_b64_tr_b16 a[154:155], v46 offset:25600
 ds_read_b64_tr_b16 a[156:157], v49 offset:24576
 ds_read_b64_tr_b16 a[158:159], v49 offset:25600
 s_waitcnt lgkmcnt(0)
 s_barrier
 s_load_dwordx2 s[12:13], s[0:1], 72
 s_lshl_b32 s21, s2, 2
 s_add_u32 s21, s21, s20
 s_mul_i32 s50, s21, 6400
 s_add_u32 s51, s50, 4096
 v_lshlrev_b32 v33, 4, v1
 s_mov_b32 s14, 819200
 v_mov_b32 v32, 76
 s_waitcnt lgkmcnt(0)
 v_and_b32 v4, 31, v1
 s_lshl_b32 s21, s20, 5
 v_add_u32 v36, s21, v4
 v_lshrrev_b32 v5, 5, v1
 v_mul_u32_u24 v6, 264, v36
 v_mul_u32_u24 v7, 40, v5
 s_mov_b32 s21, 114952
 v_add3_u32 v34, v6, v7, s21
 v_lshl_add_u32 v38, v5, 3, v34
 v_lshlrev_b32 v6, 5, v5
 v_sub_u32 v39, v34, v6
 v_lshlrev_b32 v35, 3, v1
 v_add_u32 v35, 114688, v35
 v_mov_b32 v37, 0xf149f2ca
 s_mul_i32 s21, s41, 165120
 s_mul_i32 s22, s42, 16512
 s_add_u32 s21, s21, s22
 v_lshl_add_u32 v7, v36, 4, s21
 v_mul_u32_u24 v6, 99072, v5
 v_add_u32 v29, v6, v7
 v_add_u32 v30, 33024, v29
 v_lshl_add_u32 v31, v5, 3, v7
 v_add_u32 v31, 66048, v31
 v_mov_b32 v8, 0
 v_mov_b32 v9, 0
 ds_write_b64 v35, v[8:9] offset:0
 ds_write_b64 v35, v[8:9] offset:512
 ds_write_b64 v35, v[8:9] offset:1024
 ds_write_b64 v35, v[8:9] offset:1536
 ds_write_b64 v35, v[8:9] offset:2048
 s_mul_i32 s24, s42, 1280
 s_mov_b32 s25, 327680
 s_mov_b32 s26, 8
 s_mov_b32 s27, 0
 s_mov_b32 s60, 0x3e64f92e
 s_mov_b32 s61, 0x3fb8aa3b
 s_mov_b32 s62, 0x05040100
 s_mov_b32 s63, 0x07060302
 v_cmp_le_u32 s[76:77], 0, v36
 v_cmp_le_u32 s[78:79], 1, v36
 v_cmp_le_u32 s[80:81], 2, v36
 v_cmp_le_u32 s[82:83], 3, v36
 v_cmp_le_u32 s[84:85], 4, v36
 v_cmp_le_u32 s[86:87], 5, v36
 v_cmp_le_u32 s[88:89], 6, v36
 v_cmp_le_u32 s[90:91], 7, v36
 v_and_b32 v6, 7, v2
 v_add_u32 v4, 0, v3
 v_xor_b32 v4, v4, v6
 v_lshlrev_b32 v4, 4, v4
 v_lshl_add_u32 v14, v2, 7, v4
 v_add_u32 v4, 4, v3
 v_xor_b32 v4, v4, v6
 v_lshlrev_b32 v4, 4, v4
 v_lshl_add_u32 v15, v2, 7, v4
 v_mul_u32_u24 v22, 264, v2
 v_mul_u32_u24 v4, 8, v3
 s_mul_i32 s21, s20, 64
 s_add_u32 s21, s21, 116800
 v_add3_u32 v22, v22, v4, s21
 v_lshlrev_b32 v4, 3, v3
 v_sub_u32 v16, v22, v4
 v_mov_b32 v9, 2731
 s_mov_b32 s33, 0
 s_mov_b32 s48, 0x80000000
 s_mov_b32 m0, s32
 s_nop 0
 buffer_load_dwordx4 v10, s[8:11], s30 offen offset:0 lds
 buffer_load_dwordx4 v11, s[8:11], s30 offen offset:1024 lds
 s_waitcnt vmcnt(18)
 s_barrier
 v_add_u32 v18, s33, v14
 v_add_u32 v19, s33, v15
 s_add_u32 s33, s33, 16384
 s_cmp_lt_u32 s33, 114688
 s_cselect_b32 s33, s33, 0
 ds_read_b128 v[160:163], v18 offset:0
 ds_read_b128 v[164:167], v18 offset:2048
 ds_read_b128 v[168:171], v18 offset:4096
 ds_read_b128 v[172:175], v18 offset:6144
 ds_read_b128 v[176:179], v18 offset:8192
 ds_read_b128 v[180:183], v18 offset:10240
 ds_read_b128 v[184:187], v18 offset:12288
 ds_read_b128 v[188:191], v18 offset:14336
 s_waitcnt lgkmcnt(0)
bf_blk_185:
 v_mfma_f32_16x16x32_bf16 v[64:67], a[0:3], v[160:163], 0
 ds_read_b128 v[192:195], v19 offset:0
 v_mfma_f32_16x16x32_bf16 v[68:71], a[4:7], v[160:163], 0
 v_add_u32 v18, s33, v14
 v_mfma_f32_16x16x32_bf16 v[72:75], a[0:3], v[164:167], 0
 ds_read_b128 v[196:199], v19 offset:2048
 v_mfma_f32_16x16x32_bf16 v[76:79], a[4:7], v[164:167], 0
 buffer_load_dwordx4 v12, s[8:11], s30 offen offset:2048 lds
 v_mfma_f32_16x16x32_bf16 v[80:83], a[0:3], v[168:171], 0
 ds_read_b128 v[200:203], v19 offset:4096
 v_mfma_f32_16x16x32_bf16 v[84:87], a[4:7], v[168:171], 0
 v_mfma_f32_16x16x32_bf16 v[88:91], a[0:3], v[172:175], 0
 ds_read_b128 v[204:207], v19 offset:6144
 v_mfma_f32_16x16x32_bf16 v[92:95], a[4:7], v[172:175], 0
 s_waitcnt lgkmcnt(14)
 v_mfma_f32_16x16x32_bf16 v[96:99], a[0:3], v[176:179], 0
 ds_read_b128 v[208:211], v19 offset:8192
 v_mfma_f32_16x16x32_bf16 v[100:103], a[4:7], v[176:179], 0
 v_mfma_f32_16x16x32_bf16 v[104:107], a[0:3], v[180:183], 0
 ds_read_b128 v[212:215], v19 offset:10240
 v_mfma_f32_16x16x32_bf16 v[108:111], a[4:7], v[180:183], 0
 buffer_load_dwordx4 v13, s[8:11], s30 offen offset:3072 lds
 v_mfma_f32_16x16x32_bf16 v[112:115], a[0:3], v[184:187], 0
 ds_read_b128 v[216:219], v19 offset:12288
 s_add_u32 s30, s30, 128
 v_mfma_f32_16x16x32_bf16 v[116:119], a[4:7], v[184:187], 0
 s_add_u32 m0, m0, 16384
 v_mfma_f32_16x16x32_bf16 v[120:123], a[0:3], v[188:191], 0
 ds_read_b128 v[220:223], v19 offset:14336
 v_mfma_f32_16x16x32_bf16 v[124:127], a[4:7], v[188:191], 0
 s_waitcnt vmcnt(16) lgkmcnt(4)
 s_barrier
 v_mfma_f32_16x16x32_bf16 v[64:67], a[8:11], v[192:195], v[64:67]
 ds_read_b128 v[160:163], v18 offset:0
 v_mfma_f32_16x16x32_bf16 v[68:71], a[12:15], v[192:195], v[68:71]
 s_cmp_lt_u32 m0, s46
 s_cselect_b32 m0, m0, s47
 v_mfma_f32_16x16x32_bf16 v[72:75], a[8:11], v[196:199], v[72:75]
 ds_read_b128 v[164:167], v18 offset:2048
 v_add_u32 v19, s33, v15
 v_mfma_f32_16x16x32_bf16 v[76:79], a[12:15], v[196:199], v[76:79]
 buffer_load_dwordx4 v10, s[8:11], s30 offen offset:0 lds
 v_mfma_f32_16x16x32_bf16 v[80:83], a[8:11], v[200:203], v[80:83]
 ds_read_b128 v[168:171], v18 offset:4096
 s_add_u32 s33, s33, 16384
 v_mfma_f32_16x16x32_bf16 v[84:87], a[12:15], v[200:203], v[84:87]
 s_cmp_lt_u32 s33, 114688
 s_cselect_b32 s33, s33, 0
 v_mfma_f32_16x16x32_bf16 v[88:91], a[8:11], v[204:207], v[88:91]
 ds_read_b128 v[172:175], v18 offset:6144
 v_mfma_f32_16x16x32_bf16 v[92:95], a[12:15], v[204:207], v[92:95]
 s_waitcnt lgkmcnt(4)
 v_mfma_f32_16x16x32_bf16 v[96:99], a[8:11], v[208:211], v[96:99]
 ds_read_b128 v[176:179], v18 offset:8192
 v_mfma_f32_16x16x32_bf16 v[100:103], a[12:15], v[208:211], v[100:103]
 v_mfma_f32_16x16x32_bf16 v[104:107], a[8:11], v[212:215], v[104:107]
 ds_read_b128 v[180:183], v18 offset:10240
 v_mfma_f32_16x16x32_bf16 v[108:111], a[12:15], v[212:215], v[108:111]
 buffer_load_dwordx4 v11, s[8:11], s30 offen offset:1024 lds
 v_mfma_f32_16x16x32_bf16 v[112:115], a[8:11], v[216:219], v[112:115]
 ds_read_b128 v[184:187], v18 offset:12288
 v_mfma_f32_16x16x32_bf16 v[116:119], a[12:15], v[216:219], v[116:119]
 v_mfma_f32_16x16x32_bf16 v[120:123], a[8:11], v[220:223], v[120:123]
 ds_read_b128 v[188:191], v18 offset:14336
 v_mfma_f32_16x16x32_bf16 v[124:127], a[12:15], v[220:223], v[124:127]
 s_waitcnt lgkmcnt(4)
 v_mfma_f32_16x16x32_bf16 v[64:67], a[16:19], v[160:163], v[64:67]
 ds_read_b128 v[192:195], v19 offset:0
 v_mfma_f32_16x16x32_bf16 v[68:71], a[20:23], v[160:163], v[68:71]
 v_add_u32 v18, s33, v14
 v_mfma_f32_16x16x32_bf16 v[72:75], a[16:19], v[164:167], v[72:75]
 ds_read_b128 v[196:199], v19 offset:2048
 v_mfma_f32_16x16x32_bf16 v[76:79], a[20:23], v[164:167], v[76:79]
 buffer_load_dwordx4 v12, s[8:11], s30 offen offset:2048 lds
 v_mfma_f32_16x16x32_bf16 v[80:83], a[16:19], v[168:171], v[80:83]
 ds_read_b128 v[200:203], v19 offset:4096
 v_mfma_f32_16x16x32_bf16 v[84:87], a[20:23], v[168:171], v[84:87]
 v_mfma_f32_16x16x32_bf16 v[88:91], a[16:19], v[172:175], v[88:91]
 ds_read_b128 v[204:207], v19 offset:6144
 v_mfma_f32_16x16x32_bf16 v[92:95], a[20:23], v[172:175], v[92:95]
 s_waitcnt lgkmcnt(4)
 v_mfma_f32_16x16x32_bf16 v[96:99], a[16:19], v[176:179], v[96:99]
 ds_read_b128 v[208:211], v19 offset:8192
 v_mfma_f32_16x16x32_bf16 v[100:103], a[20:23], v[176:179], v[100:103]
 v_mfma_f32_16x16x32_bf16 v[104:107], a[16:19], v[180:183], v[104:107]
 ds_read_b128 v[212:215], v19 offset:10240
 v_mfma_f32_16x16x32_bf16 v[108:111], a[20:23], v[180:183], v[108:111]
 buffer_load_dwordx4 v13, s[8:11], s30 offen offset:3072 lds
 v_mfma_f32_16x16x32_bf16 v[112:115], a[16:19], v[184:187], v[112:115]
 ds_read_b128 v[216:219], v19 offset:12288
 s_add_u32 s30, s30, 128
 v_mfma_f32_16x16x32_bf16 v[116:119], a[20:23], v[184:187], v[116:119]
 s_add_u32 m0, m0, 16384
 v_mfma_f32_16x16x32_bf16 v[120:123], a[16:19], v[188:191], v[120:123]
 ds_read_b128 v[220:223], v19 offset:14336
 v_mfma_f32_16x16x32_bf16 v[124:127], a[20:23], v[188:191], v[124:127]
 s_waitcnt vmcnt(16) lgkmcnt(4)
 s_barrier
 v_mfma_f32_16x16x32_bf16 v[64:67], a[24:27], v[192:195], v[64:67]
 ds_read_b128 v[160:163], v18 offset:0
 v_mfma_f32_16x16x32_bf16 v[68:71], a[28:31], v[192:195], v[68:71]
 s_cmp_lt_u32 m0, s46
 s_cselect_b32 m0, m0, s47
 v_mfma_f32_16x16x32_bf16 v[72:75], a[24:27], v[196:199], v[72:75]
 ds_read_b128 v[164:167], v18 offset:2048
 v_add_u32 v19, s33, v15
 v_mfma_f32_16x16x32_bf16 v[76:79], a[28:31], v[196:199], v[76:79]
 buffer_load_dwordx4 v10, s[8:11], s30 offen offset:0 lds
 v_mfma_f32_16x16x32_bf16 v[80:83], a[24:27], v[200:203], v[80:83]
 ds_read_b128 v[168:171], v18 offset:4096
 s_add_u32 s33, s33, 16384
 v_mfma_f32_16x16x32_bf16 v[84:87], a[28:31], v[200:203], v[84:87]
 s_cmp_lt_u32 s33, 114688
 s_cselect_b32 s33, s33, 0
 v_mfma_f32_16x16x32_bf16 v[88:91], a[24:27], v[204:207], v[88:91]
 ds_read_b128 v[172:175], v18 offset:6144
 v_mfma_f32_16x16x32_bf16 v[92:95], a[28:31], v[204:207], v[92:95]
 s_waitcnt lgkmcnt(4)
 v_mfma_f32_16x16x32_bf16 v[96:99], a[24:27], v[208:211], v[96:99]
 ds_read_b128 v[176:179], v18 offset:8192
 v_mfma_f32_16x16x32_bf16 v[100:103], a[28:31], v[208:211], v[100:103]
 v_mfma_f32_16x16x32_bf16 v[104:107], a[24:27], v[212:215], v[104:107]
 ds_read_b128 v[180:183], v18 offset:10240
 v_mfma_f32_16x16x32_bf16 v[108:111], a[28:31], v[212:215], v[108:111]
 buffer_load_dwordx4 v11, s[8:11], s30 offen offset:1024 lds
 v_mfma_f32_16x16x32_bf16 v[112:115], a[24:27], v[216:219], v[112:115]
 ds_read_b128 v[184:187], v18 offset:12288
 v_mfma_f32_16x16x32_bf16 v[116:119], a[28:31], v[216:219], v[116:119]
 v_mfma_f32_16x16x32_bf16 v[120:123], a[24:27], v[220:223], v[120:123]
 ds_read_b128 v[188:191], v18 offset:14336
 v_mfma_f32_16x16x32_bf16 v[124:127], a[28:31], v[220:223], v[124:127]
 s_waitcnt lgkmcnt(4)
 v_mfma_f32_16x16x32_bf16 v[64:67], a[32:35], v[160:163], v[64:67]
 ds_read_b128 v[192:195], v19 offset:0
 v_mfma_f32_16x16x32_bf16 v[68:71], a[36:39], v[160:163], v[68:71]
 v_add_u32 v18, s33, v14
 v_mfma_f32_16x16x32_bf16 v[72:75], a[32:35], v[164:167], v[72:75]
 ds_read_b128 v[196:199], v19 offset:2048
 v_mfma_f32_16x16x32_bf16 v[76:79], a[36:39], v[164:167], v[76:79]
 buffer_load_dwordx4 v12, s[8:11], s30 offen offset:2048 lds
 v_mfma_f32_16x16x32_bf16 v[80:83], a[32:35], v[168:171], v[80:83]
 ds_read_b128 v[200:203], v19 offset:4096
 v_mfma_f32_16x16x32_bf16 v[84:87], a[36:39], v[168:171], v[84:87]
 v_mfma_f32_16x16x32_bf16 v[88:91], a[32:35], v[172:175], v[88:91]
 ds_read_b128 v[204:207], v19 offset:6144
 v_mfma_f32_16x16x32_bf16 v[92:95], a[36:39], v[172:175], v[92:95]
 s_waitcnt lgkmcnt(4)
 v_mfma_f32_16x16x32_bf16 v[96:99], a[32:35], v[176:179], v[96:99]
 ds_read_b128 v[208:211], v19 offset:8192
 v_mfma_f32_16x16x32_bf16 v[100:103], a[36:39], v[176:179], v[100:103]
 v_mfma_f32_16x16x32_bf16 v[104:107], a[32:35], v[180:183], v[104:107]
 ds_read_b128 v[212:215], v19 offset:10240
 v_mfma_f32_16x16x32_bf16 v[108:111], a[36:39], v[180:183], v[108:111]
 buffer_load_dwordx4 v13, s[8:11], s30 offen offset:3072 lds
 v_mfma_f32_16x16x32_bf16 v[112:115], a[32:35], v[184:187], v[112:115]
 ds_read_b128 v[216:219], v19 offset:12288
 s_add_u32 s30, s30, 128
 v_mfma_f32_16x16x32_bf16 v[116:119], a[36:39], v[184:187], v[116:119]
 s_add_u32 m0, m0, 16384
 v_mfma_f32_16x16x32_bf16 v[120:123], a[32:35], v[188:191], v[120:123]
 ds_read_b128 v[220:223], v19 offset:14336
 v_mfma_f32_16x16x32_bf16 v[124:127], a[36:39], v[188:191], v[124:127]
 s_waitcnt vmcnt(16) lgkmcnt(4)
 s_barrier
 v_mfma_f32_16x16x32_bf16 v[64:67], a[40:43], v[192:195], v[64:67]
 ds_read_b128 v[160:163], v18 offset:0
 v_mfma_f32_16x16x32_bf16 v[68:71], a[44:47], v[192:195], v[68:71]
 s_cmp_lt_u32 m0, s46
 s_cselect_b32 m0, m0, s47
 v_mfma_f32_16x16x32_bf16 v[72:75], a[40:43], v[196:199], v[72:75]
 ds_read_b128 v[164:167], v18 offset:2048
 v_add_u32 v19, s33, v15
 v_mfma_f32_16x16x32_bf16 v[76:79], a[44:47], v[196:199], v[76:79]
 buffer_load_dwordx4 v10, s[8:11], s30 offen offset:0 lds
 v_mfma_f32_16x16x32_bf16 v[80:83], a[40:43], v[200:203], v[80:83]
 ds_read_b128 v[168:171], v18 offset:4096
 s_add_u32 s33, s33, 16384
 v_mfma_f32_16x16x32_bf16 v[84:87], a[44:47], v[200:203], v[84:87]
 s_cmp_lt_u32 s33, 114688
 s_cselect_b32 s33, s33, 0
 v_mfma_f32_16x16x32_bf16 v[88:91], a[40:43], v[204:207], v[88:91]
 ds_read_b128 v[172:175], v18 offset:6144
 v_mfma_f32_16x16x32_bf16 v[92:95], a[44:47], v[204:207], v[92:95]
 s_waitcnt lgkmcnt(4)
 v_mfma_f32_16x16x32_bf16 v[96:99], a[40:43], v[208:211], v[96:99]
 ds_read_b128 v[176:179], v18 offset:8192
 v_mfma_f32_16x16x32_bf16 v[100:103], a[44:47], v[208:211], v[100:103]
 v_mfma_f32_16x16x32_bf16 v[104:107], a[40:43], v[212:215], v[104:107]
 ds_read_b128 v[180:183], v18 offset:10240
 v_mfma_f32_16x16x32_bf16 v[108:111], a[44:47], v[212:215], v[108:111]
 buffer_load_dwordx4 v11, s[8:11], s30 offen offset:1024 lds
 v_mfma_f32_16x16x32_bf16 v[112:115], a[40:43], v[216:219], v[112:115]
 ds_read_b128 v[184:187], v18 offset:12288
 v_mfma_f32_16x16x32_bf16 v[116:119], a[44:47], v[216:219], v[116:119]
 v_mfma_f32_16x16x32_bf16 v[120:123], a[40:43], v[220:223], v[120:123]
 ds_read_b128 v[188:191], v18 offset:14336
 v_mfma_f32_16x16x32_bf16 v[124:127], a[44:47], v[220:223], v[124:127]
 s_waitcnt lgkmcnt(4)
 v_mfma_f32_16x16x32_bf16 v[64:67], a[48:51], v[160:163], v[64:67]
 ds_read_b128 v[192:195], v19 offset:0
 v_mfma_f32_16x16x32_bf16 v[68:71], a[52:55], v[160:163], v[68:71]
 v_add_u32 v18, s33, v14
 v_mfma_f32_16x16x32_bf16 v[72:75], a[48:51], v[164:167], v[72:75]
 ds_read_b128 v[196:199], v19 offset:2048
 v_mfma_f32_16x16x32_bf16 v[76:79], a[52:55], v[164:167], v[76:79]
 buffer_load_dwordx4 v12, s[8:11], s30 offen offset:2048 lds
 v_mfma_f32_16x16x32_bf16 v[80:83], a[48:51], v[168:171], v[80:83]
 ds_read_b128 v[200:203], v19 offset:4096
 v_mfma_f32_16x16x32_bf16 v[84:87], a[52:55], v[168:171], v[84:87]
 v_mfma_f32_16x16x32_bf16 v[88:91], a[48:51], v[172:175], v[88:91]
 ds_read_b128 v[204:207], v19 offset:6144
 v_mfma_f32_16x16x32_bf16 v[92:95], a[52:55], v[172:175], v[92:95]
 s_waitcnt lgkmcnt(4)
 v_mfma_f32_16x16x32_bf16 v[96:99], a[48:51], v[176:179], v[96:99]
 ds_read_b128 v[208:211], v19 offset:8192
 v_mfma_f32_16x16x32_bf16 v[100:103], a[52:55], v[176:179], v[100:103]
 v_mfma_f32_16x16x32_bf16 v[104:107], a[48:51], v[180:183], v[104:107]
 ds_read_b128 v[212:215], v19 offset:10240
 v_mfma_f32_16x16x32_bf16 v[108:111], a[52:55], v[180:183], v[108:111]
 buffer_load_dwordx4 v13, s[8:11], s30 offen offset:3072 lds
 v_mfma_f32_16x16x32_bf16 v[112:115], a[48:51], v[184:187], v[112:115]
 ds_read_b128 v[216:219], v19 offset:12288
 s_add_u32 s30, s30, 128
 v_mfma_f32_16x16x32_bf16 v[116:119], a[52:55], v[184:187], v[116:119]
 s_add_u32 m0, m0, 16384
 v_mfma_f32_16x16x32_bf16 v[120:123], a[48:51], v[188:191], v[120:123]
 ds_read_b128 v[220:223], v19 offset:14336
 v_mfma_f32_16x16x32_bf16 v[124:127], a[52:55], v[188:191], v[124:127]
 s_waitcnt vmcnt(16) lgkmcnt(4)
 s_barrier
 v_mfma_f32_16x16x32_bf16 v[64:67], a[56:59], v[192:195], v[64:67]
 ds_read_b128 v[160:163], v18 offset:0
 v_mfma_f32_16x16x32_bf16 v[68:71], a[60:63], v[192:195], v[68:71]
 s_cmp_lt_u32 m0, s46
 s_cselect_b32 m0, m0, s47
 v_mfma_f32_16x16x32_bf16 v[72:75], a[56:59], v[196:199], v[72:75]
 ds_read_b128 v[164:167], v18 offset:2048
 v_add_u32 v19, s33, v15
 v_mfma_f32_16x16x32_bf16 v[76:79], a[60:63], v[196:199], v[76:79]
 buffer_load_dwordx4 v10, s[8:11], s30 offen offset:0 lds
 v_mfma_f32_16x16x32_bf16 v[80:83], a[56:59], v[200:203], v[80:83]
 ds_read_b128 v[168:171], v18 offset:4096
 s_add_u32 s33, s33, 16384
 v_mfma_f32_16x16x32_bf16 v[84:87], a[60:63], v[200:203], v[84:87]
 s_cmp_lt_u32 s33, 114688
 s_cselect_b32 s33, s33, 0
 v_mfma_f32_16x16x32_bf16 v[88:91], a[56:59], v[204:207], v[88:91]
 ds_read_b128 v[172:175], v18 offset:6144
 v_mfma_f32_16x16x32_bf16 v[92:95], a[60:63], v[204:207], v[92:95]
 s_waitcnt lgkmcnt(4)
 v_mfma_f32_16x16x32_bf16 v[96:99], a[56:59], v[208:211], v[96:99]
 ds_read_b128 v[176:179], v18 offset:8192
 v_mfma_f32_16x16x32_bf16 v[100:103], a[60:63], v[208:211], v[100:103]
 v_mfma_f32_16x16x32_bf16 v[104:107], a[56:59], v[212:215], v[104:107]
 ds_read_b128 v[180:183], v18 offset:10240
 v_mfma_f32_16x16x32_bf16 v[108:111], a[60:63], v[212:215], v[108:111]
 buffer_load_dwordx4 v11, s[8:11], s30 offen offset:1024 lds
 v_mfma_f32_16x16x32_bf16 v[112:115], a[56:59], v[216:219], v[112:115]
 ds_read_b128 v[184:187], v18 offset:12288
 v_mfma_f32_16x16x32_bf16 v[116:119], a[60:63], v[216:219], v[116:119]
 v_mfma_f32_16x16x32_bf16 v[120:123], a[56:59], v[220:223], v[120:123]
 ds_read_b128 v[188:191], v18 offset:14336
 v_mfma_f32_16x16x32_bf16 v[124:127], a[60:63], v[220:223], v[124:127]
 s_waitcnt lgkmcnt(4)
 v_mfma_f32_16x16x32_bf16 v[64:67], a[64:67], v[160:163], v[64:67]
 ds_read_b128 v[192:195], v19 offset:0
 v_mfma_f32_16x16x32_bf16 v[68:71], a[68:71], v[160:163], v[68:71]
 v_add_u32 v18, s33, v14
 v_mfma_f32_16x16x32_bf16 v[72:75], a[64:67], v[164:167], v[72:75]
 ds_read_b128 v[196:199], v19 offset:2048
 v_mfma_f32_16x16x32_bf16 v[76:79], a[68:71], v[164:167], v[76:79]
 buffer_load_dwordx4 v12, s[8:11], s30 offen offset:2048 lds
 v_mfma_f32_16x16x32_bf16 v[80:83], a[64:67], v[168:171], v[80:83]
 ds_read_b128 v[200:203], v19 offset:4096
 v_mfma_f32_16x16x32_bf16 v[84:87], a[68:71], v[168:171], v[84:87]
 v_mfma_f32_16x16x32_bf16 v[88:91], a[64:67], v[172:175], v[88:91]
 ds_read_b128 v[204:207], v19 offset:6144
 v_mfma_f32_16x16x32_bf16 v[92:95], a[68:71], v[172:175], v[92:95]
 s_waitcnt lgkmcnt(4)
 v_mfma_f32_16x16x32_bf16 v[96:99], a[64:67], v[176:179], v[96:99]
 ds_read_b128 v[208:211], v19 offset:8192
 v_mfma_f32_16x16x32_bf16 v[100:103], a[68:71], v[176:179], v[100:103]
 v_mfma_f32_16x16x32_bf16 v[104:107], a[64:67], v[180:183], v[104:107]
 ds_read_b128 v[212:215], v19 offset:10240
 v_mfma_f32_16x16x32_bf16 v[108:111], a[68:71], v[180:183], v[108:111]
 buffer_load_dwordx4 v13, s[8:11], s30 offen offset:3072 lds
 v_mfma_f32_16x16x32_bf16 v[112:115], a[64:67], v[184:187], v[112:115]
 ds_read_b128 v[216:219], v19 offset:12288
 s_add_u32 s30, s30, s25
 v_mfma_f32_16x16x32_bf16 v[116:119], a[68:71], v[184:187], v[116:119]
 s_sub_u32 s30, s30, 1152
 s_add_u32 m0, m0, 16384
 v_mfma_f32_16x16x32_bf16 v[120:123], a[64:67], v[188:191], v[120:123]
 ds_read_b128 v[220:223], v19 offset:14336
 v_mfma_f32_16x16x32_bf16 v[124:127], a[68:71], v[188:191], v[124:127]
 s_waitcnt vmcnt(16) lgkmcnt(4)
 s_barrier
 v_mfma_f32_16x16x32_bf16 v[64:67], a[72:75], v[192:195], v[64:67]
 ds_read_b128 v[160:163], v18 offset:0
 v_mfma_f32_16x16x32_bf16 v[68:71], a[76:79], v[192:195], v[68:71]
 s_cmp_lt_u32 m0, s46
 s_cselect_b32 m0, m0, s47
 v_mfma_f32_16x16x32_bf16 v[72:75], a[72:75], v[196:199], v[72:75]
 ds_read_b128 v[164:167], v18 offset:2048
 v_add_u32 v19, s33, v15
 v_mfma_f32_16x16x32_bf16 v[76:79], a[76:79], v[196:199], v[76:79]
 buffer_load_dwordx4 v10, s[8:11], s30 offen offset:0 lds
 v_mfma_f32_16x16x32_bf16 v[80:83], a[72:75], v[200:203], v[80:83]
 ds_read_b128 v[168:171], v18 offset:4096
 s_add_u32 s33, s33, 16384
 v_mfma_f32_16x16x32_bf16 v[84:87], a[76:79], v[200:203], v[84:87]
 s_cmp_lt_u32 s33, 114688
 s_cselect_b32 s33, s33, 0
 v_mfma_f32_16x16x32_bf16 v[88:91], a[72:75], v[204:207], v[88:91]
 ds_read_b128 v[172:175], v18 offset:6144
 v_mfma_f32_16x16x32_bf16 v[92:95], a[76:79], v[204:207], v[92:95]
 s_waitcnt lgkmcnt(4)
 v_mfma_f32_16x16x32_bf16 v[96:99], a[72:75], v[208:211], v[96:99]
 ds_read_b128 v[176:179], v18 offset:8192
 v_mfma_f32_16x16x32_bf16 v[100:103], a[76:79], v[208:211], v[100:103]
 v_mfma_f32_16x16x32_bf16 v[104:107], a[72:75], v[212:215], v[104:107]
 ds_read_b128 v[180:183], v18 offset:10240
 v_mfma_f32_16x16x32_bf16 v[108:111], a[76:79], v[212:215], v[108:111]
 buffer_load_dwordx4 v11, s[8:11], s30 offen offset:1024 lds
 v_mfma_f32_16x16x32_bf16 v[112:115], a[72:75], v[216:219], v[112:115]
 ds_read_b128 v[184:187], v18 offset:12288
 v_mfma_f32_16x16x32_bf16 v[116:119], a[76:79], v[216:219], v[116:119]
 v_mfma_f32_16x16x32_bf16 v[120:123], a[72:75], v[220:223], v[120:123]
 ds_read_b128 v[188:191], v18 offset:14336
 v_mfma_f32_16x16x32_bf16 v[124:127], a[76:79], v[220:223], v[124:127]
 s_waitcnt lgkmcnt(4)
 v_mfma_f32_16x16x32_bf16 v[64:67], a[80:83], v[160:163], v[64:67]
 ds_read_b128 v[192:195], v19 offset:0
 v_mfma_f32_16x16x32_bf16 v[68:71], a[84:87], v[160:163], v[68:71]
 v_add_u32 v18, s33, v14
 v_mfma_f32_16x16x32_bf16 v[72:75], a[80:83], v[164:167], v[72:75]
 ds_read_b128 v[196:199], v19 offset:2048
 v_mfma_f32_16x16x32_bf16 v[76:79], a[84:87], v[164:167], v[76:79]
 buffer_load_dwordx4 v12, s[8:11], s30 offen offset:2048 lds
 v_mfma_f32_16x16x32_bf16 v[80:83], a[80:83], v[168:171], v[80:83]
 ds_read_b128 v[200:203], v19 offset:4096
 v_mfma_f32_16x16x32_bf16 v[84:87], a[84:87], v[168:171], v[84:87]
 v_mfma_f32_16x16x32_bf16 v[88:91], a[80:83], v[172:175], v[88:91]
 ds_read_b128 v[204:207], v19 offset:6144
 v_mfma_f32_16x16x32_bf16 v[92:95], a[84:87], v[172:175], v[92:95]
 s_waitcnt lgkmcnt(4)
 v_mfma_f32_16x16x32_bf16 v[96:99], a[80:83], v[176:179], v[96:99]
 ds_read_b128 v[208:211], v19 offset:8192
 v_mfma_f32_16x16x32_bf16 v[100:103], a[84:87], v[176:179], v[100:103]
 v_mfma_f32_16x16x32_bf16 v[104:107], a[80:83], v[180:183], v[104:107]
 ds_read_b128 v[212:215], v19 offset:10240
 v_mfma_f32_16x16x32_bf16 v[108:111], a[84:87], v[180:183], v[108:111]
 buffer_load_dwordx4 v13, s[8:11], s30 offen offset:3072 lds
 v_mfma_f32_16x16x32_bf16 v[112:115], a[80:83], v[184:187], v[112:115]
 ds_read_b128 v[216:219], v19 offset:12288
 s_add_u32 s30, s30, 128
 v_mfma_f32_16x16x32_bf16 v[116:119], a[84:87], v[184:187], v[116:119]
 s_add_u32 m0, m0, 16384
 v_mfma_f32_16x16x32_bf16 v[120:123], a[80:83], v[188:191], v[120:123]
 ds_read_b128 v[220:223], v19 offset:14336
 v_mfma_f32_16x16x32_bf16 v[124:127], a[84:87], v[188:191], v[124:127]
 s_waitcnt vmcnt(16) lgkmcnt(4)
 s_barrier
 v_mfma_f32_16x16x32_bf16 v[64:67], a[88:91], v[192:195], v[64:67]
 ds_read_b128 v[160:163], v18 offset:0
 v_mfma_f32_16x16x32_bf16 v[68:71], a[92:95], v[192:195], v[68:71]
 s_cmp_lt_u32 m0, s46
 s_cselect_b32 m0, m0, s47
 v_mfma_f32_16x16x32_bf16 v[72:75], a[88:91], v[196:199], v[72:75]
 ds_read_b128 v[164:167], v18 offset:2048
 v_add_u32 v19, s33, v15
 v_mfma_f32_16x16x32_bf16 v[76:79], a[92:95], v[196:199], v[76:79]
 buffer_load_dwordx4 v10, s[8:11], s30 offen offset:0 lds
 v_mfma_f32_16x16x32_bf16 v[80:83], a[88:91], v[200:203], v[80:83]
 ds_read_b128 v[168:171], v18 offset:4096
 s_add_u32 s33, s33, 16384
 v_mfma_f32_16x16x32_bf16 v[84:87], a[92:95], v[200:203], v[84:87]
 s_cmp_lt_u32 s33, 114688
 s_cselect_b32 s33, s33, 0
 v_mfma_f32_16x16x32_bf16 v[88:91], a[88:91], v[204:207], v[88:91]
 ds_read_b128 v[172:175], v18 offset:6144
 v_mfma_f32_16x16x32_bf16 v[92:95], a[92:95], v[204:207], v[92:95]
 s_waitcnt lgkmcnt(4)
 v_mfma_f32_16x16x32_bf16 v[96:99], a[88:91], v[208:211], v[96:99]
 ds_read_b128 v[176:179], v18 offset:8192
 v_mfma_f32_16x16x32_bf16 v[100:103], a[92:95], v[208:211], v[100:103]
 v_mfma_f32_16x16x32_bf16 v[104:107], a[88:91], v[212:215], v[104:107]
 ds_read_b128 v[180:183], v18 offset:10240
 v_mfma_f32_16x16x32_bf16 v[108:111], a[92:95], v[212:215], v[108:111]
 buffer_load_dwordx4 v11, s[8:11], s30 offen offset:1024 lds
 v_mfma_f32_16x16x32_bf16 v[112:115], a[88:91], v[216:219], v[112:115]
 ds_read_b128 v[184:187], v18 offset:12288
 v_mfma_f32_16x16x32_bf16 v[116:119], a[92:95], v[216:219], v[116:119]
 v_mfma_f32_16x16x32_bf16 v[120:123], a[88:91], v[220:223], v[120:123]
 ds_read_b128 v[188:191], v18 offset:14336
 v_mfma_f32_16x16x32_bf16 v[124:127], a[92:95], v[220:223], v[124:127]
 s_waitcnt lgkmcnt(4)
 v_mfma_f32_16x16x32_bf16 v[64:67], a[96:99], v[160:163], v[64:67]
 ds_read_b128 v[192:195], v19 offset:0
 v_mfma_f32_16x16x32_bf16 v[68:71], a[100:103], v[160:163], v[68:71]
 v_add_u32 v18, s33, v14
 v_mfma_f32_16x16x32_bf16 v[72:75], a[96:99], v[164:167], v[72:75]
 ds_read_b128 v[196:199], v19 offset:2048
 v_mfma_f32_16x16x32_bf16 v[76:79], a[100:103], v[164:167], v[76:79]
 buffer_load_dwordx4 v12, s[8:11], s30 offen offset:2048 lds
 v_mfma_f32_16x16x32_bf16 v[80:83], a[96:99], v[168:171], v[80:83]
 ds_read_b128 v[200:203], v19 offset:4096
 v_mfma_f32_16x16x32_bf16 v[84:87], a[100:103], v[168:171], v[84:87]
 v_mfma_f32_16x16x32_bf16 v[88:91], a[96:99], v[172:175], v[88:91]
 ds_read_b128 v[204:207], v19 offset:6144
 v_mfma_f32_16x16x32_bf16 v[92:95], a[100:103], v[172:175], v[92:95]
 s_waitcnt lgkmcnt(4)
 v_mfma_f32_16x16x32_bf16 v[96:99], a[96:99], v[176:179], v[96:99]
 ds_read_b128 v[208:211], v19 offset:8192
 v_mfma_f32_16x16x32_bf16 v[100:103], a[100:103], v[176:179], v[100:103]
 v_mfma_f32_16x16x32_bf16 v[104:107], a[96:99], v[180:183], v[104:107]
 ds_read_b128 v[212:215], v19 offset:10240
 v_mfma_f32_16x16x32_bf16 v[108:111], a[100:103], v[180:183], v[108:111]
 buffer_load_dwordx4 v13, s[8:11], s30 offen offset:3072 lds
 v_mfma_f32_16x16x32_bf16 v[112:115], a[96:99], v[184:187], v[112:115]
 ds_read_b128 v[216:219], v19 offset:12288
 s_add_u32 s30, s30, 128
 v_mfma_f32_16x16x32_bf16 v[116:119], a[100:103], v[184:187], v[116:119]
 s_add_u32 m0, m0, 16384
 v_mfma_f32_16x16x32_bf16 v[120:123], a[96:99], v[188:191], v[120:123]
 ds_read_b128 v[220:223], v19 offset:14336
 v_mfma_f32_16x16x32_bf16 v[124:127], a[100:103], v[188:191], v[124:127]
 s_waitcnt vmcnt(16) lgkmcnt(4)
 s_barrier
 v_mfma_f32_16x16x32_bf16 v[64:67], a[104:107], v[192:195], v[64:67]
 ds_read_b128 v[160:163], v18 offset:0
 v_mfma_f32_16x16x32_bf16 v[68:71], a[108:111], v[192:195], v[68:71]
 s_cmp_lt_u32 m0, s46
 s_cselect_b32 m0, m0, s47
 v_mfma_f32_16x16x32_bf16 v[72:75], a[104:107], v[196:199], v[72:75]
 ds_read_b128 v[164:167], v18 offset:2048
 v_add_u32 v19, s33, v15
 v_mfma_f32_16x16x32_bf16 v[76:79], a[108:111], v[196:199], v[76:79]
 buffer_load_dwordx4 v10, s[8:11], s30 offen offset:0 lds
 v_mfma_f32_16x16x32_bf16 v[80:83], a[104:107], v[200:203], v[80:83]
 ds_read_b128 v[168:171], v18 offset:4096
 s_add_u32 s33, s33, 16384
 v_mfma_f32_16x16x32_bf16 v[84:87], a[108:111], v[200:203], v[84:87]
 s_cmp_lt_u32 s33, 114688
 s_cselect_b32 s33, s33, 0
 v_mfma_f32_16x16x32_bf16 v[88:91], a[104:107], v[204:207], v[88:91]
 ds_read_b128 v[172:175], v18 offset:6144
 v_mfma_f32_16x16x32_bf16 v[92:95], a[108:111], v[204:207], v[92:95]
 s_waitcnt lgkmcnt(4)
 v_mfma_f32_16x16x32_bf16 v[96:99], a[104:107], v[208:211], v[96:99]
 ds_read_b128 v[176:179], v18 offset:8192
 v_mfma_f32_16x16x32_bf16 v[100:103], a[108:111], v[208:211], v[100:103]
 v_mfma_f32_16x16x32_bf16 v[104:107], a[104:107], v[212:215], v[104:107]
 ds_read_b128 v[180:183], v18 offset:10240
 v_mfma_f32_16x16x32_bf16 v[108:111], a[108:111], v[212:215], v[108:111]
 buffer_load_dwordx4 v11, s[8:11], s30 offen offset:1024 lds
 v_mfma_f32_16x16x32_bf16 v[112:115], a[104:107], v[216:219], v[112:115]
 ds_read_b128 v[184:187], v18 offset:12288
 v_mfma_f32_16x16x32_bf16 v[116:119], a[108:111], v[216:219], v[116:119]
 v_mfma_f32_16x16x32_bf16 v[120:123], a[104:107], v[220:223], v[120:123]
 ds_read_b128 v[188:191], v18 offset:14336
 v_mfma_f32_16x16x32_bf16 v[124:127], a[108:111], v[220:223], v[124:127]
 s_waitcnt lgkmcnt(4)
 v_mfma_f32_16x16x32_bf16 v[64:67], a[112:115], v[160:163], v[64:67]
 ds_read_b128 v[192:195], v19 offset:0
 v_mfma_f32_16x16x32_bf16 v[68:71], a[116:119], v[160:163], v[68:71]
 v_add_u32 v18, s33, v14
 v_mfma_f32_16x16x32_bf16 v[72:75], a[112:115], v[164:167], v[72:75]
 ds_read_b128 v[196:199], v19 offset:2048
 v_mfma_f32_16x16x32_bf16 v[76:79], a[116:119], v[164:167], v[76:79]
 buffer_load_dwordx4 v12, s[8:11], s30 offen offset:2048 lds
 v_mfma_f32_16x16x32_bf16 v[80:83], a[112:115], v[168:171], v[80:83]
 ds_read_b128 v[200:203], v19 offset:4096
 v_mfma_f32_16x16x32_bf16 v[84:87], a[116:119], v[168:171], v[84:87]
 v_mfma_f32_16x16x32_bf16 v[88:91], a[112:115], v[172:175], v[88:91]
 ds_read_b128 v[204:207], v19 offset:6144
 v_mfma_f32_16x16x32_bf16 v[92:95], a[116:119], v[172:175], v[92:95]
 s_waitcnt lgkmcnt(4)
 v_mfma_f32_16x16x32_bf16 v[96:99], a[112:115], v[176:179], v[96:99]
 ds_read_b128 v[208:211], v19 offset:8192
 v_mfma_f32_16x16x32_bf16 v[100:103], a[116:119], v[176:179], v[100:103]
 v_mfma_f32_16x16x32_bf16 v[104:107], a[112:115], v[180:183], v[104:107]
 ds_read_b128 v[212:215], v19 offset:10240
 v_mfma_f32_16x16x32_bf16 v[108:111], a[116:119], v[180:183], v[108:111]
 buffer_load_dwordx4 v13, s[8:11], s30 offen offset:3072 lds
 v_mfma_f32_16x16x32_bf16 v[112:115], a[112:115], v[184:187], v[112:115]
 ds_read_b128 v[216:219], v19 offset:12288
 s_add_u32 s30, s30, 128
 v_mfma_f32_16x16x32_bf16 v[116:119], a[116:119], v[184:187], v[116:119]
 s_add_u32 m0, m0, 16384
 v_mfma_f32_16x16x32_bf16 v[120:123], a[112:115], v[188:191], v[120:123]
 ds_read_b128 v[220:223], v19 offset:14336
 v_mfma_f32_16x16x32_bf16 v[124:127], a[116:119], v[188:191], v[124:127]
 s_waitcnt vmcnt(16) lgkmcnt(4)
 s_barrier
 v_mfma_f32_16x16x32_bf16 v[64:67], a[120:123], v[192:195], v[64:67]
 ds_read_b128 v[160:163], v18 offset:0
 v_mfma_f32_16x16x32_bf16 v[68:71], a[124:127], v[192:195], v[68:71]
 s_cmp_lt_u32 m0, s46
 s_cselect_b32 m0, m0, s47
 v_mfma_f32_16x16x32_bf16 v[72:75], a[120:123], v[196:199], v[72:75]
 ds_read_b128 v[164:167], v18 offset:2048
 v_add_u32 v19, s33, v15
 v_mfma_f32_16x16x32_bf16 v[76:79], a[124:127], v[196:199], v[76:79]
 buffer_load_dwordx4 v10, s[8:11], s30 offen offset:0 lds
 v_mfma_f32_16x16x32_bf16 v[80:83], a[120:123], v[200:203], v[80:83]
 ds_read_b128 v[168:171], v18 offset:4096
 s_add_u32 s33, s33, 16384
 v_mfma_f32_16x16x32_bf16 v[84:87], a[124:127], v[200:203], v[84:87]
 s_cmp_lt_u32 s33, 114688
 s_cselect_b32 s33, s33, 0
 v_mfma_f32_16x16x32_bf16 v[88:91], a[120:123], v[204:207], v[88:91]
 ds_read_b128 v[172:175], v18 offset:6144
 v_mfma_f32_16x16x32_bf16 v[92:95], a[124:127], v[204:207], v[92:95]
 s_waitcnt lgkmcnt(4)
 v_mfma_f32_16x16x32_bf16 v[96:99], a[120:123], v[208:211], v[96:99]
 ds_read_b128 v[176:179], v18 offset:8192
 v_mfma_f32_16x16x32_bf16 v[100:103], a[124:127], v[208:211], v[100:103]
 v_mfma_f32_16x16x32_bf16 v[104:107], a[120:123], v[212:215], v[104:107]
 ds_read_b128 v[180:183], v18 offset:10240
 v_mfma_f32_16x16x32_bf16 v[108:111], a[124:127], v[212:215], v[108:111]
 buffer_load_dwordx4 v11, s[8:11], s30 offen offset:1024 lds
 v_mfma_f32_16x16x32_bf16 v[112:115], a[120:123], v[216:219], v[112:115]
 ds_read_b128 v[184:187], v18 offset:12288
 v_mfma_f32_16x16x32_bf16 v[116:119], a[124:127], v[216:219], v[116:119]
 v_mfma_f32_16x16x32_bf16 v[120:123], a[120:123], v[220:223], v[120:123]
 ds_read_b128 v[188:191], v18 offset:14336
 v_mfma_f32_16x16x32_bf16 v[124:127], a[124:127], v[220:223], v[124:127]
 s_waitcnt lgkmcnt(4)
 v_mfma_f32_16x16x32_bf16 v[64:67], a[128:131], v[160:163], v[64:67]
 ds_read_b128 v[192:195], v19 offset:0
 v_mfma_f32_16x16x32_bf16 v[68:71], a[132:135], v[160:163], v[68:71]
 v_add_u32 v18, s33, v14
 v_mfma_f32_16x16x32_bf16 v[72:75], a[128:131], v[164:167], v[72:75]
 ds_read_b128 v[196:199], v19 offset:2048
 v_mfma_f32_16x16x32_bf16 v[76:79], a[132:135], v[164:167], v[76:79]
 buffer_load_dwordx4 v12, s[8:11], s30 offen offset:2048 lds
 v_mfma_f32_16x16x32_bf16 v[80:83], a[128:131], v[168:171], v[80:83]
 ds_read_b128 v[200:203], v19 offset:4096
 v_mfma_f32_16x16x32_bf16 v[84:87], a[132:135], v[168:171], v[84:87]
 v_mfma_f32_16x16x32_bf16 v[88:91], a[128:131], v[172:175], v[88:91]
 ds_read_b128 v[204:207], v19 offset:6144
 v_mfma_f32_16x16x32_bf16 v[92:95], a[132:135], v[172:175], v[92:95]
 s_waitcnt lgkmcnt(4)
 v_mfma_f32_16x16x32_bf16 v[96:99], a[128:131], v[176:179], v[96:99]
 ds_read_b128 v[208:211], v19 offset:8192
 v_mfma_f32_16x16x32_bf16 v[100:103], a[132:135], v[176:179], v[100:103]
 v_mfma_f32_16x16x32_bf16 v[104:107], a[128:131], v[180:183], v[104:107]
 ds_read_b128 v[212:215], v19 offset:10240
 v_mfma_f32_16x16x32_bf16 v[108:111], a[132:135], v[180:183], v[108:111]
 buffer_load_dwordx4 v13, s[8:11], s30 offen offset:3072 lds
 v_mfma_f32_16x16x32_bf16 v[112:115], a[128:131], v[184:187], v[112:115]
 ds_read_b128 v[216:219], v19 offset:12288
 s_add_u32 s30, s30, 128
 v_mfma_f32_16x16x32_bf16 v[116:119], a[132:135], v[184:187], v[116:119]
 s_add_u32 m0, m0, 16384
 v_mfma_f32_16x16x32_bf16 v[120:123], a[128:131], v[188:191], v[120:123]
 ds_read_b128 v[220:223], v19 offset:14336
 v_mfma_f32_16x16x32_bf16 v[124:127], a[132:135], v[188:191], v[124:127]
 s_waitcnt vmcnt(16) lgkmcnt(4)
 s_barrier
 v_mfma_f32_16x16x32_bf16 v[64:67], a[136:139], v[192:195], v[64:67]
 ds_read_b128 v[160:163], v18 offset:0
 v_mfma_f32_16x16x32_bf16 v[68:71], a[140:143], v[192:195], v[68:71]
 s_cmp_lt_u32 m0, s46
 s_cselect_b32 m0, m0, s47
 v_mfma_f32_16x16x32_bf16 v[72:75], a[136:139], v[196:199], v[72:75]
 ds_read_b128 v[164:167], v18 offset:2048
 v_add_u32 v19, s33, v15
 v_mfma_f32_16x16x32_bf16 v[76:79], a[140:143], v[196:199], v[76:79]
 buffer_load_dwordx4 v10, s[8:11], s30 offen offset:0 lds
 v_mfma_f32_16x16x32_bf16 v[80:83], a[136:139], v[200:203], v[80:83]
 ds_read_b128 v[168:171], v18 offset:4096
 s_add_u32 s33, s33, 16384
 v_mfma_f32_16x16x32_bf16 v[84:87], a[140:143], v[200:203], v[84:87]
 s_cmp_lt_u32 s33, 114688
 s_cselect_b32 s33, s33, 0
 v_mfma_f32_16x16x32_bf16 v[88:91], a[136:139], v[204:207], v[88:91]
 ds_read_b128 v[172:175], v18 offset:6144
 v_mfma_f32_16x16x32_bf16 v[92:95], a[140:143], v[204:207], v[92:95]
 s_waitcnt lgkmcnt(4)
 v_mfma_f32_16x16x32_bf16 v[96:99], a[136:139], v[208:211], v[96:99]
 ds_read_b128 v[176:179], v18 offset:8192
 v_mfma_f32_16x16x32_bf16 v[100:103], a[140:143], v[208:211], v[100:103]
 v_mfma_f32_16x16x32_bf16 v[104:107], a[136:139], v[212:215], v[104:107]
 ds_read_b128 v[180:183], v18 offset:10240
 v_mfma_f32_16x16x32_bf16 v[108:111], a[140:143], v[212:215], v[108:111]
 buffer_load_dwordx4 v11, s[8:11], s30 offen offset:1024 lds
 v_mfma_f32_16x16x32_bf16 v[112:115], a[136:139], v[216:219], v[112:115]
 ds_read_b128 v[184:187], v18 offset:12288
 v_mfma_f32_16x16x32_bf16 v[116:119], a[140:143], v[216:219], v[116:119]
 v_mfma_f32_16x16x32_bf16 v[120:123], a[136:139], v[220:223], v[120:123]
 ds_read_b128 v[188:191], v18 offset:14336
 v_mfma_f32_16x16x32_bf16 v[124:127], a[140:143], v[220:223], v[124:127]
 s_waitcnt lgkmcnt(4)
 v_mfma_f32_16x16x32_bf16 v[64:67], a[144:147], v[160:163], v[64:67]
 ds_read_b128 v[192:195], v19 offset:0
 v_mfma_f32_16x16x32_bf16 v[68:71], a[148:151], v[160:163], v[68:71]
 v_add_u32 v18, s33, v14
 v_mfma_f32_16x16x32_bf16 v[72:75], a[144:147], v[164:167], v[72:75]
 ds_read_b128 v[196:199], v19 offset:2048
 v_mfma_f32_16x16x32_bf16 v[76:79], a[148:151], v[164:167], v[76:79]
 buffer_load_dwordx4 v12, s[8:11], s30 offen offset:2048 lds
 v_mfma_f32_16x16x32_bf16 v[80:83], a[144:147], v[168:171], v[80:83]
 ds_read_b128 v[200:203], v19 offset:4096
 v_mfma_f32_16x16x32_bf16 v[84:87], a[148:151], v[168:171], v[84:87]
 v_mfma_f32_16x16x32_bf16 v[88:91], a[144:147], v[172:175], v[88:91]
 ds_read_b128 v[204:207], v19 offset:6144
 v_mfma_f32_16x16x32_bf16 v[92:95], a[148:151], v[172:175], v[92:95]
 s_waitcnt lgkmcnt(4)
 v_mfma_f32_16x16x32_bf16 v[96:99], a[144:147], v[176:179], v[96:99]
 ds_read_b128 v[208:211], v19 offset:8192
 v_mfma_f32_16x16x32_bf16 v[100:103], a[148:151], v[176:179], v[100:103]
 v_mfma_f32_16x16x32_bf16 v[104:107], a[144:147], v[180:183], v[104:107]
 ds_read_b128 v[212:215], v19 offset:10240
 v_mfma_f32_16x16x32_bf16 v[108:111], a[148:151], v[180:183], v[108:111]
 buffer_load_dwordx4 v13, s[8:11], s30 offen offset:3072 lds
 v_mfma_f32_16x16x32_bf16 v[112:115], a[144:147], v[184:187], v[112:115]
 ds_read_b128 v[216:219], v19 offset:12288
 s_add_u32 s30, s30, 128
 v_mfma_f32_16x16x32_bf16 v[116:119], a[148:151], v[184:187], v[116:119]
 s_add_u32 m0, m0, 16384
 v_mfma_f32_16x16x32_bf16 v[120:123], a[144:147], v[188:191], v[120:123]
 ds_read_b128 v[220:223], v19 offset:14336
 v_mfma_f32_16x16x32_bf16 v[124:127], a[148:151], v[188:191], v[124:127]
 s_waitcnt vmcnt(16) lgkmcnt(4)
 s_barrier
 v_mfma_f32_16x16x32_bf16 v[64:67], a[152:155], v[192:195], v[64:67]
 ds_read_b128 v[160:163], v18 offset:0
 v_mfma_f32_16x16x32_bf16 v[68:71], a[156:159], v[192:195], v[68:71]
 s_cmp_lt_u32 m0, s46
 s_cselect_b32 m0, m0, s47
 v_mfma_f32_16x16x32_bf16 v[72:75], a[152:155], v[196:199], v[72:75]
 ds_read_b128 v[164:167], v18 offset:2048
 v_add_u32 v19, s33, v15
 v_mfma_f32_16x16x32_bf16 v[76:79], a[156:159], v[196:199], v[76:79]
 buffer_load_dwordx4 v10, s[8:11], s30 offen offset:0 lds
 v_cvt_pk_bf16_f32 v224, v64, v65
 v_cvt_pk_bf16_f32 v225, v66, v67
 v_mfma_f32_16x16x32_bf16 v[80:83], a[152:155], v[200:203], v[80:83]
 ds_read_b128 v[168:171], v18 offset:4096
 s_add_u32 s33, s33, 16384
 v_cvt_pk_bf16_f32 v226, v68, v69
 v_cvt_pk_bf16_f32 v227, v70, v71
 v_mfma_f32_16x16x32_bf16 v[84:87], a[156:159], v[200:203], v[84:87]
 s_cmp_lt_u32 s33, 114688
 s_cselect_b32 s33, s33, 0
 ds_write_b64 v22, v[224:225] offset:0
 v_mfma_f32_16x16x32_bf16 v[88:91], a[152:155], v[204:207], v[88:91]
 ds_read_b128 v[172:175], v18 offset:6144
 ds_write_b64 v22, v[226:227] offset:32
 v_cvt_pk_bf16_f32 v230, v72, v73
 v_mfma_f32_16x16x32_bf16 v[92:95], a[156:159], v[204:207], v[92:95]
 s_waitcnt lgkmcnt(6)
 v_cvt_pk_bf16_f32 v231, v74, v75
 v_cvt_pk_bf16_f32 v232, v76, v77
 v_cvt_pk_bf16_f32 v233, v78, v79
 v_mfma_f32_16x16x32_bf16 v[96:99], a[152:155], v[208:211], v[96:99]
 ds_read_b128 v[176:179], v18 offset:8192
 ds_write_b64 v22, v[230:231] offset:4224
 v_mfma_f32_16x16x32_bf16 v[100:103], a[156:159], v[208:211], v[100:103]
 ds_write_b64 v22, v[232:233] offset:4256
 v_cvt_pk_bf16_f32 v224, v80, v81
 v_cvt_pk_bf16_f32 v225, v82, v83
 v_mfma_f32_16x16x32_bf16 v[104:107], a[152:155], v[212:215], v[104:107]
 ds_read_b128 v[180:183], v18 offset:10240
 v_cvt_pk_bf16_f32 v226, v84, v85
 v_cvt_pk_bf16_f32 v227, v86, v87
 v_mfma_f32_16x16x32_bf16 v[108:111], a[156:159], v[212:215], v[108:111]
 buffer_load_dwordx4 v11, s[8:11], s30 offen offset:1024 lds
 ds_write_b64 v22, v[224:225] offset:8448
 v_mfma_f32_16x16x32_bf16 v[112:115], a[152:155], v[216:219], v[112:115]
 ds_read_b128 v[184:187], v18 offset:12288
 ds_write_b64 v22, v[226:227] offset:8480
 v_cvt_pk_bf16_f32 v230, v88, v89
 v_mfma_f32_16x16x32_bf16 v[116:119], a[156:159], v[216:219], v[116:119]
 v_cvt_pk_bf16_f32 v231, v90, v91
 v_cvt_pk_bf16_f32 v232, v92, v93
 v_cvt_pk_bf16_f32 v233, v94, v95
 v_mfma_f32_16x16x32_bf16 v[120:123], a[152:155], v[220:223], v[120:123]
 ds_read_b128 v[188:191], v18 offset:14336
 ds_write_b64 v22, v[230:231] offset:12672
 v_mfma_f32_16x16x32_bf16 v[124:127], a[156:159], v[220:223], v[124:127]
 ds_write_b64 v22, v[232:233] offset:12704
 v_cvt_pk_bf16_f32 v224, v96, v97
 v_cvt_pk_bf16_f32 v225, v98, v99
bf_end_186:
 v_cvt_pk_bf16_f32 v226, v100, v101
 v_cvt_pk_bf16_f32 v227, v102, v103
 ds_write_b64 v22, v[224:225] offset:16896
 ds_write_b64 v22, v[226:227] offset:16928
 v_cvt_pk_bf16_f32 v230, v104, v105
 v_cvt_pk_bf16_f32 v231, v106, v107
 v_cvt_pk_bf16_f32 v232, v108, v109
 v_cvt_pk_bf16_f32 v233, v110, v111
 ds_write_b64 v22, v[230:231] offset:21120
 ds_write_b64 v22, v[232:233] offset:21152
 v_cvt_pk_bf16_f32 v224, v112, v113
 v_cvt_pk_bf16_f32 v225, v114, v115
 v_cvt_pk_bf16_f32 v226, v116, v117
 v_cvt_pk_bf16_f32 v227, v118, v119
 ds_write_b64 v22, v[224:225] offset:25344
 ds_write_b64 v22, v[226:227] offset:25376
 v_cvt_pk_bf16_f32 v230, v120, v121
 v_cvt_pk_bf16_f32 v231, v122, v123
 v_cvt_pk_bf16_f32 v232, v124, v125
 v_cvt_pk_bf16_f32 v233, v126, v127
 ds_write_b64 v22, v[230:231] offset:29568
 ds_write_b64 v22, v[232:233] offset:29600
 s_cmp_lg_u32 s26, 6
 s_cbranch_scc1 bw_187
 buffer_load_dword v32, v32, s[64:67], 0 offen sc1
 buffer_load_dwordx4 v[40:43], v33, s[12:15], s50 offen offset:0
 buffer_load_dwordx4 v[40:43], v33, s[12:15], s50 offen offset:1024
 buffer_load_dwordx4 v[40:43], v33, s[12:15], s50 offen offset:2048
 buffer_load_dwordx4 v[40:43], v33, s[12:15], s50 offen offset:3072
 buffer_load_dwordx4 v[40:43], v33, s[12:15], s51 offen offset:0
 buffer_load_dwordx4 v[40:43], v33, s[12:15], s51 offen offset:1024
 buffer_load_dwordx4 v[40:43], v33, s[12:15], s51 offen offset:2048
bw_187:
 s_waitcnt lgkmcnt(0)
 s_barrier
 ds_read_b64 v[144:145], v34 offset:1848
 ds_read_b64 v[146:147], v34 offset:1856
 ds_read_b64 v[148:149], v34 offset:1864
 ds_read_b64 v[150:151], v34 offset:1872
 ds_read_b64 v[152:153], v34 offset:1880
 ds_read_b64 v[64:65], v34 offset:1928
 ds_read_b64 v[66:67], v34 offset:1936
 ds_read_b64 v[68:69], v34 offset:1944
 ds_read_b64 v[70:71], v34 offset:1952
 ds_read_b64 v[72:73], v34 offset:1960
 ds_read_b64 v[74:75], v34 offset:1664
 ds_read_b64 v[76:77], v34 offset:1672
 ds_read_b64 v[78:79], v34 offset:1680
 ds_read_b64 v[80:81], v34 offset:1688
 ds_read_b64 v[82:83], v34 offset:1696
 ds_read_b64 v[84:85], v34 offset:1400
 ds_read_b64 v[86:87], v34 offset:1408
 ds_read_b64 v[88:89], v34 offset:1416
 ds_read_b64 v[90:91], v34 offset:1424
 ds_read_b64 v[92:93], v34 offset:1432
 ds_read_b64 v[94:95], v34 offset:1136
 ds_read_b64 v[96:97], v34 offset:1144
 ds_read_b64 v[98:99], v34 offset:1152
 ds_read_b64 v[100:101], v34 offset:1160
 ds_read_b64 v[102:103], v34 offset:1168
 ds_read_b64 v[104:105], v34 offset:872
 ds_read_b64 v[106:107], v34 offset:880
 ds_read_b64 v[108:109], v34 offset:888
 ds_read_b64 v[110:111], v34 offset:896
 ds_read_b64 v[112:113], v34 offset:904
 ds_read_b64 v[114:115], v34 offset:608
 ds_read_b64 v[116:117], v34 offset:616
 ds_read_b64 v[118:119], v34 offset:624
 ds_read_b64 v[120:121], v34 offset:632
 ds_read_b64 v[122:123], v34 offset:640
 ds_read_b64 v[124:125], v34 offset:344
 ds_read_b64 v[126:127], v34 offset:352
 ds_read_b64 v[128:129], v34 offset:360
 ds_read_b64 v[130:131], v34 offset:368
 ds_read_b64 v[132:133], v34 offset:376
 ds_read_b64 v[134:135], v34 offset:80
 ds_read_b64 v[136:137], v34 offset:88
 ds_read_b64 v[138:139], v34 offset:96
 ds_read_b64 v[140:141], v34 offset:104
 ds_read_b64 v[142:143], v34 offset:112
 v_mov_b32 v224, 0
 v_mov_b32 v225, 0
 v_mov_b32 v226, 0
 v_mov_b32 v227, 0
 v_mov_b32 v228, 0
 v_mov_b32 v229, 0
 v_mov_b32 v230, 0
 v_mov_b32 v231, 0
 s_waitcnt lgkmcnt(15)
 v_dot2c_f32_bf16 v224, v64, v144
 v_dot2c_f32_bf16 v225, v74, v144
 v_dot2c_f32_bf16 v226, v84, v144
 v_dot2c_f32_bf16 v227, v94, v144
 v_dot2c_f32_bf16 v224, v65, v145
 v_dot2c_f32_bf16 v225, v75, v145
 v_dot2c_f32_bf16 v226, v85, v145
 v_dot2c_f32_bf16 v227, v95, v145
 v_dot2c_f32_bf16 v224, v66, v146
 v_dot2c_f32_bf16 v225, v76, v146
 v_dot2c_f32_bf16 v226, v86, v146
 v_dot2c_f32_bf16 v227, v96, v146
 v_dot2c_f32_bf16 v224, v67, v147
 v_dot2c_f32_bf16 v225, v77, v147
 v_dot2c_f32_bf16 v226, v87, v147
 v_dot2c_f32_bf16 v227, v97, v147
 v_dot2c_f32_bf16 v224, v68, v148
 v_dot2c_f32_bf16 v225, v78, v148
 v_dot2c_f32_bf16 v226, v88, v148
 v_dot2c_f32_bf16 v227, v98, v148
 v_dot2c_f32_bf16 v224, v69, v149
 v_dot2c_f32_bf16 v225, v79, v149
 v_dot2c_f32_bf16 v226, v89, v149
 v_dot2c_f32_bf16 v227, v99, v149
 v_dot2c_f32_bf16 v224, v70, v150
 v_dot2c_f32_bf16 v225, v80, v150
 v_dot2c_f32_bf16 v226, v90, v150
 v_dot2c_f32_bf16 v227, v100, v150
 v_dot2c_f32_bf16 v224, v71, v151
 v_dot2c_f32_bf16 v225, v81, v151
 v_dot2c_f32_bf16 v226, v91, v151
 v_dot2c_f32_bf16 v227, v101, v151
 v_dot2c_f32_bf16 v224, v72, v152
 v_dot2c_f32_bf16 v225, v82, v152
 v_dot2c_f32_bf16 v226, v92, v152
 v_dot2c_f32_bf16 v227, v102, v152
 v_dot2c_f32_bf16 v224, v73, v153
 v_dot2c_f32_bf16 v225, v83, v153
 v_dot2c_f32_bf16 v226, v93, v153
 v_dot2c_f32_bf16 v227, v103, v153
 s_waitcnt lgkmcnt(0)
 v_dot2c_f32_bf16 v228, v104, v144
 v_dot2c_f32_bf16 v229, v114, v144
 v_dot2c_f32_bf16 v230, v124, v144
 v_dot2c_f32_bf16 v231, v134, v144
 v_dot2c_f32_bf16 v228, v105, v145
 v_dot2c_f32_bf16 v229, v115, v145
 v_dot2c_f32_bf16 v230, v125, v145
 v_dot2c_f32_bf16 v231, v135, v145
 v_dot2c_f32_bf16 v228, v106, v146
 v_dot2c_f32_bf16 v229, v116, v146
 v_dot2c_f32_bf16 v230, v126, v146
 v_dot2c_f32_bf16 v231, v136, v146
 v_dot2c_f32_bf16 v228, v107, v147
 v_dot2c_f32_bf16 v229, v117, v147
 v_dot2c_f32_bf16 v230, v127, v147
 v_dot2c_f32_bf16 v231, v137, v147
 v_dot2c_f32_bf16 v228, v108, v148
 v_dot2c_f32_bf16 v229, v118, v148
 v_dot2c_f32_bf16 v230, v128, v148
 v_dot2c_f32_bf16 v231, v138, v148
 v_dot2c_f32_bf16 v228, v109, v149
 v_dot2c_f32_bf16 v229, v119, v149
 v_dot2c_f32_bf16 v230, v129, v149
 v_dot2c_f32_bf16 v231, v139, v149
 v_dot2c_f32_bf16 v228, v110, v150
 v_dot2c_f32_bf16 v229, v120, v150
 v_dot2c_f32_bf16 v230, v130, v150
 v_dot2c_f32_bf16 v231, v140, v150
 v_dot2c_f32_bf16 v228, v111, v151
 v_dot2c_f32_bf16 v229, v121, v151
 v_dot2c_f32_bf16 v230, v131, v151
 v_dot2c_f32_bf16 v231, v141, v151
 v_dot2c_f32_bf16 v228, v112, v152
 v_dot2c_f32_bf16 v229, v122, v152
 v_dot2c_f32_bf16 v230, v132, v152
 v_dot2c_f32_bf16 v231, v142, v152
 v_dot2c_f32_bf16 v228, v113, v153
 v_dot2c_f32_bf16 v229, v123, v153
 v_dot2c_f32_bf16 v230, v133, v153
 v_dot2c_f32_bf16 v231, v143, v153
 ds_read_b64 v[64:65], v38 offset:2008
 ds_read_b64 v[66:67], v38 offset:2016
 ds_read_b64 v[68:69], v38 offset:2024
 ds_read_b64 v[70:71], v38 offset:2032
 ds_read_b64 v[72:73], v39 offset:2040
 ds_read_b64 v[74:75], v38 offset:1744
 ds_read_b64 v[76:77], v38 offset:1752
 ds_read_b64 v[78:79], v38 offset:1760
 ds_read_b64 v[80:81], v38 offset:1768
 ds_read_b64 v[82:83], v39 offset:1776
 ds_read_b64 v[84:85], v38 offset:1480
 ds_read_b64 v[86:87], v38 offset:1488
 ds_read_b64 v[88:89], v38 offset:1496
 ds_read_b64 v[90:91], v38 offset:1504
 ds_read_b64 v[92:93], v39 offset:1512
 ds_read_b64 v[94:95], v38 offset:1216
 ds_read_b64 v[96:97], v38 offset:1224
 ds_read_b64 v[98:99], v38 offset:1232
 ds_read_b64 v[100:101], v38 offset:1240
 ds_read_b64 v[102:103], v39 offset:1248
 ds_read_b64 v[104:105], v38 offset:952
 ds_read_b64 v[106:107], v38 offset:960
 ds_read_b64 v[108:109], v38 offset:968
 ds_read_b64 v[110:111], v38 offset:976
 ds_read_b64 v[112:113], v39 offset:984
 ds_read_b64 v[114:115], v38 offset:688
 ds_read_b64 v[116:117], v38 offset:696
 ds_read_b64 v[118:119], v38 offset:704
 ds_read_b64 v[120:121], v38 offset:712
 ds_read_b64 v[122:123], v39 offset:720
 ds_read_b64 v[124:125], v38 offset:424
 ds_read_b64 v[126:127], v38 offset:432
 ds_read_b64 v[128:129], v38 offset:440
 ds_read_b64 v[130:131], v38 offset:448
 ds_read_b64 v[132:133], v39 offset:456
 ds_read_b64 v[134:135], v38 offset:160
 ds_read_b64 v[136:137], v38 offset:168
 ds_read_b64 v[138:139], v38 offset:176
 ds_read_b64 v[140:141], v38 offset:184
 ds_read_b64 v[142:143], v39 offset:192
 v_cvt_pk_bf16_f32 v4, v224, v225
 v_lshlrev_b32 v224, 16, v4
 v_and_b32 v225, 0xffff0000, v4
 v_mul_f32 v224, s60, v224
 v_mul_f32 v225, s60, v225
 v_cvt_pk_bf16_f32 v4, v224, v225
 v_lshlrev_b32 v224, 16, v4
 v_and_b32 v225, 0xffff0000, v4
 v_cndmask_b32 v224, v37, v224, s[76:77]
 v_cndmask_b32 v225, v37, v225, s[78:79]
 v_cvt_pk_bf16_f32 v4, v226, v227
 v_lshlrev_b32 v226, 16, v4
 v_and_b32 v227, 0xffff0000, v4
 v_mul_f32 v226, s60, v226
 v_mul_f32 v227, s60, v227
 v_cvt_pk_bf16_f32 v4, v226, v227
 v_lshlrev_b32 v226, 16, v4
 v_and_b32 v227, 0xffff0000, v4
 v_cndmask_b32 v226, v37, v226, s[80:81]
 v_cndmask_b32 v227, v37, v227, s[82:83]
 v_cvt_pk_bf16_f32 v4, v228, v229
 v_lshlrev_b32 v228, 16, v4
 v_and_b32 v229, 0xffff0000, v4
 v_mul_f32 v228, s60, v228
 v_mul_f32 v229, s60, v229
 v_cvt_pk_bf16_f32 v4, v228, v229
 v_lshlrev_b32 v228, 16, v4
 v_and_b32 v229, 0xffff0000, v4
 v_cndmask_b32 v228, v37, v228, s[84:85]
 v_cndmask_b32 v229, v37, v229, s[86:87]
 v_cvt_pk_bf16_f32 v4, v230, v231
 v_lshlrev_b32 v230, 16, v4
 v_and_b32 v231, 0xffff0000, v4
 v_mul_f32 v230, s60, v230
 v_mul_f32 v231, s60, v231
 v_cvt_pk_bf16_f32 v4, v230, v231
 v_lshlrev_b32 v230, 16, v4
 v_and_b32 v231, 0xffff0000, v4
 v_cndmask_b32 v230, v37, v230, s[88:89]
 v_cndmask_b32 v231, v37, v231, s[90:91]
 v_max3_f32 v5, v224, v225, v226
 v_max3_f32 v5, v5, v227, v228
 v_max3_f32 v5, v5, v229, v230
 v_max_f32 v5, v5, v231
 v_sub_f32 v224, v224, v5
 v_mul_f32 v224, s61, v224
 v_exp_f32 v224, v224
 v_sub_f32 v225, v225, v5
 v_mul_f32 v225, s61, v225
 v_exp_f32 v225, v225
 v_sub_f32 v226, v226, v5
 v_mul_f32 v226, s61, v226
 v_exp_f32 v226, v226
 v_sub_f32 v227, v227, v5
 v_mul_f32 v227, s61, v227
 v_exp_f32 v227, v227
 v_sub_f32 v228, v228, v5
 v_mul_f32 v228, s61, v228
 v_exp_f32 v228, v228
 v_sub_f32 v229, v229, v5
 v_mul_f32 v229, s61, v229
 v_exp_f32 v229, v229
 v_sub_f32 v230, v230, v5
 v_mul_f32 v230, s61, v230
 v_exp_f32 v230, v230
 v_sub_f32 v231, v231, v5
 v_mul_f32 v231, s61, v231
 v_exp_f32 v231, v231
 s_nop 0
 v_add_f32 v5, v224, v225
 v_add_f32 v5, v5, v226
 v_add_f32 v5, v5, v227
 v_add_f32 v5, v5, v228
 v_add_f32 v5, v5, v229
 v_add_f32 v5, v5, v230
 v_add_f32 v5, v5, v231
 v_rcp_f32 v5, v5
 s_nop 0
 v_mul_f32 v224, v224, v5
 v_mul_f32 v225, v225, v5
 v_mul_f32 v226, v226, v5
 v_mul_f32 v227, v227, v5
 v_mul_f32 v228, v228, v5
 v_mul_f32 v229, v229, v5
 v_mul_f32 v230, v230, v5
 v_mul_f32 v231, v231, v5
 v_cvt_pk_bf16_f32 v232, v224, v225
 v_cvt_pk_bf16_f32 v233, v226, v227
 v_cvt_pk_bf16_f32 v234, v228, v229
 v_cvt_pk_bf16_f32 v235, v230, v231
 s_waitcnt lgkmcnt(15)
 v_perm_b32 v144, v74, v64, s62
 v_perm_b32 v145, v74, v64, s63
 v_perm_b32 v146, v75, v65, s62
 v_perm_b32 v147, v75, v65, s63
 v_perm_b32 v148, v76, v66, s62
 v_perm_b32 v149, v76, v66, s63
 v_perm_b32 v150, v77, v67, s62
 v_perm_b32 v151, v77, v67, s63
 v_perm_b32 v152, v78, v68, s62
 v_perm_b32 v153, v78, v68, s63
 v_perm_b32 v154, v79, v69, s62
 v_perm_b32 v155, v79, v69, s63
 v_perm_b32 v156, v80, v70, s62
 v_perm_b32 v157, v80, v70, s63
 v_perm_b32 v158, v81, v71, s62
 v_perm_b32 v159, v81, v71, s63
 v_perm_b32 v212, v82, v72, s62
 v_perm_b32 v213, v82, v72, s63
 v_perm_b32 v214, v83, v73, s62
 v_perm_b32 v215, v83, v73, s63
 v_dot2_f32_bf16 v192, v144, v232, 0
 v_dot2_f32_bf16 v193, v145, v232, 0
 v_dot2_f32_bf16 v194, v146, v232, 0
 v_dot2_f32_bf16 v195, v147, v232, 0
 v_dot2_f32_bf16 v196, v148, v232, 0
 v_dot2_f32_bf16 v197, v149, v232, 0
 v_dot2_f32_bf16 v198, v150, v232, 0
 v_dot2_f32_bf16 v199, v151, v232, 0
 v_dot2_f32_bf16 v200, v152, v232, 0
 v_dot2_f32_bf16 v201, v153, v232, 0
 v_dot2_f32_bf16 v202, v154, v232, 0
 v_dot2_f32_bf16 v203, v155, v232, 0
 v_dot2_f32_bf16 v204, v156, v232, 0
 v_dot2_f32_bf16 v205, v157, v232, 0
 v_dot2_f32_bf16 v206, v158, v232, 0
 v_dot2_f32_bf16 v207, v159, v232, 0
 v_dot2_f32_bf16 v208, v212, v232, 0
 v_dot2_f32_bf16 v209, v213, v232, 0
 v_dot2_f32_bf16 v210, v214, v232, 0
 v_dot2_f32_bf16 v211, v215, v232, 0
 s_waitcnt lgkmcnt(15)
 v_perm_b32 v144, v94, v84, s62
 v_perm_b32 v145, v94, v84, s63
 v_perm_b32 v146, v95, v85, s62
 v_perm_b32 v147, v95, v85, s63
 v_perm_b32 v148, v96, v86, s62
 v_perm_b32 v149, v96, v86, s63
 v_perm_b32 v150, v97, v87, s62
 v_perm_b32 v151, v97, v87, s63
 v_perm_b32 v152, v98, v88, s62
 v_perm_b32 v153, v98, v88, s63
 v_perm_b32 v154, v99, v89, s62
 v_perm_b32 v155, v99, v89, s63
 v_perm_b32 v156, v100, v90, s62
 v_perm_b32 v157, v100, v90, s63
 v_perm_b32 v158, v101, v91, s62
 v_perm_b32 v159, v101, v91, s63
 v_perm_b32 v212, v102, v92, s62
 v_perm_b32 v213, v102, v92, s63
 v_perm_b32 v214, v103, v93, s62
 v_perm_b32 v215, v103, v93, s63
 v_dot2c_f32_bf16 v192, v144, v233
 v_dot2c_f32_bf16 v193, v145, v233
 v_dot2c_f32_bf16 v194, v146, v233
 v_dot2c_f32_bf16 v195, v147, v233
 v_dot2c_f32_bf16 v196, v148, v233
 v_dot2c_f32_bf16 v197, v149, v233
 v_dot2c_f32_bf16 v198, v150, v233
 v_dot2c_f32_bf16 v199, v151, v233
 v_dot2c_f32_bf16 v200, v152, v233
 v_dot2c_f32_bf16 v201, v153, v233
 v_dot2c_f32_bf16 v202, v154, v233
 v_dot2c_f32_bf16 v203, v155, v233
 v_dot2c_f32_bf16 v204, v156, v233
 v_dot2c_f32_bf16 v205, v157, v233
 v_dot2c_f32_bf16 v206, v158, v233
 v_dot2c_f32_bf16 v207, v159, v233
 v_dot2c_f32_bf16 v208, v212, v233
 v_dot2c_f32_bf16 v209, v213, v233
 v_dot2c_f32_bf16 v210, v214, v233
 v_dot2c_f32_bf16 v211, v215, v233
 s_waitcnt lgkmcnt(10)
 v_perm_b32 v144, v114, v104, s62
 v_perm_b32 v145, v114, v104, s63
 v_perm_b32 v146, v115, v105, s62
 v_perm_b32 v147, v115, v105, s63
 v_perm_b32 v148, v116, v106, s62
 v_perm_b32 v149, v116, v106, s63
 v_perm_b32 v150, v117, v107, s62
 v_perm_b32 v151, v117, v107, s63
 v_perm_b32 v152, v118, v108, s62
 v_perm_b32 v153, v118, v108, s63
 v_perm_b32 v154, v119, v109, s62
 v_perm_b32 v155, v119, v109, s63
 v_perm_b32 v156, v120, v110, s62
 v_perm_b32 v157, v120, v110, s63
 v_perm_b32 v158, v121, v111, s62
 v_perm_b32 v159, v121, v111, s63
 v_perm_b32 v212, v122, v112, s62
 v_perm_b32 v213, v122, v112, s63
 v_perm_b32 v214, v123, v113, s62
 v_perm_b32 v215, v123, v113, s63
 v_dot2c_f32_bf16 v192, v144, v234
 v_dot2c_f32_bf16 v193, v145, v234
 v_dot2c_f32_bf16 v194, v146, v234
 v_dot2c_f32_bf16 v195, v147, v234
 v_dot2c_f32_bf16 v196, v148, v234
 v_dot2c_f32_bf16 v197, v149, v234
 v_dot2c_f32_bf16 v198, v150, v234
 v_dot2c_f32_bf16 v199, v151, v234
 v_dot2c_f32_bf16 v200, v152, v234
 v_dot2c_f32_bf16 v201, v153, v234
 v_dot2c_f32_bf16 v202, v154, v234
 v_dot2c_f32_bf16 v203, v155, v234
 v_dot2c_f32_bf16 v204, v156, v234
 v_dot2c_f32_bf16 v205, v157, v234
 v_dot2c_f32_bf16 v206, v158, v234
 v_dot2c_f32_bf16 v207, v159, v234
 v_dot2c_f32_bf16 v208, v212, v234
 v_dot2c_f32_bf16 v209, v213, v234
 v_dot2c_f32_bf16 v210, v214, v234
 v_dot2c_f32_bf16 v211, v215, v234
 s_waitcnt lgkmcnt(0)
 v_perm_b32 v144, v134, v124, s62
 v_perm_b32 v145, v134, v124, s63
 v_perm_b32 v146, v135, v125, s62
 v_perm_b32 v147, v135, v125, s63
 v_perm_b32 v148, v136, v126, s62
 v_perm_b32 v149, v136, v126, s63
 v_perm_b32 v150, v137, v127, s62
 v_perm_b32 v151, v137, v127, s63
 v_perm_b32 v152, v138, v128, s62
 v_perm_b32 v153, v138, v128, s63
 v_perm_b32 v154, v139, v129, s62
 v_perm_b32 v155, v139, v129, s63
 v_perm_b32 v156, v140, v130, s62
 v_perm_b32 v157, v140, v130, s63
 v_perm_b32 v158, v141, v131, s62
 v_perm_b32 v159, v141, v131, s63
 v_perm_b32 v212, v142, v132, s62
 v_perm_b32 v213, v142, v132, s63
 v_perm_b32 v214, v143, v133, s62
 v_perm_b32 v215, v143, v133, s63
 v_dot2c_f32_bf16 v192, v144, v235
 v_dot2c_f32_bf16 v193, v145, v235
 v_dot2c_f32_bf16 v194, v146, v235
 v_dot2c_f32_bf16 v195, v147, v235
 v_dot2c_f32_bf16 v196, v148, v235
 v_dot2c_f32_bf16 v197, v149, v235
 v_dot2c_f32_bf16 v198, v150, v235
 v_dot2c_f32_bf16 v199, v151, v235
 v_dot2c_f32_bf16 v200, v152, v235
 v_dot2c_f32_bf16 v201, v153, v235
 v_dot2c_f32_bf16 v202, v154, v235
 v_dot2c_f32_bf16 v203, v155, v235
 v_dot2c_f32_bf16 v204, v156, v235
 v_dot2c_f32_bf16 v205, v157, v235
 v_dot2c_f32_bf16 v206, v158, v235
 v_dot2c_f32_bf16 v207, v159, v235
 v_dot2c_f32_bf16 v208, v212, v235
 v_dot2c_f32_bf16 v209, v213, v235
 v_dot2c_f32_bf16 v210, v214, v235
 v_dot2c_f32_bf16 v211, v215, v235
 s_cmp_lg_u32 s20, 0
 s_cbranch_scc1 bh_188
 ds_read_b64 v[64:65], v35 offset:33792
 ds_read_b64 v[66:67], v35 offset:34304
 ds_read_b64 v[68:69], v35 offset:34816
 ds_read_b64 v[70:71], v35 offset:35328
 ds_read_b64 v[72:73], v35 offset:35840
 s_waitcnt lgkmcnt(0)
 ds_write_b64 v35, v[64:65] offset:0
 ds_write_b64 v35, v[66:67] offset:512
 ds_write_b64 v35, v[68:69] offset:1024
 ds_write_b64 v35, v[70:71] offset:1536
 ds_write_b64 v35, v[72:73] offset:2048
bh_188:
 s_nop 1
 v_cvt_pk_bf16_f32 v244, v192, v193
 v_cvt_pk_bf16_f32 v245, v194, v195
 v_cvt_pk_bf16_f32 v246, v196, v197
 v_cvt_pk_bf16_f32 v247, v198, v199
 v_cvt_pk_bf16_f32 v248, v200, v201
 v_cvt_pk_bf16_f32 v249, v202, v203
 v_cvt_pk_bf16_f32 v250, v204, v205
 v_cvt_pk_bf16_f32 v251, v206, v207
 v_cvt_pk_bf16_f32 v252, v208, v209
 v_cvt_pk_bf16_f32 v253, v210, v211
 buffer_store_dwordx4 v[244:247], v29, s[16:19], s27 offen sc1
 buffer_store_dwordx4 v[248:251], v30, s[16:19], s27 offen sc1
 buffer_store_dwordx2 v[252:253], v31, s[16:19], s27 offen sc1
 s_add_u32 s27, s27, 2048
 s_mov_b64 s[78:79], -1
 s_mov_b64 s[80:81], -1
 s_mov_b64 s[82:83], -1
 s_mov_b64 s[84:85], -1
 s_mov_b64 s[86:87], -1
 s_mov_b64 s[88:89], -1
 s_mov_b64 s[90:91], -1
 s_sub_u32 s26, s26, 1
 s_cmp_gt_u32 s26, 0
 s_waitcnt lgkmcnt(0)
 s_cbranch_scc1 bf_blk_185
 s_waitcnt vmcnt(0) lgkmcnt(0)
 s_barrier
 s_mov_b32 s84, 0
 s_mov_b32 s85, -1
 s_load_dwordx2 s[4:5], s[0:1], 0
 s_load_dwordx2 s[6:7], s[0:1], 16
 s_load_dwordx2 s[38:39], s[0:1], 104
 s_mov_b32 s42, s2
 s_mov_b32 s41, 0
 s_waitcnt lgkmcnt(0)
 s_mov_b32 s8, s4
 s_mov_b32 s9, s5
 s_mov_b32 s10, 2621440
 s_mov_b32 s11, 0x00020000
 s_mov_b32 s12, s6
 s_mov_b32 s13, s7
 s_mov_b32 s14, 7864320
 s_mov_b32 s15, 0x00020000
 s_mov_b32 s16, s38
 s_mov_b32 s17, s39
 s_mov_b32 s18, 50331648
 s_mov_b32 s19, 0x00020000
 s_add_u32 s52, s38, 50331648
 s_addc_u32 s53, s39, 0
 s_mov_b32 s54, 6291456
 s_mov_b32 s55, 0x00020000
 s_add_u32 s56, s38, 85983232
 s_addc_u32 s57, s39, 0
 s_mov_b32 s58, 6815744
 s_mov_b32 s59, 0x00020000
 s_load_dwordx2 s[72:73], s[0:1], 104
 s_waitcnt lgkmcnt(0)
 s_add_u32 s72, s72, 81068032
 s_addc_u32 s73, s73, 0
 s_mov_b32 s74, 128000
 s_mov_b32 s75, 0x00020000
 s_mul_i32 s44, s42, 384
 s_mov_b32 s24, 0
 v_mov_b32 v9, 2731
 s_and_b32 s22, s20, 1
 s_lshl_b32 s22, s22, 2
 v_add_u32 v8, 0, v1
 v_mul_u32_u24 v7, v8, v9
 v_lshrrev_b32 v7, 16, v7
 v_mul_u32_u24 v4, 24, v7
 v_sub_u32 v8, v8, v4
 v_and_b32 v4, 2, v7
 v_xor_b32 v8, v8, v4
 v_xor_b32 v8, s22, v8
 v_xor_b32 v5, 4, v8
 s_mov_b32 s21, 12288
 v_mul_lo_u32 v7, v7, s21
 v_lshl_add_u32 v40, v8, 4, v7
 v_lshl_add_u32 v43, v5, 4, v7
 v_add_u32 v8, 64, v1
 v_mul_u32_u24 v7, v8, v9
 v_lshrrev_b32 v7, 16, v7
 v_mul_u32_u24 v4, 24, v7
 v_sub_u32 v8, v8, v4
 v_and_b32 v4, 2, v7
 v_xor_b32 v8, v8, v4
 v_xor_b32 v8, s22, v8
 v_xor_b32 v5, 4, v8
 s_mov_b32 s21, 12288
 v_mul_lo_u32 v7, v7, s21
 v_lshl_add_u32 v41, v8, 4, v7
 v_lshl_add_u32 v44, v5, 4, v7
 v_add_u32 v8, 128, v1
 v_mul_u32_u24 v7, v8, v9
 v_lshrrev_b32 v7, 16, v7
 v_mul_u32_u24 v4, 24, v7
 v_sub_u32 v8, v8, v4
 v_and_b32 v4, 2, v7
 v_xor_b32 v8, v8, v4
 v_xor_b32 v8, s22, v8
 v_xor_b32 v5, 4, v8
 s_mov_b32 s21, 12288
 v_mul_lo_u32 v7, v7, s21
 v_lshl_add_u32 v42, v8, 4, v7
 v_lshl_add_u32 v45, v5, 4, v7
 s_mul_i32 s23, s20, 491520
 s_add_u32 s23, s23, s44
 s_mul_i32 s22, s20, 15360
 s_add_u32 s22, s22, 98304
 s_add_u32 s21, s23, 0
 s_add_u32 m0, s22, 0
 s_nop 0
 buffer_load_dwordx4 v40, s[12:15], s21 offen lds
 s_add_u32 m0, s22, 1024
 s_nop 0
 buffer_load_dwordx4 v41, s[12:15], s21 offen lds
 s_add_u32 m0, s22, 2048
 s_nop 0
 buffer_load_dwordx4 v42, s[12:15], s21 offen lds
 s_add_u32 s21, s23, 98304
 s_add_u32 m0, s22, 3072
 s_nop 0
 buffer_load_dwordx4 v43, s[12:15], s21 offen lds
 s_add_u32 m0, s22, 4096
 s_nop 0
 buffer_load_dwordx4 v44, s[12:15], s21 offen lds
 s_add_u32 m0, s22, 5120
 s_nop 0
 buffer_load_dwordx4 v45, s[12:15], s21 offen lds
 s_add_u32 s21, s23, 196608
 s_add_u32 m0, s22, 6144
 s_nop 0
 buffer_load_dwordx4 v40, s[12:15], s21 offen lds
 s_add_u32 m0, s22, 7168
 s_nop 0
 buffer_load_dwordx4 v41, s[12:15], s21 offen lds
 s_add_u32 m0, s22, 8192
 s_nop 0
 buffer_load_dwordx4 v42, s[12:15], s21 offen lds
 s_add_u32 s21, s23, 294912
 s_add_u32 m0, s22, 9216
 s_nop 0
 buffer_load_dwordx4 v43, s[12:15], s21 offen lds
 s_add_u32 m0, s22, 10240
 s_nop 0
 buffer_load_dwordx4 v44, s[12:15], s21 offen lds
 s_add_u32 m0, s22, 11264
 s_nop 0
 buffer_load_dwordx4 v45, s[12:15], s21 offen lds
 s_add_u32 s21, s23, 393216
 s_add_u32 m0, s22, 12288
 s_nop 0
 buffer_load_dwordx4 v40, s[12:15], s21 offen lds
 s_add_u32 m0, s22, 13312
 s_nop 0
 buffer_load_dwordx4 v41, s[12:15], s21 offen lds
 s_add_u32 m0, s22, 14336
 s_nop 0
 buffer_load_dwordx4 v42, s[12:15], s21 offen lds
 s_add_u32 s21, s23, 1966080
 buffer_load_dwordx4 v[64:67], v40, s[12:15], s21 offen
 buffer_load_dwordx4 v[68:71], v41, s[12:15], s21 offen
 buffer_load_dwordx4 v[72:75], v42, s[12:15], s21 offen
 s_add_u32 s21, s23, 2064384
 buffer_load_dwordx4 v[76:79], v43, s[12:15], s21 offen
 buffer_load_dwordx4 v[80:83], v44, s[12:15], s21 offen
 buffer_load_dwordx4 v[84:87], v45, s[12:15], s21 offen
 s_add_u32 s21, s23, 2162688
 buffer_load_dwordx4 v[88:91], v40, s[12:15], s21 offen
 buffer_load_dwordx4 v[92:95], v41, s[12:15], s21 offen
 buffer_load_dwordx4 v[96:99], v42, s[12:15], s21 offen
 s_add_u32 s21, s23, 2260992
 buffer_load_dwordx4 v[100:103], v43, s[12:15], s21 offen
 buffer_load_dwordx4 v[104:107], v44, s[12:15], s21 offen
 buffer_load_dwordx4 v[108:111], v45, s[12:15], s21 offen
 s_add_u32 s21, s23, 2359296
 buffer_load_dwordx4 v[112:115], v40, s[12:15], s21 offen
 buffer_load_dwordx4 v[116:119], v41, s[12:15], s21 offen
 buffer_load_dwordx4 v[120:123], v42, s[12:15], s21 offen
 s_add_u32 s21, s23, 3932160
 buffer_load_dwordx4 v[124:127], v40, s[12:15], s21 offen
 buffer_load_dwordx4 v[128:131], v41, s[12:15], s21 offen
 buffer_load_dwordx4 v[132:135], v42, s[12:15], s21 offen
 s_add_u32 s21, s23, 4030464
 buffer_load_dwordx4 v[136:139], v43, s[12:15], s21 offen
 buffer_load_dwordx4 v[140:143], v44, s[12:15], s21 offen
 buffer_load_dwordx4 v[144:147], v45, s[12:15], s21 offen
 s_add_u32 s21, s23, 4128768
 buffer_load_dwordx4 v[148:151], v40, s[12:15], s21 offen
 buffer_load_dwordx4 v[152:155], v41, s[12:15], s21 offen
 buffer_load_dwordx4 v[156:159], v42, s[12:15], s21 offen
 s_add_u32 s21, s23, 4227072
 buffer_load_dwordx4 v[160:163], v43, s[12:15], s21 offen
 buffer_load_dwordx4 v[164:167], v44, s[12:15], s21 offen
 buffer_load_dwordx4 v[168:171], v45, s[12:15], s21 offen
 s_add_u32 s21, s23, 4325376
 buffer_load_dwordx4 v[172:175], v40, s[12:15], s21 offen
 buffer_load_dwordx4 v[176:179], v41, s[12:15], s21 offen
 buffer_load_dwordx4 v[180:183], v42, s[12:15], s21 offen
 s_add_u32 s21, s23, 5898240
 buffer_load_dwordx4 v[184:187], v40, s[12:15], s21 offen
 buffer_load_dwordx4 v[188:191], v41, s[12:15], s21 offen
 buffer_load_dwordx4 v[192:195], v42, s[12:15], s21 offen
 s_add_u32 s21, s23, 5996544
 buffer_load_dwordx4 v[196:199], v43, s[12:15], s21 offen
 buffer_load_dwordx4 v[200:203], v44, s[12:15], s21 offen
 buffer_load_dwordx4 v[204:207], v45, s[12:15], s21 offen
 s_add_u32 s21, s23, 6094848
 buffer_load_dwordx4 v[208:211], v40, s[12:15], s21 offen
 buffer_load_dwordx4 v[212:215], v41, s[12:15], s21 offen
 buffer_load_dwordx4 v[216:219], v42, s[12:15], s21 offen
 s_add_u32 s21, s23, 6193152
 buffer_load_dwordx4 v[220:223], v43, s[12:15], s21 offen
 buffer_load_dwordx4 v[224:227], v44, s[12:15], s21 offen
 buffer_load_dwordx4 v[228:231], v45, s[12:15], s21 offen
 s_add_u32 s21, s23, 6291456
 buffer_load_dwordx4 v[232:235], v40, s[12:15], s21 offen
 buffer_load_dwordx4 v[236:239], v41, s[12:15], s21 offen
 buffer_load_dwordx4 v[240:243], v42, s[12:15], s21 offen
 v_lshl_add_u32 v49, v1, 4, s22
 v_lshrrev_b32 v7, 2, v2
 v_and_b32 v4, 2, v7
 v_and_b32 v5, 1, v3
 v_lshl_or_b32 v4, v5, 2, v4
 v_lshl_add_u32 v7, v3, 3, v7
 v_mul_u32_u24 v7, 384, v7
 v_and_b32 v5, 1, v2
 v_lshl_add_u32 v7, v5, 3, v7
 v_add_u32 v7, 98304, v7
 v_bfe_u32 v8, v2, 1, 1
 s_mul_i32 s21, s20, 6
 v_add_u32 v8, s21, v8
 v_add_u32 v5, 0, v8
 v_xor_b32 v5, v5, v4
 v_lshl_add_u32 v46, v5, 4, v7
 v_add_u32 v5, 2, v8
 v_xor_b32 v5, v5, v4
 v_lshl_add_u32 v47, v5, 4, v7
 v_add_u32 v5, 4, v8
 v_xor_b32 v5, v5, v4
 v_lshl_add_u32 v48, v5, 4, v7
 s_waitcnt vmcnt(45)
 s_barrier
 ds_read_b64_tr_b16 a[0:1], v46 offset:0
 ds_read_b64_tr_b16 a[2:3], v46 offset:1536
 ds_read_b64_tr_b16 a[4:5], v47 offset:0
 ds_read_b64_tr_b16 a[6:7], v47 offset:1536
 ds_read_b64_tr_b16 a[8:9], v48 offset:0
 ds_read_b64_tr_b16 a[10:11], v48 offset:1536
 ds_read_b64_tr_b16 a[12:13], v46 offset:12288
 ds_read_b64_tr_b16 a[14:15], v46 offset:13824
 ds_read_b64_tr_b16 a[16:17], v47 offset:12288
 ds_read_b64_tr_b16 a[18:19], v47 offset:13824
 ds_read_b64_tr_b16 a[20:21], v48 offset:12288
 ds_read_b64_tr_b16 a[22:23], v48 offset:13824
 ds_read_b64_tr_b16 a[24:25], v46 offset:24576
 ds_read_b64_tr_b16 a[26:27], v46 offset:26112
 ds_read_b64_tr_b16 a[28:29], v47 offset:24576
 ds_read_b64_tr_b16 a[30:31], v47 offset:26112
 ds_read_b64_tr_b16 a[32:33], v48 offset:24576
 ds_read_b64_tr_b16 a[34:35], v48 offset:26112
 ds_read_b64_tr_b16 a[36:37], v46 offset:36864
 ds_read_b64_tr_b16 a[38:39], v46 offset:38400
 ds_read_b64_tr_b16 a[40:41], v47 offset:36864
 ds_read_b64_tr_b16 a[42:43], v47 offset:38400
 ds_read_b64_tr_b16 a[44:45], v48 offset:36864
 ds_read_b64_tr_b16 a[46:47], v48 offset:38400
 ds_read_b64_tr_b16 a[48:49], v46 offset:49152
 ds_read_b64_tr_b16 a[50:51], v46 offset:50688
 ds_read_b64_tr_b16 a[52:53], v47 offset:49152
 ds_read_b64_tr_b16 a[54:55], v47 offset:50688
 ds_read_b64_tr_b16 a[56:57], v48 offset:49152
 ds_read_b64_tr_b16 a[58:59], v48 offset:50688
 v_lshrrev_b32 v11, 3, v1
 v_and_b32 v12, 7, v1
 v_xor_b32 v12, v12, v11
 v_mul_u32_u24 v11, 1280, v11
 v_lshl_add_u32 v10, v12, 4, v11
 s_mul_i32 s46, s20, 40960
 v_add_u32 v10, s46, v10
 s_lshl_b32 s47, s20, 12
 s_add_u32 s47, s47, 0
 s_add_u32 s46, s47, 98304
 s_mov_b32 s30, s24
 s_add_u32 s32, s47, 0
 v_add_u32 v11, 9216, v10
 v_add_u32 v12, 18432, v10
 v_add_u32 v13, 27648, v10
 s_mov_b32 m0, s32
 s_nop 0
 buffer_load_dwordx4 v10, s[8:11], s30 offen offset:0 lds
 buffer_load_dwordx4 v11, s[8:11], s30 offen offset:1024 lds
 buffer_load_dwordx4 v12, s[8:11], s30 offen offset:2048 lds
 buffer_load_dwordx4 v13, s[8:11], s30 offen offset:3072 lds
 s_add_u32 s30, s30, 128
 s_add_u32 s32, s32, 16384
 s_cmp_lt_u32 s32, s46
 s_cselect_b32 s32, s32, s47
 s_mov_b32 m0, s32
 s_nop 0
 buffer_load_dwordx4 v10, s[8:11], s30 offen offset:0 lds
 buffer_load_dwordx4 v11, s[8:11], s30 offen offset:1024 lds
 buffer_load_dwordx4 v12, s[8:11], s30 offen offset:2048 lds
 buffer_load_dwordx4 v13, s[8:11], s30 offen offset:3072 lds
 s_add_u32 s30, s30, 128
 s_add_u32 s32, s32, 16384
 s_cmp_lt_u32 s32, s46
 s_cselect_b32 s32, s32, s47
 s_mov_b32 m0, s32
 s_nop 0
 buffer_load_dwordx4 v10, s[8:11], s30 offen offset:0 lds
 buffer_load_dwordx4 v11, s[8:11], s30 offen offset:1024 lds
 buffer_load_dwordx4 v12, s[8:11], s30 offen offset:2048 lds
 buffer_load_dwordx4 v13, s[8:11], s30 offen offset:3072 lds
 s_add_u32 s30, s30, 128
 s_add_u32 s32, s32, 16384
 s_cmp_lt_u32 s32, s46
 s_cselect_b32 s32, s32, s47
 s_mov_b32 m0, s32
 s_nop 0
 buffer_load_dwordx4 v10, s[8:11], s30 offen offset:0 lds
 buffer_load_dwordx4 v11, s[8:11], s30 offen offset:1024 lds
 buffer_load_dwordx4 v12, s[8:11], s30 offen offset:2048 lds
 buffer_load_dwordx4 v13, s[8:11], s30 offen offset:3072 lds
 s_add_u32 s30, s30, 128
 s_add_u32 s32, s32, 16384
 s_cmp_lt_u32 s32, s46
 s_cselect_b32 s32, s32, s47
 s_waitcnt lgkmcnt(0)
 s_barrier
 s_waitcnt vmcnt(46)
 ds_write_b128 v49, v[64:67] offset:0
 ds_write_b128 v49, v[68:71] offset:1024
 ds_write_b128 v49, v[72:75] offset:2048
 ds_write_b128 v49, v[76:79] offset:3072
 ds_write_b128 v49, v[80:83] offset:4096
 ds_write_b128 v49, v[84:87] offset:5120
 ds_write_b128 v49, v[88:91] offset:6144
 ds_write_b128 v49, v[92:95] offset:7168
 ds_write_b128 v49, v[96:99] offset:8192
 ds_write_b128 v49, v[100:103] offset:9216
 ds_write_b128 v49, v[104:107] offset:10240
 ds_write_b128 v49, v[108:111] offset:11264
 ds_write_b128 v49, v[112:115] offset:12288
 ds_write_b128 v49, v[116:119] offset:13312
 ds_write_b128 v49, v[120:123] offset:14336
 s_waitcnt lgkmcnt(0)
 s_barrier
 ds_read_b64_tr_b16 a[60:61], v46 offset:0
 ds_read_b64_tr_b16 a[62:63], v46 offset:1536
 ds_read_b64_tr_b16 a[64:65], v47 offset:0
 ds_read_b64_tr_b16 a[66:67], v47 offset:1536
 ds_read_b64_tr_b16 a[68:69], v48 offset:0
 ds_read_b64_tr_b16 a[70:71], v48 offset:1536
 ds_read_b64_tr_b16 a[72:73], v46 offset:12288
 ds_read_b64_tr_b16 a[74:75], v46 offset:13824
 ds_read_b64_tr_b16 a[76:77], v47 offset:12288
 ds_read_b64_tr_b16 a[78:79], v47 offset:13824
 ds_read_b64_tr_b16 a[80:81], v48 offset:12288
 ds_read_b64_tr_b16 a[82:83], v48 offset:13824
 ds_read_b64_tr_b16 a[84:85], v46 offset:24576
 ds_read_b64_tr_b16 a[86:87], v46 offset:26112
 ds_read_b64_tr_b16 a[88:89], v47 offset:24576
 ds_read_b64_tr_b16 a[90:91], v47 offset:26112
 ds_read_b64_tr_b16 a[92:93], v48 offset:24576
 ds_read_b64_tr_b16 a[94:95], v48 offset:26112
 ds_read_b64_tr_b16 a[96:97], v46 offset:36864
 ds_read_b64_tr_b16 a[98:99], v46 offset:38400
 ds_read_b64_tr_b16 a[100:101], v47 offset:36864
 ds_read_b64_tr_b16 a[102:103], v47 offset:38400
 ds_read_b64_tr_b16 a[104:105], v48 offset:36864
 ds_read_b64_tr_b16 a[106:107], v48 offset:38400
 ds_read_b64_tr_b16 a[108:109], v46 offset:49152
 ds_read_b64_tr_b16 a[110:111], v46 offset:50688
 ds_read_b64_tr_b16 a[112:113], v47 offset:49152
 ds_read_b64_tr_b16 a[114:115], v47 offset:50688
 ds_read_b64_tr_b16 a[116:117], v48 offset:49152
 ds_read_b64_tr_b16 a[118:119], v48 offset:50688
 s_waitcnt lgkmcnt(0)
 s_barrier
 s_waitcnt vmcnt(31)
 ds_write_b128 v49, v[124:127] offset:0
 ds_write_b128 v49, v[128:131] offset:1024
 ds_write_b128 v49, v[132:135] offset:2048
 ds_write_b128 v49, v[136:139] offset:3072
 ds_write_b128 v49, v[140:143] offset:4096
 ds_write_b128 v49, v[144:147] offset:5120
 ds_write_b128 v49, v[148:151] offset:6144
 ds_write_b128 v49, v[152:155] offset:7168
 ds_write_b128 v49, v[156:159] offset:8192
 ds_write_b128 v49, v[160:163] offset:9216
 ds_write_b128 v49, v[164:167] offset:10240
 ds_write_b128 v49, v[168:171] offset:11264
 ds_write_b128 v49, v[172:175] offset:12288
 ds_write_b128 v49, v[176:179] offset:13312
 ds_write_b128 v49, v[180:183] offset:14336
 s_waitcnt lgkmcnt(0)
 s_barrier
 ds_read_b64_tr_b16 a[120:121], v46 offset:0
 ds_read_b64_tr_b16 a[122:123], v46 offset:1536
 ds_read_b64_tr_b16 a[124:125], v47 offset:0
 ds_read_b64_tr_b16 a[126:127], v47 offset:1536
 ds_read_b64_tr_b16 a[128:129], v48 offset:0
 ds_read_b64_tr_b16 a[130:131], v48 offset:1536
 ds_read_b64_tr_b16 a[132:133], v46 offset:12288
 ds_read_b64_tr_b16 a[134:135], v46 offset:13824
 ds_read_b64_tr_b16 a[136:137], v47 offset:12288
 ds_read_b64_tr_b16 a[138:139], v47 offset:13824
 ds_read_b64_tr_b16 a[140:141], v48 offset:12288
 ds_read_b64_tr_b16 a[142:143], v48 offset:13824
 ds_read_b64_tr_b16 a[144:145], v46 offset:24576
 ds_read_b64_tr_b16 a[146:147], v46 offset:26112
 ds_read_b64_tr_b16 a[148:149], v47 offset:24576
 ds_read_b64_tr_b16 a[150:151], v47 offset:26112
 ds_read_b64_tr_b16 a[152:153], v48 offset:24576
 ds_read_b64_tr_b16 a[154:155], v48 offset:26112
 ds_read_b64_tr_b16 a[156:157], v46 offset:36864
 ds_read_b64_tr_b16 a[158:159], v46 offset:38400
 ds_read_b64_tr_b16 a[160:161], v47 offset:36864
 ds_read_b64_tr_b16 a[162:163], v47 offset:38400
 ds_read_b64_tr_b16 a[164:165], v48 offset:36864
 ds_read_b64_tr_b16 a[166:167], v48 offset:38400
 ds_read_b64_tr_b16 a[168:169], v46 offset:49152
 ds_read_b64_tr_b16 a[170:171], v46 offset:50688
 ds_read_b64_tr_b16 a[172:173], v47 offset:49152
 ds_read_b64_tr_b16 a[174:175], v47 offset:50688
 ds_read_b64_tr_b16 a[176:177], v48 offset:49152
 ds_read_b64_tr_b16 a[178:179], v48 offset:50688
 s_waitcnt lgkmcnt(0)
 s_barrier
 s_waitcnt vmcnt(16)
 ds_write_b128 v49, v[184:187] offset:0
 ds_write_b128 v49, v[188:191] offset:1024
 ds_write_b128 v49, v[192:195] offset:2048
 ds_write_b128 v49, v[196:199] offset:3072
 ds_write_b128 v49, v[200:203] offset:4096
 ds_write_b128 v49, v[204:207] offset:5120
 ds_write_b128 v49, v[208:211] offset:6144
 ds_write_b128 v49, v[212:215] offset:7168
 ds_write_b128 v49, v[216:219] offset:8192
 ds_write_b128 v49, v[220:223] offset:9216
 ds_write_b128 v49, v[224:227] offset:10240
 ds_write_b128 v49, v[228:231] offset:11264
 ds_write_b128 v49, v[232:235] offset:12288
 ds_write_b128 v49, v[236:239] offset:13312
 ds_write_b128 v49, v[240:243] offset:14336
 s_waitcnt lgkmcnt(0)
 s_barrier
 ds_read_b64_tr_b16 a[180:181], v46 offset:0
 ds_read_b64_tr_b16 a[182:183], v46 offset:1536
 ds_read_b64_tr_b16 a[184:185], v47 offset:0
 ds_read_b64_tr_b16 a[186:187], v47 offset:1536
 ds_read_b64_tr_b16 a[188:189], v48 offset:0
 ds_read_b64_tr_b16 a[190:191], v48 offset:1536
 ds_read_b64_tr_b16 a[192:193], v46 offset:12288
 ds_read_b64_tr_b16 a[194:195], v46 offset:13824
 ds_read_b64_tr_b16 a[196:197], v47 offset:12288
 ds_read_b64_tr_b16 a[198:199], v47 offset:13824
 ds_read_b64_tr_b16 a[200:201], v48 offset:12288
 ds_read_b64_tr_b16 a[202:203], v48 offset:13824
 ds_read_b64_tr_b16 a[204:205], v46 offset:24576
 ds_read_b64_tr_b16 a[206:207], v46 offset:26112
 ds_read_b64_tr_b16 a[208:209], v47 offset:24576
 ds_read_b64_tr_b16 a[210:211], v47 offset:26112
 ds_read_b64_tr_b16 a[212:213], v48 offset:24576
 ds_read_b64_tr_b16 a[214:215], v48 offset:26112
 ds_read_b64_tr_b16 a[216:217], v46 offset:36864
 ds_read_b64_tr_b16 a[218:219], v46 offset:38400
 ds_read_b64_tr_b16 a[220:221], v47 offset:36864
 ds_read_b64_tr_b16 a[222:223], v47 offset:38400
 ds_read_b64_tr_b16 a[224:225], v48 offset:36864
 ds_read_b64_tr_b16 a[226:227], v48 offset:38400
 ds_read_b64_tr_b16 a[228:229], v46 offset:49152
 ds_read_b64_tr_b16 a[230:231], v46 offset:50688
 ds_read_b64_tr_b16 a[232:233], v47 offset:49152
 ds_read_b64_tr_b16 a[234:235], v47 offset:50688
 ds_read_b64_tr_b16 a[236:237], v48 offset:49152
 ds_read_b64_tr_b16 a[238:239], v48 offset:50688
 s_waitcnt lgkmcnt(0)
 s_barrier
 v_readfirstlane_b32 s21, v32
 s_cmp_ge_u32 s21, 32
 s_cbranch_scc1 bt_189
 s_mov_b32 s21, 76
 v_mov_b32 v4, 0
 s_mov_b32 s101, 0
wf_190:
 buffer_load_dword v5, v4, s[64:67], s21 offen sc1
 s_add_u32 s101, s101, 1
 s_cmp_gt_u32 s101, 131072
 s_cbranch_scc1 main_end
 s_waitcnt vmcnt(0)
 v_readfirstlane_b32 s100, v5
 s_cmp_ge_u32 s100, 32
 s_cbranch_scc1 wf_191
 s_sleep 8
 s_branch wf_190
wf_191:
bt_189:
 s_mov_b32 s21, 90112
 s_cmp_lg_u32 s20, 0
 s_cbranch_scc1 af_192
 v_mov_b32 v4, 0
 v_mov_b32 v5, 1
 s_mov_b64 exec, 1
 buffer_atomic_add v5, v4, s[72:75], s21 offen sc1
 s_mov_b64 exec, -1
 s_nop 1
af_192:
 s_mul_i32 s21, s20, 12800
 s_add_u32 s21, s21, 98304
 v_mul_u32_u24 v4, 400, v2
 v_lshlrev_b32 v5, 4, v3
 v_add3_u32 v29, v4, v5, s21
 v_lshlrev_b32 v30, 4, v1
 v_and_b32 v4, 1, v2
 v_bfe_u32 v5, v2, 1, 1
 v_lshl_or_b32 v4, v5, 2, v4
 v_bfe_u32 v5, v2, 2, 1
 v_lshl_or_b32 v4, v5, 1, v4
 v_lshlrev_b32 v4, 4, v4
 v_lshl_add_u32 v31, v3, 7, v4
 v_lshlrev_b32 v32, 3, v1
 v_and_b32 v4, 3, v1
 v_lshlrev_b32 v33, 3, v4
 v_mov_b32 v34, 0xf149f2ca
 v_lshlrev_b32 v4, 2, v3
 v_sub_u32 v35, v2, v4
 v_cmp_gt_u32 s[60:61], 2, v3
 s_mov_b32 s62, 0x3d93cd3a
 s_mov_b32 s63, 0x3fb8aa3b
 s_mov_b32 s83, 0x3dd53b95
 v_cmp_le_i32 s[64:65], 0, v35
 v_cmp_le_i32 s[66:67], 1, v35
 v_cmp_le_i32 s[68:69], 2, v35
 v_cmp_le_i32 s[70:71], 3, v35
 s_mov_b32 s24, 0
 s_mov_b32 s25, 163840
 s_mov_b32 s26, 14
 s_lshl_b32 s49, s41, 2
 s_add_u32 s49, s49, s20
 s_mov_b32 s29, 4
 s_mov_b32 s78, 0
 s_mov_b32 s81, 0x80000000
 s_mov_b32 s82, 0
 s_mul_i32 s21, s49, 393216
 s_mul_i32 s22, s42, 12288
 s_add_u32 s50, s21, s22
 s_mul_i32 s21, s49, 98304
 s_mul_i32 s22, s42, 3072
 s_add_u32 s51, s21, s22
 s_lshr_b32 s22, s49, 1
 s_lshr_b32 s21, s49, 2
 s_add_u32 s21, s21, 2
 s_cmp_lt_u32 s49, 8
 s_cselect_b32 s21, s22, s21
 s_lshl_b32 s21, s21, 3
 s_lshr_b32 s22, s42, 2
 s_add_u32 s21, s21, s22
 s_lshl_b32 s21, s21, 7
 s_add_u32 s76, s21, 0
 s_lshl_b32 s77, s42, 7
 s_add_u32 s77, s77, 18432
 v_mov_b32 v21, 0
 buffer_load_dword v21, v33, s[72:75], s77 offen sc1
 v_and_b32 v6, 7, v2
 v_add_u32 v4, 0, v3
 v_xor_b32 v4, v4, v6
 v_lshlrev_b32 v4, 4, v4
 v_lshl_add_u32 v14, v2, 7, v4
 v_add_u32 v4, 4, v3
 v_xor_b32 v4, v4, v6
 v_lshlrev_b32 v4, 4, v4
 v_lshl_add_u32 v15, v2, 7, v4
 v_mul_u32_u24 v22, 400, v2
 v_mul_u32_u24 v4, 16, v3
 s_mul_i32 s21, s20, 96
 s_add_u32 s21, s21, 98304
 v_add3_u32 v22, v22, v4, s21
 v_lshlrev_b32 v4, 3, v3
 v_sub_u32 v16, v22, v4
 v_mov_b32 v9, 2731
 s_mov_b32 s33, 0
 s_mov_b32 s48, 0x80000000
 s_mov_b32 m0, s32
 s_nop 0
 buffer_load_dwordx4 v10, s[8:11], s30 offen offset:0 lds
 buffer_load_dwordx4 v11, s[8:11], s30 offen offset:1024 lds
 s_waitcnt vmcnt(14)
 s_barrier
 v_add_u32 v18, s33, v14
 v_add_u32 v19, s33, v15
 s_add_u32 s33, s33, 16384
 s_cmp_lt_u32 s33, 98304
 s_cselect_b32 s33, s33, 0
 ds_read_b128 v[160:163], v18 offset:0
 ds_read_b128 v[164:167], v18 offset:2048
 ds_read_b128 v[168:171], v18 offset:4096
 ds_read_b128 v[172:175], v18 offset:6144
 ds_read_b128 v[176:179], v18 offset:8192
 ds_read_b128 v[180:183], v18 offset:10240
 ds_read_b128 v[184:187], v18 offset:12288
 ds_read_b128 v[188:191], v18 offset:14336
 s_waitcnt lgkmcnt(0)
qa_blk_194:
 v_mfma_f32_16x16x32_bf16 v[64:67], a[0:3], v[160:163], 0
 ds_read_b128 v[192:195], v19 offset:0
 v_mfma_f32_16x16x32_bf16 v[68:71], a[4:7], v[160:163], 0
 v_add_u32 v18, s33, v14
 v_cndmask_b32 v36, v34, v36, s[64:65]
 v_mfma_f32_16x16x32_bf16 v[72:75], a[8:11], v[160:163], 0
 v_cndmask_b32 v48, v34, v48, s[64:65]
 v_cndmask_b32 v37, v34, v37, s[66:67]
 v_mfma_f32_16x16x32_bf16 v[76:79], a[0:3], v[164:167], 0
 ds_read_b128 v[196:199], v19 offset:2048
 v_cndmask_b32 v49, v34, v49, s[66:67]
 v_mfma_f32_16x16x32_bf16 v[80:83], a[4:7], v[164:167], 0
 buffer_load_dwordx4 v12, s[8:11], s30 offen offset:2048 lds
 v_mfma_f32_16x16x32_bf16 v[84:87], a[8:11], v[164:167], 0
 v_cndmask_b32 v38, v34, v38, s[68:69]
 v_cndmask_b32 v50, v34, v50, s[68:69]
 v_mfma_f32_16x16x32_bf16 v[88:91], a[0:3], v[168:171], 0
 ds_read_b128 v[200:203], v19 offset:4096
 v_cndmask_b32 v39, v34, v39, s[70:71]
 v_mfma_f32_16x16x32_bf16 v[92:95], a[4:7], v[168:171], 0
 v_cndmask_b32 v51, v34, v51, s[70:71]
 v_max3_f32 v56, v36, v37, v38
 v_mfma_f32_16x16x32_bf16 v[96:99], a[8:11], v[168:171], 0
 v_max3_f32 v56, v56, v39, v40
 v_max3_f32 v56, v56, v41, v42
 v_mfma_f32_16x16x32_bf16 v[100:103], a[0:3], v[172:175], 0
 ds_read_b128 v[204:207], v19 offset:6144
 v_max_f32 v56, v56, v43
 v_mfma_f32_16x16x32_bf16 v[104:107], a[4:7], v[172:175], 0
 v_mov_b32 v57, v56
 v_mfma_f32_16x16x32_bf16 v[108:111], a[8:11], v[172:175], 0
 s_waitcnt lgkmcnt(15)
 v_mfma_f32_16x16x32_bf16 v[112:115], a[0:3], v[176:179], 0
 ds_read_b128 v[208:211], v19 offset:8192
 v_mfma_f32_16x16x32_bf16 v[116:119], a[4:7], v[176:179], 0
 s_nop 1
 v_mfma_f32_16x16x32_bf16 v[120:123], a[8:11], v[176:179], 0
 v_permlane32_swap_b32 v56, v57
 v_mfma_f32_16x16x32_bf16 v[124:127], a[0:3], v[180:183], 0
 ds_read_b128 v[212:215], v19 offset:10240
 v_max_f32 v56, v56, v57
 v_mfma_f32_16x16x32_bf16 v[128:131], a[4:7], v[180:183], 0
 buffer_load_dwordx4 v13, s[8:11], s30 offen offset:3072 lds
 v_mfma_f32_16x16x32_bf16 v[132:135], a[8:11], v[180:183], 0
 s_add_u32 s30, s30, 128
 s_add_u32 m0, m0, 16384
 v_mfma_f32_16x16x32_bf16 v[136:139], a[0:3], v[184:187], 0
 ds_read_b128 v[216:219], v19 offset:12288
 v_mov_b32 v57, v56
 v_mfma_f32_16x16x32_bf16 v[140:143], a[4:7], v[184:187], 0
 s_cmp_lt_u32 m0, s46
 s_cselect_b32 m0, m0, s47
 v_mfma_f32_16x16x32_bf16 v[144:147], a[8:11], v[184:187], 0
 s_nop 1
 v_mfma_f32_16x16x32_bf16 v[148:151], a[0:3], v[188:191], 0
 ds_read_b128 v[220:223], v19 offset:14336
 v_mfma_f32_16x16x32_bf16 v[152:155], a[4:7], v[188:191], 0
 v_permlane16_swap_b32 v56, v57
 v_mfma_f32_16x16x32_bf16 v[156:159], a[8:11], v[188:191], 0
 s_waitcnt vmcnt(12) lgkmcnt(4)
 s_barrier
 v_mfma_f32_16x16x32_bf16 v[64:67], a[12:15], v[192:195], v[64:67]
 ds_read_b128 v[160:163], v18 offset:0
 v_max_f32 v56, v56, v57
 v_mfma_f32_16x16x32_bf16 v[68:71], a[16:19], v[192:195], v[68:71]
 v_mul_f32 v56, s83, v56
 v_fma_f32 v36, v36, s83, -v56
 v_mfma_f32_16x16x32_bf16 v[72:75], a[20:23], v[192:195], v[72:75]
 v_add_u32 v19, s33, v15
 s_add_u32 s33, s33, 16384
 v_mfma_f32_16x16x32_bf16 v[76:79], a[12:15], v[196:199], v[76:79]
 ds_read_b128 v[164:167], v18 offset:2048
 s_mul_i32 s21, s49, 393216
 v_mfma_f32_16x16x32_bf16 v[80:83], a[16:19], v[196:199], v[80:83]
 buffer_load_dwordx4 v10, s[8:11], s30 offen offset:0 lds
 v_mfma_f32_16x16x32_bf16 v[84:87], a[20:23], v[196:199], v[84:87]
 s_cmp_lt_u32 s33, 98304
 s_cselect_b32 s33, s33, 0
 v_mfma_f32_16x16x32_bf16 v[88:91], a[12:15], v[200:203], v[88:91]
 ds_read_b128 v[168:171], v18 offset:4096
 s_mul_i32 s22, s42, 12288
 v_mfma_f32_16x16x32_bf16 v[92:95], a[16:19], v[200:203], v[92:95]
 s_add_u32 s50, s21, s22
 s_lshr_b32 s51, s50, 2
 v_mfma_f32_16x16x32_bf16 v[96:99], a[20:23], v[200:203], v[96:99]
 s_add_u32 s23, s49, 1
 v_cmp_gt_u32 vcc, s23, v21
 v_mfma_f32_16x16x32_bf16 v[100:103], a[12:15], v[204:207], v[100:103]
 ds_read_b128 v[172:175], v18 offset:6144
 v_fma_f32 v37, v37, s83, -v56
 v_mfma_f32_16x16x32_bf16 v[104:107], a[16:19], v[204:207], v[104:107]
 s_cmp_eq_u64 vcc, 0
 s_cselect_b32 s80, 1, 0
 v_mfma_f32_16x16x32_bf16 v[108:111], a[20:23], v[204:207], v[108:111]
 s_waitcnt lgkmcnt(4)
 s_lshl_b32 s79, s80, 3
 v_mfma_f32_16x16x32_bf16 v[112:115], a[12:15], v[208:211], v[112:115]
 ds_read_b128 v[176:179], v18 offset:8192
 v_fma_f32 v38, v38, s83, -v56
 v_mfma_f32_16x16x32_bf16 v[116:119], a[16:19], v[208:211], v[116:119]
 buffer_load_dwordx4 a[240:243], v31, s[52:55], s51 offen offset:0 sc1
 v_mfma_f32_16x16x32_bf16 v[120:123], a[20:23], v[208:211], v[120:123]
 v_fma_f32 v39, v39, s83, -v56
 v_fma_f32 v40, v40, s83, -v56
 v_mfma_f32_16x16x32_bf16 v[124:127], a[12:15], v[212:215], v[124:127]
 ds_read_b128 v[180:183], v18 offset:10240
 v_fma_f32 v41, v41, s83, -v56
 v_mfma_f32_16x16x32_bf16 v[128:131], a[16:19], v[212:215], v[128:131]
 buffer_load_dwordx4 v11, s[8:11], s30 offen offset:1024 lds
 v_mfma_f32_16x16x32_bf16 v[132:135], a[20:23], v[212:215], v[132:135]
 v_fma_f32 v42, v42, s83, -v56
 v_fma_f32 v43, v43, s83, -v56
 v_mfma_f32_16x16x32_bf16 v[136:139], a[12:15], v[216:219], v[136:139]
 ds_read_b128 v[184:187], v18 offset:12288
 v_mfma_f32_16x16x32_bf16 v[140:143], a[16:19], v[216:219], v[140:143]
 v_exp_f32 v36, v36
 v_mfma_f32_16x16x32_bf16 v[144:147], a[20:23], v[216:219], v[144:147]
 v_exp_f32 v37, v37
 v_mfma_f32_16x16x32_bf16 v[148:151], a[12:15], v[220:223], v[148:151]
 ds_read_b128 v[188:191], v18 offset:14336
 v_mfma_f32_16x16x32_bf16 v[152:155], a[16:19], v[220:223], v[152:155]
 v_exp_f32 v38, v38
 v_mfma_f32_16x16x32_bf16 v[156:159], a[20:23], v[220:223], v[156:159]
 s_waitcnt lgkmcnt(4)
 v_mfma_f32_16x16x32_bf16 v[64:67], a[24:27], v[160:163], v[64:67]
 ds_read_b128 v[192:195], v19 offset:0
 v_mfma_f32_16x16x32_bf16 v[68:71], a[28:31], v[160:163], v[68:71]
 v_add_u32 v18, s33, v14
 v_mfma_f32_16x16x32_bf16 v[72:75], a[32:35], v[160:163], v[72:75]
 v_exp_f32 v39, v39
 v_mfma_f32_16x16x32_bf16 v[76:79], a[24:27], v[164:167], v[76:79]
 ds_read_b128 v[196:199], v19 offset:2048
 v_mfma_f32_16x16x32_bf16 v[80:83], a[28:31], v[164:167], v[80:83]
 buffer_load_dwordx4 v12, s[8:11], s30 offen offset:2048 lds
 v_mfma_f32_16x16x32_bf16 v[84:87], a[32:35], v[164:167], v[84:87]
 v_exp_f32 v40, v40
 v_mfma_f32_16x16x32_bf16 v[88:91], a[24:27], v[168:171], v[88:91]
 ds_read_b128 v[200:203], v19 offset:4096
 v_mfma_f32_16x16x32_bf16 v[92:95], a[28:31], v[168:171], v[92:95]
 v_exp_f32 v41, v41
 v_mfma_f32_16x16x32_bf16 v[96:99], a[32:35], v[168:171], v[96:99]
 v_exp_f32 v42, v42
 v_mfma_f32_16x16x32_bf16 v[100:103], a[24:27], v[172:175], v[100:103]
 ds_read_b128 v[204:207], v19 offset:6144
 v_mfma_f32_16x16x32_bf16 v[104:107], a[28:31], v[172:175], v[104:107]
 buffer_load_dwordx4 a[244:247], v31, s[52:55], s51 offen offset:512 sc1
 v_mfma_f32_16x16x32_bf16 v[108:111], a[32:35], v[172:175], v[108:111]
 s_waitcnt lgkmcnt(4)
 v_mfma_f32_16x16x32_bf16 v[112:115], a[24:27], v[176:179], v[112:115]
 ds_read_b128 v[208:211], v19 offset:8192
 v_mfma_f32_16x16x32_bf16 v[116:119], a[28:31], v[176:179], v[116:119]
 v_exp_f32 v43, v43
 v_mfma_f32_16x16x32_bf16 v[120:123], a[32:35], v[176:179], v[120:123]
 s_nop 0
 v_add_f32 v56, v40, v41
 v_mfma_f32_16x16x32_bf16 v[124:127], a[24:27], v[180:183], v[124:127]
 ds_read_b128 v[212:215], v19 offset:10240
 v_add_f32 v56, v56, v42
 v_mfma_f32_16x16x32_bf16 v[128:131], a[28:31], v[180:183], v[128:131]
 buffer_load_dwordx4 v13, s[8:11], s30 offen offset:3072 lds
 v_mfma_f32_16x16x32_bf16 v[132:135], a[32:35], v[180:183], v[132:135]
 s_add_u32 s30, s30, 128
 s_add_u32 m0, m0, 16384
 v_mfma_f32_16x16x32_bf16 v[136:139], a[24:27], v[184:187], v[136:139]
 ds_read_b128 v[216:219], v19 offset:12288
 v_add_f32 v56, v56, v43
 v_mfma_f32_16x16x32_bf16 v[140:143], a[28:31], v[184:187], v[140:143]
 s_cmp_lt_u32 m0, s46
 s_cselect_b32 m0, m0, s47
 v_mfma_f32_16x16x32_bf16 v[144:147], a[32:35], v[184:187], v[144:147]
 v_cndmask_b32 v56, 0, v56, s[60:61]
 v_add_f32 v56, v56, v36
 v_mfma_f32_16x16x32_bf16 v[148:151], a[24:27], v[188:191], v[148:151]
 ds_read_b128 v[220:223], v19 offset:14336
 v_add_f32 v56, v56, v37
 v_mfma_f32_16x16x32_bf16 v[152:155], a[28:31], v[188:191], v[152:155]
 v_add_f32 v56, v56, v38
 v_add_f32 v56, v56, v39
 v_mfma_f32_16x16x32_bf16 v[156:159], a[32:35], v[188:191], v[156:159]
 s_waitcnt vmcnt(14) lgkmcnt(4)
 s_barrier
 v_mfma_f32_16x16x32_bf16 v[64:67], a[36:39], v[192:195], v[64:67]
 ds_read_b128 v[160:163], v18 offset:0
 v_mov_b32 v57, v56
 v_mfma_f32_16x16x32_bf16 v[68:71], a[40:43], v[192:195], v[68:71]
 s_nop 1
 v_mfma_f32_16x16x32_bf16 v[72:75], a[44:47], v[192:195], v[72:75]
 v_add_u32 v19, s33, v15
 s_add_u32 s33, s33, 16384
 v_mfma_f32_16x16x32_bf16 v[76:79], a[36:39], v[196:199], v[76:79]
 ds_read_b128 v[164:167], v18 offset:2048
 v_mfma_f32_16x16x32_bf16 v[80:83], a[40:43], v[196:199], v[80:83]
 buffer_load_dwordx4 v10, s[8:11], s30 offen offset:0 lds
 v_mfma_f32_16x16x32_bf16 v[84:87], a[44:47], v[196:199], v[84:87]
 s_cmp_lt_u32 s33, 98304
 s_cselect_b32 s33, s33, 0
 v_mfma_f32_16x16x32_bf16 v[88:91], a[36:39], v[200:203], v[88:91]
 ds_read_b128 v[168:171], v18 offset:4096
 v_mfma_f32_16x16x32_bf16 v[92:95], a[40:43], v[200:203], v[92:95]
 buffer_load_dwordx4 a[248:251], v31, s[52:55], s51 offen offset:1024 sc1
 v_mfma_f32_16x16x32_bf16 v[96:99], a[44:47], v[200:203], v[96:99]
 v_permlane32_swap_b32 v56, v57
 v_mfma_f32_16x16x32_bf16 v[100:103], a[36:39], v[204:207], v[100:103]
 ds_read_b128 v[172:175], v18 offset:6144
 v_add_f32 v56, v56, v57
 v_mfma_f32_16x16x32_bf16 v[104:107], a[40:43], v[204:207], v[104:107]
 v_mov_b32 v57, v56
 v_mfma_f32_16x16x32_bf16 v[108:111], a[44:47], v[204:207], v[108:111]
 s_waitcnt lgkmcnt(4)
 v_mfma_f32_16x16x32_bf16 v[112:115], a[36:39], v[208:211], v[112:115]
 ds_read_b128 v[176:179], v18 offset:8192
 v_mfma_f32_16x16x32_bf16 v[116:119], a[40:43], v[208:211], v[116:119]
 s_nop 1
 v_mfma_f32_16x16x32_bf16 v[120:123], a[44:47], v[208:211], v[120:123]
 v_permlane16_swap_b32 v56, v57
 v_mfma_f32_16x16x32_bf16 v[124:127], a[36:39], v[212:215], v[124:127]
 ds_read_b128 v[180:183], v18 offset:10240
 v_add_f32 v56, v56, v57
 v_mfma_f32_16x16x32_bf16 v[128:131], a[40:43], v[212:215], v[128:131]
 buffer_load_dwordx4 v11, s[8:11], s30 offen offset:1024 lds
 v_mfma_f32_16x16x32_bf16 v[132:135], a[44:47], v[212:215], v[132:135]
 v_rcp_f32 v56, v56
 v_mfma_f32_16x16x32_bf16 v[136:139], a[36:39], v[216:219], v[136:139]
 ds_read_b128 v[184:187], v18 offset:12288
 s_nop 0
 v_mfma_f32_16x16x32_bf16 v[140:143], a[40:43], v[216:219], v[140:143]
 v_mul_f32 v36, v36, v56
 v_mul_f32 v37, v37, v56
 v_mfma_f32_16x16x32_bf16 v[144:147], a[44:47], v[216:219], v[144:147]
 v_mul_f32 v38, v38, v56
 v_mul_f32 v39, v39, v56
 v_mfma_f32_16x16x32_bf16 v[148:151], a[36:39], v[220:223], v[148:151]
 ds_read_b128 v[188:191], v18 offset:14336
 v_mul_f32 v40, v40, v56
 v_mfma_f32_16x16x32_bf16 v[152:155], a[40:43], v[220:223], v[152:155]
 v_mul_f32 v41, v41, v56
 v_mul_f32 v42, v42, v56
 v_mfma_f32_16x16x32_bf16 v[156:159], a[44:47], v[220:223], v[156:159]
 s_waitcnt lgkmcnt(4)
 v_mul_f32 v43, v43, v56
 v_mfma_f32_16x16x32_bf16 v[64:67], a[48:51], v[160:163], v[64:67]
 ds_read_b128 v[192:195], v19 offset:0
 v_max3_f32 v56, v44, v45, v46
 v_mfma_f32_16x16x32_bf16 v[68:71], a[52:55], v[160:163], v[68:71]
 v_add_u32 v18, s33, v14
 v_max3_f32 v56, v56, v47, v48
 v_mfma_f32_16x16x32_bf16 v[72:75], a[56:59], v[160:163], v[72:75]
 v_max3_f32 v56, v56, v49, v50
 v_max3_f32 v56, v56, v51, v52
 v_mfma_f32_16x16x32_bf16 v[76:79], a[48:51], v[164:167], v[76:79]
 ds_read_b128 v[196:199], v19 offset:2048
 v_max3_f32 v56, v56, v53, v54
 v_mfma_f32_16x16x32_bf16 v[80:83], a[52:55], v[164:167], v[80:83]
 buffer_load_dwordx4 v12, s[8:11], s30 offen offset:2048 lds
 v_mfma_f32_16x16x32_bf16 v[84:87], a[56:59], v[164:167], v[84:87]
 buffer_load_dwordx4 a[252:255], v31, s[52:55], s51 offen offset:1536 sc1
 v_mfma_f32_16x16x32_bf16 v[88:91], a[48:51], v[168:171], v[88:91]
 ds_read_b128 v[200:203], v19 offset:4096
 v_max_f32 v56, v56, v55
 v_mfma_f32_16x16x32_bf16 v[92:95], a[52:55], v[168:171], v[92:95]
 v_mov_b32 v57, v56
 v_mfma_f32_16x16x32_bf16 v[96:99], a[56:59], v[168:171], v[96:99]
 s_nop 1
 v_mfma_f32_16x16x32_bf16 v[100:103], a[48:51], v[172:175], v[100:103]
 ds_read_b128 v[204:207], v19 offset:6144
 v_mfma_f32_16x16x32_bf16 v[104:107], a[52:55], v[172:175], v[104:107]
 v_permlane32_swap_b32 v56, v57
 v_mfma_f32_16x16x32_bf16 v[108:111], a[56:59], v[172:175], v[108:111]
 s_waitcnt lgkmcnt(4)
 v_max_f32 v56, v56, v57
 v_mfma_f32_16x16x32_bf16 v[112:115], a[48:51], v[176:179], v[112:115]
 ds_read_b128 v[208:211], v19 offset:8192
 v_mov_b32 v57, v56
 v_mfma_f32_16x16x32_bf16 v[116:119], a[52:55], v[176:179], v[116:119]
 s_nop 1
 v_mfma_f32_16x16x32_bf16 v[120:123], a[56:59], v[176:179], v[120:123]
 v_permlane16_swap_b32 v56, v57
 v_mfma_f32_16x16x32_bf16 v[124:127], a[48:51], v[180:183], v[124:127]
 ds_read_b128 v[212:215], v19 offset:10240
 v_max_f32 v56, v56, v57
 v_mfma_f32_16x16x32_bf16 v[128:131], a[52:55], v[180:183], v[128:131]
 buffer_load_dwordx4 v13, s[8:11], s30 offen offset:3072 lds
 v_mfma_f32_16x16x32_bf16 v[132:135], a[56:59], v[180:183], v[132:135]
 s_add_u32 s30, s30, 128
 s_add_u32 m0, m0, 16384
 v_mfma_f32_16x16x32_bf16 v[136:139], a[48:51], v[184:187], v[136:139]
 ds_read_b128 v[216:219], v19 offset:12288
 v_mul_f32 v56, s83, v56
 v_mfma_f32_16x16x32_bf16 v[140:143], a[52:55], v[184:187], v[140:143]
 s_cmp_lt_u32 m0, s46
 s_cselect_b32 m0, m0, s47
 v_mfma_f32_16x16x32_bf16 v[144:147], a[56:59], v[184:187], v[144:147]
 v_fma_f32 v44, v44, s83, -v56
 v_fma_f32 v45, v45, s83, -v56
 v_mfma_f32_16x16x32_bf16 v[148:151], a[48:51], v[188:191], v[148:151]
 ds_read_b128 v[220:223], v19 offset:14336
 v_fma_f32 v46, v46, s83, -v56
 v_mfma_f32_16x16x32_bf16 v[152:155], a[52:55], v[188:191], v[152:155]
 v_fma_f32 v47, v47, s83, -v56
 v_fma_f32 v48, v48, s83, -v56
 v_mfma_f32_16x16x32_bf16 v[156:159], a[56:59], v[188:191], v[156:159]
 s_waitcnt vmcnt(16) lgkmcnt(4)
 s_barrier
 v_mfma_f32_16x16x32_bf16 v[64:67], a[60:63], v[192:195], v[64:67]
 ds_read_b128 v[160:163], v18 offset:0
 v_fma_f32 v49, v49, s83, -v56
 v_mfma_f32_16x16x32_bf16 v[68:71], a[64:67], v[192:195], v[68:71]
 buffer_load_dwordx4 v[24:27], v31, s[52:55], s51 offen offset:2048 sc1
 v_mfma_f32_16x16x32_bf16 v[72:75], a[68:71], v[192:195], v[72:75]
 v_add_u32 v19, s33, v15
 s_add_u32 s33, s33, 16384
 v_mfma_f32_16x16x32_bf16 v[76:79], a[60:63], v[196:199], v[76:79]
 ds_read_b128 v[164:167], v18 offset:2048
 v_fma_f32 v50, v50, s83, -v56
 v_mfma_f32_16x16x32_bf16 v[80:83], a[64:67], v[196:199], v[80:83]
 buffer_load_dwordx4 v10, s[8:11], s30 offen offset:0 lds
 v_mfma_f32_16x16x32_bf16 v[84:87], a[68:71], v[196:199], v[84:87]
 s_cmp_lt_u32 s33, 98304
 s_cselect_b32 s33, s33, 0
 v_mfma_f32_16x16x32_bf16 v[88:91], a[60:63], v[200:203], v[88:91]
 ds_read_b128 v[168:171], v18 offset:4096
 v_fma_f32 v51, v51, s83, -v56
 v_mfma_f32_16x16x32_bf16 v[92:95], a[64:67], v[200:203], v[92:95]
 v_fma_f32 v52, v52, s83, -v56
 v_fma_f32 v53, v53, s83, -v56
 v_mfma_f32_16x16x32_bf16 v[96:99], a[68:71], v[200:203], v[96:99]
 v_fma_f32 v54, v54, s83, -v56
 v_fma_f32 v55, v55, s83, -v56
 v_mfma_f32_16x16x32_bf16 v[100:103], a[60:63], v[204:207], v[100:103]
 ds_read_b128 v[172:175], v18 offset:6144
 v_mfma_f32_16x16x32_bf16 v[104:107], a[64:67], v[204:207], v[104:107]
 v_exp_f32 v44, v44
 v_mfma_f32_16x16x32_bf16 v[108:111], a[68:71], v[204:207], v[108:111]
 s_waitcnt lgkmcnt(4)
 v_mfma_f32_16x16x32_bf16 v[112:115], a[60:63], v[208:211], v[112:115]
 ds_read_b128 v[176:179], v18 offset:8192
 v_mfma_f32_16x16x32_bf16 v[116:119], a[64:67], v[208:211], v[116:119]
 v_exp_f32 v45, v45
 v_mfma_f32_16x16x32_bf16 v[120:123], a[68:71], v[208:211], v[120:123]
 v_exp_f32 v46, v46
 v_mfma_f32_16x16x32_bf16 v[124:127], a[60:63], v[212:215], v[124:127]
 ds_read_b128 v[180:183], v18 offset:10240
 v_mfma_f32_16x16x32_bf16 v[128:131], a[64:67], v[212:215], v[128:131]
 buffer_load_dwordx4 v11, s[8:11], s30 offen offset:1024 lds
 v_mfma_f32_16x16x32_bf16 v[132:135], a[68:71], v[212:215], v[132:135]
 v_exp_f32 v47, v47
 v_mfma_f32_16x16x32_bf16 v[136:139], a[60:63], v[216:219], v[136:139]
 ds_read_b128 v[184:187], v18 offset:12288
 v_mfma_f32_16x16x32_bf16 v[140:143], a[64:67], v[216:219], v[140:143]
 v_exp_f32 v48, v48
 v_mfma_f32_16x16x32_bf16 v[144:147], a[68:71], v[216:219], v[144:147]
 v_exp_f32 v49, v49
 v_mfma_f32_16x16x32_bf16 v[148:151], a[60:63], v[220:223], v[148:151]
 ds_read_b128 v[188:191], v18 offset:14336
 v_mfma_f32_16x16x32_bf16 v[152:155], a[64:67], v[220:223], v[152:155]
 buffer_load_dwordx4 v[6:9], v31, s[52:55], s51 offen offset:2560 sc1
 v_mfma_f32_16x16x32_bf16 v[156:159], a[68:71], v[220:223], v[156:159]
 s_waitcnt lgkmcnt(4)
 v_mfma_f32_16x16x32_bf16 v[64:67], a[72:75], v[160:163], v[64:67]
 ds_read_b128 v[192:195], v19 offset:0
 v_mfma_f32_16x16x32_bf16 v[68:71], a[76:79], v[160:163], v[68:71]
 v_add_u32 v18, s33, v14
 v_mfma_f32_16x16x32_bf16 v[72:75], a[80:83], v[160:163], v[72:75]
 v_exp_f32 v50, v50
 v_mfma_f32_16x16x32_bf16 v[76:79], a[72:75], v[164:167], v[76:79]
 ds_read_b128 v[196:199], v19 offset:2048
 v_mfma_f32_16x16x32_bf16 v[80:83], a[76:79], v[164:167], v[80:83]
 buffer_load_dwordx4 v12, s[8:11], s30 offen offset:2048 lds
 v_mfma_f32_16x16x32_bf16 v[84:87], a[80:83], v[164:167], v[84:87]
 v_exp_f32 v51, v51
 v_mfma_f32_16x16x32_bf16 v[88:91], a[72:75], v[168:171], v[88:91]
 ds_read_b128 v[200:203], v19 offset:4096
 v_mfma_f32_16x16x32_bf16 v[92:95], a[76:79], v[168:171], v[92:95]
 v_exp_f32 v52, v52
 v_mfma_f32_16x16x32_bf16 v[96:99], a[80:83], v[168:171], v[96:99]
 v_exp_f32 v53, v53
 v_mfma_f32_16x16x32_bf16 v[100:103], a[72:75], v[172:175], v[100:103]
 ds_read_b128 v[204:207], v19 offset:6144
 v_mfma_f32_16x16x32_bf16 v[104:107], a[76:79], v[172:175], v[104:107]
 v_exp_f32 v54, v54
 v_mfma_f32_16x16x32_bf16 v[108:111], a[80:83], v[172:175], v[108:111]
 s_waitcnt lgkmcnt(4)
 v_mfma_f32_16x16x32_bf16 v[112:115], a[72:75], v[176:179], v[112:115]
 ds_read_b128 v[208:211], v19 offset:8192
 v_mfma_f32_16x16x32_bf16 v[116:119], a[76:79], v[176:179], v[116:119]
 v_exp_f32 v55, v55
 v_mfma_f32_16x16x32_bf16 v[120:123], a[80:83], v[176:179], v[120:123]
 s_nop 0
 v_add_f32 v56, v52, v53
 v_mfma_f32_16x16x32_bf16 v[124:127], a[72:75], v[180:183], v[124:127]
 ds_read_b128 v[212:215], v19 offset:10240
 v_add_f32 v56, v56, v54
 v_mfma_f32_16x16x32_bf16 v[128:131], a[76:79], v[180:183], v[128:131]
 buffer_load_dwordx4 v13, s[8:11], s30 offen offset:3072 lds
 v_mfma_f32_16x16x32_bf16 v[132:135], a[80:83], v[180:183], v[132:135]
 s_add_u32 s30, s30, 128
 s_add_u32 m0, m0, 16384
 v_mfma_f32_16x16x32_bf16 v[136:139], a[72:75], v[184:187], v[136:139]
 ds_read_b128 v[216:219], v19 offset:12288
 s_add_u32 s21, s50, 4096
 v_mfma_f32_16x16x32_bf16 v[140:143], a[76:79], v[184:187], v[140:143]
 s_cmp_lt_u32 m0, s46
 s_cselect_b32 m0, m0, s47
 v_mfma_f32_16x16x32_bf16 v[144:147], a[80:83], v[184:187], v[144:147]
 buffer_load_dwordx4 v[60:63], v30, s[16:19], s21 offen offset:2048 sc1
 v_mfma_f32_16x16x32_bf16 v[148:151], a[72:75], v[188:191], v[148:151]
 ds_read_b128 v[220:223], v19 offset:14336
 v_add_f32 v56, v56, v55
 v_mfma_f32_16x16x32_bf16 v[152:155], a[76:79], v[188:191], v[152:155]
 v_cndmask_b32 v56, 0, v56, s[60:61]
 v_add_f32 v56, v56, v44
 v_mfma_f32_16x16x32_bf16 v[156:159], a[80:83], v[188:191], v[156:159]
 s_waitcnt vmcnt(19) lgkmcnt(4)
 s_barrier
 v_mfma_f32_16x16x32_bf16 v[64:67], a[84:87], v[192:195], v[64:67]
 ds_read_b128 v[160:163], v18 offset:0
 v_add_f32 v56, v56, v45
 v_mfma_f32_16x16x32_bf16 v[68:71], a[88:91], v[192:195], v[68:71]
 v_add_f32 v56, v56, v46
 v_add_f32 v56, v56, v47
 v_mfma_f32_16x16x32_bf16 v[72:75], a[92:95], v[192:195], v[72:75]
 v_add_u32 v19, s33, v15
 s_add_u32 s33, s33, 16384
 v_mfma_f32_16x16x32_bf16 v[76:79], a[84:87], v[196:199], v[76:79]
 ds_read_b128 v[164:167], v18 offset:2048
 v_add_f32 v56, v56, v48
 v_mfma_f32_16x16x32_bf16 v[80:83], a[88:91], v[196:199], v[80:83]
 buffer_load_dwordx4 v10, s[8:11], s30 offen offset:0 lds
 v_mfma_f32_16x16x32_bf16 v[84:87], a[92:95], v[196:199], v[84:87]
 s_cmp_lt_u32 s33, 98304
 s_cselect_b32 s33, s33, 0
 v_mfma_f32_16x16x32_bf16 v[88:91], a[84:87], v[200:203], v[88:91]
 ds_read_b128 v[168:171], v18 offset:4096
 v_add_f32 v56, v56, v49
 v_mfma_f32_16x16x32_bf16 v[92:95], a[88:91], v[200:203], v[92:95]
 v_add_f32 v56, v56, v50
 v_add_f32 v56, v56, v51
 v_mfma_f32_16x16x32_bf16 v[96:99], a[92:95], v[200:203], v[96:99]
 v_mov_b32 v57, v56
 v_mfma_f32_16x16x32_bf16 v[100:103], a[84:87], v[204:207], v[100:103]
 ds_read_b128 v[172:175], v18 offset:6144
 v_mfma_f32_16x16x32_bf16 v[104:107], a[88:91], v[204:207], v[104:107]
 s_nop 1
 v_mfma_f32_16x16x32_bf16 v[108:111], a[92:95], v[204:207], v[108:111]
 s_waitcnt lgkmcnt(4)
 v_mfma_f32_16x16x32_bf16 v[112:115], a[84:87], v[208:211], v[112:115]
 ds_read_b128 v[176:179], v18 offset:8192
 v_mfma_f32_16x16x32_bf16 v[116:119], a[88:91], v[208:211], v[116:119]
 v_permlane32_swap_b32 v56, v57
 v_mfma_f32_16x16x32_bf16 v[120:123], a[92:95], v[208:211], v[120:123]
 v_add_f32 v56, v56, v57
 v_mov_b32 v57, v56
 v_mfma_f32_16x16x32_bf16 v[124:127], a[84:87], v[212:215], v[124:127]
 ds_read_b128 v[180:183], v18 offset:10240
 v_mfma_f32_16x16x32_bf16 v[128:131], a[88:91], v[212:215], v[128:131]
 buffer_load_dwordx4 v11, s[8:11], s30 offen offset:1024 lds
 v_mfma_f32_16x16x32_bf16 v[132:135], a[92:95], v[212:215], v[132:135]
 s_add_u32 s21, s50, 8192
 v_mfma_f32_16x16x32_bf16 v[136:139], a[84:87], v[216:219], v[136:139]
 ds_read_b128 v[184:187], v18 offset:12288
 v_mfma_f32_16x16x32_bf16 v[140:143], a[88:91], v[216:219], v[140:143]
 buffer_load_dwordx4 v[248:251], v30, s[16:19], s21 offen offset:2048 sc1
 v_mfma_f32_16x16x32_bf16 v[144:147], a[92:95], v[216:219], v[144:147]
 s_nop 1
 v_mfma_f32_16x16x32_bf16 v[148:151], a[84:87], v[220:223], v[148:151]
 ds_read_b128 v[188:191], v18 offset:14336
 v_mfma_f32_16x16x32_bf16 v[152:155], a[88:91], v[220:223], v[152:155]
 v_permlane16_swap_b32 v56, v57
 v_mfma_f32_16x16x32_bf16 v[156:159], a[92:95], v[220:223], v[156:159]
 s_waitcnt lgkmcnt(4)
 v_add_f32 v56, v56, v57
 v_mfma_f32_16x16x32_bf16 v[64:67], a[96:99], v[160:163], v[64:67]
 ds_read_b128 v[192:195], v19 offset:0
 v_mfma_f32_16x16x32_bf16 v[68:71], a[100:103], v[160:163], v[68:71]
 v_add_u32 v18, s33, v14
 v_mfma_f32_16x16x32_bf16 v[72:75], a[104:107], v[160:163], v[72:75]
 v_rcp_f32 v56, v56
 v_mfma_f32_16x16x32_bf16 v[76:79], a[96:99], v[164:167], v[76:79]
 ds_read_b128 v[196:199], v19 offset:2048
 s_nop 0
 v_mfma_f32_16x16x32_bf16 v[80:83], a[100:103], v[164:167], v[80:83]
 buffer_load_dwordx4 v12, s[8:11], s30 offen offset:2048 lds
 v_mfma_f32_16x16x32_bf16 v[84:87], a[104:107], v[164:167], v[84:87]
 v_mul_f32 v44, v44, v56
 v_mul_f32 v45, v45, v56
 v_mfma_f32_16x16x32_bf16 v[88:91], a[96:99], v[168:171], v[88:91]
 ds_read_b128 v[200:203], v19 offset:4096
 v_mul_f32 v46, v46, v56
 v_mfma_f32_16x16x32_bf16 v[92:95], a[100:103], v[168:171], v[92:95]
 v_mul_f32 v47, v47, v56
 v_mul_f32 v48, v48, v56
 v_mfma_f32_16x16x32_bf16 v[96:99], a[104:107], v[168:171], v[96:99]
 v_mul_f32 v49, v49, v56
 v_mul_f32 v50, v50, v56
 v_mfma_f32_16x16x32_bf16 v[100:103], a[96:99], v[172:175], v[100:103]
 ds_read_b128 v[204:207], v19 offset:6144
 v_mul_f32 v51, v51, v56
 v_mfma_f32_16x16x32_bf16 v[104:107], a[100:103], v[172:175], v[104:107]
 v_mul_f32 v52, v52, v56
 v_mul_f32 v53, v53, v56
 v_mfma_f32_16x16x32_bf16 v[108:111], a[104:107], v[172:175], v[108:111]
 s_waitcnt lgkmcnt(4)
 v_mul_f32 v54, v54, v56
 v_mfma_f32_16x16x32_bf16 v[112:115], a[96:99], v[176:179], v[112:115]
 ds_read_b128 v[208:211], v19 offset:8192
 v_mul_f32 v55, v55, v56
 v_mfma_f32_16x16x32_bf16 v[116:119], a[100:103], v[176:179], v[116:119]
 v_cvt_pk_bf16_f32 v240, v40, v41
 v_cvt_pk_bf16_f32 v241, v42, v43
 v_mfma_f32_16x16x32_bf16 v[120:123], a[104:107], v[176:179], v[120:123]
 v_cvt_pk_bf16_f32 v242, v52, v53
 v_cvt_pk_bf16_f32 v243, v54, v55
 v_mfma_f32_16x16x32_bf16 v[124:127], a[96:99], v[180:183], v[124:127]
 ds_read_b128 v[212:215], v19 offset:10240
 s_add_u32 s21, s50, 8192
 v_mfma_f32_16x16x32_bf16 v[128:131], a[100:103], v[180:183], v[128:131]
 buffer_load_dwordx4 v13, s[8:11], s30 offen offset:3072 lds
 v_mfma_f32_16x16x32_bf16 v[132:135], a[104:107], v[180:183], v[132:135]
 s_add_u32 s30, s30, 128
 s_add_u32 m0, m0, 16384
 v_mfma_f32_16x16x32_bf16 v[136:139], a[96:99], v[184:187], v[136:139]
 ds_read_b128 v[216:219], v19 offset:12288
 v_cvt_pk_bf16_f32 v236, v44, v45
 v_mfma_f32_16x16x32_bf16 v[140:143], a[100:103], v[184:187], v[140:143]
 s_cmp_lt_u32 m0, s46
 s_cselect_b32 m0, m0, s47
 v_mfma_f32_16x16x32_bf16 v[144:147], a[104:107], v[184:187], v[144:147]
 buffer_load_dwordx4 v[252:255], v30, s[16:19], s21 offen offset:3072 sc1
 v_mfma_f32_16x16x32_bf16 v[148:151], a[96:99], v[188:191], v[148:151]
 ds_read_b128 v[220:223], v19 offset:14336
 v_cvt_pk_bf16_f32 v237, v46, v47
 v_mfma_f32_16x16x32_bf16 v[152:155], a[100:103], v[188:191], v[152:155]
 v_cvt_pk_bf16_f32 v238, v48, v49
 v_cvt_pk_bf16_f32 v239, v50, v51
 v_mfma_f32_16x16x32_bf16 v[156:159], a[104:107], v[188:191], v[156:159]
 s_waitcnt vmcnt(19) lgkmcnt(4)
 s_barrier
 v_mfma_f32_16x16x32_bf16 v[64:67], a[108:111], v[192:195], v[64:67]
 ds_read_b128 v[160:163], v18 offset:0
 v_cvt_pk_bf16_f32 v244, v36, v37
 v_mfma_f32_16x16x32_bf16 v[68:71], a[112:115], v[192:195], v[68:71]
 v_cvt_pk_bf16_f32 v245, v38, v39
 v_mfma_f32_16x16x32_bf16 v[72:75], a[116:119], v[192:195], v[72:75]
 v_add_u32 v19, s33, v15
 s_add_u32 s33, s33, 16384
 v_mfma_f32_16x16x32_bf16 v[76:79], a[108:111], v[196:199], v[76:79]
 ds_read_b128 v[164:167], v18 offset:2048
 v_mfma_f32_16x16x32_bf16 v[80:83], a[112:115], v[196:199], v[80:83]
 buffer_load_dwordx4 v10, s[8:11], s30 offen offset:0 lds
 v_mfma_f32_16x16x32_bf16 v[84:87], a[116:119], v[196:199], v[84:87]
 s_cmp_lt_u32 s33, 98304
 s_cselect_b32 s33, s33, 0
 v_mfma_f32_16x16x32_bf16 v[88:91], a[108:111], v[200:203], v[88:91]
 ds_read_b128 v[168:171], v18 offset:4096
 v_mfma_f32_16x16x32_bf16 v[92:95], a[112:115], v[200:203], v[92:95]
 v_permlane16_swap_b32 v240, v242
 v_mfma_f32_16x16x32_bf16 v[96:99], a[116:119], v[200:203], v[96:99]
 v_permlane16_swap_b32 v241, v243
 v_mfma_f32_16x16x32_bf16 v[100:103], a[108:111], v[204:207], v[100:103]
 ds_read_b128 v[172:175], v18 offset:6144
 v_mfma_f32_16x16x32_bf16 v[104:107], a[112:115], v[204:207], v[104:107]
 v_mfma_f32_16x16x32_bf16 v[108:111], a[116:119], v[204:207], v[108:111]
 s_waitcnt lgkmcnt(4)
 v_mfma_f32_16x16x32_bf16 v[112:115], a[108:111], v[208:211], v[112:115]
 ds_read_b128 v[176:179], v18 offset:8192
 v_mfma_f32_16x16x32_bf16 v[116:119], a[112:115], v[208:211], v[116:119]
 v_mfma_f32_16x16x32_bf16 v[120:123], a[116:119], v[208:211], v[120:123]
 v_mfma_f32_16x16x32_bf16 v[124:127], a[108:111], v[212:215], v[124:127]
 ds_read_b128 v[180:183], v18 offset:10240
 v_mfma_f32_16x16x32_bf16 v[128:131], a[112:115], v[212:215], v[128:131]
 buffer_load_dwordx4 v11, s[8:11], s30 offen offset:1024 lds
 v_mfma_f32_16x16x32_bf16 v[132:135], a[116:119], v[212:215], v[132:135]
 v_mfma_f32_16x16x32_bf16 v[136:139], a[108:111], v[216:219], v[136:139]
 ds_read_b128 v[184:187], v18 offset:12288
 v_mfma_f32_16x16x32_bf16 v[140:143], a[112:115], v[216:219], v[140:143]
 v_mfma_f32_16x16x32_bf16 v[144:147], a[116:119], v[216:219], v[144:147]
 v_mfma_f32_16x16x32_bf16 v[148:151], a[108:111], v[220:223], v[148:151]
 ds_read_b128 v[188:191], v18 offset:14336
 v_mfma_f32_16x16x32_bf16 v[152:155], a[112:115], v[220:223], v[152:155]
 v_mfma_f32_16x16x32_bf16 v[156:159], a[116:119], v[220:223], v[156:159]
 s_waitcnt lgkmcnt(4)
 v_mfma_f32_16x16x32_bf16 v[64:67], a[120:123], v[160:163], v[64:67]
 ds_read_b128 v[192:195], v19 offset:0
 v_mfma_f32_16x16x32_bf16 v[68:71], a[124:127], v[160:163], v[68:71]
 v_add_u32 v18, s33, v14
 v_mfma_f32_16x16x32_bf16 v[72:75], a[128:131], v[160:163], v[72:75]
 v_mfma_f32_16x16x32_bf16 v[76:79], a[120:123], v[164:167], v[76:79]
 ds_read_b128 v[196:199], v19 offset:2048
 v_mfma_f32_16x16x32_bf16 v[80:83], a[124:127], v[164:167], v[80:83]
 buffer_load_dwordx4 v12, s[8:11], s30 offen offset:2048 lds
 v_mfma_f32_16x16x32_bf16 v[84:87], a[128:131], v[164:167], v[84:87]
 v_mfma_f32_16x16x32_bf16 v[88:91], a[120:123], v[168:171], v[88:91]
 ds_read_b128 v[200:203], v19 offset:4096
 v_mfma_f32_16x16x32_bf16 v[92:95], a[124:127], v[168:171], v[92:95]
 v_mfma_f32_16x16x32_bf16 v[96:99], a[128:131], v[168:171], v[96:99]
 v_mfma_f32_16x16x32_bf16 v[100:103], a[120:123], v[172:175], v[100:103]
 ds_read_b128 v[204:207], v19 offset:6144
 v_mfma_f32_16x16x32_bf16 v[104:107], a[124:127], v[172:175], v[104:107]
 v_mfma_f32_16x16x32_bf16 v[108:111], a[128:131], v[172:175], v[108:111]
 s_waitcnt lgkmcnt(4)
 v_mfma_f32_16x16x32_bf16 v[112:115], a[120:123], v[176:179], v[112:115]
 ds_read_b128 v[208:211], v19 offset:8192
 v_mfma_f32_16x16x32_bf16 v[116:119], a[124:127], v[176:179], v[116:119]
 v_mfma_f32_16x16x32_bf16 v[120:123], a[128:131], v[176:179], v[120:123]
 v_mfma_f32_16x16x32_bf16 v[124:127], a[120:123], v[180:183], v[124:127]
 ds_read_b128 v[212:215], v19 offset:10240
 v_mfma_f32_16x16x32_bf16 v[128:131], a[124:127], v[180:183], v[128:131]
 buffer_load_dwordx4 v13, s[8:11], s30 offen offset:3072 lds
 v_mfma_f32_16x16x32_bf16 v[132:135], a[128:131], v[180:183], v[132:135]
 s_add_u32 s30, s30, s25
 s_sub_u32 s30, s30, 1152
 v_mfma_f32_16x16x32_bf16 v[136:139], a[120:123], v[184:187], v[136:139]
 ds_read_b128 v[216:219], v19 offset:12288
 s_mov_b32 s25, 163840
 v_mfma_f32_16x16x32_bf16 v[140:143], a[124:127], v[184:187], v[140:143]
 s_add_u32 m0, m0, 16384
 v_mfma_f32_16x16x32_bf16 v[144:147], a[128:131], v[184:187], v[144:147]
 s_cmp_lt_u32 m0, s46
 s_cselect_b32 m0, m0, s47
 v_mfma_f32_16x16x32_bf16 v[148:151], a[120:123], v[188:191], v[148:151]
 ds_read_b128 v[220:223], v19 offset:14336
 v_mfma_f32_16x16x32_bf16 v[152:155], a[124:127], v[188:191], v[152:155]
 v_mfma_f32_16x16x32_bf16 v[156:159], a[128:131], v[188:191], v[156:159]
 s_waitcnt vmcnt(17) lgkmcnt(4)
 s_barrier
 v_mfma_f32_16x16x32_bf16 v[64:67], a[132:135], v[192:195], v[64:67]
 ds_read_b128 v[160:163], v18 offset:0
 v_mfma_f32_16x16x32_bf16 v[68:71], a[136:139], v[192:195], v[68:71]
 v_mfma_f32_16x16x32_bf16 v[72:75], a[140:143], v[192:195], v[72:75]
 v_add_u32 v19, s33, v15
 s_add_u32 s33, s33, 16384
 v_mfma_f32_16x16x32_bf16 v[76:79], a[132:135], v[196:199], v[76:79]
 ds_read_b128 v[164:167], v18 offset:2048
 v_mfma_f32_16x16x32_bf16 v[80:83], a[136:139], v[196:199], v[80:83]
 buffer_load_dwordx4 v10, s[8:11], s30 offen offset:0 lds
 v_mfma_f32_16x16x32_bf16 v[84:87], a[140:143], v[196:199], v[84:87]
 s_cmp_lt_u32 s33, 98304
 s_cselect_b32 s33, s33, 0
 v_mfma_f32_16x16x32_bf16 v[88:91], a[132:135], v[200:203], v[88:91]
 ds_read_b128 v[168:171], v18 offset:4096
 v_mfma_f32_16x16x32_bf16 v[92:95], a[136:139], v[200:203], v[92:95]
 buffer_store_dwordx4 v[236:239], v30, s[56:59], s81 offen sc1
 v_mfma_f32_16x16x32_bf16 v[96:99], a[140:143], v[200:203], v[96:99]
 v_mfma_f32_16x16x32_bf16 v[100:103], a[132:135], v[204:207], v[100:103]
 ds_read_b128 v[172:175], v18 offset:6144
 v_mfma_f32_16x16x32_bf16 v[104:107], a[136:139], v[204:207], v[104:107]
 v_mfma_f32_16x16x32_bf16 v[108:111], a[140:143], v[204:207], v[108:111]
 s_waitcnt lgkmcnt(4)
 v_mfma_f32_16x16x32_bf16 v[112:115], a[132:135], v[208:211], v[112:115]
 ds_read_b128 v[176:179], v18 offset:8192
 v_mfma_f32_16x16x32_bf16 v[116:119], a[136:139], v[208:211], v[116:119]
 s_mov_b64 exec, 0xffffffff
 buffer_store_dwordx4 v[240:243], v30, s[56:59], s81 offen offset:1024 sc1
 s_mov_b64 exec, -1
 v_mfma_f32_16x16x32_bf16 v[120:123], a[140:143], v[208:211], v[120:123]
 v_mfma_f32_16x16x32_bf16 v[124:127], a[132:135], v[212:215], v[124:127]
 ds_read_b128 v[180:183], v18 offset:10240
 v_mfma_f32_16x16x32_bf16 v[128:131], a[136:139], v[212:215], v[128:131]
 buffer_load_dwordx4 v11, s[8:11], s30 offen offset:1024 lds
 v_mfma_f32_16x16x32_bf16 v[132:135], a[140:143], v[212:215], v[132:135]
 v_mfma_f32_16x16x32_bf16 v[136:139], a[132:135], v[216:219], v[136:139]
 ds_read_b128 v[184:187], v18 offset:12288
 v_mfma_f32_16x16x32_bf16 v[140:143], a[136:139], v[216:219], v[140:143]
 buffer_store_dwordx2 v[244:245], v32, s[56:59], s81 offen offset:2048 sc1
 v_mfma_f32_16x16x32_bf16 v[144:147], a[140:143], v[216:219], v[144:147]
 s_mov_b32 s78, s82
 s_mov_b32 s82, 0
 v_mfma_f32_16x16x32_bf16 v[148:151], a[132:135], v[220:223], v[148:151]
 ds_read_b128 v[188:191], v18 offset:14336
 s_mov_b32 s81, 0x80000000
 v_mfma_f32_16x16x32_bf16 v[152:155], a[136:139], v[220:223], v[152:155]
 v_mfma_f32_16x16x32_bf16 v[156:159], a[140:143], v[220:223], v[156:159]
 s_waitcnt lgkmcnt(4)
 s_add_u32 s21, s50, 0
 v_mfma_f32_16x16x32_bf16 v[64:67], a[144:147], v[160:163], v[64:67]
 ds_read_b128 v[192:195], v19 offset:0
 v_mfma_f32_16x16x32_bf16 v[68:71], a[148:151], v[160:163], v[68:71]
 v_add_u32 v18, s33, v14
 v_mfma_f32_16x16x32_bf16 v[72:75], a[152:155], v[160:163], v[72:75]
 buffer_load_dwordx4 v[36:39], v30, s[16:19], s21 offen offset:0 sc1
 v_mfma_f32_16x16x32_bf16 v[76:79], a[144:147], v[164:167], v[76:79]
 ds_read_b128 v[196:199], v19 offset:2048
 v_mfma_f32_16x16x32_bf16 v[80:83], a[148:151], v[164:167], v[80:83]
 buffer_load_dwordx4 v12, s[8:11], s30 offen offset:2048 lds
 v_mfma_f32_16x16x32_bf16 v[84:87], a[152:155], v[164:167], v[84:87]
 v_mfma_f32_16x16x32_bf16 v[88:91], a[144:147], v[168:171], v[88:91]
 ds_read_b128 v[200:203], v19 offset:4096
 v_mfma_f32_16x16x32_bf16 v[92:95], a[148:151], v[168:171], v[92:95]
 v_mfma_f32_16x16x32_bf16 v[96:99], a[152:155], v[168:171], v[96:99]
 v_mfma_f32_16x16x32_bf16 v[100:103], a[144:147], v[172:175], v[100:103]
 ds_read_b128 v[204:207], v19 offset:6144
 v_mfma_f32_16x16x32_bf16 v[104:107], a[148:151], v[172:175], v[104:107]
 v_mfma_f32_16x16x32_bf16 v[108:111], a[152:155], v[172:175], v[108:111]
 s_waitcnt lgkmcnt(4)
 v_mfma_f32_16x16x32_bf16 v[112:115], a[144:147], v[176:179], v[112:115]
 ds_read_b128 v[208:211], v19 offset:8192
 s_add_u32 s21, s50, 0
 v_mfma_f32_16x16x32_bf16 v[116:119], a[148:151], v[176:179], v[116:119]
 buffer_load_dwordx4 v[40:43], v30, s[16:19], s21 offen offset:1024 sc1
 v_mfma_f32_16x16x32_bf16 v[120:123], a[152:155], v[176:179], v[120:123]
 v_mfma_f32_16x16x32_bf16 v[124:127], a[144:147], v[180:183], v[124:127]
 ds_read_b128 v[212:215], v19 offset:10240
 v_mfma_f32_16x16x32_bf16 v[128:131], a[148:151], v[180:183], v[128:131]
 buffer_load_dwordx4 v13, s[8:11], s30 offen offset:3072 lds
 v_mfma_f32_16x16x32_bf16 v[132:135], a[152:155], v[180:183], v[132:135]
 s_add_u32 s30, s30, 128
 s_add_u32 m0, m0, 16384
 v_mfma_f32_16x16x32_bf16 v[136:139], a[144:147], v[184:187], v[136:139]
 ds_read_b128 v[216:219], v19 offset:12288
 v_mfma_f32_16x16x32_bf16 v[140:143], a[148:151], v[184:187], v[140:143]
 s_cmp_lt_u32 m0, s46
 s_cselect_b32 m0, m0, s47
 v_mfma_f32_16x16x32_bf16 v[144:147], a[152:155], v[184:187], v[144:147]
 v_mfma_f32_16x16x32_bf16 v[148:151], a[144:147], v[188:191], v[148:151]
 ds_read_b128 v[220:223], v19 offset:14336
 v_mfma_f32_16x16x32_bf16 v[152:155], a[148:151], v[188:191], v[152:155]
 v_mfma_f32_16x16x32_bf16 v[156:159], a[152:155], v[188:191], v[156:159]
 s_waitcnt vmcnt(20) lgkmcnt(4)
 s_barrier
 v_mfma_f32_16x16x32_bf16 v[64:67], a[156:159], v[192:195], v[64:67]
 ds_read_b128 v[160:163], v18 offset:0
 s_add_u32 s21, s50, 0
 v_mfma_f32_16x16x32_bf16 v[68:71], a[160:163], v[192:195], v[68:71]
 buffer_load_dwordx4 v[44:47], v30, s[16:19], s21 offen offset:2048 sc1
 v_mfma_f32_16x16x32_bf16 v[72:75], a[164:167], v[192:195], v[72:75]
 v_add_u32 v19, s33, v15
 s_add_u32 s33, s33, 16384
 v_mfma_f32_16x16x32_bf16 v[76:79], a[156:159], v[196:199], v[76:79]
 ds_read_b128 v[164:167], v18 offset:2048
 v_mfma_f32_16x16x32_bf16 v[80:83], a[160:163], v[196:199], v[80:83]
 buffer_load_dwordx4 v10, s[8:11], s30 offen offset:0 lds
 v_mfma_f32_16x16x32_bf16 v[84:87], a[164:167], v[196:199], v[84:87]
 s_cmp_lt_u32 s33, 98304
 s_cselect_b32 s33, s33, 0
 v_mfma_f32_16x16x32_bf16 v[88:91], a[156:159], v[200:203], v[88:91]
 ds_read_b128 v[168:171], v18 offset:4096
 v_mfma_f32_16x16x32_bf16 v[92:95], a[160:163], v[200:203], v[92:95]
 v_mfma_f32_16x16x32_bf16 v[96:99], a[164:167], v[200:203], v[96:99]
 v_mfma_f32_16x16x32_bf16 v[100:103], a[156:159], v[204:207], v[100:103]
 ds_read_b128 v[172:175], v18 offset:6144
 v_mfma_f32_16x16x32_bf16 v[104:107], a[160:163], v[204:207], v[104:107]
 v_mfma_f32_16x16x32_bf16 v[108:111], a[164:167], v[204:207], v[108:111]
 s_waitcnt lgkmcnt(4)
 s_add_u32 s21, s50, 0
 v_mfma_f32_16x16x32_bf16 v[112:115], a[156:159], v[208:211], v[112:115]
 ds_read_b128 v[176:179], v18 offset:8192
 v_mfma_f32_16x16x32_bf16 v[116:119], a[160:163], v[208:211], v[116:119]
 buffer_load_dwordx4 v[48:51], v30, s[16:19], s21 offen offset:3072 sc1
 v_mfma_f32_16x16x32_bf16 v[120:123], a[164:167], v[208:211], v[120:123]
 v_mfma_f32_16x16x32_bf16 v[124:127], a[156:159], v[212:215], v[124:127]
 ds_read_b128 v[180:183], v18 offset:10240
 v_mfma_f32_16x16x32_bf16 v[128:131], a[160:163], v[212:215], v[128:131]
 buffer_load_dwordx4 v11, s[8:11], s30 offen offset:1024 lds
 v_mfma_f32_16x16x32_bf16 v[132:135], a[164:167], v[212:215], v[132:135]
 v_mfma_f32_16x16x32_bf16 v[136:139], a[156:159], v[216:219], v[136:139]
 ds_read_b128 v[184:187], v18 offset:12288
 v_mfma_f32_16x16x32_bf16 v[140:143], a[160:163], v[216:219], v[140:143]
 v_mfma_f32_16x16x32_bf16 v[144:147], a[164:167], v[216:219], v[144:147]
 v_mfma_f32_16x16x32_bf16 v[148:151], a[156:159], v[220:223], v[148:151]
 ds_read_b128 v[188:191], v18 offset:14336
 v_mfma_f32_16x16x32_bf16 v[152:155], a[160:163], v[220:223], v[152:155]
 v_mfma_f32_16x16x32_bf16 v[156:159], a[164:167], v[220:223], v[156:159]
 s_waitcnt lgkmcnt(4)
 s_add_u32 s21, s50, 4096
 v_mfma_f32_16x16x32_bf16 v[64:67], a[168:171], v[160:163], v[64:67]
 ds_read_b128 v[192:195], v19 offset:0
 v_mfma_f32_16x16x32_bf16 v[68:71], a[172:175], v[160:163], v[68:71]
 v_add_u32 v18, s33, v14
 v_mfma_f32_16x16x32_bf16 v[72:75], a[176:179], v[160:163], v[72:75]
 buffer_load_dwordx4 v[52:55], v30, s[16:19], s21 offen offset:0 sc1
 v_mfma_f32_16x16x32_bf16 v[76:79], a[168:171], v[164:167], v[76:79]
 ds_read_b128 v[196:199], v19 offset:2048
 v_mfma_f32_16x16x32_bf16 v[80:83], a[172:175], v[164:167], v[80:83]
 buffer_load_dwordx4 v12, s[8:11], s30 offen offset:2048 lds
 v_mfma_f32_16x16x32_bf16 v[84:87], a[176:179], v[164:167], v[84:87]
 v_mfma_f32_16x16x32_bf16 v[88:91], a[168:171], v[168:171], v[88:91]
 ds_read_b128 v[200:203], v19 offset:4096
 v_mfma_f32_16x16x32_bf16 v[92:95], a[172:175], v[168:171], v[92:95]
 v_mfma_f32_16x16x32_bf16 v[96:99], a[176:179], v[168:171], v[96:99]
 v_mfma_f32_16x16x32_bf16 v[100:103], a[168:171], v[172:175], v[100:103]
 ds_read_b128 v[204:207], v19 offset:6144
 v_mfma_f32_16x16x32_bf16 v[104:107], a[172:175], v[172:175], v[104:107]
 v_mfma_f32_16x16x32_bf16 v[108:111], a[176:179], v[172:175], v[108:111]
 s_waitcnt lgkmcnt(4)
 v_mfma_f32_16x16x32_bf16 v[112:115], a[168:171], v[176:179], v[112:115]
 ds_read_b128 v[208:211], v19 offset:8192
 s_add_u32 s21, s50, 4096
 v_mfma_f32_16x16x32_bf16 v[116:119], a[172:175], v[176:179], v[116:119]
 buffer_load_dwordx4 v[56:59], v30, s[16:19], s21 offen offset:1024 sc1
 v_mfma_f32_16x16x32_bf16 v[120:123], a[176:179], v[176:179], v[120:123]
 v_mfma_f32_16x16x32_bf16 v[124:127], a[168:171], v[180:183], v[124:127]
 ds_read_b128 v[212:215], v19 offset:10240
 v_mfma_f32_16x16x32_bf16 v[128:131], a[172:175], v[180:183], v[128:131]
 buffer_load_dwordx4 v13, s[8:11], s30 offen offset:3072 lds
 v_mfma_f32_16x16x32_bf16 v[132:135], a[176:179], v[180:183], v[132:135]
 s_add_u32 s30, s30, 128
 s_add_u32 m0, m0, 16384
 v_mfma_f32_16x16x32_bf16 v[136:139], a[168:171], v[184:187], v[136:139]
 ds_read_b128 v[216:219], v19 offset:12288
 v_mfma_f32_16x16x32_bf16 v[140:143], a[172:175], v[184:187], v[140:143]
 s_cmp_lt_u32 m0, s46
 s_cselect_b32 m0, m0, s47
 v_mfma_f32_16x16x32_bf16 v[144:147], a[176:179], v[184:187], v[144:147]
 v_mfma_f32_16x16x32_bf16 v[148:151], a[168:171], v[188:191], v[148:151]
 ds_read_b128 v[220:223], v19 offset:14336
 v_mfma_f32_16x16x32_bf16 v[152:155], a[172:175], v[188:191], v[152:155]
 v_mfma_f32_16x16x32_bf16 v[156:159], a[176:179], v[188:191], v[156:159]
 s_waitcnt vmcnt(22) lgkmcnt(4)
 s_barrier
 v_mfma_f32_16x16x32_bf16 v[64:67], a[180:183], v[192:195], v[64:67]
 ds_read_b128 v[160:163], v18 offset:0
 s_add_u32 s21, s50, 4096
 v_mfma_f32_16x16x32_bf16 v[68:71], a[184:187], v[192:195], v[68:71]
 buffer_load_dwordx4 v[236:239], v30, s[16:19], s21 offen offset:3072 sc1
 v_mfma_f32_16x16x32_bf16 v[72:75], a[188:191], v[192:195], v[72:75]
 v_add_u32 v19, s33, v15
 s_add_u32 s33, s33, 16384
 v_mfma_f32_16x16x32_bf16 v[76:79], a[180:183], v[196:199], v[76:79]
 ds_read_b128 v[164:167], v18 offset:2048
 v_mfma_f32_16x16x32_bf16 v[80:83], a[184:187], v[196:199], v[80:83]
 buffer_load_dwordx4 v10, s[8:11], s30 offen offset:0 lds
 v_mfma_f32_16x16x32_bf16 v[84:87], a[188:191], v[196:199], v[84:87]
 s_cmp_lt_u32 s33, 98304
 s_cselect_b32 s33, s33, 0
 v_mfma_f32_16x16x32_bf16 v[88:91], a[180:183], v[200:203], v[88:91]
 ds_read_b128 v[168:171], v18 offset:4096
 v_mfma_f32_16x16x32_bf16 v[92:95], a[184:187], v[200:203], v[92:95]
 v_mfma_f32_16x16x32_bf16 v[96:99], a[188:191], v[200:203], v[96:99]
 v_mfma_f32_16x16x32_bf16 v[100:103], a[180:183], v[204:207], v[100:103]
 ds_read_b128 v[172:175], v18 offset:6144
 v_mfma_f32_16x16x32_bf16 v[104:107], a[184:187], v[204:207], v[104:107]
 v_mfma_f32_16x16x32_bf16 v[108:111], a[188:191], v[204:207], v[108:111]
 s_waitcnt lgkmcnt(4)
 s_add_u32 s21, s50, 8192
 v_mfma_f32_16x16x32_bf16 v[112:115], a[180:183], v[208:211], v[112:115]
 ds_read_b128 v[176:179], v18 offset:8192
 v_mfma_f32_16x16x32_bf16 v[116:119], a[184:187], v[208:211], v[116:119]
 buffer_load_dwordx4 v[240:243], v30, s[16:19], s21 offen offset:0 sc1
 v_mfma_f32_16x16x32_bf16 v[120:123], a[188:191], v[208:211], v[120:123]
 v_mfma_f32_16x16x32_bf16 v[124:127], a[180:183], v[212:215], v[124:127]
 ds_read_b128 v[180:183], v18 offset:10240
 v_mfma_f32_16x16x32_bf16 v[128:131], a[184:187], v[212:215], v[128:131]
 buffer_load_dwordx4 v11, s[8:11], s30 offen offset:1024 lds
 v_mfma_f32_16x16x32_bf16 v[132:135], a[188:191], v[212:215], v[132:135]
 v_mfma_f32_16x16x32_bf16 v[136:139], a[180:183], v[216:219], v[136:139]
 ds_read_b128 v[184:187], v18 offset:12288
 v_mfma_f32_16x16x32_bf16 v[140:143], a[184:187], v[216:219], v[140:143]
 v_mfma_f32_16x16x32_bf16 v[144:147], a[188:191], v[216:219], v[144:147]
 v_mfma_f32_16x16x32_bf16 v[148:151], a[180:183], v[220:223], v[148:151]
 ds_read_b128 v[188:191], v18 offset:14336
 v_mfma_f32_16x16x32_bf16 v[152:155], a[184:187], v[220:223], v[152:155]
 v_mfma_f32_16x16x32_bf16 v[156:159], a[188:191], v[220:223], v[156:159]
 s_waitcnt lgkmcnt(4)
 s_add_u32 s21, s50, 8192
 v_mfma_f32_16x16x32_bf16 v[64:67], a[192:195], v[160:163], v[64:67]
 ds_read_b128 v[192:195], v19 offset:0
 v_mfma_f32_16x16x32_bf16 v[68:71], a[196:199], v[160:163], v[68:71]
 v_add_u32 v18, s33, v14
 v_mfma_f32_16x16x32_bf16 v[72:75], a[200:203], v[160:163], v[72:75]
 buffer_load_dwordx4 v[244:247], v30, s[16:19], s21 offen offset:1024 sc1
 v_mfma_f32_16x16x32_bf16 v[76:79], a[192:195], v[164:167], v[76:79]
 ds_read_b128 v[196:199], v19 offset:2048
 v_mfma_f32_16x16x32_bf16 v[80:83], a[196:199], v[164:167], v[80:83]
 buffer_load_dwordx4 v12, s[8:11], s30 offen offset:2048 lds
 v_mfma_f32_16x16x32_bf16 v[84:87], a[200:203], v[164:167], v[84:87]
 v_mfma_f32_16x16x32_bf16 v[88:91], a[192:195], v[168:171], v[88:91]
 ds_read_b128 v[200:203], v19 offset:4096
 v_mfma_f32_16x16x32_bf16 v[92:95], a[196:199], v[168:171], v[92:95]
 v_mfma_f32_16x16x32_bf16 v[96:99], a[200:203], v[168:171], v[96:99]
 v_mfma_f32_16x16x32_bf16 v[100:103], a[192:195], v[172:175], v[100:103]
 ds_read_b128 v[204:207], v19 offset:6144
 v_mfma_f32_16x16x32_bf16 v[104:107], a[196:199], v[172:175], v[104:107]
 v_mfma_f32_16x16x32_bf16 v[108:111], a[200:203], v[172:175], v[108:111]
 s_waitcnt lgkmcnt(4)
 v_mfma_f32_16x16x32_bf16 v[112:115], a[192:195], v[176:179], v[112:115]
 ds_read_b128 v[208:211], v19 offset:8192
 v_mfma_f32_16x16x32_bf16 v[116:119], a[196:199], v[176:179], v[116:119]
 v_mfma_f32_16x16x32_bf16 v[120:123], a[200:203], v[176:179], v[120:123]
 v_mfma_f32_16x16x32_bf16 v[124:127], a[192:195], v[180:183], v[124:127]
 ds_read_b128 v[212:215], v19 offset:10240
 v_mfma_f32_16x16x32_bf16 v[128:131], a[196:199], v[180:183], v[128:131]
 buffer_load_dwordx4 v13, s[8:11], s30 offen offset:3072 lds
 v_mfma_f32_16x16x32_bf16 v[132:135], a[200:203], v[180:183], v[132:135]
 s_add_u32 s30, s30, 128
 s_add_u32 m0, m0, 16384
 v_mfma_f32_16x16x32_bf16 v[136:139], a[192:195], v[184:187], v[136:139]
 ds_read_b128 v[216:219], v19 offset:12288
 v_mfma_f32_16x16x32_bf16 v[140:143], a[196:199], v[184:187], v[140:143]
 s_cmp_lt_u32 m0, s46
 s_cselect_b32 m0, m0, s47
 v_mfma_f32_16x16x32_bf16 v[144:147], a[200:203], v[184:187], v[144:147]
 v_mfma_f32_16x16x32_bf16 v[148:151], a[192:195], v[188:191], v[148:151]
 ds_read_b128 v[220:223], v19 offset:14336
 v_mfma_f32_16x16x32_bf16 v[152:155], a[196:199], v[188:191], v[152:155]
 v_mfma_f32_16x16x32_bf16 v[156:159], a[200:203], v[188:191], v[156:159]
 s_waitcnt vmcnt(24) lgkmcnt(4)
 s_barrier
 v_mfma_f32_16x16x32_bf16 v[64:67], a[204:207], v[192:195], v[64:67]
 ds_read_b128 v[160:163], v18 offset:0
 v_mfma_f32_16x16x32_bf16 v[68:71], a[208:211], v[192:195], v[68:71]
 v_mfma_f32_16x16x32_bf16 v[72:75], a[212:215], v[192:195], v[72:75]
 v_add_u32 v19, s33, v15
 s_add_u32 s33, s33, 16384
 v_mfma_f32_16x16x32_bf16 v[76:79], a[204:207], v[196:199], v[76:79]
 ds_read_b128 v[164:167], v18 offset:2048
 v_mfma_f32_16x16x32_bf16 v[80:83], a[208:211], v[196:199], v[80:83]
 buffer_load_dwordx4 v10, s[8:11], s30 offen offset:0 lds
 v_mfma_f32_16x16x32_bf16 v[84:87], a[212:215], v[196:199], v[84:87]
 s_cmp_lt_u32 s33, 98304
 s_cselect_b32 s33, s33, 0
 v_mfma_f32_16x16x32_bf16 v[88:91], a[204:207], v[200:203], v[88:91]
 ds_read_b128 v[168:171], v18 offset:4096
 v_mfma_f32_16x16x32_bf16 v[92:95], a[208:211], v[200:203], v[92:95]
 v_mfma_f32_16x16x32_bf16 v[96:99], a[212:215], v[200:203], v[96:99]
 v_mfma_f32_16x16x32_bf16 v[100:103], a[204:207], v[204:207], v[100:103]
 ds_read_b128 v[172:175], v18 offset:6144
 v_mfma_f32_16x16x32_bf16 v[104:107], a[208:211], v[204:207], v[104:107]
 v_mfma_f32_16x16x32_bf16 v[108:111], a[212:215], v[204:207], v[108:111]
 s_waitcnt lgkmcnt(4)
 v_mfma_f32_16x16x32_bf16 v[112:115], a[204:207], v[208:211], v[112:115]
 ds_read_b128 v[176:179], v18 offset:8192
 v_mfma_f32_16x16x32_bf16 v[116:119], a[208:211], v[208:211], v[116:119]
 v_mfma_f32_16x16x32_bf16 v[120:123], a[212:215], v[208:211], v[120:123]
 v_mfma_f32_16x16x32_bf16 v[124:127], a[204:207], v[212:215], v[124:127]
 ds_read_b128 v[180:183], v18 offset:10240
 v_mfma_f32_16x16x32_bf16 v[128:131], a[208:211], v[212:215], v[128:131]
 buffer_load_dwordx4 v11, s[8:11], s30 offen offset:1024 lds
 v_mfma_f32_16x16x32_bf16 v[132:135], a[212:215], v[212:215], v[132:135]
 v_mfma_f32_16x16x32_bf16 v[136:139], a[204:207], v[216:219], v[136:139]
 ds_read_b128 v[184:187], v18 offset:12288
 v_mfma_f32_16x16x32_bf16 v[140:143], a[208:211], v[216:219], v[140:143]
 v_mfma_f32_16x16x32_bf16 v[144:147], a[212:215], v[216:219], v[144:147]
 v_mfma_f32_16x16x32_bf16 v[148:151], a[204:207], v[220:223], v[148:151]
 ds_read_b128 v[188:191], v18 offset:14336
 v_mfma_f32_16x16x32_bf16 v[152:155], a[208:211], v[220:223], v[152:155]
 v_mfma_f32_16x16x32_bf16 v[156:159], a[212:215], v[220:223], v[156:159]
 s_waitcnt lgkmcnt(4)
 v_mfma_f32_16x16x32_bf16 v[64:67], a[216:219], v[160:163], v[64:67]
 ds_read_b128 v[192:195], v19 offset:0
 v_mfma_f32_16x16x32_bf16 v[68:71], a[220:223], v[160:163], v[68:71]
 v_add_u32 v18, s33, v14
 v_mfma_f32_16x16x32_bf16 v[72:75], a[224:227], v[160:163], v[72:75]
 v_mfma_f32_16x16x32_bf16 v[76:79], a[216:219], v[164:167], v[76:79]
 ds_read_b128 v[196:199], v19 offset:2048
 v_mfma_f32_16x16x32_bf16 v[80:83], a[220:223], v[164:167], v[80:83]
 buffer_load_dwordx4 v12, s[8:11], s30 offen offset:2048 lds
 v_mfma_f32_16x16x32_bf16 v[84:87], a[224:227], v[164:167], v[84:87]
 v_mfma_f32_16x16x32_bf16 v[88:91], a[216:219], v[168:171], v[88:91]
 ds_read_b128 v[200:203], v19 offset:4096
 v_mfma_f32_16x16x32_bf16 v[92:95], a[220:223], v[168:171], v[92:95]
 v_mfma_f32_16x16x32_bf16 v[96:99], a[224:227], v[168:171], v[96:99]
 v_mfma_f32_16x16x32_bf16 v[100:103], a[216:219], v[172:175], v[100:103]
 ds_read_b128 v[204:207], v19 offset:6144
 v_mfma_f32_16x16x32_bf16 v[104:107], a[220:223], v[172:175], v[104:107]
 v_mfma_f32_16x16x32_bf16 v[108:111], a[224:227], v[172:175], v[108:111]
 s_waitcnt lgkmcnt(4)
 v_mfma_f32_16x16x32_bf16 v[112:115], a[216:219], v[176:179], v[112:115]
 ds_read_b128 v[208:211], v19 offset:8192
 v_mfma_f32_16x16x32_bf16 v[116:119], a[220:223], v[176:179], v[116:119]
 v_mfma_f32_16x16x32_bf16 v[120:123], a[224:227], v[176:179], v[120:123]
 v_mfma_f32_16x16x32_bf16 v[124:127], a[216:219], v[180:183], v[124:127]
 ds_read_b128 v[212:215], v19 offset:10240
 v_mfma_f32_16x16x32_bf16 v[128:131], a[220:223], v[180:183], v[128:131]
 buffer_load_dwordx4 v13, s[8:11], s30 offen offset:3072 lds
 v_mfma_f32_16x16x32_bf16 v[132:135], a[224:227], v[180:183], v[132:135]
 s_add_u32 s30, s30, 128
 s_add_u32 m0, m0, 16384
 v_mfma_f32_16x16x32_bf16 v[136:139], a[216:219], v[184:187], v[136:139]
 ds_read_b128 v[216:219], v19 offset:12288
 v_mfma_f32_16x16x32_bf16 v[140:143], a[220:223], v[184:187], v[140:143]
 s_cmp_lt_u32 m0, s46
 s_cselect_b32 m0, m0, s47
 v_mfma_f32_16x16x32_bf16 v[144:147], a[224:227], v[184:187], v[144:147]
 v_mfma_f32_16x16x32_bf16 v[148:151], a[216:219], v[188:191], v[148:151]
 ds_read_b128 v[220:223], v19 offset:14336
 v_mfma_f32_16x16x32_bf16 v[152:155], a[220:223], v[188:191], v[152:155]
 v_mfma_f32_16x16x32_bf16 v[156:159], a[224:227], v[188:191], v[156:159]
 s_waitcnt vmcnt(19) lgkmcnt(4)
 s_barrier
 v_mfma_f32_16x16x32_bf16 v[64:67], a[228:231], v[192:195], v[64:67]
 ds_read_b128 v[160:163], v18 offset:0
 v_mfma_f32_16x16x32_bf16 v[68:71], a[232:235], v[192:195], v[68:71]
 s_waitcnt vmcnt(22)
 s_cmp_eq_u32 s78, 0
 s_cbranch_scc1 pf_193
 v_mov_b32 v4, 0
 v_mov_b32 v5, 1
 s_mov_b64 exec, 1
 buffer_atomic_add v5, v4, s[72:75], s78 offen sc1
 s_mov_b64 exec, -1
 s_mov_b32 s78, 0
pf_193:
 buffer_load_dword v21, v33, s[72:75], s77 offen sc1
 v_mfma_f32_16x16x32_bf16 v[72:75], a[236:239], v[192:195], v[72:75]
 v_add_u32 v19, s33, v15
 s_add_u32 s33, s33, 16384
 v_mfma_f32_16x16x32_bf16 v[76:79], a[228:231], v[196:199], v[76:79]
 ds_read_b128 v[164:167], v18 offset:2048
 v_cvt_pk_bf16_f32 v224, v64, v65
 v_cvt_pk_bf16_f32 v225, v66, v67
 v_mfma_f32_16x16x32_bf16 v[80:83], a[232:235], v[196:199], v[80:83]
 buffer_load_dwordx4 v10, s[8:11], s30 offen offset:0 lds
 v_cvt_pk_bf16_f32 v226, v68, v69
 v_cvt_pk_bf16_f32 v227, v70, v71
 v_mfma_f32_16x16x32_bf16 v[84:87], a[236:239], v[196:199], v[84:87]
 s_cmp_lt_u32 s33, 98304
 s_cselect_b32 s33, s33, 0
 v_cvt_pk_bf16_f32 v228, v72, v73
 v_cvt_pk_bf16_f32 v229, v74, v75
 v_mfma_f32_16x16x32_bf16 v[88:91], a[228:231], v[200:203], v[88:91]
 ds_read_b128 v[168:171], v18 offset:4096
 ds_write_b64 v22, v[224:225] offset:0
 v_mfma_f32_16x16x32_bf16 v[92:95], a[232:235], v[200:203], v[92:95]
 ds_write_b64 v22, v[226:227] offset:8
 ds_write_b64 v16, v[228:229] offset:64
 v_mfma_f32_16x16x32_bf16 v[96:99], a[236:239], v[200:203], v[96:99]
 v_cvt_pk_bf16_f32 v230, v76, v77
 v_cvt_pk_bf16_f32 v231, v78, v79
 v_cvt_pk_bf16_f32 v232, v80, v81
 v_cvt_pk_bf16_f32 v233, v82, v83
 v_mfma_f32_16x16x32_bf16 v[100:103], a[228:231], v[204:207], v[100:103]
 ds_read_b128 v[172:175], v18 offset:6144
 v_cvt_pk_bf16_f32 v234, v84, v85
 v_cvt_pk_bf16_f32 v235, v86, v87
 v_mfma_f32_16x16x32_bf16 v[104:107], a[232:235], v[204:207], v[104:107]
 ds_write_b64 v22, v[230:231] offset:6400
 ds_write_b64 v22, v[232:233] offset:6408
 v_mfma_f32_16x16x32_bf16 v[108:111], a[236:239], v[204:207], v[108:111]
 s_waitcnt lgkmcnt(9)
 ds_write_b64 v16, v[234:235] offset:6464
 v_cvt_pk_bf16_f32 v224, v88, v89
 v_mfma_f32_16x16x32_bf16 v[112:115], a[228:231], v[208:211], v[112:115]
 ds_read_b128 v[176:179], v18 offset:8192
 v_cvt_pk_bf16_f32 v225, v90, v91
 v_cvt_pk_bf16_f32 v226, v92, v93
 v_cvt_pk_bf16_f32 v227, v94, v95
 v_mfma_f32_16x16x32_bf16 v[116:119], a[232:235], v[208:211], v[116:119]
 v_cvt_pk_bf16_f32 v228, v96, v97
 v_cvt_pk_bf16_f32 v229, v98, v99
 ds_write_b64 v22, v[224:225] offset:12800
 v_mfma_f32_16x16x32_bf16 v[120:123], a[236:239], v[208:211], v[120:123]
 ds_write_b64 v22, v[226:227] offset:12808
 ds_write_b64 v16, v[228:229] offset:12864
 v_mfma_f32_16x16x32_bf16 v[124:127], a[228:231], v[212:215], v[124:127]
 ds_read_b128 v[180:183], v18 offset:10240
 v_cvt_pk_bf16_f32 v230, v100, v101
 v_cvt_pk_bf16_f32 v231, v102, v103
 v_cvt_pk_bf16_f32 v232, v104, v105
 v_mfma_f32_16x16x32_bf16 v[128:131], a[232:235], v[212:215], v[128:131]
 buffer_load_dwordx4 v11, s[8:11], s30 offen offset:1024 lds
 v_cvt_pk_bf16_f32 v233, v106, v107
 v_cvt_pk_bf16_f32 v234, v108, v109
 v_mfma_f32_16x16x32_bf16 v[132:135], a[236:239], v[212:215], v[132:135]
 v_cvt_pk_bf16_f32 v235, v110, v111
 ds_write_b64 v22, v[230:231] offset:19200
 v_mfma_f32_16x16x32_bf16 v[136:139], a[228:231], v[216:219], v[136:139]
 ds_read_b128 v[184:187], v18 offset:12288
 ds_write_b64 v22, v[232:233] offset:19208
 v_mfma_f32_16x16x32_bf16 v[140:143], a[232:235], v[216:219], v[140:143]
 ds_write_b64 v16, v[234:235] offset:19264
 v_cvt_pk_bf16_f32 v224, v112, v113
 v_cvt_pk_bf16_f32 v225, v114, v115
 v_mfma_f32_16x16x32_bf16 v[144:147], a[236:239], v[216:219], v[144:147]
 v_cvt_pk_bf16_f32 v226, v116, v117
 v_cvt_pk_bf16_f32 v227, v118, v119
 v_cvt_pk_bf16_f32 v228, v120, v121
 v_cvt_pk_bf16_f32 v229, v122, v123
 v_mfma_f32_16x16x32_bf16 v[148:151], a[228:231], v[220:223], v[148:151]
 ds_read_b128 v[188:191], v18 offset:14336
 ds_write_b64 v22, v[224:225] offset:25600
 v_mfma_f32_16x16x32_bf16 v[152:155], a[232:235], v[220:223], v[152:155]
 ds_write_b64 v22, v[226:227] offset:25608
 ds_write_b64 v16, v[228:229] offset:25664
 v_mfma_f32_16x16x32_bf16 v[156:159], a[236:239], v[220:223], v[156:159]
 v_cvt_pk_bf16_f32 v230, v124, v125
 v_cvt_pk_bf16_f32 v231, v126, v127
 v_cvt_pk_bf16_f32 v232, v128, v129
 v_cvt_pk_bf16_f32 v233, v130, v131
qa_end_195:
 v_cvt_pk_bf16_f32 v234, v132, v133
 v_cvt_pk_bf16_f32 v235, v134, v135
 ds_write_b64 v22, v[230:231] offset:32000
 ds_write_b64 v22, v[232:233] offset:32008
 ds_write_b64 v16, v[234:235] offset:32064
 v_cvt_pk_bf16_f32 v224, v136, v137
 v_cvt_pk_bf16_f32 v225, v138, v139
 v_cvt_pk_bf16_f32 v226, v140, v141
 v_cvt_pk_bf16_f32 v227, v142, v143
 v_cvt_pk_bf16_f32 v228, v144, v145
 v_cvt_pk_bf16_f32 v229, v146, v147
 ds_write_b64 v22, v[224:225] offset:38400
 ds_write_b64 v22, v[226:227] offset:38408
 ds_write_b64 v16, v[228:229] offset:38464
 v_cvt_pk_bf16_f32 v230, v148, v149
 v_cvt_pk_bf16_f32 v231, v150, v151
 v_cvt_pk_bf16_f32 v232, v152, v153
 v_cvt_pk_bf16_f32 v233, v154, v155
 v_cvt_pk_bf16_f32 v234, v156, v157
 v_cvt_pk_bf16_f32 v235, v158, v159
 ds_write_b64 v22, v[230:231] offset:44800
 ds_write_b64 v22, v[232:233] offset:44808
 ds_write_b64 v16, v[234:235] offset:44864
 s_cmp_eq_u32 s80, 1
 s_cselect_b32 s21, s79, 0
 s_cmp_ge_u32 s21, 8
 s_cbranch_scc0 qx_198
 s_waitcnt lgkmcnt(0) vmcnt(5)
 s_barrier
 ds_read_b128 v[64:67], v29 offset:0
 ds_read_b128 v[88:91], v29 offset:6400
 ds_read_b128 v[68:71], v29 offset:64
 ds_read_b128 v[92:95], v29 offset:6464
 ds_read_b128 v[72:75], v29 offset:128
 ds_read_b128 v[96:99], v29 offset:6528
 ds_read_b128 v[76:79], v29 offset:192
 ds_read_b128 v[100:103], v29 offset:6592
 ds_read_b128 v[80:83], v29 offset:256
 ds_read_b128 v[104:107], v29 offset:6656
 ds_read_b128 v[84:87], v29 offset:320
 ds_read_b128 v[108:111], v29 offset:6720
 s_waitcnt lgkmcnt(10)
 v_mfma_f32_16x16x32_bf16 v[112:115], v[36:39], v[64:67], 0
 v_mfma_f32_16x16x32_bf16 v[116:119], a[240:243], v[64:67], 0
 v_mfma_f32_16x16x32_bf16 v[120:123], v[36:39], v[88:91], 0
 v_mfma_f32_16x16x32_bf16 v[124:127], v[60:63], v[88:91], 0
 v_mfma_f32_16x16x32_bf16 v[128:131], a[240:243], v[88:91], 0
 s_waitcnt lgkmcnt(8)
 v_mfma_f32_16x16x32_bf16 v[112:115], v[40:43], v[68:71], v[112:115]
 v_mfma_f32_16x16x32_bf16 v[116:119], a[244:247], v[68:71], v[116:119]
 v_mfma_f32_16x16x32_bf16 v[120:123], v[40:43], v[92:95], v[120:123]
 v_mfma_f32_16x16x32_bf16 v[124:127], v[236:239], v[92:95], v[124:127]
 v_mfma_f32_16x16x32_bf16 v[128:131], a[244:247], v[92:95], v[128:131]
 s_waitcnt lgkmcnt(6)
 v_mfma_f32_16x16x32_bf16 v[112:115], v[44:47], v[72:75], v[112:115]
 v_mfma_f32_16x16x32_bf16 v[116:119], a[248:251], v[72:75], v[116:119]
 v_mfma_f32_16x16x32_bf16 v[120:123], v[44:47], v[96:99], v[120:123]
 v_mfma_f32_16x16x32_bf16 v[124:127], v[240:243], v[96:99], v[124:127]
 v_mfma_f32_16x16x32_bf16 v[128:131], a[248:251], v[96:99], v[128:131]
 s_waitcnt lgkmcnt(4)
 v_mfma_f32_16x16x32_bf16 v[112:115], v[48:51], v[76:79], v[112:115]
 v_mfma_f32_16x16x32_bf16 v[116:119], a[252:255], v[76:79], v[116:119]
 v_mfma_f32_16x16x32_bf16 v[120:123], v[48:51], v[100:103], v[120:123]
 v_mfma_f32_16x16x32_bf16 v[124:127], v[244:247], v[100:103], v[124:127]
 v_mfma_f32_16x16x32_bf16 v[128:131], a[252:255], v[100:103], v[128:131]
 s_waitcnt lgkmcnt(2)
 v_mfma_f32_16x16x32_bf16 v[112:115], v[52:55], v[80:83], v[112:115]
 v_mfma_f32_16x16x32_bf16 v[116:119], v[24:27], v[80:83], v[116:119]
 v_mfma_f32_16x16x32_bf16 v[120:123], v[52:55], v[104:107], v[120:123]
 v_mfma_f32_16x16x32_bf16 v[124:127], v[248:251], v[104:107], v[124:127]
 v_mfma_f32_16x16x32_bf16 v[128:131], v[24:27], v[104:107], v[128:131]
 s_waitcnt lgkmcnt(0)
 v_mfma_f32_16x16x32_bf16 v[112:115], v[56:59], v[84:87], v[112:115]
 v_mfma_f32_16x16x32_bf16 v[116:119], v[6:9], v[84:87], v[116:119]
 v_mfma_f32_16x16x32_bf16 v[120:123], v[56:59], v[108:111], v[120:123]
 v_mfma_f32_16x16x32_bf16 v[124:127], v[252:255], v[108:111], v[124:127]
 v_mfma_f32_16x16x32_bf16 v[128:131], v[6:9], v[108:111], v[128:131]
 s_branch qx_197
qx_198:
 buffer_load_dword v21, v33, s[72:75], s77 offen sc1
 s_waitcnt vmcnt(0)
 s_mul_i32 s21, s49, 393216
 s_mul_i32 s22, s42, 12288
 s_add_u32 s50, s21, s22
 s_mul_i32 s21, s49, 98304
 s_mul_i32 s22, s42, 3072
 s_add_u32 s51, s21, s22
 s_lshr_b32 s22, s49, 1
 s_lshr_b32 s21, s49, 2
 s_add_u32 s21, s21, 2
 s_cmp_lt_u32 s49, 8
 s_cselect_b32 s21, s22, s21
 s_lshl_b32 s21, s21, 3
 s_lshr_b32 s22, s42, 2
 s_add_u32 s21, s21, s22
 s_lshl_b32 s21, s21, 7
 s_add_u32 s76, s21, 0
 s_lshl_b32 s77, s42, 7
 s_add_u32 s77, s77, 18432
 s_add_u32 s23, s49, 1
 s_waitcnt vmcnt(6)
 v_cmp_gt_u32 vcc, s23, v21
 s_mov_b32 s80, 0
 s_nop 0
 s_cbranch_vccnz qk_200
 s_mov_b32 s80, 1
 buffer_load_dwordx4 a[240:243], v31, s[52:55], s51 offen offset:0 sc1
 buffer_load_dwordx4 a[244:247], v31, s[52:55], s51 offen offset:512 sc1
 buffer_load_dwordx4 a[248:251], v31, s[52:55], s51 offen offset:1024 sc1
 buffer_load_dwordx4 a[252:255], v31, s[52:55], s51 offen offset:1536 sc1
 buffer_load_dwordx4 v[24:27], v31, s[52:55], s51 offen offset:2048 sc1
 buffer_load_dwordx4 v[6:9], v31, s[52:55], s51 offen offset:2560 sc1
qk_200:
 s_cmp_ge_u32 s79, 8
 s_cbranch_scc1 qk_199
 v_mov_b32 v156, 0
 s_mov_b32 s101, 0
wf_201:
 buffer_load_dword v157, v156, s[72:75], s76 offen sc1
 s_add_u32 s101, s101, 1
 s_cmp_gt_u32 s101, 131072
 s_cbranch_scc1 main_end
 s_waitcnt vmcnt(0)
 v_readfirstlane_b32 s100, v157
 s_cmp_ge_u32 s100, 8
 s_cbranch_scc1 wf_202
 s_sleep 2
 s_branch wf_201
wf_202:
 s_add_u32 s21, s50, 0
 buffer_load_dwordx4 v[36:39], v30, s[16:19], s21 offen offset:0 sc1
 buffer_load_dwordx4 v[40:43], v30, s[16:19], s21 offen offset:1024 sc1
 buffer_load_dwordx4 v[44:47], v30, s[16:19], s21 offen offset:2048 sc1
 buffer_load_dwordx4 v[48:51], v30, s[16:19], s21 offen offset:3072 sc1
 s_add_u32 s21, s50, 4096
 buffer_load_dwordx4 v[52:55], v30, s[16:19], s21 offen offset:0 sc1
 buffer_load_dwordx4 v[56:59], v30, s[16:19], s21 offen offset:1024 sc1
 buffer_load_dwordx4 v[60:63], v30, s[16:19], s21 offen offset:2048 sc1
 buffer_load_dwordx4 v[236:239], v30, s[16:19], s21 offen offset:3072 sc1
 s_add_u32 s21, s50, 8192
 buffer_load_dwordx4 v[240:243], v30, s[16:19], s21 offen offset:0 sc1
 buffer_load_dwordx4 v[244:247], v30, s[16:19], s21 offen offset:1024 sc1
 buffer_load_dwordx4 v[248:251], v30, s[16:19], s21 offen offset:2048 sc1
 buffer_load_dwordx4 v[252:255], v30, s[16:19], s21 offen offset:3072 sc1
qk_199:
 s_waitcnt lgkmcnt(0)
 s_barrier
 ds_read_b128 v[64:67], v29 offset:0
 ds_read_b128 v[68:71], v29 offset:64
 ds_read_b128 v[72:75], v29 offset:128
 ds_read_b128 v[76:79], v29 offset:192
 ds_read_b128 v[80:83], v29 offset:256
 ds_read_b128 v[84:87], v29 offset:320
 ds_read_b128 v[88:91], v29 offset:6400
 ds_read_b128 v[92:95], v29 offset:6464
 ds_read_b128 v[96:99], v29 offset:6528
 ds_read_b128 v[100:103], v29 offset:6592
 ds_read_b128 v[104:107], v29 offset:6656
 ds_read_b128 v[108:111], v29 offset:6720
 s_waitcnt lgkmcnt(0)
 s_cmp_eq_u32 s80, 1
 s_cselect_b32 s21, s79, 0
 s_cmp_ge_u32 s21, 8
 s_cbranch_scc1 qw_203
 s_waitcnt vmcnt(0)
qw_203:
 v_mfma_f32_16x16x32_bf16 v[112:115], v[36:39], v[64:67], 0
 v_mfma_f32_16x16x32_bf16 v[120:123], v[36:39], v[88:91], 0
 v_mfma_f32_16x16x32_bf16 v[124:127], v[60:63], v[88:91], 0
 v_mfma_f32_16x16x32_bf16 v[112:115], v[40:43], v[68:71], v[112:115]
 v_mfma_f32_16x16x32_bf16 v[120:123], v[40:43], v[92:95], v[120:123]
 v_mfma_f32_16x16x32_bf16 v[124:127], v[236:239], v[92:95], v[124:127]
 v_mfma_f32_16x16x32_bf16 v[112:115], v[44:47], v[72:75], v[112:115]
 v_mfma_f32_16x16x32_bf16 v[120:123], v[44:47], v[96:99], v[120:123]
 v_mfma_f32_16x16x32_bf16 v[124:127], v[240:243], v[96:99], v[124:127]
 v_mfma_f32_16x16x32_bf16 v[112:115], v[48:51], v[76:79], v[112:115]
 v_mfma_f32_16x16x32_bf16 v[120:123], v[48:51], v[100:103], v[120:123]
 v_mfma_f32_16x16x32_bf16 v[124:127], v[244:247], v[100:103], v[124:127]
 v_mfma_f32_16x16x32_bf16 v[112:115], v[52:55], v[80:83], v[112:115]
 v_mfma_f32_16x16x32_bf16 v[120:123], v[52:55], v[104:107], v[120:123]
 v_mfma_f32_16x16x32_bf16 v[124:127], v[248:251], v[104:107], v[124:127]
 v_mfma_f32_16x16x32_bf16 v[112:115], v[56:59], v[84:87], v[112:115]
 v_mfma_f32_16x16x32_bf16 v[120:123], v[56:59], v[108:111], v[120:123]
 v_mfma_f32_16x16x32_bf16 v[124:127], v[252:255], v[108:111], v[124:127]
 s_cmp_eq_u32 s80, 1
 s_cbranch_scc1 qm_204
 s_add_u32 s23, s49, 1
 s_mov_b32 s101, 0
wm_205:
 buffer_load_dword v156, v33, s[72:75], s77 offen sc1
 s_add_u32 s101, s101, 1
 s_cmp_gt_u32 s101, 131072
 s_cbranch_scc1 main_end
 s_waitcnt vmcnt(0)
 v_cmp_gt_u32 vcc, s23, v156
 v_readfirstlane_b32 s100, v156
 s_nop 0
 s_cbranch_vccz wm_206
 s_sleep 16
 s_add_u32 s100, s100, 2
 s_cmp_ge_u32 s100, s23
 s_cbranch_scc1 wm_205
 s_sleep 90
 s_branch wm_205
wm_206:
 buffer_load_dwordx4 a[240:243], v31, s[52:55], s51 offen offset:0 sc1
 buffer_load_dwordx4 a[244:247], v31, s[52:55], s51 offen offset:512 sc1
 buffer_load_dwordx4 a[248:251], v31, s[52:55], s51 offen offset:1024 sc1
 buffer_load_dwordx4 a[252:255], v31, s[52:55], s51 offen offset:1536 sc1
 buffer_load_dwordx4 v[24:27], v31, s[52:55], s51 offen offset:2048 sc1
 buffer_load_dwordx4 v[6:9], v31, s[52:55], s51 offen offset:2560 sc1
qm_204:
 s_waitcnt vmcnt(0)
 v_mfma_f32_16x16x32_bf16 v[116:119], a[240:243], v[64:67], 0
 v_mfma_f32_16x16x32_bf16 v[128:131], a[240:243], v[88:91], 0
 v_mfma_f32_16x16x32_bf16 v[116:119], a[244:247], v[68:71], v[116:119]
 v_mfma_f32_16x16x32_bf16 v[128:131], a[244:247], v[92:95], v[128:131]
 v_mfma_f32_16x16x32_bf16 v[116:119], a[248:251], v[72:75], v[116:119]
 v_mfma_f32_16x16x32_bf16 v[128:131], a[248:251], v[96:99], v[128:131]
 v_mfma_f32_16x16x32_bf16 v[116:119], a[252:255], v[76:79], v[116:119]
 v_mfma_f32_16x16x32_bf16 v[128:131], a[252:255], v[100:103], v[128:131]
 v_mfma_f32_16x16x32_bf16 v[116:119], v[24:27], v[80:83], v[116:119]
 v_mfma_f32_16x16x32_bf16 v[128:131], v[24:27], v[104:107], v[128:131]
 v_mfma_f32_16x16x32_bf16 v[116:119], v[6:9], v[84:87], v[116:119]
 v_mfma_f32_16x16x32_bf16 v[128:131], v[6:9], v[108:111], v[128:131]
qx_197:
 s_lshl_b32 s21, s49, 5
 s_add_u32 s21, s21, s42
 s_mul_i32 s81, s21, 2560
 s_lshl_b32 s82, s49, 3
 s_and_b32 s21, s42, 7
 s_add_u32 s82, s82, s21
 s_lshl_b32 s82, s82, 7
 s_add_u32 s82, s82, 22528
 s_cmp_gt_u32 s26, 1
 s_cselect_b32 s21, s80, 0
 s_cmp_eq_u32 s21, 0
 s_cbranch_scc1 qi_208
 v_mov_b32 v36, v112
 v_mov_b32 v37, v113
 v_mov_b32 v38, v114
 v_mov_b32 v39, v115
 v_mov_b32 v40, v116
 v_mov_b32 v41, v117
 v_mov_b32 v42, v118
 v_mov_b32 v43, v119
 v_mov_b32 v44, v120
 v_mov_b32 v45, v121
 v_mov_b32 v46, v122
 v_mov_b32 v47, v123
 v_mov_b32 v48, v124
 v_mov_b32 v49, v125
 v_mov_b32 v50, v126
 v_mov_b32 v51, v127
 v_mov_b32 v52, v128
 v_mov_b32 v53, v129
 v_mov_b32 v54, v130
 v_mov_b32 v55, v131
 s_branch qd_207
qi_208:
 v_cndmask_b32 v112, v34, v112, s[64:65]
 v_cndmask_b32 v124, v34, v124, s[64:65]
 v_cndmask_b32 v113, v34, v113, s[66:67]
 v_cndmask_b32 v125, v34, v125, s[66:67]
 v_cndmask_b32 v114, v34, v114, s[68:69]
 v_cndmask_b32 v126, v34, v126, s[68:69]
 v_cndmask_b32 v115, v34, v115, s[70:71]
 v_cndmask_b32 v127, v34, v127, s[70:71]
 v_max3_f32 v156, v112, v113, v114
 v_max3_f32 v156, v156, v115, v116
 v_max3_f32 v156, v156, v117, v118
 v_max_f32 v156, v156, v119
 v_mov_b32 v157, v156
 s_nop 1
 v_permlane32_swap_b32 v156, v157
 v_max_f32 v156, v156, v157
 v_mov_b32 v157, v156
 s_nop 1
 v_permlane16_swap_b32 v156, v157
 v_max_f32 v156, v156, v157
 v_mul_f32 v156, s83, v156
 v_fma_f32 v112, v112, s83, -v156
 v_fma_f32 v113, v113, s83, -v156
 v_fma_f32 v114, v114, s83, -v156
 v_fma_f32 v115, v115, s83, -v156
 v_fma_f32 v116, v116, s83, -v156
 v_fma_f32 v117, v117, s83, -v156
 v_fma_f32 v118, v118, s83, -v156
 v_fma_f32 v119, v119, s83, -v156
 v_exp_f32 v112, v112
 v_exp_f32 v113, v113
 v_exp_f32 v114, v114
 v_exp_f32 v115, v115
 v_exp_f32 v116, v116
 v_exp_f32 v117, v117
 v_exp_f32 v118, v118
 v_exp_f32 v119, v119
 s_nop 0
 v_add_f32 v156, v116, v117
 v_add_f32 v156, v156, v118
 v_add_f32 v156, v156, v119
 v_cndmask_b32 v156, 0, v156, s[60:61]
 v_add_f32 v156, v156, v112
 v_add_f32 v156, v156, v113
 v_add_f32 v156, v156, v114
 v_add_f32 v156, v156, v115
 v_mov_b32 v157, v156
 s_nop 1
 v_permlane32_swap_b32 v156, v157
 v_add_f32 v156, v156, v157
 v_mov_b32 v157, v156
 s_nop 1
 v_permlane16_swap_b32 v156, v157
 v_add_f32 v156, v156, v157
 v_rcp_f32 v156, v156
 s_nop 0
 v_mul_f32 v112, v112, v156
 v_mul_f32 v113, v113, v156
 v_mul_f32 v114, v114, v156
 v_mul_f32 v115, v115, v156
 v_mul_f32 v116, v116, v156
 v_mul_f32 v117, v117, v156
 v_mul_f32 v118, v118, v156
 v_mul_f32 v119, v119, v156
 v_max3_f32 v156, v120, v121, v122
 v_max3_f32 v156, v156, v123, v124
 v_max3_f32 v156, v156, v125, v126
 v_max3_f32 v156, v156, v127, v128
 v_max3_f32 v156, v156, v129, v130
 v_max_f32 v156, v156, v131
 v_mov_b32 v157, v156
 s_nop 1
 v_permlane32_swap_b32 v156, v157
 v_max_f32 v156, v156, v157
 v_mov_b32 v157, v156
 s_nop 1
 v_permlane16_swap_b32 v156, v157
 v_max_f32 v156, v156, v157
 v_mul_f32 v156, s83, v156
 v_fma_f32 v120, v120, s83, -v156
 v_fma_f32 v121, v121, s83, -v156
 v_fma_f32 v122, v122, s83, -v156
 v_fma_f32 v123, v123, s83, -v156
 v_fma_f32 v124, v124, s83, -v156
 v_fma_f32 v125, v125, s83, -v156
 v_fma_f32 v126, v126, s83, -v156
 v_fma_f32 v127, v127, s83, -v156
 v_fma_f32 v128, v128, s83, -v156
 v_fma_f32 v129, v129, s83, -v156
 v_fma_f32 v130, v130, s83, -v156
 v_fma_f32 v131, v131, s83, -v156
 v_exp_f32 v120, v120
 v_exp_f32 v121, v121
 v_exp_f32 v122, v122
 v_exp_f32 v123, v123
 v_exp_f32 v124, v124
 v_exp_f32 v125, v125
 v_exp_f32 v126, v126
 v_exp_f32 v127, v127
 v_exp_f32 v128, v128
 v_exp_f32 v129, v129
 v_exp_f32 v130, v130
 v_exp_f32 v131, v131
 s_nop 0
 v_add_f32 v156, v128, v129
 v_add_f32 v156, v156, v130
 v_add_f32 v156, v156, v131
 v_cndmask_b32 v156, 0, v156, s[60:61]
 v_add_f32 v156, v156, v120
 v_add_f32 v156, v156, v121
 v_add_f32 v156, v156, v122
 v_add_f32 v156, v156, v123
 v_add_f32 v156, v156, v124
 v_add_f32 v156, v156, v125
 v_add_f32 v156, v156, v126
 v_add_f32 v156, v156, v127
 v_mov_b32 v157, v156
 s_nop 1
 v_permlane32_swap_b32 v156, v157
 v_add_f32 v156, v156, v157
 v_mov_b32 v157, v156
 s_nop 1
 v_permlane16_swap_b32 v156, v157
 v_add_f32 v156, v156, v157
 v_rcp_f32 v156, v156
 s_nop 0
 v_mul_f32 v120, v120, v156
 v_mul_f32 v121, v121, v156
 v_mul_f32 v122, v122, v156
 v_mul_f32 v123, v123, v156
 v_mul_f32 v124, v124, v156
 v_mul_f32 v125, v125, v156
 v_mul_f32 v126, v126, v156
 v_mul_f32 v127, v127, v156
 v_mul_f32 v128, v128, v156
 v_mul_f32 v129, v129, v156
 v_mul_f32 v130, v130, v156
 v_mul_f32 v131, v131, v156
 v_cvt_pk_bf16_f32 v196, v116, v117
 v_cvt_pk_bf16_f32 v197, v118, v119
 v_cvt_pk_bf16_f32 v198, v128, v129
 v_cvt_pk_bf16_f32 v199, v130, v131
 v_cvt_pk_bf16_f32 v192, v120, v121
 v_cvt_pk_bf16_f32 v193, v122, v123
 v_cvt_pk_bf16_f32 v194, v124, v125
 v_cvt_pk_bf16_f32 v195, v126, v127
 v_cvt_pk_bf16_f32 v200, v112, v113
 v_cvt_pk_bf16_f32 v201, v114, v115
 v_permlane16_swap_b32 v196, v198
 v_permlane16_swap_b32 v197, v199
 buffer_store_dwordx4 v[192:195], v30, s[56:59], s81 offen sc1
 s_mov_b64 exec, 0xffffffff
 buffer_store_dwordx4 v[196:199], v30, s[56:59], s81 offen offset:1024 sc1
 s_mov_b64 exec, -1
 buffer_store_dwordx2 v[200:201], v32, s[56:59], s81 offen offset:2048 sc1
 s_mov_b32 s78, s82
 s_mov_b32 s81, 0x80000000
 s_mov_b32 s82, 0
 s_cmp_eq_u32 s80, 1
 s_cbranch_scc1 qd_207
 s_waitcnt vmcnt(0)
 s_cmp_eq_u32 s78, 0
 s_cbranch_scc1 pf_209
 v_mov_b32 v4, 0
 v_mov_b32 v5, 1
 s_mov_b64 exec, 1
 buffer_atomic_add v5, v4, s[72:75], s78 offen sc1
 s_mov_b64 exec, -1
 s_mov_b32 s78, 0
pf_209:
qd_207:
 s_add_u32 s49, s49, s29
qbe_196:
 s_sub_u32 s26, s26, 1
 s_cmp_gt_u32 s26, 0
 s_waitcnt lgkmcnt(0)
 s_cbranch_scc1 qa_blk_194
 s_waitcnt vmcnt(0) lgkmcnt(0)
 s_cmp_eq_u32 s78, 0
 s_cbranch_scc1 pf_210
 v_mov_b32 v4, 0
 v_mov_b32 v5, 1
 s_mov_b64 exec, 1
 buffer_atomic_add v5, v4, s[72:75], s78 offen sc1
 s_mov_b64 exec, -1
 s_mov_b32 s78, 0
pf_210:
 s_branch q_done
q_final:
 s_mov_b32 s16, s38
 s_mov_b32 s17, s39
 s_mov_b32 s18, 50331648
 s_mov_b32 s19, 0x00020000
 s_add_u32 s52, s38, 50331648
 s_addc_u32 s53, s39, 0
 s_mov_b32 s54, 6291456
 s_mov_b32 s55, 0x00020000
 s_add_u32 s56, s38, 85983232
 s_addc_u32 s57, s39, 0
 s_mov_b32 s58, 5242880
 s_mov_b32 s59, 0x00020000
 s_mul_i32 s21, s20, 12800
 s_add_u32 s21, s21, 98304
 v_mul_u32_u24 v4, 400, v2
 v_lshlrev_b32 v5, 4, v3
 v_add3_u32 v29, v4, v5, s21
 v_lshlrev_b32 v30, 4, v1
 v_and_b32 v4, 1, v2
 v_bfe_u32 v5, v2, 1, 1
 v_lshl_or_b32 v4, v5, 2, v4
 v_bfe_u32 v5, v2, 2, 1
 v_lshl_or_b32 v4, v5, 1, v4
 v_lshlrev_b32 v4, 4, v4
 v_lshl_add_u32 v31, v3, 7, v4
 v_lshlrev_b32 v32, 3, v1
 v_and_b32 v4, 3, v1
 v_lshlrev_b32 v33, 3, v4
 v_mov_b32 v34, 0xf149f2ca
 v_lshlrev_b32 v4, 2, v3
 v_sub_u32 v35, v2, v4
 v_cmp_gt_u32 s[60:61], 2, v3
 s_mov_b32 s62, 0x3d93cd3a
 s_mov_b32 s63, 0x3fb8aa3b
 s_mov_b32 s83, 0x3dd53b95
 v_cmp_le_i32 s[64:65], 0, v35
 v_cmp_le_i32 s[66:67], 1, v35
 v_cmp_le_i32 s[68:69], 2, v35
 v_cmp_le_i32 s[70:71], 3, v35
 s_add_u32 s49, s20, 56
 s_mov_b32 s29, 4
 s_mov_b32 s78, 0
 s_add_u32 s12, s38, 57671680
 s_addc_u32 s13, s39, 0
 s_mov_b32 s14, 3145728
 s_mov_b32 s15, 0x00020000
qf_211:
 s_mul_i32 s21, s49, 393216
 s_mul_i32 s22, s42, 12288
 s_add_u32 s50, s21, s22
 s_mul_i32 s21, s49, 98304
 s_mul_i32 s22, s42, 3072
 s_add_u32 s51, s21, s22
 s_lshr_b32 s22, s49, 1
 s_lshr_b32 s21, s49, 2
 s_add_u32 s21, s21, 2
 s_cmp_lt_u32 s49, 8
 s_cselect_b32 s21, s22, s21
 s_lshl_b32 s21, s21, 3
 s_lshr_b32 s22, s42, 2
 s_add_u32 s21, s21, s22
 s_lshl_b32 s21, s21, 7
 s_add_u32 s76, s21, 0
 s_lshl_b32 s77, s42, 7
 s_add_u32 s77, s77, 18432
 s_sub_u32 s43, s50, 22020096
 buffer_load_dword v21, v33, s[72:75], s77 offen sc1
 s_add_u32 s21, s50, 0
 buffer_load_dwordx4 v[36:39], v30, s[16:19], s21 offen offset:0 sc1
 buffer_load_dwordx4 v[40:43], v30, s[16:19], s21 offen offset:1024 sc1
 buffer_load_dwordx4 v[44:47], v30, s[16:19], s21 offen offset:2048 sc1
 buffer_load_dwordx4 v[48:51], v30, s[16:19], s21 offen offset:3072 sc1
 s_add_u32 s21, s50, 4096
 buffer_load_dwordx4 v[52:55], v30, s[16:19], s21 offen offset:0 sc1
 buffer_load_dwordx4 v[56:59], v30, s[16:19], s21 offen offset:1024 sc1
 buffer_load_dwordx4 v[60:63], v30, s[16:19], s21 offen offset:2048 sc1
 buffer_load_dwordx4 v[236:239], v30, s[16:19], s21 offen offset:3072 sc1
 s_add_u32 s21, s50, 8192
 buffer_load_dwordx4 v[240:243], v30, s[16:19], s21 offen offset:0 sc1
 buffer_load_dwordx4 v[244:247], v30, s[16:19], s21 offen offset:1024 sc1
 buffer_load_dwordx4 v[248:251], v30, s[16:19], s21 offen offset:2048 sc1
 buffer_load_dwordx4 v[252:255], v30, s[16:19], s21 offen offset:3072 sc1
 s_add_u32 s21, s43, 0
 buffer_load_dwordx4 v[64:67], v30, s[12:15], s21 offen offset:0 sc1
 buffer_load_dwordx4 v[68:71], v30, s[12:15], s21 offen offset:1024 sc1
 buffer_load_dwordx4 v[72:75], v30, s[12:15], s21 offen offset:2048 sc1
 buffer_load_dwordx4 v[76:79], v30, s[12:15], s21 offen offset:3072 sc1
 s_add_u32 s21, s43, 4096
 buffer_load_dwordx4 v[80:83], v30, s[12:15], s21 offen offset:0 sc1
 buffer_load_dwordx4 v[84:87], v30, s[12:15], s21 offen offset:1024 sc1
 buffer_load_dwordx4 v[88:91], v30, s[12:15], s21 offen offset:2048 sc1
 buffer_load_dwordx4 v[92:95], v30, s[12:15], s21 offen offset:3072 sc1
 s_add_u32 s21, s43, 8192
 buffer_load_dwordx4 v[96:99], v30, s[12:15], s21 offen offset:0 sc1
 buffer_load_dwordx4 v[100:103], v30, s[12:15], s21 offen offset:1024 sc1
 buffer_load_dwordx4 v[104:107], v30, s[12:15], s21 offen offset:2048 sc1
 buffer_load_dwordx4 v[108:111], v30, s[12:15], s21 offen offset:3072 sc1
 s_waitcnt vmcnt(24)
 s_cmp_eq_u32 s78, 0
 s_cbranch_scc1 pf_215
 v_mov_b32 v4, 0
 v_mov_b32 v5, 1
 s_mov_b64 exec, 1
 buffer_atomic_add v5, v4, s[72:75], s78 offen sc1
 s_mov_b64 exec, -1
 s_mov_b32 s78, 0
pf_215:
 s_add_u32 s23, s49, 1
 v_cmp_gt_u32 vcc, s23, v21
 s_mov_b32 s80, 0
 s_nop 0
 s_cbranch_vccnz qk_214
 s_mov_b32 s80, 1
 buffer_load_dwordx4 v[132:135], v31, s[52:55], s51 offen offset:0 sc1
 buffer_load_dwordx4 v[136:139], v31, s[52:55], s51 offen offset:512 sc1
 buffer_load_dwordx4 v[140:143], v31, s[52:55], s51 offen offset:1024 sc1
 buffer_load_dwordx4 v[144:147], v31, s[52:55], s51 offen offset:1536 sc1
 buffer_load_dwordx4 v[148:151], v31, s[52:55], s51 offen offset:2048 sc1
 buffer_load_dwordx4 v[152:155], v31, s[52:55], s51 offen offset:2560 sc1
 s_waitcnt vmcnt(6)
 s_branch qk_214x
qk_214:
 s_waitcnt vmcnt(0)
qk_214x:
 v_mfma_f32_16x16x32_bf16 v[112:115], v[36:39], v[64:67], 0
 v_mfma_f32_16x16x32_bf16 v[120:123], v[36:39], v[88:91], 0
 v_mfma_f32_16x16x32_bf16 v[124:127], v[60:63], v[88:91], 0
 v_mfma_f32_16x16x32_bf16 v[112:115], v[40:43], v[68:71], v[112:115]
 v_mfma_f32_16x16x32_bf16 v[120:123], v[40:43], v[92:95], v[120:123]
 v_mfma_f32_16x16x32_bf16 v[124:127], v[236:239], v[92:95], v[124:127]
 v_mfma_f32_16x16x32_bf16 v[112:115], v[44:47], v[72:75], v[112:115]
 v_mfma_f32_16x16x32_bf16 v[120:123], v[44:47], v[96:99], v[120:123]
 v_mfma_f32_16x16x32_bf16 v[124:127], v[240:243], v[96:99], v[124:127]
 v_mfma_f32_16x16x32_bf16 v[112:115], v[48:51], v[76:79], v[112:115]
 v_mfma_f32_16x16x32_bf16 v[120:123], v[48:51], v[100:103], v[120:123]
 v_mfma_f32_16x16x32_bf16 v[124:127], v[244:247], v[100:103], v[124:127]
 v_mfma_f32_16x16x32_bf16 v[112:115], v[52:55], v[80:83], v[112:115]
 v_mfma_f32_16x16x32_bf16 v[120:123], v[52:55], v[104:107], v[120:123]
 v_mfma_f32_16x16x32_bf16 v[124:127], v[248:251], v[104:107], v[124:127]
 v_mfma_f32_16x16x32_bf16 v[112:115], v[56:59], v[84:87], v[112:115]
 v_mfma_f32_16x16x32_bf16 v[120:123], v[56:59], v[108:111], v[120:123]
 v_mfma_f32_16x16x32_bf16 v[124:127], v[252:255], v[108:111], v[124:127]
 s_cmp_eq_u32 s80, 1
 s_cbranch_scc1 qm_216
 s_add_u32 s23, s49, 1
 s_min_u32 s22, s49, 61
 s_cmp_lt_u32 s49, 58
 s_cselect_b32 s23, s23, s22
 s_mov_b32 s101, 0
wm_217:
 buffer_load_dword v156, v33, s[72:75], s77 offen sc1
 s_add_u32 s101, s101, 1
 s_cmp_gt_u32 s101, 131072
 s_cbranch_scc1 main_end
 s_waitcnt vmcnt(0)
 v_cmp_gt_u32 vcc, s23, v156
 v_readfirstlane_b32 s100, v156
 s_nop 0
 s_cbranch_vccz wm_218
 s_sleep 16
 s_add_u32 s100, s100, 2
 s_cmp_ge_u32 s100, s23
 s_cbranch_scc1 wm_217
 s_sleep 90
 s_branch wm_217
wm_218:
 s_cmp_eq_u32 s49, 63
 s_cselect_b32 s21, s101, 0
 s_cmp_lt_u32 s21, 2
 s_cbranch_scc1 qtz_221
 s_sleep 36
qtz_221:
 s_mov_b32 s101, 0
 s_branch qtp_220
qtp_219:
 s_sleep 3
qtp_220:
 buffer_load_dwordx4 v[132:135], v31, s[52:55], s51 offen offset:0 sc1
 buffer_load_dwordx4 v[136:139], v31, s[52:55], s51 offen offset:512 sc1
 buffer_load_dwordx4 v[140:143], v31, s[52:55], s51 offen offset:1024 sc1
 buffer_load_dwordx4 v[144:147], v31, s[52:55], s51 offen offset:1536 sc1
 buffer_load_dwordx4 v[148:151], v31, s[52:55], s51 offen offset:2048 sc1
 buffer_load_dwordx4 v[152:155], v31, s[52:55], s51 offen offset:2560 sc1
 s_add_u32 s101, s101, 1
 s_cmp_gt_u32 s101, 131072
 s_cbranch_scc1 main_end
 s_waitcnt vmcnt(0)
 v_max3_u32 v156, v132, v134, v136
 v_max3_u32 v156, v156, v138, v140
 v_max3_u32 v156, v156, v142, v144
 v_max3_u32 v156, v156, v146, v148
 v_max3_u32 v156, v156, v150, v152
 v_max3_u32 v156, v156, v154, v154
 v_cmp_eq_u32 vcc, -1, v156
 s_nop 1
 s_cbranch_vccnz qtp_219
qm_216:
 s_waitcnt vmcnt(0)
 v_mfma_f32_16x16x32_bf16 v[116:119], v[132:135], v[64:67], 0
 v_mfma_f32_16x16x32_bf16 v[128:131], v[132:135], v[88:91], 0
 v_mfma_f32_16x16x32_bf16 v[116:119], v[136:139], v[68:71], v[116:119]
 v_mfma_f32_16x16x32_bf16 v[128:131], v[136:139], v[92:95], v[128:131]
 v_mfma_f32_16x16x32_bf16 v[116:119], v[140:143], v[72:75], v[116:119]
 v_mfma_f32_16x16x32_bf16 v[128:131], v[140:143], v[96:99], v[128:131]
 v_mfma_f32_16x16x32_bf16 v[116:119], v[144:147], v[76:79], v[116:119]
 v_mfma_f32_16x16x32_bf16 v[128:131], v[144:147], v[100:103], v[128:131]
 v_mfma_f32_16x16x32_bf16 v[116:119], v[148:151], v[80:83], v[116:119]
 v_mfma_f32_16x16x32_bf16 v[128:131], v[148:151], v[104:107], v[128:131]
 v_mfma_f32_16x16x32_bf16 v[116:119], v[152:155], v[84:87], v[116:119]
 v_mfma_f32_16x16x32_bf16 v[128:131], v[152:155], v[108:111], v[128:131]
qx_213:
 s_lshl_b32 s21, s49, 5
 s_add_u32 s21, s21, s42
 s_mul_i32 s81, s21, 2560
 s_lshl_b32 s82, s49, 3
 s_and_b32 s21, s42, 7
 s_add_u32 s82, s82, s21
 s_lshl_b32 s82, s82, 7
 s_add_u32 s82, s82, 22528
 v_cndmask_b32 v112, v34, v112, s[64:65]
 v_cndmask_b32 v124, v34, v124, s[64:65]
 v_cndmask_b32 v113, v34, v113, s[66:67]
 v_cndmask_b32 v125, v34, v125, s[66:67]
 v_cndmask_b32 v114, v34, v114, s[68:69]
 v_cndmask_b32 v126, v34, v126, s[68:69]
 v_cndmask_b32 v115, v34, v115, s[70:71]
 v_cndmask_b32 v127, v34, v127, s[70:71]
 v_max3_f32 v156, v112, v113, v114
 v_max3_f32 v156, v156, v115, v116
 v_max3_f32 v156, v156, v117, v118
 v_max_f32 v156, v156, v119
 v_mov_b32 v157, v156
 s_nop 1
 v_permlane32_swap_b32 v156, v157
 v_max_f32 v156, v156, v157
 v_mov_b32 v157, v156
 s_nop 1
 v_permlane16_swap_b32 v156, v157
 v_max_f32 v156, v156, v157
 v_mul_f32 v156, s83, v156
 v_fma_f32 v112, v112, s83, -v156
 v_fma_f32 v113, v113, s83, -v156
 v_fma_f32 v114, v114, s83, -v156
 v_fma_f32 v115, v115, s83, -v156
 v_fma_f32 v116, v116, s83, -v156
 v_fma_f32 v117, v117, s83, -v156
 v_fma_f32 v118, v118, s83, -v156
 v_fma_f32 v119, v119, s83, -v156
 v_exp_f32 v112, v112
 v_exp_f32 v113, v113
 v_exp_f32 v114, v114
 v_exp_f32 v115, v115
 v_exp_f32 v116, v116
 v_exp_f32 v117, v117
 v_exp_f32 v118, v118
 v_exp_f32 v119, v119
 s_nop 0
 v_add_f32 v156, v116, v117
 v_add_f32 v156, v156, v118
 v_add_f32 v156, v156, v119
 v_cndmask_b32 v156, 0, v156, s[60:61]
 v_add_f32 v156, v156, v112
 v_add_f32 v156, v156, v113
 v_add_f32 v156, v156, v114
 v_add_f32 v156, v156, v115
 v_mov_b32 v157, v156
 s_nop 1
 v_permlane32_swap_b32 v156, v157
 v_add_f32 v156, v156, v157
 v_mov_b32 v157, v156
 s_nop 1
 v_permlane16_swap_b32 v156, v157
 v_add_f32 v156, v156, v157
 v_rcp_f32 v156, v156
 s_nop 0
 v_mul_f32 v112, v112, v156
 v_mul_f32 v113, v113, v156
 v_mul_f32 v114, v114, v156
 v_mul_f32 v115, v115, v156
 v_mul_f32 v116, v116, v156
 v_mul_f32 v117, v117, v156
 v_mul_f32 v118, v118, v156
 v_mul_f32 v119, v119, v156
 v_max3_f32 v156, v120, v121, v122
 v_max3_f32 v156, v156, v123, v124
 v_max3_f32 v156, v156, v125, v126
 v_max3_f32 v156, v156, v127, v128
 v_max3_f32 v156, v156, v129, v130
 v_max_f32 v156, v156, v131
 v_mov_b32 v157, v156
 s_nop 1
 v_permlane32_swap_b32 v156, v157
 v_max_f32 v156, v156, v157
 v_mov_b32 v157, v156
 s_nop 1
 v_permlane16_swap_b32 v156, v157
 v_max_f32 v156, v156, v157
 v_mul_f32 v156, s83, v156
 v_fma_f32 v120, v120, s83, -v156
 v_fma_f32 v121, v121, s83, -v156
 v_fma_f32 v122, v122, s83, -v156
 v_fma_f32 v123, v123, s83, -v156
 v_fma_f32 v124, v124, s83, -v156
 v_fma_f32 v125, v125, s83, -v156
 v_fma_f32 v126, v126, s83, -v156
 v_fma_f32 v127, v127, s83, -v156
 v_fma_f32 v128, v128, s83, -v156
 v_fma_f32 v129, v129, s83, -v156
 v_fma_f32 v130, v130, s83, -v156
 v_fma_f32 v131, v131, s83, -v156
 v_exp_f32 v120, v120
 v_exp_f32 v121, v121
 v_exp_f32 v122, v122
 v_exp_f32 v123, v123
 v_exp_f32 v124, v124
 v_exp_f32 v125, v125
 v_exp_f32 v126, v126
 v_exp_f32 v127, v127
 v_exp_f32 v128, v128
 v_exp_f32 v129, v129
 v_exp_f32 v130, v130
 v_exp_f32 v131, v131
 s_nop 0
 v_add_f32 v156, v128, v129
 v_add_f32 v156, v156, v130
 v_add_f32 v156, v156, v131
 v_cndmask_b32 v156, 0, v156, s[60:61]
 v_add_f32 v156, v156, v120
 v_add_f32 v156, v156, v121
 v_add_f32 v156, v156, v122
 v_add_f32 v156, v156, v123
 v_add_f32 v156, v156, v124
 v_add_f32 v156, v156, v125
 v_add_f32 v156, v156, v126
 v_add_f32 v156, v156, v127
 v_mov_b32 v157, v156
 s_nop 1
 v_permlane32_swap_b32 v156, v157
 v_add_f32 v156, v156, v157
 v_mov_b32 v157, v156
 s_nop 1
 v_permlane16_swap_b32 v156, v157
 v_add_f32 v156, v156, v157
 v_rcp_f32 v156, v156
 s_nop 0
 v_mul_f32 v120, v120, v156
 v_mul_f32 v121, v121, v156
 v_mul_f32 v122, v122, v156
 v_mul_f32 v123, v123, v156
 v_mul_f32 v124, v124, v156
 v_mul_f32 v125, v125, v156
 v_mul_f32 v126, v126, v156
 v_mul_f32 v127, v127, v156
 v_mul_f32 v128, v128, v156
 v_mul_f32 v129, v129, v156
 v_mul_f32 v130, v130, v156
 v_mul_f32 v131, v131, v156
 v_cvt_pk_bf16_f32 v196, v116, v117
 v_cvt_pk_bf16_f32 v197, v118, v119
 v_cvt_pk_bf16_f32 v198, v128, v129
 v_cvt_pk_bf16_f32 v199, v130, v131
 v_cvt_pk_bf16_f32 v192, v120, v121
 v_cvt_pk_bf16_f32 v193, v122, v123
 v_cvt_pk_bf16_f32 v194, v124, v125
 v_cvt_pk_bf16_f32 v195, v126, v127
 v_cvt_pk_bf16_f32 v200, v112, v113
 v_cvt_pk_bf16_f32 v201, v114, v115
 v_permlane16_swap_b32 v196, v198
 v_permlane16_swap_b32 v197, v199
 buffer_store_dwordx4 v[192:195], v30, s[56:59], s81 offen sc1
 s_mov_b64 exec, 0xffffffff
 buffer_store_dwordx4 v[196:199], v30, s[56:59], s81 offen offset:1024 sc1
 s_mov_b64 exec, -1
 buffer_store_dwordx2 v[200:201], v32, s[56:59], s81 offen offset:2048 sc1
 s_mov_b32 s78, s82
 s_mov_b32 s81, 0x80000000
 s_mov_b32 s82, 0
 s_cmp_eq_u32 s80, 1
 s_cbranch_scc1 qd_222
 s_waitcnt vmcnt(0)
 s_cmp_eq_u32 s78, 0
 s_cbranch_scc1 pf_223
 v_mov_b32 v4, 0
 v_mov_b32 v5, 1
 s_mov_b64 exec, 1
 buffer_atomic_add v5, v4, s[72:75], s78 offen sc1
 s_mov_b64 exec, -1
 s_mov_b32 s78, 0
pf_223:
qd_222:
 s_add_u32 s49, s49, s29
qbe_212:
 s_cmp_lt_u32 s49, 64
 s_cbranch_scc1 qf_211
 s_waitcnt vmcnt(0)
 s_cmp_eq_u32 s78, 0
 s_cbranch_scc1 pf_224
 v_mov_b32 v4, 0
 v_mov_b32 v5, 1
 s_mov_b64 exec, 1
 buffer_atomic_add v5, v4, s[72:75], s78 offen sc1
 s_mov_b64 exec, -1
 s_mov_b32 s78, 0
pf_224:
 s_branch queue
q_done:
 s_and_b32 s21, s3, 3
 s_cmp_lt_u32 s21, 2
 s_cbranch_scc1 queue
 s_sub_u32 s21, s21, 2
 s_lshl_b32 s21, s21, 3
 s_bfe_u32 s22, s3, 0x30002
 s_add_u32 s21, s21, s22
 s_add_u32 s87, s21, 236
 s_branch tail_item
queue:
 s_load_dwordx2 s[4:5], s[0:1], 96
 s_waitcnt lgkmcnt(0)
 s_mov_b32 s32, s4
 s_mov_b32 s33, s5
 s_mov_b32 s34, 256
 s_mov_b32 s35, 0x00020000
 s_waitcnt vmcnt(0) lgkmcnt(0)
 s_barrier
 s_mov_b32 s2, s85
 s_mov_b32 s85, -1
 s_cmp_lg_u32 s2, -1
 s_cbranch_scc1 queue_c
 v_mov_b32 v21, 0
 s_cmp_lg_u32 s20, 0
 s_cbranch_scc1 q_225
 v_mov_b32 v22, 80
 v_mov_b32 v23, 1
 s_mov_b64 exec, 1
 buffer_atomic_add v23, v22, s[32:35], 0 offen sc0 sc1
 s_waitcnt vmcnt(0)
queue_a:
 ds_write_b32 v21, v23
 s_waitcnt lgkmcnt(0)
 s_mov_b64 exec, -1
q_225:
queue_b:
 s_barrier
 ds_read_b32 v23, v21
 s_waitcnt lgkmcnt(0)
 v_readfirstlane_b32 s2, v23
 s_barrier
queue_c:
 s_add_u32 s21, s2, 0
 s_cmp_lt_u32 s2, 164
 s_cbranch_scc1 do_pv
 s_sub_u32 s2, s2, 164
 s_add_u32 s21, s2, 204
 s_cmp_lt_u32 s2, 32
 s_cbranch_scc1 do_pv
 s_sub_u32 s2, s2, 32
 s_add_u32 s21, s2, 164
 s_cmp_lt_u32 s2, 40
 s_cbranch_scc1 do_pv
 s_sub_u32 s2, s2, 40
 s_branch main_fin
do_opb:
 s_mov_b32 s87, -1
do_opb2:
 s_mov_b32 s2, s21
 s_load_dwordx2 s[4:5], s[0:1], 0
 s_load_dwordx4 s[40:43], s[0:1], 72
 s_load_dwordx2 s[38:39], s[0:1], 104
 s_lshl_b32 s59, s2, 2
 s_add_u32 s59, s59, s20
 s_lshl_b32 s59, s59, 3
 v_lshlrev_b32 v4, 4, v1
 v_lshlrev_b32 v5, 2, v1
 s_waitcnt lgkmcnt(0)
 s_mov_b32 s8, s4
 s_mov_b32 s9, s5
 s_mov_b32 s10, 2621440
 s_mov_b32 s11, 0x00020000
 s_mov_b32 s12, s42
 s_mov_b32 s13, s43
 s_mov_b32 s14, 1280
 s_mov_b32 s15, 0x00020000
 s_mov_b32 s24, s40
 s_mov_b32 s25, s41
 s_mov_b32 s26, 819200
 s_mov_b32 s27, 0x00020000
 s_add_u32 s16, s38, 70713344
 s_addc_u32 s17, s39, 0
 s_mov_b32 s18, 2641920
 s_mov_b32 s19, 0x00020000
 s_add_u32 s28, s38, 81002496
 s_addc_u32 s29, s39, 0
 s_mov_b32 s30, 8192
 s_mov_b32 s31, 0x00020000
 s_add_u32 s72, s38, 81068032
 s_addc_u32 s73, s39, 0
 s_mov_b32 s74, 128000
 s_mov_b32 s75, 0x00020000
 s_cmp_ge_u32 s2, 32
 s_cbranch_scc1 mw_226
 s_lshr_b32 s21, s2, 2
 s_lshl_b32 s21, s21, 7
 s_add_u32 s21, s21, 115712
 s_cmp_lg_u32 s20, 0
 s_cbranch_scc1 wf_228
 v_mov_b32 v20, 0
 s_mov_b32 s101, 0
wf_227:
 buffer_load_dword v21, v20, s[72:75], s21 offen sc1
 s_add_u32 s101, s101, 1
 s_cmp_gt_u32 s101, 131072
 s_cbranch_scc1 main_end
 s_waitcnt vmcnt(0)
 v_readfirstlane_b32 s100, v21
 s_cmp_ge_u32 s100, 32
 s_cbranch_scc1 wf_228
 s_sleep 32
 s_branch wf_227
wf_228:
 s_barrier
mw_226:
 s_mov_b32 s21, 90112
 v_mov_b32 v20, 0
 buffer_load_dword v21, v20, s[72:75], s21 offen sc1
 v_mov_b32 v29, 3277
 s_mul_i32 s21, s20, 320
 s_add_u32 s21, s21, 0
 v_add_u32 v22, s21, v1
 v_mul_u32_u24 v23, v22, v29
 v_lshrrev_b32 v23, 16, v23
 v_mul_u32_u24 v24, 20, v23
 v_sub_u32 v22, v22, v24
 v_bfe_u32 v24, v23, 3, 1
 v_lshlrev_b32 v24, 1, v24
 v_xor_b32 v22, v22, v24
 v_mul_u32_u24 v23, 1280, v23
 v_lshl_add_u32 v8, v22, 4, v23
 s_mul_i32 s21, s20, 320
 s_add_u32 s21, s21, 64
 v_add_u32 v22, s21, v1
 v_mul_u32_u24 v23, v22, v29
 v_lshrrev_b32 v23, 16, v23
 v_mul_u32_u24 v24, 20, v23
 v_sub_u32 v22, v22, v24
 v_bfe_u32 v24, v23, 3, 1
 v_lshlrev_b32 v24, 1, v24
 v_xor_b32 v22, v22, v24
 v_mul_u32_u24 v23, 1280, v23
 v_lshl_add_u32 v9, v22, 4, v23
 s_mul_i32 s21, s20, 320
 s_add_u32 s21, s21, 128
 v_add_u32 v22, s21, v1
 v_mul_u32_u24 v23, v22, v29
 v_lshrrev_b32 v23, 16, v23
 v_mul_u32_u24 v24, 20, v23
 v_sub_u32 v22, v22, v24
 v_bfe_u32 v24, v23, 3, 1
 v_lshlrev_b32 v24, 1, v24
 v_xor_b32 v22, v22, v24
 v_mul_u32_u24 v23, 1280, v23
 v_lshl_add_u32 v10, v22, 4, v23
 s_mul_i32 s21, s20, 320
 s_add_u32 s21, s21, 192
 v_add_u32 v22, s21, v1
 v_mul_u32_u24 v23, v22, v29
 v_lshrrev_b32 v23, 16, v23
 v_mul_u32_u24 v24, 20, v23
 v_sub_u32 v22, v22, v24
 v_bfe_u32 v24, v23, 3, 1
 v_lshlrev_b32 v24, 1, v24
 v_xor_b32 v22, v22, v24
 v_mul_u32_u24 v23, 1280, v23
 v_lshl_add_u32 v11, v22, 4, v23
 s_mul_i32 s21, s20, 320
 s_add_u32 s21, s21, 256
 v_add_u32 v22, s21, v1
 v_mul_u32_u24 v23, v22, v29
 v_lshrrev_b32 v23, 16, v23
 v_mul_u32_u24 v24, 20, v23
 v_sub_u32 v22, v22, v24
 v_bfe_u32 v24, v23, 3, 1
 v_lshlrev_b32 v24, 1, v24
 v_xor_b32 v22, v22, v24
 v_mul_u32_u24 v23, 1280, v23
 v_lshl_add_u32 v12, v22, 4, v23
 s_and_b32 s44, s2, 3
 s_mul_i32 s45, s44, 320
 s_mul_i32 s46, s20, 5120
 v_and_b32 v22, 1, v2
 v_mul_u32_u24 v22, 16512, v22
 v_mul_u32_u24 v23, 33024, v3
 v_lshrrev_b32 v24, 1, v2
 v_lshlrev_b32 v24, 4, v24
 v_add3_u32 v6, v22, v23, v24
 s_lshr_b32 s47, s2, 2
 s_lshl_b32 s47, s47, 2
 s_add_u32 s47, s47, s20
 s_lshl_b32 s47, s47, 1
 s_lshl_b32 s48, s47, 7
 v_lshrrev_b32 v22, 2, v2
 v_lshl_add_u32 v22, v3, 3, v22
 v_mul_u32_u24 v22, 320, v22
 v_and_b32 v23, 3, v2
 v_lshl_add_u32 v22, v23, 3, v22
 v_and_b32 v23, 1, v3
 v_lshlrev_b32 v23, 5, v23
 v_add_u32 v14, v22, v23
 v_sub_u32 v15, v22, v23
 v_add_u32 v16, 61440, v14
 v_add_u32 v17, 61440, v15
 v_add_u32 v18, 122880, v14
 v_add_u32 v19, 122880, v15
 s_add_u32 m0, s46, 0
 s_add_u32 s49, s45, 0
 s_nop 0
 buffer_load_dwordx4 v8, s[24:27], s49 offen lds
 s_add_u32 m0, s46, 1024
 s_nop 0
 buffer_load_dwordx4 v9, s[24:27], s49 offen lds
 s_add_u32 m0, s46, 2048
 s_nop 0
 buffer_load_dwordx4 v10, s[24:27], s49 offen lds
 s_add_u32 m0, s46, 3072
 s_nop 0
 buffer_load_dwordx4 v11, s[24:27], s49 offen lds
 s_add_u32 m0, s46, 4096
 s_nop 0
 buffer_load_dwordx4 v12, s[24:27], s49 offen lds
 s_add_u32 m0, s46, 20480
 s_add_u32 s49, s45, 81920
 s_nop 0
 buffer_load_dwordx4 v8, s[24:27], s49 offen lds
 s_add_u32 m0, s46, 21504
 s_nop 0
 buffer_load_dwordx4 v9, s[24:27], s49 offen lds
 s_add_u32 m0, s46, 22528
 s_nop 0
 buffer_load_dwordx4 v10, s[24:27], s49 offen lds
 s_add_u32 m0, s46, 23552
 s_nop 0
 buffer_load_dwordx4 v11, s[24:27], s49 offen lds
 s_add_u32 m0, s46, 24576
 s_nop 0
 buffer_load_dwordx4 v12, s[24:27], s49 offen lds
 s_waitcnt vmcnt(10)
 v_readfirstlane_b32 s21, v21
 s_cmp_ge_u32 s21, 32
 s_cbranch_scc1 o2_229
 s_mov_b32 s21, 90112
 v_mov_b32 v20, 0
 s_mov_b32 s101, 0
wf_230:
 buffer_load_dword v21, v20, s[72:75], s21 offen sc1
 s_add_u32 s101, s101, 1
 s_cmp_gt_u32 s101, 131072
 s_cbranch_scc1 main_end
 s_waitcnt vmcnt(0)
 v_readfirstlane_b32 s100, v21
 s_cmp_ge_u32 s100, 32
 s_cbranch_scc1 wf_231
 s_sleep 32
 s_branch wf_230
wf_231:
o2_229:
 buffer_load_dwordx4 a[0:3], v6, s[16:19], s48 offen offset:0 sc1
 buffer_load_dwordx4 a[4:7], v6, s[16:19], s48 offen offset:128 sc1
 s_add_u32 s48, s48, 132096
 buffer_load_dwordx4 a[8:11], v6, s[16:19], s48 offen offset:0 sc1
 buffer_load_dwordx4 a[12:15], v6, s[16:19], s48 offen offset:128 sc1
 s_add_u32 s48, s48, 132096
 buffer_load_dwordx4 a[16:19], v6, s[16:19], s48 offen offset:0 sc1
 buffer_load_dwordx4 a[20:23], v6, s[16:19], s48 offen offset:128 sc1
 s_add_u32 s48, s48, 132096
 buffer_load_dwordx4 a[24:27], v6, s[16:19], s48 offen offset:0 sc1
 buffer_load_dwordx4 a[28:31], v6, s[16:19], s48 offen offset:128 sc1
 s_add_u32 s48, s48, 132096
 s_add_u32 m0, s46, 40960
 s_add_u32 s49, s45, 163840
 s_nop 0
 buffer_load_dwordx4 v8, s[24:27], s49 offen lds
 s_add_u32 m0, s46, 41984
 s_nop 0
 buffer_load_dwordx4 v9, s[24:27], s49 offen lds
 s_add_u32 m0, s46, 43008
 s_nop 0
 buffer_load_dwordx4 v10, s[24:27], s49 offen lds
 s_add_u32 m0, s46, 44032
 s_nop 0
 buffer_load_dwordx4 v11, s[24:27], s49 offen lds
 s_add_u32 m0, s46, 45056
 s_nop 0
 buffer_load_dwordx4 v12, s[24:27], s49 offen lds
 buffer_load_dwordx4 a[32:35], v6, s[16:19], s48 offen offset:0 sc1
 buffer_load_dwordx4 a[36:39], v6, s[16:19], s48 offen offset:128 sc1
 s_add_u32 s48, s48, 132096
 buffer_load_dwordx4 a[40:43], v6, s[16:19], s48 offen offset:0 sc1
 buffer_load_dwordx4 a[44:47], v6, s[16:19], s48 offen offset:128 sc1
 s_add_u32 s48, s48, 132096
 s_add_u32 m0, s46, 61440
 s_add_u32 s49, s45, 245760
 s_nop 0
 buffer_load_dwordx4 v8, s[24:27], s49 offen lds
 s_add_u32 m0, s46, 62464
 s_nop 0
 buffer_load_dwordx4 v9, s[24:27], s49 offen lds
 s_add_u32 m0, s46, 63488
 s_nop 0
 buffer_load_dwordx4 v10, s[24:27], s49 offen lds
 s_add_u32 m0, s46, 64512
 s_nop 0
 buffer_load_dwordx4 v11, s[24:27], s49 offen lds
 s_add_u32 m0, s46, 65536
 s_nop 0
 buffer_load_dwordx4 v12, s[24:27], s49 offen lds
 buffer_load_dwordx4 a[48:51], v6, s[16:19], s48 offen offset:0 sc1
 buffer_load_dwordx4 a[52:55], v6, s[16:19], s48 offen offset:128 sc1
 s_add_u32 s48, s48, 132096
 buffer_load_dwordx4 a[56:59], v6, s[16:19], s48 offen offset:0 sc1
 buffer_load_dwordx4 a[60:63], v6, s[16:19], s48 offen offset:128 sc1
 s_add_u32 s48, s48, 132096
 s_add_u32 m0, s46, 81920
 s_add_u32 s49, s45, 327680
 s_nop 0
 buffer_load_dwordx4 v8, s[24:27], s49 offen lds
 s_add_u32 m0, s46, 82944
 s_nop 0
 buffer_load_dwordx4 v9, s[24:27], s49 offen lds
 s_add_u32 m0, s46, 83968
 s_nop 0
 buffer_load_dwordx4 v10, s[24:27], s49 offen lds
 s_add_u32 m0, s46, 84992
 s_nop 0
 buffer_load_dwordx4 v11, s[24:27], s49 offen lds
 s_add_u32 m0, s46, 86016
 s_nop 0
 buffer_load_dwordx4 v12, s[24:27], s49 offen lds
 buffer_load_dwordx4 a[64:67], v6, s[16:19], s48 offen offset:0 sc1
 buffer_load_dwordx4 a[68:71], v6, s[16:19], s48 offen offset:128 sc1
 s_add_u32 s48, s48, 132096
 buffer_load_dwordx4 a[72:75], v6, s[16:19], s48 offen offset:0 sc1
 buffer_load_dwordx4 a[76:79], v6, s[16:19], s48 offen offset:128 sc1
 s_add_u32 s48, s48, 132096
 s_add_u32 m0, s46, 102400
 s_add_u32 s49, s45, 409600
 s_nop 0
 buffer_load_dwordx4 v8, s[24:27], s49 offen lds
 s_add_u32 m0, s46, 103424
 s_nop 0
 buffer_load_dwordx4 v9, s[24:27], s49 offen lds
 s_add_u32 m0, s46, 104448
 s_nop 0
 buffer_load_dwordx4 v10, s[24:27], s49 offen lds
 s_add_u32 m0, s46, 105472
 s_nop 0
 buffer_load_dwordx4 v11, s[24:27], s49 offen lds
 s_add_u32 m0, s46, 106496
 s_nop 0
 buffer_load_dwordx4 v12, s[24:27], s49 offen lds
 s_add_u32 m0, s46, 122880
 s_add_u32 s49, s45, 491520
 s_nop 0
 buffer_load_dwordx4 v8, s[24:27], s49 offen lds
 s_add_u32 m0, s46, 123904
 s_nop 0
 buffer_load_dwordx4 v9, s[24:27], s49 offen lds
 s_add_u32 m0, s46, 124928
 s_nop 0
 buffer_load_dwordx4 v10, s[24:27], s49 offen lds
 s_add_u32 m0, s46, 125952
 s_nop 0
 buffer_load_dwordx4 v11, s[24:27], s49 offen lds
 s_add_u32 m0, s46, 126976
 s_nop 0
 buffer_load_dwordx4 v12, s[24:27], s49 offen lds
 s_waitcnt vmcnt(50)
 s_barrier
 ds_read_b64_tr_b16 v[144:145], v14 offset:0
 ds_read_b64_tr_b16 v[146:147], v14 offset:1280
 ds_read_b64_tr_b16 v[148:149], v15 offset:32
 ds_read_b64_tr_b16 v[150:151], v15 offset:1312
 ds_read_b64_tr_b16 v[152:153], v14 offset:64
 ds_read_b64_tr_b16 v[154:155], v14 offset:1344
 ds_read_b64_tr_b16 v[156:157], v15 offset:96
 ds_read_b64_tr_b16 v[158:159], v15 offset:1376
 ds_read_b64_tr_b16 v[160:161], v14 offset:128
 ds_read_b64_tr_b16 v[162:163], v14 offset:1408
 ds_read_b64_tr_b16 v[164:165], v15 offset:160
 ds_read_b64_tr_b16 v[166:167], v15 offset:1440
 ds_read_b64_tr_b16 v[168:169], v14 offset:192
 ds_read_b64_tr_b16 v[170:171], v14 offset:1472
 ds_read_b64_tr_b16 v[172:173], v15 offset:224
 ds_read_b64_tr_b16 v[174:175], v15 offset:1504
 ds_read_b64_tr_b16 v[176:177], v14 offset:256
 ds_read_b64_tr_b16 v[178:179], v14 offset:1536
 ds_read_b64_tr_b16 v[180:181], v15 offset:288
 ds_read_b64_tr_b16 v[182:183], v15 offset:1568
 s_waitcnt lgkmcnt(0) vmcnt(43)
 v_mfma_f32_16x16x32_bf16 v[64:67], v[144:147], a[0:3], 0
 ds_read_b64_tr_b16 v[184:185], v14 offset:10240
 ds_read_b64_tr_b16 v[186:187], v14 offset:11520
 v_mfma_f32_16x16x32_bf16 v[104:107], v[144:147], a[4:7], 0
 ds_read_b64_tr_b16 v[188:189], v15 offset:10272
 v_mfma_f32_16x16x32_bf16 v[68:71], v[148:151], a[0:3], 0
 ds_read_b64_tr_b16 v[190:191], v15 offset:11552
 v_mfma_f32_16x16x32_bf16 v[108:111], v[148:151], a[4:7], 0
 ds_read_b64_tr_b16 v[192:193], v14 offset:10304
 v_mfma_f32_16x16x32_bf16 v[72:75], v[152:155], a[0:3], 0
 ds_read_b64_tr_b16 v[194:195], v14 offset:11584
 v_mfma_f32_16x16x32_bf16 v[112:115], v[152:155], a[4:7], 0
 ds_read_b64_tr_b16 v[196:197], v15 offset:10336
 ds_read_b64_tr_b16 v[198:199], v15 offset:11616
 v_mfma_f32_16x16x32_bf16 v[76:79], v[156:159], a[0:3], 0
 ds_read_b64_tr_b16 v[200:201], v14 offset:10368
 v_mfma_f32_16x16x32_bf16 v[116:119], v[156:159], a[4:7], 0
 ds_read_b64_tr_b16 v[202:203], v14 offset:11648
 v_mfma_f32_16x16x32_bf16 v[80:83], v[160:163], a[0:3], 0
 ds_read_b64_tr_b16 v[204:205], v15 offset:10400
 v_mfma_f32_16x16x32_bf16 v[120:123], v[160:163], a[4:7], 0
 ds_read_b64_tr_b16 v[206:207], v15 offset:11680
 v_mfma_f32_16x16x32_bf16 v[84:87], v[164:167], a[0:3], 0
 ds_read_b64_tr_b16 v[208:209], v14 offset:10432
 v_mfma_f32_16x16x32_bf16 v[124:127], v[164:167], a[4:7], 0
 ds_read_b64_tr_b16 v[210:211], v14 offset:11712
 ds_read_b64_tr_b16 v[212:213], v15 offset:10464
 v_mfma_f32_16x16x32_bf16 v[88:91], v[168:171], a[0:3], 0
 ds_read_b64_tr_b16 v[214:215], v15 offset:11744
 v_mfma_f32_16x16x32_bf16 v[128:131], v[168:171], a[4:7], 0
 buffer_load_dwordx4 a[80:83], v6, s[16:19], s48 offen offset:0 sc1
 ds_read_b64_tr_b16 v[216:217], v14 offset:10496
 v_mfma_f32_16x16x32_bf16 v[92:95], v[172:175], a[0:3], 0
 ds_read_b64_tr_b16 v[218:219], v14 offset:11776
 v_mfma_f32_16x16x32_bf16 v[132:135], v[172:175], a[4:7], 0
 ds_read_b64_tr_b16 v[220:221], v15 offset:10528
 v_mfma_f32_16x16x32_bf16 v[96:99], v[176:179], a[0:3], 0
 ds_read_b64_tr_b16 v[222:223], v15 offset:11808
 v_mfma_f32_16x16x32_bf16 v[136:139], v[176:179], a[4:7], 0
 buffer_load_dwordx4 a[84:87], v6, s[16:19], s48 offen offset:128 sc1
 v_mfma_f32_16x16x32_bf16 v[100:103], v[180:183], a[0:3], 0
 s_add_u32 s48, s48, 132096
 v_mfma_f32_16x16x32_bf16 v[140:143], v[180:183], a[4:7], 0
 s_waitcnt lgkmcnt(0) vmcnt(43)
 s_barrier
 v_mfma_f32_16x16x32_bf16 v[64:67], v[184:187], a[8:11], v[64:67]
 s_add_u32 m0, s46, 0
 ds_read_b64_tr_b16 v[144:145], v14 offset:20480
 ds_read_b64_tr_b16 v[146:147], v14 offset:21760
 v_mfma_f32_16x16x32_bf16 v[104:107], v[184:187], a[12:15], v[104:107]
 s_add_u32 s49, s45, 573440
 ds_read_b64_tr_b16 v[148:149], v15 offset:20512
 v_mfma_f32_16x16x32_bf16 v[68:71], v[188:191], a[8:11], v[68:71]
 buffer_load_dwordx4 v8, s[24:27], s49 offen lds
 ds_read_b64_tr_b16 v[150:151], v15 offset:21792
 v_mfma_f32_16x16x32_bf16 v[108:111], v[188:191], a[12:15], v[108:111]
 s_add_u32 m0, s46, 1024
 ds_read_b64_tr_b16 v[152:153], v14 offset:20544
 v_mfma_f32_16x16x32_bf16 v[72:75], v[192:195], a[8:11], v[72:75]
 buffer_load_dwordx4 v9, s[24:27], s49 offen lds
 ds_read_b64_tr_b16 v[154:155], v14 offset:21824
 v_mfma_f32_16x16x32_bf16 v[112:115], v[192:195], a[12:15], v[112:115]
 s_add_u32 m0, s46, 2048
 ds_read_b64_tr_b16 v[156:157], v15 offset:20576
 ds_read_b64_tr_b16 v[158:159], v15 offset:21856
 v_mfma_f32_16x16x32_bf16 v[76:79], v[196:199], a[8:11], v[76:79]
 buffer_load_dwordx4 v10, s[24:27], s49 offen lds
 ds_read_b64_tr_b16 v[160:161], v14 offset:20608
 v_mfma_f32_16x16x32_bf16 v[116:119], v[196:199], a[12:15], v[116:119]
 s_add_u32 m0, s46, 3072
 ds_read_b64_tr_b16 v[162:163], v14 offset:21888
 v_mfma_f32_16x16x32_bf16 v[80:83], v[200:203], a[8:11], v[80:83]
 buffer_load_dwordx4 v11, s[24:27], s49 offen lds
 ds_read_b64_tr_b16 v[164:165], v15 offset:20640
 v_mfma_f32_16x16x32_bf16 v[120:123], v[200:203], a[12:15], v[120:123]
 s_add_u32 m0, s46, 4096
 ds_read_b64_tr_b16 v[166:167], v15 offset:21920
 v_mfma_f32_16x16x32_bf16 v[84:87], v[204:207], a[8:11], v[84:87]
 buffer_load_dwordx4 v12, s[24:27], s49 offen lds
 ds_read_b64_tr_b16 v[168:169], v14 offset:20672
 v_mfma_f32_16x16x32_bf16 v[124:127], v[204:207], a[12:15], v[124:127]
 ds_read_b64_tr_b16 v[170:171], v14 offset:21952
 ds_read_b64_tr_b16 v[172:173], v15 offset:20704
 v_mfma_f32_16x16x32_bf16 v[88:91], v[208:211], a[8:11], v[88:91]
 ds_read_b64_tr_b16 v[174:175], v15 offset:21984
 v_mfma_f32_16x16x32_bf16 v[128:131], v[208:211], a[12:15], v[128:131]
 buffer_load_dwordx4 a[88:91], v6, s[16:19], s48 offen offset:0 sc1
 ds_read_b64_tr_b16 v[176:177], v14 offset:20736
 v_mfma_f32_16x16x32_bf16 v[92:95], v[212:215], a[8:11], v[92:95]
 ds_read_b64_tr_b16 v[178:179], v14 offset:22016
 v_mfma_f32_16x16x32_bf16 v[132:135], v[212:215], a[12:15], v[132:135]
 ds_read_b64_tr_b16 v[180:181], v15 offset:20768
 v_mfma_f32_16x16x32_bf16 v[96:99], v[216:219], a[8:11], v[96:99]
 ds_read_b64_tr_b16 v[182:183], v15 offset:22048
 v_mfma_f32_16x16x32_bf16 v[136:139], v[216:219], a[12:15], v[136:139]
 buffer_load_dwordx4 a[92:95], v6, s[16:19], s48 offen offset:128 sc1
 v_mfma_f32_16x16x32_bf16 v[100:103], v[220:223], a[8:11], v[100:103]
 s_add_u32 s48, s48, 132096
 v_mfma_f32_16x16x32_bf16 v[140:143], v[220:223], a[12:15], v[140:143]
 s_waitcnt lgkmcnt(0) vmcnt(48)
 v_mfma_f32_16x16x32_bf16 v[64:67], v[144:147], a[16:19], v[64:67]
 ds_read_b64_tr_b16 v[184:185], v14 offset:30720
 ds_read_b64_tr_b16 v[186:187], v14 offset:32000
 v_mfma_f32_16x16x32_bf16 v[104:107], v[144:147], a[20:23], v[104:107]
 ds_read_b64_tr_b16 v[188:189], v15 offset:30752
 v_mfma_f32_16x16x32_bf16 v[68:71], v[148:151], a[16:19], v[68:71]
 ds_read_b64_tr_b16 v[190:191], v15 offset:32032
 v_mfma_f32_16x16x32_bf16 v[108:111], v[148:151], a[20:23], v[108:111]
 ds_read_b64_tr_b16 v[192:193], v14 offset:30784
 v_mfma_f32_16x16x32_bf16 v[72:75], v[152:155], a[16:19], v[72:75]
 ds_read_b64_tr_b16 v[194:195], v14 offset:32064
 v_mfma_f32_16x16x32_bf16 v[112:115], v[152:155], a[20:23], v[112:115]
 ds_read_b64_tr_b16 v[196:197], v15 offset:30816
 ds_read_b64_tr_b16 v[198:199], v15 offset:32096
 v_mfma_f32_16x16x32_bf16 v[76:79], v[156:159], a[16:19], v[76:79]
 ds_read_b64_tr_b16 v[200:201], v14 offset:30848
 v_mfma_f32_16x16x32_bf16 v[116:119], v[156:159], a[20:23], v[116:119]
 ds_read_b64_tr_b16 v[202:203], v14 offset:32128
 v_mfma_f32_16x16x32_bf16 v[80:83], v[160:163], a[16:19], v[80:83]
 ds_read_b64_tr_b16 v[204:205], v15 offset:30880
 v_mfma_f32_16x16x32_bf16 v[120:123], v[160:163], a[20:23], v[120:123]
 ds_read_b64_tr_b16 v[206:207], v15 offset:32160
 v_mfma_f32_16x16x32_bf16 v[84:87], v[164:167], a[16:19], v[84:87]
 ds_read_b64_tr_b16 v[208:209], v14 offset:30912
 v_mfma_f32_16x16x32_bf16 v[124:127], v[164:167], a[20:23], v[124:127]
 ds_read_b64_tr_b16 v[210:211], v14 offset:32192
 ds_read_b64_tr_b16 v[212:213], v15 offset:30944
 v_mfma_f32_16x16x32_bf16 v[88:91], v[168:171], a[16:19], v[88:91]
 ds_read_b64_tr_b16 v[214:215], v15 offset:32224
 v_mfma_f32_16x16x32_bf16 v[128:131], v[168:171], a[20:23], v[128:131]
 buffer_load_dwordx4 a[96:99], v6, s[16:19], s48 offen offset:0 sc1
 ds_read_b64_tr_b16 v[216:217], v14 offset:30976
 v_mfma_f32_16x16x32_bf16 v[92:95], v[172:175], a[16:19], v[92:95]
 ds_read_b64_tr_b16 v[218:219], v14 offset:32256
 v_mfma_f32_16x16x32_bf16 v[132:135], v[172:175], a[20:23], v[132:135]
 ds_read_b64_tr_b16 v[220:221], v15 offset:31008
 v_mfma_f32_16x16x32_bf16 v[96:99], v[176:179], a[16:19], v[96:99]
 ds_read_b64_tr_b16 v[222:223], v15 offset:32288
 v_mfma_f32_16x16x32_bf16 v[136:139], v[176:179], a[20:23], v[136:139]
 buffer_load_dwordx4 a[100:103], v6, s[16:19], s48 offen offset:128 sc1
 v_mfma_f32_16x16x32_bf16 v[100:103], v[180:183], a[16:19], v[100:103]
 s_add_u32 s48, s48, 132096
 v_mfma_f32_16x16x32_bf16 v[140:143], v[180:183], a[20:23], v[140:143]
 s_waitcnt lgkmcnt(0) vmcnt(43)
 s_barrier
 v_mfma_f32_16x16x32_bf16 v[64:67], v[184:187], a[24:27], v[64:67]
 s_add_u32 m0, s46, 20480
 ds_read_b64_tr_b16 v[144:145], v14 offset:40960
 ds_read_b64_tr_b16 v[146:147], v14 offset:42240
 v_mfma_f32_16x16x32_bf16 v[104:107], v[184:187], a[28:31], v[104:107]
 s_add_u32 s49, s45, 655360
 ds_read_b64_tr_b16 v[148:149], v15 offset:40992
 v_mfma_f32_16x16x32_bf16 v[68:71], v[188:191], a[24:27], v[68:71]
 buffer_load_dwordx4 v8, s[24:27], s49 offen lds
 ds_read_b64_tr_b16 v[150:151], v15 offset:42272
 v_mfma_f32_16x16x32_bf16 v[108:111], v[188:191], a[28:31], v[108:111]
 s_add_u32 m0, s46, 21504
 ds_read_b64_tr_b16 v[152:153], v14 offset:41024
 v_mfma_f32_16x16x32_bf16 v[72:75], v[192:195], a[24:27], v[72:75]
 buffer_load_dwordx4 v9, s[24:27], s49 offen lds
 ds_read_b64_tr_b16 v[154:155], v14 offset:42304
 v_mfma_f32_16x16x32_bf16 v[112:115], v[192:195], a[28:31], v[112:115]
 s_add_u32 m0, s46, 22528
 ds_read_b64_tr_b16 v[156:157], v15 offset:41056
 ds_read_b64_tr_b16 v[158:159], v15 offset:42336
 v_mfma_f32_16x16x32_bf16 v[76:79], v[196:199], a[24:27], v[76:79]
 buffer_load_dwordx4 v10, s[24:27], s49 offen lds
 ds_read_b64_tr_b16 v[160:161], v14 offset:41088
 v_mfma_f32_16x16x32_bf16 v[116:119], v[196:199], a[28:31], v[116:119]
 s_add_u32 m0, s46, 23552
 ds_read_b64_tr_b16 v[162:163], v14 offset:42368
 v_mfma_f32_16x16x32_bf16 v[80:83], v[200:203], a[24:27], v[80:83]
 buffer_load_dwordx4 v11, s[24:27], s49 offen lds
 ds_read_b64_tr_b16 v[164:165], v15 offset:41120
 v_mfma_f32_16x16x32_bf16 v[120:123], v[200:203], a[28:31], v[120:123]
 s_add_u32 m0, s46, 24576
 ds_read_b64_tr_b16 v[166:167], v15 offset:42400
 v_mfma_f32_16x16x32_bf16 v[84:87], v[204:207], a[24:27], v[84:87]
 buffer_load_dwordx4 v12, s[24:27], s49 offen lds
 ds_read_b64_tr_b16 v[168:169], v14 offset:41152
 v_mfma_f32_16x16x32_bf16 v[124:127], v[204:207], a[28:31], v[124:127]
 ds_read_b64_tr_b16 v[170:171], v14 offset:42432
 ds_read_b64_tr_b16 v[172:173], v15 offset:41184
 v_mfma_f32_16x16x32_bf16 v[88:91], v[208:211], a[24:27], v[88:91]
 ds_read_b64_tr_b16 v[174:175], v15 offset:42464
 v_mfma_f32_16x16x32_bf16 v[128:131], v[208:211], a[28:31], v[128:131]
 buffer_load_dwordx4 a[104:107], v6, s[16:19], s48 offen offset:0 sc1
 ds_read_b64_tr_b16 v[176:177], v14 offset:41216
 v_mfma_f32_16x16x32_bf16 v[92:95], v[212:215], a[24:27], v[92:95]
 ds_read_b64_tr_b16 v[178:179], v14 offset:42496
 v_mfma_f32_16x16x32_bf16 v[132:135], v[212:215], a[28:31], v[132:135]
 ds_read_b64_tr_b16 v[180:181], v15 offset:41248
 v_mfma_f32_16x16x32_bf16 v[96:99], v[216:219], a[24:27], v[96:99]
 ds_read_b64_tr_b16 v[182:183], v15 offset:42528
 v_mfma_f32_16x16x32_bf16 v[136:139], v[216:219], a[28:31], v[136:139]
 buffer_load_dwordx4 a[108:111], v6, s[16:19], s48 offen offset:128 sc1
 v_mfma_f32_16x16x32_bf16 v[100:103], v[220:223], a[24:27], v[100:103]
 s_add_u32 s48, s48, 132096
 v_mfma_f32_16x16x32_bf16 v[140:143], v[220:223], a[28:31], v[140:143]
 s_waitcnt lgkmcnt(0) vmcnt(48)
 v_mfma_f32_16x16x32_bf16 v[64:67], v[144:147], a[32:35], v[64:67]
 ds_read_b64_tr_b16 v[184:185], v14 offset:51200
 ds_read_b64_tr_b16 v[186:187], v14 offset:52480
 v_mfma_f32_16x16x32_bf16 v[104:107], v[144:147], a[36:39], v[104:107]
 ds_read_b64_tr_b16 v[188:189], v15 offset:51232
 v_mfma_f32_16x16x32_bf16 v[68:71], v[148:151], a[32:35], v[68:71]
 ds_read_b64_tr_b16 v[190:191], v15 offset:52512
 v_mfma_f32_16x16x32_bf16 v[108:111], v[148:151], a[36:39], v[108:111]
 ds_read_b64_tr_b16 v[192:193], v14 offset:51264
 v_mfma_f32_16x16x32_bf16 v[72:75], v[152:155], a[32:35], v[72:75]
 ds_read_b64_tr_b16 v[194:195], v14 offset:52544
 v_mfma_f32_16x16x32_bf16 v[112:115], v[152:155], a[36:39], v[112:115]
 ds_read_b64_tr_b16 v[196:197], v15 offset:51296
 ds_read_b64_tr_b16 v[198:199], v15 offset:52576
 v_mfma_f32_16x16x32_bf16 v[76:79], v[156:159], a[32:35], v[76:79]
 ds_read_b64_tr_b16 v[200:201], v14 offset:51328
 v_mfma_f32_16x16x32_bf16 v[116:119], v[156:159], a[36:39], v[116:119]
 ds_read_b64_tr_b16 v[202:203], v14 offset:52608
 v_mfma_f32_16x16x32_bf16 v[80:83], v[160:163], a[32:35], v[80:83]
 ds_read_b64_tr_b16 v[204:205], v15 offset:51360
 v_mfma_f32_16x16x32_bf16 v[120:123], v[160:163], a[36:39], v[120:123]
 ds_read_b64_tr_b16 v[206:207], v15 offset:52640
 v_mfma_f32_16x16x32_bf16 v[84:87], v[164:167], a[32:35], v[84:87]
 ds_read_b64_tr_b16 v[208:209], v14 offset:51392
 v_mfma_f32_16x16x32_bf16 v[124:127], v[164:167], a[36:39], v[124:127]
 ds_read_b64_tr_b16 v[210:211], v14 offset:52672
 ds_read_b64_tr_b16 v[212:213], v15 offset:51424
 v_mfma_f32_16x16x32_bf16 v[88:91], v[168:171], a[32:35], v[88:91]
 ds_read_b64_tr_b16 v[214:215], v15 offset:52704
 v_mfma_f32_16x16x32_bf16 v[128:131], v[168:171], a[36:39], v[128:131]
 buffer_load_dwordx4 a[112:115], v6, s[16:19], s48 offen offset:0 sc1
 ds_read_b64_tr_b16 v[216:217], v14 offset:51456
 v_mfma_f32_16x16x32_bf16 v[92:95], v[172:175], a[32:35], v[92:95]
 ds_read_b64_tr_b16 v[218:219], v14 offset:52736
 v_mfma_f32_16x16x32_bf16 v[132:135], v[172:175], a[36:39], v[132:135]
 ds_read_b64_tr_b16 v[220:221], v15 offset:51488
 v_mfma_f32_16x16x32_bf16 v[96:99], v[176:179], a[32:35], v[96:99]
 ds_read_b64_tr_b16 v[222:223], v15 offset:52768
 v_mfma_f32_16x16x32_bf16 v[136:139], v[176:179], a[36:39], v[136:139]
 buffer_load_dwordx4 a[116:119], v6, s[16:19], s48 offen offset:128 sc1
 v_mfma_f32_16x16x32_bf16 v[100:103], v[180:183], a[32:35], v[100:103]
 s_add_u32 s48, s48, 132096
 v_mfma_f32_16x16x32_bf16 v[140:143], v[180:183], a[36:39], v[140:143]
 s_waitcnt lgkmcnt(0) vmcnt(43)
 s_barrier
 v_mfma_f32_16x16x32_bf16 v[64:67], v[184:187], a[40:43], v[64:67]
 s_add_u32 m0, s46, 40960
 ds_read_b64_tr_b16 v[144:145], v16 offset:0
 ds_read_b64_tr_b16 v[146:147], v16 offset:1280
 v_mfma_f32_16x16x32_bf16 v[104:107], v[184:187], a[44:47], v[104:107]
 s_add_u32 s49, s45, 737280
 ds_read_b64_tr_b16 v[148:149], v17 offset:32
 v_mfma_f32_16x16x32_bf16 v[68:71], v[188:191], a[40:43], v[68:71]
 buffer_load_dwordx4 v8, s[24:27], s49 offen lds
 ds_read_b64_tr_b16 v[150:151], v17 offset:1312
 v_mfma_f32_16x16x32_bf16 v[108:111], v[188:191], a[44:47], v[108:111]
 s_add_u32 m0, s46, 41984
 ds_read_b64_tr_b16 v[152:153], v16 offset:64
 v_mfma_f32_16x16x32_bf16 v[72:75], v[192:195], a[40:43], v[72:75]
 buffer_load_dwordx4 v9, s[24:27], s49 offen lds
 ds_read_b64_tr_b16 v[154:155], v16 offset:1344
 v_mfma_f32_16x16x32_bf16 v[112:115], v[192:195], a[44:47], v[112:115]
 s_add_u32 m0, s46, 43008
 ds_read_b64_tr_b16 v[156:157], v17 offset:96
 ds_read_b64_tr_b16 v[158:159], v17 offset:1376
 v_mfma_f32_16x16x32_bf16 v[76:79], v[196:199], a[40:43], v[76:79]
 buffer_load_dwordx4 v10, s[24:27], s49 offen lds
 ds_read_b64_tr_b16 v[160:161], v16 offset:128
 v_mfma_f32_16x16x32_bf16 v[116:119], v[196:199], a[44:47], v[116:119]
 s_add_u32 m0, s46, 44032
 ds_read_b64_tr_b16 v[162:163], v16 offset:1408
 v_mfma_f32_16x16x32_bf16 v[80:83], v[200:203], a[40:43], v[80:83]
 buffer_load_dwordx4 v11, s[24:27], s49 offen lds
 ds_read_b64_tr_b16 v[164:165], v17 offset:160
 v_mfma_f32_16x16x32_bf16 v[120:123], v[200:203], a[44:47], v[120:123]
 s_add_u32 m0, s46, 45056
 ds_read_b64_tr_b16 v[166:167], v17 offset:1440
 v_mfma_f32_16x16x32_bf16 v[84:87], v[204:207], a[40:43], v[84:87]
 buffer_load_dwordx4 v12, s[24:27], s49 offen lds
 ds_read_b64_tr_b16 v[168:169], v16 offset:192
 v_mfma_f32_16x16x32_bf16 v[124:127], v[204:207], a[44:47], v[124:127]
 ds_read_b64_tr_b16 v[170:171], v16 offset:1472
 ds_read_b64_tr_b16 v[172:173], v17 offset:224
 v_mfma_f32_16x16x32_bf16 v[88:91], v[208:211], a[40:43], v[88:91]
 ds_read_b64_tr_b16 v[174:175], v17 offset:1504
 v_mfma_f32_16x16x32_bf16 v[128:131], v[208:211], a[44:47], v[128:131]
 buffer_load_dwordx4 a[120:123], v6, s[16:19], s48 offen offset:0 sc1
 ds_read_b64_tr_b16 v[176:177], v16 offset:256
 v_mfma_f32_16x16x32_bf16 v[92:95], v[212:215], a[40:43], v[92:95]
 ds_read_b64_tr_b16 v[178:179], v16 offset:1536
 v_mfma_f32_16x16x32_bf16 v[132:135], v[212:215], a[44:47], v[132:135]
 ds_read_b64_tr_b16 v[180:181], v17 offset:288
 v_mfma_f32_16x16x32_bf16 v[96:99], v[216:219], a[40:43], v[96:99]
 ds_read_b64_tr_b16 v[182:183], v17 offset:1568
 v_mfma_f32_16x16x32_bf16 v[136:139], v[216:219], a[44:47], v[136:139]
 buffer_load_dwordx4 a[124:127], v6, s[16:19], s48 offen offset:128 sc1
 v_mfma_f32_16x16x32_bf16 v[100:103], v[220:223], a[40:43], v[100:103]
 s_add_u32 s48, s48, 132096
 v_mfma_f32_16x16x32_bf16 v[140:143], v[220:223], a[44:47], v[140:143]
 s_waitcnt lgkmcnt(0) vmcnt(48)
 v_mfma_f32_16x16x32_bf16 v[64:67], v[144:147], a[48:51], v[64:67]
 ds_read_b64_tr_b16 v[184:185], v16 offset:10240
 ds_read_b64_tr_b16 v[186:187], v16 offset:11520
 v_mfma_f32_16x16x32_bf16 v[104:107], v[144:147], a[52:55], v[104:107]
 ds_read_b64_tr_b16 v[188:189], v17 offset:10272
 v_mfma_f32_16x16x32_bf16 v[68:71], v[148:151], a[48:51], v[68:71]
 ds_read_b64_tr_b16 v[190:191], v17 offset:11552
 v_mfma_f32_16x16x32_bf16 v[108:111], v[148:151], a[52:55], v[108:111]
 ds_read_b64_tr_b16 v[192:193], v16 offset:10304
 v_mfma_f32_16x16x32_bf16 v[72:75], v[152:155], a[48:51], v[72:75]
 ds_read_b64_tr_b16 v[194:195], v16 offset:11584
 v_mfma_f32_16x16x32_bf16 v[112:115], v[152:155], a[52:55], v[112:115]
 ds_read_b64_tr_b16 v[196:197], v17 offset:10336
 ds_read_b64_tr_b16 v[198:199], v17 offset:11616
 v_mfma_f32_16x16x32_bf16 v[76:79], v[156:159], a[48:51], v[76:79]
 ds_read_b64_tr_b16 v[200:201], v16 offset:10368
 v_mfma_f32_16x16x32_bf16 v[116:119], v[156:159], a[52:55], v[116:119]
 ds_read_b64_tr_b16 v[202:203], v16 offset:11648
 v_mfma_f32_16x16x32_bf16 v[80:83], v[160:163], a[48:51], v[80:83]
 ds_read_b64_tr_b16 v[204:205], v17 offset:10400
 v_mfma_f32_16x16x32_bf16 v[120:123], v[160:163], a[52:55], v[120:123]
 ds_read_b64_tr_b16 v[206:207], v17 offset:11680
 v_mfma_f32_16x16x32_bf16 v[84:87], v[164:167], a[48:51], v[84:87]
 ds_read_b64_tr_b16 v[208:209], v16 offset:10432
 v_mfma_f32_16x16x32_bf16 v[124:127], v[164:167], a[52:55], v[124:127]
 ds_read_b64_tr_b16 v[210:211], v16 offset:11712
 ds_read_b64_tr_b16 v[212:213], v17 offset:10464
 v_mfma_f32_16x16x32_bf16 v[88:91], v[168:171], a[48:51], v[88:91]
 ds_read_b64_tr_b16 v[214:215], v17 offset:11744
 v_mfma_f32_16x16x32_bf16 v[128:131], v[168:171], a[52:55], v[128:131]
 buffer_load_dwordx4 a[128:131], v6, s[16:19], s48 offen offset:0 sc1
 ds_read_b64_tr_b16 v[216:217], v16 offset:10496
 v_mfma_f32_16x16x32_bf16 v[92:95], v[172:175], a[48:51], v[92:95]
 ds_read_b64_tr_b16 v[218:219], v16 offset:11776
 v_mfma_f32_16x16x32_bf16 v[132:135], v[172:175], a[52:55], v[132:135]
 ds_read_b64_tr_b16 v[220:221], v17 offset:10528
 v_mfma_f32_16x16x32_bf16 v[96:99], v[176:179], a[48:51], v[96:99]
 ds_read_b64_tr_b16 v[222:223], v17 offset:11808
 v_mfma_f32_16x16x32_bf16 v[136:139], v[176:179], a[52:55], v[136:139]
 buffer_load_dwordx4 a[132:135], v6, s[16:19], s48 offen offset:128 sc1
 v_mfma_f32_16x16x32_bf16 v[100:103], v[180:183], a[48:51], v[100:103]
 s_add_u32 s48, s48, 132096
 v_mfma_f32_16x16x32_bf16 v[140:143], v[180:183], a[52:55], v[140:143]
 s_waitcnt lgkmcnt(0) vmcnt(43)
 s_barrier
 v_mfma_f32_16x16x32_bf16 v[64:67], v[184:187], a[56:59], v[64:67]
 ds_read_b64_tr_b16 v[144:145], v16 offset:20480
 ds_read_b64_tr_b16 v[146:147], v16 offset:21760
 v_mfma_f32_16x16x32_bf16 v[104:107], v[184:187], a[60:63], v[104:107]
 ds_read_b64_tr_b16 v[148:149], v17 offset:20512
 v_mfma_f32_16x16x32_bf16 v[68:71], v[188:191], a[56:59], v[68:71]
 ds_read_b64_tr_b16 v[150:151], v17 offset:21792
 v_mfma_f32_16x16x32_bf16 v[108:111], v[188:191], a[60:63], v[108:111]
 ds_read_b64_tr_b16 v[152:153], v16 offset:20544
 v_mfma_f32_16x16x32_bf16 v[72:75], v[192:195], a[56:59], v[72:75]
 ds_read_b64_tr_b16 v[154:155], v16 offset:21824
 v_mfma_f32_16x16x32_bf16 v[112:115], v[192:195], a[60:63], v[112:115]
 ds_read_b64_tr_b16 v[156:157], v17 offset:20576
 ds_read_b64_tr_b16 v[158:159], v17 offset:21856
 v_mfma_f32_16x16x32_bf16 v[76:79], v[196:199], a[56:59], v[76:79]
 ds_read_b64_tr_b16 v[160:161], v16 offset:20608
 v_mfma_f32_16x16x32_bf16 v[116:119], v[196:199], a[60:63], v[116:119]
 ds_read_b64_tr_b16 v[162:163], v16 offset:21888
 v_mfma_f32_16x16x32_bf16 v[80:83], v[200:203], a[56:59], v[80:83]
 ds_read_b64_tr_b16 v[164:165], v17 offset:20640
 v_mfma_f32_16x16x32_bf16 v[120:123], v[200:203], a[60:63], v[120:123]
 ds_read_b64_tr_b16 v[166:167], v17 offset:21920
 v_mfma_f32_16x16x32_bf16 v[84:87], v[204:207], a[56:59], v[84:87]
 ds_read_b64_tr_b16 v[168:169], v16 offset:20672
 v_mfma_f32_16x16x32_bf16 v[124:127], v[204:207], a[60:63], v[124:127]
 ds_read_b64_tr_b16 v[170:171], v16 offset:21952
 ds_read_b64_tr_b16 v[172:173], v17 offset:20704
 v_mfma_f32_16x16x32_bf16 v[88:91], v[208:211], a[56:59], v[88:91]
 ds_read_b64_tr_b16 v[174:175], v17 offset:21984
 v_mfma_f32_16x16x32_bf16 v[128:131], v[208:211], a[60:63], v[128:131]
 buffer_load_dwordx4 a[136:139], v6, s[16:19], s48 offen offset:0 sc1
 ds_read_b64_tr_b16 v[176:177], v16 offset:20736
 v_mfma_f32_16x16x32_bf16 v[92:95], v[212:215], a[56:59], v[92:95]
 ds_read_b64_tr_b16 v[178:179], v16 offset:22016
 v_mfma_f32_16x16x32_bf16 v[132:135], v[212:215], a[60:63], v[132:135]
 ds_read_b64_tr_b16 v[180:181], v17 offset:20768
 v_mfma_f32_16x16x32_bf16 v[96:99], v[216:219], a[56:59], v[96:99]
 ds_read_b64_tr_b16 v[182:183], v17 offset:22048
 v_mfma_f32_16x16x32_bf16 v[136:139], v[216:219], a[60:63], v[136:139]
 buffer_load_dwordx4 a[140:143], v6, s[16:19], s48 offen offset:128 sc1
 v_mfma_f32_16x16x32_bf16 v[100:103], v[220:223], a[56:59], v[100:103]
 s_add_u32 s48, s48, 132096
 v_mfma_f32_16x16x32_bf16 v[140:143], v[220:223], a[60:63], v[140:143]
 s_waitcnt lgkmcnt(0) vmcnt(43)
 v_mfma_f32_16x16x32_bf16 v[64:67], v[144:147], a[64:67], v[64:67]
 ds_read_b64_tr_b16 v[184:185], v16 offset:30720
 ds_read_b64_tr_b16 v[186:187], v16 offset:32000
 v_mfma_f32_16x16x32_bf16 v[104:107], v[144:147], a[68:71], v[104:107]
 ds_read_b64_tr_b16 v[188:189], v17 offset:30752
 v_mfma_f32_16x16x32_bf16 v[68:71], v[148:151], a[64:67], v[68:71]
 ds_read_b64_tr_b16 v[190:191], v17 offset:32032
 v_mfma_f32_16x16x32_bf16 v[108:111], v[148:151], a[68:71], v[108:111]
 ds_read_b64_tr_b16 v[192:193], v16 offset:30784
 v_mfma_f32_16x16x32_bf16 v[72:75], v[152:155], a[64:67], v[72:75]
 ds_read_b64_tr_b16 v[194:195], v16 offset:32064
 v_mfma_f32_16x16x32_bf16 v[112:115], v[152:155], a[68:71], v[112:115]
 ds_read_b64_tr_b16 v[196:197], v17 offset:30816
 ds_read_b64_tr_b16 v[198:199], v17 offset:32096
 v_mfma_f32_16x16x32_bf16 v[76:79], v[156:159], a[64:67], v[76:79]
 ds_read_b64_tr_b16 v[200:201], v16 offset:30848
 v_mfma_f32_16x16x32_bf16 v[116:119], v[156:159], a[68:71], v[116:119]
 ds_read_b64_tr_b16 v[202:203], v16 offset:32128
 v_mfma_f32_16x16x32_bf16 v[80:83], v[160:163], a[64:67], v[80:83]
 ds_read_b64_tr_b16 v[204:205], v17 offset:30880
 v_mfma_f32_16x16x32_bf16 v[120:123], v[160:163], a[68:71], v[120:123]
 ds_read_b64_tr_b16 v[206:207], v17 offset:32160
 v_mfma_f32_16x16x32_bf16 v[84:87], v[164:167], a[64:67], v[84:87]
 ds_read_b64_tr_b16 v[208:209], v16 offset:30912
 v_mfma_f32_16x16x32_bf16 v[124:127], v[164:167], a[68:71], v[124:127]
 ds_read_b64_tr_b16 v[210:211], v16 offset:32192
 ds_read_b64_tr_b16 v[212:213], v17 offset:30944
 v_mfma_f32_16x16x32_bf16 v[88:91], v[168:171], a[64:67], v[88:91]
 ds_read_b64_tr_b16 v[214:215], v17 offset:32224
 v_mfma_f32_16x16x32_bf16 v[128:131], v[168:171], a[68:71], v[128:131]
 buffer_load_dwordx4 a[144:147], v6, s[16:19], s48 offen offset:0 sc1
 ds_read_b64_tr_b16 v[216:217], v16 offset:30976
 v_mfma_f32_16x16x32_bf16 v[92:95], v[172:175], a[64:67], v[92:95]
 ds_read_b64_tr_b16 v[218:219], v16 offset:32256
 v_mfma_f32_16x16x32_bf16 v[132:135], v[172:175], a[68:71], v[132:135]
 ds_read_b64_tr_b16 v[220:221], v17 offset:31008
 v_mfma_f32_16x16x32_bf16 v[96:99], v[176:179], a[64:67], v[96:99]
 ds_read_b64_tr_b16 v[222:223], v17 offset:32288
 v_mfma_f32_16x16x32_bf16 v[136:139], v[176:179], a[68:71], v[136:139]
 buffer_load_dwordx4 a[148:151], v6, s[16:19], s48 offen offset:128 sc1
 v_mfma_f32_16x16x32_bf16 v[100:103], v[180:183], a[64:67], v[100:103]
 s_add_u32 s48, s48, 132096
 v_mfma_f32_16x16x32_bf16 v[140:143], v[180:183], a[68:71], v[140:143]
 s_waitcnt lgkmcnt(0) vmcnt(38)
 s_barrier
 v_mfma_f32_16x16x32_bf16 v[64:67], v[184:187], a[72:75], v[64:67]
 ds_read_b64_tr_b16 v[144:145], v16 offset:40960
 ds_read_b64_tr_b16 v[146:147], v16 offset:42240
 v_mfma_f32_16x16x32_bf16 v[104:107], v[184:187], a[76:79], v[104:107]
 ds_read_b64_tr_b16 v[148:149], v17 offset:40992
 v_mfma_f32_16x16x32_bf16 v[68:71], v[188:191], a[72:75], v[68:71]
 ds_read_b64_tr_b16 v[150:151], v17 offset:42272
 v_mfma_f32_16x16x32_bf16 v[108:111], v[188:191], a[76:79], v[108:111]
 ds_read_b64_tr_b16 v[152:153], v16 offset:41024
 v_mfma_f32_16x16x32_bf16 v[72:75], v[192:195], a[72:75], v[72:75]
 ds_read_b64_tr_b16 v[154:155], v16 offset:42304
 v_mfma_f32_16x16x32_bf16 v[112:115], v[192:195], a[76:79], v[112:115]
 ds_read_b64_tr_b16 v[156:157], v17 offset:41056
 ds_read_b64_tr_b16 v[158:159], v17 offset:42336
 v_mfma_f32_16x16x32_bf16 v[76:79], v[196:199], a[72:75], v[76:79]
 ds_read_b64_tr_b16 v[160:161], v16 offset:41088
 v_mfma_f32_16x16x32_bf16 v[116:119], v[196:199], a[76:79], v[116:119]
 ds_read_b64_tr_b16 v[162:163], v16 offset:42368
 v_mfma_f32_16x16x32_bf16 v[80:83], v[200:203], a[72:75], v[80:83]
 ds_read_b64_tr_b16 v[164:165], v17 offset:41120
 v_mfma_f32_16x16x32_bf16 v[120:123], v[200:203], a[76:79], v[120:123]
 ds_read_b64_tr_b16 v[166:167], v17 offset:42400
 v_mfma_f32_16x16x32_bf16 v[84:87], v[204:207], a[72:75], v[84:87]
 ds_read_b64_tr_b16 v[168:169], v16 offset:41152
 v_mfma_f32_16x16x32_bf16 v[124:127], v[204:207], a[76:79], v[124:127]
 ds_read_b64_tr_b16 v[170:171], v16 offset:42432
 ds_read_b64_tr_b16 v[172:173], v17 offset:41184
 v_mfma_f32_16x16x32_bf16 v[88:91], v[208:211], a[72:75], v[88:91]
 ds_read_b64_tr_b16 v[174:175], v17 offset:42464
 v_mfma_f32_16x16x32_bf16 v[128:131], v[208:211], a[76:79], v[128:131]
 buffer_load_dwordx4 a[152:155], v6, s[16:19], s48 offen offset:0 sc1
 ds_read_b64_tr_b16 v[176:177], v16 offset:41216
 v_mfma_f32_16x16x32_bf16 v[92:95], v[212:215], a[72:75], v[92:95]
 ds_read_b64_tr_b16 v[178:179], v16 offset:42496
 v_mfma_f32_16x16x32_bf16 v[132:135], v[212:215], a[76:79], v[132:135]
 ds_read_b64_tr_b16 v[180:181], v17 offset:41248
 v_mfma_f32_16x16x32_bf16 v[96:99], v[216:219], a[72:75], v[96:99]
 ds_read_b64_tr_b16 v[182:183], v17 offset:42528
 v_mfma_f32_16x16x32_bf16 v[136:139], v[216:219], a[76:79], v[136:139]
 buffer_load_dwordx4 a[156:159], v6, s[16:19], s48 offen offset:128 sc1
 v_mfma_f32_16x16x32_bf16 v[100:103], v[220:223], a[72:75], v[100:103]
 s_add_u32 s48, s48, 132096
 v_mfma_f32_16x16x32_bf16 v[140:143], v[220:223], a[76:79], v[140:143]
 s_waitcnt lgkmcnt(0) vmcnt(33)
 v_mfma_f32_16x16x32_bf16 v[64:67], v[144:147], a[80:83], v[64:67]
 ds_read_b64_tr_b16 v[184:185], v16 offset:51200
 ds_read_b64_tr_b16 v[186:187], v16 offset:52480
 v_mfma_f32_16x16x32_bf16 v[104:107], v[144:147], a[84:87], v[104:107]
 ds_read_b64_tr_b16 v[188:189], v17 offset:51232
 v_mfma_f32_16x16x32_bf16 v[68:71], v[148:151], a[80:83], v[68:71]
 ds_read_b64_tr_b16 v[190:191], v17 offset:52512
 v_mfma_f32_16x16x32_bf16 v[108:111], v[148:151], a[84:87], v[108:111]
 ds_read_b64_tr_b16 v[192:193], v16 offset:51264
 v_mfma_f32_16x16x32_bf16 v[72:75], v[152:155], a[80:83], v[72:75]
 ds_read_b64_tr_b16 v[194:195], v16 offset:52544
 v_mfma_f32_16x16x32_bf16 v[112:115], v[152:155], a[84:87], v[112:115]
 ds_read_b64_tr_b16 v[196:197], v17 offset:51296
 ds_read_b64_tr_b16 v[198:199], v17 offset:52576
 v_mfma_f32_16x16x32_bf16 v[76:79], v[156:159], a[80:83], v[76:79]
 ds_read_b64_tr_b16 v[200:201], v16 offset:51328
 v_mfma_f32_16x16x32_bf16 v[116:119], v[156:159], a[84:87], v[116:119]
 ds_read_b64_tr_b16 v[202:203], v16 offset:52608
 v_mfma_f32_16x16x32_bf16 v[80:83], v[160:163], a[80:83], v[80:83]
 ds_read_b64_tr_b16 v[204:205], v17 offset:51360
 v_mfma_f32_16x16x32_bf16 v[120:123], v[160:163], a[84:87], v[120:123]
 ds_read_b64_tr_b16 v[206:207], v17 offset:52640
 v_mfma_f32_16x16x32_bf16 v[84:87], v[164:167], a[80:83], v[84:87]
 ds_read_b64_tr_b16 v[208:209], v16 offset:51392
 v_mfma_f32_16x16x32_bf16 v[124:127], v[164:167], a[84:87], v[124:127]
 ds_read_b64_tr_b16 v[210:211], v16 offset:52672
 ds_read_b64_tr_b16 v[212:213], v17 offset:51424
 v_mfma_f32_16x16x32_bf16 v[88:91], v[168:171], a[80:83], v[88:91]
 ds_read_b64_tr_b16 v[214:215], v17 offset:52704
 v_mfma_f32_16x16x32_bf16 v[128:131], v[168:171], a[84:87], v[128:131]
 buffer_load_dwordx4 v[52:55], v4, s[12:15], 0 offen
 ds_read_b64_tr_b16 v[216:217], v16 offset:51456
 v_mfma_f32_16x16x32_bf16 v[92:95], v[172:175], a[80:83], v[92:95]
 ds_read_b64_tr_b16 v[218:219], v16 offset:52736
 v_mfma_f32_16x16x32_bf16 v[132:135], v[172:175], a[84:87], v[132:135]
 ds_read_b64_tr_b16 v[220:221], v17 offset:51488
 v_mfma_f32_16x16x32_bf16 v[96:99], v[176:179], a[80:83], v[96:99]
 ds_read_b64_tr_b16 v[222:223], v17 offset:52768
 v_mfma_f32_16x16x32_bf16 v[136:139], v[176:179], a[84:87], v[136:139]
 buffer_load_dword v56, v5, s[12:15], 0 offen offset:1024
 v_mfma_f32_16x16x32_bf16 v[100:103], v[180:183], a[80:83], v[100:103]
 s_mul_i32 s50, s59, 1280
 v_mfma_f32_16x16x32_bf16 v[140:143], v[180:183], a[84:87], v[140:143]
 s_waitcnt lgkmcnt(0) vmcnt(28)
 s_barrier
 v_mfma_f32_16x16x32_bf16 v[64:67], v[184:187], a[88:91], v[64:67]
 ds_read_b64_tr_b16 v[144:145], v18 offset:0
 ds_read_b64_tr_b16 v[146:147], v18 offset:1280
 v_mfma_f32_16x16x32_bf16 v[104:107], v[184:187], a[92:95], v[104:107]
 ds_read_b64_tr_b16 v[148:149], v19 offset:32
 v_mfma_f32_16x16x32_bf16 v[68:71], v[188:191], a[88:91], v[68:71]
 ds_read_b64_tr_b16 v[150:151], v19 offset:1312
 v_mfma_f32_16x16x32_bf16 v[108:111], v[188:191], a[92:95], v[108:111]
 ds_read_b64_tr_b16 v[152:153], v18 offset:64
 v_mfma_f32_16x16x32_bf16 v[72:75], v[192:195], a[88:91], v[72:75]
 ds_read_b64_tr_b16 v[154:155], v18 offset:1344
 v_mfma_f32_16x16x32_bf16 v[112:115], v[192:195], a[92:95], v[112:115]
 ds_read_b64_tr_b16 v[156:157], v19 offset:96
 ds_read_b64_tr_b16 v[158:159], v19 offset:1376
 v_mfma_f32_16x16x32_bf16 v[76:79], v[196:199], a[88:91], v[76:79]
 ds_read_b64_tr_b16 v[160:161], v18 offset:128
 v_mfma_f32_16x16x32_bf16 v[116:119], v[196:199], a[92:95], v[116:119]
 ds_read_b64_tr_b16 v[162:163], v18 offset:1408
 v_mfma_f32_16x16x32_bf16 v[80:83], v[200:203], a[88:91], v[80:83]
 ds_read_b64_tr_b16 v[164:165], v19 offset:160
 v_mfma_f32_16x16x32_bf16 v[120:123], v[200:203], a[92:95], v[120:123]
 ds_read_b64_tr_b16 v[166:167], v19 offset:1440
 v_mfma_f32_16x16x32_bf16 v[84:87], v[204:207], a[88:91], v[84:87]
 ds_read_b64_tr_b16 v[168:169], v18 offset:192
 v_mfma_f32_16x16x32_bf16 v[124:127], v[204:207], a[92:95], v[124:127]
 ds_read_b64_tr_b16 v[170:171], v18 offset:1472
 ds_read_b64_tr_b16 v[172:173], v19 offset:224
 v_mfma_f32_16x16x32_bf16 v[88:91], v[208:211], a[88:91], v[88:91]
 ds_read_b64_tr_b16 v[174:175], v19 offset:1504
 v_mfma_f32_16x16x32_bf16 v[128:131], v[208:211], a[92:95], v[128:131]
 buffer_load_dwordx4 v[224:227], v4, s[8:11], s50 offen
 ds_read_b64_tr_b16 v[176:177], v18 offset:256
 v_mfma_f32_16x16x32_bf16 v[92:95], v[212:215], a[88:91], v[92:95]
 ds_read_b64_tr_b16 v[178:179], v18 offset:1536
 v_mfma_f32_16x16x32_bf16 v[132:135], v[212:215], a[92:95], v[132:135]
 ds_read_b64_tr_b16 v[180:181], v19 offset:288
 v_mfma_f32_16x16x32_bf16 v[96:99], v[216:219], a[88:91], v[96:99]
 ds_read_b64_tr_b16 v[182:183], v19 offset:1568
 v_mfma_f32_16x16x32_bf16 v[136:139], v[216:219], a[92:95], v[136:139]
 buffer_load_dword v228, v5, s[8:11], s50 offen offset:1024
 v_mfma_f32_16x16x32_bf16 v[100:103], v[220:223], a[88:91], v[100:103]
 s_add_u32 s50, s50, 1280
 v_mfma_f32_16x16x32_bf16 v[140:143], v[220:223], a[92:95], v[140:143]
 s_waitcnt lgkmcnt(0) vmcnt(28)
 v_mfma_f32_16x16x32_bf16 v[64:67], v[144:147], a[96:99], v[64:67]
 ds_read_b64_tr_b16 v[184:185], v18 offset:10240
 ds_read_b64_tr_b16 v[186:187], v18 offset:11520
 v_mfma_f32_16x16x32_bf16 v[104:107], v[144:147], a[100:103], v[104:107]
 ds_read_b64_tr_b16 v[188:189], v19 offset:10272
 v_mfma_f32_16x16x32_bf16 v[68:71], v[148:151], a[96:99], v[68:71]
 ds_read_b64_tr_b16 v[190:191], v19 offset:11552
 v_mfma_f32_16x16x32_bf16 v[108:111], v[148:151], a[100:103], v[108:111]
 ds_read_b64_tr_b16 v[192:193], v18 offset:10304
 v_mfma_f32_16x16x32_bf16 v[72:75], v[152:155], a[96:99], v[72:75]
 ds_read_b64_tr_b16 v[194:195], v18 offset:11584
 v_mfma_f32_16x16x32_bf16 v[112:115], v[152:155], a[100:103], v[112:115]
 ds_read_b64_tr_b16 v[196:197], v19 offset:10336
 ds_read_b64_tr_b16 v[198:199], v19 offset:11616
 v_mfma_f32_16x16x32_bf16 v[76:79], v[156:159], a[96:99], v[76:79]
 ds_read_b64_tr_b16 v[200:201], v18 offset:10368
 v_mfma_f32_16x16x32_bf16 v[116:119], v[156:159], a[100:103], v[116:119]
 ds_read_b64_tr_b16 v[202:203], v18 offset:11648
 v_mfma_f32_16x16x32_bf16 v[80:83], v[160:163], a[96:99], v[80:83]
 ds_read_b64_tr_b16 v[204:205], v19 offset:10400
 v_mfma_f32_16x16x32_bf16 v[120:123], v[160:163], a[100:103], v[120:123]
 ds_read_b64_tr_b16 v[206:207], v19 offset:11680
 v_mfma_f32_16x16x32_bf16 v[84:87], v[164:167], a[96:99], v[84:87]
 ds_read_b64_tr_b16 v[208:209], v18 offset:10432
 v_mfma_f32_16x16x32_bf16 v[124:127], v[164:167], a[100:103], v[124:127]
 ds_read_b64_tr_b16 v[210:211], v18 offset:11712
 ds_read_b64_tr_b16 v[212:213], v19 offset:10464
 v_mfma_f32_16x16x32_bf16 v[88:91], v[168:171], a[96:99], v[88:91]
 ds_read_b64_tr_b16 v[214:215], v19 offset:11744
 v_mfma_f32_16x16x32_bf16 v[128:131], v[168:171], a[100:103], v[128:131]
 buffer_load_dwordx4 v[230:233], v4, s[8:11], s50 offen
 ds_read_b64_tr_b16 v[216:217], v18 offset:10496
 v_mfma_f32_16x16x32_bf16 v[92:95], v[172:175], a[96:99], v[92:95]
 ds_read_b64_tr_b16 v[218:219], v18 offset:11776
 v_mfma_f32_16x16x32_bf16 v[132:135], v[172:175], a[100:103], v[132:135]
 ds_read_b64_tr_b16 v[220:221], v19 offset:10528
 v_mfma_f32_16x16x32_bf16 v[96:99], v[176:179], a[96:99], v[96:99]
 ds_read_b64_tr_b16 v[222:223], v19 offset:11808
 v_mfma_f32_16x16x32_bf16 v[136:139], v[176:179], a[100:103], v[136:139]
 buffer_load_dword v234, v5, s[8:11], s50 offen offset:1024
 v_mfma_f32_16x16x32_bf16 v[100:103], v[180:183], a[96:99], v[100:103]
 s_add_u32 s50, s50, 1280
 v_mfma_f32_16x16x32_bf16 v[140:143], v[180:183], a[100:103], v[140:143]
 s_waitcnt lgkmcnt(0) vmcnt(23)
 s_barrier
 v_mfma_f32_16x16x32_bf16 v[64:67], v[184:187], a[104:107], v[64:67]
 ds_read_b64_tr_b16 v[144:145], v14 offset:0
 ds_read_b64_tr_b16 v[146:147], v14 offset:1280
 v_mfma_f32_16x16x32_bf16 v[104:107], v[184:187], a[108:111], v[104:107]
 ds_read_b64_tr_b16 v[148:149], v15 offset:32
 v_mfma_f32_16x16x32_bf16 v[68:71], v[188:191], a[104:107], v[68:71]
 ds_read_b64_tr_b16 v[150:151], v15 offset:1312
 v_mfma_f32_16x16x32_bf16 v[108:111], v[188:191], a[108:111], v[108:111]
 ds_read_b64_tr_b16 v[152:153], v14 offset:64
 v_mfma_f32_16x16x32_bf16 v[72:75], v[192:195], a[104:107], v[72:75]
 ds_read_b64_tr_b16 v[154:155], v14 offset:1344
 v_mfma_f32_16x16x32_bf16 v[112:115], v[192:195], a[108:111], v[112:115]
 ds_read_b64_tr_b16 v[156:157], v15 offset:96
 ds_read_b64_tr_b16 v[158:159], v15 offset:1376
 v_mfma_f32_16x16x32_bf16 v[76:79], v[196:199], a[104:107], v[76:79]
 ds_read_b64_tr_b16 v[160:161], v14 offset:128
 v_mfma_f32_16x16x32_bf16 v[116:119], v[196:199], a[108:111], v[116:119]
 ds_read_b64_tr_b16 v[162:163], v14 offset:1408
 v_mfma_f32_16x16x32_bf16 v[80:83], v[200:203], a[104:107], v[80:83]
 ds_read_b64_tr_b16 v[164:165], v15 offset:160
 v_mfma_f32_16x16x32_bf16 v[120:123], v[200:203], a[108:111], v[120:123]
 ds_read_b64_tr_b16 v[166:167], v15 offset:1440
 v_mfma_f32_16x16x32_bf16 v[84:87], v[204:207], a[104:107], v[84:87]
 ds_read_b64_tr_b16 v[168:169], v14 offset:192
 v_mfma_f32_16x16x32_bf16 v[124:127], v[204:207], a[108:111], v[124:127]
 ds_read_b64_tr_b16 v[170:171], v14 offset:1472
 ds_read_b64_tr_b16 v[172:173], v15 offset:224
 v_mfma_f32_16x16x32_bf16 v[88:91], v[208:211], a[104:107], v[88:91]
 ds_read_b64_tr_b16 v[174:175], v15 offset:1504
 v_mfma_f32_16x16x32_bf16 v[128:131], v[208:211], a[108:111], v[128:131]
 buffer_load_dwordx4 v[236:239], v4, s[8:11], s50 offen
 ds_read_b64_tr_b16 v[176:177], v14 offset:256
 v_mfma_f32_16x16x32_bf16 v[92:95], v[212:215], a[104:107], v[92:95]
 ds_read_b64_tr_b16 v[178:179], v14 offset:1536
 v_mfma_f32_16x16x32_bf16 v[132:135], v[212:215], a[108:111], v[132:135]
 ds_read_b64_tr_b16 v[180:181], v15 offset:288
 v_mfma_f32_16x16x32_bf16 v[96:99], v[216:219], a[104:107], v[96:99]
 ds_read_b64_tr_b16 v[182:183], v15 offset:1568
 v_mfma_f32_16x16x32_bf16 v[136:139], v[216:219], a[108:111], v[136:139]
 buffer_load_dword v240, v5, s[8:11], s50 offen offset:1024
 v_mfma_f32_16x16x32_bf16 v[100:103], v[220:223], a[104:107], v[100:103]
 s_add_u32 s50, s50, 1280
 v_mfma_f32_16x16x32_bf16 v[140:143], v[220:223], a[108:111], v[140:143]
 s_waitcnt lgkmcnt(0) vmcnt(23)
 v_mfma_f32_16x16x32_bf16 v[64:67], v[144:147], a[112:115], v[64:67]
 ds_read_b64_tr_b16 v[184:185], v14 offset:10240
 ds_read_b64_tr_b16 v[186:187], v14 offset:11520
 v_mfma_f32_16x16x32_bf16 v[104:107], v[144:147], a[116:119], v[104:107]
 ds_read_b64_tr_b16 v[188:189], v15 offset:10272
 v_mfma_f32_16x16x32_bf16 v[68:71], v[148:151], a[112:115], v[68:71]
 ds_read_b64_tr_b16 v[190:191], v15 offset:11552
 v_mfma_f32_16x16x32_bf16 v[108:111], v[148:151], a[116:119], v[108:111]
 ds_read_b64_tr_b16 v[192:193], v14 offset:10304
 v_mfma_f32_16x16x32_bf16 v[72:75], v[152:155], a[112:115], v[72:75]
 ds_read_b64_tr_b16 v[194:195], v14 offset:11584
 v_mfma_f32_16x16x32_bf16 v[112:115], v[152:155], a[116:119], v[112:115]
 ds_read_b64_tr_b16 v[196:197], v15 offset:10336
 ds_read_b64_tr_b16 v[198:199], v15 offset:11616
 v_mfma_f32_16x16x32_bf16 v[76:79], v[156:159], a[112:115], v[76:79]
 ds_read_b64_tr_b16 v[200:201], v14 offset:10368
 v_mfma_f32_16x16x32_bf16 v[116:119], v[156:159], a[116:119], v[116:119]
 ds_read_b64_tr_b16 v[202:203], v14 offset:11648
 v_mfma_f32_16x16x32_bf16 v[80:83], v[160:163], a[112:115], v[80:83]
 ds_read_b64_tr_b16 v[204:205], v15 offset:10400
 v_mfma_f32_16x16x32_bf16 v[120:123], v[160:163], a[116:119], v[120:123]
 ds_read_b64_tr_b16 v[206:207], v15 offset:11680
 v_mfma_f32_16x16x32_bf16 v[84:87], v[164:167], a[112:115], v[84:87]
 ds_read_b64_tr_b16 v[208:209], v14 offset:10432
 v_mfma_f32_16x16x32_bf16 v[124:127], v[164:167], a[116:119], v[124:127]
 ds_read_b64_tr_b16 v[210:211], v14 offset:11712
 ds_read_b64_tr_b16 v[212:213], v15 offset:10464
 v_mfma_f32_16x16x32_bf16 v[88:91], v[168:171], a[112:115], v[88:91]
 ds_read_b64_tr_b16 v[214:215], v15 offset:11744
 v_mfma_f32_16x16x32_bf16 v[128:131], v[168:171], a[116:119], v[128:131]
 buffer_load_dwordx4 v[242:245], v4, s[8:11], s50 offen
 ds_read_b64_tr_b16 v[216:217], v14 offset:10496
 v_mfma_f32_16x16x32_bf16 v[92:95], v[172:175], a[112:115], v[92:95]
 ds_read_b64_tr_b16 v[218:219], v14 offset:11776
 v_mfma_f32_16x16x32_bf16 v[132:135], v[172:175], a[116:119], v[132:135]
 ds_read_b64_tr_b16 v[220:221], v15 offset:10528
 v_mfma_f32_16x16x32_bf16 v[96:99], v[176:179], a[112:115], v[96:99]
 ds_read_b64_tr_b16 v[222:223], v15 offset:11808
 v_mfma_f32_16x16x32_bf16 v[136:139], v[176:179], a[116:119], v[136:139]
 buffer_load_dword v246, v5, s[8:11], s50 offen offset:1024
 v_mfma_f32_16x16x32_bf16 v[100:103], v[180:183], a[112:115], v[100:103]
 s_add_u32 s50, s50, 1280
 v_mfma_f32_16x16x32_bf16 v[140:143], v[180:183], a[116:119], v[140:143]
 s_waitcnt lgkmcnt(0) vmcnt(18)
 s_barrier
 v_mfma_f32_16x16x32_bf16 v[64:67], v[184:187], a[120:123], v[64:67]
 ds_read_b64_tr_b16 v[144:145], v14 offset:20480
 ds_read_b64_tr_b16 v[146:147], v14 offset:21760
 v_mfma_f32_16x16x32_bf16 v[104:107], v[184:187], a[124:127], v[104:107]
 ds_read_b64_tr_b16 v[148:149], v15 offset:20512
 v_mfma_f32_16x16x32_bf16 v[68:71], v[188:191], a[120:123], v[68:71]
 ds_read_b64_tr_b16 v[150:151], v15 offset:21792
 v_mfma_f32_16x16x32_bf16 v[108:111], v[188:191], a[124:127], v[108:111]
 ds_read_b64_tr_b16 v[152:153], v14 offset:20544
 v_mfma_f32_16x16x32_bf16 v[72:75], v[192:195], a[120:123], v[72:75]
 ds_read_b64_tr_b16 v[154:155], v14 offset:21824
 v_mfma_f32_16x16x32_bf16 v[112:115], v[192:195], a[124:127], v[112:115]
 ds_read_b64_tr_b16 v[156:157], v15 offset:20576
 ds_read_b64_tr_b16 v[158:159], v15 offset:21856
 v_mfma_f32_16x16x32_bf16 v[76:79], v[196:199], a[120:123], v[76:79]
 ds_read_b64_tr_b16 v[160:161], v14 offset:20608
 v_mfma_f32_16x16x32_bf16 v[116:119], v[196:199], a[124:127], v[116:119]
 ds_read_b64_tr_b16 v[162:163], v14 offset:21888
 v_mfma_f32_16x16x32_bf16 v[80:83], v[200:203], a[120:123], v[80:83]
 ds_read_b64_tr_b16 v[164:165], v15 offset:20640
 v_mfma_f32_16x16x32_bf16 v[120:123], v[200:203], a[124:127], v[120:123]
 ds_read_b64_tr_b16 v[166:167], v15 offset:21920
 v_mfma_f32_16x16x32_bf16 v[84:87], v[204:207], a[120:123], v[84:87]
 ds_read_b64_tr_b16 v[168:169], v14 offset:20672
 v_mfma_f32_16x16x32_bf16 v[124:127], v[204:207], a[124:127], v[124:127]
 ds_read_b64_tr_b16 v[170:171], v14 offset:21952
 ds_read_b64_tr_b16 v[172:173], v15 offset:20704
 v_mfma_f32_16x16x32_bf16 v[88:91], v[208:211], a[120:123], v[88:91]
 ds_read_b64_tr_b16 v[174:175], v15 offset:21984
 v_mfma_f32_16x16x32_bf16 v[128:131], v[208:211], a[124:127], v[128:131]
 buffer_load_dwordx4 v[248:251], v4, s[8:11], s50 offen
 ds_read_b64_tr_b16 v[176:177], v14 offset:20736
 v_mfma_f32_16x16x32_bf16 v[92:95], v[212:215], a[120:123], v[92:95]
 ds_read_b64_tr_b16 v[178:179], v14 offset:22016
 v_mfma_f32_16x16x32_bf16 v[132:135], v[212:215], a[124:127], v[132:135]
 ds_read_b64_tr_b16 v[180:181], v15 offset:20768
 v_mfma_f32_16x16x32_bf16 v[96:99], v[216:219], a[120:123], v[96:99]
 ds_read_b64_tr_b16 v[182:183], v15 offset:22048
 v_mfma_f32_16x16x32_bf16 v[136:139], v[216:219], a[124:127], v[136:139]
 buffer_load_dword v252, v5, s[8:11], s50 offen offset:1024
 v_mfma_f32_16x16x32_bf16 v[100:103], v[220:223], a[120:123], v[100:103]
 s_add_u32 s50, s50, 1280
 v_mfma_f32_16x16x32_bf16 v[140:143], v[220:223], a[124:127], v[140:143]
 s_waitcnt lgkmcnt(0) vmcnt(18)
 v_mfma_f32_16x16x32_bf16 v[64:67], v[144:147], a[128:131], v[64:67]
 ds_read_b64_tr_b16 v[184:185], v14 offset:30720
 ds_read_b64_tr_b16 v[186:187], v14 offset:32000
 v_mfma_f32_16x16x32_bf16 v[104:107], v[144:147], a[132:135], v[104:107]
 ds_read_b64_tr_b16 v[188:189], v15 offset:30752
 v_mfma_f32_16x16x32_bf16 v[68:71], v[148:151], a[128:131], v[68:71]
 ds_read_b64_tr_b16 v[190:191], v15 offset:32032
 v_mfma_f32_16x16x32_bf16 v[108:111], v[148:151], a[132:135], v[108:111]
 ds_read_b64_tr_b16 v[192:193], v14 offset:30784
 v_mfma_f32_16x16x32_bf16 v[72:75], v[152:155], a[128:131], v[72:75]
 ds_read_b64_tr_b16 v[194:195], v14 offset:32064
 v_mfma_f32_16x16x32_bf16 v[112:115], v[152:155], a[132:135], v[112:115]
 ds_read_b64_tr_b16 v[196:197], v15 offset:30816
 ds_read_b64_tr_b16 v[198:199], v15 offset:32096
 v_mfma_f32_16x16x32_bf16 v[76:79], v[156:159], a[128:131], v[76:79]
 ds_read_b64_tr_b16 v[200:201], v14 offset:30848
 v_mfma_f32_16x16x32_bf16 v[116:119], v[156:159], a[132:135], v[116:119]
 ds_read_b64_tr_b16 v[202:203], v14 offset:32128
 v_mfma_f32_16x16x32_bf16 v[80:83], v[160:163], a[128:131], v[80:83]
 ds_read_b64_tr_b16 v[204:205], v15 offset:30880
 v_mfma_f32_16x16x32_bf16 v[120:123], v[160:163], a[132:135], v[120:123]
 ds_read_b64_tr_b16 v[206:207], v15 offset:32160
 v_mfma_f32_16x16x32_bf16 v[84:87], v[164:167], a[128:131], v[84:87]
 ds_read_b64_tr_b16 v[208:209], v14 offset:30912
 v_mfma_f32_16x16x32_bf16 v[124:127], v[164:167], a[132:135], v[124:127]
 ds_read_b64_tr_b16 v[210:211], v14 offset:32192
 ds_read_b64_tr_b16 v[212:213], v15 offset:30944
 v_mfma_f32_16x16x32_bf16 v[88:91], v[168:171], a[128:131], v[88:91]
 ds_read_b64_tr_b16 v[214:215], v15 offset:32224
 v_mfma_f32_16x16x32_bf16 v[128:131], v[168:171], a[132:135], v[128:131]
 buffer_load_dwordx4 v[30:33], v4, s[8:11], s50 offen
 ds_read_b64_tr_b16 v[216:217], v14 offset:30976
 v_mfma_f32_16x16x32_bf16 v[92:95], v[172:175], a[128:131], v[92:95]
 ds_read_b64_tr_b16 v[218:219], v14 offset:32256
 v_mfma_f32_16x16x32_bf16 v[132:135], v[172:175], a[132:135], v[132:135]
 ds_read_b64_tr_b16 v[220:221], v15 offset:31008
 v_mfma_f32_16x16x32_bf16 v[96:99], v[176:179], a[128:131], v[96:99]
 ds_read_b64_tr_b16 v[222:223], v15 offset:32288
 v_mfma_f32_16x16x32_bf16 v[136:139], v[176:179], a[132:135], v[136:139]
 buffer_load_dword v34, v5, s[8:11], s50 offen offset:1024
 v_mfma_f32_16x16x32_bf16 v[100:103], v[180:183], a[128:131], v[100:103]
 s_add_u32 s50, s50, 1280
 v_mfma_f32_16x16x32_bf16 v[140:143], v[180:183], a[132:135], v[140:143]
 s_waitcnt lgkmcnt(0) vmcnt(18)
 s_barrier
 v_mfma_f32_16x16x32_bf16 v[64:67], v[184:187], a[136:139], v[64:67]
 ds_read_b64_tr_b16 v[144:145], v14 offset:40960
 ds_read_b64_tr_b16 v[146:147], v14 offset:42240
 v_mfma_f32_16x16x32_bf16 v[104:107], v[184:187], a[140:143], v[104:107]
 ds_read_b64_tr_b16 v[148:149], v15 offset:40992
 v_mfma_f32_16x16x32_bf16 v[68:71], v[188:191], a[136:139], v[68:71]
 ds_read_b64_tr_b16 v[150:151], v15 offset:42272
 v_mfma_f32_16x16x32_bf16 v[108:111], v[188:191], a[140:143], v[108:111]
 ds_read_b64_tr_b16 v[152:153], v14 offset:41024
 v_mfma_f32_16x16x32_bf16 v[72:75], v[192:195], a[136:139], v[72:75]
 ds_read_b64_tr_b16 v[154:155], v14 offset:42304
 v_mfma_f32_16x16x32_bf16 v[112:115], v[192:195], a[140:143], v[112:115]
 ds_read_b64_tr_b16 v[156:157], v15 offset:41056
 ds_read_b64_tr_b16 v[158:159], v15 offset:42336
 v_mfma_f32_16x16x32_bf16 v[76:79], v[196:199], a[136:139], v[76:79]
 ds_read_b64_tr_b16 v[160:161], v14 offset:41088
 v_mfma_f32_16x16x32_bf16 v[116:119], v[196:199], a[140:143], v[116:119]
 ds_read_b64_tr_b16 v[162:163], v14 offset:42368
 v_mfma_f32_16x16x32_bf16 v[80:83], v[200:203], a[136:139], v[80:83]
 ds_read_b64_tr_b16 v[164:165], v15 offset:41120
 v_mfma_f32_16x16x32_bf16 v[120:123], v[200:203], a[140:143], v[120:123]
 ds_read_b64_tr_b16 v[166:167], v15 offset:42400
 v_mfma_f32_16x16x32_bf16 v[84:87], v[204:207], a[136:139], v[84:87]
 ds_read_b64_tr_b16 v[168:169], v14 offset:41152
 v_mfma_f32_16x16x32_bf16 v[124:127], v[204:207], a[140:143], v[124:127]
 ds_read_b64_tr_b16 v[170:171], v14 offset:42432
 ds_read_b64_tr_b16 v[172:173], v15 offset:41184
 v_mfma_f32_16x16x32_bf16 v[88:91], v[208:211], a[136:139], v[88:91]
 ds_read_b64_tr_b16 v[174:175], v15 offset:42464
 v_mfma_f32_16x16x32_bf16 v[128:131], v[208:211], a[140:143], v[128:131]
 buffer_load_dwordx4 v[36:39], v4, s[8:11], s50 offen
 ds_read_b64_tr_b16 v[176:177], v14 offset:41216
 v_mfma_f32_16x16x32_bf16 v[92:95], v[212:215], a[136:139], v[92:95]
 ds_read_b64_tr_b16 v[178:179], v14 offset:42496
 v_mfma_f32_16x16x32_bf16 v[132:135], v[212:215], a[140:143], v[132:135]
 ds_read_b64_tr_b16 v[180:181], v15 offset:41248
 v_mfma_f32_16x16x32_bf16 v[96:99], v[216:219], a[136:139], v[96:99]
 ds_read_b64_tr_b16 v[182:183], v15 offset:42528
 v_mfma_f32_16x16x32_bf16 v[136:139], v[216:219], a[140:143], v[136:139]
 buffer_load_dword v40, v5, s[8:11], s50 offen offset:1024
 v_mfma_f32_16x16x32_bf16 v[100:103], v[220:223], a[136:139], v[100:103]
 s_add_u32 s50, s50, 1280
 v_mfma_f32_16x16x32_bf16 v[140:143], v[220:223], a[140:143], v[140:143]
 s_waitcnt lgkmcnt(0) vmcnt(18)
 v_mfma_f32_16x16x32_bf16 v[64:67], v[144:147], a[144:147], v[64:67]
 ds_read_b64_tr_b16 v[184:185], v14 offset:51200
 ds_read_b64_tr_b16 v[186:187], v14 offset:52480
 v_mfma_f32_16x16x32_bf16 v[104:107], v[144:147], a[148:151], v[104:107]
 ds_read_b64_tr_b16 v[188:189], v15 offset:51232
 v_mfma_f32_16x16x32_bf16 v[68:71], v[148:151], a[144:147], v[68:71]
 ds_read_b64_tr_b16 v[190:191], v15 offset:52512
 v_mfma_f32_16x16x32_bf16 v[108:111], v[148:151], a[148:151], v[108:111]
 ds_read_b64_tr_b16 v[192:193], v14 offset:51264
 v_mfma_f32_16x16x32_bf16 v[72:75], v[152:155], a[144:147], v[72:75]
 ds_read_b64_tr_b16 v[194:195], v14 offset:52544
 v_mfma_f32_16x16x32_bf16 v[112:115], v[152:155], a[148:151], v[112:115]
 ds_read_b64_tr_b16 v[196:197], v15 offset:51296
 ds_read_b64_tr_b16 v[198:199], v15 offset:52576
 v_mfma_f32_16x16x32_bf16 v[76:79], v[156:159], a[144:147], v[76:79]
 ds_read_b64_tr_b16 v[200:201], v14 offset:51328
 v_mfma_f32_16x16x32_bf16 v[116:119], v[156:159], a[148:151], v[116:119]
 ds_read_b64_tr_b16 v[202:203], v14 offset:52608
 v_mfma_f32_16x16x32_bf16 v[80:83], v[160:163], a[144:147], v[80:83]
 ds_read_b64_tr_b16 v[204:205], v15 offset:51360
 v_mfma_f32_16x16x32_bf16 v[120:123], v[160:163], a[148:151], v[120:123]
 ds_read_b64_tr_b16 v[206:207], v15 offset:52640
 v_mfma_f32_16x16x32_bf16 v[84:87], v[164:167], a[144:147], v[84:87]
 ds_read_b64_tr_b16 v[208:209], v14 offset:51392
 v_mfma_f32_16x16x32_bf16 v[124:127], v[164:167], a[148:151], v[124:127]
 ds_read_b64_tr_b16 v[210:211], v14 offset:52672
 ds_read_b64_tr_b16 v[212:213], v15 offset:51424
 v_mfma_f32_16x16x32_bf16 v[88:91], v[168:171], a[144:147], v[88:91]
 ds_read_b64_tr_b16 v[214:215], v15 offset:52704
 v_mfma_f32_16x16x32_bf16 v[128:131], v[168:171], a[148:151], v[128:131]
 buffer_load_dwordx4 v[42:45], v4, s[8:11], s50 offen
 ds_read_b64_tr_b16 v[216:217], v14 offset:51456
 v_mfma_f32_16x16x32_bf16 v[92:95], v[172:175], a[144:147], v[92:95]
 ds_read_b64_tr_b16 v[218:219], v14 offset:52736
 v_mfma_f32_16x16x32_bf16 v[132:135], v[172:175], a[148:151], v[132:135]
 ds_read_b64_tr_b16 v[220:221], v15 offset:51488
 v_mfma_f32_16x16x32_bf16 v[96:99], v[176:179], a[144:147], v[96:99]
 ds_read_b64_tr_b16 v[222:223], v15 offset:52768
 v_mfma_f32_16x16x32_bf16 v[136:139], v[176:179], a[148:151], v[136:139]
 buffer_load_dword v46, v5, s[8:11], s50 offen offset:1024
 v_mfma_f32_16x16x32_bf16 v[100:103], v[180:183], a[144:147], v[100:103]
 s_add_u32 s50, s50, 1280
 v_mfma_f32_16x16x32_bf16 v[140:143], v[180:183], a[148:151], v[140:143]
 s_waitcnt lgkmcnt(0) vmcnt(18)
 v_mfma_f32_16x16x32_bf16 v[64:67], v[184:187], a[152:155], v[64:67]
 v_mfma_f32_16x16x32_bf16 v[104:107], v[184:187], a[156:159], v[104:107]
 v_mfma_f32_16x16x32_bf16 v[68:71], v[188:191], a[152:155], v[68:71]
 v_mfma_f32_16x16x32_bf16 v[108:111], v[188:191], a[156:159], v[108:111]
 v_mfma_f32_16x16x32_bf16 v[72:75], v[192:195], a[152:155], v[72:75]
 v_mfma_f32_16x16x32_bf16 v[112:115], v[192:195], a[156:159], v[112:115]
 v_mfma_f32_16x16x32_bf16 v[76:79], v[196:199], a[152:155], v[76:79]
 v_mfma_f32_16x16x32_bf16 v[116:119], v[196:199], a[156:159], v[116:119]
 v_mfma_f32_16x16x32_bf16 v[80:83], v[200:203], a[152:155], v[80:83]
 v_mfma_f32_16x16x32_bf16 v[120:123], v[200:203], a[156:159], v[120:123]
 v_mfma_f32_16x16x32_bf16 v[84:87], v[204:207], a[152:155], v[84:87]
 v_mfma_f32_16x16x32_bf16 v[124:127], v[204:207], a[156:159], v[124:127]
 v_mfma_f32_16x16x32_bf16 v[88:91], v[208:211], a[152:155], v[88:91]
 v_mfma_f32_16x16x32_bf16 v[128:131], v[208:211], a[156:159], v[128:131]
 v_mfma_f32_16x16x32_bf16 v[92:95], v[212:215], a[152:155], v[92:95]
 v_mfma_f32_16x16x32_bf16 v[132:135], v[212:215], a[156:159], v[132:135]
 v_mfma_f32_16x16x32_bf16 v[96:99], v[216:219], a[152:155], v[96:99]
 v_mfma_f32_16x16x32_bf16 v[136:139], v[216:219], a[156:159], v[136:139]
 v_mfma_f32_16x16x32_bf16 v[100:103], v[220:223], a[152:155], v[100:103]
 v_mfma_f32_16x16x32_bf16 v[140:143], v[220:223], a[156:159], v[140:143]
 s_add_u32 s16, s38, 73400320
 s_addc_u32 s17, s39, 0
 s_mov_b32 s18, 5242880
 s_mov_b32 s19, 0x00020000
 s_nop 3
 s_mul_i32 s21, s47, 40
 s_mul_i32 s22, s44, 10
 s_add_u32 s21, s21, s22
 s_lshl_b32 s21, s21, 10
 s_cmp_lt_u32 s2, 32
 s_cbranch_scc1 om_232
 s_add_u32 s22, s21, 0
 buffer_store_dwordx4 v[64:67], v4, s[16:19], s22 offen offset:0 sc1
 buffer_store_dwordx4 v[68:71], v4, s[16:19], s22 offen offset:1024 sc1
 buffer_store_dwordx4 v[72:75], v4, s[16:19], s22 offen offset:2048 sc1
 buffer_store_dwordx4 v[76:79], v4, s[16:19], s22 offen offset:3072 sc1
 s_add_u32 s22, s21, 4096
 buffer_store_dwordx4 v[80:83], v4, s[16:19], s22 offen offset:0 sc1
 buffer_store_dwordx4 v[84:87], v4, s[16:19], s22 offen offset:1024 sc1
 buffer_store_dwordx4 v[88:91], v4, s[16:19], s22 offen offset:2048 sc1
 buffer_store_dwordx4 v[92:95], v4, s[16:19], s22 offen offset:3072 sc1
 s_add_u32 s22, s21, 8192
 buffer_store_dwordx4 v[96:99], v4, s[16:19], s22 offen offset:0 sc1
 buffer_store_dwordx4 v[100:103], v4, s[16:19], s22 offen offset:1024 sc1
 s_add_u32 s22, s21, 40960
 buffer_store_dwordx4 v[104:107], v4, s[16:19], s22 offen offset:0 sc1
 buffer_store_dwordx4 v[108:111], v4, s[16:19], s22 offen offset:1024 sc1
 buffer_store_dwordx4 v[112:115], v4, s[16:19], s22 offen offset:2048 sc1
 buffer_store_dwordx4 v[116:119], v4, s[16:19], s22 offen offset:3072 sc1
 s_add_u32 s22, s21, 45056
 buffer_store_dwordx4 v[120:123], v4, s[16:19], s22 offen offset:0 sc1
 buffer_store_dwordx4 v[124:127], v4, s[16:19], s22 offen offset:1024 sc1
 buffer_store_dwordx4 v[128:131], v4, s[16:19], s22 offen offset:2048 sc1
 buffer_store_dwordx4 v[132:135], v4, s[16:19], s22 offen offset:3072 sc1
 s_add_u32 s22, s21, 49152
 buffer_store_dwordx4 v[136:139], v4, s[16:19], s22 offen offset:0 sc1
 buffer_store_dwordx4 v[140:143], v4, s[16:19], s22 offen offset:1024 sc1
 s_sub_u32 s50, s50, 1320960
 buffer_load_dwordx4 v[160:163], v4, s[8:11], s50 offen
 buffer_load_dword v164, v5, s[8:11], s50 offen offset:1024
 s_add_u32 s50, s50, 1280
 buffer_load_dwordx4 v[166:169], v4, s[8:11], s50 offen
 buffer_load_dword v170, v5, s[8:11], s50 offen offset:1024
 s_add_u32 s50, s50, 1280
 buffer_load_dwordx4 v[172:175], v4, s[8:11], s50 offen
 buffer_load_dword v176, v5, s[8:11], s50 offen offset:1024
 s_add_u32 s50, s50, 1280
 buffer_load_dwordx4 v[178:181], v4, s[8:11], s50 offen
 buffer_load_dword v182, v5, s[8:11], s50 offen offset:1024
 s_add_u32 s50, s50, 1280
 buffer_load_dwordx4 v[184:187], v4, s[8:11], s50 offen
 buffer_load_dword v188, v5, s[8:11], s50 offen offset:1024
 s_add_u32 s50, s50, 1280
 buffer_load_dwordx4 v[190:193], v4, s[8:11], s50 offen
 buffer_load_dword v194, v5, s[8:11], s50 offen offset:1024
 s_add_u32 s50, s50, 1280
 buffer_load_dwordx4 v[196:199], v4, s[8:11], s50 offen
 buffer_load_dword v200, v5, s[8:11], s50 offen offset:1024
 s_add_u32 s50, s50, 1280
 buffer_load_dwordx4 v[202:205], v4, s[8:11], s50 offen
 buffer_load_dword v206, v5, s[8:11], s50 offen offset:1024
 s_add_u32 s50, s50, 1280
 s_waitcnt vmcnt(36)
 v_lshlrev_b32 v57, 16, v52
 v_and_b32 v52, 0xffff0000, v52
 v_lshlrev_b32 v58, 16, v53
 v_and_b32 v53, 0xffff0000, v53
 v_lshlrev_b32 v59, 16, v54
 v_and_b32 v54, 0xffff0000, v54
 v_lshlrev_b32 v60, 16, v55
 v_and_b32 v55, 0xffff0000, v55
 v_lshlrev_b32 v61, 16, v56
 v_and_b32 v56, 0xffff0000, v56
 v_lshlrev_b32 v25, 16, v224
 v_and_b32 v26, 0xffff0000, v224
 v_mul_f32 v25, v25, v57
 v_mul_f32 v26, v26, v52
 v_cvt_pk_bf16_f32 v25, v25, v26
 v_lshlrev_b32 v26, 16, v25
 v_and_b32 v25, 0xffff0000, v25
 v_add_f32 v144, v25, v26
 v_lshlrev_b32 v25, 16, v225
 v_and_b32 v26, 0xffff0000, v225
 v_mul_f32 v25, v25, v58
 v_mul_f32 v26, v26, v53
 v_cvt_pk_bf16_f32 v25, v25, v26
 v_lshlrev_b32 v26, 16, v25
 v_and_b32 v25, 0xffff0000, v25
 v_add_f32 v144, v144, v26
 v_add_f32 v144, v144, v25
 v_lshlrev_b32 v25, 16, v226
 v_and_b32 v26, 0xffff0000, v226
 v_mul_f32 v25, v25, v59
 v_mul_f32 v26, v26, v54
 v_cvt_pk_bf16_f32 v25, v25, v26
 v_lshlrev_b32 v26, 16, v25
 v_and_b32 v25, 0xffff0000, v25
 v_add_f32 v144, v144, v26
 v_add_f32 v144, v144, v25
 v_lshlrev_b32 v25, 16, v227
 v_and_b32 v26, 0xffff0000, v227
 v_mul_f32 v25, v25, v60
 v_mul_f32 v26, v26, v55
 v_cvt_pk_bf16_f32 v25, v25, v26
 v_lshlrev_b32 v26, 16, v25
 v_and_b32 v25, 0xffff0000, v25
 v_add_f32 v144, v144, v26
 v_add_f32 v144, v144, v25
 v_lshlrev_b32 v25, 16, v228
 v_and_b32 v26, 0xffff0000, v228
 v_mul_f32 v25, v25, v61
 v_mul_f32 v26, v26, v56
 v_cvt_pk_bf16_f32 v25, v25, v26
 v_lshlrev_b32 v26, 16, v25
 v_and_b32 v25, 0xffff0000, v25
 v_add_f32 v144, v144, v26
 v_add_f32 v144, v144, v25
 v_lshlrev_b32 v25, 16, v230
 v_and_b32 v26, 0xffff0000, v230
 v_mul_f32 v25, v25, v57
 v_mul_f32 v26, v26, v52
 v_cvt_pk_bf16_f32 v25, v25, v26
 v_lshlrev_b32 v26, 16, v25
 v_and_b32 v25, 0xffff0000, v25
 v_add_f32 v145, v25, v26
 v_lshlrev_b32 v25, 16, v231
 v_and_b32 v26, 0xffff0000, v231
 v_mul_f32 v25, v25, v58
 v_mul_f32 v26, v26, v53
 v_cvt_pk_bf16_f32 v25, v25, v26
 v_lshlrev_b32 v26, 16, v25
 v_and_b32 v25, 0xffff0000, v25
 v_add_f32 v145, v145, v26
 v_add_f32 v145, v145, v25
 v_lshlrev_b32 v25, 16, v232
 v_and_b32 v26, 0xffff0000, v232
 v_mul_f32 v25, v25, v59
 v_mul_f32 v26, v26, v54
 v_cvt_pk_bf16_f32 v25, v25, v26
 v_lshlrev_b32 v26, 16, v25
 v_and_b32 v25, 0xffff0000, v25
 v_add_f32 v145, v145, v26
 v_add_f32 v145, v145, v25
 v_lshlrev_b32 v25, 16, v233
 v_and_b32 v26, 0xffff0000, v233
 v_mul_f32 v25, v25, v60
 v_mul_f32 v26, v26, v55
 v_cvt_pk_bf16_f32 v25, v25, v26
 v_lshlrev_b32 v26, 16, v25
 v_and_b32 v25, 0xffff0000, v25
 v_add_f32 v145, v145, v26
 v_add_f32 v145, v145, v25
 v_lshlrev_b32 v25, 16, v234
 v_and_b32 v26, 0xffff0000, v234
 v_mul_f32 v25, v25, v61
 v_mul_f32 v26, v26, v56
 v_cvt_pk_bf16_f32 v25, v25, v26
 v_lshlrev_b32 v26, 16, v25
 v_and_b32 v25, 0xffff0000, v25
 v_add_f32 v145, v145, v26
 v_add_f32 v145, v145, v25
 v_lshlrev_b32 v25, 16, v236
 v_and_b32 v26, 0xffff0000, v236
 v_mul_f32 v25, v25, v57
 v_mul_f32 v26, v26, v52
 v_cvt_pk_bf16_f32 v25, v25, v26
 v_lshlrev_b32 v26, 16, v25
 v_and_b32 v25, 0xffff0000, v25
 v_add_f32 v146, v25, v26
 v_lshlrev_b32 v25, 16, v237
 v_and_b32 v26, 0xffff0000, v237
 v_mul_f32 v25, v25, v58
 v_mul_f32 v26, v26, v53
 v_cvt_pk_bf16_f32 v25, v25, v26
 v_lshlrev_b32 v26, 16, v25
 v_and_b32 v25, 0xffff0000, v25
 v_add_f32 v146, v146, v26
 v_add_f32 v146, v146, v25
 v_lshlrev_b32 v25, 16, v238
 v_and_b32 v26, 0xffff0000, v238
 v_mul_f32 v25, v25, v59
 v_mul_f32 v26, v26, v54
 v_cvt_pk_bf16_f32 v25, v25, v26
 v_lshlrev_b32 v26, 16, v25
 v_and_b32 v25, 0xffff0000, v25
 v_add_f32 v146, v146, v26
 v_add_f32 v146, v146, v25
 v_lshlrev_b32 v25, 16, v239
 v_and_b32 v26, 0xffff0000, v239
 v_mul_f32 v25, v25, v60
 v_mul_f32 v26, v26, v55
 v_cvt_pk_bf16_f32 v25, v25, v26
 v_lshlrev_b32 v26, 16, v25
 v_and_b32 v25, 0xffff0000, v25
 v_add_f32 v146, v146, v26
 v_add_f32 v146, v146, v25
 v_lshlrev_b32 v25, 16, v240
 v_and_b32 v26, 0xffff0000, v240
 v_mul_f32 v25, v25, v61
 v_mul_f32 v26, v26, v56
 v_cvt_pk_bf16_f32 v25, v25, v26
 v_lshlrev_b32 v26, 16, v25
 v_and_b32 v25, 0xffff0000, v25
 v_add_f32 v146, v146, v26
 v_add_f32 v146, v146, v25
 v_lshlrev_b32 v25, 16, v242
 v_and_b32 v26, 0xffff0000, v242
 v_mul_f32 v25, v25, v57
 v_mul_f32 v26, v26, v52
 v_cvt_pk_bf16_f32 v25, v25, v26
 v_lshlrev_b32 v26, 16, v25
 v_and_b32 v25, 0xffff0000, v25
 v_add_f32 v147, v25, v26
 v_lshlrev_b32 v25, 16, v243
 v_and_b32 v26, 0xffff0000, v243
 v_mul_f32 v25, v25, v58
 v_mul_f32 v26, v26, v53
 v_cvt_pk_bf16_f32 v25, v25, v26
 v_lshlrev_b32 v26, 16, v25
 v_and_b32 v25, 0xffff0000, v25
 v_add_f32 v147, v147, v26
 v_add_f32 v147, v147, v25
 v_lshlrev_b32 v25, 16, v244
 v_and_b32 v26, 0xffff0000, v244
 v_mul_f32 v25, v25, v59
 v_mul_f32 v26, v26, v54
 v_cvt_pk_bf16_f32 v25, v25, v26
 v_lshlrev_b32 v26, 16, v25
 v_and_b32 v25, 0xffff0000, v25
 v_add_f32 v147, v147, v26
 v_add_f32 v147, v147, v25
 v_lshlrev_b32 v25, 16, v245
 v_and_b32 v26, 0xffff0000, v245
 v_mul_f32 v25, v25, v60
 v_mul_f32 v26, v26, v55
 v_cvt_pk_bf16_f32 v25, v25, v26
 v_lshlrev_b32 v26, 16, v25
 v_and_b32 v25, 0xffff0000, v25
 v_add_f32 v147, v147, v26
 v_add_f32 v147, v147, v25
 v_lshlrev_b32 v25, 16, v246
 v_and_b32 v26, 0xffff0000, v246
 v_mul_f32 v25, v25, v61
 v_mul_f32 v26, v26, v56
 v_cvt_pk_bf16_f32 v25, v25, v26
 v_lshlrev_b32 v26, 16, v25
 v_and_b32 v25, 0xffff0000, v25
 v_add_f32 v147, v147, v26
 v_add_f32 v147, v147, v25
 v_lshlrev_b32 v25, 16, v248
 v_and_b32 v26, 0xffff0000, v248
 v_mul_f32 v25, v25, v57
 v_mul_f32 v26, v26, v52
 v_cvt_pk_bf16_f32 v25, v25, v26
 v_lshlrev_b32 v26, 16, v25
 v_and_b32 v25, 0xffff0000, v25
 v_add_f32 v148, v25, v26
 v_lshlrev_b32 v25, 16, v249
 v_and_b32 v26, 0xffff0000, v249
 v_mul_f32 v25, v25, v58
 v_mul_f32 v26, v26, v53
 v_cvt_pk_bf16_f32 v25, v25, v26
 v_lshlrev_b32 v26, 16, v25
 v_and_b32 v25, 0xffff0000, v25
 v_add_f32 v148, v148, v26
 v_add_f32 v148, v148, v25
 v_lshlrev_b32 v25, 16, v250
 v_and_b32 v26, 0xffff0000, v250
 v_mul_f32 v25, v25, v59
 v_mul_f32 v26, v26, v54
 v_cvt_pk_bf16_f32 v25, v25, v26
 v_lshlrev_b32 v26, 16, v25
 v_and_b32 v25, 0xffff0000, v25
 v_add_f32 v148, v148, v26
 v_add_f32 v148, v148, v25
 v_lshlrev_b32 v25, 16, v251
 v_and_b32 v26, 0xffff0000, v251
 v_mul_f32 v25, v25, v60
 v_mul_f32 v26, v26, v55
 v_cvt_pk_bf16_f32 v25, v25, v26
 v_lshlrev_b32 v26, 16, v25
 v_and_b32 v25, 0xffff0000, v25
 v_add_f32 v148, v148, v26
 v_add_f32 v148, v148, v25
 v_lshlrev_b32 v25, 16, v252
 v_and_b32 v26, 0xffff0000, v252
 v_mul_f32 v25, v25, v61
 v_mul_f32 v26, v26, v56
 v_cvt_pk_bf16_f32 v25, v25, v26
 v_lshlrev_b32 v26, 16, v25
 v_and_b32 v25, 0xffff0000, v25
 v_add_f32 v148, v148, v26
 v_add_f32 v148, v148, v25
 v_lshlrev_b32 v25, 16, v30
 v_and_b32 v26, 0xffff0000, v30
 v_mul_f32 v25, v25, v57
 v_mul_f32 v26, v26, v52
 v_cvt_pk_bf16_f32 v25, v25, v26
 v_lshlrev_b32 v26, 16, v25
 v_and_b32 v25, 0xffff0000, v25
 v_add_f32 v149, v25, v26
 v_lshlrev_b32 v25, 16, v31
 v_and_b32 v26, 0xffff0000, v31
 v_mul_f32 v25, v25, v58
 v_mul_f32 v26, v26, v53
 v_cvt_pk_bf16_f32 v25, v25, v26
 v_lshlrev_b32 v26, 16, v25
 v_and_b32 v25, 0xffff0000, v25
 v_add_f32 v149, v149, v26
 v_add_f32 v149, v149, v25
 v_lshlrev_b32 v25, 16, v32
 v_and_b32 v26, 0xffff0000, v32
 v_mul_f32 v25, v25, v59
 v_mul_f32 v26, v26, v54
 v_cvt_pk_bf16_f32 v25, v25, v26
 v_lshlrev_b32 v26, 16, v25
 v_and_b32 v25, 0xffff0000, v25
 v_add_f32 v149, v149, v26
 v_add_f32 v149, v149, v25
 v_lshlrev_b32 v25, 16, v33
 v_and_b32 v26, 0xffff0000, v33
 v_mul_f32 v25, v25, v60
 v_mul_f32 v26, v26, v55
 v_cvt_pk_bf16_f32 v25, v25, v26
 v_lshlrev_b32 v26, 16, v25
 v_and_b32 v25, 0xffff0000, v25
 v_add_f32 v149, v149, v26
 v_add_f32 v149, v149, v25
 v_lshlrev_b32 v25, 16, v34
 v_and_b32 v26, 0xffff0000, v34
 v_mul_f32 v25, v25, v61
 v_mul_f32 v26, v26, v56
 v_cvt_pk_bf16_f32 v25, v25, v26
 v_lshlrev_b32 v26, 16, v25
 v_and_b32 v25, 0xffff0000, v25
 v_add_f32 v149, v149, v26
 v_add_f32 v149, v149, v25
 v_lshlrev_b32 v25, 16, v36
 v_and_b32 v26, 0xffff0000, v36
 v_mul_f32 v25, v25, v57
 v_mul_f32 v26, v26, v52
 v_cvt_pk_bf16_f32 v25, v25, v26
 v_lshlrev_b32 v26, 16, v25
 v_and_b32 v25, 0xffff0000, v25
 v_add_f32 v150, v25, v26
 v_lshlrev_b32 v25, 16, v37
 v_and_b32 v26, 0xffff0000, v37
 v_mul_f32 v25, v25, v58
 v_mul_f32 v26, v26, v53
 v_cvt_pk_bf16_f32 v25, v25, v26
 v_lshlrev_b32 v26, 16, v25
 v_and_b32 v25, 0xffff0000, v25
 v_add_f32 v150, v150, v26
 v_add_f32 v150, v150, v25
 v_lshlrev_b32 v25, 16, v38
 v_and_b32 v26, 0xffff0000, v38
 v_mul_f32 v25, v25, v59
 v_mul_f32 v26, v26, v54
 v_cvt_pk_bf16_f32 v25, v25, v26
 v_lshlrev_b32 v26, 16, v25
 v_and_b32 v25, 0xffff0000, v25
 v_add_f32 v150, v150, v26
 v_add_f32 v150, v150, v25
 v_lshlrev_b32 v25, 16, v39
 v_and_b32 v26, 0xffff0000, v39
 v_mul_f32 v25, v25, v60
 v_mul_f32 v26, v26, v55
 v_cvt_pk_bf16_f32 v25, v25, v26
 v_lshlrev_b32 v26, 16, v25
 v_and_b32 v25, 0xffff0000, v25
 v_add_f32 v150, v150, v26
 v_add_f32 v150, v150, v25
 v_lshlrev_b32 v25, 16, v40
 v_and_b32 v26, 0xffff0000, v40
 v_mul_f32 v25, v25, v61
 v_mul_f32 v26, v26, v56
 v_cvt_pk_bf16_f32 v25, v25, v26
 v_lshlrev_b32 v26, 16, v25
 v_and_b32 v25, 0xffff0000, v25
 v_add_f32 v150, v150, v26
 v_add_f32 v150, v150, v25
 v_lshlrev_b32 v25, 16, v42
 v_and_b32 v26, 0xffff0000, v42
 v_mul_f32 v25, v25, v57
 v_mul_f32 v26, v26, v52
 v_cvt_pk_bf16_f32 v25, v25, v26
 v_lshlrev_b32 v26, 16, v25
 v_and_b32 v25, 0xffff0000, v25
 v_add_f32 v151, v25, v26
 v_lshlrev_b32 v25, 16, v43
 v_and_b32 v26, 0xffff0000, v43
 v_mul_f32 v25, v25, v58
 v_mul_f32 v26, v26, v53
 v_cvt_pk_bf16_f32 v25, v25, v26
 v_lshlrev_b32 v26, 16, v25
 v_and_b32 v25, 0xffff0000, v25
 v_add_f32 v151, v151, v26
 v_add_f32 v151, v151, v25
 v_lshlrev_b32 v25, 16, v44
 v_and_b32 v26, 0xffff0000, v44
 v_mul_f32 v25, v25, v59
 v_mul_f32 v26, v26, v54
 v_cvt_pk_bf16_f32 v25, v25, v26
 v_lshlrev_b32 v26, 16, v25
 v_and_b32 v25, 0xffff0000, v25
 v_add_f32 v151, v151, v26
 v_add_f32 v151, v151, v25
 v_lshlrev_b32 v25, 16, v45
 v_and_b32 v26, 0xffff0000, v45
 v_mul_f32 v25, v25, v60
 v_mul_f32 v26, v26, v55
 v_cvt_pk_bf16_f32 v25, v25, v26
 v_lshlrev_b32 v26, 16, v25
 v_and_b32 v25, 0xffff0000, v25
 v_add_f32 v151, v151, v26
 v_add_f32 v151, v151, v25
 v_lshlrev_b32 v25, 16, v46
 v_and_b32 v26, 0xffff0000, v46
 v_mul_f32 v25, v25, v61
 v_mul_f32 v26, v26, v56
 v_cvt_pk_bf16_f32 v25, v25, v26
 v_lshlrev_b32 v26, 16, v25
 v_and_b32 v25, 0xffff0000, v25
 v_add_f32 v151, v151, v26
 v_add_f32 v151, v151, v25
 v_add_f32_dpp v144, v144, v144 row_ror:8 row_mask:0xf bank_mask:0xf
 v_add_f32_dpp v145, v145, v145 row_ror:8 row_mask:0xf bank_mask:0xf
 v_add_f32_dpp v146, v146, v146 row_ror:8 row_mask:0xf bank_mask:0xf
 v_add_f32_dpp v147, v147, v147 row_ror:8 row_mask:0xf bank_mask:0xf
 v_add_f32_dpp v148, v148, v148 row_ror:8 row_mask:0xf bank_mask:0xf
 v_add_f32_dpp v149, v149, v149 row_ror:8 row_mask:0xf bank_mask:0xf
 v_add_f32_dpp v150, v150, v150 row_ror:8 row_mask:0xf bank_mask:0xf
 v_add_f32_dpp v151, v151, v151 row_ror:8 row_mask:0xf bank_mask:0xf
 v_add_f32_dpp v144, v144, v144 row_ror:4 row_mask:0xf bank_mask:0xf
 v_add_f32_dpp v145, v145, v145 row_ror:4 row_mask:0xf bank_mask:0xf
 v_add_f32_dpp v146, v146, v146 row_ror:4 row_mask:0xf bank_mask:0xf
 v_add_f32_dpp v147, v147, v147 row_ror:4 row_mask:0xf bank_mask:0xf
 v_add_f32_dpp v148, v148, v148 row_ror:4 row_mask:0xf bank_mask:0xf
 v_add_f32_dpp v149, v149, v149 row_ror:4 row_mask:0xf bank_mask:0xf
 v_add_f32_dpp v150, v150, v150 row_ror:4 row_mask:0xf bank_mask:0xf
 v_add_f32_dpp v151, v151, v151 row_ror:4 row_mask:0xf bank_mask:0xf
 v_add_f32_dpp v144, v144, v144 row_ror:2 row_mask:0xf bank_mask:0xf
 v_add_f32_dpp v145, v145, v145 row_ror:2 row_mask:0xf bank_mask:0xf
 v_add_f32_dpp v146, v146, v146 row_ror:2 row_mask:0xf bank_mask:0xf
 v_add_f32_dpp v147, v147, v147 row_ror:2 row_mask:0xf bank_mask:0xf
 v_add_f32_dpp v148, v148, v148 row_ror:2 row_mask:0xf bank_mask:0xf
 v_add_f32_dpp v149, v149, v149 row_ror:2 row_mask:0xf bank_mask:0xf
 v_add_f32_dpp v150, v150, v150 row_ror:2 row_mask:0xf bank_mask:0xf
 v_add_f32_dpp v151, v151, v151 row_ror:2 row_mask:0xf bank_mask:0xf
 v_add_f32_dpp v144, v144, v144 row_ror:1 row_mask:0xf bank_mask:0xf
 v_add_f32_dpp v145, v145, v145 row_ror:1 row_mask:0xf bank_mask:0xf
 v_add_f32_dpp v146, v146, v146 row_ror:1 row_mask:0xf bank_mask:0xf
 v_add_f32_dpp v147, v147, v147 row_ror:1 row_mask:0xf bank_mask:0xf
 v_add_f32_dpp v148, v148, v148 row_ror:1 row_mask:0xf bank_mask:0xf
 v_add_f32_dpp v149, v149, v149 row_ror:1 row_mask:0xf bank_mask:0xf
 v_add_f32_dpp v150, v150, v150 row_ror:1 row_mask:0xf bank_mask:0xf
 v_add_f32_dpp v151, v151, v151 row_ror:1 row_mask:0xf bank_mask:0xf
 v_mov_b32 v152, v144
 v_mov_b32 v153, v145
 v_mov_b32 v154, v146
 v_mov_b32 v155, v147
 v_mov_b32 v156, v148
 v_mov_b32 v157, v149
 v_mov_b32 v158, v150
 v_mov_b32 v159, v151
 v_permlane32_swap_b32 v144, v152
 v_permlane32_swap_b32 v145, v153
 v_permlane32_swap_b32 v146, v154
 v_permlane32_swap_b32 v147, v155
 v_permlane32_swap_b32 v148, v156
 v_permlane32_swap_b32 v149, v157
 v_permlane32_swap_b32 v150, v158
 v_permlane32_swap_b32 v151, v159
 v_add_f32 v144, v144, v152
 v_add_f32 v145, v145, v153
 v_add_f32 v146, v146, v154
 v_add_f32 v147, v147, v155
 v_add_f32 v148, v148, v156
 v_add_f32 v149, v149, v157
 v_add_f32 v150, v150, v158
 v_add_f32 v151, v151, v159
 v_mov_b32 v152, v144
 v_mov_b32 v153, v145
 v_mov_b32 v154, v146
 v_mov_b32 v155, v147
 v_mov_b32 v156, v148
 v_mov_b32 v157, v149
 v_mov_b32 v158, v150
 v_mov_b32 v159, v151
 v_permlane16_swap_b32 v144, v152
 v_permlane16_swap_b32 v145, v153
 v_permlane16_swap_b32 v146, v154
 v_permlane16_swap_b32 v147, v155
 v_permlane16_swap_b32 v148, v156
 v_permlane16_swap_b32 v149, v157
 v_permlane16_swap_b32 v150, v158
 v_permlane16_swap_b32 v151, v159
 v_add_f32 v144, v144, v152
 v_add_f32 v145, v145, v153
 v_add_f32 v146, v146, v154
 v_add_f32 v147, v147, v155
 v_add_f32 v148, v148, v156
 v_add_f32 v149, v149, v157
 v_add_f32 v150, v150, v158
 v_add_f32 v151, v151, v159
 v_mov_b32 v24, v144
 v_cmp_eq_u32 vcc, 1, v1
 s_nop 1
 v_cndmask_b32 v24, v24, v145, vcc
 v_cmp_eq_u32 vcc, 2, v1
 s_nop 1
 v_cndmask_b32 v24, v24, v146, vcc
 v_cmp_eq_u32 vcc, 3, v1
 s_nop 1
 v_cndmask_b32 v24, v24, v147, vcc
 v_cmp_eq_u32 vcc, 4, v1
 s_nop 1
 v_cndmask_b32 v24, v24, v148, vcc
 v_cmp_eq_u32 vcc, 5, v1
 s_nop 1
 v_cndmask_b32 v24, v24, v149, vcc
 v_cmp_eq_u32 vcc, 6, v1
 s_nop 1
 v_cndmask_b32 v24, v24, v150, vcc
 v_cmp_eq_u32 vcc, 7, v1
 s_nop 1
 v_cndmask_b32 v24, v24, v151, vcc
 v_cvt_pk_bf16_f32 v25, v24, v24
 v_lshlrev_b32 v24, 16, v25
 v_mul_f32 v24, 0xbfb8aa3b, v24
 v_exp_f32 v24, v24
 s_nop 0
 v_add_f32 v24, 1.0, v24
 v_rcp_f32 v24, v24
 s_nop 0
 v_cvt_pk_bf16_f32 v25, v24, v24
 v_lshlrev_b32 v24, 16, v25
 s_lshl_b32 s21, s59, 2
 s_mov_b64 exec, 0xff
 buffer_store_dword v24, v5, s[28:31], s21 offen sc1
 s_mov_b64 exec, -1
 s_sub_u32 s59, s59, 1024
 s_waitcnt vmcnt(1)
 v_lshlrev_b32 v25, 16, v160
 v_and_b32 v26, 0xffff0000, v160
 v_mul_f32 v25, v25, v57
 v_mul_f32 v26, v26, v52
 v_cvt_pk_bf16_f32 v25, v25, v26
 v_lshlrev_b32 v26, 16, v25
 v_and_b32 v25, 0xffff0000, v25
 v_add_f32 v144, v25, v26
 v_lshlrev_b32 v25, 16, v161
 v_and_b32 v26, 0xffff0000, v161
 v_mul_f32 v25, v25, v58
 v_mul_f32 v26, v26, v53
 v_cvt_pk_bf16_f32 v25, v25, v26
 v_lshlrev_b32 v26, 16, v25
 v_and_b32 v25, 0xffff0000, v25
 v_add_f32 v144, v144, v26
 v_add_f32 v144, v144, v25
 v_lshlrev_b32 v25, 16, v162
 v_and_b32 v26, 0xffff0000, v162
 v_mul_f32 v25, v25, v59
 v_mul_f32 v26, v26, v54
 v_cvt_pk_bf16_f32 v25, v25, v26
 v_lshlrev_b32 v26, 16, v25
 v_and_b32 v25, 0xffff0000, v25
 v_add_f32 v144, v144, v26
 v_add_f32 v144, v144, v25
 v_lshlrev_b32 v25, 16, v163
 v_and_b32 v26, 0xffff0000, v163
 v_mul_f32 v25, v25, v60
 v_mul_f32 v26, v26, v55
 v_cvt_pk_bf16_f32 v25, v25, v26
 v_lshlrev_b32 v26, 16, v25
 v_and_b32 v25, 0xffff0000, v25
 v_add_f32 v144, v144, v26
 v_add_f32 v144, v144, v25
 v_lshlrev_b32 v25, 16, v164
 v_and_b32 v26, 0xffff0000, v164
 v_mul_f32 v25, v25, v61
 v_mul_f32 v26, v26, v56
 v_cvt_pk_bf16_f32 v25, v25, v26
 v_lshlrev_b32 v26, 16, v25
 v_and_b32 v25, 0xffff0000, v25
 v_add_f32 v144, v144, v26
 v_add_f32 v144, v144, v25
 v_lshlrev_b32 v25, 16, v166
 v_and_b32 v26, 0xffff0000, v166
 v_mul_f32 v25, v25, v57
 v_mul_f32 v26, v26, v52
 v_cvt_pk_bf16_f32 v25, v25, v26
 v_lshlrev_b32 v26, 16, v25
 v_and_b32 v25, 0xffff0000, v25
 v_add_f32 v145, v25, v26
 v_lshlrev_b32 v25, 16, v167
 v_and_b32 v26, 0xffff0000, v167
 v_mul_f32 v25, v25, v58
 v_mul_f32 v26, v26, v53
 v_cvt_pk_bf16_f32 v25, v25, v26
 v_lshlrev_b32 v26, 16, v25
 v_and_b32 v25, 0xffff0000, v25
 v_add_f32 v145, v145, v26
 v_add_f32 v145, v145, v25
 v_lshlrev_b32 v25, 16, v168
 v_and_b32 v26, 0xffff0000, v168
 v_mul_f32 v25, v25, v59
 v_mul_f32 v26, v26, v54
 v_cvt_pk_bf16_f32 v25, v25, v26
 v_lshlrev_b32 v26, 16, v25
 v_and_b32 v25, 0xffff0000, v25
 v_add_f32 v145, v145, v26
 v_add_f32 v145, v145, v25
 v_lshlrev_b32 v25, 16, v169
 v_and_b32 v26, 0xffff0000, v169
 v_mul_f32 v25, v25, v60
 v_mul_f32 v26, v26, v55
 v_cvt_pk_bf16_f32 v25, v25, v26
 v_lshlrev_b32 v26, 16, v25
 v_and_b32 v25, 0xffff0000, v25
 v_add_f32 v145, v145, v26
 v_add_f32 v145, v145, v25
 v_lshlrev_b32 v25, 16, v170
 v_and_b32 v26, 0xffff0000, v170
 v_mul_f32 v25, v25, v61
 v_mul_f32 v26, v26, v56
 v_cvt_pk_bf16_f32 v25, v25, v26
 v_lshlrev_b32 v26, 16, v25
 v_and_b32 v25, 0xffff0000, v25
 v_add_f32 v145, v145, v26
 v_add_f32 v145, v145, v25
 v_lshlrev_b32 v25, 16, v172
 v_and_b32 v26, 0xffff0000, v172
 v_mul_f32 v25, v25, v57
 v_mul_f32 v26, v26, v52
 v_cvt_pk_bf16_f32 v25, v25, v26
 v_lshlrev_b32 v26, 16, v25
 v_and_b32 v25, 0xffff0000, v25
 v_add_f32 v146, v25, v26
 v_lshlrev_b32 v25, 16, v173
 v_and_b32 v26, 0xffff0000, v173
 v_mul_f32 v25, v25, v58
 v_mul_f32 v26, v26, v53
 v_cvt_pk_bf16_f32 v25, v25, v26
 v_lshlrev_b32 v26, 16, v25
 v_and_b32 v25, 0xffff0000, v25
 v_add_f32 v146, v146, v26
 v_add_f32 v146, v146, v25
 v_lshlrev_b32 v25, 16, v174
 v_and_b32 v26, 0xffff0000, v174
 v_mul_f32 v25, v25, v59
 v_mul_f32 v26, v26, v54
 v_cvt_pk_bf16_f32 v25, v25, v26
 v_lshlrev_b32 v26, 16, v25
 v_and_b32 v25, 0xffff0000, v25
 v_add_f32 v146, v146, v26
 v_add_f32 v146, v146, v25
 v_lshlrev_b32 v25, 16, v175
 v_and_b32 v26, 0xffff0000, v175
 v_mul_f32 v25, v25, v60
 v_mul_f32 v26, v26, v55
 v_cvt_pk_bf16_f32 v25, v25, v26
 v_lshlrev_b32 v26, 16, v25
 v_and_b32 v25, 0xffff0000, v25
 v_add_f32 v146, v146, v26
 v_add_f32 v146, v146, v25
 v_lshlrev_b32 v25, 16, v176
 v_and_b32 v26, 0xffff0000, v176
 v_mul_f32 v25, v25, v61
 v_mul_f32 v26, v26, v56
 v_cvt_pk_bf16_f32 v25, v25, v26
 v_lshlrev_b32 v26, 16, v25
 v_and_b32 v25, 0xffff0000, v25
 v_add_f32 v146, v146, v26
 v_add_f32 v146, v146, v25
 v_lshlrev_b32 v25, 16, v178
 v_and_b32 v26, 0xffff0000, v178
 v_mul_f32 v25, v25, v57
 v_mul_f32 v26, v26, v52
 v_cvt_pk_bf16_f32 v25, v25, v26
 v_lshlrev_b32 v26, 16, v25
 v_and_b32 v25, 0xffff0000, v25
 v_add_f32 v147, v25, v26
 v_lshlrev_b32 v25, 16, v179
 v_and_b32 v26, 0xffff0000, v179
 v_mul_f32 v25, v25, v58
 v_mul_f32 v26, v26, v53
 v_cvt_pk_bf16_f32 v25, v25, v26
 v_lshlrev_b32 v26, 16, v25
 v_and_b32 v25, 0xffff0000, v25
 v_add_f32 v147, v147, v26
 v_add_f32 v147, v147, v25
 v_lshlrev_b32 v25, 16, v180
 v_and_b32 v26, 0xffff0000, v180
 v_mul_f32 v25, v25, v59
 v_mul_f32 v26, v26, v54
 v_cvt_pk_bf16_f32 v25, v25, v26
 v_lshlrev_b32 v26, 16, v25
 v_and_b32 v25, 0xffff0000, v25
 v_add_f32 v147, v147, v26
 v_add_f32 v147, v147, v25
 v_lshlrev_b32 v25, 16, v181
 v_and_b32 v26, 0xffff0000, v181
 v_mul_f32 v25, v25, v60
 v_mul_f32 v26, v26, v55
 v_cvt_pk_bf16_f32 v25, v25, v26
 v_lshlrev_b32 v26, 16, v25
 v_and_b32 v25, 0xffff0000, v25
 v_add_f32 v147, v147, v26
 v_add_f32 v147, v147, v25
 v_lshlrev_b32 v25, 16, v182
 v_and_b32 v26, 0xffff0000, v182
 v_mul_f32 v25, v25, v61
 v_mul_f32 v26, v26, v56
 v_cvt_pk_bf16_f32 v25, v25, v26
 v_lshlrev_b32 v26, 16, v25
 v_and_b32 v25, 0xffff0000, v25
 v_add_f32 v147, v147, v26
 v_add_f32 v147, v147, v25
 v_lshlrev_b32 v25, 16, v184
 v_and_b32 v26, 0xffff0000, v184
 v_mul_f32 v25, v25, v57
 v_mul_f32 v26, v26, v52
 v_cvt_pk_bf16_f32 v25, v25, v26
 v_lshlrev_b32 v26, 16, v25
 v_and_b32 v25, 0xffff0000, v25
 v_add_f32 v148, v25, v26
 v_lshlrev_b32 v25, 16, v185
 v_and_b32 v26, 0xffff0000, v185
 v_mul_f32 v25, v25, v58
 v_mul_f32 v26, v26, v53
 v_cvt_pk_bf16_f32 v25, v25, v26
 v_lshlrev_b32 v26, 16, v25
 v_and_b32 v25, 0xffff0000, v25
 v_add_f32 v148, v148, v26
 v_add_f32 v148, v148, v25
 v_lshlrev_b32 v25, 16, v186
 v_and_b32 v26, 0xffff0000, v186
 v_mul_f32 v25, v25, v59
 v_mul_f32 v26, v26, v54
 v_cvt_pk_bf16_f32 v25, v25, v26
 v_lshlrev_b32 v26, 16, v25
 v_and_b32 v25, 0xffff0000, v25
 v_add_f32 v148, v148, v26
 v_add_f32 v148, v148, v25
 v_lshlrev_b32 v25, 16, v187
 v_and_b32 v26, 0xffff0000, v187
 v_mul_f32 v25, v25, v60
 v_mul_f32 v26, v26, v55
 v_cvt_pk_bf16_f32 v25, v25, v26
 v_lshlrev_b32 v26, 16, v25
 v_and_b32 v25, 0xffff0000, v25
 v_add_f32 v148, v148, v26
 v_add_f32 v148, v148, v25
 v_lshlrev_b32 v25, 16, v188
 v_and_b32 v26, 0xffff0000, v188
 v_mul_f32 v25, v25, v61
 v_mul_f32 v26, v26, v56
 v_cvt_pk_bf16_f32 v25, v25, v26
 v_lshlrev_b32 v26, 16, v25
 v_and_b32 v25, 0xffff0000, v25
 v_add_f32 v148, v148, v26
 v_add_f32 v148, v148, v25
 v_lshlrev_b32 v25, 16, v190
 v_and_b32 v26, 0xffff0000, v190
 v_mul_f32 v25, v25, v57
 v_mul_f32 v26, v26, v52
 v_cvt_pk_bf16_f32 v25, v25, v26
 v_lshlrev_b32 v26, 16, v25
 v_and_b32 v25, 0xffff0000, v25
 v_add_f32 v149, v25, v26
 v_lshlrev_b32 v25, 16, v191
 v_and_b32 v26, 0xffff0000, v191
 v_mul_f32 v25, v25, v58
 v_mul_f32 v26, v26, v53
 v_cvt_pk_bf16_f32 v25, v25, v26
 v_lshlrev_b32 v26, 16, v25
 v_and_b32 v25, 0xffff0000, v25
 v_add_f32 v149, v149, v26
 v_add_f32 v149, v149, v25
 v_lshlrev_b32 v25, 16, v192
 v_and_b32 v26, 0xffff0000, v192
 v_mul_f32 v25, v25, v59
 v_mul_f32 v26, v26, v54
 v_cvt_pk_bf16_f32 v25, v25, v26
 v_lshlrev_b32 v26, 16, v25
 v_and_b32 v25, 0xffff0000, v25
 v_add_f32 v149, v149, v26
 v_add_f32 v149, v149, v25
 v_lshlrev_b32 v25, 16, v193
 v_and_b32 v26, 0xffff0000, v193
 v_mul_f32 v25, v25, v60
 v_mul_f32 v26, v26, v55
 v_cvt_pk_bf16_f32 v25, v25, v26
 v_lshlrev_b32 v26, 16, v25
 v_and_b32 v25, 0xffff0000, v25
 v_add_f32 v149, v149, v26
 v_add_f32 v149, v149, v25
 v_lshlrev_b32 v25, 16, v194
 v_and_b32 v26, 0xffff0000, v194
 v_mul_f32 v25, v25, v61
 v_mul_f32 v26, v26, v56
 v_cvt_pk_bf16_f32 v25, v25, v26
 v_lshlrev_b32 v26, 16, v25
 v_and_b32 v25, 0xffff0000, v25
 v_add_f32 v149, v149, v26
 v_add_f32 v149, v149, v25
 v_lshlrev_b32 v25, 16, v196
 v_and_b32 v26, 0xffff0000, v196
 v_mul_f32 v25, v25, v57
 v_mul_f32 v26, v26, v52
 v_cvt_pk_bf16_f32 v25, v25, v26
 v_lshlrev_b32 v26, 16, v25
 v_and_b32 v25, 0xffff0000, v25
 v_add_f32 v150, v25, v26
 v_lshlrev_b32 v25, 16, v197
 v_and_b32 v26, 0xffff0000, v197
 v_mul_f32 v25, v25, v58
 v_mul_f32 v26, v26, v53
 v_cvt_pk_bf16_f32 v25, v25, v26
 v_lshlrev_b32 v26, 16, v25
 v_and_b32 v25, 0xffff0000, v25
 v_add_f32 v150, v150, v26
 v_add_f32 v150, v150, v25
 v_lshlrev_b32 v25, 16, v198
 v_and_b32 v26, 0xffff0000, v198
 v_mul_f32 v25, v25, v59
 v_mul_f32 v26, v26, v54
 v_cvt_pk_bf16_f32 v25, v25, v26
 v_lshlrev_b32 v26, 16, v25
 v_and_b32 v25, 0xffff0000, v25
 v_add_f32 v150, v150, v26
 v_add_f32 v150, v150, v25
 v_lshlrev_b32 v25, 16, v199
 v_and_b32 v26, 0xffff0000, v199
 v_mul_f32 v25, v25, v60
 v_mul_f32 v26, v26, v55
 v_cvt_pk_bf16_f32 v25, v25, v26
 v_lshlrev_b32 v26, 16, v25
 v_and_b32 v25, 0xffff0000, v25
 v_add_f32 v150, v150, v26
 v_add_f32 v150, v150, v25
 v_lshlrev_b32 v25, 16, v200
 v_and_b32 v26, 0xffff0000, v200
 v_mul_f32 v25, v25, v61
 v_mul_f32 v26, v26, v56
 v_cvt_pk_bf16_f32 v25, v25, v26
 v_lshlrev_b32 v26, 16, v25
 v_and_b32 v25, 0xffff0000, v25
 v_add_f32 v150, v150, v26
 v_add_f32 v150, v150, v25
 v_lshlrev_b32 v25, 16, v202
 v_and_b32 v26, 0xffff0000, v202
 v_mul_f32 v25, v25, v57
 v_mul_f32 v26, v26, v52
 v_cvt_pk_bf16_f32 v25, v25, v26
 v_lshlrev_b32 v26, 16, v25
 v_and_b32 v25, 0xffff0000, v25
 v_add_f32 v151, v25, v26
 v_lshlrev_b32 v25, 16, v203
 v_and_b32 v26, 0xffff0000, v203
 v_mul_f32 v25, v25, v58
 v_mul_f32 v26, v26, v53
 v_cvt_pk_bf16_f32 v25, v25, v26
 v_lshlrev_b32 v26, 16, v25
 v_and_b32 v25, 0xffff0000, v25
 v_add_f32 v151, v151, v26
 v_add_f32 v151, v151, v25
 v_lshlrev_b32 v25, 16, v204
 v_and_b32 v26, 0xffff0000, v204
 v_mul_f32 v25, v25, v59
 v_mul_f32 v26, v26, v54
 v_cvt_pk_bf16_f32 v25, v25, v26
 v_lshlrev_b32 v26, 16, v25
 v_and_b32 v25, 0xffff0000, v25
 v_add_f32 v151, v151, v26
 v_add_f32 v151, v151, v25
 v_lshlrev_b32 v25, 16, v205
 v_and_b32 v26, 0xffff0000, v205
 v_mul_f32 v25, v25, v60
 v_mul_f32 v26, v26, v55
 v_cvt_pk_bf16_f32 v25, v25, v26
 v_lshlrev_b32 v26, 16, v25
 v_and_b32 v25, 0xffff0000, v25
 v_add_f32 v151, v151, v26
 v_add_f32 v151, v151, v25
 v_lshlrev_b32 v25, 16, v206
 v_and_b32 v26, 0xffff0000, v206
 v_mul_f32 v25, v25, v61
 v_mul_f32 v26, v26, v56
 v_cvt_pk_bf16_f32 v25, v25, v26
 v_lshlrev_b32 v26, 16, v25
 v_and_b32 v25, 0xffff0000, v25
 v_add_f32 v151, v151, v26
 v_add_f32 v151, v151, v25
 v_add_f32_dpp v144, v144, v144 row_ror:8 row_mask:0xf bank_mask:0xf
 v_add_f32_dpp v145, v145, v145 row_ror:8 row_mask:0xf bank_mask:0xf
 v_add_f32_dpp v146, v146, v146 row_ror:8 row_mask:0xf bank_mask:0xf
 v_add_f32_dpp v147, v147, v147 row_ror:8 row_mask:0xf bank_mask:0xf
 v_add_f32_dpp v148, v148, v148 row_ror:8 row_mask:0xf bank_mask:0xf
 v_add_f32_dpp v149, v149, v149 row_ror:8 row_mask:0xf bank_mask:0xf
 v_add_f32_dpp v150, v150, v150 row_ror:8 row_mask:0xf bank_mask:0xf
 v_add_f32_dpp v151, v151, v151 row_ror:8 row_mask:0xf bank_mask:0xf
 v_add_f32_dpp v144, v144, v144 row_ror:4 row_mask:0xf bank_mask:0xf
 v_add_f32_dpp v145, v145, v145 row_ror:4 row_mask:0xf bank_mask:0xf
 v_add_f32_dpp v146, v146, v146 row_ror:4 row_mask:0xf bank_mask:0xf
 v_add_f32_dpp v147, v147, v147 row_ror:4 row_mask:0xf bank_mask:0xf
 v_add_f32_dpp v148, v148, v148 row_ror:4 row_mask:0xf bank_mask:0xf
 v_add_f32_dpp v149, v149, v149 row_ror:4 row_mask:0xf bank_mask:0xf
 v_add_f32_dpp v150, v150, v150 row_ror:4 row_mask:0xf bank_mask:0xf
 v_add_f32_dpp v151, v151, v151 row_ror:4 row_mask:0xf bank_mask:0xf
 v_add_f32_dpp v144, v144, v144 row_ror:2 row_mask:0xf bank_mask:0xf
 v_add_f32_dpp v145, v145, v145 row_ror:2 row_mask:0xf bank_mask:0xf
 v_add_f32_dpp v146, v146, v146 row_ror:2 row_mask:0xf bank_mask:0xf
 v_add_f32_dpp v147, v147, v147 row_ror:2 row_mask:0xf bank_mask:0xf
 v_add_f32_dpp v148, v148, v148 row_ror:2 row_mask:0xf bank_mask:0xf
 v_add_f32_dpp v149, v149, v149 row_ror:2 row_mask:0xf bank_mask:0xf
 v_add_f32_dpp v150, v150, v150 row_ror:2 row_mask:0xf bank_mask:0xf
 v_add_f32_dpp v151, v151, v151 row_ror:2 row_mask:0xf bank_mask:0xf
 v_add_f32_dpp v144, v144, v144 row_ror:1 row_mask:0xf bank_mask:0xf
 v_add_f32_dpp v145, v145, v145 row_ror:1 row_mask:0xf bank_mask:0xf
 v_add_f32_dpp v146, v146, v146 row_ror:1 row_mask:0xf bank_mask:0xf
 v_add_f32_dpp v147, v147, v147 row_ror:1 row_mask:0xf bank_mask:0xf
 v_add_f32_dpp v148, v148, v148 row_ror:1 row_mask:0xf bank_mask:0xf
 v_add_f32_dpp v149, v149, v149 row_ror:1 row_mask:0xf bank_mask:0xf
 v_add_f32_dpp v150, v150, v150 row_ror:1 row_mask:0xf bank_mask:0xf
 v_add_f32_dpp v151, v151, v151 row_ror:1 row_mask:0xf bank_mask:0xf
 v_mov_b32 v152, v144
 v_mov_b32 v153, v145
 v_mov_b32 v154, v146
 v_mov_b32 v155, v147
 v_mov_b32 v156, v148
 v_mov_b32 v157, v149
 v_mov_b32 v158, v150
 v_mov_b32 v159, v151
 v_permlane32_swap_b32 v144, v152
 v_permlane32_swap_b32 v145, v153
 v_permlane32_swap_b32 v146, v154
 v_permlane32_swap_b32 v147, v155
 v_permlane32_swap_b32 v148, v156
 v_permlane32_swap_b32 v149, v157
 v_permlane32_swap_b32 v150, v158
 v_permlane32_swap_b32 v151, v159
 v_add_f32 v144, v144, v152
 v_add_f32 v145, v145, v153
 v_add_f32 v146, v146, v154
 v_add_f32 v147, v147, v155
 v_add_f32 v148, v148, v156
 v_add_f32 v149, v149, v157
 v_add_f32 v150, v150, v158
 v_add_f32 v151, v151, v159
 v_mov_b32 v152, v144
 v_mov_b32 v153, v145
 v_mov_b32 v154, v146
 v_mov_b32 v155, v147
 v_mov_b32 v156, v148
 v_mov_b32 v157, v149
 v_mov_b32 v158, v150
 v_mov_b32 v159, v151
 v_permlane16_swap_b32 v144, v152
 v_permlane16_swap_b32 v145, v153
 v_permlane16_swap_b32 v146, v154
 v_permlane16_swap_b32 v147, v155
 v_permlane16_swap_b32 v148, v156
 v_permlane16_swap_b32 v149, v157
 v_permlane16_swap_b32 v150, v158
 v_permlane16_swap_b32 v151, v159
 v_add_f32 v144, v144, v152
 v_add_f32 v145, v145, v153
 v_add_f32 v146, v146, v154
 v_add_f32 v147, v147, v155
 v_add_f32 v148, v148, v156
 v_add_f32 v149, v149, v157
 v_add_f32 v150, v150, v158
 v_add_f32 v151, v151, v159
 v_mov_b32 v24, v144
 v_cmp_eq_u32 vcc, 1, v1
 s_nop 1
 v_cndmask_b32 v24, v24, v145, vcc
 v_cmp_eq_u32 vcc, 2, v1
 s_nop 1
 v_cndmask_b32 v24, v24, v146, vcc
 v_cmp_eq_u32 vcc, 3, v1
 s_nop 1
 v_cndmask_b32 v24, v24, v147, vcc
 v_cmp_eq_u32 vcc, 4, v1
 s_nop 1
 v_cndmask_b32 v24, v24, v148, vcc
 v_cmp_eq_u32 vcc, 5, v1
 s_nop 1
 v_cndmask_b32 v24, v24, v149, vcc
 v_cmp_eq_u32 vcc, 6, v1
 s_nop 1
 v_cndmask_b32 v24, v24, v150, vcc
 v_cmp_eq_u32 vcc, 7, v1
 s_nop 1
 v_cndmask_b32 v24, v24, v151, vcc
 v_cvt_pk_bf16_f32 v25, v24, v24
 v_lshlrev_b32 v24, 16, v25
 v_mul_f32 v24, 0xbfb8aa3b, v24
 v_exp_f32 v24, v24
 s_nop 0
 v_add_f32 v24, 1.0, v24
 v_rcp_f32 v24, v24
 s_nop 0
 v_cvt_pk_bf16_f32 v25, v24, v24
 v_lshlrev_b32 v24, 16, v25
 s_lshl_b32 s21, s59, 2
 s_mov_b64 exec, 0xff
 buffer_store_dword v24, v5, s[28:31], s21 offen sc1
 s_mov_b64 exec, -1
 s_waitcnt vmcnt(0)
 s_barrier
 s_lshr_b32 s21, s2, 2
 s_lshl_b32 s21, s21, 7
 s_add_u32 s21, s21, 92160
 s_cmp_lg_u32 s20, 0
 s_cbranch_scc1 af_234
 v_mov_b32 v10, 0
 v_mov_b32 v11, 1
 s_mov_b64 exec, 1
 buffer_atomic_add v11, v10, s[72:75], s21 offen sc1
 s_mov_b64 exec, -1
 s_nop 1
af_234:
 s_branch om_233
om_232:
 s_load_dwordx2 s[8:9], s[0:1], 88
 s_mov_b32 s51, s21
 s_lshr_b32 s52, s2, 2
 s_lshl_b32 s52, s52, 7
 s_add_u32 s21, s52, 93184
 s_cmp_lg_u32 s20, 0
 s_cbranch_scc1 wf_236
 v_mov_b32 v20, 0
 s_mov_b32 s101, 0
wf_235:
 buffer_load_dword v21, v20, s[72:75], s21 offen sc1
 s_add_u32 s101, s101, 1
 s_cmp_gt_u32 s101, 131072
 s_cbranch_scc1 main_end
 s_waitcnt vmcnt(0)
 v_readfirstlane_b32 s100, v21
 s_cmp_ge_u32 s100, 4
 s_cbranch_scc1 wf_236
 s_sleep 32
 s_branch wf_235
wf_236:
 s_barrier
 s_add_u32 s21, s52, 115712
 s_cmp_lg_u32 s20, 0
 s_cbranch_scc1 wf_238
 v_mov_b32 v20, 0
 s_mov_b32 s101, 0
wf_237:
 buffer_load_dword v21, v20, s[72:75], s21 offen sc1
 s_add_u32 s101, s101, 1
 s_cmp_gt_u32 s101, 131072
 s_cbranch_scc1 main_end
 s_waitcnt vmcnt(0)
 v_readfirstlane_b32 s100, v21
 s_cmp_ge_u32 s100, 32
 s_cbranch_scc1 wf_238
 s_sleep 32
 s_branch wf_237
wf_238:
 s_barrier
 v_lshlrev_b32 v6, 2, v2
 s_lshl_b32 s22, s47, 6
 buffer_load_dword v30, v6, s[28:31], s22 offen sc1
 buffer_load_dword v31, v6, s[28:31], s22 offen offset:64 sc1
 s_add_u32 s22, s51, 0
 buffer_load_dwordx4 v[144:147], v4, s[16:19], s22 offen offset:0 sc1
 buffer_load_dwordx4 v[148:151], v4, s[16:19], s22 offen offset:1024 sc1
 buffer_load_dwordx4 v[152:155], v4, s[16:19], s22 offen offset:2048 sc1
 buffer_load_dwordx4 v[156:159], v4, s[16:19], s22 offen offset:3072 sc1
 s_add_u32 s22, s51, 4096
 buffer_load_dwordx4 v[160:163], v4, s[16:19], s22 offen offset:0 sc1
 buffer_load_dwordx4 v[164:167], v4, s[16:19], s22 offen offset:1024 sc1
 buffer_load_dwordx4 v[168:171], v4, s[16:19], s22 offen offset:2048 sc1
 buffer_load_dwordx4 v[172:175], v4, s[16:19], s22 offen offset:3072 sc1
 s_add_u32 s22, s51, 8192
 buffer_load_dwordx4 v[176:179], v4, s[16:19], s22 offen offset:0 sc1
 buffer_load_dwordx4 v[180:183], v4, s[16:19], s22 offen offset:1024 sc1
 s_add_u32 s22, s51, 40960
 buffer_load_dwordx4 v[184:187], v4, s[16:19], s22 offen offset:0 sc1
 buffer_load_dwordx4 v[188:191], v4, s[16:19], s22 offen offset:1024 sc1
 buffer_load_dwordx4 v[192:195], v4, s[16:19], s22 offen offset:2048 sc1
 buffer_load_dwordx4 v[196:199], v4, s[16:19], s22 offen offset:3072 sc1
 s_add_u32 s22, s51, 45056
 buffer_load_dwordx4 v[200:203], v4, s[16:19], s22 offen offset:0 sc1
 buffer_load_dwordx4 v[204:207], v4, s[16:19], s22 offen offset:1024 sc1
 buffer_load_dwordx4 v[208:211], v4, s[16:19], s22 offen offset:2048 sc1
 buffer_load_dwordx4 v[212:215], v4, s[16:19], s22 offen offset:3072 sc1
 s_add_u32 s22, s51, 49152
 buffer_load_dwordx4 v[216:219], v4, s[16:19], s22 offen offset:0 sc1
 buffer_load_dwordx4 v[220:223], v4, s[16:19], s22 offen offset:1024 sc1
 v_mul_u32_u24 v9, 1280, v2
 v_lshl_add_u32 v9, v3, 3, v9
 s_mul_i32 s22, s47, 20480
 s_add_u32 s22, s22, s45
 s_add_u32 s23, s22, 20480
 s_waitcnt vmcnt(20) lgkmcnt(0)
 v_sub_f32 v32, 1.0, v30
 v_sub_f32 v33, 1.0, v31
 v_cvt_pk_bf16_f32 v26, v32, v33
 v_lshlrev_b32 v32, 16, v26
 v_and_b32 v33, 0xffff0000, v26
 v_cvt_pk_bf16_f32 v26, v64, v65
 v_lshlrev_b32 v64, 16, v26
 v_and_b32 v65, 0xffff0000, v26
 v_mul_f32 v64, v64, v32
 v_mul_f32 v65, v65, v32
 v_cvt_pk_bf16_f32 v26, v64, v65
 v_lshlrev_b32 v64, 16, v26
 v_and_b32 v65, 0xffff0000, v26
 v_cvt_pk_bf16_f32 v26, v66, v67
 v_lshlrev_b32 v66, 16, v26
 v_and_b32 v67, 0xffff0000, v26
 v_mul_f32 v66, v66, v32
 v_mul_f32 v67, v67, v32
 v_cvt_pk_bf16_f32 v26, v66, v67
 v_lshlrev_b32 v66, 16, v26
 v_and_b32 v67, 0xffff0000, v26
 v_cvt_pk_bf16_f32 v26, v68, v69
 v_lshlrev_b32 v68, 16, v26
 v_and_b32 v69, 0xffff0000, v26
 v_mul_f32 v68, v68, v32
 v_mul_f32 v69, v69, v32
 v_cvt_pk_bf16_f32 v26, v68, v69
 v_lshlrev_b32 v68, 16, v26
 v_and_b32 v69, 0xffff0000, v26
 v_cvt_pk_bf16_f32 v26, v70, v71
 v_lshlrev_b32 v70, 16, v26
 v_and_b32 v71, 0xffff0000, v26
 v_mul_f32 v70, v70, v32
 v_mul_f32 v71, v71, v32
 v_cvt_pk_bf16_f32 v26, v70, v71
 v_lshlrev_b32 v70, 16, v26
 v_and_b32 v71, 0xffff0000, v26
 v_cvt_pk_bf16_f32 v26, v72, v73
 v_lshlrev_b32 v72, 16, v26
 v_and_b32 v73, 0xffff0000, v26
 v_mul_f32 v72, v72, v32
 v_mul_f32 v73, v73, v32
 v_cvt_pk_bf16_f32 v26, v72, v73
 v_lshlrev_b32 v72, 16, v26
 v_and_b32 v73, 0xffff0000, v26
 v_cvt_pk_bf16_f32 v26, v74, v75
 v_lshlrev_b32 v74, 16, v26
 v_and_b32 v75, 0xffff0000, v26
 v_mul_f32 v74, v74, v32
 v_mul_f32 v75, v75, v32
 v_cvt_pk_bf16_f32 v26, v74, v75
 v_lshlrev_b32 v74, 16, v26
 v_and_b32 v75, 0xffff0000, v26
 v_cvt_pk_bf16_f32 v26, v76, v77
 v_lshlrev_b32 v76, 16, v26
 v_and_b32 v77, 0xffff0000, v26
 v_mul_f32 v76, v76, v32
 v_mul_f32 v77, v77, v32
 v_cvt_pk_bf16_f32 v26, v76, v77
 v_lshlrev_b32 v76, 16, v26
 v_and_b32 v77, 0xffff0000, v26
 v_cvt_pk_bf16_f32 v26, v78, v79
 v_lshlrev_b32 v78, 16, v26
 v_and_b32 v79, 0xffff0000, v26
 v_mul_f32 v78, v78, v32
 v_mul_f32 v79, v79, v32
 v_cvt_pk_bf16_f32 v26, v78, v79
 v_lshlrev_b32 v78, 16, v26
 v_and_b32 v79, 0xffff0000, v26
 v_cvt_pk_bf16_f32 v26, v80, v81
 v_lshlrev_b32 v80, 16, v26
 v_and_b32 v81, 0xffff0000, v26
 v_mul_f32 v80, v80, v32
 v_mul_f32 v81, v81, v32
 v_cvt_pk_bf16_f32 v26, v80, v81
 v_lshlrev_b32 v80, 16, v26
 v_and_b32 v81, 0xffff0000, v26
 v_cvt_pk_bf16_f32 v26, v82, v83
 v_lshlrev_b32 v82, 16, v26
 v_and_b32 v83, 0xffff0000, v26
 v_mul_f32 v82, v82, v32
 v_mul_f32 v83, v83, v32
 v_cvt_pk_bf16_f32 v26, v82, v83
 v_lshlrev_b32 v82, 16, v26
 v_and_b32 v83, 0xffff0000, v26
 v_cvt_pk_bf16_f32 v26, v84, v85
 v_lshlrev_b32 v84, 16, v26
 v_and_b32 v85, 0xffff0000, v26
 v_mul_f32 v84, v84, v32
 v_mul_f32 v85, v85, v32
 v_cvt_pk_bf16_f32 v26, v84, v85
 v_lshlrev_b32 v84, 16, v26
 v_and_b32 v85, 0xffff0000, v26
 v_cvt_pk_bf16_f32 v26, v86, v87
 v_lshlrev_b32 v86, 16, v26
 v_and_b32 v87, 0xffff0000, v26
 v_mul_f32 v86, v86, v32
 v_mul_f32 v87, v87, v32
 v_cvt_pk_bf16_f32 v26, v86, v87
 v_lshlrev_b32 v86, 16, v26
 v_and_b32 v87, 0xffff0000, v26
 v_cvt_pk_bf16_f32 v26, v88, v89
 v_lshlrev_b32 v88, 16, v26
 v_and_b32 v89, 0xffff0000, v26
 v_mul_f32 v88, v88, v32
 v_mul_f32 v89, v89, v32
 v_cvt_pk_bf16_f32 v26, v88, v89
 v_lshlrev_b32 v88, 16, v26
 v_and_b32 v89, 0xffff0000, v26
 v_cvt_pk_bf16_f32 v26, v90, v91
 v_lshlrev_b32 v90, 16, v26
 v_and_b32 v91, 0xffff0000, v26
 v_mul_f32 v90, v90, v32
 v_mul_f32 v91, v91, v32
 v_cvt_pk_bf16_f32 v26, v90, v91
 v_lshlrev_b32 v90, 16, v26
 v_and_b32 v91, 0xffff0000, v26
 v_cvt_pk_bf16_f32 v26, v92, v93
 v_lshlrev_b32 v92, 16, v26
 v_and_b32 v93, 0xffff0000, v26
 v_mul_f32 v92, v92, v32
 v_mul_f32 v93, v93, v32
 v_cvt_pk_bf16_f32 v26, v92, v93
 v_lshlrev_b32 v92, 16, v26
 v_and_b32 v93, 0xffff0000, v26
 v_cvt_pk_bf16_f32 v26, v94, v95
 v_lshlrev_b32 v94, 16, v26
 v_and_b32 v95, 0xffff0000, v26
 v_mul_f32 v94, v94, v32
 v_mul_f32 v95, v95, v32
 v_cvt_pk_bf16_f32 v26, v94, v95
 v_lshlrev_b32 v94, 16, v26
 v_and_b32 v95, 0xffff0000, v26
 v_cvt_pk_bf16_f32 v26, v96, v97
 v_lshlrev_b32 v96, 16, v26
 v_and_b32 v97, 0xffff0000, v26
 v_mul_f32 v96, v96, v32
 v_mul_f32 v97, v97, v32
 v_cvt_pk_bf16_f32 v26, v96, v97
 v_lshlrev_b32 v96, 16, v26
 v_and_b32 v97, 0xffff0000, v26
 v_cvt_pk_bf16_f32 v26, v98, v99
 v_lshlrev_b32 v98, 16, v26
 v_and_b32 v99, 0xffff0000, v26
 v_mul_f32 v98, v98, v32
 v_mul_f32 v99, v99, v32
 v_cvt_pk_bf16_f32 v26, v98, v99
 v_lshlrev_b32 v98, 16, v26
 v_and_b32 v99, 0xffff0000, v26
 v_cvt_pk_bf16_f32 v26, v100, v101
 v_lshlrev_b32 v100, 16, v26
 v_and_b32 v101, 0xffff0000, v26
 v_mul_f32 v100, v100, v32
 v_mul_f32 v101, v101, v32
 v_cvt_pk_bf16_f32 v26, v100, v101
 v_lshlrev_b32 v100, 16, v26
 v_and_b32 v101, 0xffff0000, v26
 v_cvt_pk_bf16_f32 v26, v102, v103
 v_lshlrev_b32 v102, 16, v26
 v_and_b32 v103, 0xffff0000, v26
 v_mul_f32 v102, v102, v32
 v_mul_f32 v103, v103, v32
 v_cvt_pk_bf16_f32 v26, v102, v103
 v_lshlrev_b32 v102, 16, v26
 v_and_b32 v103, 0xffff0000, v26
 v_cvt_pk_bf16_f32 v26, v104, v105
 v_lshlrev_b32 v104, 16, v26
 v_and_b32 v105, 0xffff0000, v26
 v_mul_f32 v104, v104, v33
 v_mul_f32 v105, v105, v33
 v_cvt_pk_bf16_f32 v26, v104, v105
 v_lshlrev_b32 v104, 16, v26
 v_and_b32 v105, 0xffff0000, v26
 v_cvt_pk_bf16_f32 v26, v106, v107
 v_lshlrev_b32 v106, 16, v26
 v_and_b32 v107, 0xffff0000, v26
 v_mul_f32 v106, v106, v33
 v_mul_f32 v107, v107, v33
 v_cvt_pk_bf16_f32 v26, v106, v107
 v_lshlrev_b32 v106, 16, v26
 v_and_b32 v107, 0xffff0000, v26
 v_cvt_pk_bf16_f32 v26, v108, v109
 v_lshlrev_b32 v108, 16, v26
 v_and_b32 v109, 0xffff0000, v26
 v_mul_f32 v108, v108, v33
 v_mul_f32 v109, v109, v33
 v_cvt_pk_bf16_f32 v26, v108, v109
 v_lshlrev_b32 v108, 16, v26
 v_and_b32 v109, 0xffff0000, v26
 v_cvt_pk_bf16_f32 v26, v110, v111
 v_lshlrev_b32 v110, 16, v26
 v_and_b32 v111, 0xffff0000, v26
 v_mul_f32 v110, v110, v33
 v_mul_f32 v111, v111, v33
 v_cvt_pk_bf16_f32 v26, v110, v111
 v_lshlrev_b32 v110, 16, v26
 v_and_b32 v111, 0xffff0000, v26
 v_cvt_pk_bf16_f32 v26, v112, v113
 v_lshlrev_b32 v112, 16, v26
 v_and_b32 v113, 0xffff0000, v26
 v_mul_f32 v112, v112, v33
 v_mul_f32 v113, v113, v33
 v_cvt_pk_bf16_f32 v26, v112, v113
 v_lshlrev_b32 v112, 16, v26
 v_and_b32 v113, 0xffff0000, v26
 v_cvt_pk_bf16_f32 v26, v114, v115
 v_lshlrev_b32 v114, 16, v26
 v_and_b32 v115, 0xffff0000, v26
 v_mul_f32 v114, v114, v33
 v_mul_f32 v115, v115, v33
 v_cvt_pk_bf16_f32 v26, v114, v115
 v_lshlrev_b32 v114, 16, v26
 v_and_b32 v115, 0xffff0000, v26
 v_cvt_pk_bf16_f32 v26, v116, v117
 v_lshlrev_b32 v116, 16, v26
 v_and_b32 v117, 0xffff0000, v26
 v_mul_f32 v116, v116, v33
 v_mul_f32 v117, v117, v33
 v_cvt_pk_bf16_f32 v26, v116, v117
 v_lshlrev_b32 v116, 16, v26
 v_and_b32 v117, 0xffff0000, v26
 v_cvt_pk_bf16_f32 v26, v118, v119
 v_lshlrev_b32 v118, 16, v26
 v_and_b32 v119, 0xffff0000, v26
 v_mul_f32 v118, v118, v33
 v_mul_f32 v119, v119, v33
 v_cvt_pk_bf16_f32 v26, v118, v119
 v_lshlrev_b32 v118, 16, v26
 v_and_b32 v119, 0xffff0000, v26
 v_cvt_pk_bf16_f32 v26, v120, v121
 v_lshlrev_b32 v120, 16, v26
 v_and_b32 v121, 0xffff0000, v26
 v_mul_f32 v120, v120, v33
 v_mul_f32 v121, v121, v33
 v_cvt_pk_bf16_f32 v26, v120, v121
 v_lshlrev_b32 v120, 16, v26
 v_and_b32 v121, 0xffff0000, v26
 v_cvt_pk_bf16_f32 v26, v122, v123
 v_lshlrev_b32 v122, 16, v26
 v_and_b32 v123, 0xffff0000, v26
 v_mul_f32 v122, v122, v33
 v_mul_f32 v123, v123, v33
 v_cvt_pk_bf16_f32 v26, v122, v123
 v_lshlrev_b32 v122, 16, v26
 v_and_b32 v123, 0xffff0000, v26
 v_cvt_pk_bf16_f32 v26, v124, v125
 v_lshlrev_b32 v124, 16, v26
 v_and_b32 v125, 0xffff0000, v26
 v_mul_f32 v124, v124, v33
 v_mul_f32 v125, v125, v33
 v_cvt_pk_bf16_f32 v26, v124, v125
 v_lshlrev_b32 v124, 16, v26
 v_and_b32 v125, 0xffff0000, v26
 v_cvt_pk_bf16_f32 v26, v126, v127
 v_lshlrev_b32 v126, 16, v26
 v_and_b32 v127, 0xffff0000, v26
 v_mul_f32 v126, v126, v33
 v_mul_f32 v127, v127, v33
 v_cvt_pk_bf16_f32 v26, v126, v127
 v_lshlrev_b32 v126, 16, v26
 v_and_b32 v127, 0xffff0000, v26
 v_cvt_pk_bf16_f32 v26, v128, v129
 v_lshlrev_b32 v128, 16, v26
 v_and_b32 v129, 0xffff0000, v26
 v_mul_f32 v128, v128, v33
 v_mul_f32 v129, v129, v33
 v_cvt_pk_bf16_f32 v26, v128, v129
 v_lshlrev_b32 v128, 16, v26
 v_and_b32 v129, 0xffff0000, v26
 v_cvt_pk_bf16_f32 v26, v130, v131
 v_lshlrev_b32 v130, 16, v26
 v_and_b32 v131, 0xffff0000, v26
 v_mul_f32 v130, v130, v33
 v_mul_f32 v131, v131, v33
 v_cvt_pk_bf16_f32 v26, v130, v131
 v_lshlrev_b32 v130, 16, v26
 v_and_b32 v131, 0xffff0000, v26
 v_cvt_pk_bf16_f32 v26, v132, v133
 v_lshlrev_b32 v132, 16, v26
 v_and_b32 v133, 0xffff0000, v26
 v_mul_f32 v132, v132, v33
 v_mul_f32 v133, v133, v33
 v_cvt_pk_bf16_f32 v26, v132, v133
 v_lshlrev_b32 v132, 16, v26
 v_and_b32 v133, 0xffff0000, v26
 v_cvt_pk_bf16_f32 v26, v134, v135
 v_lshlrev_b32 v134, 16, v26
 v_and_b32 v135, 0xffff0000, v26
 v_mul_f32 v134, v134, v33
 v_mul_f32 v135, v135, v33
 v_cvt_pk_bf16_f32 v26, v134, v135
 v_lshlrev_b32 v134, 16, v26
 v_and_b32 v135, 0xffff0000, v26
 v_cvt_pk_bf16_f32 v26, v136, v137
 v_lshlrev_b32 v136, 16, v26
 v_and_b32 v137, 0xffff0000, v26
 v_mul_f32 v136, v136, v33
 v_mul_f32 v137, v137, v33
 v_cvt_pk_bf16_f32 v26, v136, v137
 v_lshlrev_b32 v136, 16, v26
 v_and_b32 v137, 0xffff0000, v26
 v_cvt_pk_bf16_f32 v26, v138, v139
 v_lshlrev_b32 v138, 16, v26
 v_and_b32 v139, 0xffff0000, v26
 v_mul_f32 v138, v138, v33
 v_mul_f32 v139, v139, v33
 v_cvt_pk_bf16_f32 v26, v138, v139
 v_lshlrev_b32 v138, 16, v26
 v_and_b32 v139, 0xffff0000, v26
 v_cvt_pk_bf16_f32 v26, v140, v141
 v_lshlrev_b32 v140, 16, v26
 v_and_b32 v141, 0xffff0000, v26
 v_mul_f32 v140, v140, v33
 v_mul_f32 v141, v141, v33
 v_cvt_pk_bf16_f32 v26, v140, v141
 v_lshlrev_b32 v140, 16, v26
 v_and_b32 v141, 0xffff0000, v26
 v_cvt_pk_bf16_f32 v26, v142, v143
 v_lshlrev_b32 v142, 16, v26
 v_and_b32 v143, 0xffff0000, v26
 v_mul_f32 v142, v142, v33
 v_mul_f32 v143, v143, v33
 v_cvt_pk_bf16_f32 v26, v142, v143
 v_lshlrev_b32 v142, 16, v26
 v_and_b32 v143, 0xffff0000, v26
 s_waitcnt vmcnt(19)
 v_cvt_pk_bf16_f32 v26, v144, v145
 v_lshlrev_b32 v144, 16, v26
 v_and_b32 v145, 0xffff0000, v26
 v_mul_f32 v144, v144, v30
 v_mul_f32 v145, v145, v30
 v_cvt_pk_bf16_f32 v26, v144, v145
 v_lshlrev_b32 v144, 16, v26
 v_and_b32 v145, 0xffff0000, v26
 v_add_f32 v144, v144, v64
 v_add_f32 v145, v145, v65
 v_cvt_pk_bf16_f32 v64, v144, v145
 v_cvt_pk_bf16_f32 v26, v146, v147
 v_lshlrev_b32 v146, 16, v26
 v_and_b32 v147, 0xffff0000, v26
 v_mul_f32 v146, v146, v30
 v_mul_f32 v147, v147, v30
 v_cvt_pk_bf16_f32 v26, v146, v147
 v_lshlrev_b32 v146, 16, v26
 v_and_b32 v147, 0xffff0000, v26
 v_add_f32 v146, v146, v66
 v_add_f32 v147, v147, v67
 v_cvt_pk_bf16_f32 v65, v146, v147
 buffer_store_dwordx2 v[64:65], v9, s[8:11], s22 offen offset:0
 s_waitcnt vmcnt(19)
 v_cvt_pk_bf16_f32 v26, v148, v149
 v_lshlrev_b32 v148, 16, v26
 v_and_b32 v149, 0xffff0000, v26
 v_mul_f32 v148, v148, v30
 v_mul_f32 v149, v149, v30
 v_cvt_pk_bf16_f32 v26, v148, v149
 v_lshlrev_b32 v148, 16, v26
 v_and_b32 v149, 0xffff0000, v26
 v_add_f32 v148, v148, v68
 v_add_f32 v149, v149, v69
 v_cvt_pk_bf16_f32 v68, v148, v149
 v_cvt_pk_bf16_f32 v26, v150, v151
 v_lshlrev_b32 v150, 16, v26
 v_and_b32 v151, 0xffff0000, v26
 v_mul_f32 v150, v150, v30
 v_mul_f32 v151, v151, v30
 v_cvt_pk_bf16_f32 v26, v150, v151
 v_lshlrev_b32 v150, 16, v26
 v_and_b32 v151, 0xffff0000, v26
 v_add_f32 v150, v150, v70
 v_add_f32 v151, v151, v71
 v_cvt_pk_bf16_f32 v69, v150, v151
 buffer_store_dwordx2 v[68:69], v9, s[8:11], s22 offen offset:32
 s_waitcnt vmcnt(19)
 v_cvt_pk_bf16_f32 v26, v152, v153
 v_lshlrev_b32 v152, 16, v26
 v_and_b32 v153, 0xffff0000, v26
 v_mul_f32 v152, v152, v30
 v_mul_f32 v153, v153, v30
 v_cvt_pk_bf16_f32 v26, v152, v153
 v_lshlrev_b32 v152, 16, v26
 v_and_b32 v153, 0xffff0000, v26
 v_add_f32 v152, v152, v72
 v_add_f32 v153, v153, v73
 v_cvt_pk_bf16_f32 v72, v152, v153
 v_cvt_pk_bf16_f32 v26, v154, v155
 v_lshlrev_b32 v154, 16, v26
 v_and_b32 v155, 0xffff0000, v26
 v_mul_f32 v154, v154, v30
 v_mul_f32 v155, v155, v30
 v_cvt_pk_bf16_f32 v26, v154, v155
 v_lshlrev_b32 v154, 16, v26
 v_and_b32 v155, 0xffff0000, v26
 v_add_f32 v154, v154, v74
 v_add_f32 v155, v155, v75
 v_cvt_pk_bf16_f32 v73, v154, v155
 buffer_store_dwordx2 v[72:73], v9, s[8:11], s22 offen offset:64
 s_waitcnt vmcnt(19)
 v_cvt_pk_bf16_f32 v26, v156, v157
 v_lshlrev_b32 v156, 16, v26
 v_and_b32 v157, 0xffff0000, v26
 v_mul_f32 v156, v156, v30
 v_mul_f32 v157, v157, v30
 v_cvt_pk_bf16_f32 v26, v156, v157
 v_lshlrev_b32 v156, 16, v26
 v_and_b32 v157, 0xffff0000, v26
 v_add_f32 v156, v156, v76
 v_add_f32 v157, v157, v77
 v_cvt_pk_bf16_f32 v76, v156, v157
 v_cvt_pk_bf16_f32 v26, v158, v159
 v_lshlrev_b32 v158, 16, v26
 v_and_b32 v159, 0xffff0000, v26
 v_mul_f32 v158, v158, v30
 v_mul_f32 v159, v159, v30
 v_cvt_pk_bf16_f32 v26, v158, v159
 v_lshlrev_b32 v158, 16, v26
 v_and_b32 v159, 0xffff0000, v26
 v_add_f32 v158, v158, v78
 v_add_f32 v159, v159, v79
 v_cvt_pk_bf16_f32 v77, v158, v159
 buffer_store_dwordx2 v[76:77], v9, s[8:11], s22 offen offset:96
 s_waitcnt vmcnt(19)
 v_cvt_pk_bf16_f32 v26, v160, v161
 v_lshlrev_b32 v160, 16, v26
 v_and_b32 v161, 0xffff0000, v26
 v_mul_f32 v160, v160, v30
 v_mul_f32 v161, v161, v30
 v_cvt_pk_bf16_f32 v26, v160, v161
 v_lshlrev_b32 v160, 16, v26
 v_and_b32 v161, 0xffff0000, v26
 v_add_f32 v160, v160, v80
 v_add_f32 v161, v161, v81
 v_cvt_pk_bf16_f32 v80, v160, v161
 v_cvt_pk_bf16_f32 v26, v162, v163
 v_lshlrev_b32 v162, 16, v26
 v_and_b32 v163, 0xffff0000, v26
 v_mul_f32 v162, v162, v30
 v_mul_f32 v163, v163, v30
 v_cvt_pk_bf16_f32 v26, v162, v163
 v_lshlrev_b32 v162, 16, v26
 v_and_b32 v163, 0xffff0000, v26
 v_add_f32 v162, v162, v82
 v_add_f32 v163, v163, v83
 v_cvt_pk_bf16_f32 v81, v162, v163
 buffer_store_dwordx2 v[80:81], v9, s[8:11], s22 offen offset:128
 s_waitcnt vmcnt(19)
 v_cvt_pk_bf16_f32 v26, v164, v165
 v_lshlrev_b32 v164, 16, v26
 v_and_b32 v165, 0xffff0000, v26
 v_mul_f32 v164, v164, v30
 v_mul_f32 v165, v165, v30
 v_cvt_pk_bf16_f32 v26, v164, v165
 v_lshlrev_b32 v164, 16, v26
 v_and_b32 v165, 0xffff0000, v26
 v_add_f32 v164, v164, v84
 v_add_f32 v165, v165, v85
 v_cvt_pk_bf16_f32 v84, v164, v165
 v_cvt_pk_bf16_f32 v26, v166, v167
 v_lshlrev_b32 v166, 16, v26
 v_and_b32 v167, 0xffff0000, v26
 v_mul_f32 v166, v166, v30
 v_mul_f32 v167, v167, v30
 v_cvt_pk_bf16_f32 v26, v166, v167
 v_lshlrev_b32 v166, 16, v26
 v_and_b32 v167, 0xffff0000, v26
 v_add_f32 v166, v166, v86
 v_add_f32 v167, v167, v87
 v_cvt_pk_bf16_f32 v85, v166, v167
 buffer_store_dwordx2 v[84:85], v9, s[8:11], s22 offen offset:160
 s_waitcnt vmcnt(19)
 v_cvt_pk_bf16_f32 v26, v168, v169
 v_lshlrev_b32 v168, 16, v26
 v_and_b32 v169, 0xffff0000, v26
 v_mul_f32 v168, v168, v30
 v_mul_f32 v169, v169, v30
 v_cvt_pk_bf16_f32 v26, v168, v169
 v_lshlrev_b32 v168, 16, v26
 v_and_b32 v169, 0xffff0000, v26
 v_add_f32 v168, v168, v88
 v_add_f32 v169, v169, v89
 v_cvt_pk_bf16_f32 v88, v168, v169
 v_cvt_pk_bf16_f32 v26, v170, v171
 v_lshlrev_b32 v170, 16, v26
 v_and_b32 v171, 0xffff0000, v26
 v_mul_f32 v170, v170, v30
 v_mul_f32 v171, v171, v30
 v_cvt_pk_bf16_f32 v26, v170, v171
 v_lshlrev_b32 v170, 16, v26
 v_and_b32 v171, 0xffff0000, v26
 v_add_f32 v170, v170, v90
 v_add_f32 v171, v171, v91
 v_cvt_pk_bf16_f32 v89, v170, v171
 buffer_store_dwordx2 v[88:89], v9, s[8:11], s22 offen offset:192
 s_waitcnt vmcnt(19)
 v_cvt_pk_bf16_f32 v26, v172, v173
 v_lshlrev_b32 v172, 16, v26
 v_and_b32 v173, 0xffff0000, v26
 v_mul_f32 v172, v172, v30
 v_mul_f32 v173, v173, v30
 v_cvt_pk_bf16_f32 v26, v172, v173
 v_lshlrev_b32 v172, 16, v26
 v_and_b32 v173, 0xffff0000, v26
 v_add_f32 v172, v172, v92
 v_add_f32 v173, v173, v93
 v_cvt_pk_bf16_f32 v92, v172, v173
 v_cvt_pk_bf16_f32 v26, v174, v175
 v_lshlrev_b32 v174, 16, v26
 v_and_b32 v175, 0xffff0000, v26
 v_mul_f32 v174, v174, v30
 v_mul_f32 v175, v175, v30
 v_cvt_pk_bf16_f32 v26, v174, v175
 v_lshlrev_b32 v174, 16, v26
 v_and_b32 v175, 0xffff0000, v26
 v_add_f32 v174, v174, v94
 v_add_f32 v175, v175, v95
 v_cvt_pk_bf16_f32 v93, v174, v175
 buffer_store_dwordx2 v[92:93], v9, s[8:11], s22 offen offset:224
 s_waitcnt vmcnt(19)
 v_cvt_pk_bf16_f32 v26, v176, v177
 v_lshlrev_b32 v176, 16, v26
 v_and_b32 v177, 0xffff0000, v26
 v_mul_f32 v176, v176, v30
 v_mul_f32 v177, v177, v30
 v_cvt_pk_bf16_f32 v26, v176, v177
 v_lshlrev_b32 v176, 16, v26
 v_and_b32 v177, 0xffff0000, v26
 v_add_f32 v176, v176, v96
 v_add_f32 v177, v177, v97
 v_cvt_pk_bf16_f32 v96, v176, v177
 v_cvt_pk_bf16_f32 v26, v178, v179
 v_lshlrev_b32 v178, 16, v26
 v_and_b32 v179, 0xffff0000, v26
 v_mul_f32 v178, v178, v30
 v_mul_f32 v179, v179, v30
 v_cvt_pk_bf16_f32 v26, v178, v179
 v_lshlrev_b32 v178, 16, v26
 v_and_b32 v179, 0xffff0000, v26
 v_add_f32 v178, v178, v98
 v_add_f32 v179, v179, v99
 v_cvt_pk_bf16_f32 v97, v178, v179
 buffer_store_dwordx2 v[96:97], v9, s[8:11], s22 offen offset:256
 s_waitcnt vmcnt(19)
 v_cvt_pk_bf16_f32 v26, v180, v181
 v_lshlrev_b32 v180, 16, v26
 v_and_b32 v181, 0xffff0000, v26
 v_mul_f32 v180, v180, v30
 v_mul_f32 v181, v181, v30
 v_cvt_pk_bf16_f32 v26, v180, v181
 v_lshlrev_b32 v180, 16, v26
 v_and_b32 v181, 0xffff0000, v26
 v_add_f32 v180, v180, v100
 v_add_f32 v181, v181, v101
 v_cvt_pk_bf16_f32 v100, v180, v181
 v_cvt_pk_bf16_f32 v26, v182, v183
 v_lshlrev_b32 v182, 16, v26
 v_and_b32 v183, 0xffff0000, v26
 v_mul_f32 v182, v182, v30
 v_mul_f32 v183, v183, v30
 v_cvt_pk_bf16_f32 v26, v182, v183
 v_lshlrev_b32 v182, 16, v26
 v_and_b32 v183, 0xffff0000, v26
 v_add_f32 v182, v182, v102
 v_add_f32 v183, v183, v103
 v_cvt_pk_bf16_f32 v101, v182, v183
 buffer_store_dwordx2 v[100:101], v9, s[8:11], s22 offen offset:288
 s_waitcnt vmcnt(19)
 v_cvt_pk_bf16_f32 v26, v184, v185
 v_lshlrev_b32 v184, 16, v26
 v_and_b32 v185, 0xffff0000, v26
 v_mul_f32 v184, v184, v31
 v_mul_f32 v185, v185, v31
 v_cvt_pk_bf16_f32 v26, v184, v185
 v_lshlrev_b32 v184, 16, v26
 v_and_b32 v185, 0xffff0000, v26
 v_add_f32 v184, v184, v104
 v_add_f32 v185, v185, v105
 v_cvt_pk_bf16_f32 v104, v184, v185
 v_cvt_pk_bf16_f32 v26, v186, v187
 v_lshlrev_b32 v186, 16, v26
 v_and_b32 v187, 0xffff0000, v26
 v_mul_f32 v186, v186, v31
 v_mul_f32 v187, v187, v31
 v_cvt_pk_bf16_f32 v26, v186, v187
 v_lshlrev_b32 v186, 16, v26
 v_and_b32 v187, 0xffff0000, v26
 v_add_f32 v186, v186, v106
 v_add_f32 v187, v187, v107
 v_cvt_pk_bf16_f32 v105, v186, v187
 buffer_store_dwordx2 v[104:105], v9, s[8:11], s23 offen offset:0
 s_waitcnt vmcnt(19)
 v_cvt_pk_bf16_f32 v26, v188, v189
 v_lshlrev_b32 v188, 16, v26
 v_and_b32 v189, 0xffff0000, v26
 v_mul_f32 v188, v188, v31
 v_mul_f32 v189, v189, v31
 v_cvt_pk_bf16_f32 v26, v188, v189
 v_lshlrev_b32 v188, 16, v26
 v_and_b32 v189, 0xffff0000, v26
 v_add_f32 v188, v188, v108
 v_add_f32 v189, v189, v109
 v_cvt_pk_bf16_f32 v108, v188, v189
 v_cvt_pk_bf16_f32 v26, v190, v191
 v_lshlrev_b32 v190, 16, v26
 v_and_b32 v191, 0xffff0000, v26
 v_mul_f32 v190, v190, v31
 v_mul_f32 v191, v191, v31
 v_cvt_pk_bf16_f32 v26, v190, v191
 v_lshlrev_b32 v190, 16, v26
 v_and_b32 v191, 0xffff0000, v26
 v_add_f32 v190, v190, v110
 v_add_f32 v191, v191, v111
 v_cvt_pk_bf16_f32 v109, v190, v191
 buffer_store_dwordx2 v[108:109], v9, s[8:11], s23 offen offset:32
 s_waitcnt vmcnt(19)
 v_cvt_pk_bf16_f32 v26, v192, v193
 v_lshlrev_b32 v192, 16, v26
 v_and_b32 v193, 0xffff0000, v26
 v_mul_f32 v192, v192, v31
 v_mul_f32 v193, v193, v31
 v_cvt_pk_bf16_f32 v26, v192, v193
 v_lshlrev_b32 v192, 16, v26
 v_and_b32 v193, 0xffff0000, v26
 v_add_f32 v192, v192, v112
 v_add_f32 v193, v193, v113
 v_cvt_pk_bf16_f32 v112, v192, v193
 v_cvt_pk_bf16_f32 v26, v194, v195
 v_lshlrev_b32 v194, 16, v26
 v_and_b32 v195, 0xffff0000, v26
 v_mul_f32 v194, v194, v31
 v_mul_f32 v195, v195, v31
 v_cvt_pk_bf16_f32 v26, v194, v195
 v_lshlrev_b32 v194, 16, v26
 v_and_b32 v195, 0xffff0000, v26
 v_add_f32 v194, v194, v114
 v_add_f32 v195, v195, v115
 v_cvt_pk_bf16_f32 v113, v194, v195
 buffer_store_dwordx2 v[112:113], v9, s[8:11], s23 offen offset:64
 s_waitcnt vmcnt(19)
 v_cvt_pk_bf16_f32 v26, v196, v197
 v_lshlrev_b32 v196, 16, v26
 v_and_b32 v197, 0xffff0000, v26
 v_mul_f32 v196, v196, v31
 v_mul_f32 v197, v197, v31
 v_cvt_pk_bf16_f32 v26, v196, v197
 v_lshlrev_b32 v196, 16, v26
 v_and_b32 v197, 0xffff0000, v26
 v_add_f32 v196, v196, v116
 v_add_f32 v197, v197, v117
 v_cvt_pk_bf16_f32 v116, v196, v197
 v_cvt_pk_bf16_f32 v26, v198, v199
 v_lshlrev_b32 v198, 16, v26
 v_and_b32 v199, 0xffff0000, v26
 v_mul_f32 v198, v198, v31
 v_mul_f32 v199, v199, v31
 v_cvt_pk_bf16_f32 v26, v198, v199
 v_lshlrev_b32 v198, 16, v26
 v_and_b32 v199, 0xffff0000, v26
 v_add_f32 v198, v198, v118
 v_add_f32 v199, v199, v119
 v_cvt_pk_bf16_f32 v117, v198, v199
 buffer_store_dwordx2 v[116:117], v9, s[8:11], s23 offen offset:96
 s_waitcnt vmcnt(19)
 v_cvt_pk_bf16_f32 v26, v200, v201
 v_lshlrev_b32 v200, 16, v26
 v_and_b32 v201, 0xffff0000, v26
 v_mul_f32 v200, v200, v31
 v_mul_f32 v201, v201, v31
 v_cvt_pk_bf16_f32 v26, v200, v201
 v_lshlrev_b32 v200, 16, v26
 v_and_b32 v201, 0xffff0000, v26
 v_add_f32 v200, v200, v120
 v_add_f32 v201, v201, v121
 v_cvt_pk_bf16_f32 v120, v200, v201
 v_cvt_pk_bf16_f32 v26, v202, v203
 v_lshlrev_b32 v202, 16, v26
 v_and_b32 v203, 0xffff0000, v26
 v_mul_f32 v202, v202, v31
 v_mul_f32 v203, v203, v31
 v_cvt_pk_bf16_f32 v26, v202, v203
 v_lshlrev_b32 v202, 16, v26
 v_and_b32 v203, 0xffff0000, v26
 v_add_f32 v202, v202, v122
 v_add_f32 v203, v203, v123
 v_cvt_pk_bf16_f32 v121, v202, v203
 buffer_store_dwordx2 v[120:121], v9, s[8:11], s23 offen offset:128
 s_waitcnt vmcnt(19)
 v_cvt_pk_bf16_f32 v26, v204, v205
 v_lshlrev_b32 v204, 16, v26
 v_and_b32 v205, 0xffff0000, v26
 v_mul_f32 v204, v204, v31
 v_mul_f32 v205, v205, v31
 v_cvt_pk_bf16_f32 v26, v204, v205
 v_lshlrev_b32 v204, 16, v26
 v_and_b32 v205, 0xffff0000, v26
 v_add_f32 v204, v204, v124
 v_add_f32 v205, v205, v125
 v_cvt_pk_bf16_f32 v124, v204, v205
 v_cvt_pk_bf16_f32 v26, v206, v207
 v_lshlrev_b32 v206, 16, v26
 v_and_b32 v207, 0xffff0000, v26
 v_mul_f32 v206, v206, v31
 v_mul_f32 v207, v207, v31
 v_cvt_pk_bf16_f32 v26, v206, v207
 v_lshlrev_b32 v206, 16, v26
 v_and_b32 v207, 0xffff0000, v26
 v_add_f32 v206, v206, v126
 v_add_f32 v207, v207, v127
 v_cvt_pk_bf16_f32 v125, v206, v207
 buffer_store_dwordx2 v[124:125], v9, s[8:11], s23 offen offset:160
 s_waitcnt vmcnt(19)
 v_cvt_pk_bf16_f32 v26, v208, v209
 v_lshlrev_b32 v208, 16, v26
 v_and_b32 v209, 0xffff0000, v26
 v_mul_f32 v208, v208, v31
 v_mul_f32 v209, v209, v31
 v_cvt_pk_bf16_f32 v26, v208, v209
 v_lshlrev_b32 v208, 16, v26
 v_and_b32 v209, 0xffff0000, v26
 v_add_f32 v208, v208, v128
 v_add_f32 v209, v209, v129
 v_cvt_pk_bf16_f32 v128, v208, v209
 v_cvt_pk_bf16_f32 v26, v210, v211
 v_lshlrev_b32 v210, 16, v26
 v_and_b32 v211, 0xffff0000, v26
 v_mul_f32 v210, v210, v31
 v_mul_f32 v211, v211, v31
 v_cvt_pk_bf16_f32 v26, v210, v211
 v_lshlrev_b32 v210, 16, v26
 v_and_b32 v211, 0xffff0000, v26
 v_add_f32 v210, v210, v130
 v_add_f32 v211, v211, v131
 v_cvt_pk_bf16_f32 v129, v210, v211
 buffer_store_dwordx2 v[128:129], v9, s[8:11], s23 offen offset:192
 s_waitcnt vmcnt(19)
 v_cvt_pk_bf16_f32 v26, v212, v213
 v_lshlrev_b32 v212, 16, v26
 v_and_b32 v213, 0xffff0000, v26
 v_mul_f32 v212, v212, v31
 v_mul_f32 v213, v213, v31
 v_cvt_pk_bf16_f32 v26, v212, v213
 v_lshlrev_b32 v212, 16, v26
 v_and_b32 v213, 0xffff0000, v26
 v_add_f32 v212, v212, v132
 v_add_f32 v213, v213, v133
 v_cvt_pk_bf16_f32 v132, v212, v213
 v_cvt_pk_bf16_f32 v26, v214, v215
 v_lshlrev_b32 v214, 16, v26
 v_and_b32 v215, 0xffff0000, v26
 v_mul_f32 v214, v214, v31
 v_mul_f32 v215, v215, v31
 v_cvt_pk_bf16_f32 v26, v214, v215
 v_lshlrev_b32 v214, 16, v26
 v_and_b32 v215, 0xffff0000, v26
 v_add_f32 v214, v214, v134
 v_add_f32 v215, v215, v135
 v_cvt_pk_bf16_f32 v133, v214, v215
 buffer_store_dwordx2 v[132:133], v9, s[8:11], s23 offen offset:224
 s_waitcnt vmcnt(19)
 v_cvt_pk_bf16_f32 v26, v216, v217
 v_lshlrev_b32 v216, 16, v26
 v_and_b32 v217, 0xffff0000, v26
 v_mul_f32 v216, v216, v31
 v_mul_f32 v217, v217, v31
 v_cvt_pk_bf16_f32 v26, v216, v217
 v_lshlrev_b32 v216, 16, v26
 v_and_b32 v217, 0xffff0000, v26
 v_add_f32 v216, v216, v136
 v_add_f32 v217, v217, v137
 v_cvt_pk_bf16_f32 v136, v216, v217
 v_cvt_pk_bf16_f32 v26, v218, v219
 v_lshlrev_b32 v218, 16, v26
 v_and_b32 v219, 0xffff0000, v26
 v_mul_f32 v218, v218, v31
 v_mul_f32 v219, v219, v31
 v_cvt_pk_bf16_f32 v26, v218, v219
 v_lshlrev_b32 v218, 16, v26
 v_and_b32 v219, 0xffff0000, v26
 v_add_f32 v218, v218, v138
 v_add_f32 v219, v219, v139
 v_cvt_pk_bf16_f32 v137, v218, v219
 buffer_store_dwordx2 v[136:137], v9, s[8:11], s23 offen offset:256
 s_waitcnt vmcnt(19)
 v_cvt_pk_bf16_f32 v26, v220, v221
 v_lshlrev_b32 v220, 16, v26
 v_and_b32 v221, 0xffff0000, v26
 v_mul_f32 v220, v220, v31
 v_mul_f32 v221, v221, v31
 v_cvt_pk_bf16_f32 v26, v220, v221
 v_lshlrev_b32 v220, 16, v26
 v_and_b32 v221, 0xffff0000, v26
 v_add_f32 v220, v220, v140
 v_add_f32 v221, v221, v141
 v_cvt_pk_bf16_f32 v140, v220, v221
 v_cvt_pk_bf16_f32 v26, v222, v223
 v_lshlrev_b32 v222, 16, v26
 v_and_b32 v223, 0xffff0000, v26
 v_mul_f32 v222, v222, v31
 v_mul_f32 v223, v223, v31
 v_cvt_pk_bf16_f32 v26, v222, v223
 v_lshlrev_b32 v222, 16, v26
 v_and_b32 v223, 0xffff0000, v26
 v_add_f32 v222, v222, v142
 v_add_f32 v223, v223, v143
 v_cvt_pk_bf16_f32 v141, v222, v223
 buffer_store_dwordx2 v[140:141], v9, s[8:11], s23 offen offset:288
om_233:
 s_cmp_eq_u32 s87, -2
 s_cbranch_scc1 kv_help
 s_cmp_eq_u32 s87, -1
 s_cbranch_scc1 queue
tail_item:
 s_load_dwordx2 s[4:5], s[0:1], 96
 s_waitcnt lgkmcnt(0)
 s_mov_b32 s32, s4
 s_mov_b32 s33, s5
 s_mov_b32 s34, 256
 s_mov_b32 s35, 0x00020000
 s_waitcnt vmcnt(0)
 s_barrier
 s_mov_b32 s21, s87
do_pv:
 s_mov_b32 s2, s21
 s_load_dwordx2 s[4:5], s[0:1], 88
 s_load_dwordx2 s[38:39], s[0:1], 104
 s_waitcnt lgkmcnt(0)
 s_mov_b32 s8, s4
 s_mov_b32 s9, s5
 s_mov_b32 s10, 2621440
 s_mov_b32 s11, 0x00020000
 s_add_u32 s12, s38, 122683392
 s_addc_u32 s13, s39, 0
 s_mov_b32 s14, 83886080
 s_mov_b32 s15, 0x00020000
 s_mov_b32 s59, 0
 s_mov_b32 s60, 0
 s_add_u32 s16, s38, 85983232
 s_addc_u32 s17, s39, 0
 s_mov_b32 s18, 36700160
 s_mov_b32 s19, 0x00020000
 s_add_u32 s24, s38, 73400320
 s_addc_u32 s25, s39, 0
 s_mov_b32 s26, 5242880
 s_mov_b32 s27, 0x00020000
 s_add_u32 s28, s38, 81002496
 s_addc_u32 s29, s39, 0
 s_mov_b32 s30, 8192
 s_mov_b32 s31, 0x00020000
 s_add_u32 s72, s38, 81068032
 s_addc_u32 s73, s39, 0
 s_mov_b32 s74, 128000
 s_mov_b32 s75, 0x00020000
 v_lshlrev_b32 v4, 4, v1
 v_lshlrev_b32 v5, 3, v1
 v_lshlrev_b32 v6, 2, v2
 v_and_b32 v7, 7, v1
 v_lshlrev_b32 v7, 7, v7
 v_lshrrev_b32 v31, 3, v1
 v_lshl_add_u32 v208, v31, 10, v7
 v_bfe_u32 v31, v1, 3, 2
 v_lshl_add_u32 v31, v31, 12, v7
 s_lshl_b32 s21, s20, 10
 s_add_u32 s21, s21, 94208
 buffer_load_dword v8, v31, s[72:75], s21 offen sc1
 v_lshlrev_b32 v25, 7, v2
 s_mov_b32 s21, 92160
 buffer_load_dword v26, v25, s[72:75], s21 offen sc1
 s_mov_b32 s63, 1
 v_mul_u32_u24 v9, 1280, v2
 v_lshl_add_u32 v9, v3, 3, v9
 s_lshl_b32 s21, s20, 13
 v_add_u32 v10, s21, v4
 s_lshl_b32 s21, s20, 10
 v_add_u32 v11, s21, v4
 v_lshrrev_b32 v20, 5, v1
 v_mul_u32_u24 v21, 2560, v20
 v_add_u32 v21, v21, v4
 v_and_b32 v22, 31, v1
 v_lshlrev_b32 v22, 4, v22
 v_mul_u32_u24 v20, 10240, v20
 v_add_u32 v22, v22, v20
 v_mul_u32_u24 v21, 2560, v3
 v_lshl_add_u32 v21, v2, 4, v21
 v_mul_u32_u24 v22, 10240, v3
 v_lshl_add_u32 v22, v2, 4, v22
 v_mov_b32 v28, 80
 v_mov_b32 v30, 32768
 s_mov_b32 s50, 0
 s_mov_b32 s71, 0
 s_mov_b32 s51, 0
 s_and_b32 s43, s20, 1
 s_lshr_b32 s44, s20, 1
 v_mov_b32 v70, 0
 v_mov_b32 v71, 0
 v_mov_b32 v78, 0
 v_mov_b32 v79, 0
 v_mov_b32 v86, 0
 v_mov_b32 v87, 0
 v_mov_b32 v94, 0
 v_mov_b32 v95, 0
 v_mov_b32 v102, 0
 v_mov_b32 v103, 0
 v_mov_b32 v110, 0
 v_mov_b32 v111, 0
 v_mov_b32 v118, 0
 v_mov_b32 v119, 0
 v_mov_b32 v126, 0
 v_mov_b32 v127, 0
 s_mov_b32 s21, s2
pv_loop:
 s_mul_i32 s2, s21, 2
 s_add_u32 s2, s2, 192
 s_add_u32 s22, s21, 356
 s_cmp_lt_u32 s21, 164
 s_cselect_b32 s2, s2, s22
 s_cselect_b32 s65, 1, 0
 s_mul_i32 s22, s21, 5
 s_cmp_lt_u32 s21, 64
 s_cselect_b32 s2, s22, s2
 s_cselect_b32 s65, 4, s65
 s_mul_hi_u32 s40, s2, 0x1999999a
 s_mul_i32 s21, s40, 10
 s_sub_u32 s41, s2, s21
 s_lshl_b32 s52, s40, 10
 s_add_u32 s52, s52, 22528
 buffer_load_dword v27, v7, s[72:75], s52 offen sc1
 s_cmp_lg_u32 s20, 0
 s_cbranch_scc1 pv_247
 s_sub_u32 s21, s2, 0
 s_cmp_lt_u32 s21, 640
 s_cbranch_scc1 pv_247
 v_mov_b32 v29, 1
 s_mov_b64 exec, 1
 buffer_atomic_add v29, v28, s[32:35], 0 offen sc0 sc1
 s_mov_b64 exec, -1
pv_247:
 s_lshl_b32 s42, s40, 5
 s_lshl_b32 s21, s20, 3
 s_add_u32 s42, s42, s21
 s_mul_i32 s61, s21, 5
 s_lshr_b32 s22, s41, 1
 s_add_u32 s61, s61, s22
 s_and_b32 s62, s41, 1
 s_lshl_b32 s62, s62, 12
 s_mul_i32 s53, s42, 40960
 s_lshl_b32 s22, s41, 12
 s_add_u32 s53, s53, s22
 s_lshl_b32 s21, s40, 1
 s_add_u32 s21, s21, s43
 s_lshl_b32 s45, s21, 6
 s_mul_i32 s46, s21, 20480
 s_mul_i32 s21, s21, 40
 s_lshl_b32 s22, s41, 2
 s_add_u32 s22, s22, s44
 s_add_u32 s21, s21, s22
 s_lshl_b32 s54, s21, 10
 s_lshl_b32 s22, s22, 5
 s_add_u32 s46, s46, s22
 s_mul_i32 s47, s42, 2560
 s_mul_i32 s48, s42, 10240
 s_lshl_b32 s22, s41, 10
 s_add_u32 s48, s48, s22
 s_add_u32 s48, s48, 15728640
 s_add_u32 s23, s40, 1
 s_cmp_ge_u32 s50, s23
 s_cbranch_scc1 pv_240
 s_cmp_eq_u32 s63, 0
 s_cbranch_scc1 pv_243
 s_mov_b32 s63, 0
 s_waitcnt vmcnt(1)
 v_cmp_le_u32 vcc, 4, v26
 s_mov_b32 s51, vcc_lo
 v_cmp_gt_u32 vcc, s23, v8
 s_nop 1
 s_cbranch_vccz pv_244
pv_243:
 s_lshl_b32 s21, s20, 10
 s_add_u32 s21, s21, 94208
 s_mov_b32 s101, 0
wm_248:
 buffer_load_dword v8, v31, s[72:75], s21 offen sc1
 s_add_u32 s101, s101, 1
 s_cmp_gt_u32 s101, 131072
 s_cbranch_scc1 main_end
 s_waitcnt vmcnt(0)
 v_cmp_gt_u32 vcc, s23, v8
 v_readfirstlane_b32 s100, v8
 s_nop 0
 s_cbranch_vccz wm_249
 s_sleep 8
 s_add_u32 s100, s100, 2
 s_cmp_ge_u32 s100, s23
 s_cbranch_scc1 wm_248
 s_sleep 60
 s_branch wm_248
wm_249:
pv_244:
 v_readlane_b32 s50, v8, 0
 v_readlane_b32 s21, v8, 1
 s_min_u32 s50, s50, s21
 v_readlane_b32 s21, v8, 2
 s_min_u32 s50, s50, s21
 v_readlane_b32 s21, v8, 3
 s_min_u32 s50, s50, s21
 v_readlane_b32 s21, v8, 4
 s_min_u32 s50, s50, s21
 v_readlane_b32 s21, v8, 5
 s_min_u32 s50, s50, s21
 v_readlane_b32 s21, v8, 6
 s_min_u32 s50, s50, s21
 v_readlane_b32 s21, v8, 7
 s_min_u32 s50, s50, s21
 v_readlane_b32 s21, v8, 8
 s_min_u32 s50, s50, s21
 v_readlane_b32 s21, v8, 9
 s_min_u32 s50, s50, s21
 v_readlane_b32 s21, v8, 10
 s_min_u32 s50, s50, s21
 v_readlane_b32 s21, v8, 11
 s_min_u32 s50, s50, s21
 v_readlane_b32 s21, v8, 12
 s_min_u32 s50, s50, s21
 v_readlane_b32 s21, v8, 13
 s_min_u32 s50, s50, s21
 v_readlane_b32 s21, v8, 14
 s_min_u32 s50, s50, s21
 v_readlane_b32 s21, v8, 15
 s_min_u32 s50, s50, s21
 v_readlane_b32 s21, v8, 16
 s_min_u32 s50, s50, s21
 v_readlane_b32 s21, v8, 17
 s_min_u32 s50, s50, s21
 v_readlane_b32 s21, v8, 18
 s_min_u32 s50, s50, s21
 v_readlane_b32 s21, v8, 19
 s_min_u32 s50, s50, s21
 v_readlane_b32 s21, v8, 20
 s_min_u32 s50, s50, s21
 v_readlane_b32 s21, v8, 21
 s_min_u32 s50, s50, s21
 v_readlane_b32 s21, v8, 22
 s_min_u32 s50, s50, s21
 v_readlane_b32 s21, v8, 23
 s_min_u32 s50, s50, s21
 v_readlane_b32 s21, v8, 24
 s_min_u32 s50, s50, s21
 v_readlane_b32 s21, v8, 25
 s_min_u32 s50, s50, s21
 v_readlane_b32 s21, v8, 26
 s_min_u32 s50, s50, s21
 v_readlane_b32 s21, v8, 27
 s_min_u32 s50, s50, s21
 v_readlane_b32 s21, v8, 28
 s_min_u32 s50, s50, s21
 v_readlane_b32 s21, v8, 29
 s_min_u32 s50, s50, s21
 v_readlane_b32 s21, v8, 30
 s_min_u32 s50, s50, s21
 v_readlane_b32 s21, v8, 31
 s_min_u32 s50, s50, s21
pv_240:
 s_lshr_b32 s22, s40, 2
 s_cmp_lt_u32 s40, 32
 s_cbranch_scc1 pv_241
 s_bitcmp1_b32 s51, s22
 s_cbranch_scc1 pv_241
 s_mov_b32 s21, 92160
 v_lshlrev_b32 v25, 7, v2
 s_mov_b32 s101, 0
pv_242:
 buffer_load_dword v26, v25, s[72:75], s21 offen sc1
 s_add_u32 s101, s101, 1
 s_cmp_gt_u32 s101, 131072
 s_cbranch_scc1 main_end
 s_waitcnt vmcnt(0)
 v_cmp_le_u32 vcc, 4, v26
 s_mov_b32 s51, vcc_lo
 s_bitcmp1_b32 s51, s22
 s_cbranch_scc1 pv_241
 s_sleep 8
 s_branch pv_242
pv_241:
 buffer_load_dwordx4 a[0:3], v4, s[12:15], s53 offen offset:0 sc1
 buffer_load_dwordx4 a[4:7], v4, s[12:15], s53 offen offset:1024 sc1
 buffer_load_dwordx4 a[8:11], v4, s[12:15], s53 offen offset:2048 sc1
 buffer_load_dwordx4 a[12:15], v4, s[12:15], s53 offen offset:3072 sc1
 s_add_u32 s53, s53, 40960
 buffer_load_dwordx4 a[16:19], v4, s[12:15], s53 offen offset:0 sc1
 buffer_load_dwordx4 a[20:23], v4, s[12:15], s53 offen offset:1024 sc1
 buffer_load_dwordx4 a[24:27], v4, s[12:15], s53 offen offset:2048 sc1
 buffer_load_dwordx4 a[28:31], v4, s[12:15], s53 offen offset:3072 sc1
 s_add_u32 s53, s53, 40960
 buffer_load_dwordx4 a[32:35], v4, s[12:15], s53 offen offset:0 sc1
 buffer_load_dwordx4 a[36:39], v4, s[12:15], s53 offen offset:1024 sc1
 buffer_load_dwordx4 a[40:43], v4, s[12:15], s53 offen offset:2048 sc1
 buffer_load_dwordx4 a[44:47], v4, s[12:15], s53 offen offset:3072 sc1
 s_add_u32 s53, s53, 40960
 buffer_load_dwordx4 a[48:51], v4, s[12:15], s53 offen offset:0 sc1
 buffer_load_dwordx4 a[52:55], v4, s[12:15], s53 offen offset:1024 sc1
 buffer_load_dwordx4 a[56:59], v4, s[12:15], s53 offen offset:2048 sc1
 buffer_load_dwordx4 a[60:63], v4, s[12:15], s53 offen offset:3072 sc1
 s_add_u32 s53, s53, 40960
 buffer_load_dwordx4 a[64:67], v4, s[12:15], s53 offen offset:0 sc1
 buffer_load_dwordx4 a[68:71], v4, s[12:15], s53 offen offset:1024 sc1
 buffer_load_dwordx4 a[72:75], v4, s[12:15], s53 offen offset:2048 sc1
 buffer_load_dwordx4 a[76:79], v4, s[12:15], s53 offen offset:3072 sc1
 s_add_u32 s53, s53, 40960
 buffer_load_dwordx4 a[80:83], v4, s[12:15], s53 offen offset:0 sc1
 buffer_load_dwordx4 a[84:87], v4, s[12:15], s53 offen offset:1024 sc1
 buffer_load_dwordx4 a[88:91], v4, s[12:15], s53 offen offset:2048 sc1
 buffer_load_dwordx4 a[92:95], v4, s[12:15], s53 offen offset:3072 sc1
 s_add_u32 s53, s53, 40960
 buffer_load_dwordx4 a[96:99], v4, s[12:15], s53 offen offset:0 sc1
 buffer_load_dwordx4 a[100:103], v4, s[12:15], s53 offen offset:1024 sc1
 buffer_load_dwordx4 a[104:107], v4, s[12:15], s53 offen offset:2048 sc1
 buffer_load_dwordx4 a[108:111], v4, s[12:15], s53 offen offset:3072 sc1
 s_add_u32 s53, s53, 40960
 buffer_load_dwordx4 a[112:115], v4, s[12:15], s53 offen offset:0 sc1
 buffer_load_dwordx4 a[116:119], v4, s[12:15], s53 offen offset:1024 sc1
 buffer_load_dwordx4 a[120:123], v4, s[12:15], s53 offen offset:2048 sc1
 buffer_load_dwordx4 a[124:127], v4, s[12:15], s53 offen offset:3072 sc1
 s_cmp_lt_u32 s40, 32
 s_cselect_b32 s70, 0x80000000, s54
 buffer_load_dwordx4 v[12:15], v4, s[24:27], s70 offen sc1
 buffer_load_dwordx4 v[16:19], v4, s[24:27], s70 offen offset:2048 sc1
 buffer_load_dword v24, v6, s[28:31], s45 offen sc1
 s_waitcnt vmcnt(35)
 s_cmp_eq_u32 s71, 0
 s_cbranch_scc1 paf_252
 v_mov_b32 v25, 0
 v_mov_b32 v26, 1
 s_mov_b64 exec, 1
 buffer_atomic_add v26, v25, s[72:75], s71 offen sc1
 s_mov_b64 exec, -1
 s_mov_b32 s71, 0
paf_252:
 v_cmp_le_u32 s[68:69], 4, v27
 s_nop 1
 s_and_b32 s21, s68, 255
 s_cmp_lg_u32 s21, 255
 s_cbranch_scc1 pvw_245
 s_mov_b32 s56, s47
 s_mov_b32 s57, s48
 buffer_load_dwordx4 v[64:67], v4, s[16:19], s56 offen sc1
 buffer_load_dwordx2 v[68:69], v5, s[16:19], s56 offen offset:2048 sc1
 buffer_load_dwordx4 v[128:131], v21, s[16:19], s56 offen offset:1024 sc1
 buffer_load_dwordx4 v[132:135], v21, s[16:19], s56 offen offset:1280 sc1
 s_add_u32 s56, s56, 2560
 buffer_load_dwordx4 v[72:75], v4, s[16:19], s56 offen sc1
 buffer_load_dwordx2 v[76:77], v5, s[16:19], s56 offen offset:2048 sc1
 s_add_u32 s56, s56, 2560
 buffer_load_dwordx4 v[80:83], v4, s[16:19], s56 offen sc1
 buffer_load_dwordx2 v[84:85], v5, s[16:19], s56 offen offset:2048 sc1
 s_add_u32 s56, s56, 2560
 buffer_load_dwordx4 v[88:91], v4, s[16:19], s56 offen sc1
 buffer_load_dwordx2 v[92:93], v5, s[16:19], s56 offen offset:2048 sc1
 s_add_u32 s56, s56, 2560
 buffer_load_dwordx4 v[32:35], v22, s[16:19], s57 offen offset:0 sc1
 buffer_load_dwordx4 v[36:39], v22, s[16:19], s57 offen offset:256 sc1
 buffer_load_dwordx4 v[40:43], v22, s[16:19], s57 offen offset:512 sc1
 buffer_load_dwordx4 v[44:47], v22, s[16:19], s57 offen offset:768 sc1
 s_add_u32 s57, s57, 40960
 buffer_load_dwordx4 v[96:99], v4, s[16:19], s56 offen sc1
 buffer_load_dwordx2 v[100:101], v5, s[16:19], s56 offen offset:2048 sc1
 buffer_load_dwordx4 v[136:139], v21, s[16:19], s56 offen offset:1024 sc1
 buffer_load_dwordx4 v[140:143], v21, s[16:19], s56 offen offset:1280 sc1
 s_add_u32 s56, s56, 2560
 buffer_load_dwordx4 v[104:107], v4, s[16:19], s56 offen sc1
 buffer_load_dwordx2 v[108:109], v5, s[16:19], s56 offen offset:2048 sc1
 s_add_u32 s56, s56, 2560
 buffer_load_dwordx4 v[112:115], v4, s[16:19], s56 offen sc1
 buffer_load_dwordx2 v[116:117], v5, s[16:19], s56 offen offset:2048 sc1
 s_add_u32 s56, s56, 2560
 buffer_load_dwordx4 v[120:123], v4, s[16:19], s56 offen sc1
 buffer_load_dwordx2 v[124:125], v5, s[16:19], s56 offen offset:2048 sc1
 s_add_u32 s56, s56, 2560
 buffer_load_dwordx4 v[48:51], v22, s[16:19], s57 offen offset:0 sc1
 buffer_load_dwordx4 v[52:55], v22, s[16:19], s57 offen offset:256 sc1
 buffer_load_dwordx4 v[56:59], v22, s[16:19], s57 offen offset:512 sc1
 buffer_load_dwordx4 v[60:63], v22, s[16:19], s57 offen offset:768 sc1
 s_add_u32 s57, s57, 40960
 s_barrier
 s_waitcnt vmcnt(28)
 v_sub_f32 v25, 1.0, v24
 v_cvt_pk_bf16_f32 v26, v25, v25
 v_lshlrev_b32 v25, 16, v26
 v_cvt_pk_bf16_f32 v26, v12, v12
 v_lshlrev_b32 v12, 16, v26
 v_cvt_pk_bf16_f32 v26, v13, v13
 v_lshlrev_b32 v13, 16, v26
 v_cvt_pk_bf16_f32 v26, v14, v14
 v_lshlrev_b32 v14, 16, v26
 v_cvt_pk_bf16_f32 v26, v15, v15
 v_lshlrev_b32 v15, 16, v26
 v_cvt_pk_bf16_f32 v26, v16, v16
 v_lshlrev_b32 v16, 16, v26
 v_cvt_pk_bf16_f32 v26, v17, v17
 v_lshlrev_b32 v17, 16, v26
 v_cvt_pk_bf16_f32 v26, v18, v18
 v_lshlrev_b32 v18, 16, v26
 v_cvt_pk_bf16_f32 v26, v19, v19
 v_lshlrev_b32 v19, 16, v26
 v_mul_f32 v12, v12, v25
 v_cvt_pk_bf16_f32 v26, v12, v12
 v_lshlrev_b32 v12, 16, v26
 v_mul_f32 v13, v13, v25
 v_cvt_pk_bf16_f32 v26, v13, v13
 v_lshlrev_b32 v13, 16, v26
 v_mul_f32 v14, v14, v25
 v_cvt_pk_bf16_f32 v26, v14, v14
 v_lshlrev_b32 v14, 16, v26
 v_mul_f32 v15, v15, v25
 v_cvt_pk_bf16_f32 v26, v15, v15
 v_lshlrev_b32 v15, 16, v26
 v_mul_f32 v16, v16, v25
 v_cvt_pk_bf16_f32 v26, v16, v16
 v_lshlrev_b32 v16, 16, v26
 v_mul_f32 v17, v17, v25
 v_cvt_pk_bf16_f32 v26, v17, v17
 v_lshlrev_b32 v17, 16, v26
 v_mul_f32 v18, v18, v25
 v_cvt_pk_bf16_f32 v26, v18, v18
 v_lshlrev_b32 v18, 16, v26
 v_mul_f32 v19, v19, v25
 v_cvt_pk_bf16_f32 v26, v19, v19
 v_lshlrev_b32 v19, 16, v26
 s_cmp_ge_u32 s40, 52
 s_cbranch_scc1 pvc_251
 s_branch pvg_250
pvw_245:
 s_waitcnt vmcnt(0)
 v_sub_f32 v25, 1.0, v24
 v_cvt_pk_bf16_f32 v26, v25, v25
 v_lshlrev_b32 v25, 16, v26
 v_cvt_pk_bf16_f32 v26, v12, v12
 v_lshlrev_b32 v12, 16, v26
 v_cvt_pk_bf16_f32 v26, v13, v13
 v_lshlrev_b32 v13, 16, v26
 v_cvt_pk_bf16_f32 v26, v14, v14
 v_lshlrev_b32 v14, 16, v26
 v_cvt_pk_bf16_f32 v26, v15, v15
 v_lshlrev_b32 v15, 16, v26
 v_cvt_pk_bf16_f32 v26, v16, v16
 v_lshlrev_b32 v16, 16, v26
 v_cvt_pk_bf16_f32 v26, v17, v17
 v_lshlrev_b32 v17, 16, v26
 v_cvt_pk_bf16_f32 v26, v18, v18
 v_lshlrev_b32 v18, 16, v26
 v_cvt_pk_bf16_f32 v26, v19, v19
 v_lshlrev_b32 v19, 16, v26
 v_mul_f32 v12, v12, v25
 v_cvt_pk_bf16_f32 v26, v12, v12
 v_lshlrev_b32 v12, 16, v26
 v_mul_f32 v13, v13, v25
 v_cvt_pk_bf16_f32 v26, v13, v13
 v_lshlrev_b32 v13, 16, v26
 v_mul_f32 v14, v14, v25
 v_cvt_pk_bf16_f32 v26, v14, v14
 v_lshlrev_b32 v14, 16, v26
 v_mul_f32 v15, v15, v25
 v_cvt_pk_bf16_f32 v26, v15, v15
 v_lshlrev_b32 v15, 16, v26
 v_mul_f32 v16, v16, v25
 v_cvt_pk_bf16_f32 v26, v16, v16
 v_lshlrev_b32 v16, 16, v26
 v_mul_f32 v17, v17, v25
 v_cvt_pk_bf16_f32 v26, v17, v17
 v_lshlrev_b32 v17, 16, v26
 v_mul_f32 v18, v18, v25
 v_cvt_pk_bf16_f32 v26, v18, v18
 v_lshlrev_b32 v18, 16, v26
 v_mul_f32 v19, v19, v25
 v_cvt_pk_bf16_f32 v26, v19, v19
 v_lshlrev_b32 v19, 16, v26
 s_cmp_ge_u32 s40, 52
 s_cbranch_scc1 pvt_253
 s_cmp_lg_u32 s20, 0
 s_cbranch_scc1 wm_255
 s_mov_b32 s101, 0
wm_254:
 buffer_load_dword v26, v7, s[72:75], s52 offen sc1
 s_add_u32 s101, s101, 1
 s_cmp_gt_u32 s101, 131072
 s_cbranch_scc1 main_end
 s_waitcnt vmcnt(0)
 v_cmp_gt_u32 vcc, 4, v26
 v_readfirstlane_b32 s100, v26
 s_nop 0
 s_cbranch_vccz wm_255
 s_sleep 2
 s_add_u32 s100, s100, 3
 s_cmp_ge_u32 s100, 4
 s_cbranch_scc1 wm_254
 s_sleep 24
 s_branch wm_254
wm_255:
 s_barrier
 buffer_load_dwordx4 v[64:67], v4, s[16:19], s47 offen sc1
 buffer_load_dwordx2 v[68:69], v5, s[16:19], s47 offen offset:2048 sc1
 buffer_load_dwordx4 v[128:131], v21, s[16:19], s47 offen offset:1024 sc1
 buffer_load_dwordx4 v[132:135], v21, s[16:19], s47 offen offset:1280 sc1
 s_add_u32 s47, s47, 2560
 buffer_load_dwordx4 v[72:75], v4, s[16:19], s47 offen sc1
 buffer_load_dwordx2 v[76:77], v5, s[16:19], s47 offen offset:2048 sc1
 s_add_u32 s47, s47, 2560
 buffer_load_dwordx4 v[80:83], v4, s[16:19], s47 offen sc1
 buffer_load_dwordx2 v[84:85], v5, s[16:19], s47 offen offset:2048 sc1
 s_add_u32 s47, s47, 2560
 buffer_load_dwordx4 v[88:91], v4, s[16:19], s47 offen sc1
 buffer_load_dwordx2 v[92:93], v5, s[16:19], s47 offen offset:2048 sc1
 s_add_u32 s47, s47, 2560
 buffer_load_dwordx4 v[32:35], v22, s[16:19], s48 offen offset:0 sc1
 buffer_load_dwordx4 v[36:39], v22, s[16:19], s48 offen offset:256 sc1
 buffer_load_dwordx4 v[40:43], v22, s[16:19], s48 offen offset:512 sc1
 buffer_load_dwordx4 v[44:47], v22, s[16:19], s48 offen offset:768 sc1
 s_add_u32 s48, s48, 40960
 buffer_load_dwordx4 v[96:99], v4, s[16:19], s47 offen sc1
 buffer_load_dwordx2 v[100:101], v5, s[16:19], s47 offen offset:2048 sc1
 buffer_load_dwordx4 v[136:139], v21, s[16:19], s47 offen offset:1024 sc1
 buffer_load_dwordx4 v[140:143], v21, s[16:19], s47 offen offset:1280 sc1
 s_add_u32 s47, s47, 2560
 buffer_load_dwordx4 v[104:107], v4, s[16:19], s47 offen sc1
 buffer_load_dwordx2 v[108:109], v5, s[16:19], s47 offen offset:2048 sc1
 s_add_u32 s47, s47, 2560
 buffer_load_dwordx4 v[112:115], v4, s[16:19], s47 offen sc1
 buffer_load_dwordx2 v[116:117], v5, s[16:19], s47 offen offset:2048 sc1
 s_add_u32 s47, s47, 2560
 buffer_load_dwordx4 v[120:123], v4, s[16:19], s47 offen sc1
 buffer_load_dwordx2 v[124:125], v5, s[16:19], s47 offen offset:2048 sc1
 s_add_u32 s47, s47, 2560
 buffer_load_dwordx4 v[48:51], v22, s[16:19], s48 offen offset:0 sc1
 buffer_load_dwordx4 v[52:55], v22, s[16:19], s48 offen offset:256 sc1
 buffer_load_dwordx4 v[56:59], v22, s[16:19], s48 offen offset:512 sc1
 buffer_load_dwordx4 v[60:63], v22, s[16:19], s48 offen offset:768 sc1
 s_add_u32 s48, s48, 40960
pvg_250:
 s_add_u32 s41, s41, 1
 s_mul_i32 s53, s42, 40960
 s_lshl_b32 s22, s41, 12
 s_add_u32 s53, s53, s22
 s_mul_i32 s48, s42, 10240
 s_lshl_b32 s22, s41, 10
 s_add_u32 s48, s48, s22
 s_add_u32 s48, s48, 15728640
 s_waitcnt vmcnt(26)
 v_mfma_f32_16x16x32_bf16 v[148:151], a[0:3], v[64:67], 0
 v_mfma_f32_16x16x32_bf16 v[144:147], a[0:3], v[68:71], 0
 v_mfma_f32_16x16x32_bf16 v[156:159], a[4:7], v[64:67], 0
 v_mfma_f32_16x16x32_bf16 v[152:155], a[4:7], v[68:71], 0
 v_mfma_f32_16x16x32_bf16 v[164:167], a[8:11], v[64:67], 0
 v_mfma_f32_16x16x32_bf16 v[160:163], a[8:11], v[68:71], 0
 v_mfma_f32_16x16x32_bf16 v[172:175], a[12:15], v[64:67], 0
 v_mfma_f32_16x16x32_bf16 v[168:171], a[12:15], v[68:71], 0
 buffer_load_dwordx4 a[0:3], v4, s[12:15], s53 offen offset:0 sc1
 buffer_load_dwordx4 a[4:7], v4, s[12:15], s53 offen offset:1024 sc1
 buffer_load_dwordx4 a[8:11], v4, s[12:15], s53 offen offset:2048 sc1
 buffer_load_dwordx4 a[12:15], v4, s[12:15], s53 offen offset:3072 sc1
 s_waitcnt vmcnt(26)
 v_mfma_f32_16x16x32_bf16 v[148:151], a[16:19], v[72:75], v[148:151]
 v_mfma_f32_16x16x32_bf16 v[144:147], a[16:19], v[76:79], v[144:147]
 v_mfma_f32_16x16x32_bf16 v[156:159], a[20:23], v[72:75], v[156:159]
 v_mfma_f32_16x16x32_bf16 v[152:155], a[20:23], v[76:79], v[152:155]
 v_mfma_f32_16x16x32_bf16 v[164:167], a[24:27], v[72:75], v[164:167]
 v_mfma_f32_16x16x32_bf16 v[160:163], a[24:27], v[76:79], v[160:163]
 v_mfma_f32_16x16x32_bf16 v[172:175], a[28:31], v[72:75], v[172:175]
 v_mfma_f32_16x16x32_bf16 v[168:171], a[28:31], v[76:79], v[168:171]
 s_add_u32 s53, s53, 40960
 buffer_load_dwordx4 a[16:19], v4, s[12:15], s53 offen offset:0 sc1
 buffer_load_dwordx4 a[20:23], v4, s[12:15], s53 offen offset:1024 sc1
 buffer_load_dwordx4 a[24:27], v4, s[12:15], s53 offen offset:2048 sc1
 buffer_load_dwordx4 a[28:31], v4, s[12:15], s53 offen offset:3072 sc1
 s_waitcnt vmcnt(28)
 v_mfma_f32_16x16x32_bf16 v[148:151], a[32:35], v[80:83], v[148:151]
 v_mfma_f32_16x16x32_bf16 v[144:147], a[32:35], v[84:87], v[144:147]
 v_mfma_f32_16x16x32_bf16 v[156:159], a[36:39], v[80:83], v[156:159]
 v_mfma_f32_16x16x32_bf16 v[152:155], a[36:39], v[84:87], v[152:155]
 v_mfma_f32_16x16x32_bf16 v[164:167], a[40:43], v[80:83], v[164:167]
 v_mfma_f32_16x16x32_bf16 v[160:163], a[40:43], v[84:87], v[160:163]
 v_mfma_f32_16x16x32_bf16 v[172:175], a[44:47], v[80:83], v[172:175]
 v_mfma_f32_16x16x32_bf16 v[168:171], a[44:47], v[84:87], v[168:171]
 s_add_u32 s53, s53, 40960
 buffer_load_dwordx4 a[32:35], v4, s[12:15], s53 offen offset:0 sc1
 buffer_load_dwordx4 a[36:39], v4, s[12:15], s53 offen offset:1024 sc1
 buffer_load_dwordx4 a[40:43], v4, s[12:15], s53 offen offset:2048 sc1
 buffer_load_dwordx4 a[44:47], v4, s[12:15], s53 offen offset:3072 sc1
 s_waitcnt vmcnt(30)
 v_mfma_f32_16x16x32_bf16 v[148:151], a[48:51], v[88:91], v[148:151]
 v_mfma_f32_16x16x32_bf16 v[144:147], a[48:51], v[92:95], v[144:147]
 v_mfma_f32_16x16x32_bf16 v[156:159], a[52:55], v[88:91], v[156:159]
 v_mfma_f32_16x16x32_bf16 v[152:155], a[52:55], v[92:95], v[152:155]
 v_mfma_f32_16x16x32_bf16 v[164:167], a[56:59], v[88:91], v[164:167]
 v_mfma_f32_16x16x32_bf16 v[160:163], a[56:59], v[92:95], v[160:163]
 v_mfma_f32_16x16x32_bf16 v[172:175], a[60:63], v[88:91], v[172:175]
 v_mfma_f32_16x16x32_bf16 v[168:171], a[60:63], v[92:95], v[168:171]
 s_add_u32 s53, s53, 40960
 buffer_load_dwordx4 a[48:51], v4, s[12:15], s53 offen offset:0 sc1
 buffer_load_dwordx4 a[52:55], v4, s[12:15], s53 offen offset:1024 sc1
 buffer_load_dwordx4 a[56:59], v4, s[12:15], s53 offen offset:2048 sc1
 buffer_load_dwordx4 a[60:63], v4, s[12:15], s53 offen offset:3072 sc1
 s_waitcnt vmcnt(30)
 v_mfma_f32_16x16x32_bf16 v[144:147], v[32:35], v[128:131], v[144:147]
 v_mfma_f32_16x16x32_bf16 v[148:151], v[32:35], v[132:135], v[148:151]
 v_mfma_f32_16x16x32_bf16 v[152:155], v[36:39], v[128:131], v[152:155]
 v_mfma_f32_16x16x32_bf16 v[156:159], v[36:39], v[132:135], v[156:159]
 v_mfma_f32_16x16x32_bf16 v[160:163], v[40:43], v[128:131], v[160:163]
 v_mfma_f32_16x16x32_bf16 v[164:167], v[40:43], v[132:135], v[164:167]
 v_mfma_f32_16x16x32_bf16 v[168:171], v[44:47], v[128:131], v[168:171]
 v_mfma_f32_16x16x32_bf16 v[172:175], v[44:47], v[132:135], v[172:175]
 buffer_load_dwordx4 v[32:35], v22, s[16:19], s48 offen offset:0 sc1
 buffer_load_dwordx4 v[36:39], v22, s[16:19], s48 offen offset:256 sc1
 buffer_load_dwordx4 v[40:43], v22, s[16:19], s48 offen offset:512 sc1
 buffer_load_dwordx4 v[44:47], v22, s[16:19], s48 offen offset:768 sc1
 s_add_u32 s48, s48, 40960
 s_waitcnt vmcnt(32)
 v_mfma_f32_16x16x32_bf16 v[148:151], a[64:67], v[96:99], v[148:151]
 v_mfma_f32_16x16x32_bf16 v[144:147], a[64:67], v[100:103], v[144:147]
 v_mfma_f32_16x16x32_bf16 v[156:159], a[68:71], v[96:99], v[156:159]
 v_mfma_f32_16x16x32_bf16 v[152:155], a[68:71], v[100:103], v[152:155]
 v_mfma_f32_16x16x32_bf16 v[164:167], a[72:75], v[96:99], v[164:167]
 v_mfma_f32_16x16x32_bf16 v[160:163], a[72:75], v[100:103], v[160:163]
 v_mfma_f32_16x16x32_bf16 v[172:175], a[76:79], v[96:99], v[172:175]
 v_mfma_f32_16x16x32_bf16 v[168:171], a[76:79], v[100:103], v[168:171]
 s_add_u32 s53, s53, 40960
 buffer_load_dwordx4 a[64:67], v4, s[12:15], s53 offen offset:0 sc1
 buffer_load_dwordx4 a[68:71], v4, s[12:15], s53 offen offset:1024 sc1
 buffer_load_dwordx4 a[72:75], v4, s[12:15], s53 offen offset:2048 sc1
 buffer_load_dwordx4 a[76:79], v4, s[12:15], s53 offen offset:3072 sc1
 s_waitcnt vmcnt(32)
 v_mfma_f32_16x16x32_bf16 v[148:151], a[80:83], v[104:107], v[148:151]
 v_mfma_f32_16x16x32_bf16 v[144:147], a[80:83], v[108:111], v[144:147]
 v_mfma_f32_16x16x32_bf16 v[156:159], a[84:87], v[104:107], v[156:159]
 v_mfma_f32_16x16x32_bf16 v[152:155], a[84:87], v[108:111], v[152:155]
 v_mfma_f32_16x16x32_bf16 v[164:167], a[88:91], v[104:107], v[164:167]
 v_mfma_f32_16x16x32_bf16 v[160:163], a[88:91], v[108:111], v[160:163]
 v_mfma_f32_16x16x32_bf16 v[172:175], a[92:95], v[104:107], v[172:175]
 v_mfma_f32_16x16x32_bf16 v[168:171], a[92:95], v[108:111], v[168:171]
 s_add_u32 s53, s53, 40960
 buffer_load_dwordx4 a[80:83], v4, s[12:15], s53 offen offset:0 sc1
 buffer_load_dwordx4 a[84:87], v4, s[12:15], s53 offen offset:1024 sc1
 buffer_load_dwordx4 a[88:91], v4, s[12:15], s53 offen offset:2048 sc1
 buffer_load_dwordx4 a[92:95], v4, s[12:15], s53 offen offset:3072 sc1
 s_waitcnt vmcnt(34)
 v_mfma_f32_16x16x32_bf16 v[148:151], a[96:99], v[112:115], v[148:151]
 v_mfma_f32_16x16x32_bf16 v[144:147], a[96:99], v[116:119], v[144:147]
 v_mfma_f32_16x16x32_bf16 v[156:159], a[100:103], v[112:115], v[156:159]
 v_mfma_f32_16x16x32_bf16 v[152:155], a[100:103], v[116:119], v[152:155]
 v_mfma_f32_16x16x32_bf16 v[164:167], a[104:107], v[112:115], v[164:167]
 v_mfma_f32_16x16x32_bf16 v[160:163], a[104:107], v[116:119], v[160:163]
 v_mfma_f32_16x16x32_bf16 v[172:175], a[108:111], v[112:115], v[172:175]
 v_mfma_f32_16x16x32_bf16 v[168:171], a[108:111], v[116:119], v[168:171]
 s_add_u32 s53, s53, 40960
 buffer_load_dwordx4 a[96:99], v4, s[12:15], s53 offen offset:0 sc1
 buffer_load_dwordx4 a[100:103], v4, s[12:15], s53 offen offset:1024 sc1
 buffer_load_dwordx4 a[104:107], v4, s[12:15], s53 offen offset:2048 sc1
 buffer_load_dwordx4 a[108:111], v4, s[12:15], s53 offen offset:3072 sc1
 s_waitcnt vmcnt(36)
 v_mfma_f32_16x16x32_bf16 v[148:151], a[112:115], v[120:123], v[148:151]
 v_mfma_f32_16x16x32_bf16 v[144:147], a[112:115], v[124:127], v[144:147]
 v_mfma_f32_16x16x32_bf16 v[156:159], a[116:119], v[120:123], v[156:159]
 v_mfma_f32_16x16x32_bf16 v[152:155], a[116:119], v[124:127], v[152:155]
 v_mfma_f32_16x16x32_bf16 v[164:167], a[120:123], v[120:123], v[164:167]
 v_mfma_f32_16x16x32_bf16 v[160:163], a[120:123], v[124:127], v[160:163]
 v_mfma_f32_16x16x32_bf16 v[172:175], a[124:127], v[120:123], v[172:175]
 v_mfma_f32_16x16x32_bf16 v[168:171], a[124:127], v[124:127], v[168:171]
 s_add_u32 s53, s53, 40960
 buffer_load_dwordx4 a[112:115], v4, s[12:15], s53 offen offset:0 sc1
 buffer_load_dwordx4 a[116:119], v4, s[12:15], s53 offen offset:1024 sc1
 buffer_load_dwordx4 a[120:123], v4, s[12:15], s53 offen offset:2048 sc1
 buffer_load_dwordx4 a[124:127], v4, s[12:15], s53 offen offset:3072 sc1
 s_waitcnt vmcnt(36)
 v_mfma_f32_16x16x32_bf16 v[144:147], v[48:51], v[136:139], v[144:147]
 v_mfma_f32_16x16x32_bf16 v[148:151], v[48:51], v[140:143], v[148:151]
 v_mfma_f32_16x16x32_bf16 v[152:155], v[52:55], v[136:139], v[152:155]
 v_mfma_f32_16x16x32_bf16 v[156:159], v[52:55], v[140:143], v[156:159]
 v_mfma_f32_16x16x32_bf16 v[160:163], v[56:59], v[136:139], v[160:163]
 v_mfma_f32_16x16x32_bf16 v[164:167], v[56:59], v[140:143], v[164:167]
 v_mfma_f32_16x16x32_bf16 v[168:171], v[60:63], v[136:139], v[168:171]
 v_mfma_f32_16x16x32_bf16 v[172:175], v[60:63], v[140:143], v[172:175]
 buffer_load_dwordx4 v[48:51], v22, s[16:19], s48 offen offset:0 sc1
 buffer_load_dwordx4 v[52:55], v22, s[16:19], s48 offen offset:256 sc1
 buffer_load_dwordx4 v[56:59], v22, s[16:19], s48 offen offset:512 sc1
 buffer_load_dwordx4 v[60:63], v22, s[16:19], s48 offen offset:768 sc1
 s_add_u32 s48, s48, 40960
 s_branch pve_246
pvt_253:
 s_sub_u32 s55, s52, 2048
 s_cmp_lg_u32 s20, 0
 s_cbranch_scc1 wm_257
 s_mov_b32 s101, 0
wm_256:
 buffer_load_dword v26, v7, s[72:75], s55 offen sc1
 s_add_u32 s101, s101, 1
 s_cmp_gt_u32 s101, 131072
 s_cbranch_scc1 main_end
 s_waitcnt vmcnt(0)
 v_cmp_gt_u32 vcc, 4, v26
 v_readfirstlane_b32 s100, v26
 s_nop 0
 s_cbranch_vccz wm_257
 s_sleep 4
 s_add_u32 s100, s100, 3
 s_cmp_ge_u32 s100, 4
 s_cbranch_scc1 wm_256
 s_sleep 24
 s_branch wm_256
wm_257:
 s_barrier
 s_mov_b32 s56, s47
 s_mov_b32 s57, s48
 buffer_load_dwordx4 v[64:67], v4, s[16:19], s56 offen sc1
 buffer_load_dwordx2 v[68:69], v5, s[16:19], s56 offen offset:2048 sc1
 buffer_load_dwordx4 v[128:131], v21, s[16:19], s56 offen offset:1024 sc1
 buffer_load_dwordx4 v[132:135], v21, s[16:19], s56 offen offset:1280 sc1
 s_add_u32 s56, s56, 2560
 buffer_load_dwordx4 v[72:75], v4, s[16:19], s56 offen sc1
 buffer_load_dwordx2 v[76:77], v5, s[16:19], s56 offen offset:2048 sc1
 s_add_u32 s56, s56, 2560
 buffer_load_dwordx4 v[80:83], v4, s[16:19], s56 offen sc1
 buffer_load_dwordx2 v[84:85], v5, s[16:19], s56 offen offset:2048 sc1
 s_add_u32 s56, s56, 2560
 buffer_load_dwordx4 v[88:91], v4, s[16:19], s56 offen sc1
 buffer_load_dwordx2 v[92:93], v5, s[16:19], s56 offen offset:2048 sc1
 s_add_u32 s56, s56, 2560
 buffer_load_dwordx4 v[32:35], v22, s[16:19], s57 offen offset:0 sc1
 buffer_load_dwordx4 v[36:39], v22, s[16:19], s57 offen offset:256 sc1
 buffer_load_dwordx4 v[40:43], v22, s[16:19], s57 offen offset:512 sc1
 buffer_load_dwordx4 v[44:47], v22, s[16:19], s57 offen offset:768 sc1
 s_add_u32 s57, s57, 40960
 buffer_load_dwordx4 v[96:99], v4, s[16:19], s56 offen sc1
 buffer_load_dwordx2 v[100:101], v5, s[16:19], s56 offen offset:2048 sc1
 buffer_load_dwordx4 v[136:139], v21, s[16:19], s56 offen offset:1024 sc1
 buffer_load_dwordx4 v[140:143], v21, s[16:19], s56 offen offset:1280 sc1
 s_add_u32 s56, s56, 2560
 buffer_load_dwordx4 v[104:107], v4, s[16:19], s56 offen sc1
 buffer_load_dwordx2 v[108:109], v5, s[16:19], s56 offen offset:2048 sc1
 s_add_u32 s56, s56, 2560
 buffer_load_dwordx4 v[112:115], v4, s[16:19], s56 offen sc1
 buffer_load_dwordx2 v[116:117], v5, s[16:19], s56 offen offset:2048 sc1
 s_add_u32 s56, s56, 2560
 buffer_load_dwordx4 v[120:123], v4, s[16:19], s56 offen sc1
 buffer_load_dwordx2 v[124:125], v5, s[16:19], s56 offen offset:2048 sc1
 s_add_u32 s56, s56, 2560
 buffer_load_dwordx4 v[48:51], v22, s[16:19], s57 offen offset:0 sc1
 buffer_load_dwordx4 v[52:55], v22, s[16:19], s57 offen offset:256 sc1
 buffer_load_dwordx4 v[56:59], v22, s[16:19], s57 offen offset:512 sc1
 buffer_load_dwordx4 v[60:63], v22, s[16:19], s57 offen offset:768 sc1
 s_add_u32 s57, s57, 40960
pvc_251:
 s_mov_b32 s101, 0
 s_waitcnt vmcnt(14)
 s_branch pvr_259
pvr_258:
 s_sleep 2
 s_add_u32 s56, s47, 0
 s_add_u32 s57, s48, 0
 buffer_load_dwordx4 v[64:67], v4, s[16:19], s56 offen sc1
 buffer_load_dwordx2 v[68:69], v5, s[16:19], s56 offen offset:2048 sc1
 buffer_load_dwordx4 v[128:131], v21, s[16:19], s56 offen offset:1024 sc1
 buffer_load_dwordx4 v[132:135], v21, s[16:19], s56 offen offset:1280 sc1
 s_add_u32 s56, s56, 2560
 buffer_load_dwordx4 v[72:75], v4, s[16:19], s56 offen sc1
 buffer_load_dwordx2 v[76:77], v5, s[16:19], s56 offen offset:2048 sc1
 s_add_u32 s56, s56, 2560
 buffer_load_dwordx4 v[80:83], v4, s[16:19], s56 offen sc1
 buffer_load_dwordx2 v[84:85], v5, s[16:19], s56 offen offset:2048 sc1
 s_add_u32 s56, s56, 2560
 buffer_load_dwordx4 v[88:91], v4, s[16:19], s56 offen sc1
 buffer_load_dwordx2 v[92:93], v5, s[16:19], s56 offen offset:2048 sc1
 s_add_u32 s56, s56, 2560
 buffer_load_dwordx4 v[32:35], v22, s[16:19], s57 offen offset:0 sc1
 buffer_load_dwordx4 v[36:39], v22, s[16:19], s57 offen offset:256 sc1
 buffer_load_dwordx4 v[40:43], v22, s[16:19], s57 offen offset:512 sc1
 buffer_load_dwordx4 v[44:47], v22, s[16:19], s57 offen offset:768 sc1
 s_add_u32 s57, s57, 40960
 s_add_u32 s101, s101, 1
 s_cmp_gt_u32 s101, 131072
 s_cbranch_scc1 main_end
 s_waitcnt vmcnt(0)
pvr_259:
 v_max3_u32 v26, v64, v68, v72
 v_max3_u32 v26, v26, v76, v80
 v_max3_u32 v26, v26, v84, v88
 v_max3_u32 v26, v26, v92, v128
 v_max3_u32 v26, v26, v132, v32
 v_max3_u32 v26, v26, v36, v40
 v_max3_u32 v26, v26, v44, v44
 v_cmp_eq_u32 vcc, -1, v26
 s_nop 1
 s_cbranch_vccnz pvr_258
 v_mfma_f32_16x16x32_bf16 v[148:151], a[0:3], v[64:67], 0
 v_mfma_f32_16x16x32_bf16 v[144:147], a[0:3], v[68:71], 0
 v_mfma_f32_16x16x32_bf16 v[156:159], a[4:7], v[64:67], 0
 v_mfma_f32_16x16x32_bf16 v[152:155], a[4:7], v[68:71], 0
 v_mfma_f32_16x16x32_bf16 v[164:167], a[8:11], v[64:67], 0
 v_mfma_f32_16x16x32_bf16 v[160:163], a[8:11], v[68:71], 0
 v_mfma_f32_16x16x32_bf16 v[172:175], a[12:15], v[64:67], 0
 v_mfma_f32_16x16x32_bf16 v[168:171], a[12:15], v[68:71], 0
 v_mfma_f32_16x16x32_bf16 v[148:151], a[16:19], v[72:75], v[148:151]
 v_mfma_f32_16x16x32_bf16 v[144:147], a[16:19], v[76:79], v[144:147]
 v_mfma_f32_16x16x32_bf16 v[156:159], a[20:23], v[72:75], v[156:159]
 v_mfma_f32_16x16x32_bf16 v[152:155], a[20:23], v[76:79], v[152:155]
 v_mfma_f32_16x16x32_bf16 v[164:167], a[24:27], v[72:75], v[164:167]
 v_mfma_f32_16x16x32_bf16 v[160:163], a[24:27], v[76:79], v[160:163]
 v_mfma_f32_16x16x32_bf16 v[172:175], a[28:31], v[72:75], v[172:175]
 v_mfma_f32_16x16x32_bf16 v[168:171], a[28:31], v[76:79], v[168:171]
 v_mfma_f32_16x16x32_bf16 v[148:151], a[32:35], v[80:83], v[148:151]
 v_mfma_f32_16x16x32_bf16 v[144:147], a[32:35], v[84:87], v[144:147]
 v_mfma_f32_16x16x32_bf16 v[156:159], a[36:39], v[80:83], v[156:159]
 v_mfma_f32_16x16x32_bf16 v[152:155], a[36:39], v[84:87], v[152:155]
 v_mfma_f32_16x16x32_bf16 v[164:167], a[40:43], v[80:83], v[164:167]
 v_mfma_f32_16x16x32_bf16 v[160:163], a[40:43], v[84:87], v[160:163]
 v_mfma_f32_16x16x32_bf16 v[172:175], a[44:47], v[80:83], v[172:175]
 v_mfma_f32_16x16x32_bf16 v[168:171], a[44:47], v[84:87], v[168:171]
 v_mfma_f32_16x16x32_bf16 v[148:151], a[48:51], v[88:91], v[148:151]
 v_mfma_f32_16x16x32_bf16 v[144:147], a[48:51], v[92:95], v[144:147]
 v_mfma_f32_16x16x32_bf16 v[156:159], a[52:55], v[88:91], v[156:159]
 v_mfma_f32_16x16x32_bf16 v[152:155], a[52:55], v[92:95], v[152:155]
 v_mfma_f32_16x16x32_bf16 v[164:167], a[56:59], v[88:91], v[164:167]
 v_mfma_f32_16x16x32_bf16 v[160:163], a[56:59], v[92:95], v[160:163]
 v_mfma_f32_16x16x32_bf16 v[172:175], a[60:63], v[88:91], v[172:175]
 v_mfma_f32_16x16x32_bf16 v[168:171], a[60:63], v[92:95], v[168:171]
 s_nop 1
 v_mfma_f32_16x16x32_bf16 v[144:147], v[32:35], v[128:131], v[144:147]
 v_mfma_f32_16x16x32_bf16 v[148:151], v[32:35], v[132:135], v[148:151]
 v_mfma_f32_16x16x32_bf16 v[152:155], v[36:39], v[128:131], v[152:155]
 v_mfma_f32_16x16x32_bf16 v[156:159], v[36:39], v[132:135], v[156:159]
 v_mfma_f32_16x16x32_bf16 v[160:163], v[40:43], v[128:131], v[160:163]
 v_mfma_f32_16x16x32_bf16 v[164:167], v[40:43], v[132:135], v[164:167]
 v_mfma_f32_16x16x32_bf16 v[168:171], v[44:47], v[128:131], v[168:171]
 v_mfma_f32_16x16x32_bf16 v[172:175], v[44:47], v[132:135], v[172:175]
 s_mov_b32 s101, 0
 s_waitcnt vmcnt(0)
 s_branch pvr_261
pvr_260:
 s_sleep 2
 s_add_u32 s56, s47, 10240
 s_add_u32 s57, s48, 40960
 buffer_load_dwordx4 v[96:99], v4, s[16:19], s56 offen sc1
 buffer_load_dwordx2 v[100:101], v5, s[16:19], s56 offen offset:2048 sc1
 buffer_load_dwordx4 v[136:139], v21, s[16:19], s56 offen offset:1024 sc1
 buffer_load_dwordx4 v[140:143], v21, s[16:19], s56 offen offset:1280 sc1
 s_add_u32 s56, s56, 2560
 buffer_load_dwordx4 v[104:107], v4, s[16:19], s56 offen sc1
 buffer_load_dwordx2 v[108:109], v5, s[16:19], s56 offen offset:2048 sc1
 s_add_u32 s56, s56, 2560
 buffer_load_dwordx4 v[112:115], v4, s[16:19], s56 offen sc1
 buffer_load_dwordx2 v[116:117], v5, s[16:19], s56 offen offset:2048 sc1
 s_add_u32 s56, s56, 2560
 buffer_load_dwordx4 v[120:123], v4, s[16:19], s56 offen sc1
 buffer_load_dwordx2 v[124:125], v5, s[16:19], s56 offen offset:2048 sc1
 s_add_u32 s56, s56, 2560
 buffer_load_dwordx4 v[48:51], v22, s[16:19], s57 offen offset:0 sc1
 buffer_load_dwordx4 v[52:55], v22, s[16:19], s57 offen offset:256 sc1
 buffer_load_dwordx4 v[56:59], v22, s[16:19], s57 offen offset:512 sc1
 buffer_load_dwordx4 v[60:63], v22, s[16:19], s57 offen offset:768 sc1
 s_add_u32 s57, s57, 40960
 s_add_u32 s101, s101, 1
 s_cmp_gt_u32 s101, 131072
 s_cbranch_scc1 main_end
 s_waitcnt vmcnt(0)
pvr_261:
 v_max3_u32 v26, v96, v100, v104
 v_max3_u32 v26, v26, v108, v112
 v_max3_u32 v26, v26, v116, v120
 v_max3_u32 v26, v26, v124, v136
 v_max3_u32 v26, v26, v140, v48
 v_max3_u32 v26, v26, v52, v56
 v_max3_u32 v26, v26, v60, v60
 v_cmp_eq_u32 vcc, -1, v26
 s_nop 1
 s_cbranch_vccnz pvr_260
 v_mfma_f32_16x16x32_bf16 v[148:151], a[64:67], v[96:99], v[148:151]
 v_mfma_f32_16x16x32_bf16 v[144:147], a[64:67], v[100:103], v[144:147]
 v_mfma_f32_16x16x32_bf16 v[156:159], a[68:71], v[96:99], v[156:159]
 v_mfma_f32_16x16x32_bf16 v[152:155], a[68:71], v[100:103], v[152:155]
 v_mfma_f32_16x16x32_bf16 v[164:167], a[72:75], v[96:99], v[164:167]
 v_mfma_f32_16x16x32_bf16 v[160:163], a[72:75], v[100:103], v[160:163]
 v_mfma_f32_16x16x32_bf16 v[172:175], a[76:79], v[96:99], v[172:175]
 v_mfma_f32_16x16x32_bf16 v[168:171], a[76:79], v[100:103], v[168:171]
 v_mfma_f32_16x16x32_bf16 v[148:151], a[80:83], v[104:107], v[148:151]
 v_mfma_f32_16x16x32_bf16 v[144:147], a[80:83], v[108:111], v[144:147]
 v_mfma_f32_16x16x32_bf16 v[156:159], a[84:87], v[104:107], v[156:159]
 v_mfma_f32_16x16x32_bf16 v[152:155], a[84:87], v[108:111], v[152:155]
 v_mfma_f32_16x16x32_bf16 v[164:167], a[88:91], v[104:107], v[164:167]
 v_mfma_f32_16x16x32_bf16 v[160:163], a[88:91], v[108:111], v[160:163]
 v_mfma_f32_16x16x32_bf16 v[172:175], a[92:95], v[104:107], v[172:175]
 v_mfma_f32_16x16x32_bf16 v[168:171], a[92:95], v[108:111], v[168:171]
 v_mfma_f32_16x16x32_bf16 v[148:151], a[96:99], v[112:115], v[148:151]
 v_mfma_f32_16x16x32_bf16 v[144:147], a[96:99], v[116:119], v[144:147]
 v_mfma_f32_16x16x32_bf16 v[156:159], a[100:103], v[112:115], v[156:159]
 v_mfma_f32_16x16x32_bf16 v[152:155], a[100:103], v[116:119], v[152:155]
 v_mfma_f32_16x16x32_bf16 v[164:167], a[104:107], v[112:115], v[164:167]
 v_mfma_f32_16x16x32_bf16 v[160:163], a[104:107], v[116:119], v[160:163]
 v_mfma_f32_16x16x32_bf16 v[172:175], a[108:111], v[112:115], v[172:175]
 v_mfma_f32_16x16x32_bf16 v[168:171], a[108:111], v[116:119], v[168:171]
 v_mfma_f32_16x16x32_bf16 v[148:151], a[112:115], v[120:123], v[148:151]
 v_mfma_f32_16x16x32_bf16 v[144:147], a[112:115], v[124:127], v[144:147]
 v_mfma_f32_16x16x32_bf16 v[156:159], a[116:119], v[120:123], v[156:159]
 v_mfma_f32_16x16x32_bf16 v[152:155], a[116:119], v[124:127], v[152:155]
 v_mfma_f32_16x16x32_bf16 v[164:167], a[120:123], v[120:123], v[164:167]
 v_mfma_f32_16x16x32_bf16 v[160:163], a[120:123], v[124:127], v[160:163]
 v_mfma_f32_16x16x32_bf16 v[172:175], a[124:127], v[120:123], v[172:175]
 v_mfma_f32_16x16x32_bf16 v[168:171], a[124:127], v[124:127], v[168:171]
 s_nop 1
 v_mfma_f32_16x16x32_bf16 v[144:147], v[48:51], v[136:139], v[144:147]
 v_mfma_f32_16x16x32_bf16 v[148:151], v[48:51], v[140:143], v[148:151]
 v_mfma_f32_16x16x32_bf16 v[152:155], v[52:55], v[136:139], v[152:155]
 v_mfma_f32_16x16x32_bf16 v[156:159], v[52:55], v[140:143], v[156:159]
 v_mfma_f32_16x16x32_bf16 v[160:163], v[56:59], v[136:139], v[160:163]
 v_mfma_f32_16x16x32_bf16 v[164:167], v[56:59], v[140:143], v[164:167]
 v_mfma_f32_16x16x32_bf16 v[168:171], v[60:63], v[136:139], v[168:171]
 v_mfma_f32_16x16x32_bf16 v[172:175], v[60:63], v[140:143], v[172:175]
pve_246:
 s_nop 0
 s_cmp_lg_u32 s20, 0
 s_cbranch_scc1 lc_262
 s_sub_u32 s21, s2, 0
 s_cmp_ge_u32 s21, 640
 s_cbranch_scc1 lc_262
 v_mov_b32 v29, 1
 s_mov_b64 exec, 1
 buffer_atomic_add v29, v28, s[32:35], 0 offen sc0 sc1
 s_mov_b64 exec, -1
lc_262:
 ds_write_b128 v10, v[144:147] offset:0
 ds_write_b128 v10, v[148:151] offset:1024
 ds_write_b128 v10, v[152:155] offset:2048
 ds_write_b128 v10, v[156:159] offset:3072
 ds_write_b128 v10, v[160:163] offset:4096
 ds_write_b128 v10, v[164:167] offset:5120
 ds_write_b128 v10, v[168:171] offset:6144
 ds_write_b128 v10, v[172:175] offset:7168
 s_cmp_lg_u32 s20, 0
 s_cbranch_scc1 pvq_265
 v_readfirstlane_b32 s21, v29
 s_mov_b32 s23, -1
 v_mov_b32 v213, s23
 s_mov_b64 exec, 1
 ds_write_b32 v30, v29
 ds_write_b32 v30, v213 offset:8
 s_mov_b64 exec, -1
pvq_265:
 s_waitcnt lgkmcnt(0)
 s_barrier
 ds_read_b128 v[176:179], v11 offset:0
 ds_read_b128 v[180:183], v11 offset:8192
 ds_read_b128 v[184:187], v11 offset:16384
 ds_read_b128 v[188:191], v11 offset:24576
 ds_read_b128 v[192:195], v11 offset:4096
 ds_read_b128 v[196:199], v11 offset:12288
 ds_read_b128 v[200:203], v11 offset:20480
 ds_read_b128 v[204:207], v11 offset:28672
 ds_read_b32 v23, v30
 ds_read_b32 v213, v30 offset:8
 s_cmp_ge_u32 s40, 32
 s_cbranch_scc1 pvr_268
 s_waitcnt lgkmcnt(6)
 v_pk_add_f32 v[176:177], v[176:177], v[180:181]
 v_pk_add_f32 v[184:185], v[184:185], v[188:189]
 v_pk_add_f32 v[178:179], v[178:179], v[182:183]
 v_pk_add_f32 v[186:187], v[186:187], v[190:191]
 v_pk_add_f32 v[176:177], v[176:177], v[184:185]
 v_pk_add_f32 v[178:179], v[178:179], v[186:187]
 buffer_store_dwordx4 v[176:179], v4, s[24:27], s54 offen offset:0 sc1
 s_waitcnt lgkmcnt(2)
 v_pk_add_f32 v[192:193], v[192:193], v[196:197]
 v_pk_add_f32 v[200:201], v[200:201], v[204:205]
 v_pk_add_f32 v[194:195], v[194:195], v[198:199]
 v_pk_add_f32 v[202:203], v[202:203], v[206:207]
 v_pk_add_f32 v[192:193], v[192:193], v[200:201]
 v_pk_add_f32 v[194:195], v[194:195], v[202:203]
 buffer_store_dwordx4 v[192:195], v4, s[24:27], s54 offen offset:2048 sc1
 s_lshr_b32 s71, s40, 2
 s_lshl_b32 s71, s71, 7
 s_add_u32 s71, s71, 115712
 s_branch pvr_269
pvr_268:
 s_waitcnt lgkmcnt(6)
 v_pk_add_f32 v[176:177], v[176:177], v[180:181]
 v_pk_add_f32 v[184:185], v[184:185], v[188:189]
 v_pk_add_f32 v[178:179], v[178:179], v[182:183]
 v_pk_add_f32 v[186:187], v[186:187], v[190:191]
 v_pk_add_f32 v[176:177], v[176:177], v[184:185]
 v_pk_add_f32 v[178:179], v[178:179], v[186:187]
 v_cvt_pk_bf16_f32 v26, v176, v177
 v_lshlrev_b32 v176, 16, v26
 v_and_b32 v177, 0xffff0000, v26
 v_mul_f32 v176, v176, v24
 v_mul_f32 v177, v177, v24
 v_cvt_pk_bf16_f32 v26, v176, v177
 v_lshlrev_b32 v176, 16, v26
 v_and_b32 v177, 0xffff0000, v26
 v_add_f32 v176, v176, v12
 v_add_f32 v177, v177, v13
 v_cvt_pk_bf16_f32 v180, v176, v177
 v_cvt_pk_bf16_f32 v26, v178, v179
 v_lshlrev_b32 v178, 16, v26
 v_and_b32 v179, 0xffff0000, v26
 v_mul_f32 v178, v178, v24
 v_mul_f32 v179, v179, v24
 v_cvt_pk_bf16_f32 v26, v178, v179
 v_lshlrev_b32 v178, 16, v26
 v_and_b32 v179, 0xffff0000, v26
 v_add_f32 v178, v178, v14
 v_add_f32 v179, v179, v15
 v_cvt_pk_bf16_f32 v181, v178, v179
 buffer_store_dwordx2 v[180:181], v9, s[8:11], s46 offen offset:0
 s_waitcnt lgkmcnt(2)
 v_pk_add_f32 v[192:193], v[192:193], v[196:197]
 v_pk_add_f32 v[200:201], v[200:201], v[204:205]
 v_pk_add_f32 v[194:195], v[194:195], v[198:199]
 v_pk_add_f32 v[202:203], v[202:203], v[206:207]
 v_pk_add_f32 v[192:193], v[192:193], v[200:201]
 v_pk_add_f32 v[194:195], v[194:195], v[202:203]
 v_cvt_pk_bf16_f32 v26, v192, v193
 v_lshlrev_b32 v192, 16, v26
 v_and_b32 v193, 0xffff0000, v26
 v_mul_f32 v192, v192, v24
 v_mul_f32 v193, v193, v24
 v_cvt_pk_bf16_f32 v26, v192, v193
 v_lshlrev_b32 v192, 16, v26
 v_and_b32 v193, 0xffff0000, v26
 v_add_f32 v192, v192, v16
 v_add_f32 v193, v193, v17
 v_cvt_pk_bf16_f32 v196, v192, v193
 v_cvt_pk_bf16_f32 v26, v194, v195
 v_lshlrev_b32 v194, 16, v26
 v_and_b32 v195, 0xffff0000, v26
 v_mul_f32 v194, v194, v24
 v_mul_f32 v195, v195, v24
 v_cvt_pk_bf16_f32 v26, v194, v195
 v_lshlrev_b32 v194, 16, v26
 v_and_b32 v195, 0xffff0000, v26
 v_add_f32 v194, v194, v18
 v_add_f32 v195, v195, v19
 v_cvt_pk_bf16_f32 v197, v194, v195
 buffer_store_dwordx2 v[196:197], v9, s[8:11], s46 offen offset:64
pvr_269:
pvy_270:
 s_cmp_eq_u32 s65, 0
 s_cbranch_scc1 pvy_271
 s_sub_u32 s65, s65, 1
 s_add_u32 s46, s46, 128
 s_add_u32 s54, s54, 4096
 s_cmp_lt_u32 s40, 32
 s_cselect_b32 s70, 0x80000000, s54
 buffer_load_dwordx4 v[12:15], v4, s[24:27], s70 offen sc1
 buffer_load_dwordx4 v[16:19], v4, s[24:27], s70 offen offset:2048 sc1
 buffer_load_dword v24, v6, s[28:31], s45 offen sc1
 s_waitcnt lgkmcnt(0)
 s_barrier
 s_cmp_eq_u32 s65, 0
 s_cbranch_scc1 pvy_272
 s_add_u32 s41, s41, 1
 s_mul_i32 s53, s42, 40960
 s_lshl_b32 s22, s41, 12
 s_add_u32 s53, s53, s22
 s_mul_i32 s48, s42, 10240
 s_lshl_b32 s22, s41, 10
 s_add_u32 s48, s48, s22
 s_add_u32 s48, s48, 15728640
 s_waitcnt vmcnt(41)
 v_mfma_f32_16x16x32_bf16 v[148:151], a[0:3], v[64:67], 0
 v_mfma_f32_16x16x32_bf16 v[144:147], a[0:3], v[68:71], 0
 v_mfma_f32_16x16x32_bf16 v[156:159], a[4:7], v[64:67], 0
 v_mfma_f32_16x16x32_bf16 v[152:155], a[4:7], v[68:71], 0
 v_mfma_f32_16x16x32_bf16 v[164:167], a[8:11], v[64:67], 0
 v_mfma_f32_16x16x32_bf16 v[160:163], a[8:11], v[68:71], 0
 v_mfma_f32_16x16x32_bf16 v[172:175], a[12:15], v[64:67], 0
 v_mfma_f32_16x16x32_bf16 v[168:171], a[12:15], v[68:71], 0
 buffer_load_dwordx4 a[0:3], v4, s[12:15], s53 offen offset:0 sc1
 buffer_load_dwordx4 a[4:7], v4, s[12:15], s53 offen offset:1024 sc1
 buffer_load_dwordx4 a[8:11], v4, s[12:15], s53 offen offset:2048 sc1
 buffer_load_dwordx4 a[12:15], v4, s[12:15], s53 offen offset:3072 sc1
 s_waitcnt vmcnt(41)
 v_mfma_f32_16x16x32_bf16 v[148:151], a[16:19], v[72:75], v[148:151]
 v_mfma_f32_16x16x32_bf16 v[144:147], a[16:19], v[76:79], v[144:147]
 v_mfma_f32_16x16x32_bf16 v[156:159], a[20:23], v[72:75], v[156:159]
 v_mfma_f32_16x16x32_bf16 v[152:155], a[20:23], v[76:79], v[152:155]
 v_mfma_f32_16x16x32_bf16 v[164:167], a[24:27], v[72:75], v[164:167]
 v_mfma_f32_16x16x32_bf16 v[160:163], a[24:27], v[76:79], v[160:163]
 v_mfma_f32_16x16x32_bf16 v[172:175], a[28:31], v[72:75], v[172:175]
 v_mfma_f32_16x16x32_bf16 v[168:171], a[28:31], v[76:79], v[168:171]
 s_add_u32 s53, s53, 40960
 buffer_load_dwordx4 a[16:19], v4, s[12:15], s53 offen offset:0 sc1
 buffer_load_dwordx4 a[20:23], v4, s[12:15], s53 offen offset:1024 sc1
 buffer_load_dwordx4 a[24:27], v4, s[12:15], s53 offen offset:2048 sc1
 buffer_load_dwordx4 a[28:31], v4, s[12:15], s53 offen offset:3072 sc1
 s_waitcnt vmcnt(41)
 v_mfma_f32_16x16x32_bf16 v[148:151], a[32:35], v[80:83], v[148:151]
 v_mfma_f32_16x16x32_bf16 v[144:147], a[32:35], v[84:87], v[144:147]
 v_mfma_f32_16x16x32_bf16 v[156:159], a[36:39], v[80:83], v[156:159]
 v_mfma_f32_16x16x32_bf16 v[152:155], a[36:39], v[84:87], v[152:155]
 v_mfma_f32_16x16x32_bf16 v[164:167], a[40:43], v[80:83], v[164:167]
 v_mfma_f32_16x16x32_bf16 v[160:163], a[40:43], v[84:87], v[160:163]
 v_mfma_f32_16x16x32_bf16 v[172:175], a[44:47], v[80:83], v[172:175]
 v_mfma_f32_16x16x32_bf16 v[168:171], a[44:47], v[84:87], v[168:171]
 s_add_u32 s53, s53, 40960
 buffer_load_dwordx4 a[32:35], v4, s[12:15], s53 offen offset:0 sc1
 buffer_load_dwordx4 a[36:39], v4, s[12:15], s53 offen offset:1024 sc1
 buffer_load_dwordx4 a[40:43], v4, s[12:15], s53 offen offset:2048 sc1
 buffer_load_dwordx4 a[44:47], v4, s[12:15], s53 offen offset:3072 sc1
 s_waitcnt vmcnt(41)
 v_mfma_f32_16x16x32_bf16 v[148:151], a[48:51], v[88:91], v[148:151]
 v_mfma_f32_16x16x32_bf16 v[144:147], a[48:51], v[92:95], v[144:147]
 v_mfma_f32_16x16x32_bf16 v[156:159], a[52:55], v[88:91], v[156:159]
 v_mfma_f32_16x16x32_bf16 v[152:155], a[52:55], v[92:95], v[152:155]
 v_mfma_f32_16x16x32_bf16 v[164:167], a[56:59], v[88:91], v[164:167]
 v_mfma_f32_16x16x32_bf16 v[160:163], a[56:59], v[92:95], v[160:163]
 v_mfma_f32_16x16x32_bf16 v[172:175], a[60:63], v[88:91], v[172:175]
 v_mfma_f32_16x16x32_bf16 v[168:171], a[60:63], v[92:95], v[168:171]
 s_add_u32 s53, s53, 40960
 buffer_load_dwordx4 a[48:51], v4, s[12:15], s53 offen offset:0 sc1
 buffer_load_dwordx4 a[52:55], v4, s[12:15], s53 offen offset:1024 sc1
 buffer_load_dwordx4 a[56:59], v4, s[12:15], s53 offen offset:2048 sc1
 buffer_load_dwordx4 a[60:63], v4, s[12:15], s53 offen offset:3072 sc1
 s_waitcnt vmcnt(41)
 v_mfma_f32_16x16x32_bf16 v[144:147], v[32:35], v[128:131], v[144:147]
 v_mfma_f32_16x16x32_bf16 v[148:151], v[32:35], v[132:135], v[148:151]
 v_mfma_f32_16x16x32_bf16 v[152:155], v[36:39], v[128:131], v[152:155]
 v_mfma_f32_16x16x32_bf16 v[156:159], v[36:39], v[132:135], v[156:159]
 v_mfma_f32_16x16x32_bf16 v[160:163], v[40:43], v[128:131], v[160:163]
 v_mfma_f32_16x16x32_bf16 v[164:167], v[40:43], v[132:135], v[164:167]
 v_mfma_f32_16x16x32_bf16 v[168:171], v[44:47], v[128:131], v[168:171]
 v_mfma_f32_16x16x32_bf16 v[172:175], v[44:47], v[132:135], v[172:175]
 buffer_load_dwordx4 v[32:35], v22, s[16:19], s48 offen offset:0 sc1
 buffer_load_dwordx4 v[36:39], v22, s[16:19], s48 offen offset:256 sc1
 buffer_load_dwordx4 v[40:43], v22, s[16:19], s48 offen offset:512 sc1
 buffer_load_dwordx4 v[44:47], v22, s[16:19], s48 offen offset:768 sc1
 s_add_u32 s48, s48, 40960
 s_waitcnt vmcnt(41)
 v_mfma_f32_16x16x32_bf16 v[148:151], a[64:67], v[96:99], v[148:151]
 v_mfma_f32_16x16x32_bf16 v[144:147], a[64:67], v[100:103], v[144:147]
 v_mfma_f32_16x16x32_bf16 v[156:159], a[68:71], v[96:99], v[156:159]
 v_mfma_f32_16x16x32_bf16 v[152:155], a[68:71], v[100:103], v[152:155]
 v_mfma_f32_16x16x32_bf16 v[164:167], a[72:75], v[96:99], v[164:167]
 v_mfma_f32_16x16x32_bf16 v[160:163], a[72:75], v[100:103], v[160:163]
 v_mfma_f32_16x16x32_bf16 v[172:175], a[76:79], v[96:99], v[172:175]
 v_mfma_f32_16x16x32_bf16 v[168:171], a[76:79], v[100:103], v[168:171]
 s_add_u32 s53, s53, 40960
 buffer_load_dwordx4 a[64:67], v4, s[12:15], s53 offen offset:0 sc1
 buffer_load_dwordx4 a[68:71], v4, s[12:15], s53 offen offset:1024 sc1
 buffer_load_dwordx4 a[72:75], v4, s[12:15], s53 offen offset:2048 sc1
 buffer_load_dwordx4 a[76:79], v4, s[12:15], s53 offen offset:3072 sc1
 s_waitcnt vmcnt(41)
 v_mfma_f32_16x16x32_bf16 v[148:151], a[80:83], v[104:107], v[148:151]
 v_mfma_f32_16x16x32_bf16 v[144:147], a[80:83], v[108:111], v[144:147]
 v_mfma_f32_16x16x32_bf16 v[156:159], a[84:87], v[104:107], v[156:159]
 v_mfma_f32_16x16x32_bf16 v[152:155], a[84:87], v[108:111], v[152:155]
 v_mfma_f32_16x16x32_bf16 v[164:167], a[88:91], v[104:107], v[164:167]
 v_mfma_f32_16x16x32_bf16 v[160:163], a[88:91], v[108:111], v[160:163]
 v_mfma_f32_16x16x32_bf16 v[172:175], a[92:95], v[104:107], v[172:175]
 v_mfma_f32_16x16x32_bf16 v[168:171], a[92:95], v[108:111], v[168:171]
 s_add_u32 s53, s53, 40960
 buffer_load_dwordx4 a[80:83], v4, s[12:15], s53 offen offset:0 sc1
 buffer_load_dwordx4 a[84:87], v4, s[12:15], s53 offen offset:1024 sc1
 buffer_load_dwordx4 a[88:91], v4, s[12:15], s53 offen offset:2048 sc1
 buffer_load_dwordx4 a[92:95], v4, s[12:15], s53 offen offset:3072 sc1
 s_waitcnt vmcnt(41)
 v_mfma_f32_16x16x32_bf16 v[148:151], a[96:99], v[112:115], v[148:151]
 v_mfma_f32_16x16x32_bf16 v[144:147], a[96:99], v[116:119], v[144:147]
 v_mfma_f32_16x16x32_bf16 v[156:159], a[100:103], v[112:115], v[156:159]
 v_mfma_f32_16x16x32_bf16 v[152:155], a[100:103], v[116:119], v[152:155]
 v_mfma_f32_16x16x32_bf16 v[164:167], a[104:107], v[112:115], v[164:167]
 v_mfma_f32_16x16x32_bf16 v[160:163], a[104:107], v[116:119], v[160:163]
 v_mfma_f32_16x16x32_bf16 v[172:175], a[108:111], v[112:115], v[172:175]
 v_mfma_f32_16x16x32_bf16 v[168:171], a[108:111], v[116:119], v[168:171]
 s_add_u32 s53, s53, 40960
 buffer_load_dwordx4 a[96:99], v4, s[12:15], s53 offen offset:0 sc1
 buffer_load_dwordx4 a[100:103], v4, s[12:15], s53 offen offset:1024 sc1
 buffer_load_dwordx4 a[104:107], v4, s[12:15], s53 offen offset:2048 sc1
 buffer_load_dwordx4 a[108:111], v4, s[12:15], s53 offen offset:3072 sc1
 s_waitcnt vmcnt(41)
 v_mfma_f32_16x16x32_bf16 v[148:151], a[112:115], v[120:123], v[148:151]
 v_mfma_f32_16x16x32_bf16 v[144:147], a[112:115], v[124:127], v[144:147]
 v_mfma_f32_16x16x32_bf16 v[156:159], a[116:119], v[120:123], v[156:159]
 v_mfma_f32_16x16x32_bf16 v[152:155], a[116:119], v[124:127], v[152:155]
 v_mfma_f32_16x16x32_bf16 v[164:167], a[120:123], v[120:123], v[164:167]
 v_mfma_f32_16x16x32_bf16 v[160:163], a[120:123], v[124:127], v[160:163]
 v_mfma_f32_16x16x32_bf16 v[172:175], a[124:127], v[120:123], v[172:175]
 v_mfma_f32_16x16x32_bf16 v[168:171], a[124:127], v[124:127], v[168:171]
 s_add_u32 s53, s53, 40960
 buffer_load_dwordx4 a[112:115], v4, s[12:15], s53 offen offset:0 sc1
 buffer_load_dwordx4 a[116:119], v4, s[12:15], s53 offen offset:1024 sc1
 buffer_load_dwordx4 a[120:123], v4, s[12:15], s53 offen offset:2048 sc1
 buffer_load_dwordx4 a[124:127], v4, s[12:15], s53 offen offset:3072 sc1
 s_waitcnt vmcnt(41)
 v_mfma_f32_16x16x32_bf16 v[144:147], v[48:51], v[136:139], v[144:147]
 v_mfma_f32_16x16x32_bf16 v[148:151], v[48:51], v[140:143], v[148:151]
 v_mfma_f32_16x16x32_bf16 v[152:155], v[52:55], v[136:139], v[152:155]
 v_mfma_f32_16x16x32_bf16 v[156:159], v[52:55], v[140:143], v[156:159]
 v_mfma_f32_16x16x32_bf16 v[160:163], v[56:59], v[136:139], v[160:163]
 v_mfma_f32_16x16x32_bf16 v[164:167], v[56:59], v[140:143], v[164:167]
 v_mfma_f32_16x16x32_bf16 v[168:171], v[60:63], v[136:139], v[168:171]
 v_mfma_f32_16x16x32_bf16 v[172:175], v[60:63], v[140:143], v[172:175]
 buffer_load_dwordx4 v[48:51], v22, s[16:19], s48 offen offset:0 sc1
 buffer_load_dwordx4 v[52:55], v22, s[16:19], s48 offen offset:256 sc1
 buffer_load_dwordx4 v[56:59], v22, s[16:19], s48 offen offset:512 sc1
 buffer_load_dwordx4 v[60:63], v22, s[16:19], s48 offen offset:768 sc1
 s_add_u32 s48, s48, 40960
 s_waitcnt vmcnt(40)
 s_branch pvy_273
pvy_272:
 s_waitcnt vmcnt(41)
 v_mfma_f32_16x16x32_bf16 v[148:151], a[0:3], v[64:67], 0
 v_mfma_f32_16x16x32_bf16 v[144:147], a[0:3], v[68:71], 0
 v_mfma_f32_16x16x32_bf16 v[156:159], a[4:7], v[64:67], 0
 v_mfma_f32_16x16x32_bf16 v[152:155], a[4:7], v[68:71], 0
 v_mfma_f32_16x16x32_bf16 v[164:167], a[8:11], v[64:67], 0
 v_mfma_f32_16x16x32_bf16 v[160:163], a[8:11], v[68:71], 0
 v_mfma_f32_16x16x32_bf16 v[172:175], a[12:15], v[64:67], 0
 v_mfma_f32_16x16x32_bf16 v[168:171], a[12:15], v[68:71], 0
 s_waitcnt vmcnt(37)
 v_mfma_f32_16x16x32_bf16 v[148:151], a[16:19], v[72:75], v[148:151]
 v_mfma_f32_16x16x32_bf16 v[144:147], a[16:19], v[76:79], v[144:147]
 v_mfma_f32_16x16x32_bf16 v[156:159], a[20:23], v[72:75], v[156:159]
 v_mfma_f32_16x16x32_bf16 v[152:155], a[20:23], v[76:79], v[152:155]
 v_mfma_f32_16x16x32_bf16 v[164:167], a[24:27], v[72:75], v[164:167]
 v_mfma_f32_16x16x32_bf16 v[160:163], a[24:27], v[76:79], v[160:163]
 v_mfma_f32_16x16x32_bf16 v[172:175], a[28:31], v[72:75], v[172:175]
 v_mfma_f32_16x16x32_bf16 v[168:171], a[28:31], v[76:79], v[168:171]
 s_waitcnt vmcnt(33)
 v_mfma_f32_16x16x32_bf16 v[148:151], a[32:35], v[80:83], v[148:151]
 v_mfma_f32_16x16x32_bf16 v[144:147], a[32:35], v[84:87], v[144:147]
 v_mfma_f32_16x16x32_bf16 v[156:159], a[36:39], v[80:83], v[156:159]
 v_mfma_f32_16x16x32_bf16 v[152:155], a[36:39], v[84:87], v[152:155]
 v_mfma_f32_16x16x32_bf16 v[164:167], a[40:43], v[80:83], v[164:167]
 v_mfma_f32_16x16x32_bf16 v[160:163], a[40:43], v[84:87], v[160:163]
 v_mfma_f32_16x16x32_bf16 v[172:175], a[44:47], v[80:83], v[172:175]
 v_mfma_f32_16x16x32_bf16 v[168:171], a[44:47], v[84:87], v[168:171]
 s_waitcnt vmcnt(29)
 v_mfma_f32_16x16x32_bf16 v[148:151], a[48:51], v[88:91], v[148:151]
 v_mfma_f32_16x16x32_bf16 v[144:147], a[48:51], v[92:95], v[144:147]
 v_mfma_f32_16x16x32_bf16 v[156:159], a[52:55], v[88:91], v[156:159]
 v_mfma_f32_16x16x32_bf16 v[152:155], a[52:55], v[92:95], v[152:155]
 v_mfma_f32_16x16x32_bf16 v[164:167], a[56:59], v[88:91], v[164:167]
 v_mfma_f32_16x16x32_bf16 v[160:163], a[56:59], v[92:95], v[160:163]
 v_mfma_f32_16x16x32_bf16 v[172:175], a[60:63], v[88:91], v[172:175]
 v_mfma_f32_16x16x32_bf16 v[168:171], a[60:63], v[92:95], v[168:171]
 s_waitcnt vmcnt(25)
 v_mfma_f32_16x16x32_bf16 v[144:147], v[32:35], v[128:131], v[144:147]
 v_mfma_f32_16x16x32_bf16 v[148:151], v[32:35], v[132:135], v[148:151]
 v_mfma_f32_16x16x32_bf16 v[152:155], v[36:39], v[128:131], v[152:155]
 v_mfma_f32_16x16x32_bf16 v[156:159], v[36:39], v[132:135], v[156:159]
 v_mfma_f32_16x16x32_bf16 v[160:163], v[40:43], v[128:131], v[160:163]
 v_mfma_f32_16x16x32_bf16 v[164:167], v[40:43], v[132:135], v[164:167]
 v_mfma_f32_16x16x32_bf16 v[168:171], v[44:47], v[128:131], v[168:171]
 v_mfma_f32_16x16x32_bf16 v[172:175], v[44:47], v[132:135], v[172:175]
 s_waitcnt vmcnt(21)
 v_mfma_f32_16x16x32_bf16 v[148:151], a[64:67], v[96:99], v[148:151]
 v_mfma_f32_16x16x32_bf16 v[144:147], a[64:67], v[100:103], v[144:147]
 v_mfma_f32_16x16x32_bf16 v[156:159], a[68:71], v[96:99], v[156:159]
 v_mfma_f32_16x16x32_bf16 v[152:155], a[68:71], v[100:103], v[152:155]
 v_mfma_f32_16x16x32_bf16 v[164:167], a[72:75], v[96:99], v[164:167]
 v_mfma_f32_16x16x32_bf16 v[160:163], a[72:75], v[100:103], v[160:163]
 v_mfma_f32_16x16x32_bf16 v[172:175], a[76:79], v[96:99], v[172:175]
 v_mfma_f32_16x16x32_bf16 v[168:171], a[76:79], v[100:103], v[168:171]
 s_waitcnt vmcnt(17)
 v_mfma_f32_16x16x32_bf16 v[148:151], a[80:83], v[104:107], v[148:151]
 v_mfma_f32_16x16x32_bf16 v[144:147], a[80:83], v[108:111], v[144:147]
 v_mfma_f32_16x16x32_bf16 v[156:159], a[84:87], v[104:107], v[156:159]
 v_mfma_f32_16x16x32_bf16 v[152:155], a[84:87], v[108:111], v[152:155]
 v_mfma_f32_16x16x32_bf16 v[164:167], a[88:91], v[104:107], v[164:167]
 v_mfma_f32_16x16x32_bf16 v[160:163], a[88:91], v[108:111], v[160:163]
 v_mfma_f32_16x16x32_bf16 v[172:175], a[92:95], v[104:107], v[172:175]
 v_mfma_f32_16x16x32_bf16 v[168:171], a[92:95], v[108:111], v[168:171]
 s_waitcnt vmcnt(13)
 v_mfma_f32_16x16x32_bf16 v[148:151], a[96:99], v[112:115], v[148:151]
 v_mfma_f32_16x16x32_bf16 v[144:147], a[96:99], v[116:119], v[144:147]
 v_mfma_f32_16x16x32_bf16 v[156:159], a[100:103], v[112:115], v[156:159]
 v_mfma_f32_16x16x32_bf16 v[152:155], a[100:103], v[116:119], v[152:155]
 v_mfma_f32_16x16x32_bf16 v[164:167], a[104:107], v[112:115], v[164:167]
 v_mfma_f32_16x16x32_bf16 v[160:163], a[104:107], v[116:119], v[160:163]
 v_mfma_f32_16x16x32_bf16 v[172:175], a[108:111], v[112:115], v[172:175]
 v_mfma_f32_16x16x32_bf16 v[168:171], a[108:111], v[116:119], v[168:171]
 s_waitcnt vmcnt(9)
 v_mfma_f32_16x16x32_bf16 v[148:151], a[112:115], v[120:123], v[148:151]
 v_mfma_f32_16x16x32_bf16 v[144:147], a[112:115], v[124:127], v[144:147]
 v_mfma_f32_16x16x32_bf16 v[156:159], a[116:119], v[120:123], v[156:159]
 v_mfma_f32_16x16x32_bf16 v[152:155], a[116:119], v[124:127], v[152:155]
 v_mfma_f32_16x16x32_bf16 v[164:167], a[120:123], v[120:123], v[164:167]
 v_mfma_f32_16x16x32_bf16 v[160:163], a[120:123], v[124:127], v[160:163]
 v_mfma_f32_16x16x32_bf16 v[172:175], a[124:127], v[120:123], v[172:175]
 v_mfma_f32_16x16x32_bf16 v[168:171], a[124:127], v[124:127], v[168:171]
 s_waitcnt vmcnt(5)
 v_mfma_f32_16x16x32_bf16 v[144:147], v[48:51], v[136:139], v[144:147]
 v_mfma_f32_16x16x32_bf16 v[148:151], v[48:51], v[140:143], v[148:151]
 v_mfma_f32_16x16x32_bf16 v[152:155], v[52:55], v[136:139], v[152:155]
 v_mfma_f32_16x16x32_bf16 v[156:159], v[52:55], v[140:143], v[156:159]
 v_mfma_f32_16x16x32_bf16 v[160:163], v[56:59], v[136:139], v[160:163]
 v_mfma_f32_16x16x32_bf16 v[164:167], v[56:59], v[140:143], v[164:167]
 v_mfma_f32_16x16x32_bf16 v[168:171], v[60:63], v[136:139], v[168:171]
 v_mfma_f32_16x16x32_bf16 v[172:175], v[60:63], v[140:143], v[172:175]
 s_waitcnt vmcnt(0)
pvy_273:
 v_sub_f32 v25, 1.0, v24
 v_cvt_pk_bf16_f32 v26, v25, v25
 v_lshlrev_b32 v25, 16, v26
 v_cvt_pk_bf16_f32 v26, v12, v12
 v_lshlrev_b32 v12, 16, v26
 v_cvt_pk_bf16_f32 v26, v13, v13
 v_lshlrev_b32 v13, 16, v26
 v_cvt_pk_bf16_f32 v26, v14, v14
 v_lshlrev_b32 v14, 16, v26
 v_cvt_pk_bf16_f32 v26, v15, v15
 v_lshlrev_b32 v15, 16, v26
 v_cvt_pk_bf16_f32 v26, v16, v16
 v_lshlrev_b32 v16, 16, v26
 v_cvt_pk_bf16_f32 v26, v17, v17
 v_lshlrev_b32 v17, 16, v26
 v_cvt_pk_bf16_f32 v26, v18, v18
 v_lshlrev_b32 v18, 16, v26
 v_cvt_pk_bf16_f32 v26, v19, v19
 v_lshlrev_b32 v19, 16, v26
 v_mul_f32 v12, v12, v25
 v_cvt_pk_bf16_f32 v26, v12, v12
 v_lshlrev_b32 v12, 16, v26
 v_mul_f32 v13, v13, v25
 v_cvt_pk_bf16_f32 v26, v13, v13
 v_lshlrev_b32 v13, 16, v26
 v_mul_f32 v14, v14, v25
 v_cvt_pk_bf16_f32 v26, v14, v14
 v_lshlrev_b32 v14, 16, v26
 v_mul_f32 v15, v15, v25
 v_cvt_pk_bf16_f32 v26, v15, v15
 v_lshlrev_b32 v15, 16, v26
 v_mul_f32 v16, v16, v25
 v_cvt_pk_bf16_f32 v26, v16, v16
 v_lshlrev_b32 v16, 16, v26
 v_mul_f32 v17, v17, v25
 v_cvt_pk_bf16_f32 v26, v17, v17
 v_lshlrev_b32 v17, 16, v26
 v_mul_f32 v18, v18, v25
 v_cvt_pk_bf16_f32 v26, v18, v18
 v_lshlrev_b32 v18, 16, v26
 v_mul_f32 v19, v19, v25
 v_cvt_pk_bf16_f32 v26, v19, v19
 v_lshlrev_b32 v19, 16, v26
 ds_write_b128 v10, v[144:147] offset:0
 ds_write_b128 v10, v[148:151] offset:1024
 ds_write_b128 v10, v[152:155] offset:2048
 ds_write_b128 v10, v[156:159] offset:3072
 ds_write_b128 v10, v[160:163] offset:4096
 ds_write_b128 v10, v[164:167] offset:5120
 ds_write_b128 v10, v[168:171] offset:6144
 ds_write_b128 v10, v[172:175] offset:7168
 s_waitcnt lgkmcnt(0)
 s_barrier
 ds_read_b128 v[176:179], v11 offset:0
 ds_read_b128 v[180:183], v11 offset:8192
 ds_read_b128 v[184:187], v11 offset:16384
 ds_read_b128 v[188:191], v11 offset:24576
 ds_read_b128 v[192:195], v11 offset:4096
 ds_read_b128 v[196:199], v11 offset:12288
 ds_read_b128 v[200:203], v11 offset:20480
 ds_read_b128 v[204:207], v11 offset:28672
 s_cmp_ge_u32 s40, 32
 s_cbranch_scc1 pvr_274
 s_waitcnt lgkmcnt(4)
 v_pk_add_f32 v[176:177], v[176:177], v[180:181]
 v_pk_add_f32 v[184:185], v[184:185], v[188:189]
 v_pk_add_f32 v[178:179], v[178:179], v[182:183]
 v_pk_add_f32 v[186:187], v[186:187], v[190:191]
 v_pk_add_f32 v[176:177], v[176:177], v[184:185]
 v_pk_add_f32 v[178:179], v[178:179], v[186:187]
 buffer_store_dwordx4 v[176:179], v4, s[24:27], s54 offen offset:0 sc1
 s_waitcnt lgkmcnt(0)
 v_pk_add_f32 v[192:193], v[192:193], v[196:197]
 v_pk_add_f32 v[200:201], v[200:201], v[204:205]
 v_pk_add_f32 v[194:195], v[194:195], v[198:199]
 v_pk_add_f32 v[202:203], v[202:203], v[206:207]
 v_pk_add_f32 v[192:193], v[192:193], v[200:201]
 v_pk_add_f32 v[194:195], v[194:195], v[202:203]
 buffer_store_dwordx4 v[192:195], v4, s[24:27], s54 offen offset:2048 sc1
 s_lshr_b32 s71, s40, 2
 s_lshl_b32 s71, s71, 7
 s_add_u32 s71, s71, 115712
 s_branch pvr_275
pvr_274:
 s_waitcnt lgkmcnt(4)
 v_pk_add_f32 v[176:177], v[176:177], v[180:181]
 v_pk_add_f32 v[184:185], v[184:185], v[188:189]
 v_pk_add_f32 v[178:179], v[178:179], v[182:183]
 v_pk_add_f32 v[186:187], v[186:187], v[190:191]
 v_pk_add_f32 v[176:177], v[176:177], v[184:185]
 v_pk_add_f32 v[178:179], v[178:179], v[186:187]
 v_cvt_pk_bf16_f32 v26, v176, v177
 v_lshlrev_b32 v176, 16, v26
 v_and_b32 v177, 0xffff0000, v26
 v_mul_f32 v176, v176, v24
 v_mul_f32 v177, v177, v24
 v_cvt_pk_bf16_f32 v26, v176, v177
 v_lshlrev_b32 v176, 16, v26
 v_and_b32 v177, 0xffff0000, v26
 v_add_f32 v176, v176, v12
 v_add_f32 v177, v177, v13
 v_cvt_pk_bf16_f32 v180, v176, v177
 v_cvt_pk_bf16_f32 v26, v178, v179
 v_lshlrev_b32 v178, 16, v26
 v_and_b32 v179, 0xffff0000, v26
 v_mul_f32 v178, v178, v24
 v_mul_f32 v179, v179, v24
 v_cvt_pk_bf16_f32 v26, v178, v179
 v_lshlrev_b32 v178, 16, v26
 v_and_b32 v179, 0xffff0000, v26
 v_add_f32 v178, v178, v14
 v_add_f32 v179, v179, v15
 v_cvt_pk_bf16_f32 v181, v178, v179
 buffer_store_dwordx2 v[180:181], v9, s[8:11], s46 offen offset:0
 s_waitcnt lgkmcnt(0)
 v_pk_add_f32 v[192:193], v[192:193], v[196:197]
 v_pk_add_f32 v[200:201], v[200:201], v[204:205]
 v_pk_add_f32 v[194:195], v[194:195], v[198:199]
 v_pk_add_f32 v[202:203], v[202:203], v[206:207]
 v_pk_add_f32 v[192:193], v[192:193], v[200:201]
 v_pk_add_f32 v[194:195], v[194:195], v[202:203]
 v_cvt_pk_bf16_f32 v26, v192, v193
 v_lshlrev_b32 v192, 16, v26
 v_and_b32 v193, 0xffff0000, v26
 v_mul_f32 v192, v192, v24
 v_mul_f32 v193, v193, v24
 v_cvt_pk_bf16_f32 v26, v192, v193
 v_lshlrev_b32 v192, 16, v26
 v_and_b32 v193, 0xffff0000, v26
 v_add_f32 v192, v192, v16
 v_add_f32 v193, v193, v17
 v_cvt_pk_bf16_f32 v196, v192, v193
 v_cvt_pk_bf16_f32 v26, v194, v195
 v_lshlrev_b32 v194, 16, v26
 v_and_b32 v195, 0xffff0000, v26
 v_mul_f32 v194, v194, v24
 v_mul_f32 v195, v195, v24
 v_cvt_pk_bf16_f32 v26, v194, v195
 v_lshlrev_b32 v194, 16, v26
 v_and_b32 v195, 0xffff0000, v26
 v_add_f32 v194, v194, v18
 v_add_f32 v195, v195, v19
 v_cvt_pk_bf16_f32 v197, v194, v195
 buffer_store_dwordx2 v[196:197], v9, s[8:11], s46 offen offset:64
pvr_275:
 s_branch pvy_270
pvy_271:
 s_sub_u32 s21, s2, 0
 s_cmp_ge_u32 s21, 640
 s_cbranch_scc1 lc_276
 s_cmp_lg_u32 s20, 0
 s_cbranch_scc1 lc_276x
 s_waitcnt vmcnt(2)
 s_mov_b64 exec, 1
 ds_write_b32 v30, v29 offset:12
 s_mov_b64 exec, -1
lc_276x:
 s_waitcnt lgkmcnt(0)
 s_barrier
 ds_read_b32 v23, v30 offset:12
lc_276:
 s_waitcnt lgkmcnt(0)
 v_readfirstlane_b32 s2, v23
 v_readfirstlane_b32 s67, v213
 s_barrier
 s_cmp_lt_u32 s2, 236
 s_cbranch_scc1 pae_277
 s_waitcnt vmcnt(0)
 s_cmp_eq_u32 s71, 0
 s_cbranch_scc1 paf_278
 v_mov_b32 v25, 0
 v_mov_b32 v26, 1
 s_mov_b64 exec, 1
 buffer_atomic_add v26, v25, s[72:75], s71 offen sc1
 s_mov_b64 exec, -1
 s_mov_b32 s71, 0
paf_278:
pae_277:
 s_add_u32 s21, s2, 0
 s_cmp_lt_u32 s2, 164
 s_cbranch_scc1 pv_loop
 s_sub_u32 s2, s2, 164
 s_add_u32 s21, s2, 204
 s_cmp_lt_u32 s2, 32
 s_cbranch_scc1 pv_loop
 s_sub_u32 s2, s2, 32
 s_add_u32 s21, s2, 164
 s_cmp_lt_u32 s2, 40
 s_cbranch_scc1 pv_loop
 s_sub_u32 s2, s2, 40
 s_branch main_fin
 s_branch queue
main_fin:
 s_waitcnt vmcnt(0)
main_end:
 s_endpgm
code_end:
.section .rodata,"a"
.p2align 6
.amdhsa_kernel gated_mix__memory_aug_recurrent_mem_tr__sliding_local_dilated__prompt_kernel
  .amdhsa_next_free_vgpr 512
  .amdhsa_next_free_sgpr 102
  .amdhsa_accum_offset 256
  .amdhsa_group_segment_fixed_size 0
  .amdhsa_kernarg_size 112
  .amdhsa_user_sgpr_count 2
  .amdhsa_user_sgpr_kernarg_segment_ptr 1
  .amdhsa_system_sgpr_workgroup_id_x 1
.end_amdhsa_kernel
.text
```

```asm
; @launch kernel=gated_mix__memory_aug_recurrent_mem_tr__sliding_local_dilated__prompt_kernel grid=(256,1,1) block=(256,1,1) lds=163840
.amdgcn_target "amdgcn-amd-amdhsa--gfx950"
.text
.globl gated_mix__memory_aug_recurrent_mem_tr__sliding_local_dilated__prompt_kernel
.p2align 8
.type gated_mix__memory_aug_recurrent_mem_tr__sliding_local_dilated__prompt_kernel,@function
gated_mix__memory_aug_recurrent_mem_tr__sliding_local_dilated__prompt_kernel:
 s_cmp_ge_u32 s2, 256
 s_cbranch_scc1 end0
 s_load_dwordx2 s[4:5], s[0:1], 96
 s_load_dwordx2 s[38:39], s[0:1], 104
 v_lshrrev_b32 v1, 6, v0
 v_and_b32 v2, 15, v0
 v_readfirstlane_b32 s20, v1
 v_and_b32 v1, 63, v0
 v_lshrrev_b32 v3, 4, v1
 s_getreg_b32 s50, hwreg(HW_REG_XCC_ID)
 s_and_b32 s50, s50, 7
 s_waitcnt lgkmcnt(0)
 s_mov_b32 s32, s4
 s_mov_b32 s33, s5
 s_mov_b32 s34, 256
 s_mov_b32 s35, 0x00020000
 s_getpc_b64 s[6:7]
cpf_pc:
 s_sub_u32 s6, s6, cpf_pc - gated_mix__memory_aug_recurrent_mem_tr__sliding_local_dilated__prompt_kernel
 s_subb_u32 s7, s7, 0
 s_lshr_b32 s21, s2, 3
 s_lshl_b32 s21, s21, 12
 v_lshl_add_u32 v28, v0, 4, s21
 v_min_u32 v28, code_end - gated_mix__memory_aug_recurrent_mem_tr__sliding_local_dilated__prompt_kernel - 16, v28
 global_load_dwordx4 a[252:255], v28, s[6:7]
 v_lshl_add_u32 v28, v0, 4, s21
 v_add_u32 v28, 0x20000, v28
 v_min_u32 v28, code_end - gated_mix__memory_aug_recurrent_mem_tr__sliding_local_dilated__prompt_kernel - 16, v28
 global_load_dwordx4 a[252:255], v28, s[6:7]
 v_mov_b32 v21, 0
 s_cmp_lg_u32 s20, 0
 s_cbranch_scc1 rk_1
 s_and_b32 s21, s50, 1
 s_lshl_b32 s21, s21, 7
 s_lshl_b32 s22, s50, 1
 s_and_b32 s22, s22, 12
 s_add_u32 s21, s21, s22
 v_mov_b32 v22, s21
 v_mov_b32 v23, 1
 s_mov_b64 exec, 1
 buffer_atomic_add v23, v22, s[32:35], 0 offen sc0 sc1
 s_waitcnt vmcnt(0)
 v_readfirstlane_b32 s51, v23
 s_lshl_b32 s22, s50, 5
 s_add_u32 s22, s22, s51
 s_cmp_lt_u32 s51, 32
 s_cbranch_scc1 rk_2
 v_mov_b32 v24, 72
 v_mov_b32 v25, 1
 buffer_atomic_add v25, v24, s[32:35], 0 offen sc0 sc1
 s_waitcnt vmcnt(0)
 v_readfirstlane_b32 s23, v25
 s_mov_b32 s101, 0
 s_mov_b64 exec, -1
 v_lshlrev_b32 v24, 2, v1
rk_3:
 s_sleep 8
 buffer_load_dword v25, v24, s[32:35], 0 offen sc1
 s_add_u32 s101, s101, 1
 s_cmp_gt_u32 s101, 131072
 s_cbranch_scc1 end0
 s_waitcnt vmcnt(0)
 v_readlane_b32 s21, v25, 0
 v_readlane_b32 s22, v25, 32
 s_add_u32 s21, s21, s22
 v_readlane_b32 s22, v25, 1
 s_add_u32 s21, s21, s22
 v_readlane_b32 s22, v25, 33
 s_add_u32 s21, s21, s22
 v_readlane_b32 s22, v25, 2
 s_add_u32 s21, s21, s22
 v_readlane_b32 s22, v25, 34
 s_add_u32 s21, s21, s22
 v_readlane_b32 s22, v25, 3
 s_add_u32 s21, s21, s22
 v_readlane_b32 s22, v25, 35
 s_add_u32 s21, s21, s22
 s_cmp_lt_u32 s21, 256
 s_cbranch_scc1 rk_3
 s_mov_b64 exec, 1
 s_mov_b32 s24, 0
rk_5:
 s_and_b32 s21, s24, 1
 s_lshl_b32 s21, s21, 5
 s_lshr_b32 s22, s24, 1
 s_add_u32 s21, s21, s22
 v_readlane_b32 s21, v25, s21
 s_min_u32 s21, s21, 32
 s_sub_u32 s25, 32, s21
 s_cmp_lt_u32 s23, s25
 s_cbranch_scc1 rk_4
 s_sub_u32 s23, s23, s25
 s_add_u32 s24, s24, 1
 s_cmp_lt_u32 s24, 8
 s_cbranch_scc1 rk_5
 s_branch end0
rk_4:
 s_lshl_b32 s22, s24, 5
 s_add_u32 s22, s22, s21
 s_add_u32 s22, s22, s23
 s_or_b32 s22, s22, 0x100
rk_2:
 v_mov_b32 v23, s22
 ds_write_b32 v21, v23
 s_waitcnt lgkmcnt(0)
 s_mov_b64 exec, -1
rk_1:
 s_barrier
 ds_read_b32 v23, v21
 s_waitcnt lgkmcnt(0)
 v_readfirstlane_b32 s22, v23
 s_barrier
 s_mov_b32 s84, 0
 s_mov_b32 s85, -1
 s_lshr_b32 s53, s22, 8
 s_and_b32 s22, s22, 255
 s_cmp_ge_u32 s22, 128
 s_cbranch_scc1 gemm_side
 s_lshr_b32 s50, s22, 4
 s_and_b32 s51, s22, 15
 s_mov_b32 s86, 0x3dd53b95
 s_load_dwordx2 s[4:5], s[0:1], 8
 s_load_dwordx4 s[36:39], s[0:1], 16
 s_load_dwordx4 s[40:43], s[0:1], 32
 s_load_dwordx2 s[44:45], s[0:1], 104
 s_lshr_b32 s55, s51, 2
 s_and_b32 s56, s51, 3
 s_lshl_b32 s57, s50, 2
 s_add_u32 s58, s57, s55
 s_add_u32 s59, s57, s20
 s_lshr_b32 s21, s51, 1
 s_xor_b32 s21, s21, s55
 s_andn2_b32 s21, 1, s21
 s_xor_b32 s85, s51, s21
 s_mul_i32 s87, s85, 5
 s_lshr_b32 s87, s87, 1
 s_and_b32 s79, s85, 1
 s_waitcnt lgkmcnt(0)
 s_add_u32 s8, s44, 78643200
 s_addc_u32 s9, s45, 0
 s_mov_b32 s10, 2162688
 s_mov_b32 s11, 0x00020000
 s_mov_b32 s16, s44
 s_mov_b32 s17, s45
 s_mov_b32 s18, 50331648
 s_mov_b32 s19, 0x00020000
 s_add_u32 s24, s44, 50331648
 s_addc_u32 s25, s45, 0
 s_mov_b32 s26, 72351744
 s_mov_b32 s27, 0x00020000
 s_mov_b32 s28, s4
 s_mov_b32 s29, s5
 s_mov_b32 s30, 10240
 s_mov_b32 s31, 0x00020000
 s_add_u32 s4, s44, 83886079
 s_addc_u32 s5, s45, 0
 s_and_b32 s4, s4, 0xffe00000
 s_mov_b32 s6, 2097152
 s_mov_b32 s7, 0x00020000
 v_mov_b32 v27, 10923
 v_add_u32 v54, 0, v1
 v_mul_u32_u24 v53, v54, v27
 v_lshrrev_b32 v53, 16, v53
 v_mul_u32_u24 v52, 6, v53
 v_sub_u32 v54, v54, v52
 v_mul_u32_u24 v52, 1280, v53
 v_lshl_add_u32 v46, v54, 4, v52
 v_bfe_u32 v52, v53, 1, 1
 v_mul_u32_u24 v52, 20, v52
 v_and_b32 v51, 1, v53
 v_add_u32 v52, v52, v51
 v_lshrrev_b32 v51, 3, v53
 v_mul_u32_u24 v51, 40, v51
 v_bfe_u32 v50, v53, 2, 1
 v_lshl_add_u32 v51, v50, 1, v51
 v_add_u32 v51, v51, v52
 v_mul_u32_u24 v51, 12288, v51
 v_lshl_add_u32 v247, v54, 4, v51
 v_lshrrev_b32 v51, 4, v53
 v_mul_u32_u24 v51, 40, v51
 v_bfe_u32 v50, v53, 2, 2
 v_lshl_add_u32 v51, v50, 1, v51
 v_add_u32 v51, v51, v52
 v_mul_u32_u24 v51, 12288, v51
 v_lshl_add_u32 v244, v54, 4, v51
 v_add_u32 v54, 64, v1
 v_mul_u32_u24 v53, v54, v27
 v_lshrrev_b32 v53, 16, v53
 v_mul_u32_u24 v52, 6, v53
 v_sub_u32 v54, v54, v52
 v_mul_u32_u24 v52, 1280, v53
 v_lshl_add_u32 v47, v54, 4, v52
 v_bfe_u32 v52, v53, 1, 1
 v_mul_u32_u24 v52, 20, v52
 v_and_b32 v51, 1, v53
 v_add_u32 v52, v52, v51
 v_lshrrev_b32 v51, 3, v53
 v_mul_u32_u24 v51, 40, v51
 v_bfe_u32 v50, v53, 2, 1
 v_lshl_add_u32 v51, v50, 1, v51
 v_add_u32 v51, v51, v52
 v_mul_u32_u24 v51, 12288, v51
 v_lshl_add_u32 v248, v54, 4, v51
 v_lshrrev_b32 v51, 4, v53
 v_mul_u32_u24 v51, 40, v51
 v_bfe_u32 v50, v53, 2, 2
 v_lshl_add_u32 v51, v50, 1, v51
 v_add_u32 v51, v51, v52
 v_mul_u32_u24 v51, 12288, v51
 v_lshl_add_u32 v245, v54, 4, v51
 v_add_u32 v54, 128, v1
 v_mul_u32_u24 v53, v54, v27
 v_lshrrev_b32 v53, 16, v53
 v_mul_u32_u24 v52, 6, v53
 v_sub_u32 v54, v54, v52
 v_mul_u32_u24 v52, 1280, v53
 v_lshl_add_u32 v48, v54, 4, v52
 v_bfe_u32 v52, v53, 1, 1
 v_mul_u32_u24 v52, 20, v52
 v_and_b32 v51, 1, v53
 v_add_u32 v52, v52, v51
 v_lshrrev_b32 v51, 3, v53
 v_mul_u32_u24 v51, 40, v51
 v_bfe_u32 v50, v53, 2, 1
 v_lshl_add_u32 v51, v50, 1, v51
 v_add_u32 v51, v51, v52
 v_mul_u32_u24 v51, 12288, v51
 v_lshl_add_u32 v249, v54, 4, v51
 v_lshrrev_b32 v51, 4, v53
 v_mul_u32_u24 v51, 40, v51
 v_bfe_u32 v50, v53, 2, 2
 v_lshl_add_u32 v51, v50, 1, v51
 v_add_u32 v51, v51, v52
 v_mul_u32_u24 v51, 12288, v51
 v_lshl_add_u32 v246, v54, 4, v51
 s_mul_i32 s80, s58, 384
 s_mul_i32 s22, s56, 96
 s_add_u32 s80, s80, s22
 s_mul_i32 s22, s20, 1966080
 s_add_u32 s80, s80, s22
 s_mul_i32 s81, s20, 40448
 s_mul_i32 s82, s59, 245760
 s_lshl_b32 s22, s87, 5
 s_add_u32 s82, s82, s22
 s_mul_i32 s88, s59, 384
 s_mov_b32 s12, s42
 s_mov_b32 s13, s43
 s_mov_b32 s14, 7864320
 s_mov_b32 s15, 0x00020000
 s_add_u32 s21, s82, 0
 s_add_u32 m0, s81, 12288
 s_nop 0
 buffer_load_dwordx4 v46, s[12:15], s21 offen lds
 s_add_u32 m0, s81, 13312
 s_nop 0
 buffer_load_dwordx4 v47, s[12:15], s21 offen lds
 s_add_u32 m0, s81, 14336
 s_nop 0
 buffer_load_dwordx4 v48, s[12:15], s21 offen lds
 s_add_u32 s21, s82, 40960
 s_add_u32 m0, s81, 15360
 s_nop 0
 buffer_load_dwordx4 v46, s[12:15], s21 offen lds
 s_add_u32 m0, s81, 16384
 s_nop 0
 buffer_load_dwordx4 v47, s[12:15], s21 offen lds
 s_add_u32 m0, s81, 17408
 s_nop 0
 buffer_load_dwordx4 v48, s[12:15], s21 offen lds
 s_add_u32 s21, s82, 81920
 s_add_u32 m0, s81, 18432
 s_nop 0
 buffer_load_dwordx4 v46, s[12:15], s21 offen lds
 s_add_u32 m0, s81, 19456
 s_nop 0
 buffer_load_dwordx4 v47, s[12:15], s21 offen lds
 s_add_u32 m0, s81, 20480
 s_nop 0
 buffer_load_dwordx4 v48, s[12:15], s21 offen lds
 s_add_u32 s21, s82, 122880
 s_add_u32 m0, s81, 21504
 s_nop 0
 buffer_load_dwordx4 v46, s[12:15], s21 offen lds
 s_add_u32 m0, s81, 22528
 s_nop 0
 buffer_load_dwordx4 v47, s[12:15], s21 offen lds
 s_add_u32 m0, s81, 23552
 s_nop 0
 buffer_load_dwordx4 v48, s[12:15], s21 offen lds
 s_add_u32 s21, s82, 163840
 s_add_u32 m0, s81, 24576
 s_nop 0
 buffer_load_dwordx4 v46, s[12:15], s21 offen lds
 s_add_u32 m0, s81, 25600
 s_nop 0
 buffer_load_dwordx4 v47, s[12:15], s21 offen lds
 s_add_u32 m0, s81, 26624
 s_nop 0
 buffer_load_dwordx4 v48, s[12:15], s21 offen lds
 s_add_u32 s21, s82, 204800
 s_add_u32 m0, s81, 27648
 s_nop 0
 buffer_load_dwordx4 v46, s[12:15], s21 offen lds
 s_add_u32 m0, s81, 28672
 s_nop 0
 buffer_load_dwordx4 v47, s[12:15], s21 offen lds
 s_add_u32 m0, s81, 29696
 s_nop 0
 buffer_load_dwordx4 v48, s[12:15], s21 offen lds
 s_mov_b32 s12, s40
 s_mov_b32 s13, s41
 s_mov_b32 s14, 7864320
 s_mov_b32 s15, 0x00020000
 s_mov_b32 s40, s38
 s_mov_b32 s41, s39
 s_mov_b32 s38, 7864320
 s_mov_b32 s39, 0x00020000
 s_mov_b32 s42, s38
 s_mov_b32 s43, s39
 v_lshrrev_b32 v250, 2, v2
 v_lshl_add_u32 v250, v3, 3, v250
 v_mul_u32_u24 v250, 96, v250
 v_and_b32 v251, 3, v2
 v_lshlrev_b32 v251, 3, v251
 v_add3_u32 v250, v250, v251, s81
 v_lshlrev_b32 v251, 4, v1
 v_add_u32 v251, s81, v251
 v_lshlrev_b32 v26, 2, v1
 v_mov_b32 v27, 2731
 v_add_u32 v54, 0, v1
 v_mul_u32_u24 v53, v54, v27
 v_lshrrev_b32 v53, 16, v53
 v_mul_u32_u24 v52, 24, v53
 v_sub_u32 v54, v54, v52
 v_bfe_u32 v52, v53, 1, 1
 v_xor_b32 v54, v54, v52
 v_mul_u32_u24 v52, 20, v52
 v_and_b32 v51, 1, v53
 v_add_u32 v52, v52, v51
 v_lshrrev_b32 v51, 2, v53
 v_lshl_add_u32 v52, v51, 1, v52
 v_mul_u32_u24 v52, 12288, v52
 v_subrev_u32 v52, 0, v52
 v_lshl_add_u32 v28, v54, 4, v52
 v_xor_b32 v31, 32, v28
 v_xor_b32 v34, 64, v28
 v_xor_b32 v37, 96, v28
 v_add_u32 v54, 64, v1
 v_mul_u32_u24 v53, v54, v27
 v_lshrrev_b32 v53, 16, v53
 v_mul_u32_u24 v52, 24, v53
 v_sub_u32 v54, v54, v52
 v_bfe_u32 v52, v53, 1, 1
 v_xor_b32 v54, v54, v52
 v_mul_u32_u24 v52, 20, v52
 v_and_b32 v51, 1, v53
 v_add_u32 v52, v52, v51
 v_lshrrev_b32 v51, 2, v53
 v_lshl_add_u32 v52, v51, 1, v52
 v_mul_u32_u24 v52, 12288, v52
 v_subrev_u32 v52, 1024, v52
 v_lshl_add_u32 v29, v54, 4, v52
 v_xor_b32 v32, 32, v29
 v_xor_b32 v35, 64, v29
 v_xor_b32 v38, 96, v29
 v_add_u32 v54, 128, v1
 v_mul_u32_u24 v53, v54, v27
 v_lshrrev_b32 v53, 16, v53
 v_mul_u32_u24 v52, 24, v53
 v_sub_u32 v54, v54, v52
 v_bfe_u32 v52, v53, 1, 1
 v_xor_b32 v54, v54, v52
 v_mul_u32_u24 v52, 20, v52
 v_and_b32 v51, 1, v53
 v_add_u32 v52, v52, v51
 v_lshrrev_b32 v51, 2, v53
 v_lshl_add_u32 v52, v51, 1, v52
 v_mul_u32_u24 v52, 12288, v52
 v_subrev_u32 v52, 2048, v52
 v_lshl_add_u32 v30, v54, 4, v52
 v_xor_b32 v33, 32, v30
 v_xor_b32 v36, 64, v30
 v_xor_b32 v39, 96, v30
 s_add_u32 m0, s81, 0
 s_add_u32 s21, s88, 0
 buffer_load_dwordx4 v28, s[12:15], s21 offen offset:0 lds
 buffer_load_dwordx4 v29, s[12:15], s21 offen offset:1024 lds
 buffer_load_dwordx4 v30, s[12:15], s21 offen offset:2048 lds
 s_add_u32 m0, s81, 3072
 s_add_u32 s21, s88, 49152
 buffer_load_dwordx4 v31, s[12:15], s21 offen offset:0 lds
 buffer_load_dwordx4 v32, s[12:15], s21 offen offset:1024 lds
 buffer_load_dwordx4 v33, s[12:15], s21 offen offset:2048 lds
 s_add_u32 m0, s81, 6144
 s_add_u32 s21, s88, 491520
 buffer_load_dwordx4 v34, s[12:15], s21 offen offset:0 lds
 buffer_load_dwordx4 v35, s[12:15], s21 offen offset:1024 lds
 buffer_load_dwordx4 v36, s[12:15], s21 offen offset:2048 lds
 s_add_u32 m0, s81, 9216
 s_add_u32 s21, s88, 540672
 buffer_load_dwordx4 v37, s[12:15], s21 offen offset:0 lds
 buffer_load_dwordx4 v38, s[12:15], s21 offen offset:1024 lds
 buffer_load_dwordx4 v39, s[12:15], s21 offen offset:2048 lds
 s_add_u32 s22, s80, 0
 buffer_load_dwordx4 v[220:223], v244, s[40:43], s22 offen
 buffer_load_dwordx4 v[224:227], v245, s[40:43], s22 offen
 buffer_load_dwordx4 v[228:231], v246, s[40:43], s22 offen
 s_add_u32 s22, s80, 983040
 buffer_load_dwordx4 v[232:235], v244, s[40:43], s22 offen
 buffer_load_dwordx4 v[236:239], v245, s[40:43], s22 offen
 buffer_load_dwordx4 v[240:243], v246, s[40:43], s22 offen
 v_and_b32 v56, 7, v2
 v_lshrrev_b32 v57, 3, v2
 v_lshlrev_b32 v16, 4, v1
 s_lshr_b32 s21, s20, 1
 s_lshl_b32 s21, s21, 14
 s_and_b32 s22, s20, 1
 s_mul_i32 s22, s22, 3072
 s_add_u32 s21, s21, s22
 v_add_u32 v4, s21, v16
 v_mov_b32 v58, 0x4444
 v_mov_b32 v59, 0xeeee
 v_cmp_eq_u32 vcc, 1, v57
 s_nop 1
 v_cndmask_b32 v25, v58, v59, vcc
 v_mul_u32_u24 v58, 40, v2
 v_lshl_add_u32 v58, v3, 3, v58
 s_mul_i32 s21, s20, 1920
 v_add_u32 v5, s21, v58
 v_lshrrev_b32 v58, 2, v1
 v_mul_u32_u24 v58, 40, v58
 v_and_b32 v59, 3, v1
 v_lshl_add_u32 v6, v59, 3, v58
 v_bfe_u32 v59, v1, 1, 1
 v_mul_u32_u24 v59, 3824, v59
 v_add_u32 v21, v6, v59
 s_lshl_b32 s21, s50, 4
 s_add_u32 s21, s21, s51
 s_lshl_b32 s21, s21, 9
 s_lshl_b32 s22, s20, 7
 s_add_u32 s21, s21, s22
 s_add_u32 s21, s21, 81920
 v_and_b32 v58, 1, v3
 v_lshlrev_b32 v58, 8, v58
 v_lshl_add_u32 v58, v56, 4, v58
 v_lshrrev_b32 v59, 1, v3
 v_lshl_add_u32 v58, v59, 3, v58
 v_add_u32 v7, s21, v58
 s_lshl_b32 s22, s58, 9
 s_lshl_b32 s23, s56, 7
 s_add_u32 s22, s22, s23
 s_add_u32 s22, s22, 376704
 v_lshlrev_b32 v58, 6, v3
 v_lshl_add_u32 v58, v56, 3, v58
 v_add_u32 v58, s22, v58
 s_cmp_eq_u32 s20, 2
 s_cselect_b64 vcc, -1, 0
 v_cndmask_b32 v7, v7, v58, vcc
 s_lshl_b32 s21, s59, 11
 s_add_u32 s21, s21, 81920
 v_add_u32 v8, s21, v16
 s_lshl_b32 s21, s59, 9
 s_add_u32 s21, s21, 376832
 v_lshl_add_u32 v9, v1, 3, s21
 s_mul_i32 s21, s20, 3072
 s_add_u32 s21, s21, 24576
 v_and_b32 v58, 0x39, v1
 v_bfe_u32 v59, v1, 1, 1
 v_lshl_or_b32 v58, v59, 2, v58
 v_bfe_u32 v59, v1, 2, 1
 v_lshl_or_b32 v58, v59, 1, v58
 v_lshl_add_u32 v10, v58, 4, s21
 s_mul_i32 s22, s56, 12
 s_cmp_eq_u32 s20, 2
 s_cselect_b64 vcc, -1, 0
 v_add_u32 v58, s22, v3
 v_add3_u32 v59, 0, v58, v3
 v_lshrrev_b32 v60, 1, v59
 v_and_b32 v59, 1, v59
 v_lshlrev_b32 v59, 3, v59
 v_lshl_add_u32 v61, v60, 7, v59
 v_lshl_add_u32 v61, v56, 4, v61
 s_mul_i32 s21, s58, 3072
 v_add_u32 v62, s21, v61
 v_lshl_add_u32 v61, v60, 8, v59
 v_lshl_add_u32 v61, v2, 4, v61
 s_mul_i32 s21, s58, 12288
 s_and_b32 s22, s20, 1
 s_mul_i32 s22, s22, 6144
 s_add_u32 s21, s21, s22
 v_add_u32 v61, s21, v61
 v_cndmask_b32 v18, v61, v62, vcc
 v_add_u32 v59, 8, v58
 v_lshrrev_b32 v60, 1, v59
 v_and_b32 v59, 1, v59
 v_lshlrev_b32 v59, 3, v59
 v_lshl_add_u32 v61, v60, 7, v59
 v_lshl_add_u32 v61, v56, 4, v61
 s_mul_i32 s21, s58, 3072
 v_add_u32 v62, s21, v61
 v_lshl_add_u32 v61, v60, 8, v59
 v_lshl_add_u32 v61, v2, 4, v61
 s_mul_i32 s21, s58, 12288
 s_and_b32 s22, s20, 1
 s_mul_i32 s22, s22, 6144
 s_add_u32 s21, s21, s22
 v_add_u32 v61, s21, v61
 v_cndmask_b32 v19, v61, v62, vcc
 s_mul_i32 s21, s20, 3072
 s_add_u32 s21, s21, 8192
 v_add_u32 v11, s21, v16
 v_and_b32 v58, 3, v1
 s_lshl_b32 s21, s20, 2
 v_add_u32 v59, s21, v58
 v_cmp_eq_u32 vcc, 10, v59
 s_nop 1
 v_cndmask_b32 v59, v59, 7, vcc
 v_cmp_eq_u32 vcc, 3, v58
 v_lshrrev_b32 v60, 5, v1
 v_mul_u32_u24 v60, 10, v60
 v_cndmask_b32 v59, v59, 3, vcc
 s_lshl_b32 s21, s79, 2
 v_add3_u32 v59, v59, v60, s21
 v_lshrrev_b32 v60, 1, v59
 v_lshlrev_b32 v60, 8, v60
 v_and_b32 v59, 1, v59
 v_lshl_add_u32 v60, v59, 3, v60
 v_bfe_u32 v59, v1, 2, 3
 v_lshl_add_u32 v60, v59, 4, v60
 v_add_u32 v12, 8192, v60
 s_mov_b32 s21, 0x07060100
 s_cmp_eq_u32 s20, 1
 s_cselect_b32 s21, 0x07060302, s21
 s_cmp_eq_u32 s20, 2
 s_cselect_b32 s21, 0x07060c0c, s21
 v_mov_b32 v59, s21
 v_mov_b32 v60, 0x03020100
 v_cndmask_b32 v14, v60, v59, vcc
 s_lshr_b32 s21, s85, 3
 s_lshl_b32 s21, s21, 14
 s_bfe_u32 s22, s85, 0x10002
 s_mul_i32 s22, s22, 3072
 s_add_u32 s21, s21, s22
 s_and_b32 s22, s85, 3
 s_lshl_b32 s22, s22, 8
 s_add_u32 s21, s21, s22
 s_lshl_b32 s22, s20, 10
 s_add_u32 s22, s22, s21
 v_lshl_add_u32 v13, v1, 2, s22
 v_lshlrev_b32 v59, 10, v3
 v_lshl_add_u32 v59, v2, 4, v59
 v_add_u32 v59, s21, v59
 s_cmp_eq_u32 s20, 3
 s_cselect_b64 vcc, -1, 0
 v_cndmask_b32 v13, v13, v59, vcc
 s_mov_b32 s91, 0x3c000000
 v_and_b32 v59, 1, v3
 v_lshrrev_b32 v60, 1, v3
 v_lshl_add_u32 v59, v59, 1, v60
 v_lshlrev_b32 v59, 8, v59
 v_lshl_add_u32 v59, v2, 4, v59
 s_mul_i32 s21, s59, 10240
 s_lshl_b32 s22, s87, 8
 s_add_u32 s21, s21, s22
 v_add_u32 v15, s21, v59
 s_lshl_b32 s21, s79, 4
 s_lshl_b32 s76, -1, s21
 s_mov_b32 s77, 0xffff
 s_lshl_b32 s21, s79, 7
 v_or_b32 v17, s21, v16
 s_or_b32 s21, s21, 0xffffff7f
 v_and_b32 v20, s21, v16
 v_lshlrev_b32 v24, 3, v1
 v_cmp_gt_u32 s[60:61], 8, v2
 v_cmp_le_u32 s[62:63], 8, v2
 v_cmp_le_u32 s[72:73], 2, v3
 v_cmp_gt_u32 s[70:71], 48, v1
 s_nop 1
 s_and_b64 s[64:65], s[60:61], s[72:73]
 s_cmp_eq_u32 s20, 2
 s_cselect_b64 s[74:75], s[64:65], s[60:61]
 s_waitcnt vmcnt(18)
 ds_read_b64_tr_b16 v[64:65], v250 offset:12288
 ds_read_b64_tr_b16 v[66:67], v250 offset:12672
 ds_read_b64_tr_b16 v[88:89], v250 offset:12320
 ds_read_b64_tr_b16 v[90:91], v250 offset:12704
 ds_read_b64_tr_b16 v[112:113], v250 offset:12352
 ds_read_b64_tr_b16 v[114:115], v250 offset:12736
 ds_read_b64_tr_b16 v[68:69], v250 offset:15360
 ds_read_b64_tr_b16 v[70:71], v250 offset:15744
 ds_read_b64_tr_b16 v[92:93], v250 offset:15392
 ds_read_b64_tr_b16 v[94:95], v250 offset:15776
 ds_read_b64_tr_b16 v[116:117], v250 offset:15424
 ds_read_b64_tr_b16 v[118:119], v250 offset:15808
 ds_read_b64_tr_b16 v[72:73], v250 offset:18432
 ds_read_b64_tr_b16 v[74:75], v250 offset:18816
 ds_read_b64_tr_b16 v[96:97], v250 offset:18464
 ds_read_b64_tr_b16 v[98:99], v250 offset:18848
 ds_read_b64_tr_b16 v[120:121], v250 offset:18496
 ds_read_b64_tr_b16 v[122:123], v250 offset:18880
 ds_read_b64_tr_b16 v[76:77], v250 offset:21504
 ds_read_b64_tr_b16 v[78:79], v250 offset:21888
 ds_read_b64_tr_b16 v[100:101], v250 offset:21536
 ds_read_b64_tr_b16 v[102:103], v250 offset:21920
 ds_read_b64_tr_b16 v[124:125], v250 offset:21568
 ds_read_b64_tr_b16 v[126:127], v250 offset:21952
 ds_read_b64_tr_b16 v[80:81], v250 offset:24576
 ds_read_b64_tr_b16 v[82:83], v250 offset:24960
 ds_read_b64_tr_b16 v[104:105], v250 offset:24608
 ds_read_b64_tr_b16 v[106:107], v250 offset:24992
 ds_read_b64_tr_b16 v[128:129], v250 offset:24640
 ds_read_b64_tr_b16 v[130:131], v250 offset:25024
 ds_read_b64_tr_b16 v[84:85], v250 offset:27648
 ds_read_b64_tr_b16 v[86:87], v250 offset:28032
 ds_read_b64_tr_b16 v[108:109], v250 offset:27680
 ds_read_b64_tr_b16 v[110:111], v250 offset:28064
 ds_read_b64_tr_b16 v[132:133], v250 offset:27712
 ds_read_b64_tr_b16 v[134:135], v250 offset:28096
 s_waitcnt lgkmcnt(0)
 s_add_u32 m0, s81, 12288
 s_add_u32 s21, s88, 983040
 buffer_load_dwordx4 v28, s[12:15], s21 offen offset:0 lds
 buffer_load_dwordx4 v29, s[12:15], s21 offen offset:1024 lds
 buffer_load_dwordx4 v30, s[12:15], s21 offen offset:2048 lds
 s_add_u32 m0, s81, 15360
 s_add_u32 s21, s88, 1032192
 buffer_load_dwordx4 v31, s[12:15], s21 offen offset:0 lds
 buffer_load_dwordx4 v32, s[12:15], s21 offen offset:1024 lds
 buffer_load_dwordx4 v33, s[12:15], s21 offen offset:2048 lds
 s_add_u32 m0, s81, 18432
 s_add_u32 s21, s88, 1474560
 buffer_load_dwordx4 v34, s[12:15], s21 offen offset:0 lds
 buffer_load_dwordx4 v35, s[12:15], s21 offen offset:1024 lds
 buffer_load_dwordx4 v36, s[12:15], s21 offen offset:2048 lds
 s_add_u32 m0, s81, 21504
 s_add_u32 s21, s88, 1523712
 buffer_load_dwordx4 v37, s[12:15], s21 offen offset:0 lds
 buffer_load_dwordx4 v38, s[12:15], s21 offen offset:1024 lds
 buffer_load_dwordx4 v39, s[12:15], s21 offen offset:2048 lds
 s_add_u32 m0, s81, 24576
 s_add_u32 s21, s88, 98304
 buffer_load_dwordx4 v28, s[12:15], s21 offen offset:0 lds
 buffer_load_dwordx4 v29, s[12:15], s21 offen offset:1024 lds
 buffer_load_dwordx4 v30, s[12:15], s21 offen offset:2048 lds
 s_add_u32 m0, s81, 27648
 s_add_u32 s21, s88, 147456
 buffer_load_dwordx4 v31, s[12:15], s21 offen offset:0 lds
 buffer_load_dwordx4 v32, s[12:15], s21 offen offset:1024 lds
 buffer_load_dwordx4 v33, s[12:15], s21 offen offset:2048 lds
 s_add_u32 m0, s81, 30720
 s_add_u32 s21, s88, 589824
 buffer_load_dwordx4 v34, s[12:15], s21 offen offset:0 lds
 buffer_load_dwordx4 v35, s[12:15], s21 offen offset:1024 lds
 buffer_load_dwordx4 v36, s[12:15], s21 offen offset:2048 lds
 s_add_u32 m0, s81, 33792
 s_add_u32 s21, s88, 638976
 buffer_load_dwordx4 v37, s[12:15], s21 offen offset:0 lds
 buffer_load_dwordx4 v38, s[12:15], s21 offen offset:1024 lds
 buffer_load_dwordx4 v39, s[12:15], s21 offen offset:2048 lds
 v_lshrrev_b32 v40, 2, v2
 v_and_b32 v41, 3, v2
 v_lshl_add_u32 v41, v40, 3, v41
 v_mul_u32_u24 v41, 384, v41
 v_add_u32 v41, s81, v41
 v_lshrrev_b32 v40, 1, v2
 v_xor_b32 v40, v40, v3
 v_lshl_add_u32 v22, v40, 4, v41
 v_xor_b32 v40, 4, v40
 v_lshl_add_u32 v23, v40, 4, v41
 s_mul_i32 s64, s59, 40960
 s_lshl_b32 s21, s87, 10
 s_add_u32 s64, s64, s21
 s_add_u32 s64, s64, 1310720
 s_lshl_b32 s79, s59, 7
 s_and_b32 s21, s51, 12
 s_lshl_b32 s21, s21, 10
 s_add_u32 s79, s79, s21
 s_add_u32 s79, s79, 94208
 s_lshl_b32 s90, s58, 7
 s_add_u32 s90, s90, 18432
 s_cmp_eq_u32 s56, 0
 s_cselect_b32 s66, s90, 0x80000000
 s_bfe_u32 s82, s50, 0x10001
 s_lshl_b32 s82, s82, 5
 s_lshr_b32 s21, s50, 2
 s_add_u32 s82, s82, s21
 s_and_b32 s83, s50, 1
 s_lshl_b32 s83, s83, 4
 s_add_u32 s83, s83, 16
 s_waitcnt vmcnt(30)
 ds_read_b128 v[136:139], v22 offset:0
 ds_read_b128 v[140:143], v23 offset:0
 ds_read_b128 v[144:147], v22 offset:128
 s_waitcnt lgkmcnt(2)
 v_mfma_f32_16x16x32_bf16 v[40:43], v[136:139], v[64:67], 0
 ds_read_b128 v[148:151], v23 offset:128
 s_waitcnt vmcnt(27)
 ds_write_b128 v251, v[220:223] offset:36864
 v_mfma_f32_16x16x32_bf16 v[48:51], v[136:139], v[88:91], 0
 ds_write_b128 v251, v[224:227] offset:37888
 ds_write_b128 v251, v[228:231] offset:38912
 ds_read_b64_tr_b16 v[208:209], v250 offset:36864
 v_mfma_f32_16x16x32_bf16 v[56:59], v[136:139], v[112:115], 0
 ds_read_b64_tr_b16 v[210:211], v250 offset:37248
 ds_read_b64_tr_b16 v[212:213], v250 offset:36896
 ds_read_b64_tr_b16 v[214:215], v250 offset:37280
 ds_read_b64_tr_b16 v[216:217], v250 offset:36928
 s_waitcnt lgkmcnt(10)
 v_mfma_f32_16x16x32_bf16 v[40:43], v[140:143], v[68:71], v[40:43]
 ds_read_b128 v[136:139], v22 offset:256
 ds_read_b64_tr_b16 v[218:219], v250 offset:37312
 s_add_u32 s22, s80, 98304
 buffer_load_dwordx4 v[220:223], v244, s[40:43], s22 offen
 v_mfma_f32_16x16x32_bf16 v[48:51], v[140:143], v[92:95], v[48:51]
 buffer_load_dwordx4 v[224:227], v245, s[40:43], s22 offen
 buffer_load_dwordx4 v[228:231], v246, s[40:43], s22 offen
 v_mfma_f32_16x16x32_bf16 v[56:59], v[140:143], v[116:119], v[56:59]
 s_waitcnt lgkmcnt(11)
 v_mfma_f32_16x16x32_bf16 v[40:43], v[144:147], v[72:75], v[40:43]
 ds_read_b128 v[140:143], v23 offset:256
 v_mfma_f32_16x16x32_bf16 v[48:51], v[144:147], v[96:99], v[48:51]
 v_mfma_f32_16x16x32_bf16 v[56:59], v[144:147], v[120:123], v[56:59]
 s_waitcnt lgkmcnt(11)
 v_mfma_f32_16x16x32_bf16 v[40:43], v[148:151], v[76:79], v[40:43]
 ds_read_b128 v[144:147], v22 offset:1536
 v_mfma_f32_16x16x32_bf16 v[48:51], v[148:151], v[100:103], v[48:51]
 s_waitcnt lgkmcnt(2)
 v_lshlrev_b32 v27, 16, v208
 v_and_b32 v208, 0xffff0000, v208
 v_cvt_pk_f16_f32 v208, v27, v208
 v_accvgpr_write_b32 a60, v208
 v_mfma_f32_16x16x32_bf16 v[56:59], v[148:151], v[124:127], v[56:59]
 v_lshlrev_b32 v27, 16, v209
 v_and_b32 v209, 0xffff0000, v209
 v_cvt_pk_f16_f32 v209, v27, v209
 v_accvgpr_write_b32 a61, v209
 s_waitcnt lgkmcnt(3)
 v_mfma_f32_16x16x32_bf16 v[40:43], v[136:139], v[80:83], v[40:43]
 ds_read_b128 v[148:151], v23 offset:1536
 v_lshlrev_b32 v27, 16, v210
 v_and_b32 v210, 0xffff0000, v210
 v_cvt_pk_f16_f32 v210, v27, v210
 v_accvgpr_write_b32 a62, v210
 v_mfma_f32_16x16x32_bf16 v[48:51], v[136:139], v[104:107], v[48:51]
 v_lshlrev_b32 v27, 16, v211
 v_and_b32 v211, 0xffff0000, v211
 v_cvt_pk_f16_f32 v211, v27, v211
 v_accvgpr_write_b32 a63, v211
 v_lshlrev_b32 v27, 16, v212
 v_mfma_f32_16x16x32_bf16 v[56:59], v[136:139], v[128:131], v[56:59]
 v_and_b32 v212, 0xffff0000, v212
 v_cvt_pk_f16_f32 v212, v27, v212
 v_accvgpr_write_b32 a80, v212
 v_lshlrev_b32 v27, 16, v213
 s_waitcnt lgkmcnt(2)
 v_mfma_f32_16x16x32_bf16 v[40:43], v[140:143], v[84:87], v[40:43]
 ds_read_b128 v[136:139], v22 offset:1664
 v_and_b32 v213, 0xffff0000, v213
 v_cvt_pk_f16_f32 v213, v27, v213
 v_accvgpr_write_b32 a81, v213
 v_lshlrev_b32 v27, 16, v214
 v_mfma_f32_16x16x32_bf16 v[48:51], v[140:143], v[108:111], v[48:51]
 v_and_b32 v214, 0xffff0000, v214
 v_cvt_pk_f16_f32 v214, v27, v214
 v_accvgpr_write_b32 a82, v214
 v_lshlrev_b32 v27, 16, v215
 v_and_b32 v215, 0xffff0000, v215
 v_mfma_f32_16x16x32_bf16 v[56:59], v[140:143], v[132:135], v[56:59]
 v_cvt_pk_f16_f32 v215, v27, v215
 v_accvgpr_write_b32 a83, v215
 v_lshlrev_b32 v27, 16, v216
 v_and_b32 v216, 0xffff0000, v216
 s_waitcnt lgkmcnt(2)
 v_mfma_f32_16x16x32_bf16 v[44:47], v[144:147], v[64:67], 0
 ds_read_b128 v[140:143], v23 offset:1664
 v_cvt_pk_f16_f32 v216, v27, v216
 v_accvgpr_write_b32 a100, v216
 v_lshlrev_b32 v27, 16, v217
 v_and_b32 v217, 0xffff0000, v217
 v_mfma_f32_16x16x32_bf16 v[52:55], v[144:147], v[88:91], 0
 v_cvt_pk_f16_f32 v217, v27, v217
 v_accvgpr_write_b32 a101, v217
 v_lshlrev_b32 v27, 16, v218
 v_and_b32 v218, 0xffff0000, v218
 v_cvt_pk_f16_f32 v218, v27, v218
 v_mfma_f32_16x16x32_bf16 v[60:63], v[144:147], v[112:115], 0
 v_accvgpr_write_b32 a102, v218
 v_lshlrev_b32 v27, 16, v219
 v_and_b32 v219, 0xffff0000, v219
 v_cvt_pk_f16_f32 v219, v27, v219
 s_waitcnt lgkmcnt(2)
 v_mfma_f32_16x16x32_bf16 v[44:47], v[148:151], v[68:71], v[44:47]
 ds_read_b128 v[144:147], v22 offset:1792
 v_cvt_pk_f16_f32 v40, v40, v41
 v_accvgpr_write_b32 a103, v219
 v_accvgpr_write_b32 a120, v40
 v_cvt_pk_f16_f32 v42, v42, v43
 v_mfma_f32_16x16x32_bf16 v[52:55], v[148:151], v[92:95], v[52:55]
 v_accvgpr_write_b32 a121, v42
 v_cvt_pk_f16_f32 v48, v48, v49
 v_accvgpr_write_b32 a128, v48
 v_cvt_pk_f16_f32 v50, v50, v51
 v_accvgpr_write_b32 a129, v50
 v_mfma_f32_16x16x32_bf16 v[60:63], v[148:151], v[116:119], v[60:63]
 v_cvt_pk_f16_f32 v56, v56, v57
 v_accvgpr_write_b32 a136, v56
 v_cvt_pk_f16_f32 v58, v58, v59
 v_accvgpr_write_b32 a137, v58
 s_waitcnt lgkmcnt(2)
 v_mfma_f32_16x16x32_bf16 v[44:47], v[136:139], v[72:75], v[44:47]
 ds_read_b128 v[148:151], v23 offset:1792
 v_mfma_f32_16x16x32_bf16 v[52:55], v[136:139], v[96:99], v[52:55]
 v_mfma_f32_16x16x32_bf16 v[60:63], v[136:139], v[120:123], v[60:63]
 s_waitcnt lgkmcnt(2)
 v_mfma_f32_16x16x32_bf16 v[44:47], v[140:143], v[76:79], v[44:47]
 s_waitcnt vmcnt(15)
 ds_read_b128 v[136:139], v22 offset:12288
 v_mfma_f32_16x16x32_bf16 v[52:55], v[140:143], v[100:103], v[52:55]
 v_mfma_f32_16x16x32_bf16 v[60:63], v[140:143], v[124:127], v[60:63]
 s_waitcnt lgkmcnt(2)
 v_mfma_f32_16x16x32_bf16 v[44:47], v[144:147], v[80:83], v[44:47]
 ds_read_b128 v[140:143], v23 offset:12288
 v_mfma_f32_16x16x32_bf16 v[52:55], v[144:147], v[104:107], v[52:55]
 v_mfma_f32_16x16x32_bf16 v[60:63], v[144:147], v[128:131], v[60:63]
 s_waitcnt lgkmcnt(2)
 v_mfma_f32_16x16x32_bf16 v[44:47], v[148:151], v[84:87], v[44:47]
 ds_read_b128 v[144:147], v22 offset:12416
 s_add_u32 m0, s81, 0
 s_add_u32 s21, s88, 1081344
 v_mfma_f32_16x16x32_bf16 v[52:55], v[148:151], v[108:111], v[52:55]
 buffer_load_dwordx4 v28, s[12:15], s21 offen offset:0 lds
 v_mfma_f32_16x16x32_bf16 v[60:63], v[148:151], v[132:135], v[60:63]
 buffer_load_dwordx4 v29, s[12:15], s21 offen offset:1024 lds
 s_waitcnt lgkmcnt(2)
 v_mfma_f32_16x16x32_bf16 v[40:43], v[136:139], v[64:67], 0
 ds_read_b128 v[148:151], v23 offset:12416
 buffer_load_dwordx4 v30, s[12:15], s21 offen offset:2048 lds
 s_waitcnt vmcnt(30)
 v_mfma_f32_16x16x32_bf16 v[48:51], v[136:139], v[88:91], 0
 s_add_u32 m0, s81, 3072
 s_add_u32 s21, s88, 1130496
 ds_write_b128 v251, v[232:235] offset:36864
 v_mfma_f32_16x16x32_bf16 v[56:59], v[136:139], v[112:115], 0
 buffer_load_dwordx4 v31, s[12:15], s21 offen offset:0 lds
 ds_write_b128 v251, v[236:239] offset:37888
 s_waitcnt lgkmcnt(4)
 v_mfma_f32_16x16x32_bf16 v[40:43], v[140:143], v[68:71], v[40:43]
 ds_read_b128 v[136:139], v22 offset:12544
 v_cvt_pk_f16_f32 v44, v44, v45
 buffer_load_dwordx4 v32, s[12:15], s21 offen offset:1024 lds
 v_accvgpr_write_b32 a122, v44
 v_mfma_f32_16x16x32_bf16 v[48:51], v[140:143], v[92:95], v[48:51]
 v_cvt_pk_f16_f32 v46, v46, v47
 buffer_load_dwordx4 v33, s[12:15], s21 offen offset:2048 lds
 ds_write_b128 v251, v[240:243] offset:38912
 v_mfma_f32_16x16x32_bf16 v[56:59], v[140:143], v[116:119], v[56:59]
 v_accvgpr_write_b32 a123, v46
 s_add_u32 m0, s81, 6144
 s_add_u32 s21, s88, 1572864
 ds_read_b64_tr_b16 v[208:209], v250 offset:36864
 s_waitcnt lgkmcnt(6)
 v_mfma_f32_16x16x32_bf16 v[40:43], v[144:147], v[72:75], v[40:43]
 ds_read_b128 v[140:143], v23 offset:12544
 v_cvt_pk_f16_f32 v52, v52, v53
 buffer_load_dwordx4 v34, s[12:15], s21 offen offset:0 lds
 ds_read_b64_tr_b16 v[210:211], v250 offset:37248
 v_mfma_f32_16x16x32_bf16 v[48:51], v[144:147], v[96:99], v[48:51]
 v_accvgpr_write_b32 a130, v52
 buffer_load_dwordx4 v35, s[12:15], s21 offen offset:1024 lds
 ds_read_b64_tr_b16 v[212:213], v250 offset:36896
 ds_read_b64_tr_b16 v[214:215], v250 offset:37280
 v_mfma_f32_16x16x32_bf16 v[56:59], v[144:147], v[120:123], v[56:59]
 v_cvt_pk_f16_f32 v54, v54, v55
 buffer_load_dwordx4 v36, s[12:15], s21 offen offset:2048 lds
 ds_read_b64_tr_b16 v[216:217], v250 offset:36928
 s_waitcnt lgkmcnt(10)
 v_mfma_f32_16x16x32_bf16 v[40:43], v[148:151], v[76:79], v[40:43]
 ds_read_b128 v[144:147], v22 offset:13824
 v_accvgpr_write_b32 a131, v54
 s_add_u32 m0, s81, 9216
 s_add_u32 s21, s88, 1622016
 ds_read_b64_tr_b16 v[218:219], v250 offset:37312
 v_mfma_f32_16x16x32_bf16 v[48:51], v[148:151], v[100:103], v[48:51]
 v_cvt_pk_f16_f32 v60, v60, v61
 buffer_load_dwordx4 v37, s[12:15], s21 offen offset:0 lds
 s_add_u32 s22, s80, 1081344
 v_accvgpr_write_b32 a138, v60
 v_mfma_f32_16x16x32_bf16 v[56:59], v[148:151], v[124:127], v[56:59]
 v_cvt_pk_f16_f32 v62, v62, v63
 buffer_load_dwordx4 v38, s[12:15], s21 offen offset:1024 lds
 v_accvgpr_write_b32 a139, v62
 s_waitcnt lgkmcnt(9)
 v_mfma_f32_16x16x32_bf16 v[40:43], v[136:139], v[80:83], v[40:43]
 ds_read_b128 v[148:151], v23 offset:13824
 buffer_load_dwordx4 v39, s[12:15], s21 offen offset:2048 lds
 buffer_load_dwordx4 v[232:235], v244, s[40:43], s22 offen
 v_mfma_f32_16x16x32_bf16 v[48:51], v[136:139], v[104:107], v[48:51]
 buffer_load_dwordx4 v[236:239], v245, s[40:43], s22 offen
 buffer_load_dwordx4 v[240:243], v246, s[40:43], s22 offen
 v_mfma_f32_16x16x32_bf16 v[56:59], v[136:139], v[128:131], v[56:59]
 s_waitcnt lgkmcnt(7)
 v_mfma_f32_16x16x32_bf16 v[40:43], v[140:143], v[84:87], v[40:43]
 ds_read_b128 v[136:139], v22 offset:13952
 v_mfma_f32_16x16x32_bf16 v[48:51], v[140:143], v[108:111], v[48:51]
 v_mfma_f32_16x16x32_bf16 v[56:59], v[140:143], v[132:135], v[56:59]
 s_waitcnt lgkmcnt(3)
 v_mfma_f32_16x16x32_bf16 v[44:47], v[144:147], v[64:67], 0
 ds_read_b128 v[140:143], v23 offset:13952
 v_mfma_f32_16x16x32_bf16 v[52:55], v[144:147], v[88:91], 0
 s_waitcnt lgkmcnt(3)
 v_lshlrev_b32 v27, 16, v208
 v_and_b32 v208, 0xffff0000, v208
 v_cvt_pk_f16_f32 v208, v27, v208
 v_accvgpr_write_b32 a64, v208
 v_mfma_f32_16x16x32_bf16 v[60:63], v[144:147], v[112:115], 0
 v_lshlrev_b32 v27, 16, v209
 v_and_b32 v209, 0xffff0000, v209
 v_cvt_pk_f16_f32 v209, v27, v209
 v_accvgpr_write_b32 a65, v209
 s_waitcnt lgkmcnt(2)
 v_mfma_f32_16x16x32_bf16 v[44:47], v[148:151], v[68:71], v[44:47]
 ds_read_b128 v[144:147], v22 offset:14080
 v_cvt_pk_f16_f32 v40, v40, v41
 v_lshlrev_b32 v27, 16, v210
 v_and_b32 v210, 0xffff0000, v210
 v_cvt_pk_f16_f32 v210, v27, v210
 v_mfma_f32_16x16x32_bf16 v[52:55], v[148:151], v[92:95], v[52:55]
 v_accvgpr_write_b32 a124, v40
 v_accvgpr_write_b32 a66, v210
 v_lshlrev_b32 v27, 16, v211
 v_and_b32 v211, 0xffff0000, v211
 v_cvt_pk_f16_f32 v211, v27, v211
 v_mfma_f32_16x16x32_bf16 v[60:63], v[148:151], v[116:119], v[60:63]
 v_cvt_pk_f16_f32 v42, v42, v43
 v_accvgpr_write_b32 a67, v211
 v_lshlrev_b32 v27, 16, v212
 v_and_b32 v212, 0xffff0000, v212
 s_waitcnt lgkmcnt(2)
 v_mfma_f32_16x16x32_bf16 v[44:47], v[136:139], v[72:75], v[44:47]
 ds_read_b128 v[148:151], v23 offset:14080
 v_accvgpr_write_b32 a125, v42
 v_cvt_pk_f16_f32 v212, v27, v212
 v_accvgpr_write_b32 a84, v212
 v_lshlrev_b32 v27, 16, v213
 v_mfma_f32_16x16x32_bf16 v[52:55], v[136:139], v[96:99], v[52:55]
 v_cvt_pk_f16_f32 v48, v48, v49
 v_and_b32 v213, 0xffff0000, v213
 v_cvt_pk_f16_f32 v213, v27, v213
 v_accvgpr_write_b32 a85, v213
 v_lshlrev_b32 v27, 16, v214
 v_mfma_f32_16x16x32_bf16 v[60:63], v[136:139], v[120:123], v[60:63]
 v_accvgpr_write_b32 a132, v48
 v_and_b32 v214, 0xffff0000, v214
 v_cvt_pk_f16_f32 v214, v27, v214
 v_accvgpr_write_b32 a86, v214
 s_waitcnt lgkmcnt(2)
 v_mfma_f32_16x16x32_bf16 v[44:47], v[140:143], v[76:79], v[44:47]
 s_waitcnt vmcnt(18)
 ds_read_b128 v[136:139], v22 offset:24576
 v_cvt_pk_f16_f32 v50, v50, v51
 v_lshlrev_b32 v27, 16, v215
 v_and_b32 v215, 0xffff0000, v215
 v_cvt_pk_f16_f32 v215, v27, v215
 v_mfma_f32_16x16x32_bf16 v[52:55], v[140:143], v[100:103], v[52:55]
 v_accvgpr_write_b32 a133, v50
 v_accvgpr_write_b32 a87, v215
 v_lshlrev_b32 v27, 16, v216
 v_and_b32 v216, 0xffff0000, v216
 v_cvt_pk_f16_f32 v216, v27, v216
 v_mfma_f32_16x16x32_bf16 v[60:63], v[140:143], v[124:127], v[60:63]
 v_cvt_pk_f16_f32 v56, v56, v57
 v_accvgpr_write_b32 a104, v216
 v_lshlrev_b32 v27, 16, v217
 v_and_b32 v217, 0xffff0000, v217
 s_waitcnt lgkmcnt(2)
 v_mfma_f32_16x16x32_bf16 v[44:47], v[144:147], v[80:83], v[44:47]
 ds_read_b128 v[140:143], v23 offset:24576
 v_accvgpr_write_b32 a140, v56
 v_cvt_pk_f16_f32 v217, v27, v217
 v_accvgpr_write_b32 a105, v217
 v_lshlrev_b32 v27, 16, v218
 v_mfma_f32_16x16x32_bf16 v[52:55], v[144:147], v[104:107], v[52:55]
 v_cvt_pk_f16_f32 v58, v58, v59
 v_and_b32 v218, 0xffff0000, v218
 v_cvt_pk_f16_f32 v218, v27, v218
 v_accvgpr_write_b32 a106, v218
 v_lshlrev_b32 v27, 16, v219
 v_mfma_f32_16x16x32_bf16 v[60:63], v[144:147], v[128:131], v[60:63]
 v_accvgpr_write_b32 a141, v58
 v_and_b32 v219, 0xffff0000, v219
 v_cvt_pk_f16_f32 v219, v27, v219
 v_accvgpr_write_b32 a107, v219
 s_waitcnt lgkmcnt(2)
 v_mfma_f32_16x16x32_bf16 v[44:47], v[148:151], v[84:87], v[44:47]
 ds_read_b128 v[144:147], v22 offset:24704
 s_add_u32 m0, s81, 12288
 s_add_u32 s21, s88, 1966080
 v_mfma_f32_16x16x32_bf16 v[52:55], v[148:151], v[108:111], v[52:55]
 buffer_load_dwordx4 v28, s[12:15], s21 offen offset:0 lds
 v_mfma_f32_16x16x32_bf16 v[60:63], v[148:151], v[132:135], v[60:63]
 buffer_load_dwordx4 v29, s[12:15], s21 offen offset:1024 lds
 s_waitcnt lgkmcnt(2)
 v_mfma_f32_16x16x32_bf16 v[40:43], v[136:139], v[64:67], 0
 ds_read_b128 v[148:151], v23 offset:24704
 buffer_load_dwordx4 v30, s[12:15], s21 offen offset:2048 lds
 s_waitcnt vmcnt(18)
 v_mfma_f32_16x16x32_bf16 v[48:51], v[136:139], v[88:91], 0
 s_add_u32 m0, s81, 15360
 s_add_u32 s21, s88, 2015232
 ds_write_b128 v251, v[220:223] offset:36864
 v_mfma_f32_16x16x32_bf16 v[56:59], v[136:139], v[112:115], 0
 buffer_load_dwordx4 v31, s[12:15], s21 offen offset:0 lds
 ds_write_b128 v251, v[224:227] offset:37888
 s_waitcnt lgkmcnt(4)
 v_mfma_f32_16x16x32_bf16 v[40:43], v[140:143], v[68:71], v[40:43]
 ds_read_b128 v[136:139], v22 offset:24832
 v_cvt_pk_f16_f32 v44, v44, v45
 buffer_load_dwordx4 v32, s[12:15], s21 offen offset:1024 lds
 v_accvgpr_write_b32 a126, v44
 v_mfma_f32_16x16x32_bf16 v[48:51], v[140:143], v[92:95], v[48:51]
 v_cvt_pk_f16_f32 v46, v46, v47
 buffer_load_dwordx4 v33, s[12:15], s21 offen offset:2048 lds
 ds_write_b128 v251, v[228:231] offset:38912
 v_mfma_f32_16x16x32_bf16 v[56:59], v[140:143], v[116:119], v[56:59]
 v_accvgpr_write_b32 a127, v46
 s_add_u32 m0, s81, 18432
 s_add_u32 s21, s88, 2457600
 ds_read_b64_tr_b16 v[208:209], v250 offset:36864
 s_waitcnt lgkmcnt(6)
 v_mfma_f32_16x16x32_bf16 v[40:43], v[144:147], v[72:75], v[40:43]
 ds_read_b128 v[140:143], v23 offset:24832
 v_cvt_pk_f16_f32 v52, v52, v53
 buffer_load_dwordx4 v34, s[12:15], s21 offen offset:0 lds
 ds_read_b64_tr_b16 v[210:211], v250 offset:37248
 v_mfma_f32_16x16x32_bf16 v[48:51], v[144:147], v[96:99], v[48:51]
 v_accvgpr_write_b32 a134, v52
 buffer_load_dwordx4 v35, s[12:15], s21 offen offset:1024 lds
 ds_read_b64_tr_b16 v[212:213], v250 offset:36896
 ds_read_b64_tr_b16 v[214:215], v250 offset:37280
 v_mfma_f32_16x16x32_bf16 v[56:59], v[144:147], v[120:123], v[56:59]
 v_cvt_pk_f16_f32 v54, v54, v55
 buffer_load_dwordx4 v36, s[12:15], s21 offen offset:2048 lds
 ds_read_b64_tr_b16 v[216:217], v250 offset:36928
 s_waitcnt lgkmcnt(10)
 v_mfma_f32_16x16x32_bf16 v[40:43], v[148:151], v[76:79], v[40:43]
 ds_read_b128 v[144:147], v22 offset:26112
 v_accvgpr_write_b32 a135, v54
 s_add_u32 m0, s81, 21504
 s_add_u32 s21, s88, 2506752
 ds_read_b64_tr_b16 v[218:219], v250 offset:37312
 v_mfma_f32_16x16x32_bf16 v[48:51], v[148:151], v[100:103], v[48:51]
 v_cvt_pk_f16_f32 v60, v60, v61
 buffer_load_dwordx4 v37, s[12:15], s21 offen offset:0 lds
 s_add_u32 s22, s80, 196608
 v_accvgpr_write_b32 a142, v60
 v_mfma_f32_16x16x32_bf16 v[56:59], v[148:151], v[124:127], v[56:59]
 v_cvt_pk_f16_f32 v62, v62, v63
 buffer_load_dwordx4 v38, s[12:15], s21 offen offset:1024 lds
 v_accvgpr_write_b32 a143, v62
 s_waitcnt lgkmcnt(9)
 v_mfma_f32_16x16x32_bf16 v[40:43], v[136:139], v[80:83], v[40:43]
 ds_read_b128 v[148:151], v23 offset:26112
 buffer_load_dwordx4 v39, s[12:15], s21 offen offset:2048 lds
 buffer_load_dwordx4 v[220:223], v247, s[40:43], s22 offen
 v_mfma_f32_16x16x32_bf16 v[48:51], v[136:139], v[104:107], v[48:51]
 buffer_load_dwordx4 v[224:227], v248, s[40:43], s22 offen
 buffer_load_dwordx4 v[228:231], v249, s[40:43], s22 offen
 v_mfma_f32_16x16x32_bf16 v[56:59], v[136:139], v[128:131], v[56:59]
 s_waitcnt lgkmcnt(7)
 v_mfma_f32_16x16x32_bf16 v[40:43], v[140:143], v[84:87], v[40:43]
 ds_read_b128 v[136:139], v22 offset:26240
 v_mfma_f32_16x16x32_bf16 v[48:51], v[140:143], v[108:111], v[48:51]
 v_mfma_f32_16x16x32_bf16 v[56:59], v[140:143], v[132:135], v[56:59]
 s_waitcnt lgkmcnt(3)
 v_mfma_f32_16x16x32_bf16 v[44:47], v[144:147], v[64:67], 0
 ds_read_b128 v[140:143], v23 offset:26240
 v_mfma_f32_16x16x32_bf16 v[52:55], v[144:147], v[88:91], 0
 s_waitcnt lgkmcnt(3)
 v_lshlrev_b32 v27, 16, v208
 v_and_b32 v208, 0xffff0000, v208
 v_cvt_pk_f16_f32 v208, v27, v208
 v_accvgpr_write_b32 a68, v208
 v_mfma_f32_16x16x32_bf16 v[60:63], v[144:147], v[112:115], 0
 v_lshlrev_b32 v27, 16, v209
 v_and_b32 v209, 0xffff0000, v209
 v_cvt_pk_f16_f32 v209, v27, v209
 v_accvgpr_write_b32 a69, v209
 s_waitcnt lgkmcnt(2)
 v_mfma_f32_16x16x32_bf16 v[44:47], v[148:151], v[68:71], v[44:47]
 ds_read_b128 v[144:147], v22 offset:26368
 v_cvt_pk_f16_f32 v40, v40, v41
 v_lshlrev_b32 v27, 16, v210
 v_and_b32 v210, 0xffff0000, v210
 v_cvt_pk_f16_f32 v210, v27, v210
 v_mfma_f32_16x16x32_bf16 v[52:55], v[148:151], v[92:95], v[52:55]
 v_accvgpr_write_b32 a144, v40
 v_accvgpr_write_b32 a70, v210
 v_lshlrev_b32 v27, 16, v211
 v_and_b32 v211, 0xffff0000, v211
 v_cvt_pk_f16_f32 v211, v27, v211
 v_mfma_f32_16x16x32_bf16 v[60:63], v[148:151], v[116:119], v[60:63]
 v_cvt_pk_f16_f32 v42, v42, v43
 v_accvgpr_write_b32 a71, v211
 v_lshlrev_b32 v27, 16, v212
 v_and_b32 v212, 0xffff0000, v212
 s_waitcnt lgkmcnt(2)
 v_mfma_f32_16x16x32_bf16 v[44:47], v[136:139], v[72:75], v[44:47]
 ds_read_b128 v[148:151], v23 offset:26368
 v_accvgpr_write_b32 a145, v42
 v_cvt_pk_f16_f32 v212, v27, v212
 v_accvgpr_write_b32 a88, v212
 v_lshlrev_b32 v27, 16, v213
 v_mfma_f32_16x16x32_bf16 v[52:55], v[136:139], v[96:99], v[52:55]
 v_cvt_pk_f16_f32 v48, v48, v49
 v_and_b32 v213, 0xffff0000, v213
 v_cvt_pk_f16_f32 v213, v27, v213
 v_accvgpr_write_b32 a89, v213
 v_lshlrev_b32 v27, 16, v214
 v_mfma_f32_16x16x32_bf16 v[60:63], v[136:139], v[120:123], v[60:63]
 v_accvgpr_write_b32 a152, v48
 v_and_b32 v214, 0xffff0000, v214
 v_cvt_pk_f16_f32 v214, v27, v214
 v_accvgpr_write_b32 a90, v214
 s_waitcnt lgkmcnt(2)
 v_mfma_f32_16x16x32_bf16 v[44:47], v[140:143], v[76:79], v[44:47]
 s_waitcnt vmcnt(18)
 ds_read_b128 v[136:139], v22 offset:0
 v_cvt_pk_f16_f32 v50, v50, v51
 v_lshlrev_b32 v27, 16, v215
 v_and_b32 v215, 0xffff0000, v215
 v_cvt_pk_f16_f32 v215, v27, v215
 v_mfma_f32_16x16x32_bf16 v[52:55], v[140:143], v[100:103], v[52:55]
 v_accvgpr_write_b32 a153, v50
 v_accvgpr_write_b32 a91, v215
 v_lshlrev_b32 v27, 16, v216
 v_and_b32 v216, 0xffff0000, v216
 v_cvt_pk_f16_f32 v216, v27, v216
 v_mfma_f32_16x16x32_bf16 v[60:63], v[140:143], v[124:127], v[60:63]
 v_cvt_pk_f16_f32 v56, v56, v57
 v_accvgpr_write_b32 a108, v216
 v_lshlrev_b32 v27, 16, v217
 v_and_b32 v217, 0xffff0000, v217
 s_waitcnt lgkmcnt(2)
 v_mfma_f32_16x16x32_bf16 v[44:47], v[144:147], v[80:83], v[44:47]
 ds_read_b128 v[140:143], v23 offset:0
 v_accvgpr_write_b32 a160, v56
 v_cvt_pk_f16_f32 v217, v27, v217
 v_accvgpr_write_b32 a109, v217
 v_lshlrev_b32 v27, 16, v218
 v_mfma_f32_16x16x32_bf16 v[52:55], v[144:147], v[104:107], v[52:55]
 v_cvt_pk_f16_f32 v58, v58, v59
 v_and_b32 v218, 0xffff0000, v218
 v_cvt_pk_f16_f32 v218, v27, v218
 v_accvgpr_write_b32 a110, v218
 v_lshlrev_b32 v27, 16, v219
 v_mfma_f32_16x16x32_bf16 v[60:63], v[144:147], v[128:131], v[60:63]
 v_accvgpr_write_b32 a161, v58
 v_and_b32 v219, 0xffff0000, v219
 v_cvt_pk_f16_f32 v219, v27, v219
 v_accvgpr_write_b32 a111, v219
 s_waitcnt lgkmcnt(2)
 v_mfma_f32_16x16x32_bf16 v[44:47], v[148:151], v[84:87], v[44:47]
 ds_read_b128 v[144:147], v22 offset:128
 s_add_u32 m0, s81, 24576
 s_add_u32 s21, s88, 2949120
 v_mfma_f32_16x16x32_bf16 v[52:55], v[148:151], v[108:111], v[52:55]
 buffer_load_dwordx4 v28, s[12:15], s21 offen offset:0 lds
 v_mfma_f32_16x16x32_bf16 v[60:63], v[148:151], v[132:135], v[60:63]
 buffer_load_dwordx4 v29, s[12:15], s21 offen offset:1024 lds
 s_waitcnt lgkmcnt(2)
 v_mfma_f32_16x16x32_bf16 v[40:43], v[136:139], v[64:67], 0
 ds_read_b128 v[148:151], v23 offset:128
 buffer_load_dwordx4 v30, s[12:15], s21 offen offset:2048 lds
 s_waitcnt vmcnt(18)
 v_mfma_f32_16x16x32_bf16 v[48:51], v[136:139], v[88:91], 0
 s_add_u32 m0, s81, 27648
 s_add_u32 s21, s88, 2998272
 ds_write_b128 v251, v[232:235] offset:36864
 v_mfma_f32_16x16x32_bf16 v[56:59], v[136:139], v[112:115], 0
 buffer_load_dwordx4 v31, s[12:15], s21 offen offset:0 lds
 ds_write_b128 v251, v[236:239] offset:37888
 s_waitcnt lgkmcnt(4)
 v_mfma_f32_16x16x32_bf16 v[40:43], v[140:143], v[68:71], v[40:43]
 ds_read_b128 v[136:139], v22 offset:256
 v_cvt_pk_f16_f32 v44, v44, v45
 buffer_load_dwordx4 v32, s[12:15], s21 offen offset:1024 lds
 v_accvgpr_write_b32 a146, v44
 v_mfma_f32_16x16x32_bf16 v[48:51], v[140:143], v[92:95], v[48:51]
 v_cvt_pk_f16_f32 v46, v46, v47
 buffer_load_dwordx4 v33, s[12:15], s21 offen offset:2048 lds
 ds_write_b128 v251, v[240:243] offset:38912
 v_mfma_f32_16x16x32_bf16 v[56:59], v[140:143], v[116:119], v[56:59]
 v_accvgpr_write_b32 a147, v46
 s_add_u32 m0, s81, 30720
 s_add_u32 s21, s88, 3440640
 ds_read_b64_tr_b16 v[208:209], v250 offset:36864
 s_waitcnt lgkmcnt(6)
 v_mfma_f32_16x16x32_bf16 v[40:43], v[144:147], v[72:75], v[40:43]
 ds_read_b128 v[140:143], v23 offset:256
 v_cvt_pk_f16_f32 v52, v52, v53
 buffer_load_dwordx4 v34, s[12:15], s21 offen offset:0 lds
 ds_read_b64_tr_b16 v[210:211], v250 offset:37248
 v_mfma_f32_16x16x32_bf16 v[48:51], v[144:147], v[96:99], v[48:51]
 v_accvgpr_write_b32 a154, v52
 buffer_load_dwordx4 v35, s[12:15], s21 offen offset:1024 lds
 ds_read_b64_tr_b16 v[212:213], v250 offset:36896
 ds_read_b64_tr_b16 v[214:215], v250 offset:37280
 v_mfma_f32_16x16x32_bf16 v[56:59], v[144:147], v[120:123], v[56:59]
 v_cvt_pk_f16_f32 v54, v54, v55
 buffer_load_dwordx4 v36, s[12:15], s21 offen offset:2048 lds
 ds_read_b64_tr_b16 v[216:217], v250 offset:36928
 s_waitcnt lgkmcnt(10)
 v_mfma_f32_16x16x32_bf16 v[40:43], v[148:151], v[76:79], v[40:43]
 ds_read_b128 v[144:147], v22 offset:1536
 v_accvgpr_write_b32 a155, v54
 s_add_u32 m0, s81, 33792
 s_add_u32 s21, s88, 3489792
 ds_read_b64_tr_b16 v[218:219], v250 offset:37312
 v_mfma_f32_16x16x32_bf16 v[48:51], v[148:151], v[100:103], v[48:51]
 v_cvt_pk_f16_f32 v60, v60, v61
 buffer_load_dwordx4 v37, s[12:15], s21 offen offset:0 lds
 s_add_u32 s22, s80, 0
 v_accvgpr_write_b32 a162, v60
 v_mfma_f32_16x16x32_bf16 v[56:59], v[148:151], v[124:127], v[56:59]
 v_cvt_pk_f16_f32 v62, v62, v63
 buffer_load_dwordx4 v38, s[12:15], s21 offen offset:1024 lds
 v_accvgpr_write_b32 a163, v62
 s_waitcnt lgkmcnt(9)
 v_mfma_f32_16x16x32_bf16 v[40:43], v[136:139], v[80:83], v[40:43]
 ds_read_b128 v[148:151], v23 offset:1536
 buffer_load_dwordx4 v39, s[12:15], s21 offen offset:2048 lds
 buffer_load_dwordx4 v[232:235], v244, s[36:39], s22 offen
 v_mfma_f32_16x16x32_bf16 v[48:51], v[136:139], v[104:107], v[48:51]
 buffer_load_dwordx4 v[236:239], v245, s[36:39], s22 offen
 buffer_load_dwordx4 v[240:243], v246, s[36:39], s22 offen
 v_mfma_f32_16x16x32_bf16 v[56:59], v[136:139], v[128:131], v[56:59]
 s_waitcnt lgkmcnt(7)
 v_mfma_f32_16x16x32_bf16 v[40:43], v[140:143], v[84:87], v[40:43]
 ds_read_b128 v[136:139], v22 offset:1664
 v_mfma_f32_16x16x32_bf16 v[48:51], v[140:143], v[108:111], v[48:51]
 v_mfma_f32_16x16x32_bf16 v[56:59], v[140:143], v[132:135], v[56:59]
 s_waitcnt lgkmcnt(3)
 v_mfma_f32_16x16x32_bf16 v[44:47], v[144:147], v[64:67], 0
 ds_read_b128 v[140:143], v23 offset:1664
 v_mfma_f32_16x16x32_bf16 v[52:55], v[144:147], v[88:91], 0
 s_waitcnt lgkmcnt(3)
 v_lshlrev_b32 v27, 16, v208
 v_and_b32 v208, 0xffff0000, v208
 v_cvt_pk_f16_f32 v208, v27, v208
 v_accvgpr_write_b32 a72, v208
 v_mfma_f32_16x16x32_bf16 v[60:63], v[144:147], v[112:115], 0
 v_lshlrev_b32 v27, 16, v209
 v_and_b32 v209, 0xffff0000, v209
 v_cvt_pk_f16_f32 v209, v27, v209
 v_accvgpr_write_b32 a73, v209
 s_waitcnt lgkmcnt(2)
 v_mfma_f32_16x16x32_bf16 v[44:47], v[148:151], v[68:71], v[44:47]
 ds_read_b128 v[144:147], v22 offset:1792
 v_cvt_pk_f16_f32 v40, v40, v41
 v_lshlrev_b32 v27, 16, v210
 v_and_b32 v210, 0xffff0000, v210
 v_cvt_pk_f16_f32 v210, v27, v210
 v_mfma_f32_16x16x32_bf16 v[52:55], v[148:151], v[92:95], v[52:55]
 v_accvgpr_write_b32 a148, v40
 v_accvgpr_write_b32 a74, v210
 v_lshlrev_b32 v27, 16, v211
 v_and_b32 v211, 0xffff0000, v211
 v_cvt_pk_f16_f32 v211, v27, v211
 v_mfma_f32_16x16x32_bf16 v[60:63], v[148:151], v[116:119], v[60:63]
 v_cvt_pk_f16_f32 v42, v42, v43
 v_accvgpr_write_b32 a75, v211
 v_lshlrev_b32 v27, 16, v212
 v_and_b32 v212, 0xffff0000, v212
 s_waitcnt lgkmcnt(2)
 v_mfma_f32_16x16x32_bf16 v[44:47], v[136:139], v[72:75], v[44:47]
 ds_read_b128 v[148:151], v23 offset:1792
 v_accvgpr_write_b32 a149, v42
 v_cvt_pk_f16_f32 v212, v27, v212
 v_accvgpr_write_b32 a92, v212
 v_lshlrev_b32 v27, 16, v213
 v_mfma_f32_16x16x32_bf16 v[52:55], v[136:139], v[96:99], v[52:55]
 v_cvt_pk_f16_f32 v48, v48, v49
 v_and_b32 v213, 0xffff0000, v213
 v_cvt_pk_f16_f32 v213, v27, v213
 v_accvgpr_write_b32 a93, v213
 v_lshlrev_b32 v27, 16, v214
 v_mfma_f32_16x16x32_bf16 v[60:63], v[136:139], v[120:123], v[60:63]
 v_accvgpr_write_b32 a156, v48
 v_and_b32 v214, 0xffff0000, v214
 v_cvt_pk_f16_f32 v214, v27, v214
 v_accvgpr_write_b32 a94, v214
 s_waitcnt lgkmcnt(2)
 v_mfma_f32_16x16x32_bf16 v[44:47], v[140:143], v[76:79], v[44:47]
 s_waitcnt vmcnt(18)
 ds_read_b128 v[136:139], v22 offset:12288
 v_cvt_pk_f16_f32 v50, v50, v51
 v_lshlrev_b32 v27, 16, v215
 v_and_b32 v215, 0xffff0000, v215
 v_cvt_pk_f16_f32 v215, v27, v215
 v_mfma_f32_16x16x32_bf16 v[52:55], v[140:143], v[100:103], v[52:55]
 v_accvgpr_write_b32 a157, v50
 v_accvgpr_write_b32 a95, v215
 v_lshlrev_b32 v27, 16, v216
 v_and_b32 v216, 0xffff0000, v216
 v_cvt_pk_f16_f32 v216, v27, v216
 v_mfma_f32_16x16x32_bf16 v[60:63], v[140:143], v[124:127], v[60:63]
 v_cvt_pk_f16_f32 v56, v56, v57
 v_accvgpr_write_b32 a112, v216
 v_lshlrev_b32 v27, 16, v217
 v_and_b32 v217, 0xffff0000, v217
 s_waitcnt lgkmcnt(2)
 v_mfma_f32_16x16x32_bf16 v[44:47], v[144:147], v[80:83], v[44:47]
 ds_read_b128 v[140:143], v23 offset:12288
 v_accvgpr_write_b32 a164, v56
 v_cvt_pk_f16_f32 v217, v27, v217
 v_accvgpr_write_b32 a113, v217
 v_lshlrev_b32 v27, 16, v218
 v_mfma_f32_16x16x32_bf16 v[52:55], v[144:147], v[104:107], v[52:55]
 v_cvt_pk_f16_f32 v58, v58, v59
 v_and_b32 v218, 0xffff0000, v218
 v_cvt_pk_f16_f32 v218, v27, v218
 v_accvgpr_write_b32 a114, v218
 v_lshlrev_b32 v27, 16, v219
 v_mfma_f32_16x16x32_bf16 v[60:63], v[144:147], v[128:131], v[60:63]
 v_accvgpr_write_b32 a165, v58
 v_and_b32 v219, 0xffff0000, v219
 v_cvt_pk_f16_f32 v219, v27, v219
 v_accvgpr_write_b32 a115, v219
 s_waitcnt lgkmcnt(2)
 v_mfma_f32_16x16x32_bf16 v[44:47], v[148:151], v[84:87], v[44:47]
 ds_read_b128 v[144:147], v22 offset:12416
 s_add_u32 m0, s81, 0
 s_add_u32 s21, s88, 2064384
 v_mfma_f32_16x16x32_bf16 v[52:55], v[148:151], v[108:111], v[52:55]
 buffer_load_dwordx4 v28, s[12:15], s21 offen offset:0 lds
 v_mfma_f32_16x16x32_bf16 v[60:63], v[148:151], v[132:135], v[60:63]
 buffer_load_dwordx4 v29, s[12:15], s21 offen offset:1024 lds
 s_waitcnt lgkmcnt(2)
 v_mfma_f32_16x16x32_bf16 v[40:43], v[136:139], v[64:67], 0
 ds_read_b128 v[148:151], v23 offset:12416
 buffer_load_dwordx4 v30, s[12:15], s21 offen offset:2048 lds
 s_waitcnt vmcnt(18)
 v_mfma_f32_16x16x32_bf16 v[48:51], v[136:139], v[88:91], 0
 s_add_u32 m0, s81, 3072
 s_add_u32 s21, s88, 2113536
 ds_write_b128 v251, v[220:223] offset:36864
 v_mfma_f32_16x16x32_bf16 v[56:59], v[136:139], v[112:115], 0
 buffer_load_dwordx4 v31, s[12:15], s21 offen offset:0 lds
 ds_write_b128 v251, v[224:227] offset:37888
 s_waitcnt lgkmcnt(4)
 v_mfma_f32_16x16x32_bf16 v[40:43], v[140:143], v[68:71], v[40:43]
 ds_read_b128 v[136:139], v22 offset:12544
 v_cvt_pk_f16_f32 v44, v44, v45
 buffer_load_dwordx4 v32, s[12:15], s21 offen offset:1024 lds
 v_accvgpr_write_b32 a150, v44
 v_mfma_f32_16x16x32_bf16 v[48:51], v[140:143], v[92:95], v[48:51]
 v_cvt_pk_f16_f32 v46, v46, v47
 buffer_load_dwordx4 v33, s[12:15], s21 offen offset:2048 lds
 ds_write_b128 v251, v[228:231] offset:38912
 v_mfma_f32_16x16x32_bf16 v[56:59], v[140:143], v[116:119], v[56:59]
 v_accvgpr_write_b32 a151, v46
 s_add_u32 m0, s81, 6144
 s_add_u32 s21, s88, 2555904
 ds_read_b64_tr_b16 v[208:209], v250 offset:36864
 s_waitcnt lgkmcnt(6)
 v_mfma_f32_16x16x32_bf16 v[40:43], v[144:147], v[72:75], v[40:43]
 ds_read_b128 v[140:143], v23 offset:12544
 v_cvt_pk_f16_f32 v52, v52, v53
 buffer_load_dwordx4 v34, s[12:15], s21 offen offset:0 lds
 ds_read_b64_tr_b16 v[210:211], v250 offset:37248
 v_mfma_f32_16x16x32_bf16 v[48:51], v[144:147], v[96:99], v[48:51]
 v_accvgpr_write_b32 a158, v52
 buffer_load_dwordx4 v35, s[12:15], s21 offen offset:1024 lds
 ds_read_b64_tr_b16 v[212:213], v250 offset:36896
 ds_read_b64_tr_b16 v[214:215], v250 offset:37280
 v_mfma_f32_16x16x32_bf16 v[56:59], v[144:147], v[120:123], v[56:59]
 v_cvt_pk_f16_f32 v54, v54, v55
 buffer_load_dwordx4 v36, s[12:15], s21 offen offset:2048 lds
 ds_read_b64_tr_b16 v[216:217], v250 offset:36928
 s_waitcnt lgkmcnt(10)
 v_mfma_f32_16x16x32_bf16 v[40:43], v[148:151], v[76:79], v[40:43]
 ds_read_b128 v[144:147], v22 offset:13824
 v_accvgpr_write_b32 a159, v54
 s_add_u32 m0, s81, 9216
 s_add_u32 s21, s88, 2605056
 ds_read_b64_tr_b16 v[218:219], v250 offset:37312
 v_mfma_f32_16x16x32_bf16 v[48:51], v[148:151], v[100:103], v[48:51]
 v_cvt_pk_f16_f32 v60, v60, v61
 buffer_load_dwordx4 v37, s[12:15], s21 offen offset:0 lds
 s_add_u32 s22, s80, 983040
 v_accvgpr_write_b32 a166, v60
 v_mfma_f32_16x16x32_bf16 v[56:59], v[148:151], v[124:127], v[56:59]
 v_cvt_pk_f16_f32 v62, v62, v63
 buffer_load_dwordx4 v38, s[12:15], s21 offen offset:1024 lds
 v_accvgpr_write_b32 a167, v62
 s_waitcnt lgkmcnt(9)
 v_mfma_f32_16x16x32_bf16 v[40:43], v[136:139], v[80:83], v[40:43]
 ds_read_b128 v[148:151], v23 offset:13824
 buffer_load_dwordx4 v39, s[12:15], s21 offen offset:2048 lds
 buffer_load_dwordx4 v[220:223], v244, s[36:39], s22 offen
 v_mfma_f32_16x16x32_bf16 v[48:51], v[136:139], v[104:107], v[48:51]
 buffer_load_dwordx4 v[224:227], v245, s[36:39], s22 offen
 buffer_load_dwordx4 v[228:231], v246, s[36:39], s22 offen
 v_mfma_f32_16x16x32_bf16 v[56:59], v[136:139], v[128:131], v[56:59]
 s_waitcnt lgkmcnt(7)
 v_mfma_f32_16x16x32_bf16 v[40:43], v[140:143], v[84:87], v[40:43]
 ds_read_b128 v[136:139], v22 offset:13952
 v_mfma_f32_16x16x32_bf16 v[48:51], v[140:143], v[108:111], v[48:51]
 v_mfma_f32_16x16x32_bf16 v[56:59], v[140:143], v[132:135], v[56:59]
 s_waitcnt lgkmcnt(3)
 v_mfma_f32_16x16x32_bf16 v[44:47], v[144:147], v[64:67], 0
 ds_read_b128 v[140:143], v23 offset:13952
 v_mfma_f32_16x16x32_bf16 v[52:55], v[144:147], v[88:91], 0
 s_waitcnt lgkmcnt(3)
 v_lshlrev_b32 v27, 16, v208
 v_and_b32 v208, 0xffff0000, v208
 v_cvt_pk_f16_f32 v208, v27, v208
 v_accvgpr_write_b32 a76, v208
 v_mfma_f32_16x16x32_bf16 v[60:63], v[144:147], v[112:115], 0
 v_lshlrev_b32 v27, 16, v209
 v_and_b32 v209, 0xffff0000, v209
 v_cvt_pk_f16_f32 v209, v27, v209
 v_accvgpr_write_b32 a77, v209
 s_waitcnt lgkmcnt(2)
 v_mfma_f32_16x16x32_bf16 v[44:47], v[148:151], v[68:71], v[44:47]
 ds_read_b128 v[144:147], v22 offset:14080
 v_cvt_pk_f16_f32 v40, v40, v41
 v_lshlrev_b32 v27, 16, v210
 v_and_b32 v210, 0xffff0000, v210
 v_cvt_pk_f16_f32 v210, v27, v210
 v_mfma_f32_16x16x32_bf16 v[52:55], v[148:151], v[92:95], v[52:55]
 v_accvgpr_write_b32 a168, v40
 v_accvgpr_write_b32 a78, v210
 v_lshlrev_b32 v27, 16, v211
 v_and_b32 v211, 0xffff0000, v211
 v_cvt_pk_f16_f32 v211, v27, v211
 v_mfma_f32_16x16x32_bf16 v[60:63], v[148:151], v[116:119], v[60:63]
 v_cvt_pk_f16_f32 v42, v42, v43
 v_accvgpr_write_b32 a79, v211
 v_lshlrev_b32 v27, 16, v212
 v_and_b32 v212, 0xffff0000, v212
 s_waitcnt lgkmcnt(2)
 v_mfma_f32_16x16x32_bf16 v[44:47], v[136:139], v[72:75], v[44:47]
 ds_read_b128 v[148:151], v23 offset:14080
 v_accvgpr_write_b32 a169, v42
 v_cvt_pk_f16_f32 v212, v27, v212
 v_accvgpr_write_b32 a96, v212
 v_lshlrev_b32 v27, 16, v213
 v_mfma_f32_16x16x32_bf16 v[52:55], v[136:139], v[96:99], v[52:55]
 v_cvt_pk_f16_f32 v48, v48, v49
 v_and_b32 v213, 0xffff0000, v213
 v_cvt_pk_f16_f32 v213, v27, v213
 v_accvgpr_write_b32 a97, v213
 v_lshlrev_b32 v27, 16, v214
 v_mfma_f32_16x16x32_bf16 v[60:63], v[136:139], v[120:123], v[60:63]
 v_accvgpr_write_b32 a176, v48
 v_and_b32 v214, 0xffff0000, v214
 v_cvt_pk_f16_f32 v214, v27, v214
 v_accvgpr_write_b32 a98, v214
 s_waitcnt lgkmcnt(2)
 v_mfma_f32_16x16x32_bf16 v[44:47], v[140:143], v[76:79], v[44:47]
 s_waitcnt vmcnt(18)
 ds_read_b128 v[136:139], v22 offset:24576
 v_cvt_pk_f16_f32 v50, v50, v51
 v_lshlrev_b32 v27, 16, v215
 v_and_b32 v215, 0xffff0000, v215
 v_cvt_pk_f16_f32 v215, v27, v215
 v_mfma_f32_16x16x32_bf16 v[52:55], v[140:143], v[100:103], v[52:55]
 v_accvgpr_write_b32 a177, v50
 v_accvgpr_write_b32 a99, v215
 v_lshlrev_b32 v27, 16, v216
 v_and_b32 v216, 0xffff0000, v216
 v_cvt_pk_f16_f32 v216, v27, v216
 v_mfma_f32_16x16x32_bf16 v[60:63], v[140:143], v[124:127], v[60:63]
 v_cvt_pk_f16_f32 v56, v56, v57
 v_accvgpr_write_b32 a116, v216
 v_lshlrev_b32 v27, 16, v217
 v_and_b32 v217, 0xffff0000, v217
 s_waitcnt lgkmcnt(2)
 v_mfma_f32_16x16x32_bf16 v[44:47], v[144:147], v[80:83], v[44:47]
 ds_read_b128 v[140:143], v23 offset:24576
 v_accvgpr_write_b32 a184, v56
 v_cvt_pk_f16_f32 v217, v27, v217
 v_accvgpr_write_b32 a117, v217
 v_lshlrev_b32 v27, 16, v218
 v_mfma_f32_16x16x32_bf16 v[52:55], v[144:147], v[104:107], v[52:55]
 v_cvt_pk_f16_f32 v58, v58, v59
 v_and_b32 v218, 0xffff0000, v218
 v_cvt_pk_f16_f32 v218, v27, v218
 v_accvgpr_write_b32 a118, v218
 v_lshlrev_b32 v27, 16, v219
 v_mfma_f32_16x16x32_bf16 v[60:63], v[144:147], v[128:131], v[60:63]
 v_accvgpr_write_b32 a185, v58
 v_and_b32 v219, 0xffff0000, v219
 v_cvt_pk_f16_f32 v219, v27, v219
 v_accvgpr_write_b32 a119, v219
 s_waitcnt lgkmcnt(2)
 v_mfma_f32_16x16x32_bf16 v[44:47], v[148:151], v[84:87], v[44:47]
 ds_read_b128 v[144:147], v22 offset:24704
 s_add_u32 m0, s81, 12288
 s_add_u32 s21, s88, 3047424
 v_mfma_f32_16x16x32_bf16 v[52:55], v[148:151], v[108:111], v[52:55]
 buffer_load_dwordx4 v28, s[12:15], s21 offen offset:0 lds
 v_mfma_f32_16x16x32_bf16 v[60:63], v[148:151], v[132:135], v[60:63]
 buffer_load_dwordx4 v29, s[12:15], s21 offen offset:1024 lds
 s_waitcnt lgkmcnt(2)
 v_mfma_f32_16x16x32_bf16 v[40:43], v[136:139], v[64:67], 0
 ds_read_b128 v[148:151], v23 offset:24704
 buffer_load_dwordx4 v30, s[12:15], s21 offen offset:2048 lds
 s_waitcnt vmcnt(18)
 v_mfma_f32_16x16x32_bf16 v[48:51], v[136:139], v[88:91], 0
 s_add_u32 m0, s81, 15360
 s_add_u32 s21, s88, 3096576
 ds_write_b128 v251, v[232:235] offset:36864
 v_mfma_f32_16x16x32_bf16 v[56:59], v[136:139], v[112:115], 0
 buffer_load_dwordx4 v31, s[12:15], s21 offen offset:0 lds
 ds_write_b128 v251, v[236:239] offset:37888
 s_waitcnt lgkmcnt(4)
 v_mfma_f32_16x16x32_bf16 v[40:43], v[140:143], v[68:71], v[40:43]
 ds_read_b128 v[136:139], v22 offset:24832
 v_cvt_pk_f16_f32 v44, v44, v45
 buffer_load_dwordx4 v32, s[12:15], s21 offen offset:1024 lds
 v_accvgpr_write_b32 a170, v44
 v_mfma_f32_16x16x32_bf16 v[48:51], v[140:143], v[92:95], v[48:51]
 v_cvt_pk_f16_f32 v46, v46, v47
 buffer_load_dwordx4 v33, s[12:15], s21 offen offset:2048 lds
 ds_write_b128 v251, v[240:243] offset:38912
 v_mfma_f32_16x16x32_bf16 v[56:59], v[140:143], v[116:119], v[56:59]
 v_accvgpr_write_b32 a171, v46
 s_add_u32 m0, s81, 18432
 s_add_u32 s21, s88, 3538944
 ds_read_b64_tr_b16 v[208:209], v250 offset:36864
 s_waitcnt lgkmcnt(6)
 v_mfma_f32_16x16x32_bf16 v[40:43], v[144:147], v[72:75], v[40:43]
 ds_read_b128 v[140:143], v23 offset:24832
 v_cvt_pk_f16_f32 v52, v52, v53
 buffer_load_dwordx4 v34, s[12:15], s21 offen offset:0 lds
 ds_read_b64_tr_b16 v[210:211], v250 offset:37248
 v_mfma_f32_16x16x32_bf16 v[48:51], v[144:147], v[96:99], v[48:51]
 v_accvgpr_write_b32 a178, v52
 buffer_load_dwordx4 v35, s[12:15], s21 offen offset:1024 lds
 ds_read_b64_tr_b16 v[212:213], v250 offset:36896
 ds_read_b64_tr_b16 v[214:215], v250 offset:37280
 v_mfma_f32_16x16x32_bf16 v[56:59], v[144:147], v[120:123], v[56:59]
 v_cvt_pk_f16_f32 v54, v54, v55
 buffer_load_dwordx4 v36, s[12:15], s21 offen offset:2048 lds
 ds_read_b64_tr_b16 v[216:217], v250 offset:36928
 s_waitcnt lgkmcnt(10)
 v_mfma_f32_16x16x32_bf16 v[40:43], v[148:151], v[76:79], v[40:43]
 ds_read_b128 v[144:147], v22 offset:26112
 v_accvgpr_write_b32 a179, v54
 s_add_u32 m0, s81, 21504
 s_add_u32 s21, s88, 3588096
 ds_read_b64_tr_b16 v[218:219], v250 offset:37312
 v_mfma_f32_16x16x32_bf16 v[48:51], v[148:151], v[100:103], v[48:51]
 v_cvt_pk_f16_f32 v60, v60, v61
 buffer_load_dwordx4 v37, s[12:15], s21 offen offset:0 lds
 s_add_u32 s22, s80, 98304
 v_accvgpr_write_b32 a186, v60
 v_mfma_f32_16x16x32_bf16 v[56:59], v[148:151], v[124:127], v[56:59]
 v_cvt_pk_f16_f32 v62, v62, v63
 buffer_load_dwordx4 v38, s[12:15], s21 offen offset:1024 lds
 v_accvgpr_write_b32 a187, v62
 s_waitcnt lgkmcnt(9)
 v_mfma_f32_16x16x32_bf16 v[40:43], v[136:139], v[80:83], v[40:43]
 ds_read_b128 v[148:151], v23 offset:26112
 buffer_load_dwordx4 v39, s[12:15], s21 offen offset:2048 lds
 buffer_load_dwordx4 v[232:235], v244, s[36:39], s22 offen
 v_mfma_f32_16x16x32_bf16 v[48:51], v[136:139], v[104:107], v[48:51]
 buffer_load_dwordx4 v[236:239], v245, s[36:39], s22 offen
 buffer_load_dwordx4 v[240:243], v246, s[36:39], s22 offen
 v_mfma_f32_16x16x32_bf16 v[56:59], v[136:139], v[128:131], v[56:59]
 s_waitcnt lgkmcnt(7)
 v_mfma_f32_16x16x32_bf16 v[40:43], v[140:143], v[84:87], v[40:43]
 ds_read_b128 v[136:139], v22 offset:26240
 v_mfma_f32_16x16x32_bf16 v[48:51], v[140:143], v[108:111], v[48:51]
 v_mfma_f32_16x16x32_bf16 v[56:59], v[140:143], v[132:135], v[56:59]
 s_waitcnt lgkmcnt(3)
 v_mfma_f32_16x16x32_bf16 v[44:47], v[144:147], v[64:67], 0
 ds_read_b128 v[140:143], v23 offset:26240
 v_mfma_f32_16x16x32_bf16 v[52:55], v[144:147], v[88:91], 0
 s_waitcnt lgkmcnt(3)
 v_lshlrev_b32 v27, 16, v208
 v_and_b32 v208, 0xffff0000, v208
 v_cvt_pk_f16_f32 v208, v27, v208
 v_accvgpr_write_b32 a0, v208
 v_mfma_f32_16x16x32_bf16 v[60:63], v[144:147], v[112:115], 0
 v_lshlrev_b32 v27, 16, v209
 v_and_b32 v209, 0xffff0000, v209
 v_cvt_pk_f16_f32 v209, v27, v209
 v_accvgpr_write_b32 a1, v209
 s_waitcnt lgkmcnt(2)
 v_mfma_f32_16x16x32_bf16 v[44:47], v[148:151], v[68:71], v[44:47]
 ds_read_b128 v[144:147], v22 offset:26368
 v_cvt_pk_f16_f32 v40, v40, v41
 v_lshlrev_b32 v27, 16, v210
 v_and_b32 v210, 0xffff0000, v210
 v_cvt_pk_f16_f32 v210, v27, v210
 v_mfma_f32_16x16x32_bf16 v[52:55], v[148:151], v[92:95], v[52:55]
 v_accvgpr_write_b32 a172, v40
 v_accvgpr_write_b32 a2, v210
 v_lshlrev_b32 v27, 16, v211
 v_and_b32 v211, 0xffff0000, v211
 v_cvt_pk_f16_f32 v211, v27, v211
 v_mfma_f32_16x16x32_bf16 v[60:63], v[148:151], v[116:119], v[60:63]
 v_cvt_pk_f16_f32 v42, v42, v43
 v_accvgpr_write_b32 a3, v211
 v_lshlrev_b32 v27, 16, v212
 v_and_b32 v212, 0xffff0000, v212
 s_waitcnt lgkmcnt(2)
 v_mfma_f32_16x16x32_bf16 v[44:47], v[136:139], v[72:75], v[44:47]
 ds_read_b128 v[148:151], v23 offset:26368
 v_accvgpr_write_b32 a173, v42
 v_cvt_pk_f16_f32 v212, v27, v212
 v_accvgpr_write_b32 a20, v212
 v_lshlrev_b32 v27, 16, v213
 v_mfma_f32_16x16x32_bf16 v[52:55], v[136:139], v[96:99], v[52:55]
 v_cvt_pk_f16_f32 v48, v48, v49
 v_and_b32 v213, 0xffff0000, v213
 v_cvt_pk_f16_f32 v213, v27, v213
 v_accvgpr_write_b32 a21, v213
 v_lshlrev_b32 v27, 16, v214
 v_mfma_f32_16x16x32_bf16 v[60:63], v[136:139], v[120:123], v[60:63]
 v_accvgpr_write_b32 a180, v48
 v_and_b32 v214, 0xffff0000, v214
 v_cvt_pk_f16_f32 v214, v27, v214
 v_accvgpr_write_b32 a22, v214
 s_waitcnt lgkmcnt(2)
 v_mfma_f32_16x16x32_bf16 v[44:47], v[140:143], v[76:79], v[44:47]
 s_waitcnt vmcnt(18)
 ds_read_b128 v[136:139], v22 offset:0
 v_cvt_pk_f16_f32 v50, v50, v51
 v_lshlrev_b32 v27, 16, v215
 v_and_b32 v215, 0xffff0000, v215
 v_cvt_pk_f16_f32 v215, v27, v215
 v_mfma_f32_16x16x32_bf16 v[52:55], v[140:143], v[100:103], v[52:55]
 v_accvgpr_write_b32 a181, v50
 v_accvgpr_write_b32 a23, v215
 v_lshlrev_b32 v27, 16, v216
 v_and_b32 v216, 0xffff0000, v216
 v_cvt_pk_f16_f32 v216, v27, v216
 v_mfma_f32_16x16x32_bf16 v[60:63], v[140:143], v[124:127], v[60:63]
 v_cvt_pk_f16_f32 v56, v56, v57
 v_accvgpr_write_b32 a40, v216
 v_lshlrev_b32 v27, 16, v217
 v_and_b32 v217, 0xffff0000, v217
 s_waitcnt lgkmcnt(2)
 v_mfma_f32_16x16x32_bf16 v[44:47], v[144:147], v[80:83], v[44:47]
 ds_read_b128 v[140:143], v23 offset:0
 v_accvgpr_write_b32 a188, v56
 v_cvt_pk_f16_f32 v217, v27, v217
 v_accvgpr_write_b32 a41, v217
 v_lshlrev_b32 v27, 16, v218
 v_mfma_f32_16x16x32_bf16 v[52:55], v[144:147], v[104:107], v[52:55]
 v_cvt_pk_f16_f32 v58, v58, v59
 v_and_b32 v218, 0xffff0000, v218
 v_cvt_pk_f16_f32 v218, v27, v218
 v_accvgpr_write_b32 a42, v218
 v_lshlrev_b32 v27, 16, v219
 v_mfma_f32_16x16x32_bf16 v[60:63], v[144:147], v[128:131], v[60:63]
 v_accvgpr_write_b32 a189, v58
 v_and_b32 v219, 0xffff0000, v219
 v_cvt_pk_f16_f32 v219, v27, v219
 v_accvgpr_write_b32 a43, v219
 s_waitcnt lgkmcnt(2)
 v_mfma_f32_16x16x32_bf16 v[44:47], v[148:151], v[84:87], v[44:47]
 ds_read_b128 v[144:147], v22 offset:128
 s_add_u32 m0, s81, 24576
 s_add_u32 s21, s88, 3932160
 v_mfma_f32_16x16x32_bf16 v[52:55], v[148:151], v[108:111], v[52:55]
 buffer_load_dwordx4 v28, s[12:15], s21 offen offset:0 lds
 v_mfma_f32_16x16x32_bf16 v[60:63], v[148:151], v[132:135], v[60:63]
 buffer_load_dwordx4 v29, s[12:15], s21 offen offset:1024 lds
 s_waitcnt lgkmcnt(2)
 v_mfma_f32_16x16x32_bf16 v[40:43], v[136:139], v[64:67], 0
 ds_read_b128 v[148:151], v23 offset:128
 buffer_load_dwordx4 v30, s[12:15], s21 offen offset:2048 lds
 s_waitcnt vmcnt(18)
 v_mfma_f32_16x16x32_bf16 v[48:51], v[136:139], v[88:91], 0
 s_add_u32 m0, s81, 27648
 s_add_u32 s21, s88, 3981312
 ds_write_b128 v251, v[220:223] offset:36864
 v_mfma_f32_16x16x32_bf16 v[56:59], v[136:139], v[112:115], 0
 buffer_load_dwordx4 v31, s[12:15], s21 offen offset:0 lds
 ds_write_b128 v251, v[224:227] offset:37888
 s_waitcnt lgkmcnt(4)
 v_mfma_f32_16x16x32_bf16 v[40:43], v[140:143], v[68:71], v[40:43]
 ds_read_b128 v[136:139], v22 offset:256
 v_cvt_pk_f16_f32 v44, v44, v45
 buffer_load_dwordx4 v32, s[12:15], s21 offen offset:1024 lds
 v_accvgpr_write_b32 a174, v44
 v_mfma_f32_16x16x32_bf16 v[48:51], v[140:143], v[92:95], v[48:51]
 v_cvt_pk_f16_f32 v46, v46, v47
 buffer_load_dwordx4 v33, s[12:15], s21 offen offset:2048 lds
 ds_write_b128 v251, v[228:231] offset:38912
 v_mfma_f32_16x16x32_bf16 v[56:59], v[140:143], v[116:119], v[56:59]
 v_accvgpr_write_b32 a175, v46
 s_add_u32 m0, s81, 30720
 s_add_u32 s21, s88, 4423680
 ds_read_b64_tr_b16 v[208:209], v250 offset:36864
 s_waitcnt lgkmcnt(6)
 v_mfma_f32_16x16x32_bf16 v[40:43], v[144:147], v[72:75], v[40:43]
 ds_read_b128 v[140:143], v23 offset:256
 v_cvt_pk_f16_f32 v52, v52, v53
 buffer_load_dwordx4 v34, s[12:15], s21 offen offset:0 lds
 ds_read_b64_tr_b16 v[210:211], v250 offset:37248
 v_mfma_f32_16x16x32_bf16 v[48:51], v[144:147], v[96:99], v[48:51]
 v_accvgpr_write_b32 a182, v52
 buffer_load_dwordx4 v35, s[12:15], s21 offen offset:1024 lds
 ds_read_b64_tr_b16 v[212:213], v250 offset:36896
 ds_read_b64_tr_b16 v[214:215], v250 offset:37280
 v_mfma_f32_16x16x32_bf16 v[56:59], v[144:147], v[120:123], v[56:59]
 v_cvt_pk_f16_f32 v54, v54, v55
 buffer_load_dwordx4 v36, s[12:15], s21 offen offset:2048 lds
 ds_read_b64_tr_b16 v[216:217], v250 offset:36928
 s_waitcnt lgkmcnt(10)
 v_mfma_f32_16x16x32_bf16 v[40:43], v[148:151], v[76:79], v[40:43]
 ds_read_b128 v[144:147], v22 offset:1536
 v_accvgpr_write_b32 a183, v54
 s_add_u32 m0, s81, 33792
 s_add_u32 s21, s88, 4472832
 ds_read_b64_tr_b16 v[218:219], v250 offset:37312
 v_mfma_f32_16x16x32_bf16 v[48:51], v[148:151], v[100:103], v[48:51]
 v_cvt_pk_f16_f32 v60, v60, v61
 buffer_load_dwordx4 v37, s[12:15], s21 offen offset:0 lds
 s_add_u32 s22, s80, 1081344
 v_accvgpr_write_b32 a190, v60
 v_mfma_f32_16x16x32_bf16 v[56:59], v[148:151], v[124:127], v[56:59]
 v_cvt_pk_f16_f32 v62, v62, v63
 buffer_load_dwordx4 v38, s[12:15], s21 offen offset:1024 lds
 v_accvgpr_write_b32 a191, v62
 s_waitcnt lgkmcnt(9)
 v_mfma_f32_16x16x32_bf16 v[40:43], v[136:139], v[80:83], v[40:43]
 ds_read_b128 v[148:151], v23 offset:1536
 buffer_load_dwordx4 v39, s[12:15], s21 offen offset:2048 lds
 buffer_load_dwordx4 v[220:223], v244, s[36:39], s22 offen
 v_mfma_f32_16x16x32_bf16 v[48:51], v[136:139], v[104:107], v[48:51]
 buffer_load_dwordx4 v[224:227], v245, s[36:39], s22 offen
 buffer_load_dwordx4 v[228:231], v246, s[36:39], s22 offen
 v_mfma_f32_16x16x32_bf16 v[56:59], v[136:139], v[128:131], v[56:59]
 s_waitcnt lgkmcnt(7)
 v_mfma_f32_16x16x32_bf16 v[40:43], v[140:143], v[84:87], v[40:43]
 ds_read_b128 v[136:139], v22 offset:1664
 v_mfma_f32_16x16x32_bf16 v[48:51], v[140:143], v[108:111], v[48:51]
 v_mfma_f32_16x16x32_bf16 v[56:59], v[140:143], v[132:135], v[56:59]
 s_waitcnt lgkmcnt(3)
 v_mfma_f32_16x16x32_bf16 v[44:47], v[144:147], v[64:67], 0
 ds_read_b128 v[140:143], v23 offset:1664
 v_mfma_f32_16x16x32_bf16 v[52:55], v[144:147], v[88:91], 0
 s_waitcnt lgkmcnt(3)
 v_lshlrev_b32 v27, 16, v208
 v_and_b32 v208, 0xffff0000, v208
 v_cvt_pk_f16_f32 v208, v27, v208
 v_accvgpr_write_b32 a4, v208
 v_mfma_f32_16x16x32_bf16 v[60:63], v[144:147], v[112:115], 0
 v_lshlrev_b32 v27, 16, v209
 v_and_b32 v209, 0xffff0000, v209
 v_cvt_pk_f16_f32 v209, v27, v209
 v_accvgpr_write_b32 a5, v209
 s_waitcnt lgkmcnt(2)
 v_mfma_f32_16x16x32_bf16 v[44:47], v[148:151], v[68:71], v[44:47]
 ds_read_b128 v[144:147], v22 offset:1792
 v_cvt_pk_f16_f32 v40, v40, v41
 v_lshlrev_b32 v27, 16, v210
 v_and_b32 v210, 0xffff0000, v210
 v_cvt_pk_f16_f32 v210, v27, v210
 v_mfma_f32_16x16x32_bf16 v[52:55], v[148:151], v[92:95], v[52:55]
 v_accvgpr_write_b32 a192, v40
 v_accvgpr_write_b32 a6, v210
 v_lshlrev_b32 v27, 16, v211
 v_and_b32 v211, 0xffff0000, v211
 v_cvt_pk_f16_f32 v211, v27, v211
 v_mfma_f32_16x16x32_bf16 v[60:63], v[148:151], v[116:119], v[60:63]
 v_cvt_pk_f16_f32 v42, v42, v43
 v_accvgpr_write_b32 a7, v211
 v_lshlrev_b32 v27, 16, v212
 v_and_b32 v212, 0xffff0000, v212
 s_waitcnt lgkmcnt(2)
 v_mfma_f32_16x16x32_bf16 v[44:47], v[136:139], v[72:75], v[44:47]
 ds_read_b128 v[148:151], v23 offset:1792
 v_accvgpr_write_b32 a193, v42
 v_cvt_pk_f16_f32 v212, v27, v212
 v_accvgpr_write_b32 a24, v212
 v_lshlrev_b32 v27, 16, v213
 v_mfma_f32_16x16x32_bf16 v[52:55], v[136:139], v[96:99], v[52:55]
 v_cvt_pk_f16_f32 v48, v48, v49
 v_and_b32 v213, 0xffff0000, v213
 v_cvt_pk_f16_f32 v213, v27, v213
 v_accvgpr_write_b32 a25, v213
 v_lshlrev_b32 v27, 16, v214
 v_mfma_f32_16x16x32_bf16 v[60:63], v[136:139], v[120:123], v[60:63]
 v_accvgpr_write_b32 a200, v48
 v_and_b32 v214, 0xffff0000, v214
 v_cvt_pk_f16_f32 v214, v27, v214
 v_accvgpr_write_b32 a26, v214
 s_waitcnt lgkmcnt(2)
 v_mfma_f32_16x16x32_bf16 v[44:47], v[140:143], v[76:79], v[44:47]
 s_waitcnt vmcnt(18)
 ds_read_b128 v[136:139], v22 offset:12288
 v_cvt_pk_f16_f32 v50, v50, v51
 v_lshlrev_b32 v27, 16, v215
 v_and_b32 v215, 0xffff0000, v215
 v_cvt_pk_f16_f32 v215, v27, v215
 v_mfma_f32_16x16x32_bf16 v[52:55], v[140:143], v[100:103], v[52:55]
 v_accvgpr_write_b32 a201, v50
 v_accvgpr_write_b32 a27, v215
 v_lshlrev_b32 v27, 16, v216
 v_and_b32 v216, 0xffff0000, v216
 v_cvt_pk_f16_f32 v216, v27, v216
 v_mfma_f32_16x16x32_bf16 v[60:63], v[140:143], v[124:127], v[60:63]
 v_cvt_pk_f16_f32 v56, v56, v57
 v_accvgpr_write_b32 a44, v216
 v_lshlrev_b32 v27, 16, v217
 v_and_b32 v217, 0xffff0000, v217
 s_waitcnt lgkmcnt(2)
 v_mfma_f32_16x16x32_bf16 v[44:47], v[144:147], v[80:83], v[44:47]
 ds_read_b128 v[140:143], v23 offset:12288
 v_accvgpr_write_b32 a208, v56
 v_cvt_pk_f16_f32 v217, v27, v217
 v_accvgpr_write_b32 a45, v217
 v_lshlrev_b32 v27, 16, v218
 v_mfma_f32_16x16x32_bf16 v[52:55], v[144:147], v[104:107], v[52:55]
 v_cvt_pk_f16_f32 v58, v58, v59
 v_and_b32 v218, 0xffff0000, v218
 v_cvt_pk_f16_f32 v218, v27, v218
 v_accvgpr_write_b32 a46, v218
 v_lshlrev_b32 v27, 16, v219
 v_mfma_f32_16x16x32_bf16 v[60:63], v[144:147], v[128:131], v[60:63]
 v_accvgpr_write_b32 a209, v58
 v_and_b32 v219, 0xffff0000, v219
 v_cvt_pk_f16_f32 v219, v27, v219
 v_accvgpr_write_b32 a47, v219
 s_waitcnt lgkmcnt(2)
 v_mfma_f32_16x16x32_bf16 v[44:47], v[148:151], v[84:87], v[44:47]
 ds_read_b128 v[144:147], v22 offset:12416
 s_add_u32 m0, s81, 0
 s_add_u32 s21, s88, 4915200
 v_mfma_f32_16x16x32_bf16 v[52:55], v[148:151], v[108:111], v[52:55]
 buffer_load_dwordx4 v28, s[12:15], s21 offen offset:0 lds
 v_mfma_f32_16x16x32_bf16 v[60:63], v[148:151], v[132:135], v[60:63]
 buffer_load_dwordx4 v29, s[12:15], s21 offen offset:1024 lds
 s_waitcnt lgkmcnt(2)
 v_mfma_f32_16x16x32_bf16 v[40:43], v[136:139], v[64:67], 0
 ds_read_b128 v[148:151], v23 offset:12416
 buffer_load_dwordx4 v30, s[12:15], s21 offen offset:2048 lds
 s_waitcnt vmcnt(18)
 v_mfma_f32_16x16x32_bf16 v[48:51], v[136:139], v[88:91], 0
 s_add_u32 m0, s81, 3072
 s_add_u32 s21, s88, 4964352
 ds_write_b128 v251, v[232:235] offset:36864
 v_mfma_f32_16x16x32_bf16 v[56:59], v[136:139], v[112:115], 0
 buffer_load_dwordx4 v31, s[12:15], s21 offen offset:0 lds
 ds_write_b128 v251, v[236:239] offset:37888
 s_waitcnt lgkmcnt(4)
 v_mfma_f32_16x16x32_bf16 v[40:43], v[140:143], v[68:71], v[40:43]
 ds_read_b128 v[136:139], v22 offset:12544
 v_cvt_pk_f16_f32 v44, v44, v45
 buffer_load_dwordx4 v32, s[12:15], s21 offen offset:1024 lds
 v_accvgpr_write_b32 a194, v44
 v_mfma_f32_16x16x32_bf16 v[48:51], v[140:143], v[92:95], v[48:51]
 v_cvt_pk_f16_f32 v46, v46, v47
 buffer_load_dwordx4 v33, s[12:15], s21 offen offset:2048 lds
 ds_write_b128 v251, v[240:243] offset:38912
 v_mfma_f32_16x16x32_bf16 v[56:59], v[140:143], v[116:119], v[56:59]
 v_accvgpr_write_b32 a195, v46
 s_add_u32 m0, s81, 6144
 s_add_u32 s21, s88, 5406720
 ds_read_b64_tr_b16 v[208:209], v250 offset:36864
 s_waitcnt lgkmcnt(6)
 v_mfma_f32_16x16x32_bf16 v[40:43], v[144:147], v[72:75], v[40:43]
 ds_read_b128 v[140:143], v23 offset:12544
 v_cvt_pk_f16_f32 v52, v52, v53
 buffer_load_dwordx4 v34, s[12:15], s21 offen offset:0 lds
 ds_read_b64_tr_b16 v[210:211], v250 offset:37248
 v_mfma_f32_16x16x32_bf16 v[48:51], v[144:147], v[96:99], v[48:51]
 v_accvgpr_write_b32 a202, v52
 buffer_load_dwordx4 v35, s[12:15], s21 offen offset:1024 lds
 ds_read_b64_tr_b16 v[212:213], v250 offset:36896
 ds_read_b64_tr_b16 v[214:215], v250 offset:37280
 v_mfma_f32_16x16x32_bf16 v[56:59], v[144:147], v[120:123], v[56:59]
 v_cvt_pk_f16_f32 v54, v54, v55
 buffer_load_dwordx4 v36, s[12:15], s21 offen offset:2048 lds
 ds_read_b64_tr_b16 v[216:217], v250 offset:36928
 s_waitcnt lgkmcnt(10)
 v_mfma_f32_16x16x32_bf16 v[40:43], v[148:151], v[76:79], v[40:43]
 ds_read_b128 v[144:147], v22 offset:13824
 v_accvgpr_write_b32 a203, v54
 s_add_u32 m0, s81, 9216
 s_add_u32 s21, s88, 5455872
 ds_read_b64_tr_b16 v[218:219], v250 offset:37312
 v_mfma_f32_16x16x32_bf16 v[48:51], v[148:151], v[100:103], v[48:51]
 v_cvt_pk_f16_f32 v60, v60, v61
 buffer_load_dwordx4 v37, s[12:15], s21 offen offset:0 lds
 s_add_u32 s22, s80, 196608
 v_accvgpr_write_b32 a210, v60
 v_mfma_f32_16x16x32_bf16 v[56:59], v[148:151], v[124:127], v[56:59]
 v_cvt_pk_f16_f32 v62, v62, v63
 buffer_load_dwordx4 v38, s[12:15], s21 offen offset:1024 lds
 v_accvgpr_write_b32 a211, v62
 s_waitcnt lgkmcnt(9)
 v_mfma_f32_16x16x32_bf16 v[40:43], v[136:139], v[80:83], v[40:43]
 ds_read_b128 v[148:151], v23 offset:13824
 buffer_load_dwordx4 v39, s[12:15], s21 offen offset:2048 lds
 buffer_load_dwordx4 v[232:235], v247, s[36:39], s22 offen
 v_mfma_f32_16x16x32_bf16 v[48:51], v[136:139], v[104:107], v[48:51]
 buffer_load_dwordx4 v[236:239], v248, s[36:39], s22 offen
 buffer_load_dwordx4 v[240:243], v249, s[36:39], s22 offen
 v_mfma_f32_16x16x32_bf16 v[56:59], v[136:139], v[128:131], v[56:59]
 s_waitcnt lgkmcnt(7)
 v_mfma_f32_16x16x32_bf16 v[40:43], v[140:143], v[84:87], v[40:43]
 ds_read_b128 v[136:139], v22 offset:13952
 v_mfma_f32_16x16x32_bf16 v[48:51], v[140:143], v[108:111], v[48:51]
 v_mfma_f32_16x16x32_bf16 v[56:59], v[140:143], v[132:135], v[56:59]
 s_waitcnt lgkmcnt(3)
 v_mfma_f32_16x16x32_bf16 v[44:47], v[144:147], v[64:67], 0
 ds_read_b128 v[140:143], v23 offset:13952
 v_mfma_f32_16x16x32_bf16 v[52:55], v[144:147], v[88:91], 0
 s_waitcnt lgkmcnt(3)
 v_lshlrev_b32 v27, 16, v208
 v_and_b32 v208, 0xffff0000, v208
 v_cvt_pk_f16_f32 v208, v27, v208
 v_accvgpr_write_b32 a8, v208
 v_mfma_f32_16x16x32_bf16 v[60:63], v[144:147], v[112:115], 0
 v_lshlrev_b32 v27, 16, v209
 v_and_b32 v209, 0xffff0000, v209
 v_cvt_pk_f16_f32 v209, v27, v209
 v_accvgpr_write_b32 a9, v209
 s_waitcnt lgkmcnt(2)
 v_mfma_f32_16x16x32_bf16 v[44:47], v[148:151], v[68:71], v[44:47]
 ds_read_b128 v[144:147], v22 offset:14080
 v_cvt_pk_f16_f32 v40, v40, v41
 v_lshlrev_b32 v27, 16, v210
 v_and_b32 v210, 0xffff0000, v210
 v_cvt_pk_f16_f32 v210, v27, v210
 v_mfma_f32_16x16x32_bf16 v[52:55], v[148:151], v[92:95], v[52:55]
 v_accvgpr_write_b32 a196, v40
 v_accvgpr_write_b32 a10, v210
 v_lshlrev_b32 v27, 16, v211
 v_and_b32 v211, 0xffff0000, v211
 v_cvt_pk_f16_f32 v211, v27, v211
 v_mfma_f32_16x16x32_bf16 v[60:63], v[148:151], v[116:119], v[60:63]
 v_cvt_pk_f16_f32 v42, v42, v43
 v_accvgpr_write_b32 a11, v211
 v_lshlrev_b32 v27, 16, v212
 v_and_b32 v212, 0xffff0000, v212
 s_waitcnt lgkmcnt(2)
 v_mfma_f32_16x16x32_bf16 v[44:47], v[136:139], v[72:75], v[44:47]
 ds_read_b128 v[148:151], v23 offset:14080
 v_accvgpr_write_b32 a197, v42
 v_cvt_pk_f16_f32 v212, v27, v212
 v_accvgpr_write_b32 a28, v212
 v_lshlrev_b32 v27, 16, v213
 v_mfma_f32_16x16x32_bf16 v[52:55], v[136:139], v[96:99], v[52:55]
 v_cvt_pk_f16_f32 v48, v48, v49
 v_and_b32 v213, 0xffff0000, v213
 v_cvt_pk_f16_f32 v213, v27, v213
 v_accvgpr_write_b32 a29, v213
 v_lshlrev_b32 v27, 16, v214
 v_mfma_f32_16x16x32_bf16 v[60:63], v[136:139], v[120:123], v[60:63]
 v_accvgpr_write_b32 a204, v48
 v_and_b32 v214, 0xffff0000, v214
 v_cvt_pk_f16_f32 v214, v27, v214
 v_accvgpr_write_b32 a30, v214
 s_waitcnt lgkmcnt(2)
 v_mfma_f32_16x16x32_bf16 v[44:47], v[140:143], v[76:79], v[44:47]
 s_waitcnt vmcnt(18)
 ds_read_b128 v[136:139], v22 offset:24576
 v_cvt_pk_f16_f32 v50, v50, v51
 v_lshlrev_b32 v27, 16, v215
 v_and_b32 v215, 0xffff0000, v215
 v_cvt_pk_f16_f32 v215, v27, v215
 v_mfma_f32_16x16x32_bf16 v[52:55], v[140:143], v[100:103], v[52:55]
 v_accvgpr_write_b32 a205, v50
 v_accvgpr_write_b32 a31, v215
 v_lshlrev_b32 v27, 16, v216
 v_and_b32 v216, 0xffff0000, v216
 v_cvt_pk_f16_f32 v216, v27, v216
 v_mfma_f32_16x16x32_bf16 v[60:63], v[140:143], v[124:127], v[60:63]
 v_cvt_pk_f16_f32 v56, v56, v57
 v_accvgpr_write_b32 a48, v216
 v_lshlrev_b32 v27, 16, v217
 v_and_b32 v217, 0xffff0000, v217
 s_waitcnt lgkmcnt(2)
 v_mfma_f32_16x16x32_bf16 v[44:47], v[144:147], v[80:83], v[44:47]
 ds_read_b128 v[140:143], v23 offset:24576
 v_accvgpr_write_b32 a212, v56
 v_cvt_pk_f16_f32 v217, v27, v217
 v_accvgpr_write_b32 a49, v217
 v_lshlrev_b32 v27, 16, v218
 v_mfma_f32_16x16x32_bf16 v[52:55], v[144:147], v[104:107], v[52:55]
 v_cvt_pk_f16_f32 v58, v58, v59
 v_and_b32 v218, 0xffff0000, v218
 v_cvt_pk_f16_f32 v218, v27, v218
 v_accvgpr_write_b32 a50, v218
 v_lshlrev_b32 v27, 16, v219
 v_mfma_f32_16x16x32_bf16 v[60:63], v[144:147], v[128:131], v[60:63]
 v_accvgpr_write_b32 a213, v58
 v_and_b32 v219, 0xffff0000, v219
 v_cvt_pk_f16_f32 v219, v27, v219
 v_accvgpr_write_b32 a51, v219
 s_waitcnt lgkmcnt(2)
 v_mfma_f32_16x16x32_bf16 v[44:47], v[148:151], v[84:87], v[44:47]
 ds_read_b128 v[144:147], v22 offset:24704
 s_add_u32 m0, s81, 12288
 s_add_u32 s21, s88, 4030464
 v_mfma_f32_16x16x32_bf16 v[52:55], v[148:151], v[108:111], v[52:55]
 buffer_load_dwordx4 v28, s[12:15], s21 offen offset:0 lds
 v_mfma_f32_16x16x32_bf16 v[60:63], v[148:151], v[132:135], v[60:63]
 buffer_load_dwordx4 v29, s[12:15], s21 offen offset:1024 lds
 s_waitcnt lgkmcnt(2)
 v_mfma_f32_16x16x32_bf16 v[40:43], v[136:139], v[64:67], 0
 ds_read_b128 v[148:151], v23 offset:24704
 buffer_load_dwordx4 v30, s[12:15], s21 offen offset:2048 lds
 s_waitcnt vmcnt(18)
 v_mfma_f32_16x16x32_bf16 v[48:51], v[136:139], v[88:91], 0
 s_add_u32 m0, s81, 15360
 s_add_u32 s21, s88, 4079616
 ds_write_b128 v251, v[220:223] offset:36864
 v_mfma_f32_16x16x32_bf16 v[56:59], v[136:139], v[112:115], 0
 buffer_load_dwordx4 v31, s[12:15], s21 offen offset:0 lds
 ds_write_b128 v251, v[224:227] offset:37888
 s_waitcnt lgkmcnt(4)
 v_mfma_f32_16x16x32_bf16 v[40:43], v[140:143], v[68:71], v[40:43]
 ds_read_b128 v[136:139], v22 offset:24832
 v_cvt_pk_f16_f32 v44, v44, v45
 buffer_load_dwordx4 v32, s[12:15], s21 offen offset:1024 lds
 v_accvgpr_write_b32 a198, v44
 v_mfma_f32_16x16x32_bf16 v[48:51], v[140:143], v[92:95], v[48:51]
 v_cvt_pk_f16_f32 v46, v46, v47
 buffer_load_dwordx4 v33, s[12:15], s21 offen offset:2048 lds
 ds_write_b128 v251, v[228:231] offset:38912
 v_mfma_f32_16x16x32_bf16 v[56:59], v[140:143], v[116:119], v[56:59]
 v_accvgpr_write_b32 a199, v46
 s_add_u32 m0, s81, 18432
 s_add_u32 s21, s88, 4521984
 ds_read_b64_tr_b16 v[208:209], v250 offset:36864
 s_waitcnt lgkmcnt(6)
 v_mfma_f32_16x16x32_bf16 v[40:43], v[144:147], v[72:75], v[40:43]
 ds_read_b128 v[140:143], v23 offset:24832
 v_cvt_pk_f16_f32 v52, v52, v53
 buffer_load_dwordx4 v34, s[12:15], s21 offen offset:0 lds
 ds_read_b64_tr_b16 v[210:211], v250 offset:37248
 v_mfma_f32_16x16x32_bf16 v[48:51], v[144:147], v[96:99], v[48:51]
 v_accvgpr_write_b32 a206, v52
 buffer_load_dwordx4 v35, s[12:15], s21 offen offset:1024 lds
 ds_read_b64_tr_b16 v[212:213], v250 offset:36896
 ds_read_b64_tr_b16 v[214:215], v250 offset:37280
 v_mfma_f32_16x16x32_bf16 v[56:59], v[144:147], v[120:123], v[56:59]
 v_cvt_pk_f16_f32 v54, v54, v55
 buffer_load_dwordx4 v36, s[12:15], s21 offen offset:2048 lds
 ds_read_b64_tr_b16 v[216:217], v250 offset:36928
 s_waitcnt lgkmcnt(10)
 v_mfma_f32_16x16x32_bf16 v[40:43], v[148:151], v[76:79], v[40:43]
 ds_read_b128 v[144:147], v22 offset:26112
 v_accvgpr_write_b32 a207, v54
 s_add_u32 m0, s81, 21504
 s_add_u32 s21, s88, 4571136
 ds_read_b64_tr_b16 v[218:219], v250 offset:37312
 v_mfma_f32_16x16x32_bf16 v[48:51], v[148:151], v[100:103], v[48:51]
 v_cvt_pk_f16_f32 v60, v60, v61
 buffer_load_dwordx4 v37, s[12:15], s21 offen offset:0 lds
 v_accvgpr_write_b32 a214, v60
 v_mfma_f32_16x16x32_bf16 v[56:59], v[148:151], v[124:127], v[56:59]
 v_cvt_pk_f16_f32 v62, v62, v63
 buffer_load_dwordx4 v38, s[12:15], s21 offen offset:1024 lds
 v_accvgpr_write_b32 a215, v62
 s_waitcnt lgkmcnt(9)
 v_mfma_f32_16x16x32_bf16 v[40:43], v[136:139], v[80:83], v[40:43]
 ds_read_b128 v[148:151], v23 offset:26112
 buffer_load_dwordx4 v39, s[12:15], s21 offen offset:2048 lds
 v_mfma_f32_16x16x32_bf16 v[48:51], v[136:139], v[104:107], v[48:51]
 buffer_load_dword v0, v26, s[32:35], 0 offen sc1
 v_mfma_f32_16x16x32_bf16 v[56:59], v[136:139], v[128:131], v[56:59]
 s_waitcnt lgkmcnt(7)
 v_mfma_f32_16x16x32_bf16 v[40:43], v[140:143], v[84:87], v[40:43]
 ds_read_b128 v[136:139], v22 offset:26240
 v_mfma_f32_16x16x32_bf16 v[48:51], v[140:143], v[108:111], v[48:51]
 s_waitcnt lgkmcnt(2)
 v_lshlrev_b32 v27, 16, v208
 v_and_b32 v208, 0xffff0000, v208
 v_cvt_pk_f16_f32 v208, v27, v208
 v_accvgpr_write_b32 a12, v208
 v_mfma_f32_16x16x32_bf16 v[56:59], v[140:143], v[132:135], v[56:59]
 v_lshlrev_b32 v27, 16, v209
 v_and_b32 v209, 0xffff0000, v209
 v_cvt_pk_f16_f32 v209, v27, v209
 v_accvgpr_write_b32 a13, v209
 s_waitcnt lgkmcnt(3)
 v_mfma_f32_16x16x32_bf16 v[44:47], v[144:147], v[64:67], 0
 ds_read_b128 v[140:143], v23 offset:26240
 v_lshlrev_b32 v27, 16, v210
 v_and_b32 v210, 0xffff0000, v210
 v_cvt_pk_f16_f32 v210, v27, v210
 v_accvgpr_write_b32 a14, v210
 v_mfma_f32_16x16x32_bf16 v[52:55], v[144:147], v[88:91], 0
 v_lshlrev_b32 v27, 16, v211
 v_and_b32 v211, 0xffff0000, v211
 v_cvt_pk_f16_f32 v211, v27, v211
 v_accvgpr_write_b32 a15, v211
 v_lshlrev_b32 v27, 16, v212
 v_mfma_f32_16x16x32_bf16 v[60:63], v[144:147], v[112:115], 0
 v_and_b32 v212, 0xffff0000, v212
 v_cvt_pk_f16_f32 v212, v27, v212
 v_accvgpr_write_b32 a32, v212
 v_lshlrev_b32 v27, 16, v213
 s_waitcnt lgkmcnt(2)
 v_mfma_f32_16x16x32_bf16 v[44:47], v[148:151], v[68:71], v[44:47]
 ds_read_b128 v[144:147], v22 offset:26368
 v_cvt_pk_f16_f32 v40, v40, v41
 v_and_b32 v213, 0xffff0000, v213
 v_cvt_pk_f16_f32 v213, v27, v213
 v_accvgpr_write_b32 a33, v213
 v_mfma_f32_16x16x32_bf16 v[52:55], v[148:151], v[92:95], v[52:55]
 v_accvgpr_write_b32 a216, v40
 v_lshlrev_b32 v27, 16, v214
 v_and_b32 v214, 0xffff0000, v214
 v_cvt_pk_f16_f32 v214, v27, v214
 v_accvgpr_write_b32 a34, v214
 v_mfma_f32_16x16x32_bf16 v[60:63], v[148:151], v[116:119], v[60:63]
 v_cvt_pk_f16_f32 v42, v42, v43
 v_lshlrev_b32 v27, 16, v215
 v_and_b32 v215, 0xffff0000, v215
 v_cvt_pk_f16_f32 v215, v27, v215
 s_waitcnt lgkmcnt(2)
 v_mfma_f32_16x16x32_bf16 v[44:47], v[136:139], v[72:75], v[44:47]
 ds_read_b128 v[148:151], v23 offset:26368
 v_accvgpr_write_b32 a217, v42
 v_accvgpr_write_b32 a35, v215
 v_lshlrev_b32 v27, 16, v216
 v_and_b32 v216, 0xffff0000, v216
 v_mfma_f32_16x16x32_bf16 v[52:55], v[136:139], v[96:99], v[52:55]
 v_cvt_pk_f16_f32 v48, v48, v49
 v_cvt_pk_f16_f32 v216, v27, v216
 v_accvgpr_write_b32 a52, v216
 v_lshlrev_b32 v27, 16, v217
 v_and_b32 v217, 0xffff0000, v217
 v_mfma_f32_16x16x32_bf16 v[60:63], v[136:139], v[120:123], v[60:63]
 v_accvgpr_write_b32 a224, v48
 v_cvt_pk_f16_f32 v217, v27, v217
 v_accvgpr_write_b32 a53, v217
 v_lshlrev_b32 v27, 16, v218
 s_waitcnt lgkmcnt(2)
 v_mfma_f32_16x16x32_bf16 v[44:47], v[140:143], v[76:79], v[44:47]
 s_waitcnt vmcnt(16)
 ds_read_b128 v[136:139], v22 offset:0
 v_cvt_pk_f16_f32 v50, v50, v51
 v_and_b32 v218, 0xffff0000, v218
 v_cvt_pk_f16_f32 v218, v27, v218
 v_accvgpr_write_b32 a54, v218
 v_mfma_f32_16x16x32_bf16 v[52:55], v[140:143], v[100:103], v[52:55]
 v_accvgpr_write_b32 a225, v50
 v_lshlrev_b32 v27, 16, v219
 v_and_b32 v219, 0xffff0000, v219
 v_cvt_pk_f16_f32 v219, v27, v219
 v_accvgpr_write_b32 a55, v219
 v_mfma_f32_16x16x32_bf16 v[60:63], v[140:143], v[124:127], v[60:63]
 v_cvt_pk_f16_f32 v56, v56, v57
 v_accvgpr_write_b32 a232, v56
 v_cvt_pk_f16_f32 v58, v58, v59
 v_accvgpr_write_b32 a233, v58
 s_waitcnt lgkmcnt(2)
 v_mfma_f32_16x16x32_bf16 v[44:47], v[144:147], v[80:83], v[44:47]
 ds_read_b128 v[140:143], v23 offset:0
 v_mfma_f32_16x16x32_bf16 v[52:55], v[144:147], v[104:107], v[52:55]
 v_mfma_f32_16x16x32_bf16 v[60:63], v[144:147], v[128:131], v[60:63]
 s_waitcnt lgkmcnt(2)
 v_mfma_f32_16x16x32_bf16 v[44:47], v[148:151], v[84:87], v[44:47]
 ds_read_b128 v[144:147], v22 offset:128
 s_add_u32 m0, s81, 24576
 s_add_u32 s21, s88, 5013504
 v_mfma_f32_16x16x32_bf16 v[52:55], v[148:151], v[108:111], v[52:55]
 buffer_load_dwordx4 v28, s[12:15], s21 offen offset:0 lds
 v_mfma_f32_16x16x32_bf16 v[60:63], v[148:151], v[132:135], v[60:63]
 buffer_load_dwordx4 v29, s[12:15], s21 offen offset:1024 lds
 s_waitcnt lgkmcnt(2)
 v_mfma_f32_16x16x32_bf16 v[40:43], v[136:139], v[64:67], 0
 ds_read_b128 v[148:151], v23 offset:128
 buffer_load_dwordx4 v30, s[12:15], s21 offen offset:2048 lds
 s_waitcnt vmcnt(16)
 v_mfma_f32_16x16x32_bf16 v[48:51], v[136:139], v[88:91], 0
 s_add_u32 m0, s81, 27648
 s_add_u32 s21, s88, 5062656
 ds_write_b128 v251, v[232:235] offset:36864
 v_mfma_f32_16x16x32_bf16 v[56:59], v[136:139], v[112:115], 0
 buffer_load_dwordx4 v31, s[12:15], s21 offen offset:0 lds
 ds_write_b128 v251, v[236:239] offset:37888
 s_waitcnt lgkmcnt(4)
 v_mfma_f32_16x16x32_bf16 v[40:43], v[140:143], v[68:71], v[40:43]
 ds_read_b128 v[136:139], v22 offset:256
 v_cvt_pk_f16_f32 v44, v44, v45
 buffer_load_dwordx4 v32, s[12:15], s21 offen offset:1024 lds
 v_accvgpr_write_b32 a218, v44
 v_mfma_f32_16x16x32_bf16 v[48:51], v[140:143], v[92:95], v[48:51]
 v_cvt_pk_f16_f32 v46, v46, v47
 buffer_load_dwordx4 v33, s[12:15], s21 offen offset:2048 lds
 ds_write_b128 v251, v[240:243] offset:38912
 v_mfma_f32_16x16x32_bf16 v[56:59], v[140:143], v[116:119], v[56:59]
 v_accvgpr_write_b32 a219, v46
 s_add_u32 m0, s81, 30720
 s_add_u32 s21, s88, 5505024
 ds_read_b64_tr_b16 v[208:209], v250 offset:36864
 s_waitcnt lgkmcnt(6)
 v_mfma_f32_16x16x32_bf16 v[40:43], v[144:147], v[72:75], v[40:43]
 ds_read_b128 v[140:143], v23 offset:256
 v_cvt_pk_f16_f32 v52, v52, v53
 buffer_load_dwordx4 v34, s[12:15], s21 offen offset:0 lds
 ds_read_b64_tr_b16 v[210:211], v250 offset:37248
 v_mfma_f32_16x16x32_bf16 v[48:51], v[144:147], v[96:99], v[48:51]
 v_accvgpr_write_b32 a226, v52
 buffer_load_dwordx4 v35, s[12:15], s21 offen offset:1024 lds
 ds_read_b64_tr_b16 v[212:213], v250 offset:36896
 ds_read_b64_tr_b16 v[214:215], v250 offset:37280
 v_mfma_f32_16x16x32_bf16 v[56:59], v[144:147], v[120:123], v[56:59]
 v_cvt_pk_f16_f32 v54, v54, v55
 buffer_load_dwordx4 v36, s[12:15], s21 offen offset:2048 lds
 ds_read_b64_tr_b16 v[216:217], v250 offset:36928
 s_waitcnt lgkmcnt(10)
 v_mfma_f32_16x16x32_bf16 v[40:43], v[148:151], v[76:79], v[40:43]
 ds_read_b128 v[144:147], v22 offset:1536
 v_accvgpr_write_b32 a227, v54
 s_add_u32 m0, s81, 33792
 s_add_u32 s21, s88, 5554176
 ds_read_b64_tr_b16 v[218:219], v250 offset:37312
 v_mfma_f32_16x16x32_bf16 v[48:51], v[148:151], v[100:103], v[48:51]
 v_cvt_pk_f16_f32 v60, v60, v61
 buffer_load_dwordx4 v37, s[12:15], s21 offen offset:0 lds
 v_accvgpr_write_b32 a234, v60
 v_mfma_f32_16x16x32_bf16 v[56:59], v[148:151], v[124:127], v[56:59]
 v_cvt_pk_f16_f32 v62, v62, v63
 buffer_load_dwordx4 v38, s[12:15], s21 offen offset:1024 lds
 v_accvgpr_write_b32 a235, v62
 s_waitcnt lgkmcnt(9)
 v_mfma_f32_16x16x32_bf16 v[40:43], v[136:139], v[80:83], v[40:43]
 ds_read_b128 v[148:151], v23 offset:1536
 buffer_load_dwordx4 v39, s[12:15], s21 offen offset:2048 lds
 v_mfma_f32_16x16x32_bf16 v[48:51], v[136:139], v[104:107], v[48:51]
 v_mfma_f32_16x16x32_bf16 v[56:59], v[136:139], v[128:131], v[56:59]
 s_waitcnt lgkmcnt(7)
 v_mfma_f32_16x16x32_bf16 v[40:43], v[140:143], v[84:87], v[40:43]
 ds_read_b128 v[136:139], v22 offset:1664
 v_mfma_f32_16x16x32_bf16 v[48:51], v[140:143], v[108:111], v[48:51]
 s_waitcnt lgkmcnt(2)
 v_lshlrev_b32 v27, 16, v208
 v_and_b32 v208, 0xffff0000, v208
 v_cvt_pk_f16_f32 v208, v27, v208
 v_accvgpr_write_b32 a16, v208
 v_mfma_f32_16x16x32_bf16 v[56:59], v[140:143], v[132:135], v[56:59]
 v_lshlrev_b32 v27, 16, v209
 v_and_b32 v209, 0xffff0000, v209
 v_cvt_pk_f16_f32 v209, v27, v209
 v_accvgpr_write_b32 a17, v209
 s_waitcnt lgkmcnt(3)
 v_mfma_f32_16x16x32_bf16 v[44:47], v[144:147], v[64:67], 0
 ds_read_b128 v[140:143], v23 offset:1664
 v_lshlrev_b32 v27, 16, v210
 v_and_b32 v210, 0xffff0000, v210
 v_cvt_pk_f16_f32 v210, v27, v210
 v_accvgpr_write_b32 a18, v210
 v_mfma_f32_16x16x32_bf16 v[52:55], v[144:147], v[88:91], 0
 v_lshlrev_b32 v27, 16, v211
 v_and_b32 v211, 0xffff0000, v211
 v_cvt_pk_f16_f32 v211, v27, v211
 v_accvgpr_write_b32 a19, v211
 v_lshlrev_b32 v27, 16, v212
 v_mfma_f32_16x16x32_bf16 v[60:63], v[144:147], v[112:115], 0
 v_and_b32 v212, 0xffff0000, v212
 v_cvt_pk_f16_f32 v212, v27, v212
 v_accvgpr_write_b32 a36, v212
 v_lshlrev_b32 v27, 16, v213
 s_waitcnt lgkmcnt(2)
 v_mfma_f32_16x16x32_bf16 v[44:47], v[148:151], v[68:71], v[44:47]
 ds_read_b128 v[144:147], v22 offset:1792
 v_cvt_pk_f16_f32 v40, v40, v41
 v_and_b32 v213, 0xffff0000, v213
 v_cvt_pk_f16_f32 v213, v27, v213
 v_accvgpr_write_b32 a37, v213
 v_mfma_f32_16x16x32_bf16 v[52:55], v[148:151], v[92:95], v[52:55]
 v_accvgpr_write_b32 a220, v40
 v_lshlrev_b32 v27, 16, v214
 v_and_b32 v214, 0xffff0000, v214
 v_cvt_pk_f16_f32 v214, v27, v214
 v_accvgpr_write_b32 a38, v214
 v_mfma_f32_16x16x32_bf16 v[60:63], v[148:151], v[116:119], v[60:63]
 v_cvt_pk_f16_f32 v42, v42, v43
 v_lshlrev_b32 v27, 16, v215
 v_and_b32 v215, 0xffff0000, v215
 v_cvt_pk_f16_f32 v215, v27, v215
 s_waitcnt lgkmcnt(2)
 v_mfma_f32_16x16x32_bf16 v[44:47], v[136:139], v[72:75], v[44:47]
 ds_read_b128 v[148:151], v23 offset:1792
 v_accvgpr_write_b32 a221, v42
 v_accvgpr_write_b32 a39, v215
 v_lshlrev_b32 v27, 16, v216
 v_and_b32 v216, 0xffff0000, v216
 v_mfma_f32_16x16x32_bf16 v[52:55], v[136:139], v[96:99], v[52:55]
 v_cvt_pk_f16_f32 v48, v48, v49
 v_cvt_pk_f16_f32 v216, v27, v216
 v_accvgpr_write_b32 a56, v216
 v_lshlrev_b32 v27, 16, v217
 v_and_b32 v217, 0xffff0000, v217
 v_mfma_f32_16x16x32_bf16 v[60:63], v[136:139], v[120:123], v[60:63]
 v_accvgpr_write_b32 a228, v48
 v_cvt_pk_f16_f32 v217, v27, v217
 v_accvgpr_write_b32 a57, v217
 v_lshlrev_b32 v27, 16, v218
 s_waitcnt lgkmcnt(2)
 v_mfma_f32_16x16x32_bf16 v[44:47], v[140:143], v[76:79], v[44:47]
 s_waitcnt vmcnt(13)
 ds_read_b128 v[136:139], v22 offset:12288
 v_cvt_pk_f16_f32 v50, v50, v51
 v_and_b32 v218, 0xffff0000, v218
 v_cvt_pk_f16_f32 v218, v27, v218
 v_accvgpr_write_b32 a58, v218
 v_mfma_f32_16x16x32_bf16 v[52:55], v[140:143], v[100:103], v[52:55]
 v_accvgpr_write_b32 a229, v50
 v_lshlrev_b32 v27, 16, v219
 v_and_b32 v219, 0xffff0000, v219
 v_cvt_pk_f16_f32 v219, v27, v219
 v_accvgpr_write_b32 a59, v219
 v_mfma_f32_16x16x32_bf16 v[60:63], v[140:143], v[124:127], v[60:63]
 v_cvt_pk_f16_f32 v56, v56, v57
 v_accvgpr_write_b32 a236, v56
 v_cvt_pk_f16_f32 v58, v58, v59
 v_accvgpr_write_b32 a237, v58
 s_waitcnt lgkmcnt(2)
 v_mfma_f32_16x16x32_bf16 v[44:47], v[144:147], v[80:83], v[44:47]
 ds_read_b128 v[140:143], v23 offset:12288
 v_mfma_f32_16x16x32_bf16 v[52:55], v[144:147], v[104:107], v[52:55]
 v_mfma_f32_16x16x32_bf16 v[60:63], v[144:147], v[128:131], v[60:63]
 s_waitcnt lgkmcnt(2)
 v_mfma_f32_16x16x32_bf16 v[44:47], v[148:151], v[84:87], v[44:47]
 ds_read_b128 v[144:147], v22 offset:12416
 s_add_u32 m0, s81, 0
 s_add_u32 s21, s88, 5898240
 v_mfma_f32_16x16x32_bf16 v[52:55], v[148:151], v[108:111], v[52:55]
 buffer_load_dwordx4 v28, s[12:15], s21 offen offset:0 lds
 v_mfma_f32_16x16x32_bf16 v[60:63], v[148:151], v[132:135], v[60:63]
 buffer_load_dwordx4 v29, s[12:15], s21 offen offset:1024 lds
 s_waitcnt lgkmcnt(2)
 v_mfma_f32_16x16x32_bf16 v[40:43], v[136:139], v[64:67], 0
 ds_read_b128 v[148:151], v23 offset:12416
 buffer_load_dwordx4 v30, s[12:15], s21 offen offset:2048 lds
 v_mfma_f32_16x16x32_bf16 v[48:51], v[136:139], v[88:91], 0
 s_add_u32 m0, s81, 3072
 s_add_u32 s21, s88, 5947392
 v_mfma_f32_16x16x32_bf16 v[56:59], v[136:139], v[112:115], 0
 buffer_load_dwordx4 v31, s[12:15], s21 offen offset:0 lds
 s_waitcnt lgkmcnt(2)
 v_mfma_f32_16x16x32_bf16 v[40:43], v[140:143], v[68:71], v[40:43]
 ds_read_b128 v[136:139], v22 offset:12544
 v_cvt_pk_f16_f32 v44, v44, v45
 buffer_load_dwordx4 v32, s[12:15], s21 offen offset:1024 lds
 v_accvgpr_write_b32 a222, v44
 v_mfma_f32_16x16x32_bf16 v[48:51], v[140:143], v[92:95], v[48:51]
 v_cvt_pk_f16_f32 v46, v46, v47
 buffer_load_dwordx4 v33, s[12:15], s21 offen offset:2048 lds
 v_accvgpr_write_b32 a223, v46
 v_cvt_pk_f16_f32 v52, v52, v53
 v_mfma_f32_16x16x32_bf16 v[56:59], v[140:143], v[116:119], v[56:59]
 v_accvgpr_write_b32 a230, v52
 s_add_u32 m0, s81, 6144
 s_add_u32 s21, s88, 6389760
 v_cvt_pk_f16_f32 v54, v54, v55
 s_waitcnt lgkmcnt(2)
 v_mfma_f32_16x16x32_bf16 v[40:43], v[144:147], v[72:75], v[40:43]
 ds_read_b128 v[140:143], v23 offset:12544
 v_accvgpr_write_b32 a231, v54
 buffer_load_dwordx4 v34, s[12:15], s21 offen offset:0 lds
 v_cvt_pk_f16_f32 v60, v60, v61
 v_mfma_f32_16x16x32_bf16 v[48:51], v[144:147], v[96:99], v[48:51]
 v_accvgpr_write_b32 a238, v60
 buffer_load_dwordx4 v35, s[12:15], s21 offen offset:1024 lds
 v_cvt_pk_f16_f32 v62, v62, v63
 v_accvgpr_write_b32 a239, v62
 v_mfma_f32_16x16x32_bf16 v[56:59], v[144:147], v[120:123], v[56:59]
 buffer_load_dwordx4 v36, s[12:15], s21 offen offset:2048 lds
 s_waitcnt lgkmcnt(2)
 v_mfma_f32_16x16x32_bf16 v[40:43], v[148:151], v[76:79], v[40:43]
 ds_read_b128 v[144:147], v22 offset:13824
 s_add_u32 m0, s81, 9216
 s_add_u32 s21, s88, 6438912
 v_mfma_f32_16x16x32_bf16 v[48:51], v[148:151], v[100:103], v[48:51]
 buffer_load_dwordx4 v37, s[12:15], s21 offen offset:0 lds
 v_mfma_f32_16x16x32_bf16 v[56:59], v[148:151], v[124:127], v[56:59]
 buffer_load_dwordx4 v38, s[12:15], s21 offen offset:1024 lds
 s_waitcnt lgkmcnt(2)
 v_mfma_f32_16x16x32_bf16 v[40:43], v[136:139], v[80:83], v[40:43]
 ds_read_b128 v[148:151], v23 offset:13824
 buffer_load_dwordx4 v39, s[12:15], s21 offen offset:2048 lds
 v_mfma_f32_16x16x32_bf16 v[48:51], v[136:139], v[104:107], v[48:51]
 v_mfma_f32_16x16x32_bf16 v[56:59], v[136:139], v[128:131], v[56:59]
 s_waitcnt lgkmcnt(2)
 v_mfma_f32_16x16x32_bf16 v[40:43], v[140:143], v[84:87], v[40:43]
 ds_read_b128 v[136:139], v22 offset:13952
 v_mfma_f32_16x16x32_bf16 v[48:51], v[140:143], v[108:111], v[48:51]
 v_mfma_f32_16x16x32_bf16 v[56:59], v[140:143], v[132:135], v[56:59]
 s_waitcnt lgkmcnt(2)
 v_mfma_f32_16x16x32_bf16 v[44:47], v[144:147], v[64:67], 0
 ds_read_b128 v[140:143], v23 offset:13952
 v_mfma_f32_16x16x32_bf16 v[52:55], v[144:147], v[88:91], 0
 v_mfma_f32_16x16x32_bf16 v[60:63], v[144:147], v[112:115], 0
 s_waitcnt lgkmcnt(2)
 v_mfma_f32_16x16x32_bf16 v[44:47], v[148:151], v[68:71], v[44:47]
 ds_read_b128 v[144:147], v22 offset:14080
 v_cvt_pk_f16_f32 v40, v40, v41
 v_accvgpr_write_b32 a240, v40
 v_cvt_pk_f16_f32 v42, v42, v43
 v_accvgpr_write_b32 a241, v42
 v_mfma_f32_16x16x32_bf16 v[52:55], v[148:151], v[92:95], v[52:55]
 v_cvt_pk_f16_f32 v48, v48, v49
 v_accvgpr_write_b32 a248, v48
 v_cvt_pk_f16_f32 v50, v50, v51
 v_accvgpr_write_b32 a249, v50
 v_cvt_pk_f16_f32 v152, v56, v57
 v_mfma_f32_16x16x32_bf16 v[60:63], v[148:151], v[116:119], v[60:63]
 v_cvt_pk_f16_f32 v153, v58, v59
 s_waitcnt lgkmcnt(2)
 v_mfma_f32_16x16x32_bf16 v[44:47], v[136:139], v[72:75], v[44:47]
 ds_read_b128 v[148:151], v23 offset:14080
 v_mfma_f32_16x16x32_bf16 v[52:55], v[136:139], v[96:99], v[52:55]
 v_mfma_f32_16x16x32_bf16 v[60:63], v[136:139], v[120:123], v[60:63]
 s_waitcnt lgkmcnt(2)
 v_mfma_f32_16x16x32_bf16 v[44:47], v[140:143], v[76:79], v[44:47]
 s_waitcnt vmcnt(12)
 ds_read_b128 v[136:139], v22 offset:24576
 v_mfma_f32_16x16x32_bf16 v[52:55], v[140:143], v[100:103], v[52:55]
 v_mfma_f32_16x16x32_bf16 v[60:63], v[140:143], v[124:127], v[60:63]
 s_waitcnt lgkmcnt(2)
 v_mfma_f32_16x16x32_bf16 v[44:47], v[144:147], v[80:83], v[44:47]
 ds_read_b128 v[140:143], v23 offset:24576
 v_mfma_f32_16x16x32_bf16 v[52:55], v[144:147], v[104:107], v[52:55]
 v_mfma_f32_16x16x32_bf16 v[60:63], v[144:147], v[128:131], v[60:63]
 s_waitcnt lgkmcnt(2)
 v_mfma_f32_16x16x32_bf16 v[44:47], v[148:151], v[84:87], v[44:47]
 ds_read_b128 v[144:147], v22 offset:24704
 s_add_u32 m0, s81, 12288
 s_add_u32 s21, s88, 6881280
 v_mfma_f32_16x16x32_bf16 v[52:55], v[148:151], v[108:111], v[52:55]
 buffer_load_dwordx4 v28, s[12:15], s21 offen offset:0 lds
 v_mfma_f32_16x16x32_bf16 v[60:63], v[148:151], v[132:135], v[60:63]
 buffer_load_dwordx4 v29, s[12:15], s21 offen offset:1024 lds
 s_waitcnt lgkmcnt(2)
 v_mfma_f32_16x16x32_bf16 v[40:43], v[136:139], v[64:67], 0
 ds_read_b128 v[148:151], v23 offset:24704
 buffer_load_dwordx4 v30, s[12:15], s21 offen offset:2048 lds
 v_mfma_f32_16x16x32_bf16 v[48:51], v[136:139], v[88:91], 0
 s_add_u32 m0, s81, 15360
 s_add_u32 s21, s88, 6930432
 v_mfma_f32_16x16x32_bf16 v[56:59], v[136:139], v[112:115], 0
 buffer_load_dwordx4 v31, s[12:15], s21 offen offset:0 lds
 s_waitcnt lgkmcnt(2)
 v_mfma_f32_16x16x32_bf16 v[40:43], v[140:143], v[68:71], v[40:43]
 ds_read_b128 v[136:139], v22 offset:24832
 v_cvt_pk_f16_f32 v44, v44, v45
 buffer_load_dwordx4 v32, s[12:15], s21 offen offset:1024 lds
 v_accvgpr_write_b32 a242, v44
 v_mfma_f32_16x16x32_bf16 v[48:51], v[140:143], v[92:95], v[48:51]
 v_cvt_pk_f16_f32 v46, v46, v47
 buffer_load_dwordx4 v33, s[12:15], s21 offen offset:2048 lds
 v_accvgpr_write_b32 a243, v46
 v_cvt_pk_f16_f32 v52, v52, v53
 v_mfma_f32_16x16x32_bf16 v[56:59], v[140:143], v[116:119], v[56:59]
 v_accvgpr_write_b32 a250, v52
 s_add_u32 m0, s81, 18432
 s_add_u32 s21, s88, 7372800
 v_cvt_pk_f16_f32 v54, v54, v55
 s_waitcnt lgkmcnt(2)
 v_mfma_f32_16x16x32_bf16 v[40:43], v[144:147], v[72:75], v[40:43]
 ds_read_b128 v[140:143], v23 offset:24832
 v_accvgpr_write_b32 a251, v54
 buffer_load_dwordx4 v34, s[12:15], s21 offen offset:0 lds
 v_cvt_pk_f16_f32 v154, v60, v61
 v_mfma_f32_16x16x32_bf16 v[48:51], v[144:147], v[96:99], v[48:51]
 v_cvt_pk_f16_f32 v155, v62, v63
 buffer_load_dwordx4 v35, s[12:15], s21 offen offset:1024 lds
 v_mfma_f32_16x16x32_bf16 v[56:59], v[144:147], v[120:123], v[56:59]
 buffer_load_dwordx4 v36, s[12:15], s21 offen offset:2048 lds
 s_waitcnt lgkmcnt(2)
 v_mfma_f32_16x16x32_bf16 v[40:43], v[148:151], v[76:79], v[40:43]
 ds_read_b128 v[144:147], v22 offset:26112
 s_add_u32 m0, s81, 21504
 s_add_u32 s21, s88, 7421952
 v_mfma_f32_16x16x32_bf16 v[48:51], v[148:151], v[100:103], v[48:51]
 buffer_load_dwordx4 v37, s[12:15], s21 offen offset:0 lds
 v_mfma_f32_16x16x32_bf16 v[56:59], v[148:151], v[124:127], v[56:59]
 buffer_load_dwordx4 v38, s[12:15], s21 offen offset:1024 lds
 s_waitcnt lgkmcnt(2)
 v_mfma_f32_16x16x32_bf16 v[40:43], v[136:139], v[80:83], v[40:43]
 ds_read_b128 v[148:151], v23 offset:26112
 buffer_load_dwordx4 v39, s[12:15], s21 offen offset:2048 lds
 v_mfma_f32_16x16x32_bf16 v[48:51], v[136:139], v[104:107], v[48:51]
 v_mfma_f32_16x16x32_bf16 v[56:59], v[136:139], v[128:131], v[56:59]
 s_waitcnt lgkmcnt(2)
 v_mfma_f32_16x16x32_bf16 v[40:43], v[140:143], v[84:87], v[40:43]
 ds_read_b128 v[136:139], v22 offset:26240
 v_mfma_f32_16x16x32_bf16 v[48:51], v[140:143], v[108:111], v[48:51]
 v_mfma_f32_16x16x32_bf16 v[56:59], v[140:143], v[132:135], v[56:59]
 s_waitcnt lgkmcnt(2)
 v_mfma_f32_16x16x32_bf16 v[44:47], v[144:147], v[64:67], 0
 ds_read_b128 v[140:143], v23 offset:26240
 v_mfma_f32_16x16x32_bf16 v[52:55], v[144:147], v[88:91], 0
 v_mfma_f32_16x16x32_bf16 v[60:63], v[144:147], v[112:115], 0
 s_waitcnt lgkmcnt(2)
 v_mfma_f32_16x16x32_bf16 v[44:47], v[148:151], v[68:71], v[44:47]
 ds_read_b128 v[144:147], v22 offset:26368
 v_cvt_pk_f16_f32 v40, v40, v41
 v_accvgpr_write_b32 a244, v40
 v_cvt_pk_f16_f32 v42, v42, v43
 v_accvgpr_write_b32 a245, v42
 v_mfma_f32_16x16x32_bf16 v[52:55], v[148:151], v[92:95], v[52:55]
 v_cvt_pk_f16_f32 v48, v48, v49
 v_accvgpr_write_b32 a252, v48
 v_cvt_pk_f16_f32 v50, v50, v51
 v_accvgpr_write_b32 a253, v50
 v_cvt_pk_f16_f32 v156, v56, v57
 v_mfma_f32_16x16x32_bf16 v[60:63], v[148:151], v[116:119], v[60:63]
 v_cvt_pk_f16_f32 v157, v58, v59
 s_waitcnt lgkmcnt(2)
 v_mfma_f32_16x16x32_bf16 v[44:47], v[136:139], v[72:75], v[44:47]
 ds_read_b128 v[148:151], v23 offset:26368
 v_mfma_f32_16x16x32_bf16 v[52:55], v[136:139], v[96:99], v[52:55]
 v_mfma_f32_16x16x32_bf16 v[60:63], v[136:139], v[120:123], v[60:63]
 s_waitcnt lgkmcnt(2)
 v_mfma_f32_16x16x32_bf16 v[44:47], v[140:143], v[76:79], v[44:47]
 s_waitcnt vmcnt(12)
 ds_read_b128 v[136:139], v22 offset:0
 v_mfma_f32_16x16x32_bf16 v[52:55], v[140:143], v[100:103], v[52:55]
 v_mfma_f32_16x16x32_bf16 v[60:63], v[140:143], v[124:127], v[60:63]
 s_waitcnt lgkmcnt(2)
 v_mfma_f32_16x16x32_bf16 v[44:47], v[144:147], v[80:83], v[44:47]
 ds_read_b128 v[140:143], v23 offset:0
 v_mfma_f32_16x16x32_bf16 v[52:55], v[144:147], v[104:107], v[52:55]
 v_mfma_f32_16x16x32_bf16 v[60:63], v[144:147], v[128:131], v[60:63]
 s_waitcnt lgkmcnt(2)
 v_mfma_f32_16x16x32_bf16 v[44:47], v[148:151], v[84:87], v[44:47]
 ds_read_b128 v[144:147], v22 offset:128
 s_add_u32 m0, s81, 24576
 s_add_u32 s21, s88, 5996544
 v_mfma_f32_16x16x32_bf16 v[52:55], v[148:151], v[108:111], v[52:55]
 buffer_load_dwordx4 v28, s[12:15], s21 offen offset:0 lds
 v_mfma_f32_16x16x32_bf16 v[60:63], v[148:151], v[132:135], v[60:63]
 buffer_load_dwordx4 v29, s[12:15], s21 offen offset:1024 lds
 s_waitcnt lgkmcnt(2)
 v_mfma_f32_16x16x32_bf16 v[40:43], v[136:139], v[64:67], 0
 ds_read_b128 v[148:151], v23 offset:128
 buffer_load_dwordx4 v30, s[12:15], s21 offen offset:2048 lds
 v_mfma_f32_16x16x32_bf16 v[48:51], v[136:139], v[88:91], 0
 s_add_u32 m0, s81, 27648
 s_add_u32 s21, s88, 6045696
 v_mfma_f32_16x16x32_bf16 v[56:59], v[136:139], v[112:115], 0
 buffer_load_dwordx4 v31, s[12:15], s21 offen offset:0 lds
 s_waitcnt lgkmcnt(2)
 v_mfma_f32_16x16x32_bf16 v[40:43], v[140:143], v[68:71], v[40:43]
 ds_read_b128 v[136:139], v22 offset:256
 v_cvt_pk_f16_f32 v44, v44, v45
 buffer_load_dwordx4 v32, s[12:15], s21 offen offset:1024 lds
 v_accvgpr_write_b32 a246, v44
 v_mfma_f32_16x16x32_bf16 v[48:51], v[140:143], v[92:95], v[48:51]
 v_cvt_pk_f16_f32 v46, v46, v47
 buffer_load_dwordx4 v33, s[12:15], s21 offen offset:2048 lds
 v_accvgpr_write_b32 a247, v46
 v_cvt_pk_f16_f32 v52, v52, v53
 v_mfma_f32_16x16x32_bf16 v[56:59], v[140:143], v[116:119], v[56:59]
 v_accvgpr_write_b32 a254, v52
 s_add_u32 m0, s81, 30720
 s_add_u32 s21, s88, 6488064
 v_cvt_pk_f16_f32 v54, v54, v55
 s_waitcnt lgkmcnt(2)
 v_mfma_f32_16x16x32_bf16 v[40:43], v[144:147], v[72:75], v[40:43]
 ds_read_b128 v[140:143], v23 offset:256
 v_accvgpr_write_b32 a255, v54
 buffer_load_dwordx4 v34, s[12:15], s21 offen offset:0 lds
 v_cvt_pk_f16_f32 v158, v60, v61
 v_mfma_f32_16x16x32_bf16 v[48:51], v[144:147], v[96:99], v[48:51]
 v_cvt_pk_f16_f32 v159, v62, v63
 buffer_load_dwordx4 v35, s[12:15], s21 offen offset:1024 lds
 v_mfma_f32_16x16x32_bf16 v[56:59], v[144:147], v[120:123], v[56:59]
 buffer_load_dwordx4 v36, s[12:15], s21 offen offset:2048 lds
 s_waitcnt lgkmcnt(2)
 v_mfma_f32_16x16x32_bf16 v[40:43], v[148:151], v[76:79], v[40:43]
 ds_read_b128 v[144:147], v22 offset:1536
 s_add_u32 m0, s81, 33792
 s_add_u32 s21, s88, 6537216
 v_mfma_f32_16x16x32_bf16 v[48:51], v[148:151], v[100:103], v[48:51]
 buffer_load_dwordx4 v37, s[12:15], s21 offen offset:0 lds
 v_mfma_f32_16x16x32_bf16 v[56:59], v[148:151], v[124:127], v[56:59]
 buffer_load_dwordx4 v38, s[12:15], s21 offen offset:1024 lds
 s_waitcnt lgkmcnt(2)
 v_mfma_f32_16x16x32_bf16 v[40:43], v[136:139], v[80:83], v[40:43]
 ds_read_b128 v[148:151], v23 offset:1536
 buffer_load_dwordx4 v39, s[12:15], s21 offen offset:2048 lds
 v_mfma_f32_16x16x32_bf16 v[48:51], v[136:139], v[104:107], v[48:51]
 v_mfma_f32_16x16x32_bf16 v[56:59], v[136:139], v[128:131], v[56:59]
 s_waitcnt lgkmcnt(2)
 v_mfma_f32_16x16x32_bf16 v[40:43], v[140:143], v[84:87], v[40:43]
 ds_read_b128 v[136:139], v22 offset:1664
 v_mfma_f32_16x16x32_bf16 v[48:51], v[140:143], v[108:111], v[48:51]
 v_mfma_f32_16x16x32_bf16 v[56:59], v[140:143], v[132:135], v[56:59]
 s_waitcnt lgkmcnt(2)
 v_mfma_f32_16x16x32_bf16 v[44:47], v[144:147], v[64:67], 0
 ds_read_b128 v[140:143], v23 offset:1664
 v_mfma_f32_16x16x32_bf16 v[52:55], v[144:147], v[88:91], 0
 v_mfma_f32_16x16x32_bf16 v[60:63], v[144:147], v[112:115], 0
 s_waitcnt lgkmcnt(2)
 v_mfma_f32_16x16x32_bf16 v[44:47], v[148:151], v[68:71], v[44:47]
 ds_read_b128 v[144:147], v22 offset:1792
 v_cvt_pk_f16_f32 v160, v40, v41
 v_cvt_pk_f16_f32 v161, v42, v43
 v_cvt_pk_f16_f32 v168, v48, v49
 v_cvt_pk_f16_f32 v169, v50, v51
 v_mfma_f32_16x16x32_bf16 v[52:55], v[148:151], v[92:95], v[52:55]
 v_cvt_pk_f16_f32 v176, v56, v57
 v_cvt_pk_f16_f32 v177, v58, v59
 v_mfma_f32_16x16x32_bf16 v[60:63], v[148:151], v[116:119], v[60:63]
 s_waitcnt lgkmcnt(2)
 v_mfma_f32_16x16x32_bf16 v[44:47], v[136:139], v[72:75], v[44:47]
 ds_read_b128 v[148:151], v23 offset:1792
 v_mfma_f32_16x16x32_bf16 v[52:55], v[136:139], v[96:99], v[52:55]
 v_mfma_f32_16x16x32_bf16 v[60:63], v[136:139], v[120:123], v[60:63]
 s_waitcnt lgkmcnt(2)
 v_mfma_f32_16x16x32_bf16 v[44:47], v[140:143], v[76:79], v[44:47]
 s_waitcnt vmcnt(12)
 ds_read_b128 v[136:139], v22 offset:12288
 v_mfma_f32_16x16x32_bf16 v[52:55], v[140:143], v[100:103], v[52:55]
 v_mfma_f32_16x16x32_bf16 v[60:63], v[140:143], v[124:127], v[60:63]
 s_waitcnt lgkmcnt(2)
 v_mfma_f32_16x16x32_bf16 v[44:47], v[144:147], v[80:83], v[44:47]
 ds_read_b128 v[140:143], v23 offset:12288
 v_mfma_f32_16x16x32_bf16 v[52:55], v[144:147], v[104:107], v[52:55]
 v_mfma_f32_16x16x32_bf16 v[60:63], v[144:147], v[128:131], v[60:63]
 s_waitcnt lgkmcnt(2)
 v_mfma_f32_16x16x32_bf16 v[44:47], v[148:151], v[84:87], v[44:47]
 ds_read_b128 v[144:147], v22 offset:12416
 s_add_u32 m0, s81, 0
 s_add_u32 s21, s88, 6979584
 v_mfma_f32_16x16x32_bf16 v[52:55], v[148:151], v[108:111], v[52:55]
 buffer_load_dwordx4 v28, s[12:15], s21 offen offset:0 lds
 v_mfma_f32_16x16x32_bf16 v[60:63], v[148:151], v[132:135], v[60:63]
 buffer_load_dwordx4 v29, s[12:15], s21 offen offset:1024 lds
 s_waitcnt lgkmcnt(2)
 v_mfma_f32_16x16x32_bf16 v[40:43], v[136:139], v[64:67], 0
 ds_read_b128 v[148:151], v23 offset:12416
 buffer_load_dwordx4 v30, s[12:15], s21 offen offset:2048 lds
 v_mfma_f32_16x16x32_bf16 v[48:51], v[136:139], v[88:91], 0
 s_add_u32 m0, s81, 3072
 s_add_u32 s21, s88, 7028736
 v_mfma_f32_16x16x32_bf16 v[56:59], v[136:139], v[112:115], 0
 buffer_load_dwordx4 v31, s[12:15], s21 offen offset:0 lds
 s_waitcnt lgkmcnt(2)
 v_mfma_f32_16x16x32_bf16 v[40:43], v[140:143], v[68:71], v[40:43]
 ds_read_b128 v[136:139], v22 offset:12544
 v_cvt_pk_f16_f32 v162, v44, v45
 buffer_load_dwordx4 v32, s[12:15], s21 offen offset:1024 lds
 v_cvt_pk_f16_f32 v163, v46, v47
 v_mfma_f32_16x16x32_bf16 v[48:51], v[140:143], v[92:95], v[48:51]
 v_cvt_pk_f16_f32 v170, v52, v53
 buffer_load_dwordx4 v33, s[12:15], s21 offen offset:2048 lds
 v_cvt_pk_f16_f32 v171, v54, v55
 v_cvt_pk_f16_f32 v178, v60, v61
 v_mfma_f32_16x16x32_bf16 v[56:59], v[140:143], v[116:119], v[56:59]
 v_cvt_pk_f16_f32 v179, v62, v63
 s_add_u32 m0, s81, 6144
 s_add_u32 s21, s88, 7471104
 s_waitcnt lgkmcnt(2)
 v_mfma_f32_16x16x32_bf16 v[40:43], v[144:147], v[72:75], v[40:43]
 ds_read_b128 v[140:143], v23 offset:12544
 buffer_load_dwordx4 v34, s[12:15], s21 offen offset:0 lds
 v_mfma_f32_16x16x32_bf16 v[48:51], v[144:147], v[96:99], v[48:51]
 buffer_load_dwordx4 v35, s[12:15], s21 offen offset:1024 lds
 v_mfma_f32_16x16x32_bf16 v[56:59], v[144:147], v[120:123], v[56:59]
 buffer_load_dwordx4 v36, s[12:15], s21 offen offset:2048 lds
 s_waitcnt lgkmcnt(2)
 v_mfma_f32_16x16x32_bf16 v[40:43], v[148:151], v[76:79], v[40:43]
 ds_read_b128 v[144:147], v22 offset:13824
 s_add_u32 m0, s81, 9216
 s_add_u32 s21, s88, 7520256
 v_mfma_f32_16x16x32_bf16 v[48:51], v[148:151], v[100:103], v[48:51]
 buffer_load_dwordx4 v37, s[12:15], s21 offen offset:0 lds
 v_mfma_f32_16x16x32_bf16 v[56:59], v[148:151], v[124:127], v[56:59]
 buffer_load_dwordx4 v38, s[12:15], s21 offen offset:1024 lds
 s_waitcnt lgkmcnt(2)
 v_mfma_f32_16x16x32_bf16 v[40:43], v[136:139], v[80:83], v[40:43]
 ds_read_b128 v[148:151], v23 offset:13824
 buffer_load_dwordx4 v39, s[12:15], s21 offen offset:2048 lds
 v_mfma_f32_16x16x32_bf16 v[48:51], v[136:139], v[104:107], v[48:51]
 v_mfma_f32_16x16x32_bf16 v[56:59], v[136:139], v[128:131], v[56:59]
 s_waitcnt lgkmcnt(2)
 v_mfma_f32_16x16x32_bf16 v[40:43], v[140:143], v[84:87], v[40:43]
 ds_read_b128 v[136:139], v22 offset:13952
 v_mfma_f32_16x16x32_bf16 v[48:51], v[140:143], v[108:111], v[48:51]
 v_mfma_f32_16x16x32_bf16 v[56:59], v[140:143], v[132:135], v[56:59]
 s_waitcnt lgkmcnt(2)
 v_mfma_f32_16x16x32_bf16 v[44:47], v[144:147], v[64:67], 0
 ds_read_b128 v[140:143], v23 offset:13952
 v_mfma_f32_16x16x32_bf16 v[52:55], v[144:147], v[88:91], 0
 v_mfma_f32_16x16x32_bf16 v[60:63], v[144:147], v[112:115], 0
 s_waitcnt lgkmcnt(2)
 v_mfma_f32_16x16x32_bf16 v[44:47], v[148:151], v[68:71], v[44:47]
 ds_read_b128 v[144:147], v22 offset:14080
 v_cvt_pk_f16_f32 v164, v40, v41
 v_cvt_pk_f16_f32 v165, v42, v43
 v_cvt_pk_f16_f32 v172, v48, v49
 v_cvt_pk_f16_f32 v173, v50, v51
 v_mfma_f32_16x16x32_bf16 v[52:55], v[148:151], v[92:95], v[52:55]
 v_cvt_pk_f16_f32 v180, v56, v57
 v_cvt_pk_f16_f32 v181, v58, v59
 v_mfma_f32_16x16x32_bf16 v[60:63], v[148:151], v[116:119], v[60:63]
 s_waitcnt lgkmcnt(2)
 v_mfma_f32_16x16x32_bf16 v[44:47], v[136:139], v[72:75], v[44:47]
 ds_read_b128 v[148:151], v23 offset:14080
 v_mfma_f32_16x16x32_bf16 v[52:55], v[136:139], v[96:99], v[52:55]
 v_mfma_f32_16x16x32_bf16 v[60:63], v[136:139], v[120:123], v[60:63]
 s_waitcnt lgkmcnt(2)
 v_mfma_f32_16x16x32_bf16 v[44:47], v[140:143], v[76:79], v[44:47]
 s_waitcnt vmcnt(12)
 ds_read_b128 v[136:139], v22 offset:24576
 v_mfma_f32_16x16x32_bf16 v[52:55], v[140:143], v[100:103], v[52:55]
 v_mfma_f32_16x16x32_bf16 v[60:63], v[140:143], v[124:127], v[60:63]
 s_waitcnt lgkmcnt(2)
 v_mfma_f32_16x16x32_bf16 v[44:47], v[144:147], v[80:83], v[44:47]
 ds_read_b128 v[140:143], v23 offset:24576
 v_mfma_f32_16x16x32_bf16 v[52:55], v[144:147], v[104:107], v[52:55]
 v_mfma_f32_16x16x32_bf16 v[60:63], v[144:147], v[128:131], v[60:63]
 s_waitcnt lgkmcnt(2)
 v_mfma_f32_16x16x32_bf16 v[44:47], v[148:151], v[84:87], v[44:47]
 ds_read_b128 v[144:147], v22 offset:24704
 s_add_u32 m0, s81, 12288
 s_add_u32 s21, s88, 196608
 v_mfma_f32_16x16x32_bf16 v[52:55], v[148:151], v[108:111], v[52:55]
 buffer_load_dwordx4 v28, s[12:15], s21 offen offset:0 lds
 v_mfma_f32_16x16x32_bf16 v[60:63], v[148:151], v[132:135], v[60:63]
 buffer_load_dwordx4 v29, s[12:15], s21 offen offset:1024 lds
 s_waitcnt lgkmcnt(2)
 v_mfma_f32_16x16x32_bf16 v[40:43], v[136:139], v[64:67], 0
 ds_read_b128 v[148:151], v23 offset:24704
 buffer_load_dwordx4 v30, s[12:15], s21 offen offset:2048 lds
 v_mfma_f32_16x16x32_bf16 v[48:51], v[136:139], v[88:91], 0
 s_add_u32 m0, s81, 15360
 s_add_u32 s21, s88, 2162688
 v_mfma_f32_16x16x32_bf16 v[56:59], v[136:139], v[112:115], 0
 buffer_load_dwordx4 v31, s[12:15], s21 offen offset:0 lds
 s_waitcnt lgkmcnt(2)
 v_mfma_f32_16x16x32_bf16 v[40:43], v[140:143], v[68:71], v[40:43]
 ds_read_b128 v[136:139], v22 offset:24832
 v_cvt_pk_f16_f32 v166, v44, v45
 buffer_load_dwordx4 v32, s[12:15], s21 offen offset:1024 lds
 v_cvt_pk_f16_f32 v167, v46, v47
 v_mfma_f32_16x16x32_bf16 v[48:51], v[140:143], v[92:95], v[48:51]
 v_cvt_pk_f16_f32 v174, v52, v53
 buffer_load_dwordx4 v33, s[12:15], s21 offen offset:2048 lds
 v_cvt_pk_f16_f32 v175, v54, v55
 v_cvt_pk_f16_f32 v182, v60, v61
 v_mfma_f32_16x16x32_bf16 v[56:59], v[140:143], v[116:119], v[56:59]
 v_cvt_pk_f16_f32 v183, v62, v63
 s_add_u32 m0, s81, 18432
 s_add_u32 s21, s88, 688128
 s_waitcnt lgkmcnt(2)
 v_mfma_f32_16x16x32_bf16 v[40:43], v[144:147], v[72:75], v[40:43]
 ds_read_b128 v[140:143], v23 offset:24832
 buffer_load_dwordx4 v34, s[12:15], s21 offen offset:0 lds
 v_mfma_f32_16x16x32_bf16 v[48:51], v[144:147], v[96:99], v[48:51]
 buffer_load_dwordx4 v35, s[12:15], s21 offen offset:1024 lds
 v_mfma_f32_16x16x32_bf16 v[56:59], v[144:147], v[120:123], v[56:59]
 buffer_load_dwordx4 v36, s[12:15], s21 offen offset:2048 lds
 s_waitcnt lgkmcnt(2)
 v_mfma_f32_16x16x32_bf16 v[40:43], v[148:151], v[76:79], v[40:43]
 ds_read_b128 v[144:147], v22 offset:26112
 s_add_u32 m0, s81, 21504
 s_add_u32 s21, s88, 2654208
 v_mfma_f32_16x16x32_bf16 v[48:51], v[148:151], v[100:103], v[48:51]
 buffer_load_dwordx4 v37, s[12:15], s21 offen offset:0 lds
 v_mfma_f32_16x16x32_bf16 v[56:59], v[148:151], v[124:127], v[56:59]
 buffer_load_dwordx4 v38, s[12:15], s21 offen offset:1024 lds
 s_waitcnt lgkmcnt(2)
 v_mfma_f32_16x16x32_bf16 v[40:43], v[136:139], v[80:83], v[40:43]
 ds_read_b128 v[148:151], v23 offset:26112
 buffer_load_dwordx4 v39, s[12:15], s21 offen offset:2048 lds
 v_mfma_f32_16x16x32_bf16 v[48:51], v[136:139], v[104:107], v[48:51]
 v_mfma_f32_16x16x32_bf16 v[56:59], v[136:139], v[128:131], v[56:59]
 s_waitcnt lgkmcnt(2)
 v_mfma_f32_16x16x32_bf16 v[40:43], v[140:143], v[84:87], v[40:43]
 ds_read_b128 v[136:139], v22 offset:26240
 v_mfma_f32_16x16x32_bf16 v[48:51], v[140:143], v[108:111], v[48:51]
 v_mfma_f32_16x16x32_bf16 v[56:59], v[140:143], v[132:135], v[56:59]
 s_waitcnt lgkmcnt(2)
 v_mfma_f32_16x16x32_bf16 v[44:47], v[144:147], v[64:67], 0
 ds_read_b128 v[140:143], v23 offset:26240
 v_mfma_f32_16x16x32_bf16 v[52:55], v[144:147], v[88:91], 0
 v_mfma_f32_16x16x32_bf16 v[60:63], v[144:147], v[112:115], 0
 s_waitcnt lgkmcnt(2)
 v_mfma_f32_16x16x32_bf16 v[44:47], v[148:151], v[68:71], v[44:47]
 ds_read_b128 v[144:147], v22 offset:26368
 v_cvt_pk_f16_f32 v184, v40, v41
 v_cvt_pk_f16_f32 v185, v42, v43
 v_cvt_pk_f16_f32 v192, v48, v49
 v_cvt_pk_f16_f32 v193, v50, v51
 v_mfma_f32_16x16x32_bf16 v[52:55], v[148:151], v[92:95], v[52:55]
 v_cvt_pk_f16_f32 v200, v56, v57
 v_cvt_pk_f16_f32 v201, v58, v59
 v_mfma_f32_16x16x32_bf16 v[60:63], v[148:151], v[116:119], v[60:63]
 s_waitcnt lgkmcnt(2)
 v_mfma_f32_16x16x32_bf16 v[44:47], v[136:139], v[72:75], v[44:47]
 ds_read_b128 v[148:151], v23 offset:26368
 v_mfma_f32_16x16x32_bf16 v[52:55], v[136:139], v[96:99], v[52:55]
 v_mfma_f32_16x16x32_bf16 v[60:63], v[136:139], v[120:123], v[60:63]
 s_waitcnt lgkmcnt(2)
 v_mfma_f32_16x16x32_bf16 v[44:47], v[140:143], v[76:79], v[44:47]
 s_waitcnt vmcnt(12)
 ds_read_b128 v[136:139], v22 offset:0
 v_mfma_f32_16x16x32_bf16 v[52:55], v[140:143], v[100:103], v[52:55]
 v_mfma_f32_16x16x32_bf16 v[60:63], v[140:143], v[124:127], v[60:63]
 s_waitcnt lgkmcnt(2)
 v_mfma_f32_16x16x32_bf16 v[44:47], v[144:147], v[80:83], v[44:47]
 ds_read_b128 v[140:143], v23 offset:0
 v_mfma_f32_16x16x32_bf16 v[52:55], v[144:147], v[104:107], v[52:55]
 v_mfma_f32_16x16x32_bf16 v[60:63], v[144:147], v[128:131], v[60:63]
 s_waitcnt lgkmcnt(2)
 v_mfma_f32_16x16x32_bf16 v[44:47], v[148:151], v[84:87], v[44:47]
 ds_read_b128 v[144:147], v22 offset:128
 s_add_u32 m0, s81, 24576
 s_add_u32 s21, s88, 1179648
 v_mfma_f32_16x16x32_bf16 v[52:55], v[148:151], v[108:111], v[52:55]
 buffer_load_dwordx4 v28, s[12:15], s21 offen offset:0 lds
 v_mfma_f32_16x16x32_bf16 v[60:63], v[148:151], v[132:135], v[60:63]
 buffer_load_dwordx4 v29, s[12:15], s21 offen offset:1024 lds
 s_waitcnt lgkmcnt(2)
 v_mfma_f32_16x16x32_bf16 v[40:43], v[136:139], v[64:67], 0
 ds_read_b128 v[148:151], v23 offset:128
 buffer_load_dwordx4 v30, s[12:15], s21 offen offset:2048 lds
 v_mfma_f32_16x16x32_bf16 v[48:51], v[136:139], v[88:91], 0
 s_add_u32 m0, s81, 27648
 s_add_u32 s21, s88, 3145728
 v_mfma_f32_16x16x32_bf16 v[56:59], v[136:139], v[112:115], 0
 buffer_load_dwordx4 v31, s[12:15], s21 offen offset:0 lds
 s_waitcnt lgkmcnt(2)
 v_mfma_f32_16x16x32_bf16 v[40:43], v[140:143], v[68:71], v[40:43]
 ds_read_b128 v[136:139], v22 offset:256
 v_cvt_pk_f16_f32 v186, v44, v45
 buffer_load_dwordx4 v32, s[12:15], s21 offen offset:1024 lds
 v_cvt_pk_f16_f32 v187, v46, v47
 v_mfma_f32_16x16x32_bf16 v[48:51], v[140:143], v[92:95], v[48:51]
 v_cvt_pk_f16_f32 v194, v52, v53
 buffer_load_dwordx4 v33, s[12:15], s21 offen offset:2048 lds
 v_cvt_pk_f16_f32 v195, v54, v55
 v_cvt_pk_f16_f32 v202, v60, v61
 v_mfma_f32_16x16x32_bf16 v[56:59], v[140:143], v[116:119], v[56:59]
 v_cvt_pk_f16_f32 v203, v62, v63
 s_add_u32 m0, s81, 30720
 s_add_u32 s21, s88, 1671168
 s_waitcnt lgkmcnt(2)
 v_mfma_f32_16x16x32_bf16 v[40:43], v[144:147], v[72:75], v[40:43]
 ds_read_b128 v[140:143], v23 offset:256
 buffer_load_dwordx4 v34, s[12:15], s21 offen offset:0 lds
 v_mfma_f32_16x16x32_bf16 v[48:51], v[144:147], v[96:99], v[48:51]
 buffer_load_dwordx4 v35, s[12:15], s21 offen offset:1024 lds
 v_mfma_f32_16x16x32_bf16 v[56:59], v[144:147], v[120:123], v[56:59]
 buffer_load_dwordx4 v36, s[12:15], s21 offen offset:2048 lds
 s_waitcnt lgkmcnt(2)
 v_mfma_f32_16x16x32_bf16 v[40:43], v[148:151], v[76:79], v[40:43]
 ds_read_b128 v[144:147], v22 offset:1536
 s_add_u32 m0, s81, 33792
 s_add_u32 s21, s88, 3637248
 v_mfma_f32_16x16x32_bf16 v[48:51], v[148:151], v[100:103], v[48:51]
 buffer_load_dwordx4 v37, s[12:15], s21 offen offset:0 lds
 v_mfma_f32_16x16x32_bf16 v[56:59], v[148:151], v[124:127], v[56:59]
 buffer_load_dwordx4 v38, s[12:15], s21 offen offset:1024 lds
 s_waitcnt lgkmcnt(2)
 v_mfma_f32_16x16x32_bf16 v[40:43], v[136:139], v[80:83], v[40:43]
 ds_read_b128 v[148:151], v23 offset:1536
 buffer_load_dwordx4 v39, s[12:15], s21 offen offset:2048 lds
 v_mfma_f32_16x16x32_bf16 v[48:51], v[136:139], v[104:107], v[48:51]
 v_mfma_f32_16x16x32_bf16 v[56:59], v[136:139], v[128:131], v[56:59]
 s_waitcnt lgkmcnt(2)
 v_mfma_f32_16x16x32_bf16 v[40:43], v[140:143], v[84:87], v[40:43]
 ds_read_b128 v[136:139], v22 offset:1664
 v_mfma_f32_16x16x32_bf16 v[48:51], v[140:143], v[108:111], v[48:51]
 v_mfma_f32_16x16x32_bf16 v[56:59], v[140:143], v[132:135], v[56:59]
 s_waitcnt lgkmcnt(2)
 v_mfma_f32_16x16x32_bf16 v[44:47], v[144:147], v[64:67], 0
 ds_read_b128 v[140:143], v23 offset:1664
 v_mfma_f32_16x16x32_bf16 v[52:55], v[144:147], v[88:91], 0
 v_mfma_f32_16x16x32_bf16 v[60:63], v[144:147], v[112:115], 0
 s_waitcnt lgkmcnt(2)
 v_mfma_f32_16x16x32_bf16 v[44:47], v[148:151], v[68:71], v[44:47]
 ds_read_b128 v[144:147], v22 offset:1792
 v_cvt_pk_f16_f32 v188, v40, v41
 v_cvt_pk_f16_f32 v189, v42, v43
 v_cvt_pk_f16_f32 v196, v48, v49
 v_cvt_pk_f16_f32 v197, v50, v51
 v_mfma_f32_16x16x32_bf16 v[52:55], v[148:151], v[92:95], v[52:55]
 v_cvt_pk_f16_f32 v204, v56, v57
 v_cvt_pk_f16_f32 v205, v58, v59
 v_mfma_f32_16x16x32_bf16 v[60:63], v[148:151], v[116:119], v[60:63]
 s_waitcnt lgkmcnt(2)
 v_mfma_f32_16x16x32_bf16 v[44:47], v[136:139], v[72:75], v[44:47]
 ds_read_b128 v[148:151], v23 offset:1792
 v_mfma_f32_16x16x32_bf16 v[52:55], v[136:139], v[96:99], v[52:55]
 v_mfma_f32_16x16x32_bf16 v[60:63], v[136:139], v[120:123], v[60:63]
 s_waitcnt lgkmcnt(2)
 v_mfma_f32_16x16x32_bf16 v[44:47], v[140:143], v[76:79], v[44:47]
 s_waitcnt vmcnt(12)
 ds_read_b128 v[136:139], v22 offset:12288
 v_mfma_f32_16x16x32_bf16 v[52:55], v[140:143], v[100:103], v[52:55]
 v_mfma_f32_16x16x32_bf16 v[60:63], v[140:143], v[124:127], v[60:63]
 s_waitcnt lgkmcnt(2)
 v_mfma_f32_16x16x32_bf16 v[44:47], v[144:147], v[80:83], v[44:47]
 ds_read_b128 v[140:143], v23 offset:12288
 v_mfma_f32_16x16x32_bf16 v[52:55], v[144:147], v[104:107], v[52:55]
 v_mfma_f32_16x16x32_bf16 v[60:63], v[144:147], v[128:131], v[60:63]
 s_waitcnt lgkmcnt(2)
 v_mfma_f32_16x16x32_bf16 v[44:47], v[148:151], v[84:87], v[44:47]
 ds_read_b128 v[144:147], v22 offset:12416
 s_add_u32 m0, s81, 0
 s_add_u32 s21, s88, 4128768
 v_mfma_f32_16x16x32_bf16 v[52:55], v[148:151], v[108:111], v[52:55]
 buffer_load_dwordx4 v28, s[12:15], s21 offen offset:0 lds
 v_mfma_f32_16x16x32_bf16 v[60:63], v[148:151], v[132:135], v[60:63]
 buffer_load_dwordx4 v29, s[12:15], s21 offen offset:1024 lds
 s_waitcnt lgkmcnt(2)
 v_mfma_f32_16x16x32_bf16 v[40:43], v[136:139], v[64:67], 0
 ds_read_b128 v[148:151], v23 offset:12416
 buffer_load_dwordx4 v30, s[12:15], s21 offen offset:2048 lds
 v_mfma_f32_16x16x32_bf16 v[48:51], v[136:139], v[88:91], 0
 s_add_u32 m0, s81, 3072
 s_add_u32 s21, s88, 6094848
 v_mfma_f32_16x16x32_bf16 v[56:59], v[136:139], v[112:115], 0
 buffer_load_dwordx4 v31, s[12:15], s21 offen offset:0 lds
 s_waitcnt lgkmcnt(2)
 v_mfma_f32_16x16x32_bf16 v[40:43], v[140:143], v[68:71], v[40:43]
 ds_read_b128 v[136:139], v22 offset:12544
 v_cvt_pk_f16_f32 v190, v44, v45
 buffer_load_dwordx4 v32, s[12:15], s21 offen offset:1024 lds
 v_cvt_pk_f16_f32 v191, v46, v47
 v_mfma_f32_16x16x32_bf16 v[48:51], v[140:143], v[92:95], v[48:51]
 v_cvt_pk_f16_f32 v198, v52, v53
 buffer_load_dwordx4 v33, s[12:15], s21 offen offset:2048 lds
 v_cvt_pk_f16_f32 v199, v54, v55
 v_cvt_pk_f16_f32 v206, v60, v61
 v_mfma_f32_16x16x32_bf16 v[56:59], v[140:143], v[116:119], v[56:59]
 v_cvt_pk_f16_f32 v207, v62, v63
 s_add_u32 m0, s81, 6144
 s_add_u32 s21, s88, 4620288
 s_waitcnt lgkmcnt(2)
 v_mfma_f32_16x16x32_bf16 v[40:43], v[144:147], v[72:75], v[40:43]
 ds_read_b128 v[140:143], v23 offset:12544
 buffer_load_dwordx4 v34, s[12:15], s21 offen offset:0 lds
 v_mfma_f32_16x16x32_bf16 v[48:51], v[144:147], v[96:99], v[48:51]
 buffer_load_dwordx4 v35, s[12:15], s21 offen offset:1024 lds
 v_mfma_f32_16x16x32_bf16 v[56:59], v[144:147], v[120:123], v[56:59]
 buffer_load_dwordx4 v36, s[12:15], s21 offen offset:2048 lds
 s_waitcnt lgkmcnt(2)
 v_mfma_f32_16x16x32_bf16 v[40:43], v[148:151], v[76:79], v[40:43]
 ds_read_b128 v[144:147], v22 offset:13824
 s_add_u32 m0, s81, 9216
 s_add_u32 s21, s88, 6586368
 v_mfma_f32_16x16x32_bf16 v[48:51], v[148:151], v[100:103], v[48:51]
 buffer_load_dwordx4 v37, s[12:15], s21 offen offset:0 lds
 v_mfma_f32_16x16x32_bf16 v[56:59], v[148:151], v[124:127], v[56:59]
 buffer_load_dwordx4 v38, s[12:15], s21 offen offset:1024 lds
 s_waitcnt lgkmcnt(2)
 v_mfma_f32_16x16x32_bf16 v[40:43], v[136:139], v[80:83], v[40:43]
 ds_read_b128 v[148:151], v23 offset:13824
 buffer_load_dwordx4 v39, s[12:15], s21 offen offset:2048 lds
 v_mfma_f32_16x16x32_bf16 v[48:51], v[136:139], v[104:107], v[48:51]
 v_mfma_f32_16x16x32_bf16 v[56:59], v[136:139], v[128:131], v[56:59]
 s_waitcnt lgkmcnt(2)
 v_mfma_f32_16x16x32_bf16 v[40:43], v[140:143], v[84:87], v[40:43]
 ds_read_b128 v[136:139], v22 offset:13952
 v_mfma_f32_16x16x32_bf16 v[48:51], v[140:143], v[108:111], v[48:51]
 v_mfma_f32_16x16x32_bf16 v[56:59], v[140:143], v[132:135], v[56:59]
 s_waitcnt lgkmcnt(2)
 v_mfma_f32_16x16x32_bf16 v[44:47], v[144:147], v[64:67], 0
 ds_read_b128 v[140:143], v23 offset:13952
 v_mfma_f32_16x16x32_bf16 v[52:55], v[144:147], v[88:91], 0
 v_mfma_f32_16x16x32_bf16 v[60:63], v[144:147], v[112:115], 0
 s_waitcnt lgkmcnt(2)
 v_mfma_f32_16x16x32_bf16 v[44:47], v[148:151], v[68:71], v[44:47]
 ds_read_b128 v[144:147], v22 offset:14080
 v_cvt_pk_f16_f32 v208, v40, v41
 v_cvt_pk_f16_f32 v209, v42, v43
 v_cvt_pk_f16_f32 v216, v48, v49
 v_cvt_pk_f16_f32 v217, v50, v51
 v_mfma_f32_16x16x32_bf16 v[52:55], v[148:151], v[92:95], v[52:55]
 v_cvt_pk_f16_f32 v224, v56, v57
 v_cvt_pk_f16_f32 v225, v58, v59
 v_mfma_f32_16x16x32_bf16 v[60:63], v[148:151], v[116:119], v[60:63]
 s_waitcnt lgkmcnt(2)
 v_mfma_f32_16x16x32_bf16 v[44:47], v[136:139], v[72:75], v[44:47]
 ds_read_b128 v[148:151], v23 offset:14080
 v_mfma_f32_16x16x32_bf16 v[52:55], v[136:139], v[96:99], v[52:55]
 v_mfma_f32_16x16x32_bf16 v[60:63], v[136:139], v[120:123], v[60:63]
 s_waitcnt lgkmcnt(2)
 v_mfma_f32_16x16x32_bf16 v[44:47], v[140:143], v[76:79], v[44:47]
 s_waitcnt vmcnt(12)
 ds_read_b128 v[136:139], v22 offset:24576
 v_mfma_f32_16x16x32_bf16 v[52:55], v[140:143], v[100:103], v[52:55]
 v_mfma_f32_16x16x32_bf16 v[60:63], v[140:143], v[124:127], v[60:63]
 s_waitcnt lgkmcnt(2)
 v_mfma_f32_16x16x32_bf16 v[44:47], v[144:147], v[80:83], v[44:47]
 ds_read_b128 v[140:143], v23 offset:24576
 v_mfma_f32_16x16x32_bf16 v[52:55], v[144:147], v[104:107], v[52:55]
 v_mfma_f32_16x16x32_bf16 v[60:63], v[144:147], v[128:131], v[60:63]
 s_waitcnt lgkmcnt(2)
 v_mfma_f32_16x16x32_bf16 v[44:47], v[148:151], v[84:87], v[44:47]
 ds_read_b128 v[144:147], v22 offset:24704
 s_add_u32 m0, s81, 12288
 s_add_u32 s21, s88, 5111808
 v_mfma_f32_16x16x32_bf16 v[52:55], v[148:151], v[108:111], v[52:55]
 buffer_load_dwordx4 v28, s[12:15], s21 offen offset:0 lds
 v_mfma_f32_16x16x32_bf16 v[60:63], v[148:151], v[132:135], v[60:63]
 buffer_load_dwordx4 v29, s[12:15], s21 offen offset:1024 lds
 s_waitcnt lgkmcnt(2)
 v_mfma_f32_16x16x32_bf16 v[40:43], v[136:139], v[64:67], 0
 ds_read_b128 v[148:151], v23 offset:24704
 buffer_load_dwordx4 v30, s[12:15], s21 offen offset:2048 lds
 v_mfma_f32_16x16x32_bf16 v[48:51], v[136:139], v[88:91], 0
 s_add_u32 m0, s81, 15360
 s_add_u32 s21, s88, 7077888
 v_mfma_f32_16x16x32_bf16 v[56:59], v[136:139], v[112:115], 0
 buffer_load_dwordx4 v31, s[12:15], s21 offen offset:0 lds
 s_waitcnt lgkmcnt(2)
 v_mfma_f32_16x16x32_bf16 v[40:43], v[140:143], v[68:71], v[40:43]
 ds_read_b128 v[136:139], v22 offset:24832
 v_cvt_pk_f16_f32 v210, v44, v45
 buffer_load_dwordx4 v32, s[12:15], s21 offen offset:1024 lds
 v_cvt_pk_f16_f32 v211, v46, v47
 v_mfma_f32_16x16x32_bf16 v[48:51], v[140:143], v[92:95], v[48:51]
 v_cvt_pk_f16_f32 v218, v52, v53
 buffer_load_dwordx4 v33, s[12:15], s21 offen offset:2048 lds
 v_cvt_pk_f16_f32 v219, v54, v55
 v_cvt_pk_f16_f32 v226, v60, v61
 v_mfma_f32_16x16x32_bf16 v[56:59], v[140:143], v[116:119], v[56:59]
 v_cvt_pk_f16_f32 v227, v62, v63
 s_add_u32 m0, s81, 18432
 s_add_u32 s21, s88, 5603328
 s_waitcnt lgkmcnt(2)
 v_mfma_f32_16x16x32_bf16 v[40:43], v[144:147], v[72:75], v[40:43]
 ds_read_b128 v[140:143], v23 offset:24832
 buffer_load_dwordx4 v34, s[12:15], s21 offen offset:0 lds
 v_mfma_f32_16x16x32_bf16 v[48:51], v[144:147], v[96:99], v[48:51]
 buffer_load_dwordx4 v35, s[12:15], s21 offen offset:1024 lds
 v_mfma_f32_16x16x32_bf16 v[56:59], v[144:147], v[120:123], v[56:59]
 buffer_load_dwordx4 v36, s[12:15], s21 offen offset:2048 lds
 s_waitcnt lgkmcnt(2)
 v_mfma_f32_16x16x32_bf16 v[40:43], v[148:151], v[76:79], v[40:43]
 ds_read_b128 v[144:147], v22 offset:26112
 s_add_u32 m0, s81, 21504
 s_add_u32 s21, s88, 7569408
 v_mfma_f32_16x16x32_bf16 v[48:51], v[148:151], v[100:103], v[48:51]
 buffer_load_dwordx4 v37, s[12:15], s21 offen offset:0 lds
 v_mfma_f32_16x16x32_bf16 v[56:59], v[148:151], v[124:127], v[56:59]
 buffer_load_dwordx4 v38, s[12:15], s21 offen offset:1024 lds
 s_waitcnt lgkmcnt(2)
 v_mfma_f32_16x16x32_bf16 v[40:43], v[136:139], v[80:83], v[40:43]
 ds_read_b128 v[148:151], v23 offset:26112
 buffer_load_dwordx4 v39, s[12:15], s21 offen offset:2048 lds
 v_mfma_f32_16x16x32_bf16 v[48:51], v[136:139], v[104:107], v[48:51]
 v_mfma_f32_16x16x32_bf16 v[56:59], v[136:139], v[128:131], v[56:59]
 s_waitcnt lgkmcnt(2)
 v_mfma_f32_16x16x32_bf16 v[40:43], v[140:143], v[84:87], v[40:43]
 ds_read_b128 v[136:139], v22 offset:26240
 v_mfma_f32_16x16x32_bf16 v[48:51], v[140:143], v[108:111], v[48:51]
 v_mfma_f32_16x16x32_bf16 v[56:59], v[140:143], v[132:135], v[56:59]
 s_waitcnt lgkmcnt(2)
 v_mfma_f32_16x16x32_bf16 v[44:47], v[144:147], v[64:67], 0
 ds_read_b128 v[140:143], v23 offset:26240
 v_mfma_f32_16x16x32_bf16 v[52:55], v[144:147], v[88:91], 0
 v_mfma_f32_16x16x32_bf16 v[60:63], v[144:147], v[112:115], 0
 s_waitcnt lgkmcnt(2)
 v_mfma_f32_16x16x32_bf16 v[44:47], v[148:151], v[68:71], v[44:47]
 ds_read_b128 v[144:147], v22 offset:26368
 v_cvt_pk_f16_f32 v212, v40, v41
 v_cvt_pk_f16_f32 v213, v42, v43
 v_cvt_pk_f16_f32 v220, v48, v49
 v_cvt_pk_f16_f32 v221, v50, v51
 v_mfma_f32_16x16x32_bf16 v[52:55], v[148:151], v[92:95], v[52:55]
 v_cvt_pk_f16_f32 v228, v56, v57
 v_cvt_pk_f16_f32 v229, v58, v59
 v_mfma_f32_16x16x32_bf16 v[60:63], v[148:151], v[116:119], v[60:63]
 s_waitcnt lgkmcnt(2)
 v_mfma_f32_16x16x32_bf16 v[44:47], v[136:139], v[72:75], v[44:47]
 ds_read_b128 v[148:151], v23 offset:26368
 v_mfma_f32_16x16x32_bf16 v[52:55], v[136:139], v[96:99], v[52:55]
 v_mfma_f32_16x16x32_bf16 v[60:63], v[136:139], v[120:123], v[60:63]
 s_waitcnt lgkmcnt(2)
 v_mfma_f32_16x16x32_bf16 v[44:47], v[140:143], v[76:79], v[44:47]
 s_waitcnt vmcnt(12)
 ds_read_b128 v[136:139], v22 offset:0
 v_mfma_f32_16x16x32_bf16 v[52:55], v[140:143], v[100:103], v[52:55]
 v_mfma_f32_16x16x32_bf16 v[60:63], v[140:143], v[124:127], v[60:63]
 s_waitcnt lgkmcnt(2)
 v_mfma_f32_16x16x32_bf16 v[44:47], v[144:147], v[80:83], v[44:47]
 ds_read_b128 v[140:143], v23 offset:0
 v_mfma_f32_16x16x32_bf16 v[52:55], v[144:147], v[104:107], v[52:55]
 v_mfma_f32_16x16x32_bf16 v[60:63], v[144:147], v[128:131], v[60:63]
 s_waitcnt lgkmcnt(2)
 v_mfma_f32_16x16x32_bf16 v[44:47], v[148:151], v[84:87], v[44:47]
 ds_read_b128 v[144:147], v22 offset:128
 v_mfma_f32_16x16x32_bf16 v[52:55], v[148:151], v[108:111], v[52:55]
 v_mfma_f32_16x16x32_bf16 v[60:63], v[148:151], v[132:135], v[60:63]
 s_mov_b32 s101, 0
 s_branch fm_8
fm_7:
 s_sleep 8
 buffer_load_dword v0, v26, s[32:35], 0 offen sc1
 s_add_u32 s101, s101, 1
 s_cmp_gt_u32 s101, 131072
 s_cbranch_scc1 end0
 s_waitcnt vmcnt(0)
fm_8:
 v_readlane_b32 s22, v0, 0
 v_readlane_b32 s23, v0, 32
 s_add_u32 s22, s22, s23
 v_readlane_b32 s23, v0, 1
 s_add_u32 s22, s22, s23
 v_readlane_b32 s23, v0, 33
 s_add_u32 s22, s22, s23
 v_readlane_b32 s23, v0, 2
 s_add_u32 s22, s22, s23
 v_readlane_b32 s23, v0, 34
 s_add_u32 s22, s22, s23
 v_readlane_b32 s23, v0, 3
 s_add_u32 s22, s22, s23
 v_readlane_b32 s23, v0, 35
 s_add_u32 s22, s22, s23
 v_readlane_b32 s21, v0, 19
 v_readlane_b32 s23, v0, 21
 s_cmp_ge_u32 s22, 256
 s_cselect_b32 s23, s23, 0
 s_cmp_ge_u32 s21, 32
 s_cselect_b32 s23, s23, 0
 s_cmp_eq_u32 s23, 0
 s_cbranch_scc1 fm_7
 v_readlane_b32 s21, v0, s82
 s_cmp_ge_u32 s21, s83
 s_cselect_b32 s21, 1, 0
 s_andn2_b32 s53, s21, s53
 s_sub_u32 s23, s23, 1
 s_lshl_b32 s23, s23, 13
 v_add_u32 v13, s23, v13
 v_add_u32 v4, s23, v4
 s_add_u32 s12, s44, 81068032
 s_addc_u32 s13, s45, 0
 s_mov_b32 s14, 128000
 s_mov_b32 s15, 0x00020000
 v_and_b32 v27, 7, v2
 v_mul_u32_u24 v27, 1280, v27
 v_lshrrev_b32 v39, 3, v1
 v_mul_u32_u24 v39, 40, v39
 s_mul_i32 s21, s20, 320
 v_add3_u32 v27, v27, v39, s21
 buffer_load_dwordx4 v[28:31], v27, s[28:31], 0 offen offset:0
 buffer_load_dwordx4 v[32:35], v27, s[28:31], 0 offen offset:16
 buffer_load_dwordx2 v[36:37], v27, s[28:31], 0 offen offset:32
 s_and_b32 s21, s51, 3
 s_mul_i32 s21, s21, 540672
 buffer_load_dword v38, v9, s[8:11], s21 offen sc1
 buffer_load_dword v38, v8, s[8:11], s21 offen offset:0 sc1
 buffer_load_dword v38, v8, s[8:11], s21 offen offset:1024 sc1
 s_waitcnt lgkmcnt(2)
 v_mfma_f32_16x16x32_bf16 v[40:43], v[136:139], v[64:67], 0
 ds_read_b128 v[148:151], v23 offset:128
 v_mfma_f32_16x16x32_bf16 v[48:51], v[136:139], v[88:91], 0
 v_mfma_f32_16x16x32_bf16 v[56:59], v[136:139], v[112:115], 0
 s_waitcnt lgkmcnt(2)
 v_mfma_f32_16x16x32_bf16 v[40:43], v[140:143], v[68:71], v[40:43]
 ds_read_b128 v[136:139], v22 offset:256
 v_cvt_pk_f16_f32 v214, v44, v45
 v_cvt_pk_f16_f32 v215, v46, v47
 v_cvt_pk_f16_f32 v222, v52, v53
 v_cvt_pk_f16_f32 v223, v54, v55
 v_mfma_f32_16x16x32_bf16 v[48:51], v[140:143], v[92:95], v[48:51]
 v_cvt_pk_f16_f32 v230, v60, v61
 v_cvt_pk_f16_f32 v231, v62, v63
 v_mfma_f32_16x16x32_bf16 v[56:59], v[140:143], v[116:119], v[56:59]
 s_waitcnt lgkmcnt(2)
 v_mfma_f32_16x16x32_bf16 v[40:43], v[144:147], v[72:75], v[40:43]
 ds_read_b128 v[140:143], v23 offset:256
 v_mfma_f32_16x16x32_bf16 v[48:51], v[144:147], v[96:99], v[48:51]
 v_mfma_f32_16x16x32_bf16 v[56:59], v[144:147], v[120:123], v[56:59]
 s_waitcnt lgkmcnt(2)
 v_mfma_f32_16x16x32_bf16 v[40:43], v[148:151], v[76:79], v[40:43]
 ds_read_b128 v[144:147], v22 offset:1536
 v_mfma_f32_16x16x32_bf16 v[48:51], v[148:151], v[100:103], v[48:51]
 v_mfma_f32_16x16x32_bf16 v[56:59], v[148:151], v[124:127], v[56:59]
 s_waitcnt lgkmcnt(2)
 v_mfma_f32_16x16x32_bf16 v[40:43], v[136:139], v[80:83], v[40:43]
 ds_read_b128 v[148:151], v23 offset:1536
 v_mfma_f32_16x16x32_bf16 v[48:51], v[136:139], v[104:107], v[48:51]
 v_mfma_f32_16x16x32_bf16 v[56:59], v[136:139], v[128:131], v[56:59]
 s_waitcnt lgkmcnt(2)
 v_mfma_f32_16x16x32_bf16 v[40:43], v[140:143], v[84:87], v[40:43]
 ds_read_b128 v[136:139], v22 offset:1664
 v_mfma_f32_16x16x32_bf16 v[48:51], v[140:143], v[108:111], v[48:51]
 v_mfma_f32_16x16x32_bf16 v[56:59], v[140:143], v[132:135], v[56:59]
 s_waitcnt lgkmcnt(2)
 v_mfma_f32_16x16x32_bf16 v[44:47], v[144:147], v[64:67], 0
 ds_read_b128 v[140:143], v23 offset:1664
 v_mfma_f32_16x16x32_bf16 v[52:55], v[144:147], v[88:91], 0
 v_mfma_f32_16x16x32_bf16 v[60:63], v[144:147], v[112:115], 0
 s_waitcnt lgkmcnt(2)
 v_mfma_f32_16x16x32_bf16 v[44:47], v[148:151], v[68:71], v[44:47]
 ds_read_b128 v[144:147], v22 offset:1792
 v_cvt_pk_f16_f32 v232, v40, v41
 v_cvt_pk_f16_f32 v233, v42, v43
 v_cvt_pk_f16_f32 v240, v48, v49
 v_cvt_pk_f16_f32 v241, v50, v51
 v_mfma_f32_16x16x32_bf16 v[52:55], v[148:151], v[92:95], v[52:55]
 v_cvt_pk_f16_f32 v248, v56, v57
 v_cvt_pk_f16_f32 v249, v58, v59
 v_mfma_f32_16x16x32_bf16 v[60:63], v[148:151], v[116:119], v[60:63]
 s_waitcnt lgkmcnt(2)
 v_mfma_f32_16x16x32_bf16 v[44:47], v[136:139], v[72:75], v[44:47]
 ds_read_b128 v[148:151], v23 offset:1792
 v_mfma_f32_16x16x32_bf16 v[52:55], v[136:139], v[96:99], v[52:55]
 v_mfma_f32_16x16x32_bf16 v[60:63], v[136:139], v[120:123], v[60:63]
 s_waitcnt lgkmcnt(2)
 v_mfma_f32_16x16x32_bf16 v[44:47], v[140:143], v[76:79], v[44:47]
 s_waitcnt vmcnt(6)
 ds_read_b128 v[136:139], v22 offset:12288
 v_mfma_f32_16x16x32_bf16 v[52:55], v[140:143], v[100:103], v[52:55]
 v_mfma_f32_16x16x32_bf16 v[60:63], v[140:143], v[124:127], v[60:63]
 s_waitcnt lgkmcnt(2)
 v_mfma_f32_16x16x32_bf16 v[44:47], v[144:147], v[80:83], v[44:47]
 ds_read_b128 v[140:143], v23 offset:12288
 v_mfma_f32_16x16x32_bf16 v[52:55], v[144:147], v[104:107], v[52:55]
 v_mfma_f32_16x16x32_bf16 v[60:63], v[144:147], v[128:131], v[60:63]
 s_waitcnt lgkmcnt(2)
 v_mfma_f32_16x16x32_bf16 v[44:47], v[148:151], v[84:87], v[44:47]
 ds_read_b128 v[144:147], v22 offset:12416
 v_mfma_f32_16x16x32_bf16 v[52:55], v[148:151], v[108:111], v[52:55]
 v_mfma_f32_16x16x32_bf16 v[60:63], v[148:151], v[132:135], v[60:63]
 buffer_load_dword v0, off, s[12:15], s79 sc1
 s_waitcnt lgkmcnt(2)
 v_mfma_f32_16x16x32_bf16 v[40:43], v[136:139], v[64:67], 0
 ds_read_b128 v[148:151], v23 offset:12416
 v_mfma_f32_16x16x32_bf16 v[48:51], v[136:139], v[88:91], 0
 v_mfma_f32_16x16x32_bf16 v[56:59], v[136:139], v[112:115], 0
 s_waitcnt lgkmcnt(2)
 v_mfma_f32_16x16x32_bf16 v[40:43], v[140:143], v[68:71], v[40:43]
 ds_read_b128 v[136:139], v22 offset:12544
 v_cvt_pk_f16_f32 v234, v44, v45
 v_cvt_pk_f16_f32 v235, v46, v47
 v_cvt_pk_f16_f32 v242, v52, v53
 v_cvt_pk_f16_f32 v243, v54, v55
 v_mfma_f32_16x16x32_bf16 v[48:51], v[140:143], v[92:95], v[48:51]
 v_cvt_pk_f16_f32 v250, v60, v61
 v_cvt_pk_f16_f32 v251, v62, v63
 v_mfma_f32_16x16x32_bf16 v[56:59], v[140:143], v[116:119], v[56:59]
 s_waitcnt lgkmcnt(2)
 v_mfma_f32_16x16x32_bf16 v[40:43], v[144:147], v[72:75], v[40:43]
 ds_read_b128 v[140:143], v23 offset:12544
 v_mfma_f32_16x16x32_bf16 v[48:51], v[144:147], v[96:99], v[48:51]
 v_mfma_f32_16x16x32_bf16 v[56:59], v[144:147], v[120:123], v[56:59]
 s_waitcnt lgkmcnt(2)
 v_mfma_f32_16x16x32_bf16 v[40:43], v[148:151], v[76:79], v[40:43]
 ds_read_b128 v[144:147], v22 offset:13824
 v_mfma_f32_16x16x32_bf16 v[48:51], v[148:151], v[100:103], v[48:51]
 v_mfma_f32_16x16x32_bf16 v[56:59], v[148:151], v[124:127], v[56:59]
 s_waitcnt lgkmcnt(2)
 v_mfma_f32_16x16x32_bf16 v[40:43], v[136:139], v[80:83], v[40:43]
 ds_read_b128 v[148:151], v23 offset:13824
 v_mfma_f32_16x16x32_bf16 v[48:51], v[136:139], v[104:107], v[48:51]
 v_mfma_f32_16x16x32_bf16 v[56:59], v[136:139], v[128:131], v[56:59]
 s_waitcnt lgkmcnt(2)
 v_mfma_f32_16x16x32_bf16 v[40:43], v[140:143], v[84:87], v[40:43]
 ds_read_b128 v[136:139], v22 offset:13952
 v_mfma_f32_16x16x32_bf16 v[48:51], v[140:143], v[108:111], v[48:51]
 v_mfma_f32_16x16x32_bf16 v[56:59], v[140:143], v[132:135], v[56:59]
 s_waitcnt lgkmcnt(2)
 v_mfma_f32_16x16x32_bf16 v[44:47], v[144:147], v[64:67], 0
 ds_read_b128 v[140:143], v23 offset:13952
 v_mfma_f32_16x16x32_bf16 v[52:55], v[144:147], v[88:91], 0
 v_mfma_f32_16x16x32_bf16 v[60:63], v[144:147], v[112:115], 0
 s_waitcnt lgkmcnt(2)
 v_mfma_f32_16x16x32_bf16 v[44:47], v[148:151], v[68:71], v[44:47]
 ds_read_b128 v[144:147], v22 offset:14080
 v_cvt_pk_f16_f32 v236, v40, v41
 v_cvt_pk_f16_f32 v237, v42, v43
 v_cvt_pk_f16_f32 v244, v48, v49
 v_cvt_pk_f16_f32 v245, v50, v51
 v_mfma_f32_16x16x32_bf16 v[52:55], v[148:151], v[92:95], v[52:55]
 v_cvt_pk_f16_f32 v252, v56, v57
 v_cvt_pk_f16_f32 v253, v58, v59
 v_mfma_f32_16x16x32_bf16 v[60:63], v[148:151], v[116:119], v[60:63]
 s_waitcnt lgkmcnt(2)
 v_mfma_f32_16x16x32_bf16 v[44:47], v[136:139], v[72:75], v[44:47]
 ds_read_b128 v[148:151], v23 offset:14080
 v_mfma_f32_16x16x32_bf16 v[52:55], v[136:139], v[96:99], v[52:55]
 v_mfma_f32_16x16x32_bf16 v[60:63], v[136:139], v[120:123], v[60:63]
 s_waitcnt lgkmcnt(2)
 v_mfma_f32_16x16x32_bf16 v[44:47], v[140:143], v[76:79], v[44:47]
 v_mfma_f32_16x16x32_bf16 v[52:55], v[140:143], v[100:103], v[52:55]
 v_mfma_f32_16x16x32_bf16 v[60:63], v[140:143], v[124:127], v[60:63]
 s_waitcnt lgkmcnt(1)
 v_mfma_f32_16x16x32_bf16 v[44:47], v[144:147], v[80:83], v[44:47]
 v_mfma_f32_16x16x32_bf16 v[52:55], v[144:147], v[104:107], v[52:55]
 v_mfma_f32_16x16x32_bf16 v[60:63], v[144:147], v[128:131], v[60:63]
 s_waitcnt lgkmcnt(0)
 v_mfma_f32_16x16x32_bf16 v[44:47], v[148:151], v[84:87], v[44:47]
 v_mfma_f32_16x16x32_bf16 v[52:55], v[148:151], v[108:111], v[52:55]
 v_mfma_f32_16x16x32_bf16 v[60:63], v[148:151], v[132:135], v[60:63]
 s_nop 7
 v_cvt_pk_f16_f32 v238, v44, v45
 v_cvt_pk_f16_f32 v239, v46, v47
 v_cvt_pk_f16_f32 v246, v52, v53
 v_cvt_pk_f16_f32 v247, v54, v55
 v_cvt_pk_f16_f32 v254, v60, v61
 v_cvt_pk_f16_f32 v255, v62, v63
 s_add_u32 s28, s44, 122683392
 s_addc_u32 s29, s45, 0
 s_mov_b32 s30, 83886080
 s_mov_b32 s31, 0x00020000
 s_waitcnt vmcnt(0)
 v_readfirstlane_b32 s21, v0
 s_cmp_lg_u32 s21, 0
 s_cbranch_scc1 pf_10
 v_mov_b32 v62, 0
 s_mov_b32 s101, 0
wf_11:
 buffer_load_dword v63, v62, s[12:15], s79 offen sc1
 s_add_u32 s101, s101, 1
 s_cmp_gt_u32 s101, 131072
 s_cbranch_scc1 end0
 s_waitcnt vmcnt(0)
 v_readfirstlane_b32 s100, v63
 s_cmp_ge_u32 s100, 1
 s_cbranch_scc1 wf_12
 s_sleep 4
 s_branch wf_11
wf_12:
 v_mov_b32 v0, s100
pf_10:
 s_mov_b32 s87, 0
 s_sub_u32 s21, s64, 1310720
 s_cmp_ge_u32 s20, 2
 s_cbranch_scc1 pf_9
 buffer_load_dwordx4 v[112:115], v18, s[16:19], 0 offen sc1
 buffer_load_dwordx2 v[116:117], v19, s[16:19], 0 offen sc1
pf_9:
 buffer_load_dwordx4 v[126:129], v16, s[28:31], s21 offen offset:0 sc1
 buffer_load_dwordx4 v[130:133], v16, s[28:31], s21 offen offset:1024 sc1
 buffer_load_dwordx4 v[134:137], v16, s[28:31], s21 offen offset:2048 sc1
 v_lshlrev_b32 v27, 16, v28
 v_and_b32 v28, 0xffff0000, v28
 v_cvt_pk_f16_f32 v28, v27, v28
 v_lshlrev_b32 v27, 16, v29
 v_and_b32 v29, 0xffff0000, v29
 v_cvt_pk_f16_f32 v29, v27, v29
 v_lshlrev_b32 v27, 16, v30
 v_and_b32 v30, 0xffff0000, v30
 v_cvt_pk_f16_f32 v30, v27, v30
 v_lshlrev_b32 v27, 16, v31
 v_and_b32 v31, 0xffff0000, v31
 v_cvt_pk_f16_f32 v31, v27, v31
 v_lshlrev_b32 v27, 16, v32
 v_and_b32 v32, 0xffff0000, v32
 v_cvt_pk_f16_f32 v32, v27, v32
 v_lshlrev_b32 v27, 16, v33
 v_and_b32 v33, 0xffff0000, v33
 v_cvt_pk_f16_f32 v33, v27, v33
 v_lshlrev_b32 v27, 16, v34
 v_and_b32 v34, 0xffff0000, v34
 v_cvt_pk_f16_f32 v34, v27, v34
 v_lshlrev_b32 v27, 16, v35
 v_and_b32 v35, 0xffff0000, v35
 v_cvt_pk_f16_f32 v35, v27, v35
 v_lshlrev_b32 v27, 16, v36
 v_and_b32 v36, 0xffff0000, v36
 v_cvt_pk_f16_f32 v36, v27, v36
 v_lshlrev_b32 v27, 16, v37
 v_and_b32 v37, 0xffff0000, v37
 v_cvt_pk_f16_f32 v37, v27, v37
 s_lshl_b32 s21, s20, 2
 s_add_u32 s21, s21, 20480
 v_add_u32 v22, s21, v16
 v_bfe_u32 v23, v1, 2, 3
 v_lshlrev_b32 v23, 4, v23
 v_add_u32 v23, 20480, v23
 v_cmp_gt_u32 vcc, 2, v3
 s_mov_b32 s52, 0
 s_mov_b32 s89, 0x05040100
 v_cndmask_b32 v26, 0, 1.0, vcc
 v_mov_b32 v124, 0
 v_mov_b32 v125, 0
 v_mov_b32 v144, 0
 v_mov_b32 v145, 0
 v_mov_b32 v40, 0
 v_mov_b32 v41, 0
 v_mov_b32 v42, 0
 v_mov_b32 v43, 0
 v_mov_b32 v44, 0
 v_mov_b32 v45, 0
 v_mov_b32 v46, 0
 v_mov_b32 v47, 0
 v_mov_b32 v48, 0
 v_mov_b32 v49, 0
 v_mov_b32 v50, 0
 v_mov_b32 v51, 0
 v_mov_b32 v52, 0
 v_mov_b32 v53, 0
 v_mov_b32 v54, 0
 v_mov_b32 v55, 0
 v_mov_b32 v56, 0
 v_mov_b32 v57, 0
 v_mov_b32 v58, 0
 v_mov_b32 v59, 0
 v_mov_b32 v60, 0
 v_mov_b32 v61, 0
 v_mov_b32 v62, 0
 v_mov_b32 v63, 0
 v_mov_b32 v100, 0
 v_mov_b32 v101, 0
 v_mov_b32 v102, 0
 v_mov_b32 v103, 0
 v_mov_b32 v104, 0
 v_mov_b32 v105, 0
 v_mov_b32 v106, 0
 v_mov_b32 v107, 0
 v_mov_b32 v108, 0
 v_mov_b32 v109, 0
 v_mov_b32 v110, 0
 v_mov_b32 v111, 0
 s_barrier
 s_and_b32 s21, s52, 3
 s_mul_i32 s81, s21, 540672
 s_lshl_b32 s84, s21, 15
 s_add_u32 s21, s52, 3
 s_and_b32 s21, s21, 3
 s_lshl_b32 s83, s21, 15
 s_add_u32 s21, s52, 1
 s_and_b32 s22, s21, 3
 s_lshl_b32 s3, s22, 15
 s_mul_i32 s80, s21, 393216
 s_add_u32 s46, s21, 1
 s_min_u32 s46, s46, 64
 s_mul_i32 s85, s52, 98304
 s_mul_i32 s57, s52, 327680
 s_add_u32 s57, s57, 51380224
 s_bfe_u32 s88, s52, 0x10002
 s_max_u32 s67, s52, 1
 s_sub_u32 s67, s67, 1
 s_cmp_eq_u32 s53, 0
 s_cbranch_scc1 A1_17
 s_cmp_eq_u32 s20, 0
 s_cbranch_scc1 A1_13
 s_cmp_eq_u32 s20, 1
 s_cbranch_scc1 A1_14
 s_cmp_eq_u32 s20, 2
 s_cbranch_scc1 A1_15
 s_cmp_eq_u32 s20, 3
 s_cbranch_scc1 A1_16
 s_branch A1_17
step_18:
 s_and_b32 s21, s52, 3
 s_mul_i32 s81, s21, 540672
 s_lshl_b32 s84, s21, 15
 s_add_u32 s21, s52, 3
 s_and_b32 s21, s21, 3
 s_lshl_b32 s83, s21, 15
 s_add_u32 s21, s52, 1
 s_and_b32 s22, s21, 3
 s_lshl_b32 s3, s22, 15
 s_mul_i32 s80, s21, 393216
 s_add_u32 s46, s21, 1
 s_min_u32 s46, s46, 64
 s_mul_i32 s85, s52, 98304
 s_mul_i32 s57, s52, 327680
 s_add_u32 s57, s57, 51380224
 s_bfe_u32 s88, s52, 0x10002
 s_max_u32 s67, s52, 1
 s_sub_u32 s67, s67, 1
 v_mov_b32 v40, 0
 v_mov_b32 v41, 0
 v_mov_b32 v42, 0
 v_mov_b32 v43, 0
 v_mov_b32 v44, 0
 v_mov_b32 v45, 0
 v_mov_b32 v46, 0
 v_mov_b32 v47, 0
 v_mov_b32 v48, 0
 v_mov_b32 v49, 0
 v_mov_b32 v50, 0
 v_mov_b32 v51, 0
 v_mov_b32 v52, 0
 v_mov_b32 v53, 0
 v_mov_b32 v54, 0
 v_mov_b32 v55, 0
 v_mov_b32 v56, 0
 v_mov_b32 v57, 0
 v_mov_b32 v58, 0
 v_mov_b32 v59, 0
 v_mov_b32 v60, 0
 v_mov_b32 v61, 0
 v_mov_b32 v62, 0
 v_mov_b32 v63, 0
 v_mov_b32 v100, 0
 v_mov_b32 v101, 0
 v_mov_b32 v102, 0
 v_mov_b32 v103, 0
 v_mov_b32 v104, 0
 v_mov_b32 v105, 0
 v_mov_b32 v106, 0
 v_mov_b32 v107, 0
 v_mov_b32 v108, 0
 v_mov_b32 v109, 0
 v_mov_b32 v110, 0
 v_mov_b32 v111, 0
 s_sleep 5
 v_readfirstlane_b32 s21, v0
 s_cmp_lt_u32 s21, s46
 s_cselect_b32 s55, s55, 0
 s_cmp_lt_i32 s55, 0
 s_cbranch_scc1 fl_23
fl_24:
 s_mov_b32 s54, 0
 buffer_load_dwordx4 v[36:39], v4, s[4:7], s84 offen offset:2048 sc1
 buffer_load_dwordx4 v[28:31], v4, s[4:7], s84 offen offset:0 sc1
 buffer_load_dwordx4 v[32:35], v4, s[4:7], s84 offen offset:1024 sc1
 s_waitcnt vmcnt(3)
 v_mov_b32 v126, v88
 v_mov_b32 v127, v89
 v_mov_b32 v128, v90
 v_mov_b32 v129, v91
 v_mov_b32 v130, v92
 v_mov_b32 v131, v93
 v_mov_b32 v132, v94
 v_mov_b32 v133, v95
 v_mov_b32 v134, v96
 v_mov_b32 v135, v97
 v_mov_b32 v136, v98
 v_mov_b32 v137, v99
 s_waitcnt vmcnt(2)
 v_smfmac_f32_16x16x32_f16 v[40:43], v[36:37], a[16:19], v25
 v_smfmac_f32_16x16x32_f16 v[52:55], v[36:37], a[76:79], v25
 v_smfmac_f32_16x16x32_f16 v[44:47], v[36:37], a[36:39], v25
 s_waitcnt vmcnt(0)
 v_bitop3_b32 v27, v31, v35, v39 bitop3:0x80
 v_perm_b32 v31, v35, v31, s89
 v_cmp_gt_u32 vcc, 0x48000000, v27
 v_mov_b32 v35, v38
 v_smfmac_f32_16x16x32_f16 v[56:59], v[36:37], a[96:99], v25
 s_cbranch_vccnz pm_21
A2_22:
 v_smfmac_f32_16x16x64_f16 v[40:43], v[28:31], a[0:7], v25
 ds_write_b128 v10, v[28:31]
 v_smfmac_f32_16x16x64_f16 v[40:43], v[32:35], a[8:15], v25
 ds_write_b128 v10, v[32:35] offset:1024
 v_smfmac_f32_16x16x64_f16 v[52:55], v[28:31], a[60:67], v25
 ds_write_b64 v10, v[36:37] offset:2048
 v_smfmac_f32_16x16x64_f16 v[52:55], v[32:35], a[68:75], v25
 v_cvt_pk_f16_f32 v40, v40, v41
 v_cvt_pk_f16_f32 v41, v42, v43
 v_smfmac_f32_16x16x32_f16 v[48:51], v[36:37], a[56:59], v25
 v_smfmac_f32_16x16x32_f16 v[60:63], v[36:37], a[116:119], v25
 v_smfmac_f32_16x16x64_f16 v[44:47], v[28:31], a[20:27], v25
 v_cvt_pk_f16_f32 v52, v52, v53
 v_cvt_pk_f16_f32 v53, v54, v55
 s_nop 0
 v_smfmac_f32_16x16x64_f16 v[44:47], v[32:35], a[28:35], v25
 v_permlane32_swap_b32 v40, v52
 v_smfmac_f32_16x16x64_f16 v[56:59], v[28:31], a[80:87], v25
 v_permlane32_swap_b32 v41, v53
 v_pk_add_f16 v40, v40, v52
 v_smfmac_f32_16x16x64_f16 v[56:59], v[32:35], a[88:95], v25
 v_pk_add_f16 v41, v41, v53
 v_smfmac_f32_16x16x64_f16 v[48:51], v[28:31], a[40:47], v25
 ds_write_b64 v5, v[40:41] offset:0
 v_smfmac_f32_16x16x64_f16 v[48:51], v[32:35], a[48:55], v25
 v_cvt_pk_f16_f32 v44, v44, v45
 v_cvt_pk_f16_f32 v45, v46, v47
 v_cvt_pk_f16_f32 v56, v56, v57
 v_smfmac_f32_16x16x64_f16 v[60:63], v[28:31], a[100:107], v25
 v_cvt_pk_f16_f32 v57, v58, v59
 s_nop 0
 v_smfmac_f32_16x16x64_f16 v[60:63], v[32:35], a[108:115], v25
 v_permlane32_swap_b32 v44, v56
 v_permlane32_swap_b32 v45, v57
 v_pk_add_f16 v44, v44, v56
 v_pk_add_f16 v45, v45, v57
 ds_write_b64 v5, v[44:45] offset:640
 v_cvt_pk_f16_f32 v48, v48, v49
 v_cvt_pk_f16_f32 v49, v50, v51
 v_cvt_pk_f16_f32 v60, v60, v61
 v_cvt_pk_f16_f32 v61, v62, v63
 s_nop 0
 v_permlane32_swap_b32 v48, v60
 v_permlane32_swap_b32 v49, v61
 v_pk_add_f16 v48, v48, v60
 v_pk_add_f16 v49, v49, v61
 ds_write_b64 v5, v[48:49] offset:1280
 s_waitcnt lgkmcnt(0) vmcnt(0)
 s_barrier
 ds_read_b64_tr_b16 v[40:41], v21 offset:0
 ds_read_b64_tr_b16 v[42:43], v21 offset:1920
 ds_read_b64_tr_b16 v[44:45], v21 offset:640
 ds_read_b64_tr_b16 v[46:47], v21 offset:2560
 ds_read_b64_tr_b16 v[48:49], v21 offset:1280
 ds_read_b64_tr_b16 v[50:51], v21 offset:3200
 s_waitcnt lgkmcnt(4)
 v_fma_mix_f32 v52, v40, 1.0, v42 op_sel:[0,0,0] op_sel_hi:[1,0,1]
 v_fma_mix_f32 v53, v40, 1.0, v42 op_sel:[1,0,1] op_sel_hi:[1,0,1]
 v_fma_mix_f32 v54, v41, 1.0, v43 op_sel:[0,0,0] op_sel_hi:[1,0,1]
 v_fma_mix_f32 v55, v41, 1.0, v43 op_sel:[1,0,1] op_sel_hi:[1,0,1]
 v_add_f32_dpp v56, v52, v52 row_ror:8 row_mask:0xf bank_mask:0xf
 v_add_f32_dpp v57, v53, v53 row_ror:8 row_mask:0xf bank_mask:0xf
 v_add_f32_dpp v58, v54, v54 row_ror:8 row_mask:0xf bank_mask:0xf
 v_add_f32_dpp v59, v55, v55 row_ror:8 row_mask:0xf bank_mask:0xf
 v_cvt_pk_bf16_f32 v118, v56, v57
 v_cvt_pk_bf16_f32 v119, v58, v59
 s_waitcnt lgkmcnt(2)
 v_fma_mix_f32 v52, v44, 1.0, v46 op_sel:[0,0,0] op_sel_hi:[1,0,1]
 v_fma_mix_f32 v53, v44, 1.0, v46 op_sel:[1,0,1] op_sel_hi:[1,0,1]
 v_fma_mix_f32 v54, v45, 1.0, v47 op_sel:[0,0,0] op_sel_hi:[1,0,1]
 v_fma_mix_f32 v55, v45, 1.0, v47 op_sel:[1,0,1] op_sel_hi:[1,0,1]
 v_add_f32_dpp v56, v52, v52 row_ror:8 row_mask:0xf bank_mask:0xf
 v_add_f32_dpp v57, v53, v53 row_ror:8 row_mask:0xf bank_mask:0xf
 v_add_f32_dpp v58, v54, v54 row_ror:8 row_mask:0xf bank_mask:0xf
 v_add_f32_dpp v59, v55, v55 row_ror:8 row_mask:0xf bank_mask:0xf
 v_cvt_pk_bf16_f32 v120, v56, v57
 v_cvt_pk_bf16_f32 v121, v58, v59
 s_waitcnt lgkmcnt(0)
 v_fma_mix_f32 v52, v48, 1.0, v50 op_sel:[0,0,0] op_sel_hi:[1,0,1]
 v_fma_mix_f32 v53, v48, 1.0, v50 op_sel:[1,0,1] op_sel_hi:[1,0,1]
 v_fma_mix_f32 v54, v49, 1.0, v51 op_sel:[0,0,0] op_sel_hi:[1,0,1]
 v_fma_mix_f32 v55, v49, 1.0, v51 op_sel:[1,0,1] op_sel_hi:[1,0,1]
 v_mfma_f32_16x16x32_bf16 v[40:43], v[112:115], v[118:121], 0
 v_add_f32_dpp v56, v52, v52 row_ror:8 row_mask:0xf bank_mask:0xf
 v_add_f32_dpp v57, v53, v53 row_ror:8 row_mask:0xf bank_mask:0xf
 v_add_f32_dpp v58, v54, v54 row_ror:8 row_mask:0xf bank_mask:0xf
 v_add_f32_dpp v59, v55, v55 row_ror:8 row_mask:0xf bank_mask:0xf
 v_cvt_pk_bf16_f32 v122, v56, v57
 v_cvt_pk_bf16_f32 v123, v58, v59
 s_nop 1
 v_mfma_f32_16x16x32_bf16 v[40:43], v[116:119], v[122:125], v[40:43]
 ds_read_b128 v[28:31], v16 offset:24576
 ds_read_b128 v[32:35], v16 offset:25600
 ds_read_b128 v[64:67], v16 offset:27648
 ds_read_b128 v[68:71], v16 offset:28672
 ds_read_b128 v[72:75], v16 offset:30720
 ds_read_b128 v[76:79], v16 offset:31744
 s_nop 0
 s_mov_b64 exec, s[74:75]
 v_cvt_pk_f16_f32 v44, v40, v41
 v_cvt_pk_f16_f32 v45, v42, v43
 v_and_or_b32 v44, v44, -2, s88
 buffer_store_dwordx2 v[44:45], v7, s[8:11], s81 offen
 s_mov_b64 exec, -1
 ds_read_b128 v[80:83], v16 offset:33792
 ds_read_b128 v[84:87], v16 offset:34816
 ds_read_b64 v[88:89], v16 offset:26624
 ds_read_b64 v[90:91], v16 offset:29696
 ds_read_b64 v[92:93], v16 offset:32768
 ds_read_b64 v[94:95], v16 offset:35840
 s_cmp_eq_u32 s52, 63
 s_cbranch_scc1 last_19
 s_waitcnt lgkmcnt(10)
 v_smfmac_f32_16x16x64_f16 v[100:103], v[28:31], a[120:127], v25
 v_smfmac_f32_16x16x64_f16 v[104:107], v[28:31], a[128:135], v25
 v_smfmac_f32_16x16x64_f16 v[108:111], v[28:31], a[136:143], v25
 s_mov_b32 s54, 0
 v_smfmac_f32_16x16x64_f16 v[100:103], v[32:35], a[144:151], v25
 v_readfirstlane_b32 s21, v0
 v_smfmac_f32_16x16x64_f16 v[104:107], v[32:35], a[152:159], v25
 s_add_u32 s22, s46, 3
 v_smfmac_f32_16x16x64_f16 v[108:111], v[32:35], a[160:167], v25
 s_min_u32 s22, s22, 64
 s_waitcnt lgkmcnt(7)
 v_smfmac_f32_16x16x64_f16 v[100:103], v[64:67], a[168:175], v25
 s_sub_u32 s55, s21, s22
 v_smfmac_f32_16x16x64_f16 v[104:107], v[64:67], a[176:183], v25
 s_sub_u32 s56, s21, s46
 v_smfmac_f32_16x16x64_f16 v[108:111], v[64:67], a[184:191], v25
 v_smfmac_f32_16x16x64_f16 v[100:103], v[68:71], a[192:199], v25
 v_smfmac_f32_16x16x64_f16 v[104:107], v[68:71], a[200:207], v25
 v_smfmac_f32_16x16x64_f16 v[108:111], v[68:71], a[208:215], v25
 v_smfmac_f32_16x16x64_f16 v[100:103], v[72:75], a[216:223], v25
 v_smfmac_f32_16x16x64_f16 v[104:107], v[72:75], a[224:231], v25
 v_smfmac_f32_16x16x64_f16 v[108:111], v[72:75], a[232:239], v25
 s_waitcnt lgkmcnt(4)
 v_smfmac_f32_16x16x64_f16 v[100:103], v[76:79], a[240:247], v25
 v_smfmac_f32_16x16x64_f16 v[104:107], v[76:79], a[248:255], v25
 v_smfmac_f32_16x16x64_f16 v[108:111], v[76:79], v[152:159], v25
 v_smfmac_f32_16x16x64_f16 v[100:103], v[80:83], v[160:167], v25
 v_smfmac_f32_16x16x64_f16 v[104:107], v[80:83], v[168:175], v25
 buffer_load_dwordx2 v[58:59], v9, s[8:11], s81 offen sc1
 buffer_load_dwordx4 v[40:43], v8, s[8:11], s81 offen offset:0 sc1
 buffer_load_dwordx4 v[44:47], v8, s[8:11], s81 offen offset:1024 sc1
 v_smfmac_f32_16x16x64_f16 v[108:111], v[80:83], v[176:183], v25
 v_smfmac_f32_16x16x64_f16 v[100:103], v[84:87], v[184:191], v25
 v_smfmac_f32_16x16x64_f16 v[104:107], v[84:87], v[192:199], v25
 v_smfmac_f32_16x16x64_f16 v[108:111], v[84:87], v[200:207], v25
 s_waitcnt lgkmcnt(0)
 v_smfmac_f32_16x16x64_f16 v[100:103], v[88:91], v[208:215], v25
 v_smfmac_f32_16x16x64_f16 v[104:107], v[88:91], v[216:223], v25
 v_smfmac_f32_16x16x64_f16 v[108:111], v[88:91], v[224:231], v25
 v_smfmac_f32_16x16x64_f16 v[100:103], v[92:95], v[232:239], v25
 v_smfmac_f32_16x16x64_f16 v[104:107], v[92:95], v[240:247], v25
 v_smfmac_f32_16x16x64_f16 v[108:111], v[92:95], v[248:255], v25
 s_cmp_lt_i32 s56, 0
 s_cbranch_scc1 kvw_27
kvok_28:
 s_waitcnt vmcnt(2)
 v_xor_b32 v76, s88, v58
 s_nop 0
 v_permlane16_swap_b32 v58, v59
 v_fma_mix_f32 v60, v58, 1.0, v59 op_sel:[0,0,0] op_sel_hi:[1,0,1]
 v_fma_mix_f32 v61, v58, 1.0, v59 op_sel:[1,0,1] op_sel_hi:[1,0,1]
 v_mov_b32 v58, v60
 v_mov_b32 v59, v61
 s_nop 0
 v_permlane32_swap_b32 v58, v60
 v_permlane32_swap_b32 v59, v61
 v_add_f32 v52, v58, v60
 v_add_f32 v53, v59, v61
 v_max_f32 v79, v52, v53
 s_waitcnt vmcnt(0)
 v_pk_add_f16 v80, v40, v44
 v_pk_add_f16 v82, v42, v46
 v_pk_add_f16 v81, v41, v45
 v_pk_add_f16 v83, v43, v47
 v_permlane32_swap_b32 v80, v82
 v_bitop3_b32 v77, v40, v42, s88 bitop3:0x7e
 v_permlane32_swap_b32 v81, v83
 v_bitop3_b32 v78, v44, v46, s88 bitop3:0x7e
 v_fma_mix_f32 v48, v80, 1.0, v82 op_sel:[0,0,0] op_sel_hi:[1,0,1]
 v_or3_b32 v27, v76, v77, v78
 v_fma_mix_f32 v49, v80, 1.0, v82 op_sel:[1,0,1] op_sel_hi:[1,0,1]
 v_and_b32 v27, 1, v27
 v_fma_mix_f32 v50, v81, 1.0, v83 op_sel:[0,0,0] op_sel_hi:[1,0,1]
 v_cmp_ne_u32 vcc, 0, v27
 v_fma_mix_f32 v51, v81, 1.0, v83 op_sel:[1,0,1] op_sel_hi:[1,0,1]
 v_max3_f32 v62, v48, v49, v79
 s_cbranch_vccnz psr_25
psj_26:
 v_max3_f32 v62, v62, v50, v51
 v_cvt_pk_bf16_f32 v146, v100, v101
 v_cvt_pk_bf16_f32 v147, v102, v103
 v_max_f32_dpp v62, v62, v62 row_ror:8 row_mask:0xf bank_mask:0xf
 v_mov_b32 v63, v62
 v_cvt_pk_bf16_f32 v148, v104, v105
 v_cvt_pk_bf16_f32 v149, v106, v107
 v_permlane32_swap_b32 v62, v63
 v_max_f32 v62, v62, v63
 v_mov_b32 v63, v62
 v_cvt_pk_bf16_f32 v150, v108, v109
 v_cvt_pk_bf16_f32 v151, v110, v111
 v_permlane16_swap_b32 v62, v63
 v_max_f32 v62, v62, v63
 v_mul_f32 v62, s86, v62
 v_fma_f32 v48, v48, s86, -v62
 v_fma_f32 v49, v49, s86, -v62
 v_fma_f32 v50, v50, s86, -v62
 v_fma_f32 v51, v51, s86, -v62
 v_fma_f32 v52, v52, s86, -v62
 v_fma_f32 v53, v53, s86, -v62
 v_exp_f32 v48, v48
 v_exp_f32 v49, v49
 buffer_load_dwordx4 v[88:91], v17, s[28:31], s64 offen offset:0 sc1
 v_exp_f32 v50, v50
 v_exp_f32 v51, v51
 buffer_load_dwordx4 v[92:95], v16, s[28:31], s64 offen offset:1024 sc1
 v_exp_f32 v52, v52
 v_exp_f32 v53, v53
 buffer_load_dwordx4 v[96:99], v20, s[28:31], s64 offen offset:2048 sc1
 v_cvt_pk_bf16_f32 v138, v48, v49
 v_cvt_pk_bf16_f32 v139, v50, v51
 v_cvt_pk_bf16_f32 v142, v52, v53
 v_mov_b32_dpp v140, v138 row_ror:8 row_mask:0xf bank_mask:0xf
 v_mov_b32_dpp v141, v139 row_ror:8 row_mask:0xf bank_mask:0xf
 v_mov_b32_dpp v143, v142 row_ror:8 row_mask:0xf bank_mask:0xf
 buffer_load_dwordx4 v[112:115], v18, s[16:19], s80 offen sc1
 v_add_f32 v54, v48, v49
 v_mfma_f32_16x16x32_bf16 v[64:67], v[126:129], v[138:141], 0
 v_add_f32 v55, v50, v51
 v_add_f32 v56, v52, v53
 v_mfma_f32_16x16x32_bf16 v[64:67], v[146:149], v[142:145], v[64:67]
 v_add_f32 v62, v54, v55
 v_fmac_f32 v62, v56, v26
 v_mfma_f32_16x16x32_bf16 v[68:71], v[130:133], v[138:141], 0
 buffer_load_dwordx2 v[116:117], v19, s[16:19], s80 offen sc1
 v_add_f32_dpp v62, v62, v62 row_ror:8 row_mask:0xf bank_mask:0xf
 v_mfma_f32_16x16x32_bf16 v[68:71], v[148:151], v[142:145], v[68:71]
 v_mov_b32 v63, v62
 s_cmp_lt_i32 s55, 0
 s_cbranch_scc1 fl_29
fl_30:
 v_mfma_f32_16x16x32_bf16 v[72:75], v[134:137], v[138:141], 0
 v_permlane32_swap_b32 v62, v63
 v_mfma_f32_16x16x32_bf16 v[72:75], v[150:153], v[142:145], v[72:75]
 v_add_f32 v62, v62, v63
 v_mov_b32 v63, v62
 ds_write_b128 v11, v[64:67] offset:0
 s_nop 0
 v_permlane16_swap_b32 v62, v63
 v_add_f32 v62, v62, v63
 v_rcp_f32 v62, v62
 ds_write_b128 v11, v[68:71] offset:1024
 s_mov_b64 exec, 0xff
 ds_write_b32 v22, v62
 s_mov_b64 exec, -1
 ds_write_b128 v11, v[72:75] offset:2048
 s_waitcnt lgkmcnt(0)
 s_barrier
 ds_read_b128 v[72:75], v23
 ds_read_b64 v[64:65], v12 offset:0
 ds_read_b64 v[66:67], v12 offset:3072
 ds_read_b64 v[68:69], v12 offset:6144
 ds_read_b64 v[70:71], v12 offset:9216
 s_waitcnt lgkmcnt(2)
 v_pk_mul_f32 v[64:65], v[64:65], v[72:73] op_sel_hi:[1,0]
 v_pk_fma_f32 v[64:65], v[66:67], v[72:73], v[64:65] op_sel:[0,1,0] op_sel_hi:[1,1,1]
 s_waitcnt lgkmcnt(0)
 v_pk_fma_f32 v[64:65], v[68:69], v[74:75], v[64:65] op_sel_hi:[1,0,1]
 v_pk_fma_f32 v[64:65], v[70:71], v[74:75], v[64:65] op_sel:[0,1,0] op_sel_hi:[1,1,1]
 v_cvt_pk_f16_f32 v68, v64, v65
 v_perm_b32 v68, s91, v68, v14
 buffer_atomic_pk_add_f16 v68, v13, s[4:7], s3 offen
 v_mov_b32 v76, v108
 v_mov_b32 v77, v109
 v_mov_b32 v78, v110
 v_mov_b32 v79, v111
 v_permlane32_swap_b32 v100, v104
 v_permlane32_swap_b32 v101, v105
 v_permlane32_swap_b32 v102, v106
 v_permlane32_swap_b32 v103, v107
 v_permlane32_swap_b32 v108, v76
 v_permlane32_swap_b32 v109, v77
 v_permlane32_swap_b32 v110, v78
 v_permlane32_swap_b32 v111, v79
 v_pk_add_f32 v[100:101], v[100:101], v[104:105]
 v_pk_add_f32 v[102:103], v[102:103], v[106:107]
 v_pk_add_f32 v[108:109], v[108:109], v[76:77]
 v_pk_add_f32 v[110:111], v[110:111], v[78:79]
 v_cvt_pk_bf16_f32 v80, v100, v101
 v_cvt_pk_bf16_f32 v82, v108, v109
 v_cvt_pk_bf16_f32 v81, v102, v103
 v_cvt_pk_bf16_f32 v83, v110, v111
 s_nop 0
 v_permlane16_swap_b32 v80, v82
 v_permlane16_swap_b32 v81, v83
 v_min_u32 v80, -2, v80
 s_mov_b64 exec, s[76:77]
 buffer_store_dwordx4 v[80:83], v15, s[24:27], s57 offen sc1
 s_mov_b64 exec, -1
 s_add_u32 s64, s64, 1310720
 s_add_u32 s52, s52, 1
 s_branch step_18
fl_23:
 buffer_load_dword v0, off, s[12:15], s79 sc1
 s_branch fl_24
A1_13:
 v_smfmac_f32_16x16x32_f16 v[40:43], v[36:37], a[16:19], v25
 v_smfmac_f32_16x16x32_f16 v[52:55], v[36:37], a[76:79], v25
 v_smfmac_f32_16x16x32_f16 v[44:47], v[36:37], a[36:39], v25
 v_smfmac_f32_16x16x32_f16 v[56:59], v[36:37], a[96:99], v25
 s_branch A2_22
pm_21:
 buffer_load_dwordx4 v[36:39], v4, s[4:7], s84 offen offset:2048 sc1
 buffer_load_dwordx4 v[28:31], v4, s[4:7], s84 offen offset:0 sc1
 buffer_load_dwordx4 v[32:35], v4, s[4:7], s84 offen offset:1024 sc1
 s_nop 7
 v_mov_b32 v40, 0
 v_mov_b32 v41, 0
 v_mov_b32 v42, 0
 v_mov_b32 v43, 0
 v_mov_b32 v52, 0
 v_mov_b32 v53, 0
 v_mov_b32 v54, 0
 v_mov_b32 v55, 0
 v_mov_b32 v44, 0
 v_mov_b32 v45, 0
 v_mov_b32 v46, 0
 v_mov_b32 v47, 0
 v_mov_b32 v56, 0
 v_mov_b32 v57, 0
 v_mov_b32 v58, 0
 v_mov_b32 v59, 0
 s_waitcnt vmcnt(0)
 v_bitop3_b32 v27, v31, v35, v39 bitop3:0x80
 v_perm_b32 v31, v35, v31, s89
 v_cmp_gt_u32 vcc, 0x48000000, v27
 v_mov_b32 v35, v38
 s_cbranch_vccz A1_13
pm_20:
 s_cmp_gt_u32 s52, 3
 s_cbranch_scc1 op_31
 v_readfirstlane_b32 s21, v0
 s_cmp_ge_u32 s21, s46
 s_cbranch_scc1 op_31
 buffer_load_dword v0, off, s[12:15], s79 sc1
 s_waitcnt vmcnt(0)
 v_readfirstlane_b32 s21, v0
 s_cmp_gt_u32 s21, s52
 s_cselect_b32 s21, s87, 0
 s_cmp_eq_u32 s21, 0
 s_cbranch_scc1 op_31
 s_mov_b32 s87, 0
 s_sub_u32 s21, s64, 1310720
 buffer_load_dwordx4 v[126:129], v16, s[28:31], s21 offen offset:0 sc1
 buffer_load_dwordx4 v[130:133], v16, s[28:31], s21 offen offset:1024 sc1
 buffer_load_dwordx4 v[134:137], v16, s[28:31], s21 offen offset:2048 sc1
op_31:
 buffer_load_dwordx4 v[36:39], v4, s[4:7], s84 offen offset:2048 sc1
 buffer_load_dwordx4 v[28:31], v4, s[4:7], s84 offen offset:0 sc1
 buffer_load_dwordx4 v[32:35], v4, s[4:7], s84 offen offset:1024 sc1
 s_add_u32 s54, s54, 1
 s_cmp_gt_u32 s54, 131072
 s_cbranch_scc1 end0
 s_waitcnt vmcnt(0)
 v_bitop3_b32 v27, v31, v35, v39 bitop3:0x80
 v_perm_b32 v31, v35, v31, s89
 v_cmp_gt_u32 vcc, 0x48000000, v27
 v_mov_b32 v35, v38
 s_cbranch_vccnz pm_20
 s_branch A1_13
psr_25:
 buffer_load_dwordx2 v[58:59], v9, s[8:11], s81 offen sc1
 buffer_load_dwordx4 v[40:43], v8, s[8:11], s81 offen offset:0 sc1
 buffer_load_dwordx4 v[44:47], v8, s[8:11], s81 offen offset:1024 sc1
 s_add_u32 s54, s54, 1
 s_cmp_gt_u32 s54, 131072
 s_cbranch_scc1 end0
 s_waitcnt vmcnt(2)
 v_xor_b32 v76, s88, v58
 s_nop 0
 v_permlane16_swap_b32 v58, v59
 v_fma_mix_f32 v60, v58, 1.0, v59 op_sel:[0,0,0] op_sel_hi:[1,0,1]
 v_fma_mix_f32 v61, v58, 1.0, v59 op_sel:[1,0,1] op_sel_hi:[1,0,1]
 v_mov_b32 v58, v60
 v_mov_b32 v59, v61
 s_nop 0
 v_permlane32_swap_b32 v58, v60
 v_permlane32_swap_b32 v59, v61
 v_add_f32 v52, v58, v60
 v_add_f32 v53, v59, v61
 v_max_f32 v79, v52, v53
 s_waitcnt vmcnt(0)
 v_pk_add_f16 v80, v40, v44
 v_pk_add_f16 v82, v42, v46
 v_pk_add_f16 v81, v41, v45
 v_pk_add_f16 v83, v43, v47
 v_permlane32_swap_b32 v80, v82
 v_bitop3_b32 v77, v40, v42, s88 bitop3:0x7e
 v_permlane32_swap_b32 v81, v83
 v_bitop3_b32 v78, v44, v46, s88 bitop3:0x7e
 v_fma_mix_f32 v48, v80, 1.0, v82 op_sel:[0,0,0] op_sel_hi:[1,0,1]
 v_or3_b32 v27, v76, v77, v78
 v_fma_mix_f32 v49, v80, 1.0, v82 op_sel:[1,0,1] op_sel_hi:[1,0,1]
 v_and_b32 v27, 1, v27
 v_fma_mix_f32 v50, v81, 1.0, v83 op_sel:[0,0,0] op_sel_hi:[1,0,1]
 v_cmp_ne_u32 vcc, 0, v27
 v_fma_mix_f32 v51, v81, 1.0, v83 op_sel:[1,0,1] op_sel_hi:[1,0,1]
 v_max3_f32 v62, v48, v49, v79
 s_cbranch_vccnz psr_25
 s_branch psj_26
kvw_27:
 s_mov_b32 s22, s87
 s_cmp_eq_u32 s52, 0
 s_cselect_b32 s55, 0, s55
 s_cselect_b32 s87, 1, 0
 s_cbranch_scc1 kvok_28
 v_mov_b32 v62, 0
 s_mov_b32 s101, 0
wf_32:
 buffer_load_dword v63, v62, s[12:15], s79 offen sc1
 s_add_u32 s101, s101, 1
 s_cmp_gt_u32 s101, 131072
 s_cbranch_scc1 end0
 s_waitcnt vmcnt(0)
 v_readfirstlane_b32 s100, v63
 s_cmp_ge_u32 s100, s46
 s_cbranch_scc1 wf_33
 s_sleep 3
 s_branch wf_32
wf_33:
 s_cmp_eq_u32 s22, 0
 s_cbranch_scc1 kvok_28
 s_sub_u32 s21, s64, 1310720
 buffer_load_dwordx4 v[126:129], v16, s[28:31], s21 offen offset:0 sc1
 buffer_load_dwordx4 v[130:133], v16, s[28:31], s21 offen offset:1024 sc1
 buffer_load_dwordx4 v[134:137], v16, s[28:31], s21 offen offset:2048 sc1
 s_waitcnt vmcnt(0)
 s_branch kvok_28
fl_29:
 buffer_load_dword v0, off, s[12:15], s79 sc1
 s_branch fl_30
last_19:
 s_waitcnt lgkmcnt(10)
 v_smfmac_f32_16x16x64_f16 v[100:103], v[28:31], a[120:127], v25
 v_smfmac_f32_16x16x64_f16 v[104:107], v[28:31], a[128:135], v25
 v_smfmac_f32_16x16x64_f16 v[108:111], v[28:31], a[136:143], v25
 v_smfmac_f32_16x16x64_f16 v[100:103], v[32:35], a[144:151], v25
 v_smfmac_f32_16x16x64_f16 v[104:107], v[32:35], a[152:159], v25
 v_smfmac_f32_16x16x64_f16 v[108:111], v[32:35], a[160:167], v25
 s_waitcnt lgkmcnt(7)
 v_smfmac_f32_16x16x64_f16 v[100:103], v[64:67], a[168:175], v25
 v_smfmac_f32_16x16x64_f16 v[104:107], v[64:67], a[176:183], v25
 v_smfmac_f32_16x16x64_f16 v[108:111], v[64:67], a[184:191], v25
 v_smfmac_f32_16x16x64_f16 v[100:103], v[68:71], a[192:199], v25
 v_smfmac_f32_16x16x64_f16 v[104:107], v[68:71], a[200:207], v25
 v_smfmac_f32_16x16x64_f16 v[108:111], v[68:71], a[208:215], v25
 v_smfmac_f32_16x16x64_f16 v[100:103], v[72:75], a[216:223], v25
 v_smfmac_f32_16x16x64_f16 v[104:107], v[72:75], a[224:231], v25
 v_smfmac_f32_16x16x64_f16 v[108:111], v[72:75], a[232:239], v25
 s_waitcnt lgkmcnt(4)
 v_smfmac_f32_16x16x64_f16 v[100:103], v[76:79], a[240:247], v25
 v_smfmac_f32_16x16x64_f16 v[104:107], v[76:79], a[248:255], v25
 v_smfmac_f32_16x16x64_f16 v[108:111], v[76:79], v[152:159], v25
 v_smfmac_f32_16x16x64_f16 v[100:103], v[80:83], v[160:167], v25
 v_smfmac_f32_16x16x64_f16 v[104:107], v[80:83], v[168:175], v25
 v_smfmac_f32_16x16x64_f16 v[108:111], v[80:83], v[176:183], v25
 v_smfmac_f32_16x16x64_f16 v[100:103], v[84:87], v[184:191], v25
 v_smfmac_f32_16x16x64_f16 v[104:107], v[84:87], v[192:199], v25
 v_smfmac_f32_16x16x64_f16 v[108:111], v[84:87], v[200:207], v25
 s_waitcnt lgkmcnt(0)
 v_smfmac_f32_16x16x64_f16 v[100:103], v[88:91], v[208:215], v25
 v_smfmac_f32_16x16x64_f16 v[104:107], v[88:91], v[216:223], v25
 v_smfmac_f32_16x16x64_f16 v[108:111], v[88:91], v[224:231], v25
 v_smfmac_f32_16x16x64_f16 v[100:103], v[92:95], v[232:239], v25
 v_smfmac_f32_16x16x64_f16 v[104:107], v[92:95], v[240:247], v25
 v_smfmac_f32_16x16x64_f16 v[108:111], v[92:95], v[248:255], v25
 s_nop 7
 v_mov_b32 v76, v108
 v_mov_b32 v77, v109
 v_mov_b32 v78, v110
 v_mov_b32 v79, v111
 v_permlane32_swap_b32 v100, v104
 v_permlane32_swap_b32 v101, v105
 v_permlane32_swap_b32 v102, v106
 v_permlane32_swap_b32 v103, v107
 v_permlane32_swap_b32 v108, v76
 v_permlane32_swap_b32 v109, v77
 v_permlane32_swap_b32 v110, v78
 v_permlane32_swap_b32 v111, v79
 v_pk_add_f32 v[100:101], v[100:101], v[104:105]
 v_pk_add_f32 v[102:103], v[102:103], v[106:107]
 v_pk_add_f32 v[108:109], v[108:109], v[76:77]
 v_pk_add_f32 v[110:111], v[110:111], v[78:79]
 v_cvt_pk_bf16_f32 v80, v100, v101
 v_cvt_pk_bf16_f32 v82, v108, v109
 v_cvt_pk_bf16_f32 v81, v102, v103
 v_cvt_pk_bf16_f32 v83, v110, v111
 s_nop 0
 v_permlane16_swap_b32 v80, v82
 v_permlane16_swap_b32 v81, v83
 v_min_u32 v80, -2, v80
 s_mov_b64 exec, s[76:77]
 buffer_store_dwordx4 v[80:83], v15, s[24:27], s57 offen sc1
 s_mov_b64 exec, -1
 v_mov_b32 v246, 80
 v_mov_b32 v247, 1
 s_mov_b64 exec, 1
 buffer_atomic_add v247, v246, s[32:35], 0 offen sc0 sc1
 s_mov_b64 exec, -1
 s_branch chain_done
step_34:
 s_and_b32 s21, s52, 3
 s_mul_i32 s81, s21, 540672
 s_lshl_b32 s84, s21, 15
 s_add_u32 s21, s52, 3
 s_and_b32 s21, s21, 3
 s_lshl_b32 s83, s21, 15
 s_add_u32 s21, s52, 1
 s_and_b32 s22, s21, 3
 s_lshl_b32 s3, s22, 15
 s_mul_i32 s80, s21, 393216
 s_add_u32 s46, s21, 1
 s_min_u32 s46, s46, 64
 s_mul_i32 s85, s52, 98304
 s_mul_i32 s57, s52, 327680
 s_add_u32 s57, s57, 51380224
 s_bfe_u32 s88, s52, 0x10002
 s_max_u32 s67, s52, 1
 s_sub_u32 s67, s67, 1
 v_mov_b32 v40, 0
 v_mov_b32 v41, 0
 v_mov_b32 v42, 0
 v_mov_b32 v43, 0
 v_mov_b32 v44, 0
 v_mov_b32 v45, 0
 v_mov_b32 v46, 0
 v_mov_b32 v47, 0
 v_mov_b32 v48, 0
 v_mov_b32 v49, 0
 v_mov_b32 v50, 0
 v_mov_b32 v51, 0
 v_mov_b32 v52, 0
 v_mov_b32 v53, 0
 v_mov_b32 v54, 0
 v_mov_b32 v55, 0
 v_mov_b32 v56, 0
 v_mov_b32 v57, 0
 v_mov_b32 v58, 0
 v_mov_b32 v59, 0
 v_mov_b32 v60, 0
 v_mov_b32 v61, 0
 v_mov_b32 v62, 0
 v_mov_b32 v63, 0
 v_mov_b32 v100, 0
 v_mov_b32 v101, 0
 v_mov_b32 v102, 0
 v_mov_b32 v103, 0
 v_mov_b32 v104, 0
 v_mov_b32 v105, 0
 v_mov_b32 v106, 0
 v_mov_b32 v107, 0
 v_mov_b32 v108, 0
 v_mov_b32 v109, 0
 v_mov_b32 v110, 0
 v_mov_b32 v111, 0
 s_sleep 5
 v_readfirstlane_b32 s21, v0
 s_cmp_lt_u32 s21, s46
 s_cselect_b32 s55, s55, 0
 s_cmp_lt_i32 s55, 0
 s_cbranch_scc1 fl_39
fl_40:
 s_mov_b32 s54, 0
 buffer_load_dwordx4 v[36:39], v4, s[4:7], s84 offen offset:2048 sc1
 buffer_load_dwordx4 v[28:31], v4, s[4:7], s84 offen offset:0 sc1
 buffer_load_dwordx4 v[32:35], v4, s[4:7], s84 offen offset:1024 sc1
 s_waitcnt vmcnt(3)
 v_mov_b32 v126, v88
 v_mov_b32 v127, v89
 v_mov_b32 v128, v90
 v_mov_b32 v129, v91
 v_mov_b32 v130, v92
 v_mov_b32 v131, v93
 v_mov_b32 v132, v94
 v_mov_b32 v133, v95
 v_mov_b32 v134, v96
 v_mov_b32 v135, v97
 v_mov_b32 v136, v98
 v_mov_b32 v137, v99
 s_waitcnt vmcnt(2)
 v_smfmac_f32_16x16x32_f16 v[40:43], v[36:37], a[16:19], v25
 v_smfmac_f32_16x16x32_f16 v[52:55], v[36:37], a[76:79], v25
 v_smfmac_f32_16x16x32_f16 v[44:47], v[36:37], a[36:39], v25
 s_waitcnt vmcnt(0)
 v_bitop3_b32 v27, v31, v35, v39 bitop3:0x80
 v_perm_b32 v31, v35, v31, s89
 v_cmp_gt_u32 vcc, 0x48000000, v27
 v_mov_b32 v35, v38
 v_smfmac_f32_16x16x32_f16 v[56:59], v[36:37], a[96:99], v25
 s_cbranch_vccnz pm_37
A2_38:
 v_smfmac_f32_16x16x64_f16 v[40:43], v[28:31], a[0:7], v25
 ds_write_b128 v10, v[28:31]
 v_smfmac_f32_16x16x64_f16 v[40:43], v[32:35], a[8:15], v25
 ds_write_b128 v10, v[32:35] offset:1024
 v_smfmac_f32_16x16x64_f16 v[52:55], v[28:31], a[60:67], v25
 ds_write_b64 v10, v[36:37] offset:2048
 v_smfmac_f32_16x16x64_f16 v[52:55], v[32:35], a[68:75], v25
 v_cvt_pk_f16_f32 v40, v40, v41
 v_cvt_pk_f16_f32 v41, v42, v43
 v_smfmac_f32_16x16x32_f16 v[48:51], v[36:37], a[56:59], v25
 v_smfmac_f32_16x16x32_f16 v[60:63], v[36:37], a[116:119], v25
 v_smfmac_f32_16x16x64_f16 v[44:47], v[28:31], a[20:27], v25
 v_cvt_pk_f16_f32 v52, v52, v53
 v_cvt_pk_f16_f32 v53, v54, v55
 s_nop 0
 v_smfmac_f32_16x16x64_f16 v[44:47], v[32:35], a[28:35], v25
 v_permlane32_swap_b32 v40, v52
 v_smfmac_f32_16x16x64_f16 v[56:59], v[28:31], a[80:87], v25
 v_permlane32_swap_b32 v41, v53
 v_pk_add_f16 v40, v40, v52
 v_smfmac_f32_16x16x64_f16 v[56:59], v[32:35], a[88:95], v25
 v_pk_add_f16 v41, v41, v53
 v_smfmac_f32_16x16x64_f16 v[48:51], v[28:31], a[40:47], v25
 ds_write_b64 v5, v[40:41] offset:0
 v_smfmac_f32_16x16x64_f16 v[48:51], v[32:35], a[48:55], v25
 v_cvt_pk_f16_f32 v44, v44, v45
 v_cvt_pk_f16_f32 v45, v46, v47
 v_cvt_pk_f16_f32 v56, v56, v57
 v_smfmac_f32_16x16x64_f16 v[60:63], v[28:31], a[100:107], v25
 v_cvt_pk_f16_f32 v57, v58, v59
 s_nop 0
 v_smfmac_f32_16x16x64_f16 v[60:63], v[32:35], a[108:115], v25
 v_permlane32_swap_b32 v44, v56
 v_permlane32_swap_b32 v45, v57
 v_pk_add_f16 v44, v44, v56
 v_pk_add_f16 v45, v45, v57
 ds_write_b64 v5, v[44:45] offset:640
 v_cvt_pk_f16_f32 v48, v48, v49
 v_cvt_pk_f16_f32 v49, v50, v51
 v_cvt_pk_f16_f32 v60, v60, v61
 v_cvt_pk_f16_f32 v61, v62, v63
 s_nop 0
 v_permlane32_swap_b32 v48, v60
 v_permlane32_swap_b32 v49, v61
 v_pk_add_f16 v48, v48, v60
 v_pk_add_f16 v49, v49, v61
 ds_write_b64 v5, v[48:49] offset:1280
 s_waitcnt lgkmcnt(0) vmcnt(0)
 s_barrier
 ds_read_b64_tr_b16 v[40:41], v21 offset:0
 ds_read_b64_tr_b16 v[42:43], v21 offset:1920
 ds_read_b64_tr_b16 v[44:45], v21 offset:640
 ds_read_b64_tr_b16 v[46:47], v21 offset:2560
 ds_read_b64_tr_b16 v[48:49], v21 offset:1280
 ds_read_b64_tr_b16 v[50:51], v21 offset:3200
 s_waitcnt lgkmcnt(4)
 v_fma_mix_f32 v52, v40, 1.0, v42 op_sel:[0,0,0] op_sel_hi:[1,0,1]
 v_fma_mix_f32 v53, v40, 1.0, v42 op_sel:[1,0,1] op_sel_hi:[1,0,1]
 v_fma_mix_f32 v54, v41, 1.0, v43 op_sel:[0,0,0] op_sel_hi:[1,0,1]
 v_fma_mix_f32 v55, v41, 1.0, v43 op_sel:[1,0,1] op_sel_hi:[1,0,1]
 v_add_f32_dpp v56, v52, v52 row_ror:8 row_mask:0xf bank_mask:0xf
 v_add_f32_dpp v57, v53, v53 row_ror:8 row_mask:0xf bank_mask:0xf
 v_add_f32_dpp v58, v54, v54 row_ror:8 row_mask:0xf bank_mask:0xf
 v_add_f32_dpp v59, v55, v55 row_ror:8 row_mask:0xf bank_mask:0xf
 v_cvt_pk_bf16_f32 v118, v56, v57
 v_cvt_pk_bf16_f32 v119, v58, v59
 s_waitcnt lgkmcnt(2)
 v_fma_mix_f32 v52, v44, 1.0, v46 op_sel:[0,0,0] op_sel_hi:[1,0,1]
 v_fma_mix_f32 v53, v44, 1.0, v46 op_sel:[1,0,1] op_sel_hi:[1,0,1]
 v_fma_mix_f32 v54, v45, 1.0, v47 op_sel:[0,0,0] op_sel_hi:[1,0,1]
 v_fma_mix_f32 v55, v45, 1.0, v47 op_sel:[1,0,1] op_sel_hi:[1,0,1]
 v_add_f32_dpp v56, v52, v52 row_ror:8 row_mask:0xf bank_mask:0xf
 v_add_f32_dpp v57, v53, v53 row_ror:8 row_mask:0xf bank_mask:0xf
 v_add_f32_dpp v58, v54, v54 row_ror:8 row_mask:0xf bank_mask:0xf
 v_add_f32_dpp v59, v55, v55 row_ror:8 row_mask:0xf bank_mask:0xf
 v_cvt_pk_bf16_f32 v120, v56, v57
 v_cvt_pk_bf16_f32 v121, v58, v59
 s_waitcnt lgkmcnt(0)
 v_fma_mix_f32 v52, v48, 1.0, v50 op_sel:[0,0,0] op_sel_hi:[1,0,1]
 v_fma_mix_f32 v53, v48, 1.0, v50 op_sel:[1,0,1] op_sel_hi:[1,0,1]
 v_fma_mix_f32 v54, v49, 1.0, v51 op_sel:[0,0,0] op_sel_hi:[1,0,1]
 v_fma_mix_f32 v55, v49, 1.0, v51 op_sel:[1,0,1] op_sel_hi:[1,0,1]
 v_mfma_f32_16x16x32_bf16 v[40:43], v[112:115], v[118:121], 0
 v_add_f32_dpp v56, v52, v52 row_ror:8 row_mask:0xf bank_mask:0xf
 v_add_f32_dpp v57, v53, v53 row_ror:8 row_mask:0xf bank_mask:0xf
 v_add_f32_dpp v58, v54, v54 row_ror:8 row_mask:0xf bank_mask:0xf
 v_add_f32_dpp v59, v55, v55 row_ror:8 row_mask:0xf bank_mask:0xf
 v_cvt_pk_bf16_f32 v122, v56, v57
 v_cvt_pk_bf16_f32 v123, v58, v59
 s_nop 1
 v_mfma_f32_16x16x32_bf16 v[40:43], v[116:119], v[122:125], v[40:43]
 ds_read_b128 v[28:31], v16 offset:24576
 ds_read_b128 v[32:35], v16 offset:25600
 ds_read_b128 v[64:67], v16 offset:27648
 ds_read_b128 v[68:71], v16 offset:28672
 ds_read_b128 v[72:75], v16 offset:30720
 ds_read_b128 v[76:79], v16 offset:31744
 s_nop 0
 s_mov_b64 exec, s[74:75]
 v_cvt_pk_f16_f32 v44, v40, v41
 v_cvt_pk_f16_f32 v45, v42, v43
 v_and_or_b32 v44, v44, -2, s88
 buffer_store_dwordx2 v[44:45], v7, s[8:11], s81 offen
 s_mov_b64 exec, -1
 ds_read_b128 v[80:83], v16 offset:33792
 ds_read_b128 v[84:87], v16 offset:34816
 ds_read_b64 v[88:89], v16 offset:26624
 ds_read_b64 v[90:91], v16 offset:29696
 ds_read_b64 v[92:93], v16 offset:32768
 ds_read_b64 v[94:95], v16 offset:35840
 s_cmp_eq_u32 s52, 63
 s_cbranch_scc1 last_35
 s_waitcnt lgkmcnt(10)
 v_smfmac_f32_16x16x64_f16 v[100:103], v[28:31], a[120:127], v25
 v_smfmac_f32_16x16x64_f16 v[104:107], v[28:31], a[128:135], v25
 v_smfmac_f32_16x16x64_f16 v[108:111], v[28:31], a[136:143], v25
 s_mov_b32 s54, 0
 v_smfmac_f32_16x16x64_f16 v[100:103], v[32:35], a[144:151], v25
 v_readfirstlane_b32 s21, v0
 v_smfmac_f32_16x16x64_f16 v[104:107], v[32:35], a[152:159], v25
 s_add_u32 s22, s46, 3
 v_smfmac_f32_16x16x64_f16 v[108:111], v[32:35], a[160:167], v25
 s_min_u32 s22, s22, 64
 s_waitcnt lgkmcnt(7)
 v_smfmac_f32_16x16x64_f16 v[100:103], v[64:67], a[168:175], v25
 s_sub_u32 s55, s21, s22
 v_smfmac_f32_16x16x64_f16 v[104:107], v[64:67], a[176:183], v25
 s_sub_u32 s56, s21, s46
 v_smfmac_f32_16x16x64_f16 v[108:111], v[64:67], a[184:191], v25
 v_smfmac_f32_16x16x64_f16 v[100:103], v[68:71], a[192:199], v25
 v_smfmac_f32_16x16x64_f16 v[104:107], v[68:71], a[200:207], v25
 v_smfmac_f32_16x16x64_f16 v[108:111], v[68:71], a[208:215], v25
 v_smfmac_f32_16x16x64_f16 v[100:103], v[72:75], a[216:223], v25
 v_smfmac_f32_16x16x64_f16 v[104:107], v[72:75], a[224:231], v25
 v_smfmac_f32_16x16x64_f16 v[108:111], v[72:75], a[232:239], v25
 s_waitcnt lgkmcnt(4)
 v_smfmac_f32_16x16x64_f16 v[100:103], v[76:79], a[240:247], v25
 v_smfmac_f32_16x16x64_f16 v[104:107], v[76:79], a[248:255], v25
 v_smfmac_f32_16x16x64_f16 v[108:111], v[76:79], v[152:159], v25
 v_smfmac_f32_16x16x64_f16 v[100:103], v[80:83], v[160:167], v25
 v_smfmac_f32_16x16x64_f16 v[104:107], v[80:83], v[168:175], v25
 buffer_load_dwordx2 v[58:59], v9, s[8:11], s81 offen sc1
 buffer_load_dwordx4 v[40:43], v8, s[8:11], s81 offen offset:0 sc1
 buffer_load_dwordx4 v[44:47], v8, s[8:11], s81 offen offset:1024 sc1
 v_smfmac_f32_16x16x64_f16 v[108:111], v[80:83], v[176:183], v25
 v_smfmac_f32_16x16x64_f16 v[100:103], v[84:87], v[184:191], v25
 v_smfmac_f32_16x16x64_f16 v[104:107], v[84:87], v[192:199], v25
 v_smfmac_f32_16x16x64_f16 v[108:111], v[84:87], v[200:207], v25
 s_waitcnt lgkmcnt(0)
 v_smfmac_f32_16x16x64_f16 v[100:103], v[88:91], v[208:215], v25
 v_smfmac_f32_16x16x64_f16 v[104:107], v[88:91], v[216:223], v25
 v_smfmac_f32_16x16x64_f16 v[108:111], v[88:91], v[224:231], v25
 v_smfmac_f32_16x16x64_f16 v[100:103], v[92:95], v[232:239], v25
 v_smfmac_f32_16x16x64_f16 v[104:107], v[92:95], v[240:247], v25
 v_smfmac_f32_16x16x64_f16 v[108:111], v[92:95], v[248:255], v25
 s_cmp_lt_i32 s56, 0
 s_cbranch_scc1 kvw_43
kvok_44:
 s_waitcnt vmcnt(2)
 v_xor_b32 v76, s88, v58
 s_nop 0
 v_permlane16_swap_b32 v58, v59
 v_fma_mix_f32 v60, v58, 1.0, v59 op_sel:[0,0,0] op_sel_hi:[1,0,1]
 v_fma_mix_f32 v61, v58, 1.0, v59 op_sel:[1,0,1] op_sel_hi:[1,0,1]
 v_mov_b32 v58, v60
 v_mov_b32 v59, v61
 s_nop 0
 v_permlane32_swap_b32 v58, v60
 v_permlane32_swap_b32 v59, v61
 v_add_f32 v52, v58, v60
 v_add_f32 v53, v59, v61
 v_max_f32 v79, v52, v53
 s_waitcnt vmcnt(0)
 v_pk_add_f16 v80, v40, v44
 v_pk_add_f16 v82, v42, v46
 v_pk_add_f16 v81, v41, v45
 v_pk_add_f16 v83, v43, v47
 v_permlane32_swap_b32 v80, v82
 v_bitop3_b32 v77, v40, v42, s88 bitop3:0x7e
 v_permlane32_swap_b32 v81, v83
 v_bitop3_b32 v78, v44, v46, s88 bitop3:0x7e
 v_fma_mix_f32 v48, v80, 1.0, v82 op_sel:[0,0,0] op_sel_hi:[1,0,1]
 v_or3_b32 v27, v76, v77, v78
 v_fma_mix_f32 v49, v80, 1.0, v82 op_sel:[1,0,1] op_sel_hi:[1,0,1]
 v_and_b32 v27, 1, v27
 v_fma_mix_f32 v50, v81, 1.0, v83 op_sel:[0,0,0] op_sel_hi:[1,0,1]
 v_cmp_ne_u32 vcc, 0, v27
 v_fma_mix_f32 v51, v81, 1.0, v83 op_sel:[1,0,1] op_sel_hi:[1,0,1]
 v_max3_f32 v62, v48, v49, v79
 s_cbranch_vccnz psr_41
psj_42:
 v_max3_f32 v62, v62, v50, v51
 v_cvt_pk_bf16_f32 v146, v100, v101
 v_cvt_pk_bf16_f32 v147, v102, v103
 v_max_f32_dpp v62, v62, v62 row_ror:8 row_mask:0xf bank_mask:0xf
 v_mov_b32 v63, v62
 v_cvt_pk_bf16_f32 v148, v104, v105
 v_cvt_pk_bf16_f32 v149, v106, v107
 v_permlane32_swap_b32 v62, v63
 v_max_f32 v62, v62, v63
 v_mov_b32 v63, v62
 v_cvt_pk_bf16_f32 v150, v108, v109
 v_cvt_pk_bf16_f32 v151, v110, v111
 v_permlane16_swap_b32 v62, v63
 v_max_f32 v62, v62, v63
 v_mul_f32 v62, s86, v62
 v_fma_f32 v48, v48, s86, -v62
 v_fma_f32 v49, v49, s86, -v62
 v_fma_f32 v50, v50, s86, -v62
 v_fma_f32 v51, v51, s86, -v62
 v_fma_f32 v52, v52, s86, -v62
 v_fma_f32 v53, v53, s86, -v62
 v_exp_f32 v48, v48
 v_exp_f32 v49, v49
 buffer_load_dwordx4 v[88:91], v17, s[28:31], s64 offen offset:0 sc1
 v_exp_f32 v50, v50
 v_exp_f32 v51, v51
 buffer_load_dwordx4 v[92:95], v16, s[28:31], s64 offen offset:1024 sc1
 v_exp_f32 v52, v52
 v_exp_f32 v53, v53
 buffer_load_dwordx4 v[96:99], v20, s[28:31], s64 offen offset:2048 sc1
 v_cvt_pk_bf16_f32 v138, v48, v49
 v_cvt_pk_bf16_f32 v139, v50, v51
 v_cvt_pk_bf16_f32 v142, v52, v53
 v_mov_b32_dpp v140, v138 row_ror:8 row_mask:0xf bank_mask:0xf
 v_mov_b32_dpp v141, v139 row_ror:8 row_mask:0xf bank_mask:0xf
 v_mov_b32_dpp v143, v142 row_ror:8 row_mask:0xf bank_mask:0xf
 buffer_load_dwordx4 v[112:115], v18, s[16:19], s80 offen sc1
 v_add_f32 v54, v48, v49
 v_mfma_f32_16x16x32_bf16 v[64:67], v[126:129], v[138:141], 0
 v_add_f32 v55, v50, v51
 v_add_f32 v56, v52, v53
 v_mfma_f32_16x16x32_bf16 v[64:67], v[146:149], v[142:145], v[64:67]
 v_add_f32 v62, v54, v55
 v_fmac_f32 v62, v56, v26
 v_mfma_f32_16x16x32_bf16 v[68:71], v[130:133], v[138:141], 0
 buffer_load_dwordx2 v[116:117], v19, s[16:19], s80 offen sc1
 v_add_f32_dpp v62, v62, v62 row_ror:8 row_mask:0xf bank_mask:0xf
 v_mfma_f32_16x16x32_bf16 v[68:71], v[148:151], v[142:145], v[68:71]
 v_mov_b32 v63, v62
 s_cmp_lt_i32 s55, 0
 s_cbranch_scc1 fl_45
fl_46:
 v_mfma_f32_16x16x32_bf16 v[72:75], v[134:137], v[138:141], 0
 v_permlane32_swap_b32 v62, v63
 v_mfma_f32_16x16x32_bf16 v[72:75], v[150:153], v[142:145], v[72:75]
 v_add_f32 v62, v62, v63
 v_mov_b32 v63, v62
 ds_write_b128 v11, v[64:67] offset:0
 s_nop 0
 v_permlane16_swap_b32 v62, v63
 v_add_f32 v62, v62, v63
 v_rcp_f32 v62, v62
 ds_write_b128 v11, v[68:71] offset:1024
 s_mov_b64 exec, 0xff
 ds_write_b32 v22, v62
 s_mov_b64 exec, -1
 ds_write_b128 v11, v[72:75] offset:2048
 s_waitcnt lgkmcnt(0)
 s_barrier
 ds_read_b128 v[72:75], v23
 ds_read_b64 v[64:65], v12 offset:0
 ds_read_b64 v[66:67], v12 offset:3072
 ds_read_b64 v[68:69], v12 offset:6144
 ds_read_b64 v[70:71], v12 offset:9216
 s_waitcnt lgkmcnt(2)
 v_pk_mul_f32 v[64:65], v[64:65], v[72:73] op_sel_hi:[1,0]
 v_pk_fma_f32 v[64:65], v[66:67], v[72:73], v[64:65] op_sel:[0,1,0] op_sel_hi:[1,1,1]
 s_waitcnt lgkmcnt(0)
 v_pk_fma_f32 v[64:65], v[68:69], v[74:75], v[64:65] op_sel_hi:[1,0,1]
 v_pk_fma_f32 v[64:65], v[70:71], v[74:75], v[64:65] op_sel:[0,1,0] op_sel_hi:[1,1,1]
 v_cvt_pk_f16_f32 v68, v64, v65
 v_perm_b32 v68, s91, v68, v14
 buffer_atomic_pk_add_f16 v68, v13, s[4:7], s3 offen
 v_mov_b32 v76, v108
 v_mov_b32 v77, v109
 v_mov_b32 v78, v110
 v_mov_b32 v79, v111
 v_permlane32_swap_b32 v100, v104
 v_permlane32_swap_b32 v101, v105
 v_permlane32_swap_b32 v102, v106
 v_permlane32_swap_b32 v103, v107
 v_permlane32_swap_b32 v108, v76
 v_permlane32_swap_b32 v109, v77
 v_permlane32_swap_b32 v110, v78
 v_permlane32_swap_b32 v111, v79
 v_pk_add_f32 v[100:101], v[100:101], v[104:105]
 v_pk_add_f32 v[102:103], v[102:103], v[106:107]
 v_pk_add_f32 v[108:109], v[108:109], v[76:77]
 v_pk_add_f32 v[110:111], v[110:111], v[78:79]
 v_cvt_pk_bf16_f32 v80, v100, v101
 v_cvt_pk_bf16_f32 v82, v108, v109
 v_cvt_pk_bf16_f32 v81, v102, v103
 v_cvt_pk_bf16_f32 v83, v110, v111
 s_nop 0
 v_permlane16_swap_b32 v80, v82
 v_permlane16_swap_b32 v81, v83
 v_min_u32 v80, -2, v80
 s_mov_b64 exec, s[76:77]
 buffer_store_dwordx4 v[80:83], v15, s[24:27], s57 offen sc1
 s_mov_b64 exec, -1
 s_add_u32 s64, s64, 1310720
 s_add_u32 s52, s52, 1
 s_branch step_34
fl_39:
 buffer_load_dword v0, off, s[12:15], s79 sc1
 s_branch fl_40
A1_14:
 v_smfmac_f32_16x16x32_f16 v[40:43], v[36:37], a[16:19], v25
 v_smfmac_f32_16x16x32_f16 v[52:55], v[36:37], a[76:79], v25
 v_smfmac_f32_16x16x32_f16 v[44:47], v[36:37], a[36:39], v25
 v_smfmac_f32_16x16x32_f16 v[56:59], v[36:37], a[96:99], v25
 s_branch A2_38
pm_37:
 buffer_load_dwordx4 v[36:39], v4, s[4:7], s84 offen offset:2048 sc1
 buffer_load_dwordx4 v[28:31], v4, s[4:7], s84 offen offset:0 sc1
 buffer_load_dwordx4 v[32:35], v4, s[4:7], s84 offen offset:1024 sc1
 s_nop 7
 v_mov_b32 v40, 0
 v_mov_b32 v41, 0
 v_mov_b32 v42, 0
 v_mov_b32 v43, 0
 v_mov_b32 v52, 0
 v_mov_b32 v53, 0
 v_mov_b32 v54, 0
 v_mov_b32 v55, 0
 v_mov_b32 v44, 0
 v_mov_b32 v45, 0
 v_mov_b32 v46, 0
 v_mov_b32 v47, 0
 v_mov_b32 v56, 0
 v_mov_b32 v57, 0
 v_mov_b32 v58, 0
 v_mov_b32 v59, 0
 s_waitcnt vmcnt(0)
 v_bitop3_b32 v27, v31, v35, v39 bitop3:0x80
 v_perm_b32 v31, v35, v31, s89
 v_cmp_gt_u32 vcc, 0x48000000, v27
 v_mov_b32 v35, v38
 s_cbranch_vccz A1_14
pm_36:
 s_cmp_gt_u32 s52, 3
 s_cbranch_scc1 op_47
 v_readfirstlane_b32 s21, v0
 s_cmp_ge_u32 s21, s46
 s_cbranch_scc1 op_47
 buffer_load_dword v0, off, s[12:15], s79 sc1
 s_waitcnt vmcnt(0)
 v_readfirstlane_b32 s21, v0
 s_cmp_gt_u32 s21, s52
 s_cselect_b32 s21, s87, 0
 s_cmp_eq_u32 s21, 0
 s_cbranch_scc1 op_47
 s_mov_b32 s87, 0
 s_sub_u32 s21, s64, 1310720
 buffer_load_dwordx4 v[126:129], v16, s[28:31], s21 offen offset:0 sc1
 buffer_load_dwordx4 v[130:133], v16, s[28:31], s21 offen offset:1024 sc1
 buffer_load_dwordx4 v[134:137], v16, s[28:31], s21 offen offset:2048 sc1
op_47:
 buffer_load_dwordx4 v[36:39], v4, s[4:7], s84 offen offset:2048 sc1
 buffer_load_dwordx4 v[28:31], v4, s[4:7], s84 offen offset:0 sc1
 buffer_load_dwordx4 v[32:35], v4, s[4:7], s84 offen offset:1024 sc1
 s_add_u32 s54, s54, 1
 s_cmp_gt_u32 s54, 131072
 s_cbranch_scc1 end0
 s_waitcnt vmcnt(0)
 v_bitop3_b32 v27, v31, v35, v39 bitop3:0x80
 v_perm_b32 v31, v35, v31, s89
 v_cmp_gt_u32 vcc, 0x48000000, v27
 v_mov_b32 v35, v38
 s_cbranch_vccnz pm_36
 s_branch A1_14
psr_41:
 buffer_load_dwordx2 v[58:59], v9, s[8:11], s81 offen sc1
 buffer_load_dwordx4 v[40:43], v8, s[8:11], s81 offen offset:0 sc1
 buffer_load_dwordx4 v[44:47], v8, s[8:11], s81 offen offset:1024 sc1
 s_add_u32 s54, s54, 1
 s_cmp_gt_u32 s54, 131072
 s_cbranch_scc1 end0
 s_waitcnt vmcnt(2)
 v_xor_b32 v76, s88, v58
 s_nop 0
 v_permlane16_swap_b32 v58, v59
 v_fma_mix_f32 v60, v58, 1.0, v59 op_sel:[0,0,0] op_sel_hi:[1,0,1]
 v_fma_mix_f32 v61, v58, 1.0, v59 op_sel:[1,0,1] op_sel_hi:[1,0,1]
 v_mov_b32 v58, v60
 v_mov_b32 v59, v61
 s_nop 0
 v_permlane32_swap_b32 v58, v60
 v_permlane32_swap_b32 v59, v61
 v_add_f32 v52, v58, v60
 v_add_f32 v53, v59, v61
 v_max_f32 v79, v52, v53
 s_waitcnt vmcnt(0)
 v_pk_add_f16 v80, v40, v44
 v_pk_add_f16 v82, v42, v46
 v_pk_add_f16 v81, v41, v45
 v_pk_add_f16 v83, v43, v47
 v_permlane32_swap_b32 v80, v82
 v_bitop3_b32 v77, v40, v42, s88 bitop3:0x7e
 v_permlane32_swap_b32 v81, v83
 v_bitop3_b32 v78, v44, v46, s88 bitop3:0x7e
 v_fma_mix_f32 v48, v80, 1.0, v82 op_sel:[0,0,0] op_sel_hi:[1,0,1]
 v_or3_b32 v27, v76, v77, v78
 v_fma_mix_f32 v49, v80, 1.0, v82 op_sel:[1,0,1] op_sel_hi:[1,0,1]
 v_and_b32 v27, 1, v27
 v_fma_mix_f32 v50, v81, 1.0, v83 op_sel:[0,0,0] op_sel_hi:[1,0,1]
 v_cmp_ne_u32 vcc, 0, v27
 v_fma_mix_f32 v51, v81, 1.0, v83 op_sel:[1,0,1] op_sel_hi:[1,0,1]
 v_max3_f32 v62, v48, v49, v79
 s_cbranch_vccnz psr_41
 s_branch psj_42
kvw_43:
 s_mov_b32 s22, s87
 s_cmp_eq_u32 s52, 0
 s_cselect_b32 s55, 0, s55
 s_cselect_b32 s87, 1, 0
 s_cbranch_scc1 kvok_44
 v_mov_b32 v62, 0
 s_mov_b32 s101, 0
wf_48:
 buffer_load_dword v63, v62, s[12:15], s79 offen sc1
 s_add_u32 s101, s101, 1
 s_cmp_gt_u32 s101, 131072
 s_cbranch_scc1 end0
 s_waitcnt vmcnt(0)
 v_readfirstlane_b32 s100, v63
 s_cmp_ge_u32 s100, s46
 s_cbranch_scc1 wf_49
 s_sleep 3
 s_branch wf_48
wf_49:
 s_cmp_eq_u32 s22, 0
 s_cbranch_scc1 kvok_44
 s_sub_u32 s21, s64, 1310720
 buffer_load_dwordx4 v[126:129], v16, s[28:31], s21 offen offset:0 sc1
 buffer_load_dwordx4 v[130:133], v16, s[28:31], s21 offen offset:1024 sc1
 buffer_load_dwordx4 v[134:137], v16, s[28:31], s21 offen offset:2048 sc1
 s_waitcnt vmcnt(0)
 s_branch kvok_44
fl_45:
 buffer_load_dword v0, off, s[12:15], s79 sc1
 s_branch fl_46
last_35:
 s_waitcnt lgkmcnt(10)
 v_smfmac_f32_16x16x64_f16 v[100:103], v[28:31], a[120:127], v25
 v_smfmac_f32_16x16x64_f16 v[104:107], v[28:31], a[128:135], v25
 v_smfmac_f32_16x16x64_f16 v[108:111], v[28:31], a[136:143], v25
 v_smfmac_f32_16x16x64_f16 v[100:103], v[32:35], a[144:151], v25
 v_smfmac_f32_16x16x64_f16 v[104:107], v[32:35], a[152:159], v25
 v_smfmac_f32_16x16x64_f16 v[108:111], v[32:35], a[160:167], v25
 s_waitcnt lgkmcnt(7)
 v_smfmac_f32_16x16x64_f16 v[100:103], v[64:67], a[168:175], v25
 v_smfmac_f32_16x16x64_f16 v[104:107], v[64:67], a[176:183], v25
 v_smfmac_f32_16x16x64_f16 v[108:111], v[64:67], a[184:191], v25
 v_smfmac_f32_16x16x64_f16 v[100:103], v[68:71], a[192:199], v25
 v_smfmac_f32_16x16x64_f16 v[104:107], v[68:71], a[200:207], v25
 v_smfmac_f32_16x16x64_f16 v[108:111], v[68:71], a[208:215], v25
 v_smfmac_f32_16x16x64_f16 v[100:103], v[72:75], a[216:223], v25
 v_smfmac_f32_16x16x64_f16 v[104:107], v[72:75], a[224:231], v25
 v_smfmac_f32_16x16x64_f16 v[108:111], v[72:75], a[232:239], v25
 s_waitcnt lgkmcnt(4)
 v_smfmac_f32_16x16x64_f16 v[100:103], v[76:79], a[240:247], v25
 v_smfmac_f32_16x16x64_f16 v[104:107], v[76:79], a[248:255], v25
 v_smfmac_f32_16x16x64_f16 v[108:111], v[76:79], v[152:159], v25
 v_smfmac_f32_16x16x64_f16 v[100:103], v[80:83], v[160:167], v25
 v_smfmac_f32_16x16x64_f16 v[104:107], v[80:83], v[168:175], v25
 v_smfmac_f32_16x16x64_f16 v[108:111], v[80:83], v[176:183], v25
 v_smfmac_f32_16x16x64_f16 v[100:103], v[84:87], v[184:191], v25
 v_smfmac_f32_16x16x64_f16 v[104:107], v[84:87], v[192:199], v25
 v_smfmac_f32_16x16x64_f16 v[108:111], v[84:87], v[200:207], v25
 s_waitcnt lgkmcnt(0)
 v_smfmac_f32_16x16x64_f16 v[100:103], v[88:91], v[208:215], v25
 v_smfmac_f32_16x16x64_f16 v[104:107], v[88:91], v[216:223], v25
 v_smfmac_f32_16x16x64_f16 v[108:111], v[88:91], v[224:231], v25
 v_smfmac_f32_16x16x64_f16 v[100:103], v[92:95], v[232:239], v25
 v_smfmac_f32_16x16x64_f16 v[104:107], v[92:95], v[240:247], v25
 v_smfmac_f32_16x16x64_f16 v[108:111], v[92:95], v[248:255], v25
 s_nop 7
 v_mov_b32 v76, v108
 v_mov_b32 v77, v109
 v_mov_b32 v78, v110
 v_mov_b32 v79, v111
 v_permlane32_swap_b32 v100, v104
 v_permlane32_swap_b32 v101, v105
 v_permlane32_swap_b32 v102, v106
 v_permlane32_swap_b32 v103, v107
 v_permlane32_swap_b32 v108, v76
 v_permlane32_swap_b32 v109, v77
 v_permlane32_swap_b32 v110, v78
 v_permlane32_swap_b32 v111, v79
 v_pk_add_f32 v[100:101], v[100:101], v[104:105]
 v_pk_add_f32 v[102:103], v[102:103], v[106:107]
 v_pk_add_f32 v[108:109], v[108:109], v[76:77]
 v_pk_add_f32 v[110:111], v[110:111], v[78:79]
 v_cvt_pk_bf16_f32 v80, v100, v101
 v_cvt_pk_bf16_f32 v82, v108, v109
 v_cvt_pk_bf16_f32 v81, v102, v103
 v_cvt_pk_bf16_f32 v83, v110, v111
 s_nop 0
 v_permlane16_swap_b32 v80, v82
 v_permlane16_swap_b32 v81, v83
 v_min_u32 v80, -2, v80
 s_mov_b64 exec, s[76:77]
 buffer_store_dwordx4 v[80:83], v15, s[24:27], s57 offen sc1
 s_mov_b64 exec, -1
 s_branch chain_done
step_50:
 s_and_b32 s21, s52, 3
 s_mul_i32 s81, s21, 540672
 s_lshl_b32 s84, s21, 15
 s_add_u32 s21, s52, 3
 s_and_b32 s21, s21, 3
 s_lshl_b32 s83, s21, 15
 s_add_u32 s21, s52, 1
 s_and_b32 s22, s21, 3
 s_lshl_b32 s3, s22, 15
 s_mul_i32 s80, s21, 393216
 s_add_u32 s46, s21, 1
 s_min_u32 s46, s46, 64
 s_mul_i32 s85, s52, 98304
 s_mul_i32 s57, s52, 327680
 s_add_u32 s57, s57, 51380224
 s_bfe_u32 s88, s52, 0x10002
 s_max_u32 s67, s52, 1
 s_sub_u32 s67, s67, 1
 v_mov_b32 v40, 0
 v_mov_b32 v41, 0
 v_mov_b32 v42, 0
 v_mov_b32 v43, 0
 v_mov_b32 v44, 0
 v_mov_b32 v45, 0
 v_mov_b32 v46, 0
 v_mov_b32 v47, 0
 v_mov_b32 v48, 0
 v_mov_b32 v49, 0
 v_mov_b32 v50, 0
 v_mov_b32 v51, 0
 v_mov_b32 v52, 0
 v_mov_b32 v53, 0
 v_mov_b32 v54, 0
 v_mov_b32 v55, 0
 v_mov_b32 v56, 0
 v_mov_b32 v57, 0
 v_mov_b32 v58, 0
 v_mov_b32 v59, 0
 v_mov_b32 v60, 0
 v_mov_b32 v61, 0
 v_mov_b32 v62, 0
 v_mov_b32 v63, 0
 v_mov_b32 v100, 0
 v_mov_b32 v101, 0
 v_mov_b32 v102, 0
 v_mov_b32 v103, 0
 v_mov_b32 v104, 0
 v_mov_b32 v105, 0
 v_mov_b32 v106, 0
 v_mov_b32 v107, 0
 v_mov_b32 v108, 0
 v_mov_b32 v109, 0
 v_mov_b32 v110, 0
 v_mov_b32 v111, 0
 s_sleep 4
 s_nop 3
 v_readfirstlane_b32 s21, v0
 s_cmp_lt_u32 s21, s46
 s_cselect_b32 s55, s55, 0
 s_cmp_lt_i32 s55, 0
 s_cbranch_scc1 fl_55
fl_56:
 s_mov_b32 s54, 0
 buffer_load_dwordx4 v[36:39], v4, s[4:7], s84 offen offset:2048 sc1
 buffer_load_dwordx4 v[28:31], v4, s[4:7], s84 offen offset:0 sc1
 buffer_load_dwordx4 v[32:35], v4, s[4:7], s84 offen offset:1024 sc1
 s_waitcnt vmcnt(3)
 v_mov_b32 v126, v88
 v_mov_b32 v127, v89
 v_mov_b32 v128, v90
 v_mov_b32 v129, v91
 v_mov_b32 v130, v92
 v_mov_b32 v131, v93
 v_mov_b32 v132, v94
 v_mov_b32 v133, v95
 v_mov_b32 v134, v96
 v_mov_b32 v135, v97
 v_mov_b32 v136, v98
 v_mov_b32 v137, v99
 s_waitcnt vmcnt(2)
 v_smfmac_f32_16x16x32_f16 v[40:43], v[36:37], a[16:19], v25
 v_smfmac_f32_16x16x32_f16 v[52:55], v[36:37], a[76:79], v25
 v_smfmac_f32_16x16x32_f16 v[44:47], v[36:37], a[36:39], v25
 s_waitcnt vmcnt(0)
 v_bitop3_b32 v27, v31, v35, v39 bitop3:0x80
 v_perm_b32 v31, v35, v31, s89
 v_cmp_gt_u32 vcc, 0x48000000, v27
 v_mov_b32 v35, v38
 v_smfmac_f32_16x16x32_f16 v[56:59], v[36:37], a[96:99], v25
 s_cbranch_vccnz pm_53
A2_54:
 v_smfmac_f32_16x16x64_f16 v[40:43], v[28:31], a[0:7], v25
 ds_write_b128 v10, v[28:31]
 v_smfmac_f32_16x16x64_f16 v[40:43], v[32:35], a[8:15], v25
 ds_write_b128 v10, v[32:35] offset:1024
 v_smfmac_f32_16x16x64_f16 v[52:55], v[28:31], a[60:67], v25
 ds_write_b64 v10, v[36:37] offset:2048
 v_smfmac_f32_16x16x64_f16 v[52:55], v[32:35], a[68:75], v25
 v_cvt_pk_f16_f32 v40, v40, v41
 v_cvt_pk_f16_f32 v41, v42, v43
 v_smfmac_f32_16x16x32_f16 v[48:51], v[36:37], a[56:59], v25
 v_smfmac_f32_16x16x32_f16 v[60:63], v[36:37], a[116:119], v25
 v_smfmac_f32_16x16x64_f16 v[44:47], v[28:31], a[20:27], v25
 v_cvt_pk_f16_f32 v52, v52, v53
 v_cvt_pk_f16_f32 v53, v54, v55
 s_nop 0
 v_smfmac_f32_16x16x64_f16 v[44:47], v[32:35], a[28:35], v25
 v_permlane32_swap_b32 v40, v52
 v_smfmac_f32_16x16x64_f16 v[56:59], v[28:31], a[80:87], v25
 v_permlane32_swap_b32 v41, v53
 v_pk_add_f16 v40, v40, v52
 v_smfmac_f32_16x16x64_f16 v[56:59], v[32:35], a[88:95], v25
 v_pk_add_f16 v41, v41, v53
 v_smfmac_f32_16x16x64_f16 v[48:51], v[28:31], a[40:47], v25
 ds_write_b64 v5, v[40:41] offset:0
 v_smfmac_f32_16x16x64_f16 v[48:51], v[32:35], a[48:55], v25
 v_cvt_pk_f16_f32 v44, v44, v45
 v_cvt_pk_f16_f32 v45, v46, v47
 v_cvt_pk_f16_f32 v56, v56, v57
 v_smfmac_f32_16x16x64_f16 v[60:63], v[28:31], a[100:107], v25
 v_cvt_pk_f16_f32 v57, v58, v59
 s_nop 0
 v_smfmac_f32_16x16x64_f16 v[60:63], v[32:35], a[108:115], v25
 v_permlane32_swap_b32 v44, v56
 v_permlane32_swap_b32 v45, v57
 v_pk_add_f16 v44, v44, v56
 v_pk_add_f16 v45, v45, v57
 ds_write_b64 v5, v[44:45] offset:640
 v_cvt_pk_f16_f32 v48, v48, v49
 v_cvt_pk_f16_f32 v49, v50, v51
 v_cvt_pk_f16_f32 v60, v60, v61
 v_cvt_pk_f16_f32 v61, v62, v63
 s_nop 0
 v_permlane32_swap_b32 v48, v60
 v_permlane32_swap_b32 v49, v61
 v_pk_add_f16 v48, v48, v60
 v_pk_add_f16 v49, v49, v61
 ds_write_b64 v5, v[48:49] offset:1280
 s_waitcnt lgkmcnt(0) vmcnt(0)
 s_barrier
 ds_read_b64_tr_b16 v[40:41], v6 offset:0
 ds_read_b64_tr_b16 v[42:43], v6 offset:1920
 ds_read_b64_tr_b16 v[44:45], v6 offset:3840
 ds_read_b64_tr_b16 v[46:47], v6 offset:5760
 ds_read_b64_tr_b16 v[48:49], v6 offset:640
 ds_read_b64_tr_b16 v[50:51], v6 offset:2560
 ds_read_b64_tr_b16 v[52:53], v6 offset:4480
 ds_read_b64_tr_b16 v[54:55], v6 offset:6400
 ds_read_b64_tr_b16 v[56:57], v6 offset:1280
 ds_read_b64_tr_b16 v[58:59], v6 offset:3200
 ds_read_b64_tr_b16 v[60:61], v6 offset:5120
 ds_read_b64_tr_b16 v[62:63], v6 offset:7040
 s_waitcnt lgkmcnt(8)
 v_pk_add_f16 v40, v40, v42
 v_pk_add_f16 v44, v44, v46
 v_pk_add_f16 v41, v41, v43
 v_pk_add_f16 v45, v45, v47
 v_fma_mix_f32 v146, v40, 1.0, v44 op_sel:[0,0,0] op_sel_hi:[1,0,1]
 v_fma_mix_f32 v147, v40, 1.0, v44 op_sel:[1,0,1] op_sel_hi:[1,0,1]
 v_fma_mix_f32 v148, v41, 1.0, v45 op_sel:[0,0,0] op_sel_hi:[1,0,1]
 v_fma_mix_f32 v149, v41, 1.0, v45 op_sel:[1,0,1] op_sel_hi:[1,0,1]
 v_cvt_pk_bf16_f32 v118, v146, v147
 v_cvt_pk_bf16_f32 v119, v148, v149
 s_waitcnt lgkmcnt(4)
 v_pk_add_f16 v48, v48, v50
 v_pk_add_f16 v52, v52, v54
 v_pk_add_f16 v49, v49, v51
 v_pk_add_f16 v53, v53, v55
 v_fma_mix_f32 v146, v48, 1.0, v52 op_sel:[0,0,0] op_sel_hi:[1,0,1]
 v_fma_mix_f32 v147, v48, 1.0, v52 op_sel:[1,0,1] op_sel_hi:[1,0,1]
 v_fma_mix_f32 v148, v49, 1.0, v53 op_sel:[0,0,0] op_sel_hi:[1,0,1]
 v_fma_mix_f32 v149, v49, 1.0, v53 op_sel:[1,0,1] op_sel_hi:[1,0,1]
 v_cvt_pk_bf16_f32 v120, v146, v147
 v_cvt_pk_bf16_f32 v121, v148, v149
 s_waitcnt lgkmcnt(0)
 v_pk_add_f16 v56, v56, v58
 v_pk_add_f16 v60, v60, v62
 v_pk_add_f16 v57, v57, v59
 v_pk_add_f16 v61, v61, v63
 v_fma_mix_f32 v146, v56, 1.0, v60 op_sel:[0,0,0] op_sel_hi:[1,0,1]
 v_fma_mix_f32 v147, v56, 1.0, v60 op_sel:[1,0,1] op_sel_hi:[1,0,1]
 v_mfma_f32_16x16x32_bf16 v[40:43], v[118:121], v[118:121], 0
 v_fma_mix_f32 v148, v57, 1.0, v61 op_sel:[0,0,0] op_sel_hi:[1,0,1]
 v_fma_mix_f32 v149, v57, 1.0, v61 op_sel:[1,0,1] op_sel_hi:[1,0,1]
 v_cvt_pk_bf16_f32 v122, v146, v147
 v_cvt_pk_bf16_f32 v123, v148, v149
 s_nop 1
 v_mfma_f32_16x16x32_bf16 v[40:43], v[122:125], v[122:125], v[40:43]
 ds_read_b128 v[28:31], v16 offset:24576
 ds_read_b128 v[32:35], v16 offset:25600
 ds_read_b128 v[64:67], v16 offset:27648
 ds_read_b128 v[68:71], v16 offset:28672
 ds_read_b128 v[72:75], v16 offset:30720
 ds_read_b128 v[76:79], v16 offset:31744
 s_nop 0
 s_mov_b64 exec, s[74:75]
 v_cvt_pk_f16_f32 v44, v40, v41
 v_cvt_pk_f16_f32 v45, v42, v43
 v_and_or_b32 v44, v44, -2, s88
 buffer_store_dwordx2 v[44:45], v7, s[8:11], s81 offen
 s_mov_b64 exec, -1
 ds_read_b128 v[80:83], v16 offset:33792
 ds_read_b128 v[84:87], v16 offset:34816
 ds_read_b64 v[88:89], v16 offset:26624
 ds_read_b64 v[90:91], v16 offset:29696
 ds_read_b64 v[92:93], v16 offset:32768
 ds_read_b64 v[94:95], v16 offset:35840
 s_cmp_eq_u32 s52, 63
 s_cbranch_scc1 last_51
 s_waitcnt lgkmcnt(10)
 v_smfmac_f32_16x16x64_f16 v[100:103], v[28:31], a[120:127], v25
 v_smfmac_f32_16x16x64_f16 v[104:107], v[28:31], a[128:135], v25
 v_smfmac_f32_16x16x64_f16 v[108:111], v[28:31], a[136:143], v25
 s_mov_b32 s54, 0
 v_smfmac_f32_16x16x64_f16 v[100:103], v[32:35], a[144:151], v25
 v_readfirstlane_b32 s21, v0
 v_smfmac_f32_16x16x64_f16 v[104:107], v[32:35], a[152:159], v25
 s_add_u32 s22, s46, 3
 v_smfmac_f32_16x16x64_f16 v[108:111], v[32:35], a[160:167], v25
 s_min_u32 s22, s22, 64
 s_waitcnt lgkmcnt(7)
 v_smfmac_f32_16x16x64_f16 v[100:103], v[64:67], a[168:175], v25
 s_sub_u32 s55, s21, s22
 v_smfmac_f32_16x16x64_f16 v[104:107], v[64:67], a[176:183], v25
 s_sub_u32 s56, s21, s46
 v_smfmac_f32_16x16x64_f16 v[108:111], v[64:67], a[184:191], v25
 v_smfmac_f32_16x16x64_f16 v[100:103], v[68:71], a[192:199], v25
 v_smfmac_f32_16x16x64_f16 v[104:107], v[68:71], a[200:207], v25
 v_smfmac_f32_16x16x64_f16 v[108:111], v[68:71], a[208:215], v25
 v_smfmac_f32_16x16x64_f16 v[100:103], v[72:75], a[216:223], v25
 v_smfmac_f32_16x16x64_f16 v[104:107], v[72:75], a[224:231], v25
 v_smfmac_f32_16x16x64_f16 v[108:111], v[72:75], a[232:239], v25
 s_waitcnt lgkmcnt(4)
 v_smfmac_f32_16x16x64_f16 v[100:103], v[76:79], a[240:247], v25
 v_smfmac_f32_16x16x64_f16 v[104:107], v[76:79], a[248:255], v25
 v_smfmac_f32_16x16x64_f16 v[108:111], v[76:79], v[152:159], v25
 buffer_load_dwordx2 v[58:59], v9, s[8:11], s81 offen sc1
 buffer_load_dwordx4 v[40:43], v8, s[8:11], s81 offen offset:0 sc1
 buffer_load_dwordx4 v[44:47], v8, s[8:11], s81 offen offset:1024 sc1
 v_smfmac_f32_16x16x64_f16 v[100:103], v[80:83], v[160:167], v25
 v_smfmac_f32_16x16x64_f16 v[104:107], v[80:83], v[168:175], v25
 v_smfmac_f32_16x16x64_f16 v[108:111], v[80:83], v[176:183], v25
 v_smfmac_f32_16x16x64_f16 v[100:103], v[84:87], v[184:191], v25
 v_smfmac_f32_16x16x64_f16 v[104:107], v[84:87], v[192:199], v25
 v_smfmac_f32_16x16x64_f16 v[108:111], v[84:87], v[200:207], v25
 s_waitcnt lgkmcnt(0)
 v_smfmac_f32_16x16x64_f16 v[100:103], v[88:91], v[208:215], v25
 v_smfmac_f32_16x16x64_f16 v[104:107], v[88:91], v[216:223], v25
 v_smfmac_f32_16x16x64_f16 v[108:111], v[88:91], v[224:231], v25
 v_smfmac_f32_16x16x64_f16 v[100:103], v[92:95], v[232:239], v25
 v_smfmac_f32_16x16x64_f16 v[104:107], v[92:95], v[240:247], v25
 v_smfmac_f32_16x16x64_f16 v[108:111], v[92:95], v[248:255], v25
 s_cmp_lt_i32 s56, 0
 s_cbranch_scc1 kvw_59
kvok_60:
 s_waitcnt vmcnt(2)
 v_xor_b32 v76, s88, v58
 s_nop 0
 v_permlane16_swap_b32 v58, v59
 v_fma_mix_f32 v60, v58, 1.0, v59 op_sel:[0,0,0] op_sel_hi:[1,0,1]
 v_fma_mix_f32 v61, v58, 1.0, v59 op_sel:[1,0,1] op_sel_hi:[1,0,1]
 v_mov_b32 v58, v60
 v_mov_b32 v59, v61
 s_nop 0
 v_permlane32_swap_b32 v58, v60
 v_permlane32_swap_b32 v59, v61
 v_add_f32 v52, v58, v60
 v_add_f32 v53, v59, v61
 v_max_f32 v79, v52, v53
 s_waitcnt vmcnt(0)
 v_pk_add_f16 v80, v40, v44
 v_pk_add_f16 v82, v42, v46
 v_pk_add_f16 v81, v41, v45
 v_pk_add_f16 v83, v43, v47
 v_permlane32_swap_b32 v80, v82
 v_bitop3_b32 v77, v40, v42, s88 bitop3:0x7e
 v_permlane32_swap_b32 v81, v83
 v_bitop3_b32 v78, v44, v46, s88 bitop3:0x7e
 v_fma_mix_f32 v48, v80, 1.0, v82 op_sel:[0,0,0] op_sel_hi:[1,0,1]
 v_or3_b32 v27, v76, v77, v78
 v_fma_mix_f32 v49, v80, 1.0, v82 op_sel:[1,0,1] op_sel_hi:[1,0,1]
 v_and_b32 v27, 1, v27
 v_fma_mix_f32 v50, v81, 1.0, v83 op_sel:[0,0,0] op_sel_hi:[1,0,1]
 v_cmp_ne_u32 vcc, 0, v27
 v_fma_mix_f32 v51, v81, 1.0, v83 op_sel:[1,0,1] op_sel_hi:[1,0,1]
 v_max3_f32 v62, v48, v49, v79
 s_cbranch_vccnz psr_57
psj_58:
 v_max3_f32 v62, v62, v50, v51
 v_cvt_pk_bf16_f32 v146, v100, v101
 v_cvt_pk_bf16_f32 v147, v102, v103
 v_max_f32_dpp v62, v62, v62 row_ror:8 row_mask:0xf bank_mask:0xf
 v_mov_b32 v63, v62
 v_cvt_pk_bf16_f32 v148, v104, v105
 v_cvt_pk_bf16_f32 v149, v106, v107
 v_permlane32_swap_b32 v62, v63
 v_max_f32 v62, v62, v63
 v_mov_b32 v63, v62
 v_cvt_pk_bf16_f32 v150, v108, v109
 v_cvt_pk_bf16_f32 v151, v110, v111
 v_permlane16_swap_b32 v62, v63
 v_max_f32 v62, v62, v63
 v_mul_f32 v62, s86, v62
 v_fma_f32 v48, v48, s86, -v62
 v_fma_f32 v49, v49, s86, -v62
 v_fma_f32 v50, v50, s86, -v62
 v_fma_f32 v51, v51, s86, -v62
 v_fma_f32 v52, v52, s86, -v62
 v_fma_f32 v53, v53, s86, -v62
 v_exp_f32 v48, v48
 v_exp_f32 v49, v49
 buffer_load_dwordx4 v[88:91], v17, s[28:31], s64 offen offset:0 sc1
 v_exp_f32 v50, v50
 v_exp_f32 v51, v51
 buffer_load_dwordx4 v[92:95], v16, s[28:31], s64 offen offset:1024 sc1
 v_exp_f32 v52, v52
 v_exp_f32 v53, v53
 buffer_load_dwordx4 v[96:99], v20, s[28:31], s64 offen offset:2048 sc1
 v_cvt_pk_bf16_f32 v138, v48, v49
 v_cvt_pk_bf16_f32 v139, v50, v51
 v_cvt_pk_bf16_f32 v142, v52, v53
 v_mov_b32_dpp v140, v138 row_ror:8 row_mask:0xf bank_mask:0xf
 v_mov_b32_dpp v141, v139 row_ror:8 row_mask:0xf bank_mask:0xf
 v_mov_b32_dpp v143, v142 row_ror:8 row_mask:0xf bank_mask:0xf
 v_add_f32 v54, v48, v49
 v_mfma_f32_16x16x32_bf16 v[64:67], v[126:129], v[138:141], 0
 v_add_f32 v55, v50, v51
 v_add_f32 v56, v52, v53
 v_mfma_f32_16x16x32_bf16 v[64:67], v[146:149], v[142:145], v[64:67]
 v_add_f32 v62, v54, v55
 v_fmac_f32 v62, v56, v26
 v_mfma_f32_16x16x32_bf16 v[68:71], v[130:133], v[138:141], 0
 s_nop 0
 v_add_f32_dpp v62, v62, v62 row_ror:8 row_mask:0xf bank_mask:0xf
 v_mfma_f32_16x16x32_bf16 v[68:71], v[148:151], v[142:145], v[68:71]
 v_mov_b32 v63, v62
 s_cmp_lt_i32 s55, 0
 s_cbranch_scc1 fl_61
fl_62:
 v_mfma_f32_16x16x32_bf16 v[72:75], v[134:137], v[138:141], 0
 v_permlane32_swap_b32 v62, v63
 v_mfma_f32_16x16x32_bf16 v[72:75], v[150:153], v[142:145], v[72:75]
 v_add_f32 v62, v62, v63
 v_mov_b32 v63, v62
 ds_write_b128 v11, v[64:67] offset:0
 s_nop 0
 v_permlane16_swap_b32 v62, v63
 v_add_f32 v62, v62, v63
 v_rcp_f32 v62, v62
 ds_write_b128 v11, v[68:71] offset:1024
 s_mov_b64 exec, 0xff
 ds_write_b32 v22, v62
 s_mov_b64 exec, -1
 ds_write_b128 v11, v[72:75] offset:2048
 s_waitcnt lgkmcnt(0)
 s_barrier
 ds_read_b128 v[72:75], v23
 ds_read_b64 v[64:65], v12 offset:0
 ds_read_b64 v[66:67], v12 offset:3072
 ds_read_b64 v[68:69], v12 offset:6144
 ds_read_b64 v[70:71], v12 offset:9216
 s_waitcnt lgkmcnt(2)
 v_pk_mul_f32 v[64:65], v[64:65], v[72:73] op_sel_hi:[1,0]
 v_pk_fma_f32 v[64:65], v[66:67], v[72:73], v[64:65] op_sel:[0,1,0] op_sel_hi:[1,1,1]
 s_waitcnt lgkmcnt(0)
 v_pk_fma_f32 v[64:65], v[68:69], v[74:75], v[64:65] op_sel_hi:[1,0,1]
 v_pk_fma_f32 v[64:65], v[70:71], v[74:75], v[64:65] op_sel:[0,1,0] op_sel_hi:[1,1,1]
 v_cvt_pk_f16_f32 v68, v64, v65
 v_perm_b32 v68, s91, v68, v14
 buffer_atomic_pk_add_f16 v68, v13, s[4:7], s3 offen
 s_mov_b64 exec, s[62:63]
 buffer_store_dwordx4 v[118:121], v18, s[24:27], s85 offen sc1
 buffer_store_dwordx2 v[122:123], v19, s[24:27], s85 offen sc1
 s_mov_b64 exec, -1
 v_mov_b32 v76, v108
 v_mov_b32 v77, v109
 v_mov_b32 v78, v110
 v_mov_b32 v79, v111
 v_permlane32_swap_b32 v100, v104
 v_permlane32_swap_b32 v101, v105
 v_permlane32_swap_b32 v102, v106
 v_permlane32_swap_b32 v103, v107
 v_permlane32_swap_b32 v108, v76
 v_permlane32_swap_b32 v109, v77
 v_permlane32_swap_b32 v110, v78
 v_permlane32_swap_b32 v111, v79
 v_pk_add_f32 v[100:101], v[100:101], v[104:105]
 v_pk_add_f32 v[102:103], v[102:103], v[106:107]
 v_pk_add_f32 v[108:109], v[108:109], v[76:77]
 v_pk_add_f32 v[110:111], v[110:111], v[78:79]
 v_cvt_pk_bf16_f32 v80, v100, v101
 v_cvt_pk_bf16_f32 v82, v108, v109
 v_cvt_pk_bf16_f32 v81, v102, v103
 v_cvt_pk_bf16_f32 v83, v110, v111
 s_nop 0
 v_permlane16_swap_b32 v80, v82
 v_permlane16_swap_b32 v81, v83
 v_min_u32 v80, -2, v80
 s_mov_b64 exec, s[76:77]
 buffer_store_dwordx4 v[80:83], v15, s[24:27], s57 offen sc1
 s_mov_b64 exec, -1
 s_add_u32 s64, s64, 1310720
 s_add_u32 s52, s52, 1
 s_branch step_50
fl_55:
 buffer_load_dword v0, off, s[12:15], s79 sc1
 s_branch fl_56
A1_15:
 v_smfmac_f32_16x16x32_f16 v[40:43], v[36:37], a[16:19], v25
 v_smfmac_f32_16x16x32_f16 v[52:55], v[36:37], a[76:79], v25
 v_smfmac_f32_16x16x32_f16 v[44:47], v[36:37], a[36:39], v25
 v_smfmac_f32_16x16x32_f16 v[56:59], v[36:37], a[96:99], v25
 s_branch A2_54
pm_53:
 buffer_load_dwordx4 v[36:39], v4, s[4:7], s84 offen offset:2048 sc1
 buffer_load_dwordx4 v[28:31], v4, s[4:7], s84 offen offset:0 sc1
 buffer_load_dwordx4 v[32:35], v4, s[4:7], s84 offen offset:1024 sc1
 s_nop 7
 v_mov_b32 v40, 0
 v_mov_b32 v41, 0
 v_mov_b32 v42, 0
 v_mov_b32 v43, 0
 v_mov_b32 v52, 0
 v_mov_b32 v53, 0
 v_mov_b32 v54, 0
 v_mov_b32 v55, 0
 v_mov_b32 v44, 0
 v_mov_b32 v45, 0
 v_mov_b32 v46, 0
 v_mov_b32 v47, 0
 v_mov_b32 v56, 0
 v_mov_b32 v57, 0
 v_mov_b32 v58, 0
 v_mov_b32 v59, 0
 s_waitcnt vmcnt(0)
 v_bitop3_b32 v27, v31, v35, v39 bitop3:0x80
 v_perm_b32 v31, v35, v31, s89
 v_cmp_gt_u32 vcc, 0x48000000, v27
 v_mov_b32 v35, v38
 s_cbranch_vccz A1_15
pm_52:
 s_cmp_gt_u32 s52, 3
 s_cbranch_scc1 op_63
 v_readfirstlane_b32 s21, v0
 s_cmp_ge_u32 s21, s46
 s_cbranch_scc1 op_63
 buffer_load_dword v0, off, s[12:15], s79 sc1
 s_waitcnt vmcnt(0)
 v_readfirstlane_b32 s21, v0
 s_cmp_gt_u32 s21, s52
 s_cselect_b32 s21, s87, 0
 s_cmp_eq_u32 s21, 0
 s_cbranch_scc1 op_63
 s_mov_b32 s87, 0
 s_sub_u32 s21, s64, 1310720
 buffer_load_dwordx4 v[126:129], v16, s[28:31], s21 offen offset:0 sc1
 buffer_load_dwordx4 v[130:133], v16, s[28:31], s21 offen offset:1024 sc1
 buffer_load_dwordx4 v[134:137], v16, s[28:31], s21 offen offset:2048 sc1
op_63:
 buffer_load_dwordx4 v[36:39], v4, s[4:7], s84 offen offset:2048 sc1
 buffer_load_dwordx4 v[28:31], v4, s[4:7], s84 offen offset:0 sc1
 buffer_load_dwordx4 v[32:35], v4, s[4:7], s84 offen offset:1024 sc1
 s_add_u32 s54, s54, 1
 s_cmp_gt_u32 s54, 131072
 s_cbranch_scc1 end0
 s_waitcnt vmcnt(0)
 v_bitop3_b32 v27, v31, v35, v39 bitop3:0x80
 v_perm_b32 v31, v35, v31, s89
 v_cmp_gt_u32 vcc, 0x48000000, v27
 v_mov_b32 v35, v38
 s_cbranch_vccnz pm_52
 s_branch A1_15
psr_57:
 buffer_load_dwordx2 v[58:59], v9, s[8:11], s81 offen sc1
 buffer_load_dwordx4 v[40:43], v8, s[8:11], s81 offen offset:0 sc1
 buffer_load_dwordx4 v[44:47], v8, s[8:11], s81 offen offset:1024 sc1
 s_add_u32 s54, s54, 1
 s_cmp_gt_u32 s54, 131072
 s_cbranch_scc1 end0
 s_waitcnt vmcnt(2)
 v_xor_b32 v76, s88, v58
 s_nop 0
 v_permlane16_swap_b32 v58, v59
 v_fma_mix_f32 v60, v58, 1.0, v59 op_sel:[0,0,0] op_sel_hi:[1,0,1]
 v_fma_mix_f32 v61, v58, 1.0, v59 op_sel:[1,0,1] op_sel_hi:[1,0,1]
 v_mov_b32 v58, v60
 v_mov_b32 v59, v61
 s_nop 0
 v_permlane32_swap_b32 v58, v60
 v_permlane32_swap_b32 v59, v61
 v_add_f32 v52, v58, v60
 v_add_f32 v53, v59, v61
 v_max_f32 v79, v52, v53
 s_waitcnt vmcnt(0)
 v_pk_add_f16 v80, v40, v44
 v_pk_add_f16 v82, v42, v46
 v_pk_add_f16 v81, v41, v45
 v_pk_add_f16 v83, v43, v47
 v_permlane32_swap_b32 v80, v82
 v_bitop3_b32 v77, v40, v42, s88 bitop3:0x7e
 v_permlane32_swap_b32 v81, v83
 v_bitop3_b32 v78, v44, v46, s88 bitop3:0x7e
 v_fma_mix_f32 v48, v80, 1.0, v82 op_sel:[0,0,0] op_sel_hi:[1,0,1]
 v_or3_b32 v27, v76, v77, v78
 v_fma_mix_f32 v49, v80, 1.0, v82 op_sel:[1,0,1] op_sel_hi:[1,0,1]
 v_and_b32 v27, 1, v27
 v_fma_mix_f32 v50, v81, 1.0, v83 op_sel:[0,0,0] op_sel_hi:[1,0,1]
 v_cmp_ne_u32 vcc, 0, v27
 v_fma_mix_f32 v51, v81, 1.0, v83 op_sel:[1,0,1] op_sel_hi:[1,0,1]
 v_max3_f32 v62, v48, v49, v79
 s_cbranch_vccnz psr_57
 s_branch psj_58
kvw_59:
 s_mov_b32 s22, s87
 s_cmp_eq_u32 s52, 0
 s_cselect_b32 s55, 0, s55
 s_cselect_b32 s87, 1, 0
 s_cbranch_scc1 kvok_60
 v_mov_b32 v62, 0
 s_mov_b32 s101, 0
wf_64:
 buffer_load_dword v63, v62, s[12:15], s79 offen sc1
 s_add_u32 s101, s101, 1
 s_cmp_gt_u32 s101, 131072
 s_cbranch_scc1 end0
 s_waitcnt vmcnt(0)
 v_readfirstlane_b32 s100, v63
 s_cmp_ge_u32 s100, s46
 s_cbranch_scc1 wf_65
 s_sleep 3
 s_branch wf_64
wf_65:
 s_cmp_eq_u32 s22, 0
 s_cbranch_scc1 kvok_60
 s_sub_u32 s21, s64, 1310720
 buffer_load_dwordx4 v[126:129], v16, s[28:31], s21 offen offset:0 sc1
 buffer_load_dwordx4 v[130:133], v16, s[28:31], s21 offen offset:1024 sc1
 buffer_load_dwordx4 v[134:137], v16, s[28:31], s21 offen offset:2048 sc1
 s_waitcnt vmcnt(0)
 s_branch kvok_60
fl_61:
 buffer_load_dword v0, off, s[12:15], s79 sc1
 s_branch fl_62
last_51:
 s_mov_b64 exec, s[62:63]
 buffer_store_dwordx4 v[118:121], v18, s[24:27], s85 offen sc1
 buffer_store_dwordx2 v[122:123], v19, s[24:27], s85 offen sc1
 s_mov_b64 exec, -1
 s_waitcnt lgkmcnt(10)
 v_smfmac_f32_16x16x64_f16 v[100:103], v[28:31], a[120:127], v25
 v_smfmac_f32_16x16x64_f16 v[104:107], v[28:31], a[128:135], v25
 v_smfmac_f32_16x16x64_f16 v[108:111], v[28:31], a[136:143], v25
 v_smfmac_f32_16x16x64_f16 v[100:103], v[32:35], a[144:151], v25
 v_smfmac_f32_16x16x64_f16 v[104:107], v[32:35], a[152:159], v25
 v_smfmac_f32_16x16x64_f16 v[108:111], v[32:35], a[160:167], v25
 s_waitcnt lgkmcnt(7)
 v_smfmac_f32_16x16x64_f16 v[100:103], v[64:67], a[168:175], v25
 v_smfmac_f32_16x16x64_f16 v[104:107], v[64:67], a[176:183], v25
 v_smfmac_f32_16x16x64_f16 v[108:111], v[64:67], a[184:191], v25
 v_smfmac_f32_16x16x64_f16 v[100:103], v[68:71], a[192:199], v25
 v_smfmac_f32_16x16x64_f16 v[104:107], v[68:71], a[200:207], v25
 v_smfmac_f32_16x16x64_f16 v[108:111], v[68:71], a[208:215], v25
 v_smfmac_f32_16x16x64_f16 v[100:103], v[72:75], a[216:223], v25
 v_smfmac_f32_16x16x64_f16 v[104:107], v[72:75], a[224:231], v25
 v_smfmac_f32_16x16x64_f16 v[108:111], v[72:75], a[232:239], v25
 s_waitcnt lgkmcnt(4)
 v_smfmac_f32_16x16x64_f16 v[100:103], v[76:79], a[240:247], v25
 v_smfmac_f32_16x16x64_f16 v[104:107], v[76:79], a[248:255], v25
 v_smfmac_f32_16x16x64_f16 v[108:111], v[76:79], v[152:159], v25
 v_smfmac_f32_16x16x64_f16 v[100:103], v[80:83], v[160:167], v25
 v_smfmac_f32_16x16x64_f16 v[104:107], v[80:83], v[168:175], v25
 v_smfmac_f32_16x16x64_f16 v[108:111], v[80:83], v[176:183], v25
 v_smfmac_f32_16x16x64_f16 v[100:103], v[84:87], v[184:191], v25
 v_smfmac_f32_16x16x64_f16 v[104:107], v[84:87], v[192:199], v25
 v_smfmac_f32_16x16x64_f16 v[108:111], v[84:87], v[200:207], v25
 s_waitcnt lgkmcnt(0)
 v_smfmac_f32_16x16x64_f16 v[100:103], v[88:91], v[208:215], v25
 v_smfmac_f32_16x16x64_f16 v[104:107], v[88:91], v[216:223], v25
 v_smfmac_f32_16x16x64_f16 v[108:111], v[88:91], v[224:231], v25
 v_smfmac_f32_16x16x64_f16 v[100:103], v[92:95], v[232:239], v25
 v_smfmac_f32_16x16x64_f16 v[104:107], v[92:95], v[240:247], v25
 v_smfmac_f32_16x16x64_f16 v[108:111], v[92:95], v[248:255], v25
 s_nop 7
 v_mov_b32 v76, v108
 v_mov_b32 v77, v109
 v_mov_b32 v78, v110
 v_mov_b32 v79, v111
 v_permlane32_swap_b32 v100, v104
 v_permlane32_swap_b32 v101, v105
 v_permlane32_swap_b32 v102, v106
 v_permlane32_swap_b32 v103, v107
 v_permlane32_swap_b32 v108, v76
 v_permlane32_swap_b32 v109, v77
 v_permlane32_swap_b32 v110, v78
 v_permlane32_swap_b32 v111, v79
 v_pk_add_f32 v[100:101], v[100:101], v[104:105]
 v_pk_add_f32 v[102:103], v[102:103], v[106:107]
 v_pk_add_f32 v[108:109], v[108:109], v[76:77]
 v_pk_add_f32 v[110:111], v[110:111], v[78:79]
 v_cvt_pk_bf16_f32 v80, v100, v101
 v_cvt_pk_bf16_f32 v82, v108, v109
 v_cvt_pk_bf16_f32 v81, v102, v103
 v_cvt_pk_bf16_f32 v83, v110, v111
 s_nop 0
 v_permlane16_swap_b32 v80, v82
 v_permlane16_swap_b32 v81, v83
 v_min_u32 v80, -2, v80
 s_mov_b64 exec, s[76:77]
 buffer_store_dwordx4 v[80:83], v15, s[24:27], s57 offen sc1
 s_mov_b64 exec, -1
 s_branch chain_done
step_66:
 s_and_b32 s21, s52, 3
 s_mul_i32 s81, s21, 540672
 s_lshl_b32 s84, s21, 15
 s_add_u32 s21, s52, 3
 s_and_b32 s21, s21, 3
 s_lshl_b32 s83, s21, 15
 s_add_u32 s21, s52, 1
 s_and_b32 s22, s21, 3
 s_lshl_b32 s3, s22, 15
 s_mul_i32 s80, s21, 393216
 s_add_u32 s46, s21, 1
 s_min_u32 s46, s46, 64
 s_mul_i32 s85, s52, 98304
 s_mul_i32 s57, s52, 327680
 s_add_u32 s57, s57, 51380224
 s_bfe_u32 s88, s52, 0x10002
 s_max_u32 s67, s52, 1
 s_sub_u32 s67, s67, 1
 v_mov_b32 v40, 0
 v_mov_b32 v41, 0
 v_mov_b32 v42, 0
 v_mov_b32 v43, 0
 v_mov_b32 v44, 0
 v_mov_b32 v45, 0
 v_mov_b32 v46, 0
 v_mov_b32 v47, 0
 v_mov_b32 v48, 0
 v_mov_b32 v49, 0
 v_mov_b32 v50, 0
 v_mov_b32 v51, 0
 v_mov_b32 v52, 0
 v_mov_b32 v53, 0
 v_mov_b32 v54, 0
 v_mov_b32 v55, 0
 v_mov_b32 v56, 0
 v_mov_b32 v57, 0
 v_mov_b32 v58, 0
 v_mov_b32 v59, 0
 v_mov_b32 v60, 0
 v_mov_b32 v61, 0
 v_mov_b32 v62, 0
 v_mov_b32 v63, 0
 v_mov_b32 v100, 0
 v_mov_b32 v101, 0
 v_mov_b32 v102, 0
 v_mov_b32 v103, 0
 v_mov_b32 v104, 0
 v_mov_b32 v105, 0
 v_mov_b32 v106, 0
 v_mov_b32 v107, 0
 v_mov_b32 v108, 0
 v_mov_b32 v109, 0
 v_mov_b32 v110, 0
 v_mov_b32 v111, 0
 s_sleep 6
 v_readfirstlane_b32 s21, v0
 s_cmp_lt_u32 s21, s46
 s_cselect_b32 s55, s55, 0
 s_cmp_lt_i32 s55, 0
 s_cbranch_scc1 fl_71
fl_72:
 s_mov_b32 s54, 0
 buffer_load_dwordx4 v[36:39], v4, s[4:7], s84 offen offset:2048 sc1
 buffer_load_dwordx4 v[28:31], v4, s[4:7], s84 offen offset:0 sc1
 buffer_load_dwordx4 v[32:35], v4, s[4:7], s84 offen offset:1024 sc1
 s_waitcnt vmcnt(3)
 v_mov_b32 v126, v88
 v_mov_b32 v127, v89
 v_mov_b32 v128, v90
 v_mov_b32 v129, v91
 v_mov_b32 v130, v92
 v_mov_b32 v131, v93
 v_mov_b32 v132, v94
 v_mov_b32 v133, v95
 v_mov_b32 v134, v96
 v_mov_b32 v135, v97
 v_mov_b32 v136, v98
 v_mov_b32 v137, v99
 s_waitcnt vmcnt(2)
 v_smfmac_f32_16x16x32_f16 v[40:43], v[36:37], a[16:19], v25
 v_smfmac_f32_16x16x32_f16 v[52:55], v[36:37], a[76:79], v25
 v_smfmac_f32_16x16x32_f16 v[44:47], v[36:37], a[36:39], v25
 s_waitcnt vmcnt(0)
 v_bitop3_b32 v27, v31, v35, v39 bitop3:0x80
 v_perm_b32 v31, v35, v31, s89
 v_cmp_gt_u32 vcc, 0x48000000, v27
 v_mov_b32 v35, v38
 v_smfmac_f32_16x16x32_f16 v[56:59], v[36:37], a[96:99], v25
 s_cbranch_vccnz pm_69
A2_70:
 v_smfmac_f32_16x16x64_f16 v[40:43], v[28:31], a[0:7], v25
 ds_write_b128 v10, v[28:31]
 v_smfmac_f32_16x16x64_f16 v[40:43], v[32:35], a[8:15], v25
 ds_write_b128 v10, v[32:35] offset:1024
 v_smfmac_f32_16x16x64_f16 v[52:55], v[28:31], a[60:67], v25
 ds_write_b64 v10, v[36:37] offset:2048
 v_smfmac_f32_16x16x64_f16 v[52:55], v[32:35], a[68:75], v25
 v_cvt_pk_f16_f32 v40, v40, v41
 v_cvt_pk_f16_f32 v41, v42, v43
 v_smfmac_f32_16x16x32_f16 v[48:51], v[36:37], a[56:59], v25
 v_smfmac_f32_16x16x32_f16 v[60:63], v[36:37], a[116:119], v25
 v_smfmac_f32_16x16x64_f16 v[44:47], v[28:31], a[20:27], v25
 v_cvt_pk_f16_f32 v52, v52, v53
 v_cvt_pk_f16_f32 v53, v54, v55
 s_nop 0
 v_smfmac_f32_16x16x64_f16 v[44:47], v[32:35], a[28:35], v25
 v_permlane32_swap_b32 v40, v52
 v_smfmac_f32_16x16x64_f16 v[56:59], v[28:31], a[80:87], v25
 v_permlane32_swap_b32 v41, v53
 v_pk_add_f16 v40, v40, v52
 v_smfmac_f32_16x16x64_f16 v[56:59], v[32:35], a[88:95], v25
 v_pk_add_f16 v41, v41, v53
 v_smfmac_f32_16x16x64_f16 v[48:51], v[28:31], a[40:47], v25
 ds_write_b64 v5, v[40:41] offset:0
 v_smfmac_f32_16x16x64_f16 v[48:51], v[32:35], a[48:55], v25
 v_cvt_pk_f16_f32 v44, v44, v45
 v_cvt_pk_f16_f32 v45, v46, v47
 v_cvt_pk_f16_f32 v56, v56, v57
 v_smfmac_f32_16x16x64_f16 v[60:63], v[28:31], a[100:107], v25
 v_cvt_pk_f16_f32 v57, v58, v59
 s_nop 0
 v_smfmac_f32_16x16x64_f16 v[60:63], v[32:35], a[108:115], v25
 v_permlane32_swap_b32 v44, v56
 v_permlane32_swap_b32 v45, v57
 v_pk_add_f16 v44, v44, v56
 v_pk_add_f16 v45, v45, v57
 ds_write_b64 v5, v[44:45] offset:640
 v_cvt_pk_f16_f32 v48, v48, v49
 v_cvt_pk_f16_f32 v49, v50, v51
 v_cvt_pk_f16_f32 v60, v60, v61
 v_cvt_pk_f16_f32 v61, v62, v63
 s_nop 0
 v_permlane32_swap_b32 v48, v60
 v_permlane32_swap_b32 v49, v61
 v_pk_add_f16 v48, v48, v60
 v_pk_add_f16 v49, v49, v61
 ds_write_b64 v5, v[48:49] offset:1280
 s_waitcnt lgkmcnt(0) vmcnt(0)
 s_barrier
 ds_read_b128 v[28:31], v16 offset:24576
 ds_read_b128 v[32:35], v16 offset:25600
 ds_read_b128 v[64:67], v16 offset:27648
 ds_read_b128 v[68:71], v16 offset:28672
 ds_read_b128 v[72:75], v16 offset:30720
 ds_read_b128 v[76:79], v16 offset:31744
 ds_read_b128 v[80:83], v16 offset:33792
 ds_read_b128 v[84:87], v16 offset:34816
 ds_read_b64 v[88:89], v16 offset:26624
 ds_read_b64 v[90:91], v16 offset:29696
 ds_read_b64 v[92:93], v16 offset:32768
 ds_read_b64 v[94:95], v16 offset:35840
 s_cmp_eq_u32 s52, 63
 s_cbranch_scc1 last_67
 s_waitcnt lgkmcnt(10)
 v_smfmac_f32_16x16x64_f16 v[100:103], v[28:31], a[120:127], v25
 v_smfmac_f32_16x16x64_f16 v[104:107], v[28:31], a[128:135], v25
 v_smfmac_f32_16x16x64_f16 v[108:111], v[28:31], a[136:143], v25
 s_mov_b32 s54, 0
 v_smfmac_f32_16x16x64_f16 v[100:103], v[32:35], a[144:151], v25
 v_readfirstlane_b32 s21, v0
 v_smfmac_f32_16x16x64_f16 v[104:107], v[32:35], a[152:159], v25
 s_add_u32 s22, s46, 3
 v_smfmac_f32_16x16x64_f16 v[108:111], v[32:35], a[160:167], v25
 s_min_u32 s22, s22, 64
 s_waitcnt lgkmcnt(7)
 v_smfmac_f32_16x16x64_f16 v[100:103], v[64:67], a[168:175], v25
 s_sub_u32 s55, s21, s22
 v_smfmac_f32_16x16x64_f16 v[104:107], v[64:67], a[176:183], v25
 s_sub_u32 s56, s21, s46
 v_smfmac_f32_16x16x64_f16 v[108:111], v[64:67], a[184:191], v25
 v_smfmac_f32_16x16x64_f16 v[100:103], v[68:71], a[192:199], v25
 v_smfmac_f32_16x16x64_f16 v[104:107], v[68:71], a[200:207], v25
 v_smfmac_f32_16x16x64_f16 v[108:111], v[68:71], a[208:215], v25
 v_smfmac_f32_16x16x64_f16 v[100:103], v[72:75], a[216:223], v25
 v_smfmac_f32_16x16x64_f16 v[104:107], v[72:75], a[224:231], v25
 v_smfmac_f32_16x16x64_f16 v[108:111], v[72:75], a[232:239], v25
 s_waitcnt lgkmcnt(4)
 v_smfmac_f32_16x16x64_f16 v[100:103], v[76:79], a[240:247], v25
 v_smfmac_f32_16x16x64_f16 v[104:107], v[76:79], a[248:255], v25
 v_smfmac_f32_16x16x64_f16 v[108:111], v[76:79], v[152:159], v25
 v_smfmac_f32_16x16x64_f16 v[100:103], v[80:83], v[160:167], v25
 v_smfmac_f32_16x16x64_f16 v[104:107], v[80:83], v[168:175], v25
 v_smfmac_f32_16x16x64_f16 v[108:111], v[80:83], v[176:183], v25
 v_smfmac_f32_16x16x64_f16 v[100:103], v[84:87], v[184:191], v25
 v_smfmac_f32_16x16x64_f16 v[104:107], v[84:87], v[192:199], v25
 v_smfmac_f32_16x16x64_f16 v[108:111], v[84:87], v[200:207], v25
 s_waitcnt lgkmcnt(0)
 v_smfmac_f32_16x16x64_f16 v[100:103], v[88:91], v[208:215], v25
 v_smfmac_f32_16x16x64_f16 v[104:107], v[88:91], v[216:223], v25
 v_smfmac_f32_16x16x64_f16 v[108:111], v[88:91], v[224:231], v25
 v_smfmac_f32_16x16x64_f16 v[100:103], v[92:95], v[232:239], v25
 v_smfmac_f32_16x16x64_f16 v[104:107], v[92:95], v[240:247], v25
 v_smfmac_f32_16x16x64_f16 v[108:111], v[92:95], v[248:255], v25
 s_sleep 2
 buffer_load_dwordx2 v[58:59], v9, s[8:11], s81 offen sc1
 buffer_load_dwordx4 v[40:43], v8, s[8:11], s81 offen offset:0 sc1
 buffer_load_dwordx4 v[44:47], v8, s[8:11], s81 offen offset:1024 sc1
 s_cmp_lt_i32 s56, 0
 s_cbranch_scc1 kvw_75
kvok_76:
 s_waitcnt vmcnt(2)
 v_xor_b32 v76, s88, v58
 s_nop 0
 v_permlane16_swap_b32 v58, v59
 v_fma_mix_f32 v60, v58, 1.0, v59 op_sel:[0,0,0] op_sel_hi:[1,0,1]
 v_fma_mix_f32 v61, v58, 1.0, v59 op_sel:[1,0,1] op_sel_hi:[1,0,1]
 v_mov_b32 v58, v60
 v_mov_b32 v59, v61
 s_nop 0
 v_permlane32_swap_b32 v58, v60
 v_permlane32_swap_b32 v59, v61
 v_add_f32 v52, v58, v60
 v_add_f32 v53, v59, v61
 v_max_f32 v79, v52, v53
 s_waitcnt vmcnt(0)
 v_pk_add_f16 v80, v40, v44
 v_pk_add_f16 v82, v42, v46
 v_pk_add_f16 v81, v41, v45
 v_pk_add_f16 v83, v43, v47
 v_permlane32_swap_b32 v80, v82
 v_bitop3_b32 v77, v40, v42, s88 bitop3:0x7e
 v_permlane32_swap_b32 v81, v83
 v_bitop3_b32 v78, v44, v46, s88 bitop3:0x7e
 v_fma_mix_f32 v48, v80, 1.0, v82 op_sel:[0,0,0] op_sel_hi:[1,0,1]
 v_or3_b32 v27, v76, v77, v78
 v_fma_mix_f32 v49, v80, 1.0, v82 op_sel:[1,0,1] op_sel_hi:[1,0,1]
 v_and_b32 v27, 1, v27
 v_fma_mix_f32 v50, v81, 1.0, v83 op_sel:[0,0,0] op_sel_hi:[1,0,1]
 v_cmp_ne_u32 vcc, 0, v27
 v_fma_mix_f32 v51, v81, 1.0, v83 op_sel:[1,0,1] op_sel_hi:[1,0,1]
 v_max3_f32 v62, v48, v49, v79
 s_cbranch_vccnz psr_73
psj_74:
 v_max3_f32 v62, v62, v50, v51
 v_cvt_pk_bf16_f32 v146, v100, v101
 v_cvt_pk_bf16_f32 v147, v102, v103
 v_max_f32_dpp v62, v62, v62 row_ror:8 row_mask:0xf bank_mask:0xf
 v_mov_b32 v63, v62
 v_cvt_pk_bf16_f32 v148, v104, v105
 v_cvt_pk_bf16_f32 v149, v106, v107
 v_permlane32_swap_b32 v62, v63
 v_max_f32 v62, v62, v63
 v_mov_b32 v63, v62
 v_cvt_pk_bf16_f32 v150, v108, v109
 v_cvt_pk_bf16_f32 v151, v110, v111
 v_permlane16_swap_b32 v62, v63
 v_max_f32 v62, v62, v63
 v_mul_f32 v62, s86, v62
 v_fma_f32 v48, v48, s86, -v62
 v_fma_f32 v49, v49, s86, -v62
 v_fma_f32 v50, v50, s86, -v62
 v_fma_f32 v51, v51, s86, -v62
 v_fma_f32 v52, v52, s86, -v62
 v_fma_f32 v53, v53, s86, -v62
 v_exp_f32 v48, v48
 v_exp_f32 v49, v49
 buffer_load_dwordx4 v[88:91], v17, s[28:31], s64 offen offset:0 sc1
 v_exp_f32 v50, v50
 v_exp_f32 v51, v51
 buffer_load_dwordx4 v[92:95], v16, s[28:31], s64 offen offset:1024 sc1
 v_exp_f32 v52, v52
 v_exp_f32 v53, v53
 buffer_load_dwordx4 v[96:99], v20, s[28:31], s64 offen offset:2048 sc1
 v_cvt_pk_bf16_f32 v138, v48, v49
 v_cvt_pk_bf16_f32 v139, v50, v51
 v_cvt_pk_bf16_f32 v142, v52, v53
 v_mov_b32_dpp v140, v138 row_ror:8 row_mask:0xf bank_mask:0xf
 v_mov_b32_dpp v141, v139 row_ror:8 row_mask:0xf bank_mask:0xf
 v_mov_b32_dpp v143, v142 row_ror:8 row_mask:0xf bank_mask:0xf
 v_mov_b32 v84, s67
 v_mov_b32 v85, s67
 s_mov_b64 exec, 15
 buffer_store_dwordx2 v[84:85], v24, s[12:15], s66 offen sc1
 s_mov_b64 exec, -1
 v_add_f32 v54, v48, v49
 v_mfma_f32_16x16x32_bf16 v[64:67], v[126:129], v[138:141], 0
 v_add_f32 v55, v50, v51
 v_add_f32 v56, v52, v53
 v_mfma_f32_16x16x32_bf16 v[64:67], v[146:149], v[142:145], v[64:67]
 v_add_f32 v62, v54, v55
 v_fmac_f32 v62, v56, v26
 v_mfma_f32_16x16x32_bf16 v[68:71], v[130:133], v[138:141], 0
 s_nop 0
 v_add_f32_dpp v62, v62, v62 row_ror:8 row_mask:0xf bank_mask:0xf
 v_mfma_f32_16x16x32_bf16 v[68:71], v[148:151], v[142:145], v[68:71]
 v_mov_b32 v63, v62
 s_cmp_lt_i32 s55, 0
 s_cbranch_scc1 fl_77
fl_78:
 v_mfma_f32_16x16x32_bf16 v[72:75], v[134:137], v[138:141], 0
 v_permlane32_swap_b32 v62, v63
 v_mfma_f32_16x16x32_bf16 v[72:75], v[150:153], v[142:145], v[72:75]
 v_add_f32 v62, v62, v63
 v_mov_b32 v63, v62
 ds_write_b128 v11, v[64:67] offset:0
 s_nop 0
 v_permlane16_swap_b32 v62, v63
 v_add_f32 v62, v62, v63
 v_rcp_f32 v62, v62
 ds_write_b128 v11, v[68:71] offset:1024
 s_mov_b64 exec, 0xff
 ds_write_b32 v22, v62
 s_mov_b64 exec, -1
 ds_write_b128 v11, v[72:75] offset:2048
 s_waitcnt lgkmcnt(0)
 s_barrier
 s_and_b32 s21, s52, 7
 s_cmp_lg_u32 s21, s50
 s_cbranch_scc1 zm_79
 v_mov_b32 v64, 0
 v_mov_b32 v65, 0
 v_mov_b32 v66, 0
 v_mov_b32 v67, 0
 s_mov_b64 exec, s[70:71]
 buffer_store_dwordx4 v[64:67], v13, s[4:7], s83 offen sc1
 s_mov_b64 exec, -1
zm_79:
 v_mov_b32 v76, v108
 v_mov_b32 v77, v109
 v_mov_b32 v78, v110
 v_mov_b32 v79, v111
 v_permlane32_swap_b32 v100, v104
 v_permlane32_swap_b32 v101, v105
 v_permlane32_swap_b32 v102, v106
 v_permlane32_swap_b32 v103, v107
 v_permlane32_swap_b32 v108, v76
 v_permlane32_swap_b32 v109, v77
 v_permlane32_swap_b32 v110, v78
 v_permlane32_swap_b32 v111, v79
 v_pk_add_f32 v[100:101], v[100:101], v[104:105]
 v_pk_add_f32 v[102:103], v[102:103], v[106:107]
 v_pk_add_f32 v[108:109], v[108:109], v[76:77]
 v_pk_add_f32 v[110:111], v[110:111], v[78:79]
 v_cvt_pk_bf16_f32 v80, v100, v101
 v_cvt_pk_bf16_f32 v82, v108, v109
 v_cvt_pk_bf16_f32 v81, v102, v103
 v_cvt_pk_bf16_f32 v83, v110, v111
 s_nop 0
 v_permlane16_swap_b32 v80, v82
 v_permlane16_swap_b32 v81, v83
 v_min_u32 v80, -2, v80
 s_mov_b64 exec, s[76:77]
 buffer_store_dwordx4 v[80:83], v15, s[24:27], s57 offen sc1
 s_mov_b64 exec, -1
 s_add_u32 s64, s64, 1310720
 s_add_u32 s52, s52, 1
 s_branch step_66
fl_71:
 buffer_load_dword v0, off, s[12:15], s79 sc1
 s_branch fl_72
A1_16:
 v_smfmac_f32_16x16x32_f16 v[40:43], v[36:37], a[16:19], v25
 v_smfmac_f32_16x16x32_f16 v[52:55], v[36:37], a[76:79], v25
 v_smfmac_f32_16x16x32_f16 v[44:47], v[36:37], a[36:39], v25
 v_smfmac_f32_16x16x32_f16 v[56:59], v[36:37], a[96:99], v25
 s_branch A2_70
pm_69:
 buffer_load_dwordx4 v[36:39], v4, s[4:7], s84 offen offset:2048 sc1
 buffer_load_dwordx4 v[28:31], v4, s[4:7], s84 offen offset:0 sc1
 buffer_load_dwordx4 v[32:35], v4, s[4:7], s84 offen offset:1024 sc1
 s_nop 7
 v_mov_b32 v40, 0
 v_mov_b32 v41, 0
 v_mov_b32 v42, 0
 v_mov_b32 v43, 0
 v_mov_b32 v52, 0
 v_mov_b32 v53, 0
 v_mov_b32 v54, 0
 v_mov_b32 v55, 0
 v_mov_b32 v44, 0
 v_mov_b32 v45, 0
 v_mov_b32 v46, 0
 v_mov_b32 v47, 0
 v_mov_b32 v56, 0
 v_mov_b32 v57, 0
 v_mov_b32 v58, 0
 v_mov_b32 v59, 0
 s_waitcnt vmcnt(0)
 v_bitop3_b32 v27, v31, v35, v39 bitop3:0x80
 v_perm_b32 v31, v35, v31, s89
 v_cmp_gt_u32 vcc, 0x48000000, v27
 v_mov_b32 v35, v38
 s_cbranch_vccz A1_16
pm_68:
 s_cmp_gt_u32 s52, 3
 s_cbranch_scc1 op_80
 v_readfirstlane_b32 s21, v0
 s_cmp_ge_u32 s21, s46
 s_cbranch_scc1 op_80
 buffer_load_dword v0, off, s[12:15], s79 sc1
 s_waitcnt vmcnt(0)
 v_readfirstlane_b32 s21, v0
 s_cmp_gt_u32 s21, s52
 s_cselect_b32 s21, s87, 0
 s_cmp_eq_u32 s21, 0
 s_cbranch_scc1 op_80
 s_mov_b32 s87, 0
 s_sub_u32 s21, s64, 1310720
 buffer_load_dwordx4 v[126:129], v16, s[28:31], s21 offen offset:0 sc1
 buffer_load_dwordx4 v[130:133], v16, s[28:31], s21 offen offset:1024 sc1
 buffer_load_dwordx4 v[134:137], v16, s[28:31], s21 offen offset:2048 sc1
op_80:
 buffer_load_dwordx4 v[36:39], v4, s[4:7], s84 offen offset:2048 sc1
 buffer_load_dwordx4 v[28:31], v4, s[4:7], s84 offen offset:0 sc1
 buffer_load_dwordx4 v[32:35], v4, s[4:7], s84 offen offset:1024 sc1
 s_add_u32 s54, s54, 1
 s_cmp_gt_u32 s54, 131072
 s_cbranch_scc1 end0
 s_waitcnt vmcnt(0)
 v_bitop3_b32 v27, v31, v35, v39 bitop3:0x80
 v_perm_b32 v31, v35, v31, s89
 v_cmp_gt_u32 vcc, 0x48000000, v27
 v_mov_b32 v35, v38
 s_cbranch_vccnz pm_68
 s_branch A1_16
psr_73:
 buffer_load_dwordx2 v[58:59], v9, s[8:11], s81 offen sc1
 buffer_load_dwordx4 v[40:43], v8, s[8:11], s81 offen offset:0 sc1
 buffer_load_dwordx4 v[44:47], v8, s[8:11], s81 offen offset:1024 sc1
 s_add_u32 s54, s54, 1
 s_cmp_gt_u32 s54, 131072
 s_cbranch_scc1 end0
 s_waitcnt vmcnt(2)
 v_xor_b32 v76, s88, v58
 s_nop 0
 v_permlane16_swap_b32 v58, v59
 v_fma_mix_f32 v60, v58, 1.0, v59 op_sel:[0,0,0] op_sel_hi:[1,0,1]
 v_fma_mix_f32 v61, v58, 1.0, v59 op_sel:[1,0,1] op_sel_hi:[1,0,1]
 v_mov_b32 v58, v60
 v_mov_b32 v59, v61
 s_nop 0
 v_permlane32_swap_b32 v58, v60
 v_permlane32_swap_b32 v59, v61
 v_add_f32 v52, v58, v60
 v_add_f32 v53, v59, v61
 v_max_f32 v79, v52, v53
 s_waitcnt vmcnt(0)
 v_pk_add_f16 v80, v40, v44
 v_pk_add_f16 v82, v42, v46
 v_pk_add_f16 v81, v41, v45
 v_pk_add_f16 v83, v43, v47
 v_permlane32_swap_b32 v80, v82
 v_bitop3_b32 v77, v40, v42, s88 bitop3:0x7e
 v_permlane32_swap_b32 v81, v83
 v_bitop3_b32 v78, v44, v46, s88 bitop3:0x7e
 v_fma_mix_f32 v48, v80, 1.0, v82 op_sel:[0,0,0] op_sel_hi:[1,0,1]
 v_or3_b32 v27, v76, v77, v78
 v_fma_mix_f32 v49, v80, 1.0, v82 op_sel:[1,0,1] op_sel_hi:[1,0,1]
 v_and_b32 v27, 1, v27
 v_fma_mix_f32 v50, v81, 1.0, v83 op_sel:[0,0,0] op_sel_hi:[1,0,1]
 v_cmp_ne_u32 vcc, 0, v27
 v_fma_mix_f32 v51, v81, 1.0, v83 op_sel:[1,0,1] op_sel_hi:[1,0,1]
 v_max3_f32 v62, v48, v49, v79
 s_cbranch_vccnz psr_73
 s_branch psj_74
kvw_75:
 s_mov_b32 s22, s87
 s_cmp_eq_u32 s52, 0
 s_cselect_b32 s55, 0, s55
 s_cselect_b32 s87, 1, 0
 s_cbranch_scc1 kvok_76
 v_mov_b32 v62, 0
 s_mov_b32 s101, 0
wf_81:
 buffer_load_dword v63, v62, s[12:15], s79 offen sc1
 s_add_u32 s101, s101, 1
 s_cmp_gt_u32 s101, 131072
 s_cbranch_scc1 end0
 s_waitcnt vmcnt(0)
 v_readfirstlane_b32 s100, v63
 s_cmp_ge_u32 s100, s46
 s_cbranch_scc1 wf_82
 s_sleep 3
 s_branch wf_81
wf_82:
 s_cmp_eq_u32 s22, 0
 s_cbranch_scc1 kvok_76
 s_sub_u32 s21, s64, 1310720
 buffer_load_dwordx4 v[126:129], v16, s[28:31], s21 offen offset:0 sc1
 buffer_load_dwordx4 v[130:133], v16, s[28:31], s21 offen offset:1024 sc1
 buffer_load_dwordx4 v[134:137], v16, s[28:31], s21 offen offset:2048 sc1
 s_waitcnt vmcnt(0)
 s_branch kvok_76
fl_77:
 buffer_load_dword v0, off, s[12:15], s79 sc1
 s_branch fl_78
last_67:
 s_waitcnt lgkmcnt(10)
 v_smfmac_f32_16x16x64_f16 v[100:103], v[28:31], a[120:127], v25
 v_smfmac_f32_16x16x64_f16 v[104:107], v[28:31], a[128:135], v25
 v_smfmac_f32_16x16x64_f16 v[108:111], v[28:31], a[136:143], v25
 v_smfmac_f32_16x16x64_f16 v[100:103], v[32:35], a[144:151], v25
 v_smfmac_f32_16x16x64_f16 v[104:107], v[32:35], a[152:159], v25
 v_smfmac_f32_16x16x64_f16 v[108:111], v[32:35], a[160:167], v25
 s_waitcnt lgkmcnt(7)
 v_smfmac_f32_16x16x64_f16 v[100:103], v[64:67], a[168:175], v25
 v_smfmac_f32_16x16x64_f16 v[104:107], v[64:67], a[176:183], v25
 v_smfmac_f32_16x16x64_f16 v[108:111], v[64:67], a[184:191], v25
 v_smfmac_f32_16x16x64_f16 v[100:103], v[68:71], a[192:199], v25
 v_smfmac_f32_16x16x64_f16 v[104:107], v[68:71], a[200:207], v25
 v_smfmac_f32_16x16x64_f16 v[108:111], v[68:71], a[208:215], v25
 v_smfmac_f32_16x16x64_f16 v[100:103], v[72:75], a[216:223], v25
 v_smfmac_f32_16x16x64_f16 v[104:107], v[72:75], a[224:231], v25
 v_smfmac_f32_16x16x64_f16 v[108:111], v[72:75], a[232:239], v25
 s_waitcnt lgkmcnt(4)
 v_smfmac_f32_16x16x64_f16 v[100:103], v[76:79], a[240:247], v25
 v_smfmac_f32_16x16x64_f16 v[104:107], v[76:79], a[248:255], v25
 v_smfmac_f32_16x16x64_f16 v[108:111], v[76:79], v[152:159], v25
 v_smfmac_f32_16x16x64_f16 v[100:103], v[80:83], v[160:167], v25
 v_smfmac_f32_16x16x64_f16 v[104:107], v[80:83], v[168:175], v25
 v_smfmac_f32_16x16x64_f16 v[108:111], v[80:83], v[176:183], v25
 v_smfmac_f32_16x16x64_f16 v[100:103], v[84:87], v[184:191], v25
 v_smfmac_f32_16x16x64_f16 v[104:107], v[84:87], v[192:199], v25
 v_smfmac_f32_16x16x64_f16 v[108:111], v[84:87], v[200:207], v25
 s_waitcnt lgkmcnt(0)
 v_smfmac_f32_16x16x64_f16 v[100:103], v[88:91], v[208:215], v25
 v_smfmac_f32_16x16x64_f16 v[104:107], v[88:91], v[216:223], v25
 v_smfmac_f32_16x16x64_f16 v[108:111], v[88:91], v[224:231], v25
 v_smfmac_f32_16x16x64_f16 v[100:103], v[92:95], v[232:239], v25
 v_smfmac_f32_16x16x64_f16 v[104:107], v[92:95], v[240:247], v25
 v_smfmac_f32_16x16x64_f16 v[108:111], v[92:95], v[248:255], v25
 s_nop 7
 v_mov_b32 v76, v108
 v_mov_b32 v77, v109
 v_mov_b32 v78, v110
 v_mov_b32 v79, v111
 v_permlane32_swap_b32 v100, v104
 v_permlane32_swap_b32 v101, v105
 v_permlane32_swap_b32 v102, v106
 v_permlane32_swap_b32 v103, v107
 v_permlane32_swap_b32 v108, v76
 v_permlane32_swap_b32 v109, v77
 v_permlane32_swap_b32 v110, v78
 v_permlane32_swap_b32 v111, v79
 v_pk_add_f32 v[100:101], v[100:101], v[104:105]
 v_pk_add_f32 v[102:103], v[102:103], v[106:107]
 v_pk_add_f32 v[108:109], v[108:109], v[76:77]
 v_pk_add_f32 v[110:111], v[110:111], v[78:79]
 v_cvt_pk_bf16_f32 v80, v100, v101
 v_cvt_pk_bf16_f32 v82, v108, v109
 v_cvt_pk_bf16_f32 v81, v102, v103
 v_cvt_pk_bf16_f32 v83, v110, v111
 s_nop 0
 v_permlane16_swap_b32 v80, v82
 v_permlane16_swap_b32 v81, v83
 v_min_u32 v80, -2, v80
 s_mov_b64 exec, s[76:77]
 buffer_store_dwordx4 v[80:83], v15, s[24:27], s57 offen sc1
 s_mov_b64 exec, -1
 s_branch chain_done
step_83:
 s_and_b32 s21, s52, 3
 s_mul_i32 s81, s21, 540672
 s_lshl_b32 s84, s21, 15
 s_add_u32 s21, s52, 3
 s_and_b32 s21, s21, 3
 s_lshl_b32 s83, s21, 15
 s_add_u32 s21, s52, 1
 s_and_b32 s22, s21, 3
 s_lshl_b32 s3, s22, 15
 s_mul_i32 s80, s21, 393216
 s_add_u32 s46, s21, 1
 s_min_u32 s46, s46, 64
 s_mul_i32 s85, s52, 98304
 s_mul_i32 s57, s52, 327680
 s_add_u32 s57, s57, 51380224
 s_bfe_u32 s88, s52, 0x10002
 s_max_u32 s67, s52, 1
 s_sub_u32 s67, s67, 1
 v_mov_b32 v40, 0
 v_mov_b32 v41, 0
 v_mov_b32 v42, 0
 v_mov_b32 v43, 0
 v_mov_b32 v44, 0
 v_mov_b32 v45, 0
 v_mov_b32 v46, 0
 v_mov_b32 v47, 0
 v_mov_b32 v48, 0
 v_mov_b32 v49, 0
 v_mov_b32 v50, 0
 v_mov_b32 v51, 0
 v_mov_b32 v52, 0
 v_mov_b32 v53, 0
 v_mov_b32 v54, 0
 v_mov_b32 v55, 0
 v_mov_b32 v56, 0
 v_mov_b32 v57, 0
 v_mov_b32 v58, 0
 v_mov_b32 v59, 0
 v_mov_b32 v60, 0
 v_mov_b32 v61, 0
 v_mov_b32 v62, 0
 v_mov_b32 v63, 0
 v_mov_b32 v100, 0
 v_mov_b32 v101, 0
 v_mov_b32 v102, 0
 v_mov_b32 v103, 0
 v_mov_b32 v104, 0
 v_mov_b32 v105, 0
 v_mov_b32 v106, 0
 v_mov_b32 v107, 0
 v_mov_b32 v108, 0
 v_mov_b32 v109, 0
 v_mov_b32 v110, 0
 v_mov_b32 v111, 0
 s_sleep 8
 v_readfirstlane_b32 s21, v0
 s_cmp_lt_u32 s21, s46
 s_cselect_b32 s55, s55, 0
 s_cmp_lt_i32 s55, 0
 s_cbranch_scc1 fl_88
fl_89:
 s_mov_b32 s54, 0
 buffer_load_dwordx4 v[36:39], v4, s[4:7], s84 offen offset:2048 sc1
 buffer_load_dwordx4 v[28:31], v4, s[4:7], s84 offen offset:0 sc1
 buffer_load_dwordx4 v[32:35], v4, s[4:7], s84 offen offset:1024 sc1
 s_waitcnt vmcnt(3)
 v_mov_b32 v126, v88
 v_mov_b32 v127, v89
 v_mov_b32 v128, v90
 v_mov_b32 v129, v91
 v_mov_b32 v130, v92
 v_mov_b32 v131, v93
 v_mov_b32 v132, v94
 v_mov_b32 v133, v95
 v_mov_b32 v134, v96
 v_mov_b32 v135, v97
 v_mov_b32 v136, v98
 v_mov_b32 v137, v99
 s_waitcnt vmcnt(2)
 v_smfmac_f32_16x16x32_f16 v[40:43], v[36:37], a[16:19], v25
 v_smfmac_f32_16x16x32_f16 v[52:55], v[36:37], a[76:79], v25
 v_smfmac_f32_16x16x32_f16 v[44:47], v[36:37], a[36:39], v25
 s_waitcnt vmcnt(0)
 v_bitop3_b32 v27, v31, v35, v39 bitop3:0x80
 v_perm_b32 v31, v35, v31, s89
 v_cmp_gt_u32 vcc, 0x48000000, v27
 v_mov_b32 v35, v38
 v_smfmac_f32_16x16x32_f16 v[56:59], v[36:37], a[96:99], v25
 s_cbranch_vccnz pm_86
A2_87:
 v_smfmac_f32_16x16x64_f16 v[40:43], v[28:31], a[0:7], v25
 ds_write_b128 v10, v[28:31]
 v_smfmac_f32_16x16x64_f16 v[40:43], v[32:35], a[8:15], v25
 ds_write_b128 v10, v[32:35] offset:1024
 v_smfmac_f32_16x16x64_f16 v[52:55], v[28:31], a[60:67], v25
 ds_write_b64 v10, v[36:37] offset:2048
 v_smfmac_f32_16x16x64_f16 v[52:55], v[32:35], a[68:75], v25
 v_cvt_pk_f16_f32 v40, v40, v41
 v_cvt_pk_f16_f32 v41, v42, v43
 v_smfmac_f32_16x16x32_f16 v[48:51], v[36:37], a[56:59], v25
 v_smfmac_f32_16x16x32_f16 v[60:63], v[36:37], a[116:119], v25
 v_smfmac_f32_16x16x64_f16 v[44:47], v[28:31], a[20:27], v25
 v_cvt_pk_f16_f32 v52, v52, v53
 v_cvt_pk_f16_f32 v53, v54, v55
 s_nop 0
 v_smfmac_f32_16x16x64_f16 v[44:47], v[32:35], a[28:35], v25
 v_permlane32_swap_b32 v40, v52
 v_smfmac_f32_16x16x64_f16 v[56:59], v[28:31], a[80:87], v25
 v_permlane32_swap_b32 v41, v53
 v_pk_add_f16 v40, v40, v52
 v_smfmac_f32_16x16x64_f16 v[56:59], v[32:35], a[88:95], v25
 v_pk_add_f16 v41, v41, v53
 v_smfmac_f32_16x16x64_f16 v[48:51], v[28:31], a[40:47], v25
 ds_write_b64 v5, v[40:41] offset:0
 v_smfmac_f32_16x16x64_f16 v[48:51], v[32:35], a[48:55], v25
 v_cvt_pk_f16_f32 v44, v44, v45
 v_cvt_pk_f16_f32 v45, v46, v47
 v_cvt_pk_f16_f32 v56, v56, v57
 v_smfmac_f32_16x16x64_f16 v[60:63], v[28:31], a[100:107], v25
 v_cvt_pk_f16_f32 v57, v58, v59
 s_nop 0
 v_smfmac_f32_16x16x64_f16 v[60:63], v[32:35], a[108:115], v25
 v_permlane32_swap_b32 v44, v56
 v_permlane32_swap_b32 v45, v57
 v_pk_add_f16 v44, v44, v56
 v_pk_add_f16 v45, v45, v57
 ds_write_b64 v5, v[44:45] offset:640
 v_cvt_pk_f16_f32 v48, v48, v49
 v_cvt_pk_f16_f32 v49, v50, v51
 v_cvt_pk_f16_f32 v60, v60, v61
 v_cvt_pk_f16_f32 v61, v62, v63
 s_nop 0
 v_permlane32_swap_b32 v48, v60
 v_permlane32_swap_b32 v49, v61
 v_pk_add_f16 v48, v48, v60
 v_pk_add_f16 v49, v49, v61
 ds_write_b64 v5, v[48:49] offset:1280
 s_waitcnt lgkmcnt(0) vmcnt(0)
 s_barrier
 s_lshr_b32 s21, 3, s20
 s_bitcmp1_b32 s21, 0
 s_cbranch_scc0 bw_91
 ds_read_b64_tr_b16 v[40:41], v21 offset:0
 ds_read_b64_tr_b16 v[42:43], v21 offset:1920
 ds_read_b64_tr_b16 v[44:45], v21 offset:640
 ds_read_b64_tr_b16 v[46:47], v21 offset:2560
 ds_read_b64_tr_b16 v[48:49], v21 offset:1280
 ds_read_b64_tr_b16 v[50:51], v21 offset:3200
 s_waitcnt lgkmcnt(4)
 v_fma_mix_f32 v52, v40, 1.0, v42 op_sel:[0,0,0] op_sel_hi:[1,0,1]
 v_fma_mix_f32 v53, v40, 1.0, v42 op_sel:[1,0,1] op_sel_hi:[1,0,1]
 v_fma_mix_f32 v54, v41, 1.0, v43 op_sel:[0,0,0] op_sel_hi:[1,0,1]
 v_fma_mix_f32 v55, v41, 1.0, v43 op_sel:[1,0,1] op_sel_hi:[1,0,1]
 v_add_f32_dpp v56, v52, v52 row_ror:8 row_mask:0xf bank_mask:0xf
 v_add_f32_dpp v57, v53, v53 row_ror:8 row_mask:0xf bank_mask:0xf
 v_add_f32_dpp v58, v54, v54 row_ror:8 row_mask:0xf bank_mask:0xf
 v_add_f32_dpp v59, v55, v55 row_ror:8 row_mask:0xf bank_mask:0xf
 v_cvt_pk_bf16_f32 v118, v56, v57
 v_cvt_pk_bf16_f32 v119, v58, v59
 s_waitcnt lgkmcnt(2)
 v_fma_mix_f32 v52, v44, 1.0, v46 op_sel:[0,0,0] op_sel_hi:[1,0,1]
 v_fma_mix_f32 v53, v44, 1.0, v46 op_sel:[1,0,1] op_sel_hi:[1,0,1]
 v_fma_mix_f32 v54, v45, 1.0, v47 op_sel:[0,0,0] op_sel_hi:[1,0,1]
 v_fma_mix_f32 v55, v45, 1.0, v47 op_sel:[1,0,1] op_sel_hi:[1,0,1]
 v_add_f32_dpp v56, v52, v52 row_ror:8 row_mask:0xf bank_mask:0xf
 v_add_f32_dpp v57, v53, v53 row_ror:8 row_mask:0xf bank_mask:0xf
 v_add_f32_dpp v58, v54, v54 row_ror:8 row_mask:0xf bank_mask:0xf
 v_add_f32_dpp v59, v55, v55 row_ror:8 row_mask:0xf bank_mask:0xf
 v_cvt_pk_bf16_f32 v120, v56, v57
 v_cvt_pk_bf16_f32 v121, v58, v59
 s_waitcnt lgkmcnt(0)
 v_fma_mix_f32 v52, v48, 1.0, v50 op_sel:[0,0,0] op_sel_hi:[1,0,1]
 v_fma_mix_f32 v53, v48, 1.0, v50 op_sel:[1,0,1] op_sel_hi:[1,0,1]
 v_fma_mix_f32 v54, v49, 1.0, v51 op_sel:[0,0,0] op_sel_hi:[1,0,1]
 v_fma_mix_f32 v55, v49, 1.0, v51 op_sel:[1,0,1] op_sel_hi:[1,0,1]
 v_mfma_f32_16x16x32_bf16 v[40:43], v[112:115], v[118:121], 0
 v_add_f32_dpp v56, v52, v52 row_ror:8 row_mask:0xf bank_mask:0xf
 v_add_f32_dpp v57, v53, v53 row_ror:8 row_mask:0xf bank_mask:0xf
 v_add_f32_dpp v58, v54, v54 row_ror:8 row_mask:0xf bank_mask:0xf
 v_add_f32_dpp v59, v55, v55 row_ror:8 row_mask:0xf bank_mask:0xf
 v_cvt_pk_bf16_f32 v122, v56, v57
 v_cvt_pk_bf16_f32 v123, v58, v59
 s_nop 1
 v_mfma_f32_16x16x32_bf16 v[40:43], v[116:119], v[122:125], v[40:43]
 ds_read_b128 v[28:31], v16 offset:24576
 ds_read_b128 v[32:35], v16 offset:25600
 ds_read_b128 v[64:67], v16 offset:27648
 ds_read_b128 v[68:71], v16 offset:28672
 ds_read_b128 v[72:75], v16 offset:30720
 ds_read_b128 v[76:79], v16 offset:31744
 s_nop 0
 s_mov_b64 exec, s[74:75]
 v_cvt_pk_f16_f32 v44, v40, v41
 v_cvt_pk_f16_f32 v45, v42, v43
 v_and_or_b32 v44, v44, -2, s88
 s_cmp_eq_u32 s53, 1
 s_cbranch_scc1 si_92
 buffer_store_dwordx2 v[44:45], v7, s[8:11], s81 offen sc1
 s_branch si_93
si_92:
 buffer_store_dwordx2 v[44:45], v7, s[8:11], s81 offen
si_93:
 s_mov_b64 exec, -1
 s_branch bw_90
bw_91:
 s_lshr_b32 s21, 4, s20
 s_bitcmp1_b32 s21, 0
 s_cbranch_scc0 bw_94
 ds_read_b64_tr_b16 v[40:41], v6 offset:0
 ds_read_b64_tr_b16 v[42:43], v6 offset:1920
 ds_read_b64_tr_b16 v[44:45], v6 offset:3840
 ds_read_b64_tr_b16 v[46:47], v6 offset:5760
 ds_read_b64_tr_b16 v[48:49], v6 offset:640
 ds_read_b64_tr_b16 v[50:51], v6 offset:2560
 ds_read_b64_tr_b16 v[52:53], v6 offset:4480
 ds_read_b64_tr_b16 v[54:55], v6 offset:6400
 ds_read_b64_tr_b16 v[56:57], v6 offset:1280
 ds_read_b64_tr_b16 v[58:59], v6 offset:3200
 ds_read_b64_tr_b16 v[60:61], v6 offset:5120
 ds_read_b64_tr_b16 v[62:63], v6 offset:7040
 s_waitcnt lgkmcnt(8)
 v_pk_add_f16 v40, v40, v42
 v_pk_add_f16 v44, v44, v46
 v_pk_add_f16 v41, v41, v43
 v_pk_add_f16 v45, v45, v47
 v_fma_mix_f32 v146, v40, 1.0, v44 op_sel:[0,0,0] op_sel_hi:[1,0,1]
 v_fma_mix_f32 v147, v40, 1.0, v44 op_sel:[1,0,1] op_sel_hi:[1,0,1]
 v_fma_mix_f32 v148, v41, 1.0, v45 op_sel:[0,0,0] op_sel_hi:[1,0,1]
 v_fma_mix_f32 v149, v41, 1.0, v45 op_sel:[1,0,1] op_sel_hi:[1,0,1]
 v_cvt_pk_bf16_f32 v118, v146, v147
 v_cvt_pk_bf16_f32 v119, v148, v149
 s_waitcnt lgkmcnt(4)
 v_pk_add_f16 v48, v48, v50
 v_pk_add_f16 v52, v52, v54
 v_pk_add_f16 v49, v49, v51
 v_pk_add_f16 v53, v53, v55
 v_fma_mix_f32 v146, v48, 1.0, v52 op_sel:[0,0,0] op_sel_hi:[1,0,1]
 v_fma_mix_f32 v147, v48, 1.0, v52 op_sel:[1,0,1] op_sel_hi:[1,0,1]
 v_fma_mix_f32 v148, v49, 1.0, v53 op_sel:[0,0,0] op_sel_hi:[1,0,1]
 v_fma_mix_f32 v149, v49, 1.0, v53 op_sel:[1,0,1] op_sel_hi:[1,0,1]
 v_cvt_pk_bf16_f32 v120, v146, v147
 v_cvt_pk_bf16_f32 v121, v148, v149
 s_waitcnt lgkmcnt(0)
 v_pk_add_f16 v56, v56, v58
 v_pk_add_f16 v60, v60, v62
 v_pk_add_f16 v57, v57, v59
 v_pk_add_f16 v61, v61, v63
 v_fma_mix_f32 v146, v56, 1.0, v60 op_sel:[0,0,0] op_sel_hi:[1,0,1]
 v_fma_mix_f32 v147, v56, 1.0, v60 op_sel:[1,0,1] op_sel_hi:[1,0,1]
 v_mfma_f32_16x16x32_bf16 v[40:43], v[118:121], v[118:121], 0
 v_fma_mix_f32 v148, v57, 1.0, v61 op_sel:[0,0,0] op_sel_hi:[1,0,1]
 v_fma_mix_f32 v149, v57, 1.0, v61 op_sel:[1,0,1] op_sel_hi:[1,0,1]
 v_cvt_pk_bf16_f32 v122, v146, v147
 v_cvt_pk_bf16_f32 v123, v148, v149
 s_nop 1
 v_mfma_f32_16x16x32_bf16 v[40:43], v[122:125], v[122:125], v[40:43]
 ds_read_b128 v[28:31], v16 offset:24576
 ds_read_b128 v[32:35], v16 offset:25600
 ds_read_b128 v[64:67], v16 offset:27648
 ds_read_b128 v[68:71], v16 offset:28672
 ds_read_b128 v[72:75], v16 offset:30720
 ds_read_b128 v[76:79], v16 offset:31744
 s_nop 0
 s_mov_b64 exec, s[74:75]
 v_cvt_pk_f16_f32 v44, v40, v41
 v_cvt_pk_f16_f32 v45, v42, v43
 v_and_or_b32 v44, v44, -2, s88
 s_cmp_eq_u32 s53, 1
 s_cbranch_scc1 si_95
 buffer_store_dwordx2 v[44:45], v7, s[8:11], s81 offen sc1
 s_branch si_96
si_95:
 buffer_store_dwordx2 v[44:45], v7, s[8:11], s81 offen
si_96:
 s_mov_b64 exec, -1
 s_branch bw_90
bw_94:
 s_lshr_b32 s21, 8, s20
 s_bitcmp1_b32 s21, 0
 s_cbranch_scc0 bw_97
 ds_read_b128 v[28:31], v16 offset:24576
 ds_read_b128 v[32:35], v16 offset:25600
 ds_read_b128 v[64:67], v16 offset:27648
 ds_read_b128 v[68:71], v16 offset:28672
 ds_read_b128 v[72:75], v16 offset:30720
 ds_read_b128 v[76:79], v16 offset:31744
 s_branch bw_90
bw_97:
bw_90:
 ds_read_b128 v[80:83], v16 offset:33792
 ds_read_b128 v[84:87], v16 offset:34816
 ds_read_b64 v[88:89], v16 offset:26624
 ds_read_b64 v[90:91], v16 offset:29696
 ds_read_b64 v[92:93], v16 offset:32768
 ds_read_b64 v[94:95], v16 offset:35840
 s_cmp_eq_u32 s52, 63
 s_cbranch_scc1 last_84
 s_waitcnt lgkmcnt(10)
 v_smfmac_f32_16x16x64_f16 v[100:103], v[28:31], a[120:127], v25
 v_smfmac_f32_16x16x64_f16 v[104:107], v[28:31], a[128:135], v25
 v_smfmac_f32_16x16x64_f16 v[108:111], v[28:31], a[136:143], v25
 s_mov_b32 s54, 0
 v_smfmac_f32_16x16x64_f16 v[100:103], v[32:35], a[144:151], v25
 v_readfirstlane_b32 s21, v0
 v_smfmac_f32_16x16x64_f16 v[104:107], v[32:35], a[152:159], v25
 s_add_u32 s22, s46, 3
 v_smfmac_f32_16x16x64_f16 v[108:111], v[32:35], a[160:167], v25
 s_min_u32 s22, s22, 64
 s_waitcnt lgkmcnt(7)
 v_smfmac_f32_16x16x64_f16 v[100:103], v[64:67], a[168:175], v25
 s_sub_u32 s55, s21, s22
 v_smfmac_f32_16x16x64_f16 v[104:107], v[64:67], a[176:183], v25
 s_sub_u32 s56, s21, s46
 v_smfmac_f32_16x16x64_f16 v[108:111], v[64:67], a[184:191], v25
 v_smfmac_f32_16x16x64_f16 v[100:103], v[68:71], a[192:199], v25
 v_smfmac_f32_16x16x64_f16 v[104:107], v[68:71], a[200:207], v25
 v_smfmac_f32_16x16x64_f16 v[108:111], v[68:71], a[208:215], v25
 v_smfmac_f32_16x16x64_f16 v[100:103], v[72:75], a[216:223], v25
 v_smfmac_f32_16x16x64_f16 v[104:107], v[72:75], a[224:231], v25
 v_smfmac_f32_16x16x64_f16 v[108:111], v[72:75], a[232:239], v25
 s_waitcnt lgkmcnt(4)
 v_smfmac_f32_16x16x64_f16 v[100:103], v[76:79], a[240:247], v25
 v_smfmac_f32_16x16x64_f16 v[104:107], v[76:79], a[248:255], v25
 v_smfmac_f32_16x16x64_f16 v[108:111], v[76:79], v[152:159], v25
 v_smfmac_f32_16x16x64_f16 v[100:103], v[80:83], v[160:167], v25
 v_smfmac_f32_16x16x64_f16 v[104:107], v[80:83], v[168:175], v25
 v_smfmac_f32_16x16x64_f16 v[108:111], v[80:83], v[176:183], v25
 v_smfmac_f32_16x16x64_f16 v[100:103], v[84:87], v[184:191], v25
 v_smfmac_f32_16x16x64_f16 v[104:107], v[84:87], v[192:199], v25
 v_smfmac_f32_16x16x64_f16 v[108:111], v[84:87], v[200:207], v25
 s_waitcnt lgkmcnt(0)
 v_smfmac_f32_16x16x64_f16 v[100:103], v[88:91], v[208:215], v25
 v_smfmac_f32_16x16x64_f16 v[104:107], v[88:91], v[216:223], v25
 v_smfmac_f32_16x16x64_f16 v[108:111], v[88:91], v[224:231], v25
 v_smfmac_f32_16x16x64_f16 v[100:103], v[92:95], v[232:239], v25
 v_smfmac_f32_16x16x64_f16 v[104:107], v[92:95], v[240:247], v25
 v_smfmac_f32_16x16x64_f16 v[108:111], v[92:95], v[248:255], v25
 buffer_load_dwordx2 v[58:59], v9, s[8:11], s81 offen sc1
 buffer_load_dwordx4 v[40:43], v8, s[8:11], s81 offen offset:0 sc1
 buffer_load_dwordx4 v[44:47], v8, s[8:11], s81 offen offset:1024 sc1
 s_cmp_lt_i32 s56, 0
 s_cbranch_scc1 kvw_100
kvok_101:
 s_waitcnt vmcnt(2)
 v_xor_b32 v76, s88, v58
 s_nop 0
 v_permlane16_swap_b32 v58, v59
 v_fma_mix_f32 v60, v58, 1.0, v59 op_sel:[0,0,0] op_sel_hi:[1,0,1]
 v_fma_mix_f32 v61, v58, 1.0, v59 op_sel:[1,0,1] op_sel_hi:[1,0,1]
 v_mov_b32 v58, v60
 v_mov_b32 v59, v61
 s_nop 0
 v_permlane32_swap_b32 v58, v60
 v_permlane32_swap_b32 v59, v61
 v_add_f32 v52, v58, v60
 v_add_f32 v53, v59, v61
 v_max_f32 v79, v52, v53
 s_waitcnt vmcnt(0)
 v_pk_add_f16 v80, v40, v44
 v_pk_add_f16 v82, v42, v46
 v_pk_add_f16 v81, v41, v45
 v_pk_add_f16 v83, v43, v47
 v_permlane32_swap_b32 v80, v82
 v_bitop3_b32 v77, v40, v42, s88 bitop3:0x7e
 v_permlane32_swap_b32 v81, v83
 v_bitop3_b32 v78, v44, v46, s88 bitop3:0x7e
 v_fma_mix_f32 v48, v80, 1.0, v82 op_sel:[0,0,0] op_sel_hi:[1,0,1]
 v_or3_b32 v27, v76, v77, v78
 v_fma_mix_f32 v49, v80, 1.0, v82 op_sel:[1,0,1] op_sel_hi:[1,0,1]
 v_and_b32 v27, 1, v27
 v_fma_mix_f32 v50, v81, 1.0, v83 op_sel:[0,0,0] op_sel_hi:[1,0,1]
 v_cmp_ne_u32 vcc, 0, v27
 v_fma_mix_f32 v51, v81, 1.0, v83 op_sel:[1,0,1] op_sel_hi:[1,0,1]
 v_max3_f32 v62, v48, v49, v79
 s_cbranch_vccnz psr_98
psj_99:
 v_max3_f32 v62, v62, v50, v51
 v_cvt_pk_bf16_f32 v146, v100, v101
 v_cvt_pk_bf16_f32 v147, v102, v103
 v_max_f32_dpp v62, v62, v62 row_ror:8 row_mask:0xf bank_mask:0xf
 v_mov_b32 v63, v62
 v_cvt_pk_bf16_f32 v148, v104, v105
 v_cvt_pk_bf16_f32 v149, v106, v107
 v_permlane32_swap_b32 v62, v63
 v_max_f32 v62, v62, v63
 v_mov_b32 v63, v62
 v_cvt_pk_bf16_f32 v150, v108, v109
 v_cvt_pk_bf16_f32 v151, v110, v111
 v_permlane16_swap_b32 v62, v63
 v_max_f32 v62, v62, v63
 v_mul_f32 v62, s86, v62
 v_fma_f32 v48, v48, s86, -v62
 v_fma_f32 v49, v49, s86, -v62
 v_fma_f32 v50, v50, s86, -v62
 v_fma_f32 v51, v51, s86, -v62
 v_fma_f32 v52, v52, s86, -v62
 v_fma_f32 v53, v53, s86, -v62
 v_exp_f32 v48, v48
 v_exp_f32 v49, v49
 buffer_load_dwordx4 v[88:91], v17, s[28:31], s64 offen offset:0 sc1
 v_exp_f32 v50, v50
 v_exp_f32 v51, v51
 buffer_load_dwordx4 v[92:95], v16, s[28:31], s64 offen offset:1024 sc1
 v_exp_f32 v52, v52
 v_exp_f32 v53, v53
 buffer_load_dwordx4 v[96:99], v20, s[28:31], s64 offen offset:2048 sc1
 v_cvt_pk_bf16_f32 v138, v48, v49
 v_cvt_pk_bf16_f32 v139, v50, v51
 v_cvt_pk_bf16_f32 v142, v52, v53
 v_mov_b32_dpp v140, v138 row_ror:8 row_mask:0xf bank_mask:0xf
 v_mov_b32_dpp v141, v139 row_ror:8 row_mask:0xf bank_mask:0xf
 v_mov_b32_dpp v143, v142 row_ror:8 row_mask:0xf bank_mask:0xf
 s_lshr_b32 s21, 3, s20
 s_bitcmp1_b32 s21, 0
 s_cbranch_scc0 bw_103
 buffer_load_dwordx4 v[112:115], v18, s[16:19], s80 offen sc1
 s_branch bw_102
bw_103:
 s_lshr_b32 s21, 8, s20
 s_bitcmp1_b32 s21, 0
 s_cbranch_scc0 bw_104
 v_mov_b32 v84, s67
 v_mov_b32 v85, s67
 s_mov_b64 exec, 15
 buffer_store_dwordx2 v[84:85], v24, s[12:15], s66 offen sc1
 s_mov_b64 exec, -1
 s_branch bw_102
bw_104:
bw_102:
 v_add_f32 v54, v48, v49
 v_mfma_f32_16x16x32_bf16 v[64:67], v[126:129], v[138:141], 0
 v_add_f32 v55, v50, v51
 v_add_f32 v56, v52, v53
 v_mfma_f32_16x16x32_bf16 v[64:67], v[146:149], v[142:145], v[64:67]
 v_add_f32 v62, v54, v55
 v_fmac_f32 v62, v56, v26
 v_mfma_f32_16x16x32_bf16 v[68:71], v[130:133], v[138:141], 0
 s_lshr_b32 s21, 3, s20
 s_bitcmp1_b32 s21, 0
 s_cbranch_scc0 bw_106
 buffer_load_dwordx2 v[116:117], v19, s[16:19], s80 offen sc1
 s_branch bw_105
bw_106:
bw_105:
 v_add_f32_dpp v62, v62, v62 row_ror:8 row_mask:0xf bank_mask:0xf
 v_mfma_f32_16x16x32_bf16 v[68:71], v[148:151], v[142:145], v[68:71]
 v_mov_b32 v63, v62
 s_cmp_lt_i32 s55, 0
 s_cbranch_scc1 fl_107
fl_108:
 v_mfma_f32_16x16x32_bf16 v[72:75], v[134:137], v[138:141], 0
 v_permlane32_swap_b32 v62, v63
 v_mfma_f32_16x16x32_bf16 v[72:75], v[150:153], v[142:145], v[72:75]
 v_add_f32 v62, v62, v63
 v_mov_b32 v63, v62
 ds_write_b128 v11, v[64:67] offset:0
 s_nop 0
 v_permlane16_swap_b32 v62, v63
 v_add_f32 v62, v62, v63
 v_rcp_f32 v62, v62
 ds_write_b128 v11, v[68:71] offset:1024
 s_mov_b64 exec, 0xff
 ds_write_b32 v22, v62
 s_mov_b64 exec, -1
 ds_write_b128 v11, v[72:75] offset:2048
 s_waitcnt lgkmcnt(0)
 s_barrier
 s_lshr_b32 s21, 7, s20
 s_bitcmp1_b32 s21, 0
 s_cbranch_scc0 bw_110
 ds_read_b128 v[72:75], v23
 ds_read_b64 v[64:65], v12 offset:0
 ds_read_b64 v[66:67], v12 offset:3072
 ds_read_b64 v[68:69], v12 offset:6144
 ds_read_b64 v[70:71], v12 offset:9216
 s_waitcnt lgkmcnt(2)
 v_pk_mul_f32 v[64:65], v[64:65], v[72:73] op_sel_hi:[1,0]
 v_pk_fma_f32 v[64:65], v[66:67], v[72:73], v[64:65] op_sel:[0,1,0] op_sel_hi:[1,1,1]
 s_waitcnt lgkmcnt(0)
 v_pk_fma_f32 v[64:65], v[68:69], v[74:75], v[64:65] op_sel_hi:[1,0,1]
 v_pk_fma_f32 v[64:65], v[70:71], v[74:75], v[64:65] op_sel:[0,1,0] op_sel_hi:[1,1,1]
 v_cvt_pk_f16_f32 v68, v64, v65
 v_perm_b32 v68, s91, v68, v14
 buffer_atomic_pk_add_f16 v68, v13, s[4:7], s3 offen
 s_branch bw_109
bw_110:
 s_lshr_b32 s21, 8, s20
 s_bitcmp1_b32 s21, 0
 s_cbranch_scc0 bw_111
 s_and_b32 s21, s52, 7
 s_cmp_lg_u32 s21, s50
 s_cbranch_scc1 zm_112
 v_mov_b32 v64, 0
 v_mov_b32 v65, 0
 v_mov_b32 v66, 0
 v_mov_b32 v67, 0
 s_mov_b64 exec, s[70:71]
 buffer_store_dwordx4 v[64:67], v13, s[4:7], s83 offen sc1
 s_mov_b64 exec, -1
zm_112:
 s_branch bw_109
bw_111:
bw_109:
 s_lshr_b32 s21, 4, s20
 s_bitcmp1_b32 s21, 0
 s_cbranch_scc0 bw_114
 s_mov_b64 exec, s[62:63]
 buffer_store_dwordx4 v[118:121], v18, s[24:27], s85 offen sc1
 buffer_store_dwordx2 v[122:123], v19, s[24:27], s85 offen sc1
 s_mov_b64 exec, -1
 s_branch bw_113
bw_114:
bw_113:
 v_mov_b32 v76, v108
 v_mov_b32 v77, v109
 v_mov_b32 v78, v110
 v_mov_b32 v79, v111
 v_permlane32_swap_b32 v100, v104
 v_permlane32_swap_b32 v101, v105
 v_permlane32_swap_b32 v102, v106
 v_permlane32_swap_b32 v103, v107
 v_permlane32_swap_b32 v108, v76
 v_permlane32_swap_b32 v109, v77
 v_permlane32_swap_b32 v110, v78
 v_permlane32_swap_b32 v111, v79
 v_pk_add_f32 v[100:101], v[100:101], v[104:105]
 v_pk_add_f32 v[102:103], v[102:103], v[106:107]
 v_pk_add_f32 v[108:109], v[108:109], v[76:77]
 v_pk_add_f32 v[110:111], v[110:111], v[78:79]
 v_cvt_pk_bf16_f32 v80, v100, v101
 v_cvt_pk_bf16_f32 v82, v108, v109
 v_cvt_pk_bf16_f32 v81, v102, v103
 v_cvt_pk_bf16_f32 v83, v110, v111
 s_nop 0
 v_permlane16_swap_b32 v80, v82
 v_permlane16_swap_b32 v81, v83
 v_min_u32 v80, -2, v80
 s_mov_b64 exec, s[76:77]
 buffer_store_dwordx4 v[80:83], v15, s[24:27], s57 offen sc1
 s_mov_b64 exec, -1
 s_add_u32 s64, s64, 1310720
 s_add_u32 s52, s52, 1
 s_branch step_83
fl_88:
 buffer_load_dword v0, off, s[12:15], s79 sc1
 s_branch fl_89
A1_17:
 v_smfmac_f32_16x16x32_f16 v[40:43], v[36:37], a[16:19], v25
 v_smfmac_f32_16x16x32_f16 v[52:55], v[36:37], a[76:79], v25
 v_smfmac_f32_16x16x32_f16 v[44:47], v[36:37], a[36:39], v25
 v_smfmac_f32_16x16x32_f16 v[56:59], v[36:37], a[96:99], v25
 s_branch A2_87
pm_86:
 buffer_load_dwordx4 v[36:39], v4, s[4:7], s84 offen offset:2048 sc1
 buffer_load_dwordx4 v[28:31], v4, s[4:7], s84 offen offset:0 sc1
 buffer_load_dwordx4 v[32:35], v4, s[4:7], s84 offen offset:1024 sc1
 s_nop 7
 v_mov_b32 v40, 0
 v_mov_b32 v41, 0
 v_mov_b32 v42, 0
 v_mov_b32 v43, 0
 v_mov_b32 v52, 0
 v_mov_b32 v53, 0
 v_mov_b32 v54, 0
 v_mov_b32 v55, 0
 v_mov_b32 v44, 0
 v_mov_b32 v45, 0
 v_mov_b32 v46, 0
 v_mov_b32 v47, 0
 v_mov_b32 v56, 0
 v_mov_b32 v57, 0
 v_mov_b32 v58, 0
 v_mov_b32 v59, 0
 s_waitcnt vmcnt(0)
 v_bitop3_b32 v27, v31, v35, v39 bitop3:0x80
 v_perm_b32 v31, v35, v31, s89
 v_cmp_gt_u32 vcc, 0x48000000, v27
 v_mov_b32 v35, v38
 s_cbranch_vccz A1_17
pm_85:
 s_cmp_gt_u32 s52, 3
 s_cbranch_scc1 op_115
 v_readfirstlane_b32 s21, v0
 s_cmp_ge_u32 s21, s46
 s_cbranch_scc1 op_115
 buffer_load_dword v0, off, s[12:15], s79 sc1
 s_waitcnt vmcnt(0)
 v_readfirstlane_b32 s21, v0
 s_cmp_gt_u32 s21, s52
 s_cselect_b32 s21, s87, 0
 s_cmp_eq_u32 s21, 0
 s_cbranch_scc1 op_115
 s_mov_b32 s87, 0
 s_sub_u32 s21, s64, 1310720
 buffer_load_dwordx4 v[126:129], v16, s[28:31], s21 offen offset:0 sc1
 buffer_load_dwordx4 v[130:133], v16, s[28:31], s21 offen offset:1024 sc1
 buffer_load_dwordx4 v[134:137], v16, s[28:31], s21 offen offset:2048 sc1
op_115:
 buffer_load_dwordx4 v[36:39], v4, s[4:7], s84 offen offset:2048 sc1
 buffer_load_dwordx4 v[28:31], v4, s[4:7], s84 offen offset:0 sc1
 buffer_load_dwordx4 v[32:35], v4, s[4:7], s84 offen offset:1024 sc1
 s_add_u32 s54, s54, 1
 s_cmp_gt_u32 s54, 131072
 s_cbranch_scc1 end0
 s_waitcnt vmcnt(0)
 v_bitop3_b32 v27, v31, v35, v39 bitop3:0x80
 v_perm_b32 v31, v35, v31, s89
 v_cmp_gt_u32 vcc, 0x48000000, v27
 v_mov_b32 v35, v38
 s_cbranch_vccnz pm_85
 s_branch A1_17
psr_98:
 buffer_load_dwordx2 v[58:59], v9, s[8:11], s81 offen sc1
 buffer_load_dwordx4 v[40:43], v8, s[8:11], s81 offen offset:0 sc1
 buffer_load_dwordx4 v[44:47], v8, s[8:11], s81 offen offset:1024 sc1
 s_add_u32 s54, s54, 1
 s_cmp_gt_u32 s54, 131072
 s_cbranch_scc1 end0
 s_waitcnt vmcnt(2)
 v_xor_b32 v76, s88, v58
 s_nop 0
 v_permlane16_swap_b32 v58, v59
 v_fma_mix_f32 v60, v58, 1.0, v59 op_sel:[0,0,0] op_sel_hi:[1,0,1]
 v_fma_mix_f32 v61, v58, 1.0, v59 op_sel:[1,0,1] op_sel_hi:[1,0,1]
 v_mov_b32 v58, v60
 v_mov_b32 v59, v61
 s_nop 0
 v_permlane32_swap_b32 v58, v60
 v_permlane32_swap_b32 v59, v61
 v_add_f32 v52, v58, v60
 v_add_f32 v53, v59, v61
 v_max_f32 v79, v52, v53
 s_waitcnt vmcnt(0)
 v_pk_add_f16 v80, v40, v44
 v_pk_add_f16 v82, v42, v46
 v_pk_add_f16 v81, v41, v45
 v_pk_add_f16 v83, v43, v47
 v_permlane32_swap_b32 v80, v82
 v_bitop3_b32 v77, v40, v42, s88 bitop3:0x7e
 v_permlane32_swap_b32 v81, v83
 v_bitop3_b32 v78, v44, v46, s88 bitop3:0x7e
 v_fma_mix_f32 v48, v80, 1.0, v82 op_sel:[0,0,0] op_sel_hi:[1,0,1]
 v_or3_b32 v27, v76, v77, v78
 v_fma_mix_f32 v49, v80, 1.0, v82 op_sel:[1,0,1] op_sel_hi:[1,0,1]
 v_and_b32 v27, 1, v27
 v_fma_mix_f32 v50, v81, 1.0, v83 op_sel:[0,0,0] op_sel_hi:[1,0,1]
 v_cmp_ne_u32 vcc, 0, v27
 v_fma_mix_f32 v51, v81, 1.0, v83 op_sel:[1,0,1] op_sel_hi:[1,0,1]
 v_max3_f32 v62, v48, v49, v79
 s_cbranch_vccnz psr_98
 s_branch psj_99
kvw_100:
 s_mov_b32 s22, s87
 s_cmp_eq_u32 s52, 0
 s_cselect_b32 s55, 0, s55
 s_cselect_b32 s87, 1, 0
 s_cbranch_scc1 kvok_101
 v_mov_b32 v62, 0
 s_mov_b32 s101, 0
wf_116:
 buffer_load_dword v63, v62, s[12:15], s79 offen sc1
 s_add_u32 s101, s101, 1
 s_cmp_gt_u32 s101, 131072
 s_cbranch_scc1 end0
 s_waitcnt vmcnt(0)
 v_readfirstlane_b32 s100, v63
 s_cmp_ge_u32 s100, s46
 s_cbranch_scc1 wf_117
 s_sleep 3
 s_branch wf_116
wf_117:
 s_cmp_eq_u32 s22, 0
 s_cbranch_scc1 kvok_101
 s_sub_u32 s21, s64, 1310720
 buffer_load_dwordx4 v[126:129], v16, s[28:31], s21 offen offset:0 sc1
 buffer_load_dwordx4 v[130:133], v16, s[28:31], s21 offen offset:1024 sc1
 buffer_load_dwordx4 v[134:137], v16, s[28:31], s21 offen offset:2048 sc1
 s_waitcnt vmcnt(0)
 s_branch kvok_101
fl_107:
 buffer_load_dword v0, off, s[12:15], s79 sc1
 s_branch fl_108
last_84:
 s_lshr_b32 s21, 4, s20
 s_bitcmp1_b32 s21, 0
 s_cbranch_scc0 bw_119
 s_mov_b64 exec, s[62:63]
 buffer_store_dwordx4 v[118:121], v18, s[24:27], s85 offen sc1
 buffer_store_dwordx2 v[122:123], v19, s[24:27], s85 offen sc1
 s_mov_b64 exec, -1
 s_branch bw_118
bw_119:
bw_118:
 s_waitcnt lgkmcnt(10)
 v_smfmac_f32_16x16x64_f16 v[100:103], v[28:31], a[120:127], v25
 v_smfmac_f32_16x16x64_f16 v[104:107], v[28:31], a[128:135], v25
 v_smfmac_f32_16x16x64_f16 v[108:111], v[28:31], a[136:143], v25
 v_smfmac_f32_16x16x64_f16 v[100:103], v[32:35], a[144:151], v25
 v_smfmac_f32_16x16x64_f16 v[104:107], v[32:35], a[152:159], v25
 v_smfmac_f32_16x16x64_f16 v[108:111], v[32:35], a[160:167], v25
 s_waitcnt lgkmcnt(7)
 v_smfmac_f32_16x16x64_f16 v[100:103], v[64:67], a[168:175], v25
 v_smfmac_f32_16x16x64_f16 v[104:107], v[64:67], a[176:183], v25
 v_smfmac_f32_16x16x64_f16 v[108:111], v[64:67], a[184:191], v25
 v_smfmac_f32_16x16x64_f16 v[100:103], v[68:71], a[192:199], v25
 v_smfmac_f32_16x16x64_f16 v[104:107], v[68:71], a[200:207], v25
 v_smfmac_f32_16x16x64_f16 v[108:111], v[68:71], a[208:215], v25
 v_smfmac_f32_16x16x64_f16 v[100:103], v[72:75], a[216:223], v25
 v_smfmac_f32_16x16x64_f16 v[104:107], v[72:75], a[224:231], v25
 v_smfmac_f32_16x16x64_f16 v[108:111], v[72:75], a[232:239], v25
 s_waitcnt lgkmcnt(4)
 v_smfmac_f32_16x16x64_f16 v[100:103], v[76:79], a[240:247], v25
 v_smfmac_f32_16x16x64_f16 v[104:107], v[76:79], a[248:255], v25
 v_smfmac_f32_16x16x64_f16 v[108:111], v[76:79], v[152:159], v25
 v_smfmac_f32_16x16x64_f16 v[100:103], v[80:83], v[160:167], v25
 v_smfmac_f32_16x16x64_f16 v[104:107], v[80:83], v[168:175], v25
 v_smfmac_f32_16x16x64_f16 v[108:111], v[80:83], v[176:183], v25
 v_smfmac_f32_16x16x64_f16 v[100:103], v[84:87], v[184:191], v25
 v_smfmac_f32_16x16x64_f16 v[104:107], v[84:87], v[192:199], v25
 v_smfmac_f32_16x16x64_f16 v[108:111], v[84:87], v[200:207], v25
 s_waitcnt lgkmcnt(0)
 v_smfmac_f32_16x16x64_f16 v[100:103], v[88:91], v[208:215], v25
 v_smfmac_f32_16x16x64_f16 v[104:107], v[88:91], v[216:223], v25
 v_smfmac_f32_16x16x64_f16 v[108:111], v[88:91], v[224:231], v25
 v_smfmac_f32_16x16x64_f16 v[100:103], v[92:95], v[232:239], v25
 v_smfmac_f32_16x16x64_f16 v[104:107], v[92:95], v[240:247], v25
 v_smfmac_f32_16x16x64_f16 v[108:111], v[92:95], v[248:255], v25
 s_nop 7
 v_mov_b32 v76, v108
 v_mov_b32 v77, v109
 v_mov_b32 v78, v110
 v_mov_b32 v79, v111
 v_permlane32_swap_b32 v100, v104
 v_permlane32_swap_b32 v101, v105
 v_permlane32_swap_b32 v102, v106
 v_permlane32_swap_b32 v103, v107
 v_permlane32_swap_b32 v108, v76
 v_permlane32_swap_b32 v109, v77
 v_permlane32_swap_b32 v110, v78
 v_permlane32_swap_b32 v111, v79
 v_pk_add_f32 v[100:101], v[100:101], v[104:105]
 v_pk_add_f32 v[102:103], v[102:103], v[106:107]
 v_pk_add_f32 v[108:109], v[108:109], v[76:77]
 v_pk_add_f32 v[110:111], v[110:111], v[78:79]
 v_cvt_pk_bf16_f32 v80, v100, v101
 v_cvt_pk_bf16_f32 v82, v108, v109
 v_cvt_pk_bf16_f32 v81, v102, v103
 v_cvt_pk_bf16_f32 v83, v110, v111
 s_nop 0
 v_permlane16_swap_b32 v80, v82
 v_permlane16_swap_b32 v81, v83
 v_min_u32 v80, -2, v80
 s_mov_b64 exec, s[76:77]
 buffer_store_dwordx4 v[80:83], v15, s[24:27], s57 offen sc1
 s_mov_b64 exec, -1
 s_lshr_b32 s21, 1, s20
 s_bitcmp1_b32 s21, 0
 s_cbranch_scc0 bw_121
 v_mov_b32 v246, 80
 v_mov_b32 v247, 1
 s_mov_b64 exec, 1
 buffer_atomic_add v247, v246, s[32:35], 0 offen sc0 sc1
 s_mov_b64 exec, -1
 s_branch bw_120
bw_121:
bw_120:
 s_branch chain_done
chain_done:
 s_waitcnt vmcnt(0) lgkmcnt(0)
 s_barrier
 s_mov_b32 s84, 0
 s_mov_b32 s85, -1
 s_mov_b32 s86, 0
 v_mov_b32 v21, 0
 v_mov_b32 v23, v247
 s_cmp_lg_u32 s20, 0
 s_cbranch_scc1 queue_b
 s_mov_b64 exec, 1
 s_branch queue_a
end0:
 s_endpgm
gemm_side:
 s_bfe_u32 s23, s22, 0x20005
 s_add_u32 s22, s22, 31
 s_and_b32 s22, s22, 31
 s_lshl_b32 s21, s23, 3
 s_add_u32 s2, s21, s22
 s_add_u32 s3, s2, 72
 s_add_u32 s24, s2, 48
 s_add_u32 s2, s2, s21
 s_cmp_lt_u32 s22, 24
 s_cselect_b32 s3, s24, s3
 s_cmp_lt_u32 s22, 16
 s_cselect_b32 s3, s2, s3
 s_mov_b32 s2, s3
gemm_roles:
 s_cmp_ge_u32 s3, 64
 s_cbranch_scc1 not_kv
 s_load_dwordx2 s[4:5], s[0:1], 0
 s_load_dwordx2 s[6:7], s[0:1], 24
 s_load_dwordx2 s[36:37], s[0:1], 32
 s_load_dwordx2 s[38:39], s[0:1], 104
 s_and_b32 s43, s3, 1
 s_bfe_u32 s42, s3, 0x50001
 s_lshr_b32 s40, s42, 2
 s_waitcnt lgkmcnt(0)
 s_cmp_eq_u32 s43, 1
 s_cselect_b32 s6, s36, s6
 s_cselect_b32 s7, s37, s7
 s_mov_b32 s8, s4
 s_mov_b32 s9, s5
 s_mov_b32 s10, 2621440
 s_mov_b32 s11, 0x00020000
 s_mov_b32 s12, s6
 s_mov_b32 s13, s7
 s_mov_b32 s14, 7864320
 s_mov_b32 s15, 0x00020000
 s_mov_b32 s16, s38
 s_mov_b32 s17, s39
 s_mov_b32 s18, 50331648
 s_mov_b32 s19, 0x00020000
 s_mul_i32 s44, s42, 384
 s_mov_b32 s62, 1024
 s_mov_b32 s24, 0
 s_mov_b32 s25, 81920
 s_mov_b32 s64, s32
 s_mov_b32 s65, s33
 s_mov_b32 s66, s34
 s_mov_b32 s67, s35
 s_load_dwordx2 s[72:73], s[0:1], 104
 s_waitcnt lgkmcnt(0)
 s_add_u32 s72, s72, 81068032
 s_addc_u32 s73, s73, 0
 s_mov_b32 s74, 128000
 s_mov_b32 s75, 0x00020000
 v_mov_b32 v9, 2731
 v_add_u32 v8, 0, v1
 v_mul_u32_u24 v7, v8, v9
 v_lshrrev_b32 v7, 16, v7
 v_mul_u32_u24 v4, 24, v7
 v_sub_u32 v8, v8, v4
 v_and_b32 v4, 2, v7
 v_xor_b32 v8, v8, v4
 v_xor_b32 v5, 4, v8
 s_mov_b32 s21, 12288
 v_mul_lo_u32 v7, v7, s21
 v_lshl_add_u32 v40, v8, 4, v7
 v_lshl_add_u32 v43, v5, 4, v7
 v_add_u32 v8, 64, v1
 v_mul_u32_u24 v7, v8, v9
 v_lshrrev_b32 v7, 16, v7
 v_mul_u32_u24 v4, 24, v7
 v_sub_u32 v8, v8, v4
 v_and_b32 v4, 2, v7
 v_xor_b32 v8, v8, v4
 v_xor_b32 v5, 4, v8
 s_mov_b32 s21, 12288
 v_mul_lo_u32 v7, v7, s21
 v_lshl_add_u32 v41, v8, 4, v7
 v_lshl_add_u32 v44, v5, 4, v7
 v_add_u32 v8, 128, v1
 v_mul_u32_u24 v7, v8, v9
 v_lshrrev_b32 v7, 16, v7
 v_mul_u32_u24 v4, 24, v7
 v_sub_u32 v8, v8, v4
 v_and_b32 v4, 2, v7
 v_xor_b32 v8, v8, v4
 v_xor_b32 v5, 4, v8
 s_mov_b32 s21, 12288
 v_mul_lo_u32 v7, v7, s21
 v_lshl_add_u32 v42, v8, 4, v7
 v_lshl_add_u32 v45, v5, 4, v7
 s_mul_i32 s21, s20, 393216
 s_add_u32 s21, s21, 0
 s_add_u32 s21, s21, s44
 s_mul_i32 s22, s20, 12288
 s_add_u32 s22, s22, 0
 s_add_u32 m0, s22, 0
 s_nop 0
 buffer_load_dwordx4 v40, s[12:15], s21 offen lds
 s_add_u32 m0, s22, 1024
 s_nop 0
 buffer_load_dwordx4 v41, s[12:15], s21 offen lds
 s_add_u32 m0, s22, 2048
 s_nop 0
 buffer_load_dwordx4 v42, s[12:15], s21 offen lds
 s_mul_i32 s21, s20, 393216
 s_add_u32 s21, s21, 98304
 s_add_u32 s21, s21, s44
 s_mul_i32 s22, s20, 12288
 s_add_u32 s22, s22, 3072
 s_add_u32 m0, s22, 0
 s_nop 0
 buffer_load_dwordx4 v43, s[12:15], s21 offen lds
 s_add_u32 m0, s22, 1024
 s_nop 0
 buffer_load_dwordx4 v44, s[12:15], s21 offen lds
 s_add_u32 m0, s22, 2048
 s_nop 0
 buffer_load_dwordx4 v45, s[12:15], s21 offen lds
 s_mul_i32 s21, s20, 393216
 s_add_u32 s21, s21, 196608
 s_add_u32 s21, s21, s44
 s_mul_i32 s22, s20, 12288
 s_add_u32 s22, s22, 6144
 s_add_u32 m0, s22, 0
 s_nop 0
 buffer_load_dwordx4 v40, s[12:15], s21 offen lds
 s_add_u32 m0, s22, 1024
 s_nop 0
 buffer_load_dwordx4 v41, s[12:15], s21 offen lds
 s_add_u32 m0, s22, 2048
 s_nop 0
 buffer_load_dwordx4 v42, s[12:15], s21 offen lds
 s_mul_i32 s21, s20, 393216
 s_add_u32 s21, s21, 294912
 s_add_u32 s21, s21, s44
 s_mul_i32 s22, s20, 12288
 s_add_u32 s22, s22, 9216
 s_add_u32 m0, s22, 0
 s_nop 0
 buffer_load_dwordx4 v43, s[12:15], s21 offen lds
 s_add_u32 m0, s22, 1024
 s_nop 0
 buffer_load_dwordx4 v44, s[12:15], s21 offen lds
 s_add_u32 m0, s22, 2048
 s_nop 0
 buffer_load_dwordx4 v45, s[12:15], s21 offen lds
 v_lshrrev_b32 v11, 3, v1
 v_and_b32 v12, 7, v1
 v_xor_b32 v12, v12, v11
 v_mul_u32_u24 v11, 1280, v11
 v_lshl_add_u32 v10, v12, 4, v11
 s_mul_i32 s46, s20, 20480
 v_add_u32 v10, s46, v10
 s_lshl_b32 s47, s20, 11
 s_add_u32 s47, s47, 98304
 s_add_u32 s46, s47, 57344
 s_mov_b32 s30, s24
 s_add_u32 s32, s47, 0
 v_add_u32 v11, 9216, v10
 s_mov_b32 m0, s32
 s_nop 0
 buffer_load_dwordx4 v10, s[8:11], s30 offen offset:0 lds
 buffer_load_dwordx4 v11, s[8:11], s30 offen offset:1024 lds
 s_add_u32 s30, s30, 128
 s_add_u32 s32, s32, 8192
 s_cmp_lt_u32 s32, s46
 s_cselect_b32 s32, s32, s47
 s_mov_b32 m0, s32
 s_nop 0
 buffer_load_dwordx4 v10, s[8:11], s30 offen offset:0 lds
 buffer_load_dwordx4 v11, s[8:11], s30 offen offset:1024 lds
 s_add_u32 s30, s30, 128
 s_add_u32 s32, s32, 8192
 s_cmp_lt_u32 s32, s46
 s_cselect_b32 s32, s32, s47
 s_mov_b32 m0, s32
 s_nop 0
 buffer_load_dwordx4 v10, s[8:11], s30 offen offset:0 lds
 buffer_load_dwordx4 v11, s[8:11], s30 offen offset:1024 lds
 s_add_u32 s30, s30, 128
 s_add_u32 s32, s32, 8192
 s_cmp_lt_u32 s32, s46
 s_cselect_b32 s32, s32, s47
 s_mov_b32 m0, s32
 s_nop 0
 buffer_load_dwordx4 v10, s[8:11], s30 offen offset:0 lds
 buffer_load_dwordx4 v11, s[8:11], s30 offen offset:1024 lds
 s_add_u32 s30, s30, 128
 s_add_u32 s32, s32, 8192
 s_cmp_lt_u32 s32, s46
 s_cselect_b32 s32, s32, s47
 s_mov_b32 m0, s32
 s_nop 0
 buffer_load_dwordx4 v10, s[8:11], s30 offen offset:0 lds
 buffer_load_dwordx4 v11, s[8:11], s30 offen offset:1024 lds
 s_add_u32 s30, s30, 128
 s_add_u32 s32, s32, 8192
 s_cmp_lt_u32 s32, s46
 s_cselect_b32 s32, s32, s47
 s_mul_i32 s21, s20, 393216
 s_add_u32 s21, s21, 1572864
 s_add_u32 s21, s21, s44
 s_mul_i32 s22, s20, 12288
 s_add_u32 s22, s22, 49152
 s_add_u32 m0, s22, 0
 s_nop 0
 buffer_load_dwordx4 v40, s[12:15], s21 offen lds
 s_add_u32 m0, s22, 1024
 s_nop 0
 buffer_load_dwordx4 v41, s[12:15], s21 offen lds
 s_add_u32 m0, s22, 2048
 s_nop 0
 buffer_load_dwordx4 v42, s[12:15], s21 offen lds
 s_mul_i32 s21, s20, 393216
 s_add_u32 s21, s21, 1671168
 s_add_u32 s21, s21, s44
 s_mul_i32 s22, s20, 12288
 s_add_u32 s22, s22, 52224
 s_add_u32 m0, s22, 0
 s_nop 0
 buffer_load_dwordx4 v43, s[12:15], s21 offen lds
 s_add_u32 m0, s22, 1024
 s_nop 0
 buffer_load_dwordx4 v44, s[12:15], s21 offen lds
 s_add_u32 m0, s22, 2048
 s_nop 0
 buffer_load_dwordx4 v45, s[12:15], s21 offen lds
 s_mul_i32 s21, s20, 393216
 s_add_u32 s21, s21, 1769472
 s_add_u32 s21, s21, s44
 s_mul_i32 s22, s20, 12288
 s_add_u32 s22, s22, 55296
 s_add_u32 m0, s22, 0
 s_nop 0
 buffer_load_dwordx4 v40, s[12:15], s21 offen lds
 s_add_u32 m0, s22, 1024
 s_nop 0
 buffer_load_dwordx4 v41, s[12:15], s21 offen lds
 s_add_u32 m0, s22, 2048
 s_nop 0
 buffer_load_dwordx4 v42, s[12:15], s21 offen lds
 s_mul_i32 s21, s20, 393216
 s_add_u32 s21, s21, 1867776
 s_add_u32 s21, s21, s44
 s_mul_i32 s22, s20, 12288
 s_add_u32 s22, s22, 58368
 s_add_u32 m0, s22, 0
 s_nop 0
 buffer_load_dwordx4 v43, s[12:15], s21 offen lds
 s_add_u32 m0, s22, 1024
 s_nop 0
 buffer_load_dwordx4 v44, s[12:15], s21 offen lds
 s_add_u32 m0, s22, 2048
 s_nop 0
 buffer_load_dwordx4 v45, s[12:15], s21 offen lds
 v_lshrrev_b32 v7, 2, v2
 v_and_b32 v4, 2, v7
 v_and_b32 v5, 1, v3
 v_lshl_or_b32 v4, v5, 2, v4
 v_lshl_add_u32 v7, v3, 3, v7
 v_mul_u32_u24 v7, 384, v7
 v_and_b32 v5, 1, v2
 v_lshl_add_u32 v7, v5, 3, v7
 v_bfe_u32 v8, v2, 1, 1
 s_mul_i32 s21, s20, 6
 v_add_u32 v8, s21, v8
 v_add_u32 v5, 0, v8
 v_xor_b32 v5, v5, v4
 v_lshl_add_u32 v46, v5, 4, v7
 v_add_u32 v49, 49152, v46
 v_add_u32 v5, 2, v8
 v_xor_b32 v5, v5, v4
 v_lshl_add_u32 v47, v5, 4, v7
 v_add_u32 v50, 49152, v47
 v_add_u32 v5, 4, v8
 v_xor_b32 v5, v5, v4
 v_lshl_add_u32 v48, v5, 4, v7
 v_add_u32 v51, 49152, v48
 s_mov_b32 s26, 4
 s_mul_i32 s27, s42, 12288
 s_mul_i32 s21, s43, 25165824
 s_add_u32 s27, s27, s21
 s_mov_b32 s28, 786432
 s_lshl_b32 s60, s40, 7
 s_add_u32 s60, s60, 0
 s_mov_b32 s61, 0
 v_and_b32 v6, 7, v2
 v_add_u32 v4, 0, v3
 v_xor_b32 v4, v4, v6
 v_lshlrev_b32 v4, 4, v4
 v_lshl_add_u32 v14, v2, 7, v4
 v_add_u32 v4, 4, v3
 v_xor_b32 v4, v4, v6
 v_lshlrev_b32 v4, 4, v4
 v_lshl_add_u32 v15, v2, 7, v4
 v_mul_u32_u24 v22, 400, v2
 v_mul_u32_u24 v4, 16, v3
 s_mul_i32 s21, s20, 96
 s_add_u32 s21, s21, 0
 v_add3_u32 v22, v22, v4, s21
 v_lshlrev_b32 v4, 3, v3
 v_sub_u32 v16, v22, v4
 v_mov_b32 v9, 2731
 s_mul_i32 s21, s20, 6400
 s_add_u32 s21, s21, 0
 v_mul_u32_u24 v4, 400, v2
 v_lshlrev_b32 v5, 4, v3
 v_add3_u32 v23, v4, v5, s21
 v_lshlrev_b32 v26, 4, v1
 s_mov_b32 s33, 98304
 s_mov_b32 s48, 0x80000000
 s_mov_b32 m0, s32
 s_nop 0
 buffer_load_dwordx4 v10, s[8:11], s30 offen offset:0 lds
 s_waitcnt vmcnt(21)
 s_barrier
 v_add_u32 v18, s33, v14
 v_add_u32 v19, s33, v15
 s_add_u32 s33, s33, 8192
 s_cmp_lt_u32 s33, 155648
 s_cselect_b32 s33, s33, 98304
 ds_read_b128 v[160:163], v18 offset:0
 ds_read_b128 v[164:167], v18 offset:2048
 ds_read_b128 v[168:171], v18 offset:4096
 ds_read_b128 v[172:175], v18 offset:6144
 s_waitcnt lgkmcnt(0)
 s_waitcnt vmcnt(23)
 s_barrier
 ds_read_b64_tr_b16 a[0:1], v46 offset:0
 ds_read_b64_tr_b16 a[2:3], v46 offset:1536
 ds_read_b64_tr_b16 a[4:5], v47 offset:0
 ds_read_b64_tr_b16 a[6:7], v47 offset:1536
 ds_read_b64_tr_b16 a[8:9], v48 offset:0
 ds_read_b64_tr_b16 a[10:11], v48 offset:1536
 ds_read_b64_tr_b16 a[12:13], v46 offset:12288
 ds_read_b64_tr_b16 a[14:15], v46 offset:13824
 ds_read_b64_tr_b16 a[16:17], v47 offset:12288
 ds_read_b64_tr_b16 a[18:19], v47 offset:13824
 ds_read_b64_tr_b16 a[20:21], v48 offset:12288
 ds_read_b64_tr_b16 a[22:23], v48 offset:13824
 ds_read_b64_tr_b16 a[24:25], v46 offset:24576
 ds_read_b64_tr_b16 a[26:27], v46 offset:26112
 ds_read_b64_tr_b16 a[28:29], v47 offset:24576
 ds_read_b64_tr_b16 a[30:31], v47 offset:26112
 ds_read_b64_tr_b16 a[32:33], v48 offset:24576
 ds_read_b64_tr_b16 a[34:35], v48 offset:26112
 ds_read_b64_tr_b16 a[36:37], v46 offset:36864
 ds_read_b64_tr_b16 a[38:39], v46 offset:38400
 ds_read_b64_tr_b16 a[40:41], v47 offset:36864
 ds_read_b64_tr_b16 a[42:43], v47 offset:38400
 ds_read_b64_tr_b16 a[44:45], v48 offset:36864
 ds_read_b64_tr_b16 a[46:47], v48 offset:38400
 s_waitcnt lgkmcnt(0)
 s_barrier
 s_mov_b32 s23, m0
 s_mul_i32 s21, s20, 393216
 s_add_u32 s21, s21, 3145728
 s_add_u32 s21, s21, s44
 s_mul_i32 s22, s20, 12288
 s_add_u32 s22, s22, 0
 s_add_u32 m0, s22, 0
 s_nop 0
 buffer_load_dwordx4 v40, s[12:15], s21 offen lds
 s_add_u32 m0, s22, 1024
 s_nop 0
 buffer_load_dwordx4 v41, s[12:15], s21 offen lds
 s_add_u32 m0, s22, 2048
 s_nop 0
 buffer_load_dwordx4 v42, s[12:15], s21 offen lds
 s_mul_i32 s21, s20, 393216
 s_add_u32 s21, s21, 3244032
 s_add_u32 s21, s21, s44
 s_mul_i32 s22, s20, 12288
 s_add_u32 s22, s22, 3072
 s_add_u32 m0, s22, 0
 s_nop 0
 buffer_load_dwordx4 v43, s[12:15], s21 offen lds
 s_add_u32 m0, s22, 1024
 s_nop 0
 buffer_load_dwordx4 v44, s[12:15], s21 offen lds
 s_add_u32 m0, s22, 2048
 s_nop 0
 buffer_load_dwordx4 v45, s[12:15], s21 offen lds
 s_mul_i32 s21, s20, 393216
 s_add_u32 s21, s21, 3342336
 s_add_u32 s21, s21, s44
 s_mul_i32 s22, s20, 12288
 s_add_u32 s22, s22, 6144
 s_add_u32 m0, s22, 0
 s_nop 0
 buffer_load_dwordx4 v40, s[12:15], s21 offen lds
 s_add_u32 m0, s22, 1024
 s_nop 0
 buffer_load_dwordx4 v41, s[12:15], s21 offen lds
 s_add_u32 m0, s22, 2048
 s_nop 0
 buffer_load_dwordx4 v42, s[12:15], s21 offen lds
 s_mul_i32 s21, s20, 393216
 s_add_u32 s21, s21, 3440640
 s_add_u32 s21, s21, s44
 s_mul_i32 s22, s20, 12288
 s_add_u32 s22, s22, 9216
 s_add_u32 m0, s22, 0
 s_nop 0
 buffer_load_dwordx4 v43, s[12:15], s21 offen lds
 s_add_u32 m0, s22, 1024
 s_nop 0
 buffer_load_dwordx4 v44, s[12:15], s21 offen lds
 s_add_u32 m0, s22, 2048
 s_nop 0
 buffer_load_dwordx4 v45, s[12:15], s21 offen lds
 s_mov_b32 m0, s23
 v_mfma_f32_16x16x32_bf16 v[64:67], a[0:3], v[160:163], 0
 ds_read_b128 v[192:195], v19 offset:0
 v_mfma_f32_16x16x32_bf16 v[68:71], a[4:7], v[160:163], 0
 v_add_u32 v18, s33, v14
 v_mfma_f32_16x16x32_bf16 v[72:75], a[8:11], v[160:163], 0
 v_mfma_f32_16x16x32_bf16 v[76:79], a[0:3], v[164:167], 0
 ds_read_b128 v[196:199], v19 offset:2048
 v_mfma_f32_16x16x32_bf16 v[80:83], a[4:7], v[164:167], 0
 buffer_load_dwordx4 v11, s[8:11], s30 offen offset:1024 lds
 v_mfma_f32_16x16x32_bf16 v[84:87], a[8:11], v[164:167], 0
 s_add_u32 s30, s30, 128
 v_mfma_f32_16x16x32_bf16 v[88:91], a[0:3], v[168:171], 0
 ds_read_b128 v[200:203], v19 offset:4096
 s_add_u32 m0, m0, 8192
 v_mfma_f32_16x16x32_bf16 v[92:95], a[4:7], v[168:171], 0
 s_cmp_lt_u32 m0, s46
 s_cselect_b32 m0, m0, s47
 v_mfma_f32_16x16x32_bf16 v[96:99], a[8:11], v[168:171], 0
 v_mfma_f32_16x16x32_bf16 v[100:103], a[0:3], v[172:175], 0
 ds_read_b128 v[204:207], v19 offset:6144
 v_mfma_f32_16x16x32_bf16 v[104:107], a[4:7], v[172:175], 0
 v_mfma_f32_16x16x32_bf16 v[108:111], a[8:11], v[172:175], 0
 s_waitcnt vmcnt(32) lgkmcnt(2)
 s_barrier
 v_mfma_f32_16x16x32_bf16 v[64:67], a[12:15], v[192:195], v[64:67]
 ds_read_b128 v[160:163], v18 offset:0
 v_mfma_f32_16x16x32_bf16 v[68:71], a[16:19], v[192:195], v[68:71]
 v_mfma_f32_16x16x32_bf16 v[72:75], a[20:23], v[192:195], v[72:75]
 v_add_u32 v19, s33, v15
 s_add_u32 s33, s33, 8192
 v_mfma_f32_16x16x32_bf16 v[76:79], a[12:15], v[196:199], v[76:79]
 ds_read_b128 v[164:167], v18 offset:2048
 v_mfma_f32_16x16x32_bf16 v[80:83], a[16:19], v[196:199], v[80:83]
 buffer_load_dwordx4 v10, s[8:11], s30 offen offset:0 lds
 v_mfma_f32_16x16x32_bf16 v[84:87], a[20:23], v[196:199], v[84:87]
 s_waitcnt lgkmcnt(2)
 v_mfma_f32_16x16x32_bf16 v[88:91], a[12:15], v[200:203], v[88:91]
 ds_read_b128 v[168:171], v18 offset:4096
 v_mfma_f32_16x16x32_bf16 v[92:95], a[16:19], v[200:203], v[92:95]
 s_cmp_lt_u32 s33, 155648
 s_cselect_b32 s33, s33, 98304
 v_mfma_f32_16x16x32_bf16 v[96:99], a[20:23], v[200:203], v[96:99]
 v_mfma_f32_16x16x32_bf16 v[100:103], a[12:15], v[204:207], v[100:103]
 ds_read_b128 v[172:175], v18 offset:6144
 v_mfma_f32_16x16x32_bf16 v[104:107], a[16:19], v[204:207], v[104:107]
 v_mfma_f32_16x16x32_bf16 v[108:111], a[20:23], v[204:207], v[108:111]
 s_waitcnt lgkmcnt(2)
 v_mfma_f32_16x16x32_bf16 v[64:67], a[24:27], v[160:163], v[64:67]
 ds_read_b128 v[192:195], v19 offset:0
 v_mfma_f32_16x16x32_bf16 v[68:71], a[28:31], v[160:163], v[68:71]
 v_add_u32 v18, s33, v14
 v_mfma_f32_16x16x32_bf16 v[72:75], a[32:35], v[160:163], v[72:75]
 v_mfma_f32_16x16x32_bf16 v[76:79], a[24:27], v[164:167], v[76:79]
 ds_read_b128 v[196:199], v19 offset:2048
 v_mfma_f32_16x16x32_bf16 v[80:83], a[28:31], v[164:167], v[80:83]
 buffer_load_dwordx4 v11, s[8:11], s30 offen offset:1024 lds
 v_mfma_f32_16x16x32_bf16 v[84:87], a[32:35], v[164:167], v[84:87]
 s_waitcnt lgkmcnt(2)
 s_add_u32 s30, s30, 128
 v_mfma_f32_16x16x32_bf16 v[88:91], a[24:27], v[168:171], v[88:91]
 ds_read_b128 v[200:203], v19 offset:4096
 s_add_u32 m0, m0, 8192
 v_mfma_f32_16x16x32_bf16 v[92:95], a[28:31], v[168:171], v[92:95]
 s_cmp_lt_u32 m0, s46
 s_cselect_b32 m0, m0, s47
 v_mfma_f32_16x16x32_bf16 v[96:99], a[32:35], v[168:171], v[96:99]
 v_mfma_f32_16x16x32_bf16 v[100:103], a[24:27], v[172:175], v[100:103]
 ds_read_b128 v[204:207], v19 offset:6144
 v_mfma_f32_16x16x32_bf16 v[104:107], a[28:31], v[172:175], v[104:107]
 v_mfma_f32_16x16x32_bf16 v[108:111], a[32:35], v[172:175], v[108:111]
 s_waitcnt vmcnt(32) lgkmcnt(2)
 s_barrier
 v_mfma_f32_16x16x32_bf16 v[64:67], a[36:39], v[192:195], v[64:67]
 ds_read_b128 v[160:163], v18 offset:0
 v_mfma_f32_16x16x32_bf16 v[68:71], a[40:43], v[192:195], v[68:71]
 v_mfma_f32_16x16x32_bf16 v[72:75], a[44:47], v[192:195], v[72:75]
 v_add_u32 v19, s33, v15
 s_add_u32 s33, s33, 8192
 v_mfma_f32_16x16x32_bf16 v[76:79], a[36:39], v[196:199], v[76:79]
 ds_read_b128 v[164:167], v18 offset:2048
 v_mfma_f32_16x16x32_bf16 v[80:83], a[40:43], v[196:199], v[80:83]
 buffer_load_dwordx4 v10, s[8:11], s30 offen offset:0 lds
 v_mfma_f32_16x16x32_bf16 v[84:87], a[44:47], v[196:199], v[84:87]
 s_waitcnt lgkmcnt(2)
 v_mfma_f32_16x16x32_bf16 v[88:91], a[36:39], v[200:203], v[88:91]
 ds_read_b128 v[168:171], v18 offset:4096
 v_mfma_f32_16x16x32_bf16 v[92:95], a[40:43], v[200:203], v[92:95]
 s_cmp_lt_u32 s33, 155648
 s_cselect_b32 s33, s33, 98304
 v_mfma_f32_16x16x32_bf16 v[96:99], a[44:47], v[200:203], v[96:99]
 v_mfma_f32_16x16x32_bf16 v[100:103], a[36:39], v[204:207], v[100:103]
 ds_read_b128 v[172:175], v18 offset:6144
 v_mfma_f32_16x16x32_bf16 v[104:107], a[40:43], v[204:207], v[104:107]
 v_mfma_f32_16x16x32_bf16 v[108:111], a[44:47], v[204:207], v[108:111]
 s_waitcnt lgkmcnt(2)
 s_waitcnt vmcnt(17)
 s_barrier
 ds_read_b64_tr_b16 a[48:49], v49 offset:0
 ds_read_b64_tr_b16 a[50:51], v49 offset:1536
 ds_read_b64_tr_b16 a[52:53], v50 offset:0
 ds_read_b64_tr_b16 a[54:55], v50 offset:1536
 ds_read_b64_tr_b16 a[56:57], v51 offset:0
 ds_read_b64_tr_b16 a[58:59], v51 offset:1536
 ds_read_b64_tr_b16 a[60:61], v49 offset:12288
 ds_read_b64_tr_b16 a[62:63], v49 offset:13824
 ds_read_b64_tr_b16 a[64:65], v50 offset:12288
 ds_read_b64_tr_b16 a[66:67], v50 offset:13824
 ds_read_b64_tr_b16 a[68:69], v51 offset:12288
 ds_read_b64_tr_b16 a[70:71], v51 offset:13824
 ds_read_b64_tr_b16 a[72:73], v49 offset:24576
 ds_read_b64_tr_b16 a[74:75], v49 offset:26112
 ds_read_b64_tr_b16 a[76:77], v50 offset:24576
 ds_read_b64_tr_b16 a[78:79], v50 offset:26112
 ds_read_b64_tr_b16 a[80:81], v51 offset:24576
 ds_read_b64_tr_b16 a[82:83], v51 offset:26112
 ds_read_b64_tr_b16 a[84:85], v49 offset:36864
 ds_read_b64_tr_b16 a[86:87], v49 offset:38400
 ds_read_b64_tr_b16 a[88:89], v50 offset:36864
 ds_read_b64_tr_b16 a[90:91], v50 offset:38400
 ds_read_b64_tr_b16 a[92:93], v51 offset:36864
 ds_read_b64_tr_b16 a[94:95], v51 offset:38400
 s_waitcnt lgkmcnt(0)
 s_barrier
 s_mov_b32 s23, m0
 s_mul_i32 s21, s20, 393216
 s_add_u32 s21, s21, 4718592
 s_add_u32 s21, s21, s44
 s_mul_i32 s22, s20, 12288
 s_add_u32 s22, s22, 49152
 s_add_u32 m0, s22, 0
 s_nop 0
 buffer_load_dwordx4 v40, s[12:15], s21 offen lds
 s_add_u32 m0, s22, 1024
 s_nop 0
 buffer_load_dwordx4 v41, s[12:15], s21 offen lds
 s_add_u32 m0, s22, 2048
 s_nop 0
 buffer_load_dwordx4 v42, s[12:15], s21 offen lds
 s_mul_i32 s21, s20, 393216
 s_add_u32 s21, s21, 4816896
 s_add_u32 s21, s21, s44
 s_mul_i32 s22, s20, 12288
 s_add_u32 s22, s22, 52224
 s_add_u32 m0, s22, 0
 s_nop 0
 buffer_load_dwordx4 v43, s[12:15], s21 offen lds
 s_add_u32 m0, s22, 1024
 s_nop 0
 buffer_load_dwordx4 v44, s[12:15], s21 offen lds
 s_add_u32 m0, s22, 2048
 s_nop 0
 buffer_load_dwordx4 v45, s[12:15], s21 offen lds
 s_mul_i32 s21, s20, 393216
 s_add_u32 s21, s21, 4915200
 s_add_u32 s21, s21, s44
 s_mul_i32 s22, s20, 12288
 s_add_u32 s22, s22, 55296
 s_add_u32 m0, s22, 0
 s_nop 0
 buffer_load_dwordx4 v40, s[12:15], s21 offen lds
 s_add_u32 m0, s22, 1024
 s_nop 0
 buffer_load_dwordx4 v41, s[12:15], s21 offen lds
 s_add_u32 m0, s22, 2048
 s_nop 0
 buffer_load_dwordx4 v42, s[12:15], s21 offen lds
 s_mul_i32 s21, s20, 393216
 s_add_u32 s21, s21, 5013504
 s_add_u32 s21, s21, s44
 s_mul_i32 s22, s20, 12288
 s_add_u32 s22, s22, 58368
 s_add_u32 m0, s22, 0
 s_nop 0
 buffer_load_dwordx4 v43, s[12:15], s21 offen lds
 s_add_u32 m0, s22, 1024
 s_nop 0
 buffer_load_dwordx4 v44, s[12:15], s21 offen lds
 s_add_u32 m0, s22, 2048
 s_nop 0
 buffer_load_dwordx4 v45, s[12:15], s21 offen lds
 s_mov_b32 m0, s23
 v_mfma_f32_16x16x32_bf16 v[64:67], a[48:51], v[160:163], v[64:67]
 ds_read_b128 v[192:195], v19 offset:0
 v_mfma_f32_16x16x32_bf16 v[68:71], a[52:55], v[160:163], v[68:71]
 v_add_u32 v18, s33, v14
 v_mfma_f32_16x16x32_bf16 v[72:75], a[56:59], v[160:163], v[72:75]
 v_mfma_f32_16x16x32_bf16 v[76:79], a[48:51], v[164:167], v[76:79]
 ds_read_b128 v[196:199], v19 offset:2048
 v_mfma_f32_16x16x32_bf16 v[80:83], a[52:55], v[164:167], v[80:83]
 buffer_load_dwordx4 v11, s[8:11], s30 offen offset:1024 lds
 v_mfma_f32_16x16x32_bf16 v[84:87], a[56:59], v[164:167], v[84:87]
 s_add_u32 s30, s30, 128
 v_mfma_f32_16x16x32_bf16 v[88:91], a[48:51], v[168:171], v[88:91]
 ds_read_b128 v[200:203], v19 offset:4096
 s_add_u32 m0, m0, 8192
 v_mfma_f32_16x16x32_bf16 v[92:95], a[52:55], v[168:171], v[92:95]
 s_cmp_lt_u32 m0, s46
 s_cselect_b32 m0, m0, s47
 v_mfma_f32_16x16x32_bf16 v[96:99], a[56:59], v[168:171], v[96:99]
 v_mfma_f32_16x16x32_bf16 v[100:103], a[48:51], v[172:175], v[100:103]
 ds_read_b128 v[204:207], v19 offset:6144
 v_mfma_f32_16x16x32_bf16 v[104:107], a[52:55], v[172:175], v[104:107]
 v_mfma_f32_16x16x32_bf16 v[108:111], a[56:59], v[172:175], v[108:111]
 s_waitcnt vmcnt(44) lgkmcnt(2)
 s_barrier
 v_mfma_f32_16x16x32_bf16 v[64:67], a[60:63], v[192:195], v[64:67]
 ds_read_b128 v[160:163], v18 offset:0
 v_mfma_f32_16x16x32_bf16 v[68:71], a[64:67], v[192:195], v[68:71]
 v_mfma_f32_16x16x32_bf16 v[72:75], a[68:71], v[192:195], v[72:75]
 v_add_u32 v19, s33, v15
 s_add_u32 s33, s33, 8192
 v_mfma_f32_16x16x32_bf16 v[76:79], a[60:63], v[196:199], v[76:79]
 ds_read_b128 v[164:167], v18 offset:2048
 v_mfma_f32_16x16x32_bf16 v[80:83], a[64:67], v[196:199], v[80:83]
 buffer_load_dwordx4 v10, s[8:11], s30 offen offset:0 lds
 v_mfma_f32_16x16x32_bf16 v[84:87], a[68:71], v[196:199], v[84:87]
 s_waitcnt lgkmcnt(2)
 v_mfma_f32_16x16x32_bf16 v[88:91], a[60:63], v[200:203], v[88:91]
 ds_read_b128 v[168:171], v18 offset:4096
 v_mfma_f32_16x16x32_bf16 v[92:95], a[64:67], v[200:203], v[92:95]
 s_cmp_lt_u32 s33, 155648
 s_cselect_b32 s33, s33, 98304
 v_mfma_f32_16x16x32_bf16 v[96:99], a[68:71], v[200:203], v[96:99]
 v_mfma_f32_16x16x32_bf16 v[100:103], a[60:63], v[204:207], v[100:103]
 ds_read_b128 v[172:175], v18 offset:6144
 v_mfma_f32_16x16x32_bf16 v[104:107], a[64:67], v[204:207], v[104:107]
 v_mfma_f32_16x16x32_bf16 v[108:111], a[68:71], v[204:207], v[108:111]
 s_waitcnt lgkmcnt(2)
 v_mfma_f32_16x16x32_bf16 v[64:67], a[72:75], v[160:163], v[64:67]
 ds_read_b128 v[192:195], v19 offset:0
 v_mfma_f32_16x16x32_bf16 v[68:71], a[76:79], v[160:163], v[68:71]
 v_add_u32 v18, s33, v14
 v_mfma_f32_16x16x32_bf16 v[72:75], a[80:83], v[160:163], v[72:75]
 v_mfma_f32_16x16x32_bf16 v[76:79], a[72:75], v[164:167], v[76:79]
 ds_read_b128 v[196:199], v19 offset:2048
 v_mfma_f32_16x16x32_bf16 v[80:83], a[76:79], v[164:167], v[80:83]
 buffer_load_dwordx4 v11, s[8:11], s30 offen offset:1024 lds
 v_mfma_f32_16x16x32_bf16 v[84:87], a[80:83], v[164:167], v[84:87]
 s_waitcnt lgkmcnt(2)
 s_add_u32 s30, s30, 128
 v_mfma_f32_16x16x32_bf16 v[88:91], a[72:75], v[168:171], v[88:91]
 ds_read_b128 v[200:203], v19 offset:4096
 s_add_u32 m0, m0, 8192
 v_mfma_f32_16x16x32_bf16 v[92:95], a[76:79], v[168:171], v[92:95]
 s_cmp_lt_u32 m0, s46
 s_cselect_b32 m0, m0, s47
 v_mfma_f32_16x16x32_bf16 v[96:99], a[80:83], v[168:171], v[96:99]
 v_mfma_f32_16x16x32_bf16 v[100:103], a[72:75], v[172:175], v[100:103]
 ds_read_b128 v[204:207], v19 offset:6144
 v_mfma_f32_16x16x32_bf16 v[104:107], a[76:79], v[172:175], v[104:107]
 v_mfma_f32_16x16x32_bf16 v[108:111], a[80:83], v[172:175], v[108:111]
 s_waitcnt vmcnt(44) lgkmcnt(2)
 s_barrier
 v_mfma_f32_16x16x32_bf16 v[64:67], a[84:87], v[192:195], v[64:67]
 ds_read_b128 v[160:163], v18 offset:0
 v_mfma_f32_16x16x32_bf16 v[68:71], a[88:91], v[192:195], v[68:71]
 v_mfma_f32_16x16x32_bf16 v[72:75], a[92:95], v[192:195], v[72:75]
 v_add_u32 v19, s33, v15
 s_add_u32 s33, s33, 8192
 v_mfma_f32_16x16x32_bf16 v[76:79], a[84:87], v[196:199], v[76:79]
 ds_read_b128 v[164:167], v18 offset:2048
 v_mfma_f32_16x16x32_bf16 v[80:83], a[88:91], v[196:199], v[80:83]
 buffer_load_dwordx4 v10, s[8:11], s30 offen offset:0 lds
 v_mfma_f32_16x16x32_bf16 v[84:87], a[92:95], v[196:199], v[84:87]
 s_waitcnt lgkmcnt(2)
 v_mfma_f32_16x16x32_bf16 v[88:91], a[84:87], v[200:203], v[88:91]
 ds_read_b128 v[168:171], v18 offset:4096
 v_mfma_f32_16x16x32_bf16 v[92:95], a[88:91], v[200:203], v[92:95]
 s_cmp_lt_u32 s33, 155648
 s_cselect_b32 s33, s33, 98304
 v_mfma_f32_16x16x32_bf16 v[96:99], a[92:95], v[200:203], v[96:99]
 v_mfma_f32_16x16x32_bf16 v[100:103], a[84:87], v[204:207], v[100:103]
 ds_read_b128 v[172:175], v18 offset:6144
 v_mfma_f32_16x16x32_bf16 v[104:107], a[88:91], v[204:207], v[104:107]
 v_mfma_f32_16x16x32_bf16 v[108:111], a[92:95], v[204:207], v[108:111]
 s_waitcnt lgkmcnt(2)
 s_waitcnt vmcnt(20)
 s_barrier
 ds_read_b64_tr_b16 a[96:97], v46 offset:0
 ds_read_b64_tr_b16 a[98:99], v46 offset:1536
 ds_read_b64_tr_b16 a[100:101], v47 offset:0
 ds_read_b64_tr_b16 a[102:103], v47 offset:1536
 ds_read_b64_tr_b16 a[104:105], v48 offset:0
 ds_read_b64_tr_b16 a[106:107], v48 offset:1536
 ds_read_b64_tr_b16 a[108:109], v46 offset:12288
 ds_read_b64_tr_b16 a[110:111], v46 offset:13824
 ds_read_b64_tr_b16 a[112:113], v47 offset:12288
 ds_read_b64_tr_b16 a[114:115], v47 offset:13824
 ds_read_b64_tr_b16 a[116:117], v48 offset:12288
 ds_read_b64_tr_b16 a[118:119], v48 offset:13824
 ds_read_b64_tr_b16 a[120:121], v46 offset:24576
 ds_read_b64_tr_b16 a[122:123], v46 offset:26112
 ds_read_b64_tr_b16 a[124:125], v47 offset:24576
 ds_read_b64_tr_b16 a[126:127], v47 offset:26112
 ds_read_b64_tr_b16 a[128:129], v48 offset:24576
 ds_read_b64_tr_b16 a[130:131], v48 offset:26112
 ds_read_b64_tr_b16 a[132:133], v46 offset:36864
 ds_read_b64_tr_b16 a[134:135], v46 offset:38400
 ds_read_b64_tr_b16 a[136:137], v47 offset:36864
 ds_read_b64_tr_b16 a[138:139], v47 offset:38400
 ds_read_b64_tr_b16 a[140:141], v48 offset:36864
 ds_read_b64_tr_b16 a[142:143], v48 offset:38400
 s_waitcnt lgkmcnt(0)
 s_barrier
 s_mov_b32 s23, m0
 s_mul_i32 s21, s20, 393216
 s_add_u32 s21, s21, 6291456
 s_add_u32 s21, s21, s44
 s_mul_i32 s22, s20, 12288
 s_add_u32 s22, s22, 0
 s_add_u32 m0, s22, 0
 s_nop 0
 buffer_load_dwordx4 v40, s[12:15], s21 offen lds
 s_add_u32 m0, s22, 1024
 s_nop 0
 buffer_load_dwordx4 v41, s[12:15], s21 offen lds
 s_add_u32 m0, s22, 2048
 s_nop 0
 buffer_load_dwordx4 v42, s[12:15], s21 offen lds
 s_mul_i32 s21, s20, 393216
 s_add_u32 s21, s21, 6389760
 s_add_u32 s21, s21, s44
 s_mul_i32 s22, s20, 12288
 s_add_u32 s22, s22, 3072
 s_add_u32 m0, s22, 0
 s_nop 0
 buffer_load_dwordx4 v43, s[12:15], s21 offen lds
 s_add_u32 m0, s22, 1024
 s_nop 0
 buffer_load_dwordx4 v44, s[12:15], s21 offen lds
 s_add_u32 m0, s22, 2048
 s_nop 0
 buffer_load_dwordx4 v45, s[12:15], s21 offen lds
 s_mul_i32 s21, s20, 393216
 s_add_u32 s21, s21, 6488064
 s_add_u32 s21, s21, s44
 s_mul_i32 s22, s20, 12288
 s_add_u32 s22, s22, 6144
 s_add_u32 m0, s22, 0
 s_nop 0
 buffer_load_dwordx4 v40, s[12:15], s21 offen lds
 s_add_u32 m0, s22, 1024
 s_nop 0
 buffer_load_dwordx4 v41, s[12:15], s21 offen lds
 s_add_u32 m0, s22, 2048
 s_nop 0
 buffer_load_dwordx4 v42, s[12:15], s21 offen lds
 s_mul_i32 s21, s20, 393216
 s_add_u32 s21, s21, 6586368
 s_add_u32 s21, s21, s44
 s_mul_i32 s22, s20, 12288
 s_add_u32 s22, s22, 9216
 s_add_u32 m0, s22, 0
 s_nop 0
 buffer_load_dwordx4 v43, s[12:15], s21 offen lds
 s_add_u32 m0, s22, 1024
 s_nop 0
 buffer_load_dwordx4 v44, s[12:15], s21 offen lds
 s_add_u32 m0, s22, 2048
 s_nop 0
 buffer_load_dwordx4 v45, s[12:15], s21 offen lds
 s_mov_b32 m0, s23
 v_mov_b32 v29, 76
 buffer_load_dword v29, v29, s[64:67], 0 offen sc1
 v_mfma_f32_16x16x32_bf16 v[64:67], a[96:99], v[160:163], v[64:67]
 ds_read_b128 v[192:195], v19 offset:0
 v_mfma_f32_16x16x32_bf16 v[68:71], a[100:103], v[160:163], v[68:71]
 v_add_u32 v18, s33, v14
 s_mov_b32 s61, s60
 v_mfma_f32_16x16x32_bf16 v[72:75], a[104:107], v[160:163], v[72:75]
 s_add_u32 s60, s60, s62
 s_lshr_b32 s48, s20, 1
 v_mfma_f32_16x16x32_bf16 v[76:79], a[96:99], v[164:167], v[76:79]
 ds_read_b128 v[196:199], v19 offset:2048
 s_mul_i32 s48, s48, 393216
 v_mfma_f32_16x16x32_bf16 v[80:83], a[100:103], v[164:167], v[80:83]
 buffer_load_dwordx4 v11, s[8:11], s30 offen offset:1024 lds
 v_mfma_f32_16x16x32_bf16 v[84:87], a[104:107], v[164:167], v[84:87]
 s_add_u32 s30, s30, s25
 v_mfma_f32_16x16x32_bf16 v[88:91], a[96:99], v[168:171], v[88:91]
 ds_read_b128 v[200:203], v19 offset:4096
 s_sub_u32 s30, s30, 1152
 v_mfma_f32_16x16x32_bf16 v[92:95], a[100:103], v[168:171], v[92:95]
 s_add_u32 m0, m0, 8192
 s_and_b32 s21, s20, 1
 v_mfma_f32_16x16x32_bf16 v[96:99], a[104:107], v[168:171], v[96:99]
 s_cmp_lt_u32 m0, s46
 s_cselect_b32 m0, m0, s47
 v_mfma_f32_16x16x32_bf16 v[100:103], a[96:99], v[172:175], v[100:103]
 ds_read_b128 v[204:207], v19 offset:6144
 s_mul_i32 s21, s21, 6144
 v_mfma_f32_16x16x32_bf16 v[104:107], a[100:103], v[172:175], v[104:107]
 s_add_u32 s48, s48, s21
 s_add_u32 s48, s48, s27
 v_mfma_f32_16x16x32_bf16 v[108:111], a[104:107], v[172:175], v[108:111]
 s_waitcnt vmcnt(33) lgkmcnt(2)
 s_barrier
 v_mfma_f32_16x16x32_bf16 v[64:67], a[108:111], v[192:195], v[64:67]
 ds_read_b128 v[160:163], v18 offset:0
 s_add_u32 s27, s27, s28
 v_mfma_f32_16x16x32_bf16 v[68:71], a[112:115], v[192:195], v[68:71]
 s_sub_u32 s26, s26, 1
 v_mfma_f32_16x16x32_bf16 v[72:75], a[116:119], v[192:195], v[72:75]
 v_add_u32 v19, s33, v15
 s_add_u32 s33, s33, 8192
 v_mfma_f32_16x16x32_bf16 v[76:79], a[108:111], v[196:199], v[76:79]
 ds_read_b128 v[164:167], v18 offset:2048
 v_mfma_f32_16x16x32_bf16 v[80:83], a[112:115], v[196:199], v[80:83]
 buffer_load_dwordx4 v10, s[8:11], s30 offen offset:0 lds
 v_mfma_f32_16x16x32_bf16 v[84:87], a[116:119], v[196:199], v[84:87]
 s_waitcnt lgkmcnt(2)
 v_mfma_f32_16x16x32_bf16 v[88:91], a[108:111], v[200:203], v[88:91]
 ds_read_b128 v[168:171], v18 offset:4096
 v_mfma_f32_16x16x32_bf16 v[92:95], a[112:115], v[200:203], v[92:95]
 s_cmp_lt_u32 s33, 155648
 s_cselect_b32 s33, s33, 98304
 v_mfma_f32_16x16x32_bf16 v[96:99], a[116:119], v[200:203], v[96:99]
 v_mfma_f32_16x16x32_bf16 v[100:103], a[108:111], v[204:207], v[100:103]
 ds_read_b128 v[172:175], v18 offset:6144
 v_mfma_f32_16x16x32_bf16 v[104:107], a[112:115], v[204:207], v[104:107]
 v_mfma_f32_16x16x32_bf16 v[108:111], a[116:119], v[204:207], v[108:111]
 s_waitcnt lgkmcnt(2)
 v_mfma_f32_16x16x32_bf16 v[64:67], a[120:123], v[160:163], v[64:67]
 ds_read_b128 v[192:195], v19 offset:0
 v_mfma_f32_16x16x32_bf16 v[68:71], a[124:127], v[160:163], v[68:71]
 v_add_u32 v18, s33, v14
 v_mfma_f32_16x16x32_bf16 v[72:75], a[128:131], v[160:163], v[72:75]
 v_mfma_f32_16x16x32_bf16 v[76:79], a[120:123], v[164:167], v[76:79]
 ds_read_b128 v[196:199], v19 offset:2048
 v_mfma_f32_16x16x32_bf16 v[80:83], a[124:127], v[164:167], v[80:83]
 buffer_load_dwordx4 v11, s[8:11], s30 offen offset:1024 lds
 v_mfma_f32_16x16x32_bf16 v[84:87], a[128:131], v[164:167], v[84:87]
 s_waitcnt lgkmcnt(2)
 s_add_u32 s30, s30, 128
 v_mfma_f32_16x16x32_bf16 v[88:91], a[120:123], v[168:171], v[88:91]
 ds_read_b128 v[200:203], v19 offset:4096
 s_add_u32 m0, m0, 8192
 v_mfma_f32_16x16x32_bf16 v[92:95], a[124:127], v[168:171], v[92:95]
 s_cmp_lt_u32 m0, s46
 s_cselect_b32 m0, m0, s47
 v_mfma_f32_16x16x32_bf16 v[96:99], a[128:131], v[168:171], v[96:99]
 v_mfma_f32_16x16x32_bf16 v[100:103], a[120:123], v[172:175], v[100:103]
 ds_read_b128 v[204:207], v19 offset:6144
 v_mfma_f32_16x16x32_bf16 v[104:107], a[124:127], v[172:175], v[104:107]
 v_mfma_f32_16x16x32_bf16 v[108:111], a[128:131], v[172:175], v[108:111]
 s_waitcnt vmcnt(33) lgkmcnt(2)
 s_barrier
 v_mfma_f32_16x16x32_bf16 v[64:67], a[132:135], v[192:195], v[64:67]
 ds_read_b128 v[160:163], v18 offset:0
 v_mfma_f32_16x16x32_bf16 v[68:71], a[136:139], v[192:195], v[68:71]
 v_mfma_f32_16x16x32_bf16 v[72:75], a[140:143], v[192:195], v[72:75]
 v_add_u32 v19, s33, v15
 s_add_u32 s33, s33, 8192
 v_mfma_f32_16x16x32_bf16 v[76:79], a[132:135], v[196:199], v[76:79]
 ds_read_b128 v[164:167], v18 offset:2048
 v_mfma_f32_16x16x32_bf16 v[80:83], a[136:139], v[196:199], v[80:83]
 buffer_load_dwordx4 v10, s[8:11], s30 offen offset:0 lds
 v_mfma_f32_16x16x32_bf16 v[84:87], a[140:143], v[196:199], v[84:87]
 s_waitcnt lgkmcnt(2)
 v_mfma_f32_16x16x32_bf16 v[88:91], a[132:135], v[200:203], v[88:91]
 ds_read_b128 v[168:171], v18 offset:4096
 v_mfma_f32_16x16x32_bf16 v[92:95], a[136:139], v[200:203], v[92:95]
 s_cmp_lt_u32 s33, 155648
 s_cselect_b32 s33, s33, 98304
 v_mfma_f32_16x16x32_bf16 v[96:99], a[140:143], v[200:203], v[96:99]
 v_mfma_f32_16x16x32_bf16 v[100:103], a[132:135], v[204:207], v[100:103]
 ds_read_b128 v[172:175], v18 offset:6144
 v_mfma_f32_16x16x32_bf16 v[104:107], a[136:139], v[204:207], v[104:107]
 v_mfma_f32_16x16x32_bf16 v[108:111], a[140:143], v[204:207], v[108:111]
 s_waitcnt lgkmcnt(2)
 s_waitcnt vmcnt(21)
 s_barrier
 ds_read_b64_tr_b16 a[144:145], v49 offset:0
 ds_read_b64_tr_b16 a[146:147], v49 offset:1536
 ds_read_b64_tr_b16 a[148:149], v50 offset:0
 ds_read_b64_tr_b16 a[150:151], v50 offset:1536
 ds_read_b64_tr_b16 a[152:153], v51 offset:0
 ds_read_b64_tr_b16 a[154:155], v51 offset:1536
 ds_read_b64_tr_b16 a[156:157], v49 offset:12288
 ds_read_b64_tr_b16 a[158:159], v49 offset:13824
 ds_read_b64_tr_b16 a[160:161], v50 offset:12288
 ds_read_b64_tr_b16 a[162:163], v50 offset:13824
 ds_read_b64_tr_b16 a[164:165], v51 offset:12288
 ds_read_b64_tr_b16 a[166:167], v51 offset:13824
 ds_read_b64_tr_b16 a[168:169], v49 offset:24576
 ds_read_b64_tr_b16 a[170:171], v49 offset:26112
 ds_read_b64_tr_b16 a[172:173], v50 offset:24576
 ds_read_b64_tr_b16 a[174:175], v50 offset:26112
 ds_read_b64_tr_b16 a[176:177], v51 offset:24576
 ds_read_b64_tr_b16 a[178:179], v51 offset:26112
 ds_read_b64_tr_b16 a[180:181], v49 offset:36864
 ds_read_b64_tr_b16 a[182:183], v49 offset:38400
 ds_read_b64_tr_b16 a[184:185], v50 offset:36864
 ds_read_b64_tr_b16 a[186:187], v50 offset:38400
 ds_read_b64_tr_b16 a[188:189], v51 offset:36864
 ds_read_b64_tr_b16 a[190:191], v51 offset:38400
 s_waitcnt lgkmcnt(0)
 s_barrier
 v_mfma_f32_16x16x32_bf16 v[64:67], a[144:147], v[160:163], v[64:67]
 ds_read_b128 v[192:195], v19 offset:0
 v_mfma_f32_16x16x32_bf16 v[68:71], a[148:151], v[160:163], v[68:71]
 v_add_u32 v18, s33, v14
 v_mfma_f32_16x16x32_bf16 v[72:75], a[152:155], v[160:163], v[72:75]
 v_mfma_f32_16x16x32_bf16 v[76:79], a[144:147], v[164:167], v[76:79]
 ds_read_b128 v[196:199], v19 offset:2048
 v_mfma_f32_16x16x32_bf16 v[80:83], a[148:151], v[164:167], v[80:83]
 buffer_load_dwordx4 v11, s[8:11], s30 offen offset:1024 lds
 v_mfma_f32_16x16x32_bf16 v[84:87], a[152:155], v[164:167], v[84:87]
 s_add_u32 s30, s30, 128
 v_mfma_f32_16x16x32_bf16 v[88:91], a[144:147], v[168:171], v[88:91]
 ds_read_b128 v[200:203], v19 offset:4096
 s_add_u32 m0, m0, 8192
 v_mfma_f32_16x16x32_bf16 v[92:95], a[148:151], v[168:171], v[92:95]
 s_cmp_lt_u32 m0, s46
 s_cselect_b32 m0, m0, s47
 v_mfma_f32_16x16x32_bf16 v[96:99], a[152:155], v[168:171], v[96:99]
 v_mfma_f32_16x16x32_bf16 v[100:103], a[144:147], v[172:175], v[100:103]
 ds_read_b128 v[204:207], v19 offset:6144
 v_mfma_f32_16x16x32_bf16 v[104:107], a[148:151], v[172:175], v[104:107]
 v_mfma_f32_16x16x32_bf16 v[108:111], a[152:155], v[172:175], v[108:111]
 s_waitcnt vmcnt(21) lgkmcnt(2)
 s_barrier
 v_mfma_f32_16x16x32_bf16 v[64:67], a[156:159], v[192:195], v[64:67]
 ds_read_b128 v[160:163], v18 offset:0
 v_mfma_f32_16x16x32_bf16 v[68:71], a[160:163], v[192:195], v[68:71]
 v_mfma_f32_16x16x32_bf16 v[72:75], a[164:167], v[192:195], v[72:75]
 v_add_u32 v19, s33, v15
 s_add_u32 s33, s33, 8192
 v_mfma_f32_16x16x32_bf16 v[76:79], a[156:159], v[196:199], v[76:79]
 ds_read_b128 v[164:167], v18 offset:2048
 v_mfma_f32_16x16x32_bf16 v[80:83], a[160:163], v[196:199], v[80:83]
 buffer_load_dwordx4 v10, s[8:11], s30 offen offset:0 lds
 v_mfma_f32_16x16x32_bf16 v[84:87], a[164:167], v[196:199], v[84:87]
 s_waitcnt lgkmcnt(2)
 v_mfma_f32_16x16x32_bf16 v[88:91], a[156:159], v[200:203], v[88:91]
 ds_read_b128 v[168:171], v18 offset:4096
 v_mfma_f32_16x16x32_bf16 v[92:95], a[160:163], v[200:203], v[92:95]
 s_cmp_lt_u32 s33, 155648
 s_cselect_b32 s33, s33, 98304
 v_mfma_f32_16x16x32_bf16 v[96:99], a[164:167], v[200:203], v[96:99]
 v_mfma_f32_16x16x32_bf16 v[100:103], a[156:159], v[204:207], v[100:103]
 ds_read_b128 v[172:175], v18 offset:6144
 v_mfma_f32_16x16x32_bf16 v[104:107], a[160:163], v[204:207], v[104:107]
 v_mfma_f32_16x16x32_bf16 v[108:111], a[164:167], v[204:207], v[108:111]
 s_waitcnt lgkmcnt(2)
 v_mfma_f32_16x16x32_bf16 v[64:67], a[168:171], v[160:163], v[64:67]
 ds_read_b128 v[192:195], v19 offset:0
 v_mfma_f32_16x16x32_bf16 v[68:71], a[172:175], v[160:163], v[68:71]
 v_add_u32 v18, s33, v14
 v_mfma_f32_16x16x32_bf16 v[72:75], a[176:179], v[160:163], v[72:75]
 v_mfma_f32_16x16x32_bf16 v[76:79], a[168:171], v[164:167], v[76:79]
 ds_read_b128 v[196:199], v19 offset:2048
 v_mfma_f32_16x16x32_bf16 v[80:83], a[172:175], v[164:167], v[80:83]
 buffer_load_dwordx4 v11, s[8:11], s30 offen offset:1024 lds
 v_mfma_f32_16x16x32_bf16 v[84:87], a[176:179], v[164:167], v[84:87]
 s_waitcnt lgkmcnt(2)
 s_add_u32 s30, s30, 128
 v_mfma_f32_16x16x32_bf16 v[88:91], a[168:171], v[168:171], v[88:91]
 ds_read_b128 v[200:203], v19 offset:4096
 s_add_u32 m0, m0, 8192
 v_mfma_f32_16x16x32_bf16 v[92:95], a[172:175], v[168:171], v[92:95]
 s_cmp_lt_u32 m0, s46
 s_cselect_b32 m0, m0, s47
 v_mfma_f32_16x16x32_bf16 v[96:99], a[176:179], v[168:171], v[96:99]
 v_mfma_f32_16x16x32_bf16 v[100:103], a[168:171], v[172:175], v[100:103]
 ds_read_b128 v[204:207], v19 offset:6144
 v_mfma_f32_16x16x32_bf16 v[104:107], a[172:175], v[172:175], v[104:107]
 v_mfma_f32_16x16x32_bf16 v[108:111], a[176:179], v[172:175], v[108:111]
 s_waitcnt vmcnt(21) lgkmcnt(2)
 s_barrier
 v_mfma_f32_16x16x32_bf16 v[64:67], a[180:183], v[192:195], v[64:67]
 ds_read_b128 v[160:163], v18 offset:0
 v_mfma_f32_16x16x32_bf16 v[68:71], a[184:187], v[192:195], v[68:71]
 v_mfma_f32_16x16x32_bf16 v[72:75], a[188:191], v[192:195], v[72:75]
 v_add_u32 v19, s33, v15
 s_add_u32 s33, s33, 8192
 v_mfma_f32_16x16x32_bf16 v[76:79], a[180:183], v[196:199], v[76:79]
 ds_read_b128 v[164:167], v18 offset:2048
 v_mfma_f32_16x16x32_bf16 v[80:83], a[184:187], v[196:199], v[80:83]
 buffer_load_dwordx4 v10, s[8:11], s30 offen offset:0 lds
 v_mfma_f32_16x16x32_bf16 v[84:87], a[188:191], v[196:199], v[84:87]
 s_waitcnt lgkmcnt(2)
 v_mfma_f32_16x16x32_bf16 v[88:91], a[180:183], v[200:203], v[88:91]
 ds_read_b128 v[168:171], v18 offset:4096
 v_mfma_f32_16x16x32_bf16 v[92:95], a[184:187], v[200:203], v[92:95]
 s_cmp_lt_u32 s33, 155648
 s_cselect_b32 s33, s33, 98304
 v_mfma_f32_16x16x32_bf16 v[96:99], a[188:191], v[200:203], v[96:99]
 v_mfma_f32_16x16x32_bf16 v[100:103], a[180:183], v[204:207], v[100:103]
 ds_read_b128 v[172:175], v18 offset:6144
 v_mfma_f32_16x16x32_bf16 v[104:107], a[184:187], v[204:207], v[104:107]
 v_mfma_f32_16x16x32_bf16 v[108:111], a[188:191], v[204:207], v[108:111]
 s_waitcnt lgkmcnt(2)
 s_waitcnt vmcnt(9)
 s_barrier
 ds_read_b64_tr_b16 a[192:193], v46 offset:0
 ds_read_b64_tr_b16 a[194:195], v46 offset:1536
 ds_read_b64_tr_b16 a[196:197], v47 offset:0
 ds_read_b64_tr_b16 a[198:199], v47 offset:1536
 ds_read_b64_tr_b16 a[200:201], v48 offset:0
 ds_read_b64_tr_b16 a[202:203], v48 offset:1536
 ds_read_b64_tr_b16 a[204:205], v46 offset:12288
 ds_read_b64_tr_b16 a[206:207], v46 offset:13824
 ds_read_b64_tr_b16 a[208:209], v47 offset:12288
 ds_read_b64_tr_b16 a[210:211], v47 offset:13824
 ds_read_b64_tr_b16 a[212:213], v48 offset:12288
 ds_read_b64_tr_b16 a[214:215], v48 offset:13824
 ds_read_b64_tr_b16 a[216:217], v46 offset:24576
 ds_read_b64_tr_b16 a[218:219], v46 offset:26112
 ds_read_b64_tr_b16 a[220:221], v47 offset:24576
 ds_read_b64_tr_b16 a[222:223], v47 offset:26112
 ds_read_b64_tr_b16 a[224:225], v48 offset:24576
 ds_read_b64_tr_b16 a[226:227], v48 offset:26112
 ds_read_b64_tr_b16 a[228:229], v46 offset:36864
 ds_read_b64_tr_b16 a[230:231], v46 offset:38400
 ds_read_b64_tr_b16 a[232:233], v47 offset:36864
 ds_read_b64_tr_b16 a[234:235], v47 offset:38400
 ds_read_b64_tr_b16 a[236:237], v48 offset:36864
 ds_read_b64_tr_b16 a[238:239], v48 offset:38400
 s_waitcnt lgkmcnt(0)
 s_barrier
 v_mfma_f32_16x16x32_bf16 v[64:67], a[192:195], v[160:163], v[64:67]
 ds_read_b128 v[192:195], v19 offset:0
 v_mfma_f32_16x16x32_bf16 v[68:71], a[196:199], v[160:163], v[68:71]
 v_add_u32 v18, s33, v14
 v_mfma_f32_16x16x32_bf16 v[72:75], a[200:203], v[160:163], v[72:75]
 v_mfma_f32_16x16x32_bf16 v[76:79], a[192:195], v[164:167], v[76:79]
 ds_read_b128 v[196:199], v19 offset:2048
 v_mfma_f32_16x16x32_bf16 v[80:83], a[196:199], v[164:167], v[80:83]
 buffer_load_dwordx4 v11, s[8:11], s30 offen offset:1024 lds
 v_mfma_f32_16x16x32_bf16 v[84:87], a[200:203], v[164:167], v[84:87]
 s_add_u32 s30, s30, 128
 v_mfma_f32_16x16x32_bf16 v[88:91], a[192:195], v[168:171], v[88:91]
 ds_read_b128 v[200:203], v19 offset:4096
 s_add_u32 m0, m0, 8192
 v_mfma_f32_16x16x32_bf16 v[92:95], a[196:199], v[168:171], v[92:95]
 s_cmp_lt_u32 m0, s46
 s_cselect_b32 m0, m0, s47
 v_mfma_f32_16x16x32_bf16 v[96:99], a[200:203], v[168:171], v[96:99]
 v_mfma_f32_16x16x32_bf16 v[100:103], a[192:195], v[172:175], v[100:103]
 ds_read_b128 v[204:207], v19 offset:6144
 v_mfma_f32_16x16x32_bf16 v[104:107], a[196:199], v[172:175], v[104:107]
 v_mfma_f32_16x16x32_bf16 v[108:111], a[200:203], v[172:175], v[108:111]
 s_waitcnt vmcnt(8) lgkmcnt(2)
 s_barrier
 v_mfma_f32_16x16x32_bf16 v[64:67], a[204:207], v[192:195], v[64:67]
 ds_read_b128 v[160:163], v18 offset:0
 v_mfma_f32_16x16x32_bf16 v[68:71], a[208:211], v[192:195], v[68:71]
 v_mfma_f32_16x16x32_bf16 v[72:75], a[212:215], v[192:195], v[72:75]
 v_add_u32 v19, s33, v15
 s_add_u32 s33, s33, 8192
 v_mfma_f32_16x16x32_bf16 v[76:79], a[204:207], v[196:199], v[76:79]
 ds_read_b128 v[164:167], v18 offset:2048
 v_mfma_f32_16x16x32_bf16 v[80:83], a[208:211], v[196:199], v[80:83]
 buffer_load_dwordx4 v10, s[8:11], s30 offen offset:0 lds
 v_mfma_f32_16x16x32_bf16 v[84:87], a[212:215], v[196:199], v[84:87]
 s_waitcnt lgkmcnt(2)
 v_mfma_f32_16x16x32_bf16 v[88:91], a[204:207], v[200:203], v[88:91]
 ds_read_b128 v[168:171], v18 offset:4096
 v_mfma_f32_16x16x32_bf16 v[92:95], a[208:211], v[200:203], v[92:95]
 s_cmp_lt_u32 s33, 155648
 s_cselect_b32 s33, s33, 98304
 v_mfma_f32_16x16x32_bf16 v[96:99], a[212:215], v[200:203], v[96:99]
 v_mfma_f32_16x16x32_bf16 v[100:103], a[204:207], v[204:207], v[100:103]
 ds_read_b128 v[172:175], v18 offset:6144
 v_mfma_f32_16x16x32_bf16 v[104:107], a[208:211], v[204:207], v[104:107]
 v_mfma_f32_16x16x32_bf16 v[108:111], a[212:215], v[204:207], v[108:111]
 s_waitcnt lgkmcnt(2)
 v_mfma_f32_16x16x32_bf16 v[64:67], a[216:219], v[160:163], v[64:67]
 ds_read_b128 v[192:195], v19 offset:0
 v_mfma_f32_16x16x32_bf16 v[68:71], a[220:223], v[160:163], v[68:71]
 v_add_u32 v18, s33, v14
 v_mfma_f32_16x16x32_bf16 v[72:75], a[224:227], v[160:163], v[72:75]
 v_mfma_f32_16x16x32_bf16 v[76:79], a[216:219], v[164:167], v[76:79]
 ds_read_b128 v[196:199], v19 offset:2048
 v_mfma_f32_16x16x32_bf16 v[80:83], a[220:223], v[164:167], v[80:83]
 buffer_load_dwordx4 v11, s[8:11], s30 offen offset:1024 lds
 v_mfma_f32_16x16x32_bf16 v[84:87], a[224:227], v[164:167], v[84:87]
 s_waitcnt lgkmcnt(2)
 s_add_u32 s30, s30, 128
 v_mfma_f32_16x16x32_bf16 v[88:91], a[216:219], v[168:171], v[88:91]
 ds_read_b128 v[200:203], v19 offset:4096
 s_add_u32 m0, m0, 8192
 v_mfma_f32_16x16x32_bf16 v[92:95], a[220:223], v[168:171], v[92:95]
 s_cmp_lt_u32 m0, s46
 s_cselect_b32 m0, m0, s47
 v_mfma_f32_16x16x32_bf16 v[96:99], a[224:227], v[168:171], v[96:99]
 v_mfma_f32_16x16x32_bf16 v[100:103], a[216:219], v[172:175], v[100:103]
 ds_read_b128 v[204:207], v19 offset:6144
 v_mfma_f32_16x16x32_bf16 v[104:107], a[220:223], v[172:175], v[104:107]
 v_mfma_f32_16x16x32_bf16 v[108:111], a[224:227], v[172:175], v[108:111]
 s_waitcnt vmcnt(8) lgkmcnt(2)
 s_barrier
 v_mfma_f32_16x16x32_bf16 v[64:67], a[228:231], v[192:195], v[64:67]
 ds_read_b128 v[160:163], v18 offset:0
 v_mfma_f32_16x16x32_bf16 v[68:71], a[232:235], v[192:195], v[68:71]
 v_mfma_f32_16x16x32_bf16 v[72:75], a[236:239], v[192:195], v[72:75]
 v_add_u32 v19, s33, v15
 s_add_u32 s33, s33, 8192
 v_mfma_f32_16x16x32_bf16 v[76:79], a[228:231], v[196:199], v[76:79]
 ds_read_b128 v[164:167], v18 offset:2048
 v_cvt_pk_bf16_f32 v224, v64, v65
 v_cvt_pk_bf16_f32 v225, v66, v67
 v_mfma_f32_16x16x32_bf16 v[80:83], a[232:235], v[196:199], v[80:83]
 buffer_load_dwordx4 v10, s[8:11], s30 offen offset:0 lds
 v_cvt_pk_bf16_f32 v226, v68, v69
 v_cvt_pk_bf16_f32 v227, v70, v71
 v_mfma_f32_16x16x32_bf16 v[84:87], a[236:239], v[196:199], v[84:87]
 s_waitcnt lgkmcnt(2)
 v_cvt_pk_bf16_f32 v228, v72, v73
 v_cvt_pk_bf16_f32 v229, v74, v75
 v_mfma_f32_16x16x32_bf16 v[88:91], a[228:231], v[200:203], v[88:91]
 ds_read_b128 v[168:171], v18 offset:4096
 ds_write_b64 v22, v[224:225] offset:0
 v_mfma_f32_16x16x32_bf16 v[92:95], a[232:235], v[200:203], v[92:95]
 s_cmp_lt_u32 s33, 155648
 s_cselect_b32 s33, s33, 98304
 ds_write_b64 v22, v[226:227] offset:8
 v_mfma_f32_16x16x32_bf16 v[96:99], a[236:239], v[200:203], v[96:99]
 ds_write_b64 v16, v[228:229] offset:64
 v_cvt_pk_bf16_f32 v230, v76, v77
 v_cvt_pk_bf16_f32 v231, v78, v79
 v_mfma_f32_16x16x32_bf16 v[100:103], a[228:231], v[204:207], v[100:103]
 ds_read_b128 v[172:175], v18 offset:6144
 v_cvt_pk_bf16_f32 v232, v80, v81
 v_cvt_pk_bf16_f32 v233, v82, v83
 v_cvt_pk_bf16_f32 v234, v84, v85
 v_mfma_f32_16x16x32_bf16 v[104:107], a[232:235], v[204:207], v[104:107]
 v_cvt_pk_bf16_f32 v235, v86, v87
 ds_write_b64 v22, v[230:231] offset:6400
 v_mfma_f32_16x16x32_bf16 v[108:111], a[236:239], v[204:207], v[108:111]
 ds_write_b64 v22, v[232:233] offset:6408
 ds_write_b64 v16, v[234:235] offset:6464
 v_readfirstlane_b32 s21, v29
 s_cmp_ge_u32 s21, 32
 s_cbranch_scc1 kvz_126
 s_mov_b32 s21, 76
 v_mov_b32 v4, 0
 s_mov_b32 s101, 0
wf_127:
 buffer_load_dword v5, v4, s[64:67], s21 offen sc1
 s_add_u32 s101, s101, 1
 s_cmp_gt_u32 s101, 131072
 s_cbranch_scc1 main_end
 s_waitcnt vmcnt(0)
 v_readfirstlane_b32 s100, v5
 s_cmp_ge_u32 s100, 32
 s_cbranch_scc1 wf_128
 s_sleep 8
 s_branch wf_127
wf_128:
kvz_126:
 s_branch kvm_end_125
kvm_blk_124:
 v_mfma_f32_16x16x32_bf16 v[64:67], a[0:3], v[160:163], 0
 ds_read_b128 v[192:195], v19 offset:0
 v_mfma_f32_16x16x32_bf16 v[68:71], a[4:7], v[160:163], 0
 v_add_u32 v18, s33, v14
 v_mfma_f32_16x16x32_bf16 v[72:75], a[8:11], v[160:163], 0
 v_mfma_f32_16x16x32_bf16 v[76:79], a[0:3], v[164:167], 0
 ds_read_b128 v[196:199], v19 offset:2048
 v_mfma_f32_16x16x32_bf16 v[80:83], a[4:7], v[164:167], 0
 buffer_load_dwordx4 v11, s[8:11], s30 offen offset:1024 lds
 v_mfma_f32_16x16x32_bf16 v[84:87], a[8:11], v[164:167], 0
 s_waitcnt lgkmcnt(11)
 s_add_u32 s30, s30, 128
 v_mfma_f32_16x16x32_bf16 v[88:91], a[0:3], v[168:171], 0
 ds_read_b128 v[200:203], v19 offset:4096
 s_add_u32 m0, m0, 8192
 v_mfma_f32_16x16x32_bf16 v[92:95], a[4:7], v[168:171], 0
 s_cmp_lt_u32 m0, s46
 s_cselect_b32 m0, m0, s47
 v_mfma_f32_16x16x32_bf16 v[96:99], a[8:11], v[168:171], 0
 v_mfma_f32_16x16x32_bf16 v[100:103], a[0:3], v[172:175], 0
 ds_read_b128 v[204:207], v19 offset:6144
 v_mfma_f32_16x16x32_bf16 v[104:107], a[4:7], v[172:175], 0
 v_mfma_f32_16x16x32_bf16 v[108:111], a[8:11], v[172:175], 0
 s_waitcnt vmcnt(14) lgkmcnt(2)
 s_barrier
 v_mfma_f32_16x16x32_bf16 v[64:67], a[12:15], v[192:195], v[64:67]
 ds_read_b128 v[160:163], v18 offset:0
 v_mfma_f32_16x16x32_bf16 v[68:71], a[16:19], v[192:195], v[68:71]
 v_mfma_f32_16x16x32_bf16 v[72:75], a[20:23], v[192:195], v[72:75]
 v_add_u32 v19, s33, v15
 s_add_u32 s33, s33, 8192
 v_mfma_f32_16x16x32_bf16 v[76:79], a[12:15], v[196:199], v[76:79]
 ds_read_b128 v[164:167], v18 offset:2048
 v_mfma_f32_16x16x32_bf16 v[80:83], a[16:19], v[196:199], v[80:83]
 buffer_load_dwordx4 v10, s[8:11], s30 offen offset:0 lds
 v_mfma_f32_16x16x32_bf16 v[84:87], a[20:23], v[196:199], v[84:87]
 s_waitcnt lgkmcnt(2)
 v_mfma_f32_16x16x32_bf16 v[88:91], a[12:15], v[200:203], v[88:91]
 ds_read_b128 v[168:171], v18 offset:4096
 v_mfma_f32_16x16x32_bf16 v[92:95], a[16:19], v[200:203], v[92:95]
 s_cmp_lt_u32 s33, 155648
 s_cselect_b32 s33, s33, 98304
 v_mfma_f32_16x16x32_bf16 v[96:99], a[20:23], v[200:203], v[96:99]
 v_mfma_f32_16x16x32_bf16 v[100:103], a[12:15], v[204:207], v[100:103]
 ds_read_b128 v[172:175], v18 offset:6144
 v_mfma_f32_16x16x32_bf16 v[104:107], a[16:19], v[204:207], v[104:107]
 v_mfma_f32_16x16x32_bf16 v[108:111], a[20:23], v[204:207], v[108:111]
 s_waitcnt lgkmcnt(2)
 v_mfma_f32_16x16x32_bf16 v[64:67], a[24:27], v[160:163], v[64:67]
 ds_read_b128 v[192:195], v19 offset:0
 v_mfma_f32_16x16x32_bf16 v[68:71], a[28:31], v[160:163], v[68:71]
 v_add_u32 v18, s33, v14
 v_mfma_f32_16x16x32_bf16 v[72:75], a[32:35], v[160:163], v[72:75]
 v_mfma_f32_16x16x32_bf16 v[76:79], a[24:27], v[164:167], v[76:79]
 ds_read_b128 v[196:199], v19 offset:2048
 v_mfma_f32_16x16x32_bf16 v[80:83], a[28:31], v[164:167], v[80:83]
 buffer_load_dwordx4 v11, s[8:11], s30 offen offset:1024 lds
 v_mfma_f32_16x16x32_bf16 v[84:87], a[32:35], v[164:167], v[84:87]
 s_waitcnt lgkmcnt(2)
 s_add_u32 s30, s30, 128
 v_mfma_f32_16x16x32_bf16 v[88:91], a[24:27], v[168:171], v[88:91]
 ds_read_b128 v[200:203], v19 offset:4096
 s_add_u32 m0, m0, 8192
 v_mfma_f32_16x16x32_bf16 v[92:95], a[28:31], v[168:171], v[92:95]
 s_cmp_lt_u32 m0, s46
 s_cselect_b32 m0, m0, s47
 v_mfma_f32_16x16x32_bf16 v[96:99], a[32:35], v[168:171], v[96:99]
 v_mfma_f32_16x16x32_bf16 v[100:103], a[24:27], v[172:175], v[100:103]
 ds_read_b128 v[204:207], v19 offset:6144
 v_mfma_f32_16x16x32_bf16 v[104:107], a[28:31], v[172:175], v[104:107]
 v_mfma_f32_16x16x32_bf16 v[108:111], a[32:35], v[172:175], v[108:111]
 s_waitcnt vmcnt(14) lgkmcnt(2)
 s_barrier
 v_mfma_f32_16x16x32_bf16 v[64:67], a[36:39], v[192:195], v[64:67]
 ds_read_b128 v[160:163], v18 offset:0
 v_mfma_f32_16x16x32_bf16 v[68:71], a[40:43], v[192:195], v[68:71]
 v_mfma_f32_16x16x32_bf16 v[72:75], a[44:47], v[192:195], v[72:75]
 v_add_u32 v19, s33, v15
 s_add_u32 s33, s33, 8192
 v_mfma_f32_16x16x32_bf16 v[76:79], a[36:39], v[196:199], v[76:79]
 ds_read_b128 v[164:167], v18 offset:2048
 v_mfma_f32_16x16x32_bf16 v[80:83], a[40:43], v[196:199], v[80:83]
 buffer_load_dwordx4 v10, s[8:11], s30 offen offset:0 lds
 v_mfma_f32_16x16x32_bf16 v[84:87], a[44:47], v[196:199], v[84:87]
 s_waitcnt lgkmcnt(2)
 v_mfma_f32_16x16x32_bf16 v[88:91], a[36:39], v[200:203], v[88:91]
 ds_read_b128 v[168:171], v18 offset:4096
 v_mfma_f32_16x16x32_bf16 v[92:95], a[40:43], v[200:203], v[92:95]
 s_cmp_lt_u32 s33, 155648
 s_cselect_b32 s33, s33, 98304
 v_mfma_f32_16x16x32_bf16 v[96:99], a[44:47], v[200:203], v[96:99]
 v_mfma_f32_16x16x32_bf16 v[100:103], a[36:39], v[204:207], v[100:103]
 ds_read_b128 v[172:175], v18 offset:6144
 v_mfma_f32_16x16x32_bf16 v[104:107], a[40:43], v[204:207], v[104:107]
 v_mfma_f32_16x16x32_bf16 v[108:111], a[44:47], v[204:207], v[108:111]
 s_waitcnt lgkmcnt(2)
 v_mfma_f32_16x16x32_bf16 v[64:67], a[48:51], v[160:163], v[64:67]
 ds_read_b128 v[192:195], v19 offset:0
 v_mfma_f32_16x16x32_bf16 v[68:71], a[52:55], v[160:163], v[68:71]
 v_add_u32 v18, s33, v14
 v_mfma_f32_16x16x32_bf16 v[72:75], a[56:59], v[160:163], v[72:75]
 v_mfma_f32_16x16x32_bf16 v[76:79], a[48:51], v[164:167], v[76:79]
 ds_read_b128 v[196:199], v19 offset:2048
 v_mfma_f32_16x16x32_bf16 v[80:83], a[52:55], v[164:167], v[80:83]
 buffer_load_dwordx4 v11, s[8:11], s30 offen offset:1024 lds
 v_mfma_f32_16x16x32_bf16 v[84:87], a[56:59], v[164:167], v[84:87]
 s_waitcnt lgkmcnt(2)
 s_add_u32 s30, s30, 128
 v_mfma_f32_16x16x32_bf16 v[88:91], a[48:51], v[168:171], v[88:91]
 ds_read_b128 v[200:203], v19 offset:4096
 s_add_u32 m0, m0, 8192
 v_mfma_f32_16x16x32_bf16 v[92:95], a[52:55], v[168:171], v[92:95]
 s_cmp_lt_u32 m0, s46
 s_cselect_b32 m0, m0, s47
 v_mfma_f32_16x16x32_bf16 v[96:99], a[56:59], v[168:171], v[96:99]
 v_mfma_f32_16x16x32_bf16 v[100:103], a[48:51], v[172:175], v[100:103]
 ds_read_b128 v[204:207], v19 offset:6144
 v_mfma_f32_16x16x32_bf16 v[104:107], a[52:55], v[172:175], v[104:107]
 v_mfma_f32_16x16x32_bf16 v[108:111], a[56:59], v[172:175], v[108:111]
 s_waitcnt vmcnt(14) lgkmcnt(2)
 s_barrier
 v_mfma_f32_16x16x32_bf16 v[64:67], a[60:63], v[192:195], v[64:67]
 ds_read_b128 v[160:163], v18 offset:0
 v_mfma_f32_16x16x32_bf16 v[68:71], a[64:67], v[192:195], v[68:71]
 v_mfma_f32_16x16x32_bf16 v[72:75], a[68:71], v[192:195], v[72:75]
 v_add_u32 v19, s33, v15
 s_add_u32 s33, s33, 8192
 v_mfma_f32_16x16x32_bf16 v[76:79], a[60:63], v[196:199], v[76:79]
 ds_read_b128 v[164:167], v18 offset:2048
 v_mfma_f32_16x16x32_bf16 v[80:83], a[64:67], v[196:199], v[80:83]
 buffer_load_dwordx4 v10, s[8:11], s30 offen offset:0 lds
 v_mfma_f32_16x16x32_bf16 v[84:87], a[68:71], v[196:199], v[84:87]
 s_waitcnt lgkmcnt(2)
 v_mfma_f32_16x16x32_bf16 v[88:91], a[60:63], v[200:203], v[88:91]
 ds_read_b128 v[168:171], v18 offset:4096
 v_mfma_f32_16x16x32_bf16 v[92:95], a[64:67], v[200:203], v[92:95]
 s_cmp_lt_u32 s33, 155648
 s_cselect_b32 s33, s33, 98304
 v_mfma_f32_16x16x32_bf16 v[96:99], a[68:71], v[200:203], v[96:99]
 v_mfma_f32_16x16x32_bf16 v[100:103], a[60:63], v[204:207], v[100:103]
 ds_read_b128 v[172:175], v18 offset:6144
 v_mfma_f32_16x16x32_bf16 v[104:107], a[64:67], v[204:207], v[104:107]
 v_mfma_f32_16x16x32_bf16 v[108:111], a[68:71], v[204:207], v[108:111]
 s_waitcnt lgkmcnt(2)
 v_mfma_f32_16x16x32_bf16 v[64:67], a[72:75], v[160:163], v[64:67]
 ds_read_b128 v[192:195], v19 offset:0
 v_mfma_f32_16x16x32_bf16 v[68:71], a[76:79], v[160:163], v[68:71]
 v_add_u32 v18, s33, v14
 v_mfma_f32_16x16x32_bf16 v[72:75], a[80:83], v[160:163], v[72:75]
 v_mfma_f32_16x16x32_bf16 v[76:79], a[72:75], v[164:167], v[76:79]
 ds_read_b128 v[196:199], v19 offset:2048
 v_mfma_f32_16x16x32_bf16 v[80:83], a[76:79], v[164:167], v[80:83]
 buffer_load_dwordx4 v11, s[8:11], s30 offen offset:1024 lds
 v_mfma_f32_16x16x32_bf16 v[84:87], a[80:83], v[164:167], v[84:87]
 s_waitcnt lgkmcnt(2)
 s_add_u32 s30, s30, 128
 v_mfma_f32_16x16x32_bf16 v[88:91], a[72:75], v[168:171], v[88:91]
 ds_read_b128 v[200:203], v19 offset:4096
 s_add_u32 m0, m0, 8192
 v_mfma_f32_16x16x32_bf16 v[92:95], a[76:79], v[168:171], v[92:95]
 s_cmp_lt_u32 m0, s46
 s_cselect_b32 m0, m0, s47
 v_mfma_f32_16x16x32_bf16 v[96:99], a[80:83], v[168:171], v[96:99]
 v_mfma_f32_16x16x32_bf16 v[100:103], a[72:75], v[172:175], v[100:103]
 ds_read_b128 v[204:207], v19 offset:6144
 v_mfma_f32_16x16x32_bf16 v[104:107], a[76:79], v[172:175], v[104:107]
 v_mfma_f32_16x16x32_bf16 v[108:111], a[80:83], v[172:175], v[108:111]
 s_waitcnt vmcnt(7) lgkmcnt(2)
 s_barrier
 v_mfma_f32_16x16x32_bf16 v[64:67], a[84:87], v[192:195], v[64:67]
 ds_read_b128 v[160:163], v18 offset:0
 v_mfma_f32_16x16x32_bf16 v[68:71], a[88:91], v[192:195], v[68:71]
 s_cmp_eq_u32 s48, 0x80000000
 s_cbranch_scc1 kvm_122
 s_cmp_lg_u32 s20, 0
 s_cbranch_scc1 af_123
 v_mov_b32 v4, 0
 v_mov_b32 v5, 1
 s_mov_b64 exec, 1
 buffer_atomic_add v5, v4, s[72:75], s61 offen sc1
 s_mov_b64 exec, -1
 s_nop 1
af_123:
kvm_122:
 v_mfma_f32_16x16x32_bf16 v[72:75], a[92:95], v[192:195], v[72:75]
 v_add_u32 v19, s33, v15
 s_add_u32 s33, s33, 8192
 v_mfma_f32_16x16x32_bf16 v[76:79], a[84:87], v[196:199], v[76:79]
 ds_read_b128 v[164:167], v18 offset:2048
 v_mfma_f32_16x16x32_bf16 v[80:83], a[88:91], v[196:199], v[80:83]
 buffer_load_dwordx4 v10, s[8:11], s30 offen offset:0 lds
 v_mfma_f32_16x16x32_bf16 v[84:87], a[92:95], v[196:199], v[84:87]
 s_waitcnt lgkmcnt(2)
 v_mfma_f32_16x16x32_bf16 v[88:91], a[84:87], v[200:203], v[88:91]
 ds_read_b128 v[168:171], v18 offset:4096
 v_mfma_f32_16x16x32_bf16 v[92:95], a[88:91], v[200:203], v[92:95]
 s_cmp_lt_u32 s33, 155648
 s_cselect_b32 s33, s33, 98304
 v_mfma_f32_16x16x32_bf16 v[96:99], a[92:95], v[200:203], v[96:99]
 v_mfma_f32_16x16x32_bf16 v[100:103], a[84:87], v[204:207], v[100:103]
 ds_read_b128 v[172:175], v18 offset:6144
 v_mfma_f32_16x16x32_bf16 v[104:107], a[88:91], v[204:207], v[104:107]
 v_mfma_f32_16x16x32_bf16 v[108:111], a[92:95], v[204:207], v[108:111]
 s_waitcnt lgkmcnt(2)
 v_mfma_f32_16x16x32_bf16 v[64:67], a[96:99], v[160:163], v[64:67]
 ds_read_b128 v[192:195], v19 offset:0
 v_mfma_f32_16x16x32_bf16 v[68:71], a[100:103], v[160:163], v[68:71]
 v_add_u32 v18, s33, v14
 s_mov_b32 s61, s60
 v_mfma_f32_16x16x32_bf16 v[72:75], a[104:107], v[160:163], v[72:75]
 s_add_u32 s60, s60, s62
 s_lshr_b32 s48, s20, 1
 v_mfma_f32_16x16x32_bf16 v[76:79], a[96:99], v[164:167], v[76:79]
 ds_read_b128 v[196:199], v19 offset:2048
 s_mul_i32 s48, s48, 393216
 v_mfma_f32_16x16x32_bf16 v[80:83], a[100:103], v[164:167], v[80:83]
 buffer_load_dwordx4 v11, s[8:11], s30 offen offset:1024 lds
 v_mfma_f32_16x16x32_bf16 v[84:87], a[104:107], v[164:167], v[84:87]
 s_waitcnt lgkmcnt(2)
 s_add_u32 s30, s30, s25
 v_mfma_f32_16x16x32_bf16 v[88:91], a[96:99], v[168:171], v[88:91]
 ds_read_b128 v[200:203], v19 offset:4096
 s_sub_u32 s30, s30, 1152
 v_mfma_f32_16x16x32_bf16 v[92:95], a[100:103], v[168:171], v[92:95]
 s_add_u32 m0, m0, 8192
 s_and_b32 s21, s20, 1
 v_mfma_f32_16x16x32_bf16 v[96:99], a[104:107], v[168:171], v[96:99]
 s_cmp_lt_u32 m0, s46
 s_cselect_b32 m0, m0, s47
 v_mfma_f32_16x16x32_bf16 v[100:103], a[96:99], v[172:175], v[100:103]
 ds_read_b128 v[204:207], v19 offset:6144
 s_mul_i32 s21, s21, 6144
 v_mfma_f32_16x16x32_bf16 v[104:107], a[100:103], v[172:175], v[104:107]
 s_add_u32 s48, s48, s21
 s_add_u32 s48, s48, s27
 v_mfma_f32_16x16x32_bf16 v[108:111], a[104:107], v[172:175], v[108:111]
 s_waitcnt vmcnt(8) lgkmcnt(2)
 s_barrier
 v_mfma_f32_16x16x32_bf16 v[64:67], a[108:111], v[192:195], v[64:67]
 ds_read_b128 v[160:163], v18 offset:0
 s_add_u32 s27, s27, s28
 v_mfma_f32_16x16x32_bf16 v[68:71], a[112:115], v[192:195], v[68:71]
 s_sub_u32 s26, s26, 1
 v_mfma_f32_16x16x32_bf16 v[72:75], a[116:119], v[192:195], v[72:75]
 v_add_u32 v19, s33, v15
 s_add_u32 s33, s33, 8192
 v_mfma_f32_16x16x32_bf16 v[76:79], a[108:111], v[196:199], v[76:79]
 ds_read_b128 v[164:167], v18 offset:2048
 v_mfma_f32_16x16x32_bf16 v[80:83], a[112:115], v[196:199], v[80:83]
 buffer_load_dwordx4 v10, s[8:11], s30 offen offset:0 lds
 v_mfma_f32_16x16x32_bf16 v[84:87], a[116:119], v[196:199], v[84:87]
 s_waitcnt lgkmcnt(2)
 v_mfma_f32_16x16x32_bf16 v[88:91], a[108:111], v[200:203], v[88:91]
 ds_read_b128 v[168:171], v18 offset:4096
 v_mfma_f32_16x16x32_bf16 v[92:95], a[112:115], v[200:203], v[92:95]
 s_cmp_lt_u32 s33, 155648
 s_cselect_b32 s33, s33, 98304
 v_mfma_f32_16x16x32_bf16 v[96:99], a[116:119], v[200:203], v[96:99]
 v_mfma_f32_16x16x32_bf16 v[100:103], a[108:111], v[204:207], v[100:103]
 ds_read_b128 v[172:175], v18 offset:6144
 v_mfma_f32_16x16x32_bf16 v[104:107], a[112:115], v[204:207], v[104:107]
 v_mfma_f32_16x16x32_bf16 v[108:111], a[116:119], v[204:207], v[108:111]
 s_waitcnt lgkmcnt(2)
 v_mfma_f32_16x16x32_bf16 v[64:67], a[120:123], v[160:163], v[64:67]
 ds_read_b128 v[192:195], v19 offset:0
 v_mfma_f32_16x16x32_bf16 v[68:71], a[124:127], v[160:163], v[68:71]
 v_add_u32 v18, s33, v14
 v_mfma_f32_16x16x32_bf16 v[72:75], a[128:131], v[160:163], v[72:75]
 v_mfma_f32_16x16x32_bf16 v[76:79], a[120:123], v[164:167], v[76:79]
 ds_read_b128 v[196:199], v19 offset:2048
 v_mfma_f32_16x16x32_bf16 v[80:83], a[124:127], v[164:167], v[80:83]
 buffer_load_dwordx4 v11, s[8:11], s30 offen offset:1024 lds
 v_mfma_f32_16x16x32_bf16 v[84:87], a[128:131], v[164:167], v[84:87]
 s_waitcnt lgkmcnt(2)
 s_add_u32 s30, s30, 128
 v_mfma_f32_16x16x32_bf16 v[88:91], a[120:123], v[168:171], v[88:91]
 ds_read_b128 v[200:203], v19 offset:4096
 s_add_u32 m0, m0, 8192
 v_mfma_f32_16x16x32_bf16 v[92:95], a[124:127], v[168:171], v[92:95]
 s_cmp_lt_u32 m0, s46
 s_cselect_b32 m0, m0, s47
 v_mfma_f32_16x16x32_bf16 v[96:99], a[128:131], v[168:171], v[96:99]
 v_mfma_f32_16x16x32_bf16 v[100:103], a[120:123], v[172:175], v[100:103]
 ds_read_b128 v[204:207], v19 offset:6144
 v_mfma_f32_16x16x32_bf16 v[104:107], a[124:127], v[172:175], v[104:107]
 v_mfma_f32_16x16x32_bf16 v[108:111], a[128:131], v[172:175], v[108:111]
 s_waitcnt vmcnt(8) lgkmcnt(2)
 s_barrier
 v_mfma_f32_16x16x32_bf16 v[64:67], a[132:135], v[192:195], v[64:67]
 ds_read_b128 v[160:163], v18 offset:0
 v_mfma_f32_16x16x32_bf16 v[68:71], a[136:139], v[192:195], v[68:71]
 v_mfma_f32_16x16x32_bf16 v[72:75], a[140:143], v[192:195], v[72:75]
 v_add_u32 v19, s33, v15
 s_add_u32 s33, s33, 8192
 v_mfma_f32_16x16x32_bf16 v[76:79], a[132:135], v[196:199], v[76:79]
 ds_read_b128 v[164:167], v18 offset:2048
 v_mfma_f32_16x16x32_bf16 v[80:83], a[136:139], v[196:199], v[80:83]
 buffer_load_dwordx4 v10, s[8:11], s30 offen offset:0 lds
 v_mfma_f32_16x16x32_bf16 v[84:87], a[140:143], v[196:199], v[84:87]
 s_waitcnt lgkmcnt(2)
 v_mfma_f32_16x16x32_bf16 v[88:91], a[132:135], v[200:203], v[88:91]
 ds_read_b128 v[168:171], v18 offset:4096
 v_mfma_f32_16x16x32_bf16 v[92:95], a[136:139], v[200:203], v[92:95]
 s_cmp_lt_u32 s33, 155648
 s_cselect_b32 s33, s33, 98304
 v_mfma_f32_16x16x32_bf16 v[96:99], a[140:143], v[200:203], v[96:99]
 v_mfma_f32_16x16x32_bf16 v[100:103], a[132:135], v[204:207], v[100:103]
 ds_read_b128 v[172:175], v18 offset:6144
 v_mfma_f32_16x16x32_bf16 v[104:107], a[136:139], v[204:207], v[104:107]
 v_mfma_f32_16x16x32_bf16 v[108:111], a[140:143], v[204:207], v[108:111]
 s_waitcnt lgkmcnt(2)
 v_mfma_f32_16x16x32_bf16 v[64:67], a[144:147], v[160:163], v[64:67]
 ds_read_b128 v[192:195], v19 offset:0
 v_mfma_f32_16x16x32_bf16 v[68:71], a[148:151], v[160:163], v[68:71]
 v_add_u32 v18, s33, v14
 v_mfma_f32_16x16x32_bf16 v[72:75], a[152:155], v[160:163], v[72:75]
 v_mfma_f32_16x16x32_bf16 v[76:79], a[144:147], v[164:167], v[76:79]
 ds_read_b128 v[196:199], v19 offset:2048
 v_mfma_f32_16x16x32_bf16 v[80:83], a[148:151], v[164:167], v[80:83]
 buffer_load_dwordx4 v11, s[8:11], s30 offen offset:1024 lds
 v_mfma_f32_16x16x32_bf16 v[84:87], a[152:155], v[164:167], v[84:87]
 s_waitcnt lgkmcnt(2)
 s_add_u32 s30, s30, 128
 v_mfma_f32_16x16x32_bf16 v[88:91], a[144:147], v[168:171], v[88:91]
 ds_read_b128 v[200:203], v19 offset:4096
 s_add_u32 m0, m0, 8192
 v_mfma_f32_16x16x32_bf16 v[92:95], a[148:151], v[168:171], v[92:95]
 s_cmp_lt_u32 m0, s46
 s_cselect_b32 m0, m0, s47
 v_mfma_f32_16x16x32_bf16 v[96:99], a[152:155], v[168:171], v[96:99]
 v_mfma_f32_16x16x32_bf16 v[100:103], a[144:147], v[172:175], v[100:103]
 ds_read_b128 v[204:207], v19 offset:6144
 v_mfma_f32_16x16x32_bf16 v[104:107], a[148:151], v[172:175], v[104:107]
 v_mfma_f32_16x16x32_bf16 v[108:111], a[152:155], v[172:175], v[108:111]
 s_waitcnt vmcnt(8) lgkmcnt(2)
 s_barrier
 v_mfma_f32_16x16x32_bf16 v[64:67], a[156:159], v[192:195], v[64:67]
 ds_read_b128 v[160:163], v18 offset:0
 v_mfma_f32_16x16x32_bf16 v[68:71], a[160:163], v[192:195], v[68:71]
 v_mfma_f32_16x16x32_bf16 v[72:75], a[164:167], v[192:195], v[72:75]
 v_add_u32 v19, s33, v15
 s_add_u32 s33, s33, 8192
 v_mfma_f32_16x16x32_bf16 v[76:79], a[156:159], v[196:199], v[76:79]
 ds_read_b128 v[164:167], v18 offset:2048
 v_mfma_f32_16x16x32_bf16 v[80:83], a[160:163], v[196:199], v[80:83]
 buffer_load_dwordx4 v10, s[8:11], s30 offen offset:0 lds
 v_mfma_f32_16x16x32_bf16 v[84:87], a[164:167], v[196:199], v[84:87]
 s_waitcnt lgkmcnt(2)
 v_mfma_f32_16x16x32_bf16 v[88:91], a[156:159], v[200:203], v[88:91]
 ds_read_b128 v[168:171], v18 offset:4096
 v_mfma_f32_16x16x32_bf16 v[92:95], a[160:163], v[200:203], v[92:95]
 s_cmp_lt_u32 s33, 155648
 s_cselect_b32 s33, s33, 98304
 v_mfma_f32_16x16x32_bf16 v[96:99], a[164:167], v[200:203], v[96:99]
 v_mfma_f32_16x16x32_bf16 v[100:103], a[156:159], v[204:207], v[100:103]
 ds_read_b128 v[172:175], v18 offset:6144
 v_mfma_f32_16x16x32_bf16 v[104:107], a[160:163], v[204:207], v[104:107]
 v_mfma_f32_16x16x32_bf16 v[108:111], a[164:167], v[204:207], v[108:111]
 s_waitcnt lgkmcnt(2)
 v_mfma_f32_16x16x32_bf16 v[64:67], a[168:171], v[160:163], v[64:67]
 ds_read_b128 v[192:195], v19 offset:0
 v_mfma_f32_16x16x32_bf16 v[68:71], a[172:175], v[160:163], v[68:71]
 v_add_u32 v18, s33, v14
 v_mfma_f32_16x16x32_bf16 v[72:75], a[176:179], v[160:163], v[72:75]
 v_mfma_f32_16x16x32_bf16 v[76:79], a[168:171], v[164:167], v[76:79]
 ds_read_b128 v[196:199], v19 offset:2048
 v_mfma_f32_16x16x32_bf16 v[80:83], a[172:175], v[164:167], v[80:83]
 buffer_load_dwordx4 v11, s[8:11], s30 offen offset:1024 lds
 v_mfma_f32_16x16x32_bf16 v[84:87], a[176:179], v[164:167], v[84:87]
 s_waitcnt lgkmcnt(2)
 s_add_u32 s30, s30, 128
 v_mfma_f32_16x16x32_bf16 v[88:91], a[168:171], v[168:171], v[88:91]
 ds_read_b128 v[200:203], v19 offset:4096
 s_add_u32 m0, m0, 8192
 v_mfma_f32_16x16x32_bf16 v[92:95], a[172:175], v[168:171], v[92:95]
 s_cmp_lt_u32 m0, s46
 s_cselect_b32 m0, m0, s47
 v_mfma_f32_16x16x32_bf16 v[96:99], a[176:179], v[168:171], v[96:99]
 v_mfma_f32_16x16x32_bf16 v[100:103], a[168:171], v[172:175], v[100:103]
 ds_read_b128 v[204:207], v19 offset:6144
 v_mfma_f32_16x16x32_bf16 v[104:107], a[172:175], v[172:175], v[104:107]
 v_mfma_f32_16x16x32_bf16 v[108:111], a[176:179], v[172:175], v[108:111]
 s_waitcnt vmcnt(8) lgkmcnt(2)
 s_barrier
 v_mfma_f32_16x16x32_bf16 v[64:67], a[180:183], v[192:195], v[64:67]
 ds_read_b128 v[160:163], v18 offset:0
 v_mfma_f32_16x16x32_bf16 v[68:71], a[184:187], v[192:195], v[68:71]
 v_mfma_f32_16x16x32_bf16 v[72:75], a[188:191], v[192:195], v[72:75]
 v_add_u32 v19, s33, v15
 s_add_u32 s33, s33, 8192
 v_mfma_f32_16x16x32_bf16 v[76:79], a[180:183], v[196:199], v[76:79]
 ds_read_b128 v[164:167], v18 offset:2048
 v_mfma_f32_16x16x32_bf16 v[80:83], a[184:187], v[196:199], v[80:83]
 buffer_load_dwordx4 v10, s[8:11], s30 offen offset:0 lds
 v_mfma_f32_16x16x32_bf16 v[84:87], a[188:191], v[196:199], v[84:87]
 s_waitcnt lgkmcnt(2)
 v_mfma_f32_16x16x32_bf16 v[88:91], a[180:183], v[200:203], v[88:91]
 ds_read_b128 v[168:171], v18 offset:4096
 v_mfma_f32_16x16x32_bf16 v[92:95], a[184:187], v[200:203], v[92:95]
 s_cmp_lt_u32 s33, 155648
 s_cselect_b32 s33, s33, 98304
 v_mfma_f32_16x16x32_bf16 v[96:99], a[188:191], v[200:203], v[96:99]
 v_mfma_f32_16x16x32_bf16 v[100:103], a[180:183], v[204:207], v[100:103]
 ds_read_b128 v[172:175], v18 offset:6144
 v_mfma_f32_16x16x32_bf16 v[104:107], a[184:187], v[204:207], v[104:107]
 v_mfma_f32_16x16x32_bf16 v[108:111], a[188:191], v[204:207], v[108:111]
 s_waitcnt lgkmcnt(2)
 v_mfma_f32_16x16x32_bf16 v[64:67], a[192:195], v[160:163], v[64:67]
 ds_read_b128 v[192:195], v19 offset:0
 v_mfma_f32_16x16x32_bf16 v[68:71], a[196:199], v[160:163], v[68:71]
 v_add_u32 v18, s33, v14
 v_mfma_f32_16x16x32_bf16 v[72:75], a[200:203], v[160:163], v[72:75]
 v_mfma_f32_16x16x32_bf16 v[76:79], a[192:195], v[164:167], v[76:79]
 ds_read_b128 v[196:199], v19 offset:2048
 v_mfma_f32_16x16x32_bf16 v[80:83], a[196:199], v[164:167], v[80:83]
 buffer_load_dwordx4 v11, s[8:11], s30 offen offset:1024 lds
 v_mfma_f32_16x16x32_bf16 v[84:87], a[200:203], v[164:167], v[84:87]
 s_waitcnt lgkmcnt(2)
 s_add_u32 s30, s30, 128
 v_mfma_f32_16x16x32_bf16 v[88:91], a[192:195], v[168:171], v[88:91]
 ds_read_b128 v[200:203], v19 offset:4096
 s_add_u32 m0, m0, 8192
 v_mfma_f32_16x16x32_bf16 v[92:95], a[196:199], v[168:171], v[92:95]
 s_cmp_lt_u32 m0, s46
 s_cselect_b32 m0, m0, s47
 v_mfma_f32_16x16x32_bf16 v[96:99], a[200:203], v[168:171], v[96:99]
 v_mfma_f32_16x16x32_bf16 v[100:103], a[192:195], v[172:175], v[100:103]
 ds_read_b128 v[204:207], v19 offset:6144
 v_mfma_f32_16x16x32_bf16 v[104:107], a[196:199], v[172:175], v[104:107]
 v_mfma_f32_16x16x32_bf16 v[108:111], a[200:203], v[172:175], v[108:111]
 s_waitcnt vmcnt(8) lgkmcnt(2)
 s_barrier
 v_mfma_f32_16x16x32_bf16 v[64:67], a[204:207], v[192:195], v[64:67]
 ds_read_b128 v[160:163], v18 offset:0
 v_mfma_f32_16x16x32_bf16 v[68:71], a[208:211], v[192:195], v[68:71]
 v_mfma_f32_16x16x32_bf16 v[72:75], a[212:215], v[192:195], v[72:75]
 v_add_u32 v19, s33, v15
 s_add_u32 s33, s33, 8192
 v_mfma_f32_16x16x32_bf16 v[76:79], a[204:207], v[196:199], v[76:79]
 ds_read_b128 v[164:167], v18 offset:2048
 v_mfma_f32_16x16x32_bf16 v[80:83], a[208:211], v[196:199], v[80:83]
 buffer_load_dwordx4 v10, s[8:11], s30 offen offset:0 lds
 v_mfma_f32_16x16x32_bf16 v[84:87], a[212:215], v[196:199], v[84:87]
 s_waitcnt lgkmcnt(2)
 v_mfma_f32_16x16x32_bf16 v[88:91], a[204:207], v[200:203], v[88:91]
 ds_read_b128 v[168:171], v18 offset:4096
 v_mfma_f32_16x16x32_bf16 v[92:95], a[208:211], v[200:203], v[92:95]
 s_cmp_lt_u32 s33, 155648
 s_cselect_b32 s33, s33, 98304
 v_mfma_f32_16x16x32_bf16 v[96:99], a[212:215], v[200:203], v[96:99]
 v_mfma_f32_16x16x32_bf16 v[100:103], a[204:207], v[204:207], v[100:103]
 ds_read_b128 v[172:175], v18 offset:6144
 v_mfma_f32_16x16x32_bf16 v[104:107], a[208:211], v[204:207], v[104:107]
 v_mfma_f32_16x16x32_bf16 v[108:111], a[212:215], v[204:207], v[108:111]
 s_waitcnt lgkmcnt(2)
 v_mfma_f32_16x16x32_bf16 v[64:67], a[216:219], v[160:163], v[64:67]
 ds_read_b128 v[192:195], v19 offset:0
 v_mfma_f32_16x16x32_bf16 v[68:71], a[220:223], v[160:163], v[68:71]
 v_add_u32 v18, s33, v14
 v_mfma_f32_16x16x32_bf16 v[72:75], a[224:227], v[160:163], v[72:75]
 v_mfma_f32_16x16x32_bf16 v[76:79], a[216:219], v[164:167], v[76:79]
 ds_read_b128 v[196:199], v19 offset:2048
 v_mfma_f32_16x16x32_bf16 v[80:83], a[220:223], v[164:167], v[80:83]
 buffer_load_dwordx4 v11, s[8:11], s30 offen offset:1024 lds
 v_mfma_f32_16x16x32_bf16 v[84:87], a[224:227], v[164:167], v[84:87]
 s_waitcnt lgkmcnt(2)
 s_add_u32 s30, s30, 128
 v_mfma_f32_16x16x32_bf16 v[88:91], a[216:219], v[168:171], v[88:91]
 ds_read_b128 v[200:203], v19 offset:4096
 s_add_u32 m0, m0, 8192
 v_mfma_f32_16x16x32_bf16 v[92:95], a[220:223], v[168:171], v[92:95]
 s_cmp_lt_u32 m0, s46
 s_cselect_b32 m0, m0, s47
 v_mfma_f32_16x16x32_bf16 v[96:99], a[224:227], v[168:171], v[96:99]
 v_mfma_f32_16x16x32_bf16 v[100:103], a[216:219], v[172:175], v[100:103]
 ds_read_b128 v[204:207], v19 offset:6144
 v_mfma_f32_16x16x32_bf16 v[104:107], a[220:223], v[172:175], v[104:107]
 v_mfma_f32_16x16x32_bf16 v[108:111], a[224:227], v[172:175], v[108:111]
 s_waitcnt vmcnt(8) lgkmcnt(2)
 s_barrier
 v_mfma_f32_16x16x32_bf16 v[64:67], a[228:231], v[192:195], v[64:67]
 ds_read_b128 v[160:163], v18 offset:0
 v_mfma_f32_16x16x32_bf16 v[68:71], a[232:235], v[192:195], v[68:71]
 v_mfma_f32_16x16x32_bf16 v[72:75], a[236:239], v[192:195], v[72:75]
 v_add_u32 v19, s33, v15
 s_add_u32 s33, s33, 8192
 v_mfma_f32_16x16x32_bf16 v[76:79], a[228:231], v[196:199], v[76:79]
 ds_read_b128 v[164:167], v18 offset:2048
 v_cvt_pk_bf16_f32 v224, v64, v65
 v_cvt_pk_bf16_f32 v225, v66, v67
 v_mfma_f32_16x16x32_bf16 v[80:83], a[232:235], v[196:199], v[80:83]
 buffer_load_dwordx4 v10, s[8:11], s30 offen offset:0 lds
 v_cvt_pk_bf16_f32 v226, v68, v69
 v_cvt_pk_bf16_f32 v227, v70, v71
 v_mfma_f32_16x16x32_bf16 v[84:87], a[236:239], v[196:199], v[84:87]
 s_waitcnt lgkmcnt(2)
 v_cvt_pk_bf16_f32 v228, v72, v73
 v_cvt_pk_bf16_f32 v229, v74, v75
 v_mfma_f32_16x16x32_bf16 v[88:91], a[228:231], v[200:203], v[88:91]
 ds_read_b128 v[168:171], v18 offset:4096
 ds_write_b64 v22, v[224:225] offset:0
 v_mfma_f32_16x16x32_bf16 v[92:95], a[232:235], v[200:203], v[92:95]
 s_cmp_lt_u32 s33, 155648
 s_cselect_b32 s33, s33, 98304
 ds_write_b64 v22, v[226:227] offset:8
 v_mfma_f32_16x16x32_bf16 v[96:99], a[236:239], v[200:203], v[96:99]
 ds_write_b64 v16, v[228:229] offset:64
 v_cvt_pk_bf16_f32 v230, v76, v77
 v_cvt_pk_bf16_f32 v231, v78, v79
 v_mfma_f32_16x16x32_bf16 v[100:103], a[228:231], v[204:207], v[100:103]
 ds_read_b128 v[172:175], v18 offset:6144
 v_cvt_pk_bf16_f32 v232, v80, v81
 v_cvt_pk_bf16_f32 v233, v82, v83
 v_cvt_pk_bf16_f32 v234, v84, v85
 v_mfma_f32_16x16x32_bf16 v[104:107], a[232:235], v[204:207], v[104:107]
 v_cvt_pk_bf16_f32 v235, v86, v87
 ds_write_b64 v22, v[230:231] offset:6400
 v_mfma_f32_16x16x32_bf16 v[108:111], a[236:239], v[204:207], v[108:111]
 ds_write_b64 v22, v[232:233] offset:6408
 ds_write_b64 v16, v[234:235] offset:6464
kvm_end_125:
 v_cvt_pk_bf16_f32 v236, v88, v89
 v_cvt_pk_bf16_f32 v237, v90, v91
 v_cvt_pk_bf16_f32 v238, v92, v93
 v_cvt_pk_bf16_f32 v239, v94, v95
 v_cvt_pk_bf16_f32 v240, v96, v97
 v_cvt_pk_bf16_f32 v241, v98, v99
 ds_write_b64 v22, v[236:237] offset:12800
 ds_write_b64 v22, v[238:239] offset:12808
 ds_write_b64 v16, v[240:241] offset:12864
 v_cvt_pk_bf16_f32 v242, v100, v101
 v_cvt_pk_bf16_f32 v243, v102, v103
 v_cvt_pk_bf16_f32 v244, v104, v105
 v_cvt_pk_bf16_f32 v245, v106, v107
 v_cvt_pk_bf16_f32 v246, v108, v109
 v_cvt_pk_bf16_f32 v247, v110, v111
 ds_write_b64 v22, v[242:243] offset:19200
 ds_write_b64 v22, v[244:245] offset:19208
 ds_write_b64 v16, v[246:247] offset:19264
 s_waitcnt lgkmcnt(0)
 s_barrier
 ds_read_b128 v[224:227], v23 offset:0
 ds_read_b128 v[228:231], v23 offset:64
 ds_read_b128 v[232:235], v23 offset:128
 ds_read_b128 v[236:239], v23 offset:192
 ds_read_b128 v[240:243], v23 offset:256
 ds_read_b128 v[244:247], v23 offset:320
 s_waitcnt lgkmcnt(0)
 s_add_u32 s21, s48, 0
 buffer_store_dwordx4 v[224:227], v26, s[16:19], s21 offen offset:0 sc1
 buffer_store_dwordx4 v[228:231], v26, s[16:19], s21 offen offset:1024 sc1
 buffer_store_dwordx4 v[232:235], v26, s[16:19], s21 offen offset:2048 sc1
 buffer_store_dwordx4 v[236:239], v26, s[16:19], s21 offen offset:3072 sc1
 s_add_u32 s21, s48, 4096
 buffer_store_dwordx4 v[240:243], v26, s[16:19], s21 offen offset:0 sc1
 buffer_store_dwordx4 v[244:247], v26, s[16:19], s21 offen offset:1024 sc1
 s_nop 1
 s_cmp_gt_u32 s26, 0
 s_cbranch_scc1 kvm_blk_124
 s_waitcnt vmcnt(6)
 s_barrier
 s_mov_b32 s24, 327680
 s_mov_b32 s25, 163840
 v_lshrrev_b32 v11, 3, v1
 v_and_b32 v12, 7, v1
 v_xor_b32 v12, v12, v11
 v_mul_u32_u24 v11, 1280, v11
 v_lshl_add_u32 v10, v12, 4, v11
 s_mul_i32 s46, s20, 40960
 v_add_u32 v10, s46, v10
 s_lshl_b32 s47, s20, 12
 s_add_u32 s47, s47, 0
 s_add_u32 s46, s47, 98304
 s_mov_b32 s30, s24
 s_add_u32 s32, s47, 32768
 v_add_u32 v11, 9216, v10
 v_add_u32 v12, 18432, v10
 v_add_u32 v13, 27648, v10
 s_mov_b32 m0, s32
 s_nop 0
 buffer_load_dwordx4 v10, s[8:11], s30 offen offset:0 lds
 buffer_load_dwordx4 v11, s[8:11], s30 offen offset:1024 lds
 buffer_load_dwordx4 v12, s[8:11], s30 offen offset:2048 lds
 buffer_load_dwordx4 v13, s[8:11], s30 offen offset:3072 lds
 s_add_u32 s30, s30, 128
 s_add_u32 s32, s32, 16384
 s_cmp_lt_u32 s32, s46
 s_cselect_b32 s32, s32, s47
 s_mov_b32 m0, s32
 s_nop 0
 buffer_load_dwordx4 v10, s[8:11], s30 offen offset:0 lds
 buffer_load_dwordx4 v11, s[8:11], s30 offen offset:1024 lds
 buffer_load_dwordx4 v12, s[8:11], s30 offen offset:2048 lds
 buffer_load_dwordx4 v13, s[8:11], s30 offen offset:3072 lds
 s_add_u32 s30, s30, 128
 s_add_u32 s32, s32, 16384
 s_cmp_lt_u32 s32, s46
 s_cselect_b32 s32, s32, s47
 s_mov_b32 m0, s32
 s_nop 0
 buffer_load_dwordx4 v10, s[8:11], s30 offen offset:0 lds
 buffer_load_dwordx4 v11, s[8:11], s30 offen offset:1024 lds
 buffer_load_dwordx4 v12, s[8:11], s30 offen offset:2048 lds
 buffer_load_dwordx4 v13, s[8:11], s30 offen offset:3072 lds
 s_add_u32 s30, s30, 128
 s_add_u32 s32, s32, 16384
 s_cmp_lt_u32 s32, s46
 s_cselect_b32 s32, s32, s47
 s_mov_b32 m0, s32
 s_nop 0
 buffer_load_dwordx4 v10, s[8:11], s30 offen offset:0 lds
 buffer_load_dwordx4 v11, s[8:11], s30 offen offset:1024 lds
 buffer_load_dwordx4 v12, s[8:11], s30 offen offset:2048 lds
 buffer_load_dwordx4 v13, s[8:11], s30 offen offset:3072 lds
 s_add_u32 s30, s30, 128
 s_add_u32 s32, s32, 16384
 s_cmp_lt_u32 s32, s46
 s_cselect_b32 s32, s32, s47
 s_waitcnt vmcnt(16)
 s_barrier
 s_cmp_lg_u32 s20, 0
 s_cbranch_scc1 af_129
 v_mov_b32 v4, 0
 v_mov_b32 v5, 1
 s_mov_b64 exec, 1
 buffer_atomic_add v5, v4, s[72:75], s61 offen sc1
 s_mov_b64 exec, -1
 s_nop 1
af_129:
 s_mov_b32 s26, 14
 s_mov_b32 s28, 1572864
kv_main:
 v_and_b32 v6, 7, v2
 v_add_u32 v4, 0, v3
 v_xor_b32 v4, v4, v6
 v_lshlrev_b32 v4, 4, v4
 v_lshl_add_u32 v14, v2, 7, v4
 v_add_u32 v4, 4, v3
 v_xor_b32 v4, v4, v6
 v_lshlrev_b32 v4, 4, v4
 v_lshl_add_u32 v15, v2, 7, v4
 v_mul_u32_u24 v22, 400, v2
 v_mul_u32_u24 v4, 16, v3
 s_mul_i32 s21, s20, 96
 s_add_u32 s21, s21, 98304
 v_add3_u32 v22, v22, v4, s21
 v_lshlrev_b32 v4, 3, v3
 v_sub_u32 v16, v22, v4
 v_mov_b32 v9, 2731
 s_mul_i32 s21, s20, 12800
 s_add_u32 s21, s21, 98304
 v_mul_u32_u24 v4, 400, v2
 v_lshlrev_b32 v5, 4, v3
 v_add3_u32 v23, v4, v5, s21
 v_lshlrev_b32 v26, 4, v1
 s_mov_b32 s33, 32768
 s_mov_b32 s48, 0x80000000
 s_mov_b32 m0, s32
 s_nop 0
 buffer_load_dwordx4 v10, s[8:11], s30 offen offset:0 lds
 buffer_load_dwordx4 v11, s[8:11], s30 offen offset:1024 lds
 s_waitcnt vmcnt(14)
 s_barrier
 v_add_u32 v18, s33, v14
 v_add_u32 v19, s33, v15
 s_add_u32 s33, s33, 16384
 s_cmp_lt_u32 s33, 98304
 s_cselect_b32 s33, s33, 0
 ds_read_b128 v[160:163], v18 offset:0
 ds_read_b128 v[164:167], v18 offset:2048
 ds_read_b128 v[168:171], v18 offset:4096
 ds_read_b128 v[172:175], v18 offset:6144
 ds_read_b128 v[176:179], v18 offset:8192
 ds_read_b128 v[180:183], v18 offset:10240
 ds_read_b128 v[184:187], v18 offset:12288
 ds_read_b128 v[188:191], v18 offset:14336
 s_waitcnt lgkmcnt(0)
kv_blk_132:
 v_mfma_f32_16x16x32_bf16 v[64:67], a[0:3], v[160:163], 0
 ds_read_b128 v[192:195], v19 offset:0
 v_mfma_f32_16x16x32_bf16 v[68:71], a[4:7], v[160:163], 0
 v_add_u32 v18, s33, v14
 v_mfma_f32_16x16x32_bf16 v[72:75], a[8:11], v[160:163], 0
 ds_write_b64 v16, v[234:235] offset:6464
 v_mfma_f32_16x16x32_bf16 v[76:79], a[0:3], v[164:167], 0
 ds_read_b128 v[196:199], v19 offset:2048
 v_cvt_pk_bf16_f32 v236, v88, v89
 v_mfma_f32_16x16x32_bf16 v[80:83], a[4:7], v[164:167], 0
 buffer_load_dwordx4 v12, s[8:11], s30 offen offset:2048 lds
 v_mfma_f32_16x16x32_bf16 v[84:87], a[8:11], v[164:167], 0
 v_cvt_pk_bf16_f32 v237, v90, v91
 v_cvt_pk_bf16_f32 v238, v92, v93
 v_mfma_f32_16x16x32_bf16 v[88:91], a[0:3], v[168:171], 0
 ds_read_b128 v[200:203], v19 offset:4096
 v_cvt_pk_bf16_f32 v239, v94, v95
 v_mfma_f32_16x16x32_bf16 v[92:95], a[4:7], v[168:171], 0
 v_cvt_pk_bf16_f32 v240, v96, v97
 v_cvt_pk_bf16_f32 v241, v98, v99
 v_mfma_f32_16x16x32_bf16 v[96:99], a[8:11], v[168:171], 0
 ds_write_b64 v22, v[236:237] offset:12800
 ds_write_b64 v22, v[238:239] offset:12808
 ds_write_b64 v16, v[240:241] offset:12864
 v_cvt_pk_bf16_f32 v242, v100, v101
 v_cvt_pk_bf16_f32 v243, v102, v103
 v_mfma_f32_16x16x32_bf16 v[100:103], a[0:3], v[172:175], 0
 ds_read_b128 v[204:207], v19 offset:6144
 v_cvt_pk_bf16_f32 v244, v104, v105
 v_cvt_pk_bf16_f32 v245, v106, v107
 v_mfma_f32_16x16x32_bf16 v[104:107], a[4:7], v[172:175], 0
 v_cvt_pk_bf16_f32 v246, v108, v109
 v_cvt_pk_bf16_f32 v247, v110, v111
 v_mfma_f32_16x16x32_bf16 v[108:111], a[8:11], v[172:175], 0
 s_waitcnt lgkmcnt(9)
 ds_write_b64 v22, v[242:243] offset:19200
 ds_write_b64 v22, v[244:245] offset:19208
 ds_write_b64 v16, v[246:247] offset:19264
 v_cvt_pk_bf16_f32 v224, v112, v113
 v_cvt_pk_bf16_f32 v225, v114, v115
 v_mfma_f32_16x16x32_bf16 v[112:115], a[0:3], v[176:179], 0
 ds_read_b128 v[208:211], v19 offset:8192
 v_cvt_pk_bf16_f32 v226, v116, v117
 v_cvt_pk_bf16_f32 v227, v118, v119
 v_mfma_f32_16x16x32_bf16 v[116:119], a[4:7], v[176:179], 0
 v_cvt_pk_bf16_f32 v228, v120, v121
 v_cvt_pk_bf16_f32 v229, v122, v123
 v_mfma_f32_16x16x32_bf16 v[120:123], a[8:11], v[176:179], 0
 ds_write_b64 v22, v[224:225] offset:25600
 ds_write_b64 v22, v[226:227] offset:25608
 ds_write_b64 v16, v[228:229] offset:25664
 v_cvt_pk_bf16_f32 v230, v124, v125
 v_cvt_pk_bf16_f32 v231, v126, v127
 v_mfma_f32_16x16x32_bf16 v[124:127], a[0:3], v[180:183], 0
 ds_read_b128 v[212:215], v19 offset:10240
 v_cvt_pk_bf16_f32 v232, v128, v129
 v_cvt_pk_bf16_f32 v233, v130, v131
 v_mfma_f32_16x16x32_bf16 v[128:131], a[4:7], v[180:183], 0
 buffer_load_dwordx4 v13, s[8:11], s30 offen offset:3072 lds
 v_cvt_pk_bf16_f32 v234, v132, v133
 v_cvt_pk_bf16_f32 v235, v134, v135
 v_mfma_f32_16x16x32_bf16 v[132:135], a[8:11], v[180:183], 0
 s_add_u32 s30, s30, 128
 s_add_u32 m0, m0, 16384
 ds_write_b64 v22, v[230:231] offset:32000
 ds_write_b64 v22, v[232:233] offset:32008
 ds_write_b64 v16, v[234:235] offset:32064
 v_cvt_pk_bf16_f32 v236, v136, v137
 v_cvt_pk_bf16_f32 v237, v138, v139
 v_mfma_f32_16x16x32_bf16 v[136:139], a[0:3], v[184:187], 0
 ds_read_b128 v[216:219], v19 offset:12288
 v_cvt_pk_bf16_f32 v238, v140, v141
 v_cvt_pk_bf16_f32 v239, v142, v143
 v_mfma_f32_16x16x32_bf16 v[140:143], a[4:7], v[184:187], 0
 s_cmp_lt_u32 m0, s46
 s_cselect_b32 m0, m0, s47
 v_cvt_pk_bf16_f32 v240, v144, v145
 v_cvt_pk_bf16_f32 v241, v146, v147
 v_mfma_f32_16x16x32_bf16 v[144:147], a[8:11], v[184:187], 0
 ds_write_b64 v22, v[236:237] offset:38400
 ds_write_b64 v22, v[238:239] offset:38408
 ds_write_b64 v16, v[240:241] offset:38464
 v_cvt_pk_bf16_f32 v242, v148, v149
 v_cvt_pk_bf16_f32 v243, v150, v151
 v_mfma_f32_16x16x32_bf16 v[148:151], a[0:3], v[188:191], 0
 ds_read_b128 v[220:223], v19 offset:14336
 v_cvt_pk_bf16_f32 v244, v152, v153
 v_cvt_pk_bf16_f32 v245, v154, v155
 v_mfma_f32_16x16x32_bf16 v[152:155], a[4:7], v[188:191], 0
 v_cvt_pk_bf16_f32 v246, v156, v157
 v_cvt_pk_bf16_f32 v247, v158, v159
 v_mfma_f32_16x16x32_bf16 v[156:159], a[8:11], v[188:191], 0
 s_waitcnt vmcnt(12) lgkmcnt(15)
 s_barrier
 v_mfma_f32_16x16x32_bf16 v[64:67], a[12:15], v[192:195], v[64:67]
 ds_read_b128 v[160:163], v18 offset:0
 v_mfma_f32_16x16x32_bf16 v[68:71], a[16:19], v[192:195], v[68:71]
 ds_write_b64 v22, v[242:243] offset:44800
 v_mfma_f32_16x16x32_bf16 v[72:75], a[20:23], v[192:195], v[72:75]
 v_add_u32 v19, s33, v15
 s_add_u32 s33, s33, 16384
 v_mfma_f32_16x16x32_bf16 v[76:79], a[12:15], v[196:199], v[76:79]
 ds_read_b128 v[164:167], v18 offset:2048
 v_mfma_f32_16x16x32_bf16 v[80:83], a[16:19], v[196:199], v[80:83]
 buffer_load_dwordx4 v10, s[8:11], s30 offen offset:0 lds
 v_mfma_f32_16x16x32_bf16 v[84:87], a[20:23], v[196:199], v[84:87]
 s_cmp_lt_u32 s33, 98304
 s_cselect_b32 s33, s33, 0
 v_mfma_f32_16x16x32_bf16 v[88:91], a[12:15], v[200:203], v[88:91]
 ds_read_b128 v[168:171], v18 offset:4096
 v_mfma_f32_16x16x32_bf16 v[92:95], a[16:19], v[200:203], v[92:95]
 ds_write_b64 v22, v[244:245] offset:44808
 v_mfma_f32_16x16x32_bf16 v[96:99], a[20:23], v[200:203], v[96:99]
 ds_write_b64 v16, v[246:247] offset:44864
 v_mfma_f32_16x16x32_bf16 v[100:103], a[12:15], v[204:207], v[100:103]
 ds_read_b128 v[172:175], v18 offset:6144
 v_mfma_f32_16x16x32_bf16 v[104:107], a[16:19], v[204:207], v[104:107]
 v_mfma_f32_16x16x32_bf16 v[108:111], a[20:23], v[204:207], v[108:111]
 s_waitcnt lgkmcnt(7)
 v_mfma_f32_16x16x32_bf16 v[112:115], a[12:15], v[208:211], v[112:115]
 ds_read_b128 v[176:179], v18 offset:8192
 v_mfma_f32_16x16x32_bf16 v[116:119], a[16:19], v[208:211], v[116:119]
 v_mfma_f32_16x16x32_bf16 v[120:123], a[20:23], v[208:211], v[120:123]
 v_mfma_f32_16x16x32_bf16 v[124:127], a[12:15], v[212:215], v[124:127]
 ds_read_b128 v[180:183], v18 offset:10240
 v_mfma_f32_16x16x32_bf16 v[128:131], a[16:19], v[212:215], v[128:131]
 buffer_load_dwordx4 v11, s[8:11], s30 offen offset:1024 lds
 v_mfma_f32_16x16x32_bf16 v[132:135], a[20:23], v[212:215], v[132:135]
 v_mfma_f32_16x16x32_bf16 v[136:139], a[12:15], v[216:219], v[136:139]
 ds_read_b128 v[184:187], v18 offset:12288
 v_mfma_f32_16x16x32_bf16 v[140:143], a[16:19], v[216:219], v[140:143]
 v_mfma_f32_16x16x32_bf16 v[144:147], a[20:23], v[216:219], v[144:147]
 v_mfma_f32_16x16x32_bf16 v[148:151], a[12:15], v[220:223], v[148:151]
 ds_read_b128 v[188:191], v18 offset:14336
 v_mfma_f32_16x16x32_bf16 v[152:155], a[16:19], v[220:223], v[152:155]
 v_mfma_f32_16x16x32_bf16 v[156:159], a[20:23], v[220:223], v[156:159]
 s_waitcnt lgkmcnt(4)
 v_mfma_f32_16x16x32_bf16 v[64:67], a[24:27], v[160:163], v[64:67]
 ds_read_b128 v[192:195], v19 offset:0
 v_mfma_f32_16x16x32_bf16 v[68:71], a[28:31], v[160:163], v[68:71]
 v_add_u32 v18, s33, v14
 v_mfma_f32_16x16x32_bf16 v[72:75], a[32:35], v[160:163], v[72:75]
 v_mfma_f32_16x16x32_bf16 v[76:79], a[24:27], v[164:167], v[76:79]
 ds_read_b128 v[196:199], v19 offset:2048
 v_mfma_f32_16x16x32_bf16 v[80:83], a[28:31], v[164:167], v[80:83]
 buffer_load_dwordx4 v12, s[8:11], s30 offen offset:2048 lds
 v_mfma_f32_16x16x32_bf16 v[84:87], a[32:35], v[164:167], v[84:87]
 v_mfma_f32_16x16x32_bf16 v[88:91], a[24:27], v[168:171], v[88:91]
 ds_read_b128 v[200:203], v19 offset:4096
 v_mfma_f32_16x16x32_bf16 v[92:95], a[28:31], v[168:171], v[92:95]
 v_mfma_f32_16x16x32_bf16 v[96:99], a[32:35], v[168:171], v[96:99]
 v_mfma_f32_16x16x32_bf16 v[100:103], a[24:27], v[172:175], v[100:103]
 ds_read_b128 v[204:207], v19 offset:6144
 v_mfma_f32_16x16x32_bf16 v[104:107], a[28:31], v[172:175], v[104:107]
 v_mfma_f32_16x16x32_bf16 v[108:111], a[32:35], v[172:175], v[108:111]
 s_waitcnt lgkmcnt(4)
 v_mfma_f32_16x16x32_bf16 v[112:115], a[24:27], v[176:179], v[112:115]
 ds_read_b128 v[208:211], v19 offset:8192
 v_mfma_f32_16x16x32_bf16 v[116:119], a[28:31], v[176:179], v[116:119]
 v_mfma_f32_16x16x32_bf16 v[120:123], a[32:35], v[176:179], v[120:123]
 v_mfma_f32_16x16x32_bf16 v[124:127], a[24:27], v[180:183], v[124:127]
 ds_read_b128 v[212:215], v19 offset:10240
 v_mfma_f32_16x16x32_bf16 v[128:131], a[28:31], v[180:183], v[128:131]
 buffer_load_dwordx4 v13, s[8:11], s30 offen offset:3072 lds
 v_mfma_f32_16x16x32_bf16 v[132:135], a[32:35], v[180:183], v[132:135]
 s_add_u32 s30, s30, 128
 s_add_u32 m0, m0, 16384
 v_mfma_f32_16x16x32_bf16 v[136:139], a[24:27], v[184:187], v[136:139]
 ds_read_b128 v[216:219], v19 offset:12288
 v_mfma_f32_16x16x32_bf16 v[140:143], a[28:31], v[184:187], v[140:143]
 s_cmp_lt_u32 m0, s46
 s_cselect_b32 m0, m0, s47
 v_mfma_f32_16x16x32_bf16 v[144:147], a[32:35], v[184:187], v[144:147]
 v_mfma_f32_16x16x32_bf16 v[148:151], a[24:27], v[188:191], v[148:151]
 ds_read_b128 v[220:223], v19 offset:14336
 v_mfma_f32_16x16x32_bf16 v[152:155], a[28:31], v[188:191], v[152:155]
 v_mfma_f32_16x16x32_bf16 v[156:159], a[32:35], v[188:191], v[156:159]
 s_waitcnt vmcnt(12) lgkmcnt(4)
 s_barrier
 v_mfma_f32_16x16x32_bf16 v[64:67], a[36:39], v[192:195], v[64:67]
 ds_read_b128 v[160:163], v18 offset:0
 v_mfma_f32_16x16x32_bf16 v[68:71], a[40:43], v[192:195], v[68:71]
 v_mfma_f32_16x16x32_bf16 v[72:75], a[44:47], v[192:195], v[72:75]
 v_add_u32 v19, s33, v15
 s_add_u32 s33, s33, 16384
 v_mfma_f32_16x16x32_bf16 v[76:79], a[36:39], v[196:199], v[76:79]
 ds_read_b128 v[164:167], v18 offset:2048
 v_mfma_f32_16x16x32_bf16 v[80:83], a[40:43], v[196:199], v[80:83]
 buffer_load_dwordx4 v10, s[8:11], s30 offen offset:0 lds
 v_mfma_f32_16x16x32_bf16 v[84:87], a[44:47], v[196:199], v[84:87]
 s_cmp_lt_u32 s33, 98304
 s_cselect_b32 s33, s33, 0
 v_mfma_f32_16x16x32_bf16 v[88:91], a[36:39], v[200:203], v[88:91]
 ds_read_b128 v[168:171], v18 offset:4096
 v_mfma_f32_16x16x32_bf16 v[92:95], a[40:43], v[200:203], v[92:95]
 ds_read_b128 v[224:227], v23 offset:0
 v_mfma_f32_16x16x32_bf16 v[96:99], a[44:47], v[200:203], v[96:99]
 v_mfma_f32_16x16x32_bf16 v[100:103], a[36:39], v[204:207], v[100:103]
 ds_read_b128 v[172:175], v18 offset:6144
 v_mfma_f32_16x16x32_bf16 v[104:107], a[40:43], v[204:207], v[104:107]
 v_mfma_f32_16x16x32_bf16 v[108:111], a[44:47], v[204:207], v[108:111]
 s_waitcnt lgkmcnt(5)
 v_mfma_f32_16x16x32_bf16 v[112:115], a[36:39], v[208:211], v[112:115]
 ds_read_b128 v[176:179], v18 offset:8192
 v_mfma_f32_16x16x32_bf16 v[116:119], a[40:43], v[208:211], v[116:119]
 v_mfma_f32_16x16x32_bf16 v[120:123], a[44:47], v[208:211], v[120:123]
 v_mfma_f32_16x16x32_bf16 v[124:127], a[36:39], v[212:215], v[124:127]
 ds_read_b128 v[180:183], v18 offset:10240
 v_mfma_f32_16x16x32_bf16 v[128:131], a[40:43], v[212:215], v[128:131]
 buffer_load_dwordx4 v11, s[8:11], s30 offen offset:1024 lds
 v_mfma_f32_16x16x32_bf16 v[132:135], a[44:47], v[212:215], v[132:135]
 v_mfma_f32_16x16x32_bf16 v[136:139], a[36:39], v[216:219], v[136:139]
 ds_read_b128 v[184:187], v18 offset:12288
 v_mfma_f32_16x16x32_bf16 v[140:143], a[40:43], v[216:219], v[140:143]
 ds_read_b128 v[228:231], v23 offset:64
 v_mfma_f32_16x16x32_bf16 v[144:147], a[44:47], v[216:219], v[144:147]
 v_mfma_f32_16x16x32_bf16 v[148:151], a[36:39], v[220:223], v[148:151]
 ds_read_b128 v[188:191], v18 offset:14336
 v_mfma_f32_16x16x32_bf16 v[152:155], a[40:43], v[220:223], v[152:155]
 v_mfma_f32_16x16x32_bf16 v[156:159], a[44:47], v[220:223], v[156:159]
 s_waitcnt lgkmcnt(5)
 v_mfma_f32_16x16x32_bf16 v[64:67], a[48:51], v[160:163], v[64:67]
 ds_read_b128 v[192:195], v19 offset:0
 v_mfma_f32_16x16x32_bf16 v[68:71], a[52:55], v[160:163], v[68:71]
 v_add_u32 v18, s33, v14
 v_mfma_f32_16x16x32_bf16 v[72:75], a[56:59], v[160:163], v[72:75]
 v_mfma_f32_16x16x32_bf16 v[76:79], a[48:51], v[164:167], v[76:79]
 ds_read_b128 v[196:199], v19 offset:2048
 v_mfma_f32_16x16x32_bf16 v[80:83], a[52:55], v[164:167], v[80:83]
 buffer_load_dwordx4 v12, s[8:11], s30 offen offset:2048 lds
 v_mfma_f32_16x16x32_bf16 v[84:87], a[56:59], v[164:167], v[84:87]
 v_mfma_f32_16x16x32_bf16 v[88:91], a[48:51], v[168:171], v[88:91]
 ds_read_b128 v[200:203], v19 offset:4096
 v_mfma_f32_16x16x32_bf16 v[92:95], a[52:55], v[168:171], v[92:95]
 s_add_u32 s21, s48, 0
 ds_read_b128 v[232:235], v23 offset:128
 v_mfma_f32_16x16x32_bf16 v[96:99], a[56:59], v[168:171], v[96:99]
 v_mfma_f32_16x16x32_bf16 v[100:103], a[48:51], v[172:175], v[100:103]
 ds_read_b128 v[204:207], v19 offset:6144
 v_mfma_f32_16x16x32_bf16 v[104:107], a[52:55], v[172:175], v[104:107]
 buffer_store_dwordx4 v[224:227], v26, s[16:19], s21 offen offset:0 sc1
 v_mfma_f32_16x16x32_bf16 v[108:111], a[56:59], v[172:175], v[108:111]
 s_waitcnt lgkmcnt(5)
 v_mfma_f32_16x16x32_bf16 v[112:115], a[48:51], v[176:179], v[112:115]
 ds_read_b128 v[208:211], v19 offset:8192
 v_mfma_f32_16x16x32_bf16 v[116:119], a[52:55], v[176:179], v[116:119]
 v_mfma_f32_16x16x32_bf16 v[120:123], a[56:59], v[176:179], v[120:123]
 v_mfma_f32_16x16x32_bf16 v[124:127], a[48:51], v[180:183], v[124:127]
 ds_read_b128 v[212:215], v19 offset:10240
 v_mfma_f32_16x16x32_bf16 v[128:131], a[52:55], v[180:183], v[128:131]
 buffer_load_dwordx4 v13, s[8:11], s30 offen offset:3072 lds
 v_mfma_f32_16x16x32_bf16 v[132:135], a[56:59], v[180:183], v[132:135]
 s_add_u32 s30, s30, 128
 s_add_u32 m0, m0, 16384
 v_mfma_f32_16x16x32_bf16 v[136:139], a[48:51], v[184:187], v[136:139]
 ds_read_b128 v[216:219], v19 offset:12288
 v_mfma_f32_16x16x32_bf16 v[140:143], a[52:55], v[184:187], v[140:143]
 s_cmp_lt_u32 m0, s46
 s_cselect_b32 m0, m0, s47
 v_mfma_f32_16x16x32_bf16 v[144:147], a[56:59], v[184:187], v[144:147]
 ds_read_b128 v[236:239], v23 offset:192
 v_mfma_f32_16x16x32_bf16 v[148:151], a[48:51], v[188:191], v[148:151]
 ds_read_b128 v[220:223], v19 offset:14336
 v_mfma_f32_16x16x32_bf16 v[152:155], a[52:55], v[188:191], v[152:155]
 buffer_store_dwordx4 v[228:231], v26, s[16:19], s21 offen offset:1024 sc1
 v_mfma_f32_16x16x32_bf16 v[156:159], a[56:59], v[188:191], v[156:159]
 s_waitcnt vmcnt(14) lgkmcnt(5)
 s_barrier
 v_mfma_f32_16x16x32_bf16 v[64:67], a[60:63], v[192:195], v[64:67]
 ds_read_b128 v[160:163], v18 offset:0
 v_mfma_f32_16x16x32_bf16 v[68:71], a[64:67], v[192:195], v[68:71]
 v_mfma_f32_16x16x32_bf16 v[72:75], a[68:71], v[192:195], v[72:75]
 v_add_u32 v19, s33, v15
 s_add_u32 s33, s33, 16384
 v_mfma_f32_16x16x32_bf16 v[76:79], a[60:63], v[196:199], v[76:79]
 ds_read_b128 v[164:167], v18 offset:2048
 v_mfma_f32_16x16x32_bf16 v[80:83], a[64:67], v[196:199], v[80:83]
 buffer_load_dwordx4 v10, s[8:11], s30 offen offset:0 lds
 v_mfma_f32_16x16x32_bf16 v[84:87], a[68:71], v[196:199], v[84:87]
 s_cmp_lt_u32 s33, 98304
 s_cselect_b32 s33, s33, 0
 v_mfma_f32_16x16x32_bf16 v[88:91], a[60:63], v[200:203], v[88:91]
 ds_read_b128 v[168:171], v18 offset:4096
 v_mfma_f32_16x16x32_bf16 v[92:95], a[64:67], v[200:203], v[92:95]
 ds_read_b128 v[240:243], v23 offset:256
 v_mfma_f32_16x16x32_bf16 v[96:99], a[68:71], v[200:203], v[96:99]
 v_mfma_f32_16x16x32_bf16 v[100:103], a[60:63], v[204:207], v[100:103]
 ds_read_b128 v[172:175], v18 offset:6144
 v_mfma_f32_16x16x32_bf16 v[104:107], a[64:67], v[204:207], v[104:107]
 buffer_store_dwordx4 v[232:235], v26, s[16:19], s21 offen offset:2048 sc1
 v_mfma_f32_16x16x32_bf16 v[108:111], a[68:71], v[204:207], v[108:111]
 s_waitcnt lgkmcnt(5)
 v_mfma_f32_16x16x32_bf16 v[112:115], a[60:63], v[208:211], v[112:115]
 ds_read_b128 v[176:179], v18 offset:8192
 v_mfma_f32_16x16x32_bf16 v[116:119], a[64:67], v[208:211], v[116:119]
 v_mfma_f32_16x16x32_bf16 v[120:123], a[68:71], v[208:211], v[120:123]
 v_mfma_f32_16x16x32_bf16 v[124:127], a[60:63], v[212:215], v[124:127]
 ds_read_b128 v[180:183], v18 offset:10240
 v_mfma_f32_16x16x32_bf16 v[128:131], a[64:67], v[212:215], v[128:131]
 buffer_load_dwordx4 v11, s[8:11], s30 offen offset:1024 lds
 v_mfma_f32_16x16x32_bf16 v[132:135], a[68:71], v[212:215], v[132:135]
 v_mfma_f32_16x16x32_bf16 v[136:139], a[60:63], v[216:219], v[136:139]
 ds_read_b128 v[184:187], v18 offset:12288
 v_mfma_f32_16x16x32_bf16 v[140:143], a[64:67], v[216:219], v[140:143]
 ds_read_b128 v[244:247], v23 offset:320
 v_mfma_f32_16x16x32_bf16 v[144:147], a[68:71], v[216:219], v[144:147]
 v_mfma_f32_16x16x32_bf16 v[148:151], a[60:63], v[220:223], v[148:151]
 ds_read_b128 v[188:191], v18 offset:14336
 v_mfma_f32_16x16x32_bf16 v[152:155], a[64:67], v[220:223], v[152:155]
 buffer_store_dwordx4 v[236:239], v26, s[16:19], s21 offen offset:3072 sc1
 v_mfma_f32_16x16x32_bf16 v[156:159], a[68:71], v[220:223], v[156:159]
 s_waitcnt lgkmcnt(5)
 v_mfma_f32_16x16x32_bf16 v[64:67], a[72:75], v[160:163], v[64:67]
 ds_read_b128 v[192:195], v19 offset:0
 v_mfma_f32_16x16x32_bf16 v[68:71], a[76:79], v[160:163], v[68:71]
 v_add_u32 v18, s33, v14
 v_mfma_f32_16x16x32_bf16 v[72:75], a[80:83], v[160:163], v[72:75]
 v_mfma_f32_16x16x32_bf16 v[76:79], a[72:75], v[164:167], v[76:79]
 ds_read_b128 v[196:199], v19 offset:2048
 v_mfma_f32_16x16x32_bf16 v[80:83], a[76:79], v[164:167], v[80:83]
 buffer_load_dwordx4 v12, s[8:11], s30 offen offset:2048 lds
 v_mfma_f32_16x16x32_bf16 v[84:87], a[80:83], v[164:167], v[84:87]
 v_mfma_f32_16x16x32_bf16 v[88:91], a[72:75], v[168:171], v[88:91]
 ds_read_b128 v[200:203], v19 offset:4096
 v_mfma_f32_16x16x32_bf16 v[92:95], a[76:79], v[168:171], v[92:95]
 s_add_u32 s21, s48, 4096
 ds_read_b128 v[224:227], v23 offset:6400
 v_mfma_f32_16x16x32_bf16 v[96:99], a[80:83], v[168:171], v[96:99]
 v_mfma_f32_16x16x32_bf16 v[100:103], a[72:75], v[172:175], v[100:103]
 ds_read_b128 v[204:207], v19 offset:6144
 v_mfma_f32_16x16x32_bf16 v[104:107], a[76:79], v[172:175], v[104:107]
 buffer_store_dwordx4 v[240:243], v26, s[16:19], s21 offen offset:0 sc1
 v_mfma_f32_16x16x32_bf16 v[108:111], a[80:83], v[172:175], v[108:111]
 s_waitcnt lgkmcnt(5)
 v_mfma_f32_16x16x32_bf16 v[112:115], a[72:75], v[176:179], v[112:115]
 ds_read_b128 v[208:211], v19 offset:8192
 v_mfma_f32_16x16x32_bf16 v[116:119], a[76:79], v[176:179], v[116:119]
 v_mfma_f32_16x16x32_bf16 v[120:123], a[80:83], v[176:179], v[120:123]
 v_mfma_f32_16x16x32_bf16 v[124:127], a[72:75], v[180:183], v[124:127]
 ds_read_b128 v[212:215], v19 offset:10240
 v_mfma_f32_16x16x32_bf16 v[128:131], a[76:79], v[180:183], v[128:131]
 buffer_load_dwordx4 v13, s[8:11], s30 offen offset:3072 lds
 v_mfma_f32_16x16x32_bf16 v[132:135], a[80:83], v[180:183], v[132:135]
 s_add_u32 s30, s30, 128
 s_add_u32 m0, m0, 16384
 v_mfma_f32_16x16x32_bf16 v[136:139], a[72:75], v[184:187], v[136:139]
 ds_read_b128 v[216:219], v19 offset:12288
 v_mfma_f32_16x16x32_bf16 v[140:143], a[76:79], v[184:187], v[140:143]
 s_cmp_lt_u32 m0, s46
 s_cselect_b32 m0, m0, s47
 v_mfma_f32_16x16x32_bf16 v[144:147], a[80:83], v[184:187], v[144:147]
 ds_read_b128 v[228:231], v23 offset:6464
 v_mfma_f32_16x16x32_bf16 v[148:151], a[72:75], v[188:191], v[148:151]
 ds_read_b128 v[220:223], v19 offset:14336
 v_mfma_f32_16x16x32_bf16 v[152:155], a[76:79], v[188:191], v[152:155]
 buffer_store_dwordx4 v[244:247], v26, s[16:19], s21 offen offset:1024 sc1
 v_mfma_f32_16x16x32_bf16 v[156:159], a[80:83], v[188:191], v[156:159]
 s_waitcnt vmcnt(18) lgkmcnt(5)
 s_barrier
 v_mfma_f32_16x16x32_bf16 v[64:67], a[84:87], v[192:195], v[64:67]
 ds_read_b128 v[160:163], v18 offset:0
 v_mfma_f32_16x16x32_bf16 v[68:71], a[88:91], v[192:195], v[68:71]
 v_mfma_f32_16x16x32_bf16 v[72:75], a[92:95], v[192:195], v[72:75]
 v_add_u32 v19, s33, v15
 s_add_u32 s33, s33, 16384
 v_mfma_f32_16x16x32_bf16 v[76:79], a[84:87], v[196:199], v[76:79]
 ds_read_b128 v[164:167], v18 offset:2048
 v_mfma_f32_16x16x32_bf16 v[80:83], a[88:91], v[196:199], v[80:83]
 buffer_load_dwordx4 v10, s[8:11], s30 offen offset:0 lds
 v_mfma_f32_16x16x32_bf16 v[84:87], a[92:95], v[196:199], v[84:87]
 s_cmp_lt_u32 s33, 98304
 s_cselect_b32 s33, s33, 0
 v_mfma_f32_16x16x32_bf16 v[88:91], a[84:87], v[200:203], v[88:91]
 ds_read_b128 v[168:171], v18 offset:4096
 v_mfma_f32_16x16x32_bf16 v[92:95], a[88:91], v[200:203], v[92:95]
 ds_read_b128 v[232:235], v23 offset:6528
 v_mfma_f32_16x16x32_bf16 v[96:99], a[92:95], v[200:203], v[96:99]
 v_mfma_f32_16x16x32_bf16 v[100:103], a[84:87], v[204:207], v[100:103]
 ds_read_b128 v[172:175], v18 offset:6144
 v_mfma_f32_16x16x32_bf16 v[104:107], a[88:91], v[204:207], v[104:107]
 buffer_store_dwordx4 v[224:227], v26, s[16:19], s21 offen offset:2048 sc1
 v_mfma_f32_16x16x32_bf16 v[108:111], a[92:95], v[204:207], v[108:111]
 s_waitcnt lgkmcnt(5)
 v_mfma_f32_16x16x32_bf16 v[112:115], a[84:87], v[208:211], v[112:115]
 ds_read_b128 v[176:179], v18 offset:8192
 v_mfma_f32_16x16x32_bf16 v[116:119], a[88:91], v[208:211], v[116:119]
 v_mfma_f32_16x16x32_bf16 v[120:123], a[92:95], v[208:211], v[120:123]
 v_mfma_f32_16x16x32_bf16 v[124:127], a[84:87], v[212:215], v[124:127]
 ds_read_b128 v[180:183], v18 offset:10240
 v_mfma_f32_16x16x32_bf16 v[128:131], a[88:91], v[212:215], v[128:131]
 buffer_load_dwordx4 v11, s[8:11], s30 offen offset:1024 lds
 v_mfma_f32_16x16x32_bf16 v[132:135], a[92:95], v[212:215], v[132:135]
 v_mfma_f32_16x16x32_bf16 v[136:139], a[84:87], v[216:219], v[136:139]
 ds_read_b128 v[184:187], v18 offset:12288
 v_mfma_f32_16x16x32_bf16 v[140:143], a[88:91], v[216:219], v[140:143]
 ds_read_b128 v[236:239], v23 offset:6592
 v_mfma_f32_16x16x32_bf16 v[144:147], a[92:95], v[216:219], v[144:147]
 v_mfma_f32_16x16x32_bf16 v[148:151], a[84:87], v[220:223], v[148:151]
 ds_read_b128 v[188:191], v18 offset:14336
 v_mfma_f32_16x16x32_bf16 v[152:155], a[88:91], v[220:223], v[152:155]
 buffer_store_dwordx4 v[228:231], v26, s[16:19], s21 offen offset:3072 sc1
 v_mfma_f32_16x16x32_bf16 v[156:159], a[92:95], v[220:223], v[156:159]
 s_waitcnt lgkmcnt(5)
 v_mfma_f32_16x16x32_bf16 v[64:67], a[96:99], v[160:163], v[64:67]
 ds_read_b128 v[192:195], v19 offset:0
 v_mfma_f32_16x16x32_bf16 v[68:71], a[100:103], v[160:163], v[68:71]
 v_add_u32 v18, s33, v14
 v_mfma_f32_16x16x32_bf16 v[72:75], a[104:107], v[160:163], v[72:75]
 v_mfma_f32_16x16x32_bf16 v[76:79], a[96:99], v[164:167], v[76:79]
 ds_read_b128 v[196:199], v19 offset:2048
 v_mfma_f32_16x16x32_bf16 v[80:83], a[100:103], v[164:167], v[80:83]
 buffer_load_dwordx4 v12, s[8:11], s30 offen offset:2048 lds
 v_mfma_f32_16x16x32_bf16 v[84:87], a[104:107], v[164:167], v[84:87]
 v_mfma_f32_16x16x32_bf16 v[88:91], a[96:99], v[168:171], v[88:91]
 ds_read_b128 v[200:203], v19 offset:4096
 v_mfma_f32_16x16x32_bf16 v[92:95], a[100:103], v[168:171], v[92:95]
 s_add_u32 s21, s48, 8192
 ds_read_b128 v[240:243], v23 offset:6656
 v_mfma_f32_16x16x32_bf16 v[96:99], a[104:107], v[168:171], v[96:99]
 v_mfma_f32_16x16x32_bf16 v[100:103], a[96:99], v[172:175], v[100:103]
 ds_read_b128 v[204:207], v19 offset:6144
 v_mfma_f32_16x16x32_bf16 v[104:107], a[100:103], v[172:175], v[104:107]
 buffer_store_dwordx4 v[232:235], v26, s[16:19], s21 offen offset:0 sc1
 v_mfma_f32_16x16x32_bf16 v[108:111], a[104:107], v[172:175], v[108:111]
 s_waitcnt lgkmcnt(5)
 v_mfma_f32_16x16x32_bf16 v[112:115], a[96:99], v[176:179], v[112:115]
 ds_read_b128 v[208:211], v19 offset:8192
 v_mfma_f32_16x16x32_bf16 v[116:119], a[100:103], v[176:179], v[116:119]
 v_mfma_f32_16x16x32_bf16 v[120:123], a[104:107], v[176:179], v[120:123]
 v_mfma_f32_16x16x32_bf16 v[124:127], a[96:99], v[180:183], v[124:127]
 ds_read_b128 v[212:215], v19 offset:10240
 v_mfma_f32_16x16x32_bf16 v[128:131], a[100:103], v[180:183], v[128:131]
 buffer_load_dwordx4 v13, s[8:11], s30 offen offset:3072 lds
 v_mfma_f32_16x16x32_bf16 v[132:135], a[104:107], v[180:183], v[132:135]
 s_add_u32 s30, s30, 128
 s_add_u32 m0, m0, 16384
 v_mfma_f32_16x16x32_bf16 v[136:139], a[96:99], v[184:187], v[136:139]
 ds_read_b128 v[216:219], v19 offset:12288
 v_mfma_f32_16x16x32_bf16 v[140:143], a[100:103], v[184:187], v[140:143]
 s_cmp_lt_u32 m0, s46
 s_cselect_b32 m0, m0, s47
 v_mfma_f32_16x16x32_bf16 v[144:147], a[104:107], v[184:187], v[144:147]
 ds_read_b128 v[244:247], v23 offset:6720
 v_mfma_f32_16x16x32_bf16 v[148:151], a[96:99], v[188:191], v[148:151]
 ds_read_b128 v[220:223], v19 offset:14336
 v_mfma_f32_16x16x32_bf16 v[152:155], a[100:103], v[188:191], v[152:155]
 buffer_store_dwordx4 v[236:239], v26, s[16:19], s21 offen offset:1024 sc1
 v_mfma_f32_16x16x32_bf16 v[156:159], a[104:107], v[188:191], v[156:159]
 s_waitcnt vmcnt(22) lgkmcnt(5)
 s_barrier
 v_mfma_f32_16x16x32_bf16 v[64:67], a[108:111], v[192:195], v[64:67]
 ds_read_b128 v[160:163], v18 offset:0
 v_mfma_f32_16x16x32_bf16 v[68:71], a[112:115], v[192:195], v[68:71]
 v_mfma_f32_16x16x32_bf16 v[72:75], a[116:119], v[192:195], v[72:75]
 v_add_u32 v19, s33, v15
 s_add_u32 s33, s33, 16384
 v_mfma_f32_16x16x32_bf16 v[76:79], a[108:111], v[196:199], v[76:79]
 ds_read_b128 v[164:167], v18 offset:2048
 v_mfma_f32_16x16x32_bf16 v[80:83], a[112:115], v[196:199], v[80:83]
 buffer_load_dwordx4 v10, s[8:11], s30 offen offset:0 lds
 v_mfma_f32_16x16x32_bf16 v[84:87], a[116:119], v[196:199], v[84:87]
 s_cmp_lt_u32 s33, 98304
 s_cselect_b32 s33, s33, 0
 v_mfma_f32_16x16x32_bf16 v[88:91], a[108:111], v[200:203], v[88:91]
 ds_read_b128 v[168:171], v18 offset:4096
 v_mfma_f32_16x16x32_bf16 v[92:95], a[112:115], v[200:203], v[92:95]
 v_mfma_f32_16x16x32_bf16 v[96:99], a[116:119], v[200:203], v[96:99]
 v_mfma_f32_16x16x32_bf16 v[100:103], a[108:111], v[204:207], v[100:103]
 ds_read_b128 v[172:175], v18 offset:6144
 v_mfma_f32_16x16x32_bf16 v[104:107], a[112:115], v[204:207], v[104:107]
 buffer_store_dwordx4 v[240:243], v26, s[16:19], s21 offen offset:2048 sc1
 v_mfma_f32_16x16x32_bf16 v[108:111], a[116:119], v[204:207], v[108:111]
 s_waitcnt lgkmcnt(4)
 v_mfma_f32_16x16x32_bf16 v[112:115], a[108:111], v[208:211], v[112:115]
 ds_read_b128 v[176:179], v18 offset:8192
 v_mfma_f32_16x16x32_bf16 v[116:119], a[112:115], v[208:211], v[116:119]
 v_mfma_f32_16x16x32_bf16 v[120:123], a[116:119], v[208:211], v[120:123]
 v_mfma_f32_16x16x32_bf16 v[124:127], a[108:111], v[212:215], v[124:127]
 ds_read_b128 v[180:183], v18 offset:10240
 v_mfma_f32_16x16x32_bf16 v[128:131], a[112:115], v[212:215], v[128:131]
 buffer_load_dwordx4 v11, s[8:11], s30 offen offset:1024 lds
 v_mfma_f32_16x16x32_bf16 v[132:135], a[116:119], v[212:215], v[132:135]
 v_mfma_f32_16x16x32_bf16 v[136:139], a[108:111], v[216:219], v[136:139]
 ds_read_b128 v[184:187], v18 offset:12288
 v_mfma_f32_16x16x32_bf16 v[140:143], a[112:115], v[216:219], v[140:143]
 v_mfma_f32_16x16x32_bf16 v[144:147], a[116:119], v[216:219], v[144:147]
 v_mfma_f32_16x16x32_bf16 v[148:151], a[108:111], v[220:223], v[148:151]
 ds_read_b128 v[188:191], v18 offset:14336
 v_mfma_f32_16x16x32_bf16 v[152:155], a[112:115], v[220:223], v[152:155]
 buffer_store_dwordx4 v[244:247], v26, s[16:19], s21 offen offset:3072 sc1
 v_mfma_f32_16x16x32_bf16 v[156:159], a[116:119], v[220:223], v[156:159]
 s_waitcnt lgkmcnt(4)
 v_mfma_f32_16x16x32_bf16 v[64:67], a[120:123], v[160:163], v[64:67]
 ds_read_b128 v[192:195], v19 offset:0
 v_mfma_f32_16x16x32_bf16 v[68:71], a[124:127], v[160:163], v[68:71]
 v_add_u32 v18, s33, v14
 v_mfma_f32_16x16x32_bf16 v[72:75], a[128:131], v[160:163], v[72:75]
 v_mfma_f32_16x16x32_bf16 v[76:79], a[120:123], v[164:167], v[76:79]
 ds_read_b128 v[196:199], v19 offset:2048
 v_mfma_f32_16x16x32_bf16 v[80:83], a[124:127], v[164:167], v[80:83]
 buffer_load_dwordx4 v12, s[8:11], s30 offen offset:2048 lds
 v_mfma_f32_16x16x32_bf16 v[84:87], a[128:131], v[164:167], v[84:87]
 v_mfma_f32_16x16x32_bf16 v[88:91], a[120:123], v[168:171], v[88:91]
 ds_read_b128 v[200:203], v19 offset:4096
 v_mfma_f32_16x16x32_bf16 v[92:95], a[124:127], v[168:171], v[92:95]
 v_mfma_f32_16x16x32_bf16 v[96:99], a[128:131], v[168:171], v[96:99]
 v_mfma_f32_16x16x32_bf16 v[100:103], a[120:123], v[172:175], v[100:103]
 ds_read_b128 v[204:207], v19 offset:6144
 v_mfma_f32_16x16x32_bf16 v[104:107], a[124:127], v[172:175], v[104:107]
 v_mfma_f32_16x16x32_bf16 v[108:111], a[128:131], v[172:175], v[108:111]
 s_waitcnt lgkmcnt(4)
 v_mfma_f32_16x16x32_bf16 v[112:115], a[120:123], v[176:179], v[112:115]
 ds_read_b128 v[208:211], v19 offset:8192
 v_mfma_f32_16x16x32_bf16 v[116:119], a[124:127], v[176:179], v[116:119]
 v_mfma_f32_16x16x32_bf16 v[120:123], a[128:131], v[176:179], v[120:123]
 v_mfma_f32_16x16x32_bf16 v[124:127], a[120:123], v[180:183], v[124:127]
 ds_read_b128 v[212:215], v19 offset:10240
 v_mfma_f32_16x16x32_bf16 v[128:131], a[124:127], v[180:183], v[128:131]
 buffer_load_dwordx4 v13, s[8:11], s30 offen offset:3072 lds
 v_mfma_f32_16x16x32_bf16 v[132:135], a[128:131], v[180:183], v[132:135]
 s_add_u32 s30, s30, s25
 s_sub_u32 s30, s30, 1152
 v_mfma_f32_16x16x32_bf16 v[136:139], a[120:123], v[184:187], v[136:139]
 ds_read_b128 v[216:219], v19 offset:12288
 s_add_u32 m0, m0, 16384
 v_mfma_f32_16x16x32_bf16 v[140:143], a[124:127], v[184:187], v[140:143]
 s_cmp_lt_u32 m0, s46
 s_cselect_b32 m0, m0, s47
 v_mfma_f32_16x16x32_bf16 v[144:147], a[128:131], v[184:187], v[144:147]
 v_mfma_f32_16x16x32_bf16 v[148:151], a[120:123], v[188:191], v[148:151]
 ds_read_b128 v[220:223], v19 offset:14336
 v_mfma_f32_16x16x32_bf16 v[152:155], a[124:127], v[188:191], v[152:155]
 v_mfma_f32_16x16x32_bf16 v[156:159], a[128:131], v[188:191], v[156:159]
 s_waitcnt vmcnt(23) lgkmcnt(4)
 s_barrier
 v_mfma_f32_16x16x32_bf16 v[64:67], a[132:135], v[192:195], v[64:67]
 ds_read_b128 v[160:163], v18 offset:0
 v_mfma_f32_16x16x32_bf16 v[68:71], a[136:139], v[192:195], v[68:71]
 v_mfma_f32_16x16x32_bf16 v[72:75], a[140:143], v[192:195], v[72:75]
 v_add_u32 v19, s33, v15
 s_add_u32 s33, s33, 16384
 v_mfma_f32_16x16x32_bf16 v[76:79], a[132:135], v[196:199], v[76:79]
 ds_read_b128 v[164:167], v18 offset:2048
 v_mfma_f32_16x16x32_bf16 v[80:83], a[136:139], v[196:199], v[80:83]
 buffer_load_dwordx4 v10, s[8:11], s30 offen offset:0 lds
 v_mfma_f32_16x16x32_bf16 v[84:87], a[140:143], v[196:199], v[84:87]
 s_cmp_lt_u32 s33, 98304
 s_cselect_b32 s33, s33, 0
 v_mfma_f32_16x16x32_bf16 v[88:91], a[132:135], v[200:203], v[88:91]
 ds_read_b128 v[168:171], v18 offset:4096
 v_mfma_f32_16x16x32_bf16 v[92:95], a[136:139], v[200:203], v[92:95]
 v_mfma_f32_16x16x32_bf16 v[96:99], a[140:143], v[200:203], v[96:99]
 v_mfma_f32_16x16x32_bf16 v[100:103], a[132:135], v[204:207], v[100:103]
 ds_read_b128 v[172:175], v18 offset:6144
 v_mfma_f32_16x16x32_bf16 v[104:107], a[136:139], v[204:207], v[104:107]
 v_mfma_f32_16x16x32_bf16 v[108:111], a[140:143], v[204:207], v[108:111]
 s_waitcnt lgkmcnt(4)
 v_mfma_f32_16x16x32_bf16 v[112:115], a[132:135], v[208:211], v[112:115]
 ds_read_b128 v[176:179], v18 offset:8192
 v_mfma_f32_16x16x32_bf16 v[116:119], a[136:139], v[208:211], v[116:119]
 v_mfma_f32_16x16x32_bf16 v[120:123], a[140:143], v[208:211], v[120:123]
 v_mfma_f32_16x16x32_bf16 v[124:127], a[132:135], v[212:215], v[124:127]
 ds_read_b128 v[180:183], v18 offset:10240
 v_mfma_f32_16x16x32_bf16 v[128:131], a[136:139], v[212:215], v[128:131]
 buffer_load_dwordx4 v11, s[8:11], s30 offen offset:1024 lds
 v_mfma_f32_16x16x32_bf16 v[132:135], a[140:143], v[212:215], v[132:135]
 v_mfma_f32_16x16x32_bf16 v[136:139], a[132:135], v[216:219], v[136:139]
 ds_read_b128 v[184:187], v18 offset:12288
 v_mfma_f32_16x16x32_bf16 v[140:143], a[136:139], v[216:219], v[140:143]
 v_mfma_f32_16x16x32_bf16 v[144:147], a[140:143], v[216:219], v[144:147]
 v_mfma_f32_16x16x32_bf16 v[148:151], a[132:135], v[220:223], v[148:151]
 ds_read_b128 v[188:191], v18 offset:14336
 v_mfma_f32_16x16x32_bf16 v[152:155], a[136:139], v[220:223], v[152:155]
 v_mfma_f32_16x16x32_bf16 v[156:159], a[140:143], v[220:223], v[156:159]
 s_waitcnt lgkmcnt(4)
 v_mfma_f32_16x16x32_bf16 v[64:67], a[144:147], v[160:163], v[64:67]
 ds_read_b128 v[192:195], v19 offset:0
 v_mfma_f32_16x16x32_bf16 v[68:71], a[148:151], v[160:163], v[68:71]
 v_add_u32 v18, s33, v14
 v_mfma_f32_16x16x32_bf16 v[72:75], a[152:155], v[160:163], v[72:75]
 v_mfma_f32_16x16x32_bf16 v[76:79], a[144:147], v[164:167], v[76:79]
 ds_read_b128 v[196:199], v19 offset:2048
 v_mfma_f32_16x16x32_bf16 v[80:83], a[148:151], v[164:167], v[80:83]
 buffer_load_dwordx4 v12, s[8:11], s30 offen offset:2048 lds
 v_mfma_f32_16x16x32_bf16 v[84:87], a[152:155], v[164:167], v[84:87]
 v_mfma_f32_16x16x32_bf16 v[88:91], a[144:147], v[168:171], v[88:91]
 ds_read_b128 v[200:203], v19 offset:4096
 v_mfma_f32_16x16x32_bf16 v[92:95], a[148:151], v[168:171], v[92:95]
 v_mfma_f32_16x16x32_bf16 v[96:99], a[152:155], v[168:171], v[96:99]
 v_mfma_f32_16x16x32_bf16 v[100:103], a[144:147], v[172:175], v[100:103]
 ds_read_b128 v[204:207], v19 offset:6144
 v_mfma_f32_16x16x32_bf16 v[104:107], a[148:151], v[172:175], v[104:107]
 v_mfma_f32_16x16x32_bf16 v[108:111], a[152:155], v[172:175], v[108:111]
 s_waitcnt lgkmcnt(4)
 v_mfma_f32_16x16x32_bf16 v[112:115], a[144:147], v[176:179], v[112:115]
 ds_read_b128 v[208:211], v19 offset:8192
 v_mfma_f32_16x16x32_bf16 v[116:119], a[148:151], v[176:179], v[116:119]
 v_mfma_f32_16x16x32_bf16 v[120:123], a[152:155], v[176:179], v[120:123]
 v_mfma_f32_16x16x32_bf16 v[124:127], a[144:147], v[180:183], v[124:127]
 ds_read_b128 v[212:215], v19 offset:10240
 v_mfma_f32_16x16x32_bf16 v[128:131], a[148:151], v[180:183], v[128:131]
 buffer_load_dwordx4 v13, s[8:11], s30 offen offset:3072 lds
 v_mfma_f32_16x16x32_bf16 v[132:135], a[152:155], v[180:183], v[132:135]
 s_add_u32 s30, s30, 128
 s_add_u32 m0, m0, 16384
 v_mfma_f32_16x16x32_bf16 v[136:139], a[144:147], v[184:187], v[136:139]
 ds_read_b128 v[216:219], v19 offset:12288
 v_mfma_f32_16x16x32_bf16 v[140:143], a[148:151], v[184:187], v[140:143]
 s_cmp_lt_u32 m0, s46
 s_cselect_b32 m0, m0, s47
 v_mfma_f32_16x16x32_bf16 v[144:147], a[152:155], v[184:187], v[144:147]
 v_mfma_f32_16x16x32_bf16 v[148:151], a[144:147], v[188:191], v[148:151]
 ds_read_b128 v[220:223], v19 offset:14336
 v_mfma_f32_16x16x32_bf16 v[152:155], a[148:151], v[188:191], v[152:155]
 v_mfma_f32_16x16x32_bf16 v[156:159], a[152:155], v[188:191], v[156:159]
 s_waitcnt vmcnt(6) lgkmcnt(4)
 s_barrier
 v_mfma_f32_16x16x32_bf16 v[64:67], a[156:159], v[192:195], v[64:67]
 ds_read_b128 v[160:163], v18 offset:0
 v_mfma_f32_16x16x32_bf16 v[68:71], a[160:163], v[192:195], v[68:71]
 s_cmp_eq_u32 s48, 0x80000000
 s_cbranch_scc1 kv_130
 s_cmp_lg_u32 s20, 0
 s_cbranch_scc1 af_131
 v_mov_b32 v4, 0
 v_mov_b32 v5, 1
 s_mov_b64 exec, 1
 buffer_atomic_add v5, v4, s[72:75], s61 offen sc1
 s_mov_b64 exec, -1
 s_nop 1
af_131:
kv_130:
 v_mfma_f32_16x16x32_bf16 v[72:75], a[164:167], v[192:195], v[72:75]
 v_add_u32 v19, s33, v15
 s_add_u32 s33, s33, 16384
 v_mfma_f32_16x16x32_bf16 v[76:79], a[156:159], v[196:199], v[76:79]
 ds_read_b128 v[164:167], v18 offset:2048
 v_mfma_f32_16x16x32_bf16 v[80:83], a[160:163], v[196:199], v[80:83]
 buffer_load_dwordx4 v10, s[8:11], s30 offen offset:0 lds
 v_mfma_f32_16x16x32_bf16 v[84:87], a[164:167], v[196:199], v[84:87]
 s_cmp_lt_u32 s33, 98304
 s_cselect_b32 s33, s33, 0
 v_mfma_f32_16x16x32_bf16 v[88:91], a[156:159], v[200:203], v[88:91]
 ds_read_b128 v[168:171], v18 offset:4096
 v_mfma_f32_16x16x32_bf16 v[92:95], a[160:163], v[200:203], v[92:95]
 v_mfma_f32_16x16x32_bf16 v[96:99], a[164:167], v[200:203], v[96:99]
 v_mfma_f32_16x16x32_bf16 v[100:103], a[156:159], v[204:207], v[100:103]
 ds_read_b128 v[172:175], v18 offset:6144
 v_mfma_f32_16x16x32_bf16 v[104:107], a[160:163], v[204:207], v[104:107]
 v_mfma_f32_16x16x32_bf16 v[108:111], a[164:167], v[204:207], v[108:111]
 s_waitcnt lgkmcnt(4)
 v_mfma_f32_16x16x32_bf16 v[112:115], a[156:159], v[208:211], v[112:115]
 ds_read_b128 v[176:179], v18 offset:8192
 v_mfma_f32_16x16x32_bf16 v[116:119], a[160:163], v[208:211], v[116:119]
 v_mfma_f32_16x16x32_bf16 v[120:123], a[164:167], v[208:211], v[120:123]
 v_mfma_f32_16x16x32_bf16 v[124:127], a[156:159], v[212:215], v[124:127]
 ds_read_b128 v[180:183], v18 offset:10240
 v_mfma_f32_16x16x32_bf16 v[128:131], a[160:163], v[212:215], v[128:131]
 buffer_load_dwordx4 v11, s[8:11], s30 offen offset:1024 lds
 v_mfma_f32_16x16x32_bf16 v[132:135], a[164:167], v[212:215], v[132:135]
 v_mfma_f32_16x16x32_bf16 v[136:139], a[156:159], v[216:219], v[136:139]
 ds_read_b128 v[184:187], v18 offset:12288
 v_mfma_f32_16x16x32_bf16 v[140:143], a[160:163], v[216:219], v[140:143]
 v_mfma_f32_16x16x32_bf16 v[144:147], a[164:167], v[216:219], v[144:147]
 v_mfma_f32_16x16x32_bf16 v[148:151], a[156:159], v[220:223], v[148:151]
 ds_read_b128 v[188:191], v18 offset:14336
 v_mfma_f32_16x16x32_bf16 v[152:155], a[160:163], v[220:223], v[152:155]
 v_mfma_f32_16x16x32_bf16 v[156:159], a[164:167], v[220:223], v[156:159]
 s_waitcnt lgkmcnt(4)
 v_mfma_f32_16x16x32_bf16 v[64:67], a[168:171], v[160:163], v[64:67]
 ds_read_b128 v[192:195], v19 offset:0
 v_mfma_f32_16x16x32_bf16 v[68:71], a[172:175], v[160:163], v[68:71]
 v_add_u32 v18, s33, v14
 s_mov_b32 s61, s60
 v_mfma_f32_16x16x32_bf16 v[72:75], a[176:179], v[160:163], v[72:75]
 s_add_u32 s60, s60, s62
 s_mul_i32 s48, s20, 393216
 v_mfma_f32_16x16x32_bf16 v[76:79], a[168:171], v[164:167], v[76:79]
 ds_read_b128 v[196:199], v19 offset:2048
 s_add_u32 s48, s48, s27
 v_mfma_f32_16x16x32_bf16 v[80:83], a[172:175], v[164:167], v[80:83]
 buffer_load_dwordx4 v12, s[8:11], s30 offen offset:2048 lds
 v_mfma_f32_16x16x32_bf16 v[84:87], a[176:179], v[164:167], v[84:87]
 s_add_u32 s27, s27, s28
 s_sub_u32 s26, s26, 1
 v_mfma_f32_16x16x32_bf16 v[88:91], a[168:171], v[168:171], v[88:91]
 ds_read_b128 v[200:203], v19 offset:4096
 v_mfma_f32_16x16x32_bf16 v[92:95], a[172:175], v[168:171], v[92:95]
 v_mfma_f32_16x16x32_bf16 v[96:99], a[176:179], v[168:171], v[96:99]
 v_mfma_f32_16x16x32_bf16 v[100:103], a[168:171], v[172:175], v[100:103]
 ds_read_b128 v[204:207], v19 offset:6144
 v_mfma_f32_16x16x32_bf16 v[104:107], a[172:175], v[172:175], v[104:107]
 v_mfma_f32_16x16x32_bf16 v[108:111], a[176:179], v[172:175], v[108:111]
 s_waitcnt lgkmcnt(4)
 v_mfma_f32_16x16x32_bf16 v[112:115], a[168:171], v[176:179], v[112:115]
 ds_read_b128 v[208:211], v19 offset:8192
 v_mfma_f32_16x16x32_bf16 v[116:119], a[172:175], v[176:179], v[116:119]
 v_mfma_f32_16x16x32_bf16 v[120:123], a[176:179], v[176:179], v[120:123]
 v_mfma_f32_16x16x32_bf16 v[124:127], a[168:171], v[180:183], v[124:127]
 ds_read_b128 v[212:215], v19 offset:10240
 v_mfma_f32_16x16x32_bf16 v[128:131], a[172:175], v[180:183], v[128:131]
 buffer_load_dwordx4 v13, s[8:11], s30 offen offset:3072 lds
 v_mfma_f32_16x16x32_bf16 v[132:135], a[176:179], v[180:183], v[132:135]
 s_add_u32 s30, s30, 128
 s_add_u32 m0, m0, 16384
 v_mfma_f32_16x16x32_bf16 v[136:139], a[168:171], v[184:187], v[136:139]
 ds_read_b128 v[216:219], v19 offset:12288
 v_mfma_f32_16x16x32_bf16 v[140:143], a[172:175], v[184:187], v[140:143]
 s_cmp_lt_u32 m0, s46
 s_cselect_b32 m0, m0, s47
 v_mfma_f32_16x16x32_bf16 v[144:147], a[176:179], v[184:187], v[144:147]
 v_mfma_f32_16x16x32_bf16 v[148:151], a[168:171], v[188:191], v[148:151]
 ds_read_b128 v[220:223], v19 offset:14336
 v_mfma_f32_16x16x32_bf16 v[152:155], a[172:175], v[188:191], v[152:155]
 v_mfma_f32_16x16x32_bf16 v[156:159], a[176:179], v[188:191], v[156:159]
 s_waitcnt vmcnt(15) lgkmcnt(4)
 s_barrier
 v_mfma_f32_16x16x32_bf16 v[64:67], a[180:183], v[192:195], v[64:67]
 ds_read_b128 v[160:163], v18 offset:0
 v_mfma_f32_16x16x32_bf16 v[68:71], a[184:187], v[192:195], v[68:71]
 v_mfma_f32_16x16x32_bf16 v[72:75], a[188:191], v[192:195], v[72:75]
 v_add_u32 v19, s33, v15
 s_add_u32 s33, s33, 16384
 v_mfma_f32_16x16x32_bf16 v[76:79], a[180:183], v[196:199], v[76:79]
 ds_read_b128 v[164:167], v18 offset:2048
 v_mfma_f32_16x16x32_bf16 v[80:83], a[184:187], v[196:199], v[80:83]
 buffer_load_dwordx4 v10, s[8:11], s30 offen offset:0 lds
 v_mfma_f32_16x16x32_bf16 v[84:87], a[188:191], v[196:199], v[84:87]
 s_cmp_lt_u32 s33, 98304
 s_cselect_b32 s33, s33, 0
 v_mfma_f32_16x16x32_bf16 v[88:91], a[180:183], v[200:203], v[88:91]
 ds_read_b128 v[168:171], v18 offset:4096
 v_mfma_f32_16x16x32_bf16 v[92:95], a[184:187], v[200:203], v[92:95]
 v_mfma_f32_16x16x32_bf16 v[96:99], a[188:191], v[200:203], v[96:99]
 v_mfma_f32_16x16x32_bf16 v[100:103], a[180:183], v[204:207], v[100:103]
 ds_read_b128 v[172:175], v18 offset:6144
 v_mfma_f32_16x16x32_bf16 v[104:107], a[184:187], v[204:207], v[104:107]
 v_mfma_f32_16x16x32_bf16 v[108:111], a[188:191], v[204:207], v[108:111]
 s_waitcnt lgkmcnt(4)
 v_mfma_f32_16x16x32_bf16 v[112:115], a[180:183], v[208:211], v[112:115]
 ds_read_b128 v[176:179], v18 offset:8192
 v_mfma_f32_16x16x32_bf16 v[116:119], a[184:187], v[208:211], v[116:119]
 v_mfma_f32_16x16x32_bf16 v[120:123], a[188:191], v[208:211], v[120:123]
 v_mfma_f32_16x16x32_bf16 v[124:127], a[180:183], v[212:215], v[124:127]
 ds_read_b128 v[180:183], v18 offset:10240
 v_mfma_f32_16x16x32_bf16 v[128:131], a[184:187], v[212:215], v[128:131]
 buffer_load_dwordx4 v11, s[8:11], s30 offen offset:1024 lds
 v_mfma_f32_16x16x32_bf16 v[132:135], a[188:191], v[212:215], v[132:135]
 v_mfma_f32_16x16x32_bf16 v[136:139], a[180:183], v[216:219], v[136:139]
 ds_read_b128 v[184:187], v18 offset:12288
 v_mfma_f32_16x16x32_bf16 v[140:143], a[184:187], v[216:219], v[140:143]
 v_mfma_f32_16x16x32_bf16 v[144:147], a[188:191], v[216:219], v[144:147]
 v_mfma_f32_16x16x32_bf16 v[148:151], a[180:183], v[220:223], v[148:151]
 ds_read_b128 v[188:191], v18 offset:14336
 v_mfma_f32_16x16x32_bf16 v[152:155], a[184:187], v[220:223], v[152:155]
 v_mfma_f32_16x16x32_bf16 v[156:159], a[188:191], v[220:223], v[156:159]
 s_waitcnt lgkmcnt(4)
 v_mfma_f32_16x16x32_bf16 v[64:67], a[192:195], v[160:163], v[64:67]
 ds_read_b128 v[192:195], v19 offset:0
 v_mfma_f32_16x16x32_bf16 v[68:71], a[196:199], v[160:163], v[68:71]
 v_add_u32 v18, s33, v14
 v_mfma_f32_16x16x32_bf16 v[72:75], a[200:203], v[160:163], v[72:75]
 v_mfma_f32_16x16x32_bf16 v[76:79], a[192:195], v[164:167], v[76:79]
 ds_read_b128 v[196:199], v19 offset:2048
 v_mfma_f32_16x16x32_bf16 v[80:83], a[196:199], v[164:167], v[80:83]
 buffer_load_dwordx4 v12, s[8:11], s30 offen offset:2048 lds
 v_mfma_f32_16x16x32_bf16 v[84:87], a[200:203], v[164:167], v[84:87]
 v_mfma_f32_16x16x32_bf16 v[88:91], a[192:195], v[168:171], v[88:91]
 ds_read_b128 v[200:203], v19 offset:4096
 v_mfma_f32_16x16x32_bf16 v[92:95], a[196:199], v[168:171], v[92:95]
 v_mfma_f32_16x16x32_bf16 v[96:99], a[200:203], v[168:171], v[96:99]
 v_mfma_f32_16x16x32_bf16 v[100:103], a[192:195], v[172:175], v[100:103]
 ds_read_b128 v[204:207], v19 offset:6144
 v_mfma_f32_16x16x32_bf16 v[104:107], a[196:199], v[172:175], v[104:107]
 v_mfma_f32_16x16x32_bf16 v[108:111], a[200:203], v[172:175], v[108:111]
 s_waitcnt lgkmcnt(4)
 v_mfma_f32_16x16x32_bf16 v[112:115], a[192:195], v[176:179], v[112:115]
 ds_read_b128 v[208:211], v19 offset:8192
 v_mfma_f32_16x16x32_bf16 v[116:119], a[196:199], v[176:179], v[116:119]
 v_mfma_f32_16x16x32_bf16 v[120:123], a[200:203], v[176:179], v[120:123]
 v_mfma_f32_16x16x32_bf16 v[124:127], a[192:195], v[180:183], v[124:127]
 ds_read_b128 v[212:215], v19 offset:10240
 v_mfma_f32_16x16x32_bf16 v[128:131], a[196:199], v[180:183], v[128:131]
 buffer_load_dwordx4 v13, s[8:11], s30 offen offset:3072 lds
 v_mfma_f32_16x16x32_bf16 v[132:135], a[200:203], v[180:183], v[132:135]
 s_add_u32 s30, s30, 128
 s_add_u32 m0, m0, 16384
 v_mfma_f32_16x16x32_bf16 v[136:139], a[192:195], v[184:187], v[136:139]
 ds_read_b128 v[216:219], v19 offset:12288
 v_mfma_f32_16x16x32_bf16 v[140:143], a[196:199], v[184:187], v[140:143]
 s_cmp_lt_u32 m0, s46
 s_cselect_b32 m0, m0, s47
 v_mfma_f32_16x16x32_bf16 v[144:147], a[200:203], v[184:187], v[144:147]
 v_mfma_f32_16x16x32_bf16 v[148:151], a[192:195], v[188:191], v[148:151]
 ds_read_b128 v[220:223], v19 offset:14336
 v_mfma_f32_16x16x32_bf16 v[152:155], a[196:199], v[188:191], v[152:155]
 v_mfma_f32_16x16x32_bf16 v[156:159], a[200:203], v[188:191], v[156:159]
 s_waitcnt vmcnt(12) lgkmcnt(4)
 s_barrier
 v_mfma_f32_16x16x32_bf16 v[64:67], a[204:207], v[192:195], v[64:67]
 ds_read_b128 v[160:163], v18 offset:0
 v_mfma_f32_16x16x32_bf16 v[68:71], a[208:211], v[192:195], v[68:71]
 v_mfma_f32_16x16x32_bf16 v[72:75], a[212:215], v[192:195], v[72:75]
 v_add_u32 v19, s33, v15
 s_add_u32 s33, s33, 16384
 v_mfma_f32_16x16x32_bf16 v[76:79], a[204:207], v[196:199], v[76:79]
 ds_read_b128 v[164:167], v18 offset:2048
 v_mfma_f32_16x16x32_bf16 v[80:83], a[208:211], v[196:199], v[80:83]
 buffer_load_dwordx4 v10, s[8:11], s30 offen offset:0 lds
 v_mfma_f32_16x16x32_bf16 v[84:87], a[212:215], v[196:199], v[84:87]
 s_cmp_lt_u32 s33, 98304
 s_cselect_b32 s33, s33, 0
 v_mfma_f32_16x16x32_bf16 v[88:91], a[204:207], v[200:203], v[88:91]
 ds_read_b128 v[168:171], v18 offset:4096
 v_mfma_f32_16x16x32_bf16 v[92:95], a[208:211], v[200:203], v[92:95]
 v_mfma_f32_16x16x32_bf16 v[96:99], a[212:215], v[200:203], v[96:99]
 v_mfma_f32_16x16x32_bf16 v[100:103], a[204:207], v[204:207], v[100:103]
 ds_read_b128 v[172:175], v18 offset:6144
 v_mfma_f32_16x16x32_bf16 v[104:107], a[208:211], v[204:207], v[104:107]
 v_mfma_f32_16x16x32_bf16 v[108:111], a[212:215], v[204:207], v[108:111]
 s_waitcnt lgkmcnt(4)
 v_mfma_f32_16x16x32_bf16 v[112:115], a[204:207], v[208:211], v[112:115]
 ds_read_b128 v[176:179], v18 offset:8192
 v_mfma_f32_16x16x32_bf16 v[116:119], a[208:211], v[208:211], v[116:119]
 v_mfma_f32_16x16x32_bf16 v[120:123], a[212:215], v[208:211], v[120:123]
 v_mfma_f32_16x16x32_bf16 v[124:127], a[204:207], v[212:215], v[124:127]
 ds_read_b128 v[180:183], v18 offset:10240
 v_mfma_f32_16x16x32_bf16 v[128:131], a[208:211], v[212:215], v[128:131]
 buffer_load_dwordx4 v11, s[8:11], s30 offen offset:1024 lds
 v_mfma_f32_16x16x32_bf16 v[132:135], a[212:215], v[212:215], v[132:135]
 v_mfma_f32_16x16x32_bf16 v[136:139], a[204:207], v[216:219], v[136:139]
 ds_read_b128 v[184:187], v18 offset:12288
 v_mfma_f32_16x16x32_bf16 v[140:143], a[208:211], v[216:219], v[140:143]
 v_mfma_f32_16x16x32_bf16 v[144:147], a[212:215], v[216:219], v[144:147]
 v_mfma_f32_16x16x32_bf16 v[148:151], a[204:207], v[220:223], v[148:151]
 ds_read_b128 v[188:191], v18 offset:14336
 v_mfma_f32_16x16x32_bf16 v[152:155], a[208:211], v[220:223], v[152:155]
 v_mfma_f32_16x16x32_bf16 v[156:159], a[212:215], v[220:223], v[156:159]
 s_waitcnt lgkmcnt(4)
 v_mfma_f32_16x16x32_bf16 v[64:67], a[216:219], v[160:163], v[64:67]
 ds_read_b128 v[192:195], v19 offset:0
 v_mfma_f32_16x16x32_bf16 v[68:71], a[220:223], v[160:163], v[68:71]
 v_add_u32 v18, s33, v14
 v_mfma_f32_16x16x32_bf16 v[72:75], a[224:227], v[160:163], v[72:75]
 v_mfma_f32_16x16x32_bf16 v[76:79], a[216:219], v[164:167], v[76:79]
 ds_read_b128 v[196:199], v19 offset:2048
 v_mfma_f32_16x16x32_bf16 v[80:83], a[220:223], v[164:167], v[80:83]
 buffer_load_dwordx4 v12, s[8:11], s30 offen offset:2048 lds
 v_mfma_f32_16x16x32_bf16 v[84:87], a[224:227], v[164:167], v[84:87]
 v_mfma_f32_16x16x32_bf16 v[88:91], a[216:219], v[168:171], v[88:91]
 ds_read_b128 v[200:203], v19 offset:4096
 v_mfma_f32_16x16x32_bf16 v[92:95], a[220:223], v[168:171], v[92:95]
 v_mfma_f32_16x16x32_bf16 v[96:99], a[224:227], v[168:171], v[96:99]
 v_mfma_f32_16x16x32_bf16 v[100:103], a[216:219], v[172:175], v[100:103]
 ds_read_b128 v[204:207], v19 offset:6144
 v_mfma_f32_16x16x32_bf16 v[104:107], a[220:223], v[172:175], v[104:107]
 v_mfma_f32_16x16x32_bf16 v[108:111], a[224:227], v[172:175], v[108:111]
 s_waitcnt lgkmcnt(4)
 v_mfma_f32_16x16x32_bf16 v[112:115], a[216:219], v[176:179], v[112:115]
 ds_read_b128 v[208:211], v19 offset:8192
 v_mfma_f32_16x16x32_bf16 v[116:119], a[220:223], v[176:179], v[116:119]
 v_mfma_f32_16x16x32_bf16 v[120:123], a[224:227], v[176:179], v[120:123]
 v_mfma_f32_16x16x32_bf16 v[124:127], a[216:219], v[180:183], v[124:127]
 ds_read_b128 v[212:215], v19 offset:10240
 v_mfma_f32_16x16x32_bf16 v[128:131], a[220:223], v[180:183], v[128:131]
 buffer_load_dwordx4 v13, s[8:11], s30 offen offset:3072 lds
 v_mfma_f32_16x16x32_bf16 v[132:135], a[224:227], v[180:183], v[132:135]
 s_add_u32 s30, s30, 128
 s_add_u32 m0, m0, 16384
 v_mfma_f32_16x16x32_bf16 v[136:139], a[216:219], v[184:187], v[136:139]
 ds_read_b128 v[216:219], v19 offset:12288
 v_mfma_f32_16x16x32_bf16 v[140:143], a[220:223], v[184:187], v[140:143]
 s_cmp_lt_u32 m0, s46
 s_cselect_b32 m0, m0, s47
 v_mfma_f32_16x16x32_bf16 v[144:147], a[224:227], v[184:187], v[144:147]
 v_mfma_f32_16x16x32_bf16 v[148:151], a[216:219], v[188:191], v[148:151]
 ds_read_b128 v[220:223], v19 offset:14336
 v_mfma_f32_16x16x32_bf16 v[152:155], a[220:223], v[188:191], v[152:155]
 v_mfma_f32_16x16x32_bf16 v[156:159], a[224:227], v[188:191], v[156:159]
 s_waitcnt vmcnt(12) lgkmcnt(4)
 s_barrier
 v_mfma_f32_16x16x32_bf16 v[64:67], a[228:231], v[192:195], v[64:67]
 ds_read_b128 v[160:163], v18 offset:0
 v_mfma_f32_16x16x32_bf16 v[68:71], a[232:235], v[192:195], v[68:71]
 v_mfma_f32_16x16x32_bf16 v[72:75], a[236:239], v[192:195], v[72:75]
 v_add_u32 v19, s33, v15
 s_add_u32 s33, s33, 16384
 v_mfma_f32_16x16x32_bf16 v[76:79], a[228:231], v[196:199], v[76:79]
 ds_read_b128 v[164:167], v18 offset:2048
 v_cvt_pk_bf16_f32 v224, v64, v65
 v_mfma_f32_16x16x32_bf16 v[80:83], a[232:235], v[196:199], v[80:83]
 buffer_load_dwordx4 v10, s[8:11], s30 offen offset:0 lds
 v_mfma_f32_16x16x32_bf16 v[84:87], a[236:239], v[196:199], v[84:87]
 s_cmp_lt_u32 s33, 98304
 s_cselect_b32 s33, s33, 0
 v_mfma_f32_16x16x32_bf16 v[88:91], a[228:231], v[200:203], v[88:91]
 ds_read_b128 v[168:171], v18 offset:4096
 v_cvt_pk_bf16_f32 v225, v66, v67
 v_mfma_f32_16x16x32_bf16 v[92:95], a[232:235], v[200:203], v[92:95]
 v_cvt_pk_bf16_f32 v226, v68, v69
 v_cvt_pk_bf16_f32 v227, v70, v71
 v_mfma_f32_16x16x32_bf16 v[96:99], a[236:239], v[200:203], v[96:99]
 v_cvt_pk_bf16_f32 v228, v72, v73
 v_cvt_pk_bf16_f32 v229, v74, v75
 v_mfma_f32_16x16x32_bf16 v[100:103], a[228:231], v[204:207], v[100:103]
 ds_read_b128 v[172:175], v18 offset:6144
 v_mfma_f32_16x16x32_bf16 v[104:107], a[232:235], v[204:207], v[104:107]
 ds_write_b64 v22, v[224:225] offset:0
 v_mfma_f32_16x16x32_bf16 v[108:111], a[236:239], v[204:207], v[108:111]
 s_waitcnt lgkmcnt(5)
 v_mfma_f32_16x16x32_bf16 v[112:115], a[228:231], v[208:211], v[112:115]
 ds_read_b128 v[176:179], v18 offset:8192
 v_mfma_f32_16x16x32_bf16 v[116:119], a[232:235], v[208:211], v[116:119]
 ds_write_b64 v22, v[226:227] offset:8
 v_mfma_f32_16x16x32_bf16 v[120:123], a[236:239], v[208:211], v[120:123]
 ds_write_b64 v16, v[228:229] offset:64
 v_mfma_f32_16x16x32_bf16 v[124:127], a[228:231], v[212:215], v[124:127]
 ds_read_b128 v[180:183], v18 offset:10240
 v_cvt_pk_bf16_f32 v230, v76, v77
 v_mfma_f32_16x16x32_bf16 v[128:131], a[232:235], v[212:215], v[128:131]
 buffer_load_dwordx4 v11, s[8:11], s30 offen offset:1024 lds
 v_mfma_f32_16x16x32_bf16 v[132:135], a[236:239], v[212:215], v[132:135]
 v_cvt_pk_bf16_f32 v231, v78, v79
 v_cvt_pk_bf16_f32 v232, v80, v81
 v_mfma_f32_16x16x32_bf16 v[136:139], a[228:231], v[216:219], v[136:139]
 ds_read_b128 v[184:187], v18 offset:12288
 v_cvt_pk_bf16_f32 v233, v82, v83
 v_mfma_f32_16x16x32_bf16 v[140:143], a[232:235], v[216:219], v[140:143]
 v_cvt_pk_bf16_f32 v234, v84, v85
 v_cvt_pk_bf16_f32 v235, v86, v87
 v_mfma_f32_16x16x32_bf16 v[144:147], a[236:239], v[216:219], v[144:147]
 ds_write_b64 v22, v[230:231] offset:6400
 v_mfma_f32_16x16x32_bf16 v[148:151], a[228:231], v[220:223], v[148:151]
 ds_read_b128 v[188:191], v18 offset:14336
 v_mfma_f32_16x16x32_bf16 v[152:155], a[232:235], v[220:223], v[152:155]
 ds_write_b64 v22, v[232:233] offset:6408
 v_mfma_f32_16x16x32_bf16 v[156:159], a[236:239], v[220:223], v[156:159]
 s_waitcnt lgkmcnt(9)
kv_end_133:
 s_cmp_gt_u32 s26, 0
 s_cbranch_scc1 kv_blk_132
 s_nop 7
 ds_write_b64 v16, v[234:235] offset:6464
 v_cvt_pk_bf16_f32 v236, v88, v89
 v_cvt_pk_bf16_f32 v237, v90, v91
 v_cvt_pk_bf16_f32 v238, v92, v93
 v_cvt_pk_bf16_f32 v239, v94, v95
 v_cvt_pk_bf16_f32 v240, v96, v97
 v_cvt_pk_bf16_f32 v241, v98, v99
 ds_write_b64 v22, v[236:237] offset:12800
 ds_write_b64 v22, v[238:239] offset:12808
 ds_write_b64 v16, v[240:241] offset:12864
 v_cvt_pk_bf16_f32 v242, v100, v101
 v_cvt_pk_bf16_f32 v243, v102, v103
 v_cvt_pk_bf16_f32 v244, v104, v105
 v_cvt_pk_bf16_f32 v245, v106, v107
 v_cvt_pk_bf16_f32 v246, v108, v109
 v_cvt_pk_bf16_f32 v247, v110, v111
 ds_write_b64 v22, v[242:243] offset:19200
 ds_write_b64 v22, v[244:245] offset:19208
 ds_write_b64 v16, v[246:247] offset:19264
 v_cvt_pk_bf16_f32 v224, v112, v113
 v_cvt_pk_bf16_f32 v225, v114, v115
 v_cvt_pk_bf16_f32 v226, v116, v117
 v_cvt_pk_bf16_f32 v227, v118, v119
 v_cvt_pk_bf16_f32 v228, v120, v121
 v_cvt_pk_bf16_f32 v229, v122, v123
 ds_write_b64 v22, v[224:225] offset:25600
 ds_write_b64 v22, v[226:227] offset:25608
 ds_write_b64 v16, v[228:229] offset:25664
 v_cvt_pk_bf16_f32 v230, v124, v125
 v_cvt_pk_bf16_f32 v231, v126, v127
 v_cvt_pk_bf16_f32 v232, v128, v129
 v_cvt_pk_bf16_f32 v233, v130, v131
 v_cvt_pk_bf16_f32 v234, v132, v133
 v_cvt_pk_bf16_f32 v235, v134, v135
 ds_write_b64 v22, v[230:231] offset:32000
 ds_write_b64 v22, v[232:233] offset:32008
 ds_write_b64 v16, v[234:235] offset:32064
 v_cvt_pk_bf16_f32 v236, v136, v137
 v_cvt_pk_bf16_f32 v237, v138, v139
 v_cvt_pk_bf16_f32 v238, v140, v141
 v_cvt_pk_bf16_f32 v239, v142, v143
 v_cvt_pk_bf16_f32 v240, v144, v145
 v_cvt_pk_bf16_f32 v241, v146, v147
 ds_write_b64 v22, v[236:237] offset:38400
 ds_write_b64 v22, v[238:239] offset:38408
 ds_write_b64 v16, v[240:241] offset:38464
 v_cvt_pk_bf16_f32 v242, v148, v149
 v_cvt_pk_bf16_f32 v243, v150, v151
 v_cvt_pk_bf16_f32 v244, v152, v153
 v_cvt_pk_bf16_f32 v245, v154, v155
 v_cvt_pk_bf16_f32 v246, v156, v157
 v_cvt_pk_bf16_f32 v247, v158, v159
 ds_write_b64 v22, v[242:243] offset:44800
 ds_write_b64 v22, v[244:245] offset:44808
 ds_write_b64 v16, v[246:247] offset:44864
 s_waitcnt vmcnt(0) lgkmcnt(0)
 s_barrier
 ds_read_b128 v[224:227], v23 offset:0
 ds_read_b128 v[228:231], v23 offset:64
 ds_read_b128 v[232:235], v23 offset:128
 ds_read_b128 v[236:239], v23 offset:192
 ds_read_b128 v[240:243], v23 offset:256
 ds_read_b128 v[244:247], v23 offset:320
 s_waitcnt lgkmcnt(0)
 s_add_u32 s21, s48, 0
 buffer_store_dwordx4 v[224:227], v26, s[16:19], s21 offen offset:0 sc1
 buffer_store_dwordx4 v[228:231], v26, s[16:19], s21 offen offset:1024 sc1
 buffer_store_dwordx4 v[232:235], v26, s[16:19], s21 offen offset:2048 sc1
 buffer_store_dwordx4 v[236:239], v26, s[16:19], s21 offen offset:3072 sc1
 s_add_u32 s21, s48, 4096
 buffer_store_dwordx4 v[240:243], v26, s[16:19], s21 offen offset:0 sc1
 buffer_store_dwordx4 v[244:247], v26, s[16:19], s21 offen offset:1024 sc1
 s_nop 1
 ds_read_b128 v[224:227], v23 offset:6400
 ds_read_b128 v[228:231], v23 offset:6464
 ds_read_b128 v[232:235], v23 offset:6528
 ds_read_b128 v[236:239], v23 offset:6592
 ds_read_b128 v[240:243], v23 offset:6656
 ds_read_b128 v[244:247], v23 offset:6720
 s_waitcnt lgkmcnt(0)
 buffer_store_dwordx4 v[224:227], v26, s[16:19], s21 offen offset:2048 sc1
 buffer_store_dwordx4 v[228:231], v26, s[16:19], s21 offen offset:3072 sc1
 s_add_u32 s21, s48, 8192
 buffer_store_dwordx4 v[232:235], v26, s[16:19], s21 offen offset:0 sc1
 buffer_store_dwordx4 v[236:239], v26, s[16:19], s21 offen offset:1024 sc1
 buffer_store_dwordx4 v[240:243], v26, s[16:19], s21 offen offset:2048 sc1
 buffer_store_dwordx4 v[244:247], v26, s[16:19], s21 offen offset:3072 sc1
 s_nop 1
 s_waitcnt vmcnt(0)
 s_barrier
 s_cmp_lg_u32 s20, 0
 s_cbranch_scc1 af_134
 v_mov_b32 v4, 0
 v_mov_b32 v5, 1
 s_mov_b64 exec, 1
 buffer_atomic_add v5, v4, s[72:75], s61 offen sc1
 s_mov_b64 exec, -1
 s_nop 1
af_134:
 s_cmp_lg_u32 s43, 0
 s_cbranch_scc1 kv_fin
 s_mov_b32 s87, -2
 s_add_u32 s21, s42, 32
 s_branch do_opb2
kv_help:
 s_waitcnt vmcnt(0) lgkmcnt(0)
 s_barrier
 s_load_dwordx2 s[4:5], s[0:1], 0
 s_load_dwordx2 s[6:7], s[0:1], 24
 s_load_dwordx2 s[36:37], s[0:1], 32
 s_load_dwordx2 s[38:39], s[0:1], 104
 s_and_b32 s43, s3, 1
 s_bfe_u32 s42, s3, 0x50001
 s_lshr_b32 s40, s42, 2
 s_waitcnt lgkmcnt(0)
 s_cmp_eq_u32 s43, 1
 s_cselect_b32 s6, s36, s6
 s_cselect_b32 s7, s37, s7
 s_mov_b32 s8, s4
 s_mov_b32 s9, s5
 s_mov_b32 s10, 2621440
 s_mov_b32 s11, 0x00020000
 s_mov_b32 s12, s6
 s_mov_b32 s13, s7
 s_mov_b32 s14, 7864320
 s_mov_b32 s15, 0x00020000
 s_mov_b32 s16, s38
 s_mov_b32 s17, s39
 s_mov_b32 s18, 50331648
 s_mov_b32 s19, 0x00020000
 s_mul_i32 s44, s42, 384
 s_mov_b32 s28, 1572864
 s_mov_b32 s43, 2
 s_load_dwordx2 s[6:7], s[0:1], 16
 s_waitcnt lgkmcnt(0)
 s_mov_b32 s12, s6
 s_mov_b32 s13, s7
 s_mov_b32 s14, 7864320
 s_mov_b32 s15, 0x00020000
 s_add_u32 s16, s38, 57671680
 s_addc_u32 s17, s39, 0
 s_mov_b32 s18, 3145728
 s_mov_b32 s19, 0x00020000
 s_mov_b32 s24, 2293760
 s_mov_b32 s25, 163840
 v_mov_b32 v9, 2731
 s_and_b32 s22, s20, 1
 s_lshl_b32 s22, s22, 2
 v_add_u32 v8, 0, v1
 v_mul_u32_u24 v7, v8, v9
 v_lshrrev_b32 v7, 16, v7
 v_mul_u32_u24 v4, 24, v7
 v_sub_u32 v8, v8, v4
 v_and_b32 v4, 2, v7
 v_xor_b32 v8, v8, v4
 v_xor_b32 v8, s22, v8
 v_xor_b32 v5, 4, v8
 s_mov_b32 s21, 12288
 v_mul_lo_u32 v7, v7, s21
 v_lshl_add_u32 v40, v8, 4, v7
 v_lshl_add_u32 v43, v5, 4, v7
 v_add_u32 v8, 64, v1
 v_mul_u32_u24 v7, v8, v9
 v_lshrrev_b32 v7, 16, v7
 v_mul_u32_u24 v4, 24, v7
 v_sub_u32 v8, v8, v4
 v_and_b32 v4, 2, v7
 v_xor_b32 v8, v8, v4
 v_xor_b32 v8, s22, v8
 v_xor_b32 v5, 4, v8
 s_mov_b32 s21, 12288
 v_mul_lo_u32 v7, v7, s21
 v_lshl_add_u32 v41, v8, 4, v7
 v_lshl_add_u32 v44, v5, 4, v7
 v_add_u32 v8, 128, v1
 v_mul_u32_u24 v7, v8, v9
 v_lshrrev_b32 v7, 16, v7
 v_mul_u32_u24 v4, 24, v7
 v_sub_u32 v8, v8, v4
 v_and_b32 v4, 2, v7
 v_xor_b32 v8, v8, v4
 v_xor_b32 v8, s22, v8
 v_xor_b32 v5, 4, v8
 s_mov_b32 s21, 12288
 v_mul_lo_u32 v7, v7, s21
 v_lshl_add_u32 v42, v8, 4, v7
 v_lshl_add_u32 v45, v5, 4, v7
 s_mul_i32 s23, s20, 491520
 s_add_u32 s23, s23, s44
 s_mul_i32 s22, s20, 15360
 s_add_u32 s22, s22, 98304
 s_add_u32 s21, s23, 0
 s_waitcnt vmcnt(3)
 s_add_u32 m0, s22, 0
 s_nop 0
 buffer_load_dwordx4 v40, s[12:15], s21 offen lds
 s_add_u32 m0, s22, 1024
 s_nop 0
 buffer_load_dwordx4 v41, s[12:15], s21 offen lds
 s_add_u32 m0, s22, 2048
 s_nop 0
 buffer_load_dwordx4 v42, s[12:15], s21 offen lds
 s_add_u32 s21, s23, 98304
 s_waitcnt vmcnt(3)
 s_add_u32 m0, s22, 3072
 s_nop 0
 buffer_load_dwordx4 v43, s[12:15], s21 offen lds
 s_add_u32 m0, s22, 4096
 s_nop 0
 buffer_load_dwordx4 v44, s[12:15], s21 offen lds
 s_add_u32 m0, s22, 5120
 s_nop 0
 buffer_load_dwordx4 v45, s[12:15], s21 offen lds
 s_add_u32 s21, s23, 196608
 s_waitcnt vmcnt(3)
 s_add_u32 m0, s22, 6144
 s_nop 0
 buffer_load_dwordx4 v40, s[12:15], s21 offen lds
 s_add_u32 m0, s22, 7168
 s_nop 0
 buffer_load_dwordx4 v41, s[12:15], s21 offen lds
 s_add_u32 m0, s22, 8192
 s_nop 0
 buffer_load_dwordx4 v42, s[12:15], s21 offen lds
 s_add_u32 s21, s23, 294912
 s_waitcnt vmcnt(3)
 s_add_u32 m0, s22, 9216
 s_nop 0
 buffer_load_dwordx4 v43, s[12:15], s21 offen lds
 s_add_u32 m0, s22, 10240
 s_nop 0
 buffer_load_dwordx4 v44, s[12:15], s21 offen lds
 s_add_u32 m0, s22, 11264
 s_nop 0
 buffer_load_dwordx4 v45, s[12:15], s21 offen lds
 s_add_u32 s21, s23, 393216
 s_waitcnt vmcnt(3)
 s_add_u32 m0, s22, 12288
 s_nop 0
 buffer_load_dwordx4 v40, s[12:15], s21 offen lds
 s_add_u32 m0, s22, 13312
 s_nop 0
 buffer_load_dwordx4 v41, s[12:15], s21 offen lds
 s_add_u32 m0, s22, 14336
 s_nop 0
 buffer_load_dwordx4 v42, s[12:15], s21 offen lds
 s_add_u32 s21, s23, 1966080
 s_waitcnt vmcnt(3)
 buffer_load_dwordx4 v[64:67], v40, s[12:15], s21 offen
 buffer_load_dwordx4 v[68:71], v41, s[12:15], s21 offen
 buffer_load_dwordx4 v[72:75], v42, s[12:15], s21 offen
 s_add_u32 s21, s23, 2064384
 s_waitcnt vmcnt(3)
 buffer_load_dwordx4 v[76:79], v43, s[12:15], s21 offen
 buffer_load_dwordx4 v[80:83], v44, s[12:15], s21 offen
 buffer_load_dwordx4 v[84:87], v45, s[12:15], s21 offen
 s_add_u32 s21, s23, 2162688
 s_waitcnt vmcnt(3)
 buffer_load_dwordx4 v[88:91], v40, s[12:15], s21 offen
 buffer_load_dwordx4 v[92:95], v41, s[12:15], s21 offen
 buffer_load_dwordx4 v[96:99], v42, s[12:15], s21 offen
 s_add_u32 s21, s23, 2260992
 s_waitcnt vmcnt(3)
 buffer_load_dwordx4 v[100:103], v43, s[12:15], s21 offen
 buffer_load_dwordx4 v[104:107], v44, s[12:15], s21 offen
 buffer_load_dwordx4 v[108:111], v45, s[12:15], s21 offen
 s_add_u32 s21, s23, 2359296
 s_waitcnt vmcnt(3)
 buffer_load_dwordx4 v[112:115], v40, s[12:15], s21 offen
 buffer_load_dwordx4 v[116:119], v41, s[12:15], s21 offen
 buffer_load_dwordx4 v[120:123], v42, s[12:15], s21 offen
 s_add_u32 s21, s23, 3932160
 s_waitcnt vmcnt(3)
 buffer_load_dwordx4 v[124:127], v40, s[12:15], s21 offen
 buffer_load_dwordx4 v[128:131], v41, s[12:15], s21 offen
 buffer_load_dwordx4 v[132:135], v42, s[12:15], s21 offen
 s_add_u32 s21, s23, 4030464
 s_waitcnt vmcnt(3)
 buffer_load_dwordx4 v[136:139], v43, s[12:15], s21 offen
 buffer_load_dwordx4 v[140:143], v44, s[12:15], s21 offen
 buffer_load_dwordx4 v[144:147], v45, s[12:15], s21 offen
 s_add_u32 s21, s23, 4128768
 s_waitcnt vmcnt(3)
 buffer_load_dwordx4 v[148:151], v40, s[12:15], s21 offen
 buffer_load_dwordx4 v[152:155], v41, s[12:15], s21 offen
 buffer_load_dwordx4 v[156:159], v42, s[12:15], s21 offen
 s_add_u32 s21, s23, 4227072
 s_waitcnt vmcnt(3)
 buffer_load_dwordx4 v[160:163], v43, s[12:15], s21 offen
 buffer_load_dwordx4 v[164:167], v44, s[12:15], s21 offen
 buffer_load_dwordx4 v[168:171], v45, s[12:15], s21 offen
 s_add_u32 s21, s23, 4325376
 s_waitcnt vmcnt(3)
 buffer_load_dwordx4 v[172:175], v40, s[12:15], s21 offen
 buffer_load_dwordx4 v[176:179], v41, s[12:15], s21 offen
 buffer_load_dwordx4 v[180:183], v42, s[12:15], s21 offen
 s_add_u32 s21, s23, 5898240
 s_waitcnt vmcnt(3)
 buffer_load_dwordx4 v[184:187], v40, s[12:15], s21 offen
 buffer_load_dwordx4 v[188:191], v41, s[12:15], s21 offen
 buffer_load_dwordx4 v[192:195], v42, s[12:15], s21 offen
 s_add_u32 s21, s23, 5996544
 s_waitcnt vmcnt(3)
 buffer_load_dwordx4 v[196:199], v43, s[12:15], s21 offen
 buffer_load_dwordx4 v[200:203], v44, s[12:15], s21 offen
 buffer_load_dwordx4 v[204:207], v45, s[12:15], s21 offen
 s_add_u32 s21, s23, 6094848
 s_waitcnt vmcnt(3)
 buffer_load_dwordx4 v[208:211], v40, s[12:15], s21 offen
 buffer_load_dwordx4 v[212:215], v41, s[12:15], s21 offen
 buffer_load_dwordx4 v[216:219], v42, s[12:15], s21 offen
 s_add_u32 s21, s23, 6193152
 s_waitcnt vmcnt(3)
 buffer_load_dwordx4 v[220:223], v43, s[12:15], s21 offen
 buffer_load_dwordx4 v[224:227], v44, s[12:15], s21 offen
 buffer_load_dwordx4 v[228:231], v45, s[12:15], s21 offen
 s_add_u32 s21, s23, 6291456
 s_waitcnt vmcnt(3)
 buffer_load_dwordx4 v[232:235], v40, s[12:15], s21 offen
 buffer_load_dwordx4 v[236:239], v41, s[12:15], s21 offen
 buffer_load_dwordx4 v[240:243], v42, s[12:15], s21 offen
 v_lshl_add_u32 v49, v1, 4, s22
 v_lshrrev_b32 v7, 2, v2
 v_and_b32 v4, 2, v7
 v_and_b32 v5, 1, v3
 v_lshl_or_b32 v4, v5, 2, v4
 v_lshl_add_u32 v7, v3, 3, v7
 v_mul_u32_u24 v7, 384, v7
 v_and_b32 v5, 1, v2
 v_lshl_add_u32 v7, v5, 3, v7
 v_add_u32 v7, 98304, v7
 v_bfe_u32 v8, v2, 1, 1
 s_mul_i32 s21, s20, 6
 v_add_u32 v8, s21, v8
 v_add_u32 v5, 0, v8
 v_xor_b32 v5, v5, v4
 v_lshl_add_u32 v46, v5, 4, v7
 v_add_u32 v5, 2, v8
 v_xor_b32 v5, v5, v4
 v_lshl_add_u32 v47, v5, 4, v7
 v_add_u32 v5, 4, v8
 v_xor_b32 v5, v5, v4
 v_lshl_add_u32 v48, v5, 4, v7
 s_waitcnt vmcnt(45)
 s_barrier
 ds_read_b64_tr_b16 a[0:1], v46 offset:0
 ds_read_b64_tr_b16 a[2:3], v46 offset:1536
 ds_read_b64_tr_b16 a[4:5], v47 offset:0
 ds_read_b64_tr_b16 a[6:7], v47 offset:1536
 ds_read_b64_tr_b16 a[8:9], v48 offset:0
 ds_read_b64_tr_b16 a[10:11], v48 offset:1536
 ds_read_b64_tr_b16 a[12:13], v46 offset:12288
 ds_read_b64_tr_b16 a[14:15], v46 offset:13824
 ds_read_b64_tr_b16 a[16:17], v47 offset:12288
 ds_read_b64_tr_b16 a[18:19], v47 offset:13824
 ds_read_b64_tr_b16 a[20:21], v48 offset:12288
 ds_read_b64_tr_b16 a[22:23], v48 offset:13824
 ds_read_b64_tr_b16 a[24:25], v46 offset:24576
 ds_read_b64_tr_b16 a[26:27], v46 offset:26112
 ds_read_b64_tr_b16 a[28:29], v47 offset:24576
 ds_read_b64_tr_b16 a[30:31], v47 offset:26112
 ds_read_b64_tr_b16 a[32:33], v48 offset:24576
 ds_read_b64_tr_b16 a[34:35], v48 offset:26112
 ds_read_b64_tr_b16 a[36:37], v46 offset:36864
 ds_read_b64_tr_b16 a[38:39], v46 offset:38400
 ds_read_b64_tr_b16 a[40:41], v47 offset:36864
 ds_read_b64_tr_b16 a[42:43], v47 offset:38400
 ds_read_b64_tr_b16 a[44:45], v48 offset:36864
 ds_read_b64_tr_b16 a[46:47], v48 offset:38400
 ds_read_b64_tr_b16 a[48:49], v46 offset:49152
 ds_read_b64_tr_b16 a[50:51], v46 offset:50688
 ds_read_b64_tr_b16 a[52:53], v47 offset:49152
 ds_read_b64_tr_b16 a[54:55], v47 offset:50688
 ds_read_b64_tr_b16 a[56:57], v48 offset:49152
 ds_read_b64_tr_b16 a[58:59], v48 offset:50688
 v_lshrrev_b32 v11, 3, v1
 v_and_b32 v12, 7, v1
 v_xor_b32 v12, v12, v11
 v_mul_u32_u24 v11, 1280, v11
 v_lshl_add_u32 v10, v12, 4, v11
 s_mul_i32 s46, s20, 40960
 v_add_u32 v10, s46, v10
 s_lshl_b32 s47, s20, 12
 s_add_u32 s47, s47, 0
 s_add_u32 s46, s47, 98304
 s_mov_b32 s30, s24
 s_add_u32 s32, s47, 32768
 v_add_u32 v11, 9216, v10
 v_add_u32 v12, 18432, v10
 v_add_u32 v13, 27648, v10
 s_mov_b32 m0, s32
 s_nop 0
 buffer_load_dwordx4 v10, s[8:11], s30 offen offset:0 lds
 buffer_load_dwordx4 v11, s[8:11], s30 offen offset:1024 lds
 buffer_load_dwordx4 v12, s[8:11], s30 offen offset:2048 lds
 buffer_load_dwordx4 v13, s[8:11], s30 offen offset:3072 lds
 s_add_u32 s30, s30, 128
 s_add_u32 s32, s32, 16384
 s_cmp_lt_u32 s32, s46
 s_cselect_b32 s32, s32, s47
 s_mov_b32 m0, s32
 s_nop 0
 buffer_load_dwordx4 v10, s[8:11], s30 offen offset:0 lds
 buffer_load_dwordx4 v11, s[8:11], s30 offen offset:1024 lds
 buffer_load_dwordx4 v12, s[8:11], s30 offen offset:2048 lds
 buffer_load_dwordx4 v13, s[8:11], s30 offen offset:3072 lds
 s_add_u32 s30, s30, 128
 s_add_u32 s32, s32, 16384
 s_cmp_lt_u32 s32, s46
 s_cselect_b32 s32, s32, s47
 s_mov_b32 m0, s32
 s_nop 0
 buffer_load_dwordx4 v10, s[8:11], s30 offen offset:0 lds
 buffer_load_dwordx4 v11, s[8:11], s30 offen offset:1024 lds
 buffer_load_dwordx4 v12, s[8:11], s30 offen offset:2048 lds
 buffer_load_dwordx4 v13, s[8:11], s30 offen offset:3072 lds
 s_add_u32 s30, s30, 128
 s_add_u32 s32, s32, 16384
 s_cmp_lt_u32 s32, s46
 s_cselect_b32 s32, s32, s47
 s_mov_b32 m0, s32
 s_nop 0
 buffer_load_dwordx4 v10, s[8:11], s30 offen offset:0 lds
 buffer_load_dwordx4 v11, s[8:11], s30 offen offset:1024 lds
 buffer_load_dwordx4 v12, s[8:11], s30 offen offset:2048 lds
 buffer_load_dwordx4 v13, s[8:11], s30 offen offset:3072 lds
 s_add_u32 s30, s30, 128
 s_add_u32 s32, s32, 16384
 s_cmp_lt_u32 s32, s46
 s_cselect_b32 s32, s32, s47
 s_waitcnt lgkmcnt(0)
 s_barrier
 s_waitcnt vmcnt(46)
 ds_write_b128 v49, v[64:67] offset:0
 ds_write_b128 v49, v[68:71] offset:1024
 ds_write_b128 v49, v[72:75] offset:2048
 ds_write_b128 v49, v[76:79] offset:3072
 ds_write_b128 v49, v[80:83] offset:4096
 ds_write_b128 v49, v[84:87] offset:5120
 ds_write_b128 v49, v[88:91] offset:6144
 ds_write_b128 v49, v[92:95] offset:7168
 ds_write_b128 v49, v[96:99] offset:8192
 ds_write_b128 v49, v[100:103] offset:9216
 ds_write_b128 v49, v[104:107] offset:10240
 ds_write_b128 v49, v[108:111] offset:11264
 ds_write_b128 v49, v[112:115] offset:12288
 ds_write_b128 v49, v[116:119] offset:13312
 ds_write_b128 v49, v[120:123] offset:14336
 s_waitcnt lgkmcnt(0)
 s_barrier
 ds_read_b64_tr_b16 a[60:61], v46 offset:0
 ds_read_b64_tr_b16 a[62:63], v46 offset:1536
 ds_read_b64_tr_b16 a[64:65], v47 offset:0
 ds_read_b64_tr_b16 a[66:67], v47 offset:1536
 ds_read_b64_tr_b16 a[68:69], v48 offset:0
 ds_read_b64_tr_b16 a[70:71], v48 offset:1536
 ds_read_b64_tr_b16 a[72:73], v46 offset:12288
 ds_read_b64_tr_b16 a[74:75], v46 offset:13824
 ds_read_b64_tr_b16 a[76:77], v47 offset:12288
 ds_read_b64_tr_b16 a[78:79], v47 offset:13824
 ds_read_b64_tr_b16 a[80:81], v48 offset:12288
 ds_read_b64_tr_b16 a[82:83], v48 offset:13824
 ds_read_b64_tr_b16 a[84:85], v46 offset:24576
 ds_read_b64_tr_b16 a[86:87], v46 offset:26112
 ds_read_b64_tr_b16 a[88:89], v47 offset:24576
 ds_read_b64_tr_b16 a[90:91], v47 offset:26112
 ds_read_b64_tr_b16 a[92:93], v48 offset:24576
 ds_read_b64_tr_b16 a[94:95], v48 offset:26112
 ds_read_b64_tr_b16 a[96:97], v46 offset:36864
 ds_read_b64_tr_b16 a[98:99], v46 offset:38400
 ds_read_b64_tr_b16 a[100:101], v47 offset:36864
 ds_read_b64_tr_b16 a[102:103], v47 offset:38400
 ds_read_b64_tr_b16 a[104:105], v48 offset:36864
 ds_read_b64_tr_b16 a[106:107], v48 offset:38400
 ds_read_b64_tr_b16 a[108:109], v46 offset:49152
 ds_read_b64_tr_b16 a[110:111], v46 offset:50688
 ds_read_b64_tr_b16 a[112:113], v47 offset:49152
 ds_read_b64_tr_b16 a[114:115], v47 offset:50688
 ds_read_b64_tr_b16 a[116:117], v48 offset:49152
 ds_read_b64_tr_b16 a[118:119], v48 offset:50688
 s_waitcnt lgkmcnt(0)
 s_barrier
 s_waitcnt vmcnt(31)
 ds_write_b128 v49, v[124:127] offset:0
 ds_write_b128 v49, v[128:131] offset:1024
 ds_write_b128 v49, v[132:135] offset:2048
 ds_write_b128 v49, v[136:139] offset:3072
 ds_write_b128 v49, v[140:143] offset:4096
 ds_write_b128 v49, v[144:147] offset:5120
 ds_write_b128 v49, v[148:151] offset:6144
 ds_write_b128 v49, v[152:155] offset:7168
 ds_write_b128 v49, v[156:159] offset:8192
 ds_write_b128 v49, v[160:163] offset:9216
 ds_write_b128 v49, v[164:167] offset:10240
 ds_write_b128 v49, v[168:171] offset:11264
 ds_write_b128 v49, v[172:175] offset:12288
 ds_write_b128 v49, v[176:179] offset:13312
 ds_write_b128 v49, v[180:183] offset:14336
 s_waitcnt lgkmcnt(0)
 s_barrier
 ds_read_b64_tr_b16 a[120:121], v46 offset:0
 ds_read_b64_tr_b16 a[122:123], v46 offset:1536
 ds_read_b64_tr_b16 a[124:125], v47 offset:0
 ds_read_b64_tr_b16 a[126:127], v47 offset:1536
 ds_read_b64_tr_b16 a[128:129], v48 offset:0
 ds_read_b64_tr_b16 a[130:131], v48 offset:1536
 ds_read_b64_tr_b16 a[132:133], v46 offset:12288
 ds_read_b64_tr_b16 a[134:135], v46 offset:13824
 ds_read_b64_tr_b16 a[136:137], v47 offset:12288
 ds_read_b64_tr_b16 a[138:139], v47 offset:13824
 ds_read_b64_tr_b16 a[140:141], v48 offset:12288
 ds_read_b64_tr_b16 a[142:143], v48 offset:13824
 ds_read_b64_tr_b16 a[144:145], v46 offset:24576
 ds_read_b64_tr_b16 a[146:147], v46 offset:26112
 ds_read_b64_tr_b16 a[148:149], v47 offset:24576
 ds_read_b64_tr_b16 a[150:151], v47 offset:26112
 ds_read_b64_tr_b16 a[152:153], v48 offset:24576
 ds_read_b64_tr_b16 a[154:155], v48 offset:26112
 ds_read_b64_tr_b16 a[156:157], v46 offset:36864
 ds_read_b64_tr_b16 a[158:159], v46 offset:38400
 ds_read_b64_tr_b16 a[160:161], v47 offset:36864
 ds_read_b64_tr_b16 a[162:163], v47 offset:38400
 ds_read_b64_tr_b16 a[164:165], v48 offset:36864
 ds_read_b64_tr_b16 a[166:167], v48 offset:38400
 ds_read_b64_tr_b16 a[168:169], v46 offset:49152
 ds_read_b64_tr_b16 a[170:171], v46 offset:50688
 ds_read_b64_tr_b16 a[172:173], v47 offset:49152
 ds_read_b64_tr_b16 a[174:175], v47 offset:50688
 ds_read_b64_tr_b16 a[176:177], v48 offset:49152
 ds_read_b64_tr_b16 a[178:179], v48 offset:50688
 s_waitcnt lgkmcnt(0)
 s_barrier
 s_waitcnt vmcnt(16)
 ds_write_b128 v49, v[184:187] offset:0
 ds_write_b128 v49, v[188:191] offset:1024
 ds_write_b128 v49, v[192:195] offset:2048
 ds_write_b128 v49, v[196:199] offset:3072
 ds_write_b128 v49, v[200:203] offset:4096
 ds_write_b128 v49, v[204:207] offset:5120
 ds_write_b128 v49, v[208:211] offset:6144
 ds_write_b128 v49, v[212:215] offset:7168
 ds_write_b128 v49, v[216:219] offset:8192
 ds_write_b128 v49, v[220:223] offset:9216
 ds_write_b128 v49, v[224:227] offset:10240
 ds_write_b128 v49, v[228:231] offset:11264
 ds_write_b128 v49, v[232:235] offset:12288
 ds_write_b128 v49, v[236:239] offset:13312
 ds_write_b128 v49, v[240:243] offset:14336
 s_waitcnt lgkmcnt(0)
 s_barrier
 ds_read_b64_tr_b16 a[180:181], v46 offset:0
 ds_read_b64_tr_b16 a[182:183], v46 offset:1536
 ds_read_b64_tr_b16 a[184:185], v47 offset:0
 ds_read_b64_tr_b16 a[186:187], v47 offset:1536
 ds_read_b64_tr_b16 a[188:189], v48 offset:0
 ds_read_b64_tr_b16 a[190:191], v48 offset:1536
 ds_read_b64_tr_b16 a[192:193], v46 offset:12288
 ds_read_b64_tr_b16 a[194:195], v46 offset:13824
 ds_read_b64_tr_b16 a[196:197], v47 offset:12288
 ds_read_b64_tr_b16 a[198:199], v47 offset:13824
 ds_read_b64_tr_b16 a[200:201], v48 offset:12288
 ds_read_b64_tr_b16 a[202:203], v48 offset:13824
 ds_read_b64_tr_b16 a[204:205], v46 offset:24576
 ds_read_b64_tr_b16 a[206:207], v46 offset:26112
 ds_read_b64_tr_b16 a[208:209], v47 offset:24576
 ds_read_b64_tr_b16 a[210:211], v47 offset:26112
 ds_read_b64_tr_b16 a[212:213], v48 offset:24576
 ds_read_b64_tr_b16 a[214:215], v48 offset:26112
 ds_read_b64_tr_b16 a[216:217], v46 offset:36864
 ds_read_b64_tr_b16 a[218:219], v46 offset:38400
 ds_read_b64_tr_b16 a[220:221], v47 offset:36864
 ds_read_b64_tr_b16 a[222:223], v47 offset:38400
 ds_read_b64_tr_b16 a[224:225], v48 offset:36864
 ds_read_b64_tr_b16 a[226:227], v48 offset:38400
 ds_read_b64_tr_b16 a[228:229], v46 offset:49152
 ds_read_b64_tr_b16 a[230:231], v46 offset:50688
 ds_read_b64_tr_b16 a[232:233], v47 offset:49152
 ds_read_b64_tr_b16 a[234:235], v47 offset:50688
 ds_read_b64_tr_b16 a[236:237], v48 offset:49152
 ds_read_b64_tr_b16 a[238:239], v48 offset:50688
 s_waitcnt lgkmcnt(0)
 s_barrier
 s_mov_b32 s26, 2
 s_mul_i32 s27, s42, 12288
 s_lshl_b32 s60, s42, 7
 s_add_u32 s60, s60, 123904
 s_mov_b32 s62, 0
 s_branch kv_main
kv_fin:
 s_cmp_eq_u32 s43, 2
 s_cbranch_scc1 q_final
 s_branch queue
not_kv:
 s_cmp_ge_u32 s3, 96
 s_cbranch_scc1 not_vw
 s_sub_u32 s2, s3, 64
 s_load_dwordx2 s[72:73], s[0:1], 104
 s_waitcnt lgkmcnt(0)
 s_add_u32 s72, s72, 81068032
 s_addc_u32 s73, s73, 0
 s_mov_b32 s74, 128000
 s_mov_b32 s75, 0x00020000
 s_add_u32 s8, s38, 78643200
 s_addc_u32 s9, s39, 0
 s_mov_b32 s10, 2162688
 s_mov_b32 s11, 0x00020000
 s_add_u32 s12, s38, 50331648
 s_addc_u32 s13, s39, 0
 s_mov_b32 s14, 12582912
 s_mov_b32 s15, 0x00020000
 s_add_u32 s16, s38, 83886079
 s_addc_u32 s17, s39, 0
 s_and_b32 s16, s16, 0xffe00000
 s_mov_b32 s18, 2097152
 s_mov_b32 s19, 0x00020000
 v_lshlrev_b32 v8, 4, v0
 v_lshlrev_b32 v9, 4, v1
 v_mov_b32 v4, 0
 v_mov_b32 v12, -1
 v_mov_b32 v5, 0
 v_mov_b32 v13, -1
 v_mov_b32 v6, 0
 v_mov_b32 v14, -1
 v_mov_b32 v7, 0
 v_mov_b32 v15, -1
 s_lshl_b32 s21, s2, 12
 buffer_store_dwordx4 v[4:7], v8, s[72:75], s21 offen sc1
 s_lshr_b32 s21, s2, 3
 s_lshl_b32 s21, s21, 15
 s_bfe_u32 s22, s2, 0x10002
 s_lshl_b32 s22, s22, 13
 s_add_u32 s21, s21, s22
 s_bfe_u32 s22, s2, 0x10001
 s_lshl_b32 s22, s22, 14
 s_add_u32 s21, s21, s22
 s_and_b32 s22, s2, 1
 s_mul_i32 s22, s22, 3
 s_add_u32 s22, s22, s20
 s_lshl_b32 s22, s22, 10
 s_add_u32 s21, s21, s22
 s_cmp_lt_u32 s20, 3
 s_cselect_b32 s21, s21, 0x80000000
 buffer_store_dwordx4 v[4:7], v9, s[16:19], s21 offen sc1
 s_mul_i32 s23, s20, 540672
 s_lshl_b32 s21, s2, 11
 s_add_u32 s21, s21, s23
 s_add_u32 s21, s21, 81920
 buffer_store_dwordx4 v[12:15], v9, s[8:11], s21 offen sc1
 buffer_store_dwordx4 v[12:15], v9, s[8:11], s21 offen offset:1024 sc1
 s_mul_i32 s21, s2, 3072
 s_add_u32 s21, s21, s23
 s_add_u32 s21, s21, 278528
 buffer_store_dwordx4 v[12:15], v9, s[8:11], s21 offen sc1
 buffer_store_dwordx4 v[12:15], v9, s[8:11], s21 offen offset:1024 sc1
 buffer_store_dwordx4 v[12:15], v9, s[8:11], s21 offen offset:2048 sc1
 s_lshl_b32 s21, s2, 9
 s_add_u32 s21, s21, s23
 s_add_u32 s21, s21, 376832
 s_mov_b64 exec, 0xffffffff
 buffer_store_dwordx4 v[12:15], v9, s[8:11], s21 offen sc1
 s_mov_b64 exec, -1
 s_lshl_b32 s21, s20, 5
 s_add_u32 s21, s21, s2
 s_mul_i32 s21, s21, 3072
 s_cmp_lt_u32 s20, 3
 s_cselect_b32 s21, s21, 0x80000000
 s_add_u32 s22, s21, 6291456
 buffer_store_dwordx4 v[12:15], v9, s[12:15], s21 offen offset:0 sc1
 buffer_store_dwordx4 v[12:15], v9, s[12:15], s22 offen offset:0 sc1
 buffer_store_dwordx4 v[12:15], v9, s[12:15], s21 offen offset:1024 sc1
 buffer_store_dwordx4 v[12:15], v9, s[12:15], s22 offen offset:1024 sc1
 buffer_store_dwordx4 v[12:15], v9, s[12:15], s21 offen offset:2048 sc1
 buffer_store_dwordx4 v[12:15], v9, s[12:15], s22 offen offset:2048 sc1
 s_waitcnt vmcnt(0)
 s_barrier
 s_mov_b32 s21, 76
 s_cmp_lg_u32 s20, 0
 s_cbranch_scc1 af_135
 v_mov_b32 v10, 0
 v_mov_b32 v11, 1
 s_mov_b64 exec, 1
 buffer_atomic_add v11, v10, s[32:35], s21 offen sc1
 s_mov_b64 exec, -1
 s_nop 1
af_135:
 s_load_dwordx2 s[6:7], s[0:1], 40
 s_load_dwordx2 s[38:39], s[0:1], 104
 s_waitcnt lgkmcnt(0)
 s_mov_b32 s12, s6
 s_mov_b32 s13, s7
 s_mov_b32 s14, 7864320
 s_mov_b32 s15, 0x00020000
 s_mov_b32 s16, s38
 s_mov_b32 s17, s39
 s_mov_b32 s18, 50331648
 s_mov_b32 s19, 0x00020000
 s_add_u32 s24, s38, 122683392
 s_addc_u32 s25, s39, 0
 s_mov_b32 s26, 83886080
 s_mov_b32 s27, 0x00020000
 s_load_dwordx2 s[72:73], s[0:1], 104
 s_waitcnt lgkmcnt(0)
 s_add_u32 s72, s72, 81068032
 s_addc_u32 s73, s73, 0
 s_mov_b32 s74, 128000
 s_mov_b32 s75, 0x00020000
 v_mov_b32 v29, 52429
 s_mul_i32 s21, s20, 960
 s_add_u32 s21, s21, 0
 v_add_u32 v21, s21, v1
 v_mul_u32_u24 v22, v21, v29
 v_lshrrev_b32 v22, 22, v22
 v_mul_u32_u24 v23, 80, v22
 v_sub_u32 v21, v21, v23
 v_bfe_u32 v23, v22, 3, 1
 v_and_b32 v24, 3, v22
 v_lshl_add_u32 v23, v23, 2, v24
 v_lshlrev_b32 v23, 1, v23
 v_xor_b32 v21, v21, v23
 v_cmp_gt_u32 vcc, 32, v22
 v_bfe_u32 v26, v22, 3, 2
 v_lshl_add_u32 v25, v26, 2, v24
 v_bfe_u32 v26, v22, 2, 1
 v_lshl_add_u32 v25, v26, 4, v25
 v_cndmask_b32 v25, v22, v25, vcc
 v_mul_u32_u24 v25, 1280, v25
 v_lshl_add_u32 v64, v21, 4, v25
 s_mul_i32 s21, s20, 960
 s_add_u32 s21, s21, 64
 v_add_u32 v21, s21, v1
 v_mul_u32_u24 v22, v21, v29
 v_lshrrev_b32 v22, 22, v22
 v_mul_u32_u24 v23, 80, v22
 v_sub_u32 v21, v21, v23
 v_bfe_u32 v23, v22, 3, 1
 v_and_b32 v24, 3, v22
 v_lshl_add_u32 v23, v23, 2, v24
 v_lshlrev_b32 v23, 1, v23
 v_xor_b32 v21, v21, v23
 v_cmp_gt_u32 vcc, 32, v22
 v_bfe_u32 v26, v22, 3, 2
 v_lshl_add_u32 v25, v26, 2, v24
 v_bfe_u32 v26, v22, 2, 1
 v_lshl_add_u32 v25, v26, 4, v25
 v_cndmask_b32 v25, v22, v25, vcc
 v_mul_u32_u24 v25, 1280, v25
 v_lshl_add_u32 v65, v21, 4, v25
 s_mul_i32 s21, s20, 960
 s_add_u32 s21, s21, 128
 v_add_u32 v21, s21, v1
 v_mul_u32_u24 v22, v21, v29
 v_lshrrev_b32 v22, 22, v22
 v_mul_u32_u24 v23, 80, v22
 v_sub_u32 v21, v21, v23
 v_bfe_u32 v23, v22, 3, 1
 v_and_b32 v24, 3, v22
 v_lshl_add_u32 v23, v23, 2, v24
 v_lshlrev_b32 v23, 1, v23
 v_xor_b32 v21, v21, v23
 v_cmp_gt_u32 vcc, 32, v22
 v_bfe_u32 v26, v22, 3, 2
 v_lshl_add_u32 v25, v26, 2, v24
 v_bfe_u32 v26, v22, 2, 1
 v_lshl_add_u32 v25, v26, 4, v25
 v_cndmask_b32 v25, v22, v25, vcc
 v_mul_u32_u24 v25, 1280, v25
 v_lshl_add_u32 v66, v21, 4, v25
 s_mul_i32 s21, s20, 960
 s_add_u32 s21, s21, 192
 v_add_u32 v21, s21, v1
 v_mul_u32_u24 v22, v21, v29
 v_lshrrev_b32 v22, 22, v22
 v_mul_u32_u24 v23, 80, v22
 v_sub_u32 v21, v21, v23
 v_bfe_u32 v23, v22, 3, 1
 v_and_b32 v24, 3, v22
 v_lshl_add_u32 v23, v23, 2, v24
 v_lshlrev_b32 v23, 1, v23
 v_xor_b32 v21, v21, v23
 v_cmp_gt_u32 vcc, 32, v22
 v_bfe_u32 v26, v22, 3, 2
 v_lshl_add_u32 v25, v26, 2, v24
 v_bfe_u32 v26, v22, 2, 1
 v_lshl_add_u32 v25, v26, 4, v25
 v_cndmask_b32 v25, v22, v25, vcc
 v_mul_u32_u24 v25, 1280, v25
 v_lshl_add_u32 v67, v21, 4, v25
 s_mul_i32 s21, s20, 960
 s_add_u32 s21, s21, 256
 v_add_u32 v21, s21, v1
 v_mul_u32_u24 v22, v21, v29
 v_lshrrev_b32 v22, 22, v22
 v_mul_u32_u24 v23, 80, v22
 v_sub_u32 v21, v21, v23
 v_bfe_u32 v23, v22, 3, 1
 v_and_b32 v24, 3, v22
 v_lshl_add_u32 v23, v23, 2, v24
 v_lshlrev_b32 v23, 1, v23
 v_xor_b32 v21, v21, v23
 v_cmp_gt_u32 vcc, 32, v22
 v_bfe_u32 v26, v22, 3, 2
 v_lshl_add_u32 v25, v26, 2, v24
 v_bfe_u32 v26, v22, 2, 1
 v_lshl_add_u32 v25, v26, 4, v25
 v_cndmask_b32 v25, v22, v25, vcc
 v_mul_u32_u24 v25, 1280, v25
 v_lshl_add_u32 v68, v21, 4, v25
 s_mul_i32 s21, s20, 960
 s_add_u32 s21, s21, 320
 v_add_u32 v21, s21, v1
 v_mul_u32_u24 v22, v21, v29
 v_lshrrev_b32 v22, 22, v22
 v_mul_u32_u24 v23, 80, v22
 v_sub_u32 v21, v21, v23
 v_bfe_u32 v23, v22, 3, 1
 v_and_b32 v24, 3, v22
 v_lshl_add_u32 v23, v23, 2, v24
 v_lshlrev_b32 v23, 1, v23
 v_xor_b32 v21, v21, v23
 v_cmp_gt_u32 vcc, 32, v22
 v_bfe_u32 v26, v22, 3, 2
 v_lshl_add_u32 v25, v26, 2, v24
 v_bfe_u32 v26, v22, 2, 1
 v_lshl_add_u32 v25, v26, 4, v25
 v_cndmask_b32 v25, v22, v25, vcc
 v_mul_u32_u24 v25, 1280, v25
 v_lshl_add_u32 v69, v21, 4, v25
 s_mul_i32 s21, s20, 960
 s_add_u32 s21, s21, 384
 v_add_u32 v21, s21, v1
 v_mul_u32_u24 v22, v21, v29
 v_lshrrev_b32 v22, 22, v22
 v_mul_u32_u24 v23, 80, v22
 v_sub_u32 v21, v21, v23
 v_bfe_u32 v23, v22, 3, 1
 v_and_b32 v24, 3, v22
 v_lshl_add_u32 v23, v23, 2, v24
 v_lshlrev_b32 v23, 1, v23
 v_xor_b32 v21, v21, v23
 v_cmp_gt_u32 vcc, 32, v22
 v_bfe_u32 v26, v22, 3, 2
 v_lshl_add_u32 v25, v26, 2, v24
 v_bfe_u32 v26, v22, 2, 1
 v_lshl_add_u32 v25, v26, 4, v25
 v_cndmask_b32 v25, v22, v25, vcc
 v_mul_u32_u24 v25, 1280, v25
 v_lshl_add_u32 v70, v21, 4, v25
 s_mul_i32 s21, s20, 960
 s_add_u32 s21, s21, 448
 v_add_u32 v21, s21, v1
 v_mul_u32_u24 v22, v21, v29
 v_lshrrev_b32 v22, 22, v22
 v_mul_u32_u24 v23, 80, v22
 v_sub_u32 v21, v21, v23
 v_bfe_u32 v23, v22, 3, 1
 v_and_b32 v24, 3, v22
 v_lshl_add_u32 v23, v23, 2, v24
 v_lshlrev_b32 v23, 1, v23
 v_xor_b32 v21, v21, v23
 v_cmp_gt_u32 vcc, 32, v22
 v_bfe_u32 v26, v22, 3, 2
 v_lshl_add_u32 v25, v26, 2, v24
 v_bfe_u32 v26, v22, 2, 1
 v_lshl_add_u32 v25, v26, 4, v25
 v_cndmask_b32 v25, v22, v25, vcc
 v_mul_u32_u24 v25, 1280, v25
 v_lshl_add_u32 v71, v21, 4, v25
 s_mul_i32 s21, s20, 960
 s_add_u32 s21, s21, 512
 v_add_u32 v21, s21, v1
 v_mul_u32_u24 v22, v21, v29
 v_lshrrev_b32 v22, 22, v22
 v_mul_u32_u24 v23, 80, v22
 v_sub_u32 v21, v21, v23
 v_bfe_u32 v23, v22, 3, 1
 v_and_b32 v24, 3, v22
 v_lshl_add_u32 v23, v23, 2, v24
 v_lshlrev_b32 v23, 1, v23
 v_xor_b32 v21, v21, v23
 v_cmp_gt_u32 vcc, 32, v22
 v_bfe_u32 v26, v22, 3, 2
 v_lshl_add_u32 v25, v26, 2, v24
 v_bfe_u32 v26, v22, 2, 1
 v_lshl_add_u32 v25, v26, 4, v25
 v_cndmask_b32 v25, v22, v25, vcc
 v_mul_u32_u24 v25, 1280, v25
 v_lshl_add_u32 v72, v21, 4, v25
 s_mul_i32 s21, s20, 960
 s_add_u32 s21, s21, 576
 v_add_u32 v21, s21, v1
 v_mul_u32_u24 v22, v21, v29
 v_lshrrev_b32 v22, 22, v22
 v_mul_u32_u24 v23, 80, v22
 v_sub_u32 v21, v21, v23
 v_bfe_u32 v23, v22, 3, 1
 v_and_b32 v24, 3, v22
 v_lshl_add_u32 v23, v23, 2, v24
 v_lshlrev_b32 v23, 1, v23
 v_xor_b32 v21, v21, v23
 v_cmp_gt_u32 vcc, 32, v22
 v_bfe_u32 v26, v22, 3, 2
 v_lshl_add_u32 v25, v26, 2, v24
 v_bfe_u32 v26, v22, 2, 1
 v_lshl_add_u32 v25, v26, 4, v25
 v_cndmask_b32 v25, v22, v25, vcc
 v_mul_u32_u24 v25, 1280, v25
 v_lshl_add_u32 v73, v21, 4, v25
 s_mul_i32 s21, s20, 960
 s_add_u32 s21, s21, 640
 v_add_u32 v21, s21, v1
 v_mul_u32_u24 v22, v21, v29
 v_lshrrev_b32 v22, 22, v22
 v_mul_u32_u24 v23, 80, v22
 v_sub_u32 v21, v21, v23
 v_bfe_u32 v23, v22, 3, 1
 v_and_b32 v24, 3, v22
 v_lshl_add_u32 v23, v23, 2, v24
 v_lshlrev_b32 v23, 1, v23
 v_xor_b32 v21, v21, v23
 v_cmp_gt_u32 vcc, 32, v22
 v_bfe_u32 v26, v22, 3, 2
 v_lshl_add_u32 v25, v26, 2, v24
 v_bfe_u32 v26, v22, 2, 1
 v_lshl_add_u32 v25, v26, 4, v25
 v_cndmask_b32 v25, v22, v25, vcc
 v_mul_u32_u24 v25, 1280, v25
 v_lshl_add_u32 v74, v21, 4, v25
 s_mul_i32 s21, s20, 960
 s_add_u32 s21, s21, 704
 v_add_u32 v21, s21, v1
 v_mul_u32_u24 v22, v21, v29
 v_lshrrev_b32 v22, 22, v22
 v_mul_u32_u24 v23, 80, v22
 v_sub_u32 v21, v21, v23
 v_bfe_u32 v23, v22, 3, 1
 v_and_b32 v24, 3, v22
 v_lshl_add_u32 v23, v23, 2, v24
 v_lshlrev_b32 v23, 1, v23
 v_xor_b32 v21, v21, v23
 v_cmp_gt_u32 vcc, 32, v22
 v_bfe_u32 v26, v22, 3, 2
 v_lshl_add_u32 v25, v26, 2, v24
 v_bfe_u32 v26, v22, 2, 1
 v_lshl_add_u32 v25, v26, 4, v25
 v_cndmask_b32 v25, v22, v25, vcc
 v_mul_u32_u24 v25, 1280, v25
 v_lshl_add_u32 v75, v21, 4, v25
 s_mul_i32 s21, s20, 960
 s_add_u32 s21, s21, 768
 v_add_u32 v21, s21, v1
 v_mul_u32_u24 v22, v21, v29
 v_lshrrev_b32 v22, 22, v22
 v_mul_u32_u24 v23, 80, v22
 v_sub_u32 v21, v21, v23
 v_bfe_u32 v23, v22, 3, 1
 v_and_b32 v24, 3, v22
 v_lshl_add_u32 v23, v23, 2, v24
 v_lshlrev_b32 v23, 1, v23
 v_xor_b32 v21, v21, v23
 v_cmp_gt_u32 vcc, 32, v22
 v_bfe_u32 v26, v22, 3, 2
 v_lshl_add_u32 v25, v26, 2, v24
 v_bfe_u32 v26, v22, 2, 1
 v_lshl_add_u32 v25, v26, 4, v25
 v_cndmask_b32 v25, v22, v25, vcc
 v_mul_u32_u24 v25, 1280, v25
 v_lshl_add_u32 v76, v21, 4, v25
 s_mul_i32 s21, s20, 960
 s_add_u32 s21, s21, 832
 v_add_u32 v21, s21, v1
 v_mul_u32_u24 v22, v21, v29
 v_lshrrev_b32 v22, 22, v22
 v_mul_u32_u24 v23, 80, v22
 v_sub_u32 v21, v21, v23
 v_bfe_u32 v23, v22, 3, 1
 v_and_b32 v24, 3, v22
 v_lshl_add_u32 v23, v23, 2, v24
 v_lshlrev_b32 v23, 1, v23
 v_xor_b32 v21, v21, v23
 v_cmp_gt_u32 vcc, 32, v22
 v_bfe_u32 v26, v22, 3, 2
 v_lshl_add_u32 v25, v26, 2, v24
 v_bfe_u32 v26, v22, 2, 1
 v_lshl_add_u32 v25, v26, 4, v25
 v_cndmask_b32 v25, v22, v25, vcc
 v_mul_u32_u24 v25, 1280, v25
 v_lshl_add_u32 v77, v21, 4, v25
 s_mul_i32 s21, s20, 960
 s_add_u32 s21, s21, 896
 v_add_u32 v21, s21, v1
 v_mul_u32_u24 v22, v21, v29
 v_lshrrev_b32 v22, 22, v22
 v_mul_u32_u24 v23, 80, v22
 v_sub_u32 v21, v21, v23
 v_bfe_u32 v23, v22, 3, 1
 v_and_b32 v24, 3, v22
 v_lshl_add_u32 v23, v23, 2, v24
 v_lshlrev_b32 v23, 1, v23
 v_xor_b32 v21, v21, v23
 v_cmp_gt_u32 vcc, 32, v22
 v_bfe_u32 v26, v22, 3, 2
 v_lshl_add_u32 v25, v26, 2, v24
 v_bfe_u32 v26, v22, 2, 1
 v_lshl_add_u32 v25, v26, 4, v25
 v_cndmask_b32 v25, v22, v25, vcc
 v_mul_u32_u24 v25, 1280, v25
 v_lshl_add_u32 v78, v21, 4, v25
 s_mul_i32 s40, s2, 245760
 s_add_u32 s21, s40, 0
 s_mul_i32 s22, s20, 15360
 s_add_u32 s22, s22, 0
 s_add_u32 m0, s22, 0
 s_nop 0
 buffer_load_dwordx4 v64, s[12:15], s21 offen lds
 s_add_u32 m0, s22, 1024
 s_nop 0
 buffer_load_dwordx4 v65, s[12:15], s21 offen lds
 s_add_u32 m0, s22, 2048
 s_nop 0
 buffer_load_dwordx4 v66, s[12:15], s21 offen lds
 s_add_u32 m0, s22, 3072
 s_nop 0
 buffer_load_dwordx4 v67, s[12:15], s21 offen lds
 s_add_u32 m0, s22, 4096
 s_nop 0
 buffer_load_dwordx4 v68, s[12:15], s21 offen lds
 s_add_u32 m0, s22, 5120
 s_nop 0
 buffer_load_dwordx4 v69, s[12:15], s21 offen lds
 s_add_u32 m0, s22, 6144
 s_nop 0
 buffer_load_dwordx4 v70, s[12:15], s21 offen lds
 s_add_u32 m0, s22, 7168
 s_nop 0
 buffer_load_dwordx4 v71, s[12:15], s21 offen lds
 s_add_u32 m0, s22, 8192
 s_nop 0
 buffer_load_dwordx4 v72, s[12:15], s21 offen lds
 s_add_u32 m0, s22, 9216
 s_nop 0
 buffer_load_dwordx4 v73, s[12:15], s21 offen lds
 s_add_u32 m0, s22, 10240
 s_nop 0
 buffer_load_dwordx4 v74, s[12:15], s21 offen lds
 s_add_u32 m0, s22, 11264
 s_nop 0
 buffer_load_dwordx4 v75, s[12:15], s21 offen lds
 s_add_u32 m0, s22, 12288
 s_nop 0
 buffer_load_dwordx4 v76, s[12:15], s21 offen lds
 s_add_u32 m0, s22, 13312
 s_nop 0
 buffer_load_dwordx4 v77, s[12:15], s21 offen lds
 s_add_u32 m0, s22, 14336
 s_nop 0
 buffer_load_dwordx4 v78, s[12:15], s21 offen lds
 s_add_u32 s21, s40, 61440
 s_mul_i32 s22, s20, 15360
 s_add_u32 s22, s22, 61440
 s_add_u32 m0, s22, 0
 s_nop 0
 buffer_load_dwordx4 v64, s[12:15], s21 offen lds
 s_add_u32 m0, s22, 1024
 s_nop 0
 buffer_load_dwordx4 v65, s[12:15], s21 offen lds
 s_add_u32 m0, s22, 2048
 s_nop 0
 buffer_load_dwordx4 v66, s[12:15], s21 offen lds
 s_add_u32 m0, s22, 3072
 s_nop 0
 buffer_load_dwordx4 v67, s[12:15], s21 offen lds
 s_add_u32 m0, s22, 4096
 s_nop 0
 buffer_load_dwordx4 v68, s[12:15], s21 offen lds
 s_add_u32 m0, s22, 5120
 s_nop 0
 buffer_load_dwordx4 v69, s[12:15], s21 offen lds
 s_add_u32 m0, s22, 6144
 s_nop 0
 buffer_load_dwordx4 v70, s[12:15], s21 offen lds
 s_add_u32 m0, s22, 7168
 s_nop 0
 buffer_load_dwordx4 v71, s[12:15], s21 offen lds
 s_add_u32 m0, s22, 8192
 s_nop 0
 buffer_load_dwordx4 v72, s[12:15], s21 offen lds
 s_add_u32 m0, s22, 9216
 s_nop 0
 buffer_load_dwordx4 v73, s[12:15], s21 offen lds
 s_add_u32 m0, s22, 10240
 s_nop 0
 buffer_load_dwordx4 v74, s[12:15], s21 offen lds
 s_add_u32 m0, s22, 11264
 s_nop 0
 buffer_load_dwordx4 v75, s[12:15], s21 offen lds
 s_add_u32 m0, s22, 12288
 s_nop 0
 buffer_load_dwordx4 v76, s[12:15], s21 offen lds
 s_add_u32 m0, s22, 13312
 s_nop 0
 buffer_load_dwordx4 v77, s[12:15], s21 offen lds
 s_add_u32 m0, s22, 14336
 s_nop 0
 buffer_load_dwordx4 v78, s[12:15], s21 offen lds
 s_add_u32 s21, s40, 122880
 s_mul_i32 s22, s20, 15360
 s_add_u32 s22, s22, 0
 buffer_load_dwordx4 v[80:83], v64, s[12:15], s21 offen
 buffer_load_dwordx4 v[84:87], v65, s[12:15], s21 offen
 buffer_load_dwordx4 v[88:91], v66, s[12:15], s21 offen
 buffer_load_dwordx4 v[92:95], v67, s[12:15], s21 offen
 buffer_load_dwordx4 v[96:99], v68, s[12:15], s21 offen
 buffer_load_dwordx4 v[100:103], v69, s[12:15], s21 offen
 buffer_load_dwordx4 v[104:107], v70, s[12:15], s21 offen
 buffer_load_dwordx4 v[108:111], v71, s[12:15], s21 offen
 buffer_load_dwordx4 v[112:115], v72, s[12:15], s21 offen
 buffer_load_dwordx4 v[116:119], v73, s[12:15], s21 offen
 buffer_load_dwordx4 v[120:123], v74, s[12:15], s21 offen
 buffer_load_dwordx4 v[124:127], v75, s[12:15], s21 offen
 buffer_load_dwordx4 v[128:131], v76, s[12:15], s21 offen
 buffer_load_dwordx4 v[132:135], v77, s[12:15], s21 offen
 buffer_load_dwordx4 v[136:139], v78, s[12:15], s21 offen
 s_add_u32 s21, s40, 184320
 s_mul_i32 s22, s20, 15360
 s_add_u32 s22, s22, 61440
 buffer_load_dwordx4 v[140:143], v64, s[12:15], s21 offen
 buffer_load_dwordx4 v[144:147], v65, s[12:15], s21 offen
 buffer_load_dwordx4 v[148:151], v66, s[12:15], s21 offen
 buffer_load_dwordx4 v[152:155], v67, s[12:15], s21 offen
 buffer_load_dwordx4 v[156:159], v68, s[12:15], s21 offen
 buffer_load_dwordx4 v[160:163], v69, s[12:15], s21 offen
 buffer_load_dwordx4 v[164:167], v70, s[12:15], s21 offen
 buffer_load_dwordx4 v[168:171], v71, s[12:15], s21 offen
 buffer_load_dwordx4 v[172:175], v72, s[12:15], s21 offen
 buffer_load_dwordx4 v[176:179], v73, s[12:15], s21 offen
 buffer_load_dwordx4 v[180:183], v74, s[12:15], s21 offen
 buffer_load_dwordx4 v[184:187], v75, s[12:15], s21 offen
 buffer_load_dwordx4 v[188:191], v76, s[12:15], s21 offen
 buffer_load_dwordx4 v[192:195], v77, s[12:15], s21 offen
 buffer_load_dwordx4 v[196:199], v78, s[12:15], s21 offen
 v_lshrrev_b32 v6, 2, v2
 v_lshl_add_u32 v7, v3, 3, v6
 v_mul_u32_u24 v7, 1280, v7
 v_and_b32 v8, 1, v2
 v_lshl_add_u32 v7, v8, 3, v7
 v_and_b32 v8, 1, v3
 v_lshl_add_u32 v6, v8, 2, v6
 v_lshlrev_b32 v6, 1, v6
 v_bfe_u32 v8, v2, 1, 1
 s_mul_i32 s21, s20, 20
 v_add_u32 v8, s21, v8
 v_add_u32 v5, 0, v8
 v_xor_b32 v5, v5, v6
 v_lshl_add_u32 v200, v5, 4, v7
 v_add_u32 v210, 81920, v200
 v_add_u32 v5, 2, v8
 v_xor_b32 v5, v5, v6
 v_lshl_add_u32 v201, v5, 4, v7
 v_add_u32 v211, 81920, v201
 v_add_u32 v5, 4, v8
 v_xor_b32 v5, v5, v6
 v_lshl_add_u32 v202, v5, 4, v7
 v_add_u32 v212, 81920, v202
 v_add_u32 v5, 6, v8
 v_xor_b32 v5, v5, v6
 v_lshl_add_u32 v203, v5, 4, v7
 v_add_u32 v213, 81920, v203
 v_add_u32 v5, 8, v8
 v_xor_b32 v5, v5, v6
 v_lshl_add_u32 v204, v5, 4, v7
 v_add_u32 v214, 81920, v204
 v_add_u32 v5, 10, v8
 v_xor_b32 v5, v5, v6
 v_lshl_add_u32 v205, v5, 4, v7
 v_add_u32 v215, 81920, v205
 v_add_u32 v5, 12, v8
 v_xor_b32 v5, v5, v6
 v_lshl_add_u32 v206, v5, 4, v7
 v_add_u32 v216, 81920, v206
 v_add_u32 v5, 14, v8
 v_xor_b32 v5, v5, v6
 v_lshl_add_u32 v207, v5, 4, v7
 v_add_u32 v217, 81920, v207
 v_add_u32 v5, 16, v8
 v_xor_b32 v5, v5, v6
 v_lshl_add_u32 v208, v5, 4, v7
 v_add_u32 v218, 81920, v208
 v_add_u32 v5, 18, v8
 v_xor_b32 v5, v5, v6
 v_lshl_add_u32 v209, v5, 4, v7
 v_add_u32 v219, 81920, v209
 s_mul_i32 s22, s20, 15360
 v_lshl_add_u32 v30, v1, 4, s22
 v_add_u32 v31, 61440, v30
 s_waitcnt vmcnt(30)
 s_barrier
 ds_read_b64_tr_b16 a[0:1], v200 offset:0
 ds_read_b64_tr_b16 a[2:3], v200 offset:5120
 ds_read_b64_tr_b16 a[24:25], v201 offset:0
 ds_read_b64_tr_b16 a[26:27], v201 offset:5120
 ds_read_b64_tr_b16 a[48:49], v202 offset:0
 ds_read_b64_tr_b16 a[50:51], v202 offset:5120
 ds_read_b64_tr_b16 a[72:73], v203 offset:0
 ds_read_b64_tr_b16 a[74:75], v203 offset:5120
 ds_read_b64_tr_b16 a[96:97], v204 offset:0
 ds_read_b64_tr_b16 a[98:99], v204 offset:5120
 ds_read_b64_tr_b16 a[120:121], v205 offset:0
 ds_read_b64_tr_b16 a[122:123], v205 offset:5120
 ds_read_b64_tr_b16 a[144:145], v206 offset:0
 ds_read_b64_tr_b16 a[146:147], v206 offset:5120
 ds_read_b64_tr_b16 a[168:169], v207 offset:0
 ds_read_b64_tr_b16 a[170:171], v207 offset:5120
 ds_read_b64_tr_b16 a[192:193], v208 offset:0
 ds_read_b64_tr_b16 a[194:195], v208 offset:5120
 ds_read_b64_tr_b16 a[216:217], v209 offset:0
 ds_read_b64_tr_b16 a[218:219], v209 offset:5120
 ds_read_b64_tr_b16 a[4:5], v200 offset:40960
 ds_read_b64_tr_b16 a[6:7], v200 offset:46080
 ds_read_b64_tr_b16 a[28:29], v201 offset:40960
 ds_read_b64_tr_b16 a[30:31], v201 offset:46080
 ds_read_b64_tr_b16 a[52:53], v202 offset:40960
 ds_read_b64_tr_b16 a[54:55], v202 offset:46080
 ds_read_b64_tr_b16 a[76:77], v203 offset:40960
 ds_read_b64_tr_b16 a[78:79], v203 offset:46080
 ds_read_b64_tr_b16 a[100:101], v204 offset:40960
 ds_read_b64_tr_b16 a[102:103], v204 offset:46080
 ds_read_b64_tr_b16 a[124:125], v205 offset:40960
 ds_read_b64_tr_b16 a[126:127], v205 offset:46080
 ds_read_b64_tr_b16 a[148:149], v206 offset:40960
 ds_read_b64_tr_b16 a[150:151], v206 offset:46080
 ds_read_b64_tr_b16 a[172:173], v207 offset:40960
 ds_read_b64_tr_b16 a[174:175], v207 offset:46080
 ds_read_b64_tr_b16 a[196:197], v208 offset:40960
 ds_read_b64_tr_b16 a[198:199], v208 offset:46080
 ds_read_b64_tr_b16 a[220:221], v209 offset:40960
 ds_read_b64_tr_b16 a[222:223], v209 offset:46080
 ds_read_b64_tr_b16 a[8:9], v210 offset:0
 ds_read_b64_tr_b16 a[10:11], v210 offset:5120
 ds_read_b64_tr_b16 a[32:33], v211 offset:0
 ds_read_b64_tr_b16 a[34:35], v211 offset:5120
 ds_read_b64_tr_b16 a[56:57], v212 offset:0
 ds_read_b64_tr_b16 a[58:59], v212 offset:5120
 ds_read_b64_tr_b16 a[80:81], v213 offset:0
 ds_read_b64_tr_b16 a[82:83], v213 offset:5120
 ds_read_b64_tr_b16 a[104:105], v214 offset:0
 ds_read_b64_tr_b16 a[106:107], v214 offset:5120
 ds_read_b64_tr_b16 a[128:129], v215 offset:0
 ds_read_b64_tr_b16 a[130:131], v215 offset:5120
 ds_read_b64_tr_b16 a[152:153], v216 offset:0
 ds_read_b64_tr_b16 a[154:155], v216 offset:5120
 ds_read_b64_tr_b16 a[176:177], v217 offset:0
 ds_read_b64_tr_b16 a[178:179], v217 offset:5120
 ds_read_b64_tr_b16 a[200:201], v218 offset:0
 ds_read_b64_tr_b16 a[202:203], v218 offset:5120
 ds_read_b64_tr_b16 a[224:225], v219 offset:0
 ds_read_b64_tr_b16 a[226:227], v219 offset:5120
 s_waitcnt lgkmcnt(0)
 s_barrier
 s_waitcnt vmcnt(15)
 ds_write_b128 v30, v[80:83] offset:0
 ds_write_b128 v30, v[84:87] offset:1024
 ds_write_b128 v30, v[88:91] offset:2048
 ds_write_b128 v30, v[92:95] offset:3072
 ds_write_b128 v30, v[96:99] offset:4096
 ds_write_b128 v30, v[100:103] offset:5120
 ds_write_b128 v30, v[104:107] offset:6144
 ds_write_b128 v30, v[108:111] offset:7168
 ds_write_b128 v30, v[112:115] offset:8192
 ds_write_b128 v30, v[116:119] offset:9216
 ds_write_b128 v30, v[120:123] offset:10240
 ds_write_b128 v30, v[124:127] offset:11264
 ds_write_b128 v30, v[128:131] offset:12288
 ds_write_b128 v30, v[132:135] offset:13312
 ds_write_b128 v30, v[136:139] offset:14336
 s_waitcnt vmcnt(0)
 ds_write_b128 v31, v[140:143] offset:0
 ds_write_b128 v31, v[144:147] offset:1024
 ds_write_b128 v31, v[148:151] offset:2048
 ds_write_b128 v31, v[152:155] offset:3072
 ds_write_b128 v31, v[156:159] offset:4096
 ds_write_b128 v31, v[160:163] offset:5120
 ds_write_b128 v31, v[164:167] offset:6144
 ds_write_b128 v31, v[168:171] offset:7168
 ds_write_b128 v31, v[172:175] offset:8192
 ds_write_b128 v31, v[176:179] offset:9216
 ds_write_b128 v31, v[180:183] offset:10240
 ds_write_b128 v31, v[184:187] offset:11264
 ds_write_b128 v31, v[188:191] offset:12288
 ds_write_b128 v31, v[192:195] offset:13312
 ds_write_b128 v31, v[196:199] offset:14336
 s_waitcnt lgkmcnt(0)
 s_barrier
 ds_read_b64_tr_b16 a[12:13], v200 offset:0
 ds_read_b64_tr_b16 a[14:15], v200 offset:5120
 ds_read_b64_tr_b16 a[36:37], v201 offset:0
 ds_read_b64_tr_b16 a[38:39], v201 offset:5120
 ds_read_b64_tr_b16 a[60:61], v202 offset:0
 ds_read_b64_tr_b16 a[62:63], v202 offset:5120
 ds_read_b64_tr_b16 a[84:85], v203 offset:0
 ds_read_b64_tr_b16 a[86:87], v203 offset:5120
 ds_read_b64_tr_b16 a[108:109], v204 offset:0
 ds_read_b64_tr_b16 a[110:111], v204 offset:5120
 ds_read_b64_tr_b16 a[132:133], v205 offset:0
 ds_read_b64_tr_b16 a[134:135], v205 offset:5120
 ds_read_b64_tr_b16 a[156:157], v206 offset:0
 ds_read_b64_tr_b16 a[158:159], v206 offset:5120
 ds_read_b64_tr_b16 a[180:181], v207 offset:0
 ds_read_b64_tr_b16 a[182:183], v207 offset:5120
 ds_read_b64_tr_b16 a[204:205], v208 offset:0
 ds_read_b64_tr_b16 a[206:207], v208 offset:5120
 ds_read_b64_tr_b16 a[228:229], v209 offset:0
 ds_read_b64_tr_b16 a[230:231], v209 offset:5120
 ds_read_b64_tr_b16 a[16:17], v200 offset:40960
 ds_read_b64_tr_b16 a[18:19], v200 offset:46080
 ds_read_b64_tr_b16 a[40:41], v201 offset:40960
 ds_read_b64_tr_b16 a[42:43], v201 offset:46080
 ds_read_b64_tr_b16 a[64:65], v202 offset:40960
 ds_read_b64_tr_b16 a[66:67], v202 offset:46080
 ds_read_b64_tr_b16 a[88:89], v203 offset:40960
 ds_read_b64_tr_b16 a[90:91], v203 offset:46080
 ds_read_b64_tr_b16 a[112:113], v204 offset:40960
 ds_read_b64_tr_b16 a[114:115], v204 offset:46080
 ds_read_b64_tr_b16 a[136:137], v205 offset:40960
 ds_read_b64_tr_b16 a[138:139], v205 offset:46080
 ds_read_b64_tr_b16 a[160:161], v206 offset:40960
 ds_read_b64_tr_b16 a[162:163], v206 offset:46080
 ds_read_b64_tr_b16 a[184:185], v207 offset:40960
 ds_read_b64_tr_b16 a[186:187], v207 offset:46080
 ds_read_b64_tr_b16 a[208:209], v208 offset:40960
 ds_read_b64_tr_b16 a[210:211], v208 offset:46080
 ds_read_b64_tr_b16 a[232:233], v209 offset:40960
 ds_read_b64_tr_b16 a[234:235], v209 offset:46080
 ds_read_b64_tr_b16 a[20:21], v210 offset:0
 ds_read_b64_tr_b16 a[22:23], v210 offset:5120
 ds_read_b64_tr_b16 a[44:45], v211 offset:0
 ds_read_b64_tr_b16 a[46:47], v211 offset:5120
 ds_read_b64_tr_b16 a[68:69], v212 offset:0
 ds_read_b64_tr_b16 a[70:71], v212 offset:5120
 ds_read_b64_tr_b16 a[92:93], v213 offset:0
 ds_read_b64_tr_b16 a[94:95], v213 offset:5120
 ds_read_b64_tr_b16 a[116:117], v214 offset:0
 ds_read_b64_tr_b16 a[118:119], v214 offset:5120
 ds_read_b64_tr_b16 a[140:141], v215 offset:0
 ds_read_b64_tr_b16 a[142:143], v215 offset:5120
 ds_read_b64_tr_b16 a[164:165], v216 offset:0
 ds_read_b64_tr_b16 a[166:167], v216 offset:5120
 ds_read_b64_tr_b16 a[188:189], v217 offset:0
 ds_read_b64_tr_b16 a[190:191], v217 offset:5120
 ds_read_b64_tr_b16 a[212:213], v218 offset:0
 ds_read_b64_tr_b16 a[214:215], v218 offset:5120
 ds_read_b64_tr_b16 a[236:237], v219 offset:0
 ds_read_b64_tr_b16 a[238:239], v219 offset:5120
 s_waitcnt lgkmcnt(0)
 s_barrier
 s_load_dwordx2 s[32:33], s[0:1], 96
 s_waitcnt lgkmcnt(0)
 s_mov_b32 s32, s32
 s_mov_b32 s33, s33
 s_mov_b32 s34, 256
 s_mov_b32 s35, 0x00020000
 s_mov_b32 s21, 76
 s_cmp_lg_u32 s20, 0
 s_cbranch_scc1 wf_137
 v_mov_b32 v4, 0
 s_mov_b32 s101, 0
wf_136:
 buffer_load_dword v5, v4, s[32:35], s21 offen sc1
 s_add_u32 s101, s101, 1
 s_cmp_gt_u32 s101, 131072
 s_cbranch_scc1 main_end
 s_waitcnt vmcnt(0)
 v_readfirstlane_b32 s100, v5
 s_cmp_ge_u32 s100, 32
 s_cbranch_scc1 wf_137
 s_sleep 8
 s_branch wf_136
wf_137:
 s_barrier
 s_mul_i32 s41, s2, 12288
 s_add_u32 s47, s41, 25165824
 s_mov_b32 s41, s47
 s_mul_i32 s21, s20, 10
 s_mul_i32 s47, s2, 5
 s_lshr_b32 s22, s21, 3
 s_add_u32 s47, s47, s22
 s_and_b32 s48, s21, 7
 s_mov_b32 s66, 0
 s_mov_b32 s67, 0
 s_lshr_b32 s43, s2, 2
 s_lshl_b32 s43, s43, 7
 s_add_u32 s43, s43, 0
 s_lshl_b32 s44, s2, 7
 s_lshl_b32 s21, s20, 12
 s_add_u32 s44, s44, s21
 s_add_u32 s44, s44, 94208
 s_mov_b32 s45, 0
 s_mov_b32 s49, 1
 s_mov_b32 s50, 0
 v_mov_b32 v10, 0
 v_mov_b32 v11, 1
 v_lshlrev_b32 v4, 4, v1
 s_add_u32 s76, s38, 56623104
 s_addc_u32 s77, s39, 0
 s_mov_b32 s78, 6291456
 s_mov_b32 s79, 0x00020000
 s_add_u32 s80, s38, 101711872
 s_addc_u32 s81, s39, 0
 s_mov_b32 s82, 20971520
 s_mov_b32 s83, 0x00020000
 v_and_b32 v12, 3, v1
 v_lshlrev_b32 v12, 3, v12
 v_add_u32 v12, 4, v12
 v_and_b32 v13, 7, v2
 v_lshlrev_b32 v13, 4, v13
 v_lshl_add_u32 v13, v3, 7, v13
 v_lshrrev_b32 v14, 3, v2
 v_mul_u32_u24 v14, 98304, v14
 v_add_u32 v14, v14, v13
 v_and_b32 v15, 1, v3
 v_lshlrev_b32 v15, 8, v15
 v_lshl_add_u32 v15, v2, 4, v15
 v_lshrrev_b32 v16, 1, v3
 v_mul_u32_u24 v16, 327680, v16
 v_add_u32 v15, v15, v16
 v_lshlrev_b32 v17, 10, v1
 v_mov_b32 v19, 0
 s_lshl_b32 s53, s2, 7
 s_add_u32 s53, s53, 18432
 s_mov_b32 s55, 0
 s_mov_b32 s56, 0
 s_mov_b32 s58, 0
 s_mov_b32 s59, 0
 s_add_u32 s84, s38, 50331648
 s_addc_u32 s85, s39, 0
 s_mov_b32 s86, 12582912
 s_mov_b32 s87, 0x00020000
 s_and_b32 s21, s2, 3
 s_mul_i32 s51, s2, 3072
 s_cmp_eq_u32 s21, s20
 s_cselect_b32 s51, s51, 6291456
 v_mov_b32 v244, -1
 v_mov_b32 v245, -1
 v_mov_b32 v246, -1
 v_mov_b32 v247, -1
 s_add_u32 s88, s38, 85983232
 s_addc_u32 s89, s39, 0
 s_mov_b32 s90, 5242880
 s_mov_b32 s91, 0x00020000
 s_mul_i32 s21, s20, 3072
 s_add_u32 s41, s41, s21
 s_mov_b32 s64, s21
 s_add_u32 s67, s21, 98304
 s_mov_b32 s71, s21
 s_mov_b32 s46, 0
 s_mov_b32 s47, 0
 s_mov_b32 s65, 0
 s_mul_i32 s42, s2, 40960
 s_mul_i32 s21, s20, 10240
 s_add_u32 s42, s42, s21
 s_mov_b32 s68, 0x80000000
 s_mov_b32 s70, 0
 s_mov_b32 s40, 0
 s_mov_b32 s31, 0
 s_mov_b32 s56, s68
 s_mov_b32 s57, s68
 s_lshl_b32 s59, s20, 1
 s_sub_u32 s59, 8, s59
 s_add_u32 s61, s28, 9216
 v_min_u32 v5, 17, v1
 v_lshlrev_b32 v5, 10, v5
 v_mov_b32 v9, 0
 s_lshl_b32 s21, s20, 2
 s_add_u32 s21, s21, 110592
 v_mov_b32 v6, s21
 v_mov_b32 v7, 110592
 s_mul_i32 s51, s2, 3072
 s_lshl_b32 s21, s20, 10
 s_add_u32 s51, s51, s21
 s_cmp_lt_u32 s20, 3
 s_cselect_b32 s51, s51, 6291456
 s_add_u32 s51, s51, 5701632
 s_cmp_lg_u32 s20, 0
 s_cbranch_scc1 wf_139
 v_mov_b32 v20, 0
 s_mov_b32 s101, 0
wf_138:
 buffer_load_dword v21, v20, s[72:75], s43 offen sc1
 s_add_u32 s101, s101, 1
 s_cmp_gt_u32 s101, 131072
 s_cbranch_scc1 main_end
 s_waitcnt vmcnt(0)
 v_readfirstlane_b32 s100, v21
 s_cmp_ge_u32 s100, 8
 s_cbranch_scc1 wf_139
 s_sleep 4
 s_branch wf_138
wf_139:
 s_barrier
 v_writelane_b32 v9, 8, 0
 v_cmp_gt_u32 vcc, 8, v9
 s_nop 0
 s_bitset1_b64 vcc, 18
 s_ff1_i32_b64 s21, vcc
 s_lshl_b32 s22, s21, 1
 s_lshl_b32 s21, s21, 2
 s_sub_i32 s21, s21, 8
 s_max_i32 s47, s21, s22
 s_cmp_gt_u32 s47, s45
 s_cbranch_scc1 va_140
 s_mov_b32 s101, 0
 s_branch va_143
va_141:
 s_sleep 8
va_143:
 buffer_load_dword v9, v5, s[72:75], s43 offen sc1
 s_add_u32 s101, s101, 1
 s_cmp_gt_u32 s101, 131072
 s_cbranch_scc1 main_end
 s_waitcnt vmcnt(0)
 v_cmp_gt_u32 vcc, 8, v9
 s_nop 0
 s_bitset1_b64 vcc, 18
 s_ff1_i32_b64 s21, vcc
 s_lshl_b32 s22, s21, 1
 s_lshl_b32 s21, s21, 2
 s_sub_i32 s21, s21, 8
 s_max_i32 s47, s21, s22
 s_cmp_gt_u32 s47, s45
 s_cbranch_scc0 va_141
va_140:
 s_add_u32 s22, s45, 6
 s_min_u32 s22, s22, s47
va_142:
 s_cmp_ge_u32 s46, s22
 s_cbranch_scc1 va_144
 s_mov_b32 m0, s64
 s_mov_b32 s66, s41
 buffer_load_dwordx4 v4, s[16:19], s66 offen offset:0 sc1 lds
 buffer_load_dwordx4 v4, s[16:19], s66 offen offset:1024 sc1 lds
 buffer_load_dwordx4 v4, s[16:19], s66 offen offset:2048 sc1 lds
 s_add_u32 s46, s46, 1
 s_add_u32 s41, s41, 393216
 s_add_u32 s64, s64, 12288
 s_cmp_lt_u32 s64, s67
 s_cselect_b32 s64, s64, s71
 s_branch va_142
va_144:
 s_mov_b32 s48, s46
 s_mov_b32 s49, s46
 s_mov_b32 s50, s46
 s_waitcnt vmcnt(0)
 s_barrier
 v_mov_b32 v8, v4
 s_add_u32 s65, s65, 12288
 s_cmp_lt_u32 s65, 98304
 s_cselect_b32 s65, s65, 0
 ds_read_b128 v[144:147], v8 offset:0
 ds_read_b128 v[148:151], v8 offset:1024
 ds_read_b128 v[152:155], v8 offset:2048
 ds_read_b128 v[156:159], v8 offset:3072
 ds_read_b128 v[160:163], v8 offset:4096
 ds_read_b128 v[164:167], v8 offset:5120
 ds_read_b128 v[168:171], v8 offset:6144
 ds_read_b128 v[172:175], v8 offset:7168
 ds_read_b128 v[176:179], v8 offset:8192
 ds_read_b128 v[180:183], v8 offset:9216
 ds_read_b128 v[184:187], v8 offset:10240
 ds_read_b128 v[188:191], v8 offset:11264
vwl_145:
 s_waitcnt lgkmcnt(0)
 v_mfma_f32_16x16x32_bf16 v[64:67], v[144:147], a[0:3], 0
 v_cmp_gt_u32 vcc, 8, v9
 s_nop 0
 v_mfma_f32_16x16x32_bf16 v[72:75], v[144:147], a[24:27], 0
 s_bitset1_b64 vcc, 18
 s_ff1_i32_b64 s21, vcc
 v_mfma_f32_16x16x32_bf16 v[80:83], v[144:147], a[48:51], 0
 s_lshl_b32 s22, s21, 1
 s_lshl_b32 s21, s21, 2
 v_mfma_f32_16x16x32_bf16 v[88:91], v[144:147], a[72:75], 0
 s_sub_i32 s21, s21, 8
 s_max_i32 s47, s21, s22
 v_mfma_f32_16x16x32_bf16 v[96:99], v[144:147], a[96:99], 0
 s_add_u32 s22, s45, 7
 s_min_u32 s22, s22, s47
 v_mfma_f32_16x16x32_bf16 v[68:71], v[168:171], a[0:3], 0
 s_cmp_lt_u32 s46, s22
 s_cselect_b32 s66, s41, 0x80000000
 s_cselect_b32 m0, s64, 98304
 s_cselect_b32 s22, 1, 0
 v_mfma_f32_16x16x32_bf16 v[76:79], v[168:171], a[24:27], 0
 buffer_load_dwordx4 v4, s[16:19], s66 offen offset:0 sc1 lds
 v_mfma_f32_16x16x32_bf16 v[84:87], v[168:171], a[48:51], 0
 v_add_u32 v8, s65, v4
 s_add_u32 s65, s65, 12288
 v_mfma_f32_16x16x32_bf16 v[92:95], v[168:171], a[72:75], 0
 buffer_load_dwordx4 v4, s[16:19], s66 offen offset:1024 sc1 lds
 v_mfma_f32_16x16x32_bf16 v[100:103], v[168:171], a[96:99], 0
 s_cmp_lt_u32 s65, 98304
 s_cselect_b32 s65, s65, 0
 v_mfma_f32_16x16x32_bf16 v[64:67], v[148:151], a[4:7], v[64:67]
 buffer_load_dwordx4 v4, s[16:19], s66 offen offset:2048 sc1 lds
 v_mfma_f32_16x16x32_bf16 v[72:75], v[148:151], a[28:31], v[72:75]
 s_add_u32 s46, s46, s22
 s_mul_i32 s21, s22, 393216
 v_mfma_f32_16x16x32_bf16 v[80:83], v[148:151], a[52:55], v[80:83]
 s_add_u32 s41, s41, s21
 s_mul_i32 s21, s22, 12288
 v_mfma_f32_16x16x32_bf16 v[88:91], v[148:151], a[76:79], v[88:91]
 s_add_u32 s64, s64, s21
 v_cvt_pk_bf16_f32 v44, v104, v105
 v_mfma_f32_16x16x32_bf16 v[96:99], v[148:151], a[100:103], v[96:99]
 s_cmp_lt_u32 s64, s67
 s_cselect_b32 s64, s64, s71
 v_mfma_f32_16x16x32_bf16 v[68:71], v[172:175], a[4:7], v[68:71]
 v_cvt_pk_bf16_f32 v45, v106, v107
 v_cvt_pk_bf16_f32 v46, v108, v109
 v_mfma_f32_16x16x32_bf16 v[76:79], v[172:175], a[28:31], v[76:79]
 v_cvt_pk_bf16_f32 v47, v110, v111
 v_mfma_f32_16x16x32_bf16 v[84:87], v[172:175], a[52:55], v[84:87]
 s_add_u32 s69, s68, 4096
 v_mfma_f32_16x16x32_bf16 v[92:95], v[172:175], a[76:79], v[92:95]
 v_mfma_f32_16x16x32_bf16 v[100:103], v[172:175], a[100:103], v[100:103]
 buffer_store_dwordx4 v[44:47], v4, s[24:27], s69 offen offset:1024 sc1
 v_mfma_f32_16x16x32_bf16 v[64:67], v[152:155], a[8:11], v[64:67]
 v_mfma_f32_16x16x32_bf16 v[72:75], v[152:155], a[32:35], v[72:75]
 v_cvt_pk_bf16_f32 v48, v112, v113
 v_mfma_f32_16x16x32_bf16 v[80:83], v[152:155], a[56:59], v[80:83]
 v_cvt_pk_bf16_f32 v49, v114, v115
 v_mfma_f32_16x16x32_bf16 v[88:91], v[152:155], a[80:83], v[88:91]
 v_mfma_f32_16x16x32_bf16 v[96:99], v[152:155], a[104:107], v[96:99]
 v_cvt_pk_bf16_f32 v50, v116, v117
 v_mfma_f32_16x16x32_bf16 v[68:71], v[176:179], a[8:11], v[68:71]
 v_mfma_f32_16x16x32_bf16 v[76:79], v[176:179], a[32:35], v[76:79]
 v_cvt_pk_bf16_f32 v51, v118, v119
 v_mfma_f32_16x16x32_bf16 v[84:87], v[176:179], a[56:59], v[84:87]
 buffer_store_dwordx4 v[48:51], v4, s[24:27], s69 offen offset:2048 sc1
 v_mfma_f32_16x16x32_bf16 v[92:95], v[176:179], a[80:83], v[92:95]
 v_mfma_f32_16x16x32_bf16 v[100:103], v[176:179], a[104:107], v[100:103]
 v_cvt_pk_bf16_f32 v52, v120, v121
 v_mfma_f32_16x16x32_bf16 v[64:67], v[156:159], a[12:15], v[64:67]
 v_mfma_f32_16x16x32_bf16 v[72:75], v[156:159], a[36:39], v[72:75]
 v_cvt_pk_bf16_f32 v53, v122, v123
 v_mfma_f32_16x16x32_bf16 v[80:83], v[156:159], a[60:63], v[80:83]
 v_cvt_pk_bf16_f32 v54, v124, v125
 v_mfma_f32_16x16x32_bf16 v[88:91], v[156:159], a[84:87], v[88:91]
 v_mfma_f32_16x16x32_bf16 v[96:99], v[156:159], a[108:111], v[96:99]
 v_cvt_pk_bf16_f32 v55, v126, v127
 v_mfma_f32_16x16x32_bf16 v[68:71], v[180:183], a[12:15], v[68:71]
 v_mfma_f32_16x16x32_bf16 v[76:79], v[180:183], a[36:39], v[76:79]
 buffer_store_dwordx4 v[52:55], v4, s[24:27], s69 offen offset:3072 sc1
 v_mfma_f32_16x16x32_bf16 v[84:87], v[180:183], a[60:63], v[84:87]
 v_cvt_pk_bf16_f32 v56, v128, v129
 v_mfma_f32_16x16x32_bf16 v[92:95], v[180:183], a[84:87], v[92:95]
 v_mfma_f32_16x16x32_bf16 v[100:103], v[180:183], a[108:111], v[100:103]
 v_cvt_pk_bf16_f32 v57, v130, v131
 v_mfma_f32_16x16x32_bf16 v[64:67], v[160:163], a[16:19], v[64:67]
 s_cmp_lt_u32 s51, 6291456
 s_cselect_b32 s52, s51, 0x80000000
 v_mfma_f32_16x16x32_bf16 v[72:75], v[160:163], a[40:43], v[72:75]
 buffer_store_dwordx4 v[244:247], v4, s[84:87], s52 offen sc1
 v_mfma_f32_16x16x32_bf16 v[80:83], v[160:163], a[64:67], v[80:83]
 s_add_u32 s51, s51, 98304
 v_cvt_pk_bf16_f32 v58, v132, v133
 v_mfma_f32_16x16x32_bf16 v[88:91], v[160:163], a[88:91], v[88:91]
 v_cvt_pk_bf16_f32 v59, v134, v135
 v_mfma_f32_16x16x32_bf16 v[96:99], v[160:163], a[112:115], v[96:99]
 s_add_u32 s69, s68, 8192
 v_mfma_f32_16x16x32_bf16 v[68:71], v[184:187], a[16:19], v[68:71]
 v_mfma_f32_16x16x32_bf16 v[76:79], v[184:187], a[40:43], v[76:79]
 buffer_store_dwordx4 v[56:59], v4, s[24:27], s69 offen offset:0 sc1
 v_mfma_f32_16x16x32_bf16 v[84:87], v[184:187], a[64:67], v[84:87]
 v_cvt_pk_bf16_f32 v60, v136, v137
 v_mfma_f32_16x16x32_bf16 v[92:95], v[184:187], a[88:91], v[92:95]
 v_mfma_f32_16x16x32_bf16 v[100:103], v[184:187], a[112:115], v[100:103]
 v_cvt_pk_bf16_f32 v61, v138, v139
 v_mfma_f32_16x16x32_bf16 v[64:67], v[164:167], a[20:23], v[64:67]
 v_mfma_f32_16x16x32_bf16 v[72:75], v[164:167], a[44:47], v[72:75]
 v_cvt_pk_bf16_f32 v62, v140, v141
 v_mfma_f32_16x16x32_bf16 v[80:83], v[164:167], a[68:71], v[80:83]
 v_cvt_pk_bf16_f32 v63, v142, v143
 v_mfma_f32_16x16x32_bf16 v[88:91], v[164:167], a[92:95], v[88:91]
 v_mfma_f32_16x16x32_bf16 v[96:99], v[164:167], a[116:119], v[96:99]
 buffer_store_dwordx4 v[60:63], v4, s[24:27], s69 offen offset:1024 sc1
 v_mfma_f32_16x16x32_bf16 v[68:71], v[188:191], a[20:23], v[68:71]
 v_mfma_f32_16x16x32_bf16 v[76:79], v[188:191], a[44:47], v[76:79]
 v_mfma_f32_16x16x32_bf16 v[84:87], v[188:191], a[68:71], v[84:87]
 v_mfma_f32_16x16x32_bf16 v[92:95], v[188:191], a[92:95], v[92:95]
 v_mfma_f32_16x16x32_bf16 v[100:103], v[188:191], a[116:119], v[100:103]
 v_mfma_f32_16x16x32_bf16 v[104:107], v[144:147], a[120:123], 0
 buffer_load_dword v9, v5, s[72:75], s43 offen sc1
 v_mfma_f32_16x16x32_bf16 v[112:115], v[144:147], a[144:147], 0
 v_mfma_f32_16x16x32_bf16 v[120:123], v[144:147], a[168:171], 0
 v_mfma_f32_16x16x32_bf16 v[128:131], v[144:147], a[192:195], 0
 v_cvt_pk_bf16_f32 v24, v64, v65
 v_mfma_f32_16x16x32_bf16 v[136:139], v[144:147], a[216:219], 0
 s_add_u32 s63, s45, 1
 s_min_u32 s63, s63, 63
 v_mfma_f32_16x16x32_bf16 v[108:111], v[168:171], a[120:123], 0
 s_cmp_lt_u32 s63, s46
 s_cselect_b32 s53, 1, 0
 v_mfma_f32_16x16x32_bf16 v[116:119], v[168:171], a[144:147], 0
 v_mov_b32 v21, s53
 ds_write_b32 v6, v21 offset:0
 v_mfma_f32_16x16x32_bf16 v[124:127], v[168:171], a[168:171], 0
 v_cvt_pk_bf16_f32 v25, v66, v67
 v_cvt_pk_bf16_f32 v26, v68, v69
 v_mfma_f32_16x16x32_bf16 v[132:135], v[168:171], a[192:195], 0
 v_cvt_pk_bf16_f32 v27, v70, v71
 v_mfma_f32_16x16x32_bf16 v[140:143], v[168:171], a[216:219], 0
 v_mfma_f32_16x16x32_bf16 v[104:107], v[148:151], a[124:127], v[104:107]
 buffer_store_dwordx4 v[24:27], v4, s[24:27], s42 offen offset:0 sc1
 v_mfma_f32_16x16x32_bf16 v[112:115], v[148:151], a[148:151], v[112:115]
 v_cvt_pk_bf16_f32 v28, v72, v73
 v_mfma_f32_16x16x32_bf16 v[120:123], v[148:151], a[172:175], v[120:123]
 s_cmp_eq_u32 s40, 3
 s_cbranch_scc1 vwm_149
vwm_150:
 v_mfma_f32_16x16x32_bf16 v[128:131], v[148:151], a[196:199], v[128:131]
 v_cvt_pk_bf16_f32 v29, v74, v75
 v_mfma_f32_16x16x32_bf16 v[136:139], v[148:151], a[220:223], v[136:139]
 v_mfma_f32_16x16x32_bf16 v[108:111], v[172:175], a[124:127], v[108:111]
 v_cvt_pk_bf16_f32 v30, v76, v77
 v_mfma_f32_16x16x32_bf16 v[116:119], v[172:175], a[148:151], v[116:119]
 v_mfma_f32_16x16x32_bf16 v[124:127], v[172:175], a[172:175], v[124:127]
 v_cvt_pk_bf16_f32 v31, v78, v79
 v_mfma_f32_16x16x32_bf16 v[132:135], v[172:175], a[196:199], v[132:135]
 buffer_store_dwordx4 v[28:31], v4, s[24:27], s42 offen offset:1024 sc1
 v_mfma_f32_16x16x32_bf16 v[140:143], v[172:175], a[220:223], v[140:143]
 s_cmp_lt_u32 s63, s50
 s_cbranch_scc0 vwx_147
vwx_148:
 v_mfma_f32_16x16x32_bf16 v[104:107], v[152:155], a[128:131], v[104:107]
 s_waitcnt lgkmcnt(0)
 s_barrier
 v_mfma_f32_16x16x32_bf16 v[112:115], v[152:155], a[152:155], v[112:115]
 ds_read_b128 v[240:243], v7 offset:0
 v_cvt_pk_bf16_f32 v32, v80, v81
 v_mfma_f32_16x16x32_bf16 v[120:123], v[152:155], a[176:179], v[120:123]
 ds_read_b128 v[192:195], v8 offset:0
 v_cvt_pk_bf16_f32 v33, v82, v83
 v_mfma_f32_16x16x32_bf16 v[128:131], v[152:155], a[200:203], v[128:131]
 v_mfma_f32_16x16x32_bf16 v[136:139], v[152:155], a[224:227], v[136:139]
 ds_read_b128 v[196:199], v8 offset:1024
 v_cvt_pk_bf16_f32 v34, v84, v85
 v_mfma_f32_16x16x32_bf16 v[108:111], v[176:179], a[128:131], v[108:111]
 v_mfma_f32_16x16x32_bf16 v[116:119], v[176:179], a[152:155], v[116:119]
 v_cvt_pk_bf16_f32 v35, v86, v87
 v_mfma_f32_16x16x32_bf16 v[124:127], v[176:179], a[176:179], v[124:127]
 ds_read_b128 v[200:203], v8 offset:2048
 v_mfma_f32_16x16x32_bf16 v[132:135], v[176:179], a[200:203], v[132:135]
 buffer_store_dwordx4 v[32:35], v4, s[24:27], s42 offen offset:2048 sc1
 v_mfma_f32_16x16x32_bf16 v[140:143], v[176:179], a[224:227], v[140:143]
 ds_read_b128 v[204:207], v8 offset:3072
 v_cvt_pk_bf16_f32 v36, v88, v89
 v_mfma_f32_16x16x32_bf16 v[104:107], v[156:159], a[132:135], v[104:107]
 v_mfma_f32_16x16x32_bf16 v[112:115], v[156:159], a[156:159], v[112:115]
 v_cvt_pk_bf16_f32 v37, v90, v91
 v_mfma_f32_16x16x32_bf16 v[120:123], v[156:159], a[180:183], v[120:123]
 ds_read_b128 v[208:211], v8 offset:4096
 v_mfma_f32_16x16x32_bf16 v[128:131], v[156:159], a[204:207], v[128:131]
 v_cvt_pk_bf16_f32 v38, v92, v93
 v_mfma_f32_16x16x32_bf16 v[136:139], v[156:159], a[228:231], v[136:139]
 ds_read_b128 v[212:215], v8 offset:5120
 s_waitcnt lgkmcnt(4)
 v_mfma_f32_16x16x32_bf16 v[108:111], v[180:183], a[132:135], v[108:111]
 v_bitop3_b32 v240, v240, v241, v242 bitop3:0x80
 v_and_b32 v240, v240, v243
 v_mfma_f32_16x16x32_bf16 v[116:119], v[180:183], a[156:159], v[116:119]
 s_nop 0
 v_readfirstlane_b32 s23, v240
 v_mfma_f32_16x16x32_bf16 v[124:127], v[180:183], a[180:183], v[124:127]
 ds_read_b128 v[216:219], v8 offset:6144
 v_cvt_pk_bf16_f32 v39, v94, v95
 v_mfma_f32_16x16x32_bf16 v[132:135], v[180:183], a[204:207], v[132:135]
 buffer_store_dwordx4 v[36:39], v4, s[24:27], s42 offen offset:3072 sc1
 v_mfma_f32_16x16x32_bf16 v[140:143], v[180:183], a[228:231], v[140:143]
 ds_read_b128 v[220:223], v8 offset:7168
 v_cvt_pk_bf16_f32 v40, v96, v97
 v_mfma_f32_16x16x32_bf16 v[104:107], v[160:163], a[136:139], v[104:107]
 v_cvt_pk_bf16_f32 v41, v98, v99
 v_mfma_f32_16x16x32_bf16 v[112:115], v[160:163], a[160:163], v[112:115]
 v_cvt_pk_bf16_f32 v42, v100, v101
 v_mfma_f32_16x16x32_bf16 v[120:123], v[160:163], a[184:187], v[120:123]
 ds_read_b128 v[224:227], v8 offset:8192
 v_mfma_f32_16x16x32_bf16 v[128:131], v[160:163], a[208:211], v[128:131]
 v_cvt_pk_bf16_f32 v43, v102, v103
 v_mfma_f32_16x16x32_bf16 v[136:139], v[160:163], a[232:235], v[136:139]
 ds_read_b128 v[228:231], v8 offset:9216
 v_mfma_f32_16x16x32_bf16 v[108:111], v[184:187], a[136:139], v[108:111]
 s_add_u32 s69, s42, 4096
 v_mfma_f32_16x16x32_bf16 v[116:119], v[184:187], a[160:163], v[116:119]
 v_mfma_f32_16x16x32_bf16 v[124:127], v[184:187], a[184:187], v[124:127]
 ds_read_b128 v[232:235], v8 offset:10240
 v_mfma_f32_16x16x32_bf16 v[132:135], v[184:187], a[208:211], v[132:135]
 buffer_store_dwordx4 v[40:43], v4, s[24:27], s69 offen offset:0 sc1
 v_mfma_f32_16x16x32_bf16 v[140:143], v[184:187], a[232:235], v[140:143]
 ds_read_b128 v[236:239], v8 offset:11264
 v_mfma_f32_16x16x32_bf16 v[104:107], v[164:167], a[140:143], v[104:107]
 v_mfma_f32_16x16x32_bf16 v[112:115], v[164:167], a[164:167], v[112:115]
 v_mfma_f32_16x16x32_bf16 v[120:123], v[164:167], a[188:191], v[120:123]
 s_waitcnt vmcnt(12)
 s_mov_b32 s50, s46
 s_add_u32 s69, s45, s40
 v_mfma_f32_16x16x32_bf16 v[128:131], v[164:167], a[212:215], v[128:131]
 s_mov_b32 s40, 0
 s_sub_i32 s69, s69, 1
 s_max_i32 s69, s69, s70
 v_mfma_f32_16x16x32_bf16 v[136:139], v[164:167], a[236:239], v[136:139]
 s_add_u32 s45, s45, 1
 s_mov_b32 s68, s42
 s_add_u32 s42, s42, 1310720
 v_mfma_f32_16x16x32_bf16 v[108:111], v[188:191], a[140:143], v[108:111]
 v_mfma_f32_16x16x32_bf16 v[116:119], v[188:191], a[164:167], v[116:119]
 v_mfma_f32_16x16x32_bf16 v[124:127], v[188:191], a[188:191], v[124:127]
 v_mfma_f32_16x16x32_bf16 v[132:135], v[188:191], a[212:215], v[132:135]
 v_mfma_f32_16x16x32_bf16 v[140:143], v[188:191], a[236:239], v[140:143]
 s_mov_b64 exec, 1
 v_mov_b32 v20, s69
 buffer_store_dword v20, v10, s[72:75], s44 offen sc1
 s_mov_b64 exec, -1
 s_cmp_le_u32 s45, 16
 s_cbranch_scc1 vwe_153
vwe_154:
 s_cmp_eq_u32 s23, 0
 s_cbranch_scc1 vws_151
vwb_152:
 s_waitcnt lgkmcnt(0)
 v_mfma_f32_16x16x32_bf16 v[64:67], v[192:195], a[0:3], 0
 v_cmp_gt_u32 vcc, 8, v9
 s_nop 0
 v_mfma_f32_16x16x32_bf16 v[72:75], v[192:195], a[24:27], 0
 s_bitset1_b64 vcc, 18
 s_ff1_i32_b64 s21, vcc
 v_mfma_f32_16x16x32_bf16 v[80:83], v[192:195], a[48:51], 0
 s_lshl_b32 s22, s21, 1
 s_lshl_b32 s21, s21, 2
 v_mfma_f32_16x16x32_bf16 v[88:91], v[192:195], a[72:75], 0
 s_sub_i32 s21, s21, 8
 s_max_i32 s47, s21, s22
 v_mfma_f32_16x16x32_bf16 v[96:99], v[192:195], a[96:99], 0
 s_add_u32 s22, s45, 7
 s_min_u32 s22, s22, s47
 v_mfma_f32_16x16x32_bf16 v[68:71], v[216:219], a[0:3], 0
 s_cmp_lt_u32 s46, s22
 s_cselect_b32 s66, s41, 0x80000000
 s_cselect_b32 m0, s64, 98304
 s_cselect_b32 s22, 1, 0
 v_mfma_f32_16x16x32_bf16 v[76:79], v[216:219], a[24:27], 0
 buffer_load_dwordx4 v4, s[16:19], s66 offen offset:0 sc1 lds
 v_mfma_f32_16x16x32_bf16 v[84:87], v[216:219], a[48:51], 0
 v_add_u32 v8, s65, v4
 s_add_u32 s65, s65, 12288
 v_mfma_f32_16x16x32_bf16 v[92:95], v[216:219], a[72:75], 0
 buffer_load_dwordx4 v4, s[16:19], s66 offen offset:1024 sc1 lds
 v_mfma_f32_16x16x32_bf16 v[100:103], v[216:219], a[96:99], 0
 s_cmp_lt_u32 s65, 98304
 s_cselect_b32 s65, s65, 0
 v_mfma_f32_16x16x32_bf16 v[64:67], v[196:199], a[4:7], v[64:67]
 buffer_load_dwordx4 v4, s[16:19], s66 offen offset:2048 sc1 lds
 v_mfma_f32_16x16x32_bf16 v[72:75], v[196:199], a[28:31], v[72:75]
 s_add_u32 s46, s46, s22
 s_mul_i32 s21, s22, 393216
 v_mfma_f32_16x16x32_bf16 v[80:83], v[196:199], a[52:55], v[80:83]
 s_add_u32 s41, s41, s21
 s_mul_i32 s21, s22, 12288
 v_mfma_f32_16x16x32_bf16 v[88:91], v[196:199], a[76:79], v[88:91]
 s_add_u32 s64, s64, s21
 v_cvt_pk_bf16_f32 v44, v104, v105
 v_mfma_f32_16x16x32_bf16 v[96:99], v[196:199], a[100:103], v[96:99]
 s_cmp_lt_u32 s64, s67
 s_cselect_b32 s64, s64, s71
 v_mfma_f32_16x16x32_bf16 v[68:71], v[220:223], a[4:7], v[68:71]
 v_cvt_pk_bf16_f32 v45, v106, v107
 v_cvt_pk_bf16_f32 v46, v108, v109
 v_mfma_f32_16x16x32_bf16 v[76:79], v[220:223], a[28:31], v[76:79]
 v_cvt_pk_bf16_f32 v47, v110, v111
 v_mfma_f32_16x16x32_bf16 v[84:87], v[220:223], a[52:55], v[84:87]
 s_add_u32 s69, s68, 4096
 v_mfma_f32_16x16x32_bf16 v[92:95], v[220:223], a[76:79], v[92:95]
 v_mfma_f32_16x16x32_bf16 v[100:103], v[220:223], a[100:103], v[100:103]
 buffer_store_dwordx4 v[44:47], v4, s[24:27], s69 offen offset:1024 sc1
 v_mfma_f32_16x16x32_bf16 v[64:67], v[200:203], a[8:11], v[64:67]
 v_mfma_f32_16x16x32_bf16 v[72:75], v[200:203], a[32:35], v[72:75]
 v_cvt_pk_bf16_f32 v48, v112, v113
 v_mfma_f32_16x16x32_bf16 v[80:83], v[200:203], a[56:59], v[80:83]
 v_cvt_pk_bf16_f32 v49, v114, v115
 v_mfma_f32_16x16x32_bf16 v[88:91], v[200:203], a[80:83], v[88:91]
 v_mfma_f32_16x16x32_bf16 v[96:99], v[200:203], a[104:107], v[96:99]
 v_cvt_pk_bf16_f32 v50, v116, v117
 v_mfma_f32_16x16x32_bf16 v[68:71], v[224:227], a[8:11], v[68:71]
 v_mfma_f32_16x16x32_bf16 v[76:79], v[224:227], a[32:35], v[76:79]
 v_cvt_pk_bf16_f32 v51, v118, v119
 v_mfma_f32_16x16x32_bf16 v[84:87], v[224:227], a[56:59], v[84:87]
 buffer_store_dwordx4 v[48:51], v4, s[24:27], s69 offen offset:2048 sc1
 v_mfma_f32_16x16x32_bf16 v[92:95], v[224:227], a[80:83], v[92:95]
 v_mfma_f32_16x16x32_bf16 v[100:103], v[224:227], a[104:107], v[100:103]
 v_cvt_pk_bf16_f32 v52, v120, v121
 v_mfma_f32_16x16x32_bf16 v[64:67], v[204:207], a[12:15], v[64:67]
 v_mfma_f32_16x16x32_bf16 v[72:75], v[204:207], a[36:39], v[72:75]
 v_cvt_pk_bf16_f32 v53, v122, v123
 v_mfma_f32_16x16x32_bf16 v[80:83], v[204:207], a[60:63], v[80:83]
 v_cvt_pk_bf16_f32 v54, v124, v125
 v_mfma_f32_16x16x32_bf16 v[88:91], v[204:207], a[84:87], v[88:91]
 v_mfma_f32_16x16x32_bf16 v[96:99], v[204:207], a[108:111], v[96:99]
 v_cvt_pk_bf16_f32 v55, v126, v127
 v_mfma_f32_16x16x32_bf16 v[68:71], v[228:231], a[12:15], v[68:71]
 v_mfma_f32_16x16x32_bf16 v[76:79], v[228:231], a[36:39], v[76:79]
 buffer_store_dwordx4 v[52:55], v4, s[24:27], s69 offen offset:3072 sc1
 v_mfma_f32_16x16x32_bf16 v[84:87], v[228:231], a[60:63], v[84:87]
 v_cvt_pk_bf16_f32 v56, v128, v129
 v_mfma_f32_16x16x32_bf16 v[92:95], v[228:231], a[84:87], v[92:95]
 v_mfma_f32_16x16x32_bf16 v[100:103], v[228:231], a[108:111], v[100:103]
 v_cvt_pk_bf16_f32 v57, v130, v131
 v_mfma_f32_16x16x32_bf16 v[64:67], v[208:211], a[16:19], v[64:67]
 s_cmp_lt_u32 s51, 6291456
 s_cselect_b32 s52, s51, 0x80000000
 v_mfma_f32_16x16x32_bf16 v[72:75], v[208:211], a[40:43], v[72:75]
 buffer_store_dwordx4 v[244:247], v4, s[84:87], s52 offen sc1
 v_mfma_f32_16x16x32_bf16 v[80:83], v[208:211], a[64:67], v[80:83]
 s_add_u32 s51, s51, 98304
 v_cvt_pk_bf16_f32 v58, v132, v133
 v_mfma_f32_16x16x32_bf16 v[88:91], v[208:211], a[88:91], v[88:91]
 v_cvt_pk_bf16_f32 v59, v134, v135
 v_mfma_f32_16x16x32_bf16 v[96:99], v[208:211], a[112:115], v[96:99]
 s_add_u32 s69, s68, 8192
 v_mfma_f32_16x16x32_bf16 v[68:71], v[232:235], a[16:19], v[68:71]
 v_mfma_f32_16x16x32_bf16 v[76:79], v[232:235], a[40:43], v[76:79]
 buffer_store_dwordx4 v[56:59], v4, s[24:27], s69 offen offset:0 sc1
 v_mfma_f32_16x16x32_bf16 v[84:87], v[232:235], a[64:67], v[84:87]
 v_cvt_pk_bf16_f32 v60, v136, v137
 v_mfma_f32_16x16x32_bf16 v[92:95], v[232:235], a[88:91], v[92:95]
 v_mfma_f32_16x16x32_bf16 v[100:103], v[232:235], a[112:115], v[100:103]
 v_cvt_pk_bf16_f32 v61, v138, v139
 v_mfma_f32_16x16x32_bf16 v[64:67], v[212:215], a[20:23], v[64:67]
 v_mfma_f32_16x16x32_bf16 v[72:75], v[212:215], a[44:47], v[72:75]
 v_cvt_pk_bf16_f32 v62, v140, v141
 v_mfma_f32_16x16x32_bf16 v[80:83], v[212:215], a[68:71], v[80:83]
 v_cvt_pk_bf16_f32 v63, v142, v143
 v_mfma_f32_16x16x32_bf16 v[88:91], v[212:215], a[92:95], v[88:91]
 v_mfma_f32_16x16x32_bf16 v[96:99], v[212:215], a[116:119], v[96:99]
 buffer_store_dwordx4 v[60:63], v4, s[24:27], s69 offen offset:1024 sc1
 v_mfma_f32_16x16x32_bf16 v[68:71], v[236:239], a[20:23], v[68:71]
 v_mfma_f32_16x16x32_bf16 v[76:79], v[236:239], a[44:47], v[76:79]
 v_mfma_f32_16x16x32_bf16 v[84:87], v[236:239], a[68:71], v[84:87]
 v_mfma_f32_16x16x32_bf16 v[92:95], v[236:239], a[92:95], v[92:95]
 v_mfma_f32_16x16x32_bf16 v[100:103], v[236:239], a[116:119], v[100:103]
 v_mfma_f32_16x16x32_bf16 v[104:107], v[192:195], a[120:123], 0
 buffer_load_dword v9, v5, s[72:75], s43 offen sc1
 v_mfma_f32_16x16x32_bf16 v[112:115], v[192:195], a[144:147], 0
 v_mfma_f32_16x16x32_bf16 v[120:123], v[192:195], a[168:171], 0
 v_mfma_f32_16x16x32_bf16 v[128:131], v[192:195], a[192:195], 0
 v_cvt_pk_bf16_f32 v24, v64, v65
 v_mfma_f32_16x16x32_bf16 v[136:139], v[192:195], a[216:219], 0
 s_add_u32 s63, s45, 1
 s_min_u32 s63, s63, 63
 v_mfma_f32_16x16x32_bf16 v[108:111], v[216:219], a[120:123], 0
 s_cmp_lt_u32 s63, s46
 s_cselect_b32 s53, 1, 0
 v_mfma_f32_16x16x32_bf16 v[116:119], v[216:219], a[144:147], 0
 v_mov_b32 v21, s53
 ds_write_b32 v6, v21 offset:16
 v_mfma_f32_16x16x32_bf16 v[124:127], v[216:219], a[168:171], 0
 v_cvt_pk_bf16_f32 v25, v66, v67
 v_cvt_pk_bf16_f32 v26, v68, v69
 v_mfma_f32_16x16x32_bf16 v[132:135], v[216:219], a[192:195], 0
 v_cvt_pk_bf16_f32 v27, v70, v71
 v_mfma_f32_16x16x32_bf16 v[140:143], v[216:219], a[216:219], 0
 v_mfma_f32_16x16x32_bf16 v[104:107], v[196:199], a[124:127], v[104:107]
 buffer_store_dwordx4 v[24:27], v4, s[24:27], s42 offen offset:0 sc1
 v_mfma_f32_16x16x32_bf16 v[112:115], v[196:199], a[148:151], v[112:115]
 v_cvt_pk_bf16_f32 v28, v72, v73
 v_mfma_f32_16x16x32_bf16 v[120:123], v[196:199], a[172:175], v[120:123]
 s_cmp_eq_u32 s40, 3
 s_cbranch_scc1 vwm_159
vwm_160:
 v_mfma_f32_16x16x32_bf16 v[128:131], v[196:199], a[196:199], v[128:131]
 v_cvt_pk_bf16_f32 v29, v74, v75
 v_mfma_f32_16x16x32_bf16 v[136:139], v[196:199], a[220:223], v[136:139]
 v_mfma_f32_16x16x32_bf16 v[108:111], v[220:223], a[124:127], v[108:111]
 v_cvt_pk_bf16_f32 v30, v76, v77
 v_mfma_f32_16x16x32_bf16 v[116:119], v[220:223], a[148:151], v[116:119]
 v_mfma_f32_16x16x32_bf16 v[124:127], v[220:223], a[172:175], v[124:127]
 v_cvt_pk_bf16_f32 v31, v78, v79
 v_mfma_f32_16x16x32_bf16 v[132:135], v[220:223], a[196:199], v[132:135]
 buffer_store_dwordx4 v[28:31], v4, s[24:27], s42 offen offset:1024 sc1
 v_mfma_f32_16x16x32_bf16 v[140:143], v[220:223], a[220:223], v[140:143]
 s_cmp_lt_u32 s63, s50
 s_cbranch_scc0 vwx_157
vwx_158:
 v_mfma_f32_16x16x32_bf16 v[104:107], v[200:203], a[128:131], v[104:107]
 s_waitcnt lgkmcnt(0)
 s_barrier
 v_mfma_f32_16x16x32_bf16 v[112:115], v[200:203], a[152:155], v[112:115]
 ds_read_b128 v[240:243], v7 offset:16
 v_cvt_pk_bf16_f32 v32, v80, v81
 v_mfma_f32_16x16x32_bf16 v[120:123], v[200:203], a[176:179], v[120:123]
 ds_read_b128 v[144:147], v8 offset:0
 v_cvt_pk_bf16_f32 v33, v82, v83
 v_mfma_f32_16x16x32_bf16 v[128:131], v[200:203], a[200:203], v[128:131]
 v_mfma_f32_16x16x32_bf16 v[136:139], v[200:203], a[224:227], v[136:139]
 ds_read_b128 v[148:151], v8 offset:1024
 v_cvt_pk_bf16_f32 v34, v84, v85
 v_mfma_f32_16x16x32_bf16 v[108:111], v[224:227], a[128:131], v[108:111]
 v_mfma_f32_16x16x32_bf16 v[116:119], v[224:227], a[152:155], v[116:119]
 v_cvt_pk_bf16_f32 v35, v86, v87
 v_mfma_f32_16x16x32_bf16 v[124:127], v[224:227], a[176:179], v[124:127]
 ds_read_b128 v[152:155], v8 offset:2048
 v_mfma_f32_16x16x32_bf16 v[132:135], v[224:227], a[200:203], v[132:135]
 buffer_store_dwordx4 v[32:35], v4, s[24:27], s42 offen offset:2048 sc1
 v_mfma_f32_16x16x32_bf16 v[140:143], v[224:227], a[224:227], v[140:143]
 ds_read_b128 v[156:159], v8 offset:3072
 v_cvt_pk_bf16_f32 v36, v88, v89
 v_mfma_f32_16x16x32_bf16 v[104:107], v[204:207], a[132:135], v[104:107]
 v_mfma_f32_16x16x32_bf16 v[112:115], v[204:207], a[156:159], v[112:115]
 v_cvt_pk_bf16_f32 v37, v90, v91
 v_mfma_f32_16x16x32_bf16 v[120:123], v[204:207], a[180:183], v[120:123]
 ds_read_b128 v[160:163], v8 offset:4096
 v_mfma_f32_16x16x32_bf16 v[128:131], v[204:207], a[204:207], v[128:131]
 v_cvt_pk_bf16_f32 v38, v92, v93
 v_mfma_f32_16x16x32_bf16 v[136:139], v[204:207], a[228:231], v[136:139]
 ds_read_b128 v[164:167], v8 offset:5120
 s_waitcnt lgkmcnt(4)
 v_mfma_f32_16x16x32_bf16 v[108:111], v[228:231], a[132:135], v[108:111]
 v_bitop3_b32 v240, v240, v241, v242 bitop3:0x80
 v_and_b32 v240, v240, v243
 v_mfma_f32_16x16x32_bf16 v[116:119], v[228:231], a[156:159], v[116:119]
 s_nop 0
 v_readfirstlane_b32 s23, v240
 v_mfma_f32_16x16x32_bf16 v[124:127], v[228:231], a[180:183], v[124:127]
 ds_read_b128 v[168:171], v8 offset:6144
 v_cvt_pk_bf16_f32 v39, v94, v95
 v_mfma_f32_16x16x32_bf16 v[132:135], v[228:231], a[204:207], v[132:135]
 buffer_store_dwordx4 v[36:39], v4, s[24:27], s42 offen offset:3072 sc1
 v_mfma_f32_16x16x32_bf16 v[140:143], v[228:231], a[228:231], v[140:143]
 ds_read_b128 v[172:175], v8 offset:7168
 v_cvt_pk_bf16_f32 v40, v96, v97
 v_mfma_f32_16x16x32_bf16 v[104:107], v[208:211], a[136:139], v[104:107]
 v_cvt_pk_bf16_f32 v41, v98, v99
 v_mfma_f32_16x16x32_bf16 v[112:115], v[208:211], a[160:163], v[112:115]
 v_cvt_pk_bf16_f32 v42, v100, v101
 v_mfma_f32_16x16x32_bf16 v[120:123], v[208:211], a[184:187], v[120:123]
 ds_read_b128 v[176:179], v8 offset:8192
 v_mfma_f32_16x16x32_bf16 v[128:131], v[208:211], a[208:211], v[128:131]
 v_cvt_pk_bf16_f32 v43, v102, v103
 v_mfma_f32_16x16x32_bf16 v[136:139], v[208:211], a[232:235], v[136:139]
 ds_read_b128 v[180:183], v8 offset:9216
 v_mfma_f32_16x16x32_bf16 v[108:111], v[232:235], a[136:139], v[108:111]
 s_add_u32 s69, s42, 4096
 v_mfma_f32_16x16x32_bf16 v[116:119], v[232:235], a[160:163], v[116:119]
 v_mfma_f32_16x16x32_bf16 v[124:127], v[232:235], a[184:187], v[124:127]
 ds_read_b128 v[184:187], v8 offset:10240
 v_mfma_f32_16x16x32_bf16 v[132:135], v[232:235], a[208:211], v[132:135]
 buffer_store_dwordx4 v[40:43], v4, s[24:27], s69 offen offset:0 sc1
 v_mfma_f32_16x16x32_bf16 v[140:143], v[232:235], a[232:235], v[140:143]
 ds_read_b128 v[188:191], v8 offset:11264
 v_mfma_f32_16x16x32_bf16 v[104:107], v[212:215], a[140:143], v[104:107]
 v_mfma_f32_16x16x32_bf16 v[112:115], v[212:215], a[164:167], v[112:115]
 v_mfma_f32_16x16x32_bf16 v[120:123], v[212:215], a[188:191], v[120:123]
 s_waitcnt vmcnt(12)
 s_mov_b32 s50, s46
 s_add_u32 s69, s45, s40
 v_mfma_f32_16x16x32_bf16 v[128:131], v[212:215], a[212:215], v[128:131]
 s_mov_b32 s40, 0
 s_sub_i32 s69, s69, 1
 s_max_i32 s69, s69, s70
 v_mfma_f32_16x16x32_bf16 v[136:139], v[212:215], a[236:239], v[136:139]
 s_add_u32 s45, s45, 1
 s_mov_b32 s68, s42
 s_add_u32 s42, s42, 1310720
 v_mfma_f32_16x16x32_bf16 v[108:111], v[236:239], a[140:143], v[108:111]
 v_mfma_f32_16x16x32_bf16 v[116:119], v[236:239], a[164:167], v[116:119]
 v_mfma_f32_16x16x32_bf16 v[124:127], v[236:239], a[188:191], v[124:127]
 v_mfma_f32_16x16x32_bf16 v[132:135], v[236:239], a[212:215], v[132:135]
 v_mfma_f32_16x16x32_bf16 v[140:143], v[236:239], a[236:239], v[140:143]
 s_mov_b64 exec, 1
 v_mov_b32 v20, s69
 buffer_store_dword v20, v10, s[72:75], s44 offen sc1
 s_mov_b64 exec, -1
 s_cmp_le_u32 s45, 16
 s_cbranch_scc1 vwe_163
vwe_164:
 s_cmp_lg_u32 s45, 44
 s_cbranch_scc1 arm_167
 s_mul_i32 s21, s2, 10240
 s_mul_i32 s22, s20, 2560
 s_add_u32 s21, s21, s22
 s_add_u32 s21, s21, 17039360
 buffer_store_dwordx4 v[244:247], v15, s[80:83], s21 offen offset:0 sc1
 buffer_store_dwordx4 v[244:247], v15, s[80:83], s21 offen offset:512 sc1
 buffer_store_dwordx4 v[244:247], v15, s[80:83], s21 offen offset:1024 sc1
 buffer_store_dwordx4 v[244:247], v15, s[80:83], s21 offen offset:1536 sc1
 buffer_store_dwordx4 v[244:247], v15, s[80:83], s21 offen offset:2048 sc1
 s_add_u32 s21, s21, 655360
 buffer_store_dwordx4 v[244:247], v15, s[80:83], s21 offen offset:0 sc1
 buffer_store_dwordx4 v[244:247], v15, s[80:83], s21 offen offset:512 sc1
 buffer_store_dwordx4 v[244:247], v15, s[80:83], s21 offen offset:1024 sc1
 buffer_store_dwordx4 v[244:247], v15, s[80:83], s21 offen offset:1536 sc1
 buffer_store_dwordx4 v[244:247], v15, s[80:83], s21 offen offset:2048 sc1
 s_add_u32 s21, s21, 655360
 buffer_store_dwordx4 v[244:247], v15, s[80:83], s21 offen offset:0 sc1
 buffer_store_dwordx4 v[244:247], v15, s[80:83], s21 offen offset:512 sc1
 buffer_store_dwordx4 v[244:247], v15, s[80:83], s21 offen offset:1024 sc1
 buffer_store_dwordx4 v[244:247], v15, s[80:83], s21 offen offset:1536 sc1
 buffer_store_dwordx4 v[244:247], v15, s[80:83], s21 offen offset:2048 sc1
 s_add_u32 s21, s21, 655360
 buffer_store_dwordx4 v[244:247], v15, s[80:83], s21 offen offset:0 sc1
 buffer_store_dwordx4 v[244:247], v15, s[80:83], s21 offen offset:512 sc1
 buffer_store_dwordx4 v[244:247], v15, s[80:83], s21 offen offset:1024 sc1
 buffer_store_dwordx4 v[244:247], v15, s[80:83], s21 offen offset:1536 sc1
 buffer_store_dwordx4 v[244:247], v15, s[80:83], s21 offen offset:2048 sc1
 s_add_u32 s21, s21, 655360
 buffer_store_dwordx4 v[244:247], v15, s[80:83], s21 offen offset:0 sc1
 buffer_store_dwordx4 v[244:247], v15, s[80:83], s21 offen offset:512 sc1
 buffer_store_dwordx4 v[244:247], v15, s[80:83], s21 offen offset:1024 sc1
 buffer_store_dwordx4 v[244:247], v15, s[80:83], s21 offen offset:1536 sc1
 buffer_store_dwordx4 v[244:247], v15, s[80:83], s21 offen offset:2048 sc1
 s_add_u32 s21, s21, 655360
 buffer_store_dwordx4 v[244:247], v15, s[80:83], s21 offen offset:0 sc1
 buffer_store_dwordx4 v[244:247], v15, s[80:83], s21 offen offset:512 sc1
 buffer_store_dwordx4 v[244:247], v15, s[80:83], s21 offen offset:1024 sc1
 buffer_store_dwordx4 v[244:247], v15, s[80:83], s21 offen offset:1536 sc1
 buffer_store_dwordx4 v[244:247], v15, s[80:83], s21 offen offset:2048 sc1
 s_add_u32 s21, s21, 655360
 s_and_b32 s21, s2, 3
 s_cmp_lg_u32 s21, s20
 s_cbranch_scc1 arm_167
 s_mul_i32 s21, s2, 2560
 s_add_u32 s21, s21, 4259840
 v_lshlrev_b32 v21, 3, v1
 buffer_store_dwordx4 v[244:247], v4, s[88:91], s21 offen sc1
 buffer_store_dwordx4 v[244:247], v4, s[88:91], s21 offen offset:1024 sc1
 buffer_store_dwordx2 v[244:245], v21, s[88:91], s21 offen offset:2048 sc1
 s_add_u32 s21, s21, 81920
 buffer_store_dwordx4 v[244:247], v4, s[88:91], s21 offen sc1
 buffer_store_dwordx4 v[244:247], v4, s[88:91], s21 offen offset:1024 sc1
 buffer_store_dwordx2 v[244:245], v21, s[88:91], s21 offen offset:2048 sc1
 s_add_u32 s21, s21, 81920
 buffer_store_dwordx4 v[244:247], v4, s[88:91], s21 offen sc1
 buffer_store_dwordx4 v[244:247], v4, s[88:91], s21 offen offset:1024 sc1
 buffer_store_dwordx2 v[244:245], v21, s[88:91], s21 offen offset:2048 sc1
 s_add_u32 s21, s21, 81920
 buffer_store_dwordx4 v[244:247], v4, s[88:91], s21 offen sc1
 buffer_store_dwordx4 v[244:247], v4, s[88:91], s21 offen offset:1024 sc1
 buffer_store_dwordx2 v[244:245], v21, s[88:91], s21 offen offset:2048 sc1
 s_add_u32 s21, s21, 81920
 buffer_store_dwordx4 v[244:247], v4, s[88:91], s21 offen sc1
 buffer_store_dwordx4 v[244:247], v4, s[88:91], s21 offen offset:1024 sc1
 buffer_store_dwordx2 v[244:245], v21, s[88:91], s21 offen offset:2048 sc1
 s_add_u32 s21, s21, 81920
 buffer_store_dwordx4 v[244:247], v4, s[88:91], s21 offen sc1
 buffer_store_dwordx4 v[244:247], v4, s[88:91], s21 offen offset:1024 sc1
 buffer_store_dwordx2 v[244:245], v21, s[88:91], s21 offen offset:2048 sc1
 s_add_u32 s21, s21, 81920
 buffer_store_dwordx4 v[244:247], v4, s[88:91], s21 offen sc1
 buffer_store_dwordx4 v[244:247], v4, s[88:91], s21 offen offset:1024 sc1
 buffer_store_dwordx2 v[244:245], v21, s[88:91], s21 offen offset:2048 sc1
 s_add_u32 s21, s21, 81920
 buffer_store_dwordx4 v[244:247], v4, s[88:91], s21 offen sc1
 buffer_store_dwordx4 v[244:247], v4, s[88:91], s21 offen offset:1024 sc1
 buffer_store_dwordx2 v[244:245], v21, s[88:91], s21 offen offset:2048 sc1
 s_add_u32 s21, s21, 81920
 buffer_store_dwordx4 v[244:247], v4, s[88:91], s21 offen sc1
 buffer_store_dwordx4 v[244:247], v4, s[88:91], s21 offen offset:1024 sc1
 buffer_store_dwordx2 v[244:245], v21, s[88:91], s21 offen offset:2048 sc1
 s_add_u32 s21, s21, 81920
 buffer_store_dwordx4 v[244:247], v4, s[88:91], s21 offen sc1
 buffer_store_dwordx4 v[244:247], v4, s[88:91], s21 offen offset:1024 sc1
 buffer_store_dwordx2 v[244:245], v21, s[88:91], s21 offen offset:2048 sc1
 s_add_u32 s21, s21, 81920
 buffer_store_dwordx4 v[244:247], v4, s[88:91], s21 offen sc1
 buffer_store_dwordx4 v[244:247], v4, s[88:91], s21 offen offset:1024 sc1
 buffer_store_dwordx2 v[244:245], v21, s[88:91], s21 offen offset:2048 sc1
 s_add_u32 s21, s21, 81920
 buffer_store_dwordx4 v[244:247], v4, s[88:91], s21 offen sc1
 buffer_store_dwordx4 v[244:247], v4, s[88:91], s21 offen offset:1024 sc1
 buffer_store_dwordx2 v[244:245], v21, s[88:91], s21 offen offset:2048 sc1
 s_add_u32 s21, s21, 81920
arm_167:
 s_cmp_ge_u32 s45, 64
 s_cbranch_scc1 vwd_146
 s_cmp_lg_u32 s23, 0
 s_cbranch_scc1 vwl_145
 s_branch vws_161
vws_151:
 v_cmp_gt_u32 vcc, 8, v9
 s_nop 0
 s_bitset1_b64 vcc, 18
 s_ff1_i32_b64 s21, vcc
 s_lshl_b32 s22, s21, 1
 s_lshl_b32 s21, s21, 2
 s_sub_i32 s21, s21, 8
 s_max_i32 s47, s21, s22
 s_cmp_gt_u32 s47, s45
 s_cbranch_scc1 va_169
 s_cmp_eq_u32 s70, s45
 s_cbranch_scc1 va_174
 s_nop 4
 v_cvt_pk_bf16_f32 v44, v104, v105
 v_cvt_pk_bf16_f32 v45, v106, v107
 v_cvt_pk_bf16_f32 v46, v108, v109
 v_cvt_pk_bf16_f32 v47, v110, v111
 s_add_u32 s69, s68, 4096
 buffer_store_dwordx4 v[44:47], v4, s[24:27], s69 offen offset:1024 sc1
 v_cvt_pk_bf16_f32 v48, v112, v113
 v_cvt_pk_bf16_f32 v49, v114, v115
 v_cvt_pk_bf16_f32 v50, v116, v117
 v_cvt_pk_bf16_f32 v51, v118, v119
 buffer_store_dwordx4 v[48:51], v4, s[24:27], s69 offen offset:2048 sc1
 v_cvt_pk_bf16_f32 v52, v120, v121
 v_cvt_pk_bf16_f32 v53, v122, v123
 v_cvt_pk_bf16_f32 v54, v124, v125
 v_cvt_pk_bf16_f32 v55, v126, v127
 buffer_store_dwordx4 v[52:55], v4, s[24:27], s69 offen offset:3072 sc1
 v_cvt_pk_bf16_f32 v56, v128, v129
 v_cvt_pk_bf16_f32 v57, v130, v131
 v_cvt_pk_bf16_f32 v58, v132, v133
 v_cvt_pk_bf16_f32 v59, v134, v135
 s_add_u32 s69, s68, 8192
 buffer_store_dwordx4 v[56:59], v4, s[24:27], s69 offen offset:0 sc1
 v_cvt_pk_bf16_f32 v60, v136, v137
 v_cvt_pk_bf16_f32 v61, v138, v139
 v_cvt_pk_bf16_f32 v62, v140, v141
 v_cvt_pk_bf16_f32 v63, v142, v143
 buffer_store_dwordx4 v[60:63], v4, s[24:27], s69 offen offset:1024 sc1
 s_mov_b32 s68, 0x80000000
 s_mov_b32 s56, s68
 s_mov_b32 s57, s68
 s_waitcnt vmcnt(0)
 s_mov_b64 exec, 1
 v_mov_b32 v20, s45
 buffer_store_dword v20, v10, s[72:75], s44 offen sc1
 s_mov_b64 exec, -1
 s_mov_b32 s70, s45
 s_mov_b32 s40, 0
va_174:
 s_mov_b32 s101, 0
 s_branch va_172
va_170:
 s_sleep 8
va_172:
 buffer_load_dword v9, v5, s[72:75], s43 offen sc1
 s_add_u32 s101, s101, 1
 s_cmp_gt_u32 s101, 131072
 s_cbranch_scc1 main_end
 s_waitcnt vmcnt(0)
 v_cmp_gt_u32 vcc, 8, v9
 s_nop 0
 s_bitset1_b64 vcc, 18
 s_ff1_i32_b64 s21, vcc
 s_lshl_b32 s22, s21, 1
 s_lshl_b32 s21, s21, 2
 s_sub_i32 s21, s21, 8
 s_max_i32 s47, s21, s22
 s_cmp_gt_u32 s47, s45
 s_cbranch_scc0 va_170
va_169:
 s_add_u32 s22, s45, 6
 s_min_u32 s22, s22, s47
va_171:
 s_cmp_ge_u32 s46, s22
 s_cbranch_scc1 va_173
 s_mov_b32 m0, s64
 s_mov_b32 s66, s41
 buffer_load_dwordx4 v4, s[16:19], s66 offen offset:0 sc1 lds
 buffer_load_dwordx4 v4, s[16:19], s66 offen offset:1024 sc1 lds
 buffer_load_dwordx4 v4, s[16:19], s66 offen offset:2048 sc1 lds
 s_add_u32 s46, s46, 1
 s_add_u32 s41, s41, 393216
 s_add_u32 s64, s64, 12288
 s_cmp_lt_u32 s64, s67
 s_cselect_b32 s64, s64, s71
 s_branch va_171
va_173:
 s_mov_b32 s48, s46
 s_mov_b32 s49, s46
 s_mov_b32 s50, s46
 s_waitcnt vmcnt(0)
 s_cmp_eq_u32 s40, 0
 s_cbranch_scc1 va_175
 s_mov_b32 s40, 0
 s_mov_b64 exec, 1
 v_mov_b32 v20, s45
 buffer_store_dword v20, v10, s[72:75], s44 offen sc1
 s_mov_b64 exec, -1
 s_mov_b32 s70, s45
va_175:
 s_barrier
 ds_read_b128 v[192:195], v8 offset:0
 ds_read_b128 v[196:199], v8 offset:1024
 ds_read_b128 v[200:203], v8 offset:2048
 ds_read_b128 v[204:207], v8 offset:3072
 ds_read_b128 v[208:211], v8 offset:4096
 ds_read_b128 v[212:215], v8 offset:5120
 ds_read_b128 v[216:219], v8 offset:6144
 ds_read_b128 v[220:223], v8 offset:7168
 ds_read_b128 v[224:227], v8 offset:8192
 ds_read_b128 v[228:231], v8 offset:9216
 ds_read_b128 v[232:235], v8 offset:10240
 ds_read_b128 v[236:239], v8 offset:11264
 s_branch vwb_152
vws_161:
 v_cmp_gt_u32 vcc, 8, v9
 s_nop 0
 s_bitset1_b64 vcc, 18
 s_ff1_i32_b64 s21, vcc
 s_lshl_b32 s22, s21, 1
 s_lshl_b32 s21, s21, 2
 s_sub_i32 s21, s21, 8
 s_max_i32 s47, s21, s22
 s_cmp_gt_u32 s47, s45
 s_cbranch_scc1 va_176
 s_cmp_eq_u32 s70, s45
 s_cbranch_scc1 va_181
 s_nop 4
 v_cvt_pk_bf16_f32 v44, v104, v105
 v_cvt_pk_bf16_f32 v45, v106, v107
 v_cvt_pk_bf16_f32 v46, v108, v109
 v_cvt_pk_bf16_f32 v47, v110, v111
 s_add_u32 s69, s68, 4096
 buffer_store_dwordx4 v[44:47], v4, s[24:27], s69 offen offset:1024 sc1
 v_cvt_pk_bf16_f32 v48, v112, v113
 v_cvt_pk_bf16_f32 v49, v114, v115
 v_cvt_pk_bf16_f32 v50, v116, v117
 v_cvt_pk_bf16_f32 v51, v118, v119
 buffer_store_dwordx4 v[48:51], v4, s[24:27], s69 offen offset:2048 sc1
 v_cvt_pk_bf16_f32 v52, v120, v121
 v_cvt_pk_bf16_f32 v53, v122, v123
 v_cvt_pk_bf16_f32 v54, v124, v125
 v_cvt_pk_bf16_f32 v55, v126, v127
 buffer_store_dwordx4 v[52:55], v4, s[24:27], s69 offen offset:3072 sc1
 v_cvt_pk_bf16_f32 v56, v128, v129
 v_cvt_pk_bf16_f32 v57, v130, v131
 v_cvt_pk_bf16_f32 v58, v132, v133
 v_cvt_pk_bf16_f32 v59, v134, v135
 s_add_u32 s69, s68, 8192
 buffer_store_dwordx4 v[56:59], v4, s[24:27], s69 offen offset:0 sc1
 v_cvt_pk_bf16_f32 v60, v136, v137
 v_cvt_pk_bf16_f32 v61, v138, v139
 v_cvt_pk_bf16_f32 v62, v140, v141
 v_cvt_pk_bf16_f32 v63, v142, v143
 buffer_store_dwordx4 v[60:63], v4, s[24:27], s69 offen offset:1024 sc1
 s_mov_b32 s68, 0x80000000
 s_mov_b32 s56, s68
 s_mov_b32 s57, s68
 s_waitcnt vmcnt(0)
 s_mov_b64 exec, 1
 v_mov_b32 v20, s45
 buffer_store_dword v20, v10, s[72:75], s44 offen sc1
 s_mov_b64 exec, -1
 s_mov_b32 s70, s45
 s_mov_b32 s40, 0
va_181:
 s_mov_b32 s101, 0
 s_branch va_179
va_177:
 s_sleep 8
va_179:
 buffer_load_dword v9, v5, s[72:75], s43 offen sc1
 s_add_u32 s101, s101, 1
 s_cmp_gt_u32 s101, 131072
 s_cbranch_scc1 main_end
 s_waitcnt vmcnt(0)
 v_cmp_gt_u32 vcc, 8, v9
 s_nop 0
 s_bitset1_b64 vcc, 18
 s_ff1_i32_b64 s21, vcc
 s_lshl_b32 s22, s21, 1
 s_lshl_b32 s21, s21, 2
 s_sub_i32 s21, s21, 8
 s_max_i32 s47, s21, s22
 s_cmp_gt_u32 s47, s45
 s_cbranch_scc0 va_177
va_176:
 s_add_u32 s22, s45, 6
 s_min_u32 s22, s22, s47
va_178:
 s_cmp_ge_u32 s46, s22
 s_cbranch_scc1 va_180
 s_mov_b32 m0, s64
 s_mov_b32 s66, s41
 buffer_load_dwordx4 v4, s[16:19], s66 offen offset:0 sc1 lds
 buffer_load_dwordx4 v4, s[16:19], s66 offen offset:1024 sc1 lds
 buffer_load_dwordx4 v4, s[16:19], s66 offen offset:2048 sc1 lds
 s_add_u32 s46, s46, 1
 s_add_u32 s41, s41, 393216
 s_add_u32 s64, s64, 12288
 s_cmp_lt_u32 s64, s67
 s_cselect_b32 s64, s64, s71
 s_branch va_178
va_180:
 s_mov_b32 s48, s46
 s_mov_b32 s49, s46
 s_mov_b32 s50, s46
 s_waitcnt vmcnt(0)
 s_cmp_eq_u32 s40, 0
 s_cbranch_scc1 va_182
 s_mov_b32 s40, 0
 s_mov_b64 exec, 1
 v_mov_b32 v20, s45
 buffer_store_dword v20, v10, s[72:75], s44 offen sc1
 s_mov_b64 exec, -1
 s_mov_b32 s70, s45
va_182:
 s_barrier
 ds_read_b128 v[144:147], v8 offset:0
 ds_read_b128 v[148:151], v8 offset:1024
 ds_read_b128 v[152:155], v8 offset:2048
 ds_read_b128 v[156:159], v8 offset:3072
 ds_read_b128 v[160:163], v8 offset:4096
 ds_read_b128 v[164:167], v8 offset:5120
 ds_read_b128 v[168:171], v8 offset:6144
 ds_read_b128 v[172:175], v8 offset:7168
 ds_read_b128 v[176:179], v8 offset:8192
 ds_read_b128 v[180:183], v8 offset:9216
 ds_read_b128 v[184:187], v8 offset:10240
 ds_read_b128 v[188:191], v8 offset:11264
 s_branch vwl_145
vwe_153:
 s_nop 4
 v_cvt_pk_bf16_f32 v44, v104, v105
 v_cvt_pk_bf16_f32 v45, v106, v107
 v_cvt_pk_bf16_f32 v46, v108, v109
 v_cvt_pk_bf16_f32 v47, v110, v111
 s_add_u32 s69, s68, 4096
 buffer_store_dwordx4 v[44:47], v4, s[24:27], s69 offen offset:1024 sc1
 v_cvt_pk_bf16_f32 v48, v112, v113
 v_cvt_pk_bf16_f32 v49, v114, v115
 v_cvt_pk_bf16_f32 v50, v116, v117
 v_cvt_pk_bf16_f32 v51, v118, v119
 buffer_store_dwordx4 v[48:51], v4, s[24:27], s69 offen offset:2048 sc1
 v_cvt_pk_bf16_f32 v52, v120, v121
 v_cvt_pk_bf16_f32 v53, v122, v123
 v_cvt_pk_bf16_f32 v54, v124, v125
 v_cvt_pk_bf16_f32 v55, v126, v127
 buffer_store_dwordx4 v[52:55], v4, s[24:27], s69 offen offset:3072 sc1
 v_cvt_pk_bf16_f32 v56, v128, v129
 v_cvt_pk_bf16_f32 v57, v130, v131
 v_cvt_pk_bf16_f32 v58, v132, v133
 v_cvt_pk_bf16_f32 v59, v134, v135
 s_add_u32 s69, s68, 8192
 buffer_store_dwordx4 v[56:59], v4, s[24:27], s69 offen offset:0 sc1
 v_cvt_pk_bf16_f32 v60, v136, v137
 v_cvt_pk_bf16_f32 v61, v138, v139
 v_cvt_pk_bf16_f32 v62, v140, v141
 v_cvt_pk_bf16_f32 v63, v142, v143
 buffer_store_dwordx4 v[60:63], v4, s[24:27], s69 offen offset:1024 sc1
 s_mov_b32 s68, 0x80000000
 s_mov_b32 s56, s68
 s_mov_b32 s57, s68
 s_cmp_le_u32 s45, 4
 s_cselect_b32 s40, 3, 1
 s_branch vwe_154
vwe_163:
 s_nop 4
 v_cvt_pk_bf16_f32 v44, v104, v105
 v_cvt_pk_bf16_f32 v45, v106, v107
 v_cvt_pk_bf16_f32 v46, v108, v109
 v_cvt_pk_bf16_f32 v47, v110, v111
 s_add_u32 s69, s68, 4096
 buffer_store_dwordx4 v[44:47], v4, s[24:27], s69 offen offset:1024 sc1
 v_cvt_pk_bf16_f32 v48, v112, v113
 v_cvt_pk_bf16_f32 v49, v114, v115
 v_cvt_pk_bf16_f32 v50, v116, v117
 v_cvt_pk_bf16_f32 v51, v118, v119
 buffer_store_dwordx4 v[48:51], v4, s[24:27], s69 offen offset:2048 sc1
 v_cvt_pk_bf16_f32 v52, v120, v121
 v_cvt_pk_bf16_f32 v53, v122, v123
 v_cvt_pk_bf16_f32 v54, v124, v125
 v_cvt_pk_bf16_f32 v55, v126, v127
 buffer_store_dwordx4 v[52:55], v4, s[24:27], s69 offen offset:3072 sc1
 v_cvt_pk_bf16_f32 v56, v128, v129
 v_cvt_pk_bf16_f32 v57, v130, v131
 v_cvt_pk_bf16_f32 v58, v132, v133
 v_cvt_pk_bf16_f32 v59, v134, v135
 s_add_u32 s69, s68, 8192
 buffer_store_dwordx4 v[56:59], v4, s[24:27], s69 offen offset:0 sc1
 v_cvt_pk_bf16_f32 v60, v136, v137
 v_cvt_pk_bf16_f32 v61, v138, v139
 v_cvt_pk_bf16_f32 v62, v140, v141
 v_cvt_pk_bf16_f32 v63, v142, v143
 buffer_store_dwordx4 v[60:63], v4, s[24:27], s69 offen offset:1024 sc1
 s_mov_b32 s68, 0x80000000
 s_mov_b32 s56, s68
 s_mov_b32 s57, s68
 s_cmp_le_u32 s45, 4
 s_cselect_b32 s40, 3, 1
 s_branch vwe_164
vwx_147:
 s_waitcnt vmcnt(9)
 s_branch vwx_148
vwx_157:
 s_waitcnt vmcnt(9)
 s_branch vwx_158
vwm_149:
 s_mov_b32 s40, 0
 s_waitcnt vmcnt(11)
 s_mov_b64 exec, 1
 v_mov_b32 v20, s45
 buffer_store_dword v20, v10, s[72:75], s44 offen sc1
 s_mov_b64 exec, -1
 s_mov_b32 s70, s45
 s_branch vwm_150
vwm_159:
 s_mov_b32 s40, 0
 s_waitcnt vmcnt(11)
 s_mov_b64 exec, 1
 v_mov_b32 v20, s45
 buffer_store_dword v20, v10, s[72:75], s44 offen sc1
 s_mov_b64 exec, -1
 s_mov_b32 s70, s45
 s_branch vwm_160
vwd_146:
 s_nop 4
 v_cvt_pk_bf16_f32 v44, v104, v105
 v_cvt_pk_bf16_f32 v45, v106, v107
 v_cvt_pk_bf16_f32 v46, v108, v109
 v_cvt_pk_bf16_f32 v47, v110, v111
 s_add_u32 s69, s68, 4096
 buffer_store_dwordx4 v[44:47], v4, s[24:27], s69 offen offset:1024 sc1
 v_cvt_pk_bf16_f32 v48, v112, v113
 v_cvt_pk_bf16_f32 v49, v114, v115
 v_cvt_pk_bf16_f32 v50, v116, v117
 v_cvt_pk_bf16_f32 v51, v118, v119
 buffer_store_dwordx4 v[48:51], v4, s[24:27], s69 offen offset:2048 sc1
 v_cvt_pk_bf16_f32 v52, v120, v121
 v_cvt_pk_bf16_f32 v53, v122, v123
 v_cvt_pk_bf16_f32 v54, v124, v125
 v_cvt_pk_bf16_f32 v55, v126, v127
 buffer_store_dwordx4 v[52:55], v4, s[24:27], s69 offen offset:3072 sc1
 v_cvt_pk_bf16_f32 v56, v128, v129
 v_cvt_pk_bf16_f32 v57, v130, v131
 v_cvt_pk_bf16_f32 v58, v132, v133
 v_cvt_pk_bf16_f32 v59, v134, v135
 s_add_u32 s69, s68, 8192
 buffer_store_dwordx4 v[56:59], v4, s[24:27], s69 offen offset:0 sc1
 v_cvt_pk_bf16_f32 v60, v136, v137
 v_cvt_pk_bf16_f32 v61, v138, v139
 v_cvt_pk_bf16_f32 v62, v140, v141
 v_cvt_pk_bf16_f32 v63, v142, v143
 buffer_store_dwordx4 v[60:63], v4, s[24:27], s69 offen offset:1024 sc1
 s_waitcnt vmcnt(0)
 s_mov_b64 exec, 1
 v_mov_b32 v20, s45
 buffer_store_dword v20, v10, s[72:75], s44 offen sc1
 s_mov_b64 exec, -1
 s_mov_b32 s84, 0
 s_mov_b32 s85, -1
 s_and_b32 s21, s3, 3
 s_sub_u32 s22, s21, 0
 s_lshl_b32 s22, s22, 3
 s_bfe_u32 s87, s3, 0x30002
 s_add_u32 s87, s87, s22
 s_add_u32 s87, s87, 252
 s_cmp_lt_u32 s21, 0
 s_cselect_b32 s87, -1, s87
 s_sub_u32 s21, s3, 64
 s_waitcnt vmcnt(0) lgkmcnt(0)
 s_barrier
 s_branch do_opb2
 s_mov_b32 s84, 0
 s_mov_b32 s85, -1
 s_mov_b32 s86, 0
 s_branch queue
not_vw:
 s_sub_u32 s2, s3, 96
 s_cmp_lg_u32 s2, 31
 s_cbranch_scc1 not_cal
 s_add_u32 s8, s38, 83886079
 s_addc_u32 s9, s39, 0
 s_and_b32 s8, s8, 0xffe00000
 s_mov_b32 s10, 2097152
 s_mov_b32 s11, 0x00020000
 v_lshrrev_b32 v9, 4, v0
 v_mul_u32_u24 v9, 16640, v9
 v_bfe_u32 v10, v0, 3, 1
 v_lshl_add_u32 v9, v10, 13, v9
 v_and_b32 v10, 7, v0
 v_lshl_add_u32 v9, v10, 4, v9
 s_mov_b32 s21, 1048576
 buffer_store_dwordx4 v[4:7], v9, s[8:11], s21 offen sc1
 s_waitcnt vmcnt(0)
 s_barrier
 s_cmp_lg_u32 s20, 3
 s_cbranch_scc1 cal_183
 s_mov_b64 exec, 1
 v_mov_b32 v4, 0
 s_mov_b32 s40, -1
 s_mov_b32 s41, -1
 s_mov_b32 s42, 1048576
 s_mov_b32 s43, 0
 s_waitcnt vmcnt(0)
cal_184:
 s_add_u32 s21, s42, 0
 s_memtime s[98:99]
 s_waitcnt lgkmcnt(0)
 buffer_load_dword v5, v4, s[8:11], s21 offen sc1
 s_waitcnt vmcnt(0)
 s_memtime s[100:101]
 s_waitcnt lgkmcnt(0)
 s_sub_u32 s21, s100, s98
 s_min_u32 s40, s40, s21
 s_add_u32 s21, s42, 8192
 s_memtime s[98:99]
 s_waitcnt lgkmcnt(0)
 buffer_load_dword v5, v4, s[8:11], s21 offen sc1
 s_waitcnt vmcnt(0)
 s_memtime s[100:101]
 s_waitcnt lgkmcnt(0)
 s_sub_u32 s21, s100, s98
 s_min_u32 s41, s41, s21
 s_add_u32 s42, s42, 16640
 s_add_u32 s43, s43, 1
 s_cmp_lt_u32 s43, 4
 s_cbranch_scc1 cal_184
 s_cmp_lt_u32 s41, s40
 s_cselect_b32 s21, 1, 2
 v_mov_b32 v4, s21
 v_mov_b32 v5, s40
 v_mov_b32 v6, s41
 v_mov_b32 v8, 84
 buffer_store_dwordx3 v[4:6], v8, s[32:35], 0 offen sc1
 s_waitcnt vmcnt(0)
 s_mov_b64 exec, -1
cal_183:
 s_barrier
 s_branch armed
not_cal:
armed:
 s_load_dwordx2 s[72:73], s[0:1], 104
 s_waitcnt lgkmcnt(0)
 s_add_u32 s72, s72, 81068032
 s_addc_u32 s73, s73, 0
 s_mov_b32 s74, 128000
 s_mov_b32 s75, 0x00020000
 s_load_dwordx2 s[4:5], s[0:1], 0
 s_load_dwordx2 s[6:7], s[0:1], 64
 s_load_dwordx2 s[38:39], s[0:1], 104
 s_mov_b32 s64, s32
 s_mov_b32 s65, s33
 s_mov_b32 s66, s34
 s_mov_b32 s67, s35
 s_lshr_b32 s41, s2, 1
 s_and_b32 s42, s2, 1
 s_waitcnt lgkmcnt(0)
 s_mov_b32 s8, s4
 s_mov_b32 s9, s5
 s_mov_b32 s10, 2621440
 s_mov_b32 s11, 0x00020000
 s_mov_b32 s12, s6
 s_mov_b32 s13, s7
 s_mov_b32 s14, 2457600
 s_mov_b32 s15, 0x00020000
 s_add_u32 s16, s38, 70713344
 s_addc_u32 s17, s39, 0
 s_mov_b32 s18, 2641920
 s_mov_b32 s19, 0x00020000
 s_add_u32 s72, s38, 81068032
 s_addc_u32 s73, s39, 0
 s_mov_b32 s74, 128000
 s_mov_b32 s75, 0x00020000
 s_lshl_b32 s21, s2, 2
 s_add_u32 s21, s21, s20
 s_mul_i32 s21, s21, 19200
 v_lshlrev_b32 v5, 4, v1
 buffer_load_dwordx4 v[64:67], v5, s[12:15], s21 offen offset:0
 buffer_load_dwordx4 v[64:67], v5, s[12:15], s21 offen offset:1024
 buffer_load_dwordx4 v[64:67], v5, s[12:15], s21 offen offset:2048
 buffer_load_dwordx4 v[64:67], v5, s[12:15], s21 offen offset:3072
 s_add_u32 s21, s21, 4096
 buffer_load_dwordx4 v[64:67], v5, s[12:15], s21 offen offset:0
 buffer_load_dwordx4 v[64:67], v5, s[12:15], s21 offen offset:1024
 buffer_load_dwordx4 v[64:67], v5, s[12:15], s21 offen offset:2048
 buffer_load_dwordx4 v[64:67], v5, s[12:15], s21 offen offset:3072
 s_add_u32 s21, s21, 4096
 buffer_load_dwordx4 v[64:67], v5, s[12:15], s21 offen offset:0
 buffer_load_dwordx4 v[64:67], v5, s[12:15], s21 offen offset:1024
 buffer_load_dwordx4 v[64:67], v5, s[12:15], s21 offen offset:2048
 buffer_load_dwordx4 v[64:67], v5, s[12:15], s21 offen offset:3072
 s_add_u32 s21, s21, 4096
 buffer_load_dwordx4 v[64:67], v5, s[12:15], s21 offen offset:0
 buffer_load_dwordx4 v[64:67], v5, s[12:15], s21 offen offset:1024
 buffer_load_dwordx4 v[64:67], v5, s[12:15], s21 offen offset:2048
 buffer_load_dwordx4 v[64:67], v5, s[12:15], s21 offen offset:3072
 s_add_u32 s21, s21, 4096
 buffer_load_dwordx4 v[64:67], v5, s[12:15], s21 offen offset:0
 buffer_load_dwordx4 v[64:67], v5, s[12:15], s21 offen offset:1024
 buffer_load_dwordx4 v[64:67], v5, s[12:15], s21 offen offset:2048
 s_waitcnt vmcnt(0)
 v_lshlrev_b32 v6, 1, v3
 v_add_u32 v6, 0, v6
 v_xor_b32 v6, v6, v2
 v_min_u32 v6, 14, v6
 v_mul_u32_u24 v7, 52, v6
 v_lshrrev_b32 v7, 8, v7
 v_mul_u32_u24 v7, 1200, v7
 v_lshl_add_u32 v7, v6, 4, v7
 v_mul_u32_u24 v6, 3840, v3
 v_add_u32 v4, v6, v7
 v_lshlrev_b32 v6, 1, v3
 v_add_u32 v6, 8, v6
 v_xor_b32 v6, v6, v2
 v_min_u32 v6, 14, v6
 v_mul_u32_u24 v7, 52, v6
 v_lshrrev_b32 v7, 8, v7
 v_mul_u32_u24 v7, 1200, v7
 v_lshl_add_u32 v7, v6, 4, v7
 v_mul_u32_u24 v6, 3840, v3
 v_add_u32 v5, v6, v7
 s_mul_i32 s21, s41, 80
 s_mul_i32 s22, s20, 15360
 s_add_u32 s21, s21, s22
 s_lshl_b32 s22, s20, 10
 s_cmp_ge_u32 s20, 2
 s_cselect_b64 vcc, -1, 0
 v_cndmask_b32 v4, v4, v5, vcc
 s_add_u32 m0, s22, 0
 s_nop 0
 buffer_load_dwordx4 v4, s[12:15], s21 offen lds
 s_add_u32 s21, s21, 61440
 s_add_u32 m0, s22, 4096
 s_nop 0
 buffer_load_dwordx4 v4, s[12:15], s21 offen lds
 s_add_u32 s21, s21, 61440
 s_add_u32 m0, s22, 8192
 s_nop 0
 buffer_load_dwordx4 v4, s[12:15], s21 offen lds
 s_add_u32 s21, s21, 61440
 s_add_u32 m0, s22, 12288
 s_nop 0
 buffer_load_dwordx4 v4, s[12:15], s21 offen lds
 s_add_u32 s21, s21, 61440
 s_add_u32 m0, s22, 16384
 s_nop 0
 buffer_load_dwordx4 v4, s[12:15], s21 offen lds
 s_add_u32 s21, s21, 61440
 s_add_u32 m0, s22, 20480
 s_nop 0
 buffer_load_dwordx4 v4, s[12:15], s21 offen lds
 s_add_u32 s21, s21, 61440
 s_add_u32 m0, s22, 24576
 s_nop 0
 buffer_load_dwordx4 v4, s[12:15], s21 offen lds
 s_add_u32 s21, s21, 61440
 s_add_u32 m0, s22, 28672
 s_nop 0
 buffer_load_dwordx4 v4, s[12:15], s21 offen lds
 s_add_u32 s21, s21, 61440
 s_add_u32 m0, s22, 32768
 s_nop 0
 buffer_load_dwordx4 v4, s[12:15], s21 offen lds
 s_add_u32 s21, s21, 61440
 s_add_u32 m0, s22, 36864
 s_nop 0
 buffer_load_dwordx4 v4, s[12:15], s21 offen lds
 s_add_u32 s21, s21, 61440
 s_add_u32 m0, s22, 40960
 s_nop 0
 buffer_load_dwordx4 v4, s[12:15], s21 offen lds
 s_add_u32 s21, s21, 61440
 s_add_u32 m0, s22, 45056
 s_nop 0
 buffer_load_dwordx4 v4, s[12:15], s21 offen lds
 s_add_u32 s21, s21, 61440
 s_add_u32 m0, s22, 49152
 s_nop 0
 buffer_load_dwordx4 v4, s[12:15], s21 offen lds
 s_add_u32 s21, s21, 61440
 s_add_u32 m0, s22, 53248
 s_nop 0
 buffer_load_dwordx4 v4, s[12:15], s21 offen lds
 s_add_u32 s21, s21, 61440
 s_add_u32 m0, s22, 57344
 s_nop 0
 buffer_load_dwordx4 v4, s[12:15], s21 offen lds
 s_add_u32 s21, s21, 61440
 s_add_u32 m0, s22, 61440
 s_nop 0
 buffer_load_dwordx4 v4, s[12:15], s21 offen lds
 s_add_u32 s21, s21, 61440
 s_add_u32 m0, s22, 65536
 s_nop 0
 buffer_load_dwordx4 v4, s[12:15], s21 offen lds
 s_add_u32 s21, s21, 61440
 s_add_u32 m0, s22, 69632
 s_nop 0
 buffer_load_dwordx4 v4, s[12:15], s21 offen lds
 s_add_u32 s21, s21, 61440
 s_add_u32 m0, s22, 73728
 s_nop 0
 buffer_load_dwordx4 v4, s[12:15], s21 offen lds
 s_add_u32 s21, s21, 61440
 s_add_u32 m0, s22, 77824
 s_nop 0
 buffer_load_dwordx4 v4, s[12:15], s21 offen lds
 s_add_u32 s21, s21, 61440
 s_add_u32 m0, s22, 81920
 s_nop 0
 buffer_load_dwordx4 v4, s[12:15], s21 offen lds
 s_add_u32 s21, s21, 61440
 s_add_u32 m0, s22, 86016
 s_nop 0
 buffer_load_dwordx4 v4, s[12:15], s21 offen lds
 s_add_u32 s21, s21, 61440
 s_add_u32 m0, s22, 90112
 s_nop 0
 buffer_load_dwordx4 v4, s[12:15], s21 offen lds
 s_add_u32 s21, s21, 61440
 s_add_u32 m0, s22, 94208
 s_nop 0
 buffer_load_dwordx4 v4, s[12:15], s21 offen lds
 s_add_u32 s21, s21, 61440
 s_add_u32 m0, s22, 98304
 s_nop 0
 buffer_load_dwordx4 v4, s[12:15], s21 offen lds
 s_add_u32 s21, s21, 61440
 s_add_u32 m0, s22, 102400
 s_nop 0
 buffer_load_dwordx4 v4, s[12:15], s21 offen lds
 s_add_u32 s21, s21, 61440
 s_add_u32 m0, s22, 106496
 s_nop 0
 buffer_load_dwordx4 v4, s[12:15], s21 offen lds
 s_add_u32 s21, s21, 61440
 s_add_u32 m0, s22, 110592
 s_nop 0
 buffer_load_dwordx4 v4, s[12:15], s21 offen lds
 s_add_u32 s21, s21, 61440
 s_add_u32 m0, s22, 114688
 s_nop 0
 buffer_load_dwordx4 v4, s[12:15], s21 offen lds
 s_add_u32 s21, s21, 61440
 s_add_u32 m0, s22, 118784
 s_nop 0
 buffer_load_dwordx4 v4, s[12:15], s21 offen lds
 s_add_u32 s21, s21, 61440
 s_add_u32 m0, s22, 122880
 s_nop 0
 buffer_load_dwordx4 v4, s[12:15], s21 offen lds
 s_add_u32 s21, s21, 61440
 s_add_u32 m0, s22, 126976
 s_nop 0
 buffer_load_dwordx4 v4, s[12:15], s21 offen lds
 s_add_u32 s21, s21, 61440
 s_add_u32 m0, s22, 131072
 s_nop 0
 buffer_load_dwordx4 v4, s[12:15], s21 offen lds
 s_add_u32 s21, s21, 61440
 s_add_u32 m0, s22, 135168
 s_nop 0
 buffer_load_dwordx4 v4, s[12:15], s21 offen lds
 s_add_u32 s21, s21, 61440
 s_add_u32 m0, s22, 139264
 s_nop 0
 buffer_load_dwordx4 v4, s[12:15], s21 offen lds
 s_add_u32 s21, s21, 61440
 s_add_u32 m0, s22, 143360
 s_nop 0
 buffer_load_dwordx4 v4, s[12:15], s21 offen lds
 s_add_u32 s21, s21, 61440
 s_add_u32 m0, s22, 147456
 s_nop 0
 buffer_load_dwordx4 v4, s[12:15], s21 offen lds
 s_add_u32 s21, s21, 61440
 s_add_u32 m0, s22, 151552
 s_nop 0
 buffer_load_dwordx4 v4, s[12:15], s21 offen lds
 s_add_u32 s21, s21, 61440
 s_add_u32 m0, s22, 155648
 s_nop 0
 buffer_load_dwordx4 v4, s[12:15], s21 offen lds
 s_add_u32 s21, s21, 61440
 s_add_u32 m0, s22, 159744
 s_nop 0
 buffer_load_dwordx4 v4, s[12:15], s21 offen lds
 s_add_u32 s21, s21, 61440
 s_lshl_b32 s21, s2, 2
 s_add_u32 s21, s21, s20
 s_mul_i32 s21, s21, 20480
 v_lshlrev_b32 v5, 4, v1
 buffer_load_dwordx4 v[64:67], v5, s[8:11], s21 offen offset:0
 buffer_load_dwordx4 v[64:67], v5, s[8:11], s21 offen offset:1024
 buffer_load_dwordx4 v[64:67], v5, s[8:11], s21 offen offset:2048
 buffer_load_dwordx4 v[64:67], v5, s[8:11], s21 offen offset:3072
 s_add_u32 s21, s21, 4096
 buffer_load_dwordx4 v[64:67], v5, s[8:11], s21 offen offset:0
 buffer_load_dwordx4 v[64:67], v5, s[8:11], s21 offen offset:1024
 buffer_load_dwordx4 v[64:67], v5, s[8:11], s21 offen offset:2048
 buffer_load_dwordx4 v[64:67], v5, s[8:11], s21 offen offset:3072
 s_add_u32 s21, s21, 4096
 buffer_load_dwordx4 v[64:67], v5, s[8:11], s21 offen offset:0
 buffer_load_dwordx4 v[64:67], v5, s[8:11], s21 offen offset:1024
 buffer_load_dwordx4 v[64:67], v5, s[8:11], s21 offen offset:2048
 buffer_load_dwordx4 v[64:67], v5, s[8:11], s21 offen offset:3072
 s_add_u32 s21, s21, 4096
 buffer_load_dwordx4 v[64:67], v5, s[8:11], s21 offen offset:0
 buffer_load_dwordx4 v[64:67], v5, s[8:11], s21 offen offset:1024
 buffer_load_dwordx4 v[64:67], v5, s[8:11], s21 offen offset:2048
 buffer_load_dwordx4 v[64:67], v5, s[8:11], s21 offen offset:3072
 s_add_u32 s21, s21, 4096
 buffer_load_dwordx4 v[64:67], v5, s[8:11], s21 offen offset:0
 buffer_load_dwordx4 v[64:67], v5, s[8:11], s21 offen offset:1024
 buffer_load_dwordx4 v[64:67], v5, s[8:11], s21 offen offset:2048
 buffer_load_dwordx4 v[64:67], v5, s[8:11], s21 offen offset:3072
 v_lshrrev_b32 v6, 2, v2
 v_lshl_add_u32 v7, v3, 3, v6
 v_and_b32 v8, 1, v3
 v_lshl_add_u32 v6, v8, 2, v6
 v_lshlrev_b32 v6, 1, v6
 v_bfe_u32 v8, v2, 1, 1
 s_lshl_b32 s21, s20, 2
 v_add_u32 v8, s21, v8
 v_and_b32 v9, 1, v2
 v_lshlrev_b32 v9, 3, v9
 v_lshl_add_u32 v9, v7, 8, v9
 v_add_u32 v5, 0, v8
 v_xor_b32 v5, v5, v6
 v_lshl_add_u32 v44, v5, 4, v9
 v_add_u32 v45, 65536, v44
 v_add_u32 v46, 131072, v44
 v_add_u32 v5, 2, v8
 v_xor_b32 v5, v5, v6
 v_lshl_add_u32 v47, v5, 4, v9
 v_add_u32 v48, 65536, v47
 v_add_u32 v49, 131072, v47
 s_waitcnt vmcnt(50) lgkmcnt(0)
 s_barrier
 ds_read_b64_tr_b16 a[0:1], v44 offset:0
 ds_read_b64_tr_b16 a[2:3], v44 offset:1024
 ds_read_b64_tr_b16 a[4:5], v47 offset:0
 ds_read_b64_tr_b16 a[6:7], v47 offset:1024
 ds_read_b64_tr_b16 a[8:9], v44 offset:8192
 ds_read_b64_tr_b16 a[10:11], v44 offset:9216
 ds_read_b64_tr_b16 a[12:13], v47 offset:8192
 ds_read_b64_tr_b16 a[14:15], v47 offset:9216
 ds_read_b64_tr_b16 a[16:17], v44 offset:16384
 ds_read_b64_tr_b16 a[18:19], v44 offset:17408
 ds_read_b64_tr_b16 a[20:21], v47 offset:16384
 ds_read_b64_tr_b16 a[22:23], v47 offset:17408
 ds_read_b64_tr_b16 a[24:25], v44 offset:24576
 ds_read_b64_tr_b16 a[26:27], v44 offset:25600
 ds_read_b64_tr_b16 a[28:29], v47 offset:24576
 ds_read_b64_tr_b16 a[30:31], v47 offset:25600
 ds_read_b64_tr_b16 a[32:33], v44 offset:32768
 ds_read_b64_tr_b16 a[34:35], v44 offset:33792
 ds_read_b64_tr_b16 a[36:37], v47 offset:32768
 ds_read_b64_tr_b16 a[38:39], v47 offset:33792
 s_waitcnt vmcnt(40) lgkmcnt(0)
 s_barrier
 ds_read_b64_tr_b16 a[40:41], v44 offset:40960
 ds_read_b64_tr_b16 a[42:43], v44 offset:41984
 ds_read_b64_tr_b16 a[44:45], v47 offset:40960
 ds_read_b64_tr_b16 a[46:47], v47 offset:41984
 ds_read_b64_tr_b16 a[48:49], v44 offset:49152
 ds_read_b64_tr_b16 a[50:51], v44 offset:50176
 ds_read_b64_tr_b16 a[52:53], v47 offset:49152
 ds_read_b64_tr_b16 a[54:55], v47 offset:50176
 ds_read_b64_tr_b16 a[56:57], v44 offset:57344
 ds_read_b64_tr_b16 a[58:59], v44 offset:58368
 ds_read_b64_tr_b16 a[60:61], v47 offset:57344
 ds_read_b64_tr_b16 a[62:63], v47 offset:58368
 ds_read_b64_tr_b16 a[64:65], v45 offset:0
 ds_read_b64_tr_b16 a[66:67], v45 offset:1024
 ds_read_b64_tr_b16 a[68:69], v48 offset:0
 ds_read_b64_tr_b16 a[70:71], v48 offset:1024
 ds_read_b64_tr_b16 a[72:73], v45 offset:8192
 ds_read_b64_tr_b16 a[74:75], v45 offset:9216
 ds_read_b64_tr_b16 a[76:77], v48 offset:8192
 ds_read_b64_tr_b16 a[78:79], v48 offset:9216
 s_waitcnt vmcnt(30) lgkmcnt(0)
 s_barrier
 s_mul_i32 s24, s42, 1280
 v_lshrrev_b32 v11, 3, v1
 v_and_b32 v12, 7, v1
 v_xor_b32 v12, v12, v11
 v_mul_u32_u24 v11, 2560, v11
 v_lshl_add_u32 v10, v12, 4, v11
 s_mul_i32 s46, s20, 81920
 v_add_u32 v10, s46, v10
 s_lshl_b32 s47, s20, 12
 s_add_u32 s47, s47, 0
 s_add_u32 s46, s47, 114688
 s_mov_b32 s30, s24
 s_add_u32 s32, s47, 0
 v_add_u32 v11, 19456, v10
 v_add_u32 v12, 38912, v10
 v_add_u32 v13, 58368, v10
 s_mov_b32 m0, s32
 s_nop 0
 buffer_load_dwordx4 v10, s[8:11], s30 offen offset:0 lds
 buffer_load_dwordx4 v11, s[8:11], s30 offen offset:1024 lds
 buffer_load_dwordx4 v12, s[8:11], s30 offen offset:2048 lds
 buffer_load_dwordx4 v13, s[8:11], s30 offen offset:3072 lds
 s_add_u32 s30, s30, 128
 s_add_u32 s32, s32, 16384
 s_cmp_lt_u32 s32, s46
 s_cselect_b32 s32, s32, s47
 s_mov_b32 m0, s32
 s_nop 0
 buffer_load_dwordx4 v10, s[8:11], s30 offen offset:0 lds
 buffer_load_dwordx4 v11, s[8:11], s30 offen offset:1024 lds
 buffer_load_dwordx4 v12, s[8:11], s30 offen offset:2048 lds
 buffer_load_dwordx4 v13, s[8:11], s30 offen offset:3072 lds
 s_add_u32 s30, s30, 128
 s_add_u32 s32, s32, 16384
 s_cmp_lt_u32 s32, s46
 s_cselect_b32 s32, s32, s47
 s_mov_b32 m0, s32
 s_nop 0
 buffer_load_dwordx4 v10, s[8:11], s30 offen offset:0 lds
 buffer_load_dwordx4 v11, s[8:11], s30 offen offset:1024 lds
 buffer_load_dwordx4 v12, s[8:11], s30 offen offset:2048 lds
 buffer_load_dwordx4 v13, s[8:11], s30 offen offset:3072 lds
 s_add_u32 s30, s30, 128
 s_add_u32 s32, s32, 16384
 s_cmp_lt_u32 s32, s46
 s_cselect_b32 s32, s32, s47
 s_mov_b32 m0, s32
 s_nop 0
 buffer_load_dwordx4 v10, s[8:11], s30 offen offset:0 lds
 buffer_load_dwordx4 v11, s[8:11], s30 offen offset:1024 lds
 buffer_load_dwordx4 v12, s[8:11], s30 offen offset:2048 lds
 buffer_load_dwordx4 v13, s[8:11], s30 offen offset:3072 lds
 s_add_u32 s30, s30, 128
 s_add_u32 s32, s32, 16384
 s_cmp_lt_u32 s32, s46
 s_cselect_b32 s32, s32, s47
 s_mov_b32 m0, s32
 s_nop 0
 buffer_load_dwordx4 v10, s[8:11], s30 offen offset:0 lds
 buffer_load_dwordx4 v11, s[8:11], s30 offen offset:1024 lds
 buffer_load_dwordx4 v12, s[8:11], s30 offen offset:2048 lds
 buffer_load_dwordx4 v13, s[8:11], s30 offen offset:3072 lds
 s_add_u32 s30, s30, 128
 s_add_u32 s32, s32, 16384
 s_cmp_lt_u32 s32, s46
 s_cselect_b32 s32, s32, s47
 ds_read_b64_tr_b16 a[80:81], v45 offset:16384
 ds_read_b64_tr_b16 a[82:83], v45 offset:17408
 ds_read_b64_tr_b16 a[84:85], v48 offset:16384
 ds_read_b64_tr_b16 a[86:87], v48 offset:17408
 ds_read_b64_tr_b16 a[88:89], v45 offset:24576
 ds_read_b64_tr_b16 a[90:91], v45 offset:25600
 ds_read_b64_tr_b16 a[92:93], v48 offset:24576
 ds_read_b64_tr_b16 a[94:95], v48 offset:25600
 ds_read_b64_tr_b16 a[96:97], v45 offset:32768
 ds_read_b64_tr_b16 a[98:99], v45 offset:33792
 ds_read_b64_tr_b16 a[100:101], v48 offset:32768
 ds_read_b64_tr_b16 a[102:103], v48 offset:33792
 ds_read_b64_tr_b16 a[104:105], v45 offset:40960
 ds_read_b64_tr_b16 a[106:107], v45 offset:41984
 ds_read_b64_tr_b16 a[108:109], v48 offset:40960
 ds_read_b64_tr_b16 a[110:111], v48 offset:41984
 ds_read_b64_tr_b16 a[112:113], v45 offset:49152
 ds_read_b64_tr_b16 a[114:115], v45 offset:50176
 ds_read_b64_tr_b16 a[116:117], v48 offset:49152
 ds_read_b64_tr_b16 a[118:119], v48 offset:50176
 s_waitcnt vmcnt(40) lgkmcnt(0)
 s_barrier
 ds_read_b64_tr_b16 a[120:121], v45 offset:57344
 ds_read_b64_tr_b16 a[122:123], v45 offset:58368
 ds_read_b64_tr_b16 a[124:125], v48 offset:57344
 ds_read_b64_tr_b16 a[126:127], v48 offset:58368
 ds_read_b64_tr_b16 a[128:129], v46 offset:0
 ds_read_b64_tr_b16 a[130:131], v46 offset:1024
 ds_read_b64_tr_b16 a[132:133], v49 offset:0
 ds_read_b64_tr_b16 a[134:135], v49 offset:1024
 ds_read_b64_tr_b16 a[136:137], v46 offset:8192
 ds_read_b64_tr_b16 a[138:139], v46 offset:9216
 ds_read_b64_tr_b16 a[140:141], v49 offset:8192
 ds_read_b64_tr_b16 a[142:143], v49 offset:9216
 ds_read_b64_tr_b16 a[144:145], v46 offset:16384
 ds_read_b64_tr_b16 a[146:147], v46 offset:17408
 ds_read_b64_tr_b16 a[148:149], v49 offset:16384
 ds_read_b64_tr_b16 a[150:151], v49 offset:17408
 ds_read_b64_tr_b16 a[152:153], v46 offset:24576
 ds_read_b64_tr_b16 a[154:155], v46 offset:25600
 ds_read_b64_tr_b16 a[156:157], v49 offset:24576
 ds_read_b64_tr_b16 a[158:159], v49 offset:25600
 s_waitcnt lgkmcnt(0)
 s_barrier
 s_load_dwordx2 s[12:13], s[0:1], 72
 s_lshl_b32 s21, s2, 2
 s_add_u32 s21, s21, s20
 s_mul_i32 s50, s21, 6400
 s_add_u32 s51, s50, 4096
 v_lshlrev_b32 v33, 4, v1
 s_mov_b32 s14, 819200
 v_mov_b32 v32, 76
 s_waitcnt lgkmcnt(0)
 v_and_b32 v4, 31, v1
 s_lshl_b32 s21, s20, 5
 v_add_u32 v36, s21, v4
 v_lshrrev_b32 v5, 5, v1
 v_mul_u32_u24 v6, 264, v36
 v_mul_u32_u24 v7, 40, v5
 s_mov_b32 s21, 114952
 v_add3_u32 v34, v6, v7, s21
 v_lshl_add_u32 v38, v5, 3, v34
 v_lshlrev_b32 v6, 5, v5
 v_sub_u32 v39, v34, v6
 v_lshlrev_b32 v35, 3, v1
 v_add_u32 v35, 114688, v35
 v_mov_b32 v37, 0xf149f2ca
 s_mul_i32 s21, s41, 165120
 s_mul_i32 s22, s42, 16512
 s_add_u32 s21, s21, s22
 v_lshl_add_u32 v7, v36, 4, s21
 v_mul_u32_u24 v6, 99072, v5
 v_add_u32 v29, v6, v7
 v_add_u32 v30, 33024, v29
 v_lshl_add_u32 v31, v5, 3, v7
 v_add_u32 v31, 66048, v31
 v_mov_b32 v8, 0
 v_mov_b32 v9, 0
 ds_write_b64 v35, v[8:9] offset:0
 ds_write_b64 v35, v[8:9] offset:512
 ds_write_b64 v35, v[8:9] offset:1024
 ds_write_b64 v35, v[8:9] offset:1536
 ds_write_b64 v35, v[8:9] offset:2048
 s_mul_i32 s24, s42, 1280
 s_mov_b32 s25, 327680
 s_mov_b32 s26, 8
 s_mov_b32 s27, 0
 s_mov_b32 s60, 0x3e64f92e
 s_mov_b32 s61, 0x3fb8aa3b
 s_mov_b32 s62, 0x05040100
 s_mov_b32 s63, 0x07060302
 v_cmp_le_u32 s[76:77], 0, v36
 v_cmp_le_u32 s[78:79], 1, v36
 v_cmp_le_u32 s[80:81], 2, v36
 v_cmp_le_u32 s[82:83], 3, v36
 v_cmp_le_u32 s[84:85], 4, v36
 v_cmp_le_u32 s[86:87], 5, v36
 v_cmp_le_u32 s[88:89], 6, v36
 v_cmp_le_u32 s[90:91], 7, v36
 v_and_b32 v6, 7, v2
 v_add_u32 v4, 0, v3
 v_xor_b32 v4, v4, v6
 v_lshlrev_b32 v4, 4, v4
 v_lshl_add_u32 v14, v2, 7, v4
 v_add_u32 v4, 4, v3
 v_xor_b32 v4, v4, v6
 v_lshlrev_b32 v4, 4, v4
 v_lshl_add_u32 v15, v2, 7, v4
 v_mul_u32_u24 v22, 264, v2
 v_mul_u32_u24 v4, 8, v3
 s_mul_i32 s21, s20, 64
 s_add_u32 s21, s21, 116800
 v_add3_u32 v22, v22, v4, s21
 v_lshlrev_b32 v4, 3, v3
 v_sub_u32 v16, v22, v4
 v_mov_b32 v9, 2731
 s_mov_b32 s33, 0
 s_mov_b32 s48, 0x80000000
 s_mov_b32 m0, s32
 s_nop 0
 buffer_load_dwordx4 v10, s[8:11], s30 offen offset:0 lds
 buffer_load_dwordx4 v11, s[8:11], s30 offen offset:1024 lds
 s_waitcnt vmcnt(18)
 s_barrier
 v_add_u32 v18, s33, v14
 v_add_u32 v19, s33, v15
 s_add_u32 s33, s33, 16384
 s_cmp_lt_u32 s33, 114688
 s_cselect_b32 s33, s33, 0
 ds_read_b128 v[160:163], v18 offset:0
 ds_read_b128 v[164:167], v18 offset:2048
 ds_read_b128 v[168:171], v18 offset:4096
 ds_read_b128 v[172:175], v18 offset:6144
 ds_read_b128 v[176:179], v18 offset:8192
 ds_read_b128 v[180:183], v18 offset:10240
 ds_read_b128 v[184:187], v18 offset:12288
 ds_read_b128 v[188:191], v18 offset:14336
 s_waitcnt lgkmcnt(0)
bf_blk_185:
 v_mfma_f32_16x16x32_bf16 v[64:67], a[0:3], v[160:163], 0
 ds_read_b128 v[192:195], v19 offset:0
 v_mfma_f32_16x16x32_bf16 v[68:71], a[4:7], v[160:163], 0
 v_add_u32 v18, s33, v14
 v_mfma_f32_16x16x32_bf16 v[72:75], a[0:3], v[164:167], 0
 ds_read_b128 v[196:199], v19 offset:2048
 v_mfma_f32_16x16x32_bf16 v[76:79], a[4:7], v[164:167], 0
 buffer_load_dwordx4 v12, s[8:11], s30 offen offset:2048 lds
 v_mfma_f32_16x16x32_bf16 v[80:83], a[0:3], v[168:171], 0
 ds_read_b128 v[200:203], v19 offset:4096
 v_mfma_f32_16x16x32_bf16 v[84:87], a[4:7], v[168:171], 0
 v_mfma_f32_16x16x32_bf16 v[88:91], a[0:3], v[172:175], 0
 ds_read_b128 v[204:207], v19 offset:6144
 v_mfma_f32_16x16x32_bf16 v[92:95], a[4:7], v[172:175], 0
 s_waitcnt lgkmcnt(14)
 v_mfma_f32_16x16x32_bf16 v[96:99], a[0:3], v[176:179], 0
 ds_read_b128 v[208:211], v19 offset:8192
 v_mfma_f32_16x16x32_bf16 v[100:103], a[4:7], v[176:179], 0
 v_mfma_f32_16x16x32_bf16 v[104:107], a[0:3], v[180:183], 0
 ds_read_b128 v[212:215], v19 offset:10240
 v_mfma_f32_16x16x32_bf16 v[108:111], a[4:7], v[180:183], 0
 buffer_load_dwordx4 v13, s[8:11], s30 offen offset:3072 lds
 v_mfma_f32_16x16x32_bf16 v[112:115], a[0:3], v[184:187], 0
 ds_read_b128 v[216:219], v19 offset:12288
 s_add_u32 s30, s30, 128
 v_mfma_f32_16x16x32_bf16 v[116:119], a[4:7], v[184:187], 0
 s_add_u32 m0, m0, 16384
 v_mfma_f32_16x16x32_bf16 v[120:123], a[0:3], v[188:191], 0
 ds_read_b128 v[220:223], v19 offset:14336
 v_mfma_f32_16x16x32_bf16 v[124:127], a[4:7], v[188:191], 0
 s_waitcnt vmcnt(16) lgkmcnt(4)
 s_barrier
 v_mfma_f32_16x16x32_bf16 v[64:67], a[8:11], v[192:195], v[64:67]
 ds_read_b128 v[160:163], v18 offset:0
 v_mfma_f32_16x16x32_bf16 v[68:71], a[12:15], v[192:195], v[68:71]
 s_cmp_lt_u32 m0, s46
 s_cselect_b32 m0, m0, s47
 v_mfma_f32_16x16x32_bf16 v[72:75], a[8:11], v[196:199], v[72:75]
 ds_read_b128 v[164:167], v18 offset:2048
 v_add_u32 v19, s33, v15
 v_mfma_f32_16x16x32_bf16 v[76:79], a[12:15], v[196:199], v[76:79]
 buffer_load_dwordx4 v10, s[8:11], s30 offen offset:0 lds
 v_mfma_f32_16x16x32_bf16 v[80:83], a[8:11], v[200:203], v[80:83]
 ds_read_b128 v[168:171], v18 offset:4096
 s_add_u32 s33, s33, 16384
 v_mfma_f32_16x16x32_bf16 v[84:87], a[12:15], v[200:203], v[84:87]
 s_cmp_lt_u32 s33, 114688
 s_cselect_b32 s33, s33, 0
 v_mfma_f32_16x16x32_bf16 v[88:91], a[8:11], v[204:207], v[88:91]
 ds_read_b128 v[172:175], v18 offset:6144
 v_mfma_f32_16x16x32_bf16 v[92:95], a[12:15], v[204:207], v[92:95]
 s_waitcnt lgkmcnt(4)
 v_mfma_f32_16x16x32_bf16 v[96:99], a[8:11], v[208:211], v[96:99]
 ds_read_b128 v[176:179], v18 offset:8192
 v_mfma_f32_16x16x32_bf16 v[100:103], a[12:15], v[208:211], v[100:103]
 v_mfma_f32_16x16x32_bf16 v[104:107], a[8:11], v[212:215], v[104:107]
 ds_read_b128 v[180:183], v18 offset:10240
 v_mfma_f32_16x16x32_bf16 v[108:111], a[12:15], v[212:215], v[108:111]
 buffer_load_dwordx4 v11, s[8:11], s30 offen offset:1024 lds
 v_mfma_f32_16x16x32_bf16 v[112:115], a[8:11], v[216:219], v[112:115]
 ds_read_b128 v[184:187], v18 offset:12288
 v_mfma_f32_16x16x32_bf16 v[116:119], a[12:15], v[216:219], v[116:119]
 v_mfma_f32_16x16x32_bf16 v[120:123], a[8:11], v[220:223], v[120:123]
 ds_read_b128 v[188:191], v18 offset:14336
 v_mfma_f32_16x16x32_bf16 v[124:127], a[12:15], v[220:223], v[124:127]
 s_waitcnt lgkmcnt(4)
 v_mfma_f32_16x16x32_bf16 v[64:67], a[16:19], v[160:163], v[64:67]
 ds_read_b128 v[192:195], v19 offset:0
 v_mfma_f32_16x16x32_bf16 v[68:71], a[20:23], v[160:163], v[68:71]
 v_add_u32 v18, s33, v14
 v_mfma_f32_16x16x32_bf16 v[72:75], a[16:19], v[164:167], v[72:75]
 ds_read_b128 v[196:199], v19 offset:2048
 v_mfma_f32_16x16x32_bf16 v[76:79], a[20:23], v[164:167], v[76:79]
 buffer_load_dwordx4 v12, s[8:11], s30 offen offset:2048 lds
 v_mfma_f32_16x16x32_bf16 v[80:83], a[16:19], v[168:171], v[80:83]
 ds_read_b128 v[200:203], v19 offset:4096
 v_mfma_f32_16x16x32_bf16 v[84:87], a[20:23], v[168:171], v[84:87]
 v_mfma_f32_16x16x32_bf16 v[88:91], a[16:19], v[172:175], v[88:91]
 ds_read_b128 v[204:207], v19 offset:6144
 v_mfma_f32_16x16x32_bf16 v[92:95], a[20:23], v[172:175], v[92:95]
 s_waitcnt lgkmcnt(4)
 v_mfma_f32_16x16x32_bf16 v[96:99], a[16:19], v[176:179], v[96:99]
 ds_read_b128 v[208:211], v19 offset:8192
 v_mfma_f32_16x16x32_bf16 v[100:103], a[20:23], v[176:179], v[100:103]
 v_mfma_f32_16x16x32_bf16 v[104:107], a[16:19], v[180:183], v[104:107]
 ds_read_b128 v[212:215], v19 offset:10240
 v_mfma_f32_16x16x32_bf16 v[108:111], a[20:23], v[180:183], v[108:111]
 buffer_load_dwordx4 v13, s[8:11], s30 offen offset:3072 lds
 v_mfma_f32_16x16x32_bf16 v[112:115], a[16:19], v[184:187], v[112:115]
 ds_read_b128 v[216:219], v19 offset:12288
 s_add_u32 s30, s30, 128
 v_mfma_f32_16x16x32_bf16 v[116:119], a[20:23], v[184:187], v[116:119]
 s_add_u32 m0, m0, 16384
 v_mfma_f32_16x16x32_bf16 v[120:123], a[16:19], v[188:191], v[120:123]
 ds_read_b128 v[220:223], v19 offset:14336
 v_mfma_f32_16x16x32_bf16 v[124:127], a[20:23], v[188:191], v[124:127]
 s_waitcnt vmcnt(16) lgkmcnt(4)
 s_barrier
 v_mfma_f32_16x16x32_bf16 v[64:67], a[24:27], v[192:195], v[64:67]
 ds_read_b128 v[160:163], v18 offset:0
 v_mfma_f32_16x16x32_bf16 v[68:71], a[28:31], v[192:195], v[68:71]
 s_cmp_lt_u32 m0, s46
 s_cselect_b32 m0, m0, s47
 v_mfma_f32_16x16x32_bf16 v[72:75], a[24:27], v[196:199], v[72:75]
 ds_read_b128 v[164:167], v18 offset:2048
 v_add_u32 v19, s33, v15
 v_mfma_f32_16x16x32_bf16 v[76:79], a[28:31], v[196:199], v[76:79]
 buffer_load_dwordx4 v10, s[8:11], s30 offen offset:0 lds
 v_mfma_f32_16x16x32_bf16 v[80:83], a[24:27], v[200:203], v[80:83]
 ds_read_b128 v[168:171], v18 offset:4096
 s_add_u32 s33, s33, 16384
 v_mfma_f32_16x16x32_bf16 v[84:87], a[28:31], v[200:203], v[84:87]
 s_cmp_lt_u32 s33, 114688
 s_cselect_b32 s33, s33, 0
 v_mfma_f32_16x16x32_bf16 v[88:91], a[24:27], v[204:207], v[88:91]
 ds_read_b128 v[172:175], v18 offset:6144
 v_mfma_f32_16x16x32_bf16 v[92:95], a[28:31], v[204:207], v[92:95]
 s_waitcnt lgkmcnt(4)
 v_mfma_f32_16x16x32_bf16 v[96:99], a[24:27], v[208:211], v[96:99]
 ds_read_b128 v[176:179], v18 offset:8192
 v_mfma_f32_16x16x32_bf16 v[100:103], a[28:31], v[208:211], v[100:103]
 v_mfma_f32_16x16x32_bf16 v[104:107], a[24:27], v[212:215], v[104:107]
 ds_read_b128 v[180:183], v18 offset:10240
 v_mfma_f32_16x16x32_bf16 v[108:111], a[28:31], v[212:215], v[108:111]
 buffer_load_dwordx4 v11, s[8:11], s30 offen offset:1024 lds
 v_mfma_f32_16x16x32_bf16 v[112:115], a[24:27], v[216:219], v[112:115]
 ds_read_b128 v[184:187], v18 offset:12288
 v_mfma_f32_16x16x32_bf16 v[116:119], a[28:31], v[216:219], v[116:119]
 v_mfma_f32_16x16x32_bf16 v[120:123], a[24:27], v[220:223], v[120:123]
 ds_read_b128 v[188:191], v18 offset:14336
 v_mfma_f32_16x16x32_bf16 v[124:127], a[28:31], v[220:223], v[124:127]
 s_waitcnt lgkmcnt(4)
 v_mfma_f32_16x16x32_bf16 v[64:67], a[32:35], v[160:163], v[64:67]
 ds_read_b128 v[192:195], v19 offset:0
 v_mfma_f32_16x16x32_bf16 v[68:71], a[36:39], v[160:163], v[68:71]
 v_add_u32 v18, s33, v14
 v_mfma_f32_16x16x32_bf16 v[72:75], a[32:35], v[164:167], v[72:75]
 ds_read_b128 v[196:199], v19 offset:2048
 v_mfma_f32_16x16x32_bf16 v[76:79], a[36:39], v[164:167], v[76:79]
 buffer_load_dwordx4 v12, s[8:11], s30 offen offset:2048 lds
 v_mfma_f32_16x16x32_bf16 v[80:83], a[32:35], v[168:171], v[80:83]
 ds_read_b128 v[200:203], v19 offset:4096
 v_mfma_f32_16x16x32_bf16 v[84:87], a[36:39], v[168:171], v[84:87]
 v_mfma_f32_16x16x32_bf16 v[88:91], a[32:35], v[172:175], v[88:91]
 ds_read_b128 v[204:207], v19 offset:6144
 v_mfma_f32_16x16x32_bf16 v[92:95], a[36:39], v[172:175], v[92:95]
 s_waitcnt lgkmcnt(4)
 v_mfma_f32_16x16x32_bf16 v[96:99], a[32:35], v[176:179], v[96:99]
 ds_read_b128 v[208:211], v19 offset:8192
 v_mfma_f32_16x16x32_bf16 v[100:103], a[36:39], v[176:179], v[100:103]
 v_mfma_f32_16x16x32_bf16 v[104:107], a[32:35], v[180:183], v[104:107]
 ds_read_b128 v[212:215], v19 offset:10240
 v_mfma_f32_16x16x32_bf16 v[108:111], a[36:39], v[180:183], v[108:111]
 buffer_load_dwordx4 v13, s[8:11], s30 offen offset:3072 lds
 v_mfma_f32_16x16x32_bf16 v[112:115], a[32:35], v[184:187], v[112:115]
 ds_read_b128 v[216:219], v19 offset:12288
 s_add_u32 s30, s30, 128
 v_mfma_f32_16x16x32_bf16 v[116:119], a[36:39], v[184:187], v[116:119]
 s_add_u32 m0, m0, 16384
 v_mfma_f32_16x16x32_bf16 v[120:123], a[32:35], v[188:191], v[120:123]
 ds_read_b128 v[220:223], v19 offset:14336
 v_mfma_f32_16x16x32_bf16 v[124:127], a[36:39], v[188:191], v[124:127]
 s_waitcnt vmcnt(16) lgkmcnt(4)
 s_barrier
 v_mfma_f32_16x16x32_bf16 v[64:67], a[40:43], v[192:195], v[64:67]
 ds_read_b128 v[160:163], v18 offset:0
 v_mfma_f32_16x16x32_bf16 v[68:71], a[44:47], v[192:195], v[68:71]
 s_cmp_lt_u32 m0, s46
 s_cselect_b32 m0, m0, s47
 v_mfma_f32_16x16x32_bf16 v[72:75], a[40:43], v[196:199], v[72:75]
 ds_read_b128 v[164:167], v18 offset:2048
 v_add_u32 v19, s33, v15
 v_mfma_f32_16x16x32_bf16 v[76:79], a[44:47], v[196:199], v[76:79]
 buffer_load_dwordx4 v10, s[8:11], s30 offen offset:0 lds
 v_mfma_f32_16x16x32_bf16 v[80:83], a[40:43], v[200:203], v[80:83]
 ds_read_b128 v[168:171], v18 offset:4096
 s_add_u32 s33, s33, 16384
 v_mfma_f32_16x16x32_bf16 v[84:87], a[44:47], v[200:203], v[84:87]
 s_cmp_lt_u32 s33, 114688
 s_cselect_b32 s33, s33, 0
 v_mfma_f32_16x16x32_bf16 v[88:91], a[40:43], v[204:207], v[88:91]
 ds_read_b128 v[172:175], v18 offset:6144
 v_mfma_f32_16x16x32_bf16 v[92:95], a[44:47], v[204:207], v[92:95]
 s_waitcnt lgkmcnt(4)
 v_mfma_f32_16x16x32_bf16 v[96:99], a[40:43], v[208:211], v[96:99]
 ds_read_b128 v[176:179], v18 offset:8192
 v_mfma_f32_16x16x32_bf16 v[100:103], a[44:47], v[208:211], v[100:103]
 v_mfma_f32_16x16x32_bf16 v[104:107], a[40:43], v[212:215], v[104:107]
 ds_read_b128 v[180:183], v18 offset:10240
 v_mfma_f32_16x16x32_bf16 v[108:111], a[44:47], v[212:215], v[108:111]
 buffer_load_dwordx4 v11, s[8:11], s30 offen offset:1024 lds
 v_mfma_f32_16x16x32_bf16 v[112:115], a[40:43], v[216:219], v[112:115]
 ds_read_b128 v[184:187], v18 offset:12288
 v_mfma_f32_16x16x32_bf16 v[116:119], a[44:47], v[216:219], v[116:119]
 v_mfma_f32_16x16x32_bf16 v[120:123], a[40:43], v[220:223], v[120:123]
 ds_read_b128 v[188:191], v18 offset:14336
 v_mfma_f32_16x16x32_bf16 v[124:127], a[44:47], v[220:223], v[124:127]
 s_waitcnt lgkmcnt(4)
 v_mfma_f32_16x16x32_bf16 v[64:67], a[48:51], v[160:163], v[64:67]
 ds_read_b128 v[192:195], v19 offset:0
 v_mfma_f32_16x16x32_bf16 v[68:71], a[52:55], v[160:163], v[68:71]
 v_add_u32 v18, s33, v14
 v_mfma_f32_16x16x32_bf16 v[72:75], a[48:51], v[164:167], v[72:75]
 ds_read_b128 v[196:199], v19 offset:2048
 v_mfma_f32_16x16x32_bf16 v[76:79], a[52:55], v[164:167], v[76:79]
 buffer_load_dwordx4 v12, s[8:11], s30 offen offset:2048 lds
 v_mfma_f32_16x16x32_bf16 v[80:83], a[48:51], v[168:171], v[80:83]
 ds_read_b128 v[200:203], v19 offset:4096
 v_mfma_f32_16x16x32_bf16 v[84:87], a[52:55], v[168:171], v[84:87]
 v_mfma_f32_16x16x32_bf16 v[88:91], a[48:51], v[172:175], v[88:91]
 ds_read_b128 v[204:207], v19 offset:6144
 v_mfma_f32_16x16x32_bf16 v[92:95], a[52:55], v[172:175], v[92:95]
 s_waitcnt lgkmcnt(4)
 v_mfma_f32_16x16x32_bf16 v[96:99], a[48:51], v[176:179], v[96:99]
 ds_read_b128 v[208:211], v19 offset:8192
 v_mfma_f32_16x16x32_bf16 v[100:103], a[52:55], v[176:179], v[100:103]
 v_mfma_f32_16x16x32_bf16 v[104:107], a[48:51], v[180:183], v[104:107]
 ds_read_b128 v[212:215], v19 offset:10240
 v_mfma_f32_16x16x32_bf16 v[108:111], a[52:55], v[180:183], v[108:111]
 buffer_load_dwordx4 v13, s[8:11], s30 offen offset:3072 lds
 v_mfma_f32_16x16x32_bf16 v[112:115], a[48:51], v[184:187], v[112:115]
 ds_read_b128 v[216:219], v19 offset:12288
 s_add_u32 s30, s30, 128
 v_mfma_f32_16x16x32_bf16 v[116:119], a[52:55], v[184:187], v[116:119]
 s_add_u32 m0, m0, 16384
 v_mfma_f32_16x16x32_bf16 v[120:123], a[48:51], v[188:191], v[120:123]
 ds_read_b128 v[220:223], v19 offset:14336
 v_mfma_f32_16x16x32_bf16 v[124:127], a[52:55], v[188:191], v[124:127]
 s_waitcnt vmcnt(16) lgkmcnt(4)
 s_barrier
 v_mfma_f32_16x16x32_bf16 v[64:67], a[56:59], v[192:195], v[64:67]
 ds_read_b128 v[160:163], v18 offset:0
 v_mfma_f32_16x16x32_bf16 v[68:71], a[60:63], v[192:195], v[68:71]
 s_cmp_lt_u32 m0, s46
 s_cselect_b32 m0, m0, s47
 v_mfma_f32_16x16x32_bf16 v[72:75], a[56:59], v[196:199], v[72:75]
 ds_read_b128 v[164:167], v18 offset:2048
 v_add_u32 v19, s33, v15
 v_mfma_f32_16x16x32_bf16 v[76:79], a[60:63], v[196:199], v[76:79]
 buffer_load_dwordx4 v10, s[8:11], s30 offen offset:0 lds
 v_mfma_f32_16x16x32_bf16 v[80:83], a[56:59], v[200:203], v[80:83]
 ds_read_b128 v[168:171], v18 offset:4096
 s_add_u32 s33, s33, 16384
 v_mfma_f32_16x16x32_bf16 v[84:87], a[60:63], v[200:203], v[84:87]
 s_cmp_lt_u32 s33, 114688
 s_cselect_b32 s33, s33, 0
 v_mfma_f32_16x16x32_bf16 v[88:91], a[56:59], v[204:207], v[88:91]
 ds_read_b128 v[172:175], v18 offset:6144
 v_mfma_f32_16x16x32_bf16 v[92:95], a[60:63], v[204:207], v[92:95]
 s_waitcnt lgkmcnt(4)
 v_mfma_f32_16x16x32_bf16 v[96:99], a[56:59], v[208:211], v[96:99]
 ds_read_b128 v[176:179], v18 offset:8192
 v_mfma_f32_16x16x32_bf16 v[100:103], a[60:63], v[208:211], v[100:103]
 v_mfma_f32_16x16x32_bf16 v[104:107], a[56:59], v[212:215], v[104:107]
 ds_read_b128 v[180:183], v18 offset:10240
 v_mfma_f32_16x16x32_bf16 v[108:111], a[60:63], v[212:215], v[108:111]
 buffer_load_dwordx4 v11, s[8:11], s30 offen offset:1024 lds
 v_mfma_f32_16x16x32_bf16 v[112:115], a[56:59], v[216:219], v[112:115]
 ds_read_b128 v[184:187], v18 offset:12288
 v_mfma_f32_16x16x32_bf16 v[116:119], a[60:63], v[216:219], v[116:119]
 v_mfma_f32_16x16x32_bf16 v[120:123], a[56:59], v[220:223], v[120:123]
 ds_read_b128 v[188:191], v18 offset:14336
 v_mfma_f32_16x16x32_bf16 v[124:127], a[60:63], v[220:223], v[124:127]
 s_waitcnt lgkmcnt(4)
 v_mfma_f32_16x16x32_bf16 v[64:67], a[64:67], v[160:163], v[64:67]
 ds_read_b128 v[192:195], v19 offset:0
 v_mfma_f32_16x16x32_bf16 v[68:71], a[68:71], v[160:163], v[68:71]
 v_add_u32 v18, s33, v14
 v_mfma_f32_16x16x32_bf16 v[72:75], a[64:67], v[164:167], v[72:75]
 ds_read_b128 v[196:199], v19 offset:2048
 v_mfma_f32_16x16x32_bf16 v[76:79], a[68:71], v[164:167], v[76:79]
 buffer_load_dwordx4 v12, s[8:11], s30 offen offset:2048 lds
 v_mfma_f32_16x16x32_bf16 v[80:83], a[64:67], v[168:171], v[80:83]
 ds_read_b128 v[200:203], v19 offset:4096
 v_mfma_f32_16x16x32_bf16 v[84:87], a[68:71], v[168:171], v[84:87]
 v_mfma_f32_16x16x32_bf16 v[88:91], a[64:67], v[172:175], v[88:91]
 ds_read_b128 v[204:207], v19 offset:6144
 v_mfma_f32_16x16x32_bf16 v[92:95], a[68:71], v[172:175], v[92:95]
 s_waitcnt lgkmcnt(4)
 v_mfma_f32_16x16x32_bf16 v[96:99], a[64:67], v[176:179], v[96:99]
 ds_read_b128 v[208:211], v19 offset:8192
 v_mfma_f32_16x16x32_bf16 v[100:103], a[68:71], v[176:179], v[100:103]
 v_mfma_f32_16x16x32_bf16 v[104:107], a[64:67], v[180:183], v[104:107]
 ds_read_b128 v[212:215], v19 offset:10240
 v_mfma_f32_16x16x32_bf16 v[108:111], a[68:71], v[180:183], v[108:111]
 buffer_load_dwordx4 v13, s[8:11], s30 offen offset:3072 lds
 v_mfma_f32_16x16x32_bf16 v[112:115], a[64:67], v[184:187], v[112:115]
 ds_read_b128 v[216:219], v19 offset:12288
 s_add_u32 s30, s30, s25
 v_mfma_f32_16x16x32_bf16 v[116:119], a[68:71], v[184:187], v[116:119]
 s_sub_u32 s30, s30, 1152
 s_add_u32 m0, m0, 16384
 v_mfma_f32_16x16x32_bf16 v[120:123], a[64:67], v[188:191], v[120:123]
 ds_read_b128 v[220:223], v19 offset:14336
 v_mfma_f32_16x16x32_bf16 v[124:127], a[68:71], v[188:191], v[124:127]
 s_waitcnt vmcnt(16) lgkmcnt(4)
 s_barrier
 v_mfma_f32_16x16x32_bf16 v[64:67], a[72:75], v[192:195], v[64:67]
 ds_read_b128 v[160:163], v18 offset:0
 v_mfma_f32_16x16x32_bf16 v[68:71], a[76:79], v[192:195], v[68:71]
 s_cmp_lt_u32 m0, s46
 s_cselect_b32 m0, m0, s47
 v_mfma_f32_16x16x32_bf16 v[72:75], a[72:75], v[196:199], v[72:75]
 ds_read_b128 v[164:167], v18 offset:2048
 v_add_u32 v19, s33, v15
 v_mfma_f32_16x16x32_bf16 v[76:79], a[76:79], v[196:199], v[76:79]
 buffer_load_dwordx4 v10, s[8:11], s30 offen offset:0 lds
 v_mfma_f32_16x16x32_bf16 v[80:83], a[72:75], v[200:203], v[80:83]
 ds_read_b128 v[168:171], v18 offset:4096
 s_add_u32 s33, s33, 16384
 v_mfma_f32_16x16x32_bf16 v[84:87], a[76:79], v[200:203], v[84:87]
 s_cmp_lt_u32 s33, 114688
 s_cselect_b32 s33, s33, 0
 v_mfma_f32_16x16x32_bf16 v[88:91], a[72:75], v[204:207], v[88:91]
 ds_read_b128 v[172:175], v18 offset:6144
 v_mfma_f32_16x16x32_bf16 v[92:95], a[76:79], v[204:207], v[92:95]
 s_waitcnt lgkmcnt(4)
 v_mfma_f32_16x16x32_bf16 v[96:99], a[72:75], v[208:211], v[96:99]
 ds_read_b128 v[176:179], v18 offset:8192
 v_mfma_f32_16x16x32_bf16 v[100:103], a[76:79], v[208:211], v[100:103]
 v_mfma_f32_16x16x32_bf16 v[104:107], a[72:75], v[212:215], v[104:107]
 ds_read_b128 v[180:183], v18 offset:10240
 v_mfma_f32_16x16x32_bf16 v[108:111], a[76:79], v[212:215], v[108:111]
 buffer_load_dwordx4 v11, s[8:11], s30 offen offset:1024 lds
 v_mfma_f32_16x16x32_bf16 v[112:115], a[72:75], v[216:219], v[112:115]
 ds_read_b128 v[184:187], v18 offset:12288
 v_mfma_f32_16x16x32_bf16 v[116:119], a[76:79], v[216:219], v[116:119]
 v_mfma_f32_16x16x32_bf16 v[120:123], a[72:75], v[220:223], v[120:123]
 ds_read_b128 v[188:191], v18 offset:14336
 v_mfma_f32_16x16x32_bf16 v[124:127], a[76:79], v[220:223], v[124:127]
 s_waitcnt lgkmcnt(4)
 v_mfma_f32_16x16x32_bf16 v[64:67], a[80:83], v[160:163], v[64:67]
 ds_read_b128 v[192:195], v19 offset:0
 v_mfma_f32_16x16x32_bf16 v[68:71], a[84:87], v[160:163], v[68:71]
 v_add_u32 v18, s33, v14
 v_mfma_f32_16x16x32_bf16 v[72:75], a[80:83], v[164:167], v[72:75]
 ds_read_b128 v[196:199], v19 offset:2048
 v_mfma_f32_16x16x32_bf16 v[76:79], a[84:87], v[164:167], v[76:79]
 buffer_load_dwordx4 v12, s[8:11], s30 offen offset:2048 lds
 v_mfma_f32_16x16x32_bf16 v[80:83], a[80:83], v[168:171], v[80:83]
 ds_read_b128 v[200:203], v19 offset:4096
 v_mfma_f32_16x16x32_bf16 v[84:87], a[84:87], v[168:171], v[84:87]
 v_mfma_f32_16x16x32_bf16 v[88:91], a[80:83], v[172:175], v[88:91]
 ds_read_b128 v[204:207], v19 offset:6144
 v_mfma_f32_16x16x32_bf16 v[92:95], a[84:87], v[172:175], v[92:95]
 s_waitcnt lgkmcnt(4)
 v_mfma_f32_16x16x32_bf16 v[96:99], a[80:83], v[176:179], v[96:99]
 ds_read_b128 v[208:211], v19 offset:8192
 v_mfma_f32_16x16x32_bf16 v[100:103], a[84:87], v[176:179], v[100:103]
 v_mfma_f32_16x16x32_bf16 v[104:107], a[80:83], v[180:183], v[104:107]
 ds_read_b128 v[212:215], v19 offset:10240
 v_mfma_f32_16x16x32_bf16 v[108:111], a[84:87], v[180:183], v[108:111]
 buffer_load_dwordx4 v13, s[8:11], s30 offen offset:3072 lds
 v_mfma_f32_16x16x32_bf16 v[112:115], a[80:83], v[184:187], v[112:115]
 ds_read_b128 v[216:219], v19 offset:12288
 s_add_u32 s30, s30, 128
 v_mfma_f32_16x16x32_bf16 v[116:119], a[84:87], v[184:187], v[116:119]
 s_add_u32 m0, m0, 16384
 v_mfma_f32_16x16x32_bf16 v[120:123], a[80:83], v[188:191], v[120:123]
 ds_read_b128 v[220:223], v19 offset:14336
 v_mfma_f32_16x16x32_bf16 v[124:127], a[84:87], v[188:191], v[124:127]
 s_waitcnt vmcnt(16) lgkmcnt(4)
 s_barrier
 v_mfma_f32_16x16x32_bf16 v[64:67], a[88:91], v[192:195], v[64:67]
 ds_read_b128 v[160:163], v18 offset:0
 v_mfma_f32_16x16x32_bf16 v[68:71], a[92:95], v[192:195], v[68:71]
 s_cmp_lt_u32 m0, s46
 s_cselect_b32 m0, m0, s47
 v_mfma_f32_16x16x32_bf16 v[72:75], a[88:91], v[196:199], v[72:75]
 ds_read_b128 v[164:167], v18 offset:2048
 v_add_u32 v19, s33, v15
 v_mfma_f32_16x16x32_bf16 v[76:79], a[92:95], v[196:199], v[76:79]
 buffer_load_dwordx4 v10, s[8:11], s30 offen offset:0 lds
 v_mfma_f32_16x16x32_bf16 v[80:83], a[88:91], v[200:203], v[80:83]
 ds_read_b128 v[168:171], v18 offset:4096
 s_add_u32 s33, s33, 16384
 v_mfma_f32_16x16x32_bf16 v[84:87], a[92:95], v[200:203], v[84:87]
 s_cmp_lt_u32 s33, 114688
 s_cselect_b32 s33, s33, 0
 v_mfma_f32_16x16x32_bf16 v[88:91], a[88:91], v[204:207], v[88:91]
 ds_read_b128 v[172:175], v18 offset:6144
 v_mfma_f32_16x16x32_bf16 v[92:95], a[92:95], v[204:207], v[92:95]
 s_waitcnt lgkmcnt(4)
 v_mfma_f32_16x16x32_bf16 v[96:99], a[88:91], v[208:211], v[96:99]
 ds_read_b128 v[176:179], v18 offset:8192
 v_mfma_f32_16x16x32_bf16 v[100:103], a[92:95], v[208:211], v[100:103]
 v_mfma_f32_16x16x32_bf16 v[104:107], a[88:91], v[212:215], v[104:107]
 ds_read_b128 v[180:183], v18 offset:10240
 v_mfma_f32_16x16x32_bf16 v[108:111], a[92:95], v[212:215], v[108:111]
 buffer_load_dwordx4 v11, s[8:11], s30 offen offset:1024 lds
 v_mfma_f32_16x16x32_bf16 v[112:115], a[88:91], v[216:219], v[112:115]
 ds_read_b128 v[184:187], v18 offset:12288
 v_mfma_f32_16x16x32_bf16 v[116:119], a[92:95], v[216:219], v[116:119]
 v_mfma_f32_16x16x32_bf16 v[120:123], a[88:91], v[220:223], v[120:123]
 ds_read_b128 v[188:191], v18 offset:14336
 v_mfma_f32_16x16x32_bf16 v[124:127], a[92:95], v[220:223], v[124:127]
 s_waitcnt lgkmcnt(4)
 v_mfma_f32_16x16x32_bf16 v[64:67], a[96:99], v[160:163], v[64:67]
 ds_read_b128 v[192:195], v19 offset:0
 v_mfma_f32_16x16x32_bf16 v[68:71], a[100:103], v[160:163], v[68:71]
 v_add_u32 v18, s33, v14
 v_mfma_f32_16x16x32_bf16 v[72:75], a[96:99], v[164:167], v[72:75]
 ds_read_b128 v[196:199], v19 offset:2048
 v_mfma_f32_16x16x32_bf16 v[76:79], a[100:103], v[164:167], v[76:79]
 buffer_load_dwordx4 v12, s[8:11], s30 offen offset:2048 lds
 v_mfma_f32_16x16x32_bf16 v[80:83], a[96:99], v[168:171], v[80:83]
 ds_read_b128 v[200:203], v19 offset:4096
 v_mfma_f32_16x16x32_bf16 v[84:87], a[100:103], v[168:171], v[84:87]
 v_mfma_f32_16x16x32_bf16 v[88:91], a[96:99], v[172:175], v[88:91]
 ds_read_b128 v[204:207], v19 offset:6144
 v_mfma_f32_16x16x32_bf16 v[92:95], a[100:103], v[172:175], v[92:95]
 s_waitcnt lgkmcnt(4)
 v_mfma_f32_16x16x32_bf16 v[96:99], a[96:99], v[176:179], v[96:99]
 ds_read_b128 v[208:211], v19 offset:8192
 v_mfma_f32_16x16x32_bf16 v[100:103], a[100:103], v[176:179], v[100:103]
 v_mfma_f32_16x16x32_bf16 v[104:107], a[96:99], v[180:183], v[104:107]
 ds_read_b128 v[212:215], v19 offset:10240
 v_mfma_f32_16x16x32_bf16 v[108:111], a[100:103], v[180:183], v[108:111]
 buffer_load_dwordx4 v13, s[8:11], s30 offen offset:3072 lds
 v_mfma_f32_16x16x32_bf16 v[112:115], a[96:99], v[184:187], v[112:115]
 ds_read_b128 v[216:219], v19 offset:12288
 s_add_u32 s30, s30, 128
 v_mfma_f32_16x16x32_bf16 v[116:119], a[100:103], v[184:187], v[116:119]
 s_add_u32 m0, m0, 16384
 v_mfma_f32_16x16x32_bf16 v[120:123], a[96:99], v[188:191], v[120:123]
 ds_read_b128 v[220:223], v19 offset:14336
 v_mfma_f32_16x16x32_bf16 v[124:127], a[100:103], v[188:191], v[124:127]
 s_waitcnt vmcnt(16) lgkmcnt(4)
 s_barrier
 v_mfma_f32_16x16x32_bf16 v[64:67], a[104:107], v[192:195], v[64:67]
 ds_read_b128 v[160:163], v18 offset:0
 v_mfma_f32_16x16x32_bf16 v[68:71], a[108:111], v[192:195], v[68:71]
 s_cmp_lt_u32 m0, s46
 s_cselect_b32 m0, m0, s47
 v_mfma_f32_16x16x32_bf16 v[72:75], a[104:107], v[196:199], v[72:75]
 ds_read_b128 v[164:167], v18 offset:2048
 v_add_u32 v19, s33, v15
 v_mfma_f32_16x16x32_bf16 v[76:79], a[108:111], v[196:199], v[76:79]
 buffer_load_dwordx4 v10, s[8:11], s30 offen offset:0 lds
 v_mfma_f32_16x16x32_bf16 v[80:83], a[104:107], v[200:203], v[80:83]
 ds_read_b128 v[168:171], v18 offset:4096
 s_add_u32 s33, s33, 16384
 v_mfma_f32_16x16x32_bf16 v[84:87], a[108:111], v[200:203], v[84:87]
 s_cmp_lt_u32 s33, 114688
 s_cselect_b32 s33, s33, 0
 v_mfma_f32_16x16x32_bf16 v[88:91], a[104:107], v[204:207], v[88:91]
 ds_read_b128 v[172:175], v18 offset:6144
 v_mfma_f32_16x16x32_bf16 v[92:95], a[108:111], v[204:207], v[92:95]
 s_waitcnt lgkmcnt(4)
 v_mfma_f32_16x16x32_bf16 v[96:99], a[104:107], v[208:211], v[96:99]
 ds_read_b128 v[176:179], v18 offset:8192
 v_mfma_f32_16x16x32_bf16 v[100:103], a[108:111], v[208:211], v[100:103]
 v_mfma_f32_16x16x32_bf16 v[104:107], a[104:107], v[212:215], v[104:107]
 ds_read_b128 v[180:183], v18 offset:10240
 v_mfma_f32_16x16x32_bf16 v[108:111], a[108:111], v[212:215], v[108:111]
 buffer_load_dwordx4 v11, s[8:11], s30 offen offset:1024 lds
 v_mfma_f32_16x16x32_bf16 v[112:115], a[104:107], v[216:219], v[112:115]
 ds_read_b128 v[184:187], v18 offset:12288
 v_mfma_f32_16x16x32_bf16 v[116:119], a[108:111], v[216:219], v[116:119]
 v_mfma_f32_16x16x32_bf16 v[120:123], a[104:107], v[220:223], v[120:123]
 ds_read_b128 v[188:191], v18 offset:14336
 v_mfma_f32_16x16x32_bf16 v[124:127], a[108:111], v[220:223], v[124:127]
 s_waitcnt lgkmcnt(4)
 v_mfma_f32_16x16x32_bf16 v[64:67], a[112:115], v[160:163], v[64:67]
 ds_read_b128 v[192:195], v19 offset:0
 v_mfma_f32_16x16x32_bf16 v[68:71], a[116:119], v[160:163], v[68:71]
 v_add_u32 v18, s33, v14
 v_mfma_f32_16x16x32_bf16 v[72:75], a[112:115], v[164:167], v[72:75]
 ds_read_b128 v[196:199], v19 offset:2048
 v_mfma_f32_16x16x32_bf16 v[76:79], a[116:119], v[164:167], v[76:79]
 buffer_load_dwordx4 v12, s[8:11], s30 offen offset:2048 lds
 v_mfma_f32_16x16x32_bf16 v[80:83], a[112:115], v[168:171], v[80:83]
 ds_read_b128 v[200:203], v19 offset:4096
 v_mfma_f32_16x16x32_bf16 v[84:87], a[116:119], v[168:171], v[84:87]
 v_mfma_f32_16x16x32_bf16 v[88:91], a[112:115], v[172:175], v[88:91]
 ds_read_b128 v[204:207], v19 offset:6144
 v_mfma_f32_16x16x32_bf16 v[92:95], a[116:119], v[172:175], v[92:95]
 s_waitcnt lgkmcnt(4)
 v_mfma_f32_16x16x32_bf16 v[96:99], a[112:115], v[176:179], v[96:99]
 ds_read_b128 v[208:211], v19 offset:8192
 v_mfma_f32_16x16x32_bf16 v[100:103], a[116:119], v[176:179], v[100:103]
 v_mfma_f32_16x16x32_bf16 v[104:107], a[112:115], v[180:183], v[104:107]
 ds_read_b128 v[212:215], v19 offset:10240
 v_mfma_f32_16x16x32_bf16 v[108:111], a[116:119], v[180:183], v[108:111]
 buffer_load_dwordx4 v13, s[8:11], s30 offen offset:3072 lds
 v_mfma_f32_16x16x32_bf16 v[112:115], a[112:115], v[184:187], v[112:115]
 ds_read_b128 v[216:219], v19 offset:12288
 s_add_u32 s30, s30, 128
 v_mfma_f32_16x16x32_bf16 v[116:119], a[116:119], v[184:187], v[116:119]
 s_add_u32 m0, m0, 16384
 v_mfma_f32_16x16x32_bf16 v[120:123], a[112:115], v[188:191], v[120:123]
 ds_read_b128 v[220:223], v19 offset:14336
 v_mfma_f32_16x16x32_bf16 v[124:127], a[116:119], v[188:191], v[124:127]
 s_waitcnt vmcnt(16) lgkmcnt(4)
 s_barrier
 v_mfma_f32_16x16x32_bf16 v[64:67], a[120:123], v[192:195], v[64:67]
 ds_read_b128 v[160:163], v18 offset:0
 v_mfma_f32_16x16x32_bf16 v[68:71], a[124:127], v[192:195], v[68:71]
 s_cmp_lt_u32 m0, s46
 s_cselect_b32 m0, m0, s47
 v_mfma_f32_16x16x32_bf16 v[72:75], a[120:123], v[196:199], v[72:75]
 ds_read_b128 v[164:167], v18 offset:2048
 v_add_u32 v19, s33, v15
 v_mfma_f32_16x16x32_bf16 v[76:79], a[124:127], v[196:199], v[76:79]
 buffer_load_dwordx4 v10, s[8:11], s30 offen offset:0 lds
 v_mfma_f32_16x16x32_bf16 v[80:83], a[120:123], v[200:203], v[80:83]
 ds_read_b128 v[168:171], v18 offset:4096
 s_add_u32 s33, s33, 16384
 v_mfma_f32_16x16x32_bf16 v[84:87], a[124:127], v[200:203], v[84:87]
 s_cmp_lt_u32 s33, 114688
 s_cselect_b32 s33, s33, 0
 v_mfma_f32_16x16x32_bf16 v[88:91], a[120:123], v[204:207], v[88:91]
 ds_read_b128 v[172:175], v18 offset:6144
 v_mfma_f32_16x16x32_bf16 v[92:95], a[124:127], v[204:207], v[92:95]
 s_waitcnt lgkmcnt(4)
 v_mfma_f32_16x16x32_bf16 v[96:99], a[120:123], v[208:211], v[96:99]
 ds_read_b128 v[176:179], v18 offset:8192
 v_mfma_f32_16x16x32_bf16 v[100:103], a[124:127], v[208:211], v[100:103]
 v_mfma_f32_16x16x32_bf16 v[104:107], a[120:123], v[212:215], v[104:107]
 ds_read_b128 v[180:183], v18 offset:10240
 v_mfma_f32_16x16x32_bf16 v[108:111], a[124:127], v[212:215], v[108:111]
 buffer_load_dwordx4 v11, s[8:11], s30 offen offset:1024 lds
 v_mfma_f32_16x16x32_bf16 v[112:115], a[120:123], v[216:219], v[112:115]
 ds_read_b128 v[184:187], v18 offset:12288
 v_mfma_f32_16x16x32_bf16 v[116:119], a[124:127], v[216:219], v[116:119]
 v_mfma_f32_16x16x32_bf16 v[120:123], a[120:123], v[220:223], v[120:123]
 ds_read_b128 v[188:191], v18 offset:14336
 v_mfma_f32_16x16x32_bf16 v[124:127], a[124:127], v[220:223], v[124:127]
 s_waitcnt lgkmcnt(4)
 v_mfma_f32_16x16x32_bf16 v[64:67], a[128:131], v[160:163], v[64:67]
 ds_read_b128 v[192:195], v19 offset:0
 v_mfma_f32_16x16x32_bf16 v[68:71], a[132:135], v[160:163], v[68:71]
 v_add_u32 v18, s33, v14
 v_mfma_f32_16x16x32_bf16 v[72:75], a[128:131], v[164:167], v[72:75]
 ds_read_b128 v[196:199], v19 offset:2048
 v_mfma_f32_16x16x32_bf16 v[76:79], a[132:135], v[164:167], v[76:79]
 buffer_load_dwordx4 v12, s[8:11], s30 offen offset:2048 lds
 v_mfma_f32_16x16x32_bf16 v[80:83], a[128:131], v[168:171], v[80:83]
 ds_read_b128 v[200:203], v19 offset:4096
 v_mfma_f32_16x16x32_bf16 v[84:87], a[132:135], v[168:171], v[84:87]
 v_mfma_f32_16x16x32_bf16 v[88:91], a[128:131], v[172:175], v[88:91]
 ds_read_b128 v[204:207], v19 offset:6144
 v_mfma_f32_16x16x32_bf16 v[92:95], a[132:135], v[172:175], v[92:95]
 s_waitcnt lgkmcnt(4)
 v_mfma_f32_16x16x32_bf16 v[96:99], a[128:131], v[176:179], v[96:99]
 ds_read_b128 v[208:211], v19 offset:8192
 v_mfma_f32_16x16x32_bf16 v[100:103], a[132:135], v[176:179], v[100:103]
 v_mfma_f32_16x16x32_bf16 v[104:107], a[128:131], v[180:183], v[104:107]
 ds_read_b128 v[212:215], v19 offset:10240
 v_mfma_f32_16x16x32_bf16 v[108:111], a[132:135], v[180:183], v[108:111]
 buffer_load_dwordx4 v13, s[8:11], s30 offen offset:3072 lds
 v_mfma_f32_16x16x32_bf16 v[112:115], a[128:131], v[184:187], v[112:115]
 ds_read_b128 v[216:219], v19 offset:12288
 s_add_u32 s30, s30, 128
 v_mfma_f32_16x16x32_bf16 v[116:119], a[132:135], v[184:187], v[116:119]
 s_add_u32 m0, m0, 16384
 v_mfma_f32_16x16x32_bf16 v[120:123], a[128:131], v[188:191], v[120:123]
 ds_read_b128 v[220:223], v19 offset:14336
 v_mfma_f32_16x16x32_bf16 v[124:127], a[132:135], v[188:191], v[124:127]
 s_waitcnt vmcnt(16) lgkmcnt(4)
 s_barrier
 v_mfma_f32_16x16x32_bf16 v[64:67], a[136:139], v[192:195], v[64:67]
 ds_read_b128 v[160:163], v18 offset:0
 v_mfma_f32_16x16x32_bf16 v[68:71], a[140:143], v[192:195], v[68:71]
 s_cmp_lt_u32 m0, s46
 s_cselect_b32 m0, m0, s47
 v_mfma_f32_16x16x32_bf16 v[72:75], a[136:139], v[196:199], v[72:75]
 ds_read_b128 v[164:167], v18 offset:2048
 v_add_u32 v19, s33, v15
 v_mfma_f32_16x16x32_bf16 v[76:79], a[140:143], v[196:199], v[76:79]
 buffer_load_dwordx4 v10, s[8:11], s30 offen offset:0 lds
 v_mfma_f32_16x16x32_bf16 v[80:83], a[136:139], v[200:203], v[80:83]
 ds_read_b128 v[168:171], v18 offset:4096
 s_add_u32 s33, s33, 16384
 v_mfma_f32_16x16x32_bf16 v[84:87], a[140:143], v[200:203], v[84:87]
 s_cmp_lt_u32 s33, 114688
 s_cselect_b32 s33, s33, 0
 v_mfma_f32_16x16x32_bf16 v[88:91], a[136:139], v[204:207], v[88:91]
 ds_read_b128 v[172:175], v18 offset:6144
 v_mfma_f32_16x16x32_bf16 v[92:95], a[140:143], v[204:207], v[92:95]
 s_waitcnt lgkmcnt(4)
 v_mfma_f32_16x16x32_bf16 v[96:99], a[136:139], v[208:211], v[96:99]
 ds_read_b128 v[176:179], v18 offset:8192
 v_mfma_f32_16x16x32_bf16 v[100:103], a[140:143], v[208:211], v[100:103]
 v_mfma_f32_16x16x32_bf16 v[104:107], a[136:139], v[212:215], v[104:107]
 ds_read_b128 v[180:183], v18 offset:10240
 v_mfma_f32_16x16x32_bf16 v[108:111], a[140:143], v[212:215], v[108:111]
 buffer_load_dwordx4 v11, s[8:11], s30 offen offset:1024 lds
 v_mfma_f32_16x16x32_bf16 v[112:115], a[136:139], v[216:219], v[112:115]
 ds_read_b128 v[184:187], v18 offset:12288
 v_mfma_f32_16x16x32_bf16 v[116:119], a[140:143], v[216:219], v[116:119]
 v_mfma_f32_16x16x32_bf16 v[120:123], a[136:139], v[220:223], v[120:123]
 ds_read_b128 v[188:191], v18 offset:14336
 v_mfma_f32_16x16x32_bf16 v[124:127], a[140:143], v[220:223], v[124:127]
 s_waitcnt lgkmcnt(4)
 v_mfma_f32_16x16x32_bf16 v[64:67], a[144:147], v[160:163], v[64:67]
 ds_read_b128 v[192:195], v19 offset:0
 v_mfma_f32_16x16x32_bf16 v[68:71], a[148:151], v[160:163], v[68:71]
 v_add_u32 v18, s33, v14
 v_mfma_f32_16x16x32_bf16 v[72:75], a[144:147], v[164:167], v[72:75]
 ds_read_b128 v[196:199], v19 offset:2048
 v_mfma_f32_16x16x32_bf16 v[76:79], a[148:151], v[164:167], v[76:79]
 buffer_load_dwordx4 v12, s[8:11], s30 offen offset:2048 lds
 v_mfma_f32_16x16x32_bf16 v[80:83], a[144:147], v[168:171], v[80:83]
 ds_read_b128 v[200:203], v19 offset:4096
 v_mfma_f32_16x16x32_bf16 v[84:87], a[148:151], v[168:171], v[84:87]
 v_mfma_f32_16x16x32_bf16 v[88:91], a[144:147], v[172:175], v[88:91]
 ds_read_b128 v[204:207], v19 offset:6144
 v_mfma_f32_16x16x32_bf16 v[92:95], a[148:151], v[172:175], v[92:95]
 s_waitcnt lgkmcnt(4)
 v_mfma_f32_16x16x32_bf16 v[96:99], a[144:147], v[176:179], v[96:99]
 ds_read_b128 v[208:211], v19 offset:8192
 v_mfma_f32_16x16x32_bf16 v[100:103], a[148:151], v[176:179], v[100:103]
 v_mfma_f32_16x16x32_bf16 v[104:107], a[144:147], v[180:183], v[104:107]
 ds_read_b128 v[212:215], v19 offset:10240
 v_mfma_f32_16x16x32_bf16 v[108:111], a[148:151], v[180:183], v[108:111]
 buffer_load_dwordx4 v13, s[8:11], s30 offen offset:3072 lds
 v_mfma_f32_16x16x32_bf16 v[112:115], a[144:147], v[184:187], v[112:115]
 ds_read_b128 v[216:219], v19 offset:12288
 s_add_u32 s30, s30, 128
 v_mfma_f32_16x16x32_bf16 v[116:119], a[148:151], v[184:187], v[116:119]
 s_add_u32 m0, m0, 16384
 v_mfma_f32_16x16x32_bf16 v[120:123], a[144:147], v[188:191], v[120:123]
 ds_read_b128 v[220:223], v19 offset:14336
 v_mfma_f32_16x16x32_bf16 v[124:127], a[148:151], v[188:191], v[124:127]
 s_waitcnt vmcnt(16) lgkmcnt(4)
 s_barrier
 v_mfma_f32_16x16x32_bf16 v[64:67], a[152:155], v[192:195], v[64:67]
 ds_read_b128 v[160:163], v18 offset:0
 v_mfma_f32_16x16x32_bf16 v[68:71], a[156:159], v[192:195], v[68:71]
 s_cmp_lt_u32 m0, s46
 s_cselect_b32 m0, m0, s47
 v_mfma_f32_16x16x32_bf16 v[72:75], a[152:155], v[196:199], v[72:75]
 ds_read_b128 v[164:167], v18 offset:2048
 v_add_u32 v19, s33, v15
 v_mfma_f32_16x16x32_bf16 v[76:79], a[156:159], v[196:199], v[76:79]
 buffer_load_dwordx4 v10, s[8:11], s30 offen offset:0 lds
 v_cvt_pk_bf16_f32 v224, v64, v65
 v_cvt_pk_bf16_f32 v225, v66, v67
 v_mfma_f32_16x16x32_bf16 v[80:83], a[152:155], v[200:203], v[80:83]
 ds_read_b128 v[168:171], v18 offset:4096
 s_add_u32 s33, s33, 16384
 v_cvt_pk_bf16_f32 v226, v68, v69
 v_cvt_pk_bf16_f32 v227, v70, v71
 v_mfma_f32_16x16x32_bf16 v[84:87], a[156:159], v[200:203], v[84:87]
 s_cmp_lt_u32 s33, 114688
 s_cselect_b32 s33, s33, 0
 ds_write_b64 v22, v[224:225] offset:0
 v_mfma_f32_16x16x32_bf16 v[88:91], a[152:155], v[204:207], v[88:91]
 ds_read_b128 v[172:175], v18 offset:6144
 ds_write_b64 v22, v[226:227] offset:32
 v_cvt_pk_bf16_f32 v230, v72, v73
 v_mfma_f32_16x16x32_bf16 v[92:95], a[156:159], v[204:207], v[92:95]
 s_waitcnt lgkmcnt(6)
 v_cvt_pk_bf16_f32 v231, v74, v75
 v_cvt_pk_bf16_f32 v232, v76, v77
 v_cvt_pk_bf16_f32 v233, v78, v79
 v_mfma_f32_16x16x32_bf16 v[96:99], a[152:155], v[208:211], v[96:99]
 ds_read_b128 v[176:179], v18 offset:8192
 ds_write_b64 v22, v[230:231] offset:4224
 v_mfma_f32_16x16x32_bf16 v[100:103], a[156:159], v[208:211], v[100:103]
 ds_write_b64 v22, v[232:233] offset:4256
 v_cvt_pk_bf16_f32 v224, v80, v81
 v_cvt_pk_bf16_f32 v225, v82, v83
 v_mfma_f32_16x16x32_bf16 v[104:107], a[152:155], v[212:215], v[104:107]
 ds_read_b128 v[180:183], v18 offset:10240
 v_cvt_pk_bf16_f32 v226, v84, v85
 v_cvt_pk_bf16_f32 v227, v86, v87
 v_mfma_f32_16x16x32_bf16 v[108:111], a[156:159], v[212:215], v[108:111]
 buffer_load_dwordx4 v11, s[8:11], s30 offen offset:1024 lds
 ds_write_b64 v22, v[224:225] offset:8448
 v_mfma_f32_16x16x32_bf16 v[112:115], a[152:155], v[216:219], v[112:115]
 ds_read_b128 v[184:187], v18 offset:12288
 ds_write_b64 v22, v[226:227] offset:8480
 v_cvt_pk_bf16_f32 v230, v88, v89
 v_mfma_f32_16x16x32_bf16 v[116:119], a[156:159], v[216:219], v[116:119]
 v_cvt_pk_bf16_f32 v231, v90, v91
 v_cvt_pk_bf16_f32 v232, v92, v93
 v_cvt_pk_bf16_f32 v233, v94, v95
 v_mfma_f32_16x16x32_bf16 v[120:123], a[152:155], v[220:223], v[120:123]
 ds_read_b128 v[188:191], v18 offset:14336
 ds_write_b64 v22, v[230:231] offset:12672
 v_mfma_f32_16x16x32_bf16 v[124:127], a[156:159], v[220:223], v[124:127]
 ds_write_b64 v22, v[232:233] offset:12704
 v_cvt_pk_bf16_f32 v224, v96, v97
 v_cvt_pk_bf16_f32 v225, v98, v99
bf_end_186:
 v_cvt_pk_bf16_f32 v226, v100, v101
 v_cvt_pk_bf16_f32 v227, v102, v103
 ds_write_b64 v22, v[224:225] offset:16896
 ds_write_b64 v22, v[226:227] offset:16928
 v_cvt_pk_bf16_f32 v230, v104, v105
 v_cvt_pk_bf16_f32 v231, v106, v107
 v_cvt_pk_bf16_f32 v232, v108, v109
 v_cvt_pk_bf16_f32 v233, v110, v111
 ds_write_b64 v22, v[230:231] offset:21120
 ds_write_b64 v22, v[232:233] offset:21152
 v_cvt_pk_bf16_f32 v224, v112, v113
 v_cvt_pk_bf16_f32 v225, v114, v115
 v_cvt_pk_bf16_f32 v226, v116, v117
 v_cvt_pk_bf16_f32 v227, v118, v119
 ds_write_b64 v22, v[224:225] offset:25344
 ds_write_b64 v22, v[226:227] offset:25376
 v_cvt_pk_bf16_f32 v230, v120, v121
 v_cvt_pk_bf16_f32 v231, v122, v123
 v_cvt_pk_bf16_f32 v232, v124, v125
 v_cvt_pk_bf16_f32 v233, v126, v127
 ds_write_b64 v22, v[230:231] offset:29568
 ds_write_b64 v22, v[232:233] offset:29600
 s_cmp_lg_u32 s26, 6
 s_cbranch_scc1 bw_187
 buffer_load_dword v32, v32, s[64:67], 0 offen sc1
 buffer_load_dwordx4 v[40:43], v33, s[12:15], s50 offen offset:0
 buffer_load_dwordx4 v[40:43], v33, s[12:15], s50 offen offset:1024
 buffer_load_dwordx4 v[40:43], v33, s[12:15], s50 offen offset:2048
 buffer_load_dwordx4 v[40:43], v33, s[12:15], s50 offen offset:3072
 buffer_load_dwordx4 v[40:43], v33, s[12:15], s51 offen offset:0
 buffer_load_dwordx4 v[40:43], v33, s[12:15], s51 offen offset:1024
 buffer_load_dwordx4 v[40:43], v33, s[12:15], s51 offen offset:2048
bw_187:
 s_waitcnt lgkmcnt(0)
 s_barrier
 ds_read_b64 v[144:145], v34 offset:1848
 ds_read_b64 v[146:147], v34 offset:1856
 ds_read_b64 v[148:149], v34 offset:1864
 ds_read_b64 v[150:151], v34 offset:1872
 ds_read_b64 v[152:153], v34 offset:1880
 ds_read_b64 v[64:65], v34 offset:1928
 ds_read_b64 v[66:67], v34 offset:1936
 ds_read_b64 v[68:69], v34 offset:1944
 ds_read_b64 v[70:71], v34 offset:1952
 ds_read_b64 v[72:73], v34 offset:1960
 ds_read_b64 v[74:75], v34 offset:1664
 ds_read_b64 v[76:77], v34 offset:1672
 ds_read_b64 v[78:79], v34 offset:1680
 ds_read_b64 v[80:81], v34 offset:1688
 ds_read_b64 v[82:83], v34 offset:1696
 ds_read_b64 v[84:85], v34 offset:1400
 ds_read_b64 v[86:87], v34 offset:1408
 ds_read_b64 v[88:89], v34 offset:1416
 ds_read_b64 v[90:91], v34 offset:1424
 ds_read_b64 v[92:93], v34 offset:1432
 ds_read_b64 v[94:95], v34 offset:1136
 ds_read_b64 v[96:97], v34 offset:1144
 ds_read_b64 v[98:99], v34 offset:1152
 ds_read_b64 v[100:101], v34 offset:1160
 ds_read_b64 v[102:103], v34 offset:1168
 ds_read_b64 v[104:105], v34 offset:872
 ds_read_b64 v[106:107], v34 offset:880
 ds_read_b64 v[108:109], v34 offset:888
 ds_read_b64 v[110:111], v34 offset:896
 ds_read_b64 v[112:113], v34 offset:904
 ds_read_b64 v[114:115], v34 offset:608
 ds_read_b64 v[116:117], v34 offset:616
 ds_read_b64 v[118:119], v34 offset:624
 ds_read_b64 v[120:121], v34 offset:632
 ds_read_b64 v[122:123], v34 offset:640
 ds_read_b64 v[124:125], v34 offset:344
 ds_read_b64 v[126:127], v34 offset:352
 ds_read_b64 v[128:129], v34 offset:360
 ds_read_b64 v[130:131], v34 offset:368
 ds_read_b64 v[132:133], v34 offset:376
 ds_read_b64 v[134:135], v34 offset:80
 ds_read_b64 v[136:137], v34 offset:88
 ds_read_b64 v[138:139], v34 offset:96
 ds_read_b64 v[140:141], v34 offset:104
 ds_read_b64 v[142:143], v34 offset:112
 v_mov_b32 v224, 0
 v_mov_b32 v225, 0
 v_mov_b32 v226, 0
 v_mov_b32 v227, 0
 v_mov_b32 v228, 0
 v_mov_b32 v229, 0
 v_mov_b32 v230, 0
 v_mov_b32 v231, 0
 s_waitcnt lgkmcnt(15)
 v_dot2c_f32_bf16 v224, v64, v144
 v_dot2c_f32_bf16 v225, v74, v144
 v_dot2c_f32_bf16 v226, v84, v144
 v_dot2c_f32_bf16 v227, v94, v144
 v_dot2c_f32_bf16 v224, v65, v145
 v_dot2c_f32_bf16 v225, v75, v145
 v_dot2c_f32_bf16 v226, v85, v145
 v_dot2c_f32_bf16 v227, v95, v145
 v_dot2c_f32_bf16 v224, v66, v146
 v_dot2c_f32_bf16 v225, v76, v146
 v_dot2c_f32_bf16 v226, v86, v146
 v_dot2c_f32_bf16 v227, v96, v146
 v_dot2c_f32_bf16 v224, v67, v147
 v_dot2c_f32_bf16 v225, v77, v147
 v_dot2c_f32_bf16 v226, v87, v147
 v_dot2c_f32_bf16 v227, v97, v147
 v_dot2c_f32_bf16 v224, v68, v148
 v_dot2c_f32_bf16 v225, v78, v148
 v_dot2c_f32_bf16 v226, v88, v148
 v_dot2c_f32_bf16 v227, v98, v148
 v_dot2c_f32_bf16 v224, v69, v149
 v_dot2c_f32_bf16 v225, v79, v149
 v_dot2c_f32_bf16 v226, v89, v149
 v_dot2c_f32_bf16 v227, v99, v149
 v_dot2c_f32_bf16 v224, v70, v150
 v_dot2c_f32_bf16 v225, v80, v150
 v_dot2c_f32_bf16 v226, v90, v150
 v_dot2c_f32_bf16 v227, v100, v150
 v_dot2c_f32_bf16 v224, v71, v151
 v_dot2c_f32_bf16 v225, v81, v151
 v_dot2c_f32_bf16 v226, v91, v151
 v_dot2c_f32_bf16 v227, v101, v151
 v_dot2c_f32_bf16 v224, v72, v152
 v_dot2c_f32_bf16 v225, v82, v152
 v_dot2c_f32_bf16 v226, v92, v152
 v_dot2c_f32_bf16 v227, v102, v152
 v_dot2c_f32_bf16 v224, v73, v153
 v_dot2c_f32_bf16 v225, v83, v153
 v_dot2c_f32_bf16 v226, v93, v153
 v_dot2c_f32_bf16 v227, v103, v153
 s_waitcnt lgkmcnt(0)
 v_dot2c_f32_bf16 v228, v104, v144
 v_dot2c_f32_bf16 v229, v114, v144
 v_dot2c_f32_bf16 v230, v124, v144
 v_dot2c_f32_bf16 v231, v134, v144
 v_dot2c_f32_bf16 v228, v105, v145
 v_dot2c_f32_bf16 v229, v115, v145
 v_dot2c_f32_bf16 v230, v125, v145
 v_dot2c_f32_bf16 v231, v135, v145
 v_dot2c_f32_bf16 v228, v106, v146
 v_dot2c_f32_bf16 v229, v116, v146
 v_dot2c_f32_bf16 v230, v126, v146
 v_dot2c_f32_bf16 v231, v136, v146
 v_dot2c_f32_bf16 v228, v107, v147
 v_dot2c_f32_bf16 v229, v117, v147
 v_dot2c_f32_bf16 v230, v127, v147
 v_dot2c_f32_bf16 v231, v137, v147
 v_dot2c_f32_bf16 v228, v108, v148
 v_dot2c_f32_bf16 v229, v118, v148
 v_dot2c_f32_bf16 v230, v128, v148
 v_dot2c_f32_bf16 v231, v138, v148
 v_dot2c_f32_bf16 v228, v109, v149
 v_dot2c_f32_bf16 v229, v119, v149
 v_dot2c_f32_bf16 v230, v129, v149
 v_dot2c_f32_bf16 v231, v139, v149
 v_dot2c_f32_bf16 v228, v110, v150
 v_dot2c_f32_bf16 v229, v120, v150
 v_dot2c_f32_bf16 v230, v130, v150
 v_dot2c_f32_bf16 v231, v140, v150
 v_dot2c_f32_bf16 v228, v111, v151
 v_dot2c_f32_bf16 v229, v121, v151
 v_dot2c_f32_bf16 v230, v131, v151
 v_dot2c_f32_bf16 v231, v141, v151
 v_dot2c_f32_bf16 v228, v112, v152
 v_dot2c_f32_bf16 v229, v122, v152
 v_dot2c_f32_bf16 v230, v132, v152
 v_dot2c_f32_bf16 v231, v142, v152
 v_dot2c_f32_bf16 v228, v113, v153
 v_dot2c_f32_bf16 v229, v123, v153
 v_dot2c_f32_bf16 v230, v133, v153
 v_dot2c_f32_bf16 v231, v143, v153
 ds_read_b64 v[64:65], v38 offset:2008
 ds_read_b64 v[66:67], v38 offset:2016
 ds_read_b64 v[68:69], v38 offset:2024
 ds_read_b64 v[70:71], v38 offset:2032
 ds_read_b64 v[72:73], v39 offset:2040
 ds_read_b64 v[74:75], v38 offset:1744
 ds_read_b64 v[76:77], v38 offset:1752
 ds_read_b64 v[78:79], v38 offset:1760
 ds_read_b64 v[80:81], v38 offset:1768
 ds_read_b64 v[82:83], v39 offset:1776
 ds_read_b64 v[84:85], v38 offset:1480
 ds_read_b64 v[86:87], v38 offset:1488
 ds_read_b64 v[88:89], v38 offset:1496
 ds_read_b64 v[90:91], v38 offset:1504
 ds_read_b64 v[92:93], v39 offset:1512
 ds_read_b64 v[94:95], v38 offset:1216
 ds_read_b64 v[96:97], v38 offset:1224
 ds_read_b64 v[98:99], v38 offset:1232
 ds_read_b64 v[100:101], v38 offset:1240
 ds_read_b64 v[102:103], v39 offset:1248
 ds_read_b64 v[104:105], v38 offset:952
 ds_read_b64 v[106:107], v38 offset:960
 ds_read_b64 v[108:109], v38 offset:968
 ds_read_b64 v[110:111], v38 offset:976
 ds_read_b64 v[112:113], v39 offset:984
 ds_read_b64 v[114:115], v38 offset:688
 ds_read_b64 v[116:117], v38 offset:696
 ds_read_b64 v[118:119], v38 offset:704
 ds_read_b64 v[120:121], v38 offset:712
 ds_read_b64 v[122:123], v39 offset:720
 ds_read_b64 v[124:125], v38 offset:424
 ds_read_b64 v[126:127], v38 offset:432
 ds_read_b64 v[128:129], v38 offset:440
 ds_read_b64 v[130:131], v38 offset:448
 ds_read_b64 v[132:133], v39 offset:456
 ds_read_b64 v[134:135], v38 offset:160
 ds_read_b64 v[136:137], v38 offset:168
 ds_read_b64 v[138:139], v38 offset:176
 ds_read_b64 v[140:141], v38 offset:184
 ds_read_b64 v[142:143], v39 offset:192
 v_cvt_pk_bf16_f32 v4, v224, v225
 v_lshlrev_b32 v224, 16, v4
 v_and_b32 v225, 0xffff0000, v4
 v_mul_f32 v224, s60, v224
 v_mul_f32 v225, s60, v225
 v_cvt_pk_bf16_f32 v4, v224, v225
 v_lshlrev_b32 v224, 16, v4
 v_and_b32 v225, 0xffff0000, v4
 v_cndmask_b32 v224, v37, v224, s[76:77]
 v_cndmask_b32 v225, v37, v225, s[78:79]
 v_cvt_pk_bf16_f32 v4, v226, v227
 v_lshlrev_b32 v226, 16, v4
 v_and_b32 v227, 0xffff0000, v4
 v_mul_f32 v226, s60, v226
 v_mul_f32 v227, s60, v227
 v_cvt_pk_bf16_f32 v4, v226, v227
 v_lshlrev_b32 v226, 16, v4
 v_and_b32 v227, 0xffff0000, v4
 v_cndmask_b32 v226, v37, v226, s[80:81]
 v_cndmask_b32 v227, v37, v227, s[82:83]
 v_cvt_pk_bf16_f32 v4, v228, v229
 v_lshlrev_b32 v228, 16, v4
 v_and_b32 v229, 0xffff0000, v4
 v_mul_f32 v228, s60, v228
 v_mul_f32 v229, s60, v229
 v_cvt_pk_bf16_f32 v4, v228, v229
 v_lshlrev_b32 v228, 16, v4
 v_and_b32 v229, 0xffff0000, v4
 v_cndmask_b32 v228, v37, v228, s[84:85]
 v_cndmask_b32 v229, v37, v229, s[86:87]
 v_cvt_pk_bf16_f32 v4, v230, v231
 v_lshlrev_b32 v230, 16, v4
 v_and_b32 v231, 0xffff0000, v4
 v_mul_f32 v230, s60, v230
 v_mul_f32 v231, s60, v231
 v_cvt_pk_bf16_f32 v4, v230, v231
 v_lshlrev_b32 v230, 16, v4
 v_and_b32 v231, 0xffff0000, v4
 v_cndmask_b32 v230, v37, v230, s[88:89]
 v_cndmask_b32 v231, v37, v231, s[90:91]
 v_max3_f32 v5, v224, v225, v226
 v_max3_f32 v5, v5, v227, v228
 v_max3_f32 v5, v5, v229, v230
 v_max_f32 v5, v5, v231
 v_sub_f32 v224, v224, v5
 v_mul_f32 v224, s61, v224
 v_exp_f32 v224, v224
 v_sub_f32 v225, v225, v5
 v_mul_f32 v225, s61, v225
 v_exp_f32 v225, v225
 v_sub_f32 v226, v226, v5
 v_mul_f32 v226, s61, v226
 v_exp_f32 v226, v226
 v_sub_f32 v227, v227, v5
 v_mul_f32 v227, s61, v227
 v_exp_f32 v227, v227
 v_sub_f32 v228, v228, v5
 v_mul_f32 v228, s61, v228
 v_exp_f32 v228, v228
 v_sub_f32 v229, v229, v5
 v_mul_f32 v229, s61, v229
 v_exp_f32 v229, v229
 v_sub_f32 v230, v230, v5
 v_mul_f32 v230, s61, v230
 v_exp_f32 v230, v230
 v_sub_f32 v231, v231, v5
 v_mul_f32 v231, s61, v231
 v_exp_f32 v231, v231
 s_nop 0
 v_add_f32 v5, v224, v225
 v_add_f32 v5, v5, v226
 v_add_f32 v5, v5, v227
 v_add_f32 v5, v5, v228
 v_add_f32 v5, v5, v229
 v_add_f32 v5, v5, v230
 v_add_f32 v5, v5, v231
 v_rcp_f32 v5, v5
 s_nop 0
 v_mul_f32 v224, v224, v5
 v_mul_f32 v225, v225, v5
 v_mul_f32 v226, v226, v5
 v_mul_f32 v227, v227, v5
 v_mul_f32 v228, v228, v5
 v_mul_f32 v229, v229, v5
 v_mul_f32 v230, v230, v5
 v_mul_f32 v231, v231, v5
 v_cvt_pk_bf16_f32 v232, v224, v225
 v_cvt_pk_bf16_f32 v233, v226, v227
 v_cvt_pk_bf16_f32 v234, v228, v229
 v_cvt_pk_bf16_f32 v235, v230, v231
 s_waitcnt lgkmcnt(15)
 v_perm_b32 v144, v74, v64, s62
 v_perm_b32 v145, v74, v64, s63
 v_perm_b32 v146, v75, v65, s62
 v_perm_b32 v147, v75, v65, s63
 v_perm_b32 v148, v76, v66, s62
 v_perm_b32 v149, v76, v66, s63
 v_perm_b32 v150, v77, v67, s62
 v_perm_b32 v151, v77, v67, s63
 v_perm_b32 v152, v78, v68, s62
 v_perm_b32 v153, v78, v68, s63
 v_perm_b32 v154, v79, v69, s62
 v_perm_b32 v155, v79, v69, s63
 v_perm_b32 v156, v80, v70, s62
 v_perm_b32 v157, v80, v70, s63
 v_perm_b32 v158, v81, v71, s62
 v_perm_b32 v159, v81, v71, s63
 v_perm_b32 v212, v82, v72, s62
 v_perm_b32 v213, v82, v72, s63
 v_perm_b32 v214, v83, v73, s62
 v_perm_b32 v215, v83, v73, s63
 v_dot2_f32_bf16 v192, v144, v232, 0
 v_dot2_f32_bf16 v193, v145, v232, 0
 v_dot2_f32_bf16 v194, v146, v232, 0
 v_dot2_f32_bf16 v195, v147, v232, 0
 v_dot2_f32_bf16 v196, v148, v232, 0
 v_dot2_f32_bf16 v197, v149, v232, 0
 v_dot2_f32_bf16 v198, v150, v232, 0
 v_dot2_f32_bf16 v199, v151, v232, 0
 v_dot2_f32_bf16 v200, v152, v232, 0
 v_dot2_f32_bf16 v201, v153, v232, 0
 v_dot2_f32_bf16 v202, v154, v232, 0
 v_dot2_f32_bf16 v203, v155, v232, 0
 v_dot2_f32_bf16 v204, v156, v232, 0
 v_dot2_f32_bf16 v205, v157, v232, 0
 v_dot2_f32_bf16 v206, v158, v232, 0
 v_dot2_f32_bf16 v207, v159, v232, 0
 v_dot2_f32_bf16 v208, v212, v232, 0
 v_dot2_f32_bf16 v209, v213, v232, 0
 v_dot2_f32_bf16 v210, v214, v232, 0
 v_dot2_f32_bf16 v211, v215, v232, 0
 s_waitcnt lgkmcnt(15)
 v_perm_b32 v144, v94, v84, s62
 v_perm_b32 v145, v94, v84, s63
 v_perm_b32 v146, v95, v85, s62
 v_perm_b32 v147, v95, v85, s63
 v_perm_b32 v148, v96, v86, s62
 v_perm_b32 v149, v96, v86, s63
 v_perm_b32 v150, v97, v87, s62
 v_perm_b32 v151, v97, v87, s63
 v_perm_b32 v152, v98, v88, s62
 v_perm_b32 v153, v98, v88, s63
 v_perm_b32 v154, v99, v89, s62
 v_perm_b32 v155, v99, v89, s63
 v_perm_b32 v156, v100, v90, s62
 v_perm_b32 v157, v100, v90, s63
 v_perm_b32 v158, v101, v91, s62
 v_perm_b32 v159, v101, v91, s63
 v_perm_b32 v212, v102, v92, s62
 v_perm_b32 v213, v102, v92, s63
 v_perm_b32 v214, v103, v93, s62
 v_perm_b32 v215, v103, v93, s63
 v_dot2c_f32_bf16 v192, v144, v233
 v_dot2c_f32_bf16 v193, v145, v233
 v_dot2c_f32_bf16 v194, v146, v233
 v_dot2c_f32_bf16 v195, v147, v233
 v_dot2c_f32_bf16 v196, v148, v233
 v_dot2c_f32_bf16 v197, v149, v233
 v_dot2c_f32_bf16 v198, v150, v233
 v_dot2c_f32_bf16 v199, v151, v233
 v_dot2c_f32_bf16 v200, v152, v233
 v_dot2c_f32_bf16 v201, v153, v233
 v_dot2c_f32_bf16 v202, v154, v233
 v_dot2c_f32_bf16 v203, v155, v233
 v_dot2c_f32_bf16 v204, v156, v233
 v_dot2c_f32_bf16 v205, v157, v233
 v_dot2c_f32_bf16 v206, v158, v233
 v_dot2c_f32_bf16 v207, v159, v233
 v_dot2c_f32_bf16 v208, v212, v233
 v_dot2c_f32_bf16 v209, v213, v233
 v_dot2c_f32_bf16 v210, v214, v233
 v_dot2c_f32_bf16 v211, v215, v233
 s_waitcnt lgkmcnt(10)
 v_perm_b32 v144, v114, v104, s62
 v_perm_b32 v145, v114, v104, s63
 v_perm_b32 v146, v115, v105, s62
 v_perm_b32 v147, v115, v105, s63
 v_perm_b32 v148, v116, v106, s62
 v_perm_b32 v149, v116, v106, s63
 v_perm_b32 v150, v117, v107, s62
 v_perm_b32 v151, v117, v107, s63
 v_perm_b32 v152, v118, v108, s62
 v_perm_b32 v153, v118, v108, s63
 v_perm_b32 v154, v119, v109, s62
 v_perm_b32 v155, v119, v109, s63
 v_perm_b32 v156, v120, v110, s62
 v_perm_b32 v157, v120, v110, s63
 v_perm_b32 v158, v121, v111, s62
 v_perm_b32 v159, v121, v111, s63
 v_perm_b32 v212, v122, v112, s62
 v_perm_b32 v213, v122, v112, s63
 v_perm_b32 v214, v123, v113, s62
 v_perm_b32 v215, v123, v113, s63
 v_dot2c_f32_bf16 v192, v144, v234
 v_dot2c_f32_bf16 v193, v145, v234
 v_dot2c_f32_bf16 v194, v146, v234
 v_dot2c_f32_bf16 v195, v147, v234
 v_dot2c_f32_bf16 v196, v148, v234
 v_dot2c_f32_bf16 v197, v149, v234
 v_dot2c_f32_bf16 v198, v150, v234
 v_dot2c_f32_bf16 v199, v151, v234
 v_dot2c_f32_bf16 v200, v152, v234
 v_dot2c_f32_bf16 v201, v153, v234
 v_dot2c_f32_bf16 v202, v154, v234
 v_dot2c_f32_bf16 v203, v155, v234
 v_dot2c_f32_bf16 v204, v156, v234
 v_dot2c_f32_bf16 v205, v157, v234
 v_dot2c_f32_bf16 v206, v158, v234
 v_dot2c_f32_bf16 v207, v159, v234
 v_dot2c_f32_bf16 v208, v212, v234
 v_dot2c_f32_bf16 v209, v213, v234
 v_dot2c_f32_bf16 v210, v214, v234
 v_dot2c_f32_bf16 v211, v215, v234
 s_waitcnt lgkmcnt(0)
 v_perm_b32 v144, v134, v124, s62
 v_perm_b32 v145, v134, v124, s63
 v_perm_b32 v146, v135, v125, s62
 v_perm_b32 v147, v135, v125, s63
 v_perm_b32 v148, v136, v126, s62
 v_perm_b32 v149, v136, v126, s63
 v_perm_b32 v150, v137, v127, s62
 v_perm_b32 v151, v137, v127, s63
 v_perm_b32 v152, v138, v128, s62
 v_perm_b32 v153, v138, v128, s63
 v_perm_b32 v154, v139, v129, s62
 v_perm_b32 v155, v139, v129, s63
 v_perm_b32 v156, v140, v130, s62
 v_perm_b32 v157, v140, v130, s63
 v_perm_b32 v158, v141, v131, s62
 v_perm_b32 v159, v141, v131, s63
 v_perm_b32 v212, v142, v132, s62
 v_perm_b32 v213, v142, v132, s63
 v_perm_b32 v214, v143, v133, s62
 v_perm_b32 v215, v143, v133, s63
 v_dot2c_f32_bf16 v192, v144, v235
 v_dot2c_f32_bf16 v193, v145, v235
 v_dot2c_f32_bf16 v194, v146, v235
 v_dot2c_f32_bf16 v195, v147, v235
 v_dot2c_f32_bf16 v196, v148, v235
 v_dot2c_f32_bf16 v197, v149, v235
 v_dot2c_f32_bf16 v198, v150, v235
 v_dot2c_f32_bf16 v199, v151, v235
 v_dot2c_f32_bf16 v200, v152, v235
 v_dot2c_f32_bf16 v201, v153, v235
 v_dot2c_f32_bf16 v202, v154, v235
 v_dot2c_f32_bf16 v203, v155, v235
 v_dot2c_f32_bf16 v204, v156, v235
 v_dot2c_f32_bf16 v205, v157, v235
 v_dot2c_f32_bf16 v206, v158, v235
 v_dot2c_f32_bf16 v207, v159, v235
 v_dot2c_f32_bf16 v208, v212, v235
 v_dot2c_f32_bf16 v209, v213, v235
 v_dot2c_f32_bf16 v210, v214, v235
 v_dot2c_f32_bf16 v211, v215, v235
 s_cmp_lg_u32 s20, 0
 s_cbranch_scc1 bh_188
 ds_read_b64 v[64:65], v35 offset:33792
 ds_read_b64 v[66:67], v35 offset:34304
 ds_read_b64 v[68:69], v35 offset:34816
 ds_read_b64 v[70:71], v35 offset:35328
 ds_read_b64 v[72:73], v35 offset:35840
 s_waitcnt lgkmcnt(0)
 ds_write_b64 v35, v[64:65] offset:0
 ds_write_b64 v35, v[66:67] offset:512
 ds_write_b64 v35, v[68:69] offset:1024
 ds_write_b64 v35, v[70:71] offset:1536
 ds_write_b64 v35, v[72:73] offset:2048
bh_188:
 s_nop 1
 v_cvt_pk_bf16_f32 v244, v192, v193
 v_cvt_pk_bf16_f32 v245, v194, v195
 v_cvt_pk_bf16_f32 v246, v196, v197
 v_cvt_pk_bf16_f32 v247, v198, v199
 v_cvt_pk_bf16_f32 v248, v200, v201
 v_cvt_pk_bf16_f32 v249, v202, v203
 v_cvt_pk_bf16_f32 v250, v204, v205
 v_cvt_pk_bf16_f32 v251, v206, v207
 v_cvt_pk_bf16_f32 v252, v208, v209
 v_cvt_pk_bf16_f32 v253, v210, v211
 buffer_store_dwordx4 v[244:247], v29, s[16:19], s27 offen sc1
 buffer_store_dwordx4 v[248:251], v30, s[16:19], s27 offen sc1
 buffer_store_dwordx2 v[252:253], v31, s[16:19], s27 offen sc1
 s_add_u32 s27, s27, 2048
 s_mov_b64 s[78:79], -1
 s_mov_b64 s[80:81], -1
 s_mov_b64 s[82:83], -1
 s_mov_b64 s[84:85], -1
 s_mov_b64 s[86:87], -1
 s_mov_b64 s[88:89], -1
 s_mov_b64 s[90:91], -1
 s_sub_u32 s26, s26, 1
 s_cmp_gt_u32 s26, 0
 s_waitcnt lgkmcnt(0)
 s_cbranch_scc1 bf_blk_185
 s_waitcnt vmcnt(0) lgkmcnt(0)
 s_barrier
 s_mov_b32 s84, 0
 s_mov_b32 s85, -1
 s_load_dwordx2 s[4:5], s[0:1], 0
 s_load_dwordx2 s[6:7], s[0:1], 16
 s_load_dwordx2 s[38:39], s[0:1], 104
 s_mov_b32 s42, s2
 s_mov_b32 s41, 0
 s_waitcnt lgkmcnt(0)
 s_mov_b32 s8, s4
 s_mov_b32 s9, s5
 s_mov_b32 s10, 2621440
 s_mov_b32 s11, 0x00020000
 s_mov_b32 s12, s6
 s_mov_b32 s13, s7
 s_mov_b32 s14, 7864320
 s_mov_b32 s15, 0x00020000
 s_mov_b32 s16, s38
 s_mov_b32 s17, s39
 s_mov_b32 s18, 50331648
 s_mov_b32 s19, 0x00020000
 s_add_u32 s52, s38, 50331648
 s_addc_u32 s53, s39, 0
 s_mov_b32 s54, 6291456
 s_mov_b32 s55, 0x00020000
 s_add_u32 s56, s38, 85983232
 s_addc_u32 s57, s39, 0
 s_mov_b32 s58, 6815744
 s_mov_b32 s59, 0x00020000
 s_load_dwordx2 s[72:73], s[0:1], 104
 s_waitcnt lgkmcnt(0)
 s_add_u32 s72, s72, 81068032
 s_addc_u32 s73, s73, 0
 s_mov_b32 s74, 128000
 s_mov_b32 s75, 0x00020000
 s_mul_i32 s44, s42, 384
 s_mov_b32 s24, 0
 v_mov_b32 v9, 2731
 s_and_b32 s22, s20, 1
 s_lshl_b32 s22, s22, 2
 v_add_u32 v8, 0, v1
 v_mul_u32_u24 v7, v8, v9
 v_lshrrev_b32 v7, 16, v7
 v_mul_u32_u24 v4, 24, v7
 v_sub_u32 v8, v8, v4
 v_and_b32 v4, 2, v7
 v_xor_b32 v8, v8, v4
 v_xor_b32 v8, s22, v8
 v_xor_b32 v5, 4, v8
 s_mov_b32 s21, 12288
 v_mul_lo_u32 v7, v7, s21
 v_lshl_add_u32 v40, v8, 4, v7
 v_lshl_add_u32 v43, v5, 4, v7
 v_add_u32 v8, 64, v1
 v_mul_u32_u24 v7, v8, v9
 v_lshrrev_b32 v7, 16, v7
 v_mul_u32_u24 v4, 24, v7
 v_sub_u32 v8, v8, v4
 v_and_b32 v4, 2, v7
 v_xor_b32 v8, v8, v4
 v_xor_b32 v8, s22, v8
 v_xor_b32 v5, 4, v8
 s_mov_b32 s21, 12288
 v_mul_lo_u32 v7, v7, s21
 v_lshl_add_u32 v41, v8, 4, v7
 v_lshl_add_u32 v44, v5, 4, v7
 v_add_u32 v8, 128, v1
 v_mul_u32_u24 v7, v8, v9
 v_lshrrev_b32 v7, 16, v7
 v_mul_u32_u24 v4, 24, v7
 v_sub_u32 v8, v8, v4
 v_and_b32 v4, 2, v7
 v_xor_b32 v8, v8, v4
 v_xor_b32 v8, s22, v8
 v_xor_b32 v5, 4, v8
 s_mov_b32 s21, 12288
 v_mul_lo_u32 v7, v7, s21
 v_lshl_add_u32 v42, v8, 4, v7
 v_lshl_add_u32 v45, v5, 4, v7
 s_mul_i32 s23, s20, 491520
 s_add_u32 s23, s23, s44
 s_mul_i32 s22, s20, 15360
 s_add_u32 s22, s22, 98304
 s_add_u32 s21, s23, 0
 s_add_u32 m0, s22, 0
 s_nop 0
 buffer_load_dwordx4 v40, s[12:15], s21 offen lds
 s_add_u32 m0, s22, 1024
 s_nop 0
 buffer_load_dwordx4 v41, s[12:15], s21 offen lds
 s_add_u32 m0, s22, 2048
 s_nop 0
 buffer_load_dwordx4 v42, s[12:15], s21 offen lds
 s_add_u32 s21, s23, 98304
 s_add_u32 m0, s22, 3072
 s_nop 0
 buffer_load_dwordx4 v43, s[12:15], s21 offen lds
 s_add_u32 m0, s22, 4096
 s_nop 0
 buffer_load_dwordx4 v44, s[12:15], s21 offen lds
 s_add_u32 m0, s22, 5120
 s_nop 0
 buffer_load_dwordx4 v45, s[12:15], s21 offen lds
 s_add_u32 s21, s23, 196608
 s_add_u32 m0, s22, 6144
 s_nop 0
 buffer_load_dwordx4 v40, s[12:15], s21 offen lds
 s_add_u32 m0, s22, 7168
 s_nop 0
 buffer_load_dwordx4 v41, s[12:15], s21 offen lds
 s_add_u32 m0, s22, 8192
 s_nop 0
 buffer_load_dwordx4 v42, s[12:15], s21 offen lds
 s_add_u32 s21, s23, 294912
 s_add_u32 m0, s22, 9216
 s_nop 0
 buffer_load_dwordx4 v43, s[12:15], s21 offen lds
 s_add_u32 m0, s22, 10240
 s_nop 0
 buffer_load_dwordx4 v44, s[12:15], s21 offen lds
 s_add_u32 m0, s22, 11264
 s_nop 0
 buffer_load_dwordx4 v45, s[12:15], s21 offen lds
 s_add_u32 s21, s23, 393216
 s_add_u32 m0, s22, 12288
 s_nop 0
 buffer_load_dwordx4 v40, s[12:15], s21 offen lds
 s_add_u32 m0, s22, 13312
 s_nop 0
 buffer_load_dwordx4 v41, s[12:15], s21 offen lds
 s_add_u32 m0, s22, 14336
 s_nop 0
 buffer_load_dwordx4 v42, s[12:15], s21 offen lds
 s_add_u32 s21, s23, 1966080
 buffer_load_dwordx4 v[64:67], v40, s[12:15], s21 offen
 buffer_load_dwordx4 v[68:71], v41, s[12:15], s21 offen
 buffer_load_dwordx4 v[72:75], v42, s[12:15], s21 offen
 s_add_u32 s21, s23, 2064384
 buffer_load_dwordx4 v[76:79], v43, s[12:15], s21 offen
 buffer_load_dwordx4 v[80:83], v44, s[12:15], s21 offen
 buffer_load_dwordx4 v[84:87], v45, s[12:15], s21 offen
 s_add_u32 s21, s23, 2162688
 buffer_load_dwordx4 v[88:91], v40, s[12:15], s21 offen
 buffer_load_dwordx4 v[92:95], v41, s[12:15], s21 offen
 buffer_load_dwordx4 v[96:99], v42, s[12:15], s21 offen
 s_add_u32 s21, s23, 2260992
 buffer_load_dwordx4 v[100:103], v43, s[12:15], s21 offen
 buffer_load_dwordx4 v[104:107], v44, s[12:15], s21 offen
 buffer_load_dwordx4 v[108:111], v45, s[12:15], s21 offen
 s_add_u32 s21, s23, 2359296
 buffer_load_dwordx4 v[112:115], v40, s[12:15], s21 offen
 buffer_load_dwordx4 v[116:119], v41, s[12:15], s21 offen
 buffer_load_dwordx4 v[120:123], v42, s[12:15], s21 offen
 s_add_u32 s21, s23, 3932160
 buffer_load_dwordx4 v[124:127], v40, s[12:15], s21 offen
 buffer_load_dwordx4 v[128:131], v41, s[12:15], s21 offen
 buffer_load_dwordx4 v[132:135], v42, s[12:15], s21 offen
 s_add_u32 s21, s23, 4030464
 buffer_load_dwordx4 v[136:139], v43, s[12:15], s21 offen
 buffer_load_dwordx4 v[140:143], v44, s[12:15], s21 offen
 buffer_load_dwordx4 v[144:147], v45, s[12:15], s21 offen
 s_add_u32 s21, s23, 4128768
 buffer_load_dwordx4 v[148:151], v40, s[12:15], s21 offen
 buffer_load_dwordx4 v[152:155], v41, s[12:15], s21 offen
 buffer_load_dwordx4 v[156:159], v42, s[12:15], s21 offen
 s_add_u32 s21, s23, 4227072
 buffer_load_dwordx4 v[160:163], v43, s[12:15], s21 offen
 buffer_load_dwordx4 v[164:167], v44, s[12:15], s21 offen
 buffer_load_dwordx4 v[168:171], v45, s[12:15], s21 offen
 s_add_u32 s21, s23, 4325376
 buffer_load_dwordx4 v[172:175], v40, s[12:15], s21 offen
 buffer_load_dwordx4 v[176:179], v41, s[12:15], s21 offen
 buffer_load_dwordx4 v[180:183], v42, s[12:15], s21 offen
 s_add_u32 s21, s23, 5898240
 buffer_load_dwordx4 v[184:187], v40, s[12:15], s21 offen
 buffer_load_dwordx4 v[188:191], v41, s[12:15], s21 offen
 buffer_load_dwordx4 v[192:195], v42, s[12:15], s21 offen
 s_add_u32 s21, s23, 5996544
 buffer_load_dwordx4 v[196:199], v43, s[12:15], s21 offen
 buffer_load_dwordx4 v[200:203], v44, s[12:15], s21 offen
 buffer_load_dwordx4 v[204:207], v45, s[12:15], s21 offen
 s_add_u32 s21, s23, 6094848
 buffer_load_dwordx4 v[208:211], v40, s[12:15], s21 offen
 buffer_load_dwordx4 v[212:215], v41, s[12:15], s21 offen
 buffer_load_dwordx4 v[216:219], v42, s[12:15], s21 offen
 s_add_u32 s21, s23, 6193152
 buffer_load_dwordx4 v[220:223], v43, s[12:15], s21 offen
 buffer_load_dwordx4 v[224:227], v44, s[12:15], s21 offen
 buffer_load_dwordx4 v[228:231], v45, s[12:15], s21 offen
 s_add_u32 s21, s23, 6291456
 buffer_load_dwordx4 v[232:235], v40, s[12:15], s21 offen
 buffer_load_dwordx4 v[236:239], v41, s[12:15], s21 offen
 buffer_load_dwordx4 v[240:243], v42, s[12:15], s21 offen
 v_lshl_add_u32 v49, v1, 4, s22
 v_lshrrev_b32 v7, 2, v2
 v_and_b32 v4, 2, v7
 v_and_b32 v5, 1, v3
 v_lshl_or_b32 v4, v5, 2, v4
 v_lshl_add_u32 v7, v3, 3, v7
 v_mul_u32_u24 v7, 384, v7
 v_and_b32 v5, 1, v2
 v_lshl_add_u32 v7, v5, 3, v7
 v_add_u32 v7, 98304, v7
 v_bfe_u32 v8, v2, 1, 1
 s_mul_i32 s21, s20, 6
 v_add_u32 v8, s21, v8
 v_add_u32 v5, 0, v8
 v_xor_b32 v5, v5, v4
 v_lshl_add_u32 v46, v5, 4, v7
 v_add_u32 v5, 2, v8
 v_xor_b32 v5, v5, v4
 v_lshl_add_u32 v47, v5, 4, v7
 v_add_u32 v5, 4, v8
 v_xor_b32 v5, v5, v4
 v_lshl_add_u32 v48, v5, 4, v7
 s_waitcnt vmcnt(45)
 s_barrier
 ds_read_b64_tr_b16 a[0:1], v46 offset:0
 ds_read_b64_tr_b16 a[2:3], v46 offset:1536
 ds_read_b64_tr_b16 a[4:5], v47 offset:0
 ds_read_b64_tr_b16 a[6:7], v47 offset:1536
 ds_read_b64_tr_b16 a[8:9], v48 offset:0
 ds_read_b64_tr_b16 a[10:11], v48 offset:1536
 ds_read_b64_tr_b16 a[12:13], v46 offset:12288
 ds_read_b64_tr_b16 a[14:15], v46 offset:13824
 ds_read_b64_tr_b16 a[16:17], v47 offset:12288
 ds_read_b64_tr_b16 a[18:19], v47 offset:13824
 ds_read_b64_tr_b16 a[20:21], v48 offset:12288
 ds_read_b64_tr_b16 a[22:23], v48 offset:13824
 ds_read_b64_tr_b16 a[24:25], v46 offset:24576
 ds_read_b64_tr_b16 a[26:27], v46 offset:26112
 ds_read_b64_tr_b16 a[28:29], v47 offset:24576
 ds_read_b64_tr_b16 a[30:31], v47 offset:26112
 ds_read_b64_tr_b16 a[32:33], v48 offset:24576
 ds_read_b64_tr_b16 a[34:35], v48 offset:26112
 ds_read_b64_tr_b16 a[36:37], v46 offset:36864
 ds_read_b64_tr_b16 a[38:39], v46 offset:38400
 ds_read_b64_tr_b16 a[40:41], v47 offset:36864
 ds_read_b64_tr_b16 a[42:43], v47 offset:38400
 ds_read_b64_tr_b16 a[44:45], v48 offset:36864
 ds_read_b64_tr_b16 a[46:47], v48 offset:38400
 ds_read_b64_tr_b16 a[48:49], v46 offset:49152
 ds_read_b64_tr_b16 a[50:51], v46 offset:50688
 ds_read_b64_tr_b16 a[52:53], v47 offset:49152
 ds_read_b64_tr_b16 a[54:55], v47 offset:50688
 ds_read_b64_tr_b16 a[56:57], v48 offset:49152
 ds_read_b64_tr_b16 a[58:59], v48 offset:50688
 v_lshrrev_b32 v11, 3, v1
 v_and_b32 v12, 7, v1
 v_xor_b32 v12, v12, v11
 v_mul_u32_u24 v11, 1280, v11
 v_lshl_add_u32 v10, v12, 4, v11
 s_mul_i32 s46, s20, 40960
 v_add_u32 v10, s46, v10
 s_lshl_b32 s47, s20, 12
 s_add_u32 s47, s47, 0
 s_add_u32 s46, s47, 98304
 s_mov_b32 s30, s24
 s_add_u32 s32, s47, 0
 v_add_u32 v11, 9216, v10
 v_add_u32 v12, 18432, v10
 v_add_u32 v13, 27648, v10
 s_mov_b32 m0, s32
 s_nop 0
 buffer_load_dwordx4 v10, s[8:11], s30 offen offset:0 lds
 buffer_load_dwordx4 v11, s[8:11], s30 offen offset:1024 lds
 buffer_load_dwordx4 v12, s[8:11], s30 offen offset:2048 lds
 buffer_load_dwordx4 v13, s[8:11], s30 offen offset:3072 lds
 s_add_u32 s30, s30, 128
 s_add_u32 s32, s32, 16384
 s_cmp_lt_u32 s32, s46
 s_cselect_b32 s32, s32, s47
 s_mov_b32 m0, s32
 s_nop 0
 buffer_load_dwordx4 v10, s[8:11], s30 offen offset:0 lds
 buffer_load_dwordx4 v11, s[8:11], s30 offen offset:1024 lds
 buffer_load_dwordx4 v12, s[8:11], s30 offen offset:2048 lds
 buffer_load_dwordx4 v13, s[8:11], s30 offen offset:3072 lds
 s_add_u32 s30, s30, 128
 s_add_u32 s32, s32, 16384
 s_cmp_lt_u32 s32, s46
 s_cselect_b32 s32, s32, s47
 s_mov_b32 m0, s32
 s_nop 0
 buffer_load_dwordx4 v10, s[8:11], s30 offen offset:0 lds
 buffer_load_dwordx4 v11, s[8:11], s30 offen offset:1024 lds
 buffer_load_dwordx4 v12, s[8:11], s30 offen offset:2048 lds
 buffer_load_dwordx4 v13, s[8:11], s30 offen offset:3072 lds
 s_add_u32 s30, s30, 128
 s_add_u32 s32, s32, 16384
 s_cmp_lt_u32 s32, s46
 s_cselect_b32 s32, s32, s47
 s_mov_b32 m0, s32
 s_nop 0
 buffer_load_dwordx4 v10, s[8:11], s30 offen offset:0 lds
 buffer_load_dwordx4 v11, s[8:11], s30 offen offset:1024 lds
 buffer_load_dwordx4 v12, s[8:11], s30 offen offset:2048 lds
 buffer_load_dwordx4 v13, s[8:11], s30 offen offset:3072 lds
 s_add_u32 s30, s30, 128
 s_add_u32 s32, s32, 16384
 s_cmp_lt_u32 s32, s46
 s_cselect_b32 s32, s32, s47
 s_waitcnt lgkmcnt(0)
 s_barrier
 s_waitcnt vmcnt(46)
 ds_write_b128 v49, v[64:67] offset:0
 ds_write_b128 v49, v[68:71] offset:1024
 ds_write_b128 v49, v[72:75] offset:2048
 ds_write_b128 v49, v[76:79] offset:3072
 ds_write_b128 v49, v[80:83] offset:4096
 ds_write_b128 v49, v[84:87] offset:5120
 ds_write_b128 v49, v[88:91] offset:6144
 ds_write_b128 v49, v[92:95] offset:7168
 ds_write_b128 v49, v[96:99] offset:8192
 ds_write_b128 v49, v[100:103] offset:9216
 ds_write_b128 v49, v[104:107] offset:10240
 ds_write_b128 v49, v[108:111] offset:11264
 ds_write_b128 v49, v[112:115] offset:12288
 ds_write_b128 v49, v[116:119] offset:13312
 ds_write_b128 v49, v[120:123] offset:14336
 s_waitcnt lgkmcnt(0)
 s_barrier
 ds_read_b64_tr_b16 a[60:61], v46 offset:0
 ds_read_b64_tr_b16 a[62:63], v46 offset:1536
 ds_read_b64_tr_b16 a[64:65], v47 offset:0
 ds_read_b64_tr_b16 a[66:67], v47 offset:1536
 ds_read_b64_tr_b16 a[68:69], v48 offset:0
 ds_read_b64_tr_b16 a[70:71], v48 offset:1536
 ds_read_b64_tr_b16 a[72:73], v46 offset:12288
 ds_read_b64_tr_b16 a[74:75], v46 offset:13824
 ds_read_b64_tr_b16 a[76:77], v47 offset:12288
 ds_read_b64_tr_b16 a[78:79], v47 offset:13824
 ds_read_b64_tr_b16 a[80:81], v48 offset:12288
 ds_read_b64_tr_b16 a[82:83], v48 offset:13824
 ds_read_b64_tr_b16 a[84:85], v46 offset:24576
 ds_read_b64_tr_b16 a[86:87], v46 offset:26112
 ds_read_b64_tr_b16 a[88:89], v47 offset:24576
 ds_read_b64_tr_b16 a[90:91], v47 offset:26112
 ds_read_b64_tr_b16 a[92:93], v48 offset:24576
 ds_read_b64_tr_b16 a[94:95], v48 offset:26112
 ds_read_b64_tr_b16 a[96:97], v46 offset:36864
 ds_read_b64_tr_b16 a[98:99], v46 offset:38400
 ds_read_b64_tr_b16 a[100:101], v47 offset:36864
 ds_read_b64_tr_b16 a[102:103], v47 offset:38400
 ds_read_b64_tr_b16 a[104:105], v48 offset:36864
 ds_read_b64_tr_b16 a[106:107], v48 offset:38400
 ds_read_b64_tr_b16 a[108:109], v46 offset:49152
 ds_read_b64_tr_b16 a[110:111], v46 offset:50688
 ds_read_b64_tr_b16 a[112:113], v47 offset:49152
 ds_read_b64_tr_b16 a[114:115], v47 offset:50688
 ds_read_b64_tr_b16 a[116:117], v48 offset:49152
 ds_read_b64_tr_b16 a[118:119], v48 offset:50688
 s_waitcnt lgkmcnt(0)
 s_barrier
 s_waitcnt vmcnt(31)
 ds_write_b128 v49, v[124:127] offset:0
 ds_write_b128 v49, v[128:131] offset:1024
 ds_write_b128 v49, v[132:135] offset:2048
 ds_write_b128 v49, v[136:139] offset:3072
 ds_write_b128 v49, v[140:143] offset:4096
 ds_write_b128 v49, v[144:147] offset:5120
 ds_write_b128 v49, v[148:151] offset:6144
 ds_write_b128 v49, v[152:155] offset:7168
 ds_write_b128 v49, v[156:159] offset:8192
 ds_write_b128 v49, v[160:163] offset:9216
 ds_write_b128 v49, v[164:167] offset:10240
 ds_write_b128 v49, v[168:171] offset:11264
 ds_write_b128 v49, v[172:175] offset:12288
 ds_write_b128 v49, v[176:179] offset:13312
 ds_write_b128 v49, v[180:183] offset:14336
 s_waitcnt lgkmcnt(0)
 s_barrier
 ds_read_b64_tr_b16 a[120:121], v46 offset:0
 ds_read_b64_tr_b16 a[122:123], v46 offset:1536
 ds_read_b64_tr_b16 a[124:125], v47 offset:0
 ds_read_b64_tr_b16 a[126:127], v47 offset:1536
 ds_read_b64_tr_b16 a[128:129], v48 offset:0
 ds_read_b64_tr_b16 a[130:131], v48 offset:1536
 ds_read_b64_tr_b16 a[132:133], v46 offset:12288
 ds_read_b64_tr_b16 a[134:135], v46 offset:13824
 ds_read_b64_tr_b16 a[136:137], v47 offset:12288
 ds_read_b64_tr_b16 a[138:139], v47 offset:13824
 ds_read_b64_tr_b16 a[140:141], v48 offset:12288
 ds_read_b64_tr_b16 a[142:143], v48 offset:13824
 ds_read_b64_tr_b16 a[144:145], v46 offset:24576
 ds_read_b64_tr_b16 a[146:147], v46 offset:26112
 ds_read_b64_tr_b16 a[148:149], v47 offset:24576
 ds_read_b64_tr_b16 a[150:151], v47 offset:26112
 ds_read_b64_tr_b16 a[152:153], v48 offset:24576
 ds_read_b64_tr_b16 a[154:155], v48 offset:26112
 ds_read_b64_tr_b16 a[156:157], v46 offset:36864
 ds_read_b64_tr_b16 a[158:159], v46 offset:38400
 ds_read_b64_tr_b16 a[160:161], v47 offset:36864
 ds_read_b64_tr_b16 a[162:163], v47 offset:38400
 ds_read_b64_tr_b16 a[164:165], v48 offset:36864
 ds_read_b64_tr_b16 a[166:167], v48 offset:38400
 ds_read_b64_tr_b16 a[168:169], v46 offset:49152
 ds_read_b64_tr_b16 a[170:171], v46 offset:50688
 ds_read_b64_tr_b16 a[172:173], v47 offset:49152
 ds_read_b64_tr_b16 a[174:175], v47 offset:50688
 ds_read_b64_tr_b16 a[176:177], v48 offset:49152
 ds_read_b64_tr_b16 a[178:179], v48 offset:50688
 s_waitcnt lgkmcnt(0)
 s_barrier
 s_waitcnt vmcnt(16)
 ds_write_b128 v49, v[184:187] offset:0
 ds_write_b128 v49, v[188:191] offset:1024
 ds_write_b128 v49, v[192:195] offset:2048
 ds_write_b128 v49, v[196:199] offset:3072
 ds_write_b128 v49, v[200:203] offset:4096
 ds_write_b128 v49, v[204:207] offset:5120
 ds_write_b128 v49, v[208:211] offset:6144
 ds_write_b128 v49, v[212:215] offset:7168
 ds_write_b128 v49, v[216:219] offset:8192
 ds_write_b128 v49, v[220:223] offset:9216
 ds_write_b128 v49, v[224:227] offset:10240
 ds_write_b128 v49, v[228:231] offset:11264
 ds_write_b128 v49, v[232:235] offset:12288
 ds_write_b128 v49, v[236:239] offset:13312
 ds_write_b128 v49, v[240:243] offset:14336
 s_waitcnt lgkmcnt(0)
 s_barrier
 ds_read_b64_tr_b16 a[180:181], v46 offset:0
 ds_read_b64_tr_b16 a[182:183], v46 offset:1536
 ds_read_b64_tr_b16 a[184:185], v47 offset:0
 ds_read_b64_tr_b16 a[186:187], v47 offset:1536
 ds_read_b64_tr_b16 a[188:189], v48 offset:0
 ds_read_b64_tr_b16 a[190:191], v48 offset:1536
 ds_read_b64_tr_b16 a[192:193], v46 offset:12288
 ds_read_b64_tr_b16 a[194:195], v46 offset:13824
 ds_read_b64_tr_b16 a[196:197], v47 offset:12288
 ds_read_b64_tr_b16 a[198:199], v47 offset:13824
 ds_read_b64_tr_b16 a[200:201], v48 offset:12288
 ds_read_b64_tr_b16 a[202:203], v48 offset:13824
 ds_read_b64_tr_b16 a[204:205], v46 offset:24576
 ds_read_b64_tr_b16 a[206:207], v46 offset:26112
 ds_read_b64_tr_b16 a[208:209], v47 offset:24576
 ds_read_b64_tr_b16 a[210:211], v47 offset:26112
 ds_read_b64_tr_b16 a[212:213], v48 offset:24576
 ds_read_b64_tr_b16 a[214:215], v48 offset:26112
 ds_read_b64_tr_b16 a[216:217], v46 offset:36864
 ds_read_b64_tr_b16 a[218:219], v46 offset:38400
 ds_read_b64_tr_b16 a[220:221], v47 offset:36864
 ds_read_b64_tr_b16 a[222:223], v47 offset:38400
 ds_read_b64_tr_b16 a[224:225], v48 offset:36864
 ds_read_b64_tr_b16 a[226:227], v48 offset:38400
 ds_read_b64_tr_b16 a[228:229], v46 offset:49152
 ds_read_b64_tr_b16 a[230:231], v46 offset:50688
 ds_read_b64_tr_b16 a[232:233], v47 offset:49152
 ds_read_b64_tr_b16 a[234:235], v47 offset:50688
 ds_read_b64_tr_b16 a[236:237], v48 offset:49152
 ds_read_b64_tr_b16 a[238:239], v48 offset:50688
 s_waitcnt lgkmcnt(0)
 s_barrier
 v_readfirstlane_b32 s21, v32
 s_cmp_ge_u32 s21, 32
 s_cbranch_scc1 bt_189
 s_mov_b32 s21, 76
 v_mov_b32 v4, 0
 s_mov_b32 s101, 0
wf_190:
 buffer_load_dword v5, v4, s[64:67], s21 offen sc1
 s_add_u32 s101, s101, 1
 s_cmp_gt_u32 s101, 131072
 s_cbranch_scc1 main_end
 s_waitcnt vmcnt(0)
 v_readfirstlane_b32 s100, v5
 s_cmp_ge_u32 s100, 32
 s_cbranch_scc1 wf_191
 s_sleep 8
 s_branch wf_190
wf_191:
bt_189:
 s_mov_b32 s21, 90112
 s_cmp_lg_u32 s20, 0
 s_cbranch_scc1 af_192
 v_mov_b32 v4, 0
 v_mov_b32 v5, 1
 s_mov_b64 exec, 1
 buffer_atomic_add v5, v4, s[72:75], s21 offen sc1
 s_mov_b64 exec, -1
 s_nop 1
af_192:
 s_mul_i32 s21, s20, 12800
 s_add_u32 s21, s21, 98304
 v_mul_u32_u24 v4, 400, v2
 v_lshlrev_b32 v5, 4, v3
 v_add3_u32 v29, v4, v5, s21
 v_lshlrev_b32 v30, 4, v1
 v_and_b32 v4, 1, v2
 v_bfe_u32 v5, v2, 1, 1
 v_lshl_or_b32 v4, v5, 2, v4
 v_bfe_u32 v5, v2, 2, 1
 v_lshl_or_b32 v4, v5, 1, v4
 v_lshlrev_b32 v4, 4, v4
 v_lshl_add_u32 v31, v3, 7, v4
 v_lshlrev_b32 v32, 3, v1
 v_and_b32 v4, 3, v1
 v_lshlrev_b32 v33, 3, v4
 v_mov_b32 v34, 0xf149f2ca
 v_lshlrev_b32 v4, 2, v3
 v_sub_u32 v35, v2, v4
 v_cmp_gt_u32 s[60:61], 2, v3
 s_mov_b32 s62, 0x3d93cd3a
 s_mov_b32 s63, 0x3fb8aa3b
 s_mov_b32 s83, 0x3dd53b95
 v_cmp_le_i32 s[64:65], 0, v35
 v_cmp_le_i32 s[66:67], 1, v35
 v_cmp_le_i32 s[68:69], 2, v35
 v_cmp_le_i32 s[70:71], 3, v35
 s_mov_b32 s24, 0
 s_mov_b32 s25, 163840
 s_mov_b32 s26, 14
 s_lshl_b32 s49, s41, 2
 s_add_u32 s49, s49, s20
 s_mov_b32 s29, 4
 s_mov_b32 s78, 0
 s_mov_b32 s81, 0x80000000
 s_mov_b32 s82, 0
 s_mul_i32 s21, s49, 393216
 s_mul_i32 s22, s42, 12288
 s_add_u32 s50, s21, s22
 s_mul_i32 s21, s49, 98304
 s_mul_i32 s22, s42, 3072
 s_add_u32 s51, s21, s22
 s_lshr_b32 s22, s49, 1
 s_lshr_b32 s21, s49, 2
 s_add_u32 s21, s21, 2
 s_cmp_lt_u32 s49, 8
 s_cselect_b32 s21, s22, s21
 s_lshl_b32 s21, s21, 3
 s_lshr_b32 s22, s42, 2
 s_add_u32 s21, s21, s22
 s_lshl_b32 s21, s21, 7
 s_add_u32 s76, s21, 0
 s_lshl_b32 s77, s42, 7
 s_add_u32 s77, s77, 18432
 v_mov_b32 v21, 0
 buffer_load_dword v21, v33, s[72:75], s77 offen sc1
 v_and_b32 v6, 7, v2
 v_add_u32 v4, 0, v3
 v_xor_b32 v4, v4, v6
 v_lshlrev_b32 v4, 4, v4
 v_lshl_add_u32 v14, v2, 7, v4
 v_add_u32 v4, 4, v3
 v_xor_b32 v4, v4, v6
 v_lshlrev_b32 v4, 4, v4
 v_lshl_add_u32 v15, v2, 7, v4
 v_mul_u32_u24 v22, 400, v2
 v_mul_u32_u24 v4, 16, v3
 s_mul_i32 s21, s20, 96
 s_add_u32 s21, s21, 98304
 v_add3_u32 v22, v22, v4, s21
 v_lshlrev_b32 v4, 3, v3
 v_sub_u32 v16, v22, v4
 v_mov_b32 v9, 2731
 s_mov_b32 s33, 0
 s_mov_b32 s48, 0x80000000
 s_mov_b32 m0, s32
 s_nop 0
 buffer_load_dwordx4 v10, s[8:11], s30 offen offset:0 lds
 buffer_load_dwordx4 v11, s[8:11], s30 offen offset:1024 lds
 s_waitcnt vmcnt(14)
 s_barrier
 v_add_u32 v18, s33, v14
 v_add_u32 v19, s33, v15
 s_add_u32 s33, s33, 16384
 s_cmp_lt_u32 s33, 98304
 s_cselect_b32 s33, s33, 0
 ds_read_b128 v[160:163], v18 offset:0
 ds_read_b128 v[164:167], v18 offset:2048
 ds_read_b128 v[168:171], v18 offset:4096
 ds_read_b128 v[172:175], v18 offset:6144
 ds_read_b128 v[176:179], v18 offset:8192
 ds_read_b128 v[180:183], v18 offset:10240
 ds_read_b128 v[184:187], v18 offset:12288
 ds_read_b128 v[188:191], v18 offset:14336
 s_waitcnt lgkmcnt(0)
qa_blk_194:
 v_mfma_f32_16x16x32_bf16 v[64:67], a[0:3], v[160:163], 0
 ds_read_b128 v[192:195], v19 offset:0
 v_mfma_f32_16x16x32_bf16 v[68:71], a[4:7], v[160:163], 0
 v_add_u32 v18, s33, v14
 v_cndmask_b32 v36, v34, v36, s[64:65]
 v_mfma_f32_16x16x32_bf16 v[72:75], a[8:11], v[160:163], 0
 v_cndmask_b32 v48, v34, v48, s[64:65]
 v_cndmask_b32 v37, v34, v37, s[66:67]
 v_mfma_f32_16x16x32_bf16 v[76:79], a[0:3], v[164:167], 0
 ds_read_b128 v[196:199], v19 offset:2048
 v_cndmask_b32 v49, v34, v49, s[66:67]
 v_mfma_f32_16x16x32_bf16 v[80:83], a[4:7], v[164:167], 0
 buffer_load_dwordx4 v12, s[8:11], s30 offen offset:2048 lds
 v_mfma_f32_16x16x32_bf16 v[84:87], a[8:11], v[164:167], 0
 v_cndmask_b32 v38, v34, v38, s[68:69]
 v_cndmask_b32 v50, v34, v50, s[68:69]
 v_mfma_f32_16x16x32_bf16 v[88:91], a[0:3], v[168:171], 0
 ds_read_b128 v[200:203], v19 offset:4096
 v_cndmask_b32 v39, v34, v39, s[70:71]
 v_mfma_f32_16x16x32_bf16 v[92:95], a[4:7], v[168:171], 0
 v_cndmask_b32 v51, v34, v51, s[70:71]
 v_max3_f32 v56, v36, v37, v38
 v_mfma_f32_16x16x32_bf16 v[96:99], a[8:11], v[168:171], 0
 v_max3_f32 v56, v56, v39, v40
 v_max3_f32 v56, v56, v41, v42
 v_mfma_f32_16x16x32_bf16 v[100:103], a[0:3], v[172:175], 0
 ds_read_b128 v[204:207], v19 offset:6144
 v_max_f32 v56, v56, v43
 v_mfma_f32_16x16x32_bf16 v[104:107], a[4:7], v[172:175], 0
 v_mov_b32 v57, v56
 v_mfma_f32_16x16x32_bf16 v[108:111], a[8:11], v[172:175], 0
 s_waitcnt lgkmcnt(15)
 v_mfma_f32_16x16x32_bf16 v[112:115], a[0:3], v[176:179], 0
 ds_read_b128 v[208:211], v19 offset:8192
 v_mfma_f32_16x16x32_bf16 v[116:119], a[4:7], v[176:179], 0
 s_nop 1
 v_mfma_f32_16x16x32_bf16 v[120:123], a[8:11], v[176:179], 0
 v_permlane32_swap_b32 v56, v57
 v_mfma_f32_16x16x32_bf16 v[124:127], a[0:3], v[180:183], 0
 ds_read_b128 v[212:215], v19 offset:10240
 v_max_f32 v56, v56, v57
 v_mfma_f32_16x16x32_bf16 v[128:131], a[4:7], v[180:183], 0
 buffer_load_dwordx4 v13, s[8:11], s30 offen offset:3072 lds
 v_mfma_f32_16x16x32_bf16 v[132:135], a[8:11], v[180:183], 0
 s_add_u32 s30, s30, 128
 s_add_u32 m0, m0, 16384
 v_mfma_f32_16x16x32_bf16 v[136:139], a[0:3], v[184:187], 0
 ds_read_b128 v[216:219], v19 offset:12288
 v_mov_b32 v57, v56
 v_mfma_f32_16x16x32_bf16 v[140:143], a[4:7], v[184:187], 0
 s_cmp_lt_u32 m0, s46
 s_cselect_b32 m0, m0, s47
 v_mfma_f32_16x16x32_bf16 v[144:147], a[8:11], v[184:187], 0
 s_nop 1
 v_mfma_f32_16x16x32_bf16 v[148:151], a[0:3], v[188:191], 0
 ds_read_b128 v[220:223], v19 offset:14336
 v_mfma_f32_16x16x32_bf16 v[152:155], a[4:7], v[188:191], 0
 v_permlane16_swap_b32 v56, v57
 v_mfma_f32_16x16x32_bf16 v[156:159], a[8:11], v[188:191], 0
 s_waitcnt vmcnt(12) lgkmcnt(4)
 s_barrier
 v_mfma_f32_16x16x32_bf16 v[64:67], a[12:15], v[192:195], v[64:67]
 ds_read_b128 v[160:163], v18 offset:0
 v_max_f32 v56, v56, v57
 v_mfma_f32_16x16x32_bf16 v[68:71], a[16:19], v[192:195], v[68:71]
 v_mul_f32 v56, s83, v56
 v_fma_f32 v36, v36, s83, -v56
 v_mfma_f32_16x16x32_bf16 v[72:75], a[20:23], v[192:195], v[72:75]
 v_add_u32 v19, s33, v15
 s_add_u32 s33, s33, 16384
 v_mfma_f32_16x16x32_bf16 v[76:79], a[12:15], v[196:199], v[76:79]
 ds_read_b128 v[164:167], v18 offset:2048
 s_mul_i32 s21, s49, 393216
 v_mfma_f32_16x16x32_bf16 v[80:83], a[16:19], v[196:199], v[80:83]
 buffer_load_dwordx4 v10, s[8:11], s30 offen offset:0 lds
 v_mfma_f32_16x16x32_bf16 v[84:87], a[20:23], v[196:199], v[84:87]
 s_cmp_lt_u32 s33, 98304
 s_cselect_b32 s33, s33, 0
 v_mfma_f32_16x16x32_bf16 v[88:91], a[12:15], v[200:203], v[88:91]
 ds_read_b128 v[168:171], v18 offset:4096
 s_mul_i32 s22, s42, 12288
 v_mfma_f32_16x16x32_bf16 v[92:95], a[16:19], v[200:203], v[92:95]
 s_add_u32 s50, s21, s22
 s_lshr_b32 s51, s50, 2
 v_mfma_f32_16x16x32_bf16 v[96:99], a[20:23], v[200:203], v[96:99]
 s_add_u32 s23, s49, 1
 v_cmp_gt_u32 vcc, s23, v21
 v_mfma_f32_16x16x32_bf16 v[100:103], a[12:15], v[204:207], v[100:103]
 ds_read_b128 v[172:175], v18 offset:6144
 v_fma_f32 v37, v37, s83, -v56
 v_mfma_f32_16x16x32_bf16 v[104:107], a[16:19], v[204:207], v[104:107]
 s_cmp_eq_u64 vcc, 0
 s_cselect_b32 s80, 1, 0
 v_mfma_f32_16x16x32_bf16 v[108:111], a[20:23], v[204:207], v[108:111]
 s_waitcnt lgkmcnt(4)
 s_lshl_b32 s79, s80, 3
 v_mfma_f32_16x16x32_bf16 v[112:115], a[12:15], v[208:211], v[112:115]
 ds_read_b128 v[176:179], v18 offset:8192
 v_fma_f32 v38, v38, s83, -v56
 v_mfma_f32_16x16x32_bf16 v[116:119], a[16:19], v[208:211], v[116:119]
 buffer_load_dwordx4 a[240:243], v31, s[52:55], s51 offen offset:0 sc1
 v_mfma_f32_16x16x32_bf16 v[120:123], a[20:23], v[208:211], v[120:123]
 v_fma_f32 v39, v39, s83, -v56
 v_fma_f32 v40, v40, s83, -v56
 v_mfma_f32_16x16x32_bf16 v[124:127], a[12:15], v[212:215], v[124:127]
 ds_read_b128 v[180:183], v18 offset:10240
 v_fma_f32 v41, v41, s83, -v56
 v_mfma_f32_16x16x32_bf16 v[128:131], a[16:19], v[212:215], v[128:131]
 buffer_load_dwordx4 v11, s[8:11], s30 offen offset:1024 lds
 v_mfma_f32_16x16x32_bf16 v[132:135], a[20:23], v[212:215], v[132:135]
 v_fma_f32 v42, v42, s83, -v56
 v_fma_f32 v43, v43, s83, -v56
 v_mfma_f32_16x16x32_bf16 v[136:139], a[12:15], v[216:219], v[136:139]
 ds_read_b128 v[184:187], v18 offset:12288
 v_mfma_f32_16x16x32_bf16 v[140:143], a[16:19], v[216:219], v[140:143]
 v_exp_f32 v36, v36
 v_mfma_f32_16x16x32_bf16 v[144:147], a[20:23], v[216:219], v[144:147]
 v_exp_f32 v37, v37
 v_mfma_f32_16x16x32_bf16 v[148:151], a[12:15], v[220:223], v[148:151]
 ds_read_b128 v[188:191], v18 offset:14336
 v_mfma_f32_16x16x32_bf16 v[152:155], a[16:19], v[220:223], v[152:155]
 v_exp_f32 v38, v38
 v_mfma_f32_16x16x32_bf16 v[156:159], a[20:23], v[220:223], v[156:159]
 s_waitcnt lgkmcnt(4)
 v_mfma_f32_16x16x32_bf16 v[64:67], a[24:27], v[160:163], v[64:67]
 ds_read_b128 v[192:195], v19 offset:0
 v_mfma_f32_16x16x32_bf16 v[68:71], a[28:31], v[160:163], v[68:71]
 v_add_u32 v18, s33, v14
 v_mfma_f32_16x16x32_bf16 v[72:75], a[32:35], v[160:163], v[72:75]
 v_exp_f32 v39, v39
 v_mfma_f32_16x16x32_bf16 v[76:79], a[24:27], v[164:167], v[76:79]
 ds_read_b128 v[196:199], v19 offset:2048
 v_mfma_f32_16x16x32_bf16 v[80:83], a[28:31], v[164:167], v[80:83]
 buffer_load_dwordx4 v12, s[8:11], s30 offen offset:2048 lds
 v_mfma_f32_16x16x32_bf16 v[84:87], a[32:35], v[164:167], v[84:87]
 v_exp_f32 v40, v40
 v_mfma_f32_16x16x32_bf16 v[88:91], a[24:27], v[168:171], v[88:91]
 ds_read_b128 v[200:203], v19 offset:4096
 v_mfma_f32_16x16x32_bf16 v[92:95], a[28:31], v[168:171], v[92:95]
 v_exp_f32 v41, v41
 v_mfma_f32_16x16x32_bf16 v[96:99], a[32:35], v[168:171], v[96:99]
 v_exp_f32 v42, v42
 v_mfma_f32_16x16x32_bf16 v[100:103], a[24:27], v[172:175], v[100:103]
 ds_read_b128 v[204:207], v19 offset:6144
 v_mfma_f32_16x16x32_bf16 v[104:107], a[28:31], v[172:175], v[104:107]
 buffer_load_dwordx4 a[244:247], v31, s[52:55], s51 offen offset:512 sc1
 v_mfma_f32_16x16x32_bf16 v[108:111], a[32:35], v[172:175], v[108:111]
 s_waitcnt lgkmcnt(4)
 v_mfma_f32_16x16x32_bf16 v[112:115], a[24:27], v[176:179], v[112:115]
 ds_read_b128 v[208:211], v19 offset:8192
 v_mfma_f32_16x16x32_bf16 v[116:119], a[28:31], v[176:179], v[116:119]
 v_exp_f32 v43, v43
 v_mfma_f32_16x16x32_bf16 v[120:123], a[32:35], v[176:179], v[120:123]
 s_nop 0
 v_add_f32 v56, v40, v41
 v_mfma_f32_16x16x32_bf16 v[124:127], a[24:27], v[180:183], v[124:127]
 ds_read_b128 v[212:215], v19 offset:10240
 v_add_f32 v56, v56, v42
 v_mfma_f32_16x16x32_bf16 v[128:131], a[28:31], v[180:183], v[128:131]
 buffer_load_dwordx4 v13, s[8:11], s30 offen offset:3072 lds
 v_mfma_f32_16x16x32_bf16 v[132:135], a[32:35], v[180:183], v[132:135]
 s_add_u32 s30, s30, 128
 s_add_u32 m0, m0, 16384
 v_mfma_f32_16x16x32_bf16 v[136:139], a[24:27], v[184:187], v[136:139]
 ds_read_b128 v[216:219], v19 offset:12288
 v_add_f32 v56, v56, v43
 v_mfma_f32_16x16x32_bf16 v[140:143], a[28:31], v[184:187], v[140:143]
 s_cmp_lt_u32 m0, s46
 s_cselect_b32 m0, m0, s47
 v_mfma_f32_16x16x32_bf16 v[144:147], a[32:35], v[184:187], v[144:147]
 v_cndmask_b32 v56, 0, v56, s[60:61]
 v_add_f32 v56, v56, v36
 v_mfma_f32_16x16x32_bf16 v[148:151], a[24:27], v[188:191], v[148:151]
 ds_read_b128 v[220:223], v19 offset:14336
 v_add_f32 v56, v56, v37
 v_mfma_f32_16x16x32_bf16 v[152:155], a[28:31], v[188:191], v[152:155]
 v_add_f32 v56, v56, v38
 v_add_f32 v56, v56, v39
 v_mfma_f32_16x16x32_bf16 v[156:159], a[32:35], v[188:191], v[156:159]
 s_waitcnt vmcnt(14) lgkmcnt(4)
 s_barrier
 v_mfma_f32_16x16x32_bf16 v[64:67], a[36:39], v[192:195], v[64:67]
 ds_read_b128 v[160:163], v18 offset:0
 v_mov_b32 v57, v56
 v_mfma_f32_16x16x32_bf16 v[68:71], a[40:43], v[192:195], v[68:71]
 s_nop 1
 v_mfma_f32_16x16x32_bf16 v[72:75], a[44:47], v[192:195], v[72:75]
 v_add_u32 v19, s33, v15
 s_add_u32 s33, s33, 16384
 v_mfma_f32_16x16x32_bf16 v[76:79], a[36:39], v[196:199], v[76:79]
 ds_read_b128 v[164:167], v18 offset:2048
 v_mfma_f32_16x16x32_bf16 v[80:83], a[40:43], v[196:199], v[80:83]
 buffer_load_dwordx4 v10, s[8:11], s30 offen offset:0 lds
 v_mfma_f32_16x16x32_bf16 v[84:87], a[44:47], v[196:199], v[84:87]
 s_cmp_lt_u32 s33, 98304
 s_cselect_b32 s33, s33, 0
 v_mfma_f32_16x16x32_bf16 v[88:91], a[36:39], v[200:203], v[88:91]
 ds_read_b128 v[168:171], v18 offset:4096
 v_mfma_f32_16x16x32_bf16 v[92:95], a[40:43], v[200:203], v[92:95]
 buffer_load_dwordx4 a[248:251], v31, s[52:55], s51 offen offset:1024 sc1
 v_mfma_f32_16x16x32_bf16 v[96:99], a[44:47], v[200:203], v[96:99]
 v_permlane32_swap_b32 v56, v57
 v_mfma_f32_16x16x32_bf16 v[100:103], a[36:39], v[204:207], v[100:103]
 ds_read_b128 v[172:175], v18 offset:6144
 v_add_f32 v56, v56, v57
 v_mfma_f32_16x16x32_bf16 v[104:107], a[40:43], v[204:207], v[104:107]
 v_mov_b32 v57, v56
 v_mfma_f32_16x16x32_bf16 v[108:111], a[44:47], v[204:207], v[108:111]
 s_waitcnt lgkmcnt(4)
 v_mfma_f32_16x16x32_bf16 v[112:115], a[36:39], v[208:211], v[112:115]
 ds_read_b128 v[176:179], v18 offset:8192
 v_mfma_f32_16x16x32_bf16 v[116:119], a[40:43], v[208:211], v[116:119]
 s_nop 1
 v_mfma_f32_16x16x32_bf16 v[120:123], a[44:47], v[208:211], v[120:123]
 v_permlane16_swap_b32 v56, v57
 v_mfma_f32_16x16x32_bf16 v[124:127], a[36:39], v[212:215], v[124:127]
 ds_read_b128 v[180:183], v18 offset:10240
 v_add_f32 v56, v56, v57
 v_mfma_f32_16x16x32_bf16 v[128:131], a[40:43], v[212:215], v[128:131]
 buffer_load_dwordx4 v11, s[8:11], s30 offen offset:1024 lds
 v_mfma_f32_16x16x32_bf16 v[132:135], a[44:47], v[212:215], v[132:135]
 v_rcp_f32 v56, v56
 v_mfma_f32_16x16x32_bf16 v[136:139], a[36:39], v[216:219], v[136:139]
 ds_read_b128 v[184:187], v18 offset:12288
 s_nop 0
 v_mfma_f32_16x16x32_bf16 v[140:143], a[40:43], v[216:219], v[140:143]
 v_mul_f32 v36, v36, v56
 v_mul_f32 v37, v37, v56
 v_mfma_f32_16x16x32_bf16 v[144:147], a[44:47], v[216:219], v[144:147]
 v_mul_f32 v38, v38, v56
 v_mul_f32 v39, v39, v56
 v_mfma_f32_16x16x32_bf16 v[148:151], a[36:39], v[220:223], v[148:151]
 ds_read_b128 v[188:191], v18 offset:14336
 v_mul_f32 v40, v40, v56
 v_mfma_f32_16x16x32_bf16 v[152:155], a[40:43], v[220:223], v[152:155]
 v_mul_f32 v41, v41, v56
 v_mul_f32 v42, v42, v56
 v_mfma_f32_16x16x32_bf16 v[156:159], a[44:47], v[220:223], v[156:159]
 s_waitcnt lgkmcnt(4)
 v_mul_f32 v43, v43, v56
 v_mfma_f32_16x16x32_bf16 v[64:67], a[48:51], v[160:163], v[64:67]
 ds_read_b128 v[192:195], v19 offset:0
 v_max3_f32 v56, v44, v45, v46
 v_mfma_f32_16x16x32_bf16 v[68:71], a[52:55], v[160:163], v[68:71]
 v_add_u32 v18, s33, v14
 v_max3_f32 v56, v56, v47, v48
 v_mfma_f32_16x16x32_bf16 v[72:75], a[56:59], v[160:163], v[72:75]
 v_max3_f32 v56, v56, v49, v50
 v_max3_f32 v56, v56, v51, v52
 v_mfma_f32_16x16x32_bf16 v[76:79], a[48:51], v[164:167], v[76:79]
 ds_read_b128 v[196:199], v19 offset:2048
 v_max3_f32 v56, v56, v53, v54
 v_mfma_f32_16x16x32_bf16 v[80:83], a[52:55], v[164:167], v[80:83]
 buffer_load_dwordx4 v12, s[8:11], s30 offen offset:2048 lds
 v_mfma_f32_16x16x32_bf16 v[84:87], a[56:59], v[164:167], v[84:87]
 buffer_load_dwordx4 a[252:255], v31, s[52:55], s51 offen offset:1536 sc1
 v_mfma_f32_16x16x32_bf16 v[88:91], a[48:51], v[168:171], v[88:91]
 ds_read_b128 v[200:203], v19 offset:4096
 v_max_f32 v56, v56, v55
 v_mfma_f32_16x16x32_bf16 v[92:95], a[52:55], v[168:171], v[92:95]
 v_mov_b32 v57, v56
 v_mfma_f32_16x16x32_bf16 v[96:99], a[56:59], v[168:171], v[96:99]
 s_nop 1
 v_mfma_f32_16x16x32_bf16 v[100:103], a[48:51], v[172:175], v[100:103]
 ds_read_b128 v[204:207], v19 offset:6144
 v_mfma_f32_16x16x32_bf16 v[104:107], a[52:55], v[172:175], v[104:107]
 v_permlane32_swap_b32 v56, v57
 v_mfma_f32_16x16x32_bf16 v[108:111], a[56:59], v[172:175], v[108:111]
 s_waitcnt lgkmcnt(4)
 v_max_f32 v56, v56, v57
 v_mfma_f32_16x16x32_bf16 v[112:115], a[48:51], v[176:179], v[112:115]
 ds_read_b128 v[208:211], v19 offset:8192
 v_mov_b32 v57, v56
 v_mfma_f32_16x16x32_bf16 v[116:119], a[52:55], v[176:179], v[116:119]
 s_nop 1
 v_mfma_f32_16x16x32_bf16 v[120:123], a[56:59], v[176:179], v[120:123]
 v_permlane16_swap_b32 v56, v57
 v_mfma_f32_16x16x32_bf16 v[124:127], a[48:51], v[180:183], v[124:127]
 ds_read_b128 v[212:215], v19 offset:10240
 v_max_f32 v56, v56, v57
 v_mfma_f32_16x16x32_bf16 v[128:131], a[52:55], v[180:183], v[128:131]
 buffer_load_dwordx4 v13, s[8:11], s30 offen offset:3072 lds
 v_mfma_f32_16x16x32_bf16 v[132:135], a[56:59], v[180:183], v[132:135]
 s_add_u32 s30, s30, 128
 s_add_u32 m0, m0, 16384
 v_mfma_f32_16x16x32_bf16 v[136:139], a[48:51], v[184:187], v[136:139]
 ds_read_b128 v[216:219], v19 offset:12288
 v_mul_f32 v56, s83, v56
 v_mfma_f32_16x16x32_bf16 v[140:143], a[52:55], v[184:187], v[140:143]
 s_cmp_lt_u32 m0, s46
 s_cselect_b32 m0, m0, s47
 v_mfma_f32_16x16x32_bf16 v[144:147], a[56:59], v[184:187], v[144:147]
 v_fma_f32 v44, v44, s83, -v56
 v_fma_f32 v45, v45, s83, -v56
 v_mfma_f32_16x16x32_bf16 v[148:151], a[48:51], v[188:191], v[148:151]
 ds_read_b128 v[220:223], v19 offset:14336
 v_fma_f32 v46, v46, s83, -v56
 v_mfma_f32_16x16x32_bf16 v[152:155], a[52:55], v[188:191], v[152:155]
 v_fma_f32 v47, v47, s83, -v56
 v_fma_f32 v48, v48, s83, -v56
 v_mfma_f32_16x16x32_bf16 v[156:159], a[56:59], v[188:191], v[156:159]
 s_waitcnt vmcnt(16) lgkmcnt(4)
 s_barrier
 v_mfma_f32_16x16x32_bf16 v[64:67], a[60:63], v[192:195], v[64:67]
 ds_read_b128 v[160:163], v18 offset:0
 v_fma_f32 v49, v49, s83, -v56
 v_mfma_f32_16x16x32_bf16 v[68:71], a[64:67], v[192:195], v[68:71]
 buffer_load_dwordx4 v[24:27], v31, s[52:55], s51 offen offset:2048 sc1
 v_mfma_f32_16x16x32_bf16 v[72:75], a[68:71], v[192:195], v[72:75]
 v_add_u32 v19, s33, v15
 s_add_u32 s33, s33, 16384
 v_mfma_f32_16x16x32_bf16 v[76:79], a[60:63], v[196:199], v[76:79]
 ds_read_b128 v[164:167], v18 offset:2048
 v_fma_f32 v50, v50, s83, -v56
 v_mfma_f32_16x16x32_bf16 v[80:83], a[64:67], v[196:199], v[80:83]
 buffer_load_dwordx4 v10, s[8:11], s30 offen offset:0 lds
 v_mfma_f32_16x16x32_bf16 v[84:87], a[68:71], v[196:199], v[84:87]
 s_cmp_lt_u32 s33, 98304
 s_cselect_b32 s33, s33, 0
 v_mfma_f32_16x16x32_bf16 v[88:91], a[60:63], v[200:203], v[88:91]
 ds_read_b128 v[168:171], v18 offset:4096
 v_fma_f32 v51, v51, s83, -v56
 v_mfma_f32_16x16x32_bf16 v[92:95], a[64:67], v[200:203], v[92:95]
 v_fma_f32 v52, v52, s83, -v56
 v_fma_f32 v53, v53, s83, -v56
 v_mfma_f32_16x16x32_bf16 v[96:99], a[68:71], v[200:203], v[96:99]
 v_fma_f32 v54, v54, s83, -v56
 v_fma_f32 v55, v55, s83, -v56
 v_mfma_f32_16x16x32_bf16 v[100:103], a[60:63], v[204:207], v[100:103]
 ds_read_b128 v[172:175], v18 offset:6144
 v_mfma_f32_16x16x32_bf16 v[104:107], a[64:67], v[204:207], v[104:107]
 v_exp_f32 v44, v44
 v_mfma_f32_16x16x32_bf16 v[108:111], a[68:71], v[204:207], v[108:111]
 s_waitcnt lgkmcnt(4)
 v_mfma_f32_16x16x32_bf16 v[112:115], a[60:63], v[208:211], v[112:115]
 ds_read_b128 v[176:179], v18 offset:8192
 v_mfma_f32_16x16x32_bf16 v[116:119], a[64:67], v[208:211], v[116:119]
 v_exp_f32 v45, v45
 v_mfma_f32_16x16x32_bf16 v[120:123], a[68:71], v[208:211], v[120:123]
 v_exp_f32 v46, v46
 v_mfma_f32_16x16x32_bf16 v[124:127], a[60:63], v[212:215], v[124:127]
 ds_read_b128 v[180:183], v18 offset:10240
 v_mfma_f32_16x16x32_bf16 v[128:131], a[64:67], v[212:215], v[128:131]
 buffer_load_dwordx4 v11, s[8:11], s30 offen offset:1024 lds
 v_mfma_f32_16x16x32_bf16 v[132:135], a[68:71], v[212:215], v[132:135]
 v_exp_f32 v47, v47
 v_mfma_f32_16x16x32_bf16 v[136:139], a[60:63], v[216:219], v[136:139]
 ds_read_b128 v[184:187], v18 offset:12288
 v_mfma_f32_16x16x32_bf16 v[140:143], a[64:67], v[216:219], v[140:143]
 v_exp_f32 v48, v48
 v_mfma_f32_16x16x32_bf16 v[144:147], a[68:71], v[216:219], v[144:147]
 v_exp_f32 v49, v49
 v_mfma_f32_16x16x32_bf16 v[148:151], a[60:63], v[220:223], v[148:151]
 ds_read_b128 v[188:191], v18 offset:14336
 v_mfma_f32_16x16x32_bf16 v[152:155], a[64:67], v[220:223], v[152:155]
 buffer_load_dwordx4 v[6:9], v31, s[52:55], s51 offen offset:2560 sc1
 v_mfma_f32_16x16x32_bf16 v[156:159], a[68:71], v[220:223], v[156:159]
 s_waitcnt lgkmcnt(4)
 v_mfma_f32_16x16x32_bf16 v[64:67], a[72:75], v[160:163], v[64:67]
 ds_read_b128 v[192:195], v19 offset:0
 v_mfma_f32_16x16x32_bf16 v[68:71], a[76:79], v[160:163], v[68:71]
 v_add_u32 v18, s33, v14
 v_mfma_f32_16x16x32_bf16 v[72:75], a[80:83], v[160:163], v[72:75]
 v_exp_f32 v50, v50
 v_mfma_f32_16x16x32_bf16 v[76:79], a[72:75], v[164:167], v[76:79]
 ds_read_b128 v[196:199], v19 offset:2048
 v_mfma_f32_16x16x32_bf16 v[80:83], a[76:79], v[164:167], v[80:83]
 buffer_load_dwordx4 v12, s[8:11], s30 offen offset:2048 lds
 v_mfma_f32_16x16x32_bf16 v[84:87], a[80:83], v[164:167], v[84:87]
 v_exp_f32 v51, v51
 v_mfma_f32_16x16x32_bf16 v[88:91], a[72:75], v[168:171], v[88:91]
 ds_read_b128 v[200:203], v19 offset:4096
 v_mfma_f32_16x16x32_bf16 v[92:95], a[76:79], v[168:171], v[92:95]
 v_exp_f32 v52, v52
 v_mfma_f32_16x16x32_bf16 v[96:99], a[80:83], v[168:171], v[96:99]
 v_exp_f32 v53, v53
 v_mfma_f32_16x16x32_bf16 v[100:103], a[72:75], v[172:175], v[100:103]
 ds_read_b128 v[204:207], v19 offset:6144
 v_mfma_f32_16x16x32_bf16 v[104:107], a[76:79], v[172:175], v[104:107]
 v_exp_f32 v54, v54
 v_mfma_f32_16x16x32_bf16 v[108:111], a[80:83], v[172:175], v[108:111]
 s_waitcnt lgkmcnt(4)
 v_mfma_f32_16x16x32_bf16 v[112:115], a[72:75], v[176:179], v[112:115]
 ds_read_b128 v[208:211], v19 offset:8192
 v_mfma_f32_16x16x32_bf16 v[116:119], a[76:79], v[176:179], v[116:119]
 v_exp_f32 v55, v55
 v_mfma_f32_16x16x32_bf16 v[120:123], a[80:83], v[176:179], v[120:123]
 s_nop 0
 v_add_f32 v56, v52, v53
 v_mfma_f32_16x16x32_bf16 v[124:127], a[72:75], v[180:183], v[124:127]
 ds_read_b128 v[212:215], v19 offset:10240
 v_add_f32 v56, v56, v54
 v_mfma_f32_16x16x32_bf16 v[128:131], a[76:79], v[180:183], v[128:131]
 buffer_load_dwordx4 v13, s[8:11], s30 offen offset:3072 lds
 v_mfma_f32_16x16x32_bf16 v[132:135], a[80:83], v[180:183], v[132:135]
 s_add_u32 s30, s30, 128
 s_add_u32 m0, m0, 16384
 v_mfma_f32_16x16x32_bf16 v[136:139], a[72:75], v[184:187], v[136:139]
 ds_read_b128 v[216:219], v19 offset:12288
 s_add_u32 s21, s50, 4096
 v_mfma_f32_16x16x32_bf16 v[140:143], a[76:79], v[184:187], v[140:143]
 s_cmp_lt_u32 m0, s46
 s_cselect_b32 m0, m0, s47
 v_mfma_f32_16x16x32_bf16 v[144:147], a[80:83], v[184:187], v[144:147]
 buffer_load_dwordx4 v[60:63], v30, s[16:19], s21 offen offset:2048 sc1
 v_mfma_f32_16x16x32_bf16 v[148:151], a[72:75], v[188:191], v[148:151]
 ds_read_b128 v[220:223], v19 offset:14336
 v_add_f32 v56, v56, v55
 v_mfma_f32_16x16x32_bf16 v[152:155], a[76:79], v[188:191], v[152:155]
 v_cndmask_b32 v56, 0, v56, s[60:61]
 v_add_f32 v56, v56, v44
 v_mfma_f32_16x16x32_bf16 v[156:159], a[80:83], v[188:191], v[156:159]
 s_waitcnt vmcnt(19) lgkmcnt(4)
 s_barrier
 v_mfma_f32_16x16x32_bf16 v[64:67], a[84:87], v[192:195], v[64:67]
 ds_read_b128 v[160:163], v18 offset:0
 v_add_f32 v56, v56, v45
 v_mfma_f32_16x16x32_bf16 v[68:71], a[88:91], v[192:195], v[68:71]
 v_add_f32 v56, v56, v46
 v_add_f32 v56, v56, v47
 v_mfma_f32_16x16x32_bf16 v[72:75], a[92:95], v[192:195], v[72:75]
 v_add_u32 v19, s33, v15
 s_add_u32 s33, s33, 16384
 v_mfma_f32_16x16x32_bf16 v[76:79], a[84:87], v[196:199], v[76:79]
 ds_read_b128 v[164:167], v18 offset:2048
 v_add_f32 v56, v56, v48
 v_mfma_f32_16x16x32_bf16 v[80:83], a[88:91], v[196:199], v[80:83]
 buffer_load_dwordx4 v10, s[8:11], s30 offen offset:0 lds
 v_mfma_f32_16x16x32_bf16 v[84:87], a[92:95], v[196:199], v[84:87]
 s_cmp_lt_u32 s33, 98304
 s_cselect_b32 s33, s33, 0
 v_mfma_f32_16x16x32_bf16 v[88:91], a[84:87], v[200:203], v[88:91]
 ds_read_b128 v[168:171], v18 offset:4096
 v_add_f32 v56, v56, v49
 v_mfma_f32_16x16x32_bf16 v[92:95], a[88:91], v[200:203], v[92:95]
 v_add_f32 v56, v56, v50
 v_add_f32 v56, v56, v51
 v_mfma_f32_16x16x32_bf16 v[96:99], a[92:95], v[200:203], v[96:99]
 v_mov_b32 v57, v56
 v_mfma_f32_16x16x32_bf16 v[100:103], a[84:87], v[204:207], v[100:103]
 ds_read_b128 v[172:175], v18 offset:6144
 v_mfma_f32_16x16x32_bf16 v[104:107], a[88:91], v[204:207], v[104:107]
 s_nop 1
 v_mfma_f32_16x16x32_bf16 v[108:111], a[92:95], v[204:207], v[108:111]
 s_waitcnt lgkmcnt(4)
 v_mfma_f32_16x16x32_bf16 v[112:115], a[84:87], v[208:211], v[112:115]
 ds_read_b128 v[176:179], v18 offset:8192
 v_mfma_f32_16x16x32_bf16 v[116:119], a[88:91], v[208:211], v[116:119]
 v_permlane32_swap_b32 v56, v57
 v_mfma_f32_16x16x32_bf16 v[120:123], a[92:95], v[208:211], v[120:123]
 v_add_f32 v56, v56, v57
 v_mov_b32 v57, v56
 v_mfma_f32_16x16x32_bf16 v[124:127], a[84:87], v[212:215], v[124:127]
 ds_read_b128 v[180:183], v18 offset:10240
 v_mfma_f32_16x16x32_bf16 v[128:131], a[88:91], v[212:215], v[128:131]
 buffer_load_dwordx4 v11, s[8:11], s30 offen offset:1024 lds
 v_mfma_f32_16x16x32_bf16 v[132:135], a[92:95], v[212:215], v[132:135]
 s_add_u32 s21, s50, 8192
 v_mfma_f32_16x16x32_bf16 v[136:139], a[84:87], v[216:219], v[136:139]
 ds_read_b128 v[184:187], v18 offset:12288
 v_mfma_f32_16x16x32_bf16 v[140:143], a[88:91], v[216:219], v[140:143]
 buffer_load_dwordx4 v[248:251], v30, s[16:19], s21 offen offset:2048 sc1
 v_mfma_f32_16x16x32_bf16 v[144:147], a[92:95], v[216:219], v[144:147]
 s_nop 1
 v_mfma_f32_16x16x32_bf16 v[148:151], a[84:87], v[220:223], v[148:151]
 ds_read_b128 v[188:191], v18 offset:14336
 v_mfma_f32_16x16x32_bf16 v[152:155], a[88:91], v[220:223], v[152:155]
 v_permlane16_swap_b32 v56, v57
 v_mfma_f32_16x16x32_bf16 v[156:159], a[92:95], v[220:223], v[156:159]
 s_waitcnt lgkmcnt(4)
 v_add_f32 v56, v56, v57
 v_mfma_f32_16x16x32_bf16 v[64:67], a[96:99], v[160:163], v[64:67]
 ds_read_b128 v[192:195], v19 offset:0
 v_mfma_f32_16x16x32_bf16 v[68:71], a[100:103], v[160:163], v[68:71]
 v_add_u32 v18, s33, v14
 v_mfma_f32_16x16x32_bf16 v[72:75], a[104:107], v[160:163], v[72:75]
 v_rcp_f32 v56, v56
 v_mfma_f32_16x16x32_bf16 v[76:79], a[96:99], v[164:167], v[76:79]
 ds_read_b128 v[196:199], v19 offset:2048
 s_nop 0
 v_mfma_f32_16x16x32_bf16 v[80:83], a[100:103], v[164:167], v[80:83]
 buffer_load_dwordx4 v12, s[8:11], s30 offen offset:2048 lds
 v_mfma_f32_16x16x32_bf16 v[84:87], a[104:107], v[164:167], v[84:87]
 v_mul_f32 v44, v44, v56
 v_mul_f32 v45, v45, v56
 v_mfma_f32_16x16x32_bf16 v[88:91], a[96:99], v[168:171], v[88:91]
 ds_read_b128 v[200:203], v19 offset:4096
 v_mul_f32 v46, v46, v56
 v_mfma_f32_16x16x32_bf16 v[92:95], a[100:103], v[168:171], v[92:95]
 v_mul_f32 v47, v47, v56
 v_mul_f32 v48, v48, v56
 v_mfma_f32_16x16x32_bf16 v[96:99], a[104:107], v[168:171], v[96:99]
 v_mul_f32 v49, v49, v56
 v_mul_f32 v50, v50, v56
 v_mfma_f32_16x16x32_bf16 v[100:103], a[96:99], v[172:175], v[100:103]
 ds_read_b128 v[204:207], v19 offset:6144
 v_mul_f32 v51, v51, v56
 v_mfma_f32_16x16x32_bf16 v[104:107], a[100:103], v[172:175], v[104:107]
 v_mul_f32 v52, v52, v56
 v_mul_f32 v53, v53, v56
 v_mfma_f32_16x16x32_bf16 v[108:111], a[104:107], v[172:175], v[108:111]
 s_waitcnt lgkmcnt(4)
 v_mul_f32 v54, v54, v56
 v_mfma_f32_16x16x32_bf16 v[112:115], a[96:99], v[176:179], v[112:115]
 ds_read_b128 v[208:211], v19 offset:8192
 v_mul_f32 v55, v55, v56
 v_mfma_f32_16x16x32_bf16 v[116:119], a[100:103], v[176:179], v[116:119]
 v_cvt_pk_bf16_f32 v240, v40, v41
 v_cvt_pk_bf16_f32 v241, v42, v43
 v_mfma_f32_16x16x32_bf16 v[120:123], a[104:107], v[176:179], v[120:123]
 v_cvt_pk_bf16_f32 v242, v52, v53
 v_cvt_pk_bf16_f32 v243, v54, v55
 v_mfma_f32_16x16x32_bf16 v[124:127], a[96:99], v[180:183], v[124:127]
 ds_read_b128 v[212:215], v19 offset:10240
 s_add_u32 s21, s50, 8192
 v_mfma_f32_16x16x32_bf16 v[128:131], a[100:103], v[180:183], v[128:131]
 buffer_load_dwordx4 v13, s[8:11], s30 offen offset:3072 lds
 v_mfma_f32_16x16x32_bf16 v[132:135], a[104:107], v[180:183], v[132:135]
 s_add_u32 s30, s30, 128
 s_add_u32 m0, m0, 16384
 v_mfma_f32_16x16x32_bf16 v[136:139], a[96:99], v[184:187], v[136:139]
 ds_read_b128 v[216:219], v19 offset:12288
 v_cvt_pk_bf16_f32 v236, v44, v45
 v_mfma_f32_16x16x32_bf16 v[140:143], a[100:103], v[184:187], v[140:143]
 s_cmp_lt_u32 m0, s46
 s_cselect_b32 m0, m0, s47
 v_mfma_f32_16x16x32_bf16 v[144:147], a[104:107], v[184:187], v[144:147]
 buffer_load_dwordx4 v[252:255], v30, s[16:19], s21 offen offset:3072 sc1
 v_mfma_f32_16x16x32_bf16 v[148:151], a[96:99], v[188:191], v[148:151]
 ds_read_b128 v[220:223], v19 offset:14336
 v_cvt_pk_bf16_f32 v237, v46, v47
 v_mfma_f32_16x16x32_bf16 v[152:155], a[100:103], v[188:191], v[152:155]
 v_cvt_pk_bf16_f32 v238, v48, v49
 v_cvt_pk_bf16_f32 v239, v50, v51
 v_mfma_f32_16x16x32_bf16 v[156:159], a[104:107], v[188:191], v[156:159]
 s_waitcnt vmcnt(19) lgkmcnt(4)
 s_barrier
 v_mfma_f32_16x16x32_bf16 v[64:67], a[108:111], v[192:195], v[64:67]
 ds_read_b128 v[160:163], v18 offset:0
 v_cvt_pk_bf16_f32 v244, v36, v37
 v_mfma_f32_16x16x32_bf16 v[68:71], a[112:115], v[192:195], v[68:71]
 v_cvt_pk_bf16_f32 v245, v38, v39
 v_mfma_f32_16x16x32_bf16 v[72:75], a[116:119], v[192:195], v[72:75]
 v_add_u32 v19, s33, v15
 s_add_u32 s33, s33, 16384
 v_mfma_f32_16x16x32_bf16 v[76:79], a[108:111], v[196:199], v[76:79]
 ds_read_b128 v[164:167], v18 offset:2048
 v_mfma_f32_16x16x32_bf16 v[80:83], a[112:115], v[196:199], v[80:83]
 buffer_load_dwordx4 v10, s[8:11], s30 offen offset:0 lds
 v_mfma_f32_16x16x32_bf16 v[84:87], a[116:119], v[196:199], v[84:87]
 s_cmp_lt_u32 s33, 98304
 s_cselect_b32 s33, s33, 0
 v_mfma_f32_16x16x32_bf16 v[88:91], a[108:111], v[200:203], v[88:91]
 ds_read_b128 v[168:171], v18 offset:4096
 v_mfma_f32_16x16x32_bf16 v[92:95], a[112:115], v[200:203], v[92:95]
 v_permlane16_swap_b32 v240, v242
 v_mfma_f32_16x16x32_bf16 v[96:99], a[116:119], v[200:203], v[96:99]
 v_permlane16_swap_b32 v241, v243
 v_mfma_f32_16x16x32_bf16 v[100:103], a[108:111], v[204:207], v[100:103]
 ds_read_b128 v[172:175], v18 offset:6144
 v_mfma_f32_16x16x32_bf16 v[104:107], a[112:115], v[204:207], v[104:107]
 v_mfma_f32_16x16x32_bf16 v[108:111], a[116:119], v[204:207], v[108:111]
 s_waitcnt lgkmcnt(4)
 v_mfma_f32_16x16x32_bf16 v[112:115], a[108:111], v[208:211], v[112:115]
 ds_read_b128 v[176:179], v18 offset:8192
 v_mfma_f32_16x16x32_bf16 v[116:119], a[112:115], v[208:211], v[116:119]
 v_mfma_f32_16x16x32_bf16 v[120:123], a[116:119], v[208:211], v[120:123]
 v_mfma_f32_16x16x32_bf16 v[124:127], a[108:111], v[212:215], v[124:127]
 ds_read_b128 v[180:183], v18 offset:10240
 v_mfma_f32_16x16x32_bf16 v[128:131], a[112:115], v[212:215], v[128:131]
 buffer_load_dwordx4 v11, s[8:11], s30 offen offset:1024 lds
 v_mfma_f32_16x16x32_bf16 v[132:135], a[116:119], v[212:215], v[132:135]
 v_mfma_f32_16x16x32_bf16 v[136:139], a[108:111], v[216:219], v[136:139]
 ds_read_b128 v[184:187], v18 offset:12288
 v_mfma_f32_16x16x32_bf16 v[140:143], a[112:115], v[216:219], v[140:143]
 v_mfma_f32_16x16x32_bf16 v[144:147], a[116:119], v[216:219], v[144:147]
 v_mfma_f32_16x16x32_bf16 v[148:151], a[108:111], v[220:223], v[148:151]
 ds_read_b128 v[188:191], v18 offset:14336
 v_mfma_f32_16x16x32_bf16 v[152:155], a[112:115], v[220:223], v[152:155]
 v_mfma_f32_16x16x32_bf16 v[156:159], a[116:119], v[220:223], v[156:159]
 s_waitcnt lgkmcnt(4)
 v_mfma_f32_16x16x32_bf16 v[64:67], a[120:123], v[160:163], v[64:67]
 ds_read_b128 v[192:195], v19 offset:0
 v_mfma_f32_16x16x32_bf16 v[68:71], a[124:127], v[160:163], v[68:71]
 v_add_u32 v18, s33, v14
 v_mfma_f32_16x16x32_bf16 v[72:75], a[128:131], v[160:163], v[72:75]
 v_mfma_f32_16x16x32_bf16 v[76:79], a[120:123], v[164:167], v[76:79]
 ds_read_b128 v[196:199], v19 offset:2048
 v_mfma_f32_16x16x32_bf16 v[80:83], a[124:127], v[164:167], v[80:83]
 buffer_load_dwordx4 v12, s[8:11], s30 offen offset:2048 lds
 v_mfma_f32_16x16x32_bf16 v[84:87], a[128:131], v[164:167], v[84:87]
 v_mfma_f32_16x16x32_bf16 v[88:91], a[120:123], v[168:171], v[88:91]
 ds_read_b128 v[200:203], v19 offset:4096
 v_mfma_f32_16x16x32_bf16 v[92:95], a[124:127], v[168:171], v[92:95]
 v_mfma_f32_16x16x32_bf16 v[96:99], a[128:131], v[168:171], v[96:99]
 v_mfma_f32_16x16x32_bf16 v[100:103], a[120:123], v[172:175], v[100:103]
 ds_read_b128 v[204:207], v19 offset:6144
 v_mfma_f32_16x16x32_bf16 v[104:107], a[124:127], v[172:175], v[104:107]
 v_mfma_f32_16x16x32_bf16 v[108:111], a[128:131], v[172:175], v[108:111]
 s_waitcnt lgkmcnt(4)
 v_mfma_f32_16x16x32_bf16 v[112:115], a[120:123], v[176:179], v[112:115]
 ds_read_b128 v[208:211], v19 offset:8192
 v_mfma_f32_16x16x32_bf16 v[116:119], a[124:127], v[176:179], v[116:119]
 v_mfma_f32_16x16x32_bf16 v[120:123], a[128:131], v[176:179], v[120:123]
 v_mfma_f32_16x16x32_bf16 v[124:127], a[120:123], v[180:183], v[124:127]
 ds_read_b128 v[212:215], v19 offset:10240
 v_mfma_f32_16x16x32_bf16 v[128:131], a[124:127], v[180:183], v[128:131]
 buffer_load_dwordx4 v13, s[8:11], s30 offen offset:3072 lds
 v_mfma_f32_16x16x32_bf16 v[132:135], a[128:131], v[180:183], v[132:135]
 s_add_u32 s30, s30, s25
 s_sub_u32 s30, s30, 1152
 v_mfma_f32_16x16x32_bf16 v[136:139], a[120:123], v[184:187], v[136:139]
 ds_read_b128 v[216:219], v19 offset:12288
 s_mov_b32 s25, 163840
 v_mfma_f32_16x16x32_bf16 v[140:143], a[124:127], v[184:187], v[140:143]
 s_add_u32 m0, m0, 16384
 v_mfma_f32_16x16x32_bf16 v[144:147], a[128:131], v[184:187], v[144:147]
 s_cmp_lt_u32 m0, s46
 s_cselect_b32 m0, m0, s47
 v_mfma_f32_16x16x32_bf16 v[148:151], a[120:123], v[188:191], v[148:151]
 ds_read_b128 v[220:223], v19 offset:14336
 v_mfma_f32_16x16x32_bf16 v[152:155], a[124:127], v[188:191], v[152:155]
 v_mfma_f32_16x16x32_bf16 v[156:159], a[128:131], v[188:191], v[156:159]
 s_waitcnt vmcnt(17) lgkmcnt(4)
 s_barrier
 v_mfma_f32_16x16x32_bf16 v[64:67], a[132:135], v[192:195], v[64:67]
 ds_read_b128 v[160:163], v18 offset:0
 v_mfma_f32_16x16x32_bf16 v[68:71], a[136:139], v[192:195], v[68:71]
 v_mfma_f32_16x16x32_bf16 v[72:75], a[140:143], v[192:195], v[72:75]
 v_add_u32 v19, s33, v15
 s_add_u32 s33, s33, 16384
 v_mfma_f32_16x16x32_bf16 v[76:79], a[132:135], v[196:199], v[76:79]
 ds_read_b128 v[164:167], v18 offset:2048
 v_mfma_f32_16x16x32_bf16 v[80:83], a[136:139], v[196:199], v[80:83]
 buffer_load_dwordx4 v10, s[8:11], s30 offen offset:0 lds
 v_mfma_f32_16x16x32_bf16 v[84:87], a[140:143], v[196:199], v[84:87]
 s_cmp_lt_u32 s33, 98304
 s_cselect_b32 s33, s33, 0
 v_mfma_f32_16x16x32_bf16 v[88:91], a[132:135], v[200:203], v[88:91]
 ds_read_b128 v[168:171], v18 offset:4096
 v_mfma_f32_16x16x32_bf16 v[92:95], a[136:139], v[200:203], v[92:95]
 buffer_store_dwordx4 v[236:239], v30, s[56:59], s81 offen sc1
 v_mfma_f32_16x16x32_bf16 v[96:99], a[140:143], v[200:203], v[96:99]
 v_mfma_f32_16x16x32_bf16 v[100:103], a[132:135], v[204:207], v[100:103]
 ds_read_b128 v[172:175], v18 offset:6144
 v_mfma_f32_16x16x32_bf16 v[104:107], a[136:139], v[204:207], v[104:107]
 v_mfma_f32_16x16x32_bf16 v[108:111], a[140:143], v[204:207], v[108:111]
 s_waitcnt lgkmcnt(4)
 v_mfma_f32_16x16x32_bf16 v[112:115], a[132:135], v[208:211], v[112:115]
 ds_read_b128 v[176:179], v18 offset:8192
 v_mfma_f32_16x16x32_bf16 v[116:119], a[136:139], v[208:211], v[116:119]
 s_mov_b64 exec, 0xffffffff
 buffer_store_dwordx4 v[240:243], v30, s[56:59], s81 offen offset:1024 sc1
 s_mov_b64 exec, -1
 v_mfma_f32_16x16x32_bf16 v[120:123], a[140:143], v[208:211], v[120:123]
 v_mfma_f32_16x16x32_bf16 v[124:127], a[132:135], v[212:215], v[124:127]
 ds_read_b128 v[180:183], v18 offset:10240
 v_mfma_f32_16x16x32_bf16 v[128:131], a[136:139], v[212:215], v[128:131]
 buffer_load_dwordx4 v11, s[8:11], s30 offen offset:1024 lds
 v_mfma_f32_16x16x32_bf16 v[132:135], a[140:143], v[212:215], v[132:135]
 v_mfma_f32_16x16x32_bf16 v[136:139], a[132:135], v[216:219], v[136:139]
 ds_read_b128 v[184:187], v18 offset:12288
 v_mfma_f32_16x16x32_bf16 v[140:143], a[136:139], v[216:219], v[140:143]
 buffer_store_dwordx2 v[244:245], v32, s[56:59], s81 offen offset:2048 sc1
 v_mfma_f32_16x16x32_bf16 v[144:147], a[140:143], v[216:219], v[144:147]
 s_mov_b32 s78, s82
 s_mov_b32 s82, 0
 v_mfma_f32_16x16x32_bf16 v[148:151], a[132:135], v[220:223], v[148:151]
 ds_read_b128 v[188:191], v18 offset:14336
 s_mov_b32 s81, 0x80000000
 v_mfma_f32_16x16x32_bf16 v[152:155], a[136:139], v[220:223], v[152:155]
 v_mfma_f32_16x16x32_bf16 v[156:159], a[140:143], v[220:223], v[156:159]
 s_waitcnt lgkmcnt(4)
 s_add_u32 s21, s50, 0
 v_mfma_f32_16x16x32_bf16 v[64:67], a[144:147], v[160:163], v[64:67]
 ds_read_b128 v[192:195], v19 offset:0
 v_mfma_f32_16x16x32_bf16 v[68:71], a[148:151], v[160:163], v[68:71]
 v_add_u32 v18, s33, v14
 v_mfma_f32_16x16x32_bf16 v[72:75], a[152:155], v[160:163], v[72:75]
 buffer_load_dwordx4 v[36:39], v30, s[16:19], s21 offen offset:0 sc1
 v_mfma_f32_16x16x32_bf16 v[76:79], a[144:147], v[164:167], v[76:79]
 ds_read_b128 v[196:199], v19 offset:2048
 v_mfma_f32_16x16x32_bf16 v[80:83], a[148:151], v[164:167], v[80:83]
 buffer_load_dwordx4 v12, s[8:11], s30 offen offset:2048 lds
 v_mfma_f32_16x16x32_bf16 v[84:87], a[152:155], v[164:167], v[84:87]
 v_mfma_f32_16x16x32_bf16 v[88:91], a[144:147], v[168:171], v[88:91]
 ds_read_b128 v[200:203], v19 offset:4096
 v_mfma_f32_16x16x32_bf16 v[92:95], a[148:151], v[168:171], v[92:95]
 v_mfma_f32_16x16x32_bf16 v[96:99], a[152:155], v[168:171], v[96:99]
 v_mfma_f32_16x16x32_bf16 v[100:103], a[144:147], v[172:175], v[100:103]
 ds_read_b128 v[204:207], v19 offset:6144
 v_mfma_f32_16x16x32_bf16 v[104:107], a[148:151], v[172:175], v[104:107]
 v_mfma_f32_16x16x32_bf16 v[108:111], a[152:155], v[172:175], v[108:111]
 s_waitcnt lgkmcnt(4)
 v_mfma_f32_16x16x32_bf16 v[112:115], a[144:147], v[176:179], v[112:115]
 ds_read_b128 v[208:211], v19 offset:8192
 s_add_u32 s21, s50, 0
 v_mfma_f32_16x16x32_bf16 v[116:119], a[148:151], v[176:179], v[116:119]
 buffer_load_dwordx4 v[40:43], v30, s[16:19], s21 offen offset:1024 sc1
 v_mfma_f32_16x16x32_bf16 v[120:123], a[152:155], v[176:179], v[120:123]
 v_mfma_f32_16x16x32_bf16 v[124:127], a[144:147], v[180:183], v[124:127]
 ds_read_b128 v[212:215], v19 offset:10240
 v_mfma_f32_16x16x32_bf16 v[128:131], a[148:151], v[180:183], v[128:131]
 buffer_load_dwordx4 v13, s[8:11], s30 offen offset:3072 lds
 v_mfma_f32_16x16x32_bf16 v[132:135], a[152:155], v[180:183], v[132:135]
 s_add_u32 s30, s30, 128
 s_add_u32 m0, m0, 16384
 v_mfma_f32_16x16x32_bf16 v[136:139], a[144:147], v[184:187], v[136:139]
 ds_read_b128 v[216:219], v19 offset:12288
 v_mfma_f32_16x16x32_bf16 v[140:143], a[148:151], v[184:187], v[140:143]
 s_cmp_lt_u32 m0, s46
 s_cselect_b32 m0, m0, s47
 v_mfma_f32_16x16x32_bf16 v[144:147], a[152:155], v[184:187], v[144:147]
 v_mfma_f32_16x16x32_bf16 v[148:151], a[144:147], v[188:191], v[148:151]
 ds_read_b128 v[220:223], v19 offset:14336
 v_mfma_f32_16x16x32_bf16 v[152:155], a[148:151], v[188:191], v[152:155]
 v_mfma_f32_16x16x32_bf16 v[156:159], a[152:155], v[188:191], v[156:159]
 s_waitcnt vmcnt(20) lgkmcnt(4)
 s_barrier
 v_mfma_f32_16x16x32_bf16 v[64:67], a[156:159], v[192:195], v[64:67]
 ds_read_b128 v[160:163], v18 offset:0
 s_add_u32 s21, s50, 0
 v_mfma_f32_16x16x32_bf16 v[68:71], a[160:163], v[192:195], v[68:71]
 buffer_load_dwordx4 v[44:47], v30, s[16:19], s21 offen offset:2048 sc1
 v_mfma_f32_16x16x32_bf16 v[72:75], a[164:167], v[192:195], v[72:75]
 v_add_u32 v19, s33, v15
 s_add_u32 s33, s33, 16384
 v_mfma_f32_16x16x32_bf16 v[76:79], a[156:159], v[196:199], v[76:79]
 ds_read_b128 v[164:167], v18 offset:2048
 v_mfma_f32_16x16x32_bf16 v[80:83], a[160:163], v[196:199], v[80:83]
 buffer_load_dwordx4 v10, s[8:11], s30 offen offset:0 lds
 v_mfma_f32_16x16x32_bf16 v[84:87], a[164:167], v[196:199], v[84:87]
 s_cmp_lt_u32 s33, 98304
 s_cselect_b32 s33, s33, 0
 v_mfma_f32_16x16x32_bf16 v[88:91], a[156:159], v[200:203], v[88:91]
 ds_read_b128 v[168:171], v18 offset:4096
 v_mfma_f32_16x16x32_bf16 v[92:95], a[160:163], v[200:203], v[92:95]
 v_mfma_f32_16x16x32_bf16 v[96:99], a[164:167], v[200:203], v[96:99]
 v_mfma_f32_16x16x32_bf16 v[100:103], a[156:159], v[204:207], v[100:103]
 ds_read_b128 v[172:175], v18 offset:6144
 v_mfma_f32_16x16x32_bf16 v[104:107], a[160:163], v[204:207], v[104:107]
 v_mfma_f32_16x16x32_bf16 v[108:111], a[164:167], v[204:207], v[108:111]
 s_waitcnt lgkmcnt(4)
 s_add_u32 s21, s50, 0
 v_mfma_f32_16x16x32_bf16 v[112:115], a[156:159], v[208:211], v[112:115]
 ds_read_b128 v[176:179], v18 offset:8192
 v_mfma_f32_16x16x32_bf16 v[116:119], a[160:163], v[208:211], v[116:119]
 buffer_load_dwordx4 v[48:51], v30, s[16:19], s21 offen offset:3072 sc1
 v_mfma_f32_16x16x32_bf16 v[120:123], a[164:167], v[208:211], v[120:123]
 v_mfma_f32_16x16x32_bf16 v[124:127], a[156:159], v[212:215], v[124:127]
 ds_read_b128 v[180:183], v18 offset:10240
 v_mfma_f32_16x16x32_bf16 v[128:131], a[160:163], v[212:215], v[128:131]
 buffer_load_dwordx4 v11, s[8:11], s30 offen offset:1024 lds
 v_mfma_f32_16x16x32_bf16 v[132:135], a[164:167], v[212:215], v[132:135]
 v_mfma_f32_16x16x32_bf16 v[136:139], a[156:159], v[216:219], v[136:139]
 ds_read_b128 v[184:187], v18 offset:12288
 v_mfma_f32_16x16x32_bf16 v[140:143], a[160:163], v[216:219], v[140:143]
 v_mfma_f32_16x16x32_bf16 v[144:147], a[164:167], v[216:219], v[144:147]
 v_mfma_f32_16x16x32_bf16 v[148:151], a[156:159], v[220:223], v[148:151]
 ds_read_b128 v[188:191], v18 offset:14336
 v_mfma_f32_16x16x32_bf16 v[152:155], a[160:163], v[220:223], v[152:155]
 v_mfma_f32_16x16x32_bf16 v[156:159], a[164:167], v[220:223], v[156:159]
 s_waitcnt lgkmcnt(4)
 s_add_u32 s21, s50, 4096
 v_mfma_f32_16x16x32_bf16 v[64:67], a[168:171], v[160:163], v[64:67]
 ds_read_b128 v[192:195], v19 offset:0
 v_mfma_f32_16x16x32_bf16 v[68:71], a[172:175], v[160:163], v[68:71]
 v_add_u32 v18, s33, v14
 v_mfma_f32_16x16x32_bf16 v[72:75], a[176:179], v[160:163], v[72:75]
 buffer_load_dwordx4 v[52:55], v30, s[16:19], s21 offen offset:0 sc1
 v_mfma_f32_16x16x32_bf16 v[76:79], a[168:171], v[164:167], v[76:79]
 ds_read_b128 v[196:199], v19 offset:2048
 v_mfma_f32_16x16x32_bf16 v[80:83], a[172:175], v[164:167], v[80:83]
 buffer_load_dwordx4 v12, s[8:11], s30 offen offset:2048 lds
 v_mfma_f32_16x16x32_bf16 v[84:87], a[176:179], v[164:167], v[84:87]
 v_mfma_f32_16x16x32_bf16 v[88:91], a[168:171], v[168:171], v[88:91]
 ds_read_b128 v[200:203], v19 offset:4096
 v_mfma_f32_16x16x32_bf16 v[92:95], a[172:175], v[168:171], v[92:95]
 v_mfma_f32_16x16x32_bf16 v[96:99], a[176:179], v[168:171], v[96:99]
 v_mfma_f32_16x16x32_bf16 v[100:103], a[168:171], v[172:175], v[100:103]
 ds_read_b128 v[204:207], v19 offset:6144
 v_mfma_f32_16x16x32_bf16 v[104:107], a[172:175], v[172:175], v[104:107]
 v_mfma_f32_16x16x32_bf16 v[108:111], a[176:179], v[172:175], v[108:111]
 s_waitcnt lgkmcnt(4)
 v_mfma_f32_16x16x32_bf16 v[112:115], a[168:171], v[176:179], v[112:115]
 ds_read_b128 v[208:211], v19 offset:8192
 s_add_u32 s21, s50, 4096
 v_mfma_f32_16x16x32_bf16 v[116:119], a[172:175], v[176:179], v[116:119]
 buffer_load_dwordx4 v[56:59], v30, s[16:19], s21 offen offset:1024 sc1
 v_mfma_f32_16x16x32_bf16 v[120:123], a[176:179], v[176:179], v[120:123]
 v_mfma_f32_16x16x32_bf16 v[124:127], a[168:171], v[180:183], v[124:127]
 ds_read_b128 v[212:215], v19 offset:10240
 v_mfma_f32_16x16x32_bf16 v[128:131], a[172:175], v[180:183], v[128:131]
 buffer_load_dwordx4 v13, s[8:11], s30 offen offset:3072 lds
 v_mfma_f32_16x16x32_bf16 v[132:135], a[176:179], v[180:183], v[132:135]
 s_add_u32 s30, s30, 128
 s_add_u32 m0, m0, 16384
 v_mfma_f32_16x16x32_bf16 v[136:139], a[168:171], v[184:187], v[136:139]
 ds_read_b128 v[216:219], v19 offset:12288
 v_mfma_f32_16x16x32_bf16 v[140:143], a[172:175], v[184:187], v[140:143]
 s_cmp_lt_u32 m0, s46
 s_cselect_b32 m0, m0, s47
 v_mfma_f32_16x16x32_bf16 v[144:147], a[176:179], v[184:187], v[144:147]
 v_mfma_f32_16x16x32_bf16 v[148:151], a[168:171], v[188:191], v[148:151]
 ds_read_b128 v[220:223], v19 offset:14336
 v_mfma_f32_16x16x32_bf16 v[152:155], a[172:175], v[188:191], v[152:155]
 v_mfma_f32_16x16x32_bf16 v[156:159], a[176:179], v[188:191], v[156:159]
 s_waitcnt vmcnt(22) lgkmcnt(4)
 s_barrier
 v_mfma_f32_16x16x32_bf16 v[64:67], a[180:183], v[192:195], v[64:67]
 ds_read_b128 v[160:163], v18 offset:0
 s_add_u32 s21, s50, 4096
 v_mfma_f32_16x16x32_bf16 v[68:71], a[184:187], v[192:195], v[68:71]
 buffer_load_dwordx4 v[236:239], v30, s[16:19], s21 offen offset:3072 sc1
 v_mfma_f32_16x16x32_bf16 v[72:75], a[188:191], v[192:195], v[72:75]
 v_add_u32 v19, s33, v15
 s_add_u32 s33, s33, 16384
 v_mfma_f32_16x16x32_bf16 v[76:79], a[180:183], v[196:199], v[76:79]
 ds_read_b128 v[164:167], v18 offset:2048
 v_mfma_f32_16x16x32_bf16 v[80:83], a[184:187], v[196:199], v[80:83]
 buffer_load_dwordx4 v10, s[8:11], s30 offen offset:0 lds
 v_mfma_f32_16x16x32_bf16 v[84:87], a[188:191], v[196:199], v[84:87]
 s_cmp_lt_u32 s33, 98304
 s_cselect_b32 s33, s33, 0
 v_mfma_f32_16x16x32_bf16 v[88:91], a[180:183], v[200:203], v[88:91]
 ds_read_b128 v[168:171], v18 offset:4096
 v_mfma_f32_16x16x32_bf16 v[92:95], a[184:187], v[200:203], v[92:95]
 v_mfma_f32_16x16x32_bf16 v[96:99], a[188:191], v[200:203], v[96:99]
 v_mfma_f32_16x16x32_bf16 v[100:103], a[180:183], v[204:207], v[100:103]
 ds_read_b128 v[172:175], v18 offset:6144
 v_mfma_f32_16x16x32_bf16 v[104:107], a[184:187], v[204:207], v[104:107]
 v_mfma_f32_16x16x32_bf16 v[108:111], a[188:191], v[204:207], v[108:111]
 s_waitcnt lgkmcnt(4)
 s_add_u32 s21, s50, 8192
 v_mfma_f32_16x16x32_bf16 v[112:115], a[180:183], v[208:211], v[112:115]
 ds_read_b128 v[176:179], v18 offset:8192
 v_mfma_f32_16x16x32_bf16 v[116:119], a[184:187], v[208:211], v[116:119]
 buffer_load_dwordx4 v[240:243], v30, s[16:19], s21 offen offset:0 sc1
 v_mfma_f32_16x16x32_bf16 v[120:123], a[188:191], v[208:211], v[120:123]
 v_mfma_f32_16x16x32_bf16 v[124:127], a[180:183], v[212:215], v[124:127]
 ds_read_b128 v[180:183], v18 offset:10240
 v_mfma_f32_16x16x32_bf16 v[128:131], a[184:187], v[212:215], v[128:131]
 buffer_load_dwordx4 v11, s[8:11], s30 offen offset:1024 lds
 v_mfma_f32_16x16x32_bf16 v[132:135], a[188:191], v[212:215], v[132:135]
 v_mfma_f32_16x16x32_bf16 v[136:139], a[180:183], v[216:219], v[136:139]
 ds_read_b128 v[184:187], v18 offset:12288
 v_mfma_f32_16x16x32_bf16 v[140:143], a[184:187], v[216:219], v[140:143]
 v_mfma_f32_16x16x32_bf16 v[144:147], a[188:191], v[216:219], v[144:147]
 v_mfma_f32_16x16x32_bf16 v[148:151], a[180:183], v[220:223], v[148:151]
 ds_read_b128 v[188:191], v18 offset:14336
 v_mfma_f32_16x16x32_bf16 v[152:155], a[184:187], v[220:223], v[152:155]
 v_mfma_f32_16x16x32_bf16 v[156:159], a[188:191], v[220:223], v[156:159]
 s_waitcnt lgkmcnt(4)
 s_add_u32 s21, s50, 8192
 v_mfma_f32_16x16x32_bf16 v[64:67], a[192:195], v[160:163], v[64:67]
 ds_read_b128 v[192:195], v19 offset:0
 v_mfma_f32_16x16x32_bf16 v[68:71], a[196:199], v[160:163], v[68:71]
 v_add_u32 v18, s33, v14
 v_mfma_f32_16x16x32_bf16 v[72:75], a[200:203], v[160:163], v[72:75]
 buffer_load_dwordx4 v[244:247], v30, s[16:19], s21 offen offset:1024 sc1
 v_mfma_f32_16x16x32_bf16 v[76:79], a[192:195], v[164:167], v[76:79]
 ds_read_b128 v[196:199], v19 offset:2048
 v_mfma_f32_16x16x32_bf16 v[80:83], a[196:199], v[164:167], v[80:83]
 buffer_load_dwordx4 v12, s[8:11], s30 offen offset:2048 lds
 v_mfma_f32_16x16x32_bf16 v[84:87], a[200:203], v[164:167], v[84:87]
 v_mfma_f32_16x16x32_bf16 v[88:91], a[192:195], v[168:171], v[88:91]
 ds_read_b128 v[200:203], v19 offset:4096
 v_mfma_f32_16x16x32_bf16 v[92:95], a[196:199], v[168:171], v[92:95]
 v_mfma_f32_16x16x32_bf16 v[96:99], a[200:203], v[168:171], v[96:99]
 v_mfma_f32_16x16x32_bf16 v[100:103], a[192:195], v[172:175], v[100:103]
 ds_read_b128 v[204:207], v19 offset:6144
 v_mfma_f32_16x16x32_bf16 v[104:107], a[196:199], v[172:175], v[104:107]
 v_mfma_f32_16x16x32_bf16 v[108:111], a[200:203], v[172:175], v[108:111]
 s_waitcnt lgkmcnt(4)
 v_mfma_f32_16x16x32_bf16 v[112:115], a[192:195], v[176:179], v[112:115]
 ds_read_b128 v[208:211], v19 offset:8192
 v_mfma_f32_16x16x32_bf16 v[116:119], a[196:199], v[176:179], v[116:119]
 v_mfma_f32_16x16x32_bf16 v[120:123], a[200:203], v[176:179], v[120:123]
 v_mfma_f32_16x16x32_bf16 v[124:127], a[192:195], v[180:183], v[124:127]
 ds_read_b128 v[212:215], v19 offset:10240
 v_mfma_f32_16x16x32_bf16 v[128:131], a[196:199], v[180:183], v[128:131]
 buffer_load_dwordx4 v13, s[8:11], s30 offen offset:3072 lds
 v_mfma_f32_16x16x32_bf16 v[132:135], a[200:203], v[180:183], v[132:135]
 s_add_u32 s30, s30, 128
 s_add_u32 m0, m0, 16384
 v_mfma_f32_16x16x32_bf16 v[136:139], a[192:195], v[184:187], v[136:139]
 ds_read_b128 v[216:219], v19 offset:12288
 v_mfma_f32_16x16x32_bf16 v[140:143], a[196:199], v[184:187], v[140:143]
 s_cmp_lt_u32 m0, s46
 s_cselect_b32 m0, m0, s47
 v_mfma_f32_16x16x32_bf16 v[144:147], a[200:203], v[184:187], v[144:147]
 v_mfma_f32_16x16x32_bf16 v[148:151], a[192:195], v[188:191], v[148:151]
 ds_read_b128 v[220:223], v19 offset:14336
 v_mfma_f32_16x16x32_bf16 v[152:155], a[196:199], v[188:191], v[152:155]
 v_mfma_f32_16x16x32_bf16 v[156:159], a[200:203], v[188:191], v[156:159]
 s_waitcnt vmcnt(24) lgkmcnt(4)
 s_barrier
 v_mfma_f32_16x16x32_bf16 v[64:67], a[204:207], v[192:195], v[64:67]
 ds_read_b128 v[160:163], v18 offset:0
 v_mfma_f32_16x16x32_bf16 v[68:71], a[208:211], v[192:195], v[68:71]
 v_mfma_f32_16x16x32_bf16 v[72:75], a[212:215], v[192:195], v[72:75]
 v_add_u32 v19, s33, v15
 s_add_u32 s33, s33, 16384
 v_mfma_f32_16x16x32_bf16 v[76:79], a[204:207], v[196:199], v[76:79]
 ds_read_b128 v[164:167], v18 offset:2048
 v_mfma_f32_16x16x32_bf16 v[80:83], a[208:211], v[196:199], v[80:83]
 buffer_load_dwordx4 v10, s[8:11], s30 offen offset:0 lds
 v_mfma_f32_16x16x32_bf16 v[84:87], a[212:215], v[196:199], v[84:87]
 s_cmp_lt_u32 s33, 98304
 s_cselect_b32 s33, s33, 0
 v_mfma_f32_16x16x32_bf16 v[88:91], a[204:207], v[200:203], v[88:91]
 ds_read_b128 v[168:171], v18 offset:4096
 v_mfma_f32_16x16x32_bf16 v[92:95], a[208:211], v[200:203], v[92:95]
 v_mfma_f32_16x16x32_bf16 v[96:99], a[212:215], v[200:203], v[96:99]
 v_mfma_f32_16x16x32_bf16 v[100:103], a[204:207], v[204:207], v[100:103]
 ds_read_b128 v[172:175], v18 offset:6144
 v_mfma_f32_16x16x32_bf16 v[104:107], a[208:211], v[204:207], v[104:107]
 v_mfma_f32_16x16x32_bf16 v[108:111], a[212:215], v[204:207], v[108:111]
 s_waitcnt lgkmcnt(4)
 v_mfma_f32_16x16x32_bf16 v[112:115], a[204:207], v[208:211], v[112:115]
 ds_read_b128 v[176:179], v18 offset:8192
 v_mfma_f32_16x16x32_bf16 v[116:119], a[208:211], v[208:211], v[116:119]
 v_mfma_f32_16x16x32_bf16 v[120:123], a[212:215], v[208:211], v[120:123]
 v_mfma_f32_16x16x32_bf16 v[124:127], a[204:207], v[212:215], v[124:127]
 ds_read_b128 v[180:183], v18 offset:10240
 v_mfma_f32_16x16x32_bf16 v[128:131], a[208:211], v[212:215], v[128:131]
 buffer_load_dwordx4 v11, s[8:11], s30 offen offset:1024 lds
 v_mfma_f32_16x16x32_bf16 v[132:135], a[212:215], v[212:215], v[132:135]
 v_mfma_f32_16x16x32_bf16 v[136:139], a[204:207], v[216:219], v[136:139]
 ds_read_b128 v[184:187], v18 offset:12288
 v_mfma_f32_16x16x32_bf16 v[140:143], a[208:211], v[216:219], v[140:143]
 v_mfma_f32_16x16x32_bf16 v[144:147], a[212:215], v[216:219], v[144:147]
 v_mfma_f32_16x16x32_bf16 v[148:151], a[204:207], v[220:223], v[148:151]
 ds_read_b128 v[188:191], v18 offset:14336
 v_mfma_f32_16x16x32_bf16 v[152:155], a[208:211], v[220:223], v[152:155]
 v_mfma_f32_16x16x32_bf16 v[156:159], a[212:215], v[220:223], v[156:159]
 s_waitcnt lgkmcnt(4)
 v_mfma_f32_16x16x32_bf16 v[64:67], a[216:219], v[160:163], v[64:67]
 ds_read_b128 v[192:195], v19 offset:0
 v_mfma_f32_16x16x32_bf16 v[68:71], a[220:223], v[160:163], v[68:71]
 v_add_u32 v18, s33, v14
 v_mfma_f32_16x16x32_bf16 v[72:75], a[224:227], v[160:163], v[72:75]
 v_mfma_f32_16x16x32_bf16 v[76:79], a[216:219], v[164:167], v[76:79]
 ds_read_b128 v[196:199], v19 offset:2048
 v_mfma_f32_16x16x32_bf16 v[80:83], a[220:223], v[164:167], v[80:83]
 buffer_load_dwordx4 v12, s[8:11], s30 offen offset:2048 lds
 v_mfma_f32_16x16x32_bf16 v[84:87], a[224:227], v[164:167], v[84:87]
 v_mfma_f32_16x16x32_bf16 v[88:91], a[216:219], v[168:171], v[88:91]
 ds_read_b128 v[200:203], v19 offset:4096
 v_mfma_f32_16x16x32_bf16 v[92:95], a[220:223], v[168:171], v[92:95]
 v_mfma_f32_16x16x32_bf16 v[96:99], a[224:227], v[168:171], v[96:99]
 v_mfma_f32_16x16x32_bf16 v[100:103], a[216:219], v[172:175], v[100:103]
 ds_read_b128 v[204:207], v19 offset:6144
 v_mfma_f32_16x16x32_bf16 v[104:107], a[220:223], v[172:175], v[104:107]
 v_mfma_f32_16x16x32_bf16 v[108:111], a[224:227], v[172:175], v[108:111]
 s_waitcnt lgkmcnt(4)
 v_mfma_f32_16x16x32_bf16 v[112:115], a[216:219], v[176:179], v[112:115]
 ds_read_b128 v[208:211], v19 offset:8192
 v_mfma_f32_16x16x32_bf16 v[116:119], a[220:223], v[176:179], v[116:119]
 v_mfma_f32_16x16x32_bf16 v[120:123], a[224:227], v[176:179], v[120:123]
 v_mfma_f32_16x16x32_bf16 v[124:127], a[216:219], v[180:183], v[124:127]
 ds_read_b128 v[212:215], v19 offset:10240
 v_mfma_f32_16x16x32_bf16 v[128:131], a[220:223], v[180:183], v[128:131]
 buffer_load_dwordx4 v13, s[8:11], s30 offen offset:3072 lds
 v_mfma_f32_16x16x32_bf16 v[132:135], a[224:227], v[180:183], v[132:135]
 s_add_u32 s30, s30, 128
 s_add_u32 m0, m0, 16384
 v_mfma_f32_16x16x32_bf16 v[136:139], a[216:219], v[184:187], v[136:139]
 ds_read_b128 v[216:219], v19 offset:12288
 v_mfma_f32_16x16x32_bf16 v[140:143], a[220:223], v[184:187], v[140:143]
 s_cmp_lt_u32 m0, s46
 s_cselect_b32 m0, m0, s47
 v_mfma_f32_16x16x32_bf16 v[144:147], a[224:227], v[184:187], v[144:147]
 v_mfma_f32_16x16x32_bf16 v[148:151], a[216:219], v[188:191], v[148:151]
 ds_read_b128 v[220:223], v19 offset:14336
 v_mfma_f32_16x16x32_bf16 v[152:155], a[220:223], v[188:191], v[152:155]
 v_mfma_f32_16x16x32_bf16 v[156:159], a[224:227], v[188:191], v[156:159]
 s_waitcnt vmcnt(19) lgkmcnt(4)
 s_barrier
 v_mfma_f32_16x16x32_bf16 v[64:67], a[228:231], v[192:195], v[64:67]
 ds_read_b128 v[160:163], v18 offset:0
 v_mfma_f32_16x16x32_bf16 v[68:71], a[232:235], v[192:195], v[68:71]
 s_waitcnt vmcnt(22)
 s_cmp_eq_u32 s78, 0
 s_cbranch_scc1 pf_193
 v_mov_b32 v4, 0
 v_mov_b32 v5, 1
 s_mov_b64 exec, 1
 buffer_atomic_add v5, v4, s[72:75], s78 offen sc1
 s_mov_b64 exec, -1
 s_mov_b32 s78, 0
pf_193:
 buffer_load_dword v21, v33, s[72:75], s77 offen sc1
 v_mfma_f32_16x16x32_bf16 v[72:75], a[236:239], v[192:195], v[72:75]
 v_add_u32 v19, s33, v15
 s_add_u32 s33, s33, 16384
 v_mfma_f32_16x16x32_bf16 v[76:79], a[228:231], v[196:199], v[76:79]
 ds_read_b128 v[164:167], v18 offset:2048
 v_cvt_pk_bf16_f32 v224, v64, v65
 v_cvt_pk_bf16_f32 v225, v66, v67
 v_mfma_f32_16x16x32_bf16 v[80:83], a[232:235], v[196:199], v[80:83]
 buffer_load_dwordx4 v10, s[8:11], s30 offen offset:0 lds
 v_cvt_pk_bf16_f32 v226, v68, v69
 v_cvt_pk_bf16_f32 v227, v70, v71
 v_mfma_f32_16x16x32_bf16 v[84:87], a[236:239], v[196:199], v[84:87]
 s_cmp_lt_u32 s33, 98304
 s_cselect_b32 s33, s33, 0
 v_cvt_pk_bf16_f32 v228, v72, v73
 v_cvt_pk_bf16_f32 v229, v74, v75
 v_mfma_f32_16x16x32_bf16 v[88:91], a[228:231], v[200:203], v[88:91]
 ds_read_b128 v[168:171], v18 offset:4096
 ds_write_b64 v22, v[224:225] offset:0
 v_mfma_f32_16x16x32_bf16 v[92:95], a[232:235], v[200:203], v[92:95]
 ds_write_b64 v22, v[226:227] offset:8
 ds_write_b64 v16, v[228:229] offset:64
 v_mfma_f32_16x16x32_bf16 v[96:99], a[236:239], v[200:203], v[96:99]
 v_cvt_pk_bf16_f32 v230, v76, v77
 v_cvt_pk_bf16_f32 v231, v78, v79
 v_cvt_pk_bf16_f32 v232, v80, v81
 v_cvt_pk_bf16_f32 v233, v82, v83
 v_mfma_f32_16x16x32_bf16 v[100:103], a[228:231], v[204:207], v[100:103]
 ds_read_b128 v[172:175], v18 offset:6144
 v_cvt_pk_bf16_f32 v234, v84, v85
 v_cvt_pk_bf16_f32 v235, v86, v87
 v_mfma_f32_16x16x32_bf16 v[104:107], a[232:235], v[204:207], v[104:107]
 ds_write_b64 v22, v[230:231] offset:6400
 ds_write_b64 v22, v[232:233] offset:6408
 v_mfma_f32_16x16x32_bf16 v[108:111], a[236:239], v[204:207], v[108:111]
 s_waitcnt lgkmcnt(9)
 ds_write_b64 v16, v[234:235] offset:6464
 v_cvt_pk_bf16_f32 v224, v88, v89
 v_mfma_f32_16x16x32_bf16 v[112:115], a[228:231], v[208:211], v[112:115]
 ds_read_b128 v[176:179], v18 offset:8192
 v_cvt_pk_bf16_f32 v225, v90, v91
 v_cvt_pk_bf16_f32 v226, v92, v93
 v_cvt_pk_bf16_f32 v227, v94, v95
 v_mfma_f32_16x16x32_bf16 v[116:119], a[232:235], v[208:211], v[116:119]
 v_cvt_pk_bf16_f32 v228, v96, v97
 v_cvt_pk_bf16_f32 v229, v98, v99
 ds_write_b64 v22, v[224:225] offset:12800
 v_mfma_f32_16x16x32_bf16 v[120:123], a[236:239], v[208:211], v[120:123]
 ds_write_b64 v22, v[226:227] offset:12808
 ds_write_b64 v16, v[228:229] offset:12864
 v_mfma_f32_16x16x32_bf16 v[124:127], a[228:231], v[212:215], v[124:127]
 ds_read_b128 v[180:183], v18 offset:10240
 v_cvt_pk_bf16_f32 v230, v100, v101
 v_cvt_pk_bf16_f32 v231, v102, v103
 v_cvt_pk_bf16_f32 v232, v104, v105
 v_mfma_f32_16x16x32_bf16 v[128:131], a[232:235], v[212:215], v[128:131]
 buffer_load_dwordx4 v11, s[8:11], s30 offen offset:1024 lds
 v_cvt_pk_bf16_f32 v233, v106, v107
 v_cvt_pk_bf16_f32 v234, v108, v109
 v_mfma_f32_16x16x32_bf16 v[132:135], a[236:239], v[212:215], v[132:135]
 v_cvt_pk_bf16_f32 v235, v110, v111
 ds_write_b64 v22, v[230:231] offset:19200
 v_mfma_f32_16x16x32_bf16 v[136:139], a[228:231], v[216:219], v[136:139]
 ds_read_b128 v[184:187], v18 offset:12288
 ds_write_b64 v22, v[232:233] offset:19208
 v_mfma_f32_16x16x32_bf16 v[140:143], a[232:235], v[216:219], v[140:143]
 ds_write_b64 v16, v[234:235] offset:19264
 v_cvt_pk_bf16_f32 v224, v112, v113
 v_cvt_pk_bf16_f32 v225, v114, v115
 v_mfma_f32_16x16x32_bf16 v[144:147], a[236:239], v[216:219], v[144:147]
 v_cvt_pk_bf16_f32 v226, v116, v117
 v_cvt_pk_bf16_f32 v227, v118, v119
 v_cvt_pk_bf16_f32 v228, v120, v121
 v_cvt_pk_bf16_f32 v229, v122, v123
 v_mfma_f32_16x16x32_bf16 v[148:151], a[228:231], v[220:223], v[148:151]
 ds_read_b128 v[188:191], v18 offset:14336
 ds_write_b64 v22, v[224:225] offset:25600
 v_mfma_f32_16x16x32_bf16 v[152:155], a[232:235], v[220:223], v[152:155]
 ds_write_b64 v22, v[226:227] offset:25608
 ds_write_b64 v16, v[228:229] offset:25664
 v_mfma_f32_16x16x32_bf16 v[156:159], a[236:239], v[220:223], v[156:159]
 v_cvt_pk_bf16_f32 v230, v124, v125
 v_cvt_pk_bf16_f32 v231, v126, v127
 v_cvt_pk_bf16_f32 v232, v128, v129
 v_cvt_pk_bf16_f32 v233, v130, v131
qa_end_195:
 v_cvt_pk_bf16_f32 v234, v132, v133
 v_cvt_pk_bf16_f32 v235, v134, v135
 ds_write_b64 v22, v[230:231] offset:32000
 ds_write_b64 v22, v[232:233] offset:32008
 ds_write_b64 v16, v[234:235] offset:32064
 v_cvt_pk_bf16_f32 v224, v136, v137
 v_cvt_pk_bf16_f32 v225, v138, v139
 v_cvt_pk_bf16_f32 v226, v140, v141
 v_cvt_pk_bf16_f32 v227, v142, v143
 v_cvt_pk_bf16_f32 v228, v144, v145
 v_cvt_pk_bf16_f32 v229, v146, v147
 ds_write_b64 v22, v[224:225] offset:38400
 ds_write_b64 v22, v[226:227] offset:38408
 ds_write_b64 v16, v[228:229] offset:38464
 v_cvt_pk_bf16_f32 v230, v148, v149
 v_cvt_pk_bf16_f32 v231, v150, v151
 v_cvt_pk_bf16_f32 v232, v152, v153
 v_cvt_pk_bf16_f32 v233, v154, v155
 v_cvt_pk_bf16_f32 v234, v156, v157
 v_cvt_pk_bf16_f32 v235, v158, v159
 ds_write_b64 v22, v[230:231] offset:44800
 ds_write_b64 v22, v[232:233] offset:44808
 ds_write_b64 v16, v[234:235] offset:44864
 s_cmp_eq_u32 s80, 1
 s_cselect_b32 s21, s79, 0
 s_cmp_ge_u32 s21, 8
 s_cbranch_scc0 qx_198
 s_waitcnt lgkmcnt(0) vmcnt(5)
 s_barrier
 ds_read_b128 v[64:67], v29 offset:0
 ds_read_b128 v[88:91], v29 offset:6400
 ds_read_b128 v[68:71], v29 offset:64
 ds_read_b128 v[92:95], v29 offset:6464
 ds_read_b128 v[72:75], v29 offset:128
 ds_read_b128 v[96:99], v29 offset:6528
 ds_read_b128 v[76:79], v29 offset:192
 ds_read_b128 v[100:103], v29 offset:6592
 ds_read_b128 v[80:83], v29 offset:256
 ds_read_b128 v[104:107], v29 offset:6656
 ds_read_b128 v[84:87], v29 offset:320
 ds_read_b128 v[108:111], v29 offset:6720
 s_waitcnt lgkmcnt(10)
 v_mfma_f32_16x16x32_bf16 v[112:115], v[36:39], v[64:67], 0
 v_mfma_f32_16x16x32_bf16 v[116:119], a[240:243], v[64:67], 0
 v_mfma_f32_16x16x32_bf16 v[120:123], v[36:39], v[88:91], 0
 v_mfma_f32_16x16x32_bf16 v[124:127], v[60:63], v[88:91], 0
 v_mfma_f32_16x16x32_bf16 v[128:131], a[240:243], v[88:91], 0
 s_waitcnt lgkmcnt(8)
 v_mfma_f32_16x16x32_bf16 v[112:115], v[40:43], v[68:71], v[112:115]
 v_mfma_f32_16x16x32_bf16 v[116:119], a[244:247], v[68:71], v[116:119]
 v_mfma_f32_16x16x32_bf16 v[120:123], v[40:43], v[92:95], v[120:123]
 v_mfma_f32_16x16x32_bf16 v[124:127], v[236:239], v[92:95], v[124:127]
 v_mfma_f32_16x16x32_bf16 v[128:131], a[244:247], v[92:95], v[128:131]
 s_waitcnt lgkmcnt(6)
 v_mfma_f32_16x16x32_bf16 v[112:115], v[44:47], v[72:75], v[112:115]
 v_mfma_f32_16x16x32_bf16 v[116:119], a[248:251], v[72:75], v[116:119]
 v_mfma_f32_16x16x32_bf16 v[120:123], v[44:47], v[96:99], v[120:123]
 v_mfma_f32_16x16x32_bf16 v[124:127], v[240:243], v[96:99], v[124:127]
 v_mfma_f32_16x16x32_bf16 v[128:131], a[248:251], v[96:99], v[128:131]
 s_waitcnt lgkmcnt(4)
 v_mfma_f32_16x16x32_bf16 v[112:115], v[48:51], v[76:79], v[112:115]
 v_mfma_f32_16x16x32_bf16 v[116:119], a[252:255], v[76:79], v[116:119]
 v_mfma_f32_16x16x32_bf16 v[120:123], v[48:51], v[100:103], v[120:123]
 v_mfma_f32_16x16x32_bf16 v[124:127], v[244:247], v[100:103], v[124:127]
 v_mfma_f32_16x16x32_bf16 v[128:131], a[252:255], v[100:103], v[128:131]
 s_waitcnt lgkmcnt(2)
 v_mfma_f32_16x16x32_bf16 v[112:115], v[52:55], v[80:83], v[112:115]
 v_mfma_f32_16x16x32_bf16 v[116:119], v[24:27], v[80:83], v[116:119]
 v_mfma_f32_16x16x32_bf16 v[120:123], v[52:55], v[104:107], v[120:123]
 v_mfma_f32_16x16x32_bf16 v[124:127], v[248:251], v[104:107], v[124:127]
 v_mfma_f32_16x16x32_bf16 v[128:131], v[24:27], v[104:107], v[128:131]
 s_waitcnt lgkmcnt(0)
 v_mfma_f32_16x16x32_bf16 v[112:115], v[56:59], v[84:87], v[112:115]
 v_mfma_f32_16x16x32_bf16 v[116:119], v[6:9], v[84:87], v[116:119]
 v_mfma_f32_16x16x32_bf16 v[120:123], v[56:59], v[108:111], v[120:123]
 v_mfma_f32_16x16x32_bf16 v[124:127], v[252:255], v[108:111], v[124:127]
 v_mfma_f32_16x16x32_bf16 v[128:131], v[6:9], v[108:111], v[128:131]
 s_branch qx_197
qx_198:
 buffer_load_dword v21, v33, s[72:75], s77 offen sc1
 s_waitcnt vmcnt(0)
 s_mul_i32 s21, s49, 393216
 s_mul_i32 s22, s42, 12288
 s_add_u32 s50, s21, s22
 s_mul_i32 s21, s49, 98304
 s_mul_i32 s22, s42, 3072
 s_add_u32 s51, s21, s22
 s_lshr_b32 s22, s49, 1
 s_lshr_b32 s21, s49, 2
 s_add_u32 s21, s21, 2
 s_cmp_lt_u32 s49, 8
 s_cselect_b32 s21, s22, s21
 s_lshl_b32 s21, s21, 3
 s_lshr_b32 s22, s42, 2
 s_add_u32 s21, s21, s22
 s_lshl_b32 s21, s21, 7
 s_add_u32 s76, s21, 0
 s_lshl_b32 s77, s42, 7
 s_add_u32 s77, s77, 18432
 s_add_u32 s23, s49, 1
 s_waitcnt vmcnt(6)
 v_cmp_gt_u32 vcc, s23, v21
 s_mov_b32 s80, 0
 s_nop 0
 s_cbranch_vccnz qk_200
 s_mov_b32 s80, 1
 buffer_load_dwordx4 a[240:243], v31, s[52:55], s51 offen offset:0 sc1
 buffer_load_dwordx4 a[244:247], v31, s[52:55], s51 offen offset:512 sc1
 buffer_load_dwordx4 a[248:251], v31, s[52:55], s51 offen offset:1024 sc1
 buffer_load_dwordx4 a[252:255], v31, s[52:55], s51 offen offset:1536 sc1
 buffer_load_dwordx4 v[24:27], v31, s[52:55], s51 offen offset:2048 sc1
 buffer_load_dwordx4 v[6:9], v31, s[52:55], s51 offen offset:2560 sc1
qk_200:
 s_cmp_ge_u32 s79, 8
 s_cbranch_scc1 qk_199
 v_mov_b32 v156, 0
 s_mov_b32 s101, 0
wf_201:
 buffer_load_dword v157, v156, s[72:75], s76 offen sc1
 s_add_u32 s101, s101, 1
 s_cmp_gt_u32 s101, 131072
 s_cbranch_scc1 main_end
 s_waitcnt vmcnt(0)
 v_readfirstlane_b32 s100, v157
 s_cmp_ge_u32 s100, 8
 s_cbranch_scc1 wf_202
 s_sleep 2
 s_branch wf_201
wf_202:
 s_add_u32 s21, s50, 0
 buffer_load_dwordx4 v[36:39], v30, s[16:19], s21 offen offset:0 sc1
 buffer_load_dwordx4 v[40:43], v30, s[16:19], s21 offen offset:1024 sc1
 buffer_load_dwordx4 v[44:47], v30, s[16:19], s21 offen offset:2048 sc1
 buffer_load_dwordx4 v[48:51], v30, s[16:19], s21 offen offset:3072 sc1
 s_add_u32 s21, s50, 4096
 buffer_load_dwordx4 v[52:55], v30, s[16:19], s21 offen offset:0 sc1
 buffer_load_dwordx4 v[56:59], v30, s[16:19], s21 offen offset:1024 sc1
 buffer_load_dwordx4 v[60:63], v30, s[16:19], s21 offen offset:2048 sc1
 buffer_load_dwordx4 v[236:239], v30, s[16:19], s21 offen offset:3072 sc1
 s_add_u32 s21, s50, 8192
 buffer_load_dwordx4 v[240:243], v30, s[16:19], s21 offen offset:0 sc1
 buffer_load_dwordx4 v[244:247], v30, s[16:19], s21 offen offset:1024 sc1
 buffer_load_dwordx4 v[248:251], v30, s[16:19], s21 offen offset:2048 sc1
 buffer_load_dwordx4 v[252:255], v30, s[16:19], s21 offen offset:3072 sc1
qk_199:
 s_waitcnt lgkmcnt(0)
 s_barrier
 ds_read_b128 v[64:67], v29 offset:0
 ds_read_b128 v[68:71], v29 offset:64
 ds_read_b128 v[72:75], v29 offset:128
 ds_read_b128 v[76:79], v29 offset:192
 ds_read_b128 v[80:83], v29 offset:256
 ds_read_b128 v[84:87], v29 offset:320
 ds_read_b128 v[88:91], v29 offset:6400
 ds_read_b128 v[92:95], v29 offset:6464
 ds_read_b128 v[96:99], v29 offset:6528
 ds_read_b128 v[100:103], v29 offset:6592
 ds_read_b128 v[104:107], v29 offset:6656
 ds_read_b128 v[108:111], v29 offset:6720
 s_waitcnt lgkmcnt(0)
 s_cmp_eq_u32 s80, 1
 s_cselect_b32 s21, s79, 0
 s_cmp_ge_u32 s21, 8
 s_cbranch_scc1 qw_203
 s_waitcnt vmcnt(0)
qw_203:
 v_mfma_f32_16x16x32_bf16 v[112:115], v[36:39], v[64:67], 0
 v_mfma_f32_16x16x32_bf16 v[120:123], v[36:39], v[88:91], 0
 v_mfma_f32_16x16x32_bf16 v[124:127], v[60:63], v[88:91], 0
 v_mfma_f32_16x16x32_bf16 v[112:115], v[40:43], v[68:71], v[112:115]
 v_mfma_f32_16x16x32_bf16 v[120:123], v[40:43], v[92:95], v[120:123]
 v_mfma_f32_16x16x32_bf16 v[124:127], v[236:239], v[92:95], v[124:127]
 v_mfma_f32_16x16x32_bf16 v[112:115], v[44:47], v[72:75], v[112:115]
 v_mfma_f32_16x16x32_bf16 v[120:123], v[44:47], v[96:99], v[120:123]
 v_mfma_f32_16x16x32_bf16 v[124:127], v[240:243], v[96:99], v[124:127]
 v_mfma_f32_16x16x32_bf16 v[112:115], v[48:51], v[76:79], v[112:115]
 v_mfma_f32_16x16x32_bf16 v[120:123], v[48:51], v[100:103], v[120:123]
 v_mfma_f32_16x16x32_bf16 v[124:127], v[244:247], v[100:103], v[124:127]
 v_mfma_f32_16x16x32_bf16 v[112:115], v[52:55], v[80:83], v[112:115]
 v_mfma_f32_16x16x32_bf16 v[120:123], v[52:55], v[104:107], v[120:123]
 v_mfma_f32_16x16x32_bf16 v[124:127], v[248:251], v[104:107], v[124:127]
 v_mfma_f32_16x16x32_bf16 v[112:115], v[56:59], v[84:87], v[112:115]
 v_mfma_f32_16x16x32_bf16 v[120:123], v[56:59], v[108:111], v[120:123]
 v_mfma_f32_16x16x32_bf16 v[124:127], v[252:255], v[108:111], v[124:127]
 s_cmp_eq_u32 s80, 1
 s_cbranch_scc1 qm_204
 s_add_u32 s23, s49, 1
 s_mov_b32 s101, 0
wm_205:
 buffer_load_dword v156, v33, s[72:75], s77 offen sc1
 s_add_u32 s101, s101, 1
 s_cmp_gt_u32 s101, 131072
 s_cbranch_scc1 main_end
 s_waitcnt vmcnt(0)
 v_cmp_gt_u32 vcc, s23, v156
 v_readfirstlane_b32 s100, v156
 s_nop 0
 s_cbranch_vccz wm_206
 s_sleep 16
 s_add_u32 s100, s100, 2
 s_cmp_ge_u32 s100, s23
 s_cbranch_scc1 wm_205
 s_sleep 90
 s_branch wm_205
wm_206:
 buffer_load_dwordx4 a[240:243], v31, s[52:55], s51 offen offset:0 sc1
 buffer_load_dwordx4 a[244:247], v31, s[52:55], s51 offen offset:512 sc1
 buffer_load_dwordx4 a[248:251], v31, s[52:55], s51 offen offset:1024 sc1
 buffer_load_dwordx4 a[252:255], v31, s[52:55], s51 offen offset:1536 sc1
 buffer_load_dwordx4 v[24:27], v31, s[52:55], s51 offen offset:2048 sc1
 buffer_load_dwordx4 v[6:9], v31, s[52:55], s51 offen offset:2560 sc1
qm_204:
 s_waitcnt vmcnt(0)
 v_mfma_f32_16x16x32_bf16 v[116:119], a[240:243], v[64:67], 0
 v_mfma_f32_16x16x32_bf16 v[128:131], a[240:243], v[88:91], 0
 v_mfma_f32_16x16x32_bf16 v[116:119], a[244:247], v[68:71], v[116:119]
 v_mfma_f32_16x16x32_bf16 v[128:131], a[244:247], v[92:95], v[128:131]
 v_mfma_f32_16x16x32_bf16 v[116:119], a[248:251], v[72:75], v[116:119]
 v_mfma_f32_16x16x32_bf16 v[128:131], a[248:251], v[96:99], v[128:131]
 v_mfma_f32_16x16x32_bf16 v[116:119], a[252:255], v[76:79], v[116:119]
 v_mfma_f32_16x16x32_bf16 v[128:131], a[252:255], v[100:103], v[128:131]
 v_mfma_f32_16x16x32_bf16 v[116:119], v[24:27], v[80:83], v[116:119]
 v_mfma_f32_16x16x32_bf16 v[128:131], v[24:27], v[104:107], v[128:131]
 v_mfma_f32_16x16x32_bf16 v[116:119], v[6:9], v[84:87], v[116:119]
 v_mfma_f32_16x16x32_bf16 v[128:131], v[6:9], v[108:111], v[128:131]
qx_197:
 s_lshl_b32 s21, s49, 5
 s_add_u32 s21, s21, s42
 s_mul_i32 s81, s21, 2560
 s_lshl_b32 s82, s49, 3
 s_and_b32 s21, s42, 7
 s_add_u32 s82, s82, s21
 s_lshl_b32 s82, s82, 7
 s_add_u32 s82, s82, 22528
 s_cmp_gt_u32 s26, 1
 s_cselect_b32 s21, s80, 0
 s_cmp_eq_u32 s21, 0
 s_cbranch_scc1 qi_208
 v_mov_b32 v36, v112
 v_mov_b32 v37, v113
 v_mov_b32 v38, v114
 v_mov_b32 v39, v115
 v_mov_b32 v40, v116
 v_mov_b32 v41, v117
 v_mov_b32 v42, v118
 v_mov_b32 v43, v119
 v_mov_b32 v44, v120
 v_mov_b32 v45, v121
 v_mov_b32 v46, v122
 v_mov_b32 v47, v123
 v_mov_b32 v48, v124
 v_mov_b32 v49, v125
 v_mov_b32 v50, v126
 v_mov_b32 v51, v127
 v_mov_b32 v52, v128
 v_mov_b32 v53, v129
 v_mov_b32 v54, v130
 v_mov_b32 v55, v131
 s_branch qd_207
qi_208:
 v_cndmask_b32 v112, v34, v112, s[64:65]
 v_cndmask_b32 v124, v34, v124, s[64:65]
 v_cndmask_b32 v113, v34, v113, s[66:67]
 v_cndmask_b32 v125, v34, v125, s[66:67]
 v_cndmask_b32 v114, v34, v114, s[68:69]
 v_cndmask_b32 v126, v34, v126, s[68:69]
 v_cndmask_b32 v115, v34, v115, s[70:71]
 v_cndmask_b32 v127, v34, v127, s[70:71]
 v_max3_f32 v156, v112, v113, v114
 v_max3_f32 v156, v156, v115, v116
 v_max3_f32 v156, v156, v117, v118
 v_max_f32 v156, v156, v119
 v_mov_b32 v157, v156
 s_nop 1
 v_permlane32_swap_b32 v156, v157
 v_max_f32 v156, v156, v157
 v_mov_b32 v157, v156
 s_nop 1
 v_permlane16_swap_b32 v156, v157
 v_max_f32 v156, v156, v157
 v_mul_f32 v156, s83, v156
 v_fma_f32 v112, v112, s83, -v156
 v_fma_f32 v113, v113, s83, -v156
 v_fma_f32 v114, v114, s83, -v156
 v_fma_f32 v115, v115, s83, -v156
 v_fma_f32 v116, v116, s83, -v156
 v_fma_f32 v117, v117, s83, -v156
 v_fma_f32 v118, v118, s83, -v156
 v_fma_f32 v119, v119, s83, -v156
 v_exp_f32 v112, v112
 v_exp_f32 v113, v113
 v_exp_f32 v114, v114
 v_exp_f32 v115, v115
 v_exp_f32 v116, v116
 v_exp_f32 v117, v117
 v_exp_f32 v118, v118
 v_exp_f32 v119, v119
 s_nop 0
 v_add_f32 v156, v116, v117
 v_add_f32 v156, v156, v118
 v_add_f32 v156, v156, v119
 v_cndmask_b32 v156, 0, v156, s[60:61]
 v_add_f32 v156, v156, v112
 v_add_f32 v156, v156, v113
 v_add_f32 v156, v156, v114
 v_add_f32 v156, v156, v115
 v_mov_b32 v157, v156
 s_nop 1
 v_permlane32_swap_b32 v156, v157
 v_add_f32 v156, v156, v157
 v_mov_b32 v157, v156
 s_nop 1
 v_permlane16_swap_b32 v156, v157
 v_add_f32 v156, v156, v157
 v_rcp_f32 v156, v156
 s_nop 0
 v_mul_f32 v112, v112, v156
 v_mul_f32 v113, v113, v156
 v_mul_f32 v114, v114, v156
 v_mul_f32 v115, v115, v156
 v_mul_f32 v116, v116, v156
 v_mul_f32 v117, v117, v156
 v_mul_f32 v118, v118, v156
 v_mul_f32 v119, v119, v156
 v_max3_f32 v156, v120, v121, v122
 v_max3_f32 v156, v156, v123, v124
 v_max3_f32 v156, v156, v125, v126
 v_max3_f32 v156, v156, v127, v128
 v_max3_f32 v156, v156, v129, v130
 v_max_f32 v156, v156, v131
 v_mov_b32 v157, v156
 s_nop 1
 v_permlane32_swap_b32 v156, v157
 v_max_f32 v156, v156, v157
 v_mov_b32 v157, v156
 s_nop 1
 v_permlane16_swap_b32 v156, v157
 v_max_f32 v156, v156, v157
 v_mul_f32 v156, s83, v156
 v_fma_f32 v120, v120, s83, -v156
 v_fma_f32 v121, v121, s83, -v156
 v_fma_f32 v122, v122, s83, -v156
 v_fma_f32 v123, v123, s83, -v156
 v_fma_f32 v124, v124, s83, -v156
 v_fma_f32 v125, v125, s83, -v156
 v_fma_f32 v126, v126, s83, -v156
 v_fma_f32 v127, v127, s83, -v156
 v_fma_f32 v128, v128, s83, -v156
 v_fma_f32 v129, v129, s83, -v156
 v_fma_f32 v130, v130, s83, -v156
 v_fma_f32 v131, v131, s83, -v156
 v_exp_f32 v120, v120
 v_exp_f32 v121, v121
 v_exp_f32 v122, v122
 v_exp_f32 v123, v123
 v_exp_f32 v124, v124
 v_exp_f32 v125, v125
 v_exp_f32 v126, v126
 v_exp_f32 v127, v127
 v_exp_f32 v128, v128
 v_exp_f32 v129, v129
 v_exp_f32 v130, v130
 v_exp_f32 v131, v131
 s_nop 0
 v_add_f32 v156, v128, v129
 v_add_f32 v156, v156, v130
 v_add_f32 v156, v156, v131
 v_cndmask_b32 v156, 0, v156, s[60:61]
 v_add_f32 v156, v156, v120
 v_add_f32 v156, v156, v121
 v_add_f32 v156, v156, v122
 v_add_f32 v156, v156, v123
 v_add_f32 v156, v156, v124
 v_add_f32 v156, v156, v125
 v_add_f32 v156, v156, v126
 v_add_f32 v156, v156, v127
 v_mov_b32 v157, v156
 s_nop 1
 v_permlane32_swap_b32 v156, v157
 v_add_f32 v156, v156, v157
 v_mov_b32 v157, v156
 s_nop 1
 v_permlane16_swap_b32 v156, v157
 v_add_f32 v156, v156, v157
 v_rcp_f32 v156, v156
 s_nop 0
 v_mul_f32 v120, v120, v156
 v_mul_f32 v121, v121, v156
 v_mul_f32 v122, v122, v156
 v_mul_f32 v123, v123, v156
 v_mul_f32 v124, v124, v156
 v_mul_f32 v125, v125, v156
 v_mul_f32 v126, v126, v156
 v_mul_f32 v127, v127, v156
 v_mul_f32 v128, v128, v156
 v_mul_f32 v129, v129, v156
 v_mul_f32 v130, v130, v156
 v_mul_f32 v131, v131, v156
 v_cvt_pk_bf16_f32 v196, v116, v117
 v_cvt_pk_bf16_f32 v197, v118, v119
 v_cvt_pk_bf16_f32 v198, v128, v129
 v_cvt_pk_bf16_f32 v199, v130, v131
 v_cvt_pk_bf16_f32 v192, v120, v121
 v_cvt_pk_bf16_f32 v193, v122, v123
 v_cvt_pk_bf16_f32 v194, v124, v125
 v_cvt_pk_bf16_f32 v195, v126, v127
 v_cvt_pk_bf16_f32 v200, v112, v113
 v_cvt_pk_bf16_f32 v201, v114, v115
 v_permlane16_swap_b32 v196, v198
 v_permlane16_swap_b32 v197, v199
 buffer_store_dwordx4 v[192:195], v30, s[56:59], s81 offen sc1
 s_mov_b64 exec, 0xffffffff
 buffer_store_dwordx4 v[196:199], v30, s[56:59], s81 offen offset:1024 sc1
 s_mov_b64 exec, -1
 buffer_store_dwordx2 v[200:201], v32, s[56:59], s81 offen offset:2048 sc1
 s_mov_b32 s78, s82
 s_mov_b32 s81, 0x80000000
 s_mov_b32 s82, 0
 s_cmp_eq_u32 s80, 1
 s_cbranch_scc1 qd_207
 s_waitcnt vmcnt(0)
 s_cmp_eq_u32 s78, 0
 s_cbranch_scc1 pf_209
 v_mov_b32 v4, 0
 v_mov_b32 v5, 1
 s_mov_b64 exec, 1
 buffer_atomic_add v5, v4, s[72:75], s78 offen sc1
 s_mov_b64 exec, -1
 s_mov_b32 s78, 0
pf_209:
qd_207:
 s_add_u32 s49, s49, s29
qbe_196:
 s_sub_u32 s26, s26, 1
 s_cmp_gt_u32 s26, 0
 s_waitcnt lgkmcnt(0)
 s_cbranch_scc1 qa_blk_194
 s_waitcnt vmcnt(0) lgkmcnt(0)
 s_cmp_eq_u32 s78, 0
 s_cbranch_scc1 pf_210
 v_mov_b32 v4, 0
 v_mov_b32 v5, 1
 s_mov_b64 exec, 1
 buffer_atomic_add v5, v4, s[72:75], s78 offen sc1
 s_mov_b64 exec, -1
 s_mov_b32 s78, 0
pf_210:
 s_branch q_done
q_final:
 s_mov_b32 s16, s38
 s_mov_b32 s17, s39
 s_mov_b32 s18, 50331648
 s_mov_b32 s19, 0x00020000
 s_add_u32 s52, s38, 50331648
 s_addc_u32 s53, s39, 0
 s_mov_b32 s54, 6291456
 s_mov_b32 s55, 0x00020000
 s_add_u32 s56, s38, 85983232
 s_addc_u32 s57, s39, 0
 s_mov_b32 s58, 5242880
 s_mov_b32 s59, 0x00020000
 s_mul_i32 s21, s20, 12800
 s_add_u32 s21, s21, 98304
 v_mul_u32_u24 v4, 400, v2
 v_lshlrev_b32 v5, 4, v3
 v_add3_u32 v29, v4, v5, s21
 v_lshlrev_b32 v30, 4, v1
 v_and_b32 v4, 1, v2
 v_bfe_u32 v5, v2, 1, 1
 v_lshl_or_b32 v4, v5, 2, v4
 v_bfe_u32 v5, v2, 2, 1
 v_lshl_or_b32 v4, v5, 1, v4
 v_lshlrev_b32 v4, 4, v4
 v_lshl_add_u32 v31, v3, 7, v4
 v_lshlrev_b32 v32, 3, v1
 v_and_b32 v4, 3, v1
 v_lshlrev_b32 v33, 3, v4
 v_mov_b32 v34, 0xf149f2ca
 v_lshlrev_b32 v4, 2, v3
 v_sub_u32 v35, v2, v4
 v_cmp_gt_u32 s[60:61], 2, v3
 s_mov_b32 s62, 0x3d93cd3a
 s_mov_b32 s63, 0x3fb8aa3b
 s_mov_b32 s83, 0x3dd53b95
 v_cmp_le_i32 s[64:65], 0, v35
 v_cmp_le_i32 s[66:67], 1, v35
 v_cmp_le_i32 s[68:69], 2, v35
 v_cmp_le_i32 s[70:71], 3, v35
 s_add_u32 s49, s20, 56
 s_mov_b32 s29, 4
 s_mov_b32 s78, 0
 s_add_u32 s12, s38, 57671680
 s_addc_u32 s13, s39, 0
 s_mov_b32 s14, 3145728
 s_mov_b32 s15, 0x00020000
qf_211:
 s_mul_i32 s21, s49, 393216
 s_mul_i32 s22, s42, 12288
 s_add_u32 s50, s21, s22
 s_mul_i32 s21, s49, 98304
 s_mul_i32 s22, s42, 3072
 s_add_u32 s51, s21, s22
 s_lshr_b32 s22, s49, 1
 s_lshr_b32 s21, s49, 2
 s_add_u32 s21, s21, 2
 s_cmp_lt_u32 s49, 8
 s_cselect_b32 s21, s22, s21
 s_lshl_b32 s21, s21, 3
 s_lshr_b32 s22, s42, 2
 s_add_u32 s21, s21, s22
 s_lshl_b32 s21, s21, 7
 s_add_u32 s76, s21, 0
 s_lshl_b32 s77, s42, 7
 s_add_u32 s77, s77, 18432
 s_sub_u32 s43, s50, 22020096
 buffer_load_dword v21, v33, s[72:75], s77 offen sc1
 s_add_u32 s21, s50, 0
 buffer_load_dwordx4 v[36:39], v30, s[16:19], s21 offen offset:0 sc1
 buffer_load_dwordx4 v[40:43], v30, s[16:19], s21 offen offset:1024 sc1
 buffer_load_dwordx4 v[44:47], v30, s[16:19], s21 offen offset:2048 sc1
 buffer_load_dwordx4 v[48:51], v30, s[16:19], s21 offen offset:3072 sc1
 s_add_u32 s21, s50, 4096
 buffer_load_dwordx4 v[52:55], v30, s[16:19], s21 offen offset:0 sc1
 buffer_load_dwordx4 v[56:59], v30, s[16:19], s21 offen offset:1024 sc1
 buffer_load_dwordx4 v[60:63], v30, s[16:19], s21 offen offset:2048 sc1
 buffer_load_dwordx4 v[236:239], v30, s[16:19], s21 offen offset:3072 sc1
 s_add_u32 s21, s50, 8192
 buffer_load_dwordx4 v[240:243], v30, s[16:19], s21 offen offset:0 sc1
 buffer_load_dwordx4 v[244:247], v30, s[16:19], s21 offen offset:1024 sc1
 buffer_load_dwordx4 v[248:251], v30, s[16:19], s21 offen offset:2048 sc1
 buffer_load_dwordx4 v[252:255], v30, s[16:19], s21 offen offset:3072 sc1
 s_add_u32 s21, s43, 0
 buffer_load_dwordx4 v[64:67], v30, s[12:15], s21 offen offset:0 sc1
 buffer_load_dwordx4 v[68:71], v30, s[12:15], s21 offen offset:1024 sc1
 buffer_load_dwordx4 v[72:75], v30, s[12:15], s21 offen offset:2048 sc1
 buffer_load_dwordx4 v[76:79], v30, s[12:15], s21 offen offset:3072 sc1
 s_add_u32 s21, s43, 4096
 buffer_load_dwordx4 v[80:83], v30, s[12:15], s21 offen offset:0 sc1
 buffer_load_dwordx4 v[84:87], v30, s[12:15], s21 offen offset:1024 sc1
 buffer_load_dwordx4 v[88:91], v30, s[12:15], s21 offen offset:2048 sc1
 buffer_load_dwordx4 v[92:95], v30, s[12:15], s21 offen offset:3072 sc1
 s_add_u32 s21, s43, 8192
 buffer_load_dwordx4 v[96:99], v30, s[12:15], s21 offen offset:0 sc1
 buffer_load_dwordx4 v[100:103], v30, s[12:15], s21 offen offset:1024 sc1
 buffer_load_dwordx4 v[104:107], v30, s[12:15], s21 offen offset:2048 sc1
 buffer_load_dwordx4 v[108:111], v30, s[12:15], s21 offen offset:3072 sc1
 s_waitcnt vmcnt(24)
 s_cmp_eq_u32 s78, 0
 s_cbranch_scc1 pf_215
 v_mov_b32 v4, 0
 v_mov_b32 v5, 1
 s_mov_b64 exec, 1
 buffer_atomic_add v5, v4, s[72:75], s78 offen sc1
 s_mov_b64 exec, -1
 s_mov_b32 s78, 0
pf_215:
 s_add_u32 s23, s49, 1
 v_cmp_gt_u32 vcc, s23, v21
 s_mov_b32 s80, 0
 s_nop 0
 s_cbranch_vccnz qk_214
 s_mov_b32 s80, 1
 buffer_load_dwordx4 v[132:135], v31, s[52:55], s51 offen offset:0 sc1
 buffer_load_dwordx4 v[136:139], v31, s[52:55], s51 offen offset:512 sc1
 buffer_load_dwordx4 v[140:143], v31, s[52:55], s51 offen offset:1024 sc1
 buffer_load_dwordx4 v[144:147], v31, s[52:55], s51 offen offset:1536 sc1
 buffer_load_dwordx4 v[148:151], v31, s[52:55], s51 offen offset:2048 sc1
 buffer_load_dwordx4 v[152:155], v31, s[52:55], s51 offen offset:2560 sc1
 s_waitcnt vmcnt(6)
 s_branch qk_214x
qk_214:
 s_waitcnt vmcnt(0)
qk_214x:
 v_mfma_f32_16x16x32_bf16 v[112:115], v[36:39], v[64:67], 0
 v_mfma_f32_16x16x32_bf16 v[120:123], v[36:39], v[88:91], 0
 v_mfma_f32_16x16x32_bf16 v[124:127], v[60:63], v[88:91], 0
 v_mfma_f32_16x16x32_bf16 v[112:115], v[40:43], v[68:71], v[112:115]
 v_mfma_f32_16x16x32_bf16 v[120:123], v[40:43], v[92:95], v[120:123]
 v_mfma_f32_16x16x32_bf16 v[124:127], v[236:239], v[92:95], v[124:127]
 v_mfma_f32_16x16x32_bf16 v[112:115], v[44:47], v[72:75], v[112:115]
 v_mfma_f32_16x16x32_bf16 v[120:123], v[44:47], v[96:99], v[120:123]
 v_mfma_f32_16x16x32_bf16 v[124:127], v[240:243], v[96:99], v[124:127]
 v_mfma_f32_16x16x32_bf16 v[112:115], v[48:51], v[76:79], v[112:115]
 v_mfma_f32_16x16x32_bf16 v[120:123], v[48:51], v[100:103], v[120:123]
 v_mfma_f32_16x16x32_bf16 v[124:127], v[244:247], v[100:103], v[124:127]
 v_mfma_f32_16x16x32_bf16 v[112:115], v[52:55], v[80:83], v[112:115]
 v_mfma_f32_16x16x32_bf16 v[120:123], v[52:55], v[104:107], v[120:123]
 v_mfma_f32_16x16x32_bf16 v[124:127], v[248:251], v[104:107], v[124:127]
 v_mfma_f32_16x16x32_bf16 v[112:115], v[56:59], v[84:87], v[112:115]
 v_mfma_f32_16x16x32_bf16 v[120:123], v[56:59], v[108:111], v[120:123]
 v_mfma_f32_16x16x32_bf16 v[124:127], v[252:255], v[108:111], v[124:127]
 s_cmp_eq_u32 s80, 1
 s_cbranch_scc1 qm_216
 s_add_u32 s23, s49, 1
 s_min_u32 s22, s49, 61
 s_cmp_lt_u32 s49, 58
 s_cselect_b32 s23, s23, s22
 s_mov_b32 s101, 0
wm_217:
 buffer_load_dword v156, v33, s[72:75], s77 offen sc1
 s_add_u32 s101, s101, 1
 s_cmp_gt_u32 s101, 131072
 s_cbranch_scc1 main_end
 s_waitcnt vmcnt(0)
 v_cmp_gt_u32 vcc, s23, v156
 v_readfirstlane_b32 s100, v156
 s_nop 0
 s_cbranch_vccz wm_218
 s_sleep 16
 s_add_u32 s100, s100, 2
 s_cmp_ge_u32 s100, s23
 s_cbranch_scc1 wm_217
 s_sleep 90
 s_branch wm_217
wm_218:
 s_cmp_eq_u32 s49, 63
 s_cselect_b32 s21, s101, 0
 s_cmp_lt_u32 s21, 2
 s_cbranch_scc1 qtz_221
 s_sleep 36
qtz_221:
 s_mov_b32 s101, 0
 s_branch qtp_220
qtp_219:
 s_sleep 3
qtp_220:
 buffer_load_dwordx4 v[132:135], v31, s[52:55], s51 offen offset:0 sc1
 buffer_load_dwordx4 v[136:139], v31, s[52:55], s51 offen offset:512 sc1
 buffer_load_dwordx4 v[140:143], v31, s[52:55], s51 offen offset:1024 sc1
 buffer_load_dwordx4 v[144:147], v31, s[52:55], s51 offen offset:1536 sc1
 buffer_load_dwordx4 v[148:151], v31, s[52:55], s51 offen offset:2048 sc1
 buffer_load_dwordx4 v[152:155], v31, s[52:55], s51 offen offset:2560 sc1
 s_add_u32 s101, s101, 1
 s_cmp_gt_u32 s101, 131072
 s_cbranch_scc1 main_end
 s_waitcnt vmcnt(0)
 v_max3_u32 v156, v132, v134, v136
 v_max3_u32 v156, v156, v138, v140
 v_max3_u32 v156, v156, v142, v144
 v_max3_u32 v156, v156, v146, v148
 v_max3_u32 v156, v156, v150, v152
 v_max3_u32 v156, v156, v154, v154
 v_cmp_eq_u32 vcc, -1, v156
 s_nop 1
 s_cbranch_vccnz qtp_219
qm_216:
 s_waitcnt vmcnt(0)
 v_mfma_f32_16x16x32_bf16 v[116:119], v[132:135], v[64:67], 0
 v_mfma_f32_16x16x32_bf16 v[128:131], v[132:135], v[88:91], 0
 v_mfma_f32_16x16x32_bf16 v[116:119], v[136:139], v[68:71], v[116:119]
 v_mfma_f32_16x16x32_bf16 v[128:131], v[136:139], v[92:95], v[128:131]
 v_mfma_f32_16x16x32_bf16 v[116:119], v[140:143], v[72:75], v[116:119]
 v_mfma_f32_16x16x32_bf16 v[128:131], v[140:143], v[96:99], v[128:131]
 v_mfma_f32_16x16x32_bf16 v[116:119], v[144:147], v[76:79], v[116:119]
 v_mfma_f32_16x16x32_bf16 v[128:131], v[144:147], v[100:103], v[128:131]
 v_mfma_f32_16x16x32_bf16 v[116:119], v[148:151], v[80:83], v[116:119]
 v_mfma_f32_16x16x32_bf16 v[128:131], v[148:151], v[104:107], v[128:131]
 v_mfma_f32_16x16x32_bf16 v[116:119], v[152:155], v[84:87], v[116:119]
 v_mfma_f32_16x16x32_bf16 v[128:131], v[152:155], v[108:111], v[128:131]
qx_213:
 s_lshl_b32 s21, s49, 5
 s_add_u32 s21, s21, s42
 s_mul_i32 s81, s21, 2560
 s_lshl_b32 s82, s49, 3
 s_and_b32 s21, s42, 7
 s_add_u32 s82, s82, s21
 s_lshl_b32 s82, s82, 7
 s_add_u32 s82, s82, 22528
 v_cndmask_b32 v112, v34, v112, s[64:65]
 v_cndmask_b32 v124, v34, v124, s[64:65]
 v_cndmask_b32 v113, v34, v113, s[66:67]
 v_cndmask_b32 v125, v34, v125, s[66:67]
 v_cndmask_b32 v114, v34, v114, s[68:69]
 v_cndmask_b32 v126, v34, v126, s[68:69]
 v_cndmask_b32 v115, v34, v115, s[70:71]
 v_cndmask_b32 v127, v34, v127, s[70:71]
 v_max3_f32 v156, v112, v113, v114
 v_max3_f32 v156, v156, v115, v116
 v_max3_f32 v156, v156, v117, v118
 v_max_f32 v156, v156, v119
 v_mov_b32 v157, v156
 s_nop 1
 v_permlane32_swap_b32 v156, v157
 v_max_f32 v156, v156, v157
 v_mov_b32 v157, v156
 s_nop 1
 v_permlane16_swap_b32 v156, v157
 v_max_f32 v156, v156, v157
 v_mul_f32 v156, s83, v156
 v_fma_f32 v112, v112, s83, -v156
 v_fma_f32 v113, v113, s83, -v156
 v_fma_f32 v114, v114, s83, -v156
 v_fma_f32 v115, v115, s83, -v156
 v_fma_f32 v116, v116, s83, -v156
 v_fma_f32 v117, v117, s83, -v156
 v_fma_f32 v118, v118, s83, -v156
 v_fma_f32 v119, v119, s83, -v156
 v_exp_f32 v112, v112
 v_exp_f32 v113, v113
 v_exp_f32 v114, v114
 v_exp_f32 v115, v115
 v_exp_f32 v116, v116
 v_exp_f32 v117, v117
 v_exp_f32 v118, v118
 v_exp_f32 v119, v119
 s_nop 0
 v_add_f32 v156, v116, v117
 v_add_f32 v156, v156, v118
 v_add_f32 v156, v156, v119
 v_cndmask_b32 v156, 0, v156, s[60:61]
 v_add_f32 v156, v156, v112
 v_add_f32 v156, v156, v113
 v_add_f32 v156, v156, v114
 v_add_f32 v156, v156, v115
 v_mov_b32 v157, v156
 s_nop 1
 v_permlane32_swap_b32 v156, v157
 v_add_f32 v156, v156, v157
 v_mov_b32 v157, v156
 s_nop 1
 v_permlane16_swap_b32 v156, v157
 v_add_f32 v156, v156, v157
 v_rcp_f32 v156, v156
 s_nop 0
 v_mul_f32 v112, v112, v156
 v_mul_f32 v113, v113, v156
 v_mul_f32 v114, v114, v156
 v_mul_f32 v115, v115, v156
 v_mul_f32 v116, v116, v156
 v_mul_f32 v117, v117, v156
 v_mul_f32 v118, v118, v156
 v_mul_f32 v119, v119, v156
 v_max3_f32 v156, v120, v121, v122
 v_max3_f32 v156, v156, v123, v124
 v_max3_f32 v156, v156, v125, v126
 v_max3_f32 v156, v156, v127, v128
 v_max3_f32 v156, v156, v129, v130
 v_max_f32 v156, v156, v131
 v_mov_b32 v157, v156
 s_nop 1
 v_permlane32_swap_b32 v156, v157
 v_max_f32 v156, v156, v157
 v_mov_b32 v157, v156
 s_nop 1
 v_permlane16_swap_b32 v156, v157
 v_max_f32 v156, v156, v157
 v_mul_f32 v156, s83, v156
 v_fma_f32 v120, v120, s83, -v156
 v_fma_f32 v121, v121, s83, -v156
 v_fma_f32 v122, v122, s83, -v156
 v_fma_f32 v123, v123, s83, -v156
 v_fma_f32 v124, v124, s83, -v156
 v_fma_f32 v125, v125, s83, -v156
 v_fma_f32 v126, v126, s83, -v156
 v_fma_f32 v127, v127, s83, -v156
 v_fma_f32 v128, v128, s83, -v156
 v_fma_f32 v129, v129, s83, -v156
 v_fma_f32 v130, v130, s83, -v156
 v_fma_f32 v131, v131, s83, -v156
 v_exp_f32 v120, v120
 v_exp_f32 v121, v121
 v_exp_f32 v122, v122
 v_exp_f32 v123, v123
 v_exp_f32 v124, v124
 v_exp_f32 v125, v125
 v_exp_f32 v126, v126
 v_exp_f32 v127, v127
 v_exp_f32 v128, v128
 v_exp_f32 v129, v129
 v_exp_f32 v130, v130
 v_exp_f32 v131, v131
 s_nop 0
 v_add_f32 v156, v128, v129
 v_add_f32 v156, v156, v130
 v_add_f32 v156, v156, v131
 v_cndmask_b32 v156, 0, v156, s[60:61]
 v_add_f32 v156, v156, v120
 v_add_f32 v156, v156, v121
 v_add_f32 v156, v156, v122
 v_add_f32 v156, v156, v123
 v_add_f32 v156, v156, v124
 v_add_f32 v156, v156, v125
 v_add_f32 v156, v156, v126
 v_add_f32 v156, v156, v127
 v_mov_b32 v157, v156
 s_nop 1
 v_permlane32_swap_b32 v156, v157
 v_add_f32 v156, v156, v157
 v_mov_b32 v157, v156
 s_nop 1
 v_permlane16_swap_b32 v156, v157
 v_add_f32 v156, v156, v157
 v_rcp_f32 v156, v156
 s_nop 0
 v_mul_f32 v120, v120, v156
 v_mul_f32 v121, v121, v156
 v_mul_f32 v122, v122, v156
 v_mul_f32 v123, v123, v156
 v_mul_f32 v124, v124, v156
 v_mul_f32 v125, v125, v156
 v_mul_f32 v126, v126, v156
 v_mul_f32 v127, v127, v156
 v_mul_f32 v128, v128, v156
 v_mul_f32 v129, v129, v156
 v_mul_f32 v130, v130, v156
 v_mul_f32 v131, v131, v156
 v_cvt_pk_bf16_f32 v196, v116, v117
 v_cvt_pk_bf16_f32 v197, v118, v119
 v_cvt_pk_bf16_f32 v198, v128, v129
 v_cvt_pk_bf16_f32 v199, v130, v131
 v_cvt_pk_bf16_f32 v192, v120, v121
 v_cvt_pk_bf16_f32 v193, v122, v123
 v_cvt_pk_bf16_f32 v194, v124, v125
 v_cvt_pk_bf16_f32 v195, v126, v127
 v_cvt_pk_bf16_f32 v200, v112, v113
 v_cvt_pk_bf16_f32 v201, v114, v115
 v_permlane16_swap_b32 v196, v198
 v_permlane16_swap_b32 v197, v199
 buffer_store_dwordx4 v[192:195], v30, s[56:59], s81 offen sc1
 s_mov_b64 exec, 0xffffffff
 buffer_store_dwordx4 v[196:199], v30, s[56:59], s81 offen offset:1024 sc1
 s_mov_b64 exec, -1
 buffer_store_dwordx2 v[200:201], v32, s[56:59], s81 offen offset:2048 sc1
 s_mov_b32 s78, s82
 s_mov_b32 s81, 0x80000000
 s_mov_b32 s82, 0
 s_cmp_eq_u32 s80, 1
 s_cbranch_scc1 qd_222
 s_waitcnt vmcnt(0)
 s_cmp_eq_u32 s78, 0
 s_cbranch_scc1 pf_223
 v_mov_b32 v4, 0
 v_mov_b32 v5, 1
 s_mov_b64 exec, 1
 buffer_atomic_add v5, v4, s[72:75], s78 offen sc1
 s_mov_b64 exec, -1
 s_mov_b32 s78, 0
pf_223:
qd_222:
 s_add_u32 s49, s49, s29
qbe_212:
 s_cmp_lt_u32 s49, 64
 s_cbranch_scc1 qf_211
 s_waitcnt vmcnt(0)
 s_cmp_eq_u32 s78, 0
 s_cbranch_scc1 pf_224
 v_mov_b32 v4, 0
 v_mov_b32 v5, 1
 s_mov_b64 exec, 1
 buffer_atomic_add v5, v4, s[72:75], s78 offen sc1
 s_mov_b64 exec, -1
 s_mov_b32 s78, 0
pf_224:
 s_branch queue
q_done:
 s_and_b32 s21, s3, 3
 s_cmp_lt_u32 s21, 2
 s_cbranch_scc1 queue
 s_sub_u32 s21, s21, 2
 s_lshl_b32 s21, s21, 3
 s_bfe_u32 s22, s3, 0x30002
 s_add_u32 s21, s21, s22
 s_add_u32 s87, s21, 236
 s_branch tail_item
queue:
 s_load_dwordx2 s[4:5], s[0:1], 96
 s_waitcnt lgkmcnt(0)
 s_mov_b32 s32, s4
 s_mov_b32 s33, s5
 s_mov_b32 s34, 256
 s_mov_b32 s35, 0x00020000
 s_waitcnt vmcnt(0) lgkmcnt(0)
 s_barrier
 s_mov_b32 s2, s85
 s_mov_b32 s85, -1
 s_cmp_lg_u32 s2, -1
 s_cbranch_scc1 queue_c
 v_mov_b32 v21, 0
 s_cmp_lg_u32 s20, 0
 s_cbranch_scc1 q_225
 v_mov_b32 v22, 80
 v_mov_b32 v23, 1
 s_mov_b64 exec, 1
 buffer_atomic_add v23, v22, s[32:35], 0 offen sc0 sc1
 s_waitcnt vmcnt(0)
queue_a:
 ds_write_b32 v21, v23
 s_waitcnt lgkmcnt(0)
 s_mov_b64 exec, -1
q_225:
queue_b:
 s_barrier
 ds_read_b32 v23, v21
 s_waitcnt lgkmcnt(0)
 v_readfirstlane_b32 s2, v23
 s_barrier
queue_c:
 s_add_u32 s21, s2, 0
 s_cmp_lt_u32 s2, 164
 s_cbranch_scc1 do_pv
 s_sub_u32 s2, s2, 164
 s_add_u32 s21, s2, 204
 s_cmp_lt_u32 s2, 32
 s_cbranch_scc1 do_pv
 s_sub_u32 s2, s2, 32
 s_add_u32 s21, s2, 164
 s_cmp_lt_u32 s2, 40
 s_cbranch_scc1 do_pv
 s_sub_u32 s2, s2, 40
 s_branch main_fin
do_opb:
 s_mov_b32 s87, -1
do_opb2:
 s_mov_b32 s2, s21
 s_load_dwordx2 s[4:5], s[0:1], 0
 s_load_dwordx4 s[40:43], s[0:1], 72
 s_load_dwordx2 s[38:39], s[0:1], 104
 s_lshl_b32 s59, s2, 2
 s_add_u32 s59, s59, s20
 s_lshl_b32 s59, s59, 3
 v_lshlrev_b32 v4, 4, v1
 v_lshlrev_b32 v5, 2, v1
 s_waitcnt lgkmcnt(0)
 s_mov_b32 s8, s4
 s_mov_b32 s9, s5
 s_mov_b32 s10, 2621440
 s_mov_b32 s11, 0x00020000
 s_mov_b32 s12, s42
 s_mov_b32 s13, s43
 s_mov_b32 s14, 1280
 s_mov_b32 s15, 0x00020000
 s_mov_b32 s24, s40
 s_mov_b32 s25, s41
 s_mov_b32 s26, 819200
 s_mov_b32 s27, 0x00020000
 s_add_u32 s16, s38, 70713344
 s_addc_u32 s17, s39, 0
 s_mov_b32 s18, 2641920
 s_mov_b32 s19, 0x00020000
 s_add_u32 s28, s38, 81002496
 s_addc_u32 s29, s39, 0
 s_mov_b32 s30, 8192
 s_mov_b32 s31, 0x00020000
 s_add_u32 s72, s38, 81068032
 s_addc_u32 s73, s39, 0
 s_mov_b32 s74, 128000
 s_mov_b32 s75, 0x00020000
 s_cmp_ge_u32 s2, 32
 s_cbranch_scc1 mw_226
 s_lshr_b32 s21, s2, 2
 s_lshl_b32 s21, s21, 7
 s_add_u32 s21, s21, 115712
 s_cmp_lg_u32 s20, 0
 s_cbranch_scc1 wf_228
 v_mov_b32 v20, 0
 s_mov_b32 s101, 0
wf_227:
 buffer_load_dword v21, v20, s[72:75], s21 offen sc1
 s_add_u32 s101, s101, 1
 s_cmp_gt_u32 s101, 131072
 s_cbranch_scc1 main_end
 s_waitcnt vmcnt(0)
 v_readfirstlane_b32 s100, v21
 s_cmp_ge_u32 s100, 32
 s_cbranch_scc1 wf_228
 s_sleep 32
 s_branch wf_227
wf_228:
 s_barrier
mw_226:
 s_mov_b32 s21, 90112
 v_mov_b32 v20, 0
 buffer_load_dword v21, v20, s[72:75], s21 offen sc1
 v_mov_b32 v29, 3277
 s_mul_i32 s21, s20, 320
 s_add_u32 s21, s21, 0
 v_add_u32 v22, s21, v1
 v_mul_u32_u24 v23, v22, v29
 v_lshrrev_b32 v23, 16, v23
 v_mul_u32_u24 v24, 20, v23
 v_sub_u32 v22, v22, v24
 v_bfe_u32 v24, v23, 3, 1
 v_lshlrev_b32 v24, 1, v24
 v_xor_b32 v22, v22, v24
 v_mul_u32_u24 v23, 1280, v23
 v_lshl_add_u32 v8, v22, 4, v23
 s_mul_i32 s21, s20, 320
 s_add_u32 s21, s21, 64
 v_add_u32 v22, s21, v1
 v_mul_u32_u24 v23, v22, v29
 v_lshrrev_b32 v23, 16, v23
 v_mul_u32_u24 v24, 20, v23
 v_sub_u32 v22, v22, v24
 v_bfe_u32 v24, v23, 3, 1
 v_lshlrev_b32 v24, 1, v24
 v_xor_b32 v22, v22, v24
 v_mul_u32_u24 v23, 1280, v23
 v_lshl_add_u32 v9, v22, 4, v23
 s_mul_i32 s21, s20, 320
 s_add_u32 s21, s21, 128
 v_add_u32 v22, s21, v1
 v_mul_u32_u24 v23, v22, v29
 v_lshrrev_b32 v23, 16, v23
 v_mul_u32_u24 v24, 20, v23
 v_sub_u32 v22, v22, v24
 v_bfe_u32 v24, v23, 3, 1
 v_lshlrev_b32 v24, 1, v24
 v_xor_b32 v22, v22, v24
 v_mul_u32_u24 v23, 1280, v23
 v_lshl_add_u32 v10, v22, 4, v23
 s_mul_i32 s21, s20, 320
 s_add_u32 s21, s21, 192
 v_add_u32 v22, s21, v1
 v_mul_u32_u24 v23, v22, v29
 v_lshrrev_b32 v23, 16, v23
 v_mul_u32_u24 v24, 20, v23
 v_sub_u32 v22, v22, v24
 v_bfe_u32 v24, v23, 3, 1
 v_lshlrev_b32 v24, 1, v24
 v_xor_b32 v22, v22, v24
 v_mul_u32_u24 v23, 1280, v23
 v_lshl_add_u32 v11, v22, 4, v23
 s_mul_i32 s21, s20, 320
 s_add_u32 s21, s21, 256
 v_add_u32 v22, s21, v1
 v_mul_u32_u24 v23, v22, v29
 v_lshrrev_b32 v23, 16, v23
 v_mul_u32_u24 v24, 20, v23
 v_sub_u32 v22, v22, v24
 v_bfe_u32 v24, v23, 3, 1
 v_lshlrev_b32 v24, 1, v24
 v_xor_b32 v22, v22, v24
 v_mul_u32_u24 v23, 1280, v23
 v_lshl_add_u32 v12, v22, 4, v23
 s_and_b32 s44, s2, 3
 s_mul_i32 s45, s44, 320
 s_mul_i32 s46, s20, 5120
 v_and_b32 v22, 1, v2
 v_mul_u32_u24 v22, 16512, v22
 v_mul_u32_u24 v23, 33024, v3
 v_lshrrev_b32 v24, 1, v2
 v_lshlrev_b32 v24, 4, v24
 v_add3_u32 v6, v22, v23, v24
 s_lshr_b32 s47, s2, 2
 s_lshl_b32 s47, s47, 2
 s_add_u32 s47, s47, s20
 s_lshl_b32 s47, s47, 1
 s_lshl_b32 s48, s47, 7
 v_lshrrev_b32 v22, 2, v2
 v_lshl_add_u32 v22, v3, 3, v22
 v_mul_u32_u24 v22, 320, v22
 v_and_b32 v23, 3, v2
 v_lshl_add_u32 v22, v23, 3, v22
 v_and_b32 v23, 1, v3
 v_lshlrev_b32 v23, 5, v23
 v_add_u32 v14, v22, v23
 v_sub_u32 v15, v22, v23
 v_add_u32 v16, 61440, v14
 v_add_u32 v17, 61440, v15
 v_add_u32 v18, 122880, v14
 v_add_u32 v19, 122880, v15
 s_add_u32 m0, s46, 0
 s_add_u32 s49, s45, 0
 s_nop 0
 buffer_load_dwordx4 v8, s[24:27], s49 offen lds
 s_add_u32 m0, s46, 1024
 s_nop 0
 buffer_load_dwordx4 v9, s[24:27], s49 offen lds
 s_add_u32 m0, s46, 2048
 s_nop 0
 buffer_load_dwordx4 v10, s[24:27], s49 offen lds
 s_add_u32 m0, s46, 3072
 s_nop 0
 buffer_load_dwordx4 v11, s[24:27], s49 offen lds
 s_add_u32 m0, s46, 4096
 s_nop 0
 buffer_load_dwordx4 v12, s[24:27], s49 offen lds
 s_add_u32 m0, s46, 20480
 s_add_u32 s49, s45, 81920
 s_nop 0
 buffer_load_dwordx4 v8, s[24:27], s49 offen lds
 s_add_u32 m0, s46, 21504
 s_nop 0
 buffer_load_dwordx4 v9, s[24:27], s49 offen lds
 s_add_u32 m0, s46, 22528
 s_nop 0
 buffer_load_dwordx4 v10, s[24:27], s49 offen lds
 s_add_u32 m0, s46, 23552
 s_nop 0
 buffer_load_dwordx4 v11, s[24:27], s49 offen lds
 s_add_u32 m0, s46, 24576
 s_nop 0
 buffer_load_dwordx4 v12, s[24:27], s49 offen lds
 s_waitcnt vmcnt(10)
 v_readfirstlane_b32 s21, v21
 s_cmp_ge_u32 s21, 32
 s_cbranch_scc1 o2_229
 s_mov_b32 s21, 90112
 v_mov_b32 v20, 0
 s_mov_b32 s101, 0
wf_230:
 buffer_load_dword v21, v20, s[72:75], s21 offen sc1
 s_add_u32 s101, s101, 1
 s_cmp_gt_u32 s101, 131072
 s_cbranch_scc1 main_end
 s_waitcnt vmcnt(0)
 v_readfirstlane_b32 s100, v21
 s_cmp_ge_u32 s100, 32
 s_cbranch_scc1 wf_231
 s_sleep 32
 s_branch wf_230
wf_231:
o2_229:
 buffer_load_dwordx4 a[0:3], v6, s[16:19], s48 offen offset:0 sc1
 buffer_load_dwordx4 a[4:7], v6, s[16:19], s48 offen offset:128 sc1
 s_add_u32 s48, s48, 132096
 buffer_load_dwordx4 a[8:11], v6, s[16:19], s48 offen offset:0 sc1
 buffer_load_dwordx4 a[12:15], v6, s[16:19], s48 offen offset:128 sc1
 s_add_u32 s48, s48, 132096
 buffer_load_dwordx4 a[16:19], v6, s[16:19], s48 offen offset:0 sc1
 buffer_load_dwordx4 a[20:23], v6, s[16:19], s48 offen offset:128 sc1
 s_add_u32 s48, s48, 132096
 buffer_load_dwordx4 a[24:27], v6, s[16:19], s48 offen offset:0 sc1
 buffer_load_dwordx4 a[28:31], v6, s[16:19], s48 offen offset:128 sc1
 s_add_u32 s48, s48, 132096
 s_add_u32 m0, s46, 40960
 s_add_u32 s49, s45, 163840
 s_nop 0
 buffer_load_dwordx4 v8, s[24:27], s49 offen lds
 s_add_u32 m0, s46, 41984
 s_nop 0
 buffer_load_dwordx4 v9, s[24:27], s49 offen lds
 s_add_u32 m0, s46, 43008
 s_nop 0
 buffer_load_dwordx4 v10, s[24:27], s49 offen lds
 s_add_u32 m0, s46, 44032
 s_nop 0
 buffer_load_dwordx4 v11, s[24:27], s49 offen lds
 s_add_u32 m0, s46, 45056
 s_nop 0
 buffer_load_dwordx4 v12, s[24:27], s49 offen lds
 buffer_load_dwordx4 a[32:35], v6, s[16:19], s48 offen offset:0 sc1
 buffer_load_dwordx4 a[36:39], v6, s[16:19], s48 offen offset:128 sc1
 s_add_u32 s48, s48, 132096
 buffer_load_dwordx4 a[40:43], v6, s[16:19], s48 offen offset:0 sc1
 buffer_load_dwordx4 a[44:47], v6, s[16:19], s48 offen offset:128 sc1
 s_add_u32 s48, s48, 132096
 s_add_u32 m0, s46, 61440
 s_add_u32 s49, s45, 245760
 s_nop 0
 buffer_load_dwordx4 v8, s[24:27], s49 offen lds
 s_add_u32 m0, s46, 62464
 s_nop 0
 buffer_load_dwordx4 v9, s[24:27], s49 offen lds
 s_add_u32 m0, s46, 63488
 s_nop 0
 buffer_load_dwordx4 v10, s[24:27], s49 offen lds
 s_add_u32 m0, s46, 64512
 s_nop 0
 buffer_load_dwordx4 v11, s[24:27], s49 offen lds
 s_add_u32 m0, s46, 65536
 s_nop 0
 buffer_load_dwordx4 v12, s[24:27], s49 offen lds
 buffer_load_dwordx4 a[48:51], v6, s[16:19], s48 offen offset:0 sc1
 buffer_load_dwordx4 a[52:55], v6, s[16:19], s48 offen offset:128 sc1
 s_add_u32 s48, s48, 132096
 buffer_load_dwordx4 a[56:59], v6, s[16:19], s48 offen offset:0 sc1
 buffer_load_dwordx4 a[60:63], v6, s[16:19], s48 offen offset:128 sc1
 s_add_u32 s48, s48, 132096
 s_add_u32 m0, s46, 81920
 s_add_u32 s49, s45, 327680
 s_nop 0
 buffer_load_dwordx4 v8, s[24:27], s49 offen lds
 s_add_u32 m0, s46, 82944
 s_nop 0
 buffer_load_dwordx4 v9, s[24:27], s49 offen lds
 s_add_u32 m0, s46, 83968
 s_nop 0
 buffer_load_dwordx4 v10, s[24:27], s49 offen lds
 s_add_u32 m0, s46, 84992
 s_nop 0
 buffer_load_dwordx4 v11, s[24:27], s49 offen lds
 s_add_u32 m0, s46, 86016
 s_nop 0
 buffer_load_dwordx4 v12, s[24:27], s49 offen lds
 buffer_load_dwordx4 a[64:67], v6, s[16:19], s48 offen offset:0 sc1
 buffer_load_dwordx4 a[68:71], v6, s[16:19], s48 offen offset:128 sc1
 s_add_u32 s48, s48, 132096
 buffer_load_dwordx4 a[72:75], v6, s[16:19], s48 offen offset:0 sc1
 buffer_load_dwordx4 a[76:79], v6, s[16:19], s48 offen offset:128 sc1
 s_add_u32 s48, s48, 132096
 s_add_u32 m0, s46, 102400
 s_add_u32 s49, s45, 409600
 s_nop 0
 buffer_load_dwordx4 v8, s[24:27], s49 offen lds
 s_add_u32 m0, s46, 103424
 s_nop 0
 buffer_load_dwordx4 v9, s[24:27], s49 offen lds
 s_add_u32 m0, s46, 104448
 s_nop 0
 buffer_load_dwordx4 v10, s[24:27], s49 offen lds
 s_add_u32 m0, s46, 105472
 s_nop 0
 buffer_load_dwordx4 v11, s[24:27], s49 offen lds
 s_add_u32 m0, s46, 106496
 s_nop 0
 buffer_load_dwordx4 v12, s[24:27], s49 offen lds
 s_add_u32 m0, s46, 122880
 s_add_u32 s49, s45, 491520
 s_nop 0
 buffer_load_dwordx4 v8, s[24:27], s49 offen lds
 s_add_u32 m0, s46, 123904
 s_nop 0
 buffer_load_dwordx4 v9, s[24:27], s49 offen lds
 s_add_u32 m0, s46, 124928
 s_nop 0
 buffer_load_dwordx4 v10, s[24:27], s49 offen lds
 s_add_u32 m0, s46, 125952
 s_nop 0
 buffer_load_dwordx4 v11, s[24:27], s49 offen lds
 s_add_u32 m0, s46, 126976
 s_nop 0
 buffer_load_dwordx4 v12, s[24:27], s49 offen lds
 s_waitcnt vmcnt(50)
 s_barrier
 ds_read_b64_tr_b16 v[144:145], v14 offset:0
 ds_read_b64_tr_b16 v[146:147], v14 offset:1280
 ds_read_b64_tr_b16 v[148:149], v15 offset:32
 ds_read_b64_tr_b16 v[150:151], v15 offset:1312
 ds_read_b64_tr_b16 v[152:153], v14 offset:64
 ds_read_b64_tr_b16 v[154:155], v14 offset:1344
 ds_read_b64_tr_b16 v[156:157], v15 offset:96
 ds_read_b64_tr_b16 v[158:159], v15 offset:1376
 ds_read_b64_tr_b16 v[160:161], v14 offset:128
 ds_read_b64_tr_b16 v[162:163], v14 offset:1408
 ds_read_b64_tr_b16 v[164:165], v15 offset:160
 ds_read_b64_tr_b16 v[166:167], v15 offset:1440
 ds_read_b64_tr_b16 v[168:169], v14 offset:192
 ds_read_b64_tr_b16 v[170:171], v14 offset:1472
 ds_read_b64_tr_b16 v[172:173], v15 offset:224
 ds_read_b64_tr_b16 v[174:175], v15 offset:1504
 ds_read_b64_tr_b16 v[176:177], v14 offset:256
 ds_read_b64_tr_b16 v[178:179], v14 offset:1536
 ds_read_b64_tr_b16 v[180:181], v15 offset:288
 ds_read_b64_tr_b16 v[182:183], v15 offset:1568
 s_waitcnt lgkmcnt(0) vmcnt(43)
 v_mfma_f32_16x16x32_bf16 v[64:67], v[144:147], a[0:3], 0
 ds_read_b64_tr_b16 v[184:185], v14 offset:10240
 ds_read_b64_tr_b16 v[186:187], v14 offset:11520
 v_mfma_f32_16x16x32_bf16 v[104:107], v[144:147], a[4:7], 0
 ds_read_b64_tr_b16 v[188:189], v15 offset:10272
 v_mfma_f32_16x16x32_bf16 v[68:71], v[148:151], a[0:3], 0
 ds_read_b64_tr_b16 v[190:191], v15 offset:11552
 v_mfma_f32_16x16x32_bf16 v[108:111], v[148:151], a[4:7], 0
 ds_read_b64_tr_b16 v[192:193], v14 offset:10304
 v_mfma_f32_16x16x32_bf16 v[72:75], v[152:155], a[0:3], 0
 ds_read_b64_tr_b16 v[194:195], v14 offset:11584
 v_mfma_f32_16x16x32_bf16 v[112:115], v[152:155], a[4:7], 0
 ds_read_b64_tr_b16 v[196:197], v15 offset:10336
 ds_read_b64_tr_b16 v[198:199], v15 offset:11616
 v_mfma_f32_16x16x32_bf16 v[76:79], v[156:159], a[0:3], 0
 ds_read_b64_tr_b16 v[200:201], v14 offset:10368
 v_mfma_f32_16x16x32_bf16 v[116:119], v[156:159], a[4:7], 0
 ds_read_b64_tr_b16 v[202:203], v14 offset:11648
 v_mfma_f32_16x16x32_bf16 v[80:83], v[160:163], a[0:3], 0
 ds_read_b64_tr_b16 v[204:205], v15 offset:10400
 v_mfma_f32_16x16x32_bf16 v[120:123], v[160:163], a[4:7], 0
 ds_read_b64_tr_b16 v[206:207], v15 offset:11680
 v_mfma_f32_16x16x32_bf16 v[84:87], v[164:167], a[0:3], 0
 ds_read_b64_tr_b16 v[208:209], v14 offset:10432
 v_mfma_f32_16x16x32_bf16 v[124:127], v[164:167], a[4:7], 0
 ds_read_b64_tr_b16 v[210:211], v14 offset:11712
 ds_read_b64_tr_b16 v[212:213], v15 offset:10464
 v_mfma_f32_16x16x32_bf16 v[88:91], v[168:171], a[0:3], 0
 ds_read_b64_tr_b16 v[214:215], v15 offset:11744
 v_mfma_f32_16x16x32_bf16 v[128:131], v[168:171], a[4:7], 0
 buffer_load_dwordx4 a[80:83], v6, s[16:19], s48 offen offset:0 sc1
 ds_read_b64_tr_b16 v[216:217], v14 offset:10496
 v_mfma_f32_16x16x32_bf16 v[92:95], v[172:175], a[0:3], 0
 ds_read_b64_tr_b16 v[218:219], v14 offset:11776
 v_mfma_f32_16x16x32_bf16 v[132:135], v[172:175], a[4:7], 0
 ds_read_b64_tr_b16 v[220:221], v15 offset:10528
 v_mfma_f32_16x16x32_bf16 v[96:99], v[176:179], a[0:3], 0
 ds_read_b64_tr_b16 v[222:223], v15 offset:11808
 v_mfma_f32_16x16x32_bf16 v[136:139], v[176:179], a[4:7], 0
 buffer_load_dwordx4 a[84:87], v6, s[16:19], s48 offen offset:128 sc1
 v_mfma_f32_16x16x32_bf16 v[100:103], v[180:183], a[0:3], 0
 s_add_u32 s48, s48, 132096
 v_mfma_f32_16x16x32_bf16 v[140:143], v[180:183], a[4:7], 0
 s_waitcnt lgkmcnt(0) vmcnt(43)
 s_barrier
 v_mfma_f32_16x16x32_bf16 v[64:67], v[184:187], a[8:11], v[64:67]
 s_add_u32 m0, s46, 0
 ds_read_b64_tr_b16 v[144:145], v14 offset:20480
 ds_read_b64_tr_b16 v[146:147], v14 offset:21760
 v_mfma_f32_16x16x32_bf16 v[104:107], v[184:187], a[12:15], v[104:107]
 s_add_u32 s49, s45, 573440
 ds_read_b64_tr_b16 v[148:149], v15 offset:20512
 v_mfma_f32_16x16x32_bf16 v[68:71], v[188:191], a[8:11], v[68:71]
 buffer_load_dwordx4 v8, s[24:27], s49 offen lds
 ds_read_b64_tr_b16 v[150:151], v15 offset:21792
 v_mfma_f32_16x16x32_bf16 v[108:111], v[188:191], a[12:15], v[108:111]
 s_add_u32 m0, s46, 1024
 ds_read_b64_tr_b16 v[152:153], v14 offset:20544
 v_mfma_f32_16x16x32_bf16 v[72:75], v[192:195], a[8:11], v[72:75]
 buffer_load_dwordx4 v9, s[24:27], s49 offen lds
 ds_read_b64_tr_b16 v[154:155], v14 offset:21824
 v_mfma_f32_16x16x32_bf16 v[112:115], v[192:195], a[12:15], v[112:115]
 s_add_u32 m0, s46, 2048
 ds_read_b64_tr_b16 v[156:157], v15 offset:20576
 ds_read_b64_tr_b16 v[158:159], v15 offset:21856
 v_mfma_f32_16x16x32_bf16 v[76:79], v[196:199], a[8:11], v[76:79]
 buffer_load_dwordx4 v10, s[24:27], s49 offen lds
 ds_read_b64_tr_b16 v[160:161], v14 offset:20608
 v_mfma_f32_16x16x32_bf16 v[116:119], v[196:199], a[12:15], v[116:119]
 s_add_u32 m0, s46, 3072
 ds_read_b64_tr_b16 v[162:163], v14 offset:21888
 v_mfma_f32_16x16x32_bf16 v[80:83], v[200:203], a[8:11], v[80:83]
 buffer_load_dwordx4 v11, s[24:27], s49 offen lds
 ds_read_b64_tr_b16 v[164:165], v15 offset:20640
 v_mfma_f32_16x16x32_bf16 v[120:123], v[200:203], a[12:15], v[120:123]
 s_add_u32 m0, s46, 4096
 ds_read_b64_tr_b16 v[166:167], v15 offset:21920
 v_mfma_f32_16x16x32_bf16 v[84:87], v[204:207], a[8:11], v[84:87]
 buffer_load_dwordx4 v12, s[24:27], s49 offen lds
 ds_read_b64_tr_b16 v[168:169], v14 offset:20672
 v_mfma_f32_16x16x32_bf16 v[124:127], v[204:207], a[12:15], v[124:127]
 ds_read_b64_tr_b16 v[170:171], v14 offset:21952
 ds_read_b64_tr_b16 v[172:173], v15 offset:20704
 v_mfma_f32_16x16x32_bf16 v[88:91], v[208:211], a[8:11], v[88:91]
 ds_read_b64_tr_b16 v[174:175], v15 offset:21984
 v_mfma_f32_16x16x32_bf16 v[128:131], v[208:211], a[12:15], v[128:131]
 buffer_load_dwordx4 a[88:91], v6, s[16:19], s48 offen offset:0 sc1
 ds_read_b64_tr_b16 v[176:177], v14 offset:20736
 v_mfma_f32_16x16x32_bf16 v[92:95], v[212:215], a[8:11], v[92:95]
 ds_read_b64_tr_b16 v[178:179], v14 offset:22016
 v_mfma_f32_16x16x32_bf16 v[132:135], v[212:215], a[12:15], v[132:135]
 ds_read_b64_tr_b16 v[180:181], v15 offset:20768
 v_mfma_f32_16x16x32_bf16 v[96:99], v[216:219], a[8:11], v[96:99]
 ds_read_b64_tr_b16 v[182:183], v15 offset:22048
 v_mfma_f32_16x16x32_bf16 v[136:139], v[216:219], a[12:15], v[136:139]
 buffer_load_dwordx4 a[92:95], v6, s[16:19], s48 offen offset:128 sc1
 v_mfma_f32_16x16x32_bf16 v[100:103], v[220:223], a[8:11], v[100:103]
 s_add_u32 s48, s48, 132096
 v_mfma_f32_16x16x32_bf16 v[140:143], v[220:223], a[12:15], v[140:143]
 s_waitcnt lgkmcnt(0) vmcnt(48)
 v_mfma_f32_16x16x32_bf16 v[64:67], v[144:147], a[16:19], v[64:67]
 ds_read_b64_tr_b16 v[184:185], v14 offset:30720
 ds_read_b64_tr_b16 v[186:187], v14 offset:32000
 v_mfma_f32_16x16x32_bf16 v[104:107], v[144:147], a[20:23], v[104:107]
 ds_read_b64_tr_b16 v[188:189], v15 offset:30752
 v_mfma_f32_16x16x32_bf16 v[68:71], v[148:151], a[16:19], v[68:71]
 ds_read_b64_tr_b16 v[190:191], v15 offset:32032
 v_mfma_f32_16x16x32_bf16 v[108:111], v[148:151], a[20:23], v[108:111]
 ds_read_b64_tr_b16 v[192:193], v14 offset:30784
 v_mfma_f32_16x16x32_bf16 v[72:75], v[152:155], a[16:19], v[72:75]
 ds_read_b64_tr_b16 v[194:195], v14 offset:32064
 v_mfma_f32_16x16x32_bf16 v[112:115], v[152:155], a[20:23], v[112:115]
 ds_read_b64_tr_b16 v[196:197], v15 offset:30816
 ds_read_b64_tr_b16 v[198:199], v15 offset:32096
 v_mfma_f32_16x16x32_bf16 v[76:79], v[156:159], a[16:19], v[76:79]
 ds_read_b64_tr_b16 v[200:201], v14 offset:30848
 v_mfma_f32_16x16x32_bf16 v[116:119], v[156:159], a[20:23], v[116:119]
 ds_read_b64_tr_b16 v[202:203], v14 offset:32128
 v_mfma_f32_16x16x32_bf16 v[80:83], v[160:163], a[16:19], v[80:83]
 ds_read_b64_tr_b16 v[204:205], v15 offset:30880
 v_mfma_f32_16x16x32_bf16 v[120:123], v[160:163], a[20:23], v[120:123]
 ds_read_b64_tr_b16 v[206:207], v15 offset:32160
 v_mfma_f32_16x16x32_bf16 v[84:87], v[164:167], a[16:19], v[84:87]
 ds_read_b64_tr_b16 v[208:209], v14 offset:30912
 v_mfma_f32_16x16x32_bf16 v[124:127], v[164:167], a[20:23], v[124:127]
 ds_read_b64_tr_b16 v[210:211], v14 offset:32192
 ds_read_b64_tr_b16 v[212:213], v15 offset:30944
 v_mfma_f32_16x16x32_bf16 v[88:91], v[168:171], a[16:19], v[88:91]
 ds_read_b64_tr_b16 v[214:215], v15 offset:32224
 v_mfma_f32_16x16x32_bf16 v[128:131], v[168:171], a[20:23], v[128:131]
 buffer_load_dwordx4 a[96:99], v6, s[16:19], s48 offen offset:0 sc1
 ds_read_b64_tr_b16 v[216:217], v14 offset:30976
 v_mfma_f32_16x16x32_bf16 v[92:95], v[172:175], a[16:19], v[92:95]
 ds_read_b64_tr_b16 v[218:219], v14 offset:32256
 v_mfma_f32_16x16x32_bf16 v[132:135], v[172:175], a[20:23], v[132:135]
 ds_read_b64_tr_b16 v[220:221], v15 offset:31008
 v_mfma_f32_16x16x32_bf16 v[96:99], v[176:179], a[16:19], v[96:99]
 ds_read_b64_tr_b16 v[222:223], v15 offset:32288
 v_mfma_f32_16x16x32_bf16 v[136:139], v[176:179], a[20:23], v[136:139]
 buffer_load_dwordx4 a[100:103], v6, s[16:19], s48 offen offset:128 sc1
 v_mfma_f32_16x16x32_bf16 v[100:103], v[180:183], a[16:19], v[100:103]
 s_add_u32 s48, s48, 132096
 v_mfma_f32_16x16x32_bf16 v[140:143], v[180:183], a[20:23], v[140:143]
 s_waitcnt lgkmcnt(0) vmcnt(43)
 s_barrier
 v_mfma_f32_16x16x32_bf16 v[64:67], v[184:187], a[24:27], v[64:67]
 s_add_u32 m0, s46, 20480
 ds_read_b64_tr_b16 v[144:145], v14 offset:40960
 ds_read_b64_tr_b16 v[146:147], v14 offset:42240
 v_mfma_f32_16x16x32_bf16 v[104:107], v[184:187], a[28:31], v[104:107]
 s_add_u32 s49, s45, 655360
 ds_read_b64_tr_b16 v[148:149], v15 offset:40992
 v_mfma_f32_16x16x32_bf16 v[68:71], v[188:191], a[24:27], v[68:71]
 buffer_load_dwordx4 v8, s[24:27], s49 offen lds
 ds_read_b64_tr_b16 v[150:151], v15 offset:42272
 v_mfma_f32_16x16x32_bf16 v[108:111], v[188:191], a[28:31], v[108:111]
 s_add_u32 m0, s46, 21504
 ds_read_b64_tr_b16 v[152:153], v14 offset:41024
 v_mfma_f32_16x16x32_bf16 v[72:75], v[192:195], a[24:27], v[72:75]
 buffer_load_dwordx4 v9, s[24:27], s49 offen lds
 ds_read_b64_tr_b16 v[154:155], v14 offset:42304
 v_mfma_f32_16x16x32_bf16 v[112:115], v[192:195], a[28:31], v[112:115]
 s_add_u32 m0, s46, 22528
 ds_read_b64_tr_b16 v[156:157], v15 offset:41056
 ds_read_b64_tr_b16 v[158:159], v15 offset:42336
 v_mfma_f32_16x16x32_bf16 v[76:79], v[196:199], a[24:27], v[76:79]
 buffer_load_dwordx4 v10, s[24:27], s49 offen lds
 ds_read_b64_tr_b16 v[160:161], v14 offset:41088
 v_mfma_f32_16x16x32_bf16 v[116:119], v[196:199], a[28:31], v[116:119]
 s_add_u32 m0, s46, 23552
 ds_read_b64_tr_b16 v[162:163], v14 offset:42368
 v_mfma_f32_16x16x32_bf16 v[80:83], v[200:203], a[24:27], v[80:83]
 buffer_load_dwordx4 v11, s[24:27], s49 offen lds
 ds_read_b64_tr_b16 v[164:165], v15 offset:41120
 v_mfma_f32_16x16x32_bf16 v[120:123], v[200:203], a[28:31], v[120:123]
 s_add_u32 m0, s46, 24576
 ds_read_b64_tr_b16 v[166:167], v15 offset:42400
 v_mfma_f32_16x16x32_bf16 v[84:87], v[204:207], a[24:27], v[84:87]
 buffer_load_dwordx4 v12, s[24:27], s49 offen lds
 ds_read_b64_tr_b16 v[168:169], v14 offset:41152
 v_mfma_f32_16x16x32_bf16 v[124:127], v[204:207], a[28:31], v[124:127]
 ds_read_b64_tr_b16 v[170:171], v14 offset:42432
 ds_read_b64_tr_b16 v[172:173], v15 offset:41184
 v_mfma_f32_16x16x32_bf16 v[88:91], v[208:211], a[24:27], v[88:91]
 ds_read_b64_tr_b16 v[174:175], v15 offset:42464
 v_mfma_f32_16x16x32_bf16 v[128:131], v[208:211], a[28:31], v[128:131]
 buffer_load_dwordx4 a[104:107], v6, s[16:19], s48 offen offset:0 sc1
 ds_read_b64_tr_b16 v[176:177], v14 offset:41216
 v_mfma_f32_16x16x32_bf16 v[92:95], v[212:215], a[24:27], v[92:95]
 ds_read_b64_tr_b16 v[178:179], v14 offset:42496
 v_mfma_f32_16x16x32_bf16 v[132:135], v[212:215], a[28:31], v[132:135]
 ds_read_b64_tr_b16 v[180:181], v15 offset:41248
 v_mfma_f32_16x16x32_bf16 v[96:99], v[216:219], a[24:27], v[96:99]
 ds_read_b64_tr_b16 v[182:183], v15 offset:42528
 v_mfma_f32_16x16x32_bf16 v[136:139], v[216:219], a[28:31], v[136:139]
 buffer_load_dwordx4 a[108:111], v6, s[16:19], s48 offen offset:128 sc1
 v_mfma_f32_16x16x32_bf16 v[100:103], v[220:223], a[24:27], v[100:103]
 s_add_u32 s48, s48, 132096
 v_mfma_f32_16x16x32_bf16 v[140:143], v[220:223], a[28:31], v[140:143]
 s_waitcnt lgkmcnt(0) vmcnt(48)
 v_mfma_f32_16x16x32_bf16 v[64:67], v[144:147], a[32:35], v[64:67]
 ds_read_b64_tr_b16 v[184:185], v14 offset:51200
 ds_read_b64_tr_b16 v[186:187], v14 offset:52480
 v_mfma_f32_16x16x32_bf16 v[104:107], v[144:147], a[36:39], v[104:107]
 ds_read_b64_tr_b16 v[188:189], v15 offset:51232
 v_mfma_f32_16x16x32_bf16 v[68:71], v[148:151], a[32:35], v[68:71]
 ds_read_b64_tr_b16 v[190:191], v15 offset:52512
 v_mfma_f32_16x16x32_bf16 v[108:111], v[148:151], a[36:39], v[108:111]
 ds_read_b64_tr_b16 v[192:193], v14 offset:51264
 v_mfma_f32_16x16x32_bf16 v[72:75], v[152:155], a[32:35], v[72:75]
 ds_read_b64_tr_b16 v[194:195], v14 offset:52544
 v_mfma_f32_16x16x32_bf16 v[112:115], v[152:155], a[36:39], v[112:115]
 ds_read_b64_tr_b16 v[196:197], v15 offset:51296
 ds_read_b64_tr_b16 v[198:199], v15 offset:52576
 v_mfma_f32_16x16x32_bf16 v[76:79], v[156:159], a[32:35], v[76:79]
 ds_read_b64_tr_b16 v[200:201], v14 offset:51328
 v_mfma_f32_16x16x32_bf16 v[116:119], v[156:159], a[36:39], v[116:119]
 ds_read_b64_tr_b16 v[202:203], v14 offset:52608
 v_mfma_f32_16x16x32_bf16 v[80:83], v[160:163], a[32:35], v[80:83]
 ds_read_b64_tr_b16 v[204:205], v15 offset:51360
 v_mfma_f32_16x16x32_bf16 v[120:123], v[160:163], a[36:39], v[120:123]
 ds_read_b64_tr_b16 v[206:207], v15 offset:52640
 v_mfma_f32_16x16x32_bf16 v[84:87], v[164:167], a[32:35], v[84:87]
 ds_read_b64_tr_b16 v[208:209], v14 offset:51392
 v_mfma_f32_16x16x32_bf16 v[124:127], v[164:167], a[36:39], v[124:127]
 ds_read_b64_tr_b16 v[210:211], v14 offset:52672
 ds_read_b64_tr_b16 v[212:213], v15 offset:51424
 v_mfma_f32_16x16x32_bf16 v[88:91], v[168:171], a[32:35], v[88:91]
 ds_read_b64_tr_b16 v[214:215], v15 offset:52704
 v_mfma_f32_16x16x32_bf16 v[128:131], v[168:171], a[36:39], v[128:131]
 buffer_load_dwordx4 a[112:115], v6, s[16:19], s48 offen offset:0 sc1
 ds_read_b64_tr_b16 v[216:217], v14 offset:51456
 v_mfma_f32_16x16x32_bf16 v[92:95], v[172:175], a[32:35], v[92:95]
 ds_read_b64_tr_b16 v[218:219], v14 offset:52736
 v_mfma_f32_16x16x32_bf16 v[132:135], v[172:175], a[36:39], v[132:135]
 ds_read_b64_tr_b16 v[220:221], v15 offset:51488
 v_mfma_f32_16x16x32_bf16 v[96:99], v[176:179], a[32:35], v[96:99]
 ds_read_b64_tr_b16 v[222:223], v15 offset:52768
 v_mfma_f32_16x16x32_bf16 v[136:139], v[176:179], a[36:39], v[136:139]
 buffer_load_dwordx4 a[116:119], v6, s[16:19], s48 offen offset:128 sc1
 v_mfma_f32_16x16x32_bf16 v[100:103], v[180:183], a[32:35], v[100:103]
 s_add_u32 s48, s48, 132096
 v_mfma_f32_16x16x32_bf16 v[140:143], v[180:183], a[36:39], v[140:143]
 s_waitcnt lgkmcnt(0) vmcnt(43)
 s_barrier
 v_mfma_f32_16x16x32_bf16 v[64:67], v[184:187], a[40:43], v[64:67]
 s_add_u32 m0, s46, 40960
 ds_read_b64_tr_b16 v[144:145], v16 offset:0
 ds_read_b64_tr_b16 v[146:147], v16 offset:1280
 v_mfma_f32_16x16x32_bf16 v[104:107], v[184:187], a[44:47], v[104:107]
 s_add_u32 s49, s45, 737280
 ds_read_b64_tr_b16 v[148:149], v17 offset:32
 v_mfma_f32_16x16x32_bf16 v[68:71], v[188:191], a[40:43], v[68:71]
 buffer_load_dwordx4 v8, s[24:27], s49 offen lds
 ds_read_b64_tr_b16 v[150:151], v17 offset:1312
 v_mfma_f32_16x16x32_bf16 v[108:111], v[188:191], a[44:47], v[108:111]
 s_add_u32 m0, s46, 41984
 ds_read_b64_tr_b16 v[152:153], v16 offset:64
 v_mfma_f32_16x16x32_bf16 v[72:75], v[192:195], a[40:43], v[72:75]
 buffer_load_dwordx4 v9, s[24:27], s49 offen lds
 ds_read_b64_tr_b16 v[154:155], v16 offset:1344
 v_mfma_f32_16x16x32_bf16 v[112:115], v[192:195], a[44:47], v[112:115]
 s_add_u32 m0, s46, 43008
 ds_read_b64_tr_b16 v[156:157], v17 offset:96
 ds_read_b64_tr_b16 v[158:159], v17 offset:1376
 v_mfma_f32_16x16x32_bf16 v[76:79], v[196:199], a[40:43], v[76:79]
 buffer_load_dwordx4 v10, s[24:27], s49 offen lds
 ds_read_b64_tr_b16 v[160:161], v16 offset:128
 v_mfma_f32_16x16x32_bf16 v[116:119], v[196:199], a[44:47], v[116:119]
 s_add_u32 m0, s46, 44032
 ds_read_b64_tr_b16 v[162:163], v16 offset:1408
 v_mfma_f32_16x16x32_bf16 v[80:83], v[200:203], a[40:43], v[80:83]
 buffer_load_dwordx4 v11, s[24:27], s49 offen lds
 ds_read_b64_tr_b16 v[164:165], v17 offset:160
 v_mfma_f32_16x16x32_bf16 v[120:123], v[200:203], a[44:47], v[120:123]
 s_add_u32 m0, s46, 45056
 ds_read_b64_tr_b16 v[166:167], v17 offset:1440
 v_mfma_f32_16x16x32_bf16 v[84:87], v[204:207], a[40:43], v[84:87]
 buffer_load_dwordx4 v12, s[24:27], s49 offen lds
 ds_read_b64_tr_b16 v[168:169], v16 offset:192
 v_mfma_f32_16x16x32_bf16 v[124:127], v[204:207], a[44:47], v[124:127]
 ds_read_b64_tr_b16 v[170:171], v16 offset:1472
 ds_read_b64_tr_b16 v[172:173], v17 offset:224
 v_mfma_f32_16x16x32_bf16 v[88:91], v[208:211], a[40:43], v[88:91]
 ds_read_b64_tr_b16 v[174:175], v17 offset:1504
 v_mfma_f32_16x16x32_bf16 v[128:131], v[208:211], a[44:47], v[128:131]
 buffer_load_dwordx4 a[120:123], v6, s[16:19], s48 offen offset:0 sc1
 ds_read_b64_tr_b16 v[176:177], v16 offset:256
 v_mfma_f32_16x16x32_bf16 v[92:95], v[212:215], a[40:43], v[92:95]
 ds_read_b64_tr_b16 v[178:179], v16 offset:1536
 v_mfma_f32_16x16x32_bf16 v[132:135], v[212:215], a[44:47], v[132:135]
 ds_read_b64_tr_b16 v[180:181], v17 offset:288
 v_mfma_f32_16x16x32_bf16 v[96:99], v[216:219], a[40:43], v[96:99]
 ds_read_b64_tr_b16 v[182:183], v17 offset:1568
 v_mfma_f32_16x16x32_bf16 v[136:139], v[216:219], a[44:47], v[136:139]
 buffer_load_dwordx4 a[124:127], v6, s[16:19], s48 offen offset:128 sc1
 v_mfma_f32_16x16x32_bf16 v[100:103], v[220:223], a[40:43], v[100:103]
 s_add_u32 s48, s48, 132096
 v_mfma_f32_16x16x32_bf16 v[140:143], v[220:223], a[44:47], v[140:143]
 s_waitcnt lgkmcnt(0) vmcnt(48)
 v_mfma_f32_16x16x32_bf16 v[64:67], v[144:147], a[48:51], v[64:67]
 ds_read_b64_tr_b16 v[184:185], v16 offset:10240
 ds_read_b64_tr_b16 v[186:187], v16 offset:11520
 v_mfma_f32_16x16x32_bf16 v[104:107], v[144:147], a[52:55], v[104:107]
 ds_read_b64_tr_b16 v[188:189], v17 offset:10272
 v_mfma_f32_16x16x32_bf16 v[68:71], v[148:151], a[48:51], v[68:71]
 ds_read_b64_tr_b16 v[190:191], v17 offset:11552
 v_mfma_f32_16x16x32_bf16 v[108:111], v[148:151], a[52:55], v[108:111]
 ds_read_b64_tr_b16 v[192:193], v16 offset:10304
 v_mfma_f32_16x16x32_bf16 v[72:75], v[152:155], a[48:51], v[72:75]
 ds_read_b64_tr_b16 v[194:195], v16 offset:11584
 v_mfma_f32_16x16x32_bf16 v[112:115], v[152:155], a[52:55], v[112:115]
 ds_read_b64_tr_b16 v[196:197], v17 offset:10336
 ds_read_b64_tr_b16 v[198:199], v17 offset:11616
 v_mfma_f32_16x16x32_bf16 v[76:79], v[156:159], a[48:51], v[76:79]
 ds_read_b64_tr_b16 v[200:201], v16 offset:10368
 v_mfma_f32_16x16x32_bf16 v[116:119], v[156:159], a[52:55], v[116:119]
 ds_read_b64_tr_b16 v[202:203], v16 offset:11648
 v_mfma_f32_16x16x32_bf16 v[80:83], v[160:163], a[48:51], v[80:83]
 ds_read_b64_tr_b16 v[204:205], v17 offset:10400
 v_mfma_f32_16x16x32_bf16 v[120:123], v[160:163], a[52:55], v[120:123]
 ds_read_b64_tr_b16 v[206:207], v17 offset:11680
 v_mfma_f32_16x16x32_bf16 v[84:87], v[164:167], a[48:51], v[84:87]
 ds_read_b64_tr_b16 v[208:209], v16 offset:10432
 v_mfma_f32_16x16x32_bf16 v[124:127], v[164:167], a[52:55], v[124:127]
 ds_read_b64_tr_b16 v[210:211], v16 offset:11712
 ds_read_b64_tr_b16 v[212:213], v17 offset:10464
 v_mfma_f32_16x16x32_bf16 v[88:91], v[168:171], a[48:51], v[88:91]
 ds_read_b64_tr_b16 v[214:215], v17 offset:11744
 v_mfma_f32_16x16x32_bf16 v[128:131], v[168:171], a[52:55], v[128:131]
 buffer_load_dwordx4 a[128:131], v6, s[16:19], s48 offen offset:0 sc1
 ds_read_b64_tr_b16 v[216:217], v16 offset:10496
 v_mfma_f32_16x16x32_bf16 v[92:95], v[172:175], a[48:51], v[92:95]
 ds_read_b64_tr_b16 v[218:219], v16 offset:11776
 v_mfma_f32_16x16x32_bf16 v[132:135], v[172:175], a[52:55], v[132:135]
 ds_read_b64_tr_b16 v[220:221], v17 offset:10528
 v_mfma_f32_16x16x32_bf16 v[96:99], v[176:179], a[48:51], v[96:99]
 ds_read_b64_tr_b16 v[222:223], v17 offset:11808
 v_mfma_f32_16x16x32_bf16 v[136:139], v[176:179], a[52:55], v[136:139]
 buffer_load_dwordx4 a[132:135], v6, s[16:19], s48 offen offset:128 sc1
 v_mfma_f32_16x16x32_bf16 v[100:103], v[180:183], a[48:51], v[100:103]
 s_add_u32 s48, s48, 132096
 v_mfma_f32_16x16x32_bf16 v[140:143], v[180:183], a[52:55], v[140:143]
 s_waitcnt lgkmcnt(0) vmcnt(43)
 s_barrier
 v_mfma_f32_16x16x32_bf16 v[64:67], v[184:187], a[56:59], v[64:67]
 ds_read_b64_tr_b16 v[144:145], v16 offset:20480
 ds_read_b64_tr_b16 v[146:147], v16 offset:21760
 v_mfma_f32_16x16x32_bf16 v[104:107], v[184:187], a[60:63], v[104:107]
 ds_read_b64_tr_b16 v[148:149], v17 offset:20512
 v_mfma_f32_16x16x32_bf16 v[68:71], v[188:191], a[56:59], v[68:71]
 ds_read_b64_tr_b16 v[150:151], v17 offset:21792
 v_mfma_f32_16x16x32_bf16 v[108:111], v[188:191], a[60:63], v[108:111]
 ds_read_b64_tr_b16 v[152:153], v16 offset:20544
 v_mfma_f32_16x16x32_bf16 v[72:75], v[192:195], a[56:59], v[72:75]
 ds_read_b64_tr_b16 v[154:155], v16 offset:21824
 v_mfma_f32_16x16x32_bf16 v[112:115], v[192:195], a[60:63], v[112:115]
 ds_read_b64_tr_b16 v[156:157], v17 offset:20576
 ds_read_b64_tr_b16 v[158:159], v17 offset:21856
 v_mfma_f32_16x16x32_bf16 v[76:79], v[196:199], a[56:59], v[76:79]
 ds_read_b64_tr_b16 v[160:161], v16 offset:20608
 v_mfma_f32_16x16x32_bf16 v[116:119], v[196:199], a[60:63], v[116:119]
 ds_read_b64_tr_b16 v[162:163], v16 offset:21888
 v_mfma_f32_16x16x32_bf16 v[80:83], v[200:203], a[56:59], v[80:83]
 ds_read_b64_tr_b16 v[164:165], v17 offset:20640
 v_mfma_f32_16x16x32_bf16 v[120:123], v[200:203], a[60:63], v[120:123]
 ds_read_b64_tr_b16 v[166:167], v17 offset:21920
 v_mfma_f32_16x16x32_bf16 v[84:87], v[204:207], a[56:59], v[84:87]
 ds_read_b64_tr_b16 v[168:169], v16 offset:20672
 v_mfma_f32_16x16x32_bf16 v[124:127], v[204:207], a[60:63], v[124:127]
 ds_read_b64_tr_b16 v[170:171], v16 offset:21952
 ds_read_b64_tr_b16 v[172:173], v17 offset:20704
 v_mfma_f32_16x16x32_bf16 v[88:91], v[208:211], a[56:59], v[88:91]
 ds_read_b64_tr_b16 v[174:175], v17 offset:21984
 v_mfma_f32_16x16x32_bf16 v[128:131], v[208:211], a[60:63], v[128:131]
 buffer_load_dwordx4 a[136:139], v6, s[16:19], s48 offen offset:0 sc1
 ds_read_b64_tr_b16 v[176:177], v16 offset:20736
 v_mfma_f32_16x16x32_bf16 v[92:95], v[212:215], a[56:59], v[92:95]
 ds_read_b64_tr_b16 v[178:179], v16 offset:22016
 v_mfma_f32_16x16x32_bf16 v[132:135], v[212:215], a[60:63], v[132:135]
 ds_read_b64_tr_b16 v[180:181], v17 offset:20768
 v_mfma_f32_16x16x32_bf16 v[96:99], v[216:219], a[56:59], v[96:99]
 ds_read_b64_tr_b16 v[182:183], v17 offset:22048
 v_mfma_f32_16x16x32_bf16 v[136:139], v[216:219], a[60:63], v[136:139]
 buffer_load_dwordx4 a[140:143], v6, s[16:19], s48 offen offset:128 sc1
 v_mfma_f32_16x16x32_bf16 v[100:103], v[220:223], a[56:59], v[100:103]
 s_add_u32 s48, s48, 132096
 v_mfma_f32_16x16x32_bf16 v[140:143], v[220:223], a[60:63], v[140:143]
 s_waitcnt lgkmcnt(0) vmcnt(43)
 v_mfma_f32_16x16x32_bf16 v[64:67], v[144:147], a[64:67], v[64:67]
 ds_read_b64_tr_b16 v[184:185], v16 offset:30720
 ds_read_b64_tr_b16 v[186:187], v16 offset:32000
 v_mfma_f32_16x16x32_bf16 v[104:107], v[144:147], a[68:71], v[104:107]
 ds_read_b64_tr_b16 v[188:189], v17 offset:30752
 v_mfma_f32_16x16x32_bf16 v[68:71], v[148:151], a[64:67], v[68:71]
 ds_read_b64_tr_b16 v[190:191], v17 offset:32032
 v_mfma_f32_16x16x32_bf16 v[108:111], v[148:151], a[68:71], v[108:111]
 ds_read_b64_tr_b16 v[192:193], v16 offset:30784
 v_mfma_f32_16x16x32_bf16 v[72:75], v[152:155], a[64:67], v[72:75]
 ds_read_b64_tr_b16 v[194:195], v16 offset:32064
 v_mfma_f32_16x16x32_bf16 v[112:115], v[152:155], a[68:71], v[112:115]
 ds_read_b64_tr_b16 v[196:197], v17 offset:30816
 ds_read_b64_tr_b16 v[198:199], v17 offset:32096
 v_mfma_f32_16x16x32_bf16 v[76:79], v[156:159], a[64:67], v[76:79]
 ds_read_b64_tr_b16 v[200:201], v16 offset:30848
 v_mfma_f32_16x16x32_bf16 v[116:119], v[156:159], a[68:71], v[116:119]
 ds_read_b64_tr_b16 v[202:203], v16 offset:32128
 v_mfma_f32_16x16x32_bf16 v[80:83], v[160:163], a[64:67], v[80:83]
 ds_read_b64_tr_b16 v[204:205], v17 offset:30880
 v_mfma_f32_16x16x32_bf16 v[120:123], v[160:163], a[68:71], v[120:123]
 ds_read_b64_tr_b16 v[206:207], v17 offset:32160
 v_mfma_f32_16x16x32_bf16 v[84:87], v[164:167], a[64:67], v[84:87]
 ds_read_b64_tr_b16 v[208:209], v16 offset:30912
 v_mfma_f32_16x16x32_bf16 v[124:127], v[164:167], a[68:71], v[124:127]
 ds_read_b64_tr_b16 v[210:211], v16 offset:32192
 ds_read_b64_tr_b16 v[212:213], v17 offset:30944
 v_mfma_f32_16x16x32_bf16 v[88:91], v[168:171], a[64:67], v[88:91]
 ds_read_b64_tr_b16 v[214:215], v17 offset:32224
 v_mfma_f32_16x16x32_bf16 v[128:131], v[168:171], a[68:71], v[128:131]
 buffer_load_dwordx4 a[144:147], v6, s[16:19], s48 offen offset:0 sc1
 ds_read_b64_tr_b16 v[216:217], v16 offset:30976
 v_mfma_f32_16x16x32_bf16 v[92:95], v[172:175], a[64:67], v[92:95]
 ds_read_b64_tr_b16 v[218:219], v16 offset:32256
 v_mfma_f32_16x16x32_bf16 v[132:135], v[172:175], a[68:71], v[132:135]
 ds_read_b64_tr_b16 v[220:221], v17 offset:31008
 v_mfma_f32_16x16x32_bf16 v[96:99], v[176:179], a[64:67], v[96:99]
 ds_read_b64_tr_b16 v[222:223], v17 offset:32288
 v_mfma_f32_16x16x32_bf16 v[136:139], v[176:179], a[68:71], v[136:139]
 buffer_load_dwordx4 a[148:151], v6, s[16:19], s48 offen offset:128 sc1
 v_mfma_f32_16x16x32_bf16 v[100:103], v[180:183], a[64:67], v[100:103]
 s_add_u32 s48, s48, 132096
 v_mfma_f32_16x16x32_bf16 v[140:143], v[180:183], a[68:71], v[140:143]
 s_waitcnt lgkmcnt(0) vmcnt(38)
 s_barrier
 v_mfma_f32_16x16x32_bf16 v[64:67], v[184:187], a[72:75], v[64:67]
 ds_read_b64_tr_b16 v[144:145], v16 offset:40960
 ds_read_b64_tr_b16 v[146:147], v16 offset:42240
 v_mfma_f32_16x16x32_bf16 v[104:107], v[184:187], a[76:79], v[104:107]
 ds_read_b64_tr_b16 v[148:149], v17 offset:40992
 v_mfma_f32_16x16x32_bf16 v[68:71], v[188:191], a[72:75], v[68:71]
 ds_read_b64_tr_b16 v[150:151], v17 offset:42272
 v_mfma_f32_16x16x32_bf16 v[108:111], v[188:191], a[76:79], v[108:111]
 ds_read_b64_tr_b16 v[152:153], v16 offset:41024
 v_mfma_f32_16x16x32_bf16 v[72:75], v[192:195], a[72:75], v[72:75]
 ds_read_b64_tr_b16 v[154:155], v16 offset:42304
 v_mfma_f32_16x16x32_bf16 v[112:115], v[192:195], a[76:79], v[112:115]
 ds_read_b64_tr_b16 v[156:157], v17 offset:41056
 ds_read_b64_tr_b16 v[158:159], v17 offset:42336
 v_mfma_f32_16x16x32_bf16 v[76:79], v[196:199], a[72:75], v[76:79]
 ds_read_b64_tr_b16 v[160:161], v16 offset:41088
 v_mfma_f32_16x16x32_bf16 v[116:119], v[196:199], a[76:79], v[116:119]
 ds_read_b64_tr_b16 v[162:163], v16 offset:42368
 v_mfma_f32_16x16x32_bf16 v[80:83], v[200:203], a[72:75], v[80:83]
 ds_read_b64_tr_b16 v[164:165], v17 offset:41120
 v_mfma_f32_16x16x32_bf16 v[120:123], v[200:203], a[76:79], v[120:123]
 ds_read_b64_tr_b16 v[166:167], v17 offset:42400
 v_mfma_f32_16x16x32_bf16 v[84:87], v[204:207], a[72:75], v[84:87]
 ds_read_b64_tr_b16 v[168:169], v16 offset:41152
 v_mfma_f32_16x16x32_bf16 v[124:127], v[204:207], a[76:79], v[124:127]
 ds_read_b64_tr_b16 v[170:171], v16 offset:42432
 ds_read_b64_tr_b16 v[172:173], v17 offset:41184
 v_mfma_f32_16x16x32_bf16 v[88:91], v[208:211], a[72:75], v[88:91]
 ds_read_b64_tr_b16 v[174:175], v17 offset:42464
 v_mfma_f32_16x16x32_bf16 v[128:131], v[208:211], a[76:79], v[128:131]
 buffer_load_dwordx4 a[152:155], v6, s[16:19], s48 offen offset:0 sc1
 ds_read_b64_tr_b16 v[176:177], v16 offset:41216
 v_mfma_f32_16x16x32_bf16 v[92:95], v[212:215], a[72:75], v[92:95]
 ds_read_b64_tr_b16 v[178:179], v16 offset:42496
 v_mfma_f32_16x16x32_bf16 v[132:135], v[212:215], a[76:79], v[132:135]
 ds_read_b64_tr_b16 v[180:181], v17 offset:41248
 v_mfma_f32_16x16x32_bf16 v[96:99], v[216:219], a[72:75], v[96:99]
 ds_read_b64_tr_b16 v[182:183], v17 offset:42528
 v_mfma_f32_16x16x32_bf16 v[136:139], v[216:219], a[76:79], v[136:139]
 buffer_load_dwordx4 a[156:159], v6, s[16:19], s48 offen offset:128 sc1
 v_mfma_f32_16x16x32_bf16 v[100:103], v[220:223], a[72:75], v[100:103]
 s_add_u32 s48, s48, 132096
 v_mfma_f32_16x16x32_bf16 v[140:143], v[220:223], a[76:79], v[140:143]
 s_waitcnt lgkmcnt(0) vmcnt(33)
 v_mfma_f32_16x16x32_bf16 v[64:67], v[144:147], a[80:83], v[64:67]
 ds_read_b64_tr_b16 v[184:185], v16 offset:51200
 ds_read_b64_tr_b16 v[186:187], v16 offset:52480
 v_mfma_f32_16x16x32_bf16 v[104:107], v[144:147], a[84:87], v[104:107]
 ds_read_b64_tr_b16 v[188:189], v17 offset:51232
 v_mfma_f32_16x16x32_bf16 v[68:71], v[148:151], a[80:83], v[68:71]
 ds_read_b64_tr_b16 v[190:191], v17 offset:52512
 v_mfma_f32_16x16x32_bf16 v[108:111], v[148:151], a[84:87], v[108:111]
 ds_read_b64_tr_b16 v[192:193], v16 offset:51264
 v_mfma_f32_16x16x32_bf16 v[72:75], v[152:155], a[80:83], v[72:75]
 ds_read_b64_tr_b16 v[194:195], v16 offset:52544
 v_mfma_f32_16x16x32_bf16 v[112:115], v[152:155], a[84:87], v[112:115]
 ds_read_b64_tr_b16 v[196:197], v17 offset:51296
 ds_read_b64_tr_b16 v[198:199], v17 offset:52576
 v_mfma_f32_16x16x32_bf16 v[76:79], v[156:159], a[80:83], v[76:79]
 ds_read_b64_tr_b16 v[200:201], v16 offset:51328
 v_mfma_f32_16x16x32_bf16 v[116:119], v[156:159], a[84:87], v[116:119]
 ds_read_b64_tr_b16 v[202:203], v16 offset:52608
 v_mfma_f32_16x16x32_bf16 v[80:83], v[160:163], a[80:83], v[80:83]
 ds_read_b64_tr_b16 v[204:205], v17 offset:51360
 v_mfma_f32_16x16x32_bf16 v[120:123], v[160:163], a[84:87], v[120:123]
 ds_read_b64_tr_b16 v[206:207], v17 offset:52640
 v_mfma_f32_16x16x32_bf16 v[84:87], v[164:167], a[80:83], v[84:87]
 ds_read_b64_tr_b16 v[208:209], v16 offset:51392
 v_mfma_f32_16x16x32_bf16 v[124:127], v[164:167], a[84:87], v[124:127]
 ds_read_b64_tr_b16 v[210:211], v16 offset:52672
 ds_read_b64_tr_b16 v[212:213], v17 offset:51424
 v_mfma_f32_16x16x32_bf16 v[88:91], v[168:171], a[80:83], v[88:91]
 ds_read_b64_tr_b16 v[214:215], v17 offset:52704
 v_mfma_f32_16x16x32_bf16 v[128:131], v[168:171], a[84:87], v[128:131]
 buffer_load_dwordx4 v[52:55], v4, s[12:15], 0 offen
 ds_read_b64_tr_b16 v[216:217], v16 offset:51456
 v_mfma_f32_16x16x32_bf16 v[92:95], v[172:175], a[80:83], v[92:95]
 ds_read_b64_tr_b16 v[218:219], v16 offset:52736
 v_mfma_f32_16x16x32_bf16 v[132:135], v[172:175], a[84:87], v[132:135]
 ds_read_b64_tr_b16 v[220:221], v17 offset:51488
 v_mfma_f32_16x16x32_bf16 v[96:99], v[176:179], a[80:83], v[96:99]
 ds_read_b64_tr_b16 v[222:223], v17 offset:52768
 v_mfma_f32_16x16x32_bf16 v[136:139], v[176:179], a[84:87], v[136:139]
 buffer_load_dword v56, v5, s[12:15], 0 offen offset:1024
 v_mfma_f32_16x16x32_bf16 v[100:103], v[180:183], a[80:83], v[100:103]
 s_mul_i32 s50, s59, 1280
 v_mfma_f32_16x16x32_bf16 v[140:143], v[180:183], a[84:87], v[140:143]
 s_waitcnt lgkmcnt(0) vmcnt(28)
 s_barrier
 v_mfma_f32_16x16x32_bf16 v[64:67], v[184:187], a[88:91], v[64:67]
 ds_read_b64_tr_b16 v[144:145], v18 offset:0
 ds_read_b64_tr_b16 v[146:147], v18 offset:1280
 v_mfma_f32_16x16x32_bf16 v[104:107], v[184:187], a[92:95], v[104:107]
 ds_read_b64_tr_b16 v[148:149], v19 offset:32
 v_mfma_f32_16x16x32_bf16 v[68:71], v[188:191], a[88:91], v[68:71]
 ds_read_b64_tr_b16 v[150:151], v19 offset:1312
 v_mfma_f32_16x16x32_bf16 v[108:111], v[188:191], a[92:95], v[108:111]
 ds_read_b64_tr_b16 v[152:153], v18 offset:64
 v_mfma_f32_16x16x32_bf16 v[72:75], v[192:195], a[88:91], v[72:75]
 ds_read_b64_tr_b16 v[154:155], v18 offset:1344
 v_mfma_f32_16x16x32_bf16 v[112:115], v[192:195], a[92:95], v[112:115]
 ds_read_b64_tr_b16 v[156:157], v19 offset:96
 ds_read_b64_tr_b16 v[158:159], v19 offset:1376
 v_mfma_f32_16x16x32_bf16 v[76:79], v[196:199], a[88:91], v[76:79]
 ds_read_b64_tr_b16 v[160:161], v18 offset:128
 v_mfma_f32_16x16x32_bf16 v[116:119], v[196:199], a[92:95], v[116:119]
 ds_read_b64_tr_b16 v[162:163], v18 offset:1408
 v_mfma_f32_16x16x32_bf16 v[80:83], v[200:203], a[88:91], v[80:83]
 ds_read_b64_tr_b16 v[164:165], v19 offset:160
 v_mfma_f32_16x16x32_bf16 v[120:123], v[200:203], a[92:95], v[120:123]
 ds_read_b64_tr_b16 v[166:167], v19 offset:1440
 v_mfma_f32_16x16x32_bf16 v[84:87], v[204:207], a[88:91], v[84:87]
 ds_read_b64_tr_b16 v[168:169], v18 offset:192
 v_mfma_f32_16x16x32_bf16 v[124:127], v[204:207], a[92:95], v[124:127]
 ds_read_b64_tr_b16 v[170:171], v18 offset:1472
 ds_read_b64_tr_b16 v[172:173], v19 offset:224
 v_mfma_f32_16x16x32_bf16 v[88:91], v[208:211], a[88:91], v[88:91]
 ds_read_b64_tr_b16 v[174:175], v19 offset:1504
 v_mfma_f32_16x16x32_bf16 v[128:131], v[208:211], a[92:95], v[128:131]
 buffer_load_dwordx4 v[224:227], v4, s[8:11], s50 offen
 ds_read_b64_tr_b16 v[176:177], v18 offset:256
 v_mfma_f32_16x16x32_bf16 v[92:95], v[212:215], a[88:91], v[92:95]
 ds_read_b64_tr_b16 v[178:179], v18 offset:1536
 v_mfma_f32_16x16x32_bf16 v[132:135], v[212:215], a[92:95], v[132:135]
 ds_read_b64_tr_b16 v[180:181], v19 offset:288
 v_mfma_f32_16x16x32_bf16 v[96:99], v[216:219], a[88:91], v[96:99]
 ds_read_b64_tr_b16 v[182:183], v19 offset:1568
 v_mfma_f32_16x16x32_bf16 v[136:139], v[216:219], a[92:95], v[136:139]
 buffer_load_dword v228, v5, s[8:11], s50 offen offset:1024
 v_mfma_f32_16x16x32_bf16 v[100:103], v[220:223], a[88:91], v[100:103]
 s_add_u32 s50, s50, 1280
 v_mfma_f32_16x16x32_bf16 v[140:143], v[220:223], a[92:95], v[140:143]
 s_waitcnt lgkmcnt(0) vmcnt(28)
 v_mfma_f32_16x16x32_bf16 v[64:67], v[144:147], a[96:99], v[64:67]
 ds_read_b64_tr_b16 v[184:185], v18 offset:10240
 ds_read_b64_tr_b16 v[186:187], v18 offset:11520
 v_mfma_f32_16x16x32_bf16 v[104:107], v[144:147], a[100:103], v[104:107]
 ds_read_b64_tr_b16 v[188:189], v19 offset:10272
 v_mfma_f32_16x16x32_bf16 v[68:71], v[148:151], a[96:99], v[68:71]
 ds_read_b64_tr_b16 v[190:191], v19 offset:11552
 v_mfma_f32_16x16x32_bf16 v[108:111], v[148:151], a[100:103], v[108:111]
 ds_read_b64_tr_b16 v[192:193], v18 offset:10304
 v_mfma_f32_16x16x32_bf16 v[72:75], v[152:155], a[96:99], v[72:75]
 ds_read_b64_tr_b16 v[194:195], v18 offset:11584
 v_mfma_f32_16x16x32_bf16 v[112:115], v[152:155], a[100:103], v[112:115]
 ds_read_b64_tr_b16 v[196:197], v19 offset:10336
 ds_read_b64_tr_b16 v[198:199], v19 offset:11616
 v_mfma_f32_16x16x32_bf16 v[76:79], v[156:159], a[96:99], v[76:79]
 ds_read_b64_tr_b16 v[200:201], v18 offset:10368
 v_mfma_f32_16x16x32_bf16 v[116:119], v[156:159], a[100:103], v[116:119]
 ds_read_b64_tr_b16 v[202:203], v18 offset:11648
 v_mfma_f32_16x16x32_bf16 v[80:83], v[160:163], a[96:99], v[80:83]
 ds_read_b64_tr_b16 v[204:205], v19 offset:10400
 v_mfma_f32_16x16x32_bf16 v[120:123], v[160:163], a[100:103], v[120:123]
 ds_read_b64_tr_b16 v[206:207], v19 offset:11680
 v_mfma_f32_16x16x32_bf16 v[84:87], v[164:167], a[96:99], v[84:87]
 ds_read_b64_tr_b16 v[208:209], v18 offset:10432
 v_mfma_f32_16x16x32_bf16 v[124:127], v[164:167], a[100:103], v[124:127]
 ds_read_b64_tr_b16 v[210:211], v18 offset:11712
 ds_read_b64_tr_b16 v[212:213], v19 offset:10464
 v_mfma_f32_16x16x32_bf16 v[88:91], v[168:171], a[96:99], v[88:91]
 ds_read_b64_tr_b16 v[214:215], v19 offset:11744
 v_mfma_f32_16x16x32_bf16 v[128:131], v[168:171], a[100:103], v[128:131]
 buffer_load_dwordx4 v[230:233], v4, s[8:11], s50 offen
 ds_read_b64_tr_b16 v[216:217], v18 offset:10496
 v_mfma_f32_16x16x32_bf16 v[92:95], v[172:175], a[96:99], v[92:95]
 ds_read_b64_tr_b16 v[218:219], v18 offset:11776
 v_mfma_f32_16x16x32_bf16 v[132:135], v[172:175], a[100:103], v[132:135]
 ds_read_b64_tr_b16 v[220:221], v19 offset:10528
 v_mfma_f32_16x16x32_bf16 v[96:99], v[176:179], a[96:99], v[96:99]
 ds_read_b64_tr_b16 v[222:223], v19 offset:11808
 v_mfma_f32_16x16x32_bf16 v[136:139], v[176:179], a[100:103], v[136:139]
 buffer_load_dword v234, v5, s[8:11], s50 offen offset:1024
 v_mfma_f32_16x16x32_bf16 v[100:103], v[180:183], a[96:99], v[100:103]
 s_add_u32 s50, s50, 1280
 v_mfma_f32_16x16x32_bf16 v[140:143], v[180:183], a[100:103], v[140:143]
 s_waitcnt lgkmcnt(0) vmcnt(23)
 s_barrier
 v_mfma_f32_16x16x32_bf16 v[64:67], v[184:187], a[104:107], v[64:67]
 ds_read_b64_tr_b16 v[144:145], v14 offset:0
 ds_read_b64_tr_b16 v[146:147], v14 offset:1280
 v_mfma_f32_16x16x32_bf16 v[104:107], v[184:187], a[108:111], v[104:107]
 ds_read_b64_tr_b16 v[148:149], v15 offset:32
 v_mfma_f32_16x16x32_bf16 v[68:71], v[188:191], a[104:107], v[68:71]
 ds_read_b64_tr_b16 v[150:151], v15 offset:1312
 v_mfma_f32_16x16x32_bf16 v[108:111], v[188:191], a[108:111], v[108:111]
 ds_read_b64_tr_b16 v[152:153], v14 offset:64
 v_mfma_f32_16x16x32_bf16 v[72:75], v[192:195], a[104:107], v[72:75]
 ds_read_b64_tr_b16 v[154:155], v14 offset:1344
 v_mfma_f32_16x16x32_bf16 v[112:115], v[192:195], a[108:111], v[112:115]
 ds_read_b64_tr_b16 v[156:157], v15 offset:96
 ds_read_b64_tr_b16 v[158:159], v15 offset:1376
 v_mfma_f32_16x16x32_bf16 v[76:79], v[196:199], a[104:107], v[76:79]
 ds_read_b64_tr_b16 v[160:161], v14 offset:128
 v_mfma_f32_16x16x32_bf16 v[116:119], v[196:199], a[108:111], v[116:119]
 ds_read_b64_tr_b16 v[162:163], v14 offset:1408
 v_mfma_f32_16x16x32_bf16 v[80:83], v[200:203], a[104:107], v[80:83]
 ds_read_b64_tr_b16 v[164:165], v15 offset:160
 v_mfma_f32_16x16x32_bf16 v[120:123], v[200:203], a[108:111], v[120:123]
 ds_read_b64_tr_b16 v[166:167], v15 offset:1440
 v_mfma_f32_16x16x32_bf16 v[84:87], v[204:207], a[104:107], v[84:87]
 ds_read_b64_tr_b16 v[168:169], v14 offset:192
 v_mfma_f32_16x16x32_bf16 v[124:127], v[204:207], a[108:111], v[124:127]
 ds_read_b64_tr_b16 v[170:171], v14 offset:1472
 ds_read_b64_tr_b16 v[172:173], v15 offset:224
 v_mfma_f32_16x16x32_bf16 v[88:91], v[208:211], a[104:107], v[88:91]
 ds_read_b64_tr_b16 v[174:175], v15 offset:1504
 v_mfma_f32_16x16x32_bf16 v[128:131], v[208:211], a[108:111], v[128:131]
 buffer_load_dwordx4 v[236:239], v4, s[8:11], s50 offen
 ds_read_b64_tr_b16 v[176:177], v14 offset:256
 v_mfma_f32_16x16x32_bf16 v[92:95], v[212:215], a[104:107], v[92:95]
 ds_read_b64_tr_b16 v[178:179], v14 offset:1536
 v_mfma_f32_16x16x32_bf16 v[132:135], v[212:215], a[108:111], v[132:135]
 ds_read_b64_tr_b16 v[180:181], v15 offset:288
 v_mfma_f32_16x16x32_bf16 v[96:99], v[216:219], a[104:107], v[96:99]
 ds_read_b64_tr_b16 v[182:183], v15 offset:1568
 v_mfma_f32_16x16x32_bf16 v[136:139], v[216:219], a[108:111], v[136:139]
 buffer_load_dword v240, v5, s[8:11], s50 offen offset:1024
 v_mfma_f32_16x16x32_bf16 v[100:103], v[220:223], a[104:107], v[100:103]
 s_add_u32 s50, s50, 1280
 v_mfma_f32_16x16x32_bf16 v[140:143], v[220:223], a[108:111], v[140:143]
 s_waitcnt lgkmcnt(0) vmcnt(23)
 v_mfma_f32_16x16x32_bf16 v[64:67], v[144:147], a[112:115], v[64:67]
 ds_read_b64_tr_b16 v[184:185], v14 offset:10240
 ds_read_b64_tr_b16 v[186:187], v14 offset:11520
 v_mfma_f32_16x16x32_bf16 v[104:107], v[144:147], a[116:119], v[104:107]
 ds_read_b64_tr_b16 v[188:189], v15 offset:10272
 v_mfma_f32_16x16x32_bf16 v[68:71], v[148:151], a[112:115], v[68:71]
 ds_read_b64_tr_b16 v[190:191], v15 offset:11552
 v_mfma_f32_16x16x32_bf16 v[108:111], v[148:151], a[116:119], v[108:111]
 ds_read_b64_tr_b16 v[192:193], v14 offset:10304
 v_mfma_f32_16x16x32_bf16 v[72:75], v[152:155], a[112:115], v[72:75]
 ds_read_b64_tr_b16 v[194:195], v14 offset:11584
 v_mfma_f32_16x16x32_bf16 v[112:115], v[152:155], a[116:119], v[112:115]
 ds_read_b64_tr_b16 v[196:197], v15 offset:10336
 ds_read_b64_tr_b16 v[198:199], v15 offset:11616
 v_mfma_f32_16x16x32_bf16 v[76:79], v[156:159], a[112:115], v[76:79]
 ds_read_b64_tr_b16 v[200:201], v14 offset:10368
 v_mfma_f32_16x16x32_bf16 v[116:119], v[156:159], a[116:119], v[116:119]
 ds_read_b64_tr_b16 v[202:203], v14 offset:11648
 v_mfma_f32_16x16x32_bf16 v[80:83], v[160:163], a[112:115], v[80:83]
 ds_read_b64_tr_b16 v[204:205], v15 offset:10400
 v_mfma_f32_16x16x32_bf16 v[120:123], v[160:163], a[116:119], v[120:123]
 ds_read_b64_tr_b16 v[206:207], v15 offset:11680
 v_mfma_f32_16x16x32_bf16 v[84:87], v[164:167], a[112:115], v[84:87]
 ds_read_b64_tr_b16 v[208:209], v14 offset:10432
 v_mfma_f32_16x16x32_bf16 v[124:127], v[164:167], a[116:119], v[124:127]
 ds_read_b64_tr_b16 v[210:211], v14 offset:11712
 ds_read_b64_tr_b16 v[212:213], v15 offset:10464
 v_mfma_f32_16x16x32_bf16 v[88:91], v[168:171], a[112:115], v[88:91]
 ds_read_b64_tr_b16 v[214:215], v15 offset:11744
 v_mfma_f32_16x16x32_bf16 v[128:131], v[168:171], a[116:119], v[128:131]
 buffer_load_dwordx4 v[242:245], v4, s[8:11], s50 offen
 ds_read_b64_tr_b16 v[216:217], v14 offset:10496
 v_mfma_f32_16x16x32_bf16 v[92:95], v[172:175], a[112:115], v[92:95]
 ds_read_b64_tr_b16 v[218:219], v14 offset:11776
 v_mfma_f32_16x16x32_bf16 v[132:135], v[172:175], a[116:119], v[132:135]
 ds_read_b64_tr_b16 v[220:221], v15 offset:10528
 v_mfma_f32_16x16x32_bf16 v[96:99], v[176:179], a[112:115], v[96:99]
 ds_read_b64_tr_b16 v[222:223], v15 offset:11808
 v_mfma_f32_16x16x32_bf16 v[136:139], v[176:179], a[116:119], v[136:139]
 buffer_load_dword v246, v5, s[8:11], s50 offen offset:1024
 v_mfma_f32_16x16x32_bf16 v[100:103], v[180:183], a[112:115], v[100:103]
 s_add_u32 s50, s50, 1280
 v_mfma_f32_16x16x32_bf16 v[140:143], v[180:183], a[116:119], v[140:143]
 s_waitcnt lgkmcnt(0) vmcnt(18)
 s_barrier
 v_mfma_f32_16x16x32_bf16 v[64:67], v[184:187], a[120:123], v[64:67]
 ds_read_b64_tr_b16 v[144:145], v14 offset:20480
 ds_read_b64_tr_b16 v[146:147], v14 offset:21760
 v_mfma_f32_16x16x32_bf16 v[104:107], v[184:187], a[124:127], v[104:107]
 ds_read_b64_tr_b16 v[148:149], v15 offset:20512
 v_mfma_f32_16x16x32_bf16 v[68:71], v[188:191], a[120:123], v[68:71]
 ds_read_b64_tr_b16 v[150:151], v15 offset:21792
 v_mfma_f32_16x16x32_bf16 v[108:111], v[188:191], a[124:127], v[108:111]
 ds_read_b64_tr_b16 v[152:153], v14 offset:20544
 v_mfma_f32_16x16x32_bf16 v[72:75], v[192:195], a[120:123], v[72:75]
 ds_read_b64_tr_b16 v[154:155], v14 offset:21824
 v_mfma_f32_16x16x32_bf16 v[112:115], v[192:195], a[124:127], v[112:115]
 ds_read_b64_tr_b16 v[156:157], v15 offset:20576
 ds_read_b64_tr_b16 v[158:159], v15 offset:21856
 v_mfma_f32_16x16x32_bf16 v[76:79], v[196:199], a[120:123], v[76:79]
 ds_read_b64_tr_b16 v[160:161], v14 offset:20608
 v_mfma_f32_16x16x32_bf16 v[116:119], v[196:199], a[124:127], v[116:119]
 ds_read_b64_tr_b16 v[162:163], v14 offset:21888
 v_mfma_f32_16x16x32_bf16 v[80:83], v[200:203], a[120:123], v[80:83]
 ds_read_b64_tr_b16 v[164:165], v15 offset:20640
 v_mfma_f32_16x16x32_bf16 v[120:123], v[200:203], a[124:127], v[120:123]
 ds_read_b64_tr_b16 v[166:167], v15 offset:21920
 v_mfma_f32_16x16x32_bf16 v[84:87], v[204:207], a[120:123], v[84:87]
 ds_read_b64_tr_b16 v[168:169], v14 offset:20672
 v_mfma_f32_16x16x32_bf16 v[124:127], v[204:207], a[124:127], v[124:127]
 ds_read_b64_tr_b16 v[170:171], v14 offset:21952
 ds_read_b64_tr_b16 v[172:173], v15 offset:20704
 v_mfma_f32_16x16x32_bf16 v[88:91], v[208:211], a[120:123], v[88:91]
 ds_read_b64_tr_b16 v[174:175], v15 offset:21984
 v_mfma_f32_16x16x32_bf16 v[128:131], v[208:211], a[124:127], v[128:131]
 buffer_load_dwordx4 v[248:251], v4, s[8:11], s50 offen
 ds_read_b64_tr_b16 v[176:177], v14 offset:20736
 v_mfma_f32_16x16x32_bf16 v[92:95], v[212:215], a[120:123], v[92:95]
 ds_read_b64_tr_b16 v[178:179], v14 offset:22016
 v_mfma_f32_16x16x32_bf16 v[132:135], v[212:215], a[124:127], v[132:135]
 ds_read_b64_tr_b16 v[180:181], v15 offset:20768
 v_mfma_f32_16x16x32_bf16 v[96:99], v[216:219], a[120:123], v[96:99]
 ds_read_b64_tr_b16 v[182:183], v15 offset:22048
 v_mfma_f32_16x16x32_bf16 v[136:139], v[216:219], a[124:127], v[136:139]
 buffer_load_dword v252, v5, s[8:11], s50 offen offset:1024
 v_mfma_f32_16x16x32_bf16 v[100:103], v[220:223], a[120:123], v[100:103]
 s_add_u32 s50, s50, 1280
 v_mfma_f32_16x16x32_bf16 v[140:143], v[220:223], a[124:127], v[140:143]
 s_waitcnt lgkmcnt(0) vmcnt(18)
 v_mfma_f32_16x16x32_bf16 v[64:67], v[144:147], a[128:131], v[64:67]
 ds_read_b64_tr_b16 v[184:185], v14 offset:30720
 ds_read_b64_tr_b16 v[186:187], v14 offset:32000
 v_mfma_f32_16x16x32_bf16 v[104:107], v[144:147], a[132:135], v[104:107]
 ds_read_b64_tr_b16 v[188:189], v15 offset:30752
 v_mfma_f32_16x16x32_bf16 v[68:71], v[148:151], a[128:131], v[68:71]
 ds_read_b64_tr_b16 v[190:191], v15 offset:32032
 v_mfma_f32_16x16x32_bf16 v[108:111], v[148:151], a[132:135], v[108:111]
 ds_read_b64_tr_b16 v[192:193], v14 offset:30784
 v_mfma_f32_16x16x32_bf16 v[72:75], v[152:155], a[128:131], v[72:75]
 ds_read_b64_tr_b16 v[194:195], v14 offset:32064
 v_mfma_f32_16x16x32_bf16 v[112:115], v[152:155], a[132:135], v[112:115]
 ds_read_b64_tr_b16 v[196:197], v15 offset:30816
 ds_read_b64_tr_b16 v[198:199], v15 offset:32096
 v_mfma_f32_16x16x32_bf16 v[76:79], v[156:159], a[128:131], v[76:79]
 ds_read_b64_tr_b16 v[200:201], v14 offset:30848
 v_mfma_f32_16x16x32_bf16 v[116:119], v[156:159], a[132:135], v[116:119]
 ds_read_b64_tr_b16 v[202:203], v14 offset:32128
 v_mfma_f32_16x16x32_bf16 v[80:83], v[160:163], a[128:131], v[80:83]
 ds_read_b64_tr_b16 v[204:205], v15 offset:30880
 v_mfma_f32_16x16x32_bf16 v[120:123], v[160:163], a[132:135], v[120:123]
 ds_read_b64_tr_b16 v[206:207], v15 offset:32160
 v_mfma_f32_16x16x32_bf16 v[84:87], v[164:167], a[128:131], v[84:87]
 ds_read_b64_tr_b16 v[208:209], v14 offset:30912
 v_mfma_f32_16x16x32_bf16 v[124:127], v[164:167], a[132:135], v[124:127]
 ds_read_b64_tr_b16 v[210:211], v14 offset:32192
 ds_read_b64_tr_b16 v[212:213], v15 offset:30944
 v_mfma_f32_16x16x32_bf16 v[88:91], v[168:171], a[128:131], v[88:91]
 ds_read_b64_tr_b16 v[214:215], v15 offset:32224
 v_mfma_f32_16x16x32_bf16 v[128:131], v[168:171], a[132:135], v[128:131]
 buffer_load_dwordx4 v[30:33], v4, s[8:11], s50 offen
 ds_read_b64_tr_b16 v[216:217], v14 offset:30976
 v_mfma_f32_16x16x32_bf16 v[92:95], v[172:175], a[128:131], v[92:95]
 ds_read_b64_tr_b16 v[218:219], v14 offset:32256
 v_mfma_f32_16x16x32_bf16 v[132:135], v[172:175], a[132:135], v[132:135]
 ds_read_b64_tr_b16 v[220:221], v15 offset:31008
 v_mfma_f32_16x16x32_bf16 v[96:99], v[176:179], a[128:131], v[96:99]
 ds_read_b64_tr_b16 v[222:223], v15 offset:32288
 v_mfma_f32_16x16x32_bf16 v[136:139], v[176:179], a[132:135], v[136:139]
 buffer_load_dword v34, v5, s[8:11], s50 offen offset:1024
 v_mfma_f32_16x16x32_bf16 v[100:103], v[180:183], a[128:131], v[100:103]
 s_add_u32 s50, s50, 1280
 v_mfma_f32_16x16x32_bf16 v[140:143], v[180:183], a[132:135], v[140:143]
 s_waitcnt lgkmcnt(0) vmcnt(18)
 s_barrier
 v_mfma_f32_16x16x32_bf16 v[64:67], v[184:187], a[136:139], v[64:67]
 ds_read_b64_tr_b16 v[144:145], v14 offset:40960
 ds_read_b64_tr_b16 v[146:147], v14 offset:42240
 v_mfma_f32_16x16x32_bf16 v[104:107], v[184:187], a[140:143], v[104:107]
 ds_read_b64_tr_b16 v[148:149], v15 offset:40992
 v_mfma_f32_16x16x32_bf16 v[68:71], v[188:191], a[136:139], v[68:71]
 ds_read_b64_tr_b16 v[150:151], v15 offset:42272
 v_mfma_f32_16x16x32_bf16 v[108:111], v[188:191], a[140:143], v[108:111]
 ds_read_b64_tr_b16 v[152:153], v14 offset:41024
 v_mfma_f32_16x16x32_bf16 v[72:75], v[192:195], a[136:139], v[72:75]
 ds_read_b64_tr_b16 v[154:155], v14 offset:42304
 v_mfma_f32_16x16x32_bf16 v[112:115], v[192:195], a[140:143], v[112:115]
 ds_read_b64_tr_b16 v[156:157], v15 offset:41056
 ds_read_b64_tr_b16 v[158:159], v15 offset:42336
 v_mfma_f32_16x16x32_bf16 v[76:79], v[196:199], a[136:139], v[76:79]
 ds_read_b64_tr_b16 v[160:161], v14 offset:41088
 v_mfma_f32_16x16x32_bf16 v[116:119], v[196:199], a[140:143], v[116:119]
 ds_read_b64_tr_b16 v[162:163], v14 offset:42368
 v_mfma_f32_16x16x32_bf16 v[80:83], v[200:203], a[136:139], v[80:83]
 ds_read_b64_tr_b16 v[164:165], v15 offset:41120
 v_mfma_f32_16x16x32_bf16 v[120:123], v[200:203], a[140:143], v[120:123]
 ds_read_b64_tr_b16 v[166:167], v15 offset:42400
 v_mfma_f32_16x16x32_bf16 v[84:87], v[204:207], a[136:139], v[84:87]
 ds_read_b64_tr_b16 v[168:169], v14 offset:41152
 v_mfma_f32_16x16x32_bf16 v[124:127], v[204:207], a[140:143], v[124:127]
 ds_read_b64_tr_b16 v[170:171], v14 offset:42432
 ds_read_b64_tr_b16 v[172:173], v15 offset:41184
 v_mfma_f32_16x16x32_bf16 v[88:91], v[208:211], a[136:139], v[88:91]
 ds_read_b64_tr_b16 v[174:175], v15 offset:42464
 v_mfma_f32_16x16x32_bf16 v[128:131], v[208:211], a[140:143], v[128:131]
 buffer_load_dwordx4 v[36:39], v4, s[8:11], s50 offen
 ds_read_b64_tr_b16 v[176:177], v14 offset:41216
 v_mfma_f32_16x16x32_bf16 v[92:95], v[212:215], a[136:139], v[92:95]
 ds_read_b64_tr_b16 v[178:179], v14 offset:42496
 v_mfma_f32_16x16x32_bf16 v[132:135], v[212:215], a[140:143], v[132:135]
 ds_read_b64_tr_b16 v[180:181], v15 offset:41248
 v_mfma_f32_16x16x32_bf16 v[96:99], v[216:219], a[136:139], v[96:99]
 ds_read_b64_tr_b16 v[182:183], v15 offset:42528
 v_mfma_f32_16x16x32_bf16 v[136:139], v[216:219], a[140:143], v[136:139]
 buffer_load_dword v40, v5, s[8:11], s50 offen offset:1024
 v_mfma_f32_16x16x32_bf16 v[100:103], v[220:223], a[136:139], v[100:103]
 s_add_u32 s50, s50, 1280
 v_mfma_f32_16x16x32_bf16 v[140:143], v[220:223], a[140:143], v[140:143]
 s_waitcnt lgkmcnt(0) vmcnt(18)
 v_mfma_f32_16x16x32_bf16 v[64:67], v[144:147], a[144:147], v[64:67]
 ds_read_b64_tr_b16 v[184:185], v14 offset:51200
 ds_read_b64_tr_b16 v[186:187], v14 offset:52480
 v_mfma_f32_16x16x32_bf16 v[104:107], v[144:147], a[148:151], v[104:107]
 ds_read_b64_tr_b16 v[188:189], v15 offset:51232
 v_mfma_f32_16x16x32_bf16 v[68:71], v[148:151], a[144:147], v[68:71]
 ds_read_b64_tr_b16 v[190:191], v15 offset:52512
 v_mfma_f32_16x16x32_bf16 v[108:111], v[148:151], a[148:151], v[108:111]
 ds_read_b64_tr_b16 v[192:193], v14 offset:51264
 v_mfma_f32_16x16x32_bf16 v[72:75], v[152:155], a[144:147], v[72:75]
 ds_read_b64_tr_b16 v[194:195], v14 offset:52544
 v_mfma_f32_16x16x32_bf16 v[112:115], v[152:155], a[148:151], v[112:115]
 ds_read_b64_tr_b16 v[196:197], v15 offset:51296
 ds_read_b64_tr_b16 v[198:199], v15 offset:52576
 v_mfma_f32_16x16x32_bf16 v[76:79], v[156:159], a[144:147], v[76:79]
 ds_read_b64_tr_b16 v[200:201], v14 offset:51328
 v_mfma_f32_16x16x32_bf16 v[116:119], v[156:159], a[148:151], v[116:119]
 ds_read_b64_tr_b16 v[202:203], v14 offset:52608
 v_mfma_f32_16x16x32_bf16 v[80:83], v[160:163], a[144:147], v[80:83]
 ds_read_b64_tr_b16 v[204:205], v15 offset:51360
 v_mfma_f32_16x16x32_bf16 v[120:123], v[160:163], a[148:151], v[120:123]
 ds_read_b64_tr_b16 v[206:207], v15 offset:52640
 v_mfma_f32_16x16x32_bf16 v[84:87], v[164:167], a[144:147], v[84:87]
 ds_read_b64_tr_b16 v[208:209], v14 offset:51392
 v_mfma_f32_16x16x32_bf16 v[124:127], v[164:167], a[148:151], v[124:127]
 ds_read_b64_tr_b16 v[210:211], v14 offset:52672
 ds_read_b64_tr_b16 v[212:213], v15 offset:51424
 v_mfma_f32_16x16x32_bf16 v[88:91], v[168:171], a[144:147], v[88:91]
 ds_read_b64_tr_b16 v[214:215], v15 offset:52704
 v_mfma_f32_16x16x32_bf16 v[128:131], v[168:171], a[148:151], v[128:131]
 buffer_load_dwordx4 v[42:45], v4, s[8:11], s50 offen
 ds_read_b64_tr_b16 v[216:217], v14 offset:51456
 v_mfma_f32_16x16x32_bf16 v[92:95], v[172:175], a[144:147], v[92:95]
 ds_read_b64_tr_b16 v[218:219], v14 offset:52736
 v_mfma_f32_16x16x32_bf16 v[132:135], v[172:175], a[148:151], v[132:135]
 ds_read_b64_tr_b16 v[220:221], v15 offset:51488
 v_mfma_f32_16x16x32_bf16 v[96:99], v[176:179], a[144:147], v[96:99]
 ds_read_b64_tr_b16 v[222:223], v15 offset:52768
 v_mfma_f32_16x16x32_bf16 v[136:139], v[176:179], a[148:151], v[136:139]
 buffer_load_dword v46, v5, s[8:11], s50 offen offset:1024
 v_mfma_f32_16x16x32_bf16 v[100:103], v[180:183], a[144:147], v[100:103]
 s_add_u32 s50, s50, 1280
 v_mfma_f32_16x16x32_bf16 v[140:143], v[180:183], a[148:151], v[140:143]
 s_waitcnt lgkmcnt(0) vmcnt(18)
 v_mfma_f32_16x16x32_bf16 v[64:67], v[184:187], a[152:155], v[64:67]
 v_mfma_f32_16x16x32_bf16 v[104:107], v[184:187], a[156:159], v[104:107]
 v_mfma_f32_16x16x32_bf16 v[68:71], v[188:191], a[152:155], v[68:71]
 v_mfma_f32_16x16x32_bf16 v[108:111], v[188:191], a[156:159], v[108:111]
 v_mfma_f32_16x16x32_bf16 v[72:75], v[192:195], a[152:155], v[72:75]
 v_mfma_f32_16x16x32_bf16 v[112:115], v[192:195], a[156:159], v[112:115]
 v_mfma_f32_16x16x32_bf16 v[76:79], v[196:199], a[152:155], v[76:79]
 v_mfma_f32_16x16x32_bf16 v[116:119], v[196:199], a[156:159], v[116:119]
 v_mfma_f32_16x16x32_bf16 v[80:83], v[200:203], a[152:155], v[80:83]
 v_mfma_f32_16x16x32_bf16 v[120:123], v[200:203], a[156:159], v[120:123]
 v_mfma_f32_16x16x32_bf16 v[84:87], v[204:207], a[152:155], v[84:87]
 v_mfma_f32_16x16x32_bf16 v[124:127], v[204:207], a[156:159], v[124:127]
 v_mfma_f32_16x16x32_bf16 v[88:91], v[208:211], a[152:155], v[88:91]
 v_mfma_f32_16x16x32_bf16 v[128:131], v[208:211], a[156:159], v[128:131]
 v_mfma_f32_16x16x32_bf16 v[92:95], v[212:215], a[152:155], v[92:95]
 v_mfma_f32_16x16x32_bf16 v[132:135], v[212:215], a[156:159], v[132:135]
 v_mfma_f32_16x16x32_bf16 v[96:99], v[216:219], a[152:155], v[96:99]
 v_mfma_f32_16x16x32_bf16 v[136:139], v[216:219], a[156:159], v[136:139]
 v_mfma_f32_16x16x32_bf16 v[100:103], v[220:223], a[152:155], v[100:103]
 v_mfma_f32_16x16x32_bf16 v[140:143], v[220:223], a[156:159], v[140:143]
 s_add_u32 s16, s38, 73400320
 s_addc_u32 s17, s39, 0
 s_mov_b32 s18, 5242880
 s_mov_b32 s19, 0x00020000
 s_nop 3
 s_mul_i32 s21, s47, 40
 s_mul_i32 s22, s44, 10
 s_add_u32 s21, s21, s22
 s_lshl_b32 s21, s21, 10
 s_cmp_lt_u32 s2, 32
 s_cbranch_scc1 om_232
 s_add_u32 s22, s21, 0
 buffer_store_dwordx4 v[64:67], v4, s[16:19], s22 offen offset:0 sc1
 buffer_store_dwordx4 v[68:71], v4, s[16:19], s22 offen offset:1024 sc1
 buffer_store_dwordx4 v[72:75], v4, s[16:19], s22 offen offset:2048 sc1
 buffer_store_dwordx4 v[76:79], v4, s[16:19], s22 offen offset:3072 sc1
 s_add_u32 s22, s21, 4096
 buffer_store_dwordx4 v[80:83], v4, s[16:19], s22 offen offset:0 sc1
 buffer_store_dwordx4 v[84:87], v4, s[16:19], s22 offen offset:1024 sc1
 buffer_store_dwordx4 v[88:91], v4, s[16:19], s22 offen offset:2048 sc1
 buffer_store_dwordx4 v[92:95], v4, s[16:19], s22 offen offset:3072 sc1
 s_add_u32 s22, s21, 8192
 buffer_store_dwordx4 v[96:99], v4, s[16:19], s22 offen offset:0 sc1
 buffer_store_dwordx4 v[100:103], v4, s[16:19], s22 offen offset:1024 sc1
 s_add_u32 s22, s21, 40960
 buffer_store_dwordx4 v[104:107], v4, s[16:19], s22 offen offset:0 sc1
 buffer_store_dwordx4 v[108:111], v4, s[16:19], s22 offen offset:1024 sc1
 buffer_store_dwordx4 v[112:115], v4, s[16:19], s22 offen offset:2048 sc1
 buffer_store_dwordx4 v[116:119], v4, s[16:19], s22 offen offset:3072 sc1
 s_add_u32 s22, s21, 45056
 buffer_store_dwordx4 v[120:123], v4, s[16:19], s22 offen offset:0 sc1
 buffer_store_dwordx4 v[124:127], v4, s[16:19], s22 offen offset:1024 sc1
 buffer_store_dwordx4 v[128:131], v4, s[16:19], s22 offen offset:2048 sc1
 buffer_store_dwordx4 v[132:135], v4, s[16:19], s22 offen offset:3072 sc1
 s_add_u32 s22, s21, 49152
 buffer_store_dwordx4 v[136:139], v4, s[16:19], s22 offen offset:0 sc1
 buffer_store_dwordx4 v[140:143], v4, s[16:19], s22 offen offset:1024 sc1
 s_sub_u32 s50, s50, 1320960
 buffer_load_dwordx4 v[160:163], v4, s[8:11], s50 offen
 buffer_load_dword v164, v5, s[8:11], s50 offen offset:1024
 s_add_u32 s50, s50, 1280
 buffer_load_dwordx4 v[166:169], v4, s[8:11], s50 offen
 buffer_load_dword v170, v5, s[8:11], s50 offen offset:1024
 s_add_u32 s50, s50, 1280
 buffer_load_dwordx4 v[172:175], v4, s[8:11], s50 offen
 buffer_load_dword v176, v5, s[8:11], s50 offen offset:1024
 s_add_u32 s50, s50, 1280
 buffer_load_dwordx4 v[178:181], v4, s[8:11], s50 offen
 buffer_load_dword v182, v5, s[8:11], s50 offen offset:1024
 s_add_u32 s50, s50, 1280
 buffer_load_dwordx4 v[184:187], v4, s[8:11], s50 offen
 buffer_load_dword v188, v5, s[8:11], s50 offen offset:1024
 s_add_u32 s50, s50, 1280
 buffer_load_dwordx4 v[190:193], v4, s[8:11], s50 offen
 buffer_load_dword v194, v5, s[8:11], s50 offen offset:1024
 s_add_u32 s50, s50, 1280
 buffer_load_dwordx4 v[196:199], v4, s[8:11], s50 offen
 buffer_load_dword v200, v5, s[8:11], s50 offen offset:1024
 s_add_u32 s50, s50, 1280
 buffer_load_dwordx4 v[202:205], v4, s[8:11], s50 offen
 buffer_load_dword v206, v5, s[8:11], s50 offen offset:1024
 s_add_u32 s50, s50, 1280
 s_waitcnt vmcnt(36)
 v_lshlrev_b32 v57, 16, v52
 v_and_b32 v52, 0xffff0000, v52
 v_lshlrev_b32 v58, 16, v53
 v_and_b32 v53, 0xffff0000, v53
 v_lshlrev_b32 v59, 16, v54
 v_and_b32 v54, 0xffff0000, v54
 v_lshlrev_b32 v60, 16, v55
 v_and_b32 v55, 0xffff0000, v55
 v_lshlrev_b32 v61, 16, v56
 v_and_b32 v56, 0xffff0000, v56
 v_lshlrev_b32 v25, 16, v224
 v_and_b32 v26, 0xffff0000, v224
 v_mul_f32 v25, v25, v57
 v_mul_f32 v26, v26, v52
 v_cvt_pk_bf16_f32 v25, v25, v26
 v_lshlrev_b32 v26, 16, v25
 v_and_b32 v25, 0xffff0000, v25
 v_add_f32 v144, v25, v26
 v_lshlrev_b32 v25, 16, v225
 v_and_b32 v26, 0xffff0000, v225
 v_mul_f32 v25, v25, v58
 v_mul_f32 v26, v26, v53
 v_cvt_pk_bf16_f32 v25, v25, v26
 v_lshlrev_b32 v26, 16, v25
 v_and_b32 v25, 0xffff0000, v25
 v_add_f32 v144, v144, v26
 v_add_f32 v144, v144, v25
 v_lshlrev_b32 v25, 16, v226
 v_and_b32 v26, 0xffff0000, v226
 v_mul_f32 v25, v25, v59
 v_mul_f32 v26, v26, v54
 v_cvt_pk_bf16_f32 v25, v25, v26
 v_lshlrev_b32 v26, 16, v25
 v_and_b32 v25, 0xffff0000, v25
 v_add_f32 v144, v144, v26
 v_add_f32 v144, v144, v25
 v_lshlrev_b32 v25, 16, v227
 v_and_b32 v26, 0xffff0000, v227
 v_mul_f32 v25, v25, v60
 v_mul_f32 v26, v26, v55
 v_cvt_pk_bf16_f32 v25, v25, v26
 v_lshlrev_b32 v26, 16, v25
 v_and_b32 v25, 0xffff0000, v25
 v_add_f32 v144, v144, v26
 v_add_f32 v144, v144, v25
 v_lshlrev_b32 v25, 16, v228
 v_and_b32 v26, 0xffff0000, v228
 v_mul_f32 v25, v25, v61
 v_mul_f32 v26, v26, v56
 v_cvt_pk_bf16_f32 v25, v25, v26
 v_lshlrev_b32 v26, 16, v25
 v_and_b32 v25, 0xffff0000, v25
 v_add_f32 v144, v144, v26
 v_add_f32 v144, v144, v25
 v_lshlrev_b32 v25, 16, v230
 v_and_b32 v26, 0xffff0000, v230
 v_mul_f32 v25, v25, v57
 v_mul_f32 v26, v26, v52
 v_cvt_pk_bf16_f32 v25, v25, v26
 v_lshlrev_b32 v26, 16, v25
 v_and_b32 v25, 0xffff0000, v25
 v_add_f32 v145, v25, v26
 v_lshlrev_b32 v25, 16, v231
 v_and_b32 v26, 0xffff0000, v231
 v_mul_f32 v25, v25, v58
 v_mul_f32 v26, v26, v53
 v_cvt_pk_bf16_f32 v25, v25, v26
 v_lshlrev_b32 v26, 16, v25
 v_and_b32 v25, 0xffff0000, v25
 v_add_f32 v145, v145, v26
 v_add_f32 v145, v145, v25
 v_lshlrev_b32 v25, 16, v232
 v_and_b32 v26, 0xffff0000, v232
 v_mul_f32 v25, v25, v59
 v_mul_f32 v26, v26, v54
 v_cvt_pk_bf16_f32 v25, v25, v26
 v_lshlrev_b32 v26, 16, v25
 v_and_b32 v25, 0xffff0000, v25
 v_add_f32 v145, v145, v26
 v_add_f32 v145, v145, v25
 v_lshlrev_b32 v25, 16, v233
 v_and_b32 v26, 0xffff0000, v233
 v_mul_f32 v25, v25, v60
 v_mul_f32 v26, v26, v55
 v_cvt_pk_bf16_f32 v25, v25, v26
 v_lshlrev_b32 v26, 16, v25
 v_and_b32 v25, 0xffff0000, v25
 v_add_f32 v145, v145, v26
 v_add_f32 v145, v145, v25
 v_lshlrev_b32 v25, 16, v234
 v_and_b32 v26, 0xffff0000, v234
 v_mul_f32 v25, v25, v61
 v_mul_f32 v26, v26, v56
 v_cvt_pk_bf16_f32 v25, v25, v26
 v_lshlrev_b32 v26, 16, v25
 v_and_b32 v25, 0xffff0000, v25
 v_add_f32 v145, v145, v26
 v_add_f32 v145, v145, v25
 v_lshlrev_b32 v25, 16, v236
 v_and_b32 v26, 0xffff0000, v236
 v_mul_f32 v25, v25, v57
 v_mul_f32 v26, v26, v52
 v_cvt_pk_bf16_f32 v25, v25, v26
 v_lshlrev_b32 v26, 16, v25
 v_and_b32 v25, 0xffff0000, v25
 v_add_f32 v146, v25, v26
 v_lshlrev_b32 v25, 16, v237
 v_and_b32 v26, 0xffff0000, v237
 v_mul_f32 v25, v25, v58
 v_mul_f32 v26, v26, v53
 v_cvt_pk_bf16_f32 v25, v25, v26
 v_lshlrev_b32 v26, 16, v25
 v_and_b32 v25, 0xffff0000, v25
 v_add_f32 v146, v146, v26
 v_add_f32 v146, v146, v25
 v_lshlrev_b32 v25, 16, v238
 v_and_b32 v26, 0xffff0000, v238
 v_mul_f32 v25, v25, v59
 v_mul_f32 v26, v26, v54
 v_cvt_pk_bf16_f32 v25, v25, v26
 v_lshlrev_b32 v26, 16, v25
 v_and_b32 v25, 0xffff0000, v25
 v_add_f32 v146, v146, v26
 v_add_f32 v146, v146, v25
 v_lshlrev_b32 v25, 16, v239
 v_and_b32 v26, 0xffff0000, v239
 v_mul_f32 v25, v25, v60
 v_mul_f32 v26, v26, v55
 v_cvt_pk_bf16_f32 v25, v25, v26
 v_lshlrev_b32 v26, 16, v25
 v_and_b32 v25, 0xffff0000, v25
 v_add_f32 v146, v146, v26
 v_add_f32 v146, v146, v25
 v_lshlrev_b32 v25, 16, v240
 v_and_b32 v26, 0xffff0000, v240
 v_mul_f32 v25, v25, v61
 v_mul_f32 v26, v26, v56
 v_cvt_pk_bf16_f32 v25, v25, v26
 v_lshlrev_b32 v26, 16, v25
 v_and_b32 v25, 0xffff0000, v25
 v_add_f32 v146, v146, v26
 v_add_f32 v146, v146, v25
 v_lshlrev_b32 v25, 16, v242
 v_and_b32 v26, 0xffff0000, v242
 v_mul_f32 v25, v25, v57
 v_mul_f32 v26, v26, v52
 v_cvt_pk_bf16_f32 v25, v25, v26
 v_lshlrev_b32 v26, 16, v25
 v_and_b32 v25, 0xffff0000, v25
 v_add_f32 v147, v25, v26
 v_lshlrev_b32 v25, 16, v243
 v_and_b32 v26, 0xffff0000, v243
 v_mul_f32 v25, v25, v58
 v_mul_f32 v26, v26, v53
 v_cvt_pk_bf16_f32 v25, v25, v26
 v_lshlrev_b32 v26, 16, v25
 v_and_b32 v25, 0xffff0000, v25
 v_add_f32 v147, v147, v26
 v_add_f32 v147, v147, v25
 v_lshlrev_b32 v25, 16, v244
 v_and_b32 v26, 0xffff0000, v244
 v_mul_f32 v25, v25, v59
 v_mul_f32 v26, v26, v54
 v_cvt_pk_bf16_f32 v25, v25, v26
 v_lshlrev_b32 v26, 16, v25
 v_and_b32 v25, 0xffff0000, v25
 v_add_f32 v147, v147, v26
 v_add_f32 v147, v147, v25
 v_lshlrev_b32 v25, 16, v245
 v_and_b32 v26, 0xffff0000, v245
 v_mul_f32 v25, v25, v60
 v_mul_f32 v26, v26, v55
 v_cvt_pk_bf16_f32 v25, v25, v26
 v_lshlrev_b32 v26, 16, v25
 v_and_b32 v25, 0xffff0000, v25
 v_add_f32 v147, v147, v26
 v_add_f32 v147, v147, v25
 v_lshlrev_b32 v25, 16, v246
 v_and_b32 v26, 0xffff0000, v246
 v_mul_f32 v25, v25, v61
 v_mul_f32 v26, v26, v56
 v_cvt_pk_bf16_f32 v25, v25, v26
 v_lshlrev_b32 v26, 16, v25
 v_and_b32 v25, 0xffff0000, v25
 v_add_f32 v147, v147, v26
 v_add_f32 v147, v147, v25
 v_lshlrev_b32 v25, 16, v248
 v_and_b32 v26, 0xffff0000, v248
 v_mul_f32 v25, v25, v57
 v_mul_f32 v26, v26, v52
 v_cvt_pk_bf16_f32 v25, v25, v26
 v_lshlrev_b32 v26, 16, v25
 v_and_b32 v25, 0xffff0000, v25
 v_add_f32 v148, v25, v26
 v_lshlrev_b32 v25, 16, v249
 v_and_b32 v26, 0xffff0000, v249
 v_mul_f32 v25, v25, v58
 v_mul_f32 v26, v26, v53
 v_cvt_pk_bf16_f32 v25, v25, v26
 v_lshlrev_b32 v26, 16, v25
 v_and_b32 v25, 0xffff0000, v25
 v_add_f32 v148, v148, v26
 v_add_f32 v148, v148, v25
 v_lshlrev_b32 v25, 16, v250
 v_and_b32 v26, 0xffff0000, v250
 v_mul_f32 v25, v25, v59
 v_mul_f32 v26, v26, v54
 v_cvt_pk_bf16_f32 v25, v25, v26
 v_lshlrev_b32 v26, 16, v25
 v_and_b32 v25, 0xffff0000, v25
 v_add_f32 v148, v148, v26
 v_add_f32 v148, v148, v25
 v_lshlrev_b32 v25, 16, v251
 v_and_b32 v26, 0xffff0000, v251
 v_mul_f32 v25, v25, v60
 v_mul_f32 v26, v26, v55
 v_cvt_pk_bf16_f32 v25, v25, v26
 v_lshlrev_b32 v26, 16, v25
 v_and_b32 v25, 0xffff0000, v25
 v_add_f32 v148, v148, v26
 v_add_f32 v148, v148, v25
 v_lshlrev_b32 v25, 16, v252
 v_and_b32 v26, 0xffff0000, v252
 v_mul_f32 v25, v25, v61
 v_mul_f32 v26, v26, v56
 v_cvt_pk_bf16_f32 v25, v25, v26
 v_lshlrev_b32 v26, 16, v25
 v_and_b32 v25, 0xffff0000, v25
 v_add_f32 v148, v148, v26
 v_add_f32 v148, v148, v25
 v_lshlrev_b32 v25, 16, v30
 v_and_b32 v26, 0xffff0000, v30
 v_mul_f32 v25, v25, v57
 v_mul_f32 v26, v26, v52
 v_cvt_pk_bf16_f32 v25, v25, v26
 v_lshlrev_b32 v26, 16, v25
 v_and_b32 v25, 0xffff0000, v25
 v_add_f32 v149, v25, v26
 v_lshlrev_b32 v25, 16, v31
 v_and_b32 v26, 0xffff0000, v31
 v_mul_f32 v25, v25, v58
 v_mul_f32 v26, v26, v53
 v_cvt_pk_bf16_f32 v25, v25, v26
 v_lshlrev_b32 v26, 16, v25
 v_and_b32 v25, 0xffff0000, v25
 v_add_f32 v149, v149, v26
 v_add_f32 v149, v149, v25
 v_lshlrev_b32 v25, 16, v32
 v_and_b32 v26, 0xffff0000, v32
 v_mul_f32 v25, v25, v59
 v_mul_f32 v26, v26, v54
 v_cvt_pk_bf16_f32 v25, v25, v26
 v_lshlrev_b32 v26, 16, v25
 v_and_b32 v25, 0xffff0000, v25
 v_add_f32 v149, v149, v26
 v_add_f32 v149, v149, v25
 v_lshlrev_b32 v25, 16, v33
 v_and_b32 v26, 0xffff0000, v33
 v_mul_f32 v25, v25, v60
 v_mul_f32 v26, v26, v55
 v_cvt_pk_bf16_f32 v25, v25, v26
 v_lshlrev_b32 v26, 16, v25
 v_and_b32 v25, 0xffff0000, v25
 v_add_f32 v149, v149, v26
 v_add_f32 v149, v149, v25
 v_lshlrev_b32 v25, 16, v34
 v_and_b32 v26, 0xffff0000, v34
 v_mul_f32 v25, v25, v61
 v_mul_f32 v26, v26, v56
 v_cvt_pk_bf16_f32 v25, v25, v26
 v_lshlrev_b32 v26, 16, v25
 v_and_b32 v25, 0xffff0000, v25
 v_add_f32 v149, v149, v26
 v_add_f32 v149, v149, v25
 v_lshlrev_b32 v25, 16, v36
 v_and_b32 v26, 0xffff0000, v36
 v_mul_f32 v25, v25, v57
 v_mul_f32 v26, v26, v52
 v_cvt_pk_bf16_f32 v25, v25, v26
 v_lshlrev_b32 v26, 16, v25
 v_and_b32 v25, 0xffff0000, v25
 v_add_f32 v150, v25, v26
 v_lshlrev_b32 v25, 16, v37
 v_and_b32 v26, 0xffff0000, v37
 v_mul_f32 v25, v25, v58
 v_mul_f32 v26, v26, v53
 v_cvt_pk_bf16_f32 v25, v25, v26
 v_lshlrev_b32 v26, 16, v25
 v_and_b32 v25, 0xffff0000, v25
 v_add_f32 v150, v150, v26
 v_add_f32 v150, v150, v25
 v_lshlrev_b32 v25, 16, v38
 v_and_b32 v26, 0xffff0000, v38
 v_mul_f32 v25, v25, v59
 v_mul_f32 v26, v26, v54
 v_cvt_pk_bf16_f32 v25, v25, v26
 v_lshlrev_b32 v26, 16, v25
 v_and_b32 v25, 0xffff0000, v25
 v_add_f32 v150, v150, v26
 v_add_f32 v150, v150, v25
 v_lshlrev_b32 v25, 16, v39
 v_and_b32 v26, 0xffff0000, v39
 v_mul_f32 v25, v25, v60
 v_mul_f32 v26, v26, v55
 v_cvt_pk_bf16_f32 v25, v25, v26
 v_lshlrev_b32 v26, 16, v25
 v_and_b32 v25, 0xffff0000, v25
 v_add_f32 v150, v150, v26
 v_add_f32 v150, v150, v25
 v_lshlrev_b32 v25, 16, v40
 v_and_b32 v26, 0xffff0000, v40
 v_mul_f32 v25, v25, v61
 v_mul_f32 v26, v26, v56
 v_cvt_pk_bf16_f32 v25, v25, v26
 v_lshlrev_b32 v26, 16, v25
 v_and_b32 v25, 0xffff0000, v25
 v_add_f32 v150, v150, v26
 v_add_f32 v150, v150, v25
 v_lshlrev_b32 v25, 16, v42
 v_and_b32 v26, 0xffff0000, v42
 v_mul_f32 v25, v25, v57
 v_mul_f32 v26, v26, v52
 v_cvt_pk_bf16_f32 v25, v25, v26
 v_lshlrev_b32 v26, 16, v25
 v_and_b32 v25, 0xffff0000, v25
 v_add_f32 v151, v25, v26
 v_lshlrev_b32 v25, 16, v43
 v_and_b32 v26, 0xffff0000, v43
 v_mul_f32 v25, v25, v58
 v_mul_f32 v26, v26, v53
 v_cvt_pk_bf16_f32 v25, v25, v26
 v_lshlrev_b32 v26, 16, v25
 v_and_b32 v25, 0xffff0000, v25
 v_add_f32 v151, v151, v26
 v_add_f32 v151, v151, v25
 v_lshlrev_b32 v25, 16, v44
 v_and_b32 v26, 0xffff0000, v44
 v_mul_f32 v25, v25, v59
 v_mul_f32 v26, v26, v54
 v_cvt_pk_bf16_f32 v25, v25, v26
 v_lshlrev_b32 v26, 16, v25
 v_and_b32 v25, 0xffff0000, v25
 v_add_f32 v151, v151, v26
 v_add_f32 v151, v151, v25
 v_lshlrev_b32 v25, 16, v45
 v_and_b32 v26, 0xffff0000, v45
 v_mul_f32 v25, v25, v60
 v_mul_f32 v26, v26, v55
 v_cvt_pk_bf16_f32 v25, v25, v26
 v_lshlrev_b32 v26, 16, v25
 v_and_b32 v25, 0xffff0000, v25
 v_add_f32 v151, v151, v26
 v_add_f32 v151, v151, v25
 v_lshlrev_b32 v25, 16, v46
 v_and_b32 v26, 0xffff0000, v46
 v_mul_f32 v25, v25, v61
 v_mul_f32 v26, v26, v56
 v_cvt_pk_bf16_f32 v25, v25, v26
 v_lshlrev_b32 v26, 16, v25
 v_and_b32 v25, 0xffff0000, v25
 v_add_f32 v151, v151, v26
 v_add_f32 v151, v151, v25
 v_add_f32_dpp v144, v144, v144 row_ror:8 row_mask:0xf bank_mask:0xf
 v_add_f32_dpp v145, v145, v145 row_ror:8 row_mask:0xf bank_mask:0xf
 v_add_f32_dpp v146, v146, v146 row_ror:8 row_mask:0xf bank_mask:0xf
 v_add_f32_dpp v147, v147, v147 row_ror:8 row_mask:0xf bank_mask:0xf
 v_add_f32_dpp v148, v148, v148 row_ror:8 row_mask:0xf bank_mask:0xf
 v_add_f32_dpp v149, v149, v149 row_ror:8 row_mask:0xf bank_mask:0xf
 v_add_f32_dpp v150, v150, v150 row_ror:8 row_mask:0xf bank_mask:0xf
 v_add_f32_dpp v151, v151, v151 row_ror:8 row_mask:0xf bank_mask:0xf
 v_add_f32_dpp v144, v144, v144 row_ror:4 row_mask:0xf bank_mask:0xf
 v_add_f32_dpp v145, v145, v145 row_ror:4 row_mask:0xf bank_mask:0xf
 v_add_f32_dpp v146, v146, v146 row_ror:4 row_mask:0xf bank_mask:0xf
 v_add_f32_dpp v147, v147, v147 row_ror:4 row_mask:0xf bank_mask:0xf
 v_add_f32_dpp v148, v148, v148 row_ror:4 row_mask:0xf bank_mask:0xf
 v_add_f32_dpp v149, v149, v149 row_ror:4 row_mask:0xf bank_mask:0xf
 v_add_f32_dpp v150, v150, v150 row_ror:4 row_mask:0xf bank_mask:0xf
 v_add_f32_dpp v151, v151, v151 row_ror:4 row_mask:0xf bank_mask:0xf
 v_add_f32_dpp v144, v144, v144 row_ror:2 row_mask:0xf bank_mask:0xf
 v_add_f32_dpp v145, v145, v145 row_ror:2 row_mask:0xf bank_mask:0xf
 v_add_f32_dpp v146, v146, v146 row_ror:2 row_mask:0xf bank_mask:0xf
 v_add_f32_dpp v147, v147, v147 row_ror:2 row_mask:0xf bank_mask:0xf
 v_add_f32_dpp v148, v148, v148 row_ror:2 row_mask:0xf bank_mask:0xf
 v_add_f32_dpp v149, v149, v149 row_ror:2 row_mask:0xf bank_mask:0xf
 v_add_f32_dpp v150, v150, v150 row_ror:2 row_mask:0xf bank_mask:0xf
 v_add_f32_dpp v151, v151, v151 row_ror:2 row_mask:0xf bank_mask:0xf
 v_add_f32_dpp v144, v144, v144 row_ror:1 row_mask:0xf bank_mask:0xf
 v_add_f32_dpp v145, v145, v145 row_ror:1 row_mask:0xf bank_mask:0xf
 v_add_f32_dpp v146, v146, v146 row_ror:1 row_mask:0xf bank_mask:0xf
 v_add_f32_dpp v147, v147, v147 row_ror:1 row_mask:0xf bank_mask:0xf
 v_add_f32_dpp v148, v148, v148 row_ror:1 row_mask:0xf bank_mask:0xf
 v_add_f32_dpp v149, v149, v149 row_ror:1 row_mask:0xf bank_mask:0xf
 v_add_f32_dpp v150, v150, v150 row_ror:1 row_mask:0xf bank_mask:0xf
 v_add_f32_dpp v151, v151, v151 row_ror:1 row_mask:0xf bank_mask:0xf
 v_mov_b32 v152, v144
 v_mov_b32 v153, v145
 v_mov_b32 v154, v146
 v_mov_b32 v155, v147
 v_mov_b32 v156, v148
 v_mov_b32 v157, v149
 v_mov_b32 v158, v150
 v_mov_b32 v159, v151
 v_permlane32_swap_b32 v144, v152
 v_permlane32_swap_b32 v145, v153
 v_permlane32_swap_b32 v146, v154
 v_permlane32_swap_b32 v147, v155
 v_permlane32_swap_b32 v148, v156
 v_permlane32_swap_b32 v149, v157
 v_permlane32_swap_b32 v150, v158
 v_permlane32_swap_b32 v151, v159
 v_add_f32 v144, v144, v152
 v_add_f32 v145, v145, v153
 v_add_f32 v146, v146, v154
 v_add_f32 v147, v147, v155
 v_add_f32 v148, v148, v156
 v_add_f32 v149, v149, v157
 v_add_f32 v150, v150, v158
 v_add_f32 v151, v151, v159
 v_mov_b32 v152, v144
 v_mov_b32 v153, v145
 v_mov_b32 v154, v146
 v_mov_b32 v155, v147
 v_mov_b32 v156, v148
 v_mov_b32 v157, v149
 v_mov_b32 v158, v150
 v_mov_b32 v159, v151
 v_permlane16_swap_b32 v144, v152
 v_permlane16_swap_b32 v145, v153
 v_permlane16_swap_b32 v146, v154
 v_permlane16_swap_b32 v147, v155
 v_permlane16_swap_b32 v148, v156
 v_permlane16_swap_b32 v149, v157
 v_permlane16_swap_b32 v150, v158
 v_permlane16_swap_b32 v151, v159
 v_add_f32 v144, v144, v152
 v_add_f32 v145, v145, v153
 v_add_f32 v146, v146, v154
 v_add_f32 v147, v147, v155
 v_add_f32 v148, v148, v156
 v_add_f32 v149, v149, v157
 v_add_f32 v150, v150, v158
 v_add_f32 v151, v151, v159
 v_mov_b32 v24, v144
 v_cmp_eq_u32 vcc, 1, v1
 s_nop 1
 v_cndmask_b32 v24, v24, v145, vcc
 v_cmp_eq_u32 vcc, 2, v1
 s_nop 1
 v_cndmask_b32 v24, v24, v146, vcc
 v_cmp_eq_u32 vcc, 3, v1
 s_nop 1
 v_cndmask_b32 v24, v24, v147, vcc
 v_cmp_eq_u32 vcc, 4, v1
 s_nop 1
 v_cndmask_b32 v24, v24, v148, vcc
 v_cmp_eq_u32 vcc, 5, v1
 s_nop 1
 v_cndmask_b32 v24, v24, v149, vcc
 v_cmp_eq_u32 vcc, 6, v1
 s_nop 1
 v_cndmask_b32 v24, v24, v150, vcc
 v_cmp_eq_u32 vcc, 7, v1
 s_nop 1
 v_cndmask_b32 v24, v24, v151, vcc
 v_cvt_pk_bf16_f32 v25, v24, v24
 v_lshlrev_b32 v24, 16, v25
 v_mul_f32 v24, 0xbfb8aa3b, v24
 v_exp_f32 v24, v24
 s_nop 0
 v_add_f32 v24, 1.0, v24
 v_rcp_f32 v24, v24
 s_nop 0
 v_cvt_pk_bf16_f32 v25, v24, v24
 v_lshlrev_b32 v24, 16, v25
 s_lshl_b32 s21, s59, 2
 s_mov_b64 exec, 0xff
 buffer_store_dword v24, v5, s[28:31], s21 offen sc1
 s_mov_b64 exec, -1
 s_sub_u32 s59, s59, 1024
 s_waitcnt vmcnt(1)
 v_lshlrev_b32 v25, 16, v160
 v_and_b32 v26, 0xffff0000, v160
 v_mul_f32 v25, v25, v57
 v_mul_f32 v26, v26, v52
 v_cvt_pk_bf16_f32 v25, v25, v26
 v_lshlrev_b32 v26, 16, v25
 v_and_b32 v25, 0xffff0000, v25
 v_add_f32 v144, v25, v26
 v_lshlrev_b32 v25, 16, v161
 v_and_b32 v26, 0xffff0000, v161
 v_mul_f32 v25, v25, v58
 v_mul_f32 v26, v26, v53
 v_cvt_pk_bf16_f32 v25, v25, v26
 v_lshlrev_b32 v26, 16, v25
 v_and_b32 v25, 0xffff0000, v25
 v_add_f32 v144, v144, v26
 v_add_f32 v144, v144, v25
 v_lshlrev_b32 v25, 16, v162
 v_and_b32 v26, 0xffff0000, v162
 v_mul_f32 v25, v25, v59
 v_mul_f32 v26, v26, v54
 v_cvt_pk_bf16_f32 v25, v25, v26
 v_lshlrev_b32 v26, 16, v25
 v_and_b32 v25, 0xffff0000, v25
 v_add_f32 v144, v144, v26
 v_add_f32 v144, v144, v25
 v_lshlrev_b32 v25, 16, v163
 v_and_b32 v26, 0xffff0000, v163
 v_mul_f32 v25, v25, v60
 v_mul_f32 v26, v26, v55
 v_cvt_pk_bf16_f32 v25, v25, v26
 v_lshlrev_b32 v26, 16, v25
 v_and_b32 v25, 0xffff0000, v25
 v_add_f32 v144, v144, v26
 v_add_f32 v144, v144, v25
 v_lshlrev_b32 v25, 16, v164
 v_and_b32 v26, 0xffff0000, v164
 v_mul_f32 v25, v25, v61
 v_mul_f32 v26, v26, v56
 v_cvt_pk_bf16_f32 v25, v25, v26
 v_lshlrev_b32 v26, 16, v25
 v_and_b32 v25, 0xffff0000, v25
 v_add_f32 v144, v144, v26
 v_add_f32 v144, v144, v25
 v_lshlrev_b32 v25, 16, v166
 v_and_b32 v26, 0xffff0000, v166
 v_mul_f32 v25, v25, v57
 v_mul_f32 v26, v26, v52
 v_cvt_pk_bf16_f32 v25, v25, v26
 v_lshlrev_b32 v26, 16, v25
 v_and_b32 v25, 0xffff0000, v25
 v_add_f32 v145, v25, v26
 v_lshlrev_b32 v25, 16, v167
 v_and_b32 v26, 0xffff0000, v167
 v_mul_f32 v25, v25, v58
 v_mul_f32 v26, v26, v53
 v_cvt_pk_bf16_f32 v25, v25, v26
 v_lshlrev_b32 v26, 16, v25
 v_and_b32 v25, 0xffff0000, v25
 v_add_f32 v145, v145, v26
 v_add_f32 v145, v145, v25
 v_lshlrev_b32 v25, 16, v168
 v_and_b32 v26, 0xffff0000, v168
 v_mul_f32 v25, v25, v59
 v_mul_f32 v26, v26, v54
 v_cvt_pk_bf16_f32 v25, v25, v26
 v_lshlrev_b32 v26, 16, v25
 v_and_b32 v25, 0xffff0000, v25
 v_add_f32 v145, v145, v26
 v_add_f32 v145, v145, v25
 v_lshlrev_b32 v25, 16, v169
 v_and_b32 v26, 0xffff0000, v169
 v_mul_f32 v25, v25, v60
 v_mul_f32 v26, v26, v55
 v_cvt_pk_bf16_f32 v25, v25, v26
 v_lshlrev_b32 v26, 16, v25
 v_and_b32 v25, 0xffff0000, v25
 v_add_f32 v145, v145, v26
 v_add_f32 v145, v145, v25
 v_lshlrev_b32 v25, 16, v170
 v_and_b32 v26, 0xffff0000, v170
 v_mul_f32 v25, v25, v61
 v_mul_f32 v26, v26, v56
 v_cvt_pk_bf16_f32 v25, v25, v26
 v_lshlrev_b32 v26, 16, v25
 v_and_b32 v25, 0xffff0000, v25
 v_add_f32 v145, v145, v26
 v_add_f32 v145, v145, v25
 v_lshlrev_b32 v25, 16, v172
 v_and_b32 v26, 0xffff0000, v172
 v_mul_f32 v25, v25, v57
 v_mul_f32 v26, v26, v52
 v_cvt_pk_bf16_f32 v25, v25, v26
 v_lshlrev_b32 v26, 16, v25
 v_and_b32 v25, 0xffff0000, v25
 v_add_f32 v146, v25, v26
 v_lshlrev_b32 v25, 16, v173
 v_and_b32 v26, 0xffff0000, v173
 v_mul_f32 v25, v25, v58
 v_mul_f32 v26, v26, v53
 v_cvt_pk_bf16_f32 v25, v25, v26
 v_lshlrev_b32 v26, 16, v25
 v_and_b32 v25, 0xffff0000, v25
 v_add_f32 v146, v146, v26
 v_add_f32 v146, v146, v25
 v_lshlrev_b32 v25, 16, v174
 v_and_b32 v26, 0xffff0000, v174
 v_mul_f32 v25, v25, v59
 v_mul_f32 v26, v26, v54
 v_cvt_pk_bf16_f32 v25, v25, v26
 v_lshlrev_b32 v26, 16, v25
 v_and_b32 v25, 0xffff0000, v25
 v_add_f32 v146, v146, v26
 v_add_f32 v146, v146, v25
 v_lshlrev_b32 v25, 16, v175
 v_and_b32 v26, 0xffff0000, v175
 v_mul_f32 v25, v25, v60
 v_mul_f32 v26, v26, v55
 v_cvt_pk_bf16_f32 v25, v25, v26
 v_lshlrev_b32 v26, 16, v25
 v_and_b32 v25, 0xffff0000, v25
 v_add_f32 v146, v146, v26
 v_add_f32 v146, v146, v25
 v_lshlrev_b32 v25, 16, v176
 v_and_b32 v26, 0xffff0000, v176
 v_mul_f32 v25, v25, v61
 v_mul_f32 v26, v26, v56
 v_cvt_pk_bf16_f32 v25, v25, v26
 v_lshlrev_b32 v26, 16, v25
 v_and_b32 v25, 0xffff0000, v25
 v_add_f32 v146, v146, v26
 v_add_f32 v146, v146, v25
 v_lshlrev_b32 v25, 16, v178
 v_and_b32 v26, 0xffff0000, v178
 v_mul_f32 v25, v25, v57
 v_mul_f32 v26, v26, v52
 v_cvt_pk_bf16_f32 v25, v25, v26
 v_lshlrev_b32 v26, 16, v25
 v_and_b32 v25, 0xffff0000, v25
 v_add_f32 v147, v25, v26
 v_lshlrev_b32 v25, 16, v179
 v_and_b32 v26, 0xffff0000, v179
 v_mul_f32 v25, v25, v58
 v_mul_f32 v26, v26, v53
 v_cvt_pk_bf16_f32 v25, v25, v26
 v_lshlrev_b32 v26, 16, v25
 v_and_b32 v25, 0xffff0000, v25
 v_add_f32 v147, v147, v26
 v_add_f32 v147, v147, v25
 v_lshlrev_b32 v25, 16, v180
 v_and_b32 v26, 0xffff0000, v180
 v_mul_f32 v25, v25, v59
 v_mul_f32 v26, v26, v54
 v_cvt_pk_bf16_f32 v25, v25, v26
 v_lshlrev_b32 v26, 16, v25
 v_and_b32 v25, 0xffff0000, v25
 v_add_f32 v147, v147, v26
 v_add_f32 v147, v147, v25
 v_lshlrev_b32 v25, 16, v181
 v_and_b32 v26, 0xffff0000, v181
 v_mul_f32 v25, v25, v60
 v_mul_f32 v26, v26, v55
 v_cvt_pk_bf16_f32 v25, v25, v26
 v_lshlrev_b32 v26, 16, v25
 v_and_b32 v25, 0xffff0000, v25
 v_add_f32 v147, v147, v26
 v_add_f32 v147, v147, v25
 v_lshlrev_b32 v25, 16, v182
 v_and_b32 v26, 0xffff0000, v182
 v_mul_f32 v25, v25, v61
 v_mul_f32 v26, v26, v56
 v_cvt_pk_bf16_f32 v25, v25, v26
 v_lshlrev_b32 v26, 16, v25
 v_and_b32 v25, 0xffff0000, v25
 v_add_f32 v147, v147, v26
 v_add_f32 v147, v147, v25
 v_lshlrev_b32 v25, 16, v184
 v_and_b32 v26, 0xffff0000, v184
 v_mul_f32 v25, v25, v57
 v_mul_f32 v26, v26, v52
 v_cvt_pk_bf16_f32 v25, v25, v26
 v_lshlrev_b32 v26, 16, v25
 v_and_b32 v25, 0xffff0000, v25
 v_add_f32 v148, v25, v26
 v_lshlrev_b32 v25, 16, v185
 v_and_b32 v26, 0xffff0000, v185
 v_mul_f32 v25, v25, v58
 v_mul_f32 v26, v26, v53
 v_cvt_pk_bf16_f32 v25, v25, v26
 v_lshlrev_b32 v26, 16, v25
 v_and_b32 v25, 0xffff0000, v25
 v_add_f32 v148, v148, v26
 v_add_f32 v148, v148, v25
 v_lshlrev_b32 v25, 16, v186
 v_and_b32 v26, 0xffff0000, v186
 v_mul_f32 v25, v25, v59
 v_mul_f32 v26, v26, v54
 v_cvt_pk_bf16_f32 v25, v25, v26
 v_lshlrev_b32 v26, 16, v25
 v_and_b32 v25, 0xffff0000, v25
 v_add_f32 v148, v148, v26
 v_add_f32 v148, v148, v25
 v_lshlrev_b32 v25, 16, v187
 v_and_b32 v26, 0xffff0000, v187
 v_mul_f32 v25, v25, v60
 v_mul_f32 v26, v26, v55
 v_cvt_pk_bf16_f32 v25, v25, v26
 v_lshlrev_b32 v26, 16, v25
 v_and_b32 v25, 0xffff0000, v25
 v_add_f32 v148, v148, v26
 v_add_f32 v148, v148, v25
 v_lshlrev_b32 v25, 16, v188
 v_and_b32 v26, 0xffff0000, v188
 v_mul_f32 v25, v25, v61
 v_mul_f32 v26, v26, v56
 v_cvt_pk_bf16_f32 v25, v25, v26
 v_lshlrev_b32 v26, 16, v25
 v_and_b32 v25, 0xffff0000, v25
 v_add_f32 v148, v148, v26
 v_add_f32 v148, v148, v25
 v_lshlrev_b32 v25, 16, v190
 v_and_b32 v26, 0xffff0000, v190
 v_mul_f32 v25, v25, v57
 v_mul_f32 v26, v26, v52
 v_cvt_pk_bf16_f32 v25, v25, v26
 v_lshlrev_b32 v26, 16, v25
 v_and_b32 v25, 0xffff0000, v25
 v_add_f32 v149, v25, v26
 v_lshlrev_b32 v25, 16, v191
 v_and_b32 v26, 0xffff0000, v191
 v_mul_f32 v25, v25, v58
 v_mul_f32 v26, v26, v53
 v_cvt_pk_bf16_f32 v25, v25, v26
 v_lshlrev_b32 v26, 16, v25
 v_and_b32 v25, 0xffff0000, v25
 v_add_f32 v149, v149, v26
 v_add_f32 v149, v149, v25
 v_lshlrev_b32 v25, 16, v192
 v_and_b32 v26, 0xffff0000, v192
 v_mul_f32 v25, v25, v59
 v_mul_f32 v26, v26, v54
 v_cvt_pk_bf16_f32 v25, v25, v26
 v_lshlrev_b32 v26, 16, v25
 v_and_b32 v25, 0xffff0000, v25
 v_add_f32 v149, v149, v26
 v_add_f32 v149, v149, v25
 v_lshlrev_b32 v25, 16, v193
 v_and_b32 v26, 0xffff0000, v193
 v_mul_f32 v25, v25, v60
 v_mul_f32 v26, v26, v55
 v_cvt_pk_bf16_f32 v25, v25, v26
 v_lshlrev_b32 v26, 16, v25
 v_and_b32 v25, 0xffff0000, v25
 v_add_f32 v149, v149, v26
 v_add_f32 v149, v149, v25
 v_lshlrev_b32 v25, 16, v194
 v_and_b32 v26, 0xffff0000, v194
 v_mul_f32 v25, v25, v61
 v_mul_f32 v26, v26, v56
 v_cvt_pk_bf16_f32 v25, v25, v26
 v_lshlrev_b32 v26, 16, v25
 v_and_b32 v25, 0xffff0000, v25
 v_add_f32 v149, v149, v26
 v_add_f32 v149, v149, v25
 v_lshlrev_b32 v25, 16, v196
 v_and_b32 v26, 0xffff0000, v196
 v_mul_f32 v25, v25, v57
 v_mul_f32 v26, v26, v52
 v_cvt_pk_bf16_f32 v25, v25, v26
 v_lshlrev_b32 v26, 16, v25
 v_and_b32 v25, 0xffff0000, v25
 v_add_f32 v150, v25, v26
 v_lshlrev_b32 v25, 16, v197
 v_and_b32 v26, 0xffff0000, v197
 v_mul_f32 v25, v25, v58
 v_mul_f32 v26, v26, v53
 v_cvt_pk_bf16_f32 v25, v25, v26
 v_lshlrev_b32 v26, 16, v25
 v_and_b32 v25, 0xffff0000, v25
 v_add_f32 v150, v150, v26
 v_add_f32 v150, v150, v25
 v_lshlrev_b32 v25, 16, v198
 v_and_b32 v26, 0xffff0000, v198
 v_mul_f32 v25, v25, v59
 v_mul_f32 v26, v26, v54
 v_cvt_pk_bf16_f32 v25, v25, v26
 v_lshlrev_b32 v26, 16, v25
 v_and_b32 v25, 0xffff0000, v25
 v_add_f32 v150, v150, v26
 v_add_f32 v150, v150, v25
 v_lshlrev_b32 v25, 16, v199
 v_and_b32 v26, 0xffff0000, v199
 v_mul_f32 v25, v25, v60
 v_mul_f32 v26, v26, v55
 v_cvt_pk_bf16_f32 v25, v25, v26
 v_lshlrev_b32 v26, 16, v25
 v_and_b32 v25, 0xffff0000, v25
 v_add_f32 v150, v150, v26
 v_add_f32 v150, v150, v25
 v_lshlrev_b32 v25, 16, v200
 v_and_b32 v26, 0xffff0000, v200
 v_mul_f32 v25, v25, v61
 v_mul_f32 v26, v26, v56
 v_cvt_pk_bf16_f32 v25, v25, v26
 v_lshlrev_b32 v26, 16, v25
 v_and_b32 v25, 0xffff0000, v25
 v_add_f32 v150, v150, v26
 v_add_f32 v150, v150, v25
 v_lshlrev_b32 v25, 16, v202
 v_and_b32 v26, 0xffff0000, v202
 v_mul_f32 v25, v25, v57
 v_mul_f32 v26, v26, v52
 v_cvt_pk_bf16_f32 v25, v25, v26
 v_lshlrev_b32 v26, 16, v25
 v_and_b32 v25, 0xffff0000, v25
 v_add_f32 v151, v25, v26
 v_lshlrev_b32 v25, 16, v203
 v_and_b32 v26, 0xffff0000, v203
 v_mul_f32 v25, v25, v58
 v_mul_f32 v26, v26, v53
 v_cvt_pk_bf16_f32 v25, v25, v26
 v_lshlrev_b32 v26, 16, v25
 v_and_b32 v25, 0xffff0000, v25
 v_add_f32 v151, v151, v26
 v_add_f32 v151, v151, v25
 v_lshlrev_b32 v25, 16, v204
 v_and_b32 v26, 0xffff0000, v204
 v_mul_f32 v25, v25, v59
 v_mul_f32 v26, v26, v54
 v_cvt_pk_bf16_f32 v25, v25, v26
 v_lshlrev_b32 v26, 16, v25
 v_and_b32 v25, 0xffff0000, v25
 v_add_f32 v151, v151, v26
 v_add_f32 v151, v151, v25
 v_lshlrev_b32 v25, 16, v205
 v_and_b32 v26, 0xffff0000, v205
 v_mul_f32 v25, v25, v60
 v_mul_f32 v26, v26, v55
 v_cvt_pk_bf16_f32 v25, v25, v26
 v_lshlrev_b32 v26, 16, v25
 v_and_b32 v25, 0xffff0000, v25
 v_add_f32 v151, v151, v26
 v_add_f32 v151, v151, v25
 v_lshlrev_b32 v25, 16, v206
 v_and_b32 v26, 0xffff0000, v206
 v_mul_f32 v25, v25, v61
 v_mul_f32 v26, v26, v56
 v_cvt_pk_bf16_f32 v25, v25, v26
 v_lshlrev_b32 v26, 16, v25
 v_and_b32 v25, 0xffff0000, v25
 v_add_f32 v151, v151, v26
 v_add_f32 v151, v151, v25
 v_add_f32_dpp v144, v144, v144 row_ror:8 row_mask:0xf bank_mask:0xf
 v_add_f32_dpp v145, v145, v145 row_ror:8 row_mask:0xf bank_mask:0xf
 v_add_f32_dpp v146, v146, v146 row_ror:8 row_mask:0xf bank_mask:0xf
 v_add_f32_dpp v147, v147, v147 row_ror:8 row_mask:0xf bank_mask:0xf
 v_add_f32_dpp v148, v148, v148 row_ror:8 row_mask:0xf bank_mask:0xf
 v_add_f32_dpp v149, v149, v149 row_ror:8 row_mask:0xf bank_mask:0xf
 v_add_f32_dpp v150, v150, v150 row_ror:8 row_mask:0xf bank_mask:0xf
 v_add_f32_dpp v151, v151, v151 row_ror:8 row_mask:0xf bank_mask:0xf
 v_add_f32_dpp v144, v144, v144 row_ror:4 row_mask:0xf bank_mask:0xf
 v_add_f32_dpp v145, v145, v145 row_ror:4 row_mask:0xf bank_mask:0xf
 v_add_f32_dpp v146, v146, v146 row_ror:4 row_mask:0xf bank_mask:0xf
 v_add_f32_dpp v147, v147, v147 row_ror:4 row_mask:0xf bank_mask:0xf
 v_add_f32_dpp v148, v148, v148 row_ror:4 row_mask:0xf bank_mask:0xf
 v_add_f32_dpp v149, v149, v149 row_ror:4 row_mask:0xf bank_mask:0xf
 v_add_f32_dpp v150, v150, v150 row_ror:4 row_mask:0xf bank_mask:0xf
 v_add_f32_dpp v151, v151, v151 row_ror:4 row_mask:0xf bank_mask:0xf
 v_add_f32_dpp v144, v144, v144 row_ror:2 row_mask:0xf bank_mask:0xf
 v_add_f32_dpp v145, v145, v145 row_ror:2 row_mask:0xf bank_mask:0xf
 v_add_f32_dpp v146, v146, v146 row_ror:2 row_mask:0xf bank_mask:0xf
 v_add_f32_dpp v147, v147, v147 row_ror:2 row_mask:0xf bank_mask:0xf
 v_add_f32_dpp v148, v148, v148 row_ror:2 row_mask:0xf bank_mask:0xf
 v_add_f32_dpp v149, v149, v149 row_ror:2 row_mask:0xf bank_mask:0xf
 v_add_f32_dpp v150, v150, v150 row_ror:2 row_mask:0xf bank_mask:0xf
 v_add_f32_dpp v151, v151, v151 row_ror:2 row_mask:0xf bank_mask:0xf
 v_add_f32_dpp v144, v144, v144 row_ror:1 row_mask:0xf bank_mask:0xf
 v_add_f32_dpp v145, v145, v145 row_ror:1 row_mask:0xf bank_mask:0xf
 v_add_f32_dpp v146, v146, v146 row_ror:1 row_mask:0xf bank_mask:0xf
 v_add_f32_dpp v147, v147, v147 row_ror:1 row_mask:0xf bank_mask:0xf
 v_add_f32_dpp v148, v148, v148 row_ror:1 row_mask:0xf bank_mask:0xf
 v_add_f32_dpp v149, v149, v149 row_ror:1 row_mask:0xf bank_mask:0xf
 v_add_f32_dpp v150, v150, v150 row_ror:1 row_mask:0xf bank_mask:0xf
 v_add_f32_dpp v151, v151, v151 row_ror:1 row_mask:0xf bank_mask:0xf
 v_mov_b32 v152, v144
 v_mov_b32 v153, v145
 v_mov_b32 v154, v146
 v_mov_b32 v155, v147
 v_mov_b32 v156, v148
 v_mov_b32 v157, v149
 v_mov_b32 v158, v150
 v_mov_b32 v159, v151
 v_permlane32_swap_b32 v144, v152
 v_permlane32_swap_b32 v145, v153
 v_permlane32_swap_b32 v146, v154
 v_permlane32_swap_b32 v147, v155
 v_permlane32_swap_b32 v148, v156
 v_permlane32_swap_b32 v149, v157
 v_permlane32_swap_b32 v150, v158
 v_permlane32_swap_b32 v151, v159
 v_add_f32 v144, v144, v152
 v_add_f32 v145, v145, v153
 v_add_f32 v146, v146, v154
 v_add_f32 v147, v147, v155
 v_add_f32 v148, v148, v156
 v_add_f32 v149, v149, v157
 v_add_f32 v150, v150, v158
 v_add_f32 v151, v151, v159
 v_mov_b32 v152, v144
 v_mov_b32 v153, v145
 v_mov_b32 v154, v146
 v_mov_b32 v155, v147
 v_mov_b32 v156, v148
 v_mov_b32 v157, v149
 v_mov_b32 v158, v150
 v_mov_b32 v159, v151
 v_permlane16_swap_b32 v144, v152
 v_permlane16_swap_b32 v145, v153
 v_permlane16_swap_b32 v146, v154
 v_permlane16_swap_b32 v147, v155
 v_permlane16_swap_b32 v148, v156
 v_permlane16_swap_b32 v149, v157
 v_permlane16_swap_b32 v150, v158
 v_permlane16_swap_b32 v151, v159
 v_add_f32 v144, v144, v152
 v_add_f32 v145, v145, v153
 v_add_f32 v146, v146, v154
 v_add_f32 v147, v147, v155
 v_add_f32 v148, v148, v156
 v_add_f32 v149, v149, v157
 v_add_f32 v150, v150, v158
 v_add_f32 v151, v151, v159
 v_mov_b32 v24, v144
 v_cmp_eq_u32 vcc, 1, v1
 s_nop 1
 v_cndmask_b32 v24, v24, v145, vcc
 v_cmp_eq_u32 vcc, 2, v1
 s_nop 1
 v_cndmask_b32 v24, v24, v146, vcc
 v_cmp_eq_u32 vcc, 3, v1
 s_nop 1
 v_cndmask_b32 v24, v24, v147, vcc
 v_cmp_eq_u32 vcc, 4, v1
 s_nop 1
 v_cndmask_b32 v24, v24, v148, vcc
 v_cmp_eq_u32 vcc, 5, v1
 s_nop 1
 v_cndmask_b32 v24, v24, v149, vcc
 v_cmp_eq_u32 vcc, 6, v1
 s_nop 1
 v_cndmask_b32 v24, v24, v150, vcc
 v_cmp_eq_u32 vcc, 7, v1
 s_nop 1
 v_cndmask_b32 v24, v24, v151, vcc
 v_cvt_pk_bf16_f32 v25, v24, v24
 v_lshlrev_b32 v24, 16, v25
 v_mul_f32 v24, 0xbfb8aa3b, v24
 v_exp_f32 v24, v24
 s_nop 0
 v_add_f32 v24, 1.0, v24
 v_rcp_f32 v24, v24
 s_nop 0
 v_cvt_pk_bf16_f32 v25, v24, v24
 v_lshlrev_b32 v24, 16, v25
 s_lshl_b32 s21, s59, 2
 s_mov_b64 exec, 0xff
 buffer_store_dword v24, v5, s[28:31], s21 offen sc1
 s_mov_b64 exec, -1
 s_waitcnt vmcnt(0)
 s_barrier
 s_lshr_b32 s21, s2, 2
 s_lshl_b32 s21, s21, 7
 s_add_u32 s21, s21, 92160
 s_cmp_lg_u32 s20, 0
 s_cbranch_scc1 af_234
 v_mov_b32 v10, 0
 v_mov_b32 v11, 1
 s_mov_b64 exec, 1
 buffer_atomic_add v11, v10, s[72:75], s21 offen sc1
 s_mov_b64 exec, -1
 s_nop 1
af_234:
 s_branch om_233
om_232:
 s_load_dwordx2 s[8:9], s[0:1], 88
 s_mov_b32 s51, s21
 s_lshr_b32 s52, s2, 2
 s_lshl_b32 s52, s52, 7
 s_add_u32 s21, s52, 93184
 s_cmp_lg_u32 s20, 0
 s_cbranch_scc1 wf_236
 v_mov_b32 v20, 0
 s_mov_b32 s101, 0
wf_235:
 buffer_load_dword v21, v20, s[72:75], s21 offen sc1
 s_add_u32 s101, s101, 1
 s_cmp_gt_u32 s101, 131072
 s_cbranch_scc1 main_end
 s_waitcnt vmcnt(0)
 v_readfirstlane_b32 s100, v21
 s_cmp_ge_u32 s100, 4
 s_cbranch_scc1 wf_236
 s_sleep 32
 s_branch wf_235
wf_236:
 s_barrier
 s_add_u32 s21, s52, 115712
 s_cmp_lg_u32 s20, 0
 s_cbranch_scc1 wf_238
 v_mov_b32 v20, 0
 s_mov_b32 s101, 0
wf_237:
 buffer_load_dword v21, v20, s[72:75], s21 offen sc1
 s_add_u32 s101, s101, 1
 s_cmp_gt_u32 s101, 131072
 s_cbranch_scc1 main_end
 s_waitcnt vmcnt(0)
 v_readfirstlane_b32 s100, v21
 s_cmp_ge_u32 s100, 32
 s_cbranch_scc1 wf_238
 s_sleep 32
 s_branch wf_237
wf_238:
 s_barrier
 v_lshlrev_b32 v6, 2, v2
 s_lshl_b32 s22, s47, 6
 buffer_load_dword v30, v6, s[28:31], s22 offen sc1
 buffer_load_dword v31, v6, s[28:31], s22 offen offset:64 sc1
 s_add_u32 s22, s51, 0
 buffer_load_dwordx4 v[144:147], v4, s[16:19], s22 offen offset:0 sc1
 buffer_load_dwordx4 v[148:151], v4, s[16:19], s22 offen offset:1024 sc1
 buffer_load_dwordx4 v[152:155], v4, s[16:19], s22 offen offset:2048 sc1
 buffer_load_dwordx4 v[156:159], v4, s[16:19], s22 offen offset:3072 sc1
 s_add_u32 s22, s51, 4096
 buffer_load_dwordx4 v[160:163], v4, s[16:19], s22 offen offset:0 sc1
 buffer_load_dwordx4 v[164:167], v4, s[16:19], s22 offen offset:1024 sc1
 buffer_load_dwordx4 v[168:171], v4, s[16:19], s22 offen offset:2048 sc1
 buffer_load_dwordx4 v[172:175], v4, s[16:19], s22 offen offset:3072 sc1
 s_add_u32 s22, s51, 8192
 buffer_load_dwordx4 v[176:179], v4, s[16:19], s22 offen offset:0 sc1
 buffer_load_dwordx4 v[180:183], v4, s[16:19], s22 offen offset:1024 sc1
 s_add_u32 s22, s51, 40960
 buffer_load_dwordx4 v[184:187], v4, s[16:19], s22 offen offset:0 sc1
 buffer_load_dwordx4 v[188:191], v4, s[16:19], s22 offen offset:1024 sc1
 buffer_load_dwordx4 v[192:195], v4, s[16:19], s22 offen offset:2048 sc1
 buffer_load_dwordx4 v[196:199], v4, s[16:19], s22 offen offset:3072 sc1
 s_add_u32 s22, s51, 45056
 buffer_load_dwordx4 v[200:203], v4, s[16:19], s22 offen offset:0 sc1
 buffer_load_dwordx4 v[204:207], v4, s[16:19], s22 offen offset:1024 sc1
 buffer_load_dwordx4 v[208:211], v4, s[16:19], s22 offen offset:2048 sc1
 buffer_load_dwordx4 v[212:215], v4, s[16:19], s22 offen offset:3072 sc1
 s_add_u32 s22, s51, 49152
 buffer_load_dwordx4 v[216:219], v4, s[16:19], s22 offen offset:0 sc1
 buffer_load_dwordx4 v[220:223], v4, s[16:19], s22 offen offset:1024 sc1
 v_mul_u32_u24 v9, 1280, v2
 v_lshl_add_u32 v9, v3, 3, v9
 s_mul_i32 s22, s47, 20480
 s_add_u32 s22, s22, s45
 s_add_u32 s23, s22, 20480
 s_waitcnt vmcnt(20) lgkmcnt(0)
 v_sub_f32 v32, 1.0, v30
 v_sub_f32 v33, 1.0, v31
 v_cvt_pk_bf16_f32 v26, v32, v33
 v_lshlrev_b32 v32, 16, v26
 v_and_b32 v33, 0xffff0000, v26
 v_cvt_pk_bf16_f32 v26, v64, v65
 v_lshlrev_b32 v64, 16, v26
 v_and_b32 v65, 0xffff0000, v26
 v_mul_f32 v64, v64, v32
 v_mul_f32 v65, v65, v32
 v_cvt_pk_bf16_f32 v26, v64, v65
 v_lshlrev_b32 v64, 16, v26
 v_and_b32 v65, 0xffff0000, v26
 v_cvt_pk_bf16_f32 v26, v66, v67
 v_lshlrev_b32 v66, 16, v26
 v_and_b32 v67, 0xffff0000, v26
 v_mul_f32 v66, v66, v32
 v_mul_f32 v67, v67, v32
 v_cvt_pk_bf16_f32 v26, v66, v67
 v_lshlrev_b32 v66, 16, v26
 v_and_b32 v67, 0xffff0000, v26
 v_cvt_pk_bf16_f32 v26, v68, v69
 v_lshlrev_b32 v68, 16, v26
 v_and_b32 v69, 0xffff0000, v26
 v_mul_f32 v68, v68, v32
 v_mul_f32 v69, v69, v32
 v_cvt_pk_bf16_f32 v26, v68, v69
 v_lshlrev_b32 v68, 16, v26
 v_and_b32 v69, 0xffff0000, v26
 v_cvt_pk_bf16_f32 v26, v70, v71
 v_lshlrev_b32 v70, 16, v26
 v_and_b32 v71, 0xffff0000, v26
 v_mul_f32 v70, v70, v32
 v_mul_f32 v71, v71, v32
 v_cvt_pk_bf16_f32 v26, v70, v71
 v_lshlrev_b32 v70, 16, v26
 v_and_b32 v71, 0xffff0000, v26
 v_cvt_pk_bf16_f32 v26, v72, v73
 v_lshlrev_b32 v72, 16, v26
 v_and_b32 v73, 0xffff0000, v26
 v_mul_f32 v72, v72, v32
 v_mul_f32 v73, v73, v32
 v_cvt_pk_bf16_f32 v26, v72, v73
 v_lshlrev_b32 v72, 16, v26
 v_and_b32 v73, 0xffff0000, v26
 v_cvt_pk_bf16_f32 v26, v74, v75
 v_lshlrev_b32 v74, 16, v26
 v_and_b32 v75, 0xffff0000, v26
 v_mul_f32 v74, v74, v32
 v_mul_f32 v75, v75, v32
 v_cvt_pk_bf16_f32 v26, v74, v75
 v_lshlrev_b32 v74, 16, v26
 v_and_b32 v75, 0xffff0000, v26
 v_cvt_pk_bf16_f32 v26, v76, v77
 v_lshlrev_b32 v76, 16, v26
 v_and_b32 v77, 0xffff0000, v26
 v_mul_f32 v76, v76, v32
 v_mul_f32 v77, v77, v32
 v_cvt_pk_bf16_f32 v26, v76, v77
 v_lshlrev_b32 v76, 16, v26
 v_and_b32 v77, 0xffff0000, v26
 v_cvt_pk_bf16_f32 v26, v78, v79
 v_lshlrev_b32 v78, 16, v26
 v_and_b32 v79, 0xffff0000, v26
 v_mul_f32 v78, v78, v32
 v_mul_f32 v79, v79, v32
 v_cvt_pk_bf16_f32 v26, v78, v79
 v_lshlrev_b32 v78, 16, v26
 v_and_b32 v79, 0xffff0000, v26
 v_cvt_pk_bf16_f32 v26, v80, v81
 v_lshlrev_b32 v80, 16, v26
 v_and_b32 v81, 0xffff0000, v26
 v_mul_f32 v80, v80, v32
 v_mul_f32 v81, v81, v32
 v_cvt_pk_bf16_f32 v26, v80, v81
 v_lshlrev_b32 v80, 16, v26
 v_and_b32 v81, 0xffff0000, v26
 v_cvt_pk_bf16_f32 v26, v82, v83
 v_lshlrev_b32 v82, 16, v26
 v_and_b32 v83, 0xffff0000, v26
 v_mul_f32 v82, v82, v32
 v_mul_f32 v83, v83, v32
 v_cvt_pk_bf16_f32 v26, v82, v83
 v_lshlrev_b32 v82, 16, v26
 v_and_b32 v83, 0xffff0000, v26
 v_cvt_pk_bf16_f32 v26, v84, v85
 v_lshlrev_b32 v84, 16, v26
 v_and_b32 v85, 0xffff0000, v26
 v_mul_f32 v84, v84, v32
 v_mul_f32 v85, v85, v32
 v_cvt_pk_bf16_f32 v26, v84, v85
 v_lshlrev_b32 v84, 16, v26
 v_and_b32 v85, 0xffff0000, v26
 v_cvt_pk_bf16_f32 v26, v86, v87
 v_lshlrev_b32 v86, 16, v26
 v_and_b32 v87, 0xffff0000, v26
 v_mul_f32 v86, v86, v32
 v_mul_f32 v87, v87, v32
 v_cvt_pk_bf16_f32 v26, v86, v87
 v_lshlrev_b32 v86, 16, v26
 v_and_b32 v87, 0xffff0000, v26
 v_cvt_pk_bf16_f32 v26, v88, v89
 v_lshlrev_b32 v88, 16, v26
 v_and_b32 v89, 0xffff0000, v26
 v_mul_f32 v88, v88, v32
 v_mul_f32 v89, v89, v32
 v_cvt_pk_bf16_f32 v26, v88, v89
 v_lshlrev_b32 v88, 16, v26
 v_and_b32 v89, 0xffff0000, v26
 v_cvt_pk_bf16_f32 v26, v90, v91
 v_lshlrev_b32 v90, 16, v26
 v_and_b32 v91, 0xffff0000, v26
 v_mul_f32 v90, v90, v32
 v_mul_f32 v91, v91, v32
 v_cvt_pk_bf16_f32 v26, v90, v91
 v_lshlrev_b32 v90, 16, v26
 v_and_b32 v91, 0xffff0000, v26
 v_cvt_pk_bf16_f32 v26, v92, v93
 v_lshlrev_b32 v92, 16, v26
 v_and_b32 v93, 0xffff0000, v26
 v_mul_f32 v92, v92, v32
 v_mul_f32 v93, v93, v32
 v_cvt_pk_bf16_f32 v26, v92, v93
 v_lshlrev_b32 v92, 16, v26
 v_and_b32 v93, 0xffff0000, v26
 v_cvt_pk_bf16_f32 v26, v94, v95
 v_lshlrev_b32 v94, 16, v26
 v_and_b32 v95, 0xffff0000, v26
 v_mul_f32 v94, v94, v32
 v_mul_f32 v95, v95, v32
 v_cvt_pk_bf16_f32 v26, v94, v95
 v_lshlrev_b32 v94, 16, v26
 v_and_b32 v95, 0xffff0000, v26
 v_cvt_pk_bf16_f32 v26, v96, v97
 v_lshlrev_b32 v96, 16, v26
 v_and_b32 v97, 0xffff0000, v26
 v_mul_f32 v96, v96, v32
 v_mul_f32 v97, v97, v32
 v_cvt_pk_bf16_f32 v26, v96, v97
 v_lshlrev_b32 v96, 16, v26
 v_and_b32 v97, 0xffff0000, v26
 v_cvt_pk_bf16_f32 v26, v98, v99
 v_lshlrev_b32 v98, 16, v26
 v_and_b32 v99, 0xffff0000, v26
 v_mul_f32 v98, v98, v32
 v_mul_f32 v99, v99, v32
 v_cvt_pk_bf16_f32 v26, v98, v99
 v_lshlrev_b32 v98, 16, v26
 v_and_b32 v99, 0xffff0000, v26
 v_cvt_pk_bf16_f32 v26, v100, v101
 v_lshlrev_b32 v100, 16, v26
 v_and_b32 v101, 0xffff0000, v26
 v_mul_f32 v100, v100, v32
 v_mul_f32 v101, v101, v32
 v_cvt_pk_bf16_f32 v26, v100, v101
 v_lshlrev_b32 v100, 16, v26
 v_and_b32 v101, 0xffff0000, v26
 v_cvt_pk_bf16_f32 v26, v102, v103
 v_lshlrev_b32 v102, 16, v26
 v_and_b32 v103, 0xffff0000, v26
 v_mul_f32 v102, v102, v32
 v_mul_f32 v103, v103, v32
 v_cvt_pk_bf16_f32 v26, v102, v103
 v_lshlrev_b32 v102, 16, v26
 v_and_b32 v103, 0xffff0000, v26
 v_cvt_pk_bf16_f32 v26, v104, v105
 v_lshlrev_b32 v104, 16, v26
 v_and_b32 v105, 0xffff0000, v26
 v_mul_f32 v104, v104, v33
 v_mul_f32 v105, v105, v33
 v_cvt_pk_bf16_f32 v26, v104, v105
 v_lshlrev_b32 v104, 16, v26
 v_and_b32 v105, 0xffff0000, v26
 v_cvt_pk_bf16_f32 v26, v106, v107
 v_lshlrev_b32 v106, 16, v26
 v_and_b32 v107, 0xffff0000, v26
 v_mul_f32 v106, v106, v33
 v_mul_f32 v107, v107, v33
 v_cvt_pk_bf16_f32 v26, v106, v107
 v_lshlrev_b32 v106, 16, v26
 v_and_b32 v107, 0xffff0000, v26
 v_cvt_pk_bf16_f32 v26, v108, v109
 v_lshlrev_b32 v108, 16, v26
 v_and_b32 v109, 0xffff0000, v26
 v_mul_f32 v108, v108, v33
 v_mul_f32 v109, v109, v33
 v_cvt_pk_bf16_f32 v26, v108, v109
 v_lshlrev_b32 v108, 16, v26
 v_and_b32 v109, 0xffff0000, v26
 v_cvt_pk_bf16_f32 v26, v110, v111
 v_lshlrev_b32 v110, 16, v26
 v_and_b32 v111, 0xffff0000, v26
 v_mul_f32 v110, v110, v33
 v_mul_f32 v111, v111, v33
 v_cvt_pk_bf16_f32 v26, v110, v111
 v_lshlrev_b32 v110, 16, v26
 v_and_b32 v111, 0xffff0000, v26
 v_cvt_pk_bf16_f32 v26, v112, v113
 v_lshlrev_b32 v112, 16, v26
 v_and_b32 v113, 0xffff0000, v26
 v_mul_f32 v112, v112, v33
 v_mul_f32 v113, v113, v33
 v_cvt_pk_bf16_f32 v26, v112, v113
 v_lshlrev_b32 v112, 16, v26
 v_and_b32 v113, 0xffff0000, v26
 v_cvt_pk_bf16_f32 v26, v114, v115
 v_lshlrev_b32 v114, 16, v26
 v_and_b32 v115, 0xffff0000, v26
 v_mul_f32 v114, v114, v33
 v_mul_f32 v115, v115, v33
 v_cvt_pk_bf16_f32 v26, v114, v115
 v_lshlrev_b32 v114, 16, v26
 v_and_b32 v115, 0xffff0000, v26
 v_cvt_pk_bf16_f32 v26, v116, v117
 v_lshlrev_b32 v116, 16, v26
 v_and_b32 v117, 0xffff0000, v26
 v_mul_f32 v116, v116, v33
 v_mul_f32 v117, v117, v33
 v_cvt_pk_bf16_f32 v26, v116, v117
 v_lshlrev_b32 v116, 16, v26
 v_and_b32 v117, 0xffff0000, v26
 v_cvt_pk_bf16_f32 v26, v118, v119
 v_lshlrev_b32 v118, 16, v26
 v_and_b32 v119, 0xffff0000, v26
 v_mul_f32 v118, v118, v33
 v_mul_f32 v119, v119, v33
 v_cvt_pk_bf16_f32 v26, v118, v119
 v_lshlrev_b32 v118, 16, v26
 v_and_b32 v119, 0xffff0000, v26
 v_cvt_pk_bf16_f32 v26, v120, v121
 v_lshlrev_b32 v120, 16, v26
 v_and_b32 v121, 0xffff0000, v26
 v_mul_f32 v120, v120, v33
 v_mul_f32 v121, v121, v33
 v_cvt_pk_bf16_f32 v26, v120, v121
 v_lshlrev_b32 v120, 16, v26
 v_and_b32 v121, 0xffff0000, v26
 v_cvt_pk_bf16_f32 v26, v122, v123
 v_lshlrev_b32 v122, 16, v26
 v_and_b32 v123, 0xffff0000, v26
 v_mul_f32 v122, v122, v33
 v_mul_f32 v123, v123, v33
 v_cvt_pk_bf16_f32 v26, v122, v123
 v_lshlrev_b32 v122, 16, v26
 v_and_b32 v123, 0xffff0000, v26
 v_cvt_pk_bf16_f32 v26, v124, v125
 v_lshlrev_b32 v124, 16, v26
 v_and_b32 v125, 0xffff0000, v26
 v_mul_f32 v124, v124, v33
 v_mul_f32 v125, v125, v33
 v_cvt_pk_bf16_f32 v26, v124, v125
 v_lshlrev_b32 v124, 16, v26
 v_and_b32 v125, 0xffff0000, v26
 v_cvt_pk_bf16_f32 v26, v126, v127
 v_lshlrev_b32 v126, 16, v26
 v_and_b32 v127, 0xffff0000, v26
 v_mul_f32 v126, v126, v33
 v_mul_f32 v127, v127, v33
 v_cvt_pk_bf16_f32 v26, v126, v127
 v_lshlrev_b32 v126, 16, v26
 v_and_b32 v127, 0xffff0000, v26
 v_cvt_pk_bf16_f32 v26, v128, v129
 v_lshlrev_b32 v128, 16, v26
 v_and_b32 v129, 0xffff0000, v26
 v_mul_f32 v128, v128, v33
 v_mul_f32 v129, v129, v33
 v_cvt_pk_bf16_f32 v26, v128, v129
 v_lshlrev_b32 v128, 16, v26
 v_and_b32 v129, 0xffff0000, v26
 v_cvt_pk_bf16_f32 v26, v130, v131
 v_lshlrev_b32 v130, 16, v26
 v_and_b32 v131, 0xffff0000, v26
 v_mul_f32 v130, v130, v33
 v_mul_f32 v131, v131, v33
 v_cvt_pk_bf16_f32 v26, v130, v131
 v_lshlrev_b32 v130, 16, v26
 v_and_b32 v131, 0xffff0000, v26
 v_cvt_pk_bf16_f32 v26, v132, v133
 v_lshlrev_b32 v132, 16, v26
 v_and_b32 v133, 0xffff0000, v26
 v_mul_f32 v132, v132, v33
 v_mul_f32 v133, v133, v33
 v_cvt_pk_bf16_f32 v26, v132, v133
 v_lshlrev_b32 v132, 16, v26
 v_and_b32 v133, 0xffff0000, v26
 v_cvt_pk_bf16_f32 v26, v134, v135
 v_lshlrev_b32 v134, 16, v26
 v_and_b32 v135, 0xffff0000, v26
 v_mul_f32 v134, v134, v33
 v_mul_f32 v135, v135, v33
 v_cvt_pk_bf16_f32 v26, v134, v135
 v_lshlrev_b32 v134, 16, v26
 v_and_b32 v135, 0xffff0000, v26
 v_cvt_pk_bf16_f32 v26, v136, v137
 v_lshlrev_b32 v136, 16, v26
 v_and_b32 v137, 0xffff0000, v26
 v_mul_f32 v136, v136, v33
 v_mul_f32 v137, v137, v33
 v_cvt_pk_bf16_f32 v26, v136, v137
 v_lshlrev_b32 v136, 16, v26
 v_and_b32 v137, 0xffff0000, v26
 v_cvt_pk_bf16_f32 v26, v138, v139
 v_lshlrev_b32 v138, 16, v26
 v_and_b32 v139, 0xffff0000, v26
 v_mul_f32 v138, v138, v33
 v_mul_f32 v139, v139, v33
 v_cvt_pk_bf16_f32 v26, v138, v139
 v_lshlrev_b32 v138, 16, v26
 v_and_b32 v139, 0xffff0000, v26
 v_cvt_pk_bf16_f32 v26, v140, v141
 v_lshlrev_b32 v140, 16, v26
 v_and_b32 v141, 0xffff0000, v26
 v_mul_f32 v140, v140, v33
 v_mul_f32 v141, v141, v33
 v_cvt_pk_bf16_f32 v26, v140, v141
 v_lshlrev_b32 v140, 16, v26
 v_and_b32 v141, 0xffff0000, v26
 v_cvt_pk_bf16_f32 v26, v142, v143
 v_lshlrev_b32 v142, 16, v26
 v_and_b32 v143, 0xffff0000, v26
 v_mul_f32 v142, v142, v33
 v_mul_f32 v143, v143, v33
 v_cvt_pk_bf16_f32 v26, v142, v143
 v_lshlrev_b32 v142, 16, v26
 v_and_b32 v143, 0xffff0000, v26
 s_waitcnt vmcnt(19)
 v_cvt_pk_bf16_f32 v26, v144, v145
 v_lshlrev_b32 v144, 16, v26
 v_and_b32 v145, 0xffff0000, v26
 v_mul_f32 v144, v144, v30
 v_mul_f32 v145, v145, v30
 v_cvt_pk_bf16_f32 v26, v144, v145
 v_lshlrev_b32 v144, 16, v26
 v_and_b32 v145, 0xffff0000, v26
 v_add_f32 v144, v144, v64
 v_add_f32 v145, v145, v65
 v_cvt_pk_bf16_f32 v64, v144, v145
 v_cvt_pk_bf16_f32 v26, v146, v147
 v_lshlrev_b32 v146, 16, v26
 v_and_b32 v147, 0xffff0000, v26
 v_mul_f32 v146, v146, v30
 v_mul_f32 v147, v147, v30
 v_cvt_pk_bf16_f32 v26, v146, v147
 v_lshlrev_b32 v146, 16, v26
 v_and_b32 v147, 0xffff0000, v26
 v_add_f32 v146, v146, v66
 v_add_f32 v147, v147, v67
 v_cvt_pk_bf16_f32 v65, v146, v147
 buffer_store_dwordx2 v[64:65], v9, s[8:11], s22 offen offset:0
 s_waitcnt vmcnt(19)
 v_cvt_pk_bf16_f32 v26, v148, v149
 v_lshlrev_b32 v148, 16, v26
 v_and_b32 v149, 0xffff0000, v26
 v_mul_f32 v148, v148, v30
 v_mul_f32 v149, v149, v30
 v_cvt_pk_bf16_f32 v26, v148, v149
 v_lshlrev_b32 v148, 16, v26
 v_and_b32 v149, 0xffff0000, v26
 v_add_f32 v148, v148, v68
 v_add_f32 v149, v149, v69
 v_cvt_pk_bf16_f32 v68, v148, v149
 v_cvt_pk_bf16_f32 v26, v150, v151
 v_lshlrev_b32 v150, 16, v26
 v_and_b32 v151, 0xffff0000, v26
 v_mul_f32 v150, v150, v30
 v_mul_f32 v151, v151, v30
 v_cvt_pk_bf16_f32 v26, v150, v151
 v_lshlrev_b32 v150, 16, v26
 v_and_b32 v151, 0xffff0000, v26
 v_add_f32 v150, v150, v70
 v_add_f32 v151, v151, v71
 v_cvt_pk_bf16_f32 v69, v150, v151
 buffer_store_dwordx2 v[68:69], v9, s[8:11], s22 offen offset:32
 s_waitcnt vmcnt(19)
 v_cvt_pk_bf16_f32 v26, v152, v153
 v_lshlrev_b32 v152, 16, v26
 v_and_b32 v153, 0xffff0000, v26
 v_mul_f32 v152, v152, v30
 v_mul_f32 v153, v153, v30
 v_cvt_pk_bf16_f32 v26, v152, v153
 v_lshlrev_b32 v152, 16, v26
 v_and_b32 v153, 0xffff0000, v26
 v_add_f32 v152, v152, v72
 v_add_f32 v153, v153, v73
 v_cvt_pk_bf16_f32 v72, v152, v153
 v_cvt_pk_bf16_f32 v26, v154, v155
 v_lshlrev_b32 v154, 16, v26
 v_and_b32 v155, 0xffff0000, v26
 v_mul_f32 v154, v154, v30
 v_mul_f32 v155, v155, v30
 v_cvt_pk_bf16_f32 v26, v154, v155
 v_lshlrev_b32 v154, 16, v26
 v_and_b32 v155, 0xffff0000, v26
 v_add_f32 v154, v154, v74
 v_add_f32 v155, v155, v75
 v_cvt_pk_bf16_f32 v73, v154, v155
 buffer_store_dwordx2 v[72:73], v9, s[8:11], s22 offen offset:64
 s_waitcnt vmcnt(19)
 v_cvt_pk_bf16_f32 v26, v156, v157
 v_lshlrev_b32 v156, 16, v26
 v_and_b32 v157, 0xffff0000, v26
 v_mul_f32 v156, v156, v30
 v_mul_f32 v157, v157, v30
 v_cvt_pk_bf16_f32 v26, v156, v157
 v_lshlrev_b32 v156, 16, v26
 v_and_b32 v157, 0xffff0000, v26
 v_add_f32 v156, v156, v76
 v_add_f32 v157, v157, v77
 v_cvt_pk_bf16_f32 v76, v156, v157
 v_cvt_pk_bf16_f32 v26, v158, v159
 v_lshlrev_b32 v158, 16, v26
 v_and_b32 v159, 0xffff0000, v26
 v_mul_f32 v158, v158, v30
 v_mul_f32 v159, v159, v30
 v_cvt_pk_bf16_f32 v26, v158, v159
 v_lshlrev_b32 v158, 16, v26
 v_and_b32 v159, 0xffff0000, v26
 v_add_f32 v158, v158, v78
 v_add_f32 v159, v159, v79
 v_cvt_pk_bf16_f32 v77, v158, v159
 buffer_store_dwordx2 v[76:77], v9, s[8:11], s22 offen offset:96
 s_waitcnt vmcnt(19)
 v_cvt_pk_bf16_f32 v26, v160, v161
 v_lshlrev_b32 v160, 16, v26
 v_and_b32 v161, 0xffff0000, v26
 v_mul_f32 v160, v160, v30
 v_mul_f32 v161, v161, v30
 v_cvt_pk_bf16_f32 v26, v160, v161
 v_lshlrev_b32 v160, 16, v26
 v_and_b32 v161, 0xffff0000, v26
 v_add_f32 v160, v160, v80
 v_add_f32 v161, v161, v81
 v_cvt_pk_bf16_f32 v80, v160, v161
 v_cvt_pk_bf16_f32 v26, v162, v163
 v_lshlrev_b32 v162, 16, v26
 v_and_b32 v163, 0xffff0000, v26
 v_mul_f32 v162, v162, v30
 v_mul_f32 v163, v163, v30
 v_cvt_pk_bf16_f32 v26, v162, v163
 v_lshlrev_b32 v162, 16, v26
 v_and_b32 v163, 0xffff0000, v26
 v_add_f32 v162, v162, v82
 v_add_f32 v163, v163, v83
 v_cvt_pk_bf16_f32 v81, v162, v163
 buffer_store_dwordx2 v[80:81], v9, s[8:11], s22 offen offset:128
 s_waitcnt vmcnt(19)
 v_cvt_pk_bf16_f32 v26, v164, v165
 v_lshlrev_b32 v164, 16, v26
 v_and_b32 v165, 0xffff0000, v26
 v_mul_f32 v164, v164, v30
 v_mul_f32 v165, v165, v30
 v_cvt_pk_bf16_f32 v26, v164, v165
 v_lshlrev_b32 v164, 16, v26
 v_and_b32 v165, 0xffff0000, v26
 v_add_f32 v164, v164, v84
 v_add_f32 v165, v165, v85
 v_cvt_pk_bf16_f32 v84, v164, v165
 v_cvt_pk_bf16_f32 v26, v166, v167
 v_lshlrev_b32 v166, 16, v26
 v_and_b32 v167, 0xffff0000, v26
 v_mul_f32 v166, v166, v30
 v_mul_f32 v167, v167, v30
 v_cvt_pk_bf16_f32 v26, v166, v167
 v_lshlrev_b32 v166, 16, v26
 v_and_b32 v167, 0xffff0000, v26
 v_add_f32 v166, v166, v86
 v_add_f32 v167, v167, v87
 v_cvt_pk_bf16_f32 v85, v166, v167
 buffer_store_dwordx2 v[84:85], v9, s[8:11], s22 offen offset:160
 s_waitcnt vmcnt(19)
 v_cvt_pk_bf16_f32 v26, v168, v169
 v_lshlrev_b32 v168, 16, v26
 v_and_b32 v169, 0xffff0000, v26
 v_mul_f32 v168, v168, v30
 v_mul_f32 v169, v169, v30
 v_cvt_pk_bf16_f32 v26, v168, v169
 v_lshlrev_b32 v168, 16, v26
 v_and_b32 v169, 0xffff0000, v26
 v_add_f32 v168, v168, v88
 v_add_f32 v169, v169, v89
 v_cvt_pk_bf16_f32 v88, v168, v169
 v_cvt_pk_bf16_f32 v26, v170, v171
 v_lshlrev_b32 v170, 16, v26
 v_and_b32 v171, 0xffff0000, v26
 v_mul_f32 v170, v170, v30
 v_mul_f32 v171, v171, v30
 v_cvt_pk_bf16_f32 v26, v170, v171
 v_lshlrev_b32 v170, 16, v26
 v_and_b32 v171, 0xffff0000, v26
 v_add_f32 v170, v170, v90
 v_add_f32 v171, v171, v91
 v_cvt_pk_bf16_f32 v89, v170, v171
 buffer_store_dwordx2 v[88:89], v9, s[8:11], s22 offen offset:192
 s_waitcnt vmcnt(19)
 v_cvt_pk_bf16_f32 v26, v172, v173
 v_lshlrev_b32 v172, 16, v26
 v_and_b32 v173, 0xffff0000, v26
 v_mul_f32 v172, v172, v30
 v_mul_f32 v173, v173, v30
 v_cvt_pk_bf16_f32 v26, v172, v173
 v_lshlrev_b32 v172, 16, v26
 v_and_b32 v173, 0xffff0000, v26
 v_add_f32 v172, v172, v92
 v_add_f32 v173, v173, v93
 v_cvt_pk_bf16_f32 v92, v172, v173
 v_cvt_pk_bf16_f32 v26, v174, v175
 v_lshlrev_b32 v174, 16, v26
 v_and_b32 v175, 0xffff0000, v26
 v_mul_f32 v174, v174, v30
 v_mul_f32 v175, v175, v30
 v_cvt_pk_bf16_f32 v26, v174, v175
 v_lshlrev_b32 v174, 16, v26
 v_and_b32 v175, 0xffff0000, v26
 v_add_f32 v174, v174, v94
 v_add_f32 v175, v175, v95
 v_cvt_pk_bf16_f32 v93, v174, v175
 buffer_store_dwordx2 v[92:93], v9, s[8:11], s22 offen offset:224
 s_waitcnt vmcnt(19)
 v_cvt_pk_bf16_f32 v26, v176, v177
 v_lshlrev_b32 v176, 16, v26
 v_and_b32 v177, 0xffff0000, v26
 v_mul_f32 v176, v176, v30
 v_mul_f32 v177, v177, v30
 v_cvt_pk_bf16_f32 v26, v176, v177
 v_lshlrev_b32 v176, 16, v26
 v_and_b32 v177, 0xffff0000, v26
 v_add_f32 v176, v176, v96
 v_add_f32 v177, v177, v97
 v_cvt_pk_bf16_f32 v96, v176, v177
 v_cvt_pk_bf16_f32 v26, v178, v179
 v_lshlrev_b32 v178, 16, v26
 v_and_b32 v179, 0xffff0000, v26
 v_mul_f32 v178, v178, v30
 v_mul_f32 v179, v179, v30
 v_cvt_pk_bf16_f32 v26, v178, v179
 v_lshlrev_b32 v178, 16, v26
 v_and_b32 v179, 0xffff0000, v26
 v_add_f32 v178, v178, v98
 v_add_f32 v179, v179, v99
 v_cvt_pk_bf16_f32 v97, v178, v179
 buffer_store_dwordx2 v[96:97], v9, s[8:11], s22 offen offset:256
 s_waitcnt vmcnt(19)
 v_cvt_pk_bf16_f32 v26, v180, v181
 v_lshlrev_b32 v180, 16, v26
 v_and_b32 v181, 0xffff0000, v26
 v_mul_f32 v180, v180, v30
 v_mul_f32 v181, v181, v30
 v_cvt_pk_bf16_f32 v26, v180, v181
 v_lshlrev_b32 v180, 16, v26
 v_and_b32 v181, 0xffff0000, v26
 v_add_f32 v180, v180, v100
 v_add_f32 v181, v181, v101
 v_cvt_pk_bf16_f32 v100, v180, v181
 v_cvt_pk_bf16_f32 v26, v182, v183
 v_lshlrev_b32 v182, 16, v26
 v_and_b32 v183, 0xffff0000, v26
 v_mul_f32 v182, v182, v30
 v_mul_f32 v183, v183, v30
 v_cvt_pk_bf16_f32 v26, v182, v183
 v_lshlrev_b32 v182, 16, v26
 v_and_b32 v183, 0xffff0000, v26
 v_add_f32 v182, v182, v102
 v_add_f32 v183, v183, v103
 v_cvt_pk_bf16_f32 v101, v182, v183
 buffer_store_dwordx2 v[100:101], v9, s[8:11], s22 offen offset:288
 s_waitcnt vmcnt(19)
 v_cvt_pk_bf16_f32 v26, v184, v185
 v_lshlrev_b32 v184, 16, v26
 v_and_b32 v185, 0xffff0000, v26
 v_mul_f32 v184, v184, v31
 v_mul_f32 v185, v185, v31
 v_cvt_pk_bf16_f32 v26, v184, v185
 v_lshlrev_b32 v184, 16, v26
 v_and_b32 v185, 0xffff0000, v26
 v_add_f32 v184, v184, v104
 v_add_f32 v185, v185, v105
 v_cvt_pk_bf16_f32 v104, v184, v185
 v_cvt_pk_bf16_f32 v26, v186, v187
 v_lshlrev_b32 v186, 16, v26
 v_and_b32 v187, 0xffff0000, v26
 v_mul_f32 v186, v186, v31
 v_mul_f32 v187, v187, v31
 v_cvt_pk_bf16_f32 v26, v186, v187
 v_lshlrev_b32 v186, 16, v26
 v_and_b32 v187, 0xffff0000, v26
 v_add_f32 v186, v186, v106
 v_add_f32 v187, v187, v107
 v_cvt_pk_bf16_f32 v105, v186, v187
 buffer_store_dwordx2 v[104:105], v9, s[8:11], s23 offen offset:0
 s_waitcnt vmcnt(19)
 v_cvt_pk_bf16_f32 v26, v188, v189
 v_lshlrev_b32 v188, 16, v26
 v_and_b32 v189, 0xffff0000, v26
 v_mul_f32 v188, v188, v31
 v_mul_f32 v189, v189, v31
 v_cvt_pk_bf16_f32 v26, v188, v189
 v_lshlrev_b32 v188, 16, v26
 v_and_b32 v189, 0xffff0000, v26
 v_add_f32 v188, v188, v108
 v_add_f32 v189, v189, v109
 v_cvt_pk_bf16_f32 v108, v188, v189
 v_cvt_pk_bf16_f32 v26, v190, v191
 v_lshlrev_b32 v190, 16, v26
 v_and_b32 v191, 0xffff0000, v26
 v_mul_f32 v190, v190, v31
 v_mul_f32 v191, v191, v31
 v_cvt_pk_bf16_f32 v26, v190, v191
 v_lshlrev_b32 v190, 16, v26
 v_and_b32 v191, 0xffff0000, v26
 v_add_f32 v190, v190, v110
 v_add_f32 v191, v191, v111
 v_cvt_pk_bf16_f32 v109, v190, v191
 buffer_store_dwordx2 v[108:109], v9, s[8:11], s23 offen offset:32
 s_waitcnt vmcnt(19)
 v_cvt_pk_bf16_f32 v26, v192, v193
 v_lshlrev_b32 v192, 16, v26
 v_and_b32 v193, 0xffff0000, v26
 v_mul_f32 v192, v192, v31
 v_mul_f32 v193, v193, v31
 v_cvt_pk_bf16_f32 v26, v192, v193
 v_lshlrev_b32 v192, 16, v26
 v_and_b32 v193, 0xffff0000, v26
 v_add_f32 v192, v192, v112
 v_add_f32 v193, v193, v113
 v_cvt_pk_bf16_f32 v112, v192, v193
 v_cvt_pk_bf16_f32 v26, v194, v195
 v_lshlrev_b32 v194, 16, v26
 v_and_b32 v195, 0xffff0000, v26
 v_mul_f32 v194, v194, v31
 v_mul_f32 v195, v195, v31
 v_cvt_pk_bf16_f32 v26, v194, v195
 v_lshlrev_b32 v194, 16, v26
 v_and_b32 v195, 0xffff0000, v26
 v_add_f32 v194, v194, v114
 v_add_f32 v195, v195, v115
 v_cvt_pk_bf16_f32 v113, v194, v195
 buffer_store_dwordx2 v[112:113], v9, s[8:11], s23 offen offset:64
 s_waitcnt vmcnt(19)
 v_cvt_pk_bf16_f32 v26, v196, v197
 v_lshlrev_b32 v196, 16, v26
 v_and_b32 v197, 0xffff0000, v26
 v_mul_f32 v196, v196, v31
 v_mul_f32 v197, v197, v31
 v_cvt_pk_bf16_f32 v26, v196, v197
 v_lshlrev_b32 v196, 16, v26
 v_and_b32 v197, 0xffff0000, v26
 v_add_f32 v196, v196, v116
 v_add_f32 v197, v197, v117
 v_cvt_pk_bf16_f32 v116, v196, v197
 v_cvt_pk_bf16_f32 v26, v198, v199
 v_lshlrev_b32 v198, 16, v26
 v_and_b32 v199, 0xffff0000, v26
 v_mul_f32 v198, v198, v31
 v_mul_f32 v199, v199, v31
 v_cvt_pk_bf16_f32 v26, v198, v199
 v_lshlrev_b32 v198, 16, v26
 v_and_b32 v199, 0xffff0000, v26
 v_add_f32 v198, v198, v118
 v_add_f32 v199, v199, v119
 v_cvt_pk_bf16_f32 v117, v198, v199
 buffer_store_dwordx2 v[116:117], v9, s[8:11], s23 offen offset:96
 s_waitcnt vmcnt(19)
 v_cvt_pk_bf16_f32 v26, v200, v201
 v_lshlrev_b32 v200, 16, v26
 v_and_b32 v201, 0xffff0000, v26
 v_mul_f32 v200, v200, v31
 v_mul_f32 v201, v201, v31
 v_cvt_pk_bf16_f32 v26, v200, v201
 v_lshlrev_b32 v200, 16, v26
 v_and_b32 v201, 0xffff0000, v26
 v_add_f32 v200, v200, v120
 v_add_f32 v201, v201, v121
 v_cvt_pk_bf16_f32 v120, v200, v201
 v_cvt_pk_bf16_f32 v26, v202, v203
 v_lshlrev_b32 v202, 16, v26
 v_and_b32 v203, 0xffff0000, v26
 v_mul_f32 v202, v202, v31
 v_mul_f32 v203, v203, v31
 v_cvt_pk_bf16_f32 v26, v202, v203
 v_lshlrev_b32 v202, 16, v26
 v_and_b32 v203, 0xffff0000, v26
 v_add_f32 v202, v202, v122
 v_add_f32 v203, v203, v123
 v_cvt_pk_bf16_f32 v121, v202, v203
 buffer_store_dwordx2 v[120:121], v9, s[8:11], s23 offen offset:128
 s_waitcnt vmcnt(19)
 v_cvt_pk_bf16_f32 v26, v204, v205
 v_lshlrev_b32 v204, 16, v26
 v_and_b32 v205, 0xffff0000, v26
 v_mul_f32 v204, v204, v31
 v_mul_f32 v205, v205, v31
 v_cvt_pk_bf16_f32 v26, v204, v205
 v_lshlrev_b32 v204, 16, v26
 v_and_b32 v205, 0xffff0000, v26
 v_add_f32 v204, v204, v124
 v_add_f32 v205, v205, v125
 v_cvt_pk_bf16_f32 v124, v204, v205
 v_cvt_pk_bf16_f32 v26, v206, v207
 v_lshlrev_b32 v206, 16, v26
 v_and_b32 v207, 0xffff0000, v26
 v_mul_f32 v206, v206, v31
 v_mul_f32 v207, v207, v31
 v_cvt_pk_bf16_f32 v26, v206, v207
 v_lshlrev_b32 v206, 16, v26
 v_and_b32 v207, 0xffff0000, v26
 v_add_f32 v206, v206, v126
 v_add_f32 v207, v207, v127
 v_cvt_pk_bf16_f32 v125, v206, v207
 buffer_store_dwordx2 v[124:125], v9, s[8:11], s23 offen offset:160
 s_waitcnt vmcnt(19)
 v_cvt_pk_bf16_f32 v26, v208, v209
 v_lshlrev_b32 v208, 16, v26
 v_and_b32 v209, 0xffff0000, v26
 v_mul_f32 v208, v208, v31
 v_mul_f32 v209, v209, v31
 v_cvt_pk_bf16_f32 v26, v208, v209
 v_lshlrev_b32 v208, 16, v26
 v_and_b32 v209, 0xffff0000, v26
 v_add_f32 v208, v208, v128
 v_add_f32 v209, v209, v129
 v_cvt_pk_bf16_f32 v128, v208, v209
 v_cvt_pk_bf16_f32 v26, v210, v211
 v_lshlrev_b32 v210, 16, v26
 v_and_b32 v211, 0xffff0000, v26
 v_mul_f32 v210, v210, v31
 v_mul_f32 v211, v211, v31
 v_cvt_pk_bf16_f32 v26, v210, v211
 v_lshlrev_b32 v210, 16, v26
 v_and_b32 v211, 0xffff0000, v26
 v_add_f32 v210, v210, v130
 v_add_f32 v211, v211, v131
 v_cvt_pk_bf16_f32 v129, v210, v211
 buffer_store_dwordx2 v[128:129], v9, s[8:11], s23 offen offset:192
 s_waitcnt vmcnt(19)
 v_cvt_pk_bf16_f32 v26, v212, v213
 v_lshlrev_b32 v212, 16, v26
 v_and_b32 v213, 0xffff0000, v26
 v_mul_f32 v212, v212, v31
 v_mul_f32 v213, v213, v31
 v_cvt_pk_bf16_f32 v26, v212, v213
 v_lshlrev_b32 v212, 16, v26
 v_and_b32 v213, 0xffff0000, v26
 v_add_f32 v212, v212, v132
 v_add_f32 v213, v213, v133
 v_cvt_pk_bf16_f32 v132, v212, v213
 v_cvt_pk_bf16_f32 v26, v214, v215
 v_lshlrev_b32 v214, 16, v26
 v_and_b32 v215, 0xffff0000, v26
 v_mul_f32 v214, v214, v31
 v_mul_f32 v215, v215, v31
 v_cvt_pk_bf16_f32 v26, v214, v215
 v_lshlrev_b32 v214, 16, v26
 v_and_b32 v215, 0xffff0000, v26
 v_add_f32 v214, v214, v134
 v_add_f32 v215, v215, v135
 v_cvt_pk_bf16_f32 v133, v214, v215
 buffer_store_dwordx2 v[132:133], v9, s[8:11], s23 offen offset:224
 s_waitcnt vmcnt(19)
 v_cvt_pk_bf16_f32 v26, v216, v217
 v_lshlrev_b32 v216, 16, v26
 v_and_b32 v217, 0xffff0000, v26
 v_mul_f32 v216, v216, v31
 v_mul_f32 v217, v217, v31
 v_cvt_pk_bf16_f32 v26, v216, v217
 v_lshlrev_b32 v216, 16, v26
 v_and_b32 v217, 0xffff0000, v26
 v_add_f32 v216, v216, v136
 v_add_f32 v217, v217, v137
 v_cvt_pk_bf16_f32 v136, v216, v217
 v_cvt_pk_bf16_f32 v26, v218, v219
 v_lshlrev_b32 v218, 16, v26
 v_and_b32 v219, 0xffff0000, v26
 v_mul_f32 v218, v218, v31
 v_mul_f32 v219, v219, v31
 v_cvt_pk_bf16_f32 v26, v218, v219
 v_lshlrev_b32 v218, 16, v26
 v_and_b32 v219, 0xffff0000, v26
 v_add_f32 v218, v218, v138
 v_add_f32 v219, v219, v139
 v_cvt_pk_bf16_f32 v137, v218, v219
 buffer_store_dwordx2 v[136:137], v9, s[8:11], s23 offen offset:256
 s_waitcnt vmcnt(19)
 v_cvt_pk_bf16_f32 v26, v220, v221
 v_lshlrev_b32 v220, 16, v26
 v_and_b32 v221, 0xffff0000, v26
 v_mul_f32 v220, v220, v31
 v_mul_f32 v221, v221, v31
 v_cvt_pk_bf16_f32 v26, v220, v221
 v_lshlrev_b32 v220, 16, v26
 v_and_b32 v221, 0xffff0000, v26
 v_add_f32 v220, v220, v140
 v_add_f32 v221, v221, v141
 v_cvt_pk_bf16_f32 v140, v220, v221
 v_cvt_pk_bf16_f32 v26, v222, v223
 v_lshlrev_b32 v222, 16, v26
 v_and_b32 v223, 0xffff0000, v26
 v_mul_f32 v222, v222, v31
 v_mul_f32 v223, v223, v31
 v_cvt_pk_bf16_f32 v26, v222, v223
 v_lshlrev_b32 v222, 16, v26
 v_and_b32 v223, 0xffff0000, v26
 v_add_f32 v222, v222, v142
 v_add_f32 v223, v223, v143
 v_cvt_pk_bf16_f32 v141, v222, v223
 buffer_store_dwordx2 v[140:141], v9, s[8:11], s23 offen offset:288
om_233:
 s_cmp_eq_u32 s87, -2
 s_cbranch_scc1 kv_help
 s_cmp_eq_u32 s87, -1
 s_cbranch_scc1 queue
tail_item:
 s_load_dwordx2 s[4:5], s[0:1], 96
 s_waitcnt lgkmcnt(0)
 s_mov_b32 s32, s4
 s_mov_b32 s33, s5
 s_mov_b32 s34, 256
 s_mov_b32 s35, 0x00020000
 s_waitcnt vmcnt(0)
 s_barrier
 s_mov_b32 s21, s87
do_pv:
 s_mov_b32 s2, s21
 s_load_dwordx2 s[4:5], s[0:1], 88
 s_load_dwordx2 s[38:39], s[0:1], 104
 s_waitcnt lgkmcnt(0)
 s_mov_b32 s8, s4
 s_mov_b32 s9, s5
 s_mov_b32 s10, 2621440
 s_mov_b32 s11, 0x00020000
 s_add_u32 s12, s38, 122683392
 s_addc_u32 s13, s39, 0
 s_mov_b32 s14, 83886080
 s_mov_b32 s15, 0x00020000
 s_mov_b32 s59, 0
 s_mov_b32 s60, 0
 s_add_u32 s16, s38, 85983232
 s_addc_u32 s17, s39, 0
 s_mov_b32 s18, 36700160
 s_mov_b32 s19, 0x00020000
 s_add_u32 s24, s38, 73400320
 s_addc_u32 s25, s39, 0
 s_mov_b32 s26, 5242880
 s_mov_b32 s27, 0x00020000
 s_add_u32 s28, s38, 81002496
 s_addc_u32 s29, s39, 0
 s_mov_b32 s30, 8192
 s_mov_b32 s31, 0x00020000
 s_add_u32 s72, s38, 81068032
 s_addc_u32 s73, s39, 0
 s_mov_b32 s74, 128000
 s_mov_b32 s75, 0x00020000
 v_lshlrev_b32 v4, 4, v1
 v_lshlrev_b32 v5, 3, v1
 v_lshlrev_b32 v6, 2, v2
 v_and_b32 v7, 7, v1
 v_lshlrev_b32 v7, 7, v7
 v_lshrrev_b32 v31, 3, v1
 v_lshl_add_u32 v208, v31, 10, v7
 v_bfe_u32 v31, v1, 3, 2
 v_lshl_add_u32 v31, v31, 12, v7
 s_lshl_b32 s21, s20, 10
 s_add_u32 s21, s21, 94208
 buffer_load_dword v8, v31, s[72:75], s21 offen sc1
 v_lshlrev_b32 v25, 7, v2
 s_mov_b32 s21, 92160
 buffer_load_dword v26, v25, s[72:75], s21 offen sc1
 s_mov_b32 s63, 1
 v_mul_u32_u24 v9, 1280, v2
 v_lshl_add_u32 v9, v3, 3, v9
 s_lshl_b32 s21, s20, 13
 v_add_u32 v10, s21, v4
 s_lshl_b32 s21, s20, 10
 v_add_u32 v11, s21, v4
 v_lshrrev_b32 v20, 5, v1
 v_mul_u32_u24 v21, 2560, v20
 v_add_u32 v21, v21, v4
 v_and_b32 v22, 31, v1
 v_lshlrev_b32 v22, 4, v22
 v_mul_u32_u24 v20, 10240, v20
 v_add_u32 v22, v22, v20
 v_mul_u32_u24 v21, 2560, v3
 v_lshl_add_u32 v21, v2, 4, v21
 v_mul_u32_u24 v22, 10240, v3
 v_lshl_add_u32 v22, v2, 4, v22
 v_mov_b32 v28, 80
 v_mov_b32 v30, 32768
 s_mov_b32 s50, 0
 s_mov_b32 s71, 0
 s_mov_b32 s51, 0
 s_and_b32 s43, s20, 1
 s_lshr_b32 s44, s20, 1
 v_mov_b32 v70, 0
 v_mov_b32 v71, 0
 v_mov_b32 v78, 0
 v_mov_b32 v79, 0
 v_mov_b32 v86, 0
 v_mov_b32 v87, 0
 v_mov_b32 v94, 0
 v_mov_b32 v95, 0
 v_mov_b32 v102, 0
 v_mov_b32 v103, 0
 v_mov_b32 v110, 0
 v_mov_b32 v111, 0
 v_mov_b32 v118, 0
 v_mov_b32 v119, 0
 v_mov_b32 v126, 0
 v_mov_b32 v127, 0
 s_mov_b32 s21, s2
pv_loop:
 s_mul_i32 s2, s21, 2
 s_add_u32 s2, s2, 192
 s_add_u32 s22, s21, 356
 s_cmp_lt_u32 s21, 164
 s_cselect_b32 s2, s2, s22
 s_cselect_b32 s65, 1, 0
 s_mul_i32 s22, s21, 5
 s_cmp_lt_u32 s21, 64
 s_cselect_b32 s2, s22, s2
 s_cselect_b32 s65, 4, s65
 s_mul_hi_u32 s40, s2, 0x1999999a
 s_mul_i32 s21, s40, 10
 s_sub_u32 s41, s2, s21
 s_lshl_b32 s52, s40, 10
 s_add_u32 s52, s52, 22528
 buffer_load_dword v27, v7, s[72:75], s52 offen sc1
 s_cmp_lg_u32 s20, 0
 s_cbranch_scc1 pv_247
 s_sub_u32 s21, s2, 0
 s_cmp_lt_u32 s21, 640
 s_cbranch_scc1 pv_247
 v_mov_b32 v29, 1
 s_mov_b64 exec, 1
 buffer_atomic_add v29, v28, s[32:35], 0 offen sc0 sc1
 s_mov_b64 exec, -1
pv_247:
 s_lshl_b32 s42, s40, 5
 s_lshl_b32 s21, s20, 3
 s_add_u32 s42, s42, s21
 s_mul_i32 s61, s21, 5
 s_lshr_b32 s22, s41, 1
 s_add_u32 s61, s61, s22
 s_and_b32 s62, s41, 1
 s_lshl_b32 s62, s62, 12
 s_mul_i32 s53, s42, 40960
 s_lshl_b32 s22, s41, 12
 s_add_u32 s53, s53, s22
 s_lshl_b32 s21, s40, 1
 s_add_u32 s21, s21, s43
 s_lshl_b32 s45, s21, 6
 s_mul_i32 s46, s21, 20480
 s_mul_i32 s21, s21, 40
 s_lshl_b32 s22, s41, 2
 s_add_u32 s22, s22, s44
 s_add_u32 s21, s21, s22
 s_lshl_b32 s54, s21, 10
 s_lshl_b32 s22, s22, 5
 s_add_u32 s46, s46, s22
 s_mul_i32 s47, s42, 2560
 s_mul_i32 s48, s42, 10240
 s_lshl_b32 s22, s41, 10
 s_add_u32 s48, s48, s22
 s_add_u32 s48, s48, 15728640
 s_add_u32 s23, s40, 1
 s_cmp_ge_u32 s50, s23
 s_cbranch_scc1 pv_240
 s_cmp_eq_u32 s63, 0
 s_cbranch_scc1 pv_243
 s_mov_b32 s63, 0
 s_waitcnt vmcnt(1)
 v_cmp_le_u32 vcc, 4, v26
 s_mov_b32 s51, vcc_lo
 v_cmp_gt_u32 vcc, s23, v8
 s_nop 1
 s_cbranch_vccz pv_244
pv_243:
 s_lshl_b32 s21, s20, 10
 s_add_u32 s21, s21, 94208
 s_mov_b32 s101, 0
wm_248:
 buffer_load_dword v8, v31, s[72:75], s21 offen sc1
 s_add_u32 s101, s101, 1
 s_cmp_gt_u32 s101, 131072
 s_cbranch_scc1 main_end
 s_waitcnt vmcnt(0)
 v_cmp_gt_u32 vcc, s23, v8
 v_readfirstlane_b32 s100, v8
 s_nop 0
 s_cbranch_vccz wm_249
 s_sleep 8
 s_add_u32 s100, s100, 2
 s_cmp_ge_u32 s100, s23
 s_cbranch_scc1 wm_248
 s_sleep 60
 s_branch wm_248
wm_249:
pv_244:
 v_readlane_b32 s50, v8, 0
 v_readlane_b32 s21, v8, 1
 s_min_u32 s50, s50, s21
 v_readlane_b32 s21, v8, 2
 s_min_u32 s50, s50, s21
 v_readlane_b32 s21, v8, 3
 s_min_u32 s50, s50, s21
 v_readlane_b32 s21, v8, 4
 s_min_u32 s50, s50, s21
 v_readlane_b32 s21, v8, 5
 s_min_u32 s50, s50, s21
 v_readlane_b32 s21, v8, 6
 s_min_u32 s50, s50, s21
 v_readlane_b32 s21, v8, 7
 s_min_u32 s50, s50, s21
 v_readlane_b32 s21, v8, 8
 s_min_u32 s50, s50, s21
 v_readlane_b32 s21, v8, 9
 s_min_u32 s50, s50, s21
 v_readlane_b32 s21, v8, 10
 s_min_u32 s50, s50, s21
 v_readlane_b32 s21, v8, 11
 s_min_u32 s50, s50, s21
 v_readlane_b32 s21, v8, 12
 s_min_u32 s50, s50, s21
 v_readlane_b32 s21, v8, 13
 s_min_u32 s50, s50, s21
 v_readlane_b32 s21, v8, 14
 s_min_u32 s50, s50, s21
 v_readlane_b32 s21, v8, 15
 s_min_u32 s50, s50, s21
 v_readlane_b32 s21, v8, 16
 s_min_u32 s50, s50, s21
 v_readlane_b32 s21, v8, 17
 s_min_u32 s50, s50, s21
 v_readlane_b32 s21, v8, 18
 s_min_u32 s50, s50, s21
 v_readlane_b32 s21, v8, 19
 s_min_u32 s50, s50, s21
 v_readlane_b32 s21, v8, 20
 s_min_u32 s50, s50, s21
 v_readlane_b32 s21, v8, 21
 s_min_u32 s50, s50, s21
 v_readlane_b32 s21, v8, 22
 s_min_u32 s50, s50, s21
 v_readlane_b32 s21, v8, 23
 s_min_u32 s50, s50, s21
 v_readlane_b32 s21, v8, 24
 s_min_u32 s50, s50, s21
 v_readlane_b32 s21, v8, 25
 s_min_u32 s50, s50, s21
 v_readlane_b32 s21, v8, 26
 s_min_u32 s50, s50, s21
 v_readlane_b32 s21, v8, 27
 s_min_u32 s50, s50, s21
 v_readlane_b32 s21, v8, 28
 s_min_u32 s50, s50, s21
 v_readlane_b32 s21, v8, 29
 s_min_u32 s50, s50, s21
 v_readlane_b32 s21, v8, 30
 s_min_u32 s50, s50, s21
 v_readlane_b32 s21, v8, 31
 s_min_u32 s50, s50, s21
pv_240:
 s_lshr_b32 s22, s40, 2
 s_cmp_lt_u32 s40, 32
 s_cbranch_scc1 pv_241
 s_bitcmp1_b32 s51, s22
 s_cbranch_scc1 pv_241
 s_mov_b32 s21, 92160
 v_lshlrev_b32 v25, 7, v2
 s_mov_b32 s101, 0
pv_242:
 buffer_load_dword v26, v25, s[72:75], s21 offen sc1
 s_add_u32 s101, s101, 1
 s_cmp_gt_u32 s101, 131072
 s_cbranch_scc1 main_end
 s_waitcnt vmcnt(0)
 v_cmp_le_u32 vcc, 4, v26
 s_mov_b32 s51, vcc_lo
 s_bitcmp1_b32 s51, s22
 s_cbranch_scc1 pv_241
 s_sleep 8
 s_branch pv_242
pv_241:
 buffer_load_dwordx4 a[0:3], v4, s[12:15], s53 offen offset:0 sc1
 buffer_load_dwordx4 a[4:7], v4, s[12:15], s53 offen offset:1024 sc1
 buffer_load_dwordx4 a[8:11], v4, s[12:15], s53 offen offset:2048 sc1
 buffer_load_dwordx4 a[12:15], v4, s[12:15], s53 offen offset:3072 sc1
 s_add_u32 s53, s53, 40960
 buffer_load_dwordx4 a[16:19], v4, s[12:15], s53 offen offset:0 sc1
 buffer_load_dwordx4 a[20:23], v4, s[12:15], s53 offen offset:1024 sc1
 buffer_load_dwordx4 a[24:27], v4, s[12:15], s53 offen offset:2048 sc1
 buffer_load_dwordx4 a[28:31], v4, s[12:15], s53 offen offset:3072 sc1
 s_add_u32 s53, s53, 40960
 buffer_load_dwordx4 a[32:35], v4, s[12:15], s53 offen offset:0 sc1
 buffer_load_dwordx4 a[36:39], v4, s[12:15], s53 offen offset:1024 sc1
 buffer_load_dwordx4 a[40:43], v4, s[12:15], s53 offen offset:2048 sc1
 buffer_load_dwordx4 a[44:47], v4, s[12:15], s53 offen offset:3072 sc1
 s_add_u32 s53, s53, 40960
 buffer_load_dwordx4 a[48:51], v4, s[12:15], s53 offen offset:0 sc1
 buffer_load_dwordx4 a[52:55], v4, s[12:15], s53 offen offset:1024 sc1
 buffer_load_dwordx4 a[56:59], v4, s[12:15], s53 offen offset:2048 sc1
 buffer_load_dwordx4 a[60:63], v4, s[12:15], s53 offen offset:3072 sc1
 s_add_u32 s53, s53, 40960
 buffer_load_dwordx4 a[64:67], v4, s[12:15], s53 offen offset:0 sc1
 buffer_load_dwordx4 a[68:71], v4, s[12:15], s53 offen offset:1024 sc1
 buffer_load_dwordx4 a[72:75], v4, s[12:15], s53 offen offset:2048 sc1
 buffer_load_dwordx4 a[76:79], v4, s[12:15], s53 offen offset:3072 sc1
 s_add_u32 s53, s53, 40960
 buffer_load_dwordx4 a[80:83], v4, s[12:15], s53 offen offset:0 sc1
 buffer_load_dwordx4 a[84:87], v4, s[12:15], s53 offen offset:1024 sc1
 buffer_load_dwordx4 a[88:91], v4, s[12:15], s53 offen offset:2048 sc1
 buffer_load_dwordx4 a[92:95], v4, s[12:15], s53 offen offset:3072 sc1
 s_add_u32 s53, s53, 40960
 buffer_load_dwordx4 a[96:99], v4, s[12:15], s53 offen offset:0 sc1
 buffer_load_dwordx4 a[100:103], v4, s[12:15], s53 offen offset:1024 sc1
 buffer_load_dwordx4 a[104:107], v4, s[12:15], s53 offen offset:2048 sc1
 buffer_load_dwordx4 a[108:111], v4, s[12:15], s53 offen offset:3072 sc1
 s_add_u32 s53, s53, 40960
 buffer_load_dwordx4 a[112:115], v4, s[12:15], s53 offen offset:0 sc1
 buffer_load_dwordx4 a[116:119], v4, s[12:15], s53 offen offset:1024 sc1
 buffer_load_dwordx4 a[120:123], v4, s[12:15], s53 offen offset:2048 sc1
 buffer_load_dwordx4 a[124:127], v4, s[12:15], s53 offen offset:3072 sc1
 s_cmp_lt_u32 s40, 32
 s_cselect_b32 s70, 0x80000000, s54
 buffer_load_dwordx4 v[12:15], v4, s[24:27], s70 offen sc1
 buffer_load_dwordx4 v[16:19], v4, s[24:27], s70 offen offset:2048 sc1
 buffer_load_dword v24, v6, s[28:31], s45 offen sc1
 s_waitcnt vmcnt(35)
 s_cmp_eq_u32 s71, 0
 s_cbranch_scc1 paf_252
 v_mov_b32 v25, 0
 v_mov_b32 v26, 1
 s_mov_b64 exec, 1
 buffer_atomic_add v26, v25, s[72:75], s71 offen sc1
 s_mov_b64 exec, -1
 s_mov_b32 s71, 0
paf_252:
 v_cmp_le_u32 s[68:69], 4, v27
 s_nop 1
 s_and_b32 s21, s68, 255
 s_cmp_lg_u32 s21, 255
 s_cbranch_scc1 pvw_245
 s_mov_b32 s56, s47
 s_mov_b32 s57, s48
 buffer_load_dwordx4 v[64:67], v4, s[16:19], s56 offen sc1
 buffer_load_dwordx2 v[68:69], v5, s[16:19], s56 offen offset:2048 sc1
 buffer_load_dwordx4 v[128:131], v21, s[16:19], s56 offen offset:1024 sc1
 buffer_load_dwordx4 v[132:135], v21, s[16:19], s56 offen offset:1280 sc1
 s_add_u32 s56, s56, 2560
 buffer_load_dwordx4 v[72:75], v4, s[16:19], s56 offen sc1
 buffer_load_dwordx2 v[76:77], v5, s[16:19], s56 offen offset:2048 sc1
 s_add_u32 s56, s56, 2560
 buffer_load_dwordx4 v[80:83], v4, s[16:19], s56 offen sc1
 buffer_load_dwordx2 v[84:85], v5, s[16:19], s56 offen offset:2048 sc1
 s_add_u32 s56, s56, 2560
 buffer_load_dwordx4 v[88:91], v4, s[16:19], s56 offen sc1
 buffer_load_dwordx2 v[92:93], v5, s[16:19], s56 offen offset:2048 sc1
 s_add_u32 s56, s56, 2560
 buffer_load_dwordx4 v[32:35], v22, s[16:19], s57 offen offset:0 sc1
 buffer_load_dwordx4 v[36:39], v22, s[16:19], s57 offen offset:256 sc1
 buffer_load_dwordx4 v[40:43], v22, s[16:19], s57 offen offset:512 sc1
 buffer_load_dwordx4 v[44:47], v22, s[16:19], s57 offen offset:768 sc1
 s_add_u32 s57, s57, 40960
 buffer_load_dwordx4 v[96:99], v4, s[16:19], s56 offen sc1
 buffer_load_dwordx2 v[100:101], v5, s[16:19], s56 offen offset:2048 sc1
 buffer_load_dwordx4 v[136:139], v21, s[16:19], s56 offen offset:1024 sc1
 buffer_load_dwordx4 v[140:143], v21, s[16:19], s56 offen offset:1280 sc1
 s_add_u32 s56, s56, 2560
 buffer_load_dwordx4 v[104:107], v4, s[16:19], s56 offen sc1
 buffer_load_dwordx2 v[108:109], v5, s[16:19], s56 offen offset:2048 sc1
 s_add_u32 s56, s56, 2560
 buffer_load_dwordx4 v[112:115], v4, s[16:19], s56 offen sc1
 buffer_load_dwordx2 v[116:117], v5, s[16:19], s56 offen offset:2048 sc1
 s_add_u32 s56, s56, 2560
 buffer_load_dwordx4 v[120:123], v4, s[16:19], s56 offen sc1
 buffer_load_dwordx2 v[124:125], v5, s[16:19], s56 offen offset:2048 sc1
 s_add_u32 s56, s56, 2560
 buffer_load_dwordx4 v[48:51], v22, s[16:19], s57 offen offset:0 sc1
 buffer_load_dwordx4 v[52:55], v22, s[16:19], s57 offen offset:256 sc1
 buffer_load_dwordx4 v[56:59], v22, s[16:19], s57 offen offset:512 sc1
 buffer_load_dwordx4 v[60:63], v22, s[16:19], s57 offen offset:768 sc1
 s_add_u32 s57, s57, 40960
 s_barrier
 s_waitcnt vmcnt(28)
 v_sub_f32 v25, 1.0, v24
 v_cvt_pk_bf16_f32 v26, v25, v25
 v_lshlrev_b32 v25, 16, v26
 v_cvt_pk_bf16_f32 v26, v12, v12
 v_lshlrev_b32 v12, 16, v26
 v_cvt_pk_bf16_f32 v26, v13, v13
 v_lshlrev_b32 v13, 16, v26
 v_cvt_pk_bf16_f32 v26, v14, v14
 v_lshlrev_b32 v14, 16, v26
 v_cvt_pk_bf16_f32 v26, v15, v15
 v_lshlrev_b32 v15, 16, v26
 v_cvt_pk_bf16_f32 v26, v16, v16
 v_lshlrev_b32 v16, 16, v26
 v_cvt_pk_bf16_f32 v26, v17, v17
 v_lshlrev_b32 v17, 16, v26
 v_cvt_pk_bf16_f32 v26, v18, v18
 v_lshlrev_b32 v18, 16, v26
 v_cvt_pk_bf16_f32 v26, v19, v19
 v_lshlrev_b32 v19, 16, v26
 v_mul_f32 v12, v12, v25
 v_cvt_pk_bf16_f32 v26, v12, v12
 v_lshlrev_b32 v12, 16, v26
 v_mul_f32 v13, v13, v25
 v_cvt_pk_bf16_f32 v26, v13, v13
 v_lshlrev_b32 v13, 16, v26
 v_mul_f32 v14, v14, v25
 v_cvt_pk_bf16_f32 v26, v14, v14
 v_lshlrev_b32 v14, 16, v26
 v_mul_f32 v15, v15, v25
 v_cvt_pk_bf16_f32 v26, v15, v15
 v_lshlrev_b32 v15, 16, v26
 v_mul_f32 v16, v16, v25
 v_cvt_pk_bf16_f32 v26, v16, v16
 v_lshlrev_b32 v16, 16, v26
 v_mul_f32 v17, v17, v25
 v_cvt_pk_bf16_f32 v26, v17, v17
 v_lshlrev_b32 v17, 16, v26
 v_mul_f32 v18, v18, v25
 v_cvt_pk_bf16_f32 v26, v18, v18
 v_lshlrev_b32 v18, 16, v26
 v_mul_f32 v19, v19, v25
 v_cvt_pk_bf16_f32 v26, v19, v19
 v_lshlrev_b32 v19, 16, v26
 s_cmp_ge_u32 s40, 52
 s_cbranch_scc1 pvc_251
 s_branch pvg_250
pvw_245:
 s_waitcnt vmcnt(0)
 v_sub_f32 v25, 1.0, v24
 v_cvt_pk_bf16_f32 v26, v25, v25
 v_lshlrev_b32 v25, 16, v26
 v_cvt_pk_bf16_f32 v26, v12, v12
 v_lshlrev_b32 v12, 16, v26
 v_cvt_pk_bf16_f32 v26, v13, v13
 v_lshlrev_b32 v13, 16, v26
 v_cvt_pk_bf16_f32 v26, v14, v14
 v_lshlrev_b32 v14, 16, v26
 v_cvt_pk_bf16_f32 v26, v15, v15
 v_lshlrev_b32 v15, 16, v26
 v_cvt_pk_bf16_f32 v26, v16, v16
 v_lshlrev_b32 v16, 16, v26
 v_cvt_pk_bf16_f32 v26, v17, v17
 v_lshlrev_b32 v17, 16, v26
 v_cvt_pk_bf16_f32 v26, v18, v18
 v_lshlrev_b32 v18, 16, v26
 v_cvt_pk_bf16_f32 v26, v19, v19
 v_lshlrev_b32 v19, 16, v26
 v_mul_f32 v12, v12, v25
 v_cvt_pk_bf16_f32 v26, v12, v12
 v_lshlrev_b32 v12, 16, v26
 v_mul_f32 v13, v13, v25
 v_cvt_pk_bf16_f32 v26, v13, v13
 v_lshlrev_b32 v13, 16, v26
 v_mul_f32 v14, v14, v25
 v_cvt_pk_bf16_f32 v26, v14, v14
 v_lshlrev_b32 v14, 16, v26
 v_mul_f32 v15, v15, v25
 v_cvt_pk_bf16_f32 v26, v15, v15
 v_lshlrev_b32 v15, 16, v26
 v_mul_f32 v16, v16, v25
 v_cvt_pk_bf16_f32 v26, v16, v16
 v_lshlrev_b32 v16, 16, v26
 v_mul_f32 v17, v17, v25
 v_cvt_pk_bf16_f32 v26, v17, v17
 v_lshlrev_b32 v17, 16, v26
 v_mul_f32 v18, v18, v25
 v_cvt_pk_bf16_f32 v26, v18, v18
 v_lshlrev_b32 v18, 16, v26
 v_mul_f32 v19, v19, v25
 v_cvt_pk_bf16_f32 v26, v19, v19
 v_lshlrev_b32 v19, 16, v26
 s_cmp_ge_u32 s40, 52
 s_cbranch_scc1 pvt_253
 s_cmp_lg_u32 s20, 0
 s_cbranch_scc1 wm_255
 s_mov_b32 s101, 0
wm_254:
 buffer_load_dword v26, v7, s[72:75], s52 offen sc1
 s_add_u32 s101, s101, 1
 s_cmp_gt_u32 s101, 131072
 s_cbranch_scc1 main_end
 s_waitcnt vmcnt(0)
 v_cmp_gt_u32 vcc, 4, v26
 v_readfirstlane_b32 s100, v26
 s_nop 0
 s_cbranch_vccz wm_255
 s_sleep 2
 s_add_u32 s100, s100, 3
 s_cmp_ge_u32 s100, 4
 s_cbranch_scc1 wm_254
 s_sleep 24
 s_branch wm_254
wm_255:
 s_barrier
 buffer_load_dwordx4 v[64:67], v4, s[16:19], s47 offen sc1
 buffer_load_dwordx2 v[68:69], v5, s[16:19], s47 offen offset:2048 sc1
 buffer_load_dwordx4 v[128:131], v21, s[16:19], s47 offen offset:1024 sc1
 buffer_load_dwordx4 v[132:135], v21, s[16:19], s47 offen offset:1280 sc1
 s_add_u32 s47, s47, 2560
 buffer_load_dwordx4 v[72:75], v4, s[16:19], s47 offen sc1
 buffer_load_dwordx2 v[76:77], v5, s[16:19], s47 offen offset:2048 sc1
 s_add_u32 s47, s47, 2560
 buffer_load_dwordx4 v[80:83], v4, s[16:19], s47 offen sc1
 buffer_load_dwordx2 v[84:85], v5, s[16:19], s47 offen offset:2048 sc1
 s_add_u32 s47, s47, 2560
 buffer_load_dwordx4 v[88:91], v4, s[16:19], s47 offen sc1
 buffer_load_dwordx2 v[92:93], v5, s[16:19], s47 offen offset:2048 sc1
 s_add_u32 s47, s47, 2560
 buffer_load_dwordx4 v[32:35], v22, s[16:19], s48 offen offset:0 sc1
 buffer_load_dwordx4 v[36:39], v22, s[16:19], s48 offen offset:256 sc1
 buffer_load_dwordx4 v[40:43], v22, s[16:19], s48 offen offset:512 sc1
 buffer_load_dwordx4 v[44:47], v22, s[16:19], s48 offen offset:768 sc1
 s_add_u32 s48, s48, 40960
 buffer_load_dwordx4 v[96:99], v4, s[16:19], s47 offen sc1
 buffer_load_dwordx2 v[100:101], v5, s[16:19], s47 offen offset:2048 sc1
 buffer_load_dwordx4 v[136:139], v21, s[16:19], s47 offen offset:1024 sc1
 buffer_load_dwordx4 v[140:143], v21, s[16:19], s47 offen offset:1280 sc1
 s_add_u32 s47, s47, 2560
 buffer_load_dwordx4 v[104:107], v4, s[16:19], s47 offen sc1
 buffer_load_dwordx2 v[108:109], v5, s[16:19], s47 offen offset:2048 sc1
 s_add_u32 s47, s47, 2560
 buffer_load_dwordx4 v[112:115], v4, s[16:19], s47 offen sc1
 buffer_load_dwordx2 v[116:117], v5, s[16:19], s47 offen offset:2048 sc1
 s_add_u32 s47, s47, 2560
 buffer_load_dwordx4 v[120:123], v4, s[16:19], s47 offen sc1
 buffer_load_dwordx2 v[124:125], v5, s[16:19], s47 offen offset:2048 sc1
 s_add_u32 s47, s47, 2560
 buffer_load_dwordx4 v[48:51], v22, s[16:19], s48 offen offset:0 sc1
 buffer_load_dwordx4 v[52:55], v22, s[16:19], s48 offen offset:256 sc1
 buffer_load_dwordx4 v[56:59], v22, s[16:19], s48 offen offset:512 sc1
 buffer_load_dwordx4 v[60:63], v22, s[16:19], s48 offen offset:768 sc1
 s_add_u32 s48, s48, 40960
pvg_250:
 s_add_u32 s41, s41, 1
 s_mul_i32 s53, s42, 40960
 s_lshl_b32 s22, s41, 12
 s_add_u32 s53, s53, s22
 s_mul_i32 s48, s42, 10240
 s_lshl_b32 s22, s41, 10
 s_add_u32 s48, s48, s22
 s_add_u32 s48, s48, 15728640
 s_waitcnt vmcnt(26)
 v_mfma_f32_16x16x32_bf16 v[148:151], a[0:3], v[64:67], 0
 v_mfma_f32_16x16x32_bf16 v[144:147], a[0:3], v[68:71], 0
 v_mfma_f32_16x16x32_bf16 v[156:159], a[4:7], v[64:67], 0
 v_mfma_f32_16x16x32_bf16 v[152:155], a[4:7], v[68:71], 0
 v_mfma_f32_16x16x32_bf16 v[164:167], a[8:11], v[64:67], 0
 v_mfma_f32_16x16x32_bf16 v[160:163], a[8:11], v[68:71], 0
 v_mfma_f32_16x16x32_bf16 v[172:175], a[12:15], v[64:67], 0
 v_mfma_f32_16x16x32_bf16 v[168:171], a[12:15], v[68:71], 0
 buffer_load_dwordx4 a[0:3], v4, s[12:15], s53 offen offset:0 sc1
 buffer_load_dwordx4 a[4:7], v4, s[12:15], s53 offen offset:1024 sc1
 buffer_load_dwordx4 a[8:11], v4, s[12:15], s53 offen offset:2048 sc1
 buffer_load_dwordx4 a[12:15], v4, s[12:15], s53 offen offset:3072 sc1
 s_waitcnt vmcnt(26)
 v_mfma_f32_16x16x32_bf16 v[148:151], a[16:19], v[72:75], v[148:151]
 v_mfma_f32_16x16x32_bf16 v[144:147], a[16:19], v[76:79], v[144:147]
 v_mfma_f32_16x16x32_bf16 v[156:159], a[20:23], v[72:75], v[156:159]
 v_mfma_f32_16x16x32_bf16 v[152:155], a[20:23], v[76:79], v[152:155]
 v_mfma_f32_16x16x32_bf16 v[164:167], a[24:27], v[72:75], v[164:167]
 v_mfma_f32_16x16x32_bf16 v[160:163], a[24:27], v[76:79], v[160:163]
 v_mfma_f32_16x16x32_bf16 v[172:175], a[28:31], v[72:75], v[172:175]
 v_mfma_f32_16x16x32_bf16 v[168:171], a[28:31], v[76:79], v[168:171]
 s_add_u32 s53, s53, 40960
 buffer_load_dwordx4 a[16:19], v4, s[12:15], s53 offen offset:0 sc1
 buffer_load_dwordx4 a[20:23], v4, s[12:15], s53 offen offset:1024 sc1
 buffer_load_dwordx4 a[24:27], v4, s[12:15], s53 offen offset:2048 sc1
 buffer_load_dwordx4 a[28:31], v4, s[12:15], s53 offen offset:3072 sc1
 s_waitcnt vmcnt(28)
 v_mfma_f32_16x16x32_bf16 v[148:151], a[32:35], v[80:83], v[148:151]
 v_mfma_f32_16x16x32_bf16 v[144:147], a[32:35], v[84:87], v[144:147]
 v_mfma_f32_16x16x32_bf16 v[156:159], a[36:39], v[80:83], v[156:159]
 v_mfma_f32_16x16x32_bf16 v[152:155], a[36:39], v[84:87], v[152:155]
 v_mfma_f32_16x16x32_bf16 v[164:167], a[40:43], v[80:83], v[164:167]
 v_mfma_f32_16x16x32_bf16 v[160:163], a[40:43], v[84:87], v[160:163]
 v_mfma_f32_16x16x32_bf16 v[172:175], a[44:47], v[80:83], v[172:175]
 v_mfma_f32_16x16x32_bf16 v[168:171], a[44:47], v[84:87], v[168:171]
 s_add_u32 s53, s53, 40960
 buffer_load_dwordx4 a[32:35], v4, s[12:15], s53 offen offset:0 sc1
 buffer_load_dwordx4 a[36:39], v4, s[12:15], s53 offen offset:1024 sc1
 buffer_load_dwordx4 a[40:43], v4, s[12:15], s53 offen offset:2048 sc1
 buffer_load_dwordx4 a[44:47], v4, s[12:15], s53 offen offset:3072 sc1
 s_waitcnt vmcnt(30)
 v_mfma_f32_16x16x32_bf16 v[148:151], a[48:51], v[88:91], v[148:151]
 v_mfma_f32_16x16x32_bf16 v[144:147], a[48:51], v[92:95], v[144:147]
 v_mfma_f32_16x16x32_bf16 v[156:159], a[52:55], v[88:91], v[156:159]
 v_mfma_f32_16x16x32_bf16 v[152:155], a[52:55], v[92:95], v[152:155]
 v_mfma_f32_16x16x32_bf16 v[164:167], a[56:59], v[88:91], v[164:167]
 v_mfma_f32_16x16x32_bf16 v[160:163], a[56:59], v[92:95], v[160:163]
 v_mfma_f32_16x16x32_bf16 v[172:175], a[60:63], v[88:91], v[172:175]
 v_mfma_f32_16x16x32_bf16 v[168:171], a[60:63], v[92:95], v[168:171]
 s_add_u32 s53, s53, 40960
 buffer_load_dwordx4 a[48:51], v4, s[12:15], s53 offen offset:0 sc1
 buffer_load_dwordx4 a[52:55], v4, s[12:15], s53 offen offset:1024 sc1
 buffer_load_dwordx4 a[56:59], v4, s[12:15], s53 offen offset:2048 sc1
 buffer_load_dwordx4 a[60:63], v4, s[12:15], s53 offen offset:3072 sc1
 s_waitcnt vmcnt(30)
 v_mfma_f32_16x16x32_bf16 v[144:147], v[32:35], v[128:131], v[144:147]
 v_mfma_f32_16x16x32_bf16 v[148:151], v[32:35], v[132:135], v[148:151]
 v_mfma_f32_16x16x32_bf16 v[152:155], v[36:39], v[128:131], v[152:155]
 v_mfma_f32_16x16x32_bf16 v[156:159], v[36:39], v[132:135], v[156:159]
 v_mfma_f32_16x16x32_bf16 v[160:163], v[40:43], v[128:131], v[160:163]
 v_mfma_f32_16x16x32_bf16 v[164:167], v[40:43], v[132:135], v[164:167]
 v_mfma_f32_16x16x32_bf16 v[168:171], v[44:47], v[128:131], v[168:171]
 v_mfma_f32_16x16x32_bf16 v[172:175], v[44:47], v[132:135], v[172:175]
 buffer_load_dwordx4 v[32:35], v22, s[16:19], s48 offen offset:0 sc1
 buffer_load_dwordx4 v[36:39], v22, s[16:19], s48 offen offset:256 sc1
 buffer_load_dwordx4 v[40:43], v22, s[16:19], s48 offen offset:512 sc1
 buffer_load_dwordx4 v[44:47], v22, s[16:19], s48 offen offset:768 sc1
 s_add_u32 s48, s48, 40960
 s_waitcnt vmcnt(32)
 v_mfma_f32_16x16x32_bf16 v[148:151], a[64:67], v[96:99], v[148:151]
 v_mfma_f32_16x16x32_bf16 v[144:147], a[64:67], v[100:103], v[144:147]
 v_mfma_f32_16x16x32_bf16 v[156:159], a[68:71], v[96:99], v[156:159]
 v_mfma_f32_16x16x32_bf16 v[152:155], a[68:71], v[100:103], v[152:155]
 v_mfma_f32_16x16x32_bf16 v[164:167], a[72:75], v[96:99], v[164:167]
 v_mfma_f32_16x16x32_bf16 v[160:163], a[72:75], v[100:103], v[160:163]
 v_mfma_f32_16x16x32_bf16 v[172:175], a[76:79], v[96:99], v[172:175]
 v_mfma_f32_16x16x32_bf16 v[168:171], a[76:79], v[100:103], v[168:171]
 s_add_u32 s53, s53, 40960
 buffer_load_dwordx4 a[64:67], v4, s[12:15], s53 offen offset:0 sc1
 buffer_load_dwordx4 a[68:71], v4, s[12:15], s53 offen offset:1024 sc1
 buffer_load_dwordx4 a[72:75], v4, s[12:15], s53 offen offset:2048 sc1
 buffer_load_dwordx4 a[76:79], v4, s[12:15], s53 offen offset:3072 sc1
 s_waitcnt vmcnt(32)
 v_mfma_f32_16x16x32_bf16 v[148:151], a[80:83], v[104:107], v[148:151]
 v_mfma_f32_16x16x32_bf16 v[144:147], a[80:83], v[108:111], v[144:147]
 v_mfma_f32_16x16x32_bf16 v[156:159], a[84:87], v[104:107], v[156:159]
 v_mfma_f32_16x16x32_bf16 v[152:155], a[84:87], v[108:111], v[152:155]
 v_mfma_f32_16x16x32_bf16 v[164:167], a[88:91], v[104:107], v[164:167]
 v_mfma_f32_16x16x32_bf16 v[160:163], a[88:91], v[108:111], v[160:163]
 v_mfma_f32_16x16x32_bf16 v[172:175], a[92:95], v[104:107], v[172:175]
 v_mfma_f32_16x16x32_bf16 v[168:171], a[92:95], v[108:111], v[168:171]
 s_add_u32 s53, s53, 40960
 buffer_load_dwordx4 a[80:83], v4, s[12:15], s53 offen offset:0 sc1
 buffer_load_dwordx4 a[84:87], v4, s[12:15], s53 offen offset:1024 sc1
 buffer_load_dwordx4 a[88:91], v4, s[12:15], s53 offen offset:2048 sc1
 buffer_load_dwordx4 a[92:95], v4, s[12:15], s53 offen offset:3072 sc1
 s_waitcnt vmcnt(34)
 v_mfma_f32_16x16x32_bf16 v[148:151], a[96:99], v[112:115], v[148:151]
 v_mfma_f32_16x16x32_bf16 v[144:147], a[96:99], v[116:119], v[144:147]
 v_mfma_f32_16x16x32_bf16 v[156:159], a[100:103], v[112:115], v[156:159]
 v_mfma_f32_16x16x32_bf16 v[152:155], a[100:103], v[116:119], v[152:155]
 v_mfma_f32_16x16x32_bf16 v[164:167], a[104:107], v[112:115], v[164:167]
 v_mfma_f32_16x16x32_bf16 v[160:163], a[104:107], v[116:119], v[160:163]
 v_mfma_f32_16x16x32_bf16 v[172:175], a[108:111], v[112:115], v[172:175]
 v_mfma_f32_16x16x32_bf16 v[168:171], a[108:111], v[116:119], v[168:171]
 s_add_u32 s53, s53, 40960
 buffer_load_dwordx4 a[96:99], v4, s[12:15], s53 offen offset:0 sc1
 buffer_load_dwordx4 a[100:103], v4, s[12:15], s53 offen offset:1024 sc1
 buffer_load_dwordx4 a[104:107], v4, s[12:15], s53 offen offset:2048 sc1
 buffer_load_dwordx4 a[108:111], v4, s[12:15], s53 offen offset:3072 sc1
 s_waitcnt vmcnt(36)
 v_mfma_f32_16x16x32_bf16 v[148:151], a[112:115], v[120:123], v[148:151]
 v_mfma_f32_16x16x32_bf16 v[144:147], a[112:115], v[124:127], v[144:147]
 v_mfma_f32_16x16x32_bf16 v[156:159], a[116:119], v[120:123], v[156:159]
 v_mfma_f32_16x16x32_bf16 v[152:155], a[116:119], v[124:127], v[152:155]
 v_mfma_f32_16x16x32_bf16 v[164:167], a[120:123], v[120:123], v[164:167]
 v_mfma_f32_16x16x32_bf16 v[160:163], a[120:123], v[124:127], v[160:163]
 v_mfma_f32_16x16x32_bf16 v[172:175], a[124:127], v[120:123], v[172:175]
 v_mfma_f32_16x16x32_bf16 v[168:171], a[124:127], v[124:127], v[168:171]
 s_add_u32 s53, s53, 40960
 buffer_load_dwordx4 a[112:115], v4, s[12:15], s53 offen offset:0 sc1
 buffer_load_dwordx4 a[116:119], v4, s[12:15], s53 offen offset:1024 sc1
 buffer_load_dwordx4 a[120:123], v4, s[12:15], s53 offen offset:2048 sc1
 buffer_load_dwordx4 a[124:127], v4, s[12:15], s53 offen offset:3072 sc1
 s_waitcnt vmcnt(36)
 v_mfma_f32_16x16x32_bf16 v[144:147], v[48:51], v[136:139], v[144:147]
 v_mfma_f32_16x16x32_bf16 v[148:151], v[48:51], v[140:143], v[148:151]
 v_mfma_f32_16x16x32_bf16 v[152:155], v[52:55], v[136:139], v[152:155]
 v_mfma_f32_16x16x32_bf16 v[156:159], v[52:55], v[140:143], v[156:159]
 v_mfma_f32_16x16x32_bf16 v[160:163], v[56:59], v[136:139], v[160:163]
 v_mfma_f32_16x16x32_bf16 v[164:167], v[56:59], v[140:143], v[164:167]
 v_mfma_f32_16x16x32_bf16 v[168:171], v[60:63], v[136:139], v[168:171]
 v_mfma_f32_16x16x32_bf16 v[172:175], v[60:63], v[140:143], v[172:175]
 buffer_load_dwordx4 v[48:51], v22, s[16:19], s48 offen offset:0 sc1
 buffer_load_dwordx4 v[52:55], v22, s[16:19], s48 offen offset:256 sc1
 buffer_load_dwordx4 v[56:59], v22, s[16:19], s48 offen offset:512 sc1
 buffer_load_dwordx4 v[60:63], v22, s[16:19], s48 offen offset:768 sc1
 s_add_u32 s48, s48, 40960
 s_branch pve_246
pvt_253:
 s_sub_u32 s55, s52, 2048
 s_cmp_lg_u32 s20, 0
 s_cbranch_scc1 wm_257
 s_mov_b32 s101, 0
wm_256:
 buffer_load_dword v26, v7, s[72:75], s55 offen sc1
 s_add_u32 s101, s101, 1
 s_cmp_gt_u32 s101, 131072
 s_cbranch_scc1 main_end
 s_waitcnt vmcnt(0)
 v_cmp_gt_u32 vcc, 4, v26
 v_readfirstlane_b32 s100, v26
 s_nop 0
 s_cbranch_vccz wm_257
 s_sleep 4
 s_add_u32 s100, s100, 3
 s_cmp_ge_u32 s100, 4
 s_cbranch_scc1 wm_256
 s_sleep 24
 s_branch wm_256
wm_257:
 s_barrier
 s_mov_b32 s56, s47
 s_mov_b32 s57, s48
 buffer_load_dwordx4 v[64:67], v4, s[16:19], s56 offen sc1
 buffer_load_dwordx2 v[68:69], v5, s[16:19], s56 offen offset:2048 sc1
 buffer_load_dwordx4 v[128:131], v21, s[16:19], s56 offen offset:1024 sc1
 buffer_load_dwordx4 v[132:135], v21, s[16:19], s56 offen offset:1280 sc1
 s_add_u32 s56, s56, 2560
 buffer_load_dwordx4 v[72:75], v4, s[16:19], s56 offen sc1
 buffer_load_dwordx2 v[76:77], v5, s[16:19], s56 offen offset:2048 sc1
 s_add_u32 s56, s56, 2560
 buffer_load_dwordx4 v[80:83], v4, s[16:19], s56 offen sc1
 buffer_load_dwordx2 v[84:85], v5, s[16:19], s56 offen offset:2048 sc1
 s_add_u32 s56, s56, 2560
 buffer_load_dwordx4 v[88:91], v4, s[16:19], s56 offen sc1
 buffer_load_dwordx2 v[92:93], v5, s[16:19], s56 offen offset:2048 sc1
 s_add_u32 s56, s56, 2560
 buffer_load_dwordx4 v[32:35], v22, s[16:19], s57 offen offset:0 sc1
 buffer_load_dwordx4 v[36:39], v22, s[16:19], s57 offen offset:256 sc1
 buffer_load_dwordx4 v[40:43], v22, s[16:19], s57 offen offset:512 sc1
 buffer_load_dwordx4 v[44:47], v22, s[16:19], s57 offen offset:768 sc1
 s_add_u32 s57, s57, 40960
 buffer_load_dwordx4 v[96:99], v4, s[16:19], s56 offen sc1
 buffer_load_dwordx2 v[100:101], v5, s[16:19], s56 offen offset:2048 sc1
 buffer_load_dwordx4 v[136:139], v21, s[16:19], s56 offen offset:1024 sc1
 buffer_load_dwordx4 v[140:143], v21, s[16:19], s56 offen offset:1280 sc1
 s_add_u32 s56, s56, 2560
 buffer_load_dwordx4 v[104:107], v4, s[16:19], s56 offen sc1
 buffer_load_dwordx2 v[108:109], v5, s[16:19], s56 offen offset:2048 sc1
 s_add_u32 s56, s56, 2560
 buffer_load_dwordx4 v[112:115], v4, s[16:19], s56 offen sc1
 buffer_load_dwordx2 v[116:117], v5, s[16:19], s56 offen offset:2048 sc1
 s_add_u32 s56, s56, 2560
 buffer_load_dwordx4 v[120:123], v4, s[16:19], s56 offen sc1
 buffer_load_dwordx2 v[124:125], v5, s[16:19], s56 offen offset:2048 sc1
 s_add_u32 s56, s56, 2560
 buffer_load_dwordx4 v[48:51], v22, s[16:19], s57 offen offset:0 sc1
 buffer_load_dwordx4 v[52:55], v22, s[16:19], s57 offen offset:256 sc1
 buffer_load_dwordx4 v[56:59], v22, s[16:19], s57 offen offset:512 sc1
 buffer_load_dwordx4 v[60:63], v22, s[16:19], s57 offen offset:768 sc1
 s_add_u32 s57, s57, 40960
pvc_251:
 s_mov_b32 s101, 0
 s_waitcnt vmcnt(14)
 s_branch pvr_259
pvr_258:
 s_sleep 2
 s_add_u32 s56, s47, 0
 s_add_u32 s57, s48, 0
 buffer_load_dwordx4 v[64:67], v4, s[16:19], s56 offen sc1
 buffer_load_dwordx2 v[68:69], v5, s[16:19], s56 offen offset:2048 sc1
 buffer_load_dwordx4 v[128:131], v21, s[16:19], s56 offen offset:1024 sc1
 buffer_load_dwordx4 v[132:135], v21, s[16:19], s56 offen offset:1280 sc1
 s_add_u32 s56, s56, 2560
 buffer_load_dwordx4 v[72:75], v4, s[16:19], s56 offen sc1
 buffer_load_dwordx2 v[76:77], v5, s[16:19], s56 offen offset:2048 sc1
 s_add_u32 s56, s56, 2560
 buffer_load_dwordx4 v[80:83], v4, s[16:19], s56 offen sc1
 buffer_load_dwordx2 v[84:85], v5, s[16:19], s56 offen offset:2048 sc1
 s_add_u32 s56, s56, 2560
 buffer_load_dwordx4 v[88:91], v4, s[16:19], s56 offen sc1
 buffer_load_dwordx2 v[92:93], v5, s[16:19], s56 offen offset:2048 sc1
 s_add_u32 s56, s56, 2560
 buffer_load_dwordx4 v[32:35], v22, s[16:19], s57 offen offset:0 sc1
 buffer_load_dwordx4 v[36:39], v22, s[16:19], s57 offen offset:256 sc1
 buffer_load_dwordx4 v[40:43], v22, s[16:19], s57 offen offset:512 sc1
 buffer_load_dwordx4 v[44:47], v22, s[16:19], s57 offen offset:768 sc1
 s_add_u32 s57, s57, 40960
 s_add_u32 s101, s101, 1
 s_cmp_gt_u32 s101, 131072
 s_cbranch_scc1 main_end
 s_waitcnt vmcnt(0)
pvr_259:
 v_max3_u32 v26, v64, v68, v72
 v_max3_u32 v26, v26, v76, v80
 v_max3_u32 v26, v26, v84, v88
 v_max3_u32 v26, v26, v92, v128
 v_max3_u32 v26, v26, v132, v32
 v_max3_u32 v26, v26, v36, v40
 v_max3_u32 v26, v26, v44, v44
 v_cmp_eq_u32 vcc, -1, v26
 s_nop 1
 s_cbranch_vccnz pvr_258
 v_mfma_f32_16x16x32_bf16 v[148:151], a[0:3], v[64:67], 0
 v_mfma_f32_16x16x32_bf16 v[144:147], a[0:3], v[68:71], 0
 v_mfma_f32_16x16x32_bf16 v[156:159], a[4:7], v[64:67], 0
 v_mfma_f32_16x16x32_bf16 v[152:155], a[4:7], v[68:71], 0
 v_mfma_f32_16x16x32_bf16 v[164:167], a[8:11], v[64:67], 0
 v_mfma_f32_16x16x32_bf16 v[160:163], a[8:11], v[68:71], 0
 v_mfma_f32_16x16x32_bf16 v[172:175], a[12:15], v[64:67], 0
 v_mfma_f32_16x16x32_bf16 v[168:171], a[12:15], v[68:71], 0
 v_mfma_f32_16x16x32_bf16 v[148:151], a[16:19], v[72:75], v[148:151]
 v_mfma_f32_16x16x32_bf16 v[144:147], a[16:19], v[76:79], v[144:147]
 v_mfma_f32_16x16x32_bf16 v[156:159], a[20:23], v[72:75], v[156:159]
 v_mfma_f32_16x16x32_bf16 v[152:155], a[20:23], v[76:79], v[152:155]
 v_mfma_f32_16x16x32_bf16 v[164:167], a[24:27], v[72:75], v[164:167]
 v_mfma_f32_16x16x32_bf16 v[160:163], a[24:27], v[76:79], v[160:163]
 v_mfma_f32_16x16x32_bf16 v[172:175], a[28:31], v[72:75], v[172:175]
 v_mfma_f32_16x16x32_bf16 v[168:171], a[28:31], v[76:79], v[168:171]
 v_mfma_f32_16x16x32_bf16 v[148:151], a[32:35], v[80:83], v[148:151]
 v_mfma_f32_16x16x32_bf16 v[144:147], a[32:35], v[84:87], v[144:147]
 v_mfma_f32_16x16x32_bf16 v[156:159], a[36:39], v[80:83], v[156:159]
 v_mfma_f32_16x16x32_bf16 v[152:155], a[36:39], v[84:87], v[152:155]
 v_mfma_f32_16x16x32_bf16 v[164:167], a[40:43], v[80:83], v[164:167]
 v_mfma_f32_16x16x32_bf16 v[160:163], a[40:43], v[84:87], v[160:163]
 v_mfma_f32_16x16x32_bf16 v[172:175], a[44:47], v[80:83], v[172:175]
 v_mfma_f32_16x16x32_bf16 v[168:171], a[44:47], v[84:87], v[168:171]
 v_mfma_f32_16x16x32_bf16 v[148:151], a[48:51], v[88:91], v[148:151]
 v_mfma_f32_16x16x32_bf16 v[144:147], a[48:51], v[92:95], v[144:147]
 v_mfma_f32_16x16x32_bf16 v[156:159], a[52:55], v[88:91], v[156:159]
 v_mfma_f32_16x16x32_bf16 v[152:155], a[52:55], v[92:95], v[152:155]
 v_mfma_f32_16x16x32_bf16 v[164:167], a[56:59], v[88:91], v[164:167]
 v_mfma_f32_16x16x32_bf16 v[160:163], a[56:59], v[92:95], v[160:163]
 v_mfma_f32_16x16x32_bf16 v[172:175], a[60:63], v[88:91], v[172:175]
 v_mfma_f32_16x16x32_bf16 v[168:171], a[60:63], v[92:95], v[168:171]
 s_nop 1
 v_mfma_f32_16x16x32_bf16 v[144:147], v[32:35], v[128:131], v[144:147]
 v_mfma_f32_16x16x32_bf16 v[148:151], v[32:35], v[132:135], v[148:151]
 v_mfma_f32_16x16x32_bf16 v[152:155], v[36:39], v[128:131], v[152:155]
 v_mfma_f32_16x16x32_bf16 v[156:159], v[36:39], v[132:135], v[156:159]
 v_mfma_f32_16x16x32_bf16 v[160:163], v[40:43], v[128:131], v[160:163]
 v_mfma_f32_16x16x32_bf16 v[164:167], v[40:43], v[132:135], v[164:167]
 v_mfma_f32_16x16x32_bf16 v[168:171], v[44:47], v[128:131], v[168:171]
 v_mfma_f32_16x16x32_bf16 v[172:175], v[44:47], v[132:135], v[172:175]
 s_mov_b32 s101, 0
 s_waitcnt vmcnt(0)
 s_branch pvr_261
pvr_260:
 s_sleep 2
 s_add_u32 s56, s47, 10240
 s_add_u32 s57, s48, 40960
 buffer_load_dwordx4 v[96:99], v4, s[16:19], s56 offen sc1
 buffer_load_dwordx2 v[100:101], v5, s[16:19], s56 offen offset:2048 sc1
 buffer_load_dwordx4 v[136:139], v21, s[16:19], s56 offen offset:1024 sc1
 buffer_load_dwordx4 v[140:143], v21, s[16:19], s56 offen offset:1280 sc1
 s_add_u32 s56, s56, 2560
 buffer_load_dwordx4 v[104:107], v4, s[16:19], s56 offen sc1
 buffer_load_dwordx2 v[108:109], v5, s[16:19], s56 offen offset:2048 sc1
 s_add_u32 s56, s56, 2560
 buffer_load_dwordx4 v[112:115], v4, s[16:19], s56 offen sc1
 buffer_load_dwordx2 v[116:117], v5, s[16:19], s56 offen offset:2048 sc1
 s_add_u32 s56, s56, 2560
 buffer_load_dwordx4 v[120:123], v4, s[16:19], s56 offen sc1
 buffer_load_dwordx2 v[124:125], v5, s[16:19], s56 offen offset:2048 sc1
 s_add_u32 s56, s56, 2560
 buffer_load_dwordx4 v[48:51], v22, s[16:19], s57 offen offset:0 sc1
 buffer_load_dwordx4 v[52:55], v22, s[16:19], s57 offen offset:256 sc1
 buffer_load_dwordx4 v[56:59], v22, s[16:19], s57 offen offset:512 sc1
 buffer_load_dwordx4 v[60:63], v22, s[16:19], s57 offen offset:768 sc1
 s_add_u32 s57, s57, 40960
 s_add_u32 s101, s101, 1
 s_cmp_gt_u32 s101, 131072
 s_cbranch_scc1 main_end
 s_waitcnt vmcnt(0)
pvr_261:
 v_max3_u32 v26, v96, v100, v104
 v_max3_u32 v26, v26, v108, v112
 v_max3_u32 v26, v26, v116, v120
 v_max3_u32 v26, v26, v124, v136
 v_max3_u32 v26, v26, v140, v48
 v_max3_u32 v26, v26, v52, v56
 v_max3_u32 v26, v26, v60, v60
 v_cmp_eq_u32 vcc, -1, v26
 s_nop 1
 s_cbranch_vccnz pvr_260
 v_mfma_f32_16x16x32_bf16 v[148:151], a[64:67], v[96:99], v[148:151]
 v_mfma_f32_16x16x32_bf16 v[144:147], a[64:67], v[100:103], v[144:147]
 v_mfma_f32_16x16x32_bf16 v[156:159], a[68:71], v[96:99], v[156:159]
 v_mfma_f32_16x16x32_bf16 v[152:155], a[68:71], v[100:103], v[152:155]
 v_mfma_f32_16x16x32_bf16 v[164:167], a[72:75], v[96:99], v[164:167]
 v_mfma_f32_16x16x32_bf16 v[160:163], a[72:75], v[100:103], v[160:163]
 v_mfma_f32_16x16x32_bf16 v[172:175], a[76:79], v[96:99], v[172:175]
 v_mfma_f32_16x16x32_bf16 v[168:171], a[76:79], v[100:103], v[168:171]
 v_mfma_f32_16x16x32_bf16 v[148:151], a[80:83], v[104:107], v[148:151]
 v_mfma_f32_16x16x32_bf16 v[144:147], a[80:83], v[108:111], v[144:147]
 v_mfma_f32_16x16x32_bf16 v[156:159], a[84:87], v[104:107], v[156:159]
 v_mfma_f32_16x16x32_bf16 v[152:155], a[84:87], v[108:111], v[152:155]
 v_mfma_f32_16x16x32_bf16 v[164:167], a[88:91], v[104:107], v[164:167]
 v_mfma_f32_16x16x32_bf16 v[160:163], a[88:91], v[108:111], v[160:163]
 v_mfma_f32_16x16x32_bf16 v[172:175], a[92:95], v[104:107], v[172:175]
 v_mfma_f32_16x16x32_bf16 v[168:171], a[92:95], v[108:111], v[168:171]
 v_mfma_f32_16x16x32_bf16 v[148:151], a[96:99], v[112:115], v[148:151]
 v_mfma_f32_16x16x32_bf16 v[144:147], a[96:99], v[116:119], v[144:147]
 v_mfma_f32_16x16x32_bf16 v[156:159], a[100:103], v[112:115], v[156:159]
 v_mfma_f32_16x16x32_bf16 v[152:155], a[100:103], v[116:119], v[152:155]
 v_mfma_f32_16x16x32_bf16 v[164:167], a[104:107], v[112:115], v[164:167]
 v_mfma_f32_16x16x32_bf16 v[160:163], a[104:107], v[116:119], v[160:163]
 v_mfma_f32_16x16x32_bf16 v[172:175], a[108:111], v[112:115], v[172:175]
 v_mfma_f32_16x16x32_bf16 v[168:171], a[108:111], v[116:119], v[168:171]
 v_mfma_f32_16x16x32_bf16 v[148:151], a[112:115], v[120:123], v[148:151]
 v_mfma_f32_16x16x32_bf16 v[144:147], a[112:115], v[124:127], v[144:147]
 v_mfma_f32_16x16x32_bf16 v[156:159], a[116:119], v[120:123], v[156:159]
 v_mfma_f32_16x16x32_bf16 v[152:155], a[116:119], v[124:127], v[152:155]
 v_mfma_f32_16x16x32_bf16 v[164:167], a[120:123], v[120:123], v[164:167]
 v_mfma_f32_16x16x32_bf16 v[160:163], a[120:123], v[124:127], v[160:163]
 v_mfma_f32_16x16x32_bf16 v[172:175], a[124:127], v[120:123], v[172:175]
 v_mfma_f32_16x16x32_bf16 v[168:171], a[124:127], v[124:127], v[168:171]
 s_nop 1
 v_mfma_f32_16x16x32_bf16 v[144:147], v[48:51], v[136:139], v[144:147]
 v_mfma_f32_16x16x32_bf16 v[148:151], v[48:51], v[140:143], v[148:151]
 v_mfma_f32_16x16x32_bf16 v[152:155], v[52:55], v[136:139], v[152:155]
 v_mfma_f32_16x16x32_bf16 v[156:159], v[52:55], v[140:143], v[156:159]
 v_mfma_f32_16x16x32_bf16 v[160:163], v[56:59], v[136:139], v[160:163]
 v_mfma_f32_16x16x32_bf16 v[164:167], v[56:59], v[140:143], v[164:167]
 v_mfma_f32_16x16x32_bf16 v[168:171], v[60:63], v[136:139], v[168:171]
 v_mfma_f32_16x16x32_bf16 v[172:175], v[60:63], v[140:143], v[172:175]
pve_246:
 s_nop 0
 s_cmp_lg_u32 s20, 0
 s_cbranch_scc1 lc_262
 s_sub_u32 s21, s2, 0
 s_cmp_ge_u32 s21, 640
 s_cbranch_scc1 lc_262
 v_mov_b32 v29, 1
 s_mov_b64 exec, 1
 buffer_atomic_add v29, v28, s[32:35], 0 offen sc0 sc1
 s_mov_b64 exec, -1
lc_262:
 ds_write_b128 v10, v[144:147] offset:0
 ds_write_b128 v10, v[148:151] offset:1024
 ds_write_b128 v10, v[152:155] offset:2048
 ds_write_b128 v10, v[156:159] offset:3072
 ds_write_b128 v10, v[160:163] offset:4096
 ds_write_b128 v10, v[164:167] offset:5120
 ds_write_b128 v10, v[168:171] offset:6144
 ds_write_b128 v10, v[172:175] offset:7168
 s_cmp_lg_u32 s20, 0
 s_cbranch_scc1 pvq_265
 v_readfirstlane_b32 s21, v29
 s_mov_b32 s23, -1
 v_mov_b32 v213, s23
 s_mov_b64 exec, 1
 ds_write_b32 v30, v29
 ds_write_b32 v30, v213 offset:8
 s_mov_b64 exec, -1
pvq_265:
 s_waitcnt lgkmcnt(0)
 s_barrier
 ds_read_b128 v[176:179], v11 offset:0
 ds_read_b128 v[180:183], v11 offset:8192
 ds_read_b128 v[184:187], v11 offset:16384
 ds_read_b128 v[188:191], v11 offset:24576
 ds_read_b128 v[192:195], v11 offset:4096
 ds_read_b128 v[196:199], v11 offset:12288
 ds_read_b128 v[200:203], v11 offset:20480
 ds_read_b128 v[204:207], v11 offset:28672
 ds_read_b32 v23, v30
 ds_read_b32 v213, v30 offset:8
 s_cmp_ge_u32 s40, 32
 s_cbranch_scc1 pvr_268
 s_waitcnt lgkmcnt(6)
 v_pk_add_f32 v[176:177], v[176:177], v[180:181]
 v_pk_add_f32 v[184:185], v[184:185], v[188:189]
 v_pk_add_f32 v[178:179], v[178:179], v[182:183]
 v_pk_add_f32 v[186:187], v[186:187], v[190:191]
 v_pk_add_f32 v[176:177], v[176:177], v[184:185]
 v_pk_add_f32 v[178:179], v[178:179], v[186:187]
 buffer_store_dwordx4 v[176:179], v4, s[24:27], s54 offen offset:0 sc1
 s_waitcnt lgkmcnt(2)
 v_pk_add_f32 v[192:193], v[192:193], v[196:197]
 v_pk_add_f32 v[200:201], v[200:201], v[204:205]
 v_pk_add_f32 v[194:195], v[194:195], v[198:199]
 v_pk_add_f32 v[202:203], v[202:203], v[206:207]
 v_pk_add_f32 v[192:193], v[192:193], v[200:201]
 v_pk_add_f32 v[194:195], v[194:195], v[202:203]
 buffer_store_dwordx4 v[192:195], v4, s[24:27], s54 offen offset:2048 sc1
 s_lshr_b32 s71, s40, 2
 s_lshl_b32 s71, s71, 7
 s_add_u32 s71, s71, 115712
 s_branch pvr_269
pvr_268:
 s_waitcnt lgkmcnt(6)
 v_pk_add_f32 v[176:177], v[176:177], v[180:181]
 v_pk_add_f32 v[184:185], v[184:185], v[188:189]
 v_pk_add_f32 v[178:179], v[178:179], v[182:183]
 v_pk_add_f32 v[186:187], v[186:187], v[190:191]
 v_pk_add_f32 v[176:177], v[176:177], v[184:185]
 v_pk_add_f32 v[178:179], v[178:179], v[186:187]
 v_cvt_pk_bf16_f32 v26, v176, v177
 v_lshlrev_b32 v176, 16, v26
 v_and_b32 v177, 0xffff0000, v26
 v_mul_f32 v176, v176, v24
 v_mul_f32 v177, v177, v24
 v_cvt_pk_bf16_f32 v26, v176, v177
 v_lshlrev_b32 v176, 16, v26
 v_and_b32 v177, 0xffff0000, v26
 v_add_f32 v176, v176, v12
 v_add_f32 v177, v177, v13
 v_cvt_pk_bf16_f32 v180, v176, v177
 v_cvt_pk_bf16_f32 v26, v178, v179
 v_lshlrev_b32 v178, 16, v26
 v_and_b32 v179, 0xffff0000, v26
 v_mul_f32 v178, v178, v24
 v_mul_f32 v179, v179, v24
 v_cvt_pk_bf16_f32 v26, v178, v179
 v_lshlrev_b32 v178, 16, v26
 v_and_b32 v179, 0xffff0000, v26
 v_add_f32 v178, v178, v14
 v_add_f32 v179, v179, v15
 v_cvt_pk_bf16_f32 v181, v178, v179
 buffer_store_dwordx2 v[180:181], v9, s[8:11], s46 offen offset:0
 s_waitcnt lgkmcnt(2)
 v_pk_add_f32 v[192:193], v[192:193], v[196:197]
 v_pk_add_f32 v[200:201], v[200:201], v[204:205]
 v_pk_add_f32 v[194:195], v[194:195], v[198:199]
 v_pk_add_f32 v[202:203], v[202:203], v[206:207]
 v_pk_add_f32 v[192:193], v[192:193], v[200:201]
 v_pk_add_f32 v[194:195], v[194:195], v[202:203]
 v_cvt_pk_bf16_f32 v26, v192, v193
 v_lshlrev_b32 v192, 16, v26
 v_and_b32 v193, 0xffff0000, v26
 v_mul_f32 v192, v192, v24
 v_mul_f32 v193, v193, v24
 v_cvt_pk_bf16_f32 v26, v192, v193
 v_lshlrev_b32 v192, 16, v26
 v_and_b32 v193, 0xffff0000, v26
 v_add_f32 v192, v192, v16
 v_add_f32 v193, v193, v17
 v_cvt_pk_bf16_f32 v196, v192, v193
 v_cvt_pk_bf16_f32 v26, v194, v195
 v_lshlrev_b32 v194, 16, v26
 v_and_b32 v195, 0xffff0000, v26
 v_mul_f32 v194, v194, v24
 v_mul_f32 v195, v195, v24
 v_cvt_pk_bf16_f32 v26, v194, v195
 v_lshlrev_b32 v194, 16, v26
 v_and_b32 v195, 0xffff0000, v26
 v_add_f32 v194, v194, v18
 v_add_f32 v195, v195, v19
 v_cvt_pk_bf16_f32 v197, v194, v195
 buffer_store_dwordx2 v[196:197], v9, s[8:11], s46 offen offset:64
pvr_269:
pvy_270:
 s_cmp_eq_u32 s65, 0
 s_cbranch_scc1 pvy_271
 s_sub_u32 s65, s65, 1
 s_add_u32 s46, s46, 128
 s_add_u32 s54, s54, 4096
 s_cmp_lt_u32 s40, 32
 s_cselect_b32 s70, 0x80000000, s54
 buffer_load_dwordx4 v[12:15], v4, s[24:27], s70 offen sc1
 buffer_load_dwordx4 v[16:19], v4, s[24:27], s70 offen offset:2048 sc1
 buffer_load_dword v24, v6, s[28:31], s45 offen sc1
 s_waitcnt lgkmcnt(0)
 s_barrier
 s_cmp_eq_u32 s65, 0
 s_cbranch_scc1 pvy_272
 s_add_u32 s41, s41, 1
 s_mul_i32 s53, s42, 40960
 s_lshl_b32 s22, s41, 12
 s_add_u32 s53, s53, s22
 s_mul_i32 s48, s42, 10240
 s_lshl_b32 s22, s41, 10
 s_add_u32 s48, s48, s22
 s_add_u32 s48, s48, 15728640
 s_waitcnt vmcnt(41)
 v_mfma_f32_16x16x32_bf16 v[148:151], a[0:3], v[64:67], 0
 v_mfma_f32_16x16x32_bf16 v[144:147], a[0:3], v[68:71], 0
 v_mfma_f32_16x16x32_bf16 v[156:159], a[4:7], v[64:67], 0
 v_mfma_f32_16x16x32_bf16 v[152:155], a[4:7], v[68:71], 0
 v_mfma_f32_16x16x32_bf16 v[164:167], a[8:11], v[64:67], 0
 v_mfma_f32_16x16x32_bf16 v[160:163], a[8:11], v[68:71], 0
 v_mfma_f32_16x16x32_bf16 v[172:175], a[12:15], v[64:67], 0
 v_mfma_f32_16x16x32_bf16 v[168:171], a[12:15], v[68:71], 0
 buffer_load_dwordx4 a[0:3], v4, s[12:15], s53 offen offset:0 sc1
 buffer_load_dwordx4 a[4:7], v4, s[12:15], s53 offen offset:1024 sc1
 buffer_load_dwordx4 a[8:11], v4, s[12:15], s53 offen offset:2048 sc1
 buffer_load_dwordx4 a[12:15], v4, s[12:15], s53 offen offset:3072 sc1
 s_waitcnt vmcnt(41)
 v_mfma_f32_16x16x32_bf16 v[148:151], a[16:19], v[72:75], v[148:151]
 v_mfma_f32_16x16x32_bf16 v[144:147], a[16:19], v[76:79], v[144:147]
 v_mfma_f32_16x16x32_bf16 v[156:159], a[20:23], v[72:75], v[156:159]
 v_mfma_f32_16x16x32_bf16 v[152:155], a[20:23], v[76:79], v[152:155]
 v_mfma_f32_16x16x32_bf16 v[164:167], a[24:27], v[72:75], v[164:167]
 v_mfma_f32_16x16x32_bf16 v[160:163], a[24:27], v[76:79], v[160:163]
 v_mfma_f32_16x16x32_bf16 v[172:175], a[28:31], v[72:75], v[172:175]
 v_mfma_f32_16x16x32_bf16 v[168:171], a[28:31], v[76:79], v[168:171]
 s_add_u32 s53, s53, 40960
 buffer_load_dwordx4 a[16:19], v4, s[12:15], s53 offen offset:0 sc1
 buffer_load_dwordx4 a[20:23], v4, s[12:15], s53 offen offset:1024 sc1
 buffer_load_dwordx4 a[24:27], v4, s[12:15], s53 offen offset:2048 sc1
 buffer_load_dwordx4 a[28:31], v4, s[12:15], s53 offen offset:3072 sc1
 s_waitcnt vmcnt(41)
 v_mfma_f32_16x16x32_bf16 v[148:151], a[32:35], v[80:83], v[148:151]
 v_mfma_f32_16x16x32_bf16 v[144:147], a[32:35], v[84:87], v[144:147]
 v_mfma_f32_16x16x32_bf16 v[156:159], a[36:39], v[80:83], v[156:159]
 v_mfma_f32_16x16x32_bf16 v[152:155], a[36:39], v[84:87], v[152:155]
 v_mfma_f32_16x16x32_bf16 v[164:167], a[40:43], v[80:83], v[164:167]
 v_mfma_f32_16x16x32_bf16 v[160:163], a[40:43], v[84:87], v[160:163]
 v_mfma_f32_16x16x32_bf16 v[172:175], a[44:47], v[80:83], v[172:175]
 v_mfma_f32_16x16x32_bf16 v[168:171], a[44:47], v[84:87], v[168:171]
 s_add_u32 s53, s53, 40960
 buffer_load_dwordx4 a[32:35], v4, s[12:15], s53 offen offset:0 sc1
 buffer_load_dwordx4 a[36:39], v4, s[12:15], s53 offen offset:1024 sc1
 buffer_load_dwordx4 a[40:43], v4, s[12:15], s53 offen offset:2048 sc1
 buffer_load_dwordx4 a[44:47], v4, s[12:15], s53 offen offset:3072 sc1
 s_waitcnt vmcnt(41)
 v_mfma_f32_16x16x32_bf16 v[148:151], a[48:51], v[88:91], v[148:151]
 v_mfma_f32_16x16x32_bf16 v[144:147], a[48:51], v[92:95], v[144:147]
 v_mfma_f32_16x16x32_bf16 v[156:159], a[52:55], v[88:91], v[156:159]
 v_mfma_f32_16x16x32_bf16 v[152:155], a[52:55], v[92:95], v[152:155]
 v_mfma_f32_16x16x32_bf16 v[164:167], a[56:59], v[88:91], v[164:167]
 v_mfma_f32_16x16x32_bf16 v[160:163], a[56:59], v[92:95], v[160:163]
 v_mfma_f32_16x16x32_bf16 v[172:175], a[60:63], v[88:91], v[172:175]
 v_mfma_f32_16x16x32_bf16 v[168:171], a[60:63], v[92:95], v[168:171]
 s_add_u32 s53, s53, 40960
 buffer_load_dwordx4 a[48:51], v4, s[12:15], s53 offen offset:0 sc1
 buffer_load_dwordx4 a[52:55], v4, s[12:15], s53 offen offset:1024 sc1
 buffer_load_dwordx4 a[56:59], v4, s[12:15], s53 offen offset:2048 sc1
 buffer_load_dwordx4 a[60:63], v4, s[12:15], s53 offen offset:3072 sc1
 s_waitcnt vmcnt(41)
 v_mfma_f32_16x16x32_bf16 v[144:147], v[32:35], v[128:131], v[144:147]
 v_mfma_f32_16x16x32_bf16 v[148:151], v[32:35], v[132:135], v[148:151]
 v_mfma_f32_16x16x32_bf16 v[152:155], v[36:39], v[128:131], v[152:155]
 v_mfma_f32_16x16x32_bf16 v[156:159], v[36:39], v[132:135], v[156:159]
 v_mfma_f32_16x16x32_bf16 v[160:163], v[40:43], v[128:131], v[160:163]
 v_mfma_f32_16x16x32_bf16 v[164:167], v[40:43], v[132:135], v[164:167]
 v_mfma_f32_16x16x32_bf16 v[168:171], v[44:47], v[128:131], v[168:171]
 v_mfma_f32_16x16x32_bf16 v[172:175], v[44:47], v[132:135], v[172:175]
 buffer_load_dwordx4 v[32:35], v22, s[16:19], s48 offen offset:0 sc1
 buffer_load_dwordx4 v[36:39], v22, s[16:19], s48 offen offset:256 sc1
 buffer_load_dwordx4 v[40:43], v22, s[16:19], s48 offen offset:512 sc1
 buffer_load_dwordx4 v[44:47], v22, s[16:19], s48 offen offset:768 sc1
 s_add_u32 s48, s48, 40960
 s_waitcnt vmcnt(41)
 v_mfma_f32_16x16x32_bf16 v[148:151], a[64:67], v[96:99], v[148:151]
 v_mfma_f32_16x16x32_bf16 v[144:147], a[64:67], v[100:103], v[144:147]
 v_mfma_f32_16x16x32_bf16 v[156:159], a[68:71], v[96:99], v[156:159]
 v_mfma_f32_16x16x32_bf16 v[152:155], a[68:71], v[100:103], v[152:155]
 v_mfma_f32_16x16x32_bf16 v[164:167], a[72:75], v[96:99], v[164:167]
 v_mfma_f32_16x16x32_bf16 v[160:163], a[72:75], v[100:103], v[160:163]
 v_mfma_f32_16x16x32_bf16 v[172:175], a[76:79], v[96:99], v[172:175]
 v_mfma_f32_16x16x32_bf16 v[168:171], a[76:79], v[100:103], v[168:171]
 s_add_u32 s53, s53, 40960
 buffer_load_dwordx4 a[64:67], v4, s[12:15], s53 offen offset:0 sc1
 buffer_load_dwordx4 a[68:71], v4, s[12:15], s53 offen offset:1024 sc1
 buffer_load_dwordx4 a[72:75], v4, s[12:15], s53 offen offset:2048 sc1
 buffer_load_dwordx4 a[76:79], v4, s[12:15], s53 offen offset:3072 sc1
 s_waitcnt vmcnt(41)
 v_mfma_f32_16x16x32_bf16 v[148:151], a[80:83], v[104:107], v[148:151]
 v_mfma_f32_16x16x32_bf16 v[144:147], a[80:83], v[108:111], v[144:147]
 v_mfma_f32_16x16x32_bf16 v[156:159], a[84:87], v[104:107], v[156:159]
 v_mfma_f32_16x16x32_bf16 v[152:155], a[84:87], v[108:111], v[152:155]
 v_mfma_f32_16x16x32_bf16 v[164:167], a[88:91], v[104:107], v[164:167]
 v_mfma_f32_16x16x32_bf16 v[160:163], a[88:91], v[108:111], v[160:163]
 v_mfma_f32_16x16x32_bf16 v[172:175], a[92:95], v[104:107], v[172:175]
 v_mfma_f32_16x16x32_bf16 v[168:171], a[92:95], v[108:111], v[168:171]
 s_add_u32 s53, s53, 40960
 buffer_load_dwordx4 a[80:83], v4, s[12:15], s53 offen offset:0 sc1
 buffer_load_dwordx4 a[84:87], v4, s[12:15], s53 offen offset:1024 sc1
 buffer_load_dwordx4 a[88:91], v4, s[12:15], s53 offen offset:2048 sc1
 buffer_load_dwordx4 a[92:95], v4, s[12:15], s53 offen offset:3072 sc1
 s_waitcnt vmcnt(41)
 v_mfma_f32_16x16x32_bf16 v[148:151], a[96:99], v[112:115], v[148:151]
 v_mfma_f32_16x16x32_bf16 v[144:147], a[96:99], v[116:119], v[144:147]
 v_mfma_f32_16x16x32_bf16 v[156:159], a[100:103], v[112:115], v[156:159]
 v_mfma_f32_16x16x32_bf16 v[152:155], a[100:103], v[116:119], v[152:155]
 v_mfma_f32_16x16x32_bf16 v[164:167], a[104:107], v[112:115], v[164:167]
 v_mfma_f32_16x16x32_bf16 v[160:163], a[104:107], v[116:119], v[160:163]
 v_mfma_f32_16x16x32_bf16 v[172:175], a[108:111], v[112:115], v[172:175]
 v_mfma_f32_16x16x32_bf16 v[168:171], a[108:111], v[116:119], v[168:171]
 s_add_u32 s53, s53, 40960
 buffer_load_dwordx4 a[96:99], v4, s[12:15], s53 offen offset:0 sc1
 buffer_load_dwordx4 a[100:103], v4, s[12:15], s53 offen offset:1024 sc1
 buffer_load_dwordx4 a[104:107], v4, s[12:15], s53 offen offset:2048 sc1
 buffer_load_dwordx4 a[108:111], v4, s[12:15], s53 offen offset:3072 sc1
 s_waitcnt vmcnt(41)
 v_mfma_f32_16x16x32_bf16 v[148:151], a[112:115], v[120:123], v[148:151]
 v_mfma_f32_16x16x32_bf16 v[144:147], a[112:115], v[124:127], v[144:147]
 v_mfma_f32_16x16x32_bf16 v[156:159], a[116:119], v[120:123], v[156:159]
 v_mfma_f32_16x16x32_bf16 v[152:155], a[116:119], v[124:127], v[152:155]
 v_mfma_f32_16x16x32_bf16 v[164:167], a[120:123], v[120:123], v[164:167]
 v_mfma_f32_16x16x32_bf16 v[160:163], a[120:123], v[124:127], v[160:163]
 v_mfma_f32_16x16x32_bf16 v[172:175], a[124:127], v[120:123], v[172:175]
 v_mfma_f32_16x16x32_bf16 v[168:171], a[124:127], v[124:127], v[168:171]
 s_add_u32 s53, s53, 40960
 buffer_load_dwordx4 a[112:115], v4, s[12:15], s53 offen offset:0 sc1
 buffer_load_dwordx4 a[116:119], v4, s[12:15], s53 offen offset:1024 sc1
 buffer_load_dwordx4 a[120:123], v4, s[12:15], s53 offen offset:2048 sc1
 buffer_load_dwordx4 a[124:127], v4, s[12:15], s53 offen offset:3072 sc1
 s_waitcnt vmcnt(41)
 v_mfma_f32_16x16x32_bf16 v[144:147], v[48:51], v[136:139], v[144:147]
 v_mfma_f32_16x16x32_bf16 v[148:151], v[48:51], v[140:143], v[148:151]
 v_mfma_f32_16x16x32_bf16 v[152:155], v[52:55], v[136:139], v[152:155]
 v_mfma_f32_16x16x32_bf16 v[156:159], v[52:55], v[140:143], v[156:159]
 v_mfma_f32_16x16x32_bf16 v[160:163], v[56:59], v[136:139], v[160:163]
 v_mfma_f32_16x16x32_bf16 v[164:167], v[56:59], v[140:143], v[164:167]
 v_mfma_f32_16x16x32_bf16 v[168:171], v[60:63], v[136:139], v[168:171]
 v_mfma_f32_16x16x32_bf16 v[172:175], v[60:63], v[140:143], v[172:175]
 buffer_load_dwordx4 v[48:51], v22, s[16:19], s48 offen offset:0 sc1
 buffer_load_dwordx4 v[52:55], v22, s[16:19], s48 offen offset:256 sc1
 buffer_load_dwordx4 v[56:59], v22, s[16:19], s48 offen offset:512 sc1
 buffer_load_dwordx4 v[60:63], v22, s[16:19], s48 offen offset:768 sc1
 s_add_u32 s48, s48, 40960
 s_waitcnt vmcnt(40)
 s_branch pvy_273
pvy_272:
 s_waitcnt vmcnt(41)
 v_mfma_f32_16x16x32_bf16 v[148:151], a[0:3], v[64:67], 0
 v_mfma_f32_16x16x32_bf16 v[144:147], a[0:3], v[68:71], 0
 v_mfma_f32_16x16x32_bf16 v[156:159], a[4:7], v[64:67], 0
 v_mfma_f32_16x16x32_bf16 v[152:155], a[4:7], v[68:71], 0
 v_mfma_f32_16x16x32_bf16 v[164:167], a[8:11], v[64:67], 0
 v_mfma_f32_16x16x32_bf16 v[160:163], a[8:11], v[68:71], 0
 v_mfma_f32_16x16x32_bf16 v[172:175], a[12:15], v[64:67], 0
 v_mfma_f32_16x16x32_bf16 v[168:171], a[12:15], v[68:71], 0
 s_waitcnt vmcnt(37)
 v_mfma_f32_16x16x32_bf16 v[148:151], a[16:19], v[72:75], v[148:151]
 v_mfma_f32_16x16x32_bf16 v[144:147], a[16:19], v[76:79], v[144:147]
 v_mfma_f32_16x16x32_bf16 v[156:159], a[20:23], v[72:75], v[156:159]
 v_mfma_f32_16x16x32_bf16 v[152:155], a[20:23], v[76:79], v[152:155]
 v_mfma_f32_16x16x32_bf16 v[164:167], a[24:27], v[72:75], v[164:167]
 v_mfma_f32_16x16x32_bf16 v[160:163], a[24:27], v[76:79], v[160:163]
 v_mfma_f32_16x16x32_bf16 v[172:175], a[28:31], v[72:75], v[172:175]
 v_mfma_f32_16x16x32_bf16 v[168:171], a[28:31], v[76:79], v[168:171]
 s_waitcnt vmcnt(33)
 v_mfma_f32_16x16x32_bf16 v[148:151], a[32:35], v[80:83], v[148:151]
 v_mfma_f32_16x16x32_bf16 v[144:147], a[32:35], v[84:87], v[144:147]
 v_mfma_f32_16x16x32_bf16 v[156:159], a[36:39], v[80:83], v[156:159]
 v_mfma_f32_16x16x32_bf16 v[152:155], a[36:39], v[84:87], v[152:155]
 v_mfma_f32_16x16x32_bf16 v[164:167], a[40:43], v[80:83], v[164:167]
 v_mfma_f32_16x16x32_bf16 v[160:163], a[40:43], v[84:87], v[160:163]
 v_mfma_f32_16x16x32_bf16 v[172:175], a[44:47], v[80:83], v[172:175]
 v_mfma_f32_16x16x32_bf16 v[168:171], a[44:47], v[84:87], v[168:171]
 s_waitcnt vmcnt(29)
 v_mfma_f32_16x16x32_bf16 v[148:151], a[48:51], v[88:91], v[148:151]
 v_mfma_f32_16x16x32_bf16 v[144:147], a[48:51], v[92:95], v[144:147]
 v_mfma_f32_16x16x32_bf16 v[156:159], a[52:55], v[88:91], v[156:159]
 v_mfma_f32_16x16x32_bf16 v[152:155], a[52:55], v[92:95], v[152:155]
 v_mfma_f32_16x16x32_bf16 v[164:167], a[56:59], v[88:91], v[164:167]
 v_mfma_f32_16x16x32_bf16 v[160:163], a[56:59], v[92:95], v[160:163]
 v_mfma_f32_16x16x32_bf16 v[172:175], a[60:63], v[88:91], v[172:175]
 v_mfma_f32_16x16x32_bf16 v[168:171], a[60:63], v[92:95], v[168:171]
 s_waitcnt vmcnt(25)
 v_mfma_f32_16x16x32_bf16 v[144:147], v[32:35], v[128:131], v[144:147]
 v_mfma_f32_16x16x32_bf16 v[148:151], v[32:35], v[132:135], v[148:151]
 v_mfma_f32_16x16x32_bf16 v[152:155], v[36:39], v[128:131], v[152:155]
 v_mfma_f32_16x16x32_bf16 v[156:159], v[36:39], v[132:135], v[156:159]
 v_mfma_f32_16x16x32_bf16 v[160:163], v[40:43], v[128:131], v[160:163]
 v_mfma_f32_16x16x32_bf16 v[164:167], v[40:43], v[132:135], v[164:167]
 v_mfma_f32_16x16x32_bf16 v[168:171], v[44:47], v[128:131], v[168:171]
 v_mfma_f32_16x16x32_bf16 v[172:175], v[44:47], v[132:135], v[172:175]
 s_waitcnt vmcnt(21)
 v_mfma_f32_16x16x32_bf16 v[148:151], a[64:67], v[96:99], v[148:151]
 v_mfma_f32_16x16x32_bf16 v[144:147], a[64:67], v[100:103], v[144:147]
 v_mfma_f32_16x16x32_bf16 v[156:159], a[68:71], v[96:99], v[156:159]
 v_mfma_f32_16x16x32_bf16 v[152:155], a[68:71], v[100:103], v[152:155]
 v_mfma_f32_16x16x32_bf16 v[164:167], a[72:75], v[96:99], v[164:167]
 v_mfma_f32_16x16x32_bf16 v[160:163], a[72:75], v[100:103], v[160:163]
 v_mfma_f32_16x16x32_bf16 v[172:175], a[76:79], v[96:99], v[172:175]
 v_mfma_f32_16x16x32_bf16 v[168:171], a[76:79], v[100:103], v[168:171]
 s_waitcnt vmcnt(17)
 v_mfma_f32_16x16x32_bf16 v[148:151], a[80:83], v[104:107], v[148:151]
 v_mfma_f32_16x16x32_bf16 v[144:147], a[80:83], v[108:111], v[144:147]
 v_mfma_f32_16x16x32_bf16 v[156:159], a[84:87], v[104:107], v[156:159]
 v_mfma_f32_16x16x32_bf16 v[152:155], a[84:87], v[108:111], v[152:155]
 v_mfma_f32_16x16x32_bf16 v[164:167], a[88:91], v[104:107], v[164:167]
 v_mfma_f32_16x16x32_bf16 v[160:163], a[88:91], v[108:111], v[160:163]
 v_mfma_f32_16x16x32_bf16 v[172:175], a[92:95], v[104:107], v[172:175]
 v_mfma_f32_16x16x32_bf16 v[168:171], a[92:95], v[108:111], v[168:171]
 s_waitcnt vmcnt(13)
 v_mfma_f32_16x16x32_bf16 v[148:151], a[96:99], v[112:115], v[148:151]
 v_mfma_f32_16x16x32_bf16 v[144:147], a[96:99], v[116:119], v[144:147]
 v_mfma_f32_16x16x32_bf16 v[156:159], a[100:103], v[112:115], v[156:159]
 v_mfma_f32_16x16x32_bf16 v[152:155], a[100:103], v[116:119], v[152:155]
 v_mfma_f32_16x16x32_bf16 v[164:167], a[104:107], v[112:115], v[164:167]
 v_mfma_f32_16x16x32_bf16 v[160:163], a[104:107], v[116:119], v[160:163]
 v_mfma_f32_16x16x32_bf16 v[172:175], a[108:111], v[112:115], v[172:175]
 v_mfma_f32_16x16x32_bf16 v[168:171], a[108:111], v[116:119], v[168:171]
 s_waitcnt vmcnt(9)
 v_mfma_f32_16x16x32_bf16 v[148:151], a[112:115], v[120:123], v[148:151]
 v_mfma_f32_16x16x32_bf16 v[144:147], a[112:115], v[124:127], v[144:147]
 v_mfma_f32_16x16x32_bf16 v[156:159], a[116:119], v[120:123], v[156:159]
 v_mfma_f32_16x16x32_bf16 v[152:155], a[116:119], v[124:127], v[152:155]
 v_mfma_f32_16x16x32_bf16 v[164:167], a[120:123], v[120:123], v[164:167]
 v_mfma_f32_16x16x32_bf16 v[160:163], a[120:123], v[124:127], v[160:163]
 v_mfma_f32_16x16x32_bf16 v[172:175], a[124:127], v[120:123], v[172:175]
 v_mfma_f32_16x16x32_bf16 v[168:171], a[124:127], v[124:127], v[168:171]
 s_waitcnt vmcnt(5)
 v_mfma_f32_16x16x32_bf16 v[144:147], v[48:51], v[136:139], v[144:147]
 v_mfma_f32_16x16x32_bf16 v[148:151], v[48:51], v[140:143], v[148:151]
 v_mfma_f32_16x16x32_bf16 v[152:155], v[52:55], v[136:139], v[152:155]
 v_mfma_f32_16x16x32_bf16 v[156:159], v[52:55], v[140:143], v[156:159]
 v_mfma_f32_16x16x32_bf16 v[160:163], v[56:59], v[136:139], v[160:163]
 v_mfma_f32_16x16x32_bf16 v[164:167], v[56:59], v[140:143], v[164:167]
 v_mfma_f32_16x16x32_bf16 v[168:171], v[60:63], v[136:139], v[168:171]
 v_mfma_f32_16x16x32_bf16 v[172:175], v[60:63], v[140:143], v[172:175]
 s_waitcnt vmcnt(0)
pvy_273:
 v_sub_f32 v25, 1.0, v24
 v_cvt_pk_bf16_f32 v26, v25, v25
 v_lshlrev_b32 v25, 16, v26
 v_cvt_pk_bf16_f32 v26, v12, v12
 v_lshlrev_b32 v12, 16, v26
 v_cvt_pk_bf16_f32 v26, v13, v13
 v_lshlrev_b32 v13, 16, v26
 v_cvt_pk_bf16_f32 v26, v14, v14
 v_lshlrev_b32 v14, 16, v26
 v_cvt_pk_bf16_f32 v26, v15, v15
 v_lshlrev_b32 v15, 16, v26
 v_cvt_pk_bf16_f32 v26, v16, v16
 v_lshlrev_b32 v16, 16, v26
 v_cvt_pk_bf16_f32 v26, v17, v17
 v_lshlrev_b32 v17, 16, v26
 v_cvt_pk_bf16_f32 v26, v18, v18
 v_lshlrev_b32 v18, 16, v26
 v_cvt_pk_bf16_f32 v26, v19, v19
 v_lshlrev_b32 v19, 16, v26
 v_mul_f32 v12, v12, v25
 v_cvt_pk_bf16_f32 v26, v12, v12
 v_lshlrev_b32 v12, 16, v26
 v_mul_f32 v13, v13, v25
 v_cvt_pk_bf16_f32 v26, v13, v13
 v_lshlrev_b32 v13, 16, v26
 v_mul_f32 v14, v14, v25
 v_cvt_pk_bf16_f32 v26, v14, v14
 v_lshlrev_b32 v14, 16, v26
 v_mul_f32 v15, v15, v25
 v_cvt_pk_bf16_f32 v26, v15, v15
 v_lshlrev_b32 v15, 16, v26
 v_mul_f32 v16, v16, v25
 v_cvt_pk_bf16_f32 v26, v16, v16
 v_lshlrev_b32 v16, 16, v26
 v_mul_f32 v17, v17, v25
 v_cvt_pk_bf16_f32 v26, v17, v17
 v_lshlrev_b32 v17, 16, v26
 v_mul_f32 v18, v18, v25
 v_cvt_pk_bf16_f32 v26, v18, v18
 v_lshlrev_b32 v18, 16, v26
 v_mul_f32 v19, v19, v25
 v_cvt_pk_bf16_f32 v26, v19, v19
 v_lshlrev_b32 v19, 16, v26
 ds_write_b128 v10, v[144:147] offset:0
 ds_write_b128 v10, v[148:151] offset:1024
 ds_write_b128 v10, v[152:155] offset:2048
 ds_write_b128 v10, v[156:159] offset:3072
 ds_write_b128 v10, v[160:163] offset:4096
 ds_write_b128 v10, v[164:167] offset:5120
 ds_write_b128 v10, v[168:171] offset:6144
 ds_write_b128 v10, v[172:175] offset:7168
 s_waitcnt lgkmcnt(0)
 s_barrier
 ds_read_b128 v[176:179], v11 offset:0
 ds_read_b128 v[180:183], v11 offset:8192
 ds_read_b128 v[184:187], v11 offset:16384
 ds_read_b128 v[188:191], v11 offset:24576
 ds_read_b128 v[192:195], v11 offset:4096
 ds_read_b128 v[196:199], v11 offset:12288
 ds_read_b128 v[200:203], v11 offset:20480
 ds_read_b128 v[204:207], v11 offset:28672
 s_cmp_ge_u32 s40, 32
 s_cbranch_scc1 pvr_274
 s_waitcnt lgkmcnt(4)
 v_pk_add_f32 v[176:177], v[176:177], v[180:181]
 v_pk_add_f32 v[184:185], v[184:185], v[188:189]
 v_pk_add_f32 v[178:179], v[178:179], v[182:183]
 v_pk_add_f32 v[186:187], v[186:187], v[190:191]
 v_pk_add_f32 v[176:177], v[176:177], v[184:185]
 v_pk_add_f32 v[178:179], v[178:179], v[186:187]
 buffer_store_dwordx4 v[176:179], v4, s[24:27], s54 offen offset:0 sc1
 s_waitcnt lgkmcnt(0)
 v_pk_add_f32 v[192:193], v[192:193], v[196:197]
 v_pk_add_f32 v[200:201], v[200:201], v[204:205]
 v_pk_add_f32 v[194:195], v[194:195], v[198:199]
 v_pk_add_f32 v[202:203], v[202:203], v[206:207]
 v_pk_add_f32 v[192:193], v[192:193], v[200:201]
 v_pk_add_f32 v[194:195], v[194:195], v[202:203]
 buffer_store_dwordx4 v[192:195], v4, s[24:27], s54 offen offset:2048 sc1
 s_lshr_b32 s71, s40, 2
 s_lshl_b32 s71, s71, 7
 s_add_u32 s71, s71, 115712
 s_branch pvr_275
pvr_274:
 s_waitcnt lgkmcnt(4)
 v_pk_add_f32 v[176:177], v[176:177], v[180:181]
 v_pk_add_f32 v[184:185], v[184:185], v[188:189]
 v_pk_add_f32 v[178:179], v[178:179], v[182:183]
 v_pk_add_f32 v[186:187], v[186:187], v[190:191]
 v_pk_add_f32 v[176:177], v[176:177], v[184:185]
 v_pk_add_f32 v[178:179], v[178:179], v[186:187]
 v_cvt_pk_bf16_f32 v26, v176, v177
 v_lshlrev_b32 v176, 16, v26
 v_and_b32 v177, 0xffff0000, v26
 v_mul_f32 v176, v176, v24
 v_mul_f32 v177, v177, v24
 v_cvt_pk_bf16_f32 v26, v176, v177
 v_lshlrev_b32 v176, 16, v26
 v_and_b32 v177, 0xffff0000, v26
 v_add_f32 v176, v176, v12
 v_add_f32 v177, v177, v13
 v_cvt_pk_bf16_f32 v180, v176, v177
 v_cvt_pk_bf16_f32 v26, v178, v179
 v_lshlrev_b32 v178, 16, v26
 v_and_b32 v179, 0xffff0000, v26
 v_mul_f32 v178, v178, v24
 v_mul_f32 v179, v179, v24
 v_cvt_pk_bf16_f32 v26, v178, v179
 v_lshlrev_b32 v178, 16, v26
 v_and_b32 v179, 0xffff0000, v26
 v_add_f32 v178, v178, v14
 v_add_f32 v179, v179, v15
 v_cvt_pk_bf16_f32 v181, v178, v179
 buffer_store_dwordx2 v[180:181], v9, s[8:11], s46 offen offset:0
 s_waitcnt lgkmcnt(0)
 v_pk_add_f32 v[192:193], v[192:193], v[196:197]
 v_pk_add_f32 v[200:201], v[200:201], v[204:205]
 v_pk_add_f32 v[194:195], v[194:195], v[198:199]
 v_pk_add_f32 v[202:203], v[202:203], v[206:207]
 v_pk_add_f32 v[192:193], v[192:193], v[200:201]
 v_pk_add_f32 v[194:195], v[194:195], v[202:203]
 v_cvt_pk_bf16_f32 v26, v192, v193
 v_lshlrev_b32 v192, 16, v26
 v_and_b32 v193, 0xffff0000, v26
 v_mul_f32 v192, v192, v24
 v_mul_f32 v193, v193, v24
 v_cvt_pk_bf16_f32 v26, v192, v193
 v_lshlrev_b32 v192, 16, v26
 v_and_b32 v193, 0xffff0000, v26
 v_add_f32 v192, v192, v16
 v_add_f32 v193, v193, v17
 v_cvt_pk_bf16_f32 v196, v192, v193
 v_cvt_pk_bf16_f32 v26, v194, v195
 v_lshlrev_b32 v194, 16, v26
 v_and_b32 v195, 0xffff0000, v26
 v_mul_f32 v194, v194, v24
 v_mul_f32 v195, v195, v24
 v_cvt_pk_bf16_f32 v26, v194, v195
 v_lshlrev_b32 v194, 16, v26
 v_and_b32 v195, 0xffff0000, v26
 v_add_f32 v194, v194, v18
 v_add_f32 v195, v195, v19
 v_cvt_pk_bf16_f32 v197, v194, v195
 buffer_store_dwordx2 v[196:197], v9, s[8:11], s46 offen offset:64
pvr_275:
 s_branch pvy_270
pvy_271:
 s_sub_u32 s21, s2, 0
 s_cmp_ge_u32 s21, 640
 s_cbranch_scc1 lc_276
 s_cmp_lg_u32 s20, 0
 s_cbranch_scc1 lc_276x
 s_waitcnt vmcnt(2)
 s_mov_b64 exec, 1
 ds_write_b32 v30, v29 offset:12
 s_mov_b64 exec, -1
lc_276x:
 s_waitcnt lgkmcnt(0)
 s_barrier
 ds_read_b32 v23, v30 offset:12
lc_276:
 s_waitcnt lgkmcnt(0)
 v_readfirstlane_b32 s2, v23
 v_readfirstlane_b32 s67, v213
 s_barrier
 s_cmp_lt_u32 s2, 236
 s_cbranch_scc1 pae_277
 s_waitcnt vmcnt(0)
 s_cmp_eq_u32 s71, 0
 s_cbranch_scc1 paf_278
 v_mov_b32 v25, 0
 v_mov_b32 v26, 1
 s_mov_b64 exec, 1
 buffer_atomic_add v26, v25, s[72:75], s71 offen sc1
 s_mov_b64 exec, -1
 s_mov_b32 s71, 0
paf_278:
pae_277:
 s_add_u32 s21, s2, 0
 s_cmp_lt_u32 s2, 164
 s_cbranch_scc1 pv_loop
 s_sub_u32 s2, s2, 164
 s_add_u32 s21, s2, 204
 s_cmp_lt_u32 s2, 32
 s_cbranch_scc1 pv_loop
 s_sub_u32 s2, s2, 32
 s_add_u32 s21, s2, 164
 s_cmp_lt_u32 s2, 40
 s_cbranch_scc1 pv_loop
 s_sub_u32 s2, s2, 40
 s_branch main_fin
 s_branch queue
main_fin:
 s_waitcnt vmcnt(0)
main_end:
 s_endpgm
code_end:
.section .rodata,"a"
.p2align 6
.amdhsa_kernel gated_mix__memory_aug_recurrent_mem_tr__sliding_local_dilated__prompt_kernel
  .amdhsa_next_free_vgpr 512
  .amdhsa_next_free_sgpr 102
  .amdhsa_accum_offset 256
  .amdhsa_group_segment_fixed_size 0
  .amdhsa_kernarg_size 112
  .amdhsa_user_sgpr_count 2
  .amdhsa_user_sgpr_kernarg_segment_ptr 1
  .amdhsa_system_sgpr_workgroup_id_x 1
.end_amdhsa_kernel
.text
```

```asm
; @launch kernel=gated_mix__memory_aug_recurrent_mem_tr__sliding_local_dilated__prompt_kernel grid=(256,1,1) block=(256,1,1) lds=163840
.amdgcn_target "amdgcn-amd-amdhsa--gfx950"
.text
.globl gated_mix__memory_aug_recurrent_mem_tr__sliding_local_dilated__prompt_kernel
.p2align 8
.type gated_mix__memory_aug_recurrent_mem_tr__sliding_local_dilated__prompt_kernel,@function
gated_mix__memory_aug_recurrent_mem_tr__sliding_local_dilated__prompt_kernel:
 s_cmp_ge_u32 s2, 256
 s_cbranch_scc1 end0
 s_load_dwordx2 s[4:5], s[0:1], 96
 s_load_dwordx2 s[38:39], s[0:1], 104
 v_lshrrev_b32 v1, 6, v0
 v_and_b32 v2, 15, v0
 v_readfirstlane_b32 s20, v1
 v_and_b32 v1, 63, v0
 v_lshrrev_b32 v3, 4, v1
 s_getreg_b32 s50, hwreg(HW_REG_XCC_ID)
 s_and_b32 s50, s50, 7
 s_waitcnt lgkmcnt(0)
 s_mov_b32 s32, s4
 s_mov_b32 s33, s5
 s_mov_b32 s34, 256
 s_mov_b32 s35, 0x00020000
 s_getpc_b64 s[6:7]
cpf_pc:
 s_sub_u32 s6, s6, cpf_pc - gated_mix__memory_aug_recurrent_mem_tr__sliding_local_dilated__prompt_kernel
 s_subb_u32 s7, s7, 0
 s_lshr_b32 s21, s2, 3
 s_lshl_b32 s21, s21, 12
 v_lshl_add_u32 v28, v0, 4, s21
 v_min_u32 v28, code_end - gated_mix__memory_aug_recurrent_mem_tr__sliding_local_dilated__prompt_kernel - 16, v28
 global_load_dwordx4 a[252:255], v28, s[6:7]
 v_lshl_add_u32 v28, v0, 4, s21
 v_add_u32 v28, 0x20000, v28
 v_min_u32 v28, code_end - gated_mix__memory_aug_recurrent_mem_tr__sliding_local_dilated__prompt_kernel - 16, v28
 global_load_dwordx4 a[252:255], v28, s[6:7]
 v_mov_b32 v21, 0
 s_cmp_lg_u32 s20, 0
 s_cbranch_scc1 rk_1
 s_and_b32 s21, s50, 1
 s_lshl_b32 s21, s21, 7
 s_lshl_b32 s22, s50, 1
 s_and_b32 s22, s22, 12
 s_add_u32 s21, s21, s22
 v_mov_b32 v22, s21
 v_mov_b32 v23, 1
 s_mov_b64 exec, 1
 buffer_atomic_add v23, v22, s[32:35], 0 offen sc0 sc1
 s_waitcnt vmcnt(0)
 v_readfirstlane_b32 s51, v23
 s_lshl_b32 s22, s50, 5
 s_add_u32 s22, s22, s51
 s_cmp_lt_u32 s51, 32
 s_cbranch_scc1 rk_2
 v_mov_b32 v24, 72
 v_mov_b32 v25, 1
 buffer_atomic_add v25, v24, s[32:35], 0 offen sc0 sc1
 s_waitcnt vmcnt(0)
 v_readfirstlane_b32 s23, v25
 s_mov_b32 s101, 0
 s_mov_b64 exec, -1
 v_lshlrev_b32 v24, 2, v1
rk_3:
 s_sleep 8
 buffer_load_dword v25, v24, s[32:35], 0 offen sc1
 s_add_u32 s101, s101, 1
 s_cmp_gt_u32 s101, 131072
 s_cbranch_scc1 end0
 s_waitcnt vmcnt(0)
 v_readlane_b32 s21, v25, 0
 v_readlane_b32 s22, v25, 32
 s_add_u32 s21, s21, s22
 v_readlane_b32 s22, v25, 1
 s_add_u32 s21, s21, s22
 v_readlane_b32 s22, v25, 33
 s_add_u32 s21, s21, s22
 v_readlane_b32 s22, v25, 2
 s_add_u32 s21, s21, s22
 v_readlane_b32 s22, v25, 34
 s_add_u32 s21, s21, s22
 v_readlane_b32 s22, v25, 3
 s_add_u32 s21, s21, s22
 v_readlane_b32 s22, v25, 35
 s_add_u32 s21, s21, s22
 s_cmp_lt_u32 s21, 256
 s_cbranch_scc1 rk_3
 s_mov_b64 exec, 1
 s_mov_b32 s24, 0
rk_5:
 s_and_b32 s21, s24, 1
 s_lshl_b32 s21, s21, 5
 s_lshr_b32 s22, s24, 1
 s_add_u32 s21, s21, s22
 v_readlane_b32 s21, v25, s21
 s_min_u32 s21, s21, 32
 s_sub_u32 s25, 32, s21
 s_cmp_lt_u32 s23, s25
 s_cbranch_scc1 rk_4
 s_sub_u32 s23, s23, s25
 s_add_u32 s24, s24, 1
 s_cmp_lt_u32 s24, 8
 s_cbranch_scc1 rk_5
 s_branch end0
rk_4:
 s_lshl_b32 s22, s24, 5
 s_add_u32 s22, s22, s21
 s_add_u32 s22, s22, s23
 s_or_b32 s22, s22, 0x100
rk_2:
 v_mov_b32 v23, s22
 ds_write_b32 v21, v23
 s_waitcnt lgkmcnt(0)
 s_mov_b64 exec, -1
rk_1:
 s_barrier
 ds_read_b32 v23, v21
 s_waitcnt lgkmcnt(0)
 v_readfirstlane_b32 s22, v23
 s_barrier
 s_mov_b32 s84, 0
 s_mov_b32 s85, -1
 s_lshr_b32 s53, s22, 8
 s_and_b32 s22, s22, 255
 s_cmp_ge_u32 s22, 128
 s_cbranch_scc1 gemm_side
 s_lshr_b32 s50, s22, 4
 s_and_b32 s51, s22, 15
 s_mov_b32 s86, 0x3dd53b95
 s_load_dwordx2 s[4:5], s[0:1], 8
 s_load_dwordx4 s[36:39], s[0:1], 16
 s_load_dwordx4 s[40:43], s[0:1], 32
 s_load_dwordx2 s[44:45], s[0:1], 104
 s_lshr_b32 s55, s51, 2
 s_and_b32 s56, s51, 3
 s_lshl_b32 s57, s50, 2
 s_add_u32 s58, s57, s55
 s_add_u32 s59, s57, s20
 s_lshr_b32 s21, s51, 1
 s_xor_b32 s21, s21, s55
 s_andn2_b32 s21, 1, s21
 s_xor_b32 s85, s51, s21
 s_mul_i32 s87, s85, 5
 s_lshr_b32 s87, s87, 1
 s_and_b32 s79, s85, 1
 s_waitcnt lgkmcnt(0)
 s_add_u32 s8, s44, 78643200
 s_addc_u32 s9, s45, 0
 s_mov_b32 s10, 2162688
 s_mov_b32 s11, 0x00020000
 s_mov_b32 s16, s44
 s_mov_b32 s17, s45
 s_mov_b32 s18, 50331648
 s_mov_b32 s19, 0x00020000
 s_add_u32 s24, s44, 180355072
 s_addc_u32 s25, s45, 0
 s_mov_b32 s26, 67108864
 s_mov_b32 s27, 0x00020000
 s_mov_b32 s28, s4
 s_mov_b32 s29, s5
 s_mov_b32 s30, 10240
 s_mov_b32 s31, 0x00020000
 s_add_u32 s4, s44, 83886079
 s_addc_u32 s5, s45, 0
 s_and_b32 s4, s4, 0xffe00000
 s_or_b32 s4, s4, 262144
 s_mov_b32 s6, 131072
 s_mov_b32 s7, 0x00020000
 v_mov_b32 v27, 10923
 v_add_u32 v54, 0, v1
 v_mul_u32_u24 v53, v54, v27
 v_lshrrev_b32 v53, 16, v53
 v_mul_u32_u24 v52, 6, v53
 v_sub_u32 v54, v54, v52
 v_mul_u32_u24 v52, 1280, v53
 v_lshl_add_u32 v46, v54, 4, v52
 v_bfe_u32 v52, v53, 1, 1
 v_mul_u32_u24 v52, 20, v52
 v_and_b32 v51, 1, v53
 v_add_u32 v52, v52, v51
 v_lshrrev_b32 v51, 3, v53
 v_mul_u32_u24 v51, 40, v51
 v_bfe_u32 v50, v53, 2, 1
 v_lshl_add_u32 v51, v50, 1, v51
 v_add_u32 v51, v51, v52
 v_mul_u32_u24 v51, 12288, v51
 v_lshl_add_u32 v247, v54, 4, v51
 v_lshrrev_b32 v51, 4, v53
 v_mul_u32_u24 v51, 40, v51
 v_bfe_u32 v50, v53, 2, 2
 v_lshl_add_u32 v51, v50, 1, v51
 v_add_u32 v51, v51, v52
 v_mul_u32_u24 v51, 12288, v51
 v_lshl_add_u32 v244, v54, 4, v51
 v_add_u32 v54, 64, v1
 v_mul_u32_u24 v53, v54, v27
 v_lshrrev_b32 v53, 16, v53
 v_mul_u32_u24 v52, 6, v53
 v_sub_u32 v54, v54, v52
 v_mul_u32_u24 v52, 1280, v53
 v_lshl_add_u32 v47, v54, 4, v52
 v_bfe_u32 v52, v53, 1, 1
 v_mul_u32_u24 v52, 20, v52
 v_and_b32 v51, 1, v53
 v_add_u32 v52, v52, v51
 v_lshrrev_b32 v51, 3, v53
 v_mul_u32_u24 v51, 40, v51
 v_bfe_u32 v50, v53, 2, 1
 v_lshl_add_u32 v51, v50, 1, v51
 v_add_u32 v51, v51, v52
 v_mul_u32_u24 v51, 12288, v51
 v_lshl_add_u32 v248, v54, 4, v51
 v_lshrrev_b32 v51, 4, v53
 v_mul_u32_u24 v51, 40, v51
 v_bfe_u32 v50, v53, 2, 2
 v_lshl_add_u32 v51, v50, 1, v51
 v_add_u32 v51, v51, v52
 v_mul_u32_u24 v51, 12288, v51
 v_lshl_add_u32 v245, v54, 4, v51
 v_add_u32 v54, 128, v1
 v_mul_u32_u24 v53, v54, v27
 v_lshrrev_b32 v53, 16, v53
 v_mul_u32_u24 v52, 6, v53
 v_sub_u32 v54, v54, v52
 v_mul_u32_u24 v52, 1280, v53
 v_lshl_add_u32 v48, v54, 4, v52
 v_bfe_u32 v52, v53, 1, 1
 v_mul_u32_u24 v52, 20, v52
 v_and_b32 v51, 1, v53
 v_add_u32 v52, v52, v51
 v_lshrrev_b32 v51, 3, v53
 v_mul_u32_u24 v51, 40, v51
 v_bfe_u32 v50, v53, 2, 1
 v_lshl_add_u32 v51, v50, 1, v51
 v_add_u32 v51, v51, v52
 v_mul_u32_u24 v51, 12288, v51
 v_lshl_add_u32 v249, v54, 4, v51
 v_lshrrev_b32 v51, 4, v53
 v_mul_u32_u24 v51, 40, v51
 v_bfe_u32 v50, v53, 2, 2
 v_lshl_add_u32 v51, v50, 1, v51
 v_add_u32 v51, v51, v52
 v_mul_u32_u24 v51, 12288, v51
 v_lshl_add_u32 v246, v54, 4, v51
 s_mul_i32 s80, s58, 384
 s_mul_i32 s22, s56, 96
 s_add_u32 s80, s80, s22
 s_mul_i32 s22, s20, 1966080
 s_add_u32 s80, s80, s22
 s_mul_i32 s81, s20, 40448
 s_mul_i32 s82, s59, 245760
 s_lshl_b32 s22, s87, 5
 s_add_u32 s82, s82, s22
 s_mul_i32 s88, s59, 384
 s_mov_b32 s12, s42
 s_mov_b32 s13, s43
 s_mov_b32 s14, 7864320
 s_mov_b32 s15, 0x00020000
 s_add_u32 s21, s82, 0
 s_add_u32 m0, s81, 12288
 s_nop 0
 buffer_load_dwordx4 v46, s[12:15], s21 offen lds
 s_add_u32 m0, s81, 13312
 s_nop 0
 buffer_load_dwordx4 v47, s[12:15], s21 offen lds
 s_add_u32 m0, s81, 14336
 s_nop 0
 buffer_load_dwordx4 v48, s[12:15], s21 offen lds
 s_add_u32 s21, s82, 40960
 s_add_u32 m0, s81, 15360
 s_nop 0
 buffer_load_dwordx4 v46, s[12:15], s21 offen lds
 s_add_u32 m0, s81, 16384
 s_nop 0
 buffer_load_dwordx4 v47, s[12:15], s21 offen lds
 s_add_u32 m0, s81, 17408
 s_nop 0
 buffer_load_dwordx4 v48, s[12:15], s21 offen lds
 s_add_u32 s21, s82, 81920
 s_add_u32 m0, s81, 18432
 s_nop 0
 buffer_load_dwordx4 v46, s[12:15], s21 offen lds
 s_add_u32 m0, s81, 19456
 s_nop 0
 buffer_load_dwordx4 v47, s[12:15], s21 offen lds
 s_add_u32 m0, s81, 20480
 s_nop 0
 buffer_load_dwordx4 v48, s[12:15], s21 offen lds
 s_add_u32 s21, s82, 122880
 s_add_u32 m0, s81, 21504
 s_nop 0
 buffer_load_dwordx4 v46, s[12:15], s21 offen lds
 s_add_u32 m0, s81, 22528
 s_nop 0
 buffer_load_dwordx4 v47, s[12:15], s21 offen lds
 s_add_u32 m0, s81, 23552
 s_nop 0
 buffer_load_dwordx4 v48, s[12:15], s21 offen lds
 s_add_u32 s21, s82, 163840
 s_add_u32 m0, s81, 24576
 s_nop 0
 buffer_load_dwordx4 v46, s[12:15], s21 offen lds
 s_add_u32 m0, s81, 25600
 s_nop 0
 buffer_load_dwordx4 v47, s[12:15], s21 offen lds
 s_add_u32 m0, s81, 26624
 s_nop 0
 buffer_load_dwordx4 v48, s[12:15], s21 offen lds
 s_add_u32 s21, s82, 204800
 s_add_u32 m0, s81, 27648
 s_nop 0
 buffer_load_dwordx4 v46, s[12:15], s21 offen lds
 s_add_u32 m0, s81, 28672
 s_nop 0
 buffer_load_dwordx4 v47, s[12:15], s21 offen lds
 s_add_u32 m0, s81, 29696
 s_nop 0
 buffer_load_dwordx4 v48, s[12:15], s21 offen lds
 s_mov_b32 s12, s40
 s_mov_b32 s13, s41
 s_mov_b32 s14, 7864320
 s_mov_b32 s15, 0x00020000
 s_mov_b32 s40, s38
 s_mov_b32 s41, s39
 s_mov_b32 s38, 7864320
 s_mov_b32 s39, 0x00020000
 s_mov_b32 s42, s38
 s_mov_b32 s43, s39
 v_lshrrev_b32 v250, 2, v2
 v_lshl_add_u32 v250, v3, 3, v250
 v_mul_u32_u24 v250, 96, v250
 v_and_b32 v251, 3, v2
 v_lshlrev_b32 v251, 3, v251
 v_add3_u32 v250, v250, v251, s81
 v_lshlrev_b32 v251, 4, v1
 v_add_u32 v251, s81, v251
 v_lshlrev_b32 v26, 2, v1
 v_mov_b32 v27, 2731
 v_add_u32 v54, 0, v1
 v_mul_u32_u24 v53, v54, v27
 v_lshrrev_b32 v53, 16, v53
 v_mul_u32_u24 v52, 24, v53
 v_sub_u32 v54, v54, v52
 v_bfe_u32 v52, v53, 1, 1
 v_xor_b32 v54, v54, v52
 v_mul_u32_u24 v52, 20, v52
 v_and_b32 v51, 1, v53
 v_add_u32 v52, v52, v51
 v_lshrrev_b32 v51, 2, v53
 v_lshl_add_u32 v52, v51, 1, v52
 v_mul_u32_u24 v52, 12288, v52
 v_subrev_u32 v52, 0, v52
 v_lshl_add_u32 v28, v54, 4, v52
 v_xor_b32 v31, 32, v28
 v_xor_b32 v34, 64, v28
 v_xor_b32 v37, 96, v28
 v_add_u32 v54, 64, v1
 v_mul_u32_u24 v53, v54, v27
 v_lshrrev_b32 v53, 16, v53
 v_mul_u32_u24 v52, 24, v53
 v_sub_u32 v54, v54, v52
 v_bfe_u32 v52, v53, 1, 1
 v_xor_b32 v54, v54, v52
 v_mul_u32_u24 v52, 20, v52
 v_and_b32 v51, 1, v53
 v_add_u32 v52, v52, v51
 v_lshrrev_b32 v51, 2, v53
 v_lshl_add_u32 v52, v51, 1, v52
 v_mul_u32_u24 v52, 12288, v52
 v_subrev_u32 v52, 1024, v52
 v_lshl_add_u32 v29, v54, 4, v52
 v_xor_b32 v32, 32, v29
 v_xor_b32 v35, 64, v29
 v_xor_b32 v38, 96, v29
 v_add_u32 v54, 128, v1
 v_mul_u32_u24 v53, v54, v27
 v_lshrrev_b32 v53, 16, v53
 v_mul_u32_u24 v52, 24, v53
 v_sub_u32 v54, v54, v52
 v_bfe_u32 v52, v53, 1, 1
 v_xor_b32 v54, v54, v52
 v_mul_u32_u24 v52, 20, v52
 v_and_b32 v51, 1, v53
 v_add_u32 v52, v52, v51
 v_lshrrev_b32 v51, 2, v53
 v_lshl_add_u32 v52, v51, 1, v52
 v_mul_u32_u24 v52, 12288, v52
 v_subrev_u32 v52, 2048, v52
 v_lshl_add_u32 v30, v54, 4, v52
 v_xor_b32 v33, 32, v30
 v_xor_b32 v36, 64, v30
 v_xor_b32 v39, 96, v30
 s_add_u32 m0, s81, 0
 s_add_u32 s21, s88, 0
 buffer_load_dwordx4 v28, s[12:15], s21 offen offset:0 lds
 buffer_load_dwordx4 v29, s[12:15], s21 offen offset:1024 lds
 buffer_load_dwordx4 v30, s[12:15], s21 offen offset:2048 lds
 s_add_u32 m0, s81, 3072
 s_add_u32 s21, s88, 49152
 buffer_load_dwordx4 v31, s[12:15], s21 offen offset:0 lds
 buffer_load_dwordx4 v32, s[12:15], s21 offen offset:1024 lds
 buffer_load_dwordx4 v33, s[12:15], s21 offen offset:2048 lds
 s_add_u32 m0, s81, 6144
 s_add_u32 s21, s88, 491520
 buffer_load_dwordx4 v34, s[12:15], s21 offen offset:0 lds
 buffer_load_dwordx4 v35, s[12:15], s21 offen offset:1024 lds
 buffer_load_dwordx4 v36, s[12:15], s21 offen offset:2048 lds
 s_add_u32 m0, s81, 9216
 s_add_u32 s21, s88, 540672
 buffer_load_dwordx4 v37, s[12:15], s21 offen offset:0 lds
 buffer_load_dwordx4 v38, s[12:15], s21 offen offset:1024 lds
 buffer_load_dwordx4 v39, s[12:15], s21 offen offset:2048 lds
 s_add_u32 s22, s80, 0
 buffer_load_dwordx4 v[220:223], v244, s[40:43], s22 offen
 buffer_load_dwordx4 v[224:227], v245, s[40:43], s22 offen
 buffer_load_dwordx4 v[228:231], v246, s[40:43], s22 offen
 s_add_u32 s22, s80, 983040
 buffer_load_dwordx4 v[232:235], v244, s[40:43], s22 offen
 buffer_load_dwordx4 v[236:239], v245, s[40:43], s22 offen
 buffer_load_dwordx4 v[240:243], v246, s[40:43], s22 offen
 v_and_b32 v56, 7, v2
 v_lshrrev_b32 v57, 3, v2
 v_lshlrev_b32 v16, 4, v1
 s_lshr_b32 s21, s20, 1
 s_lshl_b32 s21, s21, 14
 s_and_b32 s22, s20, 1
 s_mul_i32 s22, s22, 3072
 s_add_u32 s21, s21, s22
 v_add_u32 v4, s21, v16
 v_mov_b32 v58, 0x4444
 v_mov_b32 v59, 0xeeee
 v_cmp_eq_u32 vcc, 1, v57
 s_nop 1
 v_cndmask_b32 v25, v58, v59, vcc
 v_mul_u32_u24 v58, 40, v2
 v_lshl_add_u32 v58, v3, 3, v58
 s_mul_i32 s21, s20, 1920
 v_add_u32 v5, s21, v58
 v_lshrrev_b32 v58, 2, v1
 v_mul_u32_u24 v58, 40, v58
 v_and_b32 v59, 3, v1
 v_lshl_add_u32 v6, v59, 3, v58
 v_bfe_u32 v59, v1, 1, 1
 v_mul_u32_u24 v59, 3824, v59
 v_add_u32 v21, v6, v59
 s_lshl_b32 s21, s50, 4
 s_add_u32 s21, s21, s51
 s_lshl_b32 s21, s21, 9
 s_lshl_b32 s22, s20, 7
 s_add_u32 s21, s21, s22
 s_add_u32 s21, s21, 81920
 v_and_b32 v58, 1, v3
 v_lshlrev_b32 v58, 8, v58
 v_lshl_add_u32 v58, v56, 4, v58
 v_lshrrev_b32 v59, 1, v3
 v_lshl_add_u32 v58, v59, 3, v58
 v_add_u32 v7, s21, v58
 s_lshl_b32 s22, s58, 9
 s_lshl_b32 s23, s56, 7
 s_add_u32 s22, s22, s23
 s_add_u32 s22, s22, 376704
 v_lshlrev_b32 v58, 6, v3
 v_lshl_add_u32 v58, v56, 3, v58
 v_add_u32 v58, s22, v58
 s_cmp_eq_u32 s20, 2
 s_cselect_b64 vcc, -1, 0
 v_cndmask_b32 v7, v7, v58, vcc
 s_lshl_b32 s21, s59, 11
 s_add_u32 s21, s21, 81920
 v_add_u32 v8, s21, v16
 s_lshl_b32 s21, s59, 9
 s_add_u32 s21, s21, 376832
 v_lshl_add_u32 v9, v1, 3, s21
 s_mul_i32 s21, s20, 3072
 s_add_u32 s21, s21, 24576
 v_and_b32 v58, 0x39, v1
 v_bfe_u32 v59, v1, 1, 1
 v_lshl_or_b32 v58, v59, 2, v58
 v_bfe_u32 v59, v1, 2, 1
 v_lshl_or_b32 v58, v59, 1, v58
 v_lshl_add_u32 v10, v58, 4, s21
 s_mul_i32 s22, s56, 12
 s_cmp_eq_u32 s20, 2
 s_cselect_b64 vcc, -1, 0
 v_add_u32 v58, s22, v3
 v_add3_u32 v59, 0, v58, v3
 v_lshrrev_b32 v60, 1, v59
 v_and_b32 v59, 1, v59
 v_lshlrev_b32 v59, 3, v59
 v_lshl_add_u32 v61, v60, 7, v59
 v_lshl_add_u32 v61, v56, 4, v61
 s_lshr_b32 s21, s58, 1
 s_lshl_b32 s21, s21, 14
 s_and_b32 s22, s58, 1
 s_mul_i32 s22, s22, 3072
 s_add_u32 s21, s21, s22
 s_add_u32 s21, s21, 655360
 v_add_u32 v62, s21, v61
 v_lshl_add_u32 v61, v60, 8, v59
 v_lshl_add_u32 v61, v2, 4, v61
 s_mul_i32 s21, s58, 12288
 s_and_b32 s22, s20, 1
 s_mul_i32 s22, s22, 6144
 s_add_u32 s21, s21, s22
 v_add_u32 v61, s21, v61
 v_cndmask_b32 v18, v61, v62, vcc
 v_add_u32 v59, 8, v58
 v_lshrrev_b32 v60, 1, v59
 v_and_b32 v59, 1, v59
 v_lshlrev_b32 v59, 3, v59
 v_lshl_add_u32 v61, v60, 7, v59
 v_lshl_add_u32 v61, v56, 4, v61
 s_lshr_b32 s21, s58, 1
 s_lshl_b32 s21, s21, 14
 s_and_b32 s22, s58, 1
 s_mul_i32 s22, s22, 3072
 s_add_u32 s21, s21, s22
 s_add_u32 s21, s21, 655360
 v_add_u32 v62, s21, v61
 v_lshl_add_u32 v61, v60, 8, v59
 v_lshl_add_u32 v61, v2, 4, v61
 s_mul_i32 s21, s58, 12288
 s_and_b32 s22, s20, 1
 s_mul_i32 s22, s22, 6144
 s_add_u32 s21, s21, s22
 v_add_u32 v61, s21, v61
 v_cndmask_b32 v19, v61, v62, vcc
 s_mul_i32 s21, s20, 3072
 s_add_u32 s21, s21, 8192
 v_add_u32 v11, s21, v16
 v_and_b32 v58, 3, v1
 s_lshl_b32 s21, s20, 2
 v_add_u32 v59, s21, v58
 v_cmp_eq_u32 vcc, 10, v59
 s_nop 1
 v_cndmask_b32 v59, v59, 7, vcc
 v_cmp_eq_u32 vcc, 3, v58
 v_lshrrev_b32 v60, 5, v1
 v_mul_u32_u24 v60, 10, v60
 v_cndmask_b32 v59, v59, 3, vcc
 s_lshl_b32 s21, s79, 2
 v_add3_u32 v59, v59, v60, s21
 v_lshrrev_b32 v60, 1, v59
 v_lshlrev_b32 v60, 8, v60
 v_and_b32 v59, 1, v59
 v_lshl_add_u32 v60, v59, 3, v60
 v_bfe_u32 v59, v1, 2, 3
 v_lshl_add_u32 v60, v59, 4, v60
 v_add_u32 v12, 8192, v60
 s_mov_b32 s21, 0x07060100
 s_cmp_eq_u32 s20, 1
 s_cselect_b32 s21, 0x07060302, s21
 s_cmp_eq_u32 s20, 2
 s_cselect_b32 s21, 0x07060c0c, s21
 v_mov_b32 v59, s21
 v_mov_b32 v60, 0x03020100
 v_cndmask_b32 v14, v60, v59, vcc
 s_lshr_b32 s21, s85, 3
 s_lshl_b32 s21, s21, 14
 s_bfe_u32 s22, s85, 0x10002
 s_mul_i32 s22, s22, 3072
 s_add_u32 s21, s21, s22
 s_and_b32 s22, s85, 3
 s_lshl_b32 s22, s22, 8
 s_add_u32 s21, s21, s22
 s_lshl_b32 s22, s20, 10
 s_add_u32 s22, s22, s21
 v_lshl_add_u32 v13, v1, 2, s22
 v_lshlrev_b32 v59, 10, v3
 v_lshl_add_u32 v59, v2, 4, v59
 v_add_u32 v59, s21, v59
 s_cmp_eq_u32 s20, 3
 s_cselect_b64 vcc, -1, 0
 v_cndmask_b32 v13, v13, v59, vcc
 s_mov_b32 s91, 0x3c000000
 v_and_b32 v59, 1, v3
 v_lshrrev_b32 v60, 1, v3
 v_lshl_add_u32 v59, v59, 1, v60
 v_add_u32 v59, s87, v59
 v_lshrrev_b32 v60, 2, v59
 v_and_b32 v59, 3, v59
 v_lshlrev_b32 v59, 8, v59
 v_lshl_add_u32 v59, v60, 16, v59
 v_lshl_add_u32 v59, v2, 4, v59
 s_lshr_b32 s21, s59, 3
 s_lshl_b32 s21, s21, 14
 s_and_b32 s22, s59, 7
 s_lshl_b32 s22, s22, 10
 s_add_u32 s21, s21, s22
 v_add_u32 v15, s21, v59
 s_lshl_b32 s21, s79, 4
 s_lshl_b32 s76, -1, s21
 s_mov_b32 s77, 0xffff
 s_lshl_b32 s21, s79, 7
 v_or_b32 v17, s21, v16
 s_or_b32 s21, s21, 0xffffff7f
 v_and_b32 v20, s21, v16
 v_lshlrev_b32 v24, 3, v1
 v_cmp_gt_u32 s[60:61], 8, v2
 v_cmp_le_u32 s[62:63], 8, v2
 v_cmp_le_u32 s[72:73], 2, v3
 v_cmp_gt_u32 s[70:71], 48, v1
 s_nop 1
 s_and_b64 s[64:65], s[60:61], s[72:73]
 s_cmp_eq_u32 s20, 2
 s_cselect_b64 s[74:75], s[64:65], s[60:61]
 s_waitcnt vmcnt(18)
 ds_read_b64_tr_b16 v[64:65], v250 offset:12288
 ds_read_b64_tr_b16 v[66:67], v250 offset:12672
 ds_read_b64_tr_b16 v[88:89], v250 offset:12320
 ds_read_b64_tr_b16 v[90:91], v250 offset:12704
 ds_read_b64_tr_b16 v[112:113], v250 offset:12352
 ds_read_b64_tr_b16 v[114:115], v250 offset:12736
 ds_read_b64_tr_b16 v[68:69], v250 offset:15360
 ds_read_b64_tr_b16 v[70:71], v250 offset:15744
 ds_read_b64_tr_b16 v[92:93], v250 offset:15392
 ds_read_b64_tr_b16 v[94:95], v250 offset:15776
 ds_read_b64_tr_b16 v[116:117], v250 offset:15424
 ds_read_b64_tr_b16 v[118:119], v250 offset:15808
 ds_read_b64_tr_b16 v[72:73], v250 offset:18432
 ds_read_b64_tr_b16 v[74:75], v250 offset:18816
 ds_read_b64_tr_b16 v[96:97], v250 offset:18464
 ds_read_b64_tr_b16 v[98:99], v250 offset:18848
 ds_read_b64_tr_b16 v[120:121], v250 offset:18496
 ds_read_b64_tr_b16 v[122:123], v250 offset:18880
 ds_read_b64_tr_b16 v[76:77], v250 offset:21504
 ds_read_b64_tr_b16 v[78:79], v250 offset:21888
 ds_read_b64_tr_b16 v[100:101], v250 offset:21536
 ds_read_b64_tr_b16 v[102:103], v250 offset:21920
 ds_read_b64_tr_b16 v[124:125], v250 offset:21568
 ds_read_b64_tr_b16 v[126:127], v250 offset:21952
 ds_read_b64_tr_b16 v[80:81], v250 offset:24576
 ds_read_b64_tr_b16 v[82:83], v250 offset:24960
 ds_read_b64_tr_b16 v[104:105], v250 offset:24608
 ds_read_b64_tr_b16 v[106:107], v250 offset:24992
 ds_read_b64_tr_b16 v[128:129], v250 offset:24640
 ds_read_b64_tr_b16 v[130:131], v250 offset:25024
 ds_read_b64_tr_b16 v[84:85], v250 offset:27648
 ds_read_b64_tr_b16 v[86:87], v250 offset:28032
 ds_read_b64_tr_b16 v[108:109], v250 offset:27680
 ds_read_b64_tr_b16 v[110:111], v250 offset:28064
 ds_read_b64_tr_b16 v[132:133], v250 offset:27712
 ds_read_b64_tr_b16 v[134:135], v250 offset:28096
 s_waitcnt lgkmcnt(0)
 s_add_u32 m0, s81, 12288
 s_add_u32 s21, s88, 983040
 buffer_load_dwordx4 v28, s[12:15], s21 offen offset:0 lds
 buffer_load_dwordx4 v29, s[12:15], s21 offen offset:1024 lds
 buffer_load_dwordx4 v30, s[12:15], s21 offen offset:2048 lds
 s_add_u32 m0, s81, 15360
 s_add_u32 s21, s88, 1032192
 buffer_load_dwordx4 v31, s[12:15], s21 offen offset:0 lds
 buffer_load_dwordx4 v32, s[12:15], s21 offen offset:1024 lds
 buffer_load_dwordx4 v33, s[12:15], s21 offen offset:2048 lds
 s_add_u32 m0, s81, 18432
 s_add_u32 s21, s88, 1474560
 buffer_load_dwordx4 v34, s[12:15], s21 offen offset:0 lds
 buffer_load_dwordx4 v35, s[12:15], s21 offen offset:1024 lds
 buffer_load_dwordx4 v36, s[12:15], s21 offen offset:2048 lds
 s_add_u32 m0, s81, 21504
 s_add_u32 s21, s88, 1523712
 buffer_load_dwordx4 v37, s[12:15], s21 offen offset:0 lds
 buffer_load_dwordx4 v38, s[12:15], s21 offen offset:1024 lds
 buffer_load_dwordx4 v39, s[12:15], s21 offen offset:2048 lds
 s_add_u32 m0, s81, 24576
 s_add_u32 s21, s88, 98304
 buffer_load_dwordx4 v28, s[12:15], s21 offen offset:0 lds
 buffer_load_dwordx4 v29, s[12:15], s21 offen offset:1024 lds
 buffer_load_dwordx4 v30, s[12:15], s21 offen offset:2048 lds
 s_add_u32 m0, s81, 27648
 s_add_u32 s21, s88, 147456
 buffer_load_dwordx4 v31, s[12:15], s21 offen offset:0 lds
 buffer_load_dwordx4 v32, s[12:15], s21 offen offset:1024 lds
 buffer_load_dwordx4 v33, s[12:15], s21 offen offset:2048 lds
 s_add_u32 m0, s81, 30720
 s_add_u32 s21, s88, 589824
 buffer_load_dwordx4 v34, s[12:15], s21 offen offset:0 lds
 buffer_load_dwordx4 v35, s[12:15], s21 offen offset:1024 lds
 buffer_load_dwordx4 v36, s[12:15], s21 offen offset:2048 lds
 s_add_u32 m0, s81, 33792
 s_add_u32 s21, s88, 638976
 buffer_load_dwordx4 v37, s[12:15], s21 offen offset:0 lds
 buffer_load_dwordx4 v38, s[12:15], s21 offen offset:1024 lds
 buffer_load_dwordx4 v39, s[12:15], s21 offen offset:2048 lds
 v_lshrrev_b32 v40, 2, v2
 v_and_b32 v41, 3, v2
 v_lshl_add_u32 v41, v40, 3, v41
 v_mul_u32_u24 v41, 384, v41
 v_add_u32 v41, s81, v41
 v_lshrrev_b32 v40, 1, v2
 v_xor_b32 v40, v40, v3
 v_lshl_add_u32 v22, v40, 4, v41
 v_xor_b32 v40, 4, v40
 v_lshl_add_u32 v23, v40, 4, v41
 s_mul_i32 s64, s59, 40960
 s_lshl_b32 s21, s87, 10
 s_add_u32 s64, s64, s21
 s_add_u32 s64, s64, 1310720
 s_lshl_b32 s79, s59, 7
 s_and_b32 s21, s51, 12
 s_lshl_b32 s21, s21, 10
 s_add_u32 s79, s79, s21
 s_add_u32 s79, s79, 95232
 s_lshl_b32 s90, s58, 7
 s_add_u32 s90, s90, 19456
 s_cmp_eq_u32 s56, 0
 s_cselect_b32 s66, s90, 0x80000000
 s_bfe_u32 s82, s50, 0x10001
 s_lshl_b32 s82, s82, 5
 s_lshr_b32 s21, s50, 2
 s_add_u32 s82, s82, s21
 s_and_b32 s83, s50, 1
 s_lshl_b32 s83, s83, 4
 s_add_u32 s83, s83, 16
 s_waitcnt vmcnt(30)
 ds_read_b128 v[136:139], v22 offset:0
 ds_read_b128 v[140:143], v23 offset:0
 ds_read_b128 v[144:147], v22 offset:128
 s_waitcnt lgkmcnt(2)
 v_mfma_f32_16x16x32_bf16 v[40:43], v[136:139], v[64:67], 0
 ds_read_b128 v[148:151], v23 offset:128
 s_waitcnt vmcnt(27)
 ds_write_b128 v251, v[220:223] offset:36864
 v_mfma_f32_16x16x32_bf16 v[48:51], v[136:139], v[88:91], 0
 ds_write_b128 v251, v[224:227] offset:37888
 ds_write_b128 v251, v[228:231] offset:38912
 ds_read_b64_tr_b16 v[208:209], v250 offset:36864
 v_mfma_f32_16x16x32_bf16 v[56:59], v[136:139], v[112:115], 0
 ds_read_b64_tr_b16 v[210:211], v250 offset:37248
 ds_read_b64_tr_b16 v[212:213], v250 offset:36896
 ds_read_b64_tr_b16 v[214:215], v250 offset:37280
 ds_read_b64_tr_b16 v[216:217], v250 offset:36928
 s_waitcnt lgkmcnt(10)
 v_mfma_f32_16x16x32_bf16 v[40:43], v[140:143], v[68:71], v[40:43]
 ds_read_b128 v[136:139], v22 offset:256
 ds_read_b64_tr_b16 v[218:219], v250 offset:37312
 s_add_u32 s22, s80, 98304
 buffer_load_dwordx4 v[220:223], v244, s[40:43], s22 offen
 v_mfma_f32_16x16x32_bf16 v[48:51], v[140:143], v[92:95], v[48:51]
 buffer_load_dwordx4 v[224:227], v245, s[40:43], s22 offen
 buffer_load_dwordx4 v[228:231], v246, s[40:43], s22 offen
 v_mfma_f32_16x16x32_bf16 v[56:59], v[140:143], v[116:119], v[56:59]
 s_waitcnt lgkmcnt(11)
 v_mfma_f32_16x16x32_bf16 v[40:43], v[144:147], v[72:75], v[40:43]
 ds_read_b128 v[140:143], v23 offset:256
 v_mfma_f32_16x16x32_bf16 v[48:51], v[144:147], v[96:99], v[48:51]
 v_mfma_f32_16x16x32_bf16 v[56:59], v[144:147], v[120:123], v[56:59]
 s_waitcnt lgkmcnt(11)
 v_mfma_f32_16x16x32_bf16 v[40:43], v[148:151], v[76:79], v[40:43]
 ds_read_b128 v[144:147], v22 offset:1536
 v_mfma_f32_16x16x32_bf16 v[48:51], v[148:151], v[100:103], v[48:51]
 s_waitcnt lgkmcnt(2)
 v_lshlrev_b32 v27, 16, v208
 v_and_b32 v208, 0xffff0000, v208
 v_cvt_pk_f16_f32 v208, v27, v208
 v_accvgpr_write_b32 a60, v208
 v_mfma_f32_16x16x32_bf16 v[56:59], v[148:151], v[124:127], v[56:59]
 v_lshlrev_b32 v27, 16, v209
 v_and_b32 v209, 0xffff0000, v209
 v_cvt_pk_f16_f32 v209, v27, v209
 v_accvgpr_write_b32 a61, v209
 s_waitcnt lgkmcnt(3)
 v_mfma_f32_16x16x32_bf16 v[40:43], v[136:139], v[80:83], v[40:43]
 ds_read_b128 v[148:151], v23 offset:1536
 v_lshlrev_b32 v27, 16, v210
 v_and_b32 v210, 0xffff0000, v210
 v_cvt_pk_f16_f32 v210, v27, v210
 v_accvgpr_write_b32 a62, v210
 v_mfma_f32_16x16x32_bf16 v[48:51], v[136:139], v[104:107], v[48:51]
 v_lshlrev_b32 v27, 16, v211
 v_and_b32 v211, 0xffff0000, v211
 v_cvt_pk_f16_f32 v211, v27, v211
 v_accvgpr_write_b32 a63, v211
 v_lshlrev_b32 v27, 16, v212
 v_mfma_f32_16x16x32_bf16 v[56:59], v[136:139], v[128:131], v[56:59]
 v_and_b32 v212, 0xffff0000, v212
 v_cvt_pk_f16_f32 v212, v27, v212
 v_accvgpr_write_b32 a80, v212
 v_lshlrev_b32 v27, 16, v213
 s_waitcnt lgkmcnt(2)
 v_mfma_f32_16x16x32_bf16 v[40:43], v[140:143], v[84:87], v[40:43]
 ds_read_b128 v[136:139], v22 offset:1664
 v_and_b32 v213, 0xffff0000, v213
 v_cvt_pk_f16_f32 v213, v27, v213
 v_accvgpr_write_b32 a81, v213
 v_lshlrev_b32 v27, 16, v214
 v_mfma_f32_16x16x32_bf16 v[48:51], v[140:143], v[108:111], v[48:51]
 v_and_b32 v214, 0xffff0000, v214
 v_cvt_pk_f16_f32 v214, v27, v214
 v_accvgpr_write_b32 a82, v214
 v_lshlrev_b32 v27, 16, v215
 v_and_b32 v215, 0xffff0000, v215
 v_mfma_f32_16x16x32_bf16 v[56:59], v[140:143], v[132:135], v[56:59]
 v_cvt_pk_f16_f32 v215, v27, v215
 v_accvgpr_write_b32 a83, v215
 v_lshlrev_b32 v27, 16, v216
 v_and_b32 v216, 0xffff0000, v216
 s_waitcnt lgkmcnt(2)
 v_mfma_f32_16x16x32_bf16 v[44:47], v[144:147], v[64:67], 0
 ds_read_b128 v[140:143], v23 offset:1664
 v_cvt_pk_f16_f32 v216, v27, v216
 v_accvgpr_write_b32 a100, v216
 v_lshlrev_b32 v27, 16, v217
 v_and_b32 v217, 0xffff0000, v217
 v_mfma_f32_16x16x32_bf16 v[52:55], v[144:147], v[88:91], 0
 v_cvt_pk_f16_f32 v217, v27, v217
 v_accvgpr_write_b32 a101, v217
 v_lshlrev_b32 v27, 16, v218
 v_and_b32 v218, 0xffff0000, v218
 v_cvt_pk_f16_f32 v218, v27, v218
 v_mfma_f32_16x16x32_bf16 v[60:63], v[144:147], v[112:115], 0
 v_accvgpr_write_b32 a102, v218
 v_lshlrev_b32 v27, 16, v219
 v_and_b32 v219, 0xffff0000, v219
 v_cvt_pk_f16_f32 v219, v27, v219
 s_waitcnt lgkmcnt(2)
 v_mfma_f32_16x16x32_bf16 v[44:47], v[148:151], v[68:71], v[44:47]
 ds_read_b128 v[144:147], v22 offset:1792
 v_cvt_pk_f16_f32 v40, v40, v41
 v_accvgpr_write_b32 a103, v219
 v_accvgpr_write_b32 a120, v40
 v_cvt_pk_f16_f32 v42, v42, v43
 v_mfma_f32_16x16x32_bf16 v[52:55], v[148:151], v[92:95], v[52:55]
 v_accvgpr_write_b32 a121, v42
 v_cvt_pk_f16_f32 v48, v48, v49
 v_accvgpr_write_b32 a128, v48
 v_cvt_pk_f16_f32 v50, v50, v51
 v_accvgpr_write_b32 a129, v50
 v_mfma_f32_16x16x32_bf16 v[60:63], v[148:151], v[116:119], v[60:63]
 v_cvt_pk_f16_f32 v56, v56, v57
 v_accvgpr_write_b32 a136, v56
 v_cvt_pk_f16_f32 v58, v58, v59
 v_accvgpr_write_b32 a137, v58
 s_waitcnt lgkmcnt(2)
 v_mfma_f32_16x16x32_bf16 v[44:47], v[136:139], v[72:75], v[44:47]
 ds_read_b128 v[148:151], v23 offset:1792
 v_mfma_f32_16x16x32_bf16 v[52:55], v[136:139], v[96:99], v[52:55]
 v_mfma_f32_16x16x32_bf16 v[60:63], v[136:139], v[120:123], v[60:63]
 s_waitcnt lgkmcnt(2)
 v_mfma_f32_16x16x32_bf16 v[44:47], v[140:143], v[76:79], v[44:47]
 s_waitcnt vmcnt(15)
 ds_read_b128 v[136:139], v22 offset:12288
 v_mfma_f32_16x16x32_bf16 v[52:55], v[140:143], v[100:103], v[52:55]
 v_mfma_f32_16x16x32_bf16 v[60:63], v[140:143], v[124:127], v[60:63]
 s_waitcnt lgkmcnt(2)
 v_mfma_f32_16x16x32_bf16 v[44:47], v[144:147], v[80:83], v[44:47]
 ds_read_b128 v[140:143], v23 offset:12288
 v_mfma_f32_16x16x32_bf16 v[52:55], v[144:147], v[104:107], v[52:55]
 v_mfma_f32_16x16x32_bf16 v[60:63], v[144:147], v[128:131], v[60:63]
 s_waitcnt lgkmcnt(2)
 v_mfma_f32_16x16x32_bf16 v[44:47], v[148:151], v[84:87], v[44:47]
 ds_read_b128 v[144:147], v22 offset:12416
 s_add_u32 m0, s81, 0
 s_add_u32 s21, s88, 1081344
 v_mfma_f32_16x16x32_bf16 v[52:55], v[148:151], v[108:111], v[52:55]
 buffer_load_dwordx4 v28, s[12:15], s21 offen offset:0 lds
 v_mfma_f32_16x16x32_bf16 v[60:63], v[148:151], v[132:135], v[60:63]
 buffer_load_dwordx4 v29, s[12:15], s21 offen offset:1024 lds
 s_waitcnt lgkmcnt(2)
 v_mfma_f32_16x16x32_bf16 v[40:43], v[136:139], v[64:67], 0
 ds_read_b128 v[148:151], v23 offset:12416
 buffer_load_dwordx4 v30, s[12:15], s21 offen offset:2048 lds
 s_waitcnt vmcnt(30)
 v_mfma_f32_16x16x32_bf16 v[48:51], v[136:139], v[88:91], 0
 s_add_u32 m0, s81, 3072
 s_add_u32 s21, s88, 1130496
 ds_write_b128 v251, v[232:235] offset:36864
 v_mfma_f32_16x16x32_bf16 v[56:59], v[136:139], v[112:115], 0
 buffer_load_dwordx4 v31, s[12:15], s21 offen offset:0 lds
 ds_write_b128 v251, v[236:239] offset:37888
 s_waitcnt lgkmcnt(4)
 v_mfma_f32_16x16x32_bf16 v[40:43], v[140:143], v[68:71], v[40:43]
 ds_read_b128 v[136:139], v22 offset:12544
 v_cvt_pk_f16_f32 v44, v44, v45
 buffer_load_dwordx4 v32, s[12:15], s21 offen offset:1024 lds
 v_accvgpr_write_b32 a122, v44
 v_mfma_f32_16x16x32_bf16 v[48:51], v[140:143], v[92:95], v[48:51]
 v_cvt_pk_f16_f32 v46, v46, v47
 buffer_load_dwordx4 v33, s[12:15], s21 offen offset:2048 lds
 ds_write_b128 v251, v[240:243] offset:38912
 v_mfma_f32_16x16x32_bf16 v[56:59], v[140:143], v[116:119], v[56:59]
 v_accvgpr_write_b32 a123, v46
 s_add_u32 m0, s81, 6144
 s_add_u32 s21, s88, 1572864
 ds_read_b64_tr_b16 v[208:209], v250 offset:36864
 s_waitcnt lgkmcnt(6)
 v_mfma_f32_16x16x32_bf16 v[40:43], v[144:147], v[72:75], v[40:43]
 ds_read_b128 v[140:143], v23 offset:12544
 v_cvt_pk_f16_f32 v52, v52, v53
 buffer_load_dwordx4 v34, s[12:15], s21 offen offset:0 lds
 ds_read_b64_tr_b16 v[210:211], v250 offset:37248
 v_mfma_f32_16x16x32_bf16 v[48:51], v[144:147], v[96:99], v[48:51]
 v_accvgpr_write_b32 a130, v52
 buffer_load_dwordx4 v35, s[12:15], s21 offen offset:1024 lds
 ds_read_b64_tr_b16 v[212:213], v250 offset:36896
 ds_read_b64_tr_b16 v[214:215], v250 offset:37280
 v_mfma_f32_16x16x32_bf16 v[56:59], v[144:147], v[120:123], v[56:59]
 v_cvt_pk_f16_f32 v54, v54, v55
 buffer_load_dwordx4 v36, s[12:15], s21 offen offset:2048 lds
 ds_read_b64_tr_b16 v[216:217], v250 offset:36928
 s_waitcnt lgkmcnt(10)
 v_mfma_f32_16x16x32_bf16 v[40:43], v[148:151], v[76:79], v[40:43]
 ds_read_b128 v[144:147], v22 offset:13824
 v_accvgpr_write_b32 a131, v54
 s_add_u32 m0, s81, 9216
 s_add_u32 s21, s88, 1622016
 ds_read_b64_tr_b16 v[218:219], v250 offset:37312
 v_mfma_f32_16x16x32_bf16 v[48:51], v[148:151], v[100:103], v[48:51]
 v_cvt_pk_f16_f32 v60, v60, v61
 buffer_load_dwordx4 v37, s[12:15], s21 offen offset:0 lds
 s_add_u32 s22, s80, 1081344
 v_accvgpr_write_b32 a138, v60
 v_mfma_f32_16x16x32_bf16 v[56:59], v[148:151], v[124:127], v[56:59]
 v_cvt_pk_f16_f32 v62, v62, v63
 buffer_load_dwordx4 v38, s[12:15], s21 offen offset:1024 lds
 v_accvgpr_write_b32 a139, v62
 s_waitcnt lgkmcnt(9)
 v_mfma_f32_16x16x32_bf16 v[40:43], v[136:139], v[80:83], v[40:43]
 ds_read_b128 v[148:151], v23 offset:13824
 buffer_load_dwordx4 v39, s[12:15], s21 offen offset:2048 lds
 buffer_load_dwordx4 v[232:235], v244, s[40:43], s22 offen
 v_mfma_f32_16x16x32_bf16 v[48:51], v[136:139], v[104:107], v[48:51]
 buffer_load_dwordx4 v[236:239], v245, s[40:43], s22 offen
 buffer_load_dwordx4 v[240:243], v246, s[40:43], s22 offen
 v_mfma_f32_16x16x32_bf16 v[56:59], v[136:139], v[128:131], v[56:59]
 s_waitcnt lgkmcnt(7)
 v_mfma_f32_16x16x32_bf16 v[40:43], v[140:143], v[84:87], v[40:43]
 ds_read_b128 v[136:139], v22 offset:13952
 v_mfma_f32_16x16x32_bf16 v[48:51], v[140:143], v[108:111], v[48:51]
 v_mfma_f32_16x16x32_bf16 v[56:59], v[140:143], v[132:135], v[56:59]
 s_waitcnt lgkmcnt(3)
 v_mfma_f32_16x16x32_bf16 v[44:47], v[144:147], v[64:67], 0
 ds_read_b128 v[140:143], v23 offset:13952
 v_mfma_f32_16x16x32_bf16 v[52:55], v[144:147], v[88:91], 0
 s_waitcnt lgkmcnt(3)
 v_lshlrev_b32 v27, 16, v208
 v_and_b32 v208, 0xffff0000, v208
 v_cvt_pk_f16_f32 v208, v27, v208
 v_accvgpr_write_b32 a64, v208
 v_mfma_f32_16x16x32_bf16 v[60:63], v[144:147], v[112:115], 0
 v_lshlrev_b32 v27, 16, v209
 v_and_b32 v209, 0xffff0000, v209
 v_cvt_pk_f16_f32 v209, v27, v209
 v_accvgpr_write_b32 a65, v209
 s_waitcnt lgkmcnt(2)
 v_mfma_f32_16x16x32_bf16 v[44:47], v[148:151], v[68:71], v[44:47]
 ds_read_b128 v[144:147], v22 offset:14080
 v_cvt_pk_f16_f32 v40, v40, v41
 v_lshlrev_b32 v27, 16, v210
 v_and_b32 v210, 0xffff0000, v210
 v_cvt_pk_f16_f32 v210, v27, v210
 v_mfma_f32_16x16x32_bf16 v[52:55], v[148:151], v[92:95], v[52:55]
 v_accvgpr_write_b32 a124, v40
 v_accvgpr_write_b32 a66, v210
 v_lshlrev_b32 v27, 16, v211
 v_and_b32 v211, 0xffff0000, v211
 v_cvt_pk_f16_f32 v211, v27, v211
 v_mfma_f32_16x16x32_bf16 v[60:63], v[148:151], v[116:119], v[60:63]
 v_cvt_pk_f16_f32 v42, v42, v43
 v_accvgpr_write_b32 a67, v211
 v_lshlrev_b32 v27, 16, v212
 v_and_b32 v212, 0xffff0000, v212
 s_waitcnt lgkmcnt(2)
 v_mfma_f32_16x16x32_bf16 v[44:47], v[136:139], v[72:75], v[44:47]
 ds_read_b128 v[148:151], v23 offset:14080
 v_accvgpr_write_b32 a125, v42
 v_cvt_pk_f16_f32 v212, v27, v212
 v_accvgpr_write_b32 a84, v212
 v_lshlrev_b32 v27, 16, v213
 v_mfma_f32_16x16x32_bf16 v[52:55], v[136:139], v[96:99], v[52:55]
 v_cvt_pk_f16_f32 v48, v48, v49
 v_and_b32 v213, 0xffff0000, v213
 v_cvt_pk_f16_f32 v213, v27, v213
 v_accvgpr_write_b32 a85, v213
 v_lshlrev_b32 v27, 16, v214
 v_mfma_f32_16x16x32_bf16 v[60:63], v[136:139], v[120:123], v[60:63]
 v_accvgpr_write_b32 a132, v48
 v_and_b32 v214, 0xffff0000, v214
 v_cvt_pk_f16_f32 v214, v27, v214
 v_accvgpr_write_b32 a86, v214
 s_waitcnt lgkmcnt(2)
 v_mfma_f32_16x16x32_bf16 v[44:47], v[140:143], v[76:79], v[44:47]
 s_waitcnt vmcnt(18)
 ds_read_b128 v[136:139], v22 offset:24576
 v_cvt_pk_f16_f32 v50, v50, v51
 v_lshlrev_b32 v27, 16, v215
 v_and_b32 v215, 0xffff0000, v215
 v_cvt_pk_f16_f32 v215, v27, v215
 v_mfma_f32_16x16x32_bf16 v[52:55], v[140:143], v[100:103], v[52:55]
 v_accvgpr_write_b32 a133, v50
 v_accvgpr_write_b32 a87, v215
 v_lshlrev_b32 v27, 16, v216
 v_and_b32 v216, 0xffff0000, v216
 v_cvt_pk_f16_f32 v216, v27, v216
 v_mfma_f32_16x16x32_bf16 v[60:63], v[140:143], v[124:127], v[60:63]
 v_cvt_pk_f16_f32 v56, v56, v57
 v_accvgpr_write_b32 a104, v216
 v_lshlrev_b32 v27, 16, v217
 v_and_b32 v217, 0xffff0000, v217
 s_waitcnt lgkmcnt(2)
 v_mfma_f32_16x16x32_bf16 v[44:47], v[144:147], v[80:83], v[44:47]
 ds_read_b128 v[140:143], v23 offset:24576
 v_accvgpr_write_b32 a140, v56
 v_cvt_pk_f16_f32 v217, v27, v217
 v_accvgpr_write_b32 a105, v217
 v_lshlrev_b32 v27, 16, v218
 v_mfma_f32_16x16x32_bf16 v[52:55], v[144:147], v[104:107], v[52:55]
 v_cvt_pk_f16_f32 v58, v58, v59
 v_and_b32 v218, 0xffff0000, v218
 v_cvt_pk_f16_f32 v218, v27, v218
 v_accvgpr_write_b32 a106, v218
 v_lshlrev_b32 v27, 16, v219
 v_mfma_f32_16x16x32_bf16 v[60:63], v[144:147], v[128:131], v[60:63]
 v_accvgpr_write_b32 a141, v58
 v_and_b32 v219, 0xffff0000, v219
 v_cvt_pk_f16_f32 v219, v27, v219
 v_accvgpr_write_b32 a107, v219
 s_waitcnt lgkmcnt(2)
 v_mfma_f32_16x16x32_bf16 v[44:47], v[148:151], v[84:87], v[44:47]
 ds_read_b128 v[144:147], v22 offset:24704
 s_add_u32 m0, s81, 12288
 s_add_u32 s21, s88, 1966080
 v_mfma_f32_16x16x32_bf16 v[52:55], v[148:151], v[108:111], v[52:55]
 buffer_load_dwordx4 v28, s[12:15], s21 offen offset:0 lds
 v_mfma_f32_16x16x32_bf16 v[60:63], v[148:151], v[132:135], v[60:63]
 buffer_load_dwordx4 v29, s[12:15], s21 offen offset:1024 lds
 s_waitcnt lgkmcnt(2)
 v_mfma_f32_16x16x32_bf16 v[40:43], v[136:139], v[64:67], 0
 ds_read_b128 v[148:151], v23 offset:24704
 buffer_load_dwordx4 v30, s[12:15], s21 offen offset:2048 lds
 s_waitcnt vmcnt(18)
 v_mfma_f32_16x16x32_bf16 v[48:51], v[136:139], v[88:91], 0
 s_add_u32 m0, s81, 15360
 s_add_u32 s21, s88, 2015232
 ds_write_b128 v251, v[220:223] offset:36864
 v_mfma_f32_16x16x32_bf16 v[56:59], v[136:139], v[112:115], 0
 buffer_load_dwordx4 v31, s[12:15], s21 offen offset:0 lds
 ds_write_b128 v251, v[224:227] offset:37888
 s_waitcnt lgkmcnt(4)
 v_mfma_f32_16x16x32_bf16 v[40:43], v[140:143], v[68:71], v[40:43]
 ds_read_b128 v[136:139], v22 offset:24832
 v_cvt_pk_f16_f32 v44, v44, v45
 buffer_load_dwordx4 v32, s[12:15], s21 offen offset:1024 lds
 v_accvgpr_write_b32 a126, v44
 v_mfma_f32_16x16x32_bf16 v[48:51], v[140:143], v[92:95], v[48:51]
 v_cvt_pk_f16_f32 v46, v46, v47
 buffer_load_dwordx4 v33, s[12:15], s21 offen offset:2048 lds
 ds_write_b128 v251, v[228:231] offset:38912
 v_mfma_f32_16x16x32_bf16 v[56:59], v[140:143], v[116:119], v[56:59]
 v_accvgpr_write_b32 a127, v46
 s_add_u32 m0, s81, 18432
 s_add_u32 s21, s88, 2457600
 ds_read_b64_tr_b16 v[208:209], v250 offset:36864
 s_waitcnt lgkmcnt(6)
 v_mfma_f32_16x16x32_bf16 v[40:43], v[144:147], v[72:75], v[40:43]
 ds_read_b128 v[140:143], v23 offset:24832
 v_cvt_pk_f16_f32 v52, v52, v53
 buffer_load_dwordx4 v34, s[12:15], s21 offen offset:0 lds
 ds_read_b64_tr_b16 v[210:211], v250 offset:37248
 v_mfma_f32_16x16x32_bf16 v[48:51], v[144:147], v[96:99], v[48:51]
 v_accvgpr_write_b32 a134, v52
 buffer_load_dwordx4 v35, s[12:15], s21 offen offset:1024 lds
 ds_read_b64_tr_b16 v[212:213], v250 offset:36896
 ds_read_b64_tr_b16 v[214:215], v250 offset:37280
 v_mfma_f32_16x16x32_bf16 v[56:59], v[144:147], v[120:123], v[56:59]
 v_cvt_pk_f16_f32 v54, v54, v55
 buffer_load_dwordx4 v36, s[12:15], s21 offen offset:2048 lds
 ds_read_b64_tr_b16 v[216:217], v250 offset:36928
 s_waitcnt lgkmcnt(10)
 v_mfma_f32_16x16x32_bf16 v[40:43], v[148:151], v[76:79], v[40:43]
 ds_read_b128 v[144:147], v22 offset:26112
 v_accvgpr_write_b32 a135, v54
 s_add_u32 m0, s81, 21504
 s_add_u32 s21, s88, 2506752
 ds_read_b64_tr_b16 v[218:219], v250 offset:37312
 v_mfma_f32_16x16x32_bf16 v[48:51], v[148:151], v[100:103], v[48:51]
 v_cvt_pk_f16_f32 v60, v60, v61
 buffer_load_dwordx4 v37, s[12:15], s21 offen offset:0 lds
 s_add_u32 s22, s80, 196608
 v_accvgpr_write_b32 a142, v60
 v_mfma_f32_16x16x32_bf16 v[56:59], v[148:151], v[124:127], v[56:59]
 v_cvt_pk_f16_f32 v62, v62, v63
 buffer_load_dwordx4 v38, s[12:15], s21 offen offset:1024 lds
 v_accvgpr_write_b32 a143, v62
 s_waitcnt lgkmcnt(9)
 v_mfma_f32_16x16x32_bf16 v[40:43], v[136:139], v[80:83], v[40:43]
 ds_read_b128 v[148:151], v23 offset:26112
 buffer_load_dwordx4 v39, s[12:15], s21 offen offset:2048 lds
 buffer_load_dwordx4 v[220:223], v247, s[40:43], s22 offen
 v_mfma_f32_16x16x32_bf16 v[48:51], v[136:139], v[104:107], v[48:51]
 buffer_load_dwordx4 v[224:227], v248, s[40:43], s22 offen
 buffer_load_dwordx4 v[228:231], v249, s[40:43], s22 offen
 v_mfma_f32_16x16x32_bf16 v[56:59], v[136:139], v[128:131], v[56:59]
 s_waitcnt lgkmcnt(7)
 v_mfma_f32_16x16x32_bf16 v[40:43], v[140:143], v[84:87], v[40:43]
 ds_read_b128 v[136:139], v22 offset:26240
 v_mfma_f32_16x16x32_bf16 v[48:51], v[140:143], v[108:111], v[48:51]
 v_mfma_f32_16x16x32_bf16 v[56:59], v[140:143], v[132:135], v[56:59]
 s_waitcnt lgkmcnt(3)
 v_mfma_f32_16x16x32_bf16 v[44:47], v[144:147], v[64:67], 0
 ds_read_b128 v[140:143], v23 offset:26240
 v_mfma_f32_16x16x32_bf16 v[52:55], v[144:147], v[88:91], 0
 s_waitcnt lgkmcnt(3)
 v_lshlrev_b32 v27, 16, v208
 v_and_b32 v208, 0xffff0000, v208
 v_cvt_pk_f16_f32 v208, v27, v208
 v_accvgpr_write_b32 a68, v208
 v_mfma_f32_16x16x32_bf16 v[60:63], v[144:147], v[112:115], 0
 v_lshlrev_b32 v27, 16, v209
 v_and_b32 v209, 0xffff0000, v209
 v_cvt_pk_f16_f32 v209, v27, v209
 v_accvgpr_write_b32 a69, v209
 s_waitcnt lgkmcnt(2)
 v_mfma_f32_16x16x32_bf16 v[44:47], v[148:151], v[68:71], v[44:47]
 ds_read_b128 v[144:147], v22 offset:26368
 v_cvt_pk_f16_f32 v40, v40, v41
 v_lshlrev_b32 v27, 16, v210
 v_and_b32 v210, 0xffff0000, v210
 v_cvt_pk_f16_f32 v210, v27, v210
 v_mfma_f32_16x16x32_bf16 v[52:55], v[148:151], v[92:95], v[52:55]
 v_accvgpr_write_b32 a144, v40
 v_accvgpr_write_b32 a70, v210
 v_lshlrev_b32 v27, 16, v211
 v_and_b32 v211, 0xffff0000, v211
 v_cvt_pk_f16_f32 v211, v27, v211
 v_mfma_f32_16x16x32_bf16 v[60:63], v[148:151], v[116:119], v[60:63]
 v_cvt_pk_f16_f32 v42, v42, v43
 v_accvgpr_write_b32 a71, v211
 v_lshlrev_b32 v27, 16, v212
 v_and_b32 v212, 0xffff0000, v212
 s_waitcnt lgkmcnt(2)
 v_mfma_f32_16x16x32_bf16 v[44:47], v[136:139], v[72:75], v[44:47]
 ds_read_b128 v[148:151], v23 offset:26368
 v_accvgpr_write_b32 a145, v42
 v_cvt_pk_f16_f32 v212, v27, v212
 v_accvgpr_write_b32 a88, v212
 v_lshlrev_b32 v27, 16, v213
 v_mfma_f32_16x16x32_bf16 v[52:55], v[136:139], v[96:99], v[52:55]
 v_cvt_pk_f16_f32 v48, v48, v49
 v_and_b32 v213, 0xffff0000, v213
 v_cvt_pk_f16_f32 v213, v27, v213
 v_accvgpr_write_b32 a89, v213
 v_lshlrev_b32 v27, 16, v214
 v_mfma_f32_16x16x32_bf16 v[60:63], v[136:139], v[120:123], v[60:63]
 v_accvgpr_write_b32 a152, v48
 v_and_b32 v214, 0xffff0000, v214
 v_cvt_pk_f16_f32 v214, v27, v214
 v_accvgpr_write_b32 a90, v214
 s_waitcnt lgkmcnt(2)
 v_mfma_f32_16x16x32_bf16 v[44:47], v[140:143], v[76:79], v[44:47]
 s_waitcnt vmcnt(18)
 ds_read_b128 v[136:139], v22 offset:0
 v_cvt_pk_f16_f32 v50, v50, v51
 v_lshlrev_b32 v27, 16, v215
 v_and_b32 v215, 0xffff0000, v215
 v_cvt_pk_f16_f32 v215, v27, v215
 v_mfma_f32_16x16x32_bf16 v[52:55], v[140:143], v[100:103], v[52:55]
 v_accvgpr_write_b32 a153, v50
 v_accvgpr_write_b32 a91, v215
 v_lshlrev_b32 v27, 16, v216
 v_and_b32 v216, 0xffff0000, v216
 v_cvt_pk_f16_f32 v216, v27, v216
 v_mfma_f32_16x16x32_bf16 v[60:63], v[140:143], v[124:127], v[60:63]
 v_cvt_pk_f16_f32 v56, v56, v57
 v_accvgpr_write_b32 a108, v216
 v_lshlrev_b32 v27, 16, v217
 v_and_b32 v217, 0xffff0000, v217
 s_waitcnt lgkmcnt(2)
 v_mfma_f32_16x16x32_bf16 v[44:47], v[144:147], v[80:83], v[44:47]
 ds_read_b128 v[140:143], v23 offset:0
 v_accvgpr_write_b32 a160, v56
 v_cvt_pk_f16_f32 v217, v27, v217
 v_accvgpr_write_b32 a109, v217
 v_lshlrev_b32 v27, 16, v218
 v_mfma_f32_16x16x32_bf16 v[52:55], v[144:147], v[104:107], v[52:55]
 v_cvt_pk_f16_f32 v58, v58, v59
 v_and_b32 v218, 0xffff0000, v218
 v_cvt_pk_f16_f32 v218, v27, v218
 v_accvgpr_write_b32 a110, v218
 v_lshlrev_b32 v27, 16, v219
 v_mfma_f32_16x16x32_bf16 v[60:63], v[144:147], v[128:131], v[60:63]
 v_accvgpr_write_b32 a161, v58
 v_and_b32 v219, 0xffff0000, v219
 v_cvt_pk_f16_f32 v219, v27, v219
 v_accvgpr_write_b32 a111, v219
 s_waitcnt lgkmcnt(2)
 v_mfma_f32_16x16x32_bf16 v[44:47], v[148:151], v[84:87], v[44:47]
 ds_read_b128 v[144:147], v22 offset:128
 s_add_u32 m0, s81, 24576
 s_add_u32 s21, s88, 2949120
 v_mfma_f32_16x16x32_bf16 v[52:55], v[148:151], v[108:111], v[52:55]
 buffer_load_dwordx4 v28, s[12:15], s21 offen offset:0 lds
 v_mfma_f32_16x16x32_bf16 v[60:63], v[148:151], v[132:135], v[60:63]
 buffer_load_dwordx4 v29, s[12:15], s21 offen offset:1024 lds
 s_waitcnt lgkmcnt(2)
 v_mfma_f32_16x16x32_bf16 v[40:43], v[136:139], v[64:67], 0
 ds_read_b128 v[148:151], v23 offset:128
 buffer_load_dwordx4 v30, s[12:15], s21 offen offset:2048 lds
 s_waitcnt vmcnt(18)
 v_mfma_f32_16x16x32_bf16 v[48:51], v[136:139], v[88:91], 0
 s_add_u32 m0, s81, 27648
 s_add_u32 s21, s88, 2998272
 ds_write_b128 v251, v[232:235] offset:36864
 v_mfma_f32_16x16x32_bf16 v[56:59], v[136:139], v[112:115], 0
 buffer_load_dwordx4 v31, s[12:15], s21 offen offset:0 lds
 ds_write_b128 v251, v[236:239] offset:37888
 s_waitcnt lgkmcnt(4)
 v_mfma_f32_16x16x32_bf16 v[40:43], v[140:143], v[68:71], v[40:43]
 ds_read_b128 v[136:139], v22 offset:256
 v_cvt_pk_f16_f32 v44, v44, v45
 buffer_load_dwordx4 v32, s[12:15], s21 offen offset:1024 lds
 v_accvgpr_write_b32 a146, v44
 v_mfma_f32_16x16x32_bf16 v[48:51], v[140:143], v[92:95], v[48:51]
 v_cvt_pk_f16_f32 v46, v46, v47
 buffer_load_dwordx4 v33, s[12:15], s21 offen offset:2048 lds
 ds_write_b128 v251, v[240:243] offset:38912
 v_mfma_f32_16x16x32_bf16 v[56:59], v[140:143], v[116:119], v[56:59]
 v_accvgpr_write_b32 a147, v46
 s_add_u32 m0, s81, 30720
 s_add_u32 s21, s88, 3440640
 ds_read_b64_tr_b16 v[208:209], v250 offset:36864
 s_waitcnt lgkmcnt(6)
 v_mfma_f32_16x16x32_bf16 v[40:43], v[144:147], v[72:75], v[40:43]
 ds_read_b128 v[140:143], v23 offset:256
 v_cvt_pk_f16_f32 v52, v52, v53
 buffer_load_dwordx4 v34, s[12:15], s21 offen offset:0 lds
 ds_read_b64_tr_b16 v[210:211], v250 offset:37248
 v_mfma_f32_16x16x32_bf16 v[48:51], v[144:147], v[96:99], v[48:51]
 v_accvgpr_write_b32 a154, v52
 buffer_load_dwordx4 v35, s[12:15], s21 offen offset:1024 lds
 ds_read_b64_tr_b16 v[212:213], v250 offset:36896
 ds_read_b64_tr_b16 v[214:215], v250 offset:37280
 v_mfma_f32_16x16x32_bf16 v[56:59], v[144:147], v[120:123], v[56:59]
 v_cvt_pk_f16_f32 v54, v54, v55
 buffer_load_dwordx4 v36, s[12:15], s21 offen offset:2048 lds
 ds_read_b64_tr_b16 v[216:217], v250 offset:36928
 s_waitcnt lgkmcnt(10)
 v_mfma_f32_16x16x32_bf16 v[40:43], v[148:151], v[76:79], v[40:43]
 ds_read_b128 v[144:147], v22 offset:1536
 v_accvgpr_write_b32 a155, v54
 s_add_u32 m0, s81, 33792
 s_add_u32 s21, s88, 3489792
 ds_read_b64_tr_b16 v[218:219], v250 offset:37312
 v_mfma_f32_16x16x32_bf16 v[48:51], v[148:151], v[100:103], v[48:51]
 v_cvt_pk_f16_f32 v60, v60, v61
 buffer_load_dwordx4 v37, s[12:15], s21 offen offset:0 lds
 s_add_u32 s22, s80, 0
 v_accvgpr_write_b32 a162, v60
 v_mfma_f32_16x16x32_bf16 v[56:59], v[148:151], v[124:127], v[56:59]
 v_cvt_pk_f16_f32 v62, v62, v63
 buffer_load_dwordx4 v38, s[12:15], s21 offen offset:1024 lds
 v_accvgpr_write_b32 a163, v62
 s_waitcnt lgkmcnt(9)
 v_mfma_f32_16x16x32_bf16 v[40:43], v[136:139], v[80:83], v[40:43]
 ds_read_b128 v[148:151], v23 offset:1536
 buffer_load_dwordx4 v39, s[12:15], s21 offen offset:2048 lds
 buffer_load_dwordx4 v[232:235], v244, s[36:39], s22 offen
 v_mfma_f32_16x16x32_bf16 v[48:51], v[136:139], v[104:107], v[48:51]
 buffer_load_dwordx4 v[236:239], v245, s[36:39], s22 offen
 buffer_load_dwordx4 v[240:243], v246, s[36:39], s22 offen
 v_mfma_f32_16x16x32_bf16 v[56:59], v[136:139], v[128:131], v[56:59]
 s_waitcnt lgkmcnt(7)
 v_mfma_f32_16x16x32_bf16 v[40:43], v[140:143], v[84:87], v[40:43]
 ds_read_b128 v[136:139], v22 offset:1664
 v_mfma_f32_16x16x32_bf16 v[48:51], v[140:143], v[108:111], v[48:51]
 v_mfma_f32_16x16x32_bf16 v[56:59], v[140:143], v[132:135], v[56:59]
 s_waitcnt lgkmcnt(3)
 v_mfma_f32_16x16x32_bf16 v[44:47], v[144:147], v[64:67], 0
 ds_read_b128 v[140:143], v23 offset:1664
 v_mfma_f32_16x16x32_bf16 v[52:55], v[144:147], v[88:91], 0
 s_waitcnt lgkmcnt(3)
 v_lshlrev_b32 v27, 16, v208
 v_and_b32 v208, 0xffff0000, v208
 v_cvt_pk_f16_f32 v208, v27, v208
 v_accvgpr_write_b32 a72, v208
 v_mfma_f32_16x16x32_bf16 v[60:63], v[144:147], v[112:115], 0
 v_lshlrev_b32 v27, 16, v209
 v_and_b32 v209, 0xffff0000, v209
 v_cvt_pk_f16_f32 v209, v27, v209
 v_accvgpr_write_b32 a73, v209
 s_waitcnt lgkmcnt(2)
 v_mfma_f32_16x16x32_bf16 v[44:47], v[148:151], v[68:71], v[44:47]
 ds_read_b128 v[144:147], v22 offset:1792
 v_cvt_pk_f16_f32 v40, v40, v41
 v_lshlrev_b32 v27, 16, v210
 v_and_b32 v210, 0xffff0000, v210
 v_cvt_pk_f16_f32 v210, v27, v210
 v_mfma_f32_16x16x32_bf16 v[52:55], v[148:151], v[92:95], v[52:55]
 v_accvgpr_write_b32 a148, v40
 v_accvgpr_write_b32 a74, v210
 v_lshlrev_b32 v27, 16, v211
 v_and_b32 v211, 0xffff0000, v211
 v_cvt_pk_f16_f32 v211, v27, v211
 v_mfma_f32_16x16x32_bf16 v[60:63], v[148:151], v[116:119], v[60:63]
 v_cvt_pk_f16_f32 v42, v42, v43
 v_accvgpr_write_b32 a75, v211
 v_lshlrev_b32 v27, 16, v212
 v_and_b32 v212, 0xffff0000, v212
 s_waitcnt lgkmcnt(2)
 v_mfma_f32_16x16x32_bf16 v[44:47], v[136:139], v[72:75], v[44:47]
 ds_read_b128 v[148:151], v23 offset:1792
 v_accvgpr_write_b32 a149, v42
 v_cvt_pk_f16_f32 v212, v27, v212
 v_accvgpr_write_b32 a92, v212
 v_lshlrev_b32 v27, 16, v213
 v_mfma_f32_16x16x32_bf16 v[52:55], v[136:139], v[96:99], v[52:55]
 v_cvt_pk_f16_f32 v48, v48, v49
 v_and_b32 v213, 0xffff0000, v213
 v_cvt_pk_f16_f32 v213, v27, v213
 v_accvgpr_write_b32 a93, v213
 v_lshlrev_b32 v27, 16, v214
 v_mfma_f32_16x16x32_bf16 v[60:63], v[136:139], v[120:123], v[60:63]
 v_accvgpr_write_b32 a156, v48
 v_and_b32 v214, 0xffff0000, v214
 v_cvt_pk_f16_f32 v214, v27, v214
 v_accvgpr_write_b32 a94, v214
 s_waitcnt lgkmcnt(2)
 v_mfma_f32_16x16x32_bf16 v[44:47], v[140:143], v[76:79], v[44:47]
 s_waitcnt vmcnt(18)
 ds_read_b128 v[136:139], v22 offset:12288
 v_cvt_pk_f16_f32 v50, v50, v51
 v_lshlrev_b32 v27, 16, v215
 v_and_b32 v215, 0xffff0000, v215
 v_cvt_pk_f16_f32 v215, v27, v215
 v_mfma_f32_16x16x32_bf16 v[52:55], v[140:143], v[100:103], v[52:55]
 v_accvgpr_write_b32 a157, v50
 v_accvgpr_write_b32 a95, v215
 v_lshlrev_b32 v27, 16, v216
 v_and_b32 v216, 0xffff0000, v216
 v_cvt_pk_f16_f32 v216, v27, v216
 v_mfma_f32_16x16x32_bf16 v[60:63], v[140:143], v[124:127], v[60:63]
 v_cvt_pk_f16_f32 v56, v56, v57
 v_accvgpr_write_b32 a112, v216
 v_lshlrev_b32 v27, 16, v217
 v_and_b32 v217, 0xffff0000, v217
 s_waitcnt lgkmcnt(2)
 v_mfma_f32_16x16x32_bf16 v[44:47], v[144:147], v[80:83], v[44:47]
 ds_read_b128 v[140:143], v23 offset:12288
 v_accvgpr_write_b32 a164, v56
 v_cvt_pk_f16_f32 v217, v27, v217
 v_accvgpr_write_b32 a113, v217
 v_lshlrev_b32 v27, 16, v218
 v_mfma_f32_16x16x32_bf16 v[52:55], v[144:147], v[104:107], v[52:55]
 v_cvt_pk_f16_f32 v58, v58, v59
 v_and_b32 v218, 0xffff0000, v218
 v_cvt_pk_f16_f32 v218, v27, v218
 v_accvgpr_write_b32 a114, v218
 v_lshlrev_b32 v27, 16, v219
 v_mfma_f32_16x16x32_bf16 v[60:63], v[144:147], v[128:131], v[60:63]
 v_accvgpr_write_b32 a165, v58
 v_and_b32 v219, 0xffff0000, v219
 v_cvt_pk_f16_f32 v219, v27, v219
 v_accvgpr_write_b32 a115, v219
 s_waitcnt lgkmcnt(2)
 v_mfma_f32_16x16x32_bf16 v[44:47], v[148:151], v[84:87], v[44:47]
 ds_read_b128 v[144:147], v22 offset:12416
 s_add_u32 m0, s81, 0
 s_add_u32 s21, s88, 2064384
 v_mfma_f32_16x16x32_bf16 v[52:55], v[148:151], v[108:111], v[52:55]
 buffer_load_dwordx4 v28, s[12:15], s21 offen offset:0 lds
 v_mfma_f32_16x16x32_bf16 v[60:63], v[148:151], v[132:135], v[60:63]
 buffer_load_dwordx4 v29, s[12:15], s21 offen offset:1024 lds
 s_waitcnt lgkmcnt(2)
 v_mfma_f32_16x16x32_bf16 v[40:43], v[136:139], v[64:67], 0
 ds_read_b128 v[148:151], v23 offset:12416
 buffer_load_dwordx4 v30, s[12:15], s21 offen offset:2048 lds
 s_waitcnt vmcnt(18)
 v_mfma_f32_16x16x32_bf16 v[48:51], v[136:139], v[88:91], 0
 s_add_u32 m0, s81, 3072
 s_add_u32 s21, s88, 2113536
 ds_write_b128 v251, v[220:223] offset:36864
 v_mfma_f32_16x16x32_bf16 v[56:59], v[136:139], v[112:115], 0
 buffer_load_dwordx4 v31, s[12:15], s21 offen offset:0 lds
 ds_write_b128 v251, v[224:227] offset:37888
 s_waitcnt lgkmcnt(4)
 v_mfma_f32_16x16x32_bf16 v[40:43], v[140:143], v[68:71], v[40:43]
 ds_read_b128 v[136:139], v22 offset:12544
 v_cvt_pk_f16_f32 v44, v44, v45
 buffer_load_dwordx4 v32, s[12:15], s21 offen offset:1024 lds
 v_accvgpr_write_b32 a150, v44
 v_mfma_f32_16x16x32_bf16 v[48:51], v[140:143], v[92:95], v[48:51]
 v_cvt_pk_f16_f32 v46, v46, v47
 buffer_load_dwordx4 v33, s[12:15], s21 offen offset:2048 lds
 ds_write_b128 v251, v[228:231] offset:38912
 v_mfma_f32_16x16x32_bf16 v[56:59], v[140:143], v[116:119], v[56:59]
 v_accvgpr_write_b32 a151, v46
 s_add_u32 m0, s81, 6144
 s_add_u32 s21, s88, 2555904
 ds_read_b64_tr_b16 v[208:209], v250 offset:36864
 s_waitcnt lgkmcnt(6)
 v_mfma_f32_16x16x32_bf16 v[40:43], v[144:147], v[72:75], v[40:43]
 ds_read_b128 v[140:143], v23 offset:12544
 v_cvt_pk_f16_f32 v52, v52, v53
 buffer_load_dwordx4 v34, s[12:15], s21 offen offset:0 lds
 ds_read_b64_tr_b16 v[210:211], v250 offset:37248
 v_mfma_f32_16x16x32_bf16 v[48:51], v[144:147], v[96:99], v[48:51]
 v_accvgpr_write_b32 a158, v52
 buffer_load_dwordx4 v35, s[12:15], s21 offen offset:1024 lds
 ds_read_b64_tr_b16 v[212:213], v250 offset:36896
 ds_read_b64_tr_b16 v[214:215], v250 offset:37280
 v_mfma_f32_16x16x32_bf16 v[56:59], v[144:147], v[120:123], v[56:59]
 v_cvt_pk_f16_f32 v54, v54, v55
 buffer_load_dwordx4 v36, s[12:15], s21 offen offset:2048 lds
 ds_read_b64_tr_b16 v[216:217], v250 offset:36928
 s_waitcnt lgkmcnt(10)
 v_mfma_f32_16x16x32_bf16 v[40:43], v[148:151], v[76:79], v[40:43]
 ds_read_b128 v[144:147], v22 offset:13824
 v_accvgpr_write_b32 a159, v54
 s_add_u32 m0, s81, 9216
 s_add_u32 s21, s88, 2605056
 ds_read_b64_tr_b16 v[218:219], v250 offset:37312
 v_mfma_f32_16x16x32_bf16 v[48:51], v[148:151], v[100:103], v[48:51]
 v_cvt_pk_f16_f32 v60, v60, v61
 buffer_load_dwordx4 v37, s[12:15], s21 offen offset:0 lds
 s_add_u32 s22, s80, 983040
 v_accvgpr_write_b32 a166, v60
 v_mfma_f32_16x16x32_bf16 v[56:59], v[148:151], v[124:127], v[56:59]
 v_cvt_pk_f16_f32 v62, v62, v63
 buffer_load_dwordx4 v38, s[12:15], s21 offen offset:1024 lds
 v_accvgpr_write_b32 a167, v62
 s_waitcnt lgkmcnt(9)
 v_mfma_f32_16x16x32_bf16 v[40:43], v[136:139], v[80:83], v[40:43]
 ds_read_b128 v[148:151], v23 offset:13824
 buffer_load_dwordx4 v39, s[12:15], s21 offen offset:2048 lds
 buffer_load_dwordx4 v[220:223], v244, s[36:39], s22 offen
 v_mfma_f32_16x16x32_bf16 v[48:51], v[136:139], v[104:107], v[48:51]
 buffer_load_dwordx4 v[224:227], v245, s[36:39], s22 offen
 buffer_load_dwordx4 v[228:231], v246, s[36:39], s22 offen
 v_mfma_f32_16x16x32_bf16 v[56:59], v[136:139], v[128:131], v[56:59]
 s_waitcnt lgkmcnt(7)
 v_mfma_f32_16x16x32_bf16 v[40:43], v[140:143], v[84:87], v[40:43]
 ds_read_b128 v[136:139], v22 offset:13952
 v_mfma_f32_16x16x32_bf16 v[48:51], v[140:143], v[108:111], v[48:51]
 v_mfma_f32_16x16x32_bf16 v[56:59], v[140:143], v[132:135], v[56:59]
 s_waitcnt lgkmcnt(3)
 v_mfma_f32_16x16x32_bf16 v[44:47], v[144:147], v[64:67], 0
 ds_read_b128 v[140:143], v23 offset:13952
 v_mfma_f32_16x16x32_bf16 v[52:55], v[144:147], v[88:91], 0
 s_waitcnt lgkmcnt(3)
 v_lshlrev_b32 v27, 16, v208
 v_and_b32 v208, 0xffff0000, v208
 v_cvt_pk_f16_f32 v208, v27, v208
 v_accvgpr_write_b32 a76, v208
 v_mfma_f32_16x16x32_bf16 v[60:63], v[144:147], v[112:115], 0
 v_lshlrev_b32 v27, 16, v209
 v_and_b32 v209, 0xffff0000, v209
 v_cvt_pk_f16_f32 v209, v27, v209
 v_accvgpr_write_b32 a77, v209
 s_waitcnt lgkmcnt(2)
 v_mfma_f32_16x16x32_bf16 v[44:47], v[148:151], v[68:71], v[44:47]
 ds_read_b128 v[144:147], v22 offset:14080
 v_cvt_pk_f16_f32 v40, v40, v41
 v_lshlrev_b32 v27, 16, v210
 v_and_b32 v210, 0xffff0000, v210
 v_cvt_pk_f16_f32 v210, v27, v210
 v_mfma_f32_16x16x32_bf16 v[52:55], v[148:151], v[92:95], v[52:55]
 v_accvgpr_write_b32 a168, v40
 v_accvgpr_write_b32 a78, v210
 v_lshlrev_b32 v27, 16, v211
 v_and_b32 v211, 0xffff0000, v211
 v_cvt_pk_f16_f32 v211, v27, v211
 v_mfma_f32_16x16x32_bf16 v[60:63], v[148:151], v[116:119], v[60:63]
 v_cvt_pk_f16_f32 v42, v42, v43
 v_accvgpr_write_b32 a79, v211
 v_lshlrev_b32 v27, 16, v212
 v_and_b32 v212, 0xffff0000, v212
 s_waitcnt lgkmcnt(2)
 v_mfma_f32_16x16x32_bf16 v[44:47], v[136:139], v[72:75], v[44:47]
 ds_read_b128 v[148:151], v23 offset:14080
 v_accvgpr_write_b32 a169, v42
 v_cvt_pk_f16_f32 v212, v27, v212
 v_accvgpr_write_b32 a96, v212
 v_lshlrev_b32 v27, 16, v213
 v_mfma_f32_16x16x32_bf16 v[52:55], v[136:139], v[96:99], v[52:55]
 v_cvt_pk_f16_f32 v48, v48, v49
 v_and_b32 v213, 0xffff0000, v213
 v_cvt_pk_f16_f32 v213, v27, v213
 v_accvgpr_write_b32 a97, v213
 v_lshlrev_b32 v27, 16, v214
 v_mfma_f32_16x16x32_bf16 v[60:63], v[136:139], v[120:123], v[60:63]
 v_accvgpr_write_b32 a176, v48
 v_and_b32 v214, 0xffff0000, v214
 v_cvt_pk_f16_f32 v214, v27, v214
 v_accvgpr_write_b32 a98, v214
 s_waitcnt lgkmcnt(2)
 v_mfma_f32_16x16x32_bf16 v[44:47], v[140:143], v[76:79], v[44:47]
 s_waitcnt vmcnt(18)
 ds_read_b128 v[136:139], v22 offset:24576
 v_cvt_pk_f16_f32 v50, v50, v51
 v_lshlrev_b32 v27, 16, v215
 v_and_b32 v215, 0xffff0000, v215
 v_cvt_pk_f16_f32 v215, v27, v215
 v_mfma_f32_16x16x32_bf16 v[52:55], v[140:143], v[100:103], v[52:55]
 v_accvgpr_write_b32 a177, v50
 v_accvgpr_write_b32 a99, v215
 v_lshlrev_b32 v27, 16, v216
 v_and_b32 v216, 0xffff0000, v216
 v_cvt_pk_f16_f32 v216, v27, v216
 v_mfma_f32_16x16x32_bf16 v[60:63], v[140:143], v[124:127], v[60:63]
 v_cvt_pk_f16_f32 v56, v56, v57
 v_accvgpr_write_b32 a116, v216
 v_lshlrev_b32 v27, 16, v217
 v_and_b32 v217, 0xffff0000, v217
 s_waitcnt lgkmcnt(2)
 v_mfma_f32_16x16x32_bf16 v[44:47], v[144:147], v[80:83], v[44:47]
 ds_read_b128 v[140:143], v23 offset:24576
 v_accvgpr_write_b32 a184, v56
 v_cvt_pk_f16_f32 v217, v27, v217
 v_accvgpr_write_b32 a117, v217
 v_lshlrev_b32 v27, 16, v218
 v_mfma_f32_16x16x32_bf16 v[52:55], v[144:147], v[104:107], v[52:55]
 v_cvt_pk_f16_f32 v58, v58, v59
 v_and_b32 v218, 0xffff0000, v218
 v_cvt_pk_f16_f32 v218, v27, v218
 v_accvgpr_write_b32 a118, v218
 v_lshlrev_b32 v27, 16, v219
 v_mfma_f32_16x16x32_bf16 v[60:63], v[144:147], v[128:131], v[60:63]
 v_accvgpr_write_b32 a185, v58
 v_and_b32 v219, 0xffff0000, v219
 v_cvt_pk_f16_f32 v219, v27, v219
 v_accvgpr_write_b32 a119, v219
 s_waitcnt lgkmcnt(2)
 v_mfma_f32_16x16x32_bf16 v[44:47], v[148:151], v[84:87], v[44:47]
 ds_read_b128 v[144:147], v22 offset:24704
 s_add_u32 m0, s81, 12288
 s_add_u32 s21, s88, 3047424
 v_mfma_f32_16x16x32_bf16 v[52:55], v[148:151], v[108:111], v[52:55]
 buffer_load_dwordx4 v28, s[12:15], s21 offen offset:0 lds
 v_mfma_f32_16x16x32_bf16 v[60:63], v[148:151], v[132:135], v[60:63]
 buffer_load_dwordx4 v29, s[12:15], s21 offen offset:1024 lds
 s_waitcnt lgkmcnt(2)
 v_mfma_f32_16x16x32_bf16 v[40:43], v[136:139], v[64:67], 0
 ds_read_b128 v[148:151], v23 offset:24704
 buffer_load_dwordx4 v30, s[12:15], s21 offen offset:2048 lds
 s_waitcnt vmcnt(18)
 v_mfma_f32_16x16x32_bf16 v[48:51], v[136:139], v[88:91], 0
 s_add_u32 m0, s81, 15360
 s_add_u32 s21, s88, 3096576
 ds_write_b128 v251, v[232:235] offset:36864
 v_mfma_f32_16x16x32_bf16 v[56:59], v[136:139], v[112:115], 0
 buffer_load_dwordx4 v31, s[12:15], s21 offen offset:0 lds
 ds_write_b128 v251, v[236:239] offset:37888
 s_waitcnt lgkmcnt(4)
 v_mfma_f32_16x16x32_bf16 v[40:43], v[140:143], v[68:71], v[40:43]
 ds_read_b128 v[136:139], v22 offset:24832
 v_cvt_pk_f16_f32 v44, v44, v45
 buffer_load_dwordx4 v32, s[12:15], s21 offen offset:1024 lds
 v_accvgpr_write_b32 a170, v44
 v_mfma_f32_16x16x32_bf16 v[48:51], v[140:143], v[92:95], v[48:51]
 v_cvt_pk_f16_f32 v46, v46, v47
 buffer_load_dwordx4 v33, s[12:15], s21 offen offset:2048 lds
 ds_write_b128 v251, v[240:243] offset:38912
 v_mfma_f32_16x16x32_bf16 v[56:59], v[140:143], v[116:119], v[56:59]
 v_accvgpr_write_b32 a171, v46
 s_add_u32 m0, s81, 18432
 s_add_u32 s21, s88, 3538944
 ds_read_b64_tr_b16 v[208:209], v250 offset:36864
 s_waitcnt lgkmcnt(6)
 v_mfma_f32_16x16x32_bf16 v[40:43], v[144:147], v[72:75], v[40:43]
 ds_read_b128 v[140:143], v23 offset:24832
 v_cvt_pk_f16_f32 v52, v52, v53
 buffer_load_dwordx4 v34, s[12:15], s21 offen offset:0 lds
 ds_read_b64_tr_b16 v[210:211], v250 offset:37248
 v_mfma_f32_16x16x32_bf16 v[48:51], v[144:147], v[96:99], v[48:51]
 v_accvgpr_write_b32 a178, v52
 buffer_load_dwordx4 v35, s[12:15], s21 offen offset:1024 lds
 ds_read_b64_tr_b16 v[212:213], v250 offset:36896
 ds_read_b64_tr_b16 v[214:215], v250 offset:37280
 v_mfma_f32_16x16x32_bf16 v[56:59], v[144:147], v[120:123], v[56:59]
 v_cvt_pk_f16_f32 v54, v54, v55
 buffer_load_dwordx4 v36, s[12:15], s21 offen offset:2048 lds
 ds_read_b64_tr_b16 v[216:217], v250 offset:36928
 s_waitcnt lgkmcnt(10)
 v_mfma_f32_16x16x32_bf16 v[40:43], v[148:151], v[76:79], v[40:43]
 ds_read_b128 v[144:147], v22 offset:26112
 v_accvgpr_write_b32 a179, v54
 s_add_u32 m0, s81, 21504
 s_add_u32 s21, s88, 3588096
 ds_read_b64_tr_b16 v[218:219], v250 offset:37312
 v_mfma_f32_16x16x32_bf16 v[48:51], v[148:151], v[100:103], v[48:51]
 v_cvt_pk_f16_f32 v60, v60, v61
 buffer_load_dwordx4 v37, s[12:15], s21 offen offset:0 lds
 s_add_u32 s22, s80, 98304
 v_accvgpr_write_b32 a186, v60
 v_mfma_f32_16x16x32_bf16 v[56:59], v[148:151], v[124:127], v[56:59]
 v_cvt_pk_f16_f32 v62, v62, v63
 buffer_load_dwordx4 v38, s[12:15], s21 offen offset:1024 lds
 v_accvgpr_write_b32 a187, v62
 s_waitcnt lgkmcnt(9)
 v_mfma_f32_16x16x32_bf16 v[40:43], v[136:139], v[80:83], v[40:43]
 ds_read_b128 v[148:151], v23 offset:26112
 buffer_load_dwordx4 v39, s[12:15], s21 offen offset:2048 lds
 buffer_load_dwordx4 v[232:235], v244, s[36:39], s22 offen
 v_mfma_f32_16x16x32_bf16 v[48:51], v[136:139], v[104:107], v[48:51]
 buffer_load_dwordx4 v[236:239], v245, s[36:39], s22 offen
 buffer_load_dwordx4 v[240:243], v246, s[36:39], s22 offen
 v_mfma_f32_16x16x32_bf16 v[56:59], v[136:139], v[128:131], v[56:59]
 s_waitcnt lgkmcnt(7)
 v_mfma_f32_16x16x32_bf16 v[40:43], v[140:143], v[84:87], v[40:43]
 ds_read_b128 v[136:139], v22 offset:26240
 v_mfma_f32_16x16x32_bf16 v[48:51], v[140:143], v[108:111], v[48:51]
 v_mfma_f32_16x16x32_bf16 v[56:59], v[140:143], v[132:135], v[56:59]
 s_waitcnt lgkmcnt(3)
 v_mfma_f32_16x16x32_bf16 v[44:47], v[144:147], v[64:67], 0
 ds_read_b128 v[140:143], v23 offset:26240
 v_mfma_f32_16x16x32_bf16 v[52:55], v[144:147], v[88:91], 0
 s_waitcnt lgkmcnt(3)
 v_lshlrev_b32 v27, 16, v208
 v_and_b32 v208, 0xffff0000, v208
 v_cvt_pk_f16_f32 v208, v27, v208
 v_accvgpr_write_b32 a0, v208
 v_mfma_f32_16x16x32_bf16 v[60:63], v[144:147], v[112:115], 0
 v_lshlrev_b32 v27, 16, v209
 v_and_b32 v209, 0xffff0000, v209
 v_cvt_pk_f16_f32 v209, v27, v209
 v_accvgpr_write_b32 a1, v209
 s_waitcnt lgkmcnt(2)
 v_mfma_f32_16x16x32_bf16 v[44:47], v[148:151], v[68:71], v[44:47]
 ds_read_b128 v[144:147], v22 offset:26368
 v_cvt_pk_f16_f32 v40, v40, v41
 v_lshlrev_b32 v27, 16, v210
 v_and_b32 v210, 0xffff0000, v210
 v_cvt_pk_f16_f32 v210, v27, v210
 v_mfma_f32_16x16x32_bf16 v[52:55], v[148:151], v[92:95], v[52:55]
 v_accvgpr_write_b32 a172, v40
 v_accvgpr_write_b32 a2, v210
 v_lshlrev_b32 v27, 16, v211
 v_and_b32 v211, 0xffff0000, v211
 v_cvt_pk_f16_f32 v211, v27, v211
 v_mfma_f32_16x16x32_bf16 v[60:63], v[148:151], v[116:119], v[60:63]
 v_cvt_pk_f16_f32 v42, v42, v43
 v_accvgpr_write_b32 a3, v211
 v_lshlrev_b32 v27, 16, v212
 v_and_b32 v212, 0xffff0000, v212
 s_waitcnt lgkmcnt(2)
 v_mfma_f32_16x16x32_bf16 v[44:47], v[136:139], v[72:75], v[44:47]
 ds_read_b128 v[148:151], v23 offset:26368
 v_accvgpr_write_b32 a173, v42
 v_cvt_pk_f16_f32 v212, v27, v212
 v_accvgpr_write_b32 a20, v212
 v_lshlrev_b32 v27, 16, v213
 v_mfma_f32_16x16x32_bf16 v[52:55], v[136:139], v[96:99], v[52:55]
 v_cvt_pk_f16_f32 v48, v48, v49
 v_and_b32 v213, 0xffff0000, v213
 v_cvt_pk_f16_f32 v213, v27, v213
 v_accvgpr_write_b32 a21, v213
 v_lshlrev_b32 v27, 16, v214
 v_mfma_f32_16x16x32_bf16 v[60:63], v[136:139], v[120:123], v[60:63]
 v_accvgpr_write_b32 a180, v48
 v_and_b32 v214, 0xffff0000, v214
 v_cvt_pk_f16_f32 v214, v27, v214
 v_accvgpr_write_b32 a22, v214
 s_waitcnt lgkmcnt(2)
 v_mfma_f32_16x16x32_bf16 v[44:47], v[140:143], v[76:79], v[44:47]
 s_waitcnt vmcnt(18)
 ds_read_b128 v[136:139], v22 offset:0
 v_cvt_pk_f16_f32 v50, v50, v51
 v_lshlrev_b32 v27, 16, v215
 v_and_b32 v215, 0xffff0000, v215
 v_cvt_pk_f16_f32 v215, v27, v215
 v_mfma_f32_16x16x32_bf16 v[52:55], v[140:143], v[100:103], v[52:55]
 v_accvgpr_write_b32 a181, v50
 v_accvgpr_write_b32 a23, v215
 v_lshlrev_b32 v27, 16, v216
 v_and_b32 v216, 0xffff0000, v216
 v_cvt_pk_f16_f32 v216, v27, v216
 v_mfma_f32_16x16x32_bf16 v[60:63], v[140:143], v[124:127], v[60:63]
 v_cvt_pk_f16_f32 v56, v56, v57
 v_accvgpr_write_b32 a40, v216
 v_lshlrev_b32 v27, 16, v217
 v_and_b32 v217, 0xffff0000, v217
 s_waitcnt lgkmcnt(2)
 v_mfma_f32_16x16x32_bf16 v[44:47], v[144:147], v[80:83], v[44:47]
 ds_read_b128 v[140:143], v23 offset:0
 v_accvgpr_write_b32 a188, v56
 v_cvt_pk_f16_f32 v217, v27, v217
 v_accvgpr_write_b32 a41, v217
 v_lshlrev_b32 v27, 16, v218
 v_mfma_f32_16x16x32_bf16 v[52:55], v[144:147], v[104:107], v[52:55]
 v_cvt_pk_f16_f32 v58, v58, v59
 v_and_b32 v218, 0xffff0000, v218
 v_cvt_pk_f16_f32 v218, v27, v218
 v_accvgpr_write_b32 a42, v218
 v_lshlrev_b32 v27, 16, v219
 v_mfma_f32_16x16x32_bf16 v[60:63], v[144:147], v[128:131], v[60:63]
 v_accvgpr_write_b32 a189, v58
 v_and_b32 v219, 0xffff0000, v219
 v_cvt_pk_f16_f32 v219, v27, v219
 v_accvgpr_write_b32 a43, v219
 s_waitcnt lgkmcnt(2)
 v_mfma_f32_16x16x32_bf16 v[44:47], v[148:151], v[84:87], v[44:47]
 ds_read_b128 v[144:147], v22 offset:128
 s_add_u32 m0, s81, 24576
 s_add_u32 s21, s88, 3932160
 v_mfma_f32_16x16x32_bf16 v[52:55], v[148:151], v[108:111], v[52:55]
 buffer_load_dwordx4 v28, s[12:15], s21 offen offset:0 lds
 v_mfma_f32_16x16x32_bf16 v[60:63], v[148:151], v[132:135], v[60:63]
 buffer_load_dwordx4 v29, s[12:15], s21 offen offset:1024 lds
 s_waitcnt lgkmcnt(2)
 v_mfma_f32_16x16x32_bf16 v[40:43], v[136:139], v[64:67], 0
 ds_read_b128 v[148:151], v23 offset:128
 buffer_load_dwordx4 v30, s[12:15], s21 offen offset:2048 lds
 s_waitcnt vmcnt(18)
 v_mfma_f32_16x16x32_bf16 v[48:51], v[136:139], v[88:91], 0
 s_add_u32 m0, s81, 27648
 s_add_u32 s21, s88, 3981312
 ds_write_b128 v251, v[220:223] offset:36864
 v_mfma_f32_16x16x32_bf16 v[56:59], v[136:139], v[112:115], 0
 buffer_load_dwordx4 v31, s[12:15], s21 offen offset:0 lds
 ds_write_b128 v251, v[224:227] offset:37888
 s_waitcnt lgkmcnt(4)
 v_mfma_f32_16x16x32_bf16 v[40:43], v[140:143], v[68:71], v[40:43]
 ds_read_b128 v[136:139], v22 offset:256
 v_cvt_pk_f16_f32 v44, v44, v45
 buffer_load_dwordx4 v32, s[12:15], s21 offen offset:1024 lds
 v_accvgpr_write_b32 a174, v44
 v_mfma_f32_16x16x32_bf16 v[48:51], v[140:143], v[92:95], v[48:51]
 v_cvt_pk_f16_f32 v46, v46, v47
 buffer_load_dwordx4 v33, s[12:15], s21 offen offset:2048 lds
 ds_write_b128 v251, v[228:231] offset:38912
 v_mfma_f32_16x16x32_bf16 v[56:59], v[140:143], v[116:119], v[56:59]
 v_accvgpr_write_b32 a175, v46
 s_add_u32 m0, s81, 30720
 s_add_u32 s21, s88, 4423680
 ds_read_b64_tr_b16 v[208:209], v250 offset:36864
 s_waitcnt lgkmcnt(6)
 v_mfma_f32_16x16x32_bf16 v[40:43], v[144:147], v[72:75], v[40:43]
 ds_read_b128 v[140:143], v23 offset:256
 v_cvt_pk_f16_f32 v52, v52, v53
 buffer_load_dwordx4 v34, s[12:15], s21 offen offset:0 lds
 ds_read_b64_tr_b16 v[210:211], v250 offset:37248
 v_mfma_f32_16x16x32_bf16 v[48:51], v[144:147], v[96:99], v[48:51]
 v_accvgpr_write_b32 a182, v52
 buffer_load_dwordx4 v35, s[12:15], s21 offen offset:1024 lds
 ds_read_b64_tr_b16 v[212:213], v250 offset:36896
 ds_read_b64_tr_b16 v[214:215], v250 offset:37280
 v_mfma_f32_16x16x32_bf16 v[56:59], v[144:147], v[120:123], v[56:59]
 v_cvt_pk_f16_f32 v54, v54, v55
 buffer_load_dwordx4 v36, s[12:15], s21 offen offset:2048 lds
 ds_read_b64_tr_b16 v[216:217], v250 offset:36928
 s_waitcnt lgkmcnt(10)
 v_mfma_f32_16x16x32_bf16 v[40:43], v[148:151], v[76:79], v[40:43]
 ds_read_b128 v[144:147], v22 offset:1536
 v_accvgpr_write_b32 a183, v54
 s_add_u32 m0, s81, 33792
 s_add_u32 s21, s88, 4472832
 ds_read_b64_tr_b16 v[218:219], v250 offset:37312
 v_mfma_f32_16x16x32_bf16 v[48:51], v[148:151], v[100:103], v[48:51]
 v_cvt_pk_f16_f32 v60, v60, v61
 buffer_load_dwordx4 v37, s[12:15], s21 offen offset:0 lds
 s_add_u32 s22, s80, 1081344
 v_accvgpr_write_b32 a190, v60
 v_mfma_f32_16x16x32_bf16 v[56:59], v[148:151], v[124:127], v[56:59]
 v_cvt_pk_f16_f32 v62, v62, v63
 buffer_load_dwordx4 v38, s[12:15], s21 offen offset:1024 lds
 v_accvgpr_write_b32 a191, v62
 s_waitcnt lgkmcnt(9)
 v_mfma_f32_16x16x32_bf16 v[40:43], v[136:139], v[80:83], v[40:43]
 ds_read_b128 v[148:151], v23 offset:1536
 buffer_load_dwordx4 v39, s[12:15], s21 offen offset:2048 lds
 buffer_load_dwordx4 v[220:223], v244, s[36:39], s22 offen
 v_mfma_f32_16x16x32_bf16 v[48:51], v[136:139], v[104:107], v[48:51]
 buffer_load_dwordx4 v[224:227], v245, s[36:39], s22 offen
 buffer_load_dwordx4 v[228:231], v246, s[36:39], s22 offen
 v_mfma_f32_16x16x32_bf16 v[56:59], v[136:139], v[128:131], v[56:59]
 s_waitcnt lgkmcnt(7)
 v_mfma_f32_16x16x32_bf16 v[40:43], v[140:143], v[84:87], v[40:43]
 ds_read_b128 v[136:139], v22 offset:1664
 v_mfma_f32_16x16x32_bf16 v[48:51], v[140:143], v[108:111], v[48:51]
 v_mfma_f32_16x16x32_bf16 v[56:59], v[140:143], v[132:135], v[56:59]
 s_waitcnt lgkmcnt(3)
 v_mfma_f32_16x16x32_bf16 v[44:47], v[144:147], v[64:67], 0
 ds_read_b128 v[140:143], v23 offset:1664
 v_mfma_f32_16x16x32_bf16 v[52:55], v[144:147], v[88:91], 0
 s_waitcnt lgkmcnt(3)
 v_lshlrev_b32 v27, 16, v208
 v_and_b32 v208, 0xffff0000, v208
 v_cvt_pk_f16_f32 v208, v27, v208
 v_accvgpr_write_b32 a4, v208
 v_mfma_f32_16x16x32_bf16 v[60:63], v[144:147], v[112:115], 0
 v_lshlrev_b32 v27, 16, v209
 v_and_b32 v209, 0xffff0000, v209
 v_cvt_pk_f16_f32 v209, v27, v209
 v_accvgpr_write_b32 a5, v209
 s_waitcnt lgkmcnt(2)
 v_mfma_f32_16x16x32_bf16 v[44:47], v[148:151], v[68:71], v[44:47]
 ds_read_b128 v[144:147], v22 offset:1792
 v_cvt_pk_f16_f32 v40, v40, v41
 v_lshlrev_b32 v27, 16, v210
 v_and_b32 v210, 0xffff0000, v210
 v_cvt_pk_f16_f32 v210, v27, v210
 v_mfma_f32_16x16x32_bf16 v[52:55], v[148:151], v[92:95], v[52:55]
 v_accvgpr_write_b32 a192, v40
 v_accvgpr_write_b32 a6, v210
 v_lshlrev_b32 v27, 16, v211
 v_and_b32 v211, 0xffff0000, v211
 v_cvt_pk_f16_f32 v211, v27, v211
 v_mfma_f32_16x16x32_bf16 v[60:63], v[148:151], v[116:119], v[60:63]
 v_cvt_pk_f16_f32 v42, v42, v43
 v_accvgpr_write_b32 a7, v211
 v_lshlrev_b32 v27, 16, v212
 v_and_b32 v212, 0xffff0000, v212
 s_waitcnt lgkmcnt(2)
 v_mfma_f32_16x16x32_bf16 v[44:47], v[136:139], v[72:75], v[44:47]
 ds_read_b128 v[148:151], v23 offset:1792
 v_accvgpr_write_b32 a193, v42
 v_cvt_pk_f16_f32 v212, v27, v212
 v_accvgpr_write_b32 a24, v212
 v_lshlrev_b32 v27, 16, v213
 v_mfma_f32_16x16x32_bf16 v[52:55], v[136:139], v[96:99], v[52:55]
 v_cvt_pk_f16_f32 v48, v48, v49
 v_and_b32 v213, 0xffff0000, v213
 v_cvt_pk_f16_f32 v213, v27, v213
 v_accvgpr_write_b32 a25, v213
 v_lshlrev_b32 v27, 16, v214
 v_mfma_f32_16x16x32_bf16 v[60:63], v[136:139], v[120:123], v[60:63]
 v_accvgpr_write_b32 a200, v48
 v_and_b32 v214, 0xffff0000, v214
 v_cvt_pk_f16_f32 v214, v27, v214
 v_accvgpr_write_b32 a26, v214
 s_waitcnt lgkmcnt(2)
 v_mfma_f32_16x16x32_bf16 v[44:47], v[140:143], v[76:79], v[44:47]
 s_waitcnt vmcnt(18)
 ds_read_b128 v[136:139], v22 offset:12288
 v_cvt_pk_f16_f32 v50, v50, v51
 v_lshlrev_b32 v27, 16, v215
 v_and_b32 v215, 0xffff0000, v215
 v_cvt_pk_f16_f32 v215, v27, v215
 v_mfma_f32_16x16x32_bf16 v[52:55], v[140:143], v[100:103], v[52:55]
 v_accvgpr_write_b32 a201, v50
 v_accvgpr_write_b32 a27, v215
 v_lshlrev_b32 v27, 16, v216
 v_and_b32 v216, 0xffff0000, v216
 v_cvt_pk_f16_f32 v216, v27, v216
 v_mfma_f32_16x16x32_bf16 v[60:63], v[140:143], v[124:127], v[60:63]
 v_cvt_pk_f16_f32 v56, v56, v57
 v_accvgpr_write_b32 a44, v216
 v_lshlrev_b32 v27, 16, v217
 v_and_b32 v217, 0xffff0000, v217
 s_waitcnt lgkmcnt(2)
 v_mfma_f32_16x16x32_bf16 v[44:47], v[144:147], v[80:83], v[44:47]
 ds_read_b128 v[140:143], v23 offset:12288
 v_accvgpr_write_b32 a208, v56
 v_cvt_pk_f16_f32 v217, v27, v217
 v_accvgpr_write_b32 a45, v217
 v_lshlrev_b32 v27, 16, v218
 v_mfma_f32_16x16x32_bf16 v[52:55], v[144:147], v[104:107], v[52:55]
 v_cvt_pk_f16_f32 v58, v58, v59
 v_and_b32 v218, 0xffff0000, v218
 v_cvt_pk_f16_f32 v218, v27, v218
 v_accvgpr_write_b32 a46, v218
 v_lshlrev_b32 v27, 16, v219
 v_mfma_f32_16x16x32_bf16 v[60:63], v[144:147], v[128:131], v[60:63]
 v_accvgpr_write_b32 a209, v58
 v_and_b32 v219, 0xffff0000, v219
 v_cvt_pk_f16_f32 v219, v27, v219
 v_accvgpr_write_b32 a47, v219
 s_waitcnt lgkmcnt(2)
 v_mfma_f32_16x16x32_bf16 v[44:47], v[148:151], v[84:87], v[44:47]
 ds_read_b128 v[144:147], v22 offset:12416
 s_add_u32 m0, s81, 0
 s_add_u32 s21, s88, 4915200
 v_mfma_f32_16x16x32_bf16 v[52:55], v[148:151], v[108:111], v[52:55]
 buffer_load_dwordx4 v28, s[12:15], s21 offen offset:0 lds
 v_mfma_f32_16x16x32_bf16 v[60:63], v[148:151], v[132:135], v[60:63]
 buffer_load_dwordx4 v29, s[12:15], s21 offen offset:1024 lds
 s_waitcnt lgkmcnt(2)
 v_mfma_f32_16x16x32_bf16 v[40:43], v[136:139], v[64:67], 0
 ds_read_b128 v[148:151], v23 offset:12416
 buffer_load_dwordx4 v30, s[12:15], s21 offen offset:2048 lds
 s_waitcnt vmcnt(18)
 v_mfma_f32_16x16x32_bf16 v[48:51], v[136:139], v[88:91], 0
 s_add_u32 m0, s81, 3072
 s_add_u32 s21, s88, 4964352
 ds_write_b128 v251, v[232:235] offset:36864
 v_mfma_f32_16x16x32_bf16 v[56:59], v[136:139], v[112:115], 0
 buffer_load_dwordx4 v31, s[12:15], s21 offen offset:0 lds
 ds_write_b128 v251, v[236:239] offset:37888
 s_waitcnt lgkmcnt(4)
 v_mfma_f32_16x16x32_bf16 v[40:43], v[140:143], v[68:71], v[40:43]
 ds_read_b128 v[136:139], v22 offset:12544
 v_cvt_pk_f16_f32 v44, v44, v45
 buffer_load_dwordx4 v32, s[12:15], s21 offen offset:1024 lds
 v_accvgpr_write_b32 a194, v44
 v_mfma_f32_16x16x32_bf16 v[48:51], v[140:143], v[92:95], v[48:51]
 v_cvt_pk_f16_f32 v46, v46, v47
 buffer_load_dwordx4 v33, s[12:15], s21 offen offset:2048 lds
 ds_write_b128 v251, v[240:243] offset:38912
 v_mfma_f32_16x16x32_bf16 v[56:59], v[140:143], v[116:119], v[56:59]
 v_accvgpr_write_b32 a195, v46
 s_add_u32 m0, s81, 6144
 s_add_u32 s21, s88, 5406720
 ds_read_b64_tr_b16 v[208:209], v250 offset:36864
 s_waitcnt lgkmcnt(6)
 v_mfma_f32_16x16x32_bf16 v[40:43], v[144:147], v[72:75], v[40:43]
 ds_read_b128 v[140:143], v23 offset:12544
 v_cvt_pk_f16_f32 v52, v52, v53
 buffer_load_dwordx4 v34, s[12:15], s21 offen offset:0 lds
 ds_read_b64_tr_b16 v[210:211], v250 offset:37248
 v_mfma_f32_16x16x32_bf16 v[48:51], v[144:147], v[96:99], v[48:51]
 v_accvgpr_write_b32 a202, v52
 buffer_load_dwordx4 v35, s[12:15], s21 offen offset:1024 lds
 ds_read_b64_tr_b16 v[212:213], v250 offset:36896
 ds_read_b64_tr_b16 v[214:215], v250 offset:37280
 v_mfma_f32_16x16x32_bf16 v[56:59], v[144:147], v[120:123], v[56:59]
 v_cvt_pk_f16_f32 v54, v54, v55
 buffer_load_dwordx4 v36, s[12:15], s21 offen offset:2048 lds
 ds_read_b64_tr_b16 v[216:217], v250 offset:36928
 s_waitcnt lgkmcnt(10)
 v_mfma_f32_16x16x32_bf16 v[40:43], v[148:151], v[76:79], v[40:43]
 ds_read_b128 v[144:147], v22 offset:13824
 v_accvgpr_write_b32 a203, v54
 s_add_u32 m0, s81, 9216
 s_add_u32 s21, s88, 5455872
 ds_read_b64_tr_b16 v[218:219], v250 offset:37312
 v_mfma_f32_16x16x32_bf16 v[48:51], v[148:151], v[100:103], v[48:51]
 v_cvt_pk_f16_f32 v60, v60, v61
 buffer_load_dwordx4 v37, s[12:15], s21 offen offset:0 lds
 s_add_u32 s22, s80, 196608
 v_accvgpr_write_b32 a210, v60
 v_mfma_f32_16x16x32_bf16 v[56:59], v[148:151], v[124:127], v[56:59]
 v_cvt_pk_f16_f32 v62, v62, v63
 buffer_load_dwordx4 v38, s[12:15], s21 offen offset:1024 lds
 v_accvgpr_write_b32 a211, v62
 s_waitcnt lgkmcnt(9)
 v_mfma_f32_16x16x32_bf16 v[40:43], v[136:139], v[80:83], v[40:43]
 ds_read_b128 v[148:151], v23 offset:13824
 buffer_load_dwordx4 v39, s[12:15], s21 offen offset:2048 lds
 buffer_load_dwordx4 v[232:235], v247, s[36:39], s22 offen
 v_mfma_f32_16x16x32_bf16 v[48:51], v[136:139], v[104:107], v[48:51]
 buffer_load_dwordx4 v[236:239], v248, s[36:39], s22 offen
 buffer_load_dwordx4 v[240:243], v249, s[36:39], s22 offen
 v_mfma_f32_16x16x32_bf16 v[56:59], v[136:139], v[128:131], v[56:59]
 s_waitcnt lgkmcnt(7)
 v_mfma_f32_16x16x32_bf16 v[40:43], v[140:143], v[84:87], v[40:43]
 ds_read_b128 v[136:139], v22 offset:13952
 v_mfma_f32_16x16x32_bf16 v[48:51], v[140:143], v[108:111], v[48:51]
 v_mfma_f32_16x16x32_bf16 v[56:59], v[140:143], v[132:135], v[56:59]
 s_waitcnt lgkmcnt(3)
 v_mfma_f32_16x16x32_bf16 v[44:47], v[144:147], v[64:67], 0
 ds_read_b128 v[140:143], v23 offset:13952
 v_mfma_f32_16x16x32_bf16 v[52:55], v[144:147], v[88:91], 0
 s_waitcnt lgkmcnt(3)
 v_lshlrev_b32 v27, 16, v208
 v_and_b32 v208, 0xffff0000, v208
 v_cvt_pk_f16_f32 v208, v27, v208
 v_accvgpr_write_b32 a8, v208
 v_mfma_f32_16x16x32_bf16 v[60:63], v[144:147], v[112:115], 0
 v_lshlrev_b32 v27, 16, v209
 v_and_b32 v209, 0xffff0000, v209
 v_cvt_pk_f16_f32 v209, v27, v209
 v_accvgpr_write_b32 a9, v209
 s_waitcnt lgkmcnt(2)
 v_mfma_f32_16x16x32_bf16 v[44:47], v[148:151], v[68:71], v[44:47]
 ds_read_b128 v[144:147], v22 offset:14080
 v_cvt_pk_f16_f32 v40, v40, v41
 v_lshlrev_b32 v27, 16, v210
 v_and_b32 v210, 0xffff0000, v210
 v_cvt_pk_f16_f32 v210, v27, v210
 v_mfma_f32_16x16x32_bf16 v[52:55], v[148:151], v[92:95], v[52:55]
 v_accvgpr_write_b32 a196, v40
 v_accvgpr_write_b32 a10, v210
 v_lshlrev_b32 v27, 16, v211
 v_and_b32 v211, 0xffff0000, v211
 v_cvt_pk_f16_f32 v211, v27, v211
 v_mfma_f32_16x16x32_bf16 v[60:63], v[148:151], v[116:119], v[60:63]
 v_cvt_pk_f16_f32 v42, v42, v43
 v_accvgpr_write_b32 a11, v211
 v_lshlrev_b32 v27, 16, v212
 v_and_b32 v212, 0xffff0000, v212
 s_waitcnt lgkmcnt(2)
 v_mfma_f32_16x16x32_bf16 v[44:47], v[136:139], v[72:75], v[44:47]
 ds_read_b128 v[148:151], v23 offset:14080
 v_accvgpr_write_b32 a197, v42
 v_cvt_pk_f16_f32 v212, v27, v212
 v_accvgpr_write_b32 a28, v212
 v_lshlrev_b32 v27, 16, v213
 v_mfma_f32_16x16x32_bf16 v[52:55], v[136:139], v[96:99], v[52:55]
 v_cvt_pk_f16_f32 v48, v48, v49
 v_and_b32 v213, 0xffff0000, v213
 v_cvt_pk_f16_f32 v213, v27, v213
 v_accvgpr_write_b32 a29, v213
 v_lshlrev_b32 v27, 16, v214
 v_mfma_f32_16x16x32_bf16 v[60:63], v[136:139], v[120:123], v[60:63]
 v_accvgpr_write_b32 a204, v48
 v_and_b32 v214, 0xffff0000, v214
 v_cvt_pk_f16_f32 v214, v27, v214
 v_accvgpr_write_b32 a30, v214
 s_waitcnt lgkmcnt(2)
 v_mfma_f32_16x16x32_bf16 v[44:47], v[140:143], v[76:79], v[44:47]
 s_waitcnt vmcnt(18)
 ds_read_b128 v[136:139], v22 offset:24576
 v_cvt_pk_f16_f32 v50, v50, v51
 v_lshlrev_b32 v27, 16, v215
 v_and_b32 v215, 0xffff0000, v215
 v_cvt_pk_f16_f32 v215, v27, v215
 v_mfma_f32_16x16x32_bf16 v[52:55], v[140:143], v[100:103], v[52:55]
 v_accvgpr_write_b32 a205, v50
 v_accvgpr_write_b32 a31, v215
 v_lshlrev_b32 v27, 16, v216
 v_and_b32 v216, 0xffff0000, v216
 v_cvt_pk_f16_f32 v216, v27, v216
 v_mfma_f32_16x16x32_bf16 v[60:63], v[140:143], v[124:127], v[60:63]
 v_cvt_pk_f16_f32 v56, v56, v57
 v_accvgpr_write_b32 a48, v216
 v_lshlrev_b32 v27, 16, v217
 v_and_b32 v217, 0xffff0000, v217
 s_waitcnt lgkmcnt(2)
 v_mfma_f32_16x16x32_bf16 v[44:47], v[144:147], v[80:83], v[44:47]
 ds_read_b128 v[140:143], v23 offset:24576
 v_accvgpr_write_b32 a212, v56
 v_cvt_pk_f16_f32 v217, v27, v217
 v_accvgpr_write_b32 a49, v217
 v_lshlrev_b32 v27, 16, v218
 v_mfma_f32_16x16x32_bf16 v[52:55], v[144:147], v[104:107], v[52:55]
 v_cvt_pk_f16_f32 v58, v58, v59
 v_and_b32 v218, 0xffff0000, v218
 v_cvt_pk_f16_f32 v218, v27, v218
 v_accvgpr_write_b32 a50, v218
 v_lshlrev_b32 v27, 16, v219
 v_mfma_f32_16x16x32_bf16 v[60:63], v[144:147], v[128:131], v[60:63]
 v_accvgpr_write_b32 a213, v58
 v_and_b32 v219, 0xffff0000, v219
 v_cvt_pk_f16_f32 v219, v27, v219
 v_accvgpr_write_b32 a51, v219
 s_waitcnt lgkmcnt(2)
 v_mfma_f32_16x16x32_bf16 v[44:47], v[148:151], v[84:87], v[44:47]
 ds_read_b128 v[144:147], v22 offset:24704
 s_add_u32 m0, s81, 12288
 s_add_u32 s21, s88, 4030464
 v_mfma_f32_16x16x32_bf16 v[52:55], v[148:151], v[108:111], v[52:55]
 buffer_load_dwordx4 v28, s[12:15], s21 offen offset:0 lds
 v_mfma_f32_16x16x32_bf16 v[60:63], v[148:151], v[132:135], v[60:63]
 buffer_load_dwordx4 v29, s[12:15], s21 offen offset:1024 lds
 s_waitcnt lgkmcnt(2)
 v_mfma_f32_16x16x32_bf16 v[40:43], v[136:139], v[64:67], 0
 ds_read_b128 v[148:151], v23 offset:24704
 buffer_load_dwordx4 v30, s[12:15], s21 offen offset:2048 lds
 s_waitcnt vmcnt(18)
 v_mfma_f32_16x16x32_bf16 v[48:51], v[136:139], v[88:91], 0
 s_add_u32 m0, s81, 15360
 s_add_u32 s21, s88, 4079616
 ds_write_b128 v251, v[220:223] offset:36864
 v_mfma_f32_16x16x32_bf16 v[56:59], v[136:139], v[112:115], 0
 buffer_load_dwordx4 v31, s[12:15], s21 offen offset:0 lds
 ds_write_b128 v251, v[224:227] offset:37888
 s_waitcnt lgkmcnt(4)
 v_mfma_f32_16x16x32_bf16 v[40:43], v[140:143], v[68:71], v[40:43]
 ds_read_b128 v[136:139], v22 offset:24832
 v_cvt_pk_f16_f32 v44, v44, v45
 buffer_load_dwordx4 v32, s[12:15], s21 offen offset:1024 lds
 v_accvgpr_write_b32 a198, v44
 v_mfma_f32_16x16x32_bf16 v[48:51], v[140:143], v[92:95], v[48:51]
 v_cvt_pk_f16_f32 v46, v46, v47
 buffer_load_dwordx4 v33, s[12:15], s21 offen offset:2048 lds
 ds_write_b128 v251, v[228:231] offset:38912
 v_mfma_f32_16x16x32_bf16 v[56:59], v[140:143], v[116:119], v[56:59]
 v_accvgpr_write_b32 a199, v46
 s_add_u32 m0, s81, 18432
 s_add_u32 s21, s88, 4521984
 ds_read_b64_tr_b16 v[208:209], v250 offset:36864
 s_waitcnt lgkmcnt(6)
 v_mfma_f32_16x16x32_bf16 v[40:43], v[144:147], v[72:75], v[40:43]
 ds_read_b128 v[140:143], v23 offset:24832
 v_cvt_pk_f16_f32 v52, v52, v53
 buffer_load_dwordx4 v34, s[12:15], s21 offen offset:0 lds
 ds_read_b64_tr_b16 v[210:211], v250 offset:37248
 v_mfma_f32_16x16x32_bf16 v[48:51], v[144:147], v[96:99], v[48:51]
 v_accvgpr_write_b32 a206, v52
 buffer_load_dwordx4 v35, s[12:15], s21 offen offset:1024 lds
 ds_read_b64_tr_b16 v[212:213], v250 offset:36896
 ds_read_b64_tr_b16 v[214:215], v250 offset:37280
 v_mfma_f32_16x16x32_bf16 v[56:59], v[144:147], v[120:123], v[56:59]
 v_cvt_pk_f16_f32 v54, v54, v55
 buffer_load_dwordx4 v36, s[12:15], s21 offen offset:2048 lds
 ds_read_b64_tr_b16 v[216:217], v250 offset:36928
 s_waitcnt lgkmcnt(10)
 v_mfma_f32_16x16x32_bf16 v[40:43], v[148:151], v[76:79], v[40:43]
 ds_read_b128 v[144:147], v22 offset:26112
 v_accvgpr_write_b32 a207, v54
 s_add_u32 m0, s81, 21504
 s_add_u32 s21, s88, 4571136
 ds_read_b64_tr_b16 v[218:219], v250 offset:37312
 v_mfma_f32_16x16x32_bf16 v[48:51], v[148:151], v[100:103], v[48:51]
 v_cvt_pk_f16_f32 v60, v60, v61
 buffer_load_dwordx4 v37, s[12:15], s21 offen offset:0 lds
 v_accvgpr_write_b32 a214, v60
 v_mfma_f32_16x16x32_bf16 v[56:59], v[148:151], v[124:127], v[56:59]
 v_cvt_pk_f16_f32 v62, v62, v63
 buffer_load_dwordx4 v38, s[12:15], s21 offen offset:1024 lds
 v_accvgpr_write_b32 a215, v62
 s_waitcnt lgkmcnt(9)
 v_mfma_f32_16x16x32_bf16 v[40:43], v[136:139], v[80:83], v[40:43]
 ds_read_b128 v[148:151], v23 offset:26112
 buffer_load_dwordx4 v39, s[12:15], s21 offen offset:2048 lds
 v_mfma_f32_16x16x32_bf16 v[48:51], v[136:139], v[104:107], v[48:51]
 buffer_load_dword v0, v26, s[32:35], 0 offen sc1
 v_mfma_f32_16x16x32_bf16 v[56:59], v[136:139], v[128:131], v[56:59]
 s_waitcnt lgkmcnt(7)
 v_mfma_f32_16x16x32_bf16 v[40:43], v[140:143], v[84:87], v[40:43]
 ds_read_b128 v[136:139], v22 offset:26240
 v_mfma_f32_16x16x32_bf16 v[48:51], v[140:143], v[108:111], v[48:51]
 s_waitcnt lgkmcnt(2)
 v_lshlrev_b32 v27, 16, v208
 v_and_b32 v208, 0xffff0000, v208
 v_cvt_pk_f16_f32 v208, v27, v208
 v_accvgpr_write_b32 a12, v208
 v_mfma_f32_16x16x32_bf16 v[56:59], v[140:143], v[132:135], v[56:59]
 v_lshlrev_b32 v27, 16, v209
 v_and_b32 v209, 0xffff0000, v209
 v_cvt_pk_f16_f32 v209, v27, v209
 v_accvgpr_write_b32 a13, v209
 s_waitcnt lgkmcnt(3)
 v_mfma_f32_16x16x32_bf16 v[44:47], v[144:147], v[64:67], 0
 ds_read_b128 v[140:143], v23 offset:26240
 v_lshlrev_b32 v27, 16, v210
 v_and_b32 v210, 0xffff0000, v210
 v_cvt_pk_f16_f32 v210, v27, v210
 v_accvgpr_write_b32 a14, v210
 v_mfma_f32_16x16x32_bf16 v[52:55], v[144:147], v[88:91], 0
 v_lshlrev_b32 v27, 16, v211
 v_and_b32 v211, 0xffff0000, v211
 v_cvt_pk_f16_f32 v211, v27, v211
 v_accvgpr_write_b32 a15, v211
 v_lshlrev_b32 v27, 16, v212
 v_mfma_f32_16x16x32_bf16 v[60:63], v[144:147], v[112:115], 0
 v_and_b32 v212, 0xffff0000, v212
 v_cvt_pk_f16_f32 v212, v27, v212
 v_accvgpr_write_b32 a32, v212
 v_lshlrev_b32 v27, 16, v213
 s_waitcnt lgkmcnt(2)
 v_mfma_f32_16x16x32_bf16 v[44:47], v[148:151], v[68:71], v[44:47]
 ds_read_b128 v[144:147], v22 offset:26368
 v_cvt_pk_f16_f32 v40, v40, v41
 v_and_b32 v213, 0xffff0000, v213
 v_cvt_pk_f16_f32 v213, v27, v213
 v_accvgpr_write_b32 a33, v213
 v_mfma_f32_16x16x32_bf16 v[52:55], v[148:151], v[92:95], v[52:55]
 v_accvgpr_write_b32 a216, v40
 v_lshlrev_b32 v27, 16, v214
 v_and_b32 v214, 0xffff0000, v214
 v_cvt_pk_f16_f32 v214, v27, v214
 v_accvgpr_write_b32 a34, v214
 v_mfma_f32_16x16x32_bf16 v[60:63], v[148:151], v[116:119], v[60:63]
 v_cvt_pk_f16_f32 v42, v42, v43
 v_lshlrev_b32 v27, 16, v215
 v_and_b32 v215, 0xffff0000, v215
 v_cvt_pk_f16_f32 v215, v27, v215
 s_waitcnt lgkmcnt(2)
 v_mfma_f32_16x16x32_bf16 v[44:47], v[136:139], v[72:75], v[44:47]
 ds_read_b128 v[148:151], v23 offset:26368
 v_accvgpr_write_b32 a217, v42
 v_accvgpr_write_b32 a35, v215
 v_lshlrev_b32 v27, 16, v216
 v_and_b32 v216, 0xffff0000, v216
 v_mfma_f32_16x16x32_bf16 v[52:55], v[136:139], v[96:99], v[52:55]
 v_cvt_pk_f16_f32 v48, v48, v49
 v_cvt_pk_f16_f32 v216, v27, v216
 v_accvgpr_write_b32 a52, v216
 v_lshlrev_b32 v27, 16, v217
 v_and_b32 v217, 0xffff0000, v217
 v_mfma_f32_16x16x32_bf16 v[60:63], v[136:139], v[120:123], v[60:63]
 v_accvgpr_write_b32 a224, v48
 v_cvt_pk_f16_f32 v217, v27, v217
 v_accvgpr_write_b32 a53, v217
 v_lshlrev_b32 v27, 16, v218
 s_waitcnt lgkmcnt(2)
 v_mfma_f32_16x16x32_bf16 v[44:47], v[140:143], v[76:79], v[44:47]
 s_waitcnt vmcnt(16)
 ds_read_b128 v[136:139], v22 offset:0
 v_cvt_pk_f16_f32 v50, v50, v51
 v_and_b32 v218, 0xffff0000, v218
 v_cvt_pk_f16_f32 v218, v27, v218
 v_accvgpr_write_b32 a54, v218
 v_mfma_f32_16x16x32_bf16 v[52:55], v[140:143], v[100:103], v[52:55]
 v_accvgpr_write_b32 a225, v50
 v_lshlrev_b32 v27, 16, v219
 v_and_b32 v219, 0xffff0000, v219
 v_cvt_pk_f16_f32 v219, v27, v219
 v_accvgpr_write_b32 a55, v219
 v_mfma_f32_16x16x32_bf16 v[60:63], v[140:143], v[124:127], v[60:63]
 v_cvt_pk_f16_f32 v56, v56, v57
 v_accvgpr_write_b32 a232, v56
 v_cvt_pk_f16_f32 v58, v58, v59
 v_accvgpr_write_b32 a233, v58
 s_waitcnt lgkmcnt(2)
 v_mfma_f32_16x16x32_bf16 v[44:47], v[144:147], v[80:83], v[44:47]
 ds_read_b128 v[140:143], v23 offset:0
 v_mfma_f32_16x16x32_bf16 v[52:55], v[144:147], v[104:107], v[52:55]
 v_mfma_f32_16x16x32_bf16 v[60:63], v[144:147], v[128:131], v[60:63]
 s_waitcnt lgkmcnt(2)
 v_mfma_f32_16x16x32_bf16 v[44:47], v[148:151], v[84:87], v[44:47]
 ds_read_b128 v[144:147], v22 offset:128
 s_add_u32 m0, s81, 24576
 s_add_u32 s21, s88, 5013504
 v_mfma_f32_16x16x32_bf16 v[52:55], v[148:151], v[108:111], v[52:55]
 buffer_load_dwordx4 v28, s[12:15], s21 offen offset:0 lds
 v_mfma_f32_16x16x32_bf16 v[60:63], v[148:151], v[132:135], v[60:63]
 buffer_load_dwordx4 v29, s[12:15], s21 offen offset:1024 lds
 s_waitcnt lgkmcnt(2)
 v_mfma_f32_16x16x32_bf16 v[40:43], v[136:139], v[64:67], 0
 ds_read_b128 v[148:151], v23 offset:128
 buffer_load_dwordx4 v30, s[12:15], s21 offen offset:2048 lds
 s_waitcnt vmcnt(16)
 v_mfma_f32_16x16x32_bf16 v[48:51], v[136:139], v[88:91], 0
 s_add_u32 m0, s81, 27648
 s_add_u32 s21, s88, 5062656
 ds_write_b128 v251, v[232:235] offset:36864
 v_mfma_f32_16x16x32_bf16 v[56:59], v[136:139], v[112:115], 0
 buffer_load_dwordx4 v31, s[12:15], s21 offen offset:0 lds
 ds_write_b128 v251, v[236:239] offset:37888
 s_waitcnt lgkmcnt(4)
 v_mfma_f32_16x16x32_bf16 v[40:43], v[140:143], v[68:71], v[40:43]
 ds_read_b128 v[136:139], v22 offset:256
 v_cvt_pk_f16_f32 v44, v44, v45
 buffer_load_dwordx4 v32, s[12:15], s21 offen offset:1024 lds
 v_accvgpr_write_b32 a218, v44
 v_mfma_f32_16x16x32_bf16 v[48:51], v[140:143], v[92:95], v[48:51]
 v_cvt_pk_f16_f32 v46, v46, v47
 buffer_load_dwordx4 v33, s[12:15], s21 offen offset:2048 lds
 ds_write_b128 v251, v[240:243] offset:38912
 v_mfma_f32_16x16x32_bf16 v[56:59], v[140:143], v[116:119], v[56:59]
 v_accvgpr_write_b32 a219, v46
 s_add_u32 m0, s81, 30720
 s_add_u32 s21, s88, 5505024
 ds_read_b64_tr_b16 v[208:209], v250 offset:36864
 s_waitcnt lgkmcnt(6)
 v_mfma_f32_16x16x32_bf16 v[40:43], v[144:147], v[72:75], v[40:43]
 ds_read_b128 v[140:143], v23 offset:256
 v_cvt_pk_f16_f32 v52, v52, v53
 buffer_load_dwordx4 v34, s[12:15], s21 offen offset:0 lds
 ds_read_b64_tr_b16 v[210:211], v250 offset:37248
 v_mfma_f32_16x16x32_bf16 v[48:51], v[144:147], v[96:99], v[48:51]
 v_accvgpr_write_b32 a226, v52
 buffer_load_dwordx4 v35, s[12:15], s21 offen offset:1024 lds
 ds_read_b64_tr_b16 v[212:213], v250 offset:36896
 ds_read_b64_tr_b16 v[214:215], v250 offset:37280
 v_mfma_f32_16x16x32_bf16 v[56:59], v[144:147], v[120:123], v[56:59]
 v_cvt_pk_f16_f32 v54, v54, v55
 buffer_load_dwordx4 v36, s[12:15], s21 offen offset:2048 lds
 ds_read_b64_tr_b16 v[216:217], v250 offset:36928
 s_waitcnt lgkmcnt(10)
 v_mfma_f32_16x16x32_bf16 v[40:43], v[148:151], v[76:79], v[40:43]
 ds_read_b128 v[144:147], v22 offset:1536
 v_accvgpr_write_b32 a227, v54
 s_add_u32 m0, s81, 33792
 s_add_u32 s21, s88, 5554176
 ds_read_b64_tr_b16 v[218:219], v250 offset:37312
 v_mfma_f32_16x16x32_bf16 v[48:51], v[148:151], v[100:103], v[48:51]
 v_cvt_pk_f16_f32 v60, v60, v61
 buffer_load_dwordx4 v37, s[12:15], s21 offen offset:0 lds
 v_accvgpr_write_b32 a234, v60
 v_mfma_f32_16x16x32_bf16 v[56:59], v[148:151], v[124:127], v[56:59]
 v_cvt_pk_f16_f32 v62, v62, v63
 buffer_load_dwordx4 v38, s[12:15], s21 offen offset:1024 lds
 v_accvgpr_write_b32 a235, v62
 s_waitcnt lgkmcnt(9)
 v_mfma_f32_16x16x32_bf16 v[40:43], v[136:139], v[80:83], v[40:43]
 ds_read_b128 v[148:151], v23 offset:1536
 buffer_load_dwordx4 v39, s[12:15], s21 offen offset:2048 lds
 v_mfma_f32_16x16x32_bf16 v[48:51], v[136:139], v[104:107], v[48:51]
 v_mfma_f32_16x16x32_bf16 v[56:59], v[136:139], v[128:131], v[56:59]
 s_waitcnt lgkmcnt(7)
 v_mfma_f32_16x16x32_bf16 v[40:43], v[140:143], v[84:87], v[40:43]
 ds_read_b128 v[136:139], v22 offset:1664
 v_mfma_f32_16x16x32_bf16 v[48:51], v[140:143], v[108:111], v[48:51]
 s_waitcnt lgkmcnt(2)
 v_lshlrev_b32 v27, 16, v208
 v_and_b32 v208, 0xffff0000, v208
 v_cvt_pk_f16_f32 v208, v27, v208
 v_accvgpr_write_b32 a16, v208
 v_mfma_f32_16x16x32_bf16 v[56:59], v[140:143], v[132:135], v[56:59]
 v_lshlrev_b32 v27, 16, v209
 v_and_b32 v209, 0xffff0000, v209
 v_cvt_pk_f16_f32 v209, v27, v209
 v_accvgpr_write_b32 a17, v209
 s_waitcnt lgkmcnt(3)
 v_mfma_f32_16x16x32_bf16 v[44:47], v[144:147], v[64:67], 0
 ds_read_b128 v[140:143], v23 offset:1664
 v_lshlrev_b32 v27, 16, v210
 v_and_b32 v210, 0xffff0000, v210
 v_cvt_pk_f16_f32 v210, v27, v210
 v_accvgpr_write_b32 a18, v210
 v_mfma_f32_16x16x32_bf16 v[52:55], v[144:147], v[88:91], 0
 v_lshlrev_b32 v27, 16, v211
 v_and_b32 v211, 0xffff0000, v211
 v_cvt_pk_f16_f32 v211, v27, v211
 v_accvgpr_write_b32 a19, v211
 v_lshlrev_b32 v27, 16, v212
 v_mfma_f32_16x16x32_bf16 v[60:63], v[144:147], v[112:115], 0
 v_and_b32 v212, 0xffff0000, v212
 v_cvt_pk_f16_f32 v212, v27, v212
 v_accvgpr_write_b32 a36, v212
 v_lshlrev_b32 v27, 16, v213
 s_waitcnt lgkmcnt(2)
 v_mfma_f32_16x16x32_bf16 v[44:47], v[148:151], v[68:71], v[44:47]
 ds_read_b128 v[144:147], v22 offset:1792
 v_cvt_pk_f16_f32 v40, v40, v41
 v_and_b32 v213, 0xffff0000, v213
 v_cvt_pk_f16_f32 v213, v27, v213
 v_accvgpr_write_b32 a37, v213
 v_mfma_f32_16x16x32_bf16 v[52:55], v[148:151], v[92:95], v[52:55]
 v_accvgpr_write_b32 a220, v40
 v_lshlrev_b32 v27, 16, v214
 v_and_b32 v214, 0xffff0000, v214
 v_cvt_pk_f16_f32 v214, v27, v214
 v_accvgpr_write_b32 a38, v214
 v_mfma_f32_16x16x32_bf16 v[60:63], v[148:151], v[116:119], v[60:63]
 v_cvt_pk_f16_f32 v42, v42, v43
 v_lshlrev_b32 v27, 16, v215
 v_and_b32 v215, 0xffff0000, v215
 v_cvt_pk_f16_f32 v215, v27, v215
 s_waitcnt lgkmcnt(2)
 v_mfma_f32_16x16x32_bf16 v[44:47], v[136:139], v[72:75], v[44:47]
 ds_read_b128 v[148:151], v23 offset:1792
 v_accvgpr_write_b32 a221, v42
 v_accvgpr_write_b32 a39, v215
 v_lshlrev_b32 v27, 16, v216
 v_and_b32 v216, 0xffff0000, v216
 v_mfma_f32_16x16x32_bf16 v[52:55], v[136:139], v[96:99], v[52:55]
 v_cvt_pk_f16_f32 v48, v48, v49
 v_cvt_pk_f16_f32 v216, v27, v216
 v_accvgpr_write_b32 a56, v216
 v_lshlrev_b32 v27, 16, v217
 v_and_b32 v217, 0xffff0000, v217
 v_mfma_f32_16x16x32_bf16 v[60:63], v[136:139], v[120:123], v[60:63]
 v_accvgpr_write_b32 a228, v48
 v_cvt_pk_f16_f32 v217, v27, v217
 v_accvgpr_write_b32 a57, v217
 v_lshlrev_b32 v27, 16, v218
 s_waitcnt lgkmcnt(2)
 v_mfma_f32_16x16x32_bf16 v[44:47], v[140:143], v[76:79], v[44:47]
 s_waitcnt vmcnt(13)
 ds_read_b128 v[136:139], v22 offset:12288
 v_cvt_pk_f16_f32 v50, v50, v51
 v_and_b32 v218, 0xffff0000, v218
 v_cvt_pk_f16_f32 v218, v27, v218
 v_accvgpr_write_b32 a58, v218
 v_mfma_f32_16x16x32_bf16 v[52:55], v[140:143], v[100:103], v[52:55]
 v_accvgpr_write_b32 a229, v50
 v_lshlrev_b32 v27, 16, v219
 v_and_b32 v219, 0xffff0000, v219
 v_cvt_pk_f16_f32 v219, v27, v219
 v_accvgpr_write_b32 a59, v219
 v_mfma_f32_16x16x32_bf16 v[60:63], v[140:143], v[124:127], v[60:63]
 v_cvt_pk_f16_f32 v56, v56, v57
 v_accvgpr_write_b32 a236, v56
 v_cvt_pk_f16_f32 v58, v58, v59
 v_accvgpr_write_b32 a237, v58
 s_waitcnt lgkmcnt(2)
 v_mfma_f32_16x16x32_bf16 v[44:47], v[144:147], v[80:83], v[44:47]
 ds_read_b128 v[140:143], v23 offset:12288
 v_mfma_f32_16x16x32_bf16 v[52:55], v[144:147], v[104:107], v[52:55]
 v_mfma_f32_16x16x32_bf16 v[60:63], v[144:147], v[128:131], v[60:63]
 s_waitcnt lgkmcnt(2)
 v_mfma_f32_16x16x32_bf16 v[44:47], v[148:151], v[84:87], v[44:47]
 ds_read_b128 v[144:147], v22 offset:12416
 s_add_u32 m0, s81, 0
 s_add_u32 s21, s88, 5898240
 v_mfma_f32_16x16x32_bf16 v[52:55], v[148:151], v[108:111], v[52:55]
 buffer_load_dwordx4 v28, s[12:15], s21 offen offset:0 lds
 v_mfma_f32_16x16x32_bf16 v[60:63], v[148:151], v[132:135], v[60:63]
 buffer_load_dwordx4 v29, s[12:15], s21 offen offset:1024 lds
 s_waitcnt lgkmcnt(2)
 v_mfma_f32_16x16x32_bf16 v[40:43], v[136:139], v[64:67], 0
 ds_read_b128 v[148:151], v23 offset:12416
 buffer_load_dwordx4 v30, s[12:15], s21 offen offset:2048 lds
 v_mfma_f32_16x16x32_bf16 v[48:51], v[136:139], v[88:91], 0
 s_add_u32 m0, s81, 3072
 s_add_u32 s21, s88, 5947392
 v_mfma_f32_16x16x32_bf16 v[56:59], v[136:139], v[112:115], 0
 buffer_load_dwordx4 v31, s[12:15], s21 offen offset:0 lds
 s_waitcnt lgkmcnt(2)
 v_mfma_f32_16x16x32_bf16 v[40:43], v[140:143], v[68:71], v[40:43]
 ds_read_b128 v[136:139], v22 offset:12544
 v_cvt_pk_f16_f32 v44, v44, v45
 buffer_load_dwordx4 v32, s[12:15], s21 offen offset:1024 lds
 v_accvgpr_write_b32 a222, v44
 v_mfma_f32_16x16x32_bf16 v[48:51], v[140:143], v[92:95], v[48:51]
 v_cvt_pk_f16_f32 v46, v46, v47
 buffer_load_dwordx4 v33, s[12:15], s21 offen offset:2048 lds
 v_accvgpr_write_b32 a223, v46
 v_cvt_pk_f16_f32 v52, v52, v53
 v_mfma_f32_16x16x32_bf16 v[56:59], v[140:143], v[116:119], v[56:59]
 v_accvgpr_write_b32 a230, v52
 s_add_u32 m0, s81, 6144
 s_add_u32 s21, s88, 6389760
 v_cvt_pk_f16_f32 v54, v54, v55
 s_waitcnt lgkmcnt(2)
 v_mfma_f32_16x16x32_bf16 v[40:43], v[144:147], v[72:75], v[40:43]
 ds_read_b128 v[140:143], v23 offset:12544
 v_accvgpr_write_b32 a231, v54
 buffer_load_dwordx4 v34, s[12:15], s21 offen offset:0 lds
 v_cvt_pk_f16_f32 v60, v60, v61
 v_mfma_f32_16x16x32_bf16 v[48:51], v[144:147], v[96:99], v[48:51]
 v_accvgpr_write_b32 a238, v60
 buffer_load_dwordx4 v35, s[12:15], s21 offen offset:1024 lds
 v_cvt_pk_f16_f32 v62, v62, v63
 v_accvgpr_write_b32 a239, v62
 v_mfma_f32_16x16x32_bf16 v[56:59], v[144:147], v[120:123], v[56:59]
 buffer_load_dwordx4 v36, s[12:15], s21 offen offset:2048 lds
 s_waitcnt lgkmcnt(2)
 v_mfma_f32_16x16x32_bf16 v[40:43], v[148:151], v[76:79], v[40:43]
 ds_read_b128 v[144:147], v22 offset:13824
 s_add_u32 m0, s81, 9216
 s_add_u32 s21, s88, 6438912
 v_mfma_f32_16x16x32_bf16 v[48:51], v[148:151], v[100:103], v[48:51]
 buffer_load_dwordx4 v37, s[12:15], s21 offen offset:0 lds
 v_mfma_f32_16x16x32_bf16 v[56:59], v[148:151], v[124:127], v[56:59]
 buffer_load_dwordx4 v38, s[12:15], s21 offen offset:1024 lds
 s_waitcnt lgkmcnt(2)
 v_mfma_f32_16x16x32_bf16 v[40:43], v[136:139], v[80:83], v[40:43]
 ds_read_b128 v[148:151], v23 offset:13824
 buffer_load_dwordx4 v39, s[12:15], s21 offen offset:2048 lds
 v_mfma_f32_16x16x32_bf16 v[48:51], v[136:139], v[104:107], v[48:51]
 v_mfma_f32_16x16x32_bf16 v[56:59], v[136:139], v[128:131], v[56:59]
 s_waitcnt lgkmcnt(2)
 v_mfma_f32_16x16x32_bf16 v[40:43], v[140:143], v[84:87], v[40:43]
 ds_read_b128 v[136:139], v22 offset:13952
 v_mfma_f32_16x16x32_bf16 v[48:51], v[140:143], v[108:111], v[48:51]
 v_mfma_f32_16x16x32_bf16 v[56:59], v[140:143], v[132:135], v[56:59]
 s_waitcnt lgkmcnt(2)
 v_mfma_f32_16x16x32_bf16 v[44:47], v[144:147], v[64:67], 0
 ds_read_b128 v[140:143], v23 offset:13952
 v_mfma_f32_16x16x32_bf16 v[52:55], v[144:147], v[88:91], 0
 v_mfma_f32_16x16x32_bf16 v[60:63], v[144:147], v[112:115], 0
 s_waitcnt lgkmcnt(2)
 v_mfma_f32_16x16x32_bf16 v[44:47], v[148:151], v[68:71], v[44:47]
 ds_read_b128 v[144:147], v22 offset:14080
 v_cvt_pk_f16_f32 v40, v40, v41
 v_accvgpr_write_b32 a240, v40
 v_cvt_pk_f16_f32 v42, v42, v43
 v_accvgpr_write_b32 a241, v42
 v_mfma_f32_16x16x32_bf16 v[52:55], v[148:151], v[92:95], v[52:55]
 v_cvt_pk_f16_f32 v48, v48, v49
 v_accvgpr_write_b32 a248, v48
 v_cvt_pk_f16_f32 v50, v50, v51
 v_accvgpr_write_b32 a249, v50
 v_cvt_pk_f16_f32 v152, v56, v57
 v_mfma_f32_16x16x32_bf16 v[60:63], v[148:151], v[116:119], v[60:63]
 v_cvt_pk_f16_f32 v153, v58, v59
 s_waitcnt lgkmcnt(2)
 v_mfma_f32_16x16x32_bf16 v[44:47], v[136:139], v[72:75], v[44:47]
 ds_read_b128 v[148:151], v23 offset:14080
 v_mfma_f32_16x16x32_bf16 v[52:55], v[136:139], v[96:99], v[52:55]
 v_mfma_f32_16x16x32_bf16 v[60:63], v[136:139], v[120:123], v[60:63]
 s_waitcnt lgkmcnt(2)
 v_mfma_f32_16x16x32_bf16 v[44:47], v[140:143], v[76:79], v[44:47]
 s_waitcnt vmcnt(12)
 ds_read_b128 v[136:139], v22 offset:24576
 v_mfma_f32_16x16x32_bf16 v[52:55], v[140:143], v[100:103], v[52:55]
 v_mfma_f32_16x16x32_bf16 v[60:63], v[140:143], v[124:127], v[60:63]
 s_waitcnt lgkmcnt(2)
 v_mfma_f32_16x16x32_bf16 v[44:47], v[144:147], v[80:83], v[44:47]
 ds_read_b128 v[140:143], v23 offset:24576
 v_mfma_f32_16x16x32_bf16 v[52:55], v[144:147], v[104:107], v[52:55]
 v_mfma_f32_16x16x32_bf16 v[60:63], v[144:147], v[128:131], v[60:63]
 s_waitcnt lgkmcnt(2)
 v_mfma_f32_16x16x32_bf16 v[44:47], v[148:151], v[84:87], v[44:47]
 ds_read_b128 v[144:147], v22 offset:24704
 s_add_u32 m0, s81, 12288
 s_add_u32 s21, s88, 6881280
 v_mfma_f32_16x16x32_bf16 v[52:55], v[148:151], v[108:111], v[52:55]
 buffer_load_dwordx4 v28, s[12:15], s21 offen offset:0 lds
 v_mfma_f32_16x16x32_bf16 v[60:63], v[148:151], v[132:135], v[60:63]
 buffer_load_dwordx4 v29, s[12:15], s21 offen offset:1024 lds
 s_waitcnt lgkmcnt(2)
 v_mfma_f32_16x16x32_bf16 v[40:43], v[136:139], v[64:67], 0
 ds_read_b128 v[148:151], v23 offset:24704
 buffer_load_dwordx4 v30, s[12:15], s21 offen offset:2048 lds
 v_mfma_f32_16x16x32_bf16 v[48:51], v[136:139], v[88:91], 0
 s_add_u32 m0, s81, 15360
 s_add_u32 s21, s88, 6930432
 v_mfma_f32_16x16x32_bf16 v[56:59], v[136:139], v[112:115], 0
 buffer_load_dwordx4 v31, s[12:15], s21 offen offset:0 lds
 s_waitcnt lgkmcnt(2)
 v_mfma_f32_16x16x32_bf16 v[40:43], v[140:143], v[68:71], v[40:43]
 ds_read_b128 v[136:139], v22 offset:24832
 v_cvt_pk_f16_f32 v44, v44, v45
 buffer_load_dwordx4 v32, s[12:15], s21 offen offset:1024 lds
 v_accvgpr_write_b32 a242, v44
 v_mfma_f32_16x16x32_bf16 v[48:51], v[140:143], v[92:95], v[48:51]
 v_cvt_pk_f16_f32 v46, v46, v47
 buffer_load_dwordx4 v33, s[12:15], s21 offen offset:2048 lds
 v_accvgpr_write_b32 a243, v46
 v_cvt_pk_f16_f32 v52, v52, v53
 v_mfma_f32_16x16x32_bf16 v[56:59], v[140:143], v[116:119], v[56:59]
 v_accvgpr_write_b32 a250, v52
 s_add_u32 m0, s81, 18432
 s_add_u32 s21, s88, 7372800
 v_cvt_pk_f16_f32 v54, v54, v55
 s_waitcnt lgkmcnt(2)
 v_mfma_f32_16x16x32_bf16 v[40:43], v[144:147], v[72:75], v[40:43]
 ds_read_b128 v[140:143], v23 offset:24832
 v_accvgpr_write_b32 a251, v54
 buffer_load_dwordx4 v34, s[12:15], s21 offen offset:0 lds
 v_cvt_pk_f16_f32 v154, v60, v61
 v_mfma_f32_16x16x32_bf16 v[48:51], v[144:147], v[96:99], v[48:51]
 v_cvt_pk_f16_f32 v155, v62, v63
 buffer_load_dwordx4 v35, s[12:15], s21 offen offset:1024 lds
 v_mfma_f32_16x16x32_bf16 v[56:59], v[144:147], v[120:123], v[56:59]
 buffer_load_dwordx4 v36, s[12:15], s21 offen offset:2048 lds
 s_waitcnt lgkmcnt(2)
 v_mfma_f32_16x16x32_bf16 v[40:43], v[148:151], v[76:79], v[40:43]
 ds_read_b128 v[144:147], v22 offset:26112
 s_add_u32 m0, s81, 21504
 s_add_u32 s21, s88, 7421952
 v_mfma_f32_16x16x32_bf16 v[48:51], v[148:151], v[100:103], v[48:51]
 buffer_load_dwordx4 v37, s[12:15], s21 offen offset:0 lds
 v_mfma_f32_16x16x32_bf16 v[56:59], v[148:151], v[124:127], v[56:59]
 buffer_load_dwordx4 v38, s[12:15], s21 offen offset:1024 lds
 s_waitcnt lgkmcnt(2)
 v_mfma_f32_16x16x32_bf16 v[40:43], v[136:139], v[80:83], v[40:43]
 ds_read_b128 v[148:151], v23 offset:26112
 buffer_load_dwordx4 v39, s[12:15], s21 offen offset:2048 lds
 v_mfma_f32_16x16x32_bf16 v[48:51], v[136:139], v[104:107], v[48:51]
 v_mfma_f32_16x16x32_bf16 v[56:59], v[136:139], v[128:131], v[56:59]
 s_waitcnt lgkmcnt(2)
 v_mfma_f32_16x16x32_bf16 v[40:43], v[140:143], v[84:87], v[40:43]
 ds_read_b128 v[136:139], v22 offset:26240
 v_mfma_f32_16x16x32_bf16 v[48:51], v[140:143], v[108:111], v[48:51]
 v_mfma_f32_16x16x32_bf16 v[56:59], v[140:143], v[132:135], v[56:59]
 s_waitcnt lgkmcnt(2)
 v_mfma_f32_16x16x32_bf16 v[44:47], v[144:147], v[64:67], 0
 ds_read_b128 v[140:143], v23 offset:26240
 v_mfma_f32_16x16x32_bf16 v[52:55], v[144:147], v[88:91], 0
 v_mfma_f32_16x16x32_bf16 v[60:63], v[144:147], v[112:115], 0
 s_waitcnt lgkmcnt(2)
 v_mfma_f32_16x16x32_bf16 v[44:47], v[148:151], v[68:71], v[44:47]
 ds_read_b128 v[144:147], v22 offset:26368
 v_cvt_pk_f16_f32 v40, v40, v41
 v_accvgpr_write_b32 a244, v40
 v_cvt_pk_f16_f32 v42, v42, v43
 v_accvgpr_write_b32 a245, v42
 v_mfma_f32_16x16x32_bf16 v[52:55], v[148:151], v[92:95], v[52:55]
 v_cvt_pk_f16_f32 v48, v48, v49
 v_accvgpr_write_b32 a252, v48
 v_cvt_pk_f16_f32 v50, v50, v51
 v_accvgpr_write_b32 a253, v50
 v_cvt_pk_f16_f32 v156, v56, v57
 v_mfma_f32_16x16x32_bf16 v[60:63], v[148:151], v[116:119], v[60:63]
 v_cvt_pk_f16_f32 v157, v58, v59
 s_waitcnt lgkmcnt(2)
 v_mfma_f32_16x16x32_bf16 v[44:47], v[136:139], v[72:75], v[44:47]
 ds_read_b128 v[148:151], v23 offset:26368
 v_mfma_f32_16x16x32_bf16 v[52:55], v[136:139], v[96:99], v[52:55]
 v_mfma_f32_16x16x32_bf16 v[60:63], v[136:139], v[120:123], v[60:63]
 s_waitcnt lgkmcnt(2)
 v_mfma_f32_16x16x32_bf16 v[44:47], v[140:143], v[76:79], v[44:47]
 s_waitcnt vmcnt(12)
 ds_read_b128 v[136:139], v22 offset:0
 v_mfma_f32_16x16x32_bf16 v[52:55], v[140:143], v[100:103], v[52:55]
 v_mfma_f32_16x16x32_bf16 v[60:63], v[140:143], v[124:127], v[60:63]
 s_waitcnt lgkmcnt(2)
 v_mfma_f32_16x16x32_bf16 v[44:47], v[144:147], v[80:83], v[44:47]
 ds_read_b128 v[140:143], v23 offset:0
 v_mfma_f32_16x16x32_bf16 v[52:55], v[144:147], v[104:107], v[52:55]
 v_mfma_f32_16x16x32_bf16 v[60:63], v[144:147], v[128:131], v[60:63]
 s_waitcnt lgkmcnt(2)
 v_mfma_f32_16x16x32_bf16 v[44:47], v[148:151], v[84:87], v[44:47]
 ds_read_b128 v[144:147], v22 offset:128
 s_add_u32 m0, s81, 24576
 s_add_u32 s21, s88, 5996544
 v_mfma_f32_16x16x32_bf16 v[52:55], v[148:151], v[108:111], v[52:55]
 buffer_load_dwordx4 v28, s[12:15], s21 offen offset:0 lds
 v_mfma_f32_16x16x32_bf16 v[60:63], v[148:151], v[132:135], v[60:63]
 buffer_load_dwordx4 v29, s[12:15], s21 offen offset:1024 lds
 s_waitcnt lgkmcnt(2)
 v_mfma_f32_16x16x32_bf16 v[40:43], v[136:139], v[64:67], 0
 ds_read_b128 v[148:151], v23 offset:128
 buffer_load_dwordx4 v30, s[12:15], s21 offen offset:2048 lds
 v_mfma_f32_16x16x32_bf16 v[48:51], v[136:139], v[88:91], 0
 s_add_u32 m0, s81, 27648
 s_add_u32 s21, s88, 6045696
 v_mfma_f32_16x16x32_bf16 v[56:59], v[136:139], v[112:115], 0
 buffer_load_dwordx4 v31, s[12:15], s21 offen offset:0 lds
 s_waitcnt lgkmcnt(2)
 v_mfma_f32_16x16x32_bf16 v[40:43], v[140:143], v[68:71], v[40:43]
 ds_read_b128 v[136:139], v22 offset:256
 v_cvt_pk_f16_f32 v44, v44, v45
 buffer_load_dwordx4 v32, s[12:15], s21 offen offset:1024 lds
 v_accvgpr_write_b32 a246, v44
 v_mfma_f32_16x16x32_bf16 v[48:51], v[140:143], v[92:95], v[48:51]
 v_cvt_pk_f16_f32 v46, v46, v47
 buffer_load_dwordx4 v33, s[12:15], s21 offen offset:2048 lds
 v_accvgpr_write_b32 a247, v46
 v_cvt_pk_f16_f32 v52, v52, v53
 v_mfma_f32_16x16x32_bf16 v[56:59], v[140:143], v[116:119], v[56:59]
 v_accvgpr_write_b32 a254, v52
 s_add_u32 m0, s81, 30720
 s_add_u32 s21, s88, 6488064
 v_cvt_pk_f16_f32 v54, v54, v55
 s_waitcnt lgkmcnt(2)
 v_mfma_f32_16x16x32_bf16 v[40:43], v[144:147], v[72:75], v[40:43]
 ds_read_b128 v[140:143], v23 offset:256
 v_accvgpr_write_b32 a255, v54
 buffer_load_dwordx4 v34, s[12:15], s21 offen offset:0 lds
 v_cvt_pk_f16_f32 v158, v60, v61
 v_mfma_f32_16x16x32_bf16 v[48:51], v[144:147], v[96:99], v[48:51]
 v_cvt_pk_f16_f32 v159, v62, v63
 buffer_load_dwordx4 v35, s[12:15], s21 offen offset:1024 lds
 v_mfma_f32_16x16x32_bf16 v[56:59], v[144:147], v[120:123], v[56:59]
 buffer_load_dwordx4 v36, s[12:15], s21 offen offset:2048 lds
 s_waitcnt lgkmcnt(2)
 v_mfma_f32_16x16x32_bf16 v[40:43], v[148:151], v[76:79], v[40:43]
 ds_read_b128 v[144:147], v22 offset:1536
 s_add_u32 m0, s81, 33792
 s_add_u32 s21, s88, 6537216
 v_mfma_f32_16x16x32_bf16 v[48:51], v[148:151], v[100:103], v[48:51]
 buffer_load_dwordx4 v37, s[12:15], s21 offen offset:0 lds
 v_mfma_f32_16x16x32_bf16 v[56:59], v[148:151], v[124:127], v[56:59]
 buffer_load_dwordx4 v38, s[12:15], s21 offen offset:1024 lds
 s_waitcnt lgkmcnt(2)
 v_mfma_f32_16x16x32_bf16 v[40:43], v[136:139], v[80:83], v[40:43]
 ds_read_b128 v[148:151], v23 offset:1536
 buffer_load_dwordx4 v39, s[12:15], s21 offen offset:2048 lds
 v_mfma_f32_16x16x32_bf16 v[48:51], v[136:139], v[104:107], v[48:51]
 v_mfma_f32_16x16x32_bf16 v[56:59], v[136:139], v[128:131], v[56:59]
 s_waitcnt lgkmcnt(2)
 v_mfma_f32_16x16x32_bf16 v[40:43], v[140:143], v[84:87], v[40:43]
 ds_read_b128 v[136:139], v22 offset:1664
 v_mfma_f32_16x16x32_bf16 v[48:51], v[140:143], v[108:111], v[48:51]
 v_mfma_f32_16x16x32_bf16 v[56:59], v[140:143], v[132:135], v[56:59]
 s_waitcnt lgkmcnt(2)
 v_mfma_f32_16x16x32_bf16 v[44:47], v[144:147], v[64:67], 0
 ds_read_b128 v[140:143], v23 offset:1664
 v_mfma_f32_16x16x32_bf16 v[52:55], v[144:147], v[88:91], 0
 v_mfma_f32_16x16x32_bf16 v[60:63], v[144:147], v[112:115], 0
 s_waitcnt lgkmcnt(2)
 v_mfma_f32_16x16x32_bf16 v[44:47], v[148:151], v[68:71], v[44:47]
 ds_read_b128 v[144:147], v22 offset:1792
 v_cvt_pk_f16_f32 v160, v40, v41
 v_cvt_pk_f16_f32 v161, v42, v43
 v_cvt_pk_f16_f32 v168, v48, v49
 v_cvt_pk_f16_f32 v169, v50, v51
 v_mfma_f32_16x16x32_bf16 v[52:55], v[148:151], v[92:95], v[52:55]
 v_cvt_pk_f16_f32 v176, v56, v57
 v_cvt_pk_f16_f32 v177, v58, v59
 v_mfma_f32_16x16x32_bf16 v[60:63], v[148:151], v[116:119], v[60:63]
 s_waitcnt lgkmcnt(2)
 v_mfma_f32_16x16x32_bf16 v[44:47], v[136:139], v[72:75], v[44:47]
 ds_read_b128 v[148:151], v23 offset:1792
 v_mfma_f32_16x16x32_bf16 v[52:55], v[136:139], v[96:99], v[52:55]
 v_mfma_f32_16x16x32_bf16 v[60:63], v[136:139], v[120:123], v[60:63]
 s_waitcnt lgkmcnt(2)
 v_mfma_f32_16x16x32_bf16 v[44:47], v[140:143], v[76:79], v[44:47]
 s_waitcnt vmcnt(12)
 ds_read_b128 v[136:139], v22 offset:12288
 v_mfma_f32_16x16x32_bf16 v[52:55], v[140:143], v[100:103], v[52:55]
 v_mfma_f32_16x16x32_bf16 v[60:63], v[140:143], v[124:127], v[60:63]
 s_waitcnt lgkmcnt(2)
 v_mfma_f32_16x16x32_bf16 v[44:47], v[144:147], v[80:83], v[44:47]
 ds_read_b128 v[140:143], v23 offset:12288
 v_mfma_f32_16x16x32_bf16 v[52:55], v[144:147], v[104:107], v[52:55]
 v_mfma_f32_16x16x32_bf16 v[60:63], v[144:147], v[128:131], v[60:63]
 s_waitcnt lgkmcnt(2)
 v_mfma_f32_16x16x32_bf16 v[44:47], v[148:151], v[84:87], v[44:47]
 ds_read_b128 v[144:147], v22 offset:12416
 s_add_u32 m0, s81, 0
 s_add_u32 s21, s88, 6979584
 v_mfma_f32_16x16x32_bf16 v[52:55], v[148:151], v[108:111], v[52:55]
 buffer_load_dwordx4 v28, s[12:15], s21 offen offset:0 lds
 v_mfma_f32_16x16x32_bf16 v[60:63], v[148:151], v[132:135], v[60:63]
 buffer_load_dwordx4 v29, s[12:15], s21 offen offset:1024 lds
 s_waitcnt lgkmcnt(2)
 v_mfma_f32_16x16x32_bf16 v[40:43], v[136:139], v[64:67], 0
 ds_read_b128 v[148:151], v23 offset:12416
 buffer_load_dwordx4 v30, s[12:15], s21 offen offset:2048 lds
 v_mfma_f32_16x16x32_bf16 v[48:51], v[136:139], v[88:91], 0
 s_add_u32 m0, s81, 3072
 s_add_u32 s21, s88, 7028736
 v_mfma_f32_16x16x32_bf16 v[56:59], v[136:139], v[112:115], 0
 buffer_load_dwordx4 v31, s[12:15], s21 offen offset:0 lds
 s_waitcnt lgkmcnt(2)
 v_mfma_f32_16x16x32_bf16 v[40:43], v[140:143], v[68:71], v[40:43]
 ds_read_b128 v[136:139], v22 offset:12544
 v_cvt_pk_f16_f32 v162, v44, v45
 buffer_load_dwordx4 v32, s[12:15], s21 offen offset:1024 lds
 v_cvt_pk_f16_f32 v163, v46, v47
 v_mfma_f32_16x16x32_bf16 v[48:51], v[140:143], v[92:95], v[48:51]
 v_cvt_pk_f16_f32 v170, v52, v53
 buffer_load_dwordx4 v33, s[12:15], s21 offen offset:2048 lds
 v_cvt_pk_f16_f32 v171, v54, v55
 v_cvt_pk_f16_f32 v178, v60, v61
 v_mfma_f32_16x16x32_bf16 v[56:59], v[140:143], v[116:119], v[56:59]
 v_cvt_pk_f16_f32 v179, v62, v63
 s_add_u32 m0, s81, 6144
 s_add_u32 s21, s88, 7471104
 s_waitcnt lgkmcnt(2)
 v_mfma_f32_16x16x32_bf16 v[40:43], v[144:147], v[72:75], v[40:43]
 ds_read_b128 v[140:143], v23 offset:12544
 buffer_load_dwordx4 v34, s[12:15], s21 offen offset:0 lds
 v_mfma_f32_16x16x32_bf16 v[48:51], v[144:147], v[96:99], v[48:51]
 buffer_load_dwordx4 v35, s[12:15], s21 offen offset:1024 lds
 v_mfma_f32_16x16x32_bf16 v[56:59], v[144:147], v[120:123], v[56:59]
 buffer_load_dwordx4 v36, s[12:15], s21 offen offset:2048 lds
 s_waitcnt lgkmcnt(2)
 v_mfma_f32_16x16x32_bf16 v[40:43], v[148:151], v[76:79], v[40:43]
 ds_read_b128 v[144:147], v22 offset:13824
 s_add_u32 m0, s81, 9216
 s_add_u32 s21, s88, 7520256
 v_mfma_f32_16x16x32_bf16 v[48:51], v[148:151], v[100:103], v[48:51]
 buffer_load_dwordx4 v37, s[12:15], s21 offen offset:0 lds
 v_mfma_f32_16x16x32_bf16 v[56:59], v[148:151], v[124:127], v[56:59]
 buffer_load_dwordx4 v38, s[12:15], s21 offen offset:1024 lds
 s_waitcnt lgkmcnt(2)
 v_mfma_f32_16x16x32_bf16 v[40:43], v[136:139], v[80:83], v[40:43]
 ds_read_b128 v[148:151], v23 offset:13824
 buffer_load_dwordx4 v39, s[12:15], s21 offen offset:2048 lds
 v_mfma_f32_16x16x32_bf16 v[48:51], v[136:139], v[104:107], v[48:51]
 v_mfma_f32_16x16x32_bf16 v[56:59], v[136:139], v[128:131], v[56:59]
 s_waitcnt lgkmcnt(2)
 v_mfma_f32_16x16x32_bf16 v[40:43], v[140:143], v[84:87], v[40:43]
 ds_read_b128 v[136:139], v22 offset:13952
 v_mfma_f32_16x16x32_bf16 v[48:51], v[140:143], v[108:111], v[48:51]
 v_mfma_f32_16x16x32_bf16 v[56:59], v[140:143], v[132:135], v[56:59]
 s_waitcnt lgkmcnt(2)
 v_mfma_f32_16x16x32_bf16 v[44:47], v[144:147], v[64:67], 0
 ds_read_b128 v[140:143], v23 offset:13952
 v_mfma_f32_16x16x32_bf16 v[52:55], v[144:147], v[88:91], 0
 v_mfma_f32_16x16x32_bf16 v[60:63], v[144:147], v[112:115], 0
 s_waitcnt lgkmcnt(2)
 v_mfma_f32_16x16x32_bf16 v[44:47], v[148:151], v[68:71], v[44:47]
 ds_read_b128 v[144:147], v22 offset:14080
 v_cvt_pk_f16_f32 v164, v40, v41
 v_cvt_pk_f16_f32 v165, v42, v43
 v_cvt_pk_f16_f32 v172, v48, v49
 v_cvt_pk_f16_f32 v173, v50, v51
 v_mfma_f32_16x16x32_bf16 v[52:55], v[148:151], v[92:95], v[52:55]
 v_cvt_pk_f16_f32 v180, v56, v57
 v_cvt_pk_f16_f32 v181, v58, v59
 v_mfma_f32_16x16x32_bf16 v[60:63], v[148:151], v[116:119], v[60:63]
 s_waitcnt lgkmcnt(2)
 v_mfma_f32_16x16x32_bf16 v[44:47], v[136:139], v[72:75], v[44:47]
 ds_read_b128 v[148:151], v23 offset:14080
 v_mfma_f32_16x16x32_bf16 v[52:55], v[136:139], v[96:99], v[52:55]
 v_mfma_f32_16x16x32_bf16 v[60:63], v[136:139], v[120:123], v[60:63]
 s_waitcnt lgkmcnt(2)
 v_mfma_f32_16x16x32_bf16 v[44:47], v[140:143], v[76:79], v[44:47]
 s_waitcnt vmcnt(12)
 ds_read_b128 v[136:139], v22 offset:24576
 v_mfma_f32_16x16x32_bf16 v[52:55], v[140:143], v[100:103], v[52:55]
 v_mfma_f32_16x16x32_bf16 v[60:63], v[140:143], v[124:127], v[60:63]
 s_waitcnt lgkmcnt(2)
 v_mfma_f32_16x16x32_bf16 v[44:47], v[144:147], v[80:83], v[44:47]
 ds_read_b128 v[140:143], v23 offset:24576
 v_mfma_f32_16x16x32_bf16 v[52:55], v[144:147], v[104:107], v[52:55]
 v_mfma_f32_16x16x32_bf16 v[60:63], v[144:147], v[128:131], v[60:63]
 s_waitcnt lgkmcnt(2)
 v_mfma_f32_16x16x32_bf16 v[44:47], v[148:151], v[84:87], v[44:47]
 ds_read_b128 v[144:147], v22 offset:24704
 s_add_u32 m0, s81, 12288
 s_add_u32 s21, s88, 196608
 v_mfma_f32_16x16x32_bf16 v[52:55], v[148:151], v[108:111], v[52:55]
 buffer_load_dwordx4 v28, s[12:15], s21 offen offset:0 lds
 v_mfma_f32_16x16x32_bf16 v[60:63], v[148:151], v[132:135], v[60:63]
 buffer_load_dwordx4 v29, s[12:15], s21 offen offset:1024 lds
 s_waitcnt lgkmcnt(2)
 v_mfma_f32_16x16x32_bf16 v[40:43], v[136:139], v[64:67], 0
 ds_read_b128 v[148:151], v23 offset:24704
 buffer_load_dwordx4 v30, s[12:15], s21 offen offset:2048 lds
 v_mfma_f32_16x16x32_bf16 v[48:51], v[136:139], v[88:91], 0
 s_add_u32 m0, s81, 15360
 s_add_u32 s21, s88, 2162688
 v_mfma_f32_16x16x32_bf16 v[56:59], v[136:139], v[112:115], 0
 buffer_load_dwordx4 v31, s[12:15], s21 offen offset:0 lds
 s_waitcnt lgkmcnt(2)
 v_mfma_f32_16x16x32_bf16 v[40:43], v[140:143], v[68:71], v[40:43]
 ds_read_b128 v[136:139], v22 offset:24832
 v_cvt_pk_f16_f32 v166, v44, v45
 buffer_load_dwordx4 v32, s[12:15], s21 offen offset:1024 lds
 v_cvt_pk_f16_f32 v167, v46, v47
 v_mfma_f32_16x16x32_bf16 v[48:51], v[140:143], v[92:95], v[48:51]
 v_cvt_pk_f16_f32 v174, v52, v53
 buffer_load_dwordx4 v33, s[12:15], s21 offen offset:2048 lds
 v_cvt_pk_f16_f32 v175, v54, v55
 v_cvt_pk_f16_f32 v182, v60, v61
 v_mfma_f32_16x16x32_bf16 v[56:59], v[140:143], v[116:119], v[56:59]
 v_cvt_pk_f16_f32 v183, v62, v63
 s_add_u32 m0, s81, 18432
 s_add_u32 s21, s88, 688128
 s_waitcnt lgkmcnt(2)
 v_mfma_f32_16x16x32_bf16 v[40:43], v[144:147], v[72:75], v[40:43]
 ds_read_b128 v[140:143], v23 offset:24832
 buffer_load_dwordx4 v34, s[12:15], s21 offen offset:0 lds
 v_mfma_f32_16x16x32_bf16 v[48:51], v[144:147], v[96:99], v[48:51]
 buffer_load_dwordx4 v35, s[12:15], s21 offen offset:1024 lds
 v_mfma_f32_16x16x32_bf16 v[56:59], v[144:147], v[120:123], v[56:59]
 buffer_load_dwordx4 v36, s[12:15], s21 offen offset:2048 lds
 s_waitcnt lgkmcnt(2)
 v_mfma_f32_16x16x32_bf16 v[40:43], v[148:151], v[76:79], v[40:43]
 ds_read_b128 v[144:147], v22 offset:26112
 s_add_u32 m0, s81, 21504
 s_add_u32 s21, s88, 2654208
 v_mfma_f32_16x16x32_bf16 v[48:51], v[148:151], v[100:103], v[48:51]
 buffer_load_dwordx4 v37, s[12:15], s21 offen offset:0 lds
 v_mfma_f32_16x16x32_bf16 v[56:59], v[148:151], v[124:127], v[56:59]
 buffer_load_dwordx4 v38, s[12:15], s21 offen offset:1024 lds
 s_waitcnt lgkmcnt(2)
 v_mfma_f32_16x16x32_bf16 v[40:43], v[136:139], v[80:83], v[40:43]
 ds_read_b128 v[148:151], v23 offset:26112
 buffer_load_dwordx4 v39, s[12:15], s21 offen offset:2048 lds
 v_mfma_f32_16x16x32_bf16 v[48:51], v[136:139], v[104:107], v[48:51]
 v_mfma_f32_16x16x32_bf16 v[56:59], v[136:139], v[128:131], v[56:59]
 s_waitcnt lgkmcnt(2)
 v_mfma_f32_16x16x32_bf16 v[40:43], v[140:143], v[84:87], v[40:43]
 ds_read_b128 v[136:139], v22 offset:26240
 v_mfma_f32_16x16x32_bf16 v[48:51], v[140:143], v[108:111], v[48:51]
 v_mfma_f32_16x16x32_bf16 v[56:59], v[140:143], v[132:135], v[56:59]
 s_waitcnt lgkmcnt(2)
 v_mfma_f32_16x16x32_bf16 v[44:47], v[144:147], v[64:67], 0
 ds_read_b128 v[140:143], v23 offset:26240
 v_mfma_f32_16x16x32_bf16 v[52:55], v[144:147], v[88:91], 0
 v_mfma_f32_16x16x32_bf16 v[60:63], v[144:147], v[112:115], 0
 s_waitcnt lgkmcnt(2)
 v_mfma_f32_16x16x32_bf16 v[44:47], v[148:151], v[68:71], v[44:47]
 ds_read_b128 v[144:147], v22 offset:26368
 v_cvt_pk_f16_f32 v184, v40, v41
 v_cvt_pk_f16_f32 v185, v42, v43
 v_cvt_pk_f16_f32 v192, v48, v49
 v_cvt_pk_f16_f32 v193, v50, v51
 v_mfma_f32_16x16x32_bf16 v[52:55], v[148:151], v[92:95], v[52:55]
 v_cvt_pk_f16_f32 v200, v56, v57
 v_cvt_pk_f16_f32 v201, v58, v59
 v_mfma_f32_16x16x32_bf16 v[60:63], v[148:151], v[116:119], v[60:63]
 s_waitcnt lgkmcnt(2)
 v_mfma_f32_16x16x32_bf16 v[44:47], v[136:139], v[72:75], v[44:47]
 ds_read_b128 v[148:151], v23 offset:26368
 v_mfma_f32_16x16x32_bf16 v[52:55], v[136:139], v[96:99], v[52:55]
 v_mfma_f32_16x16x32_bf16 v[60:63], v[136:139], v[120:123], v[60:63]
 s_waitcnt lgkmcnt(2)
 v_mfma_f32_16x16x32_bf16 v[44:47], v[140:143], v[76:79], v[44:47]
 s_waitcnt vmcnt(12)
 ds_read_b128 v[136:139], v22 offset:0
 v_mfma_f32_16x16x32_bf16 v[52:55], v[140:143], v[100:103], v[52:55]
 v_mfma_f32_16x16x32_bf16 v[60:63], v[140:143], v[124:127], v[60:63]
 s_waitcnt lgkmcnt(2)
 v_mfma_f32_16x16x32_bf16 v[44:47], v[144:147], v[80:83], v[44:47]
 ds_read_b128 v[140:143], v23 offset:0
 v_mfma_f32_16x16x32_bf16 v[52:55], v[144:147], v[104:107], v[52:55]
 v_mfma_f32_16x16x32_bf16 v[60:63], v[144:147], v[128:131], v[60:63]
 s_waitcnt lgkmcnt(2)
 v_mfma_f32_16x16x32_bf16 v[44:47], v[148:151], v[84:87], v[44:47]
 ds_read_b128 v[144:147], v22 offset:128
 s_add_u32 m0, s81, 24576
 s_add_u32 s21, s88, 1179648
 v_mfma_f32_16x16x32_bf16 v[52:55], v[148:151], v[108:111], v[52:55]
 buffer_load_dwordx4 v28, s[12:15], s21 offen offset:0 lds
 v_mfma_f32_16x16x32_bf16 v[60:63], v[148:151], v[132:135], v[60:63]
 buffer_load_dwordx4 v29, s[12:15], s21 offen offset:1024 lds
 s_waitcnt lgkmcnt(2)
 v_mfma_f32_16x16x32_bf16 v[40:43], v[136:139], v[64:67], 0
 ds_read_b128 v[148:151], v23 offset:128
 buffer_load_dwordx4 v30, s[12:15], s21 offen offset:2048 lds
 v_mfma_f32_16x16x32_bf16 v[48:51], v[136:139], v[88:91], 0
 s_add_u32 m0, s81, 27648
 s_add_u32 s21, s88, 3145728
 v_mfma_f32_16x16x32_bf16 v[56:59], v[136:139], v[112:115], 0
 buffer_load_dwordx4 v31, s[12:15], s21 offen offset:0 lds
 s_waitcnt lgkmcnt(2)
 v_mfma_f32_16x16x32_bf16 v[40:43], v[140:143], v[68:71], v[40:43]
 ds_read_b128 v[136:139], v22 offset:256
 v_cvt_pk_f16_f32 v186, v44, v45
 buffer_load_dwordx4 v32, s[12:15], s21 offen offset:1024 lds
 v_cvt_pk_f16_f32 v187, v46, v47
 v_mfma_f32_16x16x32_bf16 v[48:51], v[140:143], v[92:95], v[48:51]
 v_cvt_pk_f16_f32 v194, v52, v53
 buffer_load_dwordx4 v33, s[12:15], s21 offen offset:2048 lds
 v_cvt_pk_f16_f32 v195, v54, v55
 v_cvt_pk_f16_f32 v202, v60, v61
 v_mfma_f32_16x16x32_bf16 v[56:59], v[140:143], v[116:119], v[56:59]
 v_cvt_pk_f16_f32 v203, v62, v63
 s_add_u32 m0, s81, 30720
 s_add_u32 s21, s88, 1671168
 s_waitcnt lgkmcnt(2)
 v_mfma_f32_16x16x32_bf16 v[40:43], v[144:147], v[72:75], v[40:43]
 ds_read_b128 v[140:143], v23 offset:256
 buffer_load_dwordx4 v34, s[12:15], s21 offen offset:0 lds
 v_mfma_f32_16x16x32_bf16 v[48:51], v[144:147], v[96:99], v[48:51]
 buffer_load_dwordx4 v35, s[12:15], s21 offen offset:1024 lds
 v_mfma_f32_16x16x32_bf16 v[56:59], v[144:147], v[120:123], v[56:59]
 buffer_load_dwordx4 v36, s[12:15], s21 offen offset:2048 lds
 s_waitcnt lgkmcnt(2)
 v_mfma_f32_16x16x32_bf16 v[40:43], v[148:151], v[76:79], v[40:43]
 ds_read_b128 v[144:147], v22 offset:1536
 s_add_u32 m0, s81, 33792
 s_add_u32 s21, s88, 3637248
 v_mfma_f32_16x16x32_bf16 v[48:51], v[148:151], v[100:103], v[48:51]
 buffer_load_dwordx4 v37, s[12:15], s21 offen offset:0 lds
 v_mfma_f32_16x16x32_bf16 v[56:59], v[148:151], v[124:127], v[56:59]
 buffer_load_dwordx4 v38, s[12:15], s21 offen offset:1024 lds
 s_waitcnt lgkmcnt(2)
 v_mfma_f32_16x16x32_bf16 v[40:43], v[136:139], v[80:83], v[40:43]
 ds_read_b128 v[148:151], v23 offset:1536
 buffer_load_dwordx4 v39, s[12:15], s21 offen offset:2048 lds
 v_mfma_f32_16x16x32_bf16 v[48:51], v[136:139], v[104:107], v[48:51]
 v_mfma_f32_16x16x32_bf16 v[56:59], v[136:139], v[128:131], v[56:59]
 s_waitcnt lgkmcnt(2)
 v_mfma_f32_16x16x32_bf16 v[40:43], v[140:143], v[84:87], v[40:43]
 ds_read_b128 v[136:139], v22 offset:1664
 v_mfma_f32_16x16x32_bf16 v[48:51], v[140:143], v[108:111], v[48:51]
 v_mfma_f32_16x16x32_bf16 v[56:59], v[140:143], v[132:135], v[56:59]
 s_waitcnt lgkmcnt(2)
 v_mfma_f32_16x16x32_bf16 v[44:47], v[144:147], v[64:67], 0
 ds_read_b128 v[140:143], v23 offset:1664
 v_mfma_f32_16x16x32_bf16 v[52:55], v[144:147], v[88:91], 0
 v_mfma_f32_16x16x32_bf16 v[60:63], v[144:147], v[112:115], 0
 s_waitcnt lgkmcnt(2)
 v_mfma_f32_16x16x32_bf16 v[44:47], v[148:151], v[68:71], v[44:47]
 ds_read_b128 v[144:147], v22 offset:1792
 v_cvt_pk_f16_f32 v188, v40, v41
 v_cvt_pk_f16_f32 v189, v42, v43
 v_cvt_pk_f16_f32 v196, v48, v49
 v_cvt_pk_f16_f32 v197, v50, v51
 v_mfma_f32_16x16x32_bf16 v[52:55], v[148:151], v[92:95], v[52:55]
 v_cvt_pk_f16_f32 v204, v56, v57
 v_cvt_pk_f16_f32 v205, v58, v59
 v_mfma_f32_16x16x32_bf16 v[60:63], v[148:151], v[116:119], v[60:63]
 s_waitcnt lgkmcnt(2)
 v_mfma_f32_16x16x32_bf16 v[44:47], v[136:139], v[72:75], v[44:47]
 ds_read_b128 v[148:151], v23 offset:1792
 v_mfma_f32_16x16x32_bf16 v[52:55], v[136:139], v[96:99], v[52:55]
 v_mfma_f32_16x16x32_bf16 v[60:63], v[136:139], v[120:123], v[60:63]
 s_waitcnt lgkmcnt(2)
 v_mfma_f32_16x16x32_bf16 v[44:47], v[140:143], v[76:79], v[44:47]
 s_waitcnt vmcnt(12)
 ds_read_b128 v[136:139], v22 offset:12288
 v_mfma_f32_16x16x32_bf16 v[52:55], v[140:143], v[100:103], v[52:55]
 v_mfma_f32_16x16x32_bf16 v[60:63], v[140:143], v[124:127], v[60:63]
 s_waitcnt lgkmcnt(2)
 v_mfma_f32_16x16x32_bf16 v[44:47], v[144:147], v[80:83], v[44:47]
 ds_read_b128 v[140:143], v23 offset:12288
 v_mfma_f32_16x16x32_bf16 v[52:55], v[144:147], v[104:107], v[52:55]
 v_mfma_f32_16x16x32_bf16 v[60:63], v[144:147], v[128:131], v[60:63]
 s_waitcnt lgkmcnt(2)
 v_mfma_f32_16x16x32_bf16 v[44:47], v[148:151], v[84:87], v[44:47]
 ds_read_b128 v[144:147], v22 offset:12416
 s_add_u32 m0, s81, 0
 s_add_u32 s21, s88, 4128768
 v_mfma_f32_16x16x32_bf16 v[52:55], v[148:151], v[108:111], v[52:55]
 buffer_load_dwordx4 v28, s[12:15], s21 offen offset:0 lds
 v_mfma_f32_16x16x32_bf16 v[60:63], v[148:151], v[132:135], v[60:63]
 buffer_load_dwordx4 v29, s[12:15], s21 offen offset:1024 lds
 s_waitcnt lgkmcnt(2)
 v_mfma_f32_16x16x32_bf16 v[40:43], v[136:139], v[64:67], 0
 ds_read_b128 v[148:151], v23 offset:12416
 buffer_load_dwordx4 v30, s[12:15], s21 offen offset:2048 lds
 v_mfma_f32_16x16x32_bf16 v[48:51], v[136:139], v[88:91], 0
 s_add_u32 m0, s81, 3072
 s_add_u32 s21, s88, 6094848
 v_mfma_f32_16x16x32_bf16 v[56:59], v[136:139], v[112:115], 0
 buffer_load_dwordx4 v31, s[12:15], s21 offen offset:0 lds
 s_waitcnt lgkmcnt(2)
 v_mfma_f32_16x16x32_bf16 v[40:43], v[140:143], v[68:71], v[40:43]
 ds_read_b128 v[136:139], v22 offset:12544
 v_cvt_pk_f16_f32 v190, v44, v45
 buffer_load_dwordx4 v32, s[12:15], s21 offen offset:1024 lds
 v_cvt_pk_f16_f32 v191, v46, v47
 v_mfma_f32_16x16x32_bf16 v[48:51], v[140:143], v[92:95], v[48:51]
 v_cvt_pk_f16_f32 v198, v52, v53
 buffer_load_dwordx4 v33, s[12:15], s21 offen offset:2048 lds
 v_cvt_pk_f16_f32 v199, v54, v55
 v_cvt_pk_f16_f32 v206, v60, v61
 v_mfma_f32_16x16x32_bf16 v[56:59], v[140:143], v[116:119], v[56:59]
 v_cvt_pk_f16_f32 v207, v62, v63
 s_add_u32 m0, s81, 6144
 s_add_u32 s21, s88, 4620288
 s_waitcnt lgkmcnt(2)
 v_mfma_f32_16x16x32_bf16 v[40:43], v[144:147], v[72:75], v[40:43]
 ds_read_b128 v[140:143], v23 offset:12544
 buffer_load_dwordx4 v34, s[12:15], s21 offen offset:0 lds
 v_mfma_f32_16x16x32_bf16 v[48:51], v[144:147], v[96:99], v[48:51]
 buffer_load_dwordx4 v35, s[12:15], s21 offen offset:1024 lds
 v_mfma_f32_16x16x32_bf16 v[56:59], v[144:147], v[120:123], v[56:59]
 buffer_load_dwordx4 v36, s[12:15], s21 offen offset:2048 lds
 s_waitcnt lgkmcnt(2)
 v_mfma_f32_16x16x32_bf16 v[40:43], v[148:151], v[76:79], v[40:43]
 ds_read_b128 v[144:147], v22 offset:13824
 s_add_u32 m0, s81, 9216
 s_add_u32 s21, s88, 6586368
 v_mfma_f32_16x16x32_bf16 v[48:51], v[148:151], v[100:103], v[48:51]
 buffer_load_dwordx4 v37, s[12:15], s21 offen offset:0 lds
 v_mfma_f32_16x16x32_bf16 v[56:59], v[148:151], v[124:127], v[56:59]
 buffer_load_dwordx4 v38, s[12:15], s21 offen offset:1024 lds
 s_waitcnt lgkmcnt(2)
 v_mfma_f32_16x16x32_bf16 v[40:43], v[136:139], v[80:83], v[40:43]
 ds_read_b128 v[148:151], v23 offset:13824
 buffer_load_dwordx4 v39, s[12:15], s21 offen offset:2048 lds
 v_mfma_f32_16x16x32_bf16 v[48:51], v[136:139], v[104:107], v[48:51]
 v_mfma_f32_16x16x32_bf16 v[56:59], v[136:139], v[128:131], v[56:59]
 s_waitcnt lgkmcnt(2)
 v_mfma_f32_16x16x32_bf16 v[40:43], v[140:143], v[84:87], v[40:43]
 ds_read_b128 v[136:139], v22 offset:13952
 v_mfma_f32_16x16x32_bf16 v[48:51], v[140:143], v[108:111], v[48:51]
 v_mfma_f32_16x16x32_bf16 v[56:59], v[140:143], v[132:135], v[56:59]
 s_waitcnt lgkmcnt(2)
 v_mfma_f32_16x16x32_bf16 v[44:47], v[144:147], v[64:67], 0
 ds_read_b128 v[140:143], v23 offset:13952
 v_mfma_f32_16x16x32_bf16 v[52:55], v[144:147], v[88:91], 0
 v_mfma_f32_16x16x32_bf16 v[60:63], v[144:147], v[112:115], 0
 s_waitcnt lgkmcnt(2)
 v_mfma_f32_16x16x32_bf16 v[44:47], v[148:151], v[68:71], v[44:47]
 ds_read_b128 v[144:147], v22 offset:14080
 v_cvt_pk_f16_f32 v208, v40, v41
 v_cvt_pk_f16_f32 v209, v42, v43
 v_cvt_pk_f16_f32 v216, v48, v49
 v_cvt_pk_f16_f32 v217, v50, v51
 v_mfma_f32_16x16x32_bf16 v[52:55], v[148:151], v[92:95], v[52:55]
 v_cvt_pk_f16_f32 v224, v56, v57
 v_cvt_pk_f16_f32 v225, v58, v59
 v_mfma_f32_16x16x32_bf16 v[60:63], v[148:151], v[116:119], v[60:63]
 s_waitcnt lgkmcnt(2)
 v_mfma_f32_16x16x32_bf16 v[44:47], v[136:139], v[72:75], v[44:47]
 ds_read_b128 v[148:151], v23 offset:14080
 v_mfma_f32_16x16x32_bf16 v[52:55], v[136:139], v[96:99], v[52:55]
 v_mfma_f32_16x16x32_bf16 v[60:63], v[136:139], v[120:123], v[60:63]
 s_waitcnt lgkmcnt(2)
 v_mfma_f32_16x16x32_bf16 v[44:47], v[140:143], v[76:79], v[44:47]
 s_waitcnt vmcnt(12)
 ds_read_b128 v[136:139], v22 offset:24576
 v_mfma_f32_16x16x32_bf16 v[52:55], v[140:143], v[100:103], v[52:55]
 v_mfma_f32_16x16x32_bf16 v[60:63], v[140:143], v[124:127], v[60:63]
 s_waitcnt lgkmcnt(2)
 v_mfma_f32_16x16x32_bf16 v[44:47], v[144:147], v[80:83], v[44:47]
 ds_read_b128 v[140:143], v23 offset:24576
 v_mfma_f32_16x16x32_bf16 v[52:55], v[144:147], v[104:107], v[52:55]
 v_mfma_f32_16x16x32_bf16 v[60:63], v[144:147], v[128:131], v[60:63]
 s_waitcnt lgkmcnt(2)
 v_mfma_f32_16x16x32_bf16 v[44:47], v[148:151], v[84:87], v[44:47]
 ds_read_b128 v[144:147], v22 offset:24704
 s_add_u32 m0, s81, 12288
 s_add_u32 s21, s88, 5111808
 v_mfma_f32_16x16x32_bf16 v[52:55], v[148:151], v[108:111], v[52:55]
 buffer_load_dwordx4 v28, s[12:15], s21 offen offset:0 lds
 v_mfma_f32_16x16x32_bf16 v[60:63], v[148:151], v[132:135], v[60:63]
 buffer_load_dwordx4 v29, s[12:15], s21 offen offset:1024 lds
 s_waitcnt lgkmcnt(2)
 v_mfma_f32_16x16x32_bf16 v[40:43], v[136:139], v[64:67], 0
 ds_read_b128 v[148:151], v23 offset:24704
 buffer_load_dwordx4 v30, s[12:15], s21 offen offset:2048 lds
 v_mfma_f32_16x16x32_bf16 v[48:51], v[136:139], v[88:91], 0
 s_add_u32 m0, s81, 15360
 s_add_u32 s21, s88, 7077888
 v_mfma_f32_16x16x32_bf16 v[56:59], v[136:139], v[112:115], 0
 buffer_load_dwordx4 v31, s[12:15], s21 offen offset:0 lds
 s_waitcnt lgkmcnt(2)
 v_mfma_f32_16x16x32_bf16 v[40:43], v[140:143], v[68:71], v[40:43]
 ds_read_b128 v[136:139], v22 offset:24832
 v_cvt_pk_f16_f32 v210, v44, v45
 buffer_load_dwordx4 v32, s[12:15], s21 offen offset:1024 lds
 v_cvt_pk_f16_f32 v211, v46, v47
 v_mfma_f32_16x16x32_bf16 v[48:51], v[140:143], v[92:95], v[48:51]
 v_cvt_pk_f16_f32 v218, v52, v53
 buffer_load_dwordx4 v33, s[12:15], s21 offen offset:2048 lds
 v_cvt_pk_f16_f32 v219, v54, v55
 v_cvt_pk_f16_f32 v226, v60, v61
 v_mfma_f32_16x16x32_bf16 v[56:59], v[140:143], v[116:119], v[56:59]
 v_cvt_pk_f16_f32 v227, v62, v63
 s_add_u32 m0, s81, 18432
 s_add_u32 s21, s88, 5603328
 s_waitcnt lgkmcnt(2)
 v_mfma_f32_16x16x32_bf16 v[40:43], v[144:147], v[72:75], v[40:43]
 ds_read_b128 v[140:143], v23 offset:24832
 buffer_load_dwordx4 v34, s[12:15], s21 offen offset:0 lds
 v_mfma_f32_16x16x32_bf16 v[48:51], v[144:147], v[96:99], v[48:51]
 buffer_load_dwordx4 v35, s[12:15], s21 offen offset:1024 lds
 v_mfma_f32_16x16x32_bf16 v[56:59], v[144:147], v[120:123], v[56:59]
 buffer_load_dwordx4 v36, s[12:15], s21 offen offset:2048 lds
 s_waitcnt lgkmcnt(2)
 v_mfma_f32_16x16x32_bf16 v[40:43], v[148:151], v[76:79], v[40:43]
 ds_read_b128 v[144:147], v22 offset:26112
 s_add_u32 m0, s81, 21504
 s_add_u32 s21, s88, 7569408
 v_mfma_f32_16x16x32_bf16 v[48:51], v[148:151], v[100:103], v[48:51]
 buffer_load_dwordx4 v37, s[12:15], s21 offen offset:0 lds
 v_mfma_f32_16x16x32_bf16 v[56:59], v[148:151], v[124:127], v[56:59]
 buffer_load_dwordx4 v38, s[12:15], s21 offen offset:1024 lds
 s_waitcnt lgkmcnt(2)
 v_mfma_f32_16x16x32_bf16 v[40:43], v[136:139], v[80:83], v[40:43]
 ds_read_b128 v[148:151], v23 offset:26112
 buffer_load_dwordx4 v39, s[12:15], s21 offen offset:2048 lds
 v_mfma_f32_16x16x32_bf16 v[48:51], v[136:139], v[104:107], v[48:51]
 v_mfma_f32_16x16x32_bf16 v[56:59], v[136:139], v[128:131], v[56:59]
 s_waitcnt lgkmcnt(2)
 v_mfma_f32_16x16x32_bf16 v[40:43], v[140:143], v[84:87], v[40:43]
 ds_read_b128 v[136:139], v22 offset:26240
 v_mfma_f32_16x16x32_bf16 v[48:51], v[140:143], v[108:111], v[48:51]
 v_mfma_f32_16x16x32_bf16 v[56:59], v[140:143], v[132:135], v[56:59]
 s_waitcnt lgkmcnt(2)
 v_mfma_f32_16x16x32_bf16 v[44:47], v[144:147], v[64:67], 0
 ds_read_b128 v[140:143], v23 offset:26240
 v_mfma_f32_16x16x32_bf16 v[52:55], v[144:147], v[88:91], 0
 v_mfma_f32_16x16x32_bf16 v[60:63], v[144:147], v[112:115], 0
 s_waitcnt lgkmcnt(2)
 v_mfma_f32_16x16x32_bf16 v[44:47], v[148:151], v[68:71], v[44:47]
 ds_read_b128 v[144:147], v22 offset:26368
 v_cvt_pk_f16_f32 v212, v40, v41
 v_cvt_pk_f16_f32 v213, v42, v43
 v_cvt_pk_f16_f32 v220, v48, v49
 v_cvt_pk_f16_f32 v221, v50, v51
 v_mfma_f32_16x16x32_bf16 v[52:55], v[148:151], v[92:95], v[52:55]
 v_cvt_pk_f16_f32 v228, v56, v57
 v_cvt_pk_f16_f32 v229, v58, v59
 v_mfma_f32_16x16x32_bf16 v[60:63], v[148:151], v[116:119], v[60:63]
 s_waitcnt lgkmcnt(2)
 v_mfma_f32_16x16x32_bf16 v[44:47], v[136:139], v[72:75], v[44:47]
 ds_read_b128 v[148:151], v23 offset:26368
 v_mfma_f32_16x16x32_bf16 v[52:55], v[136:139], v[96:99], v[52:55]
 v_mfma_f32_16x16x32_bf16 v[60:63], v[136:139], v[120:123], v[60:63]
 s_waitcnt lgkmcnt(2)
 v_mfma_f32_16x16x32_bf16 v[44:47], v[140:143], v[76:79], v[44:47]
 s_waitcnt vmcnt(12)
 ds_read_b128 v[136:139], v22 offset:0
 v_mfma_f32_16x16x32_bf16 v[52:55], v[140:143], v[100:103], v[52:55]
 v_mfma_f32_16x16x32_bf16 v[60:63], v[140:143], v[124:127], v[60:63]
 s_waitcnt lgkmcnt(2)
 v_mfma_f32_16x16x32_bf16 v[44:47], v[144:147], v[80:83], v[44:47]
 ds_read_b128 v[140:143], v23 offset:0
 v_mfma_f32_16x16x32_bf16 v[52:55], v[144:147], v[104:107], v[52:55]
 v_mfma_f32_16x16x32_bf16 v[60:63], v[144:147], v[128:131], v[60:63]
 s_waitcnt lgkmcnt(2)
 v_mfma_f32_16x16x32_bf16 v[44:47], v[148:151], v[84:87], v[44:47]
 ds_read_b128 v[144:147], v22 offset:128
 v_mfma_f32_16x16x32_bf16 v[52:55], v[148:151], v[108:111], v[52:55]
 v_mfma_f32_16x16x32_bf16 v[60:63], v[148:151], v[132:135], v[60:63]
 s_mov_b32 s101, 0
 s_branch fm_8
fm_7:
 s_sleep 8
 buffer_load_dword v0, v26, s[32:35], 0 offen sc1
 s_add_u32 s101, s101, 1
 s_cmp_gt_u32 s101, 131072
 s_cbranch_scc1 end0
 s_waitcnt vmcnt(0)
fm_8:
 v_readlane_b32 s22, v0, 0
 v_readlane_b32 s23, v0, 32
 s_add_u32 s22, s22, s23
 v_readlane_b32 s23, v0, 1
 s_add_u32 s22, s22, s23
 v_readlane_b32 s23, v0, 33
 s_add_u32 s22, s22, s23
 v_readlane_b32 s23, v0, 2
 s_add_u32 s22, s22, s23
 v_readlane_b32 s23, v0, 34
 s_add_u32 s22, s22, s23
 v_readlane_b32 s23, v0, 3
 s_add_u32 s22, s22, s23
 v_readlane_b32 s23, v0, 35
 s_add_u32 s22, s22, s23
 v_readlane_b32 s21, v0, 19
 v_readlane_b32 s23, v0, 21
 s_cmp_ge_u32 s22, 256
 s_cselect_b32 s23, s23, 0
 s_cmp_ge_u32 s21, 32
 s_cselect_b32 s23, s23, 0
 s_cmp_eq_u32 s23, 0
 s_cbranch_scc1 fm_7
 v_readlane_b32 s21, v0, s82
 s_cmp_ge_u32 s21, s83
 s_cselect_b32 s21, 1, 0
 s_andn2_b32 s53, s21, s53
 s_add_u32 s37, s44, 83886079
 s_add_u32 s21, s44, 180355072
 s_xor_b32 s37, s37, s21
 s_lshr_b32 s37, s37, 21
 s_xor_b32 s37, s37, s23
 s_xor_b32 s37, s37, 0
 s_and_b32 s37, s37, 1
 s_lshl_b32 s37, s37, 13
 s_sub_u32 s23, s23, 1
 s_lshl_b32 s23, s23, 13
 v_add_u32 v13, s23, v13
 v_add_u32 v4, s23, v4
 s_add_u32 s12, s44, 81068032
 s_addc_u32 s13, s45, 0
 s_mov_b32 s14, 129024
 s_mov_b32 s15, 0x00020000
 v_and_b32 v27, 7, v2
 v_mul_u32_u24 v27, 1280, v27
 v_lshrrev_b32 v39, 3, v1
 v_mul_u32_u24 v39, 40, v39
 s_mul_i32 s21, s20, 320
 v_add3_u32 v27, v27, v39, s21
 buffer_load_dwordx4 v[28:31], v27, s[28:31], 0 offen offset:0
 buffer_load_dwordx4 v[32:35], v27, s[28:31], 0 offen offset:16
 buffer_load_dwordx2 v[36:37], v27, s[28:31], 0 offen offset:32
 s_and_b32 s21, s51, 3
 s_mul_i32 s21, s21, 540672
 buffer_load_dword v38, v9, s[8:11], s21 offen sc1
 buffer_load_dword v38, v8, s[8:11], s21 offen offset:0 sc1
 buffer_load_dword v38, v8, s[8:11], s21 offen offset:1024 sc1
 s_waitcnt lgkmcnt(2)
 v_mfma_f32_16x16x32_bf16 v[40:43], v[136:139], v[64:67], 0
 ds_read_b128 v[148:151], v23 offset:128
 v_mfma_f32_16x16x32_bf16 v[48:51], v[136:139], v[88:91], 0
 v_mfma_f32_16x16x32_bf16 v[56:59], v[136:139], v[112:115], 0
 s_waitcnt lgkmcnt(2)
 v_mfma_f32_16x16x32_bf16 v[40:43], v[140:143], v[68:71], v[40:43]
 ds_read_b128 v[136:139], v22 offset:256
 v_cvt_pk_f16_f32 v214, v44, v45
 v_cvt_pk_f16_f32 v215, v46, v47
 v_cvt_pk_f16_f32 v222, v52, v53
 v_cvt_pk_f16_f32 v223, v54, v55
 v_mfma_f32_16x16x32_bf16 v[48:51], v[140:143], v[92:95], v[48:51]
 v_cvt_pk_f16_f32 v230, v60, v61
 v_cvt_pk_f16_f32 v231, v62, v63
 v_mfma_f32_16x16x32_bf16 v[56:59], v[140:143], v[116:119], v[56:59]
 s_waitcnt lgkmcnt(2)
 v_mfma_f32_16x16x32_bf16 v[40:43], v[144:147], v[72:75], v[40:43]
 ds_read_b128 v[140:143], v23 offset:256
 v_mfma_f32_16x16x32_bf16 v[48:51], v[144:147], v[96:99], v[48:51]
 v_mfma_f32_16x16x32_bf16 v[56:59], v[144:147], v[120:123], v[56:59]
 s_waitcnt lgkmcnt(2)
 v_mfma_f32_16x16x32_bf16 v[40:43], v[148:151], v[76:79], v[40:43]
 ds_read_b128 v[144:147], v22 offset:1536
 v_mfma_f32_16x16x32_bf16 v[48:51], v[148:151], v[100:103], v[48:51]
 v_mfma_f32_16x16x32_bf16 v[56:59], v[148:151], v[124:127], v[56:59]
 s_waitcnt lgkmcnt(2)
 v_mfma_f32_16x16x32_bf16 v[40:43], v[136:139], v[80:83], v[40:43]
 ds_read_b128 v[148:151], v23 offset:1536
 v_mfma_f32_16x16x32_bf16 v[48:51], v[136:139], v[104:107], v[48:51]
 v_mfma_f32_16x16x32_bf16 v[56:59], v[136:139], v[128:131], v[56:59]
 s_waitcnt lgkmcnt(2)
 v_mfma_f32_16x16x32_bf16 v[40:43], v[140:143], v[84:87], v[40:43]
 ds_read_b128 v[136:139], v22 offset:1664
 v_mfma_f32_16x16x32_bf16 v[48:51], v[140:143], v[108:111], v[48:51]
 v_mfma_f32_16x16x32_bf16 v[56:59], v[140:143], v[132:135], v[56:59]
 s_waitcnt lgkmcnt(2)
 v_mfma_f32_16x16x32_bf16 v[44:47], v[144:147], v[64:67], 0
 ds_read_b128 v[140:143], v23 offset:1664
 v_mfma_f32_16x16x32_bf16 v[52:55], v[144:147], v[88:91], 0
 v_mfma_f32_16x16x32_bf16 v[60:63], v[144:147], v[112:115], 0
 s_waitcnt lgkmcnt(2)
 v_mfma_f32_16x16x32_bf16 v[44:47], v[148:151], v[68:71], v[44:47]
 ds_read_b128 v[144:147], v22 offset:1792
 v_cvt_pk_f16_f32 v232, v40, v41
 v_cvt_pk_f16_f32 v233, v42, v43
 v_cvt_pk_f16_f32 v240, v48, v49
 v_cvt_pk_f16_f32 v241, v50, v51
 v_mfma_f32_16x16x32_bf16 v[52:55], v[148:151], v[92:95], v[52:55]
 v_cvt_pk_f16_f32 v248, v56, v57
 v_cvt_pk_f16_f32 v249, v58, v59
 v_mfma_f32_16x16x32_bf16 v[60:63], v[148:151], v[116:119], v[60:63]
 s_waitcnt lgkmcnt(2)
 v_mfma_f32_16x16x32_bf16 v[44:47], v[136:139], v[72:75], v[44:47]
 ds_read_b128 v[148:151], v23 offset:1792
 v_mfma_f32_16x16x32_bf16 v[52:55], v[136:139], v[96:99], v[52:55]
 v_mfma_f32_16x16x32_bf16 v[60:63], v[136:139], v[120:123], v[60:63]
 s_waitcnt lgkmcnt(2)
 v_mfma_f32_16x16x32_bf16 v[44:47], v[140:143], v[76:79], v[44:47]
 s_waitcnt vmcnt(6)
 ds_read_b128 v[136:139], v22 offset:12288
 v_mfma_f32_16x16x32_bf16 v[52:55], v[140:143], v[100:103], v[52:55]
 v_mfma_f32_16x16x32_bf16 v[60:63], v[140:143], v[124:127], v[60:63]
 s_waitcnt lgkmcnt(2)
 v_mfma_f32_16x16x32_bf16 v[44:47], v[144:147], v[80:83], v[44:47]
 ds_read_b128 v[140:143], v23 offset:12288
 v_mfma_f32_16x16x32_bf16 v[52:55], v[144:147], v[104:107], v[52:55]
 v_mfma_f32_16x16x32_bf16 v[60:63], v[144:147], v[128:131], v[60:63]
 s_waitcnt lgkmcnt(2)
 v_mfma_f32_16x16x32_bf16 v[44:47], v[148:151], v[84:87], v[44:47]
 ds_read_b128 v[144:147], v22 offset:12416
 v_mfma_f32_16x16x32_bf16 v[52:55], v[148:151], v[108:111], v[52:55]
 v_mfma_f32_16x16x32_bf16 v[60:63], v[148:151], v[132:135], v[60:63]
 buffer_load_dword v0, off, s[12:15], s79 sc1
 s_waitcnt lgkmcnt(2)
 v_mfma_f32_16x16x32_bf16 v[40:43], v[136:139], v[64:67], 0
 ds_read_b128 v[148:151], v23 offset:12416
 v_mfma_f32_16x16x32_bf16 v[48:51], v[136:139], v[88:91], 0
 v_mfma_f32_16x16x32_bf16 v[56:59], v[136:139], v[112:115], 0
 s_waitcnt lgkmcnt(2)
 v_mfma_f32_16x16x32_bf16 v[40:43], v[140:143], v[68:71], v[40:43]
 ds_read_b128 v[136:139], v22 offset:12544
 v_cvt_pk_f16_f32 v234, v44, v45
 v_cvt_pk_f16_f32 v235, v46, v47
 v_cvt_pk_f16_f32 v242, v52, v53
 v_cvt_pk_f16_f32 v243, v54, v55
 v_mfma_f32_16x16x32_bf16 v[48:51], v[140:143], v[92:95], v[48:51]
 v_cvt_pk_f16_f32 v250, v60, v61
 v_cvt_pk_f16_f32 v251, v62, v63
 v_mfma_f32_16x16x32_bf16 v[56:59], v[140:143], v[116:119], v[56:59]
 s_waitcnt lgkmcnt(2)
 v_mfma_f32_16x16x32_bf16 v[40:43], v[144:147], v[72:75], v[40:43]
 ds_read_b128 v[140:143], v23 offset:12544
 v_mfma_f32_16x16x32_bf16 v[48:51], v[144:147], v[96:99], v[48:51]
 v_mfma_f32_16x16x32_bf16 v[56:59], v[144:147], v[120:123], v[56:59]
 s_waitcnt lgkmcnt(2)
 v_mfma_f32_16x16x32_bf16 v[40:43], v[148:151], v[76:79], v[40:43]
 ds_read_b128 v[144:147], v22 offset:13824
 v_mfma_f32_16x16x32_bf16 v[48:51], v[148:151], v[100:103], v[48:51]
 v_mfma_f32_16x16x32_bf16 v[56:59], v[148:151], v[124:127], v[56:59]
 s_waitcnt lgkmcnt(2)
 v_mfma_f32_16x16x32_bf16 v[40:43], v[136:139], v[80:83], v[40:43]
 ds_read_b128 v[148:151], v23 offset:13824
 v_mfma_f32_16x16x32_bf16 v[48:51], v[136:139], v[104:107], v[48:51]
 v_mfma_f32_16x16x32_bf16 v[56:59], v[136:139], v[128:131], v[56:59]
 s_waitcnt lgkmcnt(2)
 v_mfma_f32_16x16x32_bf16 v[40:43], v[140:143], v[84:87], v[40:43]
 ds_read_b128 v[136:139], v22 offset:13952
 v_mfma_f32_16x16x32_bf16 v[48:51], v[140:143], v[108:111], v[48:51]
 v_mfma_f32_16x16x32_bf16 v[56:59], v[140:143], v[132:135], v[56:59]
 s_waitcnt lgkmcnt(2)
 v_mfma_f32_16x16x32_bf16 v[44:47], v[144:147], v[64:67], 0
 ds_read_b128 v[140:143], v23 offset:13952
 v_mfma_f32_16x16x32_bf16 v[52:55], v[144:147], v[88:91], 0
 v_mfma_f32_16x16x32_bf16 v[60:63], v[144:147], v[112:115], 0
 s_waitcnt lgkmcnt(2)
 v_mfma_f32_16x16x32_bf16 v[44:47], v[148:151], v[68:71], v[44:47]
 ds_read_b128 v[144:147], v22 offset:14080
 v_cvt_pk_f16_f32 v236, v40, v41
 v_cvt_pk_f16_f32 v237, v42, v43
 v_cvt_pk_f16_f32 v244, v48, v49
 v_cvt_pk_f16_f32 v245, v50, v51
 v_mfma_f32_16x16x32_bf16 v[52:55], v[148:151], v[92:95], v[52:55]
 v_cvt_pk_f16_f32 v252, v56, v57
 v_cvt_pk_f16_f32 v253, v58, v59
 v_mfma_f32_16x16x32_bf16 v[60:63], v[148:151], v[116:119], v[60:63]
 s_waitcnt lgkmcnt(2)
 v_mfma_f32_16x16x32_bf16 v[44:47], v[136:139], v[72:75], v[44:47]
 ds_read_b128 v[148:151], v23 offset:14080
 v_mfma_f32_16x16x32_bf16 v[52:55], v[136:139], v[96:99], v[52:55]
 v_mfma_f32_16x16x32_bf16 v[60:63], v[136:139], v[120:123], v[60:63]
 s_waitcnt lgkmcnt(2)
 v_mfma_f32_16x16x32_bf16 v[44:47], v[140:143], v[76:79], v[44:47]
 v_mfma_f32_16x16x32_bf16 v[52:55], v[140:143], v[100:103], v[52:55]
 v_mfma_f32_16x16x32_bf16 v[60:63], v[140:143], v[124:127], v[60:63]
 s_waitcnt lgkmcnt(1)
 v_mfma_f32_16x16x32_bf16 v[44:47], v[144:147], v[80:83], v[44:47]
 v_mfma_f32_16x16x32_bf16 v[52:55], v[144:147], v[104:107], v[52:55]
 v_mfma_f32_16x16x32_bf16 v[60:63], v[144:147], v[128:131], v[60:63]
 s_waitcnt lgkmcnt(0)
 v_mfma_f32_16x16x32_bf16 v[44:47], v[148:151], v[84:87], v[44:47]
 v_mfma_f32_16x16x32_bf16 v[52:55], v[148:151], v[108:111], v[52:55]
 v_mfma_f32_16x16x32_bf16 v[60:63], v[148:151], v[132:135], v[60:63]
 s_nop 7
 v_cvt_pk_f16_f32 v238, v44, v45
 v_cvt_pk_f16_f32 v239, v46, v47
 v_cvt_pk_f16_f32 v246, v52, v53
 v_cvt_pk_f16_f32 v247, v54, v55
 v_cvt_pk_f16_f32 v254, v60, v61
 v_cvt_pk_f16_f32 v255, v62, v63
 s_add_u32 s28, s44, 88080384
 s_addc_u32 s29, s45, 0
 s_mov_b32 s30, 83886080
 s_mov_b32 s31, 0x00020000
 s_waitcnt vmcnt(0)
 v_readfirstlane_b32 s21, v0
 s_cmp_lg_u32 s21, 0
 s_cbranch_scc1 pf_10
 v_mov_b32 v62, 0
 s_mov_b32 s101, 0
wf_11:
 buffer_load_dword v63, v62, s[12:15], s79 offen sc1
 s_add_u32 s101, s101, 1
 s_cmp_gt_u32 s101, 131072
 s_cbranch_scc1 end0
 s_waitcnt vmcnt(0)
 v_readfirstlane_b32 s100, v63
 s_cmp_ge_u32 s100, 1
 s_cbranch_scc1 wf_12
 s_sleep 4
 s_branch wf_11
wf_12:
 v_mov_b32 v0, s100
pf_10:
 s_mov_b32 s87, 0
 s_sub_u32 s21, s64, 1310720
 s_cmp_ge_u32 s20, 2
 s_cbranch_scc1 pf_9
 buffer_load_dwordx4 v[112:115], v18, s[16:19], 0 offen sc1
 buffer_load_dwordx2 v[116:117], v19, s[16:19], 0 offen sc1
pf_9:
 buffer_load_dwordx4 v[126:129], v16, s[28:31], s21 offen offset:0 sc1
 buffer_load_dwordx4 v[130:133], v16, s[28:31], s21 offen offset:1024 sc1
 buffer_load_dwordx4 v[134:137], v16, s[28:31], s21 offen offset:2048 sc1
 v_lshlrev_b32 v27, 16, v28
 v_and_b32 v28, 0xffff0000, v28
 v_cvt_pk_f16_f32 v28, v27, v28
 v_lshlrev_b32 v27, 16, v29
 v_and_b32 v29, 0xffff0000, v29
 v_cvt_pk_f16_f32 v29, v27, v29
 v_lshlrev_b32 v27, 16, v30
 v_and_b32 v30, 0xffff0000, v30
 v_cvt_pk_f16_f32 v30, v27, v30
 v_lshlrev_b32 v27, 16, v31
 v_and_b32 v31, 0xffff0000, v31
 v_cvt_pk_f16_f32 v31, v27, v31
 v_lshlrev_b32 v27, 16, v32
 v_and_b32 v32, 0xffff0000, v32
 v_cvt_pk_f16_f32 v32, v27, v32
 v_lshlrev_b32 v27, 16, v33
 v_and_b32 v33, 0xffff0000, v33
 v_cvt_pk_f16_f32 v33, v27, v33
 v_lshlrev_b32 v27, 16, v34
 v_and_b32 v34, 0xffff0000, v34
 v_cvt_pk_f16_f32 v34, v27, v34
 v_lshlrev_b32 v27, 16, v35
 v_and_b32 v35, 0xffff0000, v35
 v_cvt_pk_f16_f32 v35, v27, v35
 v_lshlrev_b32 v27, 16, v36
 v_and_b32 v36, 0xffff0000, v36
 v_cvt_pk_f16_f32 v36, v27, v36
 v_lshlrev_b32 v27, 16, v37
 v_and_b32 v37, 0xffff0000, v37
 v_cvt_pk_f16_f32 v37, v27, v37
 s_lshl_b32 s21, s20, 2
 s_add_u32 s21, s21, 20480
 v_add_u32 v22, s21, v16
 v_bfe_u32 v23, v1, 2, 3
 v_lshlrev_b32 v23, 4, v23
 v_add_u32 v23, 20480, v23
 v_cmp_gt_u32 vcc, 2, v3
 s_mov_b32 s52, 0
 s_mov_b32 s89, 0x05040100
 v_cndmask_b32 v26, 0, 1.0, vcc
 v_mov_b32 v124, 0
 v_mov_b32 v125, 0
 v_mov_b32 v144, 0
 v_mov_b32 v145, 0
 v_mov_b32 v40, 0
 v_mov_b32 v41, 0
 v_mov_b32 v42, 0
 v_mov_b32 v43, 0
 v_mov_b32 v44, 0
 v_mov_b32 v45, 0
 v_mov_b32 v46, 0
 v_mov_b32 v47, 0
 v_mov_b32 v48, 0
 v_mov_b32 v49, 0
 v_mov_b32 v50, 0
 v_mov_b32 v51, 0
 v_mov_b32 v52, 0
 v_mov_b32 v53, 0
 v_mov_b32 v54, 0
 v_mov_b32 v55, 0
 v_mov_b32 v56, 0
 v_mov_b32 v57, 0
 v_mov_b32 v58, 0
 v_mov_b32 v59, 0
 v_mov_b32 v60, 0
 v_mov_b32 v61, 0
 v_mov_b32 v62, 0
 v_mov_b32 v63, 0
 v_mov_b32 v100, 0
 v_mov_b32 v101, 0
 v_mov_b32 v102, 0
 v_mov_b32 v103, 0
 v_mov_b32 v104, 0
 v_mov_b32 v105, 0
 v_mov_b32 v106, 0
 v_mov_b32 v107, 0
 v_mov_b32 v108, 0
 v_mov_b32 v109, 0
 v_mov_b32 v110, 0
 v_mov_b32 v111, 0
 s_barrier
 s_mov_b32 s57, 0x80000000
 s_and_b32 s21, s52, 3
 s_mul_i32 s81, s21, 540672
 s_lshl_b32 s84, s21, 15
 s_add_u32 s21, s52, 3
 s_and_b32 s21, s21, 3
 s_lshl_b32 s83, s21, 15
 s_add_u32 s21, s52, 1
 s_and_b32 s22, s21, 3
 s_lshl_b32 s3, s22, 15
 s_mul_i32 s80, s21, 393216
 s_add_u32 s46, s21, 1
 s_min_u32 s46, s46, 64
 s_mov_b32 s47, s57
 s_lshl_b32 s21, s52, 12
 s_and_b32 s21, s21, 8192
 s_xor_b32 s21, s21, s37
 s_lshl_b32 s22, s52, 20
 s_or_b32 s22, s22, s21
 s_cmp_ge_u32 s52, 36
 s_cselect_b32 s57, 8192, 0
 s_xor_b32 s57, s57, s22
 s_xor_b32 s85, s22, 8192
 s_bfe_u32 s88, s52, 0x10002
 s_max_u32 s67, s52, 1
 s_sub_u32 s67, s67, 1
 s_cmp_eq_u32 s53, 0
 s_cbranch_scc1 A1_17
 s_cmp_eq_u32 s20, 0
 s_cbranch_scc1 A1_13
 s_cmp_eq_u32 s20, 1
 s_cbranch_scc1 A1_14
 s_cmp_eq_u32 s20, 2
 s_cbranch_scc1 A1_15
 s_cmp_eq_u32 s20, 3
 s_cbranch_scc1 A1_16
 s_branch A1_17
step_18:
 s_and_b32 s21, s52, 3
 s_mul_i32 s81, s21, 540672
 s_lshl_b32 s84, s21, 15
 s_add_u32 s21, s52, 3
 s_and_b32 s21, s21, 3
 s_lshl_b32 s83, s21, 15
 s_add_u32 s21, s52, 1
 s_and_b32 s22, s21, 3
 s_lshl_b32 s3, s22, 15
 s_mul_i32 s80, s21, 393216
 s_add_u32 s46, s21, 1
 s_min_u32 s46, s46, 64
 s_mov_b32 s47, s57
 s_lshl_b32 s21, s52, 12
 s_and_b32 s21, s21, 8192
 s_xor_b32 s21, s21, s37
 s_lshl_b32 s22, s52, 20
 s_or_b32 s22, s22, s21
 s_cmp_ge_u32 s52, 36
 s_cselect_b32 s57, 8192, 0
 s_xor_b32 s57, s57, s22
 s_xor_b32 s85, s22, 8192
 s_bfe_u32 s88, s52, 0x10002
 s_max_u32 s67, s52, 1
 s_sub_u32 s67, s67, 1
 v_mov_b32 v40, 0
 v_mov_b32 v41, 0
 v_mov_b32 v42, 0
 v_mov_b32 v43, 0
 v_mov_b32 v44, 0
 v_mov_b32 v45, 0
 v_mov_b32 v46, 0
 v_mov_b32 v47, 0
 v_mov_b32 v48, 0
 v_mov_b32 v49, 0
 v_mov_b32 v50, 0
 v_mov_b32 v51, 0
 v_mov_b32 v52, 0
 v_mov_b32 v53, 0
 v_mov_b32 v54, 0
 v_mov_b32 v55, 0
 v_mov_b32 v56, 0
 v_mov_b32 v57, 0
 v_mov_b32 v58, 0
 v_mov_b32 v59, 0
 v_mov_b32 v60, 0
 v_mov_b32 v61, 0
 v_mov_b32 v62, 0
 v_mov_b32 v63, 0
 v_mov_b32 v100, 0
 v_mov_b32 v101, 0
 v_mov_b32 v102, 0
 v_mov_b32 v103, 0
 v_mov_b32 v104, 0
 v_mov_b32 v105, 0
 v_mov_b32 v106, 0
 v_mov_b32 v107, 0
 v_mov_b32 v108, 0
 v_mov_b32 v109, 0
 v_mov_b32 v110, 0
 v_mov_b32 v111, 0
 s_sleep 5
 v_readfirstlane_b32 s21, v0
 s_cmp_lt_u32 s21, s46
 s_cselect_b32 s55, s55, 0
 s_cmp_lt_i32 s55, 0
 s_cbranch_scc1 fl_23
fl_24:
 s_mov_b32 s54, 0
 buffer_load_dwordx4 v[36:39], v4, s[4:7], s84 offen offset:2048 sc1
 buffer_load_dwordx4 v[28:31], v4, s[4:7], s84 offen offset:0 sc1
 buffer_load_dwordx4 v[32:35], v4, s[4:7], s84 offen offset:1024 sc1
 s_waitcnt vmcnt(3)
 v_mov_b32 v126, v88
 v_mov_b32 v127, v89
 v_mov_b32 v128, v90
 v_mov_b32 v129, v91
 v_mov_b32 v130, v92
 v_mov_b32 v131, v93
 v_mov_b32 v132, v94
 v_mov_b32 v133, v95
 v_mov_b32 v134, v96
 v_mov_b32 v135, v97
 v_mov_b32 v136, v98
 v_mov_b32 v137, v99
 s_waitcnt vmcnt(2)
 v_smfmac_f32_16x16x32_f16 v[40:43], v[36:37], a[16:19], v25
 v_smfmac_f32_16x16x32_f16 v[52:55], v[36:37], a[76:79], v25
 v_smfmac_f32_16x16x32_f16 v[44:47], v[36:37], a[36:39], v25
 s_waitcnt vmcnt(0)
 v_bitop3_b32 v27, v31, v35, v39 bitop3:0x80
 v_perm_b32 v31, v35, v31, s89
 v_cmp_gt_u32 vcc, 0x48000000, v27
 v_mov_b32 v35, v38
 v_smfmac_f32_16x16x32_f16 v[56:59], v[36:37], a[96:99], v25
 s_cbranch_vccnz pm_21
A2_22:
 v_smfmac_f32_16x16x64_f16 v[40:43], v[28:31], a[0:7], v25
 ds_write_b128 v10, v[28:31]
 v_smfmac_f32_16x16x64_f16 v[40:43], v[32:35], a[8:15], v25
 ds_write_b128 v10, v[32:35] offset:1024
 v_smfmac_f32_16x16x64_f16 v[52:55], v[28:31], a[60:67], v25
 ds_write_b64 v10, v[36:37] offset:2048
 v_smfmac_f32_16x16x64_f16 v[52:55], v[32:35], a[68:75], v25
 v_cvt_pk_f16_f32 v40, v40, v41
 v_cvt_pk_f16_f32 v41, v42, v43
 v_smfmac_f32_16x16x32_f16 v[48:51], v[36:37], a[56:59], v25
 v_smfmac_f32_16x16x32_f16 v[60:63], v[36:37], a[116:119], v25
 v_smfmac_f32_16x16x64_f16 v[44:47], v[28:31], a[20:27], v25
 v_cvt_pk_f16_f32 v52, v52, v53
 v_cvt_pk_f16_f32 v53, v54, v55
 s_nop 0
 v_smfmac_f32_16x16x64_f16 v[44:47], v[32:35], a[28:35], v25
 v_permlane32_swap_b32 v40, v52
 v_smfmac_f32_16x16x64_f16 v[56:59], v[28:31], a[80:87], v25
 v_permlane32_swap_b32 v41, v53
 v_pk_add_f16 v40, v40, v52
 v_smfmac_f32_16x16x64_f16 v[56:59], v[32:35], a[88:95], v25
 v_pk_add_f16 v41, v41, v53
 v_smfmac_f32_16x16x64_f16 v[48:51], v[28:31], a[40:47], v25
 ds_write_b64 v5, v[40:41] offset:0
 v_smfmac_f32_16x16x64_f16 v[48:51], v[32:35], a[48:55], v25
 v_cvt_pk_f16_f32 v44, v44, v45
 v_cvt_pk_f16_f32 v45, v46, v47
 v_cvt_pk_f16_f32 v56, v56, v57
 v_smfmac_f32_16x16x64_f16 v[60:63], v[28:31], a[100:107], v25
 v_cvt_pk_f16_f32 v57, v58, v59
 s_nop 0
 v_smfmac_f32_16x16x64_f16 v[60:63], v[32:35], a[108:115], v25
 v_permlane32_swap_b32 v44, v56
 v_permlane32_swap_b32 v45, v57
 v_pk_add_f16 v44, v44, v56
 v_pk_add_f16 v45, v45, v57
 ds_write_b64 v5, v[44:45] offset:640
 v_cvt_pk_f16_f32 v48, v48, v49
 v_cvt_pk_f16_f32 v49, v50, v51
 v_cvt_pk_f16_f32 v60, v60, v61
 v_cvt_pk_f16_f32 v61, v62, v63
 s_nop 0
 v_permlane32_swap_b32 v48, v60
 v_permlane32_swap_b32 v49, v61
 v_pk_add_f16 v48, v48, v60
 v_pk_add_f16 v49, v49, v61
 ds_write_b64 v5, v[48:49] offset:1280
 s_waitcnt lgkmcnt(0) vmcnt(0)
 s_barrier
 ds_read_b64_tr_b16 v[40:41], v21 offset:0
 ds_read_b64_tr_b16 v[42:43], v21 offset:1920
 ds_read_b64_tr_b16 v[44:45], v21 offset:640
 ds_read_b64_tr_b16 v[46:47], v21 offset:2560
 ds_read_b64_tr_b16 v[48:49], v21 offset:1280
 ds_read_b64_tr_b16 v[50:51], v21 offset:3200
 s_waitcnt lgkmcnt(4)
 v_fma_mix_f32 v52, v40, 1.0, v42 op_sel:[0,0,0] op_sel_hi:[1,0,1]
 v_fma_mix_f32 v53, v40, 1.0, v42 op_sel:[1,0,1] op_sel_hi:[1,0,1]
 v_fma_mix_f32 v54, v41, 1.0, v43 op_sel:[0,0,0] op_sel_hi:[1,0,1]
 v_fma_mix_f32 v55, v41, 1.0, v43 op_sel:[1,0,1] op_sel_hi:[1,0,1]
 v_add_f32_dpp v56, v52, v52 row_ror:8 row_mask:0xf bank_mask:0xf
 v_add_f32_dpp v57, v53, v53 row_ror:8 row_mask:0xf bank_mask:0xf
 v_add_f32_dpp v58, v54, v54 row_ror:8 row_mask:0xf bank_mask:0xf
 v_add_f32_dpp v59, v55, v55 row_ror:8 row_mask:0xf bank_mask:0xf
 v_cvt_pk_bf16_f32 v118, v56, v57
 v_cvt_pk_bf16_f32 v119, v58, v59
 s_waitcnt lgkmcnt(2)
 v_fma_mix_f32 v52, v44, 1.0, v46 op_sel:[0,0,0] op_sel_hi:[1,0,1]
 v_fma_mix_f32 v53, v44, 1.0, v46 op_sel:[1,0,1] op_sel_hi:[1,0,1]
 v_fma_mix_f32 v54, v45, 1.0, v47 op_sel:[0,0,0] op_sel_hi:[1,0,1]
 v_fma_mix_f32 v55, v45, 1.0, v47 op_sel:[1,0,1] op_sel_hi:[1,0,1]
 v_add_f32_dpp v56, v52, v52 row_ror:8 row_mask:0xf bank_mask:0xf
 v_add_f32_dpp v57, v53, v53 row_ror:8 row_mask:0xf bank_mask:0xf
 v_add_f32_dpp v58, v54, v54 row_ror:8 row_mask:0xf bank_mask:0xf
 v_add_f32_dpp v59, v55, v55 row_ror:8 row_mask:0xf bank_mask:0xf
 v_cvt_pk_bf16_f32 v120, v56, v57
 v_cvt_pk_bf16_f32 v121, v58, v59
 s_waitcnt lgkmcnt(0)
 v_fma_mix_f32 v52, v48, 1.0, v50 op_sel:[0,0,0] op_sel_hi:[1,0,1]
 v_fma_mix_f32 v53, v48, 1.0, v50 op_sel:[1,0,1] op_sel_hi:[1,0,1]
 v_fma_mix_f32 v54, v49, 1.0, v51 op_sel:[0,0,0] op_sel_hi:[1,0,1]
 v_fma_mix_f32 v55, v49, 1.0, v51 op_sel:[1,0,1] op_sel_hi:[1,0,1]
 v_mfma_f32_16x16x32_bf16 v[40:43], v[112:115], v[118:121], 0
 v_add_f32_dpp v56, v52, v52 row_ror:8 row_mask:0xf bank_mask:0xf
 v_add_f32_dpp v57, v53, v53 row_ror:8 row_mask:0xf bank_mask:0xf
 v_add_f32_dpp v58, v54, v54 row_ror:8 row_mask:0xf bank_mask:0xf
 v_add_f32_dpp v59, v55, v55 row_ror:8 row_mask:0xf bank_mask:0xf
 v_cvt_pk_bf16_f32 v122, v56, v57
 v_cvt_pk_bf16_f32 v123, v58, v59
 s_nop 1
 v_mfma_f32_16x16x32_bf16 v[40:43], v[116:119], v[122:125], v[40:43]
 ds_read_b128 v[28:31], v16 offset:24576
 ds_read_b128 v[32:35], v16 offset:25600
 ds_read_b128 v[64:67], v16 offset:27648
 ds_read_b128 v[68:71], v16 offset:28672
 ds_read_b128 v[72:75], v16 offset:30720
 ds_read_b128 v[76:79], v16 offset:31744
 s_nop 0
 s_mov_b64 exec, s[74:75]
 v_cvt_pk_f16_f32 v44, v40, v41
 v_cvt_pk_f16_f32 v45, v42, v43
 v_and_or_b32 v44, v44, -2, s88
 buffer_store_dwordx2 v[44:45], v7, s[8:11], s81 offen
 s_mov_b64 exec, -1
 ds_read_b128 v[80:83], v16 offset:33792
 ds_read_b128 v[84:87], v16 offset:34816
 ds_read_b64 v[88:89], v16 offset:26624
 ds_read_b64 v[90:91], v16 offset:29696
 ds_read_b64 v[92:93], v16 offset:32768
 ds_read_b64 v[94:95], v16 offset:35840
 s_cmp_eq_u32 s52, 63
 s_cbranch_scc1 last_19
 s_waitcnt lgkmcnt(10)
 v_smfmac_f32_16x16x64_f16 v[100:103], v[28:31], a[120:127], v25
 v_smfmac_f32_16x16x64_f16 v[104:107], v[28:31], a[128:135], v25
 v_smfmac_f32_16x16x64_f16 v[108:111], v[28:31], a[136:143], v25
 s_mov_b32 s54, 0
 v_smfmac_f32_16x16x64_f16 v[100:103], v[32:35], a[144:151], v25
 v_readfirstlane_b32 s21, v0
 v_smfmac_f32_16x16x64_f16 v[104:107], v[32:35], a[152:159], v25
 s_add_u32 s22, s46, 3
 v_smfmac_f32_16x16x64_f16 v[108:111], v[32:35], a[160:167], v25
 s_min_u32 s22, s22, 64
 s_waitcnt lgkmcnt(7)
 v_smfmac_f32_16x16x64_f16 v[100:103], v[64:67], a[168:175], v25
 s_sub_u32 s55, s21, s22
 v_smfmac_f32_16x16x64_f16 v[104:107], v[64:67], a[176:183], v25
 s_sub_u32 s56, s21, s46
 v_smfmac_f32_16x16x64_f16 v[108:111], v[64:67], a[184:191], v25
 v_smfmac_f32_16x16x64_f16 v[100:103], v[68:71], a[192:199], v25
 v_smfmac_f32_16x16x64_f16 v[104:107], v[68:71], a[200:207], v25
 v_smfmac_f32_16x16x64_f16 v[108:111], v[68:71], a[208:215], v25
 v_smfmac_f32_16x16x64_f16 v[100:103], v[72:75], a[216:223], v25
 v_smfmac_f32_16x16x64_f16 v[104:107], v[72:75], a[224:231], v25
 v_smfmac_f32_16x16x64_f16 v[108:111], v[72:75], a[232:239], v25
 s_waitcnt lgkmcnt(4)
 v_smfmac_f32_16x16x64_f16 v[100:103], v[76:79], a[240:247], v25
 v_smfmac_f32_16x16x64_f16 v[104:107], v[76:79], a[248:255], v25
 v_smfmac_f32_16x16x64_f16 v[108:111], v[76:79], v[152:159], v25
 v_smfmac_f32_16x16x64_f16 v[100:103], v[80:83], v[160:167], v25
 v_smfmac_f32_16x16x64_f16 v[104:107], v[80:83], v[168:175], v25
 buffer_load_dwordx2 v[58:59], v9, s[8:11], s81 offen sc1
 buffer_load_dwordx4 v[40:43], v8, s[8:11], s81 offen offset:0 sc1
 buffer_load_dwordx4 v[44:47], v8, s[8:11], s81 offen offset:1024 sc1
 v_smfmac_f32_16x16x64_f16 v[108:111], v[80:83], v[176:183], v25
 v_smfmac_f32_16x16x64_f16 v[100:103], v[84:87], v[184:191], v25
 v_smfmac_f32_16x16x64_f16 v[104:107], v[84:87], v[192:199], v25
 v_smfmac_f32_16x16x64_f16 v[108:111], v[84:87], v[200:207], v25
 s_waitcnt lgkmcnt(0)
 v_smfmac_f32_16x16x64_f16 v[100:103], v[88:91], v[208:215], v25
 v_smfmac_f32_16x16x64_f16 v[104:107], v[88:91], v[216:223], v25
 v_smfmac_f32_16x16x64_f16 v[108:111], v[88:91], v[224:231], v25
 v_smfmac_f32_16x16x64_f16 v[100:103], v[92:95], v[232:239], v25
 v_smfmac_f32_16x16x64_f16 v[104:107], v[92:95], v[240:247], v25
 v_smfmac_f32_16x16x64_f16 v[108:111], v[92:95], v[248:255], v25
 s_cmp_lt_i32 s56, 0
 s_cbranch_scc1 kvw_27
kvok_28:
 s_waitcnt vmcnt(2)
 v_xor_b32 v76, s88, v58
 s_nop 0
 v_permlane16_swap_b32 v58, v59
 v_fma_mix_f32 v60, v58, 1.0, v59 op_sel:[0,0,0] op_sel_hi:[1,0,1]
 v_fma_mix_f32 v61, v58, 1.0, v59 op_sel:[1,0,1] op_sel_hi:[1,0,1]
 v_mov_b32 v58, v60
 v_mov_b32 v59, v61
 s_nop 0
 v_permlane32_swap_b32 v58, v60
 v_permlane32_swap_b32 v59, v61
 v_add_f32 v52, v58, v60
 v_add_f32 v53, v59, v61
 v_max_f32 v79, v52, v53
 s_waitcnt vmcnt(0)
 v_pk_add_f16 v80, v40, v44
 v_pk_add_f16 v82, v42, v46
 v_pk_add_f16 v81, v41, v45
 v_pk_add_f16 v83, v43, v47
 v_permlane32_swap_b32 v80, v82
 v_bitop3_b32 v77, v40, v42, s88 bitop3:0x7e
 v_permlane32_swap_b32 v81, v83
 v_bitop3_b32 v78, v44, v46, s88 bitop3:0x7e
 v_fma_mix_f32 v48, v80, 1.0, v82 op_sel:[0,0,0] op_sel_hi:[1,0,1]
 v_or3_b32 v27, v76, v77, v78
 v_fma_mix_f32 v49, v80, 1.0, v82 op_sel:[1,0,1] op_sel_hi:[1,0,1]
 v_and_b32 v27, 1, v27
 v_fma_mix_f32 v50, v81, 1.0, v83 op_sel:[0,0,0] op_sel_hi:[1,0,1]
 v_cmp_ne_u32 vcc, 0, v27
 v_fma_mix_f32 v51, v81, 1.0, v83 op_sel:[1,0,1] op_sel_hi:[1,0,1]
 v_max3_f32 v62, v48, v49, v79
 s_cbranch_vccnz psr_25
psj_26:
 v_max3_f32 v62, v62, v50, v51
 v_cvt_pk_bf16_f32 v146, v100, v101
 v_cvt_pk_bf16_f32 v147, v102, v103
 v_max_f32_dpp v62, v62, v62 row_ror:8 row_mask:0xf bank_mask:0xf
 v_mov_b32 v63, v62
 v_cvt_pk_bf16_f32 v148, v104, v105
 v_cvt_pk_bf16_f32 v149, v106, v107
 v_permlane32_swap_b32 v62, v63
 v_max_f32 v62, v62, v63
 v_mov_b32 v63, v62
 v_cvt_pk_bf16_f32 v150, v108, v109
 v_cvt_pk_bf16_f32 v151, v110, v111
 v_permlane16_swap_b32 v62, v63
 v_max_f32 v62, v62, v63
 v_mul_f32 v62, s86, v62
 v_fma_f32 v48, v48, s86, -v62
 v_fma_f32 v49, v49, s86, -v62
 v_fma_f32 v50, v50, s86, -v62
 v_fma_f32 v51, v51, s86, -v62
 v_fma_f32 v52, v52, s86, -v62
 v_fma_f32 v53, v53, s86, -v62
 v_exp_f32 v48, v48
 v_exp_f32 v49, v49
 buffer_load_dwordx4 v[88:91], v17, s[28:31], s64 offen offset:0 sc1
 v_exp_f32 v50, v50
 v_exp_f32 v51, v51
 buffer_load_dwordx4 v[92:95], v16, s[28:31], s64 offen offset:1024 sc1
 v_exp_f32 v52, v52
 v_exp_f32 v53, v53
 buffer_load_dwordx4 v[96:99], v20, s[28:31], s64 offen offset:2048 sc1
 v_cvt_pk_bf16_f32 v138, v48, v49
 v_cvt_pk_bf16_f32 v139, v50, v51
 v_cvt_pk_bf16_f32 v142, v52, v53
 v_mov_b32_dpp v140, v138 row_ror:8 row_mask:0xf bank_mask:0xf
 v_mov_b32_dpp v141, v139 row_ror:8 row_mask:0xf bank_mask:0xf
 v_mov_b32_dpp v143, v142 row_ror:8 row_mask:0xf bank_mask:0xf
 buffer_load_dwordx4 v[112:115], v18, s[16:19], s80 offen sc1
 v_add_f32 v54, v48, v49
 v_mfma_f32_16x16x32_bf16 v[64:67], v[126:129], v[138:141], 0
 v_add_f32 v55, v50, v51
 v_add_f32 v56, v52, v53
 v_mfma_f32_16x16x32_bf16 v[64:67], v[146:149], v[142:145], v[64:67]
 v_add_f32 v62, v54, v55
 v_fmac_f32 v62, v56, v26
 v_mfma_f32_16x16x32_bf16 v[68:71], v[130:133], v[138:141], 0
 buffer_load_dwordx2 v[116:117], v19, s[16:19], s80 offen sc1
 v_add_f32_dpp v62, v62, v62 row_ror:8 row_mask:0xf bank_mask:0xf
 v_mfma_f32_16x16x32_bf16 v[68:71], v[148:151], v[142:145], v[68:71]
 v_mov_b32 v63, v62
 s_cmp_lt_i32 s55, 0
 s_cbranch_scc1 fl_29
fl_30:
 v_mfma_f32_16x16x32_bf16 v[72:75], v[134:137], v[138:141], 0
 v_permlane32_swap_b32 v62, v63
 v_mfma_f32_16x16x32_bf16 v[72:75], v[150:153], v[142:145], v[72:75]
 v_add_f32 v62, v62, v63
 v_mov_b32 v63, v62
 ds_write_b128 v11, v[64:67] offset:0
 s_nop 0
 v_permlane16_swap_b32 v62, v63
 v_add_f32 v62, v62, v63
 v_rcp_f32 v62, v62
 ds_write_b128 v11, v[68:71] offset:1024
 s_mov_b64 exec, 0xff
 ds_write_b32 v22, v62
 s_mov_b64 exec, -1
 ds_write_b128 v11, v[72:75] offset:2048
 s_waitcnt lgkmcnt(0)
 s_barrier
 ds_read_b128 v[72:75], v23
 ds_read_b64 v[64:65], v12 offset:0
 ds_read_b64 v[66:67], v12 offset:3072
 ds_read_b64 v[68:69], v12 offset:6144
 ds_read_b64 v[70:71], v12 offset:9216
 s_waitcnt lgkmcnt(2)
 v_pk_mul_f32 v[64:65], v[64:65], v[72:73] op_sel_hi:[1,0]
 v_pk_fma_f32 v[64:65], v[66:67], v[72:73], v[64:65] op_sel:[0,1,0] op_sel_hi:[1,1,1]
 s_waitcnt lgkmcnt(0)
 v_pk_fma_f32 v[64:65], v[68:69], v[74:75], v[64:65] op_sel_hi:[1,0,1]
 v_pk_fma_f32 v[64:65], v[70:71], v[74:75], v[64:65] op_sel:[0,1,0] op_sel_hi:[1,1,1]
 v_cvt_pk_f16_f32 v68, v64, v65
 v_perm_b32 v68, s91, v68, v14
 buffer_atomic_pk_add_f16 v68, v13, s[4:7], s3 offen
 v_mov_b32 v76, v108
 v_mov_b32 v77, v109
 v_mov_b32 v78, v110
 v_mov_b32 v79, v111
 v_permlane32_swap_b32 v100, v104
 v_permlane32_swap_b32 v101, v105
 v_permlane32_swap_b32 v102, v106
 v_permlane32_swap_b32 v103, v107
 v_permlane32_swap_b32 v108, v76
 v_permlane32_swap_b32 v109, v77
 v_permlane32_swap_b32 v110, v78
 v_permlane32_swap_b32 v111, v79
 v_pk_add_f32 v[100:101], v[100:101], v[104:105]
 v_pk_add_f32 v[102:103], v[102:103], v[106:107]
 v_pk_add_f32 v[108:109], v[108:109], v[76:77]
 v_pk_add_f32 v[110:111], v[110:111], v[78:79]
 v_cvt_pk_bf16_f32 v80, v100, v101
 v_cvt_pk_bf16_f32 v82, v108, v109
 v_cvt_pk_bf16_f32 v81, v102, v103
 v_cvt_pk_bf16_f32 v83, v110, v111
 s_nop 0
 v_permlane16_swap_b32 v80, v82
 v_permlane16_swap_b32 v81, v83
 v_min_u32 v80, -2, v80
 s_mov_b64 exec, s[76:77]
 buffer_store_dwordx4 v[80:83], v15, s[24:27], s57 offen sc1
 s_mov_b64 exec, -1
 s_add_u32 s64, s64, 1310720
 s_add_u32 s52, s52, 1
 s_branch step_18
fl_23:
 buffer_load_dword v0, off, s[12:15], s79 sc1
 s_branch fl_24
A1_13:
 v_smfmac_f32_16x16x32_f16 v[40:43], v[36:37], a[16:19], v25
 v_smfmac_f32_16x16x32_f16 v[52:55], v[36:37], a[76:79], v25
 v_smfmac_f32_16x16x32_f16 v[44:47], v[36:37], a[36:39], v25
 v_smfmac_f32_16x16x32_f16 v[56:59], v[36:37], a[96:99], v25
 s_branch A2_22
pm_21:
 buffer_load_dwordx4 v[36:39], v4, s[4:7], s84 offen offset:2048 sc1
 buffer_load_dwordx4 v[28:31], v4, s[4:7], s84 offen offset:0 sc1
 buffer_load_dwordx4 v[32:35], v4, s[4:7], s84 offen offset:1024 sc1
 s_nop 7
 v_mov_b32 v40, 0
 v_mov_b32 v41, 0
 v_mov_b32 v42, 0
 v_mov_b32 v43, 0
 v_mov_b32 v52, 0
 v_mov_b32 v53, 0
 v_mov_b32 v54, 0
 v_mov_b32 v55, 0
 v_mov_b32 v44, 0
 v_mov_b32 v45, 0
 v_mov_b32 v46, 0
 v_mov_b32 v47, 0
 v_mov_b32 v56, 0
 v_mov_b32 v57, 0
 v_mov_b32 v58, 0
 v_mov_b32 v59, 0
 s_waitcnt vmcnt(0)
 v_bitop3_b32 v27, v31, v35, v39 bitop3:0x80
 v_perm_b32 v31, v35, v31, s89
 v_cmp_gt_u32 vcc, 0x48000000, v27
 v_mov_b32 v35, v38
 s_cbranch_vccz A1_13
pm_20:
 s_cmp_gt_u32 s52, 3
 s_cbranch_scc1 op_31
 v_readfirstlane_b32 s21, v0
 s_cmp_ge_u32 s21, s46
 s_cbranch_scc1 op_31
 buffer_load_dword v0, off, s[12:15], s79 sc1
 s_waitcnt vmcnt(0)
 v_readfirstlane_b32 s21, v0
 s_cmp_gt_u32 s21, s52
 s_cselect_b32 s21, s87, 0
 s_cmp_eq_u32 s21, 0
 s_cbranch_scc1 op_31
 s_mov_b32 s87, 0
 s_sub_u32 s21, s64, 1310720
 buffer_load_dwordx4 v[126:129], v16, s[28:31], s21 offen offset:0 sc1
 buffer_load_dwordx4 v[130:133], v16, s[28:31], s21 offen offset:1024 sc1
 buffer_load_dwordx4 v[134:137], v16, s[28:31], s21 offen offset:2048 sc1
op_31:
 buffer_load_dwordx4 v[36:39], v4, s[4:7], s84 offen offset:2048 sc1
 buffer_load_dwordx4 v[28:31], v4, s[4:7], s84 offen offset:0 sc1
 buffer_load_dwordx4 v[32:35], v4, s[4:7], s84 offen offset:1024 sc1
 s_add_u32 s54, s54, 1
 s_cmp_gt_u32 s54, 131072
 s_cbranch_scc1 end0
 s_waitcnt vmcnt(0)
 v_bitop3_b32 v27, v31, v35, v39 bitop3:0x80
 v_perm_b32 v31, v35, v31, s89
 v_cmp_gt_u32 vcc, 0x48000000, v27
 v_mov_b32 v35, v38
 s_cbranch_vccnz pm_20
 s_branch A1_13
psr_25:
 buffer_load_dwordx2 v[58:59], v9, s[8:11], s81 offen sc1
 buffer_load_dwordx4 v[40:43], v8, s[8:11], s81 offen offset:0 sc1
 buffer_load_dwordx4 v[44:47], v8, s[8:11], s81 offen offset:1024 sc1
 s_add_u32 s54, s54, 1
 s_cmp_gt_u32 s54, 131072
 s_cbranch_scc1 end0
 s_waitcnt vmcnt(2)
 v_xor_b32 v76, s88, v58
 s_nop 0
 v_permlane16_swap_b32 v58, v59
 v_fma_mix_f32 v60, v58, 1.0, v59 op_sel:[0,0,0] op_sel_hi:[1,0,1]
 v_fma_mix_f32 v61, v58, 1.0, v59 op_sel:[1,0,1] op_sel_hi:[1,0,1]
 v_mov_b32 v58, v60
 v_mov_b32 v59, v61
 s_nop 0
 v_permlane32_swap_b32 v58, v60
 v_permlane32_swap_b32 v59, v61
 v_add_f32 v52, v58, v60
 v_add_f32 v53, v59, v61
 v_max_f32 v79, v52, v53
 s_waitcnt vmcnt(0)
 v_pk_add_f16 v80, v40, v44
 v_pk_add_f16 v82, v42, v46
 v_pk_add_f16 v81, v41, v45
 v_pk_add_f16 v83, v43, v47
 v_permlane32_swap_b32 v80, v82
 v_bitop3_b32 v77, v40, v42, s88 bitop3:0x7e
 v_permlane32_swap_b32 v81, v83
 v_bitop3_b32 v78, v44, v46, s88 bitop3:0x7e
 v_fma_mix_f32 v48, v80, 1.0, v82 op_sel:[0,0,0] op_sel_hi:[1,0,1]
 v_or3_b32 v27, v76, v77, v78
 v_fma_mix_f32 v49, v80, 1.0, v82 op_sel:[1,0,1] op_sel_hi:[1,0,1]
 v_and_b32 v27, 1, v27
 v_fma_mix_f32 v50, v81, 1.0, v83 op_sel:[0,0,0] op_sel_hi:[1,0,1]
 v_cmp_ne_u32 vcc, 0, v27
 v_fma_mix_f32 v51, v81, 1.0, v83 op_sel:[1,0,1] op_sel_hi:[1,0,1]
 v_max3_f32 v62, v48, v49, v79
 s_cbranch_vccnz psr_25
 s_branch psj_26
kvw_27:
 s_mov_b32 s22, s87
 s_cmp_eq_u32 s52, 0
 s_cselect_b32 s55, 0, s55
 s_cselect_b32 s87, 1, 0
 s_cbranch_scc1 kvok_28
 v_mov_b32 v62, 0
 s_mov_b32 s101, 0
wf_32:
 buffer_load_dword v63, v62, s[12:15], s79 offen sc1
 s_add_u32 s101, s101, 1
 s_cmp_gt_u32 s101, 131072
 s_cbranch_scc1 end0
 s_waitcnt vmcnt(0)
 v_readfirstlane_b32 s100, v63
 s_cmp_ge_u32 s100, s46
 s_cbranch_scc1 wf_33
 s_sleep 3
 s_branch wf_32
wf_33:
 s_cmp_eq_u32 s22, 0
 s_cbranch_scc1 kvok_28
 s_sub_u32 s21, s64, 1310720
 buffer_load_dwordx4 v[126:129], v16, s[28:31], s21 offen offset:0 sc1
 buffer_load_dwordx4 v[130:133], v16, s[28:31], s21 offen offset:1024 sc1
 buffer_load_dwordx4 v[134:137], v16, s[28:31], s21 offen offset:2048 sc1
 s_waitcnt vmcnt(0)
 s_branch kvok_28
fl_29:
 buffer_load_dword v0, off, s[12:15], s79 sc1
 s_branch fl_30
last_19:
 s_waitcnt lgkmcnt(10)
 v_smfmac_f32_16x16x64_f16 v[100:103], v[28:31], a[120:127], v25
 v_smfmac_f32_16x16x64_f16 v[104:107], v[28:31], a[128:135], v25
 v_smfmac_f32_16x16x64_f16 v[108:111], v[28:31], a[136:143], v25
 v_smfmac_f32_16x16x64_f16 v[100:103], v[32:35], a[144:151], v25
 v_smfmac_f32_16x16x64_f16 v[104:107], v[32:35], a[152:159], v25
 v_smfmac_f32_16x16x64_f16 v[108:111], v[32:35], a[160:167], v25
 s_waitcnt lgkmcnt(7)
 v_smfmac_f32_16x16x64_f16 v[100:103], v[64:67], a[168:175], v25
 v_smfmac_f32_16x16x64_f16 v[104:107], v[64:67], a[176:183], v25
 v_smfmac_f32_16x16x64_f16 v[108:111], v[64:67], a[184:191], v25
 v_smfmac_f32_16x16x64_f16 v[100:103], v[68:71], a[192:199], v25
 v_smfmac_f32_16x16x64_f16 v[104:107], v[68:71], a[200:207], v25
 v_smfmac_f32_16x16x64_f16 v[108:111], v[68:71], a[208:215], v25
 v_smfmac_f32_16x16x64_f16 v[100:103], v[72:75], a[216:223], v25
 v_smfmac_f32_16x16x64_f16 v[104:107], v[72:75], a[224:231], v25
 v_smfmac_f32_16x16x64_f16 v[108:111], v[72:75], a[232:239], v25
 s_waitcnt lgkmcnt(4)
 v_smfmac_f32_16x16x64_f16 v[100:103], v[76:79], a[240:247], v25
 v_smfmac_f32_16x16x64_f16 v[104:107], v[76:79], a[248:255], v25
 v_smfmac_f32_16x16x64_f16 v[108:111], v[76:79], v[152:159], v25
 v_smfmac_f32_16x16x64_f16 v[100:103], v[80:83], v[160:167], v25
 v_smfmac_f32_16x16x64_f16 v[104:107], v[80:83], v[168:175], v25
 v_smfmac_f32_16x16x64_f16 v[108:111], v[80:83], v[176:183], v25
 v_smfmac_f32_16x16x64_f16 v[100:103], v[84:87], v[184:191], v25
 v_smfmac_f32_16x16x64_f16 v[104:107], v[84:87], v[192:199], v25
 v_smfmac_f32_16x16x64_f16 v[108:111], v[84:87], v[200:207], v25
 s_waitcnt lgkmcnt(0)
 v_smfmac_f32_16x16x64_f16 v[100:103], v[88:91], v[208:215], v25
 v_smfmac_f32_16x16x64_f16 v[104:107], v[88:91], v[216:223], v25
 v_smfmac_f32_16x16x64_f16 v[108:111], v[88:91], v[224:231], v25
 v_smfmac_f32_16x16x64_f16 v[100:103], v[92:95], v[232:239], v25
 v_smfmac_f32_16x16x64_f16 v[104:107], v[92:95], v[240:247], v25
 v_smfmac_f32_16x16x64_f16 v[108:111], v[92:95], v[248:255], v25
 s_nop 7
 v_mov_b32 v76, v108
 v_mov_b32 v77, v109
 v_mov_b32 v78, v110
 v_mov_b32 v79, v111
 v_permlane32_swap_b32 v100, v104
 v_permlane32_swap_b32 v101, v105
 v_permlane32_swap_b32 v102, v106
 v_permlane32_swap_b32 v103, v107
 v_permlane32_swap_b32 v108, v76
 v_permlane32_swap_b32 v109, v77
 v_permlane32_swap_b32 v110, v78
 v_permlane32_swap_b32 v111, v79
 v_pk_add_f32 v[100:101], v[100:101], v[104:105]
 v_pk_add_f32 v[102:103], v[102:103], v[106:107]
 v_pk_add_f32 v[108:109], v[108:109], v[76:77]
 v_pk_add_f32 v[110:111], v[110:111], v[78:79]
 v_cvt_pk_bf16_f32 v80, v100, v101
 v_cvt_pk_bf16_f32 v82, v108, v109
 v_cvt_pk_bf16_f32 v81, v102, v103
 v_cvt_pk_bf16_f32 v83, v110, v111
 s_nop 0
 v_permlane16_swap_b32 v80, v82
 v_permlane16_swap_b32 v81, v83
 v_min_u32 v80, -2, v80
 s_mov_b64 exec, s[76:77]
 buffer_store_dwordx4 v[80:83], v15, s[24:27], s57 offen sc1
 s_mov_b64 exec, -1
 v_mov_b32 v246, 80
 v_mov_b32 v247, 1
 s_mov_b64 exec, 1
 buffer_atomic_add v247, v246, s[32:35], 0 offen sc0 sc1
 s_mov_b64 exec, -1
 s_branch chain_done
step_34:
 s_and_b32 s21, s52, 3
 s_mul_i32 s81, s21, 540672
 s_lshl_b32 s84, s21, 15
 s_add_u32 s21, s52, 3
 s_and_b32 s21, s21, 3
 s_lshl_b32 s83, s21, 15
 s_add_u32 s21, s52, 1
 s_and_b32 s22, s21, 3
 s_lshl_b32 s3, s22, 15
 s_mul_i32 s80, s21, 393216
 s_add_u32 s46, s21, 1
 s_min_u32 s46, s46, 64
 s_mov_b32 s47, s57
 s_lshl_b32 s21, s52, 12
 s_and_b32 s21, s21, 8192
 s_xor_b32 s21, s21, s37
 s_lshl_b32 s22, s52, 20
 s_or_b32 s22, s22, s21
 s_cmp_ge_u32 s52, 36
 s_cselect_b32 s57, 8192, 0
 s_xor_b32 s57, s57, s22
 s_xor_b32 s85, s22, 8192
 s_bfe_u32 s88, s52, 0x10002
 s_max_u32 s67, s52, 1
 s_sub_u32 s67, s67, 1
 v_mov_b32 v40, 0
 v_mov_b32 v41, 0
 v_mov_b32 v42, 0
 v_mov_b32 v43, 0
 v_mov_b32 v44, 0
 v_mov_b32 v45, 0
 v_mov_b32 v46, 0
 v_mov_b32 v47, 0
 v_mov_b32 v48, 0
 v_mov_b32 v49, 0
 v_mov_b32 v50, 0
 v_mov_b32 v51, 0
 v_mov_b32 v52, 0
 v_mov_b32 v53, 0
 v_mov_b32 v54, 0
 v_mov_b32 v55, 0
 v_mov_b32 v56, 0
 v_mov_b32 v57, 0
 v_mov_b32 v58, 0
 v_mov_b32 v59, 0
 v_mov_b32 v60, 0
 v_mov_b32 v61, 0
 v_mov_b32 v62, 0
 v_mov_b32 v63, 0
 v_mov_b32 v100, 0
 v_mov_b32 v101, 0
 v_mov_b32 v102, 0
 v_mov_b32 v103, 0
 v_mov_b32 v104, 0
 v_mov_b32 v105, 0
 v_mov_b32 v106, 0
 v_mov_b32 v107, 0
 v_mov_b32 v108, 0
 v_mov_b32 v109, 0
 v_mov_b32 v110, 0
 v_mov_b32 v111, 0
 s_sleep 5
 v_readfirstlane_b32 s21, v0
 s_cmp_lt_u32 s21, s46
 s_cselect_b32 s55, s55, 0
 s_cmp_lt_i32 s55, 0
 s_cbranch_scc1 fl_39
fl_40:
 s_mov_b32 s54, 0
 buffer_load_dwordx4 v[36:39], v4, s[4:7], s84 offen offset:2048 sc1
 buffer_load_dwordx4 v[28:31], v4, s[4:7], s84 offen offset:0 sc1
 buffer_load_dwordx4 v[32:35], v4, s[4:7], s84 offen offset:1024 sc1
 s_waitcnt vmcnt(3)
 v_mov_b32 v126, v88
 v_mov_b32 v127, v89
 v_mov_b32 v128, v90
 v_mov_b32 v129, v91
 v_mov_b32 v130, v92
 v_mov_b32 v131, v93
 v_mov_b32 v132, v94
 v_mov_b32 v133, v95
 v_mov_b32 v134, v96
 v_mov_b32 v135, v97
 v_mov_b32 v136, v98
 v_mov_b32 v137, v99
 s_waitcnt vmcnt(2)
 v_smfmac_f32_16x16x32_f16 v[40:43], v[36:37], a[16:19], v25
 v_smfmac_f32_16x16x32_f16 v[52:55], v[36:37], a[76:79], v25
 v_smfmac_f32_16x16x32_f16 v[44:47], v[36:37], a[36:39], v25
 s_waitcnt vmcnt(0)
 v_bitop3_b32 v27, v31, v35, v39 bitop3:0x80
 v_perm_b32 v31, v35, v31, s89
 v_cmp_gt_u32 vcc, 0x48000000, v27
 v_mov_b32 v35, v38
 v_smfmac_f32_16x16x32_f16 v[56:59], v[36:37], a[96:99], v25
 s_cbranch_vccnz pm_37
A2_38:
 v_smfmac_f32_16x16x64_f16 v[40:43], v[28:31], a[0:7], v25
 ds_write_b128 v10, v[28:31]
 v_smfmac_f32_16x16x64_f16 v[40:43], v[32:35], a[8:15], v25
 ds_write_b128 v10, v[32:35] offset:1024
 v_smfmac_f32_16x16x64_f16 v[52:55], v[28:31], a[60:67], v25
 ds_write_b64 v10, v[36:37] offset:2048
 v_smfmac_f32_16x16x64_f16 v[52:55], v[32:35], a[68:75], v25
 v_cvt_pk_f16_f32 v40, v40, v41
 v_cvt_pk_f16_f32 v41, v42, v43
 v_smfmac_f32_16x16x32_f16 v[48:51], v[36:37], a[56:59], v25
 v_smfmac_f32_16x16x32_f16 v[60:63], v[36:37], a[116:119], v25
 v_smfmac_f32_16x16x64_f16 v[44:47], v[28:31], a[20:27], v25
 v_cvt_pk_f16_f32 v52, v52, v53
 v_cvt_pk_f16_f32 v53, v54, v55
 s_nop 0
 v_smfmac_f32_16x16x64_f16 v[44:47], v[32:35], a[28:35], v25
 v_permlane32_swap_b32 v40, v52
 v_smfmac_f32_16x16x64_f16 v[56:59], v[28:31], a[80:87], v25
 v_permlane32_swap_b32 v41, v53
 v_pk_add_f16 v40, v40, v52
 v_smfmac_f32_16x16x64_f16 v[56:59], v[32:35], a[88:95], v25
 v_pk_add_f16 v41, v41, v53
 v_smfmac_f32_16x16x64_f16 v[48:51], v[28:31], a[40:47], v25
 ds_write_b64 v5, v[40:41] offset:0
 v_smfmac_f32_16x16x64_f16 v[48:51], v[32:35], a[48:55], v25
 v_cvt_pk_f16_f32 v44, v44, v45
 v_cvt_pk_f16_f32 v45, v46, v47
 v_cvt_pk_f16_f32 v56, v56, v57
 v_smfmac_f32_16x16x64_f16 v[60:63], v[28:31], a[100:107], v25
 v_cvt_pk_f16_f32 v57, v58, v59
 s_nop 0
 v_smfmac_f32_16x16x64_f16 v[60:63], v[32:35], a[108:115], v25
 v_permlane32_swap_b32 v44, v56
 v_permlane32_swap_b32 v45, v57
 v_pk_add_f16 v44, v44, v56
 v_pk_add_f16 v45, v45, v57
 ds_write_b64 v5, v[44:45] offset:640
 v_cvt_pk_f16_f32 v48, v48, v49
 v_cvt_pk_f16_f32 v49, v50, v51
 v_cvt_pk_f16_f32 v60, v60, v61
 v_cvt_pk_f16_f32 v61, v62, v63
 s_nop 0
 v_permlane32_swap_b32 v48, v60
 v_permlane32_swap_b32 v49, v61
 v_pk_add_f16 v48, v48, v60
 v_pk_add_f16 v49, v49, v61
 ds_write_b64 v5, v[48:49] offset:1280
 s_waitcnt lgkmcnt(0) vmcnt(0)
 s_barrier
 ds_read_b64_tr_b16 v[40:41], v21 offset:0
 ds_read_b64_tr_b16 v[42:43], v21 offset:1920
 ds_read_b64_tr_b16 v[44:45], v21 offset:640
 ds_read_b64_tr_b16 v[46:47], v21 offset:2560
 ds_read_b64_tr_b16 v[48:49], v21 offset:1280
 ds_read_b64_tr_b16 v[50:51], v21 offset:3200
 s_waitcnt lgkmcnt(4)
 v_fma_mix_f32 v52, v40, 1.0, v42 op_sel:[0,0,0] op_sel_hi:[1,0,1]
 v_fma_mix_f32 v53, v40, 1.0, v42 op_sel:[1,0,1] op_sel_hi:[1,0,1]
 v_fma_mix_f32 v54, v41, 1.0, v43 op_sel:[0,0,0] op_sel_hi:[1,0,1]
 v_fma_mix_f32 v55, v41, 1.0, v43 op_sel:[1,0,1] op_sel_hi:[1,0,1]
 v_add_f32_dpp v56, v52, v52 row_ror:8 row_mask:0xf bank_mask:0xf
 v_add_f32_dpp v57, v53, v53 row_ror:8 row_mask:0xf bank_mask:0xf
 v_add_f32_dpp v58, v54, v54 row_ror:8 row_mask:0xf bank_mask:0xf
 v_add_f32_dpp v59, v55, v55 row_ror:8 row_mask:0xf bank_mask:0xf
 v_cvt_pk_bf16_f32 v118, v56, v57
 v_cvt_pk_bf16_f32 v119, v58, v59
 s_waitcnt lgkmcnt(2)
 v_fma_mix_f32 v52, v44, 1.0, v46 op_sel:[0,0,0] op_sel_hi:[1,0,1]
 v_fma_mix_f32 v53, v44, 1.0, v46 op_sel:[1,0,1] op_sel_hi:[1,0,1]
 v_fma_mix_f32 v54, v45, 1.0, v47 op_sel:[0,0,0] op_sel_hi:[1,0,1]
 v_fma_mix_f32 v55, v45, 1.0, v47 op_sel:[1,0,1] op_sel_hi:[1,0,1]
 v_add_f32_dpp v56, v52, v52 row_ror:8 row_mask:0xf bank_mask:0xf
 v_add_f32_dpp v57, v53, v53 row_ror:8 row_mask:0xf bank_mask:0xf
 v_add_f32_dpp v58, v54, v54 row_ror:8 row_mask:0xf bank_mask:0xf
 v_add_f32_dpp v59, v55, v55 row_ror:8 row_mask:0xf bank_mask:0xf
 v_cvt_pk_bf16_f32 v120, v56, v57
 v_cvt_pk_bf16_f32 v121, v58, v59
 s_waitcnt lgkmcnt(0)
 v_fma_mix_f32 v52, v48, 1.0, v50 op_sel:[0,0,0] op_sel_hi:[1,0,1]
 v_fma_mix_f32 v53, v48, 1.0, v50 op_sel:[1,0,1] op_sel_hi:[1,0,1]
 v_fma_mix_f32 v54, v49, 1.0, v51 op_sel:[0,0,0] op_sel_hi:[1,0,1]
 v_fma_mix_f32 v55, v49, 1.0, v51 op_sel:[1,0,1] op_sel_hi:[1,0,1]
 v_mfma_f32_16x16x32_bf16 v[40:43], v[112:115], v[118:121], 0
 v_add_f32_dpp v56, v52, v52 row_ror:8 row_mask:0xf bank_mask:0xf
 v_add_f32_dpp v57, v53, v53 row_ror:8 row_mask:0xf bank_mask:0xf
 v_add_f32_dpp v58, v54, v54 row_ror:8 row_mask:0xf bank_mask:0xf
 v_add_f32_dpp v59, v55, v55 row_ror:8 row_mask:0xf bank_mask:0xf
 v_cvt_pk_bf16_f32 v122, v56, v57
 v_cvt_pk_bf16_f32 v123, v58, v59
 s_nop 1
 v_mfma_f32_16x16x32_bf16 v[40:43], v[116:119], v[122:125], v[40:43]
 ds_read_b128 v[28:31], v16 offset:24576
 ds_read_b128 v[32:35], v16 offset:25600
 ds_read_b128 v[64:67], v16 offset:27648
 ds_read_b128 v[68:71], v16 offset:28672
 ds_read_b128 v[72:75], v16 offset:30720
 ds_read_b128 v[76:79], v16 offset:31744
 s_nop 0
 s_mov_b64 exec, s[74:75]
 v_cvt_pk_f16_f32 v44, v40, v41
 v_cvt_pk_f16_f32 v45, v42, v43
 v_and_or_b32 v44, v44, -2, s88
 buffer_store_dwordx2 v[44:45], v7, s[8:11], s81 offen
 s_mov_b64 exec, -1
 ds_read_b128 v[80:83], v16 offset:33792
 ds_read_b128 v[84:87], v16 offset:34816
 ds_read_b64 v[88:89], v16 offset:26624
 ds_read_b64 v[90:91], v16 offset:29696
 ds_read_b64 v[92:93], v16 offset:32768
 ds_read_b64 v[94:95], v16 offset:35840
 s_cmp_eq_u32 s52, 63
 s_cbranch_scc1 last_35
 s_waitcnt lgkmcnt(10)
 v_smfmac_f32_16x16x64_f16 v[100:103], v[28:31], a[120:127], v25
 v_smfmac_f32_16x16x64_f16 v[104:107], v[28:31], a[128:135], v25
 v_smfmac_f32_16x16x64_f16 v[108:111], v[28:31], a[136:143], v25
 s_mov_b32 s54, 0
 v_smfmac_f32_16x16x64_f16 v[100:103], v[32:35], a[144:151], v25
 v_readfirstlane_b32 s21, v0
 v_smfmac_f32_16x16x64_f16 v[104:107], v[32:35], a[152:159], v25
 s_add_u32 s22, s46, 3
 v_smfmac_f32_16x16x64_f16 v[108:111], v[32:35], a[160:167], v25
 s_min_u32 s22, s22, 64
 s_waitcnt lgkmcnt(7)
 v_smfmac_f32_16x16x64_f16 v[100:103], v[64:67], a[168:175], v25
 s_sub_u32 s55, s21, s22
 v_smfmac_f32_16x16x64_f16 v[104:107], v[64:67], a[176:183], v25
 s_sub_u32 s56, s21, s46
 v_smfmac_f32_16x16x64_f16 v[108:111], v[64:67], a[184:191], v25
 v_smfmac_f32_16x16x64_f16 v[100:103], v[68:71], a[192:199], v25
 v_smfmac_f32_16x16x64_f16 v[104:107], v[68:71], a[200:207], v25
 v_smfmac_f32_16x16x64_f16 v[108:111], v[68:71], a[208:215], v25
 v_smfmac_f32_16x16x64_f16 v[100:103], v[72:75], a[216:223], v25
 v_smfmac_f32_16x16x64_f16 v[104:107], v[72:75], a[224:231], v25
 v_smfmac_f32_16x16x64_f16 v[108:111], v[72:75], a[232:239], v25
 s_waitcnt lgkmcnt(4)
 v_smfmac_f32_16x16x64_f16 v[100:103], v[76:79], a[240:247], v25
 v_smfmac_f32_16x16x64_f16 v[104:107], v[76:79], a[248:255], v25
 v_smfmac_f32_16x16x64_f16 v[108:111], v[76:79], v[152:159], v25
 v_smfmac_f32_16x16x64_f16 v[100:103], v[80:83], v[160:167], v25
 v_smfmac_f32_16x16x64_f16 v[104:107], v[80:83], v[168:175], v25
 buffer_load_dwordx2 v[58:59], v9, s[8:11], s81 offen sc1
 buffer_load_dwordx4 v[40:43], v8, s[8:11], s81 offen offset:0 sc1
 buffer_load_dwordx4 v[44:47], v8, s[8:11], s81 offen offset:1024 sc1
 v_smfmac_f32_16x16x64_f16 v[108:111], v[80:83], v[176:183], v25
 v_smfmac_f32_16x16x64_f16 v[100:103], v[84:87], v[184:191], v25
 v_smfmac_f32_16x16x64_f16 v[104:107], v[84:87], v[192:199], v25
 v_smfmac_f32_16x16x64_f16 v[108:111], v[84:87], v[200:207], v25
 s_waitcnt lgkmcnt(0)
 v_smfmac_f32_16x16x64_f16 v[100:103], v[88:91], v[208:215], v25
 v_smfmac_f32_16x16x64_f16 v[104:107], v[88:91], v[216:223], v25
 v_smfmac_f32_16x16x64_f16 v[108:111], v[88:91], v[224:231], v25
 v_smfmac_f32_16x16x64_f16 v[100:103], v[92:95], v[232:239], v25
 v_smfmac_f32_16x16x64_f16 v[104:107], v[92:95], v[240:247], v25
 v_smfmac_f32_16x16x64_f16 v[108:111], v[92:95], v[248:255], v25
 s_cmp_lt_i32 s56, 0
 s_cbranch_scc1 kvw_43
kvok_44:
 s_waitcnt vmcnt(2)
 v_xor_b32 v76, s88, v58
 s_nop 0
 v_permlane16_swap_b32 v58, v59
 v_fma_mix_f32 v60, v58, 1.0, v59 op_sel:[0,0,0] op_sel_hi:[1,0,1]
 v_fma_mix_f32 v61, v58, 1.0, v59 op_sel:[1,0,1] op_sel_hi:[1,0,1]
 v_mov_b32 v58, v60
 v_mov_b32 v59, v61
 s_nop 0
 v_permlane32_swap_b32 v58, v60
 v_permlane32_swap_b32 v59, v61
 v_add_f32 v52, v58, v60
 v_add_f32 v53, v59, v61
 v_max_f32 v79, v52, v53
 s_waitcnt vmcnt(0)
 v_pk_add_f16 v80, v40, v44
 v_pk_add_f16 v82, v42, v46
 v_pk_add_f16 v81, v41, v45
 v_pk_add_f16 v83, v43, v47
 v_permlane32_swap_b32 v80, v82
 v_bitop3_b32 v77, v40, v42, s88 bitop3:0x7e
 v_permlane32_swap_b32 v81, v83
 v_bitop3_b32 v78, v44, v46, s88 bitop3:0x7e
 v_fma_mix_f32 v48, v80, 1.0, v82 op_sel:[0,0,0] op_sel_hi:[1,0,1]
 v_or3_b32 v27, v76, v77, v78
 v_fma_mix_f32 v49, v80, 1.0, v82 op_sel:[1,0,1] op_sel_hi:[1,0,1]
 v_and_b32 v27, 1, v27
 v_fma_mix_f32 v50, v81, 1.0, v83 op_sel:[0,0,0] op_sel_hi:[1,0,1]
 v_cmp_ne_u32 vcc, 0, v27
 v_fma_mix_f32 v51, v81, 1.0, v83 op_sel:[1,0,1] op_sel_hi:[1,0,1]
 v_max3_f32 v62, v48, v49, v79
 s_cbranch_vccnz psr_41
psj_42:
 v_max3_f32 v62, v62, v50, v51
 v_cvt_pk_bf16_f32 v146, v100, v101
 v_cvt_pk_bf16_f32 v147, v102, v103
 v_max_f32_dpp v62, v62, v62 row_ror:8 row_mask:0xf bank_mask:0xf
 v_mov_b32 v63, v62
 v_cvt_pk_bf16_f32 v148, v104, v105
 v_cvt_pk_bf16_f32 v149, v106, v107
 v_permlane32_swap_b32 v62, v63
 v_max_f32 v62, v62, v63
 v_mov_b32 v63, v62
 v_cvt_pk_bf16_f32 v150, v108, v109
 v_cvt_pk_bf16_f32 v151, v110, v111
 v_permlane16_swap_b32 v62, v63
 v_max_f32 v62, v62, v63
 v_mul_f32 v62, s86, v62
 v_fma_f32 v48, v48, s86, -v62
 v_fma_f32 v49, v49, s86, -v62
 v_fma_f32 v50, v50, s86, -v62
 v_fma_f32 v51, v51, s86, -v62
 v_fma_f32 v52, v52, s86, -v62
 v_fma_f32 v53, v53, s86, -v62
 v_exp_f32 v48, v48
 v_exp_f32 v49, v49
 buffer_load_dwordx4 v[88:91], v17, s[28:31], s64 offen offset:0 sc1
 v_exp_f32 v50, v50
 v_exp_f32 v51, v51
 buffer_load_dwordx4 v[92:95], v16, s[28:31], s64 offen offset:1024 sc1
 v_exp_f32 v52, v52
 v_exp_f32 v53, v53
 buffer_load_dwordx4 v[96:99], v20, s[28:31], s64 offen offset:2048 sc1
 v_cvt_pk_bf16_f32 v138, v48, v49
 v_cvt_pk_bf16_f32 v139, v50, v51
 v_cvt_pk_bf16_f32 v142, v52, v53
 v_mov_b32_dpp v140, v138 row_ror:8 row_mask:0xf bank_mask:0xf
 v_mov_b32_dpp v141, v139 row_ror:8 row_mask:0xf bank_mask:0xf
 v_mov_b32_dpp v143, v142 row_ror:8 row_mask:0xf bank_mask:0xf
 buffer_load_dwordx4 v[112:115], v18, s[16:19], s80 offen sc1
 v_add_f32 v54, v48, v49
 v_mfma_f32_16x16x32_bf16 v[64:67], v[126:129], v[138:141], 0
 v_add_f32 v55, v50, v51
 v_add_f32 v56, v52, v53
 v_mfma_f32_16x16x32_bf16 v[64:67], v[146:149], v[142:145], v[64:67]
 v_add_f32 v62, v54, v55
 v_fmac_f32 v62, v56, v26
 v_mfma_f32_16x16x32_bf16 v[68:71], v[130:133], v[138:141], 0
 buffer_load_dwordx2 v[116:117], v19, s[16:19], s80 offen sc1
 v_add_f32_dpp v62, v62, v62 row_ror:8 row_mask:0xf bank_mask:0xf
 v_mfma_f32_16x16x32_bf16 v[68:71], v[148:151], v[142:145], v[68:71]
 v_mov_b32 v63, v62
 s_cmp_lt_i32 s55, 0
 s_cbranch_scc1 fl_45
fl_46:
 v_mfma_f32_16x16x32_bf16 v[72:75], v[134:137], v[138:141], 0
 v_permlane32_swap_b32 v62, v63
 v_mfma_f32_16x16x32_bf16 v[72:75], v[150:153], v[142:145], v[72:75]
 v_add_f32 v62, v62, v63
 v_mov_b32 v63, v62
 ds_write_b128 v11, v[64:67] offset:0
 s_nop 0
 v_permlane16_swap_b32 v62, v63
 v_add_f32 v62, v62, v63
 v_rcp_f32 v62, v62
 ds_write_b128 v11, v[68:71] offset:1024
 s_mov_b64 exec, 0xff
 ds_write_b32 v22, v62
 s_mov_b64 exec, -1
 ds_write_b128 v11, v[72:75] offset:2048
 s_waitcnt lgkmcnt(0)
 s_barrier
 ds_read_b128 v[72:75], v23
 ds_read_b64 v[64:65], v12 offset:0
 ds_read_b64 v[66:67], v12 offset:3072
 ds_read_b64 v[68:69], v12 offset:6144
 ds_read_b64 v[70:71], v12 offset:9216
 s_waitcnt lgkmcnt(2)
 v_pk_mul_f32 v[64:65], v[64:65], v[72:73] op_sel_hi:[1,0]
 v_pk_fma_f32 v[64:65], v[66:67], v[72:73], v[64:65] op_sel:[0,1,0] op_sel_hi:[1,1,1]
 s_waitcnt lgkmcnt(0)
 v_pk_fma_f32 v[64:65], v[68:69], v[74:75], v[64:65] op_sel_hi:[1,0,1]
 v_pk_fma_f32 v[64:65], v[70:71], v[74:75], v[64:65] op_sel:[0,1,0] op_sel_hi:[1,1,1]
 v_cvt_pk_f16_f32 v68, v64, v65
 v_perm_b32 v68, s91, v68, v14
 buffer_atomic_pk_add_f16 v68, v13, s[4:7], s3 offen
 v_mov_b32 v76, v108
 v_mov_b32 v77, v109
 v_mov_b32 v78, v110
 v_mov_b32 v79, v111
 v_permlane32_swap_b32 v100, v104
 v_permlane32_swap_b32 v101, v105
 v_permlane32_swap_b32 v102, v106
 v_permlane32_swap_b32 v103, v107
 v_permlane32_swap_b32 v108, v76
 v_permlane32_swap_b32 v109, v77
 v_permlane32_swap_b32 v110, v78
 v_permlane32_swap_b32 v111, v79
 v_pk_add_f32 v[100:101], v[100:101], v[104:105]
 v_pk_add_f32 v[102:103], v[102:103], v[106:107]
 v_pk_add_f32 v[108:109], v[108:109], v[76:77]
 v_pk_add_f32 v[110:111], v[110:111], v[78:79]
 v_cvt_pk_bf16_f32 v80, v100, v101
 v_cvt_pk_bf16_f32 v82, v108, v109
 v_cvt_pk_bf16_f32 v81, v102, v103
 v_cvt_pk_bf16_f32 v83, v110, v111
 s_nop 0
 v_permlane16_swap_b32 v80, v82
 v_permlane16_swap_b32 v81, v83
 v_min_u32 v80, -2, v80
 s_mov_b64 exec, s[76:77]
 buffer_store_dwordx4 v[80:83], v15, s[24:27], s57 offen sc1
 s_mov_b64 exec, -1
 s_add_u32 s64, s64, 1310720
 s_add_u32 s52, s52, 1
 s_branch step_34
fl_39:
 buffer_load_dword v0, off, s[12:15], s79 sc1
 s_branch fl_40
A1_14:
 v_smfmac_f32_16x16x32_f16 v[40:43], v[36:37], a[16:19], v25
 v_smfmac_f32_16x16x32_f16 v[52:55], v[36:37], a[76:79], v25
 v_smfmac_f32_16x16x32_f16 v[44:47], v[36:37], a[36:39], v25
 v_smfmac_f32_16x16x32_f16 v[56:59], v[36:37], a[96:99], v25
 s_branch A2_38
pm_37:
 buffer_load_dwordx4 v[36:39], v4, s[4:7], s84 offen offset:2048 sc1
 buffer_load_dwordx4 v[28:31], v4, s[4:7], s84 offen offset:0 sc1
 buffer_load_dwordx4 v[32:35], v4, s[4:7], s84 offen offset:1024 sc1
 s_nop 7
 v_mov_b32 v40, 0
 v_mov_b32 v41, 0
 v_mov_b32 v42, 0
 v_mov_b32 v43, 0
 v_mov_b32 v52, 0
 v_mov_b32 v53, 0
 v_mov_b32 v54, 0
 v_mov_b32 v55, 0
 v_mov_b32 v44, 0
 v_mov_b32 v45, 0
 v_mov_b32 v46, 0
 v_mov_b32 v47, 0
 v_mov_b32 v56, 0
 v_mov_b32 v57, 0
 v_mov_b32 v58, 0
 v_mov_b32 v59, 0
 s_waitcnt vmcnt(0)
 v_bitop3_b32 v27, v31, v35, v39 bitop3:0x80
 v_perm_b32 v31, v35, v31, s89
 v_cmp_gt_u32 vcc, 0x48000000, v27
 v_mov_b32 v35, v38
 s_cbranch_vccz A1_14
pm_36:
 s_cmp_gt_u32 s52, 3
 s_cbranch_scc1 op_47
 v_readfirstlane_b32 s21, v0
 s_cmp_ge_u32 s21, s46
 s_cbranch_scc1 op_47
 buffer_load_dword v0, off, s[12:15], s79 sc1
 s_waitcnt vmcnt(0)
 v_readfirstlane_b32 s21, v0
 s_cmp_gt_u32 s21, s52
 s_cselect_b32 s21, s87, 0
 s_cmp_eq_u32 s21, 0
 s_cbranch_scc1 op_47
 s_mov_b32 s87, 0
 s_sub_u32 s21, s64, 1310720
 buffer_load_dwordx4 v[126:129], v16, s[28:31], s21 offen offset:0 sc1
 buffer_load_dwordx4 v[130:133], v16, s[28:31], s21 offen offset:1024 sc1
 buffer_load_dwordx4 v[134:137], v16, s[28:31], s21 offen offset:2048 sc1
op_47:
 buffer_load_dwordx4 v[36:39], v4, s[4:7], s84 offen offset:2048 sc1
 buffer_load_dwordx4 v[28:31], v4, s[4:7], s84 offen offset:0 sc1
 buffer_load_dwordx4 v[32:35], v4, s[4:7], s84 offen offset:1024 sc1
 s_add_u32 s54, s54, 1
 s_cmp_gt_u32 s54, 131072
 s_cbranch_scc1 end0
 s_waitcnt vmcnt(0)
 v_bitop3_b32 v27, v31, v35, v39 bitop3:0x80
 v_perm_b32 v31, v35, v31, s89
 v_cmp_gt_u32 vcc, 0x48000000, v27
 v_mov_b32 v35, v38
 s_cbranch_vccnz pm_36
 s_branch A1_14
psr_41:
 buffer_load_dwordx2 v[58:59], v9, s[8:11], s81 offen sc1
 buffer_load_dwordx4 v[40:43], v8, s[8:11], s81 offen offset:0 sc1
 buffer_load_dwordx4 v[44:47], v8, s[8:11], s81 offen offset:1024 sc1
 s_add_u32 s54, s54, 1
 s_cmp_gt_u32 s54, 131072
 s_cbranch_scc1 end0
 s_waitcnt vmcnt(2)
 v_xor_b32 v76, s88, v58
 s_nop 0
 v_permlane16_swap_b32 v58, v59
 v_fma_mix_f32 v60, v58, 1.0, v59 op_sel:[0,0,0] op_sel_hi:[1,0,1]
 v_fma_mix_f32 v61, v58, 1.0, v59 op_sel:[1,0,1] op_sel_hi:[1,0,1]
 v_mov_b32 v58, v60
 v_mov_b32 v59, v61
 s_nop 0
 v_permlane32_swap_b32 v58, v60
 v_permlane32_swap_b32 v59, v61
 v_add_f32 v52, v58, v60
 v_add_f32 v53, v59, v61
 v_max_f32 v79, v52, v53
 s_waitcnt vmcnt(0)
 v_pk_add_f16 v80, v40, v44
 v_pk_add_f16 v82, v42, v46
 v_pk_add_f16 v81, v41, v45
 v_pk_add_f16 v83, v43, v47
 v_permlane32_swap_b32 v80, v82
 v_bitop3_b32 v77, v40, v42, s88 bitop3:0x7e
 v_permlane32_swap_b32 v81, v83
 v_bitop3_b32 v78, v44, v46, s88 bitop3:0x7e
 v_fma_mix_f32 v48, v80, 1.0, v82 op_sel:[0,0,0] op_sel_hi:[1,0,1]
 v_or3_b32 v27, v76, v77, v78
 v_fma_mix_f32 v49, v80, 1.0, v82 op_sel:[1,0,1] op_sel_hi:[1,0,1]
 v_and_b32 v27, 1, v27
 v_fma_mix_f32 v50, v81, 1.0, v83 op_sel:[0,0,0] op_sel_hi:[1,0,1]
 v_cmp_ne_u32 vcc, 0, v27
 v_fma_mix_f32 v51, v81, 1.0, v83 op_sel:[1,0,1] op_sel_hi:[1,0,1]
 v_max3_f32 v62, v48, v49, v79
 s_cbranch_vccnz psr_41
 s_branch psj_42
kvw_43:
 s_mov_b32 s22, s87
 s_cmp_eq_u32 s52, 0
 s_cselect_b32 s55, 0, s55
 s_cselect_b32 s87, 1, 0
 s_cbranch_scc1 kvok_44
 v_mov_b32 v62, 0
 s_mov_b32 s101, 0
wf_48:
 buffer_load_dword v63, v62, s[12:15], s79 offen sc1
 s_add_u32 s101, s101, 1
 s_cmp_gt_u32 s101, 131072
 s_cbranch_scc1 end0
 s_waitcnt vmcnt(0)
 v_readfirstlane_b32 s100, v63
 s_cmp_ge_u32 s100, s46
 s_cbranch_scc1 wf_49
 s_sleep 3
 s_branch wf_48
wf_49:
 s_cmp_eq_u32 s22, 0
 s_cbranch_scc1 kvok_44
 s_sub_u32 s21, s64, 1310720
 buffer_load_dwordx4 v[126:129], v16, s[28:31], s21 offen offset:0 sc1
 buffer_load_dwordx4 v[130:133], v16, s[28:31], s21 offen offset:1024 sc1
 buffer_load_dwordx4 v[134:137], v16, s[28:31], s21 offen offset:2048 sc1
 s_waitcnt vmcnt(0)
 s_branch kvok_44
fl_45:
 buffer_load_dword v0, off, s[12:15], s79 sc1
 s_branch fl_46
last_35:
 s_waitcnt lgkmcnt(10)
 v_smfmac_f32_16x16x64_f16 v[100:103], v[28:31], a[120:127], v25
 v_smfmac_f32_16x16x64_f16 v[104:107], v[28:31], a[128:135], v25
 v_smfmac_f32_16x16x64_f16 v[108:111], v[28:31], a[136:143], v25
 v_smfmac_f32_16x16x64_f16 v[100:103], v[32:35], a[144:151], v25
 v_smfmac_f32_16x16x64_f16 v[104:107], v[32:35], a[152:159], v25
 v_smfmac_f32_16x16x64_f16 v[108:111], v[32:35], a[160:167], v25
 s_waitcnt lgkmcnt(7)
 v_smfmac_f32_16x16x64_f16 v[100:103], v[64:67], a[168:175], v25
 v_smfmac_f32_16x16x64_f16 v[104:107], v[64:67], a[176:183], v25
 v_smfmac_f32_16x16x64_f16 v[108:111], v[64:67], a[184:191], v25
 v_smfmac_f32_16x16x64_f16 v[100:103], v[68:71], a[192:199], v25
 v_smfmac_f32_16x16x64_f16 v[104:107], v[68:71], a[200:207], v25
 v_smfmac_f32_16x16x64_f16 v[108:111], v[68:71], a[208:215], v25
 v_smfmac_f32_16x16x64_f16 v[100:103], v[72:75], a[216:223], v25
 v_smfmac_f32_16x16x64_f16 v[104:107], v[72:75], a[224:231], v25
 v_smfmac_f32_16x16x64_f16 v[108:111], v[72:75], a[232:239], v25
 s_waitcnt lgkmcnt(4)
 v_smfmac_f32_16x16x64_f16 v[100:103], v[76:79], a[240:247], v25
 v_smfmac_f32_16x16x64_f16 v[104:107], v[76:79], a[248:255], v25
 v_smfmac_f32_16x16x64_f16 v[108:111], v[76:79], v[152:159], v25
 v_smfmac_f32_16x16x64_f16 v[100:103], v[80:83], v[160:167], v25
 v_smfmac_f32_16x16x64_f16 v[104:107], v[80:83], v[168:175], v25
 v_smfmac_f32_16x16x64_f16 v[108:111], v[80:83], v[176:183], v25
 v_smfmac_f32_16x16x64_f16 v[100:103], v[84:87], v[184:191], v25
 v_smfmac_f32_16x16x64_f16 v[104:107], v[84:87], v[192:199], v25
 v_smfmac_f32_16x16x64_f16 v[108:111], v[84:87], v[200:207], v25
 s_waitcnt lgkmcnt(0)
 v_smfmac_f32_16x16x64_f16 v[100:103], v[88:91], v[208:215], v25
 v_smfmac_f32_16x16x64_f16 v[104:107], v[88:91], v[216:223], v25
 v_smfmac_f32_16x16x64_f16 v[108:111], v[88:91], v[224:231], v25
 v_smfmac_f32_16x16x64_f16 v[100:103], v[92:95], v[232:239], v25
 v_smfmac_f32_16x16x64_f16 v[104:107], v[92:95], v[240:247], v25
 v_smfmac_f32_16x16x64_f16 v[108:111], v[92:95], v[248:255], v25
 s_nop 7
 v_mov_b32 v76, v108
 v_mov_b32 v77, v109
 v_mov_b32 v78, v110
 v_mov_b32 v79, v111
 v_permlane32_swap_b32 v100, v104
 v_permlane32_swap_b32 v101, v105
 v_permlane32_swap_b32 v102, v106
 v_permlane32_swap_b32 v103, v107
 v_permlane32_swap_b32 v108, v76
 v_permlane32_swap_b32 v109, v77
 v_permlane32_swap_b32 v110, v78
 v_permlane32_swap_b32 v111, v79
 v_pk_add_f32 v[100:101], v[100:101], v[104:105]
 v_pk_add_f32 v[102:103], v[102:103], v[106:107]
 v_pk_add_f32 v[108:109], v[108:109], v[76:77]
 v_pk_add_f32 v[110:111], v[110:111], v[78:79]
 v_cvt_pk_bf16_f32 v80, v100, v101
 v_cvt_pk_bf16_f32 v82, v108, v109
 v_cvt_pk_bf16_f32 v81, v102, v103
 v_cvt_pk_bf16_f32 v83, v110, v111
 s_nop 0
 v_permlane16_swap_b32 v80, v82
 v_permlane16_swap_b32 v81, v83
 v_min_u32 v80, -2, v80
 s_mov_b64 exec, s[76:77]
 buffer_store_dwordx4 v[80:83], v15, s[24:27], s57 offen sc1
 s_mov_b64 exec, -1
 s_branch chain_done
step_50:
 s_and_b32 s21, s52, 3
 s_mul_i32 s81, s21, 540672
 s_lshl_b32 s84, s21, 15
 s_add_u32 s21, s52, 3
 s_and_b32 s21, s21, 3
 s_lshl_b32 s83, s21, 15
 s_add_u32 s21, s52, 1
 s_and_b32 s22, s21, 3
 s_lshl_b32 s3, s22, 15
 s_mul_i32 s80, s21, 393216
 s_add_u32 s46, s21, 1
 s_min_u32 s46, s46, 64
 s_mov_b32 s47, s57
 s_lshl_b32 s21, s52, 12
 s_and_b32 s21, s21, 8192
 s_xor_b32 s21, s21, s37
 s_lshl_b32 s22, s52, 20
 s_or_b32 s22, s22, s21
 s_cmp_ge_u32 s52, 36
 s_cselect_b32 s57, 8192, 0
 s_xor_b32 s57, s57, s22
 s_xor_b32 s85, s22, 8192
 s_bfe_u32 s88, s52, 0x10002
 s_max_u32 s67, s52, 1
 s_sub_u32 s67, s67, 1
 v_mov_b32 v40, 0
 v_mov_b32 v41, 0
 v_mov_b32 v42, 0
 v_mov_b32 v43, 0
 v_mov_b32 v44, 0
 v_mov_b32 v45, 0
 v_mov_b32 v46, 0
 v_mov_b32 v47, 0
 v_mov_b32 v48, 0
 v_mov_b32 v49, 0
 v_mov_b32 v50, 0
 v_mov_b32 v51, 0
 v_mov_b32 v52, 0
 v_mov_b32 v53, 0
 v_mov_b32 v54, 0
 v_mov_b32 v55, 0
 v_mov_b32 v56, 0
 v_mov_b32 v57, 0
 v_mov_b32 v58, 0
 v_mov_b32 v59, 0
 v_mov_b32 v60, 0
 v_mov_b32 v61, 0
 v_mov_b32 v62, 0
 v_mov_b32 v63, 0
 v_mov_b32 v100, 0
 v_mov_b32 v101, 0
 v_mov_b32 v102, 0
 v_mov_b32 v103, 0
 v_mov_b32 v104, 0
 v_mov_b32 v105, 0
 v_mov_b32 v106, 0
 v_mov_b32 v107, 0
 v_mov_b32 v108, 0
 v_mov_b32 v109, 0
 v_mov_b32 v110, 0
 v_mov_b32 v111, 0
 s_sleep 4
 s_nop 3
 v_readfirstlane_b32 s21, v0
 s_cmp_lt_u32 s21, s46
 s_cselect_b32 s55, s55, 0
 s_cmp_lt_i32 s55, 0
 s_cbranch_scc1 fl_55
fl_56:
 s_mov_b32 s54, 0
 buffer_load_dwordx4 v[36:39], v4, s[4:7], s84 offen offset:2048 sc1
 buffer_load_dwordx4 v[28:31], v4, s[4:7], s84 offen offset:0 sc1
 buffer_load_dwordx4 v[32:35], v4, s[4:7], s84 offen offset:1024 sc1
 s_waitcnt vmcnt(3)
 v_mov_b32 v126, v88
 v_mov_b32 v127, v89
 v_mov_b32 v128, v90
 v_mov_b32 v129, v91
 v_mov_b32 v130, v92
 v_mov_b32 v131, v93
 v_mov_b32 v132, v94
 v_mov_b32 v133, v95
 v_mov_b32 v134, v96
 v_mov_b32 v135, v97
 v_mov_b32 v136, v98
 v_mov_b32 v137, v99
 s_waitcnt vmcnt(2)
 v_smfmac_f32_16x16x32_f16 v[40:43], v[36:37], a[16:19], v25
 v_smfmac_f32_16x16x32_f16 v[52:55], v[36:37], a[76:79], v25
 v_smfmac_f32_16x16x32_f16 v[44:47], v[36:37], a[36:39], v25
 s_waitcnt vmcnt(0)
 v_bitop3_b32 v27, v31, v35, v39 bitop3:0x80
 v_perm_b32 v31, v35, v31, s89
 v_cmp_gt_u32 vcc, 0x48000000, v27
 v_mov_b32 v35, v38
 v_smfmac_f32_16x16x32_f16 v[56:59], v[36:37], a[96:99], v25
 s_cbranch_vccnz pm_53
A2_54:
 v_smfmac_f32_16x16x64_f16 v[40:43], v[28:31], a[0:7], v25
 ds_write_b128 v10, v[28:31]
 v_smfmac_f32_16x16x64_f16 v[40:43], v[32:35], a[8:15], v25
 ds_write_b128 v10, v[32:35] offset:1024
 v_smfmac_f32_16x16x64_f16 v[52:55], v[28:31], a[60:67], v25
 ds_write_b64 v10, v[36:37] offset:2048
 v_smfmac_f32_16x16x64_f16 v[52:55], v[32:35], a[68:75], v25
 v_cvt_pk_f16_f32 v40, v40, v41
 v_cvt_pk_f16_f32 v41, v42, v43
 v_smfmac_f32_16x16x32_f16 v[48:51], v[36:37], a[56:59], v25
 v_smfmac_f32_16x16x32_f16 v[60:63], v[36:37], a[116:119], v25
 v_smfmac_f32_16x16x64_f16 v[44:47], v[28:31], a[20:27], v25
 v_cvt_pk_f16_f32 v52, v52, v53
 v_cvt_pk_f16_f32 v53, v54, v55
 s_nop 0
 v_smfmac_f32_16x16x64_f16 v[44:47], v[32:35], a[28:35], v25
 v_permlane32_swap_b32 v40, v52
 v_smfmac_f32_16x16x64_f16 v[56:59], v[28:31], a[80:87], v25
 v_permlane32_swap_b32 v41, v53
 v_pk_add_f16 v40, v40, v52
 v_smfmac_f32_16x16x64_f16 v[56:59], v[32:35], a[88:95], v25
 v_pk_add_f16 v41, v41, v53
 v_smfmac_f32_16x16x64_f16 v[48:51], v[28:31], a[40:47], v25
 ds_write_b64 v5, v[40:41] offset:0
 v_smfmac_f32_16x16x64_f16 v[48:51], v[32:35], a[48:55], v25
 v_cvt_pk_f16_f32 v44, v44, v45
 v_cvt_pk_f16_f32 v45, v46, v47
 v_cvt_pk_f16_f32 v56, v56, v57
 v_smfmac_f32_16x16x64_f16 v[60:63], v[28:31], a[100:107], v25
 v_cvt_pk_f16_f32 v57, v58, v59
 s_nop 0
 v_smfmac_f32_16x16x64_f16 v[60:63], v[32:35], a[108:115], v25
 v_permlane32_swap_b32 v44, v56
 v_permlane32_swap_b32 v45, v57
 v_pk_add_f16 v44, v44, v56
 v_pk_add_f16 v45, v45, v57
 ds_write_b64 v5, v[44:45] offset:640
 v_cvt_pk_f16_f32 v48, v48, v49
 v_cvt_pk_f16_f32 v49, v50, v51
 v_cvt_pk_f16_f32 v60, v60, v61
 v_cvt_pk_f16_f32 v61, v62, v63
 s_nop 0
 v_permlane32_swap_b32 v48, v60
 v_permlane32_swap_b32 v49, v61
 v_pk_add_f16 v48, v48, v60
 v_pk_add_f16 v49, v49, v61
 ds_write_b64 v5, v[48:49] offset:1280
 s_waitcnt lgkmcnt(0) vmcnt(0)
 s_barrier
 ds_read_b64_tr_b16 v[40:41], v6 offset:0
 ds_read_b64_tr_b16 v[42:43], v6 offset:1920
 ds_read_b64_tr_b16 v[44:45], v6 offset:3840
 ds_read_b64_tr_b16 v[46:47], v6 offset:5760
 ds_read_b64_tr_b16 v[48:49], v6 offset:640
 ds_read_b64_tr_b16 v[50:51], v6 offset:2560
 ds_read_b64_tr_b16 v[52:53], v6 offset:4480
 ds_read_b64_tr_b16 v[54:55], v6 offset:6400
 ds_read_b64_tr_b16 v[56:57], v6 offset:1280
 ds_read_b64_tr_b16 v[58:59], v6 offset:3200
 ds_read_b64_tr_b16 v[60:61], v6 offset:5120
 ds_read_b64_tr_b16 v[62:63], v6 offset:7040
 s_waitcnt lgkmcnt(8)
 v_pk_add_f16 v40, v40, v42
 v_pk_add_f16 v44, v44, v46
 v_pk_add_f16 v41, v41, v43
 v_pk_add_f16 v45, v45, v47
 v_fma_mix_f32 v146, v40, 1.0, v44 op_sel:[0,0,0] op_sel_hi:[1,0,1]
 v_fma_mix_f32 v147, v40, 1.0, v44 op_sel:[1,0,1] op_sel_hi:[1,0,1]
 v_fma_mix_f32 v148, v41, 1.0, v45 op_sel:[0,0,0] op_sel_hi:[1,0,1]
 v_fma_mix_f32 v149, v41, 1.0, v45 op_sel:[1,0,1] op_sel_hi:[1,0,1]
 v_cvt_pk_bf16_f32 v118, v146, v147
 v_cvt_pk_bf16_f32 v119, v148, v149
 s_waitcnt lgkmcnt(4)
 v_pk_add_f16 v48, v48, v50
 v_pk_add_f16 v52, v52, v54
 v_pk_add_f16 v49, v49, v51
 v_pk_add_f16 v53, v53, v55
 v_fma_mix_f32 v146, v48, 1.0, v52 op_sel:[0,0,0] op_sel_hi:[1,0,1]
 v_fma_mix_f32 v147, v48, 1.0, v52 op_sel:[1,0,1] op_sel_hi:[1,0,1]
 v_fma_mix_f32 v148, v49, 1.0, v53 op_sel:[0,0,0] op_sel_hi:[1,0,1]
 v_fma_mix_f32 v149, v49, 1.0, v53 op_sel:[1,0,1] op_sel_hi:[1,0,1]
 v_cvt_pk_bf16_f32 v120, v146, v147
 v_cvt_pk_bf16_f32 v121, v148, v149
 s_waitcnt lgkmcnt(0)
 v_pk_add_f16 v56, v56, v58
 v_pk_add_f16 v60, v60, v62
 v_pk_add_f16 v57, v57, v59
 v_pk_add_f16 v61, v61, v63
 v_fma_mix_f32 v146, v56, 1.0, v60 op_sel:[0,0,0] op_sel_hi:[1,0,1]
 v_fma_mix_f32 v147, v56, 1.0, v60 op_sel:[1,0,1] op_sel_hi:[1,0,1]
 v_mfma_f32_16x16x32_bf16 v[40:43], v[118:121], v[118:121], 0
 v_fma_mix_f32 v148, v57, 1.0, v61 op_sel:[0,0,0] op_sel_hi:[1,0,1]
 v_fma_mix_f32 v149, v57, 1.0, v61 op_sel:[1,0,1] op_sel_hi:[1,0,1]
 v_cvt_pk_bf16_f32 v122, v146, v147
 v_cvt_pk_bf16_f32 v123, v148, v149
 s_nop 1
 v_mfma_f32_16x16x32_bf16 v[40:43], v[122:125], v[122:125], v[40:43]
 ds_read_b128 v[28:31], v16 offset:24576
 ds_read_b128 v[32:35], v16 offset:25600
 ds_read_b128 v[64:67], v16 offset:27648
 ds_read_b128 v[68:71], v16 offset:28672
 ds_read_b128 v[72:75], v16 offset:30720
 ds_read_b128 v[76:79], v16 offset:31744
 s_nop 0
 s_mov_b64 exec, s[74:75]
 v_cvt_pk_f16_f32 v44, v40, v41
 v_cvt_pk_f16_f32 v45, v42, v43
 v_and_or_b32 v44, v44, -2, s88
 buffer_store_dwordx2 v[44:45], v7, s[8:11], s81 offen
 s_mov_b64 exec, -1
 ds_read_b128 v[80:83], v16 offset:33792
 ds_read_b128 v[84:87], v16 offset:34816
 ds_read_b64 v[88:89], v16 offset:26624
 ds_read_b64 v[90:91], v16 offset:29696
 ds_read_b64 v[92:93], v16 offset:32768
 ds_read_b64 v[94:95], v16 offset:35840
 s_cmp_eq_u32 s52, 63
 s_cbranch_scc1 last_51
 s_waitcnt lgkmcnt(10)
 v_smfmac_f32_16x16x64_f16 v[100:103], v[28:31], a[120:127], v25
 v_smfmac_f32_16x16x64_f16 v[104:107], v[28:31], a[128:135], v25
 v_smfmac_f32_16x16x64_f16 v[108:111], v[28:31], a[136:143], v25
 s_mov_b32 s54, 0
 v_smfmac_f32_16x16x64_f16 v[100:103], v[32:35], a[144:151], v25
 v_readfirstlane_b32 s21, v0
 v_smfmac_f32_16x16x64_f16 v[104:107], v[32:35], a[152:159], v25
 s_add_u32 s22, s46, 3
 v_smfmac_f32_16x16x64_f16 v[108:111], v[32:35], a[160:167], v25
 s_min_u32 s22, s22, 64
 s_waitcnt lgkmcnt(7)
 v_smfmac_f32_16x16x64_f16 v[100:103], v[64:67], a[168:175], v25
 s_sub_u32 s55, s21, s22
 v_smfmac_f32_16x16x64_f16 v[104:107], v[64:67], a[176:183], v25
 s_sub_u32 s56, s21, s46
 v_smfmac_f32_16x16x64_f16 v[108:111], v[64:67], a[184:191], v25
 v_smfmac_f32_16x16x64_f16 v[100:103], v[68:71], a[192:199], v25
 v_smfmac_f32_16x16x64_f16 v[104:107], v[68:71], a[200:207], v25
 v_smfmac_f32_16x16x64_f16 v[108:111], v[68:71], a[208:215], v25
 v_smfmac_f32_16x16x64_f16 v[100:103], v[72:75], a[216:223], v25
 v_smfmac_f32_16x16x64_f16 v[104:107], v[72:75], a[224:231], v25
 v_smfmac_f32_16x16x64_f16 v[108:111], v[72:75], a[232:239], v25
 s_waitcnt lgkmcnt(4)
 v_smfmac_f32_16x16x64_f16 v[100:103], v[76:79], a[240:247], v25
 v_smfmac_f32_16x16x64_f16 v[104:107], v[76:79], a[248:255], v25
 v_smfmac_f32_16x16x64_f16 v[108:111], v[76:79], v[152:159], v25
 buffer_load_dwordx2 v[58:59], v9, s[8:11], s81 offen sc1
 buffer_load_dwordx4 v[40:43], v8, s[8:11], s81 offen offset:0 sc1
 buffer_load_dwordx4 v[44:47], v8, s[8:11], s81 offen offset:1024 sc1
 v_smfmac_f32_16x16x64_f16 v[100:103], v[80:83], v[160:167], v25
 v_smfmac_f32_16x16x64_f16 v[104:107], v[80:83], v[168:175], v25
 v_smfmac_f32_16x16x64_f16 v[108:111], v[80:83], v[176:183], v25
 v_smfmac_f32_16x16x64_f16 v[100:103], v[84:87], v[184:191], v25
 v_smfmac_f32_16x16x64_f16 v[104:107], v[84:87], v[192:199], v25
 v_smfmac_f32_16x16x64_f16 v[108:111], v[84:87], v[200:207], v25
 s_waitcnt lgkmcnt(0)
 v_smfmac_f32_16x16x64_f16 v[100:103], v[88:91], v[208:215], v25
 v_smfmac_f32_16x16x64_f16 v[104:107], v[88:91], v[216:223], v25
 v_smfmac_f32_16x16x64_f16 v[108:111], v[88:91], v[224:231], v25
 v_smfmac_f32_16x16x64_f16 v[100:103], v[92:95], v[232:239], v25
 v_smfmac_f32_16x16x64_f16 v[104:107], v[92:95], v[240:247], v25
 v_smfmac_f32_16x16x64_f16 v[108:111], v[92:95], v[248:255], v25
 s_cmp_lt_i32 s56, 0
 s_cbranch_scc1 kvw_59
kvok_60:
 s_waitcnt vmcnt(2)
 v_xor_b32 v76, s88, v58
 s_nop 0
 v_permlane16_swap_b32 v58, v59
 v_fma_mix_f32 v60, v58, 1.0, v59 op_sel:[0,0,0] op_sel_hi:[1,0,1]
 v_fma_mix_f32 v61, v58, 1.0, v59 op_sel:[1,0,1] op_sel_hi:[1,0,1]
 v_mov_b32 v58, v60
 v_mov_b32 v59, v61
 s_nop 0
 v_permlane32_swap_b32 v58, v60
 v_permlane32_swap_b32 v59, v61
 v_add_f32 v52, v58, v60
 v_add_f32 v53, v59, v61
 v_max_f32 v79, v52, v53
 s_waitcnt vmcnt(0)
 v_pk_add_f16 v80, v40, v44
 v_pk_add_f16 v82, v42, v46
 v_pk_add_f16 v81, v41, v45
 v_pk_add_f16 v83, v43, v47
 v_permlane32_swap_b32 v80, v82
 v_bitop3_b32 v77, v40, v42, s88 bitop3:0x7e
 v_permlane32_swap_b32 v81, v83
 v_bitop3_b32 v78, v44, v46, s88 bitop3:0x7e
 v_fma_mix_f32 v48, v80, 1.0, v82 op_sel:[0,0,0] op_sel_hi:[1,0,1]
 v_or3_b32 v27, v76, v77, v78
 v_fma_mix_f32 v49, v80, 1.0, v82 op_sel:[1,0,1] op_sel_hi:[1,0,1]
 v_and_b32 v27, 1, v27
 v_fma_mix_f32 v50, v81, 1.0, v83 op_sel:[0,0,0] op_sel_hi:[1,0,1]
 v_cmp_ne_u32 vcc, 0, v27
 v_fma_mix_f32 v51, v81, 1.0, v83 op_sel:[1,0,1] op_sel_hi:[1,0,1]
 v_max3_f32 v62, v48, v49, v79
 s_cbranch_vccnz psr_57
psj_58:
 v_max3_f32 v62, v62, v50, v51
 v_cvt_pk_bf16_f32 v146, v100, v101
 v_cvt_pk_bf16_f32 v147, v102, v103
 v_max_f32_dpp v62, v62, v62 row_ror:8 row_mask:0xf bank_mask:0xf
 v_mov_b32 v63, v62
 v_cvt_pk_bf16_f32 v148, v104, v105
 v_cvt_pk_bf16_f32 v149, v106, v107
 v_permlane32_swap_b32 v62, v63
 v_max_f32 v62, v62, v63
 v_mov_b32 v63, v62
 v_cvt_pk_bf16_f32 v150, v108, v109
 v_cvt_pk_bf16_f32 v151, v110, v111
 v_permlane16_swap_b32 v62, v63
 v_max_f32 v62, v62, v63
 v_mul_f32 v62, s86, v62
 v_fma_f32 v48, v48, s86, -v62
 v_fma_f32 v49, v49, s86, -v62
 v_fma_f32 v50, v50, s86, -v62
 v_fma_f32 v51, v51, s86, -v62
 v_fma_f32 v52, v52, s86, -v62
 v_fma_f32 v53, v53, s86, -v62
 v_exp_f32 v48, v48
 v_exp_f32 v49, v49
 buffer_load_dwordx4 v[88:91], v17, s[28:31], s64 offen offset:0 sc1
 v_exp_f32 v50, v50
 v_exp_f32 v51, v51
 buffer_load_dwordx4 v[92:95], v16, s[28:31], s64 offen offset:1024 sc1
 v_exp_f32 v52, v52
 v_exp_f32 v53, v53
 buffer_load_dwordx4 v[96:99], v20, s[28:31], s64 offen offset:2048 sc1
 v_cvt_pk_bf16_f32 v138, v48, v49
 v_cvt_pk_bf16_f32 v139, v50, v51
 v_cvt_pk_bf16_f32 v142, v52, v53
 v_mov_b32_dpp v140, v138 row_ror:8 row_mask:0xf bank_mask:0xf
 v_mov_b32_dpp v141, v139 row_ror:8 row_mask:0xf bank_mask:0xf
 v_mov_b32_dpp v143, v142 row_ror:8 row_mask:0xf bank_mask:0xf
 v_add_f32 v54, v48, v49
 v_mfma_f32_16x16x32_bf16 v[64:67], v[126:129], v[138:141], 0
 v_add_f32 v55, v50, v51
 v_add_f32 v56, v52, v53
 v_mfma_f32_16x16x32_bf16 v[64:67], v[146:149], v[142:145], v[64:67]
 v_add_f32 v62, v54, v55
 v_fmac_f32 v62, v56, v26
 v_mfma_f32_16x16x32_bf16 v[68:71], v[130:133], v[138:141], 0
 s_nop 0
 v_add_f32_dpp v62, v62, v62 row_ror:8 row_mask:0xf bank_mask:0xf
 v_mfma_f32_16x16x32_bf16 v[68:71], v[148:151], v[142:145], v[68:71]
 v_mov_b32 v63, v62
 s_cmp_lt_i32 s55, 0
 s_cbranch_scc1 fl_61
fl_62:
 v_mfma_f32_16x16x32_bf16 v[72:75], v[134:137], v[138:141], 0
 v_permlane32_swap_b32 v62, v63
 v_mfma_f32_16x16x32_bf16 v[72:75], v[150:153], v[142:145], v[72:75]
 v_add_f32 v62, v62, v63
 v_mov_b32 v63, v62
 ds_write_b128 v11, v[64:67] offset:0
 s_nop 0
 v_permlane16_swap_b32 v62, v63
 v_add_f32 v62, v62, v63
 v_rcp_f32 v62, v62
 ds_write_b128 v11, v[68:71] offset:1024
 s_mov_b64 exec, 0xff
 ds_write_b32 v22, v62
 s_mov_b64 exec, -1
 ds_write_b128 v11, v[72:75] offset:2048
 s_waitcnt lgkmcnt(0)
 s_barrier
 ds_read_b128 v[72:75], v23
 ds_read_b64 v[64:65], v12 offset:0
 ds_read_b64 v[66:67], v12 offset:3072
 ds_read_b64 v[68:69], v12 offset:6144
 ds_read_b64 v[70:71], v12 offset:9216
 s_waitcnt lgkmcnt(2)
 v_pk_mul_f32 v[64:65], v[64:65], v[72:73] op_sel_hi:[1,0]
 v_pk_fma_f32 v[64:65], v[66:67], v[72:73], v[64:65] op_sel:[0,1,0] op_sel_hi:[1,1,1]
 s_waitcnt lgkmcnt(0)
 v_pk_fma_f32 v[64:65], v[68:69], v[74:75], v[64:65] op_sel_hi:[1,0,1]
 v_pk_fma_f32 v[64:65], v[70:71], v[74:75], v[64:65] op_sel:[0,1,0] op_sel_hi:[1,1,1]
 v_cvt_pk_f16_f32 v68, v64, v65
 v_perm_b32 v68, s91, v68, v14
 buffer_atomic_pk_add_f16 v68, v13, s[4:7], s3 offen
 s_mov_b64 exec, s[62:63]
 buffer_store_dwordx4 v[118:121], v18, s[24:27], s85 offen sc1
 buffer_store_dwordx2 v[122:123], v19, s[24:27], s85 offen sc1
 s_mov_b64 exec, -1
 v_mov_b32 v76, v108
 v_mov_b32 v77, v109
 v_mov_b32 v78, v110
 v_mov_b32 v79, v111
 v_permlane32_swap_b32 v100, v104
 v_permlane32_swap_b32 v101, v105
 v_permlane32_swap_b32 v102, v106
 v_permlane32_swap_b32 v103, v107
 v_permlane32_swap_b32 v108, v76
 v_permlane32_swap_b32 v109, v77
 v_permlane32_swap_b32 v110, v78
 v_permlane32_swap_b32 v111, v79
 v_pk_add_f32 v[100:101], v[100:101], v[104:105]
 v_pk_add_f32 v[102:103], v[102:103], v[106:107]
 v_pk_add_f32 v[108:109], v[108:109], v[76:77]
 v_pk_add_f32 v[110:111], v[110:111], v[78:79]
 v_cvt_pk_bf16_f32 v80, v100, v101
 v_cvt_pk_bf16_f32 v82, v108, v109
 v_cvt_pk_bf16_f32 v81, v102, v103
 v_cvt_pk_bf16_f32 v83, v110, v111
 s_nop 0
 v_permlane16_swap_b32 v80, v82
 v_permlane16_swap_b32 v81, v83
 v_min_u32 v80, -2, v80
 s_mov_b64 exec, s[76:77]
 buffer_store_dwordx4 v[80:83], v15, s[24:27], s57 offen sc1
 s_mov_b64 exec, -1
 s_add_u32 s64, s64, 1310720
 s_add_u32 s52, s52, 1
 s_branch step_50
fl_55:
 buffer_load_dword v0, off, s[12:15], s79 sc1
 s_branch fl_56
A1_15:
 v_smfmac_f32_16x16x32_f16 v[40:43], v[36:37], a[16:19], v25
 v_smfmac_f32_16x16x32_f16 v[52:55], v[36:37], a[76:79], v25
 v_smfmac_f32_16x16x32_f16 v[44:47], v[36:37], a[36:39], v25
 v_smfmac_f32_16x16x32_f16 v[56:59], v[36:37], a[96:99], v25
 s_branch A2_54
pm_53:
 buffer_load_dwordx4 v[36:39], v4, s[4:7], s84 offen offset:2048 sc1
 buffer_load_dwordx4 v[28:31], v4, s[4:7], s84 offen offset:0 sc1
 buffer_load_dwordx4 v[32:35], v4, s[4:7], s84 offen offset:1024 sc1
 s_nop 7
 v_mov_b32 v40, 0
 v_mov_b32 v41, 0
 v_mov_b32 v42, 0
 v_mov_b32 v43, 0
 v_mov_b32 v52, 0
 v_mov_b32 v53, 0
 v_mov_b32 v54, 0
 v_mov_b32 v55, 0
 v_mov_b32 v44, 0
 v_mov_b32 v45, 0
 v_mov_b32 v46, 0
 v_mov_b32 v47, 0
 v_mov_b32 v56, 0
 v_mov_b32 v57, 0
 v_mov_b32 v58, 0
 v_mov_b32 v59, 0
 s_waitcnt vmcnt(0)
 v_bitop3_b32 v27, v31, v35, v39 bitop3:0x80
 v_perm_b32 v31, v35, v31, s89
 v_cmp_gt_u32 vcc, 0x48000000, v27
 v_mov_b32 v35, v38
 s_cbranch_vccz A1_15
pm_52:
 s_cmp_gt_u32 s52, 3
 s_cbranch_scc1 op_63
 v_readfirstlane_b32 s21, v0
 s_cmp_ge_u32 s21, s46
 s_cbranch_scc1 op_63
 buffer_load_dword v0, off, s[12:15], s79 sc1
 s_waitcnt vmcnt(0)
 v_readfirstlane_b32 s21, v0
 s_cmp_gt_u32 s21, s52
 s_cselect_b32 s21, s87, 0
 s_cmp_eq_u32 s21, 0
 s_cbranch_scc1 op_63
 s_mov_b32 s87, 0
 s_sub_u32 s21, s64, 1310720
 buffer_load_dwordx4 v[126:129], v16, s[28:31], s21 offen offset:0 sc1
 buffer_load_dwordx4 v[130:133], v16, s[28:31], s21 offen offset:1024 sc1
 buffer_load_dwordx4 v[134:137], v16, s[28:31], s21 offen offset:2048 sc1
op_63:
 buffer_load_dwordx4 v[36:39], v4, s[4:7], s84 offen offset:2048 sc1
 buffer_load_dwordx4 v[28:31], v4, s[4:7], s84 offen offset:0 sc1
 buffer_load_dwordx4 v[32:35], v4, s[4:7], s84 offen offset:1024 sc1
 s_add_u32 s54, s54, 1
 s_cmp_gt_u32 s54, 131072
 s_cbranch_scc1 end0
 s_waitcnt vmcnt(0)
 v_bitop3_b32 v27, v31, v35, v39 bitop3:0x80
 v_perm_b32 v31, v35, v31, s89
 v_cmp_gt_u32 vcc, 0x48000000, v27
 v_mov_b32 v35, v38
 s_cbranch_vccnz pm_52
 s_branch A1_15
psr_57:
 buffer_load_dwordx2 v[58:59], v9, s[8:11], s81 offen sc1
 buffer_load_dwordx4 v[40:43], v8, s[8:11], s81 offen offset:0 sc1
 buffer_load_dwordx4 v[44:47], v8, s[8:11], s81 offen offset:1024 sc1
 s_add_u32 s54, s54, 1
 s_cmp_gt_u32 s54, 131072
 s_cbranch_scc1 end0
 s_waitcnt vmcnt(2)
 v_xor_b32 v76, s88, v58
 s_nop 0
 v_permlane16_swap_b32 v58, v59
 v_fma_mix_f32 v60, v58, 1.0, v59 op_sel:[0,0,0] op_sel_hi:[1,0,1]
 v_fma_mix_f32 v61, v58, 1.0, v59 op_sel:[1,0,1] op_sel_hi:[1,0,1]
 v_mov_b32 v58, v60
 v_mov_b32 v59, v61
 s_nop 0
 v_permlane32_swap_b32 v58, v60
 v_permlane32_swap_b32 v59, v61
 v_add_f32 v52, v58, v60
 v_add_f32 v53, v59, v61
 v_max_f32 v79, v52, v53
 s_waitcnt vmcnt(0)
 v_pk_add_f16 v80, v40, v44
 v_pk_add_f16 v82, v42, v46
 v_pk_add_f16 v81, v41, v45
 v_pk_add_f16 v83, v43, v47
 v_permlane32_swap_b32 v80, v82
 v_bitop3_b32 v77, v40, v42, s88 bitop3:0x7e
 v_permlane32_swap_b32 v81, v83
 v_bitop3_b32 v78, v44, v46, s88 bitop3:0x7e
 v_fma_mix_f32 v48, v80, 1.0, v82 op_sel:[0,0,0] op_sel_hi:[1,0,1]
 v_or3_b32 v27, v76, v77, v78
 v_fma_mix_f32 v49, v80, 1.0, v82 op_sel:[1,0,1] op_sel_hi:[1,0,1]
 v_and_b32 v27, 1, v27
 v_fma_mix_f32 v50, v81, 1.0, v83 op_sel:[0,0,0] op_sel_hi:[1,0,1]
 v_cmp_ne_u32 vcc, 0, v27
 v_fma_mix_f32 v51, v81, 1.0, v83 op_sel:[1,0,1] op_sel_hi:[1,0,1]
 v_max3_f32 v62, v48, v49, v79
 s_cbranch_vccnz psr_57
 s_branch psj_58
kvw_59:
 s_mov_b32 s22, s87
 s_cmp_eq_u32 s52, 0
 s_cselect_b32 s55, 0, s55
 s_cselect_b32 s87, 1, 0
 s_cbranch_scc1 kvok_60
 v_mov_b32 v62, 0
 s_mov_b32 s101, 0
wf_64:
 buffer_load_dword v63, v62, s[12:15], s79 offen sc1
 s_add_u32 s101, s101, 1
 s_cmp_gt_u32 s101, 131072
 s_cbranch_scc1 end0
 s_waitcnt vmcnt(0)
 v_readfirstlane_b32 s100, v63
 s_cmp_ge_u32 s100, s46
 s_cbranch_scc1 wf_65
 s_sleep 3
 s_branch wf_64
wf_65:
 s_cmp_eq_u32 s22, 0
 s_cbranch_scc1 kvok_60
 s_sub_u32 s21, s64, 1310720
 buffer_load_dwordx4 v[126:129], v16, s[28:31], s21 offen offset:0 sc1
 buffer_load_dwordx4 v[130:133], v16, s[28:31], s21 offen offset:1024 sc1
 buffer_load_dwordx4 v[134:137], v16, s[28:31], s21 offen offset:2048 sc1
 s_waitcnt vmcnt(0)
 s_branch kvok_60
fl_61:
 buffer_load_dword v0, off, s[12:15], s79 sc1
 s_branch fl_62
last_51:
 s_mov_b64 exec, s[62:63]
 buffer_store_dwordx4 v[118:121], v18, s[24:27], s85 offen sc1
 buffer_store_dwordx2 v[122:123], v19, s[24:27], s85 offen sc1
 s_mov_b64 exec, -1
 s_waitcnt lgkmcnt(10)
 v_smfmac_f32_16x16x64_f16 v[100:103], v[28:31], a[120:127], v25
 v_smfmac_f32_16x16x64_f16 v[104:107], v[28:31], a[128:135], v25
 v_smfmac_f32_16x16x64_f16 v[108:111], v[28:31], a[136:143], v25
 v_smfmac_f32_16x16x64_f16 v[100:103], v[32:35], a[144:151], v25
 v_smfmac_f32_16x16x64_f16 v[104:107], v[32:35], a[152:159], v25
 v_smfmac_f32_16x16x64_f16 v[108:111], v[32:35], a[160:167], v25
 s_waitcnt lgkmcnt(7)
 v_smfmac_f32_16x16x64_f16 v[100:103], v[64:67], a[168:175], v25
 v_smfmac_f32_16x16x64_f16 v[104:107], v[64:67], a[176:183], v25
 v_smfmac_f32_16x16x64_f16 v[108:111], v[64:67], a[184:191], v25
 v_smfmac_f32_16x16x64_f16 v[100:103], v[68:71], a[192:199], v25
 v_smfmac_f32_16x16x64_f16 v[104:107], v[68:71], a[200:207], v25
 v_smfmac_f32_16x16x64_f16 v[108:111], v[68:71], a[208:215], v25
 v_smfmac_f32_16x16x64_f16 v[100:103], v[72:75], a[216:223], v25
 v_smfmac_f32_16x16x64_f16 v[104:107], v[72:75], a[224:231], v25
 v_smfmac_f32_16x16x64_f16 v[108:111], v[72:75], a[232:239], v25
 s_waitcnt lgkmcnt(4)
 v_smfmac_f32_16x16x64_f16 v[100:103], v[76:79], a[240:247], v25
 v_smfmac_f32_16x16x64_f16 v[104:107], v[76:79], a[248:255], v25
 v_smfmac_f32_16x16x64_f16 v[108:111], v[76:79], v[152:159], v25
 v_smfmac_f32_16x16x64_f16 v[100:103], v[80:83], v[160:167], v25
 v_smfmac_f32_16x16x64_f16 v[104:107], v[80:83], v[168:175], v25
 v_smfmac_f32_16x16x64_f16 v[108:111], v[80:83], v[176:183], v25
 v_smfmac_f32_16x16x64_f16 v[100:103], v[84:87], v[184:191], v25
 v_smfmac_f32_16x16x64_f16 v[104:107], v[84:87], v[192:199], v25
 v_smfmac_f32_16x16x64_f16 v[108:111], v[84:87], v[200:207], v25
 s_waitcnt lgkmcnt(0)
 v_smfmac_f32_16x16x64_f16 v[100:103], v[88:91], v[208:215], v25
 v_smfmac_f32_16x16x64_f16 v[104:107], v[88:91], v[216:223], v25
 v_smfmac_f32_16x16x64_f16 v[108:111], v[88:91], v[224:231], v25
 v_smfmac_f32_16x16x64_f16 v[100:103], v[92:95], v[232:239], v25
 v_smfmac_f32_16x16x64_f16 v[104:107], v[92:95], v[240:247], v25
 v_smfmac_f32_16x16x64_f16 v[108:111], v[92:95], v[248:255], v25
 s_nop 7
 v_mov_b32 v76, v108
 v_mov_b32 v77, v109
 v_mov_b32 v78, v110
 v_mov_b32 v79, v111
 v_permlane32_swap_b32 v100, v104
 v_permlane32_swap_b32 v101, v105
 v_permlane32_swap_b32 v102, v106
 v_permlane32_swap_b32 v103, v107
 v_permlane32_swap_b32 v108, v76
 v_permlane32_swap_b32 v109, v77
 v_permlane32_swap_b32 v110, v78
 v_permlane32_swap_b32 v111, v79
 v_pk_add_f32 v[100:101], v[100:101], v[104:105]
 v_pk_add_f32 v[102:103], v[102:103], v[106:107]
 v_pk_add_f32 v[108:109], v[108:109], v[76:77]
 v_pk_add_f32 v[110:111], v[110:111], v[78:79]
 v_cvt_pk_bf16_f32 v80, v100, v101
 v_cvt_pk_bf16_f32 v82, v108, v109
 v_cvt_pk_bf16_f32 v81, v102, v103
 v_cvt_pk_bf16_f32 v83, v110, v111
 s_nop 0
 v_permlane16_swap_b32 v80, v82
 v_permlane16_swap_b32 v81, v83
 v_min_u32 v80, -2, v80
 s_mov_b64 exec, s[76:77]
 buffer_store_dwordx4 v[80:83], v15, s[24:27], s57 offen sc1
 s_mov_b64 exec, -1
 s_branch chain_done
step_66:
 s_and_b32 s21, s52, 3
 s_mul_i32 s81, s21, 540672
 s_lshl_b32 s84, s21, 15
 s_add_u32 s21, s52, 3
 s_and_b32 s21, s21, 3
 s_lshl_b32 s83, s21, 15
 s_add_u32 s21, s52, 1
 s_and_b32 s22, s21, 3
 s_lshl_b32 s3, s22, 15
 s_mul_i32 s80, s21, 393216
 s_add_u32 s46, s21, 1
 s_min_u32 s46, s46, 64
 s_mov_b32 s47, s57
 s_lshl_b32 s21, s52, 12
 s_and_b32 s21, s21, 8192
 s_xor_b32 s21, s21, s37
 s_lshl_b32 s22, s52, 20
 s_or_b32 s22, s22, s21
 s_cmp_ge_u32 s52, 36
 s_cselect_b32 s57, 8192, 0
 s_xor_b32 s57, s57, s22
 s_xor_b32 s85, s22, 8192
 s_bfe_u32 s88, s52, 0x10002
 s_max_u32 s67, s52, 1
 s_sub_u32 s67, s67, 1
 v_mov_b32 v40, 0
 v_mov_b32 v41, 0
 v_mov_b32 v42, 0
 v_mov_b32 v43, 0
 v_mov_b32 v44, 0
 v_mov_b32 v45, 0
 v_mov_b32 v46, 0
 v_mov_b32 v47, 0
 v_mov_b32 v48, 0
 v_mov_b32 v49, 0
 v_mov_b32 v50, 0
 v_mov_b32 v51, 0
 v_mov_b32 v52, 0
 v_mov_b32 v53, 0
 v_mov_b32 v54, 0
 v_mov_b32 v55, 0
 v_mov_b32 v56, 0
 v_mov_b32 v57, 0
 v_mov_b32 v58, 0
 v_mov_b32 v59, 0
 v_mov_b32 v60, 0
 v_mov_b32 v61, 0
 v_mov_b32 v62, 0
 v_mov_b32 v63, 0
 v_mov_b32 v100, 0
 v_mov_b32 v101, 0
 v_mov_b32 v102, 0
 v_mov_b32 v103, 0
 v_mov_b32 v104, 0
 v_mov_b32 v105, 0
 v_mov_b32 v106, 0
 v_mov_b32 v107, 0
 v_mov_b32 v108, 0
 v_mov_b32 v109, 0
 v_mov_b32 v110, 0
 v_mov_b32 v111, 0
 s_sleep 6
 v_readfirstlane_b32 s21, v0
 s_cmp_lt_u32 s21, s46
 s_cselect_b32 s55, s55, 0
 s_cmp_lt_i32 s55, 0
 s_cbranch_scc1 fl_71
fl_72:
 s_mov_b32 s54, 0
 buffer_load_dwordx4 v[36:39], v4, s[4:7], s84 offen offset:2048 sc1
 buffer_load_dwordx4 v[28:31], v4, s[4:7], s84 offen offset:0 sc1
 buffer_load_dwordx4 v[32:35], v4, s[4:7], s84 offen offset:1024 sc1
 s_waitcnt vmcnt(3)
 v_mov_b32 v126, v88
 v_mov_b32 v127, v89
 v_mov_b32 v128, v90
 v_mov_b32 v129, v91
 v_mov_b32 v130, v92
 v_mov_b32 v131, v93
 v_mov_b32 v132, v94
 v_mov_b32 v133, v95
 v_mov_b32 v134, v96
 v_mov_b32 v135, v97
 v_mov_b32 v136, v98
 v_mov_b32 v137, v99
 s_waitcnt vmcnt(2)
 v_smfmac_f32_16x16x32_f16 v[40:43], v[36:37], a[16:19], v25
 v_smfmac_f32_16x16x32_f16 v[52:55], v[36:37], a[76:79], v25
 v_smfmac_f32_16x16x32_f16 v[44:47], v[36:37], a[36:39], v25
 s_waitcnt vmcnt(0)
 v_bitop3_b32 v27, v31, v35, v39 bitop3:0x80
 v_perm_b32 v31, v35, v31, s89
 v_cmp_gt_u32 vcc, 0x48000000, v27
 v_mov_b32 v35, v38
 v_smfmac_f32_16x16x32_f16 v[56:59], v[36:37], a[96:99], v25
 s_cbranch_vccnz pm_69
A2_70:
 v_smfmac_f32_16x16x64_f16 v[40:43], v[28:31], a[0:7], v25
 ds_write_b128 v10, v[28:31]
 v_smfmac_f32_16x16x64_f16 v[40:43], v[32:35], a[8:15], v25
 ds_write_b128 v10, v[32:35] offset:1024
 v_smfmac_f32_16x16x64_f16 v[52:55], v[28:31], a[60:67], v25
 ds_write_b64 v10, v[36:37] offset:2048
 v_smfmac_f32_16x16x64_f16 v[52:55], v[32:35], a[68:75], v25
 v_cvt_pk_f16_f32 v40, v40, v41
 v_cvt_pk_f16_f32 v41, v42, v43
 v_smfmac_f32_16x16x32_f16 v[48:51], v[36:37], a[56:59], v25
 v_smfmac_f32_16x16x32_f16 v[60:63], v[36:37], a[116:119], v25
 v_smfmac_f32_16x16x64_f16 v[44:47], v[28:31], a[20:27], v25
 v_cvt_pk_f16_f32 v52, v52, v53
 v_cvt_pk_f16_f32 v53, v54, v55
 s_nop 0
 v_smfmac_f32_16x16x64_f16 v[44:47], v[32:35], a[28:35], v25
 v_permlane32_swap_b32 v40, v52
 v_smfmac_f32_16x16x64_f16 v[56:59], v[28:31], a[80:87], v25
 v_permlane32_swap_b32 v41, v53
 v_pk_add_f16 v40, v40, v52
 v_smfmac_f32_16x16x64_f16 v[56:59], v[32:35], a[88:95], v25
 v_pk_add_f16 v41, v41, v53
 v_smfmac_f32_16x16x64_f16 v[48:51], v[28:31], a[40:47], v25
 ds_write_b64 v5, v[40:41] offset:0
 v_smfmac_f32_16x16x64_f16 v[48:51], v[32:35], a[48:55], v25
 v_cvt_pk_f16_f32 v44, v44, v45
 v_cvt_pk_f16_f32 v45, v46, v47
 v_cvt_pk_f16_f32 v56, v56, v57
 v_smfmac_f32_16x16x64_f16 v[60:63], v[28:31], a[100:107], v25
 v_cvt_pk_f16_f32 v57, v58, v59
 s_nop 0
 v_smfmac_f32_16x16x64_f16 v[60:63], v[32:35], a[108:115], v25
 v_permlane32_swap_b32 v44, v56
 v_permlane32_swap_b32 v45, v57
 v_pk_add_f16 v44, v44, v56
 v_pk_add_f16 v45, v45, v57
 ds_write_b64 v5, v[44:45] offset:640
 v_cvt_pk_f16_f32 v48, v48, v49
 v_cvt_pk_f16_f32 v49, v50, v51
 v_cvt_pk_f16_f32 v60, v60, v61
 v_cvt_pk_f16_f32 v61, v62, v63
 s_nop 0
 v_permlane32_swap_b32 v48, v60
 v_permlane32_swap_b32 v49, v61
 v_pk_add_f16 v48, v48, v60
 v_pk_add_f16 v49, v49, v61
 ds_write_b64 v5, v[48:49] offset:1280
 s_waitcnt lgkmcnt(0) vmcnt(0)
 s_barrier
 ds_read_b128 v[28:31], v16 offset:24576
 ds_read_b128 v[32:35], v16 offset:25600
 ds_read_b128 v[64:67], v16 offset:27648
 ds_read_b128 v[68:71], v16 offset:28672
 ds_read_b128 v[72:75], v16 offset:30720
 ds_read_b128 v[76:79], v16 offset:31744
 ds_read_b128 v[80:83], v16 offset:33792
 ds_read_b128 v[84:87], v16 offset:34816
 ds_read_b64 v[88:89], v16 offset:26624
 ds_read_b64 v[90:91], v16 offset:29696
 ds_read_b64 v[92:93], v16 offset:32768
 ds_read_b64 v[94:95], v16 offset:35840
 s_cmp_eq_u32 s52, 63
 s_cbranch_scc1 last_67
 s_waitcnt lgkmcnt(10)
 v_smfmac_f32_16x16x64_f16 v[100:103], v[28:31], a[120:127], v25
 v_smfmac_f32_16x16x64_f16 v[104:107], v[28:31], a[128:135], v25
 v_smfmac_f32_16x16x64_f16 v[108:111], v[28:31], a[136:143], v25
 s_mov_b32 s54, 0
 v_smfmac_f32_16x16x64_f16 v[100:103], v[32:35], a[144:151], v25
 v_readfirstlane_b32 s21, v0
 v_smfmac_f32_16x16x64_f16 v[104:107], v[32:35], a[152:159], v25
 s_add_u32 s22, s46, 3
 v_smfmac_f32_16x16x64_f16 v[108:111], v[32:35], a[160:167], v25
 s_min_u32 s22, s22, 64
 s_waitcnt lgkmcnt(7)
 v_smfmac_f32_16x16x64_f16 v[100:103], v[64:67], a[168:175], v25
 s_sub_u32 s55, s21, s22
 v_smfmac_f32_16x16x64_f16 v[104:107], v[64:67], a[176:183], v25
 s_sub_u32 s56, s21, s46
 v_smfmac_f32_16x16x64_f16 v[108:111], v[64:67], a[184:191], v25
 v_smfmac_f32_16x16x64_f16 v[100:103], v[68:71], a[192:199], v25
 v_smfmac_f32_16x16x64_f16 v[104:107], v[68:71], a[200:207], v25
 v_smfmac_f32_16x16x64_f16 v[108:111], v[68:71], a[208:215], v25
 v_smfmac_f32_16x16x64_f16 v[100:103], v[72:75], a[216:223], v25
 v_smfmac_f32_16x16x64_f16 v[104:107], v[72:75], a[224:231], v25
 v_smfmac_f32_16x16x64_f16 v[108:111], v[72:75], a[232:239], v25
 s_waitcnt lgkmcnt(4)
 v_smfmac_f32_16x16x64_f16 v[100:103], v[76:79], a[240:247], v25
 v_smfmac_f32_16x16x64_f16 v[104:107], v[76:79], a[248:255], v25
 v_smfmac_f32_16x16x64_f16 v[108:111], v[76:79], v[152:159], v25
 v_smfmac_f32_16x16x64_f16 v[100:103], v[80:83], v[160:167], v25
 v_smfmac_f32_16x16x64_f16 v[104:107], v[80:83], v[168:175], v25
 v_smfmac_f32_16x16x64_f16 v[108:111], v[80:83], v[176:183], v25
 v_smfmac_f32_16x16x64_f16 v[100:103], v[84:87], v[184:191], v25
 v_smfmac_f32_16x16x64_f16 v[104:107], v[84:87], v[192:199], v25
 v_smfmac_f32_16x16x64_f16 v[108:111], v[84:87], v[200:207], v25
 s_waitcnt lgkmcnt(0)
 v_smfmac_f32_16x16x64_f16 v[100:103], v[88:91], v[208:215], v25
 v_smfmac_f32_16x16x64_f16 v[104:107], v[88:91], v[216:223], v25
 v_smfmac_f32_16x16x64_f16 v[108:111], v[88:91], v[224:231], v25
 v_smfmac_f32_16x16x64_f16 v[100:103], v[92:95], v[232:239], v25
 v_smfmac_f32_16x16x64_f16 v[104:107], v[92:95], v[240:247], v25
 v_smfmac_f32_16x16x64_f16 v[108:111], v[92:95], v[248:255], v25
 s_sleep 2
 buffer_load_dwordx2 v[58:59], v9, s[8:11], s81 offen sc1
 buffer_load_dwordx4 v[40:43], v8, s[8:11], s81 offen offset:0 sc1
 buffer_load_dwordx4 v[44:47], v8, s[8:11], s81 offen offset:1024 sc1
 s_cmp_lt_i32 s56, 0
 s_cbranch_scc1 kvw_75
kvok_76:
 s_waitcnt vmcnt(2)
 v_xor_b32 v76, s88, v58
 s_nop 0
 v_permlane16_swap_b32 v58, v59
 v_fma_mix_f32 v60, v58, 1.0, v59 op_sel:[0,0,0] op_sel_hi:[1,0,1]
 v_fma_mix_f32 v61, v58, 1.0, v59 op_sel:[1,0,1] op_sel_hi:[1,0,1]
 v_mov_b32 v58, v60
 v_mov_b32 v59, v61
 s_nop 0
 v_permlane32_swap_b32 v58, v60
 v_permlane32_swap_b32 v59, v61
 v_add_f32 v52, v58, v60
 v_add_f32 v53, v59, v61
 v_max_f32 v79, v52, v53
 s_waitcnt vmcnt(0)
 v_pk_add_f16 v80, v40, v44
 v_pk_add_f16 v82, v42, v46
 v_pk_add_f16 v81, v41, v45
 v_pk_add_f16 v83, v43, v47
 v_permlane32_swap_b32 v80, v82
 v_bitop3_b32 v77, v40, v42, s88 bitop3:0x7e
 v_permlane32_swap_b32 v81, v83
 v_bitop3_b32 v78, v44, v46, s88 bitop3:0x7e
 v_fma_mix_f32 v48, v80, 1.0, v82 op_sel:[0,0,0] op_sel_hi:[1,0,1]
 v_or3_b32 v27, v76, v77, v78
 v_fma_mix_f32 v49, v80, 1.0, v82 op_sel:[1,0,1] op_sel_hi:[1,0,1]
 v_and_b32 v27, 1, v27
 v_fma_mix_f32 v50, v81, 1.0, v83 op_sel:[0,0,0] op_sel_hi:[1,0,1]
 v_cmp_ne_u32 vcc, 0, v27
 v_fma_mix_f32 v51, v81, 1.0, v83 op_sel:[1,0,1] op_sel_hi:[1,0,1]
 v_max3_f32 v62, v48, v49, v79
 s_cbranch_vccnz psr_73
psj_74:
 v_max3_f32 v62, v62, v50, v51
 v_cvt_pk_bf16_f32 v146, v100, v101
 v_cvt_pk_bf16_f32 v147, v102, v103
 v_max_f32_dpp v62, v62, v62 row_ror:8 row_mask:0xf bank_mask:0xf
 v_mov_b32 v63, v62
 v_cvt_pk_bf16_f32 v148, v104, v105
 v_cvt_pk_bf16_f32 v149, v106, v107
 v_permlane32_swap_b32 v62, v63
 v_max_f32 v62, v62, v63
 v_mov_b32 v63, v62
 v_cvt_pk_bf16_f32 v150, v108, v109
 v_cvt_pk_bf16_f32 v151, v110, v111
 v_permlane16_swap_b32 v62, v63
 v_max_f32 v62, v62, v63
 v_mul_f32 v62, s86, v62
 v_fma_f32 v48, v48, s86, -v62
 v_fma_f32 v49, v49, s86, -v62
 v_fma_f32 v50, v50, s86, -v62
 v_fma_f32 v51, v51, s86, -v62
 v_fma_f32 v52, v52, s86, -v62
 v_fma_f32 v53, v53, s86, -v62
 v_exp_f32 v48, v48
 v_exp_f32 v49, v49
 buffer_load_dwordx4 v[88:91], v17, s[28:31], s64 offen offset:0 sc1
 v_exp_f32 v50, v50
 v_exp_f32 v51, v51
 buffer_load_dwordx4 v[92:95], v16, s[28:31], s64 offen offset:1024 sc1
 v_exp_f32 v52, v52
 v_exp_f32 v53, v53
 buffer_load_dwordx4 v[96:99], v20, s[28:31], s64 offen offset:2048 sc1
 v_cvt_pk_bf16_f32 v138, v48, v49
 v_cvt_pk_bf16_f32 v139, v50, v51
 v_cvt_pk_bf16_f32 v142, v52, v53
 v_mov_b32_dpp v140, v138 row_ror:8 row_mask:0xf bank_mask:0xf
 v_mov_b32_dpp v141, v139 row_ror:8 row_mask:0xf bank_mask:0xf
 v_mov_b32_dpp v143, v142 row_ror:8 row_mask:0xf bank_mask:0xf
 v_mov_b32 v84, s67
 v_mov_b32 v85, s67
 s_mov_b64 exec, 15
 buffer_store_dwordx2 v[84:85], v24, s[12:15], s66 offen sc1
 s_mov_b64 exec, -1
 v_add_f32 v54, v48, v49
 v_mfma_f32_16x16x32_bf16 v[64:67], v[126:129], v[138:141], 0
 v_add_f32 v55, v50, v51
 v_add_f32 v56, v52, v53
 v_mfma_f32_16x16x32_bf16 v[64:67], v[146:149], v[142:145], v[64:67]
 v_add_f32 v62, v54, v55
 v_fmac_f32 v62, v56, v26
 v_mfma_f32_16x16x32_bf16 v[68:71], v[130:133], v[138:141], 0
 s_nop 0
 v_add_f32_dpp v62, v62, v62 row_ror:8 row_mask:0xf bank_mask:0xf
 v_mfma_f32_16x16x32_bf16 v[68:71], v[148:151], v[142:145], v[68:71]
 v_mov_b32 v63, v62
 s_cmp_lt_i32 s55, 0
 s_cbranch_scc1 fl_77
fl_78:
 v_mfma_f32_16x16x32_bf16 v[72:75], v[134:137], v[138:141], 0
 v_permlane32_swap_b32 v62, v63
 v_mfma_f32_16x16x32_bf16 v[72:75], v[150:153], v[142:145], v[72:75]
 v_add_f32 v62, v62, v63
 v_mov_b32 v63, v62
 ds_write_b128 v11, v[64:67] offset:0
 s_nop 0
 v_permlane16_swap_b32 v62, v63
 v_add_f32 v62, v62, v63
 v_rcp_f32 v62, v62
 ds_write_b128 v11, v[68:71] offset:1024
 s_mov_b64 exec, 0xff
 ds_write_b32 v22, v62
 s_mov_b64 exec, -1
 ds_write_b128 v11, v[72:75] offset:2048
 s_waitcnt lgkmcnt(0)
 s_barrier
 s_and_b32 s21, s52, 7
 s_cmp_lg_u32 s21, s50
 s_cbranch_scc1 zm_79
 v_mov_b32 v64, 0
 v_mov_b32 v65, 0
 v_mov_b32 v66, 0
 v_mov_b32 v67, 0
 s_mov_b64 exec, s[70:71]
 buffer_store_dwordx4 v[64:67], v13, s[4:7], s83 offen sc1
 s_mov_b64 exec, -1
zm_79:
 v_mov_b32 v76, v108
 v_mov_b32 v77, v109
 v_mov_b32 v78, v110
 v_mov_b32 v79, v111
 v_permlane32_swap_b32 v100, v104
 v_permlane32_swap_b32 v101, v105
 v_permlane32_swap_b32 v102, v106
 v_permlane32_swap_b32 v103, v107
 v_permlane32_swap_b32 v108, v76
 v_permlane32_swap_b32 v109, v77
 v_permlane32_swap_b32 v110, v78
 v_permlane32_swap_b32 v111, v79
 v_pk_add_f32 v[100:101], v[100:101], v[104:105]
 v_pk_add_f32 v[102:103], v[102:103], v[106:107]
 v_pk_add_f32 v[108:109], v[108:109], v[76:77]
 v_pk_add_f32 v[110:111], v[110:111], v[78:79]
 v_cvt_pk_bf16_f32 v80, v100, v101
 v_cvt_pk_bf16_f32 v82, v108, v109
 v_cvt_pk_bf16_f32 v81, v102, v103
 v_cvt_pk_bf16_f32 v83, v110, v111
 s_nop 0
 v_permlane16_swap_b32 v80, v82
 v_permlane16_swap_b32 v81, v83
 v_min_u32 v80, -2, v80
 s_mov_b64 exec, s[76:77]
 buffer_store_dwordx4 v[80:83], v15, s[24:27], s57 offen sc1
 s_mov_b64 exec, -1
 s_add_u32 s64, s64, 1310720
 s_add_u32 s52, s52, 1
 s_branch step_66
fl_71:
 buffer_load_dword v0, off, s[12:15], s79 sc1
 s_branch fl_72
A1_16:
 v_smfmac_f32_16x16x32_f16 v[40:43], v[36:37], a[16:19], v25
 v_smfmac_f32_16x16x32_f16 v[52:55], v[36:37], a[76:79], v25
 v_smfmac_f32_16x16x32_f16 v[44:47], v[36:37], a[36:39], v25
 v_smfmac_f32_16x16x32_f16 v[56:59], v[36:37], a[96:99], v25
 s_branch A2_70
pm_69:
 buffer_load_dwordx4 v[36:39], v4, s[4:7], s84 offen offset:2048 sc1
 buffer_load_dwordx4 v[28:31], v4, s[4:7], s84 offen offset:0 sc1
 buffer_load_dwordx4 v[32:35], v4, s[4:7], s84 offen offset:1024 sc1
 s_nop 7
 v_mov_b32 v40, 0
 v_mov_b32 v41, 0
 v_mov_b32 v42, 0
 v_mov_b32 v43, 0
 v_mov_b32 v52, 0
 v_mov_b32 v53, 0
 v_mov_b32 v54, 0
 v_mov_b32 v55, 0
 v_mov_b32 v44, 0
 v_mov_b32 v45, 0
 v_mov_b32 v46, 0
 v_mov_b32 v47, 0
 v_mov_b32 v56, 0
 v_mov_b32 v57, 0
 v_mov_b32 v58, 0
 v_mov_b32 v59, 0
 s_waitcnt vmcnt(0)
 v_bitop3_b32 v27, v31, v35, v39 bitop3:0x80
 v_perm_b32 v31, v35, v31, s89
 v_cmp_gt_u32 vcc, 0x48000000, v27
 v_mov_b32 v35, v38
 s_cbranch_vccz A1_16
pm_68:
 s_cmp_gt_u32 s52, 3
 s_cbranch_scc1 op_80
 v_readfirstlane_b32 s21, v0
 s_cmp_ge_u32 s21, s46
 s_cbranch_scc1 op_80
 buffer_load_dword v0, off, s[12:15], s79 sc1
 s_waitcnt vmcnt(0)
 v_readfirstlane_b32 s21, v0
 s_cmp_gt_u32 s21, s52
 s_cselect_b32 s21, s87, 0
 s_cmp_eq_u32 s21, 0
 s_cbranch_scc1 op_80
 s_mov_b32 s87, 0
 s_sub_u32 s21, s64, 1310720
 buffer_load_dwordx4 v[126:129], v16, s[28:31], s21 offen offset:0 sc1
 buffer_load_dwordx4 v[130:133], v16, s[28:31], s21 offen offset:1024 sc1
 buffer_load_dwordx4 v[134:137], v16, s[28:31], s21 offen offset:2048 sc1
op_80:
 buffer_load_dwordx4 v[36:39], v4, s[4:7], s84 offen offset:2048 sc1
 buffer_load_dwordx4 v[28:31], v4, s[4:7], s84 offen offset:0 sc1
 buffer_load_dwordx4 v[32:35], v4, s[4:7], s84 offen offset:1024 sc1
 s_add_u32 s54, s54, 1
 s_cmp_gt_u32 s54, 131072
 s_cbranch_scc1 end0
 s_waitcnt vmcnt(0)
 v_bitop3_b32 v27, v31, v35, v39 bitop3:0x80
 v_perm_b32 v31, v35, v31, s89
 v_cmp_gt_u32 vcc, 0x48000000, v27
 v_mov_b32 v35, v38
 s_cbranch_vccnz pm_68
 s_branch A1_16
psr_73:
 buffer_load_dwordx2 v[58:59], v9, s[8:11], s81 offen sc1
 buffer_load_dwordx4 v[40:43], v8, s[8:11], s81 offen offset:0 sc1
 buffer_load_dwordx4 v[44:47], v8, s[8:11], s81 offen offset:1024 sc1
 s_add_u32 s54, s54, 1
 s_cmp_gt_u32 s54, 131072
 s_cbranch_scc1 end0
 s_waitcnt vmcnt(2)
 v_xor_b32 v76, s88, v58
 s_nop 0
 v_permlane16_swap_b32 v58, v59
 v_fma_mix_f32 v60, v58, 1.0, v59 op_sel:[0,0,0] op_sel_hi:[1,0,1]
 v_fma_mix_f32 v61, v58, 1.0, v59 op_sel:[1,0,1] op_sel_hi:[1,0,1]
 v_mov_b32 v58, v60
 v_mov_b32 v59, v61
 s_nop 0
 v_permlane32_swap_b32 v58, v60
 v_permlane32_swap_b32 v59, v61
 v_add_f32 v52, v58, v60
 v_add_f32 v53, v59, v61
 v_max_f32 v79, v52, v53
 s_waitcnt vmcnt(0)
 v_pk_add_f16 v80, v40, v44
 v_pk_add_f16 v82, v42, v46
 v_pk_add_f16 v81, v41, v45
 v_pk_add_f16 v83, v43, v47
 v_permlane32_swap_b32 v80, v82
 v_bitop3_b32 v77, v40, v42, s88 bitop3:0x7e
 v_permlane32_swap_b32 v81, v83
 v_bitop3_b32 v78, v44, v46, s88 bitop3:0x7e
 v_fma_mix_f32 v48, v80, 1.0, v82 op_sel:[0,0,0] op_sel_hi:[1,0,1]
 v_or3_b32 v27, v76, v77, v78
 v_fma_mix_f32 v49, v80, 1.0, v82 op_sel:[1,0,1] op_sel_hi:[1,0,1]
 v_and_b32 v27, 1, v27
 v_fma_mix_f32 v50, v81, 1.0, v83 op_sel:[0,0,0] op_sel_hi:[1,0,1]
 v_cmp_ne_u32 vcc, 0, v27
 v_fma_mix_f32 v51, v81, 1.0, v83 op_sel:[1,0,1] op_sel_hi:[1,0,1]
 v_max3_f32 v62, v48, v49, v79
 s_cbranch_vccnz psr_73
 s_branch psj_74
kvw_75:
 s_mov_b32 s22, s87
 s_cmp_eq_u32 s52, 0
 s_cselect_b32 s55, 0, s55
 s_cselect_b32 s87, 1, 0
 s_cbranch_scc1 kvok_76
 v_mov_b32 v62, 0
 s_mov_b32 s101, 0
wf_81:
 buffer_load_dword v63, v62, s[12:15], s79 offen sc1
 s_add_u32 s101, s101, 1
 s_cmp_gt_u32 s101, 131072
 s_cbranch_scc1 end0
 s_waitcnt vmcnt(0)
 v_readfirstlane_b32 s100, v63
 s_cmp_ge_u32 s100, s46
 s_cbranch_scc1 wf_82
 s_sleep 3
 s_branch wf_81
wf_82:
 s_cmp_eq_u32 s22, 0
 s_cbranch_scc1 kvok_76
 s_sub_u32 s21, s64, 1310720
 buffer_load_dwordx4 v[126:129], v16, s[28:31], s21 offen offset:0 sc1
 buffer_load_dwordx4 v[130:133], v16, s[28:31], s21 offen offset:1024 sc1
 buffer_load_dwordx4 v[134:137], v16, s[28:31], s21 offen offset:2048 sc1
 s_waitcnt vmcnt(0)
 s_branch kvok_76
fl_77:
 buffer_load_dword v0, off, s[12:15], s79 sc1
 s_branch fl_78
last_67:
 s_waitcnt lgkmcnt(10)
 v_smfmac_f32_16x16x64_f16 v[100:103], v[28:31], a[120:127], v25
 v_smfmac_f32_16x16x64_f16 v[104:107], v[28:31], a[128:135], v25
 v_smfmac_f32_16x16x64_f16 v[108:111], v[28:31], a[136:143], v25
 v_smfmac_f32_16x16x64_f16 v[100:103], v[32:35], a[144:151], v25
 v_smfmac_f32_16x16x64_f16 v[104:107], v[32:35], a[152:159], v25
 v_smfmac_f32_16x16x64_f16 v[108:111], v[32:35], a[160:167], v25
 s_waitcnt lgkmcnt(7)
 v_smfmac_f32_16x16x64_f16 v[100:103], v[64:67], a[168:175], v25
 v_smfmac_f32_16x16x64_f16 v[104:107], v[64:67], a[176:183], v25
 v_smfmac_f32_16x16x64_f16 v[108:111], v[64:67], a[184:191], v25
 v_smfmac_f32_16x16x64_f16 v[100:103], v[68:71], a[192:199], v25
 v_smfmac_f32_16x16x64_f16 v[104:107], v[68:71], a[200:207], v25
 v_smfmac_f32_16x16x64_f16 v[108:111], v[68:71], a[208:215], v25
 v_smfmac_f32_16x16x64_f16 v[100:103], v[72:75], a[216:223], v25
 v_smfmac_f32_16x16x64_f16 v[104:107], v[72:75], a[224:231], v25
 v_smfmac_f32_16x16x64_f16 v[108:111], v[72:75], a[232:239], v25
 s_waitcnt lgkmcnt(4)
 v_smfmac_f32_16x16x64_f16 v[100:103], v[76:79], a[240:247], v25
 v_smfmac_f32_16x16x64_f16 v[104:107], v[76:79], a[248:255], v25
 v_smfmac_f32_16x16x64_f16 v[108:111], v[76:79], v[152:159], v25
 v_smfmac_f32_16x16x64_f16 v[100:103], v[80:83], v[160:167], v25
 v_smfmac_f32_16x16x64_f16 v[104:107], v[80:83], v[168:175], v25
 v_smfmac_f32_16x16x64_f16 v[108:111], v[80:83], v[176:183], v25
 v_smfmac_f32_16x16x64_f16 v[100:103], v[84:87], v[184:191], v25
 v_smfmac_f32_16x16x64_f16 v[104:107], v[84:87], v[192:199], v25
 v_smfmac_f32_16x16x64_f16 v[108:111], v[84:87], v[200:207], v25
 s_waitcnt lgkmcnt(0)
 v_smfmac_f32_16x16x64_f16 v[100:103], v[88:91], v[208:215], v25
 v_smfmac_f32_16x16x64_f16 v[104:107], v[88:91], v[216:223], v25
 v_smfmac_f32_16x16x64_f16 v[108:111], v[88:91], v[224:231], v25
 v_smfmac_f32_16x16x64_f16 v[100:103], v[92:95], v[232:239], v25
 v_smfmac_f32_16x16x64_f16 v[104:107], v[92:95], v[240:247], v25
 v_smfmac_f32_16x16x64_f16 v[108:111], v[92:95], v[248:255], v25
 s_nop 7
 v_mov_b32 v76, v108
 v_mov_b32 v77, v109
 v_mov_b32 v78, v110
 v_mov_b32 v79, v111
 v_permlane32_swap_b32 v100, v104
 v_permlane32_swap_b32 v101, v105
 v_permlane32_swap_b32 v102, v106
 v_permlane32_swap_b32 v103, v107
 v_permlane32_swap_b32 v108, v76
 v_permlane32_swap_b32 v109, v77
 v_permlane32_swap_b32 v110, v78
 v_permlane32_swap_b32 v111, v79
 v_pk_add_f32 v[100:101], v[100:101], v[104:105]
 v_pk_add_f32 v[102:103], v[102:103], v[106:107]
 v_pk_add_f32 v[108:109], v[108:109], v[76:77]
 v_pk_add_f32 v[110:111], v[110:111], v[78:79]
 v_cvt_pk_bf16_f32 v80, v100, v101
 v_cvt_pk_bf16_f32 v82, v108, v109
 v_cvt_pk_bf16_f32 v81, v102, v103
 v_cvt_pk_bf16_f32 v83, v110, v111
 s_nop 0
 v_permlane16_swap_b32 v80, v82
 v_permlane16_swap_b32 v81, v83
 v_min_u32 v80, -2, v80
 s_mov_b64 exec, s[76:77]
 buffer_store_dwordx4 v[80:83], v15, s[24:27], s57 offen sc1
 s_mov_b64 exec, -1
 s_branch chain_done
step_83:
 s_and_b32 s21, s52, 3
 s_mul_i32 s81, s21, 540672
 s_lshl_b32 s84, s21, 15
 s_add_u32 s21, s52, 3
 s_and_b32 s21, s21, 3
 s_lshl_b32 s83, s21, 15
 s_add_u32 s21, s52, 1
 s_and_b32 s22, s21, 3
 s_lshl_b32 s3, s22, 15
 s_mul_i32 s80, s21, 393216
 s_add_u32 s46, s21, 1
 s_min_u32 s46, s46, 64
 s_mov_b32 s47, s57
 s_lshl_b32 s21, s52, 12
 s_and_b32 s21, s21, 8192
 s_xor_b32 s21, s21, s37
 s_lshl_b32 s22, s52, 20
 s_or_b32 s22, s22, s21
 s_cmp_ge_u32 s52, 36
 s_cselect_b32 s57, 8192, 0
 s_xor_b32 s57, s57, s22
 s_xor_b32 s85, s22, 8192
 s_bfe_u32 s88, s52, 0x10002
 s_max_u32 s67, s52, 1
 s_sub_u32 s67, s67, 1
 v_mov_b32 v40, 0
 v_mov_b32 v41, 0
 v_mov_b32 v42, 0
 v_mov_b32 v43, 0
 v_mov_b32 v44, 0
 v_mov_b32 v45, 0
 v_mov_b32 v46, 0
 v_mov_b32 v47, 0
 v_mov_b32 v48, 0
 v_mov_b32 v49, 0
 v_mov_b32 v50, 0
 v_mov_b32 v51, 0
 v_mov_b32 v52, 0
 v_mov_b32 v53, 0
 v_mov_b32 v54, 0
 v_mov_b32 v55, 0
 v_mov_b32 v56, 0
 v_mov_b32 v57, 0
 v_mov_b32 v58, 0
 v_mov_b32 v59, 0
 v_mov_b32 v60, 0
 v_mov_b32 v61, 0
 v_mov_b32 v62, 0
 v_mov_b32 v63, 0
 v_mov_b32 v100, 0
 v_mov_b32 v101, 0
 v_mov_b32 v102, 0
 v_mov_b32 v103, 0
 v_mov_b32 v104, 0
 v_mov_b32 v105, 0
 v_mov_b32 v106, 0
 v_mov_b32 v107, 0
 v_mov_b32 v108, 0
 v_mov_b32 v109, 0
 v_mov_b32 v110, 0
 v_mov_b32 v111, 0
 s_sleep 8
 v_readfirstlane_b32 s21, v0
 s_cmp_lt_u32 s21, s46
 s_cselect_b32 s55, s55, 0
 s_cmp_lt_i32 s55, 0
 s_cbranch_scc1 fl_88
fl_89:
 s_mov_b32 s54, 0
 buffer_load_dwordx4 v[36:39], v4, s[4:7], s84 offen offset:2048 sc1
 buffer_load_dwordx4 v[28:31], v4, s[4:7], s84 offen offset:0 sc1
 buffer_load_dwordx4 v[32:35], v4, s[4:7], s84 offen offset:1024 sc1
 s_waitcnt vmcnt(3)
 v_mov_b32 v126, v88
 v_mov_b32 v127, v89
 v_mov_b32 v128, v90
 v_mov_b32 v129, v91
 v_mov_b32 v130, v92
 v_mov_b32 v131, v93
 v_mov_b32 v132, v94
 v_mov_b32 v133, v95
 v_mov_b32 v134, v96
 v_mov_b32 v135, v97
 v_mov_b32 v136, v98
 v_mov_b32 v137, v99
 s_waitcnt vmcnt(2)
 v_smfmac_f32_16x16x32_f16 v[40:43], v[36:37], a[16:19], v25
 v_smfmac_f32_16x16x32_f16 v[52:55], v[36:37], a[76:79], v25
 v_smfmac_f32_16x16x32_f16 v[44:47], v[36:37], a[36:39], v25
 s_waitcnt vmcnt(0)
 v_bitop3_b32 v27, v31, v35, v39 bitop3:0x80
 v_perm_b32 v31, v35, v31, s89
 v_cmp_gt_u32 vcc, 0x48000000, v27
 v_mov_b32 v35, v38
 v_smfmac_f32_16x16x32_f16 v[56:59], v[36:37], a[96:99], v25
 s_cbranch_vccnz pm_86
A2_87:
 v_smfmac_f32_16x16x64_f16 v[40:43], v[28:31], a[0:7], v25
 ds_write_b128 v10, v[28:31]
 v_smfmac_f32_16x16x64_f16 v[40:43], v[32:35], a[8:15], v25
 ds_write_b128 v10, v[32:35] offset:1024
 v_smfmac_f32_16x16x64_f16 v[52:55], v[28:31], a[60:67], v25
 ds_write_b64 v10, v[36:37] offset:2048
 v_smfmac_f32_16x16x64_f16 v[52:55], v[32:35], a[68:75], v25
 v_cvt_pk_f16_f32 v40, v40, v41
 v_cvt_pk_f16_f32 v41, v42, v43
 v_smfmac_f32_16x16x32_f16 v[48:51], v[36:37], a[56:59], v25
 v_smfmac_f32_16x16x32_f16 v[60:63], v[36:37], a[116:119], v25
 v_smfmac_f32_16x16x64_f16 v[44:47], v[28:31], a[20:27], v25
 v_cvt_pk_f16_f32 v52, v52, v53
 v_cvt_pk_f16_f32 v53, v54, v55
 s_nop 0
 v_smfmac_f32_16x16x64_f16 v[44:47], v[32:35], a[28:35], v25
 v_permlane32_swap_b32 v40, v52
 v_smfmac_f32_16x16x64_f16 v[56:59], v[28:31], a[80:87], v25
 v_permlane32_swap_b32 v41, v53
 v_pk_add_f16 v40, v40, v52
 v_smfmac_f32_16x16x64_f16 v[56:59], v[32:35], a[88:95], v25
 v_pk_add_f16 v41, v41, v53
 v_smfmac_f32_16x16x64_f16 v[48:51], v[28:31], a[40:47], v25
 ds_write_b64 v5, v[40:41] offset:0
 v_smfmac_f32_16x16x64_f16 v[48:51], v[32:35], a[48:55], v25
 v_cvt_pk_f16_f32 v44, v44, v45
 v_cvt_pk_f16_f32 v45, v46, v47
 v_cvt_pk_f16_f32 v56, v56, v57
 v_smfmac_f32_16x16x64_f16 v[60:63], v[28:31], a[100:107], v25
 v_cvt_pk_f16_f32 v57, v58, v59
 s_nop 0
 v_smfmac_f32_16x16x64_f16 v[60:63], v[32:35], a[108:115], v25
 v_permlane32_swap_b32 v44, v56
 v_permlane32_swap_b32 v45, v57
 v_pk_add_f16 v44, v44, v56
 v_pk_add_f16 v45, v45, v57
 ds_write_b64 v5, v[44:45] offset:640
 v_cvt_pk_f16_f32 v48, v48, v49
 v_cvt_pk_f16_f32 v49, v50, v51
 v_cvt_pk_f16_f32 v60, v60, v61
 v_cvt_pk_f16_f32 v61, v62, v63
 s_nop 0
 v_permlane32_swap_b32 v48, v60
 v_permlane32_swap_b32 v49, v61
 v_pk_add_f16 v48, v48, v60
 v_pk_add_f16 v49, v49, v61
 ds_write_b64 v5, v[48:49] offset:1280
 s_waitcnt lgkmcnt(0) vmcnt(0)
 s_barrier
 s_lshr_b32 s21, 3, s20
 s_bitcmp1_b32 s21, 0
 s_cbranch_scc0 bw_91
 ds_read_b64_tr_b16 v[40:41], v21 offset:0
 ds_read_b64_tr_b16 v[42:43], v21 offset:1920
 ds_read_b64_tr_b16 v[44:45], v21 offset:640
 ds_read_b64_tr_b16 v[46:47], v21 offset:2560
 ds_read_b64_tr_b16 v[48:49], v21 offset:1280
 ds_read_b64_tr_b16 v[50:51], v21 offset:3200
 s_waitcnt lgkmcnt(4)
 v_fma_mix_f32 v52, v40, 1.0, v42 op_sel:[0,0,0] op_sel_hi:[1,0,1]
 v_fma_mix_f32 v53, v40, 1.0, v42 op_sel:[1,0,1] op_sel_hi:[1,0,1]
 v_fma_mix_f32 v54, v41, 1.0, v43 op_sel:[0,0,0] op_sel_hi:[1,0,1]
 v_fma_mix_f32 v55, v41, 1.0, v43 op_sel:[1,0,1] op_sel_hi:[1,0,1]
 v_add_f32_dpp v56, v52, v52 row_ror:8 row_mask:0xf bank_mask:0xf
 v_add_f32_dpp v57, v53, v53 row_ror:8 row_mask:0xf bank_mask:0xf
 v_add_f32_dpp v58, v54, v54 row_ror:8 row_mask:0xf bank_mask:0xf
 v_add_f32_dpp v59, v55, v55 row_ror:8 row_mask:0xf bank_mask:0xf
 v_cvt_pk_bf16_f32 v118, v56, v57
 v_cvt_pk_bf16_f32 v119, v58, v59
 s_waitcnt lgkmcnt(2)
 v_fma_mix_f32 v52, v44, 1.0, v46 op_sel:[0,0,0] op_sel_hi:[1,0,1]
 v_fma_mix_f32 v53, v44, 1.0, v46 op_sel:[1,0,1] op_sel_hi:[1,0,1]
 v_fma_mix_f32 v54, v45, 1.0, v47 op_sel:[0,0,0] op_sel_hi:[1,0,1]
 v_fma_mix_f32 v55, v45, 1.0, v47 op_sel:[1,0,1] op_sel_hi:[1,0,1]
 v_add_f32_dpp v56, v52, v52 row_ror:8 row_mask:0xf bank_mask:0xf
 v_add_f32_dpp v57, v53, v53 row_ror:8 row_mask:0xf bank_mask:0xf
 v_add_f32_dpp v58, v54, v54 row_ror:8 row_mask:0xf bank_mask:0xf
 v_add_f32_dpp v59, v55, v55 row_ror:8 row_mask:0xf bank_mask:0xf
 v_cvt_pk_bf16_f32 v120, v56, v57
 v_cvt_pk_bf16_f32 v121, v58, v59
 s_waitcnt lgkmcnt(0)
 v_fma_mix_f32 v52, v48, 1.0, v50 op_sel:[0,0,0] op_sel_hi:[1,0,1]
 v_fma_mix_f32 v53, v48, 1.0, v50 op_sel:[1,0,1] op_sel_hi:[1,0,1]
 v_fma_mix_f32 v54, v49, 1.0, v51 op_sel:[0,0,0] op_sel_hi:[1,0,1]
 v_fma_mix_f32 v55, v49, 1.0, v51 op_sel:[1,0,1] op_sel_hi:[1,0,1]
 v_mfma_f32_16x16x32_bf16 v[40:43], v[112:115], v[118:121], 0
 v_add_f32_dpp v56, v52, v52 row_ror:8 row_mask:0xf bank_mask:0xf
 v_add_f32_dpp v57, v53, v53 row_ror:8 row_mask:0xf bank_mask:0xf
 v_add_f32_dpp v58, v54, v54 row_ror:8 row_mask:0xf bank_mask:0xf
 v_add_f32_dpp v59, v55, v55 row_ror:8 row_mask:0xf bank_mask:0xf
 v_cvt_pk_bf16_f32 v122, v56, v57
 v_cvt_pk_bf16_f32 v123, v58, v59
 s_nop 1
 v_mfma_f32_16x16x32_bf16 v[40:43], v[116:119], v[122:125], v[40:43]
 ds_read_b128 v[28:31], v16 offset:24576
 ds_read_b128 v[32:35], v16 offset:25600
 ds_read_b128 v[64:67], v16 offset:27648
 ds_read_b128 v[68:71], v16 offset:28672
 ds_read_b128 v[72:75], v16 offset:30720
 ds_read_b128 v[76:79], v16 offset:31744
 s_nop 0
 s_mov_b64 exec, s[74:75]
 v_cvt_pk_f16_f32 v44, v40, v41
 v_cvt_pk_f16_f32 v45, v42, v43
 v_and_or_b32 v44, v44, -2, s88
 s_cmp_eq_u32 s53, 1
 s_cbranch_scc1 si_92
 buffer_store_dwordx2 v[44:45], v7, s[8:11], s81 offen sc1
 s_branch si_93
si_92:
 buffer_store_dwordx2 v[44:45], v7, s[8:11], s81 offen
si_93:
 s_mov_b64 exec, -1
 s_branch bw_90
bw_91:
 s_lshr_b32 s21, 4, s20
 s_bitcmp1_b32 s21, 0
 s_cbranch_scc0 bw_94
 ds_read_b64_tr_b16 v[40:41], v6 offset:0
 ds_read_b64_tr_b16 v[42:43], v6 offset:1920
 ds_read_b64_tr_b16 v[44:45], v6 offset:3840
 ds_read_b64_tr_b16 v[46:47], v6 offset:5760
 ds_read_b64_tr_b16 v[48:49], v6 offset:640
 ds_read_b64_tr_b16 v[50:51], v6 offset:2560
 ds_read_b64_tr_b16 v[52:53], v6 offset:4480
 ds_read_b64_tr_b16 v[54:55], v6 offset:6400
 ds_read_b64_tr_b16 v[56:57], v6 offset:1280
 ds_read_b64_tr_b16 v[58:59], v6 offset:3200
 ds_read_b64_tr_b16 v[60:61], v6 offset:5120
 ds_read_b64_tr_b16 v[62:63], v6 offset:7040
 s_waitcnt lgkmcnt(8)
 v_pk_add_f16 v40, v40, v42
 v_pk_add_f16 v44, v44, v46
 v_pk_add_f16 v41, v41, v43
 v_pk_add_f16 v45, v45, v47
 v_fma_mix_f32 v146, v40, 1.0, v44 op_sel:[0,0,0] op_sel_hi:[1,0,1]
 v_fma_mix_f32 v147, v40, 1.0, v44 op_sel:[1,0,1] op_sel_hi:[1,0,1]
 v_fma_mix_f32 v148, v41, 1.0, v45 op_sel:[0,0,0] op_sel_hi:[1,0,1]
 v_fma_mix_f32 v149, v41, 1.0, v45 op_sel:[1,0,1] op_sel_hi:[1,0,1]
 v_cvt_pk_bf16_f32 v118, v146, v147
 v_cvt_pk_bf16_f32 v119, v148, v149
 s_waitcnt lgkmcnt(4)
 v_pk_add_f16 v48, v48, v50
 v_pk_add_f16 v52, v52, v54
 v_pk_add_f16 v49, v49, v51
 v_pk_add_f16 v53, v53, v55
 v_fma_mix_f32 v146, v48, 1.0, v52 op_sel:[0,0,0] op_sel_hi:[1,0,1]
 v_fma_mix_f32 v147, v48, 1.0, v52 op_sel:[1,0,1] op_sel_hi:[1,0,1]
 v_fma_mix_f32 v148, v49, 1.0, v53 op_sel:[0,0,0] op_sel_hi:[1,0,1]
 v_fma_mix_f32 v149, v49, 1.0, v53 op_sel:[1,0,1] op_sel_hi:[1,0,1]
 v_cvt_pk_bf16_f32 v120, v146, v147
 v_cvt_pk_bf16_f32 v121, v148, v149
 s_waitcnt lgkmcnt(0)
 v_pk_add_f16 v56, v56, v58
 v_pk_add_f16 v60, v60, v62
 v_pk_add_f16 v57, v57, v59
 v_pk_add_f16 v61, v61, v63
 v_fma_mix_f32 v146, v56, 1.0, v60 op_sel:[0,0,0] op_sel_hi:[1,0,1]
 v_fma_mix_f32 v147, v56, 1.0, v60 op_sel:[1,0,1] op_sel_hi:[1,0,1]
 v_mfma_f32_16x16x32_bf16 v[40:43], v[118:121], v[118:121], 0
 v_fma_mix_f32 v148, v57, 1.0, v61 op_sel:[0,0,0] op_sel_hi:[1,0,1]
 v_fma_mix_f32 v149, v57, 1.0, v61 op_sel:[1,0,1] op_sel_hi:[1,0,1]
 v_cvt_pk_bf16_f32 v122, v146, v147
 v_cvt_pk_bf16_f32 v123, v148, v149
 s_nop 1
 v_mfma_f32_16x16x32_bf16 v[40:43], v[122:125], v[122:125], v[40:43]
 ds_read_b128 v[28:31], v16 offset:24576
 ds_read_b128 v[32:35], v16 offset:25600
 ds_read_b128 v[64:67], v16 offset:27648
 ds_read_b128 v[68:71], v16 offset:28672
 ds_read_b128 v[72:75], v16 offset:30720
 ds_read_b128 v[76:79], v16 offset:31744
 s_nop 0
 s_mov_b64 exec, s[74:75]
 v_cvt_pk_f16_f32 v44, v40, v41
 v_cvt_pk_f16_f32 v45, v42, v43
 v_and_or_b32 v44, v44, -2, s88
 s_cmp_eq_u32 s53, 1
 s_cbranch_scc1 si_95
 buffer_store_dwordx2 v[44:45], v7, s[8:11], s81 offen sc1
 s_branch si_96
si_95:
 buffer_store_dwordx2 v[44:45], v7, s[8:11], s81 offen
si_96:
 s_mov_b64 exec, -1
 s_branch bw_90
bw_94:
 s_lshr_b32 s21, 8, s20
 s_bitcmp1_b32 s21, 0
 s_cbranch_scc0 bw_97
 ds_read_b128 v[28:31], v16 offset:24576
 ds_read_b128 v[32:35], v16 offset:25600
 ds_read_b128 v[64:67], v16 offset:27648
 ds_read_b128 v[68:71], v16 offset:28672
 ds_read_b128 v[72:75], v16 offset:30720
 ds_read_b128 v[76:79], v16 offset:31744
 s_branch bw_90
bw_97:
bw_90:
 ds_read_b128 v[80:83], v16 offset:33792
 ds_read_b128 v[84:87], v16 offset:34816
 ds_read_b64 v[88:89], v16 offset:26624
 ds_read_b64 v[90:91], v16 offset:29696
 ds_read_b64 v[92:93], v16 offset:32768
 ds_read_b64 v[94:95], v16 offset:35840
 s_cmp_eq_u32 s52, 63
 s_cbranch_scc1 last_84
 s_waitcnt lgkmcnt(10)
 v_smfmac_f32_16x16x64_f16 v[100:103], v[28:31], a[120:127], v25
 v_smfmac_f32_16x16x64_f16 v[104:107], v[28:31], a[128:135], v25
 v_smfmac_f32_16x16x64_f16 v[108:111], v[28:31], a[136:143], v25
 s_mov_b32 s54, 0
 v_smfmac_f32_16x16x64_f16 v[100:103], v[32:35], a[144:151], v25
 v_readfirstlane_b32 s21, v0
 v_smfmac_f32_16x16x64_f16 v[104:107], v[32:35], a[152:159], v25
 s_add_u32 s22, s46, 3
 v_smfmac_f32_16x16x64_f16 v[108:111], v[32:35], a[160:167], v25
 s_min_u32 s22, s22, 64
 s_waitcnt lgkmcnt(7)
 v_smfmac_f32_16x16x64_f16 v[100:103], v[64:67], a[168:175], v25
 s_sub_u32 s55, s21, s22
 v_smfmac_f32_16x16x64_f16 v[104:107], v[64:67], a[176:183], v25
 s_sub_u32 s56, s21, s46
 v_smfmac_f32_16x16x64_f16 v[108:111], v[64:67], a[184:191], v25
 v_smfmac_f32_16x16x64_f16 v[100:103], v[68:71], a[192:199], v25
 v_smfmac_f32_16x16x64_f16 v[104:107], v[68:71], a[200:207], v25
 v_smfmac_f32_16x16x64_f16 v[108:111], v[68:71], a[208:215], v25
 v_smfmac_f32_16x16x64_f16 v[100:103], v[72:75], a[216:223], v25
 v_smfmac_f32_16x16x64_f16 v[104:107], v[72:75], a[224:231], v25
 v_smfmac_f32_16x16x64_f16 v[108:111], v[72:75], a[232:239], v25
 s_waitcnt lgkmcnt(4)
 v_smfmac_f32_16x16x64_f16 v[100:103], v[76:79], a[240:247], v25
 v_smfmac_f32_16x16x64_f16 v[104:107], v[76:79], a[248:255], v25
 v_smfmac_f32_16x16x64_f16 v[108:111], v[76:79], v[152:159], v25
 v_smfmac_f32_16x16x64_f16 v[100:103], v[80:83], v[160:167], v25
 v_smfmac_f32_16x16x64_f16 v[104:107], v[80:83], v[168:175], v25
 v_smfmac_f32_16x16x64_f16 v[108:111], v[80:83], v[176:183], v25
 v_smfmac_f32_16x16x64_f16 v[100:103], v[84:87], v[184:191], v25
 v_smfmac_f32_16x16x64_f16 v[104:107], v[84:87], v[192:199], v25
 v_smfmac_f32_16x16x64_f16 v[108:111], v[84:87], v[200:207], v25
 s_waitcnt lgkmcnt(0)
 v_smfmac_f32_16x16x64_f16 v[100:103], v[88:91], v[208:215], v25
 v_smfmac_f32_16x16x64_f16 v[104:107], v[88:91], v[216:223], v25
 v_smfmac_f32_16x16x64_f16 v[108:111], v[88:91], v[224:231], v25
 v_smfmac_f32_16x16x64_f16 v[100:103], v[92:95], v[232:239], v25
 v_smfmac_f32_16x16x64_f16 v[104:107], v[92:95], v[240:247], v25
 v_smfmac_f32_16x16x64_f16 v[108:111], v[92:95], v[248:255], v25
 buffer_load_dwordx2 v[58:59], v9, s[8:11], s81 offen sc1
 buffer_load_dwordx4 v[40:43], v8, s[8:11], s81 offen offset:0 sc1
 buffer_load_dwordx4 v[44:47], v8, s[8:11], s81 offen offset:1024 sc1
 s_cmp_lt_i32 s56, 0
 s_cbranch_scc1 kvw_100
kvok_101:
 s_waitcnt vmcnt(2)
 v_xor_b32 v76, s88, v58
 s_nop 0
 v_permlane16_swap_b32 v58, v59
 v_fma_mix_f32 v60, v58, 1.0, v59 op_sel:[0,0,0] op_sel_hi:[1,0,1]
 v_fma_mix_f32 v61, v58, 1.0, v59 op_sel:[1,0,1] op_sel_hi:[1,0,1]
 v_mov_b32 v58, v60
 v_mov_b32 v59, v61
 s_nop 0
 v_permlane32_swap_b32 v58, v60
 v_permlane32_swap_b32 v59, v61
 v_add_f32 v52, v58, v60
 v_add_f32 v53, v59, v61
 v_max_f32 v79, v52, v53
 s_waitcnt vmcnt(0)
 v_pk_add_f16 v80, v40, v44
 v_pk_add_f16 v82, v42, v46
 v_pk_add_f16 v81, v41, v45
 v_pk_add_f16 v83, v43, v47
 v_permlane32_swap_b32 v80, v82
 v_bitop3_b32 v77, v40, v42, s88 bitop3:0x7e
 v_permlane32_swap_b32 v81, v83
 v_bitop3_b32 v78, v44, v46, s88 bitop3:0x7e
 v_fma_mix_f32 v48, v80, 1.0, v82 op_sel:[0,0,0] op_sel_hi:[1,0,1]
 v_or3_b32 v27, v76, v77, v78
 v_fma_mix_f32 v49, v80, 1.0, v82 op_sel:[1,0,1] op_sel_hi:[1,0,1]
 v_and_b32 v27, 1, v27
 v_fma_mix_f32 v50, v81, 1.0, v83 op_sel:[0,0,0] op_sel_hi:[1,0,1]
 v_cmp_ne_u32 vcc, 0, v27
 v_fma_mix_f32 v51, v81, 1.0, v83 op_sel:[1,0,1] op_sel_hi:[1,0,1]
 v_max3_f32 v62, v48, v49, v79
 s_cbranch_vccnz psr_98
psj_99:
 v_max3_f32 v62, v62, v50, v51
 v_cvt_pk_bf16_f32 v146, v100, v101
 v_cvt_pk_bf16_f32 v147, v102, v103
 v_max_f32_dpp v62, v62, v62 row_ror:8 row_mask:0xf bank_mask:0xf
 v_mov_b32 v63, v62
 v_cvt_pk_bf16_f32 v148, v104, v105
 v_cvt_pk_bf16_f32 v149, v106, v107
 v_permlane32_swap_b32 v62, v63
 v_max_f32 v62, v62, v63
 v_mov_b32 v63, v62
 v_cvt_pk_bf16_f32 v150, v108, v109
 v_cvt_pk_bf16_f32 v151, v110, v111
 v_permlane16_swap_b32 v62, v63
 v_max_f32 v62, v62, v63
 v_mul_f32 v62, s86, v62
 v_fma_f32 v48, v48, s86, -v62
 v_fma_f32 v49, v49, s86, -v62
 v_fma_f32 v50, v50, s86, -v62
 v_fma_f32 v51, v51, s86, -v62
 v_fma_f32 v52, v52, s86, -v62
 v_fma_f32 v53, v53, s86, -v62
 v_exp_f32 v48, v48
 v_exp_f32 v49, v49
 buffer_load_dwordx4 v[88:91], v17, s[28:31], s64 offen offset:0 sc1
 v_exp_f32 v50, v50
 v_exp_f32 v51, v51
 buffer_load_dwordx4 v[92:95], v16, s[28:31], s64 offen offset:1024 sc1
 v_exp_f32 v52, v52
 v_exp_f32 v53, v53
 buffer_load_dwordx4 v[96:99], v20, s[28:31], s64 offen offset:2048 sc1
 v_cvt_pk_bf16_f32 v138, v48, v49
 v_cvt_pk_bf16_f32 v139, v50, v51
 v_cvt_pk_bf16_f32 v142, v52, v53
 v_mov_b32_dpp v140, v138 row_ror:8 row_mask:0xf bank_mask:0xf
 v_mov_b32_dpp v141, v139 row_ror:8 row_mask:0xf bank_mask:0xf
 v_mov_b32_dpp v143, v142 row_ror:8 row_mask:0xf bank_mask:0xf
 s_lshr_b32 s21, 3, s20
 s_bitcmp1_b32 s21, 0
 s_cbranch_scc0 bw_103
 buffer_load_dwordx4 v[112:115], v18, s[16:19], s80 offen sc1
 s_branch bw_102
bw_103:
 s_lshr_b32 s21, 8, s20
 s_bitcmp1_b32 s21, 0
 s_cbranch_scc0 bw_104
 v_mov_b32 v84, s67
 v_mov_b32 v85, s67
 s_mov_b64 exec, 15
 buffer_store_dwordx2 v[84:85], v24, s[12:15], s66 offen sc1
 s_mov_b64 exec, -1
 s_branch bw_102
bw_104:
bw_102:
 v_add_f32 v54, v48, v49
 v_mfma_f32_16x16x32_bf16 v[64:67], v[126:129], v[138:141], 0
 v_add_f32 v55, v50, v51
 v_add_f32 v56, v52, v53
 v_mfma_f32_16x16x32_bf16 v[64:67], v[146:149], v[142:145], v[64:67]
 v_add_f32 v62, v54, v55
 v_fmac_f32 v62, v56, v26
 v_mfma_f32_16x16x32_bf16 v[68:71], v[130:133], v[138:141], 0
 s_lshr_b32 s21, 3, s20
 s_bitcmp1_b32 s21, 0
 s_cbranch_scc0 bw_106
 buffer_load_dwordx2 v[116:117], v19, s[16:19], s80 offen sc1
 s_branch bw_105
bw_106:
bw_105:
 v_add_f32_dpp v62, v62, v62 row_ror:8 row_mask:0xf bank_mask:0xf
 v_mfma_f32_16x16x32_bf16 v[68:71], v[148:151], v[142:145], v[68:71]
 v_mov_b32 v63, v62
 s_cmp_lt_i32 s55, 0
 s_cbranch_scc1 fl_107
fl_108:
 v_mfma_f32_16x16x32_bf16 v[72:75], v[134:137], v[138:141], 0
 v_permlane32_swap_b32 v62, v63
 v_mfma_f32_16x16x32_bf16 v[72:75], v[150:153], v[142:145], v[72:75]
 v_add_f32 v62, v62, v63
 v_mov_b32 v63, v62
 ds_write_b128 v11, v[64:67] offset:0
 s_nop 0
 v_permlane16_swap_b32 v62, v63
 v_add_f32 v62, v62, v63
 v_rcp_f32 v62, v62
 ds_write_b128 v11, v[68:71] offset:1024
 s_mov_b64 exec, 0xff
 ds_write_b32 v22, v62
 s_mov_b64 exec, -1
 ds_write_b128 v11, v[72:75] offset:2048
 s_waitcnt lgkmcnt(0)
 s_barrier
 s_lshr_b32 s21, 7, s20
 s_bitcmp1_b32 s21, 0
 s_cbranch_scc0 bw_110
 ds_read_b128 v[72:75], v23
 ds_read_b64 v[64:65], v12 offset:0
 ds_read_b64 v[66:67], v12 offset:3072
 ds_read_b64 v[68:69], v12 offset:6144
 ds_read_b64 v[70:71], v12 offset:9216
 s_waitcnt lgkmcnt(2)
 v_pk_mul_f32 v[64:65], v[64:65], v[72:73] op_sel_hi:[1,0]
 v_pk_fma_f32 v[64:65], v[66:67], v[72:73], v[64:65] op_sel:[0,1,0] op_sel_hi:[1,1,1]
 s_waitcnt lgkmcnt(0)
 v_pk_fma_f32 v[64:65], v[68:69], v[74:75], v[64:65] op_sel_hi:[1,0,1]
 v_pk_fma_f32 v[64:65], v[70:71], v[74:75], v[64:65] op_sel:[0,1,0] op_sel_hi:[1,1,1]
 v_cvt_pk_f16_f32 v68, v64, v65
 v_perm_b32 v68, s91, v68, v14
 buffer_atomic_pk_add_f16 v68, v13, s[4:7], s3 offen
 s_branch bw_109
bw_110:
 s_lshr_b32 s21, 8, s20
 s_bitcmp1_b32 s21, 0
 s_cbranch_scc0 bw_111
 s_and_b32 s21, s52, 7
 s_cmp_lg_u32 s21, s50
 s_cbranch_scc1 zm_112
 v_mov_b32 v64, 0
 v_mov_b32 v65, 0
 v_mov_b32 v66, 0
 v_mov_b32 v67, 0
 s_mov_b64 exec, s[70:71]
 buffer_store_dwordx4 v[64:67], v13, s[4:7], s83 offen sc1
 s_mov_b64 exec, -1
zm_112:
 s_branch bw_109
bw_111:
bw_109:
 s_lshr_b32 s21, 4, s20
 s_bitcmp1_b32 s21, 0
 s_cbranch_scc0 bw_114
 s_mov_b64 exec, s[62:63]
 buffer_store_dwordx4 v[118:121], v18, s[24:27], s85 offen sc1
 buffer_store_dwordx2 v[122:123], v19, s[24:27], s85 offen sc1
 s_mov_b64 exec, -1
 s_branch bw_113
bw_114:
bw_113:
 v_mov_b32 v76, v108
 v_mov_b32 v77, v109
 v_mov_b32 v78, v110
 v_mov_b32 v79, v111
 v_permlane32_swap_b32 v100, v104
 v_permlane32_swap_b32 v101, v105
 v_permlane32_swap_b32 v102, v106
 v_permlane32_swap_b32 v103, v107
 v_permlane32_swap_b32 v108, v76
 v_permlane32_swap_b32 v109, v77
 v_permlane32_swap_b32 v110, v78
 v_permlane32_swap_b32 v111, v79
 v_pk_add_f32 v[100:101], v[100:101], v[104:105]
 v_pk_add_f32 v[102:103], v[102:103], v[106:107]
 v_pk_add_f32 v[108:109], v[108:109], v[76:77]
 v_pk_add_f32 v[110:111], v[110:111], v[78:79]
 v_cvt_pk_bf16_f32 v80, v100, v101
 v_cvt_pk_bf16_f32 v82, v108, v109
 v_cvt_pk_bf16_f32 v81, v102, v103
 v_cvt_pk_bf16_f32 v83, v110, v111
 s_nop 0
 v_permlane16_swap_b32 v80, v82
 v_permlane16_swap_b32 v81, v83
 v_min_u32 v80, -2, v80
 s_mov_b64 exec, s[76:77]
 buffer_store_dwordx4 v[80:83], v15, s[24:27], s57 offen sc1
 s_mov_b64 exec, -1
 s_add_u32 s64, s64, 1310720
 s_add_u32 s52, s52, 1
 s_branch step_83
fl_88:
 buffer_load_dword v0, off, s[12:15], s79 sc1
 s_branch fl_89
A1_17:
 v_smfmac_f32_16x16x32_f16 v[40:43], v[36:37], a[16:19], v25
 v_smfmac_f32_16x16x32_f16 v[52:55], v[36:37], a[76:79], v25
 v_smfmac_f32_16x16x32_f16 v[44:47], v[36:37], a[36:39], v25
 v_smfmac_f32_16x16x32_f16 v[56:59], v[36:37], a[96:99], v25
 s_branch A2_87
pm_86:
 buffer_load_dwordx4 v[36:39], v4, s[4:7], s84 offen offset:2048 sc1
 buffer_load_dwordx4 v[28:31], v4, s[4:7], s84 offen offset:0 sc1
 buffer_load_dwordx4 v[32:35], v4, s[4:7], s84 offen offset:1024 sc1
 s_nop 7
 v_mov_b32 v40, 0
 v_mov_b32 v41, 0
 v_mov_b32 v42, 0
 v_mov_b32 v43, 0
 v_mov_b32 v52, 0
 v_mov_b32 v53, 0
 v_mov_b32 v54, 0
 v_mov_b32 v55, 0
 v_mov_b32 v44, 0
 v_mov_b32 v45, 0
 v_mov_b32 v46, 0
 v_mov_b32 v47, 0
 v_mov_b32 v56, 0
 v_mov_b32 v57, 0
 v_mov_b32 v58, 0
 v_mov_b32 v59, 0
 s_waitcnt vmcnt(0)
 v_bitop3_b32 v27, v31, v35, v39 bitop3:0x80
 v_perm_b32 v31, v35, v31, s89
 v_cmp_gt_u32 vcc, 0x48000000, v27
 v_mov_b32 v35, v38
 s_cbranch_vccz A1_17
pm_85:
 s_cmp_gt_u32 s52, 3
 s_cbranch_scc1 op_115
 v_readfirstlane_b32 s21, v0
 s_cmp_ge_u32 s21, s46
 s_cbranch_scc1 op_115
 buffer_load_dword v0, off, s[12:15], s79 sc1
 s_waitcnt vmcnt(0)
 v_readfirstlane_b32 s21, v0
 s_cmp_gt_u32 s21, s52
 s_cselect_b32 s21, s87, 0
 s_cmp_eq_u32 s21, 0
 s_cbranch_scc1 op_115
 s_mov_b32 s87, 0
 s_sub_u32 s21, s64, 1310720
 buffer_load_dwordx4 v[126:129], v16, s[28:31], s21 offen offset:0 sc1
 buffer_load_dwordx4 v[130:133], v16, s[28:31], s21 offen offset:1024 sc1
 buffer_load_dwordx4 v[134:137], v16, s[28:31], s21 offen offset:2048 sc1
op_115:
 buffer_load_dwordx4 v[36:39], v4, s[4:7], s84 offen offset:2048 sc1
 buffer_load_dwordx4 v[28:31], v4, s[4:7], s84 offen offset:0 sc1
 buffer_load_dwordx4 v[32:35], v4, s[4:7], s84 offen offset:1024 sc1
 s_add_u32 s54, s54, 1
 s_cmp_gt_u32 s54, 131072
 s_cbranch_scc1 end0
 s_waitcnt vmcnt(0)
 v_bitop3_b32 v27, v31, v35, v39 bitop3:0x80
 v_perm_b32 v31, v35, v31, s89
 v_cmp_gt_u32 vcc, 0x48000000, v27
 v_mov_b32 v35, v38
 s_cbranch_vccnz pm_85
 s_branch A1_17
psr_98:
 buffer_load_dwordx2 v[58:59], v9, s[8:11], s81 offen sc1
 buffer_load_dwordx4 v[40:43], v8, s[8:11], s81 offen offset:0 sc1
 buffer_load_dwordx4 v[44:47], v8, s[8:11], s81 offen offset:1024 sc1
 s_add_u32 s54, s54, 1
 s_cmp_gt_u32 s54, 131072
 s_cbranch_scc1 end0
 s_waitcnt vmcnt(2)
 v_xor_b32 v76, s88, v58
 s_nop 0
 v_permlane16_swap_b32 v58, v59
 v_fma_mix_f32 v60, v58, 1.0, v59 op_sel:[0,0,0] op_sel_hi:[1,0,1]
 v_fma_mix_f32 v61, v58, 1.0, v59 op_sel:[1,0,1] op_sel_hi:[1,0,1]
 v_mov_b32 v58, v60
 v_mov_b32 v59, v61
 s_nop 0
 v_permlane32_swap_b32 v58, v60
 v_permlane32_swap_b32 v59, v61
 v_add_f32 v52, v58, v60
 v_add_f32 v53, v59, v61
 v_max_f32 v79, v52, v53
 s_waitcnt vmcnt(0)
 v_pk_add_f16 v80, v40, v44
 v_pk_add_f16 v82, v42, v46
 v_pk_add_f16 v81, v41, v45
 v_pk_add_f16 v83, v43, v47
 v_permlane32_swap_b32 v80, v82
 v_bitop3_b32 v77, v40, v42, s88 bitop3:0x7e
 v_permlane32_swap_b32 v81, v83
 v_bitop3_b32 v78, v44, v46, s88 bitop3:0x7e
 v_fma_mix_f32 v48, v80, 1.0, v82 op_sel:[0,0,0] op_sel_hi:[1,0,1]
 v_or3_b32 v27, v76, v77, v78
 v_fma_mix_f32 v49, v80, 1.0, v82 op_sel:[1,0,1] op_sel_hi:[1,0,1]
 v_and_b32 v27, 1, v27
 v_fma_mix_f32 v50, v81, 1.0, v83 op_sel:[0,0,0] op_sel_hi:[1,0,1]
 v_cmp_ne_u32 vcc, 0, v27
 v_fma_mix_f32 v51, v81, 1.0, v83 op_sel:[1,0,1] op_sel_hi:[1,0,1]
 v_max3_f32 v62, v48, v49, v79
 s_cbranch_vccnz psr_98
 s_branch psj_99
kvw_100:
 s_mov_b32 s22, s87
 s_cmp_eq_u32 s52, 0
 s_cselect_b32 s55, 0, s55
 s_cselect_b32 s87, 1, 0
 s_cbranch_scc1 kvok_101
 v_mov_b32 v62, 0
 s_mov_b32 s101, 0
wf_116:
 buffer_load_dword v63, v62, s[12:15], s79 offen sc1
 s_add_u32 s101, s101, 1
 s_cmp_gt_u32 s101, 131072
 s_cbranch_scc1 end0
 s_waitcnt vmcnt(0)
 v_readfirstlane_b32 s100, v63
 s_cmp_ge_u32 s100, s46
 s_cbranch_scc1 wf_117
 s_sleep 3
 s_branch wf_116
wf_117:
 s_cmp_eq_u32 s22, 0
 s_cbranch_scc1 kvok_101
 s_sub_u32 s21, s64, 1310720
 buffer_load_dwordx4 v[126:129], v16, s[28:31], s21 offen offset:0 sc1
 buffer_load_dwordx4 v[130:133], v16, s[28:31], s21 offen offset:1024 sc1
 buffer_load_dwordx4 v[134:137], v16, s[28:31], s21 offen offset:2048 sc1
 s_waitcnt vmcnt(0)
 s_branch kvok_101
fl_107:
 buffer_load_dword v0, off, s[12:15], s79 sc1
 s_branch fl_108
last_84:
 s_lshr_b32 s21, 4, s20
 s_bitcmp1_b32 s21, 0
 s_cbranch_scc0 bw_119
 s_mov_b64 exec, s[62:63]
 buffer_store_dwordx4 v[118:121], v18, s[24:27], s85 offen sc1
 buffer_store_dwordx2 v[122:123], v19, s[24:27], s85 offen sc1
 s_mov_b64 exec, -1
 s_branch bw_118
bw_119:
bw_118:
 s_waitcnt lgkmcnt(10)
 v_smfmac_f32_16x16x64_f16 v[100:103], v[28:31], a[120:127], v25
 v_smfmac_f32_16x16x64_f16 v[104:107], v[28:31], a[128:135], v25
 v_smfmac_f32_16x16x64_f16 v[108:111], v[28:31], a[136:143], v25
 v_smfmac_f32_16x16x64_f16 v[100:103], v[32:35], a[144:151], v25
 v_smfmac_f32_16x16x64_f16 v[104:107], v[32:35], a[152:159], v25
 v_smfmac_f32_16x16x64_f16 v[108:111], v[32:35], a[160:167], v25
 s_waitcnt lgkmcnt(7)
 v_smfmac_f32_16x16x64_f16 v[100:103], v[64:67], a[168:175], v25
 v_smfmac_f32_16x16x64_f16 v[104:107], v[64:67], a[176:183], v25
 v_smfmac_f32_16x16x64_f16 v[108:111], v[64:67], a[184:191], v25
 v_smfmac_f32_16x16x64_f16 v[100:103], v[68:71], a[192:199], v25
 v_smfmac_f32_16x16x64_f16 v[104:107], v[68:71], a[200:207], v25
 v_smfmac_f32_16x16x64_f16 v[108:111], v[68:71], a[208:215], v25
 v_smfmac_f32_16x16x64_f16 v[100:103], v[72:75], a[216:223], v25
 v_smfmac_f32_16x16x64_f16 v[104:107], v[72:75], a[224:231], v25
 v_smfmac_f32_16x16x64_f16 v[108:111], v[72:75], a[232:239], v25
 s_waitcnt lgkmcnt(4)
 v_smfmac_f32_16x16x64_f16 v[100:103], v[76:79], a[240:247], v25
 v_smfmac_f32_16x16x64_f16 v[104:107], v[76:79], a[248:255], v25
 v_smfmac_f32_16x16x64_f16 v[108:111], v[76:79], v[152:159], v25
 v_smfmac_f32_16x16x64_f16 v[100:103], v[80:83], v[160:167], v25
 v_smfmac_f32_16x16x64_f16 v[104:107], v[80:83], v[168:175], v25
 v_smfmac_f32_16x16x64_f16 v[108:111], v[80:83], v[176:183], v25
 v_smfmac_f32_16x16x64_f16 v[100:103], v[84:87], v[184:191], v25
 v_smfmac_f32_16x16x64_f16 v[104:107], v[84:87], v[192:199], v25
 v_smfmac_f32_16x16x64_f16 v[108:111], v[84:87], v[200:207], v25
 s_waitcnt lgkmcnt(0)
 v_smfmac_f32_16x16x64_f16 v[100:103], v[88:91], v[208:215], v25
 v_smfmac_f32_16x16x64_f16 v[104:107], v[88:91], v[216:223], v25
 v_smfmac_f32_16x16x64_f16 v[108:111], v[88:91], v[224:231], v25
 v_smfmac_f32_16x16x64_f16 v[100:103], v[92:95], v[232:239], v25
 v_smfmac_f32_16x16x64_f16 v[104:107], v[92:95], v[240:247], v25
 v_smfmac_f32_16x16x64_f16 v[108:111], v[92:95], v[248:255], v25
 s_nop 7
 v_mov_b32 v76, v108
 v_mov_b32 v77, v109
 v_mov_b32 v78, v110
 v_mov_b32 v79, v111
 v_permlane32_swap_b32 v100, v104
 v_permlane32_swap_b32 v101, v105
 v_permlane32_swap_b32 v102, v106
 v_permlane32_swap_b32 v103, v107
 v_permlane32_swap_b32 v108, v76
 v_permlane32_swap_b32 v109, v77
 v_permlane32_swap_b32 v110, v78
 v_permlane32_swap_b32 v111, v79
 v_pk_add_f32 v[100:101], v[100:101], v[104:105]
 v_pk_add_f32 v[102:103], v[102:103], v[106:107]
 v_pk_add_f32 v[108:109], v[108:109], v[76:77]
 v_pk_add_f32 v[110:111], v[110:111], v[78:79]
 v_cvt_pk_bf16_f32 v80, v100, v101
 v_cvt_pk_bf16_f32 v82, v108, v109
 v_cvt_pk_bf16_f32 v81, v102, v103
 v_cvt_pk_bf16_f32 v83, v110, v111
 s_nop 0
 v_permlane16_swap_b32 v80, v82
 v_permlane16_swap_b32 v81, v83
 v_min_u32 v80, -2, v80
 s_mov_b64 exec, s[76:77]
 buffer_store_dwordx4 v[80:83], v15, s[24:27], s57 offen sc1
 s_mov_b64 exec, -1
 s_lshr_b32 s21, 1, s20
 s_bitcmp1_b32 s21, 0
 s_cbranch_scc0 bw_121
 v_mov_b32 v246, 80
 v_mov_b32 v247, 1
 s_mov_b64 exec, 1
 buffer_atomic_add v247, v246, s[32:35], 0 offen sc0 sc1
 s_mov_b64 exec, -1
 s_branch bw_120
bw_121:
bw_120:
 s_branch chain_done
chain_done:
 s_waitcnt vmcnt(0) lgkmcnt(0)
 s_barrier
 s_mov_b32 s84, 0
 s_mov_b32 s85, -1
 s_mov_b32 s86, 0
 v_mov_b32 v21, 0
 v_mov_b32 v23, v247
 s_cmp_lg_u32 s20, 0
 s_cbranch_scc1 queue_b
 s_mov_b64 exec, 1
 s_branch queue_a
end0:
 s_endpgm
gemm_side:
 s_bfe_u32 s23, s22, 0x20005
 s_add_u32 s22, s22, 31
 s_and_b32 s22, s22, 31
 s_lshl_b32 s21, s23, 3
 s_add_u32 s2, s21, s22
 s_add_u32 s3, s2, 72
 s_add_u32 s24, s2, 48
 s_add_u32 s2, s2, s21
 s_cmp_lt_u32 s22, 24
 s_cselect_b32 s3, s24, s3
 s_cmp_lt_u32 s22, 16
 s_cselect_b32 s3, s2, s3
 s_mov_b32 s2, s3
gemm_roles:
 s_cmp_ge_u32 s3, 64
 s_cbranch_scc1 not_kv
 s_load_dwordx2 s[4:5], s[0:1], 0
 s_load_dwordx2 s[6:7], s[0:1], 24
 s_load_dwordx2 s[36:37], s[0:1], 32
 s_load_dwordx2 s[38:39], s[0:1], 104
 s_and_b32 s43, s3, 1
 s_bfe_u32 s42, s3, 0x50001
 s_lshr_b32 s40, s42, 2
 s_waitcnt lgkmcnt(0)
 s_cmp_eq_u32 s43, 1
 s_cselect_b32 s6, s36, s6
 s_cselect_b32 s7, s37, s7
 s_mov_b32 s8, s4
 s_mov_b32 s9, s5
 s_mov_b32 s10, 2621440
 s_mov_b32 s11, 0x00020000
 s_mov_b32 s12, s6
 s_mov_b32 s13, s7
 s_mov_b32 s14, 7864320
 s_mov_b32 s15, 0x00020000
 s_mov_b32 s16, s38
 s_mov_b32 s17, s39
 s_mov_b32 s18, 50331648
 s_mov_b32 s19, 0x00020000
 s_mul_i32 s44, s42, 384
 s_mov_b32 s62, 1024
 s_mov_b32 s24, 0
 s_mov_b32 s25, 81920
 s_mov_b32 s64, s32
 s_mov_b32 s65, s33
 s_mov_b32 s66, s34
 s_mov_b32 s67, s35
 s_load_dwordx2 s[72:73], s[0:1], 104
 s_waitcnt lgkmcnt(0)
 s_add_u32 s72, s72, 81068032
 s_addc_u32 s73, s73, 0
 s_mov_b32 s74, 129024
 s_mov_b32 s75, 0x00020000
 v_mov_b32 v9, 2731
 v_add_u32 v8, 0, v1
 v_mul_u32_u24 v7, v8, v9
 v_lshrrev_b32 v7, 16, v7
 v_mul_u32_u24 v4, 24, v7
 v_sub_u32 v8, v8, v4
 v_and_b32 v4, 2, v7
 v_xor_b32 v8, v8, v4
 v_xor_b32 v5, 4, v8
 s_mov_b32 s21, 12288
 v_mul_lo_u32 v7, v7, s21
 v_lshl_add_u32 v40, v8, 4, v7
 v_lshl_add_u32 v43, v5, 4, v7
 v_add_u32 v8, 64, v1
 v_mul_u32_u24 v7, v8, v9
 v_lshrrev_b32 v7, 16, v7
 v_mul_u32_u24 v4, 24, v7
 v_sub_u32 v8, v8, v4
 v_and_b32 v4, 2, v7
 v_xor_b32 v8, v8, v4
 v_xor_b32 v5, 4, v8
 s_mov_b32 s21, 12288
 v_mul_lo_u32 v7, v7, s21
 v_lshl_add_u32 v41, v8, 4, v7
 v_lshl_add_u32 v44, v5, 4, v7
 v_add_u32 v8, 128, v1
 v_mul_u32_u24 v7, v8, v9
 v_lshrrev_b32 v7, 16, v7
 v_mul_u32_u24 v4, 24, v7
 v_sub_u32 v8, v8, v4
 v_and_b32 v4, 2, v7
 v_xor_b32 v8, v8, v4
 v_xor_b32 v5, 4, v8
 s_mov_b32 s21, 12288
 v_mul_lo_u32 v7, v7, s21
 v_lshl_add_u32 v42, v8, 4, v7
 v_lshl_add_u32 v45, v5, 4, v7
 s_mul_i32 s21, s20, 393216
 s_add_u32 s21, s21, 0
 s_add_u32 s21, s21, s44
 s_mul_i32 s22, s20, 12288
 s_add_u32 s22, s22, 0
 s_add_u32 m0, s22, 0
 s_nop 0
 buffer_load_dwordx4 v40, s[12:15], s21 offen lds
 s_add_u32 m0, s22, 1024
 s_nop 0
 buffer_load_dwordx4 v41, s[12:15], s21 offen lds
 s_add_u32 m0, s22, 2048
 s_nop 0
 buffer_load_dwordx4 v42, s[12:15], s21 offen lds
 s_mul_i32 s21, s20, 393216
 s_add_u32 s21, s21, 98304
 s_add_u32 s21, s21, s44
 s_mul_i32 s22, s20, 12288
 s_add_u32 s22, s22, 3072
 s_add_u32 m0, s22, 0
 s_nop 0
 buffer_load_dwordx4 v43, s[12:15], s21 offen lds
 s_add_u32 m0, s22, 1024
 s_nop 0
 buffer_load_dwordx4 v44, s[12:15], s21 offen lds
 s_add_u32 m0, s22, 2048
 s_nop 0
 buffer_load_dwordx4 v45, s[12:15], s21 offen lds
 s_mul_i32 s21, s20, 393216
 s_add_u32 s21, s21, 196608
 s_add_u32 s21, s21, s44
 s_mul_i32 s22, s20, 12288
 s_add_u32 s22, s22, 6144
 s_add_u32 m0, s22, 0
 s_nop 0
 buffer_load_dwordx4 v40, s[12:15], s21 offen lds
 s_add_u32 m0, s22, 1024
 s_nop 0
 buffer_load_dwordx4 v41, s[12:15], s21 offen lds
 s_add_u32 m0, s22, 2048
 s_nop 0
 buffer_load_dwordx4 v42, s[12:15], s21 offen lds
 s_mul_i32 s21, s20, 393216
 s_add_u32 s21, s21, 294912
 s_add_u32 s21, s21, s44
 s_mul_i32 s22, s20, 12288
 s_add_u32 s22, s22, 9216
 s_add_u32 m0, s22, 0
 s_nop 0
 buffer_load_dwordx4 v43, s[12:15], s21 offen lds
 s_add_u32 m0, s22, 1024
 s_nop 0
 buffer_load_dwordx4 v44, s[12:15], s21 offen lds
 s_add_u32 m0, s22, 2048
 s_nop 0
 buffer_load_dwordx4 v45, s[12:15], s21 offen lds
 v_lshrrev_b32 v11, 3, v1
 v_and_b32 v12, 7, v1
 v_xor_b32 v12, v12, v11
 v_mul_u32_u24 v11, 1280, v11
 v_lshl_add_u32 v10, v12, 4, v11
 s_mul_i32 s46, s20, 20480
 v_add_u32 v10, s46, v10
 s_lshl_b32 s47, s20, 11
 s_add_u32 s47, s47, 98304
 s_add_u32 s46, s47, 57344
 s_mov_b32 s30, s24
 s_add_u32 s32, s47, 0
 v_add_u32 v11, 9216, v10
 s_mov_b32 m0, s32
 s_nop 0
 buffer_load_dwordx4 v10, s[8:11], s30 offen offset:0 lds
 buffer_load_dwordx4 v11, s[8:11], s30 offen offset:1024 lds
 s_add_u32 s30, s30, 128
 s_add_u32 s32, s32, 8192
 s_cmp_lt_u32 s32, s46
 s_cselect_b32 s32, s32, s47
 s_mov_b32 m0, s32
 s_nop 0
 buffer_load_dwordx4 v10, s[8:11], s30 offen offset:0 lds
 buffer_load_dwordx4 v11, s[8:11], s30 offen offset:1024 lds
 s_add_u32 s30, s30, 128
 s_add_u32 s32, s32, 8192
 s_cmp_lt_u32 s32, s46
 s_cselect_b32 s32, s32, s47
 s_mov_b32 m0, s32
 s_nop 0
 buffer_load_dwordx4 v10, s[8:11], s30 offen offset:0 lds
 buffer_load_dwordx4 v11, s[8:11], s30 offen offset:1024 lds
 s_add_u32 s30, s30, 128
 s_add_u32 s32, s32, 8192
 s_cmp_lt_u32 s32, s46
 s_cselect_b32 s32, s32, s47
 s_mov_b32 m0, s32
 s_nop 0
 buffer_load_dwordx4 v10, s[8:11], s30 offen offset:0 lds
 buffer_load_dwordx4 v11, s[8:11], s30 offen offset:1024 lds
 s_add_u32 s30, s30, 128
 s_add_u32 s32, s32, 8192
 s_cmp_lt_u32 s32, s46
 s_cselect_b32 s32, s32, s47
 s_mov_b32 m0, s32
 s_nop 0
 buffer_load_dwordx4 v10, s[8:11], s30 offen offset:0 lds
 buffer_load_dwordx4 v11, s[8:11], s30 offen offset:1024 lds
 s_add_u32 s30, s30, 128
 s_add_u32 s32, s32, 8192
 s_cmp_lt_u32 s32, s46
 s_cselect_b32 s32, s32, s47
 s_mul_i32 s21, s20, 393216
 s_add_u32 s21, s21, 1572864
 s_add_u32 s21, s21, s44
 s_mul_i32 s22, s20, 12288
 s_add_u32 s22, s22, 49152
 s_add_u32 m0, s22, 0
 s_nop 0
 buffer_load_dwordx4 v40, s[12:15], s21 offen lds
 s_add_u32 m0, s22, 1024
 s_nop 0
 buffer_load_dwordx4 v41, s[12:15], s21 offen lds
 s_add_u32 m0, s22, 2048
 s_nop 0
 buffer_load_dwordx4 v42, s[12:15], s21 offen lds
 s_mul_i32 s21, s20, 393216
 s_add_u32 s21, s21, 1671168
 s_add_u32 s21, s21, s44
 s_mul_i32 s22, s20, 12288
 s_add_u32 s22, s22, 52224
 s_add_u32 m0, s22, 0
 s_nop 0
 buffer_load_dwordx4 v43, s[12:15], s21 offen lds
 s_add_u32 m0, s22, 1024
 s_nop 0
 buffer_load_dwordx4 v44, s[12:15], s21 offen lds
 s_add_u32 m0, s22, 2048
 s_nop 0
 buffer_load_dwordx4 v45, s[12:15], s21 offen lds
 s_mul_i32 s21, s20, 393216
 s_add_u32 s21, s21, 1769472
 s_add_u32 s21, s21, s44
 s_mul_i32 s22, s20, 12288
 s_add_u32 s22, s22, 55296
 s_add_u32 m0, s22, 0
 s_nop 0
 buffer_load_dwordx4 v40, s[12:15], s21 offen lds
 s_add_u32 m0, s22, 1024
 s_nop 0
 buffer_load_dwordx4 v41, s[12:15], s21 offen lds
 s_add_u32 m0, s22, 2048
 s_nop 0
 buffer_load_dwordx4 v42, s[12:15], s21 offen lds
 s_mul_i32 s21, s20, 393216
 s_add_u32 s21, s21, 1867776
 s_add_u32 s21, s21, s44
 s_mul_i32 s22, s20, 12288
 s_add_u32 s22, s22, 58368
 s_add_u32 m0, s22, 0
 s_nop 0
 buffer_load_dwordx4 v43, s[12:15], s21 offen lds
 s_add_u32 m0, s22, 1024
 s_nop 0
 buffer_load_dwordx4 v44, s[12:15], s21 offen lds
 s_add_u32 m0, s22, 2048
 s_nop 0
 buffer_load_dwordx4 v45, s[12:15], s21 offen lds
 v_lshrrev_b32 v7, 2, v2
 v_and_b32 v4, 2, v7
 v_and_b32 v5, 1, v3
 v_lshl_or_b32 v4, v5, 2, v4
 v_lshl_add_u32 v7, v3, 3, v7
 v_mul_u32_u24 v7, 384, v7
 v_and_b32 v5, 1, v2
 v_lshl_add_u32 v7, v5, 3, v7
 v_bfe_u32 v8, v2, 1, 1
 s_mul_i32 s21, s20, 6
 v_add_u32 v8, s21, v8
 v_add_u32 v5, 0, v8
 v_xor_b32 v5, v5, v4
 v_lshl_add_u32 v46, v5, 4, v7
 v_add_u32 v49, 49152, v46
 v_add_u32 v5, 2, v8
 v_xor_b32 v5, v5, v4
 v_lshl_add_u32 v47, v5, 4, v7
 v_add_u32 v50, 49152, v47
 v_add_u32 v5, 4, v8
 v_xor_b32 v5, v5, v4
 v_lshl_add_u32 v48, v5, 4, v7
 v_add_u32 v51, 49152, v48
 s_mov_b32 s26, 6
 s_mul_i32 s27, s42, 12288
 s_mul_i32 s21, s43, 25165824
 s_add_u32 s27, s27, s21
 s_mov_b32 s28, 786432
 s_lshl_b32 s60, s40, 7
 s_add_u32 s60, s60, 0
 s_mov_b32 s61, 0
 v_and_b32 v6, 7, v2
 v_add_u32 v4, 0, v3
 v_xor_b32 v4, v4, v6
 v_lshlrev_b32 v4, 4, v4
 v_lshl_add_u32 v14, v2, 7, v4
 v_add_u32 v4, 4, v3
 v_xor_b32 v4, v4, v6
 v_lshlrev_b32 v4, 4, v4
 v_lshl_add_u32 v15, v2, 7, v4
 v_mul_u32_u24 v22, 400, v2
 v_mul_u32_u24 v4, 16, v3
 s_mul_i32 s21, s20, 96
 s_add_u32 s21, s21, 0
 v_add3_u32 v22, v22, v4, s21
 v_lshlrev_b32 v4, 3, v3
 v_sub_u32 v16, v22, v4
 v_mov_b32 v9, 2731
 s_mul_i32 s21, s20, 6400
 s_add_u32 s21, s21, 0
 v_mul_u32_u24 v4, 400, v2
 v_lshlrev_b32 v5, 4, v3
 v_add3_u32 v23, v4, v5, s21
 v_lshlrev_b32 v26, 4, v1
 s_mov_b32 s33, 98304
 s_mov_b32 s48, 0x80000000
 s_mov_b32 m0, s32
 s_nop 0
 buffer_load_dwordx4 v10, s[8:11], s30 offen offset:0 lds
 s_waitcnt vmcnt(21)
 s_barrier
 v_add_u32 v18, s33, v14
 v_add_u32 v19, s33, v15
 s_add_u32 s33, s33, 8192
 s_cmp_lt_u32 s33, 155648
 s_cselect_b32 s33, s33, 98304
 ds_read_b128 v[160:163], v18 offset:0
 ds_read_b128 v[164:167], v18 offset:2048
 ds_read_b128 v[168:171], v18 offset:4096
 ds_read_b128 v[172:175], v18 offset:6144
 s_waitcnt lgkmcnt(0)
 s_waitcnt vmcnt(23)
 s_barrier
 ds_read_b64_tr_b16 a[0:1], v46 offset:0
 ds_read_b64_tr_b16 a[2:3], v46 offset:1536
 ds_read_b64_tr_b16 a[4:5], v47 offset:0
 ds_read_b64_tr_b16 a[6:7], v47 offset:1536
 ds_read_b64_tr_b16 a[8:9], v48 offset:0
 ds_read_b64_tr_b16 a[10:11], v48 offset:1536
 ds_read_b64_tr_b16 a[12:13], v46 offset:12288
 ds_read_b64_tr_b16 a[14:15], v46 offset:13824
 ds_read_b64_tr_b16 a[16:17], v47 offset:12288
 ds_read_b64_tr_b16 a[18:19], v47 offset:13824
 ds_read_b64_tr_b16 a[20:21], v48 offset:12288
 ds_read_b64_tr_b16 a[22:23], v48 offset:13824
 ds_read_b64_tr_b16 a[24:25], v46 offset:24576
 ds_read_b64_tr_b16 a[26:27], v46 offset:26112
 ds_read_b64_tr_b16 a[28:29], v47 offset:24576
 ds_read_b64_tr_b16 a[30:31], v47 offset:26112
 ds_read_b64_tr_b16 a[32:33], v48 offset:24576
 ds_read_b64_tr_b16 a[34:35], v48 offset:26112
 ds_read_b64_tr_b16 a[36:37], v46 offset:36864
 ds_read_b64_tr_b16 a[38:39], v46 offset:38400
 ds_read_b64_tr_b16 a[40:41], v47 offset:36864
 ds_read_b64_tr_b16 a[42:43], v47 offset:38400
 ds_read_b64_tr_b16 a[44:45], v48 offset:36864
 ds_read_b64_tr_b16 a[46:47], v48 offset:38400
 s_waitcnt lgkmcnt(0)
 s_barrier
 s_mov_b32 s23, m0
 s_mul_i32 s21, s20, 393216
 s_add_u32 s21, s21, 3145728
 s_add_u32 s21, s21, s44
 s_mul_i32 s22, s20, 12288
 s_add_u32 s22, s22, 0
 s_add_u32 m0, s22, 0
 s_nop 0
 buffer_load_dwordx4 v40, s[12:15], s21 offen lds
 s_add_u32 m0, s22, 1024
 s_nop 0
 buffer_load_dwordx4 v41, s[12:15], s21 offen lds
 s_add_u32 m0, s22, 2048
 s_nop 0
 buffer_load_dwordx4 v42, s[12:15], s21 offen lds
 s_mul_i32 s21, s20, 393216
 s_add_u32 s21, s21, 3244032
 s_add_u32 s21, s21, s44
 s_mul_i32 s22, s20, 12288
 s_add_u32 s22, s22, 3072
 s_add_u32 m0, s22, 0
 s_nop 0
 buffer_load_dwordx4 v43, s[12:15], s21 offen lds
 s_add_u32 m0, s22, 1024
 s_nop 0
 buffer_load_dwordx4 v44, s[12:15], s21 offen lds
 s_add_u32 m0, s22, 2048
 s_nop 0
 buffer_load_dwordx4 v45, s[12:15], s21 offen lds
 s_mul_i32 s21, s20, 393216
 s_add_u32 s21, s21, 3342336
 s_add_u32 s21, s21, s44
 s_mul_i32 s22, s20, 12288
 s_add_u32 s22, s22, 6144
 s_add_u32 m0, s22, 0
 s_nop 0
 buffer_load_dwordx4 v40, s[12:15], s21 offen lds
 s_add_u32 m0, s22, 1024
 s_nop 0
 buffer_load_dwordx4 v41, s[12:15], s21 offen lds
 s_add_u32 m0, s22, 2048
 s_nop 0
 buffer_load_dwordx4 v42, s[12:15], s21 offen lds
 s_mul_i32 s21, s20, 393216
 s_add_u32 s21, s21, 3440640
 s_add_u32 s21, s21, s44
 s_mul_i32 s22, s20, 12288
 s_add_u32 s22, s22, 9216
 s_add_u32 m0, s22, 0
 s_nop 0
 buffer_load_dwordx4 v43, s[12:15], s21 offen lds
 s_add_u32 m0, s22, 1024
 s_nop 0
 buffer_load_dwordx4 v44, s[12:15], s21 offen lds
 s_add_u32 m0, s22, 2048
 s_nop 0
 buffer_load_dwordx4 v45, s[12:15], s21 offen lds
 s_mov_b32 m0, s23
 v_mfma_f32_16x16x32_bf16 v[64:67], a[0:3], v[160:163], 0
 ds_read_b128 v[192:195], v19 offset:0
 v_mfma_f32_16x16x32_bf16 v[68:71], a[4:7], v[160:163], 0
 v_add_u32 v18, s33, v14
 v_mfma_f32_16x16x32_bf16 v[72:75], a[8:11], v[160:163], 0
 v_mfma_f32_16x16x32_bf16 v[76:79], a[0:3], v[164:167], 0
 ds_read_b128 v[196:199], v19 offset:2048
 v_mfma_f32_16x16x32_bf16 v[80:83], a[4:7], v[164:167], 0
 buffer_load_dwordx4 v11, s[8:11], s30 offen offset:1024 lds
 v_mfma_f32_16x16x32_bf16 v[84:87], a[8:11], v[164:167], 0
 s_add_u32 s30, s30, 128
 v_mfma_f32_16x16x32_bf16 v[88:91], a[0:3], v[168:171], 0
 ds_read_b128 v[200:203], v19 offset:4096
 s_add_u32 m0, m0, 8192
 v_mfma_f32_16x16x32_bf16 v[92:95], a[4:7], v[168:171], 0
 s_cmp_lt_u32 m0, s46
 s_cselect_b32 m0, m0, s47
 v_mfma_f32_16x16x32_bf16 v[96:99], a[8:11], v[168:171], 0
 v_mfma_f32_16x16x32_bf16 v[100:103], a[0:3], v[172:175], 0
 ds_read_b128 v[204:207], v19 offset:6144
 v_mfma_f32_16x16x32_bf16 v[104:107], a[4:7], v[172:175], 0
 v_mfma_f32_16x16x32_bf16 v[108:111], a[8:11], v[172:175], 0
 s_waitcnt vmcnt(32) lgkmcnt(2)
 s_barrier
 v_mfma_f32_16x16x32_bf16 v[64:67], a[12:15], v[192:195], v[64:67]
 ds_read_b128 v[160:163], v18 offset:0
 v_mfma_f32_16x16x32_bf16 v[68:71], a[16:19], v[192:195], v[68:71]
 v_mfma_f32_16x16x32_bf16 v[72:75], a[20:23], v[192:195], v[72:75]
 v_add_u32 v19, s33, v15
 s_add_u32 s33, s33, 8192
 v_mfma_f32_16x16x32_bf16 v[76:79], a[12:15], v[196:199], v[76:79]
 ds_read_b128 v[164:167], v18 offset:2048
 v_mfma_f32_16x16x32_bf16 v[80:83], a[16:19], v[196:199], v[80:83]
 buffer_load_dwordx4 v10, s[8:11], s30 offen offset:0 lds
 v_mfma_f32_16x16x32_bf16 v[84:87], a[20:23], v[196:199], v[84:87]
 s_waitcnt lgkmcnt(2)
 v_mfma_f32_16x16x32_bf16 v[88:91], a[12:15], v[200:203], v[88:91]
 ds_read_b128 v[168:171], v18 offset:4096
 v_mfma_f32_16x16x32_bf16 v[92:95], a[16:19], v[200:203], v[92:95]
 s_cmp_lt_u32 s33, 155648
 s_cselect_b32 s33, s33, 98304
 v_mfma_f32_16x16x32_bf16 v[96:99], a[20:23], v[200:203], v[96:99]
 v_mfma_f32_16x16x32_bf16 v[100:103], a[12:15], v[204:207], v[100:103]
 ds_read_b128 v[172:175], v18 offset:6144
 v_mfma_f32_16x16x32_bf16 v[104:107], a[16:19], v[204:207], v[104:107]
 v_mfma_f32_16x16x32_bf16 v[108:111], a[20:23], v[204:207], v[108:111]
 s_waitcnt lgkmcnt(2)
 v_mfma_f32_16x16x32_bf16 v[64:67], a[24:27], v[160:163], v[64:67]
 ds_read_b128 v[192:195], v19 offset:0
 v_mfma_f32_16x16x32_bf16 v[68:71], a[28:31], v[160:163], v[68:71]
 v_add_u32 v18, s33, v14
 v_mfma_f32_16x16x32_bf16 v[72:75], a[32:35], v[160:163], v[72:75]
 v_mfma_f32_16x16x32_bf16 v[76:79], a[24:27], v[164:167], v[76:79]
 ds_read_b128 v[196:199], v19 offset:2048
 v_mfma_f32_16x16x32_bf16 v[80:83], a[28:31], v[164:167], v[80:83]
 buffer_load_dwordx4 v11, s[8:11], s30 offen offset:1024 lds
 v_mfma_f32_16x16x32_bf16 v[84:87], a[32:35], v[164:167], v[84:87]
 s_waitcnt lgkmcnt(2)
 s_add_u32 s30, s30, 128
 v_mfma_f32_16x16x32_bf16 v[88:91], a[24:27], v[168:171], v[88:91]
 ds_read_b128 v[200:203], v19 offset:4096
 s_add_u32 m0, m0, 8192
 v_mfma_f32_16x16x32_bf16 v[92:95], a[28:31], v[168:171], v[92:95]
 s_cmp_lt_u32 m0, s46
 s_cselect_b32 m0, m0, s47
 v_mfma_f32_16x16x32_bf16 v[96:99], a[32:35], v[168:171], v[96:99]
 v_mfma_f32_16x16x32_bf16 v[100:103], a[24:27], v[172:175], v[100:103]
 ds_read_b128 v[204:207], v19 offset:6144
 v_mfma_f32_16x16x32_bf16 v[104:107], a[28:31], v[172:175], v[104:107]
 v_mfma_f32_16x16x32_bf16 v[108:111], a[32:35], v[172:175], v[108:111]
 s_waitcnt vmcnt(32) lgkmcnt(2)
 s_barrier
 v_mfma_f32_16x16x32_bf16 v[64:67], a[36:39], v[192:195], v[64:67]
 ds_read_b128 v[160:163], v18 offset:0
 v_mfma_f32_16x16x32_bf16 v[68:71], a[40:43], v[192:195], v[68:71]
 v_mfma_f32_16x16x32_bf16 v[72:75], a[44:47], v[192:195], v[72:75]
 v_add_u32 v19, s33, v15
 s_add_u32 s33, s33, 8192
 v_mfma_f32_16x16x32_bf16 v[76:79], a[36:39], v[196:199], v[76:79]
 ds_read_b128 v[164:167], v18 offset:2048
 v_mfma_f32_16x16x32_bf16 v[80:83], a[40:43], v[196:199], v[80:83]
 buffer_load_dwordx4 v10, s[8:11], s30 offen offset:0 lds
 v_mfma_f32_16x16x32_bf16 v[84:87], a[44:47], v[196:199], v[84:87]
 s_waitcnt lgkmcnt(2)
 v_mfma_f32_16x16x32_bf16 v[88:91], a[36:39], v[200:203], v[88:91]
 ds_read_b128 v[168:171], v18 offset:4096
 v_mfma_f32_16x16x32_bf16 v[92:95], a[40:43], v[200:203], v[92:95]
 s_cmp_lt_u32 s33, 155648
 s_cselect_b32 s33, s33, 98304
 v_mfma_f32_16x16x32_bf16 v[96:99], a[44:47], v[200:203], v[96:99]
 v_mfma_f32_16x16x32_bf16 v[100:103], a[36:39], v[204:207], v[100:103]
 ds_read_b128 v[172:175], v18 offset:6144
 v_mfma_f32_16x16x32_bf16 v[104:107], a[40:43], v[204:207], v[104:107]
 v_mfma_f32_16x16x32_bf16 v[108:111], a[44:47], v[204:207], v[108:111]
 s_waitcnt lgkmcnt(2)
 s_waitcnt vmcnt(17)
 s_barrier
 ds_read_b64_tr_b16 a[48:49], v49 offset:0
 ds_read_b64_tr_b16 a[50:51], v49 offset:1536
 ds_read_b64_tr_b16 a[52:53], v50 offset:0
 ds_read_b64_tr_b16 a[54:55], v50 offset:1536
 ds_read_b64_tr_b16 a[56:57], v51 offset:0
 ds_read_b64_tr_b16 a[58:59], v51 offset:1536
 ds_read_b64_tr_b16 a[60:61], v49 offset:12288
 ds_read_b64_tr_b16 a[62:63], v49 offset:13824
 ds_read_b64_tr_b16 a[64:65], v50 offset:12288
 ds_read_b64_tr_b16 a[66:67], v50 offset:13824
 ds_read_b64_tr_b16 a[68:69], v51 offset:12288
 ds_read_b64_tr_b16 a[70:71], v51 offset:13824
 ds_read_b64_tr_b16 a[72:73], v49 offset:24576
 ds_read_b64_tr_b16 a[74:75], v49 offset:26112
 ds_read_b64_tr_b16 a[76:77], v50 offset:24576
 ds_read_b64_tr_b16 a[78:79], v50 offset:26112
 ds_read_b64_tr_b16 a[80:81], v51 offset:24576
 ds_read_b64_tr_b16 a[82:83], v51 offset:26112
 ds_read_b64_tr_b16 a[84:85], v49 offset:36864
 ds_read_b64_tr_b16 a[86:87], v49 offset:38400
 ds_read_b64_tr_b16 a[88:89], v50 offset:36864
 ds_read_b64_tr_b16 a[90:91], v50 offset:38400
 ds_read_b64_tr_b16 a[92:93], v51 offset:36864
 ds_read_b64_tr_b16 a[94:95], v51 offset:38400
 s_waitcnt lgkmcnt(0)
 s_barrier
 s_mov_b32 s23, m0
 s_mul_i32 s21, s20, 393216
 s_add_u32 s21, s21, 4718592
 s_add_u32 s21, s21, s44
 s_mul_i32 s22, s20, 12288
 s_add_u32 s22, s22, 49152
 s_add_u32 m0, s22, 0
 s_nop 0
 buffer_load_dwordx4 v40, s[12:15], s21 offen lds
 s_add_u32 m0, s22, 1024
 s_nop 0
 buffer_load_dwordx4 v41, s[12:15], s21 offen lds
 s_add_u32 m0, s22, 2048
 s_nop 0
 buffer_load_dwordx4 v42, s[12:15], s21 offen lds
 s_mul_i32 s21, s20, 393216
 s_add_u32 s21, s21, 4816896
 s_add_u32 s21, s21, s44
 s_mul_i32 s22, s20, 12288
 s_add_u32 s22, s22, 52224
 s_add_u32 m0, s22, 0
 s_nop 0
 buffer_load_dwordx4 v43, s[12:15], s21 offen lds
 s_add_u32 m0, s22, 1024
 s_nop 0
 buffer_load_dwordx4 v44, s[12:15], s21 offen lds
 s_add_u32 m0, s22, 2048
 s_nop 0
 buffer_load_dwordx4 v45, s[12:15], s21 offen lds
 s_mul_i32 s21, s20, 393216
 s_add_u32 s21, s21, 4915200
 s_add_u32 s21, s21, s44
 s_mul_i32 s22, s20, 12288
 s_add_u32 s22, s22, 55296
 s_add_u32 m0, s22, 0
 s_nop 0
 buffer_load_dwordx4 v40, s[12:15], s21 offen lds
 s_add_u32 m0, s22, 1024
 s_nop 0
 buffer_load_dwordx4 v41, s[12:15], s21 offen lds
 s_add_u32 m0, s22, 2048
 s_nop 0
 buffer_load_dwordx4 v42, s[12:15], s21 offen lds
 s_mul_i32 s21, s20, 393216
 s_add_u32 s21, s21, 5013504
 s_add_u32 s21, s21, s44
 s_mul_i32 s22, s20, 12288
 s_add_u32 s22, s22, 58368
 s_add_u32 m0, s22, 0
 s_nop 0
 buffer_load_dwordx4 v43, s[12:15], s21 offen lds
 s_add_u32 m0, s22, 1024
 s_nop 0
 buffer_load_dwordx4 v44, s[12:15], s21 offen lds
 s_add_u32 m0, s22, 2048
 s_nop 0
 buffer_load_dwordx4 v45, s[12:15], s21 offen lds
 s_mov_b32 m0, s23
 v_mfma_f32_16x16x32_bf16 v[64:67], a[48:51], v[160:163], v[64:67]
 ds_read_b128 v[192:195], v19 offset:0
 v_mfma_f32_16x16x32_bf16 v[68:71], a[52:55], v[160:163], v[68:71]
 v_add_u32 v18, s33, v14
 v_mfma_f32_16x16x32_bf16 v[72:75], a[56:59], v[160:163], v[72:75]
 v_mfma_f32_16x16x32_bf16 v[76:79], a[48:51], v[164:167], v[76:79]
 ds_read_b128 v[196:199], v19 offset:2048
 v_mfma_f32_16x16x32_bf16 v[80:83], a[52:55], v[164:167], v[80:83]
 buffer_load_dwordx4 v11, s[8:11], s30 offen offset:1024 lds
 v_mfma_f32_16x16x32_bf16 v[84:87], a[56:59], v[164:167], v[84:87]
 s_add_u32 s30, s30, 128
 v_mfma_f32_16x16x32_bf16 v[88:91], a[48:51], v[168:171], v[88:91]
 ds_read_b128 v[200:203], v19 offset:4096
 s_add_u32 m0, m0, 8192
 v_mfma_f32_16x16x32_bf16 v[92:95], a[52:55], v[168:171], v[92:95]
 s_cmp_lt_u32 m0, s46
 s_cselect_b32 m0, m0, s47
 v_mfma_f32_16x16x32_bf16 v[96:99], a[56:59], v[168:171], v[96:99]
 v_mfma_f32_16x16x32_bf16 v[100:103], a[48:51], v[172:175], v[100:103]
 ds_read_b128 v[204:207], v19 offset:6144
 v_mfma_f32_16x16x32_bf16 v[104:107], a[52:55], v[172:175], v[104:107]
 v_mfma_f32_16x16x32_bf16 v[108:111], a[56:59], v[172:175], v[108:111]
 s_waitcnt vmcnt(44) lgkmcnt(2)
 s_barrier
 v_mfma_f32_16x16x32_bf16 v[64:67], a[60:63], v[192:195], v[64:67]
 ds_read_b128 v[160:163], v18 offset:0
 v_mfma_f32_16x16x32_bf16 v[68:71], a[64:67], v[192:195], v[68:71]
 v_mfma_f32_16x16x32_bf16 v[72:75], a[68:71], v[192:195], v[72:75]
 v_add_u32 v19, s33, v15
 s_add_u32 s33, s33, 8192
 v_mfma_f32_16x16x32_bf16 v[76:79], a[60:63], v[196:199], v[76:79]
 ds_read_b128 v[164:167], v18 offset:2048
 v_mfma_f32_16x16x32_bf16 v[80:83], a[64:67], v[196:199], v[80:83]
 buffer_load_dwordx4 v10, s[8:11], s30 offen offset:0 lds
 v_mfma_f32_16x16x32_bf16 v[84:87], a[68:71], v[196:199], v[84:87]
 s_waitcnt lgkmcnt(2)
 v_mfma_f32_16x16x32_bf16 v[88:91], a[60:63], v[200:203], v[88:91]
 ds_read_b128 v[168:171], v18 offset:4096
 v_mfma_f32_16x16x32_bf16 v[92:95], a[64:67], v[200:203], v[92:95]
 s_cmp_lt_u32 s33, 155648
 s_cselect_b32 s33, s33, 98304
 v_mfma_f32_16x16x32_bf16 v[96:99], a[68:71], v[200:203], v[96:99]
 v_mfma_f32_16x16x32_bf16 v[100:103], a[60:63], v[204:207], v[100:103]
 ds_read_b128 v[172:175], v18 offset:6144
 v_mfma_f32_16x16x32_bf16 v[104:107], a[64:67], v[204:207], v[104:107]
 v_mfma_f32_16x16x32_bf16 v[108:111], a[68:71], v[204:207], v[108:111]
 s_waitcnt lgkmcnt(2)
 v_mfma_f32_16x16x32_bf16 v[64:67], a[72:75], v[160:163], v[64:67]
 ds_read_b128 v[192:195], v19 offset:0
 v_mfma_f32_16x16x32_bf16 v[68:71], a[76:79], v[160:163], v[68:71]
 v_add_u32 v18, s33, v14
 v_mfma_f32_16x16x32_bf16 v[72:75], a[80:83], v[160:163], v[72:75]
 v_mfma_f32_16x16x32_bf16 v[76:79], a[72:75], v[164:167], v[76:79]
 ds_read_b128 v[196:199], v19 offset:2048
 v_mfma_f32_16x16x32_bf16 v[80:83], a[76:79], v[164:167], v[80:83]
 buffer_load_dwordx4 v11, s[8:11], s30 offen offset:1024 lds
 v_mfma_f32_16x16x32_bf16 v[84:87], a[80:83], v[164:167], v[84:87]
 s_waitcnt lgkmcnt(2)
 s_add_u32 s30, s30, 128
 v_mfma_f32_16x16x32_bf16 v[88:91], a[72:75], v[168:171], v[88:91]
 ds_read_b128 v[200:203], v19 offset:4096
 s_add_u32 m0, m0, 8192
 v_mfma_f32_16x16x32_bf16 v[92:95], a[76:79], v[168:171], v[92:95]
 s_cmp_lt_u32 m0, s46
 s_cselect_b32 m0, m0, s47
 v_mfma_f32_16x16x32_bf16 v[96:99], a[80:83], v[168:171], v[96:99]
 v_mfma_f32_16x16x32_bf16 v[100:103], a[72:75], v[172:175], v[100:103]
 ds_read_b128 v[204:207], v19 offset:6144
 v_mfma_f32_16x16x32_bf16 v[104:107], a[76:79], v[172:175], v[104:107]
 v_mfma_f32_16x16x32_bf16 v[108:111], a[80:83], v[172:175], v[108:111]
 s_waitcnt vmcnt(44) lgkmcnt(2)
 s_barrier
 v_mfma_f32_16x16x32_bf16 v[64:67], a[84:87], v[192:195], v[64:67]
 ds_read_b128 v[160:163], v18 offset:0
 v_mfma_f32_16x16x32_bf16 v[68:71], a[88:91], v[192:195], v[68:71]
 v_mfma_f32_16x16x32_bf16 v[72:75], a[92:95], v[192:195], v[72:75]
 v_add_u32 v19, s33, v15
 s_add_u32 s33, s33, 8192
 v_mfma_f32_16x16x32_bf16 v[76:79], a[84:87], v[196:199], v[76:79]
 ds_read_b128 v[164:167], v18 offset:2048
 v_mfma_f32_16x16x32_bf16 v[80:83], a[88:91], v[196:199], v[80:83]
 buffer_load_dwordx4 v10, s[8:11], s30 offen offset:0 lds
 v_mfma_f32_16x16x32_bf16 v[84:87], a[92:95], v[196:199], v[84:87]
 s_waitcnt lgkmcnt(2)
 v_mfma_f32_16x16x32_bf16 v[88:91], a[84:87], v[200:203], v[88:91]
 ds_read_b128 v[168:171], v18 offset:4096
 v_mfma_f32_16x16x32_bf16 v[92:95], a[88:91], v[200:203], v[92:95]
 s_cmp_lt_u32 s33, 155648
 s_cselect_b32 s33, s33, 98304
 v_mfma_f32_16x16x32_bf16 v[96:99], a[92:95], v[200:203], v[96:99]
 v_mfma_f32_16x16x32_bf16 v[100:103], a[84:87], v[204:207], v[100:103]
 ds_read_b128 v[172:175], v18 offset:6144
 v_mfma_f32_16x16x32_bf16 v[104:107], a[88:91], v[204:207], v[104:107]
 v_mfma_f32_16x16x32_bf16 v[108:111], a[92:95], v[204:207], v[108:111]
 s_waitcnt lgkmcnt(2)
 s_waitcnt vmcnt(20)
 s_barrier
 ds_read_b64_tr_b16 a[96:97], v46 offset:0
 ds_read_b64_tr_b16 a[98:99], v46 offset:1536
 ds_read_b64_tr_b16 a[100:101], v47 offset:0
 ds_read_b64_tr_b16 a[102:103], v47 offset:1536
 ds_read_b64_tr_b16 a[104:105], v48 offset:0
 ds_read_b64_tr_b16 a[106:107], v48 offset:1536
 ds_read_b64_tr_b16 a[108:109], v46 offset:12288
 ds_read_b64_tr_b16 a[110:111], v46 offset:13824
 ds_read_b64_tr_b16 a[112:113], v47 offset:12288
 ds_read_b64_tr_b16 a[114:115], v47 offset:13824
 ds_read_b64_tr_b16 a[116:117], v48 offset:12288
 ds_read_b64_tr_b16 a[118:119], v48 offset:13824
 ds_read_b64_tr_b16 a[120:121], v46 offset:24576
 ds_read_b64_tr_b16 a[122:123], v46 offset:26112
 ds_read_b64_tr_b16 a[124:125], v47 offset:24576
 ds_read_b64_tr_b16 a[126:127], v47 offset:26112
 ds_read_b64_tr_b16 a[128:129], v48 offset:24576
 ds_read_b64_tr_b16 a[130:131], v48 offset:26112
 ds_read_b64_tr_b16 a[132:133], v46 offset:36864
 ds_read_b64_tr_b16 a[134:135], v46 offset:38400
 ds_read_b64_tr_b16 a[136:137], v47 offset:36864
 ds_read_b64_tr_b16 a[138:139], v47 offset:38400
 ds_read_b64_tr_b16 a[140:141], v48 offset:36864
 ds_read_b64_tr_b16 a[142:143], v48 offset:38400
 s_waitcnt lgkmcnt(0)
 s_barrier
 s_mov_b32 s23, m0
 s_mul_i32 s21, s20, 393216
 s_add_u32 s21, s21, 6291456
 s_add_u32 s21, s21, s44
 s_mul_i32 s22, s20, 12288
 s_add_u32 s22, s22, 0
 s_add_u32 m0, s22, 0
 s_nop 0
 buffer_load_dwordx4 v40, s[12:15], s21 offen lds
 s_add_u32 m0, s22, 1024
 s_nop 0
 buffer_load_dwordx4 v41, s[12:15], s21 offen lds
 s_add_u32 m0, s22, 2048
 s_nop 0
 buffer_load_dwordx4 v42, s[12:15], s21 offen lds
 s_mul_i32 s21, s20, 393216
 s_add_u32 s21, s21, 6389760
 s_add_u32 s21, s21, s44
 s_mul_i32 s22, s20, 12288
 s_add_u32 s22, s22, 3072
 s_add_u32 m0, s22, 0
 s_nop 0
 buffer_load_dwordx4 v43, s[12:15], s21 offen lds
 s_add_u32 m0, s22, 1024
 s_nop 0
 buffer_load_dwordx4 v44, s[12:15], s21 offen lds
 s_add_u32 m0, s22, 2048
 s_nop 0
 buffer_load_dwordx4 v45, s[12:15], s21 offen lds
 s_mul_i32 s21, s20, 393216
 s_add_u32 s21, s21, 6488064
 s_add_u32 s21, s21, s44
 s_mul_i32 s22, s20, 12288
 s_add_u32 s22, s22, 6144
 s_add_u32 m0, s22, 0
 s_nop 0
 buffer_load_dwordx4 v40, s[12:15], s21 offen lds
 s_add_u32 m0, s22, 1024
 s_nop 0
 buffer_load_dwordx4 v41, s[12:15], s21 offen lds
 s_add_u32 m0, s22, 2048
 s_nop 0
 buffer_load_dwordx4 v42, s[12:15], s21 offen lds
 s_mul_i32 s21, s20, 393216
 s_add_u32 s21, s21, 6586368
 s_add_u32 s21, s21, s44
 s_mul_i32 s22, s20, 12288
 s_add_u32 s22, s22, 9216
 s_add_u32 m0, s22, 0
 s_nop 0
 buffer_load_dwordx4 v43, s[12:15], s21 offen lds
 s_add_u32 m0, s22, 1024
 s_nop 0
 buffer_load_dwordx4 v44, s[12:15], s21 offen lds
 s_add_u32 m0, s22, 2048
 s_nop 0
 buffer_load_dwordx4 v45, s[12:15], s21 offen lds
 s_mov_b32 m0, s23
 v_mov_b32 v29, 76
 buffer_load_dword v29, v29, s[64:67], 0 offen sc1
 v_mfma_f32_16x16x32_bf16 v[64:67], a[96:99], v[160:163], v[64:67]
 ds_read_b128 v[192:195], v19 offset:0
 v_mfma_f32_16x16x32_bf16 v[68:71], a[100:103], v[160:163], v[68:71]
 v_add_u32 v18, s33, v14
 s_mov_b32 s61, s60
 v_mfma_f32_16x16x32_bf16 v[72:75], a[104:107], v[160:163], v[72:75]
 s_add_u32 s60, s60, s62
 s_lshr_b32 s48, s20, 1
 v_mfma_f32_16x16x32_bf16 v[76:79], a[96:99], v[164:167], v[76:79]
 ds_read_b128 v[196:199], v19 offset:2048
 s_mul_i32 s48, s48, 393216
 v_mfma_f32_16x16x32_bf16 v[80:83], a[100:103], v[164:167], v[80:83]
 buffer_load_dwordx4 v11, s[8:11], s30 offen offset:1024 lds
 v_mfma_f32_16x16x32_bf16 v[84:87], a[104:107], v[164:167], v[84:87]
 s_add_u32 s30, s30, s25
 v_mfma_f32_16x16x32_bf16 v[88:91], a[96:99], v[168:171], v[88:91]
 ds_read_b128 v[200:203], v19 offset:4096
 s_sub_u32 s30, s30, 1152
 v_mfma_f32_16x16x32_bf16 v[92:95], a[100:103], v[168:171], v[92:95]
 s_add_u32 m0, m0, 8192
 s_and_b32 s21, s20, 1
 v_mfma_f32_16x16x32_bf16 v[96:99], a[104:107], v[168:171], v[96:99]
 s_cmp_lt_u32 m0, s46
 s_cselect_b32 m0, m0, s47
 v_mfma_f32_16x16x32_bf16 v[100:103], a[96:99], v[172:175], v[100:103]
 ds_read_b128 v[204:207], v19 offset:6144
 s_mul_i32 s21, s21, 6144
 v_mfma_f32_16x16x32_bf16 v[104:107], a[100:103], v[172:175], v[104:107]
 s_add_u32 s48, s48, s21
 s_add_u32 s48, s48, s27
 v_mfma_f32_16x16x32_bf16 v[108:111], a[104:107], v[172:175], v[108:111]
 s_waitcnt vmcnt(33) lgkmcnt(2)
 s_barrier
 v_mfma_f32_16x16x32_bf16 v[64:67], a[108:111], v[192:195], v[64:67]
 ds_read_b128 v[160:163], v18 offset:0
 s_add_u32 s27, s27, s28
 v_mfma_f32_16x16x32_bf16 v[68:71], a[112:115], v[192:195], v[68:71]
 s_sub_u32 s26, s26, 1
 v_mfma_f32_16x16x32_bf16 v[72:75], a[116:119], v[192:195], v[72:75]
 v_add_u32 v19, s33, v15
 s_add_u32 s33, s33, 8192
 v_mfma_f32_16x16x32_bf16 v[76:79], a[108:111], v[196:199], v[76:79]
 ds_read_b128 v[164:167], v18 offset:2048
 v_mfma_f32_16x16x32_bf16 v[80:83], a[112:115], v[196:199], v[80:83]
 buffer_load_dwordx4 v10, s[8:11], s30 offen offset:0 lds
 v_mfma_f32_16x16x32_bf16 v[84:87], a[116:119], v[196:199], v[84:87]
 s_waitcnt lgkmcnt(2)
 v_mfma_f32_16x16x32_bf16 v[88:91], a[108:111], v[200:203], v[88:91]
 ds_read_b128 v[168:171], v18 offset:4096
 v_mfma_f32_16x16x32_bf16 v[92:95], a[112:115], v[200:203], v[92:95]
 s_cmp_lt_u32 s33, 155648
 s_cselect_b32 s33, s33, 98304
 v_mfma_f32_16x16x32_bf16 v[96:99], a[116:119], v[200:203], v[96:99]
 v_mfma_f32_16x16x32_bf16 v[100:103], a[108:111], v[204:207], v[100:103]
 ds_read_b128 v[172:175], v18 offset:6144
 v_mfma_f32_16x16x32_bf16 v[104:107], a[112:115], v[204:207], v[104:107]
 v_mfma_f32_16x16x32_bf16 v[108:111], a[116:119], v[204:207], v[108:111]
 s_waitcnt lgkmcnt(2)
 v_mfma_f32_16x16x32_bf16 v[64:67], a[120:123], v[160:163], v[64:67]
 ds_read_b128 v[192:195], v19 offset:0
 v_mfma_f32_16x16x32_bf16 v[68:71], a[124:127], v[160:163], v[68:71]
 v_add_u32 v18, s33, v14
 v_mfma_f32_16x16x32_bf16 v[72:75], a[128:131], v[160:163], v[72:75]
 v_mfma_f32_16x16x32_bf16 v[76:79], a[120:123], v[164:167], v[76:79]
 ds_read_b128 v[196:199], v19 offset:2048
 v_mfma_f32_16x16x32_bf16 v[80:83], a[124:127], v[164:167], v[80:83]
 buffer_load_dwordx4 v11, s[8:11], s30 offen offset:1024 lds
 v_mfma_f32_16x16x32_bf16 v[84:87], a[128:131], v[164:167], v[84:87]
 s_waitcnt lgkmcnt(2)
 s_add_u32 s30, s30, 128
 v_mfma_f32_16x16x32_bf16 v[88:91], a[120:123], v[168:171], v[88:91]
 ds_read_b128 v[200:203], v19 offset:4096
 s_add_u32 m0, m0, 8192
 v_mfma_f32_16x16x32_bf16 v[92:95], a[124:127], v[168:171], v[92:95]
 s_cmp_lt_u32 m0, s46
 s_cselect_b32 m0, m0, s47
 v_mfma_f32_16x16x32_bf16 v[96:99], a[128:131], v[168:171], v[96:99]
 v_mfma_f32_16x16x32_bf16 v[100:103], a[120:123], v[172:175], v[100:103]
 ds_read_b128 v[204:207], v19 offset:6144
 v_mfma_f32_16x16x32_bf16 v[104:107], a[124:127], v[172:175], v[104:107]
 v_mfma_f32_16x16x32_bf16 v[108:111], a[128:131], v[172:175], v[108:111]
 s_waitcnt vmcnt(33) lgkmcnt(2)
 s_barrier
 v_mfma_f32_16x16x32_bf16 v[64:67], a[132:135], v[192:195], v[64:67]
 ds_read_b128 v[160:163], v18 offset:0
 v_mfma_f32_16x16x32_bf16 v[68:71], a[136:139], v[192:195], v[68:71]
 v_mfma_f32_16x16x32_bf16 v[72:75], a[140:143], v[192:195], v[72:75]
 v_add_u32 v19, s33, v15
 s_add_u32 s33, s33, 8192
 v_mfma_f32_16x16x32_bf16 v[76:79], a[132:135], v[196:199], v[76:79]
 ds_read_b128 v[164:167], v18 offset:2048
 v_mfma_f32_16x16x32_bf16 v[80:83], a[136:139], v[196:199], v[80:83]
 buffer_load_dwordx4 v10, s[8:11], s30 offen offset:0 lds
 v_mfma_f32_16x16x32_bf16 v[84:87], a[140:143], v[196:199], v[84:87]
 s_waitcnt lgkmcnt(2)
 v_mfma_f32_16x16x32_bf16 v[88:91], a[132:135], v[200:203], v[88:91]
 ds_read_b128 v[168:171], v18 offset:4096
 v_mfma_f32_16x16x32_bf16 v[92:95], a[136:139], v[200:203], v[92:95]
 s_cmp_lt_u32 s33, 155648
 s_cselect_b32 s33, s33, 98304
 v_mfma_f32_16x16x32_bf16 v[96:99], a[140:143], v[200:203], v[96:99]
 v_mfma_f32_16x16x32_bf16 v[100:103], a[132:135], v[204:207], v[100:103]
 ds_read_b128 v[172:175], v18 offset:6144
 v_mfma_f32_16x16x32_bf16 v[104:107], a[136:139], v[204:207], v[104:107]
 v_mfma_f32_16x16x32_bf16 v[108:111], a[140:143], v[204:207], v[108:111]
 s_waitcnt lgkmcnt(2)
 s_waitcnt vmcnt(21)
 s_barrier
 ds_read_b64_tr_b16 a[144:145], v49 offset:0
 ds_read_b64_tr_b16 a[146:147], v49 offset:1536
 ds_read_b64_tr_b16 a[148:149], v50 offset:0
 ds_read_b64_tr_b16 a[150:151], v50 offset:1536
 ds_read_b64_tr_b16 a[152:153], v51 offset:0
 ds_read_b64_tr_b16 a[154:155], v51 offset:1536
 ds_read_b64_tr_b16 a[156:157], v49 offset:12288
 ds_read_b64_tr_b16 a[158:159], v49 offset:13824
 ds_read_b64_tr_b16 a[160:161], v50 offset:12288
 ds_read_b64_tr_b16 a[162:163], v50 offset:13824
 ds_read_b64_tr_b16 a[164:165], v51 offset:12288
 ds_read_b64_tr_b16 a[166:167], v51 offset:13824
 ds_read_b64_tr_b16 a[168:169], v49 offset:24576
 ds_read_b64_tr_b16 a[170:171], v49 offset:26112
 ds_read_b64_tr_b16 a[172:173], v50 offset:24576
 ds_read_b64_tr_b16 a[174:175], v50 offset:26112
 ds_read_b64_tr_b16 a[176:177], v51 offset:24576
 ds_read_b64_tr_b16 a[178:179], v51 offset:26112
 ds_read_b64_tr_b16 a[180:181], v49 offset:36864
 ds_read_b64_tr_b16 a[182:183], v49 offset:38400
 ds_read_b64_tr_b16 a[184:185], v50 offset:36864
 ds_read_b64_tr_b16 a[186:187], v50 offset:38400
 ds_read_b64_tr_b16 a[188:189], v51 offset:36864
 ds_read_b64_tr_b16 a[190:191], v51 offset:38400
 s_waitcnt lgkmcnt(0)
 s_barrier
 v_mfma_f32_16x16x32_bf16 v[64:67], a[144:147], v[160:163], v[64:67]
 ds_read_b128 v[192:195], v19 offset:0
 v_mfma_f32_16x16x32_bf16 v[68:71], a[148:151], v[160:163], v[68:71]
 v_add_u32 v18, s33, v14
 v_mfma_f32_16x16x32_bf16 v[72:75], a[152:155], v[160:163], v[72:75]
 v_mfma_f32_16x16x32_bf16 v[76:79], a[144:147], v[164:167], v[76:79]
 ds_read_b128 v[196:199], v19 offset:2048
 v_mfma_f32_16x16x32_bf16 v[80:83], a[148:151], v[164:167], v[80:83]
 buffer_load_dwordx4 v11, s[8:11], s30 offen offset:1024 lds
 v_mfma_f32_16x16x32_bf16 v[84:87], a[152:155], v[164:167], v[84:87]
 s_add_u32 s30, s30, 128
 v_mfma_f32_16x16x32_bf16 v[88:91], a[144:147], v[168:171], v[88:91]
 ds_read_b128 v[200:203], v19 offset:4096
 s_add_u32 m0, m0, 8192
 v_mfma_f32_16x16x32_bf16 v[92:95], a[148:151], v[168:171], v[92:95]
 s_cmp_lt_u32 m0, s46
 s_cselect_b32 m0, m0, s47
 v_mfma_f32_16x16x32_bf16 v[96:99], a[152:155], v[168:171], v[96:99]
 v_mfma_f32_16x16x32_bf16 v[100:103], a[144:147], v[172:175], v[100:103]
 ds_read_b128 v[204:207], v19 offset:6144
 v_mfma_f32_16x16x32_bf16 v[104:107], a[148:151], v[172:175], v[104:107]
 v_mfma_f32_16x16x32_bf16 v[108:111], a[152:155], v[172:175], v[108:111]
 s_waitcnt vmcnt(21) lgkmcnt(2)
 s_barrier
 v_mfma_f32_16x16x32_bf16 v[64:67], a[156:159], v[192:195], v[64:67]
 ds_read_b128 v[160:163], v18 offset:0
 v_mfma_f32_16x16x32_bf16 v[68:71], a[160:163], v[192:195], v[68:71]
 v_mfma_f32_16x16x32_bf16 v[72:75], a[164:167], v[192:195], v[72:75]
 v_add_u32 v19, s33, v15
 s_add_u32 s33, s33, 8192
 v_mfma_f32_16x16x32_bf16 v[76:79], a[156:159], v[196:199], v[76:79]
 ds_read_b128 v[164:167], v18 offset:2048
 v_mfma_f32_16x16x32_bf16 v[80:83], a[160:163], v[196:199], v[80:83]
 buffer_load_dwordx4 v10, s[8:11], s30 offen offset:0 lds
 v_mfma_f32_16x16x32_bf16 v[84:87], a[164:167], v[196:199], v[84:87]
 s_waitcnt lgkmcnt(2)
 v_mfma_f32_16x16x32_bf16 v[88:91], a[156:159], v[200:203], v[88:91]
 ds_read_b128 v[168:171], v18 offset:4096
 v_mfma_f32_16x16x32_bf16 v[92:95], a[160:163], v[200:203], v[92:95]
 s_cmp_lt_u32 s33, 155648
 s_cselect_b32 s33, s33, 98304
 v_mfma_f32_16x16x32_bf16 v[96:99], a[164:167], v[200:203], v[96:99]
 v_mfma_f32_16x16x32_bf16 v[100:103], a[156:159], v[204:207], v[100:103]
 ds_read_b128 v[172:175], v18 offset:6144
 v_mfma_f32_16x16x32_bf16 v[104:107], a[160:163], v[204:207], v[104:107]
 v_mfma_f32_16x16x32_bf16 v[108:111], a[164:167], v[204:207], v[108:111]
 s_waitcnt lgkmcnt(2)
 v_mfma_f32_16x16x32_bf16 v[64:67], a[168:171], v[160:163], v[64:67]
 ds_read_b128 v[192:195], v19 offset:0
 v_mfma_f32_16x16x32_bf16 v[68:71], a[172:175], v[160:163], v[68:71]
 v_add_u32 v18, s33, v14
 v_mfma_f32_16x16x32_bf16 v[72:75], a[176:179], v[160:163], v[72:75]
 v_mfma_f32_16x16x32_bf16 v[76:79], a[168:171], v[164:167], v[76:79]
 ds_read_b128 v[196:199], v19 offset:2048
 v_mfma_f32_16x16x32_bf16 v[80:83], a[172:175], v[164:167], v[80:83]
 buffer_load_dwordx4 v11, s[8:11], s30 offen offset:1024 lds
 v_mfma_f32_16x16x32_bf16 v[84:87], a[176:179], v[164:167], v[84:87]
 s_waitcnt lgkmcnt(2)
 s_add_u32 s30, s30, 128
 v_mfma_f32_16x16x32_bf16 v[88:91], a[168:171], v[168:171], v[88:91]
 ds_read_b128 v[200:203], v19 offset:4096
 s_add_u32 m0, m0, 8192
 v_mfma_f32_16x16x32_bf16 v[92:95], a[172:175], v[168:171], v[92:95]
 s_cmp_lt_u32 m0, s46
 s_cselect_b32 m0, m0, s47
 v_mfma_f32_16x16x32_bf16 v[96:99], a[176:179], v[168:171], v[96:99]
 v_mfma_f32_16x16x32_bf16 v[100:103], a[168:171], v[172:175], v[100:103]
 ds_read_b128 v[204:207], v19 offset:6144
 v_mfma_f32_16x16x32_bf16 v[104:107], a[172:175], v[172:175], v[104:107]
 v_mfma_f32_16x16x32_bf16 v[108:111], a[176:179], v[172:175], v[108:111]
 s_waitcnt vmcnt(21) lgkmcnt(2)
 s_barrier
 v_mfma_f32_16x16x32_bf16 v[64:67], a[180:183], v[192:195], v[64:67]
 ds_read_b128 v[160:163], v18 offset:0
 v_mfma_f32_16x16x32_bf16 v[68:71], a[184:187], v[192:195], v[68:71]
 v_mfma_f32_16x16x32_bf16 v[72:75], a[188:191], v[192:195], v[72:75]
 v_add_u32 v19, s33, v15
 s_add_u32 s33, s33, 8192
 v_mfma_f32_16x16x32_bf16 v[76:79], a[180:183], v[196:199], v[76:79]
 ds_read_b128 v[164:167], v18 offset:2048
 v_mfma_f32_16x16x32_bf16 v[80:83], a[184:187], v[196:199], v[80:83]
 buffer_load_dwordx4 v10, s[8:11], s30 offen offset:0 lds
 v_mfma_f32_16x16x32_bf16 v[84:87], a[188:191], v[196:199], v[84:87]
 s_waitcnt lgkmcnt(2)
 v_mfma_f32_16x16x32_bf16 v[88:91], a[180:183], v[200:203], v[88:91]
 ds_read_b128 v[168:171], v18 offset:4096
 v_mfma_f32_16x16x32_bf16 v[92:95], a[184:187], v[200:203], v[92:95]
 s_cmp_lt_u32 s33, 155648
 s_cselect_b32 s33, s33, 98304
 v_mfma_f32_16x16x32_bf16 v[96:99], a[188:191], v[200:203], v[96:99]
 v_mfma_f32_16x16x32_bf16 v[100:103], a[180:183], v[204:207], v[100:103]
 ds_read_b128 v[172:175], v18 offset:6144
 v_mfma_f32_16x16x32_bf16 v[104:107], a[184:187], v[204:207], v[104:107]
 v_mfma_f32_16x16x32_bf16 v[108:111], a[188:191], v[204:207], v[108:111]
 s_waitcnt lgkmcnt(2)
 s_waitcnt vmcnt(9)
 s_barrier
 ds_read_b64_tr_b16 a[192:193], v46 offset:0
 ds_read_b64_tr_b16 a[194:195], v46 offset:1536
 ds_read_b64_tr_b16 a[196:197], v47 offset:0
 ds_read_b64_tr_b16 a[198:199], v47 offset:1536
 ds_read_b64_tr_b16 a[200:201], v48 offset:0
 ds_read_b64_tr_b16 a[202:203], v48 offset:1536
 ds_read_b64_tr_b16 a[204:205], v46 offset:12288
 ds_read_b64_tr_b16 a[206:207], v46 offset:13824
 ds_read_b64_tr_b16 a[208:209], v47 offset:12288
 ds_read_b64_tr_b16 a[210:211], v47 offset:13824
 ds_read_b64_tr_b16 a[212:213], v48 offset:12288
 ds_read_b64_tr_b16 a[214:215], v48 offset:13824
 ds_read_b64_tr_b16 a[216:217], v46 offset:24576
 ds_read_b64_tr_b16 a[218:219], v46 offset:26112
 ds_read_b64_tr_b16 a[220:221], v47 offset:24576
 ds_read_b64_tr_b16 a[222:223], v47 offset:26112
 ds_read_b64_tr_b16 a[224:225], v48 offset:24576
 ds_read_b64_tr_b16 a[226:227], v48 offset:26112
 ds_read_b64_tr_b16 a[228:229], v46 offset:36864
 ds_read_b64_tr_b16 a[230:231], v46 offset:38400
 ds_read_b64_tr_b16 a[232:233], v47 offset:36864
 ds_read_b64_tr_b16 a[234:235], v47 offset:38400
 ds_read_b64_tr_b16 a[236:237], v48 offset:36864
 ds_read_b64_tr_b16 a[238:239], v48 offset:38400
 s_waitcnt lgkmcnt(0)
 s_barrier
 v_mfma_f32_16x16x32_bf16 v[64:67], a[192:195], v[160:163], v[64:67]
 ds_read_b128 v[192:195], v19 offset:0
 v_mfma_f32_16x16x32_bf16 v[68:71], a[196:199], v[160:163], v[68:71]
 v_add_u32 v18, s33, v14
 v_mfma_f32_16x16x32_bf16 v[72:75], a[200:203], v[160:163], v[72:75]
 v_mfma_f32_16x16x32_bf16 v[76:79], a[192:195], v[164:167], v[76:79]
 ds_read_b128 v[196:199], v19 offset:2048
 v_mfma_f32_16x16x32_bf16 v[80:83], a[196:199], v[164:167], v[80:83]
 buffer_load_dwordx4 v11, s[8:11], s30 offen offset:1024 lds
 v_mfma_f32_16x16x32_bf16 v[84:87], a[200:203], v[164:167], v[84:87]
 s_add_u32 s30, s30, 128
 v_mfma_f32_16x16x32_bf16 v[88:91], a[192:195], v[168:171], v[88:91]
 ds_read_b128 v[200:203], v19 offset:4096
 s_add_u32 m0, m0, 8192
 v_mfma_f32_16x16x32_bf16 v[92:95], a[196:199], v[168:171], v[92:95]
 s_cmp_lt_u32 m0, s46
 s_cselect_b32 m0, m0, s47
 v_mfma_f32_16x16x32_bf16 v[96:99], a[200:203], v[168:171], v[96:99]
 v_mfma_f32_16x16x32_bf16 v[100:103], a[192:195], v[172:175], v[100:103]
 ds_read_b128 v[204:207], v19 offset:6144
 v_mfma_f32_16x16x32_bf16 v[104:107], a[196:199], v[172:175], v[104:107]
 v_mfma_f32_16x16x32_bf16 v[108:111], a[200:203], v[172:175], v[108:111]
 s_waitcnt vmcnt(8) lgkmcnt(2)
 s_barrier
 v_mfma_f32_16x16x32_bf16 v[64:67], a[204:207], v[192:195], v[64:67]
 ds_read_b128 v[160:163], v18 offset:0
 v_mfma_f32_16x16x32_bf16 v[68:71], a[208:211], v[192:195], v[68:71]
 v_mfma_f32_16x16x32_bf16 v[72:75], a[212:215], v[192:195], v[72:75]
 v_add_u32 v19, s33, v15
 s_add_u32 s33, s33, 8192
 v_mfma_f32_16x16x32_bf16 v[76:79], a[204:207], v[196:199], v[76:79]
 ds_read_b128 v[164:167], v18 offset:2048
 v_mfma_f32_16x16x32_bf16 v[80:83], a[208:211], v[196:199], v[80:83]
 buffer_load_dwordx4 v10, s[8:11], s30 offen offset:0 lds
 v_mfma_f32_16x16x32_bf16 v[84:87], a[212:215], v[196:199], v[84:87]
 s_waitcnt lgkmcnt(2)
 v_mfma_f32_16x16x32_bf16 v[88:91], a[204:207], v[200:203], v[88:91]
 ds_read_b128 v[168:171], v18 offset:4096
 v_mfma_f32_16x16x32_bf16 v[92:95], a[208:211], v[200:203], v[92:95]
 s_cmp_lt_u32 s33, 155648
 s_cselect_b32 s33, s33, 98304
 v_mfma_f32_16x16x32_bf16 v[96:99], a[212:215], v[200:203], v[96:99]
 v_mfma_f32_16x16x32_bf16 v[100:103], a[204:207], v[204:207], v[100:103]
 ds_read_b128 v[172:175], v18 offset:6144
 v_mfma_f32_16x16x32_bf16 v[104:107], a[208:211], v[204:207], v[104:107]
 v_mfma_f32_16x16x32_bf16 v[108:111], a[212:215], v[204:207], v[108:111]
 s_waitcnt lgkmcnt(2)
 v_mfma_f32_16x16x32_bf16 v[64:67], a[216:219], v[160:163], v[64:67]
 ds_read_b128 v[192:195], v19 offset:0
 v_mfma_f32_16x16x32_bf16 v[68:71], a[220:223], v[160:163], v[68:71]
 v_add_u32 v18, s33, v14
 v_mfma_f32_16x16x32_bf16 v[72:75], a[224:227], v[160:163], v[72:75]
 v_mfma_f32_16x16x32_bf16 v[76:79], a[216:219], v[164:167], v[76:79]
 ds_read_b128 v[196:199], v19 offset:2048
 v_mfma_f32_16x16x32_bf16 v[80:83], a[220:223], v[164:167], v[80:83]
 buffer_load_dwordx4 v11, s[8:11], s30 offen offset:1024 lds
 v_mfma_f32_16x16x32_bf16 v[84:87], a[224:227], v[164:167], v[84:87]
 s_waitcnt lgkmcnt(2)
 s_add_u32 s30, s30, 128
 v_mfma_f32_16x16x32_bf16 v[88:91], a[216:219], v[168:171], v[88:91]
 ds_read_b128 v[200:203], v19 offset:4096
 s_add_u32 m0, m0, 8192
 v_mfma_f32_16x16x32_bf16 v[92:95], a[220:223], v[168:171], v[92:95]
 s_cmp_lt_u32 m0, s46
 s_cselect_b32 m0, m0, s47
 v_mfma_f32_16x16x32_bf16 v[96:99], a[224:227], v[168:171], v[96:99]
 v_mfma_f32_16x16x32_bf16 v[100:103], a[216:219], v[172:175], v[100:103]
 ds_read_b128 v[204:207], v19 offset:6144
 v_mfma_f32_16x16x32_bf16 v[104:107], a[220:223], v[172:175], v[104:107]
 v_mfma_f32_16x16x32_bf16 v[108:111], a[224:227], v[172:175], v[108:111]
 s_waitcnt vmcnt(8) lgkmcnt(2)
 s_barrier
 v_mfma_f32_16x16x32_bf16 v[64:67], a[228:231], v[192:195], v[64:67]
 ds_read_b128 v[160:163], v18 offset:0
 v_mfma_f32_16x16x32_bf16 v[68:71], a[232:235], v[192:195], v[68:71]
 v_mfma_f32_16x16x32_bf16 v[72:75], a[236:239], v[192:195], v[72:75]
 v_add_u32 v19, s33, v15
 s_add_u32 s33, s33, 8192
 v_mfma_f32_16x16x32_bf16 v[76:79], a[228:231], v[196:199], v[76:79]
 ds_read_b128 v[164:167], v18 offset:2048
 v_cvt_pk_bf16_f32 v224, v64, v65
 v_cvt_pk_bf16_f32 v225, v66, v67
 v_mfma_f32_16x16x32_bf16 v[80:83], a[232:235], v[196:199], v[80:83]
 buffer_load_dwordx4 v10, s[8:11], s30 offen offset:0 lds
 v_cvt_pk_bf16_f32 v226, v68, v69
 v_cvt_pk_bf16_f32 v227, v70, v71
 v_mfma_f32_16x16x32_bf16 v[84:87], a[236:239], v[196:199], v[84:87]
 s_waitcnt lgkmcnt(2)
 v_cvt_pk_bf16_f32 v228, v72, v73
 v_cvt_pk_bf16_f32 v229, v74, v75
 v_mfma_f32_16x16x32_bf16 v[88:91], a[228:231], v[200:203], v[88:91]
 ds_read_b128 v[168:171], v18 offset:4096
 ds_write_b64 v22, v[224:225] offset:0
 v_mfma_f32_16x16x32_bf16 v[92:95], a[232:235], v[200:203], v[92:95]
 s_cmp_lt_u32 s33, 155648
 s_cselect_b32 s33, s33, 98304
 ds_write_b64 v22, v[226:227] offset:8
 v_mfma_f32_16x16x32_bf16 v[96:99], a[236:239], v[200:203], v[96:99]
 ds_write_b64 v16, v[228:229] offset:64
 v_cvt_pk_bf16_f32 v230, v76, v77
 v_cvt_pk_bf16_f32 v231, v78, v79
 v_mfma_f32_16x16x32_bf16 v[100:103], a[228:231], v[204:207], v[100:103]
 ds_read_b128 v[172:175], v18 offset:6144
 v_cvt_pk_bf16_f32 v232, v80, v81
 v_cvt_pk_bf16_f32 v233, v82, v83
 v_cvt_pk_bf16_f32 v234, v84, v85
 v_mfma_f32_16x16x32_bf16 v[104:107], a[232:235], v[204:207], v[104:107]
 v_cvt_pk_bf16_f32 v235, v86, v87
 ds_write_b64 v22, v[230:231] offset:6400
 v_mfma_f32_16x16x32_bf16 v[108:111], a[236:239], v[204:207], v[108:111]
 ds_write_b64 v22, v[232:233] offset:6408
 ds_write_b64 v16, v[234:235] offset:6464
 v_readfirstlane_b32 s21, v29
 s_cmp_ge_u32 s21, 32
 s_cbranch_scc1 kvz_126
 s_mov_b32 s21, 76
 v_mov_b32 v4, 0
 s_mov_b32 s101, 0
wf_127:
 buffer_load_dword v5, v4, s[64:67], s21 offen sc1
 s_add_u32 s101, s101, 1
 s_cmp_gt_u32 s101, 131072
 s_cbranch_scc1 main_end
 s_waitcnt vmcnt(0)
 v_readfirstlane_b32 s100, v5
 s_cmp_ge_u32 s100, 32
 s_cbranch_scc1 wf_128
 s_sleep 8
 s_branch wf_127
wf_128:
kvz_126:
 s_branch kvm_end_125
kvm_blk_124:
 v_mfma_f32_16x16x32_bf16 v[64:67], a[0:3], v[160:163], 0
 ds_read_b128 v[192:195], v19 offset:0
 v_mfma_f32_16x16x32_bf16 v[68:71], a[4:7], v[160:163], 0
 v_add_u32 v18, s33, v14
 v_mfma_f32_16x16x32_bf16 v[72:75], a[8:11], v[160:163], 0
 v_mfma_f32_16x16x32_bf16 v[76:79], a[0:3], v[164:167], 0
 ds_read_b128 v[196:199], v19 offset:2048
 v_mfma_f32_16x16x32_bf16 v[80:83], a[4:7], v[164:167], 0
 buffer_load_dwordx4 v11, s[8:11], s30 offen offset:1024 lds
 v_mfma_f32_16x16x32_bf16 v[84:87], a[8:11], v[164:167], 0
 s_waitcnt lgkmcnt(11)
 s_add_u32 s30, s30, 128
 v_mfma_f32_16x16x32_bf16 v[88:91], a[0:3], v[168:171], 0
 ds_read_b128 v[200:203], v19 offset:4096
 s_add_u32 m0, m0, 8192
 v_mfma_f32_16x16x32_bf16 v[92:95], a[4:7], v[168:171], 0
 s_cmp_lt_u32 m0, s46
 s_cselect_b32 m0, m0, s47
 v_mfma_f32_16x16x32_bf16 v[96:99], a[8:11], v[168:171], 0
 v_mfma_f32_16x16x32_bf16 v[100:103], a[0:3], v[172:175], 0
 ds_read_b128 v[204:207], v19 offset:6144
 v_mfma_f32_16x16x32_bf16 v[104:107], a[4:7], v[172:175], 0
 v_mfma_f32_16x16x32_bf16 v[108:111], a[8:11], v[172:175], 0
 s_waitcnt vmcnt(14) lgkmcnt(2)
 s_barrier
 v_mfma_f32_16x16x32_bf16 v[64:67], a[12:15], v[192:195], v[64:67]
 ds_read_b128 v[160:163], v18 offset:0
 v_mfma_f32_16x16x32_bf16 v[68:71], a[16:19], v[192:195], v[68:71]
 v_mfma_f32_16x16x32_bf16 v[72:75], a[20:23], v[192:195], v[72:75]
 v_add_u32 v19, s33, v15
 s_add_u32 s33, s33, 8192
 v_mfma_f32_16x16x32_bf16 v[76:79], a[12:15], v[196:199], v[76:79]
 ds_read_b128 v[164:167], v18 offset:2048
 v_mfma_f32_16x16x32_bf16 v[80:83], a[16:19], v[196:199], v[80:83]
 buffer_load_dwordx4 v10, s[8:11], s30 offen offset:0 lds
 v_mfma_f32_16x16x32_bf16 v[84:87], a[20:23], v[196:199], v[84:87]
 s_waitcnt lgkmcnt(2)
 v_mfma_f32_16x16x32_bf16 v[88:91], a[12:15], v[200:203], v[88:91]
 ds_read_b128 v[168:171], v18 offset:4096
 v_mfma_f32_16x16x32_bf16 v[92:95], a[16:19], v[200:203], v[92:95]
 s_cmp_lt_u32 s33, 155648
 s_cselect_b32 s33, s33, 98304
 v_mfma_f32_16x16x32_bf16 v[96:99], a[20:23], v[200:203], v[96:99]
 v_mfma_f32_16x16x32_bf16 v[100:103], a[12:15], v[204:207], v[100:103]
 ds_read_b128 v[172:175], v18 offset:6144
 v_mfma_f32_16x16x32_bf16 v[104:107], a[16:19], v[204:207], v[104:107]
 v_mfma_f32_16x16x32_bf16 v[108:111], a[20:23], v[204:207], v[108:111]
 s_waitcnt lgkmcnt(2)
 v_mfma_f32_16x16x32_bf16 v[64:67], a[24:27], v[160:163], v[64:67]
 ds_read_b128 v[192:195], v19 offset:0
 v_mfma_f32_16x16x32_bf16 v[68:71], a[28:31], v[160:163], v[68:71]
 v_add_u32 v18, s33, v14
 v_mfma_f32_16x16x32_bf16 v[72:75], a[32:35], v[160:163], v[72:75]
 v_mfma_f32_16x16x32_bf16 v[76:79], a[24:27], v[164:167], v[76:79]
 ds_read_b128 v[196:199], v19 offset:2048
 v_mfma_f32_16x16x32_bf16 v[80:83], a[28:31], v[164:167], v[80:83]
 buffer_load_dwordx4 v11, s[8:11], s30 offen offset:1024 lds
 v_mfma_f32_16x16x32_bf16 v[84:87], a[32:35], v[164:167], v[84:87]
 s_waitcnt lgkmcnt(2)
 s_add_u32 s30, s30, 128
 v_mfma_f32_16x16x32_bf16 v[88:91], a[24:27], v[168:171], v[88:91]
 ds_read_b128 v[200:203], v19 offset:4096
 s_add_u32 m0, m0, 8192
 v_mfma_f32_16x16x32_bf16 v[92:95], a[28:31], v[168:171], v[92:95]
 s_cmp_lt_u32 m0, s46
 s_cselect_b32 m0, m0, s47
 v_mfma_f32_16x16x32_bf16 v[96:99], a[32:35], v[168:171], v[96:99]
 v_mfma_f32_16x16x32_bf16 v[100:103], a[24:27], v[172:175], v[100:103]
 ds_read_b128 v[204:207], v19 offset:6144
 v_mfma_f32_16x16x32_bf16 v[104:107], a[28:31], v[172:175], v[104:107]
 v_mfma_f32_16x16x32_bf16 v[108:111], a[32:35], v[172:175], v[108:111]
 s_waitcnt vmcnt(14) lgkmcnt(2)
 s_barrier
 v_mfma_f32_16x16x32_bf16 v[64:67], a[36:39], v[192:195], v[64:67]
 ds_read_b128 v[160:163], v18 offset:0
 v_mfma_f32_16x16x32_bf16 v[68:71], a[40:43], v[192:195], v[68:71]
 v_mfma_f32_16x16x32_bf16 v[72:75], a[44:47], v[192:195], v[72:75]
 v_add_u32 v19, s33, v15
 s_add_u32 s33, s33, 8192
 v_mfma_f32_16x16x32_bf16 v[76:79], a[36:39], v[196:199], v[76:79]
 ds_read_b128 v[164:167], v18 offset:2048
 v_mfma_f32_16x16x32_bf16 v[80:83], a[40:43], v[196:199], v[80:83]
 buffer_load_dwordx4 v10, s[8:11], s30 offen offset:0 lds
 v_mfma_f32_16x16x32_bf16 v[84:87], a[44:47], v[196:199], v[84:87]
 s_waitcnt lgkmcnt(2)
 v_mfma_f32_16x16x32_bf16 v[88:91], a[36:39], v[200:203], v[88:91]
 ds_read_b128 v[168:171], v18 offset:4096
 v_mfma_f32_16x16x32_bf16 v[92:95], a[40:43], v[200:203], v[92:95]
 s_cmp_lt_u32 s33, 155648
 s_cselect_b32 s33, s33, 98304
 v_mfma_f32_16x16x32_bf16 v[96:99], a[44:47], v[200:203], v[96:99]
 v_mfma_f32_16x16x32_bf16 v[100:103], a[36:39], v[204:207], v[100:103]
 ds_read_b128 v[172:175], v18 offset:6144
 v_mfma_f32_16x16x32_bf16 v[104:107], a[40:43], v[204:207], v[104:107]
 v_mfma_f32_16x16x32_bf16 v[108:111], a[44:47], v[204:207], v[108:111]
 s_waitcnt lgkmcnt(2)
 v_mfma_f32_16x16x32_bf16 v[64:67], a[48:51], v[160:163], v[64:67]
 ds_read_b128 v[192:195], v19 offset:0
 v_mfma_f32_16x16x32_bf16 v[68:71], a[52:55], v[160:163], v[68:71]
 v_add_u32 v18, s33, v14
 v_mfma_f32_16x16x32_bf16 v[72:75], a[56:59], v[160:163], v[72:75]
 v_mfma_f32_16x16x32_bf16 v[76:79], a[48:51], v[164:167], v[76:79]
 ds_read_b128 v[196:199], v19 offset:2048
 v_mfma_f32_16x16x32_bf16 v[80:83], a[52:55], v[164:167], v[80:83]
 buffer_load_dwordx4 v11, s[8:11], s30 offen offset:1024 lds
 v_mfma_f32_16x16x32_bf16 v[84:87], a[56:59], v[164:167], v[84:87]
 s_waitcnt lgkmcnt(2)
 s_add_u32 s30, s30, 128
 v_mfma_f32_16x16x32_bf16 v[88:91], a[48:51], v[168:171], v[88:91]
 ds_read_b128 v[200:203], v19 offset:4096
 s_add_u32 m0, m0, 8192
 v_mfma_f32_16x16x32_bf16 v[92:95], a[52:55], v[168:171], v[92:95]
 s_cmp_lt_u32 m0, s46
 s_cselect_b32 m0, m0, s47
 v_mfma_f32_16x16x32_bf16 v[96:99], a[56:59], v[168:171], v[96:99]
 v_mfma_f32_16x16x32_bf16 v[100:103], a[48:51], v[172:175], v[100:103]
 ds_read_b128 v[204:207], v19 offset:6144
 v_mfma_f32_16x16x32_bf16 v[104:107], a[52:55], v[172:175], v[104:107]
 v_mfma_f32_16x16x32_bf16 v[108:111], a[56:59], v[172:175], v[108:111]
 s_waitcnt vmcnt(14) lgkmcnt(2)
 s_barrier
 v_mfma_f32_16x16x32_bf16 v[64:67], a[60:63], v[192:195], v[64:67]
 ds_read_b128 v[160:163], v18 offset:0
 v_mfma_f32_16x16x32_bf16 v[68:71], a[64:67], v[192:195], v[68:71]
 v_mfma_f32_16x16x32_bf16 v[72:75], a[68:71], v[192:195], v[72:75]
 v_add_u32 v19, s33, v15
 s_add_u32 s33, s33, 8192
 v_mfma_f32_16x16x32_bf16 v[76:79], a[60:63], v[196:199], v[76:79]
 ds_read_b128 v[164:167], v18 offset:2048
 v_mfma_f32_16x16x32_bf16 v[80:83], a[64:67], v[196:199], v[80:83]
 buffer_load_dwordx4 v10, s[8:11], s30 offen offset:0 lds
 v_mfma_f32_16x16x32_bf16 v[84:87], a[68:71], v[196:199], v[84:87]
 s_waitcnt lgkmcnt(2)
 v_mfma_f32_16x16x32_bf16 v[88:91], a[60:63], v[200:203], v[88:91]
 ds_read_b128 v[168:171], v18 offset:4096
 v_mfma_f32_16x16x32_bf16 v[92:95], a[64:67], v[200:203], v[92:95]
 s_cmp_lt_u32 s33, 155648
 s_cselect_b32 s33, s33, 98304
 v_mfma_f32_16x16x32_bf16 v[96:99], a[68:71], v[200:203], v[96:99]
 v_mfma_f32_16x16x32_bf16 v[100:103], a[60:63], v[204:207], v[100:103]
 ds_read_b128 v[172:175], v18 offset:6144
 v_mfma_f32_16x16x32_bf16 v[104:107], a[64:67], v[204:207], v[104:107]
 v_mfma_f32_16x16x32_bf16 v[108:111], a[68:71], v[204:207], v[108:111]
 s_waitcnt lgkmcnt(2)
 v_mfma_f32_16x16x32_bf16 v[64:67], a[72:75], v[160:163], v[64:67]
 ds_read_b128 v[192:195], v19 offset:0
 v_mfma_f32_16x16x32_bf16 v[68:71], a[76:79], v[160:163], v[68:71]
 v_add_u32 v18, s33, v14
 v_mfma_f32_16x16x32_bf16 v[72:75], a[80:83], v[160:163], v[72:75]
 v_mfma_f32_16x16x32_bf16 v[76:79], a[72:75], v[164:167], v[76:79]
 ds_read_b128 v[196:199], v19 offset:2048
 v_mfma_f32_16x16x32_bf16 v[80:83], a[76:79], v[164:167], v[80:83]
 buffer_load_dwordx4 v11, s[8:11], s30 offen offset:1024 lds
 v_mfma_f32_16x16x32_bf16 v[84:87], a[80:83], v[164:167], v[84:87]
 s_waitcnt lgkmcnt(2)
 s_add_u32 s30, s30, 128
 v_mfma_f32_16x16x32_bf16 v[88:91], a[72:75], v[168:171], v[88:91]
 ds_read_b128 v[200:203], v19 offset:4096
 s_add_u32 m0, m0, 8192
 v_mfma_f32_16x16x32_bf16 v[92:95], a[76:79], v[168:171], v[92:95]
 s_cmp_lt_u32 m0, s46
 s_cselect_b32 m0, m0, s47
 v_mfma_f32_16x16x32_bf16 v[96:99], a[80:83], v[168:171], v[96:99]
 v_mfma_f32_16x16x32_bf16 v[100:103], a[72:75], v[172:175], v[100:103]
 ds_read_b128 v[204:207], v19 offset:6144
 v_mfma_f32_16x16x32_bf16 v[104:107], a[76:79], v[172:175], v[104:107]
 v_mfma_f32_16x16x32_bf16 v[108:111], a[80:83], v[172:175], v[108:111]
 s_waitcnt vmcnt(7) lgkmcnt(2)
 s_barrier
 v_mfma_f32_16x16x32_bf16 v[64:67], a[84:87], v[192:195], v[64:67]
 ds_read_b128 v[160:163], v18 offset:0
 v_mfma_f32_16x16x32_bf16 v[68:71], a[88:91], v[192:195], v[68:71]
 s_cmp_eq_u32 s48, 0x80000000
 s_cbranch_scc1 kvm_122
 s_cmp_lg_u32 s20, 0
 s_cbranch_scc1 af_123
 v_mov_b32 v4, 0
 v_mov_b32 v5, 1
 s_mov_b64 exec, 1
 buffer_atomic_add v5, v4, s[72:75], s61 offen sc1
 s_mov_b64 exec, -1
 s_nop 1
af_123:
kvm_122:
 v_mfma_f32_16x16x32_bf16 v[72:75], a[92:95], v[192:195], v[72:75]
 v_add_u32 v19, s33, v15
 s_add_u32 s33, s33, 8192
 v_mfma_f32_16x16x32_bf16 v[76:79], a[84:87], v[196:199], v[76:79]
 ds_read_b128 v[164:167], v18 offset:2048
 v_mfma_f32_16x16x32_bf16 v[80:83], a[88:91], v[196:199], v[80:83]
 buffer_load_dwordx4 v10, s[8:11], s30 offen offset:0 lds
 v_mfma_f32_16x16x32_bf16 v[84:87], a[92:95], v[196:199], v[84:87]
 s_waitcnt lgkmcnt(2)
 v_mfma_f32_16x16x32_bf16 v[88:91], a[84:87], v[200:203], v[88:91]
 ds_read_b128 v[168:171], v18 offset:4096
 v_mfma_f32_16x16x32_bf16 v[92:95], a[88:91], v[200:203], v[92:95]
 s_cmp_lt_u32 s33, 155648
 s_cselect_b32 s33, s33, 98304
 v_mfma_f32_16x16x32_bf16 v[96:99], a[92:95], v[200:203], v[96:99]
 v_mfma_f32_16x16x32_bf16 v[100:103], a[84:87], v[204:207], v[100:103]
 ds_read_b128 v[172:175], v18 offset:6144
 v_mfma_f32_16x16x32_bf16 v[104:107], a[88:91], v[204:207], v[104:107]
 v_mfma_f32_16x16x32_bf16 v[108:111], a[92:95], v[204:207], v[108:111]
 s_waitcnt lgkmcnt(2)
 v_mfma_f32_16x16x32_bf16 v[64:67], a[96:99], v[160:163], v[64:67]
 ds_read_b128 v[192:195], v19 offset:0
 v_mfma_f32_16x16x32_bf16 v[68:71], a[100:103], v[160:163], v[68:71]
 v_add_u32 v18, s33, v14
 s_mov_b32 s61, s60
 v_mfma_f32_16x16x32_bf16 v[72:75], a[104:107], v[160:163], v[72:75]
 s_add_u32 s60, s60, s62
 s_lshr_b32 s48, s20, 1
 v_mfma_f32_16x16x32_bf16 v[76:79], a[96:99], v[164:167], v[76:79]
 ds_read_b128 v[196:199], v19 offset:2048
 s_mul_i32 s48, s48, 393216
 v_mfma_f32_16x16x32_bf16 v[80:83], a[100:103], v[164:167], v[80:83]
 buffer_load_dwordx4 v11, s[8:11], s30 offen offset:1024 lds
 v_mfma_f32_16x16x32_bf16 v[84:87], a[104:107], v[164:167], v[84:87]
 s_waitcnt lgkmcnt(2)
 s_add_u32 s30, s30, s25
 v_mfma_f32_16x16x32_bf16 v[88:91], a[96:99], v[168:171], v[88:91]
 ds_read_b128 v[200:203], v19 offset:4096
 s_sub_u32 s30, s30, 1152
 v_mfma_f32_16x16x32_bf16 v[92:95], a[100:103], v[168:171], v[92:95]
 s_add_u32 m0, m0, 8192
 s_and_b32 s21, s20, 1
 v_mfma_f32_16x16x32_bf16 v[96:99], a[104:107], v[168:171], v[96:99]
 s_cmp_lt_u32 m0, s46
 s_cselect_b32 m0, m0, s47
 v_mfma_f32_16x16x32_bf16 v[100:103], a[96:99], v[172:175], v[100:103]
 ds_read_b128 v[204:207], v19 offset:6144
 s_mul_i32 s21, s21, 6144
 v_mfma_f32_16x16x32_bf16 v[104:107], a[100:103], v[172:175], v[104:107]
 s_add_u32 s48, s48, s21
 s_add_u32 s48, s48, s27
 v_mfma_f32_16x16x32_bf16 v[108:111], a[104:107], v[172:175], v[108:111]
 s_waitcnt vmcnt(8) lgkmcnt(2)
 s_barrier
 v_mfma_f32_16x16x32_bf16 v[64:67], a[108:111], v[192:195], v[64:67]
 ds_read_b128 v[160:163], v18 offset:0
 s_add_u32 s27, s27, s28
 v_mfma_f32_16x16x32_bf16 v[68:71], a[112:115], v[192:195], v[68:71]
 s_sub_u32 s26, s26, 1
 v_mfma_f32_16x16x32_bf16 v[72:75], a[116:119], v[192:195], v[72:75]
 v_add_u32 v19, s33, v15
 s_add_u32 s33, s33, 8192
 v_mfma_f32_16x16x32_bf16 v[76:79], a[108:111], v[196:199], v[76:79]
 ds_read_b128 v[164:167], v18 offset:2048
 v_mfma_f32_16x16x32_bf16 v[80:83], a[112:115], v[196:199], v[80:83]
 buffer_load_dwordx4 v10, s[8:11], s30 offen offset:0 lds
 v_mfma_f32_16x16x32_bf16 v[84:87], a[116:119], v[196:199], v[84:87]
 s_waitcnt lgkmcnt(2)
 v_mfma_f32_16x16x32_bf16 v[88:91], a[108:111], v[200:203], v[88:91]
 ds_read_b128 v[168:171], v18 offset:4096
 v_mfma_f32_16x16x32_bf16 v[92:95], a[112:115], v[200:203], v[92:95]
 s_cmp_lt_u32 s33, 155648
 s_cselect_b32 s33, s33, 98304
 v_mfma_f32_16x16x32_bf16 v[96:99], a[116:119], v[200:203], v[96:99]
 v_mfma_f32_16x16x32_bf16 v[100:103], a[108:111], v[204:207], v[100:103]
 ds_read_b128 v[172:175], v18 offset:6144
 v_mfma_f32_16x16x32_bf16 v[104:107], a[112:115], v[204:207], v[104:107]
 v_mfma_f32_16x16x32_bf16 v[108:111], a[116:119], v[204:207], v[108:111]
 s_waitcnt lgkmcnt(2)
 v_mfma_f32_16x16x32_bf16 v[64:67], a[120:123], v[160:163], v[64:67]
 ds_read_b128 v[192:195], v19 offset:0
 v_mfma_f32_16x16x32_bf16 v[68:71], a[124:127], v[160:163], v[68:71]
 v_add_u32 v18, s33, v14
 v_mfma_f32_16x16x32_bf16 v[72:75], a[128:131], v[160:163], v[72:75]
 v_mfma_f32_16x16x32_bf16 v[76:79], a[120:123], v[164:167], v[76:79]
 ds_read_b128 v[196:199], v19 offset:2048
 v_mfma_f32_16x16x32_bf16 v[80:83], a[124:127], v[164:167], v[80:83]
 buffer_load_dwordx4 v11, s[8:11], s30 offen offset:1024 lds
 v_mfma_f32_16x16x32_bf16 v[84:87], a[128:131], v[164:167], v[84:87]
 s_waitcnt lgkmcnt(2)
 s_add_u32 s30, s30, 128
 v_mfma_f32_16x16x32_bf16 v[88:91], a[120:123], v[168:171], v[88:91]
 ds_read_b128 v[200:203], v19 offset:4096
 s_add_u32 m0, m0, 8192
 v_mfma_f32_16x16x32_bf16 v[92:95], a[124:127], v[168:171], v[92:95]
 s_cmp_lt_u32 m0, s46
 s_cselect_b32 m0, m0, s47
 v_mfma_f32_16x16x32_bf16 v[96:99], a[128:131], v[168:171], v[96:99]
 v_mfma_f32_16x16x32_bf16 v[100:103], a[120:123], v[172:175], v[100:103]
 ds_read_b128 v[204:207], v19 offset:6144
 v_mfma_f32_16x16x32_bf16 v[104:107], a[124:127], v[172:175], v[104:107]
 v_mfma_f32_16x16x32_bf16 v[108:111], a[128:131], v[172:175], v[108:111]
 s_waitcnt vmcnt(8) lgkmcnt(2)
 s_barrier
 v_mfma_f32_16x16x32_bf16 v[64:67], a[132:135], v[192:195], v[64:67]
 ds_read_b128 v[160:163], v18 offset:0
 v_mfma_f32_16x16x32_bf16 v[68:71], a[136:139], v[192:195], v[68:71]
 v_mfma_f32_16x16x32_bf16 v[72:75], a[140:143], v[192:195], v[72:75]
 v_add_u32 v19, s33, v15
 s_add_u32 s33, s33, 8192
 v_mfma_f32_16x16x32_bf16 v[76:79], a[132:135], v[196:199], v[76:79]
 ds_read_b128 v[164:167], v18 offset:2048
 v_mfma_f32_16x16x32_bf16 v[80:83], a[136:139], v[196:199], v[80:83]
 buffer_load_dwordx4 v10, s[8:11], s30 offen offset:0 lds
 v_mfma_f32_16x16x32_bf16 v[84:87], a[140:143], v[196:199], v[84:87]
 s_waitcnt lgkmcnt(2)
 v_mfma_f32_16x16x32_bf16 v[88:91], a[132:135], v[200:203], v[88:91]
 ds_read_b128 v[168:171], v18 offset:4096
 v_mfma_f32_16x16x32_bf16 v[92:95], a[136:139], v[200:203], v[92:95]
 s_cmp_lt_u32 s33, 155648
 s_cselect_b32 s33, s33, 98304
 v_mfma_f32_16x16x32_bf16 v[96:99], a[140:143], v[200:203], v[96:99]
 v_mfma_f32_16x16x32_bf16 v[100:103], a[132:135], v[204:207], v[100:103]
 ds_read_b128 v[172:175], v18 offset:6144
 v_mfma_f32_16x16x32_bf16 v[104:107], a[136:139], v[204:207], v[104:107]
 v_mfma_f32_16x16x32_bf16 v[108:111], a[140:143], v[204:207], v[108:111]
 s_waitcnt lgkmcnt(2)
 v_mfma_f32_16x16x32_bf16 v[64:67], a[144:147], v[160:163], v[64:67]
 ds_read_b128 v[192:195], v19 offset:0
 v_mfma_f32_16x16x32_bf16 v[68:71], a[148:151], v[160:163], v[68:71]
 v_add_u32 v18, s33, v14
 v_mfma_f32_16x16x32_bf16 v[72:75], a[152:155], v[160:163], v[72:75]
 v_mfma_f32_16x16x32_bf16 v[76:79], a[144:147], v[164:167], v[76:79]
 ds_read_b128 v[196:199], v19 offset:2048
 v_mfma_f32_16x16x32_bf16 v[80:83], a[148:151], v[164:167], v[80:83]
 buffer_load_dwordx4 v11, s[8:11], s30 offen offset:1024 lds
 v_mfma_f32_16x16x32_bf16 v[84:87], a[152:155], v[164:167], v[84:87]
 s_waitcnt lgkmcnt(2)
 s_add_u32 s30, s30, 128
 v_mfma_f32_16x16x32_bf16 v[88:91], a[144:147], v[168:171], v[88:91]
 ds_read_b128 v[200:203], v19 offset:4096
 s_add_u32 m0, m0, 8192
 v_mfma_f32_16x16x32_bf16 v[92:95], a[148:151], v[168:171], v[92:95]
 s_cmp_lt_u32 m0, s46
 s_cselect_b32 m0, m0, s47
 v_mfma_f32_16x16x32_bf16 v[96:99], a[152:155], v[168:171], v[96:99]
 v_mfma_f32_16x16x32_bf16 v[100:103], a[144:147], v[172:175], v[100:103]
 ds_read_b128 v[204:207], v19 offset:6144
 v_mfma_f32_16x16x32_bf16 v[104:107], a[148:151], v[172:175], v[104:107]
 v_mfma_f32_16x16x32_bf16 v[108:111], a[152:155], v[172:175], v[108:111]
 s_waitcnt vmcnt(8) lgkmcnt(2)
 s_barrier
 v_mfma_f32_16x16x32_bf16 v[64:67], a[156:159], v[192:195], v[64:67]
 ds_read_b128 v[160:163], v18 offset:0
 v_mfma_f32_16x16x32_bf16 v[68:71], a[160:163], v[192:195], v[68:71]
 v_mfma_f32_16x16x32_bf16 v[72:75], a[164:167], v[192:195], v[72:75]
 v_add_u32 v19, s33, v15
 s_add_u32 s33, s33, 8192
 v_mfma_f32_16x16x32_bf16 v[76:79], a[156:159], v[196:199], v[76:79]
 ds_read_b128 v[164:167], v18 offset:2048
 v_mfma_f32_16x16x32_bf16 v[80:83], a[160:163], v[196:199], v[80:83]
 buffer_load_dwordx4 v10, s[8:11], s30 offen offset:0 lds
 v_mfma_f32_16x16x32_bf16 v[84:87], a[164:167], v[196:199], v[84:87]
 s_waitcnt lgkmcnt(2)
 v_mfma_f32_16x16x32_bf16 v[88:91], a[156:159], v[200:203], v[88:91]
 ds_read_b128 v[168:171], v18 offset:4096
 v_mfma_f32_16x16x32_bf16 v[92:95], a[160:163], v[200:203], v[92:95]
 s_cmp_lt_u32 s33, 155648
 s_cselect_b32 s33, s33, 98304
 v_mfma_f32_16x16x32_bf16 v[96:99], a[164:167], v[200:203], v[96:99]
 v_mfma_f32_16x16x32_bf16 v[100:103], a[156:159], v[204:207], v[100:103]
 ds_read_b128 v[172:175], v18 offset:6144
 v_mfma_f32_16x16x32_bf16 v[104:107], a[160:163], v[204:207], v[104:107]
 v_mfma_f32_16x16x32_bf16 v[108:111], a[164:167], v[204:207], v[108:111]
 s_waitcnt lgkmcnt(2)
 v_mfma_f32_16x16x32_bf16 v[64:67], a[168:171], v[160:163], v[64:67]
 ds_read_b128 v[192:195], v19 offset:0
 v_mfma_f32_16x16x32_bf16 v[68:71], a[172:175], v[160:163], v[68:71]
 v_add_u32 v18, s33, v14
 v_mfma_f32_16x16x32_bf16 v[72:75], a[176:179], v[160:163], v[72:75]
 v_mfma_f32_16x16x32_bf16 v[76:79], a[168:171], v[164:167], v[76:79]
 ds_read_b128 v[196:199], v19 offset:2048
 v_mfma_f32_16x16x32_bf16 v[80:83], a[172:175], v[164:167], v[80:83]
 buffer_load_dwordx4 v11, s[8:11], s30 offen offset:1024 lds
 v_mfma_f32_16x16x32_bf16 v[84:87], a[176:179], v[164:167], v[84:87]
 s_waitcnt lgkmcnt(2)
 s_add_u32 s30, s30, 128
 v_mfma_f32_16x16x32_bf16 v[88:91], a[168:171], v[168:171], v[88:91]
 ds_read_b128 v[200:203], v19 offset:4096
 s_add_u32 m0, m0, 8192
 v_mfma_f32_16x16x32_bf16 v[92:95], a[172:175], v[168:171], v[92:95]
 s_cmp_lt_u32 m0, s46
 s_cselect_b32 m0, m0, s47
 v_mfma_f32_16x16x32_bf16 v[96:99], a[176:179], v[168:171], v[96:99]
 v_mfma_f32_16x16x32_bf16 v[100:103], a[168:171], v[172:175], v[100:103]
 ds_read_b128 v[204:207], v19 offset:6144
 v_mfma_f32_16x16x32_bf16 v[104:107], a[172:175], v[172:175], v[104:107]
 v_mfma_f32_16x16x32_bf16 v[108:111], a[176:179], v[172:175], v[108:111]
 s_waitcnt vmcnt(8) lgkmcnt(2)
 s_barrier
 v_mfma_f32_16x16x32_bf16 v[64:67], a[180:183], v[192:195], v[64:67]
 ds_read_b128 v[160:163], v18 offset:0
 v_mfma_f32_16x16x32_bf16 v[68:71], a[184:187], v[192:195], v[68:71]
 v_mfma_f32_16x16x32_bf16 v[72:75], a[188:191], v[192:195], v[72:75]
 v_add_u32 v19, s33, v15
 s_add_u32 s33, s33, 8192
 v_mfma_f32_16x16x32_bf16 v[76:79], a[180:183], v[196:199], v[76:79]
 ds_read_b128 v[164:167], v18 offset:2048
 v_mfma_f32_16x16x32_bf16 v[80:83], a[184:187], v[196:199], v[80:83]
 buffer_load_dwordx4 v10, s[8:11], s30 offen offset:0 lds
 v_mfma_f32_16x16x32_bf16 v[84:87], a[188:191], v[196:199], v[84:87]
 s_waitcnt lgkmcnt(2)
 v_mfma_f32_16x16x32_bf16 v[88:91], a[180:183], v[200:203], v[88:91]
 ds_read_b128 v[168:171], v18 offset:4096
 v_mfma_f32_16x16x32_bf16 v[92:95], a[184:187], v[200:203], v[92:95]
 s_cmp_lt_u32 s33, 155648
 s_cselect_b32 s33, s33, 98304
 v_mfma_f32_16x16x32_bf16 v[96:99], a[188:191], v[200:203], v[96:99]
 v_mfma_f32_16x16x32_bf16 v[100:103], a[180:183], v[204:207], v[100:103]
 ds_read_b128 v[172:175], v18 offset:6144
 v_mfma_f32_16x16x32_bf16 v[104:107], a[184:187], v[204:207], v[104:107]
 v_mfma_f32_16x16x32_bf16 v[108:111], a[188:191], v[204:207], v[108:111]
 s_waitcnt lgkmcnt(2)
 v_mfma_f32_16x16x32_bf16 v[64:67], a[192:195], v[160:163], v[64:67]
 ds_read_b128 v[192:195], v19 offset:0
 v_mfma_f32_16x16x32_bf16 v[68:71], a[196:199], v[160:163], v[68:71]
 v_add_u32 v18, s33, v14
 v_mfma_f32_16x16x32_bf16 v[72:75], a[200:203], v[160:163], v[72:75]
 v_mfma_f32_16x16x32_bf16 v[76:79], a[192:195], v[164:167], v[76:79]
 ds_read_b128 v[196:199], v19 offset:2048
 v_mfma_f32_16x16x32_bf16 v[80:83], a[196:199], v[164:167], v[80:83]
 buffer_load_dwordx4 v11, s[8:11], s30 offen offset:1024 lds
 v_mfma_f32_16x16x32_bf16 v[84:87], a[200:203], v[164:167], v[84:87]
 s_waitcnt lgkmcnt(2)
 s_add_u32 s30, s30, 128
 v_mfma_f32_16x16x32_bf16 v[88:91], a[192:195], v[168:171], v[88:91]
 ds_read_b128 v[200:203], v19 offset:4096
 s_add_u32 m0, m0, 8192
 v_mfma_f32_16x16x32_bf16 v[92:95], a[196:199], v[168:171], v[92:95]
 s_cmp_lt_u32 m0, s46
 s_cselect_b32 m0, m0, s47
 v_mfma_f32_16x16x32_bf16 v[96:99], a[200:203], v[168:171], v[96:99]
 v_mfma_f32_16x16x32_bf16 v[100:103], a[192:195], v[172:175], v[100:103]
 ds_read_b128 v[204:207], v19 offset:6144
 v_mfma_f32_16x16x32_bf16 v[104:107], a[196:199], v[172:175], v[104:107]
 v_mfma_f32_16x16x32_bf16 v[108:111], a[200:203], v[172:175], v[108:111]
 s_waitcnt vmcnt(8) lgkmcnt(2)
 s_barrier
 v_mfma_f32_16x16x32_bf16 v[64:67], a[204:207], v[192:195], v[64:67]
 ds_read_b128 v[160:163], v18 offset:0
 v_mfma_f32_16x16x32_bf16 v[68:71], a[208:211], v[192:195], v[68:71]
 v_mfma_f32_16x16x32_bf16 v[72:75], a[212:215], v[192:195], v[72:75]
 v_add_u32 v19, s33, v15
 s_add_u32 s33, s33, 8192
 v_mfma_f32_16x16x32_bf16 v[76:79], a[204:207], v[196:199], v[76:79]
 ds_read_b128 v[164:167], v18 offset:2048
 v_mfma_f32_16x16x32_bf16 v[80:83], a[208:211], v[196:199], v[80:83]
 buffer_load_dwordx4 v10, s[8:11], s30 offen offset:0 lds
 v_mfma_f32_16x16x32_bf16 v[84:87], a[212:215], v[196:199], v[84:87]
 s_waitcnt lgkmcnt(2)
 v_mfma_f32_16x16x32_bf16 v[88:91], a[204:207], v[200:203], v[88:91]
 ds_read_b128 v[168:171], v18 offset:4096
 v_mfma_f32_16x16x32_bf16 v[92:95], a[208:211], v[200:203], v[92:95]
 s_cmp_lt_u32 s33, 155648
 s_cselect_b32 s33, s33, 98304
 v_mfma_f32_16x16x32_bf16 v[96:99], a[212:215], v[200:203], v[96:99]
 v_mfma_f32_16x16x32_bf16 v[100:103], a[204:207], v[204:207], v[100:103]
 ds_read_b128 v[172:175], v18 offset:6144
 v_mfma_f32_16x16x32_bf16 v[104:107], a[208:211], v[204:207], v[104:107]
 v_mfma_f32_16x16x32_bf16 v[108:111], a[212:215], v[204:207], v[108:111]
 s_waitcnt lgkmcnt(2)
 v_mfma_f32_16x16x32_bf16 v[64:67], a[216:219], v[160:163], v[64:67]
 ds_read_b128 v[192:195], v19 offset:0
 v_mfma_f32_16x16x32_bf16 v[68:71], a[220:223], v[160:163], v[68:71]
 v_add_u32 v18, s33, v14
 v_mfma_f32_16x16x32_bf16 v[72:75], a[224:227], v[160:163], v[72:75]
 v_mfma_f32_16x16x32_bf16 v[76:79], a[216:219], v[164:167], v[76:79]
 ds_read_b128 v[196:199], v19 offset:2048
 v_mfma_f32_16x16x32_bf16 v[80:83], a[220:223], v[164:167], v[80:83]
 buffer_load_dwordx4 v11, s[8:11], s30 offen offset:1024 lds
 v_mfma_f32_16x16x32_bf16 v[84:87], a[224:227], v[164:167], v[84:87]
 s_waitcnt lgkmcnt(2)
 s_add_u32 s30, s30, 128
 v_mfma_f32_16x16x32_bf16 v[88:91], a[216:219], v[168:171], v[88:91]
 ds_read_b128 v[200:203], v19 offset:4096
 s_add_u32 m0, m0, 8192
 v_mfma_f32_16x16x32_bf16 v[92:95], a[220:223], v[168:171], v[92:95]
 s_cmp_lt_u32 m0, s46
 s_cselect_b32 m0, m0, s47
 v_mfma_f32_16x16x32_bf16 v[96:99], a[224:227], v[168:171], v[96:99]
 v_mfma_f32_16x16x32_bf16 v[100:103], a[216:219], v[172:175], v[100:103]
 ds_read_b128 v[204:207], v19 offset:6144
 v_mfma_f32_16x16x32_bf16 v[104:107], a[220:223], v[172:175], v[104:107]
 v_mfma_f32_16x16x32_bf16 v[108:111], a[224:227], v[172:175], v[108:111]
 s_waitcnt vmcnt(8) lgkmcnt(2)
 s_barrier
 v_mfma_f32_16x16x32_bf16 v[64:67], a[228:231], v[192:195], v[64:67]
 ds_read_b128 v[160:163], v18 offset:0
 v_mfma_f32_16x16x32_bf16 v[68:71], a[232:235], v[192:195], v[68:71]
 v_mfma_f32_16x16x32_bf16 v[72:75], a[236:239], v[192:195], v[72:75]
 v_add_u32 v19, s33, v15
 s_add_u32 s33, s33, 8192
 v_mfma_f32_16x16x32_bf16 v[76:79], a[228:231], v[196:199], v[76:79]
 ds_read_b128 v[164:167], v18 offset:2048
 v_cvt_pk_bf16_f32 v224, v64, v65
 v_cvt_pk_bf16_f32 v225, v66, v67
 v_mfma_f32_16x16x32_bf16 v[80:83], a[232:235], v[196:199], v[80:83]
 buffer_load_dwordx4 v10, s[8:11], s30 offen offset:0 lds
 v_cvt_pk_bf16_f32 v226, v68, v69
 v_cvt_pk_bf16_f32 v227, v70, v71
 v_mfma_f32_16x16x32_bf16 v[84:87], a[236:239], v[196:199], v[84:87]
 s_waitcnt lgkmcnt(2)
 v_cvt_pk_bf16_f32 v228, v72, v73
 v_cvt_pk_bf16_f32 v229, v74, v75
 v_mfma_f32_16x16x32_bf16 v[88:91], a[228:231], v[200:203], v[88:91]
 ds_read_b128 v[168:171], v18 offset:4096
 ds_write_b64 v22, v[224:225] offset:0
 v_mfma_f32_16x16x32_bf16 v[92:95], a[232:235], v[200:203], v[92:95]
 s_cmp_lt_u32 s33, 155648
 s_cselect_b32 s33, s33, 98304
 ds_write_b64 v22, v[226:227] offset:8
 v_mfma_f32_16x16x32_bf16 v[96:99], a[236:239], v[200:203], v[96:99]
 ds_write_b64 v16, v[228:229] offset:64
 v_cvt_pk_bf16_f32 v230, v76, v77
 v_cvt_pk_bf16_f32 v231, v78, v79
 v_mfma_f32_16x16x32_bf16 v[100:103], a[228:231], v[204:207], v[100:103]
 ds_read_b128 v[172:175], v18 offset:6144
 v_cvt_pk_bf16_f32 v232, v80, v81
 v_cvt_pk_bf16_f32 v233, v82, v83
 v_cvt_pk_bf16_f32 v234, v84, v85
 v_mfma_f32_16x16x32_bf16 v[104:107], a[232:235], v[204:207], v[104:107]
 v_cvt_pk_bf16_f32 v235, v86, v87
 ds_write_b64 v22, v[230:231] offset:6400
 v_mfma_f32_16x16x32_bf16 v[108:111], a[236:239], v[204:207], v[108:111]
 ds_write_b64 v22, v[232:233] offset:6408
 ds_write_b64 v16, v[234:235] offset:6464
kvm_end_125:
 v_cvt_pk_bf16_f32 v236, v88, v89
 v_cvt_pk_bf16_f32 v237, v90, v91
 v_cvt_pk_bf16_f32 v238, v92, v93
 v_cvt_pk_bf16_f32 v239, v94, v95
 v_cvt_pk_bf16_f32 v240, v96, v97
 v_cvt_pk_bf16_f32 v241, v98, v99
 ds_write_b64 v22, v[236:237] offset:12800
 ds_write_b64 v22, v[238:239] offset:12808
 ds_write_b64 v16, v[240:241] offset:12864
 v_cvt_pk_bf16_f32 v242, v100, v101
 v_cvt_pk_bf16_f32 v243, v102, v103
 v_cvt_pk_bf16_f32 v244, v104, v105
 v_cvt_pk_bf16_f32 v245, v106, v107
 v_cvt_pk_bf16_f32 v246, v108, v109
 v_cvt_pk_bf16_f32 v247, v110, v111
 ds_write_b64 v22, v[242:243] offset:19200
 ds_write_b64 v22, v[244:245] offset:19208
 ds_write_b64 v16, v[246:247] offset:19264
 s_waitcnt lgkmcnt(0)
 s_barrier
 ds_read_b128 v[224:227], v23 offset:0
 ds_read_b128 v[228:231], v23 offset:64
 ds_read_b128 v[232:235], v23 offset:128
 ds_read_b128 v[236:239], v23 offset:192
 ds_read_b128 v[240:243], v23 offset:256
 ds_read_b128 v[244:247], v23 offset:320
 s_waitcnt lgkmcnt(0)
 s_add_u32 s21, s48, 0
 buffer_store_dwordx4 v[224:227], v26, s[16:19], s21 offen offset:0 sc1
 buffer_store_dwordx4 v[228:231], v26, s[16:19], s21 offen offset:1024 sc1
 buffer_store_dwordx4 v[232:235], v26, s[16:19], s21 offen offset:2048 sc1
 buffer_store_dwordx4 v[236:239], v26, s[16:19], s21 offen offset:3072 sc1
 s_add_u32 s21, s48, 4096
 buffer_store_dwordx4 v[240:243], v26, s[16:19], s21 offen offset:0 sc1
 buffer_store_dwordx4 v[244:247], v26, s[16:19], s21 offen offset:1024 sc1
 s_nop 1
 s_cmp_gt_u32 s26, 0
 s_cbranch_scc1 kvm_blk_124
 s_waitcnt vmcnt(6)
 s_barrier
 v_mov_b32 v29, 84
 buffer_load_dword v29, v29, s[64:67], 0 offen sc1
 s_mov_b32 s24, 491520
 s_mov_b32 s25, 163840
 v_lshrrev_b32 v11, 3, v1
 v_and_b32 v12, 7, v1
 v_xor_b32 v12, v12, v11
 v_mul_u32_u24 v11, 1280, v11
 v_lshl_add_u32 v10, v12, 4, v11
 s_mul_i32 s46, s20, 40960
 v_add_u32 v10, s46, v10
 s_lshl_b32 s47, s20, 12
 s_add_u32 s47, s47, 0
 s_add_u32 s46, s47, 98304
 s_mov_b32 s30, s24
 s_add_u32 s32, s47, 32768
 v_add_u32 v11, 9216, v10
 v_add_u32 v12, 18432, v10
 v_add_u32 v13, 27648, v10
 s_mov_b32 m0, s32
 s_nop 0
 buffer_load_dwordx4 v10, s[8:11], s30 offen offset:0 lds
 buffer_load_dwordx4 v11, s[8:11], s30 offen offset:1024 lds
 buffer_load_dwordx4 v12, s[8:11], s30 offen offset:2048 lds
 buffer_load_dwordx4 v13, s[8:11], s30 offen offset:3072 lds
 s_add_u32 s30, s30, 128
 s_add_u32 s32, s32, 16384
 s_cmp_lt_u32 s32, s46
 s_cselect_b32 s32, s32, s47
 s_mov_b32 m0, s32
 s_nop 0
 buffer_load_dwordx4 v10, s[8:11], s30 offen offset:0 lds
 buffer_load_dwordx4 v11, s[8:11], s30 offen offset:1024 lds
 buffer_load_dwordx4 v12, s[8:11], s30 offen offset:2048 lds
 buffer_load_dwordx4 v13, s[8:11], s30 offen offset:3072 lds
 s_add_u32 s30, s30, 128
 s_add_u32 s32, s32, 16384
 s_cmp_lt_u32 s32, s46
 s_cselect_b32 s32, s32, s47
 s_mov_b32 m0, s32
 s_nop 0
 buffer_load_dwordx4 v10, s[8:11], s30 offen offset:0 lds
 buffer_load_dwordx4 v11, s[8:11], s30 offen offset:1024 lds
 buffer_load_dwordx4 v12, s[8:11], s30 offen offset:2048 lds
 buffer_load_dwordx4 v13, s[8:11], s30 offen offset:3072 lds
 s_add_u32 s30, s30, 128
 s_add_u32 s32, s32, 16384
 s_cmp_lt_u32 s32, s46
 s_cselect_b32 s32, s32, s47
 s_mov_b32 m0, s32
 s_nop 0
 buffer_load_dwordx4 v10, s[8:11], s30 offen offset:0 lds
 buffer_load_dwordx4 v11, s[8:11], s30 offen offset:1024 lds
 buffer_load_dwordx4 v12, s[8:11], s30 offen offset:2048 lds
 buffer_load_dwordx4 v13, s[8:11], s30 offen offset:3072 lds
 s_add_u32 s30, s30, 128
 s_add_u32 s32, s32, 16384
 s_cmp_lt_u32 s32, s46
 s_cselect_b32 s32, s32, s47
 s_waitcnt vmcnt(16)
 s_barrier
 s_cmp_lg_u32 s20, 0
 s_cbranch_scc1 af_129
 v_mov_b32 v4, 0
 v_mov_b32 v5, 1
 s_mov_b64 exec, 1
 buffer_atomic_add v5, v4, s[72:75], s61 offen sc1
 s_mov_b64 exec, -1
 s_nop 1
af_129:
 s_mov_b32 s26, 13
 s_mov_b32 s28, 1572864
 v_readfirstlane_b32 s100, v29
 s_cmp_lg_u32 s100, 0
 s_cbranch_scc1 c0_130
 s_mov_b32 s21, 84
 v_mov_b32 v4, 0
 s_mov_b32 s101, 0
wf_131:
 buffer_load_dword v5, v4, s[64:67], s21 offen sc1
 s_add_u32 s101, s101, 1
 s_cmp_gt_u32 s101, 131072
 s_cbranch_scc1 main_end
 s_waitcnt vmcnt(0)
 v_readfirstlane_b32 s100, v5
 s_cmp_ge_u32 s100, 1
 s_cbranch_scc1 wf_132
 s_sleep 8
 s_branch wf_131
wf_132:
c0_130:
 s_add_u32 s37, s38, 83886079
 s_add_u32 s21, s38, 180355072
 s_xor_b32 s37, s37, s21
 s_lshr_b32 s37, s37, 21
 s_xor_b32 s37, s37, s100
 s_xor_b32 s37, s37, 0
 s_and_b32 s37, s37, 1
 s_lshl_b32 s37, s37, 13
kv_main:
 v_and_b32 v6, 7, v2
 v_add_u32 v4, 0, v3
 v_xor_b32 v4, v4, v6
 v_lshlrev_b32 v4, 4, v4
 v_lshl_add_u32 v14, v2, 7, v4
 v_add_u32 v4, 4, v3
 v_xor_b32 v4, v4, v6
 v_lshlrev_b32 v4, 4, v4
 v_lshl_add_u32 v15, v2, 7, v4
 v_mul_u32_u24 v22, 400, v2
 v_mul_u32_u24 v4, 16, v3
 s_mul_i32 s21, s20, 96
 s_add_u32 s21, s21, 98304
 v_add3_u32 v22, v22, v4, s21
 v_lshlrev_b32 v4, 3, v3
 v_sub_u32 v16, v22, v4
 v_mov_b32 v9, 2731
 s_mul_i32 s21, s20, 12800
 s_add_u32 s21, s21, 98304
 v_mul_u32_u24 v4, 400, v2
 v_lshlrev_b32 v5, 4, v3
 v_add3_u32 v23, v4, v5, s21
 v_lshlrev_b32 v26, 4, v1
 s_mov_b32 s33, 32768
 s_mov_b32 s48, 0x80000000
 s_mov_b32 m0, s32
 s_nop 0
 buffer_load_dwordx4 v10, s[8:11], s30 offen offset:0 lds
 buffer_load_dwordx4 v11, s[8:11], s30 offen offset:1024 lds
 s_waitcnt vmcnt(14)
 s_barrier
 v_add_u32 v18, s33, v14
 v_add_u32 v19, s33, v15
 s_add_u32 s33, s33, 16384
 s_cmp_lt_u32 s33, 98304
 s_cselect_b32 s33, s33, 0
 ds_read_b128 v[160:163], v18 offset:0
 ds_read_b128 v[164:167], v18 offset:2048
 ds_read_b128 v[168:171], v18 offset:4096
 ds_read_b128 v[172:175], v18 offset:6144
 ds_read_b128 v[176:179], v18 offset:8192
 ds_read_b128 v[180:183], v18 offset:10240
 ds_read_b128 v[184:187], v18 offset:12288
 ds_read_b128 v[188:191], v18 offset:14336
 s_waitcnt lgkmcnt(0)
kv_blk_135:
 v_mfma_f32_16x16x32_bf16 v[64:67], a[0:3], v[160:163], 0
 ds_read_b128 v[192:195], v19 offset:0
 v_mfma_f32_16x16x32_bf16 v[68:71], a[4:7], v[160:163], 0
 v_add_u32 v18, s33, v14
 v_mfma_f32_16x16x32_bf16 v[72:75], a[8:11], v[160:163], 0
 ds_write_b64 v16, v[234:235] offset:6464
 v_mfma_f32_16x16x32_bf16 v[76:79], a[0:3], v[164:167], 0
 ds_read_b128 v[196:199], v19 offset:2048
 v_cvt_pk_bf16_f32 v236, v88, v89
 v_mfma_f32_16x16x32_bf16 v[80:83], a[4:7], v[164:167], 0
 buffer_load_dwordx4 v12, s[8:11], s30 offen offset:2048 lds
 v_mfma_f32_16x16x32_bf16 v[84:87], a[8:11], v[164:167], 0
 v_cvt_pk_bf16_f32 v237, v90, v91
 v_cvt_pk_bf16_f32 v238, v92, v93
 v_mfma_f32_16x16x32_bf16 v[88:91], a[0:3], v[168:171], 0
 ds_read_b128 v[200:203], v19 offset:4096
 v_cvt_pk_bf16_f32 v239, v94, v95
 v_mfma_f32_16x16x32_bf16 v[92:95], a[4:7], v[168:171], 0
 v_cvt_pk_bf16_f32 v240, v96, v97
 v_cvt_pk_bf16_f32 v241, v98, v99
 v_mfma_f32_16x16x32_bf16 v[96:99], a[8:11], v[168:171], 0
 ds_write_b64 v22, v[236:237] offset:12800
 ds_write_b64 v22, v[238:239] offset:12808
 ds_write_b64 v16, v[240:241] offset:12864
 v_cvt_pk_bf16_f32 v242, v100, v101
 v_cvt_pk_bf16_f32 v243, v102, v103
 v_mfma_f32_16x16x32_bf16 v[100:103], a[0:3], v[172:175], 0
 ds_read_b128 v[204:207], v19 offset:6144
 v_cvt_pk_bf16_f32 v244, v104, v105
 v_cvt_pk_bf16_f32 v245, v106, v107
 v_mfma_f32_16x16x32_bf16 v[104:107], a[4:7], v[172:175], 0
 v_cvt_pk_bf16_f32 v246, v108, v109
 v_cvt_pk_bf16_f32 v247, v110, v111
 v_mfma_f32_16x16x32_bf16 v[108:111], a[8:11], v[172:175], 0
 s_waitcnt lgkmcnt(9)
 ds_write_b64 v22, v[242:243] offset:19200
 ds_write_b64 v22, v[244:245] offset:19208
 ds_write_b64 v16, v[246:247] offset:19264
 v_cvt_pk_bf16_f32 v224, v112, v113
 v_cvt_pk_bf16_f32 v225, v114, v115
 v_mfma_f32_16x16x32_bf16 v[112:115], a[0:3], v[176:179], 0
 ds_read_b128 v[208:211], v19 offset:8192
 v_cvt_pk_bf16_f32 v226, v116, v117
 v_cvt_pk_bf16_f32 v227, v118, v119
 v_mfma_f32_16x16x32_bf16 v[116:119], a[4:7], v[176:179], 0
 v_cvt_pk_bf16_f32 v228, v120, v121
 v_cvt_pk_bf16_f32 v229, v122, v123
 v_mfma_f32_16x16x32_bf16 v[120:123], a[8:11], v[176:179], 0
 ds_write_b64 v22, v[224:225] offset:25600
 ds_write_b64 v22, v[226:227] offset:25608
 ds_write_b64 v16, v[228:229] offset:25664
 v_cvt_pk_bf16_f32 v230, v124, v125
 v_cvt_pk_bf16_f32 v231, v126, v127
 v_mfma_f32_16x16x32_bf16 v[124:127], a[0:3], v[180:183], 0
 ds_read_b128 v[212:215], v19 offset:10240
 v_cvt_pk_bf16_f32 v232, v128, v129
 v_cvt_pk_bf16_f32 v233, v130, v131
 v_mfma_f32_16x16x32_bf16 v[128:131], a[4:7], v[180:183], 0
 buffer_load_dwordx4 v13, s[8:11], s30 offen offset:3072 lds
 v_cvt_pk_bf16_f32 v234, v132, v133
 v_cvt_pk_bf16_f32 v235, v134, v135
 v_mfma_f32_16x16x32_bf16 v[132:135], a[8:11], v[180:183], 0
 s_add_u32 s30, s30, 128
 s_add_u32 m0, m0, 16384
 ds_write_b64 v22, v[230:231] offset:32000
 ds_write_b64 v22, v[232:233] offset:32008
 ds_write_b64 v16, v[234:235] offset:32064
 v_cvt_pk_bf16_f32 v236, v136, v137
 v_cvt_pk_bf16_f32 v237, v138, v139
 v_mfma_f32_16x16x32_bf16 v[136:139], a[0:3], v[184:187], 0
 ds_read_b128 v[216:219], v19 offset:12288
 v_cvt_pk_bf16_f32 v238, v140, v141
 v_cvt_pk_bf16_f32 v239, v142, v143
 v_mfma_f32_16x16x32_bf16 v[140:143], a[4:7], v[184:187], 0
 s_cmp_lt_u32 m0, s46
 s_cselect_b32 m0, m0, s47
 v_cvt_pk_bf16_f32 v240, v144, v145
 v_cvt_pk_bf16_f32 v241, v146, v147
 v_mfma_f32_16x16x32_bf16 v[144:147], a[8:11], v[184:187], 0
 ds_write_b64 v22, v[236:237] offset:38400
 ds_write_b64 v22, v[238:239] offset:38408
 ds_write_b64 v16, v[240:241] offset:38464
 v_cvt_pk_bf16_f32 v242, v148, v149
 v_cvt_pk_bf16_f32 v243, v150, v151
 v_mfma_f32_16x16x32_bf16 v[148:151], a[0:3], v[188:191], 0
 ds_read_b128 v[220:223], v19 offset:14336
 v_cvt_pk_bf16_f32 v244, v152, v153
 v_cvt_pk_bf16_f32 v245, v154, v155
 v_mfma_f32_16x16x32_bf16 v[152:155], a[4:7], v[188:191], 0
 v_cvt_pk_bf16_f32 v246, v156, v157
 v_cvt_pk_bf16_f32 v247, v158, v159
 v_mfma_f32_16x16x32_bf16 v[156:159], a[8:11], v[188:191], 0
 s_waitcnt vmcnt(12) lgkmcnt(15)
 s_barrier
 v_mfma_f32_16x16x32_bf16 v[64:67], a[12:15], v[192:195], v[64:67]
 ds_read_b128 v[160:163], v18 offset:0
 v_mfma_f32_16x16x32_bf16 v[68:71], a[16:19], v[192:195], v[68:71]
 ds_write_b64 v22, v[242:243] offset:44800
 v_mfma_f32_16x16x32_bf16 v[72:75], a[20:23], v[192:195], v[72:75]
 v_add_u32 v19, s33, v15
 s_add_u32 s33, s33, 16384
 v_mfma_f32_16x16x32_bf16 v[76:79], a[12:15], v[196:199], v[76:79]
 ds_read_b128 v[164:167], v18 offset:2048
 v_mfma_f32_16x16x32_bf16 v[80:83], a[16:19], v[196:199], v[80:83]
 buffer_load_dwordx4 v10, s[8:11], s30 offen offset:0 lds
 v_mfma_f32_16x16x32_bf16 v[84:87], a[20:23], v[196:199], v[84:87]
 s_cmp_lt_u32 s33, 98304
 s_cselect_b32 s33, s33, 0
 v_mfma_f32_16x16x32_bf16 v[88:91], a[12:15], v[200:203], v[88:91]
 ds_read_b128 v[168:171], v18 offset:4096
 v_mfma_f32_16x16x32_bf16 v[92:95], a[16:19], v[200:203], v[92:95]
 ds_write_b64 v22, v[244:245] offset:44808
 v_mfma_f32_16x16x32_bf16 v[96:99], a[20:23], v[200:203], v[96:99]
 ds_write_b64 v16, v[246:247] offset:44864
 v_mfma_f32_16x16x32_bf16 v[100:103], a[12:15], v[204:207], v[100:103]
 ds_read_b128 v[172:175], v18 offset:6144
 v_mfma_f32_16x16x32_bf16 v[104:107], a[16:19], v[204:207], v[104:107]
 v_mfma_f32_16x16x32_bf16 v[108:111], a[20:23], v[204:207], v[108:111]
 s_waitcnt lgkmcnt(7)
 v_mfma_f32_16x16x32_bf16 v[112:115], a[12:15], v[208:211], v[112:115]
 ds_read_b128 v[176:179], v18 offset:8192
 v_mfma_f32_16x16x32_bf16 v[116:119], a[16:19], v[208:211], v[116:119]
 v_mfma_f32_16x16x32_bf16 v[120:123], a[20:23], v[208:211], v[120:123]
 v_mfma_f32_16x16x32_bf16 v[124:127], a[12:15], v[212:215], v[124:127]
 ds_read_b128 v[180:183], v18 offset:10240
 v_mfma_f32_16x16x32_bf16 v[128:131], a[16:19], v[212:215], v[128:131]
 buffer_load_dwordx4 v11, s[8:11], s30 offen offset:1024 lds
 v_mfma_f32_16x16x32_bf16 v[132:135], a[20:23], v[212:215], v[132:135]
 v_mfma_f32_16x16x32_bf16 v[136:139], a[12:15], v[216:219], v[136:139]
 ds_read_b128 v[184:187], v18 offset:12288
 v_mfma_f32_16x16x32_bf16 v[140:143], a[16:19], v[216:219], v[140:143]
 v_mfma_f32_16x16x32_bf16 v[144:147], a[20:23], v[216:219], v[144:147]
 v_mfma_f32_16x16x32_bf16 v[148:151], a[12:15], v[220:223], v[148:151]
 ds_read_b128 v[188:191], v18 offset:14336
 v_mfma_f32_16x16x32_bf16 v[152:155], a[16:19], v[220:223], v[152:155]
 v_mfma_f32_16x16x32_bf16 v[156:159], a[20:23], v[220:223], v[156:159]
 s_waitcnt lgkmcnt(4)
 v_mfma_f32_16x16x32_bf16 v[64:67], a[24:27], v[160:163], v[64:67]
 ds_read_b128 v[192:195], v19 offset:0
 v_mfma_f32_16x16x32_bf16 v[68:71], a[28:31], v[160:163], v[68:71]
 v_add_u32 v18, s33, v14
 v_mfma_f32_16x16x32_bf16 v[72:75], a[32:35], v[160:163], v[72:75]
 v_mfma_f32_16x16x32_bf16 v[76:79], a[24:27], v[164:167], v[76:79]
 ds_read_b128 v[196:199], v19 offset:2048
 v_mfma_f32_16x16x32_bf16 v[80:83], a[28:31], v[164:167], v[80:83]
 buffer_load_dwordx4 v12, s[8:11], s30 offen offset:2048 lds
 v_mfma_f32_16x16x32_bf16 v[84:87], a[32:35], v[164:167], v[84:87]
 v_mfma_f32_16x16x32_bf16 v[88:91], a[24:27], v[168:171], v[88:91]
 ds_read_b128 v[200:203], v19 offset:4096
 v_mfma_f32_16x16x32_bf16 v[92:95], a[28:31], v[168:171], v[92:95]
 v_mfma_f32_16x16x32_bf16 v[96:99], a[32:35], v[168:171], v[96:99]
 v_mfma_f32_16x16x32_bf16 v[100:103], a[24:27], v[172:175], v[100:103]
 ds_read_b128 v[204:207], v19 offset:6144
 v_mfma_f32_16x16x32_bf16 v[104:107], a[28:31], v[172:175], v[104:107]
 v_mfma_f32_16x16x32_bf16 v[108:111], a[32:35], v[172:175], v[108:111]
 s_waitcnt lgkmcnt(4)
 v_mfma_f32_16x16x32_bf16 v[112:115], a[24:27], v[176:179], v[112:115]
 ds_read_b128 v[208:211], v19 offset:8192
 v_mfma_f32_16x16x32_bf16 v[116:119], a[28:31], v[176:179], v[116:119]
 v_mfma_f32_16x16x32_bf16 v[120:123], a[32:35], v[176:179], v[120:123]
 v_mfma_f32_16x16x32_bf16 v[124:127], a[24:27], v[180:183], v[124:127]
 ds_read_b128 v[212:215], v19 offset:10240
 v_mfma_f32_16x16x32_bf16 v[128:131], a[28:31], v[180:183], v[128:131]
 buffer_load_dwordx4 v13, s[8:11], s30 offen offset:3072 lds
 v_mfma_f32_16x16x32_bf16 v[132:135], a[32:35], v[180:183], v[132:135]
 s_add_u32 s30, s30, 128
 s_add_u32 m0, m0, 16384
 v_mfma_f32_16x16x32_bf16 v[136:139], a[24:27], v[184:187], v[136:139]
 ds_read_b128 v[216:219], v19 offset:12288
 v_mfma_f32_16x16x32_bf16 v[140:143], a[28:31], v[184:187], v[140:143]
 s_cmp_lt_u32 m0, s46
 s_cselect_b32 m0, m0, s47
 v_mfma_f32_16x16x32_bf16 v[144:147], a[32:35], v[184:187], v[144:147]
 v_mfma_f32_16x16x32_bf16 v[148:151], a[24:27], v[188:191], v[148:151]
 ds_read_b128 v[220:223], v19 offset:14336
 v_mfma_f32_16x16x32_bf16 v[152:155], a[28:31], v[188:191], v[152:155]
 v_mfma_f32_16x16x32_bf16 v[156:159], a[32:35], v[188:191], v[156:159]
 s_waitcnt vmcnt(12) lgkmcnt(4)
 s_barrier
 v_mfma_f32_16x16x32_bf16 v[64:67], a[36:39], v[192:195], v[64:67]
 ds_read_b128 v[160:163], v18 offset:0
 v_mfma_f32_16x16x32_bf16 v[68:71], a[40:43], v[192:195], v[68:71]
 v_mfma_f32_16x16x32_bf16 v[72:75], a[44:47], v[192:195], v[72:75]
 v_add_u32 v19, s33, v15
 s_add_u32 s33, s33, 16384
 v_mfma_f32_16x16x32_bf16 v[76:79], a[36:39], v[196:199], v[76:79]
 ds_read_b128 v[164:167], v18 offset:2048
 v_mfma_f32_16x16x32_bf16 v[80:83], a[40:43], v[196:199], v[80:83]
 buffer_load_dwordx4 v10, s[8:11], s30 offen offset:0 lds
 v_mfma_f32_16x16x32_bf16 v[84:87], a[44:47], v[196:199], v[84:87]
 s_cmp_lt_u32 s33, 98304
 s_cselect_b32 s33, s33, 0
 v_mfma_f32_16x16x32_bf16 v[88:91], a[36:39], v[200:203], v[88:91]
 ds_read_b128 v[168:171], v18 offset:4096
 v_mfma_f32_16x16x32_bf16 v[92:95], a[40:43], v[200:203], v[92:95]
 ds_read_b128 v[224:227], v23 offset:0
 v_mfma_f32_16x16x32_bf16 v[96:99], a[44:47], v[200:203], v[96:99]
 v_mfma_f32_16x16x32_bf16 v[100:103], a[36:39], v[204:207], v[100:103]
 ds_read_b128 v[172:175], v18 offset:6144
 v_mfma_f32_16x16x32_bf16 v[104:107], a[40:43], v[204:207], v[104:107]
 v_mfma_f32_16x16x32_bf16 v[108:111], a[44:47], v[204:207], v[108:111]
 s_waitcnt lgkmcnt(5)
 v_mfma_f32_16x16x32_bf16 v[112:115], a[36:39], v[208:211], v[112:115]
 ds_read_b128 v[176:179], v18 offset:8192
 v_mfma_f32_16x16x32_bf16 v[116:119], a[40:43], v[208:211], v[116:119]
 v_mfma_f32_16x16x32_bf16 v[120:123], a[44:47], v[208:211], v[120:123]
 v_mfma_f32_16x16x32_bf16 v[124:127], a[36:39], v[212:215], v[124:127]
 ds_read_b128 v[180:183], v18 offset:10240
 v_mfma_f32_16x16x32_bf16 v[128:131], a[40:43], v[212:215], v[128:131]
 buffer_load_dwordx4 v11, s[8:11], s30 offen offset:1024 lds
 v_mfma_f32_16x16x32_bf16 v[132:135], a[44:47], v[212:215], v[132:135]
 v_mfma_f32_16x16x32_bf16 v[136:139], a[36:39], v[216:219], v[136:139]
 ds_read_b128 v[184:187], v18 offset:12288
 v_mfma_f32_16x16x32_bf16 v[140:143], a[40:43], v[216:219], v[140:143]
 ds_read_b128 v[228:231], v23 offset:64
 v_mfma_f32_16x16x32_bf16 v[144:147], a[44:47], v[216:219], v[144:147]
 v_mfma_f32_16x16x32_bf16 v[148:151], a[36:39], v[220:223], v[148:151]
 ds_read_b128 v[188:191], v18 offset:14336
 v_mfma_f32_16x16x32_bf16 v[152:155], a[40:43], v[220:223], v[152:155]
 v_mfma_f32_16x16x32_bf16 v[156:159], a[44:47], v[220:223], v[156:159]
 s_waitcnt lgkmcnt(5)
 v_mfma_f32_16x16x32_bf16 v[64:67], a[48:51], v[160:163], v[64:67]
 ds_read_b128 v[192:195], v19 offset:0
 v_mfma_f32_16x16x32_bf16 v[68:71], a[52:55], v[160:163], v[68:71]
 v_add_u32 v18, s33, v14
 v_mfma_f32_16x16x32_bf16 v[72:75], a[56:59], v[160:163], v[72:75]
 v_mfma_f32_16x16x32_bf16 v[76:79], a[48:51], v[164:167], v[76:79]
 ds_read_b128 v[196:199], v19 offset:2048
 v_mfma_f32_16x16x32_bf16 v[80:83], a[52:55], v[164:167], v[80:83]
 buffer_load_dwordx4 v12, s[8:11], s30 offen offset:2048 lds
 v_mfma_f32_16x16x32_bf16 v[84:87], a[56:59], v[164:167], v[84:87]
 v_mfma_f32_16x16x32_bf16 v[88:91], a[48:51], v[168:171], v[88:91]
 ds_read_b128 v[200:203], v19 offset:4096
 v_mfma_f32_16x16x32_bf16 v[92:95], a[52:55], v[168:171], v[92:95]
 s_add_u32 s21, s48, 0
 ds_read_b128 v[232:235], v23 offset:128
 v_mfma_f32_16x16x32_bf16 v[96:99], a[56:59], v[168:171], v[96:99]
 v_mfma_f32_16x16x32_bf16 v[100:103], a[48:51], v[172:175], v[100:103]
 ds_read_b128 v[204:207], v19 offset:6144
 v_mfma_f32_16x16x32_bf16 v[104:107], a[52:55], v[172:175], v[104:107]
 buffer_store_dwordx4 v[224:227], v26, s[16:19], s21 offen offset:0 sc1
 v_mfma_f32_16x16x32_bf16 v[108:111], a[56:59], v[172:175], v[108:111]
 s_waitcnt lgkmcnt(5)
 v_mfma_f32_16x16x32_bf16 v[112:115], a[48:51], v[176:179], v[112:115]
 ds_read_b128 v[208:211], v19 offset:8192
 v_mfma_f32_16x16x32_bf16 v[116:119], a[52:55], v[176:179], v[116:119]
 v_mfma_f32_16x16x32_bf16 v[120:123], a[56:59], v[176:179], v[120:123]
 v_mfma_f32_16x16x32_bf16 v[124:127], a[48:51], v[180:183], v[124:127]
 ds_read_b128 v[212:215], v19 offset:10240
 v_mfma_f32_16x16x32_bf16 v[128:131], a[52:55], v[180:183], v[128:131]
 buffer_load_dwordx4 v13, s[8:11], s30 offen offset:3072 lds
 v_mfma_f32_16x16x32_bf16 v[132:135], a[56:59], v[180:183], v[132:135]
 s_add_u32 s30, s30, 128
 s_add_u32 m0, m0, 16384
 v_mfma_f32_16x16x32_bf16 v[136:139], a[48:51], v[184:187], v[136:139]
 ds_read_b128 v[216:219], v19 offset:12288
 v_mfma_f32_16x16x32_bf16 v[140:143], a[52:55], v[184:187], v[140:143]
 s_cmp_lt_u32 m0, s46
 s_cselect_b32 m0, m0, s47
 v_mfma_f32_16x16x32_bf16 v[144:147], a[56:59], v[184:187], v[144:147]
 ds_read_b128 v[236:239], v23 offset:192
 v_mfma_f32_16x16x32_bf16 v[148:151], a[48:51], v[188:191], v[148:151]
 ds_read_b128 v[220:223], v19 offset:14336
 v_mfma_f32_16x16x32_bf16 v[152:155], a[52:55], v[188:191], v[152:155]
 buffer_store_dwordx4 v[228:231], v26, s[16:19], s21 offen offset:1024 sc1
 v_mfma_f32_16x16x32_bf16 v[156:159], a[56:59], v[188:191], v[156:159]
 s_waitcnt vmcnt(14) lgkmcnt(5)
 s_barrier
 v_mfma_f32_16x16x32_bf16 v[64:67], a[60:63], v[192:195], v[64:67]
 ds_read_b128 v[160:163], v18 offset:0
 v_mfma_f32_16x16x32_bf16 v[68:71], a[64:67], v[192:195], v[68:71]
 v_mfma_f32_16x16x32_bf16 v[72:75], a[68:71], v[192:195], v[72:75]
 v_add_u32 v19, s33, v15
 s_add_u32 s33, s33, 16384
 v_mfma_f32_16x16x32_bf16 v[76:79], a[60:63], v[196:199], v[76:79]
 ds_read_b128 v[164:167], v18 offset:2048
 v_mfma_f32_16x16x32_bf16 v[80:83], a[64:67], v[196:199], v[80:83]
 buffer_load_dwordx4 v10, s[8:11], s30 offen offset:0 lds
 v_mfma_f32_16x16x32_bf16 v[84:87], a[68:71], v[196:199], v[84:87]
 s_cmp_lt_u32 s33, 98304
 s_cselect_b32 s33, s33, 0
 v_mfma_f32_16x16x32_bf16 v[88:91], a[60:63], v[200:203], v[88:91]
 ds_read_b128 v[168:171], v18 offset:4096
 v_mfma_f32_16x16x32_bf16 v[92:95], a[64:67], v[200:203], v[92:95]
 ds_read_b128 v[240:243], v23 offset:256
 v_mfma_f32_16x16x32_bf16 v[96:99], a[68:71], v[200:203], v[96:99]
 v_mfma_f32_16x16x32_bf16 v[100:103], a[60:63], v[204:207], v[100:103]
 ds_read_b128 v[172:175], v18 offset:6144
 v_mfma_f32_16x16x32_bf16 v[104:107], a[64:67], v[204:207], v[104:107]
 buffer_store_dwordx4 v[232:235], v26, s[16:19], s21 offen offset:2048 sc1
 v_mfma_f32_16x16x32_bf16 v[108:111], a[68:71], v[204:207], v[108:111]
 s_waitcnt lgkmcnt(5)
 v_mfma_f32_16x16x32_bf16 v[112:115], a[60:63], v[208:211], v[112:115]
 ds_read_b128 v[176:179], v18 offset:8192
 v_mfma_f32_16x16x32_bf16 v[116:119], a[64:67], v[208:211], v[116:119]
 v_mfma_f32_16x16x32_bf16 v[120:123], a[68:71], v[208:211], v[120:123]
 v_mfma_f32_16x16x32_bf16 v[124:127], a[60:63], v[212:215], v[124:127]
 ds_read_b128 v[180:183], v18 offset:10240
 v_mfma_f32_16x16x32_bf16 v[128:131], a[64:67], v[212:215], v[128:131]
 buffer_load_dwordx4 v11, s[8:11], s30 offen offset:1024 lds
 v_mfma_f32_16x16x32_bf16 v[132:135], a[68:71], v[212:215], v[132:135]
 v_mfma_f32_16x16x32_bf16 v[136:139], a[60:63], v[216:219], v[136:139]
 ds_read_b128 v[184:187], v18 offset:12288
 v_mfma_f32_16x16x32_bf16 v[140:143], a[64:67], v[216:219], v[140:143]
 ds_read_b128 v[244:247], v23 offset:320
 v_mfma_f32_16x16x32_bf16 v[144:147], a[68:71], v[216:219], v[144:147]
 v_mfma_f32_16x16x32_bf16 v[148:151], a[60:63], v[220:223], v[148:151]
 ds_read_b128 v[188:191], v18 offset:14336
 v_mfma_f32_16x16x32_bf16 v[152:155], a[64:67], v[220:223], v[152:155]
 buffer_store_dwordx4 v[236:239], v26, s[16:19], s21 offen offset:3072 sc1
 v_mfma_f32_16x16x32_bf16 v[156:159], a[68:71], v[220:223], v[156:159]
 s_waitcnt lgkmcnt(5)
 v_mfma_f32_16x16x32_bf16 v[64:67], a[72:75], v[160:163], v[64:67]
 ds_read_b128 v[192:195], v19 offset:0
 v_mfma_f32_16x16x32_bf16 v[68:71], a[76:79], v[160:163], v[68:71]
 v_add_u32 v18, s33, v14
 v_mfma_f32_16x16x32_bf16 v[72:75], a[80:83], v[160:163], v[72:75]
 v_mfma_f32_16x16x32_bf16 v[76:79], a[72:75], v[164:167], v[76:79]
 ds_read_b128 v[196:199], v19 offset:2048
 v_mfma_f32_16x16x32_bf16 v[80:83], a[76:79], v[164:167], v[80:83]
 buffer_load_dwordx4 v12, s[8:11], s30 offen offset:2048 lds
 v_mfma_f32_16x16x32_bf16 v[84:87], a[80:83], v[164:167], v[84:87]
 v_mfma_f32_16x16x32_bf16 v[88:91], a[72:75], v[168:171], v[88:91]
 ds_read_b128 v[200:203], v19 offset:4096
 v_mfma_f32_16x16x32_bf16 v[92:95], a[76:79], v[168:171], v[92:95]
 s_add_u32 s21, s48, 4096
 ds_read_b128 v[224:227], v23 offset:6400
 v_mfma_f32_16x16x32_bf16 v[96:99], a[80:83], v[168:171], v[96:99]
 v_mfma_f32_16x16x32_bf16 v[100:103], a[72:75], v[172:175], v[100:103]
 ds_read_b128 v[204:207], v19 offset:6144
 v_mfma_f32_16x16x32_bf16 v[104:107], a[76:79], v[172:175], v[104:107]
 buffer_store_dwordx4 v[240:243], v26, s[16:19], s21 offen offset:0 sc1
 v_mfma_f32_16x16x32_bf16 v[108:111], a[80:83], v[172:175], v[108:111]
 s_waitcnt lgkmcnt(5)
 v_mfma_f32_16x16x32_bf16 v[112:115], a[72:75], v[176:179], v[112:115]
 ds_read_b128 v[208:211], v19 offset:8192
 v_mfma_f32_16x16x32_bf16 v[116:119], a[76:79], v[176:179], v[116:119]
 v_mfma_f32_16x16x32_bf16 v[120:123], a[80:83], v[176:179], v[120:123]
 v_mfma_f32_16x16x32_bf16 v[124:127], a[72:75], v[180:183], v[124:127]
 ds_read_b128 v[212:215], v19 offset:10240
 v_mfma_f32_16x16x32_bf16 v[128:131], a[76:79], v[180:183], v[128:131]
 buffer_load_dwordx4 v13, s[8:11], s30 offen offset:3072 lds
 v_mfma_f32_16x16x32_bf16 v[132:135], a[80:83], v[180:183], v[132:135]
 s_add_u32 s30, s30, 128
 s_add_u32 m0, m0, 16384
 v_mfma_f32_16x16x32_bf16 v[136:139], a[72:75], v[184:187], v[136:139]
 ds_read_b128 v[216:219], v19 offset:12288
 v_mfma_f32_16x16x32_bf16 v[140:143], a[76:79], v[184:187], v[140:143]
 s_cmp_lt_u32 m0, s46
 s_cselect_b32 m0, m0, s47
 v_mfma_f32_16x16x32_bf16 v[144:147], a[80:83], v[184:187], v[144:147]
 ds_read_b128 v[228:231], v23 offset:6464
 v_mfma_f32_16x16x32_bf16 v[148:151], a[72:75], v[188:191], v[148:151]
 ds_read_b128 v[220:223], v19 offset:14336
 v_mfma_f32_16x16x32_bf16 v[152:155], a[76:79], v[188:191], v[152:155]
 buffer_store_dwordx4 v[244:247], v26, s[16:19], s21 offen offset:1024 sc1
 v_mfma_f32_16x16x32_bf16 v[156:159], a[80:83], v[188:191], v[156:159]
 s_waitcnt vmcnt(18) lgkmcnt(5)
 s_barrier
 v_mfma_f32_16x16x32_bf16 v[64:67], a[84:87], v[192:195], v[64:67]
 ds_read_b128 v[160:163], v18 offset:0
 v_mfma_f32_16x16x32_bf16 v[68:71], a[88:91], v[192:195], v[68:71]
 v_mfma_f32_16x16x32_bf16 v[72:75], a[92:95], v[192:195], v[72:75]
 v_add_u32 v19, s33, v15
 s_add_u32 s33, s33, 16384
 v_mfma_f32_16x16x32_bf16 v[76:79], a[84:87], v[196:199], v[76:79]
 ds_read_b128 v[164:167], v18 offset:2048
 v_mfma_f32_16x16x32_bf16 v[80:83], a[88:91], v[196:199], v[80:83]
 buffer_load_dwordx4 v10, s[8:11], s30 offen offset:0 lds
 v_mfma_f32_16x16x32_bf16 v[84:87], a[92:95], v[196:199], v[84:87]
 s_cmp_lt_u32 s33, 98304
 s_cselect_b32 s33, s33, 0
 v_mfma_f32_16x16x32_bf16 v[88:91], a[84:87], v[200:203], v[88:91]
 ds_read_b128 v[168:171], v18 offset:4096
 v_mfma_f32_16x16x32_bf16 v[92:95], a[88:91], v[200:203], v[92:95]
 ds_read_b128 v[232:235], v23 offset:6528
 v_mfma_f32_16x16x32_bf16 v[96:99], a[92:95], v[200:203], v[96:99]
 v_mfma_f32_16x16x32_bf16 v[100:103], a[84:87], v[204:207], v[100:103]
 ds_read_b128 v[172:175], v18 offset:6144
 v_mfma_f32_16x16x32_bf16 v[104:107], a[88:91], v[204:207], v[104:107]
 buffer_store_dwordx4 v[224:227], v26, s[16:19], s21 offen offset:2048 sc1
 v_mfma_f32_16x16x32_bf16 v[108:111], a[92:95], v[204:207], v[108:111]
 s_waitcnt lgkmcnt(5)
 v_mfma_f32_16x16x32_bf16 v[112:115], a[84:87], v[208:211], v[112:115]
 ds_read_b128 v[176:179], v18 offset:8192
 v_mfma_f32_16x16x32_bf16 v[116:119], a[88:91], v[208:211], v[116:119]
 v_mfma_f32_16x16x32_bf16 v[120:123], a[92:95], v[208:211], v[120:123]
 v_mfma_f32_16x16x32_bf16 v[124:127], a[84:87], v[212:215], v[124:127]
 ds_read_b128 v[180:183], v18 offset:10240
 v_mfma_f32_16x16x32_bf16 v[128:131], a[88:91], v[212:215], v[128:131]
 buffer_load_dwordx4 v11, s[8:11], s30 offen offset:1024 lds
 v_mfma_f32_16x16x32_bf16 v[132:135], a[92:95], v[212:215], v[132:135]
 v_mfma_f32_16x16x32_bf16 v[136:139], a[84:87], v[216:219], v[136:139]
 ds_read_b128 v[184:187], v18 offset:12288
 v_mfma_f32_16x16x32_bf16 v[140:143], a[88:91], v[216:219], v[140:143]
 ds_read_b128 v[236:239], v23 offset:6592
 v_mfma_f32_16x16x32_bf16 v[144:147], a[92:95], v[216:219], v[144:147]
 v_mfma_f32_16x16x32_bf16 v[148:151], a[84:87], v[220:223], v[148:151]
 ds_read_b128 v[188:191], v18 offset:14336
 v_mfma_f32_16x16x32_bf16 v[152:155], a[88:91], v[220:223], v[152:155]
 buffer_store_dwordx4 v[228:231], v26, s[16:19], s21 offen offset:3072 sc1
 v_mfma_f32_16x16x32_bf16 v[156:159], a[92:95], v[220:223], v[156:159]
 s_waitcnt lgkmcnt(5)
 v_mfma_f32_16x16x32_bf16 v[64:67], a[96:99], v[160:163], v[64:67]
 ds_read_b128 v[192:195], v19 offset:0
 v_mfma_f32_16x16x32_bf16 v[68:71], a[100:103], v[160:163], v[68:71]
 v_add_u32 v18, s33, v14
 v_mfma_f32_16x16x32_bf16 v[72:75], a[104:107], v[160:163], v[72:75]
 v_mfma_f32_16x16x32_bf16 v[76:79], a[96:99], v[164:167], v[76:79]
 ds_read_b128 v[196:199], v19 offset:2048
 v_mfma_f32_16x16x32_bf16 v[80:83], a[100:103], v[164:167], v[80:83]
 buffer_load_dwordx4 v12, s[8:11], s30 offen offset:2048 lds
 v_mfma_f32_16x16x32_bf16 v[84:87], a[104:107], v[164:167], v[84:87]
 v_mfma_f32_16x16x32_bf16 v[88:91], a[96:99], v[168:171], v[88:91]
 ds_read_b128 v[200:203], v19 offset:4096
 v_mfma_f32_16x16x32_bf16 v[92:95], a[100:103], v[168:171], v[92:95]
 s_add_u32 s21, s48, 8192
 ds_read_b128 v[240:243], v23 offset:6656
 v_mfma_f32_16x16x32_bf16 v[96:99], a[104:107], v[168:171], v[96:99]
 v_mfma_f32_16x16x32_bf16 v[100:103], a[96:99], v[172:175], v[100:103]
 ds_read_b128 v[204:207], v19 offset:6144
 v_mfma_f32_16x16x32_bf16 v[104:107], a[100:103], v[172:175], v[104:107]
 buffer_store_dwordx4 v[232:235], v26, s[16:19], s21 offen offset:0 sc1
 v_mfma_f32_16x16x32_bf16 v[108:111], a[104:107], v[172:175], v[108:111]
 s_waitcnt lgkmcnt(5)
 v_mfma_f32_16x16x32_bf16 v[112:115], a[96:99], v[176:179], v[112:115]
 ds_read_b128 v[208:211], v19 offset:8192
 v_mfma_f32_16x16x32_bf16 v[116:119], a[100:103], v[176:179], v[116:119]
 v_mfma_f32_16x16x32_bf16 v[120:123], a[104:107], v[176:179], v[120:123]
 v_mfma_f32_16x16x32_bf16 v[124:127], a[96:99], v[180:183], v[124:127]
 ds_read_b128 v[212:215], v19 offset:10240
 v_mfma_f32_16x16x32_bf16 v[128:131], a[100:103], v[180:183], v[128:131]
 buffer_load_dwordx4 v13, s[8:11], s30 offen offset:3072 lds
 v_mfma_f32_16x16x32_bf16 v[132:135], a[104:107], v[180:183], v[132:135]
 s_add_u32 s30, s30, 128
 s_add_u32 m0, m0, 16384
 v_mfma_f32_16x16x32_bf16 v[136:139], a[96:99], v[184:187], v[136:139]
 ds_read_b128 v[216:219], v19 offset:12288
 v_mfma_f32_16x16x32_bf16 v[140:143], a[100:103], v[184:187], v[140:143]
 s_cmp_lt_u32 m0, s46
 s_cselect_b32 m0, m0, s47
 v_mfma_f32_16x16x32_bf16 v[144:147], a[104:107], v[184:187], v[144:147]
 ds_read_b128 v[244:247], v23 offset:6720
 v_mfma_f32_16x16x32_bf16 v[148:151], a[96:99], v[188:191], v[148:151]
 ds_read_b128 v[220:223], v19 offset:14336
 v_mfma_f32_16x16x32_bf16 v[152:155], a[100:103], v[188:191], v[152:155]
 buffer_store_dwordx4 v[236:239], v26, s[16:19], s21 offen offset:1024 sc1
 v_mfma_f32_16x16x32_bf16 v[156:159], a[104:107], v[188:191], v[156:159]
 s_waitcnt vmcnt(22) lgkmcnt(5)
 s_barrier
 v_mfma_f32_16x16x32_bf16 v[64:67], a[108:111], v[192:195], v[64:67]
 ds_read_b128 v[160:163], v18 offset:0
 v_mfma_f32_16x16x32_bf16 v[68:71], a[112:115], v[192:195], v[68:71]
 v_mfma_f32_16x16x32_bf16 v[72:75], a[116:119], v[192:195], v[72:75]
 v_add_u32 v19, s33, v15
 s_add_u32 s33, s33, 16384
 v_mfma_f32_16x16x32_bf16 v[76:79], a[108:111], v[196:199], v[76:79]
 ds_read_b128 v[164:167], v18 offset:2048
 v_mfma_f32_16x16x32_bf16 v[80:83], a[112:115], v[196:199], v[80:83]
 buffer_load_dwordx4 v10, s[8:11], s30 offen offset:0 lds
 v_mfma_f32_16x16x32_bf16 v[84:87], a[116:119], v[196:199], v[84:87]
 s_cmp_lt_u32 s33, 98304
 s_cselect_b32 s33, s33, 0
 v_mfma_f32_16x16x32_bf16 v[88:91], a[108:111], v[200:203], v[88:91]
 ds_read_b128 v[168:171], v18 offset:4096
 v_mfma_f32_16x16x32_bf16 v[92:95], a[112:115], v[200:203], v[92:95]
 v_mfma_f32_16x16x32_bf16 v[96:99], a[116:119], v[200:203], v[96:99]
 v_mfma_f32_16x16x32_bf16 v[100:103], a[108:111], v[204:207], v[100:103]
 ds_read_b128 v[172:175], v18 offset:6144
 v_mfma_f32_16x16x32_bf16 v[104:107], a[112:115], v[204:207], v[104:107]
 buffer_store_dwordx4 v[240:243], v26, s[16:19], s21 offen offset:2048 sc1
 v_mfma_f32_16x16x32_bf16 v[108:111], a[116:119], v[204:207], v[108:111]
 s_waitcnt lgkmcnt(4)
 v_mfma_f32_16x16x32_bf16 v[112:115], a[108:111], v[208:211], v[112:115]
 ds_read_b128 v[176:179], v18 offset:8192
 v_mfma_f32_16x16x32_bf16 v[116:119], a[112:115], v[208:211], v[116:119]
 v_mfma_f32_16x16x32_bf16 v[120:123], a[116:119], v[208:211], v[120:123]
 v_mfma_f32_16x16x32_bf16 v[124:127], a[108:111], v[212:215], v[124:127]
 ds_read_b128 v[180:183], v18 offset:10240
 v_mfma_f32_16x16x32_bf16 v[128:131], a[112:115], v[212:215], v[128:131]
 buffer_load_dwordx4 v11, s[8:11], s30 offen offset:1024 lds
 v_mfma_f32_16x16x32_bf16 v[132:135], a[116:119], v[212:215], v[132:135]
 v_mfma_f32_16x16x32_bf16 v[136:139], a[108:111], v[216:219], v[136:139]
 ds_read_b128 v[184:187], v18 offset:12288
 v_mfma_f32_16x16x32_bf16 v[140:143], a[112:115], v[216:219], v[140:143]
 v_mfma_f32_16x16x32_bf16 v[144:147], a[116:119], v[216:219], v[144:147]
 v_mfma_f32_16x16x32_bf16 v[148:151], a[108:111], v[220:223], v[148:151]
 ds_read_b128 v[188:191], v18 offset:14336
 v_mfma_f32_16x16x32_bf16 v[152:155], a[112:115], v[220:223], v[152:155]
 buffer_store_dwordx4 v[244:247], v26, s[16:19], s21 offen offset:3072 sc1
 v_mfma_f32_16x16x32_bf16 v[156:159], a[116:119], v[220:223], v[156:159]
 s_waitcnt lgkmcnt(4)
 v_mfma_f32_16x16x32_bf16 v[64:67], a[120:123], v[160:163], v[64:67]
 ds_read_b128 v[192:195], v19 offset:0
 v_mfma_f32_16x16x32_bf16 v[68:71], a[124:127], v[160:163], v[68:71]
 v_add_u32 v18, s33, v14
 v_mfma_f32_16x16x32_bf16 v[72:75], a[128:131], v[160:163], v[72:75]
 v_mfma_f32_16x16x32_bf16 v[76:79], a[120:123], v[164:167], v[76:79]
 ds_read_b128 v[196:199], v19 offset:2048
 v_mfma_f32_16x16x32_bf16 v[80:83], a[124:127], v[164:167], v[80:83]
 buffer_load_dwordx4 v12, s[8:11], s30 offen offset:2048 lds
 v_mfma_f32_16x16x32_bf16 v[84:87], a[128:131], v[164:167], v[84:87]
 v_mfma_f32_16x16x32_bf16 v[88:91], a[120:123], v[168:171], v[88:91]
 ds_read_b128 v[200:203], v19 offset:4096
 v_mfma_f32_16x16x32_bf16 v[92:95], a[124:127], v[168:171], v[92:95]
 v_mfma_f32_16x16x32_bf16 v[96:99], a[128:131], v[168:171], v[96:99]
 v_mfma_f32_16x16x32_bf16 v[100:103], a[120:123], v[172:175], v[100:103]
 ds_read_b128 v[204:207], v19 offset:6144
 v_mfma_f32_16x16x32_bf16 v[104:107], a[124:127], v[172:175], v[104:107]
 v_mfma_f32_16x16x32_bf16 v[108:111], a[128:131], v[172:175], v[108:111]
 s_waitcnt lgkmcnt(4)
 v_mfma_f32_16x16x32_bf16 v[112:115], a[120:123], v[176:179], v[112:115]
 ds_read_b128 v[208:211], v19 offset:8192
 v_mfma_f32_16x16x32_bf16 v[116:119], a[124:127], v[176:179], v[116:119]
 v_mfma_f32_16x16x32_bf16 v[120:123], a[128:131], v[176:179], v[120:123]
 v_mfma_f32_16x16x32_bf16 v[124:127], a[120:123], v[180:183], v[124:127]
 ds_read_b128 v[212:215], v19 offset:10240
 v_mfma_f32_16x16x32_bf16 v[128:131], a[124:127], v[180:183], v[128:131]
 buffer_load_dwordx4 v13, s[8:11], s30 offen offset:3072 lds
 v_mfma_f32_16x16x32_bf16 v[132:135], a[128:131], v[180:183], v[132:135]
 s_add_u32 s30, s30, s25
 s_sub_u32 s30, s30, 1152
 v_mfma_f32_16x16x32_bf16 v[136:139], a[120:123], v[184:187], v[136:139]
 ds_read_b128 v[216:219], v19 offset:12288
 s_add_u32 m0, m0, 16384
 v_mfma_f32_16x16x32_bf16 v[140:143], a[124:127], v[184:187], v[140:143]
 s_cmp_lt_u32 m0, s46
 s_cselect_b32 m0, m0, s47
 v_mfma_f32_16x16x32_bf16 v[144:147], a[128:131], v[184:187], v[144:147]
 v_mfma_f32_16x16x32_bf16 v[148:151], a[120:123], v[188:191], v[148:151]
 ds_read_b128 v[220:223], v19 offset:14336
 v_mfma_f32_16x16x32_bf16 v[152:155], a[124:127], v[188:191], v[152:155]
 v_mfma_f32_16x16x32_bf16 v[156:159], a[128:131], v[188:191], v[156:159]
 s_waitcnt vmcnt(23) lgkmcnt(4)
 s_barrier
 v_mfma_f32_16x16x32_bf16 v[64:67], a[132:135], v[192:195], v[64:67]
 ds_read_b128 v[160:163], v18 offset:0
 v_mfma_f32_16x16x32_bf16 v[68:71], a[136:139], v[192:195], v[68:71]
 v_mfma_f32_16x16x32_bf16 v[72:75], a[140:143], v[192:195], v[72:75]
 v_add_u32 v19, s33, v15
 s_add_u32 s33, s33, 16384
 v_mfma_f32_16x16x32_bf16 v[76:79], a[132:135], v[196:199], v[76:79]
 ds_read_b128 v[164:167], v18 offset:2048
 v_mfma_f32_16x16x32_bf16 v[80:83], a[136:139], v[196:199], v[80:83]
 buffer_load_dwordx4 v10, s[8:11], s30 offen offset:0 lds
 v_mfma_f32_16x16x32_bf16 v[84:87], a[140:143], v[196:199], v[84:87]
 s_cmp_lt_u32 s33, 98304
 s_cselect_b32 s33, s33, 0
 v_mfma_f32_16x16x32_bf16 v[88:91], a[132:135], v[200:203], v[88:91]
 ds_read_b128 v[168:171], v18 offset:4096
 v_mfma_f32_16x16x32_bf16 v[92:95], a[136:139], v[200:203], v[92:95]
 v_mfma_f32_16x16x32_bf16 v[96:99], a[140:143], v[200:203], v[96:99]
 v_mfma_f32_16x16x32_bf16 v[100:103], a[132:135], v[204:207], v[100:103]
 ds_read_b128 v[172:175], v18 offset:6144
 v_mfma_f32_16x16x32_bf16 v[104:107], a[136:139], v[204:207], v[104:107]
 v_mfma_f32_16x16x32_bf16 v[108:111], a[140:143], v[204:207], v[108:111]
 s_waitcnt lgkmcnt(4)
 v_mfma_f32_16x16x32_bf16 v[112:115], a[132:135], v[208:211], v[112:115]
 ds_read_b128 v[176:179], v18 offset:8192
 v_mfma_f32_16x16x32_bf16 v[116:119], a[136:139], v[208:211], v[116:119]
 v_mfma_f32_16x16x32_bf16 v[120:123], a[140:143], v[208:211], v[120:123]
 v_mfma_f32_16x16x32_bf16 v[124:127], a[132:135], v[212:215], v[124:127]
 ds_read_b128 v[180:183], v18 offset:10240
 v_mfma_f32_16x16x32_bf16 v[128:131], a[136:139], v[212:215], v[128:131]
 buffer_load_dwordx4 v11, s[8:11], s30 offen offset:1024 lds
 v_mfma_f32_16x16x32_bf16 v[132:135], a[140:143], v[212:215], v[132:135]
 v_mfma_f32_16x16x32_bf16 v[136:139], a[132:135], v[216:219], v[136:139]
 ds_read_b128 v[184:187], v18 offset:12288
 v_mfma_f32_16x16x32_bf16 v[140:143], a[136:139], v[216:219], v[140:143]
 v_mfma_f32_16x16x32_bf16 v[144:147], a[140:143], v[216:219], v[144:147]
 v_mfma_f32_16x16x32_bf16 v[148:151], a[132:135], v[220:223], v[148:151]
 ds_read_b128 v[188:191], v18 offset:14336
 v_mfma_f32_16x16x32_bf16 v[152:155], a[136:139], v[220:223], v[152:155]
 v_mfma_f32_16x16x32_bf16 v[156:159], a[140:143], v[220:223], v[156:159]
 s_waitcnt lgkmcnt(4)
 v_mfma_f32_16x16x32_bf16 v[64:67], a[144:147], v[160:163], v[64:67]
 ds_read_b128 v[192:195], v19 offset:0
 v_mfma_f32_16x16x32_bf16 v[68:71], a[148:151], v[160:163], v[68:71]
 v_add_u32 v18, s33, v14
 v_mfma_f32_16x16x32_bf16 v[72:75], a[152:155], v[160:163], v[72:75]
 v_mfma_f32_16x16x32_bf16 v[76:79], a[144:147], v[164:167], v[76:79]
 ds_read_b128 v[196:199], v19 offset:2048
 v_mfma_f32_16x16x32_bf16 v[80:83], a[148:151], v[164:167], v[80:83]
 buffer_load_dwordx4 v12, s[8:11], s30 offen offset:2048 lds
 v_mfma_f32_16x16x32_bf16 v[84:87], a[152:155], v[164:167], v[84:87]
 v_mfma_f32_16x16x32_bf16 v[88:91], a[144:147], v[168:171], v[88:91]
 ds_read_b128 v[200:203], v19 offset:4096
 v_mfma_f32_16x16x32_bf16 v[92:95], a[148:151], v[168:171], v[92:95]
 v_mfma_f32_16x16x32_bf16 v[96:99], a[152:155], v[168:171], v[96:99]
 v_mfma_f32_16x16x32_bf16 v[100:103], a[144:147], v[172:175], v[100:103]
 ds_read_b128 v[204:207], v19 offset:6144
 v_mfma_f32_16x16x32_bf16 v[104:107], a[148:151], v[172:175], v[104:107]
 v_mfma_f32_16x16x32_bf16 v[108:111], a[152:155], v[172:175], v[108:111]
 s_waitcnt lgkmcnt(4)
 v_mfma_f32_16x16x32_bf16 v[112:115], a[144:147], v[176:179], v[112:115]
 ds_read_b128 v[208:211], v19 offset:8192
 v_mfma_f32_16x16x32_bf16 v[116:119], a[148:151], v[176:179], v[116:119]
 v_mfma_f32_16x16x32_bf16 v[120:123], a[152:155], v[176:179], v[120:123]
 v_mfma_f32_16x16x32_bf16 v[124:127], a[144:147], v[180:183], v[124:127]
 ds_read_b128 v[212:215], v19 offset:10240
 v_mfma_f32_16x16x32_bf16 v[128:131], a[148:151], v[180:183], v[128:131]
 buffer_load_dwordx4 v13, s[8:11], s30 offen offset:3072 lds
 v_mfma_f32_16x16x32_bf16 v[132:135], a[152:155], v[180:183], v[132:135]
 s_add_u32 s30, s30, 128
 s_add_u32 m0, m0, 16384
 v_mfma_f32_16x16x32_bf16 v[136:139], a[144:147], v[184:187], v[136:139]
 ds_read_b128 v[216:219], v19 offset:12288
 v_mfma_f32_16x16x32_bf16 v[140:143], a[148:151], v[184:187], v[140:143]
 s_cmp_lt_u32 m0, s46
 s_cselect_b32 m0, m0, s47
 v_mfma_f32_16x16x32_bf16 v[144:147], a[152:155], v[184:187], v[144:147]
 v_mfma_f32_16x16x32_bf16 v[148:151], a[144:147], v[188:191], v[148:151]
 ds_read_b128 v[220:223], v19 offset:14336
 v_mfma_f32_16x16x32_bf16 v[152:155], a[148:151], v[188:191], v[152:155]
 v_mfma_f32_16x16x32_bf16 v[156:159], a[152:155], v[188:191], v[156:159]
 s_waitcnt vmcnt(6) lgkmcnt(4)
 s_barrier
 v_mfma_f32_16x16x32_bf16 v[64:67], a[156:159], v[192:195], v[64:67]
 ds_read_b128 v[160:163], v18 offset:0
 v_mfma_f32_16x16x32_bf16 v[68:71], a[160:163], v[192:195], v[68:71]
 s_cmp_eq_u32 s48, 0x80000000
 s_cbranch_scc1 kv_133
 s_cmp_lg_u32 s20, 0
 s_cbranch_scc1 af_134
 v_mov_b32 v4, 0
 v_mov_b32 v5, 1
 s_mov_b64 exec, 1
 buffer_atomic_add v5, v4, s[72:75], s61 offen sc1
 s_mov_b64 exec, -1
 s_nop 1
af_134:
kv_133:
 v_mfma_f32_16x16x32_bf16 v[72:75], a[164:167], v[192:195], v[72:75]
 v_add_u32 v19, s33, v15
 s_add_u32 s33, s33, 16384
 v_mfma_f32_16x16x32_bf16 v[76:79], a[156:159], v[196:199], v[76:79]
 ds_read_b128 v[164:167], v18 offset:2048
 v_mfma_f32_16x16x32_bf16 v[80:83], a[160:163], v[196:199], v[80:83]
 buffer_load_dwordx4 v10, s[8:11], s30 offen offset:0 lds
 v_mfma_f32_16x16x32_bf16 v[84:87], a[164:167], v[196:199], v[84:87]
 s_cmp_lt_u32 s33, 98304
 s_cselect_b32 s33, s33, 0
 v_mfma_f32_16x16x32_bf16 v[88:91], a[156:159], v[200:203], v[88:91]
 ds_read_b128 v[168:171], v18 offset:4096
 v_mfma_f32_16x16x32_bf16 v[92:95], a[160:163], v[200:203], v[92:95]
 v_mfma_f32_16x16x32_bf16 v[96:99], a[164:167], v[200:203], v[96:99]
 v_mfma_f32_16x16x32_bf16 v[100:103], a[156:159], v[204:207], v[100:103]
 ds_read_b128 v[172:175], v18 offset:6144
 v_mfma_f32_16x16x32_bf16 v[104:107], a[160:163], v[204:207], v[104:107]
 v_mfma_f32_16x16x32_bf16 v[108:111], a[164:167], v[204:207], v[108:111]
 s_waitcnt lgkmcnt(4)
 v_mfma_f32_16x16x32_bf16 v[112:115], a[156:159], v[208:211], v[112:115]
 ds_read_b128 v[176:179], v18 offset:8192
 v_mfma_f32_16x16x32_bf16 v[116:119], a[160:163], v[208:211], v[116:119]
 v_mfma_f32_16x16x32_bf16 v[120:123], a[164:167], v[208:211], v[120:123]
 v_mfma_f32_16x16x32_bf16 v[124:127], a[156:159], v[212:215], v[124:127]
 ds_read_b128 v[180:183], v18 offset:10240
 v_mfma_f32_16x16x32_bf16 v[128:131], a[160:163], v[212:215], v[128:131]
 buffer_load_dwordx4 v11, s[8:11], s30 offen offset:1024 lds
 v_mfma_f32_16x16x32_bf16 v[132:135], a[164:167], v[212:215], v[132:135]
 v_mfma_f32_16x16x32_bf16 v[136:139], a[156:159], v[216:219], v[136:139]
 ds_read_b128 v[184:187], v18 offset:12288
 v_mfma_f32_16x16x32_bf16 v[140:143], a[160:163], v[216:219], v[140:143]
 v_mfma_f32_16x16x32_bf16 v[144:147], a[164:167], v[216:219], v[144:147]
 v_mfma_f32_16x16x32_bf16 v[148:151], a[156:159], v[220:223], v[148:151]
 ds_read_b128 v[188:191], v18 offset:14336
 v_mfma_f32_16x16x32_bf16 v[152:155], a[160:163], v[220:223], v[152:155]
 v_mfma_f32_16x16x32_bf16 v[156:159], a[164:167], v[220:223], v[156:159]
 s_waitcnt lgkmcnt(4)
 v_mfma_f32_16x16x32_bf16 v[64:67], a[168:171], v[160:163], v[64:67]
 ds_read_b128 v[192:195], v19 offset:0
 v_mfma_f32_16x16x32_bf16 v[68:71], a[172:175], v[160:163], v[68:71]
 v_add_u32 v18, s33, v14
 s_mov_b32 s61, s60
 v_mfma_f32_16x16x32_bf16 v[72:75], a[176:179], v[160:163], v[72:75]
 s_add_u32 s60, s60, s62
 s_mul_i32 s48, s20, 393216
 v_mfma_f32_16x16x32_bf16 v[76:79], a[168:171], v[164:167], v[76:79]
 ds_read_b128 v[196:199], v19 offset:2048
 s_add_u32 s48, s48, s27
 v_mfma_f32_16x16x32_bf16 v[80:83], a[172:175], v[164:167], v[80:83]
 buffer_load_dwordx4 v12, s[8:11], s30 offen offset:2048 lds
 v_mfma_f32_16x16x32_bf16 v[84:87], a[176:179], v[164:167], v[84:87]
 s_add_u32 s27, s27, s28
 s_sub_u32 s26, s26, 1
 v_mfma_f32_16x16x32_bf16 v[88:91], a[168:171], v[168:171], v[88:91]
 ds_read_b128 v[200:203], v19 offset:4096
 v_mfma_f32_16x16x32_bf16 v[92:95], a[172:175], v[168:171], v[92:95]
 v_mfma_f32_16x16x32_bf16 v[96:99], a[176:179], v[168:171], v[96:99]
 v_mfma_f32_16x16x32_bf16 v[100:103], a[168:171], v[172:175], v[100:103]
 ds_read_b128 v[204:207], v19 offset:6144
 v_mfma_f32_16x16x32_bf16 v[104:107], a[172:175], v[172:175], v[104:107]
 v_mfma_f32_16x16x32_bf16 v[108:111], a[176:179], v[172:175], v[108:111]
 s_waitcnt lgkmcnt(4)
 v_mfma_f32_16x16x32_bf16 v[112:115], a[168:171], v[176:179], v[112:115]
 ds_read_b128 v[208:211], v19 offset:8192
 v_mfma_f32_16x16x32_bf16 v[116:119], a[172:175], v[176:179], v[116:119]
 v_mfma_f32_16x16x32_bf16 v[120:123], a[176:179], v[176:179], v[120:123]
 v_mfma_f32_16x16x32_bf16 v[124:127], a[168:171], v[180:183], v[124:127]
 ds_read_b128 v[212:215], v19 offset:10240
 v_mfma_f32_16x16x32_bf16 v[128:131], a[172:175], v[180:183], v[128:131]
 buffer_load_dwordx4 v13, s[8:11], s30 offen offset:3072 lds
 v_mfma_f32_16x16x32_bf16 v[132:135], a[176:179], v[180:183], v[132:135]
 s_add_u32 s30, s30, 128
 s_add_u32 m0, m0, 16384
 v_mfma_f32_16x16x32_bf16 v[136:139], a[168:171], v[184:187], v[136:139]
 ds_read_b128 v[216:219], v19 offset:12288
 v_mfma_f32_16x16x32_bf16 v[140:143], a[172:175], v[184:187], v[140:143]
 s_cmp_lt_u32 m0, s46
 s_cselect_b32 m0, m0, s47
 v_mfma_f32_16x16x32_bf16 v[144:147], a[176:179], v[184:187], v[144:147]
 v_mfma_f32_16x16x32_bf16 v[148:151], a[168:171], v[188:191], v[148:151]
 ds_read_b128 v[220:223], v19 offset:14336
 v_mfma_f32_16x16x32_bf16 v[152:155], a[172:175], v[188:191], v[152:155]
 v_mfma_f32_16x16x32_bf16 v[156:159], a[176:179], v[188:191], v[156:159]
 s_waitcnt vmcnt(15) lgkmcnt(4)
 s_barrier
 v_mfma_f32_16x16x32_bf16 v[64:67], a[180:183], v[192:195], v[64:67]
 ds_read_b128 v[160:163], v18 offset:0
 v_mfma_f32_16x16x32_bf16 v[68:71], a[184:187], v[192:195], v[68:71]
 v_mfma_f32_16x16x32_bf16 v[72:75], a[188:191], v[192:195], v[72:75]
 v_add_u32 v19, s33, v15
 s_add_u32 s33, s33, 16384
 v_mfma_f32_16x16x32_bf16 v[76:79], a[180:183], v[196:199], v[76:79]
 ds_read_b128 v[164:167], v18 offset:2048
 v_mfma_f32_16x16x32_bf16 v[80:83], a[184:187], v[196:199], v[80:83]
 buffer_load_dwordx4 v10, s[8:11], s30 offen offset:0 lds
 v_mfma_f32_16x16x32_bf16 v[84:87], a[188:191], v[196:199], v[84:87]
 s_cmp_lt_u32 s33, 98304
 s_cselect_b32 s33, s33, 0
 v_mfma_f32_16x16x32_bf16 v[88:91], a[180:183], v[200:203], v[88:91]
 ds_read_b128 v[168:171], v18 offset:4096
 v_mfma_f32_16x16x32_bf16 v[92:95], a[184:187], v[200:203], v[92:95]
 v_mfma_f32_16x16x32_bf16 v[96:99], a[188:191], v[200:203], v[96:99]
 v_mfma_f32_16x16x32_bf16 v[100:103], a[180:183], v[204:207], v[100:103]
 ds_read_b128 v[172:175], v18 offset:6144
 v_mfma_f32_16x16x32_bf16 v[104:107], a[184:187], v[204:207], v[104:107]
 v_mfma_f32_16x16x32_bf16 v[108:111], a[188:191], v[204:207], v[108:111]
 s_waitcnt lgkmcnt(4)
 v_mfma_f32_16x16x32_bf16 v[112:115], a[180:183], v[208:211], v[112:115]
 ds_read_b128 v[176:179], v18 offset:8192
 v_mfma_f32_16x16x32_bf16 v[116:119], a[184:187], v[208:211], v[116:119]
 v_mfma_f32_16x16x32_bf16 v[120:123], a[188:191], v[208:211], v[120:123]
 v_mfma_f32_16x16x32_bf16 v[124:127], a[180:183], v[212:215], v[124:127]
 ds_read_b128 v[180:183], v18 offset:10240
 v_mfma_f32_16x16x32_bf16 v[128:131], a[184:187], v[212:215], v[128:131]
 buffer_load_dwordx4 v11, s[8:11], s30 offen offset:1024 lds
 v_mfma_f32_16x16x32_bf16 v[132:135], a[188:191], v[212:215], v[132:135]
 v_mfma_f32_16x16x32_bf16 v[136:139], a[180:183], v[216:219], v[136:139]
 ds_read_b128 v[184:187], v18 offset:12288
 v_mfma_f32_16x16x32_bf16 v[140:143], a[184:187], v[216:219], v[140:143]
 v_mfma_f32_16x16x32_bf16 v[144:147], a[188:191], v[216:219], v[144:147]
 v_mfma_f32_16x16x32_bf16 v[148:151], a[180:183], v[220:223], v[148:151]
 ds_read_b128 v[188:191], v18 offset:14336
 v_mfma_f32_16x16x32_bf16 v[152:155], a[184:187], v[220:223], v[152:155]
 v_mfma_f32_16x16x32_bf16 v[156:159], a[188:191], v[220:223], v[156:159]
 s_waitcnt lgkmcnt(4)
 v_mfma_f32_16x16x32_bf16 v[64:67], a[192:195], v[160:163], v[64:67]
 ds_read_b128 v[192:195], v19 offset:0
 v_mfma_f32_16x16x32_bf16 v[68:71], a[196:199], v[160:163], v[68:71]
 v_add_u32 v18, s33, v14
 v_mfma_f32_16x16x32_bf16 v[72:75], a[200:203], v[160:163], v[72:75]
 v_mfma_f32_16x16x32_bf16 v[76:79], a[192:195], v[164:167], v[76:79]
 ds_read_b128 v[196:199], v19 offset:2048
 v_mfma_f32_16x16x32_bf16 v[80:83], a[196:199], v[164:167], v[80:83]
 buffer_load_dwordx4 v12, s[8:11], s30 offen offset:2048 lds
 v_mfma_f32_16x16x32_bf16 v[84:87], a[200:203], v[164:167], v[84:87]
 v_mfma_f32_16x16x32_bf16 v[88:91], a[192:195], v[168:171], v[88:91]
 ds_read_b128 v[200:203], v19 offset:4096
 v_mfma_f32_16x16x32_bf16 v[92:95], a[196:199], v[168:171], v[92:95]
 v_mfma_f32_16x16x32_bf16 v[96:99], a[200:203], v[168:171], v[96:99]
 v_mfma_f32_16x16x32_bf16 v[100:103], a[192:195], v[172:175], v[100:103]
 ds_read_b128 v[204:207], v19 offset:6144
 v_mfma_f32_16x16x32_bf16 v[104:107], a[196:199], v[172:175], v[104:107]
 v_mfma_f32_16x16x32_bf16 v[108:111], a[200:203], v[172:175], v[108:111]
 s_waitcnt lgkmcnt(4)
 v_mfma_f32_16x16x32_bf16 v[112:115], a[192:195], v[176:179], v[112:115]
 ds_read_b128 v[208:211], v19 offset:8192
 v_mfma_f32_16x16x32_bf16 v[116:119], a[196:199], v[176:179], v[116:119]
 v_mfma_f32_16x16x32_bf16 v[120:123], a[200:203], v[176:179], v[120:123]
 v_mfma_f32_16x16x32_bf16 v[124:127], a[192:195], v[180:183], v[124:127]
 ds_read_b128 v[212:215], v19 offset:10240
 v_mfma_f32_16x16x32_bf16 v[128:131], a[196:199], v[180:183], v[128:131]
 buffer_load_dwordx4 v13, s[8:11], s30 offen offset:3072 lds
 v_mfma_f32_16x16x32_bf16 v[132:135], a[200:203], v[180:183], v[132:135]
 s_add_u32 s30, s30, 128
 s_add_u32 m0, m0, 16384
 v_mfma_f32_16x16x32_bf16 v[136:139], a[192:195], v[184:187], v[136:139]
 ds_read_b128 v[216:219], v19 offset:12288
 v_mfma_f32_16x16x32_bf16 v[140:143], a[196:199], v[184:187], v[140:143]
 s_cmp_lt_u32 m0, s46
 s_cselect_b32 m0, m0, s47
 v_mfma_f32_16x16x32_bf16 v[144:147], a[200:203], v[184:187], v[144:147]
 v_mfma_f32_16x16x32_bf16 v[148:151], a[192:195], v[188:191], v[148:151]
 ds_read_b128 v[220:223], v19 offset:14336
 v_mfma_f32_16x16x32_bf16 v[152:155], a[196:199], v[188:191], v[152:155]
 v_mfma_f32_16x16x32_bf16 v[156:159], a[200:203], v[188:191], v[156:159]
 s_waitcnt vmcnt(12) lgkmcnt(4)
 s_barrier
 v_mfma_f32_16x16x32_bf16 v[64:67], a[204:207], v[192:195], v[64:67]
 ds_read_b128 v[160:163], v18 offset:0
 v_mfma_f32_16x16x32_bf16 v[68:71], a[208:211], v[192:195], v[68:71]
 v_mfma_f32_16x16x32_bf16 v[72:75], a[212:215], v[192:195], v[72:75]
 v_add_u32 v19, s33, v15
 s_add_u32 s33, s33, 16384
 v_mfma_f32_16x16x32_bf16 v[76:79], a[204:207], v[196:199], v[76:79]
 ds_read_b128 v[164:167], v18 offset:2048
 v_mfma_f32_16x16x32_bf16 v[80:83], a[208:211], v[196:199], v[80:83]
 buffer_load_dwordx4 v10, s[8:11], s30 offen offset:0 lds
 v_mfma_f32_16x16x32_bf16 v[84:87], a[212:215], v[196:199], v[84:87]
 s_cmp_lt_u32 s33, 98304
 s_cselect_b32 s33, s33, 0
 v_mfma_f32_16x16x32_bf16 v[88:91], a[204:207], v[200:203], v[88:91]
 ds_read_b128 v[168:171], v18 offset:4096
 v_mfma_f32_16x16x32_bf16 v[92:95], a[208:211], v[200:203], v[92:95]
 v_mfma_f32_16x16x32_bf16 v[96:99], a[212:215], v[200:203], v[96:99]
 v_mfma_f32_16x16x32_bf16 v[100:103], a[204:207], v[204:207], v[100:103]
 ds_read_b128 v[172:175], v18 offset:6144
 v_mfma_f32_16x16x32_bf16 v[104:107], a[208:211], v[204:207], v[104:107]
 v_mfma_f32_16x16x32_bf16 v[108:111], a[212:215], v[204:207], v[108:111]
 s_waitcnt lgkmcnt(4)
 v_mfma_f32_16x16x32_bf16 v[112:115], a[204:207], v[208:211], v[112:115]
 ds_read_b128 v[176:179], v18 offset:8192
 v_mfma_f32_16x16x32_bf16 v[116:119], a[208:211], v[208:211], v[116:119]
 v_mfma_f32_16x16x32_bf16 v[120:123], a[212:215], v[208:211], v[120:123]
 v_mfma_f32_16x16x32_bf16 v[124:127], a[204:207], v[212:215], v[124:127]
 ds_read_b128 v[180:183], v18 offset:10240
 v_mfma_f32_16x16x32_bf16 v[128:131], a[208:211], v[212:215], v[128:131]
 buffer_load_dwordx4 v11, s[8:11], s30 offen offset:1024 lds
 v_mfma_f32_16x16x32_bf16 v[132:135], a[212:215], v[212:215], v[132:135]
 v_mfma_f32_16x16x32_bf16 v[136:139], a[204:207], v[216:219], v[136:139]
 ds_read_b128 v[184:187], v18 offset:12288
 v_mfma_f32_16x16x32_bf16 v[140:143], a[208:211], v[216:219], v[140:143]
 v_mfma_f32_16x16x32_bf16 v[144:147], a[212:215], v[216:219], v[144:147]
 v_mfma_f32_16x16x32_bf16 v[148:151], a[204:207], v[220:223], v[148:151]
 ds_read_b128 v[188:191], v18 offset:14336
 v_mfma_f32_16x16x32_bf16 v[152:155], a[208:211], v[220:223], v[152:155]
 v_mfma_f32_16x16x32_bf16 v[156:159], a[212:215], v[220:223], v[156:159]
 s_waitcnt lgkmcnt(4)
 v_mfma_f32_16x16x32_bf16 v[64:67], a[216:219], v[160:163], v[64:67]
 ds_read_b128 v[192:195], v19 offset:0
 v_mfma_f32_16x16x32_bf16 v[68:71], a[220:223], v[160:163], v[68:71]
 v_add_u32 v18, s33, v14
 v_mfma_f32_16x16x32_bf16 v[72:75], a[224:227], v[160:163], v[72:75]
 v_mfma_f32_16x16x32_bf16 v[76:79], a[216:219], v[164:167], v[76:79]
 ds_read_b128 v[196:199], v19 offset:2048
 v_mfma_f32_16x16x32_bf16 v[80:83], a[220:223], v[164:167], v[80:83]
 buffer_load_dwordx4 v12, s[8:11], s30 offen offset:2048 lds
 v_mfma_f32_16x16x32_bf16 v[84:87], a[224:227], v[164:167], v[84:87]
 v_mfma_f32_16x16x32_bf16 v[88:91], a[216:219], v[168:171], v[88:91]
 ds_read_b128 v[200:203], v19 offset:4096
 v_mfma_f32_16x16x32_bf16 v[92:95], a[220:223], v[168:171], v[92:95]
 v_mfma_f32_16x16x32_bf16 v[96:99], a[224:227], v[168:171], v[96:99]
 v_mfma_f32_16x16x32_bf16 v[100:103], a[216:219], v[172:175], v[100:103]
 ds_read_b128 v[204:207], v19 offset:6144
 v_mfma_f32_16x16x32_bf16 v[104:107], a[220:223], v[172:175], v[104:107]
 v_mfma_f32_16x16x32_bf16 v[108:111], a[224:227], v[172:175], v[108:111]
 s_waitcnt lgkmcnt(4)
 v_mfma_f32_16x16x32_bf16 v[112:115], a[216:219], v[176:179], v[112:115]
 ds_read_b128 v[208:211], v19 offset:8192
 v_mfma_f32_16x16x32_bf16 v[116:119], a[220:223], v[176:179], v[116:119]
 v_mfma_f32_16x16x32_bf16 v[120:123], a[224:227], v[176:179], v[120:123]
 v_mfma_f32_16x16x32_bf16 v[124:127], a[216:219], v[180:183], v[124:127]
 ds_read_b128 v[212:215], v19 offset:10240
 v_mfma_f32_16x16x32_bf16 v[128:131], a[220:223], v[180:183], v[128:131]
 buffer_load_dwordx4 v13, s[8:11], s30 offen offset:3072 lds
 v_mfma_f32_16x16x32_bf16 v[132:135], a[224:227], v[180:183], v[132:135]
 s_add_u32 s30, s30, 128
 s_add_u32 m0, m0, 16384
 v_mfma_f32_16x16x32_bf16 v[136:139], a[216:219], v[184:187], v[136:139]
 ds_read_b128 v[216:219], v19 offset:12288
 v_mfma_f32_16x16x32_bf16 v[140:143], a[220:223], v[184:187], v[140:143]
 s_cmp_lt_u32 m0, s46
 s_cselect_b32 m0, m0, s47
 v_mfma_f32_16x16x32_bf16 v[144:147], a[224:227], v[184:187], v[144:147]
 v_mfma_f32_16x16x32_bf16 v[148:151], a[216:219], v[188:191], v[148:151]
 ds_read_b128 v[220:223], v19 offset:14336
 v_mfma_f32_16x16x32_bf16 v[152:155], a[220:223], v[188:191], v[152:155]
 v_mfma_f32_16x16x32_bf16 v[156:159], a[224:227], v[188:191], v[156:159]
 s_waitcnt vmcnt(12) lgkmcnt(4)
 s_barrier
 v_mfma_f32_16x16x32_bf16 v[64:67], a[228:231], v[192:195], v[64:67]
 ds_read_b128 v[160:163], v18 offset:0
 v_mfma_f32_16x16x32_bf16 v[68:71], a[232:235], v[192:195], v[68:71]
 v_mfma_f32_16x16x32_bf16 v[72:75], a[236:239], v[192:195], v[72:75]
 v_add_u32 v19, s33, v15
 s_add_u32 s33, s33, 16384
 v_mfma_f32_16x16x32_bf16 v[76:79], a[228:231], v[196:199], v[76:79]
 ds_read_b128 v[164:167], v18 offset:2048
 v_cvt_pk_bf16_f32 v224, v64, v65
 v_mfma_f32_16x16x32_bf16 v[80:83], a[232:235], v[196:199], v[80:83]
 buffer_load_dwordx4 v10, s[8:11], s30 offen offset:0 lds
 v_mfma_f32_16x16x32_bf16 v[84:87], a[236:239], v[196:199], v[84:87]
 s_cmp_lt_u32 s33, 98304
 s_cselect_b32 s33, s33, 0
 v_mfma_f32_16x16x32_bf16 v[88:91], a[228:231], v[200:203], v[88:91]
 ds_read_b128 v[168:171], v18 offset:4096
 v_cvt_pk_bf16_f32 v225, v66, v67
 v_mfma_f32_16x16x32_bf16 v[92:95], a[232:235], v[200:203], v[92:95]
 v_cvt_pk_bf16_f32 v226, v68, v69
 v_cvt_pk_bf16_f32 v227, v70, v71
 v_mfma_f32_16x16x32_bf16 v[96:99], a[236:239], v[200:203], v[96:99]
 v_cvt_pk_bf16_f32 v228, v72, v73
 v_cvt_pk_bf16_f32 v229, v74, v75
 v_mfma_f32_16x16x32_bf16 v[100:103], a[228:231], v[204:207], v[100:103]
 ds_read_b128 v[172:175], v18 offset:6144
 v_mfma_f32_16x16x32_bf16 v[104:107], a[232:235], v[204:207], v[104:107]
 ds_write_b64 v22, v[224:225] offset:0
 v_mfma_f32_16x16x32_bf16 v[108:111], a[236:239], v[204:207], v[108:111]
 s_waitcnt lgkmcnt(5)
 v_mfma_f32_16x16x32_bf16 v[112:115], a[228:231], v[208:211], v[112:115]
 ds_read_b128 v[176:179], v18 offset:8192
 v_mfma_f32_16x16x32_bf16 v[116:119], a[232:235], v[208:211], v[116:119]
 ds_write_b64 v22, v[226:227] offset:8
 v_mfma_f32_16x16x32_bf16 v[120:123], a[236:239], v[208:211], v[120:123]
 ds_write_b64 v16, v[228:229] offset:64
 v_mfma_f32_16x16x32_bf16 v[124:127], a[228:231], v[212:215], v[124:127]
 ds_read_b128 v[180:183], v18 offset:10240
 v_cvt_pk_bf16_f32 v230, v76, v77
 v_mfma_f32_16x16x32_bf16 v[128:131], a[232:235], v[212:215], v[128:131]
 buffer_load_dwordx4 v11, s[8:11], s30 offen offset:1024 lds
 v_mfma_f32_16x16x32_bf16 v[132:135], a[236:239], v[212:215], v[132:135]
 v_cvt_pk_bf16_f32 v231, v78, v79
 v_cvt_pk_bf16_f32 v232, v80, v81
 v_mfma_f32_16x16x32_bf16 v[136:139], a[228:231], v[216:219], v[136:139]
 ds_read_b128 v[184:187], v18 offset:12288
 v_cvt_pk_bf16_f32 v233, v82, v83
 v_mfma_f32_16x16x32_bf16 v[140:143], a[232:235], v[216:219], v[140:143]
 v_cvt_pk_bf16_f32 v234, v84, v85
 v_cvt_pk_bf16_f32 v235, v86, v87
 v_mfma_f32_16x16x32_bf16 v[144:147], a[236:239], v[216:219], v[144:147]
 ds_write_b64 v22, v[230:231] offset:6400
 v_mfma_f32_16x16x32_bf16 v[148:151], a[228:231], v[220:223], v[148:151]
 ds_read_b128 v[188:191], v18 offset:14336
 v_mfma_f32_16x16x32_bf16 v[152:155], a[232:235], v[220:223], v[152:155]
 ds_write_b64 v22, v[232:233] offset:6408
 v_mfma_f32_16x16x32_bf16 v[156:159], a[236:239], v[220:223], v[156:159]
 s_waitcnt lgkmcnt(9)
kv_end_136:
 s_cmp_gt_u32 s26, 0
 s_cbranch_scc1 kv_blk_135
 s_nop 7
 ds_write_b64 v16, v[234:235] offset:6464
 v_cvt_pk_bf16_f32 v236, v88, v89
 v_cvt_pk_bf16_f32 v237, v90, v91
 v_cvt_pk_bf16_f32 v238, v92, v93
 v_cvt_pk_bf16_f32 v239, v94, v95
 v_cvt_pk_bf16_f32 v240, v96, v97
 v_cvt_pk_bf16_f32 v241, v98, v99
 ds_write_b64 v22, v[236:237] offset:12800
 ds_write_b64 v22, v[238:239] offset:12808
 ds_write_b64 v16, v[240:241] offset:12864
 v_cvt_pk_bf16_f32 v242, v100, v101
 v_cvt_pk_bf16_f32 v243, v102, v103
 v_cvt_pk_bf16_f32 v244, v104, v105
 v_cvt_pk_bf16_f32 v245, v106, v107
 v_cvt_pk_bf16_f32 v246, v108, v109
 v_cvt_pk_bf16_f32 v247, v110, v111
 ds_write_b64 v22, v[242:243] offset:19200
 ds_write_b64 v22, v[244:245] offset:19208
 ds_write_b64 v16, v[246:247] offset:19264
 v_cvt_pk_bf16_f32 v224, v112, v113
 v_cvt_pk_bf16_f32 v225, v114, v115
 v_cvt_pk_bf16_f32 v226, v116, v117
 v_cvt_pk_bf16_f32 v227, v118, v119
 v_cvt_pk_bf16_f32 v228, v120, v121
 v_cvt_pk_bf16_f32 v229, v122, v123
 ds_write_b64 v22, v[224:225] offset:25600
 ds_write_b64 v22, v[226:227] offset:25608
 ds_write_b64 v16, v[228:229] offset:25664
 v_cvt_pk_bf16_f32 v230, v124, v125
 v_cvt_pk_bf16_f32 v231, v126, v127
 v_cvt_pk_bf16_f32 v232, v128, v129
 v_cvt_pk_bf16_f32 v233, v130, v131
 v_cvt_pk_bf16_f32 v234, v132, v133
 v_cvt_pk_bf16_f32 v235, v134, v135
 ds_write_b64 v22, v[230:231] offset:32000
 ds_write_b64 v22, v[232:233] offset:32008
 ds_write_b64 v16, v[234:235] offset:32064
 v_cvt_pk_bf16_f32 v236, v136, v137
 v_cvt_pk_bf16_f32 v237, v138, v139
 v_cvt_pk_bf16_f32 v238, v140, v141
 v_cvt_pk_bf16_f32 v239, v142, v143
 v_cvt_pk_bf16_f32 v240, v144, v145
 v_cvt_pk_bf16_f32 v241, v146, v147
 ds_write_b64 v22, v[236:237] offset:38400
 ds_write_b64 v22, v[238:239] offset:38408
 ds_write_b64 v16, v[240:241] offset:38464
 v_cvt_pk_bf16_f32 v242, v148, v149
 v_cvt_pk_bf16_f32 v243, v150, v151
 v_cvt_pk_bf16_f32 v244, v152, v153
 v_cvt_pk_bf16_f32 v245, v154, v155
 v_cvt_pk_bf16_f32 v246, v156, v157
 v_cvt_pk_bf16_f32 v247, v158, v159
 ds_write_b64 v22, v[242:243] offset:44800
 ds_write_b64 v22, v[244:245] offset:44808
 ds_write_b64 v16, v[246:247] offset:44864
 s_waitcnt vmcnt(0) lgkmcnt(0)
 s_barrier
 ds_read_b128 v[224:227], v23 offset:0
 ds_read_b128 v[228:231], v23 offset:64
 ds_read_b128 v[232:235], v23 offset:128
 ds_read_b128 v[236:239], v23 offset:192
 ds_read_b128 v[240:243], v23 offset:256
 ds_read_b128 v[244:247], v23 offset:320
 s_waitcnt lgkmcnt(0)
 s_add_u32 s21, s48, 0
 buffer_store_dwordx4 v[224:227], v26, s[16:19], s21 offen offset:0 sc1
 buffer_store_dwordx4 v[228:231], v26, s[16:19], s21 offen offset:1024 sc1
 buffer_store_dwordx4 v[232:235], v26, s[16:19], s21 offen offset:2048 sc1
 buffer_store_dwordx4 v[236:239], v26, s[16:19], s21 offen offset:3072 sc1
 s_add_u32 s21, s48, 4096
 buffer_store_dwordx4 v[240:243], v26, s[16:19], s21 offen offset:0 sc1
 buffer_store_dwordx4 v[244:247], v26, s[16:19], s21 offen offset:1024 sc1
 s_nop 1
 ds_read_b128 v[224:227], v23 offset:6400
 ds_read_b128 v[228:231], v23 offset:6464
 ds_read_b128 v[232:235], v23 offset:6528
 ds_read_b128 v[236:239], v23 offset:6592
 ds_read_b128 v[240:243], v23 offset:6656
 ds_read_b128 v[244:247], v23 offset:6720
 s_waitcnt lgkmcnt(0)
 buffer_store_dwordx4 v[224:227], v26, s[16:19], s21 offen offset:2048 sc1
 buffer_store_dwordx4 v[228:231], v26, s[16:19], s21 offen offset:3072 sc1
 s_add_u32 s21, s48, 8192
 buffer_store_dwordx4 v[232:235], v26, s[16:19], s21 offen offset:0 sc1
 buffer_store_dwordx4 v[236:239], v26, s[16:19], s21 offen offset:1024 sc1
 buffer_store_dwordx4 v[240:243], v26, s[16:19], s21 offen offset:2048 sc1
 buffer_store_dwordx4 v[244:247], v26, s[16:19], s21 offen offset:3072 sc1
 s_nop 1
 s_waitcnt vmcnt(0)
 s_barrier
 s_cmp_lg_u32 s20, 0
 s_cbranch_scc1 af_137
 v_mov_b32 v4, 0
 v_mov_b32 v5, 1
 s_mov_b64 exec, 1
 buffer_atomic_add v5, v4, s[72:75], s61 offen sc1
 s_mov_b64 exec, -1
 s_nop 1
af_137:
 s_cmp_lg_u32 s43, 0
 s_cbranch_scc1 kv_fin
 s_mov_b32 s87, -2
 s_add_u32 s21, s42, 32
 s_branch do_opb2
kv_help:
 s_waitcnt vmcnt(0) lgkmcnt(0)
 s_barrier
 s_lshr_b32 s2, s3, 1
 s_branch q_entry
kv_fin:
 s_branch queue
not_kv:
 s_cmp_ge_u32 s3, 96
 s_cbranch_scc1 not_vw
 s_sub_u32 s2, s3, 64
 s_load_dwordx2 s[72:73], s[0:1], 104
 s_waitcnt lgkmcnt(0)
 s_add_u32 s72, s72, 81068032
 s_addc_u32 s73, s73, 0
 s_mov_b32 s74, 129024
 s_mov_b32 s75, 0x00020000
 s_add_u32 s8, s38, 78643200
 s_addc_u32 s9, s39, 0
 s_mov_b32 s10, 2162688
 s_mov_b32 s11, 0x00020000
 s_add_u32 s12, s38, 50331648
 s_addc_u32 s13, s39, 0
 s_mov_b32 s14, 12582912
 s_mov_b32 s15, 0x00020000
 s_add_u32 s16, s38, 83886079
 s_addc_u32 s17, s39, 0
 s_and_b32 s16, s16, 0xffe00000
 s_or_b32 s16, s16, 262144
 s_mov_b32 s18, 131072
 s_mov_b32 s19, 0x00020000
 v_lshlrev_b32 v8, 4, v0
 v_lshlrev_b32 v9, 4, v1
 v_mov_b32 v4, 0
 v_mov_b32 v12, -1
 v_mov_b32 v5, 0
 v_mov_b32 v13, -1
 v_mov_b32 v6, 0
 v_mov_b32 v14, -1
 v_mov_b32 v7, 0
 v_mov_b32 v15, -1
 s_lshl_b32 s21, s2, 12
 buffer_store_dwordx4 v[4:7], v8, s[72:75], s21 offen sc1
 s_lshr_b32 s21, s2, 3
 s_lshl_b32 s21, s21, 15
 s_bfe_u32 s22, s2, 0x10002
 s_lshl_b32 s22, s22, 13
 s_add_u32 s21, s21, s22
 s_bfe_u32 s22, s2, 0x10001
 s_lshl_b32 s22, s22, 14
 s_add_u32 s21, s21, s22
 s_and_b32 s22, s2, 1
 s_mul_i32 s22, s22, 3
 s_add_u32 s22, s22, s20
 s_lshl_b32 s22, s22, 10
 s_add_u32 s21, s21, s22
 s_cmp_lt_u32 s20, 3
 s_cselect_b32 s21, s21, 0x80000000
 buffer_store_dwordx4 v[4:7], v9, s[16:19], s21 offen sc1
 s_mul_i32 s23, s20, 540672
 s_lshl_b32 s21, s2, 11
 s_add_u32 s21, s21, s23
 s_add_u32 s21, s21, 81920
 buffer_store_dwordx4 v[12:15], v9, s[8:11], s21 offen sc1
 buffer_store_dwordx4 v[12:15], v9, s[8:11], s21 offen offset:1024 sc1
 s_lshl_b32 s21, s2, 9
 s_add_u32 s21, s21, s23
 s_add_u32 s21, s21, 376832
 s_mov_b64 exec, 0xffffffff
 buffer_store_dwordx4 v[12:15], v9, s[8:11], s21 offen sc1
 s_mov_b64 exec, -1
 s_waitcnt vmcnt(0)
 s_barrier
 s_mov_b32 s21, 76
 s_cmp_lg_u32 s20, 0
 s_cbranch_scc1 af_138
 v_mov_b32 v10, 0
 v_mov_b32 v11, 1
 s_mov_b64 exec, 1
 buffer_atomic_add v11, v10, s[32:35], s21 offen sc1
 s_mov_b64 exec, -1
 s_nop 1
af_138:
 s_load_dwordx2 s[6:7], s[0:1], 40
 s_load_dwordx2 s[38:39], s[0:1], 104
 s_waitcnt lgkmcnt(0)
 s_mov_b32 s12, s6
 s_mov_b32 s13, s7
 s_mov_b32 s14, 7864320
 s_mov_b32 s15, 0x00020000
 s_mov_b32 s16, s38
 s_mov_b32 s17, s39
 s_mov_b32 s18, 50331648
 s_mov_b32 s19, 0x00020000
 s_add_u32 s24, s38, 88080384
 s_addc_u32 s25, s39, 0
 s_mov_b32 s26, 83886080
 s_mov_b32 s27, 0x00020000
 s_load_dwordx2 s[72:73], s[0:1], 104
 s_waitcnt lgkmcnt(0)
 s_add_u32 s72, s72, 81068032
 s_addc_u32 s73, s73, 0
 s_mov_b32 s74, 129024
 s_mov_b32 s75, 0x00020000
 v_mov_b32 v29, 52429
 s_mul_i32 s21, s20, 960
 s_add_u32 s21, s21, 0
 v_add_u32 v21, s21, v1
 v_mul_u32_u24 v22, v21, v29
 v_lshrrev_b32 v22, 22, v22
 v_mul_u32_u24 v23, 80, v22
 v_sub_u32 v21, v21, v23
 v_bfe_u32 v23, v22, 3, 1
 v_and_b32 v24, 3, v22
 v_lshl_add_u32 v23, v23, 2, v24
 v_lshlrev_b32 v23, 1, v23
 v_xor_b32 v21, v21, v23
 v_cmp_gt_u32 vcc, 32, v22
 v_bfe_u32 v26, v22, 3, 2
 v_lshl_add_u32 v25, v26, 2, v24
 v_bfe_u32 v26, v22, 2, 1
 v_lshl_add_u32 v25, v26, 4, v25
 v_cndmask_b32 v25, v22, v25, vcc
 v_mul_u32_u24 v25, 1280, v25
 v_lshl_add_u32 v64, v21, 4, v25
 s_mul_i32 s21, s20, 960
 s_add_u32 s21, s21, 64
 v_add_u32 v21, s21, v1
 v_mul_u32_u24 v22, v21, v29
 v_lshrrev_b32 v22, 22, v22
 v_mul_u32_u24 v23, 80, v22
 v_sub_u32 v21, v21, v23
 v_bfe_u32 v23, v22, 3, 1
 v_and_b32 v24, 3, v22
 v_lshl_add_u32 v23, v23, 2, v24
 v_lshlrev_b32 v23, 1, v23
 v_xor_b32 v21, v21, v23
 v_cmp_gt_u32 vcc, 32, v22
 v_bfe_u32 v26, v22, 3, 2
 v_lshl_add_u32 v25, v26, 2, v24
 v_bfe_u32 v26, v22, 2, 1
 v_lshl_add_u32 v25, v26, 4, v25
 v_cndmask_b32 v25, v22, v25, vcc
 v_mul_u32_u24 v25, 1280, v25
 v_lshl_add_u32 v65, v21, 4, v25
 s_mul_i32 s21, s20, 960
 s_add_u32 s21, s21, 128
 v_add_u32 v21, s21, v1
 v_mul_u32_u24 v22, v21, v29
 v_lshrrev_b32 v22, 22, v22
 v_mul_u32_u24 v23, 80, v22
 v_sub_u32 v21, v21, v23
 v_bfe_u32 v23, v22, 3, 1
 v_and_b32 v24, 3, v22
 v_lshl_add_u32 v23, v23, 2, v24
 v_lshlrev_b32 v23, 1, v23
 v_xor_b32 v21, v21, v23
 v_cmp_gt_u32 vcc, 32, v22
 v_bfe_u32 v26, v22, 3, 2
 v_lshl_add_u32 v25, v26, 2, v24
 v_bfe_u32 v26, v22, 2, 1
 v_lshl_add_u32 v25, v26, 4, v25
 v_cndmask_b32 v25, v22, v25, vcc
 v_mul_u32_u24 v25, 1280, v25
 v_lshl_add_u32 v66, v21, 4, v25
 s_mul_i32 s21, s20, 960
 s_add_u32 s21, s21, 192
 v_add_u32 v21, s21, v1
 v_mul_u32_u24 v22, v21, v29
 v_lshrrev_b32 v22, 22, v22
 v_mul_u32_u24 v23, 80, v22
 v_sub_u32 v21, v21, v23
 v_bfe_u32 v23, v22, 3, 1
 v_and_b32 v24, 3, v22
 v_lshl_add_u32 v23, v23, 2, v24
 v_lshlrev_b32 v23, 1, v23
 v_xor_b32 v21, v21, v23
 v_cmp_gt_u32 vcc, 32, v22
 v_bfe_u32 v26, v22, 3, 2
 v_lshl_add_u32 v25, v26, 2, v24
 v_bfe_u32 v26, v22, 2, 1
 v_lshl_add_u32 v25, v26, 4, v25
 v_cndmask_b32 v25, v22, v25, vcc
 v_mul_u32_u24 v25, 1280, v25
 v_lshl_add_u32 v67, v21, 4, v25
 s_mul_i32 s21, s20, 960
 s_add_u32 s21, s21, 256
 v_add_u32 v21, s21, v1
 v_mul_u32_u24 v22, v21, v29
 v_lshrrev_b32 v22, 22, v22
 v_mul_u32_u24 v23, 80, v22
 v_sub_u32 v21, v21, v23
 v_bfe_u32 v23, v22, 3, 1
 v_and_b32 v24, 3, v22
 v_lshl_add_u32 v23, v23, 2, v24
 v_lshlrev_b32 v23, 1, v23
 v_xor_b32 v21, v21, v23
 v_cmp_gt_u32 vcc, 32, v22
 v_bfe_u32 v26, v22, 3, 2
 v_lshl_add_u32 v25, v26, 2, v24
 v_bfe_u32 v26, v22, 2, 1
 v_lshl_add_u32 v25, v26, 4, v25
 v_cndmask_b32 v25, v22, v25, vcc
 v_mul_u32_u24 v25, 1280, v25
 v_lshl_add_u32 v68, v21, 4, v25
 s_mul_i32 s21, s20, 960
 s_add_u32 s21, s21, 320
 v_add_u32 v21, s21, v1
 v_mul_u32_u24 v22, v21, v29
 v_lshrrev_b32 v22, 22, v22
 v_mul_u32_u24 v23, 80, v22
 v_sub_u32 v21, v21, v23
 v_bfe_u32 v23, v22, 3, 1
 v_and_b32 v24, 3, v22
 v_lshl_add_u32 v23, v23, 2, v24
 v_lshlrev_b32 v23, 1, v23
 v_xor_b32 v21, v21, v23
 v_cmp_gt_u32 vcc, 32, v22
 v_bfe_u32 v26, v22, 3, 2
 v_lshl_add_u32 v25, v26, 2, v24
 v_bfe_u32 v26, v22, 2, 1
 v_lshl_add_u32 v25, v26, 4, v25
 v_cndmask_b32 v25, v22, v25, vcc
 v_mul_u32_u24 v25, 1280, v25
 v_lshl_add_u32 v69, v21, 4, v25
 s_mul_i32 s21, s20, 960
 s_add_u32 s21, s21, 384
 v_add_u32 v21, s21, v1
 v_mul_u32_u24 v22, v21, v29
 v_lshrrev_b32 v22, 22, v22
 v_mul_u32_u24 v23, 80, v22
 v_sub_u32 v21, v21, v23
 v_bfe_u32 v23, v22, 3, 1
 v_and_b32 v24, 3, v22
 v_lshl_add_u32 v23, v23, 2, v24
 v_lshlrev_b32 v23, 1, v23
 v_xor_b32 v21, v21, v23
 v_cmp_gt_u32 vcc, 32, v22
 v_bfe_u32 v26, v22, 3, 2
 v_lshl_add_u32 v25, v26, 2, v24
 v_bfe_u32 v26, v22, 2, 1
 v_lshl_add_u32 v25, v26, 4, v25
 v_cndmask_b32 v25, v22, v25, vcc
 v_mul_u32_u24 v25, 1280, v25
 v_lshl_add_u32 v70, v21, 4, v25
 s_mul_i32 s21, s20, 960
 s_add_u32 s21, s21, 448
 v_add_u32 v21, s21, v1
 v_mul_u32_u24 v22, v21, v29
 v_lshrrev_b32 v22, 22, v22
 v_mul_u32_u24 v23, 80, v22
 v_sub_u32 v21, v21, v23
 v_bfe_u32 v23, v22, 3, 1
 v_and_b32 v24, 3, v22
 v_lshl_add_u32 v23, v23, 2, v24
 v_lshlrev_b32 v23, 1, v23
 v_xor_b32 v21, v21, v23
 v_cmp_gt_u32 vcc, 32, v22
 v_bfe_u32 v26, v22, 3, 2
 v_lshl_add_u32 v25, v26, 2, v24
 v_bfe_u32 v26, v22, 2, 1
 v_lshl_add_u32 v25, v26, 4, v25
 v_cndmask_b32 v25, v22, v25, vcc
 v_mul_u32_u24 v25, 1280, v25
 v_lshl_add_u32 v71, v21, 4, v25
 s_mul_i32 s21, s20, 960
 s_add_u32 s21, s21, 512
 v_add_u32 v21, s21, v1
 v_mul_u32_u24 v22, v21, v29
 v_lshrrev_b32 v22, 22, v22
 v_mul_u32_u24 v23, 80, v22
 v_sub_u32 v21, v21, v23
 v_bfe_u32 v23, v22, 3, 1
 v_and_b32 v24, 3, v22
 v_lshl_add_u32 v23, v23, 2, v24
 v_lshlrev_b32 v23, 1, v23
 v_xor_b32 v21, v21, v23
 v_cmp_gt_u32 vcc, 32, v22
 v_bfe_u32 v26, v22, 3, 2
 v_lshl_add_u32 v25, v26, 2, v24
 v_bfe_u32 v26, v22, 2, 1
 v_lshl_add_u32 v25, v26, 4, v25
 v_cndmask_b32 v25, v22, v25, vcc
 v_mul_u32_u24 v25, 1280, v25
 v_lshl_add_u32 v72, v21, 4, v25
 s_mul_i32 s21, s20, 960
 s_add_u32 s21, s21, 576
 v_add_u32 v21, s21, v1
 v_mul_u32_u24 v22, v21, v29
 v_lshrrev_b32 v22, 22, v22
 v_mul_u32_u24 v23, 80, v22
 v_sub_u32 v21, v21, v23
 v_bfe_u32 v23, v22, 3, 1
 v_and_b32 v24, 3, v22
 v_lshl_add_u32 v23, v23, 2, v24
 v_lshlrev_b32 v23, 1, v23
 v_xor_b32 v21, v21, v23
 v_cmp_gt_u32 vcc, 32, v22
 v_bfe_u32 v26, v22, 3, 2
 v_lshl_add_u32 v25, v26, 2, v24
 v_bfe_u32 v26, v22, 2, 1
 v_lshl_add_u32 v25, v26, 4, v25
 v_cndmask_b32 v25, v22, v25, vcc
 v_mul_u32_u24 v25, 1280, v25
 v_lshl_add_u32 v73, v21, 4, v25
 s_mul_i32 s21, s20, 960
 s_add_u32 s21, s21, 640
 v_add_u32 v21, s21, v1
 v_mul_u32_u24 v22, v21, v29
 v_lshrrev_b32 v22, 22, v22
 v_mul_u32_u24 v23, 80, v22
 v_sub_u32 v21, v21, v23
 v_bfe_u32 v23, v22, 3, 1
 v_and_b32 v24, 3, v22
 v_lshl_add_u32 v23, v23, 2, v24
 v_lshlrev_b32 v23, 1, v23
 v_xor_b32 v21, v21, v23
 v_cmp_gt_u32 vcc, 32, v22
 v_bfe_u32 v26, v22, 3, 2
 v_lshl_add_u32 v25, v26, 2, v24
 v_bfe_u32 v26, v22, 2, 1
 v_lshl_add_u32 v25, v26, 4, v25
 v_cndmask_b32 v25, v22, v25, vcc
 v_mul_u32_u24 v25, 1280, v25
 v_lshl_add_u32 v74, v21, 4, v25
 s_mul_i32 s21, s20, 960
 s_add_u32 s21, s21, 704
 v_add_u32 v21, s21, v1
 v_mul_u32_u24 v22, v21, v29
 v_lshrrev_b32 v22, 22, v22
 v_mul_u32_u24 v23, 80, v22
 v_sub_u32 v21, v21, v23
 v_bfe_u32 v23, v22, 3, 1
 v_and_b32 v24, 3, v22
 v_lshl_add_u32 v23, v23, 2, v24
 v_lshlrev_b32 v23, 1, v23
 v_xor_b32 v21, v21, v23
 v_cmp_gt_u32 vcc, 32, v22
 v_bfe_u32 v26, v22, 3, 2
 v_lshl_add_u32 v25, v26, 2, v24
 v_bfe_u32 v26, v22, 2, 1
 v_lshl_add_u32 v25, v26, 4, v25
 v_cndmask_b32 v25, v22, v25, vcc
 v_mul_u32_u24 v25, 1280, v25
 v_lshl_add_u32 v75, v21, 4, v25
 s_mul_i32 s21, s20, 960
 s_add_u32 s21, s21, 768
 v_add_u32 v21, s21, v1
 v_mul_u32_u24 v22, v21, v29
 v_lshrrev_b32 v22, 22, v22
 v_mul_u32_u24 v23, 80, v22
 v_sub_u32 v21, v21, v23
 v_bfe_u32 v23, v22, 3, 1
 v_and_b32 v24, 3, v22
 v_lshl_add_u32 v23, v23, 2, v24
 v_lshlrev_b32 v23, 1, v23
 v_xor_b32 v21, v21, v23
 v_cmp_gt_u32 vcc, 32, v22
 v_bfe_u32 v26, v22, 3, 2
 v_lshl_add_u32 v25, v26, 2, v24
 v_bfe_u32 v26, v22, 2, 1
 v_lshl_add_u32 v25, v26, 4, v25
 v_cndmask_b32 v25, v22, v25, vcc
 v_mul_u32_u24 v25, 1280, v25
 v_lshl_add_u32 v76, v21, 4, v25
 s_mul_i32 s21, s20, 960
 s_add_u32 s21, s21, 832
 v_add_u32 v21, s21, v1
 v_mul_u32_u24 v22, v21, v29
 v_lshrrev_b32 v22, 22, v22
 v_mul_u32_u24 v23, 80, v22
 v_sub_u32 v21, v21, v23
 v_bfe_u32 v23, v22, 3, 1
 v_and_b32 v24, 3, v22
 v_lshl_add_u32 v23, v23, 2, v24
 v_lshlrev_b32 v23, 1, v23
 v_xor_b32 v21, v21, v23
 v_cmp_gt_u32 vcc, 32, v22
 v_bfe_u32 v26, v22, 3, 2
 v_lshl_add_u32 v25, v26, 2, v24
 v_bfe_u32 v26, v22, 2, 1
 v_lshl_add_u32 v25, v26, 4, v25
 v_cndmask_b32 v25, v22, v25, vcc
 v_mul_u32_u24 v25, 1280, v25
 v_lshl_add_u32 v77, v21, 4, v25
 s_mul_i32 s21, s20, 960
 s_add_u32 s21, s21, 896
 v_add_u32 v21, s21, v1
 v_mul_u32_u24 v22, v21, v29
 v_lshrrev_b32 v22, 22, v22
 v_mul_u32_u24 v23, 80, v22
 v_sub_u32 v21, v21, v23
 v_bfe_u32 v23, v22, 3, 1
 v_and_b32 v24, 3, v22
 v_lshl_add_u32 v23, v23, 2, v24
 v_lshlrev_b32 v23, 1, v23
 v_xor_b32 v21, v21, v23
 v_cmp_gt_u32 vcc, 32, v22
 v_bfe_u32 v26, v22, 3, 2
 v_lshl_add_u32 v25, v26, 2, v24
 v_bfe_u32 v26, v22, 2, 1
 v_lshl_add_u32 v25, v26, 4, v25
 v_cndmask_b32 v25, v22, v25, vcc
 v_mul_u32_u24 v25, 1280, v25
 v_lshl_add_u32 v78, v21, 4, v25
 s_mul_i32 s40, s2, 245760
 s_add_u32 s21, s40, 0
 s_mul_i32 s22, s20, 15360
 s_add_u32 s22, s22, 0
 s_add_u32 m0, s22, 0
 s_nop 0
 buffer_load_dwordx4 v64, s[12:15], s21 offen lds
 s_add_u32 m0, s22, 1024
 s_nop 0
 buffer_load_dwordx4 v65, s[12:15], s21 offen lds
 s_add_u32 m0, s22, 2048
 s_nop 0
 buffer_load_dwordx4 v66, s[12:15], s21 offen lds
 s_add_u32 m0, s22, 3072
 s_nop 0
 buffer_load_dwordx4 v67, s[12:15], s21 offen lds
 s_add_u32 m0, s22, 4096
 s_nop 0
 buffer_load_dwordx4 v68, s[12:15], s21 offen lds
 s_add_u32 m0, s22, 5120
 s_nop 0
 buffer_load_dwordx4 v69, s[12:15], s21 offen lds
 s_add_u32 m0, s22, 6144
 s_nop 0
 buffer_load_dwordx4 v70, s[12:15], s21 offen lds
 s_add_u32 m0, s22, 7168
 s_nop 0
 buffer_load_dwordx4 v71, s[12:15], s21 offen lds
 s_add_u32 m0, s22, 8192
 s_nop 0
 buffer_load_dwordx4 v72, s[12:15], s21 offen lds
 s_add_u32 m0, s22, 9216
 s_nop 0
 buffer_load_dwordx4 v73, s[12:15], s21 offen lds
 s_add_u32 m0, s22, 10240
 s_nop 0
 buffer_load_dwordx4 v74, s[12:15], s21 offen lds
 s_add_u32 m0, s22, 11264
 s_nop 0
 buffer_load_dwordx4 v75, s[12:15], s21 offen lds
 s_add_u32 m0, s22, 12288
 s_nop 0
 buffer_load_dwordx4 v76, s[12:15], s21 offen lds
 s_add_u32 m0, s22, 13312
 s_nop 0
 buffer_load_dwordx4 v77, s[12:15], s21 offen lds
 s_add_u32 m0, s22, 14336
 s_nop 0
 buffer_load_dwordx4 v78, s[12:15], s21 offen lds
 s_add_u32 s21, s40, 61440
 s_mul_i32 s22, s20, 15360
 s_add_u32 s22, s22, 61440
 s_add_u32 m0, s22, 0
 s_nop 0
 buffer_load_dwordx4 v64, s[12:15], s21 offen lds
 s_add_u32 m0, s22, 1024
 s_nop 0
 buffer_load_dwordx4 v65, s[12:15], s21 offen lds
 s_add_u32 m0, s22, 2048
 s_nop 0
 buffer_load_dwordx4 v66, s[12:15], s21 offen lds
 s_add_u32 m0, s22, 3072
 s_nop 0
 buffer_load_dwordx4 v67, s[12:15], s21 offen lds
 s_add_u32 m0, s22, 4096
 s_nop 0
 buffer_load_dwordx4 v68, s[12:15], s21 offen lds
 s_add_u32 m0, s22, 5120
 s_nop 0
 buffer_load_dwordx4 v69, s[12:15], s21 offen lds
 s_add_u32 m0, s22, 6144
 s_nop 0
 buffer_load_dwordx4 v70, s[12:15], s21 offen lds
 s_add_u32 m0, s22, 7168
 s_nop 0
 buffer_load_dwordx4 v71, s[12:15], s21 offen lds
 s_add_u32 m0, s22, 8192
 s_nop 0
 buffer_load_dwordx4 v72, s[12:15], s21 offen lds
 s_add_u32 m0, s22, 9216
 s_nop 0
 buffer_load_dwordx4 v73, s[12:15], s21 offen lds
 s_add_u32 m0, s22, 10240
 s_nop 0
 buffer_load_dwordx4 v74, s[12:15], s21 offen lds
 s_add_u32 m0, s22, 11264
 s_nop 0
 buffer_load_dwordx4 v75, s[12:15], s21 offen lds
 s_add_u32 m0, s22, 12288
 s_nop 0
 buffer_load_dwordx4 v76, s[12:15], s21 offen lds
 s_add_u32 m0, s22, 13312
 s_nop 0
 buffer_load_dwordx4 v77, s[12:15], s21 offen lds
 s_add_u32 m0, s22, 14336
 s_nop 0
 buffer_load_dwordx4 v78, s[12:15], s21 offen lds
 s_add_u32 s21, s40, 122880
 s_mul_i32 s22, s20, 15360
 s_add_u32 s22, s22, 0
 buffer_load_dwordx4 v[80:83], v64, s[12:15], s21 offen
 buffer_load_dwordx4 v[84:87], v65, s[12:15], s21 offen
 buffer_load_dwordx4 v[88:91], v66, s[12:15], s21 offen
 buffer_load_dwordx4 v[92:95], v67, s[12:15], s21 offen
 buffer_load_dwordx4 v[96:99], v68, s[12:15], s21 offen
 buffer_load_dwordx4 v[100:103], v69, s[12:15], s21 offen
 buffer_load_dwordx4 v[104:107], v70, s[12:15], s21 offen
 buffer_load_dwordx4 v[108:111], v71, s[12:15], s21 offen
 buffer_load_dwordx4 v[112:115], v72, s[12:15], s21 offen
 buffer_load_dwordx4 v[116:119], v73, s[12:15], s21 offen
 buffer_load_dwordx4 v[120:123], v74, s[12:15], s21 offen
 buffer_load_dwordx4 v[124:127], v75, s[12:15], s21 offen
 buffer_load_dwordx4 v[128:131], v76, s[12:15], s21 offen
 buffer_load_dwordx4 v[132:135], v77, s[12:15], s21 offen
 buffer_load_dwordx4 v[136:139], v78, s[12:15], s21 offen
 s_add_u32 s21, s40, 184320
 s_mul_i32 s22, s20, 15360
 s_add_u32 s22, s22, 61440
 buffer_load_dwordx4 v[140:143], v64, s[12:15], s21 offen
 buffer_load_dwordx4 v[144:147], v65, s[12:15], s21 offen
 buffer_load_dwordx4 v[148:151], v66, s[12:15], s21 offen
 buffer_load_dwordx4 v[152:155], v67, s[12:15], s21 offen
 buffer_load_dwordx4 v[156:159], v68, s[12:15], s21 offen
 buffer_load_dwordx4 v[160:163], v69, s[12:15], s21 offen
 buffer_load_dwordx4 v[164:167], v70, s[12:15], s21 offen
 buffer_load_dwordx4 v[168:171], v71, s[12:15], s21 offen
 buffer_load_dwordx4 v[172:175], v72, s[12:15], s21 offen
 buffer_load_dwordx4 v[176:179], v73, s[12:15], s21 offen
 buffer_load_dwordx4 v[180:183], v74, s[12:15], s21 offen
 buffer_load_dwordx4 v[184:187], v75, s[12:15], s21 offen
 buffer_load_dwordx4 v[188:191], v76, s[12:15], s21 offen
 buffer_load_dwordx4 v[192:195], v77, s[12:15], s21 offen
 buffer_load_dwordx4 v[196:199], v78, s[12:15], s21 offen
 v_lshrrev_b32 v6, 2, v2
 v_lshl_add_u32 v7, v3, 3, v6
 v_mul_u32_u24 v7, 1280, v7
 v_and_b32 v8, 1, v2
 v_lshl_add_u32 v7, v8, 3, v7
 v_and_b32 v8, 1, v3
 v_lshl_add_u32 v6, v8, 2, v6
 v_lshlrev_b32 v6, 1, v6
 v_bfe_u32 v8, v2, 1, 1
 s_mul_i32 s21, s20, 20
 v_add_u32 v8, s21, v8
 v_add_u32 v5, 0, v8
 v_xor_b32 v5, v5, v6
 v_lshl_add_u32 v200, v5, 4, v7
 v_add_u32 v210, 81920, v200
 v_add_u32 v5, 2, v8
 v_xor_b32 v5, v5, v6
 v_lshl_add_u32 v201, v5, 4, v7
 v_add_u32 v211, 81920, v201
 v_add_u32 v5, 4, v8
 v_xor_b32 v5, v5, v6
 v_lshl_add_u32 v202, v5, 4, v7
 v_add_u32 v212, 81920, v202
 v_add_u32 v5, 6, v8
 v_xor_b32 v5, v5, v6
 v_lshl_add_u32 v203, v5, 4, v7
 v_add_u32 v213, 81920, v203
 v_add_u32 v5, 8, v8
 v_xor_b32 v5, v5, v6
 v_lshl_add_u32 v204, v5, 4, v7
 v_add_u32 v214, 81920, v204
 v_add_u32 v5, 10, v8
 v_xor_b32 v5, v5, v6
 v_lshl_add_u32 v205, v5, 4, v7
 v_add_u32 v215, 81920, v205
 v_add_u32 v5, 12, v8
 v_xor_b32 v5, v5, v6
 v_lshl_add_u32 v206, v5, 4, v7
 v_add_u32 v216, 81920, v206
 v_add_u32 v5, 14, v8
 v_xor_b32 v5, v5, v6
 v_lshl_add_u32 v207, v5, 4, v7
 v_add_u32 v217, 81920, v207
 v_add_u32 v5, 16, v8
 v_xor_b32 v5, v5, v6
 v_lshl_add_u32 v208, v5, 4, v7
 v_add_u32 v218, 81920, v208
 v_add_u32 v5, 18, v8
 v_xor_b32 v5, v5, v6
 v_lshl_add_u32 v209, v5, 4, v7
 v_add_u32 v219, 81920, v209
 s_mul_i32 s22, s20, 15360
 v_lshl_add_u32 v30, v1, 4, s22
 v_add_u32 v31, 61440, v30
 s_waitcnt vmcnt(30)
 s_barrier
 ds_read_b64_tr_b16 a[0:1], v200 offset:0
 ds_read_b64_tr_b16 a[2:3], v200 offset:5120
 ds_read_b64_tr_b16 a[24:25], v201 offset:0
 ds_read_b64_tr_b16 a[26:27], v201 offset:5120
 ds_read_b64_tr_b16 a[48:49], v202 offset:0
 ds_read_b64_tr_b16 a[50:51], v202 offset:5120
 ds_read_b64_tr_b16 a[72:73], v203 offset:0
 ds_read_b64_tr_b16 a[74:75], v203 offset:5120
 ds_read_b64_tr_b16 a[96:97], v204 offset:0
 ds_read_b64_tr_b16 a[98:99], v204 offset:5120
 ds_read_b64_tr_b16 a[120:121], v205 offset:0
 ds_read_b64_tr_b16 a[122:123], v205 offset:5120
 ds_read_b64_tr_b16 a[144:145], v206 offset:0
 ds_read_b64_tr_b16 a[146:147], v206 offset:5120
 ds_read_b64_tr_b16 a[168:169], v207 offset:0
 ds_read_b64_tr_b16 a[170:171], v207 offset:5120
 ds_read_b64_tr_b16 a[192:193], v208 offset:0
 ds_read_b64_tr_b16 a[194:195], v208 offset:5120
 ds_read_b64_tr_b16 a[216:217], v209 offset:0
 ds_read_b64_tr_b16 a[218:219], v209 offset:5120
 ds_read_b64_tr_b16 a[4:5], v200 offset:40960
 ds_read_b64_tr_b16 a[6:7], v200 offset:46080
 ds_read_b64_tr_b16 a[28:29], v201 offset:40960
 ds_read_b64_tr_b16 a[30:31], v201 offset:46080
 ds_read_b64_tr_b16 a[52:53], v202 offset:40960
 ds_read_b64_tr_b16 a[54:55], v202 offset:46080
 ds_read_b64_tr_b16 a[76:77], v203 offset:40960
 ds_read_b64_tr_b16 a[78:79], v203 offset:46080
 ds_read_b64_tr_b16 a[100:101], v204 offset:40960
 ds_read_b64_tr_b16 a[102:103], v204 offset:46080
 ds_read_b64_tr_b16 a[124:125], v205 offset:40960
 ds_read_b64_tr_b16 a[126:127], v205 offset:46080
 ds_read_b64_tr_b16 a[148:149], v206 offset:40960
 ds_read_b64_tr_b16 a[150:151], v206 offset:46080
 ds_read_b64_tr_b16 a[172:173], v207 offset:40960
 ds_read_b64_tr_b16 a[174:175], v207 offset:46080
 ds_read_b64_tr_b16 a[196:197], v208 offset:40960
 ds_read_b64_tr_b16 a[198:199], v208 offset:46080
 ds_read_b64_tr_b16 a[220:221], v209 offset:40960
 ds_read_b64_tr_b16 a[222:223], v209 offset:46080
 ds_read_b64_tr_b16 a[8:9], v210 offset:0
 ds_read_b64_tr_b16 a[10:11], v210 offset:5120
 ds_read_b64_tr_b16 a[32:33], v211 offset:0
 ds_read_b64_tr_b16 a[34:35], v211 offset:5120
 ds_read_b64_tr_b16 a[56:57], v212 offset:0
 ds_read_b64_tr_b16 a[58:59], v212 offset:5120
 ds_read_b64_tr_b16 a[80:81], v213 offset:0
 ds_read_b64_tr_b16 a[82:83], v213 offset:5120
 ds_read_b64_tr_b16 a[104:105], v214 offset:0
 ds_read_b64_tr_b16 a[106:107], v214 offset:5120
 ds_read_b64_tr_b16 a[128:129], v215 offset:0
 ds_read_b64_tr_b16 a[130:131], v215 offset:5120
 ds_read_b64_tr_b16 a[152:153], v216 offset:0
 ds_read_b64_tr_b16 a[154:155], v216 offset:5120
 ds_read_b64_tr_b16 a[176:177], v217 offset:0
 ds_read_b64_tr_b16 a[178:179], v217 offset:5120
 ds_read_b64_tr_b16 a[200:201], v218 offset:0
 ds_read_b64_tr_b16 a[202:203], v218 offset:5120
 ds_read_b64_tr_b16 a[224:225], v219 offset:0
 ds_read_b64_tr_b16 a[226:227], v219 offset:5120
 s_waitcnt lgkmcnt(0)
 s_barrier
 s_waitcnt vmcnt(15)
 ds_write_b128 v30, v[80:83] offset:0
 ds_write_b128 v30, v[84:87] offset:1024
 ds_write_b128 v30, v[88:91] offset:2048
 ds_write_b128 v30, v[92:95] offset:3072
 ds_write_b128 v30, v[96:99] offset:4096
 ds_write_b128 v30, v[100:103] offset:5120
 ds_write_b128 v30, v[104:107] offset:6144
 ds_write_b128 v30, v[108:111] offset:7168
 ds_write_b128 v30, v[112:115] offset:8192
 ds_write_b128 v30, v[116:119] offset:9216
 ds_write_b128 v30, v[120:123] offset:10240
 ds_write_b128 v30, v[124:127] offset:11264
 ds_write_b128 v30, v[128:131] offset:12288
 ds_write_b128 v30, v[132:135] offset:13312
 ds_write_b128 v30, v[136:139] offset:14336
 s_waitcnt vmcnt(0)
 ds_write_b128 v31, v[140:143] offset:0
 ds_write_b128 v31, v[144:147] offset:1024
 ds_write_b128 v31, v[148:151] offset:2048
 ds_write_b128 v31, v[152:155] offset:3072
 ds_write_b128 v31, v[156:159] offset:4096
 ds_write_b128 v31, v[160:163] offset:5120
 ds_write_b128 v31, v[164:167] offset:6144
 ds_write_b128 v31, v[168:171] offset:7168
 ds_write_b128 v31, v[172:175] offset:8192
 ds_write_b128 v31, v[176:179] offset:9216
 ds_write_b128 v31, v[180:183] offset:10240
 ds_write_b128 v31, v[184:187] offset:11264
 ds_write_b128 v31, v[188:191] offset:12288
 ds_write_b128 v31, v[192:195] offset:13312
 ds_write_b128 v31, v[196:199] offset:14336
 s_waitcnt lgkmcnt(0)
 s_barrier
 ds_read_b64_tr_b16 a[12:13], v200 offset:0
 ds_read_b64_tr_b16 a[14:15], v200 offset:5120
 ds_read_b64_tr_b16 a[36:37], v201 offset:0
 ds_read_b64_tr_b16 a[38:39], v201 offset:5120
 ds_read_b64_tr_b16 a[60:61], v202 offset:0
 ds_read_b64_tr_b16 a[62:63], v202 offset:5120
 ds_read_b64_tr_b16 a[84:85], v203 offset:0
 ds_read_b64_tr_b16 a[86:87], v203 offset:5120
 ds_read_b64_tr_b16 a[108:109], v204 offset:0
 ds_read_b64_tr_b16 a[110:111], v204 offset:5120
 ds_read_b64_tr_b16 a[132:133], v205 offset:0
 ds_read_b64_tr_b16 a[134:135], v205 offset:5120
 ds_read_b64_tr_b16 a[156:157], v206 offset:0
 ds_read_b64_tr_b16 a[158:159], v206 offset:5120
 ds_read_b64_tr_b16 a[180:181], v207 offset:0
 ds_read_b64_tr_b16 a[182:183], v207 offset:5120
 ds_read_b64_tr_b16 a[204:205], v208 offset:0
 ds_read_b64_tr_b16 a[206:207], v208 offset:5120
 ds_read_b64_tr_b16 a[228:229], v209 offset:0
 ds_read_b64_tr_b16 a[230:231], v209 offset:5120
 ds_read_b64_tr_b16 a[16:17], v200 offset:40960
 ds_read_b64_tr_b16 a[18:19], v200 offset:46080
 ds_read_b64_tr_b16 a[40:41], v201 offset:40960
 ds_read_b64_tr_b16 a[42:43], v201 offset:46080
 ds_read_b64_tr_b16 a[64:65], v202 offset:40960
 ds_read_b64_tr_b16 a[66:67], v202 offset:46080
 ds_read_b64_tr_b16 a[88:89], v203 offset:40960
 ds_read_b64_tr_b16 a[90:91], v203 offset:46080
 ds_read_b64_tr_b16 a[112:113], v204 offset:40960
 ds_read_b64_tr_b16 a[114:115], v204 offset:46080
 ds_read_b64_tr_b16 a[136:137], v205 offset:40960
 ds_read_b64_tr_b16 a[138:139], v205 offset:46080
 ds_read_b64_tr_b16 a[160:161], v206 offset:40960
 ds_read_b64_tr_b16 a[162:163], v206 offset:46080
 ds_read_b64_tr_b16 a[184:185], v207 offset:40960
 ds_read_b64_tr_b16 a[186:187], v207 offset:46080
 ds_read_b64_tr_b16 a[208:209], v208 offset:40960
 ds_read_b64_tr_b16 a[210:211], v208 offset:46080
 ds_read_b64_tr_b16 a[232:233], v209 offset:40960
 ds_read_b64_tr_b16 a[234:235], v209 offset:46080
 ds_read_b64_tr_b16 a[20:21], v210 offset:0
 ds_read_b64_tr_b16 a[22:23], v210 offset:5120
 ds_read_b64_tr_b16 a[44:45], v211 offset:0
 ds_read_b64_tr_b16 a[46:47], v211 offset:5120
 ds_read_b64_tr_b16 a[68:69], v212 offset:0
 ds_read_b64_tr_b16 a[70:71], v212 offset:5120
 ds_read_b64_tr_b16 a[92:93], v213 offset:0
 ds_read_b64_tr_b16 a[94:95], v213 offset:5120
 ds_read_b64_tr_b16 a[116:117], v214 offset:0
 ds_read_b64_tr_b16 a[118:119], v214 offset:5120
 ds_read_b64_tr_b16 a[140:141], v215 offset:0
 ds_read_b64_tr_b16 a[142:143], v215 offset:5120
 ds_read_b64_tr_b16 a[164:165], v216 offset:0
 ds_read_b64_tr_b16 a[166:167], v216 offset:5120
 ds_read_b64_tr_b16 a[188:189], v217 offset:0
 ds_read_b64_tr_b16 a[190:191], v217 offset:5120
 ds_read_b64_tr_b16 a[212:213], v218 offset:0
 ds_read_b64_tr_b16 a[214:215], v218 offset:5120
 ds_read_b64_tr_b16 a[236:237], v219 offset:0
 ds_read_b64_tr_b16 a[238:239], v219 offset:5120
 s_waitcnt lgkmcnt(0)
 s_barrier
 s_load_dwordx2 s[32:33], s[0:1], 96
 s_waitcnt lgkmcnt(0)
 s_mov_b32 s32, s32
 s_mov_b32 s33, s33
 s_mov_b32 s34, 256
 s_mov_b32 s35, 0x00020000
 s_mov_b32 s21, 76
 s_cmp_lg_u32 s20, 0
 s_cbranch_scc1 wf_140
 v_mov_b32 v4, 0
 s_mov_b32 s101, 0
wf_139:
 buffer_load_dword v5, v4, s[32:35], s21 offen sc1
 s_add_u32 s101, s101, 1
 s_cmp_gt_u32 s101, 131072
 s_cbranch_scc1 main_end
 s_waitcnt vmcnt(0)
 v_readfirstlane_b32 s100, v5
 s_cmp_ge_u32 s100, 32
 s_cbranch_scc1 wf_140
 s_sleep 8
 s_branch wf_139
wf_140:
 s_barrier
 s_mov_b32 s21, 84
 v_mov_b32 v4, 0
 s_mov_b32 s101, 0
wf_141:
 buffer_load_dword v5, v4, s[32:35], s21 offen sc1
 s_add_u32 s101, s101, 1
 s_cmp_gt_u32 s101, 131072
 s_cbranch_scc1 main_end
 s_waitcnt vmcnt(0)
 v_readfirstlane_b32 s100, v5
 s_cmp_ge_u32 s100, 1
 s_cbranch_scc1 wf_142
 s_sleep 8
 s_branch wf_141
wf_142:
 s_add_u32 s37, s38, 83886079
 s_add_u32 s21, s38, 180355072
 s_xor_b32 s37, s37, s21
 s_lshr_b32 s37, s37, 21
 s_xor_b32 s37, s37, s100
 s_xor_b32 s37, s37, 0
 s_and_b32 s37, s37, 1
 s_lshl_b32 s37, s37, 13
 s_mul_i32 s41, s2, 12288
 s_add_u32 s47, s41, 25165824
 s_mov_b32 s41, s47
 s_mul_i32 s21, s20, 10
 s_mul_i32 s47, s2, 5
 s_lshr_b32 s22, s21, 3
 s_add_u32 s47, s47, s22
 s_and_b32 s48, s21, 7
 s_mov_b32 s66, 0
 s_mov_b32 s67, 0
 s_lshr_b32 s43, s2, 2
 s_lshl_b32 s43, s43, 7
 s_add_u32 s43, s43, 0
 s_lshl_b32 s44, s2, 7
 s_lshl_b32 s21, s20, 12
 s_add_u32 s44, s44, s21
 s_add_u32 s44, s44, 95232
 s_mov_b32 s45, 0
 s_mov_b32 s49, 1
 s_mov_b32 s50, 0
 v_mov_b32 v10, 0
 v_mov_b32 v11, 1
 v_lshlrev_b32 v4, 4, v1
 s_add_u32 s76, s38, 56623104
 s_addc_u32 s77, s39, 0
 s_mov_b32 s78, 6291456
 s_mov_b32 s79, 0x00020000
 s_add_u32 s80, s38, 101711872
 s_addc_u32 s81, s39, 0
 s_mov_b32 s82, 20971520
 s_mov_b32 s83, 0x00020000
 v_and_b32 v12, 3, v1
 v_lshlrev_b32 v12, 3, v12
 v_add_u32 v12, 4, v12
 v_and_b32 v13, 7, v2
 v_lshlrev_b32 v13, 4, v13
 v_lshl_add_u32 v13, v3, 7, v13
 v_lshrrev_b32 v14, 3, v2
 v_mul_u32_u24 v14, 98304, v14
 v_add_u32 v14, v14, v13
 v_and_b32 v15, 1, v3
 v_lshlrev_b32 v15, 8, v15
 v_lshl_add_u32 v15, v2, 4, v15
 v_lshrrev_b32 v16, 1, v3
 v_mul_u32_u24 v16, 327680, v16
 v_add_u32 v15, v15, v16
 v_lshlrev_b32 v17, 10, v1
 v_mov_b32 v19, 0
 s_lshl_b32 s53, s2, 7
 s_add_u32 s53, s53, 19456
 s_mov_b32 s55, 0
 s_mov_b32 s56, 0
 s_mov_b32 s58, 0
 s_mov_b32 s59, 0
 s_add_u32 s84, s38, 50331648
 s_addc_u32 s85, s39, 0
 s_mov_b32 s86, 12582912
 s_mov_b32 s87, 0x00020000
 s_and_b32 s21, s2, 3
 s_mul_i32 s51, s2, 3072
 s_cmp_eq_u32 s21, s20
 s_cselect_b32 s51, s51, 6291456
 v_mov_b32 v244, -1
 v_mov_b32 v245, -1
 v_mov_b32 v246, -1
 v_mov_b32 v247, -1
 s_add_u32 s88, s38, 180355072
 s_addc_u32 s89, s39, 0
 s_mov_b32 s90, 67108864
 s_mov_b32 s91, 0x00020000
 s_mul_i32 s21, s20, 3072
 s_add_u32 s41, s41, s21
 s_mov_b32 s64, s21
 s_add_u32 s67, s21, 98304
 s_mov_b32 s71, s21
 s_mov_b32 s46, 0
 s_mov_b32 s47, 0
 s_mov_b32 s65, 0
 s_mul_i32 s42, s2, 40960
 s_mul_i32 s21, s20, 10240
 s_add_u32 s42, s42, s21
 s_mov_b32 s68, 0x80000000
 s_mov_b32 s70, 0
 s_mov_b32 s40, 0
 s_mov_b32 s31, 0
 s_mov_b32 s56, s68
 s_mov_b32 s57, s68
 s_lshl_b32 s59, s20, 1
 s_sub_u32 s59, 8, s59
 s_add_u32 s61, s28, 9216
 v_min_u32 v5, 18, v1
 v_lshlrev_b32 v5, 10, v5
 v_mov_b32 v9, 0
 s_lshl_b32 s21, s20, 2
 s_add_u32 s21, s21, 110592
 v_mov_b32 v6, s21
 v_mov_b32 v7, 110592
 s_mul_i32 s51, s2, 3072
 s_lshl_b32 s21, s20, 10
 s_add_u32 s51, s51, s21
 s_cmp_lt_u32 s20, 3
 s_cselect_b32 s51, s51, 6291456
 s_add_u32 s51, s51, 5111808
 s_cmp_lg_u32 s20, 0
 s_cbranch_scc1 wf_144
 v_mov_b32 v20, 0
 s_mov_b32 s101, 0
wf_143:
 buffer_load_dword v21, v20, s[72:75], s43 offen sc1
 s_add_u32 s101, s101, 1
 s_cmp_gt_u32 s101, 131072
 s_cbranch_scc1 main_end
 s_waitcnt vmcnt(0)
 v_readfirstlane_b32 s100, v21
 s_cmp_ge_u32 s100, 8
 s_cbranch_scc1 wf_144
 s_sleep 4
 s_branch wf_143
wf_144:
 s_barrier
 v_writelane_b32 v9, 8, 0
 v_cmp_gt_u32 vcc, 8, v9
 s_nop 0
 s_bitset1_b64 vcc, 19
 s_ff1_i32_b64 s21, vcc
 s_lshl_b32 s22, s21, 1
 s_lshl_b32 s21, s21, 2
 s_sub_i32 s21, s21, 12
 s_max_i32 s47, s21, s22
 s_cmp_gt_u32 s47, s45
 s_cbranch_scc1 va_145
 s_mov_b32 s101, 0
 s_branch va_148
va_146:
 s_sleep 8
va_148:
 buffer_load_dword v9, v5, s[72:75], s43 offen sc1
 s_add_u32 s101, s101, 1
 s_cmp_gt_u32 s101, 131072
 s_cbranch_scc1 main_end
 s_waitcnt vmcnt(0)
 v_cmp_gt_u32 vcc, 8, v9
 s_nop 0
 s_bitset1_b64 vcc, 19
 s_ff1_i32_b64 s21, vcc
 s_lshl_b32 s22, s21, 1
 s_lshl_b32 s21, s21, 2
 s_sub_i32 s21, s21, 12
 s_max_i32 s47, s21, s22
 s_cmp_gt_u32 s47, s45
 s_cbranch_scc0 va_146
va_145:
 s_add_u32 s22, s45, 6
 s_min_u32 s22, s22, s47
va_147:
 s_cmp_ge_u32 s46, s22
 s_cbranch_scc1 va_149
 s_mov_b32 m0, s64
 s_mov_b32 s66, s41
 buffer_load_dwordx4 v4, s[16:19], s66 offen offset:0 sc1 lds
 buffer_load_dwordx4 v4, s[16:19], s66 offen offset:1024 sc1 lds
 buffer_load_dwordx4 v4, s[16:19], s66 offen offset:2048 sc1 lds
 s_add_u32 s46, s46, 1
 s_add_u32 s41, s41, 393216
 s_add_u32 s64, s64, 12288
 s_cmp_lt_u32 s64, s67
 s_cselect_b32 s64, s64, s71
 s_branch va_147
va_149:
 s_mov_b32 s48, s46
 s_mov_b32 s49, s46
 s_mov_b32 s50, s46
 s_waitcnt vmcnt(0)
 s_barrier
 v_mov_b32 v8, v4
 s_add_u32 s65, s65, 12288
 s_cmp_lt_u32 s65, 98304
 s_cselect_b32 s65, s65, 0
 ds_read_b128 v[144:147], v8 offset:0
 ds_read_b128 v[148:151], v8 offset:1024
 ds_read_b128 v[152:155], v8 offset:2048
 ds_read_b128 v[156:159], v8 offset:3072
 ds_read_b128 v[160:163], v8 offset:4096
 ds_read_b128 v[164:167], v8 offset:5120
 ds_read_b128 v[168:171], v8 offset:6144
 ds_read_b128 v[172:175], v8 offset:7168
 ds_read_b128 v[176:179], v8 offset:8192
 ds_read_b128 v[180:183], v8 offset:9216
 ds_read_b128 v[184:187], v8 offset:10240
 ds_read_b128 v[188:191], v8 offset:11264
vwl_150:
 s_waitcnt lgkmcnt(0)
 v_mfma_f32_16x16x32_bf16 v[64:67], v[144:147], a[0:3], 0
 v_cmp_gt_u32 vcc, 8, v9
 s_nop 0
 v_mfma_f32_16x16x32_bf16 v[72:75], v[144:147], a[24:27], 0
 s_bitset1_b64 vcc, 19
 s_ff1_i32_b64 s21, vcc
 v_mfma_f32_16x16x32_bf16 v[80:83], v[144:147], a[48:51], 0
 s_lshl_b32 s22, s21, 1
 s_lshl_b32 s21, s21, 2
 v_mfma_f32_16x16x32_bf16 v[88:91], v[144:147], a[72:75], 0
 s_sub_i32 s21, s21, 12
 s_max_i32 s47, s21, s22
 v_mfma_f32_16x16x32_bf16 v[96:99], v[144:147], a[96:99], 0
 s_add_u32 s22, s45, 7
 s_min_u32 s22, s22, s47
 v_mfma_f32_16x16x32_bf16 v[68:71], v[168:171], a[0:3], 0
 s_cmp_lt_u32 s46, s22
 s_cselect_b32 s66, s41, 0x80000000
 s_cselect_b32 m0, s64, 98304
 s_cselect_b32 s22, 1, 0
 v_mfma_f32_16x16x32_bf16 v[76:79], v[168:171], a[24:27], 0
 buffer_load_dwordx4 v4, s[16:19], s66 offen offset:0 sc1 lds
 v_mfma_f32_16x16x32_bf16 v[84:87], v[168:171], a[48:51], 0
 v_add_u32 v8, s65, v4
 s_add_u32 s65, s65, 12288
 v_mfma_f32_16x16x32_bf16 v[92:95], v[168:171], a[72:75], 0
 buffer_load_dwordx4 v4, s[16:19], s66 offen offset:1024 sc1 lds
 v_mfma_f32_16x16x32_bf16 v[100:103], v[168:171], a[96:99], 0
 s_cmp_lt_u32 s65, 98304
 s_cselect_b32 s65, s65, 0
 v_mfma_f32_16x16x32_bf16 v[64:67], v[148:151], a[4:7], v[64:67]
 buffer_load_dwordx4 v4, s[16:19], s66 offen offset:2048 sc1 lds
 v_mfma_f32_16x16x32_bf16 v[72:75], v[148:151], a[28:31], v[72:75]
 s_add_u32 s46, s46, s22
 s_mul_i32 s21, s22, 393216
 v_mfma_f32_16x16x32_bf16 v[80:83], v[148:151], a[52:55], v[80:83]
 s_add_u32 s41, s41, s21
 s_mul_i32 s21, s22, 12288
 v_mfma_f32_16x16x32_bf16 v[88:91], v[148:151], a[76:79], v[88:91]
 s_add_u32 s64, s64, s21
 v_cvt_pk_bf16_f32 v44, v104, v105
 v_mfma_f32_16x16x32_bf16 v[96:99], v[148:151], a[100:103], v[96:99]
 s_cmp_lt_u32 s64, s67
 s_cselect_b32 s64, s64, s71
 v_mfma_f32_16x16x32_bf16 v[68:71], v[172:175], a[4:7], v[68:71]
 v_cvt_pk_bf16_f32 v45, v106, v107
 v_cvt_pk_bf16_f32 v46, v108, v109
 v_mfma_f32_16x16x32_bf16 v[76:79], v[172:175], a[28:31], v[76:79]
 v_cvt_pk_bf16_f32 v47, v110, v111
 v_mfma_f32_16x16x32_bf16 v[84:87], v[172:175], a[52:55], v[84:87]
 s_add_u32 s69, s68, 4096
 v_mfma_f32_16x16x32_bf16 v[92:95], v[172:175], a[76:79], v[92:95]
 v_mfma_f32_16x16x32_bf16 v[100:103], v[172:175], a[100:103], v[100:103]
 buffer_store_dwordx4 v[44:47], v4, s[24:27], s69 offen offset:1024 sc1
 v_mfma_f32_16x16x32_bf16 v[64:67], v[152:155], a[8:11], v[64:67]
 v_mfma_f32_16x16x32_bf16 v[72:75], v[152:155], a[32:35], v[72:75]
 v_cvt_pk_bf16_f32 v48, v112, v113
 v_mfma_f32_16x16x32_bf16 v[80:83], v[152:155], a[56:59], v[80:83]
 v_cvt_pk_bf16_f32 v49, v114, v115
 v_mfma_f32_16x16x32_bf16 v[88:91], v[152:155], a[80:83], v[88:91]
 v_mfma_f32_16x16x32_bf16 v[96:99], v[152:155], a[104:107], v[96:99]
 v_cvt_pk_bf16_f32 v50, v116, v117
 v_mfma_f32_16x16x32_bf16 v[68:71], v[176:179], a[8:11], v[68:71]
 v_mfma_f32_16x16x32_bf16 v[76:79], v[176:179], a[32:35], v[76:79]
 v_cvt_pk_bf16_f32 v51, v118, v119
 v_mfma_f32_16x16x32_bf16 v[84:87], v[176:179], a[56:59], v[84:87]
 buffer_store_dwordx4 v[48:51], v4, s[24:27], s69 offen offset:2048 sc1
 v_mfma_f32_16x16x32_bf16 v[92:95], v[176:179], a[80:83], v[92:95]
 v_mfma_f32_16x16x32_bf16 v[100:103], v[176:179], a[104:107], v[100:103]
 v_cvt_pk_bf16_f32 v52, v120, v121
 v_mfma_f32_16x16x32_bf16 v[64:67], v[156:159], a[12:15], v[64:67]
 v_mfma_f32_16x16x32_bf16 v[72:75], v[156:159], a[36:39], v[72:75]
 v_cvt_pk_bf16_f32 v53, v122, v123
 v_mfma_f32_16x16x32_bf16 v[80:83], v[156:159], a[60:63], v[80:83]
 v_cvt_pk_bf16_f32 v54, v124, v125
 v_mfma_f32_16x16x32_bf16 v[88:91], v[156:159], a[84:87], v[88:91]
 v_mfma_f32_16x16x32_bf16 v[96:99], v[156:159], a[108:111], v[96:99]
 v_cvt_pk_bf16_f32 v55, v126, v127
 v_mfma_f32_16x16x32_bf16 v[68:71], v[180:183], a[12:15], v[68:71]
 v_mfma_f32_16x16x32_bf16 v[76:79], v[180:183], a[36:39], v[76:79]
 buffer_store_dwordx4 v[52:55], v4, s[24:27], s69 offen offset:3072 sc1
 v_mfma_f32_16x16x32_bf16 v[84:87], v[180:183], a[60:63], v[84:87]
 v_cvt_pk_bf16_f32 v56, v128, v129
 v_mfma_f32_16x16x32_bf16 v[92:95], v[180:183], a[84:87], v[92:95]
 v_mfma_f32_16x16x32_bf16 v[100:103], v[180:183], a[108:111], v[100:103]
 v_cvt_pk_bf16_f32 v57, v130, v131
 v_mfma_f32_16x16x32_bf16 v[64:67], v[160:163], a[16:19], v[64:67]
 v_mfma_f32_16x16x32_bf16 v[72:75], v[160:163], a[40:43], v[72:75]
 v_cvt_pk_bf16_f32 v58, v132, v133
 v_mfma_f32_16x16x32_bf16 v[80:83], v[160:163], a[64:67], v[80:83]
 v_cvt_pk_bf16_f32 v59, v134, v135
 v_mfma_f32_16x16x32_bf16 v[88:91], v[160:163], a[88:91], v[88:91]
 v_mfma_f32_16x16x32_bf16 v[96:99], v[160:163], a[112:115], v[96:99]
 s_add_u32 s69, s68, 8192
 v_mfma_f32_16x16x32_bf16 v[68:71], v[184:187], a[16:19], v[68:71]
 v_mfma_f32_16x16x32_bf16 v[76:79], v[184:187], a[40:43], v[76:79]
 buffer_store_dwordx4 v[56:59], v4, s[24:27], s69 offen offset:0 sc1
 v_mfma_f32_16x16x32_bf16 v[84:87], v[184:187], a[64:67], v[84:87]
 v_cvt_pk_bf16_f32 v60, v136, v137
 v_mfma_f32_16x16x32_bf16 v[92:95], v[184:187], a[88:91], v[92:95]
 v_mfma_f32_16x16x32_bf16 v[100:103], v[184:187], a[112:115], v[100:103]
 v_cvt_pk_bf16_f32 v61, v138, v139
 v_mfma_f32_16x16x32_bf16 v[64:67], v[164:167], a[20:23], v[64:67]
 v_mfma_f32_16x16x32_bf16 v[72:75], v[164:167], a[44:47], v[72:75]
 v_cvt_pk_bf16_f32 v62, v140, v141
 v_mfma_f32_16x16x32_bf16 v[80:83], v[164:167], a[68:71], v[80:83]
 v_cvt_pk_bf16_f32 v63, v142, v143
 v_mfma_f32_16x16x32_bf16 v[88:91], v[164:167], a[92:95], v[88:91]
 v_mfma_f32_16x16x32_bf16 v[96:99], v[164:167], a[116:119], v[96:99]
 buffer_store_dwordx4 v[60:63], v4, s[24:27], s69 offen offset:1024 sc1
 v_mfma_f32_16x16x32_bf16 v[68:71], v[188:191], a[20:23], v[68:71]
 v_mfma_f32_16x16x32_bf16 v[76:79], v[188:191], a[44:47], v[76:79]
 v_mfma_f32_16x16x32_bf16 v[84:87], v[188:191], a[68:71], v[84:87]
 v_mfma_f32_16x16x32_bf16 v[92:95], v[188:191], a[92:95], v[92:95]
 v_mfma_f32_16x16x32_bf16 v[100:103], v[188:191], a[116:119], v[100:103]
 v_mfma_f32_16x16x32_bf16 v[104:107], v[144:147], a[120:123], 0
 buffer_load_dword v9, v5, s[72:75], s43 offen sc1
 v_mfma_f32_16x16x32_bf16 v[112:115], v[144:147], a[144:147], 0
 v_mfma_f32_16x16x32_bf16 v[120:123], v[144:147], a[168:171], 0
 v_mfma_f32_16x16x32_bf16 v[128:131], v[144:147], a[192:195], 0
 v_cvt_pk_bf16_f32 v24, v64, v65
 v_mfma_f32_16x16x32_bf16 v[136:139], v[144:147], a[216:219], 0
 s_add_u32 s63, s45, 1
 s_min_u32 s63, s63, 63
 v_mfma_f32_16x16x32_bf16 v[108:111], v[168:171], a[120:123], 0
 s_cmp_lt_u32 s63, s46
 s_cselect_b32 s53, 1, 0
 v_mfma_f32_16x16x32_bf16 v[116:119], v[168:171], a[144:147], 0
 v_mov_b32 v21, s53
 ds_write_b32 v6, v21 offset:0
 v_mfma_f32_16x16x32_bf16 v[124:127], v[168:171], a[168:171], 0
 v_cvt_pk_bf16_f32 v25, v66, v67
 v_cvt_pk_bf16_f32 v26, v68, v69
 v_mfma_f32_16x16x32_bf16 v[132:135], v[168:171], a[192:195], 0
 v_cvt_pk_bf16_f32 v27, v70, v71
 v_mfma_f32_16x16x32_bf16 v[140:143], v[168:171], a[216:219], 0
 v_mfma_f32_16x16x32_bf16 v[104:107], v[148:151], a[124:127], v[104:107]
 buffer_store_dwordx4 v[24:27], v4, s[24:27], s42 offen offset:0 sc1
 v_mfma_f32_16x16x32_bf16 v[112:115], v[148:151], a[148:151], v[112:115]
 v_cvt_pk_bf16_f32 v28, v72, v73
 v_mfma_f32_16x16x32_bf16 v[120:123], v[148:151], a[172:175], v[120:123]
 s_cmp_eq_u32 s40, 3
 s_cbranch_scc1 vwm_154
vwm_155:
 v_mfma_f32_16x16x32_bf16 v[128:131], v[148:151], a[196:199], v[128:131]
 v_cvt_pk_bf16_f32 v29, v74, v75
 v_mfma_f32_16x16x32_bf16 v[136:139], v[148:151], a[220:223], v[136:139]
 v_mfma_f32_16x16x32_bf16 v[108:111], v[172:175], a[124:127], v[108:111]
 v_cvt_pk_bf16_f32 v30, v76, v77
 v_mfma_f32_16x16x32_bf16 v[116:119], v[172:175], a[148:151], v[116:119]
 v_mfma_f32_16x16x32_bf16 v[124:127], v[172:175], a[172:175], v[124:127]
 v_cvt_pk_bf16_f32 v31, v78, v79
 v_mfma_f32_16x16x32_bf16 v[132:135], v[172:175], a[196:199], v[132:135]
 buffer_store_dwordx4 v[28:31], v4, s[24:27], s42 offen offset:1024 sc1
 v_mfma_f32_16x16x32_bf16 v[140:143], v[172:175], a[220:223], v[140:143]
 s_cmp_lt_u32 s63, s50
 s_cbranch_scc0 vwx_152
vwx_153:
 v_mfma_f32_16x16x32_bf16 v[104:107], v[152:155], a[128:131], v[104:107]
 s_waitcnt lgkmcnt(0)
 s_barrier
 v_mfma_f32_16x16x32_bf16 v[112:115], v[152:155], a[152:155], v[112:115]
 ds_read_b128 v[240:243], v7 offset:0
 v_cvt_pk_bf16_f32 v32, v80, v81
 v_mfma_f32_16x16x32_bf16 v[120:123], v[152:155], a[176:179], v[120:123]
 ds_read_b128 v[192:195], v8 offset:0
 v_cvt_pk_bf16_f32 v33, v82, v83
 v_mfma_f32_16x16x32_bf16 v[128:131], v[152:155], a[200:203], v[128:131]
 v_mfma_f32_16x16x32_bf16 v[136:139], v[152:155], a[224:227], v[136:139]
 ds_read_b128 v[196:199], v8 offset:1024
 v_cvt_pk_bf16_f32 v34, v84, v85
 v_mfma_f32_16x16x32_bf16 v[108:111], v[176:179], a[128:131], v[108:111]
 v_mfma_f32_16x16x32_bf16 v[116:119], v[176:179], a[152:155], v[116:119]
 v_cvt_pk_bf16_f32 v35, v86, v87
 v_mfma_f32_16x16x32_bf16 v[124:127], v[176:179], a[176:179], v[124:127]
 ds_read_b128 v[200:203], v8 offset:2048
 v_mfma_f32_16x16x32_bf16 v[132:135], v[176:179], a[200:203], v[132:135]
 buffer_store_dwordx4 v[32:35], v4, s[24:27], s42 offen offset:2048 sc1
 v_mfma_f32_16x16x32_bf16 v[140:143], v[176:179], a[224:227], v[140:143]
 ds_read_b128 v[204:207], v8 offset:3072
 v_cvt_pk_bf16_f32 v36, v88, v89
 v_mfma_f32_16x16x32_bf16 v[104:107], v[156:159], a[132:135], v[104:107]
 v_mfma_f32_16x16x32_bf16 v[112:115], v[156:159], a[156:159], v[112:115]
 v_cvt_pk_bf16_f32 v37, v90, v91
 v_mfma_f32_16x16x32_bf16 v[120:123], v[156:159], a[180:183], v[120:123]
 ds_read_b128 v[208:211], v8 offset:4096
 v_mfma_f32_16x16x32_bf16 v[128:131], v[156:159], a[204:207], v[128:131]
 v_cvt_pk_bf16_f32 v38, v92, v93
 v_mfma_f32_16x16x32_bf16 v[136:139], v[156:159], a[228:231], v[136:139]
 ds_read_b128 v[212:215], v8 offset:5120
 s_waitcnt lgkmcnt(4)
 v_mfma_f32_16x16x32_bf16 v[108:111], v[180:183], a[132:135], v[108:111]
 v_bitop3_b32 v240, v240, v241, v242 bitop3:0x80
 v_and_b32 v240, v240, v243
 v_mfma_f32_16x16x32_bf16 v[116:119], v[180:183], a[156:159], v[116:119]
 s_nop 0
 v_readfirstlane_b32 s23, v240
 v_mfma_f32_16x16x32_bf16 v[124:127], v[180:183], a[180:183], v[124:127]
 ds_read_b128 v[216:219], v8 offset:6144
 v_cvt_pk_bf16_f32 v39, v94, v95
 v_mfma_f32_16x16x32_bf16 v[132:135], v[180:183], a[204:207], v[132:135]
 buffer_store_dwordx4 v[36:39], v4, s[24:27], s42 offen offset:3072 sc1
 v_mfma_f32_16x16x32_bf16 v[140:143], v[180:183], a[228:231], v[140:143]
 ds_read_b128 v[220:223], v8 offset:7168
 v_cvt_pk_bf16_f32 v40, v96, v97
 v_mfma_f32_16x16x32_bf16 v[104:107], v[160:163], a[136:139], v[104:107]
 v_cvt_pk_bf16_f32 v41, v98, v99
 v_mfma_f32_16x16x32_bf16 v[112:115], v[160:163], a[160:163], v[112:115]
 v_cvt_pk_bf16_f32 v42, v100, v101
 v_mfma_f32_16x16x32_bf16 v[120:123], v[160:163], a[184:187], v[120:123]
 ds_read_b128 v[224:227], v8 offset:8192
 v_mfma_f32_16x16x32_bf16 v[128:131], v[160:163], a[208:211], v[128:131]
 v_cvt_pk_bf16_f32 v43, v102, v103
 v_mfma_f32_16x16x32_bf16 v[136:139], v[160:163], a[232:235], v[136:139]
 ds_read_b128 v[228:231], v8 offset:9216
 v_mfma_f32_16x16x32_bf16 v[108:111], v[184:187], a[136:139], v[108:111]
 s_add_u32 s69, s42, 4096
 v_mfma_f32_16x16x32_bf16 v[116:119], v[184:187], a[160:163], v[116:119]
 v_mfma_f32_16x16x32_bf16 v[124:127], v[184:187], a[184:187], v[124:127]
 ds_read_b128 v[232:235], v8 offset:10240
 v_mfma_f32_16x16x32_bf16 v[132:135], v[184:187], a[208:211], v[132:135]
 buffer_store_dwordx4 v[40:43], v4, s[24:27], s69 offen offset:0 sc1
 v_mfma_f32_16x16x32_bf16 v[140:143], v[184:187], a[232:235], v[140:143]
 ds_read_b128 v[236:239], v8 offset:11264
 v_mfma_f32_16x16x32_bf16 v[104:107], v[164:167], a[140:143], v[104:107]
 v_mfma_f32_16x16x32_bf16 v[112:115], v[164:167], a[164:167], v[112:115]
 v_mfma_f32_16x16x32_bf16 v[120:123], v[164:167], a[188:191], v[120:123]
 s_waitcnt vmcnt(11)
 s_mov_b32 s50, s46
 s_add_u32 s69, s45, s40
 v_mfma_f32_16x16x32_bf16 v[128:131], v[164:167], a[212:215], v[128:131]
 s_mov_b32 s40, 0
 s_sub_i32 s69, s69, 1
 s_max_i32 s69, s69, s70
 v_mfma_f32_16x16x32_bf16 v[136:139], v[164:167], a[236:239], v[136:139]
 s_add_u32 s45, s45, 1
 s_mov_b32 s68, s42
 s_add_u32 s42, s42, 1310720
 v_mfma_f32_16x16x32_bf16 v[108:111], v[188:191], a[140:143], v[108:111]
 v_mfma_f32_16x16x32_bf16 v[116:119], v[188:191], a[164:167], v[116:119]
 v_mfma_f32_16x16x32_bf16 v[124:127], v[188:191], a[188:191], v[124:127]
 v_mfma_f32_16x16x32_bf16 v[132:135], v[188:191], a[212:215], v[132:135]
 v_mfma_f32_16x16x32_bf16 v[140:143], v[188:191], a[236:239], v[140:143]
 s_mov_b64 exec, 1
 v_mov_b32 v20, s69
 buffer_store_dword v20, v10, s[72:75], s44 offen sc1
 s_mov_b64 exec, -1
 s_cmp_le_u32 s45, 16
 s_cbranch_scc1 vwe_158
vwe_159:
 s_cmp_eq_u32 s23, 0
 s_cbranch_scc1 vws_156
vwb_157:
 s_waitcnt lgkmcnt(0)
 v_mfma_f32_16x16x32_bf16 v[64:67], v[192:195], a[0:3], 0
 v_cmp_gt_u32 vcc, 8, v9
 s_nop 0
 v_mfma_f32_16x16x32_bf16 v[72:75], v[192:195], a[24:27], 0
 s_bitset1_b64 vcc, 19
 s_ff1_i32_b64 s21, vcc
 v_mfma_f32_16x16x32_bf16 v[80:83], v[192:195], a[48:51], 0
 s_lshl_b32 s22, s21, 1
 s_lshl_b32 s21, s21, 2
 v_mfma_f32_16x16x32_bf16 v[88:91], v[192:195], a[72:75], 0
 s_sub_i32 s21, s21, 12
 s_max_i32 s47, s21, s22
 v_mfma_f32_16x16x32_bf16 v[96:99], v[192:195], a[96:99], 0
 s_add_u32 s22, s45, 7
 s_min_u32 s22, s22, s47
 v_mfma_f32_16x16x32_bf16 v[68:71], v[216:219], a[0:3], 0
 s_cmp_lt_u32 s46, s22
 s_cselect_b32 s66, s41, 0x80000000
 s_cselect_b32 m0, s64, 98304
 s_cselect_b32 s22, 1, 0
 v_mfma_f32_16x16x32_bf16 v[76:79], v[216:219], a[24:27], 0
 buffer_load_dwordx4 v4, s[16:19], s66 offen offset:0 sc1 lds
 v_mfma_f32_16x16x32_bf16 v[84:87], v[216:219], a[48:51], 0
 v_add_u32 v8, s65, v4
 s_add_u32 s65, s65, 12288
 v_mfma_f32_16x16x32_bf16 v[92:95], v[216:219], a[72:75], 0
 buffer_load_dwordx4 v4, s[16:19], s66 offen offset:1024 sc1 lds
 v_mfma_f32_16x16x32_bf16 v[100:103], v[216:219], a[96:99], 0
 s_cmp_lt_u32 s65, 98304
 s_cselect_b32 s65, s65, 0
 v_mfma_f32_16x16x32_bf16 v[64:67], v[196:199], a[4:7], v[64:67]
 buffer_load_dwordx4 v4, s[16:19], s66 offen offset:2048 sc1 lds
 v_mfma_f32_16x16x32_bf16 v[72:75], v[196:199], a[28:31], v[72:75]
 s_add_u32 s46, s46, s22
 s_mul_i32 s21, s22, 393216
 v_mfma_f32_16x16x32_bf16 v[80:83], v[196:199], a[52:55], v[80:83]
 s_add_u32 s41, s41, s21
 s_mul_i32 s21, s22, 12288
 v_mfma_f32_16x16x32_bf16 v[88:91], v[196:199], a[76:79], v[88:91]
 s_add_u32 s64, s64, s21
 v_cvt_pk_bf16_f32 v44, v104, v105
 v_mfma_f32_16x16x32_bf16 v[96:99], v[196:199], a[100:103], v[96:99]
 s_cmp_lt_u32 s64, s67
 s_cselect_b32 s64, s64, s71
 v_mfma_f32_16x16x32_bf16 v[68:71], v[220:223], a[4:7], v[68:71]
 v_cvt_pk_bf16_f32 v45, v106, v107
 v_cvt_pk_bf16_f32 v46, v108, v109
 v_mfma_f32_16x16x32_bf16 v[76:79], v[220:223], a[28:31], v[76:79]
 v_cvt_pk_bf16_f32 v47, v110, v111
 v_mfma_f32_16x16x32_bf16 v[84:87], v[220:223], a[52:55], v[84:87]
 s_add_u32 s69, s68, 4096
 v_mfma_f32_16x16x32_bf16 v[92:95], v[220:223], a[76:79], v[92:95]
 v_mfma_f32_16x16x32_bf16 v[100:103], v[220:223], a[100:103], v[100:103]
 buffer_store_dwordx4 v[44:47], v4, s[24:27], s69 offen offset:1024 sc1
 v_mfma_f32_16x16x32_bf16 v[64:67], v[200:203], a[8:11], v[64:67]
 v_mfma_f32_16x16x32_bf16 v[72:75], v[200:203], a[32:35], v[72:75]
 v_cvt_pk_bf16_f32 v48, v112, v113
 v_mfma_f32_16x16x32_bf16 v[80:83], v[200:203], a[56:59], v[80:83]
 v_cvt_pk_bf16_f32 v49, v114, v115
 v_mfma_f32_16x16x32_bf16 v[88:91], v[200:203], a[80:83], v[88:91]
 v_mfma_f32_16x16x32_bf16 v[96:99], v[200:203], a[104:107], v[96:99]
 v_cvt_pk_bf16_f32 v50, v116, v117
 v_mfma_f32_16x16x32_bf16 v[68:71], v[224:227], a[8:11], v[68:71]
 v_mfma_f32_16x16x32_bf16 v[76:79], v[224:227], a[32:35], v[76:79]
 v_cvt_pk_bf16_f32 v51, v118, v119
 v_mfma_f32_16x16x32_bf16 v[84:87], v[224:227], a[56:59], v[84:87]
 buffer_store_dwordx4 v[48:51], v4, s[24:27], s69 offen offset:2048 sc1
 v_mfma_f32_16x16x32_bf16 v[92:95], v[224:227], a[80:83], v[92:95]
 v_mfma_f32_16x16x32_bf16 v[100:103], v[224:227], a[104:107], v[100:103]
 v_cvt_pk_bf16_f32 v52, v120, v121
 v_mfma_f32_16x16x32_bf16 v[64:67], v[204:207], a[12:15], v[64:67]
 v_mfma_f32_16x16x32_bf16 v[72:75], v[204:207], a[36:39], v[72:75]
 v_cvt_pk_bf16_f32 v53, v122, v123
 v_mfma_f32_16x16x32_bf16 v[80:83], v[204:207], a[60:63], v[80:83]
 v_cvt_pk_bf16_f32 v54, v124, v125
 v_mfma_f32_16x16x32_bf16 v[88:91], v[204:207], a[84:87], v[88:91]
 v_mfma_f32_16x16x32_bf16 v[96:99], v[204:207], a[108:111], v[96:99]
 v_cvt_pk_bf16_f32 v55, v126, v127
 v_mfma_f32_16x16x32_bf16 v[68:71], v[228:231], a[12:15], v[68:71]
 v_mfma_f32_16x16x32_bf16 v[76:79], v[228:231], a[36:39], v[76:79]
 buffer_store_dwordx4 v[52:55], v4, s[24:27], s69 offen offset:3072 sc1
 v_mfma_f32_16x16x32_bf16 v[84:87], v[228:231], a[60:63], v[84:87]
 v_cvt_pk_bf16_f32 v56, v128, v129
 v_mfma_f32_16x16x32_bf16 v[92:95], v[228:231], a[84:87], v[92:95]
 v_mfma_f32_16x16x32_bf16 v[100:103], v[228:231], a[108:111], v[100:103]
 v_cvt_pk_bf16_f32 v57, v130, v131
 v_mfma_f32_16x16x32_bf16 v[64:67], v[208:211], a[16:19], v[64:67]
 v_mfma_f32_16x16x32_bf16 v[72:75], v[208:211], a[40:43], v[72:75]
 v_cvt_pk_bf16_f32 v58, v132, v133
 v_mfma_f32_16x16x32_bf16 v[80:83], v[208:211], a[64:67], v[80:83]
 v_cvt_pk_bf16_f32 v59, v134, v135
 v_mfma_f32_16x16x32_bf16 v[88:91], v[208:211], a[88:91], v[88:91]
 v_mfma_f32_16x16x32_bf16 v[96:99], v[208:211], a[112:115], v[96:99]
 s_add_u32 s69, s68, 8192
 v_mfma_f32_16x16x32_bf16 v[68:71], v[232:235], a[16:19], v[68:71]
 v_mfma_f32_16x16x32_bf16 v[76:79], v[232:235], a[40:43], v[76:79]
 buffer_store_dwordx4 v[56:59], v4, s[24:27], s69 offen offset:0 sc1
 v_mfma_f32_16x16x32_bf16 v[84:87], v[232:235], a[64:67], v[84:87]
 v_cvt_pk_bf16_f32 v60, v136, v137
 v_mfma_f32_16x16x32_bf16 v[92:95], v[232:235], a[88:91], v[92:95]
 v_mfma_f32_16x16x32_bf16 v[100:103], v[232:235], a[112:115], v[100:103]
 v_cvt_pk_bf16_f32 v61, v138, v139
 v_mfma_f32_16x16x32_bf16 v[64:67], v[212:215], a[20:23], v[64:67]
 v_mfma_f32_16x16x32_bf16 v[72:75], v[212:215], a[44:47], v[72:75]
 v_cvt_pk_bf16_f32 v62, v140, v141
 v_mfma_f32_16x16x32_bf16 v[80:83], v[212:215], a[68:71], v[80:83]
 v_cvt_pk_bf16_f32 v63, v142, v143
 v_mfma_f32_16x16x32_bf16 v[88:91], v[212:215], a[92:95], v[88:91]
 v_mfma_f32_16x16x32_bf16 v[96:99], v[212:215], a[116:119], v[96:99]
 buffer_store_dwordx4 v[60:63], v4, s[24:27], s69 offen offset:1024 sc1
 v_mfma_f32_16x16x32_bf16 v[68:71], v[236:239], a[20:23], v[68:71]
 v_mfma_f32_16x16x32_bf16 v[76:79], v[236:239], a[44:47], v[76:79]
 v_mfma_f32_16x16x32_bf16 v[84:87], v[236:239], a[68:71], v[84:87]
 v_mfma_f32_16x16x32_bf16 v[92:95], v[236:239], a[92:95], v[92:95]
 v_mfma_f32_16x16x32_bf16 v[100:103], v[236:239], a[116:119], v[100:103]
 v_mfma_f32_16x16x32_bf16 v[104:107], v[192:195], a[120:123], 0
 buffer_load_dword v9, v5, s[72:75], s43 offen sc1
 v_mfma_f32_16x16x32_bf16 v[112:115], v[192:195], a[144:147], 0
 v_mfma_f32_16x16x32_bf16 v[120:123], v[192:195], a[168:171], 0
 v_mfma_f32_16x16x32_bf16 v[128:131], v[192:195], a[192:195], 0
 v_cvt_pk_bf16_f32 v24, v64, v65
 v_mfma_f32_16x16x32_bf16 v[136:139], v[192:195], a[216:219], 0
 s_add_u32 s63, s45, 1
 s_min_u32 s63, s63, 63
 v_mfma_f32_16x16x32_bf16 v[108:111], v[216:219], a[120:123], 0
 s_cmp_lt_u32 s63, s46
 s_cselect_b32 s53, 1, 0
 v_mfma_f32_16x16x32_bf16 v[116:119], v[216:219], a[144:147], 0
 v_mov_b32 v21, s53
 ds_write_b32 v6, v21 offset:16
 v_mfma_f32_16x16x32_bf16 v[124:127], v[216:219], a[168:171], 0
 v_cvt_pk_bf16_f32 v25, v66, v67
 v_cvt_pk_bf16_f32 v26, v68, v69
 v_mfma_f32_16x16x32_bf16 v[132:135], v[216:219], a[192:195], 0
 v_cvt_pk_bf16_f32 v27, v70, v71
 v_mfma_f32_16x16x32_bf16 v[140:143], v[216:219], a[216:219], 0
 v_mfma_f32_16x16x32_bf16 v[104:107], v[196:199], a[124:127], v[104:107]
 buffer_store_dwordx4 v[24:27], v4, s[24:27], s42 offen offset:0 sc1
 v_mfma_f32_16x16x32_bf16 v[112:115], v[196:199], a[148:151], v[112:115]
 v_cvt_pk_bf16_f32 v28, v72, v73
 v_mfma_f32_16x16x32_bf16 v[120:123], v[196:199], a[172:175], v[120:123]
 s_cmp_eq_u32 s40, 3
 s_cbranch_scc1 vwm_164
vwm_165:
 v_mfma_f32_16x16x32_bf16 v[128:131], v[196:199], a[196:199], v[128:131]
 v_cvt_pk_bf16_f32 v29, v74, v75
 v_mfma_f32_16x16x32_bf16 v[136:139], v[196:199], a[220:223], v[136:139]
 v_mfma_f32_16x16x32_bf16 v[108:111], v[220:223], a[124:127], v[108:111]
 v_cvt_pk_bf16_f32 v30, v76, v77
 v_mfma_f32_16x16x32_bf16 v[116:119], v[220:223], a[148:151], v[116:119]
 v_mfma_f32_16x16x32_bf16 v[124:127], v[220:223], a[172:175], v[124:127]
 v_cvt_pk_bf16_f32 v31, v78, v79
 v_mfma_f32_16x16x32_bf16 v[132:135], v[220:223], a[196:199], v[132:135]
 buffer_store_dwordx4 v[28:31], v4, s[24:27], s42 offen offset:1024 sc1
 v_mfma_f32_16x16x32_bf16 v[140:143], v[220:223], a[220:223], v[140:143]
 s_cmp_lt_u32 s63, s50
 s_cbranch_scc0 vwx_162
vwx_163:
 v_mfma_f32_16x16x32_bf16 v[104:107], v[200:203], a[128:131], v[104:107]
 s_waitcnt lgkmcnt(0)
 s_barrier
 v_mfma_f32_16x16x32_bf16 v[112:115], v[200:203], a[152:155], v[112:115]
 ds_read_b128 v[240:243], v7 offset:16
 v_cvt_pk_bf16_f32 v32, v80, v81
 v_mfma_f32_16x16x32_bf16 v[120:123], v[200:203], a[176:179], v[120:123]
 ds_read_b128 v[144:147], v8 offset:0
 v_cvt_pk_bf16_f32 v33, v82, v83
 v_mfma_f32_16x16x32_bf16 v[128:131], v[200:203], a[200:203], v[128:131]
 v_mfma_f32_16x16x32_bf16 v[136:139], v[200:203], a[224:227], v[136:139]
 ds_read_b128 v[148:151], v8 offset:1024
 v_cvt_pk_bf16_f32 v34, v84, v85
 v_mfma_f32_16x16x32_bf16 v[108:111], v[224:227], a[128:131], v[108:111]
 v_mfma_f32_16x16x32_bf16 v[116:119], v[224:227], a[152:155], v[116:119]
 v_cvt_pk_bf16_f32 v35, v86, v87
 v_mfma_f32_16x16x32_bf16 v[124:127], v[224:227], a[176:179], v[124:127]
 ds_read_b128 v[152:155], v8 offset:2048
 v_mfma_f32_16x16x32_bf16 v[132:135], v[224:227], a[200:203], v[132:135]
 buffer_store_dwordx4 v[32:35], v4, s[24:27], s42 offen offset:2048 sc1
 v_mfma_f32_16x16x32_bf16 v[140:143], v[224:227], a[224:227], v[140:143]
 ds_read_b128 v[156:159], v8 offset:3072
 v_cvt_pk_bf16_f32 v36, v88, v89
 v_mfma_f32_16x16x32_bf16 v[104:107], v[204:207], a[132:135], v[104:107]
 v_mfma_f32_16x16x32_bf16 v[112:115], v[204:207], a[156:159], v[112:115]
 v_cvt_pk_bf16_f32 v37, v90, v91
 v_mfma_f32_16x16x32_bf16 v[120:123], v[204:207], a[180:183], v[120:123]
 ds_read_b128 v[160:163], v8 offset:4096
 v_mfma_f32_16x16x32_bf16 v[128:131], v[204:207], a[204:207], v[128:131]
 v_cvt_pk_bf16_f32 v38, v92, v93
 v_mfma_f32_16x16x32_bf16 v[136:139], v[204:207], a[228:231], v[136:139]
 ds_read_b128 v[164:167], v8 offset:5120
 s_waitcnt lgkmcnt(4)
 v_mfma_f32_16x16x32_bf16 v[108:111], v[228:231], a[132:135], v[108:111]
 v_bitop3_b32 v240, v240, v241, v242 bitop3:0x80
 v_and_b32 v240, v240, v243
 v_mfma_f32_16x16x32_bf16 v[116:119], v[228:231], a[156:159], v[116:119]
 s_nop 0
 v_readfirstlane_b32 s23, v240
 v_mfma_f32_16x16x32_bf16 v[124:127], v[228:231], a[180:183], v[124:127]
 ds_read_b128 v[168:171], v8 offset:6144
 v_cvt_pk_bf16_f32 v39, v94, v95
 v_mfma_f32_16x16x32_bf16 v[132:135], v[228:231], a[204:207], v[132:135]
 buffer_store_dwordx4 v[36:39], v4, s[24:27], s42 offen offset:3072 sc1
 v_mfma_f32_16x16x32_bf16 v[140:143], v[228:231], a[228:231], v[140:143]
 ds_read_b128 v[172:175], v8 offset:7168
 v_cvt_pk_bf16_f32 v40, v96, v97
 v_mfma_f32_16x16x32_bf16 v[104:107], v[208:211], a[136:139], v[104:107]
 v_cvt_pk_bf16_f32 v41, v98, v99
 v_mfma_f32_16x16x32_bf16 v[112:115], v[208:211], a[160:163], v[112:115]
 v_cvt_pk_bf16_f32 v42, v100, v101
 v_mfma_f32_16x16x32_bf16 v[120:123], v[208:211], a[184:187], v[120:123]
 ds_read_b128 v[176:179], v8 offset:8192
 v_mfma_f32_16x16x32_bf16 v[128:131], v[208:211], a[208:211], v[128:131]
 v_cvt_pk_bf16_f32 v43, v102, v103
 v_mfma_f32_16x16x32_bf16 v[136:139], v[208:211], a[232:235], v[136:139]
 ds_read_b128 v[180:183], v8 offset:9216
 v_mfma_f32_16x16x32_bf16 v[108:111], v[232:235], a[136:139], v[108:111]
 s_add_u32 s69, s42, 4096
 v_mfma_f32_16x16x32_bf16 v[116:119], v[232:235], a[160:163], v[116:119]
 v_mfma_f32_16x16x32_bf16 v[124:127], v[232:235], a[184:187], v[124:127]
 ds_read_b128 v[184:187], v8 offset:10240
 v_mfma_f32_16x16x32_bf16 v[132:135], v[232:235], a[208:211], v[132:135]
 buffer_store_dwordx4 v[40:43], v4, s[24:27], s69 offen offset:0 sc1
 v_mfma_f32_16x16x32_bf16 v[140:143], v[232:235], a[232:235], v[140:143]
 ds_read_b128 v[188:191], v8 offset:11264
 v_mfma_f32_16x16x32_bf16 v[104:107], v[212:215], a[140:143], v[104:107]
 v_mfma_f32_16x16x32_bf16 v[112:115], v[212:215], a[164:167], v[112:115]
 v_mfma_f32_16x16x32_bf16 v[120:123], v[212:215], a[188:191], v[120:123]
 s_waitcnt vmcnt(11)
 s_mov_b32 s50, s46
 s_add_u32 s69, s45, s40
 v_mfma_f32_16x16x32_bf16 v[128:131], v[212:215], a[212:215], v[128:131]
 s_mov_b32 s40, 0
 s_sub_i32 s69, s69, 1
 s_max_i32 s69, s69, s70
 v_mfma_f32_16x16x32_bf16 v[136:139], v[212:215], a[236:239], v[136:139]
 s_add_u32 s45, s45, 1
 s_mov_b32 s68, s42
 s_add_u32 s42, s42, 1310720
 v_mfma_f32_16x16x32_bf16 v[108:111], v[236:239], a[140:143], v[108:111]
 v_mfma_f32_16x16x32_bf16 v[116:119], v[236:239], a[164:167], v[116:119]
 v_mfma_f32_16x16x32_bf16 v[124:127], v[236:239], a[188:191], v[124:127]
 v_mfma_f32_16x16x32_bf16 v[132:135], v[236:239], a[212:215], v[132:135]
 v_mfma_f32_16x16x32_bf16 v[140:143], v[236:239], a[236:239], v[140:143]
 s_mov_b64 exec, 1
 v_mov_b32 v20, s69
 buffer_store_dword v20, v10, s[72:75], s44 offen sc1
 s_mov_b64 exec, -1
 s_cmp_le_u32 s45, 16
 s_cbranch_scc1 vwe_168
vwe_169:
 s_cmp_lg_u32 s45, 44
 s_cbranch_scc1 arm_172
 s_lshr_b32 s21, s2, 3
 s_lshl_b32 s21, s21, 14
 s_and_b32 s22, s2, 7
 s_lshl_b32 s22, s22, 10
 s_add_u32 s54, s21, s22
 s_lshr_b32 s21, s2, 2
 s_lshl_b32 s21, s21, 14
 s_and_b32 s22, s2, 3
 s_lshl_b32 s22, s22, 11
 s_add_u32 s21, s21, s22
 s_add_u32 s55, s21, 655360
 s_lshr_b32 s58, s2, 1
 s_lshl_b32 s58, s58, 14
 s_and_b32 s21, s2, 1
 s_mul_i32 s21, s21, 3072
 s_add_u32 s58, s58, s21
 s_add_u32 s58, s58, 655360
 s_add_u32 s56, s20, 52
arm_173:
 s_lshl_b32 s21, s56, 12
 s_and_b32 s21, s21, 8192
 s_xor_b32 s21, s21, s37
 s_lshl_b32 s57, s56, 20
 s_or_b32 s57, s57, s21
 s_cmp_ge_u32 s56, 36
 s_cselect_b32 s21, 8192, 0
 s_xor_b32 s21, s21, s57
 s_add_u32 s21, s21, s54
 buffer_store_dwordx4 v[244:247], v4, s[88:91], s21 offen sc1
 s_add_u32 s21, s21, 65536
 buffer_store_dwordx4 v[244:247], v4, s[88:91], s21 offen sc1
 s_add_u32 s21, s21, 65536
 buffer_store_dwordx4 v[244:247], v4, s[88:91], s21 offen sc1
 s_add_u32 s21, s21, 65536
 buffer_store_dwordx4 v[244:247], v4, s[88:91], s21 offen sc1
 s_add_u32 s21, s21, 65536
 buffer_store_dwordx4 v[244:247], v4, s[88:91], s21 offen sc1
 s_add_u32 s21, s21, 65536
 buffer_store_dwordx4 v[244:247], v4, s[88:91], s21 offen sc1
 s_add_u32 s21, s21, 65536
 buffer_store_dwordx4 v[244:247], v4, s[88:91], s21 offen sc1
 s_add_u32 s21, s21, 65536
 buffer_store_dwordx4 v[244:247], v4, s[88:91], s21 offen sc1
 s_add_u32 s21, s21, 65536
 buffer_store_dwordx4 v[244:247], v4, s[88:91], s21 offen sc1
 s_add_u32 s21, s21, 65536
 buffer_store_dwordx4 v[244:247], v4, s[88:91], s21 offen sc1
 s_add_u32 s21, s21, 65536
 s_add_u32 s21, s57, s55
 buffer_store_dwordx4 v[244:247], v4, s[88:91], s21 offen sc1
 buffer_store_dwordx4 v[244:247], v4, s[88:91], s21 offen offset:1024 sc1
 s_xor_b32 s21, s57, 8192
 s_add_u32 s21, s21, s58
 buffer_store_dwordx4 v[244:247], v4, s[88:91], s21 offen offset:0 sc1
 buffer_store_dwordx4 v[244:247], v4, s[88:91], s21 offen offset:1024 sc1
 buffer_store_dwordx4 v[244:247], v4, s[88:91], s21 offen offset:2048 sc1
 s_add_u32 s56, s56, 4
 s_cmp_lt_u32 s56, 64
 s_cbranch_scc1 arm_173
arm_172:
 s_cmp_ge_u32 s45, 64
 s_cbranch_scc1 vwd_151
 s_cmp_lg_u32 s23, 0
 s_cbranch_scc1 vwl_150
 s_branch vws_166
vws_156:
 v_cmp_gt_u32 vcc, 8, v9
 s_nop 0
 s_bitset1_b64 vcc, 19
 s_ff1_i32_b64 s21, vcc
 s_lshl_b32 s22, s21, 1
 s_lshl_b32 s21, s21, 2
 s_sub_i32 s21, s21, 12
 s_max_i32 s47, s21, s22
 s_cmp_gt_u32 s47, s45
 s_cbranch_scc1 va_174
 s_cmp_eq_u32 s70, s45
 s_cbranch_scc1 va_179
 s_nop 4
 v_cvt_pk_bf16_f32 v44, v104, v105
 v_cvt_pk_bf16_f32 v45, v106, v107
 v_cvt_pk_bf16_f32 v46, v108, v109
 v_cvt_pk_bf16_f32 v47, v110, v111
 s_add_u32 s69, s68, 4096
 buffer_store_dwordx4 v[44:47], v4, s[24:27], s69 offen offset:1024 sc1
 v_cvt_pk_bf16_f32 v48, v112, v113
 v_cvt_pk_bf16_f32 v49, v114, v115
 v_cvt_pk_bf16_f32 v50, v116, v117
 v_cvt_pk_bf16_f32 v51, v118, v119
 buffer_store_dwordx4 v[48:51], v4, s[24:27], s69 offen offset:2048 sc1
 v_cvt_pk_bf16_f32 v52, v120, v121
 v_cvt_pk_bf16_f32 v53, v122, v123
 v_cvt_pk_bf16_f32 v54, v124, v125
 v_cvt_pk_bf16_f32 v55, v126, v127
 buffer_store_dwordx4 v[52:55], v4, s[24:27], s69 offen offset:3072 sc1
 v_cvt_pk_bf16_f32 v56, v128, v129
 v_cvt_pk_bf16_f32 v57, v130, v131
 v_cvt_pk_bf16_f32 v58, v132, v133
 v_cvt_pk_bf16_f32 v59, v134, v135
 s_add_u32 s69, s68, 8192
 buffer_store_dwordx4 v[56:59], v4, s[24:27], s69 offen offset:0 sc1
 v_cvt_pk_bf16_f32 v60, v136, v137
 v_cvt_pk_bf16_f32 v61, v138, v139
 v_cvt_pk_bf16_f32 v62, v140, v141
 v_cvt_pk_bf16_f32 v63, v142, v143
 buffer_store_dwordx4 v[60:63], v4, s[24:27], s69 offen offset:1024 sc1
 s_mov_b32 s68, 0x80000000
 s_mov_b32 s56, s68
 s_mov_b32 s57, s68
 s_waitcnt vmcnt(0)
 s_mov_b64 exec, 1
 v_mov_b32 v20, s45
 buffer_store_dword v20, v10, s[72:75], s44 offen sc1
 s_mov_b64 exec, -1
 s_mov_b32 s70, s45
 s_mov_b32 s40, 0
va_179:
 s_mov_b32 s101, 0
 s_branch va_177
va_175:
 s_sleep 8
va_177:
 buffer_load_dword v9, v5, s[72:75], s43 offen sc1
 s_add_u32 s101, s101, 1
 s_cmp_gt_u32 s101, 131072
 s_cbranch_scc1 main_end
 s_waitcnt vmcnt(0)
 v_cmp_gt_u32 vcc, 8, v9
 s_nop 0
 s_bitset1_b64 vcc, 19
 s_ff1_i32_b64 s21, vcc
 s_lshl_b32 s22, s21, 1
 s_lshl_b32 s21, s21, 2
 s_sub_i32 s21, s21, 12
 s_max_i32 s47, s21, s22
 s_cmp_gt_u32 s47, s45
 s_cbranch_scc0 va_175
va_174:
 s_add_u32 s22, s45, 6
 s_min_u32 s22, s22, s47
va_176:
 s_cmp_ge_u32 s46, s22
 s_cbranch_scc1 va_178
 s_mov_b32 m0, s64
 s_mov_b32 s66, s41
 buffer_load_dwordx4 v4, s[16:19], s66 offen offset:0 sc1 lds
 buffer_load_dwordx4 v4, s[16:19], s66 offen offset:1024 sc1 lds
 buffer_load_dwordx4 v4, s[16:19], s66 offen offset:2048 sc1 lds
 s_add_u32 s46, s46, 1
 s_add_u32 s41, s41, 393216
 s_add_u32 s64, s64, 12288
 s_cmp_lt_u32 s64, s67
 s_cselect_b32 s64, s64, s71
 s_branch va_176
va_178:
 s_mov_b32 s48, s46
 s_mov_b32 s49, s46
 s_mov_b32 s50, s46
 s_waitcnt vmcnt(0)
 s_cmp_eq_u32 s40, 0
 s_cbranch_scc1 va_180
 s_mov_b32 s40, 0
 s_mov_b64 exec, 1
 v_mov_b32 v20, s45
 buffer_store_dword v20, v10, s[72:75], s44 offen sc1
 s_mov_b64 exec, -1
 s_mov_b32 s70, s45
va_180:
 s_barrier
 ds_read_b128 v[192:195], v8 offset:0
 ds_read_b128 v[196:199], v8 offset:1024
 ds_read_b128 v[200:203], v8 offset:2048
 ds_read_b128 v[204:207], v8 offset:3072
 ds_read_b128 v[208:211], v8 offset:4096
 ds_read_b128 v[212:215], v8 offset:5120
 ds_read_b128 v[216:219], v8 offset:6144
 ds_read_b128 v[220:223], v8 offset:7168
 ds_read_b128 v[224:227], v8 offset:8192
 ds_read_b128 v[228:231], v8 offset:9216
 ds_read_b128 v[232:235], v8 offset:10240
 ds_read_b128 v[236:239], v8 offset:11264
 s_branch vwb_157
vws_166:
 v_cmp_gt_u32 vcc, 8, v9
 s_nop 0
 s_bitset1_b64 vcc, 19
 s_ff1_i32_b64 s21, vcc
 s_lshl_b32 s22, s21, 1
 s_lshl_b32 s21, s21, 2
 s_sub_i32 s21, s21, 12
 s_max_i32 s47, s21, s22
 s_cmp_gt_u32 s47, s45
 s_cbranch_scc1 va_181
 s_cmp_eq_u32 s70, s45
 s_cbranch_scc1 va_186
 s_nop 4
 v_cvt_pk_bf16_f32 v44, v104, v105
 v_cvt_pk_bf16_f32 v45, v106, v107
 v_cvt_pk_bf16_f32 v46, v108, v109
 v_cvt_pk_bf16_f32 v47, v110, v111
 s_add_u32 s69, s68, 4096
 buffer_store_dwordx4 v[44:47], v4, s[24:27], s69 offen offset:1024 sc1
 v_cvt_pk_bf16_f32 v48, v112, v113
 v_cvt_pk_bf16_f32 v49, v114, v115
 v_cvt_pk_bf16_f32 v50, v116, v117
 v_cvt_pk_bf16_f32 v51, v118, v119
 buffer_store_dwordx4 v[48:51], v4, s[24:27], s69 offen offset:2048 sc1
 v_cvt_pk_bf16_f32 v52, v120, v121
 v_cvt_pk_bf16_f32 v53, v122, v123
 v_cvt_pk_bf16_f32 v54, v124, v125
 v_cvt_pk_bf16_f32 v55, v126, v127
 buffer_store_dwordx4 v[52:55], v4, s[24:27], s69 offen offset:3072 sc1
 v_cvt_pk_bf16_f32 v56, v128, v129
 v_cvt_pk_bf16_f32 v57, v130, v131
 v_cvt_pk_bf16_f32 v58, v132, v133
 v_cvt_pk_bf16_f32 v59, v134, v135
 s_add_u32 s69, s68, 8192
 buffer_store_dwordx4 v[56:59], v4, s[24:27], s69 offen offset:0 sc1
 v_cvt_pk_bf16_f32 v60, v136, v137
 v_cvt_pk_bf16_f32 v61, v138, v139
 v_cvt_pk_bf16_f32 v62, v140, v141
 v_cvt_pk_bf16_f32 v63, v142, v143
 buffer_store_dwordx4 v[60:63], v4, s[24:27], s69 offen offset:1024 sc1
 s_mov_b32 s68, 0x80000000
 s_mov_b32 s56, s68
 s_mov_b32 s57, s68
 s_waitcnt vmcnt(0)
 s_mov_b64 exec, 1
 v_mov_b32 v20, s45
 buffer_store_dword v20, v10, s[72:75], s44 offen sc1
 s_mov_b64 exec, -1
 s_mov_b32 s70, s45
 s_mov_b32 s40, 0
va_186:
 s_mov_b32 s101, 0
 s_branch va_184
va_182:
 s_sleep 8
va_184:
 buffer_load_dword v9, v5, s[72:75], s43 offen sc1
 s_add_u32 s101, s101, 1
 s_cmp_gt_u32 s101, 131072
 s_cbranch_scc1 main_end
 s_waitcnt vmcnt(0)
 v_cmp_gt_u32 vcc, 8, v9
 s_nop 0
 s_bitset1_b64 vcc, 19
 s_ff1_i32_b64 s21, vcc
 s_lshl_b32 s22, s21, 1
 s_lshl_b32 s21, s21, 2
 s_sub_i32 s21, s21, 12
 s_max_i32 s47, s21, s22
 s_cmp_gt_u32 s47, s45
 s_cbranch_scc0 va_182
va_181:
 s_add_u32 s22, s45, 6
 s_min_u32 s22, s22, s47
va_183:
 s_cmp_ge_u32 s46, s22
 s_cbranch_scc1 va_185
 s_mov_b32 m0, s64
 s_mov_b32 s66, s41
 buffer_load_dwordx4 v4, s[16:19], s66 offen offset:0 sc1 lds
 buffer_load_dwordx4 v4, s[16:19], s66 offen offset:1024 sc1 lds
 buffer_load_dwordx4 v4, s[16:19], s66 offen offset:2048 sc1 lds
 s_add_u32 s46, s46, 1
 s_add_u32 s41, s41, 393216
 s_add_u32 s64, s64, 12288
 s_cmp_lt_u32 s64, s67
 s_cselect_b32 s64, s64, s71
 s_branch va_183
va_185:
 s_mov_b32 s48, s46
 s_mov_b32 s49, s46
 s_mov_b32 s50, s46
 s_waitcnt vmcnt(0)
 s_cmp_eq_u32 s40, 0
 s_cbranch_scc1 va_187
 s_mov_b32 s40, 0
 s_mov_b64 exec, 1
 v_mov_b32 v20, s45
 buffer_store_dword v20, v10, s[72:75], s44 offen sc1
 s_mov_b64 exec, -1
 s_mov_b32 s70, s45
va_187:
 s_barrier
 ds_read_b128 v[144:147], v8 offset:0
 ds_read_b128 v[148:151], v8 offset:1024
 ds_read_b128 v[152:155], v8 offset:2048
 ds_read_b128 v[156:159], v8 offset:3072
 ds_read_b128 v[160:163], v8 offset:4096
 ds_read_b128 v[164:167], v8 offset:5120
 ds_read_b128 v[168:171], v8 offset:6144
 ds_read_b128 v[172:175], v8 offset:7168
 ds_read_b128 v[176:179], v8 offset:8192
 ds_read_b128 v[180:183], v8 offset:9216
 ds_read_b128 v[184:187], v8 offset:10240
 ds_read_b128 v[188:191], v8 offset:11264
 s_branch vwl_150
vwe_158:
 s_nop 4
 v_cvt_pk_bf16_f32 v44, v104, v105
 v_cvt_pk_bf16_f32 v45, v106, v107
 v_cvt_pk_bf16_f32 v46, v108, v109
 v_cvt_pk_bf16_f32 v47, v110, v111
 s_add_u32 s69, s68, 4096
 buffer_store_dwordx4 v[44:47], v4, s[24:27], s69 offen offset:1024 sc1
 v_cvt_pk_bf16_f32 v48, v112, v113
 v_cvt_pk_bf16_f32 v49, v114, v115
 v_cvt_pk_bf16_f32 v50, v116, v117
 v_cvt_pk_bf16_f32 v51, v118, v119
 buffer_store_dwordx4 v[48:51], v4, s[24:27], s69 offen offset:2048 sc1
 v_cvt_pk_bf16_f32 v52, v120, v121
 v_cvt_pk_bf16_f32 v53, v122, v123
 v_cvt_pk_bf16_f32 v54, v124, v125
 v_cvt_pk_bf16_f32 v55, v126, v127
 buffer_store_dwordx4 v[52:55], v4, s[24:27], s69 offen offset:3072 sc1
 v_cvt_pk_bf16_f32 v56, v128, v129
 v_cvt_pk_bf16_f32 v57, v130, v131
 v_cvt_pk_bf16_f32 v58, v132, v133
 v_cvt_pk_bf16_f32 v59, v134, v135
 s_add_u32 s69, s68, 8192
 buffer_store_dwordx4 v[56:59], v4, s[24:27], s69 offen offset:0 sc1
 v_cvt_pk_bf16_f32 v60, v136, v137
 v_cvt_pk_bf16_f32 v61, v138, v139
 v_cvt_pk_bf16_f32 v62, v140, v141
 v_cvt_pk_bf16_f32 v63, v142, v143
 buffer_store_dwordx4 v[60:63], v4, s[24:27], s69 offen offset:1024 sc1
 s_mov_b32 s68, 0x80000000
 s_mov_b32 s56, s68
 s_mov_b32 s57, s68
 s_cmp_le_u32 s45, 4
 s_cselect_b32 s40, 3, 1
 s_branch vwe_159
vwe_168:
 s_nop 4
 v_cvt_pk_bf16_f32 v44, v104, v105
 v_cvt_pk_bf16_f32 v45, v106, v107
 v_cvt_pk_bf16_f32 v46, v108, v109
 v_cvt_pk_bf16_f32 v47, v110, v111
 s_add_u32 s69, s68, 4096
 buffer_store_dwordx4 v[44:47], v4, s[24:27], s69 offen offset:1024 sc1
 v_cvt_pk_bf16_f32 v48, v112, v113
 v_cvt_pk_bf16_f32 v49, v114, v115
 v_cvt_pk_bf16_f32 v50, v116, v117
 v_cvt_pk_bf16_f32 v51, v118, v119
 buffer_store_dwordx4 v[48:51], v4, s[24:27], s69 offen offset:2048 sc1
 v_cvt_pk_bf16_f32 v52, v120, v121
 v_cvt_pk_bf16_f32 v53, v122, v123
 v_cvt_pk_bf16_f32 v54, v124, v125
 v_cvt_pk_bf16_f32 v55, v126, v127
 buffer_store_dwordx4 v[52:55], v4, s[24:27], s69 offen offset:3072 sc1
 v_cvt_pk_bf16_f32 v56, v128, v129
 v_cvt_pk_bf16_f32 v57, v130, v131
 v_cvt_pk_bf16_f32 v58, v132, v133
 v_cvt_pk_bf16_f32 v59, v134, v135
 s_add_u32 s69, s68, 8192
 buffer_store_dwordx4 v[56:59], v4, s[24:27], s69 offen offset:0 sc1
 v_cvt_pk_bf16_f32 v60, v136, v137
 v_cvt_pk_bf16_f32 v61, v138, v139
 v_cvt_pk_bf16_f32 v62, v140, v141
 v_cvt_pk_bf16_f32 v63, v142, v143
 buffer_store_dwordx4 v[60:63], v4, s[24:27], s69 offen offset:1024 sc1
 s_mov_b32 s68, 0x80000000
 s_mov_b32 s56, s68
 s_mov_b32 s57, s68
 s_cmp_le_u32 s45, 4
 s_cselect_b32 s40, 3, 1
 s_branch vwe_169
vwx_152:
 s_waitcnt vmcnt(8)
 s_branch vwx_153
vwx_162:
 s_waitcnt vmcnt(8)
 s_branch vwx_163
vwm_154:
 s_mov_b32 s40, 0
 s_waitcnt vmcnt(10)
 s_mov_b64 exec, 1
 v_mov_b32 v20, s45
 buffer_store_dword v20, v10, s[72:75], s44 offen sc1
 s_mov_b64 exec, -1
 s_mov_b32 s70, s45
 s_branch vwm_155
vwm_164:
 s_mov_b32 s40, 0
 s_waitcnt vmcnt(10)
 s_mov_b64 exec, 1
 v_mov_b32 v20, s45
 buffer_store_dword v20, v10, s[72:75], s44 offen sc1
 s_mov_b64 exec, -1
 s_mov_b32 s70, s45
 s_branch vwm_165
vwd_151:
 s_nop 4
 v_cvt_pk_bf16_f32 v44, v104, v105
 v_cvt_pk_bf16_f32 v45, v106, v107
 v_cvt_pk_bf16_f32 v46, v108, v109
 v_cvt_pk_bf16_f32 v47, v110, v111
 s_add_u32 s69, s68, 4096
 buffer_store_dwordx4 v[44:47], v4, s[24:27], s69 offen offset:1024 sc1
 v_cvt_pk_bf16_f32 v48, v112, v113
 v_cvt_pk_bf16_f32 v49, v114, v115
 v_cvt_pk_bf16_f32 v50, v116, v117
 v_cvt_pk_bf16_f32 v51, v118, v119
 buffer_store_dwordx4 v[48:51], v4, s[24:27], s69 offen offset:2048 sc1
 v_cvt_pk_bf16_f32 v52, v120, v121
 v_cvt_pk_bf16_f32 v53, v122, v123
 v_cvt_pk_bf16_f32 v54, v124, v125
 v_cvt_pk_bf16_f32 v55, v126, v127
 buffer_store_dwordx4 v[52:55], v4, s[24:27], s69 offen offset:3072 sc1
 v_cvt_pk_bf16_f32 v56, v128, v129
 v_cvt_pk_bf16_f32 v57, v130, v131
 v_cvt_pk_bf16_f32 v58, v132, v133
 v_cvt_pk_bf16_f32 v59, v134, v135
 s_add_u32 s69, s68, 8192
 buffer_store_dwordx4 v[56:59], v4, s[24:27], s69 offen offset:0 sc1
 v_cvt_pk_bf16_f32 v60, v136, v137
 v_cvt_pk_bf16_f32 v61, v138, v139
 v_cvt_pk_bf16_f32 v62, v140, v141
 v_cvt_pk_bf16_f32 v63, v142, v143
 buffer_store_dwordx4 v[60:63], v4, s[24:27], s69 offen offset:1024 sc1
 s_waitcnt vmcnt(0)
 s_mov_b64 exec, 1
 v_mov_b32 v20, s45
 buffer_store_dword v20, v10, s[72:75], s44 offen sc1
 s_mov_b64 exec, -1
 s_mov_b32 s84, 0
 s_mov_b32 s85, -1
 s_and_b32 s21, s3, 3
 s_sub_u32 s22, s21, 0
 s_lshl_b32 s22, s22, 3
 s_bfe_u32 s87, s3, 0x30002
 s_add_u32 s87, s87, s22
 s_add_u32 s87, s87, 252
 s_cmp_lt_u32 s21, 0
 s_cselect_b32 s87, -1, s87
 s_sub_u32 s21, s3, 64
 s_waitcnt vmcnt(0) lgkmcnt(0)
 s_barrier
 s_branch do_opb2
 s_mov_b32 s84, 0
 s_mov_b32 s85, -1
 s_mov_b32 s86, 0
 s_branch queue
not_vw:
 s_sub_u32 s2, s3, 96
 s_cmp_lg_u32 s2, 31
 s_cbranch_scc1 not_cal
 s_add_u32 s8, s38, 83886079
 s_addc_u32 s9, s39, 0
 s_and_b32 s8, s8, 0xffe00000
 s_mov_b32 s10, 2097152
 s_mov_b32 s11, 0x00020000
 v_lshrrev_b32 v9, 4, v0
 v_mul_u32_u24 v9, 16640, v9
 v_bfe_u32 v10, v0, 3, 1
 v_lshl_add_u32 v9, v10, 13, v9
 v_and_b32 v10, 7, v0
 v_lshl_add_u32 v9, v10, 4, v9
 s_mov_b32 s21, 1048576
 buffer_store_dwordx4 v[4:7], v9, s[8:11], s21 offen sc1
 s_waitcnt vmcnt(0)
 s_barrier
 s_cmp_lg_u32 s20, 3
 s_cbranch_scc1 cal_188
 s_mov_b64 exec, 1
 v_mov_b32 v4, 0
 s_mov_b32 s40, -1
 s_mov_b32 s41, -1
 s_mov_b32 s42, 1048576
 s_mov_b32 s43, 0
 s_waitcnt vmcnt(0)
cal_189:
 s_add_u32 s21, s42, 0
 s_memtime s[98:99]
 s_waitcnt lgkmcnt(0)
 buffer_load_dword v5, v4, s[8:11], s21 offen sc1
 s_waitcnt vmcnt(0)
 s_memtime s[100:101]
 s_waitcnt lgkmcnt(0)
 s_sub_u32 s21, s100, s98
 s_min_u32 s40, s40, s21
 s_add_u32 s21, s42, 8192
 s_memtime s[98:99]
 s_waitcnt lgkmcnt(0)
 buffer_load_dword v5, v4, s[8:11], s21 offen sc1
 s_waitcnt vmcnt(0)
 s_memtime s[100:101]
 s_waitcnt lgkmcnt(0)
 s_sub_u32 s21, s100, s98
 s_min_u32 s41, s41, s21
 s_add_u32 s42, s42, 16640
 s_add_u32 s43, s43, 1
 s_cmp_lt_u32 s43, 4
 s_cbranch_scc1 cal_189
 s_cmp_lt_u32 s41, s40
 s_cselect_b32 s21, 1, 2
 v_mov_b32 v4, s21
 v_mov_b32 v5, s40
 v_mov_b32 v6, s41
 v_mov_b32 v8, 84
 buffer_store_dwordx3 v[4:6], v8, s[32:35], 0 offen sc1
 s_waitcnt vmcnt(0)
 s_mov_b64 exec, -1
cal_188:
 s_barrier
 s_branch armed
not_cal:
armed:
 s_load_dwordx2 s[72:73], s[0:1], 104
 s_waitcnt lgkmcnt(0)
 s_add_u32 s72, s72, 81068032
 s_addc_u32 s73, s73, 0
 s_mov_b32 s74, 129024
 s_mov_b32 s75, 0x00020000
 s_load_dwordx2 s[4:5], s[0:1], 0
 s_load_dwordx2 s[6:7], s[0:1], 64
 s_load_dwordx2 s[38:39], s[0:1], 104
 s_mov_b32 s64, s32
 s_mov_b32 s65, s33
 s_mov_b32 s66, s34
 s_mov_b32 s67, s35
 s_lshr_b32 s41, s2, 1
 s_and_b32 s42, s2, 1
 s_waitcnt lgkmcnt(0)
 s_mov_b32 s8, s4
 s_mov_b32 s9, s5
 s_mov_b32 s10, 2621440
 s_mov_b32 s11, 0x00020000
 s_mov_b32 s12, s6
 s_mov_b32 s13, s7
 s_mov_b32 s14, 2457600
 s_mov_b32 s15, 0x00020000
 s_add_u32 s16, s38, 70713344
 s_addc_u32 s17, s39, 0
 s_mov_b32 s18, 2641920
 s_mov_b32 s19, 0x00020000
 s_add_u32 s72, s38, 81068032
 s_addc_u32 s73, s39, 0
 s_mov_b32 s74, 129024
 s_mov_b32 s75, 0x00020000
 s_lshl_b32 s21, s2, 2
 s_add_u32 s21, s21, s20
 s_mul_i32 s21, s21, 19200
 v_lshlrev_b32 v5, 4, v1
 buffer_load_dwordx4 v[64:67], v5, s[12:15], s21 offen offset:0
 buffer_load_dwordx4 v[64:67], v5, s[12:15], s21 offen offset:1024
 buffer_load_dwordx4 v[64:67], v5, s[12:15], s21 offen offset:2048
 buffer_load_dwordx4 v[64:67], v5, s[12:15], s21 offen offset:3072
 s_add_u32 s21, s21, 4096
 buffer_load_dwordx4 v[64:67], v5, s[12:15], s21 offen offset:0
 buffer_load_dwordx4 v[64:67], v5, s[12:15], s21 offen offset:1024
 buffer_load_dwordx4 v[64:67], v5, s[12:15], s21 offen offset:2048
 buffer_load_dwordx4 v[64:67], v5, s[12:15], s21 offen offset:3072
 s_add_u32 s21, s21, 4096
 buffer_load_dwordx4 v[64:67], v5, s[12:15], s21 offen offset:0
 buffer_load_dwordx4 v[64:67], v5, s[12:15], s21 offen offset:1024
 buffer_load_dwordx4 v[64:67], v5, s[12:15], s21 offen offset:2048
 buffer_load_dwordx4 v[64:67], v5, s[12:15], s21 offen offset:3072
 s_add_u32 s21, s21, 4096
 buffer_load_dwordx4 v[64:67], v5, s[12:15], s21 offen offset:0
 buffer_load_dwordx4 v[64:67], v5, s[12:15], s21 offen offset:1024
 buffer_load_dwordx4 v[64:67], v5, s[12:15], s21 offen offset:2048
 buffer_load_dwordx4 v[64:67], v5, s[12:15], s21 offen offset:3072
 s_add_u32 s21, s21, 4096
 buffer_load_dwordx4 v[64:67], v5, s[12:15], s21 offen offset:0
 buffer_load_dwordx4 v[64:67], v5, s[12:15], s21 offen offset:1024
 buffer_load_dwordx4 v[64:67], v5, s[12:15], s21 offen offset:2048
 s_waitcnt vmcnt(0)
 v_lshlrev_b32 v6, 1, v3
 v_add_u32 v6, 0, v6
 v_xor_b32 v6, v6, v2
 v_min_u32 v6, 14, v6
 v_mul_u32_u24 v7, 52, v6
 v_lshrrev_b32 v7, 8, v7
 v_mul_u32_u24 v7, 1200, v7
 v_lshl_add_u32 v7, v6, 4, v7
 v_mul_u32_u24 v6, 3840, v3
 v_add_u32 v4, v6, v7
 v_lshlrev_b32 v6, 1, v3
 v_add_u32 v6, 8, v6
 v_xor_b32 v6, v6, v2
 v_min_u32 v6, 14, v6
 v_mul_u32_u24 v7, 52, v6
 v_lshrrev_b32 v7, 8, v7
 v_mul_u32_u24 v7, 1200, v7
 v_lshl_add_u32 v7, v6, 4, v7
 v_mul_u32_u24 v6, 3840, v3
 v_add_u32 v5, v6, v7
 s_mul_i32 s21, s41, 80
 s_mul_i32 s22, s20, 15360
 s_add_u32 s21, s21, s22
 s_lshl_b32 s22, s20, 10
 s_cmp_ge_u32 s20, 2
 s_cselect_b64 vcc, -1, 0
 v_cndmask_b32 v4, v4, v5, vcc
 s_add_u32 m0, s22, 0
 s_nop 0
 buffer_load_dwordx4 v4, s[12:15], s21 offen lds
 s_add_u32 s21, s21, 61440
 s_add_u32 m0, s22, 4096
 s_nop 0
 buffer_load_dwordx4 v4, s[12:15], s21 offen lds
 s_add_u32 s21, s21, 61440
 s_add_u32 m0, s22, 8192
 s_nop 0
 buffer_load_dwordx4 v4, s[12:15], s21 offen lds
 s_add_u32 s21, s21, 61440
 s_add_u32 m0, s22, 12288
 s_nop 0
 buffer_load_dwordx4 v4, s[12:15], s21 offen lds
 s_add_u32 s21, s21, 61440
 s_add_u32 m0, s22, 16384
 s_nop 0
 buffer_load_dwordx4 v4, s[12:15], s21 offen lds
 s_add_u32 s21, s21, 61440
 s_add_u32 m0, s22, 20480
 s_nop 0
 buffer_load_dwordx4 v4, s[12:15], s21 offen lds
 s_add_u32 s21, s21, 61440
 s_add_u32 m0, s22, 24576
 s_nop 0
 buffer_load_dwordx4 v4, s[12:15], s21 offen lds
 s_add_u32 s21, s21, 61440
 s_add_u32 m0, s22, 28672
 s_nop 0
 buffer_load_dwordx4 v4, s[12:15], s21 offen lds
 s_add_u32 s21, s21, 61440
 s_add_u32 m0, s22, 32768
 s_nop 0
 buffer_load_dwordx4 v4, s[12:15], s21 offen lds
 s_add_u32 s21, s21, 61440
 s_add_u32 m0, s22, 36864
 s_nop 0
 buffer_load_dwordx4 v4, s[12:15], s21 offen lds
 s_add_u32 s21, s21, 61440
 s_add_u32 m0, s22, 40960
 s_nop 0
 buffer_load_dwordx4 v4, s[12:15], s21 offen lds
 s_add_u32 s21, s21, 61440
 s_add_u32 m0, s22, 45056
 s_nop 0
 buffer_load_dwordx4 v4, s[12:15], s21 offen lds
 s_add_u32 s21, s21, 61440
 s_add_u32 m0, s22, 49152
 s_nop 0
 buffer_load_dwordx4 v4, s[12:15], s21 offen lds
 s_add_u32 s21, s21, 61440
 s_add_u32 m0, s22, 53248
 s_nop 0
 buffer_load_dwordx4 v4, s[12:15], s21 offen lds
 s_add_u32 s21, s21, 61440
 s_add_u32 m0, s22, 57344
 s_nop 0
 buffer_load_dwordx4 v4, s[12:15], s21 offen lds
 s_add_u32 s21, s21, 61440
 s_add_u32 m0, s22, 61440
 s_nop 0
 buffer_load_dwordx4 v4, s[12:15], s21 offen lds
 s_add_u32 s21, s21, 61440
 s_add_u32 m0, s22, 65536
 s_nop 0
 buffer_load_dwordx4 v4, s[12:15], s21 offen lds
 s_add_u32 s21, s21, 61440
 s_add_u32 m0, s22, 69632
 s_nop 0
 buffer_load_dwordx4 v4, s[12:15], s21 offen lds
 s_add_u32 s21, s21, 61440
 s_add_u32 m0, s22, 73728
 s_nop 0
 buffer_load_dwordx4 v4, s[12:15], s21 offen lds
 s_add_u32 s21, s21, 61440
 s_add_u32 m0, s22, 77824
 s_nop 0
 buffer_load_dwordx4 v4, s[12:15], s21 offen lds
 s_add_u32 s21, s21, 61440
 s_add_u32 m0, s22, 81920
 s_nop 0
 buffer_load_dwordx4 v4, s[12:15], s21 offen lds
 s_add_u32 s21, s21, 61440
 s_add_u32 m0, s22, 86016
 s_nop 0
 buffer_load_dwordx4 v4, s[12:15], s21 offen lds
 s_add_u32 s21, s21, 61440
 s_add_u32 m0, s22, 90112
 s_nop 0
 buffer_load_dwordx4 v4, s[12:15], s21 offen lds
 s_add_u32 s21, s21, 61440
 s_add_u32 m0, s22, 94208
 s_nop 0
 buffer_load_dwordx4 v4, s[12:15], s21 offen lds
 s_add_u32 s21, s21, 61440
 s_add_u32 m0, s22, 98304
 s_nop 0
 buffer_load_dwordx4 v4, s[12:15], s21 offen lds
 s_add_u32 s21, s21, 61440
 s_add_u32 m0, s22, 102400
 s_nop 0
 buffer_load_dwordx4 v4, s[12:15], s21 offen lds
 s_add_u32 s21, s21, 61440
 s_add_u32 m0, s22, 106496
 s_nop 0
 buffer_load_dwordx4 v4, s[12:15], s21 offen lds
 s_add_u32 s21, s21, 61440
 s_add_u32 m0, s22, 110592
 s_nop 0
 buffer_load_dwordx4 v4, s[12:15], s21 offen lds
 s_add_u32 s21, s21, 61440
 s_add_u32 m0, s22, 114688
 s_nop 0
 buffer_load_dwordx4 v4, s[12:15], s21 offen lds
 s_add_u32 s21, s21, 61440
 s_add_u32 m0, s22, 118784
 s_nop 0
 buffer_load_dwordx4 v4, s[12:15], s21 offen lds
 s_add_u32 s21, s21, 61440
 s_add_u32 m0, s22, 122880
 s_nop 0
 buffer_load_dwordx4 v4, s[12:15], s21 offen lds
 s_add_u32 s21, s21, 61440
 s_add_u32 m0, s22, 126976
 s_nop 0
 buffer_load_dwordx4 v4, s[12:15], s21 offen lds
 s_add_u32 s21, s21, 61440
 s_add_u32 m0, s22, 131072
 s_nop 0
 buffer_load_dwordx4 v4, s[12:15], s21 offen lds
 s_add_u32 s21, s21, 61440
 s_add_u32 m0, s22, 135168
 s_nop 0
 buffer_load_dwordx4 v4, s[12:15], s21 offen lds
 s_add_u32 s21, s21, 61440
 s_add_u32 m0, s22, 139264
 s_nop 0
 buffer_load_dwordx4 v4, s[12:15], s21 offen lds
 s_add_u32 s21, s21, 61440
 s_add_u32 m0, s22, 143360
 s_nop 0
 buffer_load_dwordx4 v4, s[12:15], s21 offen lds
 s_add_u32 s21, s21, 61440
 s_add_u32 m0, s22, 147456
 s_nop 0
 buffer_load_dwordx4 v4, s[12:15], s21 offen lds
 s_add_u32 s21, s21, 61440
 s_add_u32 m0, s22, 151552
 s_nop 0
 buffer_load_dwordx4 v4, s[12:15], s21 offen lds
 s_add_u32 s21, s21, 61440
 s_add_u32 m0, s22, 155648
 s_nop 0
 buffer_load_dwordx4 v4, s[12:15], s21 offen lds
 s_add_u32 s21, s21, 61440
 s_add_u32 m0, s22, 159744
 s_nop 0
 buffer_load_dwordx4 v4, s[12:15], s21 offen lds
 s_add_u32 s21, s21, 61440
 s_lshl_b32 s21, s2, 2
 s_add_u32 s21, s21, s20
 s_mul_i32 s21, s21, 20480
 v_lshlrev_b32 v5, 4, v1
 buffer_load_dwordx4 v[64:67], v5, s[8:11], s21 offen offset:0
 buffer_load_dwordx4 v[64:67], v5, s[8:11], s21 offen offset:1024
 buffer_load_dwordx4 v[64:67], v5, s[8:11], s21 offen offset:2048
 buffer_load_dwordx4 v[64:67], v5, s[8:11], s21 offen offset:3072
 s_add_u32 s21, s21, 4096
 buffer_load_dwordx4 v[64:67], v5, s[8:11], s21 offen offset:0
 buffer_load_dwordx4 v[64:67], v5, s[8:11], s21 offen offset:1024
 buffer_load_dwordx4 v[64:67], v5, s[8:11], s21 offen offset:2048
 buffer_load_dwordx4 v[64:67], v5, s[8:11], s21 offen offset:3072
 s_add_u32 s21, s21, 4096
 buffer_load_dwordx4 v[64:67], v5, s[8:11], s21 offen offset:0
 buffer_load_dwordx4 v[64:67], v5, s[8:11], s21 offen offset:1024
 buffer_load_dwordx4 v[64:67], v5, s[8:11], s21 offen offset:2048
 buffer_load_dwordx4 v[64:67], v5, s[8:11], s21 offen offset:3072
 s_add_u32 s21, s21, 4096
 buffer_load_dwordx4 v[64:67], v5, s[8:11], s21 offen offset:0
 buffer_load_dwordx4 v[64:67], v5, s[8:11], s21 offen offset:1024
 buffer_load_dwordx4 v[64:67], v5, s[8:11], s21 offen offset:2048
 buffer_load_dwordx4 v[64:67], v5, s[8:11], s21 offen offset:3072
 s_add_u32 s21, s21, 4096
 buffer_load_dwordx4 v[64:67], v5, s[8:11], s21 offen offset:0
 buffer_load_dwordx4 v[64:67], v5, s[8:11], s21 offen offset:1024
 buffer_load_dwordx4 v[64:67], v5, s[8:11], s21 offen offset:2048
 buffer_load_dwordx4 v[64:67], v5, s[8:11], s21 offen offset:3072
 v_lshrrev_b32 v6, 2, v2
 v_lshl_add_u32 v7, v3, 3, v6
 v_and_b32 v8, 1, v3
 v_lshl_add_u32 v6, v8, 2, v6
 v_lshlrev_b32 v6, 1, v6
 v_bfe_u32 v8, v2, 1, 1
 s_lshl_b32 s21, s20, 2
 v_add_u32 v8, s21, v8
 v_and_b32 v9, 1, v2
 v_lshlrev_b32 v9, 3, v9
 v_lshl_add_u32 v9, v7, 8, v9
 v_add_u32 v5, 0, v8
 v_xor_b32 v5, v5, v6
 v_lshl_add_u32 v44, v5, 4, v9
 v_add_u32 v45, 65536, v44
 v_add_u32 v46, 131072, v44
 v_add_u32 v5, 2, v8
 v_xor_b32 v5, v5, v6
 v_lshl_add_u32 v47, v5, 4, v9
 v_add_u32 v48, 65536, v47
 v_add_u32 v49, 131072, v47
 s_waitcnt vmcnt(50) lgkmcnt(0)
 s_barrier
 ds_read_b64_tr_b16 a[0:1], v44 offset:0
 ds_read_b64_tr_b16 a[2:3], v44 offset:1024
 ds_read_b64_tr_b16 a[4:5], v47 offset:0
 ds_read_b64_tr_b16 a[6:7], v47 offset:1024
 ds_read_b64_tr_b16 a[8:9], v44 offset:8192
 ds_read_b64_tr_b16 a[10:11], v44 offset:9216
 ds_read_b64_tr_b16 a[12:13], v47 offset:8192
 ds_read_b64_tr_b16 a[14:15], v47 offset:9216
 ds_read_b64_tr_b16 a[16:17], v44 offset:16384
 ds_read_b64_tr_b16 a[18:19], v44 offset:17408
 ds_read_b64_tr_b16 a[20:21], v47 offset:16384
 ds_read_b64_tr_b16 a[22:23], v47 offset:17408
 ds_read_b64_tr_b16 a[24:25], v44 offset:24576
 ds_read_b64_tr_b16 a[26:27], v44 offset:25600
 ds_read_b64_tr_b16 a[28:29], v47 offset:24576
 ds_read_b64_tr_b16 a[30:31], v47 offset:25600
 ds_read_b64_tr_b16 a[32:33], v44 offset:32768
 ds_read_b64_tr_b16 a[34:35], v44 offset:33792
 ds_read_b64_tr_b16 a[36:37], v47 offset:32768
 ds_read_b64_tr_b16 a[38:39], v47 offset:33792
 s_waitcnt vmcnt(40) lgkmcnt(0)
 s_barrier
 ds_read_b64_tr_b16 a[40:41], v44 offset:40960
 ds_read_b64_tr_b16 a[42:43], v44 offset:41984
 ds_read_b64_tr_b16 a[44:45], v47 offset:40960
 ds_read_b64_tr_b16 a[46:47], v47 offset:41984
 ds_read_b64_tr_b16 a[48:49], v44 offset:49152
 ds_read_b64_tr_b16 a[50:51], v44 offset:50176
 ds_read_b64_tr_b16 a[52:53], v47 offset:49152
 ds_read_b64_tr_b16 a[54:55], v47 offset:50176
 ds_read_b64_tr_b16 a[56:57], v44 offset:57344
 ds_read_b64_tr_b16 a[58:59], v44 offset:58368
 ds_read_b64_tr_b16 a[60:61], v47 offset:57344
 ds_read_b64_tr_b16 a[62:63], v47 offset:58368
 ds_read_b64_tr_b16 a[64:65], v45 offset:0
 ds_read_b64_tr_b16 a[66:67], v45 offset:1024
 ds_read_b64_tr_b16 a[68:69], v48 offset:0
 ds_read_b64_tr_b16 a[70:71], v48 offset:1024
 ds_read_b64_tr_b16 a[72:73], v45 offset:8192
 ds_read_b64_tr_b16 a[74:75], v45 offset:9216
 ds_read_b64_tr_b16 a[76:77], v48 offset:8192
 ds_read_b64_tr_b16 a[78:79], v48 offset:9216
 s_waitcnt vmcnt(30) lgkmcnt(0)
 s_barrier
 s_mul_i32 s24, s42, 1280
 v_lshrrev_b32 v11, 3, v1
 v_and_b32 v12, 7, v1
 v_xor_b32 v12, v12, v11
 v_mul_u32_u24 v11, 2560, v11
 v_lshl_add_u32 v10, v12, 4, v11
 s_mul_i32 s46, s20, 81920
 v_add_u32 v10, s46, v10
 s_lshl_b32 s47, s20, 12
 s_add_u32 s47, s47, 0
 s_add_u32 s46, s47, 114688
 s_mov_b32 s30, s24
 s_add_u32 s32, s47, 0
 v_add_u32 v11, 19456, v10
 v_add_u32 v12, 38912, v10
 v_add_u32 v13, 58368, v10
 s_mov_b32 m0, s32
 s_nop 0
 buffer_load_dwordx4 v10, s[8:11], s30 offen offset:0 lds
 buffer_load_dwordx4 v11, s[8:11], s30 offen offset:1024 lds
 buffer_load_dwordx4 v12, s[8:11], s30 offen offset:2048 lds
 buffer_load_dwordx4 v13, s[8:11], s30 offen offset:3072 lds
 s_add_u32 s30, s30, 128
 s_add_u32 s32, s32, 16384
 s_cmp_lt_u32 s32, s46
 s_cselect_b32 s32, s32, s47
 s_mov_b32 m0, s32
 s_nop 0
 buffer_load_dwordx4 v10, s[8:11], s30 offen offset:0 lds
 buffer_load_dwordx4 v11, s[8:11], s30 offen offset:1024 lds
 buffer_load_dwordx4 v12, s[8:11], s30 offen offset:2048 lds
 buffer_load_dwordx4 v13, s[8:11], s30 offen offset:3072 lds
 s_add_u32 s30, s30, 128
 s_add_u32 s32, s32, 16384
 s_cmp_lt_u32 s32, s46
 s_cselect_b32 s32, s32, s47
 s_mov_b32 m0, s32
 s_nop 0
 buffer_load_dwordx4 v10, s[8:11], s30 offen offset:0 lds
 buffer_load_dwordx4 v11, s[8:11], s30 offen offset:1024 lds
 buffer_load_dwordx4 v12, s[8:11], s30 offen offset:2048 lds
 buffer_load_dwordx4 v13, s[8:11], s30 offen offset:3072 lds
 s_add_u32 s30, s30, 128
 s_add_u32 s32, s32, 16384
 s_cmp_lt_u32 s32, s46
 s_cselect_b32 s32, s32, s47
 s_mov_b32 m0, s32
 s_nop 0
 buffer_load_dwordx4 v10, s[8:11], s30 offen offset:0 lds
 buffer_load_dwordx4 v11, s[8:11], s30 offen offset:1024 lds
 buffer_load_dwordx4 v12, s[8:11], s30 offen offset:2048 lds
 buffer_load_dwordx4 v13, s[8:11], s30 offen offset:3072 lds
 s_add_u32 s30, s30, 128
 s_add_u32 s32, s32, 16384
 s_cmp_lt_u32 s32, s46
 s_cselect_b32 s32, s32, s47
 s_mov_b32 m0, s32
 s_nop 0
 buffer_load_dwordx4 v10, s[8:11], s30 offen offset:0 lds
 buffer_load_dwordx4 v11, s[8:11], s30 offen offset:1024 lds
 buffer_load_dwordx4 v12, s[8:11], s30 offen offset:2048 lds
 buffer_load_dwordx4 v13, s[8:11], s30 offen offset:3072 lds
 s_add_u32 s30, s30, 128
 s_add_u32 s32, s32, 16384
 s_cmp_lt_u32 s32, s46
 s_cselect_b32 s32, s32, s47
 ds_read_b64_tr_b16 a[80:81], v45 offset:16384
 ds_read_b64_tr_b16 a[82:83], v45 offset:17408
 ds_read_b64_tr_b16 a[84:85], v48 offset:16384
 ds_read_b64_tr_b16 a[86:87], v48 offset:17408
 ds_read_b64_tr_b16 a[88:89], v45 offset:24576
 ds_read_b64_tr_b16 a[90:91], v45 offset:25600
 ds_read_b64_tr_b16 a[92:93], v48 offset:24576
 ds_read_b64_tr_b16 a[94:95], v48 offset:25600
 ds_read_b64_tr_b16 a[96:97], v45 offset:32768
 ds_read_b64_tr_b16 a[98:99], v45 offset:33792
 ds_read_b64_tr_b16 a[100:101], v48 offset:32768
 ds_read_b64_tr_b16 a[102:103], v48 offset:33792
 ds_read_b64_tr_b16 a[104:105], v45 offset:40960
 ds_read_b64_tr_b16 a[106:107], v45 offset:41984
 ds_read_b64_tr_b16 a[108:109], v48 offset:40960
 ds_read_b64_tr_b16 a[110:111], v48 offset:41984
 ds_read_b64_tr_b16 a[112:113], v45 offset:49152
 ds_read_b64_tr_b16 a[114:115], v45 offset:50176
 ds_read_b64_tr_b16 a[116:117], v48 offset:49152
 ds_read_b64_tr_b16 a[118:119], v48 offset:50176
 s_waitcnt vmcnt(40) lgkmcnt(0)
 s_barrier
 ds_read_b64_tr_b16 a[120:121], v45 offset:57344
 ds_read_b64_tr_b16 a[122:123], v45 offset:58368
 ds_read_b64_tr_b16 a[124:125], v48 offset:57344
 ds_read_b64_tr_b16 a[126:127], v48 offset:58368
 ds_read_b64_tr_b16 a[128:129], v46 offset:0
 ds_read_b64_tr_b16 a[130:131], v46 offset:1024
 ds_read_b64_tr_b16 a[132:133], v49 offset:0
 ds_read_b64_tr_b16 a[134:135], v49 offset:1024
 ds_read_b64_tr_b16 a[136:137], v46 offset:8192
 ds_read_b64_tr_b16 a[138:139], v46 offset:9216
 ds_read_b64_tr_b16 a[140:141], v49 offset:8192
 ds_read_b64_tr_b16 a[142:143], v49 offset:9216
 ds_read_b64_tr_b16 a[144:145], v46 offset:16384
 ds_read_b64_tr_b16 a[146:147], v46 offset:17408
 ds_read_b64_tr_b16 a[148:149], v49 offset:16384
 ds_read_b64_tr_b16 a[150:151], v49 offset:17408
 ds_read_b64_tr_b16 a[152:153], v46 offset:24576
 ds_read_b64_tr_b16 a[154:155], v46 offset:25600
 ds_read_b64_tr_b16 a[156:157], v49 offset:24576
 ds_read_b64_tr_b16 a[158:159], v49 offset:25600
 s_waitcnt lgkmcnt(0)
 s_barrier
 s_load_dwordx2 s[12:13], s[0:1], 72
 s_lshl_b32 s21, s2, 2
 s_add_u32 s21, s21, s20
 s_mul_i32 s50, s21, 6400
 s_add_u32 s51, s50, 4096
 v_lshlrev_b32 v33, 4, v1
 s_mov_b32 s14, 819200
 v_mov_b32 v32, 76
 s_waitcnt lgkmcnt(0)
 v_and_b32 v4, 31, v1
 s_lshl_b32 s21, s20, 5
 v_add_u32 v36, s21, v4
 v_lshrrev_b32 v5, 5, v1
 v_mul_u32_u24 v6, 264, v36
 v_mul_u32_u24 v7, 40, v5
 s_mov_b32 s21, 114952
 v_add3_u32 v34, v6, v7, s21
 v_lshl_add_u32 v38, v5, 3, v34
 v_lshlrev_b32 v6, 5, v5
 v_sub_u32 v39, v34, v6
 v_lshlrev_b32 v35, 3, v1
 v_add_u32 v35, 114688, v35
 v_mov_b32 v37, 0xf149f2ca
 s_mul_i32 s21, s41, 165120
 s_mul_i32 s22, s42, 16512
 s_add_u32 s21, s21, s22
 v_lshl_add_u32 v7, v36, 4, s21
 v_mul_u32_u24 v6, 99072, v5
 v_add_u32 v29, v6, v7
 v_add_u32 v30, 33024, v29
 v_lshl_add_u32 v31, v5, 3, v7
 v_add_u32 v31, 66048, v31
 v_mov_b32 v8, 0
 v_mov_b32 v9, 0
 ds_write_b64 v35, v[8:9] offset:0
 ds_write_b64 v35, v[8:9] offset:512
 ds_write_b64 v35, v[8:9] offset:1024
 ds_write_b64 v35, v[8:9] offset:1536
 ds_write_b64 v35, v[8:9] offset:2048
 s_mul_i32 s24, s42, 1280
 s_mov_b32 s25, 327680
 s_mov_b32 s26, 8
 s_mov_b32 s27, 0
 s_mov_b32 s60, 0x3e64f92e
 s_mov_b32 s61, 0x3fb8aa3b
 s_mov_b32 s62, 0x05040100
 s_mov_b32 s63, 0x07060302
 v_cmp_le_u32 s[76:77], 0, v36
 v_cmp_le_u32 s[78:79], 1, v36
 v_cmp_le_u32 s[80:81], 2, v36
 v_cmp_le_u32 s[82:83], 3, v36
 v_cmp_le_u32 s[84:85], 4, v36
 v_cmp_le_u32 s[86:87], 5, v36
 v_cmp_le_u32 s[88:89], 6, v36
 v_cmp_le_u32 s[90:91], 7, v36
 v_and_b32 v6, 7, v2
 v_add_u32 v4, 0, v3
 v_xor_b32 v4, v4, v6
 v_lshlrev_b32 v4, 4, v4
 v_lshl_add_u32 v14, v2, 7, v4
 v_add_u32 v4, 4, v3
 v_xor_b32 v4, v4, v6
 v_lshlrev_b32 v4, 4, v4
 v_lshl_add_u32 v15, v2, 7, v4
 v_mul_u32_u24 v22, 264, v2
 v_mul_u32_u24 v4, 8, v3
 s_mul_i32 s21, s20, 64
 s_add_u32 s21, s21, 116800
 v_add3_u32 v22, v22, v4, s21
 v_lshlrev_b32 v4, 3, v3
 v_sub_u32 v16, v22, v4
 v_mov_b32 v9, 2731
 s_mov_b32 s33, 0
 s_mov_b32 s48, 0x80000000
 s_mov_b32 m0, s32
 s_nop 0
 buffer_load_dwordx4 v10, s[8:11], s30 offen offset:0 lds
 buffer_load_dwordx4 v11, s[8:11], s30 offen offset:1024 lds
 s_waitcnt vmcnt(18)
 s_barrier
 v_add_u32 v18, s33, v14
 v_add_u32 v19, s33, v15
 s_add_u32 s33, s33, 16384
 s_cmp_lt_u32 s33, 114688
 s_cselect_b32 s33, s33, 0
 ds_read_b128 v[160:163], v18 offset:0
 ds_read_b128 v[164:167], v18 offset:2048
 ds_read_b128 v[168:171], v18 offset:4096
 ds_read_b128 v[172:175], v18 offset:6144
 ds_read_b128 v[176:179], v18 offset:8192
 ds_read_b128 v[180:183], v18 offset:10240
 ds_read_b128 v[184:187], v18 offset:12288
 ds_read_b128 v[188:191], v18 offset:14336
 s_waitcnt lgkmcnt(0)
bf_blk_190:
 v_mfma_f32_16x16x32_bf16 v[64:67], a[0:3], v[160:163], 0
 ds_read_b128 v[192:195], v19 offset:0
 v_mfma_f32_16x16x32_bf16 v[68:71], a[4:7], v[160:163], 0
 v_add_u32 v18, s33, v14
 v_mfma_f32_16x16x32_bf16 v[72:75], a[0:3], v[164:167], 0
 ds_read_b128 v[196:199], v19 offset:2048
 v_mfma_f32_16x16x32_bf16 v[76:79], a[4:7], v[164:167], 0
 buffer_load_dwordx4 v12, s[8:11], s30 offen offset:2048 lds
 v_mfma_f32_16x16x32_bf16 v[80:83], a[0:3], v[168:171], 0
 ds_read_b128 v[200:203], v19 offset:4096
 v_mfma_f32_16x16x32_bf16 v[84:87], a[4:7], v[168:171], 0
 v_mfma_f32_16x16x32_bf16 v[88:91], a[0:3], v[172:175], 0
 ds_read_b128 v[204:207], v19 offset:6144
 v_mfma_f32_16x16x32_bf16 v[92:95], a[4:7], v[172:175], 0
 s_waitcnt lgkmcnt(14)
 v_mfma_f32_16x16x32_bf16 v[96:99], a[0:3], v[176:179], 0
 ds_read_b128 v[208:211], v19 offset:8192
 v_mfma_f32_16x16x32_bf16 v[100:103], a[4:7], v[176:179], 0
 v_mfma_f32_16x16x32_bf16 v[104:107], a[0:3], v[180:183], 0
 ds_read_b128 v[212:215], v19 offset:10240
 v_mfma_f32_16x16x32_bf16 v[108:111], a[4:7], v[180:183], 0
 buffer_load_dwordx4 v13, s[8:11], s30 offen offset:3072 lds
 v_mfma_f32_16x16x32_bf16 v[112:115], a[0:3], v[184:187], 0
 ds_read_b128 v[216:219], v19 offset:12288
 s_add_u32 s30, s30, 128
 v_mfma_f32_16x16x32_bf16 v[116:119], a[4:7], v[184:187], 0
 s_add_u32 m0, m0, 16384
 v_mfma_f32_16x16x32_bf16 v[120:123], a[0:3], v[188:191], 0
 ds_read_b128 v[220:223], v19 offset:14336
 v_mfma_f32_16x16x32_bf16 v[124:127], a[4:7], v[188:191], 0
 s_waitcnt vmcnt(16) lgkmcnt(4)
 s_barrier
 v_mfma_f32_16x16x32_bf16 v[64:67], a[8:11], v[192:195], v[64:67]
 ds_read_b128 v[160:163], v18 offset:0
 v_mfma_f32_16x16x32_bf16 v[68:71], a[12:15], v[192:195], v[68:71]
 s_cmp_lt_u32 m0, s46
 s_cselect_b32 m0, m0, s47
 v_mfma_f32_16x16x32_bf16 v[72:75], a[8:11], v[196:199], v[72:75]
 ds_read_b128 v[164:167], v18 offset:2048
 v_add_u32 v19, s33, v15
 v_mfma_f32_16x16x32_bf16 v[76:79], a[12:15], v[196:199], v[76:79]
 buffer_load_dwordx4 v10, s[8:11], s30 offen offset:0 lds
 v_mfma_f32_16x16x32_bf16 v[80:83], a[8:11], v[200:203], v[80:83]
 ds_read_b128 v[168:171], v18 offset:4096
 s_add_u32 s33, s33, 16384
 v_mfma_f32_16x16x32_bf16 v[84:87], a[12:15], v[200:203], v[84:87]
 s_cmp_lt_u32 s33, 114688
 s_cselect_b32 s33, s33, 0
 v_mfma_f32_16x16x32_bf16 v[88:91], a[8:11], v[204:207], v[88:91]
 ds_read_b128 v[172:175], v18 offset:6144
 v_mfma_f32_16x16x32_bf16 v[92:95], a[12:15], v[204:207], v[92:95]
 s_waitcnt lgkmcnt(4)
 v_mfma_f32_16x16x32_bf16 v[96:99], a[8:11], v[208:211], v[96:99]
 ds_read_b128 v[176:179], v18 offset:8192
 v_mfma_f32_16x16x32_bf16 v[100:103], a[12:15], v[208:211], v[100:103]
 v_mfma_f32_16x16x32_bf16 v[104:107], a[8:11], v[212:215], v[104:107]
 ds_read_b128 v[180:183], v18 offset:10240
 v_mfma_f32_16x16x32_bf16 v[108:111], a[12:15], v[212:215], v[108:111]
 buffer_load_dwordx4 v11, s[8:11], s30 offen offset:1024 lds
 v_mfma_f32_16x16x32_bf16 v[112:115], a[8:11], v[216:219], v[112:115]
 ds_read_b128 v[184:187], v18 offset:12288
 v_mfma_f32_16x16x32_bf16 v[116:119], a[12:15], v[216:219], v[116:119]
 v_mfma_f32_16x16x32_bf16 v[120:123], a[8:11], v[220:223], v[120:123]
 ds_read_b128 v[188:191], v18 offset:14336
 v_mfma_f32_16x16x32_bf16 v[124:127], a[12:15], v[220:223], v[124:127]
 s_waitcnt lgkmcnt(4)
 v_mfma_f32_16x16x32_bf16 v[64:67], a[16:19], v[160:163], v[64:67]
 ds_read_b128 v[192:195], v19 offset:0
 v_mfma_f32_16x16x32_bf16 v[68:71], a[20:23], v[160:163], v[68:71]
 v_add_u32 v18, s33, v14
 v_mfma_f32_16x16x32_bf16 v[72:75], a[16:19], v[164:167], v[72:75]
 ds_read_b128 v[196:199], v19 offset:2048
 v_mfma_f32_16x16x32_bf16 v[76:79], a[20:23], v[164:167], v[76:79]
 buffer_load_dwordx4 v12, s[8:11], s30 offen offset:2048 lds
 v_mfma_f32_16x16x32_bf16 v[80:83], a[16:19], v[168:171], v[80:83]
 ds_read_b128 v[200:203], v19 offset:4096
 v_mfma_f32_16x16x32_bf16 v[84:87], a[20:23], v[168:171], v[84:87]
 v_mfma_f32_16x16x32_bf16 v[88:91], a[16:19], v[172:175], v[88:91]
 ds_read_b128 v[204:207], v19 offset:6144
 v_mfma_f32_16x16x32_bf16 v[92:95], a[20:23], v[172:175], v[92:95]
 s_waitcnt lgkmcnt(4)
 v_mfma_f32_16x16x32_bf16 v[96:99], a[16:19], v[176:179], v[96:99]
 ds_read_b128 v[208:211], v19 offset:8192
 v_mfma_f32_16x16x32_bf16 v[100:103], a[20:23], v[176:179], v[100:103]
 v_mfma_f32_16x16x32_bf16 v[104:107], a[16:19], v[180:183], v[104:107]
 ds_read_b128 v[212:215], v19 offset:10240
 v_mfma_f32_16x16x32_bf16 v[108:111], a[20:23], v[180:183], v[108:111]
 buffer_load_dwordx4 v13, s[8:11], s30 offen offset:3072 lds
 v_mfma_f32_16x16x32_bf16 v[112:115], a[16:19], v[184:187], v[112:115]
 ds_read_b128 v[216:219], v19 offset:12288
 s_add_u32 s30, s30, 128
 v_mfma_f32_16x16x32_bf16 v[116:119], a[20:23], v[184:187], v[116:119]
 s_add_u32 m0, m0, 16384
 v_mfma_f32_16x16x32_bf16 v[120:123], a[16:19], v[188:191], v[120:123]
 ds_read_b128 v[220:223], v19 offset:14336
 v_mfma_f32_16x16x32_bf16 v[124:127], a[20:23], v[188:191], v[124:127]
 s_waitcnt vmcnt(16) lgkmcnt(4)
 s_barrier
 v_mfma_f32_16x16x32_bf16 v[64:67], a[24:27], v[192:195], v[64:67]
 ds_read_b128 v[160:163], v18 offset:0
 v_mfma_f32_16x16x32_bf16 v[68:71], a[28:31], v[192:195], v[68:71]
 s_cmp_lt_u32 m0, s46
 s_cselect_b32 m0, m0, s47
 v_mfma_f32_16x16x32_bf16 v[72:75], a[24:27], v[196:199], v[72:75]
 ds_read_b128 v[164:167], v18 offset:2048
 v_add_u32 v19, s33, v15
 v_mfma_f32_16x16x32_bf16 v[76:79], a[28:31], v[196:199], v[76:79]
 buffer_load_dwordx4 v10, s[8:11], s30 offen offset:0 lds
 v_mfma_f32_16x16x32_bf16 v[80:83], a[24:27], v[200:203], v[80:83]
 ds_read_b128 v[168:171], v18 offset:4096
 s_add_u32 s33, s33, 16384
 v_mfma_f32_16x16x32_bf16 v[84:87], a[28:31], v[200:203], v[84:87]
 s_cmp_lt_u32 s33, 114688
 s_cselect_b32 s33, s33, 0
 v_mfma_f32_16x16x32_bf16 v[88:91], a[24:27], v[204:207], v[88:91]
 ds_read_b128 v[172:175], v18 offset:6144
 v_mfma_f32_16x16x32_bf16 v[92:95], a[28:31], v[204:207], v[92:95]
 s_waitcnt lgkmcnt(4)
 v_mfma_f32_16x16x32_bf16 v[96:99], a[24:27], v[208:211], v[96:99]
 ds_read_b128 v[176:179], v18 offset:8192
 v_mfma_f32_16x16x32_bf16 v[100:103], a[28:31], v[208:211], v[100:103]
 v_mfma_f32_16x16x32_bf16 v[104:107], a[24:27], v[212:215], v[104:107]
 ds_read_b128 v[180:183], v18 offset:10240
 v_mfma_f32_16x16x32_bf16 v[108:111], a[28:31], v[212:215], v[108:111]
 buffer_load_dwordx4 v11, s[8:11], s30 offen offset:1024 lds
 v_mfma_f32_16x16x32_bf16 v[112:115], a[24:27], v[216:219], v[112:115]
 ds_read_b128 v[184:187], v18 offset:12288
 v_mfma_f32_16x16x32_bf16 v[116:119], a[28:31], v[216:219], v[116:119]
 v_mfma_f32_16x16x32_bf16 v[120:123], a[24:27], v[220:223], v[120:123]
 ds_read_b128 v[188:191], v18 offset:14336
 v_mfma_f32_16x16x32_bf16 v[124:127], a[28:31], v[220:223], v[124:127]
 s_waitcnt lgkmcnt(4)
 v_mfma_f32_16x16x32_bf16 v[64:67], a[32:35], v[160:163], v[64:67]
 ds_read_b128 v[192:195], v19 offset:0
 v_mfma_f32_16x16x32_bf16 v[68:71], a[36:39], v[160:163], v[68:71]
 v_add_u32 v18, s33, v14
 v_mfma_f32_16x16x32_bf16 v[72:75], a[32:35], v[164:167], v[72:75]
 ds_read_b128 v[196:199], v19 offset:2048
 v_mfma_f32_16x16x32_bf16 v[76:79], a[36:39], v[164:167], v[76:79]
 buffer_load_dwordx4 v12, s[8:11], s30 offen offset:2048 lds
 v_mfma_f32_16x16x32_bf16 v[80:83], a[32:35], v[168:171], v[80:83]
 ds_read_b128 v[200:203], v19 offset:4096
 v_mfma_f32_16x16x32_bf16 v[84:87], a[36:39], v[168:171], v[84:87]
 v_mfma_f32_16x16x32_bf16 v[88:91], a[32:35], v[172:175], v[88:91]
 ds_read_b128 v[204:207], v19 offset:6144
 v_mfma_f32_16x16x32_bf16 v[92:95], a[36:39], v[172:175], v[92:95]
 s_waitcnt lgkmcnt(4)
 v_mfma_f32_16x16x32_bf16 v[96:99], a[32:35], v[176:179], v[96:99]
 ds_read_b128 v[208:211], v19 offset:8192
 v_mfma_f32_16x16x32_bf16 v[100:103], a[36:39], v[176:179], v[100:103]
 v_mfma_f32_16x16x32_bf16 v[104:107], a[32:35], v[180:183], v[104:107]
 ds_read_b128 v[212:215], v19 offset:10240
 v_mfma_f32_16x16x32_bf16 v[108:111], a[36:39], v[180:183], v[108:111]
 buffer_load_dwordx4 v13, s[8:11], s30 offen offset:3072 lds
 v_mfma_f32_16x16x32_bf16 v[112:115], a[32:35], v[184:187], v[112:115]
 ds_read_b128 v[216:219], v19 offset:12288
 s_add_u32 s30, s30, 128
 v_mfma_f32_16x16x32_bf16 v[116:119], a[36:39], v[184:187], v[116:119]
 s_add_u32 m0, m0, 16384
 v_mfma_f32_16x16x32_bf16 v[120:123], a[32:35], v[188:191], v[120:123]
 ds_read_b128 v[220:223], v19 offset:14336
 v_mfma_f32_16x16x32_bf16 v[124:127], a[36:39], v[188:191], v[124:127]
 s_waitcnt vmcnt(16) lgkmcnt(4)
 s_barrier
 v_mfma_f32_16x16x32_bf16 v[64:67], a[40:43], v[192:195], v[64:67]
 ds_read_b128 v[160:163], v18 offset:0
 v_mfma_f32_16x16x32_bf16 v[68:71], a[44:47], v[192:195], v[68:71]
 s_cmp_lt_u32 m0, s46
 s_cselect_b32 m0, m0, s47
 v_mfma_f32_16x16x32_bf16 v[72:75], a[40:43], v[196:199], v[72:75]
 ds_read_b128 v[164:167], v18 offset:2048
 v_add_u32 v19, s33, v15
 v_mfma_f32_16x16x32_bf16 v[76:79], a[44:47], v[196:199], v[76:79]
 buffer_load_dwordx4 v10, s[8:11], s30 offen offset:0 lds
 v_mfma_f32_16x16x32_bf16 v[80:83], a[40:43], v[200:203], v[80:83]
 ds_read_b128 v[168:171], v18 offset:4096
 s_add_u32 s33, s33, 16384
 v_mfma_f32_16x16x32_bf16 v[84:87], a[44:47], v[200:203], v[84:87]
 s_cmp_lt_u32 s33, 114688
 s_cselect_b32 s33, s33, 0
 v_mfma_f32_16x16x32_bf16 v[88:91], a[40:43], v[204:207], v[88:91]
 ds_read_b128 v[172:175], v18 offset:6144
 v_mfma_f32_16x16x32_bf16 v[92:95], a[44:47], v[204:207], v[92:95]
 s_waitcnt lgkmcnt(4)
 v_mfma_f32_16x16x32_bf16 v[96:99], a[40:43], v[208:211], v[96:99]
 ds_read_b128 v[176:179], v18 offset:8192
 v_mfma_f32_16x16x32_bf16 v[100:103], a[44:47], v[208:211], v[100:103]
 v_mfma_f32_16x16x32_bf16 v[104:107], a[40:43], v[212:215], v[104:107]
 ds_read_b128 v[180:183], v18 offset:10240
 v_mfma_f32_16x16x32_bf16 v[108:111], a[44:47], v[212:215], v[108:111]
 buffer_load_dwordx4 v11, s[8:11], s30 offen offset:1024 lds
 v_mfma_f32_16x16x32_bf16 v[112:115], a[40:43], v[216:219], v[112:115]
 ds_read_b128 v[184:187], v18 offset:12288
 v_mfma_f32_16x16x32_bf16 v[116:119], a[44:47], v[216:219], v[116:119]
 v_mfma_f32_16x16x32_bf16 v[120:123], a[40:43], v[220:223], v[120:123]
 ds_read_b128 v[188:191], v18 offset:14336
 v_mfma_f32_16x16x32_bf16 v[124:127], a[44:47], v[220:223], v[124:127]
 s_waitcnt lgkmcnt(4)
 v_mfma_f32_16x16x32_bf16 v[64:67], a[48:51], v[160:163], v[64:67]
 ds_read_b128 v[192:195], v19 offset:0
 v_mfma_f32_16x16x32_bf16 v[68:71], a[52:55], v[160:163], v[68:71]
 v_add_u32 v18, s33, v14
 v_mfma_f32_16x16x32_bf16 v[72:75], a[48:51], v[164:167], v[72:75]
 ds_read_b128 v[196:199], v19 offset:2048
 v_mfma_f32_16x16x32_bf16 v[76:79], a[52:55], v[164:167], v[76:79]
 buffer_load_dwordx4 v12, s[8:11], s30 offen offset:2048 lds
 v_mfma_f32_16x16x32_bf16 v[80:83], a[48:51], v[168:171], v[80:83]
 ds_read_b128 v[200:203], v19 offset:4096
 v_mfma_f32_16x16x32_bf16 v[84:87], a[52:55], v[168:171], v[84:87]
 v_mfma_f32_16x16x32_bf16 v[88:91], a[48:51], v[172:175], v[88:91]
 ds_read_b128 v[204:207], v19 offset:6144
 v_mfma_f32_16x16x32_bf16 v[92:95], a[52:55], v[172:175], v[92:95]
 s_waitcnt lgkmcnt(4)
 v_mfma_f32_16x16x32_bf16 v[96:99], a[48:51], v[176:179], v[96:99]
 ds_read_b128 v[208:211], v19 offset:8192
 v_mfma_f32_16x16x32_bf16 v[100:103], a[52:55], v[176:179], v[100:103]
 v_mfma_f32_16x16x32_bf16 v[104:107], a[48:51], v[180:183], v[104:107]
 ds_read_b128 v[212:215], v19 offset:10240
 v_mfma_f32_16x16x32_bf16 v[108:111], a[52:55], v[180:183], v[108:111]
 buffer_load_dwordx4 v13, s[8:11], s30 offen offset:3072 lds
 v_mfma_f32_16x16x32_bf16 v[112:115], a[48:51], v[184:187], v[112:115]
 ds_read_b128 v[216:219], v19 offset:12288
 s_add_u32 s30, s30, 128
 v_mfma_f32_16x16x32_bf16 v[116:119], a[52:55], v[184:187], v[116:119]
 s_add_u32 m0, m0, 16384
 v_mfma_f32_16x16x32_bf16 v[120:123], a[48:51], v[188:191], v[120:123]
 ds_read_b128 v[220:223], v19 offset:14336
 v_mfma_f32_16x16x32_bf16 v[124:127], a[52:55], v[188:191], v[124:127]
 s_waitcnt vmcnt(16) lgkmcnt(4)
 s_barrier
 v_mfma_f32_16x16x32_bf16 v[64:67], a[56:59], v[192:195], v[64:67]
 ds_read_b128 v[160:163], v18 offset:0
 v_mfma_f32_16x16x32_bf16 v[68:71], a[60:63], v[192:195], v[68:71]
 s_cmp_lt_u32 m0, s46
 s_cselect_b32 m0, m0, s47
 v_mfma_f32_16x16x32_bf16 v[72:75], a[56:59], v[196:199], v[72:75]
 ds_read_b128 v[164:167], v18 offset:2048
 v_add_u32 v19, s33, v15
 v_mfma_f32_16x16x32_bf16 v[76:79], a[60:63], v[196:199], v[76:79]
 buffer_load_dwordx4 v10, s[8:11], s30 offen offset:0 lds
 v_mfma_f32_16x16x32_bf16 v[80:83], a[56:59], v[200:203], v[80:83]
 ds_read_b128 v[168:171], v18 offset:4096
 s_add_u32 s33, s33, 16384
 v_mfma_f32_16x16x32_bf16 v[84:87], a[60:63], v[200:203], v[84:87]
 s_cmp_lt_u32 s33, 114688
 s_cselect_b32 s33, s33, 0
 v_mfma_f32_16x16x32_bf16 v[88:91], a[56:59], v[204:207], v[88:91]
 ds_read_b128 v[172:175], v18 offset:6144
 v_mfma_f32_16x16x32_bf16 v[92:95], a[60:63], v[204:207], v[92:95]
 s_waitcnt lgkmcnt(4)
 v_mfma_f32_16x16x32_bf16 v[96:99], a[56:59], v[208:211], v[96:99]
 ds_read_b128 v[176:179], v18 offset:8192
 v_mfma_f32_16x16x32_bf16 v[100:103], a[60:63], v[208:211], v[100:103]
 v_mfma_f32_16x16x32_bf16 v[104:107], a[56:59], v[212:215], v[104:107]
 ds_read_b128 v[180:183], v18 offset:10240
 v_mfma_f32_16x16x32_bf16 v[108:111], a[60:63], v[212:215], v[108:111]
 buffer_load_dwordx4 v11, s[8:11], s30 offen offset:1024 lds
 v_mfma_f32_16x16x32_bf16 v[112:115], a[56:59], v[216:219], v[112:115]
 ds_read_b128 v[184:187], v18 offset:12288
 v_mfma_f32_16x16x32_bf16 v[116:119], a[60:63], v[216:219], v[116:119]
 v_mfma_f32_16x16x32_bf16 v[120:123], a[56:59], v[220:223], v[120:123]
 ds_read_b128 v[188:191], v18 offset:14336
 v_mfma_f32_16x16x32_bf16 v[124:127], a[60:63], v[220:223], v[124:127]
 s_waitcnt lgkmcnt(4)
 v_mfma_f32_16x16x32_bf16 v[64:67], a[64:67], v[160:163], v[64:67]
 ds_read_b128 v[192:195], v19 offset:0
 v_mfma_f32_16x16x32_bf16 v[68:71], a[68:71], v[160:163], v[68:71]
 v_add_u32 v18, s33, v14
 v_mfma_f32_16x16x32_bf16 v[72:75], a[64:67], v[164:167], v[72:75]
 ds_read_b128 v[196:199], v19 offset:2048
 v_mfma_f32_16x16x32_bf16 v[76:79], a[68:71], v[164:167], v[76:79]
 buffer_load_dwordx4 v12, s[8:11], s30 offen offset:2048 lds
 v_mfma_f32_16x16x32_bf16 v[80:83], a[64:67], v[168:171], v[80:83]
 ds_read_b128 v[200:203], v19 offset:4096
 v_mfma_f32_16x16x32_bf16 v[84:87], a[68:71], v[168:171], v[84:87]
 v_mfma_f32_16x16x32_bf16 v[88:91], a[64:67], v[172:175], v[88:91]
 ds_read_b128 v[204:207], v19 offset:6144
 v_mfma_f32_16x16x32_bf16 v[92:95], a[68:71], v[172:175], v[92:95]
 s_waitcnt lgkmcnt(4)
 v_mfma_f32_16x16x32_bf16 v[96:99], a[64:67], v[176:179], v[96:99]
 ds_read_b128 v[208:211], v19 offset:8192
 v_mfma_f32_16x16x32_bf16 v[100:103], a[68:71], v[176:179], v[100:103]
 v_mfma_f32_16x16x32_bf16 v[104:107], a[64:67], v[180:183], v[104:107]
 ds_read_b128 v[212:215], v19 offset:10240
 v_mfma_f32_16x16x32_bf16 v[108:111], a[68:71], v[180:183], v[108:111]
 buffer_load_dwordx4 v13, s[8:11], s30 offen offset:3072 lds
 v_mfma_f32_16x16x32_bf16 v[112:115], a[64:67], v[184:187], v[112:115]
 ds_read_b128 v[216:219], v19 offset:12288
 s_add_u32 s30, s30, s25
 v_mfma_f32_16x16x32_bf16 v[116:119], a[68:71], v[184:187], v[116:119]
 s_sub_u32 s30, s30, 1152
 s_add_u32 m0, m0, 16384
 v_mfma_f32_16x16x32_bf16 v[120:123], a[64:67], v[188:191], v[120:123]
 ds_read_b128 v[220:223], v19 offset:14336
 v_mfma_f32_16x16x32_bf16 v[124:127], a[68:71], v[188:191], v[124:127]
 s_waitcnt vmcnt(16) lgkmcnt(4)
 s_barrier
 v_mfma_f32_16x16x32_bf16 v[64:67], a[72:75], v[192:195], v[64:67]
 ds_read_b128 v[160:163], v18 offset:0
 v_mfma_f32_16x16x32_bf16 v[68:71], a[76:79], v[192:195], v[68:71]
 s_cmp_lt_u32 m0, s46
 s_cselect_b32 m0, m0, s47
 v_mfma_f32_16x16x32_bf16 v[72:75], a[72:75], v[196:199], v[72:75]
 ds_read_b128 v[164:167], v18 offset:2048
 v_add_u32 v19, s33, v15
 v_mfma_f32_16x16x32_bf16 v[76:79], a[76:79], v[196:199], v[76:79]
 buffer_load_dwordx4 v10, s[8:11], s30 offen offset:0 lds
 v_mfma_f32_16x16x32_bf16 v[80:83], a[72:75], v[200:203], v[80:83]
 ds_read_b128 v[168:171], v18 offset:4096
 s_add_u32 s33, s33, 16384
 v_mfma_f32_16x16x32_bf16 v[84:87], a[76:79], v[200:203], v[84:87]
 s_cmp_lt_u32 s33, 114688
 s_cselect_b32 s33, s33, 0
 v_mfma_f32_16x16x32_bf16 v[88:91], a[72:75], v[204:207], v[88:91]
 ds_read_b128 v[172:175], v18 offset:6144
 v_mfma_f32_16x16x32_bf16 v[92:95], a[76:79], v[204:207], v[92:95]
 s_waitcnt lgkmcnt(4)
 v_mfma_f32_16x16x32_bf16 v[96:99], a[72:75], v[208:211], v[96:99]
 ds_read_b128 v[176:179], v18 offset:8192
 v_mfma_f32_16x16x32_bf16 v[100:103], a[76:79], v[208:211], v[100:103]
 v_mfma_f32_16x16x32_bf16 v[104:107], a[72:75], v[212:215], v[104:107]
 ds_read_b128 v[180:183], v18 offset:10240
 v_mfma_f32_16x16x32_bf16 v[108:111], a[76:79], v[212:215], v[108:111]
 buffer_load_dwordx4 v11, s[8:11], s30 offen offset:1024 lds
 v_mfma_f32_16x16x32_bf16 v[112:115], a[72:75], v[216:219], v[112:115]
 ds_read_b128 v[184:187], v18 offset:12288
 v_mfma_f32_16x16x32_bf16 v[116:119], a[76:79], v[216:219], v[116:119]
 v_mfma_f32_16x16x32_bf16 v[120:123], a[72:75], v[220:223], v[120:123]
 ds_read_b128 v[188:191], v18 offset:14336
 v_mfma_f32_16x16x32_bf16 v[124:127], a[76:79], v[220:223], v[124:127]
 s_waitcnt lgkmcnt(4)
 v_mfma_f32_16x16x32_bf16 v[64:67], a[80:83], v[160:163], v[64:67]
 ds_read_b128 v[192:195], v19 offset:0
 v_mfma_f32_16x16x32_bf16 v[68:71], a[84:87], v[160:163], v[68:71]
 v_add_u32 v18, s33, v14
 v_mfma_f32_16x16x32_bf16 v[72:75], a[80:83], v[164:167], v[72:75]
 ds_read_b128 v[196:199], v19 offset:2048
 v_mfma_f32_16x16x32_bf16 v[76:79], a[84:87], v[164:167], v[76:79]
 buffer_load_dwordx4 v12, s[8:11], s30 offen offset:2048 lds
 v_mfma_f32_16x16x32_bf16 v[80:83], a[80:83], v[168:171], v[80:83]
 ds_read_b128 v[200:203], v19 offset:4096
 v_mfma_f32_16x16x32_bf16 v[84:87], a[84:87], v[168:171], v[84:87]
 v_mfma_f32_16x16x32_bf16 v[88:91], a[80:83], v[172:175], v[88:91]
 ds_read_b128 v[204:207], v19 offset:6144
 v_mfma_f32_16x16x32_bf16 v[92:95], a[84:87], v[172:175], v[92:95]
 s_waitcnt lgkmcnt(4)
 v_mfma_f32_16x16x32_bf16 v[96:99], a[80:83], v[176:179], v[96:99]
 ds_read_b128 v[208:211], v19 offset:8192
 v_mfma_f32_16x16x32_bf16 v[100:103], a[84:87], v[176:179], v[100:103]
 v_mfma_f32_16x16x32_bf16 v[104:107], a[80:83], v[180:183], v[104:107]
 ds_read_b128 v[212:215], v19 offset:10240
 v_mfma_f32_16x16x32_bf16 v[108:111], a[84:87], v[180:183], v[108:111]
 buffer_load_dwordx4 v13, s[8:11], s30 offen offset:3072 lds
 v_mfma_f32_16x16x32_bf16 v[112:115], a[80:83], v[184:187], v[112:115]
 ds_read_b128 v[216:219], v19 offset:12288
 s_add_u32 s30, s30, 128
 v_mfma_f32_16x16x32_bf16 v[116:119], a[84:87], v[184:187], v[116:119]
 s_add_u32 m0, m0, 16384
 v_mfma_f32_16x16x32_bf16 v[120:123], a[80:83], v[188:191], v[120:123]
 ds_read_b128 v[220:223], v19 offset:14336
 v_mfma_f32_16x16x32_bf16 v[124:127], a[84:87], v[188:191], v[124:127]
 s_waitcnt vmcnt(16) lgkmcnt(4)
 s_barrier
 v_mfma_f32_16x16x32_bf16 v[64:67], a[88:91], v[192:195], v[64:67]
 ds_read_b128 v[160:163], v18 offset:0
 v_mfma_f32_16x16x32_bf16 v[68:71], a[92:95], v[192:195], v[68:71]
 s_cmp_lt_u32 m0, s46
 s_cselect_b32 m0, m0, s47
 v_mfma_f32_16x16x32_bf16 v[72:75], a[88:91], v[196:199], v[72:75]
 ds_read_b128 v[164:167], v18 offset:2048
 v_add_u32 v19, s33, v15
 v_mfma_f32_16x16x32_bf16 v[76:79], a[92:95], v[196:199], v[76:79]
 buffer_load_dwordx4 v10, s[8:11], s30 offen offset:0 lds
 v_mfma_f32_16x16x32_bf16 v[80:83], a[88:91], v[200:203], v[80:83]
 ds_read_b128 v[168:171], v18 offset:4096
 s_add_u32 s33, s33, 16384
 v_mfma_f32_16x16x32_bf16 v[84:87], a[92:95], v[200:203], v[84:87]
 s_cmp_lt_u32 s33, 114688
 s_cselect_b32 s33, s33, 0
 v_mfma_f32_16x16x32_bf16 v[88:91], a[88:91], v[204:207], v[88:91]
 ds_read_b128 v[172:175], v18 offset:6144
 v_mfma_f32_16x16x32_bf16 v[92:95], a[92:95], v[204:207], v[92:95]
 s_waitcnt lgkmcnt(4)
 v_mfma_f32_16x16x32_bf16 v[96:99], a[88:91], v[208:211], v[96:99]
 ds_read_b128 v[176:179], v18 offset:8192
 v_mfma_f32_16x16x32_bf16 v[100:103], a[92:95], v[208:211], v[100:103]
 v_mfma_f32_16x16x32_bf16 v[104:107], a[88:91], v[212:215], v[104:107]
 ds_read_b128 v[180:183], v18 offset:10240
 v_mfma_f32_16x16x32_bf16 v[108:111], a[92:95], v[212:215], v[108:111]
 buffer_load_dwordx4 v11, s[8:11], s30 offen offset:1024 lds
 v_mfma_f32_16x16x32_bf16 v[112:115], a[88:91], v[216:219], v[112:115]
 ds_read_b128 v[184:187], v18 offset:12288
 v_mfma_f32_16x16x32_bf16 v[116:119], a[92:95], v[216:219], v[116:119]
 v_mfma_f32_16x16x32_bf16 v[120:123], a[88:91], v[220:223], v[120:123]
 ds_read_b128 v[188:191], v18 offset:14336
 v_mfma_f32_16x16x32_bf16 v[124:127], a[92:95], v[220:223], v[124:127]
 s_waitcnt lgkmcnt(4)
 v_mfma_f32_16x16x32_bf16 v[64:67], a[96:99], v[160:163], v[64:67]
 ds_read_b128 v[192:195], v19 offset:0
 v_mfma_f32_16x16x32_bf16 v[68:71], a[100:103], v[160:163], v[68:71]
 v_add_u32 v18, s33, v14
 v_mfma_f32_16x16x32_bf16 v[72:75], a[96:99], v[164:167], v[72:75]
 ds_read_b128 v[196:199], v19 offset:2048
 v_mfma_f32_16x16x32_bf16 v[76:79], a[100:103], v[164:167], v[76:79]
 buffer_load_dwordx4 v12, s[8:11], s30 offen offset:2048 lds
 v_mfma_f32_16x16x32_bf16 v[80:83], a[96:99], v[168:171], v[80:83]
 ds_read_b128 v[200:203], v19 offset:4096
 v_mfma_f32_16x16x32_bf16 v[84:87], a[100:103], v[168:171], v[84:87]
 v_mfma_f32_16x16x32_bf16 v[88:91], a[96:99], v[172:175], v[88:91]
 ds_read_b128 v[204:207], v19 offset:6144
 v_mfma_f32_16x16x32_bf16 v[92:95], a[100:103], v[172:175], v[92:95]
 s_waitcnt lgkmcnt(4)
 v_mfma_f32_16x16x32_bf16 v[96:99], a[96:99], v[176:179], v[96:99]
 ds_read_b128 v[208:211], v19 offset:8192
 v_mfma_f32_16x16x32_bf16 v[100:103], a[100:103], v[176:179], v[100:103]
 v_mfma_f32_16x16x32_bf16 v[104:107], a[96:99], v[180:183], v[104:107]
 ds_read_b128 v[212:215], v19 offset:10240
 v_mfma_f32_16x16x32_bf16 v[108:111], a[100:103], v[180:183], v[108:111]
 buffer_load_dwordx4 v13, s[8:11], s30 offen offset:3072 lds
 v_mfma_f32_16x16x32_bf16 v[112:115], a[96:99], v[184:187], v[112:115]
 ds_read_b128 v[216:219], v19 offset:12288
 s_add_u32 s30, s30, 128
 v_mfma_f32_16x16x32_bf16 v[116:119], a[100:103], v[184:187], v[116:119]
 s_add_u32 m0, m0, 16384
 v_mfma_f32_16x16x32_bf16 v[120:123], a[96:99], v[188:191], v[120:123]
 ds_read_b128 v[220:223], v19 offset:14336
 v_mfma_f32_16x16x32_bf16 v[124:127], a[100:103], v[188:191], v[124:127]
 s_waitcnt vmcnt(16) lgkmcnt(4)
 s_barrier
 v_mfma_f32_16x16x32_bf16 v[64:67], a[104:107], v[192:195], v[64:67]
 ds_read_b128 v[160:163], v18 offset:0
 v_mfma_f32_16x16x32_bf16 v[68:71], a[108:111], v[192:195], v[68:71]
 s_cmp_lt_u32 m0, s46
 s_cselect_b32 m0, m0, s47
 v_mfma_f32_16x16x32_bf16 v[72:75], a[104:107], v[196:199], v[72:75]
 ds_read_b128 v[164:167], v18 offset:2048
 v_add_u32 v19, s33, v15
 v_mfma_f32_16x16x32_bf16 v[76:79], a[108:111], v[196:199], v[76:79]
 buffer_load_dwordx4 v10, s[8:11], s30 offen offset:0 lds
 v_mfma_f32_16x16x32_bf16 v[80:83], a[104:107], v[200:203], v[80:83]
 ds_read_b128 v[168:171], v18 offset:4096
 s_add_u32 s33, s33, 16384
 v_mfma_f32_16x16x32_bf16 v[84:87], a[108:111], v[200:203], v[84:87]
 s_cmp_lt_u32 s33, 114688
 s_cselect_b32 s33, s33, 0
 v_mfma_f32_16x16x32_bf16 v[88:91], a[104:107], v[204:207], v[88:91]
 ds_read_b128 v[172:175], v18 offset:6144
 v_mfma_f32_16x16x32_bf16 v[92:95], a[108:111], v[204:207], v[92:95]
 s_waitcnt lgkmcnt(4)
 v_mfma_f32_16x16x32_bf16 v[96:99], a[104:107], v[208:211], v[96:99]
 ds_read_b128 v[176:179], v18 offset:8192
 v_mfma_f32_16x16x32_bf16 v[100:103], a[108:111], v[208:211], v[100:103]
 v_mfma_f32_16x16x32_bf16 v[104:107], a[104:107], v[212:215], v[104:107]
 ds_read_b128 v[180:183], v18 offset:10240
 v_mfma_f32_16x16x32_bf16 v[108:111], a[108:111], v[212:215], v[108:111]
 buffer_load_dwordx4 v11, s[8:11], s30 offen offset:1024 lds
 v_mfma_f32_16x16x32_bf16 v[112:115], a[104:107], v[216:219], v[112:115]
 ds_read_b128 v[184:187], v18 offset:12288
 v_mfma_f32_16x16x32_bf16 v[116:119], a[108:111], v[216:219], v[116:119]
 v_mfma_f32_16x16x32_bf16 v[120:123], a[104:107], v[220:223], v[120:123]
 ds_read_b128 v[188:191], v18 offset:14336
 v_mfma_f32_16x16x32_bf16 v[124:127], a[108:111], v[220:223], v[124:127]
 s_waitcnt lgkmcnt(4)
 v_mfma_f32_16x16x32_bf16 v[64:67], a[112:115], v[160:163], v[64:67]
 ds_read_b128 v[192:195], v19 offset:0
 v_mfma_f32_16x16x32_bf16 v[68:71], a[116:119], v[160:163], v[68:71]
 v_add_u32 v18, s33, v14
 v_mfma_f32_16x16x32_bf16 v[72:75], a[112:115], v[164:167], v[72:75]
 ds_read_b128 v[196:199], v19 offset:2048
 v_mfma_f32_16x16x32_bf16 v[76:79], a[116:119], v[164:167], v[76:79]
 buffer_load_dwordx4 v12, s[8:11], s30 offen offset:2048 lds
 v_mfma_f32_16x16x32_bf16 v[80:83], a[112:115], v[168:171], v[80:83]
 ds_read_b128 v[200:203], v19 offset:4096
 v_mfma_f32_16x16x32_bf16 v[84:87], a[116:119], v[168:171], v[84:87]
 v_mfma_f32_16x16x32_bf16 v[88:91], a[112:115], v[172:175], v[88:91]
 ds_read_b128 v[204:207], v19 offset:6144
 v_mfma_f32_16x16x32_bf16 v[92:95], a[116:119], v[172:175], v[92:95]
 s_waitcnt lgkmcnt(4)
 v_mfma_f32_16x16x32_bf16 v[96:99], a[112:115], v[176:179], v[96:99]
 ds_read_b128 v[208:211], v19 offset:8192
 v_mfma_f32_16x16x32_bf16 v[100:103], a[116:119], v[176:179], v[100:103]
 v_mfma_f32_16x16x32_bf16 v[104:107], a[112:115], v[180:183], v[104:107]
 ds_read_b128 v[212:215], v19 offset:10240
 v_mfma_f32_16x16x32_bf16 v[108:111], a[116:119], v[180:183], v[108:111]
 buffer_load_dwordx4 v13, s[8:11], s30 offen offset:3072 lds
 v_mfma_f32_16x16x32_bf16 v[112:115], a[112:115], v[184:187], v[112:115]
 ds_read_b128 v[216:219], v19 offset:12288
 s_add_u32 s30, s30, 128
 v_mfma_f32_16x16x32_bf16 v[116:119], a[116:119], v[184:187], v[116:119]
 s_add_u32 m0, m0, 16384
 v_mfma_f32_16x16x32_bf16 v[120:123], a[112:115], v[188:191], v[120:123]
 ds_read_b128 v[220:223], v19 offset:14336
 v_mfma_f32_16x16x32_bf16 v[124:127], a[116:119], v[188:191], v[124:127]
 s_waitcnt vmcnt(16) lgkmcnt(4)
 s_barrier
 v_mfma_f32_16x16x32_bf16 v[64:67], a[120:123], v[192:195], v[64:67]
 ds_read_b128 v[160:163], v18 offset:0
 v_mfma_f32_16x16x32_bf16 v[68:71], a[124:127], v[192:195], v[68:71]
 s_cmp_lt_u32 m0, s46
 s_cselect_b32 m0, m0, s47
 v_mfma_f32_16x16x32_bf16 v[72:75], a[120:123], v[196:199], v[72:75]
 ds_read_b128 v[164:167], v18 offset:2048
 v_add_u32 v19, s33, v15
 v_mfma_f32_16x16x32_bf16 v[76:79], a[124:127], v[196:199], v[76:79]
 buffer_load_dwordx4 v10, s[8:11], s30 offen offset:0 lds
 v_mfma_f32_16x16x32_bf16 v[80:83], a[120:123], v[200:203], v[80:83]
 ds_read_b128 v[168:171], v18 offset:4096
 s_add_u32 s33, s33, 16384
 v_mfma_f32_16x16x32_bf16 v[84:87], a[124:127], v[200:203], v[84:87]
 s_cmp_lt_u32 s33, 114688
 s_cselect_b32 s33, s33, 0
 v_mfma_f32_16x16x32_bf16 v[88:91], a[120:123], v[204:207], v[88:91]
 ds_read_b128 v[172:175], v18 offset:6144
 v_mfma_f32_16x16x32_bf16 v[92:95], a[124:127], v[204:207], v[92:95]
 s_waitcnt lgkmcnt(4)
 v_mfma_f32_16x16x32_bf16 v[96:99], a[120:123], v[208:211], v[96:99]
 ds_read_b128 v[176:179], v18 offset:8192
 v_mfma_f32_16x16x32_bf16 v[100:103], a[124:127], v[208:211], v[100:103]
 v_mfma_f32_16x16x32_bf16 v[104:107], a[120:123], v[212:215], v[104:107]
 ds_read_b128 v[180:183], v18 offset:10240
 v_mfma_f32_16x16x32_bf16 v[108:111], a[124:127], v[212:215], v[108:111]
 buffer_load_dwordx4 v11, s[8:11], s30 offen offset:1024 lds
 v_mfma_f32_16x16x32_bf16 v[112:115], a[120:123], v[216:219], v[112:115]
 ds_read_b128 v[184:187], v18 offset:12288
 v_mfma_f32_16x16x32_bf16 v[116:119], a[124:127], v[216:219], v[116:119]
 v_mfma_f32_16x16x32_bf16 v[120:123], a[120:123], v[220:223], v[120:123]
 ds_read_b128 v[188:191], v18 offset:14336
 v_mfma_f32_16x16x32_bf16 v[124:127], a[124:127], v[220:223], v[124:127]
 s_waitcnt lgkmcnt(4)
 v_mfma_f32_16x16x32_bf16 v[64:67], a[128:131], v[160:163], v[64:67]
 ds_read_b128 v[192:195], v19 offset:0
 v_mfma_f32_16x16x32_bf16 v[68:71], a[132:135], v[160:163], v[68:71]
 v_add_u32 v18, s33, v14
 v_mfma_f32_16x16x32_bf16 v[72:75], a[128:131], v[164:167], v[72:75]
 ds_read_b128 v[196:199], v19 offset:2048
 v_mfma_f32_16x16x32_bf16 v[76:79], a[132:135], v[164:167], v[76:79]
 buffer_load_dwordx4 v12, s[8:11], s30 offen offset:2048 lds
 v_mfma_f32_16x16x32_bf16 v[80:83], a[128:131], v[168:171], v[80:83]
 ds_read_b128 v[200:203], v19 offset:4096
 v_mfma_f32_16x16x32_bf16 v[84:87], a[132:135], v[168:171], v[84:87]
 v_mfma_f32_16x16x32_bf16 v[88:91], a[128:131], v[172:175], v[88:91]
 ds_read_b128 v[204:207], v19 offset:6144
 v_mfma_f32_16x16x32_bf16 v[92:95], a[132:135], v[172:175], v[92:95]
 s_waitcnt lgkmcnt(4)
 v_mfma_f32_16x16x32_bf16 v[96:99], a[128:131], v[176:179], v[96:99]
 ds_read_b128 v[208:211], v19 offset:8192
 v_mfma_f32_16x16x32_bf16 v[100:103], a[132:135], v[176:179], v[100:103]
 v_mfma_f32_16x16x32_bf16 v[104:107], a[128:131], v[180:183], v[104:107]
 ds_read_b128 v[212:215], v19 offset:10240
 v_mfma_f32_16x16x32_bf16 v[108:111], a[132:135], v[180:183], v[108:111]
 buffer_load_dwordx4 v13, s[8:11], s30 offen offset:3072 lds
 v_mfma_f32_16x16x32_bf16 v[112:115], a[128:131], v[184:187], v[112:115]
 ds_read_b128 v[216:219], v19 offset:12288
 s_add_u32 s30, s30, 128
 v_mfma_f32_16x16x32_bf16 v[116:119], a[132:135], v[184:187], v[116:119]
 s_add_u32 m0, m0, 16384
 v_mfma_f32_16x16x32_bf16 v[120:123], a[128:131], v[188:191], v[120:123]
 ds_read_b128 v[220:223], v19 offset:14336
 v_mfma_f32_16x16x32_bf16 v[124:127], a[132:135], v[188:191], v[124:127]
 s_waitcnt vmcnt(16) lgkmcnt(4)
 s_barrier
 v_mfma_f32_16x16x32_bf16 v[64:67], a[136:139], v[192:195], v[64:67]
 ds_read_b128 v[160:163], v18 offset:0
 v_mfma_f32_16x16x32_bf16 v[68:71], a[140:143], v[192:195], v[68:71]
 s_cmp_lt_u32 m0, s46
 s_cselect_b32 m0, m0, s47
 v_mfma_f32_16x16x32_bf16 v[72:75], a[136:139], v[196:199], v[72:75]
 ds_read_b128 v[164:167], v18 offset:2048
 v_add_u32 v19, s33, v15
 v_mfma_f32_16x16x32_bf16 v[76:79], a[140:143], v[196:199], v[76:79]
 buffer_load_dwordx4 v10, s[8:11], s30 offen offset:0 lds
 v_mfma_f32_16x16x32_bf16 v[80:83], a[136:139], v[200:203], v[80:83]
 ds_read_b128 v[168:171], v18 offset:4096
 s_add_u32 s33, s33, 16384
 v_mfma_f32_16x16x32_bf16 v[84:87], a[140:143], v[200:203], v[84:87]
 s_cmp_lt_u32 s33, 114688
 s_cselect_b32 s33, s33, 0
 v_mfma_f32_16x16x32_bf16 v[88:91], a[136:139], v[204:207], v[88:91]
 ds_read_b128 v[172:175], v18 offset:6144
 v_mfma_f32_16x16x32_bf16 v[92:95], a[140:143], v[204:207], v[92:95]
 s_waitcnt lgkmcnt(4)
 v_mfma_f32_16x16x32_bf16 v[96:99], a[136:139], v[208:211], v[96:99]
 ds_read_b128 v[176:179], v18 offset:8192
 v_mfma_f32_16x16x32_bf16 v[100:103], a[140:143], v[208:211], v[100:103]
 v_mfma_f32_16x16x32_bf16 v[104:107], a[136:139], v[212:215], v[104:107]
 ds_read_b128 v[180:183], v18 offset:10240
 v_mfma_f32_16x16x32_bf16 v[108:111], a[140:143], v[212:215], v[108:111]
 buffer_load_dwordx4 v11, s[8:11], s30 offen offset:1024 lds
 v_mfma_f32_16x16x32_bf16 v[112:115], a[136:139], v[216:219], v[112:115]
 ds_read_b128 v[184:187], v18 offset:12288
 v_mfma_f32_16x16x32_bf16 v[116:119], a[140:143], v[216:219], v[116:119]
 v_mfma_f32_16x16x32_bf16 v[120:123], a[136:139], v[220:223], v[120:123]
 ds_read_b128 v[188:191], v18 offset:14336
 v_mfma_f32_16x16x32_bf16 v[124:127], a[140:143], v[220:223], v[124:127]
 s_waitcnt lgkmcnt(4)
 v_mfma_f32_16x16x32_bf16 v[64:67], a[144:147], v[160:163], v[64:67]
 ds_read_b128 v[192:195], v19 offset:0
 v_mfma_f32_16x16x32_bf16 v[68:71], a[148:151], v[160:163], v[68:71]
 v_add_u32 v18, s33, v14
 v_mfma_f32_16x16x32_bf16 v[72:75], a[144:147], v[164:167], v[72:75]
 ds_read_b128 v[196:199], v19 offset:2048
 v_mfma_f32_16x16x32_bf16 v[76:79], a[148:151], v[164:167], v[76:79]
 buffer_load_dwordx4 v12, s[8:11], s30 offen offset:2048 lds
 v_mfma_f32_16x16x32_bf16 v[80:83], a[144:147], v[168:171], v[80:83]
 ds_read_b128 v[200:203], v19 offset:4096
 v_mfma_f32_16x16x32_bf16 v[84:87], a[148:151], v[168:171], v[84:87]
 v_mfma_f32_16x16x32_bf16 v[88:91], a[144:147], v[172:175], v[88:91]
 ds_read_b128 v[204:207], v19 offset:6144
 v_mfma_f32_16x16x32_bf16 v[92:95], a[148:151], v[172:175], v[92:95]
 s_waitcnt lgkmcnt(4)
 v_mfma_f32_16x16x32_bf16 v[96:99], a[144:147], v[176:179], v[96:99]
 ds_read_b128 v[208:211], v19 offset:8192
 v_mfma_f32_16x16x32_bf16 v[100:103], a[148:151], v[176:179], v[100:103]
 v_mfma_f32_16x16x32_bf16 v[104:107], a[144:147], v[180:183], v[104:107]
 ds_read_b128 v[212:215], v19 offset:10240
 v_mfma_f32_16x16x32_bf16 v[108:111], a[148:151], v[180:183], v[108:111]
 buffer_load_dwordx4 v13, s[8:11], s30 offen offset:3072 lds
 v_mfma_f32_16x16x32_bf16 v[112:115], a[144:147], v[184:187], v[112:115]
 ds_read_b128 v[216:219], v19 offset:12288
 s_add_u32 s30, s30, 128
 v_mfma_f32_16x16x32_bf16 v[116:119], a[148:151], v[184:187], v[116:119]
 s_add_u32 m0, m0, 16384
 v_mfma_f32_16x16x32_bf16 v[120:123], a[144:147], v[188:191], v[120:123]
 ds_read_b128 v[220:223], v19 offset:14336
 v_mfma_f32_16x16x32_bf16 v[124:127], a[148:151], v[188:191], v[124:127]
 s_waitcnt vmcnt(16) lgkmcnt(4)
 s_barrier
 v_mfma_f32_16x16x32_bf16 v[64:67], a[152:155], v[192:195], v[64:67]
 ds_read_b128 v[160:163], v18 offset:0
 v_mfma_f32_16x16x32_bf16 v[68:71], a[156:159], v[192:195], v[68:71]
 s_cmp_lt_u32 m0, s46
 s_cselect_b32 m0, m0, s47
 v_mfma_f32_16x16x32_bf16 v[72:75], a[152:155], v[196:199], v[72:75]
 ds_read_b128 v[164:167], v18 offset:2048
 v_add_u32 v19, s33, v15
 v_mfma_f32_16x16x32_bf16 v[76:79], a[156:159], v[196:199], v[76:79]
 buffer_load_dwordx4 v10, s[8:11], s30 offen offset:0 lds
 v_cvt_pk_bf16_f32 v224, v64, v65
 v_cvt_pk_bf16_f32 v225, v66, v67
 v_mfma_f32_16x16x32_bf16 v[80:83], a[152:155], v[200:203], v[80:83]
 ds_read_b128 v[168:171], v18 offset:4096
 s_add_u32 s33, s33, 16384
 v_cvt_pk_bf16_f32 v226, v68, v69
 v_cvt_pk_bf16_f32 v227, v70, v71
 v_mfma_f32_16x16x32_bf16 v[84:87], a[156:159], v[200:203], v[84:87]
 s_cmp_lt_u32 s33, 114688
 s_cselect_b32 s33, s33, 0
 ds_write_b64 v22, v[224:225] offset:0
 v_mfma_f32_16x16x32_bf16 v[88:91], a[152:155], v[204:207], v[88:91]
 ds_read_b128 v[172:175], v18 offset:6144
 ds_write_b64 v22, v[226:227] offset:32
 v_cvt_pk_bf16_f32 v230, v72, v73
 v_mfma_f32_16x16x32_bf16 v[92:95], a[156:159], v[204:207], v[92:95]
 s_waitcnt lgkmcnt(6)
 v_cvt_pk_bf16_f32 v231, v74, v75
 v_cvt_pk_bf16_f32 v232, v76, v77
 v_cvt_pk_bf16_f32 v233, v78, v79
 v_mfma_f32_16x16x32_bf16 v[96:99], a[152:155], v[208:211], v[96:99]
 ds_read_b128 v[176:179], v18 offset:8192
 ds_write_b64 v22, v[230:231] offset:4224
 v_mfma_f32_16x16x32_bf16 v[100:103], a[156:159], v[208:211], v[100:103]
 ds_write_b64 v22, v[232:233] offset:4256
 v_cvt_pk_bf16_f32 v224, v80, v81
 v_cvt_pk_bf16_f32 v225, v82, v83
 v_mfma_f32_16x16x32_bf16 v[104:107], a[152:155], v[212:215], v[104:107]
 ds_read_b128 v[180:183], v18 offset:10240
 v_cvt_pk_bf16_f32 v226, v84, v85
 v_cvt_pk_bf16_f32 v227, v86, v87
 v_mfma_f32_16x16x32_bf16 v[108:111], a[156:159], v[212:215], v[108:111]
 buffer_load_dwordx4 v11, s[8:11], s30 offen offset:1024 lds
 ds_write_b64 v22, v[224:225] offset:8448
 v_mfma_f32_16x16x32_bf16 v[112:115], a[152:155], v[216:219], v[112:115]
 ds_read_b128 v[184:187], v18 offset:12288
 ds_write_b64 v22, v[226:227] offset:8480
 v_cvt_pk_bf16_f32 v230, v88, v89
 v_mfma_f32_16x16x32_bf16 v[116:119], a[156:159], v[216:219], v[116:119]
 v_cvt_pk_bf16_f32 v231, v90, v91
 v_cvt_pk_bf16_f32 v232, v92, v93
 v_cvt_pk_bf16_f32 v233, v94, v95
 v_mfma_f32_16x16x32_bf16 v[120:123], a[152:155], v[220:223], v[120:123]
 ds_read_b128 v[188:191], v18 offset:14336
 ds_write_b64 v22, v[230:231] offset:12672
 v_mfma_f32_16x16x32_bf16 v[124:127], a[156:159], v[220:223], v[124:127]
 ds_write_b64 v22, v[232:233] offset:12704
 v_cvt_pk_bf16_f32 v224, v96, v97
 v_cvt_pk_bf16_f32 v225, v98, v99
bf_end_191:
 v_cvt_pk_bf16_f32 v226, v100, v101
 v_cvt_pk_bf16_f32 v227, v102, v103
 ds_write_b64 v22, v[224:225] offset:16896
 ds_write_b64 v22, v[226:227] offset:16928
 v_cvt_pk_bf16_f32 v230, v104, v105
 v_cvt_pk_bf16_f32 v231, v106, v107
 v_cvt_pk_bf16_f32 v232, v108, v109
 v_cvt_pk_bf16_f32 v233, v110, v111
 ds_write_b64 v22, v[230:231] offset:21120
 ds_write_b64 v22, v[232:233] offset:21152
 v_cvt_pk_bf16_f32 v224, v112, v113
 v_cvt_pk_bf16_f32 v225, v114, v115
 v_cvt_pk_bf16_f32 v226, v116, v117
 v_cvt_pk_bf16_f32 v227, v118, v119
 ds_write_b64 v22, v[224:225] offset:25344
 ds_write_b64 v22, v[226:227] offset:25376
 v_cvt_pk_bf16_f32 v230, v120, v121
 v_cvt_pk_bf16_f32 v231, v122, v123
 v_cvt_pk_bf16_f32 v232, v124, v125
 v_cvt_pk_bf16_f32 v233, v126, v127
 ds_write_b64 v22, v[230:231] offset:29568
 ds_write_b64 v22, v[232:233] offset:29600
 s_cmp_lg_u32 s26, 6
 s_cbranch_scc1 bw_192
 buffer_load_dword v50, v32, s[64:67], 0 offen offset:8 sc1
 buffer_load_dword v32, v32, s[64:67], 0 offen sc1
 buffer_load_dwordx4 v[40:43], v33, s[12:15], s50 offen offset:0
 buffer_load_dwordx4 v[40:43], v33, s[12:15], s50 offen offset:1024
 buffer_load_dwordx4 v[40:43], v33, s[12:15], s50 offen offset:2048
 buffer_load_dwordx4 v[40:43], v33, s[12:15], s50 offen offset:3072
 buffer_load_dwordx4 v[40:43], v33, s[12:15], s51 offen offset:0
 buffer_load_dwordx4 v[40:43], v33, s[12:15], s51 offen offset:1024
 buffer_load_dwordx4 v[40:43], v33, s[12:15], s51 offen offset:2048
bw_192:
 s_waitcnt lgkmcnt(0)
 s_barrier
 ds_read_b64 v[144:145], v34 offset:1848
 ds_read_b64 v[146:147], v34 offset:1856
 ds_read_b64 v[148:149], v34 offset:1864
 ds_read_b64 v[150:151], v34 offset:1872
 ds_read_b64 v[152:153], v34 offset:1880
 ds_read_b64 v[64:65], v34 offset:1928
 ds_read_b64 v[66:67], v34 offset:1936
 ds_read_b64 v[68:69], v34 offset:1944
 ds_read_b64 v[70:71], v34 offset:1952
 ds_read_b64 v[72:73], v34 offset:1960
 ds_read_b64 v[74:75], v34 offset:1664
 ds_read_b64 v[76:77], v34 offset:1672
 ds_read_b64 v[78:79], v34 offset:1680
 ds_read_b64 v[80:81], v34 offset:1688
 ds_read_b64 v[82:83], v34 offset:1696
 ds_read_b64 v[84:85], v34 offset:1400
 ds_read_b64 v[86:87], v34 offset:1408
 ds_read_b64 v[88:89], v34 offset:1416
 ds_read_b64 v[90:91], v34 offset:1424
 ds_read_b64 v[92:93], v34 offset:1432
 ds_read_b64 v[94:95], v34 offset:1136
 ds_read_b64 v[96:97], v34 offset:1144
 ds_read_b64 v[98:99], v34 offset:1152
 ds_read_b64 v[100:101], v34 offset:1160
 ds_read_b64 v[102:103], v34 offset:1168
 ds_read_b64 v[104:105], v34 offset:872
 ds_read_b64 v[106:107], v34 offset:880
 ds_read_b64 v[108:109], v34 offset:888
 ds_read_b64 v[110:111], v34 offset:896
 ds_read_b64 v[112:113], v34 offset:904
 ds_read_b64 v[114:115], v34 offset:608
 ds_read_b64 v[116:117], v34 offset:616
 ds_read_b64 v[118:119], v34 offset:624
 ds_read_b64 v[120:121], v34 offset:632
 ds_read_b64 v[122:123], v34 offset:640
 ds_read_b64 v[124:125], v34 offset:344
 ds_read_b64 v[126:127], v34 offset:352
 ds_read_b64 v[128:129], v34 offset:360
 ds_read_b64 v[130:131], v34 offset:368
 ds_read_b64 v[132:133], v34 offset:376
 ds_read_b64 v[134:135], v34 offset:80
 ds_read_b64 v[136:137], v34 offset:88
 ds_read_b64 v[138:139], v34 offset:96
 ds_read_b64 v[140:141], v34 offset:104
 ds_read_b64 v[142:143], v34 offset:112
 v_mov_b32 v224, 0
 v_mov_b32 v225, 0
 v_mov_b32 v226, 0
 v_mov_b32 v227, 0
 v_mov_b32 v228, 0
 v_mov_b32 v229, 0
 v_mov_b32 v230, 0
 v_mov_b32 v231, 0
 s_waitcnt lgkmcnt(15)
 v_dot2c_f32_bf16 v224, v64, v144
 v_dot2c_f32_bf16 v225, v74, v144
 v_dot2c_f32_bf16 v226, v84, v144
 v_dot2c_f32_bf16 v227, v94, v144
 v_dot2c_f32_bf16 v224, v65, v145
 v_dot2c_f32_bf16 v225, v75, v145
 v_dot2c_f32_bf16 v226, v85, v145
 v_dot2c_f32_bf16 v227, v95, v145
 v_dot2c_f32_bf16 v224, v66, v146
 v_dot2c_f32_bf16 v225, v76, v146
 v_dot2c_f32_bf16 v226, v86, v146
 v_dot2c_f32_bf16 v227, v96, v146
 v_dot2c_f32_bf16 v224, v67, v147
 v_dot2c_f32_bf16 v225, v77, v147
 v_dot2c_f32_bf16 v226, v87, v147
 v_dot2c_f32_bf16 v227, v97, v147
 v_dot2c_f32_bf16 v224, v68, v148
 v_dot2c_f32_bf16 v225, v78, v148
 v_dot2c_f32_bf16 v226, v88, v148
 v_dot2c_f32_bf16 v227, v98, v148
 v_dot2c_f32_bf16 v224, v69, v149
 v_dot2c_f32_bf16 v225, v79, v149
 v_dot2c_f32_bf16 v226, v89, v149
 v_dot2c_f32_bf16 v227, v99, v149
 v_dot2c_f32_bf16 v224, v70, v150
 v_dot2c_f32_bf16 v225, v80, v150
 v_dot2c_f32_bf16 v226, v90, v150
 v_dot2c_f32_bf16 v227, v100, v150
 v_dot2c_f32_bf16 v224, v71, v151
 v_dot2c_f32_bf16 v225, v81, v151
 v_dot2c_f32_bf16 v226, v91, v151
 v_dot2c_f32_bf16 v227, v101, v151
 v_dot2c_f32_bf16 v224, v72, v152
 v_dot2c_f32_bf16 v225, v82, v152
 v_dot2c_f32_bf16 v226, v92, v152
 v_dot2c_f32_bf16 v227, v102, v152
 v_dot2c_f32_bf16 v224, v73, v153
 v_dot2c_f32_bf16 v225, v83, v153
 v_dot2c_f32_bf16 v226, v93, v153
 v_dot2c_f32_bf16 v227, v103, v153
 s_waitcnt lgkmcnt(0)
 v_dot2c_f32_bf16 v228, v104, v144
 v_dot2c_f32_bf16 v229, v114, v144
 v_dot2c_f32_bf16 v230, v124, v144
 v_dot2c_f32_bf16 v231, v134, v144
 v_dot2c_f32_bf16 v228, v105, v145
 v_dot2c_f32_bf16 v229, v115, v145
 v_dot2c_f32_bf16 v230, v125, v145
 v_dot2c_f32_bf16 v231, v135, v145
 v_dot2c_f32_bf16 v228, v106, v146
 v_dot2c_f32_bf16 v229, v116, v146
 v_dot2c_f32_bf16 v230, v126, v146
 v_dot2c_f32_bf16 v231, v136, v146
 v_dot2c_f32_bf16 v228, v107, v147
 v_dot2c_f32_bf16 v229, v117, v147
 v_dot2c_f32_bf16 v230, v127, v147
 v_dot2c_f32_bf16 v231, v137, v147
 v_dot2c_f32_bf16 v228, v108, v148
 v_dot2c_f32_bf16 v229, v118, v148
 v_dot2c_f32_bf16 v230, v128, v148
 v_dot2c_f32_bf16 v231, v138, v148
 v_dot2c_f32_bf16 v228, v109, v149
 v_dot2c_f32_bf16 v229, v119, v149
 v_dot2c_f32_bf16 v230, v129, v149
 v_dot2c_f32_bf16 v231, v139, v149
 v_dot2c_f32_bf16 v228, v110, v150
 v_dot2c_f32_bf16 v229, v120, v150
 v_dot2c_f32_bf16 v230, v130, v150
 v_dot2c_f32_bf16 v231, v140, v150
 v_dot2c_f32_bf16 v228, v111, v151
 v_dot2c_f32_bf16 v229, v121, v151
 v_dot2c_f32_bf16 v230, v131, v151
 v_dot2c_f32_bf16 v231, v141, v151
 v_dot2c_f32_bf16 v228, v112, v152
 v_dot2c_f32_bf16 v229, v122, v152
 v_dot2c_f32_bf16 v230, v132, v152
 v_dot2c_f32_bf16 v231, v142, v152
 v_dot2c_f32_bf16 v228, v113, v153
 v_dot2c_f32_bf16 v229, v123, v153
 v_dot2c_f32_bf16 v230, v133, v153
 v_dot2c_f32_bf16 v231, v143, v153
 ds_read_b64 v[64:65], v38 offset:2008
 ds_read_b64 v[66:67], v38 offset:2016
 ds_read_b64 v[68:69], v38 offset:2024
 ds_read_b64 v[70:71], v38 offset:2032
 ds_read_b64 v[72:73], v39 offset:2040
 ds_read_b64 v[74:75], v38 offset:1744
 ds_read_b64 v[76:77], v38 offset:1752
 ds_read_b64 v[78:79], v38 offset:1760
 ds_read_b64 v[80:81], v38 offset:1768
 ds_read_b64 v[82:83], v39 offset:1776
 ds_read_b64 v[84:85], v38 offset:1480
 ds_read_b64 v[86:87], v38 offset:1488
 ds_read_b64 v[88:89], v38 offset:1496
 ds_read_b64 v[90:91], v38 offset:1504
 ds_read_b64 v[92:93], v39 offset:1512
 ds_read_b64 v[94:95], v38 offset:1216
 ds_read_b64 v[96:97], v38 offset:1224
 ds_read_b64 v[98:99], v38 offset:1232
 ds_read_b64 v[100:101], v38 offset:1240
 ds_read_b64 v[102:103], v39 offset:1248
 ds_read_b64 v[104:105], v38 offset:952
 ds_read_b64 v[106:107], v38 offset:960
 ds_read_b64 v[108:109], v38 offset:968
 ds_read_b64 v[110:111], v38 offset:976
 ds_read_b64 v[112:113], v39 offset:984
 ds_read_b64 v[114:115], v38 offset:688
 ds_read_b64 v[116:117], v38 offset:696
 ds_read_b64 v[118:119], v38 offset:704
 ds_read_b64 v[120:121], v38 offset:712
 ds_read_b64 v[122:123], v39 offset:720
 ds_read_b64 v[124:125], v38 offset:424
 ds_read_b64 v[126:127], v38 offset:432
 ds_read_b64 v[128:129], v38 offset:440
 ds_read_b64 v[130:131], v38 offset:448
 ds_read_b64 v[132:133], v39 offset:456
 ds_read_b64 v[134:135], v38 offset:160
 ds_read_b64 v[136:137], v38 offset:168
 ds_read_b64 v[138:139], v38 offset:176
 ds_read_b64 v[140:141], v38 offset:184
 ds_read_b64 v[142:143], v39 offset:192
 v_cvt_pk_bf16_f32 v4, v224, v225
 v_lshlrev_b32 v224, 16, v4
 v_and_b32 v225, 0xffff0000, v4
 v_mul_f32 v224, s60, v224
 v_mul_f32 v225, s60, v225
 v_cvt_pk_bf16_f32 v4, v224, v225
 v_lshlrev_b32 v224, 16, v4
 v_and_b32 v225, 0xffff0000, v4
 v_cndmask_b32 v224, v37, v224, s[76:77]
 v_cndmask_b32 v225, v37, v225, s[78:79]
 v_cvt_pk_bf16_f32 v4, v226, v227
 v_lshlrev_b32 v226, 16, v4
 v_and_b32 v227, 0xffff0000, v4
 v_mul_f32 v226, s60, v226
 v_mul_f32 v227, s60, v227
 v_cvt_pk_bf16_f32 v4, v226, v227
 v_lshlrev_b32 v226, 16, v4
 v_and_b32 v227, 0xffff0000, v4
 v_cndmask_b32 v226, v37, v226, s[80:81]
 v_cndmask_b32 v227, v37, v227, s[82:83]
 v_cvt_pk_bf16_f32 v4, v228, v229
 v_lshlrev_b32 v228, 16, v4
 v_and_b32 v229, 0xffff0000, v4
 v_mul_f32 v228, s60, v228
 v_mul_f32 v229, s60, v229
 v_cvt_pk_bf16_f32 v4, v228, v229
 v_lshlrev_b32 v228, 16, v4
 v_and_b32 v229, 0xffff0000, v4
 v_cndmask_b32 v228, v37, v228, s[84:85]
 v_cndmask_b32 v229, v37, v229, s[86:87]
 v_cvt_pk_bf16_f32 v4, v230, v231
 v_lshlrev_b32 v230, 16, v4
 v_and_b32 v231, 0xffff0000, v4
 v_mul_f32 v230, s60, v230
 v_mul_f32 v231, s60, v231
 v_cvt_pk_bf16_f32 v4, v230, v231
 v_lshlrev_b32 v230, 16, v4
 v_and_b32 v231, 0xffff0000, v4
 v_cndmask_b32 v230, v37, v230, s[88:89]
 v_cndmask_b32 v231, v37, v231, s[90:91]
 v_max3_f32 v5, v224, v225, v226
 v_max3_f32 v5, v5, v227, v228
 v_max3_f32 v5, v5, v229, v230
 v_max_f32 v5, v5, v231
 v_sub_f32 v224, v224, v5
 v_mul_f32 v224, s61, v224
 v_exp_f32 v224, v224
 v_sub_f32 v225, v225, v5
 v_mul_f32 v225, s61, v225
 v_exp_f32 v225, v225
 v_sub_f32 v226, v226, v5
 v_mul_f32 v226, s61, v226
 v_exp_f32 v226, v226
 v_sub_f32 v227, v227, v5
 v_mul_f32 v227, s61, v227
 v_exp_f32 v227, v227
 v_sub_f32 v228, v228, v5
 v_mul_f32 v228, s61, v228
 v_exp_f32 v228, v228
 v_sub_f32 v229, v229, v5
 v_mul_f32 v229, s61, v229
 v_exp_f32 v229, v229
 v_sub_f32 v230, v230, v5
 v_mul_f32 v230, s61, v230
 v_exp_f32 v230, v230
 v_sub_f32 v231, v231, v5
 v_mul_f32 v231, s61, v231
 v_exp_f32 v231, v231
 s_nop 0
 v_add_f32 v5, v224, v225
 v_add_f32 v5, v5, v226
 v_add_f32 v5, v5, v227
 v_add_f32 v5, v5, v228
 v_add_f32 v5, v5, v229
 v_add_f32 v5, v5, v230
 v_add_f32 v5, v5, v231
 v_rcp_f32 v5, v5
 s_nop 0
 v_mul_f32 v224, v224, v5
 v_mul_f32 v225, v225, v5
 v_mul_f32 v226, v226, v5
 v_mul_f32 v227, v227, v5
 v_mul_f32 v228, v228, v5
 v_mul_f32 v229, v229, v5
 v_mul_f32 v230, v230, v5
 v_mul_f32 v231, v231, v5
 v_cvt_pk_bf16_f32 v232, v224, v225
 v_cvt_pk_bf16_f32 v233, v226, v227
 v_cvt_pk_bf16_f32 v234, v228, v229
 v_cvt_pk_bf16_f32 v235, v230, v231
 s_waitcnt lgkmcnt(15)
 v_perm_b32 v144, v74, v64, s62
 v_perm_b32 v145, v74, v64, s63
 v_perm_b32 v146, v75, v65, s62
 v_perm_b32 v147, v75, v65, s63
 v_perm_b32 v148, v76, v66, s62
 v_perm_b32 v149, v76, v66, s63
 v_perm_b32 v150, v77, v67, s62
 v_perm_b32 v151, v77, v67, s63
 v_perm_b32 v152, v78, v68, s62
 v_perm_b32 v153, v78, v68, s63
 v_perm_b32 v154, v79, v69, s62
 v_perm_b32 v155, v79, v69, s63
 v_perm_b32 v156, v80, v70, s62
 v_perm_b32 v157, v80, v70, s63
 v_perm_b32 v158, v81, v71, s62
 v_perm_b32 v159, v81, v71, s63
 v_perm_b32 v212, v82, v72, s62
 v_perm_b32 v213, v82, v72, s63
 v_perm_b32 v214, v83, v73, s62
 v_perm_b32 v215, v83, v73, s63
 v_dot2_f32_bf16 v192, v144, v232, 0
 v_dot2_f32_bf16 v193, v145, v232, 0
 v_dot2_f32_bf16 v194, v146, v232, 0
 v_dot2_f32_bf16 v195, v147, v232, 0
 v_dot2_f32_bf16 v196, v148, v232, 0
 v_dot2_f32_bf16 v197, v149, v232, 0
 v_dot2_f32_bf16 v198, v150, v232, 0
 v_dot2_f32_bf16 v199, v151, v232, 0
 v_dot2_f32_bf16 v200, v152, v232, 0
 v_dot2_f32_bf16 v201, v153, v232, 0
 v_dot2_f32_bf16 v202, v154, v232, 0
 v_dot2_f32_bf16 v203, v155, v232, 0
 v_dot2_f32_bf16 v204, v156, v232, 0
 v_dot2_f32_bf16 v205, v157, v232, 0
 v_dot2_f32_bf16 v206, v158, v232, 0
 v_dot2_f32_bf16 v207, v159, v232, 0
 v_dot2_f32_bf16 v208, v212, v232, 0
 v_dot2_f32_bf16 v209, v213, v232, 0
 v_dot2_f32_bf16 v210, v214, v232, 0
 v_dot2_f32_bf16 v211, v215, v232, 0
 s_waitcnt lgkmcnt(15)
 v_perm_b32 v144, v94, v84, s62
 v_perm_b32 v145, v94, v84, s63
 v_perm_b32 v146, v95, v85, s62
 v_perm_b32 v147, v95, v85, s63
 v_perm_b32 v148, v96, v86, s62
 v_perm_b32 v149, v96, v86, s63
 v_perm_b32 v150, v97, v87, s62
 v_perm_b32 v151, v97, v87, s63
 v_perm_b32 v152, v98, v88, s62
 v_perm_b32 v153, v98, v88, s63
 v_perm_b32 v154, v99, v89, s62
 v_perm_b32 v155, v99, v89, s63
 v_perm_b32 v156, v100, v90, s62
 v_perm_b32 v157, v100, v90, s63
 v_perm_b32 v158, v101, v91, s62
 v_perm_b32 v159, v101, v91, s63
 v_perm_b32 v212, v102, v92, s62
 v_perm_b32 v213, v102, v92, s63
 v_perm_b32 v214, v103, v93, s62
 v_perm_b32 v215, v103, v93, s63
 v_dot2c_f32_bf16 v192, v144, v233
 v_dot2c_f32_bf16 v193, v145, v233
 v_dot2c_f32_bf16 v194, v146, v233
 v_dot2c_f32_bf16 v195, v147, v233
 v_dot2c_f32_bf16 v196, v148, v233
 v_dot2c_f32_bf16 v197, v149, v233
 v_dot2c_f32_bf16 v198, v150, v233
 v_dot2c_f32_bf16 v199, v151, v233
 v_dot2c_f32_bf16 v200, v152, v233
 v_dot2c_f32_bf16 v201, v153, v233
 v_dot2c_f32_bf16 v202, v154, v233
 v_dot2c_f32_bf16 v203, v155, v233
 v_dot2c_f32_bf16 v204, v156, v233
 v_dot2c_f32_bf16 v205, v157, v233
 v_dot2c_f32_bf16 v206, v158, v233
 v_dot2c_f32_bf16 v207, v159, v233
 v_dot2c_f32_bf16 v208, v212, v233
 v_dot2c_f32_bf16 v209, v213, v233
 v_dot2c_f32_bf16 v210, v214, v233
 v_dot2c_f32_bf16 v211, v215, v233
 s_waitcnt lgkmcnt(10)
 v_perm_b32 v144, v114, v104, s62
 v_perm_b32 v145, v114, v104, s63
 v_perm_b32 v146, v115, v105, s62
 v_perm_b32 v147, v115, v105, s63
 v_perm_b32 v148, v116, v106, s62
 v_perm_b32 v149, v116, v106, s63
 v_perm_b32 v150, v117, v107, s62
 v_perm_b32 v151, v117, v107, s63
 v_perm_b32 v152, v118, v108, s62
 v_perm_b32 v153, v118, v108, s63
 v_perm_b32 v154, v119, v109, s62
 v_perm_b32 v155, v119, v109, s63
 v_perm_b32 v156, v120, v110, s62
 v_perm_b32 v157, v120, v110, s63
 v_perm_b32 v158, v121, v111, s62
 v_perm_b32 v159, v121, v111, s63
 v_perm_b32 v212, v122, v112, s62
 v_perm_b32 v213, v122, v112, s63
 v_perm_b32 v214, v123, v113, s62
 v_perm_b32 v215, v123, v113, s63
 v_dot2c_f32_bf16 v192, v144, v234
 v_dot2c_f32_bf16 v193, v145, v234
 v_dot2c_f32_bf16 v194, v146, v234
 v_dot2c_f32_bf16 v195, v147, v234
 v_dot2c_f32_bf16 v196, v148, v234
 v_dot2c_f32_bf16 v197, v149, v234
 v_dot2c_f32_bf16 v198, v150, v234
 v_dot2c_f32_bf16 v199, v151, v234
 v_dot2c_f32_bf16 v200, v152, v234
 v_dot2c_f32_bf16 v201, v153, v234
 v_dot2c_f32_bf16 v202, v154, v234
 v_dot2c_f32_bf16 v203, v155, v234
 v_dot2c_f32_bf16 v204, v156, v234
 v_dot2c_f32_bf16 v205, v157, v234
 v_dot2c_f32_bf16 v206, v158, v234
 v_dot2c_f32_bf16 v207, v159, v234
 v_dot2c_f32_bf16 v208, v212, v234
 v_dot2c_f32_bf16 v209, v213, v234
 v_dot2c_f32_bf16 v210, v214, v234
 v_dot2c_f32_bf16 v211, v215, v234
 s_waitcnt lgkmcnt(0)
 v_perm_b32 v144, v134, v124, s62
 v_perm_b32 v145, v134, v124, s63
 v_perm_b32 v146, v135, v125, s62
 v_perm_b32 v147, v135, v125, s63
 v_perm_b32 v148, v136, v126, s62
 v_perm_b32 v149, v136, v126, s63
 v_perm_b32 v150, v137, v127, s62
 v_perm_b32 v151, v137, v127, s63
 v_perm_b32 v152, v138, v128, s62
 v_perm_b32 v153, v138, v128, s63
 v_perm_b32 v154, v139, v129, s62
 v_perm_b32 v155, v139, v129, s63
 v_perm_b32 v156, v140, v130, s62
 v_perm_b32 v157, v140, v130, s63
 v_perm_b32 v158, v141, v131, s62
 v_perm_b32 v159, v141, v131, s63
 v_perm_b32 v212, v142, v132, s62
 v_perm_b32 v213, v142, v132, s63
 v_perm_b32 v214, v143, v133, s62
 v_perm_b32 v215, v143, v133, s63
 v_dot2c_f32_bf16 v192, v144, v235
 v_dot2c_f32_bf16 v193, v145, v235
 v_dot2c_f32_bf16 v194, v146, v235
 v_dot2c_f32_bf16 v195, v147, v235
 v_dot2c_f32_bf16 v196, v148, v235
 v_dot2c_f32_bf16 v197, v149, v235
 v_dot2c_f32_bf16 v198, v150, v235
 v_dot2c_f32_bf16 v199, v151, v235
 v_dot2c_f32_bf16 v200, v152, v235
 v_dot2c_f32_bf16 v201, v153, v235
 v_dot2c_f32_bf16 v202, v154, v235
 v_dot2c_f32_bf16 v203, v155, v235
 v_dot2c_f32_bf16 v204, v156, v235
 v_dot2c_f32_bf16 v205, v157, v235
 v_dot2c_f32_bf16 v206, v158, v235
 v_dot2c_f32_bf16 v207, v159, v235
 v_dot2c_f32_bf16 v208, v212, v235
 v_dot2c_f32_bf16 v209, v213, v235
 v_dot2c_f32_bf16 v210, v214, v235
 v_dot2c_f32_bf16 v211, v215, v235
 s_cmp_lg_u32 s20, 0
 s_cbranch_scc1 bh_193
 ds_read_b64 v[64:65], v35 offset:33792
 ds_read_b64 v[66:67], v35 offset:34304
 ds_read_b64 v[68:69], v35 offset:34816
 ds_read_b64 v[70:71], v35 offset:35328
 ds_read_b64 v[72:73], v35 offset:35840
 s_waitcnt lgkmcnt(0)
 ds_write_b64 v35, v[64:65] offset:0
 ds_write_b64 v35, v[66:67] offset:512
 ds_write_b64 v35, v[68:69] offset:1024
 ds_write_b64 v35, v[70:71] offset:1536
 ds_write_b64 v35, v[72:73] offset:2048
bh_193:
 s_nop 1
 v_cvt_pk_bf16_f32 v244, v192, v193
 v_cvt_pk_bf16_f32 v245, v194, v195
 v_cvt_pk_bf16_f32 v246, v196, v197
 v_cvt_pk_bf16_f32 v247, v198, v199
 v_cvt_pk_bf16_f32 v248, v200, v201
 v_cvt_pk_bf16_f32 v249, v202, v203
 v_cvt_pk_bf16_f32 v250, v204, v205
 v_cvt_pk_bf16_f32 v251, v206, v207
 v_cvt_pk_bf16_f32 v252, v208, v209
 v_cvt_pk_bf16_f32 v253, v210, v211
 buffer_store_dwordx4 v[244:247], v29, s[16:19], s27 offen sc1
 buffer_store_dwordx4 v[248:251], v30, s[16:19], s27 offen sc1
 buffer_store_dwordx2 v[252:253], v31, s[16:19], s27 offen sc1
 s_add_u32 s27, s27, 2048
 s_mov_b64 s[78:79], -1
 s_mov_b64 s[80:81], -1
 s_mov_b64 s[82:83], -1
 s_mov_b64 s[84:85], -1
 s_mov_b64 s[86:87], -1
 s_mov_b64 s[88:89], -1
 s_mov_b64 s[90:91], -1
 s_sub_u32 s26, s26, 1
 s_cmp_gt_u32 s26, 0
 s_waitcnt lgkmcnt(0)
 s_cbranch_scc1 bf_blk_190
 s_waitcnt vmcnt(0) lgkmcnt(0)
 s_barrier
 s_mov_b32 s84, 0
 s_mov_b32 s85, -1
 v_readfirstlane_b32 s21, v32
 s_cmp_ge_u32 s21, 32
 s_cbranch_scc1 bt_194
 s_mov_b32 s21, 76
 v_mov_b32 v4, 0
 s_mov_b32 s101, 0
wf_195:
 buffer_load_dword v5, v4, s[64:67], s21 offen sc1
 s_add_u32 s101, s101, 1
 s_cmp_gt_u32 s101, 131072
 s_cbranch_scc1 main_end
 s_waitcnt vmcnt(0)
 v_readfirstlane_b32 s100, v5
 s_cmp_ge_u32 s100, 32
 s_cbranch_scc1 wf_196
 s_sleep 8
 s_branch wf_195
wf_196:
bt_194:
 s_mov_b32 s21, 91136
 s_cmp_lg_u32 s20, 0
 s_cbranch_scc1 af_197
 v_mov_b32 v4, 0
 v_mov_b32 v5, 1
 s_mov_b64 exec, 1
 buffer_atomic_add v5, v4, s[72:75], s21 offen sc1
 s_mov_b64 exec, -1
 s_nop 1
af_197:
 v_readfirstlane_b32 s100, v50
 s_cmp_lg_u32 s100, 0
 s_cbranch_scc1 c0_198
 s_mov_b32 s21, 84
 v_mov_b32 v6, 0
 s_mov_b32 s101, 0
wf_199:
 buffer_load_dword v7, v6, s[64:67], s21 offen sc1
 s_add_u32 s101, s101, 1
 s_cmp_gt_u32 s101, 131072
 s_cbranch_scc1 main_end
 s_waitcnt vmcnt(0)
 v_readfirstlane_b32 s100, v7
 s_cmp_ge_u32 s100, 1
 s_cbranch_scc1 wf_200
 s_sleep 8
 s_branch wf_199
wf_200:
c0_198:
 s_add_u32 s37, s38, 83886079
 s_add_u32 s21, s38, 180355072
 s_xor_b32 s37, s37, s21
 s_lshr_b32 s37, s37, 21
 s_xor_b32 s37, s37, s100
 s_xor_b32 s37, s37, 0
 s_and_b32 s37, s37, 1
 s_lshl_b32 s37, s37, 13
q_entry:
 s_load_dwordx2 s[4:5], s[0:1], 0
 s_load_dwordx2 s[6:7], s[0:1], 16
 s_load_dwordx2 s[38:39], s[0:1], 104
 s_mov_b32 s42, s2
 s_cmp_lt_u32 s3, 64
 s_cselect_b32 s41, 12, 0
 s_cselect_b32 s45, 8, 0
 s_waitcnt lgkmcnt(0)
 s_mov_b32 s8, s4
 s_mov_b32 s9, s5
 s_mov_b32 s10, 2621440
 s_mov_b32 s11, 0x00020000
 s_mov_b32 s12, s6
 s_mov_b32 s13, s7
 s_mov_b32 s14, 7864320
 s_mov_b32 s15, 0x00020000
 s_mov_b32 s16, s38
 s_mov_b32 s17, s39
 s_mov_b32 s18, 50331648
 s_mov_b32 s19, 0x00020000
 s_add_u32 s52, s38, 180355072
 s_addc_u32 s53, s39, 0
 s_mov_b32 s54, 67108864
 s_mov_b32 s55, 0x00020000
 s_add_u32 s56, s38, 180355072
 s_addc_u32 s57, s39, 0
 s_mov_b32 s58, 67108864
 s_mov_b32 s59, 0x00020000
 s_load_dwordx2 s[72:73], s[0:1], 104
 s_waitcnt lgkmcnt(0)
 s_add_u32 s72, s72, 81068032
 s_addc_u32 s73, s73, 0
 s_mov_b32 s74, 129024
 s_mov_b32 s75, 0x00020000
 s_mul_i32 s44, s42, 384
 s_mul_i32 s24, s45, 307200
 v_mov_b32 v9, 2731
 s_and_b32 s22, s20, 1
 s_lshl_b32 s22, s22, 2
 v_add_u32 v8, 0, v1
 v_mul_u32_u24 v7, v8, v9
 v_lshrrev_b32 v7, 16, v7
 v_mul_u32_u24 v4, 24, v7
 v_sub_u32 v8, v8, v4
 v_and_b32 v4, 2, v7
 v_xor_b32 v8, v8, v4
 v_xor_b32 v8, s22, v8
 v_xor_b32 v5, 4, v8
 s_mov_b32 s21, 12288
 v_mul_lo_u32 v7, v7, s21
 v_lshl_add_u32 v40, v8, 4, v7
 v_lshl_add_u32 v43, v5, 4, v7
 v_add_u32 v8, 64, v1
 v_mul_u32_u24 v7, v8, v9
 v_lshrrev_b32 v7, 16, v7
 v_mul_u32_u24 v4, 24, v7
 v_sub_u32 v8, v8, v4
 v_and_b32 v4, 2, v7
 v_xor_b32 v8, v8, v4
 v_xor_b32 v8, s22, v8
 v_xor_b32 v5, 4, v8
 s_mov_b32 s21, 12288
 v_mul_lo_u32 v7, v7, s21
 v_lshl_add_u32 v41, v8, 4, v7
 v_lshl_add_u32 v44, v5, 4, v7
 v_add_u32 v8, 128, v1
 v_mul_u32_u24 v7, v8, v9
 v_lshrrev_b32 v7, 16, v7
 v_mul_u32_u24 v4, 24, v7
 v_sub_u32 v8, v8, v4
 v_and_b32 v4, 2, v7
 v_xor_b32 v8, v8, v4
 v_xor_b32 v8, s22, v8
 v_xor_b32 v5, 4, v8
 s_mov_b32 s21, 12288
 v_mul_lo_u32 v7, v7, s21
 v_lshl_add_u32 v42, v8, 4, v7
 v_lshl_add_u32 v45, v5, 4, v7
 s_mul_i32 s23, s20, 491520
 s_add_u32 s23, s23, s44
 s_mul_i32 s22, s20, 15360
 s_add_u32 s22, s22, 98304
 s_add_u32 s21, s23, 0
 s_add_u32 m0, s22, 0
 s_nop 0
 buffer_load_dwordx4 v40, s[12:15], s21 offen lds
 s_add_u32 m0, s22, 1024
 s_nop 0
 buffer_load_dwordx4 v41, s[12:15], s21 offen lds
 s_add_u32 m0, s22, 2048
 s_nop 0
 buffer_load_dwordx4 v42, s[12:15], s21 offen lds
 s_add_u32 s21, s23, 98304
 s_add_u32 m0, s22, 3072
 s_nop 0
 buffer_load_dwordx4 v43, s[12:15], s21 offen lds
 s_add_u32 m0, s22, 4096
 s_nop 0
 buffer_load_dwordx4 v44, s[12:15], s21 offen lds
 s_add_u32 m0, s22, 5120
 s_nop 0
 buffer_load_dwordx4 v45, s[12:15], s21 offen lds
 s_add_u32 s21, s23, 196608
 s_add_u32 m0, s22, 6144
 s_nop 0
 buffer_load_dwordx4 v40, s[12:15], s21 offen lds
 s_add_u32 m0, s22, 7168
 s_nop 0
 buffer_load_dwordx4 v41, s[12:15], s21 offen lds
 s_add_u32 m0, s22, 8192
 s_nop 0
 buffer_load_dwordx4 v42, s[12:15], s21 offen lds
 s_add_u32 s21, s23, 294912
 s_add_u32 m0, s22, 9216
 s_nop 0
 buffer_load_dwordx4 v43, s[12:15], s21 offen lds
 s_add_u32 m0, s22, 10240
 s_nop 0
 buffer_load_dwordx4 v44, s[12:15], s21 offen lds
 s_add_u32 m0, s22, 11264
 s_nop 0
 buffer_load_dwordx4 v45, s[12:15], s21 offen lds
 s_add_u32 s21, s23, 393216
 s_add_u32 m0, s22, 12288
 s_nop 0
 buffer_load_dwordx4 v40, s[12:15], s21 offen lds
 s_add_u32 m0, s22, 13312
 s_nop 0
 buffer_load_dwordx4 v41, s[12:15], s21 offen lds
 s_add_u32 m0, s22, 14336
 s_nop 0
 buffer_load_dwordx4 v42, s[12:15], s21 offen lds
 s_add_u32 s21, s23, 1966080
 buffer_load_dwordx4 v[64:67], v40, s[12:15], s21 offen
 buffer_load_dwordx4 v[68:71], v41, s[12:15], s21 offen
 buffer_load_dwordx4 v[72:75], v42, s[12:15], s21 offen
 s_add_u32 s21, s23, 2064384
 buffer_load_dwordx4 v[76:79], v43, s[12:15], s21 offen
 buffer_load_dwordx4 v[80:83], v44, s[12:15], s21 offen
 buffer_load_dwordx4 v[84:87], v45, s[12:15], s21 offen
 s_add_u32 s21, s23, 2162688
 buffer_load_dwordx4 v[88:91], v40, s[12:15], s21 offen
 buffer_load_dwordx4 v[92:95], v41, s[12:15], s21 offen
 buffer_load_dwordx4 v[96:99], v42, s[12:15], s21 offen
 s_add_u32 s21, s23, 2260992
 buffer_load_dwordx4 v[100:103], v43, s[12:15], s21 offen
 buffer_load_dwordx4 v[104:107], v44, s[12:15], s21 offen
 buffer_load_dwordx4 v[108:111], v45, s[12:15], s21 offen
 s_add_u32 s21, s23, 2359296
 buffer_load_dwordx4 v[112:115], v40, s[12:15], s21 offen
 buffer_load_dwordx4 v[116:119], v41, s[12:15], s21 offen
 buffer_load_dwordx4 v[120:123], v42, s[12:15], s21 offen
 s_add_u32 s21, s23, 3932160
 buffer_load_dwordx4 v[124:127], v40, s[12:15], s21 offen
 buffer_load_dwordx4 v[128:131], v41, s[12:15], s21 offen
 buffer_load_dwordx4 v[132:135], v42, s[12:15], s21 offen
 s_add_u32 s21, s23, 4030464
 buffer_load_dwordx4 v[136:139], v43, s[12:15], s21 offen
 buffer_load_dwordx4 v[140:143], v44, s[12:15], s21 offen
 buffer_load_dwordx4 v[144:147], v45, s[12:15], s21 offen
 s_add_u32 s21, s23, 4128768
 buffer_load_dwordx4 v[148:151], v40, s[12:15], s21 offen
 buffer_load_dwordx4 v[152:155], v41, s[12:15], s21 offen
 buffer_load_dwordx4 v[156:159], v42, s[12:15], s21 offen
 s_add_u32 s21, s23, 4227072
 buffer_load_dwordx4 v[160:163], v43, s[12:15], s21 offen
 buffer_load_dwordx4 v[164:167], v44, s[12:15], s21 offen
 buffer_load_dwordx4 v[168:171], v45, s[12:15], s21 offen
 s_add_u32 s21, s23, 4325376
 buffer_load_dwordx4 v[172:175], v40, s[12:15], s21 offen
 buffer_load_dwordx4 v[176:179], v41, s[12:15], s21 offen
 buffer_load_dwordx4 v[180:183], v42, s[12:15], s21 offen
 s_add_u32 s21, s23, 5898240
 buffer_load_dwordx4 v[184:187], v40, s[12:15], s21 offen
 buffer_load_dwordx4 v[188:191], v41, s[12:15], s21 offen
 buffer_load_dwordx4 v[192:195], v42, s[12:15], s21 offen
 s_add_u32 s21, s23, 5996544
 buffer_load_dwordx4 v[196:199], v43, s[12:15], s21 offen
 buffer_load_dwordx4 v[200:203], v44, s[12:15], s21 offen
 buffer_load_dwordx4 v[204:207], v45, s[12:15], s21 offen
 s_add_u32 s21, s23, 6094848
 buffer_load_dwordx4 v[208:211], v40, s[12:15], s21 offen
 buffer_load_dwordx4 v[212:215], v41, s[12:15], s21 offen
 buffer_load_dwordx4 v[216:219], v42, s[12:15], s21 offen
 s_add_u32 s21, s23, 6193152
 buffer_load_dwordx4 v[220:223], v43, s[12:15], s21 offen
 buffer_load_dwordx4 v[224:227], v44, s[12:15], s21 offen
 buffer_load_dwordx4 v[228:231], v45, s[12:15], s21 offen
 s_add_u32 s21, s23, 6291456
 buffer_load_dwordx4 v[232:235], v40, s[12:15], s21 offen
 buffer_load_dwordx4 v[236:239], v41, s[12:15], s21 offen
 buffer_load_dwordx4 v[240:243], v42, s[12:15], s21 offen
 v_lshl_add_u32 v49, v1, 4, s22
 v_lshrrev_b32 v7, 2, v2
 v_and_b32 v4, 2, v7
 v_and_b32 v5, 1, v3
 v_lshl_or_b32 v4, v5, 2, v4
 v_lshl_add_u32 v7, v3, 3, v7
 v_mul_u32_u24 v7, 384, v7
 v_and_b32 v5, 1, v2
 v_lshl_add_u32 v7, v5, 3, v7
 v_add_u32 v7, 98304, v7
 v_bfe_u32 v8, v2, 1, 1
 s_mul_i32 s21, s20, 6
 v_add_u32 v8, s21, v8
 v_add_u32 v5, 0, v8
 v_xor_b32 v5, v5, v4
 v_lshl_add_u32 v46, v5, 4, v7
 v_add_u32 v5, 2, v8
 v_xor_b32 v5, v5, v4
 v_lshl_add_u32 v47, v5, 4, v7
 v_add_u32 v5, 4, v8
 v_xor_b32 v5, v5, v4
 v_lshl_add_u32 v48, v5, 4, v7
 s_waitcnt vmcnt(45)
 s_barrier
 ds_read_b64_tr_b16 a[0:1], v46 offset:0
 ds_read_b64_tr_b16 a[2:3], v46 offset:1536
 ds_read_b64_tr_b16 a[4:5], v47 offset:0
 ds_read_b64_tr_b16 a[6:7], v47 offset:1536
 ds_read_b64_tr_b16 a[8:9], v48 offset:0
 ds_read_b64_tr_b16 a[10:11], v48 offset:1536
 ds_read_b64_tr_b16 a[12:13], v46 offset:12288
 ds_read_b64_tr_b16 a[14:15], v46 offset:13824
 ds_read_b64_tr_b16 a[16:17], v47 offset:12288
 ds_read_b64_tr_b16 a[18:19], v47 offset:13824
 ds_read_b64_tr_b16 a[20:21], v48 offset:12288
 ds_read_b64_tr_b16 a[22:23], v48 offset:13824
 ds_read_b64_tr_b16 a[24:25], v46 offset:24576
 ds_read_b64_tr_b16 a[26:27], v46 offset:26112
 ds_read_b64_tr_b16 a[28:29], v47 offset:24576
 ds_read_b64_tr_b16 a[30:31], v47 offset:26112
 ds_read_b64_tr_b16 a[32:33], v48 offset:24576
 ds_read_b64_tr_b16 a[34:35], v48 offset:26112
 ds_read_b64_tr_b16 a[36:37], v46 offset:36864
 ds_read_b64_tr_b16 a[38:39], v46 offset:38400
 ds_read_b64_tr_b16 a[40:41], v47 offset:36864
 ds_read_b64_tr_b16 a[42:43], v47 offset:38400
 ds_read_b64_tr_b16 a[44:45], v48 offset:36864
 ds_read_b64_tr_b16 a[46:47], v48 offset:38400
 ds_read_b64_tr_b16 a[48:49], v46 offset:49152
 ds_read_b64_tr_b16 a[50:51], v46 offset:50688
 ds_read_b64_tr_b16 a[52:53], v47 offset:49152
 ds_read_b64_tr_b16 a[54:55], v47 offset:50688
 ds_read_b64_tr_b16 a[56:57], v48 offset:49152
 ds_read_b64_tr_b16 a[58:59], v48 offset:50688
 v_lshrrev_b32 v11, 3, v1
 v_and_b32 v12, 7, v1
 v_xor_b32 v12, v12, v11
 v_mul_u32_u24 v11, 1280, v11
 v_lshl_add_u32 v10, v12, 4, v11
 s_mul_i32 s46, s20, 40960
 v_add_u32 v10, s46, v10
 s_lshl_b32 s47, s20, 12
 s_add_u32 s47, s47, 0
 s_add_u32 s46, s47, 98304
 s_mov_b32 s30, s24
 s_add_u32 s32, s47, 0
 v_add_u32 v11, 9216, v10
 v_add_u32 v12, 18432, v10
 v_add_u32 v13, 27648, v10
 s_mov_b32 m0, s32
 s_nop 0
 buffer_load_dwordx4 v10, s[8:11], s30 offen offset:0 lds
 buffer_load_dwordx4 v11, s[8:11], s30 offen offset:1024 lds
 buffer_load_dwordx4 v12, s[8:11], s30 offen offset:2048 lds
 buffer_load_dwordx4 v13, s[8:11], s30 offen offset:3072 lds
 s_add_u32 s30, s30, 128
 s_add_u32 s32, s32, 16384
 s_cmp_lt_u32 s32, s46
 s_cselect_b32 s32, s32, s47
 s_mov_b32 m0, s32
 s_nop 0
 buffer_load_dwordx4 v10, s[8:11], s30 offen offset:0 lds
 buffer_load_dwordx4 v11, s[8:11], s30 offen offset:1024 lds
 buffer_load_dwordx4 v12, s[8:11], s30 offen offset:2048 lds
 buffer_load_dwordx4 v13, s[8:11], s30 offen offset:3072 lds
 s_add_u32 s30, s30, 128
 s_add_u32 s32, s32, 16384
 s_cmp_lt_u32 s32, s46
 s_cselect_b32 s32, s32, s47
 s_mov_b32 m0, s32
 s_nop 0
 buffer_load_dwordx4 v10, s[8:11], s30 offen offset:0 lds
 buffer_load_dwordx4 v11, s[8:11], s30 offen offset:1024 lds
 buffer_load_dwordx4 v12, s[8:11], s30 offen offset:2048 lds
 buffer_load_dwordx4 v13, s[8:11], s30 offen offset:3072 lds
 s_add_u32 s30, s30, 128
 s_add_u32 s32, s32, 16384
 s_cmp_lt_u32 s32, s46
 s_cselect_b32 s32, s32, s47
 s_mov_b32 m0, s32
 s_nop 0
 buffer_load_dwordx4 v10, s[8:11], s30 offen offset:0 lds
 buffer_load_dwordx4 v11, s[8:11], s30 offen offset:1024 lds
 buffer_load_dwordx4 v12, s[8:11], s30 offen offset:2048 lds
 buffer_load_dwordx4 v13, s[8:11], s30 offen offset:3072 lds
 s_add_u32 s30, s30, 128
 s_add_u32 s32, s32, 16384
 s_cmp_lt_u32 s32, s46
 s_cselect_b32 s32, s32, s47
 s_waitcnt lgkmcnt(0)
 s_barrier
 s_waitcnt vmcnt(46)
 ds_write_b128 v49, v[64:67] offset:0
 ds_write_b128 v49, v[68:71] offset:1024
 ds_write_b128 v49, v[72:75] offset:2048
 ds_write_b128 v49, v[76:79] offset:3072
 ds_write_b128 v49, v[80:83] offset:4096
 ds_write_b128 v49, v[84:87] offset:5120
 ds_write_b128 v49, v[88:91] offset:6144
 ds_write_b128 v49, v[92:95] offset:7168
 ds_write_b128 v49, v[96:99] offset:8192
 ds_write_b128 v49, v[100:103] offset:9216
 ds_write_b128 v49, v[104:107] offset:10240
 ds_write_b128 v49, v[108:111] offset:11264
 ds_write_b128 v49, v[112:115] offset:12288
 ds_write_b128 v49, v[116:119] offset:13312
 ds_write_b128 v49, v[120:123] offset:14336
 s_waitcnt lgkmcnt(0)
 s_barrier
 ds_read_b64_tr_b16 a[60:61], v46 offset:0
 ds_read_b64_tr_b16 a[62:63], v46 offset:1536
 ds_read_b64_tr_b16 a[64:65], v47 offset:0
 ds_read_b64_tr_b16 a[66:67], v47 offset:1536
 ds_read_b64_tr_b16 a[68:69], v48 offset:0
 ds_read_b64_tr_b16 a[70:71], v48 offset:1536
 ds_read_b64_tr_b16 a[72:73], v46 offset:12288
 ds_read_b64_tr_b16 a[74:75], v46 offset:13824
 ds_read_b64_tr_b16 a[76:77], v47 offset:12288
 ds_read_b64_tr_b16 a[78:79], v47 offset:13824
 ds_read_b64_tr_b16 a[80:81], v48 offset:12288
 ds_read_b64_tr_b16 a[82:83], v48 offset:13824
 ds_read_b64_tr_b16 a[84:85], v46 offset:24576
 ds_read_b64_tr_b16 a[86:87], v46 offset:26112
 ds_read_b64_tr_b16 a[88:89], v47 offset:24576
 ds_read_b64_tr_b16 a[90:91], v47 offset:26112
 ds_read_b64_tr_b16 a[92:93], v48 offset:24576
 ds_read_b64_tr_b16 a[94:95], v48 offset:26112
 ds_read_b64_tr_b16 a[96:97], v46 offset:36864
 ds_read_b64_tr_b16 a[98:99], v46 offset:38400
 ds_read_b64_tr_b16 a[100:101], v47 offset:36864
 ds_read_b64_tr_b16 a[102:103], v47 offset:38400
 ds_read_b64_tr_b16 a[104:105], v48 offset:36864
 ds_read_b64_tr_b16 a[106:107], v48 offset:38400
 ds_read_b64_tr_b16 a[108:109], v46 offset:49152
 ds_read_b64_tr_b16 a[110:111], v46 offset:50688
 ds_read_b64_tr_b16 a[112:113], v47 offset:49152
 ds_read_b64_tr_b16 a[114:115], v47 offset:50688
 ds_read_b64_tr_b16 a[116:117], v48 offset:49152
 ds_read_b64_tr_b16 a[118:119], v48 offset:50688
 s_waitcnt lgkmcnt(0)
 s_barrier
 s_waitcnt vmcnt(31)
 ds_write_b128 v49, v[124:127] offset:0
 ds_write_b128 v49, v[128:131] offset:1024
 ds_write_b128 v49, v[132:135] offset:2048
 ds_write_b128 v49, v[136:139] offset:3072
 ds_write_b128 v49, v[140:143] offset:4096
 ds_write_b128 v49, v[144:147] offset:5120
 ds_write_b128 v49, v[148:151] offset:6144
 ds_write_b128 v49, v[152:155] offset:7168
 ds_write_b128 v49, v[156:159] offset:8192
 ds_write_b128 v49, v[160:163] offset:9216
 ds_write_b128 v49, v[164:167] offset:10240
 ds_write_b128 v49, v[168:171] offset:11264
 ds_write_b128 v49, v[172:175] offset:12288
 ds_write_b128 v49, v[176:179] offset:13312
 ds_write_b128 v49, v[180:183] offset:14336
 s_waitcnt lgkmcnt(0)
 s_barrier
 ds_read_b64_tr_b16 a[120:121], v46 offset:0
 ds_read_b64_tr_b16 a[122:123], v46 offset:1536
 ds_read_b64_tr_b16 a[124:125], v47 offset:0
 ds_read_b64_tr_b16 a[126:127], v47 offset:1536
 ds_read_b64_tr_b16 a[128:129], v48 offset:0
 ds_read_b64_tr_b16 a[130:131], v48 offset:1536
 ds_read_b64_tr_b16 a[132:133], v46 offset:12288
 ds_read_b64_tr_b16 a[134:135], v46 offset:13824
 ds_read_b64_tr_b16 a[136:137], v47 offset:12288
 ds_read_b64_tr_b16 a[138:139], v47 offset:13824
 ds_read_b64_tr_b16 a[140:141], v48 offset:12288
 ds_read_b64_tr_b16 a[142:143], v48 offset:13824
 ds_read_b64_tr_b16 a[144:145], v46 offset:24576
 ds_read_b64_tr_b16 a[146:147], v46 offset:26112
 ds_read_b64_tr_b16 a[148:149], v47 offset:24576
 ds_read_b64_tr_b16 a[150:151], v47 offset:26112
 ds_read_b64_tr_b16 a[152:153], v48 offset:24576
 ds_read_b64_tr_b16 a[154:155], v48 offset:26112
 ds_read_b64_tr_b16 a[156:157], v46 offset:36864
 ds_read_b64_tr_b16 a[158:159], v46 offset:38400
 ds_read_b64_tr_b16 a[160:161], v47 offset:36864
 ds_read_b64_tr_b16 a[162:163], v47 offset:38400
 ds_read_b64_tr_b16 a[164:165], v48 offset:36864
 ds_read_b64_tr_b16 a[166:167], v48 offset:38400
 ds_read_b64_tr_b16 a[168:169], v46 offset:49152
 ds_read_b64_tr_b16 a[170:171], v46 offset:50688
 ds_read_b64_tr_b16 a[172:173], v47 offset:49152
 ds_read_b64_tr_b16 a[174:175], v47 offset:50688
 ds_read_b64_tr_b16 a[176:177], v48 offset:49152
 ds_read_b64_tr_b16 a[178:179], v48 offset:50688
 s_waitcnt lgkmcnt(0)
 s_barrier
 s_waitcnt vmcnt(16)
 ds_write_b128 v49, v[184:187] offset:0
 ds_write_b128 v49, v[188:191] offset:1024
 ds_write_b128 v49, v[192:195] offset:2048
 ds_write_b128 v49, v[196:199] offset:3072
 ds_write_b128 v49, v[200:203] offset:4096
 ds_write_b128 v49, v[204:207] offset:5120
 ds_write_b128 v49, v[208:211] offset:6144
 ds_write_b128 v49, v[212:215] offset:7168
 ds_write_b128 v49, v[216:219] offset:8192
 ds_write_b128 v49, v[220:223] offset:9216
 ds_write_b128 v49, v[224:227] offset:10240
 ds_write_b128 v49, v[228:231] offset:11264
 ds_write_b128 v49, v[232:235] offset:12288
 ds_write_b128 v49, v[236:239] offset:13312
 ds_write_b128 v49, v[240:243] offset:14336
 s_waitcnt lgkmcnt(0)
 s_barrier
 ds_read_b64_tr_b16 a[180:181], v46 offset:0
 ds_read_b64_tr_b16 a[182:183], v46 offset:1536
 ds_read_b64_tr_b16 a[184:185], v47 offset:0
 ds_read_b64_tr_b16 a[186:187], v47 offset:1536
 ds_read_b64_tr_b16 a[188:189], v48 offset:0
 ds_read_b64_tr_b16 a[190:191], v48 offset:1536
 ds_read_b64_tr_b16 a[192:193], v46 offset:12288
 ds_read_b64_tr_b16 a[194:195], v46 offset:13824
 ds_read_b64_tr_b16 a[196:197], v47 offset:12288
 ds_read_b64_tr_b16 a[198:199], v47 offset:13824
 ds_read_b64_tr_b16 a[200:201], v48 offset:12288
 ds_read_b64_tr_b16 a[202:203], v48 offset:13824
 ds_read_b64_tr_b16 a[204:205], v46 offset:24576
 ds_read_b64_tr_b16 a[206:207], v46 offset:26112
 ds_read_b64_tr_b16 a[208:209], v47 offset:24576
 ds_read_b64_tr_b16 a[210:211], v47 offset:26112
 ds_read_b64_tr_b16 a[212:213], v48 offset:24576
 ds_read_b64_tr_b16 a[214:215], v48 offset:26112
 ds_read_b64_tr_b16 a[216:217], v46 offset:36864
 ds_read_b64_tr_b16 a[218:219], v46 offset:38400
 ds_read_b64_tr_b16 a[220:221], v47 offset:36864
 ds_read_b64_tr_b16 a[222:223], v47 offset:38400
 ds_read_b64_tr_b16 a[224:225], v48 offset:36864
 ds_read_b64_tr_b16 a[226:227], v48 offset:38400
 ds_read_b64_tr_b16 a[228:229], v46 offset:49152
 ds_read_b64_tr_b16 a[230:231], v46 offset:50688
 ds_read_b64_tr_b16 a[232:233], v47 offset:49152
 ds_read_b64_tr_b16 a[234:235], v47 offset:50688
 ds_read_b64_tr_b16 a[236:237], v48 offset:49152
 ds_read_b64_tr_b16 a[238:239], v48 offset:50688
 s_waitcnt lgkmcnt(0)
 s_barrier
 s_add_u32 s12, s38, 57671680
 s_addc_u32 s13, s39, 0
 s_mov_b32 s14, 1572864
 s_mov_b32 s15, 0x00020000
 s_mul_i32 s21, s20, 12800
 s_add_u32 s21, s21, 98304
 v_mul_u32_u24 v4, 400, v2
 v_lshlrev_b32 v5, 4, v3
 v_add3_u32 v29, v4, v5, s21
 v_lshlrev_b32 v30, 4, v1
 v_and_b32 v4, 1, v2
 v_bfe_u32 v5, v2, 1, 1
 v_lshl_or_b32 v4, v5, 2, v4
 v_bfe_u32 v5, v2, 2, 1
 v_lshl_or_b32 v4, v5, 1, v4
 v_lshlrev_b32 v4, 4, v4
 v_lshl_add_u32 v31, v3, 7, v4
 v_lshlrev_b32 v32, 3, v1
 v_and_b32 v4, 3, v1
 v_lshlrev_b32 v33, 3, v4
 v_mov_b32 v34, 0xf149f2ca
 v_lshlrev_b32 v4, 2, v3
 v_sub_u32 v35, v2, v4
 v_cmp_gt_u32 s[60:61], 2, v3
 s_mov_b32 s62, 0x3d93cd3a
 s_mov_b32 s63, 0x3fb8aa3b
 s_mov_b32 s83, 0x3dd53b95
 v_cmp_le_i32 s[64:65], 0, v35
 v_cmp_le_i32 s[66:67], 1, v35
 v_cmp_le_i32 s[68:69], 2, v35
 v_cmp_le_i32 s[70:71], 3, v35
 s_mov_b32 s25, 163840
 s_cmp_lg_u32 s45, 0
 s_cselect_b32 s26, 4, 12
 s_cselect_b32 s40, 4, 99
 s_cselect_b32 s25, 4294475776, s25
 s_lshl_b32 s43, s42, 2
 s_add_u32 s43, s43, s20
 s_mul_i32 s43, s43, 12288
 s_lshr_b32 s21, s42, 2
 s_lshl_b32 s21, s21, 14
 s_and_b32 s44, s42, 3
 s_lshl_b32 s44, s44, 11
 s_add_u32 s44, s44, s21
 s_add_u32 s44, s44, 655360
 s_lshr_b32 s36, s42, 1
 s_lshl_b32 s36, s36, 14
 s_and_b32 s21, s42, 1
 s_mul_i32 s21, s21, 3072
 s_add_u32 s36, s36, s21
 s_add_u32 s36, s36, 655360
 s_lshl_b32 s49, s41, 2
 s_add_u32 s49, s49, s20
 s_mov_b32 s29, 4
 s_mov_b32 s78, 0
 s_mov_b32 s81, 0x80000000
 s_mov_b32 s82, 0
 s_mul_i32 s21, s49, 393216
 s_mul_i32 s22, s42, 12288
 s_add_u32 s50, s21, s22
 s_lshl_b32 s21, s49, 12
 s_and_b32 s21, s21, 8192
 s_xor_b32 s21, s21, s37
 s_lshl_b32 s51, s49, 20
 s_or_b32 s51, s51, s21
 s_xor_b32 s51, s51, 8192
 s_add_u32 s51, s51, s36
 s_lshr_b32 s22, s49, 1
 s_lshr_b32 s21, s49, 2
 s_add_u32 s21, s21, 3
 s_cmp_lt_u32 s49, 12
 s_cselect_b32 s21, s22, s21
 s_lshl_b32 s21, s21, 3
 s_lshr_b32 s22, s42, 2
 s_add_u32 s21, s21, s22
 s_lshl_b32 s21, s21, 7
 s_add_u32 s76, s21, 0
 s_lshl_b32 s77, s42, 7
 s_add_u32 s77, s77, 19456
 v_mov_b32 v21, 0
 buffer_load_dword v21, v33, s[72:75], s77 offen sc1
 v_and_b32 v6, 7, v2
 v_add_u32 v4, 0, v3
 v_xor_b32 v4, v4, v6
 v_lshlrev_b32 v4, 4, v4
 v_lshl_add_u32 v14, v2, 7, v4
 v_add_u32 v4, 4, v3
 v_xor_b32 v4, v4, v6
 v_lshlrev_b32 v4, 4, v4
 v_lshl_add_u32 v15, v2, 7, v4
 v_mul_u32_u24 v22, 400, v2
 v_mul_u32_u24 v4, 16, v3
 s_mul_i32 s21, s20, 96
 s_add_u32 s21, s21, 98304
 v_add3_u32 v22, v22, v4, s21
 v_lshlrev_b32 v4, 3, v3
 v_sub_u32 v16, v22, v4
 v_mov_b32 v9, 2731
 s_mov_b32 s33, 0
 s_mov_b32 s48, 0x80000000
 s_mov_b32 m0, s32
 s_nop 0
 buffer_load_dwordx4 v10, s[8:11], s30 offen offset:0 lds
 buffer_load_dwordx4 v11, s[8:11], s30 offen offset:1024 lds
 s_waitcnt vmcnt(14)
 s_barrier
 v_add_u32 v18, s33, v14
 v_add_u32 v19, s33, v15
 s_add_u32 s33, s33, 16384
 s_cmp_lt_u32 s33, 98304
 s_cselect_b32 s33, s33, 0
 ds_read_b128 v[160:163], v18 offset:0
 ds_read_b128 v[164:167], v18 offset:2048
 ds_read_b128 v[168:171], v18 offset:4096
 ds_read_b128 v[172:175], v18 offset:6144
 ds_read_b128 v[176:179], v18 offset:8192
 ds_read_b128 v[180:183], v18 offset:10240
 ds_read_b128 v[184:187], v18 offset:12288
 ds_read_b128 v[188:191], v18 offset:14336
 s_waitcnt lgkmcnt(0)
qa_blk_202:
 v_mfma_f32_16x16x32_bf16 v[64:67], a[0:3], v[160:163], 0
 ds_read_b128 v[192:195], v19 offset:0
 v_mfma_f32_16x16x32_bf16 v[68:71], a[4:7], v[160:163], 0
 v_add_u32 v18, s33, v14
 v_cndmask_b32 v36, v34, v36, s[64:65]
 v_mfma_f32_16x16x32_bf16 v[72:75], a[8:11], v[160:163], 0
 v_cndmask_b32 v48, v34, v48, s[64:65]
 v_cndmask_b32 v37, v34, v37, s[66:67]
 v_mfma_f32_16x16x32_bf16 v[76:79], a[0:3], v[164:167], 0
 ds_read_b128 v[196:199], v19 offset:2048
 v_cndmask_b32 v49, v34, v49, s[66:67]
 v_mfma_f32_16x16x32_bf16 v[80:83], a[4:7], v[164:167], 0
 buffer_load_dwordx4 v12, s[8:11], s30 offen offset:2048 lds
 v_mfma_f32_16x16x32_bf16 v[84:87], a[8:11], v[164:167], 0
 v_cndmask_b32 v38, v34, v38, s[68:69]
 v_cndmask_b32 v50, v34, v50, s[68:69]
 v_mfma_f32_16x16x32_bf16 v[88:91], a[0:3], v[168:171], 0
 ds_read_b128 v[200:203], v19 offset:4096
 v_cndmask_b32 v39, v34, v39, s[70:71]
 v_mfma_f32_16x16x32_bf16 v[92:95], a[4:7], v[168:171], 0
 v_cndmask_b32 v51, v34, v51, s[70:71]
 v_max3_f32 v56, v36, v37, v38
 v_mfma_f32_16x16x32_bf16 v[96:99], a[8:11], v[168:171], 0
 v_max3_f32 v56, v56, v39, v40
 v_max3_f32 v56, v56, v41, v42
 v_mfma_f32_16x16x32_bf16 v[100:103], a[0:3], v[172:175], 0
 ds_read_b128 v[204:207], v19 offset:6144
 v_max_f32 v56, v56, v43
 v_mfma_f32_16x16x32_bf16 v[104:107], a[4:7], v[172:175], 0
 v_mov_b32 v57, v56
 v_mfma_f32_16x16x32_bf16 v[108:111], a[8:11], v[172:175], 0
 s_waitcnt lgkmcnt(15)
 v_mfma_f32_16x16x32_bf16 v[112:115], a[0:3], v[176:179], 0
 ds_read_b128 v[208:211], v19 offset:8192
 v_mfma_f32_16x16x32_bf16 v[116:119], a[4:7], v[176:179], 0
 s_nop 1
 v_mfma_f32_16x16x32_bf16 v[120:123], a[8:11], v[176:179], 0
 v_permlane32_swap_b32 v56, v57
 v_mfma_f32_16x16x32_bf16 v[124:127], a[0:3], v[180:183], 0
 ds_read_b128 v[212:215], v19 offset:10240
 v_max_f32 v56, v56, v57
 v_mfma_f32_16x16x32_bf16 v[128:131], a[4:7], v[180:183], 0
 buffer_load_dwordx4 v13, s[8:11], s30 offen offset:3072 lds
 v_mfma_f32_16x16x32_bf16 v[132:135], a[8:11], v[180:183], 0
 s_add_u32 s30, s30, 128
 s_add_u32 m0, m0, 16384
 v_mfma_f32_16x16x32_bf16 v[136:139], a[0:3], v[184:187], 0
 ds_read_b128 v[216:219], v19 offset:12288
 v_mov_b32 v57, v56
 v_mfma_f32_16x16x32_bf16 v[140:143], a[4:7], v[184:187], 0
 s_cmp_lt_u32 m0, s46
 s_cselect_b32 m0, m0, s47
 v_mfma_f32_16x16x32_bf16 v[144:147], a[8:11], v[184:187], 0
 s_nop 1
 v_mfma_f32_16x16x32_bf16 v[148:151], a[0:3], v[188:191], 0
 ds_read_b128 v[220:223], v19 offset:14336
 v_mfma_f32_16x16x32_bf16 v[152:155], a[4:7], v[188:191], 0
 v_permlane16_swap_b32 v56, v57
 v_mfma_f32_16x16x32_bf16 v[156:159], a[8:11], v[188:191], 0
 s_waitcnt vmcnt(12) lgkmcnt(4)
 s_barrier
 v_mfma_f32_16x16x32_bf16 v[64:67], a[12:15], v[192:195], v[64:67]
 ds_read_b128 v[160:163], v18 offset:0
 v_max_f32 v56, v56, v57
 v_mfma_f32_16x16x32_bf16 v[68:71], a[16:19], v[192:195], v[68:71]
 v_mul_f32 v56, s83, v56
 v_fma_f32 v36, v36, s83, -v56
 v_mfma_f32_16x16x32_bf16 v[72:75], a[20:23], v[192:195], v[72:75]
 v_add_u32 v19, s33, v15
 s_add_u32 s33, s33, 16384
 v_mfma_f32_16x16x32_bf16 v[76:79], a[12:15], v[196:199], v[76:79]
 ds_read_b128 v[164:167], v18 offset:2048
 s_mul_i32 s21, s49, 393216
 v_mfma_f32_16x16x32_bf16 v[80:83], a[16:19], v[196:199], v[80:83]
 buffer_load_dwordx4 v10, s[8:11], s30 offen offset:0 lds
 v_mfma_f32_16x16x32_bf16 v[84:87], a[20:23], v[196:199], v[84:87]
 s_cmp_lt_u32 s33, 98304
 s_cselect_b32 s33, s33, 0
 v_mfma_f32_16x16x32_bf16 v[88:91], a[12:15], v[200:203], v[88:91]
 ds_read_b128 v[168:171], v18 offset:4096
 s_mul_i32 s22, s42, 12288
 v_mfma_f32_16x16x32_bf16 v[92:95], a[16:19], v[200:203], v[92:95]
 s_add_u32 s50, s21, s22
 s_lshl_b32 s21, s49, 12
 v_mfma_f32_16x16x32_bf16 v[96:99], a[20:23], v[200:203], v[96:99]
 s_and_b32 s21, s21, 8192
 s_xor_b32 s21, s21, s37
 v_mfma_f32_16x16x32_bf16 v[100:103], a[12:15], v[204:207], v[100:103]
 ds_read_b128 v[172:175], v18 offset:6144
 s_lshl_b32 s51, s49, 20
 v_mfma_f32_16x16x32_bf16 v[104:107], a[16:19], v[204:207], v[104:107]
 s_or_b32 s51, s51, s21
 s_xor_b32 s51, s51, 8192
 v_mfma_f32_16x16x32_bf16 v[108:111], a[20:23], v[204:207], v[108:111]
 s_waitcnt lgkmcnt(4)
 s_add_u32 s51, s51, s36
 v_mfma_f32_16x16x32_bf16 v[112:115], a[12:15], v[208:211], v[112:115]
 ds_read_b128 v[176:179], v18 offset:8192
 s_add_u32 s23, s49, 1
 v_mfma_f32_16x16x32_bf16 v[116:119], a[16:19], v[208:211], v[116:119]
 v_cmp_gt_u32 vcc, s23, v21
 v_fma_f32 v37, v37, s83, -v56
 v_mfma_f32_16x16x32_bf16 v[120:123], a[20:23], v[208:211], v[120:123]
 s_cmp_eq_u64 vcc, 0
 s_cselect_b32 s80, 1, 0
 s_cselect_b32 s51, s51, 0x80000000
 v_mfma_f32_16x16x32_bf16 v[124:127], a[12:15], v[212:215], v[124:127]
 ds_read_b128 v[180:183], v18 offset:10240
 s_lshl_b32 s79, s80, 3
 v_mfma_f32_16x16x32_bf16 v[128:131], a[16:19], v[212:215], v[128:131]
 buffer_load_dwordx4 v11, s[8:11], s30 offen offset:1024 lds
 v_mfma_f32_16x16x32_bf16 v[132:135], a[20:23], v[212:215], v[132:135]
 s_or_b32 s79, s79, s45
 v_fma_f32 v38, v38, s83, -v56
 v_mfma_f32_16x16x32_bf16 v[136:139], a[12:15], v[216:219], v[136:139]
 ds_read_b128 v[184:187], v18 offset:12288
 v_fma_f32 v39, v39, s83, -v56
 v_mfma_f32_16x16x32_bf16 v[140:143], a[16:19], v[216:219], v[140:143]
 buffer_load_dwordx4 a[240:243], v31, s[52:55], s51 offen offset:0 sc1
 v_mfma_f32_16x16x32_bf16 v[144:147], a[20:23], v[216:219], v[144:147]
 v_fma_f32 v40, v40, s83, -v56
 v_fma_f32 v41, v41, s83, -v56
 v_mfma_f32_16x16x32_bf16 v[148:151], a[12:15], v[220:223], v[148:151]
 ds_read_b128 v[188:191], v18 offset:14336
 v_fma_f32 v42, v42, s83, -v56
 v_mfma_f32_16x16x32_bf16 v[152:155], a[16:19], v[220:223], v[152:155]
 v_fma_f32 v43, v43, s83, -v56
 v_mfma_f32_16x16x32_bf16 v[156:159], a[20:23], v[220:223], v[156:159]
 s_waitcnt lgkmcnt(4)
 v_mfma_f32_16x16x32_bf16 v[64:67], a[24:27], v[160:163], v[64:67]
 ds_read_b128 v[192:195], v19 offset:0
 v_mfma_f32_16x16x32_bf16 v[68:71], a[28:31], v[160:163], v[68:71]
 v_add_u32 v18, s33, v14
 v_mfma_f32_16x16x32_bf16 v[72:75], a[32:35], v[160:163], v[72:75]
 v_exp_f32 v36, v36
 v_mfma_f32_16x16x32_bf16 v[76:79], a[24:27], v[164:167], v[76:79]
 ds_read_b128 v[196:199], v19 offset:2048
 v_mfma_f32_16x16x32_bf16 v[80:83], a[28:31], v[164:167], v[80:83]
 buffer_load_dwordx4 v12, s[8:11], s30 offen offset:2048 lds
 v_mfma_f32_16x16x32_bf16 v[84:87], a[32:35], v[164:167], v[84:87]
 v_exp_f32 v37, v37
 v_mfma_f32_16x16x32_bf16 v[88:91], a[24:27], v[168:171], v[88:91]
 ds_read_b128 v[200:203], v19 offset:4096
 v_mfma_f32_16x16x32_bf16 v[92:95], a[28:31], v[168:171], v[92:95]
 v_exp_f32 v38, v38
 v_mfma_f32_16x16x32_bf16 v[96:99], a[32:35], v[168:171], v[96:99]
 v_exp_f32 v39, v39
 v_mfma_f32_16x16x32_bf16 v[100:103], a[24:27], v[172:175], v[100:103]
 ds_read_b128 v[204:207], v19 offset:6144
 v_mfma_f32_16x16x32_bf16 v[104:107], a[28:31], v[172:175], v[104:107]
 v_exp_f32 v40, v40
 v_mfma_f32_16x16x32_bf16 v[108:111], a[32:35], v[172:175], v[108:111]
 s_waitcnt lgkmcnt(4)
 v_mfma_f32_16x16x32_bf16 v[112:115], a[24:27], v[176:179], v[112:115]
 ds_read_b128 v[208:211], v19 offset:8192
 v_mfma_f32_16x16x32_bf16 v[116:119], a[28:31], v[176:179], v[116:119]
 v_exp_f32 v41, v41
 v_mfma_f32_16x16x32_bf16 v[120:123], a[32:35], v[176:179], v[120:123]
 v_exp_f32 v42, v42
 v_mfma_f32_16x16x32_bf16 v[124:127], a[24:27], v[180:183], v[124:127]
 ds_read_b128 v[212:215], v19 offset:10240
 v_mfma_f32_16x16x32_bf16 v[128:131], a[28:31], v[180:183], v[128:131]
 buffer_load_dwordx4 v13, s[8:11], s30 offen offset:3072 lds
 v_mfma_f32_16x16x32_bf16 v[132:135], a[32:35], v[180:183], v[132:135]
 s_add_u32 s30, s30, 128
 s_add_u32 m0, m0, 16384
 v_mfma_f32_16x16x32_bf16 v[136:139], a[24:27], v[184:187], v[136:139]
 ds_read_b128 v[216:219], v19 offset:12288
 v_mfma_f32_16x16x32_bf16 v[140:143], a[28:31], v[184:187], v[140:143]
 s_cmp_lt_u32 m0, s46
 s_cselect_b32 m0, m0, s47
 v_mfma_f32_16x16x32_bf16 v[144:147], a[32:35], v[184:187], v[144:147]
 buffer_load_dwordx4 a[244:247], v31, s[52:55], s51 offen offset:512 sc1
 v_mfma_f32_16x16x32_bf16 v[148:151], a[24:27], v[188:191], v[148:151]
 ds_read_b128 v[220:223], v19 offset:14336
 v_mfma_f32_16x16x32_bf16 v[152:155], a[28:31], v[188:191], v[152:155]
 v_exp_f32 v43, v43
 v_mfma_f32_16x16x32_bf16 v[156:159], a[32:35], v[188:191], v[156:159]
 s_waitcnt vmcnt(14) lgkmcnt(4)
 s_barrier
 v_mfma_f32_16x16x32_bf16 v[64:67], a[36:39], v[192:195], v[64:67]
 ds_read_b128 v[160:163], v18 offset:0
 s_nop 0
 v_mfma_f32_16x16x32_bf16 v[68:71], a[40:43], v[192:195], v[68:71]
 v_add_f32 v56, v40, v41
 v_add_f32 v56, v56, v42
 v_mfma_f32_16x16x32_bf16 v[72:75], a[44:47], v[192:195], v[72:75]
 v_add_u32 v19, s33, v15
 s_add_u32 s33, s33, 16384
 v_mfma_f32_16x16x32_bf16 v[76:79], a[36:39], v[196:199], v[76:79]
 ds_read_b128 v[164:167], v18 offset:2048
 v_add_f32 v56, v56, v43
 v_mfma_f32_16x16x32_bf16 v[80:83], a[40:43], v[196:199], v[80:83]
 buffer_load_dwordx4 v10, s[8:11], s30 offen offset:0 lds
 v_mfma_f32_16x16x32_bf16 v[84:87], a[44:47], v[196:199], v[84:87]
 s_cmp_lt_u32 s33, 98304
 s_cselect_b32 s33, s33, 0
 v_mfma_f32_16x16x32_bf16 v[88:91], a[36:39], v[200:203], v[88:91]
 ds_read_b128 v[168:171], v18 offset:4096
 v_cndmask_b32 v56, 0, v56, s[60:61]
 v_mfma_f32_16x16x32_bf16 v[92:95], a[40:43], v[200:203], v[92:95]
 v_add_f32 v56, v56, v36
 v_add_f32 v56, v56, v37
 v_mfma_f32_16x16x32_bf16 v[96:99], a[44:47], v[200:203], v[96:99]
 v_add_f32 v56, v56, v38
 v_add_f32 v56, v56, v39
 v_mfma_f32_16x16x32_bf16 v[100:103], a[36:39], v[204:207], v[100:103]
 ds_read_b128 v[172:175], v18 offset:6144
 v_mov_b32 v57, v56
 v_mfma_f32_16x16x32_bf16 v[104:107], a[40:43], v[204:207], v[104:107]
 s_nop 1
 v_mfma_f32_16x16x32_bf16 v[108:111], a[44:47], v[204:207], v[108:111]
 s_waitcnt lgkmcnt(4)
 v_mfma_f32_16x16x32_bf16 v[112:115], a[36:39], v[208:211], v[112:115]
 ds_read_b128 v[176:179], v18 offset:8192
 v_mfma_f32_16x16x32_bf16 v[116:119], a[40:43], v[208:211], v[116:119]
 v_permlane32_swap_b32 v56, v57
 v_mfma_f32_16x16x32_bf16 v[120:123], a[44:47], v[208:211], v[120:123]
 v_add_f32 v56, v56, v57
 v_mov_b32 v57, v56
 v_mfma_f32_16x16x32_bf16 v[124:127], a[36:39], v[212:215], v[124:127]
 ds_read_b128 v[180:183], v18 offset:10240
 v_mfma_f32_16x16x32_bf16 v[128:131], a[40:43], v[212:215], v[128:131]
 buffer_load_dwordx4 v11, s[8:11], s30 offen offset:1024 lds
 v_mfma_f32_16x16x32_bf16 v[132:135], a[44:47], v[212:215], v[132:135]
 buffer_load_dwordx4 a[248:251], v31, s[52:55], s51 offen offset:1024 sc1
 v_mfma_f32_16x16x32_bf16 v[136:139], a[36:39], v[216:219], v[136:139]
 ds_read_b128 v[184:187], v18 offset:12288
 v_mfma_f32_16x16x32_bf16 v[140:143], a[40:43], v[216:219], v[140:143]
 s_nop 1
 v_mfma_f32_16x16x32_bf16 v[144:147], a[44:47], v[216:219], v[144:147]
 v_permlane16_swap_b32 v56, v57
 v_mfma_f32_16x16x32_bf16 v[148:151], a[36:39], v[220:223], v[148:151]
 ds_read_b128 v[188:191], v18 offset:14336
 v_add_f32 v56, v56, v57
 v_mfma_f32_16x16x32_bf16 v[152:155], a[40:43], v[220:223], v[152:155]
 v_rcp_f32 v56, v56
 v_mfma_f32_16x16x32_bf16 v[156:159], a[44:47], v[220:223], v[156:159]
 s_waitcnt lgkmcnt(4)
 s_nop 0
 v_mfma_f32_16x16x32_bf16 v[64:67], a[48:51], v[160:163], v[64:67]
 ds_read_b128 v[192:195], v19 offset:0
 v_mul_f32 v36, v36, v56
 v_mfma_f32_16x16x32_bf16 v[68:71], a[52:55], v[160:163], v[68:71]
 v_add_u32 v18, s33, v14
 v_mul_f32 v37, v37, v56
 v_mfma_f32_16x16x32_bf16 v[72:75], a[56:59], v[160:163], v[72:75]
 v_mul_f32 v38, v38, v56
 v_mul_f32 v39, v39, v56
 v_mfma_f32_16x16x32_bf16 v[76:79], a[48:51], v[164:167], v[76:79]
 ds_read_b128 v[196:199], v19 offset:2048
 v_mul_f32 v40, v40, v56
 v_mfma_f32_16x16x32_bf16 v[80:83], a[52:55], v[164:167], v[80:83]
 buffer_load_dwordx4 v12, s[8:11], s30 offen offset:2048 lds
 v_mfma_f32_16x16x32_bf16 v[84:87], a[56:59], v[164:167], v[84:87]
 v_mul_f32 v41, v41, v56
 v_mul_f32 v42, v42, v56
 v_mfma_f32_16x16x32_bf16 v[88:91], a[48:51], v[168:171], v[88:91]
 ds_read_b128 v[200:203], v19 offset:4096
 v_mul_f32 v43, v43, v56
 v_mfma_f32_16x16x32_bf16 v[92:95], a[52:55], v[168:171], v[92:95]
 v_max3_f32 v56, v44, v45, v46
 v_max3_f32 v56, v56, v47, v48
 v_mfma_f32_16x16x32_bf16 v[96:99], a[56:59], v[168:171], v[96:99]
 v_max3_f32 v56, v56, v49, v50
 v_max3_f32 v56, v56, v51, v52
 v_mfma_f32_16x16x32_bf16 v[100:103], a[48:51], v[172:175], v[100:103]
 ds_read_b128 v[204:207], v19 offset:6144
 v_max3_f32 v56, v56, v53, v54
 v_mfma_f32_16x16x32_bf16 v[104:107], a[52:55], v[172:175], v[104:107]
 v_max_f32 v56, v56, v55
 v_mov_b32 v57, v56
 v_mfma_f32_16x16x32_bf16 v[108:111], a[56:59], v[172:175], v[108:111]
 s_waitcnt lgkmcnt(4)
 v_mfma_f32_16x16x32_bf16 v[112:115], a[48:51], v[176:179], v[112:115]
 ds_read_b128 v[208:211], v19 offset:8192
 v_mfma_f32_16x16x32_bf16 v[116:119], a[52:55], v[176:179], v[116:119]
 buffer_load_dwordx4 a[252:255], v31, s[52:55], s51 offen offset:1536 sc1
 v_mfma_f32_16x16x32_bf16 v[120:123], a[56:59], v[176:179], v[120:123]
 s_nop 1
 v_mfma_f32_16x16x32_bf16 v[124:127], a[48:51], v[180:183], v[124:127]
 ds_read_b128 v[212:215], v19 offset:10240
 v_mfma_f32_16x16x32_bf16 v[128:131], a[52:55], v[180:183], v[128:131]
 buffer_load_dwordx4 v13, s[8:11], s30 offen offset:3072 lds
 v_mfma_f32_16x16x32_bf16 v[132:135], a[56:59], v[180:183], v[132:135]
 s_add_u32 s30, s30, 128
 s_add_u32 m0, m0, 16384
 v_mfma_f32_16x16x32_bf16 v[136:139], a[48:51], v[184:187], v[136:139]
 ds_read_b128 v[216:219], v19 offset:12288
 v_mfma_f32_16x16x32_bf16 v[140:143], a[52:55], v[184:187], v[140:143]
 s_cmp_lt_u32 m0, s46
 s_cselect_b32 m0, m0, s47
 v_mfma_f32_16x16x32_bf16 v[144:147], a[56:59], v[184:187], v[144:147]
 v_permlane32_swap_b32 v56, v57
 v_mfma_f32_16x16x32_bf16 v[148:151], a[48:51], v[188:191], v[148:151]
 ds_read_b128 v[220:223], v19 offset:14336
 v_max_f32 v56, v56, v57
 v_mfma_f32_16x16x32_bf16 v[152:155], a[52:55], v[188:191], v[152:155]
 v_mov_b32 v57, v56
 v_mfma_f32_16x16x32_bf16 v[156:159], a[56:59], v[188:191], v[156:159]
 s_waitcnt vmcnt(16) lgkmcnt(4)
 s_barrier
 v_mfma_f32_16x16x32_bf16 v[64:67], a[60:63], v[192:195], v[64:67]
 ds_read_b128 v[160:163], v18 offset:0
 v_mfma_f32_16x16x32_bf16 v[68:71], a[64:67], v[192:195], v[68:71]
 s_nop 1
 v_mfma_f32_16x16x32_bf16 v[72:75], a[68:71], v[192:195], v[72:75]
 v_add_u32 v19, s33, v15
 s_add_u32 s33, s33, 16384
 v_mfma_f32_16x16x32_bf16 v[76:79], a[60:63], v[196:199], v[76:79]
 ds_read_b128 v[164:167], v18 offset:2048
 v_mfma_f32_16x16x32_bf16 v[80:83], a[64:67], v[196:199], v[80:83]
 buffer_load_dwordx4 v10, s[8:11], s30 offen offset:0 lds
 v_mfma_f32_16x16x32_bf16 v[84:87], a[68:71], v[196:199], v[84:87]
 s_cmp_lt_u32 s33, 98304
 s_cselect_b32 s33, s33, 0
 v_mfma_f32_16x16x32_bf16 v[88:91], a[60:63], v[200:203], v[88:91]
 ds_read_b128 v[168:171], v18 offset:4096
 v_mfma_f32_16x16x32_bf16 v[92:95], a[64:67], v[200:203], v[92:95]
 v_permlane16_swap_b32 v56, v57
 v_mfma_f32_16x16x32_bf16 v[96:99], a[68:71], v[200:203], v[96:99]
 v_max_f32 v56, v56, v57
 v_mul_f32 v56, s83, v56
 v_mfma_f32_16x16x32_bf16 v[100:103], a[60:63], v[204:207], v[100:103]
 ds_read_b128 v[172:175], v18 offset:6144
 v_fma_f32 v44, v44, s83, -v56
 v_mfma_f32_16x16x32_bf16 v[104:107], a[64:67], v[204:207], v[104:107]
 buffer_load_dwordx4 v[24:27], v31, s[52:55], s51 offen offset:2048 sc1
 v_mfma_f32_16x16x32_bf16 v[108:111], a[68:71], v[204:207], v[108:111]
 s_waitcnt lgkmcnt(4)
 v_fma_f32 v45, v45, s83, -v56
 v_mfma_f32_16x16x32_bf16 v[112:115], a[60:63], v[208:211], v[112:115]
 ds_read_b128 v[176:179], v18 offset:8192
 v_fma_f32 v46, v46, s83, -v56
 v_mfma_f32_16x16x32_bf16 v[116:119], a[64:67], v[208:211], v[116:119]
 v_fma_f32 v47, v47, s83, -v56
 v_fma_f32 v48, v48, s83, -v56
 v_mfma_f32_16x16x32_bf16 v[120:123], a[68:71], v[208:211], v[120:123]
 v_fma_f32 v49, v49, s83, -v56
 v_fma_f32 v50, v50, s83, -v56
 v_mfma_f32_16x16x32_bf16 v[124:127], a[60:63], v[212:215], v[124:127]
 ds_read_b128 v[180:183], v18 offset:10240
 v_fma_f32 v51, v51, s83, -v56
 v_mfma_f32_16x16x32_bf16 v[128:131], a[64:67], v[212:215], v[128:131]
 buffer_load_dwordx4 v11, s[8:11], s30 offen offset:1024 lds
 v_mfma_f32_16x16x32_bf16 v[132:135], a[68:71], v[212:215], v[132:135]
 v_fma_f32 v52, v52, s83, -v56
 v_fma_f32 v53, v53, s83, -v56
 v_mfma_f32_16x16x32_bf16 v[136:139], a[60:63], v[216:219], v[136:139]
 ds_read_b128 v[184:187], v18 offset:12288
 v_fma_f32 v54, v54, s83, -v56
 v_mfma_f32_16x16x32_bf16 v[140:143], a[64:67], v[216:219], v[140:143]
 v_fma_f32 v55, v55, s83, -v56
 v_mfma_f32_16x16x32_bf16 v[144:147], a[68:71], v[216:219], v[144:147]
 v_exp_f32 v44, v44
 v_mfma_f32_16x16x32_bf16 v[148:151], a[60:63], v[220:223], v[148:151]
 ds_read_b128 v[188:191], v18 offset:14336
 v_mfma_f32_16x16x32_bf16 v[152:155], a[64:67], v[220:223], v[152:155]
 v_exp_f32 v45, v45
 v_mfma_f32_16x16x32_bf16 v[156:159], a[68:71], v[220:223], v[156:159]
 s_waitcnt lgkmcnt(4)
 v_mfma_f32_16x16x32_bf16 v[64:67], a[72:75], v[160:163], v[64:67]
 ds_read_b128 v[192:195], v19 offset:0
 v_mfma_f32_16x16x32_bf16 v[68:71], a[76:79], v[160:163], v[68:71]
 v_add_u32 v18, s33, v14
 v_mfma_f32_16x16x32_bf16 v[72:75], a[80:83], v[160:163], v[72:75]
 v_exp_f32 v46, v46
 v_mfma_f32_16x16x32_bf16 v[76:79], a[72:75], v[164:167], v[76:79]
 ds_read_b128 v[196:199], v19 offset:2048
 v_mfma_f32_16x16x32_bf16 v[80:83], a[76:79], v[164:167], v[80:83]
 buffer_load_dwordx4 v12, s[8:11], s30 offen offset:2048 lds
 v_mfma_f32_16x16x32_bf16 v[84:87], a[80:83], v[164:167], v[84:87]
 v_exp_f32 v47, v47
 v_mfma_f32_16x16x32_bf16 v[88:91], a[72:75], v[168:171], v[88:91]
 ds_read_b128 v[200:203], v19 offset:4096
 v_mfma_f32_16x16x32_bf16 v[92:95], a[76:79], v[168:171], v[92:95]
 buffer_load_dwordx4 v[6:9], v31, s[52:55], s51 offen offset:2560 sc1
 v_mfma_f32_16x16x32_bf16 v[96:99], a[80:83], v[168:171], v[96:99]
 v_exp_f32 v48, v48
 v_mfma_f32_16x16x32_bf16 v[100:103], a[72:75], v[172:175], v[100:103]
 ds_read_b128 v[204:207], v19 offset:6144
 v_mfma_f32_16x16x32_bf16 v[104:107], a[76:79], v[172:175], v[104:107]
 v_exp_f32 v49, v49
 v_mfma_f32_16x16x32_bf16 v[108:111], a[80:83], v[172:175], v[108:111]
 s_waitcnt lgkmcnt(4)
 v_mfma_f32_16x16x32_bf16 v[112:115], a[72:75], v[176:179], v[112:115]
 ds_read_b128 v[208:211], v19 offset:8192
 v_mfma_f32_16x16x32_bf16 v[116:119], a[76:79], v[176:179], v[116:119]
 v_exp_f32 v50, v50
 v_mfma_f32_16x16x32_bf16 v[120:123], a[80:83], v[176:179], v[120:123]
 v_exp_f32 v51, v51
 v_mfma_f32_16x16x32_bf16 v[124:127], a[72:75], v[180:183], v[124:127]
 ds_read_b128 v[212:215], v19 offset:10240
 v_mfma_f32_16x16x32_bf16 v[128:131], a[76:79], v[180:183], v[128:131]
 buffer_load_dwordx4 v13, s[8:11], s30 offen offset:3072 lds
 v_mfma_f32_16x16x32_bf16 v[132:135], a[80:83], v[180:183], v[132:135]
 s_add_u32 s30, s30, 128
 s_add_u32 m0, m0, 16384
 v_mfma_f32_16x16x32_bf16 v[136:139], a[72:75], v[184:187], v[136:139]
 ds_read_b128 v[216:219], v19 offset:12288
 v_mfma_f32_16x16x32_bf16 v[140:143], a[76:79], v[184:187], v[140:143]
 s_cmp_lt_u32 m0, s46
 s_cselect_b32 m0, m0, s47
 v_mfma_f32_16x16x32_bf16 v[144:147], a[80:83], v[184:187], v[144:147]
 v_exp_f32 v52, v52
 v_mfma_f32_16x16x32_bf16 v[148:151], a[72:75], v[188:191], v[148:151]
 ds_read_b128 v[220:223], v19 offset:14336
 v_mfma_f32_16x16x32_bf16 v[152:155], a[76:79], v[188:191], v[152:155]
 v_exp_f32 v53, v53
 v_mfma_f32_16x16x32_bf16 v[156:159], a[80:83], v[188:191], v[156:159]
 s_waitcnt vmcnt(18) lgkmcnt(4)
 s_barrier
 v_mfma_f32_16x16x32_bf16 v[64:67], a[84:87], v[192:195], v[64:67]
 ds_read_b128 v[160:163], v18 offset:0
 v_mfma_f32_16x16x32_bf16 v[68:71], a[88:91], v[192:195], v[68:71]
 v_exp_f32 v54, v54
 v_mfma_f32_16x16x32_bf16 v[72:75], a[92:95], v[192:195], v[72:75]
 v_add_u32 v19, s33, v15
 s_add_u32 s33, s33, 16384
 v_mfma_f32_16x16x32_bf16 v[76:79], a[84:87], v[196:199], v[76:79]
 ds_read_b128 v[164:167], v18 offset:2048
 s_add_u32 s21, s50, 4096
 v_mfma_f32_16x16x32_bf16 v[80:83], a[88:91], v[196:199], v[80:83]
 buffer_load_dwordx4 v10, s[8:11], s30 offen offset:0 lds
 v_mfma_f32_16x16x32_bf16 v[84:87], a[92:95], v[196:199], v[84:87]
 s_cmp_lt_u32 s33, 98304
 s_cselect_b32 s33, s33, 0
 v_mfma_f32_16x16x32_bf16 v[88:91], a[84:87], v[200:203], v[88:91]
 ds_read_b128 v[168:171], v18 offset:4096
 v_mfma_f32_16x16x32_bf16 v[92:95], a[88:91], v[200:203], v[92:95]
 buffer_load_dwordx4 v[60:63], v30, s[16:19], s21 offen offset:2048 sc1
 v_mfma_f32_16x16x32_bf16 v[96:99], a[92:95], v[200:203], v[96:99]
 v_exp_f32 v55, v55
 v_mfma_f32_16x16x32_bf16 v[100:103], a[84:87], v[204:207], v[100:103]
 ds_read_b128 v[172:175], v18 offset:6144
 s_nop 0
 v_mfma_f32_16x16x32_bf16 v[104:107], a[88:91], v[204:207], v[104:107]
 v_add_f32 v56, v52, v53
 v_add_f32 v56, v56, v54
 v_mfma_f32_16x16x32_bf16 v[108:111], a[92:95], v[204:207], v[108:111]
 s_waitcnt lgkmcnt(4)
 v_add_f32 v56, v56, v55
 v_mfma_f32_16x16x32_bf16 v[112:115], a[84:87], v[208:211], v[112:115]
 ds_read_b128 v[176:179], v18 offset:8192
 v_cndmask_b32 v56, 0, v56, s[60:61]
 v_mfma_f32_16x16x32_bf16 v[116:119], a[88:91], v[208:211], v[116:119]
 v_add_f32 v56, v56, v44
 v_add_f32 v56, v56, v45
 v_mfma_f32_16x16x32_bf16 v[120:123], a[92:95], v[208:211], v[120:123]
 v_add_f32 v56, v56, v46
 v_add_f32 v56, v56, v47
 v_mfma_f32_16x16x32_bf16 v[124:127], a[84:87], v[212:215], v[124:127]
 ds_read_b128 v[180:183], v18 offset:10240
 v_add_f32 v56, v56, v48
 v_mfma_f32_16x16x32_bf16 v[128:131], a[88:91], v[212:215], v[128:131]
 buffer_load_dwordx4 v11, s[8:11], s30 offen offset:1024 lds
 v_mfma_f32_16x16x32_bf16 v[132:135], a[92:95], v[212:215], v[132:135]
 v_add_f32 v56, v56, v49
 v_add_f32 v56, v56, v50
 v_mfma_f32_16x16x32_bf16 v[136:139], a[84:87], v[216:219], v[136:139]
 ds_read_b128 v[184:187], v18 offset:12288
 v_add_f32 v56, v56, v51
 v_mfma_f32_16x16x32_bf16 v[140:143], a[88:91], v[216:219], v[140:143]
 v_mov_b32 v57, v56
 v_mfma_f32_16x16x32_bf16 v[144:147], a[92:95], v[216:219], v[144:147]
 s_nop 1
 v_mfma_f32_16x16x32_bf16 v[148:151], a[84:87], v[220:223], v[148:151]
 ds_read_b128 v[188:191], v18 offset:14336
 v_mfma_f32_16x16x32_bf16 v[152:155], a[88:91], v[220:223], v[152:155]
 v_permlane32_swap_b32 v56, v57
 v_mfma_f32_16x16x32_bf16 v[156:159], a[92:95], v[220:223], v[156:159]
 s_waitcnt lgkmcnt(4)
 v_add_f32 v56, v56, v57
 v_mfma_f32_16x16x32_bf16 v[64:67], a[96:99], v[160:163], v[64:67]
 ds_read_b128 v[192:195], v19 offset:0
 v_mov_b32 v57, v56
 v_mfma_f32_16x16x32_bf16 v[68:71], a[100:103], v[160:163], v[68:71]
 v_add_u32 v18, s33, v14
 v_mfma_f32_16x16x32_bf16 v[72:75], a[104:107], v[160:163], v[72:75]
 s_nop 1
 v_mfma_f32_16x16x32_bf16 v[76:79], a[96:99], v[164:167], v[76:79]
 ds_read_b128 v[196:199], v19 offset:2048
 s_add_u32 s21, s50, 8192
 v_mfma_f32_16x16x32_bf16 v[80:83], a[100:103], v[164:167], v[80:83]
 buffer_load_dwordx4 v12, s[8:11], s30 offen offset:2048 lds
 v_mfma_f32_16x16x32_bf16 v[84:87], a[104:107], v[164:167], v[84:87]
 buffer_load_dwordx4 v[248:251], v30, s[16:19], s21 offen offset:2048 sc1
 v_mfma_f32_16x16x32_bf16 v[88:91], a[96:99], v[168:171], v[88:91]
 ds_read_b128 v[200:203], v19 offset:4096
 v_mfma_f32_16x16x32_bf16 v[92:95], a[100:103], v[168:171], v[92:95]
 v_permlane16_swap_b32 v56, v57
 v_mfma_f32_16x16x32_bf16 v[96:99], a[104:107], v[168:171], v[96:99]
 v_add_f32 v56, v56, v57
 v_mfma_f32_16x16x32_bf16 v[100:103], a[96:99], v[172:175], v[100:103]
 ds_read_b128 v[204:207], v19 offset:6144
 v_mfma_f32_16x16x32_bf16 v[104:107], a[100:103], v[172:175], v[104:107]
 v_rcp_f32 v56, v56
 v_mfma_f32_16x16x32_bf16 v[108:111], a[104:107], v[172:175], v[108:111]
 s_waitcnt lgkmcnt(4)
 s_nop 0
 v_mfma_f32_16x16x32_bf16 v[112:115], a[96:99], v[176:179], v[112:115]
 ds_read_b128 v[208:211], v19 offset:8192
 v_mul_f32 v44, v44, v56
 v_mfma_f32_16x16x32_bf16 v[116:119], a[100:103], v[176:179], v[116:119]
 v_mul_f32 v45, v45, v56
 v_mul_f32 v46, v46, v56
 v_mfma_f32_16x16x32_bf16 v[120:123], a[104:107], v[176:179], v[120:123]
 v_mul_f32 v47, v47, v56
 v_mul_f32 v48, v48, v56
 v_mfma_f32_16x16x32_bf16 v[124:127], a[96:99], v[180:183], v[124:127]
 ds_read_b128 v[212:215], v19 offset:10240
 v_mul_f32 v49, v49, v56
 v_mfma_f32_16x16x32_bf16 v[128:131], a[100:103], v[180:183], v[128:131]
 buffer_load_dwordx4 v13, s[8:11], s30 offen offset:3072 lds
 v_mfma_f32_16x16x32_bf16 v[132:135], a[104:107], v[180:183], v[132:135]
 s_add_u32 s30, s30, 128
 s_add_u32 m0, m0, 16384
 v_mfma_f32_16x16x32_bf16 v[136:139], a[96:99], v[184:187], v[136:139]
 ds_read_b128 v[216:219], v19 offset:12288
 v_mul_f32 v50, v50, v56
 v_mfma_f32_16x16x32_bf16 v[140:143], a[100:103], v[184:187], v[140:143]
 s_cmp_lt_u32 m0, s46
 s_cselect_b32 m0, m0, s47
 v_mfma_f32_16x16x32_bf16 v[144:147], a[104:107], v[184:187], v[144:147]
 v_mul_f32 v51, v51, v56
 v_mul_f32 v52, v52, v56
 v_mfma_f32_16x16x32_bf16 v[148:151], a[96:99], v[188:191], v[148:151]
 ds_read_b128 v[220:223], v19 offset:14336
 v_mul_f32 v53, v53, v56
 v_mfma_f32_16x16x32_bf16 v[152:155], a[100:103], v[188:191], v[152:155]
 v_mul_f32 v54, v54, v56
 v_mul_f32 v55, v55, v56
 v_mfma_f32_16x16x32_bf16 v[156:159], a[104:107], v[188:191], v[156:159]
 s_waitcnt vmcnt(19) lgkmcnt(4)
 s_barrier
 v_mfma_f32_16x16x32_bf16 v[64:67], a[108:111], v[192:195], v[64:67]
 ds_read_b128 v[160:163], v18 offset:0
 v_cvt_pk_bf16_f32 v240, v40, v41
 v_mfma_f32_16x16x32_bf16 v[68:71], a[112:115], v[192:195], v[68:71]
 s_add_u32 s21, s50, 8192
 v_cvt_pk_bf16_f32 v241, v42, v43
 v_mfma_f32_16x16x32_bf16 v[72:75], a[116:119], v[192:195], v[72:75]
 v_add_u32 v19, s33, v15
 s_add_u32 s33, s33, 16384
 v_mfma_f32_16x16x32_bf16 v[76:79], a[108:111], v[196:199], v[76:79]
 ds_read_b128 v[164:167], v18 offset:2048
 v_cvt_pk_bf16_f32 v242, v52, v53
 v_mfma_f32_16x16x32_bf16 v[80:83], a[112:115], v[196:199], v[80:83]
 buffer_load_dwordx4 v10, s[8:11], s30 offen offset:0 lds
 v_mfma_f32_16x16x32_bf16 v[84:87], a[116:119], v[196:199], v[84:87]
 s_cmp_lt_u32 s33, 98304
 s_cselect_b32 s33, s33, 0
 v_mfma_f32_16x16x32_bf16 v[88:91], a[108:111], v[200:203], v[88:91]
 ds_read_b128 v[168:171], v18 offset:4096
 v_cvt_pk_bf16_f32 v243, v54, v55
 v_mfma_f32_16x16x32_bf16 v[92:95], a[112:115], v[200:203], v[92:95]
 buffer_load_dwordx4 v[252:255], v30, s[16:19], s21 offen offset:3072 sc1
 v_mfma_f32_16x16x32_bf16 v[96:99], a[116:119], v[200:203], v[96:99]
 v_cvt_pk_bf16_f32 v236, v44, v45
 v_cvt_pk_bf16_f32 v237, v46, v47
 v_mfma_f32_16x16x32_bf16 v[100:103], a[108:111], v[204:207], v[100:103]
 ds_read_b128 v[172:175], v18 offset:6144
 v_cvt_pk_bf16_f32 v238, v48, v49
 v_mfma_f32_16x16x32_bf16 v[104:107], a[112:115], v[204:207], v[104:107]
 v_cvt_pk_bf16_f32 v239, v50, v51
 v_cvt_pk_bf16_f32 v244, v36, v37
 v_mfma_f32_16x16x32_bf16 v[108:111], a[116:119], v[204:207], v[108:111]
 s_waitcnt lgkmcnt(4)
 v_cvt_pk_bf16_f32 v245, v38, v39
 v_mfma_f32_16x16x32_bf16 v[112:115], a[108:111], v[208:211], v[112:115]
 ds_read_b128 v[176:179], v18 offset:8192
 v_mfma_f32_16x16x32_bf16 v[116:119], a[112:115], v[208:211], v[116:119]
 v_permlane16_swap_b32 v240, v242
 v_mfma_f32_16x16x32_bf16 v[120:123], a[116:119], v[208:211], v[120:123]
 v_permlane16_swap_b32 v241, v243
 v_mfma_f32_16x16x32_bf16 v[124:127], a[108:111], v[212:215], v[124:127]
 ds_read_b128 v[180:183], v18 offset:10240
 v_mfma_f32_16x16x32_bf16 v[128:131], a[112:115], v[212:215], v[128:131]
 buffer_load_dwordx4 v11, s[8:11], s30 offen offset:1024 lds
 v_mfma_f32_16x16x32_bf16 v[132:135], a[116:119], v[212:215], v[132:135]
 v_mfma_f32_16x16x32_bf16 v[136:139], a[108:111], v[216:219], v[136:139]
 ds_read_b128 v[184:187], v18 offset:12288
 v_mfma_f32_16x16x32_bf16 v[140:143], a[112:115], v[216:219], v[140:143]
 v_mfma_f32_16x16x32_bf16 v[144:147], a[116:119], v[216:219], v[144:147]
 v_mfma_f32_16x16x32_bf16 v[148:151], a[108:111], v[220:223], v[148:151]
 ds_read_b128 v[188:191], v18 offset:14336
 v_mfma_f32_16x16x32_bf16 v[152:155], a[112:115], v[220:223], v[152:155]
 v_mfma_f32_16x16x32_bf16 v[156:159], a[116:119], v[220:223], v[156:159]
 s_waitcnt lgkmcnt(4)
 v_mfma_f32_16x16x32_bf16 v[64:67], a[120:123], v[160:163], v[64:67]
 ds_read_b128 v[192:195], v19 offset:0
 v_mfma_f32_16x16x32_bf16 v[68:71], a[124:127], v[160:163], v[68:71]
 v_add_u32 v18, s33, v14
 v_mfma_f32_16x16x32_bf16 v[72:75], a[128:131], v[160:163], v[72:75]
 v_mfma_f32_16x16x32_bf16 v[76:79], a[120:123], v[164:167], v[76:79]
 ds_read_b128 v[196:199], v19 offset:2048
 v_mfma_f32_16x16x32_bf16 v[80:83], a[124:127], v[164:167], v[80:83]
 buffer_load_dwordx4 v12, s[8:11], s30 offen offset:2048 lds
 v_mfma_f32_16x16x32_bf16 v[84:87], a[128:131], v[164:167], v[84:87]
 v_mfma_f32_16x16x32_bf16 v[88:91], a[120:123], v[168:171], v[88:91]
 ds_read_b128 v[200:203], v19 offset:4096
 v_mfma_f32_16x16x32_bf16 v[92:95], a[124:127], v[168:171], v[92:95]
 v_mfma_f32_16x16x32_bf16 v[96:99], a[128:131], v[168:171], v[96:99]
 v_mfma_f32_16x16x32_bf16 v[100:103], a[120:123], v[172:175], v[100:103]
 ds_read_b128 v[204:207], v19 offset:6144
 v_mfma_f32_16x16x32_bf16 v[104:107], a[124:127], v[172:175], v[104:107]
 v_mfma_f32_16x16x32_bf16 v[108:111], a[128:131], v[172:175], v[108:111]
 s_waitcnt lgkmcnt(4)
 v_mfma_f32_16x16x32_bf16 v[112:115], a[120:123], v[176:179], v[112:115]
 ds_read_b128 v[208:211], v19 offset:8192
 v_mfma_f32_16x16x32_bf16 v[116:119], a[124:127], v[176:179], v[116:119]
 v_mfma_f32_16x16x32_bf16 v[120:123], a[128:131], v[176:179], v[120:123]
 v_mfma_f32_16x16x32_bf16 v[124:127], a[120:123], v[180:183], v[124:127]
 ds_read_b128 v[212:215], v19 offset:10240
 v_mfma_f32_16x16x32_bf16 v[128:131], a[124:127], v[180:183], v[128:131]
 buffer_load_dwordx4 v13, s[8:11], s30 offen offset:3072 lds
 v_mfma_f32_16x16x32_bf16 v[132:135], a[128:131], v[180:183], v[132:135]
 s_add_u32 s30, s30, s25
 s_sub_u32 s30, s30, 1152
 v_mfma_f32_16x16x32_bf16 v[136:139], a[120:123], v[184:187], v[136:139]
 ds_read_b128 v[216:219], v19 offset:12288
 s_mov_b32 s25, 163840
 v_mfma_f32_16x16x32_bf16 v[140:143], a[124:127], v[184:187], v[140:143]
 s_add_u32 m0, m0, 16384
 v_mfma_f32_16x16x32_bf16 v[144:147], a[128:131], v[184:187], v[144:147]
 s_cmp_lt_u32 m0, s46
 s_cselect_b32 m0, m0, s47
 v_mfma_f32_16x16x32_bf16 v[148:151], a[120:123], v[188:191], v[148:151]
 ds_read_b128 v[220:223], v19 offset:14336
 v_mfma_f32_16x16x32_bf16 v[152:155], a[124:127], v[188:191], v[152:155]
 v_mfma_f32_16x16x32_bf16 v[156:159], a[128:131], v[188:191], v[156:159]
 s_waitcnt vmcnt(17) lgkmcnt(4)
 s_barrier
 v_mfma_f32_16x16x32_bf16 v[64:67], a[132:135], v[192:195], v[64:67]
 ds_read_b128 v[160:163], v18 offset:0
 v_mfma_f32_16x16x32_bf16 v[68:71], a[136:139], v[192:195], v[68:71]
 v_mfma_f32_16x16x32_bf16 v[72:75], a[140:143], v[192:195], v[72:75]
 v_add_u32 v19, s33, v15
 s_add_u32 s33, s33, 16384
 v_mfma_f32_16x16x32_bf16 v[76:79], a[132:135], v[196:199], v[76:79]
 ds_read_b128 v[164:167], v18 offset:2048
 v_mfma_f32_16x16x32_bf16 v[80:83], a[136:139], v[196:199], v[80:83]
 buffer_load_dwordx4 v10, s[8:11], s30 offen offset:0 lds
 v_mfma_f32_16x16x32_bf16 v[84:87], a[140:143], v[196:199], v[84:87]
 s_cmp_lt_u32 s33, 98304
 s_cselect_b32 s33, s33, 0
 v_mfma_f32_16x16x32_bf16 v[88:91], a[132:135], v[200:203], v[88:91]
 ds_read_b128 v[168:171], v18 offset:4096
 v_mfma_f32_16x16x32_bf16 v[92:95], a[136:139], v[200:203], v[92:95]
 buffer_store_dwordx4 v[236:239], v30, s[56:59], s81 offen sc1
 v_mfma_f32_16x16x32_bf16 v[96:99], a[140:143], v[200:203], v[96:99]
 v_mfma_f32_16x16x32_bf16 v[100:103], a[132:135], v[204:207], v[100:103]
 ds_read_b128 v[172:175], v18 offset:6144
 v_mfma_f32_16x16x32_bf16 v[104:107], a[136:139], v[204:207], v[104:107]
 v_mfma_f32_16x16x32_bf16 v[108:111], a[140:143], v[204:207], v[108:111]
 s_waitcnt lgkmcnt(4)
 v_mfma_f32_16x16x32_bf16 v[112:115], a[132:135], v[208:211], v[112:115]
 ds_read_b128 v[176:179], v18 offset:8192
 v_mfma_f32_16x16x32_bf16 v[116:119], a[136:139], v[208:211], v[116:119]
 s_mov_b64 exec, 0xffffffff
 buffer_store_dwordx4 v[240:243], v30, s[56:59], s81 offen offset:1024 sc1
 s_mov_b64 exec, -1
 v_mfma_f32_16x16x32_bf16 v[120:123], a[140:143], v[208:211], v[120:123]
 v_mfma_f32_16x16x32_bf16 v[124:127], a[132:135], v[212:215], v[124:127]
 ds_read_b128 v[180:183], v18 offset:10240
 v_mfma_f32_16x16x32_bf16 v[128:131], a[136:139], v[212:215], v[128:131]
 buffer_load_dwordx4 v11, s[8:11], s30 offen offset:1024 lds
 v_mfma_f32_16x16x32_bf16 v[132:135], a[140:143], v[212:215], v[132:135]
 v_mfma_f32_16x16x32_bf16 v[136:139], a[132:135], v[216:219], v[136:139]
 ds_read_b128 v[184:187], v18 offset:12288
 v_mfma_f32_16x16x32_bf16 v[140:143], a[136:139], v[216:219], v[140:143]
 buffer_store_dwordx2 v[244:245], v32, s[56:59], s81 offen offset:1536 sc1
 v_mfma_f32_16x16x32_bf16 v[144:147], a[140:143], v[216:219], v[144:147]
 s_mov_b32 s78, s82
 s_mov_b32 s82, 0
 v_mfma_f32_16x16x32_bf16 v[148:151], a[132:135], v[220:223], v[148:151]
 ds_read_b128 v[188:191], v18 offset:14336
 s_mov_b32 s81, 0x80000000
 v_mfma_f32_16x16x32_bf16 v[152:155], a[136:139], v[220:223], v[152:155]
 v_mfma_f32_16x16x32_bf16 v[156:159], a[140:143], v[220:223], v[156:159]
 s_waitcnt lgkmcnt(4)
 s_add_u32 s21, s50, 0
 v_mfma_f32_16x16x32_bf16 v[64:67], a[144:147], v[160:163], v[64:67]
 ds_read_b128 v[192:195], v19 offset:0
 v_mfma_f32_16x16x32_bf16 v[68:71], a[148:151], v[160:163], v[68:71]
 v_add_u32 v18, s33, v14
 v_mfma_f32_16x16x32_bf16 v[72:75], a[152:155], v[160:163], v[72:75]
 buffer_load_dwordx4 v[36:39], v30, s[16:19], s21 offen offset:0 sc1
 v_mfma_f32_16x16x32_bf16 v[76:79], a[144:147], v[164:167], v[76:79]
 ds_read_b128 v[196:199], v19 offset:2048
 v_mfma_f32_16x16x32_bf16 v[80:83], a[148:151], v[164:167], v[80:83]
 buffer_load_dwordx4 v12, s[8:11], s30 offen offset:2048 lds
 v_mfma_f32_16x16x32_bf16 v[84:87], a[152:155], v[164:167], v[84:87]
 v_mfma_f32_16x16x32_bf16 v[88:91], a[144:147], v[168:171], v[88:91]
 ds_read_b128 v[200:203], v19 offset:4096
 v_mfma_f32_16x16x32_bf16 v[92:95], a[148:151], v[168:171], v[92:95]
 v_mfma_f32_16x16x32_bf16 v[96:99], a[152:155], v[168:171], v[96:99]
 v_mfma_f32_16x16x32_bf16 v[100:103], a[144:147], v[172:175], v[100:103]
 ds_read_b128 v[204:207], v19 offset:6144
 v_mfma_f32_16x16x32_bf16 v[104:107], a[148:151], v[172:175], v[104:107]
 v_mfma_f32_16x16x32_bf16 v[108:111], a[152:155], v[172:175], v[108:111]
 s_waitcnt lgkmcnt(4)
 v_mfma_f32_16x16x32_bf16 v[112:115], a[144:147], v[176:179], v[112:115]
 ds_read_b128 v[208:211], v19 offset:8192
 s_add_u32 s21, s50, 0
 v_mfma_f32_16x16x32_bf16 v[116:119], a[148:151], v[176:179], v[116:119]
 buffer_load_dwordx4 v[40:43], v30, s[16:19], s21 offen offset:1024 sc1
 v_mfma_f32_16x16x32_bf16 v[120:123], a[152:155], v[176:179], v[120:123]
 v_mfma_f32_16x16x32_bf16 v[124:127], a[144:147], v[180:183], v[124:127]
 ds_read_b128 v[212:215], v19 offset:10240
 v_mfma_f32_16x16x32_bf16 v[128:131], a[148:151], v[180:183], v[128:131]
 buffer_load_dwordx4 v13, s[8:11], s30 offen offset:3072 lds
 v_mfma_f32_16x16x32_bf16 v[132:135], a[152:155], v[180:183], v[132:135]
 s_add_u32 s30, s30, 128
 s_add_u32 m0, m0, 16384
 v_mfma_f32_16x16x32_bf16 v[136:139], a[144:147], v[184:187], v[136:139]
 ds_read_b128 v[216:219], v19 offset:12288
 v_mfma_f32_16x16x32_bf16 v[140:143], a[148:151], v[184:187], v[140:143]
 s_cmp_lt_u32 m0, s46
 s_cselect_b32 m0, m0, s47
 v_mfma_f32_16x16x32_bf16 v[144:147], a[152:155], v[184:187], v[144:147]
 v_mfma_f32_16x16x32_bf16 v[148:151], a[144:147], v[188:191], v[148:151]
 ds_read_b128 v[220:223], v19 offset:14336
 v_mfma_f32_16x16x32_bf16 v[152:155], a[148:151], v[188:191], v[152:155]
 v_mfma_f32_16x16x32_bf16 v[156:159], a[152:155], v[188:191], v[156:159]
 s_waitcnt vmcnt(20) lgkmcnt(4)
 s_barrier
 v_mfma_f32_16x16x32_bf16 v[64:67], a[156:159], v[192:195], v[64:67]
 ds_read_b128 v[160:163], v18 offset:0
 s_add_u32 s21, s50, 0
 v_mfma_f32_16x16x32_bf16 v[68:71], a[160:163], v[192:195], v[68:71]
 buffer_load_dwordx4 v[44:47], v30, s[16:19], s21 offen offset:2048 sc1
 v_mfma_f32_16x16x32_bf16 v[72:75], a[164:167], v[192:195], v[72:75]
 v_add_u32 v19, s33, v15
 s_add_u32 s33, s33, 16384
 v_mfma_f32_16x16x32_bf16 v[76:79], a[156:159], v[196:199], v[76:79]
 ds_read_b128 v[164:167], v18 offset:2048
 v_mfma_f32_16x16x32_bf16 v[80:83], a[160:163], v[196:199], v[80:83]
 buffer_load_dwordx4 v10, s[8:11], s30 offen offset:0 lds
 v_mfma_f32_16x16x32_bf16 v[84:87], a[164:167], v[196:199], v[84:87]
 s_cmp_lt_u32 s33, 98304
 s_cselect_b32 s33, s33, 0
 v_mfma_f32_16x16x32_bf16 v[88:91], a[156:159], v[200:203], v[88:91]
 ds_read_b128 v[168:171], v18 offset:4096
 v_mfma_f32_16x16x32_bf16 v[92:95], a[160:163], v[200:203], v[92:95]
 v_mfma_f32_16x16x32_bf16 v[96:99], a[164:167], v[200:203], v[96:99]
 v_mfma_f32_16x16x32_bf16 v[100:103], a[156:159], v[204:207], v[100:103]
 ds_read_b128 v[172:175], v18 offset:6144
 v_mfma_f32_16x16x32_bf16 v[104:107], a[160:163], v[204:207], v[104:107]
 v_mfma_f32_16x16x32_bf16 v[108:111], a[164:167], v[204:207], v[108:111]
 s_waitcnt lgkmcnt(4)
 s_add_u32 s21, s50, 0
 v_mfma_f32_16x16x32_bf16 v[112:115], a[156:159], v[208:211], v[112:115]
 ds_read_b128 v[176:179], v18 offset:8192
 v_mfma_f32_16x16x32_bf16 v[116:119], a[160:163], v[208:211], v[116:119]
 buffer_load_dwordx4 v[48:51], v30, s[16:19], s21 offen offset:3072 sc1
 v_mfma_f32_16x16x32_bf16 v[120:123], a[164:167], v[208:211], v[120:123]
 v_mfma_f32_16x16x32_bf16 v[124:127], a[156:159], v[212:215], v[124:127]
 ds_read_b128 v[180:183], v18 offset:10240
 v_mfma_f32_16x16x32_bf16 v[128:131], a[160:163], v[212:215], v[128:131]
 buffer_load_dwordx4 v11, s[8:11], s30 offen offset:1024 lds
 v_mfma_f32_16x16x32_bf16 v[132:135], a[164:167], v[212:215], v[132:135]
 v_mfma_f32_16x16x32_bf16 v[136:139], a[156:159], v[216:219], v[136:139]
 ds_read_b128 v[184:187], v18 offset:12288
 v_mfma_f32_16x16x32_bf16 v[140:143], a[160:163], v[216:219], v[140:143]
 v_mfma_f32_16x16x32_bf16 v[144:147], a[164:167], v[216:219], v[144:147]
 v_mfma_f32_16x16x32_bf16 v[148:151], a[156:159], v[220:223], v[148:151]
 ds_read_b128 v[188:191], v18 offset:14336
 v_mfma_f32_16x16x32_bf16 v[152:155], a[160:163], v[220:223], v[152:155]
 v_mfma_f32_16x16x32_bf16 v[156:159], a[164:167], v[220:223], v[156:159]
 s_waitcnt lgkmcnt(4)
 s_add_u32 s21, s50, 4096
 v_mfma_f32_16x16x32_bf16 v[64:67], a[168:171], v[160:163], v[64:67]
 ds_read_b128 v[192:195], v19 offset:0
 v_mfma_f32_16x16x32_bf16 v[68:71], a[172:175], v[160:163], v[68:71]
 v_add_u32 v18, s33, v14
 v_mfma_f32_16x16x32_bf16 v[72:75], a[176:179], v[160:163], v[72:75]
 buffer_load_dwordx4 v[52:55], v30, s[16:19], s21 offen offset:0 sc1
 v_mfma_f32_16x16x32_bf16 v[76:79], a[168:171], v[164:167], v[76:79]
 ds_read_b128 v[196:199], v19 offset:2048
 v_mfma_f32_16x16x32_bf16 v[80:83], a[172:175], v[164:167], v[80:83]
 buffer_load_dwordx4 v12, s[8:11], s30 offen offset:2048 lds
 v_mfma_f32_16x16x32_bf16 v[84:87], a[176:179], v[164:167], v[84:87]
 v_mfma_f32_16x16x32_bf16 v[88:91], a[168:171], v[168:171], v[88:91]
 ds_read_b128 v[200:203], v19 offset:4096
 v_mfma_f32_16x16x32_bf16 v[92:95], a[172:175], v[168:171], v[92:95]
 v_mfma_f32_16x16x32_bf16 v[96:99], a[176:179], v[168:171], v[96:99]
 v_mfma_f32_16x16x32_bf16 v[100:103], a[168:171], v[172:175], v[100:103]
 ds_read_b128 v[204:207], v19 offset:6144
 v_mfma_f32_16x16x32_bf16 v[104:107], a[172:175], v[172:175], v[104:107]
 v_mfma_f32_16x16x32_bf16 v[108:111], a[176:179], v[172:175], v[108:111]
 s_waitcnt lgkmcnt(4)
 v_mfma_f32_16x16x32_bf16 v[112:115], a[168:171], v[176:179], v[112:115]
 ds_read_b128 v[208:211], v19 offset:8192
 s_add_u32 s21, s50, 4096
 v_mfma_f32_16x16x32_bf16 v[116:119], a[172:175], v[176:179], v[116:119]
 buffer_load_dwordx4 v[56:59], v30, s[16:19], s21 offen offset:1024 sc1
 v_mfma_f32_16x16x32_bf16 v[120:123], a[176:179], v[176:179], v[120:123]
 v_mfma_f32_16x16x32_bf16 v[124:127], a[168:171], v[180:183], v[124:127]
 ds_read_b128 v[212:215], v19 offset:10240
 v_mfma_f32_16x16x32_bf16 v[128:131], a[172:175], v[180:183], v[128:131]
 buffer_load_dwordx4 v13, s[8:11], s30 offen offset:3072 lds
 v_mfma_f32_16x16x32_bf16 v[132:135], a[176:179], v[180:183], v[132:135]
 s_add_u32 s30, s30, 128
 s_add_u32 m0, m0, 16384
 v_mfma_f32_16x16x32_bf16 v[136:139], a[168:171], v[184:187], v[136:139]
 ds_read_b128 v[216:219], v19 offset:12288
 v_mfma_f32_16x16x32_bf16 v[140:143], a[172:175], v[184:187], v[140:143]
 s_cmp_lt_u32 m0, s46
 s_cselect_b32 m0, m0, s47
 v_mfma_f32_16x16x32_bf16 v[144:147], a[176:179], v[184:187], v[144:147]
 v_mfma_f32_16x16x32_bf16 v[148:151], a[168:171], v[188:191], v[148:151]
 ds_read_b128 v[220:223], v19 offset:14336
 v_mfma_f32_16x16x32_bf16 v[152:155], a[172:175], v[188:191], v[152:155]
 v_mfma_f32_16x16x32_bf16 v[156:159], a[176:179], v[188:191], v[156:159]
 s_waitcnt vmcnt(22) lgkmcnt(4)
 s_barrier
 v_mfma_f32_16x16x32_bf16 v[64:67], a[180:183], v[192:195], v[64:67]
 ds_read_b128 v[160:163], v18 offset:0
 s_add_u32 s21, s50, 4096
 v_mfma_f32_16x16x32_bf16 v[68:71], a[184:187], v[192:195], v[68:71]
 buffer_load_dwordx4 v[236:239], v30, s[16:19], s21 offen offset:3072 sc1
 v_mfma_f32_16x16x32_bf16 v[72:75], a[188:191], v[192:195], v[72:75]
 v_add_u32 v19, s33, v15
 s_add_u32 s33, s33, 16384
 v_mfma_f32_16x16x32_bf16 v[76:79], a[180:183], v[196:199], v[76:79]
 ds_read_b128 v[164:167], v18 offset:2048
 v_mfma_f32_16x16x32_bf16 v[80:83], a[184:187], v[196:199], v[80:83]
 buffer_load_dwordx4 v10, s[8:11], s30 offen offset:0 lds
 v_mfma_f32_16x16x32_bf16 v[84:87], a[188:191], v[196:199], v[84:87]
 s_cmp_lt_u32 s33, 98304
 s_cselect_b32 s33, s33, 0
 v_mfma_f32_16x16x32_bf16 v[88:91], a[180:183], v[200:203], v[88:91]
 ds_read_b128 v[168:171], v18 offset:4096
 v_mfma_f32_16x16x32_bf16 v[92:95], a[184:187], v[200:203], v[92:95]
 v_mfma_f32_16x16x32_bf16 v[96:99], a[188:191], v[200:203], v[96:99]
 v_mfma_f32_16x16x32_bf16 v[100:103], a[180:183], v[204:207], v[100:103]
 ds_read_b128 v[172:175], v18 offset:6144
 v_mfma_f32_16x16x32_bf16 v[104:107], a[184:187], v[204:207], v[104:107]
 v_mfma_f32_16x16x32_bf16 v[108:111], a[188:191], v[204:207], v[108:111]
 s_waitcnt lgkmcnt(4)
 s_add_u32 s21, s50, 8192
 v_mfma_f32_16x16x32_bf16 v[112:115], a[180:183], v[208:211], v[112:115]
 ds_read_b128 v[176:179], v18 offset:8192
 v_mfma_f32_16x16x32_bf16 v[116:119], a[184:187], v[208:211], v[116:119]
 buffer_load_dwordx4 v[240:243], v30, s[16:19], s21 offen offset:0 sc1
 v_mfma_f32_16x16x32_bf16 v[120:123], a[188:191], v[208:211], v[120:123]
 v_mfma_f32_16x16x32_bf16 v[124:127], a[180:183], v[212:215], v[124:127]
 ds_read_b128 v[180:183], v18 offset:10240
 v_mfma_f32_16x16x32_bf16 v[128:131], a[184:187], v[212:215], v[128:131]
 buffer_load_dwordx4 v11, s[8:11], s30 offen offset:1024 lds
 v_mfma_f32_16x16x32_bf16 v[132:135], a[188:191], v[212:215], v[132:135]
 v_mfma_f32_16x16x32_bf16 v[136:139], a[180:183], v[216:219], v[136:139]
 ds_read_b128 v[184:187], v18 offset:12288
 v_mfma_f32_16x16x32_bf16 v[140:143], a[184:187], v[216:219], v[140:143]
 v_mfma_f32_16x16x32_bf16 v[144:147], a[188:191], v[216:219], v[144:147]
 v_mfma_f32_16x16x32_bf16 v[148:151], a[180:183], v[220:223], v[148:151]
 ds_read_b128 v[188:191], v18 offset:14336
 v_mfma_f32_16x16x32_bf16 v[152:155], a[184:187], v[220:223], v[152:155]
 v_mfma_f32_16x16x32_bf16 v[156:159], a[188:191], v[220:223], v[156:159]
 s_waitcnt lgkmcnt(4)
 s_add_u32 s21, s50, 8192
 v_mfma_f32_16x16x32_bf16 v[64:67], a[192:195], v[160:163], v[64:67]
 ds_read_b128 v[192:195], v19 offset:0
 v_mfma_f32_16x16x32_bf16 v[68:71], a[196:199], v[160:163], v[68:71]
 v_add_u32 v18, s33, v14
 v_mfma_f32_16x16x32_bf16 v[72:75], a[200:203], v[160:163], v[72:75]
 buffer_load_dwordx4 v[244:247], v30, s[16:19], s21 offen offset:1024 sc1
 v_mfma_f32_16x16x32_bf16 v[76:79], a[192:195], v[164:167], v[76:79]
 ds_read_b128 v[196:199], v19 offset:2048
 v_mfma_f32_16x16x32_bf16 v[80:83], a[196:199], v[164:167], v[80:83]
 buffer_load_dwordx4 v12, s[8:11], s30 offen offset:2048 lds
 v_mfma_f32_16x16x32_bf16 v[84:87], a[200:203], v[164:167], v[84:87]
 v_mfma_f32_16x16x32_bf16 v[88:91], a[192:195], v[168:171], v[88:91]
 ds_read_b128 v[200:203], v19 offset:4096
 v_mfma_f32_16x16x32_bf16 v[92:95], a[196:199], v[168:171], v[92:95]
 v_mfma_f32_16x16x32_bf16 v[96:99], a[200:203], v[168:171], v[96:99]
 v_mfma_f32_16x16x32_bf16 v[100:103], a[192:195], v[172:175], v[100:103]
 ds_read_b128 v[204:207], v19 offset:6144
 v_mfma_f32_16x16x32_bf16 v[104:107], a[196:199], v[172:175], v[104:107]
 v_mfma_f32_16x16x32_bf16 v[108:111], a[200:203], v[172:175], v[108:111]
 s_waitcnt lgkmcnt(4)
 v_mfma_f32_16x16x32_bf16 v[112:115], a[192:195], v[176:179], v[112:115]
 ds_read_b128 v[208:211], v19 offset:8192
 v_mfma_f32_16x16x32_bf16 v[116:119], a[196:199], v[176:179], v[116:119]
 v_mfma_f32_16x16x32_bf16 v[120:123], a[200:203], v[176:179], v[120:123]
 v_mfma_f32_16x16x32_bf16 v[124:127], a[192:195], v[180:183], v[124:127]
 ds_read_b128 v[212:215], v19 offset:10240
 v_mfma_f32_16x16x32_bf16 v[128:131], a[196:199], v[180:183], v[128:131]
 buffer_load_dwordx4 v13, s[8:11], s30 offen offset:3072 lds
 v_mfma_f32_16x16x32_bf16 v[132:135], a[200:203], v[180:183], v[132:135]
 s_add_u32 s30, s30, 128
 s_add_u32 m0, m0, 16384
 v_mfma_f32_16x16x32_bf16 v[136:139], a[192:195], v[184:187], v[136:139]
 ds_read_b128 v[216:219], v19 offset:12288
 v_mfma_f32_16x16x32_bf16 v[140:143], a[196:199], v[184:187], v[140:143]
 s_cmp_lt_u32 m0, s46
 s_cselect_b32 m0, m0, s47
 v_mfma_f32_16x16x32_bf16 v[144:147], a[200:203], v[184:187], v[144:147]
 v_mfma_f32_16x16x32_bf16 v[148:151], a[192:195], v[188:191], v[148:151]
 ds_read_b128 v[220:223], v19 offset:14336
 v_mfma_f32_16x16x32_bf16 v[152:155], a[196:199], v[188:191], v[152:155]
 v_mfma_f32_16x16x32_bf16 v[156:159], a[200:203], v[188:191], v[156:159]
 s_waitcnt vmcnt(24) lgkmcnt(4)
 s_barrier
 v_mfma_f32_16x16x32_bf16 v[64:67], a[204:207], v[192:195], v[64:67]
 ds_read_b128 v[160:163], v18 offset:0
 v_mfma_f32_16x16x32_bf16 v[68:71], a[208:211], v[192:195], v[68:71]
 v_mfma_f32_16x16x32_bf16 v[72:75], a[212:215], v[192:195], v[72:75]
 v_add_u32 v19, s33, v15
 s_add_u32 s33, s33, 16384
 v_mfma_f32_16x16x32_bf16 v[76:79], a[204:207], v[196:199], v[76:79]
 ds_read_b128 v[164:167], v18 offset:2048
 v_mfma_f32_16x16x32_bf16 v[80:83], a[208:211], v[196:199], v[80:83]
 buffer_load_dwordx4 v10, s[8:11], s30 offen offset:0 lds
 v_mfma_f32_16x16x32_bf16 v[84:87], a[212:215], v[196:199], v[84:87]
 s_cmp_lt_u32 s33, 98304
 s_cselect_b32 s33, s33, 0
 v_mfma_f32_16x16x32_bf16 v[88:91], a[204:207], v[200:203], v[88:91]
 ds_read_b128 v[168:171], v18 offset:4096
 v_mfma_f32_16x16x32_bf16 v[92:95], a[208:211], v[200:203], v[92:95]
 v_mfma_f32_16x16x32_bf16 v[96:99], a[212:215], v[200:203], v[96:99]
 v_mfma_f32_16x16x32_bf16 v[100:103], a[204:207], v[204:207], v[100:103]
 ds_read_b128 v[172:175], v18 offset:6144
 v_mfma_f32_16x16x32_bf16 v[104:107], a[208:211], v[204:207], v[104:107]
 v_mfma_f32_16x16x32_bf16 v[108:111], a[212:215], v[204:207], v[108:111]
 s_waitcnt lgkmcnt(4)
 v_mfma_f32_16x16x32_bf16 v[112:115], a[204:207], v[208:211], v[112:115]
 ds_read_b128 v[176:179], v18 offset:8192
 v_mfma_f32_16x16x32_bf16 v[116:119], a[208:211], v[208:211], v[116:119]
 v_mfma_f32_16x16x32_bf16 v[120:123], a[212:215], v[208:211], v[120:123]
 v_mfma_f32_16x16x32_bf16 v[124:127], a[204:207], v[212:215], v[124:127]
 ds_read_b128 v[180:183], v18 offset:10240
 v_mfma_f32_16x16x32_bf16 v[128:131], a[208:211], v[212:215], v[128:131]
 buffer_load_dwordx4 v11, s[8:11], s30 offen offset:1024 lds
 v_mfma_f32_16x16x32_bf16 v[132:135], a[212:215], v[212:215], v[132:135]
 v_mfma_f32_16x16x32_bf16 v[136:139], a[204:207], v[216:219], v[136:139]
 ds_read_b128 v[184:187], v18 offset:12288
 v_mfma_f32_16x16x32_bf16 v[140:143], a[208:211], v[216:219], v[140:143]
 v_mfma_f32_16x16x32_bf16 v[144:147], a[212:215], v[216:219], v[144:147]
 v_mfma_f32_16x16x32_bf16 v[148:151], a[204:207], v[220:223], v[148:151]
 ds_read_b128 v[188:191], v18 offset:14336
 v_mfma_f32_16x16x32_bf16 v[152:155], a[208:211], v[220:223], v[152:155]
 v_mfma_f32_16x16x32_bf16 v[156:159], a[212:215], v[220:223], v[156:159]
 s_waitcnt lgkmcnt(4)
 v_mfma_f32_16x16x32_bf16 v[64:67], a[216:219], v[160:163], v[64:67]
 ds_read_b128 v[192:195], v19 offset:0
 v_mfma_f32_16x16x32_bf16 v[68:71], a[220:223], v[160:163], v[68:71]
 v_add_u32 v18, s33, v14
 v_mfma_f32_16x16x32_bf16 v[72:75], a[224:227], v[160:163], v[72:75]
 v_mfma_f32_16x16x32_bf16 v[76:79], a[216:219], v[164:167], v[76:79]
 ds_read_b128 v[196:199], v19 offset:2048
 v_mfma_f32_16x16x32_bf16 v[80:83], a[220:223], v[164:167], v[80:83]
 buffer_load_dwordx4 v12, s[8:11], s30 offen offset:2048 lds
 v_mfma_f32_16x16x32_bf16 v[84:87], a[224:227], v[164:167], v[84:87]
 v_mfma_f32_16x16x32_bf16 v[88:91], a[216:219], v[168:171], v[88:91]
 ds_read_b128 v[200:203], v19 offset:4096
 v_mfma_f32_16x16x32_bf16 v[92:95], a[220:223], v[168:171], v[92:95]
 v_mfma_f32_16x16x32_bf16 v[96:99], a[224:227], v[168:171], v[96:99]
 v_mfma_f32_16x16x32_bf16 v[100:103], a[216:219], v[172:175], v[100:103]
 ds_read_b128 v[204:207], v19 offset:6144
 v_mfma_f32_16x16x32_bf16 v[104:107], a[220:223], v[172:175], v[104:107]
 v_mfma_f32_16x16x32_bf16 v[108:111], a[224:227], v[172:175], v[108:111]
 s_waitcnt lgkmcnt(4)
 v_mfma_f32_16x16x32_bf16 v[112:115], a[216:219], v[176:179], v[112:115]
 ds_read_b128 v[208:211], v19 offset:8192
 v_mfma_f32_16x16x32_bf16 v[116:119], a[220:223], v[176:179], v[116:119]
 v_mfma_f32_16x16x32_bf16 v[120:123], a[224:227], v[176:179], v[120:123]
 v_mfma_f32_16x16x32_bf16 v[124:127], a[216:219], v[180:183], v[124:127]
 ds_read_b128 v[212:215], v19 offset:10240
 v_mfma_f32_16x16x32_bf16 v[128:131], a[220:223], v[180:183], v[128:131]
 buffer_load_dwordx4 v13, s[8:11], s30 offen offset:3072 lds
 v_mfma_f32_16x16x32_bf16 v[132:135], a[224:227], v[180:183], v[132:135]
 s_add_u32 s30, s30, 128
 s_add_u32 m0, m0, 16384
 v_mfma_f32_16x16x32_bf16 v[136:139], a[216:219], v[184:187], v[136:139]
 ds_read_b128 v[216:219], v19 offset:12288
 v_mfma_f32_16x16x32_bf16 v[140:143], a[220:223], v[184:187], v[140:143]
 s_cmp_lt_u32 m0, s46
 s_cselect_b32 m0, m0, s47
 v_mfma_f32_16x16x32_bf16 v[144:147], a[224:227], v[184:187], v[144:147]
 v_mfma_f32_16x16x32_bf16 v[148:151], a[216:219], v[188:191], v[148:151]
 ds_read_b128 v[220:223], v19 offset:14336
 v_mfma_f32_16x16x32_bf16 v[152:155], a[220:223], v[188:191], v[152:155]
 v_mfma_f32_16x16x32_bf16 v[156:159], a[224:227], v[188:191], v[156:159]
 s_waitcnt vmcnt(19) lgkmcnt(4)
 s_barrier
 v_mfma_f32_16x16x32_bf16 v[64:67], a[228:231], v[192:195], v[64:67]
 ds_read_b128 v[160:163], v18 offset:0
 v_mfma_f32_16x16x32_bf16 v[68:71], a[232:235], v[192:195], v[68:71]
 s_waitcnt vmcnt(22)
 s_cmp_eq_u32 s78, 0
 s_cbranch_scc1 pf_201
 v_mov_b32 v4, 0
 v_mov_b32 v5, 1
 s_mov_b64 exec, 1
 buffer_atomic_add v5, v4, s[72:75], s78 offen sc1
 s_mov_b64 exec, -1
 s_mov_b32 s78, 0
pf_201:
 buffer_load_dword v21, v33, s[72:75], s77 offen sc1
 v_mfma_f32_16x16x32_bf16 v[72:75], a[236:239], v[192:195], v[72:75]
 v_add_u32 v19, s33, v15
 s_add_u32 s33, s33, 16384
 v_mfma_f32_16x16x32_bf16 v[76:79], a[228:231], v[196:199], v[76:79]
 ds_read_b128 v[164:167], v18 offset:2048
 v_cvt_pk_bf16_f32 v224, v64, v65
 v_cvt_pk_bf16_f32 v225, v66, v67
 v_mfma_f32_16x16x32_bf16 v[80:83], a[232:235], v[196:199], v[80:83]
 buffer_load_dwordx4 v10, s[8:11], s30 offen offset:0 lds
 v_cvt_pk_bf16_f32 v226, v68, v69
 v_cvt_pk_bf16_f32 v227, v70, v71
 v_mfma_f32_16x16x32_bf16 v[84:87], a[236:239], v[196:199], v[84:87]
 s_cmp_lt_u32 s33, 98304
 s_cselect_b32 s33, s33, 0
 v_cvt_pk_bf16_f32 v228, v72, v73
 v_cvt_pk_bf16_f32 v229, v74, v75
 v_mfma_f32_16x16x32_bf16 v[88:91], a[228:231], v[200:203], v[88:91]
 ds_read_b128 v[168:171], v18 offset:4096
 ds_write_b64 v22, v[224:225] offset:0
 v_mfma_f32_16x16x32_bf16 v[92:95], a[232:235], v[200:203], v[92:95]
 ds_write_b64 v22, v[226:227] offset:8
 ds_write_b64 v16, v[228:229] offset:64
 v_mfma_f32_16x16x32_bf16 v[96:99], a[236:239], v[200:203], v[96:99]
 v_cvt_pk_bf16_f32 v230, v76, v77
 v_cvt_pk_bf16_f32 v231, v78, v79
 v_cvt_pk_bf16_f32 v232, v80, v81
 v_cvt_pk_bf16_f32 v233, v82, v83
 v_mfma_f32_16x16x32_bf16 v[100:103], a[228:231], v[204:207], v[100:103]
 ds_read_b128 v[172:175], v18 offset:6144
 v_cvt_pk_bf16_f32 v234, v84, v85
 v_cvt_pk_bf16_f32 v235, v86, v87
 v_mfma_f32_16x16x32_bf16 v[104:107], a[232:235], v[204:207], v[104:107]
 ds_write_b64 v22, v[230:231] offset:6400
 ds_write_b64 v22, v[232:233] offset:6408
 v_mfma_f32_16x16x32_bf16 v[108:111], a[236:239], v[204:207], v[108:111]
 s_waitcnt lgkmcnt(9)
 ds_write_b64 v16, v[234:235] offset:6464
 v_cvt_pk_bf16_f32 v224, v88, v89
 v_mfma_f32_16x16x32_bf16 v[112:115], a[228:231], v[208:211], v[112:115]
 ds_read_b128 v[176:179], v18 offset:8192
 v_cvt_pk_bf16_f32 v225, v90, v91
 v_cvt_pk_bf16_f32 v226, v92, v93
 v_cvt_pk_bf16_f32 v227, v94, v95
 v_mfma_f32_16x16x32_bf16 v[116:119], a[232:235], v[208:211], v[116:119]
 v_cvt_pk_bf16_f32 v228, v96, v97
 v_cvt_pk_bf16_f32 v229, v98, v99
 ds_write_b64 v22, v[224:225] offset:12800
 v_mfma_f32_16x16x32_bf16 v[120:123], a[236:239], v[208:211], v[120:123]
 ds_write_b64 v22, v[226:227] offset:12808
 ds_write_b64 v16, v[228:229] offset:12864
 v_mfma_f32_16x16x32_bf16 v[124:127], a[228:231], v[212:215], v[124:127]
 ds_read_b128 v[180:183], v18 offset:10240
 v_cvt_pk_bf16_f32 v230, v100, v101
 v_cvt_pk_bf16_f32 v231, v102, v103
 v_cvt_pk_bf16_f32 v232, v104, v105
 v_mfma_f32_16x16x32_bf16 v[128:131], a[232:235], v[212:215], v[128:131]
 buffer_load_dwordx4 v11, s[8:11], s30 offen offset:1024 lds
 v_cvt_pk_bf16_f32 v233, v106, v107
 v_cvt_pk_bf16_f32 v234, v108, v109
 v_mfma_f32_16x16x32_bf16 v[132:135], a[236:239], v[212:215], v[132:135]
 v_cvt_pk_bf16_f32 v235, v110, v111
 ds_write_b64 v22, v[230:231] offset:19200
 v_mfma_f32_16x16x32_bf16 v[136:139], a[228:231], v[216:219], v[136:139]
 ds_read_b128 v[184:187], v18 offset:12288
 ds_write_b64 v22, v[232:233] offset:19208
 v_mfma_f32_16x16x32_bf16 v[140:143], a[232:235], v[216:219], v[140:143]
 ds_write_b64 v16, v[234:235] offset:19264
 v_cvt_pk_bf16_f32 v224, v112, v113
 v_cvt_pk_bf16_f32 v225, v114, v115
 v_mfma_f32_16x16x32_bf16 v[144:147], a[236:239], v[216:219], v[144:147]
 v_cvt_pk_bf16_f32 v226, v116, v117
 v_cvt_pk_bf16_f32 v227, v118, v119
 v_cvt_pk_bf16_f32 v228, v120, v121
 v_cvt_pk_bf16_f32 v229, v122, v123
 v_mfma_f32_16x16x32_bf16 v[148:151], a[228:231], v[220:223], v[148:151]
 ds_read_b128 v[188:191], v18 offset:14336
 ds_write_b64 v22, v[224:225] offset:25600
 v_mfma_f32_16x16x32_bf16 v[152:155], a[232:235], v[220:223], v[152:155]
 ds_write_b64 v22, v[226:227] offset:25608
 ds_write_b64 v16, v[228:229] offset:25664
 v_mfma_f32_16x16x32_bf16 v[156:159], a[236:239], v[220:223], v[156:159]
 v_cvt_pk_bf16_f32 v230, v124, v125
 v_cvt_pk_bf16_f32 v231, v126, v127
 v_cvt_pk_bf16_f32 v232, v128, v129
 v_cvt_pk_bf16_f32 v233, v130, v131
qa_end_203:
 v_cvt_pk_bf16_f32 v234, v132, v133
 v_cvt_pk_bf16_f32 v235, v134, v135
 ds_write_b64 v22, v[230:231] offset:32000
 ds_write_b64 v22, v[232:233] offset:32008
 ds_write_b64 v16, v[234:235] offset:32064
 v_cvt_pk_bf16_f32 v224, v136, v137
 v_cvt_pk_bf16_f32 v225, v138, v139
 v_cvt_pk_bf16_f32 v226, v140, v141
 v_cvt_pk_bf16_f32 v227, v142, v143
 v_cvt_pk_bf16_f32 v228, v144, v145
 v_cvt_pk_bf16_f32 v229, v146, v147
 ds_write_b64 v22, v[224:225] offset:38400
 ds_write_b64 v22, v[226:227] offset:38408
 ds_write_b64 v16, v[228:229] offset:38464
 v_cvt_pk_bf16_f32 v230, v148, v149
 v_cvt_pk_bf16_f32 v231, v150, v151
 v_cvt_pk_bf16_f32 v232, v152, v153
 v_cvt_pk_bf16_f32 v233, v154, v155
 v_cvt_pk_bf16_f32 v234, v156, v157
 v_cvt_pk_bf16_f32 v235, v158, v159
 ds_write_b64 v22, v[230:231] offset:44800
 ds_write_b64 v22, v[232:233] offset:44808
 ds_write_b64 v16, v[234:235] offset:44864
 s_cmp_lg_u32 s26, s40
 s_cbranch_scc1 qbs_206
 s_waitcnt lgkmcnt(0)
 s_barrier
 ds_read_b128 v[64:67], v29 offset:0
 ds_read_b128 v[68:71], v29 offset:64
 ds_read_b128 v[72:75], v29 offset:128
 ds_read_b128 v[76:79], v29 offset:192
 ds_read_b128 v[80:83], v29 offset:256
 ds_read_b128 v[84:87], v29 offset:320
 ds_read_b128 v[88:91], v29 offset:6400
 ds_read_b128 v[92:95], v29 offset:6464
 ds_read_b128 v[96:99], v29 offset:6528
 ds_read_b128 v[100:103], v29 offset:6592
 ds_read_b128 v[104:107], v29 offset:6656
 ds_read_b128 v[108:111], v29 offset:6720
 s_waitcnt lgkmcnt(0)
 s_add_u32 s21, s43, 0
 buffer_store_dwordx4 v[64:67], v30, s[12:15], s21 offen offset:0 sc1
 buffer_store_dwordx4 v[68:71], v30, s[12:15], s21 offen offset:1024 sc1
 buffer_store_dwordx4 v[72:75], v30, s[12:15], s21 offen offset:2048 sc1
 buffer_store_dwordx4 v[76:79], v30, s[12:15], s21 offen offset:3072 sc1
 s_add_u32 s21, s43, 4096
 buffer_store_dwordx4 v[80:83], v30, s[12:15], s21 offen offset:0 sc1
 buffer_store_dwordx4 v[84:87], v30, s[12:15], s21 offen offset:1024 sc1
 buffer_store_dwordx4 v[88:91], v30, s[12:15], s21 offen offset:2048 sc1
 buffer_store_dwordx4 v[92:95], v30, s[12:15], s21 offen offset:3072 sc1
 s_add_u32 s21, s43, 8192
 buffer_store_dwordx4 v[96:99], v30, s[12:15], s21 offen offset:0 sc1
 buffer_store_dwordx4 v[100:103], v30, s[12:15], s21 offen offset:1024 sc1
 buffer_store_dwordx4 v[104:107], v30, s[12:15], s21 offen offset:2048 sc1
 buffer_store_dwordx4 v[108:111], v30, s[12:15], s21 offen offset:3072 sc1
 s_branch qbe_204
qbs_206:
 s_cmp_eq_u32 s80, 1
 s_cselect_b32 s21, s79, 0
 s_cmp_ge_u32 s21, 8
 s_cbranch_scc0 qx_207
 s_waitcnt lgkmcnt(0) vmcnt(5)
 s_barrier
 ds_read_b128 v[64:67], v29 offset:0
 ds_read_b128 v[88:91], v29 offset:6400
 ds_read_b128 v[68:71], v29 offset:64
 ds_read_b128 v[92:95], v29 offset:6464
 ds_read_b128 v[72:75], v29 offset:128
 ds_read_b128 v[96:99], v29 offset:6528
 ds_read_b128 v[76:79], v29 offset:192
 ds_read_b128 v[100:103], v29 offset:6592
 ds_read_b128 v[80:83], v29 offset:256
 ds_read_b128 v[104:107], v29 offset:6656
 ds_read_b128 v[84:87], v29 offset:320
 ds_read_b128 v[108:111], v29 offset:6720
 s_waitcnt lgkmcnt(10)
 v_mfma_f32_16x16x32_bf16 v[112:115], v[36:39], v[64:67], 0
 v_mfma_f32_16x16x32_bf16 v[116:119], a[240:243], v[64:67], 0
 v_mfma_f32_16x16x32_bf16 v[120:123], v[36:39], v[88:91], 0
 v_mfma_f32_16x16x32_bf16 v[124:127], v[60:63], v[88:91], 0
 v_mfma_f32_16x16x32_bf16 v[128:131], a[240:243], v[88:91], 0
 s_waitcnt lgkmcnt(8)
 v_mfma_f32_16x16x32_bf16 v[112:115], v[40:43], v[68:71], v[112:115]
 v_mfma_f32_16x16x32_bf16 v[116:119], a[244:247], v[68:71], v[116:119]
 v_mfma_f32_16x16x32_bf16 v[120:123], v[40:43], v[92:95], v[120:123]
 v_mfma_f32_16x16x32_bf16 v[124:127], v[236:239], v[92:95], v[124:127]
 v_mfma_f32_16x16x32_bf16 v[128:131], a[244:247], v[92:95], v[128:131]
 s_waitcnt lgkmcnt(6)
 v_mfma_f32_16x16x32_bf16 v[112:115], v[44:47], v[72:75], v[112:115]
 v_mfma_f32_16x16x32_bf16 v[116:119], a[248:251], v[72:75], v[116:119]
 v_mfma_f32_16x16x32_bf16 v[120:123], v[44:47], v[96:99], v[120:123]
 v_mfma_f32_16x16x32_bf16 v[124:127], v[240:243], v[96:99], v[124:127]
 v_mfma_f32_16x16x32_bf16 v[128:131], a[248:251], v[96:99], v[128:131]
 s_waitcnt lgkmcnt(4)
 v_mfma_f32_16x16x32_bf16 v[112:115], v[48:51], v[76:79], v[112:115]
 v_mfma_f32_16x16x32_bf16 v[116:119], a[252:255], v[76:79], v[116:119]
 v_mfma_f32_16x16x32_bf16 v[120:123], v[48:51], v[100:103], v[120:123]
 v_mfma_f32_16x16x32_bf16 v[124:127], v[244:247], v[100:103], v[124:127]
 v_mfma_f32_16x16x32_bf16 v[128:131], a[252:255], v[100:103], v[128:131]
 s_waitcnt lgkmcnt(2)
 v_mfma_f32_16x16x32_bf16 v[112:115], v[52:55], v[80:83], v[112:115]
 v_mfma_f32_16x16x32_bf16 v[116:119], v[24:27], v[80:83], v[116:119]
 v_mfma_f32_16x16x32_bf16 v[120:123], v[52:55], v[104:107], v[120:123]
 v_mfma_f32_16x16x32_bf16 v[124:127], v[248:251], v[104:107], v[124:127]
 v_mfma_f32_16x16x32_bf16 v[128:131], v[24:27], v[104:107], v[128:131]
 s_waitcnt lgkmcnt(0)
 v_mfma_f32_16x16x32_bf16 v[112:115], v[56:59], v[84:87], v[112:115]
 v_mfma_f32_16x16x32_bf16 v[116:119], v[6:9], v[84:87], v[116:119]
 v_mfma_f32_16x16x32_bf16 v[120:123], v[56:59], v[108:111], v[120:123]
 v_mfma_f32_16x16x32_bf16 v[124:127], v[252:255], v[108:111], v[124:127]
 v_mfma_f32_16x16x32_bf16 v[128:131], v[6:9], v[108:111], v[128:131]
 s_branch qx_205
qx_207:
 buffer_load_dword v21, v33, s[72:75], s77 offen sc1
 s_waitcnt vmcnt(0)
 s_mul_i32 s21, s49, 393216
 s_mul_i32 s22, s42, 12288
 s_add_u32 s50, s21, s22
 s_lshl_b32 s21, s49, 12
 s_and_b32 s21, s21, 8192
 s_xor_b32 s21, s21, s37
 s_lshl_b32 s51, s49, 20
 s_or_b32 s51, s51, s21
 s_xor_b32 s51, s51, 8192
 s_add_u32 s51, s51, s36
 s_lshr_b32 s22, s49, 1
 s_lshr_b32 s21, s49, 2
 s_add_u32 s21, s21, 3
 s_cmp_lt_u32 s49, 12
 s_cselect_b32 s21, s22, s21
 s_lshl_b32 s21, s21, 3
 s_lshr_b32 s22, s42, 2
 s_add_u32 s21, s21, s22
 s_lshl_b32 s21, s21, 7
 s_add_u32 s76, s21, 0
 s_lshl_b32 s77, s42, 7
 s_add_u32 s77, s77, 19456
 s_add_u32 s23, s49, 1
 s_waitcnt vmcnt(6)
 v_cmp_gt_u32 vcc, s23, v21
 s_mov_b32 s80, 0
 s_nop 0
 s_cbranch_vccnz qk_209
 s_mov_b32 s80, 1
 buffer_load_dwordx4 v[132:135], v31, s[52:55], s51 offen offset:0 sc1
 buffer_load_dwordx4 v[136:139], v31, s[52:55], s51 offen offset:512 sc1
 buffer_load_dwordx4 v[140:143], v31, s[52:55], s51 offen offset:1024 sc1
 buffer_load_dwordx4 v[144:147], v31, s[52:55], s51 offen offset:1536 sc1
 buffer_load_dwordx4 v[148:151], v31, s[52:55], s51 offen offset:2048 sc1
 buffer_load_dwordx4 v[152:155], v31, s[52:55], s51 offen offset:2560 sc1
qk_209:
 s_cmp_ge_u32 s79, 8
 s_cbranch_scc1 qk_208
 v_mov_b32 v156, 0
 s_mov_b32 s101, 0
wf_210:
 buffer_load_dword v157, v156, s[72:75], s76 offen sc1
 s_add_u32 s101, s101, 1
 s_cmp_gt_u32 s101, 131072
 s_cbranch_scc1 main_end
 s_waitcnt vmcnt(0)
 v_readfirstlane_b32 s100, v157
 s_cmp_ge_u32 s100, 8
 s_cbranch_scc1 wf_211
 s_sleep 2
 s_branch wf_210
wf_211:
 s_add_u32 s21, s50, 0
 buffer_load_dwordx4 v[36:39], v30, s[16:19], s21 offen offset:0 sc1
 buffer_load_dwordx4 v[40:43], v30, s[16:19], s21 offen offset:1024 sc1
 buffer_load_dwordx4 v[44:47], v30, s[16:19], s21 offen offset:2048 sc1
 buffer_load_dwordx4 v[48:51], v30, s[16:19], s21 offen offset:3072 sc1
 s_add_u32 s21, s50, 4096
 buffer_load_dwordx4 v[52:55], v30, s[16:19], s21 offen offset:0 sc1
 buffer_load_dwordx4 v[56:59], v30, s[16:19], s21 offen offset:1024 sc1
 buffer_load_dwordx4 v[60:63], v30, s[16:19], s21 offen offset:2048 sc1
 buffer_load_dwordx4 v[236:239], v30, s[16:19], s21 offen offset:3072 sc1
 s_add_u32 s21, s50, 8192
 buffer_load_dwordx4 v[240:243], v30, s[16:19], s21 offen offset:0 sc1
 buffer_load_dwordx4 v[244:247], v30, s[16:19], s21 offen offset:1024 sc1
 buffer_load_dwordx4 v[248:251], v30, s[16:19], s21 offen offset:2048 sc1
 buffer_load_dwordx4 v[252:255], v30, s[16:19], s21 offen offset:3072 sc1
qk_208:
 s_waitcnt lgkmcnt(0)
 s_barrier
 ds_read_b128 v[64:67], v29 offset:0
 ds_read_b128 v[68:71], v29 offset:64
 ds_read_b128 v[72:75], v29 offset:128
 ds_read_b128 v[76:79], v29 offset:192
 ds_read_b128 v[80:83], v29 offset:256
 ds_read_b128 v[84:87], v29 offset:320
 ds_read_b128 v[88:91], v29 offset:6400
 ds_read_b128 v[92:95], v29 offset:6464
 ds_read_b128 v[96:99], v29 offset:6528
 ds_read_b128 v[100:103], v29 offset:6592
 ds_read_b128 v[104:107], v29 offset:6656
 ds_read_b128 v[108:111], v29 offset:6720
 s_waitcnt lgkmcnt(0)
 s_cmp_eq_u32 s80, 1
 s_cselect_b32 s21, s79, 0
 s_cmp_ge_u32 s21, 8
 s_cbranch_scc1 qw_212
 s_waitcnt vmcnt(0)
qw_212:
 v_mfma_f32_16x16x32_bf16 v[112:115], v[36:39], v[64:67], 0
 v_mfma_f32_16x16x32_bf16 v[120:123], v[36:39], v[88:91], 0
 v_mfma_f32_16x16x32_bf16 v[124:127], v[60:63], v[88:91], 0
 v_mfma_f32_16x16x32_bf16 v[112:115], v[40:43], v[68:71], v[112:115]
 v_mfma_f32_16x16x32_bf16 v[120:123], v[40:43], v[92:95], v[120:123]
 v_mfma_f32_16x16x32_bf16 v[124:127], v[236:239], v[92:95], v[124:127]
 v_mfma_f32_16x16x32_bf16 v[112:115], v[44:47], v[72:75], v[112:115]
 v_mfma_f32_16x16x32_bf16 v[120:123], v[44:47], v[96:99], v[120:123]
 v_mfma_f32_16x16x32_bf16 v[124:127], v[240:243], v[96:99], v[124:127]
 v_mfma_f32_16x16x32_bf16 v[112:115], v[48:51], v[76:79], v[112:115]
 v_mfma_f32_16x16x32_bf16 v[120:123], v[48:51], v[100:103], v[120:123]
 v_mfma_f32_16x16x32_bf16 v[124:127], v[244:247], v[100:103], v[124:127]
 v_mfma_f32_16x16x32_bf16 v[112:115], v[52:55], v[80:83], v[112:115]
 v_mfma_f32_16x16x32_bf16 v[120:123], v[52:55], v[104:107], v[120:123]
 v_mfma_f32_16x16x32_bf16 v[124:127], v[248:251], v[104:107], v[124:127]
 v_mfma_f32_16x16x32_bf16 v[112:115], v[56:59], v[84:87], v[112:115]
 v_mfma_f32_16x16x32_bf16 v[120:123], v[56:59], v[108:111], v[120:123]
 v_mfma_f32_16x16x32_bf16 v[124:127], v[252:255], v[108:111], v[124:127]
 s_cmp_eq_u32 s80, 1
 s_cbranch_scc1 qm_213
 s_add_u32 s23, s49, 1
 s_min_u32 s22, s49, 61
 s_cmp_lt_u32 s49, 52
 s_cselect_b32 s23, s23, s22
 s_mov_b32 s101, 0
wm_214:
 buffer_load_dword v156, v33, s[72:75], s77 offen sc1
 s_add_u32 s101, s101, 1
 s_cmp_gt_u32 s101, 131072
 s_cbranch_scc1 main_end
 s_waitcnt vmcnt(0)
 v_cmp_gt_u32 vcc, s23, v156
 v_readfirstlane_b32 s100, v156
 s_nop 0
 s_cbranch_vccz wm_215
 s_sleep 16
 s_add_u32 s100, s100, 2
 s_cmp_ge_u32 s100, s23
 s_cbranch_scc1 wm_214
 s_sleep 90
 s_branch wm_214
wm_215:
 s_cmp_eq_u32 s49, 63
 s_cselect_b32 s21, s101, 0
 s_cmp_lt_u32 s21, 2
 s_cbranch_scc1 qtz_218
 s_sleep 36
qtz_218:
 s_mov_b32 s101, 0
 s_branch qtp_217
qtp_216:
 s_sleep 3
qtp_217:
 buffer_load_dwordx4 v[132:135], v31, s[52:55], s51 offen offset:0 sc1
 buffer_load_dwordx4 v[136:139], v31, s[52:55], s51 offen offset:512 sc1
 buffer_load_dwordx4 v[140:143], v31, s[52:55], s51 offen offset:1024 sc1
 buffer_load_dwordx4 v[144:147], v31, s[52:55], s51 offen offset:1536 sc1
 buffer_load_dwordx4 v[148:151], v31, s[52:55], s51 offen offset:2048 sc1
 buffer_load_dwordx4 v[152:155], v31, s[52:55], s51 offen offset:2560 sc1
 s_add_u32 s101, s101, 1
 s_cmp_gt_u32 s101, 131072
 s_cbranch_scc1 main_end
 s_waitcnt vmcnt(0)
 v_max3_u32 v156, v132, v134, v136
 v_max3_u32 v156, v156, v138, v140
 v_max3_u32 v156, v156, v142, v144
 v_max3_u32 v156, v156, v146, v148
 v_max3_u32 v156, v156, v150, v152
 v_max3_u32 v156, v156, v154, v154
 v_cmp_eq_u32 vcc, -1, v156
 s_nop 1
 s_cbranch_vccnz qtp_216
qm_213:
 s_waitcnt vmcnt(0)
 v_mfma_f32_16x16x32_bf16 v[116:119], v[132:135], v[64:67], 0
 v_mfma_f32_16x16x32_bf16 v[128:131], v[132:135], v[88:91], 0
 v_mfma_f32_16x16x32_bf16 v[116:119], v[136:139], v[68:71], v[116:119]
 v_mfma_f32_16x16x32_bf16 v[128:131], v[136:139], v[92:95], v[128:131]
 v_mfma_f32_16x16x32_bf16 v[116:119], v[140:143], v[72:75], v[116:119]
 v_mfma_f32_16x16x32_bf16 v[128:131], v[140:143], v[96:99], v[128:131]
 v_mfma_f32_16x16x32_bf16 v[116:119], v[144:147], v[76:79], v[116:119]
 v_mfma_f32_16x16x32_bf16 v[128:131], v[144:147], v[100:103], v[128:131]
 v_mfma_f32_16x16x32_bf16 v[116:119], v[148:151], v[80:83], v[116:119]
 v_mfma_f32_16x16x32_bf16 v[128:131], v[148:151], v[104:107], v[128:131]
 v_mfma_f32_16x16x32_bf16 v[116:119], v[152:155], v[84:87], v[116:119]
 v_mfma_f32_16x16x32_bf16 v[128:131], v[152:155], v[108:111], v[128:131]
qx_205:
 s_lshl_b32 s21, s49, 12
 s_and_b32 s21, s21, 8192
 s_xor_b32 s21, s21, s37
 s_lshl_b32 s81, s49, 20
 s_or_b32 s81, s81, s21
 s_add_u32 s81, s81, s44
 s_lshl_b32 s82, s49, 3
 s_and_b32 s21, s42, 7
 s_add_u32 s82, s82, s21
 s_lshl_b32 s82, s82, 7
 s_add_u32 s82, s82, 23552
 s_cmp_gt_u32 s26, 1
 s_cselect_b32 s21, s80, 0
 s_cmp_eq_u32 s21, 0
 s_cbranch_scc1 qi_220
 v_mov_b32 v36, v112
 v_mov_b32 v37, v113
 v_mov_b32 v38, v114
 v_mov_b32 v39, v115
 v_mov_b32 v40, v116
 v_mov_b32 v41, v117
 v_mov_b32 v42, v118
 v_mov_b32 v43, v119
 v_mov_b32 v44, v120
 v_mov_b32 v45, v121
 v_mov_b32 v46, v122
 v_mov_b32 v47, v123
 v_mov_b32 v48, v124
 v_mov_b32 v49, v125
 v_mov_b32 v50, v126
 v_mov_b32 v51, v127
 v_mov_b32 v52, v128
 v_mov_b32 v53, v129
 v_mov_b32 v54, v130
 v_mov_b32 v55, v131
 s_branch qd_219
qi_220:
 v_cndmask_b32 v112, v34, v112, s[64:65]
 v_cndmask_b32 v124, v34, v124, s[64:65]
 v_cndmask_b32 v113, v34, v113, s[66:67]
 v_cndmask_b32 v125, v34, v125, s[66:67]
 v_cndmask_b32 v114, v34, v114, s[68:69]
 v_cndmask_b32 v126, v34, v126, s[68:69]
 v_cndmask_b32 v115, v34, v115, s[70:71]
 v_cndmask_b32 v127, v34, v127, s[70:71]
 v_max3_f32 v156, v112, v113, v114
 v_max3_f32 v156, v156, v115, v116
 v_max3_f32 v156, v156, v117, v118
 v_max_f32 v156, v156, v119
 v_mov_b32 v157, v156
 s_nop 1
 v_permlane32_swap_b32 v156, v157
 v_max_f32 v156, v156, v157
 v_mov_b32 v157, v156
 s_nop 1
 v_permlane16_swap_b32 v156, v157
 v_max_f32 v156, v156, v157
 v_mul_f32 v156, s83, v156
 v_fma_f32 v112, v112, s83, -v156
 v_fma_f32 v113, v113, s83, -v156
 v_fma_f32 v114, v114, s83, -v156
 v_fma_f32 v115, v115, s83, -v156
 v_fma_f32 v116, v116, s83, -v156
 v_fma_f32 v117, v117, s83, -v156
 v_fma_f32 v118, v118, s83, -v156
 v_fma_f32 v119, v119, s83, -v156
 v_exp_f32 v112, v112
 v_exp_f32 v113, v113
 v_exp_f32 v114, v114
 v_exp_f32 v115, v115
 v_exp_f32 v116, v116
 v_exp_f32 v117, v117
 v_exp_f32 v118, v118
 v_exp_f32 v119, v119
 s_nop 0
 v_add_f32 v156, v116, v117
 v_add_f32 v156, v156, v118
 v_add_f32 v156, v156, v119
 v_cndmask_b32 v156, 0, v156, s[60:61]
 v_add_f32 v156, v156, v112
 v_add_f32 v156, v156, v113
 v_add_f32 v156, v156, v114
 v_add_f32 v156, v156, v115
 v_mov_b32 v157, v156
 s_nop 1
 v_permlane32_swap_b32 v156, v157
 v_add_f32 v156, v156, v157
 v_mov_b32 v157, v156
 s_nop 1
 v_permlane16_swap_b32 v156, v157
 v_add_f32 v156, v156, v157
 v_rcp_f32 v156, v156
 s_nop 0
 v_mul_f32 v112, v112, v156
 v_mul_f32 v113, v113, v156
 v_mul_f32 v114, v114, v156
 v_mul_f32 v115, v115, v156
 v_mul_f32 v116, v116, v156
 v_mul_f32 v117, v117, v156
 v_mul_f32 v118, v118, v156
 v_mul_f32 v119, v119, v156
 v_max3_f32 v156, v120, v121, v122
 v_max3_f32 v156, v156, v123, v124
 v_max3_f32 v156, v156, v125, v126
 v_max3_f32 v156, v156, v127, v128
 v_max3_f32 v156, v156, v129, v130
 v_max_f32 v156, v156, v131
 v_mov_b32 v157, v156
 s_nop 1
 v_permlane32_swap_b32 v156, v157
 v_max_f32 v156, v156, v157
 v_mov_b32 v157, v156
 s_nop 1
 v_permlane16_swap_b32 v156, v157
 v_max_f32 v156, v156, v157
 v_mul_f32 v156, s83, v156
 v_fma_f32 v120, v120, s83, -v156
 v_fma_f32 v121, v121, s83, -v156
 v_fma_f32 v122, v122, s83, -v156
 v_fma_f32 v123, v123, s83, -v156
 v_fma_f32 v124, v124, s83, -v156
 v_fma_f32 v125, v125, s83, -v156
 v_fma_f32 v126, v126, s83, -v156
 v_fma_f32 v127, v127, s83, -v156
 v_fma_f32 v128, v128, s83, -v156
 v_fma_f32 v129, v129, s83, -v156
 v_fma_f32 v130, v130, s83, -v156
 v_fma_f32 v131, v131, s83, -v156
 v_exp_f32 v120, v120
 v_exp_f32 v121, v121
 v_exp_f32 v122, v122
 v_exp_f32 v123, v123
 v_exp_f32 v124, v124
 v_exp_f32 v125, v125
 v_exp_f32 v126, v126
 v_exp_f32 v127, v127
 v_exp_f32 v128, v128
 v_exp_f32 v129, v129
 v_exp_f32 v130, v130
 v_exp_f32 v131, v131
 s_nop 0
 v_add_f32 v156, v128, v129
 v_add_f32 v156, v156, v130
 v_add_f32 v156, v156, v131
 v_cndmask_b32 v156, 0, v156, s[60:61]
 v_add_f32 v156, v156, v120
 v_add_f32 v156, v156, v121
 v_add_f32 v156, v156, v122
 v_add_f32 v156, v156, v123
 v_add_f32 v156, v156, v124
 v_add_f32 v156, v156, v125
 v_add_f32 v156, v156, v126
 v_add_f32 v156, v156, v127
 v_mov_b32 v157, v156
 s_nop 1
 v_permlane32_swap_b32 v156, v157
 v_add_f32 v156, v156, v157
 v_mov_b32 v157, v156
 s_nop 1
 v_permlane16_swap_b32 v156, v157
 v_add_f32 v156, v156, v157
 v_rcp_f32 v156, v156
 s_nop 0
 v_mul_f32 v120, v120, v156
 v_mul_f32 v121, v121, v156
 v_mul_f32 v122, v122, v156
 v_mul_f32 v123, v123, v156
 v_mul_f32 v124, v124, v156
 v_mul_f32 v125, v125, v156
 v_mul_f32 v126, v126, v156
 v_mul_f32 v127, v127, v156
 v_mul_f32 v128, v128, v156
 v_mul_f32 v129, v129, v156
 v_mul_f32 v130, v130, v156
 v_mul_f32 v131, v131, v156
 v_cvt_pk_bf16_f32 v196, v116, v117
 v_cvt_pk_bf16_f32 v197, v118, v119
 v_cvt_pk_bf16_f32 v198, v128, v129
 v_cvt_pk_bf16_f32 v199, v130, v131
 v_cvt_pk_bf16_f32 v192, v120, v121
 v_cvt_pk_bf16_f32 v193, v122, v123
 v_cvt_pk_bf16_f32 v194, v124, v125
 v_cvt_pk_bf16_f32 v195, v126, v127
 v_cvt_pk_bf16_f32 v200, v112, v113
 v_cvt_pk_bf16_f32 v201, v114, v115
 v_permlane16_swap_b32 v196, v198
 v_permlane16_swap_b32 v197, v199
 buffer_store_dwordx4 v[192:195], v30, s[56:59], s81 offen sc1
 s_mov_b64 exec, 0xffffffff
 buffer_store_dwordx4 v[196:199], v30, s[56:59], s81 offen offset:1024 sc1
 s_mov_b64 exec, -1
 buffer_store_dwordx2 v[200:201], v32, s[56:59], s81 offen offset:1536 sc1
 s_mov_b32 s78, s82
 s_mov_b32 s81, 0x80000000
 s_mov_b32 s82, 0
 s_cmp_eq_u32 s80, 1
 s_cbranch_scc1 qd_219
 s_waitcnt vmcnt(0)
 s_cmp_eq_u32 s78, 0
 s_cbranch_scc1 pf_221
 v_mov_b32 v4, 0
 v_mov_b32 v5, 1
 s_mov_b64 exec, 1
 buffer_atomic_add v5, v4, s[72:75], s78 offen sc1
 s_mov_b64 exec, -1
 s_mov_b32 s78, 0
pf_221:
qd_219:
 s_add_u32 s49, s49, s29
qbe_204:
 s_sub_u32 s26, s26, 1
 s_cmp_gt_u32 s26, 0
 s_waitcnt lgkmcnt(0)
 s_cbranch_scc1 qa_blk_202
 s_waitcnt vmcnt(0) lgkmcnt(0)
 s_cmp_eq_u32 s78, 0
 s_cbranch_scc1 pf_222
 v_mov_b32 v4, 0
 v_mov_b32 v5, 1
 s_mov_b64 exec, 1
 buffer_atomic_add v5, v4, s[72:75], s78 offen sc1
 s_mov_b64 exec, -1
 s_mov_b32 s78, 0
pf_222:
 s_cmp_eq_u32 s45, 0
 s_cbranch_scc1 q_done
 s_mul_i32 s21, s49, 393216
 s_mul_i32 s22, s42, 12288
 s_add_u32 s50, s21, s22
 s_lshl_b32 s21, s49, 12
 s_and_b32 s21, s21, 8192
 s_xor_b32 s21, s21, s37
 s_lshl_b32 s51, s49, 20
 s_or_b32 s51, s51, s21
 s_xor_b32 s51, s51, 8192
 s_add_u32 s51, s51, s36
 s_lshr_b32 s22, s49, 1
 s_lshr_b32 s21, s49, 2
 s_add_u32 s21, s21, 3
 s_cmp_lt_u32 s49, 12
 s_cselect_b32 s21, s22, s21
 s_lshl_b32 s21, s21, 3
 s_lshr_b32 s22, s42, 2
 s_add_u32 s21, s21, s22
 s_lshl_b32 s21, s21, 7
 s_add_u32 s76, s21, 0
 s_lshl_b32 s77, s42, 7
 s_add_u32 s77, s77, 19456
 buffer_load_dword v21, v33, s[72:75], s77 offen sc1
 s_add_u32 s21, s50, 0
 buffer_load_dwordx4 v[36:39], v30, s[16:19], s21 offen offset:0 sc1
 buffer_load_dwordx4 v[40:43], v30, s[16:19], s21 offen offset:1024 sc1
 buffer_load_dwordx4 v[44:47], v30, s[16:19], s21 offen offset:2048 sc1
 buffer_load_dwordx4 v[48:51], v30, s[16:19], s21 offen offset:3072 sc1
 s_add_u32 s21, s50, 4096
 buffer_load_dwordx4 v[52:55], v30, s[16:19], s21 offen offset:0 sc1
 buffer_load_dwordx4 v[56:59], v30, s[16:19], s21 offen offset:1024 sc1
 buffer_load_dwordx4 v[60:63], v30, s[16:19], s21 offen offset:2048 sc1
 buffer_load_dwordx4 v[236:239], v30, s[16:19], s21 offen offset:3072 sc1
 s_add_u32 s21, s50, 8192
 buffer_load_dwordx4 v[240:243], v30, s[16:19], s21 offen offset:0 sc1
 buffer_load_dwordx4 v[244:247], v30, s[16:19], s21 offen offset:1024 sc1
 buffer_load_dwordx4 v[248:251], v30, s[16:19], s21 offen offset:2048 sc1
 buffer_load_dwordx4 v[252:255], v30, s[16:19], s21 offen offset:3072 sc1
 s_add_u32 s21, s43, 0
 buffer_load_dwordx4 v[64:67], v30, s[12:15], s21 offen offset:0 sc1
 buffer_load_dwordx4 v[68:71], v30, s[12:15], s21 offen offset:1024 sc1
 buffer_load_dwordx4 v[72:75], v30, s[12:15], s21 offen offset:2048 sc1
 buffer_load_dwordx4 v[76:79], v30, s[12:15], s21 offen offset:3072 sc1
 s_add_u32 s21, s43, 4096
 buffer_load_dwordx4 v[80:83], v30, s[12:15], s21 offen offset:0 sc1
 buffer_load_dwordx4 v[84:87], v30, s[12:15], s21 offen offset:1024 sc1
 buffer_load_dwordx4 v[88:91], v30, s[12:15], s21 offen offset:2048 sc1
 buffer_load_dwordx4 v[92:95], v30, s[12:15], s21 offen offset:3072 sc1
 s_add_u32 s21, s43, 8192
 buffer_load_dwordx4 v[96:99], v30, s[12:15], s21 offen offset:0 sc1
 buffer_load_dwordx4 v[100:103], v30, s[12:15], s21 offen offset:1024 sc1
 buffer_load_dwordx4 v[104:107], v30, s[12:15], s21 offen offset:2048 sc1
 buffer_load_dwordx4 v[108:111], v30, s[12:15], s21 offen offset:3072 sc1
 s_waitcnt vmcnt(24)
 s_cmp_eq_u32 s78, 0
 s_cbranch_scc1 pf_226
 v_mov_b32 v4, 0
 v_mov_b32 v5, 1
 s_mov_b64 exec, 1
 buffer_atomic_add v5, v4, s[72:75], s78 offen sc1
 s_mov_b64 exec, -1
 s_mov_b32 s78, 0
pf_226:
 s_add_u32 s23, s49, 1
 v_cmp_gt_u32 vcc, s23, v21
 s_mov_b32 s80, 0
 s_nop 0
 s_cbranch_vccnz qk_225
 s_mov_b32 s80, 1
 buffer_load_dwordx4 v[132:135], v31, s[52:55], s51 offen offset:0 sc1
 buffer_load_dwordx4 v[136:139], v31, s[52:55], s51 offen offset:512 sc1
 buffer_load_dwordx4 v[140:143], v31, s[52:55], s51 offen offset:1024 sc1
 buffer_load_dwordx4 v[144:147], v31, s[52:55], s51 offen offset:1536 sc1
 buffer_load_dwordx4 v[148:151], v31, s[52:55], s51 offen offset:2048 sc1
 buffer_load_dwordx4 v[152:155], v31, s[52:55], s51 offen offset:2560 sc1
 s_waitcnt vmcnt(6)
 s_branch qk_225x
qk_225:
 s_waitcnt vmcnt(0)
qk_225x:
 v_mfma_f32_16x16x32_bf16 v[112:115], v[36:39], v[64:67], 0
 v_mfma_f32_16x16x32_bf16 v[120:123], v[36:39], v[88:91], 0
 v_mfma_f32_16x16x32_bf16 v[124:127], v[60:63], v[88:91], 0
 v_mfma_f32_16x16x32_bf16 v[112:115], v[40:43], v[68:71], v[112:115]
 v_mfma_f32_16x16x32_bf16 v[120:123], v[40:43], v[92:95], v[120:123]
 v_mfma_f32_16x16x32_bf16 v[124:127], v[236:239], v[92:95], v[124:127]
 v_mfma_f32_16x16x32_bf16 v[112:115], v[44:47], v[72:75], v[112:115]
 v_mfma_f32_16x16x32_bf16 v[120:123], v[44:47], v[96:99], v[120:123]
 v_mfma_f32_16x16x32_bf16 v[124:127], v[240:243], v[96:99], v[124:127]
 v_mfma_f32_16x16x32_bf16 v[112:115], v[48:51], v[76:79], v[112:115]
 v_mfma_f32_16x16x32_bf16 v[120:123], v[48:51], v[100:103], v[120:123]
 v_mfma_f32_16x16x32_bf16 v[124:127], v[244:247], v[100:103], v[124:127]
 v_mfma_f32_16x16x32_bf16 v[112:115], v[52:55], v[80:83], v[112:115]
 v_mfma_f32_16x16x32_bf16 v[120:123], v[52:55], v[104:107], v[120:123]
 v_mfma_f32_16x16x32_bf16 v[124:127], v[248:251], v[104:107], v[124:127]
 v_mfma_f32_16x16x32_bf16 v[112:115], v[56:59], v[84:87], v[112:115]
 v_mfma_f32_16x16x32_bf16 v[120:123], v[56:59], v[108:111], v[120:123]
 v_mfma_f32_16x16x32_bf16 v[124:127], v[252:255], v[108:111], v[124:127]
 s_cmp_eq_u32 s80, 1
 s_cbranch_scc1 qm_227
 s_add_u32 s23, s49, 1
 s_min_u32 s22, s49, 61
 s_cmp_lt_u32 s49, 52
 s_cselect_b32 s23, s23, s22
 s_mov_b32 s101, 0
wm_228:
 buffer_load_dword v156, v33, s[72:75], s77 offen sc1
 s_add_u32 s101, s101, 1
 s_cmp_gt_u32 s101, 131072
 s_cbranch_scc1 main_end
 s_waitcnt vmcnt(0)
 v_cmp_gt_u32 vcc, s23, v156
 v_readfirstlane_b32 s100, v156
 s_nop 0
 s_cbranch_vccz wm_229
 s_sleep 16
 s_add_u32 s100, s100, 2
 s_cmp_ge_u32 s100, s23
 s_cbranch_scc1 wm_228
 s_sleep 90
 s_branch wm_228
wm_229:
 s_cmp_eq_u32 s49, 63
 s_cselect_b32 s21, s101, 0
 s_cmp_lt_u32 s21, 2
 s_cbranch_scc1 qtz_232
 s_sleep 36
qtz_232:
 s_mov_b32 s101, 0
 s_branch qtp_231
qtp_230:
 s_sleep 3
qtp_231:
 buffer_load_dwordx4 v[132:135], v31, s[52:55], s51 offen offset:0 sc1
 buffer_load_dwordx4 v[136:139], v31, s[52:55], s51 offen offset:512 sc1
 buffer_load_dwordx4 v[140:143], v31, s[52:55], s51 offen offset:1024 sc1
 buffer_load_dwordx4 v[144:147], v31, s[52:55], s51 offen offset:1536 sc1
 buffer_load_dwordx4 v[148:151], v31, s[52:55], s51 offen offset:2048 sc1
 buffer_load_dwordx4 v[152:155], v31, s[52:55], s51 offen offset:2560 sc1
 s_add_u32 s101, s101, 1
 s_cmp_gt_u32 s101, 131072
 s_cbranch_scc1 main_end
 s_waitcnt vmcnt(0)
 v_max3_u32 v156, v132, v134, v136
 v_max3_u32 v156, v156, v138, v140
 v_max3_u32 v156, v156, v142, v144
 v_max3_u32 v156, v156, v146, v148
 v_max3_u32 v156, v156, v150, v152
 v_max3_u32 v156, v156, v154, v154
 v_cmp_eq_u32 vcc, -1, v156
 s_nop 1
 s_cbranch_vccnz qtp_230
qm_227:
 s_waitcnt vmcnt(0)
 v_mfma_f32_16x16x32_bf16 v[116:119], v[132:135], v[64:67], 0
 v_mfma_f32_16x16x32_bf16 v[128:131], v[132:135], v[88:91], 0
 v_mfma_f32_16x16x32_bf16 v[116:119], v[136:139], v[68:71], v[116:119]
 v_mfma_f32_16x16x32_bf16 v[128:131], v[136:139], v[92:95], v[128:131]
 v_mfma_f32_16x16x32_bf16 v[116:119], v[140:143], v[72:75], v[116:119]
 v_mfma_f32_16x16x32_bf16 v[128:131], v[140:143], v[96:99], v[128:131]
 v_mfma_f32_16x16x32_bf16 v[116:119], v[144:147], v[76:79], v[116:119]
 v_mfma_f32_16x16x32_bf16 v[128:131], v[144:147], v[100:103], v[128:131]
 v_mfma_f32_16x16x32_bf16 v[116:119], v[148:151], v[80:83], v[116:119]
 v_mfma_f32_16x16x32_bf16 v[128:131], v[148:151], v[104:107], v[128:131]
 v_mfma_f32_16x16x32_bf16 v[116:119], v[152:155], v[84:87], v[116:119]
 v_mfma_f32_16x16x32_bf16 v[128:131], v[152:155], v[108:111], v[128:131]
qx_224:
 s_lshl_b32 s21, s49, 12
 s_and_b32 s21, s21, 8192
 s_xor_b32 s21, s21, s37
 s_lshl_b32 s81, s49, 20
 s_or_b32 s81, s81, s21
 s_add_u32 s81, s81, s44
 s_lshl_b32 s82, s49, 3
 s_and_b32 s21, s42, 7
 s_add_u32 s82, s82, s21
 s_lshl_b32 s82, s82, 7
 s_add_u32 s82, s82, 23552
 v_cndmask_b32 v112, v34, v112, s[64:65]
 v_cndmask_b32 v124, v34, v124, s[64:65]
 v_cndmask_b32 v113, v34, v113, s[66:67]
 v_cndmask_b32 v125, v34, v125, s[66:67]
 v_cndmask_b32 v114, v34, v114, s[68:69]
 v_cndmask_b32 v126, v34, v126, s[68:69]
 v_cndmask_b32 v115, v34, v115, s[70:71]
 v_cndmask_b32 v127, v34, v127, s[70:71]
 v_max3_f32 v156, v112, v113, v114
 v_max3_f32 v156, v156, v115, v116
 v_max3_f32 v156, v156, v117, v118
 v_max_f32 v156, v156, v119
 v_mov_b32 v157, v156
 s_nop 1
 v_permlane32_swap_b32 v156, v157
 v_max_f32 v156, v156, v157
 v_mov_b32 v157, v156
 s_nop 1
 v_permlane16_swap_b32 v156, v157
 v_max_f32 v156, v156, v157
 v_mul_f32 v156, s83, v156
 v_fma_f32 v112, v112, s83, -v156
 v_fma_f32 v113, v113, s83, -v156
 v_fma_f32 v114, v114, s83, -v156
 v_fma_f32 v115, v115, s83, -v156
 v_fma_f32 v116, v116, s83, -v156
 v_fma_f32 v117, v117, s83, -v156
 v_fma_f32 v118, v118, s83, -v156
 v_fma_f32 v119, v119, s83, -v156
 v_exp_f32 v112, v112
 v_exp_f32 v113, v113
 v_exp_f32 v114, v114
 v_exp_f32 v115, v115
 v_exp_f32 v116, v116
 v_exp_f32 v117, v117
 v_exp_f32 v118, v118
 v_exp_f32 v119, v119
 s_nop 0
 v_add_f32 v156, v116, v117
 v_add_f32 v156, v156, v118
 v_add_f32 v156, v156, v119
 v_cndmask_b32 v156, 0, v156, s[60:61]
 v_add_f32 v156, v156, v112
 v_add_f32 v156, v156, v113
 v_add_f32 v156, v156, v114
 v_add_f32 v156, v156, v115
 v_mov_b32 v157, v156
 s_nop 1
 v_permlane32_swap_b32 v156, v157
 v_add_f32 v156, v156, v157
 v_mov_b32 v157, v156
 s_nop 1
 v_permlane16_swap_b32 v156, v157
 v_add_f32 v156, v156, v157
 v_rcp_f32 v156, v156
 s_nop 0
 v_mul_f32 v112, v112, v156
 v_mul_f32 v113, v113, v156
 v_mul_f32 v114, v114, v156
 v_mul_f32 v115, v115, v156
 v_mul_f32 v116, v116, v156
 v_mul_f32 v117, v117, v156
 v_mul_f32 v118, v118, v156
 v_mul_f32 v119, v119, v156
 v_max3_f32 v156, v120, v121, v122
 v_max3_f32 v156, v156, v123, v124
 v_max3_f32 v156, v156, v125, v126
 v_max3_f32 v156, v156, v127, v128
 v_max3_f32 v156, v156, v129, v130
 v_max_f32 v156, v156, v131
 v_mov_b32 v157, v156
 s_nop 1
 v_permlane32_swap_b32 v156, v157
 v_max_f32 v156, v156, v157
 v_mov_b32 v157, v156
 s_nop 1
 v_permlane16_swap_b32 v156, v157
 v_max_f32 v156, v156, v157
 v_mul_f32 v156, s83, v156
 v_fma_f32 v120, v120, s83, -v156
 v_fma_f32 v121, v121, s83, -v156
 v_fma_f32 v122, v122, s83, -v156
 v_fma_f32 v123, v123, s83, -v156
 v_fma_f32 v124, v124, s83, -v156
 v_fma_f32 v125, v125, s83, -v156
 v_fma_f32 v126, v126, s83, -v156
 v_fma_f32 v127, v127, s83, -v156
 v_fma_f32 v128, v128, s83, -v156
 v_fma_f32 v129, v129, s83, -v156
 v_fma_f32 v130, v130, s83, -v156
 v_fma_f32 v131, v131, s83, -v156
 v_exp_f32 v120, v120
 v_exp_f32 v121, v121
 v_exp_f32 v122, v122
 v_exp_f32 v123, v123
 v_exp_f32 v124, v124
 v_exp_f32 v125, v125
 v_exp_f32 v126, v126
 v_exp_f32 v127, v127
 v_exp_f32 v128, v128
 v_exp_f32 v129, v129
 v_exp_f32 v130, v130
 v_exp_f32 v131, v131
 s_nop 0
 v_add_f32 v156, v128, v129
 v_add_f32 v156, v156, v130
 v_add_f32 v156, v156, v131
 v_cndmask_b32 v156, 0, v156, s[60:61]
 v_add_f32 v156, v156, v120
 v_add_f32 v156, v156, v121
 v_add_f32 v156, v156, v122
 v_add_f32 v156, v156, v123
 v_add_f32 v156, v156, v124
 v_add_f32 v156, v156, v125
 v_add_f32 v156, v156, v126
 v_add_f32 v156, v156, v127
 v_mov_b32 v157, v156
 s_nop 1
 v_permlane32_swap_b32 v156, v157
 v_add_f32 v156, v156, v157
 v_mov_b32 v157, v156
 s_nop 1
 v_permlane16_swap_b32 v156, v157
 v_add_f32 v156, v156, v157
 v_rcp_f32 v156, v156
 s_nop 0
 v_mul_f32 v120, v120, v156
 v_mul_f32 v121, v121, v156
 v_mul_f32 v122, v122, v156
 v_mul_f32 v123, v123, v156
 v_mul_f32 v124, v124, v156
 v_mul_f32 v125, v125, v156
 v_mul_f32 v126, v126, v156
 v_mul_f32 v127, v127, v156
 v_mul_f32 v128, v128, v156
 v_mul_f32 v129, v129, v156
 v_mul_f32 v130, v130, v156
 v_mul_f32 v131, v131, v156
 v_cvt_pk_bf16_f32 v196, v116, v117
 v_cvt_pk_bf16_f32 v197, v118, v119
 v_cvt_pk_bf16_f32 v198, v128, v129
 v_cvt_pk_bf16_f32 v199, v130, v131
 v_cvt_pk_bf16_f32 v192, v120, v121
 v_cvt_pk_bf16_f32 v193, v122, v123
 v_cvt_pk_bf16_f32 v194, v124, v125
 v_cvt_pk_bf16_f32 v195, v126, v127
 v_cvt_pk_bf16_f32 v200, v112, v113
 v_cvt_pk_bf16_f32 v201, v114, v115
 v_permlane16_swap_b32 v196, v198
 v_permlane16_swap_b32 v197, v199
 buffer_store_dwordx4 v[192:195], v30, s[56:59], s81 offen sc1
 s_mov_b64 exec, 0xffffffff
 buffer_store_dwordx4 v[196:199], v30, s[56:59], s81 offen offset:1024 sc1
 s_mov_b64 exec, -1
 buffer_store_dwordx2 v[200:201], v32, s[56:59], s81 offen offset:1536 sc1
 s_mov_b32 s78, s82
 s_mov_b32 s81, 0x80000000
 s_mov_b32 s82, 0
 s_cmp_eq_u32 s80, 1
 s_cbranch_scc1 qd_233
 s_waitcnt vmcnt(0)
 s_cmp_eq_u32 s78, 0
 s_cbranch_scc1 pf_234
 v_mov_b32 v4, 0
 v_mov_b32 v5, 1
 s_mov_b64 exec, 1
 buffer_atomic_add v5, v4, s[72:75], s78 offen sc1
 s_mov_b64 exec, -1
 s_mov_b32 s78, 0
pf_234:
qd_233:
 s_add_u32 s49, s49, s29
qbe_223:
 s_waitcnt vmcnt(0)
 s_cmp_eq_u32 s78, 0
 s_cbranch_scc1 pf_235
 v_mov_b32 v4, 0
 v_mov_b32 v5, 1
 s_mov_b64 exec, 1
 buffer_atomic_add v5, v4, s[72:75], s78 offen sc1
 s_mov_b64 exec, -1
 s_mov_b32 s78, 0
pf_235:
 s_branch queue
q_done:
 s_and_b32 s21, s3, 3
 s_cmp_lt_u32 s21, 2
 s_cbranch_scc1 queue
 s_sub_u32 s21, s21, 2
 s_lshl_b32 s21, s21, 3
 s_bfe_u32 s22, s3, 0x30002
 s_add_u32 s21, s21, s22
 s_add_u32 s87, s21, 236
 s_branch tail_item
queue:
 s_load_dwordx2 s[4:5], s[0:1], 96
 s_waitcnt lgkmcnt(0)
 s_mov_b32 s32, s4
 s_mov_b32 s33, s5
 s_mov_b32 s34, 256
 s_mov_b32 s35, 0x00020000
 s_waitcnt vmcnt(0) lgkmcnt(0)
 s_barrier
 s_mov_b32 s2, s85
 s_mov_b32 s85, -1
 s_cmp_lg_u32 s2, -1
 s_cbranch_scc1 queue_c
 v_mov_b32 v21, 0
 s_cmp_lg_u32 s20, 0
 s_cbranch_scc1 q_236
 v_mov_b32 v22, 80
 v_mov_b32 v23, 1
 s_mov_b64 exec, 1
 buffer_atomic_add v23, v22, s[32:35], 0 offen sc0 sc1
 s_waitcnt vmcnt(0)
queue_a:
 ds_write_b32 v21, v23
 s_waitcnt lgkmcnt(0)
 s_mov_b64 exec, -1
q_236:
queue_b:
 s_barrier
 ds_read_b32 v23, v21
 s_waitcnt lgkmcnt(0)
 v_readfirstlane_b32 s2, v23
 s_barrier
queue_c:
 s_add_u32 s21, s2, 0
 s_cmp_lt_u32 s2, 236
 s_cbranch_scc1 do_pv
 s_sub_u32 s2, s2, 236
 s_branch main_fin
do_opb:
 s_mov_b32 s87, -1
do_opb2:
 s_mov_b32 s2, s21
 s_load_dwordx2 s[4:5], s[0:1], 0
 s_load_dwordx4 s[40:43], s[0:1], 72
 s_load_dwordx2 s[38:39], s[0:1], 104
 s_lshl_b32 s59, s2, 2
 s_add_u32 s59, s59, s20
 s_lshl_b32 s59, s59, 3
 v_lshlrev_b32 v4, 4, v1
 v_lshlrev_b32 v5, 2, v1
 s_waitcnt lgkmcnt(0)
 s_mov_b32 s8, s4
 s_mov_b32 s9, s5
 s_mov_b32 s10, 2621440
 s_mov_b32 s11, 0x00020000
 s_mov_b32 s12, s42
 s_mov_b32 s13, s43
 s_mov_b32 s14, 1280
 s_mov_b32 s15, 0x00020000
 s_mov_b32 s24, s40
 s_mov_b32 s25, s41
 s_mov_b32 s26, 819200
 s_mov_b32 s27, 0x00020000
 s_add_u32 s16, s38, 70713344
 s_addc_u32 s17, s39, 0
 s_mov_b32 s18, 2641920
 s_mov_b32 s19, 0x00020000
 s_add_u32 s28, s38, 81002496
 s_addc_u32 s29, s39, 0
 s_mov_b32 s30, 8192
 s_mov_b32 s31, 0x00020000
 s_add_u32 s72, s38, 81068032
 s_addc_u32 s73, s39, 0
 s_mov_b32 s74, 129024
 s_mov_b32 s75, 0x00020000
 s_cmp_ge_u32 s2, 32
 s_cbranch_scc1 mw_237
 s_lshr_b32 s21, s2, 2
 s_lshl_b32 s21, s21, 7
 s_add_u32 s21, s21, 116736
 s_cmp_lg_u32 s20, 0
 s_cbranch_scc1 wf_239
 v_mov_b32 v20, 0
 s_mov_b32 s101, 0
wf_238:
 buffer_load_dword v21, v20, s[72:75], s21 offen sc1
 s_add_u32 s101, s101, 1
 s_cmp_gt_u32 s101, 131072
 s_cbranch_scc1 main_end
 s_waitcnt vmcnt(0)
 v_readfirstlane_b32 s100, v21
 s_cmp_ge_u32 s100, 32
 s_cbranch_scc1 wf_239
 s_sleep 32
 s_branch wf_238
wf_239:
 s_barrier
mw_237:
 s_mov_b32 s21, 91136
 v_mov_b32 v20, 0
 buffer_load_dword v21, v20, s[72:75], s21 offen sc1
 v_mov_b32 v29, 3277
 s_mul_i32 s21, s20, 320
 s_add_u32 s21, s21, 0
 v_add_u32 v22, s21, v1
 v_mul_u32_u24 v23, v22, v29
 v_lshrrev_b32 v23, 16, v23
 v_mul_u32_u24 v24, 20, v23
 v_sub_u32 v22, v22, v24
 v_bfe_u32 v24, v23, 3, 1
 v_lshlrev_b32 v24, 1, v24
 v_xor_b32 v22, v22, v24
 v_mul_u32_u24 v23, 1280, v23
 v_lshl_add_u32 v8, v22, 4, v23
 s_mul_i32 s21, s20, 320
 s_add_u32 s21, s21, 64
 v_add_u32 v22, s21, v1
 v_mul_u32_u24 v23, v22, v29
 v_lshrrev_b32 v23, 16, v23
 v_mul_u32_u24 v24, 20, v23
 v_sub_u32 v22, v22, v24
 v_bfe_u32 v24, v23, 3, 1
 v_lshlrev_b32 v24, 1, v24
 v_xor_b32 v22, v22, v24
 v_mul_u32_u24 v23, 1280, v23
 v_lshl_add_u32 v9, v22, 4, v23
 s_mul_i32 s21, s20, 320
 s_add_u32 s21, s21, 128
 v_add_u32 v22, s21, v1
 v_mul_u32_u24 v23, v22, v29
 v_lshrrev_b32 v23, 16, v23
 v_mul_u32_u24 v24, 20, v23
 v_sub_u32 v22, v22, v24
 v_bfe_u32 v24, v23, 3, 1
 v_lshlrev_b32 v24, 1, v24
 v_xor_b32 v22, v22, v24
 v_mul_u32_u24 v23, 1280, v23
 v_lshl_add_u32 v10, v22, 4, v23
 s_mul_i32 s21, s20, 320
 s_add_u32 s21, s21, 192
 v_add_u32 v22, s21, v1
 v_mul_u32_u24 v23, v22, v29
 v_lshrrev_b32 v23, 16, v23
 v_mul_u32_u24 v24, 20, v23
 v_sub_u32 v22, v22, v24
 v_bfe_u32 v24, v23, 3, 1
 v_lshlrev_b32 v24, 1, v24
 v_xor_b32 v22, v22, v24
 v_mul_u32_u24 v23, 1280, v23
 v_lshl_add_u32 v11, v22, 4, v23
 s_mul_i32 s21, s20, 320
 s_add_u32 s21, s21, 256
 v_add_u32 v22, s21, v1
 v_mul_u32_u24 v23, v22, v29
 v_lshrrev_b32 v23, 16, v23
 v_mul_u32_u24 v24, 20, v23
 v_sub_u32 v22, v22, v24
 v_bfe_u32 v24, v23, 3, 1
 v_lshlrev_b32 v24, 1, v24
 v_xor_b32 v22, v22, v24
 v_mul_u32_u24 v23, 1280, v23
 v_lshl_add_u32 v12, v22, 4, v23
 s_and_b32 s44, s2, 3
 s_mul_i32 s45, s44, 320
 s_mul_i32 s46, s20, 5120
 v_and_b32 v22, 1, v2
 v_mul_u32_u24 v22, 16512, v22
 v_mul_u32_u24 v23, 33024, v3
 v_lshrrev_b32 v24, 1, v2
 v_lshlrev_b32 v24, 4, v24
 v_add3_u32 v6, v22, v23, v24
 s_lshr_b32 s47, s2, 2
 s_lshl_b32 s47, s47, 2
 s_add_u32 s47, s47, s20
 s_lshl_b32 s47, s47, 1
 s_lshl_b32 s48, s47, 7
 v_lshrrev_b32 v22, 2, v2
 v_lshl_add_u32 v22, v3, 3, v22
 v_mul_u32_u24 v22, 320, v22
 v_and_b32 v23, 3, v2
 v_lshl_add_u32 v22, v23, 3, v22
 v_and_b32 v23, 1, v3
 v_lshlrev_b32 v23, 5, v23
 v_add_u32 v14, v22, v23
 v_sub_u32 v15, v22, v23
 v_add_u32 v16, 61440, v14
 v_add_u32 v17, 61440, v15
 v_add_u32 v18, 122880, v14
 v_add_u32 v19, 122880, v15
 s_add_u32 m0, s46, 0
 s_add_u32 s49, s45, 0
 s_nop 0
 buffer_load_dwordx4 v8, s[24:27], s49 offen lds
 s_add_u32 m0, s46, 1024
 s_nop 0
 buffer_load_dwordx4 v9, s[24:27], s49 offen lds
 s_add_u32 m0, s46, 2048
 s_nop 0
 buffer_load_dwordx4 v10, s[24:27], s49 offen lds
 s_add_u32 m0, s46, 3072
 s_nop 0
 buffer_load_dwordx4 v11, s[24:27], s49 offen lds
 s_add_u32 m0, s46, 4096
 s_nop 0
 buffer_load_dwordx4 v12, s[24:27], s49 offen lds
 s_add_u32 m0, s46, 20480
 s_add_u32 s49, s45, 81920
 s_nop 0
 buffer_load_dwordx4 v8, s[24:27], s49 offen lds
 s_add_u32 m0, s46, 21504
 s_nop 0
 buffer_load_dwordx4 v9, s[24:27], s49 offen lds
 s_add_u32 m0, s46, 22528
 s_nop 0
 buffer_load_dwordx4 v10, s[24:27], s49 offen lds
 s_add_u32 m0, s46, 23552
 s_nop 0
 buffer_load_dwordx4 v11, s[24:27], s49 offen lds
 s_add_u32 m0, s46, 24576
 s_nop 0
 buffer_load_dwordx4 v12, s[24:27], s49 offen lds
 s_waitcnt vmcnt(10)
 v_readfirstlane_b32 s21, v21
 s_cmp_ge_u32 s21, 32
 s_cbranch_scc1 o2_240
 s_mov_b32 s21, 91136
 v_mov_b32 v20, 0
 s_mov_b32 s101, 0
wf_241:
 buffer_load_dword v21, v20, s[72:75], s21 offen sc1
 s_add_u32 s101, s101, 1
 s_cmp_gt_u32 s101, 131072
 s_cbranch_scc1 main_end
 s_waitcnt vmcnt(0)
 v_readfirstlane_b32 s100, v21
 s_cmp_ge_u32 s100, 32
 s_cbranch_scc1 wf_242
 s_sleep 32
 s_branch wf_241
wf_242:
o2_240:
 buffer_load_dwordx4 a[0:3], v6, s[16:19], s48 offen offset:0 sc1
 buffer_load_dwordx4 a[4:7], v6, s[16:19], s48 offen offset:128 sc1
 s_add_u32 s48, s48, 132096
 buffer_load_dwordx4 a[8:11], v6, s[16:19], s48 offen offset:0 sc1
 buffer_load_dwordx4 a[12:15], v6, s[16:19], s48 offen offset:128 sc1
 s_add_u32 s48, s48, 132096
 buffer_load_dwordx4 a[16:19], v6, s[16:19], s48 offen offset:0 sc1
 buffer_load_dwordx4 a[20:23], v6, s[16:19], s48 offen offset:128 sc1
 s_add_u32 s48, s48, 132096
 buffer_load_dwordx4 a[24:27], v6, s[16:19], s48 offen offset:0 sc1
 buffer_load_dwordx4 a[28:31], v6, s[16:19], s48 offen offset:128 sc1
 s_add_u32 s48, s48, 132096
 s_add_u32 m0, s46, 40960
 s_add_u32 s49, s45, 163840
 s_nop 0
 buffer_load_dwordx4 v8, s[24:27], s49 offen lds
 s_add_u32 m0, s46, 41984
 s_nop 0
 buffer_load_dwordx4 v9, s[24:27], s49 offen lds
 s_add_u32 m0, s46, 43008
 s_nop 0
 buffer_load_dwordx4 v10, s[24:27], s49 offen lds
 s_add_u32 m0, s46, 44032
 s_nop 0
 buffer_load_dwordx4 v11, s[24:27], s49 offen lds
 s_add_u32 m0, s46, 45056
 s_nop 0
 buffer_load_dwordx4 v12, s[24:27], s49 offen lds
 buffer_load_dwordx4 a[32:35], v6, s[16:19], s48 offen offset:0 sc1
 buffer_load_dwordx4 a[36:39], v6, s[16:19], s48 offen offset:128 sc1
 s_add_u32 s48, s48, 132096
 buffer_load_dwordx4 a[40:43], v6, s[16:19], s48 offen offset:0 sc1
 buffer_load_dwordx4 a[44:47], v6, s[16:19], s48 offen offset:128 sc1
 s_add_u32 s48, s48, 132096
 s_add_u32 m0, s46, 61440
 s_add_u32 s49, s45, 245760
 s_nop 0
 buffer_load_dwordx4 v8, s[24:27], s49 offen lds
 s_add_u32 m0, s46, 62464
 s_nop 0
 buffer_load_dwordx4 v9, s[24:27], s49 offen lds
 s_add_u32 m0, s46, 63488
 s_nop 0
 buffer_load_dwordx4 v10, s[24:27], s49 offen lds
 s_add_u32 m0, s46, 64512
 s_nop 0
 buffer_load_dwordx4 v11, s[24:27], s49 offen lds
 s_add_u32 m0, s46, 65536
 s_nop 0
 buffer_load_dwordx4 v12, s[24:27], s49 offen lds
 buffer_load_dwordx4 a[48:51], v6, s[16:19], s48 offen offset:0 sc1
 buffer_load_dwordx4 a[52:55], v6, s[16:19], s48 offen offset:128 sc1
 s_add_u32 s48, s48, 132096
 buffer_load_dwordx4 a[56:59], v6, s[16:19], s48 offen offset:0 sc1
 buffer_load_dwordx4 a[60:63], v6, s[16:19], s48 offen offset:128 sc1
 s_add_u32 s48, s48, 132096
 s_add_u32 m0, s46, 81920
 s_add_u32 s49, s45, 327680
 s_nop 0
 buffer_load_dwordx4 v8, s[24:27], s49 offen lds
 s_add_u32 m0, s46, 82944
 s_nop 0
 buffer_load_dwordx4 v9, s[24:27], s49 offen lds
 s_add_u32 m0, s46, 83968
 s_nop 0
 buffer_load_dwordx4 v10, s[24:27], s49 offen lds
 s_add_u32 m0, s46, 84992
 s_nop 0
 buffer_load_dwordx4 v11, s[24:27], s49 offen lds
 s_add_u32 m0, s46, 86016
 s_nop 0
 buffer_load_dwordx4 v12, s[24:27], s49 offen lds
 buffer_load_dwordx4 a[64:67], v6, s[16:19], s48 offen offset:0 sc1
 buffer_load_dwordx4 a[68:71], v6, s[16:19], s48 offen offset:128 sc1
 s_add_u32 s48, s48, 132096
 buffer_load_dwordx4 a[72:75], v6, s[16:19], s48 offen offset:0 sc1
 buffer_load_dwordx4 a[76:79], v6, s[16:19], s48 offen offset:128 sc1
 s_add_u32 s48, s48, 132096
 s_add_u32 m0, s46, 102400
 s_add_u32 s49, s45, 409600
 s_nop 0
 buffer_load_dwordx4 v8, s[24:27], s49 offen lds
 s_add_u32 m0, s46, 103424
 s_nop 0
 buffer_load_dwordx4 v9, s[24:27], s49 offen lds
 s_add_u32 m0, s46, 104448
 s_nop 0
 buffer_load_dwordx4 v10, s[24:27], s49 offen lds
 s_add_u32 m0, s46, 105472
 s_nop 0
 buffer_load_dwordx4 v11, s[24:27], s49 offen lds
 s_add_u32 m0, s46, 106496
 s_nop 0
 buffer_load_dwordx4 v12, s[24:27], s49 offen lds
 s_add_u32 m0, s46, 122880
 s_add_u32 s49, s45, 491520
 s_nop 0
 buffer_load_dwordx4 v8, s[24:27], s49 offen lds
 s_add_u32 m0, s46, 123904
 s_nop 0
 buffer_load_dwordx4 v9, s[24:27], s49 offen lds
 s_add_u32 m0, s46, 124928
 s_nop 0
 buffer_load_dwordx4 v10, s[24:27], s49 offen lds
 s_add_u32 m0, s46, 125952
 s_nop 0
 buffer_load_dwordx4 v11, s[24:27], s49 offen lds
 s_add_u32 m0, s46, 126976
 s_nop 0
 buffer_load_dwordx4 v12, s[24:27], s49 offen lds
 s_waitcnt vmcnt(50)
 s_barrier
 ds_read_b64_tr_b16 v[144:145], v14 offset:0
 ds_read_b64_tr_b16 v[146:147], v14 offset:1280
 ds_read_b64_tr_b16 v[148:149], v15 offset:32
 ds_read_b64_tr_b16 v[150:151], v15 offset:1312
 ds_read_b64_tr_b16 v[152:153], v14 offset:64
 ds_read_b64_tr_b16 v[154:155], v14 offset:1344
 ds_read_b64_tr_b16 v[156:157], v15 offset:96
 ds_read_b64_tr_b16 v[158:159], v15 offset:1376
 ds_read_b64_tr_b16 v[160:161], v14 offset:128
 ds_read_b64_tr_b16 v[162:163], v14 offset:1408
 ds_read_b64_tr_b16 v[164:165], v15 offset:160
 ds_read_b64_tr_b16 v[166:167], v15 offset:1440
 ds_read_b64_tr_b16 v[168:169], v14 offset:192
 ds_read_b64_tr_b16 v[170:171], v14 offset:1472
 ds_read_b64_tr_b16 v[172:173], v15 offset:224
 ds_read_b64_tr_b16 v[174:175], v15 offset:1504
 ds_read_b64_tr_b16 v[176:177], v14 offset:256
 ds_read_b64_tr_b16 v[178:179], v14 offset:1536
 ds_read_b64_tr_b16 v[180:181], v15 offset:288
 ds_read_b64_tr_b16 v[182:183], v15 offset:1568
 s_waitcnt lgkmcnt(0) vmcnt(43)
 v_mfma_f32_16x16x32_bf16 v[64:67], v[144:147], a[0:3], 0
 ds_read_b64_tr_b16 v[184:185], v14 offset:10240
 ds_read_b64_tr_b16 v[186:187], v14 offset:11520
 v_mfma_f32_16x16x32_bf16 v[104:107], v[144:147], a[4:7], 0
 ds_read_b64_tr_b16 v[188:189], v15 offset:10272
 v_mfma_f32_16x16x32_bf16 v[68:71], v[148:151], a[0:3], 0
 ds_read_b64_tr_b16 v[190:191], v15 offset:11552
 v_mfma_f32_16x16x32_bf16 v[108:111], v[148:151], a[4:7], 0
 ds_read_b64_tr_b16 v[192:193], v14 offset:10304
 v_mfma_f32_16x16x32_bf16 v[72:75], v[152:155], a[0:3], 0
 ds_read_b64_tr_b16 v[194:195], v14 offset:11584
 v_mfma_f32_16x16x32_bf16 v[112:115], v[152:155], a[4:7], 0
 ds_read_b64_tr_b16 v[196:197], v15 offset:10336
 ds_read_b64_tr_b16 v[198:199], v15 offset:11616
 v_mfma_f32_16x16x32_bf16 v[76:79], v[156:159], a[0:3], 0
 ds_read_b64_tr_b16 v[200:201], v14 offset:10368
 v_mfma_f32_16x16x32_bf16 v[116:119], v[156:159], a[4:7], 0
 ds_read_b64_tr_b16 v[202:203], v14 offset:11648
 v_mfma_f32_16x16x32_bf16 v[80:83], v[160:163], a[0:3], 0
 ds_read_b64_tr_b16 v[204:205], v15 offset:10400
 v_mfma_f32_16x16x32_bf16 v[120:123], v[160:163], a[4:7], 0
 ds_read_b64_tr_b16 v[206:207], v15 offset:11680
 v_mfma_f32_16x16x32_bf16 v[84:87], v[164:167], a[0:3], 0
 ds_read_b64_tr_b16 v[208:209], v14 offset:10432
 v_mfma_f32_16x16x32_bf16 v[124:127], v[164:167], a[4:7], 0
 ds_read_b64_tr_b16 v[210:211], v14 offset:11712
 ds_read_b64_tr_b16 v[212:213], v15 offset:10464
 v_mfma_f32_16x16x32_bf16 v[88:91], v[168:171], a[0:3], 0
 ds_read_b64_tr_b16 v[214:215], v15 offset:11744
 v_mfma_f32_16x16x32_bf16 v[128:131], v[168:171], a[4:7], 0
 buffer_load_dwordx4 a[80:83], v6, s[16:19], s48 offen offset:0 sc1
 ds_read_b64_tr_b16 v[216:217], v14 offset:10496
 v_mfma_f32_16x16x32_bf16 v[92:95], v[172:175], a[0:3], 0
 ds_read_b64_tr_b16 v[218:219], v14 offset:11776
 v_mfma_f32_16x16x32_bf16 v[132:135], v[172:175], a[4:7], 0
 ds_read_b64_tr_b16 v[220:221], v15 offset:10528
 v_mfma_f32_16x16x32_bf16 v[96:99], v[176:179], a[0:3], 0
 ds_read_b64_tr_b16 v[222:223], v15 offset:11808
 v_mfma_f32_16x16x32_bf16 v[136:139], v[176:179], a[4:7], 0
 buffer_load_dwordx4 a[84:87], v6, s[16:19], s48 offen offset:128 sc1
 v_mfma_f32_16x16x32_bf16 v[100:103], v[180:183], a[0:3], 0
 s_add_u32 s48, s48, 132096
 v_mfma_f32_16x16x32_bf16 v[140:143], v[180:183], a[4:7], 0
 s_waitcnt lgkmcnt(0) vmcnt(43)
 s_barrier
 v_mfma_f32_16x16x32_bf16 v[64:67], v[184:187], a[8:11], v[64:67]
 s_add_u32 m0, s46, 0
 ds_read_b64_tr_b16 v[144:145], v14 offset:20480
 ds_read_b64_tr_b16 v[146:147], v14 offset:21760
 v_mfma_f32_16x16x32_bf16 v[104:107], v[184:187], a[12:15], v[104:107]
 s_add_u32 s49, s45, 573440
 ds_read_b64_tr_b16 v[148:149], v15 offset:20512
 v_mfma_f32_16x16x32_bf16 v[68:71], v[188:191], a[8:11], v[68:71]
 buffer_load_dwordx4 v8, s[24:27], s49 offen lds
 ds_read_b64_tr_b16 v[150:151], v15 offset:21792
 v_mfma_f32_16x16x32_bf16 v[108:111], v[188:191], a[12:15], v[108:111]
 s_add_u32 m0, s46, 1024
 ds_read_b64_tr_b16 v[152:153], v14 offset:20544
 v_mfma_f32_16x16x32_bf16 v[72:75], v[192:195], a[8:11], v[72:75]
 buffer_load_dwordx4 v9, s[24:27], s49 offen lds
 ds_read_b64_tr_b16 v[154:155], v14 offset:21824
 v_mfma_f32_16x16x32_bf16 v[112:115], v[192:195], a[12:15], v[112:115]
 s_add_u32 m0, s46, 2048
 ds_read_b64_tr_b16 v[156:157], v15 offset:20576
 ds_read_b64_tr_b16 v[158:159], v15 offset:21856
 v_mfma_f32_16x16x32_bf16 v[76:79], v[196:199], a[8:11], v[76:79]
 buffer_load_dwordx4 v10, s[24:27], s49 offen lds
 ds_read_b64_tr_b16 v[160:161], v14 offset:20608
 v_mfma_f32_16x16x32_bf16 v[116:119], v[196:199], a[12:15], v[116:119]
 s_add_u32 m0, s46, 3072
 ds_read_b64_tr_b16 v[162:163], v14 offset:21888
 v_mfma_f32_16x16x32_bf16 v[80:83], v[200:203], a[8:11], v[80:83]
 buffer_load_dwordx4 v11, s[24:27], s49 offen lds
 ds_read_b64_tr_b16 v[164:165], v15 offset:20640
 v_mfma_f32_16x16x32_bf16 v[120:123], v[200:203], a[12:15], v[120:123]
 s_add_u32 m0, s46, 4096
 ds_read_b64_tr_b16 v[166:167], v15 offset:21920
 v_mfma_f32_16x16x32_bf16 v[84:87], v[204:207], a[8:11], v[84:87]
 buffer_load_dwordx4 v12, s[24:27], s49 offen lds
 ds_read_b64_tr_b16 v[168:169], v14 offset:20672
 v_mfma_f32_16x16x32_bf16 v[124:127], v[204:207], a[12:15], v[124:127]
 ds_read_b64_tr_b16 v[170:171], v14 offset:21952
 ds_read_b64_tr_b16 v[172:173], v15 offset:20704
 v_mfma_f32_16x16x32_bf16 v[88:91], v[208:211], a[8:11], v[88:91]
 ds_read_b64_tr_b16 v[174:175], v15 offset:21984
 v_mfma_f32_16x16x32_bf16 v[128:131], v[208:211], a[12:15], v[128:131]
 buffer_load_dwordx4 a[88:91], v6, s[16:19], s48 offen offset:0 sc1
 ds_read_b64_tr_b16 v[176:177], v14 offset:20736
 v_mfma_f32_16x16x32_bf16 v[92:95], v[212:215], a[8:11], v[92:95]
 ds_read_b64_tr_b16 v[178:179], v14 offset:22016
 v_mfma_f32_16x16x32_bf16 v[132:135], v[212:215], a[12:15], v[132:135]
 ds_read_b64_tr_b16 v[180:181], v15 offset:20768
 v_mfma_f32_16x16x32_bf16 v[96:99], v[216:219], a[8:11], v[96:99]
 ds_read_b64_tr_b16 v[182:183], v15 offset:22048
 v_mfma_f32_16x16x32_bf16 v[136:139], v[216:219], a[12:15], v[136:139]
 buffer_load_dwordx4 a[92:95], v6, s[16:19], s48 offen offset:128 sc1
 v_mfma_f32_16x16x32_bf16 v[100:103], v[220:223], a[8:11], v[100:103]
 s_add_u32 s48, s48, 132096
 v_mfma_f32_16x16x32_bf16 v[140:143], v[220:223], a[12:15], v[140:143]
 s_waitcnt lgkmcnt(0) vmcnt(48)
 v_mfma_f32_16x16x32_bf16 v[64:67], v[144:147], a[16:19], v[64:67]
 ds_read_b64_tr_b16 v[184:185], v14 offset:30720
 ds_read_b64_tr_b16 v[186:187], v14 offset:32000
 v_mfma_f32_16x16x32_bf16 v[104:107], v[144:147], a[20:23], v[104:107]
 ds_read_b64_tr_b16 v[188:189], v15 offset:30752
 v_mfma_f32_16x16x32_bf16 v[68:71], v[148:151], a[16:19], v[68:71]
 ds_read_b64_tr_b16 v[190:191], v15 offset:32032
 v_mfma_f32_16x16x32_bf16 v[108:111], v[148:151], a[20:23], v[108:111]
 ds_read_b64_tr_b16 v[192:193], v14 offset:30784
 v_mfma_f32_16x16x32_bf16 v[72:75], v[152:155], a[16:19], v[72:75]
 ds_read_b64_tr_b16 v[194:195], v14 offset:32064
 v_mfma_f32_16x16x32_bf16 v[112:115], v[152:155], a[20:23], v[112:115]
 ds_read_b64_tr_b16 v[196:197], v15 offset:30816
 ds_read_b64_tr_b16 v[198:199], v15 offset:32096
 v_mfma_f32_16x16x32_bf16 v[76:79], v[156:159], a[16:19], v[76:79]
 ds_read_b64_tr_b16 v[200:201], v14 offset:30848
 v_mfma_f32_16x16x32_bf16 v[116:119], v[156:159], a[20:23], v[116:119]
 ds_read_b64_tr_b16 v[202:203], v14 offset:32128
 v_mfma_f32_16x16x32_bf16 v[80:83], v[160:163], a[16:19], v[80:83]
 ds_read_b64_tr_b16 v[204:205], v15 offset:30880
 v_mfma_f32_16x16x32_bf16 v[120:123], v[160:163], a[20:23], v[120:123]
 ds_read_b64_tr_b16 v[206:207], v15 offset:32160
 v_mfma_f32_16x16x32_bf16 v[84:87], v[164:167], a[16:19], v[84:87]
 ds_read_b64_tr_b16 v[208:209], v14 offset:30912
 v_mfma_f32_16x16x32_bf16 v[124:127], v[164:167], a[20:23], v[124:127]
 ds_read_b64_tr_b16 v[210:211], v14 offset:32192
 ds_read_b64_tr_b16 v[212:213], v15 offset:30944
 v_mfma_f32_16x16x32_bf16 v[88:91], v[168:171], a[16:19], v[88:91]
 ds_read_b64_tr_b16 v[214:215], v15 offset:32224
 v_mfma_f32_16x16x32_bf16 v[128:131], v[168:171], a[20:23], v[128:131]
 buffer_load_dwordx4 a[96:99], v6, s[16:19], s48 offen offset:0 sc1
 ds_read_b64_tr_b16 v[216:217], v14 offset:30976
 v_mfma_f32_16x16x32_bf16 v[92:95], v[172:175], a[16:19], v[92:95]
 ds_read_b64_tr_b16 v[218:219], v14 offset:32256
 v_mfma_f32_16x16x32_bf16 v[132:135], v[172:175], a[20:23], v[132:135]
 ds_read_b64_tr_b16 v[220:221], v15 offset:31008
 v_mfma_f32_16x16x32_bf16 v[96:99], v[176:179], a[16:19], v[96:99]
 ds_read_b64_tr_b16 v[222:223], v15 offset:32288
 v_mfma_f32_16x16x32_bf16 v[136:139], v[176:179], a[20:23], v[136:139]
 buffer_load_dwordx4 a[100:103], v6, s[16:19], s48 offen offset:128 sc1
 v_mfma_f32_16x16x32_bf16 v[100:103], v[180:183], a[16:19], v[100:103]
 s_add_u32 s48, s48, 132096
 v_mfma_f32_16x16x32_bf16 v[140:143], v[180:183], a[20:23], v[140:143]
 s_waitcnt lgkmcnt(0) vmcnt(43)
 s_barrier
 v_mfma_f32_16x16x32_bf16 v[64:67], v[184:187], a[24:27], v[64:67]
 s_add_u32 m0, s46, 20480
 ds_read_b64_tr_b16 v[144:145], v14 offset:40960
 ds_read_b64_tr_b16 v[146:147], v14 offset:42240
 v_mfma_f32_16x16x32_bf16 v[104:107], v[184:187], a[28:31], v[104:107]
 s_add_u32 s49, s45, 655360
 ds_read_b64_tr_b16 v[148:149], v15 offset:40992
 v_mfma_f32_16x16x32_bf16 v[68:71], v[188:191], a[24:27], v[68:71]
 buffer_load_dwordx4 v8, s[24:27], s49 offen lds
 ds_read_b64_tr_b16 v[150:151], v15 offset:42272
 v_mfma_f32_16x16x32_bf16 v[108:111], v[188:191], a[28:31], v[108:111]
 s_add_u32 m0, s46, 21504
 ds_read_b64_tr_b16 v[152:153], v14 offset:41024
 v_mfma_f32_16x16x32_bf16 v[72:75], v[192:195], a[24:27], v[72:75]
 buffer_load_dwordx4 v9, s[24:27], s49 offen lds
 ds_read_b64_tr_b16 v[154:155], v14 offset:42304
 v_mfma_f32_16x16x32_bf16 v[112:115], v[192:195], a[28:31], v[112:115]
 s_add_u32 m0, s46, 22528
 ds_read_b64_tr_b16 v[156:157], v15 offset:41056
 ds_read_b64_tr_b16 v[158:159], v15 offset:42336
 v_mfma_f32_16x16x32_bf16 v[76:79], v[196:199], a[24:27], v[76:79]
 buffer_load_dwordx4 v10, s[24:27], s49 offen lds
 ds_read_b64_tr_b16 v[160:161], v14 offset:41088
 v_mfma_f32_16x16x32_bf16 v[116:119], v[196:199], a[28:31], v[116:119]
 s_add_u32 m0, s46, 23552
 ds_read_b64_tr_b16 v[162:163], v14 offset:42368
 v_mfma_f32_16x16x32_bf16 v[80:83], v[200:203], a[24:27], v[80:83]
 buffer_load_dwordx4 v11, s[24:27], s49 offen lds
 ds_read_b64_tr_b16 v[164:165], v15 offset:41120
 v_mfma_f32_16x16x32_bf16 v[120:123], v[200:203], a[28:31], v[120:123]
 s_add_u32 m0, s46, 24576
 ds_read_b64_tr_b16 v[166:167], v15 offset:42400
 v_mfma_f32_16x16x32_bf16 v[84:87], v[204:207], a[24:27], v[84:87]
 buffer_load_dwordx4 v12, s[24:27], s49 offen lds
 ds_read_b64_tr_b16 v[168:169], v14 offset:41152
 v_mfma_f32_16x16x32_bf16 v[124:127], v[204:207], a[28:31], v[124:127]
 ds_read_b64_tr_b16 v[170:171], v14 offset:42432
 ds_read_b64_tr_b16 v[172:173], v15 offset:41184
 v_mfma_f32_16x16x32_bf16 v[88:91], v[208:211], a[24:27], v[88:91]
 ds_read_b64_tr_b16 v[174:175], v15 offset:42464
 v_mfma_f32_16x16x32_bf16 v[128:131], v[208:211], a[28:31], v[128:131]
 buffer_load_dwordx4 a[104:107], v6, s[16:19], s48 offen offset:0 sc1
 ds_read_b64_tr_b16 v[176:177], v14 offset:41216
 v_mfma_f32_16x16x32_bf16 v[92:95], v[212:215], a[24:27], v[92:95]
 ds_read_b64_tr_b16 v[178:179], v14 offset:42496
 v_mfma_f32_16x16x32_bf16 v[132:135], v[212:215], a[28:31], v[132:135]
 ds_read_b64_tr_b16 v[180:181], v15 offset:41248
 v_mfma_f32_16x16x32_bf16 v[96:99], v[216:219], a[24:27], v[96:99]
 ds_read_b64_tr_b16 v[182:183], v15 offset:42528
 v_mfma_f32_16x16x32_bf16 v[136:139], v[216:219], a[28:31], v[136:139]
 buffer_load_dwordx4 a[108:111], v6, s[16:19], s48 offen offset:128 sc1
 v_mfma_f32_16x16x32_bf16 v[100:103], v[220:223], a[24:27], v[100:103]
 s_add_u32 s48, s48, 132096
 v_mfma_f32_16x16x32_bf16 v[140:143], v[220:223], a[28:31], v[140:143]
 s_waitcnt lgkmcnt(0) vmcnt(48)
 v_mfma_f32_16x16x32_bf16 v[64:67], v[144:147], a[32:35], v[64:67]
 ds_read_b64_tr_b16 v[184:185], v14 offset:51200
 ds_read_b64_tr_b16 v[186:187], v14 offset:52480
 v_mfma_f32_16x16x32_bf16 v[104:107], v[144:147], a[36:39], v[104:107]
 ds_read_b64_tr_b16 v[188:189], v15 offset:51232
 v_mfma_f32_16x16x32_bf16 v[68:71], v[148:151], a[32:35], v[68:71]
 ds_read_b64_tr_b16 v[190:191], v15 offset:52512
 v_mfma_f32_16x16x32_bf16 v[108:111], v[148:151], a[36:39], v[108:111]
 ds_read_b64_tr_b16 v[192:193], v14 offset:51264
 v_mfma_f32_16x16x32_bf16 v[72:75], v[152:155], a[32:35], v[72:75]
 ds_read_b64_tr_b16 v[194:195], v14 offset:52544
 v_mfma_f32_16x16x32_bf16 v[112:115], v[152:155], a[36:39], v[112:115]
 ds_read_b64_tr_b16 v[196:197], v15 offset:51296
 ds_read_b64_tr_b16 v[198:199], v15 offset:52576
 v_mfma_f32_16x16x32_bf16 v[76:79], v[156:159], a[32:35], v[76:79]
 ds_read_b64_tr_b16 v[200:201], v14 offset:51328
 v_mfma_f32_16x16x32_bf16 v[116:119], v[156:159], a[36:39], v[116:119]
 ds_read_b64_tr_b16 v[202:203], v14 offset:52608
 v_mfma_f32_16x16x32_bf16 v[80:83], v[160:163], a[32:35], v[80:83]
 ds_read_b64_tr_b16 v[204:205], v15 offset:51360
 v_mfma_f32_16x16x32_bf16 v[120:123], v[160:163], a[36:39], v[120:123]
 ds_read_b64_tr_b16 v[206:207], v15 offset:52640
 v_mfma_f32_16x16x32_bf16 v[84:87], v[164:167], a[32:35], v[84:87]
 ds_read_b64_tr_b16 v[208:209], v14 offset:51392
 v_mfma_f32_16x16x32_bf16 v[124:127], v[164:167], a[36:39], v[124:127]
 ds_read_b64_tr_b16 v[210:211], v14 offset:52672
 ds_read_b64_tr_b16 v[212:213], v15 offset:51424
 v_mfma_f32_16x16x32_bf16 v[88:91], v[168:171], a[32:35], v[88:91]
 ds_read_b64_tr_b16 v[214:215], v15 offset:52704
 v_mfma_f32_16x16x32_bf16 v[128:131], v[168:171], a[36:39], v[128:131]
 buffer_load_dwordx4 a[112:115], v6, s[16:19], s48 offen offset:0 sc1
 ds_read_b64_tr_b16 v[216:217], v14 offset:51456
 v_mfma_f32_16x16x32_bf16 v[92:95], v[172:175], a[32:35], v[92:95]
 ds_read_b64_tr_b16 v[218:219], v14 offset:52736
 v_mfma_f32_16x16x32_bf16 v[132:135], v[172:175], a[36:39], v[132:135]
 ds_read_b64_tr_b16 v[220:221], v15 offset:51488
 v_mfma_f32_16x16x32_bf16 v[96:99], v[176:179], a[32:35], v[96:99]
 ds_read_b64_tr_b16 v[222:223], v15 offset:52768
 v_mfma_f32_16x16x32_bf16 v[136:139], v[176:179], a[36:39], v[136:139]
 buffer_load_dwordx4 a[116:119], v6, s[16:19], s48 offen offset:128 sc1
 v_mfma_f32_16x16x32_bf16 v[100:103], v[180:183], a[32:35], v[100:103]
 s_add_u32 s48, s48, 132096
 v_mfma_f32_16x16x32_bf16 v[140:143], v[180:183], a[36:39], v[140:143]
 s_waitcnt lgkmcnt(0) vmcnt(43)
 s_barrier
 v_mfma_f32_16x16x32_bf16 v[64:67], v[184:187], a[40:43], v[64:67]
 s_add_u32 m0, s46, 40960
 ds_read_b64_tr_b16 v[144:145], v16 offset:0
 ds_read_b64_tr_b16 v[146:147], v16 offset:1280
 v_mfma_f32_16x16x32_bf16 v[104:107], v[184:187], a[44:47], v[104:107]
 s_add_u32 s49, s45, 737280
 ds_read_b64_tr_b16 v[148:149], v17 offset:32
 v_mfma_f32_16x16x32_bf16 v[68:71], v[188:191], a[40:43], v[68:71]
 buffer_load_dwordx4 v8, s[24:27], s49 offen lds
 ds_read_b64_tr_b16 v[150:151], v17 offset:1312
 v_mfma_f32_16x16x32_bf16 v[108:111], v[188:191], a[44:47], v[108:111]
 s_add_u32 m0, s46, 41984
 ds_read_b64_tr_b16 v[152:153], v16 offset:64
 v_mfma_f32_16x16x32_bf16 v[72:75], v[192:195], a[40:43], v[72:75]
 buffer_load_dwordx4 v9, s[24:27], s49 offen lds
 ds_read_b64_tr_b16 v[154:155], v16 offset:1344
 v_mfma_f32_16x16x32_bf16 v[112:115], v[192:195], a[44:47], v[112:115]
 s_add_u32 m0, s46, 43008
 ds_read_b64_tr_b16 v[156:157], v17 offset:96
 ds_read_b64_tr_b16 v[158:159], v17 offset:1376
 v_mfma_f32_16x16x32_bf16 v[76:79], v[196:199], a[40:43], v[76:79]
 buffer_load_dwordx4 v10, s[24:27], s49 offen lds
 ds_read_b64_tr_b16 v[160:161], v16 offset:128
 v_mfma_f32_16x16x32_bf16 v[116:119], v[196:199], a[44:47], v[116:119]
 s_add_u32 m0, s46, 44032
 ds_read_b64_tr_b16 v[162:163], v16 offset:1408
 v_mfma_f32_16x16x32_bf16 v[80:83], v[200:203], a[40:43], v[80:83]
 buffer_load_dwordx4 v11, s[24:27], s49 offen lds
 ds_read_b64_tr_b16 v[164:165], v17 offset:160
 v_mfma_f32_16x16x32_bf16 v[120:123], v[200:203], a[44:47], v[120:123]
 s_add_u32 m0, s46, 45056
 ds_read_b64_tr_b16 v[166:167], v17 offset:1440
 v_mfma_f32_16x16x32_bf16 v[84:87], v[204:207], a[40:43], v[84:87]
 buffer_load_dwordx4 v12, s[24:27], s49 offen lds
 ds_read_b64_tr_b16 v[168:169], v16 offset:192
 v_mfma_f32_16x16x32_bf16 v[124:127], v[204:207], a[44:47], v[124:127]
 ds_read_b64_tr_b16 v[170:171], v16 offset:1472
 ds_read_b64_tr_b16 v[172:173], v17 offset:224
 v_mfma_f32_16x16x32_bf16 v[88:91], v[208:211], a[40:43], v[88:91]
 ds_read_b64_tr_b16 v[174:175], v17 offset:1504
 v_mfma_f32_16x16x32_bf16 v[128:131], v[208:211], a[44:47], v[128:131]
 buffer_load_dwordx4 a[120:123], v6, s[16:19], s48 offen offset:0 sc1
 ds_read_b64_tr_b16 v[176:177], v16 offset:256
 v_mfma_f32_16x16x32_bf16 v[92:95], v[212:215], a[40:43], v[92:95]
 ds_read_b64_tr_b16 v[178:179], v16 offset:1536
 v_mfma_f32_16x16x32_bf16 v[132:135], v[212:215], a[44:47], v[132:135]
 ds_read_b64_tr_b16 v[180:181], v17 offset:288
 v_mfma_f32_16x16x32_bf16 v[96:99], v[216:219], a[40:43], v[96:99]
 ds_read_b64_tr_b16 v[182:183], v17 offset:1568
 v_mfma_f32_16x16x32_bf16 v[136:139], v[216:219], a[44:47], v[136:139]
 buffer_load_dwordx4 a[124:127], v6, s[16:19], s48 offen offset:128 sc1
 v_mfma_f32_16x16x32_bf16 v[100:103], v[220:223], a[40:43], v[100:103]
 s_add_u32 s48, s48, 132096
 v_mfma_f32_16x16x32_bf16 v[140:143], v[220:223], a[44:47], v[140:143]
 s_waitcnt lgkmcnt(0) vmcnt(48)
 v_mfma_f32_16x16x32_bf16 v[64:67], v[144:147], a[48:51], v[64:67]
 ds_read_b64_tr_b16 v[184:185], v16 offset:10240
 ds_read_b64_tr_b16 v[186:187], v16 offset:11520
 v_mfma_f32_16x16x32_bf16 v[104:107], v[144:147], a[52:55], v[104:107]
 ds_read_b64_tr_b16 v[188:189], v17 offset:10272
 v_mfma_f32_16x16x32_bf16 v[68:71], v[148:151], a[48:51], v[68:71]
 ds_read_b64_tr_b16 v[190:191], v17 offset:11552
 v_mfma_f32_16x16x32_bf16 v[108:111], v[148:151], a[52:55], v[108:111]
 ds_read_b64_tr_b16 v[192:193], v16 offset:10304
 v_mfma_f32_16x16x32_bf16 v[72:75], v[152:155], a[48:51], v[72:75]
 ds_read_b64_tr_b16 v[194:195], v16 offset:11584
 v_mfma_f32_16x16x32_bf16 v[112:115], v[152:155], a[52:55], v[112:115]
 ds_read_b64_tr_b16 v[196:197], v17 offset:10336
 ds_read_b64_tr_b16 v[198:199], v17 offset:11616
 v_mfma_f32_16x16x32_bf16 v[76:79], v[156:159], a[48:51], v[76:79]
 ds_read_b64_tr_b16 v[200:201], v16 offset:10368
 v_mfma_f32_16x16x32_bf16 v[116:119], v[156:159], a[52:55], v[116:119]
 ds_read_b64_tr_b16 v[202:203], v16 offset:11648
 v_mfma_f32_16x16x32_bf16 v[80:83], v[160:163], a[48:51], v[80:83]
 ds_read_b64_tr_b16 v[204:205], v17 offset:10400
 v_mfma_f32_16x16x32_bf16 v[120:123], v[160:163], a[52:55], v[120:123]
 ds_read_b64_tr_b16 v[206:207], v17 offset:11680
 v_mfma_f32_16x16x32_bf16 v[84:87], v[164:167], a[48:51], v[84:87]
 ds_read_b64_tr_b16 v[208:209], v16 offset:10432
 v_mfma_f32_16x16x32_bf16 v[124:127], v[164:167], a[52:55], v[124:127]
 ds_read_b64_tr_b16 v[210:211], v16 offset:11712
 ds_read_b64_tr_b16 v[212:213], v17 offset:10464
 v_mfma_f32_16x16x32_bf16 v[88:91], v[168:171], a[48:51], v[88:91]
 ds_read_b64_tr_b16 v[214:215], v17 offset:11744
 v_mfma_f32_16x16x32_bf16 v[128:131], v[168:171], a[52:55], v[128:131]
 buffer_load_dwordx4 a[128:131], v6, s[16:19], s48 offen offset:0 sc1
 ds_read_b64_tr_b16 v[216:217], v16 offset:10496
 v_mfma_f32_16x16x32_bf16 v[92:95], v[172:175], a[48:51], v[92:95]
 ds_read_b64_tr_b16 v[218:219], v16 offset:11776
 v_mfma_f32_16x16x32_bf16 v[132:135], v[172:175], a[52:55], v[132:135]
 ds_read_b64_tr_b16 v[220:221], v17 offset:10528
 v_mfma_f32_16x16x32_bf16 v[96:99], v[176:179], a[48:51], v[96:99]
 ds_read_b64_tr_b16 v[222:223], v17 offset:11808
 v_mfma_f32_16x16x32_bf16 v[136:139], v[176:179], a[52:55], v[136:139]
 buffer_load_dwordx4 a[132:135], v6, s[16:19], s48 offen offset:128 sc1
 v_mfma_f32_16x16x32_bf16 v[100:103], v[180:183], a[48:51], v[100:103]
 s_add_u32 s48, s48, 132096
 v_mfma_f32_16x16x32_bf16 v[140:143], v[180:183], a[52:55], v[140:143]
 s_waitcnt lgkmcnt(0) vmcnt(43)
 s_barrier
 v_mfma_f32_16x16x32_bf16 v[64:67], v[184:187], a[56:59], v[64:67]
 ds_read_b64_tr_b16 v[144:145], v16 offset:20480
 ds_read_b64_tr_b16 v[146:147], v16 offset:21760
 v_mfma_f32_16x16x32_bf16 v[104:107], v[184:187], a[60:63], v[104:107]
 ds_read_b64_tr_b16 v[148:149], v17 offset:20512
 v_mfma_f32_16x16x32_bf16 v[68:71], v[188:191], a[56:59], v[68:71]
 ds_read_b64_tr_b16 v[150:151], v17 offset:21792
 v_mfma_f32_16x16x32_bf16 v[108:111], v[188:191], a[60:63], v[108:111]
 ds_read_b64_tr_b16 v[152:153], v16 offset:20544
 v_mfma_f32_16x16x32_bf16 v[72:75], v[192:195], a[56:59], v[72:75]
 ds_read_b64_tr_b16 v[154:155], v16 offset:21824
 v_mfma_f32_16x16x32_bf16 v[112:115], v[192:195], a[60:63], v[112:115]
 ds_read_b64_tr_b16 v[156:157], v17 offset:20576
 ds_read_b64_tr_b16 v[158:159], v17 offset:21856
 v_mfma_f32_16x16x32_bf16 v[76:79], v[196:199], a[56:59], v[76:79]
 ds_read_b64_tr_b16 v[160:161], v16 offset:20608
 v_mfma_f32_16x16x32_bf16 v[116:119], v[196:199], a[60:63], v[116:119]
 ds_read_b64_tr_b16 v[162:163], v16 offset:21888
 v_mfma_f32_16x16x32_bf16 v[80:83], v[200:203], a[56:59], v[80:83]
 ds_read_b64_tr_b16 v[164:165], v17 offset:20640
 v_mfma_f32_16x16x32_bf16 v[120:123], v[200:203], a[60:63], v[120:123]
 ds_read_b64_tr_b16 v[166:167], v17 offset:21920
 v_mfma_f32_16x16x32_bf16 v[84:87], v[204:207], a[56:59], v[84:87]
 ds_read_b64_tr_b16 v[168:169], v16 offset:20672
 v_mfma_f32_16x16x32_bf16 v[124:127], v[204:207], a[60:63], v[124:127]
 ds_read_b64_tr_b16 v[170:171], v16 offset:21952
 ds_read_b64_tr_b16 v[172:173], v17 offset:20704
 v_mfma_f32_16x16x32_bf16 v[88:91], v[208:211], a[56:59], v[88:91]
 ds_read_b64_tr_b16 v[174:175], v17 offset:21984
 v_mfma_f32_16x16x32_bf16 v[128:131], v[208:211], a[60:63], v[128:131]
 buffer_load_dwordx4 a[136:139], v6, s[16:19], s48 offen offset:0 sc1
 ds_read_b64_tr_b16 v[176:177], v16 offset:20736
 v_mfma_f32_16x16x32_bf16 v[92:95], v[212:215], a[56:59], v[92:95]
 ds_read_b64_tr_b16 v[178:179], v16 offset:22016
 v_mfma_f32_16x16x32_bf16 v[132:135], v[212:215], a[60:63], v[132:135]
 ds_read_b64_tr_b16 v[180:181], v17 offset:20768
 v_mfma_f32_16x16x32_bf16 v[96:99], v[216:219], a[56:59], v[96:99]
 ds_read_b64_tr_b16 v[182:183], v17 offset:22048
 v_mfma_f32_16x16x32_bf16 v[136:139], v[216:219], a[60:63], v[136:139]
 buffer_load_dwordx4 a[140:143], v6, s[16:19], s48 offen offset:128 sc1
 v_mfma_f32_16x16x32_bf16 v[100:103], v[220:223], a[56:59], v[100:103]
 s_add_u32 s48, s48, 132096
 v_mfma_f32_16x16x32_bf16 v[140:143], v[220:223], a[60:63], v[140:143]
 s_waitcnt lgkmcnt(0) vmcnt(43)
 v_mfma_f32_16x16x32_bf16 v[64:67], v[144:147], a[64:67], v[64:67]
 ds_read_b64_tr_b16 v[184:185], v16 offset:30720
 ds_read_b64_tr_b16 v[186:187], v16 offset:32000
 v_mfma_f32_16x16x32_bf16 v[104:107], v[144:147], a[68:71], v[104:107]
 ds_read_b64_tr_b16 v[188:189], v17 offset:30752
 v_mfma_f32_16x16x32_bf16 v[68:71], v[148:151], a[64:67], v[68:71]
 ds_read_b64_tr_b16 v[190:191], v17 offset:32032
 v_mfma_f32_16x16x32_bf16 v[108:111], v[148:151], a[68:71], v[108:111]
 ds_read_b64_tr_b16 v[192:193], v16 offset:30784
 v_mfma_f32_16x16x32_bf16 v[72:75], v[152:155], a[64:67], v[72:75]
 ds_read_b64_tr_b16 v[194:195], v16 offset:32064
 v_mfma_f32_16x16x32_bf16 v[112:115], v[152:155], a[68:71], v[112:115]
 ds_read_b64_tr_b16 v[196:197], v17 offset:30816
 ds_read_b64_tr_b16 v[198:199], v17 offset:32096
 v_mfma_f32_16x16x32_bf16 v[76:79], v[156:159], a[64:67], v[76:79]
 ds_read_b64_tr_b16 v[200:201], v16 offset:30848
 v_mfma_f32_16x16x32_bf16 v[116:119], v[156:159], a[68:71], v[116:119]
 ds_read_b64_tr_b16 v[202:203], v16 offset:32128
 v_mfma_f32_16x16x32_bf16 v[80:83], v[160:163], a[64:67], v[80:83]
 ds_read_b64_tr_b16 v[204:205], v17 offset:30880
 v_mfma_f32_16x16x32_bf16 v[120:123], v[160:163], a[68:71], v[120:123]
 ds_read_b64_tr_b16 v[206:207], v17 offset:32160
 v_mfma_f32_16x16x32_bf16 v[84:87], v[164:167], a[64:67], v[84:87]
 ds_read_b64_tr_b16 v[208:209], v16 offset:30912
 v_mfma_f32_16x16x32_bf16 v[124:127], v[164:167], a[68:71], v[124:127]
 ds_read_b64_tr_b16 v[210:211], v16 offset:32192
 ds_read_b64_tr_b16 v[212:213], v17 offset:30944
 v_mfma_f32_16x16x32_bf16 v[88:91], v[168:171], a[64:67], v[88:91]
 ds_read_b64_tr_b16 v[214:215], v17 offset:32224
 v_mfma_f32_16x16x32_bf16 v[128:131], v[168:171], a[68:71], v[128:131]
 buffer_load_dwordx4 a[144:147], v6, s[16:19], s48 offen offset:0 sc1
 ds_read_b64_tr_b16 v[216:217], v16 offset:30976
 v_mfma_f32_16x16x32_bf16 v[92:95], v[172:175], a[64:67], v[92:95]
 ds_read_b64_tr_b16 v[218:219], v16 offset:32256
 v_mfma_f32_16x16x32_bf16 v[132:135], v[172:175], a[68:71], v[132:135]
 ds_read_b64_tr_b16 v[220:221], v17 offset:31008
 v_mfma_f32_16x16x32_bf16 v[96:99], v[176:179], a[64:67], v[96:99]
 ds_read_b64_tr_b16 v[222:223], v17 offset:32288
 v_mfma_f32_16x16x32_bf16 v[136:139], v[176:179], a[68:71], v[136:139]
 buffer_load_dwordx4 a[148:151], v6, s[16:19], s48 offen offset:128 sc1
 v_mfma_f32_16x16x32_bf16 v[100:103], v[180:183], a[64:67], v[100:103]
 s_add_u32 s48, s48, 132096
 v_mfma_f32_16x16x32_bf16 v[140:143], v[180:183], a[68:71], v[140:143]
 s_waitcnt lgkmcnt(0) vmcnt(38)
 s_barrier
 v_mfma_f32_16x16x32_bf16 v[64:67], v[184:187], a[72:75], v[64:67]
 ds_read_b64_tr_b16 v[144:145], v16 offset:40960
 ds_read_b64_tr_b16 v[146:147], v16 offset:42240
 v_mfma_f32_16x16x32_bf16 v[104:107], v[184:187], a[76:79], v[104:107]
 ds_read_b64_tr_b16 v[148:149], v17 offset:40992
 v_mfma_f32_16x16x32_bf16 v[68:71], v[188:191], a[72:75], v[68:71]
 ds_read_b64_tr_b16 v[150:151], v17 offset:42272
 v_mfma_f32_16x16x32_bf16 v[108:111], v[188:191], a[76:79], v[108:111]
 ds_read_b64_tr_b16 v[152:153], v16 offset:41024
 v_mfma_f32_16x16x32_bf16 v[72:75], v[192:195], a[72:75], v[72:75]
 ds_read_b64_tr_b16 v[154:155], v16 offset:42304
 v_mfma_f32_16x16x32_bf16 v[112:115], v[192:195], a[76:79], v[112:115]
 ds_read_b64_tr_b16 v[156:157], v17 offset:41056
 ds_read_b64_tr_b16 v[158:159], v17 offset:42336
 v_mfma_f32_16x16x32_bf16 v[76:79], v[196:199], a[72:75], v[76:79]
 ds_read_b64_tr_b16 v[160:161], v16 offset:41088
 v_mfma_f32_16x16x32_bf16 v[116:119], v[196:199], a[76:79], v[116:119]
 ds_read_b64_tr_b16 v[162:163], v16 offset:42368
 v_mfma_f32_16x16x32_bf16 v[80:83], v[200:203], a[72:75], v[80:83]
 ds_read_b64_tr_b16 v[164:165], v17 offset:41120
 v_mfma_f32_16x16x32_bf16 v[120:123], v[200:203], a[76:79], v[120:123]
 ds_read_b64_tr_b16 v[166:167], v17 offset:42400
 v_mfma_f32_16x16x32_bf16 v[84:87], v[204:207], a[72:75], v[84:87]
 ds_read_b64_tr_b16 v[168:169], v16 offset:41152
 v_mfma_f32_16x16x32_bf16 v[124:127], v[204:207], a[76:79], v[124:127]
 ds_read_b64_tr_b16 v[170:171], v16 offset:42432
 ds_read_b64_tr_b16 v[172:173], v17 offset:41184
 v_mfma_f32_16x16x32_bf16 v[88:91], v[208:211], a[72:75], v[88:91]
 ds_read_b64_tr_b16 v[174:175], v17 offset:42464
 v_mfma_f32_16x16x32_bf16 v[128:131], v[208:211], a[76:79], v[128:131]
 buffer_load_dwordx4 a[152:155], v6, s[16:19], s48 offen offset:0 sc1
 ds_read_b64_tr_b16 v[176:177], v16 offset:41216
 v_mfma_f32_16x16x32_bf16 v[92:95], v[212:215], a[72:75], v[92:95]
 ds_read_b64_tr_b16 v[178:179], v16 offset:42496
 v_mfma_f32_16x16x32_bf16 v[132:135], v[212:215], a[76:79], v[132:135]
 ds_read_b64_tr_b16 v[180:181], v17 offset:41248
 v_mfma_f32_16x16x32_bf16 v[96:99], v[216:219], a[72:75], v[96:99]
 ds_read_b64_tr_b16 v[182:183], v17 offset:42528
 v_mfma_f32_16x16x32_bf16 v[136:139], v[216:219], a[76:79], v[136:139]
 buffer_load_dwordx4 a[156:159], v6, s[16:19], s48 offen offset:128 sc1
 v_mfma_f32_16x16x32_bf16 v[100:103], v[220:223], a[72:75], v[100:103]
 s_add_u32 s48, s48, 132096
 v_mfma_f32_16x16x32_bf16 v[140:143], v[220:223], a[76:79], v[140:143]
 s_waitcnt lgkmcnt(0) vmcnt(33)
 v_mfma_f32_16x16x32_bf16 v[64:67], v[144:147], a[80:83], v[64:67]
 ds_read_b64_tr_b16 v[184:185], v16 offset:51200
 ds_read_b64_tr_b16 v[186:187], v16 offset:52480
 v_mfma_f32_16x16x32_bf16 v[104:107], v[144:147], a[84:87], v[104:107]
 ds_read_b64_tr_b16 v[188:189], v17 offset:51232
 v_mfma_f32_16x16x32_bf16 v[68:71], v[148:151], a[80:83], v[68:71]
 ds_read_b64_tr_b16 v[190:191], v17 offset:52512
 v_mfma_f32_16x16x32_bf16 v[108:111], v[148:151], a[84:87], v[108:111]
 ds_read_b64_tr_b16 v[192:193], v16 offset:51264
 v_mfma_f32_16x16x32_bf16 v[72:75], v[152:155], a[80:83], v[72:75]
 ds_read_b64_tr_b16 v[194:195], v16 offset:52544
 v_mfma_f32_16x16x32_bf16 v[112:115], v[152:155], a[84:87], v[112:115]
 ds_read_b64_tr_b16 v[196:197], v17 offset:51296
 ds_read_b64_tr_b16 v[198:199], v17 offset:52576
 v_mfma_f32_16x16x32_bf16 v[76:79], v[156:159], a[80:83], v[76:79]
 ds_read_b64_tr_b16 v[200:201], v16 offset:51328
 v_mfma_f32_16x16x32_bf16 v[116:119], v[156:159], a[84:87], v[116:119]
 ds_read_b64_tr_b16 v[202:203], v16 offset:52608
 v_mfma_f32_16x16x32_bf16 v[80:83], v[160:163], a[80:83], v[80:83]
 ds_read_b64_tr_b16 v[204:205], v17 offset:51360
 v_mfma_f32_16x16x32_bf16 v[120:123], v[160:163], a[84:87], v[120:123]
 ds_read_b64_tr_b16 v[206:207], v17 offset:52640
 v_mfma_f32_16x16x32_bf16 v[84:87], v[164:167], a[80:83], v[84:87]
 ds_read_b64_tr_b16 v[208:209], v16 offset:51392
 v_mfma_f32_16x16x32_bf16 v[124:127], v[164:167], a[84:87], v[124:127]
 ds_read_b64_tr_b16 v[210:211], v16 offset:52672
 ds_read_b64_tr_b16 v[212:213], v17 offset:51424
 v_mfma_f32_16x16x32_bf16 v[88:91], v[168:171], a[80:83], v[88:91]
 ds_read_b64_tr_b16 v[214:215], v17 offset:52704
 v_mfma_f32_16x16x32_bf16 v[128:131], v[168:171], a[84:87], v[128:131]
 buffer_load_dwordx4 v[52:55], v4, s[12:15], 0 offen
 ds_read_b64_tr_b16 v[216:217], v16 offset:51456
 v_mfma_f32_16x16x32_bf16 v[92:95], v[172:175], a[80:83], v[92:95]
 ds_read_b64_tr_b16 v[218:219], v16 offset:52736
 v_mfma_f32_16x16x32_bf16 v[132:135], v[172:175], a[84:87], v[132:135]
 ds_read_b64_tr_b16 v[220:221], v17 offset:51488
 v_mfma_f32_16x16x32_bf16 v[96:99], v[176:179], a[80:83], v[96:99]
 ds_read_b64_tr_b16 v[222:223], v17 offset:52768
 v_mfma_f32_16x16x32_bf16 v[136:139], v[176:179], a[84:87], v[136:139]
 buffer_load_dword v56, v5, s[12:15], 0 offen offset:1024
 v_mfma_f32_16x16x32_bf16 v[100:103], v[180:183], a[80:83], v[100:103]
 s_mul_i32 s50, s59, 1280
 v_mfma_f32_16x16x32_bf16 v[140:143], v[180:183], a[84:87], v[140:143]
 s_waitcnt lgkmcnt(0) vmcnt(28)
 s_barrier
 v_mfma_f32_16x16x32_bf16 v[64:67], v[184:187], a[88:91], v[64:67]
 ds_read_b64_tr_b16 v[144:145], v18 offset:0
 ds_read_b64_tr_b16 v[146:147], v18 offset:1280
 v_mfma_f32_16x16x32_bf16 v[104:107], v[184:187], a[92:95], v[104:107]
 ds_read_b64_tr_b16 v[148:149], v19 offset:32
 v_mfma_f32_16x16x32_bf16 v[68:71], v[188:191], a[88:91], v[68:71]
 ds_read_b64_tr_b16 v[150:151], v19 offset:1312
 v_mfma_f32_16x16x32_bf16 v[108:111], v[188:191], a[92:95], v[108:111]
 ds_read_b64_tr_b16 v[152:153], v18 offset:64
 v_mfma_f32_16x16x32_bf16 v[72:75], v[192:195], a[88:91], v[72:75]
 ds_read_b64_tr_b16 v[154:155], v18 offset:1344
 v_mfma_f32_16x16x32_bf16 v[112:115], v[192:195], a[92:95], v[112:115]
 ds_read_b64_tr_b16 v[156:157], v19 offset:96
 ds_read_b64_tr_b16 v[158:159], v19 offset:1376
 v_mfma_f32_16x16x32_bf16 v[76:79], v[196:199], a[88:91], v[76:79]
 ds_read_b64_tr_b16 v[160:161], v18 offset:128
 v_mfma_f32_16x16x32_bf16 v[116:119], v[196:199], a[92:95], v[116:119]
 ds_read_b64_tr_b16 v[162:163], v18 offset:1408
 v_mfma_f32_16x16x32_bf16 v[80:83], v[200:203], a[88:91], v[80:83]
 ds_read_b64_tr_b16 v[164:165], v19 offset:160
 v_mfma_f32_16x16x32_bf16 v[120:123], v[200:203], a[92:95], v[120:123]
 ds_read_b64_tr_b16 v[166:167], v19 offset:1440
 v_mfma_f32_16x16x32_bf16 v[84:87], v[204:207], a[88:91], v[84:87]
 ds_read_b64_tr_b16 v[168:169], v18 offset:192
 v_mfma_f32_16x16x32_bf16 v[124:127], v[204:207], a[92:95], v[124:127]
 ds_read_b64_tr_b16 v[170:171], v18 offset:1472
 ds_read_b64_tr_b16 v[172:173], v19 offset:224
 v_mfma_f32_16x16x32_bf16 v[88:91], v[208:211], a[88:91], v[88:91]
 ds_read_b64_tr_b16 v[174:175], v19 offset:1504
 v_mfma_f32_16x16x32_bf16 v[128:131], v[208:211], a[92:95], v[128:131]
 buffer_load_dwordx4 v[224:227], v4, s[8:11], s50 offen
 ds_read_b64_tr_b16 v[176:177], v18 offset:256
 v_mfma_f32_16x16x32_bf16 v[92:95], v[212:215], a[88:91], v[92:95]
 ds_read_b64_tr_b16 v[178:179], v18 offset:1536
 v_mfma_f32_16x16x32_bf16 v[132:135], v[212:215], a[92:95], v[132:135]
 ds_read_b64_tr_b16 v[180:181], v19 offset:288
 v_mfma_f32_16x16x32_bf16 v[96:99], v[216:219], a[88:91], v[96:99]
 ds_read_b64_tr_b16 v[182:183], v19 offset:1568
 v_mfma_f32_16x16x32_bf16 v[136:139], v[216:219], a[92:95], v[136:139]
 buffer_load_dword v228, v5, s[8:11], s50 offen offset:1024
 v_mfma_f32_16x16x32_bf16 v[100:103], v[220:223], a[88:91], v[100:103]
 s_add_u32 s50, s50, 1280
 v_mfma_f32_16x16x32_bf16 v[140:143], v[220:223], a[92:95], v[140:143]
 s_waitcnt lgkmcnt(0) vmcnt(28)
 v_mfma_f32_16x16x32_bf16 v[64:67], v[144:147], a[96:99], v[64:67]
 ds_read_b64_tr_b16 v[184:185], v18 offset:10240
 ds_read_b64_tr_b16 v[186:187], v18 offset:11520
 v_mfma_f32_16x16x32_bf16 v[104:107], v[144:147], a[100:103], v[104:107]
 ds_read_b64_tr_b16 v[188:189], v19 offset:10272
 v_mfma_f32_16x16x32_bf16 v[68:71], v[148:151], a[96:99], v[68:71]
 ds_read_b64_tr_b16 v[190:191], v19 offset:11552
 v_mfma_f32_16x16x32_bf16 v[108:111], v[148:151], a[100:103], v[108:111]
 ds_read_b64_tr_b16 v[192:193], v18 offset:10304
 v_mfma_f32_16x16x32_bf16 v[72:75], v[152:155], a[96:99], v[72:75]
 ds_read_b64_tr_b16 v[194:195], v18 offset:11584
 v_mfma_f32_16x16x32_bf16 v[112:115], v[152:155], a[100:103], v[112:115]
 ds_read_b64_tr_b16 v[196:197], v19 offset:10336
 ds_read_b64_tr_b16 v[198:199], v19 offset:11616
 v_mfma_f32_16x16x32_bf16 v[76:79], v[156:159], a[96:99], v[76:79]
 ds_read_b64_tr_b16 v[200:201], v18 offset:10368
 v_mfma_f32_16x16x32_bf16 v[116:119], v[156:159], a[100:103], v[116:119]
 ds_read_b64_tr_b16 v[202:203], v18 offset:11648
 v_mfma_f32_16x16x32_bf16 v[80:83], v[160:163], a[96:99], v[80:83]
 ds_read_b64_tr_b16 v[204:205], v19 offset:10400
 v_mfma_f32_16x16x32_bf16 v[120:123], v[160:163], a[100:103], v[120:123]
 ds_read_b64_tr_b16 v[206:207], v19 offset:11680
 v_mfma_f32_16x16x32_bf16 v[84:87], v[164:167], a[96:99], v[84:87]
 ds_read_b64_tr_b16 v[208:209], v18 offset:10432
 v_mfma_f32_16x16x32_bf16 v[124:127], v[164:167], a[100:103], v[124:127]
 ds_read_b64_tr_b16 v[210:211], v18 offset:11712
 ds_read_b64_tr_b16 v[212:213], v19 offset:10464
 v_mfma_f32_16x16x32_bf16 v[88:91], v[168:171], a[96:99], v[88:91]
 ds_read_b64_tr_b16 v[214:215], v19 offset:11744
 v_mfma_f32_16x16x32_bf16 v[128:131], v[168:171], a[100:103], v[128:131]
 buffer_load_dwordx4 v[230:233], v4, s[8:11], s50 offen
 ds_read_b64_tr_b16 v[216:217], v18 offset:10496
 v_mfma_f32_16x16x32_bf16 v[92:95], v[172:175], a[96:99], v[92:95]
 ds_read_b64_tr_b16 v[218:219], v18 offset:11776
 v_mfma_f32_16x16x32_bf16 v[132:135], v[172:175], a[100:103], v[132:135]
 ds_read_b64_tr_b16 v[220:221], v19 offset:10528
 v_mfma_f32_16x16x32_bf16 v[96:99], v[176:179], a[96:99], v[96:99]
 ds_read_b64_tr_b16 v[222:223], v19 offset:11808
 v_mfma_f32_16x16x32_bf16 v[136:139], v[176:179], a[100:103], v[136:139]
 buffer_load_dword v234, v5, s[8:11], s50 offen offset:1024
 v_mfma_f32_16x16x32_bf16 v[100:103], v[180:183], a[96:99], v[100:103]
 s_add_u32 s50, s50, 1280
 v_mfma_f32_16x16x32_bf16 v[140:143], v[180:183], a[100:103], v[140:143]
 s_waitcnt lgkmcnt(0) vmcnt(23)
 s_barrier
 v_mfma_f32_16x16x32_bf16 v[64:67], v[184:187], a[104:107], v[64:67]
 ds_read_b64_tr_b16 v[144:145], v14 offset:0
 ds_read_b64_tr_b16 v[146:147], v14 offset:1280
 v_mfma_f32_16x16x32_bf16 v[104:107], v[184:187], a[108:111], v[104:107]
 ds_read_b64_tr_b16 v[148:149], v15 offset:32
 v_mfma_f32_16x16x32_bf16 v[68:71], v[188:191], a[104:107], v[68:71]
 ds_read_b64_tr_b16 v[150:151], v15 offset:1312
 v_mfma_f32_16x16x32_bf16 v[108:111], v[188:191], a[108:111], v[108:111]
 ds_read_b64_tr_b16 v[152:153], v14 offset:64
 v_mfma_f32_16x16x32_bf16 v[72:75], v[192:195], a[104:107], v[72:75]
 ds_read_b64_tr_b16 v[154:155], v14 offset:1344
 v_mfma_f32_16x16x32_bf16 v[112:115], v[192:195], a[108:111], v[112:115]
 ds_read_b64_tr_b16 v[156:157], v15 offset:96
 ds_read_b64_tr_b16 v[158:159], v15 offset:1376
 v_mfma_f32_16x16x32_bf16 v[76:79], v[196:199], a[104:107], v[76:79]
 ds_read_b64_tr_b16 v[160:161], v14 offset:128
 v_mfma_f32_16x16x32_bf16 v[116:119], v[196:199], a[108:111], v[116:119]
 ds_read_b64_tr_b16 v[162:163], v14 offset:1408
 v_mfma_f32_16x16x32_bf16 v[80:83], v[200:203], a[104:107], v[80:83]
 ds_read_b64_tr_b16 v[164:165], v15 offset:160
 v_mfma_f32_16x16x32_bf16 v[120:123], v[200:203], a[108:111], v[120:123]
 ds_read_b64_tr_b16 v[166:167], v15 offset:1440
 v_mfma_f32_16x16x32_bf16 v[84:87], v[204:207], a[104:107], v[84:87]
 ds_read_b64_tr_b16 v[168:169], v14 offset:192
 v_mfma_f32_16x16x32_bf16 v[124:127], v[204:207], a[108:111], v[124:127]
 ds_read_b64_tr_b16 v[170:171], v14 offset:1472
 ds_read_b64_tr_b16 v[172:173], v15 offset:224
 v_mfma_f32_16x16x32_bf16 v[88:91], v[208:211], a[104:107], v[88:91]
 ds_read_b64_tr_b16 v[174:175], v15 offset:1504
 v_mfma_f32_16x16x32_bf16 v[128:131], v[208:211], a[108:111], v[128:131]
 buffer_load_dwordx4 v[236:239], v4, s[8:11], s50 offen
 ds_read_b64_tr_b16 v[176:177], v14 offset:256
 v_mfma_f32_16x16x32_bf16 v[92:95], v[212:215], a[104:107], v[92:95]
 ds_read_b64_tr_b16 v[178:179], v14 offset:1536
 v_mfma_f32_16x16x32_bf16 v[132:135], v[212:215], a[108:111], v[132:135]
 ds_read_b64_tr_b16 v[180:181], v15 offset:288
 v_mfma_f32_16x16x32_bf16 v[96:99], v[216:219], a[104:107], v[96:99]
 ds_read_b64_tr_b16 v[182:183], v15 offset:1568
 v_mfma_f32_16x16x32_bf16 v[136:139], v[216:219], a[108:111], v[136:139]
 buffer_load_dword v240, v5, s[8:11], s50 offen offset:1024
 v_mfma_f32_16x16x32_bf16 v[100:103], v[220:223], a[104:107], v[100:103]
 s_add_u32 s50, s50, 1280
 v_mfma_f32_16x16x32_bf16 v[140:143], v[220:223], a[108:111], v[140:143]
 s_waitcnt lgkmcnt(0) vmcnt(23)
 v_mfma_f32_16x16x32_bf16 v[64:67], v[144:147], a[112:115], v[64:67]
 ds_read_b64_tr_b16 v[184:185], v14 offset:10240
 ds_read_b64_tr_b16 v[186:187], v14 offset:11520
 v_mfma_f32_16x16x32_bf16 v[104:107], v[144:147], a[116:119], v[104:107]
 ds_read_b64_tr_b16 v[188:189], v15 offset:10272
 v_mfma_f32_16x16x32_bf16 v[68:71], v[148:151], a[112:115], v[68:71]
 ds_read_b64_tr_b16 v[190:191], v15 offset:11552
 v_mfma_f32_16x16x32_bf16 v[108:111], v[148:151], a[116:119], v[108:111]
 ds_read_b64_tr_b16 v[192:193], v14 offset:10304
 v_mfma_f32_16x16x32_bf16 v[72:75], v[152:155], a[112:115], v[72:75]
 ds_read_b64_tr_b16 v[194:195], v14 offset:11584
 v_mfma_f32_16x16x32_bf16 v[112:115], v[152:155], a[116:119], v[112:115]
 ds_read_b64_tr_b16 v[196:197], v15 offset:10336
 ds_read_b64_tr_b16 v[198:199], v15 offset:11616
 v_mfma_f32_16x16x32_bf16 v[76:79], v[156:159], a[112:115], v[76:79]
 ds_read_b64_tr_b16 v[200:201], v14 offset:10368
 v_mfma_f32_16x16x32_bf16 v[116:119], v[156:159], a[116:119], v[116:119]
 ds_read_b64_tr_b16 v[202:203], v14 offset:11648
 v_mfma_f32_16x16x32_bf16 v[80:83], v[160:163], a[112:115], v[80:83]
 ds_read_b64_tr_b16 v[204:205], v15 offset:10400
 v_mfma_f32_16x16x32_bf16 v[120:123], v[160:163], a[116:119], v[120:123]
 ds_read_b64_tr_b16 v[206:207], v15 offset:11680
 v_mfma_f32_16x16x32_bf16 v[84:87], v[164:167], a[112:115], v[84:87]
 ds_read_b64_tr_b16 v[208:209], v14 offset:10432
 v_mfma_f32_16x16x32_bf16 v[124:127], v[164:167], a[116:119], v[124:127]
 ds_read_b64_tr_b16 v[210:211], v14 offset:11712
 ds_read_b64_tr_b16 v[212:213], v15 offset:10464
 v_mfma_f32_16x16x32_bf16 v[88:91], v[168:171], a[112:115], v[88:91]
 ds_read_b64_tr_b16 v[214:215], v15 offset:11744
 v_mfma_f32_16x16x32_bf16 v[128:131], v[168:171], a[116:119], v[128:131]
 buffer_load_dwordx4 v[242:245], v4, s[8:11], s50 offen
 ds_read_b64_tr_b16 v[216:217], v14 offset:10496
 v_mfma_f32_16x16x32_bf16 v[92:95], v[172:175], a[112:115], v[92:95]
 ds_read_b64_tr_b16 v[218:219], v14 offset:11776
 v_mfma_f32_16x16x32_bf16 v[132:135], v[172:175], a[116:119], v[132:135]
 ds_read_b64_tr_b16 v[220:221], v15 offset:10528
 v_mfma_f32_16x16x32_bf16 v[96:99], v[176:179], a[112:115], v[96:99]
 ds_read_b64_tr_b16 v[222:223], v15 offset:11808
 v_mfma_f32_16x16x32_bf16 v[136:139], v[176:179], a[116:119], v[136:139]
 buffer_load_dword v246, v5, s[8:11], s50 offen offset:1024
 v_mfma_f32_16x16x32_bf16 v[100:103], v[180:183], a[112:115], v[100:103]
 s_add_u32 s50, s50, 1280
 v_mfma_f32_16x16x32_bf16 v[140:143], v[180:183], a[116:119], v[140:143]
 s_waitcnt lgkmcnt(0) vmcnt(18)
 s_barrier
 v_mfma_f32_16x16x32_bf16 v[64:67], v[184:187], a[120:123], v[64:67]
 ds_read_b64_tr_b16 v[144:145], v14 offset:20480
 ds_read_b64_tr_b16 v[146:147], v14 offset:21760
 v_mfma_f32_16x16x32_bf16 v[104:107], v[184:187], a[124:127], v[104:107]
 ds_read_b64_tr_b16 v[148:149], v15 offset:20512
 v_mfma_f32_16x16x32_bf16 v[68:71], v[188:191], a[120:123], v[68:71]
 ds_read_b64_tr_b16 v[150:151], v15 offset:21792
 v_mfma_f32_16x16x32_bf16 v[108:111], v[188:191], a[124:127], v[108:111]
 ds_read_b64_tr_b16 v[152:153], v14 offset:20544
 v_mfma_f32_16x16x32_bf16 v[72:75], v[192:195], a[120:123], v[72:75]
 ds_read_b64_tr_b16 v[154:155], v14 offset:21824
 v_mfma_f32_16x16x32_bf16 v[112:115], v[192:195], a[124:127], v[112:115]
 ds_read_b64_tr_b16 v[156:157], v15 offset:20576
 ds_read_b64_tr_b16 v[158:159], v15 offset:21856
 v_mfma_f32_16x16x32_bf16 v[76:79], v[196:199], a[120:123], v[76:79]
 ds_read_b64_tr_b16 v[160:161], v14 offset:20608
 v_mfma_f32_16x16x32_bf16 v[116:119], v[196:199], a[124:127], v[116:119]
 ds_read_b64_tr_b16 v[162:163], v14 offset:21888
 v_mfma_f32_16x16x32_bf16 v[80:83], v[200:203], a[120:123], v[80:83]
 ds_read_b64_tr_b16 v[164:165], v15 offset:20640
 v_mfma_f32_16x16x32_bf16 v[120:123], v[200:203], a[124:127], v[120:123]
 ds_read_b64_tr_b16 v[166:167], v15 offset:21920
 v_mfma_f32_16x16x32_bf16 v[84:87], v[204:207], a[120:123], v[84:87]
 ds_read_b64_tr_b16 v[168:169], v14 offset:20672
 v_mfma_f32_16x16x32_bf16 v[124:127], v[204:207], a[124:127], v[124:127]
 ds_read_b64_tr_b16 v[170:171], v14 offset:21952
 ds_read_b64_tr_b16 v[172:173], v15 offset:20704
 v_mfma_f32_16x16x32_bf16 v[88:91], v[208:211], a[120:123], v[88:91]
 ds_read_b64_tr_b16 v[174:175], v15 offset:21984
 v_mfma_f32_16x16x32_bf16 v[128:131], v[208:211], a[124:127], v[128:131]
 buffer_load_dwordx4 v[248:251], v4, s[8:11], s50 offen
 ds_read_b64_tr_b16 v[176:177], v14 offset:20736
 v_mfma_f32_16x16x32_bf16 v[92:95], v[212:215], a[120:123], v[92:95]
 ds_read_b64_tr_b16 v[178:179], v14 offset:22016
 v_mfma_f32_16x16x32_bf16 v[132:135], v[212:215], a[124:127], v[132:135]
 ds_read_b64_tr_b16 v[180:181], v15 offset:20768
 v_mfma_f32_16x16x32_bf16 v[96:99], v[216:219], a[120:123], v[96:99]
 ds_read_b64_tr_b16 v[182:183], v15 offset:22048
 v_mfma_f32_16x16x32_bf16 v[136:139], v[216:219], a[124:127], v[136:139]
 buffer_load_dword v252, v5, s[8:11], s50 offen offset:1024
 v_mfma_f32_16x16x32_bf16 v[100:103], v[220:223], a[120:123], v[100:103]
 s_add_u32 s50, s50, 1280
 v_mfma_f32_16x16x32_bf16 v[140:143], v[220:223], a[124:127], v[140:143]
 s_waitcnt lgkmcnt(0) vmcnt(18)
 v_mfma_f32_16x16x32_bf16 v[64:67], v[144:147], a[128:131], v[64:67]
 ds_read_b64_tr_b16 v[184:185], v14 offset:30720
 ds_read_b64_tr_b16 v[186:187], v14 offset:32000
 v_mfma_f32_16x16x32_bf16 v[104:107], v[144:147], a[132:135], v[104:107]
 ds_read_b64_tr_b16 v[188:189], v15 offset:30752
 v_mfma_f32_16x16x32_bf16 v[68:71], v[148:151], a[128:131], v[68:71]
 ds_read_b64_tr_b16 v[190:191], v15 offset:32032
 v_mfma_f32_16x16x32_bf16 v[108:111], v[148:151], a[132:135], v[108:111]
 ds_read_b64_tr_b16 v[192:193], v14 offset:30784
 v_mfma_f32_16x16x32_bf16 v[72:75], v[152:155], a[128:131], v[72:75]
 ds_read_b64_tr_b16 v[194:195], v14 offset:32064
 v_mfma_f32_16x16x32_bf16 v[112:115], v[152:155], a[132:135], v[112:115]
 ds_read_b64_tr_b16 v[196:197], v15 offset:30816
 ds_read_b64_tr_b16 v[198:199], v15 offset:32096
 v_mfma_f32_16x16x32_bf16 v[76:79], v[156:159], a[128:131], v[76:79]
 ds_read_b64_tr_b16 v[200:201], v14 offset:30848
 v_mfma_f32_16x16x32_bf16 v[116:119], v[156:159], a[132:135], v[116:119]
 ds_read_b64_tr_b16 v[202:203], v14 offset:32128
 v_mfma_f32_16x16x32_bf16 v[80:83], v[160:163], a[128:131], v[80:83]
 ds_read_b64_tr_b16 v[204:205], v15 offset:30880
 v_mfma_f32_16x16x32_bf16 v[120:123], v[160:163], a[132:135], v[120:123]
 ds_read_b64_tr_b16 v[206:207], v15 offset:32160
 v_mfma_f32_16x16x32_bf16 v[84:87], v[164:167], a[128:131], v[84:87]
 ds_read_b64_tr_b16 v[208:209], v14 offset:30912
 v_mfma_f32_16x16x32_bf16 v[124:127], v[164:167], a[132:135], v[124:127]
 ds_read_b64_tr_b16 v[210:211], v14 offset:32192
 ds_read_b64_tr_b16 v[212:213], v15 offset:30944
 v_mfma_f32_16x16x32_bf16 v[88:91], v[168:171], a[128:131], v[88:91]
 ds_read_b64_tr_b16 v[214:215], v15 offset:32224
 v_mfma_f32_16x16x32_bf16 v[128:131], v[168:171], a[132:135], v[128:131]
 buffer_load_dwordx4 v[30:33], v4, s[8:11], s50 offen
 ds_read_b64_tr_b16 v[216:217], v14 offset:30976
 v_mfma_f32_16x16x32_bf16 v[92:95], v[172:175], a[128:131], v[92:95]
 ds_read_b64_tr_b16 v[218:219], v14 offset:32256
 v_mfma_f32_16x16x32_bf16 v[132:135], v[172:175], a[132:135], v[132:135]
 ds_read_b64_tr_b16 v[220:221], v15 offset:31008
 v_mfma_f32_16x16x32_bf16 v[96:99], v[176:179], a[128:131], v[96:99]
 ds_read_b64_tr_b16 v[222:223], v15 offset:32288
 v_mfma_f32_16x16x32_bf16 v[136:139], v[176:179], a[132:135], v[136:139]
 buffer_load_dword v34, v5, s[8:11], s50 offen offset:1024
 v_mfma_f32_16x16x32_bf16 v[100:103], v[180:183], a[128:131], v[100:103]
 s_add_u32 s50, s50, 1280
 v_mfma_f32_16x16x32_bf16 v[140:143], v[180:183], a[132:135], v[140:143]
 s_waitcnt lgkmcnt(0) vmcnt(18)
 s_barrier
 v_mfma_f32_16x16x32_bf16 v[64:67], v[184:187], a[136:139], v[64:67]
 ds_read_b64_tr_b16 v[144:145], v14 offset:40960
 ds_read_b64_tr_b16 v[146:147], v14 offset:42240
 v_mfma_f32_16x16x32_bf16 v[104:107], v[184:187], a[140:143], v[104:107]
 ds_read_b64_tr_b16 v[148:149], v15 offset:40992
 v_mfma_f32_16x16x32_bf16 v[68:71], v[188:191], a[136:139], v[68:71]
 ds_read_b64_tr_b16 v[150:151], v15 offset:42272
 v_mfma_f32_16x16x32_bf16 v[108:111], v[188:191], a[140:143], v[108:111]
 ds_read_b64_tr_b16 v[152:153], v14 offset:41024
 v_mfma_f32_16x16x32_bf16 v[72:75], v[192:195], a[136:139], v[72:75]
 ds_read_b64_tr_b16 v[154:155], v14 offset:42304
 v_mfma_f32_16x16x32_bf16 v[112:115], v[192:195], a[140:143], v[112:115]
 ds_read_b64_tr_b16 v[156:157], v15 offset:41056
 ds_read_b64_tr_b16 v[158:159], v15 offset:42336
 v_mfma_f32_16x16x32_bf16 v[76:79], v[196:199], a[136:139], v[76:79]
 ds_read_b64_tr_b16 v[160:161], v14 offset:41088
 v_mfma_f32_16x16x32_bf16 v[116:119], v[196:199], a[140:143], v[116:119]
 ds_read_b64_tr_b16 v[162:163], v14 offset:42368
 v_mfma_f32_16x16x32_bf16 v[80:83], v[200:203], a[136:139], v[80:83]
 ds_read_b64_tr_b16 v[164:165], v15 offset:41120
 v_mfma_f32_16x16x32_bf16 v[120:123], v[200:203], a[140:143], v[120:123]
 ds_read_b64_tr_b16 v[166:167], v15 offset:42400
 v_mfma_f32_16x16x32_bf16 v[84:87], v[204:207], a[136:139], v[84:87]
 ds_read_b64_tr_b16 v[168:169], v14 offset:41152
 v_mfma_f32_16x16x32_bf16 v[124:127], v[204:207], a[140:143], v[124:127]
 ds_read_b64_tr_b16 v[170:171], v14 offset:42432
 ds_read_b64_tr_b16 v[172:173], v15 offset:41184
 v_mfma_f32_16x16x32_bf16 v[88:91], v[208:211], a[136:139], v[88:91]
 ds_read_b64_tr_b16 v[174:175], v15 offset:42464
 v_mfma_f32_16x16x32_bf16 v[128:131], v[208:211], a[140:143], v[128:131]
 buffer_load_dwordx4 v[36:39], v4, s[8:11], s50 offen
 ds_read_b64_tr_b16 v[176:177], v14 offset:41216
 v_mfma_f32_16x16x32_bf16 v[92:95], v[212:215], a[136:139], v[92:95]
 ds_read_b64_tr_b16 v[178:179], v14 offset:42496
 v_mfma_f32_16x16x32_bf16 v[132:135], v[212:215], a[140:143], v[132:135]
 ds_read_b64_tr_b16 v[180:181], v15 offset:41248
 v_mfma_f32_16x16x32_bf16 v[96:99], v[216:219], a[136:139], v[96:99]
 ds_read_b64_tr_b16 v[182:183], v15 offset:42528
 v_mfma_f32_16x16x32_bf16 v[136:139], v[216:219], a[140:143], v[136:139]
 buffer_load_dword v40, v5, s[8:11], s50 offen offset:1024
 v_mfma_f32_16x16x32_bf16 v[100:103], v[220:223], a[136:139], v[100:103]
 s_add_u32 s50, s50, 1280
 v_mfma_f32_16x16x32_bf16 v[140:143], v[220:223], a[140:143], v[140:143]
 s_waitcnt lgkmcnt(0) vmcnt(18)
 v_mfma_f32_16x16x32_bf16 v[64:67], v[144:147], a[144:147], v[64:67]
 ds_read_b64_tr_b16 v[184:185], v14 offset:51200
 ds_read_b64_tr_b16 v[186:187], v14 offset:52480
 v_mfma_f32_16x16x32_bf16 v[104:107], v[144:147], a[148:151], v[104:107]
 ds_read_b64_tr_b16 v[188:189], v15 offset:51232
 v_mfma_f32_16x16x32_bf16 v[68:71], v[148:151], a[144:147], v[68:71]
 ds_read_b64_tr_b16 v[190:191], v15 offset:52512
 v_mfma_f32_16x16x32_bf16 v[108:111], v[148:151], a[148:151], v[108:111]
 ds_read_b64_tr_b16 v[192:193], v14 offset:51264
 v_mfma_f32_16x16x32_bf16 v[72:75], v[152:155], a[144:147], v[72:75]
 ds_read_b64_tr_b16 v[194:195], v14 offset:52544
 v_mfma_f32_16x16x32_bf16 v[112:115], v[152:155], a[148:151], v[112:115]
 ds_read_b64_tr_b16 v[196:197], v15 offset:51296
 ds_read_b64_tr_b16 v[198:199], v15 offset:52576
 v_mfma_f32_16x16x32_bf16 v[76:79], v[156:159], a[144:147], v[76:79]
 ds_read_b64_tr_b16 v[200:201], v14 offset:51328
 v_mfma_f32_16x16x32_bf16 v[116:119], v[156:159], a[148:151], v[116:119]
 ds_read_b64_tr_b16 v[202:203], v14 offset:52608
 v_mfma_f32_16x16x32_bf16 v[80:83], v[160:163], a[144:147], v[80:83]
 ds_read_b64_tr_b16 v[204:205], v15 offset:51360
 v_mfma_f32_16x16x32_bf16 v[120:123], v[160:163], a[148:151], v[120:123]
 ds_read_b64_tr_b16 v[206:207], v15 offset:52640
 v_mfma_f32_16x16x32_bf16 v[84:87], v[164:167], a[144:147], v[84:87]
 ds_read_b64_tr_b16 v[208:209], v14 offset:51392
 v_mfma_f32_16x16x32_bf16 v[124:127], v[164:167], a[148:151], v[124:127]
 ds_read_b64_tr_b16 v[210:211], v14 offset:52672
 ds_read_b64_tr_b16 v[212:213], v15 offset:51424
 v_mfma_f32_16x16x32_bf16 v[88:91], v[168:171], a[144:147], v[88:91]
 ds_read_b64_tr_b16 v[214:215], v15 offset:52704
 v_mfma_f32_16x16x32_bf16 v[128:131], v[168:171], a[148:151], v[128:131]
 buffer_load_dwordx4 v[42:45], v4, s[8:11], s50 offen
 ds_read_b64_tr_b16 v[216:217], v14 offset:51456
 v_mfma_f32_16x16x32_bf16 v[92:95], v[172:175], a[144:147], v[92:95]
 ds_read_b64_tr_b16 v[218:219], v14 offset:52736
 v_mfma_f32_16x16x32_bf16 v[132:135], v[172:175], a[148:151], v[132:135]
 ds_read_b64_tr_b16 v[220:221], v15 offset:51488
 v_mfma_f32_16x16x32_bf16 v[96:99], v[176:179], a[144:147], v[96:99]
 ds_read_b64_tr_b16 v[222:223], v15 offset:52768
 v_mfma_f32_16x16x32_bf16 v[136:139], v[176:179], a[148:151], v[136:139]
 buffer_load_dword v46, v5, s[8:11], s50 offen offset:1024
 v_mfma_f32_16x16x32_bf16 v[100:103], v[180:183], a[144:147], v[100:103]
 s_add_u32 s50, s50, 1280
 v_mfma_f32_16x16x32_bf16 v[140:143], v[180:183], a[148:151], v[140:143]
 s_waitcnt lgkmcnt(0) vmcnt(18)
 v_mfma_f32_16x16x32_bf16 v[64:67], v[184:187], a[152:155], v[64:67]
 v_mfma_f32_16x16x32_bf16 v[104:107], v[184:187], a[156:159], v[104:107]
 v_mfma_f32_16x16x32_bf16 v[68:71], v[188:191], a[152:155], v[68:71]
 v_mfma_f32_16x16x32_bf16 v[108:111], v[188:191], a[156:159], v[108:111]
 v_mfma_f32_16x16x32_bf16 v[72:75], v[192:195], a[152:155], v[72:75]
 v_mfma_f32_16x16x32_bf16 v[112:115], v[192:195], a[156:159], v[112:115]
 v_mfma_f32_16x16x32_bf16 v[76:79], v[196:199], a[152:155], v[76:79]
 v_mfma_f32_16x16x32_bf16 v[116:119], v[196:199], a[156:159], v[116:119]
 v_mfma_f32_16x16x32_bf16 v[80:83], v[200:203], a[152:155], v[80:83]
 v_mfma_f32_16x16x32_bf16 v[120:123], v[200:203], a[156:159], v[120:123]
 v_mfma_f32_16x16x32_bf16 v[84:87], v[204:207], a[152:155], v[84:87]
 v_mfma_f32_16x16x32_bf16 v[124:127], v[204:207], a[156:159], v[124:127]
 v_mfma_f32_16x16x32_bf16 v[88:91], v[208:211], a[152:155], v[88:91]
 v_mfma_f32_16x16x32_bf16 v[128:131], v[208:211], a[156:159], v[128:131]
 v_mfma_f32_16x16x32_bf16 v[92:95], v[212:215], a[152:155], v[92:95]
 v_mfma_f32_16x16x32_bf16 v[132:135], v[212:215], a[156:159], v[132:135]
 v_mfma_f32_16x16x32_bf16 v[96:99], v[216:219], a[152:155], v[96:99]
 v_mfma_f32_16x16x32_bf16 v[136:139], v[216:219], a[156:159], v[136:139]
 v_mfma_f32_16x16x32_bf16 v[100:103], v[220:223], a[152:155], v[100:103]
 v_mfma_f32_16x16x32_bf16 v[140:143], v[220:223], a[156:159], v[140:143]
 s_add_u32 s16, s38, 180355072
 s_addc_u32 s17, s39, 0
 s_mov_b32 s18, 67108864
 s_mov_b32 s19, 0x00020000
 s_nop 3
 s_lshr_b32 s22, s47, 1
 s_lshl_b32 s21, s22, 12
 s_and_b32 s21, s21, 8192
 s_xor_b32 s21, s21, s37
 s_lshl_b32 s51, s22, 20
 s_or_b32 s51, s51, s21
 s_add_u32 s51, s51, 786432
 s_mul_i32 s53, s44, 5
 s_cmp_lt_u32 s2, 32
 s_cbranch_scc1 om_243
 s_add_u32 s21, s53, 0
 s_lshr_b32 s22, s21, 1
 s_lshl_b32 s22, s22, 14
 s_and_b32 s21, s21, 1
 s_lshl_b32 s21, s21, 11
 s_add_u32 s22, s22, s21
 s_add_u32 s22, s22, s51
 buffer_store_dwordx4 v[64:67], v4, s[16:19], s22 offen offset:0 sc1
 buffer_store_dwordx4 v[68:71], v4, s[16:19], s22 offen offset:1024 sc1
 s_add_u32 s21, s53, 1
 s_lshr_b32 s22, s21, 1
 s_lshl_b32 s22, s22, 14
 s_and_b32 s21, s21, 1
 s_lshl_b32 s21, s21, 11
 s_add_u32 s22, s22, s21
 s_add_u32 s22, s22, s51
 buffer_store_dwordx4 v[72:75], v4, s[16:19], s22 offen offset:0 sc1
 buffer_store_dwordx4 v[76:79], v4, s[16:19], s22 offen offset:1024 sc1
 s_add_u32 s21, s53, 2
 s_lshr_b32 s22, s21, 1
 s_lshl_b32 s22, s22, 14
 s_and_b32 s21, s21, 1
 s_lshl_b32 s21, s21, 11
 s_add_u32 s22, s22, s21
 s_add_u32 s22, s22, s51
 buffer_store_dwordx4 v[80:83], v4, s[16:19], s22 offen offset:0 sc1
 buffer_store_dwordx4 v[84:87], v4, s[16:19], s22 offen offset:1024 sc1
 s_add_u32 s21, s53, 3
 s_lshr_b32 s22, s21, 1
 s_lshl_b32 s22, s22, 14
 s_and_b32 s21, s21, 1
 s_lshl_b32 s21, s21, 11
 s_add_u32 s22, s22, s21
 s_add_u32 s22, s22, s51
 buffer_store_dwordx4 v[88:91], v4, s[16:19], s22 offen offset:0 sc1
 buffer_store_dwordx4 v[92:95], v4, s[16:19], s22 offen offset:1024 sc1
 s_add_u32 s21, s53, 4
 s_lshr_b32 s22, s21, 1
 s_lshl_b32 s22, s22, 14
 s_and_b32 s21, s21, 1
 s_lshl_b32 s21, s21, 11
 s_add_u32 s22, s22, s21
 s_add_u32 s22, s22, s51
 buffer_store_dwordx4 v[96:99], v4, s[16:19], s22 offen offset:0 sc1
 buffer_store_dwordx4 v[100:103], v4, s[16:19], s22 offen offset:1024 sc1
 s_add_u32 s21, s53, 0
 s_lshr_b32 s22, s21, 1
 s_lshl_b32 s22, s22, 14
 s_and_b32 s21, s21, 1
 s_lshl_b32 s21, s21, 11
 s_add_u32 s22, s22, s21
 s_add_u32 s22, s22, s51
 s_add_u32 s22, s22, 4096
 buffer_store_dwordx4 v[104:107], v4, s[16:19], s22 offen offset:0 sc1
 buffer_store_dwordx4 v[108:111], v4, s[16:19], s22 offen offset:1024 sc1
 s_add_u32 s21, s53, 1
 s_lshr_b32 s22, s21, 1
 s_lshl_b32 s22, s22, 14
 s_and_b32 s21, s21, 1
 s_lshl_b32 s21, s21, 11
 s_add_u32 s22, s22, s21
 s_add_u32 s22, s22, s51
 s_add_u32 s22, s22, 4096
 buffer_store_dwordx4 v[112:115], v4, s[16:19], s22 offen offset:0 sc1
 buffer_store_dwordx4 v[116:119], v4, s[16:19], s22 offen offset:1024 sc1
 s_add_u32 s21, s53, 2
 s_lshr_b32 s22, s21, 1
 s_lshl_b32 s22, s22, 14
 s_and_b32 s21, s21, 1
 s_lshl_b32 s21, s21, 11
 s_add_u32 s22, s22, s21
 s_add_u32 s22, s22, s51
 s_add_u32 s22, s22, 4096
 buffer_store_dwordx4 v[120:123], v4, s[16:19], s22 offen offset:0 sc1
 buffer_store_dwordx4 v[124:127], v4, s[16:19], s22 offen offset:1024 sc1
 s_add_u32 s21, s53, 3
 s_lshr_b32 s22, s21, 1
 s_lshl_b32 s22, s22, 14
 s_and_b32 s21, s21, 1
 s_lshl_b32 s21, s21, 11
 s_add_u32 s22, s22, s21
 s_add_u32 s22, s22, s51
 s_add_u32 s22, s22, 4096
 buffer_store_dwordx4 v[128:131], v4, s[16:19], s22 offen offset:0 sc1
 buffer_store_dwordx4 v[132:135], v4, s[16:19], s22 offen offset:1024 sc1
 s_add_u32 s21, s53, 4
 s_lshr_b32 s22, s21, 1
 s_lshl_b32 s22, s22, 14
 s_and_b32 s21, s21, 1
 s_lshl_b32 s21, s21, 11
 s_add_u32 s22, s22, s21
 s_add_u32 s22, s22, s51
 s_add_u32 s22, s22, 4096
 buffer_store_dwordx4 v[136:139], v4, s[16:19], s22 offen offset:0 sc1
 buffer_store_dwordx4 v[140:143], v4, s[16:19], s22 offen offset:1024 sc1
 s_sub_u32 s50, s50, 1320960
 buffer_load_dwordx4 v[160:163], v4, s[8:11], s50 offen
 buffer_load_dword v164, v5, s[8:11], s50 offen offset:1024
 s_add_u32 s50, s50, 1280
 buffer_load_dwordx4 v[166:169], v4, s[8:11], s50 offen
 buffer_load_dword v170, v5, s[8:11], s50 offen offset:1024
 s_add_u32 s50, s50, 1280
 buffer_load_dwordx4 v[172:175], v4, s[8:11], s50 offen
 buffer_load_dword v176, v5, s[8:11], s50 offen offset:1024
 s_add_u32 s50, s50, 1280
 buffer_load_dwordx4 v[178:181], v4, s[8:11], s50 offen
 buffer_load_dword v182, v5, s[8:11], s50 offen offset:1024
 s_add_u32 s50, s50, 1280
 buffer_load_dwordx4 v[184:187], v4, s[8:11], s50 offen
 buffer_load_dword v188, v5, s[8:11], s50 offen offset:1024
 s_add_u32 s50, s50, 1280
 buffer_load_dwordx4 v[190:193], v4, s[8:11], s50 offen
 buffer_load_dword v194, v5, s[8:11], s50 offen offset:1024
 s_add_u32 s50, s50, 1280
 buffer_load_dwordx4 v[196:199], v4, s[8:11], s50 offen
 buffer_load_dword v200, v5, s[8:11], s50 offen offset:1024
 s_add_u32 s50, s50, 1280
 buffer_load_dwordx4 v[202:205], v4, s[8:11], s50 offen
 buffer_load_dword v206, v5, s[8:11], s50 offen offset:1024
 s_add_u32 s50, s50, 1280
 s_waitcnt vmcnt(36)
 v_lshlrev_b32 v57, 16, v52
 v_and_b32 v52, 0xffff0000, v52
 v_lshlrev_b32 v58, 16, v53
 v_and_b32 v53, 0xffff0000, v53
 v_lshlrev_b32 v59, 16, v54
 v_and_b32 v54, 0xffff0000, v54
 v_lshlrev_b32 v60, 16, v55
 v_and_b32 v55, 0xffff0000, v55
 v_lshlrev_b32 v61, 16, v56
 v_and_b32 v56, 0xffff0000, v56
 v_lshlrev_b32 v25, 16, v224
 v_and_b32 v26, 0xffff0000, v224
 v_mul_f32 v25, v25, v57
 v_mul_f32 v26, v26, v52
 v_cvt_pk_bf16_f32 v25, v25, v26
 v_lshlrev_b32 v26, 16, v25
 v_and_b32 v25, 0xffff0000, v25
 v_add_f32 v144, v25, v26
 v_lshlrev_b32 v25, 16, v225
 v_and_b32 v26, 0xffff0000, v225
 v_mul_f32 v25, v25, v58
 v_mul_f32 v26, v26, v53
 v_cvt_pk_bf16_f32 v25, v25, v26
 v_lshlrev_b32 v26, 16, v25
 v_and_b32 v25, 0xffff0000, v25
 v_add_f32 v144, v144, v26
 v_add_f32 v144, v144, v25
 v_lshlrev_b32 v25, 16, v226
 v_and_b32 v26, 0xffff0000, v226
 v_mul_f32 v25, v25, v59
 v_mul_f32 v26, v26, v54
 v_cvt_pk_bf16_f32 v25, v25, v26
 v_lshlrev_b32 v26, 16, v25
 v_and_b32 v25, 0xffff0000, v25
 v_add_f32 v144, v144, v26
 v_add_f32 v144, v144, v25
 v_lshlrev_b32 v25, 16, v227
 v_and_b32 v26, 0xffff0000, v227
 v_mul_f32 v25, v25, v60
 v_mul_f32 v26, v26, v55
 v_cvt_pk_bf16_f32 v25, v25, v26
 v_lshlrev_b32 v26, 16, v25
 v_and_b32 v25, 0xffff0000, v25
 v_add_f32 v144, v144, v26
 v_add_f32 v144, v144, v25
 v_lshlrev_b32 v25, 16, v228
 v_and_b32 v26, 0xffff0000, v228
 v_mul_f32 v25, v25, v61
 v_mul_f32 v26, v26, v56
 v_cvt_pk_bf16_f32 v25, v25, v26
 v_lshlrev_b32 v26, 16, v25
 v_and_b32 v25, 0xffff0000, v25
 v_add_f32 v144, v144, v26
 v_add_f32 v144, v144, v25
 v_lshlrev_b32 v25, 16, v230
 v_and_b32 v26, 0xffff0000, v230
 v_mul_f32 v25, v25, v57
 v_mul_f32 v26, v26, v52
 v_cvt_pk_bf16_f32 v25, v25, v26
 v_lshlrev_b32 v26, 16, v25
 v_and_b32 v25, 0xffff0000, v25
 v_add_f32 v145, v25, v26
 v_lshlrev_b32 v25, 16, v231
 v_and_b32 v26, 0xffff0000, v231
 v_mul_f32 v25, v25, v58
 v_mul_f32 v26, v26, v53
 v_cvt_pk_bf16_f32 v25, v25, v26
 v_lshlrev_b32 v26, 16, v25
 v_and_b32 v25, 0xffff0000, v25
 v_add_f32 v145, v145, v26
 v_add_f32 v145, v145, v25
 v_lshlrev_b32 v25, 16, v232
 v_and_b32 v26, 0xffff0000, v232
 v_mul_f32 v25, v25, v59
 v_mul_f32 v26, v26, v54
 v_cvt_pk_bf16_f32 v25, v25, v26
 v_lshlrev_b32 v26, 16, v25
 v_and_b32 v25, 0xffff0000, v25
 v_add_f32 v145, v145, v26
 v_add_f32 v145, v145, v25
 v_lshlrev_b32 v25, 16, v233
 v_and_b32 v26, 0xffff0000, v233
 v_mul_f32 v25, v25, v60
 v_mul_f32 v26, v26, v55
 v_cvt_pk_bf16_f32 v25, v25, v26
 v_lshlrev_b32 v26, 16, v25
 v_and_b32 v25, 0xffff0000, v25
 v_add_f32 v145, v145, v26
 v_add_f32 v145, v145, v25
 v_lshlrev_b32 v25, 16, v234
 v_and_b32 v26, 0xffff0000, v234
 v_mul_f32 v25, v25, v61
 v_mul_f32 v26, v26, v56
 v_cvt_pk_bf16_f32 v25, v25, v26
 v_lshlrev_b32 v26, 16, v25
 v_and_b32 v25, 0xffff0000, v25
 v_add_f32 v145, v145, v26
 v_add_f32 v145, v145, v25
 v_lshlrev_b32 v25, 16, v236
 v_and_b32 v26, 0xffff0000, v236
 v_mul_f32 v25, v25, v57
 v_mul_f32 v26, v26, v52
 v_cvt_pk_bf16_f32 v25, v25, v26
 v_lshlrev_b32 v26, 16, v25
 v_and_b32 v25, 0xffff0000, v25
 v_add_f32 v146, v25, v26
 v_lshlrev_b32 v25, 16, v237
 v_and_b32 v26, 0xffff0000, v237
 v_mul_f32 v25, v25, v58
 v_mul_f32 v26, v26, v53
 v_cvt_pk_bf16_f32 v25, v25, v26
 v_lshlrev_b32 v26, 16, v25
 v_and_b32 v25, 0xffff0000, v25
 v_add_f32 v146, v146, v26
 v_add_f32 v146, v146, v25
 v_lshlrev_b32 v25, 16, v238
 v_and_b32 v26, 0xffff0000, v238
 v_mul_f32 v25, v25, v59
 v_mul_f32 v26, v26, v54
 v_cvt_pk_bf16_f32 v25, v25, v26
 v_lshlrev_b32 v26, 16, v25
 v_and_b32 v25, 0xffff0000, v25
 v_add_f32 v146, v146, v26
 v_add_f32 v146, v146, v25
 v_lshlrev_b32 v25, 16, v239
 v_and_b32 v26, 0xffff0000, v239
 v_mul_f32 v25, v25, v60
 v_mul_f32 v26, v26, v55
 v_cvt_pk_bf16_f32 v25, v25, v26
 v_lshlrev_b32 v26, 16, v25
 v_and_b32 v25, 0xffff0000, v25
 v_add_f32 v146, v146, v26
 v_add_f32 v146, v146, v25
 v_lshlrev_b32 v25, 16, v240
 v_and_b32 v26, 0xffff0000, v240
 v_mul_f32 v25, v25, v61
 v_mul_f32 v26, v26, v56
 v_cvt_pk_bf16_f32 v25, v25, v26
 v_lshlrev_b32 v26, 16, v25
 v_and_b32 v25, 0xffff0000, v25
 v_add_f32 v146, v146, v26
 v_add_f32 v146, v146, v25
 v_lshlrev_b32 v25, 16, v242
 v_and_b32 v26, 0xffff0000, v242
 v_mul_f32 v25, v25, v57
 v_mul_f32 v26, v26, v52
 v_cvt_pk_bf16_f32 v25, v25, v26
 v_lshlrev_b32 v26, 16, v25
 v_and_b32 v25, 0xffff0000, v25
 v_add_f32 v147, v25, v26
 v_lshlrev_b32 v25, 16, v243
 v_and_b32 v26, 0xffff0000, v243
 v_mul_f32 v25, v25, v58
 v_mul_f32 v26, v26, v53
 v_cvt_pk_bf16_f32 v25, v25, v26
 v_lshlrev_b32 v26, 16, v25
 v_and_b32 v25, 0xffff0000, v25
 v_add_f32 v147, v147, v26
 v_add_f32 v147, v147, v25
 v_lshlrev_b32 v25, 16, v244
 v_and_b32 v26, 0xffff0000, v244
 v_mul_f32 v25, v25, v59
 v_mul_f32 v26, v26, v54
 v_cvt_pk_bf16_f32 v25, v25, v26
 v_lshlrev_b32 v26, 16, v25
 v_and_b32 v25, 0xffff0000, v25
 v_add_f32 v147, v147, v26
 v_add_f32 v147, v147, v25
 v_lshlrev_b32 v25, 16, v245
 v_and_b32 v26, 0xffff0000, v245
 v_mul_f32 v25, v25, v60
 v_mul_f32 v26, v26, v55
 v_cvt_pk_bf16_f32 v25, v25, v26
 v_lshlrev_b32 v26, 16, v25
 v_and_b32 v25, 0xffff0000, v25
 v_add_f32 v147, v147, v26
 v_add_f32 v147, v147, v25
 v_lshlrev_b32 v25, 16, v246
 v_and_b32 v26, 0xffff0000, v246
 v_mul_f32 v25, v25, v61
 v_mul_f32 v26, v26, v56
 v_cvt_pk_bf16_f32 v25, v25, v26
 v_lshlrev_b32 v26, 16, v25
 v_and_b32 v25, 0xffff0000, v25
 v_add_f32 v147, v147, v26
 v_add_f32 v147, v147, v25
 v_lshlrev_b32 v25, 16, v248
 v_and_b32 v26, 0xffff0000, v248
 v_mul_f32 v25, v25, v57
 v_mul_f32 v26, v26, v52
 v_cvt_pk_bf16_f32 v25, v25, v26
 v_lshlrev_b32 v26, 16, v25
 v_and_b32 v25, 0xffff0000, v25
 v_add_f32 v148, v25, v26
 v_lshlrev_b32 v25, 16, v249
 v_and_b32 v26, 0xffff0000, v249
 v_mul_f32 v25, v25, v58
 v_mul_f32 v26, v26, v53
 v_cvt_pk_bf16_f32 v25, v25, v26
 v_lshlrev_b32 v26, 16, v25
 v_and_b32 v25, 0xffff0000, v25
 v_add_f32 v148, v148, v26
 v_add_f32 v148, v148, v25
 v_lshlrev_b32 v25, 16, v250
 v_and_b32 v26, 0xffff0000, v250
 v_mul_f32 v25, v25, v59
 v_mul_f32 v26, v26, v54
 v_cvt_pk_bf16_f32 v25, v25, v26
 v_lshlrev_b32 v26, 16, v25
 v_and_b32 v25, 0xffff0000, v25
 v_add_f32 v148, v148, v26
 v_add_f32 v148, v148, v25
 v_lshlrev_b32 v25, 16, v251
 v_and_b32 v26, 0xffff0000, v251
 v_mul_f32 v25, v25, v60
 v_mul_f32 v26, v26, v55
 v_cvt_pk_bf16_f32 v25, v25, v26
 v_lshlrev_b32 v26, 16, v25
 v_and_b32 v25, 0xffff0000, v25
 v_add_f32 v148, v148, v26
 v_add_f32 v148, v148, v25
 v_lshlrev_b32 v25, 16, v252
 v_and_b32 v26, 0xffff0000, v252
 v_mul_f32 v25, v25, v61
 v_mul_f32 v26, v26, v56
 v_cvt_pk_bf16_f32 v25, v25, v26
 v_lshlrev_b32 v26, 16, v25
 v_and_b32 v25, 0xffff0000, v25
 v_add_f32 v148, v148, v26
 v_add_f32 v148, v148, v25
 v_lshlrev_b32 v25, 16, v30
 v_and_b32 v26, 0xffff0000, v30
 v_mul_f32 v25, v25, v57
 v_mul_f32 v26, v26, v52
 v_cvt_pk_bf16_f32 v25, v25, v26
 v_lshlrev_b32 v26, 16, v25
 v_and_b32 v25, 0xffff0000, v25
 v_add_f32 v149, v25, v26
 v_lshlrev_b32 v25, 16, v31
 v_and_b32 v26, 0xffff0000, v31
 v_mul_f32 v25, v25, v58
 v_mul_f32 v26, v26, v53
 v_cvt_pk_bf16_f32 v25, v25, v26
 v_lshlrev_b32 v26, 16, v25
 v_and_b32 v25, 0xffff0000, v25
 v_add_f32 v149, v149, v26
 v_add_f32 v149, v149, v25
 v_lshlrev_b32 v25, 16, v32
 v_and_b32 v26, 0xffff0000, v32
 v_mul_f32 v25, v25, v59
 v_mul_f32 v26, v26, v54
 v_cvt_pk_bf16_f32 v25, v25, v26
 v_lshlrev_b32 v26, 16, v25
 v_and_b32 v25, 0xffff0000, v25
 v_add_f32 v149, v149, v26
 v_add_f32 v149, v149, v25
 v_lshlrev_b32 v25, 16, v33
 v_and_b32 v26, 0xffff0000, v33
 v_mul_f32 v25, v25, v60
 v_mul_f32 v26, v26, v55
 v_cvt_pk_bf16_f32 v25, v25, v26
 v_lshlrev_b32 v26, 16, v25
 v_and_b32 v25, 0xffff0000, v25
 v_add_f32 v149, v149, v26
 v_add_f32 v149, v149, v25
 v_lshlrev_b32 v25, 16, v34
 v_and_b32 v26, 0xffff0000, v34
 v_mul_f32 v25, v25, v61
 v_mul_f32 v26, v26, v56
 v_cvt_pk_bf16_f32 v25, v25, v26
 v_lshlrev_b32 v26, 16, v25
 v_and_b32 v25, 0xffff0000, v25
 v_add_f32 v149, v149, v26
 v_add_f32 v149, v149, v25
 v_lshlrev_b32 v25, 16, v36
 v_and_b32 v26, 0xffff0000, v36
 v_mul_f32 v25, v25, v57
 v_mul_f32 v26, v26, v52
 v_cvt_pk_bf16_f32 v25, v25, v26
 v_lshlrev_b32 v26, 16, v25
 v_and_b32 v25, 0xffff0000, v25
 v_add_f32 v150, v25, v26
 v_lshlrev_b32 v25, 16, v37
 v_and_b32 v26, 0xffff0000, v37
 v_mul_f32 v25, v25, v58
 v_mul_f32 v26, v26, v53
 v_cvt_pk_bf16_f32 v25, v25, v26
 v_lshlrev_b32 v26, 16, v25
 v_and_b32 v25, 0xffff0000, v25
 v_add_f32 v150, v150, v26
 v_add_f32 v150, v150, v25
 v_lshlrev_b32 v25, 16, v38
 v_and_b32 v26, 0xffff0000, v38
 v_mul_f32 v25, v25, v59
 v_mul_f32 v26, v26, v54
 v_cvt_pk_bf16_f32 v25, v25, v26
 v_lshlrev_b32 v26, 16, v25
 v_and_b32 v25, 0xffff0000, v25
 v_add_f32 v150, v150, v26
 v_add_f32 v150, v150, v25
 v_lshlrev_b32 v25, 16, v39
 v_and_b32 v26, 0xffff0000, v39
 v_mul_f32 v25, v25, v60
 v_mul_f32 v26, v26, v55
 v_cvt_pk_bf16_f32 v25, v25, v26
 v_lshlrev_b32 v26, 16, v25
 v_and_b32 v25, 0xffff0000, v25
 v_add_f32 v150, v150, v26
 v_add_f32 v150, v150, v25
 v_lshlrev_b32 v25, 16, v40
 v_and_b32 v26, 0xffff0000, v40
 v_mul_f32 v25, v25, v61
 v_mul_f32 v26, v26, v56
 v_cvt_pk_bf16_f32 v25, v25, v26
 v_lshlrev_b32 v26, 16, v25
 v_and_b32 v25, 0xffff0000, v25
 v_add_f32 v150, v150, v26
 v_add_f32 v150, v150, v25
 v_lshlrev_b32 v25, 16, v42
 v_and_b32 v26, 0xffff0000, v42
 v_mul_f32 v25, v25, v57
 v_mul_f32 v26, v26, v52
 v_cvt_pk_bf16_f32 v25, v25, v26
 v_lshlrev_b32 v26, 16, v25
 v_and_b32 v25, 0xffff0000, v25
 v_add_f32 v151, v25, v26
 v_lshlrev_b32 v25, 16, v43
 v_and_b32 v26, 0xffff0000, v43
 v_mul_f32 v25, v25, v58
 v_mul_f32 v26, v26, v53
 v_cvt_pk_bf16_f32 v25, v25, v26
 v_lshlrev_b32 v26, 16, v25
 v_and_b32 v25, 0xffff0000, v25
 v_add_f32 v151, v151, v26
 v_add_f32 v151, v151, v25
 v_lshlrev_b32 v25, 16, v44
 v_and_b32 v26, 0xffff0000, v44
 v_mul_f32 v25, v25, v59
 v_mul_f32 v26, v26, v54
 v_cvt_pk_bf16_f32 v25, v25, v26
 v_lshlrev_b32 v26, 16, v25
 v_and_b32 v25, 0xffff0000, v25
 v_add_f32 v151, v151, v26
 v_add_f32 v151, v151, v25
 v_lshlrev_b32 v25, 16, v45
 v_and_b32 v26, 0xffff0000, v45
 v_mul_f32 v25, v25, v60
 v_mul_f32 v26, v26, v55
 v_cvt_pk_bf16_f32 v25, v25, v26
 v_lshlrev_b32 v26, 16, v25
 v_and_b32 v25, 0xffff0000, v25
 v_add_f32 v151, v151, v26
 v_add_f32 v151, v151, v25
 v_lshlrev_b32 v25, 16, v46
 v_and_b32 v26, 0xffff0000, v46
 v_mul_f32 v25, v25, v61
 v_mul_f32 v26, v26, v56
 v_cvt_pk_bf16_f32 v25, v25, v26
 v_lshlrev_b32 v26, 16, v25
 v_and_b32 v25, 0xffff0000, v25
 v_add_f32 v151, v151, v26
 v_add_f32 v151, v151, v25
 v_add_f32_dpp v144, v144, v144 row_ror:8 row_mask:0xf bank_mask:0xf
 v_add_f32_dpp v145, v145, v145 row_ror:8 row_mask:0xf bank_mask:0xf
 v_add_f32_dpp v146, v146, v146 row_ror:8 row_mask:0xf bank_mask:0xf
 v_add_f32_dpp v147, v147, v147 row_ror:8 row_mask:0xf bank_mask:0xf
 v_add_f32_dpp v148, v148, v148 row_ror:8 row_mask:0xf bank_mask:0xf
 v_add_f32_dpp v149, v149, v149 row_ror:8 row_mask:0xf bank_mask:0xf
 v_add_f32_dpp v150, v150, v150 row_ror:8 row_mask:0xf bank_mask:0xf
 v_add_f32_dpp v151, v151, v151 row_ror:8 row_mask:0xf bank_mask:0xf
 v_add_f32_dpp v144, v144, v144 row_ror:4 row_mask:0xf bank_mask:0xf
 v_add_f32_dpp v145, v145, v145 row_ror:4 row_mask:0xf bank_mask:0xf
 v_add_f32_dpp v146, v146, v146 row_ror:4 row_mask:0xf bank_mask:0xf
 v_add_f32_dpp v147, v147, v147 row_ror:4 row_mask:0xf bank_mask:0xf
 v_add_f32_dpp v148, v148, v148 row_ror:4 row_mask:0xf bank_mask:0xf
 v_add_f32_dpp v149, v149, v149 row_ror:4 row_mask:0xf bank_mask:0xf
 v_add_f32_dpp v150, v150, v150 row_ror:4 row_mask:0xf bank_mask:0xf
 v_add_f32_dpp v151, v151, v151 row_ror:4 row_mask:0xf bank_mask:0xf
 v_add_f32_dpp v144, v144, v144 row_ror:2 row_mask:0xf bank_mask:0xf
 v_add_f32_dpp v145, v145, v145 row_ror:2 row_mask:0xf bank_mask:0xf
 v_add_f32_dpp v146, v146, v146 row_ror:2 row_mask:0xf bank_mask:0xf
 v_add_f32_dpp v147, v147, v147 row_ror:2 row_mask:0xf bank_mask:0xf
 v_add_f32_dpp v148, v148, v148 row_ror:2 row_mask:0xf bank_mask:0xf
 v_add_f32_dpp v149, v149, v149 row_ror:2 row_mask:0xf bank_mask:0xf
 v_add_f32_dpp v150, v150, v150 row_ror:2 row_mask:0xf bank_mask:0xf
 v_add_f32_dpp v151, v151, v151 row_ror:2 row_mask:0xf bank_mask:0xf
 v_add_f32_dpp v144, v144, v144 row_ror:1 row_mask:0xf bank_mask:0xf
 v_add_f32_dpp v145, v145, v145 row_ror:1 row_mask:0xf bank_mask:0xf
 v_add_f32_dpp v146, v146, v146 row_ror:1 row_mask:0xf bank_mask:0xf
 v_add_f32_dpp v147, v147, v147 row_ror:1 row_mask:0xf bank_mask:0xf
 v_add_f32_dpp v148, v148, v148 row_ror:1 row_mask:0xf bank_mask:0xf
 v_add_f32_dpp v149, v149, v149 row_ror:1 row_mask:0xf bank_mask:0xf
 v_add_f32_dpp v150, v150, v150 row_ror:1 row_mask:0xf bank_mask:0xf
 v_add_f32_dpp v151, v151, v151 row_ror:1 row_mask:0xf bank_mask:0xf
 v_mov_b32 v152, v144
 v_mov_b32 v153, v145
 v_mov_b32 v154, v146
 v_mov_b32 v155, v147
 v_mov_b32 v156, v148
 v_mov_b32 v157, v149
 v_mov_b32 v158, v150
 v_mov_b32 v159, v151
 v_permlane32_swap_b32 v144, v152
 v_permlane32_swap_b32 v145, v153
 v_permlane32_swap_b32 v146, v154
 v_permlane32_swap_b32 v147, v155
 v_permlane32_swap_b32 v148, v156
 v_permlane32_swap_b32 v149, v157
 v_permlane32_swap_b32 v150, v158
 v_permlane32_swap_b32 v151, v159
 v_add_f32 v144, v144, v152
 v_add_f32 v145, v145, v153
 v_add_f32 v146, v146, v154
 v_add_f32 v147, v147, v155
 v_add_f32 v148, v148, v156
 v_add_f32 v149, v149, v157
 v_add_f32 v150, v150, v158
 v_add_f32 v151, v151, v159
 v_mov_b32 v152, v144
 v_mov_b32 v153, v145
 v_mov_b32 v154, v146
 v_mov_b32 v155, v147
 v_mov_b32 v156, v148
 v_mov_b32 v157, v149
 v_mov_b32 v158, v150
 v_mov_b32 v159, v151
 v_permlane16_swap_b32 v144, v152
 v_permlane16_swap_b32 v145, v153
 v_permlane16_swap_b32 v146, v154
 v_permlane16_swap_b32 v147, v155
 v_permlane16_swap_b32 v148, v156
 v_permlane16_swap_b32 v149, v157
 v_permlane16_swap_b32 v150, v158
 v_permlane16_swap_b32 v151, v159
 v_add_f32 v144, v144, v152
 v_add_f32 v145, v145, v153
 v_add_f32 v146, v146, v154
 v_add_f32 v147, v147, v155
 v_add_f32 v148, v148, v156
 v_add_f32 v149, v149, v157
 v_add_f32 v150, v150, v158
 v_add_f32 v151, v151, v159
 v_mov_b32 v24, v144
 v_cmp_eq_u32 vcc, 1, v1
 s_nop 1
 v_cndmask_b32 v24, v24, v145, vcc
 v_cmp_eq_u32 vcc, 2, v1
 s_nop 1
 v_cndmask_b32 v24, v24, v146, vcc
 v_cmp_eq_u32 vcc, 3, v1
 s_nop 1
 v_cndmask_b32 v24, v24, v147, vcc
 v_cmp_eq_u32 vcc, 4, v1
 s_nop 1
 v_cndmask_b32 v24, v24, v148, vcc
 v_cmp_eq_u32 vcc, 5, v1
 s_nop 1
 v_cndmask_b32 v24, v24, v149, vcc
 v_cmp_eq_u32 vcc, 6, v1
 s_nop 1
 v_cndmask_b32 v24, v24, v150, vcc
 v_cmp_eq_u32 vcc, 7, v1
 s_nop 1
 v_cndmask_b32 v24, v24, v151, vcc
 v_cvt_pk_bf16_f32 v25, v24, v24
 v_lshlrev_b32 v24, 16, v25
 v_mul_f32 v24, 0xbfb8aa3b, v24
 v_exp_f32 v24, v24
 s_nop 0
 v_add_f32 v24, 1.0, v24
 v_rcp_f32 v24, v24
 s_nop 0
 v_cvt_pk_bf16_f32 v25, v24, v24
 v_lshlrev_b32 v24, 16, v25
 s_lshl_b32 s21, s59, 2
 s_mov_b64 exec, 0xff
 buffer_store_dword v24, v5, s[28:31], s21 offen sc1
 s_mov_b64 exec, -1
 s_sub_u32 s59, s59, 1024
 s_waitcnt vmcnt(1)
 v_lshlrev_b32 v25, 16, v160
 v_and_b32 v26, 0xffff0000, v160
 v_mul_f32 v25, v25, v57
 v_mul_f32 v26, v26, v52
 v_cvt_pk_bf16_f32 v25, v25, v26
 v_lshlrev_b32 v26, 16, v25
 v_and_b32 v25, 0xffff0000, v25
 v_add_f32 v144, v25, v26
 v_lshlrev_b32 v25, 16, v161
 v_and_b32 v26, 0xffff0000, v161
 v_mul_f32 v25, v25, v58
 v_mul_f32 v26, v26, v53
 v_cvt_pk_bf16_f32 v25, v25, v26
 v_lshlrev_b32 v26, 16, v25
 v_and_b32 v25, 0xffff0000, v25
 v_add_f32 v144, v144, v26
 v_add_f32 v144, v144, v25
 v_lshlrev_b32 v25, 16, v162
 v_and_b32 v26, 0xffff0000, v162
 v_mul_f32 v25, v25, v59
 v_mul_f32 v26, v26, v54
 v_cvt_pk_bf16_f32 v25, v25, v26
 v_lshlrev_b32 v26, 16, v25
 v_and_b32 v25, 0xffff0000, v25
 v_add_f32 v144, v144, v26
 v_add_f32 v144, v144, v25
 v_lshlrev_b32 v25, 16, v163
 v_and_b32 v26, 0xffff0000, v163
 v_mul_f32 v25, v25, v60
 v_mul_f32 v26, v26, v55
 v_cvt_pk_bf16_f32 v25, v25, v26
 v_lshlrev_b32 v26, 16, v25
 v_and_b32 v25, 0xffff0000, v25
 v_add_f32 v144, v144, v26
 v_add_f32 v144, v144, v25
 v_lshlrev_b32 v25, 16, v164
 v_and_b32 v26, 0xffff0000, v164
 v_mul_f32 v25, v25, v61
 v_mul_f32 v26, v26, v56
 v_cvt_pk_bf16_f32 v25, v25, v26
 v_lshlrev_b32 v26, 16, v25
 v_and_b32 v25, 0xffff0000, v25
 v_add_f32 v144, v144, v26
 v_add_f32 v144, v144, v25
 v_lshlrev_b32 v25, 16, v166
 v_and_b32 v26, 0xffff0000, v166
 v_mul_f32 v25, v25, v57
 v_mul_f32 v26, v26, v52
 v_cvt_pk_bf16_f32 v25, v25, v26
 v_lshlrev_b32 v26, 16, v25
 v_and_b32 v25, 0xffff0000, v25
 v_add_f32 v145, v25, v26
 v_lshlrev_b32 v25, 16, v167
 v_and_b32 v26, 0xffff0000, v167
 v_mul_f32 v25, v25, v58
 v_mul_f32 v26, v26, v53
 v_cvt_pk_bf16_f32 v25, v25, v26
 v_lshlrev_b32 v26, 16, v25
 v_and_b32 v25, 0xffff0000, v25
 v_add_f32 v145, v145, v26
 v_add_f32 v145, v145, v25
 v_lshlrev_b32 v25, 16, v168
 v_and_b32 v26, 0xffff0000, v168
 v_mul_f32 v25, v25, v59
 v_mul_f32 v26, v26, v54
 v_cvt_pk_bf16_f32 v25, v25, v26
 v_lshlrev_b32 v26, 16, v25
 v_and_b32 v25, 0xffff0000, v25
 v_add_f32 v145, v145, v26
 v_add_f32 v145, v145, v25
 v_lshlrev_b32 v25, 16, v169
 v_and_b32 v26, 0xffff0000, v169
 v_mul_f32 v25, v25, v60
 v_mul_f32 v26, v26, v55
 v_cvt_pk_bf16_f32 v25, v25, v26
 v_lshlrev_b32 v26, 16, v25
 v_and_b32 v25, 0xffff0000, v25
 v_add_f32 v145, v145, v26
 v_add_f32 v145, v145, v25
 v_lshlrev_b32 v25, 16, v170
 v_and_b32 v26, 0xffff0000, v170
 v_mul_f32 v25, v25, v61
 v_mul_f32 v26, v26, v56
 v_cvt_pk_bf16_f32 v25, v25, v26
 v_lshlrev_b32 v26, 16, v25
 v_and_b32 v25, 0xffff0000, v25
 v_add_f32 v145, v145, v26
 v_add_f32 v145, v145, v25
 v_lshlrev_b32 v25, 16, v172
 v_and_b32 v26, 0xffff0000, v172
 v_mul_f32 v25, v25, v57
 v_mul_f32 v26, v26, v52
 v_cvt_pk_bf16_f32 v25, v25, v26
 v_lshlrev_b32 v26, 16, v25
 v_and_b32 v25, 0xffff0000, v25
 v_add_f32 v146, v25, v26
 v_lshlrev_b32 v25, 16, v173
 v_and_b32 v26, 0xffff0000, v173
 v_mul_f32 v25, v25, v58
 v_mul_f32 v26, v26, v53
 v_cvt_pk_bf16_f32 v25, v25, v26
 v_lshlrev_b32 v26, 16, v25
 v_and_b32 v25, 0xffff0000, v25
 v_add_f32 v146, v146, v26
 v_add_f32 v146, v146, v25
 v_lshlrev_b32 v25, 16, v174
 v_and_b32 v26, 0xffff0000, v174
 v_mul_f32 v25, v25, v59
 v_mul_f32 v26, v26, v54
 v_cvt_pk_bf16_f32 v25, v25, v26
 v_lshlrev_b32 v26, 16, v25
 v_and_b32 v25, 0xffff0000, v25
 v_add_f32 v146, v146, v26
 v_add_f32 v146, v146, v25
 v_lshlrev_b32 v25, 16, v175
 v_and_b32 v26, 0xffff0000, v175
 v_mul_f32 v25, v25, v60
 v_mul_f32 v26, v26, v55
 v_cvt_pk_bf16_f32 v25, v25, v26
 v_lshlrev_b32 v26, 16, v25
 v_and_b32 v25, 0xffff0000, v25
 v_add_f32 v146, v146, v26
 v_add_f32 v146, v146, v25
 v_lshlrev_b32 v25, 16, v176
 v_and_b32 v26, 0xffff0000, v176
 v_mul_f32 v25, v25, v61
 v_mul_f32 v26, v26, v56
 v_cvt_pk_bf16_f32 v25, v25, v26
 v_lshlrev_b32 v26, 16, v25
 v_and_b32 v25, 0xffff0000, v25
 v_add_f32 v146, v146, v26
 v_add_f32 v146, v146, v25
 v_lshlrev_b32 v25, 16, v178
 v_and_b32 v26, 0xffff0000, v178
 v_mul_f32 v25, v25, v57
 v_mul_f32 v26, v26, v52
 v_cvt_pk_bf16_f32 v25, v25, v26
 v_lshlrev_b32 v26, 16, v25
 v_and_b32 v25, 0xffff0000, v25
 v_add_f32 v147, v25, v26
 v_lshlrev_b32 v25, 16, v179
 v_and_b32 v26, 0xffff0000, v179
 v_mul_f32 v25, v25, v58
 v_mul_f32 v26, v26, v53
 v_cvt_pk_bf16_f32 v25, v25, v26
 v_lshlrev_b32 v26, 16, v25
 v_and_b32 v25, 0xffff0000, v25
 v_add_f32 v147, v147, v26
 v_add_f32 v147, v147, v25
 v_lshlrev_b32 v25, 16, v180
 v_and_b32 v26, 0xffff0000, v180
 v_mul_f32 v25, v25, v59
 v_mul_f32 v26, v26, v54
 v_cvt_pk_bf16_f32 v25, v25, v26
 v_lshlrev_b32 v26, 16, v25
 v_and_b32 v25, 0xffff0000, v25
 v_add_f32 v147, v147, v26
 v_add_f32 v147, v147, v25
 v_lshlrev_b32 v25, 16, v181
 v_and_b32 v26, 0xffff0000, v181
 v_mul_f32 v25, v25, v60
 v_mul_f32 v26, v26, v55
 v_cvt_pk_bf16_f32 v25, v25, v26
 v_lshlrev_b32 v26, 16, v25
 v_and_b32 v25, 0xffff0000, v25
 v_add_f32 v147, v147, v26
 v_add_f32 v147, v147, v25
 v_lshlrev_b32 v25, 16, v182
 v_and_b32 v26, 0xffff0000, v182
 v_mul_f32 v25, v25, v61
 v_mul_f32 v26, v26, v56
 v_cvt_pk_bf16_f32 v25, v25, v26
 v_lshlrev_b32 v26, 16, v25
 v_and_b32 v25, 0xffff0000, v25
 v_add_f32 v147, v147, v26
 v_add_f32 v147, v147, v25
 v_lshlrev_b32 v25, 16, v184
 v_and_b32 v26, 0xffff0000, v184
 v_mul_f32 v25, v25, v57
 v_mul_f32 v26, v26, v52
 v_cvt_pk_bf16_f32 v25, v25, v26
 v_lshlrev_b32 v26, 16, v25
 v_and_b32 v25, 0xffff0000, v25
 v_add_f32 v148, v25, v26
 v_lshlrev_b32 v25, 16, v185
 v_and_b32 v26, 0xffff0000, v185
 v_mul_f32 v25, v25, v58
 v_mul_f32 v26, v26, v53
 v_cvt_pk_bf16_f32 v25, v25, v26
 v_lshlrev_b32 v26, 16, v25
 v_and_b32 v25, 0xffff0000, v25
 v_add_f32 v148, v148, v26
 v_add_f32 v148, v148, v25
 v_lshlrev_b32 v25, 16, v186
 v_and_b32 v26, 0xffff0000, v186
 v_mul_f32 v25, v25, v59
 v_mul_f32 v26, v26, v54
 v_cvt_pk_bf16_f32 v25, v25, v26
 v_lshlrev_b32 v26, 16, v25
 v_and_b32 v25, 0xffff0000, v25
 v_add_f32 v148, v148, v26
 v_add_f32 v148, v148, v25
 v_lshlrev_b32 v25, 16, v187
 v_and_b32 v26, 0xffff0000, v187
 v_mul_f32 v25, v25, v60
 v_mul_f32 v26, v26, v55
 v_cvt_pk_bf16_f32 v25, v25, v26
 v_lshlrev_b32 v26, 16, v25
 v_and_b32 v25, 0xffff0000, v25
 v_add_f32 v148, v148, v26
 v_add_f32 v148, v148, v25
 v_lshlrev_b32 v25, 16, v188
 v_and_b32 v26, 0xffff0000, v188
 v_mul_f32 v25, v25, v61
 v_mul_f32 v26, v26, v56
 v_cvt_pk_bf16_f32 v25, v25, v26
 v_lshlrev_b32 v26, 16, v25
 v_and_b32 v25, 0xffff0000, v25
 v_add_f32 v148, v148, v26
 v_add_f32 v148, v148, v25
 v_lshlrev_b32 v25, 16, v190
 v_and_b32 v26, 0xffff0000, v190
 v_mul_f32 v25, v25, v57
 v_mul_f32 v26, v26, v52
 v_cvt_pk_bf16_f32 v25, v25, v26
 v_lshlrev_b32 v26, 16, v25
 v_and_b32 v25, 0xffff0000, v25
 v_add_f32 v149, v25, v26
 v_lshlrev_b32 v25, 16, v191
 v_and_b32 v26, 0xffff0000, v191
 v_mul_f32 v25, v25, v58
 v_mul_f32 v26, v26, v53
 v_cvt_pk_bf16_f32 v25, v25, v26
 v_lshlrev_b32 v26, 16, v25
 v_and_b32 v25, 0xffff0000, v25
 v_add_f32 v149, v149, v26
 v_add_f32 v149, v149, v25
 v_lshlrev_b32 v25, 16, v192
 v_and_b32 v26, 0xffff0000, v192
 v_mul_f32 v25, v25, v59
 v_mul_f32 v26, v26, v54
 v_cvt_pk_bf16_f32 v25, v25, v26
 v_lshlrev_b32 v26, 16, v25
 v_and_b32 v25, 0xffff0000, v25
 v_add_f32 v149, v149, v26
 v_add_f32 v149, v149, v25
 v_lshlrev_b32 v25, 16, v193
 v_and_b32 v26, 0xffff0000, v193
 v_mul_f32 v25, v25, v60
 v_mul_f32 v26, v26, v55
 v_cvt_pk_bf16_f32 v25, v25, v26
 v_lshlrev_b32 v26, 16, v25
 v_and_b32 v25, 0xffff0000, v25
 v_add_f32 v149, v149, v26
 v_add_f32 v149, v149, v25
 v_lshlrev_b32 v25, 16, v194
 v_and_b32 v26, 0xffff0000, v194
 v_mul_f32 v25, v25, v61
 v_mul_f32 v26, v26, v56
 v_cvt_pk_bf16_f32 v25, v25, v26
 v_lshlrev_b32 v26, 16, v25
 v_and_b32 v25, 0xffff0000, v25
 v_add_f32 v149, v149, v26
 v_add_f32 v149, v149, v25
 v_lshlrev_b32 v25, 16, v196
 v_and_b32 v26, 0xffff0000, v196
 v_mul_f32 v25, v25, v57
 v_mul_f32 v26, v26, v52
 v_cvt_pk_bf16_f32 v25, v25, v26
 v_lshlrev_b32 v26, 16, v25
 v_and_b32 v25, 0xffff0000, v25
 v_add_f32 v150, v25, v26
 v_lshlrev_b32 v25, 16, v197
 v_and_b32 v26, 0xffff0000, v197
 v_mul_f32 v25, v25, v58
 v_mul_f32 v26, v26, v53
 v_cvt_pk_bf16_f32 v25, v25, v26
 v_lshlrev_b32 v26, 16, v25
 v_and_b32 v25, 0xffff0000, v25
 v_add_f32 v150, v150, v26
 v_add_f32 v150, v150, v25
 v_lshlrev_b32 v25, 16, v198
 v_and_b32 v26, 0xffff0000, v198
 v_mul_f32 v25, v25, v59
 v_mul_f32 v26, v26, v54
 v_cvt_pk_bf16_f32 v25, v25, v26
 v_lshlrev_b32 v26, 16, v25
 v_and_b32 v25, 0xffff0000, v25
 v_add_f32 v150, v150, v26
 v_add_f32 v150, v150, v25
 v_lshlrev_b32 v25, 16, v199
 v_and_b32 v26, 0xffff0000, v199
 v_mul_f32 v25, v25, v60
 v_mul_f32 v26, v26, v55
 v_cvt_pk_bf16_f32 v25, v25, v26
 v_lshlrev_b32 v26, 16, v25
 v_and_b32 v25, 0xffff0000, v25
 v_add_f32 v150, v150, v26
 v_add_f32 v150, v150, v25
 v_lshlrev_b32 v25, 16, v200
 v_and_b32 v26, 0xffff0000, v200
 v_mul_f32 v25, v25, v61
 v_mul_f32 v26, v26, v56
 v_cvt_pk_bf16_f32 v25, v25, v26
 v_lshlrev_b32 v26, 16, v25
 v_and_b32 v25, 0xffff0000, v25
 v_add_f32 v150, v150, v26
 v_add_f32 v150, v150, v25
 v_lshlrev_b32 v25, 16, v202
 v_and_b32 v26, 0xffff0000, v202
 v_mul_f32 v25, v25, v57
 v_mul_f32 v26, v26, v52
 v_cvt_pk_bf16_f32 v25, v25, v26
 v_lshlrev_b32 v26, 16, v25
 v_and_b32 v25, 0xffff0000, v25
 v_add_f32 v151, v25, v26
 v_lshlrev_b32 v25, 16, v203
 v_and_b32 v26, 0xffff0000, v203
 v_mul_f32 v25, v25, v58
 v_mul_f32 v26, v26, v53
 v_cvt_pk_bf16_f32 v25, v25, v26
 v_lshlrev_b32 v26, 16, v25
 v_and_b32 v25, 0xffff0000, v25
 v_add_f32 v151, v151, v26
 v_add_f32 v151, v151, v25
 v_lshlrev_b32 v25, 16, v204
 v_and_b32 v26, 0xffff0000, v204
 v_mul_f32 v25, v25, v59
 v_mul_f32 v26, v26, v54
 v_cvt_pk_bf16_f32 v25, v25, v26
 v_lshlrev_b32 v26, 16, v25
 v_and_b32 v25, 0xffff0000, v25
 v_add_f32 v151, v151, v26
 v_add_f32 v151, v151, v25
 v_lshlrev_b32 v25, 16, v205
 v_and_b32 v26, 0xffff0000, v205
 v_mul_f32 v25, v25, v60
 v_mul_f32 v26, v26, v55
 v_cvt_pk_bf16_f32 v25, v25, v26
 v_lshlrev_b32 v26, 16, v25
 v_and_b32 v25, 0xffff0000, v25
 v_add_f32 v151, v151, v26
 v_add_f32 v151, v151, v25
 v_lshlrev_b32 v25, 16, v206
 v_and_b32 v26, 0xffff0000, v206
 v_mul_f32 v25, v25, v61
 v_mul_f32 v26, v26, v56
 v_cvt_pk_bf16_f32 v25, v25, v26
 v_lshlrev_b32 v26, 16, v25
 v_and_b32 v25, 0xffff0000, v25
 v_add_f32 v151, v151, v26
 v_add_f32 v151, v151, v25
 v_add_f32_dpp v144, v144, v144 row_ror:8 row_mask:0xf bank_mask:0xf
 v_add_f32_dpp v145, v145, v145 row_ror:8 row_mask:0xf bank_mask:0xf
 v_add_f32_dpp v146, v146, v146 row_ror:8 row_mask:0xf bank_mask:0xf
 v_add_f32_dpp v147, v147, v147 row_ror:8 row_mask:0xf bank_mask:0xf
 v_add_f32_dpp v148, v148, v148 row_ror:8 row_mask:0xf bank_mask:0xf
 v_add_f32_dpp v149, v149, v149 row_ror:8 row_mask:0xf bank_mask:0xf
 v_add_f32_dpp v150, v150, v150 row_ror:8 row_mask:0xf bank_mask:0xf
 v_add_f32_dpp v151, v151, v151 row_ror:8 row_mask:0xf bank_mask:0xf
 v_add_f32_dpp v144, v144, v144 row_ror:4 row_mask:0xf bank_mask:0xf
 v_add_f32_dpp v145, v145, v145 row_ror:4 row_mask:0xf bank_mask:0xf
 v_add_f32_dpp v146, v146, v146 row_ror:4 row_mask:0xf bank_mask:0xf
 v_add_f32_dpp v147, v147, v147 row_ror:4 row_mask:0xf bank_mask:0xf
 v_add_f32_dpp v148, v148, v148 row_ror:4 row_mask:0xf bank_mask:0xf
 v_add_f32_dpp v149, v149, v149 row_ror:4 row_mask:0xf bank_mask:0xf
 v_add_f32_dpp v150, v150, v150 row_ror:4 row_mask:0xf bank_mask:0xf
 v_add_f32_dpp v151, v151, v151 row_ror:4 row_mask:0xf bank_mask:0xf
 v_add_f32_dpp v144, v144, v144 row_ror:2 row_mask:0xf bank_mask:0xf
 v_add_f32_dpp v145, v145, v145 row_ror:2 row_mask:0xf bank_mask:0xf
 v_add_f32_dpp v146, v146, v146 row_ror:2 row_mask:0xf bank_mask:0xf
 v_add_f32_dpp v147, v147, v147 row_ror:2 row_mask:0xf bank_mask:0xf
 v_add_f32_dpp v148, v148, v148 row_ror:2 row_mask:0xf bank_mask:0xf
 v_add_f32_dpp v149, v149, v149 row_ror:2 row_mask:0xf bank_mask:0xf
 v_add_f32_dpp v150, v150, v150 row_ror:2 row_mask:0xf bank_mask:0xf
 v_add_f32_dpp v151, v151, v151 row_ror:2 row_mask:0xf bank_mask:0xf
 v_add_f32_dpp v144, v144, v144 row_ror:1 row_mask:0xf bank_mask:0xf
 v_add_f32_dpp v145, v145, v145 row_ror:1 row_mask:0xf bank_mask:0xf
 v_add_f32_dpp v146, v146, v146 row_ror:1 row_mask:0xf bank_mask:0xf
 v_add_f32_dpp v147, v147, v147 row_ror:1 row_mask:0xf bank_mask:0xf
 v_add_f32_dpp v148, v148, v148 row_ror:1 row_mask:0xf bank_mask:0xf
 v_add_f32_dpp v149, v149, v149 row_ror:1 row_mask:0xf bank_mask:0xf
 v_add_f32_dpp v150, v150, v150 row_ror:1 row_mask:0xf bank_mask:0xf
 v_add_f32_dpp v151, v151, v151 row_ror:1 row_mask:0xf bank_mask:0xf
 v_mov_b32 v152, v144
 v_mov_b32 v153, v145
 v_mov_b32 v154, v146
 v_mov_b32 v155, v147
 v_mov_b32 v156, v148
 v_mov_b32 v157, v149
 v_mov_b32 v158, v150
 v_mov_b32 v159, v151
 v_permlane32_swap_b32 v144, v152
 v_permlane32_swap_b32 v145, v153
 v_permlane32_swap_b32 v146, v154
 v_permlane32_swap_b32 v147, v155
 v_permlane32_swap_b32 v148, v156
 v_permlane32_swap_b32 v149, v157
 v_permlane32_swap_b32 v150, v158
 v_permlane32_swap_b32 v151, v159
 v_add_f32 v144, v144, v152
 v_add_f32 v145, v145, v153
 v_add_f32 v146, v146, v154
 v_add_f32 v147, v147, v155
 v_add_f32 v148, v148, v156
 v_add_f32 v149, v149, v157
 v_add_f32 v150, v150, v158
 v_add_f32 v151, v151, v159
 v_mov_b32 v152, v144
 v_mov_b32 v153, v145
 v_mov_b32 v154, v146
 v_mov_b32 v155, v147
 v_mov_b32 v156, v148
 v_mov_b32 v157, v149
 v_mov_b32 v158, v150
 v_mov_b32 v159, v151
 v_permlane16_swap_b32 v144, v152
 v_permlane16_swap_b32 v145, v153
 v_permlane16_swap_b32 v146, v154
 v_permlane16_swap_b32 v147, v155
 v_permlane16_swap_b32 v148, v156
 v_permlane16_swap_b32 v149, v157
 v_permlane16_swap_b32 v150, v158
 v_permlane16_swap_b32 v151, v159
 v_add_f32 v144, v144, v152
 v_add_f32 v145, v145, v153
 v_add_f32 v146, v146, v154
 v_add_f32 v147, v147, v155
 v_add_f32 v148, v148, v156
 v_add_f32 v149, v149, v157
 v_add_f32 v150, v150, v158
 v_add_f32 v151, v151, v159
 v_mov_b32 v24, v144
 v_cmp_eq_u32 vcc, 1, v1
 s_nop 1
 v_cndmask_b32 v24, v24, v145, vcc
 v_cmp_eq_u32 vcc, 2, v1
 s_nop 1
 v_cndmask_b32 v24, v24, v146, vcc
 v_cmp_eq_u32 vcc, 3, v1
 s_nop 1
 v_cndmask_b32 v24, v24, v147, vcc
 v_cmp_eq_u32 vcc, 4, v1
 s_nop 1
 v_cndmask_b32 v24, v24, v148, vcc
 v_cmp_eq_u32 vcc, 5, v1
 s_nop 1
 v_cndmask_b32 v24, v24, v149, vcc
 v_cmp_eq_u32 vcc, 6, v1
 s_nop 1
 v_cndmask_b32 v24, v24, v150, vcc
 v_cmp_eq_u32 vcc, 7, v1
 s_nop 1
 v_cndmask_b32 v24, v24, v151, vcc
 v_cvt_pk_bf16_f32 v25, v24, v24
 v_lshlrev_b32 v24, 16, v25
 v_mul_f32 v24, 0xbfb8aa3b, v24
 v_exp_f32 v24, v24
 s_nop 0
 v_add_f32 v24, 1.0, v24
 v_rcp_f32 v24, v24
 s_nop 0
 v_cvt_pk_bf16_f32 v25, v24, v24
 v_lshlrev_b32 v24, 16, v25
 s_lshl_b32 s21, s59, 2
 s_mov_b64 exec, 0xff
 buffer_store_dword v24, v5, s[28:31], s21 offen sc1
 s_mov_b64 exec, -1
 s_waitcnt vmcnt(0)
 s_barrier
 s_lshr_b32 s21, s2, 2
 s_lshl_b32 s21, s21, 7
 s_add_u32 s21, s21, 93184
 s_cmp_lg_u32 s20, 0
 s_cbranch_scc1 af_245
 v_mov_b32 v10, 0
 v_mov_b32 v11, 1
 s_mov_b64 exec, 1
 buffer_atomic_add v11, v10, s[72:75], s21 offen sc1
 s_mov_b64 exec, -1
 s_nop 1
af_245:
 s_branch om_244
om_243:
 s_load_dwordx2 s[8:9], s[0:1], 88
 s_lshr_b32 s52, s2, 2
 s_lshl_b32 s52, s52, 7
 s_add_u32 s21, s52, 94208
 s_cmp_lg_u32 s20, 0
 s_cbranch_scc1 wf_247
 v_mov_b32 v20, 0
 s_mov_b32 s101, 0
wf_246:
 buffer_load_dword v21, v20, s[72:75], s21 offen sc1
 s_add_u32 s101, s101, 1
 s_cmp_gt_u32 s101, 131072
 s_cbranch_scc1 main_end
 s_waitcnt vmcnt(0)
 v_readfirstlane_b32 s100, v21
 s_cmp_ge_u32 s100, 4
 s_cbranch_scc1 wf_247
 s_sleep 32
 s_branch wf_246
wf_247:
 s_barrier
 s_add_u32 s21, s52, 116736
 s_cmp_lg_u32 s20, 0
 s_cbranch_scc1 wf_249
 v_mov_b32 v20, 0
 s_mov_b32 s101, 0
wf_248:
 buffer_load_dword v21, v20, s[72:75], s21 offen sc1
 s_add_u32 s101, s101, 1
 s_cmp_gt_u32 s101, 131072
 s_cbranch_scc1 main_end
 s_waitcnt vmcnt(0)
 v_readfirstlane_b32 s100, v21
 s_cmp_ge_u32 s100, 32
 s_cbranch_scc1 wf_249
 s_sleep 32
 s_branch wf_248
wf_249:
 s_barrier
 v_lshlrev_b32 v6, 2, v2
 s_lshl_b32 s22, s47, 6
 buffer_load_dword v30, v6, s[28:31], s22 offen sc1
 buffer_load_dword v31, v6, s[28:31], s22 offen offset:64 sc1
 s_add_u32 s21, s53, 0
 s_lshr_b32 s22, s21, 1
 s_lshl_b32 s22, s22, 14
 s_and_b32 s21, s21, 1
 s_lshl_b32 s21, s21, 11
 s_add_u32 s22, s22, s21
 s_add_u32 s22, s22, s51
 buffer_load_dwordx4 v[144:147], v4, s[16:19], s22 offen offset:0 sc1
 buffer_load_dwordx4 v[148:151], v4, s[16:19], s22 offen offset:1024 sc1
 s_add_u32 s21, s53, 1
 s_lshr_b32 s22, s21, 1
 s_lshl_b32 s22, s22, 14
 s_and_b32 s21, s21, 1
 s_lshl_b32 s21, s21, 11
 s_add_u32 s22, s22, s21
 s_add_u32 s22, s22, s51
 buffer_load_dwordx4 v[152:155], v4, s[16:19], s22 offen offset:0 sc1
 buffer_load_dwordx4 v[156:159], v4, s[16:19], s22 offen offset:1024 sc1
 s_add_u32 s21, s53, 2
 s_lshr_b32 s22, s21, 1
 s_lshl_b32 s22, s22, 14
 s_and_b32 s21, s21, 1
 s_lshl_b32 s21, s21, 11
 s_add_u32 s22, s22, s21
 s_add_u32 s22, s22, s51
 buffer_load_dwordx4 v[160:163], v4, s[16:19], s22 offen offset:0 sc1
 buffer_load_dwordx4 v[164:167], v4, s[16:19], s22 offen offset:1024 sc1
 s_add_u32 s21, s53, 3
 s_lshr_b32 s22, s21, 1
 s_lshl_b32 s22, s22, 14
 s_and_b32 s21, s21, 1
 s_lshl_b32 s21, s21, 11
 s_add_u32 s22, s22, s21
 s_add_u32 s22, s22, s51
 buffer_load_dwordx4 v[168:171], v4, s[16:19], s22 offen offset:0 sc1
 buffer_load_dwordx4 v[172:175], v4, s[16:19], s22 offen offset:1024 sc1
 s_add_u32 s21, s53, 4
 s_lshr_b32 s22, s21, 1
 s_lshl_b32 s22, s22, 14
 s_and_b32 s21, s21, 1
 s_lshl_b32 s21, s21, 11
 s_add_u32 s22, s22, s21
 s_add_u32 s22, s22, s51
 buffer_load_dwordx4 v[176:179], v4, s[16:19], s22 offen offset:0 sc1
 buffer_load_dwordx4 v[180:183], v4, s[16:19], s22 offen offset:1024 sc1
 s_add_u32 s21, s53, 0
 s_lshr_b32 s22, s21, 1
 s_lshl_b32 s22, s22, 14
 s_and_b32 s21, s21, 1
 s_lshl_b32 s21, s21, 11
 s_add_u32 s22, s22, s21
 s_add_u32 s22, s22, s51
 s_add_u32 s22, s22, 4096
 buffer_load_dwordx4 v[184:187], v4, s[16:19], s22 offen offset:0 sc1
 buffer_load_dwordx4 v[188:191], v4, s[16:19], s22 offen offset:1024 sc1
 s_add_u32 s21, s53, 1
 s_lshr_b32 s22, s21, 1
 s_lshl_b32 s22, s22, 14
 s_and_b32 s21, s21, 1
 s_lshl_b32 s21, s21, 11
 s_add_u32 s22, s22, s21
 s_add_u32 s22, s22, s51
 s_add_u32 s22, s22, 4096
 buffer_load_dwordx4 v[192:195], v4, s[16:19], s22 offen offset:0 sc1
 buffer_load_dwordx4 v[196:199], v4, s[16:19], s22 offen offset:1024 sc1
 s_add_u32 s21, s53, 2
 s_lshr_b32 s22, s21, 1
 s_lshl_b32 s22, s22, 14
 s_and_b32 s21, s21, 1
 s_lshl_b32 s21, s21, 11
 s_add_u32 s22, s22, s21
 s_add_u32 s22, s22, s51
 s_add_u32 s22, s22, 4096
 buffer_load_dwordx4 v[200:203], v4, s[16:19], s22 offen offset:0 sc1
 buffer_load_dwordx4 v[204:207], v4, s[16:19], s22 offen offset:1024 sc1
 s_add_u32 s21, s53, 3
 s_lshr_b32 s22, s21, 1
 s_lshl_b32 s22, s22, 14
 s_and_b32 s21, s21, 1
 s_lshl_b32 s21, s21, 11
 s_add_u32 s22, s22, s21
 s_add_u32 s22, s22, s51
 s_add_u32 s22, s22, 4096
 buffer_load_dwordx4 v[208:211], v4, s[16:19], s22 offen offset:0 sc1
 buffer_load_dwordx4 v[212:215], v4, s[16:19], s22 offen offset:1024 sc1
 s_add_u32 s21, s53, 4
 s_lshr_b32 s22, s21, 1
 s_lshl_b32 s22, s22, 14
 s_and_b32 s21, s21, 1
 s_lshl_b32 s21, s21, 11
 s_add_u32 s22, s22, s21
 s_add_u32 s22, s22, s51
 s_add_u32 s22, s22, 4096
 buffer_load_dwordx4 v[216:219], v4, s[16:19], s22 offen offset:0 sc1
 buffer_load_dwordx4 v[220:223], v4, s[16:19], s22 offen offset:1024 sc1
 v_mul_u32_u24 v9, 1280, v2
 v_lshl_add_u32 v9, v3, 3, v9
 s_mul_i32 s22, s47, 20480
 s_add_u32 s22, s22, s45
 s_add_u32 s23, s22, 20480
 s_waitcnt vmcnt(20) lgkmcnt(0)
 v_sub_f32 v32, 1.0, v30
 v_sub_f32 v33, 1.0, v31
 v_cvt_pk_bf16_f32 v26, v32, v33
 v_lshlrev_b32 v32, 16, v26
 v_and_b32 v33, 0xffff0000, v26
 v_cvt_pk_bf16_f32 v26, v64, v65
 v_lshlrev_b32 v64, 16, v26
 v_and_b32 v65, 0xffff0000, v26
 v_mul_f32 v64, v64, v32
 v_mul_f32 v65, v65, v32
 v_cvt_pk_bf16_f32 v26, v64, v65
 v_lshlrev_b32 v64, 16, v26
 v_and_b32 v65, 0xffff0000, v26
 v_cvt_pk_bf16_f32 v26, v66, v67
 v_lshlrev_b32 v66, 16, v26
 v_and_b32 v67, 0xffff0000, v26
 v_mul_f32 v66, v66, v32
 v_mul_f32 v67, v67, v32
 v_cvt_pk_bf16_f32 v26, v66, v67
 v_lshlrev_b32 v66, 16, v26
 v_and_b32 v67, 0xffff0000, v26
 v_cvt_pk_bf16_f32 v26, v68, v69
 v_lshlrev_b32 v68, 16, v26
 v_and_b32 v69, 0xffff0000, v26
 v_mul_f32 v68, v68, v32
 v_mul_f32 v69, v69, v32
 v_cvt_pk_bf16_f32 v26, v68, v69
 v_lshlrev_b32 v68, 16, v26
 v_and_b32 v69, 0xffff0000, v26
 v_cvt_pk_bf16_f32 v26, v70, v71
 v_lshlrev_b32 v70, 16, v26
 v_and_b32 v71, 0xffff0000, v26
 v_mul_f32 v70, v70, v32
 v_mul_f32 v71, v71, v32
 v_cvt_pk_bf16_f32 v26, v70, v71
 v_lshlrev_b32 v70, 16, v26
 v_and_b32 v71, 0xffff0000, v26
 v_cvt_pk_bf16_f32 v26, v72, v73
 v_lshlrev_b32 v72, 16, v26
 v_and_b32 v73, 0xffff0000, v26
 v_mul_f32 v72, v72, v32
 v_mul_f32 v73, v73, v32
 v_cvt_pk_bf16_f32 v26, v72, v73
 v_lshlrev_b32 v72, 16, v26
 v_and_b32 v73, 0xffff0000, v26
 v_cvt_pk_bf16_f32 v26, v74, v75
 v_lshlrev_b32 v74, 16, v26
 v_and_b32 v75, 0xffff0000, v26
 v_mul_f32 v74, v74, v32
 v_mul_f32 v75, v75, v32
 v_cvt_pk_bf16_f32 v26, v74, v75
 v_lshlrev_b32 v74, 16, v26
 v_and_b32 v75, 0xffff0000, v26
 v_cvt_pk_bf16_f32 v26, v76, v77
 v_lshlrev_b32 v76, 16, v26
 v_and_b32 v77, 0xffff0000, v26
 v_mul_f32 v76, v76, v32
 v_mul_f32 v77, v77, v32
 v_cvt_pk_bf16_f32 v26, v76, v77
 v_lshlrev_b32 v76, 16, v26
 v_and_b32 v77, 0xffff0000, v26
 v_cvt_pk_bf16_f32 v26, v78, v79
 v_lshlrev_b32 v78, 16, v26
 v_and_b32 v79, 0xffff0000, v26
 v_mul_f32 v78, v78, v32
 v_mul_f32 v79, v79, v32
 v_cvt_pk_bf16_f32 v26, v78, v79
 v_lshlrev_b32 v78, 16, v26
 v_and_b32 v79, 0xffff0000, v26
 v_cvt_pk_bf16_f32 v26, v80, v81
 v_lshlrev_b32 v80, 16, v26
 v_and_b32 v81, 0xffff0000, v26
 v_mul_f32 v80, v80, v32
 v_mul_f32 v81, v81, v32
 v_cvt_pk_bf16_f32 v26, v80, v81
 v_lshlrev_b32 v80, 16, v26
 v_and_b32 v81, 0xffff0000, v26
 v_cvt_pk_bf16_f32 v26, v82, v83
 v_lshlrev_b32 v82, 16, v26
 v_and_b32 v83, 0xffff0000, v26
 v_mul_f32 v82, v82, v32
 v_mul_f32 v83, v83, v32
 v_cvt_pk_bf16_f32 v26, v82, v83
 v_lshlrev_b32 v82, 16, v26
 v_and_b32 v83, 0xffff0000, v26
 v_cvt_pk_bf16_f32 v26, v84, v85
 v_lshlrev_b32 v84, 16, v26
 v_and_b32 v85, 0xffff0000, v26
 v_mul_f32 v84, v84, v32
 v_mul_f32 v85, v85, v32
 v_cvt_pk_bf16_f32 v26, v84, v85
 v_lshlrev_b32 v84, 16, v26
 v_and_b32 v85, 0xffff0000, v26
 v_cvt_pk_bf16_f32 v26, v86, v87
 v_lshlrev_b32 v86, 16, v26
 v_and_b32 v87, 0xffff0000, v26
 v_mul_f32 v86, v86, v32
 v_mul_f32 v87, v87, v32
 v_cvt_pk_bf16_f32 v26, v86, v87
 v_lshlrev_b32 v86, 16, v26
 v_and_b32 v87, 0xffff0000, v26
 v_cvt_pk_bf16_f32 v26, v88, v89
 v_lshlrev_b32 v88, 16, v26
 v_and_b32 v89, 0xffff0000, v26
 v_mul_f32 v88, v88, v32
 v_mul_f32 v89, v89, v32
 v_cvt_pk_bf16_f32 v26, v88, v89
 v_lshlrev_b32 v88, 16, v26
 v_and_b32 v89, 0xffff0000, v26
 v_cvt_pk_bf16_f32 v26, v90, v91
 v_lshlrev_b32 v90, 16, v26
 v_and_b32 v91, 0xffff0000, v26
 v_mul_f32 v90, v90, v32
 v_mul_f32 v91, v91, v32
 v_cvt_pk_bf16_f32 v26, v90, v91
 v_lshlrev_b32 v90, 16, v26
 v_and_b32 v91, 0xffff0000, v26
 v_cvt_pk_bf16_f32 v26, v92, v93
 v_lshlrev_b32 v92, 16, v26
 v_and_b32 v93, 0xffff0000, v26
 v_mul_f32 v92, v92, v32
 v_mul_f32 v93, v93, v32
 v_cvt_pk_bf16_f32 v26, v92, v93
 v_lshlrev_b32 v92, 16, v26
 v_and_b32 v93, 0xffff0000, v26
 v_cvt_pk_bf16_f32 v26, v94, v95
 v_lshlrev_b32 v94, 16, v26
 v_and_b32 v95, 0xffff0000, v26
 v_mul_f32 v94, v94, v32
 v_mul_f32 v95, v95, v32
 v_cvt_pk_bf16_f32 v26, v94, v95
 v_lshlrev_b32 v94, 16, v26
 v_and_b32 v95, 0xffff0000, v26
 v_cvt_pk_bf16_f32 v26, v96, v97
 v_lshlrev_b32 v96, 16, v26
 v_and_b32 v97, 0xffff0000, v26
 v_mul_f32 v96, v96, v32
 v_mul_f32 v97, v97, v32
 v_cvt_pk_bf16_f32 v26, v96, v97
 v_lshlrev_b32 v96, 16, v26
 v_and_b32 v97, 0xffff0000, v26
 v_cvt_pk_bf16_f32 v26, v98, v99
 v_lshlrev_b32 v98, 16, v26
 v_and_b32 v99, 0xffff0000, v26
 v_mul_f32 v98, v98, v32
 v_mul_f32 v99, v99, v32
 v_cvt_pk_bf16_f32 v26, v98, v99
 v_lshlrev_b32 v98, 16, v26
 v_and_b32 v99, 0xffff0000, v26
 v_cvt_pk_bf16_f32 v26, v100, v101
 v_lshlrev_b32 v100, 16, v26
 v_and_b32 v101, 0xffff0000, v26
 v_mul_f32 v100, v100, v32
 v_mul_f32 v101, v101, v32
 v_cvt_pk_bf16_f32 v26, v100, v101
 v_lshlrev_b32 v100, 16, v26
 v_and_b32 v101, 0xffff0000, v26
 v_cvt_pk_bf16_f32 v26, v102, v103
 v_lshlrev_b32 v102, 16, v26
 v_and_b32 v103, 0xffff0000, v26
 v_mul_f32 v102, v102, v32
 v_mul_f32 v103, v103, v32
 v_cvt_pk_bf16_f32 v26, v102, v103
 v_lshlrev_b32 v102, 16, v26
 v_and_b32 v103, 0xffff0000, v26
 v_cvt_pk_bf16_f32 v26, v104, v105
 v_lshlrev_b32 v104, 16, v26
 v_and_b32 v105, 0xffff0000, v26
 v_mul_f32 v104, v104, v33
 v_mul_f32 v105, v105, v33
 v_cvt_pk_bf16_f32 v26, v104, v105
 v_lshlrev_b32 v104, 16, v26
 v_and_b32 v105, 0xffff0000, v26
 v_cvt_pk_bf16_f32 v26, v106, v107
 v_lshlrev_b32 v106, 16, v26
 v_and_b32 v107, 0xffff0000, v26
 v_mul_f32 v106, v106, v33
 v_mul_f32 v107, v107, v33
 v_cvt_pk_bf16_f32 v26, v106, v107
 v_lshlrev_b32 v106, 16, v26
 v_and_b32 v107, 0xffff0000, v26
 v_cvt_pk_bf16_f32 v26, v108, v109
 v_lshlrev_b32 v108, 16, v26
 v_and_b32 v109, 0xffff0000, v26
 v_mul_f32 v108, v108, v33
 v_mul_f32 v109, v109, v33
 v_cvt_pk_bf16_f32 v26, v108, v109
 v_lshlrev_b32 v108, 16, v26
 v_and_b32 v109, 0xffff0000, v26
 v_cvt_pk_bf16_f32 v26, v110, v111
 v_lshlrev_b32 v110, 16, v26
 v_and_b32 v111, 0xffff0000, v26
 v_mul_f32 v110, v110, v33
 v_mul_f32 v111, v111, v33
 v_cvt_pk_bf16_f32 v26, v110, v111
 v_lshlrev_b32 v110, 16, v26
 v_and_b32 v111, 0xffff0000, v26
 v_cvt_pk_bf16_f32 v26, v112, v113
 v_lshlrev_b32 v112, 16, v26
 v_and_b32 v113, 0xffff0000, v26
 v_mul_f32 v112, v112, v33
 v_mul_f32 v113, v113, v33
 v_cvt_pk_bf16_f32 v26, v112, v113
 v_lshlrev_b32 v112, 16, v26
 v_and_b32 v113, 0xffff0000, v26
 v_cvt_pk_bf16_f32 v26, v114, v115
 v_lshlrev_b32 v114, 16, v26
 v_and_b32 v115, 0xffff0000, v26
 v_mul_f32 v114, v114, v33
 v_mul_f32 v115, v115, v33
 v_cvt_pk_bf16_f32 v26, v114, v115
 v_lshlrev_b32 v114, 16, v26
 v_and_b32 v115, 0xffff0000, v26
 v_cvt_pk_bf16_f32 v26, v116, v117
 v_lshlrev_b32 v116, 16, v26
 v_and_b32 v117, 0xffff0000, v26
 v_mul_f32 v116, v116, v33
 v_mul_f32 v117, v117, v33
 v_cvt_pk_bf16_f32 v26, v116, v117
 v_lshlrev_b32 v116, 16, v26
 v_and_b32 v117, 0xffff0000, v26
 v_cvt_pk_bf16_f32 v26, v118, v119
 v_lshlrev_b32 v118, 16, v26
 v_and_b32 v119, 0xffff0000, v26
 v_mul_f32 v118, v118, v33
 v_mul_f32 v119, v119, v33
 v_cvt_pk_bf16_f32 v26, v118, v119
 v_lshlrev_b32 v118, 16, v26
 v_and_b32 v119, 0xffff0000, v26
 v_cvt_pk_bf16_f32 v26, v120, v121
 v_lshlrev_b32 v120, 16, v26
 v_and_b32 v121, 0xffff0000, v26
 v_mul_f32 v120, v120, v33
 v_mul_f32 v121, v121, v33
 v_cvt_pk_bf16_f32 v26, v120, v121
 v_lshlrev_b32 v120, 16, v26
 v_and_b32 v121, 0xffff0000, v26
 v_cvt_pk_bf16_f32 v26, v122, v123
 v_lshlrev_b32 v122, 16, v26
 v_and_b32 v123, 0xffff0000, v26
 v_mul_f32 v122, v122, v33
 v_mul_f32 v123, v123, v33
 v_cvt_pk_bf16_f32 v26, v122, v123
 v_lshlrev_b32 v122, 16, v26
 v_and_b32 v123, 0xffff0000, v26
 v_cvt_pk_bf16_f32 v26, v124, v125
 v_lshlrev_b32 v124, 16, v26
 v_and_b32 v125, 0xffff0000, v26
 v_mul_f32 v124, v124, v33
 v_mul_f32 v125, v125, v33
 v_cvt_pk_bf16_f32 v26, v124, v125
 v_lshlrev_b32 v124, 16, v26
 v_and_b32 v125, 0xffff0000, v26
 v_cvt_pk_bf16_f32 v26, v126, v127
 v_lshlrev_b32 v126, 16, v26
 v_and_b32 v127, 0xffff0000, v26
 v_mul_f32 v126, v126, v33
 v_mul_f32 v127, v127, v33
 v_cvt_pk_bf16_f32 v26, v126, v127
 v_lshlrev_b32 v126, 16, v26
 v_and_b32 v127, 0xffff0000, v26
 v_cvt_pk_bf16_f32 v26, v128, v129
 v_lshlrev_b32 v128, 16, v26
 v_and_b32 v129, 0xffff0000, v26
 v_mul_f32 v128, v128, v33
 v_mul_f32 v129, v129, v33
 v_cvt_pk_bf16_f32 v26, v128, v129
 v_lshlrev_b32 v128, 16, v26
 v_and_b32 v129, 0xffff0000, v26
 v_cvt_pk_bf16_f32 v26, v130, v131
 v_lshlrev_b32 v130, 16, v26
 v_and_b32 v131, 0xffff0000, v26
 v_mul_f32 v130, v130, v33
 v_mul_f32 v131, v131, v33
 v_cvt_pk_bf16_f32 v26, v130, v131
 v_lshlrev_b32 v130, 16, v26
 v_and_b32 v131, 0xffff0000, v26
 v_cvt_pk_bf16_f32 v26, v132, v133
 v_lshlrev_b32 v132, 16, v26
 v_and_b32 v133, 0xffff0000, v26
 v_mul_f32 v132, v132, v33
 v_mul_f32 v133, v133, v33
 v_cvt_pk_bf16_f32 v26, v132, v133
 v_lshlrev_b32 v132, 16, v26
 v_and_b32 v133, 0xffff0000, v26
 v_cvt_pk_bf16_f32 v26, v134, v135
 v_lshlrev_b32 v134, 16, v26
 v_and_b32 v135, 0xffff0000, v26
 v_mul_f32 v134, v134, v33
 v_mul_f32 v135, v135, v33
 v_cvt_pk_bf16_f32 v26, v134, v135
 v_lshlrev_b32 v134, 16, v26
 v_and_b32 v135, 0xffff0000, v26
 v_cvt_pk_bf16_f32 v26, v136, v137
 v_lshlrev_b32 v136, 16, v26
 v_and_b32 v137, 0xffff0000, v26
 v_mul_f32 v136, v136, v33
 v_mul_f32 v137, v137, v33
 v_cvt_pk_bf16_f32 v26, v136, v137
 v_lshlrev_b32 v136, 16, v26
 v_and_b32 v137, 0xffff0000, v26
 v_cvt_pk_bf16_f32 v26, v138, v139
 v_lshlrev_b32 v138, 16, v26
 v_and_b32 v139, 0xffff0000, v26
 v_mul_f32 v138, v138, v33
 v_mul_f32 v139, v139, v33
 v_cvt_pk_bf16_f32 v26, v138, v139
 v_lshlrev_b32 v138, 16, v26
 v_and_b32 v139, 0xffff0000, v26
 v_cvt_pk_bf16_f32 v26, v140, v141
 v_lshlrev_b32 v140, 16, v26
 v_and_b32 v141, 0xffff0000, v26
 v_mul_f32 v140, v140, v33
 v_mul_f32 v141, v141, v33
 v_cvt_pk_bf16_f32 v26, v140, v141
 v_lshlrev_b32 v140, 16, v26
 v_and_b32 v141, 0xffff0000, v26
 v_cvt_pk_bf16_f32 v26, v142, v143
 v_lshlrev_b32 v142, 16, v26
 v_and_b32 v143, 0xffff0000, v26
 v_mul_f32 v142, v142, v33
 v_mul_f32 v143, v143, v33
 v_cvt_pk_bf16_f32 v26, v142, v143
 v_lshlrev_b32 v142, 16, v26
 v_and_b32 v143, 0xffff0000, v26
 s_waitcnt vmcnt(19)
 v_cvt_pk_bf16_f32 v26, v144, v145
 v_lshlrev_b32 v144, 16, v26
 v_and_b32 v145, 0xffff0000, v26
 v_mul_f32 v144, v144, v30
 v_mul_f32 v145, v145, v30
 v_cvt_pk_bf16_f32 v26, v144, v145
 v_lshlrev_b32 v144, 16, v26
 v_and_b32 v145, 0xffff0000, v26
 v_add_f32 v144, v144, v64
 v_add_f32 v145, v145, v65
 v_cvt_pk_bf16_f32 v64, v144, v145
 v_cvt_pk_bf16_f32 v26, v146, v147
 v_lshlrev_b32 v146, 16, v26
 v_and_b32 v147, 0xffff0000, v26
 v_mul_f32 v146, v146, v30
 v_mul_f32 v147, v147, v30
 v_cvt_pk_bf16_f32 v26, v146, v147
 v_lshlrev_b32 v146, 16, v26
 v_and_b32 v147, 0xffff0000, v26
 v_add_f32 v146, v146, v66
 v_add_f32 v147, v147, v67
 v_cvt_pk_bf16_f32 v65, v146, v147
 buffer_store_dwordx2 v[64:65], v9, s[8:11], s22 offen offset:0
 s_waitcnt vmcnt(19)
 v_cvt_pk_bf16_f32 v26, v148, v149
 v_lshlrev_b32 v148, 16, v26
 v_and_b32 v149, 0xffff0000, v26
 v_mul_f32 v148, v148, v30
 v_mul_f32 v149, v149, v30
 v_cvt_pk_bf16_f32 v26, v148, v149
 v_lshlrev_b32 v148, 16, v26
 v_and_b32 v149, 0xffff0000, v26
 v_add_f32 v148, v148, v68
 v_add_f32 v149, v149, v69
 v_cvt_pk_bf16_f32 v68, v148, v149
 v_cvt_pk_bf16_f32 v26, v150, v151
 v_lshlrev_b32 v150, 16, v26
 v_and_b32 v151, 0xffff0000, v26
 v_mul_f32 v150, v150, v30
 v_mul_f32 v151, v151, v30
 v_cvt_pk_bf16_f32 v26, v150, v151
 v_lshlrev_b32 v150, 16, v26
 v_and_b32 v151, 0xffff0000, v26
 v_add_f32 v150, v150, v70
 v_add_f32 v151, v151, v71
 v_cvt_pk_bf16_f32 v69, v150, v151
 buffer_store_dwordx2 v[68:69], v9, s[8:11], s22 offen offset:32
 s_waitcnt vmcnt(19)
 v_cvt_pk_bf16_f32 v26, v152, v153
 v_lshlrev_b32 v152, 16, v26
 v_and_b32 v153, 0xffff0000, v26
 v_mul_f32 v152, v152, v30
 v_mul_f32 v153, v153, v30
 v_cvt_pk_bf16_f32 v26, v152, v153
 v_lshlrev_b32 v152, 16, v26
 v_and_b32 v153, 0xffff0000, v26
 v_add_f32 v152, v152, v72
 v_add_f32 v153, v153, v73
 v_cvt_pk_bf16_f32 v72, v152, v153
 v_cvt_pk_bf16_f32 v26, v154, v155
 v_lshlrev_b32 v154, 16, v26
 v_and_b32 v155, 0xffff0000, v26
 v_mul_f32 v154, v154, v30
 v_mul_f32 v155, v155, v30
 v_cvt_pk_bf16_f32 v26, v154, v155
 v_lshlrev_b32 v154, 16, v26
 v_and_b32 v155, 0xffff0000, v26
 v_add_f32 v154, v154, v74
 v_add_f32 v155, v155, v75
 v_cvt_pk_bf16_f32 v73, v154, v155
 buffer_store_dwordx2 v[72:73], v9, s[8:11], s22 offen offset:64
 s_waitcnt vmcnt(19)
 v_cvt_pk_bf16_f32 v26, v156, v157
 v_lshlrev_b32 v156, 16, v26
 v_and_b32 v157, 0xffff0000, v26
 v_mul_f32 v156, v156, v30
 v_mul_f32 v157, v157, v30
 v_cvt_pk_bf16_f32 v26, v156, v157
 v_lshlrev_b32 v156, 16, v26
 v_and_b32 v157, 0xffff0000, v26
 v_add_f32 v156, v156, v76
 v_add_f32 v157, v157, v77
 v_cvt_pk_bf16_f32 v76, v156, v157
 v_cvt_pk_bf16_f32 v26, v158, v159
 v_lshlrev_b32 v158, 16, v26
 v_and_b32 v159, 0xffff0000, v26
 v_mul_f32 v158, v158, v30
 v_mul_f32 v159, v159, v30
 v_cvt_pk_bf16_f32 v26, v158, v159
 v_lshlrev_b32 v158, 16, v26
 v_and_b32 v159, 0xffff0000, v26
 v_add_f32 v158, v158, v78
 v_add_f32 v159, v159, v79
 v_cvt_pk_bf16_f32 v77, v158, v159
 buffer_store_dwordx2 v[76:77], v9, s[8:11], s22 offen offset:96
 s_waitcnt vmcnt(19)
 v_cvt_pk_bf16_f32 v26, v160, v161
 v_lshlrev_b32 v160, 16, v26
 v_and_b32 v161, 0xffff0000, v26
 v_mul_f32 v160, v160, v30
 v_mul_f32 v161, v161, v30
 v_cvt_pk_bf16_f32 v26, v160, v161
 v_lshlrev_b32 v160, 16, v26
 v_and_b32 v161, 0xffff0000, v26
 v_add_f32 v160, v160, v80
 v_add_f32 v161, v161, v81
 v_cvt_pk_bf16_f32 v80, v160, v161
 v_cvt_pk_bf16_f32 v26, v162, v163
 v_lshlrev_b32 v162, 16, v26
 v_and_b32 v163, 0xffff0000, v26
 v_mul_f32 v162, v162, v30
 v_mul_f32 v163, v163, v30
 v_cvt_pk_bf16_f32 v26, v162, v163
 v_lshlrev_b32 v162, 16, v26
 v_and_b32 v163, 0xffff0000, v26
 v_add_f32 v162, v162, v82
 v_add_f32 v163, v163, v83
 v_cvt_pk_bf16_f32 v81, v162, v163
 buffer_store_dwordx2 v[80:81], v9, s[8:11], s22 offen offset:128
 s_waitcnt vmcnt(19)
 v_cvt_pk_bf16_f32 v26, v164, v165
 v_lshlrev_b32 v164, 16, v26
 v_and_b32 v165, 0xffff0000, v26
 v_mul_f32 v164, v164, v30
 v_mul_f32 v165, v165, v30
 v_cvt_pk_bf16_f32 v26, v164, v165
 v_lshlrev_b32 v164, 16, v26
 v_and_b32 v165, 0xffff0000, v26
 v_add_f32 v164, v164, v84
 v_add_f32 v165, v165, v85
 v_cvt_pk_bf16_f32 v84, v164, v165
 v_cvt_pk_bf16_f32 v26, v166, v167
 v_lshlrev_b32 v166, 16, v26
 v_and_b32 v167, 0xffff0000, v26
 v_mul_f32 v166, v166, v30
 v_mul_f32 v167, v167, v30
 v_cvt_pk_bf16_f32 v26, v166, v167
 v_lshlrev_b32 v166, 16, v26
 v_and_b32 v167, 0xffff0000, v26
 v_add_f32 v166, v166, v86
 v_add_f32 v167, v167, v87
 v_cvt_pk_bf16_f32 v85, v166, v167
 buffer_store_dwordx2 v[84:85], v9, s[8:11], s22 offen offset:160
 s_waitcnt vmcnt(19)
 v_cvt_pk_bf16_f32 v26, v168, v169
 v_lshlrev_b32 v168, 16, v26
 v_and_b32 v169, 0xffff0000, v26
 v_mul_f32 v168, v168, v30
 v_mul_f32 v169, v169, v30
 v_cvt_pk_bf16_f32 v26, v168, v169
 v_lshlrev_b32 v168, 16, v26
 v_and_b32 v169, 0xffff0000, v26
 v_add_f32 v168, v168, v88
 v_add_f32 v169, v169, v89
 v_cvt_pk_bf16_f32 v88, v168, v169
 v_cvt_pk_bf16_f32 v26, v170, v171
 v_lshlrev_b32 v170, 16, v26
 v_and_b32 v171, 0xffff0000, v26
 v_mul_f32 v170, v170, v30
 v_mul_f32 v171, v171, v30
 v_cvt_pk_bf16_f32 v26, v170, v171
 v_lshlrev_b32 v170, 16, v26
 v_and_b32 v171, 0xffff0000, v26
 v_add_f32 v170, v170, v90
 v_add_f32 v171, v171, v91
 v_cvt_pk_bf16_f32 v89, v170, v171
 buffer_store_dwordx2 v[88:89], v9, s[8:11], s22 offen offset:192
 s_waitcnt vmcnt(19)
 v_cvt_pk_bf16_f32 v26, v172, v173
 v_lshlrev_b32 v172, 16, v26
 v_and_b32 v173, 0xffff0000, v26
 v_mul_f32 v172, v172, v30
 v_mul_f32 v173, v173, v30
 v_cvt_pk_bf16_f32 v26, v172, v173
 v_lshlrev_b32 v172, 16, v26
 v_and_b32 v173, 0xffff0000, v26
 v_add_f32 v172, v172, v92
 v_add_f32 v173, v173, v93
 v_cvt_pk_bf16_f32 v92, v172, v173
 v_cvt_pk_bf16_f32 v26, v174, v175
 v_lshlrev_b32 v174, 16, v26
 v_and_b32 v175, 0xffff0000, v26
 v_mul_f32 v174, v174, v30
 v_mul_f32 v175, v175, v30
 v_cvt_pk_bf16_f32 v26, v174, v175
 v_lshlrev_b32 v174, 16, v26
 v_and_b32 v175, 0xffff0000, v26
 v_add_f32 v174, v174, v94
 v_add_f32 v175, v175, v95
 v_cvt_pk_bf16_f32 v93, v174, v175
 buffer_store_dwordx2 v[92:93], v9, s[8:11], s22 offen offset:224
 s_waitcnt vmcnt(19)
 v_cvt_pk_bf16_f32 v26, v176, v177
 v_lshlrev_b32 v176, 16, v26
 v_and_b32 v177, 0xffff0000, v26
 v_mul_f32 v176, v176, v30
 v_mul_f32 v177, v177, v30
 v_cvt_pk_bf16_f32 v26, v176, v177
 v_lshlrev_b32 v176, 16, v26
 v_and_b32 v177, 0xffff0000, v26
 v_add_f32 v176, v176, v96
 v_add_f32 v177, v177, v97
 v_cvt_pk_bf16_f32 v96, v176, v177
 v_cvt_pk_bf16_f32 v26, v178, v179
 v_lshlrev_b32 v178, 16, v26
 v_and_b32 v179, 0xffff0000, v26
 v_mul_f32 v178, v178, v30
 v_mul_f32 v179, v179, v30
 v_cvt_pk_bf16_f32 v26, v178, v179
 v_lshlrev_b32 v178, 16, v26
 v_and_b32 v179, 0xffff0000, v26
 v_add_f32 v178, v178, v98
 v_add_f32 v179, v179, v99
 v_cvt_pk_bf16_f32 v97, v178, v179
 buffer_store_dwordx2 v[96:97], v9, s[8:11], s22 offen offset:256
 s_waitcnt vmcnt(19)
 v_cvt_pk_bf16_f32 v26, v180, v181
 v_lshlrev_b32 v180, 16, v26
 v_and_b32 v181, 0xffff0000, v26
 v_mul_f32 v180, v180, v30
 v_mul_f32 v181, v181, v30
 v_cvt_pk_bf16_f32 v26, v180, v181
 v_lshlrev_b32 v180, 16, v26
 v_and_b32 v181, 0xffff0000, v26
 v_add_f32 v180, v180, v100
 v_add_f32 v181, v181, v101
 v_cvt_pk_bf16_f32 v100, v180, v181
 v_cvt_pk_bf16_f32 v26, v182, v183
 v_lshlrev_b32 v182, 16, v26
 v_and_b32 v183, 0xffff0000, v26
 v_mul_f32 v182, v182, v30
 v_mul_f32 v183, v183, v30
 v_cvt_pk_bf16_f32 v26, v182, v183
 v_lshlrev_b32 v182, 16, v26
 v_and_b32 v183, 0xffff0000, v26
 v_add_f32 v182, v182, v102
 v_add_f32 v183, v183, v103
 v_cvt_pk_bf16_f32 v101, v182, v183
 buffer_store_dwordx2 v[100:101], v9, s[8:11], s22 offen offset:288
 s_waitcnt vmcnt(19)
 v_cvt_pk_bf16_f32 v26, v184, v185
 v_lshlrev_b32 v184, 16, v26
 v_and_b32 v185, 0xffff0000, v26
 v_mul_f32 v184, v184, v31
 v_mul_f32 v185, v185, v31
 v_cvt_pk_bf16_f32 v26, v184, v185
 v_lshlrev_b32 v184, 16, v26
 v_and_b32 v185, 0xffff0000, v26
 v_add_f32 v184, v184, v104
 v_add_f32 v185, v185, v105
 v_cvt_pk_bf16_f32 v104, v184, v185
 v_cvt_pk_bf16_f32 v26, v186, v187
 v_lshlrev_b32 v186, 16, v26
 v_and_b32 v187, 0xffff0000, v26
 v_mul_f32 v186, v186, v31
 v_mul_f32 v187, v187, v31
 v_cvt_pk_bf16_f32 v26, v186, v187
 v_lshlrev_b32 v186, 16, v26
 v_and_b32 v187, 0xffff0000, v26
 v_add_f32 v186, v186, v106
 v_add_f32 v187, v187, v107
 v_cvt_pk_bf16_f32 v105, v186, v187
 buffer_store_dwordx2 v[104:105], v9, s[8:11], s23 offen offset:0
 s_waitcnt vmcnt(19)
 v_cvt_pk_bf16_f32 v26, v188, v189
 v_lshlrev_b32 v188, 16, v26
 v_and_b32 v189, 0xffff0000, v26
 v_mul_f32 v188, v188, v31
 v_mul_f32 v189, v189, v31
 v_cvt_pk_bf16_f32 v26, v188, v189
 v_lshlrev_b32 v188, 16, v26
 v_and_b32 v189, 0xffff0000, v26
 v_add_f32 v188, v188, v108
 v_add_f32 v189, v189, v109
 v_cvt_pk_bf16_f32 v108, v188, v189
 v_cvt_pk_bf16_f32 v26, v190, v191
 v_lshlrev_b32 v190, 16, v26
 v_and_b32 v191, 0xffff0000, v26
 v_mul_f32 v190, v190, v31
 v_mul_f32 v191, v191, v31
 v_cvt_pk_bf16_f32 v26, v190, v191
 v_lshlrev_b32 v190, 16, v26
 v_and_b32 v191, 0xffff0000, v26
 v_add_f32 v190, v190, v110
 v_add_f32 v191, v191, v111
 v_cvt_pk_bf16_f32 v109, v190, v191
 buffer_store_dwordx2 v[108:109], v9, s[8:11], s23 offen offset:32
 s_waitcnt vmcnt(19)
 v_cvt_pk_bf16_f32 v26, v192, v193
 v_lshlrev_b32 v192, 16, v26
 v_and_b32 v193, 0xffff0000, v26
 v_mul_f32 v192, v192, v31
 v_mul_f32 v193, v193, v31
 v_cvt_pk_bf16_f32 v26, v192, v193
 v_lshlrev_b32 v192, 16, v26
 v_and_b32 v193, 0xffff0000, v26
 v_add_f32 v192, v192, v112
 v_add_f32 v193, v193, v113
 v_cvt_pk_bf16_f32 v112, v192, v193
 v_cvt_pk_bf16_f32 v26, v194, v195
 v_lshlrev_b32 v194, 16, v26
 v_and_b32 v195, 0xffff0000, v26
 v_mul_f32 v194, v194, v31
 v_mul_f32 v195, v195, v31
 v_cvt_pk_bf16_f32 v26, v194, v195
 v_lshlrev_b32 v194, 16, v26
 v_and_b32 v195, 0xffff0000, v26
 v_add_f32 v194, v194, v114
 v_add_f32 v195, v195, v115
 v_cvt_pk_bf16_f32 v113, v194, v195
 buffer_store_dwordx2 v[112:113], v9, s[8:11], s23 offen offset:64
 s_waitcnt vmcnt(19)
 v_cvt_pk_bf16_f32 v26, v196, v197
 v_lshlrev_b32 v196, 16, v26
 v_and_b32 v197, 0xffff0000, v26
 v_mul_f32 v196, v196, v31
 v_mul_f32 v197, v197, v31
 v_cvt_pk_bf16_f32 v26, v196, v197
 v_lshlrev_b32 v196, 16, v26
 v_and_b32 v197, 0xffff0000, v26
 v_add_f32 v196, v196, v116
 v_add_f32 v197, v197, v117
 v_cvt_pk_bf16_f32 v116, v196, v197
 v_cvt_pk_bf16_f32 v26, v198, v199
 v_lshlrev_b32 v198, 16, v26
 v_and_b32 v199, 0xffff0000, v26
 v_mul_f32 v198, v198, v31
 v_mul_f32 v199, v199, v31
 v_cvt_pk_bf16_f32 v26, v198, v199
 v_lshlrev_b32 v198, 16, v26
 v_and_b32 v199, 0xffff0000, v26
 v_add_f32 v198, v198, v118
 v_add_f32 v199, v199, v119
 v_cvt_pk_bf16_f32 v117, v198, v199
 buffer_store_dwordx2 v[116:117], v9, s[8:11], s23 offen offset:96
 s_waitcnt vmcnt(19)
 v_cvt_pk_bf16_f32 v26, v200, v201
 v_lshlrev_b32 v200, 16, v26
 v_and_b32 v201, 0xffff0000, v26
 v_mul_f32 v200, v200, v31
 v_mul_f32 v201, v201, v31
 v_cvt_pk_bf16_f32 v26, v200, v201
 v_lshlrev_b32 v200, 16, v26
 v_and_b32 v201, 0xffff0000, v26
 v_add_f32 v200, v200, v120
 v_add_f32 v201, v201, v121
 v_cvt_pk_bf16_f32 v120, v200, v201
 v_cvt_pk_bf16_f32 v26, v202, v203
 v_lshlrev_b32 v202, 16, v26
 v_and_b32 v203, 0xffff0000, v26
 v_mul_f32 v202, v202, v31
 v_mul_f32 v203, v203, v31
 v_cvt_pk_bf16_f32 v26, v202, v203
 v_lshlrev_b32 v202, 16, v26
 v_and_b32 v203, 0xffff0000, v26
 v_add_f32 v202, v202, v122
 v_add_f32 v203, v203, v123
 v_cvt_pk_bf16_f32 v121, v202, v203
 buffer_store_dwordx2 v[120:121], v9, s[8:11], s23 offen offset:128
 s_waitcnt vmcnt(19)
 v_cvt_pk_bf16_f32 v26, v204, v205
 v_lshlrev_b32 v204, 16, v26
 v_and_b32 v205, 0xffff0000, v26
 v_mul_f32 v204, v204, v31
 v_mul_f32 v205, v205, v31
 v_cvt_pk_bf16_f32 v26, v204, v205
 v_lshlrev_b32 v204, 16, v26
 v_and_b32 v205, 0xffff0000, v26
 v_add_f32 v204, v204, v124
 v_add_f32 v205, v205, v125
 v_cvt_pk_bf16_f32 v124, v204, v205
 v_cvt_pk_bf16_f32 v26, v206, v207
 v_lshlrev_b32 v206, 16, v26
 v_and_b32 v207, 0xffff0000, v26
 v_mul_f32 v206, v206, v31
 v_mul_f32 v207, v207, v31
 v_cvt_pk_bf16_f32 v26, v206, v207
 v_lshlrev_b32 v206, 16, v26
 v_and_b32 v207, 0xffff0000, v26
 v_add_f32 v206, v206, v126
 v_add_f32 v207, v207, v127
 v_cvt_pk_bf16_f32 v125, v206, v207
 buffer_store_dwordx2 v[124:125], v9, s[8:11], s23 offen offset:160
 s_waitcnt vmcnt(19)
 v_cvt_pk_bf16_f32 v26, v208, v209
 v_lshlrev_b32 v208, 16, v26
 v_and_b32 v209, 0xffff0000, v26
 v_mul_f32 v208, v208, v31
 v_mul_f32 v209, v209, v31
 v_cvt_pk_bf16_f32 v26, v208, v209
 v_lshlrev_b32 v208, 16, v26
 v_and_b32 v209, 0xffff0000, v26
 v_add_f32 v208, v208, v128
 v_add_f32 v209, v209, v129
 v_cvt_pk_bf16_f32 v128, v208, v209
 v_cvt_pk_bf16_f32 v26, v210, v211
 v_lshlrev_b32 v210, 16, v26
 v_and_b32 v211, 0xffff0000, v26
 v_mul_f32 v210, v210, v31
 v_mul_f32 v211, v211, v31
 v_cvt_pk_bf16_f32 v26, v210, v211
 v_lshlrev_b32 v210, 16, v26
 v_and_b32 v211, 0xffff0000, v26
 v_add_f32 v210, v210, v130
 v_add_f32 v211, v211, v131
 v_cvt_pk_bf16_f32 v129, v210, v211
 buffer_store_dwordx2 v[128:129], v9, s[8:11], s23 offen offset:192
 s_waitcnt vmcnt(19)
 v_cvt_pk_bf16_f32 v26, v212, v213
 v_lshlrev_b32 v212, 16, v26
 v_and_b32 v213, 0xffff0000, v26
 v_mul_f32 v212, v212, v31
 v_mul_f32 v213, v213, v31
 v_cvt_pk_bf16_f32 v26, v212, v213
 v_lshlrev_b32 v212, 16, v26
 v_and_b32 v213, 0xffff0000, v26
 v_add_f32 v212, v212, v132
 v_add_f32 v213, v213, v133
 v_cvt_pk_bf16_f32 v132, v212, v213
 v_cvt_pk_bf16_f32 v26, v214, v215
 v_lshlrev_b32 v214, 16, v26
 v_and_b32 v215, 0xffff0000, v26
 v_mul_f32 v214, v214, v31
 v_mul_f32 v215, v215, v31
 v_cvt_pk_bf16_f32 v26, v214, v215
 v_lshlrev_b32 v214, 16, v26
 v_and_b32 v215, 0xffff0000, v26
 v_add_f32 v214, v214, v134
 v_add_f32 v215, v215, v135
 v_cvt_pk_bf16_f32 v133, v214, v215
 buffer_store_dwordx2 v[132:133], v9, s[8:11], s23 offen offset:224
 s_waitcnt vmcnt(19)
 v_cvt_pk_bf16_f32 v26, v216, v217
 v_lshlrev_b32 v216, 16, v26
 v_and_b32 v217, 0xffff0000, v26
 v_mul_f32 v216, v216, v31
 v_mul_f32 v217, v217, v31
 v_cvt_pk_bf16_f32 v26, v216, v217
 v_lshlrev_b32 v216, 16, v26
 v_and_b32 v217, 0xffff0000, v26
 v_add_f32 v216, v216, v136
 v_add_f32 v217, v217, v137
 v_cvt_pk_bf16_f32 v136, v216, v217
 v_cvt_pk_bf16_f32 v26, v218, v219
 v_lshlrev_b32 v218, 16, v26
 v_and_b32 v219, 0xffff0000, v26
 v_mul_f32 v218, v218, v31
 v_mul_f32 v219, v219, v31
 v_cvt_pk_bf16_f32 v26, v218, v219
 v_lshlrev_b32 v218, 16, v26
 v_and_b32 v219, 0xffff0000, v26
 v_add_f32 v218, v218, v138
 v_add_f32 v219, v219, v139
 v_cvt_pk_bf16_f32 v137, v218, v219
 buffer_store_dwordx2 v[136:137], v9, s[8:11], s23 offen offset:256
 s_waitcnt vmcnt(19)
 v_cvt_pk_bf16_f32 v26, v220, v221
 v_lshlrev_b32 v220, 16, v26
 v_and_b32 v221, 0xffff0000, v26
 v_mul_f32 v220, v220, v31
 v_mul_f32 v221, v221, v31
 v_cvt_pk_bf16_f32 v26, v220, v221
 v_lshlrev_b32 v220, 16, v26
 v_and_b32 v221, 0xffff0000, v26
 v_add_f32 v220, v220, v140
 v_add_f32 v221, v221, v141
 v_cvt_pk_bf16_f32 v140, v220, v221
 v_cvt_pk_bf16_f32 v26, v222, v223
 v_lshlrev_b32 v222, 16, v26
 v_and_b32 v223, 0xffff0000, v26
 v_mul_f32 v222, v222, v31
 v_mul_f32 v223, v223, v31
 v_cvt_pk_bf16_f32 v26, v222, v223
 v_lshlrev_b32 v222, 16, v26
 v_and_b32 v223, 0xffff0000, v26
 v_add_f32 v222, v222, v142
 v_add_f32 v223, v223, v143
 v_cvt_pk_bf16_f32 v141, v222, v223
 buffer_store_dwordx2 v[140:141], v9, s[8:11], s23 offen offset:288
om_244:
 s_cmp_eq_u32 s87, -2
 s_cbranch_scc1 kv_help
 s_cmp_eq_u32 s87, -1
 s_cbranch_scc1 queue
tail_item:
 s_load_dwordx2 s[4:5], s[0:1], 96
 s_waitcnt lgkmcnt(0)
 s_mov_b32 s32, s4
 s_mov_b32 s33, s5
 s_mov_b32 s34, 256
 s_mov_b32 s35, 0x00020000
 s_waitcnt vmcnt(0)
 s_barrier
 s_mov_b32 s21, s87
do_pv:
 s_mov_b32 s2, s21
 s_load_dwordx2 s[4:5], s[0:1], 88
 s_load_dwordx2 s[38:39], s[0:1], 104
 s_waitcnt lgkmcnt(0)
 s_mov_b32 s8, s4
 s_mov_b32 s9, s5
 s_mov_b32 s10, 2621440
 s_mov_b32 s11, 0x00020000
 s_add_u32 s12, s38, 88080384
 s_addc_u32 s13, s39, 0
 s_mov_b32 s14, 83886080
 s_mov_b32 s15, 0x00020000
 s_mov_b32 s59, 0
 s_mov_b32 s60, 0
 s_add_u32 s16, s38, 180355072
 s_addc_u32 s17, s39, 0
 s_mov_b32 s18, 67108864
 s_mov_b32 s19, 0x00020000
 s_add_u32 s24, s38, 180355072
 s_addc_u32 s25, s39, 0
 s_mov_b32 s26, 67108864
 s_mov_b32 s27, 0x00020000
 s_add_u32 s28, s38, 81002496
 s_addc_u32 s29, s39, 0
 s_mov_b32 s30, 8192
 s_mov_b32 s31, 0x00020000
 s_add_u32 s72, s38, 81068032
 s_addc_u32 s73, s39, 0
 s_mov_b32 s74, 129024
 s_mov_b32 s75, 0x00020000
 v_lshlrev_b32 v4, 4, v1
 v_lshlrev_b32 v5, 3, v1
 v_lshlrev_b32 v6, 2, v2
 v_and_b32 v7, 7, v1
 v_lshlrev_b32 v7, 7, v7
 v_lshrrev_b32 v31, 3, v1
 v_lshl_add_u32 v208, v31, 10, v7
 v_bfe_u32 v31, v1, 3, 2
 v_lshl_add_u32 v31, v31, 12, v7
 s_lshl_b32 s21, s20, 10
 s_add_u32 s21, s21, 95232
 buffer_load_dword v8, v31, s[72:75], s21 offen sc1
 v_lshlrev_b32 v25, 7, v2
 s_mov_b32 s21, 93184
 buffer_load_dword v26, v25, s[72:75], s21 offen sc1
 s_mov_b32 s63, 1
 v_mul_u32_u24 v9, 1280, v2
 v_lshl_add_u32 v9, v3, 3, v9
 s_lshl_b32 s21, s20, 13
 v_add_u32 v10, s21, v4
 s_lshl_b32 s21, s20, 10
 v_add_u32 v11, s21, v4
 v_lshrrev_b32 v20, 5, v1
 v_mul_u32_u24 v21, 2560, v20
 v_add_u32 v21, v21, v4
 v_and_b32 v22, 31, v1
 v_lshlrev_b32 v22, 4, v22
 v_mul_u32_u24 v20, 10240, v20
 v_add_u32 v22, v22, v20
 v_mul_u32_u24 v21, 2048, v3
 v_lshl_add_u32 v21, v2, 4, v21
 v_mul_u32_u24 v22, 1024, v3
 v_lshl_add_u32 v22, v2, 4, v22
 v_mov_b32 v28, 80
 v_mov_b32 v30, 32768
 s_mov_b32 s50, 0
 s_mov_b32 s71, 0
 s_mov_b32 s51, 0
 s_and_b32 s43, s20, 1
 s_lshr_b32 s44, s20, 1
 v_mov_b32 v70, 0
 v_mov_b32 v71, 0
 v_mov_b32 v78, 0
 v_mov_b32 v79, 0
 v_mov_b32 v86, 0
 v_mov_b32 v87, 0
 v_mov_b32 v94, 0
 v_mov_b32 v95, 0
 v_mov_b32 v102, 0
 v_mov_b32 v103, 0
 v_mov_b32 v110, 0
 v_mov_b32 v111, 0
 v_mov_b32 v118, 0
 v_mov_b32 v119, 0
 v_mov_b32 v126, 0
 v_mov_b32 v127, 0
 s_mov_b32 s21, s2
pv_loop:
 s_mul_i32 s2, s21, 2
 s_add_u32 s2, s2, 192
 s_add_u32 s22, s21, 356
 s_cmp_lt_u32 s21, 164
 s_cselect_b32 s2, s2, s22
 s_cselect_b32 s65, 1, 0
 s_mul_i32 s22, s21, 5
 s_cmp_lt_u32 s21, 64
 s_cselect_b32 s2, s22, s2
 s_cselect_b32 s65, 4, s65
 s_mul_hi_u32 s40, s2, 0x1999999a
 s_mul_i32 s21, s40, 10
 s_sub_u32 s41, s2, s21
 s_lshl_b32 s52, s40, 10
 s_add_u32 s52, s52, 23552
 buffer_load_dword v27, v7, s[72:75], s52 offen sc1
 s_cmp_lg_u32 s20, 0
 s_cbranch_scc1 pv_258
 s_sub_u32 s21, s2, 0
 s_cmp_lt_u32 s21, 640
 s_cbranch_scc1 pv_258
 v_mov_b32 v29, 1
 s_mov_b64 exec, 1
 buffer_atomic_add v29, v28, s[32:35], 0 offen sc0 sc1
 s_mov_b64 exec, -1
pv_258:
 s_lshl_b32 s42, s40, 5
 s_lshl_b32 s21, s20, 3
 s_add_u32 s42, s42, s21
 s_lshl_b32 s22, s40, 12
 s_and_b32 s22, s22, 8192
 s_xor_b32 s22, s22, s37
 s_lshl_b32 s62, s40, 20
 s_or_b32 s62, s62, s22
 s_cmp_ge_u32 s40, 36
 s_cselect_b32 s61, 8192, 0
 s_xor_b32 s61, s61, s62
 s_mul_i32 s53, s42, 40960
 s_lshl_b32 s22, s41, 12
 s_add_u32 s53, s53, s22
 s_lshl_b32 s21, s40, 1
 s_add_u32 s21, s21, s43
 s_lshl_b32 s45, s21, 6
 s_mul_i32 s46, s21, 20480
 s_lshl_b32 s21, s41, 4
 s_lshl_b32 s22, s43, 2
 s_add_u32 s21, s21, s22
 s_add_u32 s21, s21, s44
 s_lshl_b32 s54, s21, 10
 s_add_u32 s54, s54, s62
 s_add_u32 s54, s54, 786432
 s_lshl_b32 s22, s41, 2
 s_add_u32 s22, s22, s44
 s_lshl_b32 s22, s22, 5
 s_add_u32 s46, s46, s22
 s_lshl_b32 s47, s20, 15
 s_add_u32 s47, s47, s62
 s_add_u32 s47, s47, 655360
 s_lshl_b32 s48, s41, 16
 s_lshl_b32 s22, s20, 14
 s_add_u32 s48, s48, s22
 s_add_u32 s48, s48, s61
 s_add_u32 s23, s40, 1
 s_cmp_ge_u32 s50, s23
 s_cbranch_scc1 pv_251
 s_cmp_eq_u32 s63, 0
 s_cbranch_scc1 pv_254
 s_mov_b32 s63, 0
 s_waitcnt vmcnt(1)
 v_cmp_le_u32 vcc, 4, v26
 s_mov_b32 s51, vcc_lo
 v_cmp_gt_u32 vcc, s23, v8
 s_nop 1
 s_cbranch_vccz pv_255
pv_254:
 s_lshl_b32 s21, s20, 10
 s_add_u32 s21, s21, 95232
 s_mov_b32 s101, 0
wm_259:
 buffer_load_dword v8, v31, s[72:75], s21 offen sc1
 s_add_u32 s101, s101, 1
 s_cmp_gt_u32 s101, 131072
 s_cbranch_scc1 main_end
 s_waitcnt vmcnt(0)
 v_cmp_gt_u32 vcc, s23, v8
 v_readfirstlane_b32 s100, v8
 s_nop 0
 s_cbranch_vccz wm_260
 s_sleep 8
 s_add_u32 s100, s100, 2
 s_cmp_ge_u32 s100, s23
 s_cbranch_scc1 wm_259
 s_sleep 60
 s_branch wm_259
wm_260:
pv_255:
 v_readlane_b32 s50, v8, 0
 v_readlane_b32 s21, v8, 1
 s_min_u32 s50, s50, s21
 v_readlane_b32 s21, v8, 2
 s_min_u32 s50, s50, s21
 v_readlane_b32 s21, v8, 3
 s_min_u32 s50, s50, s21
 v_readlane_b32 s21, v8, 4
 s_min_u32 s50, s50, s21
 v_readlane_b32 s21, v8, 5
 s_min_u32 s50, s50, s21
 v_readlane_b32 s21, v8, 6
 s_min_u32 s50, s50, s21
 v_readlane_b32 s21, v8, 7
 s_min_u32 s50, s50, s21
 v_readlane_b32 s21, v8, 8
 s_min_u32 s50, s50, s21
 v_readlane_b32 s21, v8, 9
 s_min_u32 s50, s50, s21
 v_readlane_b32 s21, v8, 10
 s_min_u32 s50, s50, s21
 v_readlane_b32 s21, v8, 11
 s_min_u32 s50, s50, s21
 v_readlane_b32 s21, v8, 12
 s_min_u32 s50, s50, s21
 v_readlane_b32 s21, v8, 13
 s_min_u32 s50, s50, s21
 v_readlane_b32 s21, v8, 14
 s_min_u32 s50, s50, s21
 v_readlane_b32 s21, v8, 15
 s_min_u32 s50, s50, s21
 v_readlane_b32 s21, v8, 16
 s_min_u32 s50, s50, s21
 v_readlane_b32 s21, v8, 17
 s_min_u32 s50, s50, s21
 v_readlane_b32 s21, v8, 18
 s_min_u32 s50, s50, s21
 v_readlane_b32 s21, v8, 19
 s_min_u32 s50, s50, s21
 v_readlane_b32 s21, v8, 20
 s_min_u32 s50, s50, s21
 v_readlane_b32 s21, v8, 21
 s_min_u32 s50, s50, s21
 v_readlane_b32 s21, v8, 22
 s_min_u32 s50, s50, s21
 v_readlane_b32 s21, v8, 23
 s_min_u32 s50, s50, s21
 v_readlane_b32 s21, v8, 24
 s_min_u32 s50, s50, s21
 v_readlane_b32 s21, v8, 25
 s_min_u32 s50, s50, s21
 v_readlane_b32 s21, v8, 26
 s_min_u32 s50, s50, s21
 v_readlane_b32 s21, v8, 27
 s_min_u32 s50, s50, s21
 v_readlane_b32 s21, v8, 28
 s_min_u32 s50, s50, s21
 v_readlane_b32 s21, v8, 29
 s_min_u32 s50, s50, s21
 v_readlane_b32 s21, v8, 30
 s_min_u32 s50, s50, s21
 v_readlane_b32 s21, v8, 31
 s_min_u32 s50, s50, s21
pv_251:
 s_lshr_b32 s22, s40, 2
 s_cmp_lt_u32 s40, 32
 s_cbranch_scc1 pv_252
 s_bitcmp1_b32 s51, s22
 s_cbranch_scc1 pv_252
 s_mov_b32 s21, 93184
 v_lshlrev_b32 v25, 7, v2
 s_mov_b32 s101, 0
pv_253:
 buffer_load_dword v26, v25, s[72:75], s21 offen sc1
 s_add_u32 s101, s101, 1
 s_cmp_gt_u32 s101, 131072
 s_cbranch_scc1 main_end
 s_waitcnt vmcnt(0)
 v_cmp_le_u32 vcc, 4, v26
 s_mov_b32 s51, vcc_lo
 s_bitcmp1_b32 s51, s22
 s_cbranch_scc1 pv_252
 s_sleep 8
 s_branch pv_253
pv_252:
 buffer_load_dwordx4 a[0:3], v4, s[12:15], s53 offen offset:0 sc1
 buffer_load_dwordx4 a[4:7], v4, s[12:15], s53 offen offset:1024 sc1
 buffer_load_dwordx4 a[8:11], v4, s[12:15], s53 offen offset:2048 sc1
 buffer_load_dwordx4 a[12:15], v4, s[12:15], s53 offen offset:3072 sc1
 s_add_u32 s53, s53, 40960
 buffer_load_dwordx4 a[16:19], v4, s[12:15], s53 offen offset:0 sc1
 buffer_load_dwordx4 a[20:23], v4, s[12:15], s53 offen offset:1024 sc1
 buffer_load_dwordx4 a[24:27], v4, s[12:15], s53 offen offset:2048 sc1
 buffer_load_dwordx4 a[28:31], v4, s[12:15], s53 offen offset:3072 sc1
 s_add_u32 s53, s53, 40960
 buffer_load_dwordx4 a[32:35], v4, s[12:15], s53 offen offset:0 sc1
 buffer_load_dwordx4 a[36:39], v4, s[12:15], s53 offen offset:1024 sc1
 buffer_load_dwordx4 a[40:43], v4, s[12:15], s53 offen offset:2048 sc1
 buffer_load_dwordx4 a[44:47], v4, s[12:15], s53 offen offset:3072 sc1
 s_add_u32 s53, s53, 40960
 buffer_load_dwordx4 a[48:51], v4, s[12:15], s53 offen offset:0 sc1
 buffer_load_dwordx4 a[52:55], v4, s[12:15], s53 offen offset:1024 sc1
 buffer_load_dwordx4 a[56:59], v4, s[12:15], s53 offen offset:2048 sc1
 buffer_load_dwordx4 a[60:63], v4, s[12:15], s53 offen offset:3072 sc1
 s_add_u32 s53, s53, 40960
 buffer_load_dwordx4 a[64:67], v4, s[12:15], s53 offen offset:0 sc1
 buffer_load_dwordx4 a[68:71], v4, s[12:15], s53 offen offset:1024 sc1
 buffer_load_dwordx4 a[72:75], v4, s[12:15], s53 offen offset:2048 sc1
 buffer_load_dwordx4 a[76:79], v4, s[12:15], s53 offen offset:3072 sc1
 s_add_u32 s53, s53, 40960
 buffer_load_dwordx4 a[80:83], v4, s[12:15], s53 offen offset:0 sc1
 buffer_load_dwordx4 a[84:87], v4, s[12:15], s53 offen offset:1024 sc1
 buffer_load_dwordx4 a[88:91], v4, s[12:15], s53 offen offset:2048 sc1
 buffer_load_dwordx4 a[92:95], v4, s[12:15], s53 offen offset:3072 sc1
 s_add_u32 s53, s53, 40960
 buffer_load_dwordx4 a[96:99], v4, s[12:15], s53 offen offset:0 sc1
 buffer_load_dwordx4 a[100:103], v4, s[12:15], s53 offen offset:1024 sc1
 buffer_load_dwordx4 a[104:107], v4, s[12:15], s53 offen offset:2048 sc1
 buffer_load_dwordx4 a[108:111], v4, s[12:15], s53 offen offset:3072 sc1
 s_add_u32 s53, s53, 40960
 buffer_load_dwordx4 a[112:115], v4, s[12:15], s53 offen offset:0 sc1
 buffer_load_dwordx4 a[116:119], v4, s[12:15], s53 offen offset:1024 sc1
 buffer_load_dwordx4 a[120:123], v4, s[12:15], s53 offen offset:2048 sc1
 buffer_load_dwordx4 a[124:127], v4, s[12:15], s53 offen offset:3072 sc1
 s_cmp_lt_u32 s40, 32
 s_cselect_b32 s70, 0x80000000, s54
 buffer_load_dwordx4 v[12:15], v4, s[24:27], s70 offen sc1
 buffer_load_dwordx4 v[16:19], v4, s[24:27], s70 offen offset:2048 sc1
 buffer_load_dword v24, v6, s[28:31], s45 offen sc1
 s_waitcnt vmcnt(35)
 s_cmp_eq_u32 s71, 0
 s_cbranch_scc1 paf_263
 v_mov_b32 v25, 0
 v_mov_b32 v26, 1
 s_mov_b64 exec, 1
 buffer_atomic_add v26, v25, s[72:75], s71 offen sc1
 s_mov_b64 exec, -1
 s_mov_b32 s71, 0
paf_263:
 v_cmp_le_u32 s[68:69], 4, v27
 s_nop 1
 s_and_b32 s21, s68, 255
 s_cmp_lg_u32 s21, 255
 s_cbranch_scc1 pvw_256
 s_mov_b32 s56, s47
 s_mov_b32 s57, s48
 buffer_load_dwordx4 v[64:67], v4, s[16:19], s56 offen sc1
 buffer_load_dwordx2 v[68:69], v5, s[16:19], s56 offen offset:1536 sc1
 buffer_load_dwordx4 v[128:131], v21, s[16:19], s56 offen offset:1024 sc1
 buffer_load_dwordx4 v[132:135], v21, s[16:19], s56 offen offset:1280 sc1
 s_add_u32 s56, s56, 2048
 buffer_load_dwordx4 v[72:75], v4, s[16:19], s56 offen sc1
 buffer_load_dwordx2 v[76:77], v5, s[16:19], s56 offen offset:1536 sc1
 s_add_u32 s56, s56, 2048
 buffer_load_dwordx4 v[80:83], v4, s[16:19], s56 offen sc1
 buffer_load_dwordx2 v[84:85], v5, s[16:19], s56 offen offset:1536 sc1
 s_add_u32 s56, s56, 2048
 buffer_load_dwordx4 v[88:91], v4, s[16:19], s56 offen sc1
 buffer_load_dwordx2 v[92:93], v5, s[16:19], s56 offen offset:1536 sc1
 s_add_u32 s56, s56, 10240
 buffer_load_dwordx4 v[32:35], v22, s[16:19], s57 offen offset:0 sc1
 buffer_load_dwordx4 v[36:39], v22, s[16:19], s57 offen offset:256 sc1
 buffer_load_dwordx4 v[40:43], v22, s[16:19], s57 offen offset:512 sc1
 buffer_load_dwordx4 v[44:47], v22, s[16:19], s57 offen offset:768 sc1
 s_add_u32 s57, s57, 4096
 buffer_load_dwordx4 v[96:99], v4, s[16:19], s56 offen sc1
 buffer_load_dwordx2 v[100:101], v5, s[16:19], s56 offen offset:1536 sc1
 buffer_load_dwordx4 v[136:139], v21, s[16:19], s56 offen offset:1024 sc1
 buffer_load_dwordx4 v[140:143], v21, s[16:19], s56 offen offset:1280 sc1
 s_add_u32 s56, s56, 2048
 buffer_load_dwordx4 v[104:107], v4, s[16:19], s56 offen sc1
 buffer_load_dwordx2 v[108:109], v5, s[16:19], s56 offen offset:1536 sc1
 s_add_u32 s56, s56, 2048
 buffer_load_dwordx4 v[112:115], v4, s[16:19], s56 offen sc1
 buffer_load_dwordx2 v[116:117], v5, s[16:19], s56 offen offset:1536 sc1
 s_add_u32 s56, s56, 2048
 buffer_load_dwordx4 v[120:123], v4, s[16:19], s56 offen sc1
 buffer_load_dwordx2 v[124:125], v5, s[16:19], s56 offen offset:1536 sc1
 s_add_u32 s56, s56, 10240
 buffer_load_dwordx4 v[48:51], v22, s[16:19], s57 offen offset:0 sc1
 buffer_load_dwordx4 v[52:55], v22, s[16:19], s57 offen offset:256 sc1
 buffer_load_dwordx4 v[56:59], v22, s[16:19], s57 offen offset:512 sc1
 buffer_load_dwordx4 v[60:63], v22, s[16:19], s57 offen offset:768 sc1
 s_add_u32 s57, s57, 4096
 s_barrier
 s_waitcnt vmcnt(28)
 v_sub_f32 v25, 1.0, v24
 v_cvt_pk_bf16_f32 v26, v25, v25
 v_lshlrev_b32 v25, 16, v26
 v_cvt_pk_bf16_f32 v26, v12, v12
 v_lshlrev_b32 v12, 16, v26
 v_cvt_pk_bf16_f32 v26, v13, v13
 v_lshlrev_b32 v13, 16, v26
 v_cvt_pk_bf16_f32 v26, v14, v14
 v_lshlrev_b32 v14, 16, v26
 v_cvt_pk_bf16_f32 v26, v15, v15
 v_lshlrev_b32 v15, 16, v26
 v_cvt_pk_bf16_f32 v26, v16, v16
 v_lshlrev_b32 v16, 16, v26
 v_cvt_pk_bf16_f32 v26, v17, v17
 v_lshlrev_b32 v17, 16, v26
 v_cvt_pk_bf16_f32 v26, v18, v18
 v_lshlrev_b32 v18, 16, v26
 v_cvt_pk_bf16_f32 v26, v19, v19
 v_lshlrev_b32 v19, 16, v26
 v_mul_f32 v12, v12, v25
 v_cvt_pk_bf16_f32 v26, v12, v12
 v_lshlrev_b32 v12, 16, v26
 v_mul_f32 v13, v13, v25
 v_cvt_pk_bf16_f32 v26, v13, v13
 v_lshlrev_b32 v13, 16, v26
 v_mul_f32 v14, v14, v25
 v_cvt_pk_bf16_f32 v26, v14, v14
 v_lshlrev_b32 v14, 16, v26
 v_mul_f32 v15, v15, v25
 v_cvt_pk_bf16_f32 v26, v15, v15
 v_lshlrev_b32 v15, 16, v26
 v_mul_f32 v16, v16, v25
 v_cvt_pk_bf16_f32 v26, v16, v16
 v_lshlrev_b32 v16, 16, v26
 v_mul_f32 v17, v17, v25
 v_cvt_pk_bf16_f32 v26, v17, v17
 v_lshlrev_b32 v17, 16, v26
 v_mul_f32 v18, v18, v25
 v_cvt_pk_bf16_f32 v26, v18, v18
 v_lshlrev_b32 v18, 16, v26
 v_mul_f32 v19, v19, v25
 v_cvt_pk_bf16_f32 v26, v19, v19
 v_lshlrev_b32 v19, 16, v26
 s_cmp_ge_u32 s40, 52
 s_cbranch_scc1 pvc_262
 s_branch pvg_261
pvw_256:
 s_waitcnt vmcnt(0)
 v_sub_f32 v25, 1.0, v24
 v_cvt_pk_bf16_f32 v26, v25, v25
 v_lshlrev_b32 v25, 16, v26
 v_cvt_pk_bf16_f32 v26, v12, v12
 v_lshlrev_b32 v12, 16, v26
 v_cvt_pk_bf16_f32 v26, v13, v13
 v_lshlrev_b32 v13, 16, v26
 v_cvt_pk_bf16_f32 v26, v14, v14
 v_lshlrev_b32 v14, 16, v26
 v_cvt_pk_bf16_f32 v26, v15, v15
 v_lshlrev_b32 v15, 16, v26
 v_cvt_pk_bf16_f32 v26, v16, v16
 v_lshlrev_b32 v16, 16, v26
 v_cvt_pk_bf16_f32 v26, v17, v17
 v_lshlrev_b32 v17, 16, v26
 v_cvt_pk_bf16_f32 v26, v18, v18
 v_lshlrev_b32 v18, 16, v26
 v_cvt_pk_bf16_f32 v26, v19, v19
 v_lshlrev_b32 v19, 16, v26
 v_mul_f32 v12, v12, v25
 v_cvt_pk_bf16_f32 v26, v12, v12
 v_lshlrev_b32 v12, 16, v26
 v_mul_f32 v13, v13, v25
 v_cvt_pk_bf16_f32 v26, v13, v13
 v_lshlrev_b32 v13, 16, v26
 v_mul_f32 v14, v14, v25
 v_cvt_pk_bf16_f32 v26, v14, v14
 v_lshlrev_b32 v14, 16, v26
 v_mul_f32 v15, v15, v25
 v_cvt_pk_bf16_f32 v26, v15, v15
 v_lshlrev_b32 v15, 16, v26
 v_mul_f32 v16, v16, v25
 v_cvt_pk_bf16_f32 v26, v16, v16
 v_lshlrev_b32 v16, 16, v26
 v_mul_f32 v17, v17, v25
 v_cvt_pk_bf16_f32 v26, v17, v17
 v_lshlrev_b32 v17, 16, v26
 v_mul_f32 v18, v18, v25
 v_cvt_pk_bf16_f32 v26, v18, v18
 v_lshlrev_b32 v18, 16, v26
 v_mul_f32 v19, v19, v25
 v_cvt_pk_bf16_f32 v26, v19, v19
 v_lshlrev_b32 v19, 16, v26
 s_cmp_ge_u32 s40, 52
 s_cbranch_scc1 pvt_264
 s_cmp_lg_u32 s20, 0
 s_cbranch_scc1 wm_266
 s_mov_b32 s101, 0
wm_265:
 buffer_load_dword v26, v7, s[72:75], s52 offen sc1
 s_add_u32 s101, s101, 1
 s_cmp_gt_u32 s101, 131072
 s_cbranch_scc1 main_end
 s_waitcnt vmcnt(0)
 v_cmp_gt_u32 vcc, 4, v26
 v_readfirstlane_b32 s100, v26
 s_nop 0
 s_cbranch_vccz wm_266
 s_sleep 2
 s_add_u32 s100, s100, 3
 s_cmp_ge_u32 s100, 4
 s_cbranch_scc1 wm_265
 s_sleep 24
 s_branch wm_265
wm_266:
 s_barrier
 buffer_load_dwordx4 v[64:67], v4, s[16:19], s47 offen sc1
 buffer_load_dwordx2 v[68:69], v5, s[16:19], s47 offen offset:1536 sc1
 buffer_load_dwordx4 v[128:131], v21, s[16:19], s47 offen offset:1024 sc1
 buffer_load_dwordx4 v[132:135], v21, s[16:19], s47 offen offset:1280 sc1
 s_add_u32 s47, s47, 2048
 buffer_load_dwordx4 v[72:75], v4, s[16:19], s47 offen sc1
 buffer_load_dwordx2 v[76:77], v5, s[16:19], s47 offen offset:1536 sc1
 s_add_u32 s47, s47, 2048
 buffer_load_dwordx4 v[80:83], v4, s[16:19], s47 offen sc1
 buffer_load_dwordx2 v[84:85], v5, s[16:19], s47 offen offset:1536 sc1
 s_add_u32 s47, s47, 2048
 buffer_load_dwordx4 v[88:91], v4, s[16:19], s47 offen sc1
 buffer_load_dwordx2 v[92:93], v5, s[16:19], s47 offen offset:1536 sc1
 s_add_u32 s47, s47, 10240
 buffer_load_dwordx4 v[32:35], v22, s[16:19], s48 offen offset:0 sc1
 buffer_load_dwordx4 v[36:39], v22, s[16:19], s48 offen offset:256 sc1
 buffer_load_dwordx4 v[40:43], v22, s[16:19], s48 offen offset:512 sc1
 buffer_load_dwordx4 v[44:47], v22, s[16:19], s48 offen offset:768 sc1
 s_add_u32 s48, s48, 4096
 buffer_load_dwordx4 v[96:99], v4, s[16:19], s47 offen sc1
 buffer_load_dwordx2 v[100:101], v5, s[16:19], s47 offen offset:1536 sc1
 buffer_load_dwordx4 v[136:139], v21, s[16:19], s47 offen offset:1024 sc1
 buffer_load_dwordx4 v[140:143], v21, s[16:19], s47 offen offset:1280 sc1
 s_add_u32 s47, s47, 2048
 buffer_load_dwordx4 v[104:107], v4, s[16:19], s47 offen sc1
 buffer_load_dwordx2 v[108:109], v5, s[16:19], s47 offen offset:1536 sc1
 s_add_u32 s47, s47, 2048
 buffer_load_dwordx4 v[112:115], v4, s[16:19], s47 offen sc1
 buffer_load_dwordx2 v[116:117], v5, s[16:19], s47 offen offset:1536 sc1
 s_add_u32 s47, s47, 2048
 buffer_load_dwordx4 v[120:123], v4, s[16:19], s47 offen sc1
 buffer_load_dwordx2 v[124:125], v5, s[16:19], s47 offen offset:1536 sc1
 s_add_u32 s47, s47, 10240
 buffer_load_dwordx4 v[48:51], v22, s[16:19], s48 offen offset:0 sc1
 buffer_load_dwordx4 v[52:55], v22, s[16:19], s48 offen offset:256 sc1
 buffer_load_dwordx4 v[56:59], v22, s[16:19], s48 offen offset:512 sc1
 buffer_load_dwordx4 v[60:63], v22, s[16:19], s48 offen offset:768 sc1
 s_add_u32 s48, s48, 4096
pvg_261:
 s_add_u32 s41, s41, 1
 s_mul_i32 s53, s42, 40960
 s_lshl_b32 s22, s41, 12
 s_add_u32 s53, s53, s22
 s_lshl_b32 s48, s41, 16
 s_lshl_b32 s22, s20, 14
 s_add_u32 s48, s48, s22
 s_add_u32 s48, s48, s61
 s_waitcnt vmcnt(26)
 v_mfma_f32_16x16x32_bf16 v[148:151], a[0:3], v[64:67], 0
 v_mfma_f32_16x16x32_bf16 v[144:147], a[0:3], v[68:71], 0
 v_mfma_f32_16x16x32_bf16 v[156:159], a[4:7], v[64:67], 0
 v_mfma_f32_16x16x32_bf16 v[152:155], a[4:7], v[68:71], 0
 v_mfma_f32_16x16x32_bf16 v[164:167], a[8:11], v[64:67], 0
 v_mfma_f32_16x16x32_bf16 v[160:163], a[8:11], v[68:71], 0
 v_mfma_f32_16x16x32_bf16 v[172:175], a[12:15], v[64:67], 0
 v_mfma_f32_16x16x32_bf16 v[168:171], a[12:15], v[68:71], 0
 buffer_load_dwordx4 a[0:3], v4, s[12:15], s53 offen offset:0 sc1
 buffer_load_dwordx4 a[4:7], v4, s[12:15], s53 offen offset:1024 sc1
 buffer_load_dwordx4 a[8:11], v4, s[12:15], s53 offen offset:2048 sc1
 buffer_load_dwordx4 a[12:15], v4, s[12:15], s53 offen offset:3072 sc1
 s_waitcnt vmcnt(26)
 v_mfma_f32_16x16x32_bf16 v[148:151], a[16:19], v[72:75], v[148:151]
 v_mfma_f32_16x16x32_bf16 v[144:147], a[16:19], v[76:79], v[144:147]
 v_mfma_f32_16x16x32_bf16 v[156:159], a[20:23], v[72:75], v[156:159]
 v_mfma_f32_16x16x32_bf16 v[152:155], a[20:23], v[76:79], v[152:155]
 v_mfma_f32_16x16x32_bf16 v[164:167], a[24:27], v[72:75], v[164:167]
 v_mfma_f32_16x16x32_bf16 v[160:163], a[24:27], v[76:79], v[160:163]
 v_mfma_f32_16x16x32_bf16 v[172:175], a[28:31], v[72:75], v[172:175]
 v_mfma_f32_16x16x32_bf16 v[168:171], a[28:31], v[76:79], v[168:171]
 s_add_u32 s53, s53, 40960
 buffer_load_dwordx4 a[16:19], v4, s[12:15], s53 offen offset:0 sc1
 buffer_load_dwordx4 a[20:23], v4, s[12:15], s53 offen offset:1024 sc1
 buffer_load_dwordx4 a[24:27], v4, s[12:15], s53 offen offset:2048 sc1
 buffer_load_dwordx4 a[28:31], v4, s[12:15], s53 offen offset:3072 sc1
 s_waitcnt vmcnt(28)
 v_mfma_f32_16x16x32_bf16 v[148:151], a[32:35], v[80:83], v[148:151]
 v_mfma_f32_16x16x32_bf16 v[144:147], a[32:35], v[84:87], v[144:147]
 v_mfma_f32_16x16x32_bf16 v[156:159], a[36:39], v[80:83], v[156:159]
 v_mfma_f32_16x16x32_bf16 v[152:155], a[36:39], v[84:87], v[152:155]
 v_mfma_f32_16x16x32_bf16 v[164:167], a[40:43], v[80:83], v[164:167]
 v_mfma_f32_16x16x32_bf16 v[160:163], a[40:43], v[84:87], v[160:163]
 v_mfma_f32_16x16x32_bf16 v[172:175], a[44:47], v[80:83], v[172:175]
 v_mfma_f32_16x16x32_bf16 v[168:171], a[44:47], v[84:87], v[168:171]
 s_add_u32 s53, s53, 40960
 buffer_load_dwordx4 a[32:35], v4, s[12:15], s53 offen offset:0 sc1
 buffer_load_dwordx4 a[36:39], v4, s[12:15], s53 offen offset:1024 sc1
 buffer_load_dwordx4 a[40:43], v4, s[12:15], s53 offen offset:2048 sc1
 buffer_load_dwordx4 a[44:47], v4, s[12:15], s53 offen offset:3072 sc1
 s_waitcnt vmcnt(30)
 v_mfma_f32_16x16x32_bf16 v[148:151], a[48:51], v[88:91], v[148:151]
 v_mfma_f32_16x16x32_bf16 v[144:147], a[48:51], v[92:95], v[144:147]
 v_mfma_f32_16x16x32_bf16 v[156:159], a[52:55], v[88:91], v[156:159]
 v_mfma_f32_16x16x32_bf16 v[152:155], a[52:55], v[92:95], v[152:155]
 v_mfma_f32_16x16x32_bf16 v[164:167], a[56:59], v[88:91], v[164:167]
 v_mfma_f32_16x16x32_bf16 v[160:163], a[56:59], v[92:95], v[160:163]
 v_mfma_f32_16x16x32_bf16 v[172:175], a[60:63], v[88:91], v[172:175]
 v_mfma_f32_16x16x32_bf16 v[168:171], a[60:63], v[92:95], v[168:171]
 s_add_u32 s53, s53, 40960
 buffer_load_dwordx4 a[48:51], v4, s[12:15], s53 offen offset:0 sc1
 buffer_load_dwordx4 a[52:55], v4, s[12:15], s53 offen offset:1024 sc1
 buffer_load_dwordx4 a[56:59], v4, s[12:15], s53 offen offset:2048 sc1
 buffer_load_dwordx4 a[60:63], v4, s[12:15], s53 offen offset:3072 sc1
 s_waitcnt vmcnt(30)
 v_mfma_f32_16x16x32_bf16 v[144:147], v[32:35], v[128:131], v[144:147]
 v_mfma_f32_16x16x32_bf16 v[148:151], v[32:35], v[132:135], v[148:151]
 v_mfma_f32_16x16x32_bf16 v[152:155], v[36:39], v[128:131], v[152:155]
 v_mfma_f32_16x16x32_bf16 v[156:159], v[36:39], v[132:135], v[156:159]
 v_mfma_f32_16x16x32_bf16 v[160:163], v[40:43], v[128:131], v[160:163]
 v_mfma_f32_16x16x32_bf16 v[164:167], v[40:43], v[132:135], v[164:167]
 v_mfma_f32_16x16x32_bf16 v[168:171], v[44:47], v[128:131], v[168:171]
 v_mfma_f32_16x16x32_bf16 v[172:175], v[44:47], v[132:135], v[172:175]
 buffer_load_dwordx4 v[32:35], v22, s[16:19], s48 offen offset:0 sc1
 buffer_load_dwordx4 v[36:39], v22, s[16:19], s48 offen offset:256 sc1
 buffer_load_dwordx4 v[40:43], v22, s[16:19], s48 offen offset:512 sc1
 buffer_load_dwordx4 v[44:47], v22, s[16:19], s48 offen offset:768 sc1
 s_add_u32 s48, s48, 4096
 s_waitcnt vmcnt(32)
 v_mfma_f32_16x16x32_bf16 v[148:151], a[64:67], v[96:99], v[148:151]
 v_mfma_f32_16x16x32_bf16 v[144:147], a[64:67], v[100:103], v[144:147]
 v_mfma_f32_16x16x32_bf16 v[156:159], a[68:71], v[96:99], v[156:159]
 v_mfma_f32_16x16x32_bf16 v[152:155], a[68:71], v[100:103], v[152:155]
 v_mfma_f32_16x16x32_bf16 v[164:167], a[72:75], v[96:99], v[164:167]
 v_mfma_f32_16x16x32_bf16 v[160:163], a[72:75], v[100:103], v[160:163]
 v_mfma_f32_16x16x32_bf16 v[172:175], a[76:79], v[96:99], v[172:175]
 v_mfma_f32_16x16x32_bf16 v[168:171], a[76:79], v[100:103], v[168:171]
 s_add_u32 s53, s53, 40960
 buffer_load_dwordx4 a[64:67], v4, s[12:15], s53 offen offset:0 sc1
 buffer_load_dwordx4 a[68:71], v4, s[12:15], s53 offen offset:1024 sc1
 buffer_load_dwordx4 a[72:75], v4, s[12:15], s53 offen offset:2048 sc1
 buffer_load_dwordx4 a[76:79], v4, s[12:15], s53 offen offset:3072 sc1
 s_waitcnt vmcnt(32)
 v_mfma_f32_16x16x32_bf16 v[148:151], a[80:83], v[104:107], v[148:151]
 v_mfma_f32_16x16x32_bf16 v[144:147], a[80:83], v[108:111], v[144:147]
 v_mfma_f32_16x16x32_bf16 v[156:159], a[84:87], v[104:107], v[156:159]
 v_mfma_f32_16x16x32_bf16 v[152:155], a[84:87], v[108:111], v[152:155]
 v_mfma_f32_16x16x32_bf16 v[164:167], a[88:91], v[104:107], v[164:167]
 v_mfma_f32_16x16x32_bf16 v[160:163], a[88:91], v[108:111], v[160:163]
 v_mfma_f32_16x16x32_bf16 v[172:175], a[92:95], v[104:107], v[172:175]
 v_mfma_f32_16x16x32_bf16 v[168:171], a[92:95], v[108:111], v[168:171]
 s_add_u32 s53, s53, 40960
 buffer_load_dwordx4 a[80:83], v4, s[12:15], s53 offen offset:0 sc1
 buffer_load_dwordx4 a[84:87], v4, s[12:15], s53 offen offset:1024 sc1
 buffer_load_dwordx4 a[88:91], v4, s[12:15], s53 offen offset:2048 sc1
 buffer_load_dwordx4 a[92:95], v4, s[12:15], s53 offen offset:3072 sc1
 s_waitcnt vmcnt(34)
 v_mfma_f32_16x16x32_bf16 v[148:151], a[96:99], v[112:115], v[148:151]
 v_mfma_f32_16x16x32_bf16 v[144:147], a[96:99], v[116:119], v[144:147]
 v_mfma_f32_16x16x32_bf16 v[156:159], a[100:103], v[112:115], v[156:159]
 v_mfma_f32_16x16x32_bf16 v[152:155], a[100:103], v[116:119], v[152:155]
 v_mfma_f32_16x16x32_bf16 v[164:167], a[104:107], v[112:115], v[164:167]
 v_mfma_f32_16x16x32_bf16 v[160:163], a[104:107], v[116:119], v[160:163]
 v_mfma_f32_16x16x32_bf16 v[172:175], a[108:111], v[112:115], v[172:175]
 v_mfma_f32_16x16x32_bf16 v[168:171], a[108:111], v[116:119], v[168:171]
 s_add_u32 s53, s53, 40960
 buffer_load_dwordx4 a[96:99], v4, s[12:15], s53 offen offset:0 sc1
 buffer_load_dwordx4 a[100:103], v4, s[12:15], s53 offen offset:1024 sc1
 buffer_load_dwordx4 a[104:107], v4, s[12:15], s53 offen offset:2048 sc1
 buffer_load_dwordx4 a[108:111], v4, s[12:15], s53 offen offset:3072 sc1
 s_waitcnt vmcnt(36)
 v_mfma_f32_16x16x32_bf16 v[148:151], a[112:115], v[120:123], v[148:151]
 v_mfma_f32_16x16x32_bf16 v[144:147], a[112:115], v[124:127], v[144:147]
 v_mfma_f32_16x16x32_bf16 v[156:159], a[116:119], v[120:123], v[156:159]
 v_mfma_f32_16x16x32_bf16 v[152:155], a[116:119], v[124:127], v[152:155]
 v_mfma_f32_16x16x32_bf16 v[164:167], a[120:123], v[120:123], v[164:167]
 v_mfma_f32_16x16x32_bf16 v[160:163], a[120:123], v[124:127], v[160:163]
 v_mfma_f32_16x16x32_bf16 v[172:175], a[124:127], v[120:123], v[172:175]
 v_mfma_f32_16x16x32_bf16 v[168:171], a[124:127], v[124:127], v[168:171]
 s_add_u32 s53, s53, 40960
 buffer_load_dwordx4 a[112:115], v4, s[12:15], s53 offen offset:0 sc1
 buffer_load_dwordx4 a[116:119], v4, s[12:15], s53 offen offset:1024 sc1
 buffer_load_dwordx4 a[120:123], v4, s[12:15], s53 offen offset:2048 sc1
 buffer_load_dwordx4 a[124:127], v4, s[12:15], s53 offen offset:3072 sc1
 s_waitcnt vmcnt(36)
 v_mfma_f32_16x16x32_bf16 v[144:147], v[48:51], v[136:139], v[144:147]
 v_mfma_f32_16x16x32_bf16 v[148:151], v[48:51], v[140:143], v[148:151]
 v_mfma_f32_16x16x32_bf16 v[152:155], v[52:55], v[136:139], v[152:155]
 v_mfma_f32_16x16x32_bf16 v[156:159], v[52:55], v[140:143], v[156:159]
 v_mfma_f32_16x16x32_bf16 v[160:163], v[56:59], v[136:139], v[160:163]
 v_mfma_f32_16x16x32_bf16 v[164:167], v[56:59], v[140:143], v[164:167]
 v_mfma_f32_16x16x32_bf16 v[168:171], v[60:63], v[136:139], v[168:171]
 v_mfma_f32_16x16x32_bf16 v[172:175], v[60:63], v[140:143], v[172:175]
 buffer_load_dwordx4 v[48:51], v22, s[16:19], s48 offen offset:0 sc1
 buffer_load_dwordx4 v[52:55], v22, s[16:19], s48 offen offset:256 sc1
 buffer_load_dwordx4 v[56:59], v22, s[16:19], s48 offen offset:512 sc1
 buffer_load_dwordx4 v[60:63], v22, s[16:19], s48 offen offset:768 sc1
 s_add_u32 s48, s48, 4096
 s_branch pve_257
pvt_264:
 s_sub_u32 s55, s52, 2048
 s_cmp_lg_u32 s20, 0
 s_cbranch_scc1 wm_268
 s_mov_b32 s101, 0
wm_267:
 buffer_load_dword v26, v7, s[72:75], s55 offen sc1
 s_add_u32 s101, s101, 1
 s_cmp_gt_u32 s101, 131072
 s_cbranch_scc1 main_end
 s_waitcnt vmcnt(0)
 v_cmp_gt_u32 vcc, 4, v26
 v_readfirstlane_b32 s100, v26
 s_nop 0
 s_cbranch_vccz wm_268
 s_sleep 4
 s_add_u32 s100, s100, 3
 s_cmp_ge_u32 s100, 4
 s_cbranch_scc1 wm_267
 s_sleep 24
 s_branch wm_267
wm_268:
 s_barrier
 s_mov_b32 s56, s47
 s_mov_b32 s57, s48
 buffer_load_dwordx4 v[64:67], v4, s[16:19], s56 offen sc1
 buffer_load_dwordx2 v[68:69], v5, s[16:19], s56 offen offset:1536 sc1
 buffer_load_dwordx4 v[128:131], v21, s[16:19], s56 offen offset:1024 sc1
 buffer_load_dwordx4 v[132:135], v21, s[16:19], s56 offen offset:1280 sc1
 s_add_u32 s56, s56, 2048
 buffer_load_dwordx4 v[72:75], v4, s[16:19], s56 offen sc1
 buffer_load_dwordx2 v[76:77], v5, s[16:19], s56 offen offset:1536 sc1
 s_add_u32 s56, s56, 2048
 buffer_load_dwordx4 v[80:83], v4, s[16:19], s56 offen sc1
 buffer_load_dwordx2 v[84:85], v5, s[16:19], s56 offen offset:1536 sc1
 s_add_u32 s56, s56, 2048
 buffer_load_dwordx4 v[88:91], v4, s[16:19], s56 offen sc1
 buffer_load_dwordx2 v[92:93], v5, s[16:19], s56 offen offset:1536 sc1
 s_add_u32 s56, s56, 10240
 buffer_load_dwordx4 v[32:35], v22, s[16:19], s57 offen offset:0 sc1
 buffer_load_dwordx4 v[36:39], v22, s[16:19], s57 offen offset:256 sc1
 buffer_load_dwordx4 v[40:43], v22, s[16:19], s57 offen offset:512 sc1
 buffer_load_dwordx4 v[44:47], v22, s[16:19], s57 offen offset:768 sc1
 s_add_u32 s57, s57, 4096
 buffer_load_dwordx4 v[96:99], v4, s[16:19], s56 offen sc1
 buffer_load_dwordx2 v[100:101], v5, s[16:19], s56 offen offset:1536 sc1
 buffer_load_dwordx4 v[136:139], v21, s[16:19], s56 offen offset:1024 sc1
 buffer_load_dwordx4 v[140:143], v21, s[16:19], s56 offen offset:1280 sc1
 s_add_u32 s56, s56, 2048
 buffer_load_dwordx4 v[104:107], v4, s[16:19], s56 offen sc1
 buffer_load_dwordx2 v[108:109], v5, s[16:19], s56 offen offset:1536 sc1
 s_add_u32 s56, s56, 2048
 buffer_load_dwordx4 v[112:115], v4, s[16:19], s56 offen sc1
 buffer_load_dwordx2 v[116:117], v5, s[16:19], s56 offen offset:1536 sc1
 s_add_u32 s56, s56, 2048
 buffer_load_dwordx4 v[120:123], v4, s[16:19], s56 offen sc1
 buffer_load_dwordx2 v[124:125], v5, s[16:19], s56 offen offset:1536 sc1
 s_add_u32 s56, s56, 10240
 buffer_load_dwordx4 v[48:51], v22, s[16:19], s57 offen offset:0 sc1
 buffer_load_dwordx4 v[52:55], v22, s[16:19], s57 offen offset:256 sc1
 buffer_load_dwordx4 v[56:59], v22, s[16:19], s57 offen offset:512 sc1
 buffer_load_dwordx4 v[60:63], v22, s[16:19], s57 offen offset:768 sc1
 s_add_u32 s57, s57, 4096
pvc_262:
 s_mov_b32 s101, 0
 s_waitcnt vmcnt(14)
 s_branch pvr_270
pvr_269:
 s_sleep 2
 s_add_u32 s56, s47, 0
 s_add_u32 s57, s48, 0
 buffer_load_dwordx4 v[64:67], v4, s[16:19], s56 offen sc1
 buffer_load_dwordx2 v[68:69], v5, s[16:19], s56 offen offset:1536 sc1
 buffer_load_dwordx4 v[128:131], v21, s[16:19], s56 offen offset:1024 sc1
 buffer_load_dwordx4 v[132:135], v21, s[16:19], s56 offen offset:1280 sc1
 s_add_u32 s56, s56, 2048
 buffer_load_dwordx4 v[72:75], v4, s[16:19], s56 offen sc1
 buffer_load_dwordx2 v[76:77], v5, s[16:19], s56 offen offset:1536 sc1
 s_add_u32 s56, s56, 2048
 buffer_load_dwordx4 v[80:83], v4, s[16:19], s56 offen sc1
 buffer_load_dwordx2 v[84:85], v5, s[16:19], s56 offen offset:1536 sc1
 s_add_u32 s56, s56, 2048
 buffer_load_dwordx4 v[88:91], v4, s[16:19], s56 offen sc1
 buffer_load_dwordx2 v[92:93], v5, s[16:19], s56 offen offset:1536 sc1
 s_add_u32 s56, s56, 10240
 buffer_load_dwordx4 v[32:35], v22, s[16:19], s57 offen offset:0 sc1
 buffer_load_dwordx4 v[36:39], v22, s[16:19], s57 offen offset:256 sc1
 buffer_load_dwordx4 v[40:43], v22, s[16:19], s57 offen offset:512 sc1
 buffer_load_dwordx4 v[44:47], v22, s[16:19], s57 offen offset:768 sc1
 s_add_u32 s57, s57, 4096
 s_add_u32 s101, s101, 1
 s_cmp_gt_u32 s101, 131072
 s_cbranch_scc1 main_end
 s_waitcnt vmcnt(0)
pvr_270:
 v_max3_u32 v26, v64, v68, v72
 v_max3_u32 v26, v26, v76, v80
 v_max3_u32 v26, v26, v84, v88
 v_max3_u32 v26, v26, v92, v128
 v_max3_u32 v26, v26, v132, v32
 v_max3_u32 v26, v26, v36, v40
 v_max3_u32 v26, v26, v44, v44
 v_cmp_eq_u32 vcc, -1, v26
 s_nop 1
 s_cbranch_vccnz pvr_269
 v_mfma_f32_16x16x32_bf16 v[148:151], a[0:3], v[64:67], 0
 v_mfma_f32_16x16x32_bf16 v[144:147], a[0:3], v[68:71], 0
 v_mfma_f32_16x16x32_bf16 v[156:159], a[4:7], v[64:67], 0
 v_mfma_f32_16x16x32_bf16 v[152:155], a[4:7], v[68:71], 0
 v_mfma_f32_16x16x32_bf16 v[164:167], a[8:11], v[64:67], 0
 v_mfma_f32_16x16x32_bf16 v[160:163], a[8:11], v[68:71], 0
 v_mfma_f32_16x16x32_bf16 v[172:175], a[12:15], v[64:67], 0
 v_mfma_f32_16x16x32_bf16 v[168:171], a[12:15], v[68:71], 0
 v_mfma_f32_16x16x32_bf16 v[148:151], a[16:19], v[72:75], v[148:151]
 v_mfma_f32_16x16x32_bf16 v[144:147], a[16:19], v[76:79], v[144:147]
 v_mfma_f32_16x16x32_bf16 v[156:159], a[20:23], v[72:75], v[156:159]
 v_mfma_f32_16x16x32_bf16 v[152:155], a[20:23], v[76:79], v[152:155]
 v_mfma_f32_16x16x32_bf16 v[164:167], a[24:27], v[72:75], v[164:167]
 v_mfma_f32_16x16x32_bf16 v[160:163], a[24:27], v[76:79], v[160:163]
 v_mfma_f32_16x16x32_bf16 v[172:175], a[28:31], v[72:75], v[172:175]
 v_mfma_f32_16x16x32_bf16 v[168:171], a[28:31], v[76:79], v[168:171]
 v_mfma_f32_16x16x32_bf16 v[148:151], a[32:35], v[80:83], v[148:151]
 v_mfma_f32_16x16x32_bf16 v[144:147], a[32:35], v[84:87], v[144:147]
 v_mfma_f32_16x16x32_bf16 v[156:159], a[36:39], v[80:83], v[156:159]
 v_mfma_f32_16x16x32_bf16 v[152:155], a[36:39], v[84:87], v[152:155]
 v_mfma_f32_16x16x32_bf16 v[164:167], a[40:43], v[80:83], v[164:167]
 v_mfma_f32_16x16x32_bf16 v[160:163], a[40:43], v[84:87], v[160:163]
 v_mfma_f32_16x16x32_bf16 v[172:175], a[44:47], v[80:83], v[172:175]
 v_mfma_f32_16x16x32_bf16 v[168:171], a[44:47], v[84:87], v[168:171]
 v_mfma_f32_16x16x32_bf16 v[148:151], a[48:51], v[88:91], v[148:151]
 v_mfma_f32_16x16x32_bf16 v[144:147], a[48:51], v[92:95], v[144:147]
 v_mfma_f32_16x16x32_bf16 v[156:159], a[52:55], v[88:91], v[156:159]
 v_mfma_f32_16x16x32_bf16 v[152:155], a[52:55], v[92:95], v[152:155]
 v_mfma_f32_16x16x32_bf16 v[164:167], a[56:59], v[88:91], v[164:167]
 v_mfma_f32_16x16x32_bf16 v[160:163], a[56:59], v[92:95], v[160:163]
 v_mfma_f32_16x16x32_bf16 v[172:175], a[60:63], v[88:91], v[172:175]
 v_mfma_f32_16x16x32_bf16 v[168:171], a[60:63], v[92:95], v[168:171]
 s_nop 1
 v_mfma_f32_16x16x32_bf16 v[144:147], v[32:35], v[128:131], v[144:147]
 v_mfma_f32_16x16x32_bf16 v[148:151], v[32:35], v[132:135], v[148:151]
 v_mfma_f32_16x16x32_bf16 v[152:155], v[36:39], v[128:131], v[152:155]
 v_mfma_f32_16x16x32_bf16 v[156:159], v[36:39], v[132:135], v[156:159]
 v_mfma_f32_16x16x32_bf16 v[160:163], v[40:43], v[128:131], v[160:163]
 v_mfma_f32_16x16x32_bf16 v[164:167], v[40:43], v[132:135], v[164:167]
 v_mfma_f32_16x16x32_bf16 v[168:171], v[44:47], v[128:131], v[168:171]
 v_mfma_f32_16x16x32_bf16 v[172:175], v[44:47], v[132:135], v[172:175]
 s_mov_b32 s101, 0
 s_waitcnt vmcnt(0)
 s_branch pvr_272
pvr_271:
 s_sleep 2
 s_add_u32 s56, s47, 16384
 s_add_u32 s57, s48, 4096
 buffer_load_dwordx4 v[96:99], v4, s[16:19], s56 offen sc1
 buffer_load_dwordx2 v[100:101], v5, s[16:19], s56 offen offset:1536 sc1
 buffer_load_dwordx4 v[136:139], v21, s[16:19], s56 offen offset:1024 sc1
 buffer_load_dwordx4 v[140:143], v21, s[16:19], s56 offen offset:1280 sc1
 s_add_u32 s56, s56, 2048
 buffer_load_dwordx4 v[104:107], v4, s[16:19], s56 offen sc1
 buffer_load_dwordx2 v[108:109], v5, s[16:19], s56 offen offset:1536 sc1
 s_add_u32 s56, s56, 2048
 buffer_load_dwordx4 v[112:115], v4, s[16:19], s56 offen sc1
 buffer_load_dwordx2 v[116:117], v5, s[16:19], s56 offen offset:1536 sc1
 s_add_u32 s56, s56, 2048
 buffer_load_dwordx4 v[120:123], v4, s[16:19], s56 offen sc1
 buffer_load_dwordx2 v[124:125], v5, s[16:19], s56 offen offset:1536 sc1
 s_add_u32 s56, s56, 10240
 buffer_load_dwordx4 v[48:51], v22, s[16:19], s57 offen offset:0 sc1
 buffer_load_dwordx4 v[52:55], v22, s[16:19], s57 offen offset:256 sc1
 buffer_load_dwordx4 v[56:59], v22, s[16:19], s57 offen offset:512 sc1
 buffer_load_dwordx4 v[60:63], v22, s[16:19], s57 offen offset:768 sc1
 s_add_u32 s57, s57, 4096
 s_add_u32 s101, s101, 1
 s_cmp_gt_u32 s101, 131072
 s_cbranch_scc1 main_end
 s_waitcnt vmcnt(0)
pvr_272:
 v_max3_u32 v26, v96, v100, v104
 v_max3_u32 v26, v26, v108, v112
 v_max3_u32 v26, v26, v116, v120
 v_max3_u32 v26, v26, v124, v136
 v_max3_u32 v26, v26, v140, v48
 v_max3_u32 v26, v26, v52, v56
 v_max3_u32 v26, v26, v60, v60
 v_cmp_eq_u32 vcc, -1, v26
 s_nop 1
 s_cbranch_vccnz pvr_271
 v_mfma_f32_16x16x32_bf16 v[148:151], a[64:67], v[96:99], v[148:151]
 v_mfma_f32_16x16x32_bf16 v[144:147], a[64:67], v[100:103], v[144:147]
 v_mfma_f32_16x16x32_bf16 v[156:159], a[68:71], v[96:99], v[156:159]
 v_mfma_f32_16x16x32_bf16 v[152:155], a[68:71], v[100:103], v[152:155]
 v_mfma_f32_16x16x32_bf16 v[164:167], a[72:75], v[96:99], v[164:167]
 v_mfma_f32_16x16x32_bf16 v[160:163], a[72:75], v[100:103], v[160:163]
 v_mfma_f32_16x16x32_bf16 v[172:175], a[76:79], v[96:99], v[172:175]
 v_mfma_f32_16x16x32_bf16 v[168:171], a[76:79], v[100:103], v[168:171]
 v_mfma_f32_16x16x32_bf16 v[148:151], a[80:83], v[104:107], v[148:151]
 v_mfma_f32_16x16x32_bf16 v[144:147], a[80:83], v[108:111], v[144:147]
 v_mfma_f32_16x16x32_bf16 v[156:159], a[84:87], v[104:107], v[156:159]
 v_mfma_f32_16x16x32_bf16 v[152:155], a[84:87], v[108:111], v[152:155]
 v_mfma_f32_16x16x32_bf16 v[164:167], a[88:91], v[104:107], v[164:167]
 v_mfma_f32_16x16x32_bf16 v[160:163], a[88:91], v[108:111], v[160:163]
 v_mfma_f32_16x16x32_bf16 v[172:175], a[92:95], v[104:107], v[172:175]
 v_mfma_f32_16x16x32_bf16 v[168:171], a[92:95], v[108:111], v[168:171]
 v_mfma_f32_16x16x32_bf16 v[148:151], a[96:99], v[112:115], v[148:151]
 v_mfma_f32_16x16x32_bf16 v[144:147], a[96:99], v[116:119], v[144:147]
 v_mfma_f32_16x16x32_bf16 v[156:159], a[100:103], v[112:115], v[156:159]
 v_mfma_f32_16x16x32_bf16 v[152:155], a[100:103], v[116:119], v[152:155]
 v_mfma_f32_16x16x32_bf16 v[164:167], a[104:107], v[112:115], v[164:167]
 v_mfma_f32_16x16x32_bf16 v[160:163], a[104:107], v[116:119], v[160:163]
 v_mfma_f32_16x16x32_bf16 v[172:175], a[108:111], v[112:115], v[172:175]
 v_mfma_f32_16x16x32_bf16 v[168:171], a[108:111], v[116:119], v[168:171]
 v_mfma_f32_16x16x32_bf16 v[148:151], a[112:115], v[120:123], v[148:151]
 v_mfma_f32_16x16x32_bf16 v[144:147], a[112:115], v[124:127], v[144:147]
 v_mfma_f32_16x16x32_bf16 v[156:159], a[116:119], v[120:123], v[156:159]
 v_mfma_f32_16x16x32_bf16 v[152:155], a[116:119], v[124:127], v[152:155]
 v_mfma_f32_16x16x32_bf16 v[164:167], a[120:123], v[120:123], v[164:167]
 v_mfma_f32_16x16x32_bf16 v[160:163], a[120:123], v[124:127], v[160:163]
 v_mfma_f32_16x16x32_bf16 v[172:175], a[124:127], v[120:123], v[172:175]
 v_mfma_f32_16x16x32_bf16 v[168:171], a[124:127], v[124:127], v[168:171]
 s_nop 1
 v_mfma_f32_16x16x32_bf16 v[144:147], v[48:51], v[136:139], v[144:147]
 v_mfma_f32_16x16x32_bf16 v[148:151], v[48:51], v[140:143], v[148:151]
 v_mfma_f32_16x16x32_bf16 v[152:155], v[52:55], v[136:139], v[152:155]
 v_mfma_f32_16x16x32_bf16 v[156:159], v[52:55], v[140:143], v[156:159]
 v_mfma_f32_16x16x32_bf16 v[160:163], v[56:59], v[136:139], v[160:163]
 v_mfma_f32_16x16x32_bf16 v[164:167], v[56:59], v[140:143], v[164:167]
 v_mfma_f32_16x16x32_bf16 v[168:171], v[60:63], v[136:139], v[168:171]
 v_mfma_f32_16x16x32_bf16 v[172:175], v[60:63], v[140:143], v[172:175]
pve_257:
 s_nop 0
 s_or_b32 s21, s20, s65
 s_cbranch_scc1 lc_273
 s_sub_u32 s21, s2, 0
 s_cmp_ge_u32 s21, 640
 s_cbranch_scc1 lc_273
 v_mov_b32 v29, 1
 s_mov_b64 exec, 1
 buffer_atomic_add v29, v28, s[32:35], 0 offen sc0 sc1
 s_mov_b64 exec, -1
lc_273:
 ds_write_b128 v10, v[144:147] offset:0
 ds_write_b128 v10, v[148:151] offset:1024
 ds_write_b128 v10, v[152:155] offset:2048
 ds_write_b128 v10, v[156:159] offset:3072
 ds_write_b128 v10, v[160:163] offset:4096
 ds_write_b128 v10, v[164:167] offset:5120
 ds_write_b128 v10, v[168:171] offset:6144
 ds_write_b128 v10, v[172:175] offset:7168
 s_cmp_lg_u32 s20, 0
 s_cbranch_scc1 pvq_276
 v_readfirstlane_b32 s21, v29
 s_mov_b32 s23, -1
 v_mov_b32 v213, s23
 s_mov_b64 exec, 1
 ds_write_b32 v30, v29
 ds_write_b32 v30, v213 offset:8
 s_mov_b64 exec, -1
pvq_276:
 s_waitcnt lgkmcnt(0)
 s_barrier
 ds_read_b128 v[176:179], v11 offset:0
 ds_read_b128 v[180:183], v11 offset:8192
 ds_read_b128 v[184:187], v11 offset:16384
 ds_read_b128 v[188:191], v11 offset:24576
 ds_read_b128 v[192:195], v11 offset:4096
 ds_read_b128 v[196:199], v11 offset:12288
 ds_read_b128 v[200:203], v11 offset:20480
 ds_read_b128 v[204:207], v11 offset:28672
 ds_read_b32 v23, v30
 ds_read_b32 v213, v30 offset:8
 s_cmp_ge_u32 s40, 32
 s_cbranch_scc1 pvr_279
 s_waitcnt lgkmcnt(6)
 v_pk_add_f32 v[176:177], v[176:177], v[180:181]
 v_pk_add_f32 v[184:185], v[184:185], v[188:189]
 v_pk_add_f32 v[178:179], v[178:179], v[182:183]
 v_pk_add_f32 v[186:187], v[186:187], v[190:191]
 v_pk_add_f32 v[176:177], v[176:177], v[184:185]
 v_pk_add_f32 v[178:179], v[178:179], v[186:187]
 buffer_store_dwordx4 v[176:179], v4, s[24:27], s54 offen offset:0 sc1
 s_waitcnt lgkmcnt(2)
 v_pk_add_f32 v[192:193], v[192:193], v[196:197]
 v_pk_add_f32 v[200:201], v[200:201], v[204:205]
 v_pk_add_f32 v[194:195], v[194:195], v[198:199]
 v_pk_add_f32 v[202:203], v[202:203], v[206:207]
 v_pk_add_f32 v[192:193], v[192:193], v[200:201]
 v_pk_add_f32 v[194:195], v[194:195], v[202:203]
 buffer_store_dwordx4 v[192:195], v4, s[24:27], s54 offen offset:2048 sc1
 s_lshr_b32 s71, s40, 2
 s_lshl_b32 s71, s71, 7
 s_add_u32 s71, s71, 116736
 s_branch pvr_280
pvr_279:
 s_waitcnt lgkmcnt(6)
 v_pk_add_f32 v[176:177], v[176:177], v[180:181]
 v_pk_add_f32 v[184:185], v[184:185], v[188:189]
 v_pk_add_f32 v[178:179], v[178:179], v[182:183]
 v_pk_add_f32 v[186:187], v[186:187], v[190:191]
 v_pk_add_f32 v[176:177], v[176:177], v[184:185]
 v_pk_add_f32 v[178:179], v[178:179], v[186:187]
 v_cvt_pk_bf16_f32 v26, v176, v177
 v_lshlrev_b32 v176, 16, v26
 v_and_b32 v177, 0xffff0000, v26
 v_mul_f32 v176, v176, v24
 v_mul_f32 v177, v177, v24
 v_cvt_pk_bf16_f32 v26, v176, v177
 v_lshlrev_b32 v176, 16, v26
 v_and_b32 v177, 0xffff0000, v26
 v_add_f32 v176, v176, v12
 v_add_f32 v177, v177, v13
 v_cvt_pk_bf16_f32 v180, v176, v177
 v_cvt_pk_bf16_f32 v26, v178, v179
 v_lshlrev_b32 v178, 16, v26
 v_and_b32 v179, 0xffff0000, v26
 v_mul_f32 v178, v178, v24
 v_mul_f32 v179, v179, v24
 v_cvt_pk_bf16_f32 v26, v178, v179
 v_lshlrev_b32 v178, 16, v26
 v_and_b32 v179, 0xffff0000, v26
 v_add_f32 v178, v178, v14
 v_add_f32 v179, v179, v15
 v_cvt_pk_bf16_f32 v181, v178, v179
 buffer_store_dwordx2 v[180:181], v9, s[8:11], s46 offen offset:0
 s_waitcnt lgkmcnt(2)
 v_pk_add_f32 v[192:193], v[192:193], v[196:197]
 v_pk_add_f32 v[200:201], v[200:201], v[204:205]
 v_pk_add_f32 v[194:195], v[194:195], v[198:199]
 v_pk_add_f32 v[202:203], v[202:203], v[206:207]
 v_pk_add_f32 v[192:193], v[192:193], v[200:201]
 v_pk_add_f32 v[194:195], v[194:195], v[202:203]
 v_cvt_pk_bf16_f32 v26, v192, v193
 v_lshlrev_b32 v192, 16, v26
 v_and_b32 v193, 0xffff0000, v26
 v_mul_f32 v192, v192, v24
 v_mul_f32 v193, v193, v24
 v_cvt_pk_bf16_f32 v26, v192, v193
 v_lshlrev_b32 v192, 16, v26
 v_and_b32 v193, 0xffff0000, v26
 v_add_f32 v192, v192, v16
 v_add_f32 v193, v193, v17
 v_cvt_pk_bf16_f32 v196, v192, v193
 v_cvt_pk_bf16_f32 v26, v194, v195
 v_lshlrev_b32 v194, 16, v26
 v_and_b32 v195, 0xffff0000, v26
 v_mul_f32 v194, v194, v24
 v_mul_f32 v195, v195, v24
 v_cvt_pk_bf16_f32 v26, v194, v195
 v_lshlrev_b32 v194, 16, v26
 v_and_b32 v195, 0xffff0000, v26
 v_add_f32 v194, v194, v18
 v_add_f32 v195, v195, v19
 v_cvt_pk_bf16_f32 v197, v194, v195
 buffer_store_dwordx2 v[196:197], v9, s[8:11], s46 offen offset:64
pvr_280:
pvy_281:
 s_cmp_eq_u32 s65, 0
 s_cbranch_scc1 pvy_282
 s_sub_u32 s65, s65, 1
 s_add_u32 s46, s46, 128
 s_add_u32 s54, s54, 16384
 s_cmp_lt_u32 s40, 32
 s_cselect_b32 s70, 0x80000000, s54
 buffer_load_dwordx4 v[12:15], v4, s[24:27], s70 offen sc1
 buffer_load_dwordx4 v[16:19], v4, s[24:27], s70 offen offset:2048 sc1
 buffer_load_dword v24, v6, s[28:31], s45 offen sc1
 s_waitcnt lgkmcnt(0)
 s_barrier
 s_cmp_eq_u32 s65, 0
 s_cbranch_scc1 pvy_283
 s_add_u32 s41, s41, 1
 s_mul_i32 s53, s42, 40960
 s_lshl_b32 s22, s41, 12
 s_add_u32 s53, s53, s22
 s_lshl_b32 s48, s41, 16
 s_lshl_b32 s22, s20, 14
 s_add_u32 s48, s48, s22
 s_add_u32 s48, s48, s61
 s_waitcnt vmcnt(41)
 v_mfma_f32_16x16x32_bf16 v[148:151], a[0:3], v[64:67], 0
 v_mfma_f32_16x16x32_bf16 v[144:147], a[0:3], v[68:71], 0
 v_mfma_f32_16x16x32_bf16 v[156:159], a[4:7], v[64:67], 0
 v_mfma_f32_16x16x32_bf16 v[152:155], a[4:7], v[68:71], 0
 v_mfma_f32_16x16x32_bf16 v[164:167], a[8:11], v[64:67], 0
 v_mfma_f32_16x16x32_bf16 v[160:163], a[8:11], v[68:71], 0
 v_mfma_f32_16x16x32_bf16 v[172:175], a[12:15], v[64:67], 0
 v_mfma_f32_16x16x32_bf16 v[168:171], a[12:15], v[68:71], 0
 buffer_load_dwordx4 a[0:3], v4, s[12:15], s53 offen offset:0 sc1
 buffer_load_dwordx4 a[4:7], v4, s[12:15], s53 offen offset:1024 sc1
 buffer_load_dwordx4 a[8:11], v4, s[12:15], s53 offen offset:2048 sc1
 buffer_load_dwordx4 a[12:15], v4, s[12:15], s53 offen offset:3072 sc1
 s_waitcnt vmcnt(41)
 v_mfma_f32_16x16x32_bf16 v[148:151], a[16:19], v[72:75], v[148:151]
 v_mfma_f32_16x16x32_bf16 v[144:147], a[16:19], v[76:79], v[144:147]
 v_mfma_f32_16x16x32_bf16 v[156:159], a[20:23], v[72:75], v[156:159]
 v_mfma_f32_16x16x32_bf16 v[152:155], a[20:23], v[76:79], v[152:155]
 v_mfma_f32_16x16x32_bf16 v[164:167], a[24:27], v[72:75], v[164:167]
 v_mfma_f32_16x16x32_bf16 v[160:163], a[24:27], v[76:79], v[160:163]
 v_mfma_f32_16x16x32_bf16 v[172:175], a[28:31], v[72:75], v[172:175]
 v_mfma_f32_16x16x32_bf16 v[168:171], a[28:31], v[76:79], v[168:171]
 s_add_u32 s53, s53, 40960
 buffer_load_dwordx4 a[16:19], v4, s[12:15], s53 offen offset:0 sc1
 buffer_load_dwordx4 a[20:23], v4, s[12:15], s53 offen offset:1024 sc1
 buffer_load_dwordx4 a[24:27], v4, s[12:15], s53 offen offset:2048 sc1
 buffer_load_dwordx4 a[28:31], v4, s[12:15], s53 offen offset:3072 sc1
 s_waitcnt vmcnt(41)
 v_mfma_f32_16x16x32_bf16 v[148:151], a[32:35], v[80:83], v[148:151]
 v_mfma_f32_16x16x32_bf16 v[144:147], a[32:35], v[84:87], v[144:147]
 v_mfma_f32_16x16x32_bf16 v[156:159], a[36:39], v[80:83], v[156:159]
 v_mfma_f32_16x16x32_bf16 v[152:155], a[36:39], v[84:87], v[152:155]
 v_mfma_f32_16x16x32_bf16 v[164:167], a[40:43], v[80:83], v[164:167]
 v_mfma_f32_16x16x32_bf16 v[160:163], a[40:43], v[84:87], v[160:163]
 v_mfma_f32_16x16x32_bf16 v[172:175], a[44:47], v[80:83], v[172:175]
 v_mfma_f32_16x16x32_bf16 v[168:171], a[44:47], v[84:87], v[168:171]
 s_add_u32 s53, s53, 40960
 buffer_load_dwordx4 a[32:35], v4, s[12:15], s53 offen offset:0 sc1
 buffer_load_dwordx4 a[36:39], v4, s[12:15], s53 offen offset:1024 sc1
 buffer_load_dwordx4 a[40:43], v4, s[12:15], s53 offen offset:2048 sc1
 buffer_load_dwordx4 a[44:47], v4, s[12:15], s53 offen offset:3072 sc1
 s_waitcnt vmcnt(41)
 v_mfma_f32_16x16x32_bf16 v[148:151], a[48:51], v[88:91], v[148:151]
 v_mfma_f32_16x16x32_bf16 v[144:147], a[48:51], v[92:95], v[144:147]
 v_mfma_f32_16x16x32_bf16 v[156:159], a[52:55], v[88:91], v[156:159]
 v_mfma_f32_16x16x32_bf16 v[152:155], a[52:55], v[92:95], v[152:155]
 v_mfma_f32_16x16x32_bf16 v[164:167], a[56:59], v[88:91], v[164:167]
 v_mfma_f32_16x16x32_bf16 v[160:163], a[56:59], v[92:95], v[160:163]
 v_mfma_f32_16x16x32_bf16 v[172:175], a[60:63], v[88:91], v[172:175]
 v_mfma_f32_16x16x32_bf16 v[168:171], a[60:63], v[92:95], v[168:171]
 s_add_u32 s53, s53, 40960
 buffer_load_dwordx4 a[48:51], v4, s[12:15], s53 offen offset:0 sc1
 buffer_load_dwordx4 a[52:55], v4, s[12:15], s53 offen offset:1024 sc1
 buffer_load_dwordx4 a[56:59], v4, s[12:15], s53 offen offset:2048 sc1
 buffer_load_dwordx4 a[60:63], v4, s[12:15], s53 offen offset:3072 sc1
 s_waitcnt vmcnt(41)
 v_mfma_f32_16x16x32_bf16 v[144:147], v[32:35], v[128:131], v[144:147]
 v_mfma_f32_16x16x32_bf16 v[148:151], v[32:35], v[132:135], v[148:151]
 v_mfma_f32_16x16x32_bf16 v[152:155], v[36:39], v[128:131], v[152:155]
 v_mfma_f32_16x16x32_bf16 v[156:159], v[36:39], v[132:135], v[156:159]
 v_mfma_f32_16x16x32_bf16 v[160:163], v[40:43], v[128:131], v[160:163]
 v_mfma_f32_16x16x32_bf16 v[164:167], v[40:43], v[132:135], v[164:167]
 v_mfma_f32_16x16x32_bf16 v[168:171], v[44:47], v[128:131], v[168:171]
 v_mfma_f32_16x16x32_bf16 v[172:175], v[44:47], v[132:135], v[172:175]
 buffer_load_dwordx4 v[32:35], v22, s[16:19], s48 offen offset:0 sc1
 buffer_load_dwordx4 v[36:39], v22, s[16:19], s48 offen offset:256 sc1
 buffer_load_dwordx4 v[40:43], v22, s[16:19], s48 offen offset:512 sc1
 buffer_load_dwordx4 v[44:47], v22, s[16:19], s48 offen offset:768 sc1
 s_add_u32 s48, s48, 4096
 s_waitcnt vmcnt(41)
 v_mfma_f32_16x16x32_bf16 v[148:151], a[64:67], v[96:99], v[148:151]
 v_mfma_f32_16x16x32_bf16 v[144:147], a[64:67], v[100:103], v[144:147]
 v_mfma_f32_16x16x32_bf16 v[156:159], a[68:71], v[96:99], v[156:159]
 v_mfma_f32_16x16x32_bf16 v[152:155], a[68:71], v[100:103], v[152:155]
 v_mfma_f32_16x16x32_bf16 v[164:167], a[72:75], v[96:99], v[164:167]
 v_mfma_f32_16x16x32_bf16 v[160:163], a[72:75], v[100:103], v[160:163]
 v_mfma_f32_16x16x32_bf16 v[172:175], a[76:79], v[96:99], v[172:175]
 v_mfma_f32_16x16x32_bf16 v[168:171], a[76:79], v[100:103], v[168:171]
 s_add_u32 s53, s53, 40960
 buffer_load_dwordx4 a[64:67], v4, s[12:15], s53 offen offset:0 sc1
 buffer_load_dwordx4 a[68:71], v4, s[12:15], s53 offen offset:1024 sc1
 buffer_load_dwordx4 a[72:75], v4, s[12:15], s53 offen offset:2048 sc1
 buffer_load_dwordx4 a[76:79], v4, s[12:15], s53 offen offset:3072 sc1
 s_waitcnt vmcnt(41)
 v_mfma_f32_16x16x32_bf16 v[148:151], a[80:83], v[104:107], v[148:151]
 v_mfma_f32_16x16x32_bf16 v[144:147], a[80:83], v[108:111], v[144:147]
 v_mfma_f32_16x16x32_bf16 v[156:159], a[84:87], v[104:107], v[156:159]
 v_mfma_f32_16x16x32_bf16 v[152:155], a[84:87], v[108:111], v[152:155]
 v_mfma_f32_16x16x32_bf16 v[164:167], a[88:91], v[104:107], v[164:167]
 v_mfma_f32_16x16x32_bf16 v[160:163], a[88:91], v[108:111], v[160:163]
 v_mfma_f32_16x16x32_bf16 v[172:175], a[92:95], v[104:107], v[172:175]
 v_mfma_f32_16x16x32_bf16 v[168:171], a[92:95], v[108:111], v[168:171]
 s_add_u32 s53, s53, 40960
 buffer_load_dwordx4 a[80:83], v4, s[12:15], s53 offen offset:0 sc1
 buffer_load_dwordx4 a[84:87], v4, s[12:15], s53 offen offset:1024 sc1
 buffer_load_dwordx4 a[88:91], v4, s[12:15], s53 offen offset:2048 sc1
 buffer_load_dwordx4 a[92:95], v4, s[12:15], s53 offen offset:3072 sc1
 s_waitcnt vmcnt(41)
 v_mfma_f32_16x16x32_bf16 v[148:151], a[96:99], v[112:115], v[148:151]
 v_mfma_f32_16x16x32_bf16 v[144:147], a[96:99], v[116:119], v[144:147]
 v_mfma_f32_16x16x32_bf16 v[156:159], a[100:103], v[112:115], v[156:159]
 v_mfma_f32_16x16x32_bf16 v[152:155], a[100:103], v[116:119], v[152:155]
 v_mfma_f32_16x16x32_bf16 v[164:167], a[104:107], v[112:115], v[164:167]
 v_mfma_f32_16x16x32_bf16 v[160:163], a[104:107], v[116:119], v[160:163]
 v_mfma_f32_16x16x32_bf16 v[172:175], a[108:111], v[112:115], v[172:175]
 v_mfma_f32_16x16x32_bf16 v[168:171], a[108:111], v[116:119], v[168:171]
 s_add_u32 s53, s53, 40960
 buffer_load_dwordx4 a[96:99], v4, s[12:15], s53 offen offset:0 sc1
 buffer_load_dwordx4 a[100:103], v4, s[12:15], s53 offen offset:1024 sc1
 buffer_load_dwordx4 a[104:107], v4, s[12:15], s53 offen offset:2048 sc1
 buffer_load_dwordx4 a[108:111], v4, s[12:15], s53 offen offset:3072 sc1
 s_waitcnt vmcnt(41)
 v_mfma_f32_16x16x32_bf16 v[148:151], a[112:115], v[120:123], v[148:151]
 v_mfma_f32_16x16x32_bf16 v[144:147], a[112:115], v[124:127], v[144:147]
 v_mfma_f32_16x16x32_bf16 v[156:159], a[116:119], v[120:123], v[156:159]
 v_mfma_f32_16x16x32_bf16 v[152:155], a[116:119], v[124:127], v[152:155]
 v_mfma_f32_16x16x32_bf16 v[164:167], a[120:123], v[120:123], v[164:167]
 v_mfma_f32_16x16x32_bf16 v[160:163], a[120:123], v[124:127], v[160:163]
 v_mfma_f32_16x16x32_bf16 v[172:175], a[124:127], v[120:123], v[172:175]
 v_mfma_f32_16x16x32_bf16 v[168:171], a[124:127], v[124:127], v[168:171]
 s_add_u32 s53, s53, 40960
 buffer_load_dwordx4 a[112:115], v4, s[12:15], s53 offen offset:0 sc1
 buffer_load_dwordx4 a[116:119], v4, s[12:15], s53 offen offset:1024 sc1
 buffer_load_dwordx4 a[120:123], v4, s[12:15], s53 offen offset:2048 sc1
 buffer_load_dwordx4 a[124:127], v4, s[12:15], s53 offen offset:3072 sc1
 s_waitcnt vmcnt(41)
 v_mfma_f32_16x16x32_bf16 v[144:147], v[48:51], v[136:139], v[144:147]
 v_mfma_f32_16x16x32_bf16 v[148:151], v[48:51], v[140:143], v[148:151]
 v_mfma_f32_16x16x32_bf16 v[152:155], v[52:55], v[136:139], v[152:155]
 v_mfma_f32_16x16x32_bf16 v[156:159], v[52:55], v[140:143], v[156:159]
 v_mfma_f32_16x16x32_bf16 v[160:163], v[56:59], v[136:139], v[160:163]
 v_mfma_f32_16x16x32_bf16 v[164:167], v[56:59], v[140:143], v[164:167]
 v_mfma_f32_16x16x32_bf16 v[168:171], v[60:63], v[136:139], v[168:171]
 v_mfma_f32_16x16x32_bf16 v[172:175], v[60:63], v[140:143], v[172:175]
 buffer_load_dwordx4 v[48:51], v22, s[16:19], s48 offen offset:0 sc1
 buffer_load_dwordx4 v[52:55], v22, s[16:19], s48 offen offset:256 sc1
 buffer_load_dwordx4 v[56:59], v22, s[16:19], s48 offen offset:512 sc1
 buffer_load_dwordx4 v[60:63], v22, s[16:19], s48 offen offset:768 sc1
 s_add_u32 s48, s48, 4096
 s_waitcnt vmcnt(40)
 s_branch pvy_284
pvy_283:
 s_waitcnt vmcnt(41)
 v_mfma_f32_16x16x32_bf16 v[148:151], a[0:3], v[64:67], 0
 v_mfma_f32_16x16x32_bf16 v[144:147], a[0:3], v[68:71], 0
 v_mfma_f32_16x16x32_bf16 v[156:159], a[4:7], v[64:67], 0
 v_mfma_f32_16x16x32_bf16 v[152:155], a[4:7], v[68:71], 0
 v_mfma_f32_16x16x32_bf16 v[164:167], a[8:11], v[64:67], 0
 v_mfma_f32_16x16x32_bf16 v[160:163], a[8:11], v[68:71], 0
 v_mfma_f32_16x16x32_bf16 v[172:175], a[12:15], v[64:67], 0
 v_mfma_f32_16x16x32_bf16 v[168:171], a[12:15], v[68:71], 0
 s_waitcnt vmcnt(37)
 v_mfma_f32_16x16x32_bf16 v[148:151], a[16:19], v[72:75], v[148:151]
 v_mfma_f32_16x16x32_bf16 v[144:147], a[16:19], v[76:79], v[144:147]
 v_mfma_f32_16x16x32_bf16 v[156:159], a[20:23], v[72:75], v[156:159]
 v_mfma_f32_16x16x32_bf16 v[152:155], a[20:23], v[76:79], v[152:155]
 v_mfma_f32_16x16x32_bf16 v[164:167], a[24:27], v[72:75], v[164:167]
 v_mfma_f32_16x16x32_bf16 v[160:163], a[24:27], v[76:79], v[160:163]
 v_mfma_f32_16x16x32_bf16 v[172:175], a[28:31], v[72:75], v[172:175]
 v_mfma_f32_16x16x32_bf16 v[168:171], a[28:31], v[76:79], v[168:171]
 s_waitcnt vmcnt(33)
 v_mfma_f32_16x16x32_bf16 v[148:151], a[32:35], v[80:83], v[148:151]
 v_mfma_f32_16x16x32_bf16 v[144:147], a[32:35], v[84:87], v[144:147]
 v_mfma_f32_16x16x32_bf16 v[156:159], a[36:39], v[80:83], v[156:159]
 v_mfma_f32_16x16x32_bf16 v[152:155], a[36:39], v[84:87], v[152:155]
 v_mfma_f32_16x16x32_bf16 v[164:167], a[40:43], v[80:83], v[164:167]
 v_mfma_f32_16x16x32_bf16 v[160:163], a[40:43], v[84:87], v[160:163]
 v_mfma_f32_16x16x32_bf16 v[172:175], a[44:47], v[80:83], v[172:175]
 v_mfma_f32_16x16x32_bf16 v[168:171], a[44:47], v[84:87], v[168:171]
 s_waitcnt vmcnt(29)
 v_mfma_f32_16x16x32_bf16 v[148:151], a[48:51], v[88:91], v[148:151]
 v_mfma_f32_16x16x32_bf16 v[144:147], a[48:51], v[92:95], v[144:147]
 v_mfma_f32_16x16x32_bf16 v[156:159], a[52:55], v[88:91], v[156:159]
 v_mfma_f32_16x16x32_bf16 v[152:155], a[52:55], v[92:95], v[152:155]
 v_mfma_f32_16x16x32_bf16 v[164:167], a[56:59], v[88:91], v[164:167]
 v_mfma_f32_16x16x32_bf16 v[160:163], a[56:59], v[92:95], v[160:163]
 v_mfma_f32_16x16x32_bf16 v[172:175], a[60:63], v[88:91], v[172:175]
 v_mfma_f32_16x16x32_bf16 v[168:171], a[60:63], v[92:95], v[168:171]
 s_waitcnt vmcnt(25)
 v_mfma_f32_16x16x32_bf16 v[144:147], v[32:35], v[128:131], v[144:147]
 v_mfma_f32_16x16x32_bf16 v[148:151], v[32:35], v[132:135], v[148:151]
 v_mfma_f32_16x16x32_bf16 v[152:155], v[36:39], v[128:131], v[152:155]
 v_mfma_f32_16x16x32_bf16 v[156:159], v[36:39], v[132:135], v[156:159]
 v_mfma_f32_16x16x32_bf16 v[160:163], v[40:43], v[128:131], v[160:163]
 v_mfma_f32_16x16x32_bf16 v[164:167], v[40:43], v[132:135], v[164:167]
 v_mfma_f32_16x16x32_bf16 v[168:171], v[44:47], v[128:131], v[168:171]
 v_mfma_f32_16x16x32_bf16 v[172:175], v[44:47], v[132:135], v[172:175]
 s_waitcnt vmcnt(21)
 v_mfma_f32_16x16x32_bf16 v[148:151], a[64:67], v[96:99], v[148:151]
 v_mfma_f32_16x16x32_bf16 v[144:147], a[64:67], v[100:103], v[144:147]
 v_mfma_f32_16x16x32_bf16 v[156:159], a[68:71], v[96:99], v[156:159]
 v_mfma_f32_16x16x32_bf16 v[152:155], a[68:71], v[100:103], v[152:155]
 v_mfma_f32_16x16x32_bf16 v[164:167], a[72:75], v[96:99], v[164:167]
 v_mfma_f32_16x16x32_bf16 v[160:163], a[72:75], v[100:103], v[160:163]
 v_mfma_f32_16x16x32_bf16 v[172:175], a[76:79], v[96:99], v[172:175]
 v_mfma_f32_16x16x32_bf16 v[168:171], a[76:79], v[100:103], v[168:171]
 s_waitcnt vmcnt(17)
 v_mfma_f32_16x16x32_bf16 v[148:151], a[80:83], v[104:107], v[148:151]
 v_mfma_f32_16x16x32_bf16 v[144:147], a[80:83], v[108:111], v[144:147]
 v_mfma_f32_16x16x32_bf16 v[156:159], a[84:87], v[104:107], v[156:159]
 v_mfma_f32_16x16x32_bf16 v[152:155], a[84:87], v[108:111], v[152:155]
 v_mfma_f32_16x16x32_bf16 v[164:167], a[88:91], v[104:107], v[164:167]
 v_mfma_f32_16x16x32_bf16 v[160:163], a[88:91], v[108:111], v[160:163]
 v_mfma_f32_16x16x32_bf16 v[172:175], a[92:95], v[104:107], v[172:175]
 v_mfma_f32_16x16x32_bf16 v[168:171], a[92:95], v[108:111], v[168:171]
 s_waitcnt vmcnt(13)
 v_mfma_f32_16x16x32_bf16 v[148:151], a[96:99], v[112:115], v[148:151]
 v_mfma_f32_16x16x32_bf16 v[144:147], a[96:99], v[116:119], v[144:147]
 v_mfma_f32_16x16x32_bf16 v[156:159], a[100:103], v[112:115], v[156:159]
 v_mfma_f32_16x16x32_bf16 v[152:155], a[100:103], v[116:119], v[152:155]
 v_mfma_f32_16x16x32_bf16 v[164:167], a[104:107], v[112:115], v[164:167]
 v_mfma_f32_16x16x32_bf16 v[160:163], a[104:107], v[116:119], v[160:163]
 v_mfma_f32_16x16x32_bf16 v[172:175], a[108:111], v[112:115], v[172:175]
 v_mfma_f32_16x16x32_bf16 v[168:171], a[108:111], v[116:119], v[168:171]
 s_waitcnt vmcnt(9)
 v_mfma_f32_16x16x32_bf16 v[148:151], a[112:115], v[120:123], v[148:151]
 v_mfma_f32_16x16x32_bf16 v[144:147], a[112:115], v[124:127], v[144:147]
 v_mfma_f32_16x16x32_bf16 v[156:159], a[116:119], v[120:123], v[156:159]
 v_mfma_f32_16x16x32_bf16 v[152:155], a[116:119], v[124:127], v[152:155]
 v_mfma_f32_16x16x32_bf16 v[164:167], a[120:123], v[120:123], v[164:167]
 v_mfma_f32_16x16x32_bf16 v[160:163], a[120:123], v[124:127], v[160:163]
 v_mfma_f32_16x16x32_bf16 v[172:175], a[124:127], v[120:123], v[172:175]
 v_mfma_f32_16x16x32_bf16 v[168:171], a[124:127], v[124:127], v[168:171]
 s_waitcnt vmcnt(5)
 v_mfma_f32_16x16x32_bf16 v[144:147], v[48:51], v[136:139], v[144:147]
 v_mfma_f32_16x16x32_bf16 v[148:151], v[48:51], v[140:143], v[148:151]
 v_mfma_f32_16x16x32_bf16 v[152:155], v[52:55], v[136:139], v[152:155]
 v_mfma_f32_16x16x32_bf16 v[156:159], v[52:55], v[140:143], v[156:159]
 v_mfma_f32_16x16x32_bf16 v[160:163], v[56:59], v[136:139], v[160:163]
 v_mfma_f32_16x16x32_bf16 v[164:167], v[56:59], v[140:143], v[164:167]
 v_mfma_f32_16x16x32_bf16 v[168:171], v[60:63], v[136:139], v[168:171]
 v_mfma_f32_16x16x32_bf16 v[172:175], v[60:63], v[140:143], v[172:175]
 s_waitcnt vmcnt(0)
pvy_284:
 s_or_b32 s21, s20, s65
 s_cbranch_scc1 lc_285
 s_sub_u32 s21, s2, 0
 s_cmp_ge_u32 s21, 640
 s_cbranch_scc1 lc_285
 v_mov_b32 v29, 1
 s_mov_b64 exec, 1
 buffer_atomic_add v29, v28, s[32:35], 0 offen sc0 sc1
 s_mov_b64 exec, -1
lc_285:
 v_sub_f32 v25, 1.0, v24
 v_cvt_pk_bf16_f32 v26, v25, v25
 v_lshlrev_b32 v25, 16, v26
 v_cvt_pk_bf16_f32 v26, v12, v12
 v_lshlrev_b32 v12, 16, v26
 v_cvt_pk_bf16_f32 v26, v13, v13
 v_lshlrev_b32 v13, 16, v26
 v_cvt_pk_bf16_f32 v26, v14, v14
 v_lshlrev_b32 v14, 16, v26
 v_cvt_pk_bf16_f32 v26, v15, v15
 v_lshlrev_b32 v15, 16, v26
 v_cvt_pk_bf16_f32 v26, v16, v16
 v_lshlrev_b32 v16, 16, v26
 v_cvt_pk_bf16_f32 v26, v17, v17
 v_lshlrev_b32 v17, 16, v26
 v_cvt_pk_bf16_f32 v26, v18, v18
 v_lshlrev_b32 v18, 16, v26
 v_cvt_pk_bf16_f32 v26, v19, v19
 v_lshlrev_b32 v19, 16, v26
 v_mul_f32 v12, v12, v25
 v_cvt_pk_bf16_f32 v26, v12, v12
 v_lshlrev_b32 v12, 16, v26
 v_mul_f32 v13, v13, v25
 v_cvt_pk_bf16_f32 v26, v13, v13
 v_lshlrev_b32 v13, 16, v26
 v_mul_f32 v14, v14, v25
 v_cvt_pk_bf16_f32 v26, v14, v14
 v_lshlrev_b32 v14, 16, v26
 v_mul_f32 v15, v15, v25
 v_cvt_pk_bf16_f32 v26, v15, v15
 v_lshlrev_b32 v15, 16, v26
 v_mul_f32 v16, v16, v25
 v_cvt_pk_bf16_f32 v26, v16, v16
 v_lshlrev_b32 v16, 16, v26
 v_mul_f32 v17, v17, v25
 v_cvt_pk_bf16_f32 v26, v17, v17
 v_lshlrev_b32 v17, 16, v26
 v_mul_f32 v18, v18, v25
 v_cvt_pk_bf16_f32 v26, v18, v18
 v_lshlrev_b32 v18, 16, v26
 v_mul_f32 v19, v19, v25
 v_cvt_pk_bf16_f32 v26, v19, v19
 v_lshlrev_b32 v19, 16, v26
 ds_write_b128 v10, v[144:147] offset:0
 ds_write_b128 v10, v[148:151] offset:1024
 ds_write_b128 v10, v[152:155] offset:2048
 ds_write_b128 v10, v[156:159] offset:3072
 ds_write_b128 v10, v[160:163] offset:4096
 ds_write_b128 v10, v[164:167] offset:5120
 ds_write_b128 v10, v[168:171] offset:6144
 ds_write_b128 v10, v[172:175] offset:7168
 s_waitcnt lgkmcnt(0)
 s_barrier
 ds_read_b128 v[176:179], v11 offset:0
 ds_read_b128 v[180:183], v11 offset:8192
 ds_read_b128 v[184:187], v11 offset:16384
 ds_read_b128 v[188:191], v11 offset:24576
 ds_read_b128 v[192:195], v11 offset:4096
 ds_read_b128 v[196:199], v11 offset:12288
 ds_read_b128 v[200:203], v11 offset:20480
 ds_read_b128 v[204:207], v11 offset:28672
 s_cmp_ge_u32 s40, 32
 s_cbranch_scc1 pvr_286
 s_waitcnt lgkmcnt(4)
 v_pk_add_f32 v[176:177], v[176:177], v[180:181]
 v_pk_add_f32 v[184:185], v[184:185], v[188:189]
 v_pk_add_f32 v[178:179], v[178:179], v[182:183]
 v_pk_add_f32 v[186:187], v[186:187], v[190:191]
 v_pk_add_f32 v[176:177], v[176:177], v[184:185]
 v_pk_add_f32 v[178:179], v[178:179], v[186:187]
 buffer_store_dwordx4 v[176:179], v4, s[24:27], s54 offen offset:0 sc1
 s_waitcnt lgkmcnt(0)
 v_pk_add_f32 v[192:193], v[192:193], v[196:197]
 v_pk_add_f32 v[200:201], v[200:201], v[204:205]
 v_pk_add_f32 v[194:195], v[194:195], v[198:199]
 v_pk_add_f32 v[202:203], v[202:203], v[206:207]
 v_pk_add_f32 v[192:193], v[192:193], v[200:201]
 v_pk_add_f32 v[194:195], v[194:195], v[202:203]
 buffer_store_dwordx4 v[192:195], v4, s[24:27], s54 offen offset:2048 sc1
 s_lshr_b32 s71, s40, 2
 s_lshl_b32 s71, s71, 7
 s_add_u32 s71, s71, 116736
 s_branch pvr_287
pvr_286:
 s_waitcnt lgkmcnt(4)
 v_pk_add_f32 v[176:177], v[176:177], v[180:181]
 v_pk_add_f32 v[184:185], v[184:185], v[188:189]
 v_pk_add_f32 v[178:179], v[178:179], v[182:183]
 v_pk_add_f32 v[186:187], v[186:187], v[190:191]
 v_pk_add_f32 v[176:177], v[176:177], v[184:185]
 v_pk_add_f32 v[178:179], v[178:179], v[186:187]
 v_cvt_pk_bf16_f32 v26, v176, v177
 v_lshlrev_b32 v176, 16, v26
 v_and_b32 v177, 0xffff0000, v26
 v_mul_f32 v176, v176, v24
 v_mul_f32 v177, v177, v24
 v_cvt_pk_bf16_f32 v26, v176, v177
 v_lshlrev_b32 v176, 16, v26
 v_and_b32 v177, 0xffff0000, v26
 v_add_f32 v176, v176, v12
 v_add_f32 v177, v177, v13
 v_cvt_pk_bf16_f32 v180, v176, v177
 v_cvt_pk_bf16_f32 v26, v178, v179
 v_lshlrev_b32 v178, 16, v26
 v_and_b32 v179, 0xffff0000, v26
 v_mul_f32 v178, v178, v24
 v_mul_f32 v179, v179, v24
 v_cvt_pk_bf16_f32 v26, v178, v179
 v_lshlrev_b32 v178, 16, v26
 v_and_b32 v179, 0xffff0000, v26
 v_add_f32 v178, v178, v14
 v_add_f32 v179, v179, v15
 v_cvt_pk_bf16_f32 v181, v178, v179
 buffer_store_dwordx2 v[180:181], v9, s[8:11], s46 offen offset:0
 s_waitcnt lgkmcnt(0)
 v_pk_add_f32 v[192:193], v[192:193], v[196:197]
 v_pk_add_f32 v[200:201], v[200:201], v[204:205]
 v_pk_add_f32 v[194:195], v[194:195], v[198:199]
 v_pk_add_f32 v[202:203], v[202:203], v[206:207]
 v_pk_add_f32 v[192:193], v[192:193], v[200:201]
 v_pk_add_f32 v[194:195], v[194:195], v[202:203]
 v_cvt_pk_bf16_f32 v26, v192, v193
 v_lshlrev_b32 v192, 16, v26
 v_and_b32 v193, 0xffff0000, v26
 v_mul_f32 v192, v192, v24
 v_mul_f32 v193, v193, v24
 v_cvt_pk_bf16_f32 v26, v192, v193
 v_lshlrev_b32 v192, 16, v26
 v_and_b32 v193, 0xffff0000, v26
 v_add_f32 v192, v192, v16
 v_add_f32 v193, v193, v17
 v_cvt_pk_bf16_f32 v196, v192, v193
 v_cvt_pk_bf16_f32 v26, v194, v195
 v_lshlrev_b32 v194, 16, v26
 v_and_b32 v195, 0xffff0000, v26
 v_mul_f32 v194, v194, v24
 v_mul_f32 v195, v195, v24
 v_cvt_pk_bf16_f32 v26, v194, v195
 v_lshlrev_b32 v194, 16, v26
 v_and_b32 v195, 0xffff0000, v26
 v_add_f32 v194, v194, v18
 v_add_f32 v195, v195, v19
 v_cvt_pk_bf16_f32 v197, v194, v195
 buffer_store_dwordx2 v[196:197], v9, s[8:11], s46 offen offset:64
pvr_287:
 s_branch pvy_281
pvy_282:
 s_sub_u32 s21, s2, 0
 s_cmp_ge_u32 s21, 640
 s_cbranch_scc1 lc_288
 s_cmp_lg_u32 s20, 0
 s_cbranch_scc1 lc_288x
 s_waitcnt vmcnt(2)
 s_mov_b64 exec, 1
 ds_write_b32 v30, v29 offset:12
 s_mov_b64 exec, -1
lc_288x:
 s_waitcnt lgkmcnt(0)
 s_barrier
 ds_read_b32 v23, v30 offset:12
lc_288:
 s_waitcnt lgkmcnt(0)
 v_readfirstlane_b32 s2, v23
 v_readfirstlane_b32 s67, v213
 s_barrier
 s_cmp_lt_u32 s2, 236
 s_cbranch_scc1 pae_289
 s_waitcnt vmcnt(0)
 s_cmp_eq_u32 s71, 0
 s_cbranch_scc1 paf_290
 v_mov_b32 v25, 0
 v_mov_b32 v26, 1
 s_mov_b64 exec, 1
 buffer_atomic_add v26, v25, s[72:75], s71 offen sc1
 s_mov_b64 exec, -1
 s_mov_b32 s71, 0
paf_290:
pae_289:
 s_add_u32 s21, s2, 0
 s_cmp_lt_u32 s2, 236
 s_cbranch_scc1 pv_loop
 s_sub_u32 s2, s2, 236
 s_branch main_fin
 s_branch queue
main_fin:
 s_waitcnt vmcnt(0)
main_end:
 s_endpgm
code_end:
.section .rodata,"a"
.p2align 6
.amdhsa_kernel gated_mix__memory_aug_recurrent_mem_tr__sliding_local_dilated__prompt_kernel
  .amdhsa_next_free_vgpr 512
  .amdhsa_next_free_sgpr 102
  .amdhsa_accum_offset 256
  .amdhsa_group_segment_fixed_size 0
  .amdhsa_kernarg_size 112
  .amdhsa_user_sgpr_count 2
  .amdhsa_user_sgpr_kernarg_segment_ptr 1
  .amdhsa_system_sgpr_workgroup_id_x 1
.end_amdhsa_kernel
.text
```

```asm
; @launch kernel=gated_mix__memory_aug_recurrent_mem_tr__sliding_local_dilated__prompt_kernel grid=(256,1,1) block=(256,1,1) lds=163840
.amdgcn_target "amdgcn-amd-amdhsa--gfx950"
.text
.globl gated_mix__memory_aug_recurrent_mem_tr__sliding_local_dilated__prompt_kernel
.p2align 8
.type gated_mix__memory_aug_recurrent_mem_tr__sliding_local_dilated__prompt_kernel,@function
gated_mix__memory_aug_recurrent_mem_tr__sliding_local_dilated__prompt_kernel:
 s_cmp_ge_u32 s2, 256
 s_cbranch_scc1 end0
 s_load_dwordx2 s[4:5], s[0:1], 96
 s_load_dwordx2 s[38:39], s[0:1], 104
 v_lshrrev_b32 v1, 6, v0
 v_and_b32 v2, 15, v0
 v_readfirstlane_b32 s20, v1
 v_and_b32 v1, 63, v0
 v_lshrrev_b32 v3, 4, v1
 s_getreg_b32 s50, hwreg(HW_REG_XCC_ID)
 s_and_b32 s50, s50, 7
 s_waitcnt lgkmcnt(0)
 s_mov_b32 s32, s4
 s_mov_b32 s33, s5
 s_mov_b32 s34, 256
 s_mov_b32 s35, 0x00020000
 s_getpc_b64 s[6:7]
cpf_pc:
 s_sub_u32 s6, s6, cpf_pc - gated_mix__memory_aug_recurrent_mem_tr__sliding_local_dilated__prompt_kernel
 s_subb_u32 s7, s7, 0
 s_lshr_b32 s21, s2, 3
 s_lshl_b32 s21, s21, 12
 v_lshl_add_u32 v28, v0, 4, s21
 v_min_u32 v28, code_end - gated_mix__memory_aug_recurrent_mem_tr__sliding_local_dilated__prompt_kernel - 16, v28
 global_load_dwordx4 a[252:255], v28, s[6:7]
 v_lshl_add_u32 v28, v0, 4, s21
 v_add_u32 v28, 0x20000, v28
 v_min_u32 v28, code_end - gated_mix__memory_aug_recurrent_mem_tr__sliding_local_dilated__prompt_kernel - 16, v28
 global_load_dwordx4 a[252:255], v28, s[6:7]
 v_mov_b32 v21, 0
 s_cmp_lg_u32 s20, 0
 s_cbranch_scc1 rk_1
 s_and_b32 s21, s50, 1
 s_lshl_b32 s21, s21, 7
 s_lshl_b32 s22, s50, 1
 s_and_b32 s22, s22, 12
 s_add_u32 s21, s21, s22
 v_mov_b32 v22, s21
 v_mov_b32 v23, 1
 s_mov_b64 exec, 1
 buffer_atomic_add v23, v22, s[32:35], 0 offen sc0 sc1
 s_waitcnt vmcnt(0)
 v_readfirstlane_b32 s51, v23
 s_lshl_b32 s22, s50, 5
 s_add_u32 s22, s22, s51
 s_cmp_lt_u32 s51, 32
 s_cbranch_scc1 rk_2
 v_mov_b32 v24, 72
 v_mov_b32 v25, 1
 buffer_atomic_add v25, v24, s[32:35], 0 offen sc0 sc1
 s_waitcnt vmcnt(0)
 v_readfirstlane_b32 s23, v25
 s_mov_b32 s101, 0
 s_mov_b64 exec, -1
 v_lshlrev_b32 v24, 2, v1
rk_3:
 s_sleep 8
 buffer_load_dword v25, v24, s[32:35], 0 offen sc1
 s_add_u32 s101, s101, 1
 s_cmp_gt_u32 s101, 131072
 s_cbranch_scc1 end0
 s_waitcnt vmcnt(0)
 v_readlane_b32 s21, v25, 0
 v_readlane_b32 s22, v25, 32
 s_add_u32 s21, s21, s22
 v_readlane_b32 s22, v25, 1
 s_add_u32 s21, s21, s22
 v_readlane_b32 s22, v25, 33
 s_add_u32 s21, s21, s22
 v_readlane_b32 s22, v25, 2
 s_add_u32 s21, s21, s22
 v_readlane_b32 s22, v25, 34
 s_add_u32 s21, s21, s22
 v_readlane_b32 s22, v25, 3
 s_add_u32 s21, s21, s22
 v_readlane_b32 s22, v25, 35
 s_add_u32 s21, s21, s22
 s_cmp_lt_u32 s21, 256
 s_cbranch_scc1 rk_3
 s_mov_b64 exec, 1
 s_mov_b32 s24, 0
rk_5:
 s_and_b32 s21, s24, 1
 s_lshl_b32 s21, s21, 5
 s_lshr_b32 s22, s24, 1
 s_add_u32 s21, s21, s22
 v_readlane_b32 s21, v25, s21
 s_min_u32 s21, s21, 32
 s_sub_u32 s25, 32, s21
 s_cmp_lt_u32 s23, s25
 s_cbranch_scc1 rk_4
 s_sub_u32 s23, s23, s25
 s_add_u32 s24, s24, 1
 s_cmp_lt_u32 s24, 8
 s_cbranch_scc1 rk_5
 s_branch end0
rk_4:
 s_lshl_b32 s22, s24, 5
 s_add_u32 s22, s22, s21
 s_add_u32 s22, s22, s23
 s_or_b32 s22, s22, 0x100
rk_2:
 v_mov_b32 v23, s22
 ds_write_b32 v21, v23
 s_waitcnt lgkmcnt(0)
 s_mov_b64 exec, -1
rk_1:
 s_barrier
 ds_read_b32 v23, v21
 s_waitcnt lgkmcnt(0)
 v_readfirstlane_b32 s22, v23
 s_barrier
 s_mov_b32 s84, 0
 s_mov_b32 s85, -1
 s_lshr_b32 s53, s22, 8
 s_and_b32 s22, s22, 255
 s_cmp_ge_u32 s22, 128
 s_cbranch_scc1 gemm_side
 s_lshr_b32 s50, s22, 4
 s_and_b32 s51, s22, 15
 s_mov_b32 s86, 0x3dd53b95
 s_load_dwordx2 s[4:5], s[0:1], 8
 s_load_dwordx4 s[36:39], s[0:1], 16
 s_load_dwordx4 s[40:43], s[0:1], 32
 s_load_dwordx2 s[44:45], s[0:1], 104
 s_lshr_b32 s55, s51, 2
 s_and_b32 s56, s51, 3
 s_lshl_b32 s57, s50, 2
 s_add_u32 s58, s57, s55
 s_add_u32 s59, s57, s20
 s_lshr_b32 s21, s51, 1
 s_xor_b32 s21, s21, s55
 s_andn2_b32 s21, 1, s21
 s_xor_b32 s85, s51, s21
 s_mul_i32 s87, s85, 5
 s_lshr_b32 s87, s87, 1
 s_and_b32 s79, s85, 1
 s_waitcnt lgkmcnt(0)
 s_add_u32 s8, s44, 78643200
 s_addc_u32 s9, s45, 0
 s_mov_b32 s10, 2162688
 s_mov_b32 s11, 0x00020000
 s_mov_b32 s16, s44
 s_mov_b32 s17, s45
 s_mov_b32 s18, 50331648
 s_mov_b32 s19, 0x00020000
 s_add_u32 s24, s44, 180355072
 s_addc_u32 s25, s45, 0
 s_mov_b32 s26, 67108864
 s_mov_b32 s27, 0x00020000
 s_mov_b32 s28, s4
 s_mov_b32 s29, s5
 s_mov_b32 s30, 10240
 s_mov_b32 s31, 0x00020000
 s_add_u32 s4, s44, 83886079
 s_addc_u32 s5, s45, 0
 s_and_b32 s4, s4, 0xffe00000
 s_or_b32 s4, s4, 262144
 s_mov_b32 s6, 131072
 s_mov_b32 s7, 0x00020000
 v_mov_b32 v27, 10923
 v_add_u32 v54, 0, v1
 v_mul_u32_u24 v53, v54, v27
 v_lshrrev_b32 v53, 16, v53
 v_mul_u32_u24 v52, 6, v53
 v_sub_u32 v54, v54, v52
 v_mul_u32_u24 v52, 1280, v53
 v_lshl_add_u32 v46, v54, 4, v52
 v_bfe_u32 v52, v53, 1, 1
 v_mul_u32_u24 v52, 20, v52
 v_and_b32 v51, 1, v53
 v_add_u32 v52, v52, v51
 v_lshrrev_b32 v51, 3, v53
 v_mul_u32_u24 v51, 40, v51
 v_bfe_u32 v50, v53, 2, 1
 v_lshl_add_u32 v51, v50, 1, v51
 v_add_u32 v51, v51, v52
 v_mul_u32_u24 v51, 12288, v51
 v_lshl_add_u32 v247, v54, 4, v51
 v_lshrrev_b32 v51, 4, v53
 v_mul_u32_u24 v51, 40, v51
 v_bfe_u32 v50, v53, 2, 2
 v_lshl_add_u32 v51, v50, 1, v51
 v_add_u32 v51, v51, v52
 v_mul_u32_u24 v51, 12288, v51
 v_lshl_add_u32 v244, v54, 4, v51
 v_add_u32 v54, 64, v1
 v_mul_u32_u24 v53, v54, v27
 v_lshrrev_b32 v53, 16, v53
 v_mul_u32_u24 v52, 6, v53
 v_sub_u32 v54, v54, v52
 v_mul_u32_u24 v52, 1280, v53
 v_lshl_add_u32 v47, v54, 4, v52
 v_bfe_u32 v52, v53, 1, 1
 v_mul_u32_u24 v52, 20, v52
 v_and_b32 v51, 1, v53
 v_add_u32 v52, v52, v51
 v_lshrrev_b32 v51, 3, v53
 v_mul_u32_u24 v51, 40, v51
 v_bfe_u32 v50, v53, 2, 1
 v_lshl_add_u32 v51, v50, 1, v51
 v_add_u32 v51, v51, v52
 v_mul_u32_u24 v51, 12288, v51
 v_lshl_add_u32 v248, v54, 4, v51
 v_lshrrev_b32 v51, 4, v53
 v_mul_u32_u24 v51, 40, v51
 v_bfe_u32 v50, v53, 2, 2
 v_lshl_add_u32 v51, v50, 1, v51
 v_add_u32 v51, v51, v52
 v_mul_u32_u24 v51, 12288, v51
 v_lshl_add_u32 v245, v54, 4, v51
 v_add_u32 v54, 128, v1
 v_mul_u32_u24 v53, v54, v27
 v_lshrrev_b32 v53, 16, v53
 v_mul_u32_u24 v52, 6, v53
 v_sub_u32 v54, v54, v52
 v_mul_u32_u24 v52, 1280, v53
 v_lshl_add_u32 v48, v54, 4, v52
 v_bfe_u32 v52, v53, 1, 1
 v_mul_u32_u24 v52, 20, v52
 v_and_b32 v51, 1, v53
 v_add_u32 v52, v52, v51
 v_lshrrev_b32 v51, 3, v53
 v_mul_u32_u24 v51, 40, v51
 v_bfe_u32 v50, v53, 2, 1
 v_lshl_add_u32 v51, v50, 1, v51
 v_add_u32 v51, v51, v52
 v_mul_u32_u24 v51, 12288, v51
 v_lshl_add_u32 v249, v54, 4, v51
 v_lshrrev_b32 v51, 4, v53
 v_mul_u32_u24 v51, 40, v51
 v_bfe_u32 v50, v53, 2, 2
 v_lshl_add_u32 v51, v50, 1, v51
 v_add_u32 v51, v51, v52
 v_mul_u32_u24 v51, 12288, v51
 v_lshl_add_u32 v246, v54, 4, v51
 s_mul_i32 s80, s58, 384
 s_mul_i32 s22, s56, 96
 s_add_u32 s80, s80, s22
 s_mul_i32 s22, s20, 1966080
 s_add_u32 s80, s80, s22
 s_mul_i32 s81, s20, 40448
 s_mul_i32 s82, s59, 245760
 s_lshl_b32 s22, s87, 5
 s_add_u32 s82, s82, s22
 s_mul_i32 s88, s59, 384
 s_mov_b32 s12, s42
 s_mov_b32 s13, s43
 s_mov_b32 s14, 7864320
 s_mov_b32 s15, 0x00020000
 s_add_u32 s21, s82, 0
 s_add_u32 m0, s81, 12288
 s_nop 0
 buffer_load_dwordx4 v46, s[12:15], s21 offen lds
 s_add_u32 m0, s81, 13312
 s_nop 0
 buffer_load_dwordx4 v47, s[12:15], s21 offen lds
 s_add_u32 m0, s81, 14336
 s_nop 0
 buffer_load_dwordx4 v48, s[12:15], s21 offen lds
 s_add_u32 s21, s82, 40960
 s_add_u32 m0, s81, 15360
 s_nop 0
 buffer_load_dwordx4 v46, s[12:15], s21 offen lds
 s_add_u32 m0, s81, 16384
 s_nop 0
 buffer_load_dwordx4 v47, s[12:15], s21 offen lds
 s_add_u32 m0, s81, 17408
 s_nop 0
 buffer_load_dwordx4 v48, s[12:15], s21 offen lds
 s_add_u32 s21, s82, 81920
 s_add_u32 m0, s81, 18432
 s_nop 0
 buffer_load_dwordx4 v46, s[12:15], s21 offen lds
 s_add_u32 m0, s81, 19456
 s_nop 0
 buffer_load_dwordx4 v47, s[12:15], s21 offen lds
 s_add_u32 m0, s81, 20480
 s_nop 0
 buffer_load_dwordx4 v48, s[12:15], s21 offen lds
 s_add_u32 s21, s82, 122880
 s_add_u32 m0, s81, 21504
 s_nop 0
 buffer_load_dwordx4 v46, s[12:15], s21 offen lds
 s_add_u32 m0, s81, 22528
 s_nop 0
 buffer_load_dwordx4 v47, s[12:15], s21 offen lds
 s_add_u32 m0, s81, 23552
 s_nop 0
 buffer_load_dwordx4 v48, s[12:15], s21 offen lds
 s_add_u32 s21, s82, 163840
 s_add_u32 m0, s81, 24576
 s_nop 0
 buffer_load_dwordx4 v46, s[12:15], s21 offen lds
 s_add_u32 m0, s81, 25600
 s_nop 0
 buffer_load_dwordx4 v47, s[12:15], s21 offen lds
 s_add_u32 m0, s81, 26624
 s_nop 0
 buffer_load_dwordx4 v48, s[12:15], s21 offen lds
 s_add_u32 s21, s82, 204800
 s_add_u32 m0, s81, 27648
 s_nop 0
 buffer_load_dwordx4 v46, s[12:15], s21 offen lds
 s_add_u32 m0, s81, 28672
 s_nop 0
 buffer_load_dwordx4 v47, s[12:15], s21 offen lds
 s_add_u32 m0, s81, 29696
 s_nop 0
 buffer_load_dwordx4 v48, s[12:15], s21 offen lds
 s_mov_b32 s12, s40
 s_mov_b32 s13, s41
 s_mov_b32 s14, 7864320
 s_mov_b32 s15, 0x00020000
 s_mov_b32 s40, s38
 s_mov_b32 s41, s39
 s_mov_b32 s38, 7864320
 s_mov_b32 s39, 0x00020000
 s_mov_b32 s42, s38
 s_mov_b32 s43, s39
 v_lshrrev_b32 v250, 2, v2
 v_lshl_add_u32 v250, v3, 3, v250
 v_mul_u32_u24 v250, 96, v250
 v_and_b32 v251, 3, v2
 v_lshlrev_b32 v251, 3, v251
 v_add3_u32 v250, v250, v251, s81
 v_lshlrev_b32 v251, 4, v1
 v_add_u32 v251, s81, v251
 v_lshlrev_b32 v26, 2, v1
 v_mov_b32 v27, 2731
 v_add_u32 v54, 0, v1
 v_mul_u32_u24 v53, v54, v27
 v_lshrrev_b32 v53, 16, v53
 v_mul_u32_u24 v52, 24, v53
 v_sub_u32 v54, v54, v52
 v_bfe_u32 v52, v53, 1, 1
 v_xor_b32 v54, v54, v52
 v_mul_u32_u24 v52, 20, v52
 v_and_b32 v51, 1, v53
 v_add_u32 v52, v52, v51
 v_lshrrev_b32 v51, 2, v53
 v_lshl_add_u32 v52, v51, 1, v52
 v_mul_u32_u24 v52, 12288, v52
 v_subrev_u32 v52, 0, v52
 v_lshl_add_u32 v28, v54, 4, v52
 v_xor_b32 v31, 32, v28
 v_xor_b32 v34, 64, v28
 v_xor_b32 v37, 96, v28
 v_add_u32 v54, 64, v1
 v_mul_u32_u24 v53, v54, v27
 v_lshrrev_b32 v53, 16, v53
 v_mul_u32_u24 v52, 24, v53
 v_sub_u32 v54, v54, v52
 v_bfe_u32 v52, v53, 1, 1
 v_xor_b32 v54, v54, v52
 v_mul_u32_u24 v52, 20, v52
 v_and_b32 v51, 1, v53
 v_add_u32 v52, v52, v51
 v_lshrrev_b32 v51, 2, v53
 v_lshl_add_u32 v52, v51, 1, v52
 v_mul_u32_u24 v52, 12288, v52
 v_subrev_u32 v52, 1024, v52
 v_lshl_add_u32 v29, v54, 4, v52
 v_xor_b32 v32, 32, v29
 v_xor_b32 v35, 64, v29
 v_xor_b32 v38, 96, v29
 v_add_u32 v54, 128, v1
 v_mul_u32_u24 v53, v54, v27
 v_lshrrev_b32 v53, 16, v53
 v_mul_u32_u24 v52, 24, v53
 v_sub_u32 v54, v54, v52
 v_bfe_u32 v52, v53, 1, 1
 v_xor_b32 v54, v54, v52
 v_mul_u32_u24 v52, 20, v52
 v_and_b32 v51, 1, v53
 v_add_u32 v52, v52, v51
 v_lshrrev_b32 v51, 2, v53
 v_lshl_add_u32 v52, v51, 1, v52
 v_mul_u32_u24 v52, 12288, v52
 v_subrev_u32 v52, 2048, v52
 v_lshl_add_u32 v30, v54, 4, v52
 v_xor_b32 v33, 32, v30
 v_xor_b32 v36, 64, v30
 v_xor_b32 v39, 96, v30
 s_add_u32 m0, s81, 0
 s_add_u32 s21, s88, 0
 buffer_load_dwordx4 v28, s[12:15], s21 offen offset:0 lds
 buffer_load_dwordx4 v29, s[12:15], s21 offen offset:1024 lds
 buffer_load_dwordx4 v30, s[12:15], s21 offen offset:2048 lds
 s_add_u32 m0, s81, 3072
 s_add_u32 s21, s88, 49152
 buffer_load_dwordx4 v31, s[12:15], s21 offen offset:0 lds
 buffer_load_dwordx4 v32, s[12:15], s21 offen offset:1024 lds
 buffer_load_dwordx4 v33, s[12:15], s21 offen offset:2048 lds
 s_add_u32 m0, s81, 6144
 s_add_u32 s21, s88, 491520
 buffer_load_dwordx4 v34, s[12:15], s21 offen offset:0 lds
 buffer_load_dwordx4 v35, s[12:15], s21 offen offset:1024 lds
 buffer_load_dwordx4 v36, s[12:15], s21 offen offset:2048 lds
 s_add_u32 m0, s81, 9216
 s_add_u32 s21, s88, 540672
 buffer_load_dwordx4 v37, s[12:15], s21 offen offset:0 lds
 buffer_load_dwordx4 v38, s[12:15], s21 offen offset:1024 lds
 buffer_load_dwordx4 v39, s[12:15], s21 offen offset:2048 lds
 s_add_u32 s22, s80, 0
 buffer_load_dwordx4 v[220:223], v244, s[40:43], s22 offen
 buffer_load_dwordx4 v[224:227], v245, s[40:43], s22 offen
 buffer_load_dwordx4 v[228:231], v246, s[40:43], s22 offen
 s_add_u32 s22, s80, 983040
 buffer_load_dwordx4 v[232:235], v244, s[40:43], s22 offen
 buffer_load_dwordx4 v[236:239], v245, s[40:43], s22 offen
 buffer_load_dwordx4 v[240:243], v246, s[40:43], s22 offen
 v_and_b32 v56, 7, v2
 v_lshrrev_b32 v57, 3, v2
 v_lshlrev_b32 v16, 4, v1
 s_lshr_b32 s21, s20, 1
 s_lshl_b32 s21, s21, 14
 s_and_b32 s22, s20, 1
 s_mul_i32 s22, s22, 3072
 s_add_u32 s21, s21, s22
 v_add_u32 v4, s21, v16
 v_mov_b32 v58, 0x4444
 v_mov_b32 v59, 0xeeee
 v_cmp_eq_u32 vcc, 1, v57
 s_nop 1
 v_cndmask_b32 v25, v58, v59, vcc
 v_mul_u32_u24 v58, 40, v2
 v_lshl_add_u32 v58, v3, 3, v58
 s_mul_i32 s21, s20, 1920
 v_add_u32 v5, s21, v58
 v_lshrrev_b32 v58, 2, v1
 v_mul_u32_u24 v58, 40, v58
 v_and_b32 v59, 3, v1
 v_lshl_add_u32 v6, v59, 3, v58
 v_bfe_u32 v59, v1, 1, 1
 v_mul_u32_u24 v59, 3824, v59
 v_add_u32 v21, v6, v59
 s_lshl_b32 s21, s50, 4
 s_add_u32 s21, s21, s51
 s_lshl_b32 s21, s21, 9
 s_lshl_b32 s22, s20, 7
 s_add_u32 s21, s21, s22
 s_add_u32 s21, s21, 81920
 v_and_b32 v58, 1, v3
 v_lshlrev_b32 v58, 8, v58
 v_lshl_add_u32 v58, v56, 4, v58
 v_lshrrev_b32 v59, 1, v3
 v_lshl_add_u32 v58, v59, 3, v58
 v_add_u32 v7, s21, v58
 s_lshl_b32 s22, s58, 9
 s_lshl_b32 s23, s56, 7
 s_add_u32 s22, s22, s23
 s_add_u32 s22, s22, 376704
 v_lshlrev_b32 v58, 6, v3
 v_lshl_add_u32 v58, v56, 3, v58
 v_add_u32 v58, s22, v58
 s_cmp_eq_u32 s20, 2
 s_cselect_b64 vcc, -1, 0
 v_cndmask_b32 v7, v7, v58, vcc
 s_lshl_b32 s21, s59, 11
 s_add_u32 s21, s21, 81920
 v_add_u32 v8, s21, v16
 s_lshl_b32 s21, s59, 9
 s_add_u32 s21, s21, 376832
 v_lshl_add_u32 v9, v1, 3, s21
 s_mul_i32 s21, s20, 3072
 s_add_u32 s21, s21, 24576
 v_and_b32 v58, 0x39, v1
 v_bfe_u32 v59, v1, 1, 1
 v_lshl_or_b32 v58, v59, 2, v58
 v_bfe_u32 v59, v1, 2, 1
 v_lshl_or_b32 v58, v59, 1, v58
 v_lshl_add_u32 v10, v58, 4, s21
 s_mul_i32 s22, s56, 12
 s_cmp_eq_u32 s20, 2
 s_cselect_b64 vcc, -1, 0
 v_add_u32 v58, s22, v3
 v_add3_u32 v59, 0, v58, v3
 v_lshrrev_b32 v60, 1, v59
 v_and_b32 v59, 1, v59
 v_lshlrev_b32 v59, 3, v59
 v_lshl_add_u32 v61, v60, 7, v59
 v_lshl_add_u32 v61, v56, 4, v61
 s_lshr_b32 s21, s58, 1
 s_lshl_b32 s21, s21, 14
 s_and_b32 s22, s58, 1
 s_mul_i32 s22, s22, 3072
 s_add_u32 s21, s21, s22
 s_add_u32 s21, s21, 655360
 v_add_u32 v62, s21, v61
 v_lshl_add_u32 v61, v60, 8, v59
 v_lshl_add_u32 v61, v2, 4, v61
 s_mul_i32 s21, s58, 12288
 s_and_b32 s22, s20, 1
 s_mul_i32 s22, s22, 6144
 s_add_u32 s21, s21, s22
 v_add_u32 v61, s21, v61
 v_cndmask_b32 v18, v61, v62, vcc
 v_add_u32 v59, 8, v58
 v_lshrrev_b32 v60, 1, v59
 v_and_b32 v59, 1, v59
 v_lshlrev_b32 v59, 3, v59
 v_lshl_add_u32 v61, v60, 7, v59
 v_lshl_add_u32 v61, v56, 4, v61
 s_lshr_b32 s21, s58, 1
 s_lshl_b32 s21, s21, 14
 s_and_b32 s22, s58, 1
 s_mul_i32 s22, s22, 3072
 s_add_u32 s21, s21, s22
 s_add_u32 s21, s21, 655360
 v_add_u32 v62, s21, v61
 v_lshl_add_u32 v61, v60, 8, v59
 v_lshl_add_u32 v61, v2, 4, v61
 s_mul_i32 s21, s58, 12288
 s_and_b32 s22, s20, 1
 s_mul_i32 s22, s22, 6144
 s_add_u32 s21, s21, s22
 v_add_u32 v61, s21, v61
 v_cndmask_b32 v19, v61, v62, vcc
 s_mul_i32 s21, s20, 3072
 s_add_u32 s21, s21, 8192
 v_add_u32 v11, s21, v16
 v_and_b32 v58, 3, v1
 s_lshl_b32 s21, s20, 2
 v_add_u32 v59, s21, v58
 v_cmp_eq_u32 vcc, 10, v59
 s_nop 1
 v_cndmask_b32 v59, v59, 7, vcc
 v_cmp_eq_u32 vcc, 3, v58
 v_lshrrev_b32 v60, 5, v1
 v_mul_u32_u24 v60, 10, v60
 v_cndmask_b32 v59, v59, 3, vcc
 s_lshl_b32 s21, s79, 2
 v_add3_u32 v59, v59, v60, s21
 v_lshrrev_b32 v60, 1, v59
 v_lshlrev_b32 v60, 8, v60
 v_and_b32 v59, 1, v59
 v_lshl_add_u32 v60, v59, 3, v60
 v_bfe_u32 v59, v1, 2, 3
 v_lshl_add_u32 v60, v59, 4, v60
 v_add_u32 v12, 8192, v60
 s_mov_b32 s21, 0x07060100
 s_cmp_eq_u32 s20, 1
 s_cselect_b32 s21, 0x07060302, s21
 s_cmp_eq_u32 s20, 2
 s_cselect_b32 s21, 0x07060c0c, s21
 v_mov_b32 v59, s21
 v_mov_b32 v60, 0x03020100
 v_cndmask_b32 v14, v60, v59, vcc
 s_lshr_b32 s21, s85, 3
 s_lshl_b32 s21, s21, 14
 s_bfe_u32 s22, s85, 0x10002
 s_mul_i32 s22, s22, 3072
 s_add_u32 s21, s21, s22
 s_and_b32 s22, s85, 3
 s_lshl_b32 s22, s22, 8
 s_add_u32 s21, s21, s22
 s_lshl_b32 s22, s20, 10
 s_add_u32 s22, s22, s21
 v_lshl_add_u32 v13, v1, 2, s22
 v_lshlrev_b32 v59, 10, v3
 v_lshl_add_u32 v59, v2, 4, v59
 v_add_u32 v59, s21, v59
 s_cmp_eq_u32 s20, 3
 s_cselect_b64 vcc, -1, 0
 v_cndmask_b32 v13, v13, v59, vcc
 s_mov_b32 s91, 0x3c000000
 v_and_b32 v59, 1, v3
 v_lshrrev_b32 v60, 1, v3
 v_lshl_add_u32 v59, v59, 1, v60
 v_add_u32 v59, s87, v59
 v_lshrrev_b32 v60, 2, v59
 v_and_b32 v59, 3, v59
 v_lshlrev_b32 v59, 8, v59
 v_lshl_add_u32 v59, v60, 16, v59
 v_lshl_add_u32 v59, v2, 4, v59
 s_lshr_b32 s21, s59, 3
 s_lshl_b32 s21, s21, 14
 s_and_b32 s22, s59, 7
 s_lshl_b32 s22, s22, 10
 s_add_u32 s21, s21, s22
 v_add_u32 v15, s21, v59
 s_lshl_b32 s21, s79, 4
 s_lshl_b32 s76, -1, s21
 s_mov_b32 s77, 0xffff
 s_lshl_b32 s21, s79, 7
 v_or_b32 v17, s21, v16
 s_or_b32 s21, s21, 0xffffff7f
 v_and_b32 v20, s21, v16
 v_lshlrev_b32 v24, 3, v1
 v_cmp_gt_u32 s[60:61], 8, v2
 v_cmp_le_u32 s[62:63], 8, v2
 v_cmp_le_u32 s[72:73], 2, v3
 v_cmp_gt_u32 s[70:71], 48, v1
 s_nop 1
 s_and_b64 s[64:65], s[60:61], s[72:73]
 s_cmp_eq_u32 s20, 2
 s_cselect_b64 s[74:75], s[64:65], s[60:61]
 s_waitcnt vmcnt(18)
 ds_read_b64_tr_b16 v[64:65], v250 offset:12288
 ds_read_b64_tr_b16 v[66:67], v250 offset:12672
 ds_read_b64_tr_b16 v[88:89], v250 offset:12320
 ds_read_b64_tr_b16 v[90:91], v250 offset:12704
 ds_read_b64_tr_b16 v[112:113], v250 offset:12352
 ds_read_b64_tr_b16 v[114:115], v250 offset:12736
 ds_read_b64_tr_b16 v[68:69], v250 offset:15360
 ds_read_b64_tr_b16 v[70:71], v250 offset:15744
 ds_read_b64_tr_b16 v[92:93], v250 offset:15392
 ds_read_b64_tr_b16 v[94:95], v250 offset:15776
 ds_read_b64_tr_b16 v[116:117], v250 offset:15424
 ds_read_b64_tr_b16 v[118:119], v250 offset:15808
 ds_read_b64_tr_b16 v[72:73], v250 offset:18432
 ds_read_b64_tr_b16 v[74:75], v250 offset:18816
 ds_read_b64_tr_b16 v[96:97], v250 offset:18464
 ds_read_b64_tr_b16 v[98:99], v250 offset:18848
 ds_read_b64_tr_b16 v[120:121], v250 offset:18496
 ds_read_b64_tr_b16 v[122:123], v250 offset:18880
 ds_read_b64_tr_b16 v[76:77], v250 offset:21504
 ds_read_b64_tr_b16 v[78:79], v250 offset:21888
 ds_read_b64_tr_b16 v[100:101], v250 offset:21536
 ds_read_b64_tr_b16 v[102:103], v250 offset:21920
 ds_read_b64_tr_b16 v[124:125], v250 offset:21568
 ds_read_b64_tr_b16 v[126:127], v250 offset:21952
 ds_read_b64_tr_b16 v[80:81], v250 offset:24576
 ds_read_b64_tr_b16 v[82:83], v250 offset:24960
 ds_read_b64_tr_b16 v[104:105], v250 offset:24608
 ds_read_b64_tr_b16 v[106:107], v250 offset:24992
 ds_read_b64_tr_b16 v[128:129], v250 offset:24640
 ds_read_b64_tr_b16 v[130:131], v250 offset:25024
 ds_read_b64_tr_b16 v[84:85], v250 offset:27648
 ds_read_b64_tr_b16 v[86:87], v250 offset:28032
 ds_read_b64_tr_b16 v[108:109], v250 offset:27680
 ds_read_b64_tr_b16 v[110:111], v250 offset:28064
 ds_read_b64_tr_b16 v[132:133], v250 offset:27712
 ds_read_b64_tr_b16 v[134:135], v250 offset:28096
 s_waitcnt lgkmcnt(0)
 s_add_u32 m0, s81, 12288
 s_add_u32 s21, s88, 983040
 buffer_load_dwordx4 v28, s[12:15], s21 offen offset:0 lds
 buffer_load_dwordx4 v29, s[12:15], s21 offen offset:1024 lds
 buffer_load_dwordx4 v30, s[12:15], s21 offen offset:2048 lds
 s_add_u32 m0, s81, 15360
 s_add_u32 s21, s88, 1032192
 buffer_load_dwordx4 v31, s[12:15], s21 offen offset:0 lds
 buffer_load_dwordx4 v32, s[12:15], s21 offen offset:1024 lds
 buffer_load_dwordx4 v33, s[12:15], s21 offen offset:2048 lds
 s_add_u32 m0, s81, 18432
 s_add_u32 s21, s88, 1474560
 buffer_load_dwordx4 v34, s[12:15], s21 offen offset:0 lds
 buffer_load_dwordx4 v35, s[12:15], s21 offen offset:1024 lds
 buffer_load_dwordx4 v36, s[12:15], s21 offen offset:2048 lds
 s_add_u32 m0, s81, 21504
 s_add_u32 s21, s88, 1523712
 buffer_load_dwordx4 v37, s[12:15], s21 offen offset:0 lds
 buffer_load_dwordx4 v38, s[12:15], s21 offen offset:1024 lds
 buffer_load_dwordx4 v39, s[12:15], s21 offen offset:2048 lds
 s_add_u32 m0, s81, 24576
 s_add_u32 s21, s88, 98304
 buffer_load_dwordx4 v28, s[12:15], s21 offen offset:0 lds
 buffer_load_dwordx4 v29, s[12:15], s21 offen offset:1024 lds
 buffer_load_dwordx4 v30, s[12:15], s21 offen offset:2048 lds
 s_add_u32 m0, s81, 27648
 s_add_u32 s21, s88, 147456
 buffer_load_dwordx4 v31, s[12:15], s21 offen offset:0 lds
 buffer_load_dwordx4 v32, s[12:15], s21 offen offset:1024 lds
 buffer_load_dwordx4 v33, s[12:15], s21 offen offset:2048 lds
 s_add_u32 m0, s81, 30720
 s_add_u32 s21, s88, 589824
 buffer_load_dwordx4 v34, s[12:15], s21 offen offset:0 lds
 buffer_load_dwordx4 v35, s[12:15], s21 offen offset:1024 lds
 buffer_load_dwordx4 v36, s[12:15], s21 offen offset:2048 lds
 s_add_u32 m0, s81, 33792
 s_add_u32 s21, s88, 638976
 buffer_load_dwordx4 v37, s[12:15], s21 offen offset:0 lds
 buffer_load_dwordx4 v38, s[12:15], s21 offen offset:1024 lds
 buffer_load_dwordx4 v39, s[12:15], s21 offen offset:2048 lds
 v_lshrrev_b32 v40, 2, v2
 v_and_b32 v41, 3, v2
 v_lshl_add_u32 v41, v40, 3, v41
 v_mul_u32_u24 v41, 384, v41
 v_add_u32 v41, s81, v41
 v_lshrrev_b32 v40, 1, v2
 v_xor_b32 v40, v40, v3
 v_lshl_add_u32 v22, v40, 4, v41
 v_xor_b32 v40, 4, v40
 v_lshl_add_u32 v23, v40, 4, v41
 s_mul_i32 s64, s59, 40960
 s_lshl_b32 s21, s87, 10
 s_add_u32 s64, s64, s21
 s_add_u32 s64, s64, 1310720
 s_lshl_b32 s79, s59, 7
 s_and_b32 s21, s51, 12
 s_lshl_b32 s21, s21, 10
 s_add_u32 s79, s79, s21
 s_add_u32 s79, s79, 95232
 s_lshl_b32 s90, s58, 7
 s_add_u32 s90, s90, 19456
 s_cmp_eq_u32 s56, 0
 s_cselect_b32 s66, s90, 0x80000000
 s_bfe_u32 s82, s50, 0x10001
 s_lshl_b32 s82, s82, 5
 s_lshr_b32 s21, s50, 2
 s_add_u32 s82, s82, s21
 s_and_b32 s83, s50, 1
 s_lshl_b32 s83, s83, 4
 s_add_u32 s83, s83, 16
 s_waitcnt vmcnt(30)
 ds_read_b128 v[136:139], v22 offset:0
 ds_read_b128 v[140:143], v23 offset:0
 ds_read_b128 v[144:147], v22 offset:128
 s_waitcnt lgkmcnt(2)
 v_mfma_f32_16x16x32_bf16 v[40:43], v[136:139], v[64:67], 0
 ds_read_b128 v[148:151], v23 offset:128
 s_waitcnt vmcnt(27)
 ds_write_b128 v251, v[220:223] offset:36864
 v_mfma_f32_16x16x32_bf16 v[48:51], v[136:139], v[88:91], 0
 ds_write_b128 v251, v[224:227] offset:37888
 ds_write_b128 v251, v[228:231] offset:38912
 ds_read_b64_tr_b16 v[208:209], v250 offset:36864
 v_mfma_f32_16x16x32_bf16 v[56:59], v[136:139], v[112:115], 0
 ds_read_b64_tr_b16 v[210:211], v250 offset:37248
 ds_read_b64_tr_b16 v[212:213], v250 offset:36896
 ds_read_b64_tr_b16 v[214:215], v250 offset:37280
 ds_read_b64_tr_b16 v[216:217], v250 offset:36928
 s_waitcnt lgkmcnt(10)
 v_mfma_f32_16x16x32_bf16 v[40:43], v[140:143], v[68:71], v[40:43]
 ds_read_b128 v[136:139], v22 offset:256
 ds_read_b64_tr_b16 v[218:219], v250 offset:37312
 s_add_u32 s22, s80, 98304
 buffer_load_dwordx4 v[220:223], v244, s[40:43], s22 offen
 v_mfma_f32_16x16x32_bf16 v[48:51], v[140:143], v[92:95], v[48:51]
 buffer_load_dwordx4 v[224:227], v245, s[40:43], s22 offen
 buffer_load_dwordx4 v[228:231], v246, s[40:43], s22 offen
 v_mfma_f32_16x16x32_bf16 v[56:59], v[140:143], v[116:119], v[56:59]
 s_waitcnt lgkmcnt(11)
 v_mfma_f32_16x16x32_bf16 v[40:43], v[144:147], v[72:75], v[40:43]
 ds_read_b128 v[140:143], v23 offset:256
 v_mfma_f32_16x16x32_bf16 v[48:51], v[144:147], v[96:99], v[48:51]
 v_mfma_f32_16x16x32_bf16 v[56:59], v[144:147], v[120:123], v[56:59]
 s_waitcnt lgkmcnt(11)
 v_mfma_f32_16x16x32_bf16 v[40:43], v[148:151], v[76:79], v[40:43]
 ds_read_b128 v[144:147], v22 offset:1536
 v_mfma_f32_16x16x32_bf16 v[48:51], v[148:151], v[100:103], v[48:51]
 s_waitcnt lgkmcnt(2)
 v_lshlrev_b32 v27, 16, v208
 v_and_b32 v208, 0xffff0000, v208
 v_cvt_pk_f16_f32 v208, v27, v208
 v_accvgpr_write_b32 a60, v208
 v_mfma_f32_16x16x32_bf16 v[56:59], v[148:151], v[124:127], v[56:59]
 v_lshlrev_b32 v27, 16, v209
 v_and_b32 v209, 0xffff0000, v209
 v_cvt_pk_f16_f32 v209, v27, v209
 v_accvgpr_write_b32 a61, v209
 s_waitcnt lgkmcnt(3)
 v_mfma_f32_16x16x32_bf16 v[40:43], v[136:139], v[80:83], v[40:43]
 ds_read_b128 v[148:151], v23 offset:1536
 v_lshlrev_b32 v27, 16, v210
 v_and_b32 v210, 0xffff0000, v210
 v_cvt_pk_f16_f32 v210, v27, v210
 v_accvgpr_write_b32 a62, v210
 v_mfma_f32_16x16x32_bf16 v[48:51], v[136:139], v[104:107], v[48:51]
 v_lshlrev_b32 v27, 16, v211
 v_and_b32 v211, 0xffff0000, v211
 v_cvt_pk_f16_f32 v211, v27, v211
 v_accvgpr_write_b32 a63, v211
 v_lshlrev_b32 v27, 16, v212
 v_mfma_f32_16x16x32_bf16 v[56:59], v[136:139], v[128:131], v[56:59]
 v_and_b32 v212, 0xffff0000, v212
 v_cvt_pk_f16_f32 v212, v27, v212
 v_accvgpr_write_b32 a80, v212
 v_lshlrev_b32 v27, 16, v213
 s_waitcnt lgkmcnt(2)
 v_mfma_f32_16x16x32_bf16 v[40:43], v[140:143], v[84:87], v[40:43]
 ds_read_b128 v[136:139], v22 offset:1664
 v_and_b32 v213, 0xffff0000, v213
 v_cvt_pk_f16_f32 v213, v27, v213
 v_accvgpr_write_b32 a81, v213
 v_lshlrev_b32 v27, 16, v214
 v_mfma_f32_16x16x32_bf16 v[48:51], v[140:143], v[108:111], v[48:51]
 v_and_b32 v214, 0xffff0000, v214
 v_cvt_pk_f16_f32 v214, v27, v214
 v_accvgpr_write_b32 a82, v214
 v_lshlrev_b32 v27, 16, v215
 v_and_b32 v215, 0xffff0000, v215
 v_mfma_f32_16x16x32_bf16 v[56:59], v[140:143], v[132:135], v[56:59]
 v_cvt_pk_f16_f32 v215, v27, v215
 v_accvgpr_write_b32 a83, v215
 v_lshlrev_b32 v27, 16, v216
 v_and_b32 v216, 0xffff0000, v216
 s_waitcnt lgkmcnt(2)
 v_mfma_f32_16x16x32_bf16 v[44:47], v[144:147], v[64:67], 0
 ds_read_b128 v[140:143], v23 offset:1664
 v_cvt_pk_f16_f32 v216, v27, v216
 v_accvgpr_write_b32 a100, v216
 v_lshlrev_b32 v27, 16, v217
 v_and_b32 v217, 0xffff0000, v217
 v_mfma_f32_16x16x32_bf16 v[52:55], v[144:147], v[88:91], 0
 v_cvt_pk_f16_f32 v217, v27, v217
 v_accvgpr_write_b32 a101, v217
 v_lshlrev_b32 v27, 16, v218
 v_and_b32 v218, 0xffff0000, v218
 v_cvt_pk_f16_f32 v218, v27, v218
 v_mfma_f32_16x16x32_bf16 v[60:63], v[144:147], v[112:115], 0
 v_accvgpr_write_b32 a102, v218
 v_lshlrev_b32 v27, 16, v219
 v_and_b32 v219, 0xffff0000, v219
 v_cvt_pk_f16_f32 v219, v27, v219
 s_waitcnt lgkmcnt(2)
 v_mfma_f32_16x16x32_bf16 v[44:47], v[148:151], v[68:71], v[44:47]
 ds_read_b128 v[144:147], v22 offset:1792
 v_cvt_pk_f16_f32 v40, v40, v41
 v_accvgpr_write_b32 a103, v219
 v_accvgpr_write_b32 a120, v40
 v_cvt_pk_f16_f32 v42, v42, v43
 v_mfma_f32_16x16x32_bf16 v[52:55], v[148:151], v[92:95], v[52:55]
 v_accvgpr_write_b32 a121, v42
 v_cvt_pk_f16_f32 v48, v48, v49
 v_accvgpr_write_b32 a128, v48
 v_cvt_pk_f16_f32 v50, v50, v51
 v_accvgpr_write_b32 a129, v50
 v_mfma_f32_16x16x32_bf16 v[60:63], v[148:151], v[116:119], v[60:63]
 v_cvt_pk_f16_f32 v56, v56, v57
 v_accvgpr_write_b32 a136, v56
 v_cvt_pk_f16_f32 v58, v58, v59
 v_accvgpr_write_b32 a137, v58
 s_waitcnt lgkmcnt(2)
 v_mfma_f32_16x16x32_bf16 v[44:47], v[136:139], v[72:75], v[44:47]
 ds_read_b128 v[148:151], v23 offset:1792
 v_mfma_f32_16x16x32_bf16 v[52:55], v[136:139], v[96:99], v[52:55]
 v_mfma_f32_16x16x32_bf16 v[60:63], v[136:139], v[120:123], v[60:63]
 s_waitcnt lgkmcnt(2)
 v_mfma_f32_16x16x32_bf16 v[44:47], v[140:143], v[76:79], v[44:47]
 s_waitcnt vmcnt(15)
 ds_read_b128 v[136:139], v22 offset:12288
 v_mfma_f32_16x16x32_bf16 v[52:55], v[140:143], v[100:103], v[52:55]
 v_mfma_f32_16x16x32_bf16 v[60:63], v[140:143], v[124:127], v[60:63]
 s_waitcnt lgkmcnt(2)
 v_mfma_f32_16x16x32_bf16 v[44:47], v[144:147], v[80:83], v[44:47]
 ds_read_b128 v[140:143], v23 offset:12288
 v_mfma_f32_16x16x32_bf16 v[52:55], v[144:147], v[104:107], v[52:55]
 v_mfma_f32_16x16x32_bf16 v[60:63], v[144:147], v[128:131], v[60:63]
 s_waitcnt lgkmcnt(2)
 v_mfma_f32_16x16x32_bf16 v[44:47], v[148:151], v[84:87], v[44:47]
 ds_read_b128 v[144:147], v22 offset:12416
 s_add_u32 m0, s81, 0
 s_add_u32 s21, s88, 1081344
 v_mfma_f32_16x16x32_bf16 v[52:55], v[148:151], v[108:111], v[52:55]
 buffer_load_dwordx4 v28, s[12:15], s21 offen offset:0 lds
 v_mfma_f32_16x16x32_bf16 v[60:63], v[148:151], v[132:135], v[60:63]
 buffer_load_dwordx4 v29, s[12:15], s21 offen offset:1024 lds
 s_waitcnt lgkmcnt(2)
 v_mfma_f32_16x16x32_bf16 v[40:43], v[136:139], v[64:67], 0
 ds_read_b128 v[148:151], v23 offset:12416
 buffer_load_dwordx4 v30, s[12:15], s21 offen offset:2048 lds
 s_waitcnt vmcnt(30)
 v_mfma_f32_16x16x32_bf16 v[48:51], v[136:139], v[88:91], 0
 s_add_u32 m0, s81, 3072
 s_add_u32 s21, s88, 1130496
 ds_write_b128 v251, v[232:235] offset:36864
 v_mfma_f32_16x16x32_bf16 v[56:59], v[136:139], v[112:115], 0
 buffer_load_dwordx4 v31, s[12:15], s21 offen offset:0 lds
 ds_write_b128 v251, v[236:239] offset:37888
 s_waitcnt lgkmcnt(4)
 v_mfma_f32_16x16x32_bf16 v[40:43], v[140:143], v[68:71], v[40:43]
 ds_read_b128 v[136:139], v22 offset:12544
 v_cvt_pk_f16_f32 v44, v44, v45
 buffer_load_dwordx4 v32, s[12:15], s21 offen offset:1024 lds
 v_accvgpr_write_b32 a122, v44
 v_mfma_f32_16x16x32_bf16 v[48:51], v[140:143], v[92:95], v[48:51]
 v_cvt_pk_f16_f32 v46, v46, v47
 buffer_load_dwordx4 v33, s[12:15], s21 offen offset:2048 lds
 ds_write_b128 v251, v[240:243] offset:38912
 v_mfma_f32_16x16x32_bf16 v[56:59], v[140:143], v[116:119], v[56:59]
 v_accvgpr_write_b32 a123, v46
 s_add_u32 m0, s81, 6144
 s_add_u32 s21, s88, 1572864
 ds_read_b64_tr_b16 v[208:209], v250 offset:36864
 s_waitcnt lgkmcnt(6)
 v_mfma_f32_16x16x32_bf16 v[40:43], v[144:147], v[72:75], v[40:43]
 ds_read_b128 v[140:143], v23 offset:12544
 v_cvt_pk_f16_f32 v52, v52, v53
 buffer_load_dwordx4 v34, s[12:15], s21 offen offset:0 lds
 ds_read_b64_tr_b16 v[210:211], v250 offset:37248
 v_mfma_f32_16x16x32_bf16 v[48:51], v[144:147], v[96:99], v[48:51]
 v_accvgpr_write_b32 a130, v52
 buffer_load_dwordx4 v35, s[12:15], s21 offen offset:1024 lds
 ds_read_b64_tr_b16 v[212:213], v250 offset:36896
 ds_read_b64_tr_b16 v[214:215], v250 offset:37280
 v_mfma_f32_16x16x32_bf16 v[56:59], v[144:147], v[120:123], v[56:59]
 v_cvt_pk_f16_f32 v54, v54, v55
 buffer_load_dwordx4 v36, s[12:15], s21 offen offset:2048 lds
 ds_read_b64_tr_b16 v[216:217], v250 offset:36928
 s_waitcnt lgkmcnt(10)
 v_mfma_f32_16x16x32_bf16 v[40:43], v[148:151], v[76:79], v[40:43]
 ds_read_b128 v[144:147], v22 offset:13824
 v_accvgpr_write_b32 a131, v54
 s_add_u32 m0, s81, 9216
 s_add_u32 s21, s88, 1622016
 ds_read_b64_tr_b16 v[218:219], v250 offset:37312
 v_mfma_f32_16x16x32_bf16 v[48:51], v[148:151], v[100:103], v[48:51]
 v_cvt_pk_f16_f32 v60, v60, v61
 buffer_load_dwordx4 v37, s[12:15], s21 offen offset:0 lds
 s_add_u32 s22, s80, 1081344
 v_accvgpr_write_b32 a138, v60
 v_mfma_f32_16x16x32_bf16 v[56:59], v[148:151], v[124:127], v[56:59]
 v_cvt_pk_f16_f32 v62, v62, v63
 buffer_load_dwordx4 v38, s[12:15], s21 offen offset:1024 lds
 v_accvgpr_write_b32 a139, v62
 s_waitcnt lgkmcnt(9)
 v_mfma_f32_16x16x32_bf16 v[40:43], v[136:139], v[80:83], v[40:43]
 ds_read_b128 v[148:151], v23 offset:13824
 buffer_load_dwordx4 v39, s[12:15], s21 offen offset:2048 lds
 buffer_load_dwordx4 v[232:235], v244, s[40:43], s22 offen
 v_mfma_f32_16x16x32_bf16 v[48:51], v[136:139], v[104:107], v[48:51]
 buffer_load_dwordx4 v[236:239], v245, s[40:43], s22 offen
 buffer_load_dwordx4 v[240:243], v246, s[40:43], s22 offen
 v_mfma_f32_16x16x32_bf16 v[56:59], v[136:139], v[128:131], v[56:59]
 s_waitcnt lgkmcnt(7)
 v_mfma_f32_16x16x32_bf16 v[40:43], v[140:143], v[84:87], v[40:43]
 ds_read_b128 v[136:139], v22 offset:13952
 v_mfma_f32_16x16x32_bf16 v[48:51], v[140:143], v[108:111], v[48:51]
 v_mfma_f32_16x16x32_bf16 v[56:59], v[140:143], v[132:135], v[56:59]
 s_waitcnt lgkmcnt(3)
 v_mfma_f32_16x16x32_bf16 v[44:47], v[144:147], v[64:67], 0
 ds_read_b128 v[140:143], v23 offset:13952
 v_mfma_f32_16x16x32_bf16 v[52:55], v[144:147], v[88:91], 0
 s_waitcnt lgkmcnt(3)
 v_lshlrev_b32 v27, 16, v208
 v_and_b32 v208, 0xffff0000, v208
 v_cvt_pk_f16_f32 v208, v27, v208
 v_accvgpr_write_b32 a64, v208
 v_mfma_f32_16x16x32_bf16 v[60:63], v[144:147], v[112:115], 0
 v_lshlrev_b32 v27, 16, v209
 v_and_b32 v209, 0xffff0000, v209
 v_cvt_pk_f16_f32 v209, v27, v209
 v_accvgpr_write_b32 a65, v209
 s_waitcnt lgkmcnt(2)
 v_mfma_f32_16x16x32_bf16 v[44:47], v[148:151], v[68:71], v[44:47]
 ds_read_b128 v[144:147], v22 offset:14080
 v_cvt_pk_f16_f32 v40, v40, v41
 v_lshlrev_b32 v27, 16, v210
 v_and_b32 v210, 0xffff0000, v210
 v_cvt_pk_f16_f32 v210, v27, v210
 v_mfma_f32_16x16x32_bf16 v[52:55], v[148:151], v[92:95], v[52:55]
 v_accvgpr_write_b32 a124, v40
 v_accvgpr_write_b32 a66, v210
 v_lshlrev_b32 v27, 16, v211
 v_and_b32 v211, 0xffff0000, v211
 v_cvt_pk_f16_f32 v211, v27, v211
 v_mfma_f32_16x16x32_bf16 v[60:63], v[148:151], v[116:119], v[60:63]
 v_cvt_pk_f16_f32 v42, v42, v43
 v_accvgpr_write_b32 a67, v211
 v_lshlrev_b32 v27, 16, v212
 v_and_b32 v212, 0xffff0000, v212
 s_waitcnt lgkmcnt(2)
 v_mfma_f32_16x16x32_bf16 v[44:47], v[136:139], v[72:75], v[44:47]
 ds_read_b128 v[148:151], v23 offset:14080
 v_accvgpr_write_b32 a125, v42
 v_cvt_pk_f16_f32 v212, v27, v212
 v_accvgpr_write_b32 a84, v212
 v_lshlrev_b32 v27, 16, v213
 v_mfma_f32_16x16x32_bf16 v[52:55], v[136:139], v[96:99], v[52:55]
 v_cvt_pk_f16_f32 v48, v48, v49
 v_and_b32 v213, 0xffff0000, v213
 v_cvt_pk_f16_f32 v213, v27, v213
 v_accvgpr_write_b32 a85, v213
 v_lshlrev_b32 v27, 16, v214
 v_mfma_f32_16x16x32_bf16 v[60:63], v[136:139], v[120:123], v[60:63]
 v_accvgpr_write_b32 a132, v48
 v_and_b32 v214, 0xffff0000, v214
 v_cvt_pk_f16_f32 v214, v27, v214
 v_accvgpr_write_b32 a86, v214
 s_waitcnt lgkmcnt(2)
 v_mfma_f32_16x16x32_bf16 v[44:47], v[140:143], v[76:79], v[44:47]
 s_waitcnt vmcnt(18)
 ds_read_b128 v[136:139], v22 offset:24576
 v_cvt_pk_f16_f32 v50, v50, v51
 v_lshlrev_b32 v27, 16, v215
 v_and_b32 v215, 0xffff0000, v215
 v_cvt_pk_f16_f32 v215, v27, v215
 v_mfma_f32_16x16x32_bf16 v[52:55], v[140:143], v[100:103], v[52:55]
 v_accvgpr_write_b32 a133, v50
 v_accvgpr_write_b32 a87, v215
 v_lshlrev_b32 v27, 16, v216
 v_and_b32 v216, 0xffff0000, v216
 v_cvt_pk_f16_f32 v216, v27, v216
 v_mfma_f32_16x16x32_bf16 v[60:63], v[140:143], v[124:127], v[60:63]
 v_cvt_pk_f16_f32 v56, v56, v57
 v_accvgpr_write_b32 a104, v216
 v_lshlrev_b32 v27, 16, v217
 v_and_b32 v217, 0xffff0000, v217
 s_waitcnt lgkmcnt(2)
 v_mfma_f32_16x16x32_bf16 v[44:47], v[144:147], v[80:83], v[44:47]
 ds_read_b128 v[140:143], v23 offset:24576
 v_accvgpr_write_b32 a140, v56
 v_cvt_pk_f16_f32 v217, v27, v217
 v_accvgpr_write_b32 a105, v217
 v_lshlrev_b32 v27, 16, v218
 v_mfma_f32_16x16x32_bf16 v[52:55], v[144:147], v[104:107], v[52:55]
 v_cvt_pk_f16_f32 v58, v58, v59
 v_and_b32 v218, 0xffff0000, v218
 v_cvt_pk_f16_f32 v218, v27, v218
 v_accvgpr_write_b32 a106, v218
 v_lshlrev_b32 v27, 16, v219
 v_mfma_f32_16x16x32_bf16 v[60:63], v[144:147], v[128:131], v[60:63]
 v_accvgpr_write_b32 a141, v58
 v_and_b32 v219, 0xffff0000, v219
 v_cvt_pk_f16_f32 v219, v27, v219
 v_accvgpr_write_b32 a107, v219
 s_waitcnt lgkmcnt(2)
 v_mfma_f32_16x16x32_bf16 v[44:47], v[148:151], v[84:87], v[44:47]
 ds_read_b128 v[144:147], v22 offset:24704
 s_add_u32 m0, s81, 12288
 s_add_u32 s21, s88, 1966080
 v_mfma_f32_16x16x32_bf16 v[52:55], v[148:151], v[108:111], v[52:55]
 buffer_load_dwordx4 v28, s[12:15], s21 offen offset:0 lds
 v_mfma_f32_16x16x32_bf16 v[60:63], v[148:151], v[132:135], v[60:63]
 buffer_load_dwordx4 v29, s[12:15], s21 offen offset:1024 lds
 s_waitcnt lgkmcnt(2)
 v_mfma_f32_16x16x32_bf16 v[40:43], v[136:139], v[64:67], 0
 ds_read_b128 v[148:151], v23 offset:24704
 buffer_load_dwordx4 v30, s[12:15], s21 offen offset:2048 lds
 s_waitcnt vmcnt(18)
 v_mfma_f32_16x16x32_bf16 v[48:51], v[136:139], v[88:91], 0
 s_add_u32 m0, s81, 15360
 s_add_u32 s21, s88, 2015232
 ds_write_b128 v251, v[220:223] offset:36864
 v_mfma_f32_16x16x32_bf16 v[56:59], v[136:139], v[112:115], 0
 buffer_load_dwordx4 v31, s[12:15], s21 offen offset:0 lds
 ds_write_b128 v251, v[224:227] offset:37888
 s_waitcnt lgkmcnt(4)
 v_mfma_f32_16x16x32_bf16 v[40:43], v[140:143], v[68:71], v[40:43]
 ds_read_b128 v[136:139], v22 offset:24832
 v_cvt_pk_f16_f32 v44, v44, v45
 buffer_load_dwordx4 v32, s[12:15], s21 offen offset:1024 lds
 v_accvgpr_write_b32 a126, v44
 v_mfma_f32_16x16x32_bf16 v[48:51], v[140:143], v[92:95], v[48:51]
 v_cvt_pk_f16_f32 v46, v46, v47
 buffer_load_dwordx4 v33, s[12:15], s21 offen offset:2048 lds
 ds_write_b128 v251, v[228:231] offset:38912
 v_mfma_f32_16x16x32_bf16 v[56:59], v[140:143], v[116:119], v[56:59]
 v_accvgpr_write_b32 a127, v46
 s_add_u32 m0, s81, 18432
 s_add_u32 s21, s88, 2457600
 ds_read_b64_tr_b16 v[208:209], v250 offset:36864
 s_waitcnt lgkmcnt(6)
 v_mfma_f32_16x16x32_bf16 v[40:43], v[144:147], v[72:75], v[40:43]
 ds_read_b128 v[140:143], v23 offset:24832
 v_cvt_pk_f16_f32 v52, v52, v53
 buffer_load_dwordx4 v34, s[12:15], s21 offen offset:0 lds
 ds_read_b64_tr_b16 v[210:211], v250 offset:37248
 v_mfma_f32_16x16x32_bf16 v[48:51], v[144:147], v[96:99], v[48:51]
 v_accvgpr_write_b32 a134, v52
 buffer_load_dwordx4 v35, s[12:15], s21 offen offset:1024 lds
 ds_read_b64_tr_b16 v[212:213], v250 offset:36896
 ds_read_b64_tr_b16 v[214:215], v250 offset:37280
 v_mfma_f32_16x16x32_bf16 v[56:59], v[144:147], v[120:123], v[56:59]
 v_cvt_pk_f16_f32 v54, v54, v55
 buffer_load_dwordx4 v36, s[12:15], s21 offen offset:2048 lds
 ds_read_b64_tr_b16 v[216:217], v250 offset:36928
 s_waitcnt lgkmcnt(10)
 v_mfma_f32_16x16x32_bf16 v[40:43], v[148:151], v[76:79], v[40:43]
 ds_read_b128 v[144:147], v22 offset:26112
 v_accvgpr_write_b32 a135, v54
 s_add_u32 m0, s81, 21504
 s_add_u32 s21, s88, 2506752
 ds_read_b64_tr_b16 v[218:219], v250 offset:37312
 v_mfma_f32_16x16x32_bf16 v[48:51], v[148:151], v[100:103], v[48:51]
 v_cvt_pk_f16_f32 v60, v60, v61
 buffer_load_dwordx4 v37, s[12:15], s21 offen offset:0 lds
 s_add_u32 s22, s80, 196608
 v_accvgpr_write_b32 a142, v60
 v_mfma_f32_16x16x32_bf16 v[56:59], v[148:151], v[124:127], v[56:59]
 v_cvt_pk_f16_f32 v62, v62, v63
 buffer_load_dwordx4 v38, s[12:15], s21 offen offset:1024 lds
 v_accvgpr_write_b32 a143, v62
 s_waitcnt lgkmcnt(9)
 v_mfma_f32_16x16x32_bf16 v[40:43], v[136:139], v[80:83], v[40:43]
 ds_read_b128 v[148:151], v23 offset:26112
 buffer_load_dwordx4 v39, s[12:15], s21 offen offset:2048 lds
 buffer_load_dwordx4 v[220:223], v247, s[40:43], s22 offen
 v_mfma_f32_16x16x32_bf16 v[48:51], v[136:139], v[104:107], v[48:51]
 buffer_load_dwordx4 v[224:227], v248, s[40:43], s22 offen
 buffer_load_dwordx4 v[228:231], v249, s[40:43], s22 offen
 v_mfma_f32_16x16x32_bf16 v[56:59], v[136:139], v[128:131], v[56:59]
 s_waitcnt lgkmcnt(7)
 v_mfma_f32_16x16x32_bf16 v[40:43], v[140:143], v[84:87], v[40:43]
 ds_read_b128 v[136:139], v22 offset:26240
 v_mfma_f32_16x16x32_bf16 v[48:51], v[140:143], v[108:111], v[48:51]
 v_mfma_f32_16x16x32_bf16 v[56:59], v[140:143], v[132:135], v[56:59]
 s_waitcnt lgkmcnt(3)
 v_mfma_f32_16x16x32_bf16 v[44:47], v[144:147], v[64:67], 0
 ds_read_b128 v[140:143], v23 offset:26240
 v_mfma_f32_16x16x32_bf16 v[52:55], v[144:147], v[88:91], 0
 s_waitcnt lgkmcnt(3)
 v_lshlrev_b32 v27, 16, v208
 v_and_b32 v208, 0xffff0000, v208
 v_cvt_pk_f16_f32 v208, v27, v208
 v_accvgpr_write_b32 a68, v208
 v_mfma_f32_16x16x32_bf16 v[60:63], v[144:147], v[112:115], 0
 v_lshlrev_b32 v27, 16, v209
 v_and_b32 v209, 0xffff0000, v209
 v_cvt_pk_f16_f32 v209, v27, v209
 v_accvgpr_write_b32 a69, v209
 s_waitcnt lgkmcnt(2)
 v_mfma_f32_16x16x32_bf16 v[44:47], v[148:151], v[68:71], v[44:47]
 ds_read_b128 v[144:147], v22 offset:26368
 v_cvt_pk_f16_f32 v40, v40, v41
 v_lshlrev_b32 v27, 16, v210
 v_and_b32 v210, 0xffff0000, v210
 v_cvt_pk_f16_f32 v210, v27, v210
 v_mfma_f32_16x16x32_bf16 v[52:55], v[148:151], v[92:95], v[52:55]
 v_accvgpr_write_b32 a144, v40
 v_accvgpr_write_b32 a70, v210
 v_lshlrev_b32 v27, 16, v211
 v_and_b32 v211, 0xffff0000, v211
 v_cvt_pk_f16_f32 v211, v27, v211
 v_mfma_f32_16x16x32_bf16 v[60:63], v[148:151], v[116:119], v[60:63]
 v_cvt_pk_f16_f32 v42, v42, v43
 v_accvgpr_write_b32 a71, v211
 v_lshlrev_b32 v27, 16, v212
 v_and_b32 v212, 0xffff0000, v212
 s_waitcnt lgkmcnt(2)
 v_mfma_f32_16x16x32_bf16 v[44:47], v[136:139], v[72:75], v[44:47]
 ds_read_b128 v[148:151], v23 offset:26368
 v_accvgpr_write_b32 a145, v42
 v_cvt_pk_f16_f32 v212, v27, v212
 v_accvgpr_write_b32 a88, v212
 v_lshlrev_b32 v27, 16, v213
 v_mfma_f32_16x16x32_bf16 v[52:55], v[136:139], v[96:99], v[52:55]
 v_cvt_pk_f16_f32 v48, v48, v49
 v_and_b32 v213, 0xffff0000, v213
 v_cvt_pk_f16_f32 v213, v27, v213
 v_accvgpr_write_b32 a89, v213
 v_lshlrev_b32 v27, 16, v214
 v_mfma_f32_16x16x32_bf16 v[60:63], v[136:139], v[120:123], v[60:63]
 v_accvgpr_write_b32 a152, v48
 v_and_b32 v214, 0xffff0000, v214
 v_cvt_pk_f16_f32 v214, v27, v214
 v_accvgpr_write_b32 a90, v214
 s_waitcnt lgkmcnt(2)
 v_mfma_f32_16x16x32_bf16 v[44:47], v[140:143], v[76:79], v[44:47]
 s_waitcnt vmcnt(18)
 ds_read_b128 v[136:139], v22 offset:0
 v_cvt_pk_f16_f32 v50, v50, v51
 v_lshlrev_b32 v27, 16, v215
 v_and_b32 v215, 0xffff0000, v215
 v_cvt_pk_f16_f32 v215, v27, v215
 v_mfma_f32_16x16x32_bf16 v[52:55], v[140:143], v[100:103], v[52:55]
 v_accvgpr_write_b32 a153, v50
 v_accvgpr_write_b32 a91, v215
 v_lshlrev_b32 v27, 16, v216
 v_and_b32 v216, 0xffff0000, v216
 v_cvt_pk_f16_f32 v216, v27, v216
 v_mfma_f32_16x16x32_bf16 v[60:63], v[140:143], v[124:127], v[60:63]
 v_cvt_pk_f16_f32 v56, v56, v57
 v_accvgpr_write_b32 a108, v216
 v_lshlrev_b32 v27, 16, v217
 v_and_b32 v217, 0xffff0000, v217
 s_waitcnt lgkmcnt(2)
 v_mfma_f32_16x16x32_bf16 v[44:47], v[144:147], v[80:83], v[44:47]
 ds_read_b128 v[140:143], v23 offset:0
 v_accvgpr_write_b32 a160, v56
 v_cvt_pk_f16_f32 v217, v27, v217
 v_accvgpr_write_b32 a109, v217
 v_lshlrev_b32 v27, 16, v218
 v_mfma_f32_16x16x32_bf16 v[52:55], v[144:147], v[104:107], v[52:55]
 v_cvt_pk_f16_f32 v58, v58, v59
 v_and_b32 v218, 0xffff0000, v218
 v_cvt_pk_f16_f32 v218, v27, v218
 v_accvgpr_write_b32 a110, v218
 v_lshlrev_b32 v27, 16, v219
 v_mfma_f32_16x16x32_bf16 v[60:63], v[144:147], v[128:131], v[60:63]
 v_accvgpr_write_b32 a161, v58
 v_and_b32 v219, 0xffff0000, v219
 v_cvt_pk_f16_f32 v219, v27, v219
 v_accvgpr_write_b32 a111, v219
 s_waitcnt lgkmcnt(2)
 v_mfma_f32_16x16x32_bf16 v[44:47], v[148:151], v[84:87], v[44:47]
 ds_read_b128 v[144:147], v22 offset:128
 s_add_u32 m0, s81, 24576
 s_add_u32 s21, s88, 2949120
 v_mfma_f32_16x16x32_bf16 v[52:55], v[148:151], v[108:111], v[52:55]
 buffer_load_dwordx4 v28, s[12:15], s21 offen offset:0 lds
 v_mfma_f32_16x16x32_bf16 v[60:63], v[148:151], v[132:135], v[60:63]
 buffer_load_dwordx4 v29, s[12:15], s21 offen offset:1024 lds
 s_waitcnt lgkmcnt(2)
 v_mfma_f32_16x16x32_bf16 v[40:43], v[136:139], v[64:67], 0
 ds_read_b128 v[148:151], v23 offset:128
 buffer_load_dwordx4 v30, s[12:15], s21 offen offset:2048 lds
 s_waitcnt vmcnt(18)
 v_mfma_f32_16x16x32_bf16 v[48:51], v[136:139], v[88:91], 0
 s_add_u32 m0, s81, 27648
 s_add_u32 s21, s88, 2998272
 ds_write_b128 v251, v[232:235] offset:36864
 v_mfma_f32_16x16x32_bf16 v[56:59], v[136:139], v[112:115], 0
 buffer_load_dwordx4 v31, s[12:15], s21 offen offset:0 lds
 ds_write_b128 v251, v[236:239] offset:37888
 s_waitcnt lgkmcnt(4)
 v_mfma_f32_16x16x32_bf16 v[40:43], v[140:143], v[68:71], v[40:43]
 ds_read_b128 v[136:139], v22 offset:256
 v_cvt_pk_f16_f32 v44, v44, v45
 buffer_load_dwordx4 v32, s[12:15], s21 offen offset:1024 lds
 v_accvgpr_write_b32 a146, v44
 v_mfma_f32_16x16x32_bf16 v[48:51], v[140:143], v[92:95], v[48:51]
 v_cvt_pk_f16_f32 v46, v46, v47
 buffer_load_dwordx4 v33, s[12:15], s21 offen offset:2048 lds
 ds_write_b128 v251, v[240:243] offset:38912
 v_mfma_f32_16x16x32_bf16 v[56:59], v[140:143], v[116:119], v[56:59]
 v_accvgpr_write_b32 a147, v46
 s_add_u32 m0, s81, 30720
 s_add_u32 s21, s88, 3440640
 ds_read_b64_tr_b16 v[208:209], v250 offset:36864
 s_waitcnt lgkmcnt(6)
 v_mfma_f32_16x16x32_bf16 v[40:43], v[144:147], v[72:75], v[40:43]
 ds_read_b128 v[140:143], v23 offset:256
 v_cvt_pk_f16_f32 v52, v52, v53
 buffer_load_dwordx4 v34, s[12:15], s21 offen offset:0 lds
 ds_read_b64_tr_b16 v[210:211], v250 offset:37248
 v_mfma_f32_16x16x32_bf16 v[48:51], v[144:147], v[96:99], v[48:51]
 v_accvgpr_write_b32 a154, v52
 buffer_load_dwordx4 v35, s[12:15], s21 offen offset:1024 lds
 ds_read_b64_tr_b16 v[212:213], v250 offset:36896
 ds_read_b64_tr_b16 v[214:215], v250 offset:37280
 v_mfma_f32_16x16x32_bf16 v[56:59], v[144:147], v[120:123], v[56:59]
 v_cvt_pk_f16_f32 v54, v54, v55
 buffer_load_dwordx4 v36, s[12:15], s21 offen offset:2048 lds
 ds_read_b64_tr_b16 v[216:217], v250 offset:36928
 s_waitcnt lgkmcnt(10)
 v_mfma_f32_16x16x32_bf16 v[40:43], v[148:151], v[76:79], v[40:43]
 ds_read_b128 v[144:147], v22 offset:1536
 v_accvgpr_write_b32 a155, v54
 s_add_u32 m0, s81, 33792
 s_add_u32 s21, s88, 3489792
 ds_read_b64_tr_b16 v[218:219], v250 offset:37312
 v_mfma_f32_16x16x32_bf16 v[48:51], v[148:151], v[100:103], v[48:51]
 v_cvt_pk_f16_f32 v60, v60, v61
 buffer_load_dwordx4 v37, s[12:15], s21 offen offset:0 lds
 s_add_u32 s22, s80, 0
 v_accvgpr_write_b32 a162, v60
 v_mfma_f32_16x16x32_bf16 v[56:59], v[148:151], v[124:127], v[56:59]
 v_cvt_pk_f16_f32 v62, v62, v63
 buffer_load_dwordx4 v38, s[12:15], s21 offen offset:1024 lds
 v_accvgpr_write_b32 a163, v62
 s_waitcnt lgkmcnt(9)
 v_mfma_f32_16x16x32_bf16 v[40:43], v[136:139], v[80:83], v[40:43]
 ds_read_b128 v[148:151], v23 offset:1536
 buffer_load_dwordx4 v39, s[12:15], s21 offen offset:2048 lds
 buffer_load_dwordx4 v[232:235], v244, s[36:39], s22 offen
 v_mfma_f32_16x16x32_bf16 v[48:51], v[136:139], v[104:107], v[48:51]
 buffer_load_dwordx4 v[236:239], v245, s[36:39], s22 offen
 buffer_load_dwordx4 v[240:243], v246, s[36:39], s22 offen
 v_mfma_f32_16x16x32_bf16 v[56:59], v[136:139], v[128:131], v[56:59]
 s_waitcnt lgkmcnt(7)
 v_mfma_f32_16x16x32_bf16 v[40:43], v[140:143], v[84:87], v[40:43]
 ds_read_b128 v[136:139], v22 offset:1664
 v_mfma_f32_16x16x32_bf16 v[48:51], v[140:143], v[108:111], v[48:51]
 v_mfma_f32_16x16x32_bf16 v[56:59], v[140:143], v[132:135], v[56:59]
 s_waitcnt lgkmcnt(3)
 v_mfma_f32_16x16x32_bf16 v[44:47], v[144:147], v[64:67], 0
 ds_read_b128 v[140:143], v23 offset:1664
 v_mfma_f32_16x16x32_bf16 v[52:55], v[144:147], v[88:91], 0
 s_waitcnt lgkmcnt(3)
 v_lshlrev_b32 v27, 16, v208
 v_and_b32 v208, 0xffff0000, v208
 v_cvt_pk_f16_f32 v208, v27, v208
 v_accvgpr_write_b32 a72, v208
 v_mfma_f32_16x16x32_bf16 v[60:63], v[144:147], v[112:115], 0
 v_lshlrev_b32 v27, 16, v209
 v_and_b32 v209, 0xffff0000, v209
 v_cvt_pk_f16_f32 v209, v27, v209
 v_accvgpr_write_b32 a73, v209
 s_waitcnt lgkmcnt(2)
 v_mfma_f32_16x16x32_bf16 v[44:47], v[148:151], v[68:71], v[44:47]
 ds_read_b128 v[144:147], v22 offset:1792
 v_cvt_pk_f16_f32 v40, v40, v41
 v_lshlrev_b32 v27, 16, v210
 v_and_b32 v210, 0xffff0000, v210
 v_cvt_pk_f16_f32 v210, v27, v210
 v_mfma_f32_16x16x32_bf16 v[52:55], v[148:151], v[92:95], v[52:55]
 v_accvgpr_write_b32 a148, v40
 v_accvgpr_write_b32 a74, v210
 v_lshlrev_b32 v27, 16, v211
 v_and_b32 v211, 0xffff0000, v211
 v_cvt_pk_f16_f32 v211, v27, v211
 v_mfma_f32_16x16x32_bf16 v[60:63], v[148:151], v[116:119], v[60:63]
 v_cvt_pk_f16_f32 v42, v42, v43
 v_accvgpr_write_b32 a75, v211
 v_lshlrev_b32 v27, 16, v212
 v_and_b32 v212, 0xffff0000, v212
 s_waitcnt lgkmcnt(2)
 v_mfma_f32_16x16x32_bf16 v[44:47], v[136:139], v[72:75], v[44:47]
 ds_read_b128 v[148:151], v23 offset:1792
 v_accvgpr_write_b32 a149, v42
 v_cvt_pk_f16_f32 v212, v27, v212
 v_accvgpr_write_b32 a92, v212
 v_lshlrev_b32 v27, 16, v213
 v_mfma_f32_16x16x32_bf16 v[52:55], v[136:139], v[96:99], v[52:55]
 v_cvt_pk_f16_f32 v48, v48, v49
 v_and_b32 v213, 0xffff0000, v213
 v_cvt_pk_f16_f32 v213, v27, v213
 v_accvgpr_write_b32 a93, v213
 v_lshlrev_b32 v27, 16, v214
 v_mfma_f32_16x16x32_bf16 v[60:63], v[136:139], v[120:123], v[60:63]
 v_accvgpr_write_b32 a156, v48
 v_and_b32 v214, 0xffff0000, v214
 v_cvt_pk_f16_f32 v214, v27, v214
 v_accvgpr_write_b32 a94, v214
 s_waitcnt lgkmcnt(2)
 v_mfma_f32_16x16x32_bf16 v[44:47], v[140:143], v[76:79], v[44:47]
 s_waitcnt vmcnt(18)
 ds_read_b128 v[136:139], v22 offset:12288
 v_cvt_pk_f16_f32 v50, v50, v51
 v_lshlrev_b32 v27, 16, v215
 v_and_b32 v215, 0xffff0000, v215
 v_cvt_pk_f16_f32 v215, v27, v215
 v_mfma_f32_16x16x32_bf16 v[52:55], v[140:143], v[100:103], v[52:55]
 v_accvgpr_write_b32 a157, v50
 v_accvgpr_write_b32 a95, v215
 v_lshlrev_b32 v27, 16, v216
 v_and_b32 v216, 0xffff0000, v216
 v_cvt_pk_f16_f32 v216, v27, v216
 v_mfma_f32_16x16x32_bf16 v[60:63], v[140:143], v[124:127], v[60:63]
 v_cvt_pk_f16_f32 v56, v56, v57
 v_accvgpr_write_b32 a112, v216
 v_lshlrev_b32 v27, 16, v217
 v_and_b32 v217, 0xffff0000, v217
 s_waitcnt lgkmcnt(2)
 v_mfma_f32_16x16x32_bf16 v[44:47], v[144:147], v[80:83], v[44:47]
 ds_read_b128 v[140:143], v23 offset:12288
 v_accvgpr_write_b32 a164, v56
 v_cvt_pk_f16_f32 v217, v27, v217
 v_accvgpr_write_b32 a113, v217
 v_lshlrev_b32 v27, 16, v218
 v_mfma_f32_16x16x32_bf16 v[52:55], v[144:147], v[104:107], v[52:55]
 v_cvt_pk_f16_f32 v58, v58, v59
 v_and_b32 v218, 0xffff0000, v218
 v_cvt_pk_f16_f32 v218, v27, v218
 v_accvgpr_write_b32 a114, v218
 v_lshlrev_b32 v27, 16, v219
 v_mfma_f32_16x16x32_bf16 v[60:63], v[144:147], v[128:131], v[60:63]
 v_accvgpr_write_b32 a165, v58
 v_and_b32 v219, 0xffff0000, v219
 v_cvt_pk_f16_f32 v219, v27, v219
 v_accvgpr_write_b32 a115, v219
 s_waitcnt lgkmcnt(2)
 v_mfma_f32_16x16x32_bf16 v[44:47], v[148:151], v[84:87], v[44:47]
 ds_read_b128 v[144:147], v22 offset:12416
 s_add_u32 m0, s81, 0
 s_add_u32 s21, s88, 2064384
 v_mfma_f32_16x16x32_bf16 v[52:55], v[148:151], v[108:111], v[52:55]
 buffer_load_dwordx4 v28, s[12:15], s21 offen offset:0 lds
 v_mfma_f32_16x16x32_bf16 v[60:63], v[148:151], v[132:135], v[60:63]
 buffer_load_dwordx4 v29, s[12:15], s21 offen offset:1024 lds
 s_waitcnt lgkmcnt(2)
 v_mfma_f32_16x16x32_bf16 v[40:43], v[136:139], v[64:67], 0
 ds_read_b128 v[148:151], v23 offset:12416
 buffer_load_dwordx4 v30, s[12:15], s21 offen offset:2048 lds
 s_waitcnt vmcnt(18)
 v_mfma_f32_16x16x32_bf16 v[48:51], v[136:139], v[88:91], 0
 s_add_u32 m0, s81, 3072
 s_add_u32 s21, s88, 2113536
 ds_write_b128 v251, v[220:223] offset:36864
 v_mfma_f32_16x16x32_bf16 v[56:59], v[136:139], v[112:115], 0
 buffer_load_dwordx4 v31, s[12:15], s21 offen offset:0 lds
 ds_write_b128 v251, v[224:227] offset:37888
 s_waitcnt lgkmcnt(4)
 v_mfma_f32_16x16x32_bf16 v[40:43], v[140:143], v[68:71], v[40:43]
 ds_read_b128 v[136:139], v22 offset:12544
 v_cvt_pk_f16_f32 v44, v44, v45
 buffer_load_dwordx4 v32, s[12:15], s21 offen offset:1024 lds
 v_accvgpr_write_b32 a150, v44
 v_mfma_f32_16x16x32_bf16 v[48:51], v[140:143], v[92:95], v[48:51]
 v_cvt_pk_f16_f32 v46, v46, v47
 buffer_load_dwordx4 v33, s[12:15], s21 offen offset:2048 lds
 ds_write_b128 v251, v[228:231] offset:38912
 v_mfma_f32_16x16x32_bf16 v[56:59], v[140:143], v[116:119], v[56:59]
 v_accvgpr_write_b32 a151, v46
 s_add_u32 m0, s81, 6144
 s_add_u32 s21, s88, 2555904
 ds_read_b64_tr_b16 v[208:209], v250 offset:36864
 s_waitcnt lgkmcnt(6)
 v_mfma_f32_16x16x32_bf16 v[40:43], v[144:147], v[72:75], v[40:43]
 ds_read_b128 v[140:143], v23 offset:12544
 v_cvt_pk_f16_f32 v52, v52, v53
 buffer_load_dwordx4 v34, s[12:15], s21 offen offset:0 lds
 ds_read_b64_tr_b16 v[210:211], v250 offset:37248
 v_mfma_f32_16x16x32_bf16 v[48:51], v[144:147], v[96:99], v[48:51]
 v_accvgpr_write_b32 a158, v52
 buffer_load_dwordx4 v35, s[12:15], s21 offen offset:1024 lds
 ds_read_b64_tr_b16 v[212:213], v250 offset:36896
 ds_read_b64_tr_b16 v[214:215], v250 offset:37280
 v_mfma_f32_16x16x32_bf16 v[56:59], v[144:147], v[120:123], v[56:59]
 v_cvt_pk_f16_f32 v54, v54, v55
 buffer_load_dwordx4 v36, s[12:15], s21 offen offset:2048 lds
 ds_read_b64_tr_b16 v[216:217], v250 offset:36928
 s_waitcnt lgkmcnt(10)
 v_mfma_f32_16x16x32_bf16 v[40:43], v[148:151], v[76:79], v[40:43]
 ds_read_b128 v[144:147], v22 offset:13824
 v_accvgpr_write_b32 a159, v54
 s_add_u32 m0, s81, 9216
 s_add_u32 s21, s88, 2605056
 ds_read_b64_tr_b16 v[218:219], v250 offset:37312
 v_mfma_f32_16x16x32_bf16 v[48:51], v[148:151], v[100:103], v[48:51]
 v_cvt_pk_f16_f32 v60, v60, v61
 buffer_load_dwordx4 v37, s[12:15], s21 offen offset:0 lds
 s_add_u32 s22, s80, 983040
 v_accvgpr_write_b32 a166, v60
 v_mfma_f32_16x16x32_bf16 v[56:59], v[148:151], v[124:127], v[56:59]
 v_cvt_pk_f16_f32 v62, v62, v63
 buffer_load_dwordx4 v38, s[12:15], s21 offen offset:1024 lds
 v_accvgpr_write_b32 a167, v62
 s_waitcnt lgkmcnt(9)
 v_mfma_f32_16x16x32_bf16 v[40:43], v[136:139], v[80:83], v[40:43]
 ds_read_b128 v[148:151], v23 offset:13824
 buffer_load_dwordx4 v39, s[12:15], s21 offen offset:2048 lds
 buffer_load_dwordx4 v[220:223], v244, s[36:39], s22 offen
 v_mfma_f32_16x16x32_bf16 v[48:51], v[136:139], v[104:107], v[48:51]
 buffer_load_dwordx4 v[224:227], v245, s[36:39], s22 offen
 buffer_load_dwordx4 v[228:231], v246, s[36:39], s22 offen
 v_mfma_f32_16x16x32_bf16 v[56:59], v[136:139], v[128:131], v[56:59]
 s_waitcnt lgkmcnt(7)
 v_mfma_f32_16x16x32_bf16 v[40:43], v[140:143], v[84:87], v[40:43]
 ds_read_b128 v[136:139], v22 offset:13952
 v_mfma_f32_16x16x32_bf16 v[48:51], v[140:143], v[108:111], v[48:51]
 v_mfma_f32_16x16x32_bf16 v[56:59], v[140:143], v[132:135], v[56:59]
 s_waitcnt lgkmcnt(3)
 v_mfma_f32_16x16x32_bf16 v[44:47], v[144:147], v[64:67], 0
 ds_read_b128 v[140:143], v23 offset:13952
 v_mfma_f32_16x16x32_bf16 v[52:55], v[144:147], v[88:91], 0
 s_waitcnt lgkmcnt(3)
 v_lshlrev_b32 v27, 16, v208
 v_and_b32 v208, 0xffff0000, v208
 v_cvt_pk_f16_f32 v208, v27, v208
 v_accvgpr_write_b32 a76, v208
 v_mfma_f32_16x16x32_bf16 v[60:63], v[144:147], v[112:115], 0
 v_lshlrev_b32 v27, 16, v209
 v_and_b32 v209, 0xffff0000, v209
 v_cvt_pk_f16_f32 v209, v27, v209
 v_accvgpr_write_b32 a77, v209
 s_waitcnt lgkmcnt(2)
 v_mfma_f32_16x16x32_bf16 v[44:47], v[148:151], v[68:71], v[44:47]
 ds_read_b128 v[144:147], v22 offset:14080
 v_cvt_pk_f16_f32 v40, v40, v41
 v_lshlrev_b32 v27, 16, v210
 v_and_b32 v210, 0xffff0000, v210
 v_cvt_pk_f16_f32 v210, v27, v210
 v_mfma_f32_16x16x32_bf16 v[52:55], v[148:151], v[92:95], v[52:55]
 v_accvgpr_write_b32 a168, v40
 v_accvgpr_write_b32 a78, v210
 v_lshlrev_b32 v27, 16, v211
 v_and_b32 v211, 0xffff0000, v211
 v_cvt_pk_f16_f32 v211, v27, v211
 v_mfma_f32_16x16x32_bf16 v[60:63], v[148:151], v[116:119], v[60:63]
 v_cvt_pk_f16_f32 v42, v42, v43
 v_accvgpr_write_b32 a79, v211
 v_lshlrev_b32 v27, 16, v212
 v_and_b32 v212, 0xffff0000, v212
 s_waitcnt lgkmcnt(2)
 v_mfma_f32_16x16x32_bf16 v[44:47], v[136:139], v[72:75], v[44:47]
 ds_read_b128 v[148:151], v23 offset:14080
 v_accvgpr_write_b32 a169, v42
 v_cvt_pk_f16_f32 v212, v27, v212
 v_accvgpr_write_b32 a96, v212
 v_lshlrev_b32 v27, 16, v213
 v_mfma_f32_16x16x32_bf16 v[52:55], v[136:139], v[96:99], v[52:55]
 v_cvt_pk_f16_f32 v48, v48, v49
 v_and_b32 v213, 0xffff0000, v213
 v_cvt_pk_f16_f32 v213, v27, v213
 v_accvgpr_write_b32 a97, v213
 v_lshlrev_b32 v27, 16, v214
 v_mfma_f32_16x16x32_bf16 v[60:63], v[136:139], v[120:123], v[60:63]
 v_accvgpr_write_b32 a176, v48
 v_and_b32 v214, 0xffff0000, v214
 v_cvt_pk_f16_f32 v214, v27, v214
 v_accvgpr_write_b32 a98, v214
 s_waitcnt lgkmcnt(2)
 v_mfma_f32_16x16x32_bf16 v[44:47], v[140:143], v[76:79], v[44:47]
 s_waitcnt vmcnt(18)
 ds_read_b128 v[136:139], v22 offset:24576
 v_cvt_pk_f16_f32 v50, v50, v51
 v_lshlrev_b32 v27, 16, v215
 v_and_b32 v215, 0xffff0000, v215
 v_cvt_pk_f16_f32 v215, v27, v215
 v_mfma_f32_16x16x32_bf16 v[52:55], v[140:143], v[100:103], v[52:55]
 v_accvgpr_write_b32 a177, v50
 v_accvgpr_write_b32 a99, v215
 v_lshlrev_b32 v27, 16, v216
 v_and_b32 v216, 0xffff0000, v216
 v_cvt_pk_f16_f32 v216, v27, v216
 v_mfma_f32_16x16x32_bf16 v[60:63], v[140:143], v[124:127], v[60:63]
 v_cvt_pk_f16_f32 v56, v56, v57
 v_accvgpr_write_b32 a116, v216
 v_lshlrev_b32 v27, 16, v217
 v_and_b32 v217, 0xffff0000, v217
 s_waitcnt lgkmcnt(2)
 v_mfma_f32_16x16x32_bf16 v[44:47], v[144:147], v[80:83], v[44:47]
 ds_read_b128 v[140:143], v23 offset:24576
 v_accvgpr_write_b32 a184, v56
 v_cvt_pk_f16_f32 v217, v27, v217
 v_accvgpr_write_b32 a117, v217
 v_lshlrev_b32 v27, 16, v218
 v_mfma_f32_16x16x32_bf16 v[52:55], v[144:147], v[104:107], v[52:55]
 v_cvt_pk_f16_f32 v58, v58, v59
 v_and_b32 v218, 0xffff0000, v218
 v_cvt_pk_f16_f32 v218, v27, v218
 v_accvgpr_write_b32 a118, v218
 v_lshlrev_b32 v27, 16, v219
 v_mfma_f32_16x16x32_bf16 v[60:63], v[144:147], v[128:131], v[60:63]
 v_accvgpr_write_b32 a185, v58
 v_and_b32 v219, 0xffff0000, v219
 v_cvt_pk_f16_f32 v219, v27, v219
 v_accvgpr_write_b32 a119, v219
 s_waitcnt lgkmcnt(2)
 v_mfma_f32_16x16x32_bf16 v[44:47], v[148:151], v[84:87], v[44:47]
 ds_read_b128 v[144:147], v22 offset:24704
 s_add_u32 m0, s81, 12288
 s_add_u32 s21, s88, 3047424
 v_mfma_f32_16x16x32_bf16 v[52:55], v[148:151], v[108:111], v[52:55]
 buffer_load_dwordx4 v28, s[12:15], s21 offen offset:0 lds
 v_mfma_f32_16x16x32_bf16 v[60:63], v[148:151], v[132:135], v[60:63]
 buffer_load_dwordx4 v29, s[12:15], s21 offen offset:1024 lds
 s_waitcnt lgkmcnt(2)
 v_mfma_f32_16x16x32_bf16 v[40:43], v[136:139], v[64:67], 0
 ds_read_b128 v[148:151], v23 offset:24704
 buffer_load_dwordx4 v30, s[12:15], s21 offen offset:2048 lds
 s_waitcnt vmcnt(18)
 v_mfma_f32_16x16x32_bf16 v[48:51], v[136:139], v[88:91], 0
 s_add_u32 m0, s81, 15360
 s_add_u32 s21, s88, 3096576
 ds_write_b128 v251, v[232:235] offset:36864
 v_mfma_f32_16x16x32_bf16 v[56:59], v[136:139], v[112:115], 0
 buffer_load_dwordx4 v31, s[12:15], s21 offen offset:0 lds
 ds_write_b128 v251, v[236:239] offset:37888
 s_waitcnt lgkmcnt(4)
 v_mfma_f32_16x16x32_bf16 v[40:43], v[140:143], v[68:71], v[40:43]
 ds_read_b128 v[136:139], v22 offset:24832
 v_cvt_pk_f16_f32 v44, v44, v45
 buffer_load_dwordx4 v32, s[12:15], s21 offen offset:1024 lds
 v_accvgpr_write_b32 a170, v44
 v_mfma_f32_16x16x32_bf16 v[48:51], v[140:143], v[92:95], v[48:51]
 v_cvt_pk_f16_f32 v46, v46, v47
 buffer_load_dwordx4 v33, s[12:15], s21 offen offset:2048 lds
 ds_write_b128 v251, v[240:243] offset:38912
 v_mfma_f32_16x16x32_bf16 v[56:59], v[140:143], v[116:119], v[56:59]
 v_accvgpr_write_b32 a171, v46
 s_add_u32 m0, s81, 18432
 s_add_u32 s21, s88, 3538944
 ds_read_b64_tr_b16 v[208:209], v250 offset:36864
 s_waitcnt lgkmcnt(6)
 v_mfma_f32_16x16x32_bf16 v[40:43], v[144:147], v[72:75], v[40:43]
 ds_read_b128 v[140:143], v23 offset:24832
 v_cvt_pk_f16_f32 v52, v52, v53
 buffer_load_dwordx4 v34, s[12:15], s21 offen offset:0 lds
 ds_read_b64_tr_b16 v[210:211], v250 offset:37248
 v_mfma_f32_16x16x32_bf16 v[48:51], v[144:147], v[96:99], v[48:51]
 v_accvgpr_write_b32 a178, v52
 buffer_load_dwordx4 v35, s[12:15], s21 offen offset:1024 lds
 ds_read_b64_tr_b16 v[212:213], v250 offset:36896
 ds_read_b64_tr_b16 v[214:215], v250 offset:37280
 v_mfma_f32_16x16x32_bf16 v[56:59], v[144:147], v[120:123], v[56:59]
 v_cvt_pk_f16_f32 v54, v54, v55
 buffer_load_dwordx4 v36, s[12:15], s21 offen offset:2048 lds
 ds_read_b64_tr_b16 v[216:217], v250 offset:36928
 s_waitcnt lgkmcnt(10)
 v_mfma_f32_16x16x32_bf16 v[40:43], v[148:151], v[76:79], v[40:43]
 ds_read_b128 v[144:147], v22 offset:26112
 v_accvgpr_write_b32 a179, v54
 s_add_u32 m0, s81, 21504
 s_add_u32 s21, s88, 3588096
 ds_read_b64_tr_b16 v[218:219], v250 offset:37312
 v_mfma_f32_16x16x32_bf16 v[48:51], v[148:151], v[100:103], v[48:51]
 v_cvt_pk_f16_f32 v60, v60, v61
 buffer_load_dwordx4 v37, s[12:15], s21 offen offset:0 lds
 s_add_u32 s22, s80, 98304
 v_accvgpr_write_b32 a186, v60
 v_mfma_f32_16x16x32_bf16 v[56:59], v[148:151], v[124:127], v[56:59]
 v_cvt_pk_f16_f32 v62, v62, v63
 buffer_load_dwordx4 v38, s[12:15], s21 offen offset:1024 lds
 v_accvgpr_write_b32 a187, v62
 s_waitcnt lgkmcnt(9)
 v_mfma_f32_16x16x32_bf16 v[40:43], v[136:139], v[80:83], v[40:43]
 ds_read_b128 v[148:151], v23 offset:26112
 buffer_load_dwordx4 v39, s[12:15], s21 offen offset:2048 lds
 buffer_load_dwordx4 v[232:235], v244, s[36:39], s22 offen
 v_mfma_f32_16x16x32_bf16 v[48:51], v[136:139], v[104:107], v[48:51]
 buffer_load_dwordx4 v[236:239], v245, s[36:39], s22 offen
 buffer_load_dwordx4 v[240:243], v246, s[36:39], s22 offen
 v_mfma_f32_16x16x32_bf16 v[56:59], v[136:139], v[128:131], v[56:59]
 s_waitcnt lgkmcnt(7)
 v_mfma_f32_16x16x32_bf16 v[40:43], v[140:143], v[84:87], v[40:43]
 ds_read_b128 v[136:139], v22 offset:26240
 v_mfma_f32_16x16x32_bf16 v[48:51], v[140:143], v[108:111], v[48:51]
 v_mfma_f32_16x16x32_bf16 v[56:59], v[140:143], v[132:135], v[56:59]
 s_waitcnt lgkmcnt(3)
 v_mfma_f32_16x16x32_bf16 v[44:47], v[144:147], v[64:67], 0
 ds_read_b128 v[140:143], v23 offset:26240
 v_mfma_f32_16x16x32_bf16 v[52:55], v[144:147], v[88:91], 0
 s_waitcnt lgkmcnt(3)
 v_lshlrev_b32 v27, 16, v208
 v_and_b32 v208, 0xffff0000, v208
 v_cvt_pk_f16_f32 v208, v27, v208
 v_accvgpr_write_b32 a0, v208
 v_mfma_f32_16x16x32_bf16 v[60:63], v[144:147], v[112:115], 0
 v_lshlrev_b32 v27, 16, v209
 v_and_b32 v209, 0xffff0000, v209
 v_cvt_pk_f16_f32 v209, v27, v209
 v_accvgpr_write_b32 a1, v209
 s_waitcnt lgkmcnt(2)
 v_mfma_f32_16x16x32_bf16 v[44:47], v[148:151], v[68:71], v[44:47]
 ds_read_b128 v[144:147], v22 offset:26368
 v_cvt_pk_f16_f32 v40, v40, v41
 v_lshlrev_b32 v27, 16, v210
 v_and_b32 v210, 0xffff0000, v210
 v_cvt_pk_f16_f32 v210, v27, v210
 v_mfma_f32_16x16x32_bf16 v[52:55], v[148:151], v[92:95], v[52:55]
 v_accvgpr_write_b32 a172, v40
 v_accvgpr_write_b32 a2, v210
 v_lshlrev_b32 v27, 16, v211
 v_and_b32 v211, 0xffff0000, v211
 v_cvt_pk_f16_f32 v211, v27, v211
 v_mfma_f32_16x16x32_bf16 v[60:63], v[148:151], v[116:119], v[60:63]
 v_cvt_pk_f16_f32 v42, v42, v43
 v_accvgpr_write_b32 a3, v211
 v_lshlrev_b32 v27, 16, v212
 v_and_b32 v212, 0xffff0000, v212
 s_waitcnt lgkmcnt(2)
 v_mfma_f32_16x16x32_bf16 v[44:47], v[136:139], v[72:75], v[44:47]
 ds_read_b128 v[148:151], v23 offset:26368
 v_accvgpr_write_b32 a173, v42
 v_cvt_pk_f16_f32 v212, v27, v212
 v_accvgpr_write_b32 a20, v212
 v_lshlrev_b32 v27, 16, v213
 v_mfma_f32_16x16x32_bf16 v[52:55], v[136:139], v[96:99], v[52:55]
 v_cvt_pk_f16_f32 v48, v48, v49
 v_and_b32 v213, 0xffff0000, v213
 v_cvt_pk_f16_f32 v213, v27, v213
 v_accvgpr_write_b32 a21, v213
 v_lshlrev_b32 v27, 16, v214
 v_mfma_f32_16x16x32_bf16 v[60:63], v[136:139], v[120:123], v[60:63]
 v_accvgpr_write_b32 a180, v48
 v_and_b32 v214, 0xffff0000, v214
 v_cvt_pk_f16_f32 v214, v27, v214
 v_accvgpr_write_b32 a22, v214
 s_waitcnt lgkmcnt(2)
 v_mfma_f32_16x16x32_bf16 v[44:47], v[140:143], v[76:79], v[44:47]
 s_waitcnt vmcnt(18)
 ds_read_b128 v[136:139], v22 offset:0
 v_cvt_pk_f16_f32 v50, v50, v51
 v_lshlrev_b32 v27, 16, v215
 v_and_b32 v215, 0xffff0000, v215
 v_cvt_pk_f16_f32 v215, v27, v215
 v_mfma_f32_16x16x32_bf16 v[52:55], v[140:143], v[100:103], v[52:55]
 v_accvgpr_write_b32 a181, v50
 v_accvgpr_write_b32 a23, v215
 v_lshlrev_b32 v27, 16, v216
 v_and_b32 v216, 0xffff0000, v216
 v_cvt_pk_f16_f32 v216, v27, v216
 v_mfma_f32_16x16x32_bf16 v[60:63], v[140:143], v[124:127], v[60:63]
 v_cvt_pk_f16_f32 v56, v56, v57
 v_accvgpr_write_b32 a40, v216
 v_lshlrev_b32 v27, 16, v217
 v_and_b32 v217, 0xffff0000, v217
 s_waitcnt lgkmcnt(2)
 v_mfma_f32_16x16x32_bf16 v[44:47], v[144:147], v[80:83], v[44:47]
 ds_read_b128 v[140:143], v23 offset:0
 v_accvgpr_write_b32 a188, v56
 v_cvt_pk_f16_f32 v217, v27, v217
 v_accvgpr_write_b32 a41, v217
 v_lshlrev_b32 v27, 16, v218
 v_mfma_f32_16x16x32_bf16 v[52:55], v[144:147], v[104:107], v[52:55]
 v_cvt_pk_f16_f32 v58, v58, v59
 v_and_b32 v218, 0xffff0000, v218
 v_cvt_pk_f16_f32 v218, v27, v218
 v_accvgpr_write_b32 a42, v218
 v_lshlrev_b32 v27, 16, v219
 v_mfma_f32_16x16x32_bf16 v[60:63], v[144:147], v[128:131], v[60:63]
 v_accvgpr_write_b32 a189, v58
 v_and_b32 v219, 0xffff0000, v219
 v_cvt_pk_f16_f32 v219, v27, v219
 v_accvgpr_write_b32 a43, v219
 s_waitcnt lgkmcnt(2)
 v_mfma_f32_16x16x32_bf16 v[44:47], v[148:151], v[84:87], v[44:47]
 ds_read_b128 v[144:147], v22 offset:128
 s_add_u32 m0, s81, 24576
 s_add_u32 s21, s88, 3932160
 v_mfma_f32_16x16x32_bf16 v[52:55], v[148:151], v[108:111], v[52:55]
 buffer_load_dwordx4 v28, s[12:15], s21 offen offset:0 lds
 v_mfma_f32_16x16x32_bf16 v[60:63], v[148:151], v[132:135], v[60:63]
 buffer_load_dwordx4 v29, s[12:15], s21 offen offset:1024 lds
 s_waitcnt lgkmcnt(2)
 v_mfma_f32_16x16x32_bf16 v[40:43], v[136:139], v[64:67], 0
 ds_read_b128 v[148:151], v23 offset:128
 buffer_load_dwordx4 v30, s[12:15], s21 offen offset:2048 lds
 s_waitcnt vmcnt(18)
 v_mfma_f32_16x16x32_bf16 v[48:51], v[136:139], v[88:91], 0
 s_add_u32 m0, s81, 27648
 s_add_u32 s21, s88, 3981312
 ds_write_b128 v251, v[220:223] offset:36864
 v_mfma_f32_16x16x32_bf16 v[56:59], v[136:139], v[112:115], 0
 buffer_load_dwordx4 v31, s[12:15], s21 offen offset:0 lds
 ds_write_b128 v251, v[224:227] offset:37888
 s_waitcnt lgkmcnt(4)
 v_mfma_f32_16x16x32_bf16 v[40:43], v[140:143], v[68:71], v[40:43]
 ds_read_b128 v[136:139], v22 offset:256
 v_cvt_pk_f16_f32 v44, v44, v45
 buffer_load_dwordx4 v32, s[12:15], s21 offen offset:1024 lds
 v_accvgpr_write_b32 a174, v44
 v_mfma_f32_16x16x32_bf16 v[48:51], v[140:143], v[92:95], v[48:51]
 v_cvt_pk_f16_f32 v46, v46, v47
 buffer_load_dwordx4 v33, s[12:15], s21 offen offset:2048 lds
 ds_write_b128 v251, v[228:231] offset:38912
 v_mfma_f32_16x16x32_bf16 v[56:59], v[140:143], v[116:119], v[56:59]
 v_accvgpr_write_b32 a175, v46
 s_add_u32 m0, s81, 30720
 s_add_u32 s21, s88, 4423680
 ds_read_b64_tr_b16 v[208:209], v250 offset:36864
 s_waitcnt lgkmcnt(6)
 v_mfma_f32_16x16x32_bf16 v[40:43], v[144:147], v[72:75], v[40:43]
 ds_read_b128 v[140:143], v23 offset:256
 v_cvt_pk_f16_f32 v52, v52, v53
 buffer_load_dwordx4 v34, s[12:15], s21 offen offset:0 lds
 ds_read_b64_tr_b16 v[210:211], v250 offset:37248
 v_mfma_f32_16x16x32_bf16 v[48:51], v[144:147], v[96:99], v[48:51]
 v_accvgpr_write_b32 a182, v52
 buffer_load_dwordx4 v35, s[12:15], s21 offen offset:1024 lds
 ds_read_b64_tr_b16 v[212:213], v250 offset:36896
 ds_read_b64_tr_b16 v[214:215], v250 offset:37280
 v_mfma_f32_16x16x32_bf16 v[56:59], v[144:147], v[120:123], v[56:59]
 v_cvt_pk_f16_f32 v54, v54, v55
 buffer_load_dwordx4 v36, s[12:15], s21 offen offset:2048 lds
 ds_read_b64_tr_b16 v[216:217], v250 offset:36928
 s_waitcnt lgkmcnt(10)
 v_mfma_f32_16x16x32_bf16 v[40:43], v[148:151], v[76:79], v[40:43]
 ds_read_b128 v[144:147], v22 offset:1536
 v_accvgpr_write_b32 a183, v54
 s_add_u32 m0, s81, 33792
 s_add_u32 s21, s88, 4472832
 ds_read_b64_tr_b16 v[218:219], v250 offset:37312
 v_mfma_f32_16x16x32_bf16 v[48:51], v[148:151], v[100:103], v[48:51]
 v_cvt_pk_f16_f32 v60, v60, v61
 buffer_load_dwordx4 v37, s[12:15], s21 offen offset:0 lds
 s_add_u32 s22, s80, 1081344
 v_accvgpr_write_b32 a190, v60
 v_mfma_f32_16x16x32_bf16 v[56:59], v[148:151], v[124:127], v[56:59]
 v_cvt_pk_f16_f32 v62, v62, v63
 buffer_load_dwordx4 v38, s[12:15], s21 offen offset:1024 lds
 v_accvgpr_write_b32 a191, v62
 s_waitcnt lgkmcnt(9)
 v_mfma_f32_16x16x32_bf16 v[40:43], v[136:139], v[80:83], v[40:43]
 ds_read_b128 v[148:151], v23 offset:1536
 buffer_load_dwordx4 v39, s[12:15], s21 offen offset:2048 lds
 buffer_load_dwordx4 v[220:223], v244, s[36:39], s22 offen
 v_mfma_f32_16x16x32_bf16 v[48:51], v[136:139], v[104:107], v[48:51]
 buffer_load_dwordx4 v[224:227], v245, s[36:39], s22 offen
 buffer_load_dwordx4 v[228:231], v246, s[36:39], s22 offen
 v_mfma_f32_16x16x32_bf16 v[56:59], v[136:139], v[128:131], v[56:59]
 s_waitcnt lgkmcnt(7)
 v_mfma_f32_16x16x32_bf16 v[40:43], v[140:143], v[84:87], v[40:43]
 ds_read_b128 v[136:139], v22 offset:1664
 v_mfma_f32_16x16x32_bf16 v[48:51], v[140:143], v[108:111], v[48:51]
 v_mfma_f32_16x16x32_bf16 v[56:59], v[140:143], v[132:135], v[56:59]
 s_waitcnt lgkmcnt(3)
 v_mfma_f32_16x16x32_bf16 v[44:47], v[144:147], v[64:67], 0
 ds_read_b128 v[140:143], v23 offset:1664
 v_mfma_f32_16x16x32_bf16 v[52:55], v[144:147], v[88:91], 0
 s_waitcnt lgkmcnt(3)
 v_lshlrev_b32 v27, 16, v208
 v_and_b32 v208, 0xffff0000, v208
 v_cvt_pk_f16_f32 v208, v27, v208
 v_accvgpr_write_b32 a4, v208
 v_mfma_f32_16x16x32_bf16 v[60:63], v[144:147], v[112:115], 0
 v_lshlrev_b32 v27, 16, v209
 v_and_b32 v209, 0xffff0000, v209
 v_cvt_pk_f16_f32 v209, v27, v209
 v_accvgpr_write_b32 a5, v209
 s_waitcnt lgkmcnt(2)
 v_mfma_f32_16x16x32_bf16 v[44:47], v[148:151], v[68:71], v[44:47]
 ds_read_b128 v[144:147], v22 offset:1792
 v_cvt_pk_f16_f32 v40, v40, v41
 v_lshlrev_b32 v27, 16, v210
 v_and_b32 v210, 0xffff0000, v210
 v_cvt_pk_f16_f32 v210, v27, v210
 v_mfma_f32_16x16x32_bf16 v[52:55], v[148:151], v[92:95], v[52:55]
 v_accvgpr_write_b32 a192, v40
 v_accvgpr_write_b32 a6, v210
 v_lshlrev_b32 v27, 16, v211
 v_and_b32 v211, 0xffff0000, v211
 v_cvt_pk_f16_f32 v211, v27, v211
 v_mfma_f32_16x16x32_bf16 v[60:63], v[148:151], v[116:119], v[60:63]
 v_cvt_pk_f16_f32 v42, v42, v43
 v_accvgpr_write_b32 a7, v211
 v_lshlrev_b32 v27, 16, v212
 v_and_b32 v212, 0xffff0000, v212
 s_waitcnt lgkmcnt(2)
 v_mfma_f32_16x16x32_bf16 v[44:47], v[136:139], v[72:75], v[44:47]
 ds_read_b128 v[148:151], v23 offset:1792
 v_accvgpr_write_b32 a193, v42
 v_cvt_pk_f16_f32 v212, v27, v212
 v_accvgpr_write_b32 a24, v212
 v_lshlrev_b32 v27, 16, v213
 v_mfma_f32_16x16x32_bf16 v[52:55], v[136:139], v[96:99], v[52:55]
 v_cvt_pk_f16_f32 v48, v48, v49
 v_and_b32 v213, 0xffff0000, v213
 v_cvt_pk_f16_f32 v213, v27, v213
 v_accvgpr_write_b32 a25, v213
 v_lshlrev_b32 v27, 16, v214
 v_mfma_f32_16x16x32_bf16 v[60:63], v[136:139], v[120:123], v[60:63]
 v_accvgpr_write_b32 a200, v48
 v_and_b32 v214, 0xffff0000, v214
 v_cvt_pk_f16_f32 v214, v27, v214
 v_accvgpr_write_b32 a26, v214
 s_waitcnt lgkmcnt(2)
 v_mfma_f32_16x16x32_bf16 v[44:47], v[140:143], v[76:79], v[44:47]
 s_waitcnt vmcnt(18)
 ds_read_b128 v[136:139], v22 offset:12288
 v_cvt_pk_f16_f32 v50, v50, v51
 v_lshlrev_b32 v27, 16, v215
 v_and_b32 v215, 0xffff0000, v215
 v_cvt_pk_f16_f32 v215, v27, v215
 v_mfma_f32_16x16x32_bf16 v[52:55], v[140:143], v[100:103], v[52:55]
 v_accvgpr_write_b32 a201, v50
 v_accvgpr_write_b32 a27, v215
 v_lshlrev_b32 v27, 16, v216
 v_and_b32 v216, 0xffff0000, v216
 v_cvt_pk_f16_f32 v216, v27, v216
 v_mfma_f32_16x16x32_bf16 v[60:63], v[140:143], v[124:127], v[60:63]
 v_cvt_pk_f16_f32 v56, v56, v57
 v_accvgpr_write_b32 a44, v216
 v_lshlrev_b32 v27, 16, v217
 v_and_b32 v217, 0xffff0000, v217
 s_waitcnt lgkmcnt(2)
 v_mfma_f32_16x16x32_bf16 v[44:47], v[144:147], v[80:83], v[44:47]
 ds_read_b128 v[140:143], v23 offset:12288
 v_accvgpr_write_b32 a208, v56
 v_cvt_pk_f16_f32 v217, v27, v217
 v_accvgpr_write_b32 a45, v217
 v_lshlrev_b32 v27, 16, v218
 v_mfma_f32_16x16x32_bf16 v[52:55], v[144:147], v[104:107], v[52:55]
 v_cvt_pk_f16_f32 v58, v58, v59
 v_and_b32 v218, 0xffff0000, v218
 v_cvt_pk_f16_f32 v218, v27, v218
 v_accvgpr_write_b32 a46, v218
 v_lshlrev_b32 v27, 16, v219
 v_mfma_f32_16x16x32_bf16 v[60:63], v[144:147], v[128:131], v[60:63]
 v_accvgpr_write_b32 a209, v58
 v_and_b32 v219, 0xffff0000, v219
 v_cvt_pk_f16_f32 v219, v27, v219
 v_accvgpr_write_b32 a47, v219
 s_waitcnt lgkmcnt(2)
 v_mfma_f32_16x16x32_bf16 v[44:47], v[148:151], v[84:87], v[44:47]
 ds_read_b128 v[144:147], v22 offset:12416
 s_add_u32 m0, s81, 0
 s_add_u32 s21, s88, 4915200
 v_mfma_f32_16x16x32_bf16 v[52:55], v[148:151], v[108:111], v[52:55]
 buffer_load_dwordx4 v28, s[12:15], s21 offen offset:0 lds
 v_mfma_f32_16x16x32_bf16 v[60:63], v[148:151], v[132:135], v[60:63]
 buffer_load_dwordx4 v29, s[12:15], s21 offen offset:1024 lds
 s_waitcnt lgkmcnt(2)
 v_mfma_f32_16x16x32_bf16 v[40:43], v[136:139], v[64:67], 0
 ds_read_b128 v[148:151], v23 offset:12416
 buffer_load_dwordx4 v30, s[12:15], s21 offen offset:2048 lds
 s_waitcnt vmcnt(18)
 v_mfma_f32_16x16x32_bf16 v[48:51], v[136:139], v[88:91], 0
 s_add_u32 m0, s81, 3072
 s_add_u32 s21, s88, 4964352
 ds_write_b128 v251, v[232:235] offset:36864
 v_mfma_f32_16x16x32_bf16 v[56:59], v[136:139], v[112:115], 0
 buffer_load_dwordx4 v31, s[12:15], s21 offen offset:0 lds
 ds_write_b128 v251, v[236:239] offset:37888
 s_waitcnt lgkmcnt(4)
 v_mfma_f32_16x16x32_bf16 v[40:43], v[140:143], v[68:71], v[40:43]
 ds_read_b128 v[136:139], v22 offset:12544
 v_cvt_pk_f16_f32 v44, v44, v45
 buffer_load_dwordx4 v32, s[12:15], s21 offen offset:1024 lds
 v_accvgpr_write_b32 a194, v44
 v_mfma_f32_16x16x32_bf16 v[48:51], v[140:143], v[92:95], v[48:51]
 v_cvt_pk_f16_f32 v46, v46, v47
 buffer_load_dwordx4 v33, s[12:15], s21 offen offset:2048 lds
 ds_write_b128 v251, v[240:243] offset:38912
 v_mfma_f32_16x16x32_bf16 v[56:59], v[140:143], v[116:119], v[56:59]
 v_accvgpr_write_b32 a195, v46
 s_add_u32 m0, s81, 6144
 s_add_u32 s21, s88, 5406720
 ds_read_b64_tr_b16 v[208:209], v250 offset:36864
 s_waitcnt lgkmcnt(6)
 v_mfma_f32_16x16x32_bf16 v[40:43], v[144:147], v[72:75], v[40:43]
 ds_read_b128 v[140:143], v23 offset:12544
 v_cvt_pk_f16_f32 v52, v52, v53
 buffer_load_dwordx4 v34, s[12:15], s21 offen offset:0 lds
 ds_read_b64_tr_b16 v[210:211], v250 offset:37248
 v_mfma_f32_16x16x32_bf16 v[48:51], v[144:147], v[96:99], v[48:51]
 v_accvgpr_write_b32 a202, v52
 buffer_load_dwordx4 v35, s[12:15], s21 offen offset:1024 lds
 ds_read_b64_tr_b16 v[212:213], v250 offset:36896
 ds_read_b64_tr_b16 v[214:215], v250 offset:37280
 v_mfma_f32_16x16x32_bf16 v[56:59], v[144:147], v[120:123], v[56:59]
 v_cvt_pk_f16_f32 v54, v54, v55
 buffer_load_dwordx4 v36, s[12:15], s21 offen offset:2048 lds
 ds_read_b64_tr_b16 v[216:217], v250 offset:36928
 s_waitcnt lgkmcnt(10)
 v_mfma_f32_16x16x32_bf16 v[40:43], v[148:151], v[76:79], v[40:43]
 ds_read_b128 v[144:147], v22 offset:13824
 v_accvgpr_write_b32 a203, v54
 s_add_u32 m0, s81, 9216
 s_add_u32 s21, s88, 5455872
 ds_read_b64_tr_b16 v[218:219], v250 offset:37312
 v_mfma_f32_16x16x32_bf16 v[48:51], v[148:151], v[100:103], v[48:51]
 v_cvt_pk_f16_f32 v60, v60, v61
 buffer_load_dwordx4 v37, s[12:15], s21 offen offset:0 lds
 s_add_u32 s22, s80, 196608
 v_accvgpr_write_b32 a210, v60
 v_mfma_f32_16x16x32_bf16 v[56:59], v[148:151], v[124:127], v[56:59]
 v_cvt_pk_f16_f32 v62, v62, v63
 buffer_load_dwordx4 v38, s[12:15], s21 offen offset:1024 lds
 v_accvgpr_write_b32 a211, v62
 s_waitcnt lgkmcnt(9)
 v_mfma_f32_16x16x32_bf16 v[40:43], v[136:139], v[80:83], v[40:43]
 ds_read_b128 v[148:151], v23 offset:13824
 buffer_load_dwordx4 v39, s[12:15], s21 offen offset:2048 lds
 buffer_load_dwordx4 v[232:235], v247, s[36:39], s22 offen
 v_mfma_f32_16x16x32_bf16 v[48:51], v[136:139], v[104:107], v[48:51]
 buffer_load_dwordx4 v[236:239], v248, s[36:39], s22 offen
 buffer_load_dwordx4 v[240:243], v249, s[36:39], s22 offen
 v_mfma_f32_16x16x32_bf16 v[56:59], v[136:139], v[128:131], v[56:59]
 s_waitcnt lgkmcnt(7)
 v_mfma_f32_16x16x32_bf16 v[40:43], v[140:143], v[84:87], v[40:43]
 ds_read_b128 v[136:139], v22 offset:13952
 v_mfma_f32_16x16x32_bf16 v[48:51], v[140:143], v[108:111], v[48:51]
 v_mfma_f32_16x16x32_bf16 v[56:59], v[140:143], v[132:135], v[56:59]
 s_waitcnt lgkmcnt(3)
 v_mfma_f32_16x16x32_bf16 v[44:47], v[144:147], v[64:67], 0
 ds_read_b128 v[140:143], v23 offset:13952
 v_mfma_f32_16x16x32_bf16 v[52:55], v[144:147], v[88:91], 0
 s_waitcnt lgkmcnt(3)
 v_lshlrev_b32 v27, 16, v208
 v_and_b32 v208, 0xffff0000, v208
 v_cvt_pk_f16_f32 v208, v27, v208
 v_accvgpr_write_b32 a8, v208
 v_mfma_f32_16x16x32_bf16 v[60:63], v[144:147], v[112:115], 0
 v_lshlrev_b32 v27, 16, v209
 v_and_b32 v209, 0xffff0000, v209
 v_cvt_pk_f16_f32 v209, v27, v209
 v_accvgpr_write_b32 a9, v209
 s_waitcnt lgkmcnt(2)
 v_mfma_f32_16x16x32_bf16 v[44:47], v[148:151], v[68:71], v[44:47]
 ds_read_b128 v[144:147], v22 offset:14080
 v_cvt_pk_f16_f32 v40, v40, v41
 v_lshlrev_b32 v27, 16, v210
 v_and_b32 v210, 0xffff0000, v210
 v_cvt_pk_f16_f32 v210, v27, v210
 v_mfma_f32_16x16x32_bf16 v[52:55], v[148:151], v[92:95], v[52:55]
 v_accvgpr_write_b32 a196, v40
 v_accvgpr_write_b32 a10, v210
 v_lshlrev_b32 v27, 16, v211
 v_and_b32 v211, 0xffff0000, v211
 v_cvt_pk_f16_f32 v211, v27, v211
 v_mfma_f32_16x16x32_bf16 v[60:63], v[148:151], v[116:119], v[60:63]
 v_cvt_pk_f16_f32 v42, v42, v43
 v_accvgpr_write_b32 a11, v211
 v_lshlrev_b32 v27, 16, v212
 v_and_b32 v212, 0xffff0000, v212
 s_waitcnt lgkmcnt(2)
 v_mfma_f32_16x16x32_bf16 v[44:47], v[136:139], v[72:75], v[44:47]
 ds_read_b128 v[148:151], v23 offset:14080
 v_accvgpr_write_b32 a197, v42
 v_cvt_pk_f16_f32 v212, v27, v212
 v_accvgpr_write_b32 a28, v212
 v_lshlrev_b32 v27, 16, v213
 v_mfma_f32_16x16x32_bf16 v[52:55], v[136:139], v[96:99], v[52:55]
 v_cvt_pk_f16_f32 v48, v48, v49
 v_and_b32 v213, 0xffff0000, v213
 v_cvt_pk_f16_f32 v213, v27, v213
 v_accvgpr_write_b32 a29, v213
 v_lshlrev_b32 v27, 16, v214
 v_mfma_f32_16x16x32_bf16 v[60:63], v[136:139], v[120:123], v[60:63]
 v_accvgpr_write_b32 a204, v48
 v_and_b32 v214, 0xffff0000, v214
 v_cvt_pk_f16_f32 v214, v27, v214
 v_accvgpr_write_b32 a30, v214
 s_waitcnt lgkmcnt(2)
 v_mfma_f32_16x16x32_bf16 v[44:47], v[140:143], v[76:79], v[44:47]
 s_waitcnt vmcnt(18)
 ds_read_b128 v[136:139], v22 offset:24576
 v_cvt_pk_f16_f32 v50, v50, v51
 v_lshlrev_b32 v27, 16, v215
 v_and_b32 v215, 0xffff0000, v215
 v_cvt_pk_f16_f32 v215, v27, v215
 v_mfma_f32_16x16x32_bf16 v[52:55], v[140:143], v[100:103], v[52:55]
 v_accvgpr_write_b32 a205, v50
 v_accvgpr_write_b32 a31, v215
 v_lshlrev_b32 v27, 16, v216
 v_and_b32 v216, 0xffff0000, v216
 v_cvt_pk_f16_f32 v216, v27, v216
 v_mfma_f32_16x16x32_bf16 v[60:63], v[140:143], v[124:127], v[60:63]
 v_cvt_pk_f16_f32 v56, v56, v57
 v_accvgpr_write_b32 a48, v216
 v_lshlrev_b32 v27, 16, v217
 v_and_b32 v217, 0xffff0000, v217
 s_waitcnt lgkmcnt(2)
 v_mfma_f32_16x16x32_bf16 v[44:47], v[144:147], v[80:83], v[44:47]
 ds_read_b128 v[140:143], v23 offset:24576
 v_accvgpr_write_b32 a212, v56
 v_cvt_pk_f16_f32 v217, v27, v217
 v_accvgpr_write_b32 a49, v217
 v_lshlrev_b32 v27, 16, v218
 v_mfma_f32_16x16x32_bf16 v[52:55], v[144:147], v[104:107], v[52:55]
 v_cvt_pk_f16_f32 v58, v58, v59
 v_and_b32 v218, 0xffff0000, v218
 v_cvt_pk_f16_f32 v218, v27, v218
 v_accvgpr_write_b32 a50, v218
 v_lshlrev_b32 v27, 16, v219
 v_mfma_f32_16x16x32_bf16 v[60:63], v[144:147], v[128:131], v[60:63]
 v_accvgpr_write_b32 a213, v58
 v_and_b32 v219, 0xffff0000, v219
 v_cvt_pk_f16_f32 v219, v27, v219
 v_accvgpr_write_b32 a51, v219
 s_waitcnt lgkmcnt(2)
 v_mfma_f32_16x16x32_bf16 v[44:47], v[148:151], v[84:87], v[44:47]
 ds_read_b128 v[144:147], v22 offset:24704
 s_add_u32 m0, s81, 12288
 s_add_u32 s21, s88, 4030464
 v_mfma_f32_16x16x32_bf16 v[52:55], v[148:151], v[108:111], v[52:55]
 buffer_load_dwordx4 v28, s[12:15], s21 offen offset:0 lds
 v_mfma_f32_16x16x32_bf16 v[60:63], v[148:151], v[132:135], v[60:63]
 buffer_load_dwordx4 v29, s[12:15], s21 offen offset:1024 lds
 s_waitcnt lgkmcnt(2)
 v_mfma_f32_16x16x32_bf16 v[40:43], v[136:139], v[64:67], 0
 ds_read_b128 v[148:151], v23 offset:24704
 buffer_load_dwordx4 v30, s[12:15], s21 offen offset:2048 lds
 s_waitcnt vmcnt(18)
 v_mfma_f32_16x16x32_bf16 v[48:51], v[136:139], v[88:91], 0
 s_add_u32 m0, s81, 15360
 s_add_u32 s21, s88, 4079616
 ds_write_b128 v251, v[220:223] offset:36864
 v_mfma_f32_16x16x32_bf16 v[56:59], v[136:139], v[112:115], 0
 buffer_load_dwordx4 v31, s[12:15], s21 offen offset:0 lds
 ds_write_b128 v251, v[224:227] offset:37888
 s_waitcnt lgkmcnt(4)
 v_mfma_f32_16x16x32_bf16 v[40:43], v[140:143], v[68:71], v[40:43]
 ds_read_b128 v[136:139], v22 offset:24832
 v_cvt_pk_f16_f32 v44, v44, v45
 buffer_load_dwordx4 v32, s[12:15], s21 offen offset:1024 lds
 v_accvgpr_write_b32 a198, v44
 v_mfma_f32_16x16x32_bf16 v[48:51], v[140:143], v[92:95], v[48:51]
 v_cvt_pk_f16_f32 v46, v46, v47
 buffer_load_dwordx4 v33, s[12:15], s21 offen offset:2048 lds
 ds_write_b128 v251, v[228:231] offset:38912
 v_mfma_f32_16x16x32_bf16 v[56:59], v[140:143], v[116:119], v[56:59]
 v_accvgpr_write_b32 a199, v46
 s_add_u32 m0, s81, 18432
 s_add_u32 s21, s88, 4521984
 ds_read_b64_tr_b16 v[208:209], v250 offset:36864
 s_waitcnt lgkmcnt(6)
 v_mfma_f32_16x16x32_bf16 v[40:43], v[144:147], v[72:75], v[40:43]
 ds_read_b128 v[140:143], v23 offset:24832
 v_cvt_pk_f16_f32 v52, v52, v53
 buffer_load_dwordx4 v34, s[12:15], s21 offen offset:0 lds
 ds_read_b64_tr_b16 v[210:211], v250 offset:37248
 v_mfma_f32_16x16x32_bf16 v[48:51], v[144:147], v[96:99], v[48:51]
 v_accvgpr_write_b32 a206, v52
 buffer_load_dwordx4 v35, s[12:15], s21 offen offset:1024 lds
 ds_read_b64_tr_b16 v[212:213], v250 offset:36896
 ds_read_b64_tr_b16 v[214:215], v250 offset:37280
 v_mfma_f32_16x16x32_bf16 v[56:59], v[144:147], v[120:123], v[56:59]
 v_cvt_pk_f16_f32 v54, v54, v55
 buffer_load_dwordx4 v36, s[12:15], s21 offen offset:2048 lds
 ds_read_b64_tr_b16 v[216:217], v250 offset:36928
 s_waitcnt lgkmcnt(10)
 v_mfma_f32_16x16x32_bf16 v[40:43], v[148:151], v[76:79], v[40:43]
 ds_read_b128 v[144:147], v22 offset:26112
 v_accvgpr_write_b32 a207, v54
 s_add_u32 m0, s81, 21504
 s_add_u32 s21, s88, 4571136
 ds_read_b64_tr_b16 v[218:219], v250 offset:37312
 v_mfma_f32_16x16x32_bf16 v[48:51], v[148:151], v[100:103], v[48:51]
 v_cvt_pk_f16_f32 v60, v60, v61
 buffer_load_dwordx4 v37, s[12:15], s21 offen offset:0 lds
 v_accvgpr_write_b32 a214, v60
 v_mfma_f32_16x16x32_bf16 v[56:59], v[148:151], v[124:127], v[56:59]
 v_cvt_pk_f16_f32 v62, v62, v63
 buffer_load_dwordx4 v38, s[12:15], s21 offen offset:1024 lds
 v_accvgpr_write_b32 a215, v62
 s_waitcnt lgkmcnt(9)
 v_mfma_f32_16x16x32_bf16 v[40:43], v[136:139], v[80:83], v[40:43]
 ds_read_b128 v[148:151], v23 offset:26112
 buffer_load_dwordx4 v39, s[12:15], s21 offen offset:2048 lds
 v_mfma_f32_16x16x32_bf16 v[48:51], v[136:139], v[104:107], v[48:51]
 buffer_load_dword v0, v26, s[32:35], 0 offen sc1
 v_mfma_f32_16x16x32_bf16 v[56:59], v[136:139], v[128:131], v[56:59]
 s_waitcnt lgkmcnt(7)
 v_mfma_f32_16x16x32_bf16 v[40:43], v[140:143], v[84:87], v[40:43]
 ds_read_b128 v[136:139], v22 offset:26240
 v_mfma_f32_16x16x32_bf16 v[48:51], v[140:143], v[108:111], v[48:51]
 s_waitcnt lgkmcnt(2)
 v_lshlrev_b32 v27, 16, v208
 v_and_b32 v208, 0xffff0000, v208
 v_cvt_pk_f16_f32 v208, v27, v208
 v_accvgpr_write_b32 a12, v208
 v_mfma_f32_16x16x32_bf16 v[56:59], v[140:143], v[132:135], v[56:59]
 v_lshlrev_b32 v27, 16, v209
 v_and_b32 v209, 0xffff0000, v209
 v_cvt_pk_f16_f32 v209, v27, v209
 v_accvgpr_write_b32 a13, v209
 s_waitcnt lgkmcnt(3)
 v_mfma_f32_16x16x32_bf16 v[44:47], v[144:147], v[64:67], 0
 ds_read_b128 v[140:143], v23 offset:26240
 v_lshlrev_b32 v27, 16, v210
 v_and_b32 v210, 0xffff0000, v210
 v_cvt_pk_f16_f32 v210, v27, v210
 v_accvgpr_write_b32 a14, v210
 v_mfma_f32_16x16x32_bf16 v[52:55], v[144:147], v[88:91], 0
 v_lshlrev_b32 v27, 16, v211
 v_and_b32 v211, 0xffff0000, v211
 v_cvt_pk_f16_f32 v211, v27, v211
 v_accvgpr_write_b32 a15, v211
 v_lshlrev_b32 v27, 16, v212
 v_mfma_f32_16x16x32_bf16 v[60:63], v[144:147], v[112:115], 0
 v_and_b32 v212, 0xffff0000, v212
 v_cvt_pk_f16_f32 v212, v27, v212
 v_accvgpr_write_b32 a32, v212
 v_lshlrev_b32 v27, 16, v213
 s_waitcnt lgkmcnt(2)
 v_mfma_f32_16x16x32_bf16 v[44:47], v[148:151], v[68:71], v[44:47]
 ds_read_b128 v[144:147], v22 offset:26368
 v_cvt_pk_f16_f32 v40, v40, v41
 v_and_b32 v213, 0xffff0000, v213
 v_cvt_pk_f16_f32 v213, v27, v213
 v_accvgpr_write_b32 a33, v213
 v_mfma_f32_16x16x32_bf16 v[52:55], v[148:151], v[92:95], v[52:55]
 v_accvgpr_write_b32 a216, v40
 v_lshlrev_b32 v27, 16, v214
 v_and_b32 v214, 0xffff0000, v214
 v_cvt_pk_f16_f32 v214, v27, v214
 v_accvgpr_write_b32 a34, v214
 v_mfma_f32_16x16x32_bf16 v[60:63], v[148:151], v[116:119], v[60:63]
 v_cvt_pk_f16_f32 v42, v42, v43
 v_lshlrev_b32 v27, 16, v215
 v_and_b32 v215, 0xffff0000, v215
 v_cvt_pk_f16_f32 v215, v27, v215
 s_waitcnt lgkmcnt(2)
 v_mfma_f32_16x16x32_bf16 v[44:47], v[136:139], v[72:75], v[44:47]
 ds_read_b128 v[148:151], v23 offset:26368
 v_accvgpr_write_b32 a217, v42
 v_accvgpr_write_b32 a35, v215
 v_lshlrev_b32 v27, 16, v216
 v_and_b32 v216, 0xffff0000, v216
 v_mfma_f32_16x16x32_bf16 v[52:55], v[136:139], v[96:99], v[52:55]
 v_cvt_pk_f16_f32 v48, v48, v49
 v_cvt_pk_f16_f32 v216, v27, v216
 v_accvgpr_write_b32 a52, v216
 v_lshlrev_b32 v27, 16, v217
 v_and_b32 v217, 0xffff0000, v217
 v_mfma_f32_16x16x32_bf16 v[60:63], v[136:139], v[120:123], v[60:63]
 v_accvgpr_write_b32 a224, v48
 v_cvt_pk_f16_f32 v217, v27, v217
 v_accvgpr_write_b32 a53, v217
 v_lshlrev_b32 v27, 16, v218
 s_waitcnt lgkmcnt(2)
 v_mfma_f32_16x16x32_bf16 v[44:47], v[140:143], v[76:79], v[44:47]
 s_waitcnt vmcnt(16)
 ds_read_b128 v[136:139], v22 offset:0
 v_cvt_pk_f16_f32 v50, v50, v51
 v_and_b32 v218, 0xffff0000, v218
 v_cvt_pk_f16_f32 v218, v27, v218
 v_accvgpr_write_b32 a54, v218
 v_mfma_f32_16x16x32_bf16 v[52:55], v[140:143], v[100:103], v[52:55]
 v_accvgpr_write_b32 a225, v50
 v_lshlrev_b32 v27, 16, v219
 v_and_b32 v219, 0xffff0000, v219
 v_cvt_pk_f16_f32 v219, v27, v219
 v_accvgpr_write_b32 a55, v219
 v_mfma_f32_16x16x32_bf16 v[60:63], v[140:143], v[124:127], v[60:63]
 v_cvt_pk_f16_f32 v56, v56, v57
 v_accvgpr_write_b32 a232, v56
 v_cvt_pk_f16_f32 v58, v58, v59
 v_accvgpr_write_b32 a233, v58
 s_waitcnt lgkmcnt(2)
 v_mfma_f32_16x16x32_bf16 v[44:47], v[144:147], v[80:83], v[44:47]
 ds_read_b128 v[140:143], v23 offset:0
 v_mfma_f32_16x16x32_bf16 v[52:55], v[144:147], v[104:107], v[52:55]
 v_mfma_f32_16x16x32_bf16 v[60:63], v[144:147], v[128:131], v[60:63]
 s_waitcnt lgkmcnt(2)
 v_mfma_f32_16x16x32_bf16 v[44:47], v[148:151], v[84:87], v[44:47]
 ds_read_b128 v[144:147], v22 offset:128
 s_add_u32 m0, s81, 24576
 s_add_u32 s21, s88, 5013504
 v_mfma_f32_16x16x32_bf16 v[52:55], v[148:151], v[108:111], v[52:55]
 buffer_load_dwordx4 v28, s[12:15], s21 offen offset:0 lds
 v_mfma_f32_16x16x32_bf16 v[60:63], v[148:151], v[132:135], v[60:63]
 buffer_load_dwordx4 v29, s[12:15], s21 offen offset:1024 lds
 s_waitcnt lgkmcnt(2)
 v_mfma_f32_16x16x32_bf16 v[40:43], v[136:139], v[64:67], 0
 ds_read_b128 v[148:151], v23 offset:128
 buffer_load_dwordx4 v30, s[12:15], s21 offen offset:2048 lds
 s_waitcnt vmcnt(16)
 v_mfma_f32_16x16x32_bf16 v[48:51], v[136:139], v[88:91], 0
 s_add_u32 m0, s81, 27648
 s_add_u32 s21, s88, 5062656
 ds_write_b128 v251, v[232:235] offset:36864
 v_mfma_f32_16x16x32_bf16 v[56:59], v[136:139], v[112:115], 0
 buffer_load_dwordx4 v31, s[12:15], s21 offen offset:0 lds
 ds_write_b128 v251, v[236:239] offset:37888
 s_waitcnt lgkmcnt(4)
 v_mfma_f32_16x16x32_bf16 v[40:43], v[140:143], v[68:71], v[40:43]
 ds_read_b128 v[136:139], v22 offset:256
 v_cvt_pk_f16_f32 v44, v44, v45
 buffer_load_dwordx4 v32, s[12:15], s21 offen offset:1024 lds
 v_accvgpr_write_b32 a218, v44
 v_mfma_f32_16x16x32_bf16 v[48:51], v[140:143], v[92:95], v[48:51]
 v_cvt_pk_f16_f32 v46, v46, v47
 buffer_load_dwordx4 v33, s[12:15], s21 offen offset:2048 lds
 ds_write_b128 v251, v[240:243] offset:38912
 v_mfma_f32_16x16x32_bf16 v[56:59], v[140:143], v[116:119], v[56:59]
 v_accvgpr_write_b32 a219, v46
 s_add_u32 m0, s81, 30720
 s_add_u32 s21, s88, 5505024
 ds_read_b64_tr_b16 v[208:209], v250 offset:36864
 s_waitcnt lgkmcnt(6)
 v_mfma_f32_16x16x32_bf16 v[40:43], v[144:147], v[72:75], v[40:43]
 ds_read_b128 v[140:143], v23 offset:256
 v_cvt_pk_f16_f32 v52, v52, v53
 buffer_load_dwordx4 v34, s[12:15], s21 offen offset:0 lds
 ds_read_b64_tr_b16 v[210:211], v250 offset:37248
 v_mfma_f32_16x16x32_bf16 v[48:51], v[144:147], v[96:99], v[48:51]
 v_accvgpr_write_b32 a226, v52
 buffer_load_dwordx4 v35, s[12:15], s21 offen offset:1024 lds
 ds_read_b64_tr_b16 v[212:213], v250 offset:36896
 ds_read_b64_tr_b16 v[214:215], v250 offset:37280
 v_mfma_f32_16x16x32_bf16 v[56:59], v[144:147], v[120:123], v[56:59]
 v_cvt_pk_f16_f32 v54, v54, v55
 buffer_load_dwordx4 v36, s[12:15], s21 offen offset:2048 lds
 ds_read_b64_tr_b16 v[216:217], v250 offset:36928
 s_waitcnt lgkmcnt(10)
 v_mfma_f32_16x16x32_bf16 v[40:43], v[148:151], v[76:79], v[40:43]
 ds_read_b128 v[144:147], v22 offset:1536
 v_accvgpr_write_b32 a227, v54
 s_add_u32 m0, s81, 33792
 s_add_u32 s21, s88, 5554176
 ds_read_b64_tr_b16 v[218:219], v250 offset:37312
 v_mfma_f32_16x16x32_bf16 v[48:51], v[148:151], v[100:103], v[48:51]
 v_cvt_pk_f16_f32 v60, v60, v61
 buffer_load_dwordx4 v37, s[12:15], s21 offen offset:0 lds
 v_accvgpr_write_b32 a234, v60
 v_mfma_f32_16x16x32_bf16 v[56:59], v[148:151], v[124:127], v[56:59]
 v_cvt_pk_f16_f32 v62, v62, v63
 buffer_load_dwordx4 v38, s[12:15], s21 offen offset:1024 lds
 v_accvgpr_write_b32 a235, v62
 s_waitcnt lgkmcnt(9)
 v_mfma_f32_16x16x32_bf16 v[40:43], v[136:139], v[80:83], v[40:43]
 ds_read_b128 v[148:151], v23 offset:1536
 buffer_load_dwordx4 v39, s[12:15], s21 offen offset:2048 lds
 v_mfma_f32_16x16x32_bf16 v[48:51], v[136:139], v[104:107], v[48:51]
 v_mfma_f32_16x16x32_bf16 v[56:59], v[136:139], v[128:131], v[56:59]
 s_waitcnt lgkmcnt(7)
 v_mfma_f32_16x16x32_bf16 v[40:43], v[140:143], v[84:87], v[40:43]
 ds_read_b128 v[136:139], v22 offset:1664
 v_mfma_f32_16x16x32_bf16 v[48:51], v[140:143], v[108:111], v[48:51]
 s_waitcnt lgkmcnt(2)
 v_lshlrev_b32 v27, 16, v208
 v_and_b32 v208, 0xffff0000, v208
 v_cvt_pk_f16_f32 v208, v27, v208
 v_accvgpr_write_b32 a16, v208
 v_mfma_f32_16x16x32_bf16 v[56:59], v[140:143], v[132:135], v[56:59]
 v_lshlrev_b32 v27, 16, v209
 v_and_b32 v209, 0xffff0000, v209
 v_cvt_pk_f16_f32 v209, v27, v209
 v_accvgpr_write_b32 a17, v209
 s_waitcnt lgkmcnt(3)
 v_mfma_f32_16x16x32_bf16 v[44:47], v[144:147], v[64:67], 0
 ds_read_b128 v[140:143], v23 offset:1664
 v_lshlrev_b32 v27, 16, v210
 v_and_b32 v210, 0xffff0000, v210
 v_cvt_pk_f16_f32 v210, v27, v210
 v_accvgpr_write_b32 a18, v210
 v_mfma_f32_16x16x32_bf16 v[52:55], v[144:147], v[88:91], 0
 v_lshlrev_b32 v27, 16, v211
 v_and_b32 v211, 0xffff0000, v211
 v_cvt_pk_f16_f32 v211, v27, v211
 v_accvgpr_write_b32 a19, v211
 v_lshlrev_b32 v27, 16, v212
 v_mfma_f32_16x16x32_bf16 v[60:63], v[144:147], v[112:115], 0
 v_and_b32 v212, 0xffff0000, v212
 v_cvt_pk_f16_f32 v212, v27, v212
 v_accvgpr_write_b32 a36, v212
 v_lshlrev_b32 v27, 16, v213
 s_waitcnt lgkmcnt(2)
 v_mfma_f32_16x16x32_bf16 v[44:47], v[148:151], v[68:71], v[44:47]
 ds_read_b128 v[144:147], v22 offset:1792
 v_cvt_pk_f16_f32 v40, v40, v41
 v_and_b32 v213, 0xffff0000, v213
 v_cvt_pk_f16_f32 v213, v27, v213
 v_accvgpr_write_b32 a37, v213
 v_mfma_f32_16x16x32_bf16 v[52:55], v[148:151], v[92:95], v[52:55]
 v_accvgpr_write_b32 a220, v40
 v_lshlrev_b32 v27, 16, v214
 v_and_b32 v214, 0xffff0000, v214
 v_cvt_pk_f16_f32 v214, v27, v214
 v_accvgpr_write_b32 a38, v214
 v_mfma_f32_16x16x32_bf16 v[60:63], v[148:151], v[116:119], v[60:63]
 v_cvt_pk_f16_f32 v42, v42, v43
 v_lshlrev_b32 v27, 16, v215
 v_and_b32 v215, 0xffff0000, v215
 v_cvt_pk_f16_f32 v215, v27, v215
 s_waitcnt lgkmcnt(2)
 v_mfma_f32_16x16x32_bf16 v[44:47], v[136:139], v[72:75], v[44:47]
 ds_read_b128 v[148:151], v23 offset:1792
 v_accvgpr_write_b32 a221, v42
 v_accvgpr_write_b32 a39, v215
 v_lshlrev_b32 v27, 16, v216
 v_and_b32 v216, 0xffff0000, v216
 v_mfma_f32_16x16x32_bf16 v[52:55], v[136:139], v[96:99], v[52:55]
 v_cvt_pk_f16_f32 v48, v48, v49
 v_cvt_pk_f16_f32 v216, v27, v216
 v_accvgpr_write_b32 a56, v216
 v_lshlrev_b32 v27, 16, v217
 v_and_b32 v217, 0xffff0000, v217
 v_mfma_f32_16x16x32_bf16 v[60:63], v[136:139], v[120:123], v[60:63]
 v_accvgpr_write_b32 a228, v48
 v_cvt_pk_f16_f32 v217, v27, v217
 v_accvgpr_write_b32 a57, v217
 v_lshlrev_b32 v27, 16, v218
 s_waitcnt lgkmcnt(2)
 v_mfma_f32_16x16x32_bf16 v[44:47], v[140:143], v[76:79], v[44:47]
 s_waitcnt vmcnt(13)
 ds_read_b128 v[136:139], v22 offset:12288
 v_cvt_pk_f16_f32 v50, v50, v51
 v_and_b32 v218, 0xffff0000, v218
 v_cvt_pk_f16_f32 v218, v27, v218
 v_accvgpr_write_b32 a58, v218
 v_mfma_f32_16x16x32_bf16 v[52:55], v[140:143], v[100:103], v[52:55]
 v_accvgpr_write_b32 a229, v50
 v_lshlrev_b32 v27, 16, v219
 v_and_b32 v219, 0xffff0000, v219
 v_cvt_pk_f16_f32 v219, v27, v219
 v_accvgpr_write_b32 a59, v219
 v_mfma_f32_16x16x32_bf16 v[60:63], v[140:143], v[124:127], v[60:63]
 v_cvt_pk_f16_f32 v56, v56, v57
 v_accvgpr_write_b32 a236, v56
 v_cvt_pk_f16_f32 v58, v58, v59
 v_accvgpr_write_b32 a237, v58
 s_waitcnt lgkmcnt(2)
 v_mfma_f32_16x16x32_bf16 v[44:47], v[144:147], v[80:83], v[44:47]
 ds_read_b128 v[140:143], v23 offset:12288
 v_mfma_f32_16x16x32_bf16 v[52:55], v[144:147], v[104:107], v[52:55]
 v_mfma_f32_16x16x32_bf16 v[60:63], v[144:147], v[128:131], v[60:63]
 s_waitcnt lgkmcnt(2)
 v_mfma_f32_16x16x32_bf16 v[44:47], v[148:151], v[84:87], v[44:47]
 ds_read_b128 v[144:147], v22 offset:12416
 s_add_u32 m0, s81, 0
 s_add_u32 s21, s88, 5898240
 v_mfma_f32_16x16x32_bf16 v[52:55], v[148:151], v[108:111], v[52:55]
 buffer_load_dwordx4 v28, s[12:15], s21 offen offset:0 lds
 v_mfma_f32_16x16x32_bf16 v[60:63], v[148:151], v[132:135], v[60:63]
 buffer_load_dwordx4 v29, s[12:15], s21 offen offset:1024 lds
 s_waitcnt lgkmcnt(2)
 v_mfma_f32_16x16x32_bf16 v[40:43], v[136:139], v[64:67], 0
 ds_read_b128 v[148:151], v23 offset:12416
 buffer_load_dwordx4 v30, s[12:15], s21 offen offset:2048 lds
 v_mfma_f32_16x16x32_bf16 v[48:51], v[136:139], v[88:91], 0
 s_add_u32 m0, s81, 3072
 s_add_u32 s21, s88, 5947392
 v_mfma_f32_16x16x32_bf16 v[56:59], v[136:139], v[112:115], 0
 buffer_load_dwordx4 v31, s[12:15], s21 offen offset:0 lds
 s_waitcnt lgkmcnt(2)
 v_mfma_f32_16x16x32_bf16 v[40:43], v[140:143], v[68:71], v[40:43]
 ds_read_b128 v[136:139], v22 offset:12544
 v_cvt_pk_f16_f32 v44, v44, v45
 buffer_load_dwordx4 v32, s[12:15], s21 offen offset:1024 lds
 v_accvgpr_write_b32 a222, v44
 v_mfma_f32_16x16x32_bf16 v[48:51], v[140:143], v[92:95], v[48:51]
 v_cvt_pk_f16_f32 v46, v46, v47
 buffer_load_dwordx4 v33, s[12:15], s21 offen offset:2048 lds
 v_accvgpr_write_b32 a223, v46
 v_cvt_pk_f16_f32 v52, v52, v53
 v_mfma_f32_16x16x32_bf16 v[56:59], v[140:143], v[116:119], v[56:59]
 v_accvgpr_write_b32 a230, v52
 s_add_u32 m0, s81, 6144
 s_add_u32 s21, s88, 6389760
 v_cvt_pk_f16_f32 v54, v54, v55
 s_waitcnt lgkmcnt(2)
 v_mfma_f32_16x16x32_bf16 v[40:43], v[144:147], v[72:75], v[40:43]
 ds_read_b128 v[140:143], v23 offset:12544
 v_accvgpr_write_b32 a231, v54
 buffer_load_dwordx4 v34, s[12:15], s21 offen offset:0 lds
 v_cvt_pk_f16_f32 v60, v60, v61
 v_mfma_f32_16x16x32_bf16 v[48:51], v[144:147], v[96:99], v[48:51]
 v_accvgpr_write_b32 a238, v60
 buffer_load_dwordx4 v35, s[12:15], s21 offen offset:1024 lds
 v_cvt_pk_f16_f32 v62, v62, v63
 v_accvgpr_write_b32 a239, v62
 v_mfma_f32_16x16x32_bf16 v[56:59], v[144:147], v[120:123], v[56:59]
 buffer_load_dwordx4 v36, s[12:15], s21 offen offset:2048 lds
 s_waitcnt lgkmcnt(2)
 v_mfma_f32_16x16x32_bf16 v[40:43], v[148:151], v[76:79], v[40:43]
 ds_read_b128 v[144:147], v22 offset:13824
 s_add_u32 m0, s81, 9216
 s_add_u32 s21, s88, 6438912
 v_mfma_f32_16x16x32_bf16 v[48:51], v[148:151], v[100:103], v[48:51]
 buffer_load_dwordx4 v37, s[12:15], s21 offen offset:0 lds
 v_mfma_f32_16x16x32_bf16 v[56:59], v[148:151], v[124:127], v[56:59]
 buffer_load_dwordx4 v38, s[12:15], s21 offen offset:1024 lds
 s_waitcnt lgkmcnt(2)
 v_mfma_f32_16x16x32_bf16 v[40:43], v[136:139], v[80:83], v[40:43]
 ds_read_b128 v[148:151], v23 offset:13824
 buffer_load_dwordx4 v39, s[12:15], s21 offen offset:2048 lds
 v_mfma_f32_16x16x32_bf16 v[48:51], v[136:139], v[104:107], v[48:51]
 v_mfma_f32_16x16x32_bf16 v[56:59], v[136:139], v[128:131], v[56:59]
 s_waitcnt lgkmcnt(2)
 v_mfma_f32_16x16x32_bf16 v[40:43], v[140:143], v[84:87], v[40:43]
 ds_read_b128 v[136:139], v22 offset:13952
 v_mfma_f32_16x16x32_bf16 v[48:51], v[140:143], v[108:111], v[48:51]
 v_mfma_f32_16x16x32_bf16 v[56:59], v[140:143], v[132:135], v[56:59]
 s_waitcnt lgkmcnt(2)
 v_mfma_f32_16x16x32_bf16 v[44:47], v[144:147], v[64:67], 0
 ds_read_b128 v[140:143], v23 offset:13952
 v_mfma_f32_16x16x32_bf16 v[52:55], v[144:147], v[88:91], 0
 v_mfma_f32_16x16x32_bf16 v[60:63], v[144:147], v[112:115], 0
 s_waitcnt lgkmcnt(2)
 v_mfma_f32_16x16x32_bf16 v[44:47], v[148:151], v[68:71], v[44:47]
 ds_read_b128 v[144:147], v22 offset:14080
 v_cvt_pk_f16_f32 v40, v40, v41
 v_accvgpr_write_b32 a240, v40
 v_cvt_pk_f16_f32 v42, v42, v43
 v_accvgpr_write_b32 a241, v42
 v_mfma_f32_16x16x32_bf16 v[52:55], v[148:151], v[92:95], v[52:55]
 v_cvt_pk_f16_f32 v48, v48, v49
 v_accvgpr_write_b32 a248, v48
 v_cvt_pk_f16_f32 v50, v50, v51
 v_accvgpr_write_b32 a249, v50
 v_cvt_pk_f16_f32 v152, v56, v57
 v_mfma_f32_16x16x32_bf16 v[60:63], v[148:151], v[116:119], v[60:63]
 v_cvt_pk_f16_f32 v153, v58, v59
 s_waitcnt lgkmcnt(2)
 v_mfma_f32_16x16x32_bf16 v[44:47], v[136:139], v[72:75], v[44:47]
 ds_read_b128 v[148:151], v23 offset:14080
 v_mfma_f32_16x16x32_bf16 v[52:55], v[136:139], v[96:99], v[52:55]
 v_mfma_f32_16x16x32_bf16 v[60:63], v[136:139], v[120:123], v[60:63]
 s_waitcnt lgkmcnt(2)
 v_mfma_f32_16x16x32_bf16 v[44:47], v[140:143], v[76:79], v[44:47]
 s_waitcnt vmcnt(12)
 ds_read_b128 v[136:139], v22 offset:24576
 v_mfma_f32_16x16x32_bf16 v[52:55], v[140:143], v[100:103], v[52:55]
 v_mfma_f32_16x16x32_bf16 v[60:63], v[140:143], v[124:127], v[60:63]
 s_waitcnt lgkmcnt(2)
 v_mfma_f32_16x16x32_bf16 v[44:47], v[144:147], v[80:83], v[44:47]
 ds_read_b128 v[140:143], v23 offset:24576
 v_mfma_f32_16x16x32_bf16 v[52:55], v[144:147], v[104:107], v[52:55]
 v_mfma_f32_16x16x32_bf16 v[60:63], v[144:147], v[128:131], v[60:63]
 s_waitcnt lgkmcnt(2)
 v_mfma_f32_16x16x32_bf16 v[44:47], v[148:151], v[84:87], v[44:47]
 ds_read_b128 v[144:147], v22 offset:24704
 s_add_u32 m0, s81, 12288
 s_add_u32 s21, s88, 6881280
 v_mfma_f32_16x16x32_bf16 v[52:55], v[148:151], v[108:111], v[52:55]
 buffer_load_dwordx4 v28, s[12:15], s21 offen offset:0 lds
 v_mfma_f32_16x16x32_bf16 v[60:63], v[148:151], v[132:135], v[60:63]
 buffer_load_dwordx4 v29, s[12:15], s21 offen offset:1024 lds
 s_waitcnt lgkmcnt(2)
 v_mfma_f32_16x16x32_bf16 v[40:43], v[136:139], v[64:67], 0
 ds_read_b128 v[148:151], v23 offset:24704
 buffer_load_dwordx4 v30, s[12:15], s21 offen offset:2048 lds
 v_mfma_f32_16x16x32_bf16 v[48:51], v[136:139], v[88:91], 0
 s_add_u32 m0, s81, 15360
 s_add_u32 s21, s88, 6930432
 v_mfma_f32_16x16x32_bf16 v[56:59], v[136:139], v[112:115], 0
 buffer_load_dwordx4 v31, s[12:15], s21 offen offset:0 lds
 s_waitcnt lgkmcnt(2)
 v_mfma_f32_16x16x32_bf16 v[40:43], v[140:143], v[68:71], v[40:43]
 ds_read_b128 v[136:139], v22 offset:24832
 v_cvt_pk_f16_f32 v44, v44, v45
 buffer_load_dwordx4 v32, s[12:15], s21 offen offset:1024 lds
 v_accvgpr_write_b32 a242, v44
 v_mfma_f32_16x16x32_bf16 v[48:51], v[140:143], v[92:95], v[48:51]
 v_cvt_pk_f16_f32 v46, v46, v47
 buffer_load_dwordx4 v33, s[12:15], s21 offen offset:2048 lds
 v_accvgpr_write_b32 a243, v46
 v_cvt_pk_f16_f32 v52, v52, v53
 v_mfma_f32_16x16x32_bf16 v[56:59], v[140:143], v[116:119], v[56:59]
 v_accvgpr_write_b32 a250, v52
 s_add_u32 m0, s81, 18432
 s_add_u32 s21, s88, 7372800
 v_cvt_pk_f16_f32 v54, v54, v55
 s_waitcnt lgkmcnt(2)
 v_mfma_f32_16x16x32_bf16 v[40:43], v[144:147], v[72:75], v[40:43]
 ds_read_b128 v[140:143], v23 offset:24832
 v_accvgpr_write_b32 a251, v54
 buffer_load_dwordx4 v34, s[12:15], s21 offen offset:0 lds
 v_cvt_pk_f16_f32 v154, v60, v61
 v_mfma_f32_16x16x32_bf16 v[48:51], v[144:147], v[96:99], v[48:51]
 v_cvt_pk_f16_f32 v155, v62, v63
 buffer_load_dwordx4 v35, s[12:15], s21 offen offset:1024 lds
 v_mfma_f32_16x16x32_bf16 v[56:59], v[144:147], v[120:123], v[56:59]
 buffer_load_dwordx4 v36, s[12:15], s21 offen offset:2048 lds
 s_waitcnt lgkmcnt(2)
 v_mfma_f32_16x16x32_bf16 v[40:43], v[148:151], v[76:79], v[40:43]
 ds_read_b128 v[144:147], v22 offset:26112
 s_add_u32 m0, s81, 21504
 s_add_u32 s21, s88, 7421952
 v_mfma_f32_16x16x32_bf16 v[48:51], v[148:151], v[100:103], v[48:51]
 buffer_load_dwordx4 v37, s[12:15], s21 offen offset:0 lds
 v_mfma_f32_16x16x32_bf16 v[56:59], v[148:151], v[124:127], v[56:59]
 buffer_load_dwordx4 v38, s[12:15], s21 offen offset:1024 lds
 s_waitcnt lgkmcnt(2)
 v_mfma_f32_16x16x32_bf16 v[40:43], v[136:139], v[80:83], v[40:43]
 ds_read_b128 v[148:151], v23 offset:26112
 buffer_load_dwordx4 v39, s[12:15], s21 offen offset:2048 lds
 v_mfma_f32_16x16x32_bf16 v[48:51], v[136:139], v[104:107], v[48:51]
 v_mfma_f32_16x16x32_bf16 v[56:59], v[136:139], v[128:131], v[56:59]
 s_waitcnt lgkmcnt(2)
 v_mfma_f32_16x16x32_bf16 v[40:43], v[140:143], v[84:87], v[40:43]
 ds_read_b128 v[136:139], v22 offset:26240
 v_mfma_f32_16x16x32_bf16 v[48:51], v[140:143], v[108:111], v[48:51]
 v_mfma_f32_16x16x32_bf16 v[56:59], v[140:143], v[132:135], v[56:59]
 s_waitcnt lgkmcnt(2)
 v_mfma_f32_16x16x32_bf16 v[44:47], v[144:147], v[64:67], 0
 ds_read_b128 v[140:143], v23 offset:26240
 v_mfma_f32_16x16x32_bf16 v[52:55], v[144:147], v[88:91], 0
 v_mfma_f32_16x16x32_bf16 v[60:63], v[144:147], v[112:115], 0
 s_waitcnt lgkmcnt(2)
 v_mfma_f32_16x16x32_bf16 v[44:47], v[148:151], v[68:71], v[44:47]
 ds_read_b128 v[144:147], v22 offset:26368
 v_cvt_pk_f16_f32 v40, v40, v41
 v_accvgpr_write_b32 a244, v40
 v_cvt_pk_f16_f32 v42, v42, v43
 v_accvgpr_write_b32 a245, v42
 v_mfma_f32_16x16x32_bf16 v[52:55], v[148:151], v[92:95], v[52:55]
 v_cvt_pk_f16_f32 v48, v48, v49
 v_accvgpr_write_b32 a252, v48
 v_cvt_pk_f16_f32 v50, v50, v51
 v_accvgpr_write_b32 a253, v50
 v_cvt_pk_f16_f32 v156, v56, v57
 v_mfma_f32_16x16x32_bf16 v[60:63], v[148:151], v[116:119], v[60:63]
 v_cvt_pk_f16_f32 v157, v58, v59
 s_waitcnt lgkmcnt(2)
 v_mfma_f32_16x16x32_bf16 v[44:47], v[136:139], v[72:75], v[44:47]
 ds_read_b128 v[148:151], v23 offset:26368
 v_mfma_f32_16x16x32_bf16 v[52:55], v[136:139], v[96:99], v[52:55]
 v_mfma_f32_16x16x32_bf16 v[60:63], v[136:139], v[120:123], v[60:63]
 s_waitcnt lgkmcnt(2)
 v_mfma_f32_16x16x32_bf16 v[44:47], v[140:143], v[76:79], v[44:47]
 s_waitcnt vmcnt(12)
 ds_read_b128 v[136:139], v22 offset:0
 v_mfma_f32_16x16x32_bf16 v[52:55], v[140:143], v[100:103], v[52:55]
 v_mfma_f32_16x16x32_bf16 v[60:63], v[140:143], v[124:127], v[60:63]
 s_waitcnt lgkmcnt(2)
 v_mfma_f32_16x16x32_bf16 v[44:47], v[144:147], v[80:83], v[44:47]
 ds_read_b128 v[140:143], v23 offset:0
 v_mfma_f32_16x16x32_bf16 v[52:55], v[144:147], v[104:107], v[52:55]
 v_mfma_f32_16x16x32_bf16 v[60:63], v[144:147], v[128:131], v[60:63]
 s_waitcnt lgkmcnt(2)
 v_mfma_f32_16x16x32_bf16 v[44:47], v[148:151], v[84:87], v[44:47]
 ds_read_b128 v[144:147], v22 offset:128
 s_add_u32 m0, s81, 24576
 s_add_u32 s21, s88, 5996544
 v_mfma_f32_16x16x32_bf16 v[52:55], v[148:151], v[108:111], v[52:55]
 buffer_load_dwordx4 v28, s[12:15], s21 offen offset:0 lds
 v_mfma_f32_16x16x32_bf16 v[60:63], v[148:151], v[132:135], v[60:63]
 buffer_load_dwordx4 v29, s[12:15], s21 offen offset:1024 lds
 s_waitcnt lgkmcnt(2)
 v_mfma_f32_16x16x32_bf16 v[40:43], v[136:139], v[64:67], 0
 ds_read_b128 v[148:151], v23 offset:128
 buffer_load_dwordx4 v30, s[12:15], s21 offen offset:2048 lds
 v_mfma_f32_16x16x32_bf16 v[48:51], v[136:139], v[88:91], 0
 s_add_u32 m0, s81, 27648
 s_add_u32 s21, s88, 6045696
 v_mfma_f32_16x16x32_bf16 v[56:59], v[136:139], v[112:115], 0
 buffer_load_dwordx4 v31, s[12:15], s21 offen offset:0 lds
 s_waitcnt lgkmcnt(2)
 v_mfma_f32_16x16x32_bf16 v[40:43], v[140:143], v[68:71], v[40:43]
 ds_read_b128 v[136:139], v22 offset:256
 v_cvt_pk_f16_f32 v44, v44, v45
 buffer_load_dwordx4 v32, s[12:15], s21 offen offset:1024 lds
 v_accvgpr_write_b32 a246, v44
 v_mfma_f32_16x16x32_bf16 v[48:51], v[140:143], v[92:95], v[48:51]
 v_cvt_pk_f16_f32 v46, v46, v47
 buffer_load_dwordx4 v33, s[12:15], s21 offen offset:2048 lds
 v_accvgpr_write_b32 a247, v46
 v_cvt_pk_f16_f32 v52, v52, v53
 v_mfma_f32_16x16x32_bf16 v[56:59], v[140:143], v[116:119], v[56:59]
 v_accvgpr_write_b32 a254, v52
 s_add_u32 m0, s81, 30720
 s_add_u32 s21, s88, 6488064
 v_cvt_pk_f16_f32 v54, v54, v55
 s_waitcnt lgkmcnt(2)
 v_mfma_f32_16x16x32_bf16 v[40:43], v[144:147], v[72:75], v[40:43]
 ds_read_b128 v[140:143], v23 offset:256
 v_accvgpr_write_b32 a255, v54
 buffer_load_dwordx4 v34, s[12:15], s21 offen offset:0 lds
 v_cvt_pk_f16_f32 v158, v60, v61
 v_mfma_f32_16x16x32_bf16 v[48:51], v[144:147], v[96:99], v[48:51]
 v_cvt_pk_f16_f32 v159, v62, v63
 buffer_load_dwordx4 v35, s[12:15], s21 offen offset:1024 lds
 v_mfma_f32_16x16x32_bf16 v[56:59], v[144:147], v[120:123], v[56:59]
 buffer_load_dwordx4 v36, s[12:15], s21 offen offset:2048 lds
 s_waitcnt lgkmcnt(2)
 v_mfma_f32_16x16x32_bf16 v[40:43], v[148:151], v[76:79], v[40:43]
 ds_read_b128 v[144:147], v22 offset:1536
 s_add_u32 m0, s81, 33792
 s_add_u32 s21, s88, 6537216
 v_mfma_f32_16x16x32_bf16 v[48:51], v[148:151], v[100:103], v[48:51]
 buffer_load_dwordx4 v37, s[12:15], s21 offen offset:0 lds
 v_mfma_f32_16x16x32_bf16 v[56:59], v[148:151], v[124:127], v[56:59]
 buffer_load_dwordx4 v38, s[12:15], s21 offen offset:1024 lds
 s_waitcnt lgkmcnt(2)
 v_mfma_f32_16x16x32_bf16 v[40:43], v[136:139], v[80:83], v[40:43]
 ds_read_b128 v[148:151], v23 offset:1536
 buffer_load_dwordx4 v39, s[12:15], s21 offen offset:2048 lds
 v_mfma_f32_16x16x32_bf16 v[48:51], v[136:139], v[104:107], v[48:51]
 v_mfma_f32_16x16x32_bf16 v[56:59], v[136:139], v[128:131], v[56:59]
 s_waitcnt lgkmcnt(2)
 v_mfma_f32_16x16x32_bf16 v[40:43], v[140:143], v[84:87], v[40:43]
 ds_read_b128 v[136:139], v22 offset:1664
 v_mfma_f32_16x16x32_bf16 v[48:51], v[140:143], v[108:111], v[48:51]
 v_mfma_f32_16x16x32_bf16 v[56:59], v[140:143], v[132:135], v[56:59]
 s_waitcnt lgkmcnt(2)
 v_mfma_f32_16x16x32_bf16 v[44:47], v[144:147], v[64:67], 0
 ds_read_b128 v[140:143], v23 offset:1664
 v_mfma_f32_16x16x32_bf16 v[52:55], v[144:147], v[88:91], 0
 v_mfma_f32_16x16x32_bf16 v[60:63], v[144:147], v[112:115], 0
 s_waitcnt lgkmcnt(2)
 v_mfma_f32_16x16x32_bf16 v[44:47], v[148:151], v[68:71], v[44:47]
 ds_read_b128 v[144:147], v22 offset:1792
 v_cvt_pk_f16_f32 v160, v40, v41
 v_cvt_pk_f16_f32 v161, v42, v43
 v_cvt_pk_f16_f32 v168, v48, v49
 v_cvt_pk_f16_f32 v169, v50, v51
 v_mfma_f32_16x16x32_bf16 v[52:55], v[148:151], v[92:95], v[52:55]
 v_cvt_pk_f16_f32 v176, v56, v57
 v_cvt_pk_f16_f32 v177, v58, v59
 v_mfma_f32_16x16x32_bf16 v[60:63], v[148:151], v[116:119], v[60:63]
 s_waitcnt lgkmcnt(2)
 v_mfma_f32_16x16x32_bf16 v[44:47], v[136:139], v[72:75], v[44:47]
 ds_read_b128 v[148:151], v23 offset:1792
 v_mfma_f32_16x16x32_bf16 v[52:55], v[136:139], v[96:99], v[52:55]
 v_mfma_f32_16x16x32_bf16 v[60:63], v[136:139], v[120:123], v[60:63]
 s_waitcnt lgkmcnt(2)
 v_mfma_f32_16x16x32_bf16 v[44:47], v[140:143], v[76:79], v[44:47]
 s_waitcnt vmcnt(12)
 ds_read_b128 v[136:139], v22 offset:12288
 v_mfma_f32_16x16x32_bf16 v[52:55], v[140:143], v[100:103], v[52:55]
 v_mfma_f32_16x16x32_bf16 v[60:63], v[140:143], v[124:127], v[60:63]
 s_waitcnt lgkmcnt(2)
 v_mfma_f32_16x16x32_bf16 v[44:47], v[144:147], v[80:83], v[44:47]
 ds_read_b128 v[140:143], v23 offset:12288
 v_mfma_f32_16x16x32_bf16 v[52:55], v[144:147], v[104:107], v[52:55]
 v_mfma_f32_16x16x32_bf16 v[60:63], v[144:147], v[128:131], v[60:63]
 s_waitcnt lgkmcnt(2)
 v_mfma_f32_16x16x32_bf16 v[44:47], v[148:151], v[84:87], v[44:47]
 ds_read_b128 v[144:147], v22 offset:12416
 s_add_u32 m0, s81, 0
 s_add_u32 s21, s88, 6979584
 v_mfma_f32_16x16x32_bf16 v[52:55], v[148:151], v[108:111], v[52:55]
 buffer_load_dwordx4 v28, s[12:15], s21 offen offset:0 lds
 v_mfma_f32_16x16x32_bf16 v[60:63], v[148:151], v[132:135], v[60:63]
 buffer_load_dwordx4 v29, s[12:15], s21 offen offset:1024 lds
 s_waitcnt lgkmcnt(2)
 v_mfma_f32_16x16x32_bf16 v[40:43], v[136:139], v[64:67], 0
 ds_read_b128 v[148:151], v23 offset:12416
 buffer_load_dwordx4 v30, s[12:15], s21 offen offset:2048 lds
 v_mfma_f32_16x16x32_bf16 v[48:51], v[136:139], v[88:91], 0
 s_add_u32 m0, s81, 3072
 s_add_u32 s21, s88, 7028736
 v_mfma_f32_16x16x32_bf16 v[56:59], v[136:139], v[112:115], 0
 buffer_load_dwordx4 v31, s[12:15], s21 offen offset:0 lds
 s_waitcnt lgkmcnt(2)
 v_mfma_f32_16x16x32_bf16 v[40:43], v[140:143], v[68:71], v[40:43]
 ds_read_b128 v[136:139], v22 offset:12544
 v_cvt_pk_f16_f32 v162, v44, v45
 buffer_load_dwordx4 v32, s[12:15], s21 offen offset:1024 lds
 v_cvt_pk_f16_f32 v163, v46, v47
 v_mfma_f32_16x16x32_bf16 v[48:51], v[140:143], v[92:95], v[48:51]
 v_cvt_pk_f16_f32 v170, v52, v53
 buffer_load_dwordx4 v33, s[12:15], s21 offen offset:2048 lds
 v_cvt_pk_f16_f32 v171, v54, v55
 v_cvt_pk_f16_f32 v178, v60, v61
 v_mfma_f32_16x16x32_bf16 v[56:59], v[140:143], v[116:119], v[56:59]
 v_cvt_pk_f16_f32 v179, v62, v63
 s_add_u32 m0, s81, 6144
 s_add_u32 s21, s88, 7471104
 s_waitcnt lgkmcnt(2)
 v_mfma_f32_16x16x32_bf16 v[40:43], v[144:147], v[72:75], v[40:43]
 ds_read_b128 v[140:143], v23 offset:12544
 buffer_load_dwordx4 v34, s[12:15], s21 offen offset:0 lds
 v_mfma_f32_16x16x32_bf16 v[48:51], v[144:147], v[96:99], v[48:51]
 buffer_load_dwordx4 v35, s[12:15], s21 offen offset:1024 lds
 v_mfma_f32_16x16x32_bf16 v[56:59], v[144:147], v[120:123], v[56:59]
 buffer_load_dwordx4 v36, s[12:15], s21 offen offset:2048 lds
 s_waitcnt lgkmcnt(2)
 v_mfma_f32_16x16x32_bf16 v[40:43], v[148:151], v[76:79], v[40:43]
 ds_read_b128 v[144:147], v22 offset:13824
 s_add_u32 m0, s81, 9216
 s_add_u32 s21, s88, 7520256
 v_mfma_f32_16x16x32_bf16 v[48:51], v[148:151], v[100:103], v[48:51]
 buffer_load_dwordx4 v37, s[12:15], s21 offen offset:0 lds
 v_mfma_f32_16x16x32_bf16 v[56:59], v[148:151], v[124:127], v[56:59]
 buffer_load_dwordx4 v38, s[12:15], s21 offen offset:1024 lds
 s_waitcnt lgkmcnt(2)
 v_mfma_f32_16x16x32_bf16 v[40:43], v[136:139], v[80:83], v[40:43]
 ds_read_b128 v[148:151], v23 offset:13824
 buffer_load_dwordx4 v39, s[12:15], s21 offen offset:2048 lds
 v_mfma_f32_16x16x32_bf16 v[48:51], v[136:139], v[104:107], v[48:51]
 v_mfma_f32_16x16x32_bf16 v[56:59], v[136:139], v[128:131], v[56:59]
 s_waitcnt lgkmcnt(2)
 v_mfma_f32_16x16x32_bf16 v[40:43], v[140:143], v[84:87], v[40:43]
 ds_read_b128 v[136:139], v22 offset:13952
 v_mfma_f32_16x16x32_bf16 v[48:51], v[140:143], v[108:111], v[48:51]
 v_mfma_f32_16x16x32_bf16 v[56:59], v[140:143], v[132:135], v[56:59]
 s_waitcnt lgkmcnt(2)
 v_mfma_f32_16x16x32_bf16 v[44:47], v[144:147], v[64:67], 0
 ds_read_b128 v[140:143], v23 offset:13952
 v_mfma_f32_16x16x32_bf16 v[52:55], v[144:147], v[88:91], 0
 v_mfma_f32_16x16x32_bf16 v[60:63], v[144:147], v[112:115], 0
 s_waitcnt lgkmcnt(2)
 v_mfma_f32_16x16x32_bf16 v[44:47], v[148:151], v[68:71], v[44:47]
 ds_read_b128 v[144:147], v22 offset:14080
 v_cvt_pk_f16_f32 v164, v40, v41
 v_cvt_pk_f16_f32 v165, v42, v43
 v_cvt_pk_f16_f32 v172, v48, v49
 v_cvt_pk_f16_f32 v173, v50, v51
 v_mfma_f32_16x16x32_bf16 v[52:55], v[148:151], v[92:95], v[52:55]
 v_cvt_pk_f16_f32 v180, v56, v57
 v_cvt_pk_f16_f32 v181, v58, v59
 v_mfma_f32_16x16x32_bf16 v[60:63], v[148:151], v[116:119], v[60:63]
 s_waitcnt lgkmcnt(2)
 v_mfma_f32_16x16x32_bf16 v[44:47], v[136:139], v[72:75], v[44:47]
 ds_read_b128 v[148:151], v23 offset:14080
 v_mfma_f32_16x16x32_bf16 v[52:55], v[136:139], v[96:99], v[52:55]
 v_mfma_f32_16x16x32_bf16 v[60:63], v[136:139], v[120:123], v[60:63]
 s_waitcnt lgkmcnt(2)
 v_mfma_f32_16x16x32_bf16 v[44:47], v[140:143], v[76:79], v[44:47]
 s_waitcnt vmcnt(12)
 ds_read_b128 v[136:139], v22 offset:24576
 v_mfma_f32_16x16x32_bf16 v[52:55], v[140:143], v[100:103], v[52:55]
 v_mfma_f32_16x16x32_bf16 v[60:63], v[140:143], v[124:127], v[60:63]
 s_waitcnt lgkmcnt(2)
 v_mfma_f32_16x16x32_bf16 v[44:47], v[144:147], v[80:83], v[44:47]
 ds_read_b128 v[140:143], v23 offset:24576
 v_mfma_f32_16x16x32_bf16 v[52:55], v[144:147], v[104:107], v[52:55]
 v_mfma_f32_16x16x32_bf16 v[60:63], v[144:147], v[128:131], v[60:63]
 s_waitcnt lgkmcnt(2)
 v_mfma_f32_16x16x32_bf16 v[44:47], v[148:151], v[84:87], v[44:47]
 ds_read_b128 v[144:147], v22 offset:24704
 s_add_u32 m0, s81, 12288
 s_add_u32 s21, s88, 196608
 v_mfma_f32_16x16x32_bf16 v[52:55], v[148:151], v[108:111], v[52:55]
 buffer_load_dwordx4 v28, s[12:15], s21 offen offset:0 lds
 v_mfma_f32_16x16x32_bf16 v[60:63], v[148:151], v[132:135], v[60:63]
 buffer_load_dwordx4 v29, s[12:15], s21 offen offset:1024 lds
 s_waitcnt lgkmcnt(2)
 v_mfma_f32_16x16x32_bf16 v[40:43], v[136:139], v[64:67], 0
 ds_read_b128 v[148:151], v23 offset:24704
 buffer_load_dwordx4 v30, s[12:15], s21 offen offset:2048 lds
 v_mfma_f32_16x16x32_bf16 v[48:51], v[136:139], v[88:91], 0
 s_add_u32 m0, s81, 15360
 s_add_u32 s21, s88, 2162688
 v_mfma_f32_16x16x32_bf16 v[56:59], v[136:139], v[112:115], 0
 buffer_load_dwordx4 v31, s[12:15], s21 offen offset:0 lds
 s_waitcnt lgkmcnt(2)
 v_mfma_f32_16x16x32_bf16 v[40:43], v[140:143], v[68:71], v[40:43]
 ds_read_b128 v[136:139], v22 offset:24832
 v_cvt_pk_f16_f32 v166, v44, v45
 buffer_load_dwordx4 v32, s[12:15], s21 offen offset:1024 lds
 v_cvt_pk_f16_f32 v167, v46, v47
 v_mfma_f32_16x16x32_bf16 v[48:51], v[140:143], v[92:95], v[48:51]
 v_cvt_pk_f16_f32 v174, v52, v53
 buffer_load_dwordx4 v33, s[12:15], s21 offen offset:2048 lds
 v_cvt_pk_f16_f32 v175, v54, v55
 v_cvt_pk_f16_f32 v182, v60, v61
 v_mfma_f32_16x16x32_bf16 v[56:59], v[140:143], v[116:119], v[56:59]
 v_cvt_pk_f16_f32 v183, v62, v63
 s_add_u32 m0, s81, 18432
 s_add_u32 s21, s88, 688128
 s_waitcnt lgkmcnt(2)
 v_mfma_f32_16x16x32_bf16 v[40:43], v[144:147], v[72:75], v[40:43]
 ds_read_b128 v[140:143], v23 offset:24832
 buffer_load_dwordx4 v34, s[12:15], s21 offen offset:0 lds
 v_mfma_f32_16x16x32_bf16 v[48:51], v[144:147], v[96:99], v[48:51]
 buffer_load_dwordx4 v35, s[12:15], s21 offen offset:1024 lds
 v_mfma_f32_16x16x32_bf16 v[56:59], v[144:147], v[120:123], v[56:59]
 buffer_load_dwordx4 v36, s[12:15], s21 offen offset:2048 lds
 s_waitcnt lgkmcnt(2)
 v_mfma_f32_16x16x32_bf16 v[40:43], v[148:151], v[76:79], v[40:43]
 ds_read_b128 v[144:147], v22 offset:26112
 s_add_u32 m0, s81, 21504
 s_add_u32 s21, s88, 2654208
 v_mfma_f32_16x16x32_bf16 v[48:51], v[148:151], v[100:103], v[48:51]
 buffer_load_dwordx4 v37, s[12:15], s21 offen offset:0 lds
 v_mfma_f32_16x16x32_bf16 v[56:59], v[148:151], v[124:127], v[56:59]
 buffer_load_dwordx4 v38, s[12:15], s21 offen offset:1024 lds
 s_waitcnt lgkmcnt(2)
 v_mfma_f32_16x16x32_bf16 v[40:43], v[136:139], v[80:83], v[40:43]
 ds_read_b128 v[148:151], v23 offset:26112
 buffer_load_dwordx4 v39, s[12:15], s21 offen offset:2048 lds
 v_mfma_f32_16x16x32_bf16 v[48:51], v[136:139], v[104:107], v[48:51]
 v_mfma_f32_16x16x32_bf16 v[56:59], v[136:139], v[128:131], v[56:59]
 s_waitcnt lgkmcnt(2)
 v_mfma_f32_16x16x32_bf16 v[40:43], v[140:143], v[84:87], v[40:43]
 ds_read_b128 v[136:139], v22 offset:26240
 v_mfma_f32_16x16x32_bf16 v[48:51], v[140:143], v[108:111], v[48:51]
 v_mfma_f32_16x16x32_bf16 v[56:59], v[140:143], v[132:135], v[56:59]
 s_waitcnt lgkmcnt(2)
 v_mfma_f32_16x16x32_bf16 v[44:47], v[144:147], v[64:67], 0
 ds_read_b128 v[140:143], v23 offset:26240
 v_mfma_f32_16x16x32_bf16 v[52:55], v[144:147], v[88:91], 0
 v_mfma_f32_16x16x32_bf16 v[60:63], v[144:147], v[112:115], 0
 s_waitcnt lgkmcnt(2)
 v_mfma_f32_16x16x32_bf16 v[44:47], v[148:151], v[68:71], v[44:47]
 ds_read_b128 v[144:147], v22 offset:26368
 v_cvt_pk_f16_f32 v184, v40, v41
 v_cvt_pk_f16_f32 v185, v42, v43
 v_cvt_pk_f16_f32 v192, v48, v49
 v_cvt_pk_f16_f32 v193, v50, v51
 v_mfma_f32_16x16x32_bf16 v[52:55], v[148:151], v[92:95], v[52:55]
 v_cvt_pk_f16_f32 v200, v56, v57
 v_cvt_pk_f16_f32 v201, v58, v59
 v_mfma_f32_16x16x32_bf16 v[60:63], v[148:151], v[116:119], v[60:63]
 s_waitcnt lgkmcnt(2)
 v_mfma_f32_16x16x32_bf16 v[44:47], v[136:139], v[72:75], v[44:47]
 ds_read_b128 v[148:151], v23 offset:26368
 v_mfma_f32_16x16x32_bf16 v[52:55], v[136:139], v[96:99], v[52:55]
 v_mfma_f32_16x16x32_bf16 v[60:63], v[136:139], v[120:123], v[60:63]
 s_waitcnt lgkmcnt(2)
 v_mfma_f32_16x16x32_bf16 v[44:47], v[140:143], v[76:79], v[44:47]
 s_waitcnt vmcnt(12)
 ds_read_b128 v[136:139], v22 offset:0
 v_mfma_f32_16x16x32_bf16 v[52:55], v[140:143], v[100:103], v[52:55]
 v_mfma_f32_16x16x32_bf16 v[60:63], v[140:143], v[124:127], v[60:63]
 s_waitcnt lgkmcnt(2)
 v_mfma_f32_16x16x32_bf16 v[44:47], v[144:147], v[80:83], v[44:47]
 ds_read_b128 v[140:143], v23 offset:0
 v_mfma_f32_16x16x32_bf16 v[52:55], v[144:147], v[104:107], v[52:55]
 v_mfma_f32_16x16x32_bf16 v[60:63], v[144:147], v[128:131], v[60:63]
 s_waitcnt lgkmcnt(2)
 v_mfma_f32_16x16x32_bf16 v[44:47], v[148:151], v[84:87], v[44:47]
 ds_read_b128 v[144:147], v22 offset:128
 s_add_u32 m0, s81, 24576
 s_add_u32 s21, s88, 1179648
 v_mfma_f32_16x16x32_bf16 v[52:55], v[148:151], v[108:111], v[52:55]
 buffer_load_dwordx4 v28, s[12:15], s21 offen offset:0 lds
 v_mfma_f32_16x16x32_bf16 v[60:63], v[148:151], v[132:135], v[60:63]
 buffer_load_dwordx4 v29, s[12:15], s21 offen offset:1024 lds
 s_waitcnt lgkmcnt(2)
 v_mfma_f32_16x16x32_bf16 v[40:43], v[136:139], v[64:67], 0
 ds_read_b128 v[148:151], v23 offset:128
 buffer_load_dwordx4 v30, s[12:15], s21 offen offset:2048 lds
 v_mfma_f32_16x16x32_bf16 v[48:51], v[136:139], v[88:91], 0
 s_add_u32 m0, s81, 27648
 s_add_u32 s21, s88, 3145728
 v_mfma_f32_16x16x32_bf16 v[56:59], v[136:139], v[112:115], 0
 buffer_load_dwordx4 v31, s[12:15], s21 offen offset:0 lds
 s_waitcnt lgkmcnt(2)
 v_mfma_f32_16x16x32_bf16 v[40:43], v[140:143], v[68:71], v[40:43]
 ds_read_b128 v[136:139], v22 offset:256
 v_cvt_pk_f16_f32 v186, v44, v45
 buffer_load_dwordx4 v32, s[12:15], s21 offen offset:1024 lds
 v_cvt_pk_f16_f32 v187, v46, v47
 v_mfma_f32_16x16x32_bf16 v[48:51], v[140:143], v[92:95], v[48:51]
 v_cvt_pk_f16_f32 v194, v52, v53
 buffer_load_dwordx4 v33, s[12:15], s21 offen offset:2048 lds
 v_cvt_pk_f16_f32 v195, v54, v55
 v_cvt_pk_f16_f32 v202, v60, v61
 v_mfma_f32_16x16x32_bf16 v[56:59], v[140:143], v[116:119], v[56:59]
 v_cvt_pk_f16_f32 v203, v62, v63
 s_add_u32 m0, s81, 30720
 s_add_u32 s21, s88, 1671168
 s_waitcnt lgkmcnt(2)
 v_mfma_f32_16x16x32_bf16 v[40:43], v[144:147], v[72:75], v[40:43]
 ds_read_b128 v[140:143], v23 offset:256
 buffer_load_dwordx4 v34, s[12:15], s21 offen offset:0 lds
 v_mfma_f32_16x16x32_bf16 v[48:51], v[144:147], v[96:99], v[48:51]
 buffer_load_dwordx4 v35, s[12:15], s21 offen offset:1024 lds
 v_mfma_f32_16x16x32_bf16 v[56:59], v[144:147], v[120:123], v[56:59]
 buffer_load_dwordx4 v36, s[12:15], s21 offen offset:2048 lds
 s_waitcnt lgkmcnt(2)
 v_mfma_f32_16x16x32_bf16 v[40:43], v[148:151], v[76:79], v[40:43]
 ds_read_b128 v[144:147], v22 offset:1536
 s_add_u32 m0, s81, 33792
 s_add_u32 s21, s88, 3637248
 v_mfma_f32_16x16x32_bf16 v[48:51], v[148:151], v[100:103], v[48:51]
 buffer_load_dwordx4 v37, s[12:15], s21 offen offset:0 lds
 v_mfma_f32_16x16x32_bf16 v[56:59], v[148:151], v[124:127], v[56:59]
 buffer_load_dwordx4 v38, s[12:15], s21 offen offset:1024 lds
 s_waitcnt lgkmcnt(2)
 v_mfma_f32_16x16x32_bf16 v[40:43], v[136:139], v[80:83], v[40:43]
 ds_read_b128 v[148:151], v23 offset:1536
 buffer_load_dwordx4 v39, s[12:15], s21 offen offset:2048 lds
 v_mfma_f32_16x16x32_bf16 v[48:51], v[136:139], v[104:107], v[48:51]
 v_mfma_f32_16x16x32_bf16 v[56:59], v[136:139], v[128:131], v[56:59]
 s_waitcnt lgkmcnt(2)
 v_mfma_f32_16x16x32_bf16 v[40:43], v[140:143], v[84:87], v[40:43]
 ds_read_b128 v[136:139], v22 offset:1664
 v_mfma_f32_16x16x32_bf16 v[48:51], v[140:143], v[108:111], v[48:51]
 v_mfma_f32_16x16x32_bf16 v[56:59], v[140:143], v[132:135], v[56:59]
 s_waitcnt lgkmcnt(2)
 v_mfma_f32_16x16x32_bf16 v[44:47], v[144:147], v[64:67], 0
 ds_read_b128 v[140:143], v23 offset:1664
 v_mfma_f32_16x16x32_bf16 v[52:55], v[144:147], v[88:91], 0
 v_mfma_f32_16x16x32_bf16 v[60:63], v[144:147], v[112:115], 0
 s_waitcnt lgkmcnt(2)
 v_mfma_f32_16x16x32_bf16 v[44:47], v[148:151], v[68:71], v[44:47]
 ds_read_b128 v[144:147], v22 offset:1792
 v_cvt_pk_f16_f32 v188, v40, v41
 v_cvt_pk_f16_f32 v189, v42, v43
 v_cvt_pk_f16_f32 v196, v48, v49
 v_cvt_pk_f16_f32 v197, v50, v51
 v_mfma_f32_16x16x32_bf16 v[52:55], v[148:151], v[92:95], v[52:55]
 v_cvt_pk_f16_f32 v204, v56, v57
 v_cvt_pk_f16_f32 v205, v58, v59
 v_mfma_f32_16x16x32_bf16 v[60:63], v[148:151], v[116:119], v[60:63]
 s_waitcnt lgkmcnt(2)
 v_mfma_f32_16x16x32_bf16 v[44:47], v[136:139], v[72:75], v[44:47]
 ds_read_b128 v[148:151], v23 offset:1792
 v_mfma_f32_16x16x32_bf16 v[52:55], v[136:139], v[96:99], v[52:55]
 v_mfma_f32_16x16x32_bf16 v[60:63], v[136:139], v[120:123], v[60:63]
 s_waitcnt lgkmcnt(2)
 v_mfma_f32_16x16x32_bf16 v[44:47], v[140:143], v[76:79], v[44:47]
 s_waitcnt vmcnt(12)
 ds_read_b128 v[136:139], v22 offset:12288
 v_mfma_f32_16x16x32_bf16 v[52:55], v[140:143], v[100:103], v[52:55]
 v_mfma_f32_16x16x32_bf16 v[60:63], v[140:143], v[124:127], v[60:63]
 s_waitcnt lgkmcnt(2)
 v_mfma_f32_16x16x32_bf16 v[44:47], v[144:147], v[80:83], v[44:47]
 ds_read_b128 v[140:143], v23 offset:12288
 v_mfma_f32_16x16x32_bf16 v[52:55], v[144:147], v[104:107], v[52:55]
 v_mfma_f32_16x16x32_bf16 v[60:63], v[144:147], v[128:131], v[60:63]
 s_waitcnt lgkmcnt(2)
 v_mfma_f32_16x16x32_bf16 v[44:47], v[148:151], v[84:87], v[44:47]
 ds_read_b128 v[144:147], v22 offset:12416
 s_add_u32 m0, s81, 0
 s_add_u32 s21, s88, 4128768
 v_mfma_f32_16x16x32_bf16 v[52:55], v[148:151], v[108:111], v[52:55]
 buffer_load_dwordx4 v28, s[12:15], s21 offen offset:0 lds
 v_mfma_f32_16x16x32_bf16 v[60:63], v[148:151], v[132:135], v[60:63]
 buffer_load_dwordx4 v29, s[12:15], s21 offen offset:1024 lds
 s_waitcnt lgkmcnt(2)
 v_mfma_f32_16x16x32_bf16 v[40:43], v[136:139], v[64:67], 0
 ds_read_b128 v[148:151], v23 offset:12416
 buffer_load_dwordx4 v30, s[12:15], s21 offen offset:2048 lds
 v_mfma_f32_16x16x32_bf16 v[48:51], v[136:139], v[88:91], 0
 s_add_u32 m0, s81, 3072
 s_add_u32 s21, s88, 6094848
 v_mfma_f32_16x16x32_bf16 v[56:59], v[136:139], v[112:115], 0
 buffer_load_dwordx4 v31, s[12:15], s21 offen offset:0 lds
 s_waitcnt lgkmcnt(2)
 v_mfma_f32_16x16x32_bf16 v[40:43], v[140:143], v[68:71], v[40:43]
 ds_read_b128 v[136:139], v22 offset:12544
 v_cvt_pk_f16_f32 v190, v44, v45
 buffer_load_dwordx4 v32, s[12:15], s21 offen offset:1024 lds
 v_cvt_pk_f16_f32 v191, v46, v47
 v_mfma_f32_16x16x32_bf16 v[48:51], v[140:143], v[92:95], v[48:51]
 v_cvt_pk_f16_f32 v198, v52, v53
 buffer_load_dwordx4 v33, s[12:15], s21 offen offset:2048 lds
 v_cvt_pk_f16_f32 v199, v54, v55
 v_cvt_pk_f16_f32 v206, v60, v61
 v_mfma_f32_16x16x32_bf16 v[56:59], v[140:143], v[116:119], v[56:59]
 v_cvt_pk_f16_f32 v207, v62, v63
 s_add_u32 m0, s81, 6144
 s_add_u32 s21, s88, 4620288
 s_waitcnt lgkmcnt(2)
 v_mfma_f32_16x16x32_bf16 v[40:43], v[144:147], v[72:75], v[40:43]
 ds_read_b128 v[140:143], v23 offset:12544
 buffer_load_dwordx4 v34, s[12:15], s21 offen offset:0 lds
 v_mfma_f32_16x16x32_bf16 v[48:51], v[144:147], v[96:99], v[48:51]
 buffer_load_dwordx4 v35, s[12:15], s21 offen offset:1024 lds
 v_mfma_f32_16x16x32_bf16 v[56:59], v[144:147], v[120:123], v[56:59]
 buffer_load_dwordx4 v36, s[12:15], s21 offen offset:2048 lds
 s_waitcnt lgkmcnt(2)
 v_mfma_f32_16x16x32_bf16 v[40:43], v[148:151], v[76:79], v[40:43]
 ds_read_b128 v[144:147], v22 offset:13824
 s_add_u32 m0, s81, 9216
 s_add_u32 s21, s88, 6586368
 v_mfma_f32_16x16x32_bf16 v[48:51], v[148:151], v[100:103], v[48:51]
 buffer_load_dwordx4 v37, s[12:15], s21 offen offset:0 lds
 v_mfma_f32_16x16x32_bf16 v[56:59], v[148:151], v[124:127], v[56:59]
 buffer_load_dwordx4 v38, s[12:15], s21 offen offset:1024 lds
 s_waitcnt lgkmcnt(2)
 v_mfma_f32_16x16x32_bf16 v[40:43], v[136:139], v[80:83], v[40:43]
 ds_read_b128 v[148:151], v23 offset:13824
 buffer_load_dwordx4 v39, s[12:15], s21 offen offset:2048 lds
 v_mfma_f32_16x16x32_bf16 v[48:51], v[136:139], v[104:107], v[48:51]
 v_mfma_f32_16x16x32_bf16 v[56:59], v[136:139], v[128:131], v[56:59]
 s_waitcnt lgkmcnt(2)
 v_mfma_f32_16x16x32_bf16 v[40:43], v[140:143], v[84:87], v[40:43]
 ds_read_b128 v[136:139], v22 offset:13952
 v_mfma_f32_16x16x32_bf16 v[48:51], v[140:143], v[108:111], v[48:51]
 v_mfma_f32_16x16x32_bf16 v[56:59], v[140:143], v[132:135], v[56:59]
 s_waitcnt lgkmcnt(2)
 v_mfma_f32_16x16x32_bf16 v[44:47], v[144:147], v[64:67], 0
 ds_read_b128 v[140:143], v23 offset:13952
 v_mfma_f32_16x16x32_bf16 v[52:55], v[144:147], v[88:91], 0
 v_mfma_f32_16x16x32_bf16 v[60:63], v[144:147], v[112:115], 0
 s_waitcnt lgkmcnt(2)
 v_mfma_f32_16x16x32_bf16 v[44:47], v[148:151], v[68:71], v[44:47]
 ds_read_b128 v[144:147], v22 offset:14080
 v_cvt_pk_f16_f32 v208, v40, v41
 v_cvt_pk_f16_f32 v209, v42, v43
 v_cvt_pk_f16_f32 v216, v48, v49
 v_cvt_pk_f16_f32 v217, v50, v51
 v_mfma_f32_16x16x32_bf16 v[52:55], v[148:151], v[92:95], v[52:55]
 v_cvt_pk_f16_f32 v224, v56, v57
 v_cvt_pk_f16_f32 v225, v58, v59
 v_mfma_f32_16x16x32_bf16 v[60:63], v[148:151], v[116:119], v[60:63]
 s_waitcnt lgkmcnt(2)
 v_mfma_f32_16x16x32_bf16 v[44:47], v[136:139], v[72:75], v[44:47]
 ds_read_b128 v[148:151], v23 offset:14080
 v_mfma_f32_16x16x32_bf16 v[52:55], v[136:139], v[96:99], v[52:55]
 v_mfma_f32_16x16x32_bf16 v[60:63], v[136:139], v[120:123], v[60:63]
 s_waitcnt lgkmcnt(2)
 v_mfma_f32_16x16x32_bf16 v[44:47], v[140:143], v[76:79], v[44:47]
 s_waitcnt vmcnt(12)
 ds_read_b128 v[136:139], v22 offset:24576
 v_mfma_f32_16x16x32_bf16 v[52:55], v[140:143], v[100:103], v[52:55]
 v_mfma_f32_16x16x32_bf16 v[60:63], v[140:143], v[124:127], v[60:63]
 s_waitcnt lgkmcnt(2)
 v_mfma_f32_16x16x32_bf16 v[44:47], v[144:147], v[80:83], v[44:47]
 ds_read_b128 v[140:143], v23 offset:24576
 v_mfma_f32_16x16x32_bf16 v[52:55], v[144:147], v[104:107], v[52:55]
 v_mfma_f32_16x16x32_bf16 v[60:63], v[144:147], v[128:131], v[60:63]
 s_waitcnt lgkmcnt(2)
 v_mfma_f32_16x16x32_bf16 v[44:47], v[148:151], v[84:87], v[44:47]
 ds_read_b128 v[144:147], v22 offset:24704
 s_add_u32 m0, s81, 12288
 s_add_u32 s21, s88, 5111808
 v_mfma_f32_16x16x32_bf16 v[52:55], v[148:151], v[108:111], v[52:55]
 buffer_load_dwordx4 v28, s[12:15], s21 offen offset:0 lds
 v_mfma_f32_16x16x32_bf16 v[60:63], v[148:151], v[132:135], v[60:63]
 buffer_load_dwordx4 v29, s[12:15], s21 offen offset:1024 lds
 s_waitcnt lgkmcnt(2)
 v_mfma_f32_16x16x32_bf16 v[40:43], v[136:139], v[64:67], 0
 ds_read_b128 v[148:151], v23 offset:24704
 buffer_load_dwordx4 v30, s[12:15], s21 offen offset:2048 lds
 v_mfma_f32_16x16x32_bf16 v[48:51], v[136:139], v[88:91], 0
 s_add_u32 m0, s81, 15360
 s_add_u32 s21, s88, 7077888
 v_mfma_f32_16x16x32_bf16 v[56:59], v[136:139], v[112:115], 0
 buffer_load_dwordx4 v31, s[12:15], s21 offen offset:0 lds
 s_waitcnt lgkmcnt(2)
 v_mfma_f32_16x16x32_bf16 v[40:43], v[140:143], v[68:71], v[40:43]
 ds_read_b128 v[136:139], v22 offset:24832
 v_cvt_pk_f16_f32 v210, v44, v45
 buffer_load_dwordx4 v32, s[12:15], s21 offen offset:1024 lds
 v_cvt_pk_f16_f32 v211, v46, v47
 v_mfma_f32_16x16x32_bf16 v[48:51], v[140:143], v[92:95], v[48:51]
 v_cvt_pk_f16_f32 v218, v52, v53
 buffer_load_dwordx4 v33, s[12:15], s21 offen offset:2048 lds
 v_cvt_pk_f16_f32 v219, v54, v55
 v_cvt_pk_f16_f32 v226, v60, v61
 v_mfma_f32_16x16x32_bf16 v[56:59], v[140:143], v[116:119], v[56:59]
 v_cvt_pk_f16_f32 v227, v62, v63
 s_add_u32 m0, s81, 18432
 s_add_u32 s21, s88, 5603328
 s_waitcnt lgkmcnt(2)
 v_mfma_f32_16x16x32_bf16 v[40:43], v[144:147], v[72:75], v[40:43]
 ds_read_b128 v[140:143], v23 offset:24832
 buffer_load_dwordx4 v34, s[12:15], s21 offen offset:0 lds
 v_mfma_f32_16x16x32_bf16 v[48:51], v[144:147], v[96:99], v[48:51]
 buffer_load_dwordx4 v35, s[12:15], s21 offen offset:1024 lds
 v_mfma_f32_16x16x32_bf16 v[56:59], v[144:147], v[120:123], v[56:59]
 buffer_load_dwordx4 v36, s[12:15], s21 offen offset:2048 lds
 s_waitcnt lgkmcnt(2)
 v_mfma_f32_16x16x32_bf16 v[40:43], v[148:151], v[76:79], v[40:43]
 ds_read_b128 v[144:147], v22 offset:26112
 s_add_u32 m0, s81, 21504
 s_add_u32 s21, s88, 7569408
 v_mfma_f32_16x16x32_bf16 v[48:51], v[148:151], v[100:103], v[48:51]
 buffer_load_dwordx4 v37, s[12:15], s21 offen offset:0 lds
 v_mfma_f32_16x16x32_bf16 v[56:59], v[148:151], v[124:127], v[56:59]
 buffer_load_dwordx4 v38, s[12:15], s21 offen offset:1024 lds
 s_waitcnt lgkmcnt(2)
 v_mfma_f32_16x16x32_bf16 v[40:43], v[136:139], v[80:83], v[40:43]
 ds_read_b128 v[148:151], v23 offset:26112
 buffer_load_dwordx4 v39, s[12:15], s21 offen offset:2048 lds
 v_mfma_f32_16x16x32_bf16 v[48:51], v[136:139], v[104:107], v[48:51]
 v_mfma_f32_16x16x32_bf16 v[56:59], v[136:139], v[128:131], v[56:59]
 s_waitcnt lgkmcnt(2)
 v_mfma_f32_16x16x32_bf16 v[40:43], v[140:143], v[84:87], v[40:43]
 ds_read_b128 v[136:139], v22 offset:26240
 v_mfma_f32_16x16x32_bf16 v[48:51], v[140:143], v[108:111], v[48:51]
 v_mfma_f32_16x16x32_bf16 v[56:59], v[140:143], v[132:135], v[56:59]
 s_waitcnt lgkmcnt(2)
 v_mfma_f32_16x16x32_bf16 v[44:47], v[144:147], v[64:67], 0
 ds_read_b128 v[140:143], v23 offset:26240
 v_mfma_f32_16x16x32_bf16 v[52:55], v[144:147], v[88:91], 0
 v_mfma_f32_16x16x32_bf16 v[60:63], v[144:147], v[112:115], 0
 s_waitcnt lgkmcnt(2)
 v_mfma_f32_16x16x32_bf16 v[44:47], v[148:151], v[68:71], v[44:47]
 ds_read_b128 v[144:147], v22 offset:26368
 v_cvt_pk_f16_f32 v212, v40, v41
 v_cvt_pk_f16_f32 v213, v42, v43
 v_cvt_pk_f16_f32 v220, v48, v49
 v_cvt_pk_f16_f32 v221, v50, v51
 v_mfma_f32_16x16x32_bf16 v[52:55], v[148:151], v[92:95], v[52:55]
 v_cvt_pk_f16_f32 v228, v56, v57
 v_cvt_pk_f16_f32 v229, v58, v59
 v_mfma_f32_16x16x32_bf16 v[60:63], v[148:151], v[116:119], v[60:63]
 s_waitcnt lgkmcnt(2)
 v_mfma_f32_16x16x32_bf16 v[44:47], v[136:139], v[72:75], v[44:47]
 ds_read_b128 v[148:151], v23 offset:26368
 v_mfma_f32_16x16x32_bf16 v[52:55], v[136:139], v[96:99], v[52:55]
 v_mfma_f32_16x16x32_bf16 v[60:63], v[136:139], v[120:123], v[60:63]
 s_waitcnt lgkmcnt(2)
 v_mfma_f32_16x16x32_bf16 v[44:47], v[140:143], v[76:79], v[44:47]
 s_waitcnt vmcnt(12)
 ds_read_b128 v[136:139], v22 offset:0
 v_mfma_f32_16x16x32_bf16 v[52:55], v[140:143], v[100:103], v[52:55]
 v_mfma_f32_16x16x32_bf16 v[60:63], v[140:143], v[124:127], v[60:63]
 s_waitcnt lgkmcnt(2)
 v_mfma_f32_16x16x32_bf16 v[44:47], v[144:147], v[80:83], v[44:47]
 ds_read_b128 v[140:143], v23 offset:0
 v_mfma_f32_16x16x32_bf16 v[52:55], v[144:147], v[104:107], v[52:55]
 v_mfma_f32_16x16x32_bf16 v[60:63], v[144:147], v[128:131], v[60:63]
 s_waitcnt lgkmcnt(2)
 v_mfma_f32_16x16x32_bf16 v[44:47], v[148:151], v[84:87], v[44:47]
 ds_read_b128 v[144:147], v22 offset:128
 v_mfma_f32_16x16x32_bf16 v[52:55], v[148:151], v[108:111], v[52:55]
 v_mfma_f32_16x16x32_bf16 v[60:63], v[148:151], v[132:135], v[60:63]
 s_mov_b32 s101, 0
 s_branch fm_8
fm_7:
 s_sleep 8
 buffer_load_dword v0, v26, s[32:35], 0 offen sc1
 s_add_u32 s101, s101, 1
 s_cmp_gt_u32 s101, 131072
 s_cbranch_scc1 end0
 s_waitcnt vmcnt(0)
fm_8:
 v_readlane_b32 s22, v0, 0
 v_readlane_b32 s23, v0, 32
 s_add_u32 s22, s22, s23
 v_readlane_b32 s23, v0, 1
 s_add_u32 s22, s22, s23
 v_readlane_b32 s23, v0, 33
 s_add_u32 s22, s22, s23
 v_readlane_b32 s23, v0, 2
 s_add_u32 s22, s22, s23
 v_readlane_b32 s23, v0, 34
 s_add_u32 s22, s22, s23
 v_readlane_b32 s23, v0, 3
 s_add_u32 s22, s22, s23
 v_readlane_b32 s23, v0, 35
 s_add_u32 s22, s22, s23
 v_readlane_b32 s21, v0, 19
 v_readlane_b32 s23, v0, 21
 s_cmp_ge_u32 s22, 256
 s_cselect_b32 s23, s23, 0
 s_cmp_ge_u32 s21, 32
 s_cselect_b32 s23, s23, 0
 s_cmp_eq_u32 s23, 0
 s_cbranch_scc1 fm_7
 v_readlane_b32 s21, v0, s82
 s_cmp_ge_u32 s21, s83
 s_cselect_b32 s21, 1, 0
 s_andn2_b32 s53, s21, s53
 s_add_u32 s37, s44, 83886079
 s_add_u32 s21, s44, 180355072
 s_xor_b32 s37, s37, s21
 s_lshr_b32 s37, s37, 21
 s_xor_b32 s37, s37, s23
 s_xor_b32 s37, s37, 0
 s_and_b32 s37, s37, 1
 s_lshl_b32 s37, s37, 13
 s_sub_u32 s23, s23, 1
 s_lshl_b32 s23, s23, 13
 v_add_u32 v13, s23, v13
 v_add_u32 v4, s23, v4
 s_add_u32 s12, s44, 81068032
 s_addc_u32 s13, s45, 0
 s_mov_b32 s14, 129024
 s_mov_b32 s15, 0x00020000
 v_and_b32 v27, 7, v2
 v_mul_u32_u24 v27, 1280, v27
 v_lshrrev_b32 v39, 3, v1
 v_mul_u32_u24 v39, 40, v39
 s_mul_i32 s21, s20, 320
 v_add3_u32 v27, v27, v39, s21
 buffer_load_dwordx4 v[28:31], v27, s[28:31], 0 offen offset:0
 buffer_load_dwordx4 v[32:35], v27, s[28:31], 0 offen offset:16
 buffer_load_dwordx2 v[36:37], v27, s[28:31], 0 offen offset:32
 s_and_b32 s21, s51, 3
 s_mul_i32 s21, s21, 540672
 buffer_load_dword v38, v9, s[8:11], s21 offen sc1
 buffer_load_dword v38, v8, s[8:11], s21 offen offset:0 sc1
 buffer_load_dword v38, v8, s[8:11], s21 offen offset:1024 sc1
 s_waitcnt lgkmcnt(2)
 v_mfma_f32_16x16x32_bf16 v[40:43], v[136:139], v[64:67], 0
 ds_read_b128 v[148:151], v23 offset:128
 v_mfma_f32_16x16x32_bf16 v[48:51], v[136:139], v[88:91], 0
 v_mfma_f32_16x16x32_bf16 v[56:59], v[136:139], v[112:115], 0
 s_waitcnt lgkmcnt(2)
 v_mfma_f32_16x16x32_bf16 v[40:43], v[140:143], v[68:71], v[40:43]
 ds_read_b128 v[136:139], v22 offset:256
 v_cvt_pk_f16_f32 v214, v44, v45
 v_cvt_pk_f16_f32 v215, v46, v47
 v_cvt_pk_f16_f32 v222, v52, v53
 v_cvt_pk_f16_f32 v223, v54, v55
 v_mfma_f32_16x16x32_bf16 v[48:51], v[140:143], v[92:95], v[48:51]
 v_cvt_pk_f16_f32 v230, v60, v61
 v_cvt_pk_f16_f32 v231, v62, v63
 v_mfma_f32_16x16x32_bf16 v[56:59], v[140:143], v[116:119], v[56:59]
 s_waitcnt lgkmcnt(2)
 v_mfma_f32_16x16x32_bf16 v[40:43], v[144:147], v[72:75], v[40:43]
 ds_read_b128 v[140:143], v23 offset:256
 v_mfma_f32_16x16x32_bf16 v[48:51], v[144:147], v[96:99], v[48:51]
 v_mfma_f32_16x16x32_bf16 v[56:59], v[144:147], v[120:123], v[56:59]
 s_waitcnt lgkmcnt(2)
 v_mfma_f32_16x16x32_bf16 v[40:43], v[148:151], v[76:79], v[40:43]
 ds_read_b128 v[144:147], v22 offset:1536
 v_mfma_f32_16x16x32_bf16 v[48:51], v[148:151], v[100:103], v[48:51]
 v_mfma_f32_16x16x32_bf16 v[56:59], v[148:151], v[124:127], v[56:59]
 s_waitcnt lgkmcnt(2)
 v_mfma_f32_16x16x32_bf16 v[40:43], v[136:139], v[80:83], v[40:43]
 ds_read_b128 v[148:151], v23 offset:1536
 v_mfma_f32_16x16x32_bf16 v[48:51], v[136:139], v[104:107], v[48:51]
 v_mfma_f32_16x16x32_bf16 v[56:59], v[136:139], v[128:131], v[56:59]
 s_waitcnt lgkmcnt(2)
 v_mfma_f32_16x16x32_bf16 v[40:43], v[140:143], v[84:87], v[40:43]
 ds_read_b128 v[136:139], v22 offset:1664
 v_mfma_f32_16x16x32_bf16 v[48:51], v[140:143], v[108:111], v[48:51]
 v_mfma_f32_16x16x32_bf16 v[56:59], v[140:143], v[132:135], v[56:59]
 s_waitcnt lgkmcnt(2)
 v_mfma_f32_16x16x32_bf16 v[44:47], v[144:147], v[64:67], 0
 ds_read_b128 v[140:143], v23 offset:1664
 v_mfma_f32_16x16x32_bf16 v[52:55], v[144:147], v[88:91], 0
 v_mfma_f32_16x16x32_bf16 v[60:63], v[144:147], v[112:115], 0
 s_waitcnt lgkmcnt(2)
 v_mfma_f32_16x16x32_bf16 v[44:47], v[148:151], v[68:71], v[44:47]
 ds_read_b128 v[144:147], v22 offset:1792
 v_cvt_pk_f16_f32 v232, v40, v41
 v_cvt_pk_f16_f32 v233, v42, v43
 v_cvt_pk_f16_f32 v240, v48, v49
 v_cvt_pk_f16_f32 v241, v50, v51
 v_mfma_f32_16x16x32_bf16 v[52:55], v[148:151], v[92:95], v[52:55]
 v_cvt_pk_f16_f32 v248, v56, v57
 v_cvt_pk_f16_f32 v249, v58, v59
 v_mfma_f32_16x16x32_bf16 v[60:63], v[148:151], v[116:119], v[60:63]
 s_waitcnt lgkmcnt(2)
 v_mfma_f32_16x16x32_bf16 v[44:47], v[136:139], v[72:75], v[44:47]
 ds_read_b128 v[148:151], v23 offset:1792
 v_mfma_f32_16x16x32_bf16 v[52:55], v[136:139], v[96:99], v[52:55]
 v_mfma_f32_16x16x32_bf16 v[60:63], v[136:139], v[120:123], v[60:63]
 s_waitcnt lgkmcnt(2)
 v_mfma_f32_16x16x32_bf16 v[44:47], v[140:143], v[76:79], v[44:47]
 s_waitcnt vmcnt(6)
 ds_read_b128 v[136:139], v22 offset:12288
 v_mfma_f32_16x16x32_bf16 v[52:55], v[140:143], v[100:103], v[52:55]
 v_mfma_f32_16x16x32_bf16 v[60:63], v[140:143], v[124:127], v[60:63]
 s_waitcnt lgkmcnt(2)
 v_mfma_f32_16x16x32_bf16 v[44:47], v[144:147], v[80:83], v[44:47]
 ds_read_b128 v[140:143], v23 offset:12288
 v_mfma_f32_16x16x32_bf16 v[52:55], v[144:147], v[104:107], v[52:55]
 v_mfma_f32_16x16x32_bf16 v[60:63], v[144:147], v[128:131], v[60:63]
 s_waitcnt lgkmcnt(2)
 v_mfma_f32_16x16x32_bf16 v[44:47], v[148:151], v[84:87], v[44:47]
 ds_read_b128 v[144:147], v22 offset:12416
 v_mfma_f32_16x16x32_bf16 v[52:55], v[148:151], v[108:111], v[52:55]
 v_mfma_f32_16x16x32_bf16 v[60:63], v[148:151], v[132:135], v[60:63]
 buffer_load_dword v0, off, s[12:15], s79 sc1
 s_waitcnt lgkmcnt(2)
 v_mfma_f32_16x16x32_bf16 v[40:43], v[136:139], v[64:67], 0
 ds_read_b128 v[148:151], v23 offset:12416
 v_mfma_f32_16x16x32_bf16 v[48:51], v[136:139], v[88:91], 0
 v_mfma_f32_16x16x32_bf16 v[56:59], v[136:139], v[112:115], 0
 s_waitcnt lgkmcnt(2)
 v_mfma_f32_16x16x32_bf16 v[40:43], v[140:143], v[68:71], v[40:43]
 ds_read_b128 v[136:139], v22 offset:12544
 v_cvt_pk_f16_f32 v234, v44, v45
 v_cvt_pk_f16_f32 v235, v46, v47
 v_cvt_pk_f16_f32 v242, v52, v53
 v_cvt_pk_f16_f32 v243, v54, v55
 v_mfma_f32_16x16x32_bf16 v[48:51], v[140:143], v[92:95], v[48:51]
 v_cvt_pk_f16_f32 v250, v60, v61
 v_cvt_pk_f16_f32 v251, v62, v63
 v_mfma_f32_16x16x32_bf16 v[56:59], v[140:143], v[116:119], v[56:59]
 s_waitcnt lgkmcnt(2)
 v_mfma_f32_16x16x32_bf16 v[40:43], v[144:147], v[72:75], v[40:43]
 ds_read_b128 v[140:143], v23 offset:12544
 v_mfma_f32_16x16x32_bf16 v[48:51], v[144:147], v[96:99], v[48:51]
 v_mfma_f32_16x16x32_bf16 v[56:59], v[144:147], v[120:123], v[56:59]
 s_waitcnt lgkmcnt(2)
 v_mfma_f32_16x16x32_bf16 v[40:43], v[148:151], v[76:79], v[40:43]
 ds_read_b128 v[144:147], v22 offset:13824
 v_mfma_f32_16x16x32_bf16 v[48:51], v[148:151], v[100:103], v[48:51]
 v_mfma_f32_16x16x32_bf16 v[56:59], v[148:151], v[124:127], v[56:59]
 s_waitcnt lgkmcnt(2)
 v_mfma_f32_16x16x32_bf16 v[40:43], v[136:139], v[80:83], v[40:43]
 ds_read_b128 v[148:151], v23 offset:13824
 v_mfma_f32_16x16x32_bf16 v[48:51], v[136:139], v[104:107], v[48:51]
 v_mfma_f32_16x16x32_bf16 v[56:59], v[136:139], v[128:131], v[56:59]
 s_waitcnt lgkmcnt(2)
 v_mfma_f32_16x16x32_bf16 v[40:43], v[140:143], v[84:87], v[40:43]
 ds_read_b128 v[136:139], v22 offset:13952
 v_mfma_f32_16x16x32_bf16 v[48:51], v[140:143], v[108:111], v[48:51]
 v_mfma_f32_16x16x32_bf16 v[56:59], v[140:143], v[132:135], v[56:59]
 s_waitcnt lgkmcnt(2)
 v_mfma_f32_16x16x32_bf16 v[44:47], v[144:147], v[64:67], 0
 ds_read_b128 v[140:143], v23 offset:13952
 v_mfma_f32_16x16x32_bf16 v[52:55], v[144:147], v[88:91], 0
 v_mfma_f32_16x16x32_bf16 v[60:63], v[144:147], v[112:115], 0
 s_waitcnt lgkmcnt(2)
 v_mfma_f32_16x16x32_bf16 v[44:47], v[148:151], v[68:71], v[44:47]
 ds_read_b128 v[144:147], v22 offset:14080
 v_cvt_pk_f16_f32 v236, v40, v41
 v_cvt_pk_f16_f32 v237, v42, v43
 v_cvt_pk_f16_f32 v244, v48, v49
 v_cvt_pk_f16_f32 v245, v50, v51
 v_mfma_f32_16x16x32_bf16 v[52:55], v[148:151], v[92:95], v[52:55]
 v_cvt_pk_f16_f32 v252, v56, v57
 v_cvt_pk_f16_f32 v253, v58, v59
 v_mfma_f32_16x16x32_bf16 v[60:63], v[148:151], v[116:119], v[60:63]
 s_waitcnt lgkmcnt(2)
 v_mfma_f32_16x16x32_bf16 v[44:47], v[136:139], v[72:75], v[44:47]
 ds_read_b128 v[148:151], v23 offset:14080
 v_mfma_f32_16x16x32_bf16 v[52:55], v[136:139], v[96:99], v[52:55]
 v_mfma_f32_16x16x32_bf16 v[60:63], v[136:139], v[120:123], v[60:63]
 s_waitcnt lgkmcnt(2)
 v_mfma_f32_16x16x32_bf16 v[44:47], v[140:143], v[76:79], v[44:47]
 v_mfma_f32_16x16x32_bf16 v[52:55], v[140:143], v[100:103], v[52:55]
 v_mfma_f32_16x16x32_bf16 v[60:63], v[140:143], v[124:127], v[60:63]
 s_waitcnt lgkmcnt(1)
 v_mfma_f32_16x16x32_bf16 v[44:47], v[144:147], v[80:83], v[44:47]
 v_mfma_f32_16x16x32_bf16 v[52:55], v[144:147], v[104:107], v[52:55]
 v_mfma_f32_16x16x32_bf16 v[60:63], v[144:147], v[128:131], v[60:63]
 s_waitcnt lgkmcnt(0)
 v_mfma_f32_16x16x32_bf16 v[44:47], v[148:151], v[84:87], v[44:47]
 v_mfma_f32_16x16x32_bf16 v[52:55], v[148:151], v[108:111], v[52:55]
 v_mfma_f32_16x16x32_bf16 v[60:63], v[148:151], v[132:135], v[60:63]
 s_nop 7
 v_cvt_pk_f16_f32 v238, v44, v45
 v_cvt_pk_f16_f32 v239, v46, v47
 v_cvt_pk_f16_f32 v246, v52, v53
 v_cvt_pk_f16_f32 v247, v54, v55
 v_cvt_pk_f16_f32 v254, v60, v61
 v_cvt_pk_f16_f32 v255, v62, v63
 s_add_u32 s28, s44, 88080384
 s_addc_u32 s29, s45, 0
 s_mov_b32 s30, 83886080
 s_mov_b32 s31, 0x00020000
 s_waitcnt vmcnt(0)
 v_readfirstlane_b32 s21, v0
 s_cmp_lg_u32 s21, 0
 s_cbranch_scc1 pf_10
 v_mov_b32 v62, 0
 s_mov_b32 s101, 0
wf_11:
 buffer_load_dword v63, v62, s[12:15], s79 offen sc1
 s_add_u32 s101, s101, 1
 s_cmp_gt_u32 s101, 131072
 s_cbranch_scc1 end0
 s_waitcnt vmcnt(0)
 v_readfirstlane_b32 s100, v63
 s_cmp_ge_u32 s100, 1
 s_cbranch_scc1 wf_12
 s_sleep 4
 s_branch wf_11
wf_12:
 v_mov_b32 v0, s100
pf_10:
 s_mov_b32 s87, 0
 s_sub_u32 s21, s64, 1310720
 s_cmp_ge_u32 s20, 2
 s_cbranch_scc1 pf_9
 buffer_load_dwordx4 v[112:115], v18, s[16:19], 0 offen sc1
 buffer_load_dwordx2 v[116:117], v19, s[16:19], 0 offen sc1
pf_9:
 buffer_load_dwordx4 v[126:129], v16, s[28:31], s21 offen offset:0 sc1
 buffer_load_dwordx4 v[130:133], v16, s[28:31], s21 offen offset:1024 sc1
 buffer_load_dwordx4 v[134:137], v16, s[28:31], s21 offen offset:2048 sc1
 v_lshlrev_b32 v27, 16, v28
 v_and_b32 v28, 0xffff0000, v28
 v_cvt_pk_f16_f32 v28, v27, v28
 v_lshlrev_b32 v27, 16, v29
 v_and_b32 v29, 0xffff0000, v29
 v_cvt_pk_f16_f32 v29, v27, v29
 v_lshlrev_b32 v27, 16, v30
 v_and_b32 v30, 0xffff0000, v30
 v_cvt_pk_f16_f32 v30, v27, v30
 v_lshlrev_b32 v27, 16, v31
 v_and_b32 v31, 0xffff0000, v31
 v_cvt_pk_f16_f32 v31, v27, v31
 v_lshlrev_b32 v27, 16, v32
 v_and_b32 v32, 0xffff0000, v32
 v_cvt_pk_f16_f32 v32, v27, v32
 v_lshlrev_b32 v27, 16, v33
 v_and_b32 v33, 0xffff0000, v33
 v_cvt_pk_f16_f32 v33, v27, v33
 v_lshlrev_b32 v27, 16, v34
 v_and_b32 v34, 0xffff0000, v34
 v_cvt_pk_f16_f32 v34, v27, v34
 v_lshlrev_b32 v27, 16, v35
 v_and_b32 v35, 0xffff0000, v35
 v_cvt_pk_f16_f32 v35, v27, v35
 v_lshlrev_b32 v27, 16, v36
 v_and_b32 v36, 0xffff0000, v36
 v_cvt_pk_f16_f32 v36, v27, v36
 v_lshlrev_b32 v27, 16, v37
 v_and_b32 v37, 0xffff0000, v37
 v_cvt_pk_f16_f32 v37, v27, v37
 s_lshl_b32 s21, s20, 2
 s_add_u32 s21, s21, 20480
 v_add_u32 v22, s21, v16
 v_bfe_u32 v23, v1, 2, 3
 v_lshlrev_b32 v23, 4, v23
 v_add_u32 v23, 20480, v23
 v_cmp_gt_u32 vcc, 2, v3
 s_mov_b32 s52, 0
 s_mov_b32 s89, 0x05040100
 v_cndmask_b32 v26, 0, 1.0, vcc
 v_mov_b32 v124, 0
 v_mov_b32 v125, 0
 v_mov_b32 v144, 0
 v_mov_b32 v145, 0
 v_mov_b32 v40, 0
 v_mov_b32 v41, 0
 v_mov_b32 v42, 0
 v_mov_b32 v43, 0
 v_mov_b32 v44, 0
 v_mov_b32 v45, 0
 v_mov_b32 v46, 0
 v_mov_b32 v47, 0
 v_mov_b32 v48, 0
 v_mov_b32 v49, 0
 v_mov_b32 v50, 0
 v_mov_b32 v51, 0
 v_mov_b32 v52, 0
 v_mov_b32 v53, 0
 v_mov_b32 v54, 0
 v_mov_b32 v55, 0
 v_mov_b32 v56, 0
 v_mov_b32 v57, 0
 v_mov_b32 v58, 0
 v_mov_b32 v59, 0
 v_mov_b32 v60, 0
 v_mov_b32 v61, 0
 v_mov_b32 v62, 0
 v_mov_b32 v63, 0
 v_mov_b32 v100, 0
 v_mov_b32 v101, 0
 v_mov_b32 v102, 0
 v_mov_b32 v103, 0
 v_mov_b32 v104, 0
 v_mov_b32 v105, 0
 v_mov_b32 v106, 0
 v_mov_b32 v107, 0
 v_mov_b32 v108, 0
 v_mov_b32 v109, 0
 v_mov_b32 v110, 0
 v_mov_b32 v111, 0
 s_barrier
 s_mov_b32 s57, 0x80000000
 s_and_b32 s21, s52, 3
 s_mul_i32 s81, s21, 540672
 s_lshl_b32 s84, s21, 15
 s_add_u32 s21, s52, 3
 s_and_b32 s21, s21, 3
 s_lshl_b32 s83, s21, 15
 s_add_u32 s21, s52, 1
 s_and_b32 s22, s21, 3
 s_lshl_b32 s3, s22, 15
 s_mul_i32 s80, s21, 393216
 s_add_u32 s46, s21, 1
 s_min_u32 s46, s46, 64
 s_mov_b32 s47, s57
 s_lshl_b32 s21, s52, 12
 s_and_b32 s21, s21, 8192
 s_xor_b32 s21, s21, s37
 s_lshl_b32 s22, s52, 20
 s_or_b32 s22, s22, s21
 s_cmp_ge_u32 s52, 36
 s_cselect_b32 s57, 8192, 0
 s_xor_b32 s57, s57, s22
 s_xor_b32 s85, s22, 8192
 s_bfe_u32 s88, s52, 0x10002
 s_max_u32 s67, s52, 1
 s_sub_u32 s67, s67, 1
 s_cmp_eq_u32 s53, 0
 s_cbranch_scc1 A1_17
 s_cmp_eq_u32 s20, 0
 s_cbranch_scc1 A1_13
 s_cmp_eq_u32 s20, 1
 s_cbranch_scc1 A1_14
 s_cmp_eq_u32 s20, 2
 s_cbranch_scc1 A1_15
 s_cmp_eq_u32 s20, 3
 s_cbranch_scc1 A1_16
 s_branch A1_17
step_18:
 s_and_b32 s21, s52, 3
 s_mul_i32 s81, s21, 540672
 s_lshl_b32 s84, s21, 15
 s_add_u32 s21, s52, 3
 s_and_b32 s21, s21, 3
 s_lshl_b32 s83, s21, 15
 s_add_u32 s21, s52, 1
 s_and_b32 s22, s21, 3
 s_lshl_b32 s3, s22, 15
 s_mul_i32 s80, s21, 393216
 s_add_u32 s46, s21, 1
 s_min_u32 s46, s46, 64
 s_mov_b32 s47, s57
 s_lshl_b32 s21, s52, 12
 s_and_b32 s21, s21, 8192
 s_xor_b32 s21, s21, s37
 s_lshl_b32 s22, s52, 20
 s_or_b32 s22, s22, s21
 s_cmp_ge_u32 s52, 36
 s_cselect_b32 s57, 8192, 0
 s_xor_b32 s57, s57, s22
 s_xor_b32 s85, s22, 8192
 s_bfe_u32 s88, s52, 0x10002
 s_max_u32 s67, s52, 1
 s_sub_u32 s67, s67, 1
 v_mov_b32 v40, 0
 v_mov_b32 v41, 0
 v_mov_b32 v42, 0
 v_mov_b32 v43, 0
 v_mov_b32 v44, 0
 v_mov_b32 v45, 0
 v_mov_b32 v46, 0
 v_mov_b32 v47, 0
 v_mov_b32 v48, 0
 v_mov_b32 v49, 0
 v_mov_b32 v50, 0
 v_mov_b32 v51, 0
 v_mov_b32 v52, 0
 v_mov_b32 v53, 0
 v_mov_b32 v54, 0
 v_mov_b32 v55, 0
 v_mov_b32 v56, 0
 v_mov_b32 v57, 0
 v_mov_b32 v58, 0
 v_mov_b32 v59, 0
 v_mov_b32 v60, 0
 v_mov_b32 v61, 0
 v_mov_b32 v62, 0
 v_mov_b32 v63, 0
 v_mov_b32 v100, 0
 v_mov_b32 v101, 0
 v_mov_b32 v102, 0
 v_mov_b32 v103, 0
 v_mov_b32 v104, 0
 v_mov_b32 v105, 0
 v_mov_b32 v106, 0
 v_mov_b32 v107, 0
 v_mov_b32 v108, 0
 v_mov_b32 v109, 0
 v_mov_b32 v110, 0
 v_mov_b32 v111, 0
 s_sleep 5
 v_readfirstlane_b32 s21, v0
 s_cmp_lt_u32 s21, s46
 s_cselect_b32 s55, s55, 0
 s_cmp_lt_i32 s55, 0
 s_cbranch_scc1 fl_23
fl_24:
 s_mov_b32 s54, 0
 buffer_load_dwordx4 v[36:39], v4, s[4:7], s84 offen offset:2048 sc1
 buffer_load_dwordx4 v[28:31], v4, s[4:7], s84 offen offset:0 sc1
 buffer_load_dwordx4 v[32:35], v4, s[4:7], s84 offen offset:1024 sc1
 s_waitcnt vmcnt(3)
 v_mov_b32 v126, v88
 v_mov_b32 v127, v89
 v_mov_b32 v128, v90
 v_mov_b32 v129, v91
 v_mov_b32 v130, v92
 v_mov_b32 v131, v93
 v_mov_b32 v132, v94
 v_mov_b32 v133, v95
 v_mov_b32 v134, v96
 v_mov_b32 v135, v97
 v_mov_b32 v136, v98
 v_mov_b32 v137, v99
 s_waitcnt vmcnt(2)
 v_smfmac_f32_16x16x32_f16 v[40:43], v[36:37], a[16:19], v25
 v_smfmac_f32_16x16x32_f16 v[52:55], v[36:37], a[76:79], v25
 v_smfmac_f32_16x16x32_f16 v[44:47], v[36:37], a[36:39], v25
 s_waitcnt vmcnt(0)
 v_bitop3_b32 v27, v31, v35, v39 bitop3:0x80
 v_perm_b32 v31, v35, v31, s89
 v_cmp_gt_u32 vcc, 0x48000000, v27
 v_mov_b32 v35, v38
 v_smfmac_f32_16x16x32_f16 v[56:59], v[36:37], a[96:99], v25
 s_cbranch_vccnz pm_21
A2_22:
 v_smfmac_f32_16x16x64_f16 v[40:43], v[28:31], a[0:7], v25
 ds_write_b128 v10, v[28:31]
 v_smfmac_f32_16x16x64_f16 v[40:43], v[32:35], a[8:15], v25
 ds_write_b128 v10, v[32:35] offset:1024
 v_smfmac_f32_16x16x64_f16 v[52:55], v[28:31], a[60:67], v25
 ds_write_b64 v10, v[36:37] offset:2048
 v_smfmac_f32_16x16x64_f16 v[52:55], v[32:35], a[68:75], v25
 v_cvt_pk_f16_f32 v40, v40, v41
 v_cvt_pk_f16_f32 v41, v42, v43
 v_smfmac_f32_16x16x32_f16 v[48:51], v[36:37], a[56:59], v25
 v_smfmac_f32_16x16x32_f16 v[60:63], v[36:37], a[116:119], v25
 v_smfmac_f32_16x16x64_f16 v[44:47], v[28:31], a[20:27], v25
 v_cvt_pk_f16_f32 v52, v52, v53
 v_cvt_pk_f16_f32 v53, v54, v55
 s_nop 0
 v_smfmac_f32_16x16x64_f16 v[44:47], v[32:35], a[28:35], v25
 v_permlane32_swap_b32 v40, v52
 v_smfmac_f32_16x16x64_f16 v[56:59], v[28:31], a[80:87], v25
 v_permlane32_swap_b32 v41, v53
 v_pk_add_f16 v40, v40, v52
 v_smfmac_f32_16x16x64_f16 v[56:59], v[32:35], a[88:95], v25
 v_pk_add_f16 v41, v41, v53
 v_smfmac_f32_16x16x64_f16 v[48:51], v[28:31], a[40:47], v25
 ds_write_b64 v5, v[40:41] offset:0
 v_smfmac_f32_16x16x64_f16 v[48:51], v[32:35], a[48:55], v25
 v_cvt_pk_f16_f32 v44, v44, v45
 v_cvt_pk_f16_f32 v45, v46, v47
 v_cvt_pk_f16_f32 v56, v56, v57
 v_smfmac_f32_16x16x64_f16 v[60:63], v[28:31], a[100:107], v25
 v_cvt_pk_f16_f32 v57, v58, v59
 s_nop 0
 v_smfmac_f32_16x16x64_f16 v[60:63], v[32:35], a[108:115], v25
 v_permlane32_swap_b32 v44, v56
 v_permlane32_swap_b32 v45, v57
 v_pk_add_f16 v44, v44, v56
 v_pk_add_f16 v45, v45, v57
 ds_write_b64 v5, v[44:45] offset:640
 v_cvt_pk_f16_f32 v48, v48, v49
 v_cvt_pk_f16_f32 v49, v50, v51
 v_cvt_pk_f16_f32 v60, v60, v61
 v_cvt_pk_f16_f32 v61, v62, v63
 s_nop 0
 v_permlane32_swap_b32 v48, v60
 v_permlane32_swap_b32 v49, v61
 v_pk_add_f16 v48, v48, v60
 v_pk_add_f16 v49, v49, v61
 ds_write_b64 v5, v[48:49] offset:1280
 s_waitcnt lgkmcnt(0) vmcnt(0)
 s_barrier
 ds_read_b64_tr_b16 v[40:41], v21 offset:0
 ds_read_b64_tr_b16 v[42:43], v21 offset:1920
 ds_read_b64_tr_b16 v[44:45], v21 offset:640
 ds_read_b64_tr_b16 v[46:47], v21 offset:2560
 ds_read_b64_tr_b16 v[48:49], v21 offset:1280
 ds_read_b64_tr_b16 v[50:51], v21 offset:3200
 s_waitcnt lgkmcnt(4)
 v_fma_mix_f32 v52, v40, 1.0, v42 op_sel:[0,0,0] op_sel_hi:[1,0,1]
 v_fma_mix_f32 v53, v40, 1.0, v42 op_sel:[1,0,1] op_sel_hi:[1,0,1]
 v_fma_mix_f32 v54, v41, 1.0, v43 op_sel:[0,0,0] op_sel_hi:[1,0,1]
 v_fma_mix_f32 v55, v41, 1.0, v43 op_sel:[1,0,1] op_sel_hi:[1,0,1]
 v_add_f32_dpp v56, v52, v52 row_ror:8 row_mask:0xf bank_mask:0xf
 v_add_f32_dpp v57, v53, v53 row_ror:8 row_mask:0xf bank_mask:0xf
 v_add_f32_dpp v58, v54, v54 row_ror:8 row_mask:0xf bank_mask:0xf
 v_add_f32_dpp v59, v55, v55 row_ror:8 row_mask:0xf bank_mask:0xf
 v_cvt_pk_bf16_f32 v118, v56, v57
 v_cvt_pk_bf16_f32 v119, v58, v59
 s_waitcnt lgkmcnt(2)
 v_fma_mix_f32 v52, v44, 1.0, v46 op_sel:[0,0,0] op_sel_hi:[1,0,1]
 v_fma_mix_f32 v53, v44, 1.0, v46 op_sel:[1,0,1] op_sel_hi:[1,0,1]
 v_fma_mix_f32 v54, v45, 1.0, v47 op_sel:[0,0,0] op_sel_hi:[1,0,1]
 v_fma_mix_f32 v55, v45, 1.0, v47 op_sel:[1,0,1] op_sel_hi:[1,0,1]
 v_add_f32_dpp v56, v52, v52 row_ror:8 row_mask:0xf bank_mask:0xf
 v_add_f32_dpp v57, v53, v53 row_ror:8 row_mask:0xf bank_mask:0xf
 v_add_f32_dpp v58, v54, v54 row_ror:8 row_mask:0xf bank_mask:0xf
 v_add_f32_dpp v59, v55, v55 row_ror:8 row_mask:0xf bank_mask:0xf
 v_cvt_pk_bf16_f32 v120, v56, v57
 v_cvt_pk_bf16_f32 v121, v58, v59
 s_waitcnt lgkmcnt(0)
 v_fma_mix_f32 v52, v48, 1.0, v50 op_sel:[0,0,0] op_sel_hi:[1,0,1]
 v_fma_mix_f32 v53, v48, 1.0, v50 op_sel:[1,0,1] op_sel_hi:[1,0,1]
 v_fma_mix_f32 v54, v49, 1.0, v51 op_sel:[0,0,0] op_sel_hi:[1,0,1]
 v_fma_mix_f32 v55, v49, 1.0, v51 op_sel:[1,0,1] op_sel_hi:[1,0,1]
 v_mfma_f32_16x16x32_bf16 v[40:43], v[112:115], v[118:121], 0
 v_add_f32_dpp v56, v52, v52 row_ror:8 row_mask:0xf bank_mask:0xf
 v_add_f32_dpp v57, v53, v53 row_ror:8 row_mask:0xf bank_mask:0xf
 v_add_f32_dpp v58, v54, v54 row_ror:8 row_mask:0xf bank_mask:0xf
 v_add_f32_dpp v59, v55, v55 row_ror:8 row_mask:0xf bank_mask:0xf
 v_cvt_pk_bf16_f32 v122, v56, v57
 v_cvt_pk_bf16_f32 v123, v58, v59
 s_nop 1
 v_mfma_f32_16x16x32_bf16 v[40:43], v[116:119], v[122:125], v[40:43]
 ds_read_b128 v[28:31], v16 offset:24576
 ds_read_b128 v[32:35], v16 offset:25600
 ds_read_b128 v[64:67], v16 offset:27648
 ds_read_b128 v[68:71], v16 offset:28672
 ds_read_b128 v[72:75], v16 offset:30720
 ds_read_b128 v[76:79], v16 offset:31744
 s_nop 0
 s_mov_b64 exec, s[74:75]
 v_cvt_pk_f16_f32 v44, v40, v41
 v_cvt_pk_f16_f32 v45, v42, v43
 v_and_or_b32 v44, v44, -2, s88
 buffer_store_dwordx2 v[44:45], v7, s[8:11], s81 offen
 s_mov_b64 exec, -1
 ds_read_b128 v[80:83], v16 offset:33792
 ds_read_b128 v[84:87], v16 offset:34816
 ds_read_b64 v[88:89], v16 offset:26624
 ds_read_b64 v[90:91], v16 offset:29696
 ds_read_b64 v[92:93], v16 offset:32768
 ds_read_b64 v[94:95], v16 offset:35840
 s_cmp_eq_u32 s52, 63
 s_cbranch_scc1 last_19
 s_waitcnt lgkmcnt(10)
 v_smfmac_f32_16x16x64_f16 v[100:103], v[28:31], a[120:127], v25
 v_smfmac_f32_16x16x64_f16 v[104:107], v[28:31], a[128:135], v25
 v_smfmac_f32_16x16x64_f16 v[108:111], v[28:31], a[136:143], v25
 s_mov_b32 s54, 0
 v_smfmac_f32_16x16x64_f16 v[100:103], v[32:35], a[144:151], v25
 v_readfirstlane_b32 s21, v0
 v_smfmac_f32_16x16x64_f16 v[104:107], v[32:35], a[152:159], v25
 s_add_u32 s22, s46, 3
 v_smfmac_f32_16x16x64_f16 v[108:111], v[32:35], a[160:167], v25
 s_min_u32 s22, s22, 64
 s_waitcnt lgkmcnt(7)
 v_smfmac_f32_16x16x64_f16 v[100:103], v[64:67], a[168:175], v25
 s_sub_u32 s55, s21, s22
 v_smfmac_f32_16x16x64_f16 v[104:107], v[64:67], a[176:183], v25
 s_sub_u32 s56, s21, s46
 v_smfmac_f32_16x16x64_f16 v[108:111], v[64:67], a[184:191], v25
 v_smfmac_f32_16x16x64_f16 v[100:103], v[68:71], a[192:199], v25
 v_smfmac_f32_16x16x64_f16 v[104:107], v[68:71], a[200:207], v25
 v_smfmac_f32_16x16x64_f16 v[108:111], v[68:71], a[208:215], v25
 v_smfmac_f32_16x16x64_f16 v[100:103], v[72:75], a[216:223], v25
 v_smfmac_f32_16x16x64_f16 v[104:107], v[72:75], a[224:231], v25
 v_smfmac_f32_16x16x64_f16 v[108:111], v[72:75], a[232:239], v25
 s_waitcnt lgkmcnt(4)
 v_smfmac_f32_16x16x64_f16 v[100:103], v[76:79], a[240:247], v25
 v_smfmac_f32_16x16x64_f16 v[104:107], v[76:79], a[248:255], v25
 v_smfmac_f32_16x16x64_f16 v[108:111], v[76:79], v[152:159], v25
 v_smfmac_f32_16x16x64_f16 v[100:103], v[80:83], v[160:167], v25
 v_smfmac_f32_16x16x64_f16 v[104:107], v[80:83], v[168:175], v25
 buffer_load_dwordx2 v[58:59], v9, s[8:11], s81 offen sc1
 buffer_load_dwordx4 v[40:43], v8, s[8:11], s81 offen offset:0 sc1
 buffer_load_dwordx4 v[44:47], v8, s[8:11], s81 offen offset:1024 sc1
 v_smfmac_f32_16x16x64_f16 v[108:111], v[80:83], v[176:183], v25
 v_smfmac_f32_16x16x64_f16 v[100:103], v[84:87], v[184:191], v25
 v_smfmac_f32_16x16x64_f16 v[104:107], v[84:87], v[192:199], v25
 v_smfmac_f32_16x16x64_f16 v[108:111], v[84:87], v[200:207], v25
 s_waitcnt lgkmcnt(0)
 v_smfmac_f32_16x16x64_f16 v[100:103], v[88:91], v[208:215], v25
 v_smfmac_f32_16x16x64_f16 v[104:107], v[88:91], v[216:223], v25
 v_smfmac_f32_16x16x64_f16 v[108:111], v[88:91], v[224:231], v25
 v_smfmac_f32_16x16x64_f16 v[100:103], v[92:95], v[232:239], v25
 v_smfmac_f32_16x16x64_f16 v[104:107], v[92:95], v[240:247], v25
 v_smfmac_f32_16x16x64_f16 v[108:111], v[92:95], v[248:255], v25
 s_cmp_lt_i32 s56, 0
 s_cbranch_scc1 kvw_27
kvok_28:
 s_waitcnt vmcnt(2)
 v_xor_b32 v76, s88, v58
 s_nop 0
 v_permlane16_swap_b32 v58, v59
 v_fma_mix_f32 v60, v58, 1.0, v59 op_sel:[0,0,0] op_sel_hi:[1,0,1]
 v_fma_mix_f32 v61, v58, 1.0, v59 op_sel:[1,0,1] op_sel_hi:[1,0,1]
 v_mov_b32 v58, v60
 v_mov_b32 v59, v61
 s_nop 0
 v_permlane32_swap_b32 v58, v60
 v_permlane32_swap_b32 v59, v61
 v_add_f32 v52, v58, v60
 v_add_f32 v53, v59, v61
 v_max_f32 v79, v52, v53
 s_waitcnt vmcnt(0)
 v_pk_add_f16 v80, v40, v44
 v_pk_add_f16 v82, v42, v46
 v_pk_add_f16 v81, v41, v45
 v_pk_add_f16 v83, v43, v47
 v_permlane32_swap_b32 v80, v82
 v_bitop3_b32 v77, v40, v42, s88 bitop3:0x7e
 v_permlane32_swap_b32 v81, v83
 v_bitop3_b32 v78, v44, v46, s88 bitop3:0x7e
 v_fma_mix_f32 v48, v80, 1.0, v82 op_sel:[0,0,0] op_sel_hi:[1,0,1]
 v_or3_b32 v27, v76, v77, v78
 v_fma_mix_f32 v49, v80, 1.0, v82 op_sel:[1,0,1] op_sel_hi:[1,0,1]
 v_and_b32 v27, 1, v27
 v_fma_mix_f32 v50, v81, 1.0, v83 op_sel:[0,0,0] op_sel_hi:[1,0,1]
 v_cmp_ne_u32 vcc, 0, v27
 v_fma_mix_f32 v51, v81, 1.0, v83 op_sel:[1,0,1] op_sel_hi:[1,0,1]
 v_max3_f32 v62, v48, v49, v79
 s_cbranch_vccnz psr_25
psj_26:
 v_max3_f32 v62, v62, v50, v51
 v_cvt_pk_bf16_f32 v146, v100, v101
 v_cvt_pk_bf16_f32 v147, v102, v103
 v_max_f32_dpp v62, v62, v62 row_ror:8 row_mask:0xf bank_mask:0xf
 v_mov_b32 v63, v62
 v_cvt_pk_bf16_f32 v148, v104, v105
 v_cvt_pk_bf16_f32 v149, v106, v107
 v_permlane32_swap_b32 v62, v63
 v_max_f32 v62, v62, v63
 v_mov_b32 v63, v62
 v_cvt_pk_bf16_f32 v150, v108, v109
 v_cvt_pk_bf16_f32 v151, v110, v111
 v_permlane16_swap_b32 v62, v63
 v_max_f32 v62, v62, v63
 v_mul_f32 v62, s86, v62
 v_fma_f32 v48, v48, s86, -v62
 v_fma_f32 v49, v49, s86, -v62
 v_fma_f32 v50, v50, s86, -v62
 v_fma_f32 v51, v51, s86, -v62
 v_fma_f32 v52, v52, s86, -v62
 v_fma_f32 v53, v53, s86, -v62
 v_exp_f32 v48, v48
 v_exp_f32 v49, v49
 buffer_load_dwordx4 v[88:91], v17, s[28:31], s64 offen offset:0 sc1
 v_exp_f32 v50, v50
 v_exp_f32 v51, v51
 buffer_load_dwordx4 v[92:95], v16, s[28:31], s64 offen offset:1024 sc1
 v_exp_f32 v52, v52
 v_exp_f32 v53, v53
 buffer_load_dwordx4 v[96:99], v20, s[28:31], s64 offen offset:2048 sc1
 v_cvt_pk_bf16_f32 v138, v48, v49
 v_cvt_pk_bf16_f32 v139, v50, v51
 v_cvt_pk_bf16_f32 v142, v52, v53
 v_mov_b32_dpp v140, v138 row_ror:8 row_mask:0xf bank_mask:0xf
 v_mov_b32_dpp v141, v139 row_ror:8 row_mask:0xf bank_mask:0xf
 v_mov_b32_dpp v143, v142 row_ror:8 row_mask:0xf bank_mask:0xf
 buffer_load_dwordx4 v[112:115], v18, s[16:19], s80 offen sc1
 v_add_f32 v54, v48, v49
 v_mfma_f32_16x16x32_bf16 v[64:67], v[126:129], v[138:141], 0
 v_add_f32 v55, v50, v51
 v_add_f32 v56, v52, v53
 v_mfma_f32_16x16x32_bf16 v[64:67], v[146:149], v[142:145], v[64:67]
 v_add_f32 v62, v54, v55
 v_fmac_f32 v62, v56, v26
 v_mfma_f32_16x16x32_bf16 v[68:71], v[130:133], v[138:141], 0
 buffer_load_dwordx2 v[116:117], v19, s[16:19], s80 offen sc1
 v_add_f32_dpp v62, v62, v62 row_ror:8 row_mask:0xf bank_mask:0xf
 v_mfma_f32_16x16x32_bf16 v[68:71], v[148:151], v[142:145], v[68:71]
 v_mov_b32 v63, v62
 s_cmp_lt_i32 s55, 0
 s_cbranch_scc1 fl_29
fl_30:
 v_mfma_f32_16x16x32_bf16 v[72:75], v[134:137], v[138:141], 0
 v_permlane32_swap_b32 v62, v63
 v_mfma_f32_16x16x32_bf16 v[72:75], v[150:153], v[142:145], v[72:75]
 v_add_f32 v62, v62, v63
 v_mov_b32 v63, v62
 ds_write_b128 v11, v[64:67] offset:0
 s_nop 0
 v_permlane16_swap_b32 v62, v63
 v_add_f32 v62, v62, v63
 v_rcp_f32 v62, v62
 ds_write_b128 v11, v[68:71] offset:1024
 s_mov_b64 exec, 0xff
 ds_write_b32 v22, v62
 s_mov_b64 exec, -1
 ds_write_b128 v11, v[72:75] offset:2048
 s_waitcnt lgkmcnt(0)
 s_barrier
 ds_read_b128 v[72:75], v23
 ds_read_b64 v[64:65], v12 offset:0
 ds_read_b64 v[66:67], v12 offset:3072
 ds_read_b64 v[68:69], v12 offset:6144
 ds_read_b64 v[70:71], v12 offset:9216
 s_waitcnt lgkmcnt(2)
 v_pk_mul_f32 v[64:65], v[64:65], v[72:73] op_sel_hi:[1,0]
 v_pk_fma_f32 v[64:65], v[66:67], v[72:73], v[64:65] op_sel:[0,1,0] op_sel_hi:[1,1,1]
 s_waitcnt lgkmcnt(0)
 v_pk_fma_f32 v[64:65], v[68:69], v[74:75], v[64:65] op_sel_hi:[1,0,1]
 v_pk_fma_f32 v[64:65], v[70:71], v[74:75], v[64:65] op_sel:[0,1,0] op_sel_hi:[1,1,1]
 v_cvt_pk_f16_f32 v68, v64, v65
 v_perm_b32 v68, s91, v68, v14
 buffer_atomic_pk_add_f16 v68, v13, s[4:7], s3 offen
 v_mov_b32 v76, v108
 v_mov_b32 v77, v109
 v_mov_b32 v78, v110
 v_mov_b32 v79, v111
 v_permlane32_swap_b32 v100, v104
 v_permlane32_swap_b32 v101, v105
 v_permlane32_swap_b32 v102, v106
 v_permlane32_swap_b32 v103, v107
 v_permlane32_swap_b32 v108, v76
 v_permlane32_swap_b32 v109, v77
 v_permlane32_swap_b32 v110, v78
 v_permlane32_swap_b32 v111, v79
 v_pk_add_f32 v[100:101], v[100:101], v[104:105]
 v_pk_add_f32 v[102:103], v[102:103], v[106:107]
 v_pk_add_f32 v[108:109], v[108:109], v[76:77]
 v_pk_add_f32 v[110:111], v[110:111], v[78:79]
 v_cvt_pk_bf16_f32 v80, v100, v101
 v_cvt_pk_bf16_f32 v82, v108, v109
 v_cvt_pk_bf16_f32 v81, v102, v103
 v_cvt_pk_bf16_f32 v83, v110, v111
 s_nop 0
 v_permlane16_swap_b32 v80, v82
 v_permlane16_swap_b32 v81, v83
 v_min_u32 v80, -2, v80
 s_mov_b64 exec, s[76:77]
 buffer_store_dwordx4 v[80:83], v15, s[24:27], s57 offen sc1
 s_mov_b64 exec, -1
 s_add_u32 s64, s64, 1310720
 s_add_u32 s52, s52, 1
 s_branch step_18
fl_23:
 buffer_load_dword v0, off, s[12:15], s79 sc1
 s_branch fl_24
A1_13:
 v_smfmac_f32_16x16x32_f16 v[40:43], v[36:37], a[16:19], v25
 v_smfmac_f32_16x16x32_f16 v[52:55], v[36:37], a[76:79], v25
 v_smfmac_f32_16x16x32_f16 v[44:47], v[36:37], a[36:39], v25
 v_smfmac_f32_16x16x32_f16 v[56:59], v[36:37], a[96:99], v25
 s_branch A2_22
pm_21:
 buffer_load_dwordx4 v[36:39], v4, s[4:7], s84 offen offset:2048 sc1
 buffer_load_dwordx4 v[28:31], v4, s[4:7], s84 offen offset:0 sc1
 buffer_load_dwordx4 v[32:35], v4, s[4:7], s84 offen offset:1024 sc1
 s_nop 7
 v_mov_b32 v40, 0
 v_mov_b32 v41, 0
 v_mov_b32 v42, 0
 v_mov_b32 v43, 0
 v_mov_b32 v52, 0
 v_mov_b32 v53, 0
 v_mov_b32 v54, 0
 v_mov_b32 v55, 0
 v_mov_b32 v44, 0
 v_mov_b32 v45, 0
 v_mov_b32 v46, 0
 v_mov_b32 v47, 0
 v_mov_b32 v56, 0
 v_mov_b32 v57, 0
 v_mov_b32 v58, 0
 v_mov_b32 v59, 0
 s_waitcnt vmcnt(0)
 v_bitop3_b32 v27, v31, v35, v39 bitop3:0x80
 v_perm_b32 v31, v35, v31, s89
 v_cmp_gt_u32 vcc, 0x48000000, v27
 v_mov_b32 v35, v38
 s_cbranch_vccz A1_13
pm_20:
 s_cmp_gt_u32 s52, 3
 s_cbranch_scc1 op_31
 v_readfirstlane_b32 s21, v0
 s_cmp_ge_u32 s21, s46
 s_cbranch_scc1 op_31
 buffer_load_dword v0, off, s[12:15], s79 sc1
 s_waitcnt vmcnt(0)
 v_readfirstlane_b32 s21, v0
 s_cmp_gt_u32 s21, s52
 s_cselect_b32 s21, s87, 0
 s_cmp_eq_u32 s21, 0
 s_cbranch_scc1 op_31
 s_mov_b32 s87, 0
 s_sub_u32 s21, s64, 1310720
 buffer_load_dwordx4 v[126:129], v16, s[28:31], s21 offen offset:0 sc1
 buffer_load_dwordx4 v[130:133], v16, s[28:31], s21 offen offset:1024 sc1
 buffer_load_dwordx4 v[134:137], v16, s[28:31], s21 offen offset:2048 sc1
op_31:
 buffer_load_dwordx4 v[36:39], v4, s[4:7], s84 offen offset:2048 sc1
 buffer_load_dwordx4 v[28:31], v4, s[4:7], s84 offen offset:0 sc1
 buffer_load_dwordx4 v[32:35], v4, s[4:7], s84 offen offset:1024 sc1
 s_add_u32 s54, s54, 1
 s_cmp_gt_u32 s54, 131072
 s_cbranch_scc1 end0
 s_waitcnt vmcnt(0)
 v_bitop3_b32 v27, v31, v35, v39 bitop3:0x80
 v_perm_b32 v31, v35, v31, s89
 v_cmp_gt_u32 vcc, 0x48000000, v27
 v_mov_b32 v35, v38
 s_cbranch_vccnz pm_20
 s_branch A1_13
psr_25:
 buffer_load_dwordx2 v[58:59], v9, s[8:11], s81 offen sc1
 buffer_load_dwordx4 v[40:43], v8, s[8:11], s81 offen offset:0 sc1
 buffer_load_dwordx4 v[44:47], v8, s[8:11], s81 offen offset:1024 sc1
 s_add_u32 s54, s54, 1
 s_cmp_gt_u32 s54, 131072
 s_cbranch_scc1 end0
 s_waitcnt vmcnt(2)
 v_xor_b32 v76, s88, v58
 s_nop 0
 v_permlane16_swap_b32 v58, v59
 v_fma_mix_f32 v60, v58, 1.0, v59 op_sel:[0,0,0] op_sel_hi:[1,0,1]
 v_fma_mix_f32 v61, v58, 1.0, v59 op_sel:[1,0,1] op_sel_hi:[1,0,1]
 v_mov_b32 v58, v60
 v_mov_b32 v59, v61
 s_nop 0
 v_permlane32_swap_b32 v58, v60
 v_permlane32_swap_b32 v59, v61
 v_add_f32 v52, v58, v60
 v_add_f32 v53, v59, v61
 v_max_f32 v79, v52, v53
 s_waitcnt vmcnt(0)
 v_pk_add_f16 v80, v40, v44
 v_pk_add_f16 v82, v42, v46
 v_pk_add_f16 v81, v41, v45
 v_pk_add_f16 v83, v43, v47
 v_permlane32_swap_b32 v80, v82
 v_bitop3_b32 v77, v40, v42, s88 bitop3:0x7e
 v_permlane32_swap_b32 v81, v83
 v_bitop3_b32 v78, v44, v46, s88 bitop3:0x7e
 v_fma_mix_f32 v48, v80, 1.0, v82 op_sel:[0,0,0] op_sel_hi:[1,0,1]
 v_or3_b32 v27, v76, v77, v78
 v_fma_mix_f32 v49, v80, 1.0, v82 op_sel:[1,0,1] op_sel_hi:[1,0,1]
 v_and_b32 v27, 1, v27
 v_fma_mix_f32 v50, v81, 1.0, v83 op_sel:[0,0,0] op_sel_hi:[1,0,1]
 v_cmp_ne_u32 vcc, 0, v27
 v_fma_mix_f32 v51, v81, 1.0, v83 op_sel:[1,0,1] op_sel_hi:[1,0,1]
 v_max3_f32 v62, v48, v49, v79
 s_cbranch_vccnz psr_25
 s_branch psj_26
kvw_27:
 s_mov_b32 s22, s87
 s_cmp_eq_u32 s52, 0
 s_cselect_b32 s55, 0, s55
 s_cselect_b32 s87, 1, 0
 s_cbranch_scc1 kvok_28
 v_mov_b32 v62, 0
 s_mov_b32 s101, 0
wf_32:
 buffer_load_dword v63, v62, s[12:15], s79 offen sc1
 s_add_u32 s101, s101, 1
 s_cmp_gt_u32 s101, 131072
 s_cbranch_scc1 end0
 s_waitcnt vmcnt(0)
 v_readfirstlane_b32 s100, v63
 s_cmp_ge_u32 s100, s46
 s_cbranch_scc1 wf_33
 s_sleep 3
 s_branch wf_32
wf_33:
 s_cmp_eq_u32 s22, 0
 s_cbranch_scc1 kvok_28
 s_sub_u32 s21, s64, 1310720
 buffer_load_dwordx4 v[126:129], v16, s[28:31], s21 offen offset:0 sc1
 buffer_load_dwordx4 v[130:133], v16, s[28:31], s21 offen offset:1024 sc1
 buffer_load_dwordx4 v[134:137], v16, s[28:31], s21 offen offset:2048 sc1
 s_waitcnt vmcnt(0)
 s_branch kvok_28
fl_29:
 buffer_load_dword v0, off, s[12:15], s79 sc1
 s_branch fl_30
last_19:
 s_waitcnt lgkmcnt(10)
 v_smfmac_f32_16x16x64_f16 v[100:103], v[28:31], a[120:127], v25
 v_smfmac_f32_16x16x64_f16 v[104:107], v[28:31], a[128:135], v25
 v_smfmac_f32_16x16x64_f16 v[108:111], v[28:31], a[136:143], v25
 v_smfmac_f32_16x16x64_f16 v[100:103], v[32:35], a[144:151], v25
 v_smfmac_f32_16x16x64_f16 v[104:107], v[32:35], a[152:159], v25
 v_smfmac_f32_16x16x64_f16 v[108:111], v[32:35], a[160:167], v25
 s_waitcnt lgkmcnt(7)
 v_smfmac_f32_16x16x64_f16 v[100:103], v[64:67], a[168:175], v25
 v_smfmac_f32_16x16x64_f16 v[104:107], v[64:67], a[176:183], v25
 v_smfmac_f32_16x16x64_f16 v[108:111], v[64:67], a[184:191], v25
 v_smfmac_f32_16x16x64_f16 v[100:103], v[68:71], a[192:199], v25
 v_smfmac_f32_16x16x64_f16 v[104:107], v[68:71], a[200:207], v25
 v_smfmac_f32_16x16x64_f16 v[108:111], v[68:71], a[208:215], v25
 v_smfmac_f32_16x16x64_f16 v[100:103], v[72:75], a[216:223], v25
 v_smfmac_f32_16x16x64_f16 v[104:107], v[72:75], a[224:231], v25
 v_smfmac_f32_16x16x64_f16 v[108:111], v[72:75], a[232:239], v25
 s_waitcnt lgkmcnt(4)
 v_smfmac_f32_16x16x64_f16 v[100:103], v[76:79], a[240:247], v25
 v_smfmac_f32_16x16x64_f16 v[104:107], v[76:79], a[248:255], v25
 v_smfmac_f32_16x16x64_f16 v[108:111], v[76:79], v[152:159], v25
 v_smfmac_f32_16x16x64_f16 v[100:103], v[80:83], v[160:167], v25
 v_smfmac_f32_16x16x64_f16 v[104:107], v[80:83], v[168:175], v25
 v_smfmac_f32_16x16x64_f16 v[108:111], v[80:83], v[176:183], v25
 v_smfmac_f32_16x16x64_f16 v[100:103], v[84:87], v[184:191], v25
 v_smfmac_f32_16x16x64_f16 v[104:107], v[84:87], v[192:199], v25
 v_smfmac_f32_16x16x64_f16 v[108:111], v[84:87], v[200:207], v25
 s_waitcnt lgkmcnt(0)
 v_smfmac_f32_16x16x64_f16 v[100:103], v[88:91], v[208:215], v25
 v_smfmac_f32_16x16x64_f16 v[104:107], v[88:91], v[216:223], v25
 v_smfmac_f32_16x16x64_f16 v[108:111], v[88:91], v[224:231], v25
 v_smfmac_f32_16x16x64_f16 v[100:103], v[92:95], v[232:239], v25
 v_smfmac_f32_16x16x64_f16 v[104:107], v[92:95], v[240:247], v25
 v_smfmac_f32_16x16x64_f16 v[108:111], v[92:95], v[248:255], v25
 s_nop 7
 v_mov_b32 v76, v108
 v_mov_b32 v77, v109
 v_mov_b32 v78, v110
 v_mov_b32 v79, v111
 v_permlane32_swap_b32 v100, v104
 v_permlane32_swap_b32 v101, v105
 v_permlane32_swap_b32 v102, v106
 v_permlane32_swap_b32 v103, v107
 v_permlane32_swap_b32 v108, v76
 v_permlane32_swap_b32 v109, v77
 v_permlane32_swap_b32 v110, v78
 v_permlane32_swap_b32 v111, v79
 v_pk_add_f32 v[100:101], v[100:101], v[104:105]
 v_pk_add_f32 v[102:103], v[102:103], v[106:107]
 v_pk_add_f32 v[108:109], v[108:109], v[76:77]
 v_pk_add_f32 v[110:111], v[110:111], v[78:79]
 v_cvt_pk_bf16_f32 v80, v100, v101
 v_cvt_pk_bf16_f32 v82, v108, v109
 v_cvt_pk_bf16_f32 v81, v102, v103
 v_cvt_pk_bf16_f32 v83, v110, v111
 s_nop 0
 v_permlane16_swap_b32 v80, v82
 v_permlane16_swap_b32 v81, v83
 v_min_u32 v80, -2, v80
 s_mov_b64 exec, s[76:77]
 buffer_store_dwordx4 v[80:83], v15, s[24:27], s57 offen sc1
 s_mov_b64 exec, -1
 v_mov_b32 v246, 80
 v_mov_b32 v247, 1
 s_mov_b64 exec, 1
 buffer_atomic_add v247, v246, s[32:35], 0 offen sc0 sc1
 s_mov_b64 exec, -1
 s_branch chain_done
step_34:
 s_and_b32 s21, s52, 3
 s_mul_i32 s81, s21, 540672
 s_lshl_b32 s84, s21, 15
 s_add_u32 s21, s52, 3
 s_and_b32 s21, s21, 3
 s_lshl_b32 s83, s21, 15
 s_add_u32 s21, s52, 1
 s_and_b32 s22, s21, 3
 s_lshl_b32 s3, s22, 15
 s_mul_i32 s80, s21, 393216
 s_add_u32 s46, s21, 1
 s_min_u32 s46, s46, 64
 s_mov_b32 s47, s57
 s_lshl_b32 s21, s52, 12
 s_and_b32 s21, s21, 8192
 s_xor_b32 s21, s21, s37
 s_lshl_b32 s22, s52, 20
 s_or_b32 s22, s22, s21
 s_cmp_ge_u32 s52, 36
 s_cselect_b32 s57, 8192, 0
 s_xor_b32 s57, s57, s22
 s_xor_b32 s85, s22, 8192
 s_bfe_u32 s88, s52, 0x10002
 s_max_u32 s67, s52, 1
 s_sub_u32 s67, s67, 1
 v_mov_b32 v40, 0
 v_mov_b32 v41, 0
 v_mov_b32 v42, 0
 v_mov_b32 v43, 0
 v_mov_b32 v44, 0
 v_mov_b32 v45, 0
 v_mov_b32 v46, 0
 v_mov_b32 v47, 0
 v_mov_b32 v48, 0
 v_mov_b32 v49, 0
 v_mov_b32 v50, 0
 v_mov_b32 v51, 0
 v_mov_b32 v52, 0
 v_mov_b32 v53, 0
 v_mov_b32 v54, 0
 v_mov_b32 v55, 0
 v_mov_b32 v56, 0
 v_mov_b32 v57, 0
 v_mov_b32 v58, 0
 v_mov_b32 v59, 0
 v_mov_b32 v60, 0
 v_mov_b32 v61, 0
 v_mov_b32 v62, 0
 v_mov_b32 v63, 0
 v_mov_b32 v100, 0
 v_mov_b32 v101, 0
 v_mov_b32 v102, 0
 v_mov_b32 v103, 0
 v_mov_b32 v104, 0
 v_mov_b32 v105, 0
 v_mov_b32 v106, 0
 v_mov_b32 v107, 0
 v_mov_b32 v108, 0
 v_mov_b32 v109, 0
 v_mov_b32 v110, 0
 v_mov_b32 v111, 0
 s_sleep 5
 v_readfirstlane_b32 s21, v0
 s_cmp_lt_u32 s21, s46
 s_cselect_b32 s55, s55, 0
 s_cmp_lt_i32 s55, 0
 s_cbranch_scc1 fl_39
fl_40:
 s_mov_b32 s54, 0
 buffer_load_dwordx4 v[36:39], v4, s[4:7], s84 offen offset:2048 sc1
 buffer_load_dwordx4 v[28:31], v4, s[4:7], s84 offen offset:0 sc1
 buffer_load_dwordx4 v[32:35], v4, s[4:7], s84 offen offset:1024 sc1
 s_waitcnt vmcnt(3)
 v_mov_b32 v126, v88
 v_mov_b32 v127, v89
 v_mov_b32 v128, v90
 v_mov_b32 v129, v91
 v_mov_b32 v130, v92
 v_mov_b32 v131, v93
 v_mov_b32 v132, v94
 v_mov_b32 v133, v95
 v_mov_b32 v134, v96
 v_mov_b32 v135, v97
 v_mov_b32 v136, v98
 v_mov_b32 v137, v99
 s_waitcnt vmcnt(2)
 v_smfmac_f32_16x16x32_f16 v[40:43], v[36:37], a[16:19], v25
 v_smfmac_f32_16x16x32_f16 v[52:55], v[36:37], a[76:79], v25
 v_smfmac_f32_16x16x32_f16 v[44:47], v[36:37], a[36:39], v25
 s_waitcnt vmcnt(0)
 v_bitop3_b32 v27, v31, v35, v39 bitop3:0x80
 v_perm_b32 v31, v35, v31, s89
 v_cmp_gt_u32 vcc, 0x48000000, v27
 v_mov_b32 v35, v38
 v_smfmac_f32_16x16x32_f16 v[56:59], v[36:37], a[96:99], v25
 s_cbranch_vccnz pm_37
A2_38:
 v_smfmac_f32_16x16x64_f16 v[40:43], v[28:31], a[0:7], v25
 ds_write_b128 v10, v[28:31]
 v_smfmac_f32_16x16x64_f16 v[40:43], v[32:35], a[8:15], v25
 ds_write_b128 v10, v[32:35] offset:1024
 v_smfmac_f32_16x16x64_f16 v[52:55], v[28:31], a[60:67], v25
 ds_write_b64 v10, v[36:37] offset:2048
 v_smfmac_f32_16x16x64_f16 v[52:55], v[32:35], a[68:75], v25
 v_cvt_pk_f16_f32 v40, v40, v41
 v_cvt_pk_f16_f32 v41, v42, v43
 v_smfmac_f32_16x16x32_f16 v[48:51], v[36:37], a[56:59], v25
 v_smfmac_f32_16x16x32_f16 v[60:63], v[36:37], a[116:119], v25
 v_smfmac_f32_16x16x64_f16 v[44:47], v[28:31], a[20:27], v25
 v_cvt_pk_f16_f32 v52, v52, v53
 v_cvt_pk_f16_f32 v53, v54, v55
 s_nop 0
 v_smfmac_f32_16x16x64_f16 v[44:47], v[32:35], a[28:35], v25
 v_permlane32_swap_b32 v40, v52
 v_smfmac_f32_16x16x64_f16 v[56:59], v[28:31], a[80:87], v25
 v_permlane32_swap_b32 v41, v53
 v_pk_add_f16 v40, v40, v52
 v_smfmac_f32_16x16x64_f16 v[56:59], v[32:35], a[88:95], v25
 v_pk_add_f16 v41, v41, v53
 v_smfmac_f32_16x16x64_f16 v[48:51], v[28:31], a[40:47], v25
 ds_write_b64 v5, v[40:41] offset:0
 v_smfmac_f32_16x16x64_f16 v[48:51], v[32:35], a[48:55], v25
 v_cvt_pk_f16_f32 v44, v44, v45
 v_cvt_pk_f16_f32 v45, v46, v47
 v_cvt_pk_f16_f32 v56, v56, v57
 v_smfmac_f32_16x16x64_f16 v[60:63], v[28:31], a[100:107], v25
 v_cvt_pk_f16_f32 v57, v58, v59
 s_nop 0
 v_smfmac_f32_16x16x64_f16 v[60:63], v[32:35], a[108:115], v25
 v_permlane32_swap_b32 v44, v56
 v_permlane32_swap_b32 v45, v57
 v_pk_add_f16 v44, v44, v56
 v_pk_add_f16 v45, v45, v57
 ds_write_b64 v5, v[44:45] offset:640
 v_cvt_pk_f16_f32 v48, v48, v49
 v_cvt_pk_f16_f32 v49, v50, v51
 v_cvt_pk_f16_f32 v60, v60, v61
 v_cvt_pk_f16_f32 v61, v62, v63
 s_nop 0
 v_permlane32_swap_b32 v48, v60
 v_permlane32_swap_b32 v49, v61
 v_pk_add_f16 v48, v48, v60
 v_pk_add_f16 v49, v49, v61
 ds_write_b64 v5, v[48:49] offset:1280
 s_waitcnt lgkmcnt(0) vmcnt(0)
 s_barrier
 ds_read_b64_tr_b16 v[40:41], v21 offset:0
 ds_read_b64_tr_b16 v[42:43], v21 offset:1920
 ds_read_b64_tr_b16 v[44:45], v21 offset:640
 ds_read_b64_tr_b16 v[46:47], v21 offset:2560
 ds_read_b64_tr_b16 v[48:49], v21 offset:1280
 ds_read_b64_tr_b16 v[50:51], v21 offset:3200
 s_waitcnt lgkmcnt(4)
 v_fma_mix_f32 v52, v40, 1.0, v42 op_sel:[0,0,0] op_sel_hi:[1,0,1]
 v_fma_mix_f32 v53, v40, 1.0, v42 op_sel:[1,0,1] op_sel_hi:[1,0,1]
 v_fma_mix_f32 v54, v41, 1.0, v43 op_sel:[0,0,0] op_sel_hi:[1,0,1]
 v_fma_mix_f32 v55, v41, 1.0, v43 op_sel:[1,0,1] op_sel_hi:[1,0,1]
 v_add_f32_dpp v56, v52, v52 row_ror:8 row_mask:0xf bank_mask:0xf
 v_add_f32_dpp v57, v53, v53 row_ror:8 row_mask:0xf bank_mask:0xf
 v_add_f32_dpp v58, v54, v54 row_ror:8 row_mask:0xf bank_mask:0xf
 v_add_f32_dpp v59, v55, v55 row_ror:8 row_mask:0xf bank_mask:0xf
 v_cvt_pk_bf16_f32 v118, v56, v57
 v_cvt_pk_bf16_f32 v119, v58, v59
 s_waitcnt lgkmcnt(2)
 v_fma_mix_f32 v52, v44, 1.0, v46 op_sel:[0,0,0] op_sel_hi:[1,0,1]
 v_fma_mix_f32 v53, v44, 1.0, v46 op_sel:[1,0,1] op_sel_hi:[1,0,1]
 v_fma_mix_f32 v54, v45, 1.0, v47 op_sel:[0,0,0] op_sel_hi:[1,0,1]
 v_fma_mix_f32 v55, v45, 1.0, v47 op_sel:[1,0,1] op_sel_hi:[1,0,1]
 v_add_f32_dpp v56, v52, v52 row_ror:8 row_mask:0xf bank_mask:0xf
 v_add_f32_dpp v57, v53, v53 row_ror:8 row_mask:0xf bank_mask:0xf
 v_add_f32_dpp v58, v54, v54 row_ror:8 row_mask:0xf bank_mask:0xf
 v_add_f32_dpp v59, v55, v55 row_ror:8 row_mask:0xf bank_mask:0xf
 v_cvt_pk_bf16_f32 v120, v56, v57
 v_cvt_pk_bf16_f32 v121, v58, v59
 s_waitcnt lgkmcnt(0)
 v_fma_mix_f32 v52, v48, 1.0, v50 op_sel:[0,0,0] op_sel_hi:[1,0,1]
 v_fma_mix_f32 v53, v48, 1.0, v50 op_sel:[1,0,1] op_sel_hi:[1,0,1]
 v_fma_mix_f32 v54, v49, 1.0, v51 op_sel:[0,0,0] op_sel_hi:[1,0,1]
 v_fma_mix_f32 v55, v49, 1.0, v51 op_sel:[1,0,1] op_sel_hi:[1,0,1]
 v_mfma_f32_16x16x32_bf16 v[40:43], v[112:115], v[118:121], 0
 v_add_f32_dpp v56, v52, v52 row_ror:8 row_mask:0xf bank_mask:0xf
 v_add_f32_dpp v57, v53, v53 row_ror:8 row_mask:0xf bank_mask:0xf
 v_add_f32_dpp v58, v54, v54 row_ror:8 row_mask:0xf bank_mask:0xf
 v_add_f32_dpp v59, v55, v55 row_ror:8 row_mask:0xf bank_mask:0xf
 v_cvt_pk_bf16_f32 v122, v56, v57
 v_cvt_pk_bf16_f32 v123, v58, v59
 s_nop 1
 v_mfma_f32_16x16x32_bf16 v[40:43], v[116:119], v[122:125], v[40:43]
 ds_read_b128 v[28:31], v16 offset:24576
 ds_read_b128 v[32:35], v16 offset:25600
 ds_read_b128 v[64:67], v16 offset:27648
 ds_read_b128 v[68:71], v16 offset:28672
 ds_read_b128 v[72:75], v16 offset:30720
 ds_read_b128 v[76:79], v16 offset:31744
 s_nop 0
 s_mov_b64 exec, s[74:75]
 v_cvt_pk_f16_f32 v44, v40, v41
 v_cvt_pk_f16_f32 v45, v42, v43
 v_and_or_b32 v44, v44, -2, s88
 buffer_store_dwordx2 v[44:45], v7, s[8:11], s81 offen
 s_mov_b64 exec, -1
 ds_read_b128 v[80:83], v16 offset:33792
 ds_read_b128 v[84:87], v16 offset:34816
 ds_read_b64 v[88:89], v16 offset:26624
 ds_read_b64 v[90:91], v16 offset:29696
 ds_read_b64 v[92:93], v16 offset:32768
 ds_read_b64 v[94:95], v16 offset:35840
 s_cmp_eq_u32 s52, 63
 s_cbranch_scc1 last_35
 s_waitcnt lgkmcnt(10)
 v_smfmac_f32_16x16x64_f16 v[100:103], v[28:31], a[120:127], v25
 v_smfmac_f32_16x16x64_f16 v[104:107], v[28:31], a[128:135], v25
 v_smfmac_f32_16x16x64_f16 v[108:111], v[28:31], a[136:143], v25
 s_mov_b32 s54, 0
 v_smfmac_f32_16x16x64_f16 v[100:103], v[32:35], a[144:151], v25
 v_readfirstlane_b32 s21, v0
 v_smfmac_f32_16x16x64_f16 v[104:107], v[32:35], a[152:159], v25
 s_add_u32 s22, s46, 3
 v_smfmac_f32_16x16x64_f16 v[108:111], v[32:35], a[160:167], v25
 s_min_u32 s22, s22, 64
 s_waitcnt lgkmcnt(7)
 v_smfmac_f32_16x16x64_f16 v[100:103], v[64:67], a[168:175], v25
 s_sub_u32 s55, s21, s22
 v_smfmac_f32_16x16x64_f16 v[104:107], v[64:67], a[176:183], v25
 s_sub_u32 s56, s21, s46
 v_smfmac_f32_16x16x64_f16 v[108:111], v[64:67], a[184:191], v25
 v_smfmac_f32_16x16x64_f16 v[100:103], v[68:71], a[192:199], v25
 v_smfmac_f32_16x16x64_f16 v[104:107], v[68:71], a[200:207], v25
 v_smfmac_f32_16x16x64_f16 v[108:111], v[68:71], a[208:215], v25
 v_smfmac_f32_16x16x64_f16 v[100:103], v[72:75], a[216:223], v25
 v_smfmac_f32_16x16x64_f16 v[104:107], v[72:75], a[224:231], v25
 v_smfmac_f32_16x16x64_f16 v[108:111], v[72:75], a[232:239], v25
 s_waitcnt lgkmcnt(4)
 v_smfmac_f32_16x16x64_f16 v[100:103], v[76:79], a[240:247], v25
 v_smfmac_f32_16x16x64_f16 v[104:107], v[76:79], a[248:255], v25
 v_smfmac_f32_16x16x64_f16 v[108:111], v[76:79], v[152:159], v25
 v_smfmac_f32_16x16x64_f16 v[100:103], v[80:83], v[160:167], v25
 v_smfmac_f32_16x16x64_f16 v[104:107], v[80:83], v[168:175], v25
 buffer_load_dwordx2 v[58:59], v9, s[8:11], s81 offen sc1
 buffer_load_dwordx4 v[40:43], v8, s[8:11], s81 offen offset:0 sc1
 buffer_load_dwordx4 v[44:47], v8, s[8:11], s81 offen offset:1024 sc1
 v_smfmac_f32_16x16x64_f16 v[108:111], v[80:83], v[176:183], v25
 v_smfmac_f32_16x16x64_f16 v[100:103], v[84:87], v[184:191], v25
 v_smfmac_f32_16x16x64_f16 v[104:107], v[84:87], v[192:199], v25
 v_smfmac_f32_16x16x64_f16 v[108:111], v[84:87], v[200:207], v25
 s_waitcnt lgkmcnt(0)
 v_smfmac_f32_16x16x64_f16 v[100:103], v[88:91], v[208:215], v25
 v_smfmac_f32_16x16x64_f16 v[104:107], v[88:91], v[216:223], v25
 v_smfmac_f32_16x16x64_f16 v[108:111], v[88:91], v[224:231], v25
 v_smfmac_f32_16x16x64_f16 v[100:103], v[92:95], v[232:239], v25
 v_smfmac_f32_16x16x64_f16 v[104:107], v[92:95], v[240:247], v25
 v_smfmac_f32_16x16x64_f16 v[108:111], v[92:95], v[248:255], v25
 s_cmp_lt_i32 s56, 0
 s_cbranch_scc1 kvw_43
kvok_44:
 s_waitcnt vmcnt(2)
 v_xor_b32 v76, s88, v58
 s_nop 0
 v_permlane16_swap_b32 v58, v59
 v_fma_mix_f32 v60, v58, 1.0, v59 op_sel:[0,0,0] op_sel_hi:[1,0,1]
 v_fma_mix_f32 v61, v58, 1.0, v59 op_sel:[1,0,1] op_sel_hi:[1,0,1]
 v_mov_b32 v58, v60
 v_mov_b32 v59, v61
 s_nop 0
 v_permlane32_swap_b32 v58, v60
 v_permlane32_swap_b32 v59, v61
 v_add_f32 v52, v58, v60
 v_add_f32 v53, v59, v61
 v_max_f32 v79, v52, v53
 s_waitcnt vmcnt(0)
 v_pk_add_f16 v80, v40, v44
 v_pk_add_f16 v82, v42, v46
 v_pk_add_f16 v81, v41, v45
 v_pk_add_f16 v83, v43, v47
 v_permlane32_swap_b32 v80, v82
 v_bitop3_b32 v77, v40, v42, s88 bitop3:0x7e
 v_permlane32_swap_b32 v81, v83
 v_bitop3_b32 v78, v44, v46, s88 bitop3:0x7e
 v_fma_mix_f32 v48, v80, 1.0, v82 op_sel:[0,0,0] op_sel_hi:[1,0,1]
 v_or3_b32 v27, v76, v77, v78
 v_fma_mix_f32 v49, v80, 1.0, v82 op_sel:[1,0,1] op_sel_hi:[1,0,1]
 v_and_b32 v27, 1, v27
 v_fma_mix_f32 v50, v81, 1.0, v83 op_sel:[0,0,0] op_sel_hi:[1,0,1]
 v_cmp_ne_u32 vcc, 0, v27
 v_fma_mix_f32 v51, v81, 1.0, v83 op_sel:[1,0,1] op_sel_hi:[1,0,1]
 v_max3_f32 v62, v48, v49, v79
 s_cbranch_vccnz psr_41
psj_42:
 v_max3_f32 v62, v62, v50, v51
 v_cvt_pk_bf16_f32 v146, v100, v101
 v_cvt_pk_bf16_f32 v147, v102, v103
 v_max_f32_dpp v62, v62, v62 row_ror:8 row_mask:0xf bank_mask:0xf
 v_mov_b32 v63, v62
 v_cvt_pk_bf16_f32 v148, v104, v105
 v_cvt_pk_bf16_f32 v149, v106, v107
 v_permlane32_swap_b32 v62, v63
 v_max_f32 v62, v62, v63
 v_mov_b32 v63, v62
 v_cvt_pk_bf16_f32 v150, v108, v109
 v_cvt_pk_bf16_f32 v151, v110, v111
 v_permlane16_swap_b32 v62, v63
 v_max_f32 v62, v62, v63
 v_mul_f32 v62, s86, v62
 v_fma_f32 v48, v48, s86, -v62
 v_fma_f32 v49, v49, s86, -v62
 v_fma_f32 v50, v50, s86, -v62
 v_fma_f32 v51, v51, s86, -v62
 v_fma_f32 v52, v52, s86, -v62
 v_fma_f32 v53, v53, s86, -v62
 v_exp_f32 v48, v48
 v_exp_f32 v49, v49
 buffer_load_dwordx4 v[88:91], v17, s[28:31], s64 offen offset:0 sc1
 v_exp_f32 v50, v50
 v_exp_f32 v51, v51
 buffer_load_dwordx4 v[92:95], v16, s[28:31], s64 offen offset:1024 sc1
 v_exp_f32 v52, v52
 v_exp_f32 v53, v53
 buffer_load_dwordx4 v[96:99], v20, s[28:31], s64 offen offset:2048 sc1
 v_cvt_pk_bf16_f32 v138, v48, v49
 v_cvt_pk_bf16_f32 v139, v50, v51
 v_cvt_pk_bf16_f32 v142, v52, v53
 v_mov_b32_dpp v140, v138 row_ror:8 row_mask:0xf bank_mask:0xf
 v_mov_b32_dpp v141, v139 row_ror:8 row_mask:0xf bank_mask:0xf
 v_mov_b32_dpp v143, v142 row_ror:8 row_mask:0xf bank_mask:0xf
 buffer_load_dwordx4 v[112:115], v18, s[16:19], s80 offen sc1
 v_add_f32 v54, v48, v49
 v_mfma_f32_16x16x32_bf16 v[64:67], v[126:129], v[138:141], 0
 v_add_f32 v55, v50, v51
 v_add_f32 v56, v52, v53
 v_mfma_f32_16x16x32_bf16 v[64:67], v[146:149], v[142:145], v[64:67]
 v_add_f32 v62, v54, v55
 v_fmac_f32 v62, v56, v26
 v_mfma_f32_16x16x32_bf16 v[68:71], v[130:133], v[138:141], 0
 buffer_load_dwordx2 v[116:117], v19, s[16:19], s80 offen sc1
 v_add_f32_dpp v62, v62, v62 row_ror:8 row_mask:0xf bank_mask:0xf
 v_mfma_f32_16x16x32_bf16 v[68:71], v[148:151], v[142:145], v[68:71]
 v_mov_b32 v63, v62
 s_cmp_lt_i32 s55, 0
 s_cbranch_scc1 fl_45
fl_46:
 v_mfma_f32_16x16x32_bf16 v[72:75], v[134:137], v[138:141], 0
 v_permlane32_swap_b32 v62, v63
 v_mfma_f32_16x16x32_bf16 v[72:75], v[150:153], v[142:145], v[72:75]
 v_add_f32 v62, v62, v63
 v_mov_b32 v63, v62
 ds_write_b128 v11, v[64:67] offset:0
 s_nop 0
 v_permlane16_swap_b32 v62, v63
 v_add_f32 v62, v62, v63
 v_rcp_f32 v62, v62
 ds_write_b128 v11, v[68:71] offset:1024
 s_mov_b64 exec, 0xff
 ds_write_b32 v22, v62
 s_mov_b64 exec, -1
 ds_write_b128 v11, v[72:75] offset:2048
 s_waitcnt lgkmcnt(0)
 s_barrier
 ds_read_b128 v[72:75], v23
 ds_read_b64 v[64:65], v12 offset:0
 ds_read_b64 v[66:67], v12 offset:3072
 ds_read_b64 v[68:69], v12 offset:6144
 ds_read_b64 v[70:71], v12 offset:9216
 s_waitcnt lgkmcnt(2)
 v_pk_mul_f32 v[64:65], v[64:65], v[72:73] op_sel_hi:[1,0]
 v_pk_fma_f32 v[64:65], v[66:67], v[72:73], v[64:65] op_sel:[0,1,0] op_sel_hi:[1,1,1]
 s_waitcnt lgkmcnt(0)
 v_pk_fma_f32 v[64:65], v[68:69], v[74:75], v[64:65] op_sel_hi:[1,0,1]
 v_pk_fma_f32 v[64:65], v[70:71], v[74:75], v[64:65] op_sel:[0,1,0] op_sel_hi:[1,1,1]
 v_cvt_pk_f16_f32 v68, v64, v65
 v_perm_b32 v68, s91, v68, v14
 buffer_atomic_pk_add_f16 v68, v13, s[4:7], s3 offen
 v_mov_b32 v76, v108
 v_mov_b32 v77, v109
 v_mov_b32 v78, v110
 v_mov_b32 v79, v111
 v_permlane32_swap_b32 v100, v104
 v_permlane32_swap_b32 v101, v105
 v_permlane32_swap_b32 v102, v106
 v_permlane32_swap_b32 v103, v107
 v_permlane32_swap_b32 v108, v76
 v_permlane32_swap_b32 v109, v77
 v_permlane32_swap_b32 v110, v78
 v_permlane32_swap_b32 v111, v79
 v_pk_add_f32 v[100:101], v[100:101], v[104:105]
 v_pk_add_f32 v[102:103], v[102:103], v[106:107]
 v_pk_add_f32 v[108:109], v[108:109], v[76:77]
 v_pk_add_f32 v[110:111], v[110:111], v[78:79]
 v_cvt_pk_bf16_f32 v80, v100, v101
 v_cvt_pk_bf16_f32 v82, v108, v109
 v_cvt_pk_bf16_f32 v81, v102, v103
 v_cvt_pk_bf16_f32 v83, v110, v111
 s_nop 0
 v_permlane16_swap_b32 v80, v82
 v_permlane16_swap_b32 v81, v83
 v_min_u32 v80, -2, v80
 s_mov_b64 exec, s[76:77]
 buffer_store_dwordx4 v[80:83], v15, s[24:27], s57 offen sc1
 s_mov_b64 exec, -1
 s_add_u32 s64, s64, 1310720
 s_add_u32 s52, s52, 1
 s_branch step_34
fl_39:
 buffer_load_dword v0, off, s[12:15], s79 sc1
 s_branch fl_40
A1_14:
 v_smfmac_f32_16x16x32_f16 v[40:43], v[36:37], a[16:19], v25
 v_smfmac_f32_16x16x32_f16 v[52:55], v[36:37], a[76:79], v25
 v_smfmac_f32_16x16x32_f16 v[44:47], v[36:37], a[36:39], v25
 v_smfmac_f32_16x16x32_f16 v[56:59], v[36:37], a[96:99], v25
 s_branch A2_38
pm_37:
 buffer_load_dwordx4 v[36:39], v4, s[4:7], s84 offen offset:2048 sc1
 buffer_load_dwordx4 v[28:31], v4, s[4:7], s84 offen offset:0 sc1
 buffer_load_dwordx4 v[32:35], v4, s[4:7], s84 offen offset:1024 sc1
 s_nop 7
 v_mov_b32 v40, 0
 v_mov_b32 v41, 0
 v_mov_b32 v42, 0
 v_mov_b32 v43, 0
 v_mov_b32 v52, 0
 v_mov_b32 v53, 0
 v_mov_b32 v54, 0
 v_mov_b32 v55, 0
 v_mov_b32 v44, 0
 v_mov_b32 v45, 0
 v_mov_b32 v46, 0
 v_mov_b32 v47, 0
 v_mov_b32 v56, 0
 v_mov_b32 v57, 0
 v_mov_b32 v58, 0
 v_mov_b32 v59, 0
 s_waitcnt vmcnt(0)
 v_bitop3_b32 v27, v31, v35, v39 bitop3:0x80
 v_perm_b32 v31, v35, v31, s89
 v_cmp_gt_u32 vcc, 0x48000000, v27
 v_mov_b32 v35, v38
 s_cbranch_vccz A1_14
pm_36:
 s_cmp_gt_u32 s52, 3
 s_cbranch_scc1 op_47
 v_readfirstlane_b32 s21, v0
 s_cmp_ge_u32 s21, s46
 s_cbranch_scc1 op_47
 buffer_load_dword v0, off, s[12:15], s79 sc1
 s_waitcnt vmcnt(0)
 v_readfirstlane_b32 s21, v0
 s_cmp_gt_u32 s21, s52
 s_cselect_b32 s21, s87, 0
 s_cmp_eq_u32 s21, 0
 s_cbranch_scc1 op_47
 s_mov_b32 s87, 0
 s_sub_u32 s21, s64, 1310720
 buffer_load_dwordx4 v[126:129], v16, s[28:31], s21 offen offset:0 sc1
 buffer_load_dwordx4 v[130:133], v16, s[28:31], s21 offen offset:1024 sc1
 buffer_load_dwordx4 v[134:137], v16, s[28:31], s21 offen offset:2048 sc1
op_47:
 buffer_load_dwordx4 v[36:39], v4, s[4:7], s84 offen offset:2048 sc1
 buffer_load_dwordx4 v[28:31], v4, s[4:7], s84 offen offset:0 sc1
 buffer_load_dwordx4 v[32:35], v4, s[4:7], s84 offen offset:1024 sc1
 s_add_u32 s54, s54, 1
 s_cmp_gt_u32 s54, 131072
 s_cbranch_scc1 end0
 s_waitcnt vmcnt(0)
 v_bitop3_b32 v27, v31, v35, v39 bitop3:0x80
 v_perm_b32 v31, v35, v31, s89
 v_cmp_gt_u32 vcc, 0x48000000, v27
 v_mov_b32 v35, v38
 s_cbranch_vccnz pm_36
 s_branch A1_14
psr_41:
 buffer_load_dwordx2 v[58:59], v9, s[8:11], s81 offen sc1
 buffer_load_dwordx4 v[40:43], v8, s[8:11], s81 offen offset:0 sc1
 buffer_load_dwordx4 v[44:47], v8, s[8:11], s81 offen offset:1024 sc1
 s_add_u32 s54, s54, 1
 s_cmp_gt_u32 s54, 131072
 s_cbranch_scc1 end0
 s_waitcnt vmcnt(2)
 v_xor_b32 v76, s88, v58
 s_nop 0
 v_permlane16_swap_b32 v58, v59
 v_fma_mix_f32 v60, v58, 1.0, v59 op_sel:[0,0,0] op_sel_hi:[1,0,1]
 v_fma_mix_f32 v61, v58, 1.0, v59 op_sel:[1,0,1] op_sel_hi:[1,0,1]
 v_mov_b32 v58, v60
 v_mov_b32 v59, v61
 s_nop 0
 v_permlane32_swap_b32 v58, v60
 v_permlane32_swap_b32 v59, v61
 v_add_f32 v52, v58, v60
 v_add_f32 v53, v59, v61
 v_max_f32 v79, v52, v53
 s_waitcnt vmcnt(0)
 v_pk_add_f16 v80, v40, v44
 v_pk_add_f16 v82, v42, v46
 v_pk_add_f16 v81, v41, v45
 v_pk_add_f16 v83, v43, v47
 v_permlane32_swap_b32 v80, v82
 v_bitop3_b32 v77, v40, v42, s88 bitop3:0x7e
 v_permlane32_swap_b32 v81, v83
 v_bitop3_b32 v78, v44, v46, s88 bitop3:0x7e
 v_fma_mix_f32 v48, v80, 1.0, v82 op_sel:[0,0,0] op_sel_hi:[1,0,1]
 v_or3_b32 v27, v76, v77, v78
 v_fma_mix_f32 v49, v80, 1.0, v82 op_sel:[1,0,1] op_sel_hi:[1,0,1]
 v_and_b32 v27, 1, v27
 v_fma_mix_f32 v50, v81, 1.0, v83 op_sel:[0,0,0] op_sel_hi:[1,0,1]
 v_cmp_ne_u32 vcc, 0, v27
 v_fma_mix_f32 v51, v81, 1.0, v83 op_sel:[1,0,1] op_sel_hi:[1,0,1]
 v_max3_f32 v62, v48, v49, v79
 s_cbranch_vccnz psr_41
 s_branch psj_42
kvw_43:
 s_mov_b32 s22, s87
 s_cmp_eq_u32 s52, 0
 s_cselect_b32 s55, 0, s55
 s_cselect_b32 s87, 1, 0
 s_cbranch_scc1 kvok_44
 v_mov_b32 v62, 0
 s_mov_b32 s101, 0
wf_48:
 buffer_load_dword v63, v62, s[12:15], s79 offen sc1
 s_add_u32 s101, s101, 1
 s_cmp_gt_u32 s101, 131072
 s_cbranch_scc1 end0
 s_waitcnt vmcnt(0)
 v_readfirstlane_b32 s100, v63
 s_cmp_ge_u32 s100, s46
 s_cbranch_scc1 wf_49
 s_sleep 3
 s_branch wf_48
wf_49:
 s_cmp_eq_u32 s22, 0
 s_cbranch_scc1 kvok_44
 s_sub_u32 s21, s64, 1310720
 buffer_load_dwordx4 v[126:129], v16, s[28:31], s21 offen offset:0 sc1
 buffer_load_dwordx4 v[130:133], v16, s[28:31], s21 offen offset:1024 sc1
 buffer_load_dwordx4 v[134:137], v16, s[28:31], s21 offen offset:2048 sc1
 s_waitcnt vmcnt(0)
 s_branch kvok_44
fl_45:
 buffer_load_dword v0, off, s[12:15], s79 sc1
 s_branch fl_46
last_35:
 s_waitcnt lgkmcnt(10)
 v_smfmac_f32_16x16x64_f16 v[100:103], v[28:31], a[120:127], v25
 v_smfmac_f32_16x16x64_f16 v[104:107], v[28:31], a[128:135], v25
 v_smfmac_f32_16x16x64_f16 v[108:111], v[28:31], a[136:143], v25
 v_smfmac_f32_16x16x64_f16 v[100:103], v[32:35], a[144:151], v25
 v_smfmac_f32_16x16x64_f16 v[104:107], v[32:35], a[152:159], v25
 v_smfmac_f32_16x16x64_f16 v[108:111], v[32:35], a[160:167], v25
 s_waitcnt lgkmcnt(7)
 v_smfmac_f32_16x16x64_f16 v[100:103], v[64:67], a[168:175], v25
 v_smfmac_f32_16x16x64_f16 v[104:107], v[64:67], a[176:183], v25
 v_smfmac_f32_16x16x64_f16 v[108:111], v[64:67], a[184:191], v25
 v_smfmac_f32_16x16x64_f16 v[100:103], v[68:71], a[192:199], v25
 v_smfmac_f32_16x16x64_f16 v[104:107], v[68:71], a[200:207], v25
 v_smfmac_f32_16x16x64_f16 v[108:111], v[68:71], a[208:215], v25
 v_smfmac_f32_16x16x64_f16 v[100:103], v[72:75], a[216:223], v25
 v_smfmac_f32_16x16x64_f16 v[104:107], v[72:75], a[224:231], v25
 v_smfmac_f32_16x16x64_f16 v[108:111], v[72:75], a[232:239], v25
 s_waitcnt lgkmcnt(4)
 v_smfmac_f32_16x16x64_f16 v[100:103], v[76:79], a[240:247], v25
 v_smfmac_f32_16x16x64_f16 v[104:107], v[76:79], a[248:255], v25
 v_smfmac_f32_16x16x64_f16 v[108:111], v[76:79], v[152:159], v25
 v_smfmac_f32_16x16x64_f16 v[100:103], v[80:83], v[160:167], v25
 v_smfmac_f32_16x16x64_f16 v[104:107], v[80:83], v[168:175], v25
 v_smfmac_f32_16x16x64_f16 v[108:111], v[80:83], v[176:183], v25
 v_smfmac_f32_16x16x64_f16 v[100:103], v[84:87], v[184:191], v25
 v_smfmac_f32_16x16x64_f16 v[104:107], v[84:87], v[192:199], v25
 v_smfmac_f32_16x16x64_f16 v[108:111], v[84:87], v[200:207], v25
 s_waitcnt lgkmcnt(0)
 v_smfmac_f32_16x16x64_f16 v[100:103], v[88:91], v[208:215], v25
 v_smfmac_f32_16x16x64_f16 v[104:107], v[88:91], v[216:223], v25
 v_smfmac_f32_16x16x64_f16 v[108:111], v[88:91], v[224:231], v25
 v_smfmac_f32_16x16x64_f16 v[100:103], v[92:95], v[232:239], v25
 v_smfmac_f32_16x16x64_f16 v[104:107], v[92:95], v[240:247], v25
 v_smfmac_f32_16x16x64_f16 v[108:111], v[92:95], v[248:255], v25
 s_nop 7
 v_mov_b32 v76, v108
 v_mov_b32 v77, v109
 v_mov_b32 v78, v110
 v_mov_b32 v79, v111
 v_permlane32_swap_b32 v100, v104
 v_permlane32_swap_b32 v101, v105
 v_permlane32_swap_b32 v102, v106
 v_permlane32_swap_b32 v103, v107
 v_permlane32_swap_b32 v108, v76
 v_permlane32_swap_b32 v109, v77
 v_permlane32_swap_b32 v110, v78
 v_permlane32_swap_b32 v111, v79
 v_pk_add_f32 v[100:101], v[100:101], v[104:105]
 v_pk_add_f32 v[102:103], v[102:103], v[106:107]
 v_pk_add_f32 v[108:109], v[108:109], v[76:77]
 v_pk_add_f32 v[110:111], v[110:111], v[78:79]
 v_cvt_pk_bf16_f32 v80, v100, v101
 v_cvt_pk_bf16_f32 v82, v108, v109
 v_cvt_pk_bf16_f32 v81, v102, v103
 v_cvt_pk_bf16_f32 v83, v110, v111
 s_nop 0
 v_permlane16_swap_b32 v80, v82
 v_permlane16_swap_b32 v81, v83
 v_min_u32 v80, -2, v80
 s_mov_b64 exec, s[76:77]
 buffer_store_dwordx4 v[80:83], v15, s[24:27], s57 offen sc1
 s_mov_b64 exec, -1
 s_branch chain_done
step_50:
 s_and_b32 s21, s52, 3
 s_mul_i32 s81, s21, 540672
 s_lshl_b32 s84, s21, 15
 s_add_u32 s21, s52, 3
 s_and_b32 s21, s21, 3
 s_lshl_b32 s83, s21, 15
 s_add_u32 s21, s52, 1
 s_and_b32 s22, s21, 3
 s_lshl_b32 s3, s22, 15
 s_mul_i32 s80, s21, 393216
 s_add_u32 s46, s21, 1
 s_min_u32 s46, s46, 64
 s_mov_b32 s47, s57
 s_lshl_b32 s21, s52, 12
 s_and_b32 s21, s21, 8192
 s_xor_b32 s21, s21, s37
 s_lshl_b32 s22, s52, 20
 s_or_b32 s22, s22, s21
 s_cmp_ge_u32 s52, 36
 s_cselect_b32 s57, 8192, 0
 s_xor_b32 s57, s57, s22
 s_xor_b32 s85, s22, 8192
 s_bfe_u32 s88, s52, 0x10002
 s_max_u32 s67, s52, 1
 s_sub_u32 s67, s67, 1
 v_mov_b32 v40, 0
 v_mov_b32 v41, 0
 v_mov_b32 v42, 0
 v_mov_b32 v43, 0
 v_mov_b32 v44, 0
 v_mov_b32 v45, 0
 v_mov_b32 v46, 0
 v_mov_b32 v47, 0
 v_mov_b32 v48, 0
 v_mov_b32 v49, 0
 v_mov_b32 v50, 0
 v_mov_b32 v51, 0
 v_mov_b32 v52, 0
 v_mov_b32 v53, 0
 v_mov_b32 v54, 0
 v_mov_b32 v55, 0
 v_mov_b32 v56, 0
 v_mov_b32 v57, 0
 v_mov_b32 v58, 0
 v_mov_b32 v59, 0
 v_mov_b32 v60, 0
 v_mov_b32 v61, 0
 v_mov_b32 v62, 0
 v_mov_b32 v63, 0
 v_mov_b32 v100, 0
 v_mov_b32 v101, 0
 v_mov_b32 v102, 0
 v_mov_b32 v103, 0
 v_mov_b32 v104, 0
 v_mov_b32 v105, 0
 v_mov_b32 v106, 0
 v_mov_b32 v107, 0
 v_mov_b32 v108, 0
 v_mov_b32 v109, 0
 v_mov_b32 v110, 0
 v_mov_b32 v111, 0
 s_sleep 4
 s_nop 3
 v_readfirstlane_b32 s21, v0
 s_cmp_lt_u32 s21, s46
 s_cselect_b32 s55, s55, 0
 s_cmp_lt_i32 s55, 0
 s_cbranch_scc1 fl_55
fl_56:
 s_mov_b32 s54, 0
 buffer_load_dwordx4 v[36:39], v4, s[4:7], s84 offen offset:2048 sc1
 buffer_load_dwordx4 v[28:31], v4, s[4:7], s84 offen offset:0 sc1
 buffer_load_dwordx4 v[32:35], v4, s[4:7], s84 offen offset:1024 sc1
 s_waitcnt vmcnt(3)
 v_mov_b32 v126, v88
 v_mov_b32 v127, v89
 v_mov_b32 v128, v90
 v_mov_b32 v129, v91
 v_mov_b32 v130, v92
 v_mov_b32 v131, v93
 v_mov_b32 v132, v94
 v_mov_b32 v133, v95
 v_mov_b32 v134, v96
 v_mov_b32 v135, v97
 v_mov_b32 v136, v98
 v_mov_b32 v137, v99
 s_waitcnt vmcnt(2)
 v_smfmac_f32_16x16x32_f16 v[40:43], v[36:37], a[16:19], v25
 v_smfmac_f32_16x16x32_f16 v[52:55], v[36:37], a[76:79], v25
 v_smfmac_f32_16x16x32_f16 v[44:47], v[36:37], a[36:39], v25
 s_waitcnt vmcnt(0)
 v_bitop3_b32 v27, v31, v35, v39 bitop3:0x80
 v_perm_b32 v31, v35, v31, s89
 v_cmp_gt_u32 vcc, 0x48000000, v27
 v_mov_b32 v35, v38
 v_smfmac_f32_16x16x32_f16 v[56:59], v[36:37], a[96:99], v25
 s_cbranch_vccnz pm_53
A2_54:
 v_smfmac_f32_16x16x64_f16 v[40:43], v[28:31], a[0:7], v25
 ds_write_b128 v10, v[28:31]
 v_smfmac_f32_16x16x64_f16 v[40:43], v[32:35], a[8:15], v25
 ds_write_b128 v10, v[32:35] offset:1024
 v_smfmac_f32_16x16x64_f16 v[52:55], v[28:31], a[60:67], v25
 ds_write_b64 v10, v[36:37] offset:2048
 v_smfmac_f32_16x16x64_f16 v[52:55], v[32:35], a[68:75], v25
 v_cvt_pk_f16_f32 v40, v40, v41
 v_cvt_pk_f16_f32 v41, v42, v43
 v_smfmac_f32_16x16x32_f16 v[48:51], v[36:37], a[56:59], v25
 v_smfmac_f32_16x16x32_f16 v[60:63], v[36:37], a[116:119], v25
 v_smfmac_f32_16x16x64_f16 v[44:47], v[28:31], a[20:27], v25
 v_cvt_pk_f16_f32 v52, v52, v53
 v_cvt_pk_f16_f32 v53, v54, v55
 s_nop 0
 v_smfmac_f32_16x16x64_f16 v[44:47], v[32:35], a[28:35], v25
 v_permlane32_swap_b32 v40, v52
 v_smfmac_f32_16x16x64_f16 v[56:59], v[28:31], a[80:87], v25
 v_permlane32_swap_b32 v41, v53
 v_pk_add_f16 v40, v40, v52
 v_smfmac_f32_16x16x64_f16 v[56:59], v[32:35], a[88:95], v25
 v_pk_add_f16 v41, v41, v53
 v_smfmac_f32_16x16x64_f16 v[48:51], v[28:31], a[40:47], v25
 ds_write_b64 v5, v[40:41] offset:0
 v_smfmac_f32_16x16x64_f16 v[48:51], v[32:35], a[48:55], v25
 v_cvt_pk_f16_f32 v44, v44, v45
 v_cvt_pk_f16_f32 v45, v46, v47
 v_cvt_pk_f16_f32 v56, v56, v57
 v_smfmac_f32_16x16x64_f16 v[60:63], v[28:31], a[100:107], v25
 v_cvt_pk_f16_f32 v57, v58, v59
 s_nop 0
 v_smfmac_f32_16x16x64_f16 v[60:63], v[32:35], a[108:115], v25
 v_permlane32_swap_b32 v44, v56
 v_permlane32_swap_b32 v45, v57
 v_pk_add_f16 v44, v44, v56
 v_pk_add_f16 v45, v45, v57
 ds_write_b64 v5, v[44:45] offset:640
 v_cvt_pk_f16_f32 v48, v48, v49
 v_cvt_pk_f16_f32 v49, v50, v51
 v_cvt_pk_f16_f32 v60, v60, v61
 v_cvt_pk_f16_f32 v61, v62, v63
 s_nop 0
 v_permlane32_swap_b32 v48, v60
 v_permlane32_swap_b32 v49, v61
 v_pk_add_f16 v48, v48, v60
 v_pk_add_f16 v49, v49, v61
 ds_write_b64 v5, v[48:49] offset:1280
 s_waitcnt lgkmcnt(0) vmcnt(0)
 s_barrier
 ds_read_b64_tr_b16 v[40:41], v6 offset:0
 ds_read_b64_tr_b16 v[42:43], v6 offset:1920
 ds_read_b64_tr_b16 v[44:45], v6 offset:3840
 ds_read_b64_tr_b16 v[46:47], v6 offset:5760
 ds_read_b64_tr_b16 v[48:49], v6 offset:640
 ds_read_b64_tr_b16 v[50:51], v6 offset:2560
 ds_read_b64_tr_b16 v[52:53], v6 offset:4480
 ds_read_b64_tr_b16 v[54:55], v6 offset:6400
 ds_read_b64_tr_b16 v[56:57], v6 offset:1280
 ds_read_b64_tr_b16 v[58:59], v6 offset:3200
 ds_read_b64_tr_b16 v[60:61], v6 offset:5120
 ds_read_b64_tr_b16 v[62:63], v6 offset:7040
 s_waitcnt lgkmcnt(8)
 v_pk_add_f16 v40, v40, v42
 v_pk_add_f16 v44, v44, v46
 v_pk_add_f16 v41, v41, v43
 v_pk_add_f16 v45, v45, v47
 v_fma_mix_f32 v146, v40, 1.0, v44 op_sel:[0,0,0] op_sel_hi:[1,0,1]
 v_fma_mix_f32 v147, v40, 1.0, v44 op_sel:[1,0,1] op_sel_hi:[1,0,1]
 v_fma_mix_f32 v148, v41, 1.0, v45 op_sel:[0,0,0] op_sel_hi:[1,0,1]
 v_fma_mix_f32 v149, v41, 1.0, v45 op_sel:[1,0,1] op_sel_hi:[1,0,1]
 v_cvt_pk_bf16_f32 v118, v146, v147
 v_cvt_pk_bf16_f32 v119, v148, v149
 s_waitcnt lgkmcnt(4)
 v_pk_add_f16 v48, v48, v50
 v_pk_add_f16 v52, v52, v54
 v_pk_add_f16 v49, v49, v51
 v_pk_add_f16 v53, v53, v55
 v_fma_mix_f32 v146, v48, 1.0, v52 op_sel:[0,0,0] op_sel_hi:[1,0,1]
 v_fma_mix_f32 v147, v48, 1.0, v52 op_sel:[1,0,1] op_sel_hi:[1,0,1]
 v_fma_mix_f32 v148, v49, 1.0, v53 op_sel:[0,0,0] op_sel_hi:[1,0,1]
 v_fma_mix_f32 v149, v49, 1.0, v53 op_sel:[1,0,1] op_sel_hi:[1,0,1]
 v_cvt_pk_bf16_f32 v120, v146, v147
 v_cvt_pk_bf16_f32 v121, v148, v149
 s_waitcnt lgkmcnt(0)
 v_pk_add_f16 v56, v56, v58
 v_pk_add_f16 v60, v60, v62
 v_pk_add_f16 v57, v57, v59
 v_pk_add_f16 v61, v61, v63
 v_fma_mix_f32 v146, v56, 1.0, v60 op_sel:[0,0,0] op_sel_hi:[1,0,1]
 v_fma_mix_f32 v147, v56, 1.0, v60 op_sel:[1,0,1] op_sel_hi:[1,0,1]
 v_mfma_f32_16x16x32_bf16 v[40:43], v[118:121], v[118:121], 0
 v_fma_mix_f32 v148, v57, 1.0, v61 op_sel:[0,0,0] op_sel_hi:[1,0,1]
 v_fma_mix_f32 v149, v57, 1.0, v61 op_sel:[1,0,1] op_sel_hi:[1,0,1]
 v_cvt_pk_bf16_f32 v122, v146, v147
 v_cvt_pk_bf16_f32 v123, v148, v149
 s_nop 1
 v_mfma_f32_16x16x32_bf16 v[40:43], v[122:125], v[122:125], v[40:43]
 ds_read_b128 v[28:31], v16 offset:24576
 ds_read_b128 v[32:35], v16 offset:25600
 ds_read_b128 v[64:67], v16 offset:27648
 ds_read_b128 v[68:71], v16 offset:28672
 ds_read_b128 v[72:75], v16 offset:30720
 ds_read_b128 v[76:79], v16 offset:31744
 s_nop 0
 s_mov_b64 exec, s[74:75]
 v_cvt_pk_f16_f32 v44, v40, v41
 v_cvt_pk_f16_f32 v45, v42, v43
 v_and_or_b32 v44, v44, -2, s88
 buffer_store_dwordx2 v[44:45], v7, s[8:11], s81 offen
 s_mov_b64 exec, -1
 ds_read_b128 v[80:83], v16 offset:33792
 ds_read_b128 v[84:87], v16 offset:34816
 ds_read_b64 v[88:89], v16 offset:26624
 ds_read_b64 v[90:91], v16 offset:29696
 ds_read_b64 v[92:93], v16 offset:32768
 ds_read_b64 v[94:95], v16 offset:35840
 s_cmp_eq_u32 s52, 63
 s_cbranch_scc1 last_51
 s_waitcnt lgkmcnt(10)
 v_smfmac_f32_16x16x64_f16 v[100:103], v[28:31], a[120:127], v25
 v_smfmac_f32_16x16x64_f16 v[104:107], v[28:31], a[128:135], v25
 v_smfmac_f32_16x16x64_f16 v[108:111], v[28:31], a[136:143], v25
 s_mov_b32 s54, 0
 v_smfmac_f32_16x16x64_f16 v[100:103], v[32:35], a[144:151], v25
 v_readfirstlane_b32 s21, v0
 v_smfmac_f32_16x16x64_f16 v[104:107], v[32:35], a[152:159], v25
 s_add_u32 s22, s46, 3
 v_smfmac_f32_16x16x64_f16 v[108:111], v[32:35], a[160:167], v25
 s_min_u32 s22, s22, 64
 s_waitcnt lgkmcnt(7)
 v_smfmac_f32_16x16x64_f16 v[100:103], v[64:67], a[168:175], v25
 s_sub_u32 s55, s21, s22
 v_smfmac_f32_16x16x64_f16 v[104:107], v[64:67], a[176:183], v25
 s_sub_u32 s56, s21, s46
 v_smfmac_f32_16x16x64_f16 v[108:111], v[64:67], a[184:191], v25
 v_smfmac_f32_16x16x64_f16 v[100:103], v[68:71], a[192:199], v25
 v_smfmac_f32_16x16x64_f16 v[104:107], v[68:71], a[200:207], v25
 v_smfmac_f32_16x16x64_f16 v[108:111], v[68:71], a[208:215], v25
 v_smfmac_f32_16x16x64_f16 v[100:103], v[72:75], a[216:223], v25
 v_smfmac_f32_16x16x64_f16 v[104:107], v[72:75], a[224:231], v25
 v_smfmac_f32_16x16x64_f16 v[108:111], v[72:75], a[232:239], v25
 s_waitcnt lgkmcnt(4)
 v_smfmac_f32_16x16x64_f16 v[100:103], v[76:79], a[240:247], v25
 v_smfmac_f32_16x16x64_f16 v[104:107], v[76:79], a[248:255], v25
 v_smfmac_f32_16x16x64_f16 v[108:111], v[76:79], v[152:159], v25
 buffer_load_dwordx2 v[58:59], v9, s[8:11], s81 offen sc1
 buffer_load_dwordx4 v[40:43], v8, s[8:11], s81 offen offset:0 sc1
 buffer_load_dwordx4 v[44:47], v8, s[8:11], s81 offen offset:1024 sc1
 v_smfmac_f32_16x16x64_f16 v[100:103], v[80:83], v[160:167], v25
 v_smfmac_f32_16x16x64_f16 v[104:107], v[80:83], v[168:175], v25
 v_smfmac_f32_16x16x64_f16 v[108:111], v[80:83], v[176:183], v25
 v_smfmac_f32_16x16x64_f16 v[100:103], v[84:87], v[184:191], v25
 v_smfmac_f32_16x16x64_f16 v[104:107], v[84:87], v[192:199], v25
 v_smfmac_f32_16x16x64_f16 v[108:111], v[84:87], v[200:207], v25
 s_waitcnt lgkmcnt(0)
 v_smfmac_f32_16x16x64_f16 v[100:103], v[88:91], v[208:215], v25
 v_smfmac_f32_16x16x64_f16 v[104:107], v[88:91], v[216:223], v25
 v_smfmac_f32_16x16x64_f16 v[108:111], v[88:91], v[224:231], v25
 v_smfmac_f32_16x16x64_f16 v[100:103], v[92:95], v[232:239], v25
 v_smfmac_f32_16x16x64_f16 v[104:107], v[92:95], v[240:247], v25
 v_smfmac_f32_16x16x64_f16 v[108:111], v[92:95], v[248:255], v25
 s_cmp_lt_i32 s56, 0
 s_cbranch_scc1 kvw_59
kvok_60:
 s_waitcnt vmcnt(2)
 v_xor_b32 v76, s88, v58
 s_nop 0
 v_permlane16_swap_b32 v58, v59
 v_fma_mix_f32 v60, v58, 1.0, v59 op_sel:[0,0,0] op_sel_hi:[1,0,1]
 v_fma_mix_f32 v61, v58, 1.0, v59 op_sel:[1,0,1] op_sel_hi:[1,0,1]
 v_mov_b32 v58, v60
 v_mov_b32 v59, v61
 s_nop 0
 v_permlane32_swap_b32 v58, v60
 v_permlane32_swap_b32 v59, v61
 v_add_f32 v52, v58, v60
 v_add_f32 v53, v59, v61
 v_max_f32 v79, v52, v53
 s_waitcnt vmcnt(0)
 v_pk_add_f16 v80, v40, v44
 v_pk_add_f16 v82, v42, v46
 v_pk_add_f16 v81, v41, v45
 v_pk_add_f16 v83, v43, v47
 v_permlane32_swap_b32 v80, v82
 v_bitop3_b32 v77, v40, v42, s88 bitop3:0x7e
 v_permlane32_swap_b32 v81, v83
 v_bitop3_b32 v78, v44, v46, s88 bitop3:0x7e
 v_fma_mix_f32 v48, v80, 1.0, v82 op_sel:[0,0,0] op_sel_hi:[1,0,1]
 v_or3_b32 v27, v76, v77, v78
 v_fma_mix_f32 v49, v80, 1.0, v82 op_sel:[1,0,1] op_sel_hi:[1,0,1]
 v_and_b32 v27, 1, v27
 v_fma_mix_f32 v50, v81, 1.0, v83 op_sel:[0,0,0] op_sel_hi:[1,0,1]
 v_cmp_ne_u32 vcc, 0, v27
 v_fma_mix_f32 v51, v81, 1.0, v83 op_sel:[1,0,1] op_sel_hi:[1,0,1]
 v_max3_f32 v62, v48, v49, v79
 s_cbranch_vccnz psr_57
psj_58:
 v_max3_f32 v62, v62, v50, v51
 v_cvt_pk_bf16_f32 v146, v100, v101
 v_cvt_pk_bf16_f32 v147, v102, v103
 v_max_f32_dpp v62, v62, v62 row_ror:8 row_mask:0xf bank_mask:0xf
 v_mov_b32 v63, v62
 v_cvt_pk_bf16_f32 v148, v104, v105
 v_cvt_pk_bf16_f32 v149, v106, v107
 v_permlane32_swap_b32 v62, v63
 v_max_f32 v62, v62, v63
 v_mov_b32 v63, v62
 v_cvt_pk_bf16_f32 v150, v108, v109
 v_cvt_pk_bf16_f32 v151, v110, v111
 v_permlane16_swap_b32 v62, v63
 v_max_f32 v62, v62, v63
 v_mul_f32 v62, s86, v62
 v_fma_f32 v48, v48, s86, -v62
 v_fma_f32 v49, v49, s86, -v62
 v_fma_f32 v50, v50, s86, -v62
 v_fma_f32 v51, v51, s86, -v62
 v_fma_f32 v52, v52, s86, -v62
 v_fma_f32 v53, v53, s86, -v62
 v_exp_f32 v48, v48
 v_exp_f32 v49, v49
 buffer_load_dwordx4 v[88:91], v17, s[28:31], s64 offen offset:0 sc1
 v_exp_f32 v50, v50
 v_exp_f32 v51, v51
 buffer_load_dwordx4 v[92:95], v16, s[28:31], s64 offen offset:1024 sc1
 v_exp_f32 v52, v52
 v_exp_f32 v53, v53
 buffer_load_dwordx4 v[96:99], v20, s[28:31], s64 offen offset:2048 sc1
 v_cvt_pk_bf16_f32 v138, v48, v49
 v_cvt_pk_bf16_f32 v139, v50, v51
 v_cvt_pk_bf16_f32 v142, v52, v53
 v_mov_b32_dpp v140, v138 row_ror:8 row_mask:0xf bank_mask:0xf
 v_mov_b32_dpp v141, v139 row_ror:8 row_mask:0xf bank_mask:0xf
 v_mov_b32_dpp v143, v142 row_ror:8 row_mask:0xf bank_mask:0xf
 v_add_f32 v54, v48, v49
 v_mfma_f32_16x16x32_bf16 v[64:67], v[126:129], v[138:141], 0
 v_add_f32 v55, v50, v51
 v_add_f32 v56, v52, v53
 v_mfma_f32_16x16x32_bf16 v[64:67], v[146:149], v[142:145], v[64:67]
 v_add_f32 v62, v54, v55
 v_fmac_f32 v62, v56, v26
 v_mfma_f32_16x16x32_bf16 v[68:71], v[130:133], v[138:141], 0
 s_nop 0
 v_add_f32_dpp v62, v62, v62 row_ror:8 row_mask:0xf bank_mask:0xf
 v_mfma_f32_16x16x32_bf16 v[68:71], v[148:151], v[142:145], v[68:71]
 v_mov_b32 v63, v62
 s_cmp_lt_i32 s55, 0
 s_cbranch_scc1 fl_61
fl_62:
 v_mfma_f32_16x16x32_bf16 v[72:75], v[134:137], v[138:141], 0
 v_permlane32_swap_b32 v62, v63
 v_mfma_f32_16x16x32_bf16 v[72:75], v[150:153], v[142:145], v[72:75]
 v_add_f32 v62, v62, v63
 v_mov_b32 v63, v62
 ds_write_b128 v11, v[64:67] offset:0
 s_nop 0
 v_permlane16_swap_b32 v62, v63
 v_add_f32 v62, v62, v63
 v_rcp_f32 v62, v62
 ds_write_b128 v11, v[68:71] offset:1024
 s_mov_b64 exec, 0xff
 ds_write_b32 v22, v62
 s_mov_b64 exec, -1
 ds_write_b128 v11, v[72:75] offset:2048
 s_waitcnt lgkmcnt(0)
 s_barrier
 ds_read_b128 v[72:75], v23
 ds_read_b64 v[64:65], v12 offset:0
 ds_read_b64 v[66:67], v12 offset:3072
 ds_read_b64 v[68:69], v12 offset:6144
 ds_read_b64 v[70:71], v12 offset:9216
 s_waitcnt lgkmcnt(2)
 v_pk_mul_f32 v[64:65], v[64:65], v[72:73] op_sel_hi:[1,0]
 v_pk_fma_f32 v[64:65], v[66:67], v[72:73], v[64:65] op_sel:[0,1,0] op_sel_hi:[1,1,1]
 s_waitcnt lgkmcnt(0)
 v_pk_fma_f32 v[64:65], v[68:69], v[74:75], v[64:65] op_sel_hi:[1,0,1]
 v_pk_fma_f32 v[64:65], v[70:71], v[74:75], v[64:65] op_sel:[0,1,0] op_sel_hi:[1,1,1]
 v_cvt_pk_f16_f32 v68, v64, v65
 v_perm_b32 v68, s91, v68, v14
 buffer_atomic_pk_add_f16 v68, v13, s[4:7], s3 offen
 s_mov_b64 exec, s[62:63]
 buffer_store_dwordx4 v[118:121], v18, s[24:27], s85 offen sc1
 buffer_store_dwordx2 v[122:123], v19, s[24:27], s85 offen sc1
 s_mov_b64 exec, -1
 v_mov_b32 v76, v108
 v_mov_b32 v77, v109
 v_mov_b32 v78, v110
 v_mov_b32 v79, v111
 v_permlane32_swap_b32 v100, v104
 v_permlane32_swap_b32 v101, v105
 v_permlane32_swap_b32 v102, v106
 v_permlane32_swap_b32 v103, v107
 v_permlane32_swap_b32 v108, v76
 v_permlane32_swap_b32 v109, v77
 v_permlane32_swap_b32 v110, v78
 v_permlane32_swap_b32 v111, v79
 v_pk_add_f32 v[100:101], v[100:101], v[104:105]
 v_pk_add_f32 v[102:103], v[102:103], v[106:107]
 v_pk_add_f32 v[108:109], v[108:109], v[76:77]
 v_pk_add_f32 v[110:111], v[110:111], v[78:79]
 v_cvt_pk_bf16_f32 v80, v100, v101
 v_cvt_pk_bf16_f32 v82, v108, v109
 v_cvt_pk_bf16_f32 v81, v102, v103
 v_cvt_pk_bf16_f32 v83, v110, v111
 s_nop 0
 v_permlane16_swap_b32 v80, v82
 v_permlane16_swap_b32 v81, v83
 v_min_u32 v80, -2, v80
 s_mov_b64 exec, s[76:77]
 buffer_store_dwordx4 v[80:83], v15, s[24:27], s57 offen sc1
 s_mov_b64 exec, -1
 s_add_u32 s64, s64, 1310720
 s_add_u32 s52, s52, 1
 s_branch step_50
fl_55:
 buffer_load_dword v0, off, s[12:15], s79 sc1
 s_branch fl_56
A1_15:
 v_smfmac_f32_16x16x32_f16 v[40:43], v[36:37], a[16:19], v25
 v_smfmac_f32_16x16x32_f16 v[52:55], v[36:37], a[76:79], v25
 v_smfmac_f32_16x16x32_f16 v[44:47], v[36:37], a[36:39], v25
 v_smfmac_f32_16x16x32_f16 v[56:59], v[36:37], a[96:99], v25
 s_branch A2_54
pm_53:
 buffer_load_dwordx4 v[36:39], v4, s[4:7], s84 offen offset:2048 sc1
 buffer_load_dwordx4 v[28:31], v4, s[4:7], s84 offen offset:0 sc1
 buffer_load_dwordx4 v[32:35], v4, s[4:7], s84 offen offset:1024 sc1
 s_nop 7
 v_mov_b32 v40, 0
 v_mov_b32 v41, 0
 v_mov_b32 v42, 0
 v_mov_b32 v43, 0
 v_mov_b32 v52, 0
 v_mov_b32 v53, 0
 v_mov_b32 v54, 0
 v_mov_b32 v55, 0
 v_mov_b32 v44, 0
 v_mov_b32 v45, 0
 v_mov_b32 v46, 0
 v_mov_b32 v47, 0
 v_mov_b32 v56, 0
 v_mov_b32 v57, 0
 v_mov_b32 v58, 0
 v_mov_b32 v59, 0
 s_waitcnt vmcnt(0)
 v_bitop3_b32 v27, v31, v35, v39 bitop3:0x80
 v_perm_b32 v31, v35, v31, s89
 v_cmp_gt_u32 vcc, 0x48000000, v27
 v_mov_b32 v35, v38
 s_cbranch_vccz A1_15
pm_52:
 s_cmp_gt_u32 s52, 3
 s_cbranch_scc1 op_63
 v_readfirstlane_b32 s21, v0
 s_cmp_ge_u32 s21, s46
 s_cbranch_scc1 op_63
 buffer_load_dword v0, off, s[12:15], s79 sc1
 s_waitcnt vmcnt(0)
 v_readfirstlane_b32 s21, v0
 s_cmp_gt_u32 s21, s52
 s_cselect_b32 s21, s87, 0
 s_cmp_eq_u32 s21, 0
 s_cbranch_scc1 op_63
 s_mov_b32 s87, 0
 s_sub_u32 s21, s64, 1310720
 buffer_load_dwordx4 v[126:129], v16, s[28:31], s21 offen offset:0 sc1
 buffer_load_dwordx4 v[130:133], v16, s[28:31], s21 offen offset:1024 sc1
 buffer_load_dwordx4 v[134:137], v16, s[28:31], s21 offen offset:2048 sc1
op_63:
 buffer_load_dwordx4 v[36:39], v4, s[4:7], s84 offen offset:2048 sc1
 buffer_load_dwordx4 v[28:31], v4, s[4:7], s84 offen offset:0 sc1
 buffer_load_dwordx4 v[32:35], v4, s[4:7], s84 offen offset:1024 sc1
 s_add_u32 s54, s54, 1
 s_cmp_gt_u32 s54, 131072
 s_cbranch_scc1 end0
 s_waitcnt vmcnt(0)
 v_bitop3_b32 v27, v31, v35, v39 bitop3:0x80
 v_perm_b32 v31, v35, v31, s89
 v_cmp_gt_u32 vcc, 0x48000000, v27
 v_mov_b32 v35, v38
 s_cbranch_vccnz pm_52
 s_branch A1_15
psr_57:
 buffer_load_dwordx2 v[58:59], v9, s[8:11], s81 offen sc1
 buffer_load_dwordx4 v[40:43], v8, s[8:11], s81 offen offset:0 sc1
 buffer_load_dwordx4 v[44:47], v8, s[8:11], s81 offen offset:1024 sc1
 s_add_u32 s54, s54, 1
 s_cmp_gt_u32 s54, 131072
 s_cbranch_scc1 end0
 s_waitcnt vmcnt(2)
 v_xor_b32 v76, s88, v58
 s_nop 0
 v_permlane16_swap_b32 v58, v59
 v_fma_mix_f32 v60, v58, 1.0, v59 op_sel:[0,0,0] op_sel_hi:[1,0,1]
 v_fma_mix_f32 v61, v58, 1.0, v59 op_sel:[1,0,1] op_sel_hi:[1,0,1]
 v_mov_b32 v58, v60
 v_mov_b32 v59, v61
 s_nop 0
 v_permlane32_swap_b32 v58, v60
 v_permlane32_swap_b32 v59, v61
 v_add_f32 v52, v58, v60
 v_add_f32 v53, v59, v61
 v_max_f32 v79, v52, v53
 s_waitcnt vmcnt(0)
 v_pk_add_f16 v80, v40, v44
 v_pk_add_f16 v82, v42, v46
 v_pk_add_f16 v81, v41, v45
 v_pk_add_f16 v83, v43, v47
 v_permlane32_swap_b32 v80, v82
 v_bitop3_b32 v77, v40, v42, s88 bitop3:0x7e
 v_permlane32_swap_b32 v81, v83
 v_bitop3_b32 v78, v44, v46, s88 bitop3:0x7e
 v_fma_mix_f32 v48, v80, 1.0, v82 op_sel:[0,0,0] op_sel_hi:[1,0,1]
 v_or3_b32 v27, v76, v77, v78
 v_fma_mix_f32 v49, v80, 1.0, v82 op_sel:[1,0,1] op_sel_hi:[1,0,1]
 v_and_b32 v27, 1, v27
 v_fma_mix_f32 v50, v81, 1.0, v83 op_sel:[0,0,0] op_sel_hi:[1,0,1]
 v_cmp_ne_u32 vcc, 0, v27
 v_fma_mix_f32 v51, v81, 1.0, v83 op_sel:[1,0,1] op_sel_hi:[1,0,1]
 v_max3_f32 v62, v48, v49, v79
 s_cbranch_vccnz psr_57
 s_branch psj_58
kvw_59:
 s_mov_b32 s22, s87
 s_cmp_eq_u32 s52, 0
 s_cselect_b32 s55, 0, s55
 s_cselect_b32 s87, 1, 0
 s_cbranch_scc1 kvok_60
 v_mov_b32 v62, 0
 s_mov_b32 s101, 0
wf_64:
 buffer_load_dword v63, v62, s[12:15], s79 offen sc1
 s_add_u32 s101, s101, 1
 s_cmp_gt_u32 s101, 131072
 s_cbranch_scc1 end0
 s_waitcnt vmcnt(0)
 v_readfirstlane_b32 s100, v63
 s_cmp_ge_u32 s100, s46
 s_cbranch_scc1 wf_65
 s_sleep 3
 s_branch wf_64
wf_65:
 s_cmp_eq_u32 s22, 0
 s_cbranch_scc1 kvok_60
 s_sub_u32 s21, s64, 1310720
 buffer_load_dwordx4 v[126:129], v16, s[28:31], s21 offen offset:0 sc1
 buffer_load_dwordx4 v[130:133], v16, s[28:31], s21 offen offset:1024 sc1
 buffer_load_dwordx4 v[134:137], v16, s[28:31], s21 offen offset:2048 sc1
 s_waitcnt vmcnt(0)
 s_branch kvok_60
fl_61:
 buffer_load_dword v0, off, s[12:15], s79 sc1
 s_branch fl_62
last_51:
 s_mov_b64 exec, s[62:63]
 buffer_store_dwordx4 v[118:121], v18, s[24:27], s85 offen sc1
 buffer_store_dwordx2 v[122:123], v19, s[24:27], s85 offen sc1
 s_mov_b64 exec, -1
 s_waitcnt lgkmcnt(10)
 v_smfmac_f32_16x16x64_f16 v[100:103], v[28:31], a[120:127], v25
 v_smfmac_f32_16x16x64_f16 v[104:107], v[28:31], a[128:135], v25
 v_smfmac_f32_16x16x64_f16 v[108:111], v[28:31], a[136:143], v25
 v_smfmac_f32_16x16x64_f16 v[100:103], v[32:35], a[144:151], v25
 v_smfmac_f32_16x16x64_f16 v[104:107], v[32:35], a[152:159], v25
 v_smfmac_f32_16x16x64_f16 v[108:111], v[32:35], a[160:167], v25
 s_waitcnt lgkmcnt(7)
 v_smfmac_f32_16x16x64_f16 v[100:103], v[64:67], a[168:175], v25
 v_smfmac_f32_16x16x64_f16 v[104:107], v[64:67], a[176:183], v25
 v_smfmac_f32_16x16x64_f16 v[108:111], v[64:67], a[184:191], v25
 v_smfmac_f32_16x16x64_f16 v[100:103], v[68:71], a[192:199], v25
 v_smfmac_f32_16x16x64_f16 v[104:107], v[68:71], a[200:207], v25
 v_smfmac_f32_16x16x64_f16 v[108:111], v[68:71], a[208:215], v25
 v_smfmac_f32_16x16x64_f16 v[100:103], v[72:75], a[216:223], v25
 v_smfmac_f32_16x16x64_f16 v[104:107], v[72:75], a[224:231], v25
 v_smfmac_f32_16x16x64_f16 v[108:111], v[72:75], a[232:239], v25
 s_waitcnt lgkmcnt(4)
 v_smfmac_f32_16x16x64_f16 v[100:103], v[76:79], a[240:247], v25
 v_smfmac_f32_16x16x64_f16 v[104:107], v[76:79], a[248:255], v25
 v_smfmac_f32_16x16x64_f16 v[108:111], v[76:79], v[152:159], v25
 v_smfmac_f32_16x16x64_f16 v[100:103], v[80:83], v[160:167], v25
 v_smfmac_f32_16x16x64_f16 v[104:107], v[80:83], v[168:175], v25
 v_smfmac_f32_16x16x64_f16 v[108:111], v[80:83], v[176:183], v25
 v_smfmac_f32_16x16x64_f16 v[100:103], v[84:87], v[184:191], v25
 v_smfmac_f32_16x16x64_f16 v[104:107], v[84:87], v[192:199], v25
 v_smfmac_f32_16x16x64_f16 v[108:111], v[84:87], v[200:207], v25
 s_waitcnt lgkmcnt(0)
 v_smfmac_f32_16x16x64_f16 v[100:103], v[88:91], v[208:215], v25
 v_smfmac_f32_16x16x64_f16 v[104:107], v[88:91], v[216:223], v25
 v_smfmac_f32_16x16x64_f16 v[108:111], v[88:91], v[224:231], v25
 v_smfmac_f32_16x16x64_f16 v[100:103], v[92:95], v[232:239], v25
 v_smfmac_f32_16x16x64_f16 v[104:107], v[92:95], v[240:247], v25
 v_smfmac_f32_16x16x64_f16 v[108:111], v[92:95], v[248:255], v25
 s_nop 7
 v_mov_b32 v76, v108
 v_mov_b32 v77, v109
 v_mov_b32 v78, v110
 v_mov_b32 v79, v111
 v_permlane32_swap_b32 v100, v104
 v_permlane32_swap_b32 v101, v105
 v_permlane32_swap_b32 v102, v106
 v_permlane32_swap_b32 v103, v107
 v_permlane32_swap_b32 v108, v76
 v_permlane32_swap_b32 v109, v77
 v_permlane32_swap_b32 v110, v78
 v_permlane32_swap_b32 v111, v79
 v_pk_add_f32 v[100:101], v[100:101], v[104:105]
 v_pk_add_f32 v[102:103], v[102:103], v[106:107]
 v_pk_add_f32 v[108:109], v[108:109], v[76:77]
 v_pk_add_f32 v[110:111], v[110:111], v[78:79]
 v_cvt_pk_bf16_f32 v80, v100, v101
 v_cvt_pk_bf16_f32 v82, v108, v109
 v_cvt_pk_bf16_f32 v81, v102, v103
 v_cvt_pk_bf16_f32 v83, v110, v111
 s_nop 0
 v_permlane16_swap_b32 v80, v82
 v_permlane16_swap_b32 v81, v83
 v_min_u32 v80, -2, v80
 s_mov_b64 exec, s[76:77]
 buffer_store_dwordx4 v[80:83], v15, s[24:27], s57 offen sc1
 s_mov_b64 exec, -1
 s_branch chain_done
step_66:
 s_and_b32 s21, s52, 3
 s_mul_i32 s81, s21, 540672
 s_lshl_b32 s84, s21, 15
 s_add_u32 s21, s52, 3
 s_and_b32 s21, s21, 3
 s_lshl_b32 s83, s21, 15
 s_add_u32 s21, s52, 1
 s_and_b32 s22, s21, 3
 s_lshl_b32 s3, s22, 15
 s_mul_i32 s80, s21, 393216
 s_add_u32 s46, s21, 1
 s_min_u32 s46, s46, 64
 s_mov_b32 s47, s57
 s_lshl_b32 s21, s52, 12
 s_and_b32 s21, s21, 8192
 s_xor_b32 s21, s21, s37
 s_lshl_b32 s22, s52, 20
 s_or_b32 s22, s22, s21
 s_cmp_ge_u32 s52, 36
 s_cselect_b32 s57, 8192, 0
 s_xor_b32 s57, s57, s22
 s_xor_b32 s85, s22, 8192
 s_bfe_u32 s88, s52, 0x10002
 s_max_u32 s67, s52, 1
 s_sub_u32 s67, s67, 1
 v_mov_b32 v40, 0
 v_mov_b32 v41, 0
 v_mov_b32 v42, 0
 v_mov_b32 v43, 0
 v_mov_b32 v44, 0
 v_mov_b32 v45, 0
 v_mov_b32 v46, 0
 v_mov_b32 v47, 0
 v_mov_b32 v48, 0
 v_mov_b32 v49, 0
 v_mov_b32 v50, 0
 v_mov_b32 v51, 0
 v_mov_b32 v52, 0
 v_mov_b32 v53, 0
 v_mov_b32 v54, 0
 v_mov_b32 v55, 0
 v_mov_b32 v56, 0
 v_mov_b32 v57, 0
 v_mov_b32 v58, 0
 v_mov_b32 v59, 0
 v_mov_b32 v60, 0
 v_mov_b32 v61, 0
 v_mov_b32 v62, 0
 v_mov_b32 v63, 0
 v_mov_b32 v100, 0
 v_mov_b32 v101, 0
 v_mov_b32 v102, 0
 v_mov_b32 v103, 0
 v_mov_b32 v104, 0
 v_mov_b32 v105, 0
 v_mov_b32 v106, 0
 v_mov_b32 v107, 0
 v_mov_b32 v108, 0
 v_mov_b32 v109, 0
 v_mov_b32 v110, 0
 v_mov_b32 v111, 0
 s_sleep 6
 v_readfirstlane_b32 s21, v0
 s_cmp_lt_u32 s21, s46
 s_cselect_b32 s55, s55, 0
 s_cmp_lt_i32 s55, 0
 s_cbranch_scc1 fl_71
fl_72:
 s_mov_b32 s54, 0
 buffer_load_dwordx4 v[36:39], v4, s[4:7], s84 offen offset:2048 sc1
 buffer_load_dwordx4 v[28:31], v4, s[4:7], s84 offen offset:0 sc1
 buffer_load_dwordx4 v[32:35], v4, s[4:7], s84 offen offset:1024 sc1
 s_waitcnt vmcnt(3)
 v_mov_b32 v126, v88
 v_mov_b32 v127, v89
 v_mov_b32 v128, v90
 v_mov_b32 v129, v91
 v_mov_b32 v130, v92
 v_mov_b32 v131, v93
 v_mov_b32 v132, v94
 v_mov_b32 v133, v95
 v_mov_b32 v134, v96
 v_mov_b32 v135, v97
 v_mov_b32 v136, v98
 v_mov_b32 v137, v99
 s_waitcnt vmcnt(2)
 v_smfmac_f32_16x16x32_f16 v[40:43], v[36:37], a[16:19], v25
 v_smfmac_f32_16x16x32_f16 v[52:55], v[36:37], a[76:79], v25
 v_smfmac_f32_16x16x32_f16 v[44:47], v[36:37], a[36:39], v25
 s_waitcnt vmcnt(0)
 v_bitop3_b32 v27, v31, v35, v39 bitop3:0x80
 v_perm_b32 v31, v35, v31, s89
 v_cmp_gt_u32 vcc, 0x48000000, v27
 v_mov_b32 v35, v38
 v_smfmac_f32_16x16x32_f16 v[56:59], v[36:37], a[96:99], v25
 s_cbranch_vccnz pm_69
A2_70:
 v_smfmac_f32_16x16x64_f16 v[40:43], v[28:31], a[0:7], v25
 ds_write_b128 v10, v[28:31]
 v_smfmac_f32_16x16x64_f16 v[40:43], v[32:35], a[8:15], v25
 ds_write_b128 v10, v[32:35] offset:1024
 v_smfmac_f32_16x16x64_f16 v[52:55], v[28:31], a[60:67], v25
 ds_write_b64 v10, v[36:37] offset:2048
 v_smfmac_f32_16x16x64_f16 v[52:55], v[32:35], a[68:75], v25
 v_cvt_pk_f16_f32 v40, v40, v41
 v_cvt_pk_f16_f32 v41, v42, v43
 v_smfmac_f32_16x16x32_f16 v[48:51], v[36:37], a[56:59], v25
 v_smfmac_f32_16x16x32_f16 v[60:63], v[36:37], a[116:119], v25
 v_smfmac_f32_16x16x64_f16 v[44:47], v[28:31], a[20:27], v25
 v_cvt_pk_f16_f32 v52, v52, v53
 v_cvt_pk_f16_f32 v53, v54, v55
 s_nop 0
 v_smfmac_f32_16x16x64_f16 v[44:47], v[32:35], a[28:35], v25
 v_permlane32_swap_b32 v40, v52
 v_smfmac_f32_16x16x64_f16 v[56:59], v[28:31], a[80:87], v25
 v_permlane32_swap_b32 v41, v53
 v_pk_add_f16 v40, v40, v52
 v_smfmac_f32_16x16x64_f16 v[56:59], v[32:35], a[88:95], v25
 v_pk_add_f16 v41, v41, v53
 v_smfmac_f32_16x16x64_f16 v[48:51], v[28:31], a[40:47], v25
 ds_write_b64 v5, v[40:41] offset:0
 v_smfmac_f32_16x16x64_f16 v[48:51], v[32:35], a[48:55], v25
 v_cvt_pk_f16_f32 v44, v44, v45
 v_cvt_pk_f16_f32 v45, v46, v47
 v_cvt_pk_f16_f32 v56, v56, v57
 v_smfmac_f32_16x16x64_f16 v[60:63], v[28:31], a[100:107], v25
 v_cvt_pk_f16_f32 v57, v58, v59
 s_nop 0
 v_smfmac_f32_16x16x64_f16 v[60:63], v[32:35], a[108:115], v25
 v_permlane32_swap_b32 v44, v56
 v_permlane32_swap_b32 v45, v57
 v_pk_add_f16 v44, v44, v56
 v_pk_add_f16 v45, v45, v57
 ds_write_b64 v5, v[44:45] offset:640
 v_cvt_pk_f16_f32 v48, v48, v49
 v_cvt_pk_f16_f32 v49, v50, v51
 v_cvt_pk_f16_f32 v60, v60, v61
 v_cvt_pk_f16_f32 v61, v62, v63
 s_nop 0
 v_permlane32_swap_b32 v48, v60
 v_permlane32_swap_b32 v49, v61
 v_pk_add_f16 v48, v48, v60
 v_pk_add_f16 v49, v49, v61
 ds_write_b64 v5, v[48:49] offset:1280
 s_waitcnt lgkmcnt(0) vmcnt(0)
 s_barrier
 ds_read_b128 v[28:31], v16 offset:24576
 ds_read_b128 v[32:35], v16 offset:25600
 ds_read_b128 v[64:67], v16 offset:27648
 ds_read_b128 v[68:71], v16 offset:28672
 ds_read_b128 v[72:75], v16 offset:30720
 ds_read_b128 v[76:79], v16 offset:31744
 ds_read_b128 v[80:83], v16 offset:33792
 ds_read_b128 v[84:87], v16 offset:34816
 ds_read_b64 v[88:89], v16 offset:26624
 ds_read_b64 v[90:91], v16 offset:29696
 ds_read_b64 v[92:93], v16 offset:32768
 ds_read_b64 v[94:95], v16 offset:35840
 s_cmp_eq_u32 s52, 63
 s_cbranch_scc1 last_67
 s_waitcnt lgkmcnt(10)
 v_smfmac_f32_16x16x64_f16 v[100:103], v[28:31], a[120:127], v25
 v_smfmac_f32_16x16x64_f16 v[104:107], v[28:31], a[128:135], v25
 v_smfmac_f32_16x16x64_f16 v[108:111], v[28:31], a[136:143], v25
 s_mov_b32 s54, 0
 v_smfmac_f32_16x16x64_f16 v[100:103], v[32:35], a[144:151], v25
 v_readfirstlane_b32 s21, v0
 v_smfmac_f32_16x16x64_f16 v[104:107], v[32:35], a[152:159], v25
 s_add_u32 s22, s46, 3
 v_smfmac_f32_16x16x64_f16 v[108:111], v[32:35], a[160:167], v25
 s_min_u32 s22, s22, 64
 s_waitcnt lgkmcnt(7)
 v_smfmac_f32_16x16x64_f16 v[100:103], v[64:67], a[168:175], v25
 s_sub_u32 s55, s21, s22
 v_smfmac_f32_16x16x64_f16 v[104:107], v[64:67], a[176:183], v25
 s_sub_u32 s56, s21, s46
 v_smfmac_f32_16x16x64_f16 v[108:111], v[64:67], a[184:191], v25
 v_smfmac_f32_16x16x64_f16 v[100:103], v[68:71], a[192:199], v25
 v_smfmac_f32_16x16x64_f16 v[104:107], v[68:71], a[200:207], v25
 v_smfmac_f32_16x16x64_f16 v[108:111], v[68:71], a[208:215], v25
 v_smfmac_f32_16x16x64_f16 v[100:103], v[72:75], a[216:223], v25
 v_smfmac_f32_16x16x64_f16 v[104:107], v[72:75], a[224:231], v25
 v_smfmac_f32_16x16x64_f16 v[108:111], v[72:75], a[232:239], v25
 s_waitcnt lgkmcnt(4)
 v_smfmac_f32_16x16x64_f16 v[100:103], v[76:79], a[240:247], v25
 v_smfmac_f32_16x16x64_f16 v[104:107], v[76:79], a[248:255], v25
 v_smfmac_f32_16x16x64_f16 v[108:111], v[76:79], v[152:159], v25
 v_smfmac_f32_16x16x64_f16 v[100:103], v[80:83], v[160:167], v25
 v_smfmac_f32_16x16x64_f16 v[104:107], v[80:83], v[168:175], v25
 v_smfmac_f32_16x16x64_f16 v[108:111], v[80:83], v[176:183], v25
 v_smfmac_f32_16x16x64_f16 v[100:103], v[84:87], v[184:191], v25
 v_smfmac_f32_16x16x64_f16 v[104:107], v[84:87], v[192:199], v25
 v_smfmac_f32_16x16x64_f16 v[108:111], v[84:87], v[200:207], v25
 s_waitcnt lgkmcnt(0)
 v_smfmac_f32_16x16x64_f16 v[100:103], v[88:91], v[208:215], v25
 v_smfmac_f32_16x16x64_f16 v[104:107], v[88:91], v[216:223], v25
 v_smfmac_f32_16x16x64_f16 v[108:111], v[88:91], v[224:231], v25
 v_smfmac_f32_16x16x64_f16 v[100:103], v[92:95], v[232:239], v25
 v_smfmac_f32_16x16x64_f16 v[104:107], v[92:95], v[240:247], v25
 v_smfmac_f32_16x16x64_f16 v[108:111], v[92:95], v[248:255], v25
 s_sleep 2
 buffer_load_dwordx2 v[58:59], v9, s[8:11], s81 offen sc1
 buffer_load_dwordx4 v[40:43], v8, s[8:11], s81 offen offset:0 sc1
 buffer_load_dwordx4 v[44:47], v8, s[8:11], s81 offen offset:1024 sc1
 s_cmp_lt_i32 s56, 0
 s_cbranch_scc1 kvw_75
kvok_76:
 s_waitcnt vmcnt(2)
 v_xor_b32 v76, s88, v58
 s_nop 0
 v_permlane16_swap_b32 v58, v59
 v_fma_mix_f32 v60, v58, 1.0, v59 op_sel:[0,0,0] op_sel_hi:[1,0,1]
 v_fma_mix_f32 v61, v58, 1.0, v59 op_sel:[1,0,1] op_sel_hi:[1,0,1]
 v_mov_b32 v58, v60
 v_mov_b32 v59, v61
 s_nop 0
 v_permlane32_swap_b32 v58, v60
 v_permlane32_swap_b32 v59, v61
 v_add_f32 v52, v58, v60
 v_add_f32 v53, v59, v61
 v_max_f32 v79, v52, v53
 s_waitcnt vmcnt(0)
 v_pk_add_f16 v80, v40, v44
 v_pk_add_f16 v82, v42, v46
 v_pk_add_f16 v81, v41, v45
 v_pk_add_f16 v83, v43, v47
 v_permlane32_swap_b32 v80, v82
 v_bitop3_b32 v77, v40, v42, s88 bitop3:0x7e
 v_permlane32_swap_b32 v81, v83
 v_bitop3_b32 v78, v44, v46, s88 bitop3:0x7e
 v_fma_mix_f32 v48, v80, 1.0, v82 op_sel:[0,0,0] op_sel_hi:[1,0,1]
 v_or3_b32 v27, v76, v77, v78
 v_fma_mix_f32 v49, v80, 1.0, v82 op_sel:[1,0,1] op_sel_hi:[1,0,1]
 v_and_b32 v27, 1, v27
 v_fma_mix_f32 v50, v81, 1.0, v83 op_sel:[0,0,0] op_sel_hi:[1,0,1]
 v_cmp_ne_u32 vcc, 0, v27
 v_fma_mix_f32 v51, v81, 1.0, v83 op_sel:[1,0,1] op_sel_hi:[1,0,1]
 v_max3_f32 v62, v48, v49, v79
 s_cbranch_vccnz psr_73
psj_74:
 v_max3_f32 v62, v62, v50, v51
 v_cvt_pk_bf16_f32 v146, v100, v101
 v_cvt_pk_bf16_f32 v147, v102, v103
 v_max_f32_dpp v62, v62, v62 row_ror:8 row_mask:0xf bank_mask:0xf
 v_mov_b32 v63, v62
 v_cvt_pk_bf16_f32 v148, v104, v105
 v_cvt_pk_bf16_f32 v149, v106, v107
 v_permlane32_swap_b32 v62, v63
 v_max_f32 v62, v62, v63
 v_mov_b32 v63, v62
 v_cvt_pk_bf16_f32 v150, v108, v109
 v_cvt_pk_bf16_f32 v151, v110, v111
 v_permlane16_swap_b32 v62, v63
 v_max_f32 v62, v62, v63
 v_mul_f32 v62, s86, v62
 v_fma_f32 v48, v48, s86, -v62
 v_fma_f32 v49, v49, s86, -v62
 v_fma_f32 v50, v50, s86, -v62
 v_fma_f32 v51, v51, s86, -v62
 v_fma_f32 v52, v52, s86, -v62
 v_fma_f32 v53, v53, s86, -v62
 v_exp_f32 v48, v48
 v_exp_f32 v49, v49
 buffer_load_dwordx4 v[88:91], v17, s[28:31], s64 offen offset:0 sc1
 v_exp_f32 v50, v50
 v_exp_f32 v51, v51
 buffer_load_dwordx4 v[92:95], v16, s[28:31], s64 offen offset:1024 sc1
 v_exp_f32 v52, v52
 v_exp_f32 v53, v53
 buffer_load_dwordx4 v[96:99], v20, s[28:31], s64 offen offset:2048 sc1
 v_cvt_pk_bf16_f32 v138, v48, v49
 v_cvt_pk_bf16_f32 v139, v50, v51
 v_cvt_pk_bf16_f32 v142, v52, v53
 v_mov_b32_dpp v140, v138 row_ror:8 row_mask:0xf bank_mask:0xf
 v_mov_b32_dpp v141, v139 row_ror:8 row_mask:0xf bank_mask:0xf
 v_mov_b32_dpp v143, v142 row_ror:8 row_mask:0xf bank_mask:0xf
 v_mov_b32 v84, s67
 v_mov_b32 v85, s67
 s_mov_b64 exec, 15
 buffer_store_dwordx2 v[84:85], v24, s[12:15], s66 offen sc1
 s_mov_b64 exec, -1
 v_add_f32 v54, v48, v49
 v_mfma_f32_16x16x32_bf16 v[64:67], v[126:129], v[138:141], 0
 v_add_f32 v55, v50, v51
 v_add_f32 v56, v52, v53
 v_mfma_f32_16x16x32_bf16 v[64:67], v[146:149], v[142:145], v[64:67]
 v_add_f32 v62, v54, v55
 v_fmac_f32 v62, v56, v26
 v_mfma_f32_16x16x32_bf16 v[68:71], v[130:133], v[138:141], 0
 s_nop 0
 v_add_f32_dpp v62, v62, v62 row_ror:8 row_mask:0xf bank_mask:0xf
 v_mfma_f32_16x16x32_bf16 v[68:71], v[148:151], v[142:145], v[68:71]
 v_mov_b32 v63, v62
 s_cmp_lt_i32 s55, 0
 s_cbranch_scc1 fl_77
fl_78:
 v_mfma_f32_16x16x32_bf16 v[72:75], v[134:137], v[138:141], 0
 v_permlane32_swap_b32 v62, v63
 v_mfma_f32_16x16x32_bf16 v[72:75], v[150:153], v[142:145], v[72:75]
 v_add_f32 v62, v62, v63
 v_mov_b32 v63, v62
 ds_write_b128 v11, v[64:67] offset:0
 s_nop 0
 v_permlane16_swap_b32 v62, v63
 v_add_f32 v62, v62, v63
 v_rcp_f32 v62, v62
 ds_write_b128 v11, v[68:71] offset:1024
 s_mov_b64 exec, 0xff
 ds_write_b32 v22, v62
 s_mov_b64 exec, -1
 ds_write_b128 v11, v[72:75] offset:2048
 s_waitcnt lgkmcnt(0)
 s_barrier
 s_and_b32 s21, s52, 7
 s_cmp_lg_u32 s21, s50
 s_cbranch_scc1 zm_79
 v_mov_b32 v64, 0
 v_mov_b32 v65, 0
 v_mov_b32 v66, 0
 v_mov_b32 v67, 0
 s_mov_b64 exec, s[70:71]
 buffer_store_dwordx4 v[64:67], v13, s[4:7], s83 offen sc1
 s_mov_b64 exec, -1
zm_79:
 v_mov_b32 v76, v108
 v_mov_b32 v77, v109
 v_mov_b32 v78, v110
 v_mov_b32 v79, v111
 v_permlane32_swap_b32 v100, v104
 v_permlane32_swap_b32 v101, v105
 v_permlane32_swap_b32 v102, v106
 v_permlane32_swap_b32 v103, v107
 v_permlane32_swap_b32 v108, v76
 v_permlane32_swap_b32 v109, v77
 v_permlane32_swap_b32 v110, v78
 v_permlane32_swap_b32 v111, v79
 v_pk_add_f32 v[100:101], v[100:101], v[104:105]
 v_pk_add_f32 v[102:103], v[102:103], v[106:107]
 v_pk_add_f32 v[108:109], v[108:109], v[76:77]
 v_pk_add_f32 v[110:111], v[110:111], v[78:79]
 v_cvt_pk_bf16_f32 v80, v100, v101
 v_cvt_pk_bf16_f32 v82, v108, v109
 v_cvt_pk_bf16_f32 v81, v102, v103
 v_cvt_pk_bf16_f32 v83, v110, v111
 s_nop 0
 v_permlane16_swap_b32 v80, v82
 v_permlane16_swap_b32 v81, v83
 v_min_u32 v80, -2, v80
 s_mov_b64 exec, s[76:77]
 buffer_store_dwordx4 v[80:83], v15, s[24:27], s57 offen sc1
 s_mov_b64 exec, -1
 s_add_u32 s64, s64, 1310720
 s_add_u32 s52, s52, 1
 s_branch step_66
fl_71:
 buffer_load_dword v0, off, s[12:15], s79 sc1
 s_branch fl_72
A1_16:
 v_smfmac_f32_16x16x32_f16 v[40:43], v[36:37], a[16:19], v25
 v_smfmac_f32_16x16x32_f16 v[52:55], v[36:37], a[76:79], v25
 v_smfmac_f32_16x16x32_f16 v[44:47], v[36:37], a[36:39], v25
 v_smfmac_f32_16x16x32_f16 v[56:59], v[36:37], a[96:99], v25
 s_branch A2_70
pm_69:
 buffer_load_dwordx4 v[36:39], v4, s[4:7], s84 offen offset:2048 sc1
 buffer_load_dwordx4 v[28:31], v4, s[4:7], s84 offen offset:0 sc1
 buffer_load_dwordx4 v[32:35], v4, s[4:7], s84 offen offset:1024 sc1
 s_nop 7
 v_mov_b32 v40, 0
 v_mov_b32 v41, 0
 v_mov_b32 v42, 0
 v_mov_b32 v43, 0
 v_mov_b32 v52, 0
 v_mov_b32 v53, 0
 v_mov_b32 v54, 0
 v_mov_b32 v55, 0
 v_mov_b32 v44, 0
 v_mov_b32 v45, 0
 v_mov_b32 v46, 0
 v_mov_b32 v47, 0
 v_mov_b32 v56, 0
 v_mov_b32 v57, 0
 v_mov_b32 v58, 0
 v_mov_b32 v59, 0
 s_waitcnt vmcnt(0)
 v_bitop3_b32 v27, v31, v35, v39 bitop3:0x80
 v_perm_b32 v31, v35, v31, s89
 v_cmp_gt_u32 vcc, 0x48000000, v27
 v_mov_b32 v35, v38
 s_cbranch_vccz A1_16
pm_68:
 s_cmp_gt_u32 s52, 3
 s_cbranch_scc1 op_80
 v_readfirstlane_b32 s21, v0
 s_cmp_ge_u32 s21, s46
 s_cbranch_scc1 op_80
 buffer_load_dword v0, off, s[12:15], s79 sc1
 s_waitcnt vmcnt(0)
 v_readfirstlane_b32 s21, v0
 s_cmp_gt_u32 s21, s52
 s_cselect_b32 s21, s87, 0
 s_cmp_eq_u32 s21, 0
 s_cbranch_scc1 op_80
 s_mov_b32 s87, 0
 s_sub_u32 s21, s64, 1310720
 buffer_load_dwordx4 v[126:129], v16, s[28:31], s21 offen offset:0 sc1
 buffer_load_dwordx4 v[130:133], v16, s[28:31], s21 offen offset:1024 sc1
 buffer_load_dwordx4 v[134:137], v16, s[28:31], s21 offen offset:2048 sc1
op_80:
 buffer_load_dwordx4 v[36:39], v4, s[4:7], s84 offen offset:2048 sc1
 buffer_load_dwordx4 v[28:31], v4, s[4:7], s84 offen offset:0 sc1
 buffer_load_dwordx4 v[32:35], v4, s[4:7], s84 offen offset:1024 sc1
 s_add_u32 s54, s54, 1
 s_cmp_gt_u32 s54, 131072
 s_cbranch_scc1 end0
 s_waitcnt vmcnt(0)
 v_bitop3_b32 v27, v31, v35, v39 bitop3:0x80
 v_perm_b32 v31, v35, v31, s89
 v_cmp_gt_u32 vcc, 0x48000000, v27
 v_mov_b32 v35, v38
 s_cbranch_vccnz pm_68
 s_branch A1_16
psr_73:
 buffer_load_dwordx2 v[58:59], v9, s[8:11], s81 offen sc1
 buffer_load_dwordx4 v[40:43], v8, s[8:11], s81 offen offset:0 sc1
 buffer_load_dwordx4 v[44:47], v8, s[8:11], s81 offen offset:1024 sc1
 s_add_u32 s54, s54, 1
 s_cmp_gt_u32 s54, 131072
 s_cbranch_scc1 end0
 s_waitcnt vmcnt(2)
 v_xor_b32 v76, s88, v58
 s_nop 0
 v_permlane16_swap_b32 v58, v59
 v_fma_mix_f32 v60, v58, 1.0, v59 op_sel:[0,0,0] op_sel_hi:[1,0,1]
 v_fma_mix_f32 v61, v58, 1.0, v59 op_sel:[1,0,1] op_sel_hi:[1,0,1]
 v_mov_b32 v58, v60
 v_mov_b32 v59, v61
 s_nop 0
 v_permlane32_swap_b32 v58, v60
 v_permlane32_swap_b32 v59, v61
 v_add_f32 v52, v58, v60
 v_add_f32 v53, v59, v61
 v_max_f32 v79, v52, v53
 s_waitcnt vmcnt(0)
 v_pk_add_f16 v80, v40, v44
 v_pk_add_f16 v82, v42, v46
 v_pk_add_f16 v81, v41, v45
 v_pk_add_f16 v83, v43, v47
 v_permlane32_swap_b32 v80, v82
 v_bitop3_b32 v77, v40, v42, s88 bitop3:0x7e
 v_permlane32_swap_b32 v81, v83
 v_bitop3_b32 v78, v44, v46, s88 bitop3:0x7e
 v_fma_mix_f32 v48, v80, 1.0, v82 op_sel:[0,0,0] op_sel_hi:[1,0,1]
 v_or3_b32 v27, v76, v77, v78
 v_fma_mix_f32 v49, v80, 1.0, v82 op_sel:[1,0,1] op_sel_hi:[1,0,1]
 v_and_b32 v27, 1, v27
 v_fma_mix_f32 v50, v81, 1.0, v83 op_sel:[0,0,0] op_sel_hi:[1,0,1]
 v_cmp_ne_u32 vcc, 0, v27
 v_fma_mix_f32 v51, v81, 1.0, v83 op_sel:[1,0,1] op_sel_hi:[1,0,1]
 v_max3_f32 v62, v48, v49, v79
 s_cbranch_vccnz psr_73
 s_branch psj_74
kvw_75:
 s_mov_b32 s22, s87
 s_cmp_eq_u32 s52, 0
 s_cselect_b32 s55, 0, s55
 s_cselect_b32 s87, 1, 0
 s_cbranch_scc1 kvok_76
 v_mov_b32 v62, 0
 s_mov_b32 s101, 0
wf_81:
 buffer_load_dword v63, v62, s[12:15], s79 offen sc1
 s_add_u32 s101, s101, 1
 s_cmp_gt_u32 s101, 131072
 s_cbranch_scc1 end0
 s_waitcnt vmcnt(0)
 v_readfirstlane_b32 s100, v63
 s_cmp_ge_u32 s100, s46
 s_cbranch_scc1 wf_82
 s_sleep 3
 s_branch wf_81
wf_82:
 s_cmp_eq_u32 s22, 0
 s_cbranch_scc1 kvok_76
 s_sub_u32 s21, s64, 1310720
 buffer_load_dwordx4 v[126:129], v16, s[28:31], s21 offen offset:0 sc1
 buffer_load_dwordx4 v[130:133], v16, s[28:31], s21 offen offset:1024 sc1
 buffer_load_dwordx4 v[134:137], v16, s[28:31], s21 offen offset:2048 sc1
 s_waitcnt vmcnt(0)
 s_branch kvok_76
fl_77:
 buffer_load_dword v0, off, s[12:15], s79 sc1
 s_branch fl_78
last_67:
 s_waitcnt lgkmcnt(10)
 v_smfmac_f32_16x16x64_f16 v[100:103], v[28:31], a[120:127], v25
 v_smfmac_f32_16x16x64_f16 v[104:107], v[28:31], a[128:135], v25
 v_smfmac_f32_16x16x64_f16 v[108:111], v[28:31], a[136:143], v25
 v_smfmac_f32_16x16x64_f16 v[100:103], v[32:35], a[144:151], v25
 v_smfmac_f32_16x16x64_f16 v[104:107], v[32:35], a[152:159], v25
 v_smfmac_f32_16x16x64_f16 v[108:111], v[32:35], a[160:167], v25
 s_waitcnt lgkmcnt(7)
 v_smfmac_f32_16x16x64_f16 v[100:103], v[64:67], a[168:175], v25
 v_smfmac_f32_16x16x64_f16 v[104:107], v[64:67], a[176:183], v25
 v_smfmac_f32_16x16x64_f16 v[108:111], v[64:67], a[184:191], v25
 v_smfmac_f32_16x16x64_f16 v[100:103], v[68:71], a[192:199], v25
 v_smfmac_f32_16x16x64_f16 v[104:107], v[68:71], a[200:207], v25
 v_smfmac_f32_16x16x64_f16 v[108:111], v[68:71], a[208:215], v25
 v_smfmac_f32_16x16x64_f16 v[100:103], v[72:75], a[216:223], v25
 v_smfmac_f32_16x16x64_f16 v[104:107], v[72:75], a[224:231], v25
 v_smfmac_f32_16x16x64_f16 v[108:111], v[72:75], a[232:239], v25
 s_waitcnt lgkmcnt(4)
 v_smfmac_f32_16x16x64_f16 v[100:103], v[76:79], a[240:247], v25
 v_smfmac_f32_16x16x64_f16 v[104:107], v[76:79], a[248:255], v25
 v_smfmac_f32_16x16x64_f16 v[108:111], v[76:79], v[152:159], v25
 v_smfmac_f32_16x16x64_f16 v[100:103], v[80:83], v[160:167], v25
 v_smfmac_f32_16x16x64_f16 v[104:107], v[80:83], v[168:175], v25
 v_smfmac_f32_16x16x64_f16 v[108:111], v[80:83], v[176:183], v25
 v_smfmac_f32_16x16x64_f16 v[100:103], v[84:87], v[184:191], v25
 v_smfmac_f32_16x16x64_f16 v[104:107], v[84:87], v[192:199], v25
 v_smfmac_f32_16x16x64_f16 v[108:111], v[84:87], v[200:207], v25
 s_waitcnt lgkmcnt(0)
 v_smfmac_f32_16x16x64_f16 v[100:103], v[88:91], v[208:215], v25
 v_smfmac_f32_16x16x64_f16 v[104:107], v[88:91], v[216:223], v25
 v_smfmac_f32_16x16x64_f16 v[108:111], v[88:91], v[224:231], v25
 v_smfmac_f32_16x16x64_f16 v[100:103], v[92:95], v[232:239], v25
 v_smfmac_f32_16x16x64_f16 v[104:107], v[92:95], v[240:247], v25
 v_smfmac_f32_16x16x64_f16 v[108:111], v[92:95], v[248:255], v25
 s_nop 7
 v_mov_b32 v76, v108
 v_mov_b32 v77, v109
 v_mov_b32 v78, v110
 v_mov_b32 v79, v111
 v_permlane32_swap_b32 v100, v104
 v_permlane32_swap_b32 v101, v105
 v_permlane32_swap_b32 v102, v106
 v_permlane32_swap_b32 v103, v107
 v_permlane32_swap_b32 v108, v76
 v_permlane32_swap_b32 v109, v77
 v_permlane32_swap_b32 v110, v78
 v_permlane32_swap_b32 v111, v79
 v_pk_add_f32 v[100:101], v[100:101], v[104:105]
 v_pk_add_f32 v[102:103], v[102:103], v[106:107]
 v_pk_add_f32 v[108:109], v[108:109], v[76:77]
 v_pk_add_f32 v[110:111], v[110:111], v[78:79]
 v_cvt_pk_bf16_f32 v80, v100, v101
 v_cvt_pk_bf16_f32 v82, v108, v109
 v_cvt_pk_bf16_f32 v81, v102, v103
 v_cvt_pk_bf16_f32 v83, v110, v111
 s_nop 0
 v_permlane16_swap_b32 v80, v82
 v_permlane16_swap_b32 v81, v83
 v_min_u32 v80, -2, v80
 s_mov_b64 exec, s[76:77]
 buffer_store_dwordx4 v[80:83], v15, s[24:27], s57 offen sc1
 s_mov_b64 exec, -1
 s_branch chain_done
step_83:
 s_and_b32 s21, s52, 3
 s_mul_i32 s81, s21, 540672
 s_lshl_b32 s84, s21, 15
 s_add_u32 s21, s52, 3
 s_and_b32 s21, s21, 3
 s_lshl_b32 s83, s21, 15
 s_add_u32 s21, s52, 1
 s_and_b32 s22, s21, 3
 s_lshl_b32 s3, s22, 15
 s_mul_i32 s80, s21, 393216
 s_add_u32 s46, s21, 1
 s_min_u32 s46, s46, 64
 s_mov_b32 s47, s57
 s_lshl_b32 s21, s52, 12
 s_and_b32 s21, s21, 8192
 s_xor_b32 s21, s21, s37
 s_lshl_b32 s22, s52, 20
 s_or_b32 s22, s22, s21
 s_cmp_ge_u32 s52, 36
 s_cselect_b32 s57, 8192, 0
 s_xor_b32 s57, s57, s22
 s_xor_b32 s85, s22, 8192
 s_bfe_u32 s88, s52, 0x10002
 s_max_u32 s67, s52, 1
 s_sub_u32 s67, s67, 1
 v_mov_b32 v40, 0
 v_mov_b32 v41, 0
 v_mov_b32 v42, 0
 v_mov_b32 v43, 0
 v_mov_b32 v44, 0
 v_mov_b32 v45, 0
 v_mov_b32 v46, 0
 v_mov_b32 v47, 0
 v_mov_b32 v48, 0
 v_mov_b32 v49, 0
 v_mov_b32 v50, 0
 v_mov_b32 v51, 0
 v_mov_b32 v52, 0
 v_mov_b32 v53, 0
 v_mov_b32 v54, 0
 v_mov_b32 v55, 0
 v_mov_b32 v56, 0
 v_mov_b32 v57, 0
 v_mov_b32 v58, 0
 v_mov_b32 v59, 0
 v_mov_b32 v60, 0
 v_mov_b32 v61, 0
 v_mov_b32 v62, 0
 v_mov_b32 v63, 0
 v_mov_b32 v100, 0
 v_mov_b32 v101, 0
 v_mov_b32 v102, 0
 v_mov_b32 v103, 0
 v_mov_b32 v104, 0
 v_mov_b32 v105, 0
 v_mov_b32 v106, 0
 v_mov_b32 v107, 0
 v_mov_b32 v108, 0
 v_mov_b32 v109, 0
 v_mov_b32 v110, 0
 v_mov_b32 v111, 0
 s_sleep 8
 v_readfirstlane_b32 s21, v0
 s_cmp_lt_u32 s21, s46
 s_cselect_b32 s55, s55, 0
 s_cmp_lt_i32 s55, 0
 s_cbranch_scc1 fl_88
fl_89:
 s_mov_b32 s54, 0
 buffer_load_dwordx4 v[36:39], v4, s[4:7], s84 offen offset:2048 sc1
 buffer_load_dwordx4 v[28:31], v4, s[4:7], s84 offen offset:0 sc1
 buffer_load_dwordx4 v[32:35], v4, s[4:7], s84 offen offset:1024 sc1
 s_waitcnt vmcnt(3)
 v_mov_b32 v126, v88
 v_mov_b32 v127, v89
 v_mov_b32 v128, v90
 v_mov_b32 v129, v91
 v_mov_b32 v130, v92
 v_mov_b32 v131, v93
 v_mov_b32 v132, v94
 v_mov_b32 v133, v95
 v_mov_b32 v134, v96
 v_mov_b32 v135, v97
 v_mov_b32 v136, v98
 v_mov_b32 v137, v99
 s_waitcnt vmcnt(2)
 v_smfmac_f32_16x16x32_f16 v[40:43], v[36:37], a[16:19], v25
 v_smfmac_f32_16x16x32_f16 v[52:55], v[36:37], a[76:79], v25
 v_smfmac_f32_16x16x32_f16 v[44:47], v[36:37], a[36:39], v25
 s_waitcnt vmcnt(0)
 v_bitop3_b32 v27, v31, v35, v39 bitop3:0x80
 v_perm_b32 v31, v35, v31, s89
 v_cmp_gt_u32 vcc, 0x48000000, v27
 v_mov_b32 v35, v38
 v_smfmac_f32_16x16x32_f16 v[56:59], v[36:37], a[96:99], v25
 s_cbranch_vccnz pm_86
A2_87:
 v_smfmac_f32_16x16x64_f16 v[40:43], v[28:31], a[0:7], v25
 ds_write_b128 v10, v[28:31]
 v_smfmac_f32_16x16x64_f16 v[40:43], v[32:35], a[8:15], v25
 ds_write_b128 v10, v[32:35] offset:1024
 v_smfmac_f32_16x16x64_f16 v[52:55], v[28:31], a[60:67], v25
 ds_write_b64 v10, v[36:37] offset:2048
 v_smfmac_f32_16x16x64_f16 v[52:55], v[32:35], a[68:75], v25
 v_cvt_pk_f16_f32 v40, v40, v41
 v_cvt_pk_f16_f32 v41, v42, v43
 v_smfmac_f32_16x16x32_f16 v[48:51], v[36:37], a[56:59], v25
 v_smfmac_f32_16x16x32_f16 v[60:63], v[36:37], a[116:119], v25
 v_smfmac_f32_16x16x64_f16 v[44:47], v[28:31], a[20:27], v25
 v_cvt_pk_f16_f32 v52, v52, v53
 v_cvt_pk_f16_f32 v53, v54, v55
 s_nop 0
 v_smfmac_f32_16x16x64_f16 v[44:47], v[32:35], a[28:35], v25
 v_permlane32_swap_b32 v40, v52
 v_smfmac_f32_16x16x64_f16 v[56:59], v[28:31], a[80:87], v25
 v_permlane32_swap_b32 v41, v53
 v_pk_add_f16 v40, v40, v52
 v_smfmac_f32_16x16x64_f16 v[56:59], v[32:35], a[88:95], v25
 v_pk_add_f16 v41, v41, v53
 v_smfmac_f32_16x16x64_f16 v[48:51], v[28:31], a[40:47], v25
 ds_write_b64 v5, v[40:41] offset:0
 v_smfmac_f32_16x16x64_f16 v[48:51], v[32:35], a[48:55], v25
 v_cvt_pk_f16_f32 v44, v44, v45
 v_cvt_pk_f16_f32 v45, v46, v47
 v_cvt_pk_f16_f32 v56, v56, v57
 v_smfmac_f32_16x16x64_f16 v[60:63], v[28:31], a[100:107], v25
 v_cvt_pk_f16_f32 v57, v58, v59
 s_nop 0
 v_smfmac_f32_16x16x64_f16 v[60:63], v[32:35], a[108:115], v25
 v_permlane32_swap_b32 v44, v56
 v_permlane32_swap_b32 v45, v57
 v_pk_add_f16 v44, v44, v56
 v_pk_add_f16 v45, v45, v57
 ds_write_b64 v5, v[44:45] offset:640
 v_cvt_pk_f16_f32 v48, v48, v49
 v_cvt_pk_f16_f32 v49, v50, v51
 v_cvt_pk_f16_f32 v60, v60, v61
 v_cvt_pk_f16_f32 v61, v62, v63
 s_nop 0
 v_permlane32_swap_b32 v48, v60
 v_permlane32_swap_b32 v49, v61
 v_pk_add_f16 v48, v48, v60
 v_pk_add_f16 v49, v49, v61
 ds_write_b64 v5, v[48:49] offset:1280
 s_waitcnt lgkmcnt(0) vmcnt(0)
 s_barrier
 s_lshr_b32 s21, 3, s20
 s_bitcmp1_b32 s21, 0
 s_cbranch_scc0 bw_91
 ds_read_b64_tr_b16 v[40:41], v21 offset:0
 ds_read_b64_tr_b16 v[42:43], v21 offset:1920
 ds_read_b64_tr_b16 v[44:45], v21 offset:640
 ds_read_b64_tr_b16 v[46:47], v21 offset:2560
 ds_read_b64_tr_b16 v[48:49], v21 offset:1280
 ds_read_b64_tr_b16 v[50:51], v21 offset:3200
 s_waitcnt lgkmcnt(4)
 v_fma_mix_f32 v52, v40, 1.0, v42 op_sel:[0,0,0] op_sel_hi:[1,0,1]
 v_fma_mix_f32 v53, v40, 1.0, v42 op_sel:[1,0,1] op_sel_hi:[1,0,1]
 v_fma_mix_f32 v54, v41, 1.0, v43 op_sel:[0,0,0] op_sel_hi:[1,0,1]
 v_fma_mix_f32 v55, v41, 1.0, v43 op_sel:[1,0,1] op_sel_hi:[1,0,1]
 v_add_f32_dpp v56, v52, v52 row_ror:8 row_mask:0xf bank_mask:0xf
 v_add_f32_dpp v57, v53, v53 row_ror:8 row_mask:0xf bank_mask:0xf
 v_add_f32_dpp v58, v54, v54 row_ror:8 row_mask:0xf bank_mask:0xf
 v_add_f32_dpp v59, v55, v55 row_ror:8 row_mask:0xf bank_mask:0xf
 v_cvt_pk_bf16_f32 v118, v56, v57
 v_cvt_pk_bf16_f32 v119, v58, v59
 s_waitcnt lgkmcnt(2)
 v_fma_mix_f32 v52, v44, 1.0, v46 op_sel:[0,0,0] op_sel_hi:[1,0,1]
 v_fma_mix_f32 v53, v44, 1.0, v46 op_sel:[1,0,1] op_sel_hi:[1,0,1]
 v_fma_mix_f32 v54, v45, 1.0, v47 op_sel:[0,0,0] op_sel_hi:[1,0,1]
 v_fma_mix_f32 v55, v45, 1.0, v47 op_sel:[1,0,1] op_sel_hi:[1,0,1]
 v_add_f32_dpp v56, v52, v52 row_ror:8 row_mask:0xf bank_mask:0xf
 v_add_f32_dpp v57, v53, v53 row_ror:8 row_mask:0xf bank_mask:0xf
 v_add_f32_dpp v58, v54, v54 row_ror:8 row_mask:0xf bank_mask:0xf
 v_add_f32_dpp v59, v55, v55 row_ror:8 row_mask:0xf bank_mask:0xf
 v_cvt_pk_bf16_f32 v120, v56, v57
 v_cvt_pk_bf16_f32 v121, v58, v59
 s_waitcnt lgkmcnt(0)
 v_fma_mix_f32 v52, v48, 1.0, v50 op_sel:[0,0,0] op_sel_hi:[1,0,1]
 v_fma_mix_f32 v53, v48, 1.0, v50 op_sel:[1,0,1] op_sel_hi:[1,0,1]
 v_fma_mix_f32 v54, v49, 1.0, v51 op_sel:[0,0,0] op_sel_hi:[1,0,1]
 v_fma_mix_f32 v55, v49, 1.0, v51 op_sel:[1,0,1] op_sel_hi:[1,0,1]
 v_mfma_f32_16x16x32_bf16 v[40:43], v[112:115], v[118:121], 0
 v_add_f32_dpp v56, v52, v52 row_ror:8 row_mask:0xf bank_mask:0xf
 v_add_f32_dpp v57, v53, v53 row_ror:8 row_mask:0xf bank_mask:0xf
 v_add_f32_dpp v58, v54, v54 row_ror:8 row_mask:0xf bank_mask:0xf
 v_add_f32_dpp v59, v55, v55 row_ror:8 row_mask:0xf bank_mask:0xf
 v_cvt_pk_bf16_f32 v122, v56, v57
 v_cvt_pk_bf16_f32 v123, v58, v59
 s_nop 1
 v_mfma_f32_16x16x32_bf16 v[40:43], v[116:119], v[122:125], v[40:43]
 ds_read_b128 v[28:31], v16 offset:24576
 ds_read_b128 v[32:35], v16 offset:25600
 ds_read_b128 v[64:67], v16 offset:27648
 ds_read_b128 v[68:71], v16 offset:28672
 ds_read_b128 v[72:75], v16 offset:30720
 ds_read_b128 v[76:79], v16 offset:31744
 s_nop 0
 s_mov_b64 exec, s[74:75]
 v_cvt_pk_f16_f32 v44, v40, v41
 v_cvt_pk_f16_f32 v45, v42, v43
 v_and_or_b32 v44, v44, -2, s88
 s_cmp_eq_u32 s53, 1
 s_cbranch_scc1 si_92
 buffer_store_dwordx2 v[44:45], v7, s[8:11], s81 offen sc1
 s_branch si_93
si_92:
 buffer_store_dwordx2 v[44:45], v7, s[8:11], s81 offen
si_93:
 s_mov_b64 exec, -1
 s_branch bw_90
bw_91:
 s_lshr_b32 s21, 4, s20
 s_bitcmp1_b32 s21, 0
 s_cbranch_scc0 bw_94
 ds_read_b64_tr_b16 v[40:41], v6 offset:0
 ds_read_b64_tr_b16 v[42:43], v6 offset:1920
 ds_read_b64_tr_b16 v[44:45], v6 offset:3840
 ds_read_b64_tr_b16 v[46:47], v6 offset:5760
 ds_read_b64_tr_b16 v[48:49], v6 offset:640
 ds_read_b64_tr_b16 v[50:51], v6 offset:2560
 ds_read_b64_tr_b16 v[52:53], v6 offset:4480
 ds_read_b64_tr_b16 v[54:55], v6 offset:6400
 ds_read_b64_tr_b16 v[56:57], v6 offset:1280
 ds_read_b64_tr_b16 v[58:59], v6 offset:3200
 ds_read_b64_tr_b16 v[60:61], v6 offset:5120
 ds_read_b64_tr_b16 v[62:63], v6 offset:7040
 s_waitcnt lgkmcnt(8)
 v_pk_add_f16 v40, v40, v42
 v_pk_add_f16 v44, v44, v46
 v_pk_add_f16 v41, v41, v43
 v_pk_add_f16 v45, v45, v47
 v_fma_mix_f32 v146, v40, 1.0, v44 op_sel:[0,0,0] op_sel_hi:[1,0,1]
 v_fma_mix_f32 v147, v40, 1.0, v44 op_sel:[1,0,1] op_sel_hi:[1,0,1]
 v_fma_mix_f32 v148, v41, 1.0, v45 op_sel:[0,0,0] op_sel_hi:[1,0,1]
 v_fma_mix_f32 v149, v41, 1.0, v45 op_sel:[1,0,1] op_sel_hi:[1,0,1]
 v_cvt_pk_bf16_f32 v118, v146, v147
 v_cvt_pk_bf16_f32 v119, v148, v149
 s_waitcnt lgkmcnt(4)
 v_pk_add_f16 v48, v48, v50
 v_pk_add_f16 v52, v52, v54
 v_pk_add_f16 v49, v49, v51
 v_pk_add_f16 v53, v53, v55
 v_fma_mix_f32 v146, v48, 1.0, v52 op_sel:[0,0,0] op_sel_hi:[1,0,1]
 v_fma_mix_f32 v147, v48, 1.0, v52 op_sel:[1,0,1] op_sel_hi:[1,0,1]
 v_fma_mix_f32 v148, v49, 1.0, v53 op_sel:[0,0,0] op_sel_hi:[1,0,1]
 v_fma_mix_f32 v149, v49, 1.0, v53 op_sel:[1,0,1] op_sel_hi:[1,0,1]
 v_cvt_pk_bf16_f32 v120, v146, v147
 v_cvt_pk_bf16_f32 v121, v148, v149
 s_waitcnt lgkmcnt(0)
 v_pk_add_f16 v56, v56, v58
 v_pk_add_f16 v60, v60, v62
 v_pk_add_f16 v57, v57, v59
 v_pk_add_f16 v61, v61, v63
 v_fma_mix_f32 v146, v56, 1.0, v60 op_sel:[0,0,0] op_sel_hi:[1,0,1]
 v_fma_mix_f32 v147, v56, 1.0, v60 op_sel:[1,0,1] op_sel_hi:[1,0,1]
 v_mfma_f32_16x16x32_bf16 v[40:43], v[118:121], v[118:121], 0
 v_fma_mix_f32 v148, v57, 1.0, v61 op_sel:[0,0,0] op_sel_hi:[1,0,1]
 v_fma_mix_f32 v149, v57, 1.0, v61 op_sel:[1,0,1] op_sel_hi:[1,0,1]
 v_cvt_pk_bf16_f32 v122, v146, v147
 v_cvt_pk_bf16_f32 v123, v148, v149
 s_nop 1
 v_mfma_f32_16x16x32_bf16 v[40:43], v[122:125], v[122:125], v[40:43]
 ds_read_b128 v[28:31], v16 offset:24576
 ds_read_b128 v[32:35], v16 offset:25600
 ds_read_b128 v[64:67], v16 offset:27648
 ds_read_b128 v[68:71], v16 offset:28672
 ds_read_b128 v[72:75], v16 offset:30720
 ds_read_b128 v[76:79], v16 offset:31744
 s_nop 0
 s_mov_b64 exec, s[74:75]
 v_cvt_pk_f16_f32 v44, v40, v41
 v_cvt_pk_f16_f32 v45, v42, v43
 v_and_or_b32 v44, v44, -2, s88
 s_cmp_eq_u32 s53, 1
 s_cbranch_scc1 si_95
 buffer_store_dwordx2 v[44:45], v7, s[8:11], s81 offen sc1
 s_branch si_96
si_95:
 buffer_store_dwordx2 v[44:45], v7, s[8:11], s81 offen
si_96:
 s_mov_b64 exec, -1
 s_branch bw_90
bw_94:
 s_lshr_b32 s21, 8, s20
 s_bitcmp1_b32 s21, 0
 s_cbranch_scc0 bw_97
 ds_read_b128 v[28:31], v16 offset:24576
 ds_read_b128 v[32:35], v16 offset:25600
 ds_read_b128 v[64:67], v16 offset:27648
 ds_read_b128 v[68:71], v16 offset:28672
 ds_read_b128 v[72:75], v16 offset:30720
 ds_read_b128 v[76:79], v16 offset:31744
 s_branch bw_90
bw_97:
bw_90:
 ds_read_b128 v[80:83], v16 offset:33792
 ds_read_b128 v[84:87], v16 offset:34816
 ds_read_b64 v[88:89], v16 offset:26624
 ds_read_b64 v[90:91], v16 offset:29696
 ds_read_b64 v[92:93], v16 offset:32768
 ds_read_b64 v[94:95], v16 offset:35840
 s_cmp_eq_u32 s52, 63
 s_cbranch_scc1 last_84
 s_waitcnt lgkmcnt(10)
 v_smfmac_f32_16x16x64_f16 v[100:103], v[28:31], a[120:127], v25
 v_smfmac_f32_16x16x64_f16 v[104:107], v[28:31], a[128:135], v25
 v_smfmac_f32_16x16x64_f16 v[108:111], v[28:31], a[136:143], v25
 s_mov_b32 s54, 0
 v_smfmac_f32_16x16x64_f16 v[100:103], v[32:35], a[144:151], v25
 v_readfirstlane_b32 s21, v0
 v_smfmac_f32_16x16x64_f16 v[104:107], v[32:35], a[152:159], v25
 s_add_u32 s22, s46, 3
 v_smfmac_f32_16x16x64_f16 v[108:111], v[32:35], a[160:167], v25
 s_min_u32 s22, s22, 64
 s_waitcnt lgkmcnt(7)
 v_smfmac_f32_16x16x64_f16 v[100:103], v[64:67], a[168:175], v25
 s_sub_u32 s55, s21, s22
 v_smfmac_f32_16x16x64_f16 v[104:107], v[64:67], a[176:183], v25
 s_sub_u32 s56, s21, s46
 v_smfmac_f32_16x16x64_f16 v[108:111], v[64:67], a[184:191], v25
 v_smfmac_f32_16x16x64_f16 v[100:103], v[68:71], a[192:199], v25
 v_smfmac_f32_16x16x64_f16 v[104:107], v[68:71], a[200:207], v25
 v_smfmac_f32_16x16x64_f16 v[108:111], v[68:71], a[208:215], v25
 v_smfmac_f32_16x16x64_f16 v[100:103], v[72:75], a[216:223], v25
 v_smfmac_f32_16x16x64_f16 v[104:107], v[72:75], a[224:231], v25
 v_smfmac_f32_16x16x64_f16 v[108:111], v[72:75], a[232:239], v25
 s_waitcnt lgkmcnt(4)
 v_smfmac_f32_16x16x64_f16 v[100:103], v[76:79], a[240:247], v25
 v_smfmac_f32_16x16x64_f16 v[104:107], v[76:79], a[248:255], v25
 v_smfmac_f32_16x16x64_f16 v[108:111], v[76:79], v[152:159], v25
 v_smfmac_f32_16x16x64_f16 v[100:103], v[80:83], v[160:167], v25
 v_smfmac_f32_16x16x64_f16 v[104:107], v[80:83], v[168:175], v25
 v_smfmac_f32_16x16x64_f16 v[108:111], v[80:83], v[176:183], v25
 v_smfmac_f32_16x16x64_f16 v[100:103], v[84:87], v[184:191], v25
 v_smfmac_f32_16x16x64_f16 v[104:107], v[84:87], v[192:199], v25
 v_smfmac_f32_16x16x64_f16 v[108:111], v[84:87], v[200:207], v25
 s_waitcnt lgkmcnt(0)
 v_smfmac_f32_16x16x64_f16 v[100:103], v[88:91], v[208:215], v25
 v_smfmac_f32_16x16x64_f16 v[104:107], v[88:91], v[216:223], v25
 v_smfmac_f32_16x16x64_f16 v[108:111], v[88:91], v[224:231], v25
 v_smfmac_f32_16x16x64_f16 v[100:103], v[92:95], v[232:239], v25
 v_smfmac_f32_16x16x64_f16 v[104:107], v[92:95], v[240:247], v25
 v_smfmac_f32_16x16x64_f16 v[108:111], v[92:95], v[248:255], v25
 buffer_load_dwordx2 v[58:59], v9, s[8:11], s81 offen sc1
 buffer_load_dwordx4 v[40:43], v8, s[8:11], s81 offen offset:0 sc1
 buffer_load_dwordx4 v[44:47], v8, s[8:11], s81 offen offset:1024 sc1
 s_cmp_lt_i32 s56, 0
 s_cbranch_scc1 kvw_100
kvok_101:
 s_waitcnt vmcnt(2)
 v_xor_b32 v76, s88, v58
 s_nop 0
 v_permlane16_swap_b32 v58, v59
 v_fma_mix_f32 v60, v58, 1.0, v59 op_sel:[0,0,0] op_sel_hi:[1,0,1]
 v_fma_mix_f32 v61, v58, 1.0, v59 op_sel:[1,0,1] op_sel_hi:[1,0,1]
 v_mov_b32 v58, v60
 v_mov_b32 v59, v61
 s_nop 0
 v_permlane32_swap_b32 v58, v60
 v_permlane32_swap_b32 v59, v61
 v_add_f32 v52, v58, v60
 v_add_f32 v53, v59, v61
 v_max_f32 v79, v52, v53
 s_waitcnt vmcnt(0)
 v_pk_add_f16 v80, v40, v44
 v_pk_add_f16 v82, v42, v46
 v_pk_add_f16 v81, v41, v45
 v_pk_add_f16 v83, v43, v47
 v_permlane32_swap_b32 v80, v82
 v_bitop3_b32 v77, v40, v42, s88 bitop3:0x7e
 v_permlane32_swap_b32 v81, v83
 v_bitop3_b32 v78, v44, v46, s88 bitop3:0x7e
 v_fma_mix_f32 v48, v80, 1.0, v82 op_sel:[0,0,0] op_sel_hi:[1,0,1]
 v_or3_b32 v27, v76, v77, v78
 v_fma_mix_f32 v49, v80, 1.0, v82 op_sel:[1,0,1] op_sel_hi:[1,0,1]
 v_and_b32 v27, 1, v27
 v_fma_mix_f32 v50, v81, 1.0, v83 op_sel:[0,0,0] op_sel_hi:[1,0,1]
 v_cmp_ne_u32 vcc, 0, v27
 v_fma_mix_f32 v51, v81, 1.0, v83 op_sel:[1,0,1] op_sel_hi:[1,0,1]
 v_max3_f32 v62, v48, v49, v79
 s_cbranch_vccnz psr_98
psj_99:
 v_max3_f32 v62, v62, v50, v51
 v_cvt_pk_bf16_f32 v146, v100, v101
 v_cvt_pk_bf16_f32 v147, v102, v103
 v_max_f32_dpp v62, v62, v62 row_ror:8 row_mask:0xf bank_mask:0xf
 v_mov_b32 v63, v62
 v_cvt_pk_bf16_f32 v148, v104, v105
 v_cvt_pk_bf16_f32 v149, v106, v107
 v_permlane32_swap_b32 v62, v63
 v_max_f32 v62, v62, v63
 v_mov_b32 v63, v62
 v_cvt_pk_bf16_f32 v150, v108, v109
 v_cvt_pk_bf16_f32 v151, v110, v111
 v_permlane16_swap_b32 v62, v63
 v_max_f32 v62, v62, v63
 v_mul_f32 v62, s86, v62
 v_fma_f32 v48, v48, s86, -v62
 v_fma_f32 v49, v49, s86, -v62
 v_fma_f32 v50, v50, s86, -v62
 v_fma_f32 v51, v51, s86, -v62
 v_fma_f32 v52, v52, s86, -v62
 v_fma_f32 v53, v53, s86, -v62
 v_exp_f32 v48, v48
 v_exp_f32 v49, v49
 buffer_load_dwordx4 v[88:91], v17, s[28:31], s64 offen offset:0 sc1
 v_exp_f32 v50, v50
 v_exp_f32 v51, v51
 buffer_load_dwordx4 v[92:95], v16, s[28:31], s64 offen offset:1024 sc1
 v_exp_f32 v52, v52
 v_exp_f32 v53, v53
 buffer_load_dwordx4 v[96:99], v20, s[28:31], s64 offen offset:2048 sc1
 v_cvt_pk_bf16_f32 v138, v48, v49
 v_cvt_pk_bf16_f32 v139, v50, v51
 v_cvt_pk_bf16_f32 v142, v52, v53
 v_mov_b32_dpp v140, v138 row_ror:8 row_mask:0xf bank_mask:0xf
 v_mov_b32_dpp v141, v139 row_ror:8 row_mask:0xf bank_mask:0xf
 v_mov_b32_dpp v143, v142 row_ror:8 row_mask:0xf bank_mask:0xf
 s_lshr_b32 s21, 3, s20
 s_bitcmp1_b32 s21, 0
 s_cbranch_scc0 bw_103
 buffer_load_dwordx4 v[112:115], v18, s[16:19], s80 offen sc1
 s_branch bw_102
bw_103:
 s_lshr_b32 s21, 8, s20
 s_bitcmp1_b32 s21, 0
 s_cbranch_scc0 bw_104
 v_mov_b32 v84, s67
 v_mov_b32 v85, s67
 s_mov_b64 exec, 15
 buffer_store_dwordx2 v[84:85], v24, s[12:15], s66 offen sc1
 s_mov_b64 exec, -1
 s_branch bw_102
bw_104:
bw_102:
 v_add_f32 v54, v48, v49
 v_mfma_f32_16x16x32_bf16 v[64:67], v[126:129], v[138:141], 0
 v_add_f32 v55, v50, v51
 v_add_f32 v56, v52, v53
 v_mfma_f32_16x16x32_bf16 v[64:67], v[146:149], v[142:145], v[64:67]
 v_add_f32 v62, v54, v55
 v_fmac_f32 v62, v56, v26
 v_mfma_f32_16x16x32_bf16 v[68:71], v[130:133], v[138:141], 0
 s_lshr_b32 s21, 3, s20
 s_bitcmp1_b32 s21, 0
 s_cbranch_scc0 bw_106
 buffer_load_dwordx2 v[116:117], v19, s[16:19], s80 offen sc1
 s_branch bw_105
bw_106:
bw_105:
 v_add_f32_dpp v62, v62, v62 row_ror:8 row_mask:0xf bank_mask:0xf
 v_mfma_f32_16x16x32_bf16 v[68:71], v[148:151], v[142:145], v[68:71]
 v_mov_b32 v63, v62
 s_cmp_lt_i32 s55, 0
 s_cbranch_scc1 fl_107
fl_108:
 v_mfma_f32_16x16x32_bf16 v[72:75], v[134:137], v[138:141], 0
 v_permlane32_swap_b32 v62, v63
 v_mfma_f32_16x16x32_bf16 v[72:75], v[150:153], v[142:145], v[72:75]
 v_add_f32 v62, v62, v63
 v_mov_b32 v63, v62
 ds_write_b128 v11, v[64:67] offset:0
 s_nop 0
 v_permlane16_swap_b32 v62, v63
 v_add_f32 v62, v62, v63
 v_rcp_f32 v62, v62
 ds_write_b128 v11, v[68:71] offset:1024
 s_mov_b64 exec, 0xff
 ds_write_b32 v22, v62
 s_mov_b64 exec, -1
 ds_write_b128 v11, v[72:75] offset:2048
 s_waitcnt lgkmcnt(0)
 s_barrier
 s_lshr_b32 s21, 7, s20
 s_bitcmp1_b32 s21, 0
 s_cbranch_scc0 bw_110
 ds_read_b128 v[72:75], v23
 ds_read_b64 v[64:65], v12 offset:0
 ds_read_b64 v[66:67], v12 offset:3072
 ds_read_b64 v[68:69], v12 offset:6144
 ds_read_b64 v[70:71], v12 offset:9216
 s_waitcnt lgkmcnt(2)
 v_pk_mul_f32 v[64:65], v[64:65], v[72:73] op_sel_hi:[1,0]
 v_pk_fma_f32 v[64:65], v[66:67], v[72:73], v[64:65] op_sel:[0,1,0] op_sel_hi:[1,1,1]
 s_waitcnt lgkmcnt(0)
 v_pk_fma_f32 v[64:65], v[68:69], v[74:75], v[64:65] op_sel_hi:[1,0,1]
 v_pk_fma_f32 v[64:65], v[70:71], v[74:75], v[64:65] op_sel:[0,1,0] op_sel_hi:[1,1,1]
 v_cvt_pk_f16_f32 v68, v64, v65
 v_perm_b32 v68, s91, v68, v14
 buffer_atomic_pk_add_f16 v68, v13, s[4:7], s3 offen
 s_branch bw_109
bw_110:
 s_lshr_b32 s21, 8, s20
 s_bitcmp1_b32 s21, 0
 s_cbranch_scc0 bw_111
 s_and_b32 s21, s52, 7
 s_cmp_lg_u32 s21, s50
 s_cbranch_scc1 zm_112
 v_mov_b32 v64, 0
 v_mov_b32 v65, 0
 v_mov_b32 v66, 0
 v_mov_b32 v67, 0
 s_mov_b64 exec, s[70:71]
 buffer_store_dwordx4 v[64:67], v13, s[4:7], s83 offen sc1
 s_mov_b64 exec, -1
zm_112:
 s_branch bw_109
bw_111:
bw_109:
 s_lshr_b32 s21, 4, s20
 s_bitcmp1_b32 s21, 0
 s_cbranch_scc0 bw_114
 s_mov_b64 exec, s[62:63]
 buffer_store_dwordx4 v[118:121], v18, s[24:27], s85 offen sc1
 buffer_store_dwordx2 v[122:123], v19, s[24:27], s85 offen sc1
 s_mov_b64 exec, -1
 s_branch bw_113
bw_114:
bw_113:
 v_mov_b32 v76, v108
 v_mov_b32 v77, v109
 v_mov_b32 v78, v110
 v_mov_b32 v79, v111
 v_permlane32_swap_b32 v100, v104
 v_permlane32_swap_b32 v101, v105
 v_permlane32_swap_b32 v102, v106
 v_permlane32_swap_b32 v103, v107
 v_permlane32_swap_b32 v108, v76
 v_permlane32_swap_b32 v109, v77
 v_permlane32_swap_b32 v110, v78
 v_permlane32_swap_b32 v111, v79
 v_pk_add_f32 v[100:101], v[100:101], v[104:105]
 v_pk_add_f32 v[102:103], v[102:103], v[106:107]
 v_pk_add_f32 v[108:109], v[108:109], v[76:77]
 v_pk_add_f32 v[110:111], v[110:111], v[78:79]
 v_cvt_pk_bf16_f32 v80, v100, v101
 v_cvt_pk_bf16_f32 v82, v108, v109
 v_cvt_pk_bf16_f32 v81, v102, v103
 v_cvt_pk_bf16_f32 v83, v110, v111
 s_nop 0
 v_permlane16_swap_b32 v80, v82
 v_permlane16_swap_b32 v81, v83
 v_min_u32 v80, -2, v80
 s_mov_b64 exec, s[76:77]
 buffer_store_dwordx4 v[80:83], v15, s[24:27], s57 offen sc1
 s_mov_b64 exec, -1
 s_add_u32 s64, s64, 1310720
 s_add_u32 s52, s52, 1
 s_branch step_83
fl_88:
 buffer_load_dword v0, off, s[12:15], s79 sc1
 s_branch fl_89
A1_17:
 v_smfmac_f32_16x16x32_f16 v[40:43], v[36:37], a[16:19], v25
 v_smfmac_f32_16x16x32_f16 v[52:55], v[36:37], a[76:79], v25
 v_smfmac_f32_16x16x32_f16 v[44:47], v[36:37], a[36:39], v25
 v_smfmac_f32_16x16x32_f16 v[56:59], v[36:37], a[96:99], v25
 s_branch A2_87
pm_86:
 buffer_load_dwordx4 v[36:39], v4, s[4:7], s84 offen offset:2048 sc1
 buffer_load_dwordx4 v[28:31], v4, s[4:7], s84 offen offset:0 sc1
 buffer_load_dwordx4 v[32:35], v4, s[4:7], s84 offen offset:1024 sc1
 s_nop 7
 v_mov_b32 v40, 0
 v_mov_b32 v41, 0
 v_mov_b32 v42, 0
 v_mov_b32 v43, 0
 v_mov_b32 v52, 0
 v_mov_b32 v53, 0
 v_mov_b32 v54, 0
 v_mov_b32 v55, 0
 v_mov_b32 v44, 0
 v_mov_b32 v45, 0
 v_mov_b32 v46, 0
 v_mov_b32 v47, 0
 v_mov_b32 v56, 0
 v_mov_b32 v57, 0
 v_mov_b32 v58, 0
 v_mov_b32 v59, 0
 s_waitcnt vmcnt(0)
 v_bitop3_b32 v27, v31, v35, v39 bitop3:0x80
 v_perm_b32 v31, v35, v31, s89
 v_cmp_gt_u32 vcc, 0x48000000, v27
 v_mov_b32 v35, v38
 s_cbranch_vccz A1_17
pm_85:
 s_cmp_gt_u32 s52, 3
 s_cbranch_scc1 op_115
 v_readfirstlane_b32 s21, v0
 s_cmp_ge_u32 s21, s46
 s_cbranch_scc1 op_115
 buffer_load_dword v0, off, s[12:15], s79 sc1
 s_waitcnt vmcnt(0)
 v_readfirstlane_b32 s21, v0
 s_cmp_gt_u32 s21, s52
 s_cselect_b32 s21, s87, 0
 s_cmp_eq_u32 s21, 0
 s_cbranch_scc1 op_115
 s_mov_b32 s87, 0
 s_sub_u32 s21, s64, 1310720
 buffer_load_dwordx4 v[126:129], v16, s[28:31], s21 offen offset:0 sc1
 buffer_load_dwordx4 v[130:133], v16, s[28:31], s21 offen offset:1024 sc1
 buffer_load_dwordx4 v[134:137], v16, s[28:31], s21 offen offset:2048 sc1
op_115:
 buffer_load_dwordx4 v[36:39], v4, s[4:7], s84 offen offset:2048 sc1
 buffer_load_dwordx4 v[28:31], v4, s[4:7], s84 offen offset:0 sc1
 buffer_load_dwordx4 v[32:35], v4, s[4:7], s84 offen offset:1024 sc1
 s_add_u32 s54, s54, 1
 s_cmp_gt_u32 s54, 131072
 s_cbranch_scc1 end0
 s_waitcnt vmcnt(0)
 v_bitop3_b32 v27, v31, v35, v39 bitop3:0x80
 v_perm_b32 v31, v35, v31, s89
 v_cmp_gt_u32 vcc, 0x48000000, v27
 v_mov_b32 v35, v38
 s_cbranch_vccnz pm_85
 s_branch A1_17
psr_98:
 buffer_load_dwordx2 v[58:59], v9, s[8:11], s81 offen sc1
 buffer_load_dwordx4 v[40:43], v8, s[8:11], s81 offen offset:0 sc1
 buffer_load_dwordx4 v[44:47], v8, s[8:11], s81 offen offset:1024 sc1
 s_add_u32 s54, s54, 1
 s_cmp_gt_u32 s54, 131072
 s_cbranch_scc1 end0
 s_waitcnt vmcnt(2)
 v_xor_b32 v76, s88, v58
 s_nop 0
 v_permlane16_swap_b32 v58, v59
 v_fma_mix_f32 v60, v58, 1.0, v59 op_sel:[0,0,0] op_sel_hi:[1,0,1]
 v_fma_mix_f32 v61, v58, 1.0, v59 op_sel:[1,0,1] op_sel_hi:[1,0,1]
 v_mov_b32 v58, v60
 v_mov_b32 v59, v61
 s_nop 0
 v_permlane32_swap_b32 v58, v60
 v_permlane32_swap_b32 v59, v61
 v_add_f32 v52, v58, v60
 v_add_f32 v53, v59, v61
 v_max_f32 v79, v52, v53
 s_waitcnt vmcnt(0)
 v_pk_add_f16 v80, v40, v44
 v_pk_add_f16 v82, v42, v46
 v_pk_add_f16 v81, v41, v45
 v_pk_add_f16 v83, v43, v47
 v_permlane32_swap_b32 v80, v82
 v_bitop3_b32 v77, v40, v42, s88 bitop3:0x7e
 v_permlane32_swap_b32 v81, v83
 v_bitop3_b32 v78, v44, v46, s88 bitop3:0x7e
 v_fma_mix_f32 v48, v80, 1.0, v82 op_sel:[0,0,0] op_sel_hi:[1,0,1]
 v_or3_b32 v27, v76, v77, v78
 v_fma_mix_f32 v49, v80, 1.0, v82 op_sel:[1,0,1] op_sel_hi:[1,0,1]
 v_and_b32 v27, 1, v27
 v_fma_mix_f32 v50, v81, 1.0, v83 op_sel:[0,0,0] op_sel_hi:[1,0,1]
 v_cmp_ne_u32 vcc, 0, v27
 v_fma_mix_f32 v51, v81, 1.0, v83 op_sel:[1,0,1] op_sel_hi:[1,0,1]
 v_max3_f32 v62, v48, v49, v79
 s_cbranch_vccnz psr_98
 s_branch psj_99
kvw_100:
 s_mov_b32 s22, s87
 s_cmp_eq_u32 s52, 0
 s_cselect_b32 s55, 0, s55
 s_cselect_b32 s87, 1, 0
 s_cbranch_scc1 kvok_101
 v_mov_b32 v62, 0
 s_mov_b32 s101, 0
wf_116:
 buffer_load_dword v63, v62, s[12:15], s79 offen sc1
 s_add_u32 s101, s101, 1
 s_cmp_gt_u32 s101, 131072
 s_cbranch_scc1 end0
 s_waitcnt vmcnt(0)
 v_readfirstlane_b32 s100, v63
 s_cmp_ge_u32 s100, s46
 s_cbranch_scc1 wf_117
 s_sleep 3
 s_branch wf_116
wf_117:
 s_cmp_eq_u32 s22, 0
 s_cbranch_scc1 kvok_101
 s_sub_u32 s21, s64, 1310720
 buffer_load_dwordx4 v[126:129], v16, s[28:31], s21 offen offset:0 sc1
 buffer_load_dwordx4 v[130:133], v16, s[28:31], s21 offen offset:1024 sc1
 buffer_load_dwordx4 v[134:137], v16, s[28:31], s21 offen offset:2048 sc1
 s_waitcnt vmcnt(0)
 s_branch kvok_101
fl_107:
 buffer_load_dword v0, off, s[12:15], s79 sc1
 s_branch fl_108
last_84:
 s_lshr_b32 s21, 4, s20
 s_bitcmp1_b32 s21, 0
 s_cbranch_scc0 bw_119
 s_mov_b64 exec, s[62:63]
 buffer_store_dwordx4 v[118:121], v18, s[24:27], s85 offen sc1
 buffer_store_dwordx2 v[122:123], v19, s[24:27], s85 offen sc1
 s_mov_b64 exec, -1
 s_branch bw_118
bw_119:
bw_118:
 s_waitcnt lgkmcnt(10)
 v_smfmac_f32_16x16x64_f16 v[100:103], v[28:31], a[120:127], v25
 v_smfmac_f32_16x16x64_f16 v[104:107], v[28:31], a[128:135], v25
 v_smfmac_f32_16x16x64_f16 v[108:111], v[28:31], a[136:143], v25
 v_smfmac_f32_16x16x64_f16 v[100:103], v[32:35], a[144:151], v25
 v_smfmac_f32_16x16x64_f16 v[104:107], v[32:35], a[152:159], v25
 v_smfmac_f32_16x16x64_f16 v[108:111], v[32:35], a[160:167], v25
 s_waitcnt lgkmcnt(7)
 v_smfmac_f32_16x16x64_f16 v[100:103], v[64:67], a[168:175], v25
 v_smfmac_f32_16x16x64_f16 v[104:107], v[64:67], a[176:183], v25
 v_smfmac_f32_16x16x64_f16 v[108:111], v[64:67], a[184:191], v25
 v_smfmac_f32_16x16x64_f16 v[100:103], v[68:71], a[192:199], v25
 v_smfmac_f32_16x16x64_f16 v[104:107], v[68:71], a[200:207], v25
 v_smfmac_f32_16x16x64_f16 v[108:111], v[68:71], a[208:215], v25
 v_smfmac_f32_16x16x64_f16 v[100:103], v[72:75], a[216:223], v25
 v_smfmac_f32_16x16x64_f16 v[104:107], v[72:75], a[224:231], v25
 v_smfmac_f32_16x16x64_f16 v[108:111], v[72:75], a[232:239], v25
 s_waitcnt lgkmcnt(4)
 v_smfmac_f32_16x16x64_f16 v[100:103], v[76:79], a[240:247], v25
 v_smfmac_f32_16x16x64_f16 v[104:107], v[76:79], a[248:255], v25
 v_smfmac_f32_16x16x64_f16 v[108:111], v[76:79], v[152:159], v25
 v_smfmac_f32_16x16x64_f16 v[100:103], v[80:83], v[160:167], v25
 v_smfmac_f32_16x16x64_f16 v[104:107], v[80:83], v[168:175], v25
 v_smfmac_f32_16x16x64_f16 v[108:111], v[80:83], v[176:183], v25
 v_smfmac_f32_16x16x64_f16 v[100:103], v[84:87], v[184:191], v25
 v_smfmac_f32_16x16x64_f16 v[104:107], v[84:87], v[192:199], v25
 v_smfmac_f32_16x16x64_f16 v[108:111], v[84:87], v[200:207], v25
 s_waitcnt lgkmcnt(0)
 v_smfmac_f32_16x16x64_f16 v[100:103], v[88:91], v[208:215], v25
 v_smfmac_f32_16x16x64_f16 v[104:107], v[88:91], v[216:223], v25
 v_smfmac_f32_16x16x64_f16 v[108:111], v[88:91], v[224:231], v25
 v_smfmac_f32_16x16x64_f16 v[100:103], v[92:95], v[232:239], v25
 v_smfmac_f32_16x16x64_f16 v[104:107], v[92:95], v[240:247], v25
 v_smfmac_f32_16x16x64_f16 v[108:111], v[92:95], v[248:255], v25
 s_nop 7
 v_mov_b32 v76, v108
 v_mov_b32 v77, v109
 v_mov_b32 v78, v110
 v_mov_b32 v79, v111
 v_permlane32_swap_b32 v100, v104
 v_permlane32_swap_b32 v101, v105
 v_permlane32_swap_b32 v102, v106
 v_permlane32_swap_b32 v103, v107
 v_permlane32_swap_b32 v108, v76
 v_permlane32_swap_b32 v109, v77
 v_permlane32_swap_b32 v110, v78
 v_permlane32_swap_b32 v111, v79
 v_pk_add_f32 v[100:101], v[100:101], v[104:105]
 v_pk_add_f32 v[102:103], v[102:103], v[106:107]
 v_pk_add_f32 v[108:109], v[108:109], v[76:77]
 v_pk_add_f32 v[110:111], v[110:111], v[78:79]
 v_cvt_pk_bf16_f32 v80, v100, v101
 v_cvt_pk_bf16_f32 v82, v108, v109
 v_cvt_pk_bf16_f32 v81, v102, v103
 v_cvt_pk_bf16_f32 v83, v110, v111
 s_nop 0
 v_permlane16_swap_b32 v80, v82
 v_permlane16_swap_b32 v81, v83
 v_min_u32 v80, -2, v80
 s_mov_b64 exec, s[76:77]
 buffer_store_dwordx4 v[80:83], v15, s[24:27], s57 offen sc1
 s_mov_b64 exec, -1
 s_lshr_b32 s21, 1, s20
 s_bitcmp1_b32 s21, 0
 s_cbranch_scc0 bw_121
 v_mov_b32 v246, 80
 v_mov_b32 v247, 1
 s_mov_b64 exec, 1
 buffer_atomic_add v247, v246, s[32:35], 0 offen sc0 sc1
 s_mov_b64 exec, -1
 s_branch bw_120
bw_121:
bw_120:
 s_branch chain_done
chain_done:
 s_waitcnt vmcnt(0) lgkmcnt(0)
 s_barrier
 s_mov_b32 s84, 0
 s_mov_b32 s85, -1
 s_mov_b32 s86, 0
 v_mov_b32 v21, 0
 v_mov_b32 v23, v247
 s_cmp_lg_u32 s20, 0
 s_cbranch_scc1 queue_b
 s_mov_b64 exec, 1
 s_branch queue_a
end0:
 s_endpgm
gemm_side:
 s_bfe_u32 s23, s22, 0x20005
 s_add_u32 s22, s22, 31
 s_and_b32 s22, s22, 31
 s_lshl_b32 s21, s23, 3
 s_add_u32 s2, s21, s22
 s_add_u32 s3, s2, 72
 s_add_u32 s24, s2, 48
 s_add_u32 s2, s2, s21
 s_cmp_lt_u32 s22, 24
 s_cselect_b32 s3, s24, s3
 s_cmp_lt_u32 s22, 16
 s_cselect_b32 s3, s2, s3
 s_mov_b32 s2, s3
gemm_roles:
 s_cmp_ge_u32 s3, 64
 s_cbranch_scc1 not_kv
 s_load_dwordx2 s[4:5], s[0:1], 0
 s_load_dwordx2 s[6:7], s[0:1], 24
 s_load_dwordx2 s[36:37], s[0:1], 32
 s_load_dwordx2 s[38:39], s[0:1], 104
 s_and_b32 s43, s3, 1
 s_bfe_u32 s42, s3, 0x50001
 s_lshr_b32 s40, s42, 2
 s_waitcnt lgkmcnt(0)
 s_cmp_eq_u32 s43, 1
 s_cselect_b32 s6, s36, s6
 s_cselect_b32 s7, s37, s7
 s_mov_b32 s8, s4
 s_mov_b32 s9, s5
 s_mov_b32 s10, 2621440
 s_mov_b32 s11, 0x00020000
 s_mov_b32 s12, s6
 s_mov_b32 s13, s7
 s_mov_b32 s14, 7864320
 s_mov_b32 s15, 0x00020000
 s_mov_b32 s16, s38
 s_mov_b32 s17, s39
 s_mov_b32 s18, 50331648
 s_mov_b32 s19, 0x00020000
 s_mul_i32 s44, s42, 384
 s_mov_b32 s62, 1024
 s_mov_b32 s24, 0
 s_mov_b32 s25, 81920
 s_mov_b32 s64, s32
 s_mov_b32 s65, s33
 s_mov_b32 s66, s34
 s_mov_b32 s67, s35
 s_load_dwordx2 s[72:73], s[0:1], 104
 s_waitcnt lgkmcnt(0)
 s_add_u32 s72, s72, 81068032
 s_addc_u32 s73, s73, 0
 s_mov_b32 s74, 129024
 s_mov_b32 s75, 0x00020000
 v_mov_b32 v9, 2731
 v_add_u32 v8, 0, v1
 v_mul_u32_u24 v7, v8, v9
 v_lshrrev_b32 v7, 16, v7
 v_mul_u32_u24 v4, 24, v7
 v_sub_u32 v8, v8, v4
 v_and_b32 v4, 2, v7
 v_xor_b32 v8, v8, v4
 v_xor_b32 v5, 4, v8
 s_mov_b32 s21, 12288
 v_mul_lo_u32 v7, v7, s21
 v_lshl_add_u32 v40, v8, 4, v7
 v_lshl_add_u32 v43, v5, 4, v7
 v_add_u32 v8, 64, v1
 v_mul_u32_u24 v7, v8, v9
 v_lshrrev_b32 v7, 16, v7
 v_mul_u32_u24 v4, 24, v7
 v_sub_u32 v8, v8, v4
 v_and_b32 v4, 2, v7
 v_xor_b32 v8, v8, v4
 v_xor_b32 v5, 4, v8
 s_mov_b32 s21, 12288
 v_mul_lo_u32 v7, v7, s21
 v_lshl_add_u32 v41, v8, 4, v7
 v_lshl_add_u32 v44, v5, 4, v7
 v_add_u32 v8, 128, v1
 v_mul_u32_u24 v7, v8, v9
 v_lshrrev_b32 v7, 16, v7
 v_mul_u32_u24 v4, 24, v7
 v_sub_u32 v8, v8, v4
 v_and_b32 v4, 2, v7
 v_xor_b32 v8, v8, v4
 v_xor_b32 v5, 4, v8
 s_mov_b32 s21, 12288
 v_mul_lo_u32 v7, v7, s21
 v_lshl_add_u32 v42, v8, 4, v7
 v_lshl_add_u32 v45, v5, 4, v7
 s_mul_i32 s21, s20, 393216
 s_add_u32 s21, s21, 0
 s_add_u32 s21, s21, s44
 s_mul_i32 s22, s20, 12288
 s_add_u32 s22, s22, 0
 s_add_u32 m0, s22, 0
 s_nop 0
 buffer_load_dwordx4 v40, s[12:15], s21 offen lds
 s_add_u32 m0, s22, 1024
 s_nop 0
 buffer_load_dwordx4 v41, s[12:15], s21 offen lds
 s_add_u32 m0, s22, 2048
 s_nop 0
 buffer_load_dwordx4 v42, s[12:15], s21 offen lds
 s_mul_i32 s21, s20, 393216
 s_add_u32 s21, s21, 98304
 s_add_u32 s21, s21, s44
 s_mul_i32 s22, s20, 12288
 s_add_u32 s22, s22, 3072
 s_add_u32 m0, s22, 0
 s_nop 0
 buffer_load_dwordx4 v43, s[12:15], s21 offen lds
 s_add_u32 m0, s22, 1024
 s_nop 0
 buffer_load_dwordx4 v44, s[12:15], s21 offen lds
 s_add_u32 m0, s22, 2048
 s_nop 0
 buffer_load_dwordx4 v45, s[12:15], s21 offen lds
 s_mul_i32 s21, s20, 393216
 s_add_u32 s21, s21, 196608
 s_add_u32 s21, s21, s44
 s_mul_i32 s22, s20, 12288
 s_add_u32 s22, s22, 6144
 s_add_u32 m0, s22, 0
 s_nop 0
 buffer_load_dwordx4 v40, s[12:15], s21 offen lds
 s_add_u32 m0, s22, 1024
 s_nop 0
 buffer_load_dwordx4 v41, s[12:15], s21 offen lds
 s_add_u32 m0, s22, 2048
 s_nop 0
 buffer_load_dwordx4 v42, s[12:15], s21 offen lds
 s_mul_i32 s21, s20, 393216
 s_add_u32 s21, s21, 294912
 s_add_u32 s21, s21, s44
 s_mul_i32 s22, s20, 12288
 s_add_u32 s22, s22, 9216
 s_add_u32 m0, s22, 0
 s_nop 0
 buffer_load_dwordx4 v43, s[12:15], s21 offen lds
 s_add_u32 m0, s22, 1024
 s_nop 0
 buffer_load_dwordx4 v44, s[12:15], s21 offen lds
 s_add_u32 m0, s22, 2048
 s_nop 0
 buffer_load_dwordx4 v45, s[12:15], s21 offen lds
 v_lshrrev_b32 v11, 3, v1
 v_and_b32 v12, 7, v1
 v_xor_b32 v12, v12, v11
 v_mul_u32_u24 v11, 1280, v11
 v_lshl_add_u32 v10, v12, 4, v11
 s_mul_i32 s46, s20, 20480
 v_add_u32 v10, s46, v10
 s_lshl_b32 s47, s20, 11
 s_add_u32 s47, s47, 98304
 s_add_u32 s46, s47, 57344
 s_mov_b32 s30, s24
 s_add_u32 s32, s47, 0
 v_add_u32 v11, 9216, v10
 s_mov_b32 m0, s32
 s_nop 0
 buffer_load_dwordx4 v10, s[8:11], s30 offen offset:0 lds
 buffer_load_dwordx4 v11, s[8:11], s30 offen offset:1024 lds
 s_add_u32 s30, s30, 128
 s_add_u32 s32, s32, 8192
 s_cmp_lt_u32 s32, s46
 s_cselect_b32 s32, s32, s47
 s_mov_b32 m0, s32
 s_nop 0
 buffer_load_dwordx4 v10, s[8:11], s30 offen offset:0 lds
 buffer_load_dwordx4 v11, s[8:11], s30 offen offset:1024 lds
 s_add_u32 s30, s30, 128
 s_add_u32 s32, s32, 8192
 s_cmp_lt_u32 s32, s46
 s_cselect_b32 s32, s32, s47
 s_mov_b32 m0, s32
 s_nop 0
 buffer_load_dwordx4 v10, s[8:11], s30 offen offset:0 lds
 buffer_load_dwordx4 v11, s[8:11], s30 offen offset:1024 lds
 s_add_u32 s30, s30, 128
 s_add_u32 s32, s32, 8192
 s_cmp_lt_u32 s32, s46
 s_cselect_b32 s32, s32, s47
 s_mov_b32 m0, s32
 s_nop 0
 buffer_load_dwordx4 v10, s[8:11], s30 offen offset:0 lds
 buffer_load_dwordx4 v11, s[8:11], s30 offen offset:1024 lds
 s_add_u32 s30, s30, 128
 s_add_u32 s32, s32, 8192
 s_cmp_lt_u32 s32, s46
 s_cselect_b32 s32, s32, s47
 s_mov_b32 m0, s32
 s_nop 0
 buffer_load_dwordx4 v10, s[8:11], s30 offen offset:0 lds
 buffer_load_dwordx4 v11, s[8:11], s30 offen offset:1024 lds
 s_add_u32 s30, s30, 128
 s_add_u32 s32, s32, 8192
 s_cmp_lt_u32 s32, s46
 s_cselect_b32 s32, s32, s47
 s_mul_i32 s21, s20, 393216
 s_add_u32 s21, s21, 1572864
 s_add_u32 s21, s21, s44
 s_mul_i32 s22, s20, 12288
 s_add_u32 s22, s22, 49152
 s_add_u32 m0, s22, 0
 s_nop 0
 buffer_load_dwordx4 v40, s[12:15], s21 offen lds
 s_add_u32 m0, s22, 1024
 s_nop 0
 buffer_load_dwordx4 v41, s[12:15], s21 offen lds
 s_add_u32 m0, s22, 2048
 s_nop 0
 buffer_load_dwordx4 v42, s[12:15], s21 offen lds
 s_mul_i32 s21, s20, 393216
 s_add_u32 s21, s21, 1671168
 s_add_u32 s21, s21, s44
 s_mul_i32 s22, s20, 12288
 s_add_u32 s22, s22, 52224
 s_add_u32 m0, s22, 0
 s_nop 0
 buffer_load_dwordx4 v43, s[12:15], s21 offen lds
 s_add_u32 m0, s22, 1024
 s_nop 0
 buffer_load_dwordx4 v44, s[12:15], s21 offen lds
 s_add_u32 m0, s22, 2048
 s_nop 0
 buffer_load_dwordx4 v45, s[12:15], s21 offen lds
 s_mul_i32 s21, s20, 393216
 s_add_u32 s21, s21, 1769472
 s_add_u32 s21, s21, s44
 s_mul_i32 s22, s20, 12288
 s_add_u32 s22, s22, 55296
 s_add_u32 m0, s22, 0
 s_nop 0
 buffer_load_dwordx4 v40, s[12:15], s21 offen lds
 s_add_u32 m0, s22, 1024
 s_nop 0
 buffer_load_dwordx4 v41, s[12:15], s21 offen lds
 s_add_u32 m0, s22, 2048
 s_nop 0
 buffer_load_dwordx4 v42, s[12:15], s21 offen lds
 s_mul_i32 s21, s20, 393216
 s_add_u32 s21, s21, 1867776
 s_add_u32 s21, s21, s44
 s_mul_i32 s22, s20, 12288
 s_add_u32 s22, s22, 58368
 s_add_u32 m0, s22, 0
 s_nop 0
 buffer_load_dwordx4 v43, s[12:15], s21 offen lds
 s_add_u32 m0, s22, 1024
 s_nop 0
 buffer_load_dwordx4 v44, s[12:15], s21 offen lds
 s_add_u32 m0, s22, 2048
 s_nop 0
 buffer_load_dwordx4 v45, s[12:15], s21 offen lds
 v_lshrrev_b32 v7, 2, v2
 v_and_b32 v4, 2, v7
 v_and_b32 v5, 1, v3
 v_lshl_or_b32 v4, v5, 2, v4
 v_lshl_add_u32 v7, v3, 3, v7
 v_mul_u32_u24 v7, 384, v7
 v_and_b32 v5, 1, v2
 v_lshl_add_u32 v7, v5, 3, v7
 v_bfe_u32 v8, v2, 1, 1
 s_mul_i32 s21, s20, 6
 v_add_u32 v8, s21, v8
 v_add_u32 v5, 0, v8
 v_xor_b32 v5, v5, v4
 v_lshl_add_u32 v46, v5, 4, v7
 v_add_u32 v49, 49152, v46
 v_add_u32 v5, 2, v8
 v_xor_b32 v5, v5, v4
 v_lshl_add_u32 v47, v5, 4, v7
 v_add_u32 v50, 49152, v47
 v_add_u32 v5, 4, v8
 v_xor_b32 v5, v5, v4
 v_lshl_add_u32 v48, v5, 4, v7
 v_add_u32 v51, 49152, v48
 s_mov_b32 s26, 6
 s_mul_i32 s27, s42, 12288
 s_mul_i32 s21, s43, 25165824
 s_add_u32 s27, s27, s21
 s_mov_b32 s28, 786432
 s_lshl_b32 s60, s40, 7
 s_add_u32 s60, s60, 0
 s_mov_b32 s61, 0
 v_and_b32 v6, 7, v2
 v_add_u32 v4, 0, v3
 v_xor_b32 v4, v4, v6
 v_lshlrev_b32 v4, 4, v4
 v_lshl_add_u32 v14, v2, 7, v4
 v_add_u32 v4, 4, v3
 v_xor_b32 v4, v4, v6
 v_lshlrev_b32 v4, 4, v4
 v_lshl_add_u32 v15, v2, 7, v4
 v_mul_u32_u24 v22, 400, v2
 v_mul_u32_u24 v4, 16, v3
 s_mul_i32 s21, s20, 96
 s_add_u32 s21, s21, 0
 v_add3_u32 v22, v22, v4, s21
 v_lshlrev_b32 v4, 3, v3
 v_sub_u32 v16, v22, v4
 v_mov_b32 v9, 2731
 s_mul_i32 s21, s20, 6400
 s_add_u32 s21, s21, 0
 v_mul_u32_u24 v4, 400, v2
 v_lshlrev_b32 v5, 4, v3
 v_add3_u32 v23, v4, v5, s21
 v_lshlrev_b32 v26, 4, v1
 s_mov_b32 s33, 98304
 s_mov_b32 s48, 0x80000000
 s_mov_b32 m0, s32
 s_nop 0
 buffer_load_dwordx4 v10, s[8:11], s30 offen offset:0 lds
 s_waitcnt vmcnt(21)
 s_barrier
 v_add_u32 v18, s33, v14
 v_add_u32 v19, s33, v15
 s_add_u32 s33, s33, 8192
 s_cmp_lt_u32 s33, 155648
 s_cselect_b32 s33, s33, 98304
 ds_read_b128 v[160:163], v18 offset:0
 ds_read_b128 v[164:167], v18 offset:2048
 ds_read_b128 v[168:171], v18 offset:4096
 ds_read_b128 v[172:175], v18 offset:6144
 s_waitcnt lgkmcnt(0)
 s_waitcnt vmcnt(23)
 s_barrier
 ds_read_b64_tr_b16 a[0:1], v46 offset:0
 ds_read_b64_tr_b16 a[2:3], v46 offset:1536
 ds_read_b64_tr_b16 a[4:5], v47 offset:0
 ds_read_b64_tr_b16 a[6:7], v47 offset:1536
 ds_read_b64_tr_b16 a[8:9], v48 offset:0
 ds_read_b64_tr_b16 a[10:11], v48 offset:1536
 ds_read_b64_tr_b16 a[12:13], v46 offset:12288
 ds_read_b64_tr_b16 a[14:15], v46 offset:13824
 ds_read_b64_tr_b16 a[16:17], v47 offset:12288
 ds_read_b64_tr_b16 a[18:19], v47 offset:13824
 ds_read_b64_tr_b16 a[20:21], v48 offset:12288
 ds_read_b64_tr_b16 a[22:23], v48 offset:13824
 ds_read_b64_tr_b16 a[24:25], v46 offset:24576
 ds_read_b64_tr_b16 a[26:27], v46 offset:26112
 ds_read_b64_tr_b16 a[28:29], v47 offset:24576
 ds_read_b64_tr_b16 a[30:31], v47 offset:26112
 ds_read_b64_tr_b16 a[32:33], v48 offset:24576
 ds_read_b64_tr_b16 a[34:35], v48 offset:26112
 ds_read_b64_tr_b16 a[36:37], v46 offset:36864
 ds_read_b64_tr_b16 a[38:39], v46 offset:38400
 ds_read_b64_tr_b16 a[40:41], v47 offset:36864
 ds_read_b64_tr_b16 a[42:43], v47 offset:38400
 ds_read_b64_tr_b16 a[44:45], v48 offset:36864
 ds_read_b64_tr_b16 a[46:47], v48 offset:38400
 s_waitcnt lgkmcnt(0)
 s_barrier
 s_mov_b32 s23, m0
 s_mul_i32 s21, s20, 393216
 s_add_u32 s21, s21, 3145728
 s_add_u32 s21, s21, s44
 s_mul_i32 s22, s20, 12288
 s_add_u32 s22, s22, 0
 s_add_u32 m0, s22, 0
 s_nop 0
 buffer_load_dwordx4 v40, s[12:15], s21 offen lds
 s_add_u32 m0, s22, 1024
 s_nop 0
 buffer_load_dwordx4 v41, s[12:15], s21 offen lds
 s_add_u32 m0, s22, 2048
 s_nop 0
 buffer_load_dwordx4 v42, s[12:15], s21 offen lds
 s_mul_i32 s21, s20, 393216
 s_add_u32 s21, s21, 3244032
 s_add_u32 s21, s21, s44
 s_mul_i32 s22, s20, 12288
 s_add_u32 s22, s22, 3072
 s_add_u32 m0, s22, 0
 s_nop 0
 buffer_load_dwordx4 v43, s[12:15], s21 offen lds
 s_add_u32 m0, s22, 1024
 s_nop 0
 buffer_load_dwordx4 v44, s[12:15], s21 offen lds
 s_add_u32 m0, s22, 2048
 s_nop 0
 buffer_load_dwordx4 v45, s[12:15], s21 offen lds
 s_mul_i32 s21, s20, 393216
 s_add_u32 s21, s21, 3342336
 s_add_u32 s21, s21, s44
 s_mul_i32 s22, s20, 12288
 s_add_u32 s22, s22, 6144
 s_add_u32 m0, s22, 0
 s_nop 0
 buffer_load_dwordx4 v40, s[12:15], s21 offen lds
 s_add_u32 m0, s22, 1024
 s_nop 0
 buffer_load_dwordx4 v41, s[12:15], s21 offen lds
 s_add_u32 m0, s22, 2048
 s_nop 0
 buffer_load_dwordx4 v42, s[12:15], s21 offen lds
 s_mul_i32 s21, s20, 393216
 s_add_u32 s21, s21, 3440640
 s_add_u32 s21, s21, s44
 s_mul_i32 s22, s20, 12288
 s_add_u32 s22, s22, 9216
 s_add_u32 m0, s22, 0
 s_nop 0
 buffer_load_dwordx4 v43, s[12:15], s21 offen lds
 s_add_u32 m0, s22, 1024
 s_nop 0
 buffer_load_dwordx4 v44, s[12:15], s21 offen lds
 s_add_u32 m0, s22, 2048
 s_nop 0
 buffer_load_dwordx4 v45, s[12:15], s21 offen lds
 s_mov_b32 m0, s23
 v_mfma_f32_16x16x32_bf16 v[64:67], a[0:3], v[160:163], 0
 ds_read_b128 v[192:195], v19 offset:0
 v_mfma_f32_16x16x32_bf16 v[68:71], a[4:7], v[160:163], 0
 v_add_u32 v18, s33, v14
 v_mfma_f32_16x16x32_bf16 v[72:75], a[8:11], v[160:163], 0
 v_mfma_f32_16x16x32_bf16 v[76:79], a[0:3], v[164:167], 0
 ds_read_b128 v[196:199], v19 offset:2048
 v_mfma_f32_16x16x32_bf16 v[80:83], a[4:7], v[164:167], 0
 buffer_load_dwordx4 v11, s[8:11], s30 offen offset:1024 lds
 v_mfma_f32_16x16x32_bf16 v[84:87], a[8:11], v[164:167], 0
 s_add_u32 s30, s30, 128
 v_mfma_f32_16x16x32_bf16 v[88:91], a[0:3], v[168:171], 0
 ds_read_b128 v[200:203], v19 offset:4096
 s_add_u32 m0, m0, 8192
 v_mfma_f32_16x16x32_bf16 v[92:95], a[4:7], v[168:171], 0
 s_cmp_lt_u32 m0, s46
 s_cselect_b32 m0, m0, s47
 v_mfma_f32_16x16x32_bf16 v[96:99], a[8:11], v[168:171], 0
 v_mfma_f32_16x16x32_bf16 v[100:103], a[0:3], v[172:175], 0
 ds_read_b128 v[204:207], v19 offset:6144
 v_mfma_f32_16x16x32_bf16 v[104:107], a[4:7], v[172:175], 0
 v_mfma_f32_16x16x32_bf16 v[108:111], a[8:11], v[172:175], 0
 s_waitcnt vmcnt(32) lgkmcnt(2)
 s_barrier
 v_mfma_f32_16x16x32_bf16 v[64:67], a[12:15], v[192:195], v[64:67]
 ds_read_b128 v[160:163], v18 offset:0
 v_mfma_f32_16x16x32_bf16 v[68:71], a[16:19], v[192:195], v[68:71]
 v_mfma_f32_16x16x32_bf16 v[72:75], a[20:23], v[192:195], v[72:75]
 v_add_u32 v19, s33, v15
 s_add_u32 s33, s33, 8192
 v_mfma_f32_16x16x32_bf16 v[76:79], a[12:15], v[196:199], v[76:79]
 ds_read_b128 v[164:167], v18 offset:2048
 v_mfma_f32_16x16x32_bf16 v[80:83], a[16:19], v[196:199], v[80:83]
 buffer_load_dwordx4 v10, s[8:11], s30 offen offset:0 lds
 v_mfma_f32_16x16x32_bf16 v[84:87], a[20:23], v[196:199], v[84:87]
 s_waitcnt lgkmcnt(2)
 v_mfma_f32_16x16x32_bf16 v[88:91], a[12:15], v[200:203], v[88:91]
 ds_read_b128 v[168:171], v18 offset:4096
 v_mfma_f32_16x16x32_bf16 v[92:95], a[16:19], v[200:203], v[92:95]
 s_cmp_lt_u32 s33, 155648
 s_cselect_b32 s33, s33, 98304
 v_mfma_f32_16x16x32_bf16 v[96:99], a[20:23], v[200:203], v[96:99]
 v_mfma_f32_16x16x32_bf16 v[100:103], a[12:15], v[204:207], v[100:103]
 ds_read_b128 v[172:175], v18 offset:6144
 v_mfma_f32_16x16x32_bf16 v[104:107], a[16:19], v[204:207], v[104:107]
 v_mfma_f32_16x16x32_bf16 v[108:111], a[20:23], v[204:207], v[108:111]
 s_waitcnt lgkmcnt(2)
 v_mfma_f32_16x16x32_bf16 v[64:67], a[24:27], v[160:163], v[64:67]
 ds_read_b128 v[192:195], v19 offset:0
 v_mfma_f32_16x16x32_bf16 v[68:71], a[28:31], v[160:163], v[68:71]
 v_add_u32 v18, s33, v14
 v_mfma_f32_16x16x32_bf16 v[72:75], a[32:35], v[160:163], v[72:75]
 v_mfma_f32_16x16x32_bf16 v[76:79], a[24:27], v[164:167], v[76:79]
 ds_read_b128 v[196:199], v19 offset:2048
 v_mfma_f32_16x16x32_bf16 v[80:83], a[28:31], v[164:167], v[80:83]
 buffer_load_dwordx4 v11, s[8:11], s30 offen offset:1024 lds
 v_mfma_f32_16x16x32_bf16 v[84:87], a[32:35], v[164:167], v[84:87]
 s_waitcnt lgkmcnt(2)
 s_add_u32 s30, s30, 128
 v_mfma_f32_16x16x32_bf16 v[88:91], a[24:27], v[168:171], v[88:91]
 ds_read_b128 v[200:203], v19 offset:4096
 s_add_u32 m0, m0, 8192
 v_mfma_f32_16x16x32_bf16 v[92:95], a[28:31], v[168:171], v[92:95]
 s_cmp_lt_u32 m0, s46
 s_cselect_b32 m0, m0, s47
 v_mfma_f32_16x16x32_bf16 v[96:99], a[32:35], v[168:171], v[96:99]
 v_mfma_f32_16x16x32_bf16 v[100:103], a[24:27], v[172:175], v[100:103]
 ds_read_b128 v[204:207], v19 offset:6144
 v_mfma_f32_16x16x32_bf16 v[104:107], a[28:31], v[172:175], v[104:107]
 v_mfma_f32_16x16x32_bf16 v[108:111], a[32:35], v[172:175], v[108:111]
 s_waitcnt vmcnt(32) lgkmcnt(2)
 s_barrier
 v_mfma_f32_16x16x32_bf16 v[64:67], a[36:39], v[192:195], v[64:67]
 ds_read_b128 v[160:163], v18 offset:0
 v_mfma_f32_16x16x32_bf16 v[68:71], a[40:43], v[192:195], v[68:71]
 v_mfma_f32_16x16x32_bf16 v[72:75], a[44:47], v[192:195], v[72:75]
 v_add_u32 v19, s33, v15
 s_add_u32 s33, s33, 8192
 v_mfma_f32_16x16x32_bf16 v[76:79], a[36:39], v[196:199], v[76:79]
 ds_read_b128 v[164:167], v18 offset:2048
 v_mfma_f32_16x16x32_bf16 v[80:83], a[40:43], v[196:199], v[80:83]
 buffer_load_dwordx4 v10, s[8:11], s30 offen offset:0 lds
 v_mfma_f32_16x16x32_bf16 v[84:87], a[44:47], v[196:199], v[84:87]
 s_waitcnt lgkmcnt(2)
 v_mfma_f32_16x16x32_bf16 v[88:91], a[36:39], v[200:203], v[88:91]
 ds_read_b128 v[168:171], v18 offset:4096
 v_mfma_f32_16x16x32_bf16 v[92:95], a[40:43], v[200:203], v[92:95]
 s_cmp_lt_u32 s33, 155648
 s_cselect_b32 s33, s33, 98304
 v_mfma_f32_16x16x32_bf16 v[96:99], a[44:47], v[200:203], v[96:99]
 v_mfma_f32_16x16x32_bf16 v[100:103], a[36:39], v[204:207], v[100:103]
 ds_read_b128 v[172:175], v18 offset:6144
 v_mfma_f32_16x16x32_bf16 v[104:107], a[40:43], v[204:207], v[104:107]
 v_mfma_f32_16x16x32_bf16 v[108:111], a[44:47], v[204:207], v[108:111]
 s_waitcnt lgkmcnt(2)
 s_waitcnt vmcnt(17)
 s_barrier
 ds_read_b64_tr_b16 a[48:49], v49 offset:0
 ds_read_b64_tr_b16 a[50:51], v49 offset:1536
 ds_read_b64_tr_b16 a[52:53], v50 offset:0
 ds_read_b64_tr_b16 a[54:55], v50 offset:1536
 ds_read_b64_tr_b16 a[56:57], v51 offset:0
 ds_read_b64_tr_b16 a[58:59], v51 offset:1536
 ds_read_b64_tr_b16 a[60:61], v49 offset:12288
 ds_read_b64_tr_b16 a[62:63], v49 offset:13824
 ds_read_b64_tr_b16 a[64:65], v50 offset:12288
 ds_read_b64_tr_b16 a[66:67], v50 offset:13824
 ds_read_b64_tr_b16 a[68:69], v51 offset:12288
 ds_read_b64_tr_b16 a[70:71], v51 offset:13824
 ds_read_b64_tr_b16 a[72:73], v49 offset:24576
 ds_read_b64_tr_b16 a[74:75], v49 offset:26112
 ds_read_b64_tr_b16 a[76:77], v50 offset:24576
 ds_read_b64_tr_b16 a[78:79], v50 offset:26112
 ds_read_b64_tr_b16 a[80:81], v51 offset:24576
 ds_read_b64_tr_b16 a[82:83], v51 offset:26112
 ds_read_b64_tr_b16 a[84:85], v49 offset:36864
 ds_read_b64_tr_b16 a[86:87], v49 offset:38400
 ds_read_b64_tr_b16 a[88:89], v50 offset:36864
 ds_read_b64_tr_b16 a[90:91], v50 offset:38400
 ds_read_b64_tr_b16 a[92:93], v51 offset:36864
 ds_read_b64_tr_b16 a[94:95], v51 offset:38400
 s_waitcnt lgkmcnt(0)
 s_barrier
 s_mov_b32 s23, m0
 s_mul_i32 s21, s20, 393216
 s_add_u32 s21, s21, 4718592
 s_add_u32 s21, s21, s44
 s_mul_i32 s22, s20, 12288
 s_add_u32 s22, s22, 49152
 s_add_u32 m0, s22, 0
 s_nop 0
 buffer_load_dwordx4 v40, s[12:15], s21 offen lds
 s_add_u32 m0, s22, 1024
 s_nop 0
 buffer_load_dwordx4 v41, s[12:15], s21 offen lds
 s_add_u32 m0, s22, 2048
 s_nop 0
 buffer_load_dwordx4 v42, s[12:15], s21 offen lds
 s_mul_i32 s21, s20, 393216
 s_add_u32 s21, s21, 4816896
 s_add_u32 s21, s21, s44
 s_mul_i32 s22, s20, 12288
 s_add_u32 s22, s22, 52224
 s_add_u32 m0, s22, 0
 s_nop 0
 buffer_load_dwordx4 v43, s[12:15], s21 offen lds
 s_add_u32 m0, s22, 1024
 s_nop 0
 buffer_load_dwordx4 v44, s[12:15], s21 offen lds
 s_add_u32 m0, s22, 2048
 s_nop 0
 buffer_load_dwordx4 v45, s[12:15], s21 offen lds
 s_mul_i32 s21, s20, 393216
 s_add_u32 s21, s21, 4915200
 s_add_u32 s21, s21, s44
 s_mul_i32 s22, s20, 12288
 s_add_u32 s22, s22, 55296
 s_add_u32 m0, s22, 0
 s_nop 0
 buffer_load_dwordx4 v40, s[12:15], s21 offen lds
 s_add_u32 m0, s22, 1024
 s_nop 0
 buffer_load_dwordx4 v41, s[12:15], s21 offen lds
 s_add_u32 m0, s22, 2048
 s_nop 0
 buffer_load_dwordx4 v42, s[12:15], s21 offen lds
 s_mul_i32 s21, s20, 393216
 s_add_u32 s21, s21, 5013504
 s_add_u32 s21, s21, s44
 s_mul_i32 s22, s20, 12288
 s_add_u32 s22, s22, 58368
 s_add_u32 m0, s22, 0
 s_nop 0
 buffer_load_dwordx4 v43, s[12:15], s21 offen lds
 s_add_u32 m0, s22, 1024
 s_nop 0
 buffer_load_dwordx4 v44, s[12:15], s21 offen lds
 s_add_u32 m0, s22, 2048
 s_nop 0
 buffer_load_dwordx4 v45, s[12:15], s21 offen lds
 s_mov_b32 m0, s23
 v_mfma_f32_16x16x32_bf16 v[64:67], a[48:51], v[160:163], v[64:67]
 ds_read_b128 v[192:195], v19 offset:0
 v_mfma_f32_16x16x32_bf16 v[68:71], a[52:55], v[160:163], v[68:71]
 v_add_u32 v18, s33, v14
 v_mfma_f32_16x16x32_bf16 v[72:75], a[56:59], v[160:163], v[72:75]
 v_mfma_f32_16x16x32_bf16 v[76:79], a[48:51], v[164:167], v[76:79]
 ds_read_b128 v[196:199], v19 offset:2048
 v_mfma_f32_16x16x32_bf16 v[80:83], a[52:55], v[164:167], v[80:83]
 buffer_load_dwordx4 v11, s[8:11], s30 offen offset:1024 lds
 v_mfma_f32_16x16x32_bf16 v[84:87], a[56:59], v[164:167], v[84:87]
 s_add_u32 s30, s30, 128
 v_mfma_f32_16x16x32_bf16 v[88:91], a[48:51], v[168:171], v[88:91]
 ds_read_b128 v[200:203], v19 offset:4096
 s_add_u32 m0, m0, 8192
 v_mfma_f32_16x16x32_bf16 v[92:95], a[52:55], v[168:171], v[92:95]
 s_cmp_lt_u32 m0, s46
 s_cselect_b32 m0, m0, s47
 v_mfma_f32_16x16x32_bf16 v[96:99], a[56:59], v[168:171], v[96:99]
 v_mfma_f32_16x16x32_bf16 v[100:103], a[48:51], v[172:175], v[100:103]
 ds_read_b128 v[204:207], v19 offset:6144
 v_mfma_f32_16x16x32_bf16 v[104:107], a[52:55], v[172:175], v[104:107]
 v_mfma_f32_16x16x32_bf16 v[108:111], a[56:59], v[172:175], v[108:111]
 s_waitcnt vmcnt(44) lgkmcnt(2)
 s_barrier
 v_mfma_f32_16x16x32_bf16 v[64:67], a[60:63], v[192:195], v[64:67]
 ds_read_b128 v[160:163], v18 offset:0
 v_mfma_f32_16x16x32_bf16 v[68:71], a[64:67], v[192:195], v[68:71]
 v_mfma_f32_16x16x32_bf16 v[72:75], a[68:71], v[192:195], v[72:75]
 v_add_u32 v19, s33, v15
 s_add_u32 s33, s33, 8192
 v_mfma_f32_16x16x32_bf16 v[76:79], a[60:63], v[196:199], v[76:79]
 ds_read_b128 v[164:167], v18 offset:2048
 v_mfma_f32_16x16x32_bf16 v[80:83], a[64:67], v[196:199], v[80:83]
 buffer_load_dwordx4 v10, s[8:11], s30 offen offset:0 lds
 v_mfma_f32_16x16x32_bf16 v[84:87], a[68:71], v[196:199], v[84:87]
 s_waitcnt lgkmcnt(2)
 v_mfma_f32_16x16x32_bf16 v[88:91], a[60:63], v[200:203], v[88:91]
 ds_read_b128 v[168:171], v18 offset:4096
 v_mfma_f32_16x16x32_bf16 v[92:95], a[64:67], v[200:203], v[92:95]
 s_cmp_lt_u32 s33, 155648
 s_cselect_b32 s33, s33, 98304
 v_mfma_f32_16x16x32_bf16 v[96:99], a[68:71], v[200:203], v[96:99]
 v_mfma_f32_16x16x32_bf16 v[100:103], a[60:63], v[204:207], v[100:103]
 ds_read_b128 v[172:175], v18 offset:6144
 v_mfma_f32_16x16x32_bf16 v[104:107], a[64:67], v[204:207], v[104:107]
 v_mfma_f32_16x16x32_bf16 v[108:111], a[68:71], v[204:207], v[108:111]
 s_waitcnt lgkmcnt(2)
 v_mfma_f32_16x16x32_bf16 v[64:67], a[72:75], v[160:163], v[64:67]
 ds_read_b128 v[192:195], v19 offset:0
 v_mfma_f32_16x16x32_bf16 v[68:71], a[76:79], v[160:163], v[68:71]
 v_add_u32 v18, s33, v14
 v_mfma_f32_16x16x32_bf16 v[72:75], a[80:83], v[160:163], v[72:75]
 v_mfma_f32_16x16x32_bf16 v[76:79], a[72:75], v[164:167], v[76:79]
 ds_read_b128 v[196:199], v19 offset:2048
 v_mfma_f32_16x16x32_bf16 v[80:83], a[76:79], v[164:167], v[80:83]
 buffer_load_dwordx4 v11, s[8:11], s30 offen offset:1024 lds
 v_mfma_f32_16x16x32_bf16 v[84:87], a[80:83], v[164:167], v[84:87]
 s_waitcnt lgkmcnt(2)
 s_add_u32 s30, s30, 128
 v_mfma_f32_16x16x32_bf16 v[88:91], a[72:75], v[168:171], v[88:91]
 ds_read_b128 v[200:203], v19 offset:4096
 s_add_u32 m0, m0, 8192
 v_mfma_f32_16x16x32_bf16 v[92:95], a[76:79], v[168:171], v[92:95]
 s_cmp_lt_u32 m0, s46
 s_cselect_b32 m0, m0, s47
 v_mfma_f32_16x16x32_bf16 v[96:99], a[80:83], v[168:171], v[96:99]
 v_mfma_f32_16x16x32_bf16 v[100:103], a[72:75], v[172:175], v[100:103]
 ds_read_b128 v[204:207], v19 offset:6144
 v_mfma_f32_16x16x32_bf16 v[104:107], a[76:79], v[172:175], v[104:107]
 v_mfma_f32_16x16x32_bf16 v[108:111], a[80:83], v[172:175], v[108:111]
 s_waitcnt vmcnt(44) lgkmcnt(2)
 s_barrier
 v_mfma_f32_16x16x32_bf16 v[64:67], a[84:87], v[192:195], v[64:67]
 ds_read_b128 v[160:163], v18 offset:0
 v_mfma_f32_16x16x32_bf16 v[68:71], a[88:91], v[192:195], v[68:71]
 v_mfma_f32_16x16x32_bf16 v[72:75], a[92:95], v[192:195], v[72:75]
 v_add_u32 v19, s33, v15
 s_add_u32 s33, s33, 8192
 v_mfma_f32_16x16x32_bf16 v[76:79], a[84:87], v[196:199], v[76:79]
 ds_read_b128 v[164:167], v18 offset:2048
 v_mfma_f32_16x16x32_bf16 v[80:83], a[88:91], v[196:199], v[80:83]
 buffer_load_dwordx4 v10, s[8:11], s30 offen offset:0 lds
 v_mfma_f32_16x16x32_bf16 v[84:87], a[92:95], v[196:199], v[84:87]
 s_waitcnt lgkmcnt(2)
 v_mfma_f32_16x16x32_bf16 v[88:91], a[84:87], v[200:203], v[88:91]
 ds_read_b128 v[168:171], v18 offset:4096
 v_mfma_f32_16x16x32_bf16 v[92:95], a[88:91], v[200:203], v[92:95]
 s_cmp_lt_u32 s33, 155648
 s_cselect_b32 s33, s33, 98304
 v_mfma_f32_16x16x32_bf16 v[96:99], a[92:95], v[200:203], v[96:99]
 v_mfma_f32_16x16x32_bf16 v[100:103], a[84:87], v[204:207], v[100:103]
 ds_read_b128 v[172:175], v18 offset:6144
 v_mfma_f32_16x16x32_bf16 v[104:107], a[88:91], v[204:207], v[104:107]
 v_mfma_f32_16x16x32_bf16 v[108:111], a[92:95], v[204:207], v[108:111]
 s_waitcnt lgkmcnt(2)
 s_waitcnt vmcnt(20)
 s_barrier
 ds_read_b64_tr_b16 a[96:97], v46 offset:0
 ds_read_b64_tr_b16 a[98:99], v46 offset:1536
 ds_read_b64_tr_b16 a[100:101], v47 offset:0
 ds_read_b64_tr_b16 a[102:103], v47 offset:1536
 ds_read_b64_tr_b16 a[104:105], v48 offset:0
 ds_read_b64_tr_b16 a[106:107], v48 offset:1536
 ds_read_b64_tr_b16 a[108:109], v46 offset:12288
 ds_read_b64_tr_b16 a[110:111], v46 offset:13824
 ds_read_b64_tr_b16 a[112:113], v47 offset:12288
 ds_read_b64_tr_b16 a[114:115], v47 offset:13824
 ds_read_b64_tr_b16 a[116:117], v48 offset:12288
 ds_read_b64_tr_b16 a[118:119], v48 offset:13824
 ds_read_b64_tr_b16 a[120:121], v46 offset:24576
 ds_read_b64_tr_b16 a[122:123], v46 offset:26112
 ds_read_b64_tr_b16 a[124:125], v47 offset:24576
 ds_read_b64_tr_b16 a[126:127], v47 offset:26112
 ds_read_b64_tr_b16 a[128:129], v48 offset:24576
 ds_read_b64_tr_b16 a[130:131], v48 offset:26112
 ds_read_b64_tr_b16 a[132:133], v46 offset:36864
 ds_read_b64_tr_b16 a[134:135], v46 offset:38400
 ds_read_b64_tr_b16 a[136:137], v47 offset:36864
 ds_read_b64_tr_b16 a[138:139], v47 offset:38400
 ds_read_b64_tr_b16 a[140:141], v48 offset:36864
 ds_read_b64_tr_b16 a[142:143], v48 offset:38400
 s_waitcnt lgkmcnt(0)
 s_barrier
 s_mov_b32 s23, m0
 s_mul_i32 s21, s20, 393216
 s_add_u32 s21, s21, 6291456
 s_add_u32 s21, s21, s44
 s_mul_i32 s22, s20, 12288
 s_add_u32 s22, s22, 0
 s_add_u32 m0, s22, 0
 s_nop 0
 buffer_load_dwordx4 v40, s[12:15], s21 offen lds
 s_add_u32 m0, s22, 1024
 s_nop 0
 buffer_load_dwordx4 v41, s[12:15], s21 offen lds
 s_add_u32 m0, s22, 2048
 s_nop 0
 buffer_load_dwordx4 v42, s[12:15], s21 offen lds
 s_mul_i32 s21, s20, 393216
 s_add_u32 s21, s21, 6389760
 s_add_u32 s21, s21, s44
 s_mul_i32 s22, s20, 12288
 s_add_u32 s22, s22, 3072
 s_add_u32 m0, s22, 0
 s_nop 0
 buffer_load_dwordx4 v43, s[12:15], s21 offen lds
 s_add_u32 m0, s22, 1024
 s_nop 0
 buffer_load_dwordx4 v44, s[12:15], s21 offen lds
 s_add_u32 m0, s22, 2048
 s_nop 0
 buffer_load_dwordx4 v45, s[12:15], s21 offen lds
 s_mul_i32 s21, s20, 393216
 s_add_u32 s21, s21, 6488064
 s_add_u32 s21, s21, s44
 s_mul_i32 s22, s20, 12288
 s_add_u32 s22, s22, 6144
 s_add_u32 m0, s22, 0
 s_nop 0
 buffer_load_dwordx4 v40, s[12:15], s21 offen lds
 s_add_u32 m0, s22, 1024
 s_nop 0
 buffer_load_dwordx4 v41, s[12:15], s21 offen lds
 s_add_u32 m0, s22, 2048
 s_nop 0
 buffer_load_dwordx4 v42, s[12:15], s21 offen lds
 s_mul_i32 s21, s20, 393216
 s_add_u32 s21, s21, 6586368
 s_add_u32 s21, s21, s44
 s_mul_i32 s22, s20, 12288
 s_add_u32 s22, s22, 9216
 s_add_u32 m0, s22, 0
 s_nop 0
 buffer_load_dwordx4 v43, s[12:15], s21 offen lds
 s_add_u32 m0, s22, 1024
 s_nop 0
 buffer_load_dwordx4 v44, s[12:15], s21 offen lds
 s_add_u32 m0, s22, 2048
 s_nop 0
 buffer_load_dwordx4 v45, s[12:15], s21 offen lds
 s_mov_b32 m0, s23
 v_mov_b32 v29, 76
 buffer_load_dword v29, v29, s[64:67], 0 offen sc1
 v_mfma_f32_16x16x32_bf16 v[64:67], a[96:99], v[160:163], v[64:67]
 ds_read_b128 v[192:195], v19 offset:0
 v_mfma_f32_16x16x32_bf16 v[68:71], a[100:103], v[160:163], v[68:71]
 v_add_u32 v18, s33, v14
 s_mov_b32 s61, s60
 v_mfma_f32_16x16x32_bf16 v[72:75], a[104:107], v[160:163], v[72:75]
 s_add_u32 s60, s60, s62
 s_lshr_b32 s48, s20, 1
 v_mfma_f32_16x16x32_bf16 v[76:79], a[96:99], v[164:167], v[76:79]
 ds_read_b128 v[196:199], v19 offset:2048
 s_mul_i32 s48, s48, 393216
 v_mfma_f32_16x16x32_bf16 v[80:83], a[100:103], v[164:167], v[80:83]
 buffer_load_dwordx4 v11, s[8:11], s30 offen offset:1024 lds
 v_mfma_f32_16x16x32_bf16 v[84:87], a[104:107], v[164:167], v[84:87]
 s_add_u32 s30, s30, s25
 v_mfma_f32_16x16x32_bf16 v[88:91], a[96:99], v[168:171], v[88:91]
 ds_read_b128 v[200:203], v19 offset:4096
 s_sub_u32 s30, s30, 1152
 v_mfma_f32_16x16x32_bf16 v[92:95], a[100:103], v[168:171], v[92:95]
 s_add_u32 m0, m0, 8192
 s_and_b32 s21, s20, 1
 v_mfma_f32_16x16x32_bf16 v[96:99], a[104:107], v[168:171], v[96:99]
 s_cmp_lt_u32 m0, s46
 s_cselect_b32 m0, m0, s47
 v_mfma_f32_16x16x32_bf16 v[100:103], a[96:99], v[172:175], v[100:103]
 ds_read_b128 v[204:207], v19 offset:6144
 s_mul_i32 s21, s21, 6144
 v_mfma_f32_16x16x32_bf16 v[104:107], a[100:103], v[172:175], v[104:107]
 s_add_u32 s48, s48, s21
 s_add_u32 s48, s48, s27
 v_mfma_f32_16x16x32_bf16 v[108:111], a[104:107], v[172:175], v[108:111]
 s_waitcnt vmcnt(33) lgkmcnt(2)
 s_barrier
 v_mfma_f32_16x16x32_bf16 v[64:67], a[108:111], v[192:195], v[64:67]
 ds_read_b128 v[160:163], v18 offset:0
 s_add_u32 s27, s27, s28
 v_mfma_f32_16x16x32_bf16 v[68:71], a[112:115], v[192:195], v[68:71]
 s_sub_u32 s26, s26, 1
 v_mfma_f32_16x16x32_bf16 v[72:75], a[116:119], v[192:195], v[72:75]
 v_add_u32 v19, s33, v15
 s_add_u32 s33, s33, 8192
 v_mfma_f32_16x16x32_bf16 v[76:79], a[108:111], v[196:199], v[76:79]
 ds_read_b128 v[164:167], v18 offset:2048
 v_mfma_f32_16x16x32_bf16 v[80:83], a[112:115], v[196:199], v[80:83]
 buffer_load_dwordx4 v10, s[8:11], s30 offen offset:0 lds
 v_mfma_f32_16x16x32_bf16 v[84:87], a[116:119], v[196:199], v[84:87]
 s_waitcnt lgkmcnt(2)
 v_mfma_f32_16x16x32_bf16 v[88:91], a[108:111], v[200:203], v[88:91]
 ds_read_b128 v[168:171], v18 offset:4096
 v_mfma_f32_16x16x32_bf16 v[92:95], a[112:115], v[200:203], v[92:95]
 s_cmp_lt_u32 s33, 155648
 s_cselect_b32 s33, s33, 98304
 v_mfma_f32_16x16x32_bf16 v[96:99], a[116:119], v[200:203], v[96:99]
 v_mfma_f32_16x16x32_bf16 v[100:103], a[108:111], v[204:207], v[100:103]
 ds_read_b128 v[172:175], v18 offset:6144
 v_mfma_f32_16x16x32_bf16 v[104:107], a[112:115], v[204:207], v[104:107]
 v_mfma_f32_16x16x32_bf16 v[108:111], a[116:119], v[204:207], v[108:111]
 s_waitcnt lgkmcnt(2)
 v_mfma_f32_16x16x32_bf16 v[64:67], a[120:123], v[160:163], v[64:67]
 ds_read_b128 v[192:195], v19 offset:0
 v_mfma_f32_16x16x32_bf16 v[68:71], a[124:127], v[160:163], v[68:71]
 v_add_u32 v18, s33, v14
 v_mfma_f32_16x16x32_bf16 v[72:75], a[128:131], v[160:163], v[72:75]
 v_mfma_f32_16x16x32_bf16 v[76:79], a[120:123], v[164:167], v[76:79]
 ds_read_b128 v[196:199], v19 offset:2048
 v_mfma_f32_16x16x32_bf16 v[80:83], a[124:127], v[164:167], v[80:83]
 buffer_load_dwordx4 v11, s[8:11], s30 offen offset:1024 lds
 v_mfma_f32_16x16x32_bf16 v[84:87], a[128:131], v[164:167], v[84:87]
 s_waitcnt lgkmcnt(2)
 s_add_u32 s30, s30, 128
 v_mfma_f32_16x16x32_bf16 v[88:91], a[120:123], v[168:171], v[88:91]
 ds_read_b128 v[200:203], v19 offset:4096
 s_add_u32 m0, m0, 8192
 v_mfma_f32_16x16x32_bf16 v[92:95], a[124:127], v[168:171], v[92:95]
 s_cmp_lt_u32 m0, s46
 s_cselect_b32 m0, m0, s47
 v_mfma_f32_16x16x32_bf16 v[96:99], a[128:131], v[168:171], v[96:99]
 v_mfma_f32_16x16x32_bf16 v[100:103], a[120:123], v[172:175], v[100:103]
 ds_read_b128 v[204:207], v19 offset:6144
 v_mfma_f32_16x16x32_bf16 v[104:107], a[124:127], v[172:175], v[104:107]
 v_mfma_f32_16x16x32_bf16 v[108:111], a[128:131], v[172:175], v[108:111]
 s_waitcnt vmcnt(33) lgkmcnt(2)
 s_barrier
 v_mfma_f32_16x16x32_bf16 v[64:67], a[132:135], v[192:195], v[64:67]
 ds_read_b128 v[160:163], v18 offset:0
 v_mfma_f32_16x16x32_bf16 v[68:71], a[136:139], v[192:195], v[68:71]
 v_mfma_f32_16x16x32_bf16 v[72:75], a[140:143], v[192:195], v[72:75]
 v_add_u32 v19, s33, v15
 s_add_u32 s33, s33, 8192
 v_mfma_f32_16x16x32_bf16 v[76:79], a[132:135], v[196:199], v[76:79]
 ds_read_b128 v[164:167], v18 offset:2048
 v_mfma_f32_16x16x32_bf16 v[80:83], a[136:139], v[196:199], v[80:83]
 buffer_load_dwordx4 v10, s[8:11], s30 offen offset:0 lds
 v_mfma_f32_16x16x32_bf16 v[84:87], a[140:143], v[196:199], v[84:87]
 s_waitcnt lgkmcnt(2)
 v_mfma_f32_16x16x32_bf16 v[88:91], a[132:135], v[200:203], v[88:91]
 ds_read_b128 v[168:171], v18 offset:4096
 v_mfma_f32_16x16x32_bf16 v[92:95], a[136:139], v[200:203], v[92:95]
 s_cmp_lt_u32 s33, 155648
 s_cselect_b32 s33, s33, 98304
 v_mfma_f32_16x16x32_bf16 v[96:99], a[140:143], v[200:203], v[96:99]
 v_mfma_f32_16x16x32_bf16 v[100:103], a[132:135], v[204:207], v[100:103]
 ds_read_b128 v[172:175], v18 offset:6144
 v_mfma_f32_16x16x32_bf16 v[104:107], a[136:139], v[204:207], v[104:107]
 v_mfma_f32_16x16x32_bf16 v[108:111], a[140:143], v[204:207], v[108:111]
 s_waitcnt lgkmcnt(2)
 s_waitcnt vmcnt(21)
 s_barrier
 ds_read_b64_tr_b16 a[144:145], v49 offset:0
 ds_read_b64_tr_b16 a[146:147], v49 offset:1536
 ds_read_b64_tr_b16 a[148:149], v50 offset:0
 ds_read_b64_tr_b16 a[150:151], v50 offset:1536
 ds_read_b64_tr_b16 a[152:153], v51 offset:0
 ds_read_b64_tr_b16 a[154:155], v51 offset:1536
 ds_read_b64_tr_b16 a[156:157], v49 offset:12288
 ds_read_b64_tr_b16 a[158:159], v49 offset:13824
 ds_read_b64_tr_b16 a[160:161], v50 offset:12288
 ds_read_b64_tr_b16 a[162:163], v50 offset:13824
 ds_read_b64_tr_b16 a[164:165], v51 offset:12288
 ds_read_b64_tr_b16 a[166:167], v51 offset:13824
 ds_read_b64_tr_b16 a[168:169], v49 offset:24576
 ds_read_b64_tr_b16 a[170:171], v49 offset:26112
 ds_read_b64_tr_b16 a[172:173], v50 offset:24576
 ds_read_b64_tr_b16 a[174:175], v50 offset:26112
 ds_read_b64_tr_b16 a[176:177], v51 offset:24576
 ds_read_b64_tr_b16 a[178:179], v51 offset:26112
 ds_read_b64_tr_b16 a[180:181], v49 offset:36864
 ds_read_b64_tr_b16 a[182:183], v49 offset:38400
 ds_read_b64_tr_b16 a[184:185], v50 offset:36864
 ds_read_b64_tr_b16 a[186:187], v50 offset:38400
 ds_read_b64_tr_b16 a[188:189], v51 offset:36864
 ds_read_b64_tr_b16 a[190:191], v51 offset:38400
 s_waitcnt lgkmcnt(0)
 s_barrier
 v_mfma_f32_16x16x32_bf16 v[64:67], a[144:147], v[160:163], v[64:67]
 ds_read_b128 v[192:195], v19 offset:0
 v_mfma_f32_16x16x32_bf16 v[68:71], a[148:151], v[160:163], v[68:71]
 v_add_u32 v18, s33, v14
 v_mfma_f32_16x16x32_bf16 v[72:75], a[152:155], v[160:163], v[72:75]
 v_mfma_f32_16x16x32_bf16 v[76:79], a[144:147], v[164:167], v[76:79]
 ds_read_b128 v[196:199], v19 offset:2048
 v_mfma_f32_16x16x32_bf16 v[80:83], a[148:151], v[164:167], v[80:83]
 buffer_load_dwordx4 v11, s[8:11], s30 offen offset:1024 lds
 v_mfma_f32_16x16x32_bf16 v[84:87], a[152:155], v[164:167], v[84:87]
 s_add_u32 s30, s30, 128
 v_mfma_f32_16x16x32_bf16 v[88:91], a[144:147], v[168:171], v[88:91]
 ds_read_b128 v[200:203], v19 offset:4096
 s_add_u32 m0, m0, 8192
 v_mfma_f32_16x16x32_bf16 v[92:95], a[148:151], v[168:171], v[92:95]
 s_cmp_lt_u32 m0, s46
 s_cselect_b32 m0, m0, s47
 v_mfma_f32_16x16x32_bf16 v[96:99], a[152:155], v[168:171], v[96:99]
 v_mfma_f32_16x16x32_bf16 v[100:103], a[144:147], v[172:175], v[100:103]
 ds_read_b128 v[204:207], v19 offset:6144
 v_mfma_f32_16x16x32_bf16 v[104:107], a[148:151], v[172:175], v[104:107]
 v_mfma_f32_16x16x32_bf16 v[108:111], a[152:155], v[172:175], v[108:111]
 s_waitcnt vmcnt(21) lgkmcnt(2)
 s_barrier
 v_mfma_f32_16x16x32_bf16 v[64:67], a[156:159], v[192:195], v[64:67]
 ds_read_b128 v[160:163], v18 offset:0
 v_mfma_f32_16x16x32_bf16 v[68:71], a[160:163], v[192:195], v[68:71]
 v_mfma_f32_16x16x32_bf16 v[72:75], a[164:167], v[192:195], v[72:75]
 v_add_u32 v19, s33, v15
 s_add_u32 s33, s33, 8192
 v_mfma_f32_16x16x32_bf16 v[76:79], a[156:159], v[196:199], v[76:79]
 ds_read_b128 v[164:167], v18 offset:2048
 v_mfma_f32_16x16x32_bf16 v[80:83], a[160:163], v[196:199], v[80:83]
 buffer_load_dwordx4 v10, s[8:11], s30 offen offset:0 lds
 v_mfma_f32_16x16x32_bf16 v[84:87], a[164:167], v[196:199], v[84:87]
 s_waitcnt lgkmcnt(2)
 v_mfma_f32_16x16x32_bf16 v[88:91], a[156:159], v[200:203], v[88:91]
 ds_read_b128 v[168:171], v18 offset:4096
 v_mfma_f32_16x16x32_bf16 v[92:95], a[160:163], v[200:203], v[92:95]
 s_cmp_lt_u32 s33, 155648
 s_cselect_b32 s33, s33, 98304
 v_mfma_f32_16x16x32_bf16 v[96:99], a[164:167], v[200:203], v[96:99]
 v_mfma_f32_16x16x32_bf16 v[100:103], a[156:159], v[204:207], v[100:103]
 ds_read_b128 v[172:175], v18 offset:6144
 v_mfma_f32_16x16x32_bf16 v[104:107], a[160:163], v[204:207], v[104:107]
 v_mfma_f32_16x16x32_bf16 v[108:111], a[164:167], v[204:207], v[108:111]
 s_waitcnt lgkmcnt(2)
 v_mfma_f32_16x16x32_bf16 v[64:67], a[168:171], v[160:163], v[64:67]
 ds_read_b128 v[192:195], v19 offset:0
 v_mfma_f32_16x16x32_bf16 v[68:71], a[172:175], v[160:163], v[68:71]
 v_add_u32 v18, s33, v14
 v_mfma_f32_16x16x32_bf16 v[72:75], a[176:179], v[160:163], v[72:75]
 v_mfma_f32_16x16x32_bf16 v[76:79], a[168:171], v[164:167], v[76:79]
 ds_read_b128 v[196:199], v19 offset:2048
 v_mfma_f32_16x16x32_bf16 v[80:83], a[172:175], v[164:167], v[80:83]
 buffer_load_dwordx4 v11, s[8:11], s30 offen offset:1024 lds
 v_mfma_f32_16x16x32_bf16 v[84:87], a[176:179], v[164:167], v[84:87]
 s_waitcnt lgkmcnt(2)
 s_add_u32 s30, s30, 128
 v_mfma_f32_16x16x32_bf16 v[88:91], a[168:171], v[168:171], v[88:91]
 ds_read_b128 v[200:203], v19 offset:4096
 s_add_u32 m0, m0, 8192
 v_mfma_f32_16x16x32_bf16 v[92:95], a[172:175], v[168:171], v[92:95]
 s_cmp_lt_u32 m0, s46
 s_cselect_b32 m0, m0, s47
 v_mfma_f32_16x16x32_bf16 v[96:99], a[176:179], v[168:171], v[96:99]
 v_mfma_f32_16x16x32_bf16 v[100:103], a[168:171], v[172:175], v[100:103]
 ds_read_b128 v[204:207], v19 offset:6144
 v_mfma_f32_16x16x32_bf16 v[104:107], a[172:175], v[172:175], v[104:107]
 v_mfma_f32_16x16x32_bf16 v[108:111], a[176:179], v[172:175], v[108:111]
 s_waitcnt vmcnt(21) lgkmcnt(2)
 s_barrier
 v_mfma_f32_16x16x32_bf16 v[64:67], a[180:183], v[192:195], v[64:67]
 ds_read_b128 v[160:163], v18 offset:0
 v_mfma_f32_16x16x32_bf16 v[68:71], a[184:187], v[192:195], v[68:71]
 v_mfma_f32_16x16x32_bf16 v[72:75], a[188:191], v[192:195], v[72:75]
 v_add_u32 v19, s33, v15
 s_add_u32 s33, s33, 8192
 v_mfma_f32_16x16x32_bf16 v[76:79], a[180:183], v[196:199], v[76:79]
 ds_read_b128 v[164:167], v18 offset:2048
 v_mfma_f32_16x16x32_bf16 v[80:83], a[184:187], v[196:199], v[80:83]
 buffer_load_dwordx4 v10, s[8:11], s30 offen offset:0 lds
 v_mfma_f32_16x16x32_bf16 v[84:87], a[188:191], v[196:199], v[84:87]
 s_waitcnt lgkmcnt(2)
 v_mfma_f32_16x16x32_bf16 v[88:91], a[180:183], v[200:203], v[88:91]
 ds_read_b128 v[168:171], v18 offset:4096
 v_mfma_f32_16x16x32_bf16 v[92:95], a[184:187], v[200:203], v[92:95]
 s_cmp_lt_u32 s33, 155648
 s_cselect_b32 s33, s33, 98304
 v_mfma_f32_16x16x32_bf16 v[96:99], a[188:191], v[200:203], v[96:99]
 v_mfma_f32_16x16x32_bf16 v[100:103], a[180:183], v[204:207], v[100:103]
 ds_read_b128 v[172:175], v18 offset:6144
 v_mfma_f32_16x16x32_bf16 v[104:107], a[184:187], v[204:207], v[104:107]
 v_mfma_f32_16x16x32_bf16 v[108:111], a[188:191], v[204:207], v[108:111]
 s_waitcnt lgkmcnt(2)
 s_waitcnt vmcnt(9)
 s_barrier
 ds_read_b64_tr_b16 a[192:193], v46 offset:0
 ds_read_b64_tr_b16 a[194:195], v46 offset:1536
 ds_read_b64_tr_b16 a[196:197], v47 offset:0
 ds_read_b64_tr_b16 a[198:199], v47 offset:1536
 ds_read_b64_tr_b16 a[200:201], v48 offset:0
 ds_read_b64_tr_b16 a[202:203], v48 offset:1536
 ds_read_b64_tr_b16 a[204:205], v46 offset:12288
 ds_read_b64_tr_b16 a[206:207], v46 offset:13824
 ds_read_b64_tr_b16 a[208:209], v47 offset:12288
 ds_read_b64_tr_b16 a[210:211], v47 offset:13824
 ds_read_b64_tr_b16 a[212:213], v48 offset:12288
 ds_read_b64_tr_b16 a[214:215], v48 offset:13824
 ds_read_b64_tr_b16 a[216:217], v46 offset:24576
 ds_read_b64_tr_b16 a[218:219], v46 offset:26112
 ds_read_b64_tr_b16 a[220:221], v47 offset:24576
 ds_read_b64_tr_b16 a[222:223], v47 offset:26112
 ds_read_b64_tr_b16 a[224:225], v48 offset:24576
 ds_read_b64_tr_b16 a[226:227], v48 offset:26112
 ds_read_b64_tr_b16 a[228:229], v46 offset:36864
 ds_read_b64_tr_b16 a[230:231], v46 offset:38400
 ds_read_b64_tr_b16 a[232:233], v47 offset:36864
 ds_read_b64_tr_b16 a[234:235], v47 offset:38400
 ds_read_b64_tr_b16 a[236:237], v48 offset:36864
 ds_read_b64_tr_b16 a[238:239], v48 offset:38400
 s_waitcnt lgkmcnt(0)
 s_barrier
 v_mfma_f32_16x16x32_bf16 v[64:67], a[192:195], v[160:163], v[64:67]
 ds_read_b128 v[192:195], v19 offset:0
 v_mfma_f32_16x16x32_bf16 v[68:71], a[196:199], v[160:163], v[68:71]
 v_add_u32 v18, s33, v14
 v_mfma_f32_16x16x32_bf16 v[72:75], a[200:203], v[160:163], v[72:75]
 v_mfma_f32_16x16x32_bf16 v[76:79], a[192:195], v[164:167], v[76:79]
 ds_read_b128 v[196:199], v19 offset:2048
 v_mfma_f32_16x16x32_bf16 v[80:83], a[196:199], v[164:167], v[80:83]
 buffer_load_dwordx4 v11, s[8:11], s30 offen offset:1024 lds
 v_mfma_f32_16x16x32_bf16 v[84:87], a[200:203], v[164:167], v[84:87]
 s_add_u32 s30, s30, 128
 v_mfma_f32_16x16x32_bf16 v[88:91], a[192:195], v[168:171], v[88:91]
 ds_read_b128 v[200:203], v19 offset:4096
 s_add_u32 m0, m0, 8192
 v_mfma_f32_16x16x32_bf16 v[92:95], a[196:199], v[168:171], v[92:95]
 s_cmp_lt_u32 m0, s46
 s_cselect_b32 m0, m0, s47
 v_mfma_f32_16x16x32_bf16 v[96:99], a[200:203], v[168:171], v[96:99]
 v_mfma_f32_16x16x32_bf16 v[100:103], a[192:195], v[172:175], v[100:103]
 ds_read_b128 v[204:207], v19 offset:6144
 v_mfma_f32_16x16x32_bf16 v[104:107], a[196:199], v[172:175], v[104:107]
 v_mfma_f32_16x16x32_bf16 v[108:111], a[200:203], v[172:175], v[108:111]
 s_waitcnt vmcnt(8) lgkmcnt(2)
 s_barrier
 v_mfma_f32_16x16x32_bf16 v[64:67], a[204:207], v[192:195], v[64:67]
 ds_read_b128 v[160:163], v18 offset:0
 v_mfma_f32_16x16x32_bf16 v[68:71], a[208:211], v[192:195], v[68:71]
 v_mfma_f32_16x16x32_bf16 v[72:75], a[212:215], v[192:195], v[72:75]
 v_add_u32 v19, s33, v15
 s_add_u32 s33, s33, 8192
 v_mfma_f32_16x16x32_bf16 v[76:79], a[204:207], v[196:199], v[76:79]
 ds_read_b128 v[164:167], v18 offset:2048
 v_mfma_f32_16x16x32_bf16 v[80:83], a[208:211], v[196:199], v[80:83]
 buffer_load_dwordx4 v10, s[8:11], s30 offen offset:0 lds
 v_mfma_f32_16x16x32_bf16 v[84:87], a[212:215], v[196:199], v[84:87]
 s_waitcnt lgkmcnt(2)
 v_mfma_f32_16x16x32_bf16 v[88:91], a[204:207], v[200:203], v[88:91]
 ds_read_b128 v[168:171], v18 offset:4096
 v_mfma_f32_16x16x32_bf16 v[92:95], a[208:211], v[200:203], v[92:95]
 s_cmp_lt_u32 s33, 155648
 s_cselect_b32 s33, s33, 98304
 v_mfma_f32_16x16x32_bf16 v[96:99], a[212:215], v[200:203], v[96:99]
 v_mfma_f32_16x16x32_bf16 v[100:103], a[204:207], v[204:207], v[100:103]
 ds_read_b128 v[172:175], v18 offset:6144
 v_mfma_f32_16x16x32_bf16 v[104:107], a[208:211], v[204:207], v[104:107]
 v_mfma_f32_16x16x32_bf16 v[108:111], a[212:215], v[204:207], v[108:111]
 s_waitcnt lgkmcnt(2)
 v_mfma_f32_16x16x32_bf16 v[64:67], a[216:219], v[160:163], v[64:67]
 ds_read_b128 v[192:195], v19 offset:0
 v_mfma_f32_16x16x32_bf16 v[68:71], a[220:223], v[160:163], v[68:71]
 v_add_u32 v18, s33, v14
 v_mfma_f32_16x16x32_bf16 v[72:75], a[224:227], v[160:163], v[72:75]
 v_mfma_f32_16x16x32_bf16 v[76:79], a[216:219], v[164:167], v[76:79]
 ds_read_b128 v[196:199], v19 offset:2048
 v_mfma_f32_16x16x32_bf16 v[80:83], a[220:223], v[164:167], v[80:83]
 buffer_load_dwordx4 v11, s[8:11], s30 offen offset:1024 lds
 v_mfma_f32_16x16x32_bf16 v[84:87], a[224:227], v[164:167], v[84:87]
 s_waitcnt lgkmcnt(2)
 s_add_u32 s30, s30, 128
 v_mfma_f32_16x16x32_bf16 v[88:91], a[216:219], v[168:171], v[88:91]
 ds_read_b128 v[200:203], v19 offset:4096
 s_add_u32 m0, m0, 8192
 v_mfma_f32_16x16x32_bf16 v[92:95], a[220:223], v[168:171], v[92:95]
 s_cmp_lt_u32 m0, s46
 s_cselect_b32 m0, m0, s47
 v_mfma_f32_16x16x32_bf16 v[96:99], a[224:227], v[168:171], v[96:99]
 v_mfma_f32_16x16x32_bf16 v[100:103], a[216:219], v[172:175], v[100:103]
 ds_read_b128 v[204:207], v19 offset:6144
 v_mfma_f32_16x16x32_bf16 v[104:107], a[220:223], v[172:175], v[104:107]
 v_mfma_f32_16x16x32_bf16 v[108:111], a[224:227], v[172:175], v[108:111]
 s_waitcnt vmcnt(8) lgkmcnt(2)
 s_barrier
 v_mfma_f32_16x16x32_bf16 v[64:67], a[228:231], v[192:195], v[64:67]
 ds_read_b128 v[160:163], v18 offset:0
 v_mfma_f32_16x16x32_bf16 v[68:71], a[232:235], v[192:195], v[68:71]
 v_mfma_f32_16x16x32_bf16 v[72:75], a[236:239], v[192:195], v[72:75]
 v_add_u32 v19, s33, v15
 s_add_u32 s33, s33, 8192
 v_mfma_f32_16x16x32_bf16 v[76:79], a[228:231], v[196:199], v[76:79]
 ds_read_b128 v[164:167], v18 offset:2048
 v_cvt_pk_bf16_f32 v224, v64, v65
 v_cvt_pk_bf16_f32 v225, v66, v67
 v_mfma_f32_16x16x32_bf16 v[80:83], a[232:235], v[196:199], v[80:83]
 buffer_load_dwordx4 v10, s[8:11], s30 offen offset:0 lds
 v_cvt_pk_bf16_f32 v226, v68, v69
 v_cvt_pk_bf16_f32 v227, v70, v71
 v_mfma_f32_16x16x32_bf16 v[84:87], a[236:239], v[196:199], v[84:87]
 s_waitcnt lgkmcnt(2)
 v_cvt_pk_bf16_f32 v228, v72, v73
 v_cvt_pk_bf16_f32 v229, v74, v75
 v_mfma_f32_16x16x32_bf16 v[88:91], a[228:231], v[200:203], v[88:91]
 ds_read_b128 v[168:171], v18 offset:4096
 ds_write_b64 v22, v[224:225] offset:0
 v_mfma_f32_16x16x32_bf16 v[92:95], a[232:235], v[200:203], v[92:95]
 s_cmp_lt_u32 s33, 155648
 s_cselect_b32 s33, s33, 98304
 ds_write_b64 v22, v[226:227] offset:8
 v_mfma_f32_16x16x32_bf16 v[96:99], a[236:239], v[200:203], v[96:99]
 ds_write_b64 v16, v[228:229] offset:64
 v_cvt_pk_bf16_f32 v230, v76, v77
 v_cvt_pk_bf16_f32 v231, v78, v79
 v_mfma_f32_16x16x32_bf16 v[100:103], a[228:231], v[204:207], v[100:103]
 ds_read_b128 v[172:175], v18 offset:6144
 v_cvt_pk_bf16_f32 v232, v80, v81
 v_cvt_pk_bf16_f32 v233, v82, v83
 v_cvt_pk_bf16_f32 v234, v84, v85
 v_mfma_f32_16x16x32_bf16 v[104:107], a[232:235], v[204:207], v[104:107]
 v_cvt_pk_bf16_f32 v235, v86, v87
 ds_write_b64 v22, v[230:231] offset:6400
 v_mfma_f32_16x16x32_bf16 v[108:111], a[236:239], v[204:207], v[108:111]
 ds_write_b64 v22, v[232:233] offset:6408
 ds_write_b64 v16, v[234:235] offset:6464
 v_readfirstlane_b32 s21, v29
 s_cmp_ge_u32 s21, 32
 s_cbranch_scc1 kvz_126
 s_mov_b32 s21, 76
 v_mov_b32 v4, 0
 s_mov_b32 s101, 0
wf_127:
 buffer_load_dword v5, v4, s[64:67], s21 offen sc1
 s_add_u32 s101, s101, 1
 s_cmp_gt_u32 s101, 131072
 s_cbranch_scc1 main_end
 s_waitcnt vmcnt(0)
 v_readfirstlane_b32 s100, v5
 s_cmp_ge_u32 s100, 32
 s_cbranch_scc1 wf_128
 s_sleep 8
 s_branch wf_127
wf_128:
kvz_126:
 s_branch kvm_end_125
kvm_blk_124:
 v_mfma_f32_16x16x32_bf16 v[64:67], a[0:3], v[160:163], 0
 ds_read_b128 v[192:195], v19 offset:0
 v_mfma_f32_16x16x32_bf16 v[68:71], a[4:7], v[160:163], 0
 v_add_u32 v18, s33, v14
 v_mfma_f32_16x16x32_bf16 v[72:75], a[8:11], v[160:163], 0
 v_mfma_f32_16x16x32_bf16 v[76:79], a[0:3], v[164:167], 0
 ds_read_b128 v[196:199], v19 offset:2048
 v_mfma_f32_16x16x32_bf16 v[80:83], a[4:7], v[164:167], 0
 buffer_load_dwordx4 v11, s[8:11], s30 offen offset:1024 lds
 v_mfma_f32_16x16x32_bf16 v[84:87], a[8:11], v[164:167], 0
 s_waitcnt lgkmcnt(11)
 s_add_u32 s30, s30, 128
 v_mfma_f32_16x16x32_bf16 v[88:91], a[0:3], v[168:171], 0
 ds_read_b128 v[200:203], v19 offset:4096
 s_add_u32 m0, m0, 8192
 v_mfma_f32_16x16x32_bf16 v[92:95], a[4:7], v[168:171], 0
 s_cmp_lt_u32 m0, s46
 s_cselect_b32 m0, m0, s47
 v_mfma_f32_16x16x32_bf16 v[96:99], a[8:11], v[168:171], 0
 v_mfma_f32_16x16x32_bf16 v[100:103], a[0:3], v[172:175], 0
 ds_read_b128 v[204:207], v19 offset:6144
 v_mfma_f32_16x16x32_bf16 v[104:107], a[4:7], v[172:175], 0
 v_mfma_f32_16x16x32_bf16 v[108:111], a[8:11], v[172:175], 0
 s_waitcnt vmcnt(14) lgkmcnt(2)
 s_barrier
 v_mfma_f32_16x16x32_bf16 v[64:67], a[12:15], v[192:195], v[64:67]
 ds_read_b128 v[160:163], v18 offset:0
 v_mfma_f32_16x16x32_bf16 v[68:71], a[16:19], v[192:195], v[68:71]
 v_mfma_f32_16x16x32_bf16 v[72:75], a[20:23], v[192:195], v[72:75]
 v_add_u32 v19, s33, v15
 s_add_u32 s33, s33, 8192
 v_mfma_f32_16x16x32_bf16 v[76:79], a[12:15], v[196:199], v[76:79]
 ds_read_b128 v[164:167], v18 offset:2048
 v_mfma_f32_16x16x32_bf16 v[80:83], a[16:19], v[196:199], v[80:83]
 buffer_load_dwordx4 v10, s[8:11], s30 offen offset:0 lds
 v_mfma_f32_16x16x32_bf16 v[84:87], a[20:23], v[196:199], v[84:87]
 s_waitcnt lgkmcnt(2)
 v_mfma_f32_16x16x32_bf16 v[88:91], a[12:15], v[200:203], v[88:91]
 ds_read_b128 v[168:171], v18 offset:4096
 v_mfma_f32_16x16x32_bf16 v[92:95], a[16:19], v[200:203], v[92:95]
 s_cmp_lt_u32 s33, 155648
 s_cselect_b32 s33, s33, 98304
 v_mfma_f32_16x16x32_bf16 v[96:99], a[20:23], v[200:203], v[96:99]
 v_mfma_f32_16x16x32_bf16 v[100:103], a[12:15], v[204:207], v[100:103]
 ds_read_b128 v[172:175], v18 offset:6144
 v_mfma_f32_16x16x32_bf16 v[104:107], a[16:19], v[204:207], v[104:107]
 v_mfma_f32_16x16x32_bf16 v[108:111], a[20:23], v[204:207], v[108:111]
 s_waitcnt lgkmcnt(2)
 v_mfma_f32_16x16x32_bf16 v[64:67], a[24:27], v[160:163], v[64:67]
 ds_read_b128 v[192:195], v19 offset:0
 v_mfma_f32_16x16x32_bf16 v[68:71], a[28:31], v[160:163], v[68:71]
 v_add_u32 v18, s33, v14
 v_mfma_f32_16x16x32_bf16 v[72:75], a[32:35], v[160:163], v[72:75]
 v_mfma_f32_16x16x32_bf16 v[76:79], a[24:27], v[164:167], v[76:79]
 ds_read_b128 v[196:199], v19 offset:2048
 v_mfma_f32_16x16x32_bf16 v[80:83], a[28:31], v[164:167], v[80:83]
 buffer_load_dwordx4 v11, s[8:11], s30 offen offset:1024 lds
 v_mfma_f32_16x16x32_bf16 v[84:87], a[32:35], v[164:167], v[84:87]
 s_waitcnt lgkmcnt(2)
 s_add_u32 s30, s30, 128
 v_mfma_f32_16x16x32_bf16 v[88:91], a[24:27], v[168:171], v[88:91]
 ds_read_b128 v[200:203], v19 offset:4096
 s_add_u32 m0, m0, 8192
 v_mfma_f32_16x16x32_bf16 v[92:95], a[28:31], v[168:171], v[92:95]
 s_cmp_lt_u32 m0, s46
 s_cselect_b32 m0, m0, s47
 v_mfma_f32_16x16x32_bf16 v[96:99], a[32:35], v[168:171], v[96:99]
 v_mfma_f32_16x16x32_bf16 v[100:103], a[24:27], v[172:175], v[100:103]
 ds_read_b128 v[204:207], v19 offset:6144
 v_mfma_f32_16x16x32_bf16 v[104:107], a[28:31], v[172:175], v[104:107]
 v_mfma_f32_16x16x32_bf16 v[108:111], a[32:35], v[172:175], v[108:111]
 s_waitcnt vmcnt(14) lgkmcnt(2)
 s_barrier
 v_mfma_f32_16x16x32_bf16 v[64:67], a[36:39], v[192:195], v[64:67]
 ds_read_b128 v[160:163], v18 offset:0
 v_mfma_f32_16x16x32_bf16 v[68:71], a[40:43], v[192:195], v[68:71]
 v_mfma_f32_16x16x32_bf16 v[72:75], a[44:47], v[192:195], v[72:75]
 v_add_u32 v19, s33, v15
 s_add_u32 s33, s33, 8192
 v_mfma_f32_16x16x32_bf16 v[76:79], a[36:39], v[196:199], v[76:79]
 ds_read_b128 v[164:167], v18 offset:2048
 v_mfma_f32_16x16x32_bf16 v[80:83], a[40:43], v[196:199], v[80:83]
 buffer_load_dwordx4 v10, s[8:11], s30 offen offset:0 lds
 v_mfma_f32_16x16x32_bf16 v[84:87], a[44:47], v[196:199], v[84:87]
 s_waitcnt lgkmcnt(2)
 v_mfma_f32_16x16x32_bf16 v[88:91], a[36:39], v[200:203], v[88:91]
 ds_read_b128 v[168:171], v18 offset:4096
 v_mfma_f32_16x16x32_bf16 v[92:95], a[40:43], v[200:203], v[92:95]
 s_cmp_lt_u32 s33, 155648
 s_cselect_b32 s33, s33, 98304
 v_mfma_f32_16x16x32_bf16 v[96:99], a[44:47], v[200:203], v[96:99]
 v_mfma_f32_16x16x32_bf16 v[100:103], a[36:39], v[204:207], v[100:103]
 ds_read_b128 v[172:175], v18 offset:6144
 v_mfma_f32_16x16x32_bf16 v[104:107], a[40:43], v[204:207], v[104:107]
 v_mfma_f32_16x16x32_bf16 v[108:111], a[44:47], v[204:207], v[108:111]
 s_waitcnt lgkmcnt(2)
 v_mfma_f32_16x16x32_bf16 v[64:67], a[48:51], v[160:163], v[64:67]
 ds_read_b128 v[192:195], v19 offset:0
 v_mfma_f32_16x16x32_bf16 v[68:71], a[52:55], v[160:163], v[68:71]
 v_add_u32 v18, s33, v14
 v_mfma_f32_16x16x32_bf16 v[72:75], a[56:59], v[160:163], v[72:75]
 v_mfma_f32_16x16x32_bf16 v[76:79], a[48:51], v[164:167], v[76:79]
 ds_read_b128 v[196:199], v19 offset:2048
 v_mfma_f32_16x16x32_bf16 v[80:83], a[52:55], v[164:167], v[80:83]
 buffer_load_dwordx4 v11, s[8:11], s30 offen offset:1024 lds
 v_mfma_f32_16x16x32_bf16 v[84:87], a[56:59], v[164:167], v[84:87]
 s_waitcnt lgkmcnt(2)
 s_add_u32 s30, s30, 128
 v_mfma_f32_16x16x32_bf16 v[88:91], a[48:51], v[168:171], v[88:91]
 ds_read_b128 v[200:203], v19 offset:4096
 s_add_u32 m0, m0, 8192
 v_mfma_f32_16x16x32_bf16 v[92:95], a[52:55], v[168:171], v[92:95]
 s_cmp_lt_u32 m0, s46
 s_cselect_b32 m0, m0, s47
 v_mfma_f32_16x16x32_bf16 v[96:99], a[56:59], v[168:171], v[96:99]
 v_mfma_f32_16x16x32_bf16 v[100:103], a[48:51], v[172:175], v[100:103]
 ds_read_b128 v[204:207], v19 offset:6144
 v_mfma_f32_16x16x32_bf16 v[104:107], a[52:55], v[172:175], v[104:107]
 v_mfma_f32_16x16x32_bf16 v[108:111], a[56:59], v[172:175], v[108:111]
 s_waitcnt vmcnt(14) lgkmcnt(2)
 s_barrier
 v_mfma_f32_16x16x32_bf16 v[64:67], a[60:63], v[192:195], v[64:67]
 ds_read_b128 v[160:163], v18 offset:0
 v_mfma_f32_16x16x32_bf16 v[68:71], a[64:67], v[192:195], v[68:71]
 v_mfma_f32_16x16x32_bf16 v[72:75], a[68:71], v[192:195], v[72:75]
 v_add_u32 v19, s33, v15
 s_add_u32 s33, s33, 8192
 v_mfma_f32_16x16x32_bf16 v[76:79], a[60:63], v[196:199], v[76:79]
 ds_read_b128 v[164:167], v18 offset:2048
 v_mfma_f32_16x16x32_bf16 v[80:83], a[64:67], v[196:199], v[80:83]
 buffer_load_dwordx4 v10, s[8:11], s30 offen offset:0 lds
 v_mfma_f32_16x16x32_bf16 v[84:87], a[68:71], v[196:199], v[84:87]
 s_waitcnt lgkmcnt(2)
 v_mfma_f32_16x16x32_bf16 v[88:91], a[60:63], v[200:203], v[88:91]
 ds_read_b128 v[168:171], v18 offset:4096
 v_mfma_f32_16x16x32_bf16 v[92:95], a[64:67], v[200:203], v[92:95]
 s_cmp_lt_u32 s33, 155648
 s_cselect_b32 s33, s33, 98304
 v_mfma_f32_16x16x32_bf16 v[96:99], a[68:71], v[200:203], v[96:99]
 v_mfma_f32_16x16x32_bf16 v[100:103], a[60:63], v[204:207], v[100:103]
 ds_read_b128 v[172:175], v18 offset:6144
 v_mfma_f32_16x16x32_bf16 v[104:107], a[64:67], v[204:207], v[104:107]
 v_mfma_f32_16x16x32_bf16 v[108:111], a[68:71], v[204:207], v[108:111]
 s_waitcnt lgkmcnt(2)
 v_mfma_f32_16x16x32_bf16 v[64:67], a[72:75], v[160:163], v[64:67]
 ds_read_b128 v[192:195], v19 offset:0
 v_mfma_f32_16x16x32_bf16 v[68:71], a[76:79], v[160:163], v[68:71]
 v_add_u32 v18, s33, v14
 v_mfma_f32_16x16x32_bf16 v[72:75], a[80:83], v[160:163], v[72:75]
 v_mfma_f32_16x16x32_bf16 v[76:79], a[72:75], v[164:167], v[76:79]
 ds_read_b128 v[196:199], v19 offset:2048
 v_mfma_f32_16x16x32_bf16 v[80:83], a[76:79], v[164:167], v[80:83]
 buffer_load_dwordx4 v11, s[8:11], s30 offen offset:1024 lds
 v_mfma_f32_16x16x32_bf16 v[84:87], a[80:83], v[164:167], v[84:87]
 s_waitcnt lgkmcnt(2)
 s_add_u32 s30, s30, 128
 v_mfma_f32_16x16x32_bf16 v[88:91], a[72:75], v[168:171], v[88:91]
 ds_read_b128 v[200:203], v19 offset:4096
 s_add_u32 m0, m0, 8192
 v_mfma_f32_16x16x32_bf16 v[92:95], a[76:79], v[168:171], v[92:95]
 s_cmp_lt_u32 m0, s46
 s_cselect_b32 m0, m0, s47
 v_mfma_f32_16x16x32_bf16 v[96:99], a[80:83], v[168:171], v[96:99]
 v_mfma_f32_16x16x32_bf16 v[100:103], a[72:75], v[172:175], v[100:103]
 ds_read_b128 v[204:207], v19 offset:6144
 v_mfma_f32_16x16x32_bf16 v[104:107], a[76:79], v[172:175], v[104:107]
 v_mfma_f32_16x16x32_bf16 v[108:111], a[80:83], v[172:175], v[108:111]
 s_waitcnt vmcnt(7) lgkmcnt(2)
 s_barrier
 v_mfma_f32_16x16x32_bf16 v[64:67], a[84:87], v[192:195], v[64:67]
 ds_read_b128 v[160:163], v18 offset:0
 v_mfma_f32_16x16x32_bf16 v[68:71], a[88:91], v[192:195], v[68:71]
 s_cmp_eq_u32 s48, 0x80000000
 s_cbranch_scc1 kvm_122
 s_cmp_lg_u32 s20, 0
 s_cbranch_scc1 af_123
 v_mov_b32 v4, 0
 v_mov_b32 v5, 1
 s_mov_b64 exec, 1
 buffer_atomic_add v5, v4, s[72:75], s61 offen sc1
 s_mov_b64 exec, -1
 s_nop 1
af_123:
kvm_122:
 v_mfma_f32_16x16x32_bf16 v[72:75], a[92:95], v[192:195], v[72:75]
 v_add_u32 v19, s33, v15
 s_add_u32 s33, s33, 8192
 v_mfma_f32_16x16x32_bf16 v[76:79], a[84:87], v[196:199], v[76:79]
 ds_read_b128 v[164:167], v18 offset:2048
 v_mfma_f32_16x16x32_bf16 v[80:83], a[88:91], v[196:199], v[80:83]
 buffer_load_dwordx4 v10, s[8:11], s30 offen offset:0 lds
 v_mfma_f32_16x16x32_bf16 v[84:87], a[92:95], v[196:199], v[84:87]
 s_waitcnt lgkmcnt(2)
 v_mfma_f32_16x16x32_bf16 v[88:91], a[84:87], v[200:203], v[88:91]
 ds_read_b128 v[168:171], v18 offset:4096
 v_mfma_f32_16x16x32_bf16 v[92:95], a[88:91], v[200:203], v[92:95]
 s_cmp_lt_u32 s33, 155648
 s_cselect_b32 s33, s33, 98304
 v_mfma_f32_16x16x32_bf16 v[96:99], a[92:95], v[200:203], v[96:99]
 v_mfma_f32_16x16x32_bf16 v[100:103], a[84:87], v[204:207], v[100:103]
 ds_read_b128 v[172:175], v18 offset:6144
 v_mfma_f32_16x16x32_bf16 v[104:107], a[88:91], v[204:207], v[104:107]
 v_mfma_f32_16x16x32_bf16 v[108:111], a[92:95], v[204:207], v[108:111]
 s_waitcnt lgkmcnt(2)
 v_mfma_f32_16x16x32_bf16 v[64:67], a[96:99], v[160:163], v[64:67]
 ds_read_b128 v[192:195], v19 offset:0
 v_mfma_f32_16x16x32_bf16 v[68:71], a[100:103], v[160:163], v[68:71]
 v_add_u32 v18, s33, v14
 s_mov_b32 s61, s60
 v_mfma_f32_16x16x32_bf16 v[72:75], a[104:107], v[160:163], v[72:75]
 s_add_u32 s60, s60, s62
 s_lshr_b32 s48, s20, 1
 v_mfma_f32_16x16x32_bf16 v[76:79], a[96:99], v[164:167], v[76:79]
 ds_read_b128 v[196:199], v19 offset:2048
 s_mul_i32 s48, s48, 393216
 v_mfma_f32_16x16x32_bf16 v[80:83], a[100:103], v[164:167], v[80:83]
 buffer_load_dwordx4 v11, s[8:11], s30 offen offset:1024 lds
 v_mfma_f32_16x16x32_bf16 v[84:87], a[104:107], v[164:167], v[84:87]
 s_waitcnt lgkmcnt(2)
 s_add_u32 s30, s30, s25
 v_mfma_f32_16x16x32_bf16 v[88:91], a[96:99], v[168:171], v[88:91]
 ds_read_b128 v[200:203], v19 offset:4096
 s_sub_u32 s30, s30, 1152
 v_mfma_f32_16x16x32_bf16 v[92:95], a[100:103], v[168:171], v[92:95]
 s_add_u32 m0, m0, 8192
 s_and_b32 s21, s20, 1
 v_mfma_f32_16x16x32_bf16 v[96:99], a[104:107], v[168:171], v[96:99]
 s_cmp_lt_u32 m0, s46
 s_cselect_b32 m0, m0, s47
 v_mfma_f32_16x16x32_bf16 v[100:103], a[96:99], v[172:175], v[100:103]
 ds_read_b128 v[204:207], v19 offset:6144
 s_mul_i32 s21, s21, 6144
 v_mfma_f32_16x16x32_bf16 v[104:107], a[100:103], v[172:175], v[104:107]
 s_add_u32 s48, s48, s21
 s_add_u32 s48, s48, s27
 v_mfma_f32_16x16x32_bf16 v[108:111], a[104:107], v[172:175], v[108:111]
 s_waitcnt vmcnt(8) lgkmcnt(2)
 s_barrier
 v_mfma_f32_16x16x32_bf16 v[64:67], a[108:111], v[192:195], v[64:67]
 ds_read_b128 v[160:163], v18 offset:0
 s_add_u32 s27, s27, s28
 v_mfma_f32_16x16x32_bf16 v[68:71], a[112:115], v[192:195], v[68:71]
 s_sub_u32 s26, s26, 1
 v_mfma_f32_16x16x32_bf16 v[72:75], a[116:119], v[192:195], v[72:75]
 v_add_u32 v19, s33, v15
 s_add_u32 s33, s33, 8192
 v_mfma_f32_16x16x32_bf16 v[76:79], a[108:111], v[196:199], v[76:79]
 ds_read_b128 v[164:167], v18 offset:2048
 v_mfma_f32_16x16x32_bf16 v[80:83], a[112:115], v[196:199], v[80:83]
 buffer_load_dwordx4 v10, s[8:11], s30 offen offset:0 lds
 v_mfma_f32_16x16x32_bf16 v[84:87], a[116:119], v[196:199], v[84:87]
 s_waitcnt lgkmcnt(2)
 v_mfma_f32_16x16x32_bf16 v[88:91], a[108:111], v[200:203], v[88:91]
 ds_read_b128 v[168:171], v18 offset:4096
 v_mfma_f32_16x16x32_bf16 v[92:95], a[112:115], v[200:203], v[92:95]
 s_cmp_lt_u32 s33, 155648
 s_cselect_b32 s33, s33, 98304
 v_mfma_f32_16x16x32_bf16 v[96:99], a[116:119], v[200:203], v[96:99]
 v_mfma_f32_16x16x32_bf16 v[100:103], a[108:111], v[204:207], v[100:103]
 ds_read_b128 v[172:175], v18 offset:6144
 v_mfma_f32_16x16x32_bf16 v[104:107], a[112:115], v[204:207], v[104:107]
 v_mfma_f32_16x16x32_bf16 v[108:111], a[116:119], v[204:207], v[108:111]
 s_waitcnt lgkmcnt(2)
 v_mfma_f32_16x16x32_bf16 v[64:67], a[120:123], v[160:163], v[64:67]
 ds_read_b128 v[192:195], v19 offset:0
 v_mfma_f32_16x16x32_bf16 v[68:71], a[124:127], v[160:163], v[68:71]
 v_add_u32 v18, s33, v14
 v_mfma_f32_16x16x32_bf16 v[72:75], a[128:131], v[160:163], v[72:75]
 v_mfma_f32_16x16x32_bf16 v[76:79], a[120:123], v[164:167], v[76:79]
 ds_read_b128 v[196:199], v19 offset:2048
 v_mfma_f32_16x16x32_bf16 v[80:83], a[124:127], v[164:167], v[80:83]
 buffer_load_dwordx4 v11, s[8:11], s30 offen offset:1024 lds
 v_mfma_f32_16x16x32_bf16 v[84:87], a[128:131], v[164:167], v[84:87]
 s_waitcnt lgkmcnt(2)
 s_add_u32 s30, s30, 128
 v_mfma_f32_16x16x32_bf16 v[88:91], a[120:123], v[168:171], v[88:91]
 ds_read_b128 v[200:203], v19 offset:4096
 s_add_u32 m0, m0, 8192
 v_mfma_f32_16x16x32_bf16 v[92:95], a[124:127], v[168:171], v[92:95]
 s_cmp_lt_u32 m0, s46
 s_cselect_b32 m0, m0, s47
 v_mfma_f32_16x16x32_bf16 v[96:99], a[128:131], v[168:171], v[96:99]
 v_mfma_f32_16x16x32_bf16 v[100:103], a[120:123], v[172:175], v[100:103]
 ds_read_b128 v[204:207], v19 offset:6144
 v_mfma_f32_16x16x32_bf16 v[104:107], a[124:127], v[172:175], v[104:107]
 v_mfma_f32_16x16x32_bf16 v[108:111], a[128:131], v[172:175], v[108:111]
 s_waitcnt vmcnt(8) lgkmcnt(2)
 s_barrier
 v_mfma_f32_16x16x32_bf16 v[64:67], a[132:135], v[192:195], v[64:67]
 ds_read_b128 v[160:163], v18 offset:0
 v_mfma_f32_16x16x32_bf16 v[68:71], a[136:139], v[192:195], v[68:71]
 v_mfma_f32_16x16x32_bf16 v[72:75], a[140:143], v[192:195], v[72:75]
 v_add_u32 v19, s33, v15
 s_add_u32 s33, s33, 8192
 v_mfma_f32_16x16x32_bf16 v[76:79], a[132:135], v[196:199], v[76:79]
 ds_read_b128 v[164:167], v18 offset:2048
 v_mfma_f32_16x16x32_bf16 v[80:83], a[136:139], v[196:199], v[80:83]
 buffer_load_dwordx4 v10, s[8:11], s30 offen offset:0 lds
 v_mfma_f32_16x16x32_bf16 v[84:87], a[140:143], v[196:199], v[84:87]
 s_waitcnt lgkmcnt(2)
 v_mfma_f32_16x16x32_bf16 v[88:91], a[132:135], v[200:203], v[88:91]
 ds_read_b128 v[168:171], v18 offset:4096
 v_mfma_f32_16x16x32_bf16 v[92:95], a[136:139], v[200:203], v[92:95]
 s_cmp_lt_u32 s33, 155648
 s_cselect_b32 s33, s33, 98304
 v_mfma_f32_16x16x32_bf16 v[96:99], a[140:143], v[200:203], v[96:99]
 v_mfma_f32_16x16x32_bf16 v[100:103], a[132:135], v[204:207], v[100:103]
 ds_read_b128 v[172:175], v18 offset:6144
 v_mfma_f32_16x16x32_bf16 v[104:107], a[136:139], v[204:207], v[104:107]
 v_mfma_f32_16x16x32_bf16 v[108:111], a[140:143], v[204:207], v[108:111]
 s_waitcnt lgkmcnt(2)
 v_mfma_f32_16x16x32_bf16 v[64:67], a[144:147], v[160:163], v[64:67]
 ds_read_b128 v[192:195], v19 offset:0
 v_mfma_f32_16x16x32_bf16 v[68:71], a[148:151], v[160:163], v[68:71]
 v_add_u32 v18, s33, v14
 v_mfma_f32_16x16x32_bf16 v[72:75], a[152:155], v[160:163], v[72:75]
 v_mfma_f32_16x16x32_bf16 v[76:79], a[144:147], v[164:167], v[76:79]
 ds_read_b128 v[196:199], v19 offset:2048
 v_mfma_f32_16x16x32_bf16 v[80:83], a[148:151], v[164:167], v[80:83]
 buffer_load_dwordx4 v11, s[8:11], s30 offen offset:1024 lds
 v_mfma_f32_16x16x32_bf16 v[84:87], a[152:155], v[164:167], v[84:87]
 s_waitcnt lgkmcnt(2)
 s_add_u32 s30, s30, 128
 v_mfma_f32_16x16x32_bf16 v[88:91], a[144:147], v[168:171], v[88:91]
 ds_read_b128 v[200:203], v19 offset:4096
 s_add_u32 m0, m0, 8192
 v_mfma_f32_16x16x32_bf16 v[92:95], a[148:151], v[168:171], v[92:95]
 s_cmp_lt_u32 m0, s46
 s_cselect_b32 m0, m0, s47
 v_mfma_f32_16x16x32_bf16 v[96:99], a[152:155], v[168:171], v[96:99]
 v_mfma_f32_16x16x32_bf16 v[100:103], a[144:147], v[172:175], v[100:103]
 ds_read_b128 v[204:207], v19 offset:6144
 v_mfma_f32_16x16x32_bf16 v[104:107], a[148:151], v[172:175], v[104:107]
 v_mfma_f32_16x16x32_bf16 v[108:111], a[152:155], v[172:175], v[108:111]
 s_waitcnt vmcnt(8) lgkmcnt(2)
 s_barrier
 v_mfma_f32_16x16x32_bf16 v[64:67], a[156:159], v[192:195], v[64:67]
 ds_read_b128 v[160:163], v18 offset:0
 v_mfma_f32_16x16x32_bf16 v[68:71], a[160:163], v[192:195], v[68:71]
 v_mfma_f32_16x16x32_bf16 v[72:75], a[164:167], v[192:195], v[72:75]
 v_add_u32 v19, s33, v15
 s_add_u32 s33, s33, 8192
 v_mfma_f32_16x16x32_bf16 v[76:79], a[156:159], v[196:199], v[76:79]
 ds_read_b128 v[164:167], v18 offset:2048
 v_mfma_f32_16x16x32_bf16 v[80:83], a[160:163], v[196:199], v[80:83]
 buffer_load_dwordx4 v10, s[8:11], s30 offen offset:0 lds
 v_mfma_f32_16x16x32_bf16 v[84:87], a[164:167], v[196:199], v[84:87]
 s_waitcnt lgkmcnt(2)
 v_mfma_f32_16x16x32_bf16 v[88:91], a[156:159], v[200:203], v[88:91]
 ds_read_b128 v[168:171], v18 offset:4096
 v_mfma_f32_16x16x32_bf16 v[92:95], a[160:163], v[200:203], v[92:95]
 s_cmp_lt_u32 s33, 155648
 s_cselect_b32 s33, s33, 98304
 v_mfma_f32_16x16x32_bf16 v[96:99], a[164:167], v[200:203], v[96:99]
 v_mfma_f32_16x16x32_bf16 v[100:103], a[156:159], v[204:207], v[100:103]
 ds_read_b128 v[172:175], v18 offset:6144
 v_mfma_f32_16x16x32_bf16 v[104:107], a[160:163], v[204:207], v[104:107]
 v_mfma_f32_16x16x32_bf16 v[108:111], a[164:167], v[204:207], v[108:111]
 s_waitcnt lgkmcnt(2)
 v_mfma_f32_16x16x32_bf16 v[64:67], a[168:171], v[160:163], v[64:67]
 ds_read_b128 v[192:195], v19 offset:0
 v_mfma_f32_16x16x32_bf16 v[68:71], a[172:175], v[160:163], v[68:71]
 v_add_u32 v18, s33, v14
 v_mfma_f32_16x16x32_bf16 v[72:75], a[176:179], v[160:163], v[72:75]
 v_mfma_f32_16x16x32_bf16 v[76:79], a[168:171], v[164:167], v[76:79]
 ds_read_b128 v[196:199], v19 offset:2048
 v_mfma_f32_16x16x32_bf16 v[80:83], a[172:175], v[164:167], v[80:83]
 buffer_load_dwordx4 v11, s[8:11], s30 offen offset:1024 lds
 v_mfma_f32_16x16x32_bf16 v[84:87], a[176:179], v[164:167], v[84:87]
 s_waitcnt lgkmcnt(2)
 s_add_u32 s30, s30, 128
 v_mfma_f32_16x16x32_bf16 v[88:91], a[168:171], v[168:171], v[88:91]
 ds_read_b128 v[200:203], v19 offset:4096
 s_add_u32 m0, m0, 8192
 v_mfma_f32_16x16x32_bf16 v[92:95], a[172:175], v[168:171], v[92:95]
 s_cmp_lt_u32 m0, s46
 s_cselect_b32 m0, m0, s47
 v_mfma_f32_16x16x32_bf16 v[96:99], a[176:179], v[168:171], v[96:99]
 v_mfma_f32_16x16x32_bf16 v[100:103], a[168:171], v[172:175], v[100:103]
 ds_read_b128 v[204:207], v19 offset:6144
 v_mfma_f32_16x16x32_bf16 v[104:107], a[172:175], v[172:175], v[104:107]
 v_mfma_f32_16x16x32_bf16 v[108:111], a[176:179], v[172:175], v[108:111]
 s_waitcnt vmcnt(8) lgkmcnt(2)
 s_barrier
 v_mfma_f32_16x16x32_bf16 v[64:67], a[180:183], v[192:195], v[64:67]
 ds_read_b128 v[160:163], v18 offset:0
 v_mfma_f32_16x16x32_bf16 v[68:71], a[184:187], v[192:195], v[68:71]
 v_mfma_f32_16x16x32_bf16 v[72:75], a[188:191], v[192:195], v[72:75]
 v_add_u32 v19, s33, v15
 s_add_u32 s33, s33, 8192
 v_mfma_f32_16x16x32_bf16 v[76:79], a[180:183], v[196:199], v[76:79]
 ds_read_b128 v[164:167], v18 offset:2048
 v_mfma_f32_16x16x32_bf16 v[80:83], a[184:187], v[196:199], v[80:83]
 buffer_load_dwordx4 v10, s[8:11], s30 offen offset:0 lds
 v_mfma_f32_16x16x32_bf16 v[84:87], a[188:191], v[196:199], v[84:87]
 s_waitcnt lgkmcnt(2)
 v_mfma_f32_16x16x32_bf16 v[88:91], a[180:183], v[200:203], v[88:91]
 ds_read_b128 v[168:171], v18 offset:4096
 v_mfma_f32_16x16x32_bf16 v[92:95], a[184:187], v[200:203], v[92:95]
 s_cmp_lt_u32 s33, 155648
 s_cselect_b32 s33, s33, 98304
 v_mfma_f32_16x16x32_bf16 v[96:99], a[188:191], v[200:203], v[96:99]
 v_mfma_f32_16x16x32_bf16 v[100:103], a[180:183], v[204:207], v[100:103]
 ds_read_b128 v[172:175], v18 offset:6144
 v_mfma_f32_16x16x32_bf16 v[104:107], a[184:187], v[204:207], v[104:107]
 v_mfma_f32_16x16x32_bf16 v[108:111], a[188:191], v[204:207], v[108:111]
 s_waitcnt lgkmcnt(2)
 v_mfma_f32_16x16x32_bf16 v[64:67], a[192:195], v[160:163], v[64:67]
 ds_read_b128 v[192:195], v19 offset:0
 v_mfma_f32_16x16x32_bf16 v[68:71], a[196:199], v[160:163], v[68:71]
 v_add_u32 v18, s33, v14
 v_mfma_f32_16x16x32_bf16 v[72:75], a[200:203], v[160:163], v[72:75]
 v_mfma_f32_16x16x32_bf16 v[76:79], a[192:195], v[164:167], v[76:79]
 ds_read_b128 v[196:199], v19 offset:2048
 v_mfma_f32_16x16x32_bf16 v[80:83], a[196:199], v[164:167], v[80:83]
 buffer_load_dwordx4 v11, s[8:11], s30 offen offset:1024 lds
 v_mfma_f32_16x16x32_bf16 v[84:87], a[200:203], v[164:167], v[84:87]
 s_waitcnt lgkmcnt(2)
 s_add_u32 s30, s30, 128
 v_mfma_f32_16x16x32_bf16 v[88:91], a[192:195], v[168:171], v[88:91]
 ds_read_b128 v[200:203], v19 offset:4096
 s_add_u32 m0, m0, 8192
 v_mfma_f32_16x16x32_bf16 v[92:95], a[196:199], v[168:171], v[92:95]
 s_cmp_lt_u32 m0, s46
 s_cselect_b32 m0, m0, s47
 v_mfma_f32_16x16x32_bf16 v[96:99], a[200:203], v[168:171], v[96:99]
 v_mfma_f32_16x16x32_bf16 v[100:103], a[192:195], v[172:175], v[100:103]
 ds_read_b128 v[204:207], v19 offset:6144
 v_mfma_f32_16x16x32_bf16 v[104:107], a[196:199], v[172:175], v[104:107]
 v_mfma_f32_16x16x32_bf16 v[108:111], a[200:203], v[172:175], v[108:111]
 s_waitcnt vmcnt(8) lgkmcnt(2)
 s_barrier
 v_mfma_f32_16x16x32_bf16 v[64:67], a[204:207], v[192:195], v[64:67]
 ds_read_b128 v[160:163], v18 offset:0
 v_mfma_f32_16x16x32_bf16 v[68:71], a[208:211], v[192:195], v[68:71]
 v_mfma_f32_16x16x32_bf16 v[72:75], a[212:215], v[192:195], v[72:75]
 v_add_u32 v19, s33, v15
 s_add_u32 s33, s33, 8192
 v_mfma_f32_16x16x32_bf16 v[76:79], a[204:207], v[196:199], v[76:79]
 ds_read_b128 v[164:167], v18 offset:2048
 v_mfma_f32_16x16x32_bf16 v[80:83], a[208:211], v[196:199], v[80:83]
 buffer_load_dwordx4 v10, s[8:11], s30 offen offset:0 lds
 v_mfma_f32_16x16x32_bf16 v[84:87], a[212:215], v[196:199], v[84:87]
 s_waitcnt lgkmcnt(2)
 v_mfma_f32_16x16x32_bf16 v[88:91], a[204:207], v[200:203], v[88:91]
 ds_read_b128 v[168:171], v18 offset:4096
 v_mfma_f32_16x16x32_bf16 v[92:95], a[208:211], v[200:203], v[92:95]
 s_cmp_lt_u32 s33, 155648
 s_cselect_b32 s33, s33, 98304
 v_mfma_f32_16x16x32_bf16 v[96:99], a[212:215], v[200:203], v[96:99]
 v_mfma_f32_16x16x32_bf16 v[100:103], a[204:207], v[204:207], v[100:103]
 ds_read_b128 v[172:175], v18 offset:6144
 v_mfma_f32_16x16x32_bf16 v[104:107], a[208:211], v[204:207], v[104:107]
 v_mfma_f32_16x16x32_bf16 v[108:111], a[212:215], v[204:207], v[108:111]
 s_waitcnt lgkmcnt(2)
 v_mfma_f32_16x16x32_bf16 v[64:67], a[216:219], v[160:163], v[64:67]
 ds_read_b128 v[192:195], v19 offset:0
 v_mfma_f32_16x16x32_bf16 v[68:71], a[220:223], v[160:163], v[68:71]
 v_add_u32 v18, s33, v14
 v_mfma_f32_16x16x32_bf16 v[72:75], a[224:227], v[160:163], v[72:75]
 v_mfma_f32_16x16x32_bf16 v[76:79], a[216:219], v[164:167], v[76:79]
 ds_read_b128 v[196:199], v19 offset:2048
 v_mfma_f32_16x16x32_bf16 v[80:83], a[220:223], v[164:167], v[80:83]
 buffer_load_dwordx4 v11, s[8:11], s30 offen offset:1024 lds
 v_mfma_f32_16x16x32_bf16 v[84:87], a[224:227], v[164:167], v[84:87]
 s_waitcnt lgkmcnt(2)
 s_add_u32 s30, s30, 128
 v_mfma_f32_16x16x32_bf16 v[88:91], a[216:219], v[168:171], v[88:91]
 ds_read_b128 v[200:203], v19 offset:4096
 s_add_u32 m0, m0, 8192
 v_mfma_f32_16x16x32_bf16 v[92:95], a[220:223], v[168:171], v[92:95]
 s_cmp_lt_u32 m0, s46
 s_cselect_b32 m0, m0, s47
 v_mfma_f32_16x16x32_bf16 v[96:99], a[224:227], v[168:171], v[96:99]
 v_mfma_f32_16x16x32_bf16 v[100:103], a[216:219], v[172:175], v[100:103]
 ds_read_b128 v[204:207], v19 offset:6144
 v_mfma_f32_16x16x32_bf16 v[104:107], a[220:223], v[172:175], v[104:107]
 v_mfma_f32_16x16x32_bf16 v[108:111], a[224:227], v[172:175], v[108:111]
 s_waitcnt vmcnt(8) lgkmcnt(2)
 s_barrier
 v_mfma_f32_16x16x32_bf16 v[64:67], a[228:231], v[192:195], v[64:67]
 ds_read_b128 v[160:163], v18 offset:0
 v_mfma_f32_16x16x32_bf16 v[68:71], a[232:235], v[192:195], v[68:71]
 v_mfma_f32_16x16x32_bf16 v[72:75], a[236:239], v[192:195], v[72:75]
 v_add_u32 v19, s33, v15
 s_add_u32 s33, s33, 8192
 v_mfma_f32_16x16x32_bf16 v[76:79], a[228:231], v[196:199], v[76:79]
 ds_read_b128 v[164:167], v18 offset:2048
 v_cvt_pk_bf16_f32 v224, v64, v65
 v_cvt_pk_bf16_f32 v225, v66, v67
 v_mfma_f32_16x16x32_bf16 v[80:83], a[232:235], v[196:199], v[80:83]
 buffer_load_dwordx4 v10, s[8:11], s30 offen offset:0 lds
 v_cvt_pk_bf16_f32 v226, v68, v69
 v_cvt_pk_bf16_f32 v227, v70, v71
 v_mfma_f32_16x16x32_bf16 v[84:87], a[236:239], v[196:199], v[84:87]
 s_waitcnt lgkmcnt(2)
 v_cvt_pk_bf16_f32 v228, v72, v73
 v_cvt_pk_bf16_f32 v229, v74, v75
 v_mfma_f32_16x16x32_bf16 v[88:91], a[228:231], v[200:203], v[88:91]
 ds_read_b128 v[168:171], v18 offset:4096
 ds_write_b64 v22, v[224:225] offset:0
 v_mfma_f32_16x16x32_bf16 v[92:95], a[232:235], v[200:203], v[92:95]
 s_cmp_lt_u32 s33, 155648
 s_cselect_b32 s33, s33, 98304
 ds_write_b64 v22, v[226:227] offset:8
 v_mfma_f32_16x16x32_bf16 v[96:99], a[236:239], v[200:203], v[96:99]
 ds_write_b64 v16, v[228:229] offset:64
 v_cvt_pk_bf16_f32 v230, v76, v77
 v_cvt_pk_bf16_f32 v231, v78, v79
 v_mfma_f32_16x16x32_bf16 v[100:103], a[228:231], v[204:207], v[100:103]
 ds_read_b128 v[172:175], v18 offset:6144
 v_cvt_pk_bf16_f32 v232, v80, v81
 v_cvt_pk_bf16_f32 v233, v82, v83
 v_cvt_pk_bf16_f32 v234, v84, v85
 v_mfma_f32_16x16x32_bf16 v[104:107], a[232:235], v[204:207], v[104:107]
 v_cvt_pk_bf16_f32 v235, v86, v87
 ds_write_b64 v22, v[230:231] offset:6400
 v_mfma_f32_16x16x32_bf16 v[108:111], a[236:239], v[204:207], v[108:111]
 ds_write_b64 v22, v[232:233] offset:6408
 ds_write_b64 v16, v[234:235] offset:6464
kvm_end_125:
 v_cvt_pk_bf16_f32 v236, v88, v89
 v_cvt_pk_bf16_f32 v237, v90, v91
 v_cvt_pk_bf16_f32 v238, v92, v93
 v_cvt_pk_bf16_f32 v239, v94, v95
 v_cvt_pk_bf16_f32 v240, v96, v97
 v_cvt_pk_bf16_f32 v241, v98, v99
 ds_write_b64 v22, v[236:237] offset:12800
 ds_write_b64 v22, v[238:239] offset:12808
 ds_write_b64 v16, v[240:241] offset:12864
 v_cvt_pk_bf16_f32 v242, v100, v101
 v_cvt_pk_bf16_f32 v243, v102, v103
 v_cvt_pk_bf16_f32 v244, v104, v105
 v_cvt_pk_bf16_f32 v245, v106, v107
 v_cvt_pk_bf16_f32 v246, v108, v109
 v_cvt_pk_bf16_f32 v247, v110, v111
 ds_write_b64 v22, v[242:243] offset:19200
 ds_write_b64 v22, v[244:245] offset:19208
 ds_write_b64 v16, v[246:247] offset:19264
 s_waitcnt lgkmcnt(0)
 s_barrier
 ds_read_b128 v[224:227], v23 offset:0
 ds_read_b128 v[228:231], v23 offset:64
 ds_read_b128 v[232:235], v23 offset:128
 ds_read_b128 v[236:239], v23 offset:192
 ds_read_b128 v[240:243], v23 offset:256
 ds_read_b128 v[244:247], v23 offset:320
 s_waitcnt lgkmcnt(0)
 s_add_u32 s21, s48, 0
 buffer_store_dwordx4 v[224:227], v26, s[16:19], s21 offen offset:0 sc1
 buffer_store_dwordx4 v[228:231], v26, s[16:19], s21 offen offset:1024 sc1
 buffer_store_dwordx4 v[232:235], v26, s[16:19], s21 offen offset:2048 sc1
 buffer_store_dwordx4 v[236:239], v26, s[16:19], s21 offen offset:3072 sc1
 s_add_u32 s21, s48, 4096
 buffer_store_dwordx4 v[240:243], v26, s[16:19], s21 offen offset:0 sc1
 buffer_store_dwordx4 v[244:247], v26, s[16:19], s21 offen offset:1024 sc1
 s_nop 1
 s_cmp_gt_u32 s26, 0
 s_cbranch_scc1 kvm_blk_124
 s_waitcnt vmcnt(6)
 s_barrier
 v_mov_b32 v29, 84
 buffer_load_dword v29, v29, s[64:67], 0 offen sc1
 s_mov_b32 s24, 491520
 s_mov_b32 s25, 163840
 v_lshrrev_b32 v11, 3, v1
 v_and_b32 v12, 7, v1
 v_xor_b32 v12, v12, v11
 v_mul_u32_u24 v11, 1280, v11
 v_lshl_add_u32 v10, v12, 4, v11
 s_mul_i32 s46, s20, 40960
 v_add_u32 v10, s46, v10
 s_lshl_b32 s47, s20, 12
 s_add_u32 s47, s47, 0
 s_add_u32 s46, s47, 98304
 s_mov_b32 s30, s24
 s_add_u32 s32, s47, 32768
 v_add_u32 v11, 9216, v10
 v_add_u32 v12, 18432, v10
 v_add_u32 v13, 27648, v10
 s_mov_b32 m0, s32
 s_nop 0
 buffer_load_dwordx4 v10, s[8:11], s30 offen offset:0 lds
 buffer_load_dwordx4 v11, s[8:11], s30 offen offset:1024 lds
 buffer_load_dwordx4 v12, s[8:11], s30 offen offset:2048 lds
 buffer_load_dwordx4 v13, s[8:11], s30 offen offset:3072 lds
 s_add_u32 s30, s30, 128
 s_add_u32 s32, s32, 16384
 s_cmp_lt_u32 s32, s46
 s_cselect_b32 s32, s32, s47
 s_mov_b32 m0, s32
 s_nop 0
 buffer_load_dwordx4 v10, s[8:11], s30 offen offset:0 lds
 buffer_load_dwordx4 v11, s[8:11], s30 offen offset:1024 lds
 buffer_load_dwordx4 v12, s[8:11], s30 offen offset:2048 lds
 buffer_load_dwordx4 v13, s[8:11], s30 offen offset:3072 lds
 s_add_u32 s30, s30, 128
 s_add_u32 s32, s32, 16384
 s_cmp_lt_u32 s32, s46
 s_cselect_b32 s32, s32, s47
 s_mov_b32 m0, s32
 s_nop 0
 buffer_load_dwordx4 v10, s[8:11], s30 offen offset:0 lds
 buffer_load_dwordx4 v11, s[8:11], s30 offen offset:1024 lds
 buffer_load_dwordx4 v12, s[8:11], s30 offen offset:2048 lds
 buffer_load_dwordx4 v13, s[8:11], s30 offen offset:3072 lds
 s_add_u32 s30, s30, 128
 s_add_u32 s32, s32, 16384
 s_cmp_lt_u32 s32, s46
 s_cselect_b32 s32, s32, s47
 s_mov_b32 m0, s32
 s_nop 0
 buffer_load_dwordx4 v10, s[8:11], s30 offen offset:0 lds
 buffer_load_dwordx4 v11, s[8:11], s30 offen offset:1024 lds
 buffer_load_dwordx4 v12, s[8:11], s30 offen offset:2048 lds
 buffer_load_dwordx4 v13, s[8:11], s30 offen offset:3072 lds
 s_add_u32 s30, s30, 128
 s_add_u32 s32, s32, 16384
 s_cmp_lt_u32 s32, s46
 s_cselect_b32 s32, s32, s47
 s_waitcnt vmcnt(16)
 s_barrier
 s_cmp_lg_u32 s20, 0
 s_cbranch_scc1 af_129
 v_mov_b32 v4, 0
 v_mov_b32 v5, 1
 s_mov_b64 exec, 1
 buffer_atomic_add v5, v4, s[72:75], s61 offen sc1
 s_mov_b64 exec, -1
 s_nop 1
af_129:
 s_mov_b32 s26, 13
 s_mov_b32 s28, 1572864
 v_readfirstlane_b32 s100, v29
 s_cmp_lg_u32 s100, 0
 s_cbranch_scc1 c0_130
 s_mov_b32 s21, 84
 v_mov_b32 v4, 0
 s_mov_b32 s101, 0
wf_131:
 buffer_load_dword v5, v4, s[64:67], s21 offen sc1
 s_add_u32 s101, s101, 1
 s_cmp_gt_u32 s101, 131072
 s_cbranch_scc1 main_end
 s_waitcnt vmcnt(0)
 v_readfirstlane_b32 s100, v5
 s_cmp_ge_u32 s100, 1
 s_cbranch_scc1 wf_132
 s_sleep 8
 s_branch wf_131
wf_132:
c0_130:
 s_add_u32 s37, s38, 83886079
 s_add_u32 s21, s38, 180355072
 s_xor_b32 s37, s37, s21
 s_lshr_b32 s37, s37, 21
 s_xor_b32 s37, s37, s100
 s_xor_b32 s37, s37, 0
 s_and_b32 s37, s37, 1
 s_lshl_b32 s37, s37, 13
kv_main:
 v_and_b32 v6, 7, v2
 v_add_u32 v4, 0, v3
 v_xor_b32 v4, v4, v6
 v_lshlrev_b32 v4, 4, v4
 v_lshl_add_u32 v14, v2, 7, v4
 v_add_u32 v4, 4, v3
 v_xor_b32 v4, v4, v6
 v_lshlrev_b32 v4, 4, v4
 v_lshl_add_u32 v15, v2, 7, v4
 v_mul_u32_u24 v22, 400, v2
 v_mul_u32_u24 v4, 16, v3
 s_mul_i32 s21, s20, 96
 s_add_u32 s21, s21, 98304
 v_add3_u32 v22, v22, v4, s21
 v_lshlrev_b32 v4, 3, v3
 v_sub_u32 v16, v22, v4
 v_mov_b32 v9, 2731
 s_mul_i32 s21, s20, 12800
 s_add_u32 s21, s21, 98304
 v_mul_u32_u24 v4, 400, v2
 v_lshlrev_b32 v5, 4, v3
 v_add3_u32 v23, v4, v5, s21
 v_lshlrev_b32 v26, 4, v1
 s_mov_b32 s33, 32768
 s_mov_b32 s48, 0x80000000
 s_mov_b32 m0, s32
 s_nop 0
 buffer_load_dwordx4 v10, s[8:11], s30 offen offset:0 lds
 buffer_load_dwordx4 v11, s[8:11], s30 offen offset:1024 lds
 s_waitcnt vmcnt(14)
 s_barrier
 v_add_u32 v18, s33, v14
 v_add_u32 v19, s33, v15
 s_add_u32 s33, s33, 16384
 s_cmp_lt_u32 s33, 98304
 s_cselect_b32 s33, s33, 0
 ds_read_b128 v[160:163], v18 offset:0
 ds_read_b128 v[164:167], v18 offset:2048
 ds_read_b128 v[168:171], v18 offset:4096
 ds_read_b128 v[172:175], v18 offset:6144
 ds_read_b128 v[176:179], v18 offset:8192
 ds_read_b128 v[180:183], v18 offset:10240
 ds_read_b128 v[184:187], v18 offset:12288
 ds_read_b128 v[188:191], v18 offset:14336
 s_waitcnt lgkmcnt(0)
kv_blk_135:
 v_mfma_f32_16x16x32_bf16 v[64:67], a[0:3], v[160:163], 0
 ds_read_b128 v[192:195], v19 offset:0
 v_mfma_f32_16x16x32_bf16 v[68:71], a[4:7], v[160:163], 0
 v_add_u32 v18, s33, v14
 v_mfma_f32_16x16x32_bf16 v[72:75], a[8:11], v[160:163], 0
 ds_write_b64 v16, v[234:235] offset:6464
 v_mfma_f32_16x16x32_bf16 v[76:79], a[0:3], v[164:167], 0
 ds_read_b128 v[196:199], v19 offset:2048
 v_cvt_pk_bf16_f32 v236, v88, v89
 v_mfma_f32_16x16x32_bf16 v[80:83], a[4:7], v[164:167], 0
 buffer_load_dwordx4 v12, s[8:11], s30 offen offset:2048 lds
 v_mfma_f32_16x16x32_bf16 v[84:87], a[8:11], v[164:167], 0
 v_cvt_pk_bf16_f32 v237, v90, v91
 v_cvt_pk_bf16_f32 v238, v92, v93
 v_mfma_f32_16x16x32_bf16 v[88:91], a[0:3], v[168:171], 0
 ds_read_b128 v[200:203], v19 offset:4096
 v_cvt_pk_bf16_f32 v239, v94, v95
 v_mfma_f32_16x16x32_bf16 v[92:95], a[4:7], v[168:171], 0
 v_cvt_pk_bf16_f32 v240, v96, v97
 v_cvt_pk_bf16_f32 v241, v98, v99
 v_mfma_f32_16x16x32_bf16 v[96:99], a[8:11], v[168:171], 0
 ds_write_b64 v22, v[236:237] offset:12800
 ds_write_b64 v22, v[238:239] offset:12808
 ds_write_b64 v16, v[240:241] offset:12864
 v_cvt_pk_bf16_f32 v242, v100, v101
 v_cvt_pk_bf16_f32 v243, v102, v103
 v_mfma_f32_16x16x32_bf16 v[100:103], a[0:3], v[172:175], 0
 ds_read_b128 v[204:207], v19 offset:6144
 v_cvt_pk_bf16_f32 v244, v104, v105
 v_cvt_pk_bf16_f32 v245, v106, v107
 v_mfma_f32_16x16x32_bf16 v[104:107], a[4:7], v[172:175], 0
 v_cvt_pk_bf16_f32 v246, v108, v109
 v_cvt_pk_bf16_f32 v247, v110, v111
 v_mfma_f32_16x16x32_bf16 v[108:111], a[8:11], v[172:175], 0
 s_waitcnt lgkmcnt(9)
 ds_write_b64 v22, v[242:243] offset:19200
 ds_write_b64 v22, v[244:245] offset:19208
 ds_write_b64 v16, v[246:247] offset:19264
 v_cvt_pk_bf16_f32 v224, v112, v113
 v_cvt_pk_bf16_f32 v225, v114, v115
 v_mfma_f32_16x16x32_bf16 v[112:115], a[0:3], v[176:179], 0
 ds_read_b128 v[208:211], v19 offset:8192
 v_cvt_pk_bf16_f32 v226, v116, v117
 v_cvt_pk_bf16_f32 v227, v118, v119
 v_mfma_f32_16x16x32_bf16 v[116:119], a[4:7], v[176:179], 0
 v_cvt_pk_bf16_f32 v228, v120, v121
 v_cvt_pk_bf16_f32 v229, v122, v123
 v_mfma_f32_16x16x32_bf16 v[120:123], a[8:11], v[176:179], 0
 ds_write_b64 v22, v[224:225] offset:25600
 ds_write_b64 v22, v[226:227] offset:25608
 ds_write_b64 v16, v[228:229] offset:25664
 v_cvt_pk_bf16_f32 v230, v124, v125
 v_cvt_pk_bf16_f32 v231, v126, v127
 v_mfma_f32_16x16x32_bf16 v[124:127], a[0:3], v[180:183], 0
 ds_read_b128 v[212:215], v19 offset:10240
 v_cvt_pk_bf16_f32 v232, v128, v129
 v_cvt_pk_bf16_f32 v233, v130, v131
 v_mfma_f32_16x16x32_bf16 v[128:131], a[4:7], v[180:183], 0
 buffer_load_dwordx4 v13, s[8:11], s30 offen offset:3072 lds
 v_cvt_pk_bf16_f32 v234, v132, v133
 v_cvt_pk_bf16_f32 v235, v134, v135
 v_mfma_f32_16x16x32_bf16 v[132:135], a[8:11], v[180:183], 0
 s_add_u32 s30, s30, 128
 s_add_u32 m0, m0, 16384
 ds_write_b64 v22, v[230:231] offset:32000
 ds_write_b64 v22, v[232:233] offset:32008
 ds_write_b64 v16, v[234:235] offset:32064
 v_cvt_pk_bf16_f32 v236, v136, v137
 v_cvt_pk_bf16_f32 v237, v138, v139
 v_mfma_f32_16x16x32_bf16 v[136:139], a[0:3], v[184:187], 0
 ds_read_b128 v[216:219], v19 offset:12288
 v_cvt_pk_bf16_f32 v238, v140, v141
 v_cvt_pk_bf16_f32 v239, v142, v143
 v_mfma_f32_16x16x32_bf16 v[140:143], a[4:7], v[184:187], 0
 s_cmp_lt_u32 m0, s46
 s_cselect_b32 m0, m0, s47
 v_cvt_pk_bf16_f32 v240, v144, v145
 v_cvt_pk_bf16_f32 v241, v146, v147
 v_mfma_f32_16x16x32_bf16 v[144:147], a[8:11], v[184:187], 0
 ds_write_b64 v22, v[236:237] offset:38400
 ds_write_b64 v22, v[238:239] offset:38408
 ds_write_b64 v16, v[240:241] offset:38464
 v_cvt_pk_bf16_f32 v242, v148, v149
 v_cvt_pk_bf16_f32 v243, v150, v151
 v_mfma_f32_16x16x32_bf16 v[148:151], a[0:3], v[188:191], 0
 ds_read_b128 v[220:223], v19 offset:14336
 v_cvt_pk_bf16_f32 v244, v152, v153
 v_cvt_pk_bf16_f32 v245, v154, v155
 v_mfma_f32_16x16x32_bf16 v[152:155], a[4:7], v[188:191], 0
 v_cvt_pk_bf16_f32 v246, v156, v157
 v_cvt_pk_bf16_f32 v247, v158, v159
 v_mfma_f32_16x16x32_bf16 v[156:159], a[8:11], v[188:191], 0
 s_waitcnt vmcnt(12) lgkmcnt(15)
 s_barrier
 v_mfma_f32_16x16x32_bf16 v[64:67], a[12:15], v[192:195], v[64:67]
 ds_read_b128 v[160:163], v18 offset:0
 v_mfma_f32_16x16x32_bf16 v[68:71], a[16:19], v[192:195], v[68:71]
 ds_write_b64 v22, v[242:243] offset:44800
 v_mfma_f32_16x16x32_bf16 v[72:75], a[20:23], v[192:195], v[72:75]
 v_add_u32 v19, s33, v15
 s_add_u32 s33, s33, 16384
 v_mfma_f32_16x16x32_bf16 v[76:79], a[12:15], v[196:199], v[76:79]
 ds_read_b128 v[164:167], v18 offset:2048
 v_mfma_f32_16x16x32_bf16 v[80:83], a[16:19], v[196:199], v[80:83]
 buffer_load_dwordx4 v10, s[8:11], s30 offen offset:0 lds
 v_mfma_f32_16x16x32_bf16 v[84:87], a[20:23], v[196:199], v[84:87]
 s_cmp_lt_u32 s33, 98304
 s_cselect_b32 s33, s33, 0
 v_mfma_f32_16x16x32_bf16 v[88:91], a[12:15], v[200:203], v[88:91]
 ds_read_b128 v[168:171], v18 offset:4096
 v_mfma_f32_16x16x32_bf16 v[92:95], a[16:19], v[200:203], v[92:95]
 ds_write_b64 v22, v[244:245] offset:44808
 v_mfma_f32_16x16x32_bf16 v[96:99], a[20:23], v[200:203], v[96:99]
 ds_write_b64 v16, v[246:247] offset:44864
 v_mfma_f32_16x16x32_bf16 v[100:103], a[12:15], v[204:207], v[100:103]
 ds_read_b128 v[172:175], v18 offset:6144
 v_mfma_f32_16x16x32_bf16 v[104:107], a[16:19], v[204:207], v[104:107]
 v_mfma_f32_16x16x32_bf16 v[108:111], a[20:23], v[204:207], v[108:111]
 s_waitcnt lgkmcnt(7)
 v_mfma_f32_16x16x32_bf16 v[112:115], a[12:15], v[208:211], v[112:115]
 ds_read_b128 v[176:179], v18 offset:8192
 v_mfma_f32_16x16x32_bf16 v[116:119], a[16:19], v[208:211], v[116:119]
 v_mfma_f32_16x16x32_bf16 v[120:123], a[20:23], v[208:211], v[120:123]
 v_mfma_f32_16x16x32_bf16 v[124:127], a[12:15], v[212:215], v[124:127]
 ds_read_b128 v[180:183], v18 offset:10240
 v_mfma_f32_16x16x32_bf16 v[128:131], a[16:19], v[212:215], v[128:131]
 buffer_load_dwordx4 v11, s[8:11], s30 offen offset:1024 lds
 v_mfma_f32_16x16x32_bf16 v[132:135], a[20:23], v[212:215], v[132:135]
 v_mfma_f32_16x16x32_bf16 v[136:139], a[12:15], v[216:219], v[136:139]
 ds_read_b128 v[184:187], v18 offset:12288
 v_mfma_f32_16x16x32_bf16 v[140:143], a[16:19], v[216:219], v[140:143]
 v_mfma_f32_16x16x32_bf16 v[144:147], a[20:23], v[216:219], v[144:147]
 v_mfma_f32_16x16x32_bf16 v[148:151], a[12:15], v[220:223], v[148:151]
 ds_read_b128 v[188:191], v18 offset:14336
 v_mfma_f32_16x16x32_bf16 v[152:155], a[16:19], v[220:223], v[152:155]
 v_mfma_f32_16x16x32_bf16 v[156:159], a[20:23], v[220:223], v[156:159]
 s_waitcnt lgkmcnt(4)
 v_mfma_f32_16x16x32_bf16 v[64:67], a[24:27], v[160:163], v[64:67]
 ds_read_b128 v[192:195], v19 offset:0
 v_mfma_f32_16x16x32_bf16 v[68:71], a[28:31], v[160:163], v[68:71]
 v_add_u32 v18, s33, v14
 v_mfma_f32_16x16x32_bf16 v[72:75], a[32:35], v[160:163], v[72:75]
 v_mfma_f32_16x16x32_bf16 v[76:79], a[24:27], v[164:167], v[76:79]
 ds_read_b128 v[196:199], v19 offset:2048
 v_mfma_f32_16x16x32_bf16 v[80:83], a[28:31], v[164:167], v[80:83]
 buffer_load_dwordx4 v12, s[8:11], s30 offen offset:2048 lds
 v_mfma_f32_16x16x32_bf16 v[84:87], a[32:35], v[164:167], v[84:87]
 v_mfma_f32_16x16x32_bf16 v[88:91], a[24:27], v[168:171], v[88:91]
 ds_read_b128 v[200:203], v19 offset:4096
 v_mfma_f32_16x16x32_bf16 v[92:95], a[28:31], v[168:171], v[92:95]
 v_mfma_f32_16x16x32_bf16 v[96:99], a[32:35], v[168:171], v[96:99]
 v_mfma_f32_16x16x32_bf16 v[100:103], a[24:27], v[172:175], v[100:103]
 ds_read_b128 v[204:207], v19 offset:6144
 v_mfma_f32_16x16x32_bf16 v[104:107], a[28:31], v[172:175], v[104:107]
 v_mfma_f32_16x16x32_bf16 v[108:111], a[32:35], v[172:175], v[108:111]
 s_waitcnt lgkmcnt(4)
 v_mfma_f32_16x16x32_bf16 v[112:115], a[24:27], v[176:179], v[112:115]
 ds_read_b128 v[208:211], v19 offset:8192
 v_mfma_f32_16x16x32_bf16 v[116:119], a[28:31], v[176:179], v[116:119]
 v_mfma_f32_16x16x32_bf16 v[120:123], a[32:35], v[176:179], v[120:123]
 v_mfma_f32_16x16x32_bf16 v[124:127], a[24:27], v[180:183], v[124:127]
 ds_read_b128 v[212:215], v19 offset:10240
 v_mfma_f32_16x16x32_bf16 v[128:131], a[28:31], v[180:183], v[128:131]
 buffer_load_dwordx4 v13, s[8:11], s30 offen offset:3072 lds
 v_mfma_f32_16x16x32_bf16 v[132:135], a[32:35], v[180:183], v[132:135]
 s_add_u32 s30, s30, 128
 s_add_u32 m0, m0, 16384
 v_mfma_f32_16x16x32_bf16 v[136:139], a[24:27], v[184:187], v[136:139]
 ds_read_b128 v[216:219], v19 offset:12288
 v_mfma_f32_16x16x32_bf16 v[140:143], a[28:31], v[184:187], v[140:143]
 s_cmp_lt_u32 m0, s46
 s_cselect_b32 m0, m0, s47
 v_mfma_f32_16x16x32_bf16 v[144:147], a[32:35], v[184:187], v[144:147]
 v_mfma_f32_16x16x32_bf16 v[148:151], a[24:27], v[188:191], v[148:151]
 ds_read_b128 v[220:223], v19 offset:14336
 v_mfma_f32_16x16x32_bf16 v[152:155], a[28:31], v[188:191], v[152:155]
 v_mfma_f32_16x16x32_bf16 v[156:159], a[32:35], v[188:191], v[156:159]
 s_waitcnt vmcnt(12) lgkmcnt(4)
 s_barrier
 v_mfma_f32_16x16x32_bf16 v[64:67], a[36:39], v[192:195], v[64:67]
 ds_read_b128 v[160:163], v18 offset:0
 v_mfma_f32_16x16x32_bf16 v[68:71], a[40:43], v[192:195], v[68:71]
 v_mfma_f32_16x16x32_bf16 v[72:75], a[44:47], v[192:195], v[72:75]
 v_add_u32 v19, s33, v15
 s_add_u32 s33, s33, 16384
 v_mfma_f32_16x16x32_bf16 v[76:79], a[36:39], v[196:199], v[76:79]
 ds_read_b128 v[164:167], v18 offset:2048
 v_mfma_f32_16x16x32_bf16 v[80:83], a[40:43], v[196:199], v[80:83]
 buffer_load_dwordx4 v10, s[8:11], s30 offen offset:0 lds
 v_mfma_f32_16x16x32_bf16 v[84:87], a[44:47], v[196:199], v[84:87]
 s_cmp_lt_u32 s33, 98304
 s_cselect_b32 s33, s33, 0
 v_mfma_f32_16x16x32_bf16 v[88:91], a[36:39], v[200:203], v[88:91]
 ds_read_b128 v[168:171], v18 offset:4096
 v_mfma_f32_16x16x32_bf16 v[92:95], a[40:43], v[200:203], v[92:95]
 ds_read_b128 v[224:227], v23 offset:0
 v_mfma_f32_16x16x32_bf16 v[96:99], a[44:47], v[200:203], v[96:99]
 v_mfma_f32_16x16x32_bf16 v[100:103], a[36:39], v[204:207], v[100:103]
 ds_read_b128 v[172:175], v18 offset:6144
 v_mfma_f32_16x16x32_bf16 v[104:107], a[40:43], v[204:207], v[104:107]
 v_mfma_f32_16x16x32_bf16 v[108:111], a[44:47], v[204:207], v[108:111]
 s_waitcnt lgkmcnt(5)
 v_mfma_f32_16x16x32_bf16 v[112:115], a[36:39], v[208:211], v[112:115]
 ds_read_b128 v[176:179], v18 offset:8192
 v_mfma_f32_16x16x32_bf16 v[116:119], a[40:43], v[208:211], v[116:119]
 v_mfma_f32_16x16x32_bf16 v[120:123], a[44:47], v[208:211], v[120:123]
 v_mfma_f32_16x16x32_bf16 v[124:127], a[36:39], v[212:215], v[124:127]
 ds_read_b128 v[180:183], v18 offset:10240
 v_mfma_f32_16x16x32_bf16 v[128:131], a[40:43], v[212:215], v[128:131]
 buffer_load_dwordx4 v11, s[8:11], s30 offen offset:1024 lds
 v_mfma_f32_16x16x32_bf16 v[132:135], a[44:47], v[212:215], v[132:135]
 v_mfma_f32_16x16x32_bf16 v[136:139], a[36:39], v[216:219], v[136:139]
 ds_read_b128 v[184:187], v18 offset:12288
 v_mfma_f32_16x16x32_bf16 v[140:143], a[40:43], v[216:219], v[140:143]
 ds_read_b128 v[228:231], v23 offset:64
 v_mfma_f32_16x16x32_bf16 v[144:147], a[44:47], v[216:219], v[144:147]
 v_mfma_f32_16x16x32_bf16 v[148:151], a[36:39], v[220:223], v[148:151]
 ds_read_b128 v[188:191], v18 offset:14336
 v_mfma_f32_16x16x32_bf16 v[152:155], a[40:43], v[220:223], v[152:155]
 v_mfma_f32_16x16x32_bf16 v[156:159], a[44:47], v[220:223], v[156:159]
 s_waitcnt lgkmcnt(5)
 v_mfma_f32_16x16x32_bf16 v[64:67], a[48:51], v[160:163], v[64:67]
 ds_read_b128 v[192:195], v19 offset:0
 v_mfma_f32_16x16x32_bf16 v[68:71], a[52:55], v[160:163], v[68:71]
 v_add_u32 v18, s33, v14
 v_mfma_f32_16x16x32_bf16 v[72:75], a[56:59], v[160:163], v[72:75]
 v_mfma_f32_16x16x32_bf16 v[76:79], a[48:51], v[164:167], v[76:79]
 ds_read_b128 v[196:199], v19 offset:2048
 v_mfma_f32_16x16x32_bf16 v[80:83], a[52:55], v[164:167], v[80:83]
 buffer_load_dwordx4 v12, s[8:11], s30 offen offset:2048 lds
 v_mfma_f32_16x16x32_bf16 v[84:87], a[56:59], v[164:167], v[84:87]
 v_mfma_f32_16x16x32_bf16 v[88:91], a[48:51], v[168:171], v[88:91]
 ds_read_b128 v[200:203], v19 offset:4096
 v_mfma_f32_16x16x32_bf16 v[92:95], a[52:55], v[168:171], v[92:95]
 s_add_u32 s21, s48, 0
 ds_read_b128 v[232:235], v23 offset:128
 v_mfma_f32_16x16x32_bf16 v[96:99], a[56:59], v[168:171], v[96:99]
 v_mfma_f32_16x16x32_bf16 v[100:103], a[48:51], v[172:175], v[100:103]
 ds_read_b128 v[204:207], v19 offset:6144
 v_mfma_f32_16x16x32_bf16 v[104:107], a[52:55], v[172:175], v[104:107]
 buffer_store_dwordx4 v[224:227], v26, s[16:19], s21 offen offset:0 sc1
 v_mfma_f32_16x16x32_bf16 v[108:111], a[56:59], v[172:175], v[108:111]
 s_waitcnt lgkmcnt(5)
 v_mfma_f32_16x16x32_bf16 v[112:115], a[48:51], v[176:179], v[112:115]
 ds_read_b128 v[208:211], v19 offset:8192
 v_mfma_f32_16x16x32_bf16 v[116:119], a[52:55], v[176:179], v[116:119]
 v_mfma_f32_16x16x32_bf16 v[120:123], a[56:59], v[176:179], v[120:123]
 v_mfma_f32_16x16x32_bf16 v[124:127], a[48:51], v[180:183], v[124:127]
 ds_read_b128 v[212:215], v19 offset:10240
 v_mfma_f32_16x16x32_bf16 v[128:131], a[52:55], v[180:183], v[128:131]
 buffer_load_dwordx4 v13, s[8:11], s30 offen offset:3072 lds
 v_mfma_f32_16x16x32_bf16 v[132:135], a[56:59], v[180:183], v[132:135]
 s_add_u32 s30, s30, 128
 s_add_u32 m0, m0, 16384
 v_mfma_f32_16x16x32_bf16 v[136:139], a[48:51], v[184:187], v[136:139]
 ds_read_b128 v[216:219], v19 offset:12288
 v_mfma_f32_16x16x32_bf16 v[140:143], a[52:55], v[184:187], v[140:143]
 s_cmp_lt_u32 m0, s46
 s_cselect_b32 m0, m0, s47
 v_mfma_f32_16x16x32_bf16 v[144:147], a[56:59], v[184:187], v[144:147]
 ds_read_b128 v[236:239], v23 offset:192
 v_mfma_f32_16x16x32_bf16 v[148:151], a[48:51], v[188:191], v[148:151]
 ds_read_b128 v[220:223], v19 offset:14336
 v_mfma_f32_16x16x32_bf16 v[152:155], a[52:55], v[188:191], v[152:155]
 buffer_store_dwordx4 v[228:231], v26, s[16:19], s21 offen offset:1024 sc1
 v_mfma_f32_16x16x32_bf16 v[156:159], a[56:59], v[188:191], v[156:159]
 s_waitcnt vmcnt(14) lgkmcnt(5)
 s_barrier
 v_mfma_f32_16x16x32_bf16 v[64:67], a[60:63], v[192:195], v[64:67]
 ds_read_b128 v[160:163], v18 offset:0
 v_mfma_f32_16x16x32_bf16 v[68:71], a[64:67], v[192:195], v[68:71]
 v_mfma_f32_16x16x32_bf16 v[72:75], a[68:71], v[192:195], v[72:75]
 v_add_u32 v19, s33, v15
 s_add_u32 s33, s33, 16384
 v_mfma_f32_16x16x32_bf16 v[76:79], a[60:63], v[196:199], v[76:79]
 ds_read_b128 v[164:167], v18 offset:2048
 v_mfma_f32_16x16x32_bf16 v[80:83], a[64:67], v[196:199], v[80:83]
 buffer_load_dwordx4 v10, s[8:11], s30 offen offset:0 lds
 v_mfma_f32_16x16x32_bf16 v[84:87], a[68:71], v[196:199], v[84:87]
 s_cmp_lt_u32 s33, 98304
 s_cselect_b32 s33, s33, 0
 v_mfma_f32_16x16x32_bf16 v[88:91], a[60:63], v[200:203], v[88:91]
 ds_read_b128 v[168:171], v18 offset:4096
 v_mfma_f32_16x16x32_bf16 v[92:95], a[64:67], v[200:203], v[92:95]
 ds_read_b128 v[240:243], v23 offset:256
 v_mfma_f32_16x16x32_bf16 v[96:99], a[68:71], v[200:203], v[96:99]
 v_mfma_f32_16x16x32_bf16 v[100:103], a[60:63], v[204:207], v[100:103]
 ds_read_b128 v[172:175], v18 offset:6144
 v_mfma_f32_16x16x32_bf16 v[104:107], a[64:67], v[204:207], v[104:107]
 buffer_store_dwordx4 v[232:235], v26, s[16:19], s21 offen offset:2048 sc1
 v_mfma_f32_16x16x32_bf16 v[108:111], a[68:71], v[204:207], v[108:111]
 s_waitcnt lgkmcnt(5)
 v_mfma_f32_16x16x32_bf16 v[112:115], a[60:63], v[208:211], v[112:115]
 ds_read_b128 v[176:179], v18 offset:8192
 v_mfma_f32_16x16x32_bf16 v[116:119], a[64:67], v[208:211], v[116:119]
 v_mfma_f32_16x16x32_bf16 v[120:123], a[68:71], v[208:211], v[120:123]
 v_mfma_f32_16x16x32_bf16 v[124:127], a[60:63], v[212:215], v[124:127]
 ds_read_b128 v[180:183], v18 offset:10240
 v_mfma_f32_16x16x32_bf16 v[128:131], a[64:67], v[212:215], v[128:131]
 buffer_load_dwordx4 v11, s[8:11], s30 offen offset:1024 lds
 v_mfma_f32_16x16x32_bf16 v[132:135], a[68:71], v[212:215], v[132:135]
 v_mfma_f32_16x16x32_bf16 v[136:139], a[60:63], v[216:219], v[136:139]
 ds_read_b128 v[184:187], v18 offset:12288
 v_mfma_f32_16x16x32_bf16 v[140:143], a[64:67], v[216:219], v[140:143]
 ds_read_b128 v[244:247], v23 offset:320
 v_mfma_f32_16x16x32_bf16 v[144:147], a[68:71], v[216:219], v[144:147]
 v_mfma_f32_16x16x32_bf16 v[148:151], a[60:63], v[220:223], v[148:151]
 ds_read_b128 v[188:191], v18 offset:14336
 v_mfma_f32_16x16x32_bf16 v[152:155], a[64:67], v[220:223], v[152:155]
 buffer_store_dwordx4 v[236:239], v26, s[16:19], s21 offen offset:3072 sc1
 v_mfma_f32_16x16x32_bf16 v[156:159], a[68:71], v[220:223], v[156:159]
 s_waitcnt lgkmcnt(5)
 v_mfma_f32_16x16x32_bf16 v[64:67], a[72:75], v[160:163], v[64:67]
 ds_read_b128 v[192:195], v19 offset:0
 v_mfma_f32_16x16x32_bf16 v[68:71], a[76:79], v[160:163], v[68:71]
 v_add_u32 v18, s33, v14
 v_mfma_f32_16x16x32_bf16 v[72:75], a[80:83], v[160:163], v[72:75]
 v_mfma_f32_16x16x32_bf16 v[76:79], a[72:75], v[164:167], v[76:79]
 ds_read_b128 v[196:199], v19 offset:2048
 v_mfma_f32_16x16x32_bf16 v[80:83], a[76:79], v[164:167], v[80:83]
 buffer_load_dwordx4 v12, s[8:11], s30 offen offset:2048 lds
 v_mfma_f32_16x16x32_bf16 v[84:87], a[80:83], v[164:167], v[84:87]
 v_mfma_f32_16x16x32_bf16 v[88:91], a[72:75], v[168:171], v[88:91]
 ds_read_b128 v[200:203], v19 offset:4096
 v_mfma_f32_16x16x32_bf16 v[92:95], a[76:79], v[168:171], v[92:95]
 s_add_u32 s21, s48, 4096
 ds_read_b128 v[224:227], v23 offset:6400
 v_mfma_f32_16x16x32_bf16 v[96:99], a[80:83], v[168:171], v[96:99]
 v_mfma_f32_16x16x32_bf16 v[100:103], a[72:75], v[172:175], v[100:103]
 ds_read_b128 v[204:207], v19 offset:6144
 v_mfma_f32_16x16x32_bf16 v[104:107], a[76:79], v[172:175], v[104:107]
 buffer_store_dwordx4 v[240:243], v26, s[16:19], s21 offen offset:0 sc1
 v_mfma_f32_16x16x32_bf16 v[108:111], a[80:83], v[172:175], v[108:111]
 s_waitcnt lgkmcnt(5)
 v_mfma_f32_16x16x32_bf16 v[112:115], a[72:75], v[176:179], v[112:115]
 ds_read_b128 v[208:211], v19 offset:8192
 v_mfma_f32_16x16x32_bf16 v[116:119], a[76:79], v[176:179], v[116:119]
 v_mfma_f32_16x16x32_bf16 v[120:123], a[80:83], v[176:179], v[120:123]
 v_mfma_f32_16x16x32_bf16 v[124:127], a[72:75], v[180:183], v[124:127]
 ds_read_b128 v[212:215], v19 offset:10240
 v_mfma_f32_16x16x32_bf16 v[128:131], a[76:79], v[180:183], v[128:131]
 buffer_load_dwordx4 v13, s[8:11], s30 offen offset:3072 lds
 v_mfma_f32_16x16x32_bf16 v[132:135], a[80:83], v[180:183], v[132:135]
 s_add_u32 s30, s30, 128
 s_add_u32 m0, m0, 16384
 v_mfma_f32_16x16x32_bf16 v[136:139], a[72:75], v[184:187], v[136:139]
 ds_read_b128 v[216:219], v19 offset:12288
 v_mfma_f32_16x16x32_bf16 v[140:143], a[76:79], v[184:187], v[140:143]
 s_cmp_lt_u32 m0, s46
 s_cselect_b32 m0, m0, s47
 v_mfma_f32_16x16x32_bf16 v[144:147], a[80:83], v[184:187], v[144:147]
 ds_read_b128 v[228:231], v23 offset:6464
 v_mfma_f32_16x16x32_bf16 v[148:151], a[72:75], v[188:191], v[148:151]
 ds_read_b128 v[220:223], v19 offset:14336
 v_mfma_f32_16x16x32_bf16 v[152:155], a[76:79], v[188:191], v[152:155]
 buffer_store_dwordx4 v[244:247], v26, s[16:19], s21 offen offset:1024 sc1
 v_mfma_f32_16x16x32_bf16 v[156:159], a[80:83], v[188:191], v[156:159]
 s_waitcnt vmcnt(18) lgkmcnt(5)
 s_barrier
 v_mfma_f32_16x16x32_bf16 v[64:67], a[84:87], v[192:195], v[64:67]
 ds_read_b128 v[160:163], v18 offset:0
 v_mfma_f32_16x16x32_bf16 v[68:71], a[88:91], v[192:195], v[68:71]
 v_mfma_f32_16x16x32_bf16 v[72:75], a[92:95], v[192:195], v[72:75]
 v_add_u32 v19, s33, v15
 s_add_u32 s33, s33, 16384
 v_mfma_f32_16x16x32_bf16 v[76:79], a[84:87], v[196:199], v[76:79]
 ds_read_b128 v[164:167], v18 offset:2048
 v_mfma_f32_16x16x32_bf16 v[80:83], a[88:91], v[196:199], v[80:83]
 buffer_load_dwordx4 v10, s[8:11], s30 offen offset:0 lds
 v_mfma_f32_16x16x32_bf16 v[84:87], a[92:95], v[196:199], v[84:87]
 s_cmp_lt_u32 s33, 98304
 s_cselect_b32 s33, s33, 0
 v_mfma_f32_16x16x32_bf16 v[88:91], a[84:87], v[200:203], v[88:91]
 ds_read_b128 v[168:171], v18 offset:4096
 v_mfma_f32_16x16x32_bf16 v[92:95], a[88:91], v[200:203], v[92:95]
 ds_read_b128 v[232:235], v23 offset:6528
 v_mfma_f32_16x16x32_bf16 v[96:99], a[92:95], v[200:203], v[96:99]
 v_mfma_f32_16x16x32_bf16 v[100:103], a[84:87], v[204:207], v[100:103]
 ds_read_b128 v[172:175], v18 offset:6144
 v_mfma_f32_16x16x32_bf16 v[104:107], a[88:91], v[204:207], v[104:107]
 buffer_store_dwordx4 v[224:227], v26, s[16:19], s21 offen offset:2048 sc1
 v_mfma_f32_16x16x32_bf16 v[108:111], a[92:95], v[204:207], v[108:111]
 s_waitcnt lgkmcnt(5)
 v_mfma_f32_16x16x32_bf16 v[112:115], a[84:87], v[208:211], v[112:115]
 ds_read_b128 v[176:179], v18 offset:8192
 v_mfma_f32_16x16x32_bf16 v[116:119], a[88:91], v[208:211], v[116:119]
 v_mfma_f32_16x16x32_bf16 v[120:123], a[92:95], v[208:211], v[120:123]
 v_mfma_f32_16x16x32_bf16 v[124:127], a[84:87], v[212:215], v[124:127]
 ds_read_b128 v[180:183], v18 offset:10240
 v_mfma_f32_16x16x32_bf16 v[128:131], a[88:91], v[212:215], v[128:131]
 buffer_load_dwordx4 v11, s[8:11], s30 offen offset:1024 lds
 v_mfma_f32_16x16x32_bf16 v[132:135], a[92:95], v[212:215], v[132:135]
 v_mfma_f32_16x16x32_bf16 v[136:139], a[84:87], v[216:219], v[136:139]
 ds_read_b128 v[184:187], v18 offset:12288
 v_mfma_f32_16x16x32_bf16 v[140:143], a[88:91], v[216:219], v[140:143]
 ds_read_b128 v[236:239], v23 offset:6592
 v_mfma_f32_16x16x32_bf16 v[144:147], a[92:95], v[216:219], v[144:147]
 v_mfma_f32_16x16x32_bf16 v[148:151], a[84:87], v[220:223], v[148:151]
 ds_read_b128 v[188:191], v18 offset:14336
 v_mfma_f32_16x16x32_bf16 v[152:155], a[88:91], v[220:223], v[152:155]
 buffer_store_dwordx4 v[228:231], v26, s[16:19], s21 offen offset:3072 sc1
 v_mfma_f32_16x16x32_bf16 v[156:159], a[92:95], v[220:223], v[156:159]
 s_waitcnt lgkmcnt(5)
 v_mfma_f32_16x16x32_bf16 v[64:67], a[96:99], v[160:163], v[64:67]
 ds_read_b128 v[192:195], v19 offset:0
 v_mfma_f32_16x16x32_bf16 v[68:71], a[100:103], v[160:163], v[68:71]
 v_add_u32 v18, s33, v14
 v_mfma_f32_16x16x32_bf16 v[72:75], a[104:107], v[160:163], v[72:75]
 v_mfma_f32_16x16x32_bf16 v[76:79], a[96:99], v[164:167], v[76:79]
 ds_read_b128 v[196:199], v19 offset:2048
 v_mfma_f32_16x16x32_bf16 v[80:83], a[100:103], v[164:167], v[80:83]
 buffer_load_dwordx4 v12, s[8:11], s30 offen offset:2048 lds
 v_mfma_f32_16x16x32_bf16 v[84:87], a[104:107], v[164:167], v[84:87]
 v_mfma_f32_16x16x32_bf16 v[88:91], a[96:99], v[168:171], v[88:91]
 ds_read_b128 v[200:203], v19 offset:4096
 v_mfma_f32_16x16x32_bf16 v[92:95], a[100:103], v[168:171], v[92:95]
 s_add_u32 s21, s48, 8192
 ds_read_b128 v[240:243], v23 offset:6656
 v_mfma_f32_16x16x32_bf16 v[96:99], a[104:107], v[168:171], v[96:99]
 v_mfma_f32_16x16x32_bf16 v[100:103], a[96:99], v[172:175], v[100:103]
 ds_read_b128 v[204:207], v19 offset:6144
 v_mfma_f32_16x16x32_bf16 v[104:107], a[100:103], v[172:175], v[104:107]
 buffer_store_dwordx4 v[232:235], v26, s[16:19], s21 offen offset:0 sc1
 v_mfma_f32_16x16x32_bf16 v[108:111], a[104:107], v[172:175], v[108:111]
 s_waitcnt lgkmcnt(5)
 v_mfma_f32_16x16x32_bf16 v[112:115], a[96:99], v[176:179], v[112:115]
 ds_read_b128 v[208:211], v19 offset:8192
 v_mfma_f32_16x16x32_bf16 v[116:119], a[100:103], v[176:179], v[116:119]
 v_mfma_f32_16x16x32_bf16 v[120:123], a[104:107], v[176:179], v[120:123]
 v_mfma_f32_16x16x32_bf16 v[124:127], a[96:99], v[180:183], v[124:127]
 ds_read_b128 v[212:215], v19 offset:10240
 v_mfma_f32_16x16x32_bf16 v[128:131], a[100:103], v[180:183], v[128:131]
 buffer_load_dwordx4 v13, s[8:11], s30 offen offset:3072 lds
 v_mfma_f32_16x16x32_bf16 v[132:135], a[104:107], v[180:183], v[132:135]
 s_add_u32 s30, s30, 128
 s_add_u32 m0, m0, 16384
 v_mfma_f32_16x16x32_bf16 v[136:139], a[96:99], v[184:187], v[136:139]
 ds_read_b128 v[216:219], v19 offset:12288
 v_mfma_f32_16x16x32_bf16 v[140:143], a[100:103], v[184:187], v[140:143]
 s_cmp_lt_u32 m0, s46
 s_cselect_b32 m0, m0, s47
 v_mfma_f32_16x16x32_bf16 v[144:147], a[104:107], v[184:187], v[144:147]
 ds_read_b128 v[244:247], v23 offset:6720
 v_mfma_f32_16x16x32_bf16 v[148:151], a[96:99], v[188:191], v[148:151]
 ds_read_b128 v[220:223], v19 offset:14336
 v_mfma_f32_16x16x32_bf16 v[152:155], a[100:103], v[188:191], v[152:155]
 buffer_store_dwordx4 v[236:239], v26, s[16:19], s21 offen offset:1024 sc1
 v_mfma_f32_16x16x32_bf16 v[156:159], a[104:107], v[188:191], v[156:159]
 s_waitcnt vmcnt(22) lgkmcnt(5)
 s_barrier
 v_mfma_f32_16x16x32_bf16 v[64:67], a[108:111], v[192:195], v[64:67]
 ds_read_b128 v[160:163], v18 offset:0
 v_mfma_f32_16x16x32_bf16 v[68:71], a[112:115], v[192:195], v[68:71]
 v_mfma_f32_16x16x32_bf16 v[72:75], a[116:119], v[192:195], v[72:75]
 v_add_u32 v19, s33, v15
 s_add_u32 s33, s33, 16384
 v_mfma_f32_16x16x32_bf16 v[76:79], a[108:111], v[196:199], v[76:79]
 ds_read_b128 v[164:167], v18 offset:2048
 v_mfma_f32_16x16x32_bf16 v[80:83], a[112:115], v[196:199], v[80:83]
 buffer_load_dwordx4 v10, s[8:11], s30 offen offset:0 lds
 v_mfma_f32_16x16x32_bf16 v[84:87], a[116:119], v[196:199], v[84:87]
 s_cmp_lt_u32 s33, 98304
 s_cselect_b32 s33, s33, 0
 v_mfma_f32_16x16x32_bf16 v[88:91], a[108:111], v[200:203], v[88:91]
 ds_read_b128 v[168:171], v18 offset:4096
 v_mfma_f32_16x16x32_bf16 v[92:95], a[112:115], v[200:203], v[92:95]
 v_mfma_f32_16x16x32_bf16 v[96:99], a[116:119], v[200:203], v[96:99]
 v_mfma_f32_16x16x32_bf16 v[100:103], a[108:111], v[204:207], v[100:103]
 ds_read_b128 v[172:175], v18 offset:6144
 v_mfma_f32_16x16x32_bf16 v[104:107], a[112:115], v[204:207], v[104:107]
 buffer_store_dwordx4 v[240:243], v26, s[16:19], s21 offen offset:2048 sc1
 v_mfma_f32_16x16x32_bf16 v[108:111], a[116:119], v[204:207], v[108:111]
 s_waitcnt lgkmcnt(4)
 v_mfma_f32_16x16x32_bf16 v[112:115], a[108:111], v[208:211], v[112:115]
 ds_read_b128 v[176:179], v18 offset:8192
 v_mfma_f32_16x16x32_bf16 v[116:119], a[112:115], v[208:211], v[116:119]
 v_mfma_f32_16x16x32_bf16 v[120:123], a[116:119], v[208:211], v[120:123]
 v_mfma_f32_16x16x32_bf16 v[124:127], a[108:111], v[212:215], v[124:127]
 ds_read_b128 v[180:183], v18 offset:10240
 v_mfma_f32_16x16x32_bf16 v[128:131], a[112:115], v[212:215], v[128:131]
 buffer_load_dwordx4 v11, s[8:11], s30 offen offset:1024 lds
 v_mfma_f32_16x16x32_bf16 v[132:135], a[116:119], v[212:215], v[132:135]
 v_mfma_f32_16x16x32_bf16 v[136:139], a[108:111], v[216:219], v[136:139]
 ds_read_b128 v[184:187], v18 offset:12288
 v_mfma_f32_16x16x32_bf16 v[140:143], a[112:115], v[216:219], v[140:143]
 v_mfma_f32_16x16x32_bf16 v[144:147], a[116:119], v[216:219], v[144:147]
 v_mfma_f32_16x16x32_bf16 v[148:151], a[108:111], v[220:223], v[148:151]
 ds_read_b128 v[188:191], v18 offset:14336
 v_mfma_f32_16x16x32_bf16 v[152:155], a[112:115], v[220:223], v[152:155]
 buffer_store_dwordx4 v[244:247], v26, s[16:19], s21 offen offset:3072 sc1
 v_mfma_f32_16x16x32_bf16 v[156:159], a[116:119], v[220:223], v[156:159]
 s_waitcnt lgkmcnt(4)
 v_mfma_f32_16x16x32_bf16 v[64:67], a[120:123], v[160:163], v[64:67]
 ds_read_b128 v[192:195], v19 offset:0
 v_mfma_f32_16x16x32_bf16 v[68:71], a[124:127], v[160:163], v[68:71]
 v_add_u32 v18, s33, v14
 v_mfma_f32_16x16x32_bf16 v[72:75], a[128:131], v[160:163], v[72:75]
 v_mfma_f32_16x16x32_bf16 v[76:79], a[120:123], v[164:167], v[76:79]
 ds_read_b128 v[196:199], v19 offset:2048
 v_mfma_f32_16x16x32_bf16 v[80:83], a[124:127], v[164:167], v[80:83]
 buffer_load_dwordx4 v12, s[8:11], s30 offen offset:2048 lds
 v_mfma_f32_16x16x32_bf16 v[84:87], a[128:131], v[164:167], v[84:87]
 v_mfma_f32_16x16x32_bf16 v[88:91], a[120:123], v[168:171], v[88:91]
 ds_read_b128 v[200:203], v19 offset:4096
 v_mfma_f32_16x16x32_bf16 v[92:95], a[124:127], v[168:171], v[92:95]
 v_mfma_f32_16x16x32_bf16 v[96:99], a[128:131], v[168:171], v[96:99]
 v_mfma_f32_16x16x32_bf16 v[100:103], a[120:123], v[172:175], v[100:103]
 ds_read_b128 v[204:207], v19 offset:6144
 v_mfma_f32_16x16x32_bf16 v[104:107], a[124:127], v[172:175], v[104:107]
 v_mfma_f32_16x16x32_bf16 v[108:111], a[128:131], v[172:175], v[108:111]
 s_waitcnt lgkmcnt(4)
 v_mfma_f32_16x16x32_bf16 v[112:115], a[120:123], v[176:179], v[112:115]
 ds_read_b128 v[208:211], v19 offset:8192
 v_mfma_f32_16x16x32_bf16 v[116:119], a[124:127], v[176:179], v[116:119]
 v_mfma_f32_16x16x32_bf16 v[120:123], a[128:131], v[176:179], v[120:123]
 v_mfma_f32_16x16x32_bf16 v[124:127], a[120:123], v[180:183], v[124:127]
 ds_read_b128 v[212:215], v19 offset:10240
 v_mfma_f32_16x16x32_bf16 v[128:131], a[124:127], v[180:183], v[128:131]
 buffer_load_dwordx4 v13, s[8:11], s30 offen offset:3072 lds
 v_mfma_f32_16x16x32_bf16 v[132:135], a[128:131], v[180:183], v[132:135]
 s_add_u32 s30, s30, s25
 s_sub_u32 s30, s30, 1152
 v_mfma_f32_16x16x32_bf16 v[136:139], a[120:123], v[184:187], v[136:139]
 ds_read_b128 v[216:219], v19 offset:12288
 s_add_u32 m0, m0, 16384
 v_mfma_f32_16x16x32_bf16 v[140:143], a[124:127], v[184:187], v[140:143]
 s_cmp_lt_u32 m0, s46
 s_cselect_b32 m0, m0, s47
 v_mfma_f32_16x16x32_bf16 v[144:147], a[128:131], v[184:187], v[144:147]
 v_mfma_f32_16x16x32_bf16 v[148:151], a[120:123], v[188:191], v[148:151]
 ds_read_b128 v[220:223], v19 offset:14336
 v_mfma_f32_16x16x32_bf16 v[152:155], a[124:127], v[188:191], v[152:155]
 v_mfma_f32_16x16x32_bf16 v[156:159], a[128:131], v[188:191], v[156:159]
 s_waitcnt vmcnt(23) lgkmcnt(4)
 s_barrier
 v_mfma_f32_16x16x32_bf16 v[64:67], a[132:135], v[192:195], v[64:67]
 ds_read_b128 v[160:163], v18 offset:0
 v_mfma_f32_16x16x32_bf16 v[68:71], a[136:139], v[192:195], v[68:71]
 v_mfma_f32_16x16x32_bf16 v[72:75], a[140:143], v[192:195], v[72:75]
 v_add_u32 v19, s33, v15
 s_add_u32 s33, s33, 16384
 v_mfma_f32_16x16x32_bf16 v[76:79], a[132:135], v[196:199], v[76:79]
 ds_read_b128 v[164:167], v18 offset:2048
 v_mfma_f32_16x16x32_bf16 v[80:83], a[136:139], v[196:199], v[80:83]
 buffer_load_dwordx4 v10, s[8:11], s30 offen offset:0 lds
 v_mfma_f32_16x16x32_bf16 v[84:87], a[140:143], v[196:199], v[84:87]
 s_cmp_lt_u32 s33, 98304
 s_cselect_b32 s33, s33, 0
 v_mfma_f32_16x16x32_bf16 v[88:91], a[132:135], v[200:203], v[88:91]
 ds_read_b128 v[168:171], v18 offset:4096
 v_mfma_f32_16x16x32_bf16 v[92:95], a[136:139], v[200:203], v[92:95]
 v_mfma_f32_16x16x32_bf16 v[96:99], a[140:143], v[200:203], v[96:99]
 v_mfma_f32_16x16x32_bf16 v[100:103], a[132:135], v[204:207], v[100:103]
 ds_read_b128 v[172:175], v18 offset:6144
 v_mfma_f32_16x16x32_bf16 v[104:107], a[136:139], v[204:207], v[104:107]
 v_mfma_f32_16x16x32_bf16 v[108:111], a[140:143], v[204:207], v[108:111]
 s_waitcnt lgkmcnt(4)
 v_mfma_f32_16x16x32_bf16 v[112:115], a[132:135], v[208:211], v[112:115]
 ds_read_b128 v[176:179], v18 offset:8192
 v_mfma_f32_16x16x32_bf16 v[116:119], a[136:139], v[208:211], v[116:119]
 v_mfma_f32_16x16x32_bf16 v[120:123], a[140:143], v[208:211], v[120:123]
 v_mfma_f32_16x16x32_bf16 v[124:127], a[132:135], v[212:215], v[124:127]
 ds_read_b128 v[180:183], v18 offset:10240
 v_mfma_f32_16x16x32_bf16 v[128:131], a[136:139], v[212:215], v[128:131]
 buffer_load_dwordx4 v11, s[8:11], s30 offen offset:1024 lds
 v_mfma_f32_16x16x32_bf16 v[132:135], a[140:143], v[212:215], v[132:135]
 v_mfma_f32_16x16x32_bf16 v[136:139], a[132:135], v[216:219], v[136:139]
 ds_read_b128 v[184:187], v18 offset:12288
 v_mfma_f32_16x16x32_bf16 v[140:143], a[136:139], v[216:219], v[140:143]
 v_mfma_f32_16x16x32_bf16 v[144:147], a[140:143], v[216:219], v[144:147]
 v_mfma_f32_16x16x32_bf16 v[148:151], a[132:135], v[220:223], v[148:151]
 ds_read_b128 v[188:191], v18 offset:14336
 v_mfma_f32_16x16x32_bf16 v[152:155], a[136:139], v[220:223], v[152:155]
 v_mfma_f32_16x16x32_bf16 v[156:159], a[140:143], v[220:223], v[156:159]
 s_waitcnt lgkmcnt(4)
 v_mfma_f32_16x16x32_bf16 v[64:67], a[144:147], v[160:163], v[64:67]
 ds_read_b128 v[192:195], v19 offset:0
 v_mfma_f32_16x16x32_bf16 v[68:71], a[148:151], v[160:163], v[68:71]
 v_add_u32 v18, s33, v14
 v_mfma_f32_16x16x32_bf16 v[72:75], a[152:155], v[160:163], v[72:75]
 v_mfma_f32_16x16x32_bf16 v[76:79], a[144:147], v[164:167], v[76:79]
 ds_read_b128 v[196:199], v19 offset:2048
 v_mfma_f32_16x16x32_bf16 v[80:83], a[148:151], v[164:167], v[80:83]
 buffer_load_dwordx4 v12, s[8:11], s30 offen offset:2048 lds
 v_mfma_f32_16x16x32_bf16 v[84:87], a[152:155], v[164:167], v[84:87]
 v_mfma_f32_16x16x32_bf16 v[88:91], a[144:147], v[168:171], v[88:91]
 ds_read_b128 v[200:203], v19 offset:4096
 v_mfma_f32_16x16x32_bf16 v[92:95], a[148:151], v[168:171], v[92:95]
 v_mfma_f32_16x16x32_bf16 v[96:99], a[152:155], v[168:171], v[96:99]
 v_mfma_f32_16x16x32_bf16 v[100:103], a[144:147], v[172:175], v[100:103]
 ds_read_b128 v[204:207], v19 offset:6144
 v_mfma_f32_16x16x32_bf16 v[104:107], a[148:151], v[172:175], v[104:107]
 v_mfma_f32_16x16x32_bf16 v[108:111], a[152:155], v[172:175], v[108:111]
 s_waitcnt lgkmcnt(4)
 v_mfma_f32_16x16x32_bf16 v[112:115], a[144:147], v[176:179], v[112:115]
 ds_read_b128 v[208:211], v19 offset:8192
 v_mfma_f32_16x16x32_bf16 v[116:119], a[148:151], v[176:179], v[116:119]
 v_mfma_f32_16x16x32_bf16 v[120:123], a[152:155], v[176:179], v[120:123]
 v_mfma_f32_16x16x32_bf16 v[124:127], a[144:147], v[180:183], v[124:127]
 ds_read_b128 v[212:215], v19 offset:10240
 v_mfma_f32_16x16x32_bf16 v[128:131], a[148:151], v[180:183], v[128:131]
 buffer_load_dwordx4 v13, s[8:11], s30 offen offset:3072 lds
 v_mfma_f32_16x16x32_bf16 v[132:135], a[152:155], v[180:183], v[132:135]
 s_add_u32 s30, s30, 128
 s_add_u32 m0, m0, 16384
 v_mfma_f32_16x16x32_bf16 v[136:139], a[144:147], v[184:187], v[136:139]
 ds_read_b128 v[216:219], v19 offset:12288
 v_mfma_f32_16x16x32_bf16 v[140:143], a[148:151], v[184:187], v[140:143]
 s_cmp_lt_u32 m0, s46
 s_cselect_b32 m0, m0, s47
 v_mfma_f32_16x16x32_bf16 v[144:147], a[152:155], v[184:187], v[144:147]
 v_mfma_f32_16x16x32_bf16 v[148:151], a[144:147], v[188:191], v[148:151]
 ds_read_b128 v[220:223], v19 offset:14336
 v_mfma_f32_16x16x32_bf16 v[152:155], a[148:151], v[188:191], v[152:155]
 v_mfma_f32_16x16x32_bf16 v[156:159], a[152:155], v[188:191], v[156:159]
 s_waitcnt vmcnt(6) lgkmcnt(4)
 s_barrier
 v_mfma_f32_16x16x32_bf16 v[64:67], a[156:159], v[192:195], v[64:67]
 ds_read_b128 v[160:163], v18 offset:0
 v_mfma_f32_16x16x32_bf16 v[68:71], a[160:163], v[192:195], v[68:71]
 s_cmp_eq_u32 s48, 0x80000000
 s_cbranch_scc1 kv_133
 s_cmp_lg_u32 s20, 0
 s_cbranch_scc1 af_134
 v_mov_b32 v4, 0
 v_mov_b32 v5, 1
 s_mov_b64 exec, 1
 buffer_atomic_add v5, v4, s[72:75], s61 offen sc1
 s_mov_b64 exec, -1
 s_nop 1
af_134:
kv_133:
 v_mfma_f32_16x16x32_bf16 v[72:75], a[164:167], v[192:195], v[72:75]
 v_add_u32 v19, s33, v15
 s_add_u32 s33, s33, 16384
 v_mfma_f32_16x16x32_bf16 v[76:79], a[156:159], v[196:199], v[76:79]
 ds_read_b128 v[164:167], v18 offset:2048
 v_mfma_f32_16x16x32_bf16 v[80:83], a[160:163], v[196:199], v[80:83]
 buffer_load_dwordx4 v10, s[8:11], s30 offen offset:0 lds
 v_mfma_f32_16x16x32_bf16 v[84:87], a[164:167], v[196:199], v[84:87]
 s_cmp_lt_u32 s33, 98304
 s_cselect_b32 s33, s33, 0
 v_mfma_f32_16x16x32_bf16 v[88:91], a[156:159], v[200:203], v[88:91]
 ds_read_b128 v[168:171], v18 offset:4096
 v_mfma_f32_16x16x32_bf16 v[92:95], a[160:163], v[200:203], v[92:95]
 v_mfma_f32_16x16x32_bf16 v[96:99], a[164:167], v[200:203], v[96:99]
 v_mfma_f32_16x16x32_bf16 v[100:103], a[156:159], v[204:207], v[100:103]
 ds_read_b128 v[172:175], v18 offset:6144
 v_mfma_f32_16x16x32_bf16 v[104:107], a[160:163], v[204:207], v[104:107]
 v_mfma_f32_16x16x32_bf16 v[108:111], a[164:167], v[204:207], v[108:111]
 s_waitcnt lgkmcnt(4)
 v_mfma_f32_16x16x32_bf16 v[112:115], a[156:159], v[208:211], v[112:115]
 ds_read_b128 v[176:179], v18 offset:8192
 v_mfma_f32_16x16x32_bf16 v[116:119], a[160:163], v[208:211], v[116:119]
 v_mfma_f32_16x16x32_bf16 v[120:123], a[164:167], v[208:211], v[120:123]
 v_mfma_f32_16x16x32_bf16 v[124:127], a[156:159], v[212:215], v[124:127]
 ds_read_b128 v[180:183], v18 offset:10240
 v_mfma_f32_16x16x32_bf16 v[128:131], a[160:163], v[212:215], v[128:131]
 buffer_load_dwordx4 v11, s[8:11], s30 offen offset:1024 lds
 v_mfma_f32_16x16x32_bf16 v[132:135], a[164:167], v[212:215], v[132:135]
 v_mfma_f32_16x16x32_bf16 v[136:139], a[156:159], v[216:219], v[136:139]
 ds_read_b128 v[184:187], v18 offset:12288
 v_mfma_f32_16x16x32_bf16 v[140:143], a[160:163], v[216:219], v[140:143]
 v_mfma_f32_16x16x32_bf16 v[144:147], a[164:167], v[216:219], v[144:147]
 v_mfma_f32_16x16x32_bf16 v[148:151], a[156:159], v[220:223], v[148:151]
 ds_read_b128 v[188:191], v18 offset:14336
 v_mfma_f32_16x16x32_bf16 v[152:155], a[160:163], v[220:223], v[152:155]
 v_mfma_f32_16x16x32_bf16 v[156:159], a[164:167], v[220:223], v[156:159]
 s_waitcnt lgkmcnt(4)
 v_mfma_f32_16x16x32_bf16 v[64:67], a[168:171], v[160:163], v[64:67]
 ds_read_b128 v[192:195], v19 offset:0
 v_mfma_f32_16x16x32_bf16 v[68:71], a[172:175], v[160:163], v[68:71]
 v_add_u32 v18, s33, v14
 s_mov_b32 s61, s60
 v_mfma_f32_16x16x32_bf16 v[72:75], a[176:179], v[160:163], v[72:75]
 s_add_u32 s60, s60, s62
 s_mul_i32 s48, s20, 393216
 v_mfma_f32_16x16x32_bf16 v[76:79], a[168:171], v[164:167], v[76:79]
 ds_read_b128 v[196:199], v19 offset:2048
 s_add_u32 s48, s48, s27
 v_mfma_f32_16x16x32_bf16 v[80:83], a[172:175], v[164:167], v[80:83]
 buffer_load_dwordx4 v12, s[8:11], s30 offen offset:2048 lds
 v_mfma_f32_16x16x32_bf16 v[84:87], a[176:179], v[164:167], v[84:87]
 s_add_u32 s27, s27, s28
 s_sub_u32 s26, s26, 1
 v_mfma_f32_16x16x32_bf16 v[88:91], a[168:171], v[168:171], v[88:91]
 ds_read_b128 v[200:203], v19 offset:4096
 v_mfma_f32_16x16x32_bf16 v[92:95], a[172:175], v[168:171], v[92:95]
 v_mfma_f32_16x16x32_bf16 v[96:99], a[176:179], v[168:171], v[96:99]
 v_mfma_f32_16x16x32_bf16 v[100:103], a[168:171], v[172:175], v[100:103]
 ds_read_b128 v[204:207], v19 offset:6144
 v_mfma_f32_16x16x32_bf16 v[104:107], a[172:175], v[172:175], v[104:107]
 v_mfma_f32_16x16x32_bf16 v[108:111], a[176:179], v[172:175], v[108:111]
 s_waitcnt lgkmcnt(4)
 v_mfma_f32_16x16x32_bf16 v[112:115], a[168:171], v[176:179], v[112:115]
 ds_read_b128 v[208:211], v19 offset:8192
 v_mfma_f32_16x16x32_bf16 v[116:119], a[172:175], v[176:179], v[116:119]
 v_mfma_f32_16x16x32_bf16 v[120:123], a[176:179], v[176:179], v[120:123]
 v_mfma_f32_16x16x32_bf16 v[124:127], a[168:171], v[180:183], v[124:127]
 ds_read_b128 v[212:215], v19 offset:10240
 v_mfma_f32_16x16x32_bf16 v[128:131], a[172:175], v[180:183], v[128:131]
 buffer_load_dwordx4 v13, s[8:11], s30 offen offset:3072 lds
 v_mfma_f32_16x16x32_bf16 v[132:135], a[176:179], v[180:183], v[132:135]
 s_add_u32 s30, s30, 128
 s_add_u32 m0, m0, 16384
 v_mfma_f32_16x16x32_bf16 v[136:139], a[168:171], v[184:187], v[136:139]
 ds_read_b128 v[216:219], v19 offset:12288
 v_mfma_f32_16x16x32_bf16 v[140:143], a[172:175], v[184:187], v[140:143]
 s_cmp_lt_u32 m0, s46
 s_cselect_b32 m0, m0, s47
 v_mfma_f32_16x16x32_bf16 v[144:147], a[176:179], v[184:187], v[144:147]
 v_mfma_f32_16x16x32_bf16 v[148:151], a[168:171], v[188:191], v[148:151]
 ds_read_b128 v[220:223], v19 offset:14336
 v_mfma_f32_16x16x32_bf16 v[152:155], a[172:175], v[188:191], v[152:155]
 v_mfma_f32_16x16x32_bf16 v[156:159], a[176:179], v[188:191], v[156:159]
 s_waitcnt vmcnt(15) lgkmcnt(4)
 s_barrier
 v_mfma_f32_16x16x32_bf16 v[64:67], a[180:183], v[192:195], v[64:67]
 ds_read_b128 v[160:163], v18 offset:0
 v_mfma_f32_16x16x32_bf16 v[68:71], a[184:187], v[192:195], v[68:71]
 v_mfma_f32_16x16x32_bf16 v[72:75], a[188:191], v[192:195], v[72:75]
 v_add_u32 v19, s33, v15
 s_add_u32 s33, s33, 16384
 v_mfma_f32_16x16x32_bf16 v[76:79], a[180:183], v[196:199], v[76:79]
 ds_read_b128 v[164:167], v18 offset:2048
 v_mfma_f32_16x16x32_bf16 v[80:83], a[184:187], v[196:199], v[80:83]
 buffer_load_dwordx4 v10, s[8:11], s30 offen offset:0 lds
 v_mfma_f32_16x16x32_bf16 v[84:87], a[188:191], v[196:199], v[84:87]
 s_cmp_lt_u32 s33, 98304
 s_cselect_b32 s33, s33, 0
 v_mfma_f32_16x16x32_bf16 v[88:91], a[180:183], v[200:203], v[88:91]
 ds_read_b128 v[168:171], v18 offset:4096
 v_mfma_f32_16x16x32_bf16 v[92:95], a[184:187], v[200:203], v[92:95]
 v_mfma_f32_16x16x32_bf16 v[96:99], a[188:191], v[200:203], v[96:99]
 v_mfma_f32_16x16x32_bf16 v[100:103], a[180:183], v[204:207], v[100:103]
 ds_read_b128 v[172:175], v18 offset:6144
 v_mfma_f32_16x16x32_bf16 v[104:107], a[184:187], v[204:207], v[104:107]
 v_mfma_f32_16x16x32_bf16 v[108:111], a[188:191], v[204:207], v[108:111]
 s_waitcnt lgkmcnt(4)
 v_mfma_f32_16x16x32_bf16 v[112:115], a[180:183], v[208:211], v[112:115]
 ds_read_b128 v[176:179], v18 offset:8192
 v_mfma_f32_16x16x32_bf16 v[116:119], a[184:187], v[208:211], v[116:119]
 v_mfma_f32_16x16x32_bf16 v[120:123], a[188:191], v[208:211], v[120:123]
 v_mfma_f32_16x16x32_bf16 v[124:127], a[180:183], v[212:215], v[124:127]
 ds_read_b128 v[180:183], v18 offset:10240
 v_mfma_f32_16x16x32_bf16 v[128:131], a[184:187], v[212:215], v[128:131]
 buffer_load_dwordx4 v11, s[8:11], s30 offen offset:1024 lds
 v_mfma_f32_16x16x32_bf16 v[132:135], a[188:191], v[212:215], v[132:135]
 v_mfma_f32_16x16x32_bf16 v[136:139], a[180:183], v[216:219], v[136:139]
 ds_read_b128 v[184:187], v18 offset:12288
 v_mfma_f32_16x16x32_bf16 v[140:143], a[184:187], v[216:219], v[140:143]
 v_mfma_f32_16x16x32_bf16 v[144:147], a[188:191], v[216:219], v[144:147]
 v_mfma_f32_16x16x32_bf16 v[148:151], a[180:183], v[220:223], v[148:151]
 ds_read_b128 v[188:191], v18 offset:14336
 v_mfma_f32_16x16x32_bf16 v[152:155], a[184:187], v[220:223], v[152:155]
 v_mfma_f32_16x16x32_bf16 v[156:159], a[188:191], v[220:223], v[156:159]
 s_waitcnt lgkmcnt(4)
 v_mfma_f32_16x16x32_bf16 v[64:67], a[192:195], v[160:163], v[64:67]
 ds_read_b128 v[192:195], v19 offset:0
 v_mfma_f32_16x16x32_bf16 v[68:71], a[196:199], v[160:163], v[68:71]
 v_add_u32 v18, s33, v14
 v_mfma_f32_16x16x32_bf16 v[72:75], a[200:203], v[160:163], v[72:75]
 v_mfma_f32_16x16x32_bf16 v[76:79], a[192:195], v[164:167], v[76:79]
 ds_read_b128 v[196:199], v19 offset:2048
 v_mfma_f32_16x16x32_bf16 v[80:83], a[196:199], v[164:167], v[80:83]
 buffer_load_dwordx4 v12, s[8:11], s30 offen offset:2048 lds
 v_mfma_f32_16x16x32_bf16 v[84:87], a[200:203], v[164:167], v[84:87]
 v_mfma_f32_16x16x32_bf16 v[88:91], a[192:195], v[168:171], v[88:91]
 ds_read_b128 v[200:203], v19 offset:4096
 v_mfma_f32_16x16x32_bf16 v[92:95], a[196:199], v[168:171], v[92:95]
 v_mfma_f32_16x16x32_bf16 v[96:99], a[200:203], v[168:171], v[96:99]
 v_mfma_f32_16x16x32_bf16 v[100:103], a[192:195], v[172:175], v[100:103]
 ds_read_b128 v[204:207], v19 offset:6144
 v_mfma_f32_16x16x32_bf16 v[104:107], a[196:199], v[172:175], v[104:107]
 v_mfma_f32_16x16x32_bf16 v[108:111], a[200:203], v[172:175], v[108:111]
 s_waitcnt lgkmcnt(4)
 v_mfma_f32_16x16x32_bf16 v[112:115], a[192:195], v[176:179], v[112:115]
 ds_read_b128 v[208:211], v19 offset:8192
 v_mfma_f32_16x16x32_bf16 v[116:119], a[196:199], v[176:179], v[116:119]
 v_mfma_f32_16x16x32_bf16 v[120:123], a[200:203], v[176:179], v[120:123]
 v_mfma_f32_16x16x32_bf16 v[124:127], a[192:195], v[180:183], v[124:127]
 ds_read_b128 v[212:215], v19 offset:10240
 v_mfma_f32_16x16x32_bf16 v[128:131], a[196:199], v[180:183], v[128:131]
 buffer_load_dwordx4 v13, s[8:11], s30 offen offset:3072 lds
 v_mfma_f32_16x16x32_bf16 v[132:135], a[200:203], v[180:183], v[132:135]
 s_add_u32 s30, s30, 128
 s_add_u32 m0, m0, 16384
 v_mfma_f32_16x16x32_bf16 v[136:139], a[192:195], v[184:187], v[136:139]
 ds_read_b128 v[216:219], v19 offset:12288
 v_mfma_f32_16x16x32_bf16 v[140:143], a[196:199], v[184:187], v[140:143]
 s_cmp_lt_u32 m0, s46
 s_cselect_b32 m0, m0, s47
 v_mfma_f32_16x16x32_bf16 v[144:147], a[200:203], v[184:187], v[144:147]
 v_mfma_f32_16x16x32_bf16 v[148:151], a[192:195], v[188:191], v[148:151]
 ds_read_b128 v[220:223], v19 offset:14336
 v_mfma_f32_16x16x32_bf16 v[152:155], a[196:199], v[188:191], v[152:155]
 v_mfma_f32_16x16x32_bf16 v[156:159], a[200:203], v[188:191], v[156:159]
 s_waitcnt vmcnt(12) lgkmcnt(4)
 s_barrier
 v_mfma_f32_16x16x32_bf16 v[64:67], a[204:207], v[192:195], v[64:67]
 ds_read_b128 v[160:163], v18 offset:0
 v_mfma_f32_16x16x32_bf16 v[68:71], a[208:211], v[192:195], v[68:71]
 v_mfma_f32_16x16x32_bf16 v[72:75], a[212:215], v[192:195], v[72:75]
 v_add_u32 v19, s33, v15
 s_add_u32 s33, s33, 16384
 v_mfma_f32_16x16x32_bf16 v[76:79], a[204:207], v[196:199], v[76:79]
 ds_read_b128 v[164:167], v18 offset:2048
 v_mfma_f32_16x16x32_bf16 v[80:83], a[208:211], v[196:199], v[80:83]
 buffer_load_dwordx4 v10, s[8:11], s30 offen offset:0 lds
 v_mfma_f32_16x16x32_bf16 v[84:87], a[212:215], v[196:199], v[84:87]
 s_cmp_lt_u32 s33, 98304
 s_cselect_b32 s33, s33, 0
 v_mfma_f32_16x16x32_bf16 v[88:91], a[204:207], v[200:203], v[88:91]
 ds_read_b128 v[168:171], v18 offset:4096
 v_mfma_f32_16x16x32_bf16 v[92:95], a[208:211], v[200:203], v[92:95]
 v_mfma_f32_16x16x32_bf16 v[96:99], a[212:215], v[200:203], v[96:99]
 v_mfma_f32_16x16x32_bf16 v[100:103], a[204:207], v[204:207], v[100:103]
 ds_read_b128 v[172:175], v18 offset:6144
 v_mfma_f32_16x16x32_bf16 v[104:107], a[208:211], v[204:207], v[104:107]
 v_mfma_f32_16x16x32_bf16 v[108:111], a[212:215], v[204:207], v[108:111]
 s_waitcnt lgkmcnt(4)
 v_mfma_f32_16x16x32_bf16 v[112:115], a[204:207], v[208:211], v[112:115]
 ds_read_b128 v[176:179], v18 offset:8192
 v_mfma_f32_16x16x32_bf16 v[116:119], a[208:211], v[208:211], v[116:119]
 v_mfma_f32_16x16x32_bf16 v[120:123], a[212:215], v[208:211], v[120:123]
 v_mfma_f32_16x16x32_bf16 v[124:127], a[204:207], v[212:215], v[124:127]
 ds_read_b128 v[180:183], v18 offset:10240
 v_mfma_f32_16x16x32_bf16 v[128:131], a[208:211], v[212:215], v[128:131]
 buffer_load_dwordx4 v11, s[8:11], s30 offen offset:1024 lds
 v_mfma_f32_16x16x32_bf16 v[132:135], a[212:215], v[212:215], v[132:135]
 v_mfma_f32_16x16x32_bf16 v[136:139], a[204:207], v[216:219], v[136:139]
 ds_read_b128 v[184:187], v18 offset:12288
 v_mfma_f32_16x16x32_bf16 v[140:143], a[208:211], v[216:219], v[140:143]
 v_mfma_f32_16x16x32_bf16 v[144:147], a[212:215], v[216:219], v[144:147]
 v_mfma_f32_16x16x32_bf16 v[148:151], a[204:207], v[220:223], v[148:151]
 ds_read_b128 v[188:191], v18 offset:14336
 v_mfma_f32_16x16x32_bf16 v[152:155], a[208:211], v[220:223], v[152:155]
 v_mfma_f32_16x16x32_bf16 v[156:159], a[212:215], v[220:223], v[156:159]
 s_waitcnt lgkmcnt(4)
 v_mfma_f32_16x16x32_bf16 v[64:67], a[216:219], v[160:163], v[64:67]
 ds_read_b128 v[192:195], v19 offset:0
 v_mfma_f32_16x16x32_bf16 v[68:71], a[220:223], v[160:163], v[68:71]
 v_add_u32 v18, s33, v14
 v_mfma_f32_16x16x32_bf16 v[72:75], a[224:227], v[160:163], v[72:75]
 v_mfma_f32_16x16x32_bf16 v[76:79], a[216:219], v[164:167], v[76:79]
 ds_read_b128 v[196:199], v19 offset:2048
 v_mfma_f32_16x16x32_bf16 v[80:83], a[220:223], v[164:167], v[80:83]
 buffer_load_dwordx4 v12, s[8:11], s30 offen offset:2048 lds
 v_mfma_f32_16x16x32_bf16 v[84:87], a[224:227], v[164:167], v[84:87]
 v_mfma_f32_16x16x32_bf16 v[88:91], a[216:219], v[168:171], v[88:91]
 ds_read_b128 v[200:203], v19 offset:4096
 v_mfma_f32_16x16x32_bf16 v[92:95], a[220:223], v[168:171], v[92:95]
 v_mfma_f32_16x16x32_bf16 v[96:99], a[224:227], v[168:171], v[96:99]
 v_mfma_f32_16x16x32_bf16 v[100:103], a[216:219], v[172:175], v[100:103]
 ds_read_b128 v[204:207], v19 offset:6144
 v_mfma_f32_16x16x32_bf16 v[104:107], a[220:223], v[172:175], v[104:107]
 v_mfma_f32_16x16x32_bf16 v[108:111], a[224:227], v[172:175], v[108:111]
 s_waitcnt lgkmcnt(4)
 v_mfma_f32_16x16x32_bf16 v[112:115], a[216:219], v[176:179], v[112:115]
 ds_read_b128 v[208:211], v19 offset:8192
 v_mfma_f32_16x16x32_bf16 v[116:119], a[220:223], v[176:179], v[116:119]
 v_mfma_f32_16x16x32_bf16 v[120:123], a[224:227], v[176:179], v[120:123]
 v_mfma_f32_16x16x32_bf16 v[124:127], a[216:219], v[180:183], v[124:127]
 ds_read_b128 v[212:215], v19 offset:10240
 v_mfma_f32_16x16x32_bf16 v[128:131], a[220:223], v[180:183], v[128:131]
 buffer_load_dwordx4 v13, s[8:11], s30 offen offset:3072 lds
 v_mfma_f32_16x16x32_bf16 v[132:135], a[224:227], v[180:183], v[132:135]
 s_add_u32 s30, s30, 128
 s_add_u32 m0, m0, 16384
 v_mfma_f32_16x16x32_bf16 v[136:139], a[216:219], v[184:187], v[136:139]
 ds_read_b128 v[216:219], v19 offset:12288
 v_mfma_f32_16x16x32_bf16 v[140:143], a[220:223], v[184:187], v[140:143]
 s_cmp_lt_u32 m0, s46
 s_cselect_b32 m0, m0, s47
 v_mfma_f32_16x16x32_bf16 v[144:147], a[224:227], v[184:187], v[144:147]
 v_mfma_f32_16x16x32_bf16 v[148:151], a[216:219], v[188:191], v[148:151]
 ds_read_b128 v[220:223], v19 offset:14336
 v_mfma_f32_16x16x32_bf16 v[152:155], a[220:223], v[188:191], v[152:155]
 v_mfma_f32_16x16x32_bf16 v[156:159], a[224:227], v[188:191], v[156:159]
 s_waitcnt vmcnt(12) lgkmcnt(4)
 s_barrier
 v_mfma_f32_16x16x32_bf16 v[64:67], a[228:231], v[192:195], v[64:67]
 ds_read_b128 v[160:163], v18 offset:0
 v_mfma_f32_16x16x32_bf16 v[68:71], a[232:235], v[192:195], v[68:71]
 v_mfma_f32_16x16x32_bf16 v[72:75], a[236:239], v[192:195], v[72:75]
 v_add_u32 v19, s33, v15
 s_add_u32 s33, s33, 16384
 v_mfma_f32_16x16x32_bf16 v[76:79], a[228:231], v[196:199], v[76:79]
 ds_read_b128 v[164:167], v18 offset:2048
 v_cvt_pk_bf16_f32 v224, v64, v65
 v_mfma_f32_16x16x32_bf16 v[80:83], a[232:235], v[196:199], v[80:83]
 buffer_load_dwordx4 v10, s[8:11], s30 offen offset:0 lds
 v_mfma_f32_16x16x32_bf16 v[84:87], a[236:239], v[196:199], v[84:87]
 s_cmp_lt_u32 s33, 98304
 s_cselect_b32 s33, s33, 0
 v_mfma_f32_16x16x32_bf16 v[88:91], a[228:231], v[200:203], v[88:91]
 ds_read_b128 v[168:171], v18 offset:4096
 v_cvt_pk_bf16_f32 v225, v66, v67
 v_mfma_f32_16x16x32_bf16 v[92:95], a[232:235], v[200:203], v[92:95]
 v_cvt_pk_bf16_f32 v226, v68, v69
 v_cvt_pk_bf16_f32 v227, v70, v71
 v_mfma_f32_16x16x32_bf16 v[96:99], a[236:239], v[200:203], v[96:99]
 v_cvt_pk_bf16_f32 v228, v72, v73
 v_cvt_pk_bf16_f32 v229, v74, v75
 v_mfma_f32_16x16x32_bf16 v[100:103], a[228:231], v[204:207], v[100:103]
 ds_read_b128 v[172:175], v18 offset:6144
 v_mfma_f32_16x16x32_bf16 v[104:107], a[232:235], v[204:207], v[104:107]
 ds_write_b64 v22, v[224:225] offset:0
 v_mfma_f32_16x16x32_bf16 v[108:111], a[236:239], v[204:207], v[108:111]
 s_waitcnt lgkmcnt(5)
 v_mfma_f32_16x16x32_bf16 v[112:115], a[228:231], v[208:211], v[112:115]
 ds_read_b128 v[176:179], v18 offset:8192
 v_mfma_f32_16x16x32_bf16 v[116:119], a[232:235], v[208:211], v[116:119]
 ds_write_b64 v22, v[226:227] offset:8
 v_mfma_f32_16x16x32_bf16 v[120:123], a[236:239], v[208:211], v[120:123]
 ds_write_b64 v16, v[228:229] offset:64
 v_mfma_f32_16x16x32_bf16 v[124:127], a[228:231], v[212:215], v[124:127]
 ds_read_b128 v[180:183], v18 offset:10240
 v_cvt_pk_bf16_f32 v230, v76, v77
 v_mfma_f32_16x16x32_bf16 v[128:131], a[232:235], v[212:215], v[128:131]
 buffer_load_dwordx4 v11, s[8:11], s30 offen offset:1024 lds
 v_mfma_f32_16x16x32_bf16 v[132:135], a[236:239], v[212:215], v[132:135]
 v_cvt_pk_bf16_f32 v231, v78, v79
 v_cvt_pk_bf16_f32 v232, v80, v81
 v_mfma_f32_16x16x32_bf16 v[136:139], a[228:231], v[216:219], v[136:139]
 ds_read_b128 v[184:187], v18 offset:12288
 v_cvt_pk_bf16_f32 v233, v82, v83
 v_mfma_f32_16x16x32_bf16 v[140:143], a[232:235], v[216:219], v[140:143]
 v_cvt_pk_bf16_f32 v234, v84, v85
 v_cvt_pk_bf16_f32 v235, v86, v87
 v_mfma_f32_16x16x32_bf16 v[144:147], a[236:239], v[216:219], v[144:147]
 ds_write_b64 v22, v[230:231] offset:6400
 v_mfma_f32_16x16x32_bf16 v[148:151], a[228:231], v[220:223], v[148:151]
 ds_read_b128 v[188:191], v18 offset:14336
 v_mfma_f32_16x16x32_bf16 v[152:155], a[232:235], v[220:223], v[152:155]
 ds_write_b64 v22, v[232:233] offset:6408
 v_mfma_f32_16x16x32_bf16 v[156:159], a[236:239], v[220:223], v[156:159]
 s_waitcnt lgkmcnt(9)
kv_end_136:
 s_cmp_gt_u32 s26, 0
 s_cbranch_scc1 kv_blk_135
 s_nop 7
 ds_write_b64 v16, v[234:235] offset:6464
 v_cvt_pk_bf16_f32 v236, v88, v89
 v_cvt_pk_bf16_f32 v237, v90, v91
 v_cvt_pk_bf16_f32 v238, v92, v93
 v_cvt_pk_bf16_f32 v239, v94, v95
 v_cvt_pk_bf16_f32 v240, v96, v97
 v_cvt_pk_bf16_f32 v241, v98, v99
 ds_write_b64 v22, v[236:237] offset:12800
 ds_write_b64 v22, v[238:239] offset:12808
 ds_write_b64 v16, v[240:241] offset:12864
 v_cvt_pk_bf16_f32 v242, v100, v101
 v_cvt_pk_bf16_f32 v243, v102, v103
 v_cvt_pk_bf16_f32 v244, v104, v105
 v_cvt_pk_bf16_f32 v245, v106, v107
 v_cvt_pk_bf16_f32 v246, v108, v109
 v_cvt_pk_bf16_f32 v247, v110, v111
 ds_write_b64 v22, v[242:243] offset:19200
 ds_write_b64 v22, v[244:245] offset:19208
 ds_write_b64 v16, v[246:247] offset:19264
 v_cvt_pk_bf16_f32 v224, v112, v113
 v_cvt_pk_bf16_f32 v225, v114, v115
 v_cvt_pk_bf16_f32 v226, v116, v117
 v_cvt_pk_bf16_f32 v227, v118, v119
 v_cvt_pk_bf16_f32 v228, v120, v121
 v_cvt_pk_bf16_f32 v229, v122, v123
 ds_write_b64 v22, v[224:225] offset:25600
 ds_write_b64 v22, v[226:227] offset:25608
 ds_write_b64 v16, v[228:229] offset:25664
 v_cvt_pk_bf16_f32 v230, v124, v125
 v_cvt_pk_bf16_f32 v231, v126, v127
 v_cvt_pk_bf16_f32 v232, v128, v129
 v_cvt_pk_bf16_f32 v233, v130, v131
 v_cvt_pk_bf16_f32 v234, v132, v133
 v_cvt_pk_bf16_f32 v235, v134, v135
 ds_write_b64 v22, v[230:231] offset:32000
 ds_write_b64 v22, v[232:233] offset:32008
 ds_write_b64 v16, v[234:235] offset:32064
 v_cvt_pk_bf16_f32 v236, v136, v137
 v_cvt_pk_bf16_f32 v237, v138, v139
 v_cvt_pk_bf16_f32 v238, v140, v141
 v_cvt_pk_bf16_f32 v239, v142, v143
 v_cvt_pk_bf16_f32 v240, v144, v145
 v_cvt_pk_bf16_f32 v241, v146, v147
 ds_write_b64 v22, v[236:237] offset:38400
 ds_write_b64 v22, v[238:239] offset:38408
 ds_write_b64 v16, v[240:241] offset:38464
 v_cvt_pk_bf16_f32 v242, v148, v149
 v_cvt_pk_bf16_f32 v243, v150, v151
 v_cvt_pk_bf16_f32 v244, v152, v153
 v_cvt_pk_bf16_f32 v245, v154, v155
 v_cvt_pk_bf16_f32 v246, v156, v157
 v_cvt_pk_bf16_f32 v247, v158, v159
 ds_write_b64 v22, v[242:243] offset:44800
 ds_write_b64 v22, v[244:245] offset:44808
 ds_write_b64 v16, v[246:247] offset:44864
 s_waitcnt vmcnt(0) lgkmcnt(0)
 s_barrier
 ds_read_b128 v[224:227], v23 offset:0
 ds_read_b128 v[228:231], v23 offset:64
 ds_read_b128 v[232:235], v23 offset:128
 ds_read_b128 v[236:239], v23 offset:192
 ds_read_b128 v[240:243], v23 offset:256
 ds_read_b128 v[244:247], v23 offset:320
 s_waitcnt lgkmcnt(0)
 s_add_u32 s21, s48, 0
 buffer_store_dwordx4 v[224:227], v26, s[16:19], s21 offen offset:0 sc1
 buffer_store_dwordx4 v[228:231], v26, s[16:19], s21 offen offset:1024 sc1
 buffer_store_dwordx4 v[232:235], v26, s[16:19], s21 offen offset:2048 sc1
 buffer_store_dwordx4 v[236:239], v26, s[16:19], s21 offen offset:3072 sc1
 s_add_u32 s21, s48, 4096
 buffer_store_dwordx4 v[240:243], v26, s[16:19], s21 offen offset:0 sc1
 buffer_store_dwordx4 v[244:247], v26, s[16:19], s21 offen offset:1024 sc1
 s_nop 1
 ds_read_b128 v[224:227], v23 offset:6400
 ds_read_b128 v[228:231], v23 offset:6464
 ds_read_b128 v[232:235], v23 offset:6528
 ds_read_b128 v[236:239], v23 offset:6592
 ds_read_b128 v[240:243], v23 offset:6656
 ds_read_b128 v[244:247], v23 offset:6720
 s_waitcnt lgkmcnt(0)
 buffer_store_dwordx4 v[224:227], v26, s[16:19], s21 offen offset:2048 sc1
 buffer_store_dwordx4 v[228:231], v26, s[16:19], s21 offen offset:3072 sc1
 s_add_u32 s21, s48, 8192
 buffer_store_dwordx4 v[232:235], v26, s[16:19], s21 offen offset:0 sc1
 buffer_store_dwordx4 v[236:239], v26, s[16:19], s21 offen offset:1024 sc1
 buffer_store_dwordx4 v[240:243], v26, s[16:19], s21 offen offset:2048 sc1
 buffer_store_dwordx4 v[244:247], v26, s[16:19], s21 offen offset:3072 sc1
 s_nop 1
 s_waitcnt vmcnt(0)
 s_barrier
 s_cmp_lg_u32 s20, 0
 s_cbranch_scc1 af_137
 v_mov_b32 v4, 0
 v_mov_b32 v5, 1
 s_mov_b64 exec, 1
 buffer_atomic_add v5, v4, s[72:75], s61 offen sc1
 s_mov_b64 exec, -1
 s_nop 1
af_137:
 s_cmp_lg_u32 s43, 0
 s_cbranch_scc1 kv_fin
 s_lshr_b32 s2, s3, 1
 s_branch q_entry
kv_fin:
 s_branch queue
not_kv:
 s_cmp_ge_u32 s3, 96
 s_cbranch_scc1 not_vw
 s_sub_u32 s2, s3, 64
 s_load_dwordx2 s[72:73], s[0:1], 104
 s_waitcnt lgkmcnt(0)
 s_add_u32 s72, s72, 81068032
 s_addc_u32 s73, s73, 0
 s_mov_b32 s74, 129024
 s_mov_b32 s75, 0x00020000
 s_add_u32 s8, s38, 78643200
 s_addc_u32 s9, s39, 0
 s_mov_b32 s10, 2162688
 s_mov_b32 s11, 0x00020000
 s_add_u32 s12, s38, 50331648
 s_addc_u32 s13, s39, 0
 s_mov_b32 s14, 12582912
 s_mov_b32 s15, 0x00020000
 s_add_u32 s16, s38, 83886079
 s_addc_u32 s17, s39, 0
 s_and_b32 s16, s16, 0xffe00000
 s_or_b32 s16, s16, 262144
 s_mov_b32 s18, 131072
 s_mov_b32 s19, 0x00020000
 v_lshlrev_b32 v8, 4, v0
 v_lshlrev_b32 v9, 4, v1
 v_mov_b32 v4, 0
 v_mov_b32 v12, -1
 v_mov_b32 v5, 0
 v_mov_b32 v13, -1
 v_mov_b32 v6, 0
 v_mov_b32 v14, -1
 v_mov_b32 v7, 0
 v_mov_b32 v15, -1
 s_lshl_b32 s21, s2, 12
 buffer_store_dwordx4 v[4:7], v8, s[72:75], s21 offen sc1
 s_lshr_b32 s21, s2, 3
 s_lshl_b32 s21, s21, 15
 s_bfe_u32 s22, s2, 0x10002
 s_lshl_b32 s22, s22, 13
 s_add_u32 s21, s21, s22
 s_bfe_u32 s22, s2, 0x10001
 s_lshl_b32 s22, s22, 14
 s_add_u32 s21, s21, s22
 s_and_b32 s22, s2, 1
 s_mul_i32 s22, s22, 3
 s_add_u32 s22, s22, s20
 s_lshl_b32 s22, s22, 10
 s_add_u32 s21, s21, s22
 s_cmp_lt_u32 s20, 3
 s_cselect_b32 s21, s21, 0x80000000
 buffer_store_dwordx4 v[4:7], v9, s[16:19], s21 offen sc1
 s_mul_i32 s23, s20, 540672
 s_lshl_b32 s21, s2, 11
 s_add_u32 s21, s21, s23
 s_add_u32 s21, s21, 81920
 buffer_store_dwordx4 v[12:15], v9, s[8:11], s21 offen sc1
 buffer_store_dwordx4 v[12:15], v9, s[8:11], s21 offen offset:1024 sc1
 s_lshl_b32 s21, s2, 9
 s_add_u32 s21, s21, s23
 s_add_u32 s21, s21, 376832
 s_mov_b64 exec, 0xffffffff
 buffer_store_dwordx4 v[12:15], v9, s[8:11], s21 offen sc1
 s_mov_b64 exec, -1
 s_nop 1
 s_load_dwordx2 s[4:5], s[0:1], 0
 s_load_dwordx2 s[6:7], s[0:1], 80
 s_load_dwordx2 s[38:39], s[0:1], 104
 s_lshl_b32 s59, s2, 2
 s_add_u32 s59, s59, s20
 s_lshl_b32 s59, s59, 4
 s_waitcnt lgkmcnt(0)
 s_mov_b32 s8, s4
 s_mov_b32 s9, s5
 s_mov_b32 s10, 2621440
 s_mov_b32 s11, 0x00020000
 s_mov_b32 s12, s6
 s_mov_b32 s13, s7
 s_mov_b32 s14, 1280
 s_mov_b32 s15, 0x00020000
 s_add_u32 s28, s38, 81002496
 s_addc_u32 s29, s39, 0
 s_mov_b32 s30, 8192
 s_mov_b32 s31, 0x00020000
 v_lshlrev_b32 v4, 2, v1
 v_lshlrev_b32 v5, 4, v1
 buffer_load_dwordx4 v[16:19], v5, s[12:15], 0 offen
 buffer_load_dword v20, v4, s[12:15], 0 offen offset:1024
 s_mul_i32 s22, s59, 1280
 buffer_load_dwordx4 v[64:67], v5, s[8:11], s22 offen
 buffer_load_dword v68, v4, s[8:11], s22 offen offset:1024
 s_add_u32 s22, s22, 1280
 buffer_load_dwordx4 v[70:73], v5, s[8:11], s22 offen
 buffer_load_dword v74, v4, s[8:11], s22 offen offset:1024
 s_add_u32 s22, s22, 1280
 buffer_load_dwordx4 v[76:79], v5, s[8:11], s22 offen
 buffer_load_dword v80, v4, s[8:11], s22 offen offset:1024
 s_add_u32 s22, s22, 1280
 buffer_load_dwordx4 v[82:85], v5, s[8:11], s22 offen
 buffer_load_dword v86, v4, s[8:11], s22 offen offset:1024
 s_add_u32 s22, s22, 1280
 buffer_load_dwordx4 v[88:91], v5, s[8:11], s22 offen
 buffer_load_dword v92, v4, s[8:11], s22 offen offset:1024
 s_add_u32 s22, s22, 1280
 buffer_load_dwordx4 v[94:97], v5, s[8:11], s22 offen
 buffer_load_dword v98, v4, s[8:11], s22 offen offset:1024
 s_add_u32 s22, s22, 1280
 buffer_load_dwordx4 v[100:103], v5, s[8:11], s22 offen
 buffer_load_dword v104, v4, s[8:11], s22 offen offset:1024
 s_add_u32 s22, s22, 1280
 buffer_load_dwordx4 v[106:109], v5, s[8:11], s22 offen
 buffer_load_dword v110, v4, s[8:11], s22 offen offset:1024
 s_add_u32 s22, s22, 1280
 buffer_load_dwordx4 v[112:115], v5, s[8:11], s22 offen
 buffer_load_dword v116, v4, s[8:11], s22 offen offset:1024
 s_add_u32 s22, s22, 1280
 buffer_load_dwordx4 v[118:121], v5, s[8:11], s22 offen
 buffer_load_dword v122, v4, s[8:11], s22 offen offset:1024
 s_add_u32 s22, s22, 1280
 buffer_load_dwordx4 v[124:127], v5, s[8:11], s22 offen
 buffer_load_dword v128, v4, s[8:11], s22 offen offset:1024
 s_add_u32 s22, s22, 1280
 buffer_load_dwordx4 v[130:133], v5, s[8:11], s22 offen
 buffer_load_dword v134, v4, s[8:11], s22 offen offset:1024
 s_add_u32 s22, s22, 1280
 buffer_load_dwordx4 v[136:139], v5, s[8:11], s22 offen
 buffer_load_dword v140, v4, s[8:11], s22 offen offset:1024
 s_add_u32 s22, s22, 1280
 buffer_load_dwordx4 v[142:145], v5, s[8:11], s22 offen
 buffer_load_dword v146, v4, s[8:11], s22 offen offset:1024
 s_add_u32 s22, s22, 1280
 buffer_load_dwordx4 v[148:151], v5, s[8:11], s22 offen
 buffer_load_dword v152, v4, s[8:11], s22 offen offset:1024
 s_add_u32 s22, s22, 1280
 buffer_load_dwordx4 v[154:157], v5, s[8:11], s22 offen
 buffer_load_dword v158, v4, s[8:11], s22 offen offset:1024
 s_add_u32 s22, s22, 1280
 s_waitcnt vmcnt(32)
 v_lshlrev_b32 v8, 16, v16
 v_and_b32 v16, 0xffff0000, v16
 v_lshlrev_b32 v9, 16, v17
 v_and_b32 v17, 0xffff0000, v17
 v_lshlrev_b32 v10, 16, v18
 v_and_b32 v18, 0xffff0000, v18
 v_lshlrev_b32 v11, 16, v19
 v_and_b32 v19, 0xffff0000, v19
 v_lshlrev_b32 v12, 16, v20
 v_and_b32 v20, 0xffff0000, v20
 s_waitcnt vmcnt(30)
 v_mov_b32 v160, 0
 v_lshlrev_b32 v25, 16, v64
 v_and_b32 v26, 0xffff0000, v64
 v_mul_f32 v25, v25, v8
 v_mul_f32 v26, v26, v16
 v_cvt_pk_bf16_f32 v25, v25, v26
 v_lshlrev_b32 v26, 16, v25
 v_and_b32 v25, 0xffff0000, v25
 v_add_f32 v160, v160, v26
 v_add_f32 v160, v160, v25
 v_lshlrev_b32 v25, 16, v65
 v_and_b32 v26, 0xffff0000, v65
 v_mul_f32 v25, v25, v9
 v_mul_f32 v26, v26, v17
 v_cvt_pk_bf16_f32 v25, v25, v26
 v_lshlrev_b32 v26, 16, v25
 v_and_b32 v25, 0xffff0000, v25
 v_add_f32 v160, v160, v26
 v_add_f32 v160, v160, v25
 v_lshlrev_b32 v25, 16, v66
 v_and_b32 v26, 0xffff0000, v66
 v_mul_f32 v25, v25, v10
 v_mul_f32 v26, v26, v18
 v_cvt_pk_bf16_f32 v25, v25, v26
 v_lshlrev_b32 v26, 16, v25
 v_and_b32 v25, 0xffff0000, v25
 v_add_f32 v160, v160, v26
 v_add_f32 v160, v160, v25
 v_lshlrev_b32 v25, 16, v67
 v_and_b32 v26, 0xffff0000, v67
 v_mul_f32 v25, v25, v11
 v_mul_f32 v26, v26, v19
 v_cvt_pk_bf16_f32 v25, v25, v26
 v_lshlrev_b32 v26, 16, v25
 v_and_b32 v25, 0xffff0000, v25
 v_add_f32 v160, v160, v26
 v_add_f32 v160, v160, v25
 v_lshlrev_b32 v25, 16, v68
 v_and_b32 v26, 0xffff0000, v68
 v_mul_f32 v25, v25, v12
 v_mul_f32 v26, v26, v20
 v_cvt_pk_bf16_f32 v25, v25, v26
 v_lshlrev_b32 v26, 16, v25
 v_and_b32 v25, 0xffff0000, v25
 v_add_f32 v160, v160, v26
 v_add_f32 v160, v160, v25
 s_waitcnt vmcnt(28)
 v_mov_b32 v161, 0
 v_lshlrev_b32 v25, 16, v70
 v_and_b32 v26, 0xffff0000, v70
 v_mul_f32 v25, v25, v8
 v_mul_f32 v26, v26, v16
 v_cvt_pk_bf16_f32 v25, v25, v26
 v_lshlrev_b32 v26, 16, v25
 v_and_b32 v25, 0xffff0000, v25
 v_add_f32 v161, v161, v26
 v_add_f32 v161, v161, v25
 v_lshlrev_b32 v25, 16, v71
 v_and_b32 v26, 0xffff0000, v71
 v_mul_f32 v25, v25, v9
 v_mul_f32 v26, v26, v17
 v_cvt_pk_bf16_f32 v25, v25, v26
 v_lshlrev_b32 v26, 16, v25
 v_and_b32 v25, 0xffff0000, v25
 v_add_f32 v161, v161, v26
 v_add_f32 v161, v161, v25
 v_lshlrev_b32 v25, 16, v72
 v_and_b32 v26, 0xffff0000, v72
 v_mul_f32 v25, v25, v10
 v_mul_f32 v26, v26, v18
 v_cvt_pk_bf16_f32 v25, v25, v26
 v_lshlrev_b32 v26, 16, v25
 v_and_b32 v25, 0xffff0000, v25
 v_add_f32 v161, v161, v26
 v_add_f32 v161, v161, v25
 v_lshlrev_b32 v25, 16, v73
 v_and_b32 v26, 0xffff0000, v73
 v_mul_f32 v25, v25, v11
 v_mul_f32 v26, v26, v19
 v_cvt_pk_bf16_f32 v25, v25, v26
 v_lshlrev_b32 v26, 16, v25
 v_and_b32 v25, 0xffff0000, v25
 v_add_f32 v161, v161, v26
 v_add_f32 v161, v161, v25
 v_lshlrev_b32 v25, 16, v74
 v_and_b32 v26, 0xffff0000, v74
 v_mul_f32 v25, v25, v12
 v_mul_f32 v26, v26, v20
 v_cvt_pk_bf16_f32 v25, v25, v26
 v_lshlrev_b32 v26, 16, v25
 v_and_b32 v25, 0xffff0000, v25
 v_add_f32 v161, v161, v26
 v_add_f32 v161, v161, v25
 s_waitcnt vmcnt(26)
 v_mov_b32 v162, 0
 v_lshlrev_b32 v25, 16, v76
 v_and_b32 v26, 0xffff0000, v76
 v_mul_f32 v25, v25, v8
 v_mul_f32 v26, v26, v16
 v_cvt_pk_bf16_f32 v25, v25, v26
 v_lshlrev_b32 v26, 16, v25
 v_and_b32 v25, 0xffff0000, v25
 v_add_f32 v162, v162, v26
 v_add_f32 v162, v162, v25
 v_lshlrev_b32 v25, 16, v77
 v_and_b32 v26, 0xffff0000, v77
 v_mul_f32 v25, v25, v9
 v_mul_f32 v26, v26, v17
 v_cvt_pk_bf16_f32 v25, v25, v26
 v_lshlrev_b32 v26, 16, v25
 v_and_b32 v25, 0xffff0000, v25
 v_add_f32 v162, v162, v26
 v_add_f32 v162, v162, v25
 v_lshlrev_b32 v25, 16, v78
 v_and_b32 v26, 0xffff0000, v78
 v_mul_f32 v25, v25, v10
 v_mul_f32 v26, v26, v18
 v_cvt_pk_bf16_f32 v25, v25, v26
 v_lshlrev_b32 v26, 16, v25
 v_and_b32 v25, 0xffff0000, v25
 v_add_f32 v162, v162, v26
 v_add_f32 v162, v162, v25
 v_lshlrev_b32 v25, 16, v79
 v_and_b32 v26, 0xffff0000, v79
 v_mul_f32 v25, v25, v11
 v_mul_f32 v26, v26, v19
 v_cvt_pk_bf16_f32 v25, v25, v26
 v_lshlrev_b32 v26, 16, v25
 v_and_b32 v25, 0xffff0000, v25
 v_add_f32 v162, v162, v26
 v_add_f32 v162, v162, v25
 v_lshlrev_b32 v25, 16, v80
 v_and_b32 v26, 0xffff0000, v80
 v_mul_f32 v25, v25, v12
 v_mul_f32 v26, v26, v20
 v_cvt_pk_bf16_f32 v25, v25, v26
 v_lshlrev_b32 v26, 16, v25
 v_and_b32 v25, 0xffff0000, v25
 v_add_f32 v162, v162, v26
 v_add_f32 v162, v162, v25
 s_waitcnt vmcnt(24)
 v_mov_b32 v163, 0
 v_lshlrev_b32 v25, 16, v82
 v_and_b32 v26, 0xffff0000, v82
 v_mul_f32 v25, v25, v8
 v_mul_f32 v26, v26, v16
 v_cvt_pk_bf16_f32 v25, v25, v26
 v_lshlrev_b32 v26, 16, v25
 v_and_b32 v25, 0xffff0000, v25
 v_add_f32 v163, v163, v26
 v_add_f32 v163, v163, v25
 v_lshlrev_b32 v25, 16, v83
 v_and_b32 v26, 0xffff0000, v83
 v_mul_f32 v25, v25, v9
 v_mul_f32 v26, v26, v17
 v_cvt_pk_bf16_f32 v25, v25, v26
 v_lshlrev_b32 v26, 16, v25
 v_and_b32 v25, 0xffff0000, v25
 v_add_f32 v163, v163, v26
 v_add_f32 v163, v163, v25
 v_lshlrev_b32 v25, 16, v84
 v_and_b32 v26, 0xffff0000, v84
 v_mul_f32 v25, v25, v10
 v_mul_f32 v26, v26, v18
 v_cvt_pk_bf16_f32 v25, v25, v26
 v_lshlrev_b32 v26, 16, v25
 v_and_b32 v25, 0xffff0000, v25
 v_add_f32 v163, v163, v26
 v_add_f32 v163, v163, v25
 v_lshlrev_b32 v25, 16, v85
 v_and_b32 v26, 0xffff0000, v85
 v_mul_f32 v25, v25, v11
 v_mul_f32 v26, v26, v19
 v_cvt_pk_bf16_f32 v25, v25, v26
 v_lshlrev_b32 v26, 16, v25
 v_and_b32 v25, 0xffff0000, v25
 v_add_f32 v163, v163, v26
 v_add_f32 v163, v163, v25
 v_lshlrev_b32 v25, 16, v86
 v_and_b32 v26, 0xffff0000, v86
 v_mul_f32 v25, v25, v12
 v_mul_f32 v26, v26, v20
 v_cvt_pk_bf16_f32 v25, v25, v26
 v_lshlrev_b32 v26, 16, v25
 v_and_b32 v25, 0xffff0000, v25
 v_add_f32 v163, v163, v26
 v_add_f32 v163, v163, v25
 s_waitcnt vmcnt(22)
 v_mov_b32 v164, 0
 v_lshlrev_b32 v25, 16, v88
 v_and_b32 v26, 0xffff0000, v88
 v_mul_f32 v25, v25, v8
 v_mul_f32 v26, v26, v16
 v_cvt_pk_bf16_f32 v25, v25, v26
 v_lshlrev_b32 v26, 16, v25
 v_and_b32 v25, 0xffff0000, v25
 v_add_f32 v164, v164, v26
 v_add_f32 v164, v164, v25
 v_lshlrev_b32 v25, 16, v89
 v_and_b32 v26, 0xffff0000, v89
 v_mul_f32 v25, v25, v9
 v_mul_f32 v26, v26, v17
 v_cvt_pk_bf16_f32 v25, v25, v26
 v_lshlrev_b32 v26, 16, v25
 v_and_b32 v25, 0xffff0000, v25
 v_add_f32 v164, v164, v26
 v_add_f32 v164, v164, v25
 v_lshlrev_b32 v25, 16, v90
 v_and_b32 v26, 0xffff0000, v90
 v_mul_f32 v25, v25, v10
 v_mul_f32 v26, v26, v18
 v_cvt_pk_bf16_f32 v25, v25, v26
 v_lshlrev_b32 v26, 16, v25
 v_and_b32 v25, 0xffff0000, v25
 v_add_f32 v164, v164, v26
 v_add_f32 v164, v164, v25
 v_lshlrev_b32 v25, 16, v91
 v_and_b32 v26, 0xffff0000, v91
 v_mul_f32 v25, v25, v11
 v_mul_f32 v26, v26, v19
 v_cvt_pk_bf16_f32 v25, v25, v26
 v_lshlrev_b32 v26, 16, v25
 v_and_b32 v25, 0xffff0000, v25
 v_add_f32 v164, v164, v26
 v_add_f32 v164, v164, v25
 v_lshlrev_b32 v25, 16, v92
 v_and_b32 v26, 0xffff0000, v92
 v_mul_f32 v25, v25, v12
 v_mul_f32 v26, v26, v20
 v_cvt_pk_bf16_f32 v25, v25, v26
 v_lshlrev_b32 v26, 16, v25
 v_and_b32 v25, 0xffff0000, v25
 v_add_f32 v164, v164, v26
 v_add_f32 v164, v164, v25
 s_waitcnt vmcnt(20)
 v_mov_b32 v165, 0
 v_lshlrev_b32 v25, 16, v94
 v_and_b32 v26, 0xffff0000, v94
 v_mul_f32 v25, v25, v8
 v_mul_f32 v26, v26, v16
 v_cvt_pk_bf16_f32 v25, v25, v26
 v_lshlrev_b32 v26, 16, v25
 v_and_b32 v25, 0xffff0000, v25
 v_add_f32 v165, v165, v26
 v_add_f32 v165, v165, v25
 v_lshlrev_b32 v25, 16, v95
 v_and_b32 v26, 0xffff0000, v95
 v_mul_f32 v25, v25, v9
 v_mul_f32 v26, v26, v17
 v_cvt_pk_bf16_f32 v25, v25, v26
 v_lshlrev_b32 v26, 16, v25
 v_and_b32 v25, 0xffff0000, v25
 v_add_f32 v165, v165, v26
 v_add_f32 v165, v165, v25
 v_lshlrev_b32 v25, 16, v96
 v_and_b32 v26, 0xffff0000, v96
 v_mul_f32 v25, v25, v10
 v_mul_f32 v26, v26, v18
 v_cvt_pk_bf16_f32 v25, v25, v26
 v_lshlrev_b32 v26, 16, v25
 v_and_b32 v25, 0xffff0000, v25
 v_add_f32 v165, v165, v26
 v_add_f32 v165, v165, v25
 v_lshlrev_b32 v25, 16, v97
 v_and_b32 v26, 0xffff0000, v97
 v_mul_f32 v25, v25, v11
 v_mul_f32 v26, v26, v19
 v_cvt_pk_bf16_f32 v25, v25, v26
 v_lshlrev_b32 v26, 16, v25
 v_and_b32 v25, 0xffff0000, v25
 v_add_f32 v165, v165, v26
 v_add_f32 v165, v165, v25
 v_lshlrev_b32 v25, 16, v98
 v_and_b32 v26, 0xffff0000, v98
 v_mul_f32 v25, v25, v12
 v_mul_f32 v26, v26, v20
 v_cvt_pk_bf16_f32 v25, v25, v26
 v_lshlrev_b32 v26, 16, v25
 v_and_b32 v25, 0xffff0000, v25
 v_add_f32 v165, v165, v26
 v_add_f32 v165, v165, v25
 s_waitcnt vmcnt(18)
 v_mov_b32 v166, 0
 v_lshlrev_b32 v25, 16, v100
 v_and_b32 v26, 0xffff0000, v100
 v_mul_f32 v25, v25, v8
 v_mul_f32 v26, v26, v16
 v_cvt_pk_bf16_f32 v25, v25, v26
 v_lshlrev_b32 v26, 16, v25
 v_and_b32 v25, 0xffff0000, v25
 v_add_f32 v166, v166, v26
 v_add_f32 v166, v166, v25
 v_lshlrev_b32 v25, 16, v101
 v_and_b32 v26, 0xffff0000, v101
 v_mul_f32 v25, v25, v9
 v_mul_f32 v26, v26, v17
 v_cvt_pk_bf16_f32 v25, v25, v26
 v_lshlrev_b32 v26, 16, v25
 v_and_b32 v25, 0xffff0000, v25
 v_add_f32 v166, v166, v26
 v_add_f32 v166, v166, v25
 v_lshlrev_b32 v25, 16, v102
 v_and_b32 v26, 0xffff0000, v102
 v_mul_f32 v25, v25, v10
 v_mul_f32 v26, v26, v18
 v_cvt_pk_bf16_f32 v25, v25, v26
 v_lshlrev_b32 v26, 16, v25
 v_and_b32 v25, 0xffff0000, v25
 v_add_f32 v166, v166, v26
 v_add_f32 v166, v166, v25
 v_lshlrev_b32 v25, 16, v103
 v_and_b32 v26, 0xffff0000, v103
 v_mul_f32 v25, v25, v11
 v_mul_f32 v26, v26, v19
 v_cvt_pk_bf16_f32 v25, v25, v26
 v_lshlrev_b32 v26, 16, v25
 v_and_b32 v25, 0xffff0000, v25
 v_add_f32 v166, v166, v26
 v_add_f32 v166, v166, v25
 v_lshlrev_b32 v25, 16, v104
 v_and_b32 v26, 0xffff0000, v104
 v_mul_f32 v25, v25, v12
 v_mul_f32 v26, v26, v20
 v_cvt_pk_bf16_f32 v25, v25, v26
 v_lshlrev_b32 v26, 16, v25
 v_and_b32 v25, 0xffff0000, v25
 v_add_f32 v166, v166, v26
 v_add_f32 v166, v166, v25
 s_waitcnt vmcnt(16)
 v_mov_b32 v167, 0
 v_lshlrev_b32 v25, 16, v106
 v_and_b32 v26, 0xffff0000, v106
 v_mul_f32 v25, v25, v8
 v_mul_f32 v26, v26, v16
 v_cvt_pk_bf16_f32 v25, v25, v26
 v_lshlrev_b32 v26, 16, v25
 v_and_b32 v25, 0xffff0000, v25
 v_add_f32 v167, v167, v26
 v_add_f32 v167, v167, v25
 v_lshlrev_b32 v25, 16, v107
 v_and_b32 v26, 0xffff0000, v107
 v_mul_f32 v25, v25, v9
 v_mul_f32 v26, v26, v17
 v_cvt_pk_bf16_f32 v25, v25, v26
 v_lshlrev_b32 v26, 16, v25
 v_and_b32 v25, 0xffff0000, v25
 v_add_f32 v167, v167, v26
 v_add_f32 v167, v167, v25
 v_lshlrev_b32 v25, 16, v108
 v_and_b32 v26, 0xffff0000, v108
 v_mul_f32 v25, v25, v10
 v_mul_f32 v26, v26, v18
 v_cvt_pk_bf16_f32 v25, v25, v26
 v_lshlrev_b32 v26, 16, v25
 v_and_b32 v25, 0xffff0000, v25
 v_add_f32 v167, v167, v26
 v_add_f32 v167, v167, v25
 v_lshlrev_b32 v25, 16, v109
 v_and_b32 v26, 0xffff0000, v109
 v_mul_f32 v25, v25, v11
 v_mul_f32 v26, v26, v19
 v_cvt_pk_bf16_f32 v25, v25, v26
 v_lshlrev_b32 v26, 16, v25
 v_and_b32 v25, 0xffff0000, v25
 v_add_f32 v167, v167, v26
 v_add_f32 v167, v167, v25
 v_lshlrev_b32 v25, 16, v110
 v_and_b32 v26, 0xffff0000, v110
 v_mul_f32 v25, v25, v12
 v_mul_f32 v26, v26, v20
 v_cvt_pk_bf16_f32 v25, v25, v26
 v_lshlrev_b32 v26, 16, v25
 v_and_b32 v25, 0xffff0000, v25
 v_add_f32 v167, v167, v26
 v_add_f32 v167, v167, v25
 s_waitcnt vmcnt(14)
 v_mov_b32 v168, 0
 v_lshlrev_b32 v25, 16, v112
 v_and_b32 v26, 0xffff0000, v112
 v_mul_f32 v25, v25, v8
 v_mul_f32 v26, v26, v16
 v_cvt_pk_bf16_f32 v25, v25, v26
 v_lshlrev_b32 v26, 16, v25
 v_and_b32 v25, 0xffff0000, v25
 v_add_f32 v168, v168, v26
 v_add_f32 v168, v168, v25
 v_lshlrev_b32 v25, 16, v113
 v_and_b32 v26, 0xffff0000, v113
 v_mul_f32 v25, v25, v9
 v_mul_f32 v26, v26, v17
 v_cvt_pk_bf16_f32 v25, v25, v26
 v_lshlrev_b32 v26, 16, v25
 v_and_b32 v25, 0xffff0000, v25
 v_add_f32 v168, v168, v26
 v_add_f32 v168, v168, v25
 v_lshlrev_b32 v25, 16, v114
 v_and_b32 v26, 0xffff0000, v114
 v_mul_f32 v25, v25, v10
 v_mul_f32 v26, v26, v18
 v_cvt_pk_bf16_f32 v25, v25, v26
 v_lshlrev_b32 v26, 16, v25
 v_and_b32 v25, 0xffff0000, v25
 v_add_f32 v168, v168, v26
 v_add_f32 v168, v168, v25
 v_lshlrev_b32 v25, 16, v115
 v_and_b32 v26, 0xffff0000, v115
 v_mul_f32 v25, v25, v11
 v_mul_f32 v26, v26, v19
 v_cvt_pk_bf16_f32 v25, v25, v26
 v_lshlrev_b32 v26, 16, v25
 v_and_b32 v25, 0xffff0000, v25
 v_add_f32 v168, v168, v26
 v_add_f32 v168, v168, v25
 v_lshlrev_b32 v25, 16, v116
 v_and_b32 v26, 0xffff0000, v116
 v_mul_f32 v25, v25, v12
 v_mul_f32 v26, v26, v20
 v_cvt_pk_bf16_f32 v25, v25, v26
 v_lshlrev_b32 v26, 16, v25
 v_and_b32 v25, 0xffff0000, v25
 v_add_f32 v168, v168, v26
 v_add_f32 v168, v168, v25
 s_waitcnt vmcnt(12)
 v_mov_b32 v169, 0
 v_lshlrev_b32 v25, 16, v118
 v_and_b32 v26, 0xffff0000, v118
 v_mul_f32 v25, v25, v8
 v_mul_f32 v26, v26, v16
 v_cvt_pk_bf16_f32 v25, v25, v26
 v_lshlrev_b32 v26, 16, v25
 v_and_b32 v25, 0xffff0000, v25
 v_add_f32 v169, v169, v26
 v_add_f32 v169, v169, v25
 v_lshlrev_b32 v25, 16, v119
 v_and_b32 v26, 0xffff0000, v119
 v_mul_f32 v25, v25, v9
 v_mul_f32 v26, v26, v17
 v_cvt_pk_bf16_f32 v25, v25, v26
 v_lshlrev_b32 v26, 16, v25
 v_and_b32 v25, 0xffff0000, v25
 v_add_f32 v169, v169, v26
 v_add_f32 v169, v169, v25
 v_lshlrev_b32 v25, 16, v120
 v_and_b32 v26, 0xffff0000, v120
 v_mul_f32 v25, v25, v10
 v_mul_f32 v26, v26, v18
 v_cvt_pk_bf16_f32 v25, v25, v26
 v_lshlrev_b32 v26, 16, v25
 v_and_b32 v25, 0xffff0000, v25
 v_add_f32 v169, v169, v26
 v_add_f32 v169, v169, v25
 v_lshlrev_b32 v25, 16, v121
 v_and_b32 v26, 0xffff0000, v121
 v_mul_f32 v25, v25, v11
 v_mul_f32 v26, v26, v19
 v_cvt_pk_bf16_f32 v25, v25, v26
 v_lshlrev_b32 v26, 16, v25
 v_and_b32 v25, 0xffff0000, v25
 v_add_f32 v169, v169, v26
 v_add_f32 v169, v169, v25
 v_lshlrev_b32 v25, 16, v122
 v_and_b32 v26, 0xffff0000, v122
 v_mul_f32 v25, v25, v12
 v_mul_f32 v26, v26, v20
 v_cvt_pk_bf16_f32 v25, v25, v26
 v_lshlrev_b32 v26, 16, v25
 v_and_b32 v25, 0xffff0000, v25
 v_add_f32 v169, v169, v26
 v_add_f32 v169, v169, v25
 s_waitcnt vmcnt(10)
 v_mov_b32 v170, 0
 v_lshlrev_b32 v25, 16, v124
 v_and_b32 v26, 0xffff0000, v124
 v_mul_f32 v25, v25, v8
 v_mul_f32 v26, v26, v16
 v_cvt_pk_bf16_f32 v25, v25, v26
 v_lshlrev_b32 v26, 16, v25
 v_and_b32 v25, 0xffff0000, v25
 v_add_f32 v170, v170, v26
 v_add_f32 v170, v170, v25
 v_lshlrev_b32 v25, 16, v125
 v_and_b32 v26, 0xffff0000, v125
 v_mul_f32 v25, v25, v9
 v_mul_f32 v26, v26, v17
 v_cvt_pk_bf16_f32 v25, v25, v26
 v_lshlrev_b32 v26, 16, v25
 v_and_b32 v25, 0xffff0000, v25
 v_add_f32 v170, v170, v26
 v_add_f32 v170, v170, v25
 v_lshlrev_b32 v25, 16, v126
 v_and_b32 v26, 0xffff0000, v126
 v_mul_f32 v25, v25, v10
 v_mul_f32 v26, v26, v18
 v_cvt_pk_bf16_f32 v25, v25, v26
 v_lshlrev_b32 v26, 16, v25
 v_and_b32 v25, 0xffff0000, v25
 v_add_f32 v170, v170, v26
 v_add_f32 v170, v170, v25
 v_lshlrev_b32 v25, 16, v127
 v_and_b32 v26, 0xffff0000, v127
 v_mul_f32 v25, v25, v11
 v_mul_f32 v26, v26, v19
 v_cvt_pk_bf16_f32 v25, v25, v26
 v_lshlrev_b32 v26, 16, v25
 v_and_b32 v25, 0xffff0000, v25
 v_add_f32 v170, v170, v26
 v_add_f32 v170, v170, v25
 v_lshlrev_b32 v25, 16, v128
 v_and_b32 v26, 0xffff0000, v128
 v_mul_f32 v25, v25, v12
 v_mul_f32 v26, v26, v20
 v_cvt_pk_bf16_f32 v25, v25, v26
 v_lshlrev_b32 v26, 16, v25
 v_and_b32 v25, 0xffff0000, v25
 v_add_f32 v170, v170, v26
 v_add_f32 v170, v170, v25
 s_waitcnt vmcnt(8)
 v_mov_b32 v171, 0
 v_lshlrev_b32 v25, 16, v130
 v_and_b32 v26, 0xffff0000, v130
 v_mul_f32 v25, v25, v8
 v_mul_f32 v26, v26, v16
 v_cvt_pk_bf16_f32 v25, v25, v26
 v_lshlrev_b32 v26, 16, v25
 v_and_b32 v25, 0xffff0000, v25
 v_add_f32 v171, v171, v26
 v_add_f32 v171, v171, v25
 v_lshlrev_b32 v25, 16, v131
 v_and_b32 v26, 0xffff0000, v131
 v_mul_f32 v25, v25, v9
 v_mul_f32 v26, v26, v17
 v_cvt_pk_bf16_f32 v25, v25, v26
 v_lshlrev_b32 v26, 16, v25
 v_and_b32 v25, 0xffff0000, v25
 v_add_f32 v171, v171, v26
 v_add_f32 v171, v171, v25
 v_lshlrev_b32 v25, 16, v132
 v_and_b32 v26, 0xffff0000, v132
 v_mul_f32 v25, v25, v10
 v_mul_f32 v26, v26, v18
 v_cvt_pk_bf16_f32 v25, v25, v26
 v_lshlrev_b32 v26, 16, v25
 v_and_b32 v25, 0xffff0000, v25
 v_add_f32 v171, v171, v26
 v_add_f32 v171, v171, v25
 v_lshlrev_b32 v25, 16, v133
 v_and_b32 v26, 0xffff0000, v133
 v_mul_f32 v25, v25, v11
 v_mul_f32 v26, v26, v19
 v_cvt_pk_bf16_f32 v25, v25, v26
 v_lshlrev_b32 v26, 16, v25
 v_and_b32 v25, 0xffff0000, v25
 v_add_f32 v171, v171, v26
 v_add_f32 v171, v171, v25
 v_lshlrev_b32 v25, 16, v134
 v_and_b32 v26, 0xffff0000, v134
 v_mul_f32 v25, v25, v12
 v_mul_f32 v26, v26, v20
 v_cvt_pk_bf16_f32 v25, v25, v26
 v_lshlrev_b32 v26, 16, v25
 v_and_b32 v25, 0xffff0000, v25
 v_add_f32 v171, v171, v26
 v_add_f32 v171, v171, v25
 s_waitcnt vmcnt(6)
 v_mov_b32 v172, 0
 v_lshlrev_b32 v25, 16, v136
 v_and_b32 v26, 0xffff0000, v136
 v_mul_f32 v25, v25, v8
 v_mul_f32 v26, v26, v16
 v_cvt_pk_bf16_f32 v25, v25, v26
 v_lshlrev_b32 v26, 16, v25
 v_and_b32 v25, 0xffff0000, v25
 v_add_f32 v172, v172, v26
 v_add_f32 v172, v172, v25
 v_lshlrev_b32 v25, 16, v137
 v_and_b32 v26, 0xffff0000, v137
 v_mul_f32 v25, v25, v9
 v_mul_f32 v26, v26, v17
 v_cvt_pk_bf16_f32 v25, v25, v26
 v_lshlrev_b32 v26, 16, v25
 v_and_b32 v25, 0xffff0000, v25
 v_add_f32 v172, v172, v26
 v_add_f32 v172, v172, v25
 v_lshlrev_b32 v25, 16, v138
 v_and_b32 v26, 0xffff0000, v138
 v_mul_f32 v25, v25, v10
 v_mul_f32 v26, v26, v18
 v_cvt_pk_bf16_f32 v25, v25, v26
 v_lshlrev_b32 v26, 16, v25
 v_and_b32 v25, 0xffff0000, v25
 v_add_f32 v172, v172, v26
 v_add_f32 v172, v172, v25
 v_lshlrev_b32 v25, 16, v139
 v_and_b32 v26, 0xffff0000, v139
 v_mul_f32 v25, v25, v11
 v_mul_f32 v26, v26, v19
 v_cvt_pk_bf16_f32 v25, v25, v26
 v_lshlrev_b32 v26, 16, v25
 v_and_b32 v25, 0xffff0000, v25
 v_add_f32 v172, v172, v26
 v_add_f32 v172, v172, v25
 v_lshlrev_b32 v25, 16, v140
 v_and_b32 v26, 0xffff0000, v140
 v_mul_f32 v25, v25, v12
 v_mul_f32 v26, v26, v20
 v_cvt_pk_bf16_f32 v25, v25, v26
 v_lshlrev_b32 v26, 16, v25
 v_and_b32 v25, 0xffff0000, v25
 v_add_f32 v172, v172, v26
 v_add_f32 v172, v172, v25
 s_waitcnt vmcnt(4)
 v_mov_b32 v173, 0
 v_lshlrev_b32 v25, 16, v142
 v_and_b32 v26, 0xffff0000, v142
 v_mul_f32 v25, v25, v8
 v_mul_f32 v26, v26, v16
 v_cvt_pk_bf16_f32 v25, v25, v26
 v_lshlrev_b32 v26, 16, v25
 v_and_b32 v25, 0xffff0000, v25
 v_add_f32 v173, v173, v26
 v_add_f32 v173, v173, v25
 v_lshlrev_b32 v25, 16, v143
 v_and_b32 v26, 0xffff0000, v143
 v_mul_f32 v25, v25, v9
 v_mul_f32 v26, v26, v17
 v_cvt_pk_bf16_f32 v25, v25, v26
 v_lshlrev_b32 v26, 16, v25
 v_and_b32 v25, 0xffff0000, v25
 v_add_f32 v173, v173, v26
 v_add_f32 v173, v173, v25
 v_lshlrev_b32 v25, 16, v144
 v_and_b32 v26, 0xffff0000, v144
 v_mul_f32 v25, v25, v10
 v_mul_f32 v26, v26, v18
 v_cvt_pk_bf16_f32 v25, v25, v26
 v_lshlrev_b32 v26, 16, v25
 v_and_b32 v25, 0xffff0000, v25
 v_add_f32 v173, v173, v26
 v_add_f32 v173, v173, v25
 v_lshlrev_b32 v25, 16, v145
 v_and_b32 v26, 0xffff0000, v145
 v_mul_f32 v25, v25, v11
 v_mul_f32 v26, v26, v19
 v_cvt_pk_bf16_f32 v25, v25, v26
 v_lshlrev_b32 v26, 16, v25
 v_and_b32 v25, 0xffff0000, v25
 v_add_f32 v173, v173, v26
 v_add_f32 v173, v173, v25
 v_lshlrev_b32 v25, 16, v146
 v_and_b32 v26, 0xffff0000, v146
 v_mul_f32 v25, v25, v12
 v_mul_f32 v26, v26, v20
 v_cvt_pk_bf16_f32 v25, v25, v26
 v_lshlrev_b32 v26, 16, v25
 v_and_b32 v25, 0xffff0000, v25
 v_add_f32 v173, v173, v26
 v_add_f32 v173, v173, v25
 s_waitcnt vmcnt(2)
 v_mov_b32 v174, 0
 v_lshlrev_b32 v25, 16, v148
 v_and_b32 v26, 0xffff0000, v148
 v_mul_f32 v25, v25, v8
 v_mul_f32 v26, v26, v16
 v_cvt_pk_bf16_f32 v25, v25, v26
 v_lshlrev_b32 v26, 16, v25
 v_and_b32 v25, 0xffff0000, v25
 v_add_f32 v174, v174, v26
 v_add_f32 v174, v174, v25
 v_lshlrev_b32 v25, 16, v149
 v_and_b32 v26, 0xffff0000, v149
 v_mul_f32 v25, v25, v9
 v_mul_f32 v26, v26, v17
 v_cvt_pk_bf16_f32 v25, v25, v26
 v_lshlrev_b32 v26, 16, v25
 v_and_b32 v25, 0xffff0000, v25
 v_add_f32 v174, v174, v26
 v_add_f32 v174, v174, v25
 v_lshlrev_b32 v25, 16, v150
 v_and_b32 v26, 0xffff0000, v150
 v_mul_f32 v25, v25, v10
 v_mul_f32 v26, v26, v18
 v_cvt_pk_bf16_f32 v25, v25, v26
 v_lshlrev_b32 v26, 16, v25
 v_and_b32 v25, 0xffff0000, v25
 v_add_f32 v174, v174, v26
 v_add_f32 v174, v174, v25
 v_lshlrev_b32 v25, 16, v151
 v_and_b32 v26, 0xffff0000, v151
 v_mul_f32 v25, v25, v11
 v_mul_f32 v26, v26, v19
 v_cvt_pk_bf16_f32 v25, v25, v26
 v_lshlrev_b32 v26, 16, v25
 v_and_b32 v25, 0xffff0000, v25
 v_add_f32 v174, v174, v26
 v_add_f32 v174, v174, v25
 v_lshlrev_b32 v25, 16, v152
 v_and_b32 v26, 0xffff0000, v152
 v_mul_f32 v25, v25, v12
 v_mul_f32 v26, v26, v20
 v_cvt_pk_bf16_f32 v25, v25, v26
 v_lshlrev_b32 v26, 16, v25
 v_and_b32 v25, 0xffff0000, v25
 v_add_f32 v174, v174, v26
 v_add_f32 v174, v174, v25
 s_waitcnt vmcnt(0)
 v_mov_b32 v175, 0
 v_lshlrev_b32 v25, 16, v154
 v_and_b32 v26, 0xffff0000, v154
 v_mul_f32 v25, v25, v8
 v_mul_f32 v26, v26, v16
 v_cvt_pk_bf16_f32 v25, v25, v26
 v_lshlrev_b32 v26, 16, v25
 v_and_b32 v25, 0xffff0000, v25
 v_add_f32 v175, v175, v26
 v_add_f32 v175, v175, v25
 v_lshlrev_b32 v25, 16, v155
 v_and_b32 v26, 0xffff0000, v155
 v_mul_f32 v25, v25, v9
 v_mul_f32 v26, v26, v17
 v_cvt_pk_bf16_f32 v25, v25, v26
 v_lshlrev_b32 v26, 16, v25
 v_and_b32 v25, 0xffff0000, v25
 v_add_f32 v175, v175, v26
 v_add_f32 v175, v175, v25
 v_lshlrev_b32 v25, 16, v156
 v_and_b32 v26, 0xffff0000, v156
 v_mul_f32 v25, v25, v10
 v_mul_f32 v26, v26, v18
 v_cvt_pk_bf16_f32 v25, v25, v26
 v_lshlrev_b32 v26, 16, v25
 v_and_b32 v25, 0xffff0000, v25
 v_add_f32 v175, v175, v26
 v_add_f32 v175, v175, v25
 v_lshlrev_b32 v25, 16, v157
 v_and_b32 v26, 0xffff0000, v157
 v_mul_f32 v25, v25, v11
 v_mul_f32 v26, v26, v19
 v_cvt_pk_bf16_f32 v25, v25, v26
 v_lshlrev_b32 v26, 16, v25
 v_and_b32 v25, 0xffff0000, v25
 v_add_f32 v175, v175, v26
 v_add_f32 v175, v175, v25
 v_lshlrev_b32 v25, 16, v158
 v_and_b32 v26, 0xffff0000, v158
 v_mul_f32 v25, v25, v12
 v_mul_f32 v26, v26, v20
 v_cvt_pk_bf16_f32 v25, v25, v26
 v_lshlrev_b32 v26, 16, v25
 v_and_b32 v25, 0xffff0000, v25
 v_add_f32 v175, v175, v26
 v_add_f32 v175, v175, v25
 v_add_f32_dpp v160, v160, v160 row_ror:8 row_mask:0xf bank_mask:0xf
 v_add_f32_dpp v161, v161, v161 row_ror:8 row_mask:0xf bank_mask:0xf
 v_add_f32_dpp v162, v162, v162 row_ror:8 row_mask:0xf bank_mask:0xf
 v_add_f32_dpp v163, v163, v163 row_ror:8 row_mask:0xf bank_mask:0xf
 v_add_f32_dpp v164, v164, v164 row_ror:8 row_mask:0xf bank_mask:0xf
 v_add_f32_dpp v165, v165, v165 row_ror:8 row_mask:0xf bank_mask:0xf
 v_add_f32_dpp v166, v166, v166 row_ror:8 row_mask:0xf bank_mask:0xf
 v_add_f32_dpp v167, v167, v167 row_ror:8 row_mask:0xf bank_mask:0xf
 v_add_f32_dpp v168, v168, v168 row_ror:8 row_mask:0xf bank_mask:0xf
 v_add_f32_dpp v169, v169, v169 row_ror:8 row_mask:0xf bank_mask:0xf
 v_add_f32_dpp v170, v170, v170 row_ror:8 row_mask:0xf bank_mask:0xf
 v_add_f32_dpp v171, v171, v171 row_ror:8 row_mask:0xf bank_mask:0xf
 v_add_f32_dpp v172, v172, v172 row_ror:8 row_mask:0xf bank_mask:0xf
 v_add_f32_dpp v173, v173, v173 row_ror:8 row_mask:0xf bank_mask:0xf
 v_add_f32_dpp v174, v174, v174 row_ror:8 row_mask:0xf bank_mask:0xf
 v_add_f32_dpp v175, v175, v175 row_ror:8 row_mask:0xf bank_mask:0xf
 v_add_f32_dpp v160, v160, v160 row_ror:4 row_mask:0xf bank_mask:0xf
 v_add_f32_dpp v161, v161, v161 row_ror:4 row_mask:0xf bank_mask:0xf
 v_add_f32_dpp v162, v162, v162 row_ror:4 row_mask:0xf bank_mask:0xf
 v_add_f32_dpp v163, v163, v163 row_ror:4 row_mask:0xf bank_mask:0xf
 v_add_f32_dpp v164, v164, v164 row_ror:4 row_mask:0xf bank_mask:0xf
 v_add_f32_dpp v165, v165, v165 row_ror:4 row_mask:0xf bank_mask:0xf
 v_add_f32_dpp v166, v166, v166 row_ror:4 row_mask:0xf bank_mask:0xf
 v_add_f32_dpp v167, v167, v167 row_ror:4 row_mask:0xf bank_mask:0xf
 v_add_f32_dpp v168, v168, v168 row_ror:4 row_mask:0xf bank_mask:0xf
 v_add_f32_dpp v169, v169, v169 row_ror:4 row_mask:0xf bank_mask:0xf
 v_add_f32_dpp v170, v170, v170 row_ror:4 row_mask:0xf bank_mask:0xf
 v_add_f32_dpp v171, v171, v171 row_ror:4 row_mask:0xf bank_mask:0xf
 v_add_f32_dpp v172, v172, v172 row_ror:4 row_mask:0xf bank_mask:0xf
 v_add_f32_dpp v173, v173, v173 row_ror:4 row_mask:0xf bank_mask:0xf
 v_add_f32_dpp v174, v174, v174 row_ror:4 row_mask:0xf bank_mask:0xf
 v_add_f32_dpp v175, v175, v175 row_ror:4 row_mask:0xf bank_mask:0xf
 v_add_f32_dpp v160, v160, v160 row_ror:2 row_mask:0xf bank_mask:0xf
 v_add_f32_dpp v161, v161, v161 row_ror:2 row_mask:0xf bank_mask:0xf
 v_add_f32_dpp v162, v162, v162 row_ror:2 row_mask:0xf bank_mask:0xf
 v_add_f32_dpp v163, v163, v163 row_ror:2 row_mask:0xf bank_mask:0xf
 v_add_f32_dpp v164, v164, v164 row_ror:2 row_mask:0xf bank_mask:0xf
 v_add_f32_dpp v165, v165, v165 row_ror:2 row_mask:0xf bank_mask:0xf
 v_add_f32_dpp v166, v166, v166 row_ror:2 row_mask:0xf bank_mask:0xf
 v_add_f32_dpp v167, v167, v167 row_ror:2 row_mask:0xf bank_mask:0xf
 v_add_f32_dpp v168, v168, v168 row_ror:2 row_mask:0xf bank_mask:0xf
 v_add_f32_dpp v169, v169, v169 row_ror:2 row_mask:0xf bank_mask:0xf
 v_add_f32_dpp v170, v170, v170 row_ror:2 row_mask:0xf bank_mask:0xf
 v_add_f32_dpp v171, v171, v171 row_ror:2 row_mask:0xf bank_mask:0xf
 v_add_f32_dpp v172, v172, v172 row_ror:2 row_mask:0xf bank_mask:0xf
 v_add_f32_dpp v173, v173, v173 row_ror:2 row_mask:0xf bank_mask:0xf
 v_add_f32_dpp v174, v174, v174 row_ror:2 row_mask:0xf bank_mask:0xf
 v_add_f32_dpp v175, v175, v175 row_ror:2 row_mask:0xf bank_mask:0xf
 v_add_f32_dpp v160, v160, v160 row_ror:1 row_mask:0xf bank_mask:0xf
 v_add_f32_dpp v161, v161, v161 row_ror:1 row_mask:0xf bank_mask:0xf
 v_add_f32_dpp v162, v162, v162 row_ror:1 row_mask:0xf bank_mask:0xf
 v_add_f32_dpp v163, v163, v163 row_ror:1 row_mask:0xf bank_mask:0xf
 v_add_f32_dpp v164, v164, v164 row_ror:1 row_mask:0xf bank_mask:0xf
 v_add_f32_dpp v165, v165, v165 row_ror:1 row_mask:0xf bank_mask:0xf
 v_add_f32_dpp v166, v166, v166 row_ror:1 row_mask:0xf bank_mask:0xf
 v_add_f32_dpp v167, v167, v167 row_ror:1 row_mask:0xf bank_mask:0xf
 v_add_f32_dpp v168, v168, v168 row_ror:1 row_mask:0xf bank_mask:0xf
 v_add_f32_dpp v169, v169, v169 row_ror:1 row_mask:0xf bank_mask:0xf
 v_add_f32_dpp v170, v170, v170 row_ror:1 row_mask:0xf bank_mask:0xf
 v_add_f32_dpp v171, v171, v171 row_ror:1 row_mask:0xf bank_mask:0xf
 v_add_f32_dpp v172, v172, v172 row_ror:1 row_mask:0xf bank_mask:0xf
 v_add_f32_dpp v173, v173, v173 row_ror:1 row_mask:0xf bank_mask:0xf
 v_add_f32_dpp v174, v174, v174 row_ror:1 row_mask:0xf bank_mask:0xf
 v_add_f32_dpp v175, v175, v175 row_ror:1 row_mask:0xf bank_mask:0xf
 v_mov_b32 v192, v160
 v_mov_b32 v193, v161
 v_mov_b32 v194, v162
 v_mov_b32 v195, v163
 v_mov_b32 v196, v164
 v_mov_b32 v197, v165
 v_mov_b32 v198, v166
 v_mov_b32 v199, v167
 v_mov_b32 v200, v168
 v_mov_b32 v201, v169
 v_mov_b32 v202, v170
 v_mov_b32 v203, v171
 v_mov_b32 v204, v172
 v_mov_b32 v205, v173
 v_mov_b32 v206, v174
 v_mov_b32 v207, v175
 v_permlane32_swap_b32 v160, v192
 v_permlane32_swap_b32 v161, v193
 v_permlane32_swap_b32 v162, v194
 v_permlane32_swap_b32 v163, v195
 v_permlane32_swap_b32 v164, v196
 v_permlane32_swap_b32 v165, v197
 v_permlane32_swap_b32 v166, v198
 v_permlane32_swap_b32 v167, v199
 v_permlane32_swap_b32 v168, v200
 v_permlane32_swap_b32 v169, v201
 v_permlane32_swap_b32 v170, v202
 v_permlane32_swap_b32 v171, v203
 v_permlane32_swap_b32 v172, v204
 v_permlane32_swap_b32 v173, v205
 v_permlane32_swap_b32 v174, v206
 v_permlane32_swap_b32 v175, v207
 v_add_f32 v160, v160, v192
 v_add_f32 v161, v161, v193
 v_add_f32 v162, v162, v194
 v_add_f32 v163, v163, v195
 v_add_f32 v164, v164, v196
 v_add_f32 v165, v165, v197
 v_add_f32 v166, v166, v198
 v_add_f32 v167, v167, v199
 v_add_f32 v168, v168, v200
 v_add_f32 v169, v169, v201
 v_add_f32 v170, v170, v202
 v_add_f32 v171, v171, v203
 v_add_f32 v172, v172, v204
 v_add_f32 v173, v173, v205
 v_add_f32 v174, v174, v206
 v_add_f32 v175, v175, v207
 v_mov_b32 v192, v160
 v_mov_b32 v193, v161
 v_mov_b32 v194, v162
 v_mov_b32 v195, v163
 v_mov_b32 v196, v164
 v_mov_b32 v197, v165
 v_mov_b32 v198, v166
 v_mov_b32 v199, v167
 v_mov_b32 v200, v168
 v_mov_b32 v201, v169
 v_mov_b32 v202, v170
 v_mov_b32 v203, v171
 v_mov_b32 v204, v172
 v_mov_b32 v205, v173
 v_mov_b32 v206, v174
 v_mov_b32 v207, v175
 v_permlane16_swap_b32 v160, v192
 v_permlane16_swap_b32 v161, v193
 v_permlane16_swap_b32 v162, v194
 v_permlane16_swap_b32 v163, v195
 v_permlane16_swap_b32 v164, v196
 v_permlane16_swap_b32 v165, v197
 v_permlane16_swap_b32 v166, v198
 v_permlane16_swap_b32 v167, v199
 v_permlane16_swap_b32 v168, v200
 v_permlane16_swap_b32 v169, v201
 v_permlane16_swap_b32 v170, v202
 v_permlane16_swap_b32 v171, v203
 v_permlane16_swap_b32 v172, v204
 v_permlane16_swap_b32 v173, v205
 v_permlane16_swap_b32 v174, v206
 v_permlane16_swap_b32 v175, v207
 v_add_f32 v160, v160, v192
 v_add_f32 v161, v161, v193
 v_add_f32 v162, v162, v194
 v_add_f32 v163, v163, v195
 v_add_f32 v164, v164, v196
 v_add_f32 v165, v165, v197
 v_add_f32 v166, v166, v198
 v_add_f32 v167, v167, v199
 v_add_f32 v168, v168, v200
 v_add_f32 v169, v169, v201
 v_add_f32 v170, v170, v202
 v_add_f32 v171, v171, v203
 v_add_f32 v172, v172, v204
 v_add_f32 v173, v173, v205
 v_add_f32 v174, v174, v206
 v_add_f32 v175, v175, v207
 v_mov_b32 v24, v160
 v_cmp_eq_u32 vcc, 1, v1
 s_nop 1
 v_cndmask_b32 v24, v24, v161, vcc
 v_cmp_eq_u32 vcc, 2, v1
 s_nop 1
 v_cndmask_b32 v24, v24, v162, vcc
 v_cmp_eq_u32 vcc, 3, v1
 s_nop 1
 v_cndmask_b32 v24, v24, v163, vcc
 v_cmp_eq_u32 vcc, 4, v1
 s_nop 1
 v_cndmask_b32 v24, v24, v164, vcc
 v_cmp_eq_u32 vcc, 5, v1
 s_nop 1
 v_cndmask_b32 v24, v24, v165, vcc
 v_cmp_eq_u32 vcc, 6, v1
 s_nop 1
 v_cndmask_b32 v24, v24, v166, vcc
 v_cmp_eq_u32 vcc, 7, v1
 s_nop 1
 v_cndmask_b32 v24, v24, v167, vcc
 v_cmp_eq_u32 vcc, 8, v1
 s_nop 1
 v_cndmask_b32 v24, v24, v168, vcc
 v_cmp_eq_u32 vcc, 9, v1
 s_nop 1
 v_cndmask_b32 v24, v24, v169, vcc
 v_cmp_eq_u32 vcc, 10, v1
 s_nop 1
 v_cndmask_b32 v24, v24, v170, vcc
 v_cmp_eq_u32 vcc, 11, v1
 s_nop 1
 v_cndmask_b32 v24, v24, v171, vcc
 v_cmp_eq_u32 vcc, 12, v1
 s_nop 1
 v_cndmask_b32 v24, v24, v172, vcc
 v_cmp_eq_u32 vcc, 13, v1
 s_nop 1
 v_cndmask_b32 v24, v24, v173, vcc
 v_cmp_eq_u32 vcc, 14, v1
 s_nop 1
 v_cndmask_b32 v24, v24, v174, vcc
 v_cmp_eq_u32 vcc, 15, v1
 s_nop 1
 v_cndmask_b32 v24, v24, v175, vcc
 v_cvt_pk_bf16_f32 v25, v24, v24
 v_lshlrev_b32 v24, 16, v25
 v_mul_f32 v24, 0xbfb8aa3b, v24
 v_exp_f32 v24, v24
 s_nop 0
 v_add_f32 v24, 1.0, v24
 v_rcp_f32 v24, v24
 s_nop 0
 v_cvt_pk_bf16_f32 v25, v24, v24
 v_lshlrev_b32 v24, 16, v25
 s_lshl_b32 s21, s59, 2
 s_mov_b64 exec, 65535
 buffer_store_dword v24, v4, s[28:31], s21 offen sc1
 s_mov_b64 exec, -1
 s_waitcnt vmcnt(0)
 s_barrier
 s_mov_b32 s21, 76
 s_cmp_lg_u32 s20, 0
 s_cbranch_scc1 af_138
 v_mov_b32 v10, 0
 v_mov_b32 v11, 1
 s_mov_b64 exec, 1
 buffer_atomic_add v11, v10, s[32:35], s21 offen sc1
 s_mov_b64 exec, -1
 s_nop 1
af_138:
 s_load_dwordx2 s[6:7], s[0:1], 40
 s_load_dwordx2 s[38:39], s[0:1], 104
 s_waitcnt lgkmcnt(0)
 s_mov_b32 s12, s6
 s_mov_b32 s13, s7
 s_mov_b32 s14, 7864320
 s_mov_b32 s15, 0x00020000
 s_mov_b32 s16, s38
 s_mov_b32 s17, s39
 s_mov_b32 s18, 50331648
 s_mov_b32 s19, 0x00020000
 s_add_u32 s24, s38, 88080384
 s_addc_u32 s25, s39, 0
 s_mov_b32 s26, 83886080
 s_mov_b32 s27, 0x00020000
 s_load_dwordx2 s[72:73], s[0:1], 104
 s_waitcnt lgkmcnt(0)
 s_add_u32 s72, s72, 81068032
 s_addc_u32 s73, s73, 0
 s_mov_b32 s74, 129024
 s_mov_b32 s75, 0x00020000
 v_mov_b32 v29, 52429
 s_mul_i32 s21, s20, 960
 s_add_u32 s21, s21, 0
 v_add_u32 v21, s21, v1
 v_mul_u32_u24 v22, v21, v29
 v_lshrrev_b32 v22, 22, v22
 v_mul_u32_u24 v23, 80, v22
 v_sub_u32 v21, v21, v23
 v_bfe_u32 v23, v22, 3, 1
 v_and_b32 v24, 3, v22
 v_lshl_add_u32 v23, v23, 2, v24
 v_lshlrev_b32 v23, 1, v23
 v_xor_b32 v21, v21, v23
 v_cmp_gt_u32 vcc, 32, v22
 v_bfe_u32 v26, v22, 3, 2
 v_lshl_add_u32 v25, v26, 2, v24
 v_bfe_u32 v26, v22, 2, 1
 v_lshl_add_u32 v25, v26, 4, v25
 v_cndmask_b32 v25, v22, v25, vcc
 v_mul_u32_u24 v25, 1280, v25
 v_lshl_add_u32 v64, v21, 4, v25
 s_mul_i32 s21, s20, 960
 s_add_u32 s21, s21, 64
 v_add_u32 v21, s21, v1
 v_mul_u32_u24 v22, v21, v29
 v_lshrrev_b32 v22, 22, v22
 v_mul_u32_u24 v23, 80, v22
 v_sub_u32 v21, v21, v23
 v_bfe_u32 v23, v22, 3, 1
 v_and_b32 v24, 3, v22
 v_lshl_add_u32 v23, v23, 2, v24
 v_lshlrev_b32 v23, 1, v23
 v_xor_b32 v21, v21, v23
 v_cmp_gt_u32 vcc, 32, v22
 v_bfe_u32 v26, v22, 3, 2
 v_lshl_add_u32 v25, v26, 2, v24
 v_bfe_u32 v26, v22, 2, 1
 v_lshl_add_u32 v25, v26, 4, v25
 v_cndmask_b32 v25, v22, v25, vcc
 v_mul_u32_u24 v25, 1280, v25
 v_lshl_add_u32 v65, v21, 4, v25
 s_mul_i32 s21, s20, 960
 s_add_u32 s21, s21, 128
 v_add_u32 v21, s21, v1
 v_mul_u32_u24 v22, v21, v29
 v_lshrrev_b32 v22, 22, v22
 v_mul_u32_u24 v23, 80, v22
 v_sub_u32 v21, v21, v23
 v_bfe_u32 v23, v22, 3, 1
 v_and_b32 v24, 3, v22
 v_lshl_add_u32 v23, v23, 2, v24
 v_lshlrev_b32 v23, 1, v23
 v_xor_b32 v21, v21, v23
 v_cmp_gt_u32 vcc, 32, v22
 v_bfe_u32 v26, v22, 3, 2
 v_lshl_add_u32 v25, v26, 2, v24
 v_bfe_u32 v26, v22, 2, 1
 v_lshl_add_u32 v25, v26, 4, v25
 v_cndmask_b32 v25, v22, v25, vcc
 v_mul_u32_u24 v25, 1280, v25
 v_lshl_add_u32 v66, v21, 4, v25
 s_mul_i32 s21, s20, 960
 s_add_u32 s21, s21, 192
 v_add_u32 v21, s21, v1
 v_mul_u32_u24 v22, v21, v29
 v_lshrrev_b32 v22, 22, v22
 v_mul_u32_u24 v23, 80, v22
 v_sub_u32 v21, v21, v23
 v_bfe_u32 v23, v22, 3, 1
 v_and_b32 v24, 3, v22
 v_lshl_add_u32 v23, v23, 2, v24
 v_lshlrev_b32 v23, 1, v23
 v_xor_b32 v21, v21, v23
 v_cmp_gt_u32 vcc, 32, v22
 v_bfe_u32 v26, v22, 3, 2
 v_lshl_add_u32 v25, v26, 2, v24
 v_bfe_u32 v26, v22, 2, 1
 v_lshl_add_u32 v25, v26, 4, v25
 v_cndmask_b32 v25, v22, v25, vcc
 v_mul_u32_u24 v25, 1280, v25
 v_lshl_add_u32 v67, v21, 4, v25
 s_mul_i32 s21, s20, 960
 s_add_u32 s21, s21, 256
 v_add_u32 v21, s21, v1
 v_mul_u32_u24 v22, v21, v29
 v_lshrrev_b32 v22, 22, v22
 v_mul_u32_u24 v23, 80, v22
 v_sub_u32 v21, v21, v23
 v_bfe_u32 v23, v22, 3, 1
 v_and_b32 v24, 3, v22
 v_lshl_add_u32 v23, v23, 2, v24
 v_lshlrev_b32 v23, 1, v23
 v_xor_b32 v21, v21, v23
 v_cmp_gt_u32 vcc, 32, v22
 v_bfe_u32 v26, v22, 3, 2
 v_lshl_add_u32 v25, v26, 2, v24
 v_bfe_u32 v26, v22, 2, 1
 v_lshl_add_u32 v25, v26, 4, v25
 v_cndmask_b32 v25, v22, v25, vcc
 v_mul_u32_u24 v25, 1280, v25
 v_lshl_add_u32 v68, v21, 4, v25
 s_mul_i32 s21, s20, 960
 s_add_u32 s21, s21, 320
 v_add_u32 v21, s21, v1
 v_mul_u32_u24 v22, v21, v29
 v_lshrrev_b32 v22, 22, v22
 v_mul_u32_u24 v23, 80, v22
 v_sub_u32 v21, v21, v23
 v_bfe_u32 v23, v22, 3, 1
 v_and_b32 v24, 3, v22
 v_lshl_add_u32 v23, v23, 2, v24
 v_lshlrev_b32 v23, 1, v23
 v_xor_b32 v21, v21, v23
 v_cmp_gt_u32 vcc, 32, v22
 v_bfe_u32 v26, v22, 3, 2
 v_lshl_add_u32 v25, v26, 2, v24
 v_bfe_u32 v26, v22, 2, 1
 v_lshl_add_u32 v25, v26, 4, v25
 v_cndmask_b32 v25, v22, v25, vcc
 v_mul_u32_u24 v25, 1280, v25
 v_lshl_add_u32 v69, v21, 4, v25
 s_mul_i32 s21, s20, 960
 s_add_u32 s21, s21, 384
 v_add_u32 v21, s21, v1
 v_mul_u32_u24 v22, v21, v29
 v_lshrrev_b32 v22, 22, v22
 v_mul_u32_u24 v23, 80, v22
 v_sub_u32 v21, v21, v23
 v_bfe_u32 v23, v22, 3, 1
 v_and_b32 v24, 3, v22
 v_lshl_add_u32 v23, v23, 2, v24
 v_lshlrev_b32 v23, 1, v23
 v_xor_b32 v21, v21, v23
 v_cmp_gt_u32 vcc, 32, v22
 v_bfe_u32 v26, v22, 3, 2
 v_lshl_add_u32 v25, v26, 2, v24
 v_bfe_u32 v26, v22, 2, 1
 v_lshl_add_u32 v25, v26, 4, v25
 v_cndmask_b32 v25, v22, v25, vcc
 v_mul_u32_u24 v25, 1280, v25
 v_lshl_add_u32 v70, v21, 4, v25
 s_mul_i32 s21, s20, 960
 s_add_u32 s21, s21, 448
 v_add_u32 v21, s21, v1
 v_mul_u32_u24 v22, v21, v29
 v_lshrrev_b32 v22, 22, v22
 v_mul_u32_u24 v23, 80, v22
 v_sub_u32 v21, v21, v23
 v_bfe_u32 v23, v22, 3, 1
 v_and_b32 v24, 3, v22
 v_lshl_add_u32 v23, v23, 2, v24
 v_lshlrev_b32 v23, 1, v23
 v_xor_b32 v21, v21, v23
 v_cmp_gt_u32 vcc, 32, v22
 v_bfe_u32 v26, v22, 3, 2
 v_lshl_add_u32 v25, v26, 2, v24
 v_bfe_u32 v26, v22, 2, 1
 v_lshl_add_u32 v25, v26, 4, v25
 v_cndmask_b32 v25, v22, v25, vcc
 v_mul_u32_u24 v25, 1280, v25
 v_lshl_add_u32 v71, v21, 4, v25
 s_mul_i32 s21, s20, 960
 s_add_u32 s21, s21, 512
 v_add_u32 v21, s21, v1
 v_mul_u32_u24 v22, v21, v29
 v_lshrrev_b32 v22, 22, v22
 v_mul_u32_u24 v23, 80, v22
 v_sub_u32 v21, v21, v23
 v_bfe_u32 v23, v22, 3, 1
 v_and_b32 v24, 3, v22
 v_lshl_add_u32 v23, v23, 2, v24
 v_lshlrev_b32 v23, 1, v23
 v_xor_b32 v21, v21, v23
 v_cmp_gt_u32 vcc, 32, v22
 v_bfe_u32 v26, v22, 3, 2
 v_lshl_add_u32 v25, v26, 2, v24
 v_bfe_u32 v26, v22, 2, 1
 v_lshl_add_u32 v25, v26, 4, v25
 v_cndmask_b32 v25, v22, v25, vcc
 v_mul_u32_u24 v25, 1280, v25
 v_lshl_add_u32 v72, v21, 4, v25
 s_mul_i32 s21, s20, 960
 s_add_u32 s21, s21, 576
 v_add_u32 v21, s21, v1
 v_mul_u32_u24 v22, v21, v29
 v_lshrrev_b32 v22, 22, v22
 v_mul_u32_u24 v23, 80, v22
 v_sub_u32 v21, v21, v23
 v_bfe_u32 v23, v22, 3, 1
 v_and_b32 v24, 3, v22
 v_lshl_add_u32 v23, v23, 2, v24
 v_lshlrev_b32 v23, 1, v23
 v_xor_b32 v21, v21, v23
 v_cmp_gt_u32 vcc, 32, v22
 v_bfe_u32 v26, v22, 3, 2
 v_lshl_add_u32 v25, v26, 2, v24
 v_bfe_u32 v26, v22, 2, 1
 v_lshl_add_u32 v25, v26, 4, v25
 v_cndmask_b32 v25, v22, v25, vcc
 v_mul_u32_u24 v25, 1280, v25
 v_lshl_add_u32 v73, v21, 4, v25
 s_mul_i32 s21, s20, 960
 s_add_u32 s21, s21, 640
 v_add_u32 v21, s21, v1
 v_mul_u32_u24 v22, v21, v29
 v_lshrrev_b32 v22, 22, v22
 v_mul_u32_u24 v23, 80, v22
 v_sub_u32 v21, v21, v23
 v_bfe_u32 v23, v22, 3, 1
 v_and_b32 v24, 3, v22
 v_lshl_add_u32 v23, v23, 2, v24
 v_lshlrev_b32 v23, 1, v23
 v_xor_b32 v21, v21, v23
 v_cmp_gt_u32 vcc, 32, v22
 v_bfe_u32 v26, v22, 3, 2
 v_lshl_add_u32 v25, v26, 2, v24
 v_bfe_u32 v26, v22, 2, 1
 v_lshl_add_u32 v25, v26, 4, v25
 v_cndmask_b32 v25, v22, v25, vcc
 v_mul_u32_u24 v25, 1280, v25
 v_lshl_add_u32 v74, v21, 4, v25
 s_mul_i32 s21, s20, 960
 s_add_u32 s21, s21, 704
 v_add_u32 v21, s21, v1
 v_mul_u32_u24 v22, v21, v29
 v_lshrrev_b32 v22, 22, v22
 v_mul_u32_u24 v23, 80, v22
 v_sub_u32 v21, v21, v23
 v_bfe_u32 v23, v22, 3, 1
 v_and_b32 v24, 3, v22
 v_lshl_add_u32 v23, v23, 2, v24
 v_lshlrev_b32 v23, 1, v23
 v_xor_b32 v21, v21, v23
 v_cmp_gt_u32 vcc, 32, v22
 v_bfe_u32 v26, v22, 3, 2
 v_lshl_add_u32 v25, v26, 2, v24
 v_bfe_u32 v26, v22, 2, 1
 v_lshl_add_u32 v25, v26, 4, v25
 v_cndmask_b32 v25, v22, v25, vcc
 v_mul_u32_u24 v25, 1280, v25
 v_lshl_add_u32 v75, v21, 4, v25
 s_mul_i32 s21, s20, 960
 s_add_u32 s21, s21, 768
 v_add_u32 v21, s21, v1
 v_mul_u32_u24 v22, v21, v29
 v_lshrrev_b32 v22, 22, v22
 v_mul_u32_u24 v23, 80, v22
 v_sub_u32 v21, v21, v23
 v_bfe_u32 v23, v22, 3, 1
 v_and_b32 v24, 3, v22
 v_lshl_add_u32 v23, v23, 2, v24
 v_lshlrev_b32 v23, 1, v23
 v_xor_b32 v21, v21, v23
 v_cmp_gt_u32 vcc, 32, v22
 v_bfe_u32 v26, v22, 3, 2
 v_lshl_add_u32 v25, v26, 2, v24
 v_bfe_u32 v26, v22, 2, 1
 v_lshl_add_u32 v25, v26, 4, v25
 v_cndmask_b32 v25, v22, v25, vcc
 v_mul_u32_u24 v25, 1280, v25
 v_lshl_add_u32 v76, v21, 4, v25
 s_mul_i32 s21, s20, 960
 s_add_u32 s21, s21, 832
 v_add_u32 v21, s21, v1
 v_mul_u32_u24 v22, v21, v29
 v_lshrrev_b32 v22, 22, v22
 v_mul_u32_u24 v23, 80, v22
 v_sub_u32 v21, v21, v23
 v_bfe_u32 v23, v22, 3, 1
 v_and_b32 v24, 3, v22
 v_lshl_add_u32 v23, v23, 2, v24
 v_lshlrev_b32 v23, 1, v23
 v_xor_b32 v21, v21, v23
 v_cmp_gt_u32 vcc, 32, v22
 v_bfe_u32 v26, v22, 3, 2
 v_lshl_add_u32 v25, v26, 2, v24
 v_bfe_u32 v26, v22, 2, 1
 v_lshl_add_u32 v25, v26, 4, v25
 v_cndmask_b32 v25, v22, v25, vcc
 v_mul_u32_u24 v25, 1280, v25
 v_lshl_add_u32 v77, v21, 4, v25
 s_mul_i32 s21, s20, 960
 s_add_u32 s21, s21, 896
 v_add_u32 v21, s21, v1
 v_mul_u32_u24 v22, v21, v29
 v_lshrrev_b32 v22, 22, v22
 v_mul_u32_u24 v23, 80, v22
 v_sub_u32 v21, v21, v23
 v_bfe_u32 v23, v22, 3, 1
 v_and_b32 v24, 3, v22
 v_lshl_add_u32 v23, v23, 2, v24
 v_lshlrev_b32 v23, 1, v23
 v_xor_b32 v21, v21, v23
 v_cmp_gt_u32 vcc, 32, v22
 v_bfe_u32 v26, v22, 3, 2
 v_lshl_add_u32 v25, v26, 2, v24
 v_bfe_u32 v26, v22, 2, 1
 v_lshl_add_u32 v25, v26, 4, v25
 v_cndmask_b32 v25, v22, v25, vcc
 v_mul_u32_u24 v25, 1280, v25
 v_lshl_add_u32 v78, v21, 4, v25
 s_mul_i32 s40, s2, 245760
 s_add_u32 s21, s40, 0
 s_mul_i32 s22, s20, 15360
 s_add_u32 s22, s22, 0
 s_add_u32 m0, s22, 0
 s_nop 0
 buffer_load_dwordx4 v64, s[12:15], s21 offen lds
 s_add_u32 m0, s22, 1024
 s_nop 0
 buffer_load_dwordx4 v65, s[12:15], s21 offen lds
 s_add_u32 m0, s22, 2048
 s_nop 0
 buffer_load_dwordx4 v66, s[12:15], s21 offen lds
 s_add_u32 m0, s22, 3072
 s_nop 0
 buffer_load_dwordx4 v67, s[12:15], s21 offen lds
 s_add_u32 m0, s22, 4096
 s_nop 0
 buffer_load_dwordx4 v68, s[12:15], s21 offen lds
 s_add_u32 m0, s22, 5120
 s_nop 0
 buffer_load_dwordx4 v69, s[12:15], s21 offen lds
 s_add_u32 m0, s22, 6144
 s_nop 0
 buffer_load_dwordx4 v70, s[12:15], s21 offen lds
 s_add_u32 m0, s22, 7168
 s_nop 0
 buffer_load_dwordx4 v71, s[12:15], s21 offen lds
 s_add_u32 m0, s22, 8192
 s_nop 0
 buffer_load_dwordx4 v72, s[12:15], s21 offen lds
 s_add_u32 m0, s22, 9216
 s_nop 0
 buffer_load_dwordx4 v73, s[12:15], s21 offen lds
 s_add_u32 m0, s22, 10240
 s_nop 0
 buffer_load_dwordx4 v74, s[12:15], s21 offen lds
 s_add_u32 m0, s22, 11264
 s_nop 0
 buffer_load_dwordx4 v75, s[12:15], s21 offen lds
 s_add_u32 m0, s22, 12288
 s_nop 0
 buffer_load_dwordx4 v76, s[12:15], s21 offen lds
 s_add_u32 m0, s22, 13312
 s_nop 0
 buffer_load_dwordx4 v77, s[12:15], s21 offen lds
 s_add_u32 m0, s22, 14336
 s_nop 0
 buffer_load_dwordx4 v78, s[12:15], s21 offen lds
 s_add_u32 s21, s40, 61440
 s_mul_i32 s22, s20, 15360
 s_add_u32 s22, s22, 61440
 s_add_u32 m0, s22, 0
 s_nop 0
 buffer_load_dwordx4 v64, s[12:15], s21 offen lds
 s_add_u32 m0, s22, 1024
 s_nop 0
 buffer_load_dwordx4 v65, s[12:15], s21 offen lds
 s_add_u32 m0, s22, 2048
 s_nop 0
 buffer_load_dwordx4 v66, s[12:15], s21 offen lds
 s_add_u32 m0, s22, 3072
 s_nop 0
 buffer_load_dwordx4 v67, s[12:15], s21 offen lds
 s_add_u32 m0, s22, 4096
 s_nop 0
 buffer_load_dwordx4 v68, s[12:15], s21 offen lds
 s_add_u32 m0, s22, 5120
 s_nop 0
 buffer_load_dwordx4 v69, s[12:15], s21 offen lds
 s_add_u32 m0, s22, 6144
 s_nop 0
 buffer_load_dwordx4 v70, s[12:15], s21 offen lds
 s_add_u32 m0, s22, 7168
 s_nop 0
 buffer_load_dwordx4 v71, s[12:15], s21 offen lds
 s_add_u32 m0, s22, 8192
 s_nop 0
 buffer_load_dwordx4 v72, s[12:15], s21 offen lds
 s_add_u32 m0, s22, 9216
 s_nop 0
 buffer_load_dwordx4 v73, s[12:15], s21 offen lds
 s_add_u32 m0, s22, 10240
 s_nop 0
 buffer_load_dwordx4 v74, s[12:15], s21 offen lds
 s_add_u32 m0, s22, 11264
 s_nop 0
 buffer_load_dwordx4 v75, s[12:15], s21 offen lds
 s_add_u32 m0, s22, 12288
 s_nop 0
 buffer_load_dwordx4 v76, s[12:15], s21 offen lds
 s_add_u32 m0, s22, 13312
 s_nop 0
 buffer_load_dwordx4 v77, s[12:15], s21 offen lds
 s_add_u32 m0, s22, 14336
 s_nop 0
 buffer_load_dwordx4 v78, s[12:15], s21 offen lds
 s_add_u32 s21, s40, 122880
 s_mul_i32 s22, s20, 15360
 s_add_u32 s22, s22, 0
 buffer_load_dwordx4 v[80:83], v64, s[12:15], s21 offen
 buffer_load_dwordx4 v[84:87], v65, s[12:15], s21 offen
 buffer_load_dwordx4 v[88:91], v66, s[12:15], s21 offen
 buffer_load_dwordx4 v[92:95], v67, s[12:15], s21 offen
 buffer_load_dwordx4 v[96:99], v68, s[12:15], s21 offen
 buffer_load_dwordx4 v[100:103], v69, s[12:15], s21 offen
 buffer_load_dwordx4 v[104:107], v70, s[12:15], s21 offen
 buffer_load_dwordx4 v[108:111], v71, s[12:15], s21 offen
 buffer_load_dwordx4 v[112:115], v72, s[12:15], s21 offen
 buffer_load_dwordx4 v[116:119], v73, s[12:15], s21 offen
 buffer_load_dwordx4 v[120:123], v74, s[12:15], s21 offen
 buffer_load_dwordx4 v[124:127], v75, s[12:15], s21 offen
 buffer_load_dwordx4 v[128:131], v76, s[12:15], s21 offen
 buffer_load_dwordx4 v[132:135], v77, s[12:15], s21 offen
 buffer_load_dwordx4 v[136:139], v78, s[12:15], s21 offen
 s_add_u32 s21, s40, 184320
 s_mul_i32 s22, s20, 15360
 s_add_u32 s22, s22, 61440
 buffer_load_dwordx4 v[140:143], v64, s[12:15], s21 offen
 buffer_load_dwordx4 v[144:147], v65, s[12:15], s21 offen
 buffer_load_dwordx4 v[148:151], v66, s[12:15], s21 offen
 buffer_load_dwordx4 v[152:155], v67, s[12:15], s21 offen
 buffer_load_dwordx4 v[156:159], v68, s[12:15], s21 offen
 buffer_load_dwordx4 v[160:163], v69, s[12:15], s21 offen
 buffer_load_dwordx4 v[164:167], v70, s[12:15], s21 offen
 buffer_load_dwordx4 v[168:171], v71, s[12:15], s21 offen
 buffer_load_dwordx4 v[172:175], v72, s[12:15], s21 offen
 buffer_load_dwordx4 v[176:179], v73, s[12:15], s21 offen
 buffer_load_dwordx4 v[180:183], v74, s[12:15], s21 offen
 buffer_load_dwordx4 v[184:187], v75, s[12:15], s21 offen
 buffer_load_dwordx4 v[188:191], v76, s[12:15], s21 offen
 buffer_load_dwordx4 v[192:195], v77, s[12:15], s21 offen
 buffer_load_dwordx4 v[196:199], v78, s[12:15], s21 offen
 v_lshrrev_b32 v6, 2, v2
 v_lshl_add_u32 v7, v3, 3, v6
 v_mul_u32_u24 v7, 1280, v7
 v_and_b32 v8, 1, v2
 v_lshl_add_u32 v7, v8, 3, v7
 v_and_b32 v8, 1, v3
 v_lshl_add_u32 v6, v8, 2, v6
 v_lshlrev_b32 v6, 1, v6
 v_bfe_u32 v8, v2, 1, 1
 s_mul_i32 s21, s20, 20
 v_add_u32 v8, s21, v8
 v_add_u32 v5, 0, v8
 v_xor_b32 v5, v5, v6
 v_lshl_add_u32 v200, v5, 4, v7
 v_add_u32 v210, 81920, v200
 v_add_u32 v5, 2, v8
 v_xor_b32 v5, v5, v6
 v_lshl_add_u32 v201, v5, 4, v7
 v_add_u32 v211, 81920, v201
 v_add_u32 v5, 4, v8
 v_xor_b32 v5, v5, v6
 v_lshl_add_u32 v202, v5, 4, v7
 v_add_u32 v212, 81920, v202
 v_add_u32 v5, 6, v8
 v_xor_b32 v5, v5, v6
 v_lshl_add_u32 v203, v5, 4, v7
 v_add_u32 v213, 81920, v203
 v_add_u32 v5, 8, v8
 v_xor_b32 v5, v5, v6
 v_lshl_add_u32 v204, v5, 4, v7
 v_add_u32 v214, 81920, v204
 v_add_u32 v5, 10, v8
 v_xor_b32 v5, v5, v6
 v_lshl_add_u32 v205, v5, 4, v7
 v_add_u32 v215, 81920, v205
 v_add_u32 v5, 12, v8
 v_xor_b32 v5, v5, v6
 v_lshl_add_u32 v206, v5, 4, v7
 v_add_u32 v216, 81920, v206
 v_add_u32 v5, 14, v8
 v_xor_b32 v5, v5, v6
 v_lshl_add_u32 v207, v5, 4, v7
 v_add_u32 v217, 81920, v207
 v_add_u32 v5, 16, v8
 v_xor_b32 v5, v5, v6
 v_lshl_add_u32 v208, v5, 4, v7
 v_add_u32 v218, 81920, v208
 v_add_u32 v5, 18, v8
 v_xor_b32 v5, v5, v6
 v_lshl_add_u32 v209, v5, 4, v7
 v_add_u32 v219, 81920, v209
 s_mul_i32 s22, s20, 15360
 v_lshl_add_u32 v30, v1, 4, s22
 v_add_u32 v31, 61440, v30
 s_waitcnt vmcnt(30)
 s_barrier
 ds_read_b64_tr_b16 a[0:1], v200 offset:0
 ds_read_b64_tr_b16 a[2:3], v200 offset:5120
 ds_read_b64_tr_b16 a[24:25], v201 offset:0
 ds_read_b64_tr_b16 a[26:27], v201 offset:5120
 ds_read_b64_tr_b16 a[48:49], v202 offset:0
 ds_read_b64_tr_b16 a[50:51], v202 offset:5120
 ds_read_b64_tr_b16 a[72:73], v203 offset:0
 ds_read_b64_tr_b16 a[74:75], v203 offset:5120
 ds_read_b64_tr_b16 a[96:97], v204 offset:0
 ds_read_b64_tr_b16 a[98:99], v204 offset:5120
 ds_read_b64_tr_b16 a[120:121], v205 offset:0
 ds_read_b64_tr_b16 a[122:123], v205 offset:5120
 ds_read_b64_tr_b16 a[144:145], v206 offset:0
 ds_read_b64_tr_b16 a[146:147], v206 offset:5120
 ds_read_b64_tr_b16 a[168:169], v207 offset:0
 ds_read_b64_tr_b16 a[170:171], v207 offset:5120
 ds_read_b64_tr_b16 a[192:193], v208 offset:0
 ds_read_b64_tr_b16 a[194:195], v208 offset:5120
 ds_read_b64_tr_b16 a[216:217], v209 offset:0
 ds_read_b64_tr_b16 a[218:219], v209 offset:5120
 ds_read_b64_tr_b16 a[4:5], v200 offset:40960
 ds_read_b64_tr_b16 a[6:7], v200 offset:46080
 ds_read_b64_tr_b16 a[28:29], v201 offset:40960
 ds_read_b64_tr_b16 a[30:31], v201 offset:46080
 ds_read_b64_tr_b16 a[52:53], v202 offset:40960
 ds_read_b64_tr_b16 a[54:55], v202 offset:46080
 ds_read_b64_tr_b16 a[76:77], v203 offset:40960
 ds_read_b64_tr_b16 a[78:79], v203 offset:46080
 ds_read_b64_tr_b16 a[100:101], v204 offset:40960
 ds_read_b64_tr_b16 a[102:103], v204 offset:46080
 ds_read_b64_tr_b16 a[124:125], v205 offset:40960
 ds_read_b64_tr_b16 a[126:127], v205 offset:46080
 ds_read_b64_tr_b16 a[148:149], v206 offset:40960
 ds_read_b64_tr_b16 a[150:151], v206 offset:46080
 ds_read_b64_tr_b16 a[172:173], v207 offset:40960
 ds_read_b64_tr_b16 a[174:175], v207 offset:46080
 ds_read_b64_tr_b16 a[196:197], v208 offset:40960
 ds_read_b64_tr_b16 a[198:199], v208 offset:46080
 ds_read_b64_tr_b16 a[220:221], v209 offset:40960
 ds_read_b64_tr_b16 a[222:223], v209 offset:46080
 ds_read_b64_tr_b16 a[8:9], v210 offset:0
 ds_read_b64_tr_b16 a[10:11], v210 offset:5120
 ds_read_b64_tr_b16 a[32:33], v211 offset:0
 ds_read_b64_tr_b16 a[34:35], v211 offset:5120
 ds_read_b64_tr_b16 a[56:57], v212 offset:0
 ds_read_b64_tr_b16 a[58:59], v212 offset:5120
 ds_read_b64_tr_b16 a[80:81], v213 offset:0
 ds_read_b64_tr_b16 a[82:83], v213 offset:5120
 ds_read_b64_tr_b16 a[104:105], v214 offset:0
 ds_read_b64_tr_b16 a[106:107], v214 offset:5120
 ds_read_b64_tr_b16 a[128:129], v215 offset:0
 ds_read_b64_tr_b16 a[130:131], v215 offset:5120
 ds_read_b64_tr_b16 a[152:153], v216 offset:0
 ds_read_b64_tr_b16 a[154:155], v216 offset:5120
 ds_read_b64_tr_b16 a[176:177], v217 offset:0
 ds_read_b64_tr_b16 a[178:179], v217 offset:5120
 ds_read_b64_tr_b16 a[200:201], v218 offset:0
 ds_read_b64_tr_b16 a[202:203], v218 offset:5120
 ds_read_b64_tr_b16 a[224:225], v219 offset:0
 ds_read_b64_tr_b16 a[226:227], v219 offset:5120
 s_waitcnt lgkmcnt(0)
 s_barrier
 s_waitcnt vmcnt(15)
 ds_write_b128 v30, v[80:83] offset:0
 ds_write_b128 v30, v[84:87] offset:1024
 ds_write_b128 v30, v[88:91] offset:2048
 ds_write_b128 v30, v[92:95] offset:3072
 ds_write_b128 v30, v[96:99] offset:4096
 ds_write_b128 v30, v[100:103] offset:5120
 ds_write_b128 v30, v[104:107] offset:6144
 ds_write_b128 v30, v[108:111] offset:7168
 ds_write_b128 v30, v[112:115] offset:8192
 ds_write_b128 v30, v[116:119] offset:9216
 ds_write_b128 v30, v[120:123] offset:10240
 ds_write_b128 v30, v[124:127] offset:11264
 ds_write_b128 v30, v[128:131] offset:12288
 ds_write_b128 v30, v[132:135] offset:13312
 ds_write_b128 v30, v[136:139] offset:14336
 s_waitcnt vmcnt(0)
 ds_write_b128 v31, v[140:143] offset:0
 ds_write_b128 v31, v[144:147] offset:1024
 ds_write_b128 v31, v[148:151] offset:2048
 ds_write_b128 v31, v[152:155] offset:3072
 ds_write_b128 v31, v[156:159] offset:4096
 ds_write_b128 v31, v[160:163] offset:5120
 ds_write_b128 v31, v[164:167] offset:6144
 ds_write_b128 v31, v[168:171] offset:7168
 ds_write_b128 v31, v[172:175] offset:8192
 ds_write_b128 v31, v[176:179] offset:9216
 ds_write_b128 v31, v[180:183] offset:10240
 ds_write_b128 v31, v[184:187] offset:11264
 ds_write_b128 v31, v[188:191] offset:12288
 ds_write_b128 v31, v[192:195] offset:13312
 ds_write_b128 v31, v[196:199] offset:14336
 s_waitcnt lgkmcnt(0)
 s_barrier
 ds_read_b64_tr_b16 a[12:13], v200 offset:0
 ds_read_b64_tr_b16 a[14:15], v200 offset:5120
 ds_read_b64_tr_b16 a[36:37], v201 offset:0
 ds_read_b64_tr_b16 a[38:39], v201 offset:5120
 ds_read_b64_tr_b16 a[60:61], v202 offset:0
 ds_read_b64_tr_b16 a[62:63], v202 offset:5120
 ds_read_b64_tr_b16 a[84:85], v203 offset:0
 ds_read_b64_tr_b16 a[86:87], v203 offset:5120
 ds_read_b64_tr_b16 a[108:109], v204 offset:0
 ds_read_b64_tr_b16 a[110:111], v204 offset:5120
 ds_read_b64_tr_b16 a[132:133], v205 offset:0
 ds_read_b64_tr_b16 a[134:135], v205 offset:5120
 ds_read_b64_tr_b16 a[156:157], v206 offset:0
 ds_read_b64_tr_b16 a[158:159], v206 offset:5120
 ds_read_b64_tr_b16 a[180:181], v207 offset:0
 ds_read_b64_tr_b16 a[182:183], v207 offset:5120
 ds_read_b64_tr_b16 a[204:205], v208 offset:0
 ds_read_b64_tr_b16 a[206:207], v208 offset:5120
 ds_read_b64_tr_b16 a[228:229], v209 offset:0
 ds_read_b64_tr_b16 a[230:231], v209 offset:5120
 ds_read_b64_tr_b16 a[16:17], v200 offset:40960
 ds_read_b64_tr_b16 a[18:19], v200 offset:46080
 ds_read_b64_tr_b16 a[40:41], v201 offset:40960
 ds_read_b64_tr_b16 a[42:43], v201 offset:46080
 ds_read_b64_tr_b16 a[64:65], v202 offset:40960
 ds_read_b64_tr_b16 a[66:67], v202 offset:46080
 ds_read_b64_tr_b16 a[88:89], v203 offset:40960
 ds_read_b64_tr_b16 a[90:91], v203 offset:46080
 ds_read_b64_tr_b16 a[112:113], v204 offset:40960
 ds_read_b64_tr_b16 a[114:115], v204 offset:46080
 ds_read_b64_tr_b16 a[136:137], v205 offset:40960
 ds_read_b64_tr_b16 a[138:139], v205 offset:46080
 ds_read_b64_tr_b16 a[160:161], v206 offset:40960
 ds_read_b64_tr_b16 a[162:163], v206 offset:46080
 ds_read_b64_tr_b16 a[184:185], v207 offset:40960
 ds_read_b64_tr_b16 a[186:187], v207 offset:46080
 ds_read_b64_tr_b16 a[208:209], v208 offset:40960
 ds_read_b64_tr_b16 a[210:211], v208 offset:46080
 ds_read_b64_tr_b16 a[232:233], v209 offset:40960
 ds_read_b64_tr_b16 a[234:235], v209 offset:46080
 ds_read_b64_tr_b16 a[20:21], v210 offset:0
 ds_read_b64_tr_b16 a[22:23], v210 offset:5120
 ds_read_b64_tr_b16 a[44:45], v211 offset:0
 ds_read_b64_tr_b16 a[46:47], v211 offset:5120
 ds_read_b64_tr_b16 a[68:69], v212 offset:0
 ds_read_b64_tr_b16 a[70:71], v212 offset:5120
 ds_read_b64_tr_b16 a[92:93], v213 offset:0
 ds_read_b64_tr_b16 a[94:95], v213 offset:5120
 ds_read_b64_tr_b16 a[116:117], v214 offset:0
 ds_read_b64_tr_b16 a[118:119], v214 offset:5120
 ds_read_b64_tr_b16 a[140:141], v215 offset:0
 ds_read_b64_tr_b16 a[142:143], v215 offset:5120
 ds_read_b64_tr_b16 a[164:165], v216 offset:0
 ds_read_b64_tr_b16 a[166:167], v216 offset:5120
 ds_read_b64_tr_b16 a[188:189], v217 offset:0
 ds_read_b64_tr_b16 a[190:191], v217 offset:5120
 ds_read_b64_tr_b16 a[212:213], v218 offset:0
 ds_read_b64_tr_b16 a[214:215], v218 offset:5120
 ds_read_b64_tr_b16 a[236:237], v219 offset:0
 ds_read_b64_tr_b16 a[238:239], v219 offset:5120
 s_waitcnt lgkmcnt(0)
 s_barrier
 s_load_dwordx2 s[32:33], s[0:1], 96
 s_waitcnt lgkmcnt(0)
 s_mov_b32 s32, s32
 s_mov_b32 s33, s33
 s_mov_b32 s34, 256
 s_mov_b32 s35, 0x00020000
 s_mov_b32 s21, 76
 s_cmp_lg_u32 s20, 0
 s_cbranch_scc1 wf_140
 v_mov_b32 v4, 0
 s_mov_b32 s101, 0
wf_139:
 buffer_load_dword v5, v4, s[32:35], s21 offen sc1
 s_add_u32 s101, s101, 1
 s_cmp_gt_u32 s101, 131072
 s_cbranch_scc1 main_end
 s_waitcnt vmcnt(0)
 v_readfirstlane_b32 s100, v5
 s_cmp_ge_u32 s100, 32
 s_cbranch_scc1 wf_140
 s_sleep 8
 s_branch wf_139
wf_140:
 s_barrier
 s_mov_b32 s21, 84
 v_mov_b32 v4, 0
 s_mov_b32 s101, 0
wf_141:
 buffer_load_dword v5, v4, s[32:35], s21 offen sc1
 s_add_u32 s101, s101, 1
 s_cmp_gt_u32 s101, 131072
 s_cbranch_scc1 main_end
 s_waitcnt vmcnt(0)
 v_readfirstlane_b32 s100, v5
 s_cmp_ge_u32 s100, 1
 s_cbranch_scc1 wf_142
 s_sleep 8
 s_branch wf_141
wf_142:
 s_add_u32 s37, s38, 83886079
 s_add_u32 s21, s38, 180355072
 s_xor_b32 s37, s37, s21
 s_lshr_b32 s37, s37, 21
 s_xor_b32 s37, s37, s100
 s_xor_b32 s37, s37, 0
 s_and_b32 s37, s37, 1
 s_lshl_b32 s37, s37, 13
 s_mul_i32 s41, s2, 12288
 s_add_u32 s47, s41, 25165824
 s_mov_b32 s41, s47
 s_mul_i32 s21, s20, 10
 s_mul_i32 s47, s2, 5
 s_lshr_b32 s22, s21, 3
 s_add_u32 s47, s47, s22
 s_and_b32 s48, s21, 7
 s_mov_b32 s66, 0
 s_mov_b32 s67, 0
 s_lshr_b32 s43, s2, 2
 s_lshl_b32 s43, s43, 7
 s_add_u32 s43, s43, 0
 s_lshl_b32 s44, s2, 7
 s_lshl_b32 s21, s20, 12
 s_add_u32 s44, s44, s21
 s_add_u32 s44, s44, 95232
 s_mov_b32 s45, 0
 s_mov_b32 s49, 1
 s_mov_b32 s50, 0
 v_mov_b32 v10, 0
 v_mov_b32 v11, 1
 v_lshlrev_b32 v4, 4, v1
 s_add_u32 s76, s38, 56623104
 s_addc_u32 s77, s39, 0
 s_mov_b32 s78, 6291456
 s_mov_b32 s79, 0x00020000
 s_add_u32 s80, s38, 101711872
 s_addc_u32 s81, s39, 0
 s_mov_b32 s82, 20971520
 s_mov_b32 s83, 0x00020000
 v_and_b32 v12, 3, v1
 v_lshlrev_b32 v12, 3, v12
 v_add_u32 v12, 4, v12
 v_and_b32 v13, 7, v2
 v_lshlrev_b32 v13, 4, v13
 v_lshl_add_u32 v13, v3, 7, v13
 v_lshrrev_b32 v14, 3, v2
 v_mul_u32_u24 v14, 98304, v14
 v_add_u32 v14, v14, v13
 v_and_b32 v15, 1, v3
 v_lshlrev_b32 v15, 8, v15
 v_lshl_add_u32 v15, v2, 4, v15
 v_lshrrev_b32 v16, 1, v3
 v_mul_u32_u24 v16, 327680, v16
 v_add_u32 v15, v15, v16
 v_lshlrev_b32 v17, 10, v1
 v_mov_b32 v19, 0
 s_lshl_b32 s53, s2, 7
 s_add_u32 s53, s53, 19456
 s_mov_b32 s55, 0
 s_mov_b32 s56, 0
 s_mov_b32 s58, 0
 s_mov_b32 s59, 0
 s_add_u32 s84, s38, 50331648
 s_addc_u32 s85, s39, 0
 s_mov_b32 s86, 12582912
 s_mov_b32 s87, 0x00020000
 s_and_b32 s21, s2, 3
 s_mul_i32 s51, s2, 3072
 s_cmp_eq_u32 s21, s20
 s_cselect_b32 s51, s51, 6291456
 v_mov_b32 v244, -1
 v_mov_b32 v245, -1
 v_mov_b32 v246, -1
 v_mov_b32 v247, -1
 s_add_u32 s88, s38, 180355072
 s_addc_u32 s89, s39, 0
 s_mov_b32 s90, 67108864
 s_mov_b32 s91, 0x00020000
 s_mul_i32 s21, s20, 3072
 s_add_u32 s41, s41, s21
 s_mov_b32 s64, s21
 s_add_u32 s67, s21, 98304
 s_mov_b32 s71, s21
 s_mov_b32 s46, 0
 s_mov_b32 s47, 0
 s_mov_b32 s65, 0
 s_mul_i32 s42, s2, 40960
 s_mul_i32 s21, s20, 10240
 s_add_u32 s42, s42, s21
 s_mov_b32 s68, 0x80000000
 s_mov_b32 s70, 0
 s_mov_b32 s40, 0
 s_mov_b32 s31, 0
 s_mov_b32 s56, s68
 s_mov_b32 s57, s68
 s_lshl_b32 s59, s20, 1
 s_sub_u32 s59, 8, s59
 s_add_u32 s61, s28, 9216
 v_min_u32 v5, 18, v1
 v_lshlrev_b32 v5, 10, v5
 v_mov_b32 v9, 0
 s_lshl_b32 s21, s20, 2
 s_add_u32 s21, s21, 110592
 v_mov_b32 v6, s21
 v_mov_b32 v7, 110592
 s_mul_i32 s51, s2, 3072
 s_lshl_b32 s21, s20, 10
 s_add_u32 s51, s51, s21
 s_cmp_lt_u32 s20, 3
 s_cselect_b32 s51, s51, 6291456
 s_add_u32 s51, s51, 5111808
 s_cmp_lg_u32 s20, 0
 s_cbranch_scc1 wf_144
 v_mov_b32 v20, 0
 s_mov_b32 s101, 0
wf_143:
 buffer_load_dword v21, v20, s[72:75], s43 offen sc1
 s_add_u32 s101, s101, 1
 s_cmp_gt_u32 s101, 131072
 s_cbranch_scc1 main_end
 s_waitcnt vmcnt(0)
 v_readfirstlane_b32 s100, v21
 s_cmp_ge_u32 s100, 8
 s_cbranch_scc1 wf_144
 s_sleep 4
 s_branch wf_143
wf_144:
 s_barrier
 v_writelane_b32 v9, 8, 0
 v_cmp_gt_u32 vcc, 8, v9
 s_nop 0
 s_bitset1_b64 vcc, 19
 s_ff1_i32_b64 s21, vcc
 s_lshl_b32 s22, s21, 1
 s_lshl_b32 s21, s21, 2
 s_sub_i32 s21, s21, 12
 s_max_i32 s47, s21, s22
 s_cmp_gt_u32 s47, s45
 s_cbranch_scc1 va_145
 s_mov_b32 s101, 0
 s_branch va_148
va_146:
 s_sleep 8
va_148:
 buffer_load_dword v9, v5, s[72:75], s43 offen sc1
 s_add_u32 s101, s101, 1
 s_cmp_gt_u32 s101, 131072
 s_cbranch_scc1 main_end
 s_waitcnt vmcnt(0)
 v_cmp_gt_u32 vcc, 8, v9
 s_nop 0
 s_bitset1_b64 vcc, 19
 s_ff1_i32_b64 s21, vcc
 s_lshl_b32 s22, s21, 1
 s_lshl_b32 s21, s21, 2
 s_sub_i32 s21, s21, 12
 s_max_i32 s47, s21, s22
 s_cmp_gt_u32 s47, s45
 s_cbranch_scc0 va_146
va_145:
 s_add_u32 s22, s45, 6
 s_min_u32 s22, s22, s47
va_147:
 s_cmp_ge_u32 s46, s22
 s_cbranch_scc1 va_149
 s_mov_b32 m0, s64
 s_mov_b32 s66, s41
 buffer_load_dwordx4 v4, s[16:19], s66 offen offset:0 sc1 lds
 buffer_load_dwordx4 v4, s[16:19], s66 offen offset:1024 sc1 lds
 buffer_load_dwordx4 v4, s[16:19], s66 offen offset:2048 sc1 lds
 s_add_u32 s46, s46, 1
 s_add_u32 s41, s41, 393216
 s_add_u32 s64, s64, 12288
 s_cmp_lt_u32 s64, s67
 s_cselect_b32 s64, s64, s71
 s_branch va_147
va_149:
 s_mov_b32 s48, s46
 s_mov_b32 s49, s46
 s_mov_b32 s50, s46
 s_waitcnt vmcnt(0)
 s_barrier
 v_mov_b32 v8, v4
 s_add_u32 s65, s65, 12288
 s_cmp_lt_u32 s65, 98304
 s_cselect_b32 s65, s65, 0
 ds_read_b128 v[144:147], v8 offset:0
 ds_read_b128 v[148:151], v8 offset:1024
 ds_read_b128 v[152:155], v8 offset:2048
 ds_read_b128 v[156:159], v8 offset:3072
 ds_read_b128 v[160:163], v8 offset:4096
 ds_read_b128 v[164:167], v8 offset:5120
 ds_read_b128 v[168:171], v8 offset:6144
 ds_read_b128 v[172:175], v8 offset:7168
 ds_read_b128 v[176:179], v8 offset:8192
 ds_read_b128 v[180:183], v8 offset:9216
 ds_read_b128 v[184:187], v8 offset:10240
 ds_read_b128 v[188:191], v8 offset:11264
vwl_150:
 s_waitcnt lgkmcnt(0)
 v_mfma_f32_16x16x32_bf16 v[64:67], v[144:147], a[0:3], 0
 v_cmp_gt_u32 vcc, 8, v9
 s_nop 0
 v_mfma_f32_16x16x32_bf16 v[72:75], v[144:147], a[24:27], 0
 s_bitset1_b64 vcc, 19
 s_ff1_i32_b64 s21, vcc
 v_mfma_f32_16x16x32_bf16 v[80:83], v[144:147], a[48:51], 0
 s_lshl_b32 s22, s21, 1
 s_lshl_b32 s21, s21, 2
 v_mfma_f32_16x16x32_bf16 v[88:91], v[144:147], a[72:75], 0
 s_sub_i32 s21, s21, 12
 s_max_i32 s47, s21, s22
 v_mfma_f32_16x16x32_bf16 v[96:99], v[144:147], a[96:99], 0
 s_add_u32 s22, s45, 7
 s_min_u32 s22, s22, s47
 v_mfma_f32_16x16x32_bf16 v[68:71], v[168:171], a[0:3], 0
 s_cmp_lt_u32 s46, s22
 s_cselect_b32 s66, s41, 0x80000000
 s_cselect_b32 m0, s64, 98304
 s_cselect_b32 s22, 1, 0
 v_mfma_f32_16x16x32_bf16 v[76:79], v[168:171], a[24:27], 0
 buffer_load_dwordx4 v4, s[16:19], s66 offen offset:0 sc1 lds
 v_mfma_f32_16x16x32_bf16 v[84:87], v[168:171], a[48:51], 0
 v_add_u32 v8, s65, v4
 s_add_u32 s65, s65, 12288
 v_mfma_f32_16x16x32_bf16 v[92:95], v[168:171], a[72:75], 0
 buffer_load_dwordx4 v4, s[16:19], s66 offen offset:1024 sc1 lds
 v_mfma_f32_16x16x32_bf16 v[100:103], v[168:171], a[96:99], 0
 s_cmp_lt_u32 s65, 98304
 s_cselect_b32 s65, s65, 0
 v_mfma_f32_16x16x32_bf16 v[64:67], v[148:151], a[4:7], v[64:67]
 buffer_load_dwordx4 v4, s[16:19], s66 offen offset:2048 sc1 lds
 v_mfma_f32_16x16x32_bf16 v[72:75], v[148:151], a[28:31], v[72:75]
 s_add_u32 s46, s46, s22
 s_mul_i32 s21, s22, 393216
 v_mfma_f32_16x16x32_bf16 v[80:83], v[148:151], a[52:55], v[80:83]
 s_add_u32 s41, s41, s21
 s_mul_i32 s21, s22, 12288
 v_mfma_f32_16x16x32_bf16 v[88:91], v[148:151], a[76:79], v[88:91]
 s_add_u32 s64, s64, s21
 v_cvt_pk_bf16_f32 v44, v104, v105
 v_mfma_f32_16x16x32_bf16 v[96:99], v[148:151], a[100:103], v[96:99]
 s_cmp_lt_u32 s64, s67
 s_cselect_b32 s64, s64, s71
 v_mfma_f32_16x16x32_bf16 v[68:71], v[172:175], a[4:7], v[68:71]
 v_cvt_pk_bf16_f32 v45, v106, v107
 v_cvt_pk_bf16_f32 v46, v108, v109
 v_mfma_f32_16x16x32_bf16 v[76:79], v[172:175], a[28:31], v[76:79]
 v_cvt_pk_bf16_f32 v47, v110, v111
 v_mfma_f32_16x16x32_bf16 v[84:87], v[172:175], a[52:55], v[84:87]
 s_add_u32 s69, s68, 4096
 v_mfma_f32_16x16x32_bf16 v[92:95], v[172:175], a[76:79], v[92:95]
 v_mfma_f32_16x16x32_bf16 v[100:103], v[172:175], a[100:103], v[100:103]
 buffer_store_dwordx4 v[44:47], v4, s[24:27], s69 offen offset:1024 sc1
 v_mfma_f32_16x16x32_bf16 v[64:67], v[152:155], a[8:11], v[64:67]
 v_mfma_f32_16x16x32_bf16 v[72:75], v[152:155], a[32:35], v[72:75]
 v_cvt_pk_bf16_f32 v48, v112, v113
 v_mfma_f32_16x16x32_bf16 v[80:83], v[152:155], a[56:59], v[80:83]
 v_cvt_pk_bf16_f32 v49, v114, v115
 v_mfma_f32_16x16x32_bf16 v[88:91], v[152:155], a[80:83], v[88:91]
 v_mfma_f32_16x16x32_bf16 v[96:99], v[152:155], a[104:107], v[96:99]
 v_cvt_pk_bf16_f32 v50, v116, v117
 v_mfma_f32_16x16x32_bf16 v[68:71], v[176:179], a[8:11], v[68:71]
 v_mfma_f32_16x16x32_bf16 v[76:79], v[176:179], a[32:35], v[76:79]
 v_cvt_pk_bf16_f32 v51, v118, v119
 v_mfma_f32_16x16x32_bf16 v[84:87], v[176:179], a[56:59], v[84:87]
 buffer_store_dwordx4 v[48:51], v4, s[24:27], s69 offen offset:2048 sc1
 v_mfma_f32_16x16x32_bf16 v[92:95], v[176:179], a[80:83], v[92:95]
 v_mfma_f32_16x16x32_bf16 v[100:103], v[176:179], a[104:107], v[100:103]
 v_cvt_pk_bf16_f32 v52, v120, v121
 v_mfma_f32_16x16x32_bf16 v[64:67], v[156:159], a[12:15], v[64:67]
 v_mfma_f32_16x16x32_bf16 v[72:75], v[156:159], a[36:39], v[72:75]
 v_cvt_pk_bf16_f32 v53, v122, v123
 v_mfma_f32_16x16x32_bf16 v[80:83], v[156:159], a[60:63], v[80:83]
 v_cvt_pk_bf16_f32 v54, v124, v125
 v_mfma_f32_16x16x32_bf16 v[88:91], v[156:159], a[84:87], v[88:91]
 v_mfma_f32_16x16x32_bf16 v[96:99], v[156:159], a[108:111], v[96:99]
 v_cvt_pk_bf16_f32 v55, v126, v127
 v_mfma_f32_16x16x32_bf16 v[68:71], v[180:183], a[12:15], v[68:71]
 v_mfma_f32_16x16x32_bf16 v[76:79], v[180:183], a[36:39], v[76:79]
 buffer_store_dwordx4 v[52:55], v4, s[24:27], s69 offen offset:3072 sc1
 v_mfma_f32_16x16x32_bf16 v[84:87], v[180:183], a[60:63], v[84:87]
 v_cvt_pk_bf16_f32 v56, v128, v129
 v_mfma_f32_16x16x32_bf16 v[92:95], v[180:183], a[84:87], v[92:95]
 v_mfma_f32_16x16x32_bf16 v[100:103], v[180:183], a[108:111], v[100:103]
 v_cvt_pk_bf16_f32 v57, v130, v131
 v_mfma_f32_16x16x32_bf16 v[64:67], v[160:163], a[16:19], v[64:67]
 v_mfma_f32_16x16x32_bf16 v[72:75], v[160:163], a[40:43], v[72:75]
 v_cvt_pk_bf16_f32 v58, v132, v133
 v_mfma_f32_16x16x32_bf16 v[80:83], v[160:163], a[64:67], v[80:83]
 v_cvt_pk_bf16_f32 v59, v134, v135
 v_mfma_f32_16x16x32_bf16 v[88:91], v[160:163], a[88:91], v[88:91]
 v_mfma_f32_16x16x32_bf16 v[96:99], v[160:163], a[112:115], v[96:99]
 s_add_u32 s69, s68, 8192
 v_mfma_f32_16x16x32_bf16 v[68:71], v[184:187], a[16:19], v[68:71]
 v_mfma_f32_16x16x32_bf16 v[76:79], v[184:187], a[40:43], v[76:79]
 buffer_store_dwordx4 v[56:59], v4, s[24:27], s69 offen offset:0 sc1
 v_mfma_f32_16x16x32_bf16 v[84:87], v[184:187], a[64:67], v[84:87]
 v_cvt_pk_bf16_f32 v60, v136, v137
 v_mfma_f32_16x16x32_bf16 v[92:95], v[184:187], a[88:91], v[92:95]
 v_mfma_f32_16x16x32_bf16 v[100:103], v[184:187], a[112:115], v[100:103]
 v_cvt_pk_bf16_f32 v61, v138, v139
 v_mfma_f32_16x16x32_bf16 v[64:67], v[164:167], a[20:23], v[64:67]
 v_mfma_f32_16x16x32_bf16 v[72:75], v[164:167], a[44:47], v[72:75]
 v_cvt_pk_bf16_f32 v62, v140, v141
 v_mfma_f32_16x16x32_bf16 v[80:83], v[164:167], a[68:71], v[80:83]
 v_cvt_pk_bf16_f32 v63, v142, v143
 v_mfma_f32_16x16x32_bf16 v[88:91], v[164:167], a[92:95], v[88:91]
 v_mfma_f32_16x16x32_bf16 v[96:99], v[164:167], a[116:119], v[96:99]
 buffer_store_dwordx4 v[60:63], v4, s[24:27], s69 offen offset:1024 sc1
 v_mfma_f32_16x16x32_bf16 v[68:71], v[188:191], a[20:23], v[68:71]
 v_mfma_f32_16x16x32_bf16 v[76:79], v[188:191], a[44:47], v[76:79]
 v_mfma_f32_16x16x32_bf16 v[84:87], v[188:191], a[68:71], v[84:87]
 v_mfma_f32_16x16x32_bf16 v[92:95], v[188:191], a[92:95], v[92:95]
 v_mfma_f32_16x16x32_bf16 v[100:103], v[188:191], a[116:119], v[100:103]
 v_mfma_f32_16x16x32_bf16 v[104:107], v[144:147], a[120:123], 0
 buffer_load_dword v9, v5, s[72:75], s43 offen sc1
 v_mfma_f32_16x16x32_bf16 v[112:115], v[144:147], a[144:147], 0
 v_mfma_f32_16x16x32_bf16 v[120:123], v[144:147], a[168:171], 0
 v_mfma_f32_16x16x32_bf16 v[128:131], v[144:147], a[192:195], 0
 v_cvt_pk_bf16_f32 v24, v64, v65
 v_mfma_f32_16x16x32_bf16 v[136:139], v[144:147], a[216:219], 0
 s_add_u32 s63, s45, 1
 s_min_u32 s63, s63, 63
 v_mfma_f32_16x16x32_bf16 v[108:111], v[168:171], a[120:123], 0
 s_cmp_lt_u32 s63, s46
 s_cselect_b32 s53, 1, 0
 v_mfma_f32_16x16x32_bf16 v[116:119], v[168:171], a[144:147], 0
 v_mov_b32 v21, s53
 ds_write_b32 v6, v21 offset:0
 v_mfma_f32_16x16x32_bf16 v[124:127], v[168:171], a[168:171], 0
 v_cvt_pk_bf16_f32 v25, v66, v67
 v_cvt_pk_bf16_f32 v26, v68, v69
 v_mfma_f32_16x16x32_bf16 v[132:135], v[168:171], a[192:195], 0
 v_cvt_pk_bf16_f32 v27, v70, v71
 v_mfma_f32_16x16x32_bf16 v[140:143], v[168:171], a[216:219], 0
 v_mfma_f32_16x16x32_bf16 v[104:107], v[148:151], a[124:127], v[104:107]
 buffer_store_dwordx4 v[24:27], v4, s[24:27], s42 offen offset:0 sc1
 v_mfma_f32_16x16x32_bf16 v[112:115], v[148:151], a[148:151], v[112:115]
 v_cvt_pk_bf16_f32 v28, v72, v73
 v_mfma_f32_16x16x32_bf16 v[120:123], v[148:151], a[172:175], v[120:123]
 s_cmp_eq_u32 s40, 3
 s_cbranch_scc1 vwm_154
vwm_155:
 v_mfma_f32_16x16x32_bf16 v[128:131], v[148:151], a[196:199], v[128:131]
 v_cvt_pk_bf16_f32 v29, v74, v75
 v_mfma_f32_16x16x32_bf16 v[136:139], v[148:151], a[220:223], v[136:139]
 v_mfma_f32_16x16x32_bf16 v[108:111], v[172:175], a[124:127], v[108:111]
 v_cvt_pk_bf16_f32 v30, v76, v77
 v_mfma_f32_16x16x32_bf16 v[116:119], v[172:175], a[148:151], v[116:119]
 v_mfma_f32_16x16x32_bf16 v[124:127], v[172:175], a[172:175], v[124:127]
 v_cvt_pk_bf16_f32 v31, v78, v79
 v_mfma_f32_16x16x32_bf16 v[132:135], v[172:175], a[196:199], v[132:135]
 buffer_store_dwordx4 v[28:31], v4, s[24:27], s42 offen offset:1024 sc1
 v_mfma_f32_16x16x32_bf16 v[140:143], v[172:175], a[220:223], v[140:143]
 s_cmp_lt_u32 s63, s50
 s_cbranch_scc0 vwx_152
vwx_153:
 v_mfma_f32_16x16x32_bf16 v[104:107], v[152:155], a[128:131], v[104:107]
 s_waitcnt lgkmcnt(0)
 s_barrier
 v_mfma_f32_16x16x32_bf16 v[112:115], v[152:155], a[152:155], v[112:115]
 ds_read_b128 v[240:243], v7 offset:0
 v_cvt_pk_bf16_f32 v32, v80, v81
 v_mfma_f32_16x16x32_bf16 v[120:123], v[152:155], a[176:179], v[120:123]
 ds_read_b128 v[192:195], v8 offset:0
 v_cvt_pk_bf16_f32 v33, v82, v83
 v_mfma_f32_16x16x32_bf16 v[128:131], v[152:155], a[200:203], v[128:131]
 v_mfma_f32_16x16x32_bf16 v[136:139], v[152:155], a[224:227], v[136:139]
 ds_read_b128 v[196:199], v8 offset:1024
 v_cvt_pk_bf16_f32 v34, v84, v85
 v_mfma_f32_16x16x32_bf16 v[108:111], v[176:179], a[128:131], v[108:111]
 v_mfma_f32_16x16x32_bf16 v[116:119], v[176:179], a[152:155], v[116:119]
 v_cvt_pk_bf16_f32 v35, v86, v87
 v_mfma_f32_16x16x32_bf16 v[124:127], v[176:179], a[176:179], v[124:127]
 ds_read_b128 v[200:203], v8 offset:2048
 v_mfma_f32_16x16x32_bf16 v[132:135], v[176:179], a[200:203], v[132:135]
 buffer_store_dwordx4 v[32:35], v4, s[24:27], s42 offen offset:2048 sc1
 v_mfma_f32_16x16x32_bf16 v[140:143], v[176:179], a[224:227], v[140:143]
 ds_read_b128 v[204:207], v8 offset:3072
 v_cvt_pk_bf16_f32 v36, v88, v89
 v_mfma_f32_16x16x32_bf16 v[104:107], v[156:159], a[132:135], v[104:107]
 v_mfma_f32_16x16x32_bf16 v[112:115], v[156:159], a[156:159], v[112:115]
 v_cvt_pk_bf16_f32 v37, v90, v91
 v_mfma_f32_16x16x32_bf16 v[120:123], v[156:159], a[180:183], v[120:123]
 ds_read_b128 v[208:211], v8 offset:4096
 v_mfma_f32_16x16x32_bf16 v[128:131], v[156:159], a[204:207], v[128:131]
 v_cvt_pk_bf16_f32 v38, v92, v93
 v_mfma_f32_16x16x32_bf16 v[136:139], v[156:159], a[228:231], v[136:139]
 ds_read_b128 v[212:215], v8 offset:5120
 s_waitcnt lgkmcnt(4)
 v_mfma_f32_16x16x32_bf16 v[108:111], v[180:183], a[132:135], v[108:111]
 v_bitop3_b32 v240, v240, v241, v242 bitop3:0x80
 v_and_b32 v240, v240, v243
 v_mfma_f32_16x16x32_bf16 v[116:119], v[180:183], a[156:159], v[116:119]
 s_nop 0
 v_readfirstlane_b32 s23, v240
 v_mfma_f32_16x16x32_bf16 v[124:127], v[180:183], a[180:183], v[124:127]
 ds_read_b128 v[216:219], v8 offset:6144
 v_cvt_pk_bf16_f32 v39, v94, v95
 v_mfma_f32_16x16x32_bf16 v[132:135], v[180:183], a[204:207], v[132:135]
 buffer_store_dwordx4 v[36:39], v4, s[24:27], s42 offen offset:3072 sc1
 v_mfma_f32_16x16x32_bf16 v[140:143], v[180:183], a[228:231], v[140:143]
 ds_read_b128 v[220:223], v8 offset:7168
 v_cvt_pk_bf16_f32 v40, v96, v97
 v_mfma_f32_16x16x32_bf16 v[104:107], v[160:163], a[136:139], v[104:107]
 v_cvt_pk_bf16_f32 v41, v98, v99
 v_mfma_f32_16x16x32_bf16 v[112:115], v[160:163], a[160:163], v[112:115]
 v_cvt_pk_bf16_f32 v42, v100, v101
 v_mfma_f32_16x16x32_bf16 v[120:123], v[160:163], a[184:187], v[120:123]
 ds_read_b128 v[224:227], v8 offset:8192
 v_mfma_f32_16x16x32_bf16 v[128:131], v[160:163], a[208:211], v[128:131]
 v_cvt_pk_bf16_f32 v43, v102, v103
 v_mfma_f32_16x16x32_bf16 v[136:139], v[160:163], a[232:235], v[136:139]
 ds_read_b128 v[228:231], v8 offset:9216
 v_mfma_f32_16x16x32_bf16 v[108:111], v[184:187], a[136:139], v[108:111]
 s_add_u32 s69, s42, 4096
 v_mfma_f32_16x16x32_bf16 v[116:119], v[184:187], a[160:163], v[116:119]
 v_mfma_f32_16x16x32_bf16 v[124:127], v[184:187], a[184:187], v[124:127]
 ds_read_b128 v[232:235], v8 offset:10240
 v_mfma_f32_16x16x32_bf16 v[132:135], v[184:187], a[208:211], v[132:135]
 buffer_store_dwordx4 v[40:43], v4, s[24:27], s69 offen offset:0 sc1
 v_mfma_f32_16x16x32_bf16 v[140:143], v[184:187], a[232:235], v[140:143]
 ds_read_b128 v[236:239], v8 offset:11264
 v_mfma_f32_16x16x32_bf16 v[104:107], v[164:167], a[140:143], v[104:107]
 v_mfma_f32_16x16x32_bf16 v[112:115], v[164:167], a[164:167], v[112:115]
 v_mfma_f32_16x16x32_bf16 v[120:123], v[164:167], a[188:191], v[120:123]
 s_waitcnt vmcnt(11)
 s_mov_b32 s50, s46
 s_add_u32 s69, s45, s40
 v_mfma_f32_16x16x32_bf16 v[128:131], v[164:167], a[212:215], v[128:131]
 s_mov_b32 s40, 0
 s_sub_i32 s69, s69, 1
 s_max_i32 s69, s69, s70
 v_mfma_f32_16x16x32_bf16 v[136:139], v[164:167], a[236:239], v[136:139]
 s_add_u32 s45, s45, 1
 s_mov_b32 s68, s42
 s_add_u32 s42, s42, 1310720
 v_mfma_f32_16x16x32_bf16 v[108:111], v[188:191], a[140:143], v[108:111]
 v_mfma_f32_16x16x32_bf16 v[116:119], v[188:191], a[164:167], v[116:119]
 v_mfma_f32_16x16x32_bf16 v[124:127], v[188:191], a[188:191], v[124:127]
 v_mfma_f32_16x16x32_bf16 v[132:135], v[188:191], a[212:215], v[132:135]
 v_mfma_f32_16x16x32_bf16 v[140:143], v[188:191], a[236:239], v[140:143]
 s_mov_b64 exec, 1
 v_mov_b32 v20, s69
 buffer_store_dword v20, v10, s[72:75], s44 offen sc1
 s_mov_b64 exec, -1
 s_cmp_le_u32 s45, 16
 s_cbranch_scc1 vwe_158
vwe_159:
 s_cmp_eq_u32 s23, 0
 s_cbranch_scc1 vws_156
vwb_157:
 s_waitcnt lgkmcnt(0)
 v_mfma_f32_16x16x32_bf16 v[64:67], v[192:195], a[0:3], 0
 v_cmp_gt_u32 vcc, 8, v9
 s_nop 0
 v_mfma_f32_16x16x32_bf16 v[72:75], v[192:195], a[24:27], 0
 s_bitset1_b64 vcc, 19
 s_ff1_i32_b64 s21, vcc
 v_mfma_f32_16x16x32_bf16 v[80:83], v[192:195], a[48:51], 0
 s_lshl_b32 s22, s21, 1
 s_lshl_b32 s21, s21, 2
 v_mfma_f32_16x16x32_bf16 v[88:91], v[192:195], a[72:75], 0
 s_sub_i32 s21, s21, 12
 s_max_i32 s47, s21, s22
 v_mfma_f32_16x16x32_bf16 v[96:99], v[192:195], a[96:99], 0
 s_add_u32 s22, s45, 7
 s_min_u32 s22, s22, s47
 v_mfma_f32_16x16x32_bf16 v[68:71], v[216:219], a[0:3], 0
 s_cmp_lt_u32 s46, s22
 s_cselect_b32 s66, s41, 0x80000000
 s_cselect_b32 m0, s64, 98304
 s_cselect_b32 s22, 1, 0
 v_mfma_f32_16x16x32_bf16 v[76:79], v[216:219], a[24:27], 0
 buffer_load_dwordx4 v4, s[16:19], s66 offen offset:0 sc1 lds
 v_mfma_f32_16x16x32_bf16 v[84:87], v[216:219], a[48:51], 0
 v_add_u32 v8, s65, v4
 s_add_u32 s65, s65, 12288
 v_mfma_f32_16x16x32_bf16 v[92:95], v[216:219], a[72:75], 0
 buffer_load_dwordx4 v4, s[16:19], s66 offen offset:1024 sc1 lds
 v_mfma_f32_16x16x32_bf16 v[100:103], v[216:219], a[96:99], 0
 s_cmp_lt_u32 s65, 98304
 s_cselect_b32 s65, s65, 0
 v_mfma_f32_16x16x32_bf16 v[64:67], v[196:199], a[4:7], v[64:67]
 buffer_load_dwordx4 v4, s[16:19], s66 offen offset:2048 sc1 lds
 v_mfma_f32_16x16x32_bf16 v[72:75], v[196:199], a[28:31], v[72:75]
 s_add_u32 s46, s46, s22
 s_mul_i32 s21, s22, 393216
 v_mfma_f32_16x16x32_bf16 v[80:83], v[196:199], a[52:55], v[80:83]
 s_add_u32 s41, s41, s21
 s_mul_i32 s21, s22, 12288
 v_mfma_f32_16x16x32_bf16 v[88:91], v[196:199], a[76:79], v[88:91]
 s_add_u32 s64, s64, s21
 v_cvt_pk_bf16_f32 v44, v104, v105
 v_mfma_f32_16x16x32_bf16 v[96:99], v[196:199], a[100:103], v[96:99]
 s_cmp_lt_u32 s64, s67
 s_cselect_b32 s64, s64, s71
 v_mfma_f32_16x16x32_bf16 v[68:71], v[220:223], a[4:7], v[68:71]
 v_cvt_pk_bf16_f32 v45, v106, v107
 v_cvt_pk_bf16_f32 v46, v108, v109
 v_mfma_f32_16x16x32_bf16 v[76:79], v[220:223], a[28:31], v[76:79]
 v_cvt_pk_bf16_f32 v47, v110, v111
 v_mfma_f32_16x16x32_bf16 v[84:87], v[220:223], a[52:55], v[84:87]
 s_add_u32 s69, s68, 4096
 v_mfma_f32_16x16x32_bf16 v[92:95], v[220:223], a[76:79], v[92:95]
 v_mfma_f32_16x16x32_bf16 v[100:103], v[220:223], a[100:103], v[100:103]
 buffer_store_dwordx4 v[44:47], v4, s[24:27], s69 offen offset:1024 sc1
 v_mfma_f32_16x16x32_bf16 v[64:67], v[200:203], a[8:11], v[64:67]
 v_mfma_f32_16x16x32_bf16 v[72:75], v[200:203], a[32:35], v[72:75]
 v_cvt_pk_bf16_f32 v48, v112, v113
 v_mfma_f32_16x16x32_bf16 v[80:83], v[200:203], a[56:59], v[80:83]
 v_cvt_pk_bf16_f32 v49, v114, v115
 v_mfma_f32_16x16x32_bf16 v[88:91], v[200:203], a[80:83], v[88:91]
 v_mfma_f32_16x16x32_bf16 v[96:99], v[200:203], a[104:107], v[96:99]
 v_cvt_pk_bf16_f32 v50, v116, v117
 v_mfma_f32_16x16x32_bf16 v[68:71], v[224:227], a[8:11], v[68:71]
 v_mfma_f32_16x16x32_bf16 v[76:79], v[224:227], a[32:35], v[76:79]
 v_cvt_pk_bf16_f32 v51, v118, v119
 v_mfma_f32_16x16x32_bf16 v[84:87], v[224:227], a[56:59], v[84:87]
 buffer_store_dwordx4 v[48:51], v4, s[24:27], s69 offen offset:2048 sc1
 v_mfma_f32_16x16x32_bf16 v[92:95], v[224:227], a[80:83], v[92:95]
 v_mfma_f32_16x16x32_bf16 v[100:103], v[224:227], a[104:107], v[100:103]
 v_cvt_pk_bf16_f32 v52, v120, v121
 v_mfma_f32_16x16x32_bf16 v[64:67], v[204:207], a[12:15], v[64:67]
 v_mfma_f32_16x16x32_bf16 v[72:75], v[204:207], a[36:39], v[72:75]
 v_cvt_pk_bf16_f32 v53, v122, v123
 v_mfma_f32_16x16x32_bf16 v[80:83], v[204:207], a[60:63], v[80:83]
 v_cvt_pk_bf16_f32 v54, v124, v125
 v_mfma_f32_16x16x32_bf16 v[88:91], v[204:207], a[84:87], v[88:91]
 v_mfma_f32_16x16x32_bf16 v[96:99], v[204:207], a[108:111], v[96:99]
 v_cvt_pk_bf16_f32 v55, v126, v127
 v_mfma_f32_16x16x32_bf16 v[68:71], v[228:231], a[12:15], v[68:71]
 v_mfma_f32_16x16x32_bf16 v[76:79], v[228:231], a[36:39], v[76:79]
 buffer_store_dwordx4 v[52:55], v4, s[24:27], s69 offen offset:3072 sc1
 v_mfma_f32_16x16x32_bf16 v[84:87], v[228:231], a[60:63], v[84:87]
 v_cvt_pk_bf16_f32 v56, v128, v129
 v_mfma_f32_16x16x32_bf16 v[92:95], v[228:231], a[84:87], v[92:95]
 v_mfma_f32_16x16x32_bf16 v[100:103], v[228:231], a[108:111], v[100:103]
 v_cvt_pk_bf16_f32 v57, v130, v131
 v_mfma_f32_16x16x32_bf16 v[64:67], v[208:211], a[16:19], v[64:67]
 v_mfma_f32_16x16x32_bf16 v[72:75], v[208:211], a[40:43], v[72:75]
 v_cvt_pk_bf16_f32 v58, v132, v133
 v_mfma_f32_16x16x32_bf16 v[80:83], v[208:211], a[64:67], v[80:83]
 v_cvt_pk_bf16_f32 v59, v134, v135
 v_mfma_f32_16x16x32_bf16 v[88:91], v[208:211], a[88:91], v[88:91]
 v_mfma_f32_16x16x32_bf16 v[96:99], v[208:211], a[112:115], v[96:99]
 s_add_u32 s69, s68, 8192
 v_mfma_f32_16x16x32_bf16 v[68:71], v[232:235], a[16:19], v[68:71]
 v_mfma_f32_16x16x32_bf16 v[76:79], v[232:235], a[40:43], v[76:79]
 buffer_store_dwordx4 v[56:59], v4, s[24:27], s69 offen offset:0 sc1
 v_mfma_f32_16x16x32_bf16 v[84:87], v[232:235], a[64:67], v[84:87]
 v_cvt_pk_bf16_f32 v60, v136, v137
 v_mfma_f32_16x16x32_bf16 v[92:95], v[232:235], a[88:91], v[92:95]
 v_mfma_f32_16x16x32_bf16 v[100:103], v[232:235], a[112:115], v[100:103]
 v_cvt_pk_bf16_f32 v61, v138, v139
 v_mfma_f32_16x16x32_bf16 v[64:67], v[212:215], a[20:23], v[64:67]
 v_mfma_f32_16x16x32_bf16 v[72:75], v[212:215], a[44:47], v[72:75]
 v_cvt_pk_bf16_f32 v62, v140, v141
 v_mfma_f32_16x16x32_bf16 v[80:83], v[212:215], a[68:71], v[80:83]
 v_cvt_pk_bf16_f32 v63, v142, v143
 v_mfma_f32_16x16x32_bf16 v[88:91], v[212:215], a[92:95], v[88:91]
 v_mfma_f32_16x16x32_bf16 v[96:99], v[212:215], a[116:119], v[96:99]
 buffer_store_dwordx4 v[60:63], v4, s[24:27], s69 offen offset:1024 sc1
 v_mfma_f32_16x16x32_bf16 v[68:71], v[236:239], a[20:23], v[68:71]
 v_mfma_f32_16x16x32_bf16 v[76:79], v[236:239], a[44:47], v[76:79]
 v_mfma_f32_16x16x32_bf16 v[84:87], v[236:239], a[68:71], v[84:87]
 v_mfma_f32_16x16x32_bf16 v[92:95], v[236:239], a[92:95], v[92:95]
 v_mfma_f32_16x16x32_bf16 v[100:103], v[236:239], a[116:119], v[100:103]
 v_mfma_f32_16x16x32_bf16 v[104:107], v[192:195], a[120:123], 0
 buffer_load_dword v9, v5, s[72:75], s43 offen sc1
 v_mfma_f32_16x16x32_bf16 v[112:115], v[192:195], a[144:147], 0
 v_mfma_f32_16x16x32_bf16 v[120:123], v[192:195], a[168:171], 0
 v_mfma_f32_16x16x32_bf16 v[128:131], v[192:195], a[192:195], 0
 v_cvt_pk_bf16_f32 v24, v64, v65
 v_mfma_f32_16x16x32_bf16 v[136:139], v[192:195], a[216:219], 0
 s_add_u32 s63, s45, 1
 s_min_u32 s63, s63, 63
 v_mfma_f32_16x16x32_bf16 v[108:111], v[216:219], a[120:123], 0
 s_cmp_lt_u32 s63, s46
 s_cselect_b32 s53, 1, 0
 v_mfma_f32_16x16x32_bf16 v[116:119], v[216:219], a[144:147], 0
 v_mov_b32 v21, s53
 ds_write_b32 v6, v21 offset:16
 v_mfma_f32_16x16x32_bf16 v[124:127], v[216:219], a[168:171], 0
 v_cvt_pk_bf16_f32 v25, v66, v67
 v_cvt_pk_bf16_f32 v26, v68, v69
 v_mfma_f32_16x16x32_bf16 v[132:135], v[216:219], a[192:195], 0
 v_cvt_pk_bf16_f32 v27, v70, v71
 v_mfma_f32_16x16x32_bf16 v[140:143], v[216:219], a[216:219], 0
 v_mfma_f32_16x16x32_bf16 v[104:107], v[196:199], a[124:127], v[104:107]
 buffer_store_dwordx4 v[24:27], v4, s[24:27], s42 offen offset:0 sc1
 v_mfma_f32_16x16x32_bf16 v[112:115], v[196:199], a[148:151], v[112:115]
 v_cvt_pk_bf16_f32 v28, v72, v73
 v_mfma_f32_16x16x32_bf16 v[120:123], v[196:199], a[172:175], v[120:123]
 s_cmp_eq_u32 s40, 3
 s_cbranch_scc1 vwm_164
vwm_165:
 v_mfma_f32_16x16x32_bf16 v[128:131], v[196:199], a[196:199], v[128:131]
 v_cvt_pk_bf16_f32 v29, v74, v75
 v_mfma_f32_16x16x32_bf16 v[136:139], v[196:199], a[220:223], v[136:139]
 v_mfma_f32_16x16x32_bf16 v[108:111], v[220:223], a[124:127], v[108:111]
 v_cvt_pk_bf16_f32 v30, v76, v77
 v_mfma_f32_16x16x32_bf16 v[116:119], v[220:223], a[148:151], v[116:119]
 v_mfma_f32_16x16x32_bf16 v[124:127], v[220:223], a[172:175], v[124:127]
 v_cvt_pk_bf16_f32 v31, v78, v79
 v_mfma_f32_16x16x32_bf16 v[132:135], v[220:223], a[196:199], v[132:135]
 buffer_store_dwordx4 v[28:31], v4, s[24:27], s42 offen offset:1024 sc1
 v_mfma_f32_16x16x32_bf16 v[140:143], v[220:223], a[220:223], v[140:143]
 s_cmp_lt_u32 s63, s50
 s_cbranch_scc0 vwx_162
vwx_163:
 v_mfma_f32_16x16x32_bf16 v[104:107], v[200:203], a[128:131], v[104:107]
 s_waitcnt lgkmcnt(0)
 s_barrier
 v_mfma_f32_16x16x32_bf16 v[112:115], v[200:203], a[152:155], v[112:115]
 ds_read_b128 v[240:243], v7 offset:16
 v_cvt_pk_bf16_f32 v32, v80, v81
 v_mfma_f32_16x16x32_bf16 v[120:123], v[200:203], a[176:179], v[120:123]
 ds_read_b128 v[144:147], v8 offset:0
 v_cvt_pk_bf16_f32 v33, v82, v83
 v_mfma_f32_16x16x32_bf16 v[128:131], v[200:203], a[200:203], v[128:131]
 v_mfma_f32_16x16x32_bf16 v[136:139], v[200:203], a[224:227], v[136:139]
 ds_read_b128 v[148:151], v8 offset:1024
 v_cvt_pk_bf16_f32 v34, v84, v85
 v_mfma_f32_16x16x32_bf16 v[108:111], v[224:227], a[128:131], v[108:111]
 v_mfma_f32_16x16x32_bf16 v[116:119], v[224:227], a[152:155], v[116:119]
 v_cvt_pk_bf16_f32 v35, v86, v87
 v_mfma_f32_16x16x32_bf16 v[124:127], v[224:227], a[176:179], v[124:127]
 ds_read_b128 v[152:155], v8 offset:2048
 v_mfma_f32_16x16x32_bf16 v[132:135], v[224:227], a[200:203], v[132:135]
 buffer_store_dwordx4 v[32:35], v4, s[24:27], s42 offen offset:2048 sc1
 v_mfma_f32_16x16x32_bf16 v[140:143], v[224:227], a[224:227], v[140:143]
 ds_read_b128 v[156:159], v8 offset:3072
 v_cvt_pk_bf16_f32 v36, v88, v89
 v_mfma_f32_16x16x32_bf16 v[104:107], v[204:207], a[132:135], v[104:107]
 v_mfma_f32_16x16x32_bf16 v[112:115], v[204:207], a[156:159], v[112:115]
 v_cvt_pk_bf16_f32 v37, v90, v91
 v_mfma_f32_16x16x32_bf16 v[120:123], v[204:207], a[180:183], v[120:123]
 ds_read_b128 v[160:163], v8 offset:4096
 v_mfma_f32_16x16x32_bf16 v[128:131], v[204:207], a[204:207], v[128:131]
 v_cvt_pk_bf16_f32 v38, v92, v93
 v_mfma_f32_16x16x32_bf16 v[136:139], v[204:207], a[228:231], v[136:139]
 ds_read_b128 v[164:167], v8 offset:5120
 s_waitcnt lgkmcnt(4)
 v_mfma_f32_16x16x32_bf16 v[108:111], v[228:231], a[132:135], v[108:111]
 v_bitop3_b32 v240, v240, v241, v242 bitop3:0x80
 v_and_b32 v240, v240, v243
 v_mfma_f32_16x16x32_bf16 v[116:119], v[228:231], a[156:159], v[116:119]
 s_nop 0
 v_readfirstlane_b32 s23, v240
 v_mfma_f32_16x16x32_bf16 v[124:127], v[228:231], a[180:183], v[124:127]
 ds_read_b128 v[168:171], v8 offset:6144
 v_cvt_pk_bf16_f32 v39, v94, v95
 v_mfma_f32_16x16x32_bf16 v[132:135], v[228:231], a[204:207], v[132:135]
 buffer_store_dwordx4 v[36:39], v4, s[24:27], s42 offen offset:3072 sc1
 v_mfma_f32_16x16x32_bf16 v[140:143], v[228:231], a[228:231], v[140:143]
 ds_read_b128 v[172:175], v8 offset:7168
 v_cvt_pk_bf16_f32 v40, v96, v97
 v_mfma_f32_16x16x32_bf16 v[104:107], v[208:211], a[136:139], v[104:107]
 v_cvt_pk_bf16_f32 v41, v98, v99
 v_mfma_f32_16x16x32_bf16 v[112:115], v[208:211], a[160:163], v[112:115]
 v_cvt_pk_bf16_f32 v42, v100, v101
 v_mfma_f32_16x16x32_bf16 v[120:123], v[208:211], a[184:187], v[120:123]
 ds_read_b128 v[176:179], v8 offset:8192
 v_mfma_f32_16x16x32_bf16 v[128:131], v[208:211], a[208:211], v[128:131]
 v_cvt_pk_bf16_f32 v43, v102, v103
 v_mfma_f32_16x16x32_bf16 v[136:139], v[208:211], a[232:235], v[136:139]
 ds_read_b128 v[180:183], v8 offset:9216
 v_mfma_f32_16x16x32_bf16 v[108:111], v[232:235], a[136:139], v[108:111]
 s_add_u32 s69, s42, 4096
 v_mfma_f32_16x16x32_bf16 v[116:119], v[232:235], a[160:163], v[116:119]
 v_mfma_f32_16x16x32_bf16 v[124:127], v[232:235], a[184:187], v[124:127]
 ds_read_b128 v[184:187], v8 offset:10240
 v_mfma_f32_16x16x32_bf16 v[132:135], v[232:235], a[208:211], v[132:135]
 buffer_store_dwordx4 v[40:43], v4, s[24:27], s69 offen offset:0 sc1
 v_mfma_f32_16x16x32_bf16 v[140:143], v[232:235], a[232:235], v[140:143]
 ds_read_b128 v[188:191], v8 offset:11264
 v_mfma_f32_16x16x32_bf16 v[104:107], v[212:215], a[140:143], v[104:107]
 v_mfma_f32_16x16x32_bf16 v[112:115], v[212:215], a[164:167], v[112:115]
 v_mfma_f32_16x16x32_bf16 v[120:123], v[212:215], a[188:191], v[120:123]
 s_waitcnt vmcnt(11)
 s_mov_b32 s50, s46
 s_add_u32 s69, s45, s40
 v_mfma_f32_16x16x32_bf16 v[128:131], v[212:215], a[212:215], v[128:131]
 s_mov_b32 s40, 0
 s_sub_i32 s69, s69, 1
 s_max_i32 s69, s69, s70
 v_mfma_f32_16x16x32_bf16 v[136:139], v[212:215], a[236:239], v[136:139]
 s_add_u32 s45, s45, 1
 s_mov_b32 s68, s42
 s_add_u32 s42, s42, 1310720
 v_mfma_f32_16x16x32_bf16 v[108:111], v[236:239], a[140:143], v[108:111]
 v_mfma_f32_16x16x32_bf16 v[116:119], v[236:239], a[164:167], v[116:119]
 v_mfma_f32_16x16x32_bf16 v[124:127], v[236:239], a[188:191], v[124:127]
 v_mfma_f32_16x16x32_bf16 v[132:135], v[236:239], a[212:215], v[132:135]
 v_mfma_f32_16x16x32_bf16 v[140:143], v[236:239], a[236:239], v[140:143]
 s_mov_b64 exec, 1
 v_mov_b32 v20, s69
 buffer_store_dword v20, v10, s[72:75], s44 offen sc1
 s_mov_b64 exec, -1
 s_cmp_le_u32 s45, 16
 s_cbranch_scc1 vwe_168
vwe_169:
 s_cmp_lg_u32 s45, 44
 s_cbranch_scc1 arm_172
 s_lshr_b32 s21, s2, 3
 s_lshl_b32 s21, s21, 14
 s_and_b32 s22, s2, 7
 s_lshl_b32 s22, s22, 10
 s_add_u32 s54, s21, s22
 s_lshr_b32 s21, s2, 2
 s_lshl_b32 s21, s21, 14
 s_and_b32 s22, s2, 3
 s_lshl_b32 s22, s22, 11
 s_add_u32 s21, s21, s22
 s_add_u32 s55, s21, 655360
 s_lshr_b32 s58, s2, 1
 s_lshl_b32 s58, s58, 14
 s_and_b32 s21, s2, 1
 s_mul_i32 s21, s21, 3072
 s_add_u32 s58, s58, s21
 s_add_u32 s58, s58, 655360
 s_add_u32 s56, s20, 52
arm_173:
 s_lshl_b32 s21, s56, 12
 s_and_b32 s21, s21, 8192
 s_xor_b32 s21, s21, s37
 s_lshl_b32 s57, s56, 20
 s_or_b32 s57, s57, s21
 s_cmp_ge_u32 s56, 36
 s_cselect_b32 s21, 8192, 0
 s_xor_b32 s21, s21, s57
 s_add_u32 s21, s21, s54
 buffer_store_dwordx4 v[244:247], v4, s[88:91], s21 offen sc1
 s_add_u32 s21, s21, 65536
 buffer_store_dwordx4 v[244:247], v4, s[88:91], s21 offen sc1
 s_add_u32 s21, s21, 65536
 buffer_store_dwordx4 v[244:247], v4, s[88:91], s21 offen sc1
 s_add_u32 s21, s21, 65536
 buffer_store_dwordx4 v[244:247], v4, s[88:91], s21 offen sc1
 s_add_u32 s21, s21, 65536
 buffer_store_dwordx4 v[244:247], v4, s[88:91], s21 offen sc1
 s_add_u32 s21, s21, 65536
 buffer_store_dwordx4 v[244:247], v4, s[88:91], s21 offen sc1
 s_add_u32 s21, s21, 65536
 buffer_store_dwordx4 v[244:247], v4, s[88:91], s21 offen sc1
 s_add_u32 s21, s21, 65536
 buffer_store_dwordx4 v[244:247], v4, s[88:91], s21 offen sc1
 s_add_u32 s21, s21, 65536
 buffer_store_dwordx4 v[244:247], v4, s[88:91], s21 offen sc1
 s_add_u32 s21, s21, 65536
 buffer_store_dwordx4 v[244:247], v4, s[88:91], s21 offen sc1
 s_add_u32 s21, s21, 65536
 s_add_u32 s21, s57, s55
 buffer_store_dwordx4 v[244:247], v4, s[88:91], s21 offen sc1
 buffer_store_dwordx4 v[244:247], v4, s[88:91], s21 offen offset:1024 sc1
 s_xor_b32 s21, s57, 8192
 s_add_u32 s21, s21, s58
 buffer_store_dwordx4 v[244:247], v4, s[88:91], s21 offen offset:0 sc1
 buffer_store_dwordx4 v[244:247], v4, s[88:91], s21 offen offset:1024 sc1
 buffer_store_dwordx4 v[244:247], v4, s[88:91], s21 offen offset:2048 sc1
 s_add_u32 s56, s56, 4
 s_cmp_lt_u32 s56, 64
 s_cbranch_scc1 arm_173
arm_172:
 s_cmp_ge_u32 s45, 64
 s_cbranch_scc1 vwd_151
 s_cmp_lg_u32 s23, 0
 s_cbranch_scc1 vwl_150
 s_branch vws_166
vws_156:
 v_cmp_gt_u32 vcc, 8, v9
 s_nop 0
 s_bitset1_b64 vcc, 19
 s_ff1_i32_b64 s21, vcc
 s_lshl_b32 s22, s21, 1
 s_lshl_b32 s21, s21, 2
 s_sub_i32 s21, s21, 12
 s_max_i32 s47, s21, s22
 s_cmp_gt_u32 s47, s45
 s_cbranch_scc1 va_174
 s_cmp_eq_u32 s70, s45
 s_cbranch_scc1 va_179
 s_nop 4
 v_cvt_pk_bf16_f32 v44, v104, v105
 v_cvt_pk_bf16_f32 v45, v106, v107
 v_cvt_pk_bf16_f32 v46, v108, v109
 v_cvt_pk_bf16_f32 v47, v110, v111
 s_add_u32 s69, s68, 4096
 buffer_store_dwordx4 v[44:47], v4, s[24:27], s69 offen offset:1024 sc1
 v_cvt_pk_bf16_f32 v48, v112, v113
 v_cvt_pk_bf16_f32 v49, v114, v115
 v_cvt_pk_bf16_f32 v50, v116, v117
 v_cvt_pk_bf16_f32 v51, v118, v119
 buffer_store_dwordx4 v[48:51], v4, s[24:27], s69 offen offset:2048 sc1
 v_cvt_pk_bf16_f32 v52, v120, v121
 v_cvt_pk_bf16_f32 v53, v122, v123
 v_cvt_pk_bf16_f32 v54, v124, v125
 v_cvt_pk_bf16_f32 v55, v126, v127
 buffer_store_dwordx4 v[52:55], v4, s[24:27], s69 offen offset:3072 sc1
 v_cvt_pk_bf16_f32 v56, v128, v129
 v_cvt_pk_bf16_f32 v57, v130, v131
 v_cvt_pk_bf16_f32 v58, v132, v133
 v_cvt_pk_bf16_f32 v59, v134, v135
 s_add_u32 s69, s68, 8192
 buffer_store_dwordx4 v[56:59], v4, s[24:27], s69 offen offset:0 sc1
 v_cvt_pk_bf16_f32 v60, v136, v137
 v_cvt_pk_bf16_f32 v61, v138, v139
 v_cvt_pk_bf16_f32 v62, v140, v141
 v_cvt_pk_bf16_f32 v63, v142, v143
 buffer_store_dwordx4 v[60:63], v4, s[24:27], s69 offen offset:1024 sc1
 s_mov_b32 s68, 0x80000000
 s_mov_b32 s56, s68
 s_mov_b32 s57, s68
 s_waitcnt vmcnt(0)
 s_mov_b64 exec, 1
 v_mov_b32 v20, s45
 buffer_store_dword v20, v10, s[72:75], s44 offen sc1
 s_mov_b64 exec, -1
 s_mov_b32 s70, s45
 s_mov_b32 s40, 0
va_179:
 s_mov_b32 s101, 0
 s_branch va_177
va_175:
 s_sleep 8
va_177:
 buffer_load_dword v9, v5, s[72:75], s43 offen sc1
 s_add_u32 s101, s101, 1
 s_cmp_gt_u32 s101, 131072
 s_cbranch_scc1 main_end
 s_waitcnt vmcnt(0)
 v_cmp_gt_u32 vcc, 8, v9
 s_nop 0
 s_bitset1_b64 vcc, 19
 s_ff1_i32_b64 s21, vcc
 s_lshl_b32 s22, s21, 1
 s_lshl_b32 s21, s21, 2
 s_sub_i32 s21, s21, 12
 s_max_i32 s47, s21, s22
 s_cmp_gt_u32 s47, s45
 s_cbranch_scc0 va_175
va_174:
 s_add_u32 s22, s45, 6
 s_min_u32 s22, s22, s47
va_176:
 s_cmp_ge_u32 s46, s22
 s_cbranch_scc1 va_178
 s_mov_b32 m0, s64
 s_mov_b32 s66, s41
 buffer_load_dwordx4 v4, s[16:19], s66 offen offset:0 sc1 lds
 buffer_load_dwordx4 v4, s[16:19], s66 offen offset:1024 sc1 lds
 buffer_load_dwordx4 v4, s[16:19], s66 offen offset:2048 sc1 lds
 s_add_u32 s46, s46, 1
 s_add_u32 s41, s41, 393216
 s_add_u32 s64, s64, 12288
 s_cmp_lt_u32 s64, s67
 s_cselect_b32 s64, s64, s71
 s_branch va_176
va_178:
 s_mov_b32 s48, s46
 s_mov_b32 s49, s46
 s_mov_b32 s50, s46
 s_waitcnt vmcnt(0)
 s_cmp_eq_u32 s40, 0
 s_cbranch_scc1 va_180
 s_mov_b32 s40, 0
 s_mov_b64 exec, 1
 v_mov_b32 v20, s45
 buffer_store_dword v20, v10, s[72:75], s44 offen sc1
 s_mov_b64 exec, -1
 s_mov_b32 s70, s45
va_180:
 s_barrier
 ds_read_b128 v[192:195], v8 offset:0
 ds_read_b128 v[196:199], v8 offset:1024
 ds_read_b128 v[200:203], v8 offset:2048
 ds_read_b128 v[204:207], v8 offset:3072
 ds_read_b128 v[208:211], v8 offset:4096
 ds_read_b128 v[212:215], v8 offset:5120
 ds_read_b128 v[216:219], v8 offset:6144
 ds_read_b128 v[220:223], v8 offset:7168
 ds_read_b128 v[224:227], v8 offset:8192
 ds_read_b128 v[228:231], v8 offset:9216
 ds_read_b128 v[232:235], v8 offset:10240
 ds_read_b128 v[236:239], v8 offset:11264
 s_branch vwb_157
vws_166:
 v_cmp_gt_u32 vcc, 8, v9
 s_nop 0
 s_bitset1_b64 vcc, 19
 s_ff1_i32_b64 s21, vcc
 s_lshl_b32 s22, s21, 1
 s_lshl_b32 s21, s21, 2
 s_sub_i32 s21, s21, 12
 s_max_i32 s47, s21, s22
 s_cmp_gt_u32 s47, s45
 s_cbranch_scc1 va_181
 s_cmp_eq_u32 s70, s45
 s_cbranch_scc1 va_186
 s_nop 4
 v_cvt_pk_bf16_f32 v44, v104, v105
 v_cvt_pk_bf16_f32 v45, v106, v107
 v_cvt_pk_bf16_f32 v46, v108, v109
 v_cvt_pk_bf16_f32 v47, v110, v111
 s_add_u32 s69, s68, 4096
 buffer_store_dwordx4 v[44:47], v4, s[24:27], s69 offen offset:1024 sc1
 v_cvt_pk_bf16_f32 v48, v112, v113
 v_cvt_pk_bf16_f32 v49, v114, v115
 v_cvt_pk_bf16_f32 v50, v116, v117
 v_cvt_pk_bf16_f32 v51, v118, v119
 buffer_store_dwordx4 v[48:51], v4, s[24:27], s69 offen offset:2048 sc1
 v_cvt_pk_bf16_f32 v52, v120, v121
 v_cvt_pk_bf16_f32 v53, v122, v123
 v_cvt_pk_bf16_f32 v54, v124, v125
 v_cvt_pk_bf16_f32 v55, v126, v127
 buffer_store_dwordx4 v[52:55], v4, s[24:27], s69 offen offset:3072 sc1
 v_cvt_pk_bf16_f32 v56, v128, v129
 v_cvt_pk_bf16_f32 v57, v130, v131
 v_cvt_pk_bf16_f32 v58, v132, v133
 v_cvt_pk_bf16_f32 v59, v134, v135
 s_add_u32 s69, s68, 8192
 buffer_store_dwordx4 v[56:59], v4, s[24:27], s69 offen offset:0 sc1
 v_cvt_pk_bf16_f32 v60, v136, v137
 v_cvt_pk_bf16_f32 v61, v138, v139
 v_cvt_pk_bf16_f32 v62, v140, v141
 v_cvt_pk_bf16_f32 v63, v142, v143
 buffer_store_dwordx4 v[60:63], v4, s[24:27], s69 offen offset:1024 sc1
 s_mov_b32 s68, 0x80000000
 s_mov_b32 s56, s68
 s_mov_b32 s57, s68
 s_waitcnt vmcnt(0)
 s_mov_b64 exec, 1
 v_mov_b32 v20, s45
 buffer_store_dword v20, v10, s[72:75], s44 offen sc1
 s_mov_b64 exec, -1
 s_mov_b32 s70, s45
 s_mov_b32 s40, 0
va_186:
 s_mov_b32 s101, 0
 s_branch va_184
va_182:
 s_sleep 8
va_184:
 buffer_load_dword v9, v5, s[72:75], s43 offen sc1
 s_add_u32 s101, s101, 1
 s_cmp_gt_u32 s101, 131072
 s_cbranch_scc1 main_end
 s_waitcnt vmcnt(0)
 v_cmp_gt_u32 vcc, 8, v9
 s_nop 0
 s_bitset1_b64 vcc, 19
 s_ff1_i32_b64 s21, vcc
 s_lshl_b32 s22, s21, 1
 s_lshl_b32 s21, s21, 2
 s_sub_i32 s21, s21, 12
 s_max_i32 s47, s21, s22
 s_cmp_gt_u32 s47, s45
 s_cbranch_scc0 va_182
va_181:
 s_add_u32 s22, s45, 6
 s_min_u32 s22, s22, s47
va_183:
 s_cmp_ge_u32 s46, s22
 s_cbranch_scc1 va_185
 s_mov_b32 m0, s64
 s_mov_b32 s66, s41
 buffer_load_dwordx4 v4, s[16:19], s66 offen offset:0 sc1 lds
 buffer_load_dwordx4 v4, s[16:19], s66 offen offset:1024 sc1 lds
 buffer_load_dwordx4 v4, s[16:19], s66 offen offset:2048 sc1 lds
 s_add_u32 s46, s46, 1
 s_add_u32 s41, s41, 393216
 s_add_u32 s64, s64, 12288
 s_cmp_lt_u32 s64, s67
 s_cselect_b32 s64, s64, s71
 s_branch va_183
va_185:
 s_mov_b32 s48, s46
 s_mov_b32 s49, s46
 s_mov_b32 s50, s46
 s_waitcnt vmcnt(0)
 s_cmp_eq_u32 s40, 0
 s_cbranch_scc1 va_187
 s_mov_b32 s40, 0
 s_mov_b64 exec, 1
 v_mov_b32 v20, s45
 buffer_store_dword v20, v10, s[72:75], s44 offen sc1
 s_mov_b64 exec, -1
 s_mov_b32 s70, s45
va_187:
 s_barrier
 ds_read_b128 v[144:147], v8 offset:0
 ds_read_b128 v[148:151], v8 offset:1024
 ds_read_b128 v[152:155], v8 offset:2048
 ds_read_b128 v[156:159], v8 offset:3072
 ds_read_b128 v[160:163], v8 offset:4096
 ds_read_b128 v[164:167], v8 offset:5120
 ds_read_b128 v[168:171], v8 offset:6144
 ds_read_b128 v[172:175], v8 offset:7168
 ds_read_b128 v[176:179], v8 offset:8192
 ds_read_b128 v[180:183], v8 offset:9216
 ds_read_b128 v[184:187], v8 offset:10240
 ds_read_b128 v[188:191], v8 offset:11264
 s_branch vwl_150
vwe_158:
 s_nop 4
 v_cvt_pk_bf16_f32 v44, v104, v105
 v_cvt_pk_bf16_f32 v45, v106, v107
 v_cvt_pk_bf16_f32 v46, v108, v109
 v_cvt_pk_bf16_f32 v47, v110, v111
 s_add_u32 s69, s68, 4096
 buffer_store_dwordx4 v[44:47], v4, s[24:27], s69 offen offset:1024 sc1
 v_cvt_pk_bf16_f32 v48, v112, v113
 v_cvt_pk_bf16_f32 v49, v114, v115
 v_cvt_pk_bf16_f32 v50, v116, v117
 v_cvt_pk_bf16_f32 v51, v118, v119
 buffer_store_dwordx4 v[48:51], v4, s[24:27], s69 offen offset:2048 sc1
 v_cvt_pk_bf16_f32 v52, v120, v121
 v_cvt_pk_bf16_f32 v53, v122, v123
 v_cvt_pk_bf16_f32 v54, v124, v125
 v_cvt_pk_bf16_f32 v55, v126, v127
 buffer_store_dwordx4 v[52:55], v4, s[24:27], s69 offen offset:3072 sc1
 v_cvt_pk_bf16_f32 v56, v128, v129
 v_cvt_pk_bf16_f32 v57, v130, v131
 v_cvt_pk_bf16_f32 v58, v132, v133
 v_cvt_pk_bf16_f32 v59, v134, v135
 s_add_u32 s69, s68, 8192
 buffer_store_dwordx4 v[56:59], v4, s[24:27], s69 offen offset:0 sc1
 v_cvt_pk_bf16_f32 v60, v136, v137
 v_cvt_pk_bf16_f32 v61, v138, v139
 v_cvt_pk_bf16_f32 v62, v140, v141
 v_cvt_pk_bf16_f32 v63, v142, v143
 buffer_store_dwordx4 v[60:63], v4, s[24:27], s69 offen offset:1024 sc1
 s_mov_b32 s68, 0x80000000
 s_mov_b32 s56, s68
 s_mov_b32 s57, s68
 s_cmp_le_u32 s45, 4
 s_cselect_b32 s40, 3, 1
 s_branch vwe_159
vwe_168:
 s_nop 4
 v_cvt_pk_bf16_f32 v44, v104, v105
 v_cvt_pk_bf16_f32 v45, v106, v107
 v_cvt_pk_bf16_f32 v46, v108, v109
 v_cvt_pk_bf16_f32 v47, v110, v111
 s_add_u32 s69, s68, 4096
 buffer_store_dwordx4 v[44:47], v4, s[24:27], s69 offen offset:1024 sc1
 v_cvt_pk_bf16_f32 v48, v112, v113
 v_cvt_pk_bf16_f32 v49, v114, v115
 v_cvt_pk_bf16_f32 v50, v116, v117
 v_cvt_pk_bf16_f32 v51, v118, v119
 buffer_store_dwordx4 v[48:51], v4, s[24:27], s69 offen offset:2048 sc1
 v_cvt_pk_bf16_f32 v52, v120, v121
 v_cvt_pk_bf16_f32 v53, v122, v123
 v_cvt_pk_bf16_f32 v54, v124, v125
 v_cvt_pk_bf16_f32 v55, v126, v127
 buffer_store_dwordx4 v[52:55], v4, s[24:27], s69 offen offset:3072 sc1
 v_cvt_pk_bf16_f32 v56, v128, v129
 v_cvt_pk_bf16_f32 v57, v130, v131
 v_cvt_pk_bf16_f32 v58, v132, v133
 v_cvt_pk_bf16_f32 v59, v134, v135
 s_add_u32 s69, s68, 8192
 buffer_store_dwordx4 v[56:59], v4, s[24:27], s69 offen offset:0 sc1
 v_cvt_pk_bf16_f32 v60, v136, v137
 v_cvt_pk_bf16_f32 v61, v138, v139
 v_cvt_pk_bf16_f32 v62, v140, v141
 v_cvt_pk_bf16_f32 v63, v142, v143
 buffer_store_dwordx4 v[60:63], v4, s[24:27], s69 offen offset:1024 sc1
 s_mov_b32 s68, 0x80000000
 s_mov_b32 s56, s68
 s_mov_b32 s57, s68
 s_cmp_le_u32 s45, 4
 s_cselect_b32 s40, 3, 1
 s_branch vwe_169
vwx_152:
 s_waitcnt vmcnt(8)
 s_branch vwx_153
vwx_162:
 s_waitcnt vmcnt(8)
 s_branch vwx_163
vwm_154:
 s_mov_b32 s40, 0
 s_waitcnt vmcnt(10)
 s_mov_b64 exec, 1
 v_mov_b32 v20, s45
 buffer_store_dword v20, v10, s[72:75], s44 offen sc1
 s_mov_b64 exec, -1
 s_mov_b32 s70, s45
 s_branch vwm_155
vwm_164:
 s_mov_b32 s40, 0
 s_waitcnt vmcnt(10)
 s_mov_b64 exec, 1
 v_mov_b32 v20, s45
 buffer_store_dword v20, v10, s[72:75], s44 offen sc1
 s_mov_b64 exec, -1
 s_mov_b32 s70, s45
 s_branch vwm_165
vwd_151:
 s_nop 4
 v_cvt_pk_bf16_f32 v44, v104, v105
 v_cvt_pk_bf16_f32 v45, v106, v107
 v_cvt_pk_bf16_f32 v46, v108, v109
 v_cvt_pk_bf16_f32 v47, v110, v111
 s_add_u32 s69, s68, 4096
 buffer_store_dwordx4 v[44:47], v4, s[24:27], s69 offen offset:1024 sc1
 v_cvt_pk_bf16_f32 v48, v112, v113
 v_cvt_pk_bf16_f32 v49, v114, v115
 v_cvt_pk_bf16_f32 v50, v116, v117
 v_cvt_pk_bf16_f32 v51, v118, v119
 buffer_store_dwordx4 v[48:51], v4, s[24:27], s69 offen offset:2048 sc1
 v_cvt_pk_bf16_f32 v52, v120, v121
 v_cvt_pk_bf16_f32 v53, v122, v123
 v_cvt_pk_bf16_f32 v54, v124, v125
 v_cvt_pk_bf16_f32 v55, v126, v127
 buffer_store_dwordx4 v[52:55], v4, s[24:27], s69 offen offset:3072 sc1
 v_cvt_pk_bf16_f32 v56, v128, v129
 v_cvt_pk_bf16_f32 v57, v130, v131
 v_cvt_pk_bf16_f32 v58, v132, v133
 v_cvt_pk_bf16_f32 v59, v134, v135
 s_add_u32 s69, s68, 8192
 buffer_store_dwordx4 v[56:59], v4, s[24:27], s69 offen offset:0 sc1
 v_cvt_pk_bf16_f32 v60, v136, v137
 v_cvt_pk_bf16_f32 v61, v138, v139
 v_cvt_pk_bf16_f32 v62, v140, v141
 v_cvt_pk_bf16_f32 v63, v142, v143
 buffer_store_dwordx4 v[60:63], v4, s[24:27], s69 offen offset:1024 sc1
 s_waitcnt vmcnt(0)
 s_mov_b64 exec, 1
 v_mov_b32 v20, s45
 buffer_store_dword v20, v10, s[72:75], s44 offen sc1
 s_mov_b64 exec, -1
 s_mov_b32 s84, 0
 s_mov_b32 s85, -1
 s_and_b32 s21, s3, 3
 s_cmp_lt_u32 s21, 2
 s_cbranch_scc1 queue
 s_sub_u32 s22, s21, 2
 s_lshl_b32 s22, s22, 3
 s_bfe_u32 s21, s3, 0x30002
 s_add_u32 s21, s21, s22
 s_add_u32 s87, s21, 284
 s_add_u32 s21, s21, 48
 s_mov_b32 s87, -1
 s_waitcnt vmcnt(0) lgkmcnt(0)
 s_barrier
 s_branch do_opb2
 s_mov_b32 s84, 0
 s_mov_b32 s85, -1
 s_mov_b32 s86, 0
 s_branch queue
not_vw:
 s_sub_u32 s2, s3, 96
 s_cmp_lg_u32 s2, 31
 s_cbranch_scc1 not_cal
 s_add_u32 s8, s38, 83886079
 s_addc_u32 s9, s39, 0
 s_and_b32 s8, s8, 0xffe00000
 s_mov_b32 s10, 2097152
 s_mov_b32 s11, 0x00020000
 v_lshrrev_b32 v9, 4, v0
 v_mul_u32_u24 v9, 16640, v9
 v_bfe_u32 v10, v0, 3, 1
 v_lshl_add_u32 v9, v10, 13, v9
 v_and_b32 v10, 7, v0
 v_lshl_add_u32 v9, v10, 4, v9
 s_mov_b32 s21, 1048576
 buffer_store_dwordx4 v[4:7], v9, s[8:11], s21 offen sc1
 s_waitcnt vmcnt(0)
 s_barrier
 s_cmp_lg_u32 s20, 3
 s_cbranch_scc1 cal_188
 s_mov_b64 exec, 1
 v_mov_b32 v4, 0
 s_mov_b32 s40, -1
 s_mov_b32 s41, -1
 s_mov_b32 s42, 1048576
 s_mov_b32 s43, 0
 s_waitcnt vmcnt(0)
cal_189:
 s_add_u32 s21, s42, 0
 s_memtime s[98:99]
 s_waitcnt lgkmcnt(0)
 buffer_load_dword v5, v4, s[8:11], s21 offen sc1
 s_waitcnt vmcnt(0)
 s_memtime s[100:101]
 s_waitcnt lgkmcnt(0)
 s_sub_u32 s21, s100, s98
 s_min_u32 s40, s40, s21
 s_add_u32 s21, s42, 8192
 s_memtime s[98:99]
 s_waitcnt lgkmcnt(0)
 buffer_load_dword v5, v4, s[8:11], s21 offen sc1
 s_waitcnt vmcnt(0)
 s_memtime s[100:101]
 s_waitcnt lgkmcnt(0)
 s_sub_u32 s21, s100, s98
 s_min_u32 s41, s41, s21
 s_add_u32 s42, s42, 16640
 s_add_u32 s43, s43, 1
 s_cmp_lt_u32 s43, 4
 s_cbranch_scc1 cal_189
 s_cmp_lt_u32 s41, s40
 s_cselect_b32 s21, 1, 2
 v_mov_b32 v4, s21
 v_mov_b32 v5, s40
 v_mov_b32 v6, s41
 v_mov_b32 v8, 84
 buffer_store_dwordx3 v[4:6], v8, s[32:35], 0 offen sc1
 s_waitcnt vmcnt(0)
 s_mov_b64 exec, -1
cal_188:
 s_barrier
 s_branch armed
not_cal:
armed:
 s_load_dwordx2 s[72:73], s[0:1], 104
 s_waitcnt lgkmcnt(0)
 s_add_u32 s72, s72, 81068032
 s_addc_u32 s73, s73, 0
 s_mov_b32 s74, 129024
 s_mov_b32 s75, 0x00020000
 s_load_dwordx2 s[4:5], s[0:1], 0
 s_load_dwordx2 s[6:7], s[0:1], 64
 s_load_dwordx2 s[38:39], s[0:1], 104
 s_mov_b32 s64, s32
 s_mov_b32 s65, s33
 s_mov_b32 s66, s34
 s_mov_b32 s67, s35
 s_lshr_b32 s41, s2, 1
 s_and_b32 s42, s2, 1
 s_waitcnt lgkmcnt(0)
 s_mov_b32 s8, s4
 s_mov_b32 s9, s5
 s_mov_b32 s10, 2621440
 s_mov_b32 s11, 0x00020000
 s_mov_b32 s12, s6
 s_mov_b32 s13, s7
 s_mov_b32 s14, 2457600
 s_mov_b32 s15, 0x00020000
 s_add_u32 s16, s38, 70713344
 s_addc_u32 s17, s39, 0
 s_mov_b32 s18, 2641920
 s_mov_b32 s19, 0x00020000
 s_add_u32 s72, s38, 81068032
 s_addc_u32 s73, s39, 0
 s_mov_b32 s74, 129024
 s_mov_b32 s75, 0x00020000
 s_lshl_b32 s21, s2, 2
 s_add_u32 s21, s21, s20
 s_mul_i32 s21, s21, 19200
 v_lshlrev_b32 v5, 4, v1
 buffer_load_dwordx4 v[64:67], v5, s[12:15], s21 offen offset:0
 buffer_load_dwordx4 v[64:67], v5, s[12:15], s21 offen offset:1024
 buffer_load_dwordx4 v[64:67], v5, s[12:15], s21 offen offset:2048
 buffer_load_dwordx4 v[64:67], v5, s[12:15], s21 offen offset:3072
 s_add_u32 s21, s21, 4096
 buffer_load_dwordx4 v[64:67], v5, s[12:15], s21 offen offset:0
 buffer_load_dwordx4 v[64:67], v5, s[12:15], s21 offen offset:1024
 buffer_load_dwordx4 v[64:67], v5, s[12:15], s21 offen offset:2048
 buffer_load_dwordx4 v[64:67], v5, s[12:15], s21 offen offset:3072
 s_add_u32 s21, s21, 4096
 buffer_load_dwordx4 v[64:67], v5, s[12:15], s21 offen offset:0
 buffer_load_dwordx4 v[64:67], v5, s[12:15], s21 offen offset:1024
 buffer_load_dwordx4 v[64:67], v5, s[12:15], s21 offen offset:2048
 buffer_load_dwordx4 v[64:67], v5, s[12:15], s21 offen offset:3072
 s_add_u32 s21, s21, 4096
 buffer_load_dwordx4 v[64:67], v5, s[12:15], s21 offen offset:0
 buffer_load_dwordx4 v[64:67], v5, s[12:15], s21 offen offset:1024
 buffer_load_dwordx4 v[64:67], v5, s[12:15], s21 offen offset:2048
 buffer_load_dwordx4 v[64:67], v5, s[12:15], s21 offen offset:3072
 s_add_u32 s21, s21, 4096
 buffer_load_dwordx4 v[64:67], v5, s[12:15], s21 offen offset:0
 buffer_load_dwordx4 v[64:67], v5, s[12:15], s21 offen offset:1024
 buffer_load_dwordx4 v[64:67], v5, s[12:15], s21 offen offset:2048
 s_waitcnt vmcnt(0)
 v_lshlrev_b32 v6, 1, v3
 v_add_u32 v6, 0, v6
 v_xor_b32 v6, v6, v2
 v_min_u32 v6, 14, v6
 v_mul_u32_u24 v7, 52, v6
 v_lshrrev_b32 v7, 8, v7
 v_mul_u32_u24 v7, 1200, v7
 v_lshl_add_u32 v7, v6, 4, v7
 v_mul_u32_u24 v6, 3840, v3
 v_add_u32 v4, v6, v7
 v_lshlrev_b32 v6, 1, v3
 v_add_u32 v6, 8, v6
 v_xor_b32 v6, v6, v2
 v_min_u32 v6, 14, v6
 v_mul_u32_u24 v7, 52, v6
 v_lshrrev_b32 v7, 8, v7
 v_mul_u32_u24 v7, 1200, v7
 v_lshl_add_u32 v7, v6, 4, v7
 v_mul_u32_u24 v6, 3840, v3
 v_add_u32 v5, v6, v7
 s_mul_i32 s21, s41, 80
 s_mul_i32 s22, s20, 15360
 s_add_u32 s21, s21, s22
 s_lshl_b32 s22, s20, 10
 s_cmp_ge_u32 s20, 2
 s_cselect_b64 vcc, -1, 0
 v_cndmask_b32 v4, v4, v5, vcc
 s_add_u32 m0, s22, 0
 s_nop 0
 buffer_load_dwordx4 v4, s[12:15], s21 offen lds
 s_add_u32 s21, s21, 61440
 s_add_u32 m0, s22, 4096
 s_nop 0
 buffer_load_dwordx4 v4, s[12:15], s21 offen lds
 s_add_u32 s21, s21, 61440
 s_add_u32 m0, s22, 8192
 s_nop 0
 buffer_load_dwordx4 v4, s[12:15], s21 offen lds
 s_add_u32 s21, s21, 61440
 s_add_u32 m0, s22, 12288
 s_nop 0
 buffer_load_dwordx4 v4, s[12:15], s21 offen lds
 s_add_u32 s21, s21, 61440
 s_add_u32 m0, s22, 16384
 s_nop 0
 buffer_load_dwordx4 v4, s[12:15], s21 offen lds
 s_add_u32 s21, s21, 61440
 s_add_u32 m0, s22, 20480
 s_nop 0
 buffer_load_dwordx4 v4, s[12:15], s21 offen lds
 s_add_u32 s21, s21, 61440
 s_add_u32 m0, s22, 24576
 s_nop 0
 buffer_load_dwordx4 v4, s[12:15], s21 offen lds
 s_add_u32 s21, s21, 61440
 s_add_u32 m0, s22, 28672
 s_nop 0
 buffer_load_dwordx4 v4, s[12:15], s21 offen lds
 s_add_u32 s21, s21, 61440
 s_add_u32 m0, s22, 32768
 s_nop 0
 buffer_load_dwordx4 v4, s[12:15], s21 offen lds
 s_add_u32 s21, s21, 61440
 s_add_u32 m0, s22, 36864
 s_nop 0
 buffer_load_dwordx4 v4, s[12:15], s21 offen lds
 s_add_u32 s21, s21, 61440
 s_add_u32 m0, s22, 40960
 s_nop 0
 buffer_load_dwordx4 v4, s[12:15], s21 offen lds
 s_add_u32 s21, s21, 61440
 s_add_u32 m0, s22, 45056
 s_nop 0
 buffer_load_dwordx4 v4, s[12:15], s21 offen lds
 s_add_u32 s21, s21, 61440
 s_add_u32 m0, s22, 49152
 s_nop 0
 buffer_load_dwordx4 v4, s[12:15], s21 offen lds
 s_add_u32 s21, s21, 61440
 s_add_u32 m0, s22, 53248
 s_nop 0
 buffer_load_dwordx4 v4, s[12:15], s21 offen lds
 s_add_u32 s21, s21, 61440
 s_add_u32 m0, s22, 57344
 s_nop 0
 buffer_load_dwordx4 v4, s[12:15], s21 offen lds
 s_add_u32 s21, s21, 61440
 s_add_u32 m0, s22, 61440
 s_nop 0
 buffer_load_dwordx4 v4, s[12:15], s21 offen lds
 s_add_u32 s21, s21, 61440
 s_add_u32 m0, s22, 65536
 s_nop 0
 buffer_load_dwordx4 v4, s[12:15], s21 offen lds
 s_add_u32 s21, s21, 61440
 s_add_u32 m0, s22, 69632
 s_nop 0
 buffer_load_dwordx4 v4, s[12:15], s21 offen lds
 s_add_u32 s21, s21, 61440
 s_add_u32 m0, s22, 73728
 s_nop 0
 buffer_load_dwordx4 v4, s[12:15], s21 offen lds
 s_add_u32 s21, s21, 61440
 s_add_u32 m0, s22, 77824
 s_nop 0
 buffer_load_dwordx4 v4, s[12:15], s21 offen lds
 s_add_u32 s21, s21, 61440
 s_add_u32 m0, s22, 81920
 s_nop 0
 buffer_load_dwordx4 v4, s[12:15], s21 offen lds
 s_add_u32 s21, s21, 61440
 s_add_u32 m0, s22, 86016
 s_nop 0
 buffer_load_dwordx4 v4, s[12:15], s21 offen lds
 s_add_u32 s21, s21, 61440
 s_add_u32 m0, s22, 90112
 s_nop 0
 buffer_load_dwordx4 v4, s[12:15], s21 offen lds
 s_add_u32 s21, s21, 61440
 s_add_u32 m0, s22, 94208
 s_nop 0
 buffer_load_dwordx4 v4, s[12:15], s21 offen lds
 s_add_u32 s21, s21, 61440
 s_add_u32 m0, s22, 98304
 s_nop 0
 buffer_load_dwordx4 v4, s[12:15], s21 offen lds
 s_add_u32 s21, s21, 61440
 s_add_u32 m0, s22, 102400
 s_nop 0
 buffer_load_dwordx4 v4, s[12:15], s21 offen lds
 s_add_u32 s21, s21, 61440
 s_add_u32 m0, s22, 106496
 s_nop 0
 buffer_load_dwordx4 v4, s[12:15], s21 offen lds
 s_add_u32 s21, s21, 61440
 s_add_u32 m0, s22, 110592
 s_nop 0
 buffer_load_dwordx4 v4, s[12:15], s21 offen lds
 s_add_u32 s21, s21, 61440
 s_add_u32 m0, s22, 114688
 s_nop 0
 buffer_load_dwordx4 v4, s[12:15], s21 offen lds
 s_add_u32 s21, s21, 61440
 s_add_u32 m0, s22, 118784
 s_nop 0
 buffer_load_dwordx4 v4, s[12:15], s21 offen lds
 s_add_u32 s21, s21, 61440
 s_add_u32 m0, s22, 122880
 s_nop 0
 buffer_load_dwordx4 v4, s[12:15], s21 offen lds
 s_add_u32 s21, s21, 61440
 s_add_u32 m0, s22, 126976
 s_nop 0
 buffer_load_dwordx4 v4, s[12:15], s21 offen lds
 s_add_u32 s21, s21, 61440
 s_add_u32 m0, s22, 131072
 s_nop 0
 buffer_load_dwordx4 v4, s[12:15], s21 offen lds
 s_add_u32 s21, s21, 61440
 s_add_u32 m0, s22, 135168
 s_nop 0
 buffer_load_dwordx4 v4, s[12:15], s21 offen lds
 s_add_u32 s21, s21, 61440
 s_add_u32 m0, s22, 139264
 s_nop 0
 buffer_load_dwordx4 v4, s[12:15], s21 offen lds
 s_add_u32 s21, s21, 61440
 s_add_u32 m0, s22, 143360
 s_nop 0
 buffer_load_dwordx4 v4, s[12:15], s21 offen lds
 s_add_u32 s21, s21, 61440
 s_add_u32 m0, s22, 147456
 s_nop 0
 buffer_load_dwordx4 v4, s[12:15], s21 offen lds
 s_add_u32 s21, s21, 61440
 s_add_u32 m0, s22, 151552
 s_nop 0
 buffer_load_dwordx4 v4, s[12:15], s21 offen lds
 s_add_u32 s21, s21, 61440
 s_add_u32 m0, s22, 155648
 s_nop 0
 buffer_load_dwordx4 v4, s[12:15], s21 offen lds
 s_add_u32 s21, s21, 61440
 s_add_u32 m0, s22, 159744
 s_nop 0
 buffer_load_dwordx4 v4, s[12:15], s21 offen lds
 s_add_u32 s21, s21, 61440
 s_lshl_b32 s21, s2, 2
 s_add_u32 s21, s21, s20
 s_mul_i32 s21, s21, 20480
 v_lshlrev_b32 v5, 4, v1
 buffer_load_dwordx4 v[64:67], v5, s[8:11], s21 offen offset:0
 buffer_load_dwordx4 v[64:67], v5, s[8:11], s21 offen offset:1024
 buffer_load_dwordx4 v[64:67], v5, s[8:11], s21 offen offset:2048
 buffer_load_dwordx4 v[64:67], v5, s[8:11], s21 offen offset:3072
 s_add_u32 s21, s21, 4096
 buffer_load_dwordx4 v[64:67], v5, s[8:11], s21 offen offset:0
 buffer_load_dwordx4 v[64:67], v5, s[8:11], s21 offen offset:1024
 buffer_load_dwordx4 v[64:67], v5, s[8:11], s21 offen offset:2048
 buffer_load_dwordx4 v[64:67], v5, s[8:11], s21 offen offset:3072
 s_add_u32 s21, s21, 4096
 buffer_load_dwordx4 v[64:67], v5, s[8:11], s21 offen offset:0
 buffer_load_dwordx4 v[64:67], v5, s[8:11], s21 offen offset:1024
 buffer_load_dwordx4 v[64:67], v5, s[8:11], s21 offen offset:2048
 buffer_load_dwordx4 v[64:67], v5, s[8:11], s21 offen offset:3072
 s_add_u32 s21, s21, 4096
 buffer_load_dwordx4 v[64:67], v5, s[8:11], s21 offen offset:0
 buffer_load_dwordx4 v[64:67], v5, s[8:11], s21 offen offset:1024
 buffer_load_dwordx4 v[64:67], v5, s[8:11], s21 offen offset:2048
 buffer_load_dwordx4 v[64:67], v5, s[8:11], s21 offen offset:3072
 s_add_u32 s21, s21, 4096
 buffer_load_dwordx4 v[64:67], v5, s[8:11], s21 offen offset:0
 buffer_load_dwordx4 v[64:67], v5, s[8:11], s21 offen offset:1024
 buffer_load_dwordx4 v[64:67], v5, s[8:11], s21 offen offset:2048
 buffer_load_dwordx4 v[64:67], v5, s[8:11], s21 offen offset:3072
 v_lshrrev_b32 v6, 2, v2
 v_lshl_add_u32 v7, v3, 3, v6
 v_and_b32 v8, 1, v3
 v_lshl_add_u32 v6, v8, 2, v6
 v_lshlrev_b32 v6, 1, v6
 v_bfe_u32 v8, v2, 1, 1
 s_lshl_b32 s21, s20, 2
 v_add_u32 v8, s21, v8
 v_and_b32 v9, 1, v2
 v_lshlrev_b32 v9, 3, v9
 v_lshl_add_u32 v9, v7, 8, v9
 v_add_u32 v5, 0, v8
 v_xor_b32 v5, v5, v6
 v_lshl_add_u32 v44, v5, 4, v9
 v_add_u32 v45, 65536, v44
 v_add_u32 v46, 131072, v44
 v_add_u32 v5, 2, v8
 v_xor_b32 v5, v5, v6
 v_lshl_add_u32 v47, v5, 4, v9
 v_add_u32 v48, 65536, v47
 v_add_u32 v49, 131072, v47
 s_waitcnt vmcnt(50) lgkmcnt(0)
 s_barrier
 ds_read_b64_tr_b16 a[0:1], v44 offset:0
 ds_read_b64_tr_b16 a[2:3], v44 offset:1024
 ds_read_b64_tr_b16 a[4:5], v47 offset:0
 ds_read_b64_tr_b16 a[6:7], v47 offset:1024
 ds_read_b64_tr_b16 a[8:9], v44 offset:8192
 ds_read_b64_tr_b16 a[10:11], v44 offset:9216
 ds_read_b64_tr_b16 a[12:13], v47 offset:8192
 ds_read_b64_tr_b16 a[14:15], v47 offset:9216
 ds_read_b64_tr_b16 a[16:17], v44 offset:16384
 ds_read_b64_tr_b16 a[18:19], v44 offset:17408
 ds_read_b64_tr_b16 a[20:21], v47 offset:16384
 ds_read_b64_tr_b16 a[22:23], v47 offset:17408
 ds_read_b64_tr_b16 a[24:25], v44 offset:24576
 ds_read_b64_tr_b16 a[26:27], v44 offset:25600
 ds_read_b64_tr_b16 a[28:29], v47 offset:24576
 ds_read_b64_tr_b16 a[30:31], v47 offset:25600
 ds_read_b64_tr_b16 a[32:33], v44 offset:32768
 ds_read_b64_tr_b16 a[34:35], v44 offset:33792
 ds_read_b64_tr_b16 a[36:37], v47 offset:32768
 ds_read_b64_tr_b16 a[38:39], v47 offset:33792
 s_waitcnt vmcnt(40) lgkmcnt(0)
 s_barrier
 ds_read_b64_tr_b16 a[40:41], v44 offset:40960
 ds_read_b64_tr_b16 a[42:43], v44 offset:41984
 ds_read_b64_tr_b16 a[44:45], v47 offset:40960
 ds_read_b64_tr_b16 a[46:47], v47 offset:41984
 ds_read_b64_tr_b16 a[48:49], v44 offset:49152
 ds_read_b64_tr_b16 a[50:51], v44 offset:50176
 ds_read_b64_tr_b16 a[52:53], v47 offset:49152
 ds_read_b64_tr_b16 a[54:55], v47 offset:50176
 ds_read_b64_tr_b16 a[56:57], v44 offset:57344
 ds_read_b64_tr_b16 a[58:59], v44 offset:58368
 ds_read_b64_tr_b16 a[60:61], v47 offset:57344
 ds_read_b64_tr_b16 a[62:63], v47 offset:58368
 ds_read_b64_tr_b16 a[64:65], v45 offset:0
 ds_read_b64_tr_b16 a[66:67], v45 offset:1024
 ds_read_b64_tr_b16 a[68:69], v48 offset:0
 ds_read_b64_tr_b16 a[70:71], v48 offset:1024
 ds_read_b64_tr_b16 a[72:73], v45 offset:8192
 ds_read_b64_tr_b16 a[74:75], v45 offset:9216
 ds_read_b64_tr_b16 a[76:77], v48 offset:8192
 ds_read_b64_tr_b16 a[78:79], v48 offset:9216
 s_waitcnt vmcnt(30) lgkmcnt(0)
 s_barrier
 s_mul_i32 s24, s42, 1280
 v_lshrrev_b32 v11, 3, v1
 v_and_b32 v12, 7, v1
 v_xor_b32 v12, v12, v11
 v_mul_u32_u24 v11, 2560, v11
 v_lshl_add_u32 v10, v12, 4, v11
 s_mul_i32 s46, s20, 81920
 v_add_u32 v10, s46, v10
 s_lshl_b32 s47, s20, 12
 s_add_u32 s47, s47, 0
 s_add_u32 s46, s47, 114688
 s_mov_b32 s30, s24
 s_add_u32 s32, s47, 0
 v_add_u32 v11, 19456, v10
 v_add_u32 v12, 38912, v10
 v_add_u32 v13, 58368, v10
 s_mov_b32 m0, s32
 s_nop 0
 buffer_load_dwordx4 v10, s[8:11], s30 offen offset:0 lds
 buffer_load_dwordx4 v11, s[8:11], s30 offen offset:1024 lds
 buffer_load_dwordx4 v12, s[8:11], s30 offen offset:2048 lds
 buffer_load_dwordx4 v13, s[8:11], s30 offen offset:3072 lds
 s_add_u32 s30, s30, 128
 s_add_u32 s32, s32, 16384
 s_cmp_lt_u32 s32, s46
 s_cselect_b32 s32, s32, s47
 s_mov_b32 m0, s32
 s_nop 0
 buffer_load_dwordx4 v10, s[8:11], s30 offen offset:0 lds
 buffer_load_dwordx4 v11, s[8:11], s30 offen offset:1024 lds
 buffer_load_dwordx4 v12, s[8:11], s30 offen offset:2048 lds
 buffer_load_dwordx4 v13, s[8:11], s30 offen offset:3072 lds
 s_add_u32 s30, s30, 128
 s_add_u32 s32, s32, 16384
 s_cmp_lt_u32 s32, s46
 s_cselect_b32 s32, s32, s47
 s_mov_b32 m0, s32
 s_nop 0
 buffer_load_dwordx4 v10, s[8:11], s30 offen offset:0 lds
 buffer_load_dwordx4 v11, s[8:11], s30 offen offset:1024 lds
 buffer_load_dwordx4 v12, s[8:11], s30 offen offset:2048 lds
 buffer_load_dwordx4 v13, s[8:11], s30 offen offset:3072 lds
 s_add_u32 s30, s30, 128
 s_add_u32 s32, s32, 16384
 s_cmp_lt_u32 s32, s46
 s_cselect_b32 s32, s32, s47
 s_mov_b32 m0, s32
 s_nop 0
 buffer_load_dwordx4 v10, s[8:11], s30 offen offset:0 lds
 buffer_load_dwordx4 v11, s[8:11], s30 offen offset:1024 lds
 buffer_load_dwordx4 v12, s[8:11], s30 offen offset:2048 lds
 buffer_load_dwordx4 v13, s[8:11], s30 offen offset:3072 lds
 s_add_u32 s30, s30, 128
 s_add_u32 s32, s32, 16384
 s_cmp_lt_u32 s32, s46
 s_cselect_b32 s32, s32, s47
 s_mov_b32 m0, s32
 s_nop 0
 buffer_load_dwordx4 v10, s[8:11], s30 offen offset:0 lds
 buffer_load_dwordx4 v11, s[8:11], s30 offen offset:1024 lds
 buffer_load_dwordx4 v12, s[8:11], s30 offen offset:2048 lds
 buffer_load_dwordx4 v13, s[8:11], s30 offen offset:3072 lds
 s_add_u32 s30, s30, 128
 s_add_u32 s32, s32, 16384
 s_cmp_lt_u32 s32, s46
 s_cselect_b32 s32, s32, s47
 ds_read_b64_tr_b16 a[80:81], v45 offset:16384
 ds_read_b64_tr_b16 a[82:83], v45 offset:17408
 ds_read_b64_tr_b16 a[84:85], v48 offset:16384
 ds_read_b64_tr_b16 a[86:87], v48 offset:17408
 ds_read_b64_tr_b16 a[88:89], v45 offset:24576
 ds_read_b64_tr_b16 a[90:91], v45 offset:25600
 ds_read_b64_tr_b16 a[92:93], v48 offset:24576
 ds_read_b64_tr_b16 a[94:95], v48 offset:25600
 ds_read_b64_tr_b16 a[96:97], v45 offset:32768
 ds_read_b64_tr_b16 a[98:99], v45 offset:33792
 ds_read_b64_tr_b16 a[100:101], v48 offset:32768
 ds_read_b64_tr_b16 a[102:103], v48 offset:33792
 ds_read_b64_tr_b16 a[104:105], v45 offset:40960
 ds_read_b64_tr_b16 a[106:107], v45 offset:41984
 ds_read_b64_tr_b16 a[108:109], v48 offset:40960
 ds_read_b64_tr_b16 a[110:111], v48 offset:41984
 ds_read_b64_tr_b16 a[112:113], v45 offset:49152
 ds_read_b64_tr_b16 a[114:115], v45 offset:50176
 ds_read_b64_tr_b16 a[116:117], v48 offset:49152
 ds_read_b64_tr_b16 a[118:119], v48 offset:50176
 s_waitcnt vmcnt(40) lgkmcnt(0)
 s_barrier
 ds_read_b64_tr_b16 a[120:121], v45 offset:57344
 ds_read_b64_tr_b16 a[122:123], v45 offset:58368
 ds_read_b64_tr_b16 a[124:125], v48 offset:57344
 ds_read_b64_tr_b16 a[126:127], v48 offset:58368
 ds_read_b64_tr_b16 a[128:129], v46 offset:0
 ds_read_b64_tr_b16 a[130:131], v46 offset:1024
 ds_read_b64_tr_b16 a[132:133], v49 offset:0
 ds_read_b64_tr_b16 a[134:135], v49 offset:1024
 ds_read_b64_tr_b16 a[136:137], v46 offset:8192
 ds_read_b64_tr_b16 a[138:139], v46 offset:9216
 ds_read_b64_tr_b16 a[140:141], v49 offset:8192
 ds_read_b64_tr_b16 a[142:143], v49 offset:9216
 ds_read_b64_tr_b16 a[144:145], v46 offset:16384
 ds_read_b64_tr_b16 a[146:147], v46 offset:17408
 ds_read_b64_tr_b16 a[148:149], v49 offset:16384
 ds_read_b64_tr_b16 a[150:151], v49 offset:17408
 ds_read_b64_tr_b16 a[152:153], v46 offset:24576
 ds_read_b64_tr_b16 a[154:155], v46 offset:25600
 ds_read_b64_tr_b16 a[156:157], v49 offset:24576
 ds_read_b64_tr_b16 a[158:159], v49 offset:25600
 s_waitcnt lgkmcnt(0)
 s_barrier
 s_load_dwordx2 s[12:13], s[0:1], 72
 s_lshl_b32 s21, s2, 2
 s_add_u32 s21, s21, s20
 s_mul_i32 s50, s21, 6400
 s_add_u32 s51, s50, 4096
 v_lshlrev_b32 v33, 4, v1
 s_mov_b32 s14, 819200
 v_mov_b32 v32, 76
 s_waitcnt lgkmcnt(0)
 v_and_b32 v4, 31, v1
 s_lshl_b32 s21, s20, 5
 v_add_u32 v36, s21, v4
 v_lshrrev_b32 v5, 5, v1
 v_mul_u32_u24 v6, 264, v36
 v_mul_u32_u24 v7, 40, v5
 s_mov_b32 s21, 114952
 v_add3_u32 v34, v6, v7, s21
 v_lshl_add_u32 v38, v5, 3, v34
 v_lshlrev_b32 v6, 5, v5
 v_sub_u32 v39, v34, v6
 v_lshlrev_b32 v35, 3, v1
 v_add_u32 v35, 114688, v35
 v_mov_b32 v37, 0xf149f2ca
 s_mul_i32 s21, s41, 165120
 s_mul_i32 s22, s42, 16512
 s_add_u32 s21, s21, s22
 v_lshl_add_u32 v7, v36, 4, s21
 v_mul_u32_u24 v6, 99072, v5
 v_add_u32 v29, v6, v7
 v_add_u32 v30, 33024, v29
 v_lshl_add_u32 v31, v5, 3, v7
 v_add_u32 v31, 66048, v31
 v_mov_b32 v8, 0
 v_mov_b32 v9, 0
 ds_write_b64 v35, v[8:9] offset:0
 ds_write_b64 v35, v[8:9] offset:512
 ds_write_b64 v35, v[8:9] offset:1024
 ds_write_b64 v35, v[8:9] offset:1536
 ds_write_b64 v35, v[8:9] offset:2048
 s_mul_i32 s24, s42, 1280
 s_mov_b32 s25, 327680
 s_mov_b32 s26, 8
 s_mov_b32 s27, 0
 s_mov_b32 s60, 0x3e64f92e
 s_mov_b32 s61, 0x3fb8aa3b
 s_mov_b32 s62, 0x05040100
 s_mov_b32 s63, 0x07060302
 v_cmp_le_u32 s[76:77], 0, v36
 v_cmp_le_u32 s[78:79], 1, v36
 v_cmp_le_u32 s[80:81], 2, v36
 v_cmp_le_u32 s[82:83], 3, v36
 v_cmp_le_u32 s[84:85], 4, v36
 v_cmp_le_u32 s[86:87], 5, v36
 v_cmp_le_u32 s[88:89], 6, v36
 v_cmp_le_u32 s[90:91], 7, v36
 v_and_b32 v6, 7, v2
 v_add_u32 v4, 0, v3
 v_xor_b32 v4, v4, v6
 v_lshlrev_b32 v4, 4, v4
 v_lshl_add_u32 v14, v2, 7, v4
 v_add_u32 v4, 4, v3
 v_xor_b32 v4, v4, v6
 v_lshlrev_b32 v4, 4, v4
 v_lshl_add_u32 v15, v2, 7, v4
 v_mul_u32_u24 v22, 264, v2
 v_mul_u32_u24 v4, 8, v3
 s_mul_i32 s21, s20, 64
 s_add_u32 s21, s21, 116800
 v_add3_u32 v22, v22, v4, s21
 v_lshlrev_b32 v4, 3, v3
 v_sub_u32 v16, v22, v4
 v_mov_b32 v9, 2731
 s_mov_b32 s33, 0
 s_mov_b32 s48, 0x80000000
 s_mov_b32 m0, s32
 s_nop 0
 buffer_load_dwordx4 v10, s[8:11], s30 offen offset:0 lds
 buffer_load_dwordx4 v11, s[8:11], s30 offen offset:1024 lds
 s_waitcnt vmcnt(18)
 s_barrier
 v_add_u32 v18, s33, v14
 v_add_u32 v19, s33, v15
 s_add_u32 s33, s33, 16384
 s_cmp_lt_u32 s33, 114688
 s_cselect_b32 s33, s33, 0
 ds_read_b128 v[160:163], v18 offset:0
 ds_read_b128 v[164:167], v18 offset:2048
 ds_read_b128 v[168:171], v18 offset:4096
 ds_read_b128 v[172:175], v18 offset:6144
 ds_read_b128 v[176:179], v18 offset:8192
 ds_read_b128 v[180:183], v18 offset:10240
 ds_read_b128 v[184:187], v18 offset:12288
 ds_read_b128 v[188:191], v18 offset:14336
 s_waitcnt lgkmcnt(0)
bf_blk_190:
 v_mfma_f32_16x16x32_bf16 v[64:67], a[0:3], v[160:163], 0
 ds_read_b128 v[192:195], v19 offset:0
 v_mfma_f32_16x16x32_bf16 v[68:71], a[4:7], v[160:163], 0
 v_add_u32 v18, s33, v14
 v_mfma_f32_16x16x32_bf16 v[72:75], a[0:3], v[164:167], 0
 ds_read_b128 v[196:199], v19 offset:2048
 v_mfma_f32_16x16x32_bf16 v[76:79], a[4:7], v[164:167], 0
 buffer_load_dwordx4 v12, s[8:11], s30 offen offset:2048 lds
 v_mfma_f32_16x16x32_bf16 v[80:83], a[0:3], v[168:171], 0
 ds_read_b128 v[200:203], v19 offset:4096
 v_mfma_f32_16x16x32_bf16 v[84:87], a[4:7], v[168:171], 0
 v_mfma_f32_16x16x32_bf16 v[88:91], a[0:3], v[172:175], 0
 ds_read_b128 v[204:207], v19 offset:6144
 v_mfma_f32_16x16x32_bf16 v[92:95], a[4:7], v[172:175], 0
 s_waitcnt lgkmcnt(14)
 v_mfma_f32_16x16x32_bf16 v[96:99], a[0:3], v[176:179], 0
 ds_read_b128 v[208:211], v19 offset:8192
 v_mfma_f32_16x16x32_bf16 v[100:103], a[4:7], v[176:179], 0
 v_mfma_f32_16x16x32_bf16 v[104:107], a[0:3], v[180:183], 0
 ds_read_b128 v[212:215], v19 offset:10240
 v_mfma_f32_16x16x32_bf16 v[108:111], a[4:7], v[180:183], 0
 buffer_load_dwordx4 v13, s[8:11], s30 offen offset:3072 lds
 v_mfma_f32_16x16x32_bf16 v[112:115], a[0:3], v[184:187], 0
 ds_read_b128 v[216:219], v19 offset:12288
 s_add_u32 s30, s30, 128
 v_mfma_f32_16x16x32_bf16 v[116:119], a[4:7], v[184:187], 0
 s_add_u32 m0, m0, 16384
 v_mfma_f32_16x16x32_bf16 v[120:123], a[0:3], v[188:191], 0
 ds_read_b128 v[220:223], v19 offset:14336
 v_mfma_f32_16x16x32_bf16 v[124:127], a[4:7], v[188:191], 0
 s_waitcnt vmcnt(16) lgkmcnt(4)
 s_barrier
 v_mfma_f32_16x16x32_bf16 v[64:67], a[8:11], v[192:195], v[64:67]
 ds_read_b128 v[160:163], v18 offset:0
 v_mfma_f32_16x16x32_bf16 v[68:71], a[12:15], v[192:195], v[68:71]
 s_cmp_lt_u32 m0, s46
 s_cselect_b32 m0, m0, s47
 v_mfma_f32_16x16x32_bf16 v[72:75], a[8:11], v[196:199], v[72:75]
 ds_read_b128 v[164:167], v18 offset:2048
 v_add_u32 v19, s33, v15
 v_mfma_f32_16x16x32_bf16 v[76:79], a[12:15], v[196:199], v[76:79]
 buffer_load_dwordx4 v10, s[8:11], s30 offen offset:0 lds
 v_mfma_f32_16x16x32_bf16 v[80:83], a[8:11], v[200:203], v[80:83]
 ds_read_b128 v[168:171], v18 offset:4096
 s_add_u32 s33, s33, 16384
 v_mfma_f32_16x16x32_bf16 v[84:87], a[12:15], v[200:203], v[84:87]
 s_cmp_lt_u32 s33, 114688
 s_cselect_b32 s33, s33, 0
 v_mfma_f32_16x16x32_bf16 v[88:91], a[8:11], v[204:207], v[88:91]
 ds_read_b128 v[172:175], v18 offset:6144
 v_mfma_f32_16x16x32_bf16 v[92:95], a[12:15], v[204:207], v[92:95]
 s_waitcnt lgkmcnt(4)
 v_mfma_f32_16x16x32_bf16 v[96:99], a[8:11], v[208:211], v[96:99]
 ds_read_b128 v[176:179], v18 offset:8192
 v_mfma_f32_16x16x32_bf16 v[100:103], a[12:15], v[208:211], v[100:103]
 v_mfma_f32_16x16x32_bf16 v[104:107], a[8:11], v[212:215], v[104:107]
 ds_read_b128 v[180:183], v18 offset:10240
 v_mfma_f32_16x16x32_bf16 v[108:111], a[12:15], v[212:215], v[108:111]
 buffer_load_dwordx4 v11, s[8:11], s30 offen offset:1024 lds
 v_mfma_f32_16x16x32_bf16 v[112:115], a[8:11], v[216:219], v[112:115]
 ds_read_b128 v[184:187], v18 offset:12288
 v_mfma_f32_16x16x32_bf16 v[116:119], a[12:15], v[216:219], v[116:119]
 v_mfma_f32_16x16x32_bf16 v[120:123], a[8:11], v[220:223], v[120:123]
 ds_read_b128 v[188:191], v18 offset:14336
 v_mfma_f32_16x16x32_bf16 v[124:127], a[12:15], v[220:223], v[124:127]
 s_waitcnt lgkmcnt(4)
 v_mfma_f32_16x16x32_bf16 v[64:67], a[16:19], v[160:163], v[64:67]
 ds_read_b128 v[192:195], v19 offset:0
 v_mfma_f32_16x16x32_bf16 v[68:71], a[20:23], v[160:163], v[68:71]
 v_add_u32 v18, s33, v14
 v_mfma_f32_16x16x32_bf16 v[72:75], a[16:19], v[164:167], v[72:75]
 ds_read_b128 v[196:199], v19 offset:2048
 v_mfma_f32_16x16x32_bf16 v[76:79], a[20:23], v[164:167], v[76:79]
 buffer_load_dwordx4 v12, s[8:11], s30 offen offset:2048 lds
 v_mfma_f32_16x16x32_bf16 v[80:83], a[16:19], v[168:171], v[80:83]
 ds_read_b128 v[200:203], v19 offset:4096
 v_mfma_f32_16x16x32_bf16 v[84:87], a[20:23], v[168:171], v[84:87]
 v_mfma_f32_16x16x32_bf16 v[88:91], a[16:19], v[172:175], v[88:91]
 ds_read_b128 v[204:207], v19 offset:6144
 v_mfma_f32_16x16x32_bf16 v[92:95], a[20:23], v[172:175], v[92:95]
 s_waitcnt lgkmcnt(4)
 v_mfma_f32_16x16x32_bf16 v[96:99], a[16:19], v[176:179], v[96:99]
 ds_read_b128 v[208:211], v19 offset:8192
 v_mfma_f32_16x16x32_bf16 v[100:103], a[20:23], v[176:179], v[100:103]
 v_mfma_f32_16x16x32_bf16 v[104:107], a[16:19], v[180:183], v[104:107]
 ds_read_b128 v[212:215], v19 offset:10240
 v_mfma_f32_16x16x32_bf16 v[108:111], a[20:23], v[180:183], v[108:111]
 buffer_load_dwordx4 v13, s[8:11], s30 offen offset:3072 lds
 v_mfma_f32_16x16x32_bf16 v[112:115], a[16:19], v[184:187], v[112:115]
 ds_read_b128 v[216:219], v19 offset:12288
 s_add_u32 s30, s30, 128
 v_mfma_f32_16x16x32_bf16 v[116:119], a[20:23], v[184:187], v[116:119]
 s_add_u32 m0, m0, 16384
 v_mfma_f32_16x16x32_bf16 v[120:123], a[16:19], v[188:191], v[120:123]
 ds_read_b128 v[220:223], v19 offset:14336
 v_mfma_f32_16x16x32_bf16 v[124:127], a[20:23], v[188:191], v[124:127]
 s_waitcnt vmcnt(16) lgkmcnt(4)
 s_barrier
 v_mfma_f32_16x16x32_bf16 v[64:67], a[24:27], v[192:195], v[64:67]
 ds_read_b128 v[160:163], v18 offset:0
 v_mfma_f32_16x16x32_bf16 v[68:71], a[28:31], v[192:195], v[68:71]
 s_cmp_lt_u32 m0, s46
 s_cselect_b32 m0, m0, s47
 v_mfma_f32_16x16x32_bf16 v[72:75], a[24:27], v[196:199], v[72:75]
 ds_read_b128 v[164:167], v18 offset:2048
 v_add_u32 v19, s33, v15
 v_mfma_f32_16x16x32_bf16 v[76:79], a[28:31], v[196:199], v[76:79]
 buffer_load_dwordx4 v10, s[8:11], s30 offen offset:0 lds
 v_mfma_f32_16x16x32_bf16 v[80:83], a[24:27], v[200:203], v[80:83]
 ds_read_b128 v[168:171], v18 offset:4096
 s_add_u32 s33, s33, 16384
 v_mfma_f32_16x16x32_bf16 v[84:87], a[28:31], v[200:203], v[84:87]
 s_cmp_lt_u32 s33, 114688
 s_cselect_b32 s33, s33, 0
 v_mfma_f32_16x16x32_bf16 v[88:91], a[24:27], v[204:207], v[88:91]
 ds_read_b128 v[172:175], v18 offset:6144
 v_mfma_f32_16x16x32_bf16 v[92:95], a[28:31], v[204:207], v[92:95]
 s_waitcnt lgkmcnt(4)
 v_mfma_f32_16x16x32_bf16 v[96:99], a[24:27], v[208:211], v[96:99]
 ds_read_b128 v[176:179], v18 offset:8192
 v_mfma_f32_16x16x32_bf16 v[100:103], a[28:31], v[208:211], v[100:103]
 v_mfma_f32_16x16x32_bf16 v[104:107], a[24:27], v[212:215], v[104:107]
 ds_read_b128 v[180:183], v18 offset:10240
 v_mfma_f32_16x16x32_bf16 v[108:111], a[28:31], v[212:215], v[108:111]
 buffer_load_dwordx4 v11, s[8:11], s30 offen offset:1024 lds
 v_mfma_f32_16x16x32_bf16 v[112:115], a[24:27], v[216:219], v[112:115]
 ds_read_b128 v[184:187], v18 offset:12288
 v_mfma_f32_16x16x32_bf16 v[116:119], a[28:31], v[216:219], v[116:119]
 v_mfma_f32_16x16x32_bf16 v[120:123], a[24:27], v[220:223], v[120:123]
 ds_read_b128 v[188:191], v18 offset:14336
 v_mfma_f32_16x16x32_bf16 v[124:127], a[28:31], v[220:223], v[124:127]
 s_waitcnt lgkmcnt(4)
 v_mfma_f32_16x16x32_bf16 v[64:67], a[32:35], v[160:163], v[64:67]
 ds_read_b128 v[192:195], v19 offset:0
 v_mfma_f32_16x16x32_bf16 v[68:71], a[36:39], v[160:163], v[68:71]
 v_add_u32 v18, s33, v14
 v_mfma_f32_16x16x32_bf16 v[72:75], a[32:35], v[164:167], v[72:75]
 ds_read_b128 v[196:199], v19 offset:2048
 v_mfma_f32_16x16x32_bf16 v[76:79], a[36:39], v[164:167], v[76:79]
 buffer_load_dwordx4 v12, s[8:11], s30 offen offset:2048 lds
 v_mfma_f32_16x16x32_bf16 v[80:83], a[32:35], v[168:171], v[80:83]
 ds_read_b128 v[200:203], v19 offset:4096
 v_mfma_f32_16x16x32_bf16 v[84:87], a[36:39], v[168:171], v[84:87]
 v_mfma_f32_16x16x32_bf16 v[88:91], a[32:35], v[172:175], v[88:91]
 ds_read_b128 v[204:207], v19 offset:6144
 v_mfma_f32_16x16x32_bf16 v[92:95], a[36:39], v[172:175], v[92:95]
 s_waitcnt lgkmcnt(4)
 v_mfma_f32_16x16x32_bf16 v[96:99], a[32:35], v[176:179], v[96:99]
 ds_read_b128 v[208:211], v19 offset:8192
 v_mfma_f32_16x16x32_bf16 v[100:103], a[36:39], v[176:179], v[100:103]
 v_mfma_f32_16x16x32_bf16 v[104:107], a[32:35], v[180:183], v[104:107]
 ds_read_b128 v[212:215], v19 offset:10240
 v_mfma_f32_16x16x32_bf16 v[108:111], a[36:39], v[180:183], v[108:111]
 buffer_load_dwordx4 v13, s[8:11], s30 offen offset:3072 lds
 v_mfma_f32_16x16x32_bf16 v[112:115], a[32:35], v[184:187], v[112:115]
 ds_read_b128 v[216:219], v19 offset:12288
 s_add_u32 s30, s30, 128
 v_mfma_f32_16x16x32_bf16 v[116:119], a[36:39], v[184:187], v[116:119]
 s_add_u32 m0, m0, 16384
 v_mfma_f32_16x16x32_bf16 v[120:123], a[32:35], v[188:191], v[120:123]
 ds_read_b128 v[220:223], v19 offset:14336
 v_mfma_f32_16x16x32_bf16 v[124:127], a[36:39], v[188:191], v[124:127]
 s_waitcnt vmcnt(16) lgkmcnt(4)
 s_barrier
 v_mfma_f32_16x16x32_bf16 v[64:67], a[40:43], v[192:195], v[64:67]
 ds_read_b128 v[160:163], v18 offset:0
 v_mfma_f32_16x16x32_bf16 v[68:71], a[44:47], v[192:195], v[68:71]
 s_cmp_lt_u32 m0, s46
 s_cselect_b32 m0, m0, s47
 v_mfma_f32_16x16x32_bf16 v[72:75], a[40:43], v[196:199], v[72:75]
 ds_read_b128 v[164:167], v18 offset:2048
 v_add_u32 v19, s33, v15
 v_mfma_f32_16x16x32_bf16 v[76:79], a[44:47], v[196:199], v[76:79]
 buffer_load_dwordx4 v10, s[8:11], s30 offen offset:0 lds
 v_mfma_f32_16x16x32_bf16 v[80:83], a[40:43], v[200:203], v[80:83]
 ds_read_b128 v[168:171], v18 offset:4096
 s_add_u32 s33, s33, 16384
 v_mfma_f32_16x16x32_bf16 v[84:87], a[44:47], v[200:203], v[84:87]
 s_cmp_lt_u32 s33, 114688
 s_cselect_b32 s33, s33, 0
 v_mfma_f32_16x16x32_bf16 v[88:91], a[40:43], v[204:207], v[88:91]
 ds_read_b128 v[172:175], v18 offset:6144
 v_mfma_f32_16x16x32_bf16 v[92:95], a[44:47], v[204:207], v[92:95]
 s_waitcnt lgkmcnt(4)
 v_mfma_f32_16x16x32_bf16 v[96:99], a[40:43], v[208:211], v[96:99]
 ds_read_b128 v[176:179], v18 offset:8192
 v_mfma_f32_16x16x32_bf16 v[100:103], a[44:47], v[208:211], v[100:103]
 v_mfma_f32_16x16x32_bf16 v[104:107], a[40:43], v[212:215], v[104:107]
 ds_read_b128 v[180:183], v18 offset:10240
 v_mfma_f32_16x16x32_bf16 v[108:111], a[44:47], v[212:215], v[108:111]
 buffer_load_dwordx4 v11, s[8:11], s30 offen offset:1024 lds
 v_mfma_f32_16x16x32_bf16 v[112:115], a[40:43], v[216:219], v[112:115]
 ds_read_b128 v[184:187], v18 offset:12288
 v_mfma_f32_16x16x32_bf16 v[116:119], a[44:47], v[216:219], v[116:119]
 v_mfma_f32_16x16x32_bf16 v[120:123], a[40:43], v[220:223], v[120:123]
 ds_read_b128 v[188:191], v18 offset:14336
 v_mfma_f32_16x16x32_bf16 v[124:127], a[44:47], v[220:223], v[124:127]
 s_waitcnt lgkmcnt(4)
 v_mfma_f32_16x16x32_bf16 v[64:67], a[48:51], v[160:163], v[64:67]
 ds_read_b128 v[192:195], v19 offset:0
 v_mfma_f32_16x16x32_bf16 v[68:71], a[52:55], v[160:163], v[68:71]
 v_add_u32 v18, s33, v14
 v_mfma_f32_16x16x32_bf16 v[72:75], a[48:51], v[164:167], v[72:75]
 ds_read_b128 v[196:199], v19 offset:2048
 v_mfma_f32_16x16x32_bf16 v[76:79], a[52:55], v[164:167], v[76:79]
 buffer_load_dwordx4 v12, s[8:11], s30 offen offset:2048 lds
 v_mfma_f32_16x16x32_bf16 v[80:83], a[48:51], v[168:171], v[80:83]
 ds_read_b128 v[200:203], v19 offset:4096
 v_mfma_f32_16x16x32_bf16 v[84:87], a[52:55], v[168:171], v[84:87]
 v_mfma_f32_16x16x32_bf16 v[88:91], a[48:51], v[172:175], v[88:91]
 ds_read_b128 v[204:207], v19 offset:6144
 v_mfma_f32_16x16x32_bf16 v[92:95], a[52:55], v[172:175], v[92:95]
 s_waitcnt lgkmcnt(4)
 v_mfma_f32_16x16x32_bf16 v[96:99], a[48:51], v[176:179], v[96:99]
 ds_read_b128 v[208:211], v19 offset:8192
 v_mfma_f32_16x16x32_bf16 v[100:103], a[52:55], v[176:179], v[100:103]
 v_mfma_f32_16x16x32_bf16 v[104:107], a[48:51], v[180:183], v[104:107]
 ds_read_b128 v[212:215], v19 offset:10240
 v_mfma_f32_16x16x32_bf16 v[108:111], a[52:55], v[180:183], v[108:111]
 buffer_load_dwordx4 v13, s[8:11], s30 offen offset:3072 lds
 v_mfma_f32_16x16x32_bf16 v[112:115], a[48:51], v[184:187], v[112:115]
 ds_read_b128 v[216:219], v19 offset:12288
 s_add_u32 s30, s30, 128
 v_mfma_f32_16x16x32_bf16 v[116:119], a[52:55], v[184:187], v[116:119]
 s_add_u32 m0, m0, 16384
 v_mfma_f32_16x16x32_bf16 v[120:123], a[48:51], v[188:191], v[120:123]
 ds_read_b128 v[220:223], v19 offset:14336
 v_mfma_f32_16x16x32_bf16 v[124:127], a[52:55], v[188:191], v[124:127]
 s_waitcnt vmcnt(16) lgkmcnt(4)
 s_barrier
 v_mfma_f32_16x16x32_bf16 v[64:67], a[56:59], v[192:195], v[64:67]
 ds_read_b128 v[160:163], v18 offset:0
 v_mfma_f32_16x16x32_bf16 v[68:71], a[60:63], v[192:195], v[68:71]
 s_cmp_lt_u32 m0, s46
 s_cselect_b32 m0, m0, s47
 v_mfma_f32_16x16x32_bf16 v[72:75], a[56:59], v[196:199], v[72:75]
 ds_read_b128 v[164:167], v18 offset:2048
 v_add_u32 v19, s33, v15
 v_mfma_f32_16x16x32_bf16 v[76:79], a[60:63], v[196:199], v[76:79]
 buffer_load_dwordx4 v10, s[8:11], s30 offen offset:0 lds
 v_mfma_f32_16x16x32_bf16 v[80:83], a[56:59], v[200:203], v[80:83]
 ds_read_b128 v[168:171], v18 offset:4096
 s_add_u32 s33, s33, 16384
 v_mfma_f32_16x16x32_bf16 v[84:87], a[60:63], v[200:203], v[84:87]
 s_cmp_lt_u32 s33, 114688
 s_cselect_b32 s33, s33, 0
 v_mfma_f32_16x16x32_bf16 v[88:91], a[56:59], v[204:207], v[88:91]
 ds_read_b128 v[172:175], v18 offset:6144
 v_mfma_f32_16x16x32_bf16 v[92:95], a[60:63], v[204:207], v[92:95]
 s_waitcnt lgkmcnt(4)
 v_mfma_f32_16x16x32_bf16 v[96:99], a[56:59], v[208:211], v[96:99]
 ds_read_b128 v[176:179], v18 offset:8192
 v_mfma_f32_16x16x32_bf16 v[100:103], a[60:63], v[208:211], v[100:103]
 v_mfma_f32_16x16x32_bf16 v[104:107], a[56:59], v[212:215], v[104:107]
 ds_read_b128 v[180:183], v18 offset:10240
 v_mfma_f32_16x16x32_bf16 v[108:111], a[60:63], v[212:215], v[108:111]
 buffer_load_dwordx4 v11, s[8:11], s30 offen offset:1024 lds
 v_mfma_f32_16x16x32_bf16 v[112:115], a[56:59], v[216:219], v[112:115]
 ds_read_b128 v[184:187], v18 offset:12288
 v_mfma_f32_16x16x32_bf16 v[116:119], a[60:63], v[216:219], v[116:119]
 v_mfma_f32_16x16x32_bf16 v[120:123], a[56:59], v[220:223], v[120:123]
 ds_read_b128 v[188:191], v18 offset:14336
 v_mfma_f32_16x16x32_bf16 v[124:127], a[60:63], v[220:223], v[124:127]
 s_waitcnt lgkmcnt(4)
 v_mfma_f32_16x16x32_bf16 v[64:67], a[64:67], v[160:163], v[64:67]
 ds_read_b128 v[192:195], v19 offset:0
 v_mfma_f32_16x16x32_bf16 v[68:71], a[68:71], v[160:163], v[68:71]
 v_add_u32 v18, s33, v14
 v_mfma_f32_16x16x32_bf16 v[72:75], a[64:67], v[164:167], v[72:75]
 ds_read_b128 v[196:199], v19 offset:2048
 v_mfma_f32_16x16x32_bf16 v[76:79], a[68:71], v[164:167], v[76:79]
 buffer_load_dwordx4 v12, s[8:11], s30 offen offset:2048 lds
 v_mfma_f32_16x16x32_bf16 v[80:83], a[64:67], v[168:171], v[80:83]
 ds_read_b128 v[200:203], v19 offset:4096
 v_mfma_f32_16x16x32_bf16 v[84:87], a[68:71], v[168:171], v[84:87]
 v_mfma_f32_16x16x32_bf16 v[88:91], a[64:67], v[172:175], v[88:91]
 ds_read_b128 v[204:207], v19 offset:6144
 v_mfma_f32_16x16x32_bf16 v[92:95], a[68:71], v[172:175], v[92:95]
 s_waitcnt lgkmcnt(4)
 v_mfma_f32_16x16x32_bf16 v[96:99], a[64:67], v[176:179], v[96:99]
 ds_read_b128 v[208:211], v19 offset:8192
 v_mfma_f32_16x16x32_bf16 v[100:103], a[68:71], v[176:179], v[100:103]
 v_mfma_f32_16x16x32_bf16 v[104:107], a[64:67], v[180:183], v[104:107]
 ds_read_b128 v[212:215], v19 offset:10240
 v_mfma_f32_16x16x32_bf16 v[108:111], a[68:71], v[180:183], v[108:111]
 buffer_load_dwordx4 v13, s[8:11], s30 offen offset:3072 lds
 v_mfma_f32_16x16x32_bf16 v[112:115], a[64:67], v[184:187], v[112:115]
 ds_read_b128 v[216:219], v19 offset:12288
 s_add_u32 s30, s30, s25
 v_mfma_f32_16x16x32_bf16 v[116:119], a[68:71], v[184:187], v[116:119]
 s_sub_u32 s30, s30, 1152
 s_add_u32 m0, m0, 16384
 v_mfma_f32_16x16x32_bf16 v[120:123], a[64:67], v[188:191], v[120:123]
 ds_read_b128 v[220:223], v19 offset:14336
 v_mfma_f32_16x16x32_bf16 v[124:127], a[68:71], v[188:191], v[124:127]
 s_waitcnt vmcnt(16) lgkmcnt(4)
 s_barrier
 v_mfma_f32_16x16x32_bf16 v[64:67], a[72:75], v[192:195], v[64:67]
 ds_read_b128 v[160:163], v18 offset:0
 v_mfma_f32_16x16x32_bf16 v[68:71], a[76:79], v[192:195], v[68:71]
 s_cmp_lt_u32 m0, s46
 s_cselect_b32 m0, m0, s47
 v_mfma_f32_16x16x32_bf16 v[72:75], a[72:75], v[196:199], v[72:75]
 ds_read_b128 v[164:167], v18 offset:2048
 v_add_u32 v19, s33, v15
 v_mfma_f32_16x16x32_bf16 v[76:79], a[76:79], v[196:199], v[76:79]
 buffer_load_dwordx4 v10, s[8:11], s30 offen offset:0 lds
 v_mfma_f32_16x16x32_bf16 v[80:83], a[72:75], v[200:203], v[80:83]
 ds_read_b128 v[168:171], v18 offset:4096
 s_add_u32 s33, s33, 16384
 v_mfma_f32_16x16x32_bf16 v[84:87], a[76:79], v[200:203], v[84:87]
 s_cmp_lt_u32 s33, 114688
 s_cselect_b32 s33, s33, 0
 v_mfma_f32_16x16x32_bf16 v[88:91], a[72:75], v[204:207], v[88:91]
 ds_read_b128 v[172:175], v18 offset:6144
 v_mfma_f32_16x16x32_bf16 v[92:95], a[76:79], v[204:207], v[92:95]
 s_waitcnt lgkmcnt(4)
 v_mfma_f32_16x16x32_bf16 v[96:99], a[72:75], v[208:211], v[96:99]
 ds_read_b128 v[176:179], v18 offset:8192
 v_mfma_f32_16x16x32_bf16 v[100:103], a[76:79], v[208:211], v[100:103]
 v_mfma_f32_16x16x32_bf16 v[104:107], a[72:75], v[212:215], v[104:107]
 ds_read_b128 v[180:183], v18 offset:10240
 v_mfma_f32_16x16x32_bf16 v[108:111], a[76:79], v[212:215], v[108:111]
 buffer_load_dwordx4 v11, s[8:11], s30 offen offset:1024 lds
 v_mfma_f32_16x16x32_bf16 v[112:115], a[72:75], v[216:219], v[112:115]
 ds_read_b128 v[184:187], v18 offset:12288
 v_mfma_f32_16x16x32_bf16 v[116:119], a[76:79], v[216:219], v[116:119]
 v_mfma_f32_16x16x32_bf16 v[120:123], a[72:75], v[220:223], v[120:123]
 ds_read_b128 v[188:191], v18 offset:14336
 v_mfma_f32_16x16x32_bf16 v[124:127], a[76:79], v[220:223], v[124:127]
 s_waitcnt lgkmcnt(4)
 v_mfma_f32_16x16x32_bf16 v[64:67], a[80:83], v[160:163], v[64:67]
 ds_read_b128 v[192:195], v19 offset:0
 v_mfma_f32_16x16x32_bf16 v[68:71], a[84:87], v[160:163], v[68:71]
 v_add_u32 v18, s33, v14
 v_mfma_f32_16x16x32_bf16 v[72:75], a[80:83], v[164:167], v[72:75]
 ds_read_b128 v[196:199], v19 offset:2048
 v_mfma_f32_16x16x32_bf16 v[76:79], a[84:87], v[164:167], v[76:79]
 buffer_load_dwordx4 v12, s[8:11], s30 offen offset:2048 lds
 v_mfma_f32_16x16x32_bf16 v[80:83], a[80:83], v[168:171], v[80:83]
 ds_read_b128 v[200:203], v19 offset:4096
 v_mfma_f32_16x16x32_bf16 v[84:87], a[84:87], v[168:171], v[84:87]
 v_mfma_f32_16x16x32_bf16 v[88:91], a[80:83], v[172:175], v[88:91]
 ds_read_b128 v[204:207], v19 offset:6144
 v_mfma_f32_16x16x32_bf16 v[92:95], a[84:87], v[172:175], v[92:95]
 s_waitcnt lgkmcnt(4)
 v_mfma_f32_16x16x32_bf16 v[96:99], a[80:83], v[176:179], v[96:99]
 ds_read_b128 v[208:211], v19 offset:8192
 v_mfma_f32_16x16x32_bf16 v[100:103], a[84:87], v[176:179], v[100:103]
 v_mfma_f32_16x16x32_bf16 v[104:107], a[80:83], v[180:183], v[104:107]
 ds_read_b128 v[212:215], v19 offset:10240
 v_mfma_f32_16x16x32_bf16 v[108:111], a[84:87], v[180:183], v[108:111]
 buffer_load_dwordx4 v13, s[8:11], s30 offen offset:3072 lds
 v_mfma_f32_16x16x32_bf16 v[112:115], a[80:83], v[184:187], v[112:115]
 ds_read_b128 v[216:219], v19 offset:12288
 s_add_u32 s30, s30, 128
 v_mfma_f32_16x16x32_bf16 v[116:119], a[84:87], v[184:187], v[116:119]
 s_add_u32 m0, m0, 16384
 v_mfma_f32_16x16x32_bf16 v[120:123], a[80:83], v[188:191], v[120:123]
 ds_read_b128 v[220:223], v19 offset:14336
 v_mfma_f32_16x16x32_bf16 v[124:127], a[84:87], v[188:191], v[124:127]
 s_waitcnt vmcnt(16) lgkmcnt(4)
 s_barrier
 v_mfma_f32_16x16x32_bf16 v[64:67], a[88:91], v[192:195], v[64:67]
 ds_read_b128 v[160:163], v18 offset:0
 v_mfma_f32_16x16x32_bf16 v[68:71], a[92:95], v[192:195], v[68:71]
 s_cmp_lt_u32 m0, s46
 s_cselect_b32 m0, m0, s47
 v_mfma_f32_16x16x32_bf16 v[72:75], a[88:91], v[196:199], v[72:75]
 ds_read_b128 v[164:167], v18 offset:2048
 v_add_u32 v19, s33, v15
 v_mfma_f32_16x16x32_bf16 v[76:79], a[92:95], v[196:199], v[76:79]
 buffer_load_dwordx4 v10, s[8:11], s30 offen offset:0 lds
 v_mfma_f32_16x16x32_bf16 v[80:83], a[88:91], v[200:203], v[80:83]
 ds_read_b128 v[168:171], v18 offset:4096
 s_add_u32 s33, s33, 16384
 v_mfma_f32_16x16x32_bf16 v[84:87], a[92:95], v[200:203], v[84:87]
 s_cmp_lt_u32 s33, 114688
 s_cselect_b32 s33, s33, 0
 v_mfma_f32_16x16x32_bf16 v[88:91], a[88:91], v[204:207], v[88:91]
 ds_read_b128 v[172:175], v18 offset:6144
 v_mfma_f32_16x16x32_bf16 v[92:95], a[92:95], v[204:207], v[92:95]
 s_waitcnt lgkmcnt(4)
 v_mfma_f32_16x16x32_bf16 v[96:99], a[88:91], v[208:211], v[96:99]
 ds_read_b128 v[176:179], v18 offset:8192
 v_mfma_f32_16x16x32_bf16 v[100:103], a[92:95], v[208:211], v[100:103]
 v_mfma_f32_16x16x32_bf16 v[104:107], a[88:91], v[212:215], v[104:107]
 ds_read_b128 v[180:183], v18 offset:10240
 v_mfma_f32_16x16x32_bf16 v[108:111], a[92:95], v[212:215], v[108:111]
 buffer_load_dwordx4 v11, s[8:11], s30 offen offset:1024 lds
 v_mfma_f32_16x16x32_bf16 v[112:115], a[88:91], v[216:219], v[112:115]
 ds_read_b128 v[184:187], v18 offset:12288
 v_mfma_f32_16x16x32_bf16 v[116:119], a[92:95], v[216:219], v[116:119]
 v_mfma_f32_16x16x32_bf16 v[120:123], a[88:91], v[220:223], v[120:123]
 ds_read_b128 v[188:191], v18 offset:14336
 v_mfma_f32_16x16x32_bf16 v[124:127], a[92:95], v[220:223], v[124:127]
 s_waitcnt lgkmcnt(4)
 v_mfma_f32_16x16x32_bf16 v[64:67], a[96:99], v[160:163], v[64:67]
 ds_read_b128 v[192:195], v19 offset:0
 v_mfma_f32_16x16x32_bf16 v[68:71], a[100:103], v[160:163], v[68:71]
 v_add_u32 v18, s33, v14
 v_mfma_f32_16x16x32_bf16 v[72:75], a[96:99], v[164:167], v[72:75]
 ds_read_b128 v[196:199], v19 offset:2048
 v_mfma_f32_16x16x32_bf16 v[76:79], a[100:103], v[164:167], v[76:79]
 buffer_load_dwordx4 v12, s[8:11], s30 offen offset:2048 lds
 v_mfma_f32_16x16x32_bf16 v[80:83], a[96:99], v[168:171], v[80:83]
 ds_read_b128 v[200:203], v19 offset:4096
 v_mfma_f32_16x16x32_bf16 v[84:87], a[100:103], v[168:171], v[84:87]
 v_mfma_f32_16x16x32_bf16 v[88:91], a[96:99], v[172:175], v[88:91]
 ds_read_b128 v[204:207], v19 offset:6144
 v_mfma_f32_16x16x32_bf16 v[92:95], a[100:103], v[172:175], v[92:95]
 s_waitcnt lgkmcnt(4)
 v_mfma_f32_16x16x32_bf16 v[96:99], a[96:99], v[176:179], v[96:99]
 ds_read_b128 v[208:211], v19 offset:8192
 v_mfma_f32_16x16x32_bf16 v[100:103], a[100:103], v[176:179], v[100:103]
 v_mfma_f32_16x16x32_bf16 v[104:107], a[96:99], v[180:183], v[104:107]
 ds_read_b128 v[212:215], v19 offset:10240
 v_mfma_f32_16x16x32_bf16 v[108:111], a[100:103], v[180:183], v[108:111]
 buffer_load_dwordx4 v13, s[8:11], s30 offen offset:3072 lds
 v_mfma_f32_16x16x32_bf16 v[112:115], a[96:99], v[184:187], v[112:115]
 ds_read_b128 v[216:219], v19 offset:12288
 s_add_u32 s30, s30, 128
 v_mfma_f32_16x16x32_bf16 v[116:119], a[100:103], v[184:187], v[116:119]
 s_add_u32 m0, m0, 16384
 v_mfma_f32_16x16x32_bf16 v[120:123], a[96:99], v[188:191], v[120:123]
 ds_read_b128 v[220:223], v19 offset:14336
 v_mfma_f32_16x16x32_bf16 v[124:127], a[100:103], v[188:191], v[124:127]
 s_waitcnt vmcnt(16) lgkmcnt(4)
 s_barrier
 v_mfma_f32_16x16x32_bf16 v[64:67], a[104:107], v[192:195], v[64:67]
 ds_read_b128 v[160:163], v18 offset:0
 v_mfma_f32_16x16x32_bf16 v[68:71], a[108:111], v[192:195], v[68:71]
 s_cmp_lt_u32 m0, s46
 s_cselect_b32 m0, m0, s47
 v_mfma_f32_16x16x32_bf16 v[72:75], a[104:107], v[196:199], v[72:75]
 ds_read_b128 v[164:167], v18 offset:2048
 v_add_u32 v19, s33, v15
 v_mfma_f32_16x16x32_bf16 v[76:79], a[108:111], v[196:199], v[76:79]
 buffer_load_dwordx4 v10, s[8:11], s30 offen offset:0 lds
 v_mfma_f32_16x16x32_bf16 v[80:83], a[104:107], v[200:203], v[80:83]
 ds_read_b128 v[168:171], v18 offset:4096
 s_add_u32 s33, s33, 16384
 v_mfma_f32_16x16x32_bf16 v[84:87], a[108:111], v[200:203], v[84:87]
 s_cmp_lt_u32 s33, 114688
 s_cselect_b32 s33, s33, 0
 v_mfma_f32_16x16x32_bf16 v[88:91], a[104:107], v[204:207], v[88:91]
 ds_read_b128 v[172:175], v18 offset:6144
 v_mfma_f32_16x16x32_bf16 v[92:95], a[108:111], v[204:207], v[92:95]
 s_waitcnt lgkmcnt(4)
 v_mfma_f32_16x16x32_bf16 v[96:99], a[104:107], v[208:211], v[96:99]
 ds_read_b128 v[176:179], v18 offset:8192
 v_mfma_f32_16x16x32_bf16 v[100:103], a[108:111], v[208:211], v[100:103]
 v_mfma_f32_16x16x32_bf16 v[104:107], a[104:107], v[212:215], v[104:107]
 ds_read_b128 v[180:183], v18 offset:10240
 v_mfma_f32_16x16x32_bf16 v[108:111], a[108:111], v[212:215], v[108:111]
 buffer_load_dwordx4 v11, s[8:11], s30 offen offset:1024 lds
 v_mfma_f32_16x16x32_bf16 v[112:115], a[104:107], v[216:219], v[112:115]
 ds_read_b128 v[184:187], v18 offset:12288
 v_mfma_f32_16x16x32_bf16 v[116:119], a[108:111], v[216:219], v[116:119]
 v_mfma_f32_16x16x32_bf16 v[120:123], a[104:107], v[220:223], v[120:123]
 ds_read_b128 v[188:191], v18 offset:14336
 v_mfma_f32_16x16x32_bf16 v[124:127], a[108:111], v[220:223], v[124:127]
 s_waitcnt lgkmcnt(4)
 v_mfma_f32_16x16x32_bf16 v[64:67], a[112:115], v[160:163], v[64:67]
 ds_read_b128 v[192:195], v19 offset:0
 v_mfma_f32_16x16x32_bf16 v[68:71], a[116:119], v[160:163], v[68:71]
 v_add_u32 v18, s33, v14
 v_mfma_f32_16x16x32_bf16 v[72:75], a[112:115], v[164:167], v[72:75]
 ds_read_b128 v[196:199], v19 offset:2048
 v_mfma_f32_16x16x32_bf16 v[76:79], a[116:119], v[164:167], v[76:79]
 buffer_load_dwordx4 v12, s[8:11], s30 offen offset:2048 lds
 v_mfma_f32_16x16x32_bf16 v[80:83], a[112:115], v[168:171], v[80:83]
 ds_read_b128 v[200:203], v19 offset:4096
 v_mfma_f32_16x16x32_bf16 v[84:87], a[116:119], v[168:171], v[84:87]
 v_mfma_f32_16x16x32_bf16 v[88:91], a[112:115], v[172:175], v[88:91]
 ds_read_b128 v[204:207], v19 offset:6144
 v_mfma_f32_16x16x32_bf16 v[92:95], a[116:119], v[172:175], v[92:95]
 s_waitcnt lgkmcnt(4)
 v_mfma_f32_16x16x32_bf16 v[96:99], a[112:115], v[176:179], v[96:99]
 ds_read_b128 v[208:211], v19 offset:8192
 v_mfma_f32_16x16x32_bf16 v[100:103], a[116:119], v[176:179], v[100:103]
 v_mfma_f32_16x16x32_bf16 v[104:107], a[112:115], v[180:183], v[104:107]
 ds_read_b128 v[212:215], v19 offset:10240
 v_mfma_f32_16x16x32_bf16 v[108:111], a[116:119], v[180:183], v[108:111]
 buffer_load_dwordx4 v13, s[8:11], s30 offen offset:3072 lds
 v_mfma_f32_16x16x32_bf16 v[112:115], a[112:115], v[184:187], v[112:115]
 ds_read_b128 v[216:219], v19 offset:12288
 s_add_u32 s30, s30, 128
 v_mfma_f32_16x16x32_bf16 v[116:119], a[116:119], v[184:187], v[116:119]
 s_add_u32 m0, m0, 16384
 v_mfma_f32_16x16x32_bf16 v[120:123], a[112:115], v[188:191], v[120:123]
 ds_read_b128 v[220:223], v19 offset:14336
 v_mfma_f32_16x16x32_bf16 v[124:127], a[116:119], v[188:191], v[124:127]
 s_waitcnt vmcnt(16) lgkmcnt(4)
 s_barrier
 v_mfma_f32_16x16x32_bf16 v[64:67], a[120:123], v[192:195], v[64:67]
 ds_read_b128 v[160:163], v18 offset:0
 v_mfma_f32_16x16x32_bf16 v[68:71], a[124:127], v[192:195], v[68:71]
 s_cmp_lt_u32 m0, s46
 s_cselect_b32 m0, m0, s47
 v_mfma_f32_16x16x32_bf16 v[72:75], a[120:123], v[196:199], v[72:75]
 ds_read_b128 v[164:167], v18 offset:2048
 v_add_u32 v19, s33, v15
 v_mfma_f32_16x16x32_bf16 v[76:79], a[124:127], v[196:199], v[76:79]
 buffer_load_dwordx4 v10, s[8:11], s30 offen offset:0 lds
 v_mfma_f32_16x16x32_bf16 v[80:83], a[120:123], v[200:203], v[80:83]
 ds_read_b128 v[168:171], v18 offset:4096
 s_add_u32 s33, s33, 16384
 v_mfma_f32_16x16x32_bf16 v[84:87], a[124:127], v[200:203], v[84:87]
 s_cmp_lt_u32 s33, 114688
 s_cselect_b32 s33, s33, 0
 v_mfma_f32_16x16x32_bf16 v[88:91], a[120:123], v[204:207], v[88:91]
 ds_read_b128 v[172:175], v18 offset:6144
 v_mfma_f32_16x16x32_bf16 v[92:95], a[124:127], v[204:207], v[92:95]
 s_waitcnt lgkmcnt(4)
 v_mfma_f32_16x16x32_bf16 v[96:99], a[120:123], v[208:211], v[96:99]
 ds_read_b128 v[176:179], v18 offset:8192
 v_mfma_f32_16x16x32_bf16 v[100:103], a[124:127], v[208:211], v[100:103]
 v_mfma_f32_16x16x32_bf16 v[104:107], a[120:123], v[212:215], v[104:107]
 ds_read_b128 v[180:183], v18 offset:10240
 v_mfma_f32_16x16x32_bf16 v[108:111], a[124:127], v[212:215], v[108:111]
 buffer_load_dwordx4 v11, s[8:11], s30 offen offset:1024 lds
 v_mfma_f32_16x16x32_bf16 v[112:115], a[120:123], v[216:219], v[112:115]
 ds_read_b128 v[184:187], v18 offset:12288
 v_mfma_f32_16x16x32_bf16 v[116:119], a[124:127], v[216:219], v[116:119]
 v_mfma_f32_16x16x32_bf16 v[120:123], a[120:123], v[220:223], v[120:123]
 ds_read_b128 v[188:191], v18 offset:14336
 v_mfma_f32_16x16x32_bf16 v[124:127], a[124:127], v[220:223], v[124:127]
 s_waitcnt lgkmcnt(4)
 v_mfma_f32_16x16x32_bf16 v[64:67], a[128:131], v[160:163], v[64:67]
 ds_read_b128 v[192:195], v19 offset:0
 v_mfma_f32_16x16x32_bf16 v[68:71], a[132:135], v[160:163], v[68:71]
 v_add_u32 v18, s33, v14
 v_mfma_f32_16x16x32_bf16 v[72:75], a[128:131], v[164:167], v[72:75]
 ds_read_b128 v[196:199], v19 offset:2048
 v_mfma_f32_16x16x32_bf16 v[76:79], a[132:135], v[164:167], v[76:79]
 buffer_load_dwordx4 v12, s[8:11], s30 offen offset:2048 lds
 v_mfma_f32_16x16x32_bf16 v[80:83], a[128:131], v[168:171], v[80:83]
 ds_read_b128 v[200:203], v19 offset:4096
 v_mfma_f32_16x16x32_bf16 v[84:87], a[132:135], v[168:171], v[84:87]
 v_mfma_f32_16x16x32_bf16 v[88:91], a[128:131], v[172:175], v[88:91]
 ds_read_b128 v[204:207], v19 offset:6144
 v_mfma_f32_16x16x32_bf16 v[92:95], a[132:135], v[172:175], v[92:95]
 s_waitcnt lgkmcnt(4)
 v_mfma_f32_16x16x32_bf16 v[96:99], a[128:131], v[176:179], v[96:99]
 ds_read_b128 v[208:211], v19 offset:8192
 v_mfma_f32_16x16x32_bf16 v[100:103], a[132:135], v[176:179], v[100:103]
 v_mfma_f32_16x16x32_bf16 v[104:107], a[128:131], v[180:183], v[104:107]
 ds_read_b128 v[212:215], v19 offset:10240
 v_mfma_f32_16x16x32_bf16 v[108:111], a[132:135], v[180:183], v[108:111]
 buffer_load_dwordx4 v13, s[8:11], s30 offen offset:3072 lds
 v_mfma_f32_16x16x32_bf16 v[112:115], a[128:131], v[184:187], v[112:115]
 ds_read_b128 v[216:219], v19 offset:12288
 s_add_u32 s30, s30, 128
 v_mfma_f32_16x16x32_bf16 v[116:119], a[132:135], v[184:187], v[116:119]
 s_add_u32 m0, m0, 16384
 v_mfma_f32_16x16x32_bf16 v[120:123], a[128:131], v[188:191], v[120:123]
 ds_read_b128 v[220:223], v19 offset:14336
 v_mfma_f32_16x16x32_bf16 v[124:127], a[132:135], v[188:191], v[124:127]
 s_waitcnt vmcnt(16) lgkmcnt(4)
 s_barrier
 v_mfma_f32_16x16x32_bf16 v[64:67], a[136:139], v[192:195], v[64:67]
 ds_read_b128 v[160:163], v18 offset:0
 v_mfma_f32_16x16x32_bf16 v[68:71], a[140:143], v[192:195], v[68:71]
 s_cmp_lt_u32 m0, s46
 s_cselect_b32 m0, m0, s47
 v_mfma_f32_16x16x32_bf16 v[72:75], a[136:139], v[196:199], v[72:75]
 ds_read_b128 v[164:167], v18 offset:2048
 v_add_u32 v19, s33, v15
 v_mfma_f32_16x16x32_bf16 v[76:79], a[140:143], v[196:199], v[76:79]
 buffer_load_dwordx4 v10, s[8:11], s30 offen offset:0 lds
 v_mfma_f32_16x16x32_bf16 v[80:83], a[136:139], v[200:203], v[80:83]
 ds_read_b128 v[168:171], v18 offset:4096
 s_add_u32 s33, s33, 16384
 v_mfma_f32_16x16x32_bf16 v[84:87], a[140:143], v[200:203], v[84:87]
 s_cmp_lt_u32 s33, 114688
 s_cselect_b32 s33, s33, 0
 v_mfma_f32_16x16x32_bf16 v[88:91], a[136:139], v[204:207], v[88:91]
 ds_read_b128 v[172:175], v18 offset:6144
 v_mfma_f32_16x16x32_bf16 v[92:95], a[140:143], v[204:207], v[92:95]
 s_waitcnt lgkmcnt(4)
 v_mfma_f32_16x16x32_bf16 v[96:99], a[136:139], v[208:211], v[96:99]
 ds_read_b128 v[176:179], v18 offset:8192
 v_mfma_f32_16x16x32_bf16 v[100:103], a[140:143], v[208:211], v[100:103]
 v_mfma_f32_16x16x32_bf16 v[104:107], a[136:139], v[212:215], v[104:107]
 ds_read_b128 v[180:183], v18 offset:10240
 v_mfma_f32_16x16x32_bf16 v[108:111], a[140:143], v[212:215], v[108:111]
 buffer_load_dwordx4 v11, s[8:11], s30 offen offset:1024 lds
 v_mfma_f32_16x16x32_bf16 v[112:115], a[136:139], v[216:219], v[112:115]
 ds_read_b128 v[184:187], v18 offset:12288
 v_mfma_f32_16x16x32_bf16 v[116:119], a[140:143], v[216:219], v[116:119]
 v_mfma_f32_16x16x32_bf16 v[120:123], a[136:139], v[220:223], v[120:123]
 ds_read_b128 v[188:191], v18 offset:14336
 v_mfma_f32_16x16x32_bf16 v[124:127], a[140:143], v[220:223], v[124:127]
 s_waitcnt lgkmcnt(4)
 v_mfma_f32_16x16x32_bf16 v[64:67], a[144:147], v[160:163], v[64:67]
 ds_read_b128 v[192:195], v19 offset:0
 v_mfma_f32_16x16x32_bf16 v[68:71], a[148:151], v[160:163], v[68:71]
 v_add_u32 v18, s33, v14
 v_mfma_f32_16x16x32_bf16 v[72:75], a[144:147], v[164:167], v[72:75]
 ds_read_b128 v[196:199], v19 offset:2048
 v_mfma_f32_16x16x32_bf16 v[76:79], a[148:151], v[164:167], v[76:79]
 buffer_load_dwordx4 v12, s[8:11], s30 offen offset:2048 lds
 v_mfma_f32_16x16x32_bf16 v[80:83], a[144:147], v[168:171], v[80:83]
 ds_read_b128 v[200:203], v19 offset:4096
 v_mfma_f32_16x16x32_bf16 v[84:87], a[148:151], v[168:171], v[84:87]
 v_mfma_f32_16x16x32_bf16 v[88:91], a[144:147], v[172:175], v[88:91]
 ds_read_b128 v[204:207], v19 offset:6144
 v_mfma_f32_16x16x32_bf16 v[92:95], a[148:151], v[172:175], v[92:95]
 s_waitcnt lgkmcnt(4)
 v_mfma_f32_16x16x32_bf16 v[96:99], a[144:147], v[176:179], v[96:99]
 ds_read_b128 v[208:211], v19 offset:8192
 v_mfma_f32_16x16x32_bf16 v[100:103], a[148:151], v[176:179], v[100:103]
 v_mfma_f32_16x16x32_bf16 v[104:107], a[144:147], v[180:183], v[104:107]
 ds_read_b128 v[212:215], v19 offset:10240
 v_mfma_f32_16x16x32_bf16 v[108:111], a[148:151], v[180:183], v[108:111]
 buffer_load_dwordx4 v13, s[8:11], s30 offen offset:3072 lds
 v_mfma_f32_16x16x32_bf16 v[112:115], a[144:147], v[184:187], v[112:115]
 ds_read_b128 v[216:219], v19 offset:12288
 s_add_u32 s30, s30, 128
 v_mfma_f32_16x16x32_bf16 v[116:119], a[148:151], v[184:187], v[116:119]
 s_add_u32 m0, m0, 16384
 v_mfma_f32_16x16x32_bf16 v[120:123], a[144:147], v[188:191], v[120:123]
 ds_read_b128 v[220:223], v19 offset:14336
 v_mfma_f32_16x16x32_bf16 v[124:127], a[148:151], v[188:191], v[124:127]
 s_waitcnt vmcnt(16) lgkmcnt(4)
 s_barrier
 v_mfma_f32_16x16x32_bf16 v[64:67], a[152:155], v[192:195], v[64:67]
 ds_read_b128 v[160:163], v18 offset:0
 v_mfma_f32_16x16x32_bf16 v[68:71], a[156:159], v[192:195], v[68:71]
 s_cmp_lt_u32 m0, s46
 s_cselect_b32 m0, m0, s47
 v_mfma_f32_16x16x32_bf16 v[72:75], a[152:155], v[196:199], v[72:75]
 ds_read_b128 v[164:167], v18 offset:2048
 v_add_u32 v19, s33, v15
 v_mfma_f32_16x16x32_bf16 v[76:79], a[156:159], v[196:199], v[76:79]
 buffer_load_dwordx4 v10, s[8:11], s30 offen offset:0 lds
 v_cvt_pk_bf16_f32 v224, v64, v65
 v_cvt_pk_bf16_f32 v225, v66, v67
 v_mfma_f32_16x16x32_bf16 v[80:83], a[152:155], v[200:203], v[80:83]
 ds_read_b128 v[168:171], v18 offset:4096
 s_add_u32 s33, s33, 16384
 v_cvt_pk_bf16_f32 v226, v68, v69
 v_cvt_pk_bf16_f32 v227, v70, v71
 v_mfma_f32_16x16x32_bf16 v[84:87], a[156:159], v[200:203], v[84:87]
 s_cmp_lt_u32 s33, 114688
 s_cselect_b32 s33, s33, 0
 ds_write_b64 v22, v[224:225] offset:0
 v_mfma_f32_16x16x32_bf16 v[88:91], a[152:155], v[204:207], v[88:91]
 ds_read_b128 v[172:175], v18 offset:6144
 ds_write_b64 v22, v[226:227] offset:32
 v_cvt_pk_bf16_f32 v230, v72, v73
 v_mfma_f32_16x16x32_bf16 v[92:95], a[156:159], v[204:207], v[92:95]
 s_waitcnt lgkmcnt(6)
 v_cvt_pk_bf16_f32 v231, v74, v75
 v_cvt_pk_bf16_f32 v232, v76, v77
 v_cvt_pk_bf16_f32 v233, v78, v79
 v_mfma_f32_16x16x32_bf16 v[96:99], a[152:155], v[208:211], v[96:99]
 ds_read_b128 v[176:179], v18 offset:8192
 ds_write_b64 v22, v[230:231] offset:4224
 v_mfma_f32_16x16x32_bf16 v[100:103], a[156:159], v[208:211], v[100:103]
 ds_write_b64 v22, v[232:233] offset:4256
 v_cvt_pk_bf16_f32 v224, v80, v81
 v_cvt_pk_bf16_f32 v225, v82, v83
 v_mfma_f32_16x16x32_bf16 v[104:107], a[152:155], v[212:215], v[104:107]
 ds_read_b128 v[180:183], v18 offset:10240
 v_cvt_pk_bf16_f32 v226, v84, v85
 v_cvt_pk_bf16_f32 v227, v86, v87
 v_mfma_f32_16x16x32_bf16 v[108:111], a[156:159], v[212:215], v[108:111]
 buffer_load_dwordx4 v11, s[8:11], s30 offen offset:1024 lds
 ds_write_b64 v22, v[224:225] offset:8448
 v_mfma_f32_16x16x32_bf16 v[112:115], a[152:155], v[216:219], v[112:115]
 ds_read_b128 v[184:187], v18 offset:12288
 ds_write_b64 v22, v[226:227] offset:8480
 v_cvt_pk_bf16_f32 v230, v88, v89
 v_mfma_f32_16x16x32_bf16 v[116:119], a[156:159], v[216:219], v[116:119]
 v_cvt_pk_bf16_f32 v231, v90, v91
 v_cvt_pk_bf16_f32 v232, v92, v93
 v_cvt_pk_bf16_f32 v233, v94, v95
 v_mfma_f32_16x16x32_bf16 v[120:123], a[152:155], v[220:223], v[120:123]
 ds_read_b128 v[188:191], v18 offset:14336
 ds_write_b64 v22, v[230:231] offset:12672
 v_mfma_f32_16x16x32_bf16 v[124:127], a[156:159], v[220:223], v[124:127]
 ds_write_b64 v22, v[232:233] offset:12704
 v_cvt_pk_bf16_f32 v224, v96, v97
 v_cvt_pk_bf16_f32 v225, v98, v99
bf_end_191:
 v_cvt_pk_bf16_f32 v226, v100, v101
 v_cvt_pk_bf16_f32 v227, v102, v103
 ds_write_b64 v22, v[224:225] offset:16896
 ds_write_b64 v22, v[226:227] offset:16928
 v_cvt_pk_bf16_f32 v230, v104, v105
 v_cvt_pk_bf16_f32 v231, v106, v107
 v_cvt_pk_bf16_f32 v232, v108, v109
 v_cvt_pk_bf16_f32 v233, v110, v111
 ds_write_b64 v22, v[230:231] offset:21120
 ds_write_b64 v22, v[232:233] offset:21152
 v_cvt_pk_bf16_f32 v224, v112, v113
 v_cvt_pk_bf16_f32 v225, v114, v115
 v_cvt_pk_bf16_f32 v226, v116, v117
 v_cvt_pk_bf16_f32 v227, v118, v119
 ds_write_b64 v22, v[224:225] offset:25344
 ds_write_b64 v22, v[226:227] offset:25376
 v_cvt_pk_bf16_f32 v230, v120, v121
 v_cvt_pk_bf16_f32 v231, v122, v123
 v_cvt_pk_bf16_f32 v232, v124, v125
 v_cvt_pk_bf16_f32 v233, v126, v127
 ds_write_b64 v22, v[230:231] offset:29568
 ds_write_b64 v22, v[232:233] offset:29600
 s_cmp_lg_u32 s26, 6
 s_cbranch_scc1 bw_192
 buffer_load_dword v50, v32, s[64:67], 0 offen offset:8 sc1
 buffer_load_dword v32, v32, s[64:67], 0 offen sc1
 buffer_load_dwordx4 v[40:43], v33, s[12:15], s50 offen offset:0
 buffer_load_dwordx4 v[40:43], v33, s[12:15], s50 offen offset:1024
 buffer_load_dwordx4 v[40:43], v33, s[12:15], s50 offen offset:2048
 buffer_load_dwordx4 v[40:43], v33, s[12:15], s50 offen offset:3072
 buffer_load_dwordx4 v[40:43], v33, s[12:15], s51 offen offset:0
 buffer_load_dwordx4 v[40:43], v33, s[12:15], s51 offen offset:1024
 buffer_load_dwordx4 v[40:43], v33, s[12:15], s51 offen offset:2048
bw_192:
 s_waitcnt lgkmcnt(0)
 s_barrier
 ds_read_b64 v[144:145], v34 offset:1848
 ds_read_b64 v[146:147], v34 offset:1856
 ds_read_b64 v[148:149], v34 offset:1864
 ds_read_b64 v[150:151], v34 offset:1872
 ds_read_b64 v[152:153], v34 offset:1880
 ds_read_b64 v[64:65], v34 offset:1928
 ds_read_b64 v[66:67], v34 offset:1936
 ds_read_b64 v[68:69], v34 offset:1944
 ds_read_b64 v[70:71], v34 offset:1952
 ds_read_b64 v[72:73], v34 offset:1960
 ds_read_b64 v[74:75], v34 offset:1664
 ds_read_b64 v[76:77], v34 offset:1672
 ds_read_b64 v[78:79], v34 offset:1680
 ds_read_b64 v[80:81], v34 offset:1688
 ds_read_b64 v[82:83], v34 offset:1696
 ds_read_b64 v[84:85], v34 offset:1400
 ds_read_b64 v[86:87], v34 offset:1408
 ds_read_b64 v[88:89], v34 offset:1416
 ds_read_b64 v[90:91], v34 offset:1424
 ds_read_b64 v[92:93], v34 offset:1432
 ds_read_b64 v[94:95], v34 offset:1136
 ds_read_b64 v[96:97], v34 offset:1144
 ds_read_b64 v[98:99], v34 offset:1152
 ds_read_b64 v[100:101], v34 offset:1160
 ds_read_b64 v[102:103], v34 offset:1168
 ds_read_b64 v[104:105], v34 offset:872
 ds_read_b64 v[106:107], v34 offset:880
 ds_read_b64 v[108:109], v34 offset:888
 ds_read_b64 v[110:111], v34 offset:896
 ds_read_b64 v[112:113], v34 offset:904
 ds_read_b64 v[114:115], v34 offset:608
 ds_read_b64 v[116:117], v34 offset:616
 ds_read_b64 v[118:119], v34 offset:624
 ds_read_b64 v[120:121], v34 offset:632
 ds_read_b64 v[122:123], v34 offset:640
 ds_read_b64 v[124:125], v34 offset:344
 ds_read_b64 v[126:127], v34 offset:352
 ds_read_b64 v[128:129], v34 offset:360
 ds_read_b64 v[130:131], v34 offset:368
 ds_read_b64 v[132:133], v34 offset:376
 ds_read_b64 v[134:135], v34 offset:80
 ds_read_b64 v[136:137], v34 offset:88
 ds_read_b64 v[138:139], v34 offset:96
 ds_read_b64 v[140:141], v34 offset:104
 ds_read_b64 v[142:143], v34 offset:112
 v_mov_b32 v224, 0
 v_mov_b32 v225, 0
 v_mov_b32 v226, 0
 v_mov_b32 v227, 0
 v_mov_b32 v228, 0
 v_mov_b32 v229, 0
 v_mov_b32 v230, 0
 v_mov_b32 v231, 0
 s_waitcnt lgkmcnt(15)
 v_dot2c_f32_bf16 v224, v64, v144
 v_dot2c_f32_bf16 v225, v74, v144
 v_dot2c_f32_bf16 v226, v84, v144
 v_dot2c_f32_bf16 v227, v94, v144
 v_dot2c_f32_bf16 v224, v65, v145
 v_dot2c_f32_bf16 v225, v75, v145
 v_dot2c_f32_bf16 v226, v85, v145
 v_dot2c_f32_bf16 v227, v95, v145
 v_dot2c_f32_bf16 v224, v66, v146
 v_dot2c_f32_bf16 v225, v76, v146
 v_dot2c_f32_bf16 v226, v86, v146
 v_dot2c_f32_bf16 v227, v96, v146
 v_dot2c_f32_bf16 v224, v67, v147
 v_dot2c_f32_bf16 v225, v77, v147
 v_dot2c_f32_bf16 v226, v87, v147
 v_dot2c_f32_bf16 v227, v97, v147
 v_dot2c_f32_bf16 v224, v68, v148
 v_dot2c_f32_bf16 v225, v78, v148
 v_dot2c_f32_bf16 v226, v88, v148
 v_dot2c_f32_bf16 v227, v98, v148
 v_dot2c_f32_bf16 v224, v69, v149
 v_dot2c_f32_bf16 v225, v79, v149
 v_dot2c_f32_bf16 v226, v89, v149
 v_dot2c_f32_bf16 v227, v99, v149
 v_dot2c_f32_bf16 v224, v70, v150
 v_dot2c_f32_bf16 v225, v80, v150
 v_dot2c_f32_bf16 v226, v90, v150
 v_dot2c_f32_bf16 v227, v100, v150
 v_dot2c_f32_bf16 v224, v71, v151
 v_dot2c_f32_bf16 v225, v81, v151
 v_dot2c_f32_bf16 v226, v91, v151
 v_dot2c_f32_bf16 v227, v101, v151
 v_dot2c_f32_bf16 v224, v72, v152
 v_dot2c_f32_bf16 v225, v82, v152
 v_dot2c_f32_bf16 v226, v92, v152
 v_dot2c_f32_bf16 v227, v102, v152
 v_dot2c_f32_bf16 v224, v73, v153
 v_dot2c_f32_bf16 v225, v83, v153
 v_dot2c_f32_bf16 v226, v93, v153
 v_dot2c_f32_bf16 v227, v103, v153
 s_waitcnt lgkmcnt(0)
 v_dot2c_f32_bf16 v228, v104, v144
 v_dot2c_f32_bf16 v229, v114, v144
 v_dot2c_f32_bf16 v230, v124, v144
 v_dot2c_f32_bf16 v231, v134, v144
 v_dot2c_f32_bf16 v228, v105, v145
 v_dot2c_f32_bf16 v229, v115, v145
 v_dot2c_f32_bf16 v230, v125, v145
 v_dot2c_f32_bf16 v231, v135, v145
 v_dot2c_f32_bf16 v228, v106, v146
 v_dot2c_f32_bf16 v229, v116, v146
 v_dot2c_f32_bf16 v230, v126, v146
 v_dot2c_f32_bf16 v231, v136, v146
 v_dot2c_f32_bf16 v228, v107, v147
 v_dot2c_f32_bf16 v229, v117, v147
 v_dot2c_f32_bf16 v230, v127, v147
 v_dot2c_f32_bf16 v231, v137, v147
 v_dot2c_f32_bf16 v228, v108, v148
 v_dot2c_f32_bf16 v229, v118, v148
 v_dot2c_f32_bf16 v230, v128, v148
 v_dot2c_f32_bf16 v231, v138, v148
 v_dot2c_f32_bf16 v228, v109, v149
 v_dot2c_f32_bf16 v229, v119, v149
 v_dot2c_f32_bf16 v230, v129, v149
 v_dot2c_f32_bf16 v231, v139, v149
 v_dot2c_f32_bf16 v228, v110, v150
 v_dot2c_f32_bf16 v229, v120, v150
 v_dot2c_f32_bf16 v230, v130, v150
 v_dot2c_f32_bf16 v231, v140, v150
 v_dot2c_f32_bf16 v228, v111, v151
 v_dot2c_f32_bf16 v229, v121, v151
 v_dot2c_f32_bf16 v230, v131, v151
 v_dot2c_f32_bf16 v231, v141, v151
 v_dot2c_f32_bf16 v228, v112, v152
 v_dot2c_f32_bf16 v229, v122, v152
 v_dot2c_f32_bf16 v230, v132, v152
 v_dot2c_f32_bf16 v231, v142, v152
 v_dot2c_f32_bf16 v228, v113, v153
 v_dot2c_f32_bf16 v229, v123, v153
 v_dot2c_f32_bf16 v230, v133, v153
 v_dot2c_f32_bf16 v231, v143, v153
 ds_read_b64 v[64:65], v38 offset:2008
 ds_read_b64 v[66:67], v38 offset:2016
 ds_read_b64 v[68:69], v38 offset:2024
 ds_read_b64 v[70:71], v38 offset:2032
 ds_read_b64 v[72:73], v39 offset:2040
 ds_read_b64 v[74:75], v38 offset:1744
 ds_read_b64 v[76:77], v38 offset:1752
 ds_read_b64 v[78:79], v38 offset:1760
 ds_read_b64 v[80:81], v38 offset:1768
 ds_read_b64 v[82:83], v39 offset:1776
 ds_read_b64 v[84:85], v38 offset:1480
 ds_read_b64 v[86:87], v38 offset:1488
 ds_read_b64 v[88:89], v38 offset:1496
 ds_read_b64 v[90:91], v38 offset:1504
 ds_read_b64 v[92:93], v39 offset:1512
 ds_read_b64 v[94:95], v38 offset:1216
 ds_read_b64 v[96:97], v38 offset:1224
 ds_read_b64 v[98:99], v38 offset:1232
 ds_read_b64 v[100:101], v38 offset:1240
 ds_read_b64 v[102:103], v39 offset:1248
 ds_read_b64 v[104:105], v38 offset:952
 ds_read_b64 v[106:107], v38 offset:960
 ds_read_b64 v[108:109], v38 offset:968
 ds_read_b64 v[110:111], v38 offset:976
 ds_read_b64 v[112:113], v39 offset:984
 ds_read_b64 v[114:115], v38 offset:688
 ds_read_b64 v[116:117], v38 offset:696
 ds_read_b64 v[118:119], v38 offset:704
 ds_read_b64 v[120:121], v38 offset:712
 ds_read_b64 v[122:123], v39 offset:720
 ds_read_b64 v[124:125], v38 offset:424
 ds_read_b64 v[126:127], v38 offset:432
 ds_read_b64 v[128:129], v38 offset:440
 ds_read_b64 v[130:131], v38 offset:448
 ds_read_b64 v[132:133], v39 offset:456
 ds_read_b64 v[134:135], v38 offset:160
 ds_read_b64 v[136:137], v38 offset:168
 ds_read_b64 v[138:139], v38 offset:176
 ds_read_b64 v[140:141], v38 offset:184
 ds_read_b64 v[142:143], v39 offset:192
 v_cvt_pk_bf16_f32 v4, v224, v225
 v_lshlrev_b32 v224, 16, v4
 v_and_b32 v225, 0xffff0000, v4
 v_mul_f32 v224, s60, v224
 v_mul_f32 v225, s60, v225
 v_cvt_pk_bf16_f32 v4, v224, v225
 v_lshlrev_b32 v224, 16, v4
 v_and_b32 v225, 0xffff0000, v4
 v_cndmask_b32 v224, v37, v224, s[76:77]
 v_cndmask_b32 v225, v37, v225, s[78:79]
 v_cvt_pk_bf16_f32 v4, v226, v227
 v_lshlrev_b32 v226, 16, v4
 v_and_b32 v227, 0xffff0000, v4
 v_mul_f32 v226, s60, v226
 v_mul_f32 v227, s60, v227
 v_cvt_pk_bf16_f32 v4, v226, v227
 v_lshlrev_b32 v226, 16, v4
 v_and_b32 v227, 0xffff0000, v4
 v_cndmask_b32 v226, v37, v226, s[80:81]
 v_cndmask_b32 v227, v37, v227, s[82:83]
 v_cvt_pk_bf16_f32 v4, v228, v229
 v_lshlrev_b32 v228, 16, v4
 v_and_b32 v229, 0xffff0000, v4
 v_mul_f32 v228, s60, v228
 v_mul_f32 v229, s60, v229
 v_cvt_pk_bf16_f32 v4, v228, v229
 v_lshlrev_b32 v228, 16, v4
 v_and_b32 v229, 0xffff0000, v4
 v_cndmask_b32 v228, v37, v228, s[84:85]
 v_cndmask_b32 v229, v37, v229, s[86:87]
 v_cvt_pk_bf16_f32 v4, v230, v231
 v_lshlrev_b32 v230, 16, v4
 v_and_b32 v231, 0xffff0000, v4
 v_mul_f32 v230, s60, v230
 v_mul_f32 v231, s60, v231
 v_cvt_pk_bf16_f32 v4, v230, v231
 v_lshlrev_b32 v230, 16, v4
 v_and_b32 v231, 0xffff0000, v4
 v_cndmask_b32 v230, v37, v230, s[88:89]
 v_cndmask_b32 v231, v37, v231, s[90:91]
 v_max3_f32 v5, v224, v225, v226
 v_max3_f32 v5, v5, v227, v228
 v_max3_f32 v5, v5, v229, v230
 v_max_f32 v5, v5, v231
 v_sub_f32 v224, v224, v5
 v_mul_f32 v224, s61, v224
 v_exp_f32 v224, v224
 v_sub_f32 v225, v225, v5
 v_mul_f32 v225, s61, v225
 v_exp_f32 v225, v225
 v_sub_f32 v226, v226, v5
 v_mul_f32 v226, s61, v226
 v_exp_f32 v226, v226
 v_sub_f32 v227, v227, v5
 v_mul_f32 v227, s61, v227
 v_exp_f32 v227, v227
 v_sub_f32 v228, v228, v5
 v_mul_f32 v228, s61, v228
 v_exp_f32 v228, v228
 v_sub_f32 v229, v229, v5
 v_mul_f32 v229, s61, v229
 v_exp_f32 v229, v229
 v_sub_f32 v230, v230, v5
 v_mul_f32 v230, s61, v230
 v_exp_f32 v230, v230
 v_sub_f32 v231, v231, v5
 v_mul_f32 v231, s61, v231
 v_exp_f32 v231, v231
 s_nop 0
 v_add_f32 v5, v224, v225
 v_add_f32 v5, v5, v226
 v_add_f32 v5, v5, v227
 v_add_f32 v5, v5, v228
 v_add_f32 v5, v5, v229
 v_add_f32 v5, v5, v230
 v_add_f32 v5, v5, v231
 v_rcp_f32 v5, v5
 s_nop 0
 v_mul_f32 v224, v224, v5
 v_mul_f32 v225, v225, v5
 v_mul_f32 v226, v226, v5
 v_mul_f32 v227, v227, v5
 v_mul_f32 v228, v228, v5
 v_mul_f32 v229, v229, v5
 v_mul_f32 v230, v230, v5
 v_mul_f32 v231, v231, v5
 v_cvt_pk_bf16_f32 v232, v224, v225
 v_cvt_pk_bf16_f32 v233, v226, v227
 v_cvt_pk_bf16_f32 v234, v228, v229
 v_cvt_pk_bf16_f32 v235, v230, v231
 s_waitcnt lgkmcnt(15)
 v_perm_b32 v144, v74, v64, s62
 v_perm_b32 v145, v74, v64, s63
 v_perm_b32 v146, v75, v65, s62
 v_perm_b32 v147, v75, v65, s63
 v_perm_b32 v148, v76, v66, s62
 v_perm_b32 v149, v76, v66, s63
 v_perm_b32 v150, v77, v67, s62
 v_perm_b32 v151, v77, v67, s63
 v_perm_b32 v152, v78, v68, s62
 v_perm_b32 v153, v78, v68, s63
 v_perm_b32 v154, v79, v69, s62
 v_perm_b32 v155, v79, v69, s63
 v_perm_b32 v156, v80, v70, s62
 v_perm_b32 v157, v80, v70, s63
 v_perm_b32 v158, v81, v71, s62
 v_perm_b32 v159, v81, v71, s63
 v_perm_b32 v212, v82, v72, s62
 v_perm_b32 v213, v82, v72, s63
 v_perm_b32 v214, v83, v73, s62
 v_perm_b32 v215, v83, v73, s63
 v_dot2_f32_bf16 v192, v144, v232, 0
 v_dot2_f32_bf16 v193, v145, v232, 0
 v_dot2_f32_bf16 v194, v146, v232, 0
 v_dot2_f32_bf16 v195, v147, v232, 0
 v_dot2_f32_bf16 v196, v148, v232, 0
 v_dot2_f32_bf16 v197, v149, v232, 0
 v_dot2_f32_bf16 v198, v150, v232, 0
 v_dot2_f32_bf16 v199, v151, v232, 0
 v_dot2_f32_bf16 v200, v152, v232, 0
 v_dot2_f32_bf16 v201, v153, v232, 0
 v_dot2_f32_bf16 v202, v154, v232, 0
 v_dot2_f32_bf16 v203, v155, v232, 0
 v_dot2_f32_bf16 v204, v156, v232, 0
 v_dot2_f32_bf16 v205, v157, v232, 0
 v_dot2_f32_bf16 v206, v158, v232, 0
 v_dot2_f32_bf16 v207, v159, v232, 0
 v_dot2_f32_bf16 v208, v212, v232, 0
 v_dot2_f32_bf16 v209, v213, v232, 0
 v_dot2_f32_bf16 v210, v214, v232, 0
 v_dot2_f32_bf16 v211, v215, v232, 0
 s_waitcnt lgkmcnt(15)
 v_perm_b32 v144, v94, v84, s62
 v_perm_b32 v145, v94, v84, s63
 v_perm_b32 v146, v95, v85, s62
 v_perm_b32 v147, v95, v85, s63
 v_perm_b32 v148, v96, v86, s62
 v_perm_b32 v149, v96, v86, s63
 v_perm_b32 v150, v97, v87, s62
 v_perm_b32 v151, v97, v87, s63
 v_perm_b32 v152, v98, v88, s62
 v_perm_b32 v153, v98, v88, s63
 v_perm_b32 v154, v99, v89, s62
 v_perm_b32 v155, v99, v89, s63
 v_perm_b32 v156, v100, v90, s62
 v_perm_b32 v157, v100, v90, s63
 v_perm_b32 v158, v101, v91, s62
 v_perm_b32 v159, v101, v91, s63
 v_perm_b32 v212, v102, v92, s62
 v_perm_b32 v213, v102, v92, s63
 v_perm_b32 v214, v103, v93, s62
 v_perm_b32 v215, v103, v93, s63
 v_dot2c_f32_bf16 v192, v144, v233
 v_dot2c_f32_bf16 v193, v145, v233
 v_dot2c_f32_bf16 v194, v146, v233
 v_dot2c_f32_bf16 v195, v147, v233
 v_dot2c_f32_bf16 v196, v148, v233
 v_dot2c_f32_bf16 v197, v149, v233
 v_dot2c_f32_bf16 v198, v150, v233
 v_dot2c_f32_bf16 v199, v151, v233
 v_dot2c_f32_bf16 v200, v152, v233
 v_dot2c_f32_bf16 v201, v153, v233
 v_dot2c_f32_bf16 v202, v154, v233
 v_dot2c_f32_bf16 v203, v155, v233
 v_dot2c_f32_bf16 v204, v156, v233
 v_dot2c_f32_bf16 v205, v157, v233
 v_dot2c_f32_bf16 v206, v158, v233
 v_dot2c_f32_bf16 v207, v159, v233
 v_dot2c_f32_bf16 v208, v212, v233
 v_dot2c_f32_bf16 v209, v213, v233
 v_dot2c_f32_bf16 v210, v214, v233
 v_dot2c_f32_bf16 v211, v215, v233
 s_waitcnt lgkmcnt(10)
 v_perm_b32 v144, v114, v104, s62
 v_perm_b32 v145, v114, v104, s63
 v_perm_b32 v146, v115, v105, s62
 v_perm_b32 v147, v115, v105, s63
 v_perm_b32 v148, v116, v106, s62
 v_perm_b32 v149, v116, v106, s63
 v_perm_b32 v150, v117, v107, s62
 v_perm_b32 v151, v117, v107, s63
 v_perm_b32 v152, v118, v108, s62
 v_perm_b32 v153, v118, v108, s63
 v_perm_b32 v154, v119, v109, s62
 v_perm_b32 v155, v119, v109, s63
 v_perm_b32 v156, v120, v110, s62
 v_perm_b32 v157, v120, v110, s63
 v_perm_b32 v158, v121, v111, s62
 v_perm_b32 v159, v121, v111, s63
 v_perm_b32 v212, v122, v112, s62
 v_perm_b32 v213, v122, v112, s63
 v_perm_b32 v214, v123, v113, s62
 v_perm_b32 v215, v123, v113, s63
 v_dot2c_f32_bf16 v192, v144, v234
 v_dot2c_f32_bf16 v193, v145, v234
 v_dot2c_f32_bf16 v194, v146, v234
 v_dot2c_f32_bf16 v195, v147, v234
 v_dot2c_f32_bf16 v196, v148, v234
 v_dot2c_f32_bf16 v197, v149, v234
 v_dot2c_f32_bf16 v198, v150, v234
 v_dot2c_f32_bf16 v199, v151, v234
 v_dot2c_f32_bf16 v200, v152, v234
 v_dot2c_f32_bf16 v201, v153, v234
 v_dot2c_f32_bf16 v202, v154, v234
 v_dot2c_f32_bf16 v203, v155, v234
 v_dot2c_f32_bf16 v204, v156, v234
 v_dot2c_f32_bf16 v205, v157, v234
 v_dot2c_f32_bf16 v206, v158, v234
 v_dot2c_f32_bf16 v207, v159, v234
 v_dot2c_f32_bf16 v208, v212, v234
 v_dot2c_f32_bf16 v209, v213, v234
 v_dot2c_f32_bf16 v210, v214, v234
 v_dot2c_f32_bf16 v211, v215, v234
 s_waitcnt lgkmcnt(0)
 v_perm_b32 v144, v134, v124, s62
 v_perm_b32 v145, v134, v124, s63
 v_perm_b32 v146, v135, v125, s62
 v_perm_b32 v147, v135, v125, s63
 v_perm_b32 v148, v136, v126, s62
 v_perm_b32 v149, v136, v126, s63
 v_perm_b32 v150, v137, v127, s62
 v_perm_b32 v151, v137, v127, s63
 v_perm_b32 v152, v138, v128, s62
 v_perm_b32 v153, v138, v128, s63
 v_perm_b32 v154, v139, v129, s62
 v_perm_b32 v155, v139, v129, s63
 v_perm_b32 v156, v140, v130, s62
 v_perm_b32 v157, v140, v130, s63
 v_perm_b32 v158, v141, v131, s62
 v_perm_b32 v159, v141, v131, s63
 v_perm_b32 v212, v142, v132, s62
 v_perm_b32 v213, v142, v132, s63
 v_perm_b32 v214, v143, v133, s62
 v_perm_b32 v215, v143, v133, s63
 v_dot2c_f32_bf16 v192, v144, v235
 v_dot2c_f32_bf16 v193, v145, v235
 v_dot2c_f32_bf16 v194, v146, v235
 v_dot2c_f32_bf16 v195, v147, v235
 v_dot2c_f32_bf16 v196, v148, v235
 v_dot2c_f32_bf16 v197, v149, v235
 v_dot2c_f32_bf16 v198, v150, v235
 v_dot2c_f32_bf16 v199, v151, v235
 v_dot2c_f32_bf16 v200, v152, v235
 v_dot2c_f32_bf16 v201, v153, v235
 v_dot2c_f32_bf16 v202, v154, v235
 v_dot2c_f32_bf16 v203, v155, v235
 v_dot2c_f32_bf16 v204, v156, v235
 v_dot2c_f32_bf16 v205, v157, v235
 v_dot2c_f32_bf16 v206, v158, v235
 v_dot2c_f32_bf16 v207, v159, v235
 v_dot2c_f32_bf16 v208, v212, v235
 v_dot2c_f32_bf16 v209, v213, v235
 v_dot2c_f32_bf16 v210, v214, v235
 v_dot2c_f32_bf16 v211, v215, v235
 s_cmp_lg_u32 s20, 0
 s_cbranch_scc1 bh_193
 ds_read_b64 v[64:65], v35 offset:33792
 ds_read_b64 v[66:67], v35 offset:34304
 ds_read_b64 v[68:69], v35 offset:34816
 ds_read_b64 v[70:71], v35 offset:35328
 ds_read_b64 v[72:73], v35 offset:35840
 s_waitcnt lgkmcnt(0)
 ds_write_b64 v35, v[64:65] offset:0
 ds_write_b64 v35, v[66:67] offset:512
 ds_write_b64 v35, v[68:69] offset:1024
 ds_write_b64 v35, v[70:71] offset:1536
 ds_write_b64 v35, v[72:73] offset:2048
bh_193:
 s_nop 1
 v_cvt_pk_bf16_f32 v244, v192, v193
 v_cvt_pk_bf16_f32 v245, v194, v195
 v_cvt_pk_bf16_f32 v246, v196, v197
 v_cvt_pk_bf16_f32 v247, v198, v199
 v_cvt_pk_bf16_f32 v248, v200, v201
 v_cvt_pk_bf16_f32 v249, v202, v203
 v_cvt_pk_bf16_f32 v250, v204, v205
 v_cvt_pk_bf16_f32 v251, v206, v207
 v_cvt_pk_bf16_f32 v252, v208, v209
 v_cvt_pk_bf16_f32 v253, v210, v211
 buffer_store_dwordx4 v[244:247], v29, s[16:19], s27 offen sc1
 buffer_store_dwordx4 v[248:251], v30, s[16:19], s27 offen sc1
 buffer_store_dwordx2 v[252:253], v31, s[16:19], s27 offen sc1
 s_add_u32 s27, s27, 2048
 s_mov_b64 s[78:79], -1
 s_mov_b64 s[80:81], -1
 s_mov_b64 s[82:83], -1
 s_mov_b64 s[84:85], -1
 s_mov_b64 s[86:87], -1
 s_mov_b64 s[88:89], -1
 s_mov_b64 s[90:91], -1
 s_sub_u32 s26, s26, 1
 s_cmp_gt_u32 s26, 0
 s_waitcnt lgkmcnt(0)
 s_cbranch_scc1 bf_blk_190
 s_waitcnt vmcnt(0) lgkmcnt(0)
 s_barrier
 s_mov_b32 s84, 0
 s_mov_b32 s85, -1
 v_readfirstlane_b32 s21, v32
 s_cmp_ge_u32 s21, 32
 s_cbranch_scc1 bt_194
 s_mov_b32 s21, 76
 v_mov_b32 v4, 0
 s_mov_b32 s101, 0
wf_195:
 buffer_load_dword v5, v4, s[64:67], s21 offen sc1
 s_add_u32 s101, s101, 1
 s_cmp_gt_u32 s101, 131072
 s_cbranch_scc1 main_end
 s_waitcnt vmcnt(0)
 v_readfirstlane_b32 s100, v5
 s_cmp_ge_u32 s100, 32
 s_cbranch_scc1 wf_196
 s_sleep 8
 s_branch wf_195
wf_196:
bt_194:
 s_mov_b32 s21, 91136
 s_cmp_lg_u32 s20, 0
 s_cbranch_scc1 af_197
 v_mov_b32 v4, 0
 v_mov_b32 v5, 1
 s_mov_b64 exec, 1
 buffer_atomic_add v5, v4, s[72:75], s21 offen sc1
 s_mov_b64 exec, -1
 s_nop 1
af_197:
 v_readfirstlane_b32 s100, v50
 s_cmp_lg_u32 s100, 0
 s_cbranch_scc1 c0_198
 s_mov_b32 s21, 84
 v_mov_b32 v6, 0
 s_mov_b32 s101, 0
wf_199:
 buffer_load_dword v7, v6, s[64:67], s21 offen sc1
 s_add_u32 s101, s101, 1
 s_cmp_gt_u32 s101, 131072
 s_cbranch_scc1 main_end
 s_waitcnt vmcnt(0)
 v_readfirstlane_b32 s100, v7
 s_cmp_ge_u32 s100, 1
 s_cbranch_scc1 wf_200
 s_sleep 8
 s_branch wf_199
wf_200:
c0_198:
 s_add_u32 s37, s38, 83886079
 s_add_u32 s21, s38, 180355072
 s_xor_b32 s37, s37, s21
 s_lshr_b32 s37, s37, 21
 s_xor_b32 s37, s37, s100
 s_xor_b32 s37, s37, 0
 s_and_b32 s37, s37, 1
 s_lshl_b32 s37, s37, 13
q_entry:
 s_load_dwordx2 s[4:5], s[0:1], 0
 s_load_dwordx2 s[6:7], s[0:1], 16
 s_load_dwordx2 s[38:39], s[0:1], 104
 s_mov_b32 s42, s2
 s_cmp_lt_u32 s3, 64
 s_cselect_b32 s41, 10, 0
 s_cselect_b32 s45, 8, 0
 s_waitcnt lgkmcnt(0)
 s_mov_b32 s8, s4
 s_mov_b32 s9, s5
 s_mov_b32 s10, 2621440
 s_mov_b32 s11, 0x00020000
 s_mov_b32 s12, s6
 s_mov_b32 s13, s7
 s_mov_b32 s14, 7864320
 s_mov_b32 s15, 0x00020000
 s_mov_b32 s16, s38
 s_mov_b32 s17, s39
 s_mov_b32 s18, 50331648
 s_mov_b32 s19, 0x00020000
 s_add_u32 s52, s38, 180355072
 s_addc_u32 s53, s39, 0
 s_mov_b32 s54, 67108864
 s_mov_b32 s55, 0x00020000
 s_add_u32 s56, s38, 180355072
 s_addc_u32 s57, s39, 0
 s_mov_b32 s58, 67108864
 s_mov_b32 s59, 0x00020000
 s_load_dwordx2 s[72:73], s[0:1], 104
 s_waitcnt lgkmcnt(0)
 s_add_u32 s72, s72, 81068032
 s_addc_u32 s73, s73, 0
 s_mov_b32 s74, 129024
 s_mov_b32 s75, 0x00020000
 s_mul_i32 s44, s42, 384
 s_mul_i32 s24, s45, 307200
 v_mov_b32 v9, 2731
 s_and_b32 s22, s20, 1
 s_lshl_b32 s22, s22, 2
 v_add_u32 v8, 0, v1
 v_mul_u32_u24 v7, v8, v9
 v_lshrrev_b32 v7, 16, v7
 v_mul_u32_u24 v4, 24, v7
 v_sub_u32 v8, v8, v4
 v_and_b32 v4, 2, v7
 v_xor_b32 v8, v8, v4
 v_xor_b32 v8, s22, v8
 v_xor_b32 v5, 4, v8
 s_mov_b32 s21, 12288
 v_mul_lo_u32 v7, v7, s21
 v_lshl_add_u32 v40, v8, 4, v7
 v_lshl_add_u32 v43, v5, 4, v7
 v_add_u32 v8, 64, v1
 v_mul_u32_u24 v7, v8, v9
 v_lshrrev_b32 v7, 16, v7
 v_mul_u32_u24 v4, 24, v7
 v_sub_u32 v8, v8, v4
 v_and_b32 v4, 2, v7
 v_xor_b32 v8, v8, v4
 v_xor_b32 v8, s22, v8
 v_xor_b32 v5, 4, v8
 s_mov_b32 s21, 12288
 v_mul_lo_u32 v7, v7, s21
 v_lshl_add_u32 v41, v8, 4, v7
 v_lshl_add_u32 v44, v5, 4, v7
 v_add_u32 v8, 128, v1
 v_mul_u32_u24 v7, v8, v9
 v_lshrrev_b32 v7, 16, v7
 v_mul_u32_u24 v4, 24, v7
 v_sub_u32 v8, v8, v4
 v_and_b32 v4, 2, v7
 v_xor_b32 v8, v8, v4
 v_xor_b32 v8, s22, v8
 v_xor_b32 v5, 4, v8
 s_mov_b32 s21, 12288
 v_mul_lo_u32 v7, v7, s21
 v_lshl_add_u32 v42, v8, 4, v7
 v_lshl_add_u32 v45, v5, 4, v7
 s_mul_i32 s23, s20, 491520
 s_add_u32 s23, s23, s44
 s_mul_i32 s22, s20, 15360
 s_add_u32 s22, s22, 98304
 s_add_u32 s21, s23, 0
 s_add_u32 m0, s22, 0
 s_nop 0
 buffer_load_dwordx4 v40, s[12:15], s21 offen lds
 s_add_u32 m0, s22, 1024
 s_nop 0
 buffer_load_dwordx4 v41, s[12:15], s21 offen lds
 s_add_u32 m0, s22, 2048
 s_nop 0
 buffer_load_dwordx4 v42, s[12:15], s21 offen lds
 s_add_u32 s21, s23, 98304
 s_add_u32 m0, s22, 3072
 s_nop 0
 buffer_load_dwordx4 v43, s[12:15], s21 offen lds
 s_add_u32 m0, s22, 4096
 s_nop 0
 buffer_load_dwordx4 v44, s[12:15], s21 offen lds
 s_add_u32 m0, s22, 5120
 s_nop 0
 buffer_load_dwordx4 v45, s[12:15], s21 offen lds
 s_add_u32 s21, s23, 196608
 s_add_u32 m0, s22, 6144
 s_nop 0
 buffer_load_dwordx4 v40, s[12:15], s21 offen lds
 s_add_u32 m0, s22, 7168
 s_nop 0
 buffer_load_dwordx4 v41, s[12:15], s21 offen lds
 s_add_u32 m0, s22, 8192
 s_nop 0
 buffer_load_dwordx4 v42, s[12:15], s21 offen lds
 s_add_u32 s21, s23, 294912
 s_add_u32 m0, s22, 9216
 s_nop 0
 buffer_load_dwordx4 v43, s[12:15], s21 offen lds
 s_add_u32 m0, s22, 10240
 s_nop 0
 buffer_load_dwordx4 v44, s[12:15], s21 offen lds
 s_add_u32 m0, s22, 11264
 s_nop 0
 buffer_load_dwordx4 v45, s[12:15], s21 offen lds
 s_add_u32 s21, s23, 393216
 s_add_u32 m0, s22, 12288
 s_nop 0
 buffer_load_dwordx4 v40, s[12:15], s21 offen lds
 s_add_u32 m0, s22, 13312
 s_nop 0
 buffer_load_dwordx4 v41, s[12:15], s21 offen lds
 s_add_u32 m0, s22, 14336
 s_nop 0
 buffer_load_dwordx4 v42, s[12:15], s21 offen lds
 s_add_u32 s21, s23, 1966080
 buffer_load_dwordx4 v[64:67], v40, s[12:15], s21 offen
 buffer_load_dwordx4 v[68:71], v41, s[12:15], s21 offen
 buffer_load_dwordx4 v[72:75], v42, s[12:15], s21 offen
 s_add_u32 s21, s23, 2064384
 buffer_load_dwordx4 v[76:79], v43, s[12:15], s21 offen
 buffer_load_dwordx4 v[80:83], v44, s[12:15], s21 offen
 buffer_load_dwordx4 v[84:87], v45, s[12:15], s21 offen
 s_add_u32 s21, s23, 2162688
 buffer_load_dwordx4 v[88:91], v40, s[12:15], s21 offen
 buffer_load_dwordx4 v[92:95], v41, s[12:15], s21 offen
 buffer_load_dwordx4 v[96:99], v42, s[12:15], s21 offen
 s_add_u32 s21, s23, 2260992
 buffer_load_dwordx4 v[100:103], v43, s[12:15], s21 offen
 buffer_load_dwordx4 v[104:107], v44, s[12:15], s21 offen
 buffer_load_dwordx4 v[108:111], v45, s[12:15], s21 offen
 s_add_u32 s21, s23, 2359296
 buffer_load_dwordx4 v[112:115], v40, s[12:15], s21 offen
 buffer_load_dwordx4 v[116:119], v41, s[12:15], s21 offen
 buffer_load_dwordx4 v[120:123], v42, s[12:15], s21 offen
 s_add_u32 s21, s23, 3932160
 buffer_load_dwordx4 v[124:127], v40, s[12:15], s21 offen
 buffer_load_dwordx4 v[128:131], v41, s[12:15], s21 offen
 buffer_load_dwordx4 v[132:135], v42, s[12:15], s21 offen
 s_add_u32 s21, s23, 4030464
 buffer_load_dwordx4 v[136:139], v43, s[12:15], s21 offen
 buffer_load_dwordx4 v[140:143], v44, s[12:15], s21 offen
 buffer_load_dwordx4 v[144:147], v45, s[12:15], s21 offen
 s_add_u32 s21, s23, 4128768
 buffer_load_dwordx4 v[148:151], v40, s[12:15], s21 offen
 buffer_load_dwordx4 v[152:155], v41, s[12:15], s21 offen
 buffer_load_dwordx4 v[156:159], v42, s[12:15], s21 offen
 s_add_u32 s21, s23, 4227072
 buffer_load_dwordx4 v[160:163], v43, s[12:15], s21 offen
 buffer_load_dwordx4 v[164:167], v44, s[12:15], s21 offen
 buffer_load_dwordx4 v[168:171], v45, s[12:15], s21 offen
 s_add_u32 s21, s23, 4325376
 buffer_load_dwordx4 v[172:175], v40, s[12:15], s21 offen
 buffer_load_dwordx4 v[176:179], v41, s[12:15], s21 offen
 buffer_load_dwordx4 v[180:183], v42, s[12:15], s21 offen
 s_add_u32 s21, s23, 5898240
 buffer_load_dwordx4 v[184:187], v40, s[12:15], s21 offen
 buffer_load_dwordx4 v[188:191], v41, s[12:15], s21 offen
 buffer_load_dwordx4 v[192:195], v42, s[12:15], s21 offen
 s_add_u32 s21, s23, 5996544
 buffer_load_dwordx4 v[196:199], v43, s[12:15], s21 offen
 buffer_load_dwordx4 v[200:203], v44, s[12:15], s21 offen
 buffer_load_dwordx4 v[204:207], v45, s[12:15], s21 offen
 s_add_u32 s21, s23, 6094848
 buffer_load_dwordx4 v[208:211], v40, s[12:15], s21 offen
 buffer_load_dwordx4 v[212:215], v41, s[12:15], s21 offen
 buffer_load_dwordx4 v[216:219], v42, s[12:15], s21 offen
 s_add_u32 s21, s23, 6193152
 buffer_load_dwordx4 v[220:223], v43, s[12:15], s21 offen
 buffer_load_dwordx4 v[224:227], v44, s[12:15], s21 offen
 buffer_load_dwordx4 v[228:231], v45, s[12:15], s21 offen
 s_add_u32 s21, s23, 6291456
 buffer_load_dwordx4 v[232:235], v40, s[12:15], s21 offen
 buffer_load_dwordx4 v[236:239], v41, s[12:15], s21 offen
 buffer_load_dwordx4 v[240:243], v42, s[12:15], s21 offen
 v_lshl_add_u32 v49, v1, 4, s22
 v_lshrrev_b32 v7, 2, v2
 v_and_b32 v4, 2, v7
 v_and_b32 v5, 1, v3
 v_lshl_or_b32 v4, v5, 2, v4
 v_lshl_add_u32 v7, v3, 3, v7
 v_mul_u32_u24 v7, 384, v7
 v_and_b32 v5, 1, v2
 v_lshl_add_u32 v7, v5, 3, v7
 v_add_u32 v7, 98304, v7
 v_bfe_u32 v8, v2, 1, 1
 s_mul_i32 s21, s20, 6
 v_add_u32 v8, s21, v8
 v_add_u32 v5, 0, v8
 v_xor_b32 v5, v5, v4
 v_lshl_add_u32 v46, v5, 4, v7
 v_add_u32 v5, 2, v8
 v_xor_b32 v5, v5, v4
 v_lshl_add_u32 v47, v5, 4, v7
 v_add_u32 v5, 4, v8
 v_xor_b32 v5, v5, v4
 v_lshl_add_u32 v48, v5, 4, v7
 s_waitcnt vmcnt(45)
 s_barrier
 ds_read_b64_tr_b16 a[0:1], v46 offset:0
 ds_read_b64_tr_b16 a[2:3], v46 offset:1536
 ds_read_b64_tr_b16 a[4:5], v47 offset:0
 ds_read_b64_tr_b16 a[6:7], v47 offset:1536
 ds_read_b64_tr_b16 a[8:9], v48 offset:0
 ds_read_b64_tr_b16 a[10:11], v48 offset:1536
 ds_read_b64_tr_b16 a[12:13], v46 offset:12288
 ds_read_b64_tr_b16 a[14:15], v46 offset:13824
 ds_read_b64_tr_b16 a[16:17], v47 offset:12288
 ds_read_b64_tr_b16 a[18:19], v47 offset:13824
 ds_read_b64_tr_b16 a[20:21], v48 offset:12288
 ds_read_b64_tr_b16 a[22:23], v48 offset:13824
 ds_read_b64_tr_b16 a[24:25], v46 offset:24576
 ds_read_b64_tr_b16 a[26:27], v46 offset:26112
 ds_read_b64_tr_b16 a[28:29], v47 offset:24576
 ds_read_b64_tr_b16 a[30:31], v47 offset:26112
 ds_read_b64_tr_b16 a[32:33], v48 offset:24576
 ds_read_b64_tr_b16 a[34:35], v48 offset:26112
 ds_read_b64_tr_b16 a[36:37], v46 offset:36864
 ds_read_b64_tr_b16 a[38:39], v46 offset:38400
 ds_read_b64_tr_b16 a[40:41], v47 offset:36864
 ds_read_b64_tr_b16 a[42:43], v47 offset:38400
 ds_read_b64_tr_b16 a[44:45], v48 offset:36864
 ds_read_b64_tr_b16 a[46:47], v48 offset:38400
 ds_read_b64_tr_b16 a[48:49], v46 offset:49152
 ds_read_b64_tr_b16 a[50:51], v46 offset:50688
 ds_read_b64_tr_b16 a[52:53], v47 offset:49152
 ds_read_b64_tr_b16 a[54:55], v47 offset:50688
 ds_read_b64_tr_b16 a[56:57], v48 offset:49152
 ds_read_b64_tr_b16 a[58:59], v48 offset:50688
 v_lshrrev_b32 v11, 3, v1
 v_and_b32 v12, 7, v1
 v_xor_b32 v12, v12, v11
 v_mul_u32_u24 v11, 1280, v11
 v_lshl_add_u32 v10, v12, 4, v11
 s_mul_i32 s46, s20, 40960
 v_add_u32 v10, s46, v10
 s_lshl_b32 s47, s20, 12
 s_add_u32 s47, s47, 0
 s_add_u32 s46, s47, 98304
 s_mov_b32 s30, s24
 s_add_u32 s32, s47, 0
 v_add_u32 v11, 9216, v10
 v_add_u32 v12, 18432, v10
 v_add_u32 v13, 27648, v10
 s_mov_b32 m0, s32
 s_nop 0
 buffer_load_dwordx4 v10, s[8:11], s30 offen offset:0 lds
 buffer_load_dwordx4 v11, s[8:11], s30 offen offset:1024 lds
 buffer_load_dwordx4 v12, s[8:11], s30 offen offset:2048 lds
 buffer_load_dwordx4 v13, s[8:11], s30 offen offset:3072 lds
 s_add_u32 s30, s30, 128
 s_add_u32 s32, s32, 16384
 s_cmp_lt_u32 s32, s46
 s_cselect_b32 s32, s32, s47
 s_mov_b32 m0, s32
 s_nop 0
 buffer_load_dwordx4 v10, s[8:11], s30 offen offset:0 lds
 buffer_load_dwordx4 v11, s[8:11], s30 offen offset:1024 lds
 buffer_load_dwordx4 v12, s[8:11], s30 offen offset:2048 lds
 buffer_load_dwordx4 v13, s[8:11], s30 offen offset:3072 lds
 s_add_u32 s30, s30, 128
 s_add_u32 s32, s32, 16384
 s_cmp_lt_u32 s32, s46
 s_cselect_b32 s32, s32, s47
 s_mov_b32 m0, s32
 s_nop 0
 buffer_load_dwordx4 v10, s[8:11], s30 offen offset:0 lds
 buffer_load_dwordx4 v11, s[8:11], s30 offen offset:1024 lds
 buffer_load_dwordx4 v12, s[8:11], s30 offen offset:2048 lds
 buffer_load_dwordx4 v13, s[8:11], s30 offen offset:3072 lds
 s_add_u32 s30, s30, 128
 s_add_u32 s32, s32, 16384
 s_cmp_lt_u32 s32, s46
 s_cselect_b32 s32, s32, s47
 s_mov_b32 m0, s32
 s_nop 0
 buffer_load_dwordx4 v10, s[8:11], s30 offen offset:0 lds
 buffer_load_dwordx4 v11, s[8:11], s30 offen offset:1024 lds
 buffer_load_dwordx4 v12, s[8:11], s30 offen offset:2048 lds
 buffer_load_dwordx4 v13, s[8:11], s30 offen offset:3072 lds
 s_add_u32 s30, s30, 128
 s_add_u32 s32, s32, 16384
 s_cmp_lt_u32 s32, s46
 s_cselect_b32 s32, s32, s47
 s_waitcnt lgkmcnt(0)
 s_barrier
 s_waitcnt vmcnt(46)
 ds_write_b128 v49, v[64:67] offset:0
 ds_write_b128 v49, v[68:71] offset:1024
 ds_write_b128 v49, v[72:75] offset:2048
 ds_write_b128 v49, v[76:79] offset:3072
 ds_write_b128 v49, v[80:83] offset:4096
 ds_write_b128 v49, v[84:87] offset:5120
 ds_write_b128 v49, v[88:91] offset:6144
 ds_write_b128 v49, v[92:95] offset:7168
 ds_write_b128 v49, v[96:99] offset:8192
 ds_write_b128 v49, v[100:103] offset:9216
 ds_write_b128 v49, v[104:107] offset:10240
 ds_write_b128 v49, v[108:111] offset:11264
 ds_write_b128 v49, v[112:115] offset:12288
 ds_write_b128 v49, v[116:119] offset:13312
 ds_write_b128 v49, v[120:123] offset:14336
 s_waitcnt lgkmcnt(0)
 s_barrier
 ds_read_b64_tr_b16 a[60:61], v46 offset:0
 ds_read_b64_tr_b16 a[62:63], v46 offset:1536
 ds_read_b64_tr_b16 a[64:65], v47 offset:0
 ds_read_b64_tr_b16 a[66:67], v47 offset:1536
 ds_read_b64_tr_b16 a[68:69], v48 offset:0
 ds_read_b64_tr_b16 a[70:71], v48 offset:1536
 ds_read_b64_tr_b16 a[72:73], v46 offset:12288
 ds_read_b64_tr_b16 a[74:75], v46 offset:13824
 ds_read_b64_tr_b16 a[76:77], v47 offset:12288
 ds_read_b64_tr_b16 a[78:79], v47 offset:13824
 ds_read_b64_tr_b16 a[80:81], v48 offset:12288
 ds_read_b64_tr_b16 a[82:83], v48 offset:13824
 ds_read_b64_tr_b16 a[84:85], v46 offset:24576
 ds_read_b64_tr_b16 a[86:87], v46 offset:26112
 ds_read_b64_tr_b16 a[88:89], v47 offset:24576
 ds_read_b64_tr_b16 a[90:91], v47 offset:26112
 ds_read_b64_tr_b16 a[92:93], v48 offset:24576
 ds_read_b64_tr_b16 a[94:95], v48 offset:26112
 ds_read_b64_tr_b16 a[96:97], v46 offset:36864
 ds_read_b64_tr_b16 a[98:99], v46 offset:38400
 ds_read_b64_tr_b16 a[100:101], v47 offset:36864
 ds_read_b64_tr_b16 a[102:103], v47 offset:38400
 ds_read_b64_tr_b16 a[104:105], v48 offset:36864
 ds_read_b64_tr_b16 a[106:107], v48 offset:38400
 ds_read_b64_tr_b16 a[108:109], v46 offset:49152
 ds_read_b64_tr_b16 a[110:111], v46 offset:50688
 ds_read_b64_tr_b16 a[112:113], v47 offset:49152
 ds_read_b64_tr_b16 a[114:115], v47 offset:50688
 ds_read_b64_tr_b16 a[116:117], v48 offset:49152
 ds_read_b64_tr_b16 a[118:119], v48 offset:50688
 s_waitcnt lgkmcnt(0)
 s_barrier
 s_waitcnt vmcnt(31)
 ds_write_b128 v49, v[124:127] offset:0
 ds_write_b128 v49, v[128:131] offset:1024
 ds_write_b128 v49, v[132:135] offset:2048
 ds_write_b128 v49, v[136:139] offset:3072
 ds_write_b128 v49, v[140:143] offset:4096
 ds_write_b128 v49, v[144:147] offset:5120
 ds_write_b128 v49, v[148:151] offset:6144
 ds_write_b128 v49, v[152:155] offset:7168
 ds_write_b128 v49, v[156:159] offset:8192
 ds_write_b128 v49, v[160:163] offset:9216
 ds_write_b128 v49, v[164:167] offset:10240
 ds_write_b128 v49, v[168:171] offset:11264
 ds_write_b128 v49, v[172:175] offset:12288
 ds_write_b128 v49, v[176:179] offset:13312
 ds_write_b128 v49, v[180:183] offset:14336
 s_waitcnt lgkmcnt(0)
 s_barrier
 ds_read_b64_tr_b16 a[120:121], v46 offset:0
 ds_read_b64_tr_b16 a[122:123], v46 offset:1536
 ds_read_b64_tr_b16 a[124:125], v47 offset:0
 ds_read_b64_tr_b16 a[126:127], v47 offset:1536
 ds_read_b64_tr_b16 a[128:129], v48 offset:0
 ds_read_b64_tr_b16 a[130:131], v48 offset:1536
 ds_read_b64_tr_b16 a[132:133], v46 offset:12288
 ds_read_b64_tr_b16 a[134:135], v46 offset:13824
 ds_read_b64_tr_b16 a[136:137], v47 offset:12288
 ds_read_b64_tr_b16 a[138:139], v47 offset:13824
 ds_read_b64_tr_b16 a[140:141], v48 offset:12288
 ds_read_b64_tr_b16 a[142:143], v48 offset:13824
 ds_read_b64_tr_b16 a[144:145], v46 offset:24576
 ds_read_b64_tr_b16 a[146:147], v46 offset:26112
 ds_read_b64_tr_b16 a[148:149], v47 offset:24576
 ds_read_b64_tr_b16 a[150:151], v47 offset:26112
 ds_read_b64_tr_b16 a[152:153], v48 offset:24576
 ds_read_b64_tr_b16 a[154:155], v48 offset:26112
 ds_read_b64_tr_b16 a[156:157], v46 offset:36864
 ds_read_b64_tr_b16 a[158:159], v46 offset:38400
 ds_read_b64_tr_b16 a[160:161], v47 offset:36864
 ds_read_b64_tr_b16 a[162:163], v47 offset:38400
 ds_read_b64_tr_b16 a[164:165], v48 offset:36864
 ds_read_b64_tr_b16 a[166:167], v48 offset:38400
 ds_read_b64_tr_b16 a[168:169], v46 offset:49152
 ds_read_b64_tr_b16 a[170:171], v46 offset:50688
 ds_read_b64_tr_b16 a[172:173], v47 offset:49152
 ds_read_b64_tr_b16 a[174:175], v47 offset:50688
 ds_read_b64_tr_b16 a[176:177], v48 offset:49152
 ds_read_b64_tr_b16 a[178:179], v48 offset:50688
 s_waitcnt lgkmcnt(0)
 s_barrier
 s_waitcnt vmcnt(16)
 ds_write_b128 v49, v[184:187] offset:0
 ds_write_b128 v49, v[188:191] offset:1024
 ds_write_b128 v49, v[192:195] offset:2048
 ds_write_b128 v49, v[196:199] offset:3072
 ds_write_b128 v49, v[200:203] offset:4096
 ds_write_b128 v49, v[204:207] offset:5120
 ds_write_b128 v49, v[208:211] offset:6144
 ds_write_b128 v49, v[212:215] offset:7168
 ds_write_b128 v49, v[216:219] offset:8192
 ds_write_b128 v49, v[220:223] offset:9216
 ds_write_b128 v49, v[224:227] offset:10240
 ds_write_b128 v49, v[228:231] offset:11264
 ds_write_b128 v49, v[232:235] offset:12288
 ds_write_b128 v49, v[236:239] offset:13312
 ds_write_b128 v49, v[240:243] offset:14336
 s_waitcnt lgkmcnt(0)
 s_barrier
 ds_read_b64_tr_b16 a[180:181], v46 offset:0
 ds_read_b64_tr_b16 a[182:183], v46 offset:1536
 ds_read_b64_tr_b16 a[184:185], v47 offset:0
 ds_read_b64_tr_b16 a[186:187], v47 offset:1536
 ds_read_b64_tr_b16 a[188:189], v48 offset:0
 ds_read_b64_tr_b16 a[190:191], v48 offset:1536
 ds_read_b64_tr_b16 a[192:193], v46 offset:12288
 ds_read_b64_tr_b16 a[194:195], v46 offset:13824
 ds_read_b64_tr_b16 a[196:197], v47 offset:12288
 ds_read_b64_tr_b16 a[198:199], v47 offset:13824
 ds_read_b64_tr_b16 a[200:201], v48 offset:12288
 ds_read_b64_tr_b16 a[202:203], v48 offset:13824
 ds_read_b64_tr_b16 a[204:205], v46 offset:24576
 ds_read_b64_tr_b16 a[206:207], v46 offset:26112
 ds_read_b64_tr_b16 a[208:209], v47 offset:24576
 ds_read_b64_tr_b16 a[210:211], v47 offset:26112
 ds_read_b64_tr_b16 a[212:213], v48 offset:24576
 ds_read_b64_tr_b16 a[214:215], v48 offset:26112
 ds_read_b64_tr_b16 a[216:217], v46 offset:36864
 ds_read_b64_tr_b16 a[218:219], v46 offset:38400
 ds_read_b64_tr_b16 a[220:221], v47 offset:36864
 ds_read_b64_tr_b16 a[222:223], v47 offset:38400
 ds_read_b64_tr_b16 a[224:225], v48 offset:36864
 ds_read_b64_tr_b16 a[226:227], v48 offset:38400
 ds_read_b64_tr_b16 a[228:229], v46 offset:49152
 ds_read_b64_tr_b16 a[230:231], v46 offset:50688
 ds_read_b64_tr_b16 a[232:233], v47 offset:49152
 ds_read_b64_tr_b16 a[234:235], v47 offset:50688
 ds_read_b64_tr_b16 a[236:237], v48 offset:49152
 ds_read_b64_tr_b16 a[238:239], v48 offset:50688
 s_waitcnt lgkmcnt(0)
 s_barrier
 s_add_u32 s12, s38, 57671680
 s_addc_u32 s13, s39, 0
 s_mov_b32 s14, 1572864
 s_mov_b32 s15, 0x00020000
 s_mul_i32 s21, s20, 12800
 s_add_u32 s21, s21, 98304
 v_mul_u32_u24 v4, 400, v2
 v_lshlrev_b32 v5, 4, v3
 v_add3_u32 v29, v4, v5, s21
 v_lshlrev_b32 v30, 4, v1
 v_and_b32 v4, 1, v2
 v_bfe_u32 v5, v2, 1, 1
 v_lshl_or_b32 v4, v5, 2, v4
 v_bfe_u32 v5, v2, 2, 1
 v_lshl_or_b32 v4, v5, 1, v4
 v_lshlrev_b32 v4, 4, v4
 v_lshl_add_u32 v31, v3, 7, v4
 v_lshlrev_b32 v32, 3, v1
 v_and_b32 v4, 3, v1
 v_lshlrev_b32 v33, 3, v4
 v_mov_b32 v34, 0xf149f2ca
 v_lshlrev_b32 v4, 2, v3
 v_sub_u32 v35, v2, v4
 v_cmp_gt_u32 s[60:61], 2, v3
 s_mov_b32 s62, 0x3d93cd3a
 s_mov_b32 s63, 0x3fb8aa3b
 s_mov_b32 s83, 0x3dd53b95
 v_cmp_le_i32 s[64:65], 0, v35
 v_cmp_le_i32 s[66:67], 1, v35
 v_cmp_le_i32 s[68:69], 2, v35
 v_cmp_le_i32 s[70:71], 3, v35
 s_mov_b32 s25, 163840
 s_cmp_lg_u32 s45, 0
 s_cselect_b32 s26, 6, 10
 s_cselect_b32 s40, 6, 99
 s_cselect_b32 s25, 4294148096, s25
 s_lshl_b32 s43, s42, 2
 s_add_u32 s43, s43, s20
 s_mul_i32 s43, s43, 12288
 s_lshr_b32 s21, s42, 2
 s_lshl_b32 s21, s21, 14
 s_and_b32 s44, s42, 3
 s_lshl_b32 s44, s44, 11
 s_add_u32 s44, s44, s21
 s_add_u32 s44, s44, 655360
 s_lshr_b32 s36, s42, 1
 s_lshl_b32 s36, s36, 14
 s_and_b32 s21, s42, 1
 s_mul_i32 s21, s21, 3072
 s_add_u32 s36, s36, s21
 s_add_u32 s36, s36, 655360
 s_lshl_b32 s49, s41, 2
 s_add_u32 s49, s49, s20
 s_mov_b32 s29, 4
 s_mov_b32 s78, 0
 s_mov_b32 s81, 0x80000000
 s_mov_b32 s82, 0
 s_mul_i32 s21, s49, 393216
 s_mul_i32 s22, s42, 12288
 s_add_u32 s50, s21, s22
 s_lshl_b32 s21, s49, 12
 s_and_b32 s21, s21, 8192
 s_xor_b32 s21, s21, s37
 s_lshl_b32 s51, s49, 20
 s_or_b32 s51, s51, s21
 s_xor_b32 s51, s51, 8192
 s_add_u32 s51, s51, s36
 s_lshr_b32 s22, s49, 1
 s_lshr_b32 s21, s49, 2
 s_add_u32 s21, s21, 3
 s_cmp_lt_u32 s49, 12
 s_cselect_b32 s21, s22, s21
 s_lshl_b32 s21, s21, 3
 s_lshr_b32 s22, s42, 2
 s_add_u32 s21, s21, s22
 s_lshl_b32 s21, s21, 7
 s_add_u32 s76, s21, 0
 s_lshl_b32 s77, s42, 7
 s_add_u32 s77, s77, 19456
 v_mov_b32 v21, 0
 buffer_load_dword v21, v33, s[72:75], s77 offen sc1
 v_and_b32 v6, 7, v2
 v_add_u32 v4, 0, v3
 v_xor_b32 v4, v4, v6
 v_lshlrev_b32 v4, 4, v4
 v_lshl_add_u32 v14, v2, 7, v4
 v_add_u32 v4, 4, v3
 v_xor_b32 v4, v4, v6
 v_lshlrev_b32 v4, 4, v4
 v_lshl_add_u32 v15, v2, 7, v4
 v_mul_u32_u24 v22, 400, v2
 v_mul_u32_u24 v4, 16, v3
 s_mul_i32 s21, s20, 96
 s_add_u32 s21, s21, 98304
 v_add3_u32 v22, v22, v4, s21
 v_lshlrev_b32 v4, 3, v3
 v_sub_u32 v16, v22, v4
 v_mov_b32 v9, 2731
 s_mov_b32 s33, 0
 s_mov_b32 s48, 0x80000000
 s_mov_b32 m0, s32
 s_nop 0
 buffer_load_dwordx4 v10, s[8:11], s30 offen offset:0 lds
 buffer_load_dwordx4 v11, s[8:11], s30 offen offset:1024 lds
 s_waitcnt vmcnt(14)
 s_barrier
 v_add_u32 v18, s33, v14
 v_add_u32 v19, s33, v15
 s_add_u32 s33, s33, 16384
 s_cmp_lt_u32 s33, 98304
 s_cselect_b32 s33, s33, 0
 ds_read_b128 v[160:163], v18 offset:0
 ds_read_b128 v[164:167], v18 offset:2048
 ds_read_b128 v[168:171], v18 offset:4096
 ds_read_b128 v[172:175], v18 offset:6144
 ds_read_b128 v[176:179], v18 offset:8192
 ds_read_b128 v[180:183], v18 offset:10240
 ds_read_b128 v[184:187], v18 offset:12288
 ds_read_b128 v[188:191], v18 offset:14336
 s_waitcnt lgkmcnt(0)
qa_blk_202:
 v_mfma_f32_16x16x32_bf16 v[64:67], a[0:3], v[160:163], 0
 ds_read_b128 v[192:195], v19 offset:0
 v_mfma_f32_16x16x32_bf16 v[68:71], a[4:7], v[160:163], 0
 v_add_u32 v18, s33, v14
 v_cndmask_b32 v36, v34, v36, s[64:65]
 v_mfma_f32_16x16x32_bf16 v[72:75], a[8:11], v[160:163], 0
 v_cndmask_b32 v48, v34, v48, s[64:65]
 v_cndmask_b32 v37, v34, v37, s[66:67]
 v_mfma_f32_16x16x32_bf16 v[76:79], a[0:3], v[164:167], 0
 ds_read_b128 v[196:199], v19 offset:2048
 v_cndmask_b32 v49, v34, v49, s[66:67]
 v_mfma_f32_16x16x32_bf16 v[80:83], a[4:7], v[164:167], 0
 buffer_load_dwordx4 v12, s[8:11], s30 offen offset:2048 lds
 v_mfma_f32_16x16x32_bf16 v[84:87], a[8:11], v[164:167], 0
 v_cndmask_b32 v38, v34, v38, s[68:69]
 v_cndmask_b32 v50, v34, v50, s[68:69]
 v_mfma_f32_16x16x32_bf16 v[88:91], a[0:3], v[168:171], 0
 ds_read_b128 v[200:203], v19 offset:4096
 v_cndmask_b32 v39, v34, v39, s[70:71]
 v_mfma_f32_16x16x32_bf16 v[92:95], a[4:7], v[168:171], 0
 v_cndmask_b32 v51, v34, v51, s[70:71]
 v_max3_f32 v56, v36, v37, v38
 v_mfma_f32_16x16x32_bf16 v[96:99], a[8:11], v[168:171], 0
 v_max3_f32 v56, v56, v39, v40
 v_max3_f32 v56, v56, v41, v42
 v_mfma_f32_16x16x32_bf16 v[100:103], a[0:3], v[172:175], 0
 ds_read_b128 v[204:207], v19 offset:6144
 v_max_f32 v56, v56, v43
 v_mfma_f32_16x16x32_bf16 v[104:107], a[4:7], v[172:175], 0
 v_mov_b32 v57, v56
 v_mfma_f32_16x16x32_bf16 v[108:111], a[8:11], v[172:175], 0
 s_waitcnt lgkmcnt(15)
 v_mfma_f32_16x16x32_bf16 v[112:115], a[0:3], v[176:179], 0
 ds_read_b128 v[208:211], v19 offset:8192
 v_mfma_f32_16x16x32_bf16 v[116:119], a[4:7], v[176:179], 0
 s_nop 1
 v_mfma_f32_16x16x32_bf16 v[120:123], a[8:11], v[176:179], 0
 v_permlane32_swap_b32 v56, v57
 v_mfma_f32_16x16x32_bf16 v[124:127], a[0:3], v[180:183], 0
 ds_read_b128 v[212:215], v19 offset:10240
 v_max_f32 v56, v56, v57
 v_mfma_f32_16x16x32_bf16 v[128:131], a[4:7], v[180:183], 0
 buffer_load_dwordx4 v13, s[8:11], s30 offen offset:3072 lds
 v_mfma_f32_16x16x32_bf16 v[132:135], a[8:11], v[180:183], 0
 s_add_u32 s30, s30, 128
 s_add_u32 m0, m0, 16384
 v_mfma_f32_16x16x32_bf16 v[136:139], a[0:3], v[184:187], 0
 ds_read_b128 v[216:219], v19 offset:12288
 v_mov_b32 v57, v56
 v_mfma_f32_16x16x32_bf16 v[140:143], a[4:7], v[184:187], 0
 s_cmp_lt_u32 m0, s46
 s_cselect_b32 m0, m0, s47
 v_mfma_f32_16x16x32_bf16 v[144:147], a[8:11], v[184:187], 0
 s_nop 1
 v_mfma_f32_16x16x32_bf16 v[148:151], a[0:3], v[188:191], 0
 ds_read_b128 v[220:223], v19 offset:14336
 v_mfma_f32_16x16x32_bf16 v[152:155], a[4:7], v[188:191], 0
 v_permlane16_swap_b32 v56, v57
 v_mfma_f32_16x16x32_bf16 v[156:159], a[8:11], v[188:191], 0
 s_waitcnt vmcnt(12) lgkmcnt(4)
 s_barrier
 v_mfma_f32_16x16x32_bf16 v[64:67], a[12:15], v[192:195], v[64:67]
 ds_read_b128 v[160:163], v18 offset:0
 v_max_f32 v56, v56, v57
 v_mfma_f32_16x16x32_bf16 v[68:71], a[16:19], v[192:195], v[68:71]
 v_mul_f32 v56, s83, v56
 v_fma_f32 v36, v36, s83, -v56
 v_mfma_f32_16x16x32_bf16 v[72:75], a[20:23], v[192:195], v[72:75]
 v_add_u32 v19, s33, v15
 s_add_u32 s33, s33, 16384
 v_mfma_f32_16x16x32_bf16 v[76:79], a[12:15], v[196:199], v[76:79]
 ds_read_b128 v[164:167], v18 offset:2048
 s_mul_i32 s21, s49, 393216
 v_mfma_f32_16x16x32_bf16 v[80:83], a[16:19], v[196:199], v[80:83]
 buffer_load_dwordx4 v10, s[8:11], s30 offen offset:0 lds
 v_mfma_f32_16x16x32_bf16 v[84:87], a[20:23], v[196:199], v[84:87]
 s_cmp_lt_u32 s33, 98304
 s_cselect_b32 s33, s33, 0
 v_mfma_f32_16x16x32_bf16 v[88:91], a[12:15], v[200:203], v[88:91]
 ds_read_b128 v[168:171], v18 offset:4096
 s_mul_i32 s22, s42, 12288
 v_mfma_f32_16x16x32_bf16 v[92:95], a[16:19], v[200:203], v[92:95]
 s_add_u32 s50, s21, s22
 s_lshl_b32 s21, s49, 12
 v_mfma_f32_16x16x32_bf16 v[96:99], a[20:23], v[200:203], v[96:99]
 s_and_b32 s21, s21, 8192
 s_xor_b32 s21, s21, s37
 v_mfma_f32_16x16x32_bf16 v[100:103], a[12:15], v[204:207], v[100:103]
 ds_read_b128 v[172:175], v18 offset:6144
 s_lshl_b32 s51, s49, 20
 v_mfma_f32_16x16x32_bf16 v[104:107], a[16:19], v[204:207], v[104:107]
 s_or_b32 s51, s51, s21
 s_xor_b32 s51, s51, 8192
 v_mfma_f32_16x16x32_bf16 v[108:111], a[20:23], v[204:207], v[108:111]
 s_waitcnt lgkmcnt(4)
 s_add_u32 s51, s51, s36
 v_mfma_f32_16x16x32_bf16 v[112:115], a[12:15], v[208:211], v[112:115]
 ds_read_b128 v[176:179], v18 offset:8192
 s_add_u32 s23, s49, 1
 v_mfma_f32_16x16x32_bf16 v[116:119], a[16:19], v[208:211], v[116:119]
 v_cmp_gt_u32 vcc, s23, v21
 v_fma_f32 v37, v37, s83, -v56
 v_mfma_f32_16x16x32_bf16 v[120:123], a[20:23], v[208:211], v[120:123]
 s_cmp_eq_u64 vcc, 0
 s_cselect_b32 s80, 1, 0
 s_cselect_b32 s51, s51, 0x80000000
 v_mfma_f32_16x16x32_bf16 v[124:127], a[12:15], v[212:215], v[124:127]
 ds_read_b128 v[180:183], v18 offset:10240
 s_lshl_b32 s79, s80, 3
 v_mfma_f32_16x16x32_bf16 v[128:131], a[16:19], v[212:215], v[128:131]
 buffer_load_dwordx4 v11, s[8:11], s30 offen offset:1024 lds
 v_mfma_f32_16x16x32_bf16 v[132:135], a[20:23], v[212:215], v[132:135]
 s_or_b32 s79, s79, s45
 v_fma_f32 v38, v38, s83, -v56
 v_mfma_f32_16x16x32_bf16 v[136:139], a[12:15], v[216:219], v[136:139]
 ds_read_b128 v[184:187], v18 offset:12288
 v_fma_f32 v39, v39, s83, -v56
 v_mfma_f32_16x16x32_bf16 v[140:143], a[16:19], v[216:219], v[140:143]
 buffer_load_dwordx4 a[240:243], v31, s[52:55], s51 offen offset:0 sc1
 v_mfma_f32_16x16x32_bf16 v[144:147], a[20:23], v[216:219], v[144:147]
 v_fma_f32 v40, v40, s83, -v56
 v_fma_f32 v41, v41, s83, -v56
 v_mfma_f32_16x16x32_bf16 v[148:151], a[12:15], v[220:223], v[148:151]
 ds_read_b128 v[188:191], v18 offset:14336
 v_fma_f32 v42, v42, s83, -v56
 v_mfma_f32_16x16x32_bf16 v[152:155], a[16:19], v[220:223], v[152:155]
 v_fma_f32 v43, v43, s83, -v56
 v_mfma_f32_16x16x32_bf16 v[156:159], a[20:23], v[220:223], v[156:159]
 s_waitcnt lgkmcnt(4)
 v_mfma_f32_16x16x32_bf16 v[64:67], a[24:27], v[160:163], v[64:67]
 ds_read_b128 v[192:195], v19 offset:0
 v_mfma_f32_16x16x32_bf16 v[68:71], a[28:31], v[160:163], v[68:71]
 v_add_u32 v18, s33, v14
 v_mfma_f32_16x16x32_bf16 v[72:75], a[32:35], v[160:163], v[72:75]
 v_exp_f32 v36, v36
 v_mfma_f32_16x16x32_bf16 v[76:79], a[24:27], v[164:167], v[76:79]
 ds_read_b128 v[196:199], v19 offset:2048
 v_mfma_f32_16x16x32_bf16 v[80:83], a[28:31], v[164:167], v[80:83]
 buffer_load_dwordx4 v12, s[8:11], s30 offen offset:2048 lds
 v_mfma_f32_16x16x32_bf16 v[84:87], a[32:35], v[164:167], v[84:87]
 v_exp_f32 v37, v37
 v_mfma_f32_16x16x32_bf16 v[88:91], a[24:27], v[168:171], v[88:91]
 ds_read_b128 v[200:203], v19 offset:4096
 v_mfma_f32_16x16x32_bf16 v[92:95], a[28:31], v[168:171], v[92:95]
 v_exp_f32 v38, v38
 v_mfma_f32_16x16x32_bf16 v[96:99], a[32:35], v[168:171], v[96:99]
 v_exp_f32 v39, v39
 v_mfma_f32_16x16x32_bf16 v[100:103], a[24:27], v[172:175], v[100:103]
 ds_read_b128 v[204:207], v19 offset:6144
 v_mfma_f32_16x16x32_bf16 v[104:107], a[28:31], v[172:175], v[104:107]
 v_exp_f32 v40, v40
 v_mfma_f32_16x16x32_bf16 v[108:111], a[32:35], v[172:175], v[108:111]
 s_waitcnt lgkmcnt(4)
 v_mfma_f32_16x16x32_bf16 v[112:115], a[24:27], v[176:179], v[112:115]
 ds_read_b128 v[208:211], v19 offset:8192
 v_mfma_f32_16x16x32_bf16 v[116:119], a[28:31], v[176:179], v[116:119]
 v_exp_f32 v41, v41
 v_mfma_f32_16x16x32_bf16 v[120:123], a[32:35], v[176:179], v[120:123]
 v_exp_f32 v42, v42
 v_mfma_f32_16x16x32_bf16 v[124:127], a[24:27], v[180:183], v[124:127]
 ds_read_b128 v[212:215], v19 offset:10240
 v_mfma_f32_16x16x32_bf16 v[128:131], a[28:31], v[180:183], v[128:131]
 buffer_load_dwordx4 v13, s[8:11], s30 offen offset:3072 lds
 v_mfma_f32_16x16x32_bf16 v[132:135], a[32:35], v[180:183], v[132:135]
 s_add_u32 s30, s30, 128
 s_add_u32 m0, m0, 16384
 v_mfma_f32_16x16x32_bf16 v[136:139], a[24:27], v[184:187], v[136:139]
 ds_read_b128 v[216:219], v19 offset:12288
 v_mfma_f32_16x16x32_bf16 v[140:143], a[28:31], v[184:187], v[140:143]
 s_cmp_lt_u32 m0, s46
 s_cselect_b32 m0, m0, s47
 v_mfma_f32_16x16x32_bf16 v[144:147], a[32:35], v[184:187], v[144:147]
 buffer_load_dwordx4 a[244:247], v31, s[52:55], s51 offen offset:512 sc1
 v_mfma_f32_16x16x32_bf16 v[148:151], a[24:27], v[188:191], v[148:151]
 ds_read_b128 v[220:223], v19 offset:14336
 v_mfma_f32_16x16x32_bf16 v[152:155], a[28:31], v[188:191], v[152:155]
 v_exp_f32 v43, v43
 v_mfma_f32_16x16x32_bf16 v[156:159], a[32:35], v[188:191], v[156:159]
 s_waitcnt vmcnt(14) lgkmcnt(4)
 s_barrier
 v_mfma_f32_16x16x32_bf16 v[64:67], a[36:39], v[192:195], v[64:67]
 ds_read_b128 v[160:163], v18 offset:0
 s_nop 0
 v_mfma_f32_16x16x32_bf16 v[68:71], a[40:43], v[192:195], v[68:71]
 v_add_f32 v56, v40, v41
 v_add_f32 v56, v56, v42
 v_mfma_f32_16x16x32_bf16 v[72:75], a[44:47], v[192:195], v[72:75]
 v_add_u32 v19, s33, v15
 s_add_u32 s33, s33, 16384
 v_mfma_f32_16x16x32_bf16 v[76:79], a[36:39], v[196:199], v[76:79]
 ds_read_b128 v[164:167], v18 offset:2048
 v_add_f32 v56, v56, v43
 v_mfma_f32_16x16x32_bf16 v[80:83], a[40:43], v[196:199], v[80:83]
 buffer_load_dwordx4 v10, s[8:11], s30 offen offset:0 lds
 v_mfma_f32_16x16x32_bf16 v[84:87], a[44:47], v[196:199], v[84:87]
 s_cmp_lt_u32 s33, 98304
 s_cselect_b32 s33, s33, 0
 v_mfma_f32_16x16x32_bf16 v[88:91], a[36:39], v[200:203], v[88:91]
 ds_read_b128 v[168:171], v18 offset:4096
 v_cndmask_b32 v56, 0, v56, s[60:61]
 v_mfma_f32_16x16x32_bf16 v[92:95], a[40:43], v[200:203], v[92:95]
 v_add_f32 v56, v56, v36
 v_add_f32 v56, v56, v37
 v_mfma_f32_16x16x32_bf16 v[96:99], a[44:47], v[200:203], v[96:99]
 v_add_f32 v56, v56, v38
 v_add_f32 v56, v56, v39
 v_mfma_f32_16x16x32_bf16 v[100:103], a[36:39], v[204:207], v[100:103]
 ds_read_b128 v[172:175], v18 offset:6144
 v_mov_b32 v57, v56
 v_mfma_f32_16x16x32_bf16 v[104:107], a[40:43], v[204:207], v[104:107]
 s_nop 1
 v_mfma_f32_16x16x32_bf16 v[108:111], a[44:47], v[204:207], v[108:111]
 s_waitcnt lgkmcnt(4)
 v_mfma_f32_16x16x32_bf16 v[112:115], a[36:39], v[208:211], v[112:115]
 ds_read_b128 v[176:179], v18 offset:8192
 v_mfma_f32_16x16x32_bf16 v[116:119], a[40:43], v[208:211], v[116:119]
 v_permlane32_swap_b32 v56, v57
 v_mfma_f32_16x16x32_bf16 v[120:123], a[44:47], v[208:211], v[120:123]
 v_add_f32 v56, v56, v57
 v_mov_b32 v57, v56
 v_mfma_f32_16x16x32_bf16 v[124:127], a[36:39], v[212:215], v[124:127]
 ds_read_b128 v[180:183], v18 offset:10240
 v_mfma_f32_16x16x32_bf16 v[128:131], a[40:43], v[212:215], v[128:131]
 buffer_load_dwordx4 v11, s[8:11], s30 offen offset:1024 lds
 v_mfma_f32_16x16x32_bf16 v[132:135], a[44:47], v[212:215], v[132:135]
 buffer_load_dwordx4 a[248:251], v31, s[52:55], s51 offen offset:1024 sc1
 v_mfma_f32_16x16x32_bf16 v[136:139], a[36:39], v[216:219], v[136:139]
 ds_read_b128 v[184:187], v18 offset:12288
 v_mfma_f32_16x16x32_bf16 v[140:143], a[40:43], v[216:219], v[140:143]
 s_nop 1
 v_mfma_f32_16x16x32_bf16 v[144:147], a[44:47], v[216:219], v[144:147]
 v_permlane16_swap_b32 v56, v57
 v_mfma_f32_16x16x32_bf16 v[148:151], a[36:39], v[220:223], v[148:151]
 ds_read_b128 v[188:191], v18 offset:14336
 v_add_f32 v56, v56, v57
 v_mfma_f32_16x16x32_bf16 v[152:155], a[40:43], v[220:223], v[152:155]
 v_rcp_f32 v56, v56
 v_mfma_f32_16x16x32_bf16 v[156:159], a[44:47], v[220:223], v[156:159]
 s_waitcnt lgkmcnt(4)
 s_nop 0
 v_mfma_f32_16x16x32_bf16 v[64:67], a[48:51], v[160:163], v[64:67]
 ds_read_b128 v[192:195], v19 offset:0
 v_mul_f32 v36, v36, v56
 v_mfma_f32_16x16x32_bf16 v[68:71], a[52:55], v[160:163], v[68:71]
 v_add_u32 v18, s33, v14
 v_mul_f32 v37, v37, v56
 v_mfma_f32_16x16x32_bf16 v[72:75], a[56:59], v[160:163], v[72:75]
 v_mul_f32 v38, v38, v56
 v_mul_f32 v39, v39, v56
 v_mfma_f32_16x16x32_bf16 v[76:79], a[48:51], v[164:167], v[76:79]
 ds_read_b128 v[196:199], v19 offset:2048
 v_mul_f32 v40, v40, v56
 v_mfma_f32_16x16x32_bf16 v[80:83], a[52:55], v[164:167], v[80:83]
 buffer_load_dwordx4 v12, s[8:11], s30 offen offset:2048 lds
 v_mfma_f32_16x16x32_bf16 v[84:87], a[56:59], v[164:167], v[84:87]
 v_mul_f32 v41, v41, v56
 v_mul_f32 v42, v42, v56
 v_mfma_f32_16x16x32_bf16 v[88:91], a[48:51], v[168:171], v[88:91]
 ds_read_b128 v[200:203], v19 offset:4096
 v_mul_f32 v43, v43, v56
 v_mfma_f32_16x16x32_bf16 v[92:95], a[52:55], v[168:171], v[92:95]
 v_max3_f32 v56, v44, v45, v46
 v_max3_f32 v56, v56, v47, v48
 v_mfma_f32_16x16x32_bf16 v[96:99], a[56:59], v[168:171], v[96:99]
 v_max3_f32 v56, v56, v49, v50
 v_max3_f32 v56, v56, v51, v52
 v_mfma_f32_16x16x32_bf16 v[100:103], a[48:51], v[172:175], v[100:103]
 ds_read_b128 v[204:207], v19 offset:6144
 v_max3_f32 v56, v56, v53, v54
 v_mfma_f32_16x16x32_bf16 v[104:107], a[52:55], v[172:175], v[104:107]
 v_max_f32 v56, v56, v55
 v_mov_b32 v57, v56
 v_mfma_f32_16x16x32_bf16 v[108:111], a[56:59], v[172:175], v[108:111]
 s_waitcnt lgkmcnt(4)
 v_mfma_f32_16x16x32_bf16 v[112:115], a[48:51], v[176:179], v[112:115]
 ds_read_b128 v[208:211], v19 offset:8192
 v_mfma_f32_16x16x32_bf16 v[116:119], a[52:55], v[176:179], v[116:119]
 buffer_load_dwordx4 a[252:255], v31, s[52:55], s51 offen offset:1536 sc1
 v_mfma_f32_16x16x32_bf16 v[120:123], a[56:59], v[176:179], v[120:123]
 s_nop 1
 v_mfma_f32_16x16x32_bf16 v[124:127], a[48:51], v[180:183], v[124:127]
 ds_read_b128 v[212:215], v19 offset:10240
 v_mfma_f32_16x16x32_bf16 v[128:131], a[52:55], v[180:183], v[128:131]
 buffer_load_dwordx4 v13, s[8:11], s30 offen offset:3072 lds
 v_mfma_f32_16x16x32_bf16 v[132:135], a[56:59], v[180:183], v[132:135]
 s_add_u32 s30, s30, 128
 s_add_u32 m0, m0, 16384
 v_mfma_f32_16x16x32_bf16 v[136:139], a[48:51], v[184:187], v[136:139]
 ds_read_b128 v[216:219], v19 offset:12288
 v_mfma_f32_16x16x32_bf16 v[140:143], a[52:55], v[184:187], v[140:143]
 s_cmp_lt_u32 m0, s46
 s_cselect_b32 m0, m0, s47
 v_mfma_f32_16x16x32_bf16 v[144:147], a[56:59], v[184:187], v[144:147]
 v_permlane32_swap_b32 v56, v57
 v_mfma_f32_16x16x32_bf16 v[148:151], a[48:51], v[188:191], v[148:151]
 ds_read_b128 v[220:223], v19 offset:14336
 v_max_f32 v56, v56, v57
 v_mfma_f32_16x16x32_bf16 v[152:155], a[52:55], v[188:191], v[152:155]
 v_mov_b32 v57, v56
 v_mfma_f32_16x16x32_bf16 v[156:159], a[56:59], v[188:191], v[156:159]
 s_waitcnt vmcnt(16) lgkmcnt(4)
 s_barrier
 v_mfma_f32_16x16x32_bf16 v[64:67], a[60:63], v[192:195], v[64:67]
 ds_read_b128 v[160:163], v18 offset:0
 v_mfma_f32_16x16x32_bf16 v[68:71], a[64:67], v[192:195], v[68:71]
 s_nop 1
 v_mfma_f32_16x16x32_bf16 v[72:75], a[68:71], v[192:195], v[72:75]
 v_add_u32 v19, s33, v15
 s_add_u32 s33, s33, 16384
 v_mfma_f32_16x16x32_bf16 v[76:79], a[60:63], v[196:199], v[76:79]
 ds_read_b128 v[164:167], v18 offset:2048
 v_mfma_f32_16x16x32_bf16 v[80:83], a[64:67], v[196:199], v[80:83]
 buffer_load_dwordx4 v10, s[8:11], s30 offen offset:0 lds
 v_mfma_f32_16x16x32_bf16 v[84:87], a[68:71], v[196:199], v[84:87]
 s_cmp_lt_u32 s33, 98304
 s_cselect_b32 s33, s33, 0
 v_mfma_f32_16x16x32_bf16 v[88:91], a[60:63], v[200:203], v[88:91]
 ds_read_b128 v[168:171], v18 offset:4096
 v_mfma_f32_16x16x32_bf16 v[92:95], a[64:67], v[200:203], v[92:95]
 v_permlane16_swap_b32 v56, v57
 v_mfma_f32_16x16x32_bf16 v[96:99], a[68:71], v[200:203], v[96:99]
 v_max_f32 v56, v56, v57
 v_mul_f32 v56, s83, v56
 v_mfma_f32_16x16x32_bf16 v[100:103], a[60:63], v[204:207], v[100:103]
 ds_read_b128 v[172:175], v18 offset:6144
 v_fma_f32 v44, v44, s83, -v56
 v_mfma_f32_16x16x32_bf16 v[104:107], a[64:67], v[204:207], v[104:107]
 buffer_load_dwordx4 v[24:27], v31, s[52:55], s51 offen offset:2048 sc1
 v_mfma_f32_16x16x32_bf16 v[108:111], a[68:71], v[204:207], v[108:111]
 s_waitcnt lgkmcnt(4)
 v_fma_f32 v45, v45, s83, -v56
 v_mfma_f32_16x16x32_bf16 v[112:115], a[60:63], v[208:211], v[112:115]
 ds_read_b128 v[176:179], v18 offset:8192
 v_fma_f32 v46, v46, s83, -v56
 v_mfma_f32_16x16x32_bf16 v[116:119], a[64:67], v[208:211], v[116:119]
 v_fma_f32 v47, v47, s83, -v56
 v_fma_f32 v48, v48, s83, -v56
 v_mfma_f32_16x16x32_bf16 v[120:123], a[68:71], v[208:211], v[120:123]
 v_fma_f32 v49, v49, s83, -v56
 v_fma_f32 v50, v50, s83, -v56
 v_mfma_f32_16x16x32_bf16 v[124:127], a[60:63], v[212:215], v[124:127]
 ds_read_b128 v[180:183], v18 offset:10240
 v_fma_f32 v51, v51, s83, -v56
 v_mfma_f32_16x16x32_bf16 v[128:131], a[64:67], v[212:215], v[128:131]
 buffer_load_dwordx4 v11, s[8:11], s30 offen offset:1024 lds
 v_mfma_f32_16x16x32_bf16 v[132:135], a[68:71], v[212:215], v[132:135]
 v_fma_f32 v52, v52, s83, -v56
 v_fma_f32 v53, v53, s83, -v56
 v_mfma_f32_16x16x32_bf16 v[136:139], a[60:63], v[216:219], v[136:139]
 ds_read_b128 v[184:187], v18 offset:12288
 v_fma_f32 v54, v54, s83, -v56
 v_mfma_f32_16x16x32_bf16 v[140:143], a[64:67], v[216:219], v[140:143]
 v_fma_f32 v55, v55, s83, -v56
 v_mfma_f32_16x16x32_bf16 v[144:147], a[68:71], v[216:219], v[144:147]
 v_exp_f32 v44, v44
 v_mfma_f32_16x16x32_bf16 v[148:151], a[60:63], v[220:223], v[148:151]
 ds_read_b128 v[188:191], v18 offset:14336
 v_mfma_f32_16x16x32_bf16 v[152:155], a[64:67], v[220:223], v[152:155]
 v_exp_f32 v45, v45
 v_mfma_f32_16x16x32_bf16 v[156:159], a[68:71], v[220:223], v[156:159]
 s_waitcnt lgkmcnt(4)
 v_mfma_f32_16x16x32_bf16 v[64:67], a[72:75], v[160:163], v[64:67]
 ds_read_b128 v[192:195], v19 offset:0
 v_mfma_f32_16x16x32_bf16 v[68:71], a[76:79], v[160:163], v[68:71]
 v_add_u32 v18, s33, v14
 v_mfma_f32_16x16x32_bf16 v[72:75], a[80:83], v[160:163], v[72:75]
 v_exp_f32 v46, v46
 v_mfma_f32_16x16x32_bf16 v[76:79], a[72:75], v[164:167], v[76:79]
 ds_read_b128 v[196:199], v19 offset:2048
 v_mfma_f32_16x16x32_bf16 v[80:83], a[76:79], v[164:167], v[80:83]
 buffer_load_dwordx4 v12, s[8:11], s30 offen offset:2048 lds
 v_mfma_f32_16x16x32_bf16 v[84:87], a[80:83], v[164:167], v[84:87]
 v_exp_f32 v47, v47
 v_mfma_f32_16x16x32_bf16 v[88:91], a[72:75], v[168:171], v[88:91]
 ds_read_b128 v[200:203], v19 offset:4096
 v_mfma_f32_16x16x32_bf16 v[92:95], a[76:79], v[168:171], v[92:95]
 buffer_load_dwordx4 v[6:9], v31, s[52:55], s51 offen offset:2560 sc1
 v_mfma_f32_16x16x32_bf16 v[96:99], a[80:83], v[168:171], v[96:99]
 v_exp_f32 v48, v48
 v_mfma_f32_16x16x32_bf16 v[100:103], a[72:75], v[172:175], v[100:103]
 ds_read_b128 v[204:207], v19 offset:6144
 v_mfma_f32_16x16x32_bf16 v[104:107], a[76:79], v[172:175], v[104:107]
 v_exp_f32 v49, v49
 v_mfma_f32_16x16x32_bf16 v[108:111], a[80:83], v[172:175], v[108:111]
 s_waitcnt lgkmcnt(4)
 v_mfma_f32_16x16x32_bf16 v[112:115], a[72:75], v[176:179], v[112:115]
 ds_read_b128 v[208:211], v19 offset:8192
 v_mfma_f32_16x16x32_bf16 v[116:119], a[76:79], v[176:179], v[116:119]
 v_exp_f32 v50, v50
 v_mfma_f32_16x16x32_bf16 v[120:123], a[80:83], v[176:179], v[120:123]
 v_exp_f32 v51, v51
 v_mfma_f32_16x16x32_bf16 v[124:127], a[72:75], v[180:183], v[124:127]
 ds_read_b128 v[212:215], v19 offset:10240
 v_mfma_f32_16x16x32_bf16 v[128:131], a[76:79], v[180:183], v[128:131]
 buffer_load_dwordx4 v13, s[8:11], s30 offen offset:3072 lds
 v_mfma_f32_16x16x32_bf16 v[132:135], a[80:83], v[180:183], v[132:135]
 s_add_u32 s30, s30, 128
 s_add_u32 m0, m0, 16384
 v_mfma_f32_16x16x32_bf16 v[136:139], a[72:75], v[184:187], v[136:139]
 ds_read_b128 v[216:219], v19 offset:12288
 v_mfma_f32_16x16x32_bf16 v[140:143], a[76:79], v[184:187], v[140:143]
 s_cmp_lt_u32 m0, s46
 s_cselect_b32 m0, m0, s47
 v_mfma_f32_16x16x32_bf16 v[144:147], a[80:83], v[184:187], v[144:147]
 v_exp_f32 v52, v52
 v_mfma_f32_16x16x32_bf16 v[148:151], a[72:75], v[188:191], v[148:151]
 ds_read_b128 v[220:223], v19 offset:14336
 v_mfma_f32_16x16x32_bf16 v[152:155], a[76:79], v[188:191], v[152:155]
 v_exp_f32 v53, v53
 v_mfma_f32_16x16x32_bf16 v[156:159], a[80:83], v[188:191], v[156:159]
 s_waitcnt vmcnt(18) lgkmcnt(4)
 s_barrier
 v_mfma_f32_16x16x32_bf16 v[64:67], a[84:87], v[192:195], v[64:67]
 ds_read_b128 v[160:163], v18 offset:0
 v_mfma_f32_16x16x32_bf16 v[68:71], a[88:91], v[192:195], v[68:71]
 v_exp_f32 v54, v54
 v_mfma_f32_16x16x32_bf16 v[72:75], a[92:95], v[192:195], v[72:75]
 v_add_u32 v19, s33, v15
 s_add_u32 s33, s33, 16384
 v_mfma_f32_16x16x32_bf16 v[76:79], a[84:87], v[196:199], v[76:79]
 ds_read_b128 v[164:167], v18 offset:2048
 s_add_u32 s21, s50, 4096
 v_mfma_f32_16x16x32_bf16 v[80:83], a[88:91], v[196:199], v[80:83]
 buffer_load_dwordx4 v10, s[8:11], s30 offen offset:0 lds
 v_mfma_f32_16x16x32_bf16 v[84:87], a[92:95], v[196:199], v[84:87]
 s_cmp_lt_u32 s33, 98304
 s_cselect_b32 s33, s33, 0
 v_mfma_f32_16x16x32_bf16 v[88:91], a[84:87], v[200:203], v[88:91]
 ds_read_b128 v[168:171], v18 offset:4096
 v_mfma_f32_16x16x32_bf16 v[92:95], a[88:91], v[200:203], v[92:95]
 buffer_load_dwordx4 v[60:63], v30, s[16:19], s21 offen offset:2048 sc1
 v_mfma_f32_16x16x32_bf16 v[96:99], a[92:95], v[200:203], v[96:99]
 v_exp_f32 v55, v55
 v_mfma_f32_16x16x32_bf16 v[100:103], a[84:87], v[204:207], v[100:103]
 ds_read_b128 v[172:175], v18 offset:6144
 s_nop 0
 v_mfma_f32_16x16x32_bf16 v[104:107], a[88:91], v[204:207], v[104:107]
 v_add_f32 v56, v52, v53
 v_add_f32 v56, v56, v54
 v_mfma_f32_16x16x32_bf16 v[108:111], a[92:95], v[204:207], v[108:111]
 s_waitcnt lgkmcnt(4)
 v_add_f32 v56, v56, v55
 v_mfma_f32_16x16x32_bf16 v[112:115], a[84:87], v[208:211], v[112:115]
 ds_read_b128 v[176:179], v18 offset:8192
 v_cndmask_b32 v56, 0, v56, s[60:61]
 v_mfma_f32_16x16x32_bf16 v[116:119], a[88:91], v[208:211], v[116:119]
 v_add_f32 v56, v56, v44
 v_add_f32 v56, v56, v45
 v_mfma_f32_16x16x32_bf16 v[120:123], a[92:95], v[208:211], v[120:123]
 v_add_f32 v56, v56, v46
 v_add_f32 v56, v56, v47
 v_mfma_f32_16x16x32_bf16 v[124:127], a[84:87], v[212:215], v[124:127]
 ds_read_b128 v[180:183], v18 offset:10240
 v_add_f32 v56, v56, v48
 v_mfma_f32_16x16x32_bf16 v[128:131], a[88:91], v[212:215], v[128:131]
 buffer_load_dwordx4 v11, s[8:11], s30 offen offset:1024 lds
 v_mfma_f32_16x16x32_bf16 v[132:135], a[92:95], v[212:215], v[132:135]
 v_add_f32 v56, v56, v49
 v_add_f32 v56, v56, v50
 v_mfma_f32_16x16x32_bf16 v[136:139], a[84:87], v[216:219], v[136:139]
 ds_read_b128 v[184:187], v18 offset:12288
 v_add_f32 v56, v56, v51
 v_mfma_f32_16x16x32_bf16 v[140:143], a[88:91], v[216:219], v[140:143]
 v_mov_b32 v57, v56
 v_mfma_f32_16x16x32_bf16 v[144:147], a[92:95], v[216:219], v[144:147]
 s_nop 1
 v_mfma_f32_16x16x32_bf16 v[148:151], a[84:87], v[220:223], v[148:151]
 ds_read_b128 v[188:191], v18 offset:14336
 v_mfma_f32_16x16x32_bf16 v[152:155], a[88:91], v[220:223], v[152:155]
 v_permlane32_swap_b32 v56, v57
 v_mfma_f32_16x16x32_bf16 v[156:159], a[92:95], v[220:223], v[156:159]
 s_waitcnt lgkmcnt(4)
 v_add_f32 v56, v56, v57
 v_mfma_f32_16x16x32_bf16 v[64:67], a[96:99], v[160:163], v[64:67]
 ds_read_b128 v[192:195], v19 offset:0
 v_mov_b32 v57, v56
 v_mfma_f32_16x16x32_bf16 v[68:71], a[100:103], v[160:163], v[68:71]
 v_add_u32 v18, s33, v14
 v_mfma_f32_16x16x32_bf16 v[72:75], a[104:107], v[160:163], v[72:75]
 s_nop 1
 v_mfma_f32_16x16x32_bf16 v[76:79], a[96:99], v[164:167], v[76:79]
 ds_read_b128 v[196:199], v19 offset:2048
 s_add_u32 s21, s50, 8192
 v_mfma_f32_16x16x32_bf16 v[80:83], a[100:103], v[164:167], v[80:83]
 buffer_load_dwordx4 v12, s[8:11], s30 offen offset:2048 lds
 v_mfma_f32_16x16x32_bf16 v[84:87], a[104:107], v[164:167], v[84:87]
 buffer_load_dwordx4 v[248:251], v30, s[16:19], s21 offen offset:2048 sc1
 v_mfma_f32_16x16x32_bf16 v[88:91], a[96:99], v[168:171], v[88:91]
 ds_read_b128 v[200:203], v19 offset:4096
 v_mfma_f32_16x16x32_bf16 v[92:95], a[100:103], v[168:171], v[92:95]
 v_permlane16_swap_b32 v56, v57
 v_mfma_f32_16x16x32_bf16 v[96:99], a[104:107], v[168:171], v[96:99]
 v_add_f32 v56, v56, v57
 v_mfma_f32_16x16x32_bf16 v[100:103], a[96:99], v[172:175], v[100:103]
 ds_read_b128 v[204:207], v19 offset:6144
 v_mfma_f32_16x16x32_bf16 v[104:107], a[100:103], v[172:175], v[104:107]
 v_rcp_f32 v56, v56
 v_mfma_f32_16x16x32_bf16 v[108:111], a[104:107], v[172:175], v[108:111]
 s_waitcnt lgkmcnt(4)
 s_nop 0
 v_mfma_f32_16x16x32_bf16 v[112:115], a[96:99], v[176:179], v[112:115]
 ds_read_b128 v[208:211], v19 offset:8192
 v_mul_f32 v44, v44, v56
 v_mfma_f32_16x16x32_bf16 v[116:119], a[100:103], v[176:179], v[116:119]
 v_mul_f32 v45, v45, v56
 v_mul_f32 v46, v46, v56
 v_mfma_f32_16x16x32_bf16 v[120:123], a[104:107], v[176:179], v[120:123]
 v_mul_f32 v47, v47, v56
 v_mul_f32 v48, v48, v56
 v_mfma_f32_16x16x32_bf16 v[124:127], a[96:99], v[180:183], v[124:127]
 ds_read_b128 v[212:215], v19 offset:10240
 v_mul_f32 v49, v49, v56
 v_mfma_f32_16x16x32_bf16 v[128:131], a[100:103], v[180:183], v[128:131]
 buffer_load_dwordx4 v13, s[8:11], s30 offen offset:3072 lds
 v_mfma_f32_16x16x32_bf16 v[132:135], a[104:107], v[180:183], v[132:135]
 s_add_u32 s30, s30, 128
 s_add_u32 m0, m0, 16384
 v_mfma_f32_16x16x32_bf16 v[136:139], a[96:99], v[184:187], v[136:139]
 ds_read_b128 v[216:219], v19 offset:12288
 v_mul_f32 v50, v50, v56
 v_mfma_f32_16x16x32_bf16 v[140:143], a[100:103], v[184:187], v[140:143]
 s_cmp_lt_u32 m0, s46
 s_cselect_b32 m0, m0, s47
 v_mfma_f32_16x16x32_bf16 v[144:147], a[104:107], v[184:187], v[144:147]
 v_mul_f32 v51, v51, v56
 v_mul_f32 v52, v52, v56
 v_mfma_f32_16x16x32_bf16 v[148:151], a[96:99], v[188:191], v[148:151]
 ds_read_b128 v[220:223], v19 offset:14336
 v_mul_f32 v53, v53, v56
 v_mfma_f32_16x16x32_bf16 v[152:155], a[100:103], v[188:191], v[152:155]
 v_mul_f32 v54, v54, v56
 v_mul_f32 v55, v55, v56
 v_mfma_f32_16x16x32_bf16 v[156:159], a[104:107], v[188:191], v[156:159]
 s_waitcnt vmcnt(19) lgkmcnt(4)
 s_barrier
 v_mfma_f32_16x16x32_bf16 v[64:67], a[108:111], v[192:195], v[64:67]
 ds_read_b128 v[160:163], v18 offset:0
 v_cvt_pk_bf16_f32 v240, v40, v41
 v_mfma_f32_16x16x32_bf16 v[68:71], a[112:115], v[192:195], v[68:71]
 s_add_u32 s21, s50, 8192
 v_cvt_pk_bf16_f32 v241, v42, v43
 v_mfma_f32_16x16x32_bf16 v[72:75], a[116:119], v[192:195], v[72:75]
 v_add_u32 v19, s33, v15
 s_add_u32 s33, s33, 16384
 v_mfma_f32_16x16x32_bf16 v[76:79], a[108:111], v[196:199], v[76:79]
 ds_read_b128 v[164:167], v18 offset:2048
 v_cvt_pk_bf16_f32 v242, v52, v53
 v_mfma_f32_16x16x32_bf16 v[80:83], a[112:115], v[196:199], v[80:83]
 buffer_load_dwordx4 v10, s[8:11], s30 offen offset:0 lds
 v_mfma_f32_16x16x32_bf16 v[84:87], a[116:119], v[196:199], v[84:87]
 s_cmp_lt_u32 s33, 98304
 s_cselect_b32 s33, s33, 0
 v_mfma_f32_16x16x32_bf16 v[88:91], a[108:111], v[200:203], v[88:91]
 ds_read_b128 v[168:171], v18 offset:4096
 v_cvt_pk_bf16_f32 v243, v54, v55
 v_mfma_f32_16x16x32_bf16 v[92:95], a[112:115], v[200:203], v[92:95]
 buffer_load_dwordx4 v[252:255], v30, s[16:19], s21 offen offset:3072 sc1
 v_mfma_f32_16x16x32_bf16 v[96:99], a[116:119], v[200:203], v[96:99]
 v_cvt_pk_bf16_f32 v236, v44, v45
 v_cvt_pk_bf16_f32 v237, v46, v47
 v_mfma_f32_16x16x32_bf16 v[100:103], a[108:111], v[204:207], v[100:103]
 ds_read_b128 v[172:175], v18 offset:6144
 v_cvt_pk_bf16_f32 v238, v48, v49
 v_mfma_f32_16x16x32_bf16 v[104:107], a[112:115], v[204:207], v[104:107]
 v_cvt_pk_bf16_f32 v239, v50, v51
 v_cvt_pk_bf16_f32 v244, v36, v37
 v_mfma_f32_16x16x32_bf16 v[108:111], a[116:119], v[204:207], v[108:111]
 s_waitcnt lgkmcnt(4)
 v_cvt_pk_bf16_f32 v245, v38, v39
 v_mfma_f32_16x16x32_bf16 v[112:115], a[108:111], v[208:211], v[112:115]
 ds_read_b128 v[176:179], v18 offset:8192
 v_mfma_f32_16x16x32_bf16 v[116:119], a[112:115], v[208:211], v[116:119]
 v_permlane16_swap_b32 v240, v242
 v_mfma_f32_16x16x32_bf16 v[120:123], a[116:119], v[208:211], v[120:123]
 v_permlane16_swap_b32 v241, v243
 v_mfma_f32_16x16x32_bf16 v[124:127], a[108:111], v[212:215], v[124:127]
 ds_read_b128 v[180:183], v18 offset:10240
 v_mfma_f32_16x16x32_bf16 v[128:131], a[112:115], v[212:215], v[128:131]
 buffer_load_dwordx4 v11, s[8:11], s30 offen offset:1024 lds
 v_mfma_f32_16x16x32_bf16 v[132:135], a[116:119], v[212:215], v[132:135]
 v_mfma_f32_16x16x32_bf16 v[136:139], a[108:111], v[216:219], v[136:139]
 ds_read_b128 v[184:187], v18 offset:12288
 v_mfma_f32_16x16x32_bf16 v[140:143], a[112:115], v[216:219], v[140:143]
 v_mfma_f32_16x16x32_bf16 v[144:147], a[116:119], v[216:219], v[144:147]
 v_mfma_f32_16x16x32_bf16 v[148:151], a[108:111], v[220:223], v[148:151]
 ds_read_b128 v[188:191], v18 offset:14336
 v_mfma_f32_16x16x32_bf16 v[152:155], a[112:115], v[220:223], v[152:155]
 v_mfma_f32_16x16x32_bf16 v[156:159], a[116:119], v[220:223], v[156:159]
 s_waitcnt lgkmcnt(4)
 v_mfma_f32_16x16x32_bf16 v[64:67], a[120:123], v[160:163], v[64:67]
 ds_read_b128 v[192:195], v19 offset:0
 v_mfma_f32_16x16x32_bf16 v[68:71], a[124:127], v[160:163], v[68:71]
 v_add_u32 v18, s33, v14
 v_mfma_f32_16x16x32_bf16 v[72:75], a[128:131], v[160:163], v[72:75]
 v_mfma_f32_16x16x32_bf16 v[76:79], a[120:123], v[164:167], v[76:79]
 ds_read_b128 v[196:199], v19 offset:2048
 v_mfma_f32_16x16x32_bf16 v[80:83], a[124:127], v[164:167], v[80:83]
 buffer_load_dwordx4 v12, s[8:11], s30 offen offset:2048 lds
 v_mfma_f32_16x16x32_bf16 v[84:87], a[128:131], v[164:167], v[84:87]
 v_mfma_f32_16x16x32_bf16 v[88:91], a[120:123], v[168:171], v[88:91]
 ds_read_b128 v[200:203], v19 offset:4096
 v_mfma_f32_16x16x32_bf16 v[92:95], a[124:127], v[168:171], v[92:95]
 v_mfma_f32_16x16x32_bf16 v[96:99], a[128:131], v[168:171], v[96:99]
 v_mfma_f32_16x16x32_bf16 v[100:103], a[120:123], v[172:175], v[100:103]
 ds_read_b128 v[204:207], v19 offset:6144
 v_mfma_f32_16x16x32_bf16 v[104:107], a[124:127], v[172:175], v[104:107]
 v_mfma_f32_16x16x32_bf16 v[108:111], a[128:131], v[172:175], v[108:111]
 s_waitcnt lgkmcnt(4)
 v_mfma_f32_16x16x32_bf16 v[112:115], a[120:123], v[176:179], v[112:115]
 ds_read_b128 v[208:211], v19 offset:8192
 v_mfma_f32_16x16x32_bf16 v[116:119], a[124:127], v[176:179], v[116:119]
 v_mfma_f32_16x16x32_bf16 v[120:123], a[128:131], v[176:179], v[120:123]
 v_mfma_f32_16x16x32_bf16 v[124:127], a[120:123], v[180:183], v[124:127]
 ds_read_b128 v[212:215], v19 offset:10240
 v_mfma_f32_16x16x32_bf16 v[128:131], a[124:127], v[180:183], v[128:131]
 buffer_load_dwordx4 v13, s[8:11], s30 offen offset:3072 lds
 v_mfma_f32_16x16x32_bf16 v[132:135], a[128:131], v[180:183], v[132:135]
 s_add_u32 s30, s30, s25
 s_sub_u32 s30, s30, 1152
 v_mfma_f32_16x16x32_bf16 v[136:139], a[120:123], v[184:187], v[136:139]
 ds_read_b128 v[216:219], v19 offset:12288
 s_mov_b32 s25, 163840
 v_mfma_f32_16x16x32_bf16 v[140:143], a[124:127], v[184:187], v[140:143]
 s_add_u32 m0, m0, 16384
 v_mfma_f32_16x16x32_bf16 v[144:147], a[128:131], v[184:187], v[144:147]
 s_cmp_lt_u32 m0, s46
 s_cselect_b32 m0, m0, s47
 v_mfma_f32_16x16x32_bf16 v[148:151], a[120:123], v[188:191], v[148:151]
 ds_read_b128 v[220:223], v19 offset:14336
 v_mfma_f32_16x16x32_bf16 v[152:155], a[124:127], v[188:191], v[152:155]
 v_mfma_f32_16x16x32_bf16 v[156:159], a[128:131], v[188:191], v[156:159]
 s_waitcnt vmcnt(17) lgkmcnt(4)
 s_barrier
 v_mfma_f32_16x16x32_bf16 v[64:67], a[132:135], v[192:195], v[64:67]
 ds_read_b128 v[160:163], v18 offset:0
 v_mfma_f32_16x16x32_bf16 v[68:71], a[136:139], v[192:195], v[68:71]
 v_mfma_f32_16x16x32_bf16 v[72:75], a[140:143], v[192:195], v[72:75]
 v_add_u32 v19, s33, v15
 s_add_u32 s33, s33, 16384
 v_mfma_f32_16x16x32_bf16 v[76:79], a[132:135], v[196:199], v[76:79]
 ds_read_b128 v[164:167], v18 offset:2048
 v_mfma_f32_16x16x32_bf16 v[80:83], a[136:139], v[196:199], v[80:83]
 buffer_load_dwordx4 v10, s[8:11], s30 offen offset:0 lds
 v_mfma_f32_16x16x32_bf16 v[84:87], a[140:143], v[196:199], v[84:87]
 s_cmp_lt_u32 s33, 98304
 s_cselect_b32 s33, s33, 0
 v_mfma_f32_16x16x32_bf16 v[88:91], a[132:135], v[200:203], v[88:91]
 ds_read_b128 v[168:171], v18 offset:4096
 v_mfma_f32_16x16x32_bf16 v[92:95], a[136:139], v[200:203], v[92:95]
 buffer_store_dwordx4 v[236:239], v30, s[56:59], s81 offen sc1
 v_mfma_f32_16x16x32_bf16 v[96:99], a[140:143], v[200:203], v[96:99]
 v_mfma_f32_16x16x32_bf16 v[100:103], a[132:135], v[204:207], v[100:103]
 ds_read_b128 v[172:175], v18 offset:6144
 v_mfma_f32_16x16x32_bf16 v[104:107], a[136:139], v[204:207], v[104:107]
 v_mfma_f32_16x16x32_bf16 v[108:111], a[140:143], v[204:207], v[108:111]
 s_waitcnt lgkmcnt(4)
 v_mfma_f32_16x16x32_bf16 v[112:115], a[132:135], v[208:211], v[112:115]
 ds_read_b128 v[176:179], v18 offset:8192
 v_mfma_f32_16x16x32_bf16 v[116:119], a[136:139], v[208:211], v[116:119]
 s_mov_b64 exec, 0xffffffff
 buffer_store_dwordx4 v[240:243], v30, s[56:59], s81 offen offset:1024 sc1
 s_mov_b64 exec, -1
 v_mfma_f32_16x16x32_bf16 v[120:123], a[140:143], v[208:211], v[120:123]
 v_mfma_f32_16x16x32_bf16 v[124:127], a[132:135], v[212:215], v[124:127]
 ds_read_b128 v[180:183], v18 offset:10240
 v_mfma_f32_16x16x32_bf16 v[128:131], a[136:139], v[212:215], v[128:131]
 buffer_load_dwordx4 v11, s[8:11], s30 offen offset:1024 lds
 v_mfma_f32_16x16x32_bf16 v[132:135], a[140:143], v[212:215], v[132:135]
 v_mfma_f32_16x16x32_bf16 v[136:139], a[132:135], v[216:219], v[136:139]
 ds_read_b128 v[184:187], v18 offset:12288
 v_mfma_f32_16x16x32_bf16 v[140:143], a[136:139], v[216:219], v[140:143]
 buffer_store_dwordx2 v[244:245], v32, s[56:59], s81 offen offset:1536 sc1
 v_mfma_f32_16x16x32_bf16 v[144:147], a[140:143], v[216:219], v[144:147]
 s_mov_b32 s78, s82
 s_mov_b32 s82, 0
 v_mfma_f32_16x16x32_bf16 v[148:151], a[132:135], v[220:223], v[148:151]
 ds_read_b128 v[188:191], v18 offset:14336
 s_mov_b32 s81, 0x80000000
 v_mfma_f32_16x16x32_bf16 v[152:155], a[136:139], v[220:223], v[152:155]
 v_mfma_f32_16x16x32_bf16 v[156:159], a[140:143], v[220:223], v[156:159]
 s_waitcnt lgkmcnt(4)
 s_add_u32 s21, s50, 0
 v_mfma_f32_16x16x32_bf16 v[64:67], a[144:147], v[160:163], v[64:67]
 ds_read_b128 v[192:195], v19 offset:0
 v_mfma_f32_16x16x32_bf16 v[68:71], a[148:151], v[160:163], v[68:71]
 v_add_u32 v18, s33, v14
 v_mfma_f32_16x16x32_bf16 v[72:75], a[152:155], v[160:163], v[72:75]
 buffer_load_dwordx4 v[36:39], v30, s[16:19], s21 offen offset:0 sc1
 v_mfma_f32_16x16x32_bf16 v[76:79], a[144:147], v[164:167], v[76:79]
 ds_read_b128 v[196:199], v19 offset:2048
 v_mfma_f32_16x16x32_bf16 v[80:83], a[148:151], v[164:167], v[80:83]
 buffer_load_dwordx4 v12, s[8:11], s30 offen offset:2048 lds
 v_mfma_f32_16x16x32_bf16 v[84:87], a[152:155], v[164:167], v[84:87]
 v_mfma_f32_16x16x32_bf16 v[88:91], a[144:147], v[168:171], v[88:91]
 ds_read_b128 v[200:203], v19 offset:4096
 v_mfma_f32_16x16x32_bf16 v[92:95], a[148:151], v[168:171], v[92:95]
 v_mfma_f32_16x16x32_bf16 v[96:99], a[152:155], v[168:171], v[96:99]
 v_mfma_f32_16x16x32_bf16 v[100:103], a[144:147], v[172:175], v[100:103]
 ds_read_b128 v[204:207], v19 offset:6144
 v_mfma_f32_16x16x32_bf16 v[104:107], a[148:151], v[172:175], v[104:107]
 v_mfma_f32_16x16x32_bf16 v[108:111], a[152:155], v[172:175], v[108:111]
 s_waitcnt lgkmcnt(4)
 v_mfma_f32_16x16x32_bf16 v[112:115], a[144:147], v[176:179], v[112:115]
 ds_read_b128 v[208:211], v19 offset:8192
 s_add_u32 s21, s50, 0
 v_mfma_f32_16x16x32_bf16 v[116:119], a[148:151], v[176:179], v[116:119]
 buffer_load_dwordx4 v[40:43], v30, s[16:19], s21 offen offset:1024 sc1
 v_mfma_f32_16x16x32_bf16 v[120:123], a[152:155], v[176:179], v[120:123]
 v_mfma_f32_16x16x32_bf16 v[124:127], a[144:147], v[180:183], v[124:127]
 ds_read_b128 v[212:215], v19 offset:10240
 v_mfma_f32_16x16x32_bf16 v[128:131], a[148:151], v[180:183], v[128:131]
 buffer_load_dwordx4 v13, s[8:11], s30 offen offset:3072 lds
 v_mfma_f32_16x16x32_bf16 v[132:135], a[152:155], v[180:183], v[132:135]
 s_add_u32 s30, s30, 128
 s_add_u32 m0, m0, 16384
 v_mfma_f32_16x16x32_bf16 v[136:139], a[144:147], v[184:187], v[136:139]
 ds_read_b128 v[216:219], v19 offset:12288
 v_mfma_f32_16x16x32_bf16 v[140:143], a[148:151], v[184:187], v[140:143]
 s_cmp_lt_u32 m0, s46
 s_cselect_b32 m0, m0, s47
 v_mfma_f32_16x16x32_bf16 v[144:147], a[152:155], v[184:187], v[144:147]
 v_mfma_f32_16x16x32_bf16 v[148:151], a[144:147], v[188:191], v[148:151]
 ds_read_b128 v[220:223], v19 offset:14336
 v_mfma_f32_16x16x32_bf16 v[152:155], a[148:151], v[188:191], v[152:155]
 v_mfma_f32_16x16x32_bf16 v[156:159], a[152:155], v[188:191], v[156:159]
 s_waitcnt vmcnt(20) lgkmcnt(4)
 s_barrier
 v_mfma_f32_16x16x32_bf16 v[64:67], a[156:159], v[192:195], v[64:67]
 ds_read_b128 v[160:163], v18 offset:0
 s_add_u32 s21, s50, 0
 v_mfma_f32_16x16x32_bf16 v[68:71], a[160:163], v[192:195], v[68:71]
 buffer_load_dwordx4 v[44:47], v30, s[16:19], s21 offen offset:2048 sc1
 v_mfma_f32_16x16x32_bf16 v[72:75], a[164:167], v[192:195], v[72:75]
 v_add_u32 v19, s33, v15
 s_add_u32 s33, s33, 16384
 v_mfma_f32_16x16x32_bf16 v[76:79], a[156:159], v[196:199], v[76:79]
 ds_read_b128 v[164:167], v18 offset:2048
 v_mfma_f32_16x16x32_bf16 v[80:83], a[160:163], v[196:199], v[80:83]
 buffer_load_dwordx4 v10, s[8:11], s30 offen offset:0 lds
 v_mfma_f32_16x16x32_bf16 v[84:87], a[164:167], v[196:199], v[84:87]
 s_cmp_lt_u32 s33, 98304
 s_cselect_b32 s33, s33, 0
 v_mfma_f32_16x16x32_bf16 v[88:91], a[156:159], v[200:203], v[88:91]
 ds_read_b128 v[168:171], v18 offset:4096
 v_mfma_f32_16x16x32_bf16 v[92:95], a[160:163], v[200:203], v[92:95]
 v_mfma_f32_16x16x32_bf16 v[96:99], a[164:167], v[200:203], v[96:99]
 v_mfma_f32_16x16x32_bf16 v[100:103], a[156:159], v[204:207], v[100:103]
 ds_read_b128 v[172:175], v18 offset:6144
 v_mfma_f32_16x16x32_bf16 v[104:107], a[160:163], v[204:207], v[104:107]
 v_mfma_f32_16x16x32_bf16 v[108:111], a[164:167], v[204:207], v[108:111]
 s_waitcnt lgkmcnt(4)
 s_add_u32 s21, s50, 0
 v_mfma_f32_16x16x32_bf16 v[112:115], a[156:159], v[208:211], v[112:115]
 ds_read_b128 v[176:179], v18 offset:8192
 v_mfma_f32_16x16x32_bf16 v[116:119], a[160:163], v[208:211], v[116:119]
 buffer_load_dwordx4 v[48:51], v30, s[16:19], s21 offen offset:3072 sc1
 v_mfma_f32_16x16x32_bf16 v[120:123], a[164:167], v[208:211], v[120:123]
 v_mfma_f32_16x16x32_bf16 v[124:127], a[156:159], v[212:215], v[124:127]
 ds_read_b128 v[180:183], v18 offset:10240
 v_mfma_f32_16x16x32_bf16 v[128:131], a[160:163], v[212:215], v[128:131]
 buffer_load_dwordx4 v11, s[8:11], s30 offen offset:1024 lds
 v_mfma_f32_16x16x32_bf16 v[132:135], a[164:167], v[212:215], v[132:135]
 v_mfma_f32_16x16x32_bf16 v[136:139], a[156:159], v[216:219], v[136:139]
 ds_read_b128 v[184:187], v18 offset:12288
 v_mfma_f32_16x16x32_bf16 v[140:143], a[160:163], v[216:219], v[140:143]
 v_mfma_f32_16x16x32_bf16 v[144:147], a[164:167], v[216:219], v[144:147]
 v_mfma_f32_16x16x32_bf16 v[148:151], a[156:159], v[220:223], v[148:151]
 ds_read_b128 v[188:191], v18 offset:14336
 v_mfma_f32_16x16x32_bf16 v[152:155], a[160:163], v[220:223], v[152:155]
 v_mfma_f32_16x16x32_bf16 v[156:159], a[164:167], v[220:223], v[156:159]
 s_waitcnt lgkmcnt(4)
 s_add_u32 s21, s50, 4096
 v_mfma_f32_16x16x32_bf16 v[64:67], a[168:171], v[160:163], v[64:67]
 ds_read_b128 v[192:195], v19 offset:0
 v_mfma_f32_16x16x32_bf16 v[68:71], a[172:175], v[160:163], v[68:71]
 v_add_u32 v18, s33, v14
 v_mfma_f32_16x16x32_bf16 v[72:75], a[176:179], v[160:163], v[72:75]
 buffer_load_dwordx4 v[52:55], v30, s[16:19], s21 offen offset:0 sc1
 v_mfma_f32_16x16x32_bf16 v[76:79], a[168:171], v[164:167], v[76:79]
 ds_read_b128 v[196:199], v19 offset:2048
 v_mfma_f32_16x16x32_bf16 v[80:83], a[172:175], v[164:167], v[80:83]
 buffer_load_dwordx4 v12, s[8:11], s30 offen offset:2048 lds
 v_mfma_f32_16x16x32_bf16 v[84:87], a[176:179], v[164:167], v[84:87]
 v_mfma_f32_16x16x32_bf16 v[88:91], a[168:171], v[168:171], v[88:91]
 ds_read_b128 v[200:203], v19 offset:4096
 v_mfma_f32_16x16x32_bf16 v[92:95], a[172:175], v[168:171], v[92:95]
 v_mfma_f32_16x16x32_bf16 v[96:99], a[176:179], v[168:171], v[96:99]
 v_mfma_f32_16x16x32_bf16 v[100:103], a[168:171], v[172:175], v[100:103]
 ds_read_b128 v[204:207], v19 offset:6144
 v_mfma_f32_16x16x32_bf16 v[104:107], a[172:175], v[172:175], v[104:107]
 v_mfma_f32_16x16x32_bf16 v[108:111], a[176:179], v[172:175], v[108:111]
 s_waitcnt lgkmcnt(4)
 v_mfma_f32_16x16x32_bf16 v[112:115], a[168:171], v[176:179], v[112:115]
 ds_read_b128 v[208:211], v19 offset:8192
 s_add_u32 s21, s50, 4096
 v_mfma_f32_16x16x32_bf16 v[116:119], a[172:175], v[176:179], v[116:119]
 buffer_load_dwordx4 v[56:59], v30, s[16:19], s21 offen offset:1024 sc1
 v_mfma_f32_16x16x32_bf16 v[120:123], a[176:179], v[176:179], v[120:123]
 v_mfma_f32_16x16x32_bf16 v[124:127], a[168:171], v[180:183], v[124:127]
 ds_read_b128 v[212:215], v19 offset:10240
 v_mfma_f32_16x16x32_bf16 v[128:131], a[172:175], v[180:183], v[128:131]
 buffer_load_dwordx4 v13, s[8:11], s30 offen offset:3072 lds
 v_mfma_f32_16x16x32_bf16 v[132:135], a[176:179], v[180:183], v[132:135]
 s_add_u32 s30, s30, 128
 s_add_u32 m0, m0, 16384
 v_mfma_f32_16x16x32_bf16 v[136:139], a[168:171], v[184:187], v[136:139]
 ds_read_b128 v[216:219], v19 offset:12288
 v_mfma_f32_16x16x32_bf16 v[140:143], a[172:175], v[184:187], v[140:143]
 s_cmp_lt_u32 m0, s46
 s_cselect_b32 m0, m0, s47
 v_mfma_f32_16x16x32_bf16 v[144:147], a[176:179], v[184:187], v[144:147]
 v_mfma_f32_16x16x32_bf16 v[148:151], a[168:171], v[188:191], v[148:151]
 ds_read_b128 v[220:223], v19 offset:14336
 v_mfma_f32_16x16x32_bf16 v[152:155], a[172:175], v[188:191], v[152:155]
 v_mfma_f32_16x16x32_bf16 v[156:159], a[176:179], v[188:191], v[156:159]
 s_waitcnt vmcnt(22) lgkmcnt(4)
 s_barrier
 v_mfma_f32_16x16x32_bf16 v[64:67], a[180:183], v[192:195], v[64:67]
 ds_read_b128 v[160:163], v18 offset:0
 s_add_u32 s21, s50, 4096
 v_mfma_f32_16x16x32_bf16 v[68:71], a[184:187], v[192:195], v[68:71]
 buffer_load_dwordx4 v[236:239], v30, s[16:19], s21 offen offset:3072 sc1
 v_mfma_f32_16x16x32_bf16 v[72:75], a[188:191], v[192:195], v[72:75]
 v_add_u32 v19, s33, v15
 s_add_u32 s33, s33, 16384
 v_mfma_f32_16x16x32_bf16 v[76:79], a[180:183], v[196:199], v[76:79]
 ds_read_b128 v[164:167], v18 offset:2048
 v_mfma_f32_16x16x32_bf16 v[80:83], a[184:187], v[196:199], v[80:83]
 buffer_load_dwordx4 v10, s[8:11], s30 offen offset:0 lds
 v_mfma_f32_16x16x32_bf16 v[84:87], a[188:191], v[196:199], v[84:87]
 s_cmp_lt_u32 s33, 98304
 s_cselect_b32 s33, s33, 0
 v_mfma_f32_16x16x32_bf16 v[88:91], a[180:183], v[200:203], v[88:91]
 ds_read_b128 v[168:171], v18 offset:4096
 v_mfma_f32_16x16x32_bf16 v[92:95], a[184:187], v[200:203], v[92:95]
 v_mfma_f32_16x16x32_bf16 v[96:99], a[188:191], v[200:203], v[96:99]
 v_mfma_f32_16x16x32_bf16 v[100:103], a[180:183], v[204:207], v[100:103]
 ds_read_b128 v[172:175], v18 offset:6144
 v_mfma_f32_16x16x32_bf16 v[104:107], a[184:187], v[204:207], v[104:107]
 v_mfma_f32_16x16x32_bf16 v[108:111], a[188:191], v[204:207], v[108:111]
 s_waitcnt lgkmcnt(4)
 s_add_u32 s21, s50, 8192
 v_mfma_f32_16x16x32_bf16 v[112:115], a[180:183], v[208:211], v[112:115]
 ds_read_b128 v[176:179], v18 offset:8192
 v_mfma_f32_16x16x32_bf16 v[116:119], a[184:187], v[208:211], v[116:119]
 buffer_load_dwordx4 v[240:243], v30, s[16:19], s21 offen offset:0 sc1
 v_mfma_f32_16x16x32_bf16 v[120:123], a[188:191], v[208:211], v[120:123]
 v_mfma_f32_16x16x32_bf16 v[124:127], a[180:183], v[212:215], v[124:127]
 ds_read_b128 v[180:183], v18 offset:10240
 v_mfma_f32_16x16x32_bf16 v[128:131], a[184:187], v[212:215], v[128:131]
 buffer_load_dwordx4 v11, s[8:11], s30 offen offset:1024 lds
 v_mfma_f32_16x16x32_bf16 v[132:135], a[188:191], v[212:215], v[132:135]
 v_mfma_f32_16x16x32_bf16 v[136:139], a[180:183], v[216:219], v[136:139]
 ds_read_b128 v[184:187], v18 offset:12288
 v_mfma_f32_16x16x32_bf16 v[140:143], a[184:187], v[216:219], v[140:143]
 v_mfma_f32_16x16x32_bf16 v[144:147], a[188:191], v[216:219], v[144:147]
 v_mfma_f32_16x16x32_bf16 v[148:151], a[180:183], v[220:223], v[148:151]
 ds_read_b128 v[188:191], v18 offset:14336
 v_mfma_f32_16x16x32_bf16 v[152:155], a[184:187], v[220:223], v[152:155]
 v_mfma_f32_16x16x32_bf16 v[156:159], a[188:191], v[220:223], v[156:159]
 s_waitcnt lgkmcnt(4)
 s_add_u32 s21, s50, 8192
 v_mfma_f32_16x16x32_bf16 v[64:67], a[192:195], v[160:163], v[64:67]
 ds_read_b128 v[192:195], v19 offset:0
 v_mfma_f32_16x16x32_bf16 v[68:71], a[196:199], v[160:163], v[68:71]
 v_add_u32 v18, s33, v14
 v_mfma_f32_16x16x32_bf16 v[72:75], a[200:203], v[160:163], v[72:75]
 buffer_load_dwordx4 v[244:247], v30, s[16:19], s21 offen offset:1024 sc1
 v_mfma_f32_16x16x32_bf16 v[76:79], a[192:195], v[164:167], v[76:79]
 ds_read_b128 v[196:199], v19 offset:2048
 v_mfma_f32_16x16x32_bf16 v[80:83], a[196:199], v[164:167], v[80:83]
 buffer_load_dwordx4 v12, s[8:11], s30 offen offset:2048 lds
 v_mfma_f32_16x16x32_bf16 v[84:87], a[200:203], v[164:167], v[84:87]
 v_mfma_f32_16x16x32_bf16 v[88:91], a[192:195], v[168:171], v[88:91]
 ds_read_b128 v[200:203], v19 offset:4096
 v_mfma_f32_16x16x32_bf16 v[92:95], a[196:199], v[168:171], v[92:95]
 v_mfma_f32_16x16x32_bf16 v[96:99], a[200:203], v[168:171], v[96:99]
 v_mfma_f32_16x16x32_bf16 v[100:103], a[192:195], v[172:175], v[100:103]
 ds_read_b128 v[204:207], v19 offset:6144
 v_mfma_f32_16x16x32_bf16 v[104:107], a[196:199], v[172:175], v[104:107]
 v_mfma_f32_16x16x32_bf16 v[108:111], a[200:203], v[172:175], v[108:111]
 s_waitcnt lgkmcnt(4)
 v_mfma_f32_16x16x32_bf16 v[112:115], a[192:195], v[176:179], v[112:115]
 ds_read_b128 v[208:211], v19 offset:8192
 v_mfma_f32_16x16x32_bf16 v[116:119], a[196:199], v[176:179], v[116:119]
 v_mfma_f32_16x16x32_bf16 v[120:123], a[200:203], v[176:179], v[120:123]
 v_mfma_f32_16x16x32_bf16 v[124:127], a[192:195], v[180:183], v[124:127]
 ds_read_b128 v[212:215], v19 offset:10240
 v_mfma_f32_16x16x32_bf16 v[128:131], a[196:199], v[180:183], v[128:131]
 buffer_load_dwordx4 v13, s[8:11], s30 offen offset:3072 lds
 v_mfma_f32_16x16x32_bf16 v[132:135], a[200:203], v[180:183], v[132:135]
 s_add_u32 s30, s30, 128
 s_add_u32 m0, m0, 16384
 v_mfma_f32_16x16x32_bf16 v[136:139], a[192:195], v[184:187], v[136:139]
 ds_read_b128 v[216:219], v19 offset:12288
 v_mfma_f32_16x16x32_bf16 v[140:143], a[196:199], v[184:187], v[140:143]
 s_cmp_lt_u32 m0, s46
 s_cselect_b32 m0, m0, s47
 v_mfma_f32_16x16x32_bf16 v[144:147], a[200:203], v[184:187], v[144:147]
 v_mfma_f32_16x16x32_bf16 v[148:151], a[192:195], v[188:191], v[148:151]
 ds_read_b128 v[220:223], v19 offset:14336
 v_mfma_f32_16x16x32_bf16 v[152:155], a[196:199], v[188:191], v[152:155]
 v_mfma_f32_16x16x32_bf16 v[156:159], a[200:203], v[188:191], v[156:159]
 s_waitcnt vmcnt(24) lgkmcnt(4)
 s_barrier
 v_mfma_f32_16x16x32_bf16 v[64:67], a[204:207], v[192:195], v[64:67]
 ds_read_b128 v[160:163], v18 offset:0
 v_mfma_f32_16x16x32_bf16 v[68:71], a[208:211], v[192:195], v[68:71]
 v_mfma_f32_16x16x32_bf16 v[72:75], a[212:215], v[192:195], v[72:75]
 v_add_u32 v19, s33, v15
 s_add_u32 s33, s33, 16384
 v_mfma_f32_16x16x32_bf16 v[76:79], a[204:207], v[196:199], v[76:79]
 ds_read_b128 v[164:167], v18 offset:2048
 v_mfma_f32_16x16x32_bf16 v[80:83], a[208:211], v[196:199], v[80:83]
 buffer_load_dwordx4 v10, s[8:11], s30 offen offset:0 lds
 v_mfma_f32_16x16x32_bf16 v[84:87], a[212:215], v[196:199], v[84:87]
 s_cmp_lt_u32 s33, 98304
 s_cselect_b32 s33, s33, 0
 v_mfma_f32_16x16x32_bf16 v[88:91], a[204:207], v[200:203], v[88:91]
 ds_read_b128 v[168:171], v18 offset:4096
 v_mfma_f32_16x16x32_bf16 v[92:95], a[208:211], v[200:203], v[92:95]
 v_mfma_f32_16x16x32_bf16 v[96:99], a[212:215], v[200:203], v[96:99]
 v_mfma_f32_16x16x32_bf16 v[100:103], a[204:207], v[204:207], v[100:103]
 ds_read_b128 v[172:175], v18 offset:6144
 v_mfma_f32_16x16x32_bf16 v[104:107], a[208:211], v[204:207], v[104:107]
 v_mfma_f32_16x16x32_bf16 v[108:111], a[212:215], v[204:207], v[108:111]
 s_waitcnt lgkmcnt(4)
 v_mfma_f32_16x16x32_bf16 v[112:115], a[204:207], v[208:211], v[112:115]
 ds_read_b128 v[176:179], v18 offset:8192
 v_mfma_f32_16x16x32_bf16 v[116:119], a[208:211], v[208:211], v[116:119]
 v_mfma_f32_16x16x32_bf16 v[120:123], a[212:215], v[208:211], v[120:123]
 v_mfma_f32_16x16x32_bf16 v[124:127], a[204:207], v[212:215], v[124:127]
 ds_read_b128 v[180:183], v18 offset:10240
 v_mfma_f32_16x16x32_bf16 v[128:131], a[208:211], v[212:215], v[128:131]
 buffer_load_dwordx4 v11, s[8:11], s30 offen offset:1024 lds
 v_mfma_f32_16x16x32_bf16 v[132:135], a[212:215], v[212:215], v[132:135]
 v_mfma_f32_16x16x32_bf16 v[136:139], a[204:207], v[216:219], v[136:139]
 ds_read_b128 v[184:187], v18 offset:12288
 v_mfma_f32_16x16x32_bf16 v[140:143], a[208:211], v[216:219], v[140:143]
 v_mfma_f32_16x16x32_bf16 v[144:147], a[212:215], v[216:219], v[144:147]
 v_mfma_f32_16x16x32_bf16 v[148:151], a[204:207], v[220:223], v[148:151]
 ds_read_b128 v[188:191], v18 offset:14336
 v_mfma_f32_16x16x32_bf16 v[152:155], a[208:211], v[220:223], v[152:155]
 v_mfma_f32_16x16x32_bf16 v[156:159], a[212:215], v[220:223], v[156:159]
 s_waitcnt lgkmcnt(4)
 v_mfma_f32_16x16x32_bf16 v[64:67], a[216:219], v[160:163], v[64:67]
 ds_read_b128 v[192:195], v19 offset:0
 v_mfma_f32_16x16x32_bf16 v[68:71], a[220:223], v[160:163], v[68:71]
 v_add_u32 v18, s33, v14
 v_mfma_f32_16x16x32_bf16 v[72:75], a[224:227], v[160:163], v[72:75]
 v_mfma_f32_16x16x32_bf16 v[76:79], a[216:219], v[164:167], v[76:79]
 ds_read_b128 v[196:199], v19 offset:2048
 v_mfma_f32_16x16x32_bf16 v[80:83], a[220:223], v[164:167], v[80:83]
 buffer_load_dwordx4 v12, s[8:11], s30 offen offset:2048 lds
 v_mfma_f32_16x16x32_bf16 v[84:87], a[224:227], v[164:167], v[84:87]
 v_mfma_f32_16x16x32_bf16 v[88:91], a[216:219], v[168:171], v[88:91]
 ds_read_b128 v[200:203], v19 offset:4096
 v_mfma_f32_16x16x32_bf16 v[92:95], a[220:223], v[168:171], v[92:95]
 v_mfma_f32_16x16x32_bf16 v[96:99], a[224:227], v[168:171], v[96:99]
 v_mfma_f32_16x16x32_bf16 v[100:103], a[216:219], v[172:175], v[100:103]
 ds_read_b128 v[204:207], v19 offset:6144
 v_mfma_f32_16x16x32_bf16 v[104:107], a[220:223], v[172:175], v[104:107]
 v_mfma_f32_16x16x32_bf16 v[108:111], a[224:227], v[172:175], v[108:111]
 s_waitcnt lgkmcnt(4)
 v_mfma_f32_16x16x32_bf16 v[112:115], a[216:219], v[176:179], v[112:115]
 ds_read_b128 v[208:211], v19 offset:8192
 v_mfma_f32_16x16x32_bf16 v[116:119], a[220:223], v[176:179], v[116:119]
 v_mfma_f32_16x16x32_bf16 v[120:123], a[224:227], v[176:179], v[120:123]
 v_mfma_f32_16x16x32_bf16 v[124:127], a[216:219], v[180:183], v[124:127]
 ds_read_b128 v[212:215], v19 offset:10240
 v_mfma_f32_16x16x32_bf16 v[128:131], a[220:223], v[180:183], v[128:131]
 buffer_load_dwordx4 v13, s[8:11], s30 offen offset:3072 lds
 v_mfma_f32_16x16x32_bf16 v[132:135], a[224:227], v[180:183], v[132:135]
 s_add_u32 s30, s30, 128
 s_add_u32 m0, m0, 16384
 v_mfma_f32_16x16x32_bf16 v[136:139], a[216:219], v[184:187], v[136:139]
 ds_read_b128 v[216:219], v19 offset:12288
 v_mfma_f32_16x16x32_bf16 v[140:143], a[220:223], v[184:187], v[140:143]
 s_cmp_lt_u32 m0, s46
 s_cselect_b32 m0, m0, s47
 v_mfma_f32_16x16x32_bf16 v[144:147], a[224:227], v[184:187], v[144:147]
 v_mfma_f32_16x16x32_bf16 v[148:151], a[216:219], v[188:191], v[148:151]
 ds_read_b128 v[220:223], v19 offset:14336
 v_mfma_f32_16x16x32_bf16 v[152:155], a[220:223], v[188:191], v[152:155]
 v_mfma_f32_16x16x32_bf16 v[156:159], a[224:227], v[188:191], v[156:159]
 s_waitcnt vmcnt(19) lgkmcnt(4)
 s_barrier
 v_mfma_f32_16x16x32_bf16 v[64:67], a[228:231], v[192:195], v[64:67]
 ds_read_b128 v[160:163], v18 offset:0
 v_mfma_f32_16x16x32_bf16 v[68:71], a[232:235], v[192:195], v[68:71]
 s_waitcnt vmcnt(22)
 s_cmp_eq_u32 s78, 0
 s_cbranch_scc1 pf_201
 v_mov_b32 v4, 0
 v_mov_b32 v5, 1
 s_mov_b64 exec, 1
 buffer_atomic_add v5, v4, s[72:75], s78 offen sc1
 s_mov_b64 exec, -1
 s_mov_b32 s78, 0
pf_201:
 buffer_load_dword v21, v33, s[72:75], s77 offen sc1
 v_mfma_f32_16x16x32_bf16 v[72:75], a[236:239], v[192:195], v[72:75]
 v_add_u32 v19, s33, v15
 s_add_u32 s33, s33, 16384
 v_mfma_f32_16x16x32_bf16 v[76:79], a[228:231], v[196:199], v[76:79]
 ds_read_b128 v[164:167], v18 offset:2048
 v_cvt_pk_bf16_f32 v224, v64, v65
 v_cvt_pk_bf16_f32 v225, v66, v67
 v_mfma_f32_16x16x32_bf16 v[80:83], a[232:235], v[196:199], v[80:83]
 buffer_load_dwordx4 v10, s[8:11], s30 offen offset:0 lds
 v_cvt_pk_bf16_f32 v226, v68, v69
 v_cvt_pk_bf16_f32 v227, v70, v71
 v_mfma_f32_16x16x32_bf16 v[84:87], a[236:239], v[196:199], v[84:87]
 s_cmp_lt_u32 s33, 98304
 s_cselect_b32 s33, s33, 0
 v_cvt_pk_bf16_f32 v228, v72, v73
 v_cvt_pk_bf16_f32 v229, v74, v75
 v_mfma_f32_16x16x32_bf16 v[88:91], a[228:231], v[200:203], v[88:91]
 ds_read_b128 v[168:171], v18 offset:4096
 ds_write_b64 v22, v[224:225] offset:0
 v_mfma_f32_16x16x32_bf16 v[92:95], a[232:235], v[200:203], v[92:95]
 ds_write_b64 v22, v[226:227] offset:8
 ds_write_b64 v16, v[228:229] offset:64
 v_mfma_f32_16x16x32_bf16 v[96:99], a[236:239], v[200:203], v[96:99]
 v_cvt_pk_bf16_f32 v230, v76, v77
 v_cvt_pk_bf16_f32 v231, v78, v79
 v_cvt_pk_bf16_f32 v232, v80, v81
 v_cvt_pk_bf16_f32 v233, v82, v83
 v_mfma_f32_16x16x32_bf16 v[100:103], a[228:231], v[204:207], v[100:103]
 ds_read_b128 v[172:175], v18 offset:6144
 v_cvt_pk_bf16_f32 v234, v84, v85
 v_cvt_pk_bf16_f32 v235, v86, v87
 v_mfma_f32_16x16x32_bf16 v[104:107], a[232:235], v[204:207], v[104:107]
 ds_write_b64 v22, v[230:231] offset:6400
 ds_write_b64 v22, v[232:233] offset:6408
 v_mfma_f32_16x16x32_bf16 v[108:111], a[236:239], v[204:207], v[108:111]
 s_waitcnt lgkmcnt(9)
 ds_write_b64 v16, v[234:235] offset:6464
 v_cvt_pk_bf16_f32 v224, v88, v89
 v_mfma_f32_16x16x32_bf16 v[112:115], a[228:231], v[208:211], v[112:115]
 ds_read_b128 v[176:179], v18 offset:8192
 v_cvt_pk_bf16_f32 v225, v90, v91
 v_cvt_pk_bf16_f32 v226, v92, v93
 v_cvt_pk_bf16_f32 v227, v94, v95
 v_mfma_f32_16x16x32_bf16 v[116:119], a[232:235], v[208:211], v[116:119]
 v_cvt_pk_bf16_f32 v228, v96, v97
 v_cvt_pk_bf16_f32 v229, v98, v99
 ds_write_b64 v22, v[224:225] offset:12800
 v_mfma_f32_16x16x32_bf16 v[120:123], a[236:239], v[208:211], v[120:123]
 ds_write_b64 v22, v[226:227] offset:12808
 ds_write_b64 v16, v[228:229] offset:12864
 v_mfma_f32_16x16x32_bf16 v[124:127], a[228:231], v[212:215], v[124:127]
 ds_read_b128 v[180:183], v18 offset:10240
 v_cvt_pk_bf16_f32 v230, v100, v101
 v_cvt_pk_bf16_f32 v231, v102, v103
 v_cvt_pk_bf16_f32 v232, v104, v105
 v_mfma_f32_16x16x32_bf16 v[128:131], a[232:235], v[212:215], v[128:131]
 buffer_load_dwordx4 v11, s[8:11], s30 offen offset:1024 lds
 v_cvt_pk_bf16_f32 v233, v106, v107
 v_cvt_pk_bf16_f32 v234, v108, v109
 v_mfma_f32_16x16x32_bf16 v[132:135], a[236:239], v[212:215], v[132:135]
 v_cvt_pk_bf16_f32 v235, v110, v111
 ds_write_b64 v22, v[230:231] offset:19200
 v_mfma_f32_16x16x32_bf16 v[136:139], a[228:231], v[216:219], v[136:139]
 ds_read_b128 v[184:187], v18 offset:12288
 ds_write_b64 v22, v[232:233] offset:19208
 v_mfma_f32_16x16x32_bf16 v[140:143], a[232:235], v[216:219], v[140:143]
 ds_write_b64 v16, v[234:235] offset:19264
 v_cvt_pk_bf16_f32 v224, v112, v113
 v_cvt_pk_bf16_f32 v225, v114, v115
 v_mfma_f32_16x16x32_bf16 v[144:147], a[236:239], v[216:219], v[144:147]
 v_cvt_pk_bf16_f32 v226, v116, v117
 v_cvt_pk_bf16_f32 v227, v118, v119
 v_cvt_pk_bf16_f32 v228, v120, v121
 v_cvt_pk_bf16_f32 v229, v122, v123
 v_mfma_f32_16x16x32_bf16 v[148:151], a[228:231], v[220:223], v[148:151]
 ds_read_b128 v[188:191], v18 offset:14336
 ds_write_b64 v22, v[224:225] offset:25600
 v_mfma_f32_16x16x32_bf16 v[152:155], a[232:235], v[220:223], v[152:155]
 ds_write_b64 v22, v[226:227] offset:25608
 ds_write_b64 v16, v[228:229] offset:25664
 v_mfma_f32_16x16x32_bf16 v[156:159], a[236:239], v[220:223], v[156:159]
 v_cvt_pk_bf16_f32 v230, v124, v125
 v_cvt_pk_bf16_f32 v231, v126, v127
 v_cvt_pk_bf16_f32 v232, v128, v129
 v_cvt_pk_bf16_f32 v233, v130, v131
qa_end_203:
 v_cvt_pk_bf16_f32 v234, v132, v133
 v_cvt_pk_bf16_f32 v235, v134, v135
 ds_write_b64 v22, v[230:231] offset:32000
 ds_write_b64 v22, v[232:233] offset:32008
 ds_write_b64 v16, v[234:235] offset:32064
 v_cvt_pk_bf16_f32 v224, v136, v137
 v_cvt_pk_bf16_f32 v225, v138, v139
 v_cvt_pk_bf16_f32 v226, v140, v141
 v_cvt_pk_bf16_f32 v227, v142, v143
 v_cvt_pk_bf16_f32 v228, v144, v145
 v_cvt_pk_bf16_f32 v229, v146, v147
 ds_write_b64 v22, v[224:225] offset:38400
 ds_write_b64 v22, v[226:227] offset:38408
 ds_write_b64 v16, v[228:229] offset:38464
 v_cvt_pk_bf16_f32 v230, v148, v149
 v_cvt_pk_bf16_f32 v231, v150, v151
 v_cvt_pk_bf16_f32 v232, v152, v153
 v_cvt_pk_bf16_f32 v233, v154, v155
 v_cvt_pk_bf16_f32 v234, v156, v157
 v_cvt_pk_bf16_f32 v235, v158, v159
 ds_write_b64 v22, v[230:231] offset:44800
 ds_write_b64 v22, v[232:233] offset:44808
 ds_write_b64 v16, v[234:235] offset:44864
 s_cmp_lg_u32 s26, s40
 s_cbranch_scc1 qbs_206
 s_waitcnt lgkmcnt(0)
 s_barrier
 ds_read_b128 v[64:67], v29 offset:0
 ds_read_b128 v[68:71], v29 offset:64
 ds_read_b128 v[72:75], v29 offset:128
 ds_read_b128 v[76:79], v29 offset:192
 ds_read_b128 v[80:83], v29 offset:256
 ds_read_b128 v[84:87], v29 offset:320
 ds_read_b128 v[88:91], v29 offset:6400
 ds_read_b128 v[92:95], v29 offset:6464
 ds_read_b128 v[96:99], v29 offset:6528
 ds_read_b128 v[100:103], v29 offset:6592
 ds_read_b128 v[104:107], v29 offset:6656
 ds_read_b128 v[108:111], v29 offset:6720
 s_waitcnt lgkmcnt(0)
 s_add_u32 s21, s43, 0
 buffer_store_dwordx4 v[64:67], v30, s[12:15], s21 offen offset:0 sc1
 buffer_store_dwordx4 v[68:71], v30, s[12:15], s21 offen offset:1024 sc1
 buffer_store_dwordx4 v[72:75], v30, s[12:15], s21 offen offset:2048 sc1
 buffer_store_dwordx4 v[76:79], v30, s[12:15], s21 offen offset:3072 sc1
 s_add_u32 s21, s43, 4096
 buffer_store_dwordx4 v[80:83], v30, s[12:15], s21 offen offset:0 sc1
 buffer_store_dwordx4 v[84:87], v30, s[12:15], s21 offen offset:1024 sc1
 buffer_store_dwordx4 v[88:91], v30, s[12:15], s21 offen offset:2048 sc1
 buffer_store_dwordx4 v[92:95], v30, s[12:15], s21 offen offset:3072 sc1
 s_add_u32 s21, s43, 8192
 buffer_store_dwordx4 v[96:99], v30, s[12:15], s21 offen offset:0 sc1
 buffer_store_dwordx4 v[100:103], v30, s[12:15], s21 offen offset:1024 sc1
 buffer_store_dwordx4 v[104:107], v30, s[12:15], s21 offen offset:2048 sc1
 buffer_store_dwordx4 v[108:111], v30, s[12:15], s21 offen offset:3072 sc1
 s_branch qbe_204
qbs_206:
 s_cmp_eq_u32 s80, 1
 s_cselect_b32 s21, s79, 0
 s_cmp_ge_u32 s21, 8
 s_cbranch_scc0 qx_207
 s_waitcnt lgkmcnt(0) vmcnt(5)
 s_barrier
 ds_read_b128 v[64:67], v29 offset:0
 ds_read_b128 v[88:91], v29 offset:6400
 ds_read_b128 v[68:71], v29 offset:64
 ds_read_b128 v[92:95], v29 offset:6464
 ds_read_b128 v[72:75], v29 offset:128
 ds_read_b128 v[96:99], v29 offset:6528
 ds_read_b128 v[76:79], v29 offset:192
 ds_read_b128 v[100:103], v29 offset:6592
 ds_read_b128 v[80:83], v29 offset:256
 ds_read_b128 v[104:107], v29 offset:6656
 ds_read_b128 v[84:87], v29 offset:320
 ds_read_b128 v[108:111], v29 offset:6720
 s_waitcnt lgkmcnt(10)
 v_mfma_f32_16x16x32_bf16 v[112:115], v[36:39], v[64:67], 0
 v_mfma_f32_16x16x32_bf16 v[116:119], a[240:243], v[64:67], 0
 v_mfma_f32_16x16x32_bf16 v[120:123], v[36:39], v[88:91], 0
 v_mfma_f32_16x16x32_bf16 v[124:127], v[60:63], v[88:91], 0
 v_mfma_f32_16x16x32_bf16 v[128:131], a[240:243], v[88:91], 0
 s_waitcnt lgkmcnt(8)
 v_mfma_f32_16x16x32_bf16 v[112:115], v[40:43], v[68:71], v[112:115]
 v_mfma_f32_16x16x32_bf16 v[116:119], a[244:247], v[68:71], v[116:119]
 v_mfma_f32_16x16x32_bf16 v[120:123], v[40:43], v[92:95], v[120:123]
 v_mfma_f32_16x16x32_bf16 v[124:127], v[236:239], v[92:95], v[124:127]
 v_mfma_f32_16x16x32_bf16 v[128:131], a[244:247], v[92:95], v[128:131]
 s_waitcnt lgkmcnt(6)
 v_mfma_f32_16x16x32_bf16 v[112:115], v[44:47], v[72:75], v[112:115]
 v_mfma_f32_16x16x32_bf16 v[116:119], a[248:251], v[72:75], v[116:119]
 v_mfma_f32_16x16x32_bf16 v[120:123], v[44:47], v[96:99], v[120:123]
 v_mfma_f32_16x16x32_bf16 v[124:127], v[240:243], v[96:99], v[124:127]
 v_mfma_f32_16x16x32_bf16 v[128:131], a[248:251], v[96:99], v[128:131]
 s_waitcnt lgkmcnt(4)
 v_mfma_f32_16x16x32_bf16 v[112:115], v[48:51], v[76:79], v[112:115]
 v_mfma_f32_16x16x32_bf16 v[116:119], a[252:255], v[76:79], v[116:119]
 v_mfma_f32_16x16x32_bf16 v[120:123], v[48:51], v[100:103], v[120:123]
 v_mfma_f32_16x16x32_bf16 v[124:127], v[244:247], v[100:103], v[124:127]
 v_mfma_f32_16x16x32_bf16 v[128:131], a[252:255], v[100:103], v[128:131]
 s_waitcnt lgkmcnt(2)
 v_mfma_f32_16x16x32_bf16 v[112:115], v[52:55], v[80:83], v[112:115]
 v_mfma_f32_16x16x32_bf16 v[116:119], v[24:27], v[80:83], v[116:119]
 v_mfma_f32_16x16x32_bf16 v[120:123], v[52:55], v[104:107], v[120:123]
 v_mfma_f32_16x16x32_bf16 v[124:127], v[248:251], v[104:107], v[124:127]
 v_mfma_f32_16x16x32_bf16 v[128:131], v[24:27], v[104:107], v[128:131]
 s_waitcnt lgkmcnt(0)
 v_mfma_f32_16x16x32_bf16 v[112:115], v[56:59], v[84:87], v[112:115]
 v_mfma_f32_16x16x32_bf16 v[116:119], v[6:9], v[84:87], v[116:119]
 v_mfma_f32_16x16x32_bf16 v[120:123], v[56:59], v[108:111], v[120:123]
 v_mfma_f32_16x16x32_bf16 v[124:127], v[252:255], v[108:111], v[124:127]
 v_mfma_f32_16x16x32_bf16 v[128:131], v[6:9], v[108:111], v[128:131]
 s_branch qx_205
qx_207:
 buffer_load_dword v21, v33, s[72:75], s77 offen sc1
 s_waitcnt vmcnt(0)
 s_mul_i32 s21, s49, 393216
 s_mul_i32 s22, s42, 12288
 s_add_u32 s50, s21, s22
 s_lshl_b32 s21, s49, 12
 s_and_b32 s21, s21, 8192
 s_xor_b32 s21, s21, s37
 s_lshl_b32 s51, s49, 20
 s_or_b32 s51, s51, s21
 s_xor_b32 s51, s51, 8192
 s_add_u32 s51, s51, s36
 s_lshr_b32 s22, s49, 1
 s_lshr_b32 s21, s49, 2
 s_add_u32 s21, s21, 3
 s_cmp_lt_u32 s49, 12
 s_cselect_b32 s21, s22, s21
 s_lshl_b32 s21, s21, 3
 s_lshr_b32 s22, s42, 2
 s_add_u32 s21, s21, s22
 s_lshl_b32 s21, s21, 7
 s_add_u32 s76, s21, 0
 s_lshl_b32 s77, s42, 7
 s_add_u32 s77, s77, 19456
 s_add_u32 s23, s49, 1
 s_waitcnt vmcnt(6)
 v_cmp_gt_u32 vcc, s23, v21
 s_mov_b32 s80, 0
 s_nop 0
 s_cbranch_vccnz qk_209
 s_mov_b32 s80, 1
 buffer_load_dwordx4 v[132:135], v31, s[52:55], s51 offen offset:0 sc1
 buffer_load_dwordx4 v[136:139], v31, s[52:55], s51 offen offset:512 sc1
 buffer_load_dwordx4 v[140:143], v31, s[52:55], s51 offen offset:1024 sc1
 buffer_load_dwordx4 v[144:147], v31, s[52:55], s51 offen offset:1536 sc1
 buffer_load_dwordx4 v[148:151], v31, s[52:55], s51 offen offset:2048 sc1
 buffer_load_dwordx4 v[152:155], v31, s[52:55], s51 offen offset:2560 sc1
qk_209:
 s_cmp_ge_u32 s79, 8
 s_cbranch_scc1 qk_208
 v_mov_b32 v156, 0
 s_mov_b32 s101, 0
wf_210:
 buffer_load_dword v157, v156, s[72:75], s76 offen sc1
 s_add_u32 s101, s101, 1
 s_cmp_gt_u32 s101, 131072
 s_cbranch_scc1 main_end
 s_waitcnt vmcnt(0)
 v_readfirstlane_b32 s100, v157
 s_cmp_ge_u32 s100, 8
 s_cbranch_scc1 wf_211
 s_sleep 2
 s_branch wf_210
wf_211:
 s_add_u32 s21, s50, 0
 buffer_load_dwordx4 v[36:39], v30, s[16:19], s21 offen offset:0 sc1
 buffer_load_dwordx4 v[40:43], v30, s[16:19], s21 offen offset:1024 sc1
 buffer_load_dwordx4 v[44:47], v30, s[16:19], s21 offen offset:2048 sc1
 buffer_load_dwordx4 v[48:51], v30, s[16:19], s21 offen offset:3072 sc1
 s_add_u32 s21, s50, 4096
 buffer_load_dwordx4 v[52:55], v30, s[16:19], s21 offen offset:0 sc1
 buffer_load_dwordx4 v[56:59], v30, s[16:19], s21 offen offset:1024 sc1
 buffer_load_dwordx4 v[60:63], v30, s[16:19], s21 offen offset:2048 sc1
 buffer_load_dwordx4 v[236:239], v30, s[16:19], s21 offen offset:3072 sc1
 s_add_u32 s21, s50, 8192
 buffer_load_dwordx4 v[240:243], v30, s[16:19], s21 offen offset:0 sc1
 buffer_load_dwordx4 v[244:247], v30, s[16:19], s21 offen offset:1024 sc1
 buffer_load_dwordx4 v[248:251], v30, s[16:19], s21 offen offset:2048 sc1
 buffer_load_dwordx4 v[252:255], v30, s[16:19], s21 offen offset:3072 sc1
qk_208:
 s_waitcnt lgkmcnt(0)
 s_barrier
 ds_read_b128 v[64:67], v29 offset:0
 ds_read_b128 v[68:71], v29 offset:64
 ds_read_b128 v[72:75], v29 offset:128
 ds_read_b128 v[76:79], v29 offset:192
 ds_read_b128 v[80:83], v29 offset:256
 ds_read_b128 v[84:87], v29 offset:320
 ds_read_b128 v[88:91], v29 offset:6400
 ds_read_b128 v[92:95], v29 offset:6464
 ds_read_b128 v[96:99], v29 offset:6528
 ds_read_b128 v[100:103], v29 offset:6592
 ds_read_b128 v[104:107], v29 offset:6656
 ds_read_b128 v[108:111], v29 offset:6720
 s_waitcnt lgkmcnt(0)
 s_cmp_eq_u32 s80, 1
 s_cselect_b32 s21, s79, 0
 s_cmp_ge_u32 s21, 8
 s_cbranch_scc1 qw_212
 s_waitcnt vmcnt(0)
qw_212:
 v_mfma_f32_16x16x32_bf16 v[112:115], v[36:39], v[64:67], 0
 v_mfma_f32_16x16x32_bf16 v[120:123], v[36:39], v[88:91], 0
 v_mfma_f32_16x16x32_bf16 v[124:127], v[60:63], v[88:91], 0
 v_mfma_f32_16x16x32_bf16 v[112:115], v[40:43], v[68:71], v[112:115]
 v_mfma_f32_16x16x32_bf16 v[120:123], v[40:43], v[92:95], v[120:123]
 v_mfma_f32_16x16x32_bf16 v[124:127], v[236:239], v[92:95], v[124:127]
 v_mfma_f32_16x16x32_bf16 v[112:115], v[44:47], v[72:75], v[112:115]
 v_mfma_f32_16x16x32_bf16 v[120:123], v[44:47], v[96:99], v[120:123]
 v_mfma_f32_16x16x32_bf16 v[124:127], v[240:243], v[96:99], v[124:127]
 v_mfma_f32_16x16x32_bf16 v[112:115], v[48:51], v[76:79], v[112:115]
 v_mfma_f32_16x16x32_bf16 v[120:123], v[48:51], v[100:103], v[120:123]
 v_mfma_f32_16x16x32_bf16 v[124:127], v[244:247], v[100:103], v[124:127]
 v_mfma_f32_16x16x32_bf16 v[112:115], v[52:55], v[80:83], v[112:115]
 v_mfma_f32_16x16x32_bf16 v[120:123], v[52:55], v[104:107], v[120:123]
 v_mfma_f32_16x16x32_bf16 v[124:127], v[248:251], v[104:107], v[124:127]
 v_mfma_f32_16x16x32_bf16 v[112:115], v[56:59], v[84:87], v[112:115]
 v_mfma_f32_16x16x32_bf16 v[120:123], v[56:59], v[108:111], v[120:123]
 v_mfma_f32_16x16x32_bf16 v[124:127], v[252:255], v[108:111], v[124:127]
 s_cmp_eq_u32 s80, 1
 s_cbranch_scc1 qm_213
 s_add_u32 s23, s49, 1
 s_min_u32 s22, s49, 61
 s_cmp_lt_u32 s49, 52
 s_cselect_b32 s23, s23, s22
 s_mov_b32 s101, 0
wm_214:
 buffer_load_dword v156, v33, s[72:75], s77 offen sc1
 s_add_u32 s101, s101, 1
 s_cmp_gt_u32 s101, 131072
 s_cbranch_scc1 main_end
 s_waitcnt vmcnt(0)
 v_cmp_gt_u32 vcc, s23, v156
 v_readfirstlane_b32 s100, v156
 s_nop 0
 s_cbranch_vccz wm_215
 s_sleep 16
 s_add_u32 s100, s100, 2
 s_cmp_ge_u32 s100, s23
 s_cbranch_scc1 wm_214
 s_sleep 90
 s_branch wm_214
wm_215:
 s_cmp_eq_u32 s49, 63
 s_cselect_b32 s21, s101, 0
 s_cmp_lt_u32 s21, 2
 s_cbranch_scc1 qtz_218
 s_sleep 36
qtz_218:
 s_mov_b32 s101, 0
 s_branch qtp_217
qtp_216:
 s_sleep 3
qtp_217:
 buffer_load_dwordx4 v[132:135], v31, s[52:55], s51 offen offset:0 sc1
 buffer_load_dwordx4 v[136:139], v31, s[52:55], s51 offen offset:512 sc1
 buffer_load_dwordx4 v[140:143], v31, s[52:55], s51 offen offset:1024 sc1
 buffer_load_dwordx4 v[144:147], v31, s[52:55], s51 offen offset:1536 sc1
 buffer_load_dwordx4 v[148:151], v31, s[52:55], s51 offen offset:2048 sc1
 buffer_load_dwordx4 v[152:155], v31, s[52:55], s51 offen offset:2560 sc1
 s_add_u32 s101, s101, 1
 s_cmp_gt_u32 s101, 131072
 s_cbranch_scc1 main_end
 s_waitcnt vmcnt(0)
 v_max3_u32 v156, v132, v134, v136
 v_max3_u32 v156, v156, v138, v140
 v_max3_u32 v156, v156, v142, v144
 v_max3_u32 v156, v156, v146, v148
 v_max3_u32 v156, v156, v150, v152
 v_max3_u32 v156, v156, v154, v154
 v_cmp_eq_u32 vcc, -1, v156
 s_nop 1
 s_cbranch_vccnz qtp_216
qm_213:
 s_waitcnt vmcnt(0)
 v_mfma_f32_16x16x32_bf16 v[116:119], v[132:135], v[64:67], 0
 v_mfma_f32_16x16x32_bf16 v[128:131], v[132:135], v[88:91], 0
 v_mfma_f32_16x16x32_bf16 v[116:119], v[136:139], v[68:71], v[116:119]
 v_mfma_f32_16x16x32_bf16 v[128:131], v[136:139], v[92:95], v[128:131]
 v_mfma_f32_16x16x32_bf16 v[116:119], v[140:143], v[72:75], v[116:119]
 v_mfma_f32_16x16x32_bf16 v[128:131], v[140:143], v[96:99], v[128:131]
 v_mfma_f32_16x16x32_bf16 v[116:119], v[144:147], v[76:79], v[116:119]
 v_mfma_f32_16x16x32_bf16 v[128:131], v[144:147], v[100:103], v[128:131]
 v_mfma_f32_16x16x32_bf16 v[116:119], v[148:151], v[80:83], v[116:119]
 v_mfma_f32_16x16x32_bf16 v[128:131], v[148:151], v[104:107], v[128:131]
 v_mfma_f32_16x16x32_bf16 v[116:119], v[152:155], v[84:87], v[116:119]
 v_mfma_f32_16x16x32_bf16 v[128:131], v[152:155], v[108:111], v[128:131]
qx_205:
 s_lshl_b32 s21, s49, 12
 s_and_b32 s21, s21, 8192
 s_xor_b32 s21, s21, s37
 s_lshl_b32 s81, s49, 20
 s_or_b32 s81, s81, s21
 s_add_u32 s81, s81, s44
 s_lshl_b32 s82, s49, 3
 s_and_b32 s21, s42, 7
 s_add_u32 s82, s82, s21
 s_lshl_b32 s82, s82, 7
 s_add_u32 s82, s82, 23552
 s_cmp_gt_u32 s26, 1
 s_cselect_b32 s21, s80, 0
 s_cmp_eq_u32 s21, 0
 s_cbranch_scc1 qi_220
 v_mov_b32 v36, v112
 v_mov_b32 v37, v113
 v_mov_b32 v38, v114
 v_mov_b32 v39, v115
 v_mov_b32 v40, v116
 v_mov_b32 v41, v117
 v_mov_b32 v42, v118
 v_mov_b32 v43, v119
 v_mov_b32 v44, v120
 v_mov_b32 v45, v121
 v_mov_b32 v46, v122
 v_mov_b32 v47, v123
 v_mov_b32 v48, v124
 v_mov_b32 v49, v125
 v_mov_b32 v50, v126
 v_mov_b32 v51, v127
 v_mov_b32 v52, v128
 v_mov_b32 v53, v129
 v_mov_b32 v54, v130
 v_mov_b32 v55, v131
 s_branch qd_219
qi_220:
 v_cndmask_b32 v112, v34, v112, s[64:65]
 v_cndmask_b32 v124, v34, v124, s[64:65]
 v_cndmask_b32 v113, v34, v113, s[66:67]
 v_cndmask_b32 v125, v34, v125, s[66:67]
 v_cndmask_b32 v114, v34, v114, s[68:69]
 v_cndmask_b32 v126, v34, v126, s[68:69]
 v_cndmask_b32 v115, v34, v115, s[70:71]
 v_cndmask_b32 v127, v34, v127, s[70:71]
 v_max3_f32 v156, v112, v113, v114
 v_max3_f32 v156, v156, v115, v116
 v_max3_f32 v156, v156, v117, v118
 v_max_f32 v156, v156, v119
 v_mov_b32 v157, v156
 s_nop 1
 v_permlane32_swap_b32 v156, v157
 v_max_f32 v156, v156, v157
 v_mov_b32 v157, v156
 s_nop 1
 v_permlane16_swap_b32 v156, v157
 v_max_f32 v156, v156, v157
 v_mul_f32 v156, s83, v156
 v_fma_f32 v112, v112, s83, -v156
 v_fma_f32 v113, v113, s83, -v156
 v_fma_f32 v114, v114, s83, -v156
 v_fma_f32 v115, v115, s83, -v156
 v_fma_f32 v116, v116, s83, -v156
 v_fma_f32 v117, v117, s83, -v156
 v_fma_f32 v118, v118, s83, -v156
 v_fma_f32 v119, v119, s83, -v156
 v_exp_f32 v112, v112
 v_exp_f32 v113, v113
 v_exp_f32 v114, v114
 v_exp_f32 v115, v115
 v_exp_f32 v116, v116
 v_exp_f32 v117, v117
 v_exp_f32 v118, v118
 v_exp_f32 v119, v119
 s_nop 0
 v_add_f32 v156, v116, v117
 v_add_f32 v156, v156, v118
 v_add_f32 v156, v156, v119
 v_cndmask_b32 v156, 0, v156, s[60:61]
 v_add_f32 v156, v156, v112
 v_add_f32 v156, v156, v113
 v_add_f32 v156, v156, v114
 v_add_f32 v156, v156, v115
 v_mov_b32 v157, v156
 s_nop 1
 v_permlane32_swap_b32 v156, v157
 v_add_f32 v156, v156, v157
 v_mov_b32 v157, v156
 s_nop 1
 v_permlane16_swap_b32 v156, v157
 v_add_f32 v156, v156, v157
 v_rcp_f32 v156, v156
 s_nop 0
 v_mul_f32 v112, v112, v156
 v_mul_f32 v113, v113, v156
 v_mul_f32 v114, v114, v156
 v_mul_f32 v115, v115, v156
 v_mul_f32 v116, v116, v156
 v_mul_f32 v117, v117, v156
 v_mul_f32 v118, v118, v156
 v_mul_f32 v119, v119, v156
 v_max3_f32 v156, v120, v121, v122
 v_max3_f32 v156, v156, v123, v124
 v_max3_f32 v156, v156, v125, v126
 v_max3_f32 v156, v156, v127, v128
 v_max3_f32 v156, v156, v129, v130
 v_max_f32 v156, v156, v131
 v_mov_b32 v157, v156
 s_nop 1
 v_permlane32_swap_b32 v156, v157
 v_max_f32 v156, v156, v157
 v_mov_b32 v157, v156
 s_nop 1
 v_permlane16_swap_b32 v156, v157
 v_max_f32 v156, v156, v157
 v_mul_f32 v156, s83, v156
 v_fma_f32 v120, v120, s83, -v156
 v_fma_f32 v121, v121, s83, -v156
 v_fma_f32 v122, v122, s83, -v156
 v_fma_f32 v123, v123, s83, -v156
 v_fma_f32 v124, v124, s83, -v156
 v_fma_f32 v125, v125, s83, -v156
 v_fma_f32 v126, v126, s83, -v156
 v_fma_f32 v127, v127, s83, -v156
 v_fma_f32 v128, v128, s83, -v156
 v_fma_f32 v129, v129, s83, -v156
 v_fma_f32 v130, v130, s83, -v156
 v_fma_f32 v131, v131, s83, -v156
 v_exp_f32 v120, v120
 v_exp_f32 v121, v121
 v_exp_f32 v122, v122
 v_exp_f32 v123, v123
 v_exp_f32 v124, v124
 v_exp_f32 v125, v125
 v_exp_f32 v126, v126
 v_exp_f32 v127, v127
 v_exp_f32 v128, v128
 v_exp_f32 v129, v129
 v_exp_f32 v130, v130
 v_exp_f32 v131, v131
 s_nop 0
 v_add_f32 v156, v128, v129
 v_add_f32 v156, v156, v130
 v_add_f32 v156, v156, v131
 v_cndmask_b32 v156, 0, v156, s[60:61]
 v_add_f32 v156, v156, v120
 v_add_f32 v156, v156, v121
 v_add_f32 v156, v156, v122
 v_add_f32 v156, v156, v123
 v_add_f32 v156, v156, v124
 v_add_f32 v156, v156, v125
 v_add_f32 v156, v156, v126
 v_add_f32 v156, v156, v127
 v_mov_b32 v157, v156
 s_nop 1
 v_permlane32_swap_b32 v156, v157
 v_add_f32 v156, v156, v157
 v_mov_b32 v157, v156
 s_nop 1
 v_permlane16_swap_b32 v156, v157
 v_add_f32 v156, v156, v157
 v_rcp_f32 v156, v156
 s_nop 0
 v_mul_f32 v120, v120, v156
 v_mul_f32 v121, v121, v156
 v_mul_f32 v122, v122, v156
 v_mul_f32 v123, v123, v156
 v_mul_f32 v124, v124, v156
 v_mul_f32 v125, v125, v156
 v_mul_f32 v126, v126, v156
 v_mul_f32 v127, v127, v156
 v_mul_f32 v128, v128, v156
 v_mul_f32 v129, v129, v156
 v_mul_f32 v130, v130, v156
 v_mul_f32 v131, v131, v156
 v_cvt_pk_bf16_f32 v196, v116, v117
 v_cvt_pk_bf16_f32 v197, v118, v119
 v_cvt_pk_bf16_f32 v198, v128, v129
 v_cvt_pk_bf16_f32 v199, v130, v131
 v_cvt_pk_bf16_f32 v192, v120, v121
 v_cvt_pk_bf16_f32 v193, v122, v123
 v_cvt_pk_bf16_f32 v194, v124, v125
 v_cvt_pk_bf16_f32 v195, v126, v127
 v_cvt_pk_bf16_f32 v200, v112, v113
 v_cvt_pk_bf16_f32 v201, v114, v115
 v_permlane16_swap_b32 v196, v198
 v_permlane16_swap_b32 v197, v199
 buffer_store_dwordx4 v[192:195], v30, s[56:59], s81 offen sc1
 s_mov_b64 exec, 0xffffffff
 buffer_store_dwordx4 v[196:199], v30, s[56:59], s81 offen offset:1024 sc1
 s_mov_b64 exec, -1
 buffer_store_dwordx2 v[200:201], v32, s[56:59], s81 offen offset:1536 sc1
 s_mov_b32 s78, s82
 s_mov_b32 s81, 0x80000000
 s_mov_b32 s82, 0
 s_cmp_eq_u32 s80, 1
 s_cbranch_scc1 qd_219
 s_waitcnt vmcnt(0)
 s_cmp_eq_u32 s78, 0
 s_cbranch_scc1 pf_221
 v_mov_b32 v4, 0
 v_mov_b32 v5, 1
 s_mov_b64 exec, 1
 buffer_atomic_add v5, v4, s[72:75], s78 offen sc1
 s_mov_b64 exec, -1
 s_mov_b32 s78, 0
pf_221:
qd_219:
 s_add_u32 s49, s49, s29
qbe_204:
 s_sub_u32 s26, s26, 1
 s_cmp_gt_u32 s26, 0
 s_waitcnt lgkmcnt(0)
 s_cbranch_scc1 qa_blk_202
 s_waitcnt vmcnt(0) lgkmcnt(0)
 s_cmp_eq_u32 s78, 0
 s_cbranch_scc1 pf_222
 v_mov_b32 v4, 0
 v_mov_b32 v5, 1
 s_mov_b64 exec, 1
 buffer_atomic_add v5, v4, s[72:75], s78 offen sc1
 s_mov_b64 exec, -1
 s_mov_b32 s78, 0
pf_222:
 s_cmp_eq_u32 s45, 0
 s_cbranch_scc1 q_done
 s_mul_i32 s21, s49, 393216
 s_mul_i32 s22, s42, 12288
 s_add_u32 s50, s21, s22
 s_lshl_b32 s21, s49, 12
 s_and_b32 s21, s21, 8192
 s_xor_b32 s21, s21, s37
 s_lshl_b32 s51, s49, 20
 s_or_b32 s51, s51, s21
 s_xor_b32 s51, s51, 8192
 s_add_u32 s51, s51, s36
 s_lshr_b32 s22, s49, 1
 s_lshr_b32 s21, s49, 2
 s_add_u32 s21, s21, 3
 s_cmp_lt_u32 s49, 12
 s_cselect_b32 s21, s22, s21
 s_lshl_b32 s21, s21, 3
 s_lshr_b32 s22, s42, 2
 s_add_u32 s21, s21, s22
 s_lshl_b32 s21, s21, 7
 s_add_u32 s76, s21, 0
 s_lshl_b32 s77, s42, 7
 s_add_u32 s77, s77, 19456
 buffer_load_dword v21, v33, s[72:75], s77 offen sc1
 s_add_u32 s21, s50, 0
 buffer_load_dwordx4 v[36:39], v30, s[16:19], s21 offen offset:0 sc1
 buffer_load_dwordx4 v[40:43], v30, s[16:19], s21 offen offset:1024 sc1
 buffer_load_dwordx4 v[44:47], v30, s[16:19], s21 offen offset:2048 sc1
 buffer_load_dwordx4 v[48:51], v30, s[16:19], s21 offen offset:3072 sc1
 s_add_u32 s21, s50, 4096
 buffer_load_dwordx4 v[52:55], v30, s[16:19], s21 offen offset:0 sc1
 buffer_load_dwordx4 v[56:59], v30, s[16:19], s21 offen offset:1024 sc1
 buffer_load_dwordx4 v[60:63], v30, s[16:19], s21 offen offset:2048 sc1
 buffer_load_dwordx4 v[236:239], v30, s[16:19], s21 offen offset:3072 sc1
 s_add_u32 s21, s50, 8192
 buffer_load_dwordx4 v[240:243], v30, s[16:19], s21 offen offset:0 sc1
 buffer_load_dwordx4 v[244:247], v30, s[16:19], s21 offen offset:1024 sc1
 buffer_load_dwordx4 v[248:251], v30, s[16:19], s21 offen offset:2048 sc1
 buffer_load_dwordx4 v[252:255], v30, s[16:19], s21 offen offset:3072 sc1
 s_add_u32 s21, s43, 0
 buffer_load_dwordx4 v[64:67], v30, s[12:15], s21 offen offset:0 sc1
 buffer_load_dwordx4 v[68:71], v30, s[12:15], s21 offen offset:1024 sc1
 buffer_load_dwordx4 v[72:75], v30, s[12:15], s21 offen offset:2048 sc1
 buffer_load_dwordx4 v[76:79], v30, s[12:15], s21 offen offset:3072 sc1
 s_add_u32 s21, s43, 4096
 buffer_load_dwordx4 v[80:83], v30, s[12:15], s21 offen offset:0 sc1
 buffer_load_dwordx4 v[84:87], v30, s[12:15], s21 offen offset:1024 sc1
 buffer_load_dwordx4 v[88:91], v30, s[12:15], s21 offen offset:2048 sc1
 buffer_load_dwordx4 v[92:95], v30, s[12:15], s21 offen offset:3072 sc1
 s_add_u32 s21, s43, 8192
 buffer_load_dwordx4 v[96:99], v30, s[12:15], s21 offen offset:0 sc1
 buffer_load_dwordx4 v[100:103], v30, s[12:15], s21 offen offset:1024 sc1
 buffer_load_dwordx4 v[104:107], v30, s[12:15], s21 offen offset:2048 sc1
 buffer_load_dwordx4 v[108:111], v30, s[12:15], s21 offen offset:3072 sc1
 s_waitcnt vmcnt(24)
 s_cmp_eq_u32 s78, 0
 s_cbranch_scc1 pf_226
 v_mov_b32 v4, 0
 v_mov_b32 v5, 1
 s_mov_b64 exec, 1
 buffer_atomic_add v5, v4, s[72:75], s78 offen sc1
 s_mov_b64 exec, -1
 s_mov_b32 s78, 0
pf_226:
 s_add_u32 s23, s49, 1
 v_cmp_gt_u32 vcc, s23, v21
 s_mov_b32 s80, 0
 s_nop 0
 s_cbranch_vccnz qk_225
 s_mov_b32 s80, 1
 buffer_load_dwordx4 v[132:135], v31, s[52:55], s51 offen offset:0 sc1
 buffer_load_dwordx4 v[136:139], v31, s[52:55], s51 offen offset:512 sc1
 buffer_load_dwordx4 v[140:143], v31, s[52:55], s51 offen offset:1024 sc1
 buffer_load_dwordx4 v[144:147], v31, s[52:55], s51 offen offset:1536 sc1
 buffer_load_dwordx4 v[148:151], v31, s[52:55], s51 offen offset:2048 sc1
 buffer_load_dwordx4 v[152:155], v31, s[52:55], s51 offen offset:2560 sc1
 s_waitcnt vmcnt(6)
 s_branch qk_225x
qk_225:
 s_waitcnt vmcnt(0)
qk_225x:
 v_mfma_f32_16x16x32_bf16 v[112:115], v[36:39], v[64:67], 0
 v_mfma_f32_16x16x32_bf16 v[120:123], v[36:39], v[88:91], 0
 v_mfma_f32_16x16x32_bf16 v[124:127], v[60:63], v[88:91], 0
 v_mfma_f32_16x16x32_bf16 v[112:115], v[40:43], v[68:71], v[112:115]
 v_mfma_f32_16x16x32_bf16 v[120:123], v[40:43], v[92:95], v[120:123]
 v_mfma_f32_16x16x32_bf16 v[124:127], v[236:239], v[92:95], v[124:127]
 v_mfma_f32_16x16x32_bf16 v[112:115], v[44:47], v[72:75], v[112:115]
 v_mfma_f32_16x16x32_bf16 v[120:123], v[44:47], v[96:99], v[120:123]
 v_mfma_f32_16x16x32_bf16 v[124:127], v[240:243], v[96:99], v[124:127]
 v_mfma_f32_16x16x32_bf16 v[112:115], v[48:51], v[76:79], v[112:115]
 v_mfma_f32_16x16x32_bf16 v[120:123], v[48:51], v[100:103], v[120:123]
 v_mfma_f32_16x16x32_bf16 v[124:127], v[244:247], v[100:103], v[124:127]
 v_mfma_f32_16x16x32_bf16 v[112:115], v[52:55], v[80:83], v[112:115]
 v_mfma_f32_16x16x32_bf16 v[120:123], v[52:55], v[104:107], v[120:123]
 v_mfma_f32_16x16x32_bf16 v[124:127], v[248:251], v[104:107], v[124:127]
 v_mfma_f32_16x16x32_bf16 v[112:115], v[56:59], v[84:87], v[112:115]
 v_mfma_f32_16x16x32_bf16 v[120:123], v[56:59], v[108:111], v[120:123]
 v_mfma_f32_16x16x32_bf16 v[124:127], v[252:255], v[108:111], v[124:127]
 s_cmp_eq_u32 s80, 1
 s_cbranch_scc1 qm_227
 s_add_u32 s23, s49, 1
 s_min_u32 s22, s49, 61
 s_cmp_lt_u32 s49, 52
 s_cselect_b32 s23, s23, s22
 s_mov_b32 s101, 0
wm_228:
 buffer_load_dword v156, v33, s[72:75], s77 offen sc1
 s_add_u32 s101, s101, 1
 s_cmp_gt_u32 s101, 131072
 s_cbranch_scc1 main_end
 s_waitcnt vmcnt(0)
 v_cmp_gt_u32 vcc, s23, v156
 v_readfirstlane_b32 s100, v156
 s_nop 0
 s_cbranch_vccz wm_229
 s_sleep 16
 s_add_u32 s100, s100, 2
 s_cmp_ge_u32 s100, s23
 s_cbranch_scc1 wm_228
 s_sleep 90
 s_branch wm_228
wm_229:
 s_cmp_eq_u32 s49, 63
 s_cselect_b32 s21, s101, 0
 s_cmp_lt_u32 s21, 2
 s_cbranch_scc1 qtz_232
 s_sleep 36
qtz_232:
 s_mov_b32 s101, 0
 s_branch qtp_231
qtp_230:
 s_sleep 3
qtp_231:
 buffer_load_dwordx4 v[132:135], v31, s[52:55], s51 offen offset:0 sc1
 buffer_load_dwordx4 v[136:139], v31, s[52:55], s51 offen offset:512 sc1
 buffer_load_dwordx4 v[140:143], v31, s[52:55], s51 offen offset:1024 sc1
 buffer_load_dwordx4 v[144:147], v31, s[52:55], s51 offen offset:1536 sc1
 buffer_load_dwordx4 v[148:151], v31, s[52:55], s51 offen offset:2048 sc1
 buffer_load_dwordx4 v[152:155], v31, s[52:55], s51 offen offset:2560 sc1
 s_add_u32 s101, s101, 1
 s_cmp_gt_u32 s101, 131072
 s_cbranch_scc1 main_end
 s_waitcnt vmcnt(0)
 v_max3_u32 v156, v132, v134, v136
 v_max3_u32 v156, v156, v138, v140
 v_max3_u32 v156, v156, v142, v144
 v_max3_u32 v156, v156, v146, v148
 v_max3_u32 v156, v156, v150, v152
 v_max3_u32 v156, v156, v154, v154
 v_cmp_eq_u32 vcc, -1, v156
 s_nop 1
 s_cbranch_vccnz qtp_230
qm_227:
 s_waitcnt vmcnt(0)
 v_mfma_f32_16x16x32_bf16 v[116:119], v[132:135], v[64:67], 0
 v_mfma_f32_16x16x32_bf16 v[128:131], v[132:135], v[88:91], 0
 v_mfma_f32_16x16x32_bf16 v[116:119], v[136:139], v[68:71], v[116:119]
 v_mfma_f32_16x16x32_bf16 v[128:131], v[136:139], v[92:95], v[128:131]
 v_mfma_f32_16x16x32_bf16 v[116:119], v[140:143], v[72:75], v[116:119]
 v_mfma_f32_16x16x32_bf16 v[128:131], v[140:143], v[96:99], v[128:131]
 v_mfma_f32_16x16x32_bf16 v[116:119], v[144:147], v[76:79], v[116:119]
 v_mfma_f32_16x16x32_bf16 v[128:131], v[144:147], v[100:103], v[128:131]
 v_mfma_f32_16x16x32_bf16 v[116:119], v[148:151], v[80:83], v[116:119]
 v_mfma_f32_16x16x32_bf16 v[128:131], v[148:151], v[104:107], v[128:131]
 v_mfma_f32_16x16x32_bf16 v[116:119], v[152:155], v[84:87], v[116:119]
 v_mfma_f32_16x16x32_bf16 v[128:131], v[152:155], v[108:111], v[128:131]
qx_224:
 s_lshl_b32 s21, s49, 12
 s_and_b32 s21, s21, 8192
 s_xor_b32 s21, s21, s37
 s_lshl_b32 s81, s49, 20
 s_or_b32 s81, s81, s21
 s_add_u32 s81, s81, s44
 s_lshl_b32 s82, s49, 3
 s_and_b32 s21, s42, 7
 s_add_u32 s82, s82, s21
 s_lshl_b32 s82, s82, 7
 s_add_u32 s82, s82, 23552
 v_cndmask_b32 v112, v34, v112, s[64:65]
 v_cndmask_b32 v124, v34, v124, s[64:65]
 v_cndmask_b32 v113, v34, v113, s[66:67]
 v_cndmask_b32 v125, v34, v125, s[66:67]
 v_cndmask_b32 v114, v34, v114, s[68:69]
 v_cndmask_b32 v126, v34, v126, s[68:69]
 v_cndmask_b32 v115, v34, v115, s[70:71]
 v_cndmask_b32 v127, v34, v127, s[70:71]
 v_max3_f32 v156, v112, v113, v114
 v_max3_f32 v156, v156, v115, v116
 v_max3_f32 v156, v156, v117, v118
 v_max_f32 v156, v156, v119
 v_mov_b32 v157, v156
 s_nop 1
 v_permlane32_swap_b32 v156, v157
 v_max_f32 v156, v156, v157
 v_mov_b32 v157, v156
 s_nop 1
 v_permlane16_swap_b32 v156, v157
 v_max_f32 v156, v156, v157
 v_mul_f32 v156, s83, v156
 v_fma_f32 v112, v112, s83, -v156
 v_fma_f32 v113, v113, s83, -v156
 v_fma_f32 v114, v114, s83, -v156
 v_fma_f32 v115, v115, s83, -v156
 v_fma_f32 v116, v116, s83, -v156
 v_fma_f32 v117, v117, s83, -v156
 v_fma_f32 v118, v118, s83, -v156
 v_fma_f32 v119, v119, s83, -v156
 v_exp_f32 v112, v112
 v_exp_f32 v113, v113
 v_exp_f32 v114, v114
 v_exp_f32 v115, v115
 v_exp_f32 v116, v116
 v_exp_f32 v117, v117
 v_exp_f32 v118, v118
 v_exp_f32 v119, v119
 s_nop 0
 v_add_f32 v156, v116, v117
 v_add_f32 v156, v156, v118
 v_add_f32 v156, v156, v119
 v_cndmask_b32 v156, 0, v156, s[60:61]
 v_add_f32 v156, v156, v112
 v_add_f32 v156, v156, v113
 v_add_f32 v156, v156, v114
 v_add_f32 v156, v156, v115
 v_mov_b32 v157, v156
 s_nop 1
 v_permlane32_swap_b32 v156, v157
 v_add_f32 v156, v156, v157
 v_mov_b32 v157, v156
 s_nop 1
 v_permlane16_swap_b32 v156, v157
 v_add_f32 v156, v156, v157
 v_rcp_f32 v156, v156
 s_nop 0
 v_mul_f32 v112, v112, v156
 v_mul_f32 v113, v113, v156
 v_mul_f32 v114, v114, v156
 v_mul_f32 v115, v115, v156
 v_mul_f32 v116, v116, v156
 v_mul_f32 v117, v117, v156
 v_mul_f32 v118, v118, v156
 v_mul_f32 v119, v119, v156
 v_max3_f32 v156, v120, v121, v122
 v_max3_f32 v156, v156, v123, v124
 v_max3_f32 v156, v156, v125, v126
 v_max3_f32 v156, v156, v127, v128
 v_max3_f32 v156, v156, v129, v130
 v_max_f32 v156, v156, v131
 v_mov_b32 v157, v156
 s_nop 1
 v_permlane32_swap_b32 v156, v157
 v_max_f32 v156, v156, v157
 v_mov_b32 v157, v156
 s_nop 1
 v_permlane16_swap_b32 v156, v157
 v_max_f32 v156, v156, v157
 v_mul_f32 v156, s83, v156
 v_fma_f32 v120, v120, s83, -v156
 v_fma_f32 v121, v121, s83, -v156
 v_fma_f32 v122, v122, s83, -v156
 v_fma_f32 v123, v123, s83, -v156
 v_fma_f32 v124, v124, s83, -v156
 v_fma_f32 v125, v125, s83, -v156
 v_fma_f32 v126, v126, s83, -v156
 v_fma_f32 v127, v127, s83, -v156
 v_fma_f32 v128, v128, s83, -v156
 v_fma_f32 v129, v129, s83, -v156
 v_fma_f32 v130, v130, s83, -v156
 v_fma_f32 v131, v131, s83, -v156
 v_exp_f32 v120, v120
 v_exp_f32 v121, v121
 v_exp_f32 v122, v122
 v_exp_f32 v123, v123
 v_exp_f32 v124, v124
 v_exp_f32 v125, v125
 v_exp_f32 v126, v126
 v_exp_f32 v127, v127
 v_exp_f32 v128, v128
 v_exp_f32 v129, v129
 v_exp_f32 v130, v130
 v_exp_f32 v131, v131
 s_nop 0
 v_add_f32 v156, v128, v129
 v_add_f32 v156, v156, v130
 v_add_f32 v156, v156, v131
 v_cndmask_b32 v156, 0, v156, s[60:61]
 v_add_f32 v156, v156, v120
 v_add_f32 v156, v156, v121
 v_add_f32 v156, v156, v122
 v_add_f32 v156, v156, v123
 v_add_f32 v156, v156, v124
 v_add_f32 v156, v156, v125
 v_add_f32 v156, v156, v126
 v_add_f32 v156, v156, v127
 v_mov_b32 v157, v156
 s_nop 1
 v_permlane32_swap_b32 v156, v157
 v_add_f32 v156, v156, v157
 v_mov_b32 v157, v156
 s_nop 1
 v_permlane16_swap_b32 v156, v157
 v_add_f32 v156, v156, v157
 v_rcp_f32 v156, v156
 s_nop 0
 v_mul_f32 v120, v120, v156
 v_mul_f32 v121, v121, v156
 v_mul_f32 v122, v122, v156
 v_mul_f32 v123, v123, v156
 v_mul_f32 v124, v124, v156
 v_mul_f32 v125, v125, v156
 v_mul_f32 v126, v126, v156
 v_mul_f32 v127, v127, v156
 v_mul_f32 v128, v128, v156
 v_mul_f32 v129, v129, v156
 v_mul_f32 v130, v130, v156
 v_mul_f32 v131, v131, v156
 v_cvt_pk_bf16_f32 v196, v116, v117
 v_cvt_pk_bf16_f32 v197, v118, v119
 v_cvt_pk_bf16_f32 v198, v128, v129
 v_cvt_pk_bf16_f32 v199, v130, v131
 v_cvt_pk_bf16_f32 v192, v120, v121
 v_cvt_pk_bf16_f32 v193, v122, v123
 v_cvt_pk_bf16_f32 v194, v124, v125
 v_cvt_pk_bf16_f32 v195, v126, v127
 v_cvt_pk_bf16_f32 v200, v112, v113
 v_cvt_pk_bf16_f32 v201, v114, v115
 v_permlane16_swap_b32 v196, v198
 v_permlane16_swap_b32 v197, v199
 buffer_store_dwordx4 v[192:195], v30, s[56:59], s81 offen sc1
 s_mov_b64 exec, 0xffffffff
 buffer_store_dwordx4 v[196:199], v30, s[56:59], s81 offen offset:1024 sc1
 s_mov_b64 exec, -1
 buffer_store_dwordx2 v[200:201], v32, s[56:59], s81 offen offset:1536 sc1
 s_mov_b32 s78, s82
 s_mov_b32 s81, 0x80000000
 s_mov_b32 s82, 0
 s_cmp_eq_u32 s80, 1
 s_cbranch_scc1 qd_233
 s_waitcnt vmcnt(0)
 s_cmp_eq_u32 s78, 0
 s_cbranch_scc1 pf_234
 v_mov_b32 v4, 0
 v_mov_b32 v5, 1
 s_mov_b64 exec, 1
 buffer_atomic_add v5, v4, s[72:75], s78 offen sc1
 s_mov_b64 exec, -1
 s_mov_b32 s78, 0
pf_234:
qd_233:
 s_add_u32 s49, s49, s29
qbe_223:
 s_waitcnt vmcnt(0)
 s_cmp_eq_u32 s78, 0
 s_cbranch_scc1 pf_235
 v_mov_b32 v4, 0
 v_mov_b32 v5, 1
 s_mov_b64 exec, 1
 buffer_atomic_add v5, v4, s[72:75], s78 offen sc1
 s_mov_b64 exec, -1
 s_mov_b32 s78, 0
pf_235:
 s_branch queue
q_done:
 s_and_b32 s21, s3, 3
 s_sub_u32 s22, s21, 0
 s_lshl_b32 s22, s22, 3
 s_bfe_u32 s87, s3, 0x30002
 s_add_u32 s87, s87, s22
 s_add_u32 s87, s87, 252
 s_cmp_lt_u32 s21, 0
 s_cselect_b32 s87, -1, s87
 s_sub_u32 s21, s3, 96
 s_waitcnt vmcnt(0) lgkmcnt(0)
 s_barrier
 s_branch do_opb2
queue:
 s_load_dwordx2 s[4:5], s[0:1], 96
 s_waitcnt lgkmcnt(0)
 s_mov_b32 s32, s4
 s_mov_b32 s33, s5
 s_mov_b32 s34, 256
 s_mov_b32 s35, 0x00020000
 s_waitcnt vmcnt(0) lgkmcnt(0)
 s_barrier
 s_mov_b32 s2, s85
 s_mov_b32 s85, -1
 s_cmp_lg_u32 s2, -1
 s_cbranch_scc1 queue_c
 v_mov_b32 v21, 0
 s_cmp_lg_u32 s20, 0
 s_cbranch_scc1 q_236
 v_mov_b32 v22, 80
 v_mov_b32 v23, 1
 s_mov_b64 exec, 1
 buffer_atomic_add v23, v22, s[32:35], 0 offen sc0 sc1
 s_waitcnt vmcnt(0)
queue_a:
 ds_write_b32 v21, v23
 s_waitcnt lgkmcnt(0)
 s_mov_b64 exec, -1
q_236:
queue_b:
 s_barrier
 ds_read_b32 v23, v21
 s_waitcnt lgkmcnt(0)
 v_readfirstlane_b32 s2, v23
 s_barrier
queue_c:
 s_add_u32 s21, s2, 0
 s_cmp_lt_u32 s2, 64
 s_cbranch_scc1 do_pv
 s_sub_u32 s2, s2, 64
 s_add_u32 s21, s2, 64
 s_cmp_lt_u32 s2, 20
 s_cbranch_scc1 do_pv
 s_sub_u32 s2, s2, 20
 s_add_u32 s21, s2, 104
 s_cmp_lt_u32 s2, 20
 s_cbranch_scc1 do_pv
 s_sub_u32 s2, s2, 20
 s_add_u32 s21, s2, 84
 s_cmp_lt_u32 s2, 20
 s_cbranch_scc1 do_pv
 s_sub_u32 s2, s2, 20
 s_add_u32 s21, s2, 124
 s_cmp_lt_u32 s2, 20
 s_cbranch_scc1 do_pv
 s_sub_u32 s2, s2, 20
 s_add_u32 s21, s2, 144
 s_cmp_lt_u32 s2, 108
 s_cbranch_scc1 do_pv
 s_sub_u32 s2, s2, 108
 s_branch main_fin
do_opb:
 s_mov_b32 s87, -1
do_opb2:
 s_mov_b32 s2, s21
 s_load_dwordx2 s[4:5], s[0:1], 0
 s_load_dwordx4 s[40:43], s[0:1], 72
 s_load_dwordx2 s[38:39], s[0:1], 104
 s_lshl_b32 s59, s2, 2
 s_add_u32 s59, s59, s20
 s_lshl_b32 s59, s59, 3
 v_lshlrev_b32 v4, 4, v1
 v_lshlrev_b32 v5, 2, v1
 s_waitcnt lgkmcnt(0)
 s_mov_b32 s8, s4
 s_mov_b32 s9, s5
 s_mov_b32 s10, 2621440
 s_mov_b32 s11, 0x00020000
 s_mov_b32 s12, s42
 s_mov_b32 s13, s43
 s_mov_b32 s14, 1280
 s_mov_b32 s15, 0x00020000
 s_mov_b32 s24, s40
 s_mov_b32 s25, s41
 s_mov_b32 s26, 819200
 s_mov_b32 s27, 0x00020000
 s_add_u32 s16, s38, 70713344
 s_addc_u32 s17, s39, 0
 s_mov_b32 s18, 2641920
 s_mov_b32 s19, 0x00020000
 s_add_u32 s28, s38, 81002496
 s_addc_u32 s29, s39, 0
 s_mov_b32 s30, 8192
 s_mov_b32 s31, 0x00020000
 s_add_u32 s72, s38, 81068032
 s_addc_u32 s73, s39, 0
 s_mov_b32 s74, 129024
 s_mov_b32 s75, 0x00020000
 s_mov_b32 s21, 91136
 v_mov_b32 v20, 0
 buffer_load_dword v21, v20, s[72:75], s21 offen sc1
 v_mov_b32 v29, 3277
 s_mul_i32 s21, s20, 320
 s_add_u32 s21, s21, 0
 v_add_u32 v22, s21, v1
 v_mul_u32_u24 v23, v22, v29
 v_lshrrev_b32 v23, 16, v23
 v_mul_u32_u24 v24, 20, v23
 v_sub_u32 v22, v22, v24
 v_bfe_u32 v24, v23, 3, 1
 v_lshlrev_b32 v24, 1, v24
 v_xor_b32 v22, v22, v24
 v_mul_u32_u24 v23, 1280, v23
 v_lshl_add_u32 v8, v22, 4, v23
 s_mul_i32 s21, s20, 320
 s_add_u32 s21, s21, 64
 v_add_u32 v22, s21, v1
 v_mul_u32_u24 v23, v22, v29
 v_lshrrev_b32 v23, 16, v23
 v_mul_u32_u24 v24, 20, v23
 v_sub_u32 v22, v22, v24
 v_bfe_u32 v24, v23, 3, 1
 v_lshlrev_b32 v24, 1, v24
 v_xor_b32 v22, v22, v24
 v_mul_u32_u24 v23, 1280, v23
 v_lshl_add_u32 v9, v22, 4, v23
 s_mul_i32 s21, s20, 320
 s_add_u32 s21, s21, 128
 v_add_u32 v22, s21, v1
 v_mul_u32_u24 v23, v22, v29
 v_lshrrev_b32 v23, 16, v23
 v_mul_u32_u24 v24, 20, v23
 v_sub_u32 v22, v22, v24
 v_bfe_u32 v24, v23, 3, 1
 v_lshlrev_b32 v24, 1, v24
 v_xor_b32 v22, v22, v24
 v_mul_u32_u24 v23, 1280, v23
 v_lshl_add_u32 v10, v22, 4, v23
 s_mul_i32 s21, s20, 320
 s_add_u32 s21, s21, 192
 v_add_u32 v22, s21, v1
 v_mul_u32_u24 v23, v22, v29
 v_lshrrev_b32 v23, 16, v23
 v_mul_u32_u24 v24, 20, v23
 v_sub_u32 v22, v22, v24
 v_bfe_u32 v24, v23, 3, 1
 v_lshlrev_b32 v24, 1, v24
 v_xor_b32 v22, v22, v24
 v_mul_u32_u24 v23, 1280, v23
 v_lshl_add_u32 v11, v22, 4, v23
 s_mul_i32 s21, s20, 320
 s_add_u32 s21, s21, 256
 v_add_u32 v22, s21, v1
 v_mul_u32_u24 v23, v22, v29
 v_lshrrev_b32 v23, 16, v23
 v_mul_u32_u24 v24, 20, v23
 v_sub_u32 v22, v22, v24
 v_bfe_u32 v24, v23, 3, 1
 v_lshlrev_b32 v24, 1, v24
 v_xor_b32 v22, v22, v24
 v_mul_u32_u24 v23, 1280, v23
 v_lshl_add_u32 v12, v22, 4, v23
 s_and_b32 s44, s2, 3
 s_mul_i32 s45, s44, 320
 s_mul_i32 s46, s20, 5120
 v_and_b32 v22, 1, v2
 v_mul_u32_u24 v22, 16512, v22
 v_mul_u32_u24 v23, 33024, v3
 v_lshrrev_b32 v24, 1, v2
 v_lshlrev_b32 v24, 4, v24
 v_add3_u32 v6, v22, v23, v24
 s_lshr_b32 s47, s2, 2
 s_lshl_b32 s47, s47, 2
 s_add_u32 s47, s47, s20
 s_lshl_b32 s47, s47, 1
 s_lshl_b32 s48, s47, 7
 v_lshrrev_b32 v22, 2, v2
 v_lshl_add_u32 v22, v3, 3, v22
 v_mul_u32_u24 v22, 320, v22
 v_and_b32 v23, 3, v2
 v_lshl_add_u32 v22, v23, 3, v22
 v_and_b32 v23, 1, v3
 v_lshlrev_b32 v23, 5, v23
 v_add_u32 v14, v22, v23
 v_sub_u32 v15, v22, v23
 v_add_u32 v16, 61440, v14
 v_add_u32 v17, 61440, v15
 v_add_u32 v18, 122880, v14
 v_add_u32 v19, 122880, v15
 s_add_u32 m0, s46, 0
 s_add_u32 s49, s45, 0
 s_nop 0
 buffer_load_dwordx4 v8, s[24:27], s49 offen lds
 s_add_u32 m0, s46, 1024
 s_nop 0
 buffer_load_dwordx4 v9, s[24:27], s49 offen lds
 s_add_u32 m0, s46, 2048
 s_nop 0
 buffer_load_dwordx4 v10, s[24:27], s49 offen lds
 s_add_u32 m0, s46, 3072
 s_nop 0
 buffer_load_dwordx4 v11, s[24:27], s49 offen lds
 s_add_u32 m0, s46, 4096
 s_nop 0
 buffer_load_dwordx4 v12, s[24:27], s49 offen lds
 s_add_u32 m0, s46, 20480
 s_add_u32 s49, s45, 81920
 s_nop 0
 buffer_load_dwordx4 v8, s[24:27], s49 offen lds
 s_add_u32 m0, s46, 21504
 s_nop 0
 buffer_load_dwordx4 v9, s[24:27], s49 offen lds
 s_add_u32 m0, s46, 22528
 s_nop 0
 buffer_load_dwordx4 v10, s[24:27], s49 offen lds
 s_add_u32 m0, s46, 23552
 s_nop 0
 buffer_load_dwordx4 v11, s[24:27], s49 offen lds
 s_add_u32 m0, s46, 24576
 s_nop 0
 buffer_load_dwordx4 v12, s[24:27], s49 offen lds
 s_waitcnt vmcnt(10)
 v_readfirstlane_b32 s21, v21
 s_cmp_ge_u32 s21, 32
 s_cbranch_scc1 o2_237
 s_mov_b32 s21, 91136
 v_mov_b32 v20, 0
 s_mov_b32 s101, 0
wf_238:
 buffer_load_dword v21, v20, s[72:75], s21 offen sc1
 s_add_u32 s101, s101, 1
 s_cmp_gt_u32 s101, 131072
 s_cbranch_scc1 main_end
 s_waitcnt vmcnt(0)
 v_readfirstlane_b32 s100, v21
 s_cmp_ge_u32 s100, 32
 s_cbranch_scc1 wf_239
 s_sleep 32
 s_branch wf_238
wf_239:
o2_237:
 buffer_load_dwordx4 a[0:3], v6, s[16:19], s48 offen offset:0 sc1
 buffer_load_dwordx4 a[4:7], v6, s[16:19], s48 offen offset:128 sc1
 s_add_u32 s48, s48, 132096
 buffer_load_dwordx4 a[8:11], v6, s[16:19], s48 offen offset:0 sc1
 buffer_load_dwordx4 a[12:15], v6, s[16:19], s48 offen offset:128 sc1
 s_add_u32 s48, s48, 132096
 buffer_load_dwordx4 a[16:19], v6, s[16:19], s48 offen offset:0 sc1
 buffer_load_dwordx4 a[20:23], v6, s[16:19], s48 offen offset:128 sc1
 s_add_u32 s48, s48, 132096
 buffer_load_dwordx4 a[24:27], v6, s[16:19], s48 offen offset:0 sc1
 buffer_load_dwordx4 a[28:31], v6, s[16:19], s48 offen offset:128 sc1
 s_add_u32 s48, s48, 132096
 s_add_u32 m0, s46, 40960
 s_add_u32 s49, s45, 163840
 s_nop 0
 buffer_load_dwordx4 v8, s[24:27], s49 offen lds
 s_add_u32 m0, s46, 41984
 s_nop 0
 buffer_load_dwordx4 v9, s[24:27], s49 offen lds
 s_add_u32 m0, s46, 43008
 s_nop 0
 buffer_load_dwordx4 v10, s[24:27], s49 offen lds
 s_add_u32 m0, s46, 44032
 s_nop 0
 buffer_load_dwordx4 v11, s[24:27], s49 offen lds
 s_add_u32 m0, s46, 45056
 s_nop 0
 buffer_load_dwordx4 v12, s[24:27], s49 offen lds
 buffer_load_dwordx4 a[32:35], v6, s[16:19], s48 offen offset:0 sc1
 buffer_load_dwordx4 a[36:39], v6, s[16:19], s48 offen offset:128 sc1
 s_add_u32 s48, s48, 132096
 buffer_load_dwordx4 a[40:43], v6, s[16:19], s48 offen offset:0 sc1
 buffer_load_dwordx4 a[44:47], v6, s[16:19], s48 offen offset:128 sc1
 s_add_u32 s48, s48, 132096
 s_add_u32 m0, s46, 61440
 s_add_u32 s49, s45, 245760
 s_nop 0
 buffer_load_dwordx4 v8, s[24:27], s49 offen lds
 s_add_u32 m0, s46, 62464
 s_nop 0
 buffer_load_dwordx4 v9, s[24:27], s49 offen lds
 s_add_u32 m0, s46, 63488
 s_nop 0
 buffer_load_dwordx4 v10, s[24:27], s49 offen lds
 s_add_u32 m0, s46, 64512
 s_nop 0
 buffer_load_dwordx4 v11, s[24:27], s49 offen lds
 s_add_u32 m0, s46, 65536
 s_nop 0
 buffer_load_dwordx4 v12, s[24:27], s49 offen lds
 buffer_load_dwordx4 a[48:51], v6, s[16:19], s48 offen offset:0 sc1
 buffer_load_dwordx4 a[52:55], v6, s[16:19], s48 offen offset:128 sc1
 s_add_u32 s48, s48, 132096
 buffer_load_dwordx4 a[56:59], v6, s[16:19], s48 offen offset:0 sc1
 buffer_load_dwordx4 a[60:63], v6, s[16:19], s48 offen offset:128 sc1
 s_add_u32 s48, s48, 132096
 s_add_u32 m0, s46, 81920
 s_add_u32 s49, s45, 327680
 s_nop 0
 buffer_load_dwordx4 v8, s[24:27], s49 offen lds
 s_add_u32 m0, s46, 82944
 s_nop 0
 buffer_load_dwordx4 v9, s[24:27], s49 offen lds
 s_add_u32 m0, s46, 83968
 s_nop 0
 buffer_load_dwordx4 v10, s[24:27], s49 offen lds
 s_add_u32 m0, s46, 84992
 s_nop 0
 buffer_load_dwordx4 v11, s[24:27], s49 offen lds
 s_add_u32 m0, s46, 86016
 s_nop 0
 buffer_load_dwordx4 v12, s[24:27], s49 offen lds
 buffer_load_dwordx4 a[64:67], v6, s[16:19], s48 offen offset:0 sc1
 buffer_load_dwordx4 a[68:71], v6, s[16:19], s48 offen offset:128 sc1
 s_add_u32 s48, s48, 132096
 buffer_load_dwordx4 a[72:75], v6, s[16:19], s48 offen offset:0 sc1
 buffer_load_dwordx4 a[76:79], v6, s[16:19], s48 offen offset:128 sc1
 s_add_u32 s48, s48, 132096
 s_add_u32 m0, s46, 102400
 s_add_u32 s49, s45, 409600
 s_nop 0
 buffer_load_dwordx4 v8, s[24:27], s49 offen lds
 s_add_u32 m0, s46, 103424
 s_nop 0
 buffer_load_dwordx4 v9, s[24:27], s49 offen lds
 s_add_u32 m0, s46, 104448
 s_nop 0
 buffer_load_dwordx4 v10, s[24:27], s49 offen lds
 s_add_u32 m0, s46, 105472
 s_nop 0
 buffer_load_dwordx4 v11, s[24:27], s49 offen lds
 s_add_u32 m0, s46, 106496
 s_nop 0
 buffer_load_dwordx4 v12, s[24:27], s49 offen lds
 s_add_u32 m0, s46, 122880
 s_add_u32 s49, s45, 491520
 s_nop 0
 buffer_load_dwordx4 v8, s[24:27], s49 offen lds
 s_add_u32 m0, s46, 123904
 s_nop 0
 buffer_load_dwordx4 v9, s[24:27], s49 offen lds
 s_add_u32 m0, s46, 124928
 s_nop 0
 buffer_load_dwordx4 v10, s[24:27], s49 offen lds
 s_add_u32 m0, s46, 125952
 s_nop 0
 buffer_load_dwordx4 v11, s[24:27], s49 offen lds
 s_add_u32 m0, s46, 126976
 s_nop 0
 buffer_load_dwordx4 v12, s[24:27], s49 offen lds
 s_waitcnt vmcnt(50)
 s_barrier
 ds_read_b64_tr_b16 v[144:145], v14 offset:0
 ds_read_b64_tr_b16 v[146:147], v14 offset:1280
 ds_read_b64_tr_b16 v[148:149], v15 offset:32
 ds_read_b64_tr_b16 v[150:151], v15 offset:1312
 ds_read_b64_tr_b16 v[152:153], v14 offset:64
 ds_read_b64_tr_b16 v[154:155], v14 offset:1344
 ds_read_b64_tr_b16 v[156:157], v15 offset:96
 ds_read_b64_tr_b16 v[158:159], v15 offset:1376
 ds_read_b64_tr_b16 v[160:161], v14 offset:128
 ds_read_b64_tr_b16 v[162:163], v14 offset:1408
 ds_read_b64_tr_b16 v[164:165], v15 offset:160
 ds_read_b64_tr_b16 v[166:167], v15 offset:1440
 ds_read_b64_tr_b16 v[168:169], v14 offset:192
 ds_read_b64_tr_b16 v[170:171], v14 offset:1472
 ds_read_b64_tr_b16 v[172:173], v15 offset:224
 ds_read_b64_tr_b16 v[174:175], v15 offset:1504
 ds_read_b64_tr_b16 v[176:177], v14 offset:256
 ds_read_b64_tr_b16 v[178:179], v14 offset:1536
 ds_read_b64_tr_b16 v[180:181], v15 offset:288
 ds_read_b64_tr_b16 v[182:183], v15 offset:1568
 s_waitcnt lgkmcnt(0) vmcnt(43)
 v_mfma_f32_16x16x32_bf16 v[64:67], v[144:147], a[0:3], 0
 ds_read_b64_tr_b16 v[184:185], v14 offset:10240
 ds_read_b64_tr_b16 v[186:187], v14 offset:11520
 v_mfma_f32_16x16x32_bf16 v[104:107], v[144:147], a[4:7], 0
 ds_read_b64_tr_b16 v[188:189], v15 offset:10272
 v_mfma_f32_16x16x32_bf16 v[68:71], v[148:151], a[0:3], 0
 ds_read_b64_tr_b16 v[190:191], v15 offset:11552
 v_mfma_f32_16x16x32_bf16 v[108:111], v[148:151], a[4:7], 0
 ds_read_b64_tr_b16 v[192:193], v14 offset:10304
 v_mfma_f32_16x16x32_bf16 v[72:75], v[152:155], a[0:3], 0
 ds_read_b64_tr_b16 v[194:195], v14 offset:11584
 v_mfma_f32_16x16x32_bf16 v[112:115], v[152:155], a[4:7], 0
 ds_read_b64_tr_b16 v[196:197], v15 offset:10336
 ds_read_b64_tr_b16 v[198:199], v15 offset:11616
 v_mfma_f32_16x16x32_bf16 v[76:79], v[156:159], a[0:3], 0
 ds_read_b64_tr_b16 v[200:201], v14 offset:10368
 v_mfma_f32_16x16x32_bf16 v[116:119], v[156:159], a[4:7], 0
 ds_read_b64_tr_b16 v[202:203], v14 offset:11648
 v_mfma_f32_16x16x32_bf16 v[80:83], v[160:163], a[0:3], 0
 ds_read_b64_tr_b16 v[204:205], v15 offset:10400
 v_mfma_f32_16x16x32_bf16 v[120:123], v[160:163], a[4:7], 0
 ds_read_b64_tr_b16 v[206:207], v15 offset:11680
 v_mfma_f32_16x16x32_bf16 v[84:87], v[164:167], a[0:3], 0
 ds_read_b64_tr_b16 v[208:209], v14 offset:10432
 v_mfma_f32_16x16x32_bf16 v[124:127], v[164:167], a[4:7], 0
 ds_read_b64_tr_b16 v[210:211], v14 offset:11712
 ds_read_b64_tr_b16 v[212:213], v15 offset:10464
 v_mfma_f32_16x16x32_bf16 v[88:91], v[168:171], a[0:3], 0
 ds_read_b64_tr_b16 v[214:215], v15 offset:11744
 v_mfma_f32_16x16x32_bf16 v[128:131], v[168:171], a[4:7], 0
 buffer_load_dwordx4 a[80:83], v6, s[16:19], s48 offen offset:0 sc1
 ds_read_b64_tr_b16 v[216:217], v14 offset:10496
 v_mfma_f32_16x16x32_bf16 v[92:95], v[172:175], a[0:3], 0
 ds_read_b64_tr_b16 v[218:219], v14 offset:11776
 v_mfma_f32_16x16x32_bf16 v[132:135], v[172:175], a[4:7], 0
 ds_read_b64_tr_b16 v[220:221], v15 offset:10528
 v_mfma_f32_16x16x32_bf16 v[96:99], v[176:179], a[0:3], 0
 ds_read_b64_tr_b16 v[222:223], v15 offset:11808
 v_mfma_f32_16x16x32_bf16 v[136:139], v[176:179], a[4:7], 0
 buffer_load_dwordx4 a[84:87], v6, s[16:19], s48 offen offset:128 sc1
 v_mfma_f32_16x16x32_bf16 v[100:103], v[180:183], a[0:3], 0
 s_add_u32 s48, s48, 132096
 v_mfma_f32_16x16x32_bf16 v[140:143], v[180:183], a[4:7], 0
 s_waitcnt lgkmcnt(0) vmcnt(43)
 s_barrier
 v_mfma_f32_16x16x32_bf16 v[64:67], v[184:187], a[8:11], v[64:67]
 s_add_u32 m0, s46, 0
 ds_read_b64_tr_b16 v[144:145], v14 offset:20480
 ds_read_b64_tr_b16 v[146:147], v14 offset:21760
 v_mfma_f32_16x16x32_bf16 v[104:107], v[184:187], a[12:15], v[104:107]
 s_add_u32 s49, s45, 573440
 ds_read_b64_tr_b16 v[148:149], v15 offset:20512
 v_mfma_f32_16x16x32_bf16 v[68:71], v[188:191], a[8:11], v[68:71]
 buffer_load_dwordx4 v8, s[24:27], s49 offen lds
 ds_read_b64_tr_b16 v[150:151], v15 offset:21792
 v_mfma_f32_16x16x32_bf16 v[108:111], v[188:191], a[12:15], v[108:111]
 s_add_u32 m0, s46, 1024
 ds_read_b64_tr_b16 v[152:153], v14 offset:20544
 v_mfma_f32_16x16x32_bf16 v[72:75], v[192:195], a[8:11], v[72:75]
 buffer_load_dwordx4 v9, s[24:27], s49 offen lds
 ds_read_b64_tr_b16 v[154:155], v14 offset:21824
 v_mfma_f32_16x16x32_bf16 v[112:115], v[192:195], a[12:15], v[112:115]
 s_add_u32 m0, s46, 2048
 ds_read_b64_tr_b16 v[156:157], v15 offset:20576
 ds_read_b64_tr_b16 v[158:159], v15 offset:21856
 v_mfma_f32_16x16x32_bf16 v[76:79], v[196:199], a[8:11], v[76:79]
 buffer_load_dwordx4 v10, s[24:27], s49 offen lds
 ds_read_b64_tr_b16 v[160:161], v14 offset:20608
 v_mfma_f32_16x16x32_bf16 v[116:119], v[196:199], a[12:15], v[116:119]
 s_add_u32 m0, s46, 3072
 ds_read_b64_tr_b16 v[162:163], v14 offset:21888
 v_mfma_f32_16x16x32_bf16 v[80:83], v[200:203], a[8:11], v[80:83]
 buffer_load_dwordx4 v11, s[24:27], s49 offen lds
 ds_read_b64_tr_b16 v[164:165], v15 offset:20640
 v_mfma_f32_16x16x32_bf16 v[120:123], v[200:203], a[12:15], v[120:123]
 s_add_u32 m0, s46, 4096
 ds_read_b64_tr_b16 v[166:167], v15 offset:21920
 v_mfma_f32_16x16x32_bf16 v[84:87], v[204:207], a[8:11], v[84:87]
 buffer_load_dwordx4 v12, s[24:27], s49 offen lds
 ds_read_b64_tr_b16 v[168:169], v14 offset:20672
 v_mfma_f32_16x16x32_bf16 v[124:127], v[204:207], a[12:15], v[124:127]
 ds_read_b64_tr_b16 v[170:171], v14 offset:21952
 ds_read_b64_tr_b16 v[172:173], v15 offset:20704
 v_mfma_f32_16x16x32_bf16 v[88:91], v[208:211], a[8:11], v[88:91]
 ds_read_b64_tr_b16 v[174:175], v15 offset:21984
 v_mfma_f32_16x16x32_bf16 v[128:131], v[208:211], a[12:15], v[128:131]
 buffer_load_dwordx4 a[88:91], v6, s[16:19], s48 offen offset:0 sc1
 ds_read_b64_tr_b16 v[176:177], v14 offset:20736
 v_mfma_f32_16x16x32_bf16 v[92:95], v[212:215], a[8:11], v[92:95]
 ds_read_b64_tr_b16 v[178:179], v14 offset:22016
 v_mfma_f32_16x16x32_bf16 v[132:135], v[212:215], a[12:15], v[132:135]
 ds_read_b64_tr_b16 v[180:181], v15 offset:20768
 v_mfma_f32_16x16x32_bf16 v[96:99], v[216:219], a[8:11], v[96:99]
 ds_read_b64_tr_b16 v[182:183], v15 offset:22048
 v_mfma_f32_16x16x32_bf16 v[136:139], v[216:219], a[12:15], v[136:139]
 buffer_load_dwordx4 a[92:95], v6, s[16:19], s48 offen offset:128 sc1
 v_mfma_f32_16x16x32_bf16 v[100:103], v[220:223], a[8:11], v[100:103]
 s_add_u32 s48, s48, 132096
 v_mfma_f32_16x16x32_bf16 v[140:143], v[220:223], a[12:15], v[140:143]
 s_waitcnt lgkmcnt(0) vmcnt(48)
 v_mfma_f32_16x16x32_bf16 v[64:67], v[144:147], a[16:19], v[64:67]
 ds_read_b64_tr_b16 v[184:185], v14 offset:30720
 ds_read_b64_tr_b16 v[186:187], v14 offset:32000
 v_mfma_f32_16x16x32_bf16 v[104:107], v[144:147], a[20:23], v[104:107]
 ds_read_b64_tr_b16 v[188:189], v15 offset:30752
 v_mfma_f32_16x16x32_bf16 v[68:71], v[148:151], a[16:19], v[68:71]
 ds_read_b64_tr_b16 v[190:191], v15 offset:32032
 v_mfma_f32_16x16x32_bf16 v[108:111], v[148:151], a[20:23], v[108:111]
 ds_read_b64_tr_b16 v[192:193], v14 offset:30784
 v_mfma_f32_16x16x32_bf16 v[72:75], v[152:155], a[16:19], v[72:75]
 ds_read_b64_tr_b16 v[194:195], v14 offset:32064
 v_mfma_f32_16x16x32_bf16 v[112:115], v[152:155], a[20:23], v[112:115]
 ds_read_b64_tr_b16 v[196:197], v15 offset:30816
 ds_read_b64_tr_b16 v[198:199], v15 offset:32096
 v_mfma_f32_16x16x32_bf16 v[76:79], v[156:159], a[16:19], v[76:79]
 ds_read_b64_tr_b16 v[200:201], v14 offset:30848
 v_mfma_f32_16x16x32_bf16 v[116:119], v[156:159], a[20:23], v[116:119]
 ds_read_b64_tr_b16 v[202:203], v14 offset:32128
 v_mfma_f32_16x16x32_bf16 v[80:83], v[160:163], a[16:19], v[80:83]
 ds_read_b64_tr_b16 v[204:205], v15 offset:30880
 v_mfma_f32_16x16x32_bf16 v[120:123], v[160:163], a[20:23], v[120:123]
 ds_read_b64_tr_b16 v[206:207], v15 offset:32160
 v_mfma_f32_16x16x32_bf16 v[84:87], v[164:167], a[16:19], v[84:87]
 ds_read_b64_tr_b16 v[208:209], v14 offset:30912
 v_mfma_f32_16x16x32_bf16 v[124:127], v[164:167], a[20:23], v[124:127]
 ds_read_b64_tr_b16 v[210:211], v14 offset:32192
 ds_read_b64_tr_b16 v[212:213], v15 offset:30944
 v_mfma_f32_16x16x32_bf16 v[88:91], v[168:171], a[16:19], v[88:91]
 ds_read_b64_tr_b16 v[214:215], v15 offset:32224
 v_mfma_f32_16x16x32_bf16 v[128:131], v[168:171], a[20:23], v[128:131]
 buffer_load_dwordx4 a[96:99], v6, s[16:19], s48 offen offset:0 sc1
 ds_read_b64_tr_b16 v[216:217], v14 offset:30976
 v_mfma_f32_16x16x32_bf16 v[92:95], v[172:175], a[16:19], v[92:95]
 ds_read_b64_tr_b16 v[218:219], v14 offset:32256
 v_mfma_f32_16x16x32_bf16 v[132:135], v[172:175], a[20:23], v[132:135]
 ds_read_b64_tr_b16 v[220:221], v15 offset:31008
 v_mfma_f32_16x16x32_bf16 v[96:99], v[176:179], a[16:19], v[96:99]
 ds_read_b64_tr_b16 v[222:223], v15 offset:32288
 v_mfma_f32_16x16x32_bf16 v[136:139], v[176:179], a[20:23], v[136:139]
 buffer_load_dwordx4 a[100:103], v6, s[16:19], s48 offen offset:128 sc1
 v_mfma_f32_16x16x32_bf16 v[100:103], v[180:183], a[16:19], v[100:103]
 s_add_u32 s48, s48, 132096
 v_mfma_f32_16x16x32_bf16 v[140:143], v[180:183], a[20:23], v[140:143]
 s_waitcnt lgkmcnt(0) vmcnt(43)
 s_barrier
 v_mfma_f32_16x16x32_bf16 v[64:67], v[184:187], a[24:27], v[64:67]
 s_add_u32 m0, s46, 20480
 ds_read_b64_tr_b16 v[144:145], v14 offset:40960
 ds_read_b64_tr_b16 v[146:147], v14 offset:42240
 v_mfma_f32_16x16x32_bf16 v[104:107], v[184:187], a[28:31], v[104:107]
 s_add_u32 s49, s45, 655360
 ds_read_b64_tr_b16 v[148:149], v15 offset:40992
 v_mfma_f32_16x16x32_bf16 v[68:71], v[188:191], a[24:27], v[68:71]
 buffer_load_dwordx4 v8, s[24:27], s49 offen lds
 ds_read_b64_tr_b16 v[150:151], v15 offset:42272
 v_mfma_f32_16x16x32_bf16 v[108:111], v[188:191], a[28:31], v[108:111]
 s_add_u32 m0, s46, 21504
 ds_read_b64_tr_b16 v[152:153], v14 offset:41024
 v_mfma_f32_16x16x32_bf16 v[72:75], v[192:195], a[24:27], v[72:75]
 buffer_load_dwordx4 v9, s[24:27], s49 offen lds
 ds_read_b64_tr_b16 v[154:155], v14 offset:42304
 v_mfma_f32_16x16x32_bf16 v[112:115], v[192:195], a[28:31], v[112:115]
 s_add_u32 m0, s46, 22528
 ds_read_b64_tr_b16 v[156:157], v15 offset:41056
 ds_read_b64_tr_b16 v[158:159], v15 offset:42336
 v_mfma_f32_16x16x32_bf16 v[76:79], v[196:199], a[24:27], v[76:79]
 buffer_load_dwordx4 v10, s[24:27], s49 offen lds
 ds_read_b64_tr_b16 v[160:161], v14 offset:41088
 v_mfma_f32_16x16x32_bf16 v[116:119], v[196:199], a[28:31], v[116:119]
 s_add_u32 m0, s46, 23552
 ds_read_b64_tr_b16 v[162:163], v14 offset:42368
 v_mfma_f32_16x16x32_bf16 v[80:83], v[200:203], a[24:27], v[80:83]
 buffer_load_dwordx4 v11, s[24:27], s49 offen lds
 ds_read_b64_tr_b16 v[164:165], v15 offset:41120
 v_mfma_f32_16x16x32_bf16 v[120:123], v[200:203], a[28:31], v[120:123]
 s_add_u32 m0, s46, 24576
 ds_read_b64_tr_b16 v[166:167], v15 offset:42400
 v_mfma_f32_16x16x32_bf16 v[84:87], v[204:207], a[24:27], v[84:87]
 buffer_load_dwordx4 v12, s[24:27], s49 offen lds
 ds_read_b64_tr_b16 v[168:169], v14 offset:41152
 v_mfma_f32_16x16x32_bf16 v[124:127], v[204:207], a[28:31], v[124:127]
 ds_read_b64_tr_b16 v[170:171], v14 offset:42432
 ds_read_b64_tr_b16 v[172:173], v15 offset:41184
 v_mfma_f32_16x16x32_bf16 v[88:91], v[208:211], a[24:27], v[88:91]
 ds_read_b64_tr_b16 v[174:175], v15 offset:42464
 v_mfma_f32_16x16x32_bf16 v[128:131], v[208:211], a[28:31], v[128:131]
 buffer_load_dwordx4 a[104:107], v6, s[16:19], s48 offen offset:0 sc1
 ds_read_b64_tr_b16 v[176:177], v14 offset:41216
 v_mfma_f32_16x16x32_bf16 v[92:95], v[212:215], a[24:27], v[92:95]
 ds_read_b64_tr_b16 v[178:179], v14 offset:42496
 v_mfma_f32_16x16x32_bf16 v[132:135], v[212:215], a[28:31], v[132:135]
 ds_read_b64_tr_b16 v[180:181], v15 offset:41248
 v_mfma_f32_16x16x32_bf16 v[96:99], v[216:219], a[24:27], v[96:99]
 ds_read_b64_tr_b16 v[182:183], v15 offset:42528
 v_mfma_f32_16x16x32_bf16 v[136:139], v[216:219], a[28:31], v[136:139]
 buffer_load_dwordx4 a[108:111], v6, s[16:19], s48 offen offset:128 sc1
 v_mfma_f32_16x16x32_bf16 v[100:103], v[220:223], a[24:27], v[100:103]
 s_add_u32 s48, s48, 132096
 v_mfma_f32_16x16x32_bf16 v[140:143], v[220:223], a[28:31], v[140:143]
 s_waitcnt lgkmcnt(0) vmcnt(48)
 v_mfma_f32_16x16x32_bf16 v[64:67], v[144:147], a[32:35], v[64:67]
 ds_read_b64_tr_b16 v[184:185], v14 offset:51200
 ds_read_b64_tr_b16 v[186:187], v14 offset:52480
 v_mfma_f32_16x16x32_bf16 v[104:107], v[144:147], a[36:39], v[104:107]
 ds_read_b64_tr_b16 v[188:189], v15 offset:51232
 v_mfma_f32_16x16x32_bf16 v[68:71], v[148:151], a[32:35], v[68:71]
 ds_read_b64_tr_b16 v[190:191], v15 offset:52512
 v_mfma_f32_16x16x32_bf16 v[108:111], v[148:151], a[36:39], v[108:111]
 ds_read_b64_tr_b16 v[192:193], v14 offset:51264
 v_mfma_f32_16x16x32_bf16 v[72:75], v[152:155], a[32:35], v[72:75]
 ds_read_b64_tr_b16 v[194:195], v14 offset:52544
 v_mfma_f32_16x16x32_bf16 v[112:115], v[152:155], a[36:39], v[112:115]
 ds_read_b64_tr_b16 v[196:197], v15 offset:51296
 ds_read_b64_tr_b16 v[198:199], v15 offset:52576
 v_mfma_f32_16x16x32_bf16 v[76:79], v[156:159], a[32:35], v[76:79]
 ds_read_b64_tr_b16 v[200:201], v14 offset:51328
 v_mfma_f32_16x16x32_bf16 v[116:119], v[156:159], a[36:39], v[116:119]
 ds_read_b64_tr_b16 v[202:203], v14 offset:52608
 v_mfma_f32_16x16x32_bf16 v[80:83], v[160:163], a[32:35], v[80:83]
 ds_read_b64_tr_b16 v[204:205], v15 offset:51360
 v_mfma_f32_16x16x32_bf16 v[120:123], v[160:163], a[36:39], v[120:123]
 ds_read_b64_tr_b16 v[206:207], v15 offset:52640
 v_mfma_f32_16x16x32_bf16 v[84:87], v[164:167], a[32:35], v[84:87]
 ds_read_b64_tr_b16 v[208:209], v14 offset:51392
 v_mfma_f32_16x16x32_bf16 v[124:127], v[164:167], a[36:39], v[124:127]
 ds_read_b64_tr_b16 v[210:211], v14 offset:52672
 ds_read_b64_tr_b16 v[212:213], v15 offset:51424
 v_mfma_f32_16x16x32_bf16 v[88:91], v[168:171], a[32:35], v[88:91]
 ds_read_b64_tr_b16 v[214:215], v15 offset:52704
 v_mfma_f32_16x16x32_bf16 v[128:131], v[168:171], a[36:39], v[128:131]
 buffer_load_dwordx4 a[112:115], v6, s[16:19], s48 offen offset:0 sc1
 ds_read_b64_tr_b16 v[216:217], v14 offset:51456
 v_mfma_f32_16x16x32_bf16 v[92:95], v[172:175], a[32:35], v[92:95]
 ds_read_b64_tr_b16 v[218:219], v14 offset:52736
 v_mfma_f32_16x16x32_bf16 v[132:135], v[172:175], a[36:39], v[132:135]
 ds_read_b64_tr_b16 v[220:221], v15 offset:51488
 v_mfma_f32_16x16x32_bf16 v[96:99], v[176:179], a[32:35], v[96:99]
 ds_read_b64_tr_b16 v[222:223], v15 offset:52768
 v_mfma_f32_16x16x32_bf16 v[136:139], v[176:179], a[36:39], v[136:139]
 buffer_load_dwordx4 a[116:119], v6, s[16:19], s48 offen offset:128 sc1
 v_mfma_f32_16x16x32_bf16 v[100:103], v[180:183], a[32:35], v[100:103]
 s_add_u32 s48, s48, 132096
 v_mfma_f32_16x16x32_bf16 v[140:143], v[180:183], a[36:39], v[140:143]
 s_waitcnt lgkmcnt(0) vmcnt(43)
 s_barrier
 v_mfma_f32_16x16x32_bf16 v[64:67], v[184:187], a[40:43], v[64:67]
 s_add_u32 m0, s46, 40960
 ds_read_b64_tr_b16 v[144:145], v16 offset:0
 ds_read_b64_tr_b16 v[146:147], v16 offset:1280
 v_mfma_f32_16x16x32_bf16 v[104:107], v[184:187], a[44:47], v[104:107]
 s_add_u32 s49, s45, 737280
 ds_read_b64_tr_b16 v[148:149], v17 offset:32
 v_mfma_f32_16x16x32_bf16 v[68:71], v[188:191], a[40:43], v[68:71]
 buffer_load_dwordx4 v8, s[24:27], s49 offen lds
 ds_read_b64_tr_b16 v[150:151], v17 offset:1312
 v_mfma_f32_16x16x32_bf16 v[108:111], v[188:191], a[44:47], v[108:111]
 s_add_u32 m0, s46, 41984
 ds_read_b64_tr_b16 v[152:153], v16 offset:64
 v_mfma_f32_16x16x32_bf16 v[72:75], v[192:195], a[40:43], v[72:75]
 buffer_load_dwordx4 v9, s[24:27], s49 offen lds
 ds_read_b64_tr_b16 v[154:155], v16 offset:1344
 v_mfma_f32_16x16x32_bf16 v[112:115], v[192:195], a[44:47], v[112:115]
 s_add_u32 m0, s46, 43008
 ds_read_b64_tr_b16 v[156:157], v17 offset:96
 ds_read_b64_tr_b16 v[158:159], v17 offset:1376
 v_mfma_f32_16x16x32_bf16 v[76:79], v[196:199], a[40:43], v[76:79]
 buffer_load_dwordx4 v10, s[24:27], s49 offen lds
 ds_read_b64_tr_b16 v[160:161], v16 offset:128
 v_mfma_f32_16x16x32_bf16 v[116:119], v[196:199], a[44:47], v[116:119]
 s_add_u32 m0, s46, 44032
 ds_read_b64_tr_b16 v[162:163], v16 offset:1408
 v_mfma_f32_16x16x32_bf16 v[80:83], v[200:203], a[40:43], v[80:83]
 buffer_load_dwordx4 v11, s[24:27], s49 offen lds
 ds_read_b64_tr_b16 v[164:165], v17 offset:160
 v_mfma_f32_16x16x32_bf16 v[120:123], v[200:203], a[44:47], v[120:123]
 s_add_u32 m0, s46, 45056
 ds_read_b64_tr_b16 v[166:167], v17 offset:1440
 v_mfma_f32_16x16x32_bf16 v[84:87], v[204:207], a[40:43], v[84:87]
 buffer_load_dwordx4 v12, s[24:27], s49 offen lds
 ds_read_b64_tr_b16 v[168:169], v16 offset:192
 v_mfma_f32_16x16x32_bf16 v[124:127], v[204:207], a[44:47], v[124:127]
 ds_read_b64_tr_b16 v[170:171], v16 offset:1472
 ds_read_b64_tr_b16 v[172:173], v17 offset:224
 v_mfma_f32_16x16x32_bf16 v[88:91], v[208:211], a[40:43], v[88:91]
 ds_read_b64_tr_b16 v[174:175], v17 offset:1504
 v_mfma_f32_16x16x32_bf16 v[128:131], v[208:211], a[44:47], v[128:131]
 buffer_load_dwordx4 a[120:123], v6, s[16:19], s48 offen offset:0 sc1
 ds_read_b64_tr_b16 v[176:177], v16 offset:256
 v_mfma_f32_16x16x32_bf16 v[92:95], v[212:215], a[40:43], v[92:95]
 ds_read_b64_tr_b16 v[178:179], v16 offset:1536
 v_mfma_f32_16x16x32_bf16 v[132:135], v[212:215], a[44:47], v[132:135]
 ds_read_b64_tr_b16 v[180:181], v17 offset:288
 v_mfma_f32_16x16x32_bf16 v[96:99], v[216:219], a[40:43], v[96:99]
 ds_read_b64_tr_b16 v[182:183], v17 offset:1568
 v_mfma_f32_16x16x32_bf16 v[136:139], v[216:219], a[44:47], v[136:139]
 buffer_load_dwordx4 a[124:127], v6, s[16:19], s48 offen offset:128 sc1
 v_mfma_f32_16x16x32_bf16 v[100:103], v[220:223], a[40:43], v[100:103]
 s_add_u32 s48, s48, 132096
 v_mfma_f32_16x16x32_bf16 v[140:143], v[220:223], a[44:47], v[140:143]
 s_waitcnt lgkmcnt(0) vmcnt(48)
 v_mfma_f32_16x16x32_bf16 v[64:67], v[144:147], a[48:51], v[64:67]
 ds_read_b64_tr_b16 v[184:185], v16 offset:10240
 ds_read_b64_tr_b16 v[186:187], v16 offset:11520
 v_mfma_f32_16x16x32_bf16 v[104:107], v[144:147], a[52:55], v[104:107]
 ds_read_b64_tr_b16 v[188:189], v17 offset:10272
 v_mfma_f32_16x16x32_bf16 v[68:71], v[148:151], a[48:51], v[68:71]
 ds_read_b64_tr_b16 v[190:191], v17 offset:11552
 v_mfma_f32_16x16x32_bf16 v[108:111], v[148:151], a[52:55], v[108:111]
 ds_read_b64_tr_b16 v[192:193], v16 offset:10304
 v_mfma_f32_16x16x32_bf16 v[72:75], v[152:155], a[48:51], v[72:75]
 ds_read_b64_tr_b16 v[194:195], v16 offset:11584
 v_mfma_f32_16x16x32_bf16 v[112:115], v[152:155], a[52:55], v[112:115]
 ds_read_b64_tr_b16 v[196:197], v17 offset:10336
 ds_read_b64_tr_b16 v[198:199], v17 offset:11616
 v_mfma_f32_16x16x32_bf16 v[76:79], v[156:159], a[48:51], v[76:79]
 ds_read_b64_tr_b16 v[200:201], v16 offset:10368
 v_mfma_f32_16x16x32_bf16 v[116:119], v[156:159], a[52:55], v[116:119]
 ds_read_b64_tr_b16 v[202:203], v16 offset:11648
 v_mfma_f32_16x16x32_bf16 v[80:83], v[160:163], a[48:51], v[80:83]
 ds_read_b64_tr_b16 v[204:205], v17 offset:10400
 v_mfma_f32_16x16x32_bf16 v[120:123], v[160:163], a[52:55], v[120:123]
 ds_read_b64_tr_b16 v[206:207], v17 offset:11680
 v_mfma_f32_16x16x32_bf16 v[84:87], v[164:167], a[48:51], v[84:87]
 ds_read_b64_tr_b16 v[208:209], v16 offset:10432
 v_mfma_f32_16x16x32_bf16 v[124:127], v[164:167], a[52:55], v[124:127]
 ds_read_b64_tr_b16 v[210:211], v16 offset:11712
 ds_read_b64_tr_b16 v[212:213], v17 offset:10464
 v_mfma_f32_16x16x32_bf16 v[88:91], v[168:171], a[48:51], v[88:91]
 ds_read_b64_tr_b16 v[214:215], v17 offset:11744
 v_mfma_f32_16x16x32_bf16 v[128:131], v[168:171], a[52:55], v[128:131]
 buffer_load_dwordx4 a[128:131], v6, s[16:19], s48 offen offset:0 sc1
 ds_read_b64_tr_b16 v[216:217], v16 offset:10496
 v_mfma_f32_16x16x32_bf16 v[92:95], v[172:175], a[48:51], v[92:95]
 ds_read_b64_tr_b16 v[218:219], v16 offset:11776
 v_mfma_f32_16x16x32_bf16 v[132:135], v[172:175], a[52:55], v[132:135]
 ds_read_b64_tr_b16 v[220:221], v17 offset:10528
 v_mfma_f32_16x16x32_bf16 v[96:99], v[176:179], a[48:51], v[96:99]
 ds_read_b64_tr_b16 v[222:223], v17 offset:11808
 v_mfma_f32_16x16x32_bf16 v[136:139], v[176:179], a[52:55], v[136:139]
 buffer_load_dwordx4 a[132:135], v6, s[16:19], s48 offen offset:128 sc1
 v_mfma_f32_16x16x32_bf16 v[100:103], v[180:183], a[48:51], v[100:103]
 s_add_u32 s48, s48, 132096
 v_mfma_f32_16x16x32_bf16 v[140:143], v[180:183], a[52:55], v[140:143]
 s_waitcnt lgkmcnt(0) vmcnt(43)
 s_barrier
 v_mfma_f32_16x16x32_bf16 v[64:67], v[184:187], a[56:59], v[64:67]
 ds_read_b64_tr_b16 v[144:145], v16 offset:20480
 ds_read_b64_tr_b16 v[146:147], v16 offset:21760
 v_mfma_f32_16x16x32_bf16 v[104:107], v[184:187], a[60:63], v[104:107]
 ds_read_b64_tr_b16 v[148:149], v17 offset:20512
 v_mfma_f32_16x16x32_bf16 v[68:71], v[188:191], a[56:59], v[68:71]
 ds_read_b64_tr_b16 v[150:151], v17 offset:21792
 v_mfma_f32_16x16x32_bf16 v[108:111], v[188:191], a[60:63], v[108:111]
 ds_read_b64_tr_b16 v[152:153], v16 offset:20544
 v_mfma_f32_16x16x32_bf16 v[72:75], v[192:195], a[56:59], v[72:75]
 ds_read_b64_tr_b16 v[154:155], v16 offset:21824
 v_mfma_f32_16x16x32_bf16 v[112:115], v[192:195], a[60:63], v[112:115]
 ds_read_b64_tr_b16 v[156:157], v17 offset:20576
 ds_read_b64_tr_b16 v[158:159], v17 offset:21856
 v_mfma_f32_16x16x32_bf16 v[76:79], v[196:199], a[56:59], v[76:79]
 ds_read_b64_tr_b16 v[160:161], v16 offset:20608
 v_mfma_f32_16x16x32_bf16 v[116:119], v[196:199], a[60:63], v[116:119]
 ds_read_b64_tr_b16 v[162:163], v16 offset:21888
 v_mfma_f32_16x16x32_bf16 v[80:83], v[200:203], a[56:59], v[80:83]
 ds_read_b64_tr_b16 v[164:165], v17 offset:20640
 v_mfma_f32_16x16x32_bf16 v[120:123], v[200:203], a[60:63], v[120:123]
 ds_read_b64_tr_b16 v[166:167], v17 offset:21920
 v_mfma_f32_16x16x32_bf16 v[84:87], v[204:207], a[56:59], v[84:87]
 ds_read_b64_tr_b16 v[168:169], v16 offset:20672
 v_mfma_f32_16x16x32_bf16 v[124:127], v[204:207], a[60:63], v[124:127]
 ds_read_b64_tr_b16 v[170:171], v16 offset:21952
 ds_read_b64_tr_b16 v[172:173], v17 offset:20704
 v_mfma_f32_16x16x32_bf16 v[88:91], v[208:211], a[56:59], v[88:91]
 ds_read_b64_tr_b16 v[174:175], v17 offset:21984
 v_mfma_f32_16x16x32_bf16 v[128:131], v[208:211], a[60:63], v[128:131]
 buffer_load_dwordx4 a[136:139], v6, s[16:19], s48 offen offset:0 sc1
 ds_read_b64_tr_b16 v[176:177], v16 offset:20736
 v_mfma_f32_16x16x32_bf16 v[92:95], v[212:215], a[56:59], v[92:95]
 ds_read_b64_tr_b16 v[178:179], v16 offset:22016
 v_mfma_f32_16x16x32_bf16 v[132:135], v[212:215], a[60:63], v[132:135]
 ds_read_b64_tr_b16 v[180:181], v17 offset:20768
 v_mfma_f32_16x16x32_bf16 v[96:99], v[216:219], a[56:59], v[96:99]
 ds_read_b64_tr_b16 v[182:183], v17 offset:22048
 v_mfma_f32_16x16x32_bf16 v[136:139], v[216:219], a[60:63], v[136:139]
 buffer_load_dwordx4 a[140:143], v6, s[16:19], s48 offen offset:128 sc1
 v_mfma_f32_16x16x32_bf16 v[100:103], v[220:223], a[56:59], v[100:103]
 s_add_u32 s48, s48, 132096
 v_mfma_f32_16x16x32_bf16 v[140:143], v[220:223], a[60:63], v[140:143]
 s_waitcnt lgkmcnt(0) vmcnt(43)
 v_mfma_f32_16x16x32_bf16 v[64:67], v[144:147], a[64:67], v[64:67]
 ds_read_b64_tr_b16 v[184:185], v16 offset:30720
 ds_read_b64_tr_b16 v[186:187], v16 offset:32000
 v_mfma_f32_16x16x32_bf16 v[104:107], v[144:147], a[68:71], v[104:107]
 ds_read_b64_tr_b16 v[188:189], v17 offset:30752
 v_mfma_f32_16x16x32_bf16 v[68:71], v[148:151], a[64:67], v[68:71]
 ds_read_b64_tr_b16 v[190:191], v17 offset:32032
 v_mfma_f32_16x16x32_bf16 v[108:111], v[148:151], a[68:71], v[108:111]
 ds_read_b64_tr_b16 v[192:193], v16 offset:30784
 v_mfma_f32_16x16x32_bf16 v[72:75], v[152:155], a[64:67], v[72:75]
 ds_read_b64_tr_b16 v[194:195], v16 offset:32064
 v_mfma_f32_16x16x32_bf16 v[112:115], v[152:155], a[68:71], v[112:115]
 ds_read_b64_tr_b16 v[196:197], v17 offset:30816
 ds_read_b64_tr_b16 v[198:199], v17 offset:32096
 v_mfma_f32_16x16x32_bf16 v[76:79], v[156:159], a[64:67], v[76:79]
 ds_read_b64_tr_b16 v[200:201], v16 offset:30848
 v_mfma_f32_16x16x32_bf16 v[116:119], v[156:159], a[68:71], v[116:119]
 ds_read_b64_tr_b16 v[202:203], v16 offset:32128
 v_mfma_f32_16x16x32_bf16 v[80:83], v[160:163], a[64:67], v[80:83]
 ds_read_b64_tr_b16 v[204:205], v17 offset:30880
 v_mfma_f32_16x16x32_bf16 v[120:123], v[160:163], a[68:71], v[120:123]
 ds_read_b64_tr_b16 v[206:207], v17 offset:32160
 v_mfma_f32_16x16x32_bf16 v[84:87], v[164:167], a[64:67], v[84:87]
 ds_read_b64_tr_b16 v[208:209], v16 offset:30912
 v_mfma_f32_16x16x32_bf16 v[124:127], v[164:167], a[68:71], v[124:127]
 ds_read_b64_tr_b16 v[210:211], v16 offset:32192
 ds_read_b64_tr_b16 v[212:213], v17 offset:30944
 v_mfma_f32_16x16x32_bf16 v[88:91], v[168:171], a[64:67], v[88:91]
 ds_read_b64_tr_b16 v[214:215], v17 offset:32224
 v_mfma_f32_16x16x32_bf16 v[128:131], v[168:171], a[68:71], v[128:131]
 buffer_load_dwordx4 a[144:147], v6, s[16:19], s48 offen offset:0 sc1
 ds_read_b64_tr_b16 v[216:217], v16 offset:30976
 v_mfma_f32_16x16x32_bf16 v[92:95], v[172:175], a[64:67], v[92:95]
 ds_read_b64_tr_b16 v[218:219], v16 offset:32256
 v_mfma_f32_16x16x32_bf16 v[132:135], v[172:175], a[68:71], v[132:135]
 ds_read_b64_tr_b16 v[220:221], v17 offset:31008
 v_mfma_f32_16x16x32_bf16 v[96:99], v[176:179], a[64:67], v[96:99]
 ds_read_b64_tr_b16 v[222:223], v17 offset:32288
 v_mfma_f32_16x16x32_bf16 v[136:139], v[176:179], a[68:71], v[136:139]
 buffer_load_dwordx4 a[148:151], v6, s[16:19], s48 offen offset:128 sc1
 v_mfma_f32_16x16x32_bf16 v[100:103], v[180:183], a[64:67], v[100:103]
 s_add_u32 s48, s48, 132096
 v_mfma_f32_16x16x32_bf16 v[140:143], v[180:183], a[68:71], v[140:143]
 s_waitcnt lgkmcnt(0) vmcnt(38)
 s_barrier
 v_mfma_f32_16x16x32_bf16 v[64:67], v[184:187], a[72:75], v[64:67]
 ds_read_b64_tr_b16 v[144:145], v16 offset:40960
 ds_read_b64_tr_b16 v[146:147], v16 offset:42240
 v_mfma_f32_16x16x32_bf16 v[104:107], v[184:187], a[76:79], v[104:107]
 ds_read_b64_tr_b16 v[148:149], v17 offset:40992
 v_mfma_f32_16x16x32_bf16 v[68:71], v[188:191], a[72:75], v[68:71]
 ds_read_b64_tr_b16 v[150:151], v17 offset:42272
 v_mfma_f32_16x16x32_bf16 v[108:111], v[188:191], a[76:79], v[108:111]
 ds_read_b64_tr_b16 v[152:153], v16 offset:41024
 v_mfma_f32_16x16x32_bf16 v[72:75], v[192:195], a[72:75], v[72:75]
 ds_read_b64_tr_b16 v[154:155], v16 offset:42304
 v_mfma_f32_16x16x32_bf16 v[112:115], v[192:195], a[76:79], v[112:115]
 ds_read_b64_tr_b16 v[156:157], v17 offset:41056
 ds_read_b64_tr_b16 v[158:159], v17 offset:42336
 v_mfma_f32_16x16x32_bf16 v[76:79], v[196:199], a[72:75], v[76:79]
 ds_read_b64_tr_b16 v[160:161], v16 offset:41088
 v_mfma_f32_16x16x32_bf16 v[116:119], v[196:199], a[76:79], v[116:119]
 ds_read_b64_tr_b16 v[162:163], v16 offset:42368
 v_mfma_f32_16x16x32_bf16 v[80:83], v[200:203], a[72:75], v[80:83]
 ds_read_b64_tr_b16 v[164:165], v17 offset:41120
 v_mfma_f32_16x16x32_bf16 v[120:123], v[200:203], a[76:79], v[120:123]
 ds_read_b64_tr_b16 v[166:167], v17 offset:42400
 v_mfma_f32_16x16x32_bf16 v[84:87], v[204:207], a[72:75], v[84:87]
 ds_read_b64_tr_b16 v[168:169], v16 offset:41152
 v_mfma_f32_16x16x32_bf16 v[124:127], v[204:207], a[76:79], v[124:127]
 ds_read_b64_tr_b16 v[170:171], v16 offset:42432
 ds_read_b64_tr_b16 v[172:173], v17 offset:41184
 v_mfma_f32_16x16x32_bf16 v[88:91], v[208:211], a[72:75], v[88:91]
 ds_read_b64_tr_b16 v[174:175], v17 offset:42464
 v_mfma_f32_16x16x32_bf16 v[128:131], v[208:211], a[76:79], v[128:131]
 buffer_load_dwordx4 a[152:155], v6, s[16:19], s48 offen offset:0 sc1
 ds_read_b64_tr_b16 v[176:177], v16 offset:41216
 v_mfma_f32_16x16x32_bf16 v[92:95], v[212:215], a[72:75], v[92:95]
 ds_read_b64_tr_b16 v[178:179], v16 offset:42496
 v_mfma_f32_16x16x32_bf16 v[132:135], v[212:215], a[76:79], v[132:135]
 ds_read_b64_tr_b16 v[180:181], v17 offset:41248
 v_mfma_f32_16x16x32_bf16 v[96:99], v[216:219], a[72:75], v[96:99]
 ds_read_b64_tr_b16 v[182:183], v17 offset:42528
 v_mfma_f32_16x16x32_bf16 v[136:139], v[216:219], a[76:79], v[136:139]
 buffer_load_dwordx4 a[156:159], v6, s[16:19], s48 offen offset:128 sc1
 v_mfma_f32_16x16x32_bf16 v[100:103], v[220:223], a[72:75], v[100:103]
 s_add_u32 s48, s48, 132096
 v_mfma_f32_16x16x32_bf16 v[140:143], v[220:223], a[76:79], v[140:143]
 s_waitcnt lgkmcnt(0) vmcnt(33)
 v_mfma_f32_16x16x32_bf16 v[64:67], v[144:147], a[80:83], v[64:67]
 ds_read_b64_tr_b16 v[184:185], v16 offset:51200
 ds_read_b64_tr_b16 v[186:187], v16 offset:52480
 v_mfma_f32_16x16x32_bf16 v[104:107], v[144:147], a[84:87], v[104:107]
 ds_read_b64_tr_b16 v[188:189], v17 offset:51232
 v_mfma_f32_16x16x32_bf16 v[68:71], v[148:151], a[80:83], v[68:71]
 ds_read_b64_tr_b16 v[190:191], v17 offset:52512
 v_mfma_f32_16x16x32_bf16 v[108:111], v[148:151], a[84:87], v[108:111]
 ds_read_b64_tr_b16 v[192:193], v16 offset:51264
 v_mfma_f32_16x16x32_bf16 v[72:75], v[152:155], a[80:83], v[72:75]
 ds_read_b64_tr_b16 v[194:195], v16 offset:52544
 v_mfma_f32_16x16x32_bf16 v[112:115], v[152:155], a[84:87], v[112:115]
 ds_read_b64_tr_b16 v[196:197], v17 offset:51296
 ds_read_b64_tr_b16 v[198:199], v17 offset:52576
 v_mfma_f32_16x16x32_bf16 v[76:79], v[156:159], a[80:83], v[76:79]
 ds_read_b64_tr_b16 v[200:201], v16 offset:51328
 v_mfma_f32_16x16x32_bf16 v[116:119], v[156:159], a[84:87], v[116:119]
 ds_read_b64_tr_b16 v[202:203], v16 offset:52608
 v_mfma_f32_16x16x32_bf16 v[80:83], v[160:163], a[80:83], v[80:83]
 ds_read_b64_tr_b16 v[204:205], v17 offset:51360
 v_mfma_f32_16x16x32_bf16 v[120:123], v[160:163], a[84:87], v[120:123]
 ds_read_b64_tr_b16 v[206:207], v17 offset:52640
 v_mfma_f32_16x16x32_bf16 v[84:87], v[164:167], a[80:83], v[84:87]
 ds_read_b64_tr_b16 v[208:209], v16 offset:51392
 v_mfma_f32_16x16x32_bf16 v[124:127], v[164:167], a[84:87], v[124:127]
 ds_read_b64_tr_b16 v[210:211], v16 offset:52672
 ds_read_b64_tr_b16 v[212:213], v17 offset:51424
 v_mfma_f32_16x16x32_bf16 v[88:91], v[168:171], a[80:83], v[88:91]
 ds_read_b64_tr_b16 v[214:215], v17 offset:52704
 v_mfma_f32_16x16x32_bf16 v[128:131], v[168:171], a[84:87], v[128:131]
 ds_read_b64_tr_b16 v[216:217], v16 offset:51456
 v_mfma_f32_16x16x32_bf16 v[92:95], v[172:175], a[80:83], v[92:95]
 ds_read_b64_tr_b16 v[218:219], v16 offset:52736
 v_mfma_f32_16x16x32_bf16 v[132:135], v[172:175], a[84:87], v[132:135]
 ds_read_b64_tr_b16 v[220:221], v17 offset:51488
 v_mfma_f32_16x16x32_bf16 v[96:99], v[176:179], a[80:83], v[96:99]
 ds_read_b64_tr_b16 v[222:223], v17 offset:52768
 v_mfma_f32_16x16x32_bf16 v[136:139], v[176:179], a[84:87], v[136:139]
 v_mfma_f32_16x16x32_bf16 v[100:103], v[180:183], a[80:83], v[100:103]
 v_mfma_f32_16x16x32_bf16 v[140:143], v[180:183], a[84:87], v[140:143]
 s_waitcnt lgkmcnt(0) vmcnt(26)
 s_barrier
 v_mfma_f32_16x16x32_bf16 v[64:67], v[184:187], a[88:91], v[64:67]
 ds_read_b64_tr_b16 v[144:145], v18 offset:0
 ds_read_b64_tr_b16 v[146:147], v18 offset:1280
 v_mfma_f32_16x16x32_bf16 v[104:107], v[184:187], a[92:95], v[104:107]
 ds_read_b64_tr_b16 v[148:149], v19 offset:32
 v_mfma_f32_16x16x32_bf16 v[68:71], v[188:191], a[88:91], v[68:71]
 ds_read_b64_tr_b16 v[150:151], v19 offset:1312
 v_mfma_f32_16x16x32_bf16 v[108:111], v[188:191], a[92:95], v[108:111]
 ds_read_b64_tr_b16 v[152:153], v18 offset:64
 v_mfma_f32_16x16x32_bf16 v[72:75], v[192:195], a[88:91], v[72:75]
 ds_read_b64_tr_b16 v[154:155], v18 offset:1344
 v_mfma_f32_16x16x32_bf16 v[112:115], v[192:195], a[92:95], v[112:115]
 ds_read_b64_tr_b16 v[156:157], v19 offset:96
 ds_read_b64_tr_b16 v[158:159], v19 offset:1376
 v_mfma_f32_16x16x32_bf16 v[76:79], v[196:199], a[88:91], v[76:79]
 ds_read_b64_tr_b16 v[160:161], v18 offset:128
 v_mfma_f32_16x16x32_bf16 v[116:119], v[196:199], a[92:95], v[116:119]
 ds_read_b64_tr_b16 v[162:163], v18 offset:1408
 v_mfma_f32_16x16x32_bf16 v[80:83], v[200:203], a[88:91], v[80:83]
 ds_read_b64_tr_b16 v[164:165], v19 offset:160
 v_mfma_f32_16x16x32_bf16 v[120:123], v[200:203], a[92:95], v[120:123]
 ds_read_b64_tr_b16 v[166:167], v19 offset:1440
 v_mfma_f32_16x16x32_bf16 v[84:87], v[204:207], a[88:91], v[84:87]
 ds_read_b64_tr_b16 v[168:169], v18 offset:192
 v_mfma_f32_16x16x32_bf16 v[124:127], v[204:207], a[92:95], v[124:127]
 ds_read_b64_tr_b16 v[170:171], v18 offset:1472
 ds_read_b64_tr_b16 v[172:173], v19 offset:224
 v_mfma_f32_16x16x32_bf16 v[88:91], v[208:211], a[88:91], v[88:91]
 ds_read_b64_tr_b16 v[174:175], v19 offset:1504
 v_mfma_f32_16x16x32_bf16 v[128:131], v[208:211], a[92:95], v[128:131]
 ds_read_b64_tr_b16 v[176:177], v18 offset:256
 v_mfma_f32_16x16x32_bf16 v[92:95], v[212:215], a[88:91], v[92:95]
 ds_read_b64_tr_b16 v[178:179], v18 offset:1536
 v_mfma_f32_16x16x32_bf16 v[132:135], v[212:215], a[92:95], v[132:135]
 ds_read_b64_tr_b16 v[180:181], v19 offset:288
 v_mfma_f32_16x16x32_bf16 v[96:99], v[216:219], a[88:91], v[96:99]
 ds_read_b64_tr_b16 v[182:183], v19 offset:1568
 v_mfma_f32_16x16x32_bf16 v[136:139], v[216:219], a[92:95], v[136:139]
 v_mfma_f32_16x16x32_bf16 v[100:103], v[220:223], a[88:91], v[100:103]
 v_mfma_f32_16x16x32_bf16 v[140:143], v[220:223], a[92:95], v[140:143]
 s_waitcnt lgkmcnt(0) vmcnt(24)
 v_mfma_f32_16x16x32_bf16 v[64:67], v[144:147], a[96:99], v[64:67]
 ds_read_b64_tr_b16 v[184:185], v18 offset:10240
 ds_read_b64_tr_b16 v[186:187], v18 offset:11520
 v_mfma_f32_16x16x32_bf16 v[104:107], v[144:147], a[100:103], v[104:107]
 ds_read_b64_tr_b16 v[188:189], v19 offset:10272
 v_mfma_f32_16x16x32_bf16 v[68:71], v[148:151], a[96:99], v[68:71]
 ds_read_b64_tr_b16 v[190:191], v19 offset:11552
 v_mfma_f32_16x16x32_bf16 v[108:111], v[148:151], a[100:103], v[108:111]
 ds_read_b64_tr_b16 v[192:193], v18 offset:10304
 v_mfma_f32_16x16x32_bf16 v[72:75], v[152:155], a[96:99], v[72:75]
 ds_read_b64_tr_b16 v[194:195], v18 offset:11584
 v_mfma_f32_16x16x32_bf16 v[112:115], v[152:155], a[100:103], v[112:115]
 ds_read_b64_tr_b16 v[196:197], v19 offset:10336
 ds_read_b64_tr_b16 v[198:199], v19 offset:11616
 v_mfma_f32_16x16x32_bf16 v[76:79], v[156:159], a[96:99], v[76:79]
 ds_read_b64_tr_b16 v[200:201], v18 offset:10368
 v_mfma_f32_16x16x32_bf16 v[116:119], v[156:159], a[100:103], v[116:119]
 ds_read_b64_tr_b16 v[202:203], v18 offset:11648
 v_mfma_f32_16x16x32_bf16 v[80:83], v[160:163], a[96:99], v[80:83]
 ds_read_b64_tr_b16 v[204:205], v19 offset:10400
 v_mfma_f32_16x16x32_bf16 v[120:123], v[160:163], a[100:103], v[120:123]
 ds_read_b64_tr_b16 v[206:207], v19 offset:11680
 v_mfma_f32_16x16x32_bf16 v[84:87], v[164:167], a[96:99], v[84:87]
 ds_read_b64_tr_b16 v[208:209], v18 offset:10432
 v_mfma_f32_16x16x32_bf16 v[124:127], v[164:167], a[100:103], v[124:127]
 ds_read_b64_tr_b16 v[210:211], v18 offset:11712
 ds_read_b64_tr_b16 v[212:213], v19 offset:10464
 v_mfma_f32_16x16x32_bf16 v[88:91], v[168:171], a[96:99], v[88:91]
 ds_read_b64_tr_b16 v[214:215], v19 offset:11744
 v_mfma_f32_16x16x32_bf16 v[128:131], v[168:171], a[100:103], v[128:131]
 ds_read_b64_tr_b16 v[216:217], v18 offset:10496
 v_mfma_f32_16x16x32_bf16 v[92:95], v[172:175], a[96:99], v[92:95]
 ds_read_b64_tr_b16 v[218:219], v18 offset:11776
 v_mfma_f32_16x16x32_bf16 v[132:135], v[172:175], a[100:103], v[132:135]
 ds_read_b64_tr_b16 v[220:221], v19 offset:10528
 v_mfma_f32_16x16x32_bf16 v[96:99], v[176:179], a[96:99], v[96:99]
 ds_read_b64_tr_b16 v[222:223], v19 offset:11808
 v_mfma_f32_16x16x32_bf16 v[136:139], v[176:179], a[100:103], v[136:139]
 v_mfma_f32_16x16x32_bf16 v[100:103], v[180:183], a[96:99], v[100:103]
 v_mfma_f32_16x16x32_bf16 v[140:143], v[180:183], a[100:103], v[140:143]
 s_waitcnt lgkmcnt(0) vmcnt(17)
 s_barrier
 v_mfma_f32_16x16x32_bf16 v[64:67], v[184:187], a[104:107], v[64:67]
 ds_read_b64_tr_b16 v[144:145], v14 offset:0
 ds_read_b64_tr_b16 v[146:147], v14 offset:1280
 v_mfma_f32_16x16x32_bf16 v[104:107], v[184:187], a[108:111], v[104:107]
 ds_read_b64_tr_b16 v[148:149], v15 offset:32
 v_mfma_f32_16x16x32_bf16 v[68:71], v[188:191], a[104:107], v[68:71]
 ds_read_b64_tr_b16 v[150:151], v15 offset:1312
 v_mfma_f32_16x16x32_bf16 v[108:111], v[188:191], a[108:111], v[108:111]
 ds_read_b64_tr_b16 v[152:153], v14 offset:64
 v_mfma_f32_16x16x32_bf16 v[72:75], v[192:195], a[104:107], v[72:75]
 ds_read_b64_tr_b16 v[154:155], v14 offset:1344
 v_mfma_f32_16x16x32_bf16 v[112:115], v[192:195], a[108:111], v[112:115]
 ds_read_b64_tr_b16 v[156:157], v15 offset:96
 ds_read_b64_tr_b16 v[158:159], v15 offset:1376
 v_mfma_f32_16x16x32_bf16 v[76:79], v[196:199], a[104:107], v[76:79]
 ds_read_b64_tr_b16 v[160:161], v14 offset:128
 v_mfma_f32_16x16x32_bf16 v[116:119], v[196:199], a[108:111], v[116:119]
 ds_read_b64_tr_b16 v[162:163], v14 offset:1408
 v_mfma_f32_16x16x32_bf16 v[80:83], v[200:203], a[104:107], v[80:83]
 ds_read_b64_tr_b16 v[164:165], v15 offset:160
 v_mfma_f32_16x16x32_bf16 v[120:123], v[200:203], a[108:111], v[120:123]
 ds_read_b64_tr_b16 v[166:167], v15 offset:1440
 v_mfma_f32_16x16x32_bf16 v[84:87], v[204:207], a[104:107], v[84:87]
 ds_read_b64_tr_b16 v[168:169], v14 offset:192
 v_mfma_f32_16x16x32_bf16 v[124:127], v[204:207], a[108:111], v[124:127]
 ds_read_b64_tr_b16 v[170:171], v14 offset:1472
 ds_read_b64_tr_b16 v[172:173], v15 offset:224
 v_mfma_f32_16x16x32_bf16 v[88:91], v[208:211], a[104:107], v[88:91]
 ds_read_b64_tr_b16 v[174:175], v15 offset:1504
 v_mfma_f32_16x16x32_bf16 v[128:131], v[208:211], a[108:111], v[128:131]
 ds_read_b64_tr_b16 v[176:177], v14 offset:256
 v_mfma_f32_16x16x32_bf16 v[92:95], v[212:215], a[104:107], v[92:95]
 ds_read_b64_tr_b16 v[178:179], v14 offset:1536
 v_mfma_f32_16x16x32_bf16 v[132:135], v[212:215], a[108:111], v[132:135]
 ds_read_b64_tr_b16 v[180:181], v15 offset:288
 v_mfma_f32_16x16x32_bf16 v[96:99], v[216:219], a[104:107], v[96:99]
 ds_read_b64_tr_b16 v[182:183], v15 offset:1568
 v_mfma_f32_16x16x32_bf16 v[136:139], v[216:219], a[108:111], v[136:139]
 v_mfma_f32_16x16x32_bf16 v[100:103], v[220:223], a[104:107], v[100:103]
 v_mfma_f32_16x16x32_bf16 v[140:143], v[220:223], a[108:111], v[140:143]
 s_waitcnt lgkmcnt(0) vmcnt(15)
 v_mfma_f32_16x16x32_bf16 v[64:67], v[144:147], a[112:115], v[64:67]
 ds_read_b64_tr_b16 v[184:185], v14 offset:10240
 ds_read_b64_tr_b16 v[186:187], v14 offset:11520
 v_mfma_f32_16x16x32_bf16 v[104:107], v[144:147], a[116:119], v[104:107]
 ds_read_b64_tr_b16 v[188:189], v15 offset:10272
 v_mfma_f32_16x16x32_bf16 v[68:71], v[148:151], a[112:115], v[68:71]
 ds_read_b64_tr_b16 v[190:191], v15 offset:11552
 v_mfma_f32_16x16x32_bf16 v[108:111], v[148:151], a[116:119], v[108:111]
 ds_read_b64_tr_b16 v[192:193], v14 offset:10304
 v_mfma_f32_16x16x32_bf16 v[72:75], v[152:155], a[112:115], v[72:75]
 ds_read_b64_tr_b16 v[194:195], v14 offset:11584
 v_mfma_f32_16x16x32_bf16 v[112:115], v[152:155], a[116:119], v[112:115]
 ds_read_b64_tr_b16 v[196:197], v15 offset:10336
 ds_read_b64_tr_b16 v[198:199], v15 offset:11616
 v_mfma_f32_16x16x32_bf16 v[76:79], v[156:159], a[112:115], v[76:79]
 ds_read_b64_tr_b16 v[200:201], v14 offset:10368
 v_mfma_f32_16x16x32_bf16 v[116:119], v[156:159], a[116:119], v[116:119]
 ds_read_b64_tr_b16 v[202:203], v14 offset:11648
 v_mfma_f32_16x16x32_bf16 v[80:83], v[160:163], a[112:115], v[80:83]
 ds_read_b64_tr_b16 v[204:205], v15 offset:10400
 v_mfma_f32_16x16x32_bf16 v[120:123], v[160:163], a[116:119], v[120:123]
 ds_read_b64_tr_b16 v[206:207], v15 offset:11680
 v_mfma_f32_16x16x32_bf16 v[84:87], v[164:167], a[112:115], v[84:87]
 ds_read_b64_tr_b16 v[208:209], v14 offset:10432
 v_mfma_f32_16x16x32_bf16 v[124:127], v[164:167], a[116:119], v[124:127]
 ds_read_b64_tr_b16 v[210:211], v14 offset:11712
 ds_read_b64_tr_b16 v[212:213], v15 offset:10464
 v_mfma_f32_16x16x32_bf16 v[88:91], v[168:171], a[112:115], v[88:91]
 ds_read_b64_tr_b16 v[214:215], v15 offset:11744
 v_mfma_f32_16x16x32_bf16 v[128:131], v[168:171], a[116:119], v[128:131]
 ds_read_b64_tr_b16 v[216:217], v14 offset:10496
 v_mfma_f32_16x16x32_bf16 v[92:95], v[172:175], a[112:115], v[92:95]
 ds_read_b64_tr_b16 v[218:219], v14 offset:11776
 v_mfma_f32_16x16x32_bf16 v[132:135], v[172:175], a[116:119], v[132:135]
 ds_read_b64_tr_b16 v[220:221], v15 offset:10528
 v_mfma_f32_16x16x32_bf16 v[96:99], v[176:179], a[112:115], v[96:99]
 ds_read_b64_tr_b16 v[222:223], v15 offset:11808
 v_mfma_f32_16x16x32_bf16 v[136:139], v[176:179], a[116:119], v[136:139]
 v_mfma_f32_16x16x32_bf16 v[100:103], v[180:183], a[112:115], v[100:103]
 v_mfma_f32_16x16x32_bf16 v[140:143], v[180:183], a[116:119], v[140:143]
 s_waitcnt lgkmcnt(0) vmcnt(8)
 s_barrier
 v_mfma_f32_16x16x32_bf16 v[64:67], v[184:187], a[120:123], v[64:67]
 ds_read_b64_tr_b16 v[144:145], v14 offset:20480
 ds_read_b64_tr_b16 v[146:147], v14 offset:21760
 v_mfma_f32_16x16x32_bf16 v[104:107], v[184:187], a[124:127], v[104:107]
 ds_read_b64_tr_b16 v[148:149], v15 offset:20512
 v_mfma_f32_16x16x32_bf16 v[68:71], v[188:191], a[120:123], v[68:71]
 ds_read_b64_tr_b16 v[150:151], v15 offset:21792
 v_mfma_f32_16x16x32_bf16 v[108:111], v[188:191], a[124:127], v[108:111]
 ds_read_b64_tr_b16 v[152:153], v14 offset:20544
 v_mfma_f32_16x16x32_bf16 v[72:75], v[192:195], a[120:123], v[72:75]
 ds_read_b64_tr_b16 v[154:155], v14 offset:21824
 v_mfma_f32_16x16x32_bf16 v[112:115], v[192:195], a[124:127], v[112:115]
 ds_read_b64_tr_b16 v[156:157], v15 offset:20576
 ds_read_b64_tr_b16 v[158:159], v15 offset:21856
 v_mfma_f32_16x16x32_bf16 v[76:79], v[196:199], a[120:123], v[76:79]
 ds_read_b64_tr_b16 v[160:161], v14 offset:20608
 v_mfma_f32_16x16x32_bf16 v[116:119], v[196:199], a[124:127], v[116:119]
 ds_read_b64_tr_b16 v[162:163], v14 offset:21888
 v_mfma_f32_16x16x32_bf16 v[80:83], v[200:203], a[120:123], v[80:83]
 ds_read_b64_tr_b16 v[164:165], v15 offset:20640
 v_mfma_f32_16x16x32_bf16 v[120:123], v[200:203], a[124:127], v[120:123]
 ds_read_b64_tr_b16 v[166:167], v15 offset:21920
 v_mfma_f32_16x16x32_bf16 v[84:87], v[204:207], a[120:123], v[84:87]
 ds_read_b64_tr_b16 v[168:169], v14 offset:20672
 v_mfma_f32_16x16x32_bf16 v[124:127], v[204:207], a[124:127], v[124:127]
 ds_read_b64_tr_b16 v[170:171], v14 offset:21952
 ds_read_b64_tr_b16 v[172:173], v15 offset:20704
 v_mfma_f32_16x16x32_bf16 v[88:91], v[208:211], a[120:123], v[88:91]
 ds_read_b64_tr_b16 v[174:175], v15 offset:21984
 v_mfma_f32_16x16x32_bf16 v[128:131], v[208:211], a[124:127], v[128:131]
 ds_read_b64_tr_b16 v[176:177], v14 offset:20736
 v_mfma_f32_16x16x32_bf16 v[92:95], v[212:215], a[120:123], v[92:95]
 ds_read_b64_tr_b16 v[178:179], v14 offset:22016
 v_mfma_f32_16x16x32_bf16 v[132:135], v[212:215], a[124:127], v[132:135]
 ds_read_b64_tr_b16 v[180:181], v15 offset:20768
 v_mfma_f32_16x16x32_bf16 v[96:99], v[216:219], a[120:123], v[96:99]
 ds_read_b64_tr_b16 v[182:183], v15 offset:22048
 v_mfma_f32_16x16x32_bf16 v[136:139], v[216:219], a[124:127], v[136:139]
 v_mfma_f32_16x16x32_bf16 v[100:103], v[220:223], a[120:123], v[100:103]
 v_mfma_f32_16x16x32_bf16 v[140:143], v[220:223], a[124:127], v[140:143]
 s_waitcnt lgkmcnt(0) vmcnt(6)
 v_mfma_f32_16x16x32_bf16 v[64:67], v[144:147], a[128:131], v[64:67]
 ds_read_b64_tr_b16 v[184:185], v14 offset:30720
 ds_read_b64_tr_b16 v[186:187], v14 offset:32000
 v_mfma_f32_16x16x32_bf16 v[104:107], v[144:147], a[132:135], v[104:107]
 ds_read_b64_tr_b16 v[188:189], v15 offset:30752
 v_mfma_f32_16x16x32_bf16 v[68:71], v[148:151], a[128:131], v[68:71]
 ds_read_b64_tr_b16 v[190:191], v15 offset:32032
 v_mfma_f32_16x16x32_bf16 v[108:111], v[148:151], a[132:135], v[108:111]
 ds_read_b64_tr_b16 v[192:193], v14 offset:30784
 v_mfma_f32_16x16x32_bf16 v[72:75], v[152:155], a[128:131], v[72:75]
 ds_read_b64_tr_b16 v[194:195], v14 offset:32064
 v_mfma_f32_16x16x32_bf16 v[112:115], v[152:155], a[132:135], v[112:115]
 ds_read_b64_tr_b16 v[196:197], v15 offset:30816
 ds_read_b64_tr_b16 v[198:199], v15 offset:32096
 v_mfma_f32_16x16x32_bf16 v[76:79], v[156:159], a[128:131], v[76:79]
 ds_read_b64_tr_b16 v[200:201], v14 offset:30848
 v_mfma_f32_16x16x32_bf16 v[116:119], v[156:159], a[132:135], v[116:119]
 ds_read_b64_tr_b16 v[202:203], v14 offset:32128
 v_mfma_f32_16x16x32_bf16 v[80:83], v[160:163], a[128:131], v[80:83]
 ds_read_b64_tr_b16 v[204:205], v15 offset:30880
 v_mfma_f32_16x16x32_bf16 v[120:123], v[160:163], a[132:135], v[120:123]
 ds_read_b64_tr_b16 v[206:207], v15 offset:32160
 v_mfma_f32_16x16x32_bf16 v[84:87], v[164:167], a[128:131], v[84:87]
 ds_read_b64_tr_b16 v[208:209], v14 offset:30912
 v_mfma_f32_16x16x32_bf16 v[124:127], v[164:167], a[132:135], v[124:127]
 ds_read_b64_tr_b16 v[210:211], v14 offset:32192
 ds_read_b64_tr_b16 v[212:213], v15 offset:30944
 v_mfma_f32_16x16x32_bf16 v[88:91], v[168:171], a[128:131], v[88:91]
 ds_read_b64_tr_b16 v[214:215], v15 offset:32224
 v_mfma_f32_16x16x32_bf16 v[128:131], v[168:171], a[132:135], v[128:131]
 ds_read_b64_tr_b16 v[216:217], v14 offset:30976
 v_mfma_f32_16x16x32_bf16 v[92:95], v[172:175], a[128:131], v[92:95]
 ds_read_b64_tr_b16 v[218:219], v14 offset:32256
 v_mfma_f32_16x16x32_bf16 v[132:135], v[172:175], a[132:135], v[132:135]
 ds_read_b64_tr_b16 v[220:221], v15 offset:31008
 v_mfma_f32_16x16x32_bf16 v[96:99], v[176:179], a[128:131], v[96:99]
 ds_read_b64_tr_b16 v[222:223], v15 offset:32288
 v_mfma_f32_16x16x32_bf16 v[136:139], v[176:179], a[132:135], v[136:139]
 v_mfma_f32_16x16x32_bf16 v[100:103], v[180:183], a[128:131], v[100:103]
 v_mfma_f32_16x16x32_bf16 v[140:143], v[180:183], a[132:135], v[140:143]
 s_waitcnt lgkmcnt(0) vmcnt(4)
 s_barrier
 v_mfma_f32_16x16x32_bf16 v[64:67], v[184:187], a[136:139], v[64:67]
 ds_read_b64_tr_b16 v[144:145], v14 offset:40960
 ds_read_b64_tr_b16 v[146:147], v14 offset:42240
 v_mfma_f32_16x16x32_bf16 v[104:107], v[184:187], a[140:143], v[104:107]
 ds_read_b64_tr_b16 v[148:149], v15 offset:40992
 v_mfma_f32_16x16x32_bf16 v[68:71], v[188:191], a[136:139], v[68:71]
 ds_read_b64_tr_b16 v[150:151], v15 offset:42272
 v_mfma_f32_16x16x32_bf16 v[108:111], v[188:191], a[140:143], v[108:111]
 ds_read_b64_tr_b16 v[152:153], v14 offset:41024
 v_mfma_f32_16x16x32_bf16 v[72:75], v[192:195], a[136:139], v[72:75]
 ds_read_b64_tr_b16 v[154:155], v14 offset:42304
 v_mfma_f32_16x16x32_bf16 v[112:115], v[192:195], a[140:143], v[112:115]
 ds_read_b64_tr_b16 v[156:157], v15 offset:41056
 ds_read_b64_tr_b16 v[158:159], v15 offset:42336
 v_mfma_f32_16x16x32_bf16 v[76:79], v[196:199], a[136:139], v[76:79]
 ds_read_b64_tr_b16 v[160:161], v14 offset:41088
 v_mfma_f32_16x16x32_bf16 v[116:119], v[196:199], a[140:143], v[116:119]
 ds_read_b64_tr_b16 v[162:163], v14 offset:42368
 v_mfma_f32_16x16x32_bf16 v[80:83], v[200:203], a[136:139], v[80:83]
 ds_read_b64_tr_b16 v[164:165], v15 offset:41120
 v_mfma_f32_16x16x32_bf16 v[120:123], v[200:203], a[140:143], v[120:123]
 ds_read_b64_tr_b16 v[166:167], v15 offset:42400
 v_mfma_f32_16x16x32_bf16 v[84:87], v[204:207], a[136:139], v[84:87]
 ds_read_b64_tr_b16 v[168:169], v14 offset:41152
 v_mfma_f32_16x16x32_bf16 v[124:127], v[204:207], a[140:143], v[124:127]
 ds_read_b64_tr_b16 v[170:171], v14 offset:42432
 ds_read_b64_tr_b16 v[172:173], v15 offset:41184
 v_mfma_f32_16x16x32_bf16 v[88:91], v[208:211], a[136:139], v[88:91]
 ds_read_b64_tr_b16 v[174:175], v15 offset:42464
 v_mfma_f32_16x16x32_bf16 v[128:131], v[208:211], a[140:143], v[128:131]
 ds_read_b64_tr_b16 v[176:177], v14 offset:41216
 v_mfma_f32_16x16x32_bf16 v[92:95], v[212:215], a[136:139], v[92:95]
 ds_read_b64_tr_b16 v[178:179], v14 offset:42496
 v_mfma_f32_16x16x32_bf16 v[132:135], v[212:215], a[140:143], v[132:135]
 ds_read_b64_tr_b16 v[180:181], v15 offset:41248
 v_mfma_f32_16x16x32_bf16 v[96:99], v[216:219], a[136:139], v[96:99]
 ds_read_b64_tr_b16 v[182:183], v15 offset:42528
 v_mfma_f32_16x16x32_bf16 v[136:139], v[216:219], a[140:143], v[136:139]
 v_mfma_f32_16x16x32_bf16 v[100:103], v[220:223], a[136:139], v[100:103]
 v_mfma_f32_16x16x32_bf16 v[140:143], v[220:223], a[140:143], v[140:143]
 s_waitcnt lgkmcnt(0) vmcnt(2)
 v_mfma_f32_16x16x32_bf16 v[64:67], v[144:147], a[144:147], v[64:67]
 ds_read_b64_tr_b16 v[184:185], v14 offset:51200
 ds_read_b64_tr_b16 v[186:187], v14 offset:52480
 v_mfma_f32_16x16x32_bf16 v[104:107], v[144:147], a[148:151], v[104:107]
 ds_read_b64_tr_b16 v[188:189], v15 offset:51232
 v_mfma_f32_16x16x32_bf16 v[68:71], v[148:151], a[144:147], v[68:71]
 ds_read_b64_tr_b16 v[190:191], v15 offset:52512
 v_mfma_f32_16x16x32_bf16 v[108:111], v[148:151], a[148:151], v[108:111]
 ds_read_b64_tr_b16 v[192:193], v14 offset:51264
 v_mfma_f32_16x16x32_bf16 v[72:75], v[152:155], a[144:147], v[72:75]
 ds_read_b64_tr_b16 v[194:195], v14 offset:52544
 v_mfma_f32_16x16x32_bf16 v[112:115], v[152:155], a[148:151], v[112:115]
 ds_read_b64_tr_b16 v[196:197], v15 offset:51296
 ds_read_b64_tr_b16 v[198:199], v15 offset:52576
 v_mfma_f32_16x16x32_bf16 v[76:79], v[156:159], a[144:147], v[76:79]
 ds_read_b64_tr_b16 v[200:201], v14 offset:51328
 v_mfma_f32_16x16x32_bf16 v[116:119], v[156:159], a[148:151], v[116:119]
 ds_read_b64_tr_b16 v[202:203], v14 offset:52608
 v_mfma_f32_16x16x32_bf16 v[80:83], v[160:163], a[144:147], v[80:83]
 ds_read_b64_tr_b16 v[204:205], v15 offset:51360
 v_mfma_f32_16x16x32_bf16 v[120:123], v[160:163], a[148:151], v[120:123]
 ds_read_b64_tr_b16 v[206:207], v15 offset:52640
 v_mfma_f32_16x16x32_bf16 v[84:87], v[164:167], a[144:147], v[84:87]
 ds_read_b64_tr_b16 v[208:209], v14 offset:51392
 v_mfma_f32_16x16x32_bf16 v[124:127], v[164:167], a[148:151], v[124:127]
 ds_read_b64_tr_b16 v[210:211], v14 offset:52672
 ds_read_b64_tr_b16 v[212:213], v15 offset:51424
 v_mfma_f32_16x16x32_bf16 v[88:91], v[168:171], a[144:147], v[88:91]
 ds_read_b64_tr_b16 v[214:215], v15 offset:52704
 v_mfma_f32_16x16x32_bf16 v[128:131], v[168:171], a[148:151], v[128:131]
 ds_read_b64_tr_b16 v[216:217], v14 offset:51456
 v_mfma_f32_16x16x32_bf16 v[92:95], v[172:175], a[144:147], v[92:95]
 ds_read_b64_tr_b16 v[218:219], v14 offset:52736
 v_mfma_f32_16x16x32_bf16 v[132:135], v[172:175], a[148:151], v[132:135]
 ds_read_b64_tr_b16 v[220:221], v15 offset:51488
 v_mfma_f32_16x16x32_bf16 v[96:99], v[176:179], a[144:147], v[96:99]
 ds_read_b64_tr_b16 v[222:223], v15 offset:52768
 v_mfma_f32_16x16x32_bf16 v[136:139], v[176:179], a[148:151], v[136:139]
 v_mfma_f32_16x16x32_bf16 v[100:103], v[180:183], a[144:147], v[100:103]
 v_mfma_f32_16x16x32_bf16 v[140:143], v[180:183], a[148:151], v[140:143]
 s_waitcnt lgkmcnt(0) vmcnt(0)
 v_mfma_f32_16x16x32_bf16 v[64:67], v[184:187], a[152:155], v[64:67]
 v_mfma_f32_16x16x32_bf16 v[104:107], v[184:187], a[156:159], v[104:107]
 v_mfma_f32_16x16x32_bf16 v[68:71], v[188:191], a[152:155], v[68:71]
 v_mfma_f32_16x16x32_bf16 v[108:111], v[188:191], a[156:159], v[108:111]
 v_mfma_f32_16x16x32_bf16 v[72:75], v[192:195], a[152:155], v[72:75]
 v_mfma_f32_16x16x32_bf16 v[112:115], v[192:195], a[156:159], v[112:115]
 v_mfma_f32_16x16x32_bf16 v[76:79], v[196:199], a[152:155], v[76:79]
 v_mfma_f32_16x16x32_bf16 v[116:119], v[196:199], a[156:159], v[116:119]
 v_mfma_f32_16x16x32_bf16 v[80:83], v[200:203], a[152:155], v[80:83]
 v_mfma_f32_16x16x32_bf16 v[120:123], v[200:203], a[156:159], v[120:123]
 v_mfma_f32_16x16x32_bf16 v[84:87], v[204:207], a[152:155], v[84:87]
 v_mfma_f32_16x16x32_bf16 v[124:127], v[204:207], a[156:159], v[124:127]
 v_mfma_f32_16x16x32_bf16 v[88:91], v[208:211], a[152:155], v[88:91]
 v_mfma_f32_16x16x32_bf16 v[128:131], v[208:211], a[156:159], v[128:131]
 v_mfma_f32_16x16x32_bf16 v[92:95], v[212:215], a[152:155], v[92:95]
 v_mfma_f32_16x16x32_bf16 v[132:135], v[212:215], a[156:159], v[132:135]
 v_mfma_f32_16x16x32_bf16 v[96:99], v[216:219], a[152:155], v[96:99]
 v_mfma_f32_16x16x32_bf16 v[136:139], v[216:219], a[156:159], v[136:139]
 v_mfma_f32_16x16x32_bf16 v[100:103], v[220:223], a[152:155], v[100:103]
 v_mfma_f32_16x16x32_bf16 v[140:143], v[220:223], a[156:159], v[140:143]
 s_add_u32 s16, s38, 180355072
 s_addc_u32 s17, s39, 0
 s_mov_b32 s18, 67108864
 s_mov_b32 s19, 0x00020000
 s_nop 3
 s_lshr_b32 s22, s47, 1
 s_lshl_b32 s21, s22, 12
 s_and_b32 s21, s21, 8192
 s_xor_b32 s21, s21, s37
 s_lshl_b32 s51, s22, 20
 s_or_b32 s51, s51, s21
 s_add_u32 s51, s51, 786432
 s_mul_i32 s53, s44, 5
 s_cmp_lt_u32 s2, 48
 s_cbranch_scc1 om_240
 s_add_u32 s21, s53, 0
 s_lshr_b32 s22, s21, 1
 s_lshl_b32 s22, s22, 14
 s_and_b32 s21, s21, 1
 s_lshl_b32 s21, s21, 11
 s_add_u32 s22, s22, s21
 s_add_u32 s22, s22, s51
 buffer_store_dwordx4 v[64:67], v4, s[16:19], s22 offen offset:0 sc1
 buffer_store_dwordx4 v[68:71], v4, s[16:19], s22 offen offset:1024 sc1
 s_add_u32 s21, s53, 1
 s_lshr_b32 s22, s21, 1
 s_lshl_b32 s22, s22, 14
 s_and_b32 s21, s21, 1
 s_lshl_b32 s21, s21, 11
 s_add_u32 s22, s22, s21
 s_add_u32 s22, s22, s51
 buffer_store_dwordx4 v[72:75], v4, s[16:19], s22 offen offset:0 sc1
 buffer_store_dwordx4 v[76:79], v4, s[16:19], s22 offen offset:1024 sc1
 s_add_u32 s21, s53, 2
 s_lshr_b32 s22, s21, 1
 s_lshl_b32 s22, s22, 14
 s_and_b32 s21, s21, 1
 s_lshl_b32 s21, s21, 11
 s_add_u32 s22, s22, s21
 s_add_u32 s22, s22, s51
 buffer_store_dwordx4 v[80:83], v4, s[16:19], s22 offen offset:0 sc1
 buffer_store_dwordx4 v[84:87], v4, s[16:19], s22 offen offset:1024 sc1
 s_add_u32 s21, s53, 3
 s_lshr_b32 s22, s21, 1
 s_lshl_b32 s22, s22, 14
 s_and_b32 s21, s21, 1
 s_lshl_b32 s21, s21, 11
 s_add_u32 s22, s22, s21
 s_add_u32 s22, s22, s51
 buffer_store_dwordx4 v[88:91], v4, s[16:19], s22 offen offset:0 sc1
 buffer_store_dwordx4 v[92:95], v4, s[16:19], s22 offen offset:1024 sc1
 s_add_u32 s21, s53, 4
 s_lshr_b32 s22, s21, 1
 s_lshl_b32 s22, s22, 14
 s_and_b32 s21, s21, 1
 s_lshl_b32 s21, s21, 11
 s_add_u32 s22, s22, s21
 s_add_u32 s22, s22, s51
 buffer_store_dwordx4 v[96:99], v4, s[16:19], s22 offen offset:0 sc1
 buffer_store_dwordx4 v[100:103], v4, s[16:19], s22 offen offset:1024 sc1
 s_add_u32 s21, s53, 0
 s_lshr_b32 s22, s21, 1
 s_lshl_b32 s22, s22, 14
 s_and_b32 s21, s21, 1
 s_lshl_b32 s21, s21, 11
 s_add_u32 s22, s22, s21
 s_add_u32 s22, s22, s51
 s_add_u32 s22, s22, 4096
 buffer_store_dwordx4 v[104:107], v4, s[16:19], s22 offen offset:0 sc1
 buffer_store_dwordx4 v[108:111], v4, s[16:19], s22 offen offset:1024 sc1
 s_add_u32 s21, s53, 1
 s_lshr_b32 s22, s21, 1
 s_lshl_b32 s22, s22, 14
 s_and_b32 s21, s21, 1
 s_lshl_b32 s21, s21, 11
 s_add_u32 s22, s22, s21
 s_add_u32 s22, s22, s51
 s_add_u32 s22, s22, 4096
 buffer_store_dwordx4 v[112:115], v4, s[16:19], s22 offen offset:0 sc1
 buffer_store_dwordx4 v[116:119], v4, s[16:19], s22 offen offset:1024 sc1
 s_add_u32 s21, s53, 2
 s_lshr_b32 s22, s21, 1
 s_lshl_b32 s22, s22, 14
 s_and_b32 s21, s21, 1
 s_lshl_b32 s21, s21, 11
 s_add_u32 s22, s22, s21
 s_add_u32 s22, s22, s51
 s_add_u32 s22, s22, 4096
 buffer_store_dwordx4 v[120:123], v4, s[16:19], s22 offen offset:0 sc1
 buffer_store_dwordx4 v[124:127], v4, s[16:19], s22 offen offset:1024 sc1
 s_add_u32 s21, s53, 3
 s_lshr_b32 s22, s21, 1
 s_lshl_b32 s22, s22, 14
 s_and_b32 s21, s21, 1
 s_lshl_b32 s21, s21, 11
 s_add_u32 s22, s22, s21
 s_add_u32 s22, s22, s51
 s_add_u32 s22, s22, 4096
 buffer_store_dwordx4 v[128:131], v4, s[16:19], s22 offen offset:0 sc1
 buffer_store_dwordx4 v[132:135], v4, s[16:19], s22 offen offset:1024 sc1
 s_add_u32 s21, s53, 4
 s_lshr_b32 s22, s21, 1
 s_lshl_b32 s22, s22, 14
 s_and_b32 s21, s21, 1
 s_lshl_b32 s21, s21, 11
 s_add_u32 s22, s22, s21
 s_add_u32 s22, s22, s51
 s_add_u32 s22, s22, 4096
 buffer_store_dwordx4 v[136:139], v4, s[16:19], s22 offen offset:0 sc1
 buffer_store_dwordx4 v[140:143], v4, s[16:19], s22 offen offset:1024 sc1
 s_waitcnt vmcnt(0)
 s_barrier
 s_lshr_b32 s21, s2, 2
 s_lshl_b32 s21, s21, 7
 s_add_u32 s21, s21, 93184
 s_cmp_lg_u32 s20, 0
 s_cbranch_scc1 af_242
 v_mov_b32 v10, 0
 v_mov_b32 v11, 1
 s_mov_b64 exec, 1
 buffer_atomic_add v11, v10, s[72:75], s21 offen sc1
 s_mov_b64 exec, -1
 s_nop 1
af_242:
 s_branch om_241
om_240:
 s_load_dwordx2 s[8:9], s[0:1], 88
 s_lshr_b32 s52, s2, 2
 s_lshl_b32 s52, s52, 7
 s_and_b32 s21, s52, 511
 s_add_u32 s21, s21, 94720
 s_cmp_lt_u32 s2, 32
 s_cselect_b32 s54, 32, 80
 s_add_u32 s21, s52, 116736
 s_cmp_lg_u32 s20, 0
 s_cbranch_scc1 wf_244
 v_mov_b32 v20, 0
 s_mov_b32 s101, 0
wf_243:
 buffer_load_dword v21, v20, s[72:75], s21 offen sc1
 s_add_u32 s101, s101, 1
 s_cmp_gt_u32 s101, 131072
 s_cbranch_scc1 main_end
 s_waitcnt vmcnt(0)
 v_readfirstlane_b32 s100, v21
 s_cmp_ge_u32 s100, s54
 s_cbranch_scc1 wf_244
 s_sleep 16
 s_branch wf_243
wf_244:
 s_barrier
 v_lshlrev_b32 v6, 2, v2
 s_lshl_b32 s22, s47, 6
 buffer_load_dword v30, v6, s[28:31], s22 offen sc1
 buffer_load_dword v31, v6, s[28:31], s22 offen offset:64 sc1
 s_add_u32 s21, s53, 0
 s_lshr_b32 s22, s21, 1
 s_lshl_b32 s22, s22, 14
 s_and_b32 s21, s21, 1
 s_lshl_b32 s21, s21, 11
 s_add_u32 s22, s22, s21
 s_add_u32 s22, s22, s51
 buffer_load_dwordx4 v[144:147], v4, s[16:19], s22 offen offset:0 sc1
 buffer_load_dwordx4 v[148:151], v4, s[16:19], s22 offen offset:1024 sc1
 s_add_u32 s21, s53, 1
 s_lshr_b32 s22, s21, 1
 s_lshl_b32 s22, s22, 14
 s_and_b32 s21, s21, 1
 s_lshl_b32 s21, s21, 11
 s_add_u32 s22, s22, s21
 s_add_u32 s22, s22, s51
 buffer_load_dwordx4 v[152:155], v4, s[16:19], s22 offen offset:0 sc1
 buffer_load_dwordx4 v[156:159], v4, s[16:19], s22 offen offset:1024 sc1
 s_add_u32 s21, s53, 2
 s_lshr_b32 s22, s21, 1
 s_lshl_b32 s22, s22, 14
 s_and_b32 s21, s21, 1
 s_lshl_b32 s21, s21, 11
 s_add_u32 s22, s22, s21
 s_add_u32 s22, s22, s51
 buffer_load_dwordx4 v[160:163], v4, s[16:19], s22 offen offset:0 sc1
 buffer_load_dwordx4 v[164:167], v4, s[16:19], s22 offen offset:1024 sc1
 s_add_u32 s21, s53, 3
 s_lshr_b32 s22, s21, 1
 s_lshl_b32 s22, s22, 14
 s_and_b32 s21, s21, 1
 s_lshl_b32 s21, s21, 11
 s_add_u32 s22, s22, s21
 s_add_u32 s22, s22, s51
 buffer_load_dwordx4 v[168:171], v4, s[16:19], s22 offen offset:0 sc1
 buffer_load_dwordx4 v[172:175], v4, s[16:19], s22 offen offset:1024 sc1
 s_add_u32 s21, s53, 4
 s_lshr_b32 s22, s21, 1
 s_lshl_b32 s22, s22, 14
 s_and_b32 s21, s21, 1
 s_lshl_b32 s21, s21, 11
 s_add_u32 s22, s22, s21
 s_add_u32 s22, s22, s51
 buffer_load_dwordx4 v[176:179], v4, s[16:19], s22 offen offset:0 sc1
 buffer_load_dwordx4 v[180:183], v4, s[16:19], s22 offen offset:1024 sc1
 s_add_u32 s21, s53, 0
 s_lshr_b32 s22, s21, 1
 s_lshl_b32 s22, s22, 14
 s_and_b32 s21, s21, 1
 s_lshl_b32 s21, s21, 11
 s_add_u32 s22, s22, s21
 s_add_u32 s22, s22, s51
 s_add_u32 s22, s22, 4096
 buffer_load_dwordx4 v[184:187], v4, s[16:19], s22 offen offset:0 sc1
 buffer_load_dwordx4 v[188:191], v4, s[16:19], s22 offen offset:1024 sc1
 s_add_u32 s21, s53, 1
 s_lshr_b32 s22, s21, 1
 s_lshl_b32 s22, s22, 14
 s_and_b32 s21, s21, 1
 s_lshl_b32 s21, s21, 11
 s_add_u32 s22, s22, s21
 s_add_u32 s22, s22, s51
 s_add_u32 s22, s22, 4096
 buffer_load_dwordx4 v[192:195], v4, s[16:19], s22 offen offset:0 sc1
 buffer_load_dwordx4 v[196:199], v4, s[16:19], s22 offen offset:1024 sc1
 s_add_u32 s21, s53, 2
 s_lshr_b32 s22, s21, 1
 s_lshl_b32 s22, s22, 14
 s_and_b32 s21, s21, 1
 s_lshl_b32 s21, s21, 11
 s_add_u32 s22, s22, s21
 s_add_u32 s22, s22, s51
 s_add_u32 s22, s22, 4096
 buffer_load_dwordx4 v[200:203], v4, s[16:19], s22 offen offset:0 sc1
 buffer_load_dwordx4 v[204:207], v4, s[16:19], s22 offen offset:1024 sc1
 s_add_u32 s21, s53, 3
 s_lshr_b32 s22, s21, 1
 s_lshl_b32 s22, s22, 14
 s_and_b32 s21, s21, 1
 s_lshl_b32 s21, s21, 11
 s_add_u32 s22, s22, s21
 s_add_u32 s22, s22, s51
 s_add_u32 s22, s22, 4096
 buffer_load_dwordx4 v[208:211], v4, s[16:19], s22 offen offset:0 sc1
 buffer_load_dwordx4 v[212:215], v4, s[16:19], s22 offen offset:1024 sc1
 s_add_u32 s21, s53, 4
 s_lshr_b32 s22, s21, 1
 s_lshl_b32 s22, s22, 14
 s_and_b32 s21, s21, 1
 s_lshl_b32 s21, s21, 11
 s_add_u32 s22, s22, s21
 s_add_u32 s22, s22, s51
 s_add_u32 s22, s22, 4096
 buffer_load_dwordx4 v[216:219], v4, s[16:19], s22 offen offset:0 sc1
 buffer_load_dwordx4 v[220:223], v4, s[16:19], s22 offen offset:1024 sc1
 v_mul_u32_u24 v9, 1280, v2
 v_lshl_add_u32 v9, v3, 3, v9
 s_mul_i32 s22, s47, 20480
 s_add_u32 s22, s22, s45
 s_add_u32 s23, s22, 20480
 s_waitcnt vmcnt(20) lgkmcnt(0)
 v_sub_f32 v32, 1.0, v30
 v_sub_f32 v33, 1.0, v31
 v_cvt_pk_bf16_f32 v26, v32, v33
 v_lshlrev_b32 v32, 16, v26
 v_and_b32 v33, 0xffff0000, v26
 v_cvt_pk_bf16_f32 v26, v64, v65
 v_lshlrev_b32 v64, 16, v26
 v_and_b32 v65, 0xffff0000, v26
 v_mul_f32 v64, v64, v32
 v_mul_f32 v65, v65, v32
 v_cvt_pk_bf16_f32 v26, v64, v65
 v_lshlrev_b32 v64, 16, v26
 v_and_b32 v65, 0xffff0000, v26
 v_cvt_pk_bf16_f32 v26, v66, v67
 v_lshlrev_b32 v66, 16, v26
 v_and_b32 v67, 0xffff0000, v26
 v_mul_f32 v66, v66, v32
 v_mul_f32 v67, v67, v32
 v_cvt_pk_bf16_f32 v26, v66, v67
 v_lshlrev_b32 v66, 16, v26
 v_and_b32 v67, 0xffff0000, v26
 v_cvt_pk_bf16_f32 v26, v68, v69
 v_lshlrev_b32 v68, 16, v26
 v_and_b32 v69, 0xffff0000, v26
 v_mul_f32 v68, v68, v32
 v_mul_f32 v69, v69, v32
 v_cvt_pk_bf16_f32 v26, v68, v69
 v_lshlrev_b32 v68, 16, v26
 v_and_b32 v69, 0xffff0000, v26
 v_cvt_pk_bf16_f32 v26, v70, v71
 v_lshlrev_b32 v70, 16, v26
 v_and_b32 v71, 0xffff0000, v26
 v_mul_f32 v70, v70, v32
 v_mul_f32 v71, v71, v32
 v_cvt_pk_bf16_f32 v26, v70, v71
 v_lshlrev_b32 v70, 16, v26
 v_and_b32 v71, 0xffff0000, v26
 v_cvt_pk_bf16_f32 v26, v72, v73
 v_lshlrev_b32 v72, 16, v26
 v_and_b32 v73, 0xffff0000, v26
 v_mul_f32 v72, v72, v32
 v_mul_f32 v73, v73, v32
 v_cvt_pk_bf16_f32 v26, v72, v73
 v_lshlrev_b32 v72, 16, v26
 v_and_b32 v73, 0xffff0000, v26
 v_cvt_pk_bf16_f32 v26, v74, v75
 v_lshlrev_b32 v74, 16, v26
 v_and_b32 v75, 0xffff0000, v26
 v_mul_f32 v74, v74, v32
 v_mul_f32 v75, v75, v32
 v_cvt_pk_bf16_f32 v26, v74, v75
 v_lshlrev_b32 v74, 16, v26
 v_and_b32 v75, 0xffff0000, v26
 v_cvt_pk_bf16_f32 v26, v76, v77
 v_lshlrev_b32 v76, 16, v26
 v_and_b32 v77, 0xffff0000, v26
 v_mul_f32 v76, v76, v32
 v_mul_f32 v77, v77, v32
 v_cvt_pk_bf16_f32 v26, v76, v77
 v_lshlrev_b32 v76, 16, v26
 v_and_b32 v77, 0xffff0000, v26
 v_cvt_pk_bf16_f32 v26, v78, v79
 v_lshlrev_b32 v78, 16, v26
 v_and_b32 v79, 0xffff0000, v26
 v_mul_f32 v78, v78, v32
 v_mul_f32 v79, v79, v32
 v_cvt_pk_bf16_f32 v26, v78, v79
 v_lshlrev_b32 v78, 16, v26
 v_and_b32 v79, 0xffff0000, v26
 v_cvt_pk_bf16_f32 v26, v80, v81
 v_lshlrev_b32 v80, 16, v26
 v_and_b32 v81, 0xffff0000, v26
 v_mul_f32 v80, v80, v32
 v_mul_f32 v81, v81, v32
 v_cvt_pk_bf16_f32 v26, v80, v81
 v_lshlrev_b32 v80, 16, v26
 v_and_b32 v81, 0xffff0000, v26
 v_cvt_pk_bf16_f32 v26, v82, v83
 v_lshlrev_b32 v82, 16, v26
 v_and_b32 v83, 0xffff0000, v26
 v_mul_f32 v82, v82, v32
 v_mul_f32 v83, v83, v32
 v_cvt_pk_bf16_f32 v26, v82, v83
 v_lshlrev_b32 v82, 16, v26
 v_and_b32 v83, 0xffff0000, v26
 v_cvt_pk_bf16_f32 v26, v84, v85
 v_lshlrev_b32 v84, 16, v26
 v_and_b32 v85, 0xffff0000, v26
 v_mul_f32 v84, v84, v32
 v_mul_f32 v85, v85, v32
 v_cvt_pk_bf16_f32 v26, v84, v85
 v_lshlrev_b32 v84, 16, v26
 v_and_b32 v85, 0xffff0000, v26
 v_cvt_pk_bf16_f32 v26, v86, v87
 v_lshlrev_b32 v86, 16, v26
 v_and_b32 v87, 0xffff0000, v26
 v_mul_f32 v86, v86, v32
 v_mul_f32 v87, v87, v32
 v_cvt_pk_bf16_f32 v26, v86, v87
 v_lshlrev_b32 v86, 16, v26
 v_and_b32 v87, 0xffff0000, v26
 v_cvt_pk_bf16_f32 v26, v88, v89
 v_lshlrev_b32 v88, 16, v26
 v_and_b32 v89, 0xffff0000, v26
 v_mul_f32 v88, v88, v32
 v_mul_f32 v89, v89, v32
 v_cvt_pk_bf16_f32 v26, v88, v89
 v_lshlrev_b32 v88, 16, v26
 v_and_b32 v89, 0xffff0000, v26
 v_cvt_pk_bf16_f32 v26, v90, v91
 v_lshlrev_b32 v90, 16, v26
 v_and_b32 v91, 0xffff0000, v26
 v_mul_f32 v90, v90, v32
 v_mul_f32 v91, v91, v32
 v_cvt_pk_bf16_f32 v26, v90, v91
 v_lshlrev_b32 v90, 16, v26
 v_and_b32 v91, 0xffff0000, v26
 v_cvt_pk_bf16_f32 v26, v92, v93
 v_lshlrev_b32 v92, 16, v26
 v_and_b32 v93, 0xffff0000, v26
 v_mul_f32 v92, v92, v32
 v_mul_f32 v93, v93, v32
 v_cvt_pk_bf16_f32 v26, v92, v93
 v_lshlrev_b32 v92, 16, v26
 v_and_b32 v93, 0xffff0000, v26
 v_cvt_pk_bf16_f32 v26, v94, v95
 v_lshlrev_b32 v94, 16, v26
 v_and_b32 v95, 0xffff0000, v26
 v_mul_f32 v94, v94, v32
 v_mul_f32 v95, v95, v32
 v_cvt_pk_bf16_f32 v26, v94, v95
 v_lshlrev_b32 v94, 16, v26
 v_and_b32 v95, 0xffff0000, v26
 v_cvt_pk_bf16_f32 v26, v96, v97
 v_lshlrev_b32 v96, 16, v26
 v_and_b32 v97, 0xffff0000, v26
 v_mul_f32 v96, v96, v32
 v_mul_f32 v97, v97, v32
 v_cvt_pk_bf16_f32 v26, v96, v97
 v_lshlrev_b32 v96, 16, v26
 v_and_b32 v97, 0xffff0000, v26
 v_cvt_pk_bf16_f32 v26, v98, v99
 v_lshlrev_b32 v98, 16, v26
 v_and_b32 v99, 0xffff0000, v26
 v_mul_f32 v98, v98, v32
 v_mul_f32 v99, v99, v32
 v_cvt_pk_bf16_f32 v26, v98, v99
 v_lshlrev_b32 v98, 16, v26
 v_and_b32 v99, 0xffff0000, v26
 v_cvt_pk_bf16_f32 v26, v100, v101
 v_lshlrev_b32 v100, 16, v26
 v_and_b32 v101, 0xffff0000, v26
 v_mul_f32 v100, v100, v32
 v_mul_f32 v101, v101, v32
 v_cvt_pk_bf16_f32 v26, v100, v101
 v_lshlrev_b32 v100, 16, v26
 v_and_b32 v101, 0xffff0000, v26
 v_cvt_pk_bf16_f32 v26, v102, v103
 v_lshlrev_b32 v102, 16, v26
 v_and_b32 v103, 0xffff0000, v26
 v_mul_f32 v102, v102, v32
 v_mul_f32 v103, v103, v32
 v_cvt_pk_bf16_f32 v26, v102, v103
 v_lshlrev_b32 v102, 16, v26
 v_and_b32 v103, 0xffff0000, v26
 v_cvt_pk_bf16_f32 v26, v104, v105
 v_lshlrev_b32 v104, 16, v26
 v_and_b32 v105, 0xffff0000, v26
 v_mul_f32 v104, v104, v33
 v_mul_f32 v105, v105, v33
 v_cvt_pk_bf16_f32 v26, v104, v105
 v_lshlrev_b32 v104, 16, v26
 v_and_b32 v105, 0xffff0000, v26
 v_cvt_pk_bf16_f32 v26, v106, v107
 v_lshlrev_b32 v106, 16, v26
 v_and_b32 v107, 0xffff0000, v26
 v_mul_f32 v106, v106, v33
 v_mul_f32 v107, v107, v33
 v_cvt_pk_bf16_f32 v26, v106, v107
 v_lshlrev_b32 v106, 16, v26
 v_and_b32 v107, 0xffff0000, v26
 v_cvt_pk_bf16_f32 v26, v108, v109
 v_lshlrev_b32 v108, 16, v26
 v_and_b32 v109, 0xffff0000, v26
 v_mul_f32 v108, v108, v33
 v_mul_f32 v109, v109, v33
 v_cvt_pk_bf16_f32 v26, v108, v109
 v_lshlrev_b32 v108, 16, v26
 v_and_b32 v109, 0xffff0000, v26
 v_cvt_pk_bf16_f32 v26, v110, v111
 v_lshlrev_b32 v110, 16, v26
 v_and_b32 v111, 0xffff0000, v26
 v_mul_f32 v110, v110, v33
 v_mul_f32 v111, v111, v33
 v_cvt_pk_bf16_f32 v26, v110, v111
 v_lshlrev_b32 v110, 16, v26
 v_and_b32 v111, 0xffff0000, v26
 v_cvt_pk_bf16_f32 v26, v112, v113
 v_lshlrev_b32 v112, 16, v26
 v_and_b32 v113, 0xffff0000, v26
 v_mul_f32 v112, v112, v33
 v_mul_f32 v113, v113, v33
 v_cvt_pk_bf16_f32 v26, v112, v113
 v_lshlrev_b32 v112, 16, v26
 v_and_b32 v113, 0xffff0000, v26
 v_cvt_pk_bf16_f32 v26, v114, v115
 v_lshlrev_b32 v114, 16, v26
 v_and_b32 v115, 0xffff0000, v26
 v_mul_f32 v114, v114, v33
 v_mul_f32 v115, v115, v33
 v_cvt_pk_bf16_f32 v26, v114, v115
 v_lshlrev_b32 v114, 16, v26
 v_and_b32 v115, 0xffff0000, v26
 v_cvt_pk_bf16_f32 v26, v116, v117
 v_lshlrev_b32 v116, 16, v26
 v_and_b32 v117, 0xffff0000, v26
 v_mul_f32 v116, v116, v33
 v_mul_f32 v117, v117, v33
 v_cvt_pk_bf16_f32 v26, v116, v117
 v_lshlrev_b32 v116, 16, v26
 v_and_b32 v117, 0xffff0000, v26
 v_cvt_pk_bf16_f32 v26, v118, v119
 v_lshlrev_b32 v118, 16, v26
 v_and_b32 v119, 0xffff0000, v26
 v_mul_f32 v118, v118, v33
 v_mul_f32 v119, v119, v33
 v_cvt_pk_bf16_f32 v26, v118, v119
 v_lshlrev_b32 v118, 16, v26
 v_and_b32 v119, 0xffff0000, v26
 v_cvt_pk_bf16_f32 v26, v120, v121
 v_lshlrev_b32 v120, 16, v26
 v_and_b32 v121, 0xffff0000, v26
 v_mul_f32 v120, v120, v33
 v_mul_f32 v121, v121, v33
 v_cvt_pk_bf16_f32 v26, v120, v121
 v_lshlrev_b32 v120, 16, v26
 v_and_b32 v121, 0xffff0000, v26
 v_cvt_pk_bf16_f32 v26, v122, v123
 v_lshlrev_b32 v122, 16, v26
 v_and_b32 v123, 0xffff0000, v26
 v_mul_f32 v122, v122, v33
 v_mul_f32 v123, v123, v33
 v_cvt_pk_bf16_f32 v26, v122, v123
 v_lshlrev_b32 v122, 16, v26
 v_and_b32 v123, 0xffff0000, v26
 v_cvt_pk_bf16_f32 v26, v124, v125
 v_lshlrev_b32 v124, 16, v26
 v_and_b32 v125, 0xffff0000, v26
 v_mul_f32 v124, v124, v33
 v_mul_f32 v125, v125, v33
 v_cvt_pk_bf16_f32 v26, v124, v125
 v_lshlrev_b32 v124, 16, v26
 v_and_b32 v125, 0xffff0000, v26
 v_cvt_pk_bf16_f32 v26, v126, v127
 v_lshlrev_b32 v126, 16, v26
 v_and_b32 v127, 0xffff0000, v26
 v_mul_f32 v126, v126, v33
 v_mul_f32 v127, v127, v33
 v_cvt_pk_bf16_f32 v26, v126, v127
 v_lshlrev_b32 v126, 16, v26
 v_and_b32 v127, 0xffff0000, v26
 v_cvt_pk_bf16_f32 v26, v128, v129
 v_lshlrev_b32 v128, 16, v26
 v_and_b32 v129, 0xffff0000, v26
 v_mul_f32 v128, v128, v33
 v_mul_f32 v129, v129, v33
 v_cvt_pk_bf16_f32 v26, v128, v129
 v_lshlrev_b32 v128, 16, v26
 v_and_b32 v129, 0xffff0000, v26
 v_cvt_pk_bf16_f32 v26, v130, v131
 v_lshlrev_b32 v130, 16, v26
 v_and_b32 v131, 0xffff0000, v26
 v_mul_f32 v130, v130, v33
 v_mul_f32 v131, v131, v33
 v_cvt_pk_bf16_f32 v26, v130, v131
 v_lshlrev_b32 v130, 16, v26
 v_and_b32 v131, 0xffff0000, v26
 v_cvt_pk_bf16_f32 v26, v132, v133
 v_lshlrev_b32 v132, 16, v26
 v_and_b32 v133, 0xffff0000, v26
 v_mul_f32 v132, v132, v33
 v_mul_f32 v133, v133, v33
 v_cvt_pk_bf16_f32 v26, v132, v133
 v_lshlrev_b32 v132, 16, v26
 v_and_b32 v133, 0xffff0000, v26
 v_cvt_pk_bf16_f32 v26, v134, v135
 v_lshlrev_b32 v134, 16, v26
 v_and_b32 v135, 0xffff0000, v26
 v_mul_f32 v134, v134, v33
 v_mul_f32 v135, v135, v33
 v_cvt_pk_bf16_f32 v26, v134, v135
 v_lshlrev_b32 v134, 16, v26
 v_and_b32 v135, 0xffff0000, v26
 v_cvt_pk_bf16_f32 v26, v136, v137
 v_lshlrev_b32 v136, 16, v26
 v_and_b32 v137, 0xffff0000, v26
 v_mul_f32 v136, v136, v33
 v_mul_f32 v137, v137, v33
 v_cvt_pk_bf16_f32 v26, v136, v137
 v_lshlrev_b32 v136, 16, v26
 v_and_b32 v137, 0xffff0000, v26
 v_cvt_pk_bf16_f32 v26, v138, v139
 v_lshlrev_b32 v138, 16, v26
 v_and_b32 v139, 0xffff0000, v26
 v_mul_f32 v138, v138, v33
 v_mul_f32 v139, v139, v33
 v_cvt_pk_bf16_f32 v26, v138, v139
 v_lshlrev_b32 v138, 16, v26
 v_and_b32 v139, 0xffff0000, v26
 v_cvt_pk_bf16_f32 v26, v140, v141
 v_lshlrev_b32 v140, 16, v26
 v_and_b32 v141, 0xffff0000, v26
 v_mul_f32 v140, v140, v33
 v_mul_f32 v141, v141, v33
 v_cvt_pk_bf16_f32 v26, v140, v141
 v_lshlrev_b32 v140, 16, v26
 v_and_b32 v141, 0xffff0000, v26
 v_cvt_pk_bf16_f32 v26, v142, v143
 v_lshlrev_b32 v142, 16, v26
 v_and_b32 v143, 0xffff0000, v26
 v_mul_f32 v142, v142, v33
 v_mul_f32 v143, v143, v33
 v_cvt_pk_bf16_f32 v26, v142, v143
 v_lshlrev_b32 v142, 16, v26
 v_and_b32 v143, 0xffff0000, v26
 s_waitcnt vmcnt(19)
 v_cvt_pk_bf16_f32 v26, v144, v145
 v_lshlrev_b32 v144, 16, v26
 v_and_b32 v145, 0xffff0000, v26
 v_mul_f32 v144, v144, v30
 v_mul_f32 v145, v145, v30
 v_cvt_pk_bf16_f32 v26, v144, v145
 v_lshlrev_b32 v144, 16, v26
 v_and_b32 v145, 0xffff0000, v26
 v_add_f32 v144, v144, v64
 v_add_f32 v145, v145, v65
 v_cvt_pk_bf16_f32 v64, v144, v145
 v_cvt_pk_bf16_f32 v26, v146, v147
 v_lshlrev_b32 v146, 16, v26
 v_and_b32 v147, 0xffff0000, v26
 v_mul_f32 v146, v146, v30
 v_mul_f32 v147, v147, v30
 v_cvt_pk_bf16_f32 v26, v146, v147
 v_lshlrev_b32 v146, 16, v26
 v_and_b32 v147, 0xffff0000, v26
 v_add_f32 v146, v146, v66
 v_add_f32 v147, v147, v67
 v_cvt_pk_bf16_f32 v65, v146, v147
 buffer_store_dwordx2 v[64:65], v9, s[8:11], s22 offen offset:0
 s_waitcnt vmcnt(19)
 v_cvt_pk_bf16_f32 v26, v148, v149
 v_lshlrev_b32 v148, 16, v26
 v_and_b32 v149, 0xffff0000, v26
 v_mul_f32 v148, v148, v30
 v_mul_f32 v149, v149, v30
 v_cvt_pk_bf16_f32 v26, v148, v149
 v_lshlrev_b32 v148, 16, v26
 v_and_b32 v149, 0xffff0000, v26
 v_add_f32 v148, v148, v68
 v_add_f32 v149, v149, v69
 v_cvt_pk_bf16_f32 v68, v148, v149
 v_cvt_pk_bf16_f32 v26, v150, v151
 v_lshlrev_b32 v150, 16, v26
 v_and_b32 v151, 0xffff0000, v26
 v_mul_f32 v150, v150, v30
 v_mul_f32 v151, v151, v30
 v_cvt_pk_bf16_f32 v26, v150, v151
 v_lshlrev_b32 v150, 16, v26
 v_and_b32 v151, 0xffff0000, v26
 v_add_f32 v150, v150, v70
 v_add_f32 v151, v151, v71
 v_cvt_pk_bf16_f32 v69, v150, v151
 buffer_store_dwordx2 v[68:69], v9, s[8:11], s22 offen offset:32
 s_waitcnt vmcnt(19)
 v_cvt_pk_bf16_f32 v26, v152, v153
 v_lshlrev_b32 v152, 16, v26
 v_and_b32 v153, 0xffff0000, v26
 v_mul_f32 v152, v152, v30
 v_mul_f32 v153, v153, v30
 v_cvt_pk_bf16_f32 v26, v152, v153
 v_lshlrev_b32 v152, 16, v26
 v_and_b32 v153, 0xffff0000, v26
 v_add_f32 v152, v152, v72
 v_add_f32 v153, v153, v73
 v_cvt_pk_bf16_f32 v72, v152, v153
 v_cvt_pk_bf16_f32 v26, v154, v155
 v_lshlrev_b32 v154, 16, v26
 v_and_b32 v155, 0xffff0000, v26
 v_mul_f32 v154, v154, v30
 v_mul_f32 v155, v155, v30
 v_cvt_pk_bf16_f32 v26, v154, v155
 v_lshlrev_b32 v154, 16, v26
 v_and_b32 v155, 0xffff0000, v26
 v_add_f32 v154, v154, v74
 v_add_f32 v155, v155, v75
 v_cvt_pk_bf16_f32 v73, v154, v155
 buffer_store_dwordx2 v[72:73], v9, s[8:11], s22 offen offset:64
 s_waitcnt vmcnt(19)
 v_cvt_pk_bf16_f32 v26, v156, v157
 v_lshlrev_b32 v156, 16, v26
 v_and_b32 v157, 0xffff0000, v26
 v_mul_f32 v156, v156, v30
 v_mul_f32 v157, v157, v30
 v_cvt_pk_bf16_f32 v26, v156, v157
 v_lshlrev_b32 v156, 16, v26
 v_and_b32 v157, 0xffff0000, v26
 v_add_f32 v156, v156, v76
 v_add_f32 v157, v157, v77
 v_cvt_pk_bf16_f32 v76, v156, v157
 v_cvt_pk_bf16_f32 v26, v158, v159
 v_lshlrev_b32 v158, 16, v26
 v_and_b32 v159, 0xffff0000, v26
 v_mul_f32 v158, v158, v30
 v_mul_f32 v159, v159, v30
 v_cvt_pk_bf16_f32 v26, v158, v159
 v_lshlrev_b32 v158, 16, v26
 v_and_b32 v159, 0xffff0000, v26
 v_add_f32 v158, v158, v78
 v_add_f32 v159, v159, v79
 v_cvt_pk_bf16_f32 v77, v158, v159
 buffer_store_dwordx2 v[76:77], v9, s[8:11], s22 offen offset:96
 s_waitcnt vmcnt(19)
 v_cvt_pk_bf16_f32 v26, v160, v161
 v_lshlrev_b32 v160, 16, v26
 v_and_b32 v161, 0xffff0000, v26
 v_mul_f32 v160, v160, v30
 v_mul_f32 v161, v161, v30
 v_cvt_pk_bf16_f32 v26, v160, v161
 v_lshlrev_b32 v160, 16, v26
 v_and_b32 v161, 0xffff0000, v26
 v_add_f32 v160, v160, v80
 v_add_f32 v161, v161, v81
 v_cvt_pk_bf16_f32 v80, v160, v161
 v_cvt_pk_bf16_f32 v26, v162, v163
 v_lshlrev_b32 v162, 16, v26
 v_and_b32 v163, 0xffff0000, v26
 v_mul_f32 v162, v162, v30
 v_mul_f32 v163, v163, v30
 v_cvt_pk_bf16_f32 v26, v162, v163
 v_lshlrev_b32 v162, 16, v26
 v_and_b32 v163, 0xffff0000, v26
 v_add_f32 v162, v162, v82
 v_add_f32 v163, v163, v83
 v_cvt_pk_bf16_f32 v81, v162, v163
 buffer_store_dwordx2 v[80:81], v9, s[8:11], s22 offen offset:128
 s_waitcnt vmcnt(19)
 v_cvt_pk_bf16_f32 v26, v164, v165
 v_lshlrev_b32 v164, 16, v26
 v_and_b32 v165, 0xffff0000, v26
 v_mul_f32 v164, v164, v30
 v_mul_f32 v165, v165, v30
 v_cvt_pk_bf16_f32 v26, v164, v165
 v_lshlrev_b32 v164, 16, v26
 v_and_b32 v165, 0xffff0000, v26
 v_add_f32 v164, v164, v84
 v_add_f32 v165, v165, v85
 v_cvt_pk_bf16_f32 v84, v164, v165
 v_cvt_pk_bf16_f32 v26, v166, v167
 v_lshlrev_b32 v166, 16, v26
 v_and_b32 v167, 0xffff0000, v26
 v_mul_f32 v166, v166, v30
 v_mul_f32 v167, v167, v30
 v_cvt_pk_bf16_f32 v26, v166, v167
 v_lshlrev_b32 v166, 16, v26
 v_and_b32 v167, 0xffff0000, v26
 v_add_f32 v166, v166, v86
 v_add_f32 v167, v167, v87
 v_cvt_pk_bf16_f32 v85, v166, v167
 buffer_store_dwordx2 v[84:85], v9, s[8:11], s22 offen offset:160
 s_waitcnt vmcnt(19)
 v_cvt_pk_bf16_f32 v26, v168, v169
 v_lshlrev_b32 v168, 16, v26
 v_and_b32 v169, 0xffff0000, v26
 v_mul_f32 v168, v168, v30
 v_mul_f32 v169, v169, v30
 v_cvt_pk_bf16_f32 v26, v168, v169
 v_lshlrev_b32 v168, 16, v26
 v_and_b32 v169, 0xffff0000, v26
 v_add_f32 v168, v168, v88
 v_add_f32 v169, v169, v89
 v_cvt_pk_bf16_f32 v88, v168, v169
 v_cvt_pk_bf16_f32 v26, v170, v171
 v_lshlrev_b32 v170, 16, v26
 v_and_b32 v171, 0xffff0000, v26
 v_mul_f32 v170, v170, v30
 v_mul_f32 v171, v171, v30
 v_cvt_pk_bf16_f32 v26, v170, v171
 v_lshlrev_b32 v170, 16, v26
 v_and_b32 v171, 0xffff0000, v26
 v_add_f32 v170, v170, v90
 v_add_f32 v171, v171, v91
 v_cvt_pk_bf16_f32 v89, v170, v171
 buffer_store_dwordx2 v[88:89], v9, s[8:11], s22 offen offset:192
 s_waitcnt vmcnt(19)
 v_cvt_pk_bf16_f32 v26, v172, v173
 v_lshlrev_b32 v172, 16, v26
 v_and_b32 v173, 0xffff0000, v26
 v_mul_f32 v172, v172, v30
 v_mul_f32 v173, v173, v30
 v_cvt_pk_bf16_f32 v26, v172, v173
 v_lshlrev_b32 v172, 16, v26
 v_and_b32 v173, 0xffff0000, v26
 v_add_f32 v172, v172, v92
 v_add_f32 v173, v173, v93
 v_cvt_pk_bf16_f32 v92, v172, v173
 v_cvt_pk_bf16_f32 v26, v174, v175
 v_lshlrev_b32 v174, 16, v26
 v_and_b32 v175, 0xffff0000, v26
 v_mul_f32 v174, v174, v30
 v_mul_f32 v175, v175, v30
 v_cvt_pk_bf16_f32 v26, v174, v175
 v_lshlrev_b32 v174, 16, v26
 v_and_b32 v175, 0xffff0000, v26
 v_add_f32 v174, v174, v94
 v_add_f32 v175, v175, v95
 v_cvt_pk_bf16_f32 v93, v174, v175
 buffer_store_dwordx2 v[92:93], v9, s[8:11], s22 offen offset:224
 s_waitcnt vmcnt(19)
 v_cvt_pk_bf16_f32 v26, v176, v177
 v_lshlrev_b32 v176, 16, v26
 v_and_b32 v177, 0xffff0000, v26
 v_mul_f32 v176, v176, v30
 v_mul_f32 v177, v177, v30
 v_cvt_pk_bf16_f32 v26, v176, v177
 v_lshlrev_b32 v176, 16, v26
 v_and_b32 v177, 0xffff0000, v26
 v_add_f32 v176, v176, v96
 v_add_f32 v177, v177, v97
 v_cvt_pk_bf16_f32 v96, v176, v177
 v_cvt_pk_bf16_f32 v26, v178, v179
 v_lshlrev_b32 v178, 16, v26
 v_and_b32 v179, 0xffff0000, v26
 v_mul_f32 v178, v178, v30
 v_mul_f32 v179, v179, v30
 v_cvt_pk_bf16_f32 v26, v178, v179
 v_lshlrev_b32 v178, 16, v26
 v_and_b32 v179, 0xffff0000, v26
 v_add_f32 v178, v178, v98
 v_add_f32 v179, v179, v99
 v_cvt_pk_bf16_f32 v97, v178, v179
 buffer_store_dwordx2 v[96:97], v9, s[8:11], s22 offen offset:256
 s_waitcnt vmcnt(19)
 v_cvt_pk_bf16_f32 v26, v180, v181
 v_lshlrev_b32 v180, 16, v26
 v_and_b32 v181, 0xffff0000, v26
 v_mul_f32 v180, v180, v30
 v_mul_f32 v181, v181, v30
 v_cvt_pk_bf16_f32 v26, v180, v181
 v_lshlrev_b32 v180, 16, v26
 v_and_b32 v181, 0xffff0000, v26
 v_add_f32 v180, v180, v100
 v_add_f32 v181, v181, v101
 v_cvt_pk_bf16_f32 v100, v180, v181
 v_cvt_pk_bf16_f32 v26, v182, v183
 v_lshlrev_b32 v182, 16, v26
 v_and_b32 v183, 0xffff0000, v26
 v_mul_f32 v182, v182, v30
 v_mul_f32 v183, v183, v30
 v_cvt_pk_bf16_f32 v26, v182, v183
 v_lshlrev_b32 v182, 16, v26
 v_and_b32 v183, 0xffff0000, v26
 v_add_f32 v182, v182, v102
 v_add_f32 v183, v183, v103
 v_cvt_pk_bf16_f32 v101, v182, v183
 buffer_store_dwordx2 v[100:101], v9, s[8:11], s22 offen offset:288
 s_waitcnt vmcnt(19)
 v_cvt_pk_bf16_f32 v26, v184, v185
 v_lshlrev_b32 v184, 16, v26
 v_and_b32 v185, 0xffff0000, v26
 v_mul_f32 v184, v184, v31
 v_mul_f32 v185, v185, v31
 v_cvt_pk_bf16_f32 v26, v184, v185
 v_lshlrev_b32 v184, 16, v26
 v_and_b32 v185, 0xffff0000, v26
 v_add_f32 v184, v184, v104
 v_add_f32 v185, v185, v105
 v_cvt_pk_bf16_f32 v104, v184, v185
 v_cvt_pk_bf16_f32 v26, v186, v187
 v_lshlrev_b32 v186, 16, v26
 v_and_b32 v187, 0xffff0000, v26
 v_mul_f32 v186, v186, v31
 v_mul_f32 v187, v187, v31
 v_cvt_pk_bf16_f32 v26, v186, v187
 v_lshlrev_b32 v186, 16, v26
 v_and_b32 v187, 0xffff0000, v26
 v_add_f32 v186, v186, v106
 v_add_f32 v187, v187, v107
 v_cvt_pk_bf16_f32 v105, v186, v187
 buffer_store_dwordx2 v[104:105], v9, s[8:11], s23 offen offset:0
 s_waitcnt vmcnt(19)
 v_cvt_pk_bf16_f32 v26, v188, v189
 v_lshlrev_b32 v188, 16, v26
 v_and_b32 v189, 0xffff0000, v26
 v_mul_f32 v188, v188, v31
 v_mul_f32 v189, v189, v31
 v_cvt_pk_bf16_f32 v26, v188, v189
 v_lshlrev_b32 v188, 16, v26
 v_and_b32 v189, 0xffff0000, v26
 v_add_f32 v188, v188, v108
 v_add_f32 v189, v189, v109
 v_cvt_pk_bf16_f32 v108, v188, v189
 v_cvt_pk_bf16_f32 v26, v190, v191
 v_lshlrev_b32 v190, 16, v26
 v_and_b32 v191, 0xffff0000, v26
 v_mul_f32 v190, v190, v31
 v_mul_f32 v191, v191, v31
 v_cvt_pk_bf16_f32 v26, v190, v191
 v_lshlrev_b32 v190, 16, v26
 v_and_b32 v191, 0xffff0000, v26
 v_add_f32 v190, v190, v110
 v_add_f32 v191, v191, v111
 v_cvt_pk_bf16_f32 v109, v190, v191
 buffer_store_dwordx2 v[108:109], v9, s[8:11], s23 offen offset:32
 s_waitcnt vmcnt(19)
 v_cvt_pk_bf16_f32 v26, v192, v193
 v_lshlrev_b32 v192, 16, v26
 v_and_b32 v193, 0xffff0000, v26
 v_mul_f32 v192, v192, v31
 v_mul_f32 v193, v193, v31
 v_cvt_pk_bf16_f32 v26, v192, v193
 v_lshlrev_b32 v192, 16, v26
 v_and_b32 v193, 0xffff0000, v26
 v_add_f32 v192, v192, v112
 v_add_f32 v193, v193, v113
 v_cvt_pk_bf16_f32 v112, v192, v193
 v_cvt_pk_bf16_f32 v26, v194, v195
 v_lshlrev_b32 v194, 16, v26
 v_and_b32 v195, 0xffff0000, v26
 v_mul_f32 v194, v194, v31
 v_mul_f32 v195, v195, v31
 v_cvt_pk_bf16_f32 v26, v194, v195
 v_lshlrev_b32 v194, 16, v26
 v_and_b32 v195, 0xffff0000, v26
 v_add_f32 v194, v194, v114
 v_add_f32 v195, v195, v115
 v_cvt_pk_bf16_f32 v113, v194, v195
 buffer_store_dwordx2 v[112:113], v9, s[8:11], s23 offen offset:64
 s_waitcnt vmcnt(19)
 v_cvt_pk_bf16_f32 v26, v196, v197
 v_lshlrev_b32 v196, 16, v26
 v_and_b32 v197, 0xffff0000, v26
 v_mul_f32 v196, v196, v31
 v_mul_f32 v197, v197, v31
 v_cvt_pk_bf16_f32 v26, v196, v197
 v_lshlrev_b32 v196, 16, v26
 v_and_b32 v197, 0xffff0000, v26
 v_add_f32 v196, v196, v116
 v_add_f32 v197, v197, v117
 v_cvt_pk_bf16_f32 v116, v196, v197
 v_cvt_pk_bf16_f32 v26, v198, v199
 v_lshlrev_b32 v198, 16, v26
 v_and_b32 v199, 0xffff0000, v26
 v_mul_f32 v198, v198, v31
 v_mul_f32 v199, v199, v31
 v_cvt_pk_bf16_f32 v26, v198, v199
 v_lshlrev_b32 v198, 16, v26
 v_and_b32 v199, 0xffff0000, v26
 v_add_f32 v198, v198, v118
 v_add_f32 v199, v199, v119
 v_cvt_pk_bf16_f32 v117, v198, v199
 buffer_store_dwordx2 v[116:117], v9, s[8:11], s23 offen offset:96
 s_waitcnt vmcnt(19)
 v_cvt_pk_bf16_f32 v26, v200, v201
 v_lshlrev_b32 v200, 16, v26
 v_and_b32 v201, 0xffff0000, v26
 v_mul_f32 v200, v200, v31
 v_mul_f32 v201, v201, v31
 v_cvt_pk_bf16_f32 v26, v200, v201
 v_lshlrev_b32 v200, 16, v26
 v_and_b32 v201, 0xffff0000, v26
 v_add_f32 v200, v200, v120
 v_add_f32 v201, v201, v121
 v_cvt_pk_bf16_f32 v120, v200, v201
 v_cvt_pk_bf16_f32 v26, v202, v203
 v_lshlrev_b32 v202, 16, v26
 v_and_b32 v203, 0xffff0000, v26
 v_mul_f32 v202, v202, v31
 v_mul_f32 v203, v203, v31
 v_cvt_pk_bf16_f32 v26, v202, v203
 v_lshlrev_b32 v202, 16, v26
 v_and_b32 v203, 0xffff0000, v26
 v_add_f32 v202, v202, v122
 v_add_f32 v203, v203, v123
 v_cvt_pk_bf16_f32 v121, v202, v203
 buffer_store_dwordx2 v[120:121], v9, s[8:11], s23 offen offset:128
 s_waitcnt vmcnt(19)
 v_cvt_pk_bf16_f32 v26, v204, v205
 v_lshlrev_b32 v204, 16, v26
 v_and_b32 v205, 0xffff0000, v26
 v_mul_f32 v204, v204, v31
 v_mul_f32 v205, v205, v31
 v_cvt_pk_bf16_f32 v26, v204, v205
 v_lshlrev_b32 v204, 16, v26
 v_and_b32 v205, 0xffff0000, v26
 v_add_f32 v204, v204, v124
 v_add_f32 v205, v205, v125
 v_cvt_pk_bf16_f32 v124, v204, v205
 v_cvt_pk_bf16_f32 v26, v206, v207
 v_lshlrev_b32 v206, 16, v26
 v_and_b32 v207, 0xffff0000, v26
 v_mul_f32 v206, v206, v31
 v_mul_f32 v207, v207, v31
 v_cvt_pk_bf16_f32 v26, v206, v207
 v_lshlrev_b32 v206, 16, v26
 v_and_b32 v207, 0xffff0000, v26
 v_add_f32 v206, v206, v126
 v_add_f32 v207, v207, v127
 v_cvt_pk_bf16_f32 v125, v206, v207
 buffer_store_dwordx2 v[124:125], v9, s[8:11], s23 offen offset:160
 s_waitcnt vmcnt(19)
 v_cvt_pk_bf16_f32 v26, v208, v209
 v_lshlrev_b32 v208, 16, v26
 v_and_b32 v209, 0xffff0000, v26
 v_mul_f32 v208, v208, v31
 v_mul_f32 v209, v209, v31
 v_cvt_pk_bf16_f32 v26, v208, v209
 v_lshlrev_b32 v208, 16, v26
 v_and_b32 v209, 0xffff0000, v26
 v_add_f32 v208, v208, v128
 v_add_f32 v209, v209, v129
 v_cvt_pk_bf16_f32 v128, v208, v209
 v_cvt_pk_bf16_f32 v26, v210, v211
 v_lshlrev_b32 v210, 16, v26
 v_and_b32 v211, 0xffff0000, v26
 v_mul_f32 v210, v210, v31
 v_mul_f32 v211, v211, v31
 v_cvt_pk_bf16_f32 v26, v210, v211
 v_lshlrev_b32 v210, 16, v26
 v_and_b32 v211, 0xffff0000, v26
 v_add_f32 v210, v210, v130
 v_add_f32 v211, v211, v131
 v_cvt_pk_bf16_f32 v129, v210, v211
 buffer_store_dwordx2 v[128:129], v9, s[8:11], s23 offen offset:192
 s_waitcnt vmcnt(19)
 v_cvt_pk_bf16_f32 v26, v212, v213
 v_lshlrev_b32 v212, 16, v26
 v_and_b32 v213, 0xffff0000, v26
 v_mul_f32 v212, v212, v31
 v_mul_f32 v213, v213, v31
 v_cvt_pk_bf16_f32 v26, v212, v213
 v_lshlrev_b32 v212, 16, v26
 v_and_b32 v213, 0xffff0000, v26
 v_add_f32 v212, v212, v132
 v_add_f32 v213, v213, v133
 v_cvt_pk_bf16_f32 v132, v212, v213
 v_cvt_pk_bf16_f32 v26, v214, v215
 v_lshlrev_b32 v214, 16, v26
 v_and_b32 v215, 0xffff0000, v26
 v_mul_f32 v214, v214, v31
 v_mul_f32 v215, v215, v31
 v_cvt_pk_bf16_f32 v26, v214, v215
 v_lshlrev_b32 v214, 16, v26
 v_and_b32 v215, 0xffff0000, v26
 v_add_f32 v214, v214, v134
 v_add_f32 v215, v215, v135
 v_cvt_pk_bf16_f32 v133, v214, v215
 buffer_store_dwordx2 v[132:133], v9, s[8:11], s23 offen offset:224
 s_waitcnt vmcnt(19)
 v_cvt_pk_bf16_f32 v26, v216, v217
 v_lshlrev_b32 v216, 16, v26
 v_and_b32 v217, 0xffff0000, v26
 v_mul_f32 v216, v216, v31
 v_mul_f32 v217, v217, v31
 v_cvt_pk_bf16_f32 v26, v216, v217
 v_lshlrev_b32 v216, 16, v26
 v_and_b32 v217, 0xffff0000, v26
 v_add_f32 v216, v216, v136
 v_add_f32 v217, v217, v137
 v_cvt_pk_bf16_f32 v136, v216, v217
 v_cvt_pk_bf16_f32 v26, v218, v219
 v_lshlrev_b32 v218, 16, v26
 v_and_b32 v219, 0xffff0000, v26
 v_mul_f32 v218, v218, v31
 v_mul_f32 v219, v219, v31
 v_cvt_pk_bf16_f32 v26, v218, v219
 v_lshlrev_b32 v218, 16, v26
 v_and_b32 v219, 0xffff0000, v26
 v_add_f32 v218, v218, v138
 v_add_f32 v219, v219, v139
 v_cvt_pk_bf16_f32 v137, v218, v219
 buffer_store_dwordx2 v[136:137], v9, s[8:11], s23 offen offset:256
 s_waitcnt vmcnt(19)
 v_cvt_pk_bf16_f32 v26, v220, v221
 v_lshlrev_b32 v220, 16, v26
 v_and_b32 v221, 0xffff0000, v26
 v_mul_f32 v220, v220, v31
 v_mul_f32 v221, v221, v31
 v_cvt_pk_bf16_f32 v26, v220, v221
 v_lshlrev_b32 v220, 16, v26
 v_and_b32 v221, 0xffff0000, v26
 v_add_f32 v220, v220, v140
 v_add_f32 v221, v221, v141
 v_cvt_pk_bf16_f32 v140, v220, v221
 v_cvt_pk_bf16_f32 v26, v222, v223
 v_lshlrev_b32 v222, 16, v26
 v_and_b32 v223, 0xffff0000, v26
 v_mul_f32 v222, v222, v31
 v_mul_f32 v223, v223, v31
 v_cvt_pk_bf16_f32 v26, v222, v223
 v_lshlrev_b32 v222, 16, v26
 v_and_b32 v223, 0xffff0000, v26
 v_add_f32 v222, v222, v142
 v_add_f32 v223, v223, v143
 v_cvt_pk_bf16_f32 v141, v222, v223
 buffer_store_dwordx2 v[140:141], v9, s[8:11], s23 offen offset:288
om_241:
 s_waitcnt vmcnt(0) lgkmcnt(0)
 s_barrier
 s_sub_u32 s21, s2, 16
 s_cmp_ge_u32 s2, 48
 s_cbranch_scc1 do_opb2
 s_cmp_eq_u32 s87, -1
 s_cbranch_scc1 queue
tail_item:
 s_load_dwordx2 s[4:5], s[0:1], 96
 s_waitcnt lgkmcnt(0)
 s_mov_b32 s32, s4
 s_mov_b32 s33, s5
 s_mov_b32 s34, 256
 s_mov_b32 s35, 0x00020000
 s_waitcnt vmcnt(0)
 s_barrier
 s_mov_b32 s21, s87
do_pv:
 s_mov_b32 s2, s21
 s_load_dwordx2 s[4:5], s[0:1], 88
 s_load_dwordx2 s[38:39], s[0:1], 104
 s_waitcnt lgkmcnt(0)
 s_mov_b32 s8, s4
 s_mov_b32 s9, s5
 s_mov_b32 s10, 2621440
 s_mov_b32 s11, 0x00020000
 s_add_u32 s12, s38, 88080384
 s_addc_u32 s13, s39, 0
 s_mov_b32 s14, 83886080
 s_mov_b32 s15, 0x00020000
 s_mov_b32 s59, 0
 s_mov_b32 s60, 0
 s_add_u32 s16, s38, 180355072
 s_addc_u32 s17, s39, 0
 s_mov_b32 s18, 67108864
 s_mov_b32 s19, 0x00020000
 s_add_u32 s24, s38, 180355072
 s_addc_u32 s25, s39, 0
 s_mov_b32 s26, 67108864
 s_mov_b32 s27, 0x00020000
 s_add_u32 s28, s38, 81002496
 s_addc_u32 s29, s39, 0
 s_mov_b32 s30, 8192
 s_mov_b32 s31, 0x00020000
 s_add_u32 s72, s38, 81068032
 s_addc_u32 s73, s39, 0
 s_mov_b32 s74, 129024
 s_mov_b32 s75, 0x00020000
 v_lshlrev_b32 v4, 4, v1
 v_lshlrev_b32 v5, 3, v1
 v_lshlrev_b32 v6, 2, v2
 v_and_b32 v7, 7, v1
 v_lshlrev_b32 v7, 7, v7
 v_lshrrev_b32 v31, 3, v1
 v_lshl_add_u32 v208, v31, 10, v7
 v_bfe_u32 v31, v1, 3, 2
 v_lshl_add_u32 v31, v31, 12, v7
 s_lshl_b32 s21, s20, 10
 s_add_u32 s21, s21, 95232
 buffer_load_dword v8, v31, s[72:75], s21 offen sc1
 v_lshlrev_b32 v25, 7, v2
 s_mov_b32 s21, 93184
 buffer_load_dword v26, v25, s[72:75], s21 offen sc1
 s_mov_b32 s63, 1
 v_mul_u32_u24 v9, 1280, v2
 v_lshl_add_u32 v9, v3, 3, v9
 s_lshl_b32 s21, s20, 13
 v_add_u32 v10, s21, v4
 s_lshl_b32 s21, s20, 10
 v_add_u32 v11, s21, v4
 v_lshrrev_b32 v20, 5, v1
 v_mul_u32_u24 v21, 2560, v20
 v_add_u32 v21, v21, v4
 v_and_b32 v22, 31, v1
 v_lshlrev_b32 v22, 4, v22
 v_mul_u32_u24 v20, 10240, v20
 v_add_u32 v22, v22, v20
 v_mul_u32_u24 v21, 2048, v3
 v_lshl_add_u32 v21, v2, 4, v21
 v_mul_u32_u24 v22, 1024, v3
 v_lshl_add_u32 v22, v2, 4, v22
 v_mov_b32 v28, 80
 v_mov_b32 v30, 32768
 s_mov_b32 s50, 0
 s_mov_b32 s71, 0
 s_mov_b32 s51, 0
 s_and_b32 s43, s20, 1
 s_lshr_b32 s44, s20, 1
 v_mov_b32 v70, 0
 v_mov_b32 v71, 0
 v_mov_b32 v78, 0
 v_mov_b32 v79, 0
 v_mov_b32 v86, 0
 v_mov_b32 v87, 0
 v_mov_b32 v94, 0
 v_mov_b32 v95, 0
 v_mov_b32 v102, 0
 v_mov_b32 v103, 0
 v_mov_b32 v110, 0
 v_mov_b32 v111, 0
 v_mov_b32 v118, 0
 v_mov_b32 v119, 0
 v_mov_b32 v126, 0
 v_mov_b32 v127, 0
 s_mov_b32 s21, s2
pv_loop:
 s_mul_i32 s2, s21, 2
 s_add_u32 s2, s2, 192
 s_add_u32 s22, s21, 356
 s_cmp_lt_u32 s21, 164
 s_cselect_b32 s2, s2, s22
 s_cselect_b32 s65, 1, 0
 s_mul_i32 s22, s21, 5
 s_cmp_lt_u32 s21, 64
 s_cselect_b32 s2, s22, s2
 s_cselect_b32 s65, 4, s65
 s_mul_hi_u32 s40, s2, 0x1999999a
 s_mul_i32 s21, s40, 10
 s_sub_u32 s41, s2, s21
 s_lshl_b32 s52, s40, 10
 s_add_u32 s52, s52, 23552
 buffer_load_dword v27, v7, s[72:75], s52 offen sc1
 s_cmp_lg_u32 s20, 0
 s_cbranch_scc1 pv_253
 s_sub_u32 s21, s2, 0
 s_cmp_lt_u32 s21, 640
 s_cbranch_scc1 pv_253
 v_mov_b32 v29, 1
 s_mov_b64 exec, 1
 buffer_atomic_add v29, v28, s[32:35], 0 offen sc0 sc1
 s_mov_b64 exec, -1
pv_253:
 s_lshl_b32 s42, s40, 5
 s_lshl_b32 s21, s20, 3
 s_add_u32 s42, s42, s21
 s_lshl_b32 s22, s40, 12
 s_and_b32 s22, s22, 8192
 s_xor_b32 s22, s22, s37
 s_lshl_b32 s62, s40, 20
 s_or_b32 s62, s62, s22
 s_cmp_ge_u32 s40, 36
 s_cselect_b32 s61, 8192, 0
 s_xor_b32 s61, s61, s62
 s_mul_i32 s53, s42, 40960
 s_lshl_b32 s22, s41, 12
 s_add_u32 s53, s53, s22
 s_lshl_b32 s21, s40, 1
 s_add_u32 s21, s21, s43
 s_lshl_b32 s45, s21, 6
 s_mul_i32 s46, s21, 20480
 s_lshl_b32 s21, s41, 4
 s_lshl_b32 s22, s43, 2
 s_add_u32 s21, s21, s22
 s_add_u32 s21, s21, s44
 s_lshl_b32 s54, s21, 10
 s_add_u32 s54, s54, s62
 s_add_u32 s54, s54, 786432
 s_lshl_b32 s22, s41, 2
 s_add_u32 s22, s22, s44
 s_lshl_b32 s22, s22, 5
 s_add_u32 s46, s46, s22
 s_lshl_b32 s47, s20, 15
 s_add_u32 s47, s47, s62
 s_add_u32 s47, s47, 655360
 s_lshl_b32 s48, s41, 16
 s_lshl_b32 s22, s20, 14
 s_add_u32 s48, s48, s22
 s_add_u32 s48, s48, s61
 s_add_u32 s23, s40, 1
 s_cmp_ge_u32 s50, s23
 s_cbranch_scc1 pv_246
 s_cmp_eq_u32 s63, 0
 s_cbranch_scc1 pv_249
 s_mov_b32 s63, 0
 s_waitcnt vmcnt(1)
 v_cmp_le_u32 vcc, 4, v26
 s_mov_b32 s51, vcc_lo
 v_cmp_gt_u32 vcc, s23, v8
 s_nop 1
 s_cbranch_vccz pv_250
pv_249:
 s_lshl_b32 s21, s20, 10
 s_add_u32 s21, s21, 95232
 s_mov_b32 s101, 0
wm_254:
 buffer_load_dword v8, v31, s[72:75], s21 offen sc1
 s_add_u32 s101, s101, 1
 s_cmp_gt_u32 s101, 131072
 s_cbranch_scc1 main_end
 s_waitcnt vmcnt(0)
 v_cmp_gt_u32 vcc, s23, v8
 v_readfirstlane_b32 s100, v8
 s_nop 0
 s_cbranch_vccz wm_255
 s_sleep 8
 s_add_u32 s100, s100, 2
 s_cmp_ge_u32 s100, s23
 s_cbranch_scc1 wm_254
 s_sleep 60
 s_branch wm_254
wm_255:
pv_250:
 v_readlane_b32 s50, v8, 0
 v_readlane_b32 s21, v8, 1
 s_min_u32 s50, s50, s21
 v_readlane_b32 s21, v8, 2
 s_min_u32 s50, s50, s21
 v_readlane_b32 s21, v8, 3
 s_min_u32 s50, s50, s21
 v_readlane_b32 s21, v8, 4
 s_min_u32 s50, s50, s21
 v_readlane_b32 s21, v8, 5
 s_min_u32 s50, s50, s21
 v_readlane_b32 s21, v8, 6
 s_min_u32 s50, s50, s21
 v_readlane_b32 s21, v8, 7
 s_min_u32 s50, s50, s21
 v_readlane_b32 s21, v8, 8
 s_min_u32 s50, s50, s21
 v_readlane_b32 s21, v8, 9
 s_min_u32 s50, s50, s21
 v_readlane_b32 s21, v8, 10
 s_min_u32 s50, s50, s21
 v_readlane_b32 s21, v8, 11
 s_min_u32 s50, s50, s21
 v_readlane_b32 s21, v8, 12
 s_min_u32 s50, s50, s21
 v_readlane_b32 s21, v8, 13
 s_min_u32 s50, s50, s21
 v_readlane_b32 s21, v8, 14
 s_min_u32 s50, s50, s21
 v_readlane_b32 s21, v8, 15
 s_min_u32 s50, s50, s21
 v_readlane_b32 s21, v8, 16
 s_min_u32 s50, s50, s21
 v_readlane_b32 s21, v8, 17
 s_min_u32 s50, s50, s21
 v_readlane_b32 s21, v8, 18
 s_min_u32 s50, s50, s21
 v_readlane_b32 s21, v8, 19
 s_min_u32 s50, s50, s21
 v_readlane_b32 s21, v8, 20
 s_min_u32 s50, s50, s21
 v_readlane_b32 s21, v8, 21
 s_min_u32 s50, s50, s21
 v_readlane_b32 s21, v8, 22
 s_min_u32 s50, s50, s21
 v_readlane_b32 s21, v8, 23
 s_min_u32 s50, s50, s21
 v_readlane_b32 s21, v8, 24
 s_min_u32 s50, s50, s21
 v_readlane_b32 s21, v8, 25
 s_min_u32 s50, s50, s21
 v_readlane_b32 s21, v8, 26
 s_min_u32 s50, s50, s21
 v_readlane_b32 s21, v8, 27
 s_min_u32 s50, s50, s21
 v_readlane_b32 s21, v8, 28
 s_min_u32 s50, s50, s21
 v_readlane_b32 s21, v8, 29
 s_min_u32 s50, s50, s21
 v_readlane_b32 s21, v8, 30
 s_min_u32 s50, s50, s21
 v_readlane_b32 s21, v8, 31
 s_min_u32 s50, s50, s21
pv_246:
 s_lshr_b32 s22, s40, 2
 s_cmp_lt_u32 s40, 48
 s_cbranch_scc1 pv_247
 s_bitcmp1_b32 s51, s22
 s_cbranch_scc1 pv_247
 s_mov_b32 s21, 93184
 v_lshlrev_b32 v25, 7, v2
 s_mov_b32 s101, 0
pv_248:
 buffer_load_dword v26, v25, s[72:75], s21 offen sc1
 s_add_u32 s101, s101, 1
 s_cmp_gt_u32 s101, 131072
 s_cbranch_scc1 main_end
 s_waitcnt vmcnt(0)
 v_cmp_le_u32 vcc, 4, v26
 s_mov_b32 s51, vcc_lo
 s_bitcmp1_b32 s51, s22
 s_cbranch_scc1 pv_247
 s_sleep 8
 s_branch pv_248
pv_247:
 buffer_load_dwordx4 a[0:3], v4, s[12:15], s53 offen offset:0 sc1
 buffer_load_dwordx4 a[4:7], v4, s[12:15], s53 offen offset:1024 sc1
 buffer_load_dwordx4 a[8:11], v4, s[12:15], s53 offen offset:2048 sc1
 buffer_load_dwordx4 a[12:15], v4, s[12:15], s53 offen offset:3072 sc1
 s_add_u32 s53, s53, 40960
 buffer_load_dwordx4 a[16:19], v4, s[12:15], s53 offen offset:0 sc1
 buffer_load_dwordx4 a[20:23], v4, s[12:15], s53 offen offset:1024 sc1
 buffer_load_dwordx4 a[24:27], v4, s[12:15], s53 offen offset:2048 sc1
 buffer_load_dwordx4 a[28:31], v4, s[12:15], s53 offen offset:3072 sc1
 s_add_u32 s53, s53, 40960
 buffer_load_dwordx4 a[32:35], v4, s[12:15], s53 offen offset:0 sc1
 buffer_load_dwordx4 a[36:39], v4, s[12:15], s53 offen offset:1024 sc1
 buffer_load_dwordx4 a[40:43], v4, s[12:15], s53 offen offset:2048 sc1
 buffer_load_dwordx4 a[44:47], v4, s[12:15], s53 offen offset:3072 sc1
 s_add_u32 s53, s53, 40960
 buffer_load_dwordx4 a[48:51], v4, s[12:15], s53 offen offset:0 sc1
 buffer_load_dwordx4 a[52:55], v4, s[12:15], s53 offen offset:1024 sc1
 buffer_load_dwordx4 a[56:59], v4, s[12:15], s53 offen offset:2048 sc1
 buffer_load_dwordx4 a[60:63], v4, s[12:15], s53 offen offset:3072 sc1
 s_add_u32 s53, s53, 40960
 buffer_load_dwordx4 a[64:67], v4, s[12:15], s53 offen offset:0 sc1
 buffer_load_dwordx4 a[68:71], v4, s[12:15], s53 offen offset:1024 sc1
 buffer_load_dwordx4 a[72:75], v4, s[12:15], s53 offen offset:2048 sc1
 buffer_load_dwordx4 a[76:79], v4, s[12:15], s53 offen offset:3072 sc1
 s_add_u32 s53, s53, 40960
 buffer_load_dwordx4 a[80:83], v4, s[12:15], s53 offen offset:0 sc1
 buffer_load_dwordx4 a[84:87], v4, s[12:15], s53 offen offset:1024 sc1
 buffer_load_dwordx4 a[88:91], v4, s[12:15], s53 offen offset:2048 sc1
 buffer_load_dwordx4 a[92:95], v4, s[12:15], s53 offen offset:3072 sc1
 s_add_u32 s53, s53, 40960
 buffer_load_dwordx4 a[96:99], v4, s[12:15], s53 offen offset:0 sc1
 buffer_load_dwordx4 a[100:103], v4, s[12:15], s53 offen offset:1024 sc1
 buffer_load_dwordx4 a[104:107], v4, s[12:15], s53 offen offset:2048 sc1
 buffer_load_dwordx4 a[108:111], v4, s[12:15], s53 offen offset:3072 sc1
 s_add_u32 s53, s53, 40960
 buffer_load_dwordx4 a[112:115], v4, s[12:15], s53 offen offset:0 sc1
 buffer_load_dwordx4 a[116:119], v4, s[12:15], s53 offen offset:1024 sc1
 buffer_load_dwordx4 a[120:123], v4, s[12:15], s53 offen offset:2048 sc1
 buffer_load_dwordx4 a[124:127], v4, s[12:15], s53 offen offset:3072 sc1
 s_cmp_lt_u32 s40, 48
 s_cselect_b32 s70, 0x80000000, s54
 buffer_load_dwordx4 v[12:15], v4, s[24:27], s70 offen sc1
 buffer_load_dwordx4 v[16:19], v4, s[24:27], s70 offen offset:2048 sc1
 buffer_load_dword v24, v6, s[28:31], s45 offen sc1
 s_waitcnt vmcnt(35)
 s_cmp_eq_u32 s71, 0
 s_cbranch_scc1 paf_258
 v_mov_b32 v25, 0
 v_mov_b32 v26, 1
 s_mov_b64 exec, 1
 buffer_atomic_add v26, v25, s[72:75], s71 offen sc1
 s_mov_b64 exec, -1
 s_mov_b32 s71, 0
paf_258:
 v_cmp_le_u32 s[68:69], 4, v27
 s_nop 1
 s_and_b32 s21, s68, 255
 s_cmp_lg_u32 s21, 255
 s_cbranch_scc1 pvw_251
 s_mov_b32 s56, s47
 s_mov_b32 s57, s48
 buffer_load_dwordx4 v[64:67], v4, s[16:19], s56 offen sc1
 buffer_load_dwordx2 v[68:69], v5, s[16:19], s56 offen offset:1536 sc1
 buffer_load_dwordx4 v[128:131], v21, s[16:19], s56 offen offset:1024 sc1
 buffer_load_dwordx4 v[132:135], v21, s[16:19], s56 offen offset:1280 sc1
 s_add_u32 s56, s56, 2048
 buffer_load_dwordx4 v[72:75], v4, s[16:19], s56 offen sc1
 buffer_load_dwordx2 v[76:77], v5, s[16:19], s56 offen offset:1536 sc1
 s_add_u32 s56, s56, 2048
 buffer_load_dwordx4 v[80:83], v4, s[16:19], s56 offen sc1
 buffer_load_dwordx2 v[84:85], v5, s[16:19], s56 offen offset:1536 sc1
 s_add_u32 s56, s56, 2048
 buffer_load_dwordx4 v[88:91], v4, s[16:19], s56 offen sc1
 buffer_load_dwordx2 v[92:93], v5, s[16:19], s56 offen offset:1536 sc1
 s_add_u32 s56, s56, 10240
 buffer_load_dwordx4 v[32:35], v22, s[16:19], s57 offen offset:0 sc1
 buffer_load_dwordx4 v[36:39], v22, s[16:19], s57 offen offset:256 sc1
 buffer_load_dwordx4 v[40:43], v22, s[16:19], s57 offen offset:512 sc1
 buffer_load_dwordx4 v[44:47], v22, s[16:19], s57 offen offset:768 sc1
 s_add_u32 s57, s57, 4096
 buffer_load_dwordx4 v[96:99], v4, s[16:19], s56 offen sc1
 buffer_load_dwordx2 v[100:101], v5, s[16:19], s56 offen offset:1536 sc1
 buffer_load_dwordx4 v[136:139], v21, s[16:19], s56 offen offset:1024 sc1
 buffer_load_dwordx4 v[140:143], v21, s[16:19], s56 offen offset:1280 sc1
 s_add_u32 s56, s56, 2048
 buffer_load_dwordx4 v[104:107], v4, s[16:19], s56 offen sc1
 buffer_load_dwordx2 v[108:109], v5, s[16:19], s56 offen offset:1536 sc1
 s_add_u32 s56, s56, 2048
 buffer_load_dwordx4 v[112:115], v4, s[16:19], s56 offen sc1
 buffer_load_dwordx2 v[116:117], v5, s[16:19], s56 offen offset:1536 sc1
 s_add_u32 s56, s56, 2048
 buffer_load_dwordx4 v[120:123], v4, s[16:19], s56 offen sc1
 buffer_load_dwordx2 v[124:125], v5, s[16:19], s56 offen offset:1536 sc1
 s_add_u32 s56, s56, 10240
 buffer_load_dwordx4 v[48:51], v22, s[16:19], s57 offen offset:0 sc1
 buffer_load_dwordx4 v[52:55], v22, s[16:19], s57 offen offset:256 sc1
 buffer_load_dwordx4 v[56:59], v22, s[16:19], s57 offen offset:512 sc1
 buffer_load_dwordx4 v[60:63], v22, s[16:19], s57 offen offset:768 sc1
 s_add_u32 s57, s57, 4096
 s_barrier
 s_waitcnt vmcnt(28)
 v_sub_f32 v25, 1.0, v24
 v_cvt_pk_bf16_f32 v26, v25, v25
 v_lshlrev_b32 v25, 16, v26
 v_cvt_pk_bf16_f32 v26, v12, v12
 v_lshlrev_b32 v12, 16, v26
 v_cvt_pk_bf16_f32 v26, v13, v13
 v_lshlrev_b32 v13, 16, v26
 v_cvt_pk_bf16_f32 v26, v14, v14
 v_lshlrev_b32 v14, 16, v26
 v_cvt_pk_bf16_f32 v26, v15, v15
 v_lshlrev_b32 v15, 16, v26
 v_cvt_pk_bf16_f32 v26, v16, v16
 v_lshlrev_b32 v16, 16, v26
 v_cvt_pk_bf16_f32 v26, v17, v17
 v_lshlrev_b32 v17, 16, v26
 v_cvt_pk_bf16_f32 v26, v18, v18
 v_lshlrev_b32 v18, 16, v26
 v_cvt_pk_bf16_f32 v26, v19, v19
 v_lshlrev_b32 v19, 16, v26
 v_mul_f32 v12, v12, v25
 v_cvt_pk_bf16_f32 v26, v12, v12
 v_lshlrev_b32 v12, 16, v26
 v_mul_f32 v13, v13, v25
 v_cvt_pk_bf16_f32 v26, v13, v13
 v_lshlrev_b32 v13, 16, v26
 v_mul_f32 v14, v14, v25
 v_cvt_pk_bf16_f32 v26, v14, v14
 v_lshlrev_b32 v14, 16, v26
 v_mul_f32 v15, v15, v25
 v_cvt_pk_bf16_f32 v26, v15, v15
 v_lshlrev_b32 v15, 16, v26
 v_mul_f32 v16, v16, v25
 v_cvt_pk_bf16_f32 v26, v16, v16
 v_lshlrev_b32 v16, 16, v26
 v_mul_f32 v17, v17, v25
 v_cvt_pk_bf16_f32 v26, v17, v17
 v_lshlrev_b32 v17, 16, v26
 v_mul_f32 v18, v18, v25
 v_cvt_pk_bf16_f32 v26, v18, v18
 v_lshlrev_b32 v18, 16, v26
 v_mul_f32 v19, v19, v25
 v_cvt_pk_bf16_f32 v26, v19, v19
 v_lshlrev_b32 v19, 16, v26
 s_cmp_ge_u32 s40, 52
 s_cbranch_scc1 pvc_257
 s_branch pvg_256
pvw_251:
 s_waitcnt vmcnt(0)
 v_sub_f32 v25, 1.0, v24
 v_cvt_pk_bf16_f32 v26, v25, v25
 v_lshlrev_b32 v25, 16, v26
 v_cvt_pk_bf16_f32 v26, v12, v12
 v_lshlrev_b32 v12, 16, v26
 v_cvt_pk_bf16_f32 v26, v13, v13
 v_lshlrev_b32 v13, 16, v26
 v_cvt_pk_bf16_f32 v26, v14, v14
 v_lshlrev_b32 v14, 16, v26
 v_cvt_pk_bf16_f32 v26, v15, v15
 v_lshlrev_b32 v15, 16, v26
 v_cvt_pk_bf16_f32 v26, v16, v16
 v_lshlrev_b32 v16, 16, v26
 v_cvt_pk_bf16_f32 v26, v17, v17
 v_lshlrev_b32 v17, 16, v26
 v_cvt_pk_bf16_f32 v26, v18, v18
 v_lshlrev_b32 v18, 16, v26
 v_cvt_pk_bf16_f32 v26, v19, v19
 v_lshlrev_b32 v19, 16, v26
 v_mul_f32 v12, v12, v25
 v_cvt_pk_bf16_f32 v26, v12, v12
 v_lshlrev_b32 v12, 16, v26
 v_mul_f32 v13, v13, v25
 v_cvt_pk_bf16_f32 v26, v13, v13
 v_lshlrev_b32 v13, 16, v26
 v_mul_f32 v14, v14, v25
 v_cvt_pk_bf16_f32 v26, v14, v14
 v_lshlrev_b32 v14, 16, v26
 v_mul_f32 v15, v15, v25
 v_cvt_pk_bf16_f32 v26, v15, v15
 v_lshlrev_b32 v15, 16, v26
 v_mul_f32 v16, v16, v25
 v_cvt_pk_bf16_f32 v26, v16, v16
 v_lshlrev_b32 v16, 16, v26
 v_mul_f32 v17, v17, v25
 v_cvt_pk_bf16_f32 v26, v17, v17
 v_lshlrev_b32 v17, 16, v26
 v_mul_f32 v18, v18, v25
 v_cvt_pk_bf16_f32 v26, v18, v18
 v_lshlrev_b32 v18, 16, v26
 v_mul_f32 v19, v19, v25
 v_cvt_pk_bf16_f32 v26, v19, v19
 v_lshlrev_b32 v19, 16, v26
 s_cmp_ge_u32 s40, 52
 s_cbranch_scc1 pvt_259
 s_cmp_lg_u32 s20, 0
 s_cbranch_scc1 wm_261
 s_mov_b32 s101, 0
wm_260:
 buffer_load_dword v26, v7, s[72:75], s52 offen sc1
 s_add_u32 s101, s101, 1
 s_cmp_gt_u32 s101, 131072
 s_cbranch_scc1 main_end
 s_waitcnt vmcnt(0)
 v_cmp_gt_u32 vcc, 4, v26
 v_readfirstlane_b32 s100, v26
 s_nop 0
 s_cbranch_vccz wm_261
 s_sleep 2
 s_add_u32 s100, s100, 3
 s_cmp_ge_u32 s100, 4
 s_cbranch_scc1 wm_260
 s_sleep 24
 s_branch wm_260
wm_261:
 s_barrier
 buffer_load_dwordx4 v[64:67], v4, s[16:19], s47 offen sc1
 buffer_load_dwordx2 v[68:69], v5, s[16:19], s47 offen offset:1536 sc1
 buffer_load_dwordx4 v[128:131], v21, s[16:19], s47 offen offset:1024 sc1
 buffer_load_dwordx4 v[132:135], v21, s[16:19], s47 offen offset:1280 sc1
 s_add_u32 s47, s47, 2048
 buffer_load_dwordx4 v[72:75], v4, s[16:19], s47 offen sc1
 buffer_load_dwordx2 v[76:77], v5, s[16:19], s47 offen offset:1536 sc1
 s_add_u32 s47, s47, 2048
 buffer_load_dwordx4 v[80:83], v4, s[16:19], s47 offen sc1
 buffer_load_dwordx2 v[84:85], v5, s[16:19], s47 offen offset:1536 sc1
 s_add_u32 s47, s47, 2048
 buffer_load_dwordx4 v[88:91], v4, s[16:19], s47 offen sc1
 buffer_load_dwordx2 v[92:93], v5, s[16:19], s47 offen offset:1536 sc1
 s_add_u32 s47, s47, 10240
 buffer_load_dwordx4 v[32:35], v22, s[16:19], s48 offen offset:0 sc1
 buffer_load_dwordx4 v[36:39], v22, s[16:19], s48 offen offset:256 sc1
 buffer_load_dwordx4 v[40:43], v22, s[16:19], s48 offen offset:512 sc1
 buffer_load_dwordx4 v[44:47], v22, s[16:19], s48 offen offset:768 sc1
 s_add_u32 s48, s48, 4096
 buffer_load_dwordx4 v[96:99], v4, s[16:19], s47 offen sc1
 buffer_load_dwordx2 v[100:101], v5, s[16:19], s47 offen offset:1536 sc1
 buffer_load_dwordx4 v[136:139], v21, s[16:19], s47 offen offset:1024 sc1
 buffer_load_dwordx4 v[140:143], v21, s[16:19], s47 offen offset:1280 sc1
 s_add_u32 s47, s47, 2048
 buffer_load_dwordx4 v[104:107], v4, s[16:19], s47 offen sc1
 buffer_load_dwordx2 v[108:109], v5, s[16:19], s47 offen offset:1536 sc1
 s_add_u32 s47, s47, 2048
 buffer_load_dwordx4 v[112:115], v4, s[16:19], s47 offen sc1
 buffer_load_dwordx2 v[116:117], v5, s[16:19], s47 offen offset:1536 sc1
 s_add_u32 s47, s47, 2048
 buffer_load_dwordx4 v[120:123], v4, s[16:19], s47 offen sc1
 buffer_load_dwordx2 v[124:125], v5, s[16:19], s47 offen offset:1536 sc1
 s_add_u32 s47, s47, 10240
 buffer_load_dwordx4 v[48:51], v22, s[16:19], s48 offen offset:0 sc1
 buffer_load_dwordx4 v[52:55], v22, s[16:19], s48 offen offset:256 sc1
 buffer_load_dwordx4 v[56:59], v22, s[16:19], s48 offen offset:512 sc1
 buffer_load_dwordx4 v[60:63], v22, s[16:19], s48 offen offset:768 sc1
 s_add_u32 s48, s48, 4096
pvg_256:
 s_add_u32 s41, s41, 1
 s_mul_i32 s53, s42, 40960
 s_lshl_b32 s22, s41, 12
 s_add_u32 s53, s53, s22
 s_lshl_b32 s48, s41, 16
 s_lshl_b32 s22, s20, 14
 s_add_u32 s48, s48, s22
 s_add_u32 s48, s48, s61
 s_waitcnt vmcnt(26)
 v_mfma_f32_16x16x32_bf16 v[148:151], a[0:3], v[64:67], 0
 v_mfma_f32_16x16x32_bf16 v[144:147], a[0:3], v[68:71], 0
 v_mfma_f32_16x16x32_bf16 v[156:159], a[4:7], v[64:67], 0
 v_mfma_f32_16x16x32_bf16 v[152:155], a[4:7], v[68:71], 0
 v_mfma_f32_16x16x32_bf16 v[164:167], a[8:11], v[64:67], 0
 v_mfma_f32_16x16x32_bf16 v[160:163], a[8:11], v[68:71], 0
 v_mfma_f32_16x16x32_bf16 v[172:175], a[12:15], v[64:67], 0
 v_mfma_f32_16x16x32_bf16 v[168:171], a[12:15], v[68:71], 0
 buffer_load_dwordx4 a[0:3], v4, s[12:15], s53 offen offset:0 sc1
 buffer_load_dwordx4 a[4:7], v4, s[12:15], s53 offen offset:1024 sc1
 buffer_load_dwordx4 a[8:11], v4, s[12:15], s53 offen offset:2048 sc1
 buffer_load_dwordx4 a[12:15], v4, s[12:15], s53 offen offset:3072 sc1
 s_waitcnt vmcnt(26)
 v_mfma_f32_16x16x32_bf16 v[148:151], a[16:19], v[72:75], v[148:151]
 v_mfma_f32_16x16x32_bf16 v[144:147], a[16:19], v[76:79], v[144:147]
 v_mfma_f32_16x16x32_bf16 v[156:159], a[20:23], v[72:75], v[156:159]
 v_mfma_f32_16x16x32_bf16 v[152:155], a[20:23], v[76:79], v[152:155]
 v_mfma_f32_16x16x32_bf16 v[164:167], a[24:27], v[72:75], v[164:167]
 v_mfma_f32_16x16x32_bf16 v[160:163], a[24:27], v[76:79], v[160:163]
 v_mfma_f32_16x16x32_bf16 v[172:175], a[28:31], v[72:75], v[172:175]
 v_mfma_f32_16x16x32_bf16 v[168:171], a[28:31], v[76:79], v[168:171]
 s_add_u32 s53, s53, 40960
 buffer_load_dwordx4 a[16:19], v4, s[12:15], s53 offen offset:0 sc1
 buffer_load_dwordx4 a[20:23], v4, s[12:15], s53 offen offset:1024 sc1
 buffer_load_dwordx4 a[24:27], v4, s[12:15], s53 offen offset:2048 sc1
 buffer_load_dwordx4 a[28:31], v4, s[12:15], s53 offen offset:3072 sc1
 s_waitcnt vmcnt(28)
 v_mfma_f32_16x16x32_bf16 v[148:151], a[32:35], v[80:83], v[148:151]
 v_mfma_f32_16x16x32_bf16 v[144:147], a[32:35], v[84:87], v[144:147]
 v_mfma_f32_16x16x32_bf16 v[156:159], a[36:39], v[80:83], v[156:159]
 v_mfma_f32_16x16x32_bf16 v[152:155], a[36:39], v[84:87], v[152:155]
 v_mfma_f32_16x16x32_bf16 v[164:167], a[40:43], v[80:83], v[164:167]
 v_mfma_f32_16x16x32_bf16 v[160:163], a[40:43], v[84:87], v[160:163]
 v_mfma_f32_16x16x32_bf16 v[172:175], a[44:47], v[80:83], v[172:175]
 v_mfma_f32_16x16x32_bf16 v[168:171], a[44:47], v[84:87], v[168:171]
 s_add_u32 s53, s53, 40960
 buffer_load_dwordx4 a[32:35], v4, s[12:15], s53 offen offset:0 sc1
 buffer_load_dwordx4 a[36:39], v4, s[12:15], s53 offen offset:1024 sc1
 buffer_load_dwordx4 a[40:43], v4, s[12:15], s53 offen offset:2048 sc1
 buffer_load_dwordx4 a[44:47], v4, s[12:15], s53 offen offset:3072 sc1
 s_waitcnt vmcnt(30)
 v_mfma_f32_16x16x32_bf16 v[148:151], a[48:51], v[88:91], v[148:151]
 v_mfma_f32_16x16x32_bf16 v[144:147], a[48:51], v[92:95], v[144:147]
 v_mfma_f32_16x16x32_bf16 v[156:159], a[52:55], v[88:91], v[156:159]
 v_mfma_f32_16x16x32_bf16 v[152:155], a[52:55], v[92:95], v[152:155]
 v_mfma_f32_16x16x32_bf16 v[164:167], a[56:59], v[88:91], v[164:167]
 v_mfma_f32_16x16x32_bf16 v[160:163], a[56:59], v[92:95], v[160:163]
 v_mfma_f32_16x16x32_bf16 v[172:175], a[60:63], v[88:91], v[172:175]
 v_mfma_f32_16x16x32_bf16 v[168:171], a[60:63], v[92:95], v[168:171]
 s_add_u32 s53, s53, 40960
 buffer_load_dwordx4 a[48:51], v4, s[12:15], s53 offen offset:0 sc1
 buffer_load_dwordx4 a[52:55], v4, s[12:15], s53 offen offset:1024 sc1
 buffer_load_dwordx4 a[56:59], v4, s[12:15], s53 offen offset:2048 sc1
 buffer_load_dwordx4 a[60:63], v4, s[12:15], s53 offen offset:3072 sc1
 s_waitcnt vmcnt(30)
 v_mfma_f32_16x16x32_bf16 v[144:147], v[32:35], v[128:131], v[144:147]
 v_mfma_f32_16x16x32_bf16 v[148:151], v[32:35], v[132:135], v[148:151]
 v_mfma_f32_16x16x32_bf16 v[152:155], v[36:39], v[128:131], v[152:155]
 v_mfma_f32_16x16x32_bf16 v[156:159], v[36:39], v[132:135], v[156:159]
 v_mfma_f32_16x16x32_bf16 v[160:163], v[40:43], v[128:131], v[160:163]
 v_mfma_f32_16x16x32_bf16 v[164:167], v[40:43], v[132:135], v[164:167]
 v_mfma_f32_16x16x32_bf16 v[168:171], v[44:47], v[128:131], v[168:171]
 v_mfma_f32_16x16x32_bf16 v[172:175], v[44:47], v[132:135], v[172:175]
 buffer_load_dwordx4 v[32:35], v22, s[16:19], s48 offen offset:0 sc1
 buffer_load_dwordx4 v[36:39], v22, s[16:19], s48 offen offset:256 sc1
 buffer_load_dwordx4 v[40:43], v22, s[16:19], s48 offen offset:512 sc1
 buffer_load_dwordx4 v[44:47], v22, s[16:19], s48 offen offset:768 sc1
 s_add_u32 s48, s48, 4096
 s_waitcnt vmcnt(32)
 v_mfma_f32_16x16x32_bf16 v[148:151], a[64:67], v[96:99], v[148:151]
 v_mfma_f32_16x16x32_bf16 v[144:147], a[64:67], v[100:103], v[144:147]
 v_mfma_f32_16x16x32_bf16 v[156:159], a[68:71], v[96:99], v[156:159]
 v_mfma_f32_16x16x32_bf16 v[152:155], a[68:71], v[100:103], v[152:155]
 v_mfma_f32_16x16x32_bf16 v[164:167], a[72:75], v[96:99], v[164:167]
 v_mfma_f32_16x16x32_bf16 v[160:163], a[72:75], v[100:103], v[160:163]
 v_mfma_f32_16x16x32_bf16 v[172:175], a[76:79], v[96:99], v[172:175]
 v_mfma_f32_16x16x32_bf16 v[168:171], a[76:79], v[100:103], v[168:171]
 s_add_u32 s53, s53, 40960
 buffer_load_dwordx4 a[64:67], v4, s[12:15], s53 offen offset:0 sc1
 buffer_load_dwordx4 a[68:71], v4, s[12:15], s53 offen offset:1024 sc1
 buffer_load_dwordx4 a[72:75], v4, s[12:15], s53 offen offset:2048 sc1
 buffer_load_dwordx4 a[76:79], v4, s[12:15], s53 offen offset:3072 sc1
 s_waitcnt vmcnt(32)
 v_mfma_f32_16x16x32_bf16 v[148:151], a[80:83], v[104:107], v[148:151]
 v_mfma_f32_16x16x32_bf16 v[144:147], a[80:83], v[108:111], v[144:147]
 v_mfma_f32_16x16x32_bf16 v[156:159], a[84:87], v[104:107], v[156:159]
 v_mfma_f32_16x16x32_bf16 v[152:155], a[84:87], v[108:111], v[152:155]
 v_mfma_f32_16x16x32_bf16 v[164:167], a[88:91], v[104:107], v[164:167]
 v_mfma_f32_16x16x32_bf16 v[160:163], a[88:91], v[108:111], v[160:163]
 v_mfma_f32_16x16x32_bf16 v[172:175], a[92:95], v[104:107], v[172:175]
 v_mfma_f32_16x16x32_bf16 v[168:171], a[92:95], v[108:111], v[168:171]
 s_add_u32 s53, s53, 40960
 buffer_load_dwordx4 a[80:83], v4, s[12:15], s53 offen offset:0 sc1
 buffer_load_dwordx4 a[84:87], v4, s[12:15], s53 offen offset:1024 sc1
 buffer_load_dwordx4 a[88:91], v4, s[12:15], s53 offen offset:2048 sc1
 buffer_load_dwordx4 a[92:95], v4, s[12:15], s53 offen offset:3072 sc1
 s_waitcnt vmcnt(34)
 v_mfma_f32_16x16x32_bf16 v[148:151], a[96:99], v[112:115], v[148:151]
 v_mfma_f32_16x16x32_bf16 v[144:147], a[96:99], v[116:119], v[144:147]
 v_mfma_f32_16x16x32_bf16 v[156:159], a[100:103], v[112:115], v[156:159]
 v_mfma_f32_16x16x32_bf16 v[152:155], a[100:103], v[116:119], v[152:155]
 v_mfma_f32_16x16x32_bf16 v[164:167], a[104:107], v[112:115], v[164:167]
 v_mfma_f32_16x16x32_bf16 v[160:163], a[104:107], v[116:119], v[160:163]
 v_mfma_f32_16x16x32_bf16 v[172:175], a[108:111], v[112:115], v[172:175]
 v_mfma_f32_16x16x32_bf16 v[168:171], a[108:111], v[116:119], v[168:171]
 s_add_u32 s53, s53, 40960
 buffer_load_dwordx4 a[96:99], v4, s[12:15], s53 offen offset:0 sc1
 buffer_load_dwordx4 a[100:103], v4, s[12:15], s53 offen offset:1024 sc1
 buffer_load_dwordx4 a[104:107], v4, s[12:15], s53 offen offset:2048 sc1
 buffer_load_dwordx4 a[108:111], v4, s[12:15], s53 offen offset:3072 sc1
 s_waitcnt vmcnt(36)
 v_mfma_f32_16x16x32_bf16 v[148:151], a[112:115], v[120:123], v[148:151]
 v_mfma_f32_16x16x32_bf16 v[144:147], a[112:115], v[124:127], v[144:147]
 v_mfma_f32_16x16x32_bf16 v[156:159], a[116:119], v[120:123], v[156:159]
 v_mfma_f32_16x16x32_bf16 v[152:155], a[116:119], v[124:127], v[152:155]
 v_mfma_f32_16x16x32_bf16 v[164:167], a[120:123], v[120:123], v[164:167]
 v_mfma_f32_16x16x32_bf16 v[160:163], a[120:123], v[124:127], v[160:163]
 v_mfma_f32_16x16x32_bf16 v[172:175], a[124:127], v[120:123], v[172:175]
 v_mfma_f32_16x16x32_bf16 v[168:171], a[124:127], v[124:127], v[168:171]
 s_add_u32 s53, s53, 40960
 buffer_load_dwordx4 a[112:115], v4, s[12:15], s53 offen offset:0 sc1
 buffer_load_dwordx4 a[116:119], v4, s[12:15], s53 offen offset:1024 sc1
 buffer_load_dwordx4 a[120:123], v4, s[12:15], s53 offen offset:2048 sc1
 buffer_load_dwordx4 a[124:127], v4, s[12:15], s53 offen offset:3072 sc1
 s_waitcnt vmcnt(36)
 v_mfma_f32_16x16x32_bf16 v[144:147], v[48:51], v[136:139], v[144:147]
 v_mfma_f32_16x16x32_bf16 v[148:151], v[48:51], v[140:143], v[148:151]
 v_mfma_f32_16x16x32_bf16 v[152:155], v[52:55], v[136:139], v[152:155]
 v_mfma_f32_16x16x32_bf16 v[156:159], v[52:55], v[140:143], v[156:159]
 v_mfma_f32_16x16x32_bf16 v[160:163], v[56:59], v[136:139], v[160:163]
 v_mfma_f32_16x16x32_bf16 v[164:167], v[56:59], v[140:143], v[164:167]
 v_mfma_f32_16x16x32_bf16 v[168:171], v[60:63], v[136:139], v[168:171]
 v_mfma_f32_16x16x32_bf16 v[172:175], v[60:63], v[140:143], v[172:175]
 buffer_load_dwordx4 v[48:51], v22, s[16:19], s48 offen offset:0 sc1
 buffer_load_dwordx4 v[52:55], v22, s[16:19], s48 offen offset:256 sc1
 buffer_load_dwordx4 v[56:59], v22, s[16:19], s48 offen offset:512 sc1
 buffer_load_dwordx4 v[60:63], v22, s[16:19], s48 offen offset:768 sc1
 s_add_u32 s48, s48, 4096
 s_branch pve_252
pvt_259:
 s_sub_u32 s55, s52, 2048
 s_cmp_lg_u32 s20, 0
 s_cbranch_scc1 wm_263
 s_mov_b32 s101, 0
wm_262:
 buffer_load_dword v26, v7, s[72:75], s55 offen sc1
 s_add_u32 s101, s101, 1
 s_cmp_gt_u32 s101, 131072
 s_cbranch_scc1 main_end
 s_waitcnt vmcnt(0)
 v_cmp_gt_u32 vcc, 4, v26
 v_readfirstlane_b32 s100, v26
 s_nop 0
 s_cbranch_vccz wm_263
 s_sleep 4
 s_add_u32 s100, s100, 3
 s_cmp_ge_u32 s100, 4
 s_cbranch_scc1 wm_262
 s_sleep 24
 s_branch wm_262
wm_263:
 s_barrier
 s_mov_b32 s56, s47
 s_mov_b32 s57, s48
 buffer_load_dwordx4 v[64:67], v4, s[16:19], s56 offen sc1
 buffer_load_dwordx2 v[68:69], v5, s[16:19], s56 offen offset:1536 sc1
 buffer_load_dwordx4 v[128:131], v21, s[16:19], s56 offen offset:1024 sc1
 buffer_load_dwordx4 v[132:135], v21, s[16:19], s56 offen offset:1280 sc1
 s_add_u32 s56, s56, 2048
 buffer_load_dwordx4 v[72:75], v4, s[16:19], s56 offen sc1
 buffer_load_dwordx2 v[76:77], v5, s[16:19], s56 offen offset:1536 sc1
 s_add_u32 s56, s56, 2048
 buffer_load_dwordx4 v[80:83], v4, s[16:19], s56 offen sc1
 buffer_load_dwordx2 v[84:85], v5, s[16:19], s56 offen offset:1536 sc1
 s_add_u32 s56, s56, 2048
 buffer_load_dwordx4 v[88:91], v4, s[16:19], s56 offen sc1
 buffer_load_dwordx2 v[92:93], v5, s[16:19], s56 offen offset:1536 sc1
 s_add_u32 s56, s56, 10240
 buffer_load_dwordx4 v[32:35], v22, s[16:19], s57 offen offset:0 sc1
 buffer_load_dwordx4 v[36:39], v22, s[16:19], s57 offen offset:256 sc1
 buffer_load_dwordx4 v[40:43], v22, s[16:19], s57 offen offset:512 sc1
 buffer_load_dwordx4 v[44:47], v22, s[16:19], s57 offen offset:768 sc1
 s_add_u32 s57, s57, 4096
 buffer_load_dwordx4 v[96:99], v4, s[16:19], s56 offen sc1
 buffer_load_dwordx2 v[100:101], v5, s[16:19], s56 offen offset:1536 sc1
 buffer_load_dwordx4 v[136:139], v21, s[16:19], s56 offen offset:1024 sc1
 buffer_load_dwordx4 v[140:143], v21, s[16:19], s56 offen offset:1280 sc1
 s_add_u32 s56, s56, 2048
 buffer_load_dwordx4 v[104:107], v4, s[16:19], s56 offen sc1
 buffer_load_dwordx2 v[108:109], v5, s[16:19], s56 offen offset:1536 sc1
 s_add_u32 s56, s56, 2048
 buffer_load_dwordx4 v[112:115], v4, s[16:19], s56 offen sc1
 buffer_load_dwordx2 v[116:117], v5, s[16:19], s56 offen offset:1536 sc1
 s_add_u32 s56, s56, 2048
 buffer_load_dwordx4 v[120:123], v4, s[16:19], s56 offen sc1
 buffer_load_dwordx2 v[124:125], v5, s[16:19], s56 offen offset:1536 sc1
 s_add_u32 s56, s56, 10240
 buffer_load_dwordx4 v[48:51], v22, s[16:19], s57 offen offset:0 sc1
 buffer_load_dwordx4 v[52:55], v22, s[16:19], s57 offen offset:256 sc1
 buffer_load_dwordx4 v[56:59], v22, s[16:19], s57 offen offset:512 sc1
 buffer_load_dwordx4 v[60:63], v22, s[16:19], s57 offen offset:768 sc1
 s_add_u32 s57, s57, 4096
pvc_257:
 s_mov_b32 s101, 0
 s_waitcnt vmcnt(14)
 s_branch pvr_265
pvr_264:
 s_sleep 2
 s_add_u32 s56, s47, 0
 s_add_u32 s57, s48, 0
 buffer_load_dwordx4 v[64:67], v4, s[16:19], s56 offen sc1
 buffer_load_dwordx2 v[68:69], v5, s[16:19], s56 offen offset:1536 sc1
 buffer_load_dwordx4 v[128:131], v21, s[16:19], s56 offen offset:1024 sc1
 buffer_load_dwordx4 v[132:135], v21, s[16:19], s56 offen offset:1280 sc1
 s_add_u32 s56, s56, 2048
 buffer_load_dwordx4 v[72:75], v4, s[16:19], s56 offen sc1
 buffer_load_dwordx2 v[76:77], v5, s[16:19], s56 offen offset:1536 sc1
 s_add_u32 s56, s56, 2048
 buffer_load_dwordx4 v[80:83], v4, s[16:19], s56 offen sc1
 buffer_load_dwordx2 v[84:85], v5, s[16:19], s56 offen offset:1536 sc1
 s_add_u32 s56, s56, 2048
 buffer_load_dwordx4 v[88:91], v4, s[16:19], s56 offen sc1
 buffer_load_dwordx2 v[92:93], v5, s[16:19], s56 offen offset:1536 sc1
 s_add_u32 s56, s56, 10240
 buffer_load_dwordx4 v[32:35], v22, s[16:19], s57 offen offset:0 sc1
 buffer_load_dwordx4 v[36:39], v22, s[16:19], s57 offen offset:256 sc1
 buffer_load_dwordx4 v[40:43], v22, s[16:19], s57 offen offset:512 sc1
 buffer_load_dwordx4 v[44:47], v22, s[16:19], s57 offen offset:768 sc1
 s_add_u32 s57, s57, 4096
 s_add_u32 s101, s101, 1
 s_cmp_gt_u32 s101, 131072
 s_cbranch_scc1 main_end
 s_waitcnt vmcnt(0)
pvr_265:
 v_max3_u32 v26, v64, v68, v72
 v_max3_u32 v26, v26, v76, v80
 v_max3_u32 v26, v26, v84, v88
 v_max3_u32 v26, v26, v92, v128
 v_max3_u32 v26, v26, v132, v32
 v_max3_u32 v26, v26, v36, v40
 v_max3_u32 v26, v26, v44, v44
 v_cmp_eq_u32 vcc, -1, v26
 s_nop 1
 s_cbranch_vccnz pvr_264
 v_mfma_f32_16x16x32_bf16 v[148:151], a[0:3], v[64:67], 0
 v_mfma_f32_16x16x32_bf16 v[144:147], a[0:3], v[68:71], 0
 v_mfma_f32_16x16x32_bf16 v[156:159], a[4:7], v[64:67], 0
 v_mfma_f32_16x16x32_bf16 v[152:155], a[4:7], v[68:71], 0
 v_mfma_f32_16x16x32_bf16 v[164:167], a[8:11], v[64:67], 0
 v_mfma_f32_16x16x32_bf16 v[160:163], a[8:11], v[68:71], 0
 v_mfma_f32_16x16x32_bf16 v[172:175], a[12:15], v[64:67], 0
 v_mfma_f32_16x16x32_bf16 v[168:171], a[12:15], v[68:71], 0
 v_mfma_f32_16x16x32_bf16 v[148:151], a[16:19], v[72:75], v[148:151]
 v_mfma_f32_16x16x32_bf16 v[144:147], a[16:19], v[76:79], v[144:147]
 v_mfma_f32_16x16x32_bf16 v[156:159], a[20:23], v[72:75], v[156:159]
 v_mfma_f32_16x16x32_bf16 v[152:155], a[20:23], v[76:79], v[152:155]
 v_mfma_f32_16x16x32_bf16 v[164:167], a[24:27], v[72:75], v[164:167]
 v_mfma_f32_16x16x32_bf16 v[160:163], a[24:27], v[76:79], v[160:163]
 v_mfma_f32_16x16x32_bf16 v[172:175], a[28:31], v[72:75], v[172:175]
 v_mfma_f32_16x16x32_bf16 v[168:171], a[28:31], v[76:79], v[168:171]
 v_mfma_f32_16x16x32_bf16 v[148:151], a[32:35], v[80:83], v[148:151]
 v_mfma_f32_16x16x32_bf16 v[144:147], a[32:35], v[84:87], v[144:147]
 v_mfma_f32_16x16x32_bf16 v[156:159], a[36:39], v[80:83], v[156:159]
 v_mfma_f32_16x16x32_bf16 v[152:155], a[36:39], v[84:87], v[152:155]
 v_mfma_f32_16x16x32_bf16 v[164:167], a[40:43], v[80:83], v[164:167]
 v_mfma_f32_16x16x32_bf16 v[160:163], a[40:43], v[84:87], v[160:163]
 v_mfma_f32_16x16x32_bf16 v[172:175], a[44:47], v[80:83], v[172:175]
 v_mfma_f32_16x16x32_bf16 v[168:171], a[44:47], v[84:87], v[168:171]
 v_mfma_f32_16x16x32_bf16 v[148:151], a[48:51], v[88:91], v[148:151]
 v_mfma_f32_16x16x32_bf16 v[144:147], a[48:51], v[92:95], v[144:147]
 v_mfma_f32_16x16x32_bf16 v[156:159], a[52:55], v[88:91], v[156:159]
 v_mfma_f32_16x16x32_bf16 v[152:155], a[52:55], v[92:95], v[152:155]
 v_mfma_f32_16x16x32_bf16 v[164:167], a[56:59], v[88:91], v[164:167]
 v_mfma_f32_16x16x32_bf16 v[160:163], a[56:59], v[92:95], v[160:163]
 v_mfma_f32_16x16x32_bf16 v[172:175], a[60:63], v[88:91], v[172:175]
 v_mfma_f32_16x16x32_bf16 v[168:171], a[60:63], v[92:95], v[168:171]
 s_nop 1
 v_mfma_f32_16x16x32_bf16 v[144:147], v[32:35], v[128:131], v[144:147]
 v_mfma_f32_16x16x32_bf16 v[148:151], v[32:35], v[132:135], v[148:151]
 v_mfma_f32_16x16x32_bf16 v[152:155], v[36:39], v[128:131], v[152:155]
 v_mfma_f32_16x16x32_bf16 v[156:159], v[36:39], v[132:135], v[156:159]
 v_mfma_f32_16x16x32_bf16 v[160:163], v[40:43], v[128:131], v[160:163]
 v_mfma_f32_16x16x32_bf16 v[164:167], v[40:43], v[132:135], v[164:167]
 v_mfma_f32_16x16x32_bf16 v[168:171], v[44:47], v[128:131], v[168:171]
 v_mfma_f32_16x16x32_bf16 v[172:175], v[44:47], v[132:135], v[172:175]
 s_mov_b32 s101, 0
 s_waitcnt vmcnt(0)
 s_branch pvr_267
pvr_266:
 s_sleep 2
 s_add_u32 s56, s47, 16384
 s_add_u32 s57, s48, 4096
 buffer_load_dwordx4 v[96:99], v4, s[16:19], s56 offen sc1
 buffer_load_dwordx2 v[100:101], v5, s[16:19], s56 offen offset:1536 sc1
 buffer_load_dwordx4 v[136:139], v21, s[16:19], s56 offen offset:1024 sc1
 buffer_load_dwordx4 v[140:143], v21, s[16:19], s56 offen offset:1280 sc1
 s_add_u32 s56, s56, 2048
 buffer_load_dwordx4 v[104:107], v4, s[16:19], s56 offen sc1
 buffer_load_dwordx2 v[108:109], v5, s[16:19], s56 offen offset:1536 sc1
 s_add_u32 s56, s56, 2048
 buffer_load_dwordx4 v[112:115], v4, s[16:19], s56 offen sc1
 buffer_load_dwordx2 v[116:117], v5, s[16:19], s56 offen offset:1536 sc1
 s_add_u32 s56, s56, 2048
 buffer_load_dwordx4 v[120:123], v4, s[16:19], s56 offen sc1
 buffer_load_dwordx2 v[124:125], v5, s[16:19], s56 offen offset:1536 sc1
 s_add_u32 s56, s56, 10240
 buffer_load_dwordx4 v[48:51], v22, s[16:19], s57 offen offset:0 sc1
 buffer_load_dwordx4 v[52:55], v22, s[16:19], s57 offen offset:256 sc1
 buffer_load_dwordx4 v[56:59], v22, s[16:19], s57 offen offset:512 sc1
 buffer_load_dwordx4 v[60:63], v22, s[16:19], s57 offen offset:768 sc1
 s_add_u32 s57, s57, 4096
 s_add_u32 s101, s101, 1
 s_cmp_gt_u32 s101, 131072
 s_cbranch_scc1 main_end
 s_waitcnt vmcnt(0)
pvr_267:
 v_max3_u32 v26, v96, v100, v104
 v_max3_u32 v26, v26, v108, v112
 v_max3_u32 v26, v26, v116, v120
 v_max3_u32 v26, v26, v124, v136
 v_max3_u32 v26, v26, v140, v48
 v_max3_u32 v26, v26, v52, v56
 v_max3_u32 v26, v26, v60, v60
 v_cmp_eq_u32 vcc, -1, v26
 s_nop 1
 s_cbranch_vccnz pvr_266
 v_mfma_f32_16x16x32_bf16 v[148:151], a[64:67], v[96:99], v[148:151]
 v_mfma_f32_16x16x32_bf16 v[144:147], a[64:67], v[100:103], v[144:147]
 v_mfma_f32_16x16x32_bf16 v[156:159], a[68:71], v[96:99], v[156:159]
 v_mfma_f32_16x16x32_bf16 v[152:155], a[68:71], v[100:103], v[152:155]
 v_mfma_f32_16x16x32_bf16 v[164:167], a[72:75], v[96:99], v[164:167]
 v_mfma_f32_16x16x32_bf16 v[160:163], a[72:75], v[100:103], v[160:163]
 v_mfma_f32_16x16x32_bf16 v[172:175], a[76:79], v[96:99], v[172:175]
 v_mfma_f32_16x16x32_bf16 v[168:171], a[76:79], v[100:103], v[168:171]
 v_mfma_f32_16x16x32_bf16 v[148:151], a[80:83], v[104:107], v[148:151]
 v_mfma_f32_16x16x32_bf16 v[144:147], a[80:83], v[108:111], v[144:147]
 v_mfma_f32_16x16x32_bf16 v[156:159], a[84:87], v[104:107], v[156:159]
 v_mfma_f32_16x16x32_bf16 v[152:155], a[84:87], v[108:111], v[152:155]
 v_mfma_f32_16x16x32_bf16 v[164:167], a[88:91], v[104:107], v[164:167]
 v_mfma_f32_16x16x32_bf16 v[160:163], a[88:91], v[108:111], v[160:163]
 v_mfma_f32_16x16x32_bf16 v[172:175], a[92:95], v[104:107], v[172:175]
 v_mfma_f32_16x16x32_bf16 v[168:171], a[92:95], v[108:111], v[168:171]
 v_mfma_f32_16x16x32_bf16 v[148:151], a[96:99], v[112:115], v[148:151]
 v_mfma_f32_16x16x32_bf16 v[144:147], a[96:99], v[116:119], v[144:147]
 v_mfma_f32_16x16x32_bf16 v[156:159], a[100:103], v[112:115], v[156:159]
 v_mfma_f32_16x16x32_bf16 v[152:155], a[100:103], v[116:119], v[152:155]
 v_mfma_f32_16x16x32_bf16 v[164:167], a[104:107], v[112:115], v[164:167]
 v_mfma_f32_16x16x32_bf16 v[160:163], a[104:107], v[116:119], v[160:163]
 v_mfma_f32_16x16x32_bf16 v[172:175], a[108:111], v[112:115], v[172:175]
 v_mfma_f32_16x16x32_bf16 v[168:171], a[108:111], v[116:119], v[168:171]
 v_mfma_f32_16x16x32_bf16 v[148:151], a[112:115], v[120:123], v[148:151]
 v_mfma_f32_16x16x32_bf16 v[144:147], a[112:115], v[124:127], v[144:147]
 v_mfma_f32_16x16x32_bf16 v[156:159], a[116:119], v[120:123], v[156:159]
 v_mfma_f32_16x16x32_bf16 v[152:155], a[116:119], v[124:127], v[152:155]
 v_mfma_f32_16x16x32_bf16 v[164:167], a[120:123], v[120:123], v[164:167]
 v_mfma_f32_16x16x32_bf16 v[160:163], a[120:123], v[124:127], v[160:163]
 v_mfma_f32_16x16x32_bf16 v[172:175], a[124:127], v[120:123], v[172:175]
 v_mfma_f32_16x16x32_bf16 v[168:171], a[124:127], v[124:127], v[168:171]
 s_nop 1
 v_mfma_f32_16x16x32_bf16 v[144:147], v[48:51], v[136:139], v[144:147]
 v_mfma_f32_16x16x32_bf16 v[148:151], v[48:51], v[140:143], v[148:151]
 v_mfma_f32_16x16x32_bf16 v[152:155], v[52:55], v[136:139], v[152:155]
 v_mfma_f32_16x16x32_bf16 v[156:159], v[52:55], v[140:143], v[156:159]
 v_mfma_f32_16x16x32_bf16 v[160:163], v[56:59], v[136:139], v[160:163]
 v_mfma_f32_16x16x32_bf16 v[164:167], v[56:59], v[140:143], v[164:167]
 v_mfma_f32_16x16x32_bf16 v[168:171], v[60:63], v[136:139], v[168:171]
 v_mfma_f32_16x16x32_bf16 v[172:175], v[60:63], v[140:143], v[172:175]
pve_252:
 s_nop 0
 s_or_b32 s21, s20, s65
 s_cbranch_scc1 lc_268
 s_sub_u32 s21, s2, 0
 s_cmp_ge_u32 s21, 640
 s_cbranch_scc1 lc_268
 v_mov_b32 v29, 1
 s_mov_b64 exec, 1
 buffer_atomic_add v29, v28, s[32:35], 0 offen sc0 sc1
 s_mov_b64 exec, -1
lc_268:
 ds_write_b128 v10, v[144:147] offset:0
 ds_write_b128 v10, v[148:151] offset:1024
 ds_write_b128 v10, v[152:155] offset:2048
 ds_write_b128 v10, v[156:159] offset:3072
 ds_write_b128 v10, v[160:163] offset:4096
 ds_write_b128 v10, v[164:167] offset:5120
 ds_write_b128 v10, v[168:171] offset:6144
 ds_write_b128 v10, v[172:175] offset:7168
 s_cmp_lg_u32 s20, 0
 s_cbranch_scc1 pvq_271
 v_readfirstlane_b32 s21, v29
 s_mov_b32 s23, -1
 v_mov_b32 v213, s23
 s_mov_b64 exec, 1
 ds_write_b32 v30, v29
 ds_write_b32 v30, v213 offset:8
 s_mov_b64 exec, -1
pvq_271:
 s_waitcnt lgkmcnt(0)
 s_barrier
 ds_read_b128 v[176:179], v11 offset:0
 ds_read_b128 v[180:183], v11 offset:8192
 ds_read_b128 v[184:187], v11 offset:16384
 ds_read_b128 v[188:191], v11 offset:24576
 ds_read_b128 v[192:195], v11 offset:4096
 ds_read_b128 v[196:199], v11 offset:12288
 ds_read_b128 v[200:203], v11 offset:20480
 ds_read_b128 v[204:207], v11 offset:28672
 ds_read_b32 v23, v30
 ds_read_b32 v213, v30 offset:8
 s_cmp_ge_u32 s40, 48
 s_cbranch_scc1 pvr_274
 s_waitcnt lgkmcnt(6)
 v_pk_add_f32 v[176:177], v[176:177], v[180:181]
 v_pk_add_f32 v[184:185], v[184:185], v[188:189]
 v_pk_add_f32 v[178:179], v[178:179], v[182:183]
 v_pk_add_f32 v[186:187], v[186:187], v[190:191]
 v_pk_add_f32 v[176:177], v[176:177], v[184:185]
 v_pk_add_f32 v[178:179], v[178:179], v[186:187]
 buffer_store_dwordx4 v[176:179], v4, s[24:27], s54 offen offset:0 sc1
 s_waitcnt lgkmcnt(2)
 v_pk_add_f32 v[192:193], v[192:193], v[196:197]
 v_pk_add_f32 v[200:201], v[200:201], v[204:205]
 v_pk_add_f32 v[194:195], v[194:195], v[198:199]
 v_pk_add_f32 v[202:203], v[202:203], v[206:207]
 v_pk_add_f32 v[192:193], v[192:193], v[200:201]
 v_pk_add_f32 v[194:195], v[194:195], v[202:203]
 buffer_store_dwordx4 v[192:195], v4, s[24:27], s54 offen offset:2048 sc1
 s_lshr_b32 s71, s40, 2
 s_lshl_b32 s71, s71, 7
 s_add_u32 s71, s71, 116736
 s_branch pvr_275
pvr_274:
 s_waitcnt lgkmcnt(6)
 v_pk_add_f32 v[176:177], v[176:177], v[180:181]
 v_pk_add_f32 v[184:185], v[184:185], v[188:189]
 v_pk_add_f32 v[178:179], v[178:179], v[182:183]
 v_pk_add_f32 v[186:187], v[186:187], v[190:191]
 v_pk_add_f32 v[176:177], v[176:177], v[184:185]
 v_pk_add_f32 v[178:179], v[178:179], v[186:187]
 v_cvt_pk_bf16_f32 v26, v176, v177
 v_lshlrev_b32 v176, 16, v26
 v_and_b32 v177, 0xffff0000, v26
 v_mul_f32 v176, v176, v24
 v_mul_f32 v177, v177, v24
 v_cvt_pk_bf16_f32 v26, v176, v177
 v_lshlrev_b32 v176, 16, v26
 v_and_b32 v177, 0xffff0000, v26
 v_add_f32 v176, v176, v12
 v_add_f32 v177, v177, v13
 v_cvt_pk_bf16_f32 v180, v176, v177
 v_cvt_pk_bf16_f32 v26, v178, v179
 v_lshlrev_b32 v178, 16, v26
 v_and_b32 v179, 0xffff0000, v26
 v_mul_f32 v178, v178, v24
 v_mul_f32 v179, v179, v24
 v_cvt_pk_bf16_f32 v26, v178, v179
 v_lshlrev_b32 v178, 16, v26
 v_and_b32 v179, 0xffff0000, v26
 v_add_f32 v178, v178, v14
 v_add_f32 v179, v179, v15
 v_cvt_pk_bf16_f32 v181, v178, v179
 buffer_store_dwordx2 v[180:181], v9, s[8:11], s46 offen offset:0
 s_waitcnt lgkmcnt(2)
 v_pk_add_f32 v[192:193], v[192:193], v[196:197]
 v_pk_add_f32 v[200:201], v[200:201], v[204:205]
 v_pk_add_f32 v[194:195], v[194:195], v[198:199]
 v_pk_add_f32 v[202:203], v[202:203], v[206:207]
 v_pk_add_f32 v[192:193], v[192:193], v[200:201]
 v_pk_add_f32 v[194:195], v[194:195], v[202:203]
 v_cvt_pk_bf16_f32 v26, v192, v193
 v_lshlrev_b32 v192, 16, v26
 v_and_b32 v193, 0xffff0000, v26
 v_mul_f32 v192, v192, v24
 v_mul_f32 v193, v193, v24
 v_cvt_pk_bf16_f32 v26, v192, v193
 v_lshlrev_b32 v192, 16, v26
 v_and_b32 v193, 0xffff0000, v26
 v_add_f32 v192, v192, v16
 v_add_f32 v193, v193, v17
 v_cvt_pk_bf16_f32 v196, v192, v193
 v_cvt_pk_bf16_f32 v26, v194, v195
 v_lshlrev_b32 v194, 16, v26
 v_and_b32 v195, 0xffff0000, v26
 v_mul_f32 v194, v194, v24
 v_mul_f32 v195, v195, v24
 v_cvt_pk_bf16_f32 v26, v194, v195
 v_lshlrev_b32 v194, 16, v26
 v_and_b32 v195, 0xffff0000, v26
 v_add_f32 v194, v194, v18
 v_add_f32 v195, v195, v19
 v_cvt_pk_bf16_f32 v197, v194, v195
 buffer_store_dwordx2 v[196:197], v9, s[8:11], s46 offen offset:64
pvr_275:
pvy_276:
 s_cmp_eq_u32 s65, 0
 s_cbranch_scc1 pvy_277
 s_sub_u32 s65, s65, 1
 s_add_u32 s46, s46, 128
 s_add_u32 s54, s54, 16384
 s_cmp_lt_u32 s40, 48
 s_cselect_b32 s70, 0x80000000, s54
 buffer_load_dwordx4 v[12:15], v4, s[24:27], s70 offen sc1
 buffer_load_dwordx4 v[16:19], v4, s[24:27], s70 offen offset:2048 sc1
 buffer_load_dword v24, v6, s[28:31], s45 offen sc1
 s_waitcnt lgkmcnt(0)
 s_barrier
 s_cmp_eq_u32 s65, 0
 s_cbranch_scc1 pvy_278
 s_add_u32 s41, s41, 1
 s_mul_i32 s53, s42, 40960
 s_lshl_b32 s22, s41, 12
 s_add_u32 s53, s53, s22
 s_lshl_b32 s48, s41, 16
 s_lshl_b32 s22, s20, 14
 s_add_u32 s48, s48, s22
 s_add_u32 s48, s48, s61
 s_waitcnt vmcnt(41)
 v_mfma_f32_16x16x32_bf16 v[148:151], a[0:3], v[64:67], 0
 v_mfma_f32_16x16x32_bf16 v[144:147], a[0:3], v[68:71], 0
 v_mfma_f32_16x16x32_bf16 v[156:159], a[4:7], v[64:67], 0
 v_mfma_f32_16x16x32_bf16 v[152:155], a[4:7], v[68:71], 0
 v_mfma_f32_16x16x32_bf16 v[164:167], a[8:11], v[64:67], 0
 v_mfma_f32_16x16x32_bf16 v[160:163], a[8:11], v[68:71], 0
 v_mfma_f32_16x16x32_bf16 v[172:175], a[12:15], v[64:67], 0
 v_mfma_f32_16x16x32_bf16 v[168:171], a[12:15], v[68:71], 0
 buffer_load_dwordx4 a[0:3], v4, s[12:15], s53 offen offset:0 sc1
 buffer_load_dwordx4 a[4:7], v4, s[12:15], s53 offen offset:1024 sc1
 buffer_load_dwordx4 a[8:11], v4, s[12:15], s53 offen offset:2048 sc1
 buffer_load_dwordx4 a[12:15], v4, s[12:15], s53 offen offset:3072 sc1
 s_waitcnt vmcnt(41)
 v_mfma_f32_16x16x32_bf16 v[148:151], a[16:19], v[72:75], v[148:151]
 v_mfma_f32_16x16x32_bf16 v[144:147], a[16:19], v[76:79], v[144:147]
 v_mfma_f32_16x16x32_bf16 v[156:159], a[20:23], v[72:75], v[156:159]
 v_mfma_f32_16x16x32_bf16 v[152:155], a[20:23], v[76:79], v[152:155]
 v_mfma_f32_16x16x32_bf16 v[164:167], a[24:27], v[72:75], v[164:167]
 v_mfma_f32_16x16x32_bf16 v[160:163], a[24:27], v[76:79], v[160:163]
 v_mfma_f32_16x16x32_bf16 v[172:175], a[28:31], v[72:75], v[172:175]
 v_mfma_f32_16x16x32_bf16 v[168:171], a[28:31], v[76:79], v[168:171]
 s_add_u32 s53, s53, 40960
 buffer_load_dwordx4 a[16:19], v4, s[12:15], s53 offen offset:0 sc1
 buffer_load_dwordx4 a[20:23], v4, s[12:15], s53 offen offset:1024 sc1
 buffer_load_dwordx4 a[24:27], v4, s[12:15], s53 offen offset:2048 sc1
 buffer_load_dwordx4 a[28:31], v4, s[12:15], s53 offen offset:3072 sc1
 s_waitcnt vmcnt(41)
 v_mfma_f32_16x16x32_bf16 v[148:151], a[32:35], v[80:83], v[148:151]
 v_mfma_f32_16x16x32_bf16 v[144:147], a[32:35], v[84:87], v[144:147]
 v_mfma_f32_16x16x32_bf16 v[156:159], a[36:39], v[80:83], v[156:159]
 v_mfma_f32_16x16x32_bf16 v[152:155], a[36:39], v[84:87], v[152:155]
 v_mfma_f32_16x16x32_bf16 v[164:167], a[40:43], v[80:83], v[164:167]
 v_mfma_f32_16x16x32_bf16 v[160:163], a[40:43], v[84:87], v[160:163]
 v_mfma_f32_16x16x32_bf16 v[172:175], a[44:47], v[80:83], v[172:175]
 v_mfma_f32_16x16x32_bf16 v[168:171], a[44:47], v[84:87], v[168:171]
 s_add_u32 s53, s53, 40960
 buffer_load_dwordx4 a[32:35], v4, s[12:15], s53 offen offset:0 sc1
 buffer_load_dwordx4 a[36:39], v4, s[12:15], s53 offen offset:1024 sc1
 buffer_load_dwordx4 a[40:43], v4, s[12:15], s53 offen offset:2048 sc1
 buffer_load_dwordx4 a[44:47], v4, s[12:15], s53 offen offset:3072 sc1
 s_waitcnt vmcnt(41)
 v_mfma_f32_16x16x32_bf16 v[148:151], a[48:51], v[88:91], v[148:151]
 v_mfma_f32_16x16x32_bf16 v[144:147], a[48:51], v[92:95], v[144:147]
 v_mfma_f32_16x16x32_bf16 v[156:159], a[52:55], v[88:91], v[156:159]
 v_mfma_f32_16x16x32_bf16 v[152:155], a[52:55], v[92:95], v[152:155]
 v_mfma_f32_16x16x32_bf16 v[164:167], a[56:59], v[88:91], v[164:167]
 v_mfma_f32_16x16x32_bf16 v[160:163], a[56:59], v[92:95], v[160:163]
 v_mfma_f32_16x16x32_bf16 v[172:175], a[60:63], v[88:91], v[172:175]
 v_mfma_f32_16x16x32_bf16 v[168:171], a[60:63], v[92:95], v[168:171]
 s_add_u32 s53, s53, 40960
 buffer_load_dwordx4 a[48:51], v4, s[12:15], s53 offen offset:0 sc1
 buffer_load_dwordx4 a[52:55], v4, s[12:15], s53 offen offset:1024 sc1
 buffer_load_dwordx4 a[56:59], v4, s[12:15], s53 offen offset:2048 sc1
 buffer_load_dwordx4 a[60:63], v4, s[12:15], s53 offen offset:3072 sc1
 s_waitcnt vmcnt(41)
 v_mfma_f32_16x16x32_bf16 v[144:147], v[32:35], v[128:131], v[144:147]
 v_mfma_f32_16x16x32_bf16 v[148:151], v[32:35], v[132:135], v[148:151]
 v_mfma_f32_16x16x32_bf16 v[152:155], v[36:39], v[128:131], v[152:155]
 v_mfma_f32_16x16x32_bf16 v[156:159], v[36:39], v[132:135], v[156:159]
 v_mfma_f32_16x16x32_bf16 v[160:163], v[40:43], v[128:131], v[160:163]
 v_mfma_f32_16x16x32_bf16 v[164:167], v[40:43], v[132:135], v[164:167]
 v_mfma_f32_16x16x32_bf16 v[168:171], v[44:47], v[128:131], v[168:171]
 v_mfma_f32_16x16x32_bf16 v[172:175], v[44:47], v[132:135], v[172:175]
 buffer_load_dwordx4 v[32:35], v22, s[16:19], s48 offen offset:0 sc1
 buffer_load_dwordx4 v[36:39], v22, s[16:19], s48 offen offset:256 sc1
 buffer_load_dwordx4 v[40:43], v22, s[16:19], s48 offen offset:512 sc1
 buffer_load_dwordx4 v[44:47], v22, s[16:19], s48 offen offset:768 sc1
 s_add_u32 s48, s48, 4096
 s_waitcnt vmcnt(41)
 v_mfma_f32_16x16x32_bf16 v[148:151], a[64:67], v[96:99], v[148:151]
 v_mfma_f32_16x16x32_bf16 v[144:147], a[64:67], v[100:103], v[144:147]
 v_mfma_f32_16x16x32_bf16 v[156:159], a[68:71], v[96:99], v[156:159]
 v_mfma_f32_16x16x32_bf16 v[152:155], a[68:71], v[100:103], v[152:155]
 v_mfma_f32_16x16x32_bf16 v[164:167], a[72:75], v[96:99], v[164:167]
 v_mfma_f32_16x16x32_bf16 v[160:163], a[72:75], v[100:103], v[160:163]
 v_mfma_f32_16x16x32_bf16 v[172:175], a[76:79], v[96:99], v[172:175]
 v_mfma_f32_16x16x32_bf16 v[168:171], a[76:79], v[100:103], v[168:171]
 s_add_u32 s53, s53, 40960
 buffer_load_dwordx4 a[64:67], v4, s[12:15], s53 offen offset:0 sc1
 buffer_load_dwordx4 a[68:71], v4, s[12:15], s53 offen offset:1024 sc1
 buffer_load_dwordx4 a[72:75], v4, s[12:15], s53 offen offset:2048 sc1
 buffer_load_dwordx4 a[76:79], v4, s[12:15], s53 offen offset:3072 sc1
 s_waitcnt vmcnt(41)
 v_mfma_f32_16x16x32_bf16 v[148:151], a[80:83], v[104:107], v[148:151]
 v_mfma_f32_16x16x32_bf16 v[144:147], a[80:83], v[108:111], v[144:147]
 v_mfma_f32_16x16x32_bf16 v[156:159], a[84:87], v[104:107], v[156:159]
 v_mfma_f32_16x16x32_bf16 v[152:155], a[84:87], v[108:111], v[152:155]
 v_mfma_f32_16x16x32_bf16 v[164:167], a[88:91], v[104:107], v[164:167]
 v_mfma_f32_16x16x32_bf16 v[160:163], a[88:91], v[108:111], v[160:163]
 v_mfma_f32_16x16x32_bf16 v[172:175], a[92:95], v[104:107], v[172:175]
 v_mfma_f32_16x16x32_bf16 v[168:171], a[92:95], v[108:111], v[168:171]
 s_add_u32 s53, s53, 40960
 buffer_load_dwordx4 a[80:83], v4, s[12:15], s53 offen offset:0 sc1
 buffer_load_dwordx4 a[84:87], v4, s[12:15], s53 offen offset:1024 sc1
 buffer_load_dwordx4 a[88:91], v4, s[12:15], s53 offen offset:2048 sc1
 buffer_load_dwordx4 a[92:95], v4, s[12:15], s53 offen offset:3072 sc1
 s_waitcnt vmcnt(41)
 v_mfma_f32_16x16x32_bf16 v[148:151], a[96:99], v[112:115], v[148:151]
 v_mfma_f32_16x16x32_bf16 v[144:147], a[96:99], v[116:119], v[144:147]
 v_mfma_f32_16x16x32_bf16 v[156:159], a[100:103], v[112:115], v[156:159]
 v_mfma_f32_16x16x32_bf16 v[152:155], a[100:103], v[116:119], v[152:155]
 v_mfma_f32_16x16x32_bf16 v[164:167], a[104:107], v[112:115], v[164:167]
 v_mfma_f32_16x16x32_bf16 v[160:163], a[104:107], v[116:119], v[160:163]
 v_mfma_f32_16x16x32_bf16 v[172:175], a[108:111], v[112:115], v[172:175]
 v_mfma_f32_16x16x32_bf16 v[168:171], a[108:111], v[116:119], v[168:171]
 s_add_u32 s53, s53, 40960
 buffer_load_dwordx4 a[96:99], v4, s[12:15], s53 offen offset:0 sc1
 buffer_load_dwordx4 a[100:103], v4, s[12:15], s53 offen offset:1024 sc1
 buffer_load_dwordx4 a[104:107], v4, s[12:15], s53 offen offset:2048 sc1
 buffer_load_dwordx4 a[108:111], v4, s[12:15], s53 offen offset:3072 sc1
 s_waitcnt vmcnt(41)
 v_mfma_f32_16x16x32_bf16 v[148:151], a[112:115], v[120:123], v[148:151]
 v_mfma_f32_16x16x32_bf16 v[144:147], a[112:115], v[124:127], v[144:147]
 v_mfma_f32_16x16x32_bf16 v[156:159], a[116:119], v[120:123], v[156:159]
 v_mfma_f32_16x16x32_bf16 v[152:155], a[116:119], v[124:127], v[152:155]
 v_mfma_f32_16x16x32_bf16 v[164:167], a[120:123], v[120:123], v[164:167]
 v_mfma_f32_16x16x32_bf16 v[160:163], a[120:123], v[124:127], v[160:163]
 v_mfma_f32_16x16x32_bf16 v[172:175], a[124:127], v[120:123], v[172:175]
 v_mfma_f32_16x16x32_bf16 v[168:171], a[124:127], v[124:127], v[168:171]
 s_add_u32 s53, s53, 40960
 buffer_load_dwordx4 a[112:115], v4, s[12:15], s53 offen offset:0 sc1
 buffer_load_dwordx4 a[116:119], v4, s[12:15], s53 offen offset:1024 sc1
 buffer_load_dwordx4 a[120:123], v4, s[12:15], s53 offen offset:2048 sc1
 buffer_load_dwordx4 a[124:127], v4, s[12:15], s53 offen offset:3072 sc1
 s_waitcnt vmcnt(41)
 v_mfma_f32_16x16x32_bf16 v[144:147], v[48:51], v[136:139], v[144:147]
 v_mfma_f32_16x16x32_bf16 v[148:151], v[48:51], v[140:143], v[148:151]
 v_mfma_f32_16x16x32_bf16 v[152:155], v[52:55], v[136:139], v[152:155]
 v_mfma_f32_16x16x32_bf16 v[156:159], v[52:55], v[140:143], v[156:159]
 v_mfma_f32_16x16x32_bf16 v[160:163], v[56:59], v[136:139], v[160:163]
 v_mfma_f32_16x16x32_bf16 v[164:167], v[56:59], v[140:143], v[164:167]
 v_mfma_f32_16x16x32_bf16 v[168:171], v[60:63], v[136:139], v[168:171]
 v_mfma_f32_16x16x32_bf16 v[172:175], v[60:63], v[140:143], v[172:175]
 buffer_load_dwordx4 v[48:51], v22, s[16:19], s48 offen offset:0 sc1
 buffer_load_dwordx4 v[52:55], v22, s[16:19], s48 offen offset:256 sc1
 buffer_load_dwordx4 v[56:59], v22, s[16:19], s48 offen offset:512 sc1
 buffer_load_dwordx4 v[60:63], v22, s[16:19], s48 offen offset:768 sc1
 s_add_u32 s48, s48, 4096
 s_waitcnt vmcnt(40)
 s_branch pvy_279
pvy_278:
 s_waitcnt vmcnt(41)
 v_mfma_f32_16x16x32_bf16 v[148:151], a[0:3], v[64:67], 0
 v_mfma_f32_16x16x32_bf16 v[144:147], a[0:3], v[68:71], 0
 v_mfma_f32_16x16x32_bf16 v[156:159], a[4:7], v[64:67], 0
 v_mfma_f32_16x16x32_bf16 v[152:155], a[4:7], v[68:71], 0
 v_mfma_f32_16x16x32_bf16 v[164:167], a[8:11], v[64:67], 0
 v_mfma_f32_16x16x32_bf16 v[160:163], a[8:11], v[68:71], 0
 v_mfma_f32_16x16x32_bf16 v[172:175], a[12:15], v[64:67], 0
 v_mfma_f32_16x16x32_bf16 v[168:171], a[12:15], v[68:71], 0
 s_waitcnt vmcnt(37)
 v_mfma_f32_16x16x32_bf16 v[148:151], a[16:19], v[72:75], v[148:151]
 v_mfma_f32_16x16x32_bf16 v[144:147], a[16:19], v[76:79], v[144:147]
 v_mfma_f32_16x16x32_bf16 v[156:159], a[20:23], v[72:75], v[156:159]
 v_mfma_f32_16x16x32_bf16 v[152:155], a[20:23], v[76:79], v[152:155]
 v_mfma_f32_16x16x32_bf16 v[164:167], a[24:27], v[72:75], v[164:167]
 v_mfma_f32_16x16x32_bf16 v[160:163], a[24:27], v[76:79], v[160:163]
 v_mfma_f32_16x16x32_bf16 v[172:175], a[28:31], v[72:75], v[172:175]
 v_mfma_f32_16x16x32_bf16 v[168:171], a[28:31], v[76:79], v[168:171]
 s_waitcnt vmcnt(33)
 v_mfma_f32_16x16x32_bf16 v[148:151], a[32:35], v[80:83], v[148:151]
 v_mfma_f32_16x16x32_bf16 v[144:147], a[32:35], v[84:87], v[144:147]
 v_mfma_f32_16x16x32_bf16 v[156:159], a[36:39], v[80:83], v[156:159]
 v_mfma_f32_16x16x32_bf16 v[152:155], a[36:39], v[84:87], v[152:155]
 v_mfma_f32_16x16x32_bf16 v[164:167], a[40:43], v[80:83], v[164:167]
 v_mfma_f32_16x16x32_bf16 v[160:163], a[40:43], v[84:87], v[160:163]
 v_mfma_f32_16x16x32_bf16 v[172:175], a[44:47], v[80:83], v[172:175]
 v_mfma_f32_16x16x32_bf16 v[168:171], a[44:47], v[84:87], v[168:171]
 s_waitcnt vmcnt(29)
 v_mfma_f32_16x16x32_bf16 v[148:151], a[48:51], v[88:91], v[148:151]
 v_mfma_f32_16x16x32_bf16 v[144:147], a[48:51], v[92:95], v[144:147]
 v_mfma_f32_16x16x32_bf16 v[156:159], a[52:55], v[88:91], v[156:159]
 v_mfma_f32_16x16x32_bf16 v[152:155], a[52:55], v[92:95], v[152:155]
 v_mfma_f32_16x16x32_bf16 v[164:167], a[56:59], v[88:91], v[164:167]
 v_mfma_f32_16x16x32_bf16 v[160:163], a[56:59], v[92:95], v[160:163]
 v_mfma_f32_16x16x32_bf16 v[172:175], a[60:63], v[88:91], v[172:175]
 v_mfma_f32_16x16x32_bf16 v[168:171], a[60:63], v[92:95], v[168:171]
 s_waitcnt vmcnt(25)
 v_mfma_f32_16x16x32_bf16 v[144:147], v[32:35], v[128:131], v[144:147]
 v_mfma_f32_16x16x32_bf16 v[148:151], v[32:35], v[132:135], v[148:151]
 v_mfma_f32_16x16x32_bf16 v[152:155], v[36:39], v[128:131], v[152:155]
 v_mfma_f32_16x16x32_bf16 v[156:159], v[36:39], v[132:135], v[156:159]
 v_mfma_f32_16x16x32_bf16 v[160:163], v[40:43], v[128:131], v[160:163]
 v_mfma_f32_16x16x32_bf16 v[164:167], v[40:43], v[132:135], v[164:167]
 v_mfma_f32_16x16x32_bf16 v[168:171], v[44:47], v[128:131], v[168:171]
 v_mfma_f32_16x16x32_bf16 v[172:175], v[44:47], v[132:135], v[172:175]
 s_waitcnt vmcnt(21)
 v_mfma_f32_16x16x32_bf16 v[148:151], a[64:67], v[96:99], v[148:151]
 v_mfma_f32_16x16x32_bf16 v[144:147], a[64:67], v[100:103], v[144:147]
 v_mfma_f32_16x16x32_bf16 v[156:159], a[68:71], v[96:99], v[156:159]
 v_mfma_f32_16x16x32_bf16 v[152:155], a[68:71], v[100:103], v[152:155]
 v_mfma_f32_16x16x32_bf16 v[164:167], a[72:75], v[96:99], v[164:167]
 v_mfma_f32_16x16x32_bf16 v[160:163], a[72:75], v[100:103], v[160:163]
 v_mfma_f32_16x16x32_bf16 v[172:175], a[76:79], v[96:99], v[172:175]
 v_mfma_f32_16x16x32_bf16 v[168:171], a[76:79], v[100:103], v[168:171]
 s_waitcnt vmcnt(17)
 v_mfma_f32_16x16x32_bf16 v[148:151], a[80:83], v[104:107], v[148:151]
 v_mfma_f32_16x16x32_bf16 v[144:147], a[80:83], v[108:111], v[144:147]
 v_mfma_f32_16x16x32_bf16 v[156:159], a[84:87], v[104:107], v[156:159]
 v_mfma_f32_16x16x32_bf16 v[152:155], a[84:87], v[108:111], v[152:155]
 v_mfma_f32_16x16x32_bf16 v[164:167], a[88:91], v[104:107], v[164:167]
 v_mfma_f32_16x16x32_bf16 v[160:163], a[88:91], v[108:111], v[160:163]
 v_mfma_f32_16x16x32_bf16 v[172:175], a[92:95], v[104:107], v[172:175]
 v_mfma_f32_16x16x32_bf16 v[168:171], a[92:95], v[108:111], v[168:171]
 s_waitcnt vmcnt(13)
 v_mfma_f32_16x16x32_bf16 v[148:151], a[96:99], v[112:115], v[148:151]
 v_mfma_f32_16x16x32_bf16 v[144:147], a[96:99], v[116:119], v[144:147]
 v_mfma_f32_16x16x32_bf16 v[156:159], a[100:103], v[112:115], v[156:159]
 v_mfma_f32_16x16x32_bf16 v[152:155], a[100:103], v[116:119], v[152:155]
 v_mfma_f32_16x16x32_bf16 v[164:167], a[104:107], v[112:115], v[164:167]
 v_mfma_f32_16x16x32_bf16 v[160:163], a[104:107], v[116:119], v[160:163]
 v_mfma_f32_16x16x32_bf16 v[172:175], a[108:111], v[112:115], v[172:175]
 v_mfma_f32_16x16x32_bf16 v[168:171], a[108:111], v[116:119], v[168:171]
 s_waitcnt vmcnt(9)
 v_mfma_f32_16x16x32_bf16 v[148:151], a[112:115], v[120:123], v[148:151]
 v_mfma_f32_16x16x32_bf16 v[144:147], a[112:115], v[124:127], v[144:147]
 v_mfma_f32_16x16x32_bf16 v[156:159], a[116:119], v[120:123], v[156:159]
 v_mfma_f32_16x16x32_bf16 v[152:155], a[116:119], v[124:127], v[152:155]
 v_mfma_f32_16x16x32_bf16 v[164:167], a[120:123], v[120:123], v[164:167]
 v_mfma_f32_16x16x32_bf16 v[160:163], a[120:123], v[124:127], v[160:163]
 v_mfma_f32_16x16x32_bf16 v[172:175], a[124:127], v[120:123], v[172:175]
 v_mfma_f32_16x16x32_bf16 v[168:171], a[124:127], v[124:127], v[168:171]
 s_waitcnt vmcnt(5)
 v_mfma_f32_16x16x32_bf16 v[144:147], v[48:51], v[136:139], v[144:147]
 v_mfma_f32_16x16x32_bf16 v[148:151], v[48:51], v[140:143], v[148:151]
 v_mfma_f32_16x16x32_bf16 v[152:155], v[52:55], v[136:139], v[152:155]
 v_mfma_f32_16x16x32_bf16 v[156:159], v[52:55], v[140:143], v[156:159]
 v_mfma_f32_16x16x32_bf16 v[160:163], v[56:59], v[136:139], v[160:163]
 v_mfma_f32_16x16x32_bf16 v[164:167], v[56:59], v[140:143], v[164:167]
 v_mfma_f32_16x16x32_bf16 v[168:171], v[60:63], v[136:139], v[168:171]
 v_mfma_f32_16x16x32_bf16 v[172:175], v[60:63], v[140:143], v[172:175]
 s_waitcnt vmcnt(0)
pvy_279:
 s_or_b32 s21, s20, s65
 s_cbranch_scc1 lc_280
 s_sub_u32 s21, s2, 0
 s_cmp_ge_u32 s21, 640
 s_cbranch_scc1 lc_280
 v_mov_b32 v29, 1
 s_mov_b64 exec, 1
 buffer_atomic_add v29, v28, s[32:35], 0 offen sc0 sc1
 s_mov_b64 exec, -1
lc_280:
 v_sub_f32 v25, 1.0, v24
 v_cvt_pk_bf16_f32 v26, v25, v25
 v_lshlrev_b32 v25, 16, v26
 v_cvt_pk_bf16_f32 v26, v12, v12
 v_lshlrev_b32 v12, 16, v26
 v_cvt_pk_bf16_f32 v26, v13, v13
 v_lshlrev_b32 v13, 16, v26
 v_cvt_pk_bf16_f32 v26, v14, v14
 v_lshlrev_b32 v14, 16, v26
 v_cvt_pk_bf16_f32 v26, v15, v15
 v_lshlrev_b32 v15, 16, v26
 v_cvt_pk_bf16_f32 v26, v16, v16
 v_lshlrev_b32 v16, 16, v26
 v_cvt_pk_bf16_f32 v26, v17, v17
 v_lshlrev_b32 v17, 16, v26
 v_cvt_pk_bf16_f32 v26, v18, v18
 v_lshlrev_b32 v18, 16, v26
 v_cvt_pk_bf16_f32 v26, v19, v19
 v_lshlrev_b32 v19, 16, v26
 v_mul_f32 v12, v12, v25
 v_cvt_pk_bf16_f32 v26, v12, v12
 v_lshlrev_b32 v12, 16, v26
 v_mul_f32 v13, v13, v25
 v_cvt_pk_bf16_f32 v26, v13, v13
 v_lshlrev_b32 v13, 16, v26
 v_mul_f32 v14, v14, v25
 v_cvt_pk_bf16_f32 v26, v14, v14
 v_lshlrev_b32 v14, 16, v26
 v_mul_f32 v15, v15, v25
 v_cvt_pk_bf16_f32 v26, v15, v15
 v_lshlrev_b32 v15, 16, v26
 v_mul_f32 v16, v16, v25
 v_cvt_pk_bf16_f32 v26, v16, v16
 v_lshlrev_b32 v16, 16, v26
 v_mul_f32 v17, v17, v25
 v_cvt_pk_bf16_f32 v26, v17, v17
 v_lshlrev_b32 v17, 16, v26
 v_mul_f32 v18, v18, v25
 v_cvt_pk_bf16_f32 v26, v18, v18
 v_lshlrev_b32 v18, 16, v26
 v_mul_f32 v19, v19, v25
 v_cvt_pk_bf16_f32 v26, v19, v19
 v_lshlrev_b32 v19, 16, v26
 ds_write_b128 v10, v[144:147] offset:0
 ds_write_b128 v10, v[148:151] offset:1024
 ds_write_b128 v10, v[152:155] offset:2048
 ds_write_b128 v10, v[156:159] offset:3072
 ds_write_b128 v10, v[160:163] offset:4096
 ds_write_b128 v10, v[164:167] offset:5120
 ds_write_b128 v10, v[168:171] offset:6144
 ds_write_b128 v10, v[172:175] offset:7168
 s_waitcnt lgkmcnt(0)
 s_barrier
 ds_read_b128 v[176:179], v11 offset:0
 ds_read_b128 v[180:183], v11 offset:8192
 ds_read_b128 v[184:187], v11 offset:16384
 ds_read_b128 v[188:191], v11 offset:24576
 ds_read_b128 v[192:195], v11 offset:4096
 ds_read_b128 v[196:199], v11 offset:12288
 ds_read_b128 v[200:203], v11 offset:20480
 ds_read_b128 v[204:207], v11 offset:28672
 s_cmp_ge_u32 s40, 48
 s_cbranch_scc1 pvr_281
 s_waitcnt lgkmcnt(4)
 v_pk_add_f32 v[176:177], v[176:177], v[180:181]
 v_pk_add_f32 v[184:185], v[184:185], v[188:189]
 v_pk_add_f32 v[178:179], v[178:179], v[182:183]
 v_pk_add_f32 v[186:187], v[186:187], v[190:191]
 v_pk_add_f32 v[176:177], v[176:177], v[184:185]
 v_pk_add_f32 v[178:179], v[178:179], v[186:187]
 buffer_store_dwordx4 v[176:179], v4, s[24:27], s54 offen offset:0 sc1
 s_waitcnt lgkmcnt(0)
 v_pk_add_f32 v[192:193], v[192:193], v[196:197]
 v_pk_add_f32 v[200:201], v[200:201], v[204:205]
 v_pk_add_f32 v[194:195], v[194:195], v[198:199]
 v_pk_add_f32 v[202:203], v[202:203], v[206:207]
 v_pk_add_f32 v[192:193], v[192:193], v[200:201]
 v_pk_add_f32 v[194:195], v[194:195], v[202:203]
 buffer_store_dwordx4 v[192:195], v4, s[24:27], s54 offen offset:2048 sc1
 s_lshr_b32 s71, s40, 2
 s_lshl_b32 s71, s71, 7
 s_add_u32 s71, s71, 116736
 s_branch pvr_282
pvr_281:
 s_waitcnt lgkmcnt(4)
 v_pk_add_f32 v[176:177], v[176:177], v[180:181]
 v_pk_add_f32 v[184:185], v[184:185], v[188:189]
 v_pk_add_f32 v[178:179], v[178:179], v[182:183]
 v_pk_add_f32 v[186:187], v[186:187], v[190:191]
 v_pk_add_f32 v[176:177], v[176:177], v[184:185]
 v_pk_add_f32 v[178:179], v[178:179], v[186:187]
 v_cvt_pk_bf16_f32 v26, v176, v177
 v_lshlrev_b32 v176, 16, v26
 v_and_b32 v177, 0xffff0000, v26
 v_mul_f32 v176, v176, v24
 v_mul_f32 v177, v177, v24
 v_cvt_pk_bf16_f32 v26, v176, v177
 v_lshlrev_b32 v176, 16, v26
 v_and_b32 v177, 0xffff0000, v26
 v_add_f32 v176, v176, v12
 v_add_f32 v177, v177, v13
 v_cvt_pk_bf16_f32 v180, v176, v177
 v_cvt_pk_bf16_f32 v26, v178, v179
 v_lshlrev_b32 v178, 16, v26
 v_and_b32 v179, 0xffff0000, v26
 v_mul_f32 v178, v178, v24
 v_mul_f32 v179, v179, v24
 v_cvt_pk_bf16_f32 v26, v178, v179
 v_lshlrev_b32 v178, 16, v26
 v_and_b32 v179, 0xffff0000, v26
 v_add_f32 v178, v178, v14
 v_add_f32 v179, v179, v15
 v_cvt_pk_bf16_f32 v181, v178, v179
 buffer_store_dwordx2 v[180:181], v9, s[8:11], s46 offen offset:0
 s_waitcnt lgkmcnt(0)
 v_pk_add_f32 v[192:193], v[192:193], v[196:197]
 v_pk_add_f32 v[200:201], v[200:201], v[204:205]
 v_pk_add_f32 v[194:195], v[194:195], v[198:199]
 v_pk_add_f32 v[202:203], v[202:203], v[206:207]
 v_pk_add_f32 v[192:193], v[192:193], v[200:201]
 v_pk_add_f32 v[194:195], v[194:195], v[202:203]
 v_cvt_pk_bf16_f32 v26, v192, v193
 v_lshlrev_b32 v192, 16, v26
 v_and_b32 v193, 0xffff0000, v26
 v_mul_f32 v192, v192, v24
 v_mul_f32 v193, v193, v24
 v_cvt_pk_bf16_f32 v26, v192, v193
 v_lshlrev_b32 v192, 16, v26
 v_and_b32 v193, 0xffff0000, v26
 v_add_f32 v192, v192, v16
 v_add_f32 v193, v193, v17
 v_cvt_pk_bf16_f32 v196, v192, v193
 v_cvt_pk_bf16_f32 v26, v194, v195
 v_lshlrev_b32 v194, 16, v26
 v_and_b32 v195, 0xffff0000, v26
 v_mul_f32 v194, v194, v24
 v_mul_f32 v195, v195, v24
 v_cvt_pk_bf16_f32 v26, v194, v195
 v_lshlrev_b32 v194, 16, v26
 v_and_b32 v195, 0xffff0000, v26
 v_add_f32 v194, v194, v18
 v_add_f32 v195, v195, v19
 v_cvt_pk_bf16_f32 v197, v194, v195
 buffer_store_dwordx2 v[196:197], v9, s[8:11], s46 offen offset:64
pvr_282:
 s_branch pvy_276
pvy_277:
 s_sub_u32 s21, s2, 0
 s_cmp_ge_u32 s21, 640
 s_cbranch_scc1 lc_283
 s_cmp_lg_u32 s20, 0
 s_cbranch_scc1 lc_283x
 s_waitcnt vmcnt(2)
 s_mov_b64 exec, 1
 ds_write_b32 v30, v29 offset:12
 s_mov_b64 exec, -1
lc_283x:
 s_waitcnt lgkmcnt(0)
 s_barrier
 ds_read_b32 v23, v30 offset:12
lc_283:
 s_waitcnt lgkmcnt(0)
 v_readfirstlane_b32 s2, v23
 v_readfirstlane_b32 s67, v213
 s_barrier
 s_cmp_lt_u32 s2, 252
 s_cbranch_scc1 pae_284
 s_waitcnt vmcnt(0)
 s_cmp_eq_u32 s71, 0
 s_cbranch_scc1 paf_285
 v_mov_b32 v25, 0
 v_mov_b32 v26, 1
 s_mov_b64 exec, 1
 buffer_atomic_add v26, v25, s[72:75], s71 offen sc1
 s_mov_b64 exec, -1
 s_mov_b32 s71, 0
paf_285:
pae_284:
 s_add_u32 s21, s2, 0
 s_cmp_lt_u32 s2, 64
 s_cbranch_scc1 pv_loop
 s_sub_u32 s2, s2, 64
 s_add_u32 s21, s2, 64
 s_cmp_lt_u32 s2, 20
 s_cbranch_scc1 pv_loop
 s_sub_u32 s2, s2, 20
 s_add_u32 s21, s2, 104
 s_cmp_lt_u32 s2, 20
 s_cbranch_scc1 pv_loop
 s_sub_u32 s2, s2, 20
 s_add_u32 s21, s2, 84
 s_cmp_lt_u32 s2, 20
 s_cbranch_scc1 pv_loop
 s_sub_u32 s2, s2, 20
 s_add_u32 s21, s2, 124
 s_cmp_lt_u32 s2, 20
 s_cbranch_scc1 pv_loop
 s_sub_u32 s2, s2, 20
 s_add_u32 s21, s2, 144
 s_cmp_lt_u32 s2, 108
 s_cbranch_scc1 pv_loop
 s_sub_u32 s2, s2, 108
 s_branch main_fin
 s_branch queue
main_fin:
 s_waitcnt vmcnt(0)
main_end:
 s_endpgm
code_end:
.section .rodata,"a"
.p2align 6
.amdhsa_kernel gated_mix__memory_aug_recurrent_mem_tr__sliding_local_dilated__prompt_kernel
  .amdhsa_next_free_vgpr 512
  .amdhsa_next_free_sgpr 102
  .amdhsa_accum_offset 256
  .amdhsa_group_segment_fixed_size 0
  .amdhsa_kernarg_size 112
  .amdhsa_user_sgpr_count 2
  .amdhsa_user_sgpr_kernarg_segment_ptr 1
  .amdhsa_system_sgpr_workgroup_id_x 1
.end_amdhsa_kernel
.text
```

```asm
; @launch kernel=gated_mix__memory_aug_recurrent_mem_tr__sliding_local_dilated__prompt_kernel grid=(256,1,1) block=(256,1,1) lds=163840
.amdgcn_target "amdgcn-amd-amdhsa--gfx950"
.text
.globl gated_mix__memory_aug_recurrent_mem_tr__sliding_local_dilated__prompt_kernel
.p2align 8
.type gated_mix__memory_aug_recurrent_mem_tr__sliding_local_dilated__prompt_kernel,@function
gated_mix__memory_aug_recurrent_mem_tr__sliding_local_dilated__prompt_kernel:
 s_cmp_ge_u32 s2, 256
 s_cbranch_scc1 end0
 s_load_dwordx2 s[4:5], s[0:1], 96
 s_load_dwordx2 s[38:39], s[0:1], 104
 v_lshrrev_b32 v1, 6, v0
 v_and_b32 v2, 15, v0
 v_readfirstlane_b32 s20, v1
 v_and_b32 v1, 63, v0
 v_lshrrev_b32 v3, 4, v1
 s_getreg_b32 s50, hwreg(HW_REG_XCC_ID)
 s_and_b32 s50, s50, 7
 s_waitcnt lgkmcnt(0)
 s_mov_b32 s32, s4
 s_mov_b32 s33, s5
 s_mov_b32 s34, 256
 s_mov_b32 s35, 0x00020000
 s_getpc_b64 s[6:7]
cpf_pc:
 s_sub_u32 s6, s6, cpf_pc - gated_mix__memory_aug_recurrent_mem_tr__sliding_local_dilated__prompt_kernel
 s_subb_u32 s7, s7, 0
 s_lshr_b32 s21, s2, 3
 s_lshl_b32 s21, s21, 12
 v_lshl_add_u32 v28, v0, 4, s21
 v_min_u32 v28, code_end - gated_mix__memory_aug_recurrent_mem_tr__sliding_local_dilated__prompt_kernel - 16, v28
 global_load_dwordx4 a[252:255], v28, s[6:7]
 v_lshl_add_u32 v28, v0, 4, s21
 v_add_u32 v28, 0x20000, v28
 v_min_u32 v28, code_end - gated_mix__memory_aug_recurrent_mem_tr__sliding_local_dilated__prompt_kernel - 16, v28
 global_load_dwordx4 a[252:255], v28, s[6:7]
 v_mov_b32 v21, 0
 s_cmp_lg_u32 s20, 0
 s_cbranch_scc1 rk_1
 s_and_b32 s21, s50, 1
 s_lshl_b32 s21, s21, 7
 s_lshl_b32 s22, s50, 1
 s_and_b32 s22, s22, 12
 s_add_u32 s21, s21, s22
 v_mov_b32 v22, s21
 v_mov_b32 v23, 1
 s_mov_b64 exec, 1
 buffer_atomic_add v23, v22, s[32:35], 0 offen sc0 sc1
 s_waitcnt vmcnt(0)
 v_readfirstlane_b32 s51, v23
 s_lshl_b32 s22, s50, 5
 s_add_u32 s22, s22, s51
 s_cmp_lt_u32 s51, 32
 s_cbranch_scc1 rk_2
 v_mov_b32 v24, 72
 v_mov_b32 v25, 1
 buffer_atomic_add v25, v24, s[32:35], 0 offen sc0 sc1
 s_waitcnt vmcnt(0)
 v_readfirstlane_b32 s23, v25
 s_mov_b32 s101, 0
 s_mov_b64 exec, -1
 v_lshlrev_b32 v24, 2, v1
rk_3:
 s_sleep 8
 buffer_load_dword v25, v24, s[32:35], 0 offen sc1
 s_add_u32 s101, s101, 1
 s_cmp_gt_u32 s101, 131072
 s_cbranch_scc1 end0
 s_waitcnt vmcnt(0)
 v_readlane_b32 s21, v25, 0
 v_readlane_b32 s22, v25, 32
 s_add_u32 s21, s21, s22
 v_readlane_b32 s22, v25, 1
 s_add_u32 s21, s21, s22
 v_readlane_b32 s22, v25, 33
 s_add_u32 s21, s21, s22
 v_readlane_b32 s22, v25, 2
 s_add_u32 s21, s21, s22
 v_readlane_b32 s22, v25, 34
 s_add_u32 s21, s21, s22
 v_readlane_b32 s22, v25, 3
 s_add_u32 s21, s21, s22
 v_readlane_b32 s22, v25, 35
 s_add_u32 s21, s21, s22
 s_cmp_lt_u32 s21, 256
 s_cbranch_scc1 rk_3
 s_mov_b64 exec, 1
 s_mov_b32 s24, 0
rk_5:
 s_and_b32 s21, s24, 1
 s_lshl_b32 s21, s21, 5
 s_lshr_b32 s22, s24, 1
 s_add_u32 s21, s21, s22
 v_readlane_b32 s21, v25, s21
 s_min_u32 s21, s21, 32
 s_sub_u32 s25, 32, s21
 s_cmp_lt_u32 s23, s25
 s_cbranch_scc1 rk_4
 s_sub_u32 s23, s23, s25
 s_add_u32 s24, s24, 1
 s_cmp_lt_u32 s24, 8
 s_cbranch_scc1 rk_5
 s_branch end0
rk_4:
 s_lshl_b32 s22, s24, 5
 s_add_u32 s22, s22, s21
 s_add_u32 s22, s22, s23
 s_or_b32 s22, s22, 0x100
rk_2:
 v_mov_b32 v23, s22
 ds_write_b32 v21, v23
 s_waitcnt lgkmcnt(0)
 s_mov_b64 exec, -1
rk_1:
 s_barrier
 ds_read_b32 v23, v21
 s_waitcnt lgkmcnt(0)
 v_readfirstlane_b32 s22, v23
 s_barrier
 s_mov_b32 s84, 0
 s_mov_b32 s85, -1
 s_lshr_b32 s53, s22, 8
 s_and_b32 s22, s22, 255
 s_cmp_ge_u32 s22, 128
 s_cbranch_scc1 gemm_side
 s_lshr_b32 s50, s22, 4
 s_and_b32 s51, s22, 15
 s_mov_b32 s86, 0x3dd53b95
 s_load_dwordx2 s[4:5], s[0:1], 8
 s_load_dwordx4 s[36:39], s[0:1], 16
 s_load_dwordx4 s[40:43], s[0:1], 32
 s_load_dwordx2 s[44:45], s[0:1], 104
 s_lshr_b32 s55, s51, 2
 s_and_b32 s56, s51, 3
 s_lshl_b32 s57, s50, 2
 s_add_u32 s58, s57, s55
 s_add_u32 s59, s57, s20
 s_lshr_b32 s21, s51, 1
 s_xor_b32 s21, s21, s55
 s_andn2_b32 s21, 1, s21
 s_xor_b32 s85, s51, s21
 s_mul_i32 s87, s85, 5
 s_lshr_b32 s87, s87, 1
 s_and_b32 s79, s85, 1
 s_waitcnt lgkmcnt(0)
 s_add_u32 s8, s44, 78643200
 s_addc_u32 s9, s45, 0
 s_mov_b32 s10, 2162688
 s_mov_b32 s11, 0x00020000
 s_mov_b32 s16, s44
 s_mov_b32 s17, s45
 s_mov_b32 s18, 50331648
 s_mov_b32 s19, 0x00020000
 s_add_u32 s24, s44, 180355072
 s_addc_u32 s25, s45, 0
 s_mov_b32 s26, 67108864
 s_mov_b32 s27, 0x00020000
 s_mov_b32 s28, s4
 s_mov_b32 s29, s5
 s_mov_b32 s30, 10240
 s_mov_b32 s31, 0x00020000
 s_add_u32 s4, s44, 181305344
 s_addc_u32 s5, s45, 0
 s_mov_b32 s6, 1114112
 s_mov_b32 s7, 0x00020000
 v_mov_b32 v27, 10923
 v_add_u32 v54, 0, v1
 v_mul_u32_u24 v53, v54, v27
 v_lshrrev_b32 v53, 16, v53
 v_mul_u32_u24 v52, 6, v53
 v_sub_u32 v54, v54, v52
 v_mul_u32_u24 v52, 1280, v53
 v_lshl_add_u32 v46, v54, 4, v52
 v_bfe_u32 v52, v53, 1, 1
 v_mul_u32_u24 v52, 20, v52
 v_and_b32 v51, 1, v53
 v_add_u32 v52, v52, v51
 v_lshrrev_b32 v51, 3, v53
 v_mul_u32_u24 v51, 40, v51
 v_bfe_u32 v50, v53, 2, 1
 v_lshl_add_u32 v51, v50, 1, v51
 v_add_u32 v51, v51, v52
 v_mul_u32_u24 v51, 12288, v51
 v_lshl_add_u32 v247, v54, 4, v51
 v_lshrrev_b32 v51, 4, v53
 v_mul_u32_u24 v51, 40, v51
 v_bfe_u32 v50, v53, 2, 2
 v_lshl_add_u32 v51, v50, 1, v51
 v_add_u32 v51, v51, v52
 v_mul_u32_u24 v51, 12288, v51
 v_lshl_add_u32 v244, v54, 4, v51
 v_add_u32 v54, 64, v1
 v_mul_u32_u24 v53, v54, v27
 v_lshrrev_b32 v53, 16, v53
 v_mul_u32_u24 v52, 6, v53
 v_sub_u32 v54, v54, v52
 v_mul_u32_u24 v52, 1280, v53
 v_lshl_add_u32 v47, v54, 4, v52
 v_bfe_u32 v52, v53, 1, 1
 v_mul_u32_u24 v52, 20, v52
 v_and_b32 v51, 1, v53
 v_add_u32 v52, v52, v51
 v_lshrrev_b32 v51, 3, v53
 v_mul_u32_u24 v51, 40, v51
 v_bfe_u32 v50, v53, 2, 1
 v_lshl_add_u32 v51, v50, 1, v51
 v_add_u32 v51, v51, v52
 v_mul_u32_u24 v51, 12288, v51
 v_lshl_add_u32 v248, v54, 4, v51
 v_lshrrev_b32 v51, 4, v53
 v_mul_u32_u24 v51, 40, v51
 v_bfe_u32 v50, v53, 2, 2
 v_lshl_add_u32 v51, v50, 1, v51
 v_add_u32 v51, v51, v52
 v_mul_u32_u24 v51, 12288, v51
 v_lshl_add_u32 v245, v54, 4, v51
 v_add_u32 v54, 128, v1
 v_mul_u32_u24 v53, v54, v27
 v_lshrrev_b32 v53, 16, v53
 v_mul_u32_u24 v52, 6, v53
 v_sub_u32 v54, v54, v52
 v_mul_u32_u24 v52, 1280, v53
 v_lshl_add_u32 v48, v54, 4, v52
 v_bfe_u32 v52, v53, 1, 1
 v_mul_u32_u24 v52, 20, v52
 v_and_b32 v51, 1, v53
 v_add_u32 v52, v52, v51
 v_lshrrev_b32 v51, 3, v53
 v_mul_u32_u24 v51, 40, v51
 v_bfe_u32 v50, v53, 2, 1
 v_lshl_add_u32 v51, v50, 1, v51
 v_add_u32 v51, v51, v52
 v_mul_u32_u24 v51, 12288, v51
 v_lshl_add_u32 v249, v54, 4, v51
 v_lshrrev_b32 v51, 4, v53
 v_mul_u32_u24 v51, 40, v51
 v_bfe_u32 v50, v53, 2, 2
 v_lshl_add_u32 v51, v50, 1, v51
 v_add_u32 v51, v51, v52
 v_mul_u32_u24 v51, 12288, v51
 v_lshl_add_u32 v246, v54, 4, v51
 s_mul_i32 s80, s58, 384
 s_mul_i32 s22, s56, 96
 s_add_u32 s80, s80, s22
 s_mul_i32 s22, s20, 1966080
 s_add_u32 s80, s80, s22
 s_mul_i32 s81, s20, 40448
 s_mul_i32 s82, s59, 245760
 s_lshl_b32 s22, s87, 5
 s_add_u32 s82, s82, s22
 s_mul_i32 s88, s59, 384
 s_mov_b32 s12, s42
 s_mov_b32 s13, s43
 s_mov_b32 s14, 7864320
 s_mov_b32 s15, 0x00020000
 s_add_u32 s21, s82, 0
 s_add_u32 m0, s81, 12288
 s_nop 0
 buffer_load_dwordx4 v46, s[12:15], s21 offen lds
 s_add_u32 m0, s81, 13312
 s_nop 0
 buffer_load_dwordx4 v47, s[12:15], s21 offen lds
 s_add_u32 m0, s81, 14336
 s_nop 0
 buffer_load_dwordx4 v48, s[12:15], s21 offen lds
 s_add_u32 s21, s82, 40960
 s_add_u32 m0, s81, 15360
 s_nop 0
 buffer_load_dwordx4 v46, s[12:15], s21 offen lds
 s_add_u32 m0, s81, 16384
 s_nop 0
 buffer_load_dwordx4 v47, s[12:15], s21 offen lds
 s_add_u32 m0, s81, 17408
 s_nop 0
 buffer_load_dwordx4 v48, s[12:15], s21 offen lds
 s_add_u32 s21, s82, 81920
 s_add_u32 m0, s81, 18432
 s_nop 0
 buffer_load_dwordx4 v46, s[12:15], s21 offen lds
 s_add_u32 m0, s81, 19456
 s_nop 0
 buffer_load_dwordx4 v47, s[12:15], s21 offen lds
 s_add_u32 m0, s81, 20480
 s_nop 0
 buffer_load_dwordx4 v48, s[12:15], s21 offen lds
 s_add_u32 s21, s82, 122880
 s_add_u32 m0, s81, 21504
 s_nop 0
 buffer_load_dwordx4 v46, s[12:15], s21 offen lds
 s_add_u32 m0, s81, 22528
 s_nop 0
 buffer_load_dwordx4 v47, s[12:15], s21 offen lds
 s_add_u32 m0, s81, 23552
 s_nop 0
 buffer_load_dwordx4 v48, s[12:15], s21 offen lds
 s_add_u32 s21, s82, 163840
 s_add_u32 m0, s81, 24576
 s_nop 0
 buffer_load_dwordx4 v46, s[12:15], s21 offen lds
 s_add_u32 m0, s81, 25600
 s_nop 0
 buffer_load_dwordx4 v47, s[12:15], s21 offen lds
 s_add_u32 m0, s81, 26624
 s_nop 0
 buffer_load_dwordx4 v48, s[12:15], s21 offen lds
 s_add_u32 s21, s82, 204800
 s_add_u32 m0, s81, 27648
 s_nop 0
 buffer_load_dwordx4 v46, s[12:15], s21 offen lds
 s_add_u32 m0, s81, 28672
 s_nop 0
 buffer_load_dwordx4 v47, s[12:15], s21 offen lds
 s_add_u32 m0, s81, 29696
 s_nop 0
 buffer_load_dwordx4 v48, s[12:15], s21 offen lds
 s_mov_b32 s12, s40
 s_mov_b32 s13, s41
 s_mov_b32 s14, 7864320
 s_mov_b32 s15, 0x00020000
 s_mov_b32 s40, s38
 s_mov_b32 s41, s39
 s_mov_b32 s38, 7864320
 s_mov_b32 s39, 0x00020000
 s_mov_b32 s42, s38
 s_mov_b32 s43, s39
 v_lshrrev_b32 v250, 2, v2
 v_lshl_add_u32 v250, v3, 3, v250
 v_mul_u32_u24 v250, 96, v250
 v_and_b32 v251, 3, v2
 v_lshlrev_b32 v251, 3, v251
 v_add3_u32 v250, v250, v251, s81
 v_lshlrev_b32 v251, 4, v1
 v_add_u32 v251, s81, v251
 v_lshlrev_b32 v26, 2, v1
 v_mov_b32 v27, 2731
 v_add_u32 v54, 0, v1
 v_mul_u32_u24 v53, v54, v27
 v_lshrrev_b32 v53, 16, v53
 v_mul_u32_u24 v52, 24, v53
 v_sub_u32 v54, v54, v52
 v_bfe_u32 v52, v53, 1, 1
 v_xor_b32 v54, v54, v52
 v_mul_u32_u24 v52, 20, v52
 v_and_b32 v51, 1, v53
 v_add_u32 v52, v52, v51
 v_lshrrev_b32 v51, 2, v53
 v_lshl_add_u32 v52, v51, 1, v52
 v_mul_u32_u24 v52, 12288, v52
 v_subrev_u32 v52, 0, v52
 v_lshl_add_u32 v28, v54, 4, v52
 v_xor_b32 v31, 32, v28
 v_xor_b32 v34, 64, v28
 v_xor_b32 v37, 96, v28
 v_add_u32 v54, 64, v1
 v_mul_u32_u24 v53, v54, v27
 v_lshrrev_b32 v53, 16, v53
 v_mul_u32_u24 v52, 24, v53
 v_sub_u32 v54, v54, v52
 v_bfe_u32 v52, v53, 1, 1
 v_xor_b32 v54, v54, v52
 v_mul_u32_u24 v52, 20, v52
 v_and_b32 v51, 1, v53
 v_add_u32 v52, v52, v51
 v_lshrrev_b32 v51, 2, v53
 v_lshl_add_u32 v52, v51, 1, v52
 v_mul_u32_u24 v52, 12288, v52
 v_subrev_u32 v52, 1024, v52
 v_lshl_add_u32 v29, v54, 4, v52
 v_xor_b32 v32, 32, v29
 v_xor_b32 v35, 64, v29
 v_xor_b32 v38, 96, v29
 v_add_u32 v54, 128, v1
 v_mul_u32_u24 v53, v54, v27
 v_lshrrev_b32 v53, 16, v53
 v_mul_u32_u24 v52, 24, v53
 v_sub_u32 v54, v54, v52
 v_bfe_u32 v52, v53, 1, 1
 v_xor_b32 v54, v54, v52
 v_mul_u32_u24 v52, 20, v52
 v_and_b32 v51, 1, v53
 v_add_u32 v52, v52, v51
 v_lshrrev_b32 v51, 2, v53
 v_lshl_add_u32 v52, v51, 1, v52
 v_mul_u32_u24 v52, 12288, v52
 v_subrev_u32 v52, 2048, v52
 v_lshl_add_u32 v30, v54, 4, v52
 v_xor_b32 v33, 32, v30
 v_xor_b32 v36, 64, v30
 v_xor_b32 v39, 96, v30
 s_add_u32 m0, s81, 0
 s_add_u32 s21, s88, 0
 buffer_load_dwordx4 v28, s[12:15], s21 offen offset:0 lds
 buffer_load_dwordx4 v29, s[12:15], s21 offen offset:1024 lds
 buffer_load_dwordx4 v30, s[12:15], s21 offen offset:2048 lds
 s_add_u32 m0, s81, 3072
 s_add_u32 s21, s88, 49152
 buffer_load_dwordx4 v31, s[12:15], s21 offen offset:0 lds
 buffer_load_dwordx4 v32, s[12:15], s21 offen offset:1024 lds
 buffer_load_dwordx4 v33, s[12:15], s21 offen offset:2048 lds
 s_add_u32 m0, s81, 6144
 s_add_u32 s21, s88, 491520
 buffer_load_dwordx4 v34, s[12:15], s21 offen offset:0 lds
 buffer_load_dwordx4 v35, s[12:15], s21 offen offset:1024 lds
 buffer_load_dwordx4 v36, s[12:15], s21 offen offset:2048 lds
 s_add_u32 m0, s81, 9216
 s_add_u32 s21, s88, 540672
 buffer_load_dwordx4 v37, s[12:15], s21 offen offset:0 lds
 buffer_load_dwordx4 v38, s[12:15], s21 offen offset:1024 lds
 buffer_load_dwordx4 v39, s[12:15], s21 offen offset:2048 lds
 s_add_u32 s22, s80, 0
 buffer_load_dwordx4 v[220:223], v244, s[40:43], s22 offen
 buffer_load_dwordx4 v[224:227], v245, s[40:43], s22 offen
 buffer_load_dwordx4 v[228:231], v246, s[40:43], s22 offen
 s_add_u32 s22, s80, 983040
 buffer_load_dwordx4 v[232:235], v244, s[40:43], s22 offen
 buffer_load_dwordx4 v[236:239], v245, s[40:43], s22 offen
 buffer_load_dwordx4 v[240:243], v246, s[40:43], s22 offen
 v_and_b32 v56, 7, v2
 v_lshrrev_b32 v57, 3, v2
 v_lshlrev_b32 v16, 4, v1
 s_lshr_b32 s21, s20, 1
 s_lshl_b32 s21, s21, 14
 s_and_b32 s22, s20, 1
 s_mul_i32 s22, s22, 3072
 s_add_u32 s21, s21, s22
 v_add_u32 v4, s21, v16
 v_mov_b32 v58, 0x4444
 v_mov_b32 v59, 0xeeee
 v_cmp_eq_u32 vcc, 1, v57
 s_nop 1
 v_cndmask_b32 v25, v58, v59, vcc
 v_mul_u32_u24 v58, 40, v2
 v_lshl_add_u32 v58, v3, 3, v58
 s_mul_i32 s21, s20, 1920
 v_add_u32 v5, s21, v58
 v_lshrrev_b32 v58, 2, v1
 v_mul_u32_u24 v58, 40, v58
 v_and_b32 v59, 3, v1
 v_lshl_add_u32 v6, v59, 3, v58
 v_bfe_u32 v59, v1, 1, 1
 v_mul_u32_u24 v59, 3824, v59
 v_add_u32 v21, v6, v59
 s_lshl_b32 s21, s50, 4
 s_add_u32 s21, s21, s51
 s_lshl_b32 s21, s21, 9
 s_lshl_b32 s22, s20, 7
 s_add_u32 s21, s21, s22
 s_add_u32 s21, s21, 81920
 v_and_b32 v58, 1, v3
 v_lshlrev_b32 v58, 8, v58
 v_lshl_add_u32 v58, v56, 4, v58
 v_lshrrev_b32 v59, 1, v3
 v_lshl_add_u32 v58, v59, 3, v58
 v_add_u32 v7, s21, v58
 s_lshl_b32 s22, s58, 9
 s_lshl_b32 s23, s56, 7
 s_add_u32 s22, s22, s23
 s_add_u32 s22, s22, 376704
 v_lshlrev_b32 v58, 6, v3
 v_lshl_add_u32 v58, v56, 3, v58
 v_add_u32 v58, s22, v58
 s_cmp_eq_u32 s20, 2
 s_cselect_b64 vcc, -1, 0
 v_cndmask_b32 v7, v7, v58, vcc
 s_lshl_b32 s21, s59, 11
 s_add_u32 s21, s21, 81920
 v_add_u32 v8, s21, v16
 s_lshl_b32 s21, s59, 9
 s_add_u32 s21, s21, 376832
 v_lshl_add_u32 v9, v1, 3, s21
 s_mul_i32 s21, s20, 3072
 s_add_u32 s21, s21, 24576
 v_and_b32 v58, 0x39, v1
 v_bfe_u32 v59, v1, 1, 1
 v_lshl_or_b32 v58, v59, 2, v58
 v_bfe_u32 v59, v1, 2, 1
 v_lshl_or_b32 v58, v59, 1, v58
 v_lshl_add_u32 v10, v58, 4, s21
 s_mul_i32 s22, s56, 12
 s_cmp_eq_u32 s20, 2
 s_cselect_b64 vcc, -1, 0
 v_add_u32 v58, s22, v3
 v_add3_u32 v59, 0, v58, v3
 v_lshrrev_b32 v60, 1, v59
 v_and_b32 v59, 1, v59
 v_lshlrev_b32 v59, 3, v59
 v_lshl_add_u32 v61, v60, 7, v59
 v_lshl_add_u32 v61, v56, 4, v61
 s_lshr_b32 s21, s58, 1
 s_lshl_b32 s21, s21, 14
 s_and_b32 s22, s58, 1
 s_mul_i32 s22, s22, 3072
 s_add_u32 s21, s21, s22
 s_add_u32 s21, s21, 655360
 v_add_u32 v62, s21, v61
 v_lshl_add_u32 v61, v60, 8, v59
 v_lshl_add_u32 v61, v2, 4, v61
 s_mul_i32 s21, s58, 12288
 s_and_b32 s22, s20, 1
 s_mul_i32 s22, s22, 6144
 s_add_u32 s21, s21, s22
 v_add_u32 v61, s21, v61
 v_cndmask_b32 v18, v61, v62, vcc
 v_add_u32 v59, 8, v58
 v_lshrrev_b32 v60, 1, v59
 v_and_b32 v59, 1, v59
 v_lshlrev_b32 v59, 3, v59
 v_lshl_add_u32 v61, v60, 7, v59
 v_lshl_add_u32 v61, v56, 4, v61
 s_lshr_b32 s21, s58, 1
 s_lshl_b32 s21, s21, 14
 s_and_b32 s22, s58, 1
 s_mul_i32 s22, s22, 3072
 s_add_u32 s21, s21, s22
 s_add_u32 s21, s21, 655360
 v_add_u32 v62, s21, v61
 v_lshl_add_u32 v61, v60, 8, v59
 v_lshl_add_u32 v61, v2, 4, v61
 s_mul_i32 s21, s58, 12288
 s_and_b32 s22, s20, 1
 s_mul_i32 s22, s22, 6144
 s_add_u32 s21, s21, s22
 v_add_u32 v61, s21, v61
 v_cndmask_b32 v19, v61, v62, vcc
 s_mul_i32 s21, s20, 3072
 s_add_u32 s21, s21, 8192
 v_add_u32 v11, s21, v16
 v_and_b32 v58, 3, v1
 s_lshl_b32 s21, s20, 2
 v_add_u32 v59, s21, v58
 v_cmp_eq_u32 vcc, 10, v59
 s_nop 1
 v_cndmask_b32 v59, v59, 7, vcc
 v_cmp_eq_u32 vcc, 3, v58
 v_lshrrev_b32 v60, 5, v1
 v_mul_u32_u24 v60, 10, v60
 v_cndmask_b32 v59, v59, 3, vcc
 s_lshl_b32 s21, s79, 2
 v_add3_u32 v59, v59, v60, s21
 v_lshrrev_b32 v60, 1, v59
 v_lshlrev_b32 v60, 8, v60
 v_and_b32 v59, 1, v59
 v_lshl_add_u32 v60, v59, 3, v60
 v_bfe_u32 v59, v1, 2, 3
 v_lshl_add_u32 v60, v59, 4, v60
 v_add_u32 v12, 8192, v60
 s_mov_b32 s21, 0x07060100
 s_cmp_eq_u32 s20, 1
 s_cselect_b32 s21, 0x07060302, s21
 s_cmp_eq_u32 s20, 2
 s_cselect_b32 s21, 0x07060c0c, s21
 v_mov_b32 v59, s21
 v_mov_b32 v60, 0x03020100
 v_cndmask_b32 v14, v60, v59, vcc
 s_lshr_b32 s21, s85, 3
 s_lshl_b32 s21, s21, 14
 s_bfe_u32 s22, s85, 0x10002
 s_mul_i32 s22, s22, 3072
 s_add_u32 s21, s21, s22
 s_and_b32 s22, s85, 3
 s_lshl_b32 s22, s22, 8
 s_add_u32 s21, s21, s22
 s_lshl_b32 s22, s20, 10
 s_add_u32 s22, s22, s21
 v_lshl_add_u32 v13, v1, 2, s22
 v_lshlrev_b32 v59, 10, v3
 v_lshl_add_u32 v59, v2, 4, v59
 v_add_u32 v59, s21, v59
 s_cmp_eq_u32 s20, 3
 s_cselect_b64 vcc, -1, 0
 v_cndmask_b32 v13, v13, v59, vcc
 s_mov_b32 s91, 0x3c000000
 v_and_b32 v59, 1, v3
 v_lshrrev_b32 v60, 1, v3
 v_lshl_add_u32 v59, v59, 1, v60
 v_add_u32 v59, s87, v59
 v_lshrrev_b32 v60, 2, v59
 v_and_b32 v59, 3, v59
 v_lshlrev_b32 v59, 8, v59
 v_lshl_add_u32 v59, v60, 16, v59
 v_lshl_add_u32 v59, v2, 4, v59
 s_lshr_b32 s21, s59, 3
 s_lshl_b32 s21, s21, 14
 s_and_b32 s22, s59, 7
 s_lshl_b32 s22, s22, 10
 s_add_u32 s21, s21, s22
 v_add_u32 v15, s21, v59
 s_lshl_b32 s21, s79, 4
 s_lshl_b32 s76, -1, s21
 s_mov_b32 s77, 0xffff
 s_lshl_b32 s21, s79, 7
 v_or_b32 v17, s21, v16
 s_or_b32 s21, s21, 0xffffff7f
 v_and_b32 v20, s21, v16
 v_lshlrev_b32 v24, 3, v1
 v_cmp_gt_u32 s[60:61], 8, v2
 v_cmp_le_u32 s[62:63], 8, v2
 v_cmp_le_u32 s[72:73], 2, v3
 v_cmp_gt_u32 s[70:71], 48, v1
 s_nop 1
 s_and_b64 s[64:65], s[60:61], s[72:73]
 s_cmp_eq_u32 s20, 2
 s_cselect_b64 s[74:75], s[64:65], s[60:61]
 s_waitcnt vmcnt(18)
 ds_read_b64_tr_b16 v[64:65], v250 offset:12288
 ds_read_b64_tr_b16 v[66:67], v250 offset:12672
 ds_read_b64_tr_b16 v[88:89], v250 offset:12320
 ds_read_b64_tr_b16 v[90:91], v250 offset:12704
 ds_read_b64_tr_b16 v[112:113], v250 offset:12352
 ds_read_b64_tr_b16 v[114:115], v250 offset:12736
 ds_read_b64_tr_b16 v[68:69], v250 offset:15360
 ds_read_b64_tr_b16 v[70:71], v250 offset:15744
 ds_read_b64_tr_b16 v[92:93], v250 offset:15392
 ds_read_b64_tr_b16 v[94:95], v250 offset:15776
 ds_read_b64_tr_b16 v[116:117], v250 offset:15424
 ds_read_b64_tr_b16 v[118:119], v250 offset:15808
 ds_read_b64_tr_b16 v[72:73], v250 offset:18432
 ds_read_b64_tr_b16 v[74:75], v250 offset:18816
 ds_read_b64_tr_b16 v[96:97], v250 offset:18464
 ds_read_b64_tr_b16 v[98:99], v250 offset:18848
 ds_read_b64_tr_b16 v[120:121], v250 offset:18496
 ds_read_b64_tr_b16 v[122:123], v250 offset:18880
 ds_read_b64_tr_b16 v[76:77], v250 offset:21504
 ds_read_b64_tr_b16 v[78:79], v250 offset:21888
 ds_read_b64_tr_b16 v[100:101], v250 offset:21536
 ds_read_b64_tr_b16 v[102:103], v250 offset:21920
 ds_read_b64_tr_b16 v[124:125], v250 offset:21568
 ds_read_b64_tr_b16 v[126:127], v250 offset:21952
 ds_read_b64_tr_b16 v[80:81], v250 offset:24576
 ds_read_b64_tr_b16 v[82:83], v250 offset:24960
 ds_read_b64_tr_b16 v[104:105], v250 offset:24608
 ds_read_b64_tr_b16 v[106:107], v250 offset:24992
 ds_read_b64_tr_b16 v[128:129], v250 offset:24640
 ds_read_b64_tr_b16 v[130:131], v250 offset:25024
 ds_read_b64_tr_b16 v[84:85], v250 offset:27648
 ds_read_b64_tr_b16 v[86:87], v250 offset:28032
 ds_read_b64_tr_b16 v[108:109], v250 offset:27680
 ds_read_b64_tr_b16 v[110:111], v250 offset:28064
 ds_read_b64_tr_b16 v[132:133], v250 offset:27712
 ds_read_b64_tr_b16 v[134:135], v250 offset:28096
 s_waitcnt lgkmcnt(0)
 s_add_u32 m0, s81, 12288
 s_add_u32 s21, s88, 983040
 buffer_load_dwordx4 v28, s[12:15], s21 offen offset:0 lds
 buffer_load_dwordx4 v29, s[12:15], s21 offen offset:1024 lds
 buffer_load_dwordx4 v30, s[12:15], s21 offen offset:2048 lds
 s_add_u32 m0, s81, 15360
 s_add_u32 s21, s88, 1032192
 buffer_load_dwordx4 v31, s[12:15], s21 offen offset:0 lds
 buffer_load_dwordx4 v32, s[12:15], s21 offen offset:1024 lds
 buffer_load_dwordx4 v33, s[12:15], s21 offen offset:2048 lds
 s_add_u32 m0, s81, 18432
 s_add_u32 s21, s88, 1474560
 buffer_load_dwordx4 v34, s[12:15], s21 offen offset:0 lds
 buffer_load_dwordx4 v35, s[12:15], s21 offen offset:1024 lds
 buffer_load_dwordx4 v36, s[12:15], s21 offen offset:2048 lds
 s_add_u32 m0, s81, 21504
 s_add_u32 s21, s88, 1523712
 buffer_load_dwordx4 v37, s[12:15], s21 offen offset:0 lds
 buffer_load_dwordx4 v38, s[12:15], s21 offen offset:1024 lds
 buffer_load_dwordx4 v39, s[12:15], s21 offen offset:2048 lds
 s_add_u32 m0, s81, 24576
 s_add_u32 s21, s88, 98304
 buffer_load_dwordx4 v28, s[12:15], s21 offen offset:0 lds
 buffer_load_dwordx4 v29, s[12:15], s21 offen offset:1024 lds
 buffer_load_dwordx4 v30, s[12:15], s21 offen offset:2048 lds
 s_add_u32 m0, s81, 27648
 s_add_u32 s21, s88, 147456
 buffer_load_dwordx4 v31, s[12:15], s21 offen offset:0 lds
 buffer_load_dwordx4 v32, s[12:15], s21 offen offset:1024 lds
 buffer_load_dwordx4 v33, s[12:15], s21 offen offset:2048 lds
 s_add_u32 m0, s81, 30720
 s_add_u32 s21, s88, 589824
 buffer_load_dwordx4 v34, s[12:15], s21 offen offset:0 lds
 buffer_load_dwordx4 v35, s[12:15], s21 offen offset:1024 lds
 buffer_load_dwordx4 v36, s[12:15], s21 offen offset:2048 lds
 s_add_u32 m0, s81, 33792
 s_add_u32 s21, s88, 638976
 buffer_load_dwordx4 v37, s[12:15], s21 offen offset:0 lds
 buffer_load_dwordx4 v38, s[12:15], s21 offen offset:1024 lds
 buffer_load_dwordx4 v39, s[12:15], s21 offen offset:2048 lds
 v_lshrrev_b32 v40, 2, v2
 v_and_b32 v41, 3, v2
 v_lshl_add_u32 v41, v40, 3, v41
 v_mul_u32_u24 v41, 384, v41
 v_add_u32 v41, s81, v41
 v_lshrrev_b32 v40, 1, v2
 v_xor_b32 v40, v40, v3
 v_lshl_add_u32 v22, v40, 4, v41
 v_xor_b32 v40, 4, v40
 v_lshl_add_u32 v23, v40, 4, v41
 s_mul_i32 s64, s59, 40960
 s_lshl_b32 s21, s87, 10
 s_add_u32 s64, s64, s21
 s_add_u32 s64, s64, 1310720
 s_lshl_b32 s79, s59, 7
 s_and_b32 s21, s51, 12
 s_lshl_b32 s21, s21, 10
 s_add_u32 s79, s79, s21
 s_add_u32 s79, s79, 95232
 s_lshl_b32 s90, s58, 7
 s_add_u32 s90, s90, 19456
 s_cmp_eq_u32 s56, 0
 s_cselect_b32 s66, s90, 0x80000000
 s_bfe_u32 s82, s50, 0x10001
 s_lshl_b32 s82, s82, 5
 s_lshr_b32 s21, s50, 2
 s_add_u32 s82, s82, s21
 s_and_b32 s83, s50, 1
 s_lshl_b32 s83, s83, 4
 s_add_u32 s83, s83, 16
 s_waitcnt vmcnt(30)
 ds_read_b128 v[136:139], v22 offset:0
 ds_read_b128 v[140:143], v23 offset:0
 ds_read_b128 v[144:147], v22 offset:128
 s_waitcnt lgkmcnt(2)
 v_mfma_f32_16x16x32_bf16 v[40:43], v[136:139], v[64:67], 0
 ds_read_b128 v[148:151], v23 offset:128
 s_waitcnt vmcnt(27)
 ds_write_b128 v251, v[220:223] offset:36864
 v_mfma_f32_16x16x32_bf16 v[48:51], v[136:139], v[88:91], 0
 ds_write_b128 v251, v[224:227] offset:37888
 ds_write_b128 v251, v[228:231] offset:38912
 ds_read_b64_tr_b16 v[208:209], v250 offset:36864
 v_mfma_f32_16x16x32_bf16 v[56:59], v[136:139], v[112:115], 0
 ds_read_b64_tr_b16 v[210:211], v250 offset:37248
 ds_read_b64_tr_b16 v[212:213], v250 offset:36896
 ds_read_b64_tr_b16 v[214:215], v250 offset:37280
 ds_read_b64_tr_b16 v[216:217], v250 offset:36928
 s_waitcnt lgkmcnt(10)
 v_mfma_f32_16x16x32_bf16 v[40:43], v[140:143], v[68:71], v[40:43]
 ds_read_b128 v[136:139], v22 offset:256
 ds_read_b64_tr_b16 v[218:219], v250 offset:37312
 s_add_u32 s22, s80, 98304
 buffer_load_dwordx4 v[220:223], v244, s[40:43], s22 offen
 v_mfma_f32_16x16x32_bf16 v[48:51], v[140:143], v[92:95], v[48:51]
 buffer_load_dwordx4 v[224:227], v245, s[40:43], s22 offen
 buffer_load_dwordx4 v[228:231], v246, s[40:43], s22 offen
 v_mfma_f32_16x16x32_bf16 v[56:59], v[140:143], v[116:119], v[56:59]
 s_waitcnt lgkmcnt(11)
 v_mfma_f32_16x16x32_bf16 v[40:43], v[144:147], v[72:75], v[40:43]
 ds_read_b128 v[140:143], v23 offset:256
 v_mfma_f32_16x16x32_bf16 v[48:51], v[144:147], v[96:99], v[48:51]
 v_mfma_f32_16x16x32_bf16 v[56:59], v[144:147], v[120:123], v[56:59]
 s_waitcnt lgkmcnt(11)
 v_mfma_f32_16x16x32_bf16 v[40:43], v[148:151], v[76:79], v[40:43]
 ds_read_b128 v[144:147], v22 offset:1536
 v_mfma_f32_16x16x32_bf16 v[48:51], v[148:151], v[100:103], v[48:51]
 s_waitcnt lgkmcnt(2)
 v_lshlrev_b32 v27, 16, v208
 v_and_b32 v208, 0xffff0000, v208
 v_cvt_pk_f16_f32 v208, v27, v208
 v_accvgpr_write_b32 a60, v208
 v_mfma_f32_16x16x32_bf16 v[56:59], v[148:151], v[124:127], v[56:59]
 v_lshlrev_b32 v27, 16, v209
 v_and_b32 v209, 0xffff0000, v209
 v_cvt_pk_f16_f32 v209, v27, v209
 v_accvgpr_write_b32 a61, v209
 s_waitcnt lgkmcnt(3)
 v_mfma_f32_16x16x32_bf16 v[40:43], v[136:139], v[80:83], v[40:43]
 ds_read_b128 v[148:151], v23 offset:1536
 v_lshlrev_b32 v27, 16, v210
 v_and_b32 v210, 0xffff0000, v210
 v_cvt_pk_f16_f32 v210, v27, v210
 v_accvgpr_write_b32 a62, v210
 v_mfma_f32_16x16x32_bf16 v[48:51], v[136:139], v[104:107], v[48:51]
 v_lshlrev_b32 v27, 16, v211
 v_and_b32 v211, 0xffff0000, v211
 v_cvt_pk_f16_f32 v211, v27, v211
 v_accvgpr_write_b32 a63, v211
 v_lshlrev_b32 v27, 16, v212
 v_mfma_f32_16x16x32_bf16 v[56:59], v[136:139], v[128:131], v[56:59]
 v_and_b32 v212, 0xffff0000, v212
 v_cvt_pk_f16_f32 v212, v27, v212
 v_accvgpr_write_b32 a80, v212
 v_lshlrev_b32 v27, 16, v213
 s_waitcnt lgkmcnt(2)
 v_mfma_f32_16x16x32_bf16 v[40:43], v[140:143], v[84:87], v[40:43]
 ds_read_b128 v[136:139], v22 offset:1664
 v_and_b32 v213, 0xffff0000, v213
 v_cvt_pk_f16_f32 v213, v27, v213
 v_accvgpr_write_b32 a81, v213
 v_lshlrev_b32 v27, 16, v214
 v_mfma_f32_16x16x32_bf16 v[48:51], v[140:143], v[108:111], v[48:51]
 v_and_b32 v214, 0xffff0000, v214
 v_cvt_pk_f16_f32 v214, v27, v214
 v_accvgpr_write_b32 a82, v214
 v_lshlrev_b32 v27, 16, v215
 v_and_b32 v215, 0xffff0000, v215
 v_mfma_f32_16x16x32_bf16 v[56:59], v[140:143], v[132:135], v[56:59]
 v_cvt_pk_f16_f32 v215, v27, v215
 v_accvgpr_write_b32 a83, v215
 v_lshlrev_b32 v27, 16, v216
 v_and_b32 v216, 0xffff0000, v216
 s_waitcnt lgkmcnt(2)
 v_mfma_f32_16x16x32_bf16 v[44:47], v[144:147], v[64:67], 0
 ds_read_b128 v[140:143], v23 offset:1664
 v_cvt_pk_f16_f32 v216, v27, v216
 v_accvgpr_write_b32 a100, v216
 v_lshlrev_b32 v27, 16, v217
 v_and_b32 v217, 0xffff0000, v217
 v_mfma_f32_16x16x32_bf16 v[52:55], v[144:147], v[88:91], 0
 v_cvt_pk_f16_f32 v217, v27, v217
 v_accvgpr_write_b32 a101, v217
 v_lshlrev_b32 v27, 16, v218
 v_and_b32 v218, 0xffff0000, v218
 v_cvt_pk_f16_f32 v218, v27, v218
 v_mfma_f32_16x16x32_bf16 v[60:63], v[144:147], v[112:115], 0
 v_accvgpr_write_b32 a102, v218
 v_lshlrev_b32 v27, 16, v219
 v_and_b32 v219, 0xffff0000, v219
 v_cvt_pk_f16_f32 v219, v27, v219
 s_waitcnt lgkmcnt(2)
 v_mfma_f32_16x16x32_bf16 v[44:47], v[148:151], v[68:71], v[44:47]
 ds_read_b128 v[144:147], v22 offset:1792
 v_cvt_pk_f16_f32 v40, v40, v41
 v_accvgpr_write_b32 a103, v219
 v_accvgpr_write_b32 a120, v40
 v_cvt_pk_f16_f32 v42, v42, v43
 v_mfma_f32_16x16x32_bf16 v[52:55], v[148:151], v[92:95], v[52:55]
 v_accvgpr_write_b32 a121, v42
 v_cvt_pk_f16_f32 v48, v48, v49
 v_accvgpr_write_b32 a128, v48
 v_cvt_pk_f16_f32 v50, v50, v51
 v_accvgpr_write_b32 a129, v50
 v_mfma_f32_16x16x32_bf16 v[60:63], v[148:151], v[116:119], v[60:63]
 v_cvt_pk_f16_f32 v56, v56, v57
 v_accvgpr_write_b32 a136, v56
 v_cvt_pk_f16_f32 v58, v58, v59
 v_accvgpr_write_b32 a137, v58
 s_waitcnt lgkmcnt(2)
 v_mfma_f32_16x16x32_bf16 v[44:47], v[136:139], v[72:75], v[44:47]
 ds_read_b128 v[148:151], v23 offset:1792
 v_mfma_f32_16x16x32_bf16 v[52:55], v[136:139], v[96:99], v[52:55]
 v_mfma_f32_16x16x32_bf16 v[60:63], v[136:139], v[120:123], v[60:63]
 s_waitcnt lgkmcnt(2)
 v_mfma_f32_16x16x32_bf16 v[44:47], v[140:143], v[76:79], v[44:47]
 s_waitcnt vmcnt(15)
 ds_read_b128 v[136:139], v22 offset:12288
 v_mfma_f32_16x16x32_bf16 v[52:55], v[140:143], v[100:103], v[52:55]
 v_mfma_f32_16x16x32_bf16 v[60:63], v[140:143], v[124:127], v[60:63]
 s_waitcnt lgkmcnt(2)
 v_mfma_f32_16x16x32_bf16 v[44:47], v[144:147], v[80:83], v[44:47]
 ds_read_b128 v[140:143], v23 offset:12288
 v_mfma_f32_16x16x32_bf16 v[52:55], v[144:147], v[104:107], v[52:55]
 v_mfma_f32_16x16x32_bf16 v[60:63], v[144:147], v[128:131], v[60:63]
 s_waitcnt lgkmcnt(2)
 v_mfma_f32_16x16x32_bf16 v[44:47], v[148:151], v[84:87], v[44:47]
 ds_read_b128 v[144:147], v22 offset:12416
 s_add_u32 m0, s81, 0
 s_add_u32 s21, s88, 1081344
 v_mfma_f32_16x16x32_bf16 v[52:55], v[148:151], v[108:111], v[52:55]
 buffer_load_dwordx4 v28, s[12:15], s21 offen offset:0 lds
 v_mfma_f32_16x16x32_bf16 v[60:63], v[148:151], v[132:135], v[60:63]
 buffer_load_dwordx4 v29, s[12:15], s21 offen offset:1024 lds
 s_waitcnt lgkmcnt(2)
 v_mfma_f32_16x16x32_bf16 v[40:43], v[136:139], v[64:67], 0
 ds_read_b128 v[148:151], v23 offset:12416
 buffer_load_dwordx4 v30, s[12:15], s21 offen offset:2048 lds
 s_waitcnt vmcnt(30)
 v_mfma_f32_16x16x32_bf16 v[48:51], v[136:139], v[88:91], 0
 s_add_u32 m0, s81, 3072
 s_add_u32 s21, s88, 1130496
 ds_write_b128 v251, v[232:235] offset:36864
 v_mfma_f32_16x16x32_bf16 v[56:59], v[136:139], v[112:115], 0
 buffer_load_dwordx4 v31, s[12:15], s21 offen offset:0 lds
 ds_write_b128 v251, v[236:239] offset:37888
 s_waitcnt lgkmcnt(4)
 v_mfma_f32_16x16x32_bf16 v[40:43], v[140:143], v[68:71], v[40:43]
 ds_read_b128 v[136:139], v22 offset:12544
 v_cvt_pk_f16_f32 v44, v44, v45
 buffer_load_dwordx4 v32, s[12:15], s21 offen offset:1024 lds
 v_accvgpr_write_b32 a122, v44
 v_mfma_f32_16x16x32_bf16 v[48:51], v[140:143], v[92:95], v[48:51]
 v_cvt_pk_f16_f32 v46, v46, v47
 buffer_load_dwordx4 v33, s[12:15], s21 offen offset:2048 lds
 ds_write_b128 v251, v[240:243] offset:38912
 v_mfma_f32_16x16x32_bf16 v[56:59], v[140:143], v[116:119], v[56:59]
 v_accvgpr_write_b32 a123, v46
 s_add_u32 m0, s81, 6144
 s_add_u32 s21, s88, 1572864
 ds_read_b64_tr_b16 v[208:209], v250 offset:36864
 s_waitcnt lgkmcnt(6)
 v_mfma_f32_16x16x32_bf16 v[40:43], v[144:147], v[72:75], v[40:43]
 ds_read_b128 v[140:143], v23 offset:12544
 v_cvt_pk_f16_f32 v52, v52, v53
 buffer_load_dwordx4 v34, s[12:15], s21 offen offset:0 lds
 ds_read_b64_tr_b16 v[210:211], v250 offset:37248
 v_mfma_f32_16x16x32_bf16 v[48:51], v[144:147], v[96:99], v[48:51]
 v_accvgpr_write_b32 a130, v52
 buffer_load_dwordx4 v35, s[12:15], s21 offen offset:1024 lds
 ds_read_b64_tr_b16 v[212:213], v250 offset:36896
 ds_read_b64_tr_b16 v[214:215], v250 offset:37280
 v_mfma_f32_16x16x32_bf16 v[56:59], v[144:147], v[120:123], v[56:59]
 v_cvt_pk_f16_f32 v54, v54, v55
 buffer_load_dwordx4 v36, s[12:15], s21 offen offset:2048 lds
 ds_read_b64_tr_b16 v[216:217], v250 offset:36928
 s_waitcnt lgkmcnt(10)
 v_mfma_f32_16x16x32_bf16 v[40:43], v[148:151], v[76:79], v[40:43]
 ds_read_b128 v[144:147], v22 offset:13824
 v_accvgpr_write_b32 a131, v54
 s_add_u32 m0, s81, 9216
 s_add_u32 s21, s88, 1622016
 ds_read_b64_tr_b16 v[218:219], v250 offset:37312
 v_mfma_f32_16x16x32_bf16 v[48:51], v[148:151], v[100:103], v[48:51]
 v_cvt_pk_f16_f32 v60, v60, v61
 buffer_load_dwordx4 v37, s[12:15], s21 offen offset:0 lds
 s_add_u32 s22, s80, 1081344
 v_accvgpr_write_b32 a138, v60
 v_mfma_f32_16x16x32_bf16 v[56:59], v[148:151], v[124:127], v[56:59]
 v_cvt_pk_f16_f32 v62, v62, v63
 buffer_load_dwordx4 v38, s[12:15], s21 offen offset:1024 lds
 v_accvgpr_write_b32 a139, v62
 s_waitcnt lgkmcnt(9)
 v_mfma_f32_16x16x32_bf16 v[40:43], v[136:139], v[80:83], v[40:43]
 ds_read_b128 v[148:151], v23 offset:13824
 buffer_load_dwordx4 v39, s[12:15], s21 offen offset:2048 lds
 buffer_load_dwordx4 v[232:235], v244, s[40:43], s22 offen
 v_mfma_f32_16x16x32_bf16 v[48:51], v[136:139], v[104:107], v[48:51]
 buffer_load_dwordx4 v[236:239], v245, s[40:43], s22 offen
 buffer_load_dwordx4 v[240:243], v246, s[40:43], s22 offen
 v_mfma_f32_16x16x32_bf16 v[56:59], v[136:139], v[128:131], v[56:59]
 s_waitcnt lgkmcnt(7)
 v_mfma_f32_16x16x32_bf16 v[40:43], v[140:143], v[84:87], v[40:43]
 ds_read_b128 v[136:139], v22 offset:13952
 v_mfma_f32_16x16x32_bf16 v[48:51], v[140:143], v[108:111], v[48:51]
 v_mfma_f32_16x16x32_bf16 v[56:59], v[140:143], v[132:135], v[56:59]
 s_waitcnt lgkmcnt(3)
 v_mfma_f32_16x16x32_bf16 v[44:47], v[144:147], v[64:67], 0
 ds_read_b128 v[140:143], v23 offset:13952
 v_mfma_f32_16x16x32_bf16 v[52:55], v[144:147], v[88:91], 0
 s_waitcnt lgkmcnt(3)
 v_lshlrev_b32 v27, 16, v208
 v_and_b32 v208, 0xffff0000, v208
 v_cvt_pk_f16_f32 v208, v27, v208
 v_accvgpr_write_b32 a64, v208
 v_mfma_f32_16x16x32_bf16 v[60:63], v[144:147], v[112:115], 0
 v_lshlrev_b32 v27, 16, v209
 v_and_b32 v209, 0xffff0000, v209
 v_cvt_pk_f16_f32 v209, v27, v209
 v_accvgpr_write_b32 a65, v209
 s_waitcnt lgkmcnt(2)
 v_mfma_f32_16x16x32_bf16 v[44:47], v[148:151], v[68:71], v[44:47]
 ds_read_b128 v[144:147], v22 offset:14080
 v_cvt_pk_f16_f32 v40, v40, v41
 v_lshlrev_b32 v27, 16, v210
 v_and_b32 v210, 0xffff0000, v210
 v_cvt_pk_f16_f32 v210, v27, v210
 v_mfma_f32_16x16x32_bf16 v[52:55], v[148:151], v[92:95], v[52:55]
 v_accvgpr_write_b32 a124, v40
 v_accvgpr_write_b32 a66, v210
 v_lshlrev_b32 v27, 16, v211
 v_and_b32 v211, 0xffff0000, v211
 v_cvt_pk_f16_f32 v211, v27, v211
 v_mfma_f32_16x16x32_bf16 v[60:63], v[148:151], v[116:119], v[60:63]
 v_cvt_pk_f16_f32 v42, v42, v43
 v_accvgpr_write_b32 a67, v211
 v_lshlrev_b32 v27, 16, v212
 v_and_b32 v212, 0xffff0000, v212
 s_waitcnt lgkmcnt(2)
 v_mfma_f32_16x16x32_bf16 v[44:47], v[136:139], v[72:75], v[44:47]
 ds_read_b128 v[148:151], v23 offset:14080
 v_accvgpr_write_b32 a125, v42
 v_cvt_pk_f16_f32 v212, v27, v212
 v_accvgpr_write_b32 a84, v212
 v_lshlrev_b32 v27, 16, v213
 v_mfma_f32_16x16x32_bf16 v[52:55], v[136:139], v[96:99], v[52:55]
 v_cvt_pk_f16_f32 v48, v48, v49
 v_and_b32 v213, 0xffff0000, v213
 v_cvt_pk_f16_f32 v213, v27, v213
 v_accvgpr_write_b32 a85, v213
 v_lshlrev_b32 v27, 16, v214
 v_mfma_f32_16x16x32_bf16 v[60:63], v[136:139], v[120:123], v[60:63]
 v_accvgpr_write_b32 a132, v48
 v_and_b32 v214, 0xffff0000, v214
 v_cvt_pk_f16_f32 v214, v27, v214
 v_accvgpr_write_b32 a86, v214
 s_waitcnt lgkmcnt(2)
 v_mfma_f32_16x16x32_bf16 v[44:47], v[140:143], v[76:79], v[44:47]
 s_waitcnt vmcnt(18)
 ds_read_b128 v[136:139], v22 offset:24576
 v_cvt_pk_f16_f32 v50, v50, v51
 v_lshlrev_b32 v27, 16, v215
 v_and_b32 v215, 0xffff0000, v215
 v_cvt_pk_f16_f32 v215, v27, v215
 v_mfma_f32_16x16x32_bf16 v[52:55], v[140:143], v[100:103], v[52:55]
 v_accvgpr_write_b32 a133, v50
 v_accvgpr_write_b32 a87, v215
 v_lshlrev_b32 v27, 16, v216
 v_and_b32 v216, 0xffff0000, v216
 v_cvt_pk_f16_f32 v216, v27, v216
 v_mfma_f32_16x16x32_bf16 v[60:63], v[140:143], v[124:127], v[60:63]
 v_cvt_pk_f16_f32 v56, v56, v57
 v_accvgpr_write_b32 a104, v216
 v_lshlrev_b32 v27, 16, v217
 v_and_b32 v217, 0xffff0000, v217
 s_waitcnt lgkmcnt(2)
 v_mfma_f32_16x16x32_bf16 v[44:47], v[144:147], v[80:83], v[44:47]
 ds_read_b128 v[140:143], v23 offset:24576
 v_accvgpr_write_b32 a140, v56
 v_cvt_pk_f16_f32 v217, v27, v217
 v_accvgpr_write_b32 a105, v217
 v_lshlrev_b32 v27, 16, v218
 v_mfma_f32_16x16x32_bf16 v[52:55], v[144:147], v[104:107], v[52:55]
 v_cvt_pk_f16_f32 v58, v58, v59
 v_and_b32 v218, 0xffff0000, v218
 v_cvt_pk_f16_f32 v218, v27, v218
 v_accvgpr_write_b32 a106, v218
 v_lshlrev_b32 v27, 16, v219
 v_mfma_f32_16x16x32_bf16 v[60:63], v[144:147], v[128:131], v[60:63]
 v_accvgpr_write_b32 a141, v58
 v_and_b32 v219, 0xffff0000, v219
 v_cvt_pk_f16_f32 v219, v27, v219
 v_accvgpr_write_b32 a107, v219
 s_waitcnt lgkmcnt(2)
 v_mfma_f32_16x16x32_bf16 v[44:47], v[148:151], v[84:87], v[44:47]
 ds_read_b128 v[144:147], v22 offset:24704
 s_add_u32 m0, s81, 12288
 s_add_u32 s21, s88, 1966080
 v_mfma_f32_16x16x32_bf16 v[52:55], v[148:151], v[108:111], v[52:55]
 buffer_load_dwordx4 v28, s[12:15], s21 offen offset:0 lds
 v_mfma_f32_16x16x32_bf16 v[60:63], v[148:151], v[132:135], v[60:63]
 buffer_load_dwordx4 v29, s[12:15], s21 offen offset:1024 lds
 s_waitcnt lgkmcnt(2)
 v_mfma_f32_16x16x32_bf16 v[40:43], v[136:139], v[64:67], 0
 ds_read_b128 v[148:151], v23 offset:24704
 buffer_load_dwordx4 v30, s[12:15], s21 offen offset:2048 lds
 s_waitcnt vmcnt(18)
 v_mfma_f32_16x16x32_bf16 v[48:51], v[136:139], v[88:91], 0
 s_add_u32 m0, s81, 15360
 s_add_u32 s21, s88, 2015232
 ds_write_b128 v251, v[220:223] offset:36864
 v_mfma_f32_16x16x32_bf16 v[56:59], v[136:139], v[112:115], 0
 buffer_load_dwordx4 v31, s[12:15], s21 offen offset:0 lds
 ds_write_b128 v251, v[224:227] offset:37888
 s_waitcnt lgkmcnt(4)
 v_mfma_f32_16x16x32_bf16 v[40:43], v[140:143], v[68:71], v[40:43]
 ds_read_b128 v[136:139], v22 offset:24832
 v_cvt_pk_f16_f32 v44, v44, v45
 buffer_load_dwordx4 v32, s[12:15], s21 offen offset:1024 lds
 v_accvgpr_write_b32 a126, v44
 v_mfma_f32_16x16x32_bf16 v[48:51], v[140:143], v[92:95], v[48:51]
 v_cvt_pk_f16_f32 v46, v46, v47
 buffer_load_dwordx4 v33, s[12:15], s21 offen offset:2048 lds
 ds_write_b128 v251, v[228:231] offset:38912
 v_mfma_f32_16x16x32_bf16 v[56:59], v[140:143], v[116:119], v[56:59]
 v_accvgpr_write_b32 a127, v46
 s_add_u32 m0, s81, 18432
 s_add_u32 s21, s88, 2457600
 ds_read_b64_tr_b16 v[208:209], v250 offset:36864
 s_waitcnt lgkmcnt(6)
 v_mfma_f32_16x16x32_bf16 v[40:43], v[144:147], v[72:75], v[40:43]
 ds_read_b128 v[140:143], v23 offset:24832
 v_cvt_pk_f16_f32 v52, v52, v53
 buffer_load_dwordx4 v34, s[12:15], s21 offen offset:0 lds
 ds_read_b64_tr_b16 v[210:211], v250 offset:37248
 v_mfma_f32_16x16x32_bf16 v[48:51], v[144:147], v[96:99], v[48:51]
 v_accvgpr_write_b32 a134, v52
 buffer_load_dwordx4 v35, s[12:15], s21 offen offset:1024 lds
 ds_read_b64_tr_b16 v[212:213], v250 offset:36896
 ds_read_b64_tr_b16 v[214:215], v250 offset:37280
 v_mfma_f32_16x16x32_bf16 v[56:59], v[144:147], v[120:123], v[56:59]
 v_cvt_pk_f16_f32 v54, v54, v55
 buffer_load_dwordx4 v36, s[12:15], s21 offen offset:2048 lds
 ds_read_b64_tr_b16 v[216:217], v250 offset:36928
 s_waitcnt lgkmcnt(10)
 v_mfma_f32_16x16x32_bf16 v[40:43], v[148:151], v[76:79], v[40:43]
 ds_read_b128 v[144:147], v22 offset:26112
 v_accvgpr_write_b32 a135, v54
 s_add_u32 m0, s81, 21504
 s_add_u32 s21, s88, 2506752
 ds_read_b64_tr_b16 v[218:219], v250 offset:37312
 v_mfma_f32_16x16x32_bf16 v[48:51], v[148:151], v[100:103], v[48:51]
 v_cvt_pk_f16_f32 v60, v60, v61
 buffer_load_dwordx4 v37, s[12:15], s21 offen offset:0 lds
 s_add_u32 s22, s80, 196608
 v_accvgpr_write_b32 a142, v60
 v_mfma_f32_16x16x32_bf16 v[56:59], v[148:151], v[124:127], v[56:59]
 v_cvt_pk_f16_f32 v62, v62, v63
 buffer_load_dwordx4 v38, s[12:15], s21 offen offset:1024 lds
 v_accvgpr_write_b32 a143, v62
 s_waitcnt lgkmcnt(9)
 v_mfma_f32_16x16x32_bf16 v[40:43], v[136:139], v[80:83], v[40:43]
 ds_read_b128 v[148:151], v23 offset:26112
 buffer_load_dwordx4 v39, s[12:15], s21 offen offset:2048 lds
 buffer_load_dwordx4 v[220:223], v247, s[40:43], s22 offen
 v_mfma_f32_16x16x32_bf16 v[48:51], v[136:139], v[104:107], v[48:51]
 buffer_load_dwordx4 v[224:227], v248, s[40:43], s22 offen
 buffer_load_dwordx4 v[228:231], v249, s[40:43], s22 offen
 v_mfma_f32_16x16x32_bf16 v[56:59], v[136:139], v[128:131], v[56:59]
 s_waitcnt lgkmcnt(7)
 v_mfma_f32_16x16x32_bf16 v[40:43], v[140:143], v[84:87], v[40:43]
 ds_read_b128 v[136:139], v22 offset:26240
 v_mfma_f32_16x16x32_bf16 v[48:51], v[140:143], v[108:111], v[48:51]
 v_mfma_f32_16x16x32_bf16 v[56:59], v[140:143], v[132:135], v[56:59]
 s_waitcnt lgkmcnt(3)
 v_mfma_f32_16x16x32_bf16 v[44:47], v[144:147], v[64:67], 0
 ds_read_b128 v[140:143], v23 offset:26240
 v_mfma_f32_16x16x32_bf16 v[52:55], v[144:147], v[88:91], 0
 s_waitcnt lgkmcnt(3)
 v_lshlrev_b32 v27, 16, v208
 v_and_b32 v208, 0xffff0000, v208
 v_cvt_pk_f16_f32 v208, v27, v208
 v_accvgpr_write_b32 a68, v208
 v_mfma_f32_16x16x32_bf16 v[60:63], v[144:147], v[112:115], 0
 v_lshlrev_b32 v27, 16, v209
 v_and_b32 v209, 0xffff0000, v209
 v_cvt_pk_f16_f32 v209, v27, v209
 v_accvgpr_write_b32 a69, v209
 s_waitcnt lgkmcnt(2)
 v_mfma_f32_16x16x32_bf16 v[44:47], v[148:151], v[68:71], v[44:47]
 ds_read_b128 v[144:147], v22 offset:26368
 v_cvt_pk_f16_f32 v40, v40, v41
 v_lshlrev_b32 v27, 16, v210
 v_and_b32 v210, 0xffff0000, v210
 v_cvt_pk_f16_f32 v210, v27, v210
 v_mfma_f32_16x16x32_bf16 v[52:55], v[148:151], v[92:95], v[52:55]
 v_accvgpr_write_b32 a144, v40
 v_accvgpr_write_b32 a70, v210
 v_lshlrev_b32 v27, 16, v211
 v_and_b32 v211, 0xffff0000, v211
 v_cvt_pk_f16_f32 v211, v27, v211
 v_mfma_f32_16x16x32_bf16 v[60:63], v[148:151], v[116:119], v[60:63]
 v_cvt_pk_f16_f32 v42, v42, v43
 v_accvgpr_write_b32 a71, v211
 v_lshlrev_b32 v27, 16, v212
 v_and_b32 v212, 0xffff0000, v212
 s_waitcnt lgkmcnt(2)
 v_mfma_f32_16x16x32_bf16 v[44:47], v[136:139], v[72:75], v[44:47]
 ds_read_b128 v[148:151], v23 offset:26368
 v_accvgpr_write_b32 a145, v42
 v_cvt_pk_f16_f32 v212, v27, v212
 v_accvgpr_write_b32 a88, v212
 v_lshlrev_b32 v27, 16, v213
 v_mfma_f32_16x16x32_bf16 v[52:55], v[136:139], v[96:99], v[52:55]
 v_cvt_pk_f16_f32 v48, v48, v49
 v_and_b32 v213, 0xffff0000, v213
 v_cvt_pk_f16_f32 v213, v27, v213
 v_accvgpr_write_b32 a89, v213
 v_lshlrev_b32 v27, 16, v214
 v_mfma_f32_16x16x32_bf16 v[60:63], v[136:139], v[120:123], v[60:63]
 v_accvgpr_write_b32 a152, v48
 v_and_b32 v214, 0xffff0000, v214
 v_cvt_pk_f16_f32 v214, v27, v214
 v_accvgpr_write_b32 a90, v214
 s_waitcnt lgkmcnt(2)
 v_mfma_f32_16x16x32_bf16 v[44:47], v[140:143], v[76:79], v[44:47]
 s_waitcnt vmcnt(18)
 ds_read_b128 v[136:139], v22 offset:0
 v_cvt_pk_f16_f32 v50, v50, v51
 v_lshlrev_b32 v27, 16, v215
 v_and_b32 v215, 0xffff0000, v215
 v_cvt_pk_f16_f32 v215, v27, v215
 v_mfma_f32_16x16x32_bf16 v[52:55], v[140:143], v[100:103], v[52:55]
 v_accvgpr_write_b32 a153, v50
 v_accvgpr_write_b32 a91, v215
 v_lshlrev_b32 v27, 16, v216
 v_and_b32 v216, 0xffff0000, v216
 v_cvt_pk_f16_f32 v216, v27, v216
 v_mfma_f32_16x16x32_bf16 v[60:63], v[140:143], v[124:127], v[60:63]
 v_cvt_pk_f16_f32 v56, v56, v57
 v_accvgpr_write_b32 a108, v216
 v_lshlrev_b32 v27, 16, v217
 v_and_b32 v217, 0xffff0000, v217
 s_waitcnt lgkmcnt(2)
 v_mfma_f32_16x16x32_bf16 v[44:47], v[144:147], v[80:83], v[44:47]
 ds_read_b128 v[140:143], v23 offset:0
 v_accvgpr_write_b32 a160, v56
 v_cvt_pk_f16_f32 v217, v27, v217
 v_accvgpr_write_b32 a109, v217
 v_lshlrev_b32 v27, 16, v218
 v_mfma_f32_16x16x32_bf16 v[52:55], v[144:147], v[104:107], v[52:55]
 v_cvt_pk_f16_f32 v58, v58, v59
 v_and_b32 v218, 0xffff0000, v218
 v_cvt_pk_f16_f32 v218, v27, v218
 v_accvgpr_write_b32 a110, v218
 v_lshlrev_b32 v27, 16, v219
 v_mfma_f32_16x16x32_bf16 v[60:63], v[144:147], v[128:131], v[60:63]
 v_accvgpr_write_b32 a161, v58
 v_and_b32 v219, 0xffff0000, v219
 v_cvt_pk_f16_f32 v219, v27, v219
 v_accvgpr_write_b32 a111, v219
 s_waitcnt lgkmcnt(2)
 v_mfma_f32_16x16x32_bf16 v[44:47], v[148:151], v[84:87], v[44:47]
 ds_read_b128 v[144:147], v22 offset:128
 s_add_u32 m0, s81, 24576
 s_add_u32 s21, s88, 2949120
 v_mfma_f32_16x16x32_bf16 v[52:55], v[148:151], v[108:111], v[52:55]
 buffer_load_dwordx4 v28, s[12:15], s21 offen offset:0 lds
 v_mfma_f32_16x16x32_bf16 v[60:63], v[148:151], v[132:135], v[60:63]
 buffer_load_dwordx4 v29, s[12:15], s21 offen offset:1024 lds
 s_waitcnt lgkmcnt(2)
 v_mfma_f32_16x16x32_bf16 v[40:43], v[136:139], v[64:67], 0
 ds_read_b128 v[148:151], v23 offset:128
 buffer_load_dwordx4 v30, s[12:15], s21 offen offset:2048 lds
 s_waitcnt vmcnt(18)
 v_mfma_f32_16x16x32_bf16 v[48:51], v[136:139], v[88:91], 0
 s_add_u32 m0, s81, 27648
 s_add_u32 s21, s88, 2998272
 ds_write_b128 v251, v[232:235] offset:36864
 v_mfma_f32_16x16x32_bf16 v[56:59], v[136:139], v[112:115], 0
 buffer_load_dwordx4 v31, s[12:15], s21 offen offset:0 lds
 ds_write_b128 v251, v[236:239] offset:37888
 s_waitcnt lgkmcnt(4)
 v_mfma_f32_16x16x32_bf16 v[40:43], v[140:143], v[68:71], v[40:43]
 ds_read_b128 v[136:139], v22 offset:256
 v_cvt_pk_f16_f32 v44, v44, v45
 buffer_load_dwordx4 v32, s[12:15], s21 offen offset:1024 lds
 v_accvgpr_write_b32 a146, v44
 v_mfma_f32_16x16x32_bf16 v[48:51], v[140:143], v[92:95], v[48:51]
 v_cvt_pk_f16_f32 v46, v46, v47
 buffer_load_dwordx4 v33, s[12:15], s21 offen offset:2048 lds
 ds_write_b128 v251, v[240:243] offset:38912
 v_mfma_f32_16x16x32_bf16 v[56:59], v[140:143], v[116:119], v[56:59]
 v_accvgpr_write_b32 a147, v46
 s_add_u32 m0, s81, 30720
 s_add_u32 s21, s88, 3440640
 ds_read_b64_tr_b16 v[208:209], v250 offset:36864
 s_waitcnt lgkmcnt(6)
 v_mfma_f32_16x16x32_bf16 v[40:43], v[144:147], v[72:75], v[40:43]
 ds_read_b128 v[140:143], v23 offset:256
 v_cvt_pk_f16_f32 v52, v52, v53
 buffer_load_dwordx4 v34, s[12:15], s21 offen offset:0 lds
 ds_read_b64_tr_b16 v[210:211], v250 offset:37248
 v_mfma_f32_16x16x32_bf16 v[48:51], v[144:147], v[96:99], v[48:51]
 v_accvgpr_write_b32 a154, v52
 buffer_load_dwordx4 v35, s[12:15], s21 offen offset:1024 lds
 ds_read_b64_tr_b16 v[212:213], v250 offset:36896
 ds_read_b64_tr_b16 v[214:215], v250 offset:37280
 v_mfma_f32_16x16x32_bf16 v[56:59], v[144:147], v[120:123], v[56:59]
 v_cvt_pk_f16_f32 v54, v54, v55
 buffer_load_dwordx4 v36, s[12:15], s21 offen offset:2048 lds
 ds_read_b64_tr_b16 v[216:217], v250 offset:36928
 s_waitcnt lgkmcnt(10)
 v_mfma_f32_16x16x32_bf16 v[40:43], v[148:151], v[76:79], v[40:43]
 ds_read_b128 v[144:147], v22 offset:1536
 v_accvgpr_write_b32 a155, v54
 s_add_u32 m0, s81, 33792
 s_add_u32 s21, s88, 3489792
 ds_read_b64_tr_b16 v[218:219], v250 offset:37312
 v_mfma_f32_16x16x32_bf16 v[48:51], v[148:151], v[100:103], v[48:51]
 v_cvt_pk_f16_f32 v60, v60, v61
 buffer_load_dwordx4 v37, s[12:15], s21 offen offset:0 lds
 s_add_u32 s22, s80, 0
 v_accvgpr_write_b32 a162, v60
 v_mfma_f32_16x16x32_bf16 v[56:59], v[148:151], v[124:127], v[56:59]
 v_cvt_pk_f16_f32 v62, v62, v63
 buffer_load_dwordx4 v38, s[12:15], s21 offen offset:1024 lds
 v_accvgpr_write_b32 a163, v62
 s_waitcnt lgkmcnt(9)
 v_mfma_f32_16x16x32_bf16 v[40:43], v[136:139], v[80:83], v[40:43]
 ds_read_b128 v[148:151], v23 offset:1536
 buffer_load_dwordx4 v39, s[12:15], s21 offen offset:2048 lds
 buffer_load_dwordx4 v[232:235], v244, s[36:39], s22 offen
 v_mfma_f32_16x16x32_bf16 v[48:51], v[136:139], v[104:107], v[48:51]
 buffer_load_dwordx4 v[236:239], v245, s[36:39], s22 offen
 buffer_load_dwordx4 v[240:243], v246, s[36:39], s22 offen
 v_mfma_f32_16x16x32_bf16 v[56:59], v[136:139], v[128:131], v[56:59]
 s_waitcnt lgkmcnt(7)
 v_mfma_f32_16x16x32_bf16 v[40:43], v[140:143], v[84:87], v[40:43]
 ds_read_b128 v[136:139], v22 offset:1664
 v_mfma_f32_16x16x32_bf16 v[48:51], v[140:143], v[108:111], v[48:51]
 v_mfma_f32_16x16x32_bf16 v[56:59], v[140:143], v[132:135], v[56:59]
 s_waitcnt lgkmcnt(3)
 v_mfma_f32_16x16x32_bf16 v[44:47], v[144:147], v[64:67], 0
 ds_read_b128 v[140:143], v23 offset:1664
 v_mfma_f32_16x16x32_bf16 v[52:55], v[144:147], v[88:91], 0
 s_waitcnt lgkmcnt(3)
 v_lshlrev_b32 v27, 16, v208
 v_and_b32 v208, 0xffff0000, v208
 v_cvt_pk_f16_f32 v208, v27, v208
 v_accvgpr_write_b32 a72, v208
 v_mfma_f32_16x16x32_bf16 v[60:63], v[144:147], v[112:115], 0
 v_lshlrev_b32 v27, 16, v209
 v_and_b32 v209, 0xffff0000, v209
 v_cvt_pk_f16_f32 v209, v27, v209
 v_accvgpr_write_b32 a73, v209
 s_waitcnt lgkmcnt(2)
 v_mfma_f32_16x16x32_bf16 v[44:47], v[148:151], v[68:71], v[44:47]
 ds_read_b128 v[144:147], v22 offset:1792
 v_cvt_pk_f16_f32 v40, v40, v41
 v_lshlrev_b32 v27, 16, v210
 v_and_b32 v210, 0xffff0000, v210
 v_cvt_pk_f16_f32 v210, v27, v210
 v_mfma_f32_16x16x32_bf16 v[52:55], v[148:151], v[92:95], v[52:55]
 v_accvgpr_write_b32 a148, v40
 v_accvgpr_write_b32 a74, v210
 v_lshlrev_b32 v27, 16, v211
 v_and_b32 v211, 0xffff0000, v211
 v_cvt_pk_f16_f32 v211, v27, v211
 v_mfma_f32_16x16x32_bf16 v[60:63], v[148:151], v[116:119], v[60:63]
 v_cvt_pk_f16_f32 v42, v42, v43
 v_accvgpr_write_b32 a75, v211
 v_lshlrev_b32 v27, 16, v212
 v_and_b32 v212, 0xffff0000, v212
 s_waitcnt lgkmcnt(2)
 v_mfma_f32_16x16x32_bf16 v[44:47], v[136:139], v[72:75], v[44:47]
 ds_read_b128 v[148:151], v23 offset:1792
 v_accvgpr_write_b32 a149, v42
 v_cvt_pk_f16_f32 v212, v27, v212
 v_accvgpr_write_b32 a92, v212
 v_lshlrev_b32 v27, 16, v213
 v_mfma_f32_16x16x32_bf16 v[52:55], v[136:139], v[96:99], v[52:55]
 v_cvt_pk_f16_f32 v48, v48, v49
 v_and_b32 v213, 0xffff0000, v213
 v_cvt_pk_f16_f32 v213, v27, v213
 v_accvgpr_write_b32 a93, v213
 v_lshlrev_b32 v27, 16, v214
 v_mfma_f32_16x16x32_bf16 v[60:63], v[136:139], v[120:123], v[60:63]
 v_accvgpr_write_b32 a156, v48
 v_and_b32 v214, 0xffff0000, v214
 v_cvt_pk_f16_f32 v214, v27, v214
 v_accvgpr_write_b32 a94, v214
 s_waitcnt lgkmcnt(2)
 v_mfma_f32_16x16x32_bf16 v[44:47], v[140:143], v[76:79], v[44:47]
 s_waitcnt vmcnt(18)
 ds_read_b128 v[136:139], v22 offset:12288
 v_cvt_pk_f16_f32 v50, v50, v51
 v_lshlrev_b32 v27, 16, v215
 v_and_b32 v215, 0xffff0000, v215
 v_cvt_pk_f16_f32 v215, v27, v215
 v_mfma_f32_16x16x32_bf16 v[52:55], v[140:143], v[100:103], v[52:55]
 v_accvgpr_write_b32 a157, v50
 v_accvgpr_write_b32 a95, v215
 v_lshlrev_b32 v27, 16, v216
 v_and_b32 v216, 0xffff0000, v216
 v_cvt_pk_f16_f32 v216, v27, v216
 v_mfma_f32_16x16x32_bf16 v[60:63], v[140:143], v[124:127], v[60:63]
 v_cvt_pk_f16_f32 v56, v56, v57
 v_accvgpr_write_b32 a112, v216
 v_lshlrev_b32 v27, 16, v217
 v_and_b32 v217, 0xffff0000, v217
 s_waitcnt lgkmcnt(2)
 v_mfma_f32_16x16x32_bf16 v[44:47], v[144:147], v[80:83], v[44:47]
 ds_read_b128 v[140:143], v23 offset:12288
 v_accvgpr_write_b32 a164, v56
 v_cvt_pk_f16_f32 v217, v27, v217
 v_accvgpr_write_b32 a113, v217
 v_lshlrev_b32 v27, 16, v218
 v_mfma_f32_16x16x32_bf16 v[52:55], v[144:147], v[104:107], v[52:55]
 v_cvt_pk_f16_f32 v58, v58, v59
 v_and_b32 v218, 0xffff0000, v218
 v_cvt_pk_f16_f32 v218, v27, v218
 v_accvgpr_write_b32 a114, v218
 v_lshlrev_b32 v27, 16, v219
 v_mfma_f32_16x16x32_bf16 v[60:63], v[144:147], v[128:131], v[60:63]
 v_accvgpr_write_b32 a165, v58
 v_and_b32 v219, 0xffff0000, v219
 v_cvt_pk_f16_f32 v219, v27, v219
 v_accvgpr_write_b32 a115, v219
 s_waitcnt lgkmcnt(2)
 v_mfma_f32_16x16x32_bf16 v[44:47], v[148:151], v[84:87], v[44:47]
 ds_read_b128 v[144:147], v22 offset:12416
 s_add_u32 m0, s81, 0
 s_add_u32 s21, s88, 2064384
 v_mfma_f32_16x16x32_bf16 v[52:55], v[148:151], v[108:111], v[52:55]
 buffer_load_dwordx4 v28, s[12:15], s21 offen offset:0 lds
 v_mfma_f32_16x16x32_bf16 v[60:63], v[148:151], v[132:135], v[60:63]
 buffer_load_dwordx4 v29, s[12:15], s21 offen offset:1024 lds
 s_waitcnt lgkmcnt(2)
 v_mfma_f32_16x16x32_bf16 v[40:43], v[136:139], v[64:67], 0
 ds_read_b128 v[148:151], v23 offset:12416
 buffer_load_dwordx4 v30, s[12:15], s21 offen offset:2048 lds
 s_waitcnt vmcnt(18)
 v_mfma_f32_16x16x32_bf16 v[48:51], v[136:139], v[88:91], 0
 s_add_u32 m0, s81, 3072
 s_add_u32 s21, s88, 2113536
 ds_write_b128 v251, v[220:223] offset:36864
 v_mfma_f32_16x16x32_bf16 v[56:59], v[136:139], v[112:115], 0
 buffer_load_dwordx4 v31, s[12:15], s21 offen offset:0 lds
 ds_write_b128 v251, v[224:227] offset:37888
 s_waitcnt lgkmcnt(4)
 v_mfma_f32_16x16x32_bf16 v[40:43], v[140:143], v[68:71], v[40:43]
 ds_read_b128 v[136:139], v22 offset:12544
 v_cvt_pk_f16_f32 v44, v44, v45
 buffer_load_dwordx4 v32, s[12:15], s21 offen offset:1024 lds
 v_accvgpr_write_b32 a150, v44
 v_mfma_f32_16x16x32_bf16 v[48:51], v[140:143], v[92:95], v[48:51]
 v_cvt_pk_f16_f32 v46, v46, v47
 buffer_load_dwordx4 v33, s[12:15], s21 offen offset:2048 lds
 ds_write_b128 v251, v[228:231] offset:38912
 v_mfma_f32_16x16x32_bf16 v[56:59], v[140:143], v[116:119], v[56:59]
 v_accvgpr_write_b32 a151, v46
 s_add_u32 m0, s81, 6144
 s_add_u32 s21, s88, 2555904
 ds_read_b64_tr_b16 v[208:209], v250 offset:36864
 s_waitcnt lgkmcnt(6)
 v_mfma_f32_16x16x32_bf16 v[40:43], v[144:147], v[72:75], v[40:43]
 ds_read_b128 v[140:143], v23 offset:12544
 v_cvt_pk_f16_f32 v52, v52, v53
 buffer_load_dwordx4 v34, s[12:15], s21 offen offset:0 lds
 ds_read_b64_tr_b16 v[210:211], v250 offset:37248
 v_mfma_f32_16x16x32_bf16 v[48:51], v[144:147], v[96:99], v[48:51]
 v_accvgpr_write_b32 a158, v52
 buffer_load_dwordx4 v35, s[12:15], s21 offen offset:1024 lds
 ds_read_b64_tr_b16 v[212:213], v250 offset:36896
 ds_read_b64_tr_b16 v[214:215], v250 offset:37280
 v_mfma_f32_16x16x32_bf16 v[56:59], v[144:147], v[120:123], v[56:59]
 v_cvt_pk_f16_f32 v54, v54, v55
 buffer_load_dwordx4 v36, s[12:15], s21 offen offset:2048 lds
 ds_read_b64_tr_b16 v[216:217], v250 offset:36928
 s_waitcnt lgkmcnt(10)
 v_mfma_f32_16x16x32_bf16 v[40:43], v[148:151], v[76:79], v[40:43]
 ds_read_b128 v[144:147], v22 offset:13824
 v_accvgpr_write_b32 a159, v54
 s_add_u32 m0, s81, 9216
 s_add_u32 s21, s88, 2605056
 ds_read_b64_tr_b16 v[218:219], v250 offset:37312
 v_mfma_f32_16x16x32_bf16 v[48:51], v[148:151], v[100:103], v[48:51]
 v_cvt_pk_f16_f32 v60, v60, v61
 buffer_load_dwordx4 v37, s[12:15], s21 offen offset:0 lds
 s_add_u32 s22, s80, 983040
 v_accvgpr_write_b32 a166, v60
 v_mfma_f32_16x16x32_bf16 v[56:59], v[148:151], v[124:127], v[56:59]
 v_cvt_pk_f16_f32 v62, v62, v63
 buffer_load_dwordx4 v38, s[12:15], s21 offen offset:1024 lds
 v_accvgpr_write_b32 a167, v62
 s_waitcnt lgkmcnt(9)
 v_mfma_f32_16x16x32_bf16 v[40:43], v[136:139], v[80:83], v[40:43]
 ds_read_b128 v[148:151], v23 offset:13824
 buffer_load_dwordx4 v39, s[12:15], s21 offen offset:2048 lds
 buffer_load_dwordx4 v[220:223], v244, s[36:39], s22 offen
 v_mfma_f32_16x16x32_bf16 v[48:51], v[136:139], v[104:107], v[48:51]
 buffer_load_dwordx4 v[224:227], v245, s[36:39], s22 offen
 buffer_load_dwordx4 v[228:231], v246, s[36:39], s22 offen
 v_mfma_f32_16x16x32_bf16 v[56:59], v[136:139], v[128:131], v[56:59]
 s_waitcnt lgkmcnt(7)
 v_mfma_f32_16x16x32_bf16 v[40:43], v[140:143], v[84:87], v[40:43]
 ds_read_b128 v[136:139], v22 offset:13952
 v_mfma_f32_16x16x32_bf16 v[48:51], v[140:143], v[108:111], v[48:51]
 v_mfma_f32_16x16x32_bf16 v[56:59], v[140:143], v[132:135], v[56:59]
 s_waitcnt lgkmcnt(3)
 v_mfma_f32_16x16x32_bf16 v[44:47], v[144:147], v[64:67], 0
 ds_read_b128 v[140:143], v23 offset:13952
 v_mfma_f32_16x16x32_bf16 v[52:55], v[144:147], v[88:91], 0
 s_waitcnt lgkmcnt(3)
 v_lshlrev_b32 v27, 16, v208
 v_and_b32 v208, 0xffff0000, v208
 v_cvt_pk_f16_f32 v208, v27, v208
 v_accvgpr_write_b32 a76, v208
 v_mfma_f32_16x16x32_bf16 v[60:63], v[144:147], v[112:115], 0
 v_lshlrev_b32 v27, 16, v209
 v_and_b32 v209, 0xffff0000, v209
 v_cvt_pk_f16_f32 v209, v27, v209
 v_accvgpr_write_b32 a77, v209
 s_waitcnt lgkmcnt(2)
 v_mfma_f32_16x16x32_bf16 v[44:47], v[148:151], v[68:71], v[44:47]
 ds_read_b128 v[144:147], v22 offset:14080
 v_cvt_pk_f16_f32 v40, v40, v41
 v_lshlrev_b32 v27, 16, v210
 v_and_b32 v210, 0xffff0000, v210
 v_cvt_pk_f16_f32 v210, v27, v210
 v_mfma_f32_16x16x32_bf16 v[52:55], v[148:151], v[92:95], v[52:55]
 v_accvgpr_write_b32 a168, v40
 v_accvgpr_write_b32 a78, v210
 v_lshlrev_b32 v27, 16, v211
 v_and_b32 v211, 0xffff0000, v211
 v_cvt_pk_f16_f32 v211, v27, v211
 v_mfma_f32_16x16x32_bf16 v[60:63], v[148:151], v[116:119], v[60:63]
 v_cvt_pk_f16_f32 v42, v42, v43
 v_accvgpr_write_b32 a79, v211
 v_lshlrev_b32 v27, 16, v212
 v_and_b32 v212, 0xffff0000, v212
 s_waitcnt lgkmcnt(2)
 v_mfma_f32_16x16x32_bf16 v[44:47], v[136:139], v[72:75], v[44:47]
 ds_read_b128 v[148:151], v23 offset:14080
 v_accvgpr_write_b32 a169, v42
 v_cvt_pk_f16_f32 v212, v27, v212
 v_accvgpr_write_b32 a96, v212
 v_lshlrev_b32 v27, 16, v213
 v_mfma_f32_16x16x32_bf16 v[52:55], v[136:139], v[96:99], v[52:55]
 v_cvt_pk_f16_f32 v48, v48, v49
 v_and_b32 v213, 0xffff0000, v213
 v_cvt_pk_f16_f32 v213, v27, v213
 v_accvgpr_write_b32 a97, v213
 v_lshlrev_b32 v27, 16, v214
 v_mfma_f32_16x16x32_bf16 v[60:63], v[136:139], v[120:123], v[60:63]
 v_accvgpr_write_b32 a176, v48
 v_and_b32 v214, 0xffff0000, v214
 v_cvt_pk_f16_f32 v214, v27, v214
 v_accvgpr_write_b32 a98, v214
 s_waitcnt lgkmcnt(2)
 v_mfma_f32_16x16x32_bf16 v[44:47], v[140:143], v[76:79], v[44:47]
 s_waitcnt vmcnt(18)
 ds_read_b128 v[136:139], v22 offset:24576
 v_cvt_pk_f16_f32 v50, v50, v51
 v_lshlrev_b32 v27, 16, v215
 v_and_b32 v215, 0xffff0000, v215
 v_cvt_pk_f16_f32 v215, v27, v215
 v_mfma_f32_16x16x32_bf16 v[52:55], v[140:143], v[100:103], v[52:55]
 v_accvgpr_write_b32 a177, v50
 v_accvgpr_write_b32 a99, v215
 v_lshlrev_b32 v27, 16, v216
 v_and_b32 v216, 0xffff0000, v216
 v_cvt_pk_f16_f32 v216, v27, v216
 v_mfma_f32_16x16x32_bf16 v[60:63], v[140:143], v[124:127], v[60:63]
 v_cvt_pk_f16_f32 v56, v56, v57
 v_accvgpr_write_b32 a116, v216
 v_lshlrev_b32 v27, 16, v217
 v_and_b32 v217, 0xffff0000, v217
 s_waitcnt lgkmcnt(2)
 v_mfma_f32_16x16x32_bf16 v[44:47], v[144:147], v[80:83], v[44:47]
 ds_read_b128 v[140:143], v23 offset:24576
 v_accvgpr_write_b32 a184, v56
 v_cvt_pk_f16_f32 v217, v27, v217
 v_accvgpr_write_b32 a117, v217
 v_lshlrev_b32 v27, 16, v218
 v_mfma_f32_16x16x32_bf16 v[52:55], v[144:147], v[104:107], v[52:55]
 v_cvt_pk_f16_f32 v58, v58, v59
 v_and_b32 v218, 0xffff0000, v218
 v_cvt_pk_f16_f32 v218, v27, v218
 v_accvgpr_write_b32 a118, v218
 v_lshlrev_b32 v27, 16, v219
 v_mfma_f32_16x16x32_bf16 v[60:63], v[144:147], v[128:131], v[60:63]
 v_accvgpr_write_b32 a185, v58
 v_and_b32 v219, 0xffff0000, v219
 v_cvt_pk_f16_f32 v219, v27, v219
 v_accvgpr_write_b32 a119, v219
 s_waitcnt lgkmcnt(2)
 v_mfma_f32_16x16x32_bf16 v[44:47], v[148:151], v[84:87], v[44:47]
 ds_read_b128 v[144:147], v22 offset:24704
 s_add_u32 m0, s81, 12288
 s_add_u32 s21, s88, 3047424
 v_mfma_f32_16x16x32_bf16 v[52:55], v[148:151], v[108:111], v[52:55]
 buffer_load_dwordx4 v28, s[12:15], s21 offen offset:0 lds
 v_mfma_f32_16x16x32_bf16 v[60:63], v[148:151], v[132:135], v[60:63]
 buffer_load_dwordx4 v29, s[12:15], s21 offen offset:1024 lds
 s_waitcnt lgkmcnt(2)
 v_mfma_f32_16x16x32_bf16 v[40:43], v[136:139], v[64:67], 0
 ds_read_b128 v[148:151], v23 offset:24704
 buffer_load_dwordx4 v30, s[12:15], s21 offen offset:2048 lds
 s_waitcnt vmcnt(18)
 v_mfma_f32_16x16x32_bf16 v[48:51], v[136:139], v[88:91], 0
 s_add_u32 m0, s81, 15360
 s_add_u32 s21, s88, 3096576
 ds_write_b128 v251, v[232:235] offset:36864
 v_mfma_f32_16x16x32_bf16 v[56:59], v[136:139], v[112:115], 0
 buffer_load_dwordx4 v31, s[12:15], s21 offen offset:0 lds
 ds_write_b128 v251, v[236:239] offset:37888
 s_waitcnt lgkmcnt(4)
 v_mfma_f32_16x16x32_bf16 v[40:43], v[140:143], v[68:71], v[40:43]
 ds_read_b128 v[136:139], v22 offset:24832
 v_cvt_pk_f16_f32 v44, v44, v45
 buffer_load_dwordx4 v32, s[12:15], s21 offen offset:1024 lds
 v_accvgpr_write_b32 a170, v44
 v_mfma_f32_16x16x32_bf16 v[48:51], v[140:143], v[92:95], v[48:51]
 v_cvt_pk_f16_f32 v46, v46, v47
 buffer_load_dwordx4 v33, s[12:15], s21 offen offset:2048 lds
 ds_write_b128 v251, v[240:243] offset:38912
 v_mfma_f32_16x16x32_bf16 v[56:59], v[140:143], v[116:119], v[56:59]
 v_accvgpr_write_b32 a171, v46
 s_add_u32 m0, s81, 18432
 s_add_u32 s21, s88, 3538944
 ds_read_b64_tr_b16 v[208:209], v250 offset:36864
 s_waitcnt lgkmcnt(6)
 v_mfma_f32_16x16x32_bf16 v[40:43], v[144:147], v[72:75], v[40:43]
 ds_read_b128 v[140:143], v23 offset:24832
 v_cvt_pk_f16_f32 v52, v52, v53
 buffer_load_dwordx4 v34, s[12:15], s21 offen offset:0 lds
 ds_read_b64_tr_b16 v[210:211], v250 offset:37248
 v_mfma_f32_16x16x32_bf16 v[48:51], v[144:147], v[96:99], v[48:51]
 v_accvgpr_write_b32 a178, v52
 buffer_load_dwordx4 v35, s[12:15], s21 offen offset:1024 lds
 ds_read_b64_tr_b16 v[212:213], v250 offset:36896
 ds_read_b64_tr_b16 v[214:215], v250 offset:37280
 v_mfma_f32_16x16x32_bf16 v[56:59], v[144:147], v[120:123], v[56:59]
 v_cvt_pk_f16_f32 v54, v54, v55
 buffer_load_dwordx4 v36, s[12:15], s21 offen offset:2048 lds
 ds_read_b64_tr_b16 v[216:217], v250 offset:36928
 s_waitcnt lgkmcnt(10)
 v_mfma_f32_16x16x32_bf16 v[40:43], v[148:151], v[76:79], v[40:43]
 ds_read_b128 v[144:147], v22 offset:26112
 v_accvgpr_write_b32 a179, v54
 s_add_u32 m0, s81, 21504
 s_add_u32 s21, s88, 3588096
 ds_read_b64_tr_b16 v[218:219], v250 offset:37312
 v_mfma_f32_16x16x32_bf16 v[48:51], v[148:151], v[100:103], v[48:51]
 v_cvt_pk_f16_f32 v60, v60, v61
 buffer_load_dwordx4 v37, s[12:15], s21 offen offset:0 lds
 s_add_u32 s22, s80, 98304
 v_accvgpr_write_b32 a186, v60
 v_mfma_f32_16x16x32_bf16 v[56:59], v[148:151], v[124:127], v[56:59]
 v_cvt_pk_f16_f32 v62, v62, v63
 buffer_load_dwordx4 v38, s[12:15], s21 offen offset:1024 lds
 v_accvgpr_write_b32 a187, v62
 s_waitcnt lgkmcnt(9)
 v_mfma_f32_16x16x32_bf16 v[40:43], v[136:139], v[80:83], v[40:43]
 ds_read_b128 v[148:151], v23 offset:26112
 buffer_load_dwordx4 v39, s[12:15], s21 offen offset:2048 lds
 buffer_load_dwordx4 v[232:235], v244, s[36:39], s22 offen
 v_mfma_f32_16x16x32_bf16 v[48:51], v[136:139], v[104:107], v[48:51]
 buffer_load_dwordx4 v[236:239], v245, s[36:39], s22 offen
 buffer_load_dwordx4 v[240:243], v246, s[36:39], s22 offen
 v_mfma_f32_16x16x32_bf16 v[56:59], v[136:139], v[128:131], v[56:59]
 s_waitcnt lgkmcnt(7)
 v_mfma_f32_16x16x32_bf16 v[40:43], v[140:143], v[84:87], v[40:43]
 ds_read_b128 v[136:139], v22 offset:26240
 v_mfma_f32_16x16x32_bf16 v[48:51], v[140:143], v[108:111], v[48:51]
 v_mfma_f32_16x16x32_bf16 v[56:59], v[140:143], v[132:135], v[56:59]
 s_waitcnt lgkmcnt(3)
 v_mfma_f32_16x16x32_bf16 v[44:47], v[144:147], v[64:67], 0
 ds_read_b128 v[140:143], v23 offset:26240
 v_mfma_f32_16x16x32_bf16 v[52:55], v[144:147], v[88:91], 0
 s_waitcnt lgkmcnt(3)
 v_lshlrev_b32 v27, 16, v208
 v_and_b32 v208, 0xffff0000, v208
 v_cvt_pk_f16_f32 v208, v27, v208
 v_accvgpr_write_b32 a0, v208
 v_mfma_f32_16x16x32_bf16 v[60:63], v[144:147], v[112:115], 0
 v_lshlrev_b32 v27, 16, v209
 v_and_b32 v209, 0xffff0000, v209
 v_cvt_pk_f16_f32 v209, v27, v209
 v_accvgpr_write_b32 a1, v209
 s_waitcnt lgkmcnt(2)
 v_mfma_f32_16x16x32_bf16 v[44:47], v[148:151], v[68:71], v[44:47]
 ds_read_b128 v[144:147], v22 offset:26368
 v_cvt_pk_f16_f32 v40, v40, v41
 v_lshlrev_b32 v27, 16, v210
 v_and_b32 v210, 0xffff0000, v210
 v_cvt_pk_f16_f32 v210, v27, v210
 v_mfma_f32_16x16x32_bf16 v[52:55], v[148:151], v[92:95], v[52:55]
 v_accvgpr_write_b32 a172, v40
 v_accvgpr_write_b32 a2, v210
 v_lshlrev_b32 v27, 16, v211
 v_and_b32 v211, 0xffff0000, v211
 v_cvt_pk_f16_f32 v211, v27, v211
 v_mfma_f32_16x16x32_bf16 v[60:63], v[148:151], v[116:119], v[60:63]
 v_cvt_pk_f16_f32 v42, v42, v43
 v_accvgpr_write_b32 a3, v211
 v_lshlrev_b32 v27, 16, v212
 v_and_b32 v212, 0xffff0000, v212
 s_waitcnt lgkmcnt(2)
 v_mfma_f32_16x16x32_bf16 v[44:47], v[136:139], v[72:75], v[44:47]
 ds_read_b128 v[148:151], v23 offset:26368
 v_accvgpr_write_b32 a173, v42
 v_cvt_pk_f16_f32 v212, v27, v212
 v_accvgpr_write_b32 a20, v212
 v_lshlrev_b32 v27, 16, v213
 v_mfma_f32_16x16x32_bf16 v[52:55], v[136:139], v[96:99], v[52:55]
 v_cvt_pk_f16_f32 v48, v48, v49
 v_and_b32 v213, 0xffff0000, v213
 v_cvt_pk_f16_f32 v213, v27, v213
 v_accvgpr_write_b32 a21, v213
 v_lshlrev_b32 v27, 16, v214
 v_mfma_f32_16x16x32_bf16 v[60:63], v[136:139], v[120:123], v[60:63]
 v_accvgpr_write_b32 a180, v48
 v_and_b32 v214, 0xffff0000, v214
 v_cvt_pk_f16_f32 v214, v27, v214
 v_accvgpr_write_b32 a22, v214
 s_waitcnt lgkmcnt(2)
 v_mfma_f32_16x16x32_bf16 v[44:47], v[140:143], v[76:79], v[44:47]
 s_waitcnt vmcnt(18)
 ds_read_b128 v[136:139], v22 offset:0
 v_cvt_pk_f16_f32 v50, v50, v51
 v_lshlrev_b32 v27, 16, v215
 v_and_b32 v215, 0xffff0000, v215
 v_cvt_pk_f16_f32 v215, v27, v215
 v_mfma_f32_16x16x32_bf16 v[52:55], v[140:143], v[100:103], v[52:55]
 v_accvgpr_write_b32 a181, v50
 v_accvgpr_write_b32 a23, v215
 v_lshlrev_b32 v27, 16, v216
 v_and_b32 v216, 0xffff0000, v216
 v_cvt_pk_f16_f32 v216, v27, v216
 v_mfma_f32_16x16x32_bf16 v[60:63], v[140:143], v[124:127], v[60:63]
 v_cvt_pk_f16_f32 v56, v56, v57
 v_accvgpr_write_b32 a40, v216
 v_lshlrev_b32 v27, 16, v217
 v_and_b32 v217, 0xffff0000, v217
 s_waitcnt lgkmcnt(2)
 v_mfma_f32_16x16x32_bf16 v[44:47], v[144:147], v[80:83], v[44:47]
 ds_read_b128 v[140:143], v23 offset:0
 v_accvgpr_write_b32 a188, v56
 v_cvt_pk_f16_f32 v217, v27, v217
 v_accvgpr_write_b32 a41, v217
 v_lshlrev_b32 v27, 16, v218
 v_mfma_f32_16x16x32_bf16 v[52:55], v[144:147], v[104:107], v[52:55]
 v_cvt_pk_f16_f32 v58, v58, v59
 v_and_b32 v218, 0xffff0000, v218
 v_cvt_pk_f16_f32 v218, v27, v218
 v_accvgpr_write_b32 a42, v218
 v_lshlrev_b32 v27, 16, v219
 v_mfma_f32_16x16x32_bf16 v[60:63], v[144:147], v[128:131], v[60:63]
 v_accvgpr_write_b32 a189, v58
 v_and_b32 v219, 0xffff0000, v219
 v_cvt_pk_f16_f32 v219, v27, v219
 v_accvgpr_write_b32 a43, v219
 s_waitcnt lgkmcnt(2)
 v_mfma_f32_16x16x32_bf16 v[44:47], v[148:151], v[84:87], v[44:47]
 ds_read_b128 v[144:147], v22 offset:128
 s_add_u32 m0, s81, 24576
 s_add_u32 s21, s88, 3932160
 v_mfma_f32_16x16x32_bf16 v[52:55], v[148:151], v[108:111], v[52:55]
 buffer_load_dwordx4 v28, s[12:15], s21 offen offset:0 lds
 v_mfma_f32_16x16x32_bf16 v[60:63], v[148:151], v[132:135], v[60:63]
 buffer_load_dwordx4 v29, s[12:15], s21 offen offset:1024 lds
 s_waitcnt lgkmcnt(2)
 v_mfma_f32_16x16x32_bf16 v[40:43], v[136:139], v[64:67], 0
 ds_read_b128 v[148:151], v23 offset:128
 buffer_load_dwordx4 v30, s[12:15], s21 offen offset:2048 lds
 s_waitcnt vmcnt(18)
 v_mfma_f32_16x16x32_bf16 v[48:51], v[136:139], v[88:91], 0
 s_add_u32 m0, s81, 27648
 s_add_u32 s21, s88, 3981312
 ds_write_b128 v251, v[220:223] offset:36864
 v_mfma_f32_16x16x32_bf16 v[56:59], v[136:139], v[112:115], 0
 buffer_load_dwordx4 v31, s[12:15], s21 offen offset:0 lds
 ds_write_b128 v251, v[224:227] offset:37888
 s_waitcnt lgkmcnt(4)
 v_mfma_f32_16x16x32_bf16 v[40:43], v[140:143], v[68:71], v[40:43]
 ds_read_b128 v[136:139], v22 offset:256
 v_cvt_pk_f16_f32 v44, v44, v45
 buffer_load_dwordx4 v32, s[12:15], s21 offen offset:1024 lds
 v_accvgpr_write_b32 a174, v44
 v_mfma_f32_16x16x32_bf16 v[48:51], v[140:143], v[92:95], v[48:51]
 v_cvt_pk_f16_f32 v46, v46, v47
 buffer_load_dwordx4 v33, s[12:15], s21 offen offset:2048 lds
 ds_write_b128 v251, v[228:231] offset:38912
 v_mfma_f32_16x16x32_bf16 v[56:59], v[140:143], v[116:119], v[56:59]
 v_accvgpr_write_b32 a175, v46
 s_add_u32 m0, s81, 30720
 s_add_u32 s21, s88, 4423680
 ds_read_b64_tr_b16 v[208:209], v250 offset:36864
 s_waitcnt lgkmcnt(6)
 v_mfma_f32_16x16x32_bf16 v[40:43], v[144:147], v[72:75], v[40:43]
 ds_read_b128 v[140:143], v23 offset:256
 v_cvt_pk_f16_f32 v52, v52, v53
 buffer_load_dwordx4 v34, s[12:15], s21 offen offset:0 lds
 ds_read_b64_tr_b16 v[210:211], v250 offset:37248
 v_mfma_f32_16x16x32_bf16 v[48:51], v[144:147], v[96:99], v[48:51]
 v_accvgpr_write_b32 a182, v52
 buffer_load_dwordx4 v35, s[12:15], s21 offen offset:1024 lds
 ds_read_b64_tr_b16 v[212:213], v250 offset:36896
 ds_read_b64_tr_b16 v[214:215], v250 offset:37280
 v_mfma_f32_16x16x32_bf16 v[56:59], v[144:147], v[120:123], v[56:59]
 v_cvt_pk_f16_f32 v54, v54, v55
 buffer_load_dwordx4 v36, s[12:15], s21 offen offset:2048 lds
 ds_read_b64_tr_b16 v[216:217], v250 offset:36928
 s_waitcnt lgkmcnt(10)
 v_mfma_f32_16x16x32_bf16 v[40:43], v[148:151], v[76:79], v[40:43]
 ds_read_b128 v[144:147], v22 offset:1536
 v_accvgpr_write_b32 a183, v54
 s_add_u32 m0, s81, 33792
 s_add_u32 s21, s88, 4472832
 ds_read_b64_tr_b16 v[218:219], v250 offset:37312
 v_mfma_f32_16x16x32_bf16 v[48:51], v[148:151], v[100:103], v[48:51]
 v_cvt_pk_f16_f32 v60, v60, v61
 buffer_load_dwordx4 v37, s[12:15], s21 offen offset:0 lds
 s_add_u32 s22, s80, 1081344
 v_accvgpr_write_b32 a190, v60
 v_mfma_f32_16x16x32_bf16 v[56:59], v[148:151], v[124:127], v[56:59]
 v_cvt_pk_f16_f32 v62, v62, v63
 buffer_load_dwordx4 v38, s[12:15], s21 offen offset:1024 lds
 v_accvgpr_write_b32 a191, v62
 s_waitcnt lgkmcnt(9)
 v_mfma_f32_16x16x32_bf16 v[40:43], v[136:139], v[80:83], v[40:43]
 ds_read_b128 v[148:151], v23 offset:1536
 buffer_load_dwordx4 v39, s[12:15], s21 offen offset:2048 lds
 buffer_load_dwordx4 v[220:223], v244, s[36:39], s22 offen
 v_mfma_f32_16x16x32_bf16 v[48:51], v[136:139], v[104:107], v[48:51]
 buffer_load_dwordx4 v[224:227], v245, s[36:39], s22 offen
 buffer_load_dwordx4 v[228:231], v246, s[36:39], s22 offen
 v_mfma_f32_16x16x32_bf16 v[56:59], v[136:139], v[128:131], v[56:59]
 s_waitcnt lgkmcnt(7)
 v_mfma_f32_16x16x32_bf16 v[40:43], v[140:143], v[84:87], v[40:43]
 ds_read_b128 v[136:139], v22 offset:1664
 v_mfma_f32_16x16x32_bf16 v[48:51], v[140:143], v[108:111], v[48:51]
 v_mfma_f32_16x16x32_bf16 v[56:59], v[140:143], v[132:135], v[56:59]
 s_waitcnt lgkmcnt(3)
 v_mfma_f32_16x16x32_bf16 v[44:47], v[144:147], v[64:67], 0
 ds_read_b128 v[140:143], v23 offset:1664
 v_mfma_f32_16x16x32_bf16 v[52:55], v[144:147], v[88:91], 0
 s_waitcnt lgkmcnt(3)
 v_lshlrev_b32 v27, 16, v208
 v_and_b32 v208, 0xffff0000, v208
 v_cvt_pk_f16_f32 v208, v27, v208
 v_accvgpr_write_b32 a4, v208
 v_mfma_f32_16x16x32_bf16 v[60:63], v[144:147], v[112:115], 0
 v_lshlrev_b32 v27, 16, v209
 v_and_b32 v209, 0xffff0000, v209
 v_cvt_pk_f16_f32 v209, v27, v209
 v_accvgpr_write_b32 a5, v209
 s_waitcnt lgkmcnt(2)
 v_mfma_f32_16x16x32_bf16 v[44:47], v[148:151], v[68:71], v[44:47]
 ds_read_b128 v[144:147], v22 offset:1792
 v_cvt_pk_f16_f32 v40, v40, v41
 v_lshlrev_b32 v27, 16, v210
 v_and_b32 v210, 0xffff0000, v210
 v_cvt_pk_f16_f32 v210, v27, v210
 v_mfma_f32_16x16x32_bf16 v[52:55], v[148:151], v[92:95], v[52:55]
 v_accvgpr_write_b32 a192, v40
 v_accvgpr_write_b32 a6, v210
 v_lshlrev_b32 v27, 16, v211
 v_and_b32 v211, 0xffff0000, v211
 v_cvt_pk_f16_f32 v211, v27, v211
 v_mfma_f32_16x16x32_bf16 v[60:63], v[148:151], v[116:119], v[60:63]
 v_cvt_pk_f16_f32 v42, v42, v43
 v_accvgpr_write_b32 a7, v211
 v_lshlrev_b32 v27, 16, v212
 v_and_b32 v212, 0xffff0000, v212
 s_waitcnt lgkmcnt(2)
 v_mfma_f32_16x16x32_bf16 v[44:47], v[136:139], v[72:75], v[44:47]
 ds_read_b128 v[148:151], v23 offset:1792
 v_accvgpr_write_b32 a193, v42
 v_cvt_pk_f16_f32 v212, v27, v212
 v_accvgpr_write_b32 a24, v212
 v_lshlrev_b32 v27, 16, v213
 v_mfma_f32_16x16x32_bf16 v[52:55], v[136:139], v[96:99], v[52:55]
 v_cvt_pk_f16_f32 v48, v48, v49
 v_and_b32 v213, 0xffff0000, v213
 v_cvt_pk_f16_f32 v213, v27, v213
 v_accvgpr_write_b32 a25, v213
 v_lshlrev_b32 v27, 16, v214
 v_mfma_f32_16x16x32_bf16 v[60:63], v[136:139], v[120:123], v[60:63]
 v_accvgpr_write_b32 a200, v48
 v_and_b32 v214, 0xffff0000, v214
 v_cvt_pk_f16_f32 v214, v27, v214
 v_accvgpr_write_b32 a26, v214
 s_waitcnt lgkmcnt(2)
 v_mfma_f32_16x16x32_bf16 v[44:47], v[140:143], v[76:79], v[44:47]
 s_waitcnt vmcnt(18)
 ds_read_b128 v[136:139], v22 offset:12288
 v_cvt_pk_f16_f32 v50, v50, v51
 v_lshlrev_b32 v27, 16, v215
 v_and_b32 v215, 0xffff0000, v215
 v_cvt_pk_f16_f32 v215, v27, v215
 v_mfma_f32_16x16x32_bf16 v[52:55], v[140:143], v[100:103], v[52:55]
 v_accvgpr_write_b32 a201, v50
 v_accvgpr_write_b32 a27, v215
 v_lshlrev_b32 v27, 16, v216
 v_and_b32 v216, 0xffff0000, v216
 v_cvt_pk_f16_f32 v216, v27, v216
 v_mfma_f32_16x16x32_bf16 v[60:63], v[140:143], v[124:127], v[60:63]
 v_cvt_pk_f16_f32 v56, v56, v57
 v_accvgpr_write_b32 a44, v216
 v_lshlrev_b32 v27, 16, v217
 v_and_b32 v217, 0xffff0000, v217
 s_waitcnt lgkmcnt(2)
 v_mfma_f32_16x16x32_bf16 v[44:47], v[144:147], v[80:83], v[44:47]
 ds_read_b128 v[140:143], v23 offset:12288
 v_accvgpr_write_b32 a208, v56
 v_cvt_pk_f16_f32 v217, v27, v217
 v_accvgpr_write_b32 a45, v217
 v_lshlrev_b32 v27, 16, v218
 v_mfma_f32_16x16x32_bf16 v[52:55], v[144:147], v[104:107], v[52:55]
 v_cvt_pk_f16_f32 v58, v58, v59
 v_and_b32 v218, 0xffff0000, v218
 v_cvt_pk_f16_f32 v218, v27, v218
 v_accvgpr_write_b32 a46, v218
 v_lshlrev_b32 v27, 16, v219
 v_mfma_f32_16x16x32_bf16 v[60:63], v[144:147], v[128:131], v[60:63]
 v_accvgpr_write_b32 a209, v58
 v_and_b32 v219, 0xffff0000, v219
 v_cvt_pk_f16_f32 v219, v27, v219
 v_accvgpr_write_b32 a47, v219
 s_waitcnt lgkmcnt(2)
 v_mfma_f32_16x16x32_bf16 v[44:47], v[148:151], v[84:87], v[44:47]
 ds_read_b128 v[144:147], v22 offset:12416
 s_add_u32 m0, s81, 0
 s_add_u32 s21, s88, 4915200
 v_mfma_f32_16x16x32_bf16 v[52:55], v[148:151], v[108:111], v[52:55]
 buffer_load_dwordx4 v28, s[12:15], s21 offen offset:0 lds
 v_mfma_f32_16x16x32_bf16 v[60:63], v[148:151], v[132:135], v[60:63]
 buffer_load_dwordx4 v29, s[12:15], s21 offen offset:1024 lds
 s_waitcnt lgkmcnt(2)
 v_mfma_f32_16x16x32_bf16 v[40:43], v[136:139], v[64:67], 0
 ds_read_b128 v[148:151], v23 offset:12416
 buffer_load_dwordx4 v30, s[12:15], s21 offen offset:2048 lds
 s_waitcnt vmcnt(18)
 v_mfma_f32_16x16x32_bf16 v[48:51], v[136:139], v[88:91], 0
 s_add_u32 m0, s81, 3072
 s_add_u32 s21, s88, 4964352
 ds_write_b128 v251, v[232:235] offset:36864
 v_mfma_f32_16x16x32_bf16 v[56:59], v[136:139], v[112:115], 0
 buffer_load_dwordx4 v31, s[12:15], s21 offen offset:0 lds
 ds_write_b128 v251, v[236:239] offset:37888
 s_waitcnt lgkmcnt(4)
 v_mfma_f32_16x16x32_bf16 v[40:43], v[140:143], v[68:71], v[40:43]
 ds_read_b128 v[136:139], v22 offset:12544
 v_cvt_pk_f16_f32 v44, v44, v45
 buffer_load_dwordx4 v32, s[12:15], s21 offen offset:1024 lds
 v_accvgpr_write_b32 a194, v44
 v_mfma_f32_16x16x32_bf16 v[48:51], v[140:143], v[92:95], v[48:51]
 v_cvt_pk_f16_f32 v46, v46, v47
 buffer_load_dwordx4 v33, s[12:15], s21 offen offset:2048 lds
 ds_write_b128 v251, v[240:243] offset:38912
 v_mfma_f32_16x16x32_bf16 v[56:59], v[140:143], v[116:119], v[56:59]
 v_accvgpr_write_b32 a195, v46
 s_add_u32 m0, s81, 6144
 s_add_u32 s21, s88, 5406720
 ds_read_b64_tr_b16 v[208:209], v250 offset:36864
 s_waitcnt lgkmcnt(6)
 v_mfma_f32_16x16x32_bf16 v[40:43], v[144:147], v[72:75], v[40:43]
 ds_read_b128 v[140:143], v23 offset:12544
 v_cvt_pk_f16_f32 v52, v52, v53
 buffer_load_dwordx4 v34, s[12:15], s21 offen offset:0 lds
 ds_read_b64_tr_b16 v[210:211], v250 offset:37248
 v_mfma_f32_16x16x32_bf16 v[48:51], v[144:147], v[96:99], v[48:51]
 v_accvgpr_write_b32 a202, v52
 buffer_load_dwordx4 v35, s[12:15], s21 offen offset:1024 lds
 ds_read_b64_tr_b16 v[212:213], v250 offset:36896
 ds_read_b64_tr_b16 v[214:215], v250 offset:37280
 v_mfma_f32_16x16x32_bf16 v[56:59], v[144:147], v[120:123], v[56:59]
 v_cvt_pk_f16_f32 v54, v54, v55
 buffer_load_dwordx4 v36, s[12:15], s21 offen offset:2048 lds
 ds_read_b64_tr_b16 v[216:217], v250 offset:36928
 s_waitcnt lgkmcnt(10)
 v_mfma_f32_16x16x32_bf16 v[40:43], v[148:151], v[76:79], v[40:43]
 ds_read_b128 v[144:147], v22 offset:13824
 v_accvgpr_write_b32 a203, v54
 s_add_u32 m0, s81, 9216
 s_add_u32 s21, s88, 5455872
 ds_read_b64_tr_b16 v[218:219], v250 offset:37312
 v_mfma_f32_16x16x32_bf16 v[48:51], v[148:151], v[100:103], v[48:51]
 v_cvt_pk_f16_f32 v60, v60, v61
 buffer_load_dwordx4 v37, s[12:15], s21 offen offset:0 lds
 s_add_u32 s22, s80, 196608
 v_accvgpr_write_b32 a210, v60
 v_mfma_f32_16x16x32_bf16 v[56:59], v[148:151], v[124:127], v[56:59]
 v_cvt_pk_f16_f32 v62, v62, v63
 buffer_load_dwordx4 v38, s[12:15], s21 offen offset:1024 lds
 v_accvgpr_write_b32 a211, v62
 s_waitcnt lgkmcnt(9)
 v_mfma_f32_16x16x32_bf16 v[40:43], v[136:139], v[80:83], v[40:43]
 ds_read_b128 v[148:151], v23 offset:13824
 buffer_load_dwordx4 v39, s[12:15], s21 offen offset:2048 lds
 buffer_load_dwordx4 v[232:235], v247, s[36:39], s22 offen
 v_mfma_f32_16x16x32_bf16 v[48:51], v[136:139], v[104:107], v[48:51]
 buffer_load_dwordx4 v[236:239], v248, s[36:39], s22 offen
 buffer_load_dwordx4 v[240:243], v249, s[36:39], s22 offen
 v_mfma_f32_16x16x32_bf16 v[56:59], v[136:139], v[128:131], v[56:59]
 s_waitcnt lgkmcnt(7)
 v_mfma_f32_16x16x32_bf16 v[40:43], v[140:143], v[84:87], v[40:43]
 ds_read_b128 v[136:139], v22 offset:13952
 v_mfma_f32_16x16x32_bf16 v[48:51], v[140:143], v[108:111], v[48:51]
 v_mfma_f32_16x16x32_bf16 v[56:59], v[140:143], v[132:135], v[56:59]
 s_waitcnt lgkmcnt(3)
 v_mfma_f32_16x16x32_bf16 v[44:47], v[144:147], v[64:67], 0
 ds_read_b128 v[140:143], v23 offset:13952
 v_mfma_f32_16x16x32_bf16 v[52:55], v[144:147], v[88:91], 0
 s_waitcnt lgkmcnt(3)
 v_lshlrev_b32 v27, 16, v208
 v_and_b32 v208, 0xffff0000, v208
 v_cvt_pk_f16_f32 v208, v27, v208
 v_accvgpr_write_b32 a8, v208
 v_mfma_f32_16x16x32_bf16 v[60:63], v[144:147], v[112:115], 0
 v_lshlrev_b32 v27, 16, v209
 v_and_b32 v209, 0xffff0000, v209
 v_cvt_pk_f16_f32 v209, v27, v209
 v_accvgpr_write_b32 a9, v209
 s_waitcnt lgkmcnt(2)
 v_mfma_f32_16x16x32_bf16 v[44:47], v[148:151], v[68:71], v[44:47]
 ds_read_b128 v[144:147], v22 offset:14080
 v_cvt_pk_f16_f32 v40, v40, v41
 v_lshlrev_b32 v27, 16, v210
 v_and_b32 v210, 0xffff0000, v210
 v_cvt_pk_f16_f32 v210, v27, v210
 v_mfma_f32_16x16x32_bf16 v[52:55], v[148:151], v[92:95], v[52:55]
 v_accvgpr_write_b32 a196, v40
 v_accvgpr_write_b32 a10, v210
 v_lshlrev_b32 v27, 16, v211
 v_and_b32 v211, 0xffff0000, v211
 v_cvt_pk_f16_f32 v211, v27, v211
 v_mfma_f32_16x16x32_bf16 v[60:63], v[148:151], v[116:119], v[60:63]
 v_cvt_pk_f16_f32 v42, v42, v43
 v_accvgpr_write_b32 a11, v211
 v_lshlrev_b32 v27, 16, v212
 v_and_b32 v212, 0xffff0000, v212
 s_waitcnt lgkmcnt(2)
 v_mfma_f32_16x16x32_bf16 v[44:47], v[136:139], v[72:75], v[44:47]
 ds_read_b128 v[148:151], v23 offset:14080
 v_accvgpr_write_b32 a197, v42
 v_cvt_pk_f16_f32 v212, v27, v212
 v_accvgpr_write_b32 a28, v212
 v_lshlrev_b32 v27, 16, v213
 v_mfma_f32_16x16x32_bf16 v[52:55], v[136:139], v[96:99], v[52:55]
 v_cvt_pk_f16_f32 v48, v48, v49
 v_and_b32 v213, 0xffff0000, v213
 v_cvt_pk_f16_f32 v213, v27, v213
 v_accvgpr_write_b32 a29, v213
 v_lshlrev_b32 v27, 16, v214
 v_mfma_f32_16x16x32_bf16 v[60:63], v[136:139], v[120:123], v[60:63]
 v_accvgpr_write_b32 a204, v48
 v_and_b32 v214, 0xffff0000, v214
 v_cvt_pk_f16_f32 v214, v27, v214
 v_accvgpr_write_b32 a30, v214
 s_waitcnt lgkmcnt(2)
 v_mfma_f32_16x16x32_bf16 v[44:47], v[140:143], v[76:79], v[44:47]
 s_waitcnt vmcnt(18)
 ds_read_b128 v[136:139], v22 offset:24576
 v_cvt_pk_f16_f32 v50, v50, v51
 v_lshlrev_b32 v27, 16, v215
 v_and_b32 v215, 0xffff0000, v215
 v_cvt_pk_f16_f32 v215, v27, v215
 v_mfma_f32_16x16x32_bf16 v[52:55], v[140:143], v[100:103], v[52:55]
 v_accvgpr_write_b32 a205, v50
 v_accvgpr_write_b32 a31, v215
 v_lshlrev_b32 v27, 16, v216
 v_and_b32 v216, 0xffff0000, v216
 v_cvt_pk_f16_f32 v216, v27, v216
 v_mfma_f32_16x16x32_bf16 v[60:63], v[140:143], v[124:127], v[60:63]
 v_cvt_pk_f16_f32 v56, v56, v57
 v_accvgpr_write_b32 a48, v216
 v_lshlrev_b32 v27, 16, v217
 v_and_b32 v217, 0xffff0000, v217
 s_waitcnt lgkmcnt(2)
 v_mfma_f32_16x16x32_bf16 v[44:47], v[144:147], v[80:83], v[44:47]
 ds_read_b128 v[140:143], v23 offset:24576
 v_accvgpr_write_b32 a212, v56
 v_cvt_pk_f16_f32 v217, v27, v217
 v_accvgpr_write_b32 a49, v217
 v_lshlrev_b32 v27, 16, v218
 v_mfma_f32_16x16x32_bf16 v[52:55], v[144:147], v[104:107], v[52:55]
 v_cvt_pk_f16_f32 v58, v58, v59
 v_and_b32 v218, 0xffff0000, v218
 v_cvt_pk_f16_f32 v218, v27, v218
 v_accvgpr_write_b32 a50, v218
 v_lshlrev_b32 v27, 16, v219
 v_mfma_f32_16x16x32_bf16 v[60:63], v[144:147], v[128:131], v[60:63]
 v_accvgpr_write_b32 a213, v58
 v_and_b32 v219, 0xffff0000, v219
 v_cvt_pk_f16_f32 v219, v27, v219
 v_accvgpr_write_b32 a51, v219
 s_waitcnt lgkmcnt(2)
 v_mfma_f32_16x16x32_bf16 v[44:47], v[148:151], v[84:87], v[44:47]
 ds_read_b128 v[144:147], v22 offset:24704
 s_add_u32 m0, s81, 12288
 s_add_u32 s21, s88, 4030464
 v_mfma_f32_16x16x32_bf16 v[52:55], v[148:151], v[108:111], v[52:55]
 buffer_load_dwordx4 v28, s[12:15], s21 offen offset:0 lds
 v_mfma_f32_16x16x32_bf16 v[60:63], v[148:151], v[132:135], v[60:63]
 buffer_load_dwordx4 v29, s[12:15], s21 offen offset:1024 lds
 s_waitcnt lgkmcnt(2)
 v_mfma_f32_16x16x32_bf16 v[40:43], v[136:139], v[64:67], 0
 ds_read_b128 v[148:151], v23 offset:24704
 buffer_load_dwordx4 v30, s[12:15], s21 offen offset:2048 lds
 s_waitcnt vmcnt(18)
 v_mfma_f32_16x16x32_bf16 v[48:51], v[136:139], v[88:91], 0
 s_add_u32 m0, s81, 15360
 s_add_u32 s21, s88, 4079616
 ds_write_b128 v251, v[220:223] offset:36864
 v_mfma_f32_16x16x32_bf16 v[56:59], v[136:139], v[112:115], 0
 buffer_load_dwordx4 v31, s[12:15], s21 offen offset:0 lds
 ds_write_b128 v251, v[224:227] offset:37888
 s_waitcnt lgkmcnt(4)
 v_mfma_f32_16x16x32_bf16 v[40:43], v[140:143], v[68:71], v[40:43]
 ds_read_b128 v[136:139], v22 offset:24832
 v_cvt_pk_f16_f32 v44, v44, v45
 buffer_load_dwordx4 v32, s[12:15], s21 offen offset:1024 lds
 v_accvgpr_write_b32 a198, v44
 v_mfma_f32_16x16x32_bf16 v[48:51], v[140:143], v[92:95], v[48:51]
 v_cvt_pk_f16_f32 v46, v46, v47
 buffer_load_dwordx4 v33, s[12:15], s21 offen offset:2048 lds
 ds_write_b128 v251, v[228:231] offset:38912
 v_mfma_f32_16x16x32_bf16 v[56:59], v[140:143], v[116:119], v[56:59]
 v_accvgpr_write_b32 a199, v46
 s_add_u32 m0, s81, 18432
 s_add_u32 s21, s88, 4521984
 ds_read_b64_tr_b16 v[208:209], v250 offset:36864
 s_waitcnt lgkmcnt(6)
 v_mfma_f32_16x16x32_bf16 v[40:43], v[144:147], v[72:75], v[40:43]
 ds_read_b128 v[140:143], v23 offset:24832
 v_cvt_pk_f16_f32 v52, v52, v53
 buffer_load_dwordx4 v34, s[12:15], s21 offen offset:0 lds
 ds_read_b64_tr_b16 v[210:211], v250 offset:37248
 v_mfma_f32_16x16x32_bf16 v[48:51], v[144:147], v[96:99], v[48:51]
 v_accvgpr_write_b32 a206, v52
 buffer_load_dwordx4 v35, s[12:15], s21 offen offset:1024 lds
 ds_read_b64_tr_b16 v[212:213], v250 offset:36896
 ds_read_b64_tr_b16 v[214:215], v250 offset:37280
 v_mfma_f32_16x16x32_bf16 v[56:59], v[144:147], v[120:123], v[56:59]
 v_cvt_pk_f16_f32 v54, v54, v55
 buffer_load_dwordx4 v36, s[12:15], s21 offen offset:2048 lds
 ds_read_b64_tr_b16 v[216:217], v250 offset:36928
 s_waitcnt lgkmcnt(10)
 v_mfma_f32_16x16x32_bf16 v[40:43], v[148:151], v[76:79], v[40:43]
 ds_read_b128 v[144:147], v22 offset:26112
 v_accvgpr_write_b32 a207, v54
 s_add_u32 m0, s81, 21504
 s_add_u32 s21, s88, 4571136
 ds_read_b64_tr_b16 v[218:219], v250 offset:37312
 v_mfma_f32_16x16x32_bf16 v[48:51], v[148:151], v[100:103], v[48:51]
 v_cvt_pk_f16_f32 v60, v60, v61
 buffer_load_dwordx4 v37, s[12:15], s21 offen offset:0 lds
 v_accvgpr_write_b32 a214, v60
 v_mfma_f32_16x16x32_bf16 v[56:59], v[148:151], v[124:127], v[56:59]
 v_cvt_pk_f16_f32 v62, v62, v63
 buffer_load_dwordx4 v38, s[12:15], s21 offen offset:1024 lds
 v_accvgpr_write_b32 a215, v62
 s_waitcnt lgkmcnt(9)
 v_mfma_f32_16x16x32_bf16 v[40:43], v[136:139], v[80:83], v[40:43]
 ds_read_b128 v[148:151], v23 offset:26112
 buffer_load_dwordx4 v39, s[12:15], s21 offen offset:2048 lds
 v_mfma_f32_16x16x32_bf16 v[48:51], v[136:139], v[104:107], v[48:51]
 v_mfma_f32_16x16x32_bf16 v[56:59], v[136:139], v[128:131], v[56:59]
 s_waitcnt lgkmcnt(7)
 v_mfma_f32_16x16x32_bf16 v[40:43], v[140:143], v[84:87], v[40:43]
 ds_read_b128 v[136:139], v22 offset:26240
 v_mfma_f32_16x16x32_bf16 v[48:51], v[140:143], v[108:111], v[48:51]
 s_waitcnt lgkmcnt(2)
 v_lshlrev_b32 v27, 16, v208
 v_and_b32 v208, 0xffff0000, v208
 v_cvt_pk_f16_f32 v208, v27, v208
 v_accvgpr_write_b32 a12, v208
 v_mfma_f32_16x16x32_bf16 v[56:59], v[140:143], v[132:135], v[56:59]
 v_lshlrev_b32 v27, 16, v209
 v_and_b32 v209, 0xffff0000, v209
 v_cvt_pk_f16_f32 v209, v27, v209
 v_accvgpr_write_b32 a13, v209
 s_waitcnt lgkmcnt(3)
 v_mfma_f32_16x16x32_bf16 v[44:47], v[144:147], v[64:67], 0
 ds_read_b128 v[140:143], v23 offset:26240
 v_lshlrev_b32 v27, 16, v210
 v_and_b32 v210, 0xffff0000, v210
 v_cvt_pk_f16_f32 v210, v27, v210
 v_accvgpr_write_b32 a14, v210
 v_mfma_f32_16x16x32_bf16 v[52:55], v[144:147], v[88:91], 0
 v_lshlrev_b32 v27, 16, v211
 v_and_b32 v211, 0xffff0000, v211
 v_cvt_pk_f16_f32 v211, v27, v211
 v_accvgpr_write_b32 a15, v211
 v_lshlrev_b32 v27, 16, v212
 v_mfma_f32_16x16x32_bf16 v[60:63], v[144:147], v[112:115], 0
 v_and_b32 v212, 0xffff0000, v212
 v_cvt_pk_f16_f32 v212, v27, v212
 v_accvgpr_write_b32 a32, v212
 v_lshlrev_b32 v27, 16, v213
 s_waitcnt lgkmcnt(2)
 v_mfma_f32_16x16x32_bf16 v[44:47], v[148:151], v[68:71], v[44:47]
 ds_read_b128 v[144:147], v22 offset:26368
 v_cvt_pk_f16_f32 v40, v40, v41
 v_and_b32 v213, 0xffff0000, v213
 v_cvt_pk_f16_f32 v213, v27, v213
 v_accvgpr_write_b32 a33, v213
 v_mfma_f32_16x16x32_bf16 v[52:55], v[148:151], v[92:95], v[52:55]
 v_accvgpr_write_b32 a216, v40
 v_lshlrev_b32 v27, 16, v214
 v_and_b32 v214, 0xffff0000, v214
 v_cvt_pk_f16_f32 v214, v27, v214
 v_accvgpr_write_b32 a34, v214
 v_mfma_f32_16x16x32_bf16 v[60:63], v[148:151], v[116:119], v[60:63]
 v_cvt_pk_f16_f32 v42, v42, v43
 v_lshlrev_b32 v27, 16, v215
 v_and_b32 v215, 0xffff0000, v215
 v_cvt_pk_f16_f32 v215, v27, v215
 s_waitcnt lgkmcnt(2)
 v_mfma_f32_16x16x32_bf16 v[44:47], v[136:139], v[72:75], v[44:47]
 ds_read_b128 v[148:151], v23 offset:26368
 v_accvgpr_write_b32 a217, v42
 v_accvgpr_write_b32 a35, v215
 v_lshlrev_b32 v27, 16, v216
 v_and_b32 v216, 0xffff0000, v216
 v_mfma_f32_16x16x32_bf16 v[52:55], v[136:139], v[96:99], v[52:55]
 v_cvt_pk_f16_f32 v48, v48, v49
 v_cvt_pk_f16_f32 v216, v27, v216
 v_accvgpr_write_b32 a52, v216
 v_lshlrev_b32 v27, 16, v217
 v_and_b32 v217, 0xffff0000, v217
 v_mfma_f32_16x16x32_bf16 v[60:63], v[136:139], v[120:123], v[60:63]
 v_accvgpr_write_b32 a224, v48
 v_cvt_pk_f16_f32 v217, v27, v217
 v_accvgpr_write_b32 a53, v217
 v_lshlrev_b32 v27, 16, v218
 s_waitcnt lgkmcnt(2)
 v_mfma_f32_16x16x32_bf16 v[44:47], v[140:143], v[76:79], v[44:47]
 s_waitcnt vmcnt(15)
 ds_read_b128 v[136:139], v22 offset:0
 v_cvt_pk_f16_f32 v50, v50, v51
 v_and_b32 v218, 0xffff0000, v218
 v_cvt_pk_f16_f32 v218, v27, v218
 v_accvgpr_write_b32 a54, v218
 v_mfma_f32_16x16x32_bf16 v[52:55], v[140:143], v[100:103], v[52:55]
 v_accvgpr_write_b32 a225, v50
 v_lshlrev_b32 v27, 16, v219
 v_and_b32 v219, 0xffff0000, v219
 v_cvt_pk_f16_f32 v219, v27, v219
 v_accvgpr_write_b32 a55, v219
 v_mfma_f32_16x16x32_bf16 v[60:63], v[140:143], v[124:127], v[60:63]
 v_cvt_pk_f16_f32 v56, v56, v57
 v_accvgpr_write_b32 a232, v56
 v_cvt_pk_f16_f32 v58, v58, v59
 v_accvgpr_write_b32 a233, v58
 s_waitcnt lgkmcnt(2)
 v_mfma_f32_16x16x32_bf16 v[44:47], v[144:147], v[80:83], v[44:47]
 ds_read_b128 v[140:143], v23 offset:0
 v_mfma_f32_16x16x32_bf16 v[52:55], v[144:147], v[104:107], v[52:55]
 v_mfma_f32_16x16x32_bf16 v[60:63], v[144:147], v[128:131], v[60:63]
 s_waitcnt lgkmcnt(2)
 v_mfma_f32_16x16x32_bf16 v[44:47], v[148:151], v[84:87], v[44:47]
 ds_read_b128 v[144:147], v22 offset:128
 s_add_u32 m0, s81, 24576
 s_add_u32 s21, s88, 5013504
 v_mfma_f32_16x16x32_bf16 v[52:55], v[148:151], v[108:111], v[52:55]
 buffer_load_dwordx4 v28, s[12:15], s21 offen offset:0 lds
 v_mfma_f32_16x16x32_bf16 v[60:63], v[148:151], v[132:135], v[60:63]
 buffer_load_dwordx4 v29, s[12:15], s21 offen offset:1024 lds
 s_waitcnt lgkmcnt(2)
 v_mfma_f32_16x16x32_bf16 v[40:43], v[136:139], v[64:67], 0
 ds_read_b128 v[148:151], v23 offset:128
 buffer_load_dwordx4 v30, s[12:15], s21 offen offset:2048 lds
 s_waitcnt vmcnt(15)
 v_mfma_f32_16x16x32_bf16 v[48:51], v[136:139], v[88:91], 0
 s_add_u32 m0, s81, 27648
 s_add_u32 s21, s88, 5062656
 ds_write_b128 v251, v[232:235] offset:36864
 v_mfma_f32_16x16x32_bf16 v[56:59], v[136:139], v[112:115], 0
 buffer_load_dwordx4 v31, s[12:15], s21 offen offset:0 lds
 ds_write_b128 v251, v[236:239] offset:37888
 s_waitcnt lgkmcnt(4)
 v_mfma_f32_16x16x32_bf16 v[40:43], v[140:143], v[68:71], v[40:43]
 ds_read_b128 v[136:139], v22 offset:256
 v_cvt_pk_f16_f32 v44, v44, v45
 buffer_load_dwordx4 v32, s[12:15], s21 offen offset:1024 lds
 v_accvgpr_write_b32 a218, v44
 v_mfma_f32_16x16x32_bf16 v[48:51], v[140:143], v[92:95], v[48:51]
 v_cvt_pk_f16_f32 v46, v46, v47
 buffer_load_dwordx4 v33, s[12:15], s21 offen offset:2048 lds
 ds_write_b128 v251, v[240:243] offset:38912
 v_mfma_f32_16x16x32_bf16 v[56:59], v[140:143], v[116:119], v[56:59]
 v_accvgpr_write_b32 a219, v46
 s_add_u32 m0, s81, 30720
 s_add_u32 s21, s88, 5505024
 ds_read_b64_tr_b16 v[208:209], v250 offset:36864
 s_waitcnt lgkmcnt(6)
 v_mfma_f32_16x16x32_bf16 v[40:43], v[144:147], v[72:75], v[40:43]
 ds_read_b128 v[140:143], v23 offset:256
 v_cvt_pk_f16_f32 v52, v52, v53
 buffer_load_dwordx4 v34, s[12:15], s21 offen offset:0 lds
 ds_read_b64_tr_b16 v[210:211], v250 offset:37248
 v_mfma_f32_16x16x32_bf16 v[48:51], v[144:147], v[96:99], v[48:51]
 v_accvgpr_write_b32 a226, v52
 buffer_load_dwordx4 v35, s[12:15], s21 offen offset:1024 lds
 ds_read_b64_tr_b16 v[212:213], v250 offset:36896
 ds_read_b64_tr_b16 v[214:215], v250 offset:37280
 v_mfma_f32_16x16x32_bf16 v[56:59], v[144:147], v[120:123], v[56:59]
 v_cvt_pk_f16_f32 v54, v54, v55
 buffer_load_dwordx4 v36, s[12:15], s21 offen offset:2048 lds
 ds_read_b64_tr_b16 v[216:217], v250 offset:36928
 s_waitcnt lgkmcnt(10)
 v_mfma_f32_16x16x32_bf16 v[40:43], v[148:151], v[76:79], v[40:43]
 ds_read_b128 v[144:147], v22 offset:1536
 v_accvgpr_write_b32 a227, v54
 s_add_u32 m0, s81, 33792
 s_add_u32 s21, s88, 5554176
 ds_read_b64_tr_b16 v[218:219], v250 offset:37312
 v_mfma_f32_16x16x32_bf16 v[48:51], v[148:151], v[100:103], v[48:51]
 v_cvt_pk_f16_f32 v60, v60, v61
 buffer_load_dwordx4 v37, s[12:15], s21 offen offset:0 lds
 v_accvgpr_write_b32 a234, v60
 v_mfma_f32_16x16x32_bf16 v[56:59], v[148:151], v[124:127], v[56:59]
 v_cvt_pk_f16_f32 v62, v62, v63
 buffer_load_dwordx4 v38, s[12:15], s21 offen offset:1024 lds
 v_accvgpr_write_b32 a235, v62
 s_waitcnt lgkmcnt(9)
 v_mfma_f32_16x16x32_bf16 v[40:43], v[136:139], v[80:83], v[40:43]
 ds_read_b128 v[148:151], v23 offset:1536
 buffer_load_dwordx4 v39, s[12:15], s21 offen offset:2048 lds
 v_mfma_f32_16x16x32_bf16 v[48:51], v[136:139], v[104:107], v[48:51]
 v_mfma_f32_16x16x32_bf16 v[56:59], v[136:139], v[128:131], v[56:59]
 s_waitcnt lgkmcnt(7)
 v_mfma_f32_16x16x32_bf16 v[40:43], v[140:143], v[84:87], v[40:43]
 ds_read_b128 v[136:139], v22 offset:1664
 v_mfma_f32_16x16x32_bf16 v[48:51], v[140:143], v[108:111], v[48:51]
 s_waitcnt lgkmcnt(2)
 v_lshlrev_b32 v27, 16, v208
 v_and_b32 v208, 0xffff0000, v208
 v_cvt_pk_f16_f32 v208, v27, v208
 v_accvgpr_write_b32 a16, v208
 v_mfma_f32_16x16x32_bf16 v[56:59], v[140:143], v[132:135], v[56:59]
 v_lshlrev_b32 v27, 16, v209
 v_and_b32 v209, 0xffff0000, v209
 v_cvt_pk_f16_f32 v209, v27, v209
 v_accvgpr_write_b32 a17, v209
 s_waitcnt lgkmcnt(3)
 v_mfma_f32_16x16x32_bf16 v[44:47], v[144:147], v[64:67], 0
 ds_read_b128 v[140:143], v23 offset:1664
 v_lshlrev_b32 v27, 16, v210
 v_and_b32 v210, 0xffff0000, v210
 v_cvt_pk_f16_f32 v210, v27, v210
 v_accvgpr_write_b32 a18, v210
 v_mfma_f32_16x16x32_bf16 v[52:55], v[144:147], v[88:91], 0
 v_lshlrev_b32 v27, 16, v211
 v_and_b32 v211, 0xffff0000, v211
 v_cvt_pk_f16_f32 v211, v27, v211
 v_accvgpr_write_b32 a19, v211
 v_lshlrev_b32 v27, 16, v212
 v_mfma_f32_16x16x32_bf16 v[60:63], v[144:147], v[112:115], 0
 v_and_b32 v212, 0xffff0000, v212
 v_cvt_pk_f16_f32 v212, v27, v212
 v_accvgpr_write_b32 a36, v212
 v_lshlrev_b32 v27, 16, v213
 s_waitcnt lgkmcnt(2)
 v_mfma_f32_16x16x32_bf16 v[44:47], v[148:151], v[68:71], v[44:47]
 ds_read_b128 v[144:147], v22 offset:1792
 v_cvt_pk_f16_f32 v40, v40, v41
 v_and_b32 v213, 0xffff0000, v213
 v_cvt_pk_f16_f32 v213, v27, v213
 v_accvgpr_write_b32 a37, v213
 v_mfma_f32_16x16x32_bf16 v[52:55], v[148:151], v[92:95], v[52:55]
 v_accvgpr_write_b32 a220, v40
 v_lshlrev_b32 v27, 16, v214
 v_and_b32 v214, 0xffff0000, v214
 v_cvt_pk_f16_f32 v214, v27, v214
 v_accvgpr_write_b32 a38, v214
 v_mfma_f32_16x16x32_bf16 v[60:63], v[148:151], v[116:119], v[60:63]
 v_cvt_pk_f16_f32 v42, v42, v43
 v_lshlrev_b32 v27, 16, v215
 v_and_b32 v215, 0xffff0000, v215
 v_cvt_pk_f16_f32 v215, v27, v215
 s_waitcnt lgkmcnt(2)
 v_mfma_f32_16x16x32_bf16 v[44:47], v[136:139], v[72:75], v[44:47]
 ds_read_b128 v[148:151], v23 offset:1792
 v_accvgpr_write_b32 a221, v42
 v_accvgpr_write_b32 a39, v215
 v_lshlrev_b32 v27, 16, v216
 v_and_b32 v216, 0xffff0000, v216
 v_mfma_f32_16x16x32_bf16 v[52:55], v[136:139], v[96:99], v[52:55]
 v_cvt_pk_f16_f32 v48, v48, v49
 v_cvt_pk_f16_f32 v216, v27, v216
 v_accvgpr_write_b32 a56, v216
 v_lshlrev_b32 v27, 16, v217
 v_and_b32 v217, 0xffff0000, v217
 v_mfma_f32_16x16x32_bf16 v[60:63], v[136:139], v[120:123], v[60:63]
 v_accvgpr_write_b32 a228, v48
 v_cvt_pk_f16_f32 v217, v27, v217
 v_accvgpr_write_b32 a57, v217
 v_lshlrev_b32 v27, 16, v218
 s_waitcnt lgkmcnt(2)
 v_mfma_f32_16x16x32_bf16 v[44:47], v[140:143], v[76:79], v[44:47]
 s_waitcnt vmcnt(12)
 ds_read_b128 v[136:139], v22 offset:12288
 v_cvt_pk_f16_f32 v50, v50, v51
 v_and_b32 v218, 0xffff0000, v218
 v_cvt_pk_f16_f32 v218, v27, v218
 v_accvgpr_write_b32 a58, v218
 v_mfma_f32_16x16x32_bf16 v[52:55], v[140:143], v[100:103], v[52:55]
 v_accvgpr_write_b32 a229, v50
 v_lshlrev_b32 v27, 16, v219
 v_and_b32 v219, 0xffff0000, v219
 v_cvt_pk_f16_f32 v219, v27, v219
 v_accvgpr_write_b32 a59, v219
 v_mfma_f32_16x16x32_bf16 v[60:63], v[140:143], v[124:127], v[60:63]
 v_cvt_pk_f16_f32 v56, v56, v57
 v_accvgpr_write_b32 a236, v56
 v_cvt_pk_f16_f32 v58, v58, v59
 v_accvgpr_write_b32 a237, v58
 s_waitcnt lgkmcnt(2)
 v_mfma_f32_16x16x32_bf16 v[44:47], v[144:147], v[80:83], v[44:47]
 ds_read_b128 v[140:143], v23 offset:12288
 v_mfma_f32_16x16x32_bf16 v[52:55], v[144:147], v[104:107], v[52:55]
 v_mfma_f32_16x16x32_bf16 v[60:63], v[144:147], v[128:131], v[60:63]
 s_waitcnt lgkmcnt(2)
 v_mfma_f32_16x16x32_bf16 v[44:47], v[148:151], v[84:87], v[44:47]
 ds_read_b128 v[144:147], v22 offset:12416
 s_add_u32 m0, s81, 0
 s_add_u32 s21, s88, 5898240
 v_mfma_f32_16x16x32_bf16 v[52:55], v[148:151], v[108:111], v[52:55]
 buffer_load_dwordx4 v28, s[12:15], s21 offen offset:0 lds
 v_mfma_f32_16x16x32_bf16 v[60:63], v[148:151], v[132:135], v[60:63]
 buffer_load_dwordx4 v29, s[12:15], s21 offen offset:1024 lds
 s_waitcnt lgkmcnt(2)
 v_mfma_f32_16x16x32_bf16 v[40:43], v[136:139], v[64:67], 0
 ds_read_b128 v[148:151], v23 offset:12416
 buffer_load_dwordx4 v30, s[12:15], s21 offen offset:2048 lds
 v_mfma_f32_16x16x32_bf16 v[48:51], v[136:139], v[88:91], 0
 s_add_u32 m0, s81, 3072
 s_add_u32 s21, s88, 5947392
 v_mfma_f32_16x16x32_bf16 v[56:59], v[136:139], v[112:115], 0
 buffer_load_dwordx4 v31, s[12:15], s21 offen offset:0 lds
 s_waitcnt lgkmcnt(2)
 v_mfma_f32_16x16x32_bf16 v[40:43], v[140:143], v[68:71], v[40:43]
 ds_read_b128 v[136:139], v22 offset:12544
 v_cvt_pk_f16_f32 v44, v44, v45
 buffer_load_dwordx4 v32, s[12:15], s21 offen offset:1024 lds
 v_accvgpr_write_b32 a222, v44
 v_mfma_f32_16x16x32_bf16 v[48:51], v[140:143], v[92:95], v[48:51]
 v_cvt_pk_f16_f32 v46, v46, v47
 buffer_load_dwordx4 v33, s[12:15], s21 offen offset:2048 lds
 v_accvgpr_write_b32 a223, v46
 v_cvt_pk_f16_f32 v52, v52, v53
 v_mfma_f32_16x16x32_bf16 v[56:59], v[140:143], v[116:119], v[56:59]
 v_accvgpr_write_b32 a230, v52
 s_add_u32 m0, s81, 6144
 s_add_u32 s21, s88, 6389760
 v_cvt_pk_f16_f32 v54, v54, v55
 s_waitcnt lgkmcnt(2)
 v_mfma_f32_16x16x32_bf16 v[40:43], v[144:147], v[72:75], v[40:43]
 ds_read_b128 v[140:143], v23 offset:12544
 v_accvgpr_write_b32 a231, v54
 buffer_load_dwordx4 v34, s[12:15], s21 offen offset:0 lds
 v_cvt_pk_f16_f32 v60, v60, v61
 v_mfma_f32_16x16x32_bf16 v[48:51], v[144:147], v[96:99], v[48:51]
 v_accvgpr_write_b32 a238, v60
 buffer_load_dwordx4 v35, s[12:15], s21 offen offset:1024 lds
 v_cvt_pk_f16_f32 v62, v62, v63
 v_accvgpr_write_b32 a239, v62
 v_mfma_f32_16x16x32_bf16 v[56:59], v[144:147], v[120:123], v[56:59]
 buffer_load_dwordx4 v36, s[12:15], s21 offen offset:2048 lds
 s_waitcnt lgkmcnt(2)
 v_mfma_f32_16x16x32_bf16 v[40:43], v[148:151], v[76:79], v[40:43]
 ds_read_b128 v[144:147], v22 offset:13824
 s_add_u32 m0, s81, 9216
 s_add_u32 s21, s88, 6438912
 v_mfma_f32_16x16x32_bf16 v[48:51], v[148:151], v[100:103], v[48:51]
 buffer_load_dwordx4 v37, s[12:15], s21 offen offset:0 lds
 v_mfma_f32_16x16x32_bf16 v[56:59], v[148:151], v[124:127], v[56:59]
 buffer_load_dwordx4 v38, s[12:15], s21 offen offset:1024 lds
 s_waitcnt lgkmcnt(2)
 v_mfma_f32_16x16x32_bf16 v[40:43], v[136:139], v[80:83], v[40:43]
 ds_read_b128 v[148:151], v23 offset:13824
 buffer_load_dwordx4 v39, s[12:15], s21 offen offset:2048 lds
 v_mfma_f32_16x16x32_bf16 v[48:51], v[136:139], v[104:107], v[48:51]
 v_mfma_f32_16x16x32_bf16 v[56:59], v[136:139], v[128:131], v[56:59]
 s_waitcnt lgkmcnt(2)
 v_mfma_f32_16x16x32_bf16 v[40:43], v[140:143], v[84:87], v[40:43]
 ds_read_b128 v[136:139], v22 offset:13952
 v_mfma_f32_16x16x32_bf16 v[48:51], v[140:143], v[108:111], v[48:51]
 v_mfma_f32_16x16x32_bf16 v[56:59], v[140:143], v[132:135], v[56:59]
 s_waitcnt lgkmcnt(2)
 v_mfma_f32_16x16x32_bf16 v[44:47], v[144:147], v[64:67], 0
 ds_read_b128 v[140:143], v23 offset:13952
 v_mfma_f32_16x16x32_bf16 v[52:55], v[144:147], v[88:91], 0
 v_mfma_f32_16x16x32_bf16 v[60:63], v[144:147], v[112:115], 0
 s_waitcnt lgkmcnt(2)
 v_mfma_f32_16x16x32_bf16 v[44:47], v[148:151], v[68:71], v[44:47]
 ds_read_b128 v[144:147], v22 offset:14080
 v_cvt_pk_f16_f32 v40, v40, v41
 v_accvgpr_write_b32 a240, v40
 v_cvt_pk_f16_f32 v42, v42, v43
 v_accvgpr_write_b32 a241, v42
 v_mfma_f32_16x16x32_bf16 v[52:55], v[148:151], v[92:95], v[52:55]
 v_cvt_pk_f16_f32 v48, v48, v49
 v_accvgpr_write_b32 a248, v48
 v_cvt_pk_f16_f32 v50, v50, v51
 v_accvgpr_write_b32 a249, v50
 v_cvt_pk_f16_f32 v152, v56, v57
 v_mfma_f32_16x16x32_bf16 v[60:63], v[148:151], v[116:119], v[60:63]
 v_cvt_pk_f16_f32 v153, v58, v59
 s_waitcnt lgkmcnt(2)
 v_mfma_f32_16x16x32_bf16 v[44:47], v[136:139], v[72:75], v[44:47]
 ds_read_b128 v[148:151], v23 offset:14080
 v_mfma_f32_16x16x32_bf16 v[52:55], v[136:139], v[96:99], v[52:55]
 v_mfma_f32_16x16x32_bf16 v[60:63], v[136:139], v[120:123], v[60:63]
 s_waitcnt lgkmcnt(2)
 v_mfma_f32_16x16x32_bf16 v[44:47], v[140:143], v[76:79], v[44:47]
 s_waitcnt vmcnt(12)
 ds_read_b128 v[136:139], v22 offset:24576
 v_mfma_f32_16x16x32_bf16 v[52:55], v[140:143], v[100:103], v[52:55]
 v_mfma_f32_16x16x32_bf16 v[60:63], v[140:143], v[124:127], v[60:63]
 s_waitcnt lgkmcnt(2)
 v_mfma_f32_16x16x32_bf16 v[44:47], v[144:147], v[80:83], v[44:47]
 ds_read_b128 v[140:143], v23 offset:24576
 v_mfma_f32_16x16x32_bf16 v[52:55], v[144:147], v[104:107], v[52:55]
 v_mfma_f32_16x16x32_bf16 v[60:63], v[144:147], v[128:131], v[60:63]
 s_waitcnt lgkmcnt(2)
 v_mfma_f32_16x16x32_bf16 v[44:47], v[148:151], v[84:87], v[44:47]
 ds_read_b128 v[144:147], v22 offset:24704
 s_add_u32 m0, s81, 12288
 s_add_u32 s21, s88, 6881280
 v_mfma_f32_16x16x32_bf16 v[52:55], v[148:151], v[108:111], v[52:55]
 buffer_load_dwordx4 v28, s[12:15], s21 offen offset:0 lds
 v_mfma_f32_16x16x32_bf16 v[60:63], v[148:151], v[132:135], v[60:63]
 buffer_load_dwordx4 v29, s[12:15], s21 offen offset:1024 lds
 s_waitcnt lgkmcnt(2)
 v_mfma_f32_16x16x32_bf16 v[40:43], v[136:139], v[64:67], 0
 ds_read_b128 v[148:151], v23 offset:24704
 buffer_load_dwordx4 v30, s[12:15], s21 offen offset:2048 lds
 v_mfma_f32_16x16x32_bf16 v[48:51], v[136:139], v[88:91], 0
 s_add_u32 m0, s81, 15360
 s_add_u32 s21, s88, 6930432
 v_mfma_f32_16x16x32_bf16 v[56:59], v[136:139], v[112:115], 0
 buffer_load_dwordx4 v31, s[12:15], s21 offen offset:0 lds
 s_waitcnt lgkmcnt(2)
 v_mfma_f32_16x16x32_bf16 v[40:43], v[140:143], v[68:71], v[40:43]
 ds_read_b128 v[136:139], v22 offset:24832
 v_cvt_pk_f16_f32 v44, v44, v45
 buffer_load_dwordx4 v32, s[12:15], s21 offen offset:1024 lds
 v_accvgpr_write_b32 a242, v44
 v_mfma_f32_16x16x32_bf16 v[48:51], v[140:143], v[92:95], v[48:51]
 v_cvt_pk_f16_f32 v46, v46, v47
 buffer_load_dwordx4 v33, s[12:15], s21 offen offset:2048 lds
 v_accvgpr_write_b32 a243, v46
 v_cvt_pk_f16_f32 v52, v52, v53
 v_mfma_f32_16x16x32_bf16 v[56:59], v[140:143], v[116:119], v[56:59]
 v_accvgpr_write_b32 a250, v52
 s_add_u32 m0, s81, 18432
 s_add_u32 s21, s88, 7372800
 v_cvt_pk_f16_f32 v54, v54, v55
 s_waitcnt lgkmcnt(2)
 v_mfma_f32_16x16x32_bf16 v[40:43], v[144:147], v[72:75], v[40:43]
 ds_read_b128 v[140:143], v23 offset:24832
 v_accvgpr_write_b32 a251, v54
 buffer_load_dwordx4 v34, s[12:15], s21 offen offset:0 lds
 v_cvt_pk_f16_f32 v154, v60, v61
 v_mfma_f32_16x16x32_bf16 v[48:51], v[144:147], v[96:99], v[48:51]
 v_cvt_pk_f16_f32 v155, v62, v63
 buffer_load_dwordx4 v35, s[12:15], s21 offen offset:1024 lds
 v_mfma_f32_16x16x32_bf16 v[56:59], v[144:147], v[120:123], v[56:59]
 buffer_load_dwordx4 v36, s[12:15], s21 offen offset:2048 lds
 s_waitcnt lgkmcnt(2)
 v_mfma_f32_16x16x32_bf16 v[40:43], v[148:151], v[76:79], v[40:43]
 ds_read_b128 v[144:147], v22 offset:26112
 s_add_u32 m0, s81, 21504
 s_add_u32 s21, s88, 7421952
 v_mfma_f32_16x16x32_bf16 v[48:51], v[148:151], v[100:103], v[48:51]
 buffer_load_dwordx4 v37, s[12:15], s21 offen offset:0 lds
 v_mfma_f32_16x16x32_bf16 v[56:59], v[148:151], v[124:127], v[56:59]
 buffer_load_dwordx4 v38, s[12:15], s21 offen offset:1024 lds
 s_waitcnt lgkmcnt(2)
 v_mfma_f32_16x16x32_bf16 v[40:43], v[136:139], v[80:83], v[40:43]
 ds_read_b128 v[148:151], v23 offset:26112
 buffer_load_dwordx4 v39, s[12:15], s21 offen offset:2048 lds
 v_mfma_f32_16x16x32_bf16 v[48:51], v[136:139], v[104:107], v[48:51]
 v_mfma_f32_16x16x32_bf16 v[56:59], v[136:139], v[128:131], v[56:59]
 s_waitcnt lgkmcnt(2)
 v_mfma_f32_16x16x32_bf16 v[40:43], v[140:143], v[84:87], v[40:43]
 ds_read_b128 v[136:139], v22 offset:26240
 v_mfma_f32_16x16x32_bf16 v[48:51], v[140:143], v[108:111], v[48:51]
 v_mfma_f32_16x16x32_bf16 v[56:59], v[140:143], v[132:135], v[56:59]
 s_waitcnt lgkmcnt(2)
 v_mfma_f32_16x16x32_bf16 v[44:47], v[144:147], v[64:67], 0
 ds_read_b128 v[140:143], v23 offset:26240
 v_mfma_f32_16x16x32_bf16 v[52:55], v[144:147], v[88:91], 0
 v_mfma_f32_16x16x32_bf16 v[60:63], v[144:147], v[112:115], 0
 s_waitcnt lgkmcnt(2)
 v_mfma_f32_16x16x32_bf16 v[44:47], v[148:151], v[68:71], v[44:47]
 ds_read_b128 v[144:147], v22 offset:26368
 v_cvt_pk_f16_f32 v40, v40, v41
 v_accvgpr_write_b32 a244, v40
 v_cvt_pk_f16_f32 v42, v42, v43
 v_accvgpr_write_b32 a245, v42
 v_mfma_f32_16x16x32_bf16 v[52:55], v[148:151], v[92:95], v[52:55]
 v_cvt_pk_f16_f32 v48, v48, v49
 v_accvgpr_write_b32 a252, v48
 v_cvt_pk_f16_f32 v50, v50, v51
 v_accvgpr_write_b32 a253, v50
 v_cvt_pk_f16_f32 v156, v56, v57
 v_mfma_f32_16x16x32_bf16 v[60:63], v[148:151], v[116:119], v[60:63]
 v_cvt_pk_f16_f32 v157, v58, v59
 s_waitcnt lgkmcnt(2)
 v_mfma_f32_16x16x32_bf16 v[44:47], v[136:139], v[72:75], v[44:47]
 ds_read_b128 v[148:151], v23 offset:26368
 v_mfma_f32_16x16x32_bf16 v[52:55], v[136:139], v[96:99], v[52:55]
 v_mfma_f32_16x16x32_bf16 v[60:63], v[136:139], v[120:123], v[60:63]
 s_waitcnt lgkmcnt(2)
 v_mfma_f32_16x16x32_bf16 v[44:47], v[140:143], v[76:79], v[44:47]
 s_waitcnt vmcnt(12)
 ds_read_b128 v[136:139], v22 offset:0
 v_mfma_f32_16x16x32_bf16 v[52:55], v[140:143], v[100:103], v[52:55]
 v_mfma_f32_16x16x32_bf16 v[60:63], v[140:143], v[124:127], v[60:63]
 s_waitcnt lgkmcnt(2)
 v_mfma_f32_16x16x32_bf16 v[44:47], v[144:147], v[80:83], v[44:47]
 ds_read_b128 v[140:143], v23 offset:0
 v_mfma_f32_16x16x32_bf16 v[52:55], v[144:147], v[104:107], v[52:55]
 v_mfma_f32_16x16x32_bf16 v[60:63], v[144:147], v[128:131], v[60:63]
 s_waitcnt lgkmcnt(2)
 v_mfma_f32_16x16x32_bf16 v[44:47], v[148:151], v[84:87], v[44:47]
 ds_read_b128 v[144:147], v22 offset:128
 s_add_u32 m0, s81, 24576
 s_add_u32 s21, s88, 5996544
 v_mfma_f32_16x16x32_bf16 v[52:55], v[148:151], v[108:111], v[52:55]
 buffer_load_dwordx4 v28, s[12:15], s21 offen offset:0 lds
 v_mfma_f32_16x16x32_bf16 v[60:63], v[148:151], v[132:135], v[60:63]
 buffer_load_dwordx4 v29, s[12:15], s21 offen offset:1024 lds
 s_waitcnt lgkmcnt(2)
 v_mfma_f32_16x16x32_bf16 v[40:43], v[136:139], v[64:67], 0
 ds_read_b128 v[148:151], v23 offset:128
 buffer_load_dwordx4 v30, s[12:15], s21 offen offset:2048 lds
 v_mfma_f32_16x16x32_bf16 v[48:51], v[136:139], v[88:91], 0
 s_add_u32 m0, s81, 27648
 s_add_u32 s21, s88, 6045696
 v_mfma_f32_16x16x32_bf16 v[56:59], v[136:139], v[112:115], 0
 buffer_load_dwordx4 v31, s[12:15], s21 offen offset:0 lds
 s_waitcnt lgkmcnt(2)
 v_mfma_f32_16x16x32_bf16 v[40:43], v[140:143], v[68:71], v[40:43]
 ds_read_b128 v[136:139], v22 offset:256
 v_cvt_pk_f16_f32 v44, v44, v45
 buffer_load_dwordx4 v32, s[12:15], s21 offen offset:1024 lds
 v_accvgpr_write_b32 a246, v44
 v_mfma_f32_16x16x32_bf16 v[48:51], v[140:143], v[92:95], v[48:51]
 v_cvt_pk_f16_f32 v46, v46, v47
 buffer_load_dwordx4 v33, s[12:15], s21 offen offset:2048 lds
 v_accvgpr_write_b32 a247, v46
 v_cvt_pk_f16_f32 v52, v52, v53
 v_mfma_f32_16x16x32_bf16 v[56:59], v[140:143], v[116:119], v[56:59]
 v_accvgpr_write_b32 a254, v52
 s_add_u32 m0, s81, 30720
 s_add_u32 s21, s88, 6488064
 v_cvt_pk_f16_f32 v54, v54, v55
 s_waitcnt lgkmcnt(2)
 v_mfma_f32_16x16x32_bf16 v[40:43], v[144:147], v[72:75], v[40:43]
 ds_read_b128 v[140:143], v23 offset:256
 v_accvgpr_write_b32 a255, v54
 buffer_load_dwordx4 v34, s[12:15], s21 offen offset:0 lds
 v_cvt_pk_f16_f32 v158, v60, v61
 v_mfma_f32_16x16x32_bf16 v[48:51], v[144:147], v[96:99], v[48:51]
 v_cvt_pk_f16_f32 v159, v62, v63
 buffer_load_dwordx4 v35, s[12:15], s21 offen offset:1024 lds
 v_mfma_f32_16x16x32_bf16 v[56:59], v[144:147], v[120:123], v[56:59]
 buffer_load_dwordx4 v36, s[12:15], s21 offen offset:2048 lds
 s_waitcnt lgkmcnt(2)
 v_mfma_f32_16x16x32_bf16 v[40:43], v[148:151], v[76:79], v[40:43]
 ds_read_b128 v[144:147], v22 offset:1536
 s_add_u32 m0, s81, 33792
 s_add_u32 s21, s88, 6537216
 v_mfma_f32_16x16x32_bf16 v[48:51], v[148:151], v[100:103], v[48:51]
 buffer_load_dwordx4 v37, s[12:15], s21 offen offset:0 lds
 v_mfma_f32_16x16x32_bf16 v[56:59], v[148:151], v[124:127], v[56:59]
 buffer_load_dwordx4 v38, s[12:15], s21 offen offset:1024 lds
 s_waitcnt lgkmcnt(2)
 v_mfma_f32_16x16x32_bf16 v[40:43], v[136:139], v[80:83], v[40:43]
 ds_read_b128 v[148:151], v23 offset:1536
 buffer_load_dwordx4 v39, s[12:15], s21 offen offset:2048 lds
 v_mfma_f32_16x16x32_bf16 v[48:51], v[136:139], v[104:107], v[48:51]
 v_mfma_f32_16x16x32_bf16 v[56:59], v[136:139], v[128:131], v[56:59]
 s_waitcnt lgkmcnt(2)
 v_mfma_f32_16x16x32_bf16 v[40:43], v[140:143], v[84:87], v[40:43]
 ds_read_b128 v[136:139], v22 offset:1664
 v_mfma_f32_16x16x32_bf16 v[48:51], v[140:143], v[108:111], v[48:51]
 v_mfma_f32_16x16x32_bf16 v[56:59], v[140:143], v[132:135], v[56:59]
 s_waitcnt lgkmcnt(2)
 v_mfma_f32_16x16x32_bf16 v[44:47], v[144:147], v[64:67], 0
 ds_read_b128 v[140:143], v23 offset:1664
 v_mfma_f32_16x16x32_bf16 v[52:55], v[144:147], v[88:91], 0
 v_mfma_f32_16x16x32_bf16 v[60:63], v[144:147], v[112:115], 0
 s_waitcnt lgkmcnt(2)
 v_mfma_f32_16x16x32_bf16 v[44:47], v[148:151], v[68:71], v[44:47]
 ds_read_b128 v[144:147], v22 offset:1792
 v_cvt_pk_f16_f32 v160, v40, v41
 v_cvt_pk_f16_f32 v161, v42, v43
 v_cvt_pk_f16_f32 v168, v48, v49
 v_cvt_pk_f16_f32 v169, v50, v51
 v_mfma_f32_16x16x32_bf16 v[52:55], v[148:151], v[92:95], v[52:55]
 v_cvt_pk_f16_f32 v176, v56, v57
 v_cvt_pk_f16_f32 v177, v58, v59
 v_mfma_f32_16x16x32_bf16 v[60:63], v[148:151], v[116:119], v[60:63]
 s_waitcnt lgkmcnt(2)
 v_mfma_f32_16x16x32_bf16 v[44:47], v[136:139], v[72:75], v[44:47]
 ds_read_b128 v[148:151], v23 offset:1792
 v_mfma_f32_16x16x32_bf16 v[52:55], v[136:139], v[96:99], v[52:55]
 v_mfma_f32_16x16x32_bf16 v[60:63], v[136:139], v[120:123], v[60:63]
 s_waitcnt lgkmcnt(2)
 v_mfma_f32_16x16x32_bf16 v[44:47], v[140:143], v[76:79], v[44:47]
 s_waitcnt vmcnt(12)
 ds_read_b128 v[136:139], v22 offset:12288
 v_mfma_f32_16x16x32_bf16 v[52:55], v[140:143], v[100:103], v[52:55]
 v_mfma_f32_16x16x32_bf16 v[60:63], v[140:143], v[124:127], v[60:63]
 s_waitcnt lgkmcnt(2)
 v_mfma_f32_16x16x32_bf16 v[44:47], v[144:147], v[80:83], v[44:47]
 ds_read_b128 v[140:143], v23 offset:12288
 v_mfma_f32_16x16x32_bf16 v[52:55], v[144:147], v[104:107], v[52:55]
 v_mfma_f32_16x16x32_bf16 v[60:63], v[144:147], v[128:131], v[60:63]
 s_waitcnt lgkmcnt(2)
 v_mfma_f32_16x16x32_bf16 v[44:47], v[148:151], v[84:87], v[44:47]
 ds_read_b128 v[144:147], v22 offset:12416
 s_add_u32 m0, s81, 0
 s_add_u32 s21, s88, 6979584
 v_mfma_f32_16x16x32_bf16 v[52:55], v[148:151], v[108:111], v[52:55]
 buffer_load_dwordx4 v28, s[12:15], s21 offen offset:0 lds
 v_mfma_f32_16x16x32_bf16 v[60:63], v[148:151], v[132:135], v[60:63]
 buffer_load_dwordx4 v29, s[12:15], s21 offen offset:1024 lds
 s_waitcnt lgkmcnt(2)
 v_mfma_f32_16x16x32_bf16 v[40:43], v[136:139], v[64:67], 0
 ds_read_b128 v[148:151], v23 offset:12416
 buffer_load_dwordx4 v30, s[12:15], s21 offen offset:2048 lds
 v_mfma_f32_16x16x32_bf16 v[48:51], v[136:139], v[88:91], 0
 s_add_u32 m0, s81, 3072
 s_add_u32 s21, s88, 7028736
 v_mfma_f32_16x16x32_bf16 v[56:59], v[136:139], v[112:115], 0
 buffer_load_dwordx4 v31, s[12:15], s21 offen offset:0 lds
 s_waitcnt lgkmcnt(2)
 v_mfma_f32_16x16x32_bf16 v[40:43], v[140:143], v[68:71], v[40:43]
 ds_read_b128 v[136:139], v22 offset:12544
 v_cvt_pk_f16_f32 v162, v44, v45
 buffer_load_dwordx4 v32, s[12:15], s21 offen offset:1024 lds
 v_cvt_pk_f16_f32 v163, v46, v47
 v_mfma_f32_16x16x32_bf16 v[48:51], v[140:143], v[92:95], v[48:51]
 v_cvt_pk_f16_f32 v170, v52, v53
 buffer_load_dwordx4 v33, s[12:15], s21 offen offset:2048 lds
 v_cvt_pk_f16_f32 v171, v54, v55
 v_cvt_pk_f16_f32 v178, v60, v61
 v_mfma_f32_16x16x32_bf16 v[56:59], v[140:143], v[116:119], v[56:59]
 v_cvt_pk_f16_f32 v179, v62, v63
 s_add_u32 m0, s81, 6144
 s_add_u32 s21, s88, 7471104
 s_waitcnt lgkmcnt(2)
 v_mfma_f32_16x16x32_bf16 v[40:43], v[144:147], v[72:75], v[40:43]
 ds_read_b128 v[140:143], v23 offset:12544
 buffer_load_dwordx4 v34, s[12:15], s21 offen offset:0 lds
 v_mfma_f32_16x16x32_bf16 v[48:51], v[144:147], v[96:99], v[48:51]
 buffer_load_dwordx4 v35, s[12:15], s21 offen offset:1024 lds
 v_mfma_f32_16x16x32_bf16 v[56:59], v[144:147], v[120:123], v[56:59]
 buffer_load_dwordx4 v36, s[12:15], s21 offen offset:2048 lds
 s_waitcnt lgkmcnt(2)
 v_mfma_f32_16x16x32_bf16 v[40:43], v[148:151], v[76:79], v[40:43]
 ds_read_b128 v[144:147], v22 offset:13824
 s_add_u32 m0, s81, 9216
 s_add_u32 s21, s88, 7520256
 v_mfma_f32_16x16x32_bf16 v[48:51], v[148:151], v[100:103], v[48:51]
 buffer_load_dwordx4 v37, s[12:15], s21 offen offset:0 lds
 v_mfma_f32_16x16x32_bf16 v[56:59], v[148:151], v[124:127], v[56:59]
 buffer_load_dwordx4 v38, s[12:15], s21 offen offset:1024 lds
 s_waitcnt lgkmcnt(2)
 v_mfma_f32_16x16x32_bf16 v[40:43], v[136:139], v[80:83], v[40:43]
 ds_read_b128 v[148:151], v23 offset:13824
 buffer_load_dwordx4 v39, s[12:15], s21 offen offset:2048 lds
 v_mfma_f32_16x16x32_bf16 v[48:51], v[136:139], v[104:107], v[48:51]
 buffer_load_dword v0, v26, s[32:35], 0 offen sc1
 v_mfma_f32_16x16x32_bf16 v[56:59], v[136:139], v[128:131], v[56:59]
 v_and_b32 v253, 31, v1
 buffer_load_ubyte v252, v253, s[32:35], 0 offen offset:160 sc1
 s_waitcnt lgkmcnt(2)
 v_mfma_f32_16x16x32_bf16 v[40:43], v[140:143], v[84:87], v[40:43]
 ds_read_b128 v[136:139], v22 offset:13952
 v_mfma_f32_16x16x32_bf16 v[48:51], v[140:143], v[108:111], v[48:51]
 v_mfma_f32_16x16x32_bf16 v[56:59], v[140:143], v[132:135], v[56:59]
 s_waitcnt lgkmcnt(2)
 v_mfma_f32_16x16x32_bf16 v[44:47], v[144:147], v[64:67], 0
 ds_read_b128 v[140:143], v23 offset:13952
 v_mfma_f32_16x16x32_bf16 v[52:55], v[144:147], v[88:91], 0
 v_mfma_f32_16x16x32_bf16 v[60:63], v[144:147], v[112:115], 0
 s_waitcnt lgkmcnt(2)
 v_mfma_f32_16x16x32_bf16 v[44:47], v[148:151], v[68:71], v[44:47]
 ds_read_b128 v[144:147], v22 offset:14080
 v_cvt_pk_f16_f32 v164, v40, v41
 v_cvt_pk_f16_f32 v165, v42, v43
 v_cvt_pk_f16_f32 v172, v48, v49
 v_cvt_pk_f16_f32 v173, v50, v51
 v_mfma_f32_16x16x32_bf16 v[52:55], v[148:151], v[92:95], v[52:55]
 v_cvt_pk_f16_f32 v180, v56, v57
 v_cvt_pk_f16_f32 v181, v58, v59
 v_mfma_f32_16x16x32_bf16 v[60:63], v[148:151], v[116:119], v[60:63]
 s_waitcnt lgkmcnt(2)
 v_mfma_f32_16x16x32_bf16 v[44:47], v[136:139], v[72:75], v[44:47]
 ds_read_b128 v[148:151], v23 offset:14080
 v_mfma_f32_16x16x32_bf16 v[52:55], v[136:139], v[96:99], v[52:55]
 v_mfma_f32_16x16x32_bf16 v[60:63], v[136:139], v[120:123], v[60:63]
 s_waitcnt lgkmcnt(2)
 v_mfma_f32_16x16x32_bf16 v[44:47], v[140:143], v[76:79], v[44:47]
 s_waitcnt vmcnt(14)
 ds_read_b128 v[136:139], v22 offset:24576
 v_mfma_f32_16x16x32_bf16 v[52:55], v[140:143], v[100:103], v[52:55]
 v_mfma_f32_16x16x32_bf16 v[60:63], v[140:143], v[124:127], v[60:63]
 s_waitcnt lgkmcnt(2)
 v_mfma_f32_16x16x32_bf16 v[44:47], v[144:147], v[80:83], v[44:47]
 ds_read_b128 v[140:143], v23 offset:24576
 v_mfma_f32_16x16x32_bf16 v[52:55], v[144:147], v[104:107], v[52:55]
 v_mfma_f32_16x16x32_bf16 v[60:63], v[144:147], v[128:131], v[60:63]
 s_waitcnt lgkmcnt(2)
 v_mfma_f32_16x16x32_bf16 v[44:47], v[148:151], v[84:87], v[44:47]
 ds_read_b128 v[144:147], v22 offset:24704
 s_add_u32 m0, s81, 12288
 s_add_u32 s21, s88, 196608
 v_mfma_f32_16x16x32_bf16 v[52:55], v[148:151], v[108:111], v[52:55]
 buffer_load_dwordx4 v28, s[12:15], s21 offen offset:0 lds
 v_mfma_f32_16x16x32_bf16 v[60:63], v[148:151], v[132:135], v[60:63]
 buffer_load_dwordx4 v29, s[12:15], s21 offen offset:1024 lds
 s_waitcnt lgkmcnt(2)
 v_mfma_f32_16x16x32_bf16 v[40:43], v[136:139], v[64:67], 0
 ds_read_b128 v[148:151], v23 offset:24704
 buffer_load_dwordx4 v30, s[12:15], s21 offen offset:2048 lds
 v_mfma_f32_16x16x32_bf16 v[48:51], v[136:139], v[88:91], 0
 s_add_u32 m0, s81, 15360
 s_add_u32 s21, s88, 2162688
 v_mfma_f32_16x16x32_bf16 v[56:59], v[136:139], v[112:115], 0
 buffer_load_dwordx4 v31, s[12:15], s21 offen offset:0 lds
 s_waitcnt lgkmcnt(2)
 v_mfma_f32_16x16x32_bf16 v[40:43], v[140:143], v[68:71], v[40:43]
 ds_read_b128 v[136:139], v22 offset:24832
 v_cvt_pk_f16_f32 v166, v44, v45
 buffer_load_dwordx4 v32, s[12:15], s21 offen offset:1024 lds
 v_cvt_pk_f16_f32 v167, v46, v47
 v_mfma_f32_16x16x32_bf16 v[48:51], v[140:143], v[92:95], v[48:51]
 v_cvt_pk_f16_f32 v174, v52, v53
 buffer_load_dwordx4 v33, s[12:15], s21 offen offset:2048 lds
 v_cvt_pk_f16_f32 v175, v54, v55
 v_cvt_pk_f16_f32 v182, v60, v61
 v_mfma_f32_16x16x32_bf16 v[56:59], v[140:143], v[116:119], v[56:59]
 v_cvt_pk_f16_f32 v183, v62, v63
 s_add_u32 m0, s81, 18432
 s_add_u32 s21, s88, 688128
 s_waitcnt lgkmcnt(2)
 v_mfma_f32_16x16x32_bf16 v[40:43], v[144:147], v[72:75], v[40:43]
 ds_read_b128 v[140:143], v23 offset:24832
 buffer_load_dwordx4 v34, s[12:15], s21 offen offset:0 lds
 v_mfma_f32_16x16x32_bf16 v[48:51], v[144:147], v[96:99], v[48:51]
 buffer_load_dwordx4 v35, s[12:15], s21 offen offset:1024 lds
 v_mfma_f32_16x16x32_bf16 v[56:59], v[144:147], v[120:123], v[56:59]
 buffer_load_dwordx4 v36, s[12:15], s21 offen offset:2048 lds
 s_waitcnt lgkmcnt(2)
 v_mfma_f32_16x16x32_bf16 v[40:43], v[148:151], v[76:79], v[40:43]
 ds_read_b128 v[144:147], v22 offset:26112
 s_add_u32 m0, s81, 21504
 s_add_u32 s21, s88, 2654208
 v_mfma_f32_16x16x32_bf16 v[48:51], v[148:151], v[100:103], v[48:51]
 buffer_load_dwordx4 v37, s[12:15], s21 offen offset:0 lds
 v_mfma_f32_16x16x32_bf16 v[56:59], v[148:151], v[124:127], v[56:59]
 buffer_load_dwordx4 v38, s[12:15], s21 offen offset:1024 lds
 s_waitcnt lgkmcnt(2)
 v_mfma_f32_16x16x32_bf16 v[40:43], v[136:139], v[80:83], v[40:43]
 ds_read_b128 v[148:151], v23 offset:26112
 buffer_load_dwordx4 v39, s[12:15], s21 offen offset:2048 lds
 v_mfma_f32_16x16x32_bf16 v[48:51], v[136:139], v[104:107], v[48:51]
 v_mfma_f32_16x16x32_bf16 v[56:59], v[136:139], v[128:131], v[56:59]
 s_waitcnt lgkmcnt(2)
 v_mfma_f32_16x16x32_bf16 v[40:43], v[140:143], v[84:87], v[40:43]
 ds_read_b128 v[136:139], v22 offset:26240
 v_mfma_f32_16x16x32_bf16 v[48:51], v[140:143], v[108:111], v[48:51]
 v_mfma_f32_16x16x32_bf16 v[56:59], v[140:143], v[132:135], v[56:59]
 s_waitcnt lgkmcnt(2)
 v_mfma_f32_16x16x32_bf16 v[44:47], v[144:147], v[64:67], 0
 ds_read_b128 v[140:143], v23 offset:26240
 v_mfma_f32_16x16x32_bf16 v[52:55], v[144:147], v[88:91], 0
 v_mfma_f32_16x16x32_bf16 v[60:63], v[144:147], v[112:115], 0
 s_waitcnt lgkmcnt(2)
 v_mfma_f32_16x16x32_bf16 v[44:47], v[148:151], v[68:71], v[44:47]
 ds_read_b128 v[144:147], v22 offset:26368
 v_cvt_pk_f16_f32 v184, v40, v41
 v_cvt_pk_f16_f32 v185, v42, v43
 v_cvt_pk_f16_f32 v192, v48, v49
 v_cvt_pk_f16_f32 v193, v50, v51
 v_mfma_f32_16x16x32_bf16 v[52:55], v[148:151], v[92:95], v[52:55]
 v_cvt_pk_f16_f32 v200, v56, v57
 v_cvt_pk_f16_f32 v201, v58, v59
 v_mfma_f32_16x16x32_bf16 v[60:63], v[148:151], v[116:119], v[60:63]
 s_waitcnt lgkmcnt(2)
 v_mfma_f32_16x16x32_bf16 v[44:47], v[136:139], v[72:75], v[44:47]
 ds_read_b128 v[148:151], v23 offset:26368
 v_mfma_f32_16x16x32_bf16 v[52:55], v[136:139], v[96:99], v[52:55]
 v_mfma_f32_16x16x32_bf16 v[60:63], v[136:139], v[120:123], v[60:63]
 s_waitcnt lgkmcnt(2)
 v_mfma_f32_16x16x32_bf16 v[44:47], v[140:143], v[76:79], v[44:47]
 s_waitcnt vmcnt(14)
 ds_read_b128 v[136:139], v22 offset:0
 v_mfma_f32_16x16x32_bf16 v[52:55], v[140:143], v[100:103], v[52:55]
 v_mfma_f32_16x16x32_bf16 v[60:63], v[140:143], v[124:127], v[60:63]
 s_waitcnt lgkmcnt(2)
 v_mfma_f32_16x16x32_bf16 v[44:47], v[144:147], v[80:83], v[44:47]
 ds_read_b128 v[140:143], v23 offset:0
 v_mfma_f32_16x16x32_bf16 v[52:55], v[144:147], v[104:107], v[52:55]
 v_mfma_f32_16x16x32_bf16 v[60:63], v[144:147], v[128:131], v[60:63]
 s_waitcnt lgkmcnt(2)
 v_mfma_f32_16x16x32_bf16 v[44:47], v[148:151], v[84:87], v[44:47]
 ds_read_b128 v[144:147], v22 offset:128
 s_add_u32 m0, s81, 24576
 s_add_u32 s21, s88, 1179648
 v_mfma_f32_16x16x32_bf16 v[52:55], v[148:151], v[108:111], v[52:55]
 buffer_load_dwordx4 v28, s[12:15], s21 offen offset:0 lds
 v_mfma_f32_16x16x32_bf16 v[60:63], v[148:151], v[132:135], v[60:63]
 buffer_load_dwordx4 v29, s[12:15], s21 offen offset:1024 lds
 s_waitcnt lgkmcnt(2)
 v_mfma_f32_16x16x32_bf16 v[40:43], v[136:139], v[64:67], 0
 ds_read_b128 v[148:151], v23 offset:128
 buffer_load_dwordx4 v30, s[12:15], s21 offen offset:2048 lds
 v_mfma_f32_16x16x32_bf16 v[48:51], v[136:139], v[88:91], 0
 s_add_u32 m0, s81, 27648
 s_add_u32 s21, s88, 3145728
 v_mfma_f32_16x16x32_bf16 v[56:59], v[136:139], v[112:115], 0
 buffer_load_dwordx4 v31, s[12:15], s21 offen offset:0 lds
 s_waitcnt lgkmcnt(2)
 v_mfma_f32_16x16x32_bf16 v[40:43], v[140:143], v[68:71], v[40:43]
 ds_read_b128 v[136:139], v22 offset:256
 v_cvt_pk_f16_f32 v186, v44, v45
 buffer_load_dwordx4 v32, s[12:15], s21 offen offset:1024 lds
 v_cvt_pk_f16_f32 v187, v46, v47
 v_mfma_f32_16x16x32_bf16 v[48:51], v[140:143], v[92:95], v[48:51]
 v_cvt_pk_f16_f32 v194, v52, v53
 buffer_load_dwordx4 v33, s[12:15], s21 offen offset:2048 lds
 v_cvt_pk_f16_f32 v195, v54, v55
 v_cvt_pk_f16_f32 v202, v60, v61
 v_mfma_f32_16x16x32_bf16 v[56:59], v[140:143], v[116:119], v[56:59]
 v_cvt_pk_f16_f32 v203, v62, v63
 s_add_u32 m0, s81, 30720
 s_add_u32 s21, s88, 1671168
 s_waitcnt lgkmcnt(2)
 v_mfma_f32_16x16x32_bf16 v[40:43], v[144:147], v[72:75], v[40:43]
 ds_read_b128 v[140:143], v23 offset:256
 buffer_load_dwordx4 v34, s[12:15], s21 offen offset:0 lds
 v_mfma_f32_16x16x32_bf16 v[48:51], v[144:147], v[96:99], v[48:51]
 buffer_load_dwordx4 v35, s[12:15], s21 offen offset:1024 lds
 v_mfma_f32_16x16x32_bf16 v[56:59], v[144:147], v[120:123], v[56:59]
 buffer_load_dwordx4 v36, s[12:15], s21 offen offset:2048 lds
 s_waitcnt lgkmcnt(2)
 v_mfma_f32_16x16x32_bf16 v[40:43], v[148:151], v[76:79], v[40:43]
 ds_read_b128 v[144:147], v22 offset:1536
 s_add_u32 m0, s81, 33792
 s_add_u32 s21, s88, 3637248
 v_mfma_f32_16x16x32_bf16 v[48:51], v[148:151], v[100:103], v[48:51]
 buffer_load_dwordx4 v37, s[12:15], s21 offen offset:0 lds
 v_mfma_f32_16x16x32_bf16 v[56:59], v[148:151], v[124:127], v[56:59]
 buffer_load_dwordx4 v38, s[12:15], s21 offen offset:1024 lds
 s_waitcnt lgkmcnt(2)
 v_mfma_f32_16x16x32_bf16 v[40:43], v[136:139], v[80:83], v[40:43]
 ds_read_b128 v[148:151], v23 offset:1536
 buffer_load_dwordx4 v39, s[12:15], s21 offen offset:2048 lds
 v_mfma_f32_16x16x32_bf16 v[48:51], v[136:139], v[104:107], v[48:51]
 v_mfma_f32_16x16x32_bf16 v[56:59], v[136:139], v[128:131], v[56:59]
 s_waitcnt lgkmcnt(2)
 v_mfma_f32_16x16x32_bf16 v[40:43], v[140:143], v[84:87], v[40:43]
 ds_read_b128 v[136:139], v22 offset:1664
 v_mfma_f32_16x16x32_bf16 v[48:51], v[140:143], v[108:111], v[48:51]
 v_mfma_f32_16x16x32_bf16 v[56:59], v[140:143], v[132:135], v[56:59]
 s_waitcnt lgkmcnt(2)
 v_mfma_f32_16x16x32_bf16 v[44:47], v[144:147], v[64:67], 0
 ds_read_b128 v[140:143], v23 offset:1664
 v_mfma_f32_16x16x32_bf16 v[52:55], v[144:147], v[88:91], 0
 v_mfma_f32_16x16x32_bf16 v[60:63], v[144:147], v[112:115], 0
 s_waitcnt lgkmcnt(2)
 v_mfma_f32_16x16x32_bf16 v[44:47], v[148:151], v[68:71], v[44:47]
 ds_read_b128 v[144:147], v22 offset:1792
 v_cvt_pk_f16_f32 v188, v40, v41
 v_cvt_pk_f16_f32 v189, v42, v43
 v_cvt_pk_f16_f32 v196, v48, v49
 v_cvt_pk_f16_f32 v197, v50, v51
 v_mfma_f32_16x16x32_bf16 v[52:55], v[148:151], v[92:95], v[52:55]
 v_cvt_pk_f16_f32 v204, v56, v57
 v_cvt_pk_f16_f32 v205, v58, v59
 v_mfma_f32_16x16x32_bf16 v[60:63], v[148:151], v[116:119], v[60:63]
 s_waitcnt lgkmcnt(2)
 v_mfma_f32_16x16x32_bf16 v[44:47], v[136:139], v[72:75], v[44:47]
 ds_read_b128 v[148:151], v23 offset:1792
 v_mfma_f32_16x16x32_bf16 v[52:55], v[136:139], v[96:99], v[52:55]
 v_mfma_f32_16x16x32_bf16 v[60:63], v[136:139], v[120:123], v[60:63]
 s_waitcnt lgkmcnt(2)
 v_mfma_f32_16x16x32_bf16 v[44:47], v[140:143], v[76:79], v[44:47]
 s_waitcnt vmcnt(12)
 ds_read_b128 v[136:139], v22 offset:12288
 v_mfma_f32_16x16x32_bf16 v[52:55], v[140:143], v[100:103], v[52:55]
 v_mfma_f32_16x16x32_bf16 v[60:63], v[140:143], v[124:127], v[60:63]
 s_waitcnt lgkmcnt(2)
 v_mfma_f32_16x16x32_bf16 v[44:47], v[144:147], v[80:83], v[44:47]
 ds_read_b128 v[140:143], v23 offset:12288
 v_mfma_f32_16x16x32_bf16 v[52:55], v[144:147], v[104:107], v[52:55]
 v_mfma_f32_16x16x32_bf16 v[60:63], v[144:147], v[128:131], v[60:63]
 s_waitcnt lgkmcnt(2)
 v_mfma_f32_16x16x32_bf16 v[44:47], v[148:151], v[84:87], v[44:47]
 ds_read_b128 v[144:147], v22 offset:12416
 s_add_u32 m0, s81, 0
 s_add_u32 s21, s88, 4128768
 v_mfma_f32_16x16x32_bf16 v[52:55], v[148:151], v[108:111], v[52:55]
 buffer_load_dwordx4 v28, s[12:15], s21 offen offset:0 lds
 v_mfma_f32_16x16x32_bf16 v[60:63], v[148:151], v[132:135], v[60:63]
 buffer_load_dwordx4 v29, s[12:15], s21 offen offset:1024 lds
 s_waitcnt lgkmcnt(2)
 v_mfma_f32_16x16x32_bf16 v[40:43], v[136:139], v[64:67], 0
 ds_read_b128 v[148:151], v23 offset:12416
 buffer_load_dwordx4 v30, s[12:15], s21 offen offset:2048 lds
 v_mfma_f32_16x16x32_bf16 v[48:51], v[136:139], v[88:91], 0
 s_add_u32 m0, s81, 3072
 s_add_u32 s21, s88, 6094848
 v_mfma_f32_16x16x32_bf16 v[56:59], v[136:139], v[112:115], 0
 buffer_load_dwordx4 v31, s[12:15], s21 offen offset:0 lds
 s_waitcnt lgkmcnt(2)
 v_mfma_f32_16x16x32_bf16 v[40:43], v[140:143], v[68:71], v[40:43]
 ds_read_b128 v[136:139], v22 offset:12544
 v_cvt_pk_f16_f32 v190, v44, v45
 buffer_load_dwordx4 v32, s[12:15], s21 offen offset:1024 lds
 v_cvt_pk_f16_f32 v191, v46, v47
 v_mfma_f32_16x16x32_bf16 v[48:51], v[140:143], v[92:95], v[48:51]
 v_cvt_pk_f16_f32 v198, v52, v53
 buffer_load_dwordx4 v33, s[12:15], s21 offen offset:2048 lds
 v_cvt_pk_f16_f32 v199, v54, v55
 v_cvt_pk_f16_f32 v206, v60, v61
 v_mfma_f32_16x16x32_bf16 v[56:59], v[140:143], v[116:119], v[56:59]
 v_cvt_pk_f16_f32 v207, v62, v63
 s_add_u32 m0, s81, 6144
 s_add_u32 s21, s88, 4620288
 s_waitcnt lgkmcnt(2)
 v_mfma_f32_16x16x32_bf16 v[40:43], v[144:147], v[72:75], v[40:43]
 ds_read_b128 v[140:143], v23 offset:12544
 buffer_load_dwordx4 v34, s[12:15], s21 offen offset:0 lds
 v_mfma_f32_16x16x32_bf16 v[48:51], v[144:147], v[96:99], v[48:51]
 buffer_load_dwordx4 v35, s[12:15], s21 offen offset:1024 lds
 v_mfma_f32_16x16x32_bf16 v[56:59], v[144:147], v[120:123], v[56:59]
 buffer_load_dwordx4 v36, s[12:15], s21 offen offset:2048 lds
 s_waitcnt lgkmcnt(2)
 v_mfma_f32_16x16x32_bf16 v[40:43], v[148:151], v[76:79], v[40:43]
 ds_read_b128 v[144:147], v22 offset:13824
 s_add_u32 m0, s81, 9216
 s_add_u32 s21, s88, 6586368
 v_mfma_f32_16x16x32_bf16 v[48:51], v[148:151], v[100:103], v[48:51]
 buffer_load_dwordx4 v37, s[12:15], s21 offen offset:0 lds
 v_mfma_f32_16x16x32_bf16 v[56:59], v[148:151], v[124:127], v[56:59]
 buffer_load_dwordx4 v38, s[12:15], s21 offen offset:1024 lds
 s_waitcnt lgkmcnt(2)
 v_mfma_f32_16x16x32_bf16 v[40:43], v[136:139], v[80:83], v[40:43]
 ds_read_b128 v[148:151], v23 offset:13824
 buffer_load_dwordx4 v39, s[12:15], s21 offen offset:2048 lds
 v_mfma_f32_16x16x32_bf16 v[48:51], v[136:139], v[104:107], v[48:51]
 v_mfma_f32_16x16x32_bf16 v[56:59], v[136:139], v[128:131], v[56:59]
 s_waitcnt lgkmcnt(2)
 v_mfma_f32_16x16x32_bf16 v[40:43], v[140:143], v[84:87], v[40:43]
 ds_read_b128 v[136:139], v22 offset:13952
 v_mfma_f32_16x16x32_bf16 v[48:51], v[140:143], v[108:111], v[48:51]
 v_mfma_f32_16x16x32_bf16 v[56:59], v[140:143], v[132:135], v[56:59]
 s_waitcnt lgkmcnt(2)
 v_mfma_f32_16x16x32_bf16 v[44:47], v[144:147], v[64:67], 0
 ds_read_b128 v[140:143], v23 offset:13952
 v_mfma_f32_16x16x32_bf16 v[52:55], v[144:147], v[88:91], 0
 v_mfma_f32_16x16x32_bf16 v[60:63], v[144:147], v[112:115], 0
 s_waitcnt lgkmcnt(2)
 v_mfma_f32_16x16x32_bf16 v[44:47], v[148:151], v[68:71], v[44:47]
 ds_read_b128 v[144:147], v22 offset:14080
 v_cvt_pk_f16_f32 v208, v40, v41
 v_cvt_pk_f16_f32 v209, v42, v43
 v_cvt_pk_f16_f32 v216, v48, v49
 v_cvt_pk_f16_f32 v217, v50, v51
 v_mfma_f32_16x16x32_bf16 v[52:55], v[148:151], v[92:95], v[52:55]
 v_cvt_pk_f16_f32 v224, v56, v57
 v_cvt_pk_f16_f32 v225, v58, v59
 v_mfma_f32_16x16x32_bf16 v[60:63], v[148:151], v[116:119], v[60:63]
 s_waitcnt lgkmcnt(2)
 v_mfma_f32_16x16x32_bf16 v[44:47], v[136:139], v[72:75], v[44:47]
 ds_read_b128 v[148:151], v23 offset:14080
 v_mfma_f32_16x16x32_bf16 v[52:55], v[136:139], v[96:99], v[52:55]
 v_mfma_f32_16x16x32_bf16 v[60:63], v[136:139], v[120:123], v[60:63]
 s_waitcnt lgkmcnt(2)
 v_mfma_f32_16x16x32_bf16 v[44:47], v[140:143], v[76:79], v[44:47]
 s_waitcnt vmcnt(12)
 ds_read_b128 v[136:139], v22 offset:24576
 v_mfma_f32_16x16x32_bf16 v[52:55], v[140:143], v[100:103], v[52:55]
 v_mfma_f32_16x16x32_bf16 v[60:63], v[140:143], v[124:127], v[60:63]
 s_waitcnt lgkmcnt(2)
 v_mfma_f32_16x16x32_bf16 v[44:47], v[144:147], v[80:83], v[44:47]
 ds_read_b128 v[140:143], v23 offset:24576
 v_mfma_f32_16x16x32_bf16 v[52:55], v[144:147], v[104:107], v[52:55]
 v_mfma_f32_16x16x32_bf16 v[60:63], v[144:147], v[128:131], v[60:63]
 s_waitcnt lgkmcnt(2)
 v_mfma_f32_16x16x32_bf16 v[44:47], v[148:151], v[84:87], v[44:47]
 ds_read_b128 v[144:147], v22 offset:24704
 s_add_u32 m0, s81, 12288
 s_add_u32 s21, s88, 5111808
 v_mfma_f32_16x16x32_bf16 v[52:55], v[148:151], v[108:111], v[52:55]
 buffer_load_dwordx4 v28, s[12:15], s21 offen offset:0 lds
 v_mfma_f32_16x16x32_bf16 v[60:63], v[148:151], v[132:135], v[60:63]
 buffer_load_dwordx4 v29, s[12:15], s21 offen offset:1024 lds
 s_waitcnt lgkmcnt(2)
 v_mfma_f32_16x16x32_bf16 v[40:43], v[136:139], v[64:67], 0
 ds_read_b128 v[148:151], v23 offset:24704
 buffer_load_dwordx4 v30, s[12:15], s21 offen offset:2048 lds
 v_mfma_f32_16x16x32_bf16 v[48:51], v[136:139], v[88:91], 0
 s_add_u32 m0, s81, 15360
 s_add_u32 s21, s88, 7077888
 v_mfma_f32_16x16x32_bf16 v[56:59], v[136:139], v[112:115], 0
 buffer_load_dwordx4 v31, s[12:15], s21 offen offset:0 lds
 s_waitcnt lgkmcnt(2)
 v_mfma_f32_16x16x32_bf16 v[40:43], v[140:143], v[68:71], v[40:43]
 ds_read_b128 v[136:139], v22 offset:24832
 v_cvt_pk_f16_f32 v210, v44, v45
 buffer_load_dwordx4 v32, s[12:15], s21 offen offset:1024 lds
 v_cvt_pk_f16_f32 v211, v46, v47
 v_mfma_f32_16x16x32_bf16 v[48:51], v[140:143], v[92:95], v[48:51]
 v_cvt_pk_f16_f32 v218, v52, v53
 buffer_load_dwordx4 v33, s[12:15], s21 offen offset:2048 lds
 v_cvt_pk_f16_f32 v219, v54, v55
 v_cvt_pk_f16_f32 v226, v60, v61
 v_mfma_f32_16x16x32_bf16 v[56:59], v[140:143], v[116:119], v[56:59]
 v_cvt_pk_f16_f32 v227, v62, v63
 s_add_u32 m0, s81, 18432
 s_add_u32 s21, s88, 5603328
 s_waitcnt lgkmcnt(2)
 v_mfma_f32_16x16x32_bf16 v[40:43], v[144:147], v[72:75], v[40:43]
 ds_read_b128 v[140:143], v23 offset:24832
 buffer_load_dwordx4 v34, s[12:15], s21 offen offset:0 lds
 v_mfma_f32_16x16x32_bf16 v[48:51], v[144:147], v[96:99], v[48:51]
 buffer_load_dwordx4 v35, s[12:15], s21 offen offset:1024 lds
 v_mfma_f32_16x16x32_bf16 v[56:59], v[144:147], v[120:123], v[56:59]
 buffer_load_dwordx4 v36, s[12:15], s21 offen offset:2048 lds
 s_waitcnt lgkmcnt(2)
 v_mfma_f32_16x16x32_bf16 v[40:43], v[148:151], v[76:79], v[40:43]
 ds_read_b128 v[144:147], v22 offset:26112
 s_add_u32 m0, s81, 21504
 s_add_u32 s21, s88, 7569408
 v_mfma_f32_16x16x32_bf16 v[48:51], v[148:151], v[100:103], v[48:51]
 buffer_load_dwordx4 v37, s[12:15], s21 offen offset:0 lds
 v_mfma_f32_16x16x32_bf16 v[56:59], v[148:151], v[124:127], v[56:59]
 buffer_load_dwordx4 v38, s[12:15], s21 offen offset:1024 lds
 s_waitcnt lgkmcnt(2)
 v_mfma_f32_16x16x32_bf16 v[40:43], v[136:139], v[80:83], v[40:43]
 ds_read_b128 v[148:151], v23 offset:26112
 buffer_load_dwordx4 v39, s[12:15], s21 offen offset:2048 lds
 v_mfma_f32_16x16x32_bf16 v[48:51], v[136:139], v[104:107], v[48:51]
 v_mfma_f32_16x16x32_bf16 v[56:59], v[136:139], v[128:131], v[56:59]
 s_waitcnt lgkmcnt(2)
 v_mfma_f32_16x16x32_bf16 v[40:43], v[140:143], v[84:87], v[40:43]
 ds_read_b128 v[136:139], v22 offset:26240
 v_mfma_f32_16x16x32_bf16 v[48:51], v[140:143], v[108:111], v[48:51]
 v_mfma_f32_16x16x32_bf16 v[56:59], v[140:143], v[132:135], v[56:59]
 s_waitcnt lgkmcnt(2)
 v_mfma_f32_16x16x32_bf16 v[44:47], v[144:147], v[64:67], 0
 ds_read_b128 v[140:143], v23 offset:26240
 v_mfma_f32_16x16x32_bf16 v[52:55], v[144:147], v[88:91], 0
 v_mfma_f32_16x16x32_bf16 v[60:63], v[144:147], v[112:115], 0
 s_waitcnt lgkmcnt(2)
 v_mfma_f32_16x16x32_bf16 v[44:47], v[148:151], v[68:71], v[44:47]
 ds_read_b128 v[144:147], v22 offset:26368
 v_cvt_pk_f16_f32 v212, v40, v41
 v_cvt_pk_f16_f32 v213, v42, v43
 v_cvt_pk_f16_f32 v220, v48, v49
 v_cvt_pk_f16_f32 v221, v50, v51
 v_mfma_f32_16x16x32_bf16 v[52:55], v[148:151], v[92:95], v[52:55]
 v_cvt_pk_f16_f32 v228, v56, v57
 v_cvt_pk_f16_f32 v229, v58, v59
 v_mfma_f32_16x16x32_bf16 v[60:63], v[148:151], v[116:119], v[60:63]
 s_waitcnt lgkmcnt(2)
 v_mfma_f32_16x16x32_bf16 v[44:47], v[136:139], v[72:75], v[44:47]
 ds_read_b128 v[148:151], v23 offset:26368
 v_mfma_f32_16x16x32_bf16 v[52:55], v[136:139], v[96:99], v[52:55]
 v_mfma_f32_16x16x32_bf16 v[60:63], v[136:139], v[120:123], v[60:63]
 s_waitcnt lgkmcnt(2)
 v_mfma_f32_16x16x32_bf16 v[44:47], v[140:143], v[76:79], v[44:47]
 s_waitcnt vmcnt(12)
 ds_read_b128 v[136:139], v22 offset:0
 v_mfma_f32_16x16x32_bf16 v[52:55], v[140:143], v[100:103], v[52:55]
 v_mfma_f32_16x16x32_bf16 v[60:63], v[140:143], v[124:127], v[60:63]
 s_waitcnt lgkmcnt(2)
 v_mfma_f32_16x16x32_bf16 v[44:47], v[144:147], v[80:83], v[44:47]
 ds_read_b128 v[140:143], v23 offset:0
 v_mfma_f32_16x16x32_bf16 v[52:55], v[144:147], v[104:107], v[52:55]
 v_mfma_f32_16x16x32_bf16 v[60:63], v[144:147], v[128:131], v[60:63]
 s_waitcnt lgkmcnt(2)
 v_mfma_f32_16x16x32_bf16 v[44:47], v[148:151], v[84:87], v[44:47]
 ds_read_b128 v[144:147], v22 offset:128
 v_mfma_f32_16x16x32_bf16 v[52:55], v[148:151], v[108:111], v[52:55]
 v_mfma_f32_16x16x32_bf16 v[60:63], v[148:151], v[132:135], v[60:63]
 s_mov_b32 s101, 0
 s_branch fm_8
fm_7:
 s_sleep 8
 buffer_load_dword v0, v26, s[32:35], 0 offen sc1
 s_add_u32 s101, s101, 1
 s_cmp_gt_u32 s101, 131072
 s_cbranch_scc1 end0
 s_waitcnt vmcnt(0)
fm_8:
 v_readlane_b32 s22, v0, 0
 v_readlane_b32 s23, v0, 32
 s_add_u32 s22, s22, s23
 v_readlane_b32 s23, v0, 1
 s_add_u32 s22, s22, s23
 v_readlane_b32 s23, v0, 33
 s_add_u32 s22, s22, s23
 v_readlane_b32 s23, v0, 2
 s_add_u32 s22, s22, s23
 v_readlane_b32 s23, v0, 34
 s_add_u32 s22, s22, s23
 v_readlane_b32 s23, v0, 3
 s_add_u32 s22, s22, s23
 v_readlane_b32 s23, v0, 35
 s_add_u32 s22, s22, s23
 v_readlane_b32 s21, v0, 19
 s_cmp_ge_u32 s22, 256
 s_cselect_b32 s21, s21, 0
 s_cmp_lt_u32 s21, 32
 s_cbranch_scc1 fm_7
 v_readlane_b32 s21, v0, s82
 s_cmp_ge_u32 s21, s83
 s_cselect_b32 s21, 1, 0
 s_andn2_b32 s53, s21, s53
 s_mov_b32 s101, 0
c0_9:
 v_cmp_eq_u32 vcc, 0, v252
 s_nop 1
 s_cbranch_vccz c0_10
 s_sleep 8
 v_and_b32 v253, 31, v1
 buffer_load_ubyte v252, v253, s[32:35], 0 offen offset:160 sc1
 s_add_u32 s101, s101, 1
 s_cmp_gt_u32 s101, 131072
 s_cbranch_scc1 end0
 s_waitcnt vmcnt(0)
 s_branch c0_9
c0_10:
 v_cmp_eq_u32 vcc, 2, v252
 s_nop 1
 s_mov_b32 s37, vcc_lo
 s_bitcmp0_b32 s37, 0
 s_cselect_b32 s23, 8192, 0
 v_add_u32 v13, s23, v13
 v_add_u32 v4, s23, v4
 s_add_u32 s12, s44, 81068032
 s_addc_u32 s13, s45, 0
 s_mov_b32 s14, 129024
 s_mov_b32 s15, 0x00020000
 v_and_b32 v27, 7, v2
 v_mul_u32_u24 v27, 1280, v27
 v_lshrrev_b32 v39, 3, v1
 v_mul_u32_u24 v39, 40, v39
 s_mul_i32 s21, s20, 320
 v_add3_u32 v27, v27, v39, s21
 buffer_load_dwordx4 v[28:31], v27, s[28:31], 0 offen offset:0
 buffer_load_dwordx4 v[32:35], v27, s[28:31], 0 offen offset:16
 buffer_load_dwordx2 v[36:37], v27, s[28:31], 0 offen offset:32
 s_and_b32 s21, s51, 3
 s_mul_i32 s21, s21, 540672
 buffer_load_dword v38, v9, s[8:11], s21 offen sc1
 buffer_load_dword v38, v8, s[8:11], s21 offen offset:0 sc1
 buffer_load_dword v38, v8, s[8:11], s21 offen offset:1024 sc1
 s_waitcnt lgkmcnt(2)
 v_mfma_f32_16x16x32_bf16 v[40:43], v[136:139], v[64:67], 0
 ds_read_b128 v[148:151], v23 offset:128
 v_mfma_f32_16x16x32_bf16 v[48:51], v[136:139], v[88:91], 0
 v_mfma_f32_16x16x32_bf16 v[56:59], v[136:139], v[112:115], 0
 s_waitcnt lgkmcnt(2)
 v_mfma_f32_16x16x32_bf16 v[40:43], v[140:143], v[68:71], v[40:43]
 ds_read_b128 v[136:139], v22 offset:256
 v_cvt_pk_f16_f32 v214, v44, v45
 v_cvt_pk_f16_f32 v215, v46, v47
 v_cvt_pk_f16_f32 v222, v52, v53
 v_cvt_pk_f16_f32 v223, v54, v55
 v_mfma_f32_16x16x32_bf16 v[48:51], v[140:143], v[92:95], v[48:51]
 v_cvt_pk_f16_f32 v230, v60, v61
 v_cvt_pk_f16_f32 v231, v62, v63
 v_mfma_f32_16x16x32_bf16 v[56:59], v[140:143], v[116:119], v[56:59]
 s_waitcnt lgkmcnt(2)
 v_mfma_f32_16x16x32_bf16 v[40:43], v[144:147], v[72:75], v[40:43]
 ds_read_b128 v[140:143], v23 offset:256
 v_mfma_f32_16x16x32_bf16 v[48:51], v[144:147], v[96:99], v[48:51]
 v_mfma_f32_16x16x32_bf16 v[56:59], v[144:147], v[120:123], v[56:59]
 s_waitcnt lgkmcnt(2)
 v_mfma_f32_16x16x32_bf16 v[40:43], v[148:151], v[76:79], v[40:43]
 ds_read_b128 v[144:147], v22 offset:1536
 v_mfma_f32_16x16x32_bf16 v[48:51], v[148:151], v[100:103], v[48:51]
 v_mfma_f32_16x16x32_bf16 v[56:59], v[148:151], v[124:127], v[56:59]
 s_waitcnt lgkmcnt(2)
 v_mfma_f32_16x16x32_bf16 v[40:43], v[136:139], v[80:83], v[40:43]
 ds_read_b128 v[148:151], v23 offset:1536
 v_mfma_f32_16x16x32_bf16 v[48:51], v[136:139], v[104:107], v[48:51]
 v_mfma_f32_16x16x32_bf16 v[56:59], v[136:139], v[128:131], v[56:59]
 s_waitcnt lgkmcnt(2)
 v_mfma_f32_16x16x32_bf16 v[40:43], v[140:143], v[84:87], v[40:43]
 ds_read_b128 v[136:139], v22 offset:1664
 v_mfma_f32_16x16x32_bf16 v[48:51], v[140:143], v[108:111], v[48:51]
 v_mfma_f32_16x16x32_bf16 v[56:59], v[140:143], v[132:135], v[56:59]
 s_waitcnt lgkmcnt(2)
 v_mfma_f32_16x16x32_bf16 v[44:47], v[144:147], v[64:67], 0
 ds_read_b128 v[140:143], v23 offset:1664
 v_mfma_f32_16x16x32_bf16 v[52:55], v[144:147], v[88:91], 0
 v_mfma_f32_16x16x32_bf16 v[60:63], v[144:147], v[112:115], 0
 s_waitcnt lgkmcnt(2)
 v_mfma_f32_16x16x32_bf16 v[44:47], v[148:151], v[68:71], v[44:47]
 ds_read_b128 v[144:147], v22 offset:1792
 v_cvt_pk_f16_f32 v232, v40, v41
 v_cvt_pk_f16_f32 v233, v42, v43
 v_cvt_pk_f16_f32 v240, v48, v49
 v_cvt_pk_f16_f32 v241, v50, v51
 v_mfma_f32_16x16x32_bf16 v[52:55], v[148:151], v[92:95], v[52:55]
 v_cvt_pk_f16_f32 v248, v56, v57
 v_cvt_pk_f16_f32 v249, v58, v59
 v_mfma_f32_16x16x32_bf16 v[60:63], v[148:151], v[116:119], v[60:63]
 s_waitcnt lgkmcnt(2)
 v_mfma_f32_16x16x32_bf16 v[44:47], v[136:139], v[72:75], v[44:47]
 ds_read_b128 v[148:151], v23 offset:1792
 v_mfma_f32_16x16x32_bf16 v[52:55], v[136:139], v[96:99], v[52:55]
 v_mfma_f32_16x16x32_bf16 v[60:63], v[136:139], v[120:123], v[60:63]
 s_waitcnt lgkmcnt(2)
 v_mfma_f32_16x16x32_bf16 v[44:47], v[140:143], v[76:79], v[44:47]
 s_waitcnt vmcnt(6)
 ds_read_b128 v[136:139], v22 offset:12288
 v_mfma_f32_16x16x32_bf16 v[52:55], v[140:143], v[100:103], v[52:55]
 v_mfma_f32_16x16x32_bf16 v[60:63], v[140:143], v[124:127], v[60:63]
 s_waitcnt lgkmcnt(2)
 v_mfma_f32_16x16x32_bf16 v[44:47], v[144:147], v[80:83], v[44:47]
 ds_read_b128 v[140:143], v23 offset:12288
 v_mfma_f32_16x16x32_bf16 v[52:55], v[144:147], v[104:107], v[52:55]
 v_mfma_f32_16x16x32_bf16 v[60:63], v[144:147], v[128:131], v[60:63]
 s_waitcnt lgkmcnt(2)
 v_mfma_f32_16x16x32_bf16 v[44:47], v[148:151], v[84:87], v[44:47]
 ds_read_b128 v[144:147], v22 offset:12416
 v_mfma_f32_16x16x32_bf16 v[52:55], v[148:151], v[108:111], v[52:55]
 v_mfma_f32_16x16x32_bf16 v[60:63], v[148:151], v[132:135], v[60:63]
 buffer_load_dword v0, off, s[12:15], s79 sc1
 s_waitcnt lgkmcnt(2)
 v_mfma_f32_16x16x32_bf16 v[40:43], v[136:139], v[64:67], 0
 ds_read_b128 v[148:151], v23 offset:12416
 v_mfma_f32_16x16x32_bf16 v[48:51], v[136:139], v[88:91], 0
 v_mfma_f32_16x16x32_bf16 v[56:59], v[136:139], v[112:115], 0
 s_waitcnt lgkmcnt(2)
 v_mfma_f32_16x16x32_bf16 v[40:43], v[140:143], v[68:71], v[40:43]
 ds_read_b128 v[136:139], v22 offset:12544
 v_cvt_pk_f16_f32 v234, v44, v45
 v_cvt_pk_f16_f32 v235, v46, v47
 v_cvt_pk_f16_f32 v242, v52, v53
 v_cvt_pk_f16_f32 v243, v54, v55
 v_mfma_f32_16x16x32_bf16 v[48:51], v[140:143], v[92:95], v[48:51]
 v_cvt_pk_f16_f32 v250, v60, v61
 v_cvt_pk_f16_f32 v251, v62, v63
 v_mfma_f32_16x16x32_bf16 v[56:59], v[140:143], v[116:119], v[56:59]
 s_waitcnt lgkmcnt(2)
 v_mfma_f32_16x16x32_bf16 v[40:43], v[144:147], v[72:75], v[40:43]
 ds_read_b128 v[140:143], v23 offset:12544
 v_mfma_f32_16x16x32_bf16 v[48:51], v[144:147], v[96:99], v[48:51]
 v_mfma_f32_16x16x32_bf16 v[56:59], v[144:147], v[120:123], v[56:59]
 s_waitcnt lgkmcnt(2)
 v_mfma_f32_16x16x32_bf16 v[40:43], v[148:151], v[76:79], v[40:43]
 ds_read_b128 v[144:147], v22 offset:13824
 v_mfma_f32_16x16x32_bf16 v[48:51], v[148:151], v[100:103], v[48:51]
 v_mfma_f32_16x16x32_bf16 v[56:59], v[148:151], v[124:127], v[56:59]
 s_waitcnt lgkmcnt(2)
 v_mfma_f32_16x16x32_bf16 v[40:43], v[136:139], v[80:83], v[40:43]
 ds_read_b128 v[148:151], v23 offset:13824
 v_mfma_f32_16x16x32_bf16 v[48:51], v[136:139], v[104:107], v[48:51]
 v_mfma_f32_16x16x32_bf16 v[56:59], v[136:139], v[128:131], v[56:59]
 s_waitcnt lgkmcnt(2)
 v_mfma_f32_16x16x32_bf16 v[40:43], v[140:143], v[84:87], v[40:43]
 ds_read_b128 v[136:139], v22 offset:13952
 v_mfma_f32_16x16x32_bf16 v[48:51], v[140:143], v[108:111], v[48:51]
 v_mfma_f32_16x16x32_bf16 v[56:59], v[140:143], v[132:135], v[56:59]
 s_waitcnt lgkmcnt(2)
 v_mfma_f32_16x16x32_bf16 v[44:47], v[144:147], v[64:67], 0
 ds_read_b128 v[140:143], v23 offset:13952
 v_mfma_f32_16x16x32_bf16 v[52:55], v[144:147], v[88:91], 0
 v_mfma_f32_16x16x32_bf16 v[60:63], v[144:147], v[112:115], 0
 s_waitcnt lgkmcnt(2)
 v_mfma_f32_16x16x32_bf16 v[44:47], v[148:151], v[68:71], v[44:47]
 ds_read_b128 v[144:147], v22 offset:14080
 v_cvt_pk_f16_f32 v236, v40, v41
 v_cvt_pk_f16_f32 v237, v42, v43
 v_cvt_pk_f16_f32 v244, v48, v49
 v_cvt_pk_f16_f32 v245, v50, v51
 v_mfma_f32_16x16x32_bf16 v[52:55], v[148:151], v[92:95], v[52:55]
 v_cvt_pk_f16_f32 v252, v56, v57
 v_cvt_pk_f16_f32 v253, v58, v59
 v_mfma_f32_16x16x32_bf16 v[60:63], v[148:151], v[116:119], v[60:63]
 s_waitcnt lgkmcnt(2)
 v_mfma_f32_16x16x32_bf16 v[44:47], v[136:139], v[72:75], v[44:47]
 ds_read_b128 v[148:151], v23 offset:14080
 v_mfma_f32_16x16x32_bf16 v[52:55], v[136:139], v[96:99], v[52:55]
 v_mfma_f32_16x16x32_bf16 v[60:63], v[136:139], v[120:123], v[60:63]
 s_waitcnt lgkmcnt(2)
 v_mfma_f32_16x16x32_bf16 v[44:47], v[140:143], v[76:79], v[44:47]
 v_mfma_f32_16x16x32_bf16 v[52:55], v[140:143], v[100:103], v[52:55]
 v_mfma_f32_16x16x32_bf16 v[60:63], v[140:143], v[124:127], v[60:63]
 s_waitcnt lgkmcnt(1)
 v_mfma_f32_16x16x32_bf16 v[44:47], v[144:147], v[80:83], v[44:47]
 v_mfma_f32_16x16x32_bf16 v[52:55], v[144:147], v[104:107], v[52:55]
 v_mfma_f32_16x16x32_bf16 v[60:63], v[144:147], v[128:131], v[60:63]
 s_waitcnt lgkmcnt(0)
 v_mfma_f32_16x16x32_bf16 v[44:47], v[148:151], v[84:87], v[44:47]
 v_mfma_f32_16x16x32_bf16 v[52:55], v[148:151], v[108:111], v[52:55]
 v_mfma_f32_16x16x32_bf16 v[60:63], v[148:151], v[132:135], v[60:63]
 s_nop 7
 v_cvt_pk_f16_f32 v238, v44, v45
 v_cvt_pk_f16_f32 v239, v46, v47
 v_cvt_pk_f16_f32 v246, v52, v53
 v_cvt_pk_f16_f32 v247, v54, v55
 v_cvt_pk_f16_f32 v254, v60, v61
 v_cvt_pk_f16_f32 v255, v62, v63
 s_add_u32 s28, s44, 88080384
 s_addc_u32 s29, s45, 0
 s_mov_b32 s30, 83886080
 s_mov_b32 s31, 0x00020000
 s_waitcnt vmcnt(0)
 v_readfirstlane_b32 s21, v0
 s_cmp_lg_u32 s21, 0
 s_cbranch_scc1 pf_12
 v_mov_b32 v62, 0
 s_mov_b32 s101, 0
wf_13:
 buffer_load_dword v63, v62, s[12:15], s79 offen sc1
 s_add_u32 s101, s101, 1
 s_cmp_gt_u32 s101, 131072
 s_cbranch_scc1 end0
 s_waitcnt vmcnt(0)
 v_readfirstlane_b32 s100, v63
 s_cmp_ge_u32 s100, 1
 s_cbranch_scc1 wf_14
 s_sleep 4
 s_branch wf_13
wf_14:
 v_mov_b32 v0, s100
pf_12:
 s_mov_b32 s87, 0
 s_sub_u32 s21, s64, 1310720
 s_cmp_ge_u32 s20, 2
 s_cbranch_scc1 pf_11
 buffer_load_dwordx4 v[112:115], v18, s[16:19], 0 offen sc1
 buffer_load_dwordx2 v[116:117], v19, s[16:19], 0 offen sc1
pf_11:
 buffer_load_dwordx4 v[126:129], v16, s[28:31], s21 offen offset:0 sc1
 buffer_load_dwordx4 v[130:133], v16, s[28:31], s21 offen offset:1024 sc1
 buffer_load_dwordx4 v[134:137], v16, s[28:31], s21 offen offset:2048 sc1
 v_lshlrev_b32 v27, 16, v28
 v_and_b32 v28, 0xffff0000, v28
 v_cvt_pk_f16_f32 v28, v27, v28
 v_lshlrev_b32 v27, 16, v29
 v_and_b32 v29, 0xffff0000, v29
 v_cvt_pk_f16_f32 v29, v27, v29
 v_lshlrev_b32 v27, 16, v30
 v_and_b32 v30, 0xffff0000, v30
 v_cvt_pk_f16_f32 v30, v27, v30
 v_lshlrev_b32 v27, 16, v31
 v_and_b32 v31, 0xffff0000, v31
 v_cvt_pk_f16_f32 v31, v27, v31
 v_lshlrev_b32 v27, 16, v32
 v_and_b32 v32, 0xffff0000, v32
 v_cvt_pk_f16_f32 v32, v27, v32
 v_lshlrev_b32 v27, 16, v33
 v_and_b32 v33, 0xffff0000, v33
 v_cvt_pk_f16_f32 v33, v27, v33
 v_lshlrev_b32 v27, 16, v34
 v_and_b32 v34, 0xffff0000, v34
 v_cvt_pk_f16_f32 v34, v27, v34
 v_lshlrev_b32 v27, 16, v35
 v_and_b32 v35, 0xffff0000, v35
 v_cvt_pk_f16_f32 v35, v27, v35
 v_lshlrev_b32 v27, 16, v36
 v_and_b32 v36, 0xffff0000, v36
 v_cvt_pk_f16_f32 v36, v27, v36
 v_lshlrev_b32 v27, 16, v37
 v_and_b32 v37, 0xffff0000, v37
 v_cvt_pk_f16_f32 v37, v27, v37
 s_lshl_b32 s21, s20, 2
 s_add_u32 s21, s21, 20480
 v_add_u32 v22, s21, v16
 v_bfe_u32 v23, v1, 2, 3
 v_lshlrev_b32 v23, 4, v23
 v_add_u32 v23, 20480, v23
 v_cmp_gt_u32 vcc, 2, v3
 s_mov_b32 s52, 0
 s_mov_b32 s89, 0x05040100
 v_cndmask_b32 v26, 0, 1.0, vcc
 v_mov_b32 v124, 0
 v_mov_b32 v125, 0
 v_mov_b32 v144, 0
 v_mov_b32 v145, 0
 v_mov_b32 v40, 0
 v_mov_b32 v41, 0
 v_mov_b32 v42, 0
 v_mov_b32 v43, 0
 v_mov_b32 v44, 0
 v_mov_b32 v45, 0
 v_mov_b32 v46, 0
 v_mov_b32 v47, 0
 v_mov_b32 v48, 0
 v_mov_b32 v49, 0
 v_mov_b32 v50, 0
 v_mov_b32 v51, 0
 v_mov_b32 v52, 0
 v_mov_b32 v53, 0
 v_mov_b32 v54, 0
 v_mov_b32 v55, 0
 v_mov_b32 v56, 0
 v_mov_b32 v57, 0
 v_mov_b32 v58, 0
 v_mov_b32 v59, 0
 v_mov_b32 v60, 0
 v_mov_b32 v61, 0
 v_mov_b32 v62, 0
 v_mov_b32 v63, 0
 v_mov_b32 v100, 0
 v_mov_b32 v101, 0
 v_mov_b32 v102, 0
 v_mov_b32 v103, 0
 v_mov_b32 v104, 0
 v_mov_b32 v105, 0
 v_mov_b32 v106, 0
 v_mov_b32 v107, 0
 v_mov_b32 v108, 0
 v_mov_b32 v109, 0
 v_mov_b32 v110, 0
 v_mov_b32 v111, 0
 s_barrier
 s_mov_b32 s57, 0x80000000
 s_and_b32 s21, s52, 3
 s_mul_i32 s81, s21, 540672
 s_mul_i32 s84, s21, 0x88000
 s_and_b32 s84, s84, 0x108000
 s_add_u32 s21, s52, 3
 s_and_b32 s21, s21, 3
 s_mul_i32 s83, s21, 0x88000
 s_and_b32 s83, s83, 0x108000
 s_add_u32 s21, s52, 1
 s_and_b32 s22, s21, 3
 s_mul_i32 s3, s22, 0x88000
 s_and_b32 s3, s3, 0x108000
 s_mul_i32 s80, s21, 393216
 s_add_u32 s46, s21, 1
 s_min_u32 s46, s46, 64
 s_mov_b32 s47, s57
 s_lshr_b32 s21, s52, 1
 s_bitcmp1_b32 s37, s21
 s_cselect_b32 s21, 8192, 0
 s_lshl_b32 s22, s52, 20
 s_or_b32 s22, s22, s21
 s_cmp_ge_u32 s52, 40
 s_cselect_b32 s57, 8192, 0
 s_xor_b32 s57, s57, s22
 s_xor_b32 s85, s22, 8192
 s_bfe_u32 s88, s52, 0x10002
 s_max_u32 s67, s52, 1
 s_sub_u32 s67, s67, 1
 s_cmp_eq_u32 s53, 0
 s_cbranch_scc1 A1_19
 s_cmp_eq_u32 s20, 0
 s_cbranch_scc1 A1_15
 s_cmp_eq_u32 s20, 1
 s_cbranch_scc1 A1_16
 s_cmp_eq_u32 s20, 2
 s_cbranch_scc1 A1_17
 s_cmp_eq_u32 s20, 3
 s_cbranch_scc1 A1_18
 s_branch A1_19
step_20:
 s_and_b32 s21, s52, 3
 s_mul_i32 s81, s21, 540672
 s_mul_i32 s84, s21, 0x88000
 s_and_b32 s84, s84, 0x108000
 s_add_u32 s21, s52, 3
 s_and_b32 s21, s21, 3
 s_mul_i32 s83, s21, 0x88000
 s_and_b32 s83, s83, 0x108000
 s_add_u32 s21, s52, 1
 s_and_b32 s22, s21, 3
 s_mul_i32 s3, s22, 0x88000
 s_and_b32 s3, s3, 0x108000
 s_mul_i32 s80, s21, 393216
 s_add_u32 s46, s21, 1
 s_min_u32 s46, s46, 64
 s_mov_b32 s47, s57
 s_lshr_b32 s21, s52, 1
 s_bitcmp1_b32 s37, s21
 s_cselect_b32 s21, 8192, 0
 s_lshl_b32 s22, s52, 20
 s_or_b32 s22, s22, s21
 s_cmp_ge_u32 s52, 40
 s_cselect_b32 s57, 8192, 0
 s_xor_b32 s57, s57, s22
 s_xor_b32 s85, s22, 8192
 s_bfe_u32 s88, s52, 0x10002
 s_max_u32 s67, s52, 1
 s_sub_u32 s67, s67, 1
 v_mov_b32 v40, 0
 v_mov_b32 v41, 0
 v_mov_b32 v42, 0
 v_mov_b32 v43, 0
 v_mov_b32 v44, 0
 v_mov_b32 v45, 0
 v_mov_b32 v46, 0
 v_mov_b32 v47, 0
 v_mov_b32 v48, 0
 v_mov_b32 v49, 0
 v_mov_b32 v50, 0
 v_mov_b32 v51, 0
 v_mov_b32 v52, 0
 v_mov_b32 v53, 0
 v_mov_b32 v54, 0
 v_mov_b32 v55, 0
 v_mov_b32 v56, 0
 v_mov_b32 v57, 0
 v_mov_b32 v58, 0
 v_mov_b32 v59, 0
 v_mov_b32 v60, 0
 v_mov_b32 v61, 0
 v_mov_b32 v62, 0
 v_mov_b32 v63, 0
 v_mov_b32 v100, 0
 v_mov_b32 v101, 0
 v_mov_b32 v102, 0
 v_mov_b32 v103, 0
 v_mov_b32 v104, 0
 v_mov_b32 v105, 0
 v_mov_b32 v106, 0
 v_mov_b32 v107, 0
 v_mov_b32 v108, 0
 v_mov_b32 v109, 0
 v_mov_b32 v110, 0
 v_mov_b32 v111, 0
 s_sleep 5
 v_readfirstlane_b32 s21, v0
 s_cmp_lt_u32 s21, s46
 s_cselect_b32 s55, s55, 0
 s_cmp_lt_i32 s55, 0
 s_cbranch_scc1 fl_25
fl_26:
 s_mov_b32 s54, 0
 buffer_load_dwordx4 v[36:39], v4, s[4:7], s84 offen offset:2048 sc1
 buffer_load_dwordx4 v[28:31], v4, s[4:7], s84 offen offset:0 sc1
 buffer_load_dwordx4 v[32:35], v4, s[4:7], s84 offen offset:1024 sc1
 s_waitcnt vmcnt(3)
 v_mov_b32 v126, v88
 v_mov_b32 v127, v89
 v_mov_b32 v128, v90
 v_mov_b32 v129, v91
 v_mov_b32 v130, v92
 v_mov_b32 v131, v93
 v_mov_b32 v132, v94
 v_mov_b32 v133, v95
 v_mov_b32 v134, v96
 v_mov_b32 v135, v97
 v_mov_b32 v136, v98
 v_mov_b32 v137, v99
 s_waitcnt vmcnt(2)
 v_smfmac_f32_16x16x32_f16 v[40:43], v[36:37], a[16:19], v25
 v_smfmac_f32_16x16x32_f16 v[52:55], v[36:37], a[76:79], v25
 v_smfmac_f32_16x16x32_f16 v[44:47], v[36:37], a[36:39], v25
 s_waitcnt vmcnt(0)
 v_bitop3_b32 v27, v31, v35, v39 bitop3:0x80
 v_perm_b32 v31, v35, v31, s89
 v_cmp_gt_u32 vcc, 0x48000000, v27
 v_mov_b32 v35, v38
 v_smfmac_f32_16x16x32_f16 v[56:59], v[36:37], a[96:99], v25
 s_cbranch_vccnz pm_23
A2_24:
 v_smfmac_f32_16x16x64_f16 v[40:43], v[28:31], a[0:7], v25
 ds_write_b128 v10, v[28:31]
 v_smfmac_f32_16x16x64_f16 v[40:43], v[32:35], a[8:15], v25
 ds_write_b128 v10, v[32:35] offset:1024
 v_smfmac_f32_16x16x64_f16 v[52:55], v[28:31], a[60:67], v25
 ds_write_b64 v10, v[36:37] offset:2048
 v_smfmac_f32_16x16x64_f16 v[52:55], v[32:35], a[68:75], v25
 v_cvt_pk_f16_f32 v40, v40, v41
 v_cvt_pk_f16_f32 v41, v42, v43
 v_smfmac_f32_16x16x32_f16 v[48:51], v[36:37], a[56:59], v25
 v_smfmac_f32_16x16x32_f16 v[60:63], v[36:37], a[116:119], v25
 v_smfmac_f32_16x16x64_f16 v[44:47], v[28:31], a[20:27], v25
 v_cvt_pk_f16_f32 v52, v52, v53
 v_cvt_pk_f16_f32 v53, v54, v55
 s_nop 0
 v_smfmac_f32_16x16x64_f16 v[44:47], v[32:35], a[28:35], v25
 v_permlane32_swap_b32 v40, v52
 v_smfmac_f32_16x16x64_f16 v[56:59], v[28:31], a[80:87], v25
 v_permlane32_swap_b32 v41, v53
 v_pk_add_f16 v40, v40, v52
 v_smfmac_f32_16x16x64_f16 v[56:59], v[32:35], a[88:95], v25
 v_pk_add_f16 v41, v41, v53
 v_smfmac_f32_16x16x64_f16 v[48:51], v[28:31], a[40:47], v25
 ds_write_b64 v5, v[40:41] offset:0
 v_smfmac_f32_16x16x64_f16 v[48:51], v[32:35], a[48:55], v25
 v_cvt_pk_f16_f32 v44, v44, v45
 v_cvt_pk_f16_f32 v45, v46, v47
 v_cvt_pk_f16_f32 v56, v56, v57
 v_smfmac_f32_16x16x64_f16 v[60:63], v[28:31], a[100:107], v25
 v_cvt_pk_f16_f32 v57, v58, v59
 s_nop 0
 v_smfmac_f32_16x16x64_f16 v[60:63], v[32:35], a[108:115], v25
 v_permlane32_swap_b32 v44, v56
 v_permlane32_swap_b32 v45, v57
 v_pk_add_f16 v44, v44, v56
 v_pk_add_f16 v45, v45, v57
 ds_write_b64 v5, v[44:45] offset:640
 v_cvt_pk_f16_f32 v48, v48, v49
 v_cvt_pk_f16_f32 v49, v50, v51
 v_cvt_pk_f16_f32 v60, v60, v61
 v_cvt_pk_f16_f32 v61, v62, v63
 s_nop 0
 v_permlane32_swap_b32 v48, v60
 v_permlane32_swap_b32 v49, v61
 v_pk_add_f16 v48, v48, v60
 v_pk_add_f16 v49, v49, v61
 ds_write_b64 v5, v[48:49] offset:1280
 s_waitcnt lgkmcnt(0) vmcnt(0)
 s_barrier
 ds_read_b64_tr_b16 v[40:41], v21 offset:0
 ds_read_b64_tr_b16 v[42:43], v21 offset:1920
 ds_read_b64_tr_b16 v[44:45], v21 offset:640
 ds_read_b64_tr_b16 v[46:47], v21 offset:2560
 ds_read_b64_tr_b16 v[48:49], v21 offset:1280
 ds_read_b64_tr_b16 v[50:51], v21 offset:3200
 s_waitcnt lgkmcnt(4)
 v_fma_mix_f32 v52, v40, 1.0, v42 op_sel:[0,0,0] op_sel_hi:[1,0,1]
 v_fma_mix_f32 v53, v40, 1.0, v42 op_sel:[1,0,1] op_sel_hi:[1,0,1]
 v_fma_mix_f32 v54, v41, 1.0, v43 op_sel:[0,0,0] op_sel_hi:[1,0,1]
 v_fma_mix_f32 v55, v41, 1.0, v43 op_sel:[1,0,1] op_sel_hi:[1,0,1]
 v_add_f32_dpp v56, v52, v52 row_ror:8 row_mask:0xf bank_mask:0xf
 v_add_f32_dpp v57, v53, v53 row_ror:8 row_mask:0xf bank_mask:0xf
 v_add_f32_dpp v58, v54, v54 row_ror:8 row_mask:0xf bank_mask:0xf
 v_add_f32_dpp v59, v55, v55 row_ror:8 row_mask:0xf bank_mask:0xf
 v_cvt_pk_bf16_f32 v118, v56, v57
 v_cvt_pk_bf16_f32 v119, v58, v59
 s_waitcnt lgkmcnt(2)
 v_fma_mix_f32 v52, v44, 1.0, v46 op_sel:[0,0,0] op_sel_hi:[1,0,1]
 v_fma_mix_f32 v53, v44, 1.0, v46 op_sel:[1,0,1] op_sel_hi:[1,0,1]
 v_fma_mix_f32 v54, v45, 1.0, v47 op_sel:[0,0,0] op_sel_hi:[1,0,1]
 v_fma_mix_f32 v55, v45, 1.0, v47 op_sel:[1,0,1] op_sel_hi:[1,0,1]
 v_add_f32_dpp v56, v52, v52 row_ror:8 row_mask:0xf bank_mask:0xf
 v_add_f32_dpp v57, v53, v53 row_ror:8 row_mask:0xf bank_mask:0xf
 v_add_f32_dpp v58, v54, v54 row_ror:8 row_mask:0xf bank_mask:0xf
 v_add_f32_dpp v59, v55, v55 row_ror:8 row_mask:0xf bank_mask:0xf
 v_cvt_pk_bf16_f32 v120, v56, v57
 v_cvt_pk_bf16_f32 v121, v58, v59
 s_waitcnt lgkmcnt(0)
 v_fma_mix_f32 v52, v48, 1.0, v50 op_sel:[0,0,0] op_sel_hi:[1,0,1]
 v_fma_mix_f32 v53, v48, 1.0, v50 op_sel:[1,0,1] op_sel_hi:[1,0,1]
 v_fma_mix_f32 v54, v49, 1.0, v51 op_sel:[0,0,0] op_sel_hi:[1,0,1]
 v_fma_mix_f32 v55, v49, 1.0, v51 op_sel:[1,0,1] op_sel_hi:[1,0,1]
 v_mfma_f32_16x16x32_bf16 v[40:43], v[112:115], v[118:121], 0
 v_add_f32_dpp v56, v52, v52 row_ror:8 row_mask:0xf bank_mask:0xf
 v_add_f32_dpp v57, v53, v53 row_ror:8 row_mask:0xf bank_mask:0xf
 v_add_f32_dpp v58, v54, v54 row_ror:8 row_mask:0xf bank_mask:0xf
 v_add_f32_dpp v59, v55, v55 row_ror:8 row_mask:0xf bank_mask:0xf
 v_cvt_pk_bf16_f32 v122, v56, v57
 v_cvt_pk_bf16_f32 v123, v58, v59
 s_nop 1
 v_mfma_f32_16x16x32_bf16 v[40:43], v[116:119], v[122:125], v[40:43]
 ds_read_b128 v[28:31], v16 offset:24576
 ds_read_b128 v[32:35], v16 offset:25600
 ds_read_b128 v[64:67], v16 offset:27648
 ds_read_b128 v[68:71], v16 offset:28672
 ds_read_b128 v[72:75], v16 offset:30720
 ds_read_b128 v[76:79], v16 offset:31744
 s_nop 0
 s_mov_b64 exec, s[74:75]
 v_cvt_pk_f16_f32 v44, v40, v41
 v_cvt_pk_f16_f32 v45, v42, v43
 v_and_or_b32 v44, v44, -2, s88
 buffer_store_dwordx2 v[44:45], v7, s[8:11], s81 offen
 s_mov_b64 exec, -1
 ds_read_b128 v[80:83], v16 offset:33792
 ds_read_b128 v[84:87], v16 offset:34816
 ds_read_b64 v[88:89], v16 offset:26624
 ds_read_b64 v[90:91], v16 offset:29696
 ds_read_b64 v[92:93], v16 offset:32768
 ds_read_b64 v[94:95], v16 offset:35840
 s_cmp_eq_u32 s52, 63
 s_cbranch_scc1 last_21
 s_waitcnt lgkmcnt(10)
 v_smfmac_f32_16x16x64_f16 v[100:103], v[28:31], a[120:127], v25
 v_smfmac_f32_16x16x64_f16 v[104:107], v[28:31], a[128:135], v25
 v_smfmac_f32_16x16x64_f16 v[108:111], v[28:31], a[136:143], v25
 s_mov_b32 s54, 0
 v_smfmac_f32_16x16x64_f16 v[100:103], v[32:35], a[144:151], v25
 v_readfirstlane_b32 s21, v0
 v_smfmac_f32_16x16x64_f16 v[104:107], v[32:35], a[152:159], v25
 s_add_u32 s22, s46, 3
 v_smfmac_f32_16x16x64_f16 v[108:111], v[32:35], a[160:167], v25
 s_min_u32 s22, s22, 64
 s_waitcnt lgkmcnt(7)
 v_smfmac_f32_16x16x64_f16 v[100:103], v[64:67], a[168:175], v25
 s_sub_u32 s55, s21, s22
 v_smfmac_f32_16x16x64_f16 v[104:107], v[64:67], a[176:183], v25
 s_sub_u32 s56, s21, s46
 v_smfmac_f32_16x16x64_f16 v[108:111], v[64:67], a[184:191], v25
 v_smfmac_f32_16x16x64_f16 v[100:103], v[68:71], a[192:199], v25
 v_smfmac_f32_16x16x64_f16 v[104:107], v[68:71], a[200:207], v25
 v_smfmac_f32_16x16x64_f16 v[108:111], v[68:71], a[208:215], v25
 v_smfmac_f32_16x16x64_f16 v[100:103], v[72:75], a[216:223], v25
 v_smfmac_f32_16x16x64_f16 v[104:107], v[72:75], a[224:231], v25
 v_smfmac_f32_16x16x64_f16 v[108:111], v[72:75], a[232:239], v25
 s_waitcnt lgkmcnt(4)
 v_smfmac_f32_16x16x64_f16 v[100:103], v[76:79], a[240:247], v25
 v_smfmac_f32_16x16x64_f16 v[104:107], v[76:79], a[248:255], v25
 v_smfmac_f32_16x16x64_f16 v[108:111], v[76:79], v[152:159], v25
 v_smfmac_f32_16x16x64_f16 v[100:103], v[80:83], v[160:167], v25
 v_smfmac_f32_16x16x64_f16 v[104:107], v[80:83], v[168:175], v25
 buffer_load_dwordx2 v[58:59], v9, s[8:11], s81 offen sc1
 buffer_load_dwordx4 v[40:43], v8, s[8:11], s81 offen offset:0 sc1
 buffer_load_dwordx4 v[44:47], v8, s[8:11], s81 offen offset:1024 sc1
 v_smfmac_f32_16x16x64_f16 v[108:111], v[80:83], v[176:183], v25
 v_smfmac_f32_16x16x64_f16 v[100:103], v[84:87], v[184:191], v25
 v_smfmac_f32_16x16x64_f16 v[104:107], v[84:87], v[192:199], v25
 v_smfmac_f32_16x16x64_f16 v[108:111], v[84:87], v[200:207], v25
 s_waitcnt lgkmcnt(0)
 v_smfmac_f32_16x16x64_f16 v[100:103], v[88:91], v[208:215], v25
 v_smfmac_f32_16x16x64_f16 v[104:107], v[88:91], v[216:223], v25
 v_smfmac_f32_16x16x64_f16 v[108:111], v[88:91], v[224:231], v25
 v_smfmac_f32_16x16x64_f16 v[100:103], v[92:95], v[232:239], v25
 v_smfmac_f32_16x16x64_f16 v[104:107], v[92:95], v[240:247], v25
 v_smfmac_f32_16x16x64_f16 v[108:111], v[92:95], v[248:255], v25
 s_cmp_lt_i32 s56, 0
 s_cbranch_scc1 kvw_29
kvok_30:
 s_waitcnt vmcnt(2)
 v_xor_b32 v76, s88, v58
 s_nop 0
 v_permlane16_swap_b32 v58, v59
 v_fma_mix_f32 v60, v58, 1.0, v59 op_sel:[0,0,0] op_sel_hi:[1,0,1]
 v_fma_mix_f32 v61, v58, 1.0, v59 op_sel:[1,0,1] op_sel_hi:[1,0,1]
 v_mov_b32 v58, v60
 v_mov_b32 v59, v61
 s_nop 0
 v_permlane32_swap_b32 v58, v60
 v_permlane32_swap_b32 v59, v61
 v_add_f32 v52, v58, v60
 v_add_f32 v53, v59, v61
 v_max_f32 v79, v52, v53
 s_waitcnt vmcnt(0)
 v_pk_add_f16 v80, v40, v44
 v_pk_add_f16 v82, v42, v46
 v_pk_add_f16 v81, v41, v45
 v_pk_add_f16 v83, v43, v47
 v_permlane32_swap_b32 v80, v82
 v_bitop3_b32 v77, v40, v42, s88 bitop3:0x7e
 v_permlane32_swap_b32 v81, v83
 v_bitop3_b32 v78, v44, v46, s88 bitop3:0x7e
 v_fma_mix_f32 v48, v80, 1.0, v82 op_sel:[0,0,0] op_sel_hi:[1,0,1]
 v_or3_b32 v27, v76, v77, v78
 v_fma_mix_f32 v49, v80, 1.0, v82 op_sel:[1,0,1] op_sel_hi:[1,0,1]
 v_and_b32 v27, 1, v27
 v_fma_mix_f32 v50, v81, 1.0, v83 op_sel:[0,0,0] op_sel_hi:[1,0,1]
 v_cmp_ne_u32 vcc, 0, v27
 v_fma_mix_f32 v51, v81, 1.0, v83 op_sel:[1,0,1] op_sel_hi:[1,0,1]
 v_max3_f32 v62, v48, v49, v79
 s_cbranch_vccnz psr_27
psj_28:
 v_max3_f32 v62, v62, v50, v51
 v_cvt_pk_bf16_f32 v146, v100, v101
 v_cvt_pk_bf16_f32 v147, v102, v103
 v_max_f32_dpp v62, v62, v62 row_ror:8 row_mask:0xf bank_mask:0xf
 v_mov_b32 v63, v62
 v_cvt_pk_bf16_f32 v148, v104, v105
 v_cvt_pk_bf16_f32 v149, v106, v107
 v_permlane32_swap_b32 v62, v63
 v_max_f32 v62, v62, v63
 v_mov_b32 v63, v62
 v_cvt_pk_bf16_f32 v150, v108, v109
 v_cvt_pk_bf16_f32 v151, v110, v111
 v_permlane16_swap_b32 v62, v63
 v_max_f32 v62, v62, v63
 v_mul_f32 v62, s86, v62
 v_fma_f32 v48, v48, s86, -v62
 v_fma_f32 v49, v49, s86, -v62
 v_fma_f32 v50, v50, s86, -v62
 v_fma_f32 v51, v51, s86, -v62
 v_fma_f32 v52, v52, s86, -v62
 v_fma_f32 v53, v53, s86, -v62
 v_exp_f32 v48, v48
 v_exp_f32 v49, v49
 buffer_load_dwordx4 v[88:91], v17, s[28:31], s64 offen offset:0 sc1
 v_exp_f32 v50, v50
 v_exp_f32 v51, v51
 buffer_load_dwordx4 v[92:95], v16, s[28:31], s64 offen offset:1024 sc1
 v_exp_f32 v52, v52
 v_exp_f32 v53, v53
 buffer_load_dwordx4 v[96:99], v20, s[28:31], s64 offen offset:2048 sc1
 v_cvt_pk_bf16_f32 v138, v48, v49
 v_cvt_pk_bf16_f32 v139, v50, v51
 v_cvt_pk_bf16_f32 v142, v52, v53
 v_mov_b32_dpp v140, v138 row_ror:8 row_mask:0xf bank_mask:0xf
 v_mov_b32_dpp v141, v139 row_ror:8 row_mask:0xf bank_mask:0xf
 v_mov_b32_dpp v143, v142 row_ror:8 row_mask:0xf bank_mask:0xf
 buffer_load_dwordx4 v[112:115], v18, s[16:19], s80 offen sc1
 v_add_f32 v54, v48, v49
 v_mfma_f32_16x16x32_bf16 v[64:67], v[126:129], v[138:141], 0
 v_add_f32 v55, v50, v51
 v_add_f32 v56, v52, v53
 v_mfma_f32_16x16x32_bf16 v[64:67], v[146:149], v[142:145], v[64:67]
 v_add_f32 v62, v54, v55
 v_fmac_f32 v62, v56, v26
 v_mfma_f32_16x16x32_bf16 v[68:71], v[130:133], v[138:141], 0
 buffer_load_dwordx2 v[116:117], v19, s[16:19], s80 offen sc1
 v_add_f32_dpp v62, v62, v62 row_ror:8 row_mask:0xf bank_mask:0xf
 v_mfma_f32_16x16x32_bf16 v[68:71], v[148:151], v[142:145], v[68:71]
 v_mov_b32 v63, v62
 s_cmp_lt_i32 s55, 0
 s_cbranch_scc1 fl_31
fl_32:
 v_mfma_f32_16x16x32_bf16 v[72:75], v[134:137], v[138:141], 0
 v_permlane32_swap_b32 v62, v63
 v_mfma_f32_16x16x32_bf16 v[72:75], v[150:153], v[142:145], v[72:75]
 v_add_f32 v62, v62, v63
 v_mov_b32 v63, v62
 ds_write_b128 v11, v[64:67] offset:0
 s_nop 0
 v_permlane16_swap_b32 v62, v63
 v_add_f32 v62, v62, v63
 v_rcp_f32 v62, v62
 ds_write_b128 v11, v[68:71] offset:1024
 s_mov_b64 exec, 0xff
 ds_write_b32 v22, v62
 s_mov_b64 exec, -1
 ds_write_b128 v11, v[72:75] offset:2048
 s_waitcnt lgkmcnt(0)
 s_barrier
 ds_read_b128 v[72:75], v23
 ds_read_b64 v[64:65], v12 offset:0
 ds_read_b64 v[66:67], v12 offset:3072
 ds_read_b64 v[68:69], v12 offset:6144
 ds_read_b64 v[70:71], v12 offset:9216
 s_waitcnt lgkmcnt(2)
 v_pk_mul_f32 v[64:65], v[64:65], v[72:73] op_sel_hi:[1,0]
 v_pk_fma_f32 v[64:65], v[66:67], v[72:73], v[64:65] op_sel:[0,1,0] op_sel_hi:[1,1,1]
 s_waitcnt lgkmcnt(0)
 v_pk_fma_f32 v[64:65], v[68:69], v[74:75], v[64:65] op_sel_hi:[1,0,1]
 v_pk_fma_f32 v[64:65], v[70:71], v[74:75], v[64:65] op_sel:[0,1,0] op_sel_hi:[1,1,1]
 v_cvt_pk_f16_f32 v68, v64, v65
 v_perm_b32 v68, s91, v68, v14
 buffer_atomic_pk_add_f16 v68, v13, s[4:7], s3 offen
 v_mov_b32 v76, v108
 v_mov_b32 v77, v109
 v_mov_b32 v78, v110
 v_mov_b32 v79, v111
 v_permlane32_swap_b32 v100, v104
 v_permlane32_swap_b32 v101, v105
 v_permlane32_swap_b32 v102, v106
 v_permlane32_swap_b32 v103, v107
 v_permlane32_swap_b32 v108, v76
 v_permlane32_swap_b32 v109, v77
 v_permlane32_swap_b32 v110, v78
 v_permlane32_swap_b32 v111, v79
 v_pk_add_f32 v[100:101], v[100:101], v[104:105]
 v_pk_add_f32 v[102:103], v[102:103], v[106:107]
 v_pk_add_f32 v[108:109], v[108:109], v[76:77]
 v_pk_add_f32 v[110:111], v[110:111], v[78:79]
 v_cvt_pk_bf16_f32 v80, v100, v101
 v_cvt_pk_bf16_f32 v82, v108, v109
 v_cvt_pk_bf16_f32 v81, v102, v103
 v_cvt_pk_bf16_f32 v83, v110, v111
 s_nop 0
 v_permlane16_swap_b32 v80, v82
 v_permlane16_swap_b32 v81, v83
 v_min_u32 v80, -2, v80
 s_mov_b64 exec, s[76:77]
 buffer_store_dwordx4 v[80:83], v15, s[24:27], s57 offen sc1
 s_mov_b64 exec, -1
 s_add_u32 s64, s64, 1310720
 s_add_u32 s52, s52, 1
 s_branch step_20
fl_25:
 buffer_load_dword v0, off, s[12:15], s79 sc1
 s_branch fl_26
A1_15:
 v_smfmac_f32_16x16x32_f16 v[40:43], v[36:37], a[16:19], v25
 v_smfmac_f32_16x16x32_f16 v[52:55], v[36:37], a[76:79], v25
 v_smfmac_f32_16x16x32_f16 v[44:47], v[36:37], a[36:39], v25
 v_smfmac_f32_16x16x32_f16 v[56:59], v[36:37], a[96:99], v25
 s_branch A2_24
pm_23:
 buffer_load_dwordx4 v[36:39], v4, s[4:7], s84 offen offset:2048 sc1
 buffer_load_dwordx4 v[28:31], v4, s[4:7], s84 offen offset:0 sc1
 buffer_load_dwordx4 v[32:35], v4, s[4:7], s84 offen offset:1024 sc1
 s_nop 7
 v_mov_b32 v40, 0
 v_mov_b32 v41, 0
 v_mov_b32 v42, 0
 v_mov_b32 v43, 0
 v_mov_b32 v52, 0
 v_mov_b32 v53, 0
 v_mov_b32 v54, 0
 v_mov_b32 v55, 0
 v_mov_b32 v44, 0
 v_mov_b32 v45, 0
 v_mov_b32 v46, 0
 v_mov_b32 v47, 0
 v_mov_b32 v56, 0
 v_mov_b32 v57, 0
 v_mov_b32 v58, 0
 v_mov_b32 v59, 0
 s_waitcnt vmcnt(0)
 v_bitop3_b32 v27, v31, v35, v39 bitop3:0x80
 v_perm_b32 v31, v35, v31, s89
 v_cmp_gt_u32 vcc, 0x48000000, v27
 v_mov_b32 v35, v38
 s_cbranch_vccz A1_15
pm_22:
 s_cmp_gt_u32 s52, 3
 s_cbranch_scc1 op_33
 v_readfirstlane_b32 s21, v0
 s_cmp_ge_u32 s21, s46
 s_cbranch_scc1 op_33
 buffer_load_dword v0, off, s[12:15], s79 sc1
 s_waitcnt vmcnt(0)
 v_readfirstlane_b32 s21, v0
 s_cmp_gt_u32 s21, s52
 s_cselect_b32 s21, s87, 0
 s_cmp_eq_u32 s21, 0
 s_cbranch_scc1 op_33
 s_mov_b32 s87, 0
 s_sub_u32 s21, s64, 1310720
 buffer_load_dwordx4 v[126:129], v16, s[28:31], s21 offen offset:0 sc1
 buffer_load_dwordx4 v[130:133], v16, s[28:31], s21 offen offset:1024 sc1
 buffer_load_dwordx4 v[134:137], v16, s[28:31], s21 offen offset:2048 sc1
op_33:
 buffer_load_dwordx4 v[36:39], v4, s[4:7], s84 offen offset:2048 sc1
 buffer_load_dwordx4 v[28:31], v4, s[4:7], s84 offen offset:0 sc1
 buffer_load_dwordx4 v[32:35], v4, s[4:7], s84 offen offset:1024 sc1
 s_add_u32 s54, s54, 1
 s_cmp_gt_u32 s54, 131072
 s_cbranch_scc1 end0
 s_waitcnt vmcnt(0)
 v_bitop3_b32 v27, v31, v35, v39 bitop3:0x80
 v_perm_b32 v31, v35, v31, s89
 v_cmp_gt_u32 vcc, 0x48000000, v27
 v_mov_b32 v35, v38
 s_cbranch_vccnz pm_22
 s_branch A1_15
psr_27:
 buffer_load_dwordx2 v[58:59], v9, s[8:11], s81 offen sc1
 buffer_load_dwordx4 v[40:43], v8, s[8:11], s81 offen offset:0 sc1
 buffer_load_dwordx4 v[44:47], v8, s[8:11], s81 offen offset:1024 sc1
 s_add_u32 s54, s54, 1
 s_cmp_gt_u32 s54, 131072
 s_cbranch_scc1 end0
 s_waitcnt vmcnt(2)
 v_xor_b32 v76, s88, v58
 s_nop 0
 v_permlane16_swap_b32 v58, v59
 v_fma_mix_f32 v60, v58, 1.0, v59 op_sel:[0,0,0] op_sel_hi:[1,0,1]
 v_fma_mix_f32 v61, v58, 1.0, v59 op_sel:[1,0,1] op_sel_hi:[1,0,1]
 v_mov_b32 v58, v60
 v_mov_b32 v59, v61
 s_nop 0
 v_permlane32_swap_b32 v58, v60
 v_permlane32_swap_b32 v59, v61
 v_add_f32 v52, v58, v60
 v_add_f32 v53, v59, v61
 v_max_f32 v79, v52, v53
 s_waitcnt vmcnt(0)
 v_pk_add_f16 v80, v40, v44
 v_pk_add_f16 v82, v42, v46
 v_pk_add_f16 v81, v41, v45
 v_pk_add_f16 v83, v43, v47
 v_permlane32_swap_b32 v80, v82
 v_bitop3_b32 v77, v40, v42, s88 bitop3:0x7e
 v_permlane32_swap_b32 v81, v83
 v_bitop3_b32 v78, v44, v46, s88 bitop3:0x7e
 v_fma_mix_f32 v48, v80, 1.0, v82 op_sel:[0,0,0] op_sel_hi:[1,0,1]
 v_or3_b32 v27, v76, v77, v78
 v_fma_mix_f32 v49, v80, 1.0, v82 op_sel:[1,0,1] op_sel_hi:[1,0,1]
 v_and_b32 v27, 1, v27
 v_fma_mix_f32 v50, v81, 1.0, v83 op_sel:[0,0,0] op_sel_hi:[1,0,1]
 v_cmp_ne_u32 vcc, 0, v27
 v_fma_mix_f32 v51, v81, 1.0, v83 op_sel:[1,0,1] op_sel_hi:[1,0,1]
 v_max3_f32 v62, v48, v49, v79
 s_cbranch_vccnz psr_27
 s_branch psj_28
kvw_29:
 s_mov_b32 s22, s87
 s_cmp_eq_u32 s52, 0
 s_cselect_b32 s55, 0, s55
 s_cselect_b32 s87, 1, 0
 s_cbranch_scc1 kvok_30
 v_mov_b32 v62, 0
 s_mov_b32 s101, 0
wf_34:
 buffer_load_dword v63, v62, s[12:15], s79 offen sc1
 s_add_u32 s101, s101, 1
 s_cmp_gt_u32 s101, 131072
 s_cbranch_scc1 end0
 s_waitcnt vmcnt(0)
 v_readfirstlane_b32 s100, v63
 s_cmp_ge_u32 s100, s46
 s_cbranch_scc1 wf_35
 s_sleep 3
 s_branch wf_34
wf_35:
 s_cmp_eq_u32 s22, 0
 s_cbranch_scc1 kvok_30
 s_sub_u32 s21, s64, 1310720
 buffer_load_dwordx4 v[126:129], v16, s[28:31], s21 offen offset:0 sc1
 buffer_load_dwordx4 v[130:133], v16, s[28:31], s21 offen offset:1024 sc1
 buffer_load_dwordx4 v[134:137], v16, s[28:31], s21 offen offset:2048 sc1
 s_waitcnt vmcnt(0)
 s_branch kvok_30
fl_31:
 buffer_load_dword v0, off, s[12:15], s79 sc1
 s_branch fl_32
last_21:
 s_waitcnt lgkmcnt(10)
 v_smfmac_f32_16x16x64_f16 v[100:103], v[28:31], a[120:127], v25
 v_smfmac_f32_16x16x64_f16 v[104:107], v[28:31], a[128:135], v25
 v_smfmac_f32_16x16x64_f16 v[108:111], v[28:31], a[136:143], v25
 v_smfmac_f32_16x16x64_f16 v[100:103], v[32:35], a[144:151], v25
 v_smfmac_f32_16x16x64_f16 v[104:107], v[32:35], a[152:159], v25
 v_smfmac_f32_16x16x64_f16 v[108:111], v[32:35], a[160:167], v25
 s_waitcnt lgkmcnt(7)
 v_smfmac_f32_16x16x64_f16 v[100:103], v[64:67], a[168:175], v25
 v_smfmac_f32_16x16x64_f16 v[104:107], v[64:67], a[176:183], v25
 v_smfmac_f32_16x16x64_f16 v[108:111], v[64:67], a[184:191], v25
 v_smfmac_f32_16x16x64_f16 v[100:103], v[68:71], a[192:199], v25
 v_smfmac_f32_16x16x64_f16 v[104:107], v[68:71], a[200:207], v25
 v_smfmac_f32_16x16x64_f16 v[108:111], v[68:71], a[208:215], v25
 v_smfmac_f32_16x16x64_f16 v[100:103], v[72:75], a[216:223], v25
 v_smfmac_f32_16x16x64_f16 v[104:107], v[72:75], a[224:231], v25
 v_smfmac_f32_16x16x64_f16 v[108:111], v[72:75], a[232:239], v25
 s_waitcnt lgkmcnt(4)
 v_smfmac_f32_16x16x64_f16 v[100:103], v[76:79], a[240:247], v25
 v_smfmac_f32_16x16x64_f16 v[104:107], v[76:79], a[248:255], v25
 v_smfmac_f32_16x16x64_f16 v[108:111], v[76:79], v[152:159], v25
 v_smfmac_f32_16x16x64_f16 v[100:103], v[80:83], v[160:167], v25
 v_smfmac_f32_16x16x64_f16 v[104:107], v[80:83], v[168:175], v25
 v_smfmac_f32_16x16x64_f16 v[108:111], v[80:83], v[176:183], v25
 v_smfmac_f32_16x16x64_f16 v[100:103], v[84:87], v[184:191], v25
 v_smfmac_f32_16x16x64_f16 v[104:107], v[84:87], v[192:199], v25
 v_smfmac_f32_16x16x64_f16 v[108:111], v[84:87], v[200:207], v25
 s_waitcnt lgkmcnt(0)
 v_smfmac_f32_16x16x64_f16 v[100:103], v[88:91], v[208:215], v25
 v_smfmac_f32_16x16x64_f16 v[104:107], v[88:91], v[216:223], v25
 v_smfmac_f32_16x16x64_f16 v[108:111], v[88:91], v[224:231], v25
 v_smfmac_f32_16x16x64_f16 v[100:103], v[92:95], v[232:239], v25
 v_smfmac_f32_16x16x64_f16 v[104:107], v[92:95], v[240:247], v25
 v_smfmac_f32_16x16x64_f16 v[108:111], v[92:95], v[248:255], v25
 s_nop 7
 v_mov_b32 v76, v108
 v_mov_b32 v77, v109
 v_mov_b32 v78, v110
 v_mov_b32 v79, v111
 v_permlane32_swap_b32 v100, v104
 v_permlane32_swap_b32 v101, v105
 v_permlane32_swap_b32 v102, v106
 v_permlane32_swap_b32 v103, v107
 v_permlane32_swap_b32 v108, v76
 v_permlane32_swap_b32 v109, v77
 v_permlane32_swap_b32 v110, v78
 v_permlane32_swap_b32 v111, v79
 v_pk_add_f32 v[100:101], v[100:101], v[104:105]
 v_pk_add_f32 v[102:103], v[102:103], v[106:107]
 v_pk_add_f32 v[108:109], v[108:109], v[76:77]
 v_pk_add_f32 v[110:111], v[110:111], v[78:79]
 v_cvt_pk_bf16_f32 v80, v100, v101
 v_cvt_pk_bf16_f32 v82, v108, v109
 v_cvt_pk_bf16_f32 v81, v102, v103
 v_cvt_pk_bf16_f32 v83, v110, v111
 s_nop 0
 v_permlane16_swap_b32 v80, v82
 v_permlane16_swap_b32 v81, v83
 v_min_u32 v80, -2, v80
 s_mov_b64 exec, s[76:77]
 buffer_store_dwordx4 v[80:83], v15, s[24:27], s57 offen sc1
 s_mov_b64 exec, -1
 v_mov_b32 v246, 80
 v_mov_b32 v247, 1
 s_mov_b64 exec, 1
 buffer_atomic_add v247, v246, s[32:35], 0 offen sc0 sc1
 s_mov_b64 exec, -1
 s_branch chain_done
step_36:
 s_and_b32 s21, s52, 3
 s_mul_i32 s81, s21, 540672
 s_mul_i32 s84, s21, 0x88000
 s_and_b32 s84, s84, 0x108000
 s_add_u32 s21, s52, 3
 s_and_b32 s21, s21, 3
 s_mul_i32 s83, s21, 0x88000
 s_and_b32 s83, s83, 0x108000
 s_add_u32 s21, s52, 1
 s_and_b32 s22, s21, 3
 s_mul_i32 s3, s22, 0x88000
 s_and_b32 s3, s3, 0x108000
 s_mul_i32 s80, s21, 393216
 s_add_u32 s46, s21, 1
 s_min_u32 s46, s46, 64
 s_mov_b32 s47, s57
 s_lshr_b32 s21, s52, 1
 s_bitcmp1_b32 s37, s21
 s_cselect_b32 s21, 8192, 0
 s_lshl_b32 s22, s52, 20
 s_or_b32 s22, s22, s21
 s_cmp_ge_u32 s52, 40
 s_cselect_b32 s57, 8192, 0
 s_xor_b32 s57, s57, s22
 s_xor_b32 s85, s22, 8192
 s_bfe_u32 s88, s52, 0x10002
 s_max_u32 s67, s52, 1
 s_sub_u32 s67, s67, 1
 v_mov_b32 v40, 0
 v_mov_b32 v41, 0
 v_mov_b32 v42, 0
 v_mov_b32 v43, 0
 v_mov_b32 v44, 0
 v_mov_b32 v45, 0
 v_mov_b32 v46, 0
 v_mov_b32 v47, 0
 v_mov_b32 v48, 0
 v_mov_b32 v49, 0
 v_mov_b32 v50, 0
 v_mov_b32 v51, 0
 v_mov_b32 v52, 0
 v_mov_b32 v53, 0
 v_mov_b32 v54, 0
 v_mov_b32 v55, 0
 v_mov_b32 v56, 0
 v_mov_b32 v57, 0
 v_mov_b32 v58, 0
 v_mov_b32 v59, 0
 v_mov_b32 v60, 0
 v_mov_b32 v61, 0
 v_mov_b32 v62, 0
 v_mov_b32 v63, 0
 v_mov_b32 v100, 0
 v_mov_b32 v101, 0
 v_mov_b32 v102, 0
 v_mov_b32 v103, 0
 v_mov_b32 v104, 0
 v_mov_b32 v105, 0
 v_mov_b32 v106, 0
 v_mov_b32 v107, 0
 v_mov_b32 v108, 0
 v_mov_b32 v109, 0
 v_mov_b32 v110, 0
 v_mov_b32 v111, 0
 s_sleep 5
 v_readfirstlane_b32 s21, v0
 s_cmp_lt_u32 s21, s46
 s_cselect_b32 s55, s55, 0
 s_cmp_lt_i32 s55, 0
 s_cbranch_scc1 fl_41
fl_42:
 s_mov_b32 s54, 0
 buffer_load_dwordx4 v[36:39], v4, s[4:7], s84 offen offset:2048 sc1
 buffer_load_dwordx4 v[28:31], v4, s[4:7], s84 offen offset:0 sc1
 buffer_load_dwordx4 v[32:35], v4, s[4:7], s84 offen offset:1024 sc1
 s_waitcnt vmcnt(3)
 v_mov_b32 v126, v88
 v_mov_b32 v127, v89
 v_mov_b32 v128, v90
 v_mov_b32 v129, v91
 v_mov_b32 v130, v92
 v_mov_b32 v131, v93
 v_mov_b32 v132, v94
 v_mov_b32 v133, v95
 v_mov_b32 v134, v96
 v_mov_b32 v135, v97
 v_mov_b32 v136, v98
 v_mov_b32 v137, v99
 s_waitcnt vmcnt(2)
 v_smfmac_f32_16x16x32_f16 v[40:43], v[36:37], a[16:19], v25
 v_smfmac_f32_16x16x32_f16 v[52:55], v[36:37], a[76:79], v25
 v_smfmac_f32_16x16x32_f16 v[44:47], v[36:37], a[36:39], v25
 s_waitcnt vmcnt(0)
 v_bitop3_b32 v27, v31, v35, v39 bitop3:0x80
 v_perm_b32 v31, v35, v31, s89
 v_cmp_gt_u32 vcc, 0x48000000, v27
 v_mov_b32 v35, v38
 v_smfmac_f32_16x16x32_f16 v[56:59], v[36:37], a[96:99], v25
 s_cbranch_vccnz pm_39
A2_40:
 v_smfmac_f32_16x16x64_f16 v[40:43], v[28:31], a[0:7], v25
 ds_write_b128 v10, v[28:31]
 v_smfmac_f32_16x16x64_f16 v[40:43], v[32:35], a[8:15], v25
 ds_write_b128 v10, v[32:35] offset:1024
 v_smfmac_f32_16x16x64_f16 v[52:55], v[28:31], a[60:67], v25
 ds_write_b64 v10, v[36:37] offset:2048
 v_smfmac_f32_16x16x64_f16 v[52:55], v[32:35], a[68:75], v25
 v_cvt_pk_f16_f32 v40, v40, v41
 v_cvt_pk_f16_f32 v41, v42, v43
 v_smfmac_f32_16x16x32_f16 v[48:51], v[36:37], a[56:59], v25
 v_smfmac_f32_16x16x32_f16 v[60:63], v[36:37], a[116:119], v25
 v_smfmac_f32_16x16x64_f16 v[44:47], v[28:31], a[20:27], v25
 v_cvt_pk_f16_f32 v52, v52, v53
 v_cvt_pk_f16_f32 v53, v54, v55
 s_nop 0
 v_smfmac_f32_16x16x64_f16 v[44:47], v[32:35], a[28:35], v25
 v_permlane32_swap_b32 v40, v52
 v_smfmac_f32_16x16x64_f16 v[56:59], v[28:31], a[80:87], v25
 v_permlane32_swap_b32 v41, v53
 v_pk_add_f16 v40, v40, v52
 v_smfmac_f32_16x16x64_f16 v[56:59], v[32:35], a[88:95], v25
 v_pk_add_f16 v41, v41, v53
 v_smfmac_f32_16x16x64_f16 v[48:51], v[28:31], a[40:47], v25
 ds_write_b64 v5, v[40:41] offset:0
 v_smfmac_f32_16x16x64_f16 v[48:51], v[32:35], a[48:55], v25
 v_cvt_pk_f16_f32 v44, v44, v45
 v_cvt_pk_f16_f32 v45, v46, v47
 v_cvt_pk_f16_f32 v56, v56, v57
 v_smfmac_f32_16x16x64_f16 v[60:63], v[28:31], a[100:107], v25
 v_cvt_pk_f16_f32 v57, v58, v59
 s_nop 0
 v_smfmac_f32_16x16x64_f16 v[60:63], v[32:35], a[108:115], v25
 v_permlane32_swap_b32 v44, v56
 v_permlane32_swap_b32 v45, v57
 v_pk_add_f16 v44, v44, v56
 v_pk_add_f16 v45, v45, v57
 ds_write_b64 v5, v[44:45] offset:640
 v_cvt_pk_f16_f32 v48, v48, v49
 v_cvt_pk_f16_f32 v49, v50, v51
 v_cvt_pk_f16_f32 v60, v60, v61
 v_cvt_pk_f16_f32 v61, v62, v63
 s_nop 0
 v_permlane32_swap_b32 v48, v60
 v_permlane32_swap_b32 v49, v61
 v_pk_add_f16 v48, v48, v60
 v_pk_add_f16 v49, v49, v61
 ds_write_b64 v5, v[48:49] offset:1280
 s_waitcnt lgkmcnt(0) vmcnt(0)
 s_barrier
 ds_read_b64_tr_b16 v[40:41], v21 offset:0
 ds_read_b64_tr_b16 v[42:43], v21 offset:1920
 ds_read_b64_tr_b16 v[44:45], v21 offset:640
 ds_read_b64_tr_b16 v[46:47], v21 offset:2560
 ds_read_b64_tr_b16 v[48:49], v21 offset:1280
 ds_read_b64_tr_b16 v[50:51], v21 offset:3200
 s_waitcnt lgkmcnt(4)
 v_fma_mix_f32 v52, v40, 1.0, v42 op_sel:[0,0,0] op_sel_hi:[1,0,1]
 v_fma_mix_f32 v53, v40, 1.0, v42 op_sel:[1,0,1] op_sel_hi:[1,0,1]
 v_fma_mix_f32 v54, v41, 1.0, v43 op_sel:[0,0,0] op_sel_hi:[1,0,1]
 v_fma_mix_f32 v55, v41, 1.0, v43 op_sel:[1,0,1] op_sel_hi:[1,0,1]
 v_add_f32_dpp v56, v52, v52 row_ror:8 row_mask:0xf bank_mask:0xf
 v_add_f32_dpp v57, v53, v53 row_ror:8 row_mask:0xf bank_mask:0xf
 v_add_f32_dpp v58, v54, v54 row_ror:8 row_mask:0xf bank_mask:0xf
 v_add_f32_dpp v59, v55, v55 row_ror:8 row_mask:0xf bank_mask:0xf
 v_cvt_pk_bf16_f32 v118, v56, v57
 v_cvt_pk_bf16_f32 v119, v58, v59
 s_waitcnt lgkmcnt(2)
 v_fma_mix_f32 v52, v44, 1.0, v46 op_sel:[0,0,0] op_sel_hi:[1,0,1]
 v_fma_mix_f32 v53, v44, 1.0, v46 op_sel:[1,0,1] op_sel_hi:[1,0,1]
 v_fma_mix_f32 v54, v45, 1.0, v47 op_sel:[0,0,0] op_sel_hi:[1,0,1]
 v_fma_mix_f32 v55, v45, 1.0, v47 op_sel:[1,0,1] op_sel_hi:[1,0,1]
 v_add_f32_dpp v56, v52, v52 row_ror:8 row_mask:0xf bank_mask:0xf
 v_add_f32_dpp v57, v53, v53 row_ror:8 row_mask:0xf bank_mask:0xf
 v_add_f32_dpp v58, v54, v54 row_ror:8 row_mask:0xf bank_mask:0xf
 v_add_f32_dpp v59, v55, v55 row_ror:8 row_mask:0xf bank_mask:0xf
 v_cvt_pk_bf16_f32 v120, v56, v57
 v_cvt_pk_bf16_f32 v121, v58, v59
 s_waitcnt lgkmcnt(0)
 v_fma_mix_f32 v52, v48, 1.0, v50 op_sel:[0,0,0] op_sel_hi:[1,0,1]
 v_fma_mix_f32 v53, v48, 1.0, v50 op_sel:[1,0,1] op_sel_hi:[1,0,1]
 v_fma_mix_f32 v54, v49, 1.0, v51 op_sel:[0,0,0] op_sel_hi:[1,0,1]
 v_fma_mix_f32 v55, v49, 1.0, v51 op_sel:[1,0,1] op_sel_hi:[1,0,1]
 v_mfma_f32_16x16x32_bf16 v[40:43], v[112:115], v[118:121], 0
 v_add_f32_dpp v56, v52, v52 row_ror:8 row_mask:0xf bank_mask:0xf
 v_add_f32_dpp v57, v53, v53 row_ror:8 row_mask:0xf bank_mask:0xf
 v_add_f32_dpp v58, v54, v54 row_ror:8 row_mask:0xf bank_mask:0xf
 v_add_f32_dpp v59, v55, v55 row_ror:8 row_mask:0xf bank_mask:0xf
 v_cvt_pk_bf16_f32 v122, v56, v57
 v_cvt_pk_bf16_f32 v123, v58, v59
 s_nop 1
 v_mfma_f32_16x16x32_bf16 v[40:43], v[116:119], v[122:125], v[40:43]
 ds_read_b128 v[28:31], v16 offset:24576
 ds_read_b128 v[32:35], v16 offset:25600
 ds_read_b128 v[64:67], v16 offset:27648
 ds_read_b128 v[68:71], v16 offset:28672
 ds_read_b128 v[72:75], v16 offset:30720
 ds_read_b128 v[76:79], v16 offset:31744
 s_nop 0
 s_mov_b64 exec, s[74:75]
 v_cvt_pk_f16_f32 v44, v40, v41
 v_cvt_pk_f16_f32 v45, v42, v43
 v_and_or_b32 v44, v44, -2, s88
 buffer_store_dwordx2 v[44:45], v7, s[8:11], s81 offen
 s_mov_b64 exec, -1
 ds_read_b128 v[80:83], v16 offset:33792
 ds_read_b128 v[84:87], v16 offset:34816
 ds_read_b64 v[88:89], v16 offset:26624
 ds_read_b64 v[90:91], v16 offset:29696
 ds_read_b64 v[92:93], v16 offset:32768
 ds_read_b64 v[94:95], v16 offset:35840
 s_cmp_eq_u32 s52, 63
 s_cbranch_scc1 last_37
 s_waitcnt lgkmcnt(10)
 v_smfmac_f32_16x16x64_f16 v[100:103], v[28:31], a[120:127], v25
 v_smfmac_f32_16x16x64_f16 v[104:107], v[28:31], a[128:135], v25
 v_smfmac_f32_16x16x64_f16 v[108:111], v[28:31], a[136:143], v25
 s_mov_b32 s54, 0
 v_smfmac_f32_16x16x64_f16 v[100:103], v[32:35], a[144:151], v25
 v_readfirstlane_b32 s21, v0
 v_smfmac_f32_16x16x64_f16 v[104:107], v[32:35], a[152:159], v25
 s_add_u32 s22, s46, 3
 v_smfmac_f32_16x16x64_f16 v[108:111], v[32:35], a[160:167], v25
 s_min_u32 s22, s22, 64
 s_waitcnt lgkmcnt(7)
 v_smfmac_f32_16x16x64_f16 v[100:103], v[64:67], a[168:175], v25
 s_sub_u32 s55, s21, s22
 v_smfmac_f32_16x16x64_f16 v[104:107], v[64:67], a[176:183], v25
 s_sub_u32 s56, s21, s46
 v_smfmac_f32_16x16x64_f16 v[108:111], v[64:67], a[184:191], v25
 v_smfmac_f32_16x16x64_f16 v[100:103], v[68:71], a[192:199], v25
 v_smfmac_f32_16x16x64_f16 v[104:107], v[68:71], a[200:207], v25
 v_smfmac_f32_16x16x64_f16 v[108:111], v[68:71], a[208:215], v25
 v_smfmac_f32_16x16x64_f16 v[100:103], v[72:75], a[216:223], v25
 v_smfmac_f32_16x16x64_f16 v[104:107], v[72:75], a[224:231], v25
 v_smfmac_f32_16x16x64_f16 v[108:111], v[72:75], a[232:239], v25
 s_waitcnt lgkmcnt(4)
 v_smfmac_f32_16x16x64_f16 v[100:103], v[76:79], a[240:247], v25
 v_smfmac_f32_16x16x64_f16 v[104:107], v[76:79], a[248:255], v25
 v_smfmac_f32_16x16x64_f16 v[108:111], v[76:79], v[152:159], v25
 v_smfmac_f32_16x16x64_f16 v[100:103], v[80:83], v[160:167], v25
 v_smfmac_f32_16x16x64_f16 v[104:107], v[80:83], v[168:175], v25
 buffer_load_dwordx2 v[58:59], v9, s[8:11], s81 offen sc1
 buffer_load_dwordx4 v[40:43], v8, s[8:11], s81 offen offset:0 sc1
 buffer_load_dwordx4 v[44:47], v8, s[8:11], s81 offen offset:1024 sc1
 v_smfmac_f32_16x16x64_f16 v[108:111], v[80:83], v[176:183], v25
 v_smfmac_f32_16x16x64_f16 v[100:103], v[84:87], v[184:191], v25
 v_smfmac_f32_16x16x64_f16 v[104:107], v[84:87], v[192:199], v25
 v_smfmac_f32_16x16x64_f16 v[108:111], v[84:87], v[200:207], v25
 s_waitcnt lgkmcnt(0)
 v_smfmac_f32_16x16x64_f16 v[100:103], v[88:91], v[208:215], v25
 v_smfmac_f32_16x16x64_f16 v[104:107], v[88:91], v[216:223], v25
 v_smfmac_f32_16x16x64_f16 v[108:111], v[88:91], v[224:231], v25
 v_smfmac_f32_16x16x64_f16 v[100:103], v[92:95], v[232:239], v25
 v_smfmac_f32_16x16x64_f16 v[104:107], v[92:95], v[240:247], v25
 v_smfmac_f32_16x16x64_f16 v[108:111], v[92:95], v[248:255], v25
 s_cmp_lt_i32 s56, 0
 s_cbranch_scc1 kvw_45
kvok_46:
 s_waitcnt vmcnt(2)
 v_xor_b32 v76, s88, v58
 s_nop 0
 v_permlane16_swap_b32 v58, v59
 v_fma_mix_f32 v60, v58, 1.0, v59 op_sel:[0,0,0] op_sel_hi:[1,0,1]
 v_fma_mix_f32 v61, v58, 1.0, v59 op_sel:[1,0,1] op_sel_hi:[1,0,1]
 v_mov_b32 v58, v60
 v_mov_b32 v59, v61
 s_nop 0
 v_permlane32_swap_b32 v58, v60
 v_permlane32_swap_b32 v59, v61
 v_add_f32 v52, v58, v60
 v_add_f32 v53, v59, v61
 v_max_f32 v79, v52, v53
 s_waitcnt vmcnt(0)
 v_pk_add_f16 v80, v40, v44
 v_pk_add_f16 v82, v42, v46
 v_pk_add_f16 v81, v41, v45
 v_pk_add_f16 v83, v43, v47
 v_permlane32_swap_b32 v80, v82
 v_bitop3_b32 v77, v40, v42, s88 bitop3:0x7e
 v_permlane32_swap_b32 v81, v83
 v_bitop3_b32 v78, v44, v46, s88 bitop3:0x7e
 v_fma_mix_f32 v48, v80, 1.0, v82 op_sel:[0,0,0] op_sel_hi:[1,0,1]
 v_or3_b32 v27, v76, v77, v78
 v_fma_mix_f32 v49, v80, 1.0, v82 op_sel:[1,0,1] op_sel_hi:[1,0,1]
 v_and_b32 v27, 1, v27
 v_fma_mix_f32 v50, v81, 1.0, v83 op_sel:[0,0,0] op_sel_hi:[1,0,1]
 v_cmp_ne_u32 vcc, 0, v27
 v_fma_mix_f32 v51, v81, 1.0, v83 op_sel:[1,0,1] op_sel_hi:[1,0,1]
 v_max3_f32 v62, v48, v49, v79
 s_cbranch_vccnz psr_43
psj_44:
 v_max3_f32 v62, v62, v50, v51
 v_cvt_pk_bf16_f32 v146, v100, v101
 v_cvt_pk_bf16_f32 v147, v102, v103
 v_max_f32_dpp v62, v62, v62 row_ror:8 row_mask:0xf bank_mask:0xf
 v_mov_b32 v63, v62
 v_cvt_pk_bf16_f32 v148, v104, v105
 v_cvt_pk_bf16_f32 v149, v106, v107
 v_permlane32_swap_b32 v62, v63
 v_max_f32 v62, v62, v63
 v_mov_b32 v63, v62
 v_cvt_pk_bf16_f32 v150, v108, v109
 v_cvt_pk_bf16_f32 v151, v110, v111
 v_permlane16_swap_b32 v62, v63
 v_max_f32 v62, v62, v63
 v_mul_f32 v62, s86, v62
 v_fma_f32 v48, v48, s86, -v62
 v_fma_f32 v49, v49, s86, -v62
 v_fma_f32 v50, v50, s86, -v62
 v_fma_f32 v51, v51, s86, -v62
 v_fma_f32 v52, v52, s86, -v62
 v_fma_f32 v53, v53, s86, -v62
 v_exp_f32 v48, v48
 v_exp_f32 v49, v49
 buffer_load_dwordx4 v[88:91], v17, s[28:31], s64 offen offset:0 sc1
 v_exp_f32 v50, v50
 v_exp_f32 v51, v51
 buffer_load_dwordx4 v[92:95], v16, s[28:31], s64 offen offset:1024 sc1
 v_exp_f32 v52, v52
 v_exp_f32 v53, v53
 buffer_load_dwordx4 v[96:99], v20, s[28:31], s64 offen offset:2048 sc1
 v_cvt_pk_bf16_f32 v138, v48, v49
 v_cvt_pk_bf16_f32 v139, v50, v51
 v_cvt_pk_bf16_f32 v142, v52, v53
 v_mov_b32_dpp v140, v138 row_ror:8 row_mask:0xf bank_mask:0xf
 v_mov_b32_dpp v141, v139 row_ror:8 row_mask:0xf bank_mask:0xf
 v_mov_b32_dpp v143, v142 row_ror:8 row_mask:0xf bank_mask:0xf
 buffer_load_dwordx4 v[112:115], v18, s[16:19], s80 offen sc1
 v_add_f32 v54, v48, v49
 v_mfma_f32_16x16x32_bf16 v[64:67], v[126:129], v[138:141], 0
 v_add_f32 v55, v50, v51
 v_add_f32 v56, v52, v53
 v_mfma_f32_16x16x32_bf16 v[64:67], v[146:149], v[142:145], v[64:67]
 v_add_f32 v62, v54, v55
 v_fmac_f32 v62, v56, v26
 v_mfma_f32_16x16x32_bf16 v[68:71], v[130:133], v[138:141], 0
 buffer_load_dwordx2 v[116:117], v19, s[16:19], s80 offen sc1
 v_add_f32_dpp v62, v62, v62 row_ror:8 row_mask:0xf bank_mask:0xf
 v_mfma_f32_16x16x32_bf16 v[68:71], v[148:151], v[142:145], v[68:71]
 v_mov_b32 v63, v62
 s_cmp_lt_i32 s55, 0
 s_cbranch_scc1 fl_47
fl_48:
 v_mfma_f32_16x16x32_bf16 v[72:75], v[134:137], v[138:141], 0
 v_permlane32_swap_b32 v62, v63
 v_mfma_f32_16x16x32_bf16 v[72:75], v[150:153], v[142:145], v[72:75]
 v_add_f32 v62, v62, v63
 v_mov_b32 v63, v62
 ds_write_b128 v11, v[64:67] offset:0
 s_nop 0
 v_permlane16_swap_b32 v62, v63
 v_add_f32 v62, v62, v63
 v_rcp_f32 v62, v62
 ds_write_b128 v11, v[68:71] offset:1024
 s_mov_b64 exec, 0xff
 ds_write_b32 v22, v62
 s_mov_b64 exec, -1
 ds_write_b128 v11, v[72:75] offset:2048
 s_waitcnt lgkmcnt(0)
 s_barrier
 ds_read_b128 v[72:75], v23
 ds_read_b64 v[64:65], v12 offset:0
 ds_read_b64 v[66:67], v12 offset:3072
 ds_read_b64 v[68:69], v12 offset:6144
 ds_read_b64 v[70:71], v12 offset:9216
 s_waitcnt lgkmcnt(2)
 v_pk_mul_f32 v[64:65], v[64:65], v[72:73] op_sel_hi:[1,0]
 v_pk_fma_f32 v[64:65], v[66:67], v[72:73], v[64:65] op_sel:[0,1,0] op_sel_hi:[1,1,1]
 s_waitcnt lgkmcnt(0)
 v_pk_fma_f32 v[64:65], v[68:69], v[74:75], v[64:65] op_sel_hi:[1,0,1]
 v_pk_fma_f32 v[64:65], v[70:71], v[74:75], v[64:65] op_sel:[0,1,0] op_sel_hi:[1,1,1]
 v_cvt_pk_f16_f32 v68, v64, v65
 v_perm_b32 v68, s91, v68, v14
 buffer_atomic_pk_add_f16 v68, v13, s[4:7], s3 offen
 v_mov_b32 v76, v108
 v_mov_b32 v77, v109
 v_mov_b32 v78, v110
 v_mov_b32 v79, v111
 v_permlane32_swap_b32 v100, v104
 v_permlane32_swap_b32 v101, v105
 v_permlane32_swap_b32 v102, v106
 v_permlane32_swap_b32 v103, v107
 v_permlane32_swap_b32 v108, v76
 v_permlane32_swap_b32 v109, v77
 v_permlane32_swap_b32 v110, v78
 v_permlane32_swap_b32 v111, v79
 v_pk_add_f32 v[100:101], v[100:101], v[104:105]
 v_pk_add_f32 v[102:103], v[102:103], v[106:107]
 v_pk_add_f32 v[108:109], v[108:109], v[76:77]
 v_pk_add_f32 v[110:111], v[110:111], v[78:79]
 v_cvt_pk_bf16_f32 v80, v100, v101
 v_cvt_pk_bf16_f32 v82, v108, v109
 v_cvt_pk_bf16_f32 v81, v102, v103
 v_cvt_pk_bf16_f32 v83, v110, v111
 s_nop 0
 v_permlane16_swap_b32 v80, v82
 v_permlane16_swap_b32 v81, v83
 v_min_u32 v80, -2, v80
 s_mov_b64 exec, s[76:77]
 buffer_store_dwordx4 v[80:83], v15, s[24:27], s57 offen sc1
 s_mov_b64 exec, -1
 s_add_u32 s64, s64, 1310720
 s_add_u32 s52, s52, 1
 s_branch step_36
fl_41:
 buffer_load_dword v0, off, s[12:15], s79 sc1
 s_branch fl_42
A1_16:
 v_smfmac_f32_16x16x32_f16 v[40:43], v[36:37], a[16:19], v25
 v_smfmac_f32_16x16x32_f16 v[52:55], v[36:37], a[76:79], v25
 v_smfmac_f32_16x16x32_f16 v[44:47], v[36:37], a[36:39], v25
 v_smfmac_f32_16x16x32_f16 v[56:59], v[36:37], a[96:99], v25
 s_branch A2_40
pm_39:
 buffer_load_dwordx4 v[36:39], v4, s[4:7], s84 offen offset:2048 sc1
 buffer_load_dwordx4 v[28:31], v4, s[4:7], s84 offen offset:0 sc1
 buffer_load_dwordx4 v[32:35], v4, s[4:7], s84 offen offset:1024 sc1
 s_nop 7
 v_mov_b32 v40, 0
 v_mov_b32 v41, 0
 v_mov_b32 v42, 0
 v_mov_b32 v43, 0
 v_mov_b32 v52, 0
 v_mov_b32 v53, 0
 v_mov_b32 v54, 0
 v_mov_b32 v55, 0
 v_mov_b32 v44, 0
 v_mov_b32 v45, 0
 v_mov_b32 v46, 0
 v_mov_b32 v47, 0
 v_mov_b32 v56, 0
 v_mov_b32 v57, 0
 v_mov_b32 v58, 0
 v_mov_b32 v59, 0
 s_waitcnt vmcnt(0)
 v_bitop3_b32 v27, v31, v35, v39 bitop3:0x80
 v_perm_b32 v31, v35, v31, s89
 v_cmp_gt_u32 vcc, 0x48000000, v27
 v_mov_b32 v35, v38
 s_cbranch_vccz A1_16
pm_38:
 s_cmp_gt_u32 s52, 3
 s_cbranch_scc1 op_49
 v_readfirstlane_b32 s21, v0
 s_cmp_ge_u32 s21, s46
 s_cbranch_scc1 op_49
 buffer_load_dword v0, off, s[12:15], s79 sc1
 s_waitcnt vmcnt(0)
 v_readfirstlane_b32 s21, v0
 s_cmp_gt_u32 s21, s52
 s_cselect_b32 s21, s87, 0
 s_cmp_eq_u32 s21, 0
 s_cbranch_scc1 op_49
 s_mov_b32 s87, 0
 s_sub_u32 s21, s64, 1310720
 buffer_load_dwordx4 v[126:129], v16, s[28:31], s21 offen offset:0 sc1
 buffer_load_dwordx4 v[130:133], v16, s[28:31], s21 offen offset:1024 sc1
 buffer_load_dwordx4 v[134:137], v16, s[28:31], s21 offen offset:2048 sc1
op_49:
 buffer_load_dwordx4 v[36:39], v4, s[4:7], s84 offen offset:2048 sc1
 buffer_load_dwordx4 v[28:31], v4, s[4:7], s84 offen offset:0 sc1
 buffer_load_dwordx4 v[32:35], v4, s[4:7], s84 offen offset:1024 sc1
 s_add_u32 s54, s54, 1
 s_cmp_gt_u32 s54, 131072
 s_cbranch_scc1 end0
 s_waitcnt vmcnt(0)
 v_bitop3_b32 v27, v31, v35, v39 bitop3:0x80
 v_perm_b32 v31, v35, v31, s89
 v_cmp_gt_u32 vcc, 0x48000000, v27
 v_mov_b32 v35, v38
 s_cbranch_vccnz pm_38
 s_branch A1_16
psr_43:
 buffer_load_dwordx2 v[58:59], v9, s[8:11], s81 offen sc1
 buffer_load_dwordx4 v[40:43], v8, s[8:11], s81 offen offset:0 sc1
 buffer_load_dwordx4 v[44:47], v8, s[8:11], s81 offen offset:1024 sc1
 s_add_u32 s54, s54, 1
 s_cmp_gt_u32 s54, 131072
 s_cbranch_scc1 end0
 s_waitcnt vmcnt(2)
 v_xor_b32 v76, s88, v58
 s_nop 0
 v_permlane16_swap_b32 v58, v59
 v_fma_mix_f32 v60, v58, 1.0, v59 op_sel:[0,0,0] op_sel_hi:[1,0,1]
 v_fma_mix_f32 v61, v58, 1.0, v59 op_sel:[1,0,1] op_sel_hi:[1,0,1]
 v_mov_b32 v58, v60
 v_mov_b32 v59, v61
 s_nop 0
 v_permlane32_swap_b32 v58, v60
 v_permlane32_swap_b32 v59, v61
 v_add_f32 v52, v58, v60
 v_add_f32 v53, v59, v61
 v_max_f32 v79, v52, v53
 s_waitcnt vmcnt(0)
 v_pk_add_f16 v80, v40, v44
 v_pk_add_f16 v82, v42, v46
 v_pk_add_f16 v81, v41, v45
 v_pk_add_f16 v83, v43, v47
 v_permlane32_swap_b32 v80, v82
 v_bitop3_b32 v77, v40, v42, s88 bitop3:0x7e
 v_permlane32_swap_b32 v81, v83
 v_bitop3_b32 v78, v44, v46, s88 bitop3:0x7e
 v_fma_mix_f32 v48, v80, 1.0, v82 op_sel:[0,0,0] op_sel_hi:[1,0,1]
 v_or3_b32 v27, v76, v77, v78
 v_fma_mix_f32 v49, v80, 1.0, v82 op_sel:[1,0,1] op_sel_hi:[1,0,1]
 v_and_b32 v27, 1, v27
 v_fma_mix_f32 v50, v81, 1.0, v83 op_sel:[0,0,0] op_sel_hi:[1,0,1]
 v_cmp_ne_u32 vcc, 0, v27
 v_fma_mix_f32 v51, v81, 1.0, v83 op_sel:[1,0,1] op_sel_hi:[1,0,1]
 v_max3_f32 v62, v48, v49, v79
 s_cbranch_vccnz psr_43
 s_branch psj_44
kvw_45:
 s_mov_b32 s22, s87
 s_cmp_eq_u32 s52, 0
 s_cselect_b32 s55, 0, s55
 s_cselect_b32 s87, 1, 0
 s_cbranch_scc1 kvok_46
 v_mov_b32 v62, 0
 s_mov_b32 s101, 0
wf_50:
 buffer_load_dword v63, v62, s[12:15], s79 offen sc1
 s_add_u32 s101, s101, 1
 s_cmp_gt_u32 s101, 131072
 s_cbranch_scc1 end0
 s_waitcnt vmcnt(0)
 v_readfirstlane_b32 s100, v63
 s_cmp_ge_u32 s100, s46
 s_cbranch_scc1 wf_51
 s_sleep 3
 s_branch wf_50
wf_51:
 s_cmp_eq_u32 s22, 0
 s_cbranch_scc1 kvok_46
 s_sub_u32 s21, s64, 1310720
 buffer_load_dwordx4 v[126:129], v16, s[28:31], s21 offen offset:0 sc1
 buffer_load_dwordx4 v[130:133], v16, s[28:31], s21 offen offset:1024 sc1
 buffer_load_dwordx4 v[134:137], v16, s[28:31], s21 offen offset:2048 sc1
 s_waitcnt vmcnt(0)
 s_branch kvok_46
fl_47:
 buffer_load_dword v0, off, s[12:15], s79 sc1
 s_branch fl_48
last_37:
 s_waitcnt lgkmcnt(10)
 v_smfmac_f32_16x16x64_f16 v[100:103], v[28:31], a[120:127], v25
 v_smfmac_f32_16x16x64_f16 v[104:107], v[28:31], a[128:135], v25
 v_smfmac_f32_16x16x64_f16 v[108:111], v[28:31], a[136:143], v25
 v_smfmac_f32_16x16x64_f16 v[100:103], v[32:35], a[144:151], v25
 v_smfmac_f32_16x16x64_f16 v[104:107], v[32:35], a[152:159], v25
 v_smfmac_f32_16x16x64_f16 v[108:111], v[32:35], a[160:167], v25
 s_waitcnt lgkmcnt(7)
 v_smfmac_f32_16x16x64_f16 v[100:103], v[64:67], a[168:175], v25
 v_smfmac_f32_16x16x64_f16 v[104:107], v[64:67], a[176:183], v25
 v_smfmac_f32_16x16x64_f16 v[108:111], v[64:67], a[184:191], v25
 v_smfmac_f32_16x16x64_f16 v[100:103], v[68:71], a[192:199], v25
 v_smfmac_f32_16x16x64_f16 v[104:107], v[68:71], a[200:207], v25
 v_smfmac_f32_16x16x64_f16 v[108:111], v[68:71], a[208:215], v25
 v_smfmac_f32_16x16x64_f16 v[100:103], v[72:75], a[216:223], v25
 v_smfmac_f32_16x16x64_f16 v[104:107], v[72:75], a[224:231], v25
 v_smfmac_f32_16x16x64_f16 v[108:111], v[72:75], a[232:239], v25
 s_waitcnt lgkmcnt(4)
 v_smfmac_f32_16x16x64_f16 v[100:103], v[76:79], a[240:247], v25
 v_smfmac_f32_16x16x64_f16 v[104:107], v[76:79], a[248:255], v25
 v_smfmac_f32_16x16x64_f16 v[108:111], v[76:79], v[152:159], v25
 v_smfmac_f32_16x16x64_f16 v[100:103], v[80:83], v[160:167], v25
 v_smfmac_f32_16x16x64_f16 v[104:107], v[80:83], v[168:175], v25
 v_smfmac_f32_16x16x64_f16 v[108:111], v[80:83], v[176:183], v25
 v_smfmac_f32_16x16x64_f16 v[100:103], v[84:87], v[184:191], v25
 v_smfmac_f32_16x16x64_f16 v[104:107], v[84:87], v[192:199], v25
 v_smfmac_f32_16x16x64_f16 v[108:111], v[84:87], v[200:207], v25
 s_waitcnt lgkmcnt(0)
 v_smfmac_f32_16x16x64_f16 v[100:103], v[88:91], v[208:215], v25
 v_smfmac_f32_16x16x64_f16 v[104:107], v[88:91], v[216:223], v25
 v_smfmac_f32_16x16x64_f16 v[108:111], v[88:91], v[224:231], v25
 v_smfmac_f32_16x16x64_f16 v[100:103], v[92:95], v[232:239], v25
 v_smfmac_f32_16x16x64_f16 v[104:107], v[92:95], v[240:247], v25
 v_smfmac_f32_16x16x64_f16 v[108:111], v[92:95], v[248:255], v25
 s_nop 7
 v_mov_b32 v76, v108
 v_mov_b32 v77, v109
 v_mov_b32 v78, v110
 v_mov_b32 v79, v111
 v_permlane32_swap_b32 v100, v104
 v_permlane32_swap_b32 v101, v105
 v_permlane32_swap_b32 v102, v106
 v_permlane32_swap_b32 v103, v107
 v_permlane32_swap_b32 v108, v76
 v_permlane32_swap_b32 v109, v77
 v_permlane32_swap_b32 v110, v78
 v_permlane32_swap_b32 v111, v79
 v_pk_add_f32 v[100:101], v[100:101], v[104:105]
 v_pk_add_f32 v[102:103], v[102:103], v[106:107]
 v_pk_add_f32 v[108:109], v[108:109], v[76:77]
 v_pk_add_f32 v[110:111], v[110:111], v[78:79]
 v_cvt_pk_bf16_f32 v80, v100, v101
 v_cvt_pk_bf16_f32 v82, v108, v109
 v_cvt_pk_bf16_f32 v81, v102, v103
 v_cvt_pk_bf16_f32 v83, v110, v111
 s_nop 0
 v_permlane16_swap_b32 v80, v82
 v_permlane16_swap_b32 v81, v83
 v_min_u32 v80, -2, v80
 s_mov_b64 exec, s[76:77]
 buffer_store_dwordx4 v[80:83], v15, s[24:27], s57 offen sc1
 s_mov_b64 exec, -1
 s_branch chain_done
step_52:
 s_and_b32 s21, s52, 3
 s_mul_i32 s81, s21, 540672
 s_mul_i32 s84, s21, 0x88000
 s_and_b32 s84, s84, 0x108000
 s_add_u32 s21, s52, 3
 s_and_b32 s21, s21, 3
 s_mul_i32 s83, s21, 0x88000
 s_and_b32 s83, s83, 0x108000
 s_add_u32 s21, s52, 1
 s_and_b32 s22, s21, 3
 s_mul_i32 s3, s22, 0x88000
 s_and_b32 s3, s3, 0x108000
 s_mul_i32 s80, s21, 393216
 s_add_u32 s46, s21, 1
 s_min_u32 s46, s46, 64
 s_mov_b32 s47, s57
 s_lshr_b32 s21, s52, 1
 s_bitcmp1_b32 s37, s21
 s_cselect_b32 s21, 8192, 0
 s_lshl_b32 s22, s52, 20
 s_or_b32 s22, s22, s21
 s_cmp_ge_u32 s52, 40
 s_cselect_b32 s57, 8192, 0
 s_xor_b32 s57, s57, s22
 s_xor_b32 s85, s22, 8192
 s_bfe_u32 s88, s52, 0x10002
 s_max_u32 s67, s52, 1
 s_sub_u32 s67, s67, 1
 v_mov_b32 v40, 0
 v_mov_b32 v41, 0
 v_mov_b32 v42, 0
 v_mov_b32 v43, 0
 v_mov_b32 v44, 0
 v_mov_b32 v45, 0
 v_mov_b32 v46, 0
 v_mov_b32 v47, 0
 v_mov_b32 v48, 0
 v_mov_b32 v49, 0
 v_mov_b32 v50, 0
 v_mov_b32 v51, 0
 v_mov_b32 v52, 0
 v_mov_b32 v53, 0
 v_mov_b32 v54, 0
 v_mov_b32 v55, 0
 v_mov_b32 v56, 0
 v_mov_b32 v57, 0
 v_mov_b32 v58, 0
 v_mov_b32 v59, 0
 v_mov_b32 v60, 0
 v_mov_b32 v61, 0
 v_mov_b32 v62, 0
 v_mov_b32 v63, 0
 v_mov_b32 v100, 0
 v_mov_b32 v101, 0
 v_mov_b32 v102, 0
 v_mov_b32 v103, 0
 v_mov_b32 v104, 0
 v_mov_b32 v105, 0
 v_mov_b32 v106, 0
 v_mov_b32 v107, 0
 v_mov_b32 v108, 0
 v_mov_b32 v109, 0
 v_mov_b32 v110, 0
 v_mov_b32 v111, 0
 s_sleep 4
 s_nop 3
 v_readfirstlane_b32 s21, v0
 s_cmp_lt_u32 s21, s46
 s_cselect_b32 s55, s55, 0
 s_cmp_lt_i32 s55, 0
 s_cbranch_scc1 fl_57
fl_58:
 s_mov_b32 s54, 0
 buffer_load_dwordx4 v[36:39], v4, s[4:7], s84 offen offset:2048 sc1
 buffer_load_dwordx4 v[28:31], v4, s[4:7], s84 offen offset:0 sc1
 buffer_load_dwordx4 v[32:35], v4, s[4:7], s84 offen offset:1024 sc1
 s_waitcnt vmcnt(3)
 v_mov_b32 v126, v88
 v_mov_b32 v127, v89
 v_mov_b32 v128, v90
 v_mov_b32 v129, v91
 v_mov_b32 v130, v92
 v_mov_b32 v131, v93
 v_mov_b32 v132, v94
 v_mov_b32 v133, v95
 v_mov_b32 v134, v96
 v_mov_b32 v135, v97
 v_mov_b32 v136, v98
 v_mov_b32 v137, v99
 s_waitcnt vmcnt(2)
 v_smfmac_f32_16x16x32_f16 v[40:43], v[36:37], a[16:19], v25
 v_smfmac_f32_16x16x32_f16 v[52:55], v[36:37], a[76:79], v25
 v_smfmac_f32_16x16x32_f16 v[44:47], v[36:37], a[36:39], v25
 s_waitcnt vmcnt(0)
 v_bitop3_b32 v27, v31, v35, v39 bitop3:0x80
 v_perm_b32 v31, v35, v31, s89
 v_cmp_gt_u32 vcc, 0x48000000, v27
 v_mov_b32 v35, v38
 v_smfmac_f32_16x16x32_f16 v[56:59], v[36:37], a[96:99], v25
 s_cbranch_vccnz pm_55
A2_56:
 v_smfmac_f32_16x16x64_f16 v[40:43], v[28:31], a[0:7], v25
 ds_write_b128 v10, v[28:31]
 v_smfmac_f32_16x16x64_f16 v[40:43], v[32:35], a[8:15], v25
 ds_write_b128 v10, v[32:35] offset:1024
 v_smfmac_f32_16x16x64_f16 v[52:55], v[28:31], a[60:67], v25
 ds_write_b64 v10, v[36:37] offset:2048
 v_smfmac_f32_16x16x64_f16 v[52:55], v[32:35], a[68:75], v25
 v_cvt_pk_f16_f32 v40, v40, v41
 v_cvt_pk_f16_f32 v41, v42, v43
 v_smfmac_f32_16x16x32_f16 v[48:51], v[36:37], a[56:59], v25
 v_smfmac_f32_16x16x32_f16 v[60:63], v[36:37], a[116:119], v25
 v_smfmac_f32_16x16x64_f16 v[44:47], v[28:31], a[20:27], v25
 v_cvt_pk_f16_f32 v52, v52, v53
 v_cvt_pk_f16_f32 v53, v54, v55
 s_nop 0
 v_smfmac_f32_16x16x64_f16 v[44:47], v[32:35], a[28:35], v25
 v_permlane32_swap_b32 v40, v52
 v_smfmac_f32_16x16x64_f16 v[56:59], v[28:31], a[80:87], v25
 v_permlane32_swap_b32 v41, v53
 v_pk_add_f16 v40, v40, v52
 v_smfmac_f32_16x16x64_f16 v[56:59], v[32:35], a[88:95], v25
 v_pk_add_f16 v41, v41, v53
 v_smfmac_f32_16x16x64_f16 v[48:51], v[28:31], a[40:47], v25
 ds_write_b64 v5, v[40:41] offset:0
 v_smfmac_f32_16x16x64_f16 v[48:51], v[32:35], a[48:55], v25
 v_cvt_pk_f16_f32 v44, v44, v45
 v_cvt_pk_f16_f32 v45, v46, v47
 v_cvt_pk_f16_f32 v56, v56, v57
 v_smfmac_f32_16x16x64_f16 v[60:63], v[28:31], a[100:107], v25
 v_cvt_pk_f16_f32 v57, v58, v59
 s_nop 0
 v_smfmac_f32_16x16x64_f16 v[60:63], v[32:35], a[108:115], v25
 v_permlane32_swap_b32 v44, v56
 v_permlane32_swap_b32 v45, v57
 v_pk_add_f16 v44, v44, v56
 v_pk_add_f16 v45, v45, v57
 ds_write_b64 v5, v[44:45] offset:640
 v_cvt_pk_f16_f32 v48, v48, v49
 v_cvt_pk_f16_f32 v49, v50, v51
 v_cvt_pk_f16_f32 v60, v60, v61
 v_cvt_pk_f16_f32 v61, v62, v63
 s_nop 0
 v_permlane32_swap_b32 v48, v60
 v_permlane32_swap_b32 v49, v61
 v_pk_add_f16 v48, v48, v60
 v_pk_add_f16 v49, v49, v61
 ds_write_b64 v5, v[48:49] offset:1280
 s_waitcnt lgkmcnt(0) vmcnt(0)
 s_barrier
 ds_read_b64_tr_b16 v[40:41], v6 offset:0
 ds_read_b64_tr_b16 v[42:43], v6 offset:1920
 ds_read_b64_tr_b16 v[44:45], v6 offset:3840
 ds_read_b64_tr_b16 v[46:47], v6 offset:5760
 ds_read_b64_tr_b16 v[48:49], v6 offset:640
 ds_read_b64_tr_b16 v[50:51], v6 offset:2560
 ds_read_b64_tr_b16 v[52:53], v6 offset:4480
 ds_read_b64_tr_b16 v[54:55], v6 offset:6400
 ds_read_b64_tr_b16 v[56:57], v6 offset:1280
 ds_read_b64_tr_b16 v[58:59], v6 offset:3200
 ds_read_b64_tr_b16 v[60:61], v6 offset:5120
 ds_read_b64_tr_b16 v[62:63], v6 offset:7040
 s_waitcnt lgkmcnt(8)
 v_pk_add_f16 v40, v40, v42
 v_pk_add_f16 v44, v44, v46
 v_pk_add_f16 v41, v41, v43
 v_pk_add_f16 v45, v45, v47
 v_fma_mix_f32 v146, v40, 1.0, v44 op_sel:[0,0,0] op_sel_hi:[1,0,1]
 v_fma_mix_f32 v147, v40, 1.0, v44 op_sel:[1,0,1] op_sel_hi:[1,0,1]
 v_fma_mix_f32 v148, v41, 1.0, v45 op_sel:[0,0,0] op_sel_hi:[1,0,1]
 v_fma_mix_f32 v149, v41, 1.0, v45 op_sel:[1,0,1] op_sel_hi:[1,0,1]
 v_cvt_pk_bf16_f32 v118, v146, v147
 v_cvt_pk_bf16_f32 v119, v148, v149
 s_waitcnt lgkmcnt(4)
 v_pk_add_f16 v48, v48, v50
 v_pk_add_f16 v52, v52, v54
 v_pk_add_f16 v49, v49, v51
 v_pk_add_f16 v53, v53, v55
 v_fma_mix_f32 v146, v48, 1.0, v52 op_sel:[0,0,0] op_sel_hi:[1,0,1]
 v_fma_mix_f32 v147, v48, 1.0, v52 op_sel:[1,0,1] op_sel_hi:[1,0,1]
 v_fma_mix_f32 v148, v49, 1.0, v53 op_sel:[0,0,0] op_sel_hi:[1,0,1]
 v_fma_mix_f32 v149, v49, 1.0, v53 op_sel:[1,0,1] op_sel_hi:[1,0,1]
 v_cvt_pk_bf16_f32 v120, v146, v147
 v_cvt_pk_bf16_f32 v121, v148, v149
 s_waitcnt lgkmcnt(0)
 v_pk_add_f16 v56, v56, v58
 v_pk_add_f16 v60, v60, v62
 v_pk_add_f16 v57, v57, v59
 v_pk_add_f16 v61, v61, v63
 v_fma_mix_f32 v146, v56, 1.0, v60 op_sel:[0,0,0] op_sel_hi:[1,0,1]
 v_fma_mix_f32 v147, v56, 1.0, v60 op_sel:[1,0,1] op_sel_hi:[1,0,1]
 v_mfma_f32_16x16x32_bf16 v[40:43], v[118:121], v[118:121], 0
 v_fma_mix_f32 v148, v57, 1.0, v61 op_sel:[0,0,0] op_sel_hi:[1,0,1]
 v_fma_mix_f32 v149, v57, 1.0, v61 op_sel:[1,0,1] op_sel_hi:[1,0,1]
 v_cvt_pk_bf16_f32 v122, v146, v147
 v_cvt_pk_bf16_f32 v123, v148, v149
 s_nop 1
 v_mfma_f32_16x16x32_bf16 v[40:43], v[122:125], v[122:125], v[40:43]
 ds_read_b128 v[28:31], v16 offset:24576
 ds_read_b128 v[32:35], v16 offset:25600
 ds_read_b128 v[64:67], v16 offset:27648
 ds_read_b128 v[68:71], v16 offset:28672
 ds_read_b128 v[72:75], v16 offset:30720
 ds_read_b128 v[76:79], v16 offset:31744
 s_nop 0
 s_mov_b64 exec, s[74:75]
 v_cvt_pk_f16_f32 v44, v40, v41
 v_cvt_pk_f16_f32 v45, v42, v43
 v_and_or_b32 v44, v44, -2, s88
 buffer_store_dwordx2 v[44:45], v7, s[8:11], s81 offen
 s_mov_b64 exec, -1
 ds_read_b128 v[80:83], v16 offset:33792
 ds_read_b128 v[84:87], v16 offset:34816
 ds_read_b64 v[88:89], v16 offset:26624
 ds_read_b64 v[90:91], v16 offset:29696
 ds_read_b64 v[92:93], v16 offset:32768
 ds_read_b64 v[94:95], v16 offset:35840
 s_cmp_eq_u32 s52, 63
 s_cbranch_scc1 last_53
 s_waitcnt lgkmcnt(10)
 v_smfmac_f32_16x16x64_f16 v[100:103], v[28:31], a[120:127], v25
 v_smfmac_f32_16x16x64_f16 v[104:107], v[28:31], a[128:135], v25
 v_smfmac_f32_16x16x64_f16 v[108:111], v[28:31], a[136:143], v25
 s_mov_b32 s54, 0
 v_smfmac_f32_16x16x64_f16 v[100:103], v[32:35], a[144:151], v25
 v_readfirstlane_b32 s21, v0
 v_smfmac_f32_16x16x64_f16 v[104:107], v[32:35], a[152:159], v25
 s_add_u32 s22, s46, 3
 v_smfmac_f32_16x16x64_f16 v[108:111], v[32:35], a[160:167], v25
 s_min_u32 s22, s22, 64
 s_waitcnt lgkmcnt(7)
 v_smfmac_f32_16x16x64_f16 v[100:103], v[64:67], a[168:175], v25
 s_sub_u32 s55, s21, s22
 v_smfmac_f32_16x16x64_f16 v[104:107], v[64:67], a[176:183], v25
 s_sub_u32 s56, s21, s46
 v_smfmac_f32_16x16x64_f16 v[108:111], v[64:67], a[184:191], v25
 v_smfmac_f32_16x16x64_f16 v[100:103], v[68:71], a[192:199], v25
 v_smfmac_f32_16x16x64_f16 v[104:107], v[68:71], a[200:207], v25
 v_smfmac_f32_16x16x64_f16 v[108:111], v[68:71], a[208:215], v25
 v_smfmac_f32_16x16x64_f16 v[100:103], v[72:75], a[216:223], v25
 v_smfmac_f32_16x16x64_f16 v[104:107], v[72:75], a[224:231], v25
 v_smfmac_f32_16x16x64_f16 v[108:111], v[72:75], a[232:239], v25
 s_waitcnt lgkmcnt(4)
 v_smfmac_f32_16x16x64_f16 v[100:103], v[76:79], a[240:247], v25
 v_smfmac_f32_16x16x64_f16 v[104:107], v[76:79], a[248:255], v25
 v_smfmac_f32_16x16x64_f16 v[108:111], v[76:79], v[152:159], v25
 buffer_load_dwordx2 v[58:59], v9, s[8:11], s81 offen sc1
 buffer_load_dwordx4 v[40:43], v8, s[8:11], s81 offen offset:0 sc1
 buffer_load_dwordx4 v[44:47], v8, s[8:11], s81 offen offset:1024 sc1
 v_smfmac_f32_16x16x64_f16 v[100:103], v[80:83], v[160:167], v25
 v_smfmac_f32_16x16x64_f16 v[104:107], v[80:83], v[168:175], v25
 v_smfmac_f32_16x16x64_f16 v[108:111], v[80:83], v[176:183], v25
 v_smfmac_f32_16x16x64_f16 v[100:103], v[84:87], v[184:191], v25
 v_smfmac_f32_16x16x64_f16 v[104:107], v[84:87], v[192:199], v25
 v_smfmac_f32_16x16x64_f16 v[108:111], v[84:87], v[200:207], v25
 s_waitcnt lgkmcnt(0)
 v_smfmac_f32_16x16x64_f16 v[100:103], v[88:91], v[208:215], v25
 v_smfmac_f32_16x16x64_f16 v[104:107], v[88:91], v[216:223], v25
 v_smfmac_f32_16x16x64_f16 v[108:111], v[88:91], v[224:231], v25
 v_smfmac_f32_16x16x64_f16 v[100:103], v[92:95], v[232:239], v25
 v_smfmac_f32_16x16x64_f16 v[104:107], v[92:95], v[240:247], v25
 v_smfmac_f32_16x16x64_f16 v[108:111], v[92:95], v[248:255], v25
 s_cmp_lt_i32 s56, 0
 s_cbranch_scc1 kvw_61
kvok_62:
 s_waitcnt vmcnt(2)
 v_xor_b32 v76, s88, v58
 s_nop 0
 v_permlane16_swap_b32 v58, v59
 v_fma_mix_f32 v60, v58, 1.0, v59 op_sel:[0,0,0] op_sel_hi:[1,0,1]
 v_fma_mix_f32 v61, v58, 1.0, v59 op_sel:[1,0,1] op_sel_hi:[1,0,1]
 v_mov_b32 v58, v60
 v_mov_b32 v59, v61
 s_nop 0
 v_permlane32_swap_b32 v58, v60
 v_permlane32_swap_b32 v59, v61
 v_add_f32 v52, v58, v60
 v_add_f32 v53, v59, v61
 v_max_f32 v79, v52, v53
 s_waitcnt vmcnt(0)
 v_pk_add_f16 v80, v40, v44
 v_pk_add_f16 v82, v42, v46
 v_pk_add_f16 v81, v41, v45
 v_pk_add_f16 v83, v43, v47
 v_permlane32_swap_b32 v80, v82
 v_bitop3_b32 v77, v40, v42, s88 bitop3:0x7e
 v_permlane32_swap_b32 v81, v83
 v_bitop3_b32 v78, v44, v46, s88 bitop3:0x7e
 v_fma_mix_f32 v48, v80, 1.0, v82 op_sel:[0,0,0] op_sel_hi:[1,0,1]
 v_or3_b32 v27, v76, v77, v78
 v_fma_mix_f32 v49, v80, 1.0, v82 op_sel:[1,0,1] op_sel_hi:[1,0,1]
 v_and_b32 v27, 1, v27
 v_fma_mix_f32 v50, v81, 1.0, v83 op_sel:[0,0,0] op_sel_hi:[1,0,1]
 v_cmp_ne_u32 vcc, 0, v27
 v_fma_mix_f32 v51, v81, 1.0, v83 op_sel:[1,0,1] op_sel_hi:[1,0,1]
 v_max3_f32 v62, v48, v49, v79
 s_cbranch_vccnz psr_59
psj_60:
 v_max3_f32 v62, v62, v50, v51
 v_cvt_pk_bf16_f32 v146, v100, v101
 v_cvt_pk_bf16_f32 v147, v102, v103
 v_max_f32_dpp v62, v62, v62 row_ror:8 row_mask:0xf bank_mask:0xf
 v_mov_b32 v63, v62
 v_cvt_pk_bf16_f32 v148, v104, v105
 v_cvt_pk_bf16_f32 v149, v106, v107
 v_permlane32_swap_b32 v62, v63
 v_max_f32 v62, v62, v63
 v_mov_b32 v63, v62
 v_cvt_pk_bf16_f32 v150, v108, v109
 v_cvt_pk_bf16_f32 v151, v110, v111
 v_permlane16_swap_b32 v62, v63
 v_max_f32 v62, v62, v63
 v_mul_f32 v62, s86, v62
 v_fma_f32 v48, v48, s86, -v62
 v_fma_f32 v49, v49, s86, -v62
 v_fma_f32 v50, v50, s86, -v62
 v_fma_f32 v51, v51, s86, -v62
 v_fma_f32 v52, v52, s86, -v62
 v_fma_f32 v53, v53, s86, -v62
 v_exp_f32 v48, v48
 v_exp_f32 v49, v49
 buffer_load_dwordx4 v[88:91], v17, s[28:31], s64 offen offset:0 sc1
 v_exp_f32 v50, v50
 v_exp_f32 v51, v51
 buffer_load_dwordx4 v[92:95], v16, s[28:31], s64 offen offset:1024 sc1
 v_exp_f32 v52, v52
 v_exp_f32 v53, v53
 buffer_load_dwordx4 v[96:99], v20, s[28:31], s64 offen offset:2048 sc1
 v_cvt_pk_bf16_f32 v138, v48, v49
 v_cvt_pk_bf16_f32 v139, v50, v51
 v_cvt_pk_bf16_f32 v142, v52, v53
 v_mov_b32_dpp v140, v138 row_ror:8 row_mask:0xf bank_mask:0xf
 v_mov_b32_dpp v141, v139 row_ror:8 row_mask:0xf bank_mask:0xf
 v_mov_b32_dpp v143, v142 row_ror:8 row_mask:0xf bank_mask:0xf
 v_add_f32 v54, v48, v49
 v_mfma_f32_16x16x32_bf16 v[64:67], v[126:129], v[138:141], 0
 v_add_f32 v55, v50, v51
 v_add_f32 v56, v52, v53
 v_mfma_f32_16x16x32_bf16 v[64:67], v[146:149], v[142:145], v[64:67]
 v_add_f32 v62, v54, v55
 v_fmac_f32 v62, v56, v26
 v_mfma_f32_16x16x32_bf16 v[68:71], v[130:133], v[138:141], 0
 s_nop 0
 v_add_f32_dpp v62, v62, v62 row_ror:8 row_mask:0xf bank_mask:0xf
 v_mfma_f32_16x16x32_bf16 v[68:71], v[148:151], v[142:145], v[68:71]
 v_mov_b32 v63, v62
 s_cmp_lt_i32 s55, 0
 s_cbranch_scc1 fl_63
fl_64:
 v_mfma_f32_16x16x32_bf16 v[72:75], v[134:137], v[138:141], 0
 v_permlane32_swap_b32 v62, v63
 v_mfma_f32_16x16x32_bf16 v[72:75], v[150:153], v[142:145], v[72:75]
 v_add_f32 v62, v62, v63
 v_mov_b32 v63, v62
 ds_write_b128 v11, v[64:67] offset:0
 s_nop 0
 v_permlane16_swap_b32 v62, v63
 v_add_f32 v62, v62, v63
 v_rcp_f32 v62, v62
 ds_write_b128 v11, v[68:71] offset:1024
 s_mov_b64 exec, 0xff
 ds_write_b32 v22, v62
 s_mov_b64 exec, -1
 ds_write_b128 v11, v[72:75] offset:2048
 s_waitcnt lgkmcnt(0)
 s_barrier
 ds_read_b128 v[72:75], v23
 ds_read_b64 v[64:65], v12 offset:0
 ds_read_b64 v[66:67], v12 offset:3072
 ds_read_b64 v[68:69], v12 offset:6144
 ds_read_b64 v[70:71], v12 offset:9216
 s_waitcnt lgkmcnt(2)
 v_pk_mul_f32 v[64:65], v[64:65], v[72:73] op_sel_hi:[1,0]
 v_pk_fma_f32 v[64:65], v[66:67], v[72:73], v[64:65] op_sel:[0,1,0] op_sel_hi:[1,1,1]
 s_waitcnt lgkmcnt(0)
 v_pk_fma_f32 v[64:65], v[68:69], v[74:75], v[64:65] op_sel_hi:[1,0,1]
 v_pk_fma_f32 v[64:65], v[70:71], v[74:75], v[64:65] op_sel:[0,1,0] op_sel_hi:[1,1,1]
 v_cvt_pk_f16_f32 v68, v64, v65
 v_perm_b32 v68, s91, v68, v14
 buffer_atomic_pk_add_f16 v68, v13, s[4:7], s3 offen
 s_mov_b64 exec, s[62:63]
 buffer_store_dwordx4 v[118:121], v18, s[24:27], s85 offen sc1
 buffer_store_dwordx2 v[122:123], v19, s[24:27], s85 offen sc1
 s_mov_b64 exec, -1
 v_mov_b32 v76, v108
 v_mov_b32 v77, v109
 v_mov_b32 v78, v110
 v_mov_b32 v79, v111
 v_permlane32_swap_b32 v100, v104
 v_permlane32_swap_b32 v101, v105
 v_permlane32_swap_b32 v102, v106
 v_permlane32_swap_b32 v103, v107
 v_permlane32_swap_b32 v108, v76
 v_permlane32_swap_b32 v109, v77
 v_permlane32_swap_b32 v110, v78
 v_permlane32_swap_b32 v111, v79
 v_pk_add_f32 v[100:101], v[100:101], v[104:105]
 v_pk_add_f32 v[102:103], v[102:103], v[106:107]
 v_pk_add_f32 v[108:109], v[108:109], v[76:77]
 v_pk_add_f32 v[110:111], v[110:111], v[78:79]
 v_cvt_pk_bf16_f32 v80, v100, v101
 v_cvt_pk_bf16_f32 v82, v108, v109
 v_cvt_pk_bf16_f32 v81, v102, v103
 v_cvt_pk_bf16_f32 v83, v110, v111
 s_nop 0
 v_permlane16_swap_b32 v80, v82
 v_permlane16_swap_b32 v81, v83
 v_min_u32 v80, -2, v80
 s_mov_b64 exec, s[76:77]
 buffer_store_dwordx4 v[80:83], v15, s[24:27], s57 offen sc1
 s_mov_b64 exec, -1
 s_add_u32 s64, s64, 1310720
 s_add_u32 s52, s52, 1
 s_branch step_52
fl_57:
 buffer_load_dword v0, off, s[12:15], s79 sc1
 s_branch fl_58
A1_17:
 v_smfmac_f32_16x16x32_f16 v[40:43], v[36:37], a[16:19], v25
 v_smfmac_f32_16x16x32_f16 v[52:55], v[36:37], a[76:79], v25
 v_smfmac_f32_16x16x32_f16 v[44:47], v[36:37], a[36:39], v25
 v_smfmac_f32_16x16x32_f16 v[56:59], v[36:37], a[96:99], v25
 s_branch A2_56
pm_55:
 buffer_load_dwordx4 v[36:39], v4, s[4:7], s84 offen offset:2048 sc1
 buffer_load_dwordx4 v[28:31], v4, s[4:7], s84 offen offset:0 sc1
 buffer_load_dwordx4 v[32:35], v4, s[4:7], s84 offen offset:1024 sc1
 s_nop 7
 v_mov_b32 v40, 0
 v_mov_b32 v41, 0
 v_mov_b32 v42, 0
 v_mov_b32 v43, 0
 v_mov_b32 v52, 0
 v_mov_b32 v53, 0
 v_mov_b32 v54, 0
 v_mov_b32 v55, 0
 v_mov_b32 v44, 0
 v_mov_b32 v45, 0
 v_mov_b32 v46, 0
 v_mov_b32 v47, 0
 v_mov_b32 v56, 0
 v_mov_b32 v57, 0
 v_mov_b32 v58, 0
 v_mov_b32 v59, 0
 s_waitcnt vmcnt(0)
 v_bitop3_b32 v27, v31, v35, v39 bitop3:0x80
 v_perm_b32 v31, v35, v31, s89
 v_cmp_gt_u32 vcc, 0x48000000, v27
 v_mov_b32 v35, v38
 s_cbranch_vccz A1_17
pm_54:
 s_cmp_gt_u32 s52, 3
 s_cbranch_scc1 op_65
 v_readfirstlane_b32 s21, v0
 s_cmp_ge_u32 s21, s46
 s_cbranch_scc1 op_65
 buffer_load_dword v0, off, s[12:15], s79 sc1
 s_waitcnt vmcnt(0)
 v_readfirstlane_b32 s21, v0
 s_cmp_gt_u32 s21, s52
 s_cselect_b32 s21, s87, 0
 s_cmp_eq_u32 s21, 0
 s_cbranch_scc1 op_65
 s_mov_b32 s87, 0
 s_sub_u32 s21, s64, 1310720
 buffer_load_dwordx4 v[126:129], v16, s[28:31], s21 offen offset:0 sc1
 buffer_load_dwordx4 v[130:133], v16, s[28:31], s21 offen offset:1024 sc1
 buffer_load_dwordx4 v[134:137], v16, s[28:31], s21 offen offset:2048 sc1
op_65:
 buffer_load_dwordx4 v[36:39], v4, s[4:7], s84 offen offset:2048 sc1
 buffer_load_dwordx4 v[28:31], v4, s[4:7], s84 offen offset:0 sc1
 buffer_load_dwordx4 v[32:35], v4, s[4:7], s84 offen offset:1024 sc1
 s_add_u32 s54, s54, 1
 s_cmp_gt_u32 s54, 131072
 s_cbranch_scc1 end0
 s_waitcnt vmcnt(0)
 v_bitop3_b32 v27, v31, v35, v39 bitop3:0x80
 v_perm_b32 v31, v35, v31, s89
 v_cmp_gt_u32 vcc, 0x48000000, v27
 v_mov_b32 v35, v38
 s_cbranch_vccnz pm_54
 s_branch A1_17
psr_59:
 buffer_load_dwordx2 v[58:59], v9, s[8:11], s81 offen sc1
 buffer_load_dwordx4 v[40:43], v8, s[8:11], s81 offen offset:0 sc1
 buffer_load_dwordx4 v[44:47], v8, s[8:11], s81 offen offset:1024 sc1
 s_add_u32 s54, s54, 1
 s_cmp_gt_u32 s54, 131072
 s_cbranch_scc1 end0
 s_waitcnt vmcnt(2)
 v_xor_b32 v76, s88, v58
 s_nop 0
 v_permlane16_swap_b32 v58, v59
 v_fma_mix_f32 v60, v58, 1.0, v59 op_sel:[0,0,0] op_sel_hi:[1,0,1]
 v_fma_mix_f32 v61, v58, 1.0, v59 op_sel:[1,0,1] op_sel_hi:[1,0,1]
 v_mov_b32 v58, v60
 v_mov_b32 v59, v61
 s_nop 0
 v_permlane32_swap_b32 v58, v60
 v_permlane32_swap_b32 v59, v61
 v_add_f32 v52, v58, v60
 v_add_f32 v53, v59, v61
 v_max_f32 v79, v52, v53
 s_waitcnt vmcnt(0)
 v_pk_add_f16 v80, v40, v44
 v_pk_add_f16 v82, v42, v46
 v_pk_add_f16 v81, v41, v45
 v_pk_add_f16 v83, v43, v47
 v_permlane32_swap_b32 v80, v82
 v_bitop3_b32 v77, v40, v42, s88 bitop3:0x7e
 v_permlane32_swap_b32 v81, v83
 v_bitop3_b32 v78, v44, v46, s88 bitop3:0x7e
 v_fma_mix_f32 v48, v80, 1.0, v82 op_sel:[0,0,0] op_sel_hi:[1,0,1]
 v_or3_b32 v27, v76, v77, v78
 v_fma_mix_f32 v49, v80, 1.0, v82 op_sel:[1,0,1] op_sel_hi:[1,0,1]
 v_and_b32 v27, 1, v27
 v_fma_mix_f32 v50, v81, 1.0, v83 op_sel:[0,0,0] op_sel_hi:[1,0,1]
 v_cmp_ne_u32 vcc, 0, v27
 v_fma_mix_f32 v51, v81, 1.0, v83 op_sel:[1,0,1] op_sel_hi:[1,0,1]
 v_max3_f32 v62, v48, v49, v79
 s_cbranch_vccnz psr_59
 s_branch psj_60
kvw_61:
 s_mov_b32 s22, s87
 s_cmp_eq_u32 s52, 0
 s_cselect_b32 s55, 0, s55
 s_cselect_b32 s87, 1, 0
 s_cbranch_scc1 kvok_62
 v_mov_b32 v62, 0
 s_mov_b32 s101, 0
wf_66:
 buffer_load_dword v63, v62, s[12:15], s79 offen sc1
 s_add_u32 s101, s101, 1
 s_cmp_gt_u32 s101, 131072
 s_cbranch_scc1 end0
 s_waitcnt vmcnt(0)
 v_readfirstlane_b32 s100, v63
 s_cmp_ge_u32 s100, s46
 s_cbranch_scc1 wf_67
 s_sleep 3
 s_branch wf_66
wf_67:
 s_cmp_eq_u32 s22, 0
 s_cbranch_scc1 kvok_62
 s_sub_u32 s21, s64, 1310720
 buffer_load_dwordx4 v[126:129], v16, s[28:31], s21 offen offset:0 sc1
 buffer_load_dwordx4 v[130:133], v16, s[28:31], s21 offen offset:1024 sc1
 buffer_load_dwordx4 v[134:137], v16, s[28:31], s21 offen offset:2048 sc1
 s_waitcnt vmcnt(0)
 s_branch kvok_62
fl_63:
 buffer_load_dword v0, off, s[12:15], s79 sc1
 s_branch fl_64
last_53:
 s_mov_b64 exec, s[62:63]
 buffer_store_dwordx4 v[118:121], v18, s[24:27], s85 offen sc1
 buffer_store_dwordx2 v[122:123], v19, s[24:27], s85 offen sc1
 s_mov_b64 exec, -1
 s_waitcnt lgkmcnt(10)
 v_smfmac_f32_16x16x64_f16 v[100:103], v[28:31], a[120:127], v25
 v_smfmac_f32_16x16x64_f16 v[104:107], v[28:31], a[128:135], v25
 v_smfmac_f32_16x16x64_f16 v[108:111], v[28:31], a[136:143], v25
 v_smfmac_f32_16x16x64_f16 v[100:103], v[32:35], a[144:151], v25
 v_smfmac_f32_16x16x64_f16 v[104:107], v[32:35], a[152:159], v25
 v_smfmac_f32_16x16x64_f16 v[108:111], v[32:35], a[160:167], v25
 s_waitcnt lgkmcnt(7)
 v_smfmac_f32_16x16x64_f16 v[100:103], v[64:67], a[168:175], v25
 v_smfmac_f32_16x16x64_f16 v[104:107], v[64:67], a[176:183], v25
 v_smfmac_f32_16x16x64_f16 v[108:111], v[64:67], a[184:191], v25
 v_smfmac_f32_16x16x64_f16 v[100:103], v[68:71], a[192:199], v25
 v_smfmac_f32_16x16x64_f16 v[104:107], v[68:71], a[200:207], v25
 v_smfmac_f32_16x16x64_f16 v[108:111], v[68:71], a[208:215], v25
 v_smfmac_f32_16x16x64_f16 v[100:103], v[72:75], a[216:223], v25
 v_smfmac_f32_16x16x64_f16 v[104:107], v[72:75], a[224:231], v25
 v_smfmac_f32_16x16x64_f16 v[108:111], v[72:75], a[232:239], v25
 s_waitcnt lgkmcnt(4)
 v_smfmac_f32_16x16x64_f16 v[100:103], v[76:79], a[240:247], v25
 v_smfmac_f32_16x16x64_f16 v[104:107], v[76:79], a[248:255], v25
 v_smfmac_f32_16x16x64_f16 v[108:111], v[76:79], v[152:159], v25
 v_smfmac_f32_16x16x64_f16 v[100:103], v[80:83], v[160:167], v25
 v_smfmac_f32_16x16x64_f16 v[104:107], v[80:83], v[168:175], v25
 v_smfmac_f32_16x16x64_f16 v[108:111], v[80:83], v[176:183], v25
 v_smfmac_f32_16x16x64_f16 v[100:103], v[84:87], v[184:191], v25
 v_smfmac_f32_16x16x64_f16 v[104:107], v[84:87], v[192:199], v25
 v_smfmac_f32_16x16x64_f16 v[108:111], v[84:87], v[200:207], v25
 s_waitcnt lgkmcnt(0)
 v_smfmac_f32_16x16x64_f16 v[100:103], v[88:91], v[208:215], v25
 v_smfmac_f32_16x16x64_f16 v[104:107], v[88:91], v[216:223], v25
 v_smfmac_f32_16x16x64_f16 v[108:111], v[88:91], v[224:231], v25
 v_smfmac_f32_16x16x64_f16 v[100:103], v[92:95], v[232:239], v25
 v_smfmac_f32_16x16x64_f16 v[104:107], v[92:95], v[240:247], v25
 v_smfmac_f32_16x16x64_f16 v[108:111], v[92:95], v[248:255], v25
 s_nop 7
 v_mov_b32 v76, v108
 v_mov_b32 v77, v109
 v_mov_b32 v78, v110
 v_mov_b32 v79, v111
 v_permlane32_swap_b32 v100, v104
 v_permlane32_swap_b32 v101, v105
 v_permlane32_swap_b32 v102, v106
 v_permlane32_swap_b32 v103, v107
 v_permlane32_swap_b32 v108, v76
 v_permlane32_swap_b32 v109, v77
 v_permlane32_swap_b32 v110, v78
 v_permlane32_swap_b32 v111, v79
 v_pk_add_f32 v[100:101], v[100:101], v[104:105]
 v_pk_add_f32 v[102:103], v[102:103], v[106:107]
 v_pk_add_f32 v[108:109], v[108:109], v[76:77]
 v_pk_add_f32 v[110:111], v[110:111], v[78:79]
 v_cvt_pk_bf16_f32 v80, v100, v101
 v_cvt_pk_bf16_f32 v82, v108, v109
 v_cvt_pk_bf16_f32 v81, v102, v103
 v_cvt_pk_bf16_f32 v83, v110, v111
 s_nop 0
 v_permlane16_swap_b32 v80, v82
 v_permlane16_swap_b32 v81, v83
 v_min_u32 v80, -2, v80
 s_mov_b64 exec, s[76:77]
 buffer_store_dwordx4 v[80:83], v15, s[24:27], s57 offen sc1
 s_mov_b64 exec, -1
 s_branch chain_done
step_68:
 s_and_b32 s21, s52, 3
 s_mul_i32 s81, s21, 540672
 s_mul_i32 s84, s21, 0x88000
 s_and_b32 s84, s84, 0x108000
 s_add_u32 s21, s52, 3
 s_and_b32 s21, s21, 3
 s_mul_i32 s83, s21, 0x88000
 s_and_b32 s83, s83, 0x108000
 s_add_u32 s21, s52, 1
 s_and_b32 s22, s21, 3
 s_mul_i32 s3, s22, 0x88000
 s_and_b32 s3, s3, 0x108000
 s_mul_i32 s80, s21, 393216
 s_add_u32 s46, s21, 1
 s_min_u32 s46, s46, 64
 s_mov_b32 s47, s57
 s_lshr_b32 s21, s52, 1
 s_bitcmp1_b32 s37, s21
 s_cselect_b32 s21, 8192, 0
 s_lshl_b32 s22, s52, 20
 s_or_b32 s22, s22, s21
 s_cmp_ge_u32 s52, 40
 s_cselect_b32 s57, 8192, 0
 s_xor_b32 s57, s57, s22
 s_xor_b32 s85, s22, 8192
 s_bfe_u32 s88, s52, 0x10002
 s_max_u32 s67, s52, 1
 s_sub_u32 s67, s67, 1
 v_mov_b32 v40, 0
 v_mov_b32 v41, 0
 v_mov_b32 v42, 0
 v_mov_b32 v43, 0
 v_mov_b32 v44, 0
 v_mov_b32 v45, 0
 v_mov_b32 v46, 0
 v_mov_b32 v47, 0
 v_mov_b32 v48, 0
 v_mov_b32 v49, 0
 v_mov_b32 v50, 0
 v_mov_b32 v51, 0
 v_mov_b32 v52, 0
 v_mov_b32 v53, 0
 v_mov_b32 v54, 0
 v_mov_b32 v55, 0
 v_mov_b32 v56, 0
 v_mov_b32 v57, 0
 v_mov_b32 v58, 0
 v_mov_b32 v59, 0
 v_mov_b32 v60, 0
 v_mov_b32 v61, 0
 v_mov_b32 v62, 0
 v_mov_b32 v63, 0
 v_mov_b32 v100, 0
 v_mov_b32 v101, 0
 v_mov_b32 v102, 0
 v_mov_b32 v103, 0
 v_mov_b32 v104, 0
 v_mov_b32 v105, 0
 v_mov_b32 v106, 0
 v_mov_b32 v107, 0
 v_mov_b32 v108, 0
 v_mov_b32 v109, 0
 v_mov_b32 v110, 0
 v_mov_b32 v111, 0
 s_sleep 6
 v_readfirstlane_b32 s21, v0
 s_cmp_lt_u32 s21, s46
 s_cselect_b32 s55, s55, 0
 s_cmp_lt_i32 s55, 0
 s_cbranch_scc1 fl_73
fl_74:
 s_mov_b32 s54, 0
 buffer_load_dwordx4 v[36:39], v4, s[4:7], s84 offen offset:2048 sc1
 buffer_load_dwordx4 v[28:31], v4, s[4:7], s84 offen offset:0 sc1
 buffer_load_dwordx4 v[32:35], v4, s[4:7], s84 offen offset:1024 sc1
 s_waitcnt vmcnt(3)
 v_mov_b32 v126, v88
 v_mov_b32 v127, v89
 v_mov_b32 v128, v90
 v_mov_b32 v129, v91
 v_mov_b32 v130, v92
 v_mov_b32 v131, v93
 v_mov_b32 v132, v94
 v_mov_b32 v133, v95
 v_mov_b32 v134, v96
 v_mov_b32 v135, v97
 v_mov_b32 v136, v98
 v_mov_b32 v137, v99
 s_waitcnt vmcnt(2)
 v_smfmac_f32_16x16x32_f16 v[40:43], v[36:37], a[16:19], v25
 v_smfmac_f32_16x16x32_f16 v[52:55], v[36:37], a[76:79], v25
 v_smfmac_f32_16x16x32_f16 v[44:47], v[36:37], a[36:39], v25
 s_waitcnt vmcnt(0)
 v_bitop3_b32 v27, v31, v35, v39 bitop3:0x80
 v_perm_b32 v31, v35, v31, s89
 v_cmp_gt_u32 vcc, 0x48000000, v27
 v_mov_b32 v35, v38
 v_smfmac_f32_16x16x32_f16 v[56:59], v[36:37], a[96:99], v25
 s_cbranch_vccnz pm_71
A2_72:
 v_smfmac_f32_16x16x64_f16 v[40:43], v[28:31], a[0:7], v25
 ds_write_b128 v10, v[28:31]
 v_smfmac_f32_16x16x64_f16 v[40:43], v[32:35], a[8:15], v25
 ds_write_b128 v10, v[32:35] offset:1024
 v_smfmac_f32_16x16x64_f16 v[52:55], v[28:31], a[60:67], v25
 ds_write_b64 v10, v[36:37] offset:2048
 v_smfmac_f32_16x16x64_f16 v[52:55], v[32:35], a[68:75], v25
 v_cvt_pk_f16_f32 v40, v40, v41
 v_cvt_pk_f16_f32 v41, v42, v43
 v_smfmac_f32_16x16x32_f16 v[48:51], v[36:37], a[56:59], v25
 v_smfmac_f32_16x16x32_f16 v[60:63], v[36:37], a[116:119], v25
 v_smfmac_f32_16x16x64_f16 v[44:47], v[28:31], a[20:27], v25
 v_cvt_pk_f16_f32 v52, v52, v53
 v_cvt_pk_f16_f32 v53, v54, v55
 s_nop 0
 v_smfmac_f32_16x16x64_f16 v[44:47], v[32:35], a[28:35], v25
 v_permlane32_swap_b32 v40, v52
 v_smfmac_f32_16x16x64_f16 v[56:59], v[28:31], a[80:87], v25
 v_permlane32_swap_b32 v41, v53
 v_pk_add_f16 v40, v40, v52
 v_smfmac_f32_16x16x64_f16 v[56:59], v[32:35], a[88:95], v25
 v_pk_add_f16 v41, v41, v53
 v_smfmac_f32_16x16x64_f16 v[48:51], v[28:31], a[40:47], v25
 ds_write_b64 v5, v[40:41] offset:0
 v_smfmac_f32_16x16x64_f16 v[48:51], v[32:35], a[48:55], v25
 v_cvt_pk_f16_f32 v44, v44, v45
 v_cvt_pk_f16_f32 v45, v46, v47
 v_cvt_pk_f16_f32 v56, v56, v57
 v_smfmac_f32_16x16x64_f16 v[60:63], v[28:31], a[100:107], v25
 v_cvt_pk_f16_f32 v57, v58, v59
 s_nop 0
 v_smfmac_f32_16x16x64_f16 v[60:63], v[32:35], a[108:115], v25
 v_permlane32_swap_b32 v44, v56
 v_permlane32_swap_b32 v45, v57
 v_pk_add_f16 v44, v44, v56
 v_pk_add_f16 v45, v45, v57
 ds_write_b64 v5, v[44:45] offset:640
 v_cvt_pk_f16_f32 v48, v48, v49
 v_cvt_pk_f16_f32 v49, v50, v51
 v_cvt_pk_f16_f32 v60, v60, v61
 v_cvt_pk_f16_f32 v61, v62, v63
 s_nop 0
 v_permlane32_swap_b32 v48, v60
 v_permlane32_swap_b32 v49, v61
 v_pk_add_f16 v48, v48, v60
 v_pk_add_f16 v49, v49, v61
 ds_write_b64 v5, v[48:49] offset:1280
 s_waitcnt lgkmcnt(0) vmcnt(0)
 s_barrier
 ds_read_b128 v[28:31], v16 offset:24576
 ds_read_b128 v[32:35], v16 offset:25600
 ds_read_b128 v[64:67], v16 offset:27648
 ds_read_b128 v[68:71], v16 offset:28672
 ds_read_b128 v[72:75], v16 offset:30720
 ds_read_b128 v[76:79], v16 offset:31744
 ds_read_b128 v[80:83], v16 offset:33792
 ds_read_b128 v[84:87], v16 offset:34816
 ds_read_b64 v[88:89], v16 offset:26624
 ds_read_b64 v[90:91], v16 offset:29696
 ds_read_b64 v[92:93], v16 offset:32768
 ds_read_b64 v[94:95], v16 offset:35840
 s_cmp_eq_u32 s52, 63
 s_cbranch_scc1 last_69
 s_waitcnt lgkmcnt(10)
 v_smfmac_f32_16x16x64_f16 v[100:103], v[28:31], a[120:127], v25
 v_smfmac_f32_16x16x64_f16 v[104:107], v[28:31], a[128:135], v25
 v_smfmac_f32_16x16x64_f16 v[108:111], v[28:31], a[136:143], v25
 s_mov_b32 s54, 0
 v_smfmac_f32_16x16x64_f16 v[100:103], v[32:35], a[144:151], v25
 v_readfirstlane_b32 s21, v0
 v_smfmac_f32_16x16x64_f16 v[104:107], v[32:35], a[152:159], v25
 s_add_u32 s22, s46, 3
 v_smfmac_f32_16x16x64_f16 v[108:111], v[32:35], a[160:167], v25
 s_min_u32 s22, s22, 64
 s_waitcnt lgkmcnt(7)
 v_smfmac_f32_16x16x64_f16 v[100:103], v[64:67], a[168:175], v25
 s_sub_u32 s55, s21, s22
 v_smfmac_f32_16x16x64_f16 v[104:107], v[64:67], a[176:183], v25
 s_sub_u32 s56, s21, s46
 v_smfmac_f32_16x16x64_f16 v[108:111], v[64:67], a[184:191], v25
 v_smfmac_f32_16x16x64_f16 v[100:103], v[68:71], a[192:199], v25
 v_smfmac_f32_16x16x64_f16 v[104:107], v[68:71], a[200:207], v25
 v_smfmac_f32_16x16x64_f16 v[108:111], v[68:71], a[208:215], v25
 v_smfmac_f32_16x16x64_f16 v[100:103], v[72:75], a[216:223], v25
 v_smfmac_f32_16x16x64_f16 v[104:107], v[72:75], a[224:231], v25
 v_smfmac_f32_16x16x64_f16 v[108:111], v[72:75], a[232:239], v25
 s_waitcnt lgkmcnt(4)
 v_smfmac_f32_16x16x64_f16 v[100:103], v[76:79], a[240:247], v25
 v_smfmac_f32_16x16x64_f16 v[104:107], v[76:79], a[248:255], v25
 v_smfmac_f32_16x16x64_f16 v[108:111], v[76:79], v[152:159], v25
 v_smfmac_f32_16x16x64_f16 v[100:103], v[80:83], v[160:167], v25
 v_smfmac_f32_16x16x64_f16 v[104:107], v[80:83], v[168:175], v25
 v_smfmac_f32_16x16x64_f16 v[108:111], v[80:83], v[176:183], v25
 v_smfmac_f32_16x16x64_f16 v[100:103], v[84:87], v[184:191], v25
 v_smfmac_f32_16x16x64_f16 v[104:107], v[84:87], v[192:199], v25
 v_smfmac_f32_16x16x64_f16 v[108:111], v[84:87], v[200:207], v25
 s_waitcnt lgkmcnt(0)
 v_smfmac_f32_16x16x64_f16 v[100:103], v[88:91], v[208:215], v25
 v_smfmac_f32_16x16x64_f16 v[104:107], v[88:91], v[216:223], v25
 v_smfmac_f32_16x16x64_f16 v[108:111], v[88:91], v[224:231], v25
 v_smfmac_f32_16x16x64_f16 v[100:103], v[92:95], v[232:239], v25
 v_smfmac_f32_16x16x64_f16 v[104:107], v[92:95], v[240:247], v25
 v_smfmac_f32_16x16x64_f16 v[108:111], v[92:95], v[248:255], v25
 s_sleep 2
 buffer_load_dwordx2 v[58:59], v9, s[8:11], s81 offen sc1
 buffer_load_dwordx4 v[40:43], v8, s[8:11], s81 offen offset:0 sc1
 buffer_load_dwordx4 v[44:47], v8, s[8:11], s81 offen offset:1024 sc1
 s_cmp_lt_i32 s56, 0
 s_cbranch_scc1 kvw_77
kvok_78:
 s_waitcnt vmcnt(2)
 v_xor_b32 v76, s88, v58
 s_nop 0
 v_permlane16_swap_b32 v58, v59
 v_fma_mix_f32 v60, v58, 1.0, v59 op_sel:[0,0,0] op_sel_hi:[1,0,1]
 v_fma_mix_f32 v61, v58, 1.0, v59 op_sel:[1,0,1] op_sel_hi:[1,0,1]
 v_mov_b32 v58, v60
 v_mov_b32 v59, v61
 s_nop 0
 v_permlane32_swap_b32 v58, v60
 v_permlane32_swap_b32 v59, v61
 v_add_f32 v52, v58, v60
 v_add_f32 v53, v59, v61
 v_max_f32 v79, v52, v53
 s_waitcnt vmcnt(0)
 v_pk_add_f16 v80, v40, v44
 v_pk_add_f16 v82, v42, v46
 v_pk_add_f16 v81, v41, v45
 v_pk_add_f16 v83, v43, v47
 v_permlane32_swap_b32 v80, v82
 v_bitop3_b32 v77, v40, v42, s88 bitop3:0x7e
 v_permlane32_swap_b32 v81, v83
 v_bitop3_b32 v78, v44, v46, s88 bitop3:0x7e
 v_fma_mix_f32 v48, v80, 1.0, v82 op_sel:[0,0,0] op_sel_hi:[1,0,1]
 v_or3_b32 v27, v76, v77, v78
 v_fma_mix_f32 v49, v80, 1.0, v82 op_sel:[1,0,1] op_sel_hi:[1,0,1]
 v_and_b32 v27, 1, v27
 v_fma_mix_f32 v50, v81, 1.0, v83 op_sel:[0,0,0] op_sel_hi:[1,0,1]
 v_cmp_ne_u32 vcc, 0, v27
 v_fma_mix_f32 v51, v81, 1.0, v83 op_sel:[1,0,1] op_sel_hi:[1,0,1]
 v_max3_f32 v62, v48, v49, v79
 s_cbranch_vccnz psr_75
psj_76:
 v_max3_f32 v62, v62, v50, v51
 v_cvt_pk_bf16_f32 v146, v100, v101
 v_cvt_pk_bf16_f32 v147, v102, v103
 v_max_f32_dpp v62, v62, v62 row_ror:8 row_mask:0xf bank_mask:0xf
 v_mov_b32 v63, v62
 v_cvt_pk_bf16_f32 v148, v104, v105
 v_cvt_pk_bf16_f32 v149, v106, v107
 v_permlane32_swap_b32 v62, v63
 v_max_f32 v62, v62, v63
 v_mov_b32 v63, v62
 v_cvt_pk_bf16_f32 v150, v108, v109
 v_cvt_pk_bf16_f32 v151, v110, v111
 v_permlane16_swap_b32 v62, v63
 v_max_f32 v62, v62, v63
 v_mul_f32 v62, s86, v62
 v_fma_f32 v48, v48, s86, -v62
 v_fma_f32 v49, v49, s86, -v62
 v_fma_f32 v50, v50, s86, -v62
 v_fma_f32 v51, v51, s86, -v62
 v_fma_f32 v52, v52, s86, -v62
 v_fma_f32 v53, v53, s86, -v62
 v_exp_f32 v48, v48
 v_exp_f32 v49, v49
 buffer_load_dwordx4 v[88:91], v17, s[28:31], s64 offen offset:0 sc1
 v_exp_f32 v50, v50
 v_exp_f32 v51, v51
 buffer_load_dwordx4 v[92:95], v16, s[28:31], s64 offen offset:1024 sc1
 v_exp_f32 v52, v52
 v_exp_f32 v53, v53
 buffer_load_dwordx4 v[96:99], v20, s[28:31], s64 offen offset:2048 sc1
 v_cvt_pk_bf16_f32 v138, v48, v49
 v_cvt_pk_bf16_f32 v139, v50, v51
 v_cvt_pk_bf16_f32 v142, v52, v53
 v_mov_b32_dpp v140, v138 row_ror:8 row_mask:0xf bank_mask:0xf
 v_mov_b32_dpp v141, v139 row_ror:8 row_mask:0xf bank_mask:0xf
 v_mov_b32_dpp v143, v142 row_ror:8 row_mask:0xf bank_mask:0xf
 v_mov_b32 v84, s67
 v_mov_b32 v85, s67
 s_mov_b64 exec, 15
 buffer_store_dwordx2 v[84:85], v24, s[12:15], s66 offen sc1
 s_mov_b64 exec, -1
 v_add_f32 v54, v48, v49
 v_mfma_f32_16x16x32_bf16 v[64:67], v[126:129], v[138:141], 0
 v_add_f32 v55, v50, v51
 v_add_f32 v56, v52, v53
 v_mfma_f32_16x16x32_bf16 v[64:67], v[146:149], v[142:145], v[64:67]
 v_add_f32 v62, v54, v55
 v_fmac_f32 v62, v56, v26
 v_mfma_f32_16x16x32_bf16 v[68:71], v[130:133], v[138:141], 0
 s_nop 0
 v_add_f32_dpp v62, v62, v62 row_ror:8 row_mask:0xf bank_mask:0xf
 v_mfma_f32_16x16x32_bf16 v[68:71], v[148:151], v[142:145], v[68:71]
 v_mov_b32 v63, v62
 s_cmp_lt_i32 s55, 0
 s_cbranch_scc1 fl_79
fl_80:
 v_mfma_f32_16x16x32_bf16 v[72:75], v[134:137], v[138:141], 0
 v_permlane32_swap_b32 v62, v63
 v_mfma_f32_16x16x32_bf16 v[72:75], v[150:153], v[142:145], v[72:75]
 v_add_f32 v62, v62, v63
 v_mov_b32 v63, v62
 ds_write_b128 v11, v[64:67] offset:0
 s_nop 0
 v_permlane16_swap_b32 v62, v63
 v_add_f32 v62, v62, v63
 v_rcp_f32 v62, v62
 ds_write_b128 v11, v[68:71] offset:1024
 s_mov_b64 exec, 0xff
 ds_write_b32 v22, v62
 s_mov_b64 exec, -1
 ds_write_b128 v11, v[72:75] offset:2048
 s_waitcnt lgkmcnt(0)
 s_barrier
 s_and_b32 s21, s52, 7
 s_cmp_lg_u32 s21, s50
 s_cbranch_scc1 zm_81
 v_mov_b32 v64, 0
 v_mov_b32 v65, 0
 v_mov_b32 v66, 0
 v_mov_b32 v67, 0
 s_mov_b64 exec, s[70:71]
 buffer_store_dwordx4 v[64:67], v13, s[4:7], s83 offen sc1
 s_mov_b64 exec, -1
zm_81:
 v_mov_b32 v76, v108
 v_mov_b32 v77, v109
 v_mov_b32 v78, v110
 v_mov_b32 v79, v111
 v_permlane32_swap_b32 v100, v104
 v_permlane32_swap_b32 v101, v105
 v_permlane32_swap_b32 v102, v106
 v_permlane32_swap_b32 v103, v107
 v_permlane32_swap_b32 v108, v76
 v_permlane32_swap_b32 v109, v77
 v_permlane32_swap_b32 v110, v78
 v_permlane32_swap_b32 v111, v79
 v_pk_add_f32 v[100:101], v[100:101], v[104:105]
 v_pk_add_f32 v[102:103], v[102:103], v[106:107]
 v_pk_add_f32 v[108:109], v[108:109], v[76:77]
 v_pk_add_f32 v[110:111], v[110:111], v[78:79]
 v_cvt_pk_bf16_f32 v80, v100, v101
 v_cvt_pk_bf16_f32 v82, v108, v109
 v_cvt_pk_bf16_f32 v81, v102, v103
 v_cvt_pk_bf16_f32 v83, v110, v111
 s_nop 0
 v_permlane16_swap_b32 v80, v82
 v_permlane16_swap_b32 v81, v83
 v_min_u32 v80, -2, v80
 s_mov_b64 exec, s[76:77]
 buffer_store_dwordx4 v[80:83], v15, s[24:27], s57 offen sc1
 s_mov_b64 exec, -1
 s_add_u32 s64, s64, 1310720
 s_add_u32 s52, s52, 1
 s_branch step_68
fl_73:
 buffer_load_dword v0, off, s[12:15], s79 sc1
 s_branch fl_74
A1_18:
 v_smfmac_f32_16x16x32_f16 v[40:43], v[36:37], a[16:19], v25
 v_smfmac_f32_16x16x32_f16 v[52:55], v[36:37], a[76:79], v25
 v_smfmac_f32_16x16x32_f16 v[44:47], v[36:37], a[36:39], v25
 v_smfmac_f32_16x16x32_f16 v[56:59], v[36:37], a[96:99], v25
 s_branch A2_72
pm_71:
 buffer_load_dwordx4 v[36:39], v4, s[4:7], s84 offen offset:2048 sc1
 buffer_load_dwordx4 v[28:31], v4, s[4:7], s84 offen offset:0 sc1
 buffer_load_dwordx4 v[32:35], v4, s[4:7], s84 offen offset:1024 sc1
 s_nop 7
 v_mov_b32 v40, 0
 v_mov_b32 v41, 0
 v_mov_b32 v42, 0
 v_mov_b32 v43, 0
 v_mov_b32 v52, 0
 v_mov_b32 v53, 0
 v_mov_b32 v54, 0
 v_mov_b32 v55, 0
 v_mov_b32 v44, 0
 v_mov_b32 v45, 0
 v_mov_b32 v46, 0
 v_mov_b32 v47, 0
 v_mov_b32 v56, 0
 v_mov_b32 v57, 0
 v_mov_b32 v58, 0
 v_mov_b32 v59, 0
 s_waitcnt vmcnt(0)
 v_bitop3_b32 v27, v31, v35, v39 bitop3:0x80
 v_perm_b32 v31, v35, v31, s89
 v_cmp_gt_u32 vcc, 0x48000000, v27
 v_mov_b32 v35, v38
 s_cbranch_vccz A1_18
pm_70:
 s_cmp_gt_u32 s52, 3
 s_cbranch_scc1 op_82
 v_readfirstlane_b32 s21, v0
 s_cmp_ge_u32 s21, s46
 s_cbranch_scc1 op_82
 buffer_load_dword v0, off, s[12:15], s79 sc1
 s_waitcnt vmcnt(0)
 v_readfirstlane_b32 s21, v0
 s_cmp_gt_u32 s21, s52
 s_cselect_b32 s21, s87, 0
 s_cmp_eq_u32 s21, 0
 s_cbranch_scc1 op_82
 s_mov_b32 s87, 0
 s_sub_u32 s21, s64, 1310720
 buffer_load_dwordx4 v[126:129], v16, s[28:31], s21 offen offset:0 sc1
 buffer_load_dwordx4 v[130:133], v16, s[28:31], s21 offen offset:1024 sc1
 buffer_load_dwordx4 v[134:137], v16, s[28:31], s21 offen offset:2048 sc1
op_82:
 buffer_load_dwordx4 v[36:39], v4, s[4:7], s84 offen offset:2048 sc1
 buffer_load_dwordx4 v[28:31], v4, s[4:7], s84 offen offset:0 sc1
 buffer_load_dwordx4 v[32:35], v4, s[4:7], s84 offen offset:1024 sc1
 s_add_u32 s54, s54, 1
 s_cmp_gt_u32 s54, 131072
 s_cbranch_scc1 end0
 s_waitcnt vmcnt(0)
 v_bitop3_b32 v27, v31, v35, v39 bitop3:0x80
 v_perm_b32 v31, v35, v31, s89
 v_cmp_gt_u32 vcc, 0x48000000, v27
 v_mov_b32 v35, v38
 s_cbranch_vccnz pm_70
 s_branch A1_18
psr_75:
 buffer_load_dwordx2 v[58:59], v9, s[8:11], s81 offen sc1
 buffer_load_dwordx4 v[40:43], v8, s[8:11], s81 offen offset:0 sc1
 buffer_load_dwordx4 v[44:47], v8, s[8:11], s81 offen offset:1024 sc1
 s_add_u32 s54, s54, 1
 s_cmp_gt_u32 s54, 131072
 s_cbranch_scc1 end0
 s_waitcnt vmcnt(2)
 v_xor_b32 v76, s88, v58
 s_nop 0
 v_permlane16_swap_b32 v58, v59
 v_fma_mix_f32 v60, v58, 1.0, v59 op_sel:[0,0,0] op_sel_hi:[1,0,1]
 v_fma_mix_f32 v61, v58, 1.0, v59 op_sel:[1,0,1] op_sel_hi:[1,0,1]
 v_mov_b32 v58, v60
 v_mov_b32 v59, v61
 s_nop 0
 v_permlane32_swap_b32 v58, v60
 v_permlane32_swap_b32 v59, v61
 v_add_f32 v52, v58, v60
 v_add_f32 v53, v59, v61
 v_max_f32 v79, v52, v53
 s_waitcnt vmcnt(0)
 v_pk_add_f16 v80, v40, v44
 v_pk_add_f16 v82, v42, v46
 v_pk_add_f16 v81, v41, v45
 v_pk_add_f16 v83, v43, v47
 v_permlane32_swap_b32 v80, v82
 v_bitop3_b32 v77, v40, v42, s88 bitop3:0x7e
 v_permlane32_swap_b32 v81, v83
 v_bitop3_b32 v78, v44, v46, s88 bitop3:0x7e
 v_fma_mix_f32 v48, v80, 1.0, v82 op_sel:[0,0,0] op_sel_hi:[1,0,1]
 v_or3_b32 v27, v76, v77, v78
 v_fma_mix_f32 v49, v80, 1.0, v82 op_sel:[1,0,1] op_sel_hi:[1,0,1]
 v_and_b32 v27, 1, v27
 v_fma_mix_f32 v50, v81, 1.0, v83 op_sel:[0,0,0] op_sel_hi:[1,0,1]
 v_cmp_ne_u32 vcc, 0, v27
 v_fma_mix_f32 v51, v81, 1.0, v83 op_sel:[1,0,1] op_sel_hi:[1,0,1]
 v_max3_f32 v62, v48, v49, v79
 s_cbranch_vccnz psr_75
 s_branch psj_76
kvw_77:
 s_mov_b32 s22, s87
 s_cmp_eq_u32 s52, 0
 s_cselect_b32 s55, 0, s55
 s_cselect_b32 s87, 1, 0
 s_cbranch_scc1 kvok_78
 v_mov_b32 v62, 0
 s_mov_b32 s101, 0
wf_83:
 buffer_load_dword v63, v62, s[12:15], s79 offen sc1
 s_add_u32 s101, s101, 1
 s_cmp_gt_u32 s101, 131072
 s_cbranch_scc1 end0
 s_waitcnt vmcnt(0)
 v_readfirstlane_b32 s100, v63
 s_cmp_ge_u32 s100, s46
 s_cbranch_scc1 wf_84
 s_sleep 3
 s_branch wf_83
wf_84:
 s_cmp_eq_u32 s22, 0
 s_cbranch_scc1 kvok_78
 s_sub_u32 s21, s64, 1310720
 buffer_load_dwordx4 v[126:129], v16, s[28:31], s21 offen offset:0 sc1
 buffer_load_dwordx4 v[130:133], v16, s[28:31], s21 offen offset:1024 sc1
 buffer_load_dwordx4 v[134:137], v16, s[28:31], s21 offen offset:2048 sc1
 s_waitcnt vmcnt(0)
 s_branch kvok_78
fl_79:
 buffer_load_dword v0, off, s[12:15], s79 sc1
 s_branch fl_80
last_69:
 s_waitcnt lgkmcnt(10)
 v_smfmac_f32_16x16x64_f16 v[100:103], v[28:31], a[120:127], v25
 v_smfmac_f32_16x16x64_f16 v[104:107], v[28:31], a[128:135], v25
 v_smfmac_f32_16x16x64_f16 v[108:111], v[28:31], a[136:143], v25
 v_smfmac_f32_16x16x64_f16 v[100:103], v[32:35], a[144:151], v25
 v_smfmac_f32_16x16x64_f16 v[104:107], v[32:35], a[152:159], v25
 v_smfmac_f32_16x16x64_f16 v[108:111], v[32:35], a[160:167], v25
 s_waitcnt lgkmcnt(7)
 v_smfmac_f32_16x16x64_f16 v[100:103], v[64:67], a[168:175], v25
 v_smfmac_f32_16x16x64_f16 v[104:107], v[64:67], a[176:183], v25
 v_smfmac_f32_16x16x64_f16 v[108:111], v[64:67], a[184:191], v25
 v_smfmac_f32_16x16x64_f16 v[100:103], v[68:71], a[192:199], v25
 v_smfmac_f32_16x16x64_f16 v[104:107], v[68:71], a[200:207], v25
 v_smfmac_f32_16x16x64_f16 v[108:111], v[68:71], a[208:215], v25
 v_smfmac_f32_16x16x64_f16 v[100:103], v[72:75], a[216:223], v25
 v_smfmac_f32_16x16x64_f16 v[104:107], v[72:75], a[224:231], v25
 v_smfmac_f32_16x16x64_f16 v[108:111], v[72:75], a[232:239], v25
 s_waitcnt lgkmcnt(4)
 v_smfmac_f32_16x16x64_f16 v[100:103], v[76:79], a[240:247], v25
 v_smfmac_f32_16x16x64_f16 v[104:107], v[76:79], a[248:255], v25
 v_smfmac_f32_16x16x64_f16 v[108:111], v[76:79], v[152:159], v25
 v_smfmac_f32_16x16x64_f16 v[100:103], v[80:83], v[160:167], v25
 v_smfmac_f32_16x16x64_f16 v[104:107], v[80:83], v[168:175], v25
 v_smfmac_f32_16x16x64_f16 v[108:111], v[80:83], v[176:183], v25
 v_smfmac_f32_16x16x64_f16 v[100:103], v[84:87], v[184:191], v25
 v_smfmac_f32_16x16x64_f16 v[104:107], v[84:87], v[192:199], v25
 v_smfmac_f32_16x16x64_f16 v[108:111], v[84:87], v[200:207], v25
 s_waitcnt lgkmcnt(0)
 v_smfmac_f32_16x16x64_f16 v[100:103], v[88:91], v[208:215], v25
 v_smfmac_f32_16x16x64_f16 v[104:107], v[88:91], v[216:223], v25
 v_smfmac_f32_16x16x64_f16 v[108:111], v[88:91], v[224:231], v25
 v_smfmac_f32_16x16x64_f16 v[100:103], v[92:95], v[232:239], v25
 v_smfmac_f32_16x16x64_f16 v[104:107], v[92:95], v[240:247], v25
 v_smfmac_f32_16x16x64_f16 v[108:111], v[92:95], v[248:255], v25
 s_nop 7
 v_mov_b32 v76, v108
 v_mov_b32 v77, v109
 v_mov_b32 v78, v110
 v_mov_b32 v79, v111
 v_permlane32_swap_b32 v100, v104
 v_permlane32_swap_b32 v101, v105
 v_permlane32_swap_b32 v102, v106
 v_permlane32_swap_b32 v103, v107
 v_permlane32_swap_b32 v108, v76
 v_permlane32_swap_b32 v109, v77
 v_permlane32_swap_b32 v110, v78
 v_permlane32_swap_b32 v111, v79
 v_pk_add_f32 v[100:101], v[100:101], v[104:105]
 v_pk_add_f32 v[102:103], v[102:103], v[106:107]
 v_pk_add_f32 v[108:109], v[108:109], v[76:77]
 v_pk_add_f32 v[110:111], v[110:111], v[78:79]
 v_cvt_pk_bf16_f32 v80, v100, v101
 v_cvt_pk_bf16_f32 v82, v108, v109
 v_cvt_pk_bf16_f32 v81, v102, v103
 v_cvt_pk_bf16_f32 v83, v110, v111
 s_nop 0
 v_permlane16_swap_b32 v80, v82
 v_permlane16_swap_b32 v81, v83
 v_min_u32 v80, -2, v80
 s_mov_b64 exec, s[76:77]
 buffer_store_dwordx4 v[80:83], v15, s[24:27], s57 offen sc1
 s_mov_b64 exec, -1
 s_branch chain_done
step_85:
 s_and_b32 s21, s52, 3
 s_mul_i32 s81, s21, 540672
 s_mul_i32 s84, s21, 0x88000
 s_and_b32 s84, s84, 0x108000
 s_add_u32 s21, s52, 3
 s_and_b32 s21, s21, 3
 s_mul_i32 s83, s21, 0x88000
 s_and_b32 s83, s83, 0x108000
 s_add_u32 s21, s52, 1
 s_and_b32 s22, s21, 3
 s_mul_i32 s3, s22, 0x88000
 s_and_b32 s3, s3, 0x108000
 s_mul_i32 s80, s21, 393216
 s_add_u32 s46, s21, 1
 s_min_u32 s46, s46, 64
 s_mov_b32 s47, s57
 s_lshr_b32 s21, s52, 1
 s_bitcmp1_b32 s37, s21
 s_cselect_b32 s21, 8192, 0
 s_lshl_b32 s22, s52, 20
 s_or_b32 s22, s22, s21
 s_cmp_ge_u32 s52, 40
 s_cselect_b32 s57, 8192, 0
 s_xor_b32 s57, s57, s22
 s_xor_b32 s85, s22, 8192
 s_bfe_u32 s88, s52, 0x10002
 s_max_u32 s67, s52, 1
 s_sub_u32 s67, s67, 1
 v_mov_b32 v40, 0
 v_mov_b32 v41, 0
 v_mov_b32 v42, 0
 v_mov_b32 v43, 0
 v_mov_b32 v44, 0
 v_mov_b32 v45, 0
 v_mov_b32 v46, 0
 v_mov_b32 v47, 0
 v_mov_b32 v48, 0
 v_mov_b32 v49, 0
 v_mov_b32 v50, 0
 v_mov_b32 v51, 0
 v_mov_b32 v52, 0
 v_mov_b32 v53, 0
 v_mov_b32 v54, 0
 v_mov_b32 v55, 0
 v_mov_b32 v56, 0
 v_mov_b32 v57, 0
 v_mov_b32 v58, 0
 v_mov_b32 v59, 0
 v_mov_b32 v60, 0
 v_mov_b32 v61, 0
 v_mov_b32 v62, 0
 v_mov_b32 v63, 0
 v_mov_b32 v100, 0
 v_mov_b32 v101, 0
 v_mov_b32 v102, 0
 v_mov_b32 v103, 0
 v_mov_b32 v104, 0
 v_mov_b32 v105, 0
 v_mov_b32 v106, 0
 v_mov_b32 v107, 0
 v_mov_b32 v108, 0
 v_mov_b32 v109, 0
 v_mov_b32 v110, 0
 v_mov_b32 v111, 0
 s_sleep 8
 v_readfirstlane_b32 s21, v0
 s_cmp_lt_u32 s21, s46
 s_cselect_b32 s55, s55, 0
 s_cmp_lt_i32 s55, 0
 s_cbranch_scc1 fl_90
fl_91:
 s_mov_b32 s54, 0
 buffer_load_dwordx4 v[36:39], v4, s[4:7], s84 offen offset:2048 sc1
 buffer_load_dwordx4 v[28:31], v4, s[4:7], s84 offen offset:0 sc1
 buffer_load_dwordx4 v[32:35], v4, s[4:7], s84 offen offset:1024 sc1
 s_waitcnt vmcnt(3)
 v_mov_b32 v126, v88
 v_mov_b32 v127, v89
 v_mov_b32 v128, v90
 v_mov_b32 v129, v91
 v_mov_b32 v130, v92
 v_mov_b32 v131, v93
 v_mov_b32 v132, v94
 v_mov_b32 v133, v95
 v_mov_b32 v134, v96
 v_mov_b32 v135, v97
 v_mov_b32 v136, v98
 v_mov_b32 v137, v99
 s_waitcnt vmcnt(2)
 v_smfmac_f32_16x16x32_f16 v[40:43], v[36:37], a[16:19], v25
 v_smfmac_f32_16x16x32_f16 v[52:55], v[36:37], a[76:79], v25
 v_smfmac_f32_16x16x32_f16 v[44:47], v[36:37], a[36:39], v25
 s_waitcnt vmcnt(0)
 v_bitop3_b32 v27, v31, v35, v39 bitop3:0x80
 v_perm_b32 v31, v35, v31, s89
 v_cmp_gt_u32 vcc, 0x48000000, v27
 v_mov_b32 v35, v38
 v_smfmac_f32_16x16x32_f16 v[56:59], v[36:37], a[96:99], v25
 s_cbranch_vccnz pm_88
A2_89:
 v_smfmac_f32_16x16x64_f16 v[40:43], v[28:31], a[0:7], v25
 ds_write_b128 v10, v[28:31]
 v_smfmac_f32_16x16x64_f16 v[40:43], v[32:35], a[8:15], v25
 ds_write_b128 v10, v[32:35] offset:1024
 v_smfmac_f32_16x16x64_f16 v[52:55], v[28:31], a[60:67], v25
 ds_write_b64 v10, v[36:37] offset:2048
 v_smfmac_f32_16x16x64_f16 v[52:55], v[32:35], a[68:75], v25
 v_cvt_pk_f16_f32 v40, v40, v41
 v_cvt_pk_f16_f32 v41, v42, v43
 v_smfmac_f32_16x16x32_f16 v[48:51], v[36:37], a[56:59], v25
 v_smfmac_f32_16x16x32_f16 v[60:63], v[36:37], a[116:119], v25
 v_smfmac_f32_16x16x64_f16 v[44:47], v[28:31], a[20:27], v25
 v_cvt_pk_f16_f32 v52, v52, v53
 v_cvt_pk_f16_f32 v53, v54, v55
 s_nop 0
 v_smfmac_f32_16x16x64_f16 v[44:47], v[32:35], a[28:35], v25
 v_permlane32_swap_b32 v40, v52
 v_smfmac_f32_16x16x64_f16 v[56:59], v[28:31], a[80:87], v25
 v_permlane32_swap_b32 v41, v53
 v_pk_add_f16 v40, v40, v52
 v_smfmac_f32_16x16x64_f16 v[56:59], v[32:35], a[88:95], v25
 v_pk_add_f16 v41, v41, v53
 v_smfmac_f32_16x16x64_f16 v[48:51], v[28:31], a[40:47], v25
 ds_write_b64 v5, v[40:41] offset:0
 v_smfmac_f32_16x16x64_f16 v[48:51], v[32:35], a[48:55], v25
 v_cvt_pk_f16_f32 v44, v44, v45
 v_cvt_pk_f16_f32 v45, v46, v47
 v_cvt_pk_f16_f32 v56, v56, v57
 v_smfmac_f32_16x16x64_f16 v[60:63], v[28:31], a[100:107], v25
 v_cvt_pk_f16_f32 v57, v58, v59
 s_nop 0
 v_smfmac_f32_16x16x64_f16 v[60:63], v[32:35], a[108:115], v25
 v_permlane32_swap_b32 v44, v56
 v_permlane32_swap_b32 v45, v57
 v_pk_add_f16 v44, v44, v56
 v_pk_add_f16 v45, v45, v57
 ds_write_b64 v5, v[44:45] offset:640
 v_cvt_pk_f16_f32 v48, v48, v49
 v_cvt_pk_f16_f32 v49, v50, v51
 v_cvt_pk_f16_f32 v60, v60, v61
 v_cvt_pk_f16_f32 v61, v62, v63
 s_nop 0
 v_permlane32_swap_b32 v48, v60
 v_permlane32_swap_b32 v49, v61
 v_pk_add_f16 v48, v48, v60
 v_pk_add_f16 v49, v49, v61
 ds_write_b64 v5, v[48:49] offset:1280
 s_waitcnt lgkmcnt(0) vmcnt(0)
 s_barrier
 s_lshr_b32 s21, 3, s20
 s_bitcmp1_b32 s21, 0
 s_cbranch_scc0 bw_93
 ds_read_b64_tr_b16 v[40:41], v21 offset:0
 ds_read_b64_tr_b16 v[42:43], v21 offset:1920
 ds_read_b64_tr_b16 v[44:45], v21 offset:640
 ds_read_b64_tr_b16 v[46:47], v21 offset:2560
 ds_read_b64_tr_b16 v[48:49], v21 offset:1280
 ds_read_b64_tr_b16 v[50:51], v21 offset:3200
 s_waitcnt lgkmcnt(4)
 v_fma_mix_f32 v52, v40, 1.0, v42 op_sel:[0,0,0] op_sel_hi:[1,0,1]
 v_fma_mix_f32 v53, v40, 1.0, v42 op_sel:[1,0,1] op_sel_hi:[1,0,1]
 v_fma_mix_f32 v54, v41, 1.0, v43 op_sel:[0,0,0] op_sel_hi:[1,0,1]
 v_fma_mix_f32 v55, v41, 1.0, v43 op_sel:[1,0,1] op_sel_hi:[1,0,1]
 v_add_f32_dpp v56, v52, v52 row_ror:8 row_mask:0xf bank_mask:0xf
 v_add_f32_dpp v57, v53, v53 row_ror:8 row_mask:0xf bank_mask:0xf
 v_add_f32_dpp v58, v54, v54 row_ror:8 row_mask:0xf bank_mask:0xf
 v_add_f32_dpp v59, v55, v55 row_ror:8 row_mask:0xf bank_mask:0xf
 v_cvt_pk_bf16_f32 v118, v56, v57
 v_cvt_pk_bf16_f32 v119, v58, v59
 s_waitcnt lgkmcnt(2)
 v_fma_mix_f32 v52, v44, 1.0, v46 op_sel:[0,0,0] op_sel_hi:[1,0,1]
 v_fma_mix_f32 v53, v44, 1.0, v46 op_sel:[1,0,1] op_sel_hi:[1,0,1]
 v_fma_mix_f32 v54, v45, 1.0, v47 op_sel:[0,0,0] op_sel_hi:[1,0,1]
 v_fma_mix_f32 v55, v45, 1.0, v47 op_sel:[1,0,1] op_sel_hi:[1,0,1]
 v_add_f32_dpp v56, v52, v52 row_ror:8 row_mask:0xf bank_mask:0xf
 v_add_f32_dpp v57, v53, v53 row_ror:8 row_mask:0xf bank_mask:0xf
 v_add_f32_dpp v58, v54, v54 row_ror:8 row_mask:0xf bank_mask:0xf
 v_add_f32_dpp v59, v55, v55 row_ror:8 row_mask:0xf bank_mask:0xf
 v_cvt_pk_bf16_f32 v120, v56, v57
 v_cvt_pk_bf16_f32 v121, v58, v59
 s_waitcnt lgkmcnt(0)
 v_fma_mix_f32 v52, v48, 1.0, v50 op_sel:[0,0,0] op_sel_hi:[1,0,1]
 v_fma_mix_f32 v53, v48, 1.0, v50 op_sel:[1,0,1] op_sel_hi:[1,0,1]
 v_fma_mix_f32 v54, v49, 1.0, v51 op_sel:[0,0,0] op_sel_hi:[1,0,1]
 v_fma_mix_f32 v55, v49, 1.0, v51 op_sel:[1,0,1] op_sel_hi:[1,0,1]
 v_mfma_f32_16x16x32_bf16 v[40:43], v[112:115], v[118:121], 0
 v_add_f32_dpp v56, v52, v52 row_ror:8 row_mask:0xf bank_mask:0xf
 v_add_f32_dpp v57, v53, v53 row_ror:8 row_mask:0xf bank_mask:0xf
 v_add_f32_dpp v58, v54, v54 row_ror:8 row_mask:0xf bank_mask:0xf
 v_add_f32_dpp v59, v55, v55 row_ror:8 row_mask:0xf bank_mask:0xf
 v_cvt_pk_bf16_f32 v122, v56, v57
 v_cvt_pk_bf16_f32 v123, v58, v59
 s_nop 1
 v_mfma_f32_16x16x32_bf16 v[40:43], v[116:119], v[122:125], v[40:43]
 ds_read_b128 v[28:31], v16 offset:24576
 ds_read_b128 v[32:35], v16 offset:25600
 ds_read_b128 v[64:67], v16 offset:27648
 ds_read_b128 v[68:71], v16 offset:28672
 ds_read_b128 v[72:75], v16 offset:30720
 ds_read_b128 v[76:79], v16 offset:31744
 s_nop 0
 s_mov_b64 exec, s[74:75]
 v_cvt_pk_f16_f32 v44, v40, v41
 v_cvt_pk_f16_f32 v45, v42, v43
 v_and_or_b32 v44, v44, -2, s88
 s_cmp_eq_u32 s53, 1
 s_cbranch_scc1 si_94
 buffer_store_dwordx2 v[44:45], v7, s[8:11], s81 offen sc1
 s_branch si_95
si_94:
 buffer_store_dwordx2 v[44:45], v7, s[8:11], s81 offen
si_95:
 s_mov_b64 exec, -1
 s_branch bw_92
bw_93:
 s_lshr_b32 s21, 4, s20
 s_bitcmp1_b32 s21, 0
 s_cbranch_scc0 bw_96
 ds_read_b64_tr_b16 v[40:41], v6 offset:0
 ds_read_b64_tr_b16 v[42:43], v6 offset:1920
 ds_read_b64_tr_b16 v[44:45], v6 offset:3840
 ds_read_b64_tr_b16 v[46:47], v6 offset:5760
 ds_read_b64_tr_b16 v[48:49], v6 offset:640
 ds_read_b64_tr_b16 v[50:51], v6 offset:2560
 ds_read_b64_tr_b16 v[52:53], v6 offset:4480
 ds_read_b64_tr_b16 v[54:55], v6 offset:6400
 ds_read_b64_tr_b16 v[56:57], v6 offset:1280
 ds_read_b64_tr_b16 v[58:59], v6 offset:3200
 ds_read_b64_tr_b16 v[60:61], v6 offset:5120
 ds_read_b64_tr_b16 v[62:63], v6 offset:7040
 s_waitcnt lgkmcnt(8)
 v_pk_add_f16 v40, v40, v42
 v_pk_add_f16 v44, v44, v46
 v_pk_add_f16 v41, v41, v43
 v_pk_add_f16 v45, v45, v47
 v_fma_mix_f32 v146, v40, 1.0, v44 op_sel:[0,0,0] op_sel_hi:[1,0,1]
 v_fma_mix_f32 v147, v40, 1.0, v44 op_sel:[1,0,1] op_sel_hi:[1,0,1]
 v_fma_mix_f32 v148, v41, 1.0, v45 op_sel:[0,0,0] op_sel_hi:[1,0,1]
 v_fma_mix_f32 v149, v41, 1.0, v45 op_sel:[1,0,1] op_sel_hi:[1,0,1]
 v_cvt_pk_bf16_f32 v118, v146, v147
 v_cvt_pk_bf16_f32 v119, v148, v149
 s_waitcnt lgkmcnt(4)
 v_pk_add_f16 v48, v48, v50
 v_pk_add_f16 v52, v52, v54
 v_pk_add_f16 v49, v49, v51
 v_pk_add_f16 v53, v53, v55
 v_fma_mix_f32 v146, v48, 1.0, v52 op_sel:[0,0,0] op_sel_hi:[1,0,1]
 v_fma_mix_f32 v147, v48, 1.0, v52 op_sel:[1,0,1] op_sel_hi:[1,0,1]
 v_fma_mix_f32 v148, v49, 1.0, v53 op_sel:[0,0,0] op_sel_hi:[1,0,1]
 v_fma_mix_f32 v149, v49, 1.0, v53 op_sel:[1,0,1] op_sel_hi:[1,0,1]
 v_cvt_pk_bf16_f32 v120, v146, v147
 v_cvt_pk_bf16_f32 v121, v148, v149
 s_waitcnt lgkmcnt(0)
 v_pk_add_f16 v56, v56, v58
 v_pk_add_f16 v60, v60, v62
 v_pk_add_f16 v57, v57, v59
 v_pk_add_f16 v61, v61, v63
 v_fma_mix_f32 v146, v56, 1.0, v60 op_sel:[0,0,0] op_sel_hi:[1,0,1]
 v_fma_mix_f32 v147, v56, 1.0, v60 op_sel:[1,0,1] op_sel_hi:[1,0,1]
 v_mfma_f32_16x16x32_bf16 v[40:43], v[118:121], v[118:121], 0
 v_fma_mix_f32 v148, v57, 1.0, v61 op_sel:[0,0,0] op_sel_hi:[1,0,1]
 v_fma_mix_f32 v149, v57, 1.0, v61 op_sel:[1,0,1] op_sel_hi:[1,0,1]
 v_cvt_pk_bf16_f32 v122, v146, v147
 v_cvt_pk_bf16_f32 v123, v148, v149
 s_nop 1
 v_mfma_f32_16x16x32_bf16 v[40:43], v[122:125], v[122:125], v[40:43]
 ds_read_b128 v[28:31], v16 offset:24576
 ds_read_b128 v[32:35], v16 offset:25600
 ds_read_b128 v[64:67], v16 offset:27648
 ds_read_b128 v[68:71], v16 offset:28672
 ds_read_b128 v[72:75], v16 offset:30720
 ds_read_b128 v[76:79], v16 offset:31744
 s_nop 0
 s_mov_b64 exec, s[74:75]
 v_cvt_pk_f16_f32 v44, v40, v41
 v_cvt_pk_f16_f32 v45, v42, v43
 v_and_or_b32 v44, v44, -2, s88
 s_cmp_eq_u32 s53, 1
 s_cbranch_scc1 si_97
 buffer_store_dwordx2 v[44:45], v7, s[8:11], s81 offen sc1
 s_branch si_98
si_97:
 buffer_store_dwordx2 v[44:45], v7, s[8:11], s81 offen
si_98:
 s_mov_b64 exec, -1
 s_branch bw_92
bw_96:
 s_lshr_b32 s21, 8, s20
 s_bitcmp1_b32 s21, 0
 s_cbranch_scc0 bw_99
 ds_read_b128 v[28:31], v16 offset:24576
 ds_read_b128 v[32:35], v16 offset:25600
 ds_read_b128 v[64:67], v16 offset:27648
 ds_read_b128 v[68:71], v16 offset:28672
 ds_read_b128 v[72:75], v16 offset:30720
 ds_read_b128 v[76:79], v16 offset:31744
 s_branch bw_92
bw_99:
bw_92:
 ds_read_b128 v[80:83], v16 offset:33792
 ds_read_b128 v[84:87], v16 offset:34816
 ds_read_b64 v[88:89], v16 offset:26624
 ds_read_b64 v[90:91], v16 offset:29696
 ds_read_b64 v[92:93], v16 offset:32768
 ds_read_b64 v[94:95], v16 offset:35840
 s_cmp_eq_u32 s52, 63
 s_cbranch_scc1 last_86
 s_waitcnt lgkmcnt(10)
 v_smfmac_f32_16x16x64_f16 v[100:103], v[28:31], a[120:127], v25
 v_smfmac_f32_16x16x64_f16 v[104:107], v[28:31], a[128:135], v25
 v_smfmac_f32_16x16x64_f16 v[108:111], v[28:31], a[136:143], v25
 s_mov_b32 s54, 0
 v_smfmac_f32_16x16x64_f16 v[100:103], v[32:35], a[144:151], v25
 v_readfirstlane_b32 s21, v0
 v_smfmac_f32_16x16x64_f16 v[104:107], v[32:35], a[152:159], v25
 s_add_u32 s22, s46, 3
 v_smfmac_f32_16x16x64_f16 v[108:111], v[32:35], a[160:167], v25
 s_min_u32 s22, s22, 64
 s_waitcnt lgkmcnt(7)
 v_smfmac_f32_16x16x64_f16 v[100:103], v[64:67], a[168:175], v25
 s_sub_u32 s55, s21, s22
 v_smfmac_f32_16x16x64_f16 v[104:107], v[64:67], a[176:183], v25
 s_sub_u32 s56, s21, s46
 v_smfmac_f32_16x16x64_f16 v[108:111], v[64:67], a[184:191], v25
 v_smfmac_f32_16x16x64_f16 v[100:103], v[68:71], a[192:199], v25
 v_smfmac_f32_16x16x64_f16 v[104:107], v[68:71], a[200:207], v25
 v_smfmac_f32_16x16x64_f16 v[108:111], v[68:71], a[208:215], v25
 v_smfmac_f32_16x16x64_f16 v[100:103], v[72:75], a[216:223], v25
 v_smfmac_f32_16x16x64_f16 v[104:107], v[72:75], a[224:231], v25
 v_smfmac_f32_16x16x64_f16 v[108:111], v[72:75], a[232:239], v25
 s_waitcnt lgkmcnt(4)
 v_smfmac_f32_16x16x64_f16 v[100:103], v[76:79], a[240:247], v25
 v_smfmac_f32_16x16x64_f16 v[104:107], v[76:79], a[248:255], v25
 v_smfmac_f32_16x16x64_f16 v[108:111], v[76:79], v[152:159], v25
 v_smfmac_f32_16x16x64_f16 v[100:103], v[80:83], v[160:167], v25
 v_smfmac_f32_16x16x64_f16 v[104:107], v[80:83], v[168:175], v25
 v_smfmac_f32_16x16x64_f16 v[108:111], v[80:83], v[176:183], v25
 v_smfmac_f32_16x16x64_f16 v[100:103], v[84:87], v[184:191], v25
 v_smfmac_f32_16x16x64_f16 v[104:107], v[84:87], v[192:199], v25
 v_smfmac_f32_16x16x64_f16 v[108:111], v[84:87], v[200:207], v25
 s_waitcnt lgkmcnt(0)
 v_smfmac_f32_16x16x64_f16 v[100:103], v[88:91], v[208:215], v25
 v_smfmac_f32_16x16x64_f16 v[104:107], v[88:91], v[216:223], v25
 v_smfmac_f32_16x16x64_f16 v[108:111], v[88:91], v[224:231], v25
 v_smfmac_f32_16x16x64_f16 v[100:103], v[92:95], v[232:239], v25
 v_smfmac_f32_16x16x64_f16 v[104:107], v[92:95], v[240:247], v25
 v_smfmac_f32_16x16x64_f16 v[108:111], v[92:95], v[248:255], v25
 buffer_load_dwordx2 v[58:59], v9, s[8:11], s81 offen sc1
 buffer_load_dwordx4 v[40:43], v8, s[8:11], s81 offen offset:0 sc1
 buffer_load_dwordx4 v[44:47], v8, s[8:11], s81 offen offset:1024 sc1
 s_cmp_lt_i32 s56, 0
 s_cbranch_scc1 kvw_102
kvok_103:
 s_waitcnt vmcnt(2)
 v_xor_b32 v76, s88, v58
 s_nop 0
 v_permlane16_swap_b32 v58, v59
 v_fma_mix_f32 v60, v58, 1.0, v59 op_sel:[0,0,0] op_sel_hi:[1,0,1]
 v_fma_mix_f32 v61, v58, 1.0, v59 op_sel:[1,0,1] op_sel_hi:[1,0,1]
 v_mov_b32 v58, v60
 v_mov_b32 v59, v61
 s_nop 0
 v_permlane32_swap_b32 v58, v60
 v_permlane32_swap_b32 v59, v61
 v_add_f32 v52, v58, v60
 v_add_f32 v53, v59, v61
 v_max_f32 v79, v52, v53
 s_waitcnt vmcnt(0)
 v_pk_add_f16 v80, v40, v44
 v_pk_add_f16 v82, v42, v46
 v_pk_add_f16 v81, v41, v45
 v_pk_add_f16 v83, v43, v47
 v_permlane32_swap_b32 v80, v82
 v_bitop3_b32 v77, v40, v42, s88 bitop3:0x7e
 v_permlane32_swap_b32 v81, v83
 v_bitop3_b32 v78, v44, v46, s88 bitop3:0x7e
 v_fma_mix_f32 v48, v80, 1.0, v82 op_sel:[0,0,0] op_sel_hi:[1,0,1]
 v_or3_b32 v27, v76, v77, v78
 v_fma_mix_f32 v49, v80, 1.0, v82 op_sel:[1,0,1] op_sel_hi:[1,0,1]
 v_and_b32 v27, 1, v27
 v_fma_mix_f32 v50, v81, 1.0, v83 op_sel:[0,0,0] op_sel_hi:[1,0,1]
 v_cmp_ne_u32 vcc, 0, v27
 v_fma_mix_f32 v51, v81, 1.0, v83 op_sel:[1,0,1] op_sel_hi:[1,0,1]
 v_max3_f32 v62, v48, v49, v79
 s_cbranch_vccnz psr_100
psj_101:
 v_max3_f32 v62, v62, v50, v51
 v_cvt_pk_bf16_f32 v146, v100, v101
 v_cvt_pk_bf16_f32 v147, v102, v103
 v_max_f32_dpp v62, v62, v62 row_ror:8 row_mask:0xf bank_mask:0xf
 v_mov_b32 v63, v62
 v_cvt_pk_bf16_f32 v148, v104, v105
 v_cvt_pk_bf16_f32 v149, v106, v107
 v_permlane32_swap_b32 v62, v63
 v_max_f32 v62, v62, v63
 v_mov_b32 v63, v62
 v_cvt_pk_bf16_f32 v150, v108, v109
 v_cvt_pk_bf16_f32 v151, v110, v111
 v_permlane16_swap_b32 v62, v63
 v_max_f32 v62, v62, v63
 v_mul_f32 v62, s86, v62
 v_fma_f32 v48, v48, s86, -v62
 v_fma_f32 v49, v49, s86, -v62
 v_fma_f32 v50, v50, s86, -v62
 v_fma_f32 v51, v51, s86, -v62
 v_fma_f32 v52, v52, s86, -v62
 v_fma_f32 v53, v53, s86, -v62
 v_exp_f32 v48, v48
 v_exp_f32 v49, v49
 buffer_load_dwordx4 v[88:91], v17, s[28:31], s64 offen offset:0 sc1
 v_exp_f32 v50, v50
 v_exp_f32 v51, v51
 buffer_load_dwordx4 v[92:95], v16, s[28:31], s64 offen offset:1024 sc1
 v_exp_f32 v52, v52
 v_exp_f32 v53, v53
 buffer_load_dwordx4 v[96:99], v20, s[28:31], s64 offen offset:2048 sc1
 v_cvt_pk_bf16_f32 v138, v48, v49
 v_cvt_pk_bf16_f32 v139, v50, v51
 v_cvt_pk_bf16_f32 v142, v52, v53
 v_mov_b32_dpp v140, v138 row_ror:8 row_mask:0xf bank_mask:0xf
 v_mov_b32_dpp v141, v139 row_ror:8 row_mask:0xf bank_mask:0xf
 v_mov_b32_dpp v143, v142 row_ror:8 row_mask:0xf bank_mask:0xf
 s_lshr_b32 s21, 3, s20
 s_bitcmp1_b32 s21, 0
 s_cbranch_scc0 bw_105
 buffer_load_dwordx4 v[112:115], v18, s[16:19], s80 offen sc1
 s_branch bw_104
bw_105:
 s_lshr_b32 s21, 8, s20
 s_bitcmp1_b32 s21, 0
 s_cbranch_scc0 bw_106
 v_mov_b32 v84, s67
 v_mov_b32 v85, s67
 s_mov_b64 exec, 15
 buffer_store_dwordx2 v[84:85], v24, s[12:15], s66 offen sc1
 s_mov_b64 exec, -1
 s_branch bw_104
bw_106:
bw_104:
 v_add_f32 v54, v48, v49
 v_mfma_f32_16x16x32_bf16 v[64:67], v[126:129], v[138:141], 0
 v_add_f32 v55, v50, v51
 v_add_f32 v56, v52, v53
 v_mfma_f32_16x16x32_bf16 v[64:67], v[146:149], v[142:145], v[64:67]
 v_add_f32 v62, v54, v55
 v_fmac_f32 v62, v56, v26
 v_mfma_f32_16x16x32_bf16 v[68:71], v[130:133], v[138:141], 0
 s_lshr_b32 s21, 3, s20
 s_bitcmp1_b32 s21, 0
 s_cbranch_scc0 bw_108
 buffer_load_dwordx2 v[116:117], v19, s[16:19], s80 offen sc1
 s_branch bw_107
bw_108:
bw_107:
 v_add_f32_dpp v62, v62, v62 row_ror:8 row_mask:0xf bank_mask:0xf
 v_mfma_f32_16x16x32_bf16 v[68:71], v[148:151], v[142:145], v[68:71]
 v_mov_b32 v63, v62
 s_cmp_lt_i32 s55, 0
 s_cbranch_scc1 fl_109
fl_110:
 v_mfma_f32_16x16x32_bf16 v[72:75], v[134:137], v[138:141], 0
 v_permlane32_swap_b32 v62, v63
 v_mfma_f32_16x16x32_bf16 v[72:75], v[150:153], v[142:145], v[72:75]
 v_add_f32 v62, v62, v63
 v_mov_b32 v63, v62
 ds_write_b128 v11, v[64:67] offset:0
 s_nop 0
 v_permlane16_swap_b32 v62, v63
 v_add_f32 v62, v62, v63
 v_rcp_f32 v62, v62
 ds_write_b128 v11, v[68:71] offset:1024
 s_mov_b64 exec, 0xff
 ds_write_b32 v22, v62
 s_mov_b64 exec, -1
 ds_write_b128 v11, v[72:75] offset:2048
 s_waitcnt lgkmcnt(0)
 s_barrier
 s_lshr_b32 s21, 7, s20
 s_bitcmp1_b32 s21, 0
 s_cbranch_scc0 bw_112
 ds_read_b128 v[72:75], v23
 ds_read_b64 v[64:65], v12 offset:0
 ds_read_b64 v[66:67], v12 offset:3072
 ds_read_b64 v[68:69], v12 offset:6144
 ds_read_b64 v[70:71], v12 offset:9216
 s_waitcnt lgkmcnt(2)
 v_pk_mul_f32 v[64:65], v[64:65], v[72:73] op_sel_hi:[1,0]
 v_pk_fma_f32 v[64:65], v[66:67], v[72:73], v[64:65] op_sel:[0,1,0] op_sel_hi:[1,1,1]
 s_waitcnt lgkmcnt(0)
 v_pk_fma_f32 v[64:65], v[68:69], v[74:75], v[64:65] op_sel_hi:[1,0,1]
 v_pk_fma_f32 v[64:65], v[70:71], v[74:75], v[64:65] op_sel:[0,1,0] op_sel_hi:[1,1,1]
 v_cvt_pk_f16_f32 v68, v64, v65
 v_perm_b32 v68, s91, v68, v14
 buffer_atomic_pk_add_f16 v68, v13, s[4:7], s3 offen
 s_branch bw_111
bw_112:
 s_lshr_b32 s21, 8, s20
 s_bitcmp1_b32 s21, 0
 s_cbranch_scc0 bw_113
 s_and_b32 s21, s52, 7
 s_cmp_lg_u32 s21, s50
 s_cbranch_scc1 zm_114
 v_mov_b32 v64, 0
 v_mov_b32 v65, 0
 v_mov_b32 v66, 0
 v_mov_b32 v67, 0
 s_mov_b64 exec, s[70:71]
 buffer_store_dwordx4 v[64:67], v13, s[4:7], s83 offen sc1
 s_mov_b64 exec, -1
zm_114:
 s_branch bw_111
bw_113:
bw_111:
 s_lshr_b32 s21, 4, s20
 s_bitcmp1_b32 s21, 0
 s_cbranch_scc0 bw_116
 s_mov_b64 exec, s[62:63]
 buffer_store_dwordx4 v[118:121], v18, s[24:27], s85 offen sc1
 buffer_store_dwordx2 v[122:123], v19, s[24:27], s85 offen sc1
 s_mov_b64 exec, -1
 s_branch bw_115
bw_116:
bw_115:
 v_mov_b32 v76, v108
 v_mov_b32 v77, v109
 v_mov_b32 v78, v110
 v_mov_b32 v79, v111
 v_permlane32_swap_b32 v100, v104
 v_permlane32_swap_b32 v101, v105
 v_permlane32_swap_b32 v102, v106
 v_permlane32_swap_b32 v103, v107
 v_permlane32_swap_b32 v108, v76
 v_permlane32_swap_b32 v109, v77
 v_permlane32_swap_b32 v110, v78
 v_permlane32_swap_b32 v111, v79
 v_pk_add_f32 v[100:101], v[100:101], v[104:105]
 v_pk_add_f32 v[102:103], v[102:103], v[106:107]
 v_pk_add_f32 v[108:109], v[108:109], v[76:77]
 v_pk_add_f32 v[110:111], v[110:111], v[78:79]
 v_cvt_pk_bf16_f32 v80, v100, v101
 v_cvt_pk_bf16_f32 v82, v108, v109
 v_cvt_pk_bf16_f32 v81, v102, v103
 v_cvt_pk_bf16_f32 v83, v110, v111
 s_nop 0
 v_permlane16_swap_b32 v80, v82
 v_permlane16_swap_b32 v81, v83
 v_min_u32 v80, -2, v80
 s_mov_b64 exec, s[76:77]
 buffer_store_dwordx4 v[80:83], v15, s[24:27], s57 offen sc1
 s_mov_b64 exec, -1
 s_add_u32 s64, s64, 1310720
 s_add_u32 s52, s52, 1
 s_branch step_85
fl_90:
 buffer_load_dword v0, off, s[12:15], s79 sc1
 s_branch fl_91
A1_19:
 v_smfmac_f32_16x16x32_f16 v[40:43], v[36:37], a[16:19], v25
 v_smfmac_f32_16x16x32_f16 v[52:55], v[36:37], a[76:79], v25
 v_smfmac_f32_16x16x32_f16 v[44:47], v[36:37], a[36:39], v25
 v_smfmac_f32_16x16x32_f16 v[56:59], v[36:37], a[96:99], v25
 s_branch A2_89
pm_88:
 buffer_load_dwordx4 v[36:39], v4, s[4:7], s84 offen offset:2048 sc1
 buffer_load_dwordx4 v[28:31], v4, s[4:7], s84 offen offset:0 sc1
 buffer_load_dwordx4 v[32:35], v4, s[4:7], s84 offen offset:1024 sc1
 s_nop 7
 v_mov_b32 v40, 0
 v_mov_b32 v41, 0
 v_mov_b32 v42, 0
 v_mov_b32 v43, 0
 v_mov_b32 v52, 0
 v_mov_b32 v53, 0
 v_mov_b32 v54, 0
 v_mov_b32 v55, 0
 v_mov_b32 v44, 0
 v_mov_b32 v45, 0
 v_mov_b32 v46, 0
 v_mov_b32 v47, 0
 v_mov_b32 v56, 0
 v_mov_b32 v57, 0
 v_mov_b32 v58, 0
 v_mov_b32 v59, 0
 s_waitcnt vmcnt(0)
 v_bitop3_b32 v27, v31, v35, v39 bitop3:0x80
 v_perm_b32 v31, v35, v31, s89
 v_cmp_gt_u32 vcc, 0x48000000, v27
 v_mov_b32 v35, v38
 s_cbranch_vccz A1_19
pm_87:
 s_cmp_gt_u32 s52, 3
 s_cbranch_scc1 op_117
 v_readfirstlane_b32 s21, v0
 s_cmp_ge_u32 s21, s46
 s_cbranch_scc1 op_117
 buffer_load_dword v0, off, s[12:15], s79 sc1
 s_waitcnt vmcnt(0)
 v_readfirstlane_b32 s21, v0
 s_cmp_gt_u32 s21, s52
 s_cselect_b32 s21, s87, 0
 s_cmp_eq_u32 s21, 0
 s_cbranch_scc1 op_117
 s_mov_b32 s87, 0
 s_sub_u32 s21, s64, 1310720
 buffer_load_dwordx4 v[126:129], v16, s[28:31], s21 offen offset:0 sc1
 buffer_load_dwordx4 v[130:133], v16, s[28:31], s21 offen offset:1024 sc1
 buffer_load_dwordx4 v[134:137], v16, s[28:31], s21 offen offset:2048 sc1
op_117:
 buffer_load_dwordx4 v[36:39], v4, s[4:7], s84 offen offset:2048 sc1
 buffer_load_dwordx4 v[28:31], v4, s[4:7], s84 offen offset:0 sc1
 buffer_load_dwordx4 v[32:35], v4, s[4:7], s84 offen offset:1024 sc1
 s_add_u32 s54, s54, 1
 s_cmp_gt_u32 s54, 131072
 s_cbranch_scc1 end0
 s_waitcnt vmcnt(0)
 v_bitop3_b32 v27, v31, v35, v39 bitop3:0x80
 v_perm_b32 v31, v35, v31, s89
 v_cmp_gt_u32 vcc, 0x48000000, v27
 v_mov_b32 v35, v38
 s_cbranch_vccnz pm_87
 s_branch A1_19
psr_100:
 buffer_load_dwordx2 v[58:59], v9, s[8:11], s81 offen sc1
 buffer_load_dwordx4 v[40:43], v8, s[8:11], s81 offen offset:0 sc1
 buffer_load_dwordx4 v[44:47], v8, s[8:11], s81 offen offset:1024 sc1
 s_add_u32 s54, s54, 1
 s_cmp_gt_u32 s54, 131072
 s_cbranch_scc1 end0
 s_waitcnt vmcnt(2)
 v_xor_b32 v76, s88, v58
 s_nop 0
 v_permlane16_swap_b32 v58, v59
 v_fma_mix_f32 v60, v58, 1.0, v59 op_sel:[0,0,0] op_sel_hi:[1,0,1]
 v_fma_mix_f32 v61, v58, 1.0, v59 op_sel:[1,0,1] op_sel_hi:[1,0,1]
 v_mov_b32 v58, v60
 v_mov_b32 v59, v61
 s_nop 0
 v_permlane32_swap_b32 v58, v60
 v_permlane32_swap_b32 v59, v61
 v_add_f32 v52, v58, v60
 v_add_f32 v53, v59, v61
 v_max_f32 v79, v52, v53
 s_waitcnt vmcnt(0)
 v_pk_add_f16 v80, v40, v44
 v_pk_add_f16 v82, v42, v46
 v_pk_add_f16 v81, v41, v45
 v_pk_add_f16 v83, v43, v47
 v_permlane32_swap_b32 v80, v82
 v_bitop3_b32 v77, v40, v42, s88 bitop3:0x7e
 v_permlane32_swap_b32 v81, v83
 v_bitop3_b32 v78, v44, v46, s88 bitop3:0x7e
 v_fma_mix_f32 v48, v80, 1.0, v82 op_sel:[0,0,0] op_sel_hi:[1,0,1]
 v_or3_b32 v27, v76, v77, v78
 v_fma_mix_f32 v49, v80, 1.0, v82 op_sel:[1,0,1] op_sel_hi:[1,0,1]
 v_and_b32 v27, 1, v27
 v_fma_mix_f32 v50, v81, 1.0, v83 op_sel:[0,0,0] op_sel_hi:[1,0,1]
 v_cmp_ne_u32 vcc, 0, v27
 v_fma_mix_f32 v51, v81, 1.0, v83 op_sel:[1,0,1] op_sel_hi:[1,0,1]
 v_max3_f32 v62, v48, v49, v79
 s_cbranch_vccnz psr_100
 s_branch psj_101
kvw_102:
 s_mov_b32 s22, s87
 s_cmp_eq_u32 s52, 0
 s_cselect_b32 s55, 0, s55
 s_cselect_b32 s87, 1, 0
 s_cbranch_scc1 kvok_103
 v_mov_b32 v62, 0
 s_mov_b32 s101, 0
wf_118:
 buffer_load_dword v63, v62, s[12:15], s79 offen sc1
 s_add_u32 s101, s101, 1
 s_cmp_gt_u32 s101, 131072
 s_cbranch_scc1 end0
 s_waitcnt vmcnt(0)
 v_readfirstlane_b32 s100, v63
 s_cmp_ge_u32 s100, s46
 s_cbranch_scc1 wf_119
 s_sleep 3
 s_branch wf_118
wf_119:
 s_cmp_eq_u32 s22, 0
 s_cbranch_scc1 kvok_103
 s_sub_u32 s21, s64, 1310720
 buffer_load_dwordx4 v[126:129], v16, s[28:31], s21 offen offset:0 sc1
 buffer_load_dwordx4 v[130:133], v16, s[28:31], s21 offen offset:1024 sc1
 buffer_load_dwordx4 v[134:137], v16, s[28:31], s21 offen offset:2048 sc1
 s_waitcnt vmcnt(0)
 s_branch kvok_103
fl_109:
 buffer_load_dword v0, off, s[12:15], s79 sc1
 s_branch fl_110
last_86:
 s_lshr_b32 s21, 4, s20
 s_bitcmp1_b32 s21, 0
 s_cbranch_scc0 bw_121
 s_mov_b64 exec, s[62:63]
 buffer_store_dwordx4 v[118:121], v18, s[24:27], s85 offen sc1
 buffer_store_dwordx2 v[122:123], v19, s[24:27], s85 offen sc1
 s_mov_b64 exec, -1
 s_branch bw_120
bw_121:
bw_120:
 s_waitcnt lgkmcnt(10)
 v_smfmac_f32_16x16x64_f16 v[100:103], v[28:31], a[120:127], v25
 v_smfmac_f32_16x16x64_f16 v[104:107], v[28:31], a[128:135], v25
 v_smfmac_f32_16x16x64_f16 v[108:111], v[28:31], a[136:143], v25
 v_smfmac_f32_16x16x64_f16 v[100:103], v[32:35], a[144:151], v25
 v_smfmac_f32_16x16x64_f16 v[104:107], v[32:35], a[152:159], v25
 v_smfmac_f32_16x16x64_f16 v[108:111], v[32:35], a[160:167], v25
 s_waitcnt lgkmcnt(7)
 v_smfmac_f32_16x16x64_f16 v[100:103], v[64:67], a[168:175], v25
 v_smfmac_f32_16x16x64_f16 v[104:107], v[64:67], a[176:183], v25
 v_smfmac_f32_16x16x64_f16 v[108:111], v[64:67], a[184:191], v25
 v_smfmac_f32_16x16x64_f16 v[100:103], v[68:71], a[192:199], v25
 v_smfmac_f32_16x16x64_f16 v[104:107], v[68:71], a[200:207], v25
 v_smfmac_f32_16x16x64_f16 v[108:111], v[68:71], a[208:215], v25
 v_smfmac_f32_16x16x64_f16 v[100:103], v[72:75], a[216:223], v25
 v_smfmac_f32_16x16x64_f16 v[104:107], v[72:75], a[224:231], v25
 v_smfmac_f32_16x16x64_f16 v[108:111], v[72:75], a[232:239], v25
 s_waitcnt lgkmcnt(4)
 v_smfmac_f32_16x16x64_f16 v[100:103], v[76:79], a[240:247], v25
 v_smfmac_f32_16x16x64_f16 v[104:107], v[76:79], a[248:255], v25
 v_smfmac_f32_16x16x64_f16 v[108:111], v[76:79], v[152:159], v25
 v_smfmac_f32_16x16x64_f16 v[100:103], v[80:83], v[160:167], v25
 v_smfmac_f32_16x16x64_f16 v[104:107], v[80:83], v[168:175], v25
 v_smfmac_f32_16x16x64_f16 v[108:111], v[80:83], v[176:183], v25
 v_smfmac_f32_16x16x64_f16 v[100:103], v[84:87], v[184:191], v25
 v_smfmac_f32_16x16x64_f16 v[104:107], v[84:87], v[192:199], v25
 v_smfmac_f32_16x16x64_f16 v[108:111], v[84:87], v[200:207], v25
 s_waitcnt lgkmcnt(0)
 v_smfmac_f32_16x16x64_f16 v[100:103], v[88:91], v[208:215], v25
 v_smfmac_f32_16x16x64_f16 v[104:107], v[88:91], v[216:223], v25
 v_smfmac_f32_16x16x64_f16 v[108:111], v[88:91], v[224:231], v25
 v_smfmac_f32_16x16x64_f16 v[100:103], v[92:95], v[232:239], v25
 v_smfmac_f32_16x16x64_f16 v[104:107], v[92:95], v[240:247], v25
 v_smfmac_f32_16x16x64_f16 v[108:111], v[92:95], v[248:255], v25
 s_nop 7
 v_mov_b32 v76, v108
 v_mov_b32 v77, v109
 v_mov_b32 v78, v110
 v_mov_b32 v79, v111
 v_permlane32_swap_b32 v100, v104
 v_permlane32_swap_b32 v101, v105
 v_permlane32_swap_b32 v102, v106
 v_permlane32_swap_b32 v103, v107
 v_permlane32_swap_b32 v108, v76
 v_permlane32_swap_b32 v109, v77
 v_permlane32_swap_b32 v110, v78
 v_permlane32_swap_b32 v111, v79
 v_pk_add_f32 v[100:101], v[100:101], v[104:105]
 v_pk_add_f32 v[102:103], v[102:103], v[106:107]
 v_pk_add_f32 v[108:109], v[108:109], v[76:77]
 v_pk_add_f32 v[110:111], v[110:111], v[78:79]
 v_cvt_pk_bf16_f32 v80, v100, v101
 v_cvt_pk_bf16_f32 v82, v108, v109
 v_cvt_pk_bf16_f32 v81, v102, v103
 v_cvt_pk_bf16_f32 v83, v110, v111
 s_nop 0
 v_permlane16_swap_b32 v80, v82
 v_permlane16_swap_b32 v81, v83
 v_min_u32 v80, -2, v80
 s_mov_b64 exec, s[76:77]
 buffer_store_dwordx4 v[80:83], v15, s[24:27], s57 offen sc1
 s_mov_b64 exec, -1
 s_lshr_b32 s21, 1, s20
 s_bitcmp1_b32 s21, 0
 s_cbranch_scc0 bw_123
 v_mov_b32 v246, 80
 v_mov_b32 v247, 1
 s_mov_b64 exec, 1
 buffer_atomic_add v247, v246, s[32:35], 0 offen sc0 sc1
 s_mov_b64 exec, -1
 s_branch bw_122
bw_123:
bw_122:
 s_branch chain_done
chain_done:
 s_waitcnt vmcnt(0) lgkmcnt(0)
 s_barrier
 s_mov_b32 s84, 0
 s_mov_b32 s85, -1
 s_mov_b32 s86, 0
 v_mov_b32 v21, 0
 v_mov_b32 v23, v247
 s_cmp_lg_u32 s20, 0
 s_cbranch_scc1 queue_b
 s_mov_b64 exec, 1
 s_branch queue_a
end0:
 s_endpgm
gemm_side:
 s_bfe_u32 s23, s22, 0x20005
 s_add_u32 s22, s22, 31
 s_and_b32 s22, s22, 31
 s_lshl_b32 s21, s23, 3
 s_add_u32 s2, s21, s22
 s_add_u32 s3, s2, 72
 s_add_u32 s24, s2, 48
 s_add_u32 s2, s2, s21
 s_cmp_lt_u32 s22, 24
 s_cselect_b32 s3, s24, s3
 s_cmp_lt_u32 s22, 16
 s_cselect_b32 s3, s2, s3
 s_mov_b32 s2, s3
gemm_roles:
 s_cmp_ge_u32 s3, 64
 s_cbranch_scc1 not_kv
 s_load_dwordx2 s[4:5], s[0:1], 0
 s_load_dwordx2 s[6:7], s[0:1], 24
 s_load_dwordx2 s[36:37], s[0:1], 32
 s_load_dwordx2 s[38:39], s[0:1], 104
 s_and_b32 s43, s3, 1
 s_bfe_u32 s42, s3, 0x50001
 s_lshr_b32 s40, s42, 2
 s_waitcnt lgkmcnt(0)
 s_cmp_eq_u32 s43, 1
 s_cselect_b32 s6, s36, s6
 s_cselect_b32 s7, s37, s7
 s_mov_b32 s8, s4
 s_mov_b32 s9, s5
 s_mov_b32 s10, 2621440
 s_mov_b32 s11, 0x00020000
 s_mov_b32 s12, s6
 s_mov_b32 s13, s7
 s_mov_b32 s14, 7864320
 s_mov_b32 s15, 0x00020000
 s_mov_b32 s16, s38
 s_mov_b32 s17, s39
 s_mov_b32 s18, 50331648
 s_mov_b32 s19, 0x00020000
 s_mul_i32 s44, s42, 384
 s_mov_b32 s62, 1024
 s_mov_b32 s24, 0
 s_mov_b32 s25, 81920
 s_mov_b32 s64, s32
 s_mov_b32 s65, s33
 s_mov_b32 s66, s34
 s_mov_b32 s67, s35
 s_load_dwordx2 s[72:73], s[0:1], 104
 s_waitcnt lgkmcnt(0)
 s_add_u32 s72, s72, 81068032
 s_addc_u32 s73, s73, 0
 s_mov_b32 s74, 129024
 s_mov_b32 s75, 0x00020000
 v_mov_b32 v9, 2731
 v_add_u32 v8, 0, v1
 v_mul_u32_u24 v7, v8, v9
 v_lshrrev_b32 v7, 16, v7
 v_mul_u32_u24 v4, 24, v7
 v_sub_u32 v8, v8, v4
 v_and_b32 v4, 2, v7
 v_xor_b32 v8, v8, v4
 v_xor_b32 v5, 4, v8
 s_mov_b32 s21, 12288
 v_mul_lo_u32 v7, v7, s21
 v_lshl_add_u32 v40, v8, 4, v7
 v_lshl_add_u32 v43, v5, 4, v7
 v_add_u32 v8, 64, v1
 v_mul_u32_u24 v7, v8, v9
 v_lshrrev_b32 v7, 16, v7
 v_mul_u32_u24 v4, 24, v7
 v_sub_u32 v8, v8, v4
 v_and_b32 v4, 2, v7
 v_xor_b32 v8, v8, v4
 v_xor_b32 v5, 4, v8
 s_mov_b32 s21, 12288
 v_mul_lo_u32 v7, v7, s21
 v_lshl_add_u32 v41, v8, 4, v7
 v_lshl_add_u32 v44, v5, 4, v7
 v_add_u32 v8, 128, v1
 v_mul_u32_u24 v7, v8, v9
 v_lshrrev_b32 v7, 16, v7
 v_mul_u32_u24 v4, 24, v7
 v_sub_u32 v8, v8, v4
 v_and_b32 v4, 2, v7
 v_xor_b32 v8, v8, v4
 v_xor_b32 v5, 4, v8
 s_mov_b32 s21, 12288
 v_mul_lo_u32 v7, v7, s21
 v_lshl_add_u32 v42, v8, 4, v7
 v_lshl_add_u32 v45, v5, 4, v7
 s_mul_i32 s21, s20, 393216
 s_add_u32 s21, s21, 0
 s_add_u32 s21, s21, s44
 s_mul_i32 s22, s20, 12288
 s_add_u32 s22, s22, 0
 s_add_u32 m0, s22, 0
 s_nop 0
 buffer_load_dwordx4 v40, s[12:15], s21 offen lds
 s_add_u32 m0, s22, 1024
 s_nop 0
 buffer_load_dwordx4 v41, s[12:15], s21 offen lds
 s_add_u32 m0, s22, 2048
 s_nop 0
 buffer_load_dwordx4 v42, s[12:15], s21 offen lds
 s_mul_i32 s21, s20, 393216
 s_add_u32 s21, s21, 98304
 s_add_u32 s21, s21, s44
 s_mul_i32 s22, s20, 12288
 s_add_u32 s22, s22, 3072
 s_add_u32 m0, s22, 0
 s_nop 0
 buffer_load_dwordx4 v43, s[12:15], s21 offen lds
 s_add_u32 m0, s22, 1024
 s_nop 0
 buffer_load_dwordx4 v44, s[12:15], s21 offen lds
 s_add_u32 m0, s22, 2048
 s_nop 0
 buffer_load_dwordx4 v45, s[12:15], s21 offen lds
 s_mul_i32 s21, s20, 393216
 s_add_u32 s21, s21, 196608
 s_add_u32 s21, s21, s44
 s_mul_i32 s22, s20, 12288
 s_add_u32 s22, s22, 6144
 s_add_u32 m0, s22, 0
 s_nop 0
 buffer_load_dwordx4 v40, s[12:15], s21 offen lds
 s_add_u32 m0, s22, 1024
 s_nop 0
 buffer_load_dwordx4 v41, s[12:15], s21 offen lds
 s_add_u32 m0, s22, 2048
 s_nop 0
 buffer_load_dwordx4 v42, s[12:15], s21 offen lds
 s_mul_i32 s21, s20, 393216
 s_add_u32 s21, s21, 294912
 s_add_u32 s21, s21, s44
 s_mul_i32 s22, s20, 12288
 s_add_u32 s22, s22, 9216
 s_add_u32 m0, s22, 0
 s_nop 0
 buffer_load_dwordx4 v43, s[12:15], s21 offen lds
 s_add_u32 m0, s22, 1024
 s_nop 0
 buffer_load_dwordx4 v44, s[12:15], s21 offen lds
 s_add_u32 m0, s22, 2048
 s_nop 0
 buffer_load_dwordx4 v45, s[12:15], s21 offen lds
 v_lshrrev_b32 v11, 3, v1
 v_and_b32 v12, 7, v1
 v_xor_b32 v12, v12, v11
 v_mul_u32_u24 v11, 1280, v11
 v_lshl_add_u32 v10, v12, 4, v11
 s_mul_i32 s46, s20, 20480
 v_add_u32 v10, s46, v10
 s_lshl_b32 s47, s20, 11
 s_add_u32 s47, s47, 98304
 s_add_u32 s46, s47, 57344
 s_mov_b32 s30, s24
 s_add_u32 s32, s47, 0
 v_add_u32 v11, 9216, v10
 s_mov_b32 m0, s32
 s_nop 0
 buffer_load_dwordx4 v10, s[8:11], s30 offen offset:0 lds
 buffer_load_dwordx4 v11, s[8:11], s30 offen offset:1024 lds
 s_add_u32 s30, s30, 128
 s_add_u32 s32, s32, 8192
 s_cmp_lt_u32 s32, s46
 s_cselect_b32 s32, s32, s47
 s_mov_b32 m0, s32
 s_nop 0
 buffer_load_dwordx4 v10, s[8:11], s30 offen offset:0 lds
 buffer_load_dwordx4 v11, s[8:11], s30 offen offset:1024 lds
 s_add_u32 s30, s30, 128
 s_add_u32 s32, s32, 8192
 s_cmp_lt_u32 s32, s46
 s_cselect_b32 s32, s32, s47
 s_mov_b32 m0, s32
 s_nop 0
 buffer_load_dwordx4 v10, s[8:11], s30 offen offset:0 lds
 buffer_load_dwordx4 v11, s[8:11], s30 offen offset:1024 lds
 s_add_u32 s30, s30, 128
 s_add_u32 s32, s32, 8192
 s_cmp_lt_u32 s32, s46
 s_cselect_b32 s32, s32, s47
 s_mov_b32 m0, s32
 s_nop 0
 buffer_load_dwordx4 v10, s[8:11], s30 offen offset:0 lds
 buffer_load_dwordx4 v11, s[8:11], s30 offen offset:1024 lds
 s_add_u32 s30, s30, 128
 s_add_u32 s32, s32, 8192
 s_cmp_lt_u32 s32, s46
 s_cselect_b32 s32, s32, s47
 s_mov_b32 m0, s32
 s_nop 0
 buffer_load_dwordx4 v10, s[8:11], s30 offen offset:0 lds
 buffer_load_dwordx4 v11, s[8:11], s30 offen offset:1024 lds
 s_add_u32 s30, s30, 128
 s_add_u32 s32, s32, 8192
 s_cmp_lt_u32 s32, s46
 s_cselect_b32 s32, s32, s47
 s_mul_i32 s21, s20, 393216
 s_add_u32 s21, s21, 1572864
 s_add_u32 s21, s21, s44
 s_mul_i32 s22, s20, 12288
 s_add_u32 s22, s22, 49152
 s_add_u32 m0, s22, 0
 s_nop 0
 buffer_load_dwordx4 v40, s[12:15], s21 offen lds
 s_add_u32 m0, s22, 1024
 s_nop 0
 buffer_load_dwordx4 v41, s[12:15], s21 offen lds
 s_add_u32 m0, s22, 2048
 s_nop 0
 buffer_load_dwordx4 v42, s[12:15], s21 offen lds
 s_mul_i32 s21, s20, 393216
 s_add_u32 s21, s21, 1671168
 s_add_u32 s21, s21, s44
 s_mul_i32 s22, s20, 12288
 s_add_u32 s22, s22, 52224
 s_add_u32 m0, s22, 0
 s_nop 0
 buffer_load_dwordx4 v43, s[12:15], s21 offen lds
 s_add_u32 m0, s22, 1024
 s_nop 0
 buffer_load_dwordx4 v44, s[12:15], s21 offen lds
 s_add_u32 m0, s22, 2048
 s_nop 0
 buffer_load_dwordx4 v45, s[12:15], s21 offen lds
 s_mul_i32 s21, s20, 393216
 s_add_u32 s21, s21, 1769472
 s_add_u32 s21, s21, s44
 s_mul_i32 s22, s20, 12288
 s_add_u32 s22, s22, 55296
 s_add_u32 m0, s22, 0
 s_nop 0
 buffer_load_dwordx4 v40, s[12:15], s21 offen lds
 s_add_u32 m0, s22, 1024
 s_nop 0
 buffer_load_dwordx4 v41, s[12:15], s21 offen lds
 s_add_u32 m0, s22, 2048
 s_nop 0
 buffer_load_dwordx4 v42, s[12:15], s21 offen lds
 s_mul_i32 s21, s20, 393216
 s_add_u32 s21, s21, 1867776
 s_add_u32 s21, s21, s44
 s_mul_i32 s22, s20, 12288
 s_add_u32 s22, s22, 58368
 s_add_u32 m0, s22, 0
 s_nop 0
 buffer_load_dwordx4 v43, s[12:15], s21 offen lds
 s_add_u32 m0, s22, 1024
 s_nop 0
 buffer_load_dwordx4 v44, s[12:15], s21 offen lds
 s_add_u32 m0, s22, 2048
 s_nop 0
 buffer_load_dwordx4 v45, s[12:15], s21 offen lds
 v_lshrrev_b32 v7, 2, v2
 v_and_b32 v4, 2, v7
 v_and_b32 v5, 1, v3
 v_lshl_or_b32 v4, v5, 2, v4
 v_lshl_add_u32 v7, v3, 3, v7
 v_mul_u32_u24 v7, 384, v7
 v_and_b32 v5, 1, v2
 v_lshl_add_u32 v7, v5, 3, v7
 v_bfe_u32 v8, v2, 1, 1
 s_mul_i32 s21, s20, 6
 v_add_u32 v8, s21, v8
 v_add_u32 v5, 0, v8
 v_xor_b32 v5, v5, v4
 v_lshl_add_u32 v46, v5, 4, v7
 v_add_u32 v49, 49152, v46
 v_add_u32 v5, 2, v8
 v_xor_b32 v5, v5, v4
 v_lshl_add_u32 v47, v5, 4, v7
 v_add_u32 v50, 49152, v47
 v_add_u32 v5, 4, v8
 v_xor_b32 v5, v5, v4
 v_lshl_add_u32 v48, v5, 4, v7
 v_add_u32 v51, 49152, v48
 s_mov_b32 s26, 6
 s_mul_i32 s27, s42, 12288
 s_mul_i32 s21, s43, 25165824
 s_add_u32 s27, s27, s21
 s_mov_b32 s28, 786432
 s_lshl_b32 s60, s40, 7
 s_add_u32 s60, s60, 0
 s_mov_b32 s61, 0
 v_and_b32 v6, 7, v2
 v_add_u32 v4, 0, v3
 v_xor_b32 v4, v4, v6
 v_lshlrev_b32 v4, 4, v4
 v_lshl_add_u32 v14, v2, 7, v4
 v_add_u32 v4, 4, v3
 v_xor_b32 v4, v4, v6
 v_lshlrev_b32 v4, 4, v4
 v_lshl_add_u32 v15, v2, 7, v4
 v_mul_u32_u24 v22, 400, v2
 v_mul_u32_u24 v4, 16, v3
 s_mul_i32 s21, s20, 96
 s_add_u32 s21, s21, 0
 v_add3_u32 v22, v22, v4, s21
 v_lshlrev_b32 v4, 3, v3
 v_sub_u32 v16, v22, v4
 v_mov_b32 v9, 2731
 s_mul_i32 s21, s20, 6400
 s_add_u32 s21, s21, 0
 v_mul_u32_u24 v4, 400, v2
 v_lshlrev_b32 v5, 4, v3
 v_add3_u32 v23, v4, v5, s21
 v_lshlrev_b32 v26, 4, v1
 s_mov_b32 s33, 98304
 s_mov_b32 s48, 0x80000000
 s_mov_b32 m0, s32
 s_nop 0
 buffer_load_dwordx4 v10, s[8:11], s30 offen offset:0 lds
 s_waitcnt vmcnt(21)
 s_barrier
 v_add_u32 v18, s33, v14
 v_add_u32 v19, s33, v15
 s_add_u32 s33, s33, 8192
 s_cmp_lt_u32 s33, 155648
 s_cselect_b32 s33, s33, 98304
 ds_read_b128 v[160:163], v18 offset:0
 ds_read_b128 v[164:167], v18 offset:2048
 ds_read_b128 v[168:171], v18 offset:4096
 ds_read_b128 v[172:175], v18 offset:6144
 s_waitcnt lgkmcnt(0)
 s_waitcnt vmcnt(23)
 s_barrier
 ds_read_b64_tr_b16 a[0:1], v46 offset:0
 ds_read_b64_tr_b16 a[2:3], v46 offset:1536
 ds_read_b64_tr_b16 a[4:5], v47 offset:0
 ds_read_b64_tr_b16 a[6:7], v47 offset:1536
 ds_read_b64_tr_b16 a[8:9], v48 offset:0
 ds_read_b64_tr_b16 a[10:11], v48 offset:1536
 ds_read_b64_tr_b16 a[12:13], v46 offset:12288
 ds_read_b64_tr_b16 a[14:15], v46 offset:13824
 ds_read_b64_tr_b16 a[16:17], v47 offset:12288
 ds_read_b64_tr_b16 a[18:19], v47 offset:13824
 ds_read_b64_tr_b16 a[20:21], v48 offset:12288
 ds_read_b64_tr_b16 a[22:23], v48 offset:13824
 ds_read_b64_tr_b16 a[24:25], v46 offset:24576
 ds_read_b64_tr_b16 a[26:27], v46 offset:26112
 ds_read_b64_tr_b16 a[28:29], v47 offset:24576
 ds_read_b64_tr_b16 a[30:31], v47 offset:26112
 ds_read_b64_tr_b16 a[32:33], v48 offset:24576
 ds_read_b64_tr_b16 a[34:35], v48 offset:26112
 ds_read_b64_tr_b16 a[36:37], v46 offset:36864
 ds_read_b64_tr_b16 a[38:39], v46 offset:38400
 ds_read_b64_tr_b16 a[40:41], v47 offset:36864
 ds_read_b64_tr_b16 a[42:43], v47 offset:38400
 ds_read_b64_tr_b16 a[44:45], v48 offset:36864
 ds_read_b64_tr_b16 a[46:47], v48 offset:38400
 s_waitcnt lgkmcnt(0)
 s_barrier
 s_mov_b32 s23, m0
 s_mul_i32 s21, s20, 393216
 s_add_u32 s21, s21, 3145728
 s_add_u32 s21, s21, s44
 s_mul_i32 s22, s20, 12288
 s_add_u32 s22, s22, 0
 s_add_u32 m0, s22, 0
 s_nop 0
 buffer_load_dwordx4 v40, s[12:15], s21 offen lds
 s_add_u32 m0, s22, 1024
 s_nop 0
 buffer_load_dwordx4 v41, s[12:15], s21 offen lds
 s_add_u32 m0, s22, 2048
 s_nop 0
 buffer_load_dwordx4 v42, s[12:15], s21 offen lds
 s_mul_i32 s21, s20, 393216
 s_add_u32 s21, s21, 3244032
 s_add_u32 s21, s21, s44
 s_mul_i32 s22, s20, 12288
 s_add_u32 s22, s22, 3072
 s_add_u32 m0, s22, 0
 s_nop 0
 buffer_load_dwordx4 v43, s[12:15], s21 offen lds
 s_add_u32 m0, s22, 1024
 s_nop 0
 buffer_load_dwordx4 v44, s[12:15], s21 offen lds
 s_add_u32 m0, s22, 2048
 s_nop 0
 buffer_load_dwordx4 v45, s[12:15], s21 offen lds
 s_mul_i32 s21, s20, 393216
 s_add_u32 s21, s21, 3342336
 s_add_u32 s21, s21, s44
 s_mul_i32 s22, s20, 12288
 s_add_u32 s22, s22, 6144
 s_add_u32 m0, s22, 0
 s_nop 0
 buffer_load_dwordx4 v40, s[12:15], s21 offen lds
 s_add_u32 m0, s22, 1024
 s_nop 0
 buffer_load_dwordx4 v41, s[12:15], s21 offen lds
 s_add_u32 m0, s22, 2048
 s_nop 0
 buffer_load_dwordx4 v42, s[12:15], s21 offen lds
 s_mul_i32 s21, s20, 393216
 s_add_u32 s21, s21, 3440640
 s_add_u32 s21, s21, s44
 s_mul_i32 s22, s20, 12288
 s_add_u32 s22, s22, 9216
 s_add_u32 m0, s22, 0
 s_nop 0
 buffer_load_dwordx4 v43, s[12:15], s21 offen lds
 s_add_u32 m0, s22, 1024
 s_nop 0
 buffer_load_dwordx4 v44, s[12:15], s21 offen lds
 s_add_u32 m0, s22, 2048
 s_nop 0
 buffer_load_dwordx4 v45, s[12:15], s21 offen lds
 s_mov_b32 m0, s23
 v_mfma_f32_16x16x32_bf16 v[64:67], a[0:3], v[160:163], 0
 ds_read_b128 v[192:195], v19 offset:0
 v_mfma_f32_16x16x32_bf16 v[68:71], a[4:7], v[160:163], 0
 v_add_u32 v18, s33, v14
 v_mfma_f32_16x16x32_bf16 v[72:75], a[8:11], v[160:163], 0
 v_mfma_f32_16x16x32_bf16 v[76:79], a[0:3], v[164:167], 0
 ds_read_b128 v[196:199], v19 offset:2048
 v_mfma_f32_16x16x32_bf16 v[80:83], a[4:7], v[164:167], 0
 buffer_load_dwordx4 v11, s[8:11], s30 offen offset:1024 lds
 v_mfma_f32_16x16x32_bf16 v[84:87], a[8:11], v[164:167], 0
 s_add_u32 s30, s30, 128
 v_mfma_f32_16x16x32_bf16 v[88:91], a[0:3], v[168:171], 0
 ds_read_b128 v[200:203], v19 offset:4096
 s_add_u32 m0, m0, 8192
 v_mfma_f32_16x16x32_bf16 v[92:95], a[4:7], v[168:171], 0
 s_cmp_lt_u32 m0, s46
 s_cselect_b32 m0, m0, s47
 v_mfma_f32_16x16x32_bf16 v[96:99], a[8:11], v[168:171], 0
 v_mfma_f32_16x16x32_bf16 v[100:103], a[0:3], v[172:175], 0
 ds_read_b128 v[204:207], v19 offset:6144
 v_mfma_f32_16x16x32_bf16 v[104:107], a[4:7], v[172:175], 0
 v_mfma_f32_16x16x32_bf16 v[108:111], a[8:11], v[172:175], 0
 s_waitcnt vmcnt(32) lgkmcnt(2)
 s_barrier
 v_mfma_f32_16x16x32_bf16 v[64:67], a[12:15], v[192:195], v[64:67]
 ds_read_b128 v[160:163], v18 offset:0
 v_mfma_f32_16x16x32_bf16 v[68:71], a[16:19], v[192:195], v[68:71]
 v_mfma_f32_16x16x32_bf16 v[72:75], a[20:23], v[192:195], v[72:75]
 v_add_u32 v19, s33, v15
 s_add_u32 s33, s33, 8192
 v_mfma_f32_16x16x32_bf16 v[76:79], a[12:15], v[196:199], v[76:79]
 ds_read_b128 v[164:167], v18 offset:2048
 v_mfma_f32_16x16x32_bf16 v[80:83], a[16:19], v[196:199], v[80:83]
 buffer_load_dwordx4 v10, s[8:11], s30 offen offset:0 lds
 v_mfma_f32_16x16x32_bf16 v[84:87], a[20:23], v[196:199], v[84:87]
 s_waitcnt lgkmcnt(2)
 v_mfma_f32_16x16x32_bf16 v[88:91], a[12:15], v[200:203], v[88:91]
 ds_read_b128 v[168:171], v18 offset:4096
 v_mfma_f32_16x16x32_bf16 v[92:95], a[16:19], v[200:203], v[92:95]
 s_cmp_lt_u32 s33, 155648
 s_cselect_b32 s33, s33, 98304
 v_mfma_f32_16x16x32_bf16 v[96:99], a[20:23], v[200:203], v[96:99]
 v_mfma_f32_16x16x32_bf16 v[100:103], a[12:15], v[204:207], v[100:103]
 ds_read_b128 v[172:175], v18 offset:6144
 v_mfma_f32_16x16x32_bf16 v[104:107], a[16:19], v[204:207], v[104:107]
 v_mfma_f32_16x16x32_bf16 v[108:111], a[20:23], v[204:207], v[108:111]
 s_waitcnt lgkmcnt(2)
 v_mfma_f32_16x16x32_bf16 v[64:67], a[24:27], v[160:163], v[64:67]
 ds_read_b128 v[192:195], v19 offset:0
 v_mfma_f32_16x16x32_bf16 v[68:71], a[28:31], v[160:163], v[68:71]
 v_add_u32 v18, s33, v14
 v_mfma_f32_16x16x32_bf16 v[72:75], a[32:35], v[160:163], v[72:75]
 v_mfma_f32_16x16x32_bf16 v[76:79], a[24:27], v[164:167], v[76:79]
 ds_read_b128 v[196:199], v19 offset:2048
 v_mfma_f32_16x16x32_bf16 v[80:83], a[28:31], v[164:167], v[80:83]
 buffer_load_dwordx4 v11, s[8:11], s30 offen offset:1024 lds
 v_mfma_f32_16x16x32_bf16 v[84:87], a[32:35], v[164:167], v[84:87]
 s_waitcnt lgkmcnt(2)
 s_add_u32 s30, s30, 128
 v_mfma_f32_16x16x32_bf16 v[88:91], a[24:27], v[168:171], v[88:91]
 ds_read_b128 v[200:203], v19 offset:4096
 s_add_u32 m0, m0, 8192
 v_mfma_f32_16x16x32_bf16 v[92:95], a[28:31], v[168:171], v[92:95]
 s_cmp_lt_u32 m0, s46
 s_cselect_b32 m0, m0, s47
 v_mfma_f32_16x16x32_bf16 v[96:99], a[32:35], v[168:171], v[96:99]
 v_mfma_f32_16x16x32_bf16 v[100:103], a[24:27], v[172:175], v[100:103]
 ds_read_b128 v[204:207], v19 offset:6144
 v_mfma_f32_16x16x32_bf16 v[104:107], a[28:31], v[172:175], v[104:107]
 v_mfma_f32_16x16x32_bf16 v[108:111], a[32:35], v[172:175], v[108:111]
 s_waitcnt vmcnt(32) lgkmcnt(2)
 s_barrier
 v_mfma_f32_16x16x32_bf16 v[64:67], a[36:39], v[192:195], v[64:67]
 ds_read_b128 v[160:163], v18 offset:0
 v_mfma_f32_16x16x32_bf16 v[68:71], a[40:43], v[192:195], v[68:71]
 v_mfma_f32_16x16x32_bf16 v[72:75], a[44:47], v[192:195], v[72:75]
 v_add_u32 v19, s33, v15
 s_add_u32 s33, s33, 8192
 v_mfma_f32_16x16x32_bf16 v[76:79], a[36:39], v[196:199], v[76:79]
 ds_read_b128 v[164:167], v18 offset:2048
 v_mfma_f32_16x16x32_bf16 v[80:83], a[40:43], v[196:199], v[80:83]
 buffer_load_dwordx4 v10, s[8:11], s30 offen offset:0 lds
 v_mfma_f32_16x16x32_bf16 v[84:87], a[44:47], v[196:199], v[84:87]
 s_waitcnt lgkmcnt(2)
 v_mfma_f32_16x16x32_bf16 v[88:91], a[36:39], v[200:203], v[88:91]
 ds_read_b128 v[168:171], v18 offset:4096
 v_mfma_f32_16x16x32_bf16 v[92:95], a[40:43], v[200:203], v[92:95]
 s_cmp_lt_u32 s33, 155648
 s_cselect_b32 s33, s33, 98304
 v_mfma_f32_16x16x32_bf16 v[96:99], a[44:47], v[200:203], v[96:99]
 v_mfma_f32_16x16x32_bf16 v[100:103], a[36:39], v[204:207], v[100:103]
 ds_read_b128 v[172:175], v18 offset:6144
 v_mfma_f32_16x16x32_bf16 v[104:107], a[40:43], v[204:207], v[104:107]
 v_mfma_f32_16x16x32_bf16 v[108:111], a[44:47], v[204:207], v[108:111]
 s_waitcnt lgkmcnt(2)
 s_waitcnt vmcnt(17)
 s_barrier
 ds_read_b64_tr_b16 a[48:49], v49 offset:0
 ds_read_b64_tr_b16 a[50:51], v49 offset:1536
 ds_read_b64_tr_b16 a[52:53], v50 offset:0
 ds_read_b64_tr_b16 a[54:55], v50 offset:1536
 ds_read_b64_tr_b16 a[56:57], v51 offset:0
 ds_read_b64_tr_b16 a[58:59], v51 offset:1536
 ds_read_b64_tr_b16 a[60:61], v49 offset:12288
 ds_read_b64_tr_b16 a[62:63], v49 offset:13824
 ds_read_b64_tr_b16 a[64:65], v50 offset:12288
 ds_read_b64_tr_b16 a[66:67], v50 offset:13824
 ds_read_b64_tr_b16 a[68:69], v51 offset:12288
 ds_read_b64_tr_b16 a[70:71], v51 offset:13824
 ds_read_b64_tr_b16 a[72:73], v49 offset:24576
 ds_read_b64_tr_b16 a[74:75], v49 offset:26112
 ds_read_b64_tr_b16 a[76:77], v50 offset:24576
 ds_read_b64_tr_b16 a[78:79], v50 offset:26112
 ds_read_b64_tr_b16 a[80:81], v51 offset:24576
 ds_read_b64_tr_b16 a[82:83], v51 offset:26112
 ds_read_b64_tr_b16 a[84:85], v49 offset:36864
 ds_read_b64_tr_b16 a[86:87], v49 offset:38400
 ds_read_b64_tr_b16 a[88:89], v50 offset:36864
 ds_read_b64_tr_b16 a[90:91], v50 offset:38400
 ds_read_b64_tr_b16 a[92:93], v51 offset:36864
 ds_read_b64_tr_b16 a[94:95], v51 offset:38400
 s_waitcnt lgkmcnt(0)
 s_barrier
 s_mov_b32 s23, m0
 s_mul_i32 s21, s20, 393216
 s_add_u32 s21, s21, 4718592
 s_add_u32 s21, s21, s44
 s_mul_i32 s22, s20, 12288
 s_add_u32 s22, s22, 49152
 s_add_u32 m0, s22, 0
 s_nop 0
 buffer_load_dwordx4 v40, s[12:15], s21 offen lds
 s_add_u32 m0, s22, 1024
 s_nop 0
 buffer_load_dwordx4 v41, s[12:15], s21 offen lds
 s_add_u32 m0, s22, 2048
 s_nop 0
 buffer_load_dwordx4 v42, s[12:15], s21 offen lds
 s_mul_i32 s21, s20, 393216
 s_add_u32 s21, s21, 4816896
 s_add_u32 s21, s21, s44
 s_mul_i32 s22, s20, 12288
 s_add_u32 s22, s22, 52224
 s_add_u32 m0, s22, 0
 s_nop 0
 buffer_load_dwordx4 v43, s[12:15], s21 offen lds
 s_add_u32 m0, s22, 1024
 s_nop 0
 buffer_load_dwordx4 v44, s[12:15], s21 offen lds
 s_add_u32 m0, s22, 2048
 s_nop 0
 buffer_load_dwordx4 v45, s[12:15], s21 offen lds
 s_mul_i32 s21, s20, 393216
 s_add_u32 s21, s21, 4915200
 s_add_u32 s21, s21, s44
 s_mul_i32 s22, s20, 12288
 s_add_u32 s22, s22, 55296
 s_add_u32 m0, s22, 0
 s_nop 0
 buffer_load_dwordx4 v40, s[12:15], s21 offen lds
 s_add_u32 m0, s22, 1024
 s_nop 0
 buffer_load_dwordx4 v41, s[12:15], s21 offen lds
 s_add_u32 m0, s22, 2048
 s_nop 0
 buffer_load_dwordx4 v42, s[12:15], s21 offen lds
 s_mul_i32 s21, s20, 393216
 s_add_u32 s21, s21, 5013504
 s_add_u32 s21, s21, s44
 s_mul_i32 s22, s20, 12288
 s_add_u32 s22, s22, 58368
 s_add_u32 m0, s22, 0
 s_nop 0
 buffer_load_dwordx4 v43, s[12:15], s21 offen lds
 s_add_u32 m0, s22, 1024
 s_nop 0
 buffer_load_dwordx4 v44, s[12:15], s21 offen lds
 s_add_u32 m0, s22, 2048
 s_nop 0
 buffer_load_dwordx4 v45, s[12:15], s21 offen lds
 s_mov_b32 m0, s23
 v_mfma_f32_16x16x32_bf16 v[64:67], a[48:51], v[160:163], v[64:67]
 ds_read_b128 v[192:195], v19 offset:0
 v_mfma_f32_16x16x32_bf16 v[68:71], a[52:55], v[160:163], v[68:71]
 v_add_u32 v18, s33, v14
 v_mfma_f32_16x16x32_bf16 v[72:75], a[56:59], v[160:163], v[72:75]
 v_mfma_f32_16x16x32_bf16 v[76:79], a[48:51], v[164:167], v[76:79]
 ds_read_b128 v[196:199], v19 offset:2048
 v_mfma_f32_16x16x32_bf16 v[80:83], a[52:55], v[164:167], v[80:83]
 buffer_load_dwordx4 v11, s[8:11], s30 offen offset:1024 lds
 v_mfma_f32_16x16x32_bf16 v[84:87], a[56:59], v[164:167], v[84:87]
 s_add_u32 s30, s30, 128
 v_mfma_f32_16x16x32_bf16 v[88:91], a[48:51], v[168:171], v[88:91]
 ds_read_b128 v[200:203], v19 offset:4096
 s_add_u32 m0, m0, 8192
 v_mfma_f32_16x16x32_bf16 v[92:95], a[52:55], v[168:171], v[92:95]
 s_cmp_lt_u32 m0, s46
 s_cselect_b32 m0, m0, s47
 v_mfma_f32_16x16x32_bf16 v[96:99], a[56:59], v[168:171], v[96:99]
 v_mfma_f32_16x16x32_bf16 v[100:103], a[48:51], v[172:175], v[100:103]
 ds_read_b128 v[204:207], v19 offset:6144
 v_mfma_f32_16x16x32_bf16 v[104:107], a[52:55], v[172:175], v[104:107]
 v_mfma_f32_16x16x32_bf16 v[108:111], a[56:59], v[172:175], v[108:111]
 s_waitcnt vmcnt(44) lgkmcnt(2)
 s_barrier
 v_mfma_f32_16x16x32_bf16 v[64:67], a[60:63], v[192:195], v[64:67]
 ds_read_b128 v[160:163], v18 offset:0
 v_mfma_f32_16x16x32_bf16 v[68:71], a[64:67], v[192:195], v[68:71]
 v_mfma_f32_16x16x32_bf16 v[72:75], a[68:71], v[192:195], v[72:75]
 v_add_u32 v19, s33, v15
 s_add_u32 s33, s33, 8192
 v_mfma_f32_16x16x32_bf16 v[76:79], a[60:63], v[196:199], v[76:79]
 ds_read_b128 v[164:167], v18 offset:2048
 v_mfma_f32_16x16x32_bf16 v[80:83], a[64:67], v[196:199], v[80:83]
 buffer_load_dwordx4 v10, s[8:11], s30 offen offset:0 lds
 v_mfma_f32_16x16x32_bf16 v[84:87], a[68:71], v[196:199], v[84:87]
 s_waitcnt lgkmcnt(2)
 v_mfma_f32_16x16x32_bf16 v[88:91], a[60:63], v[200:203], v[88:91]
 ds_read_b128 v[168:171], v18 offset:4096
 v_mfma_f32_16x16x32_bf16 v[92:95], a[64:67], v[200:203], v[92:95]
 s_cmp_lt_u32 s33, 155648
 s_cselect_b32 s33, s33, 98304
 v_mfma_f32_16x16x32_bf16 v[96:99], a[68:71], v[200:203], v[96:99]
 v_mfma_f32_16x16x32_bf16 v[100:103], a[60:63], v[204:207], v[100:103]
 ds_read_b128 v[172:175], v18 offset:6144
 v_mfma_f32_16x16x32_bf16 v[104:107], a[64:67], v[204:207], v[104:107]
 v_mfma_f32_16x16x32_bf16 v[108:111], a[68:71], v[204:207], v[108:111]
 s_waitcnt lgkmcnt(2)
 v_mfma_f32_16x16x32_bf16 v[64:67], a[72:75], v[160:163], v[64:67]
 ds_read_b128 v[192:195], v19 offset:0
 v_mfma_f32_16x16x32_bf16 v[68:71], a[76:79], v[160:163], v[68:71]
 v_add_u32 v18, s33, v14
 v_mfma_f32_16x16x32_bf16 v[72:75], a[80:83], v[160:163], v[72:75]
 v_mfma_f32_16x16x32_bf16 v[76:79], a[72:75], v[164:167], v[76:79]
 ds_read_b128 v[196:199], v19 offset:2048
 v_mfma_f32_16x16x32_bf16 v[80:83], a[76:79], v[164:167], v[80:83]
 buffer_load_dwordx4 v11, s[8:11], s30 offen offset:1024 lds
 v_mfma_f32_16x16x32_bf16 v[84:87], a[80:83], v[164:167], v[84:87]
 s_waitcnt lgkmcnt(2)
 s_add_u32 s30, s30, 128
 v_mfma_f32_16x16x32_bf16 v[88:91], a[72:75], v[168:171], v[88:91]
 ds_read_b128 v[200:203], v19 offset:4096
 s_add_u32 m0, m0, 8192
 v_mfma_f32_16x16x32_bf16 v[92:95], a[76:79], v[168:171], v[92:95]
 s_cmp_lt_u32 m0, s46
 s_cselect_b32 m0, m0, s47
 v_mfma_f32_16x16x32_bf16 v[96:99], a[80:83], v[168:171], v[96:99]
 v_mfma_f32_16x16x32_bf16 v[100:103], a[72:75], v[172:175], v[100:103]
 ds_read_b128 v[204:207], v19 offset:6144
 v_mfma_f32_16x16x32_bf16 v[104:107], a[76:79], v[172:175], v[104:107]
 v_mfma_f32_16x16x32_bf16 v[108:111], a[80:83], v[172:175], v[108:111]
 s_waitcnt vmcnt(44) lgkmcnt(2)
 s_barrier
 v_mfma_f32_16x16x32_bf16 v[64:67], a[84:87], v[192:195], v[64:67]
 ds_read_b128 v[160:163], v18 offset:0
 v_mfma_f32_16x16x32_bf16 v[68:71], a[88:91], v[192:195], v[68:71]
 v_mfma_f32_16x16x32_bf16 v[72:75], a[92:95], v[192:195], v[72:75]
 v_add_u32 v19, s33, v15
 s_add_u32 s33, s33, 8192
 v_mfma_f32_16x16x32_bf16 v[76:79], a[84:87], v[196:199], v[76:79]
 ds_read_b128 v[164:167], v18 offset:2048
 v_mfma_f32_16x16x32_bf16 v[80:83], a[88:91], v[196:199], v[80:83]
 buffer_load_dwordx4 v10, s[8:11], s30 offen offset:0 lds
 v_mfma_f32_16x16x32_bf16 v[84:87], a[92:95], v[196:199], v[84:87]
 s_waitcnt lgkmcnt(2)
 v_mfma_f32_16x16x32_bf16 v[88:91], a[84:87], v[200:203], v[88:91]
 ds_read_b128 v[168:171], v18 offset:4096
 v_mfma_f32_16x16x32_bf16 v[92:95], a[88:91], v[200:203], v[92:95]
 s_cmp_lt_u32 s33, 155648
 s_cselect_b32 s33, s33, 98304
 v_mfma_f32_16x16x32_bf16 v[96:99], a[92:95], v[200:203], v[96:99]
 v_mfma_f32_16x16x32_bf16 v[100:103], a[84:87], v[204:207], v[100:103]
 ds_read_b128 v[172:175], v18 offset:6144
 v_mfma_f32_16x16x32_bf16 v[104:107], a[88:91], v[204:207], v[104:107]
 v_mfma_f32_16x16x32_bf16 v[108:111], a[92:95], v[204:207], v[108:111]
 s_waitcnt lgkmcnt(2)
 s_waitcnt vmcnt(20)
 s_barrier
 ds_read_b64_tr_b16 a[96:97], v46 offset:0
 ds_read_b64_tr_b16 a[98:99], v46 offset:1536
 ds_read_b64_tr_b16 a[100:101], v47 offset:0
 ds_read_b64_tr_b16 a[102:103], v47 offset:1536
 ds_read_b64_tr_b16 a[104:105], v48 offset:0
 ds_read_b64_tr_b16 a[106:107], v48 offset:1536
 ds_read_b64_tr_b16 a[108:109], v46 offset:12288
 ds_read_b64_tr_b16 a[110:111], v46 offset:13824
 ds_read_b64_tr_b16 a[112:113], v47 offset:12288
 ds_read_b64_tr_b16 a[114:115], v47 offset:13824
 ds_read_b64_tr_b16 a[116:117], v48 offset:12288
 ds_read_b64_tr_b16 a[118:119], v48 offset:13824
 ds_read_b64_tr_b16 a[120:121], v46 offset:24576
 ds_read_b64_tr_b16 a[122:123], v46 offset:26112
 ds_read_b64_tr_b16 a[124:125], v47 offset:24576
 ds_read_b64_tr_b16 a[126:127], v47 offset:26112
 ds_read_b64_tr_b16 a[128:129], v48 offset:24576
 ds_read_b64_tr_b16 a[130:131], v48 offset:26112
 ds_read_b64_tr_b16 a[132:133], v46 offset:36864
 ds_read_b64_tr_b16 a[134:135], v46 offset:38400
 ds_read_b64_tr_b16 a[136:137], v47 offset:36864
 ds_read_b64_tr_b16 a[138:139], v47 offset:38400
 ds_read_b64_tr_b16 a[140:141], v48 offset:36864
 ds_read_b64_tr_b16 a[142:143], v48 offset:38400
 s_waitcnt lgkmcnt(0)
 s_barrier
 s_mov_b32 s23, m0
 s_mul_i32 s21, s20, 393216
 s_add_u32 s21, s21, 6291456
 s_add_u32 s21, s21, s44
 s_mul_i32 s22, s20, 12288
 s_add_u32 s22, s22, 0
 s_add_u32 m0, s22, 0
 s_nop 0
 buffer_load_dwordx4 v40, s[12:15], s21 offen lds
 s_add_u32 m0, s22, 1024
 s_nop 0
 buffer_load_dwordx4 v41, s[12:15], s21 offen lds
 s_add_u32 m0, s22, 2048
 s_nop 0
 buffer_load_dwordx4 v42, s[12:15], s21 offen lds
 s_mul_i32 s21, s20, 393216
 s_add_u32 s21, s21, 6389760
 s_add_u32 s21, s21, s44
 s_mul_i32 s22, s20, 12288
 s_add_u32 s22, s22, 3072
 s_add_u32 m0, s22, 0
 s_nop 0
 buffer_load_dwordx4 v43, s[12:15], s21 offen lds
 s_add_u32 m0, s22, 1024
 s_nop 0
 buffer_load_dwordx4 v44, s[12:15], s21 offen lds
 s_add_u32 m0, s22, 2048
 s_nop 0
 buffer_load_dwordx4 v45, s[12:15], s21 offen lds
 s_mul_i32 s21, s20, 393216
 s_add_u32 s21, s21, 6488064
 s_add_u32 s21, s21, s44
 s_mul_i32 s22, s20, 12288
 s_add_u32 s22, s22, 6144
 s_add_u32 m0, s22, 0
 s_nop 0
 buffer_load_dwordx4 v40, s[12:15], s21 offen lds
 s_add_u32 m0, s22, 1024
 s_nop 0
 buffer_load_dwordx4 v41, s[12:15], s21 offen lds
 s_add_u32 m0, s22, 2048
 s_nop 0
 buffer_load_dwordx4 v42, s[12:15], s21 offen lds
 s_mul_i32 s21, s20, 393216
 s_add_u32 s21, s21, 6586368
 s_add_u32 s21, s21, s44
 s_mul_i32 s22, s20, 12288
 s_add_u32 s22, s22, 9216
 s_add_u32 m0, s22, 0
 s_nop 0
 buffer_load_dwordx4 v43, s[12:15], s21 offen lds
 s_add_u32 m0, s22, 1024
 s_nop 0
 buffer_load_dwordx4 v44, s[12:15], s21 offen lds
 s_add_u32 m0, s22, 2048
 s_nop 0
 buffer_load_dwordx4 v45, s[12:15], s21 offen lds
 s_mov_b32 m0, s23
 v_mov_b32 v29, 76
 buffer_load_dword v29, v29, s[64:67], 0 offen sc1
 v_mfma_f32_16x16x32_bf16 v[64:67], a[96:99], v[160:163], v[64:67]
 ds_read_b128 v[192:195], v19 offset:0
 v_mfma_f32_16x16x32_bf16 v[68:71], a[100:103], v[160:163], v[68:71]
 v_add_u32 v18, s33, v14
 s_mov_b32 s61, s60
 v_mfma_f32_16x16x32_bf16 v[72:75], a[104:107], v[160:163], v[72:75]
 s_add_u32 s60, s60, s62
 s_lshr_b32 s48, s20, 1
 v_mfma_f32_16x16x32_bf16 v[76:79], a[96:99], v[164:167], v[76:79]
 ds_read_b128 v[196:199], v19 offset:2048
 s_mul_i32 s48, s48, 393216
 v_mfma_f32_16x16x32_bf16 v[80:83], a[100:103], v[164:167], v[80:83]
 buffer_load_dwordx4 v11, s[8:11], s30 offen offset:1024 lds
 v_mfma_f32_16x16x32_bf16 v[84:87], a[104:107], v[164:167], v[84:87]
 s_add_u32 s30, s30, s25
 v_mfma_f32_16x16x32_bf16 v[88:91], a[96:99], v[168:171], v[88:91]
 ds_read_b128 v[200:203], v19 offset:4096
 s_sub_u32 s30, s30, 1152
 v_mfma_f32_16x16x32_bf16 v[92:95], a[100:103], v[168:171], v[92:95]
 s_add_u32 m0, m0, 8192
 s_and_b32 s21, s20, 1
 v_mfma_f32_16x16x32_bf16 v[96:99], a[104:107], v[168:171], v[96:99]
 s_cmp_lt_u32 m0, s46
 s_cselect_b32 m0, m0, s47
 v_mfma_f32_16x16x32_bf16 v[100:103], a[96:99], v[172:175], v[100:103]
 ds_read_b128 v[204:207], v19 offset:6144
 s_mul_i32 s21, s21, 6144
 v_mfma_f32_16x16x32_bf16 v[104:107], a[100:103], v[172:175], v[104:107]
 s_add_u32 s48, s48, s21
 s_add_u32 s48, s48, s27
 v_mfma_f32_16x16x32_bf16 v[108:111], a[104:107], v[172:175], v[108:111]
 s_waitcnt vmcnt(33) lgkmcnt(2)
 s_barrier
 v_mfma_f32_16x16x32_bf16 v[64:67], a[108:111], v[192:195], v[64:67]
 ds_read_b128 v[160:163], v18 offset:0
 s_add_u32 s27, s27, s28
 v_mfma_f32_16x16x32_bf16 v[68:71], a[112:115], v[192:195], v[68:71]
 s_sub_u32 s26, s26, 1
 v_mfma_f32_16x16x32_bf16 v[72:75], a[116:119], v[192:195], v[72:75]
 v_add_u32 v19, s33, v15
 s_add_u32 s33, s33, 8192
 v_mfma_f32_16x16x32_bf16 v[76:79], a[108:111], v[196:199], v[76:79]
 ds_read_b128 v[164:167], v18 offset:2048
 v_mfma_f32_16x16x32_bf16 v[80:83], a[112:115], v[196:199], v[80:83]
 buffer_load_dwordx4 v10, s[8:11], s30 offen offset:0 lds
 v_mfma_f32_16x16x32_bf16 v[84:87], a[116:119], v[196:199], v[84:87]
 s_waitcnt lgkmcnt(2)
 v_mfma_f32_16x16x32_bf16 v[88:91], a[108:111], v[200:203], v[88:91]
 ds_read_b128 v[168:171], v18 offset:4096
 v_mfma_f32_16x16x32_bf16 v[92:95], a[112:115], v[200:203], v[92:95]
 s_cmp_lt_u32 s33, 155648
 s_cselect_b32 s33, s33, 98304
 v_mfma_f32_16x16x32_bf16 v[96:99], a[116:119], v[200:203], v[96:99]
 v_mfma_f32_16x16x32_bf16 v[100:103], a[108:111], v[204:207], v[100:103]
 ds_read_b128 v[172:175], v18 offset:6144
 v_mfma_f32_16x16x32_bf16 v[104:107], a[112:115], v[204:207], v[104:107]
 v_mfma_f32_16x16x32_bf16 v[108:111], a[116:119], v[204:207], v[108:111]
 s_waitcnt lgkmcnt(2)
 v_mfma_f32_16x16x32_bf16 v[64:67], a[120:123], v[160:163], v[64:67]
 ds_read_b128 v[192:195], v19 offset:0
 v_mfma_f32_16x16x32_bf16 v[68:71], a[124:127], v[160:163], v[68:71]
 v_add_u32 v18, s33, v14
 v_mfma_f32_16x16x32_bf16 v[72:75], a[128:131], v[160:163], v[72:75]
 v_mfma_f32_16x16x32_bf16 v[76:79], a[120:123], v[164:167], v[76:79]
 ds_read_b128 v[196:199], v19 offset:2048
 v_mfma_f32_16x16x32_bf16 v[80:83], a[124:127], v[164:167], v[80:83]
 buffer_load_dwordx4 v11, s[8:11], s30 offen offset:1024 lds
 v_mfma_f32_16x16x32_bf16 v[84:87], a[128:131], v[164:167], v[84:87]
 s_waitcnt lgkmcnt(2)
 s_add_u32 s30, s30, 128
 v_mfma_f32_16x16x32_bf16 v[88:91], a[120:123], v[168:171], v[88:91]
 ds_read_b128 v[200:203], v19 offset:4096
 s_add_u32 m0, m0, 8192
 v_mfma_f32_16x16x32_bf16 v[92:95], a[124:127], v[168:171], v[92:95]
 s_cmp_lt_u32 m0, s46
 s_cselect_b32 m0, m0, s47
 v_mfma_f32_16x16x32_bf16 v[96:99], a[128:131], v[168:171], v[96:99]
 v_mfma_f32_16x16x32_bf16 v[100:103], a[120:123], v[172:175], v[100:103]
 ds_read_b128 v[204:207], v19 offset:6144
 v_mfma_f32_16x16x32_bf16 v[104:107], a[124:127], v[172:175], v[104:107]
 v_mfma_f32_16x16x32_bf16 v[108:111], a[128:131], v[172:175], v[108:111]
 s_waitcnt vmcnt(33) lgkmcnt(2)
 s_barrier
 v_mfma_f32_16x16x32_bf16 v[64:67], a[132:135], v[192:195], v[64:67]
 ds_read_b128 v[160:163], v18 offset:0
 v_mfma_f32_16x16x32_bf16 v[68:71], a[136:139], v[192:195], v[68:71]
 v_mfma_f32_16x16x32_bf16 v[72:75], a[140:143], v[192:195], v[72:75]
 v_add_u32 v19, s33, v15
 s_add_u32 s33, s33, 8192
 v_mfma_f32_16x16x32_bf16 v[76:79], a[132:135], v[196:199], v[76:79]
 ds_read_b128 v[164:167], v18 offset:2048
 v_mfma_f32_16x16x32_bf16 v[80:83], a[136:139], v[196:199], v[80:83]
 buffer_load_dwordx4 v10, s[8:11], s30 offen offset:0 lds
 v_mfma_f32_16x16x32_bf16 v[84:87], a[140:143], v[196:199], v[84:87]
 s_waitcnt lgkmcnt(2)
 v_mfma_f32_16x16x32_bf16 v[88:91], a[132:135], v[200:203], v[88:91]
 ds_read_b128 v[168:171], v18 offset:4096
 v_mfma_f32_16x16x32_bf16 v[92:95], a[136:139], v[200:203], v[92:95]
 s_cmp_lt_u32 s33, 155648
 s_cselect_b32 s33, s33, 98304
 v_mfma_f32_16x16x32_bf16 v[96:99], a[140:143], v[200:203], v[96:99]
 v_mfma_f32_16x16x32_bf16 v[100:103], a[132:135], v[204:207], v[100:103]
 ds_read_b128 v[172:175], v18 offset:6144
 v_mfma_f32_16x16x32_bf16 v[104:107], a[136:139], v[204:207], v[104:107]
 v_mfma_f32_16x16x32_bf16 v[108:111], a[140:143], v[204:207], v[108:111]
 s_waitcnt lgkmcnt(2)
 s_waitcnt vmcnt(21)
 s_barrier
 ds_read_b64_tr_b16 a[144:145], v49 offset:0
 ds_read_b64_tr_b16 a[146:147], v49 offset:1536
 ds_read_b64_tr_b16 a[148:149], v50 offset:0
 ds_read_b64_tr_b16 a[150:151], v50 offset:1536
 ds_read_b64_tr_b16 a[152:153], v51 offset:0
 ds_read_b64_tr_b16 a[154:155], v51 offset:1536
 ds_read_b64_tr_b16 a[156:157], v49 offset:12288
 ds_read_b64_tr_b16 a[158:159], v49 offset:13824
 ds_read_b64_tr_b16 a[160:161], v50 offset:12288
 ds_read_b64_tr_b16 a[162:163], v50 offset:13824
 ds_read_b64_tr_b16 a[164:165], v51 offset:12288
 ds_read_b64_tr_b16 a[166:167], v51 offset:13824
 ds_read_b64_tr_b16 a[168:169], v49 offset:24576
 ds_read_b64_tr_b16 a[170:171], v49 offset:26112
 ds_read_b64_tr_b16 a[172:173], v50 offset:24576
 ds_read_b64_tr_b16 a[174:175], v50 offset:26112
 ds_read_b64_tr_b16 a[176:177], v51 offset:24576
 ds_read_b64_tr_b16 a[178:179], v51 offset:26112
 ds_read_b64_tr_b16 a[180:181], v49 offset:36864
 ds_read_b64_tr_b16 a[182:183], v49 offset:38400
 ds_read_b64_tr_b16 a[184:185], v50 offset:36864
 ds_read_b64_tr_b16 a[186:187], v50 offset:38400
 ds_read_b64_tr_b16 a[188:189], v51 offset:36864
 ds_read_b64_tr_b16 a[190:191], v51 offset:38400
 s_waitcnt lgkmcnt(0)
 s_barrier
 v_mfma_f32_16x16x32_bf16 v[64:67], a[144:147], v[160:163], v[64:67]
 ds_read_b128 v[192:195], v19 offset:0
 v_mfma_f32_16x16x32_bf16 v[68:71], a[148:151], v[160:163], v[68:71]
 v_add_u32 v18, s33, v14
 v_mfma_f32_16x16x32_bf16 v[72:75], a[152:155], v[160:163], v[72:75]
 v_mfma_f32_16x16x32_bf16 v[76:79], a[144:147], v[164:167], v[76:79]
 ds_read_b128 v[196:199], v19 offset:2048
 v_mfma_f32_16x16x32_bf16 v[80:83], a[148:151], v[164:167], v[80:83]
 buffer_load_dwordx4 v11, s[8:11], s30 offen offset:1024 lds
 v_mfma_f32_16x16x32_bf16 v[84:87], a[152:155], v[164:167], v[84:87]
 s_add_u32 s30, s30, 128
 v_mfma_f32_16x16x32_bf16 v[88:91], a[144:147], v[168:171], v[88:91]
 ds_read_b128 v[200:203], v19 offset:4096
 s_add_u32 m0, m0, 8192
 v_mfma_f32_16x16x32_bf16 v[92:95], a[148:151], v[168:171], v[92:95]
 s_cmp_lt_u32 m0, s46
 s_cselect_b32 m0, m0, s47
 v_mfma_f32_16x16x32_bf16 v[96:99], a[152:155], v[168:171], v[96:99]
 v_mfma_f32_16x16x32_bf16 v[100:103], a[144:147], v[172:175], v[100:103]
 ds_read_b128 v[204:207], v19 offset:6144
 v_mfma_f32_16x16x32_bf16 v[104:107], a[148:151], v[172:175], v[104:107]
 v_mfma_f32_16x16x32_bf16 v[108:111], a[152:155], v[172:175], v[108:111]
 s_waitcnt vmcnt(21) lgkmcnt(2)
 s_barrier
 v_mfma_f32_16x16x32_bf16 v[64:67], a[156:159], v[192:195], v[64:67]
 ds_read_b128 v[160:163], v18 offset:0
 v_mfma_f32_16x16x32_bf16 v[68:71], a[160:163], v[192:195], v[68:71]
 v_mfma_f32_16x16x32_bf16 v[72:75], a[164:167], v[192:195], v[72:75]
 v_add_u32 v19, s33, v15
 s_add_u32 s33, s33, 8192
 v_mfma_f32_16x16x32_bf16 v[76:79], a[156:159], v[196:199], v[76:79]
 ds_read_b128 v[164:167], v18 offset:2048
 v_mfma_f32_16x16x32_bf16 v[80:83], a[160:163], v[196:199], v[80:83]
 buffer_load_dwordx4 v10, s[8:11], s30 offen offset:0 lds
 v_mfma_f32_16x16x32_bf16 v[84:87], a[164:167], v[196:199], v[84:87]
 s_waitcnt lgkmcnt(2)
 v_mfma_f32_16x16x32_bf16 v[88:91], a[156:159], v[200:203], v[88:91]
 ds_read_b128 v[168:171], v18 offset:4096
 v_mfma_f32_16x16x32_bf16 v[92:95], a[160:163], v[200:203], v[92:95]
 s_cmp_lt_u32 s33, 155648
 s_cselect_b32 s33, s33, 98304
 v_mfma_f32_16x16x32_bf16 v[96:99], a[164:167], v[200:203], v[96:99]
 v_mfma_f32_16x16x32_bf16 v[100:103], a[156:159], v[204:207], v[100:103]
 ds_read_b128 v[172:175], v18 offset:6144
 v_mfma_f32_16x16x32_bf16 v[104:107], a[160:163], v[204:207], v[104:107]
 v_mfma_f32_16x16x32_bf16 v[108:111], a[164:167], v[204:207], v[108:111]
 s_waitcnt lgkmcnt(2)
 v_mfma_f32_16x16x32_bf16 v[64:67], a[168:171], v[160:163], v[64:67]
 ds_read_b128 v[192:195], v19 offset:0
 v_mfma_f32_16x16x32_bf16 v[68:71], a[172:175], v[160:163], v[68:71]
 v_add_u32 v18, s33, v14
 v_mfma_f32_16x16x32_bf16 v[72:75], a[176:179], v[160:163], v[72:75]
 v_mfma_f32_16x16x32_bf16 v[76:79], a[168:171], v[164:167], v[76:79]
 ds_read_b128 v[196:199], v19 offset:2048
 v_mfma_f32_16x16x32_bf16 v[80:83], a[172:175], v[164:167], v[80:83]
 buffer_load_dwordx4 v11, s[8:11], s30 offen offset:1024 lds
 v_mfma_f32_16x16x32_bf16 v[84:87], a[176:179], v[164:167], v[84:87]
 s_waitcnt lgkmcnt(2)
 s_add_u32 s30, s30, 128
 v_mfma_f32_16x16x32_bf16 v[88:91], a[168:171], v[168:171], v[88:91]
 ds_read_b128 v[200:203], v19 offset:4096
 s_add_u32 m0, m0, 8192
 v_mfma_f32_16x16x32_bf16 v[92:95], a[172:175], v[168:171], v[92:95]
 s_cmp_lt_u32 m0, s46
 s_cselect_b32 m0, m0, s47
 v_mfma_f32_16x16x32_bf16 v[96:99], a[176:179], v[168:171], v[96:99]
 v_mfma_f32_16x16x32_bf16 v[100:103], a[168:171], v[172:175], v[100:103]
 ds_read_b128 v[204:207], v19 offset:6144
 v_mfma_f32_16x16x32_bf16 v[104:107], a[172:175], v[172:175], v[104:107]
 v_mfma_f32_16x16x32_bf16 v[108:111], a[176:179], v[172:175], v[108:111]
 s_waitcnt vmcnt(21) lgkmcnt(2)
 s_barrier
 v_mfma_f32_16x16x32_bf16 v[64:67], a[180:183], v[192:195], v[64:67]
 ds_read_b128 v[160:163], v18 offset:0
 v_mfma_f32_16x16x32_bf16 v[68:71], a[184:187], v[192:195], v[68:71]
 v_mfma_f32_16x16x32_bf16 v[72:75], a[188:191], v[192:195], v[72:75]
 v_add_u32 v19, s33, v15
 s_add_u32 s33, s33, 8192
 v_mfma_f32_16x16x32_bf16 v[76:79], a[180:183], v[196:199], v[76:79]
 ds_read_b128 v[164:167], v18 offset:2048
 v_mfma_f32_16x16x32_bf16 v[80:83], a[184:187], v[196:199], v[80:83]
 buffer_load_dwordx4 v10, s[8:11], s30 offen offset:0 lds
 v_mfma_f32_16x16x32_bf16 v[84:87], a[188:191], v[196:199], v[84:87]
 s_waitcnt lgkmcnt(2)
 v_mfma_f32_16x16x32_bf16 v[88:91], a[180:183], v[200:203], v[88:91]
 ds_read_b128 v[168:171], v18 offset:4096
 v_mfma_f32_16x16x32_bf16 v[92:95], a[184:187], v[200:203], v[92:95]
 s_cmp_lt_u32 s33, 155648
 s_cselect_b32 s33, s33, 98304
 v_mfma_f32_16x16x32_bf16 v[96:99], a[188:191], v[200:203], v[96:99]
 v_mfma_f32_16x16x32_bf16 v[100:103], a[180:183], v[204:207], v[100:103]
 ds_read_b128 v[172:175], v18 offset:6144
 v_mfma_f32_16x16x32_bf16 v[104:107], a[184:187], v[204:207], v[104:107]
 v_mfma_f32_16x16x32_bf16 v[108:111], a[188:191], v[204:207], v[108:111]
 s_waitcnt lgkmcnt(2)
 s_waitcnt vmcnt(9)
 s_barrier
 ds_read_b64_tr_b16 a[192:193], v46 offset:0
 ds_read_b64_tr_b16 a[194:195], v46 offset:1536
 ds_read_b64_tr_b16 a[196:197], v47 offset:0
 ds_read_b64_tr_b16 a[198:199], v47 offset:1536
 ds_read_b64_tr_b16 a[200:201], v48 offset:0
 ds_read_b64_tr_b16 a[202:203], v48 offset:1536
 ds_read_b64_tr_b16 a[204:205], v46 offset:12288
 ds_read_b64_tr_b16 a[206:207], v46 offset:13824
 ds_read_b64_tr_b16 a[208:209], v47 offset:12288
 ds_read_b64_tr_b16 a[210:211], v47 offset:13824
 ds_read_b64_tr_b16 a[212:213], v48 offset:12288
 ds_read_b64_tr_b16 a[214:215], v48 offset:13824
 ds_read_b64_tr_b16 a[216:217], v46 offset:24576
 ds_read_b64_tr_b16 a[218:219], v46 offset:26112
 ds_read_b64_tr_b16 a[220:221], v47 offset:24576
 ds_read_b64_tr_b16 a[222:223], v47 offset:26112
 ds_read_b64_tr_b16 a[224:225], v48 offset:24576
 ds_read_b64_tr_b16 a[226:227], v48 offset:26112
 ds_read_b64_tr_b16 a[228:229], v46 offset:36864
 ds_read_b64_tr_b16 a[230:231], v46 offset:38400
 ds_read_b64_tr_b16 a[232:233], v47 offset:36864
 ds_read_b64_tr_b16 a[234:235], v47 offset:38400
 ds_read_b64_tr_b16 a[236:237], v48 offset:36864
 ds_read_b64_tr_b16 a[238:239], v48 offset:38400
 s_waitcnt lgkmcnt(0)
 s_barrier
 v_mfma_f32_16x16x32_bf16 v[64:67], a[192:195], v[160:163], v[64:67]
 ds_read_b128 v[192:195], v19 offset:0
 v_mfma_f32_16x16x32_bf16 v[68:71], a[196:199], v[160:163], v[68:71]
 v_add_u32 v18, s33, v14
 v_mfma_f32_16x16x32_bf16 v[72:75], a[200:203], v[160:163], v[72:75]
 v_mfma_f32_16x16x32_bf16 v[76:79], a[192:195], v[164:167], v[76:79]
 ds_read_b128 v[196:199], v19 offset:2048
 v_mfma_f32_16x16x32_bf16 v[80:83], a[196:199], v[164:167], v[80:83]
 buffer_load_dwordx4 v11, s[8:11], s30 offen offset:1024 lds
 v_mfma_f32_16x16x32_bf16 v[84:87], a[200:203], v[164:167], v[84:87]
 s_add_u32 s30, s30, 128
 v_mfma_f32_16x16x32_bf16 v[88:91], a[192:195], v[168:171], v[88:91]
 ds_read_b128 v[200:203], v19 offset:4096
 s_add_u32 m0, m0, 8192
 v_mfma_f32_16x16x32_bf16 v[92:95], a[196:199], v[168:171], v[92:95]
 s_cmp_lt_u32 m0, s46
 s_cselect_b32 m0, m0, s47
 v_mfma_f32_16x16x32_bf16 v[96:99], a[200:203], v[168:171], v[96:99]
 v_mfma_f32_16x16x32_bf16 v[100:103], a[192:195], v[172:175], v[100:103]
 ds_read_b128 v[204:207], v19 offset:6144
 v_mfma_f32_16x16x32_bf16 v[104:107], a[196:199], v[172:175], v[104:107]
 v_mfma_f32_16x16x32_bf16 v[108:111], a[200:203], v[172:175], v[108:111]
 s_waitcnt vmcnt(8) lgkmcnt(2)
 s_barrier
 v_mfma_f32_16x16x32_bf16 v[64:67], a[204:207], v[192:195], v[64:67]
 ds_read_b128 v[160:163], v18 offset:0
 v_mfma_f32_16x16x32_bf16 v[68:71], a[208:211], v[192:195], v[68:71]
 v_mfma_f32_16x16x32_bf16 v[72:75], a[212:215], v[192:195], v[72:75]
 v_add_u32 v19, s33, v15
 s_add_u32 s33, s33, 8192
 v_mfma_f32_16x16x32_bf16 v[76:79], a[204:207], v[196:199], v[76:79]
 ds_read_b128 v[164:167], v18 offset:2048
 v_mfma_f32_16x16x32_bf16 v[80:83], a[208:211], v[196:199], v[80:83]
 buffer_load_dwordx4 v10, s[8:11], s30 offen offset:0 lds
 v_mfma_f32_16x16x32_bf16 v[84:87], a[212:215], v[196:199], v[84:87]
 s_waitcnt lgkmcnt(2)
 v_mfma_f32_16x16x32_bf16 v[88:91], a[204:207], v[200:203], v[88:91]
 ds_read_b128 v[168:171], v18 offset:4096
 v_mfma_f32_16x16x32_bf16 v[92:95], a[208:211], v[200:203], v[92:95]
 s_cmp_lt_u32 s33, 155648
 s_cselect_b32 s33, s33, 98304
 v_mfma_f32_16x16x32_bf16 v[96:99], a[212:215], v[200:203], v[96:99]
 v_mfma_f32_16x16x32_bf16 v[100:103], a[204:207], v[204:207], v[100:103]
 ds_read_b128 v[172:175], v18 offset:6144
 v_mfma_f32_16x16x32_bf16 v[104:107], a[208:211], v[204:207], v[104:107]
 v_mfma_f32_16x16x32_bf16 v[108:111], a[212:215], v[204:207], v[108:111]
 s_waitcnt lgkmcnt(2)
 v_mfma_f32_16x16x32_bf16 v[64:67], a[216:219], v[160:163], v[64:67]
 ds_read_b128 v[192:195], v19 offset:0
 v_mfma_f32_16x16x32_bf16 v[68:71], a[220:223], v[160:163], v[68:71]
 v_add_u32 v18, s33, v14
 v_mfma_f32_16x16x32_bf16 v[72:75], a[224:227], v[160:163], v[72:75]
 v_mfma_f32_16x16x32_bf16 v[76:79], a[216:219], v[164:167], v[76:79]
 ds_read_b128 v[196:199], v19 offset:2048
 v_mfma_f32_16x16x32_bf16 v[80:83], a[220:223], v[164:167], v[80:83]
 buffer_load_dwordx4 v11, s[8:11], s30 offen offset:1024 lds
 v_mfma_f32_16x16x32_bf16 v[84:87], a[224:227], v[164:167], v[84:87]
 s_waitcnt lgkmcnt(2)
 s_add_u32 s30, s30, 128
 v_mfma_f32_16x16x32_bf16 v[88:91], a[216:219], v[168:171], v[88:91]
 ds_read_b128 v[200:203], v19 offset:4096
 s_add_u32 m0, m0, 8192
 v_mfma_f32_16x16x32_bf16 v[92:95], a[220:223], v[168:171], v[92:95]
 s_cmp_lt_u32 m0, s46
 s_cselect_b32 m0, m0, s47
 v_mfma_f32_16x16x32_bf16 v[96:99], a[224:227], v[168:171], v[96:99]
 v_mfma_f32_16x16x32_bf16 v[100:103], a[216:219], v[172:175], v[100:103]
 ds_read_b128 v[204:207], v19 offset:6144
 v_mfma_f32_16x16x32_bf16 v[104:107], a[220:223], v[172:175], v[104:107]
 v_mfma_f32_16x16x32_bf16 v[108:111], a[224:227], v[172:175], v[108:111]
 s_waitcnt vmcnt(8) lgkmcnt(2)
 s_barrier
 v_mfma_f32_16x16x32_bf16 v[64:67], a[228:231], v[192:195], v[64:67]
 ds_read_b128 v[160:163], v18 offset:0
 v_mfma_f32_16x16x32_bf16 v[68:71], a[232:235], v[192:195], v[68:71]
 v_mfma_f32_16x16x32_bf16 v[72:75], a[236:239], v[192:195], v[72:75]
 v_add_u32 v19, s33, v15
 s_add_u32 s33, s33, 8192
 v_mfma_f32_16x16x32_bf16 v[76:79], a[228:231], v[196:199], v[76:79]
 ds_read_b128 v[164:167], v18 offset:2048
 v_cvt_pk_bf16_f32 v224, v64, v65
 v_cvt_pk_bf16_f32 v225, v66, v67
 v_mfma_f32_16x16x32_bf16 v[80:83], a[232:235], v[196:199], v[80:83]
 buffer_load_dwordx4 v10, s[8:11], s30 offen offset:0 lds
 v_cvt_pk_bf16_f32 v226, v68, v69
 v_cvt_pk_bf16_f32 v227, v70, v71
 v_mfma_f32_16x16x32_bf16 v[84:87], a[236:239], v[196:199], v[84:87]
 s_waitcnt lgkmcnt(2)
 v_cvt_pk_bf16_f32 v228, v72, v73
 v_cvt_pk_bf16_f32 v229, v74, v75
 v_mfma_f32_16x16x32_bf16 v[88:91], a[228:231], v[200:203], v[88:91]
 ds_read_b128 v[168:171], v18 offset:4096
 ds_write_b64 v22, v[224:225] offset:0
 v_mfma_f32_16x16x32_bf16 v[92:95], a[232:235], v[200:203], v[92:95]
 s_cmp_lt_u32 s33, 155648
 s_cselect_b32 s33, s33, 98304
 ds_write_b64 v22, v[226:227] offset:8
 v_mfma_f32_16x16x32_bf16 v[96:99], a[236:239], v[200:203], v[96:99]
 ds_write_b64 v16, v[228:229] offset:64
 v_cvt_pk_bf16_f32 v230, v76, v77
 v_cvt_pk_bf16_f32 v231, v78, v79
 v_mfma_f32_16x16x32_bf16 v[100:103], a[228:231], v[204:207], v[100:103]
 ds_read_b128 v[172:175], v18 offset:6144
 v_cvt_pk_bf16_f32 v232, v80, v81
 v_cvt_pk_bf16_f32 v233, v82, v83
 v_cvt_pk_bf16_f32 v234, v84, v85
 v_mfma_f32_16x16x32_bf16 v[104:107], a[232:235], v[204:207], v[104:107]
 v_cvt_pk_bf16_f32 v235, v86, v87
 ds_write_b64 v22, v[230:231] offset:6400
 v_mfma_f32_16x16x32_bf16 v[108:111], a[236:239], v[204:207], v[108:111]
 ds_write_b64 v22, v[232:233] offset:6408
 ds_write_b64 v16, v[234:235] offset:6464
 v_readfirstlane_b32 s21, v29
 s_cmp_ge_u32 s21, 32
 s_cbranch_scc1 kvz_128
 s_mov_b32 s21, 76
 v_mov_b32 v4, 0
 s_mov_b32 s101, 0
wf_129:
 buffer_load_dword v5, v4, s[64:67], s21 offen sc1
 s_add_u32 s101, s101, 1
 s_cmp_gt_u32 s101, 131072
 s_cbranch_scc1 main_end
 s_waitcnt vmcnt(0)
 v_readfirstlane_b32 s100, v5
 s_cmp_ge_u32 s100, 32
 s_cbranch_scc1 wf_130
 s_sleep 8
 s_branch wf_129
wf_130:
kvz_128:
 s_branch kvm_end_127
kvm_blk_126:
 v_mfma_f32_16x16x32_bf16 v[64:67], a[0:3], v[160:163], 0
 ds_read_b128 v[192:195], v19 offset:0
 v_mfma_f32_16x16x32_bf16 v[68:71], a[4:7], v[160:163], 0
 v_add_u32 v18, s33, v14
 v_mfma_f32_16x16x32_bf16 v[72:75], a[8:11], v[160:163], 0
 v_mfma_f32_16x16x32_bf16 v[76:79], a[0:3], v[164:167], 0
 ds_read_b128 v[196:199], v19 offset:2048
 v_mfma_f32_16x16x32_bf16 v[80:83], a[4:7], v[164:167], 0
 buffer_load_dwordx4 v11, s[8:11], s30 offen offset:1024 lds
 v_mfma_f32_16x16x32_bf16 v[84:87], a[8:11], v[164:167], 0
 s_waitcnt lgkmcnt(11)
 s_add_u32 s30, s30, 128
 v_mfma_f32_16x16x32_bf16 v[88:91], a[0:3], v[168:171], 0
 ds_read_b128 v[200:203], v19 offset:4096
 s_add_u32 m0, m0, 8192
 v_mfma_f32_16x16x32_bf16 v[92:95], a[4:7], v[168:171], 0
 s_cmp_lt_u32 m0, s46
 s_cselect_b32 m0, m0, s47
 v_mfma_f32_16x16x32_bf16 v[96:99], a[8:11], v[168:171], 0
 v_mfma_f32_16x16x32_bf16 v[100:103], a[0:3], v[172:175], 0
 ds_read_b128 v[204:207], v19 offset:6144
 v_mfma_f32_16x16x32_bf16 v[104:107], a[4:7], v[172:175], 0
 v_mfma_f32_16x16x32_bf16 v[108:111], a[8:11], v[172:175], 0
 s_waitcnt vmcnt(14) lgkmcnt(2)
 s_barrier
 v_mfma_f32_16x16x32_bf16 v[64:67], a[12:15], v[192:195], v[64:67]
 ds_read_b128 v[160:163], v18 offset:0
 v_mfma_f32_16x16x32_bf16 v[68:71], a[16:19], v[192:195], v[68:71]
 v_mfma_f32_16x16x32_bf16 v[72:75], a[20:23], v[192:195], v[72:75]
 v_add_u32 v19, s33, v15
 s_add_u32 s33, s33, 8192
 v_mfma_f32_16x16x32_bf16 v[76:79], a[12:15], v[196:199], v[76:79]
 ds_read_b128 v[164:167], v18 offset:2048
 v_mfma_f32_16x16x32_bf16 v[80:83], a[16:19], v[196:199], v[80:83]
 buffer_load_dwordx4 v10, s[8:11], s30 offen offset:0 lds
 v_mfma_f32_16x16x32_bf16 v[84:87], a[20:23], v[196:199], v[84:87]
 s_waitcnt lgkmcnt(2)
 v_mfma_f32_16x16x32_bf16 v[88:91], a[12:15], v[200:203], v[88:91]
 ds_read_b128 v[168:171], v18 offset:4096
 v_mfma_f32_16x16x32_bf16 v[92:95], a[16:19], v[200:203], v[92:95]
 s_cmp_lt_u32 s33, 155648
 s_cselect_b32 s33, s33, 98304
 v_mfma_f32_16x16x32_bf16 v[96:99], a[20:23], v[200:203], v[96:99]
 v_mfma_f32_16x16x32_bf16 v[100:103], a[12:15], v[204:207], v[100:103]
 ds_read_b128 v[172:175], v18 offset:6144
 v_mfma_f32_16x16x32_bf16 v[104:107], a[16:19], v[204:207], v[104:107]
 v_mfma_f32_16x16x32_bf16 v[108:111], a[20:23], v[204:207], v[108:111]
 s_waitcnt lgkmcnt(2)
 v_mfma_f32_16x16x32_bf16 v[64:67], a[24:27], v[160:163], v[64:67]
 ds_read_b128 v[192:195], v19 offset:0
 v_mfma_f32_16x16x32_bf16 v[68:71], a[28:31], v[160:163], v[68:71]
 v_add_u32 v18, s33, v14
 v_mfma_f32_16x16x32_bf16 v[72:75], a[32:35], v[160:163], v[72:75]
 v_mfma_f32_16x16x32_bf16 v[76:79], a[24:27], v[164:167], v[76:79]
 ds_read_b128 v[196:199], v19 offset:2048
 v_mfma_f32_16x16x32_bf16 v[80:83], a[28:31], v[164:167], v[80:83]
 buffer_load_dwordx4 v11, s[8:11], s30 offen offset:1024 lds
 v_mfma_f32_16x16x32_bf16 v[84:87], a[32:35], v[164:167], v[84:87]
 s_waitcnt lgkmcnt(2)
 s_add_u32 s30, s30, 128
 v_mfma_f32_16x16x32_bf16 v[88:91], a[24:27], v[168:171], v[88:91]
 ds_read_b128 v[200:203], v19 offset:4096
 s_add_u32 m0, m0, 8192
 v_mfma_f32_16x16x32_bf16 v[92:95], a[28:31], v[168:171], v[92:95]
 s_cmp_lt_u32 m0, s46
 s_cselect_b32 m0, m0, s47
 v_mfma_f32_16x16x32_bf16 v[96:99], a[32:35], v[168:171], v[96:99]
 v_mfma_f32_16x16x32_bf16 v[100:103], a[24:27], v[172:175], v[100:103]
 ds_read_b128 v[204:207], v19 offset:6144
 v_mfma_f32_16x16x32_bf16 v[104:107], a[28:31], v[172:175], v[104:107]
 v_mfma_f32_16x16x32_bf16 v[108:111], a[32:35], v[172:175], v[108:111]
 s_waitcnt vmcnt(14) lgkmcnt(2)
 s_barrier
 v_mfma_f32_16x16x32_bf16 v[64:67], a[36:39], v[192:195], v[64:67]
 ds_read_b128 v[160:163], v18 offset:0
 v_mfma_f32_16x16x32_bf16 v[68:71], a[40:43], v[192:195], v[68:71]
 v_mfma_f32_16x16x32_bf16 v[72:75], a[44:47], v[192:195], v[72:75]
 v_add_u32 v19, s33, v15
 s_add_u32 s33, s33, 8192
 v_mfma_f32_16x16x32_bf16 v[76:79], a[36:39], v[196:199], v[76:79]
 ds_read_b128 v[164:167], v18 offset:2048
 v_mfma_f32_16x16x32_bf16 v[80:83], a[40:43], v[196:199], v[80:83]
 buffer_load_dwordx4 v10, s[8:11], s30 offen offset:0 lds
 v_mfma_f32_16x16x32_bf16 v[84:87], a[44:47], v[196:199], v[84:87]
 s_waitcnt lgkmcnt(2)
 v_mfma_f32_16x16x32_bf16 v[88:91], a[36:39], v[200:203], v[88:91]
 ds_read_b128 v[168:171], v18 offset:4096
 v_mfma_f32_16x16x32_bf16 v[92:95], a[40:43], v[200:203], v[92:95]
 s_cmp_lt_u32 s33, 155648
 s_cselect_b32 s33, s33, 98304
 v_mfma_f32_16x16x32_bf16 v[96:99], a[44:47], v[200:203], v[96:99]
 v_mfma_f32_16x16x32_bf16 v[100:103], a[36:39], v[204:207], v[100:103]
 ds_read_b128 v[172:175], v18 offset:6144
 v_mfma_f32_16x16x32_bf16 v[104:107], a[40:43], v[204:207], v[104:107]
 v_mfma_f32_16x16x32_bf16 v[108:111], a[44:47], v[204:207], v[108:111]
 s_waitcnt lgkmcnt(2)
 v_mfma_f32_16x16x32_bf16 v[64:67], a[48:51], v[160:163], v[64:67]
 ds_read_b128 v[192:195], v19 offset:0
 v_mfma_f32_16x16x32_bf16 v[68:71], a[52:55], v[160:163], v[68:71]
 v_add_u32 v18, s33, v14
 v_mfma_f32_16x16x32_bf16 v[72:75], a[56:59], v[160:163], v[72:75]
 v_mfma_f32_16x16x32_bf16 v[76:79], a[48:51], v[164:167], v[76:79]
 ds_read_b128 v[196:199], v19 offset:2048
 v_mfma_f32_16x16x32_bf16 v[80:83], a[52:55], v[164:167], v[80:83]
 buffer_load_dwordx4 v11, s[8:11], s30 offen offset:1024 lds
 v_mfma_f32_16x16x32_bf16 v[84:87], a[56:59], v[164:167], v[84:87]
 s_waitcnt lgkmcnt(2)
 s_add_u32 s30, s30, 128
 v_mfma_f32_16x16x32_bf16 v[88:91], a[48:51], v[168:171], v[88:91]
 ds_read_b128 v[200:203], v19 offset:4096
 s_add_u32 m0, m0, 8192
 v_mfma_f32_16x16x32_bf16 v[92:95], a[52:55], v[168:171], v[92:95]
 s_cmp_lt_u32 m0, s46
 s_cselect_b32 m0, m0, s47
 v_mfma_f32_16x16x32_bf16 v[96:99], a[56:59], v[168:171], v[96:99]
 v_mfma_f32_16x16x32_bf16 v[100:103], a[48:51], v[172:175], v[100:103]
 ds_read_b128 v[204:207], v19 offset:6144
 v_mfma_f32_16x16x32_bf16 v[104:107], a[52:55], v[172:175], v[104:107]
 v_mfma_f32_16x16x32_bf16 v[108:111], a[56:59], v[172:175], v[108:111]
 s_waitcnt vmcnt(14) lgkmcnt(2)
 s_barrier
 v_mfma_f32_16x16x32_bf16 v[64:67], a[60:63], v[192:195], v[64:67]
 ds_read_b128 v[160:163], v18 offset:0
 v_mfma_f32_16x16x32_bf16 v[68:71], a[64:67], v[192:195], v[68:71]
 v_mfma_f32_16x16x32_bf16 v[72:75], a[68:71], v[192:195], v[72:75]
 v_add_u32 v19, s33, v15
 s_add_u32 s33, s33, 8192
 v_mfma_f32_16x16x32_bf16 v[76:79], a[60:63], v[196:199], v[76:79]
 ds_read_b128 v[164:167], v18 offset:2048
 v_mfma_f32_16x16x32_bf16 v[80:83], a[64:67], v[196:199], v[80:83]
 buffer_load_dwordx4 v10, s[8:11], s30 offen offset:0 lds
 v_mfma_f32_16x16x32_bf16 v[84:87], a[68:71], v[196:199], v[84:87]
 s_waitcnt lgkmcnt(2)
 v_mfma_f32_16x16x32_bf16 v[88:91], a[60:63], v[200:203], v[88:91]
 ds_read_b128 v[168:171], v18 offset:4096
 v_mfma_f32_16x16x32_bf16 v[92:95], a[64:67], v[200:203], v[92:95]
 s_cmp_lt_u32 s33, 155648
 s_cselect_b32 s33, s33, 98304
 v_mfma_f32_16x16x32_bf16 v[96:99], a[68:71], v[200:203], v[96:99]
 v_mfma_f32_16x16x32_bf16 v[100:103], a[60:63], v[204:207], v[100:103]
 ds_read_b128 v[172:175], v18 offset:6144
 v_mfma_f32_16x16x32_bf16 v[104:107], a[64:67], v[204:207], v[104:107]
 v_mfma_f32_16x16x32_bf16 v[108:111], a[68:71], v[204:207], v[108:111]
 s_waitcnt lgkmcnt(2)
 v_mfma_f32_16x16x32_bf16 v[64:67], a[72:75], v[160:163], v[64:67]
 ds_read_b128 v[192:195], v19 offset:0
 v_mfma_f32_16x16x32_bf16 v[68:71], a[76:79], v[160:163], v[68:71]
 v_add_u32 v18, s33, v14
 v_mfma_f32_16x16x32_bf16 v[72:75], a[80:83], v[160:163], v[72:75]
 v_mfma_f32_16x16x32_bf16 v[76:79], a[72:75], v[164:167], v[76:79]
 ds_read_b128 v[196:199], v19 offset:2048
 v_mfma_f32_16x16x32_bf16 v[80:83], a[76:79], v[164:167], v[80:83]
 buffer_load_dwordx4 v11, s[8:11], s30 offen offset:1024 lds
 v_mfma_f32_16x16x32_bf16 v[84:87], a[80:83], v[164:167], v[84:87]
 s_waitcnt lgkmcnt(2)
 s_add_u32 s30, s30, 128
 v_mfma_f32_16x16x32_bf16 v[88:91], a[72:75], v[168:171], v[88:91]
 ds_read_b128 v[200:203], v19 offset:4096
 s_add_u32 m0, m0, 8192
 v_mfma_f32_16x16x32_bf16 v[92:95], a[76:79], v[168:171], v[92:95]
 s_cmp_lt_u32 m0, s46
 s_cselect_b32 m0, m0, s47
 v_mfma_f32_16x16x32_bf16 v[96:99], a[80:83], v[168:171], v[96:99]
 v_mfma_f32_16x16x32_bf16 v[100:103], a[72:75], v[172:175], v[100:103]
 ds_read_b128 v[204:207], v19 offset:6144
 v_mfma_f32_16x16x32_bf16 v[104:107], a[76:79], v[172:175], v[104:107]
 v_mfma_f32_16x16x32_bf16 v[108:111], a[80:83], v[172:175], v[108:111]
 s_waitcnt vmcnt(7) lgkmcnt(2)
 s_barrier
 v_mfma_f32_16x16x32_bf16 v[64:67], a[84:87], v[192:195], v[64:67]
 ds_read_b128 v[160:163], v18 offset:0
 v_mfma_f32_16x16x32_bf16 v[68:71], a[88:91], v[192:195], v[68:71]
 s_cmp_eq_u32 s48, 0x80000000
 s_cbranch_scc1 kvm_124
 s_cmp_lg_u32 s20, 0
 s_cbranch_scc1 af_125
 v_mov_b32 v4, 0
 v_mov_b32 v5, 1
 s_mov_b64 exec, 1
 buffer_atomic_add v5, v4, s[72:75], s61 offen sc1
 s_mov_b64 exec, -1
 s_nop 1
af_125:
kvm_124:
 v_mfma_f32_16x16x32_bf16 v[72:75], a[92:95], v[192:195], v[72:75]
 v_add_u32 v19, s33, v15
 s_add_u32 s33, s33, 8192
 v_mfma_f32_16x16x32_bf16 v[76:79], a[84:87], v[196:199], v[76:79]
 ds_read_b128 v[164:167], v18 offset:2048
 v_mfma_f32_16x16x32_bf16 v[80:83], a[88:91], v[196:199], v[80:83]
 buffer_load_dwordx4 v10, s[8:11], s30 offen offset:0 lds
 v_mfma_f32_16x16x32_bf16 v[84:87], a[92:95], v[196:199], v[84:87]
 s_waitcnt lgkmcnt(2)
 v_mfma_f32_16x16x32_bf16 v[88:91], a[84:87], v[200:203], v[88:91]
 ds_read_b128 v[168:171], v18 offset:4096
 v_mfma_f32_16x16x32_bf16 v[92:95], a[88:91], v[200:203], v[92:95]
 s_cmp_lt_u32 s33, 155648
 s_cselect_b32 s33, s33, 98304
 v_mfma_f32_16x16x32_bf16 v[96:99], a[92:95], v[200:203], v[96:99]
 v_mfma_f32_16x16x32_bf16 v[100:103], a[84:87], v[204:207], v[100:103]
 ds_read_b128 v[172:175], v18 offset:6144
 v_mfma_f32_16x16x32_bf16 v[104:107], a[88:91], v[204:207], v[104:107]
 v_mfma_f32_16x16x32_bf16 v[108:111], a[92:95], v[204:207], v[108:111]
 s_waitcnt lgkmcnt(2)
 v_mfma_f32_16x16x32_bf16 v[64:67], a[96:99], v[160:163], v[64:67]
 ds_read_b128 v[192:195], v19 offset:0
 v_mfma_f32_16x16x32_bf16 v[68:71], a[100:103], v[160:163], v[68:71]
 v_add_u32 v18, s33, v14
 s_mov_b32 s61, s60
 v_mfma_f32_16x16x32_bf16 v[72:75], a[104:107], v[160:163], v[72:75]
 s_add_u32 s60, s60, s62
 s_lshr_b32 s48, s20, 1
 v_mfma_f32_16x16x32_bf16 v[76:79], a[96:99], v[164:167], v[76:79]
 ds_read_b128 v[196:199], v19 offset:2048
 s_mul_i32 s48, s48, 393216
 v_mfma_f32_16x16x32_bf16 v[80:83], a[100:103], v[164:167], v[80:83]
 buffer_load_dwordx4 v11, s[8:11], s30 offen offset:1024 lds
 v_mfma_f32_16x16x32_bf16 v[84:87], a[104:107], v[164:167], v[84:87]
 s_waitcnt lgkmcnt(2)
 s_add_u32 s30, s30, s25
 v_mfma_f32_16x16x32_bf16 v[88:91], a[96:99], v[168:171], v[88:91]
 ds_read_b128 v[200:203], v19 offset:4096
 s_sub_u32 s30, s30, 1152
 v_mfma_f32_16x16x32_bf16 v[92:95], a[100:103], v[168:171], v[92:95]
 s_add_u32 m0, m0, 8192
 s_and_b32 s21, s20, 1
 v_mfma_f32_16x16x32_bf16 v[96:99], a[104:107], v[168:171], v[96:99]
 s_cmp_lt_u32 m0, s46
 s_cselect_b32 m0, m0, s47
 v_mfma_f32_16x16x32_bf16 v[100:103], a[96:99], v[172:175], v[100:103]
 ds_read_b128 v[204:207], v19 offset:6144
 s_mul_i32 s21, s21, 6144
 v_mfma_f32_16x16x32_bf16 v[104:107], a[100:103], v[172:175], v[104:107]
 s_add_u32 s48, s48, s21
 s_add_u32 s48, s48, s27
 v_mfma_f32_16x16x32_bf16 v[108:111], a[104:107], v[172:175], v[108:111]
 s_waitcnt vmcnt(8) lgkmcnt(2)
 s_barrier
 v_mfma_f32_16x16x32_bf16 v[64:67], a[108:111], v[192:195], v[64:67]
 ds_read_b128 v[160:163], v18 offset:0
 s_add_u32 s27, s27, s28
 v_mfma_f32_16x16x32_bf16 v[68:71], a[112:115], v[192:195], v[68:71]
 s_sub_u32 s26, s26, 1
 v_mfma_f32_16x16x32_bf16 v[72:75], a[116:119], v[192:195], v[72:75]
 v_add_u32 v19, s33, v15
 s_add_u32 s33, s33, 8192
 v_mfma_f32_16x16x32_bf16 v[76:79], a[108:111], v[196:199], v[76:79]
 ds_read_b128 v[164:167], v18 offset:2048
 v_mfma_f32_16x16x32_bf16 v[80:83], a[112:115], v[196:199], v[80:83]
 buffer_load_dwordx4 v10, s[8:11], s30 offen offset:0 lds
 v_mfma_f32_16x16x32_bf16 v[84:87], a[116:119], v[196:199], v[84:87]
 s_waitcnt lgkmcnt(2)
 v_mfma_f32_16x16x32_bf16 v[88:91], a[108:111], v[200:203], v[88:91]
 ds_read_b128 v[168:171], v18 offset:4096
 v_mfma_f32_16x16x32_bf16 v[92:95], a[112:115], v[200:203], v[92:95]
 s_cmp_lt_u32 s33, 155648
 s_cselect_b32 s33, s33, 98304
 v_mfma_f32_16x16x32_bf16 v[96:99], a[116:119], v[200:203], v[96:99]
 v_mfma_f32_16x16x32_bf16 v[100:103], a[108:111], v[204:207], v[100:103]
 ds_read_b128 v[172:175], v18 offset:6144
 v_mfma_f32_16x16x32_bf16 v[104:107], a[112:115], v[204:207], v[104:107]
 v_mfma_f32_16x16x32_bf16 v[108:111], a[116:119], v[204:207], v[108:111]
 s_waitcnt lgkmcnt(2)
 v_mfma_f32_16x16x32_bf16 v[64:67], a[120:123], v[160:163], v[64:67]
 ds_read_b128 v[192:195], v19 offset:0
 v_mfma_f32_16x16x32_bf16 v[68:71], a[124:127], v[160:163], v[68:71]
 v_add_u32 v18, s33, v14
 v_mfma_f32_16x16x32_bf16 v[72:75], a[128:131], v[160:163], v[72:75]
 v_mfma_f32_16x16x32_bf16 v[76:79], a[120:123], v[164:167], v[76:79]
 ds_read_b128 v[196:199], v19 offset:2048
 v_mfma_f32_16x16x32_bf16 v[80:83], a[124:127], v[164:167], v[80:83]
 buffer_load_dwordx4 v11, s[8:11], s30 offen offset:1024 lds
 v_mfma_f32_16x16x32_bf16 v[84:87], a[128:131], v[164:167], v[84:87]
 s_waitcnt lgkmcnt(2)
 s_add_u32 s30, s30, 128
 v_mfma_f32_16x16x32_bf16 v[88:91], a[120:123], v[168:171], v[88:91]
 ds_read_b128 v[200:203], v19 offset:4096
 s_add_u32 m0, m0, 8192
 v_mfma_f32_16x16x32_bf16 v[92:95], a[124:127], v[168:171], v[92:95]
 s_cmp_lt_u32 m0, s46
 s_cselect_b32 m0, m0, s47
 v_mfma_f32_16x16x32_bf16 v[96:99], a[128:131], v[168:171], v[96:99]
 v_mfma_f32_16x16x32_bf16 v[100:103], a[120:123], v[172:175], v[100:103]
 ds_read_b128 v[204:207], v19 offset:6144
 v_mfma_f32_16x16x32_bf16 v[104:107], a[124:127], v[172:175], v[104:107]
 v_mfma_f32_16x16x32_bf16 v[108:111], a[128:131], v[172:175], v[108:111]
 s_waitcnt vmcnt(8) lgkmcnt(2)
 s_barrier
 v_mfma_f32_16x16x32_bf16 v[64:67], a[132:135], v[192:195], v[64:67]
 ds_read_b128 v[160:163], v18 offset:0
 v_mfma_f32_16x16x32_bf16 v[68:71], a[136:139], v[192:195], v[68:71]
 v_mfma_f32_16x16x32_bf16 v[72:75], a[140:143], v[192:195], v[72:75]
 v_add_u32 v19, s33, v15
 s_add_u32 s33, s33, 8192
 v_mfma_f32_16x16x32_bf16 v[76:79], a[132:135], v[196:199], v[76:79]
 ds_read_b128 v[164:167], v18 offset:2048
 v_mfma_f32_16x16x32_bf16 v[80:83], a[136:139], v[196:199], v[80:83]
 buffer_load_dwordx4 v10, s[8:11], s30 offen offset:0 lds
 v_mfma_f32_16x16x32_bf16 v[84:87], a[140:143], v[196:199], v[84:87]
 s_waitcnt lgkmcnt(2)
 v_mfma_f32_16x16x32_bf16 v[88:91], a[132:135], v[200:203], v[88:91]
 ds_read_b128 v[168:171], v18 offset:4096
 v_mfma_f32_16x16x32_bf16 v[92:95], a[136:139], v[200:203], v[92:95]
 s_cmp_lt_u32 s33, 155648
 s_cselect_b32 s33, s33, 98304
 v_mfma_f32_16x16x32_bf16 v[96:99], a[140:143], v[200:203], v[96:99]
 v_mfma_f32_16x16x32_bf16 v[100:103], a[132:135], v[204:207], v[100:103]
 ds_read_b128 v[172:175], v18 offset:6144
 v_mfma_f32_16x16x32_bf16 v[104:107], a[136:139], v[204:207], v[104:107]
 v_mfma_f32_16x16x32_bf16 v[108:111], a[140:143], v[204:207], v[108:111]
 s_waitcnt lgkmcnt(2)
 v_mfma_f32_16x16x32_bf16 v[64:67], a[144:147], v[160:163], v[64:67]
 ds_read_b128 v[192:195], v19 offset:0
 v_mfma_f32_16x16x32_bf16 v[68:71], a[148:151], v[160:163], v[68:71]
 v_add_u32 v18, s33, v14
 v_mfma_f32_16x16x32_bf16 v[72:75], a[152:155], v[160:163], v[72:75]
 v_mfma_f32_16x16x32_bf16 v[76:79], a[144:147], v[164:167], v[76:79]
 ds_read_b128 v[196:199], v19 offset:2048
 v_mfma_f32_16x16x32_bf16 v[80:83], a[148:151], v[164:167], v[80:83]
 buffer_load_dwordx4 v11, s[8:11], s30 offen offset:1024 lds
 v_mfma_f32_16x16x32_bf16 v[84:87], a[152:155], v[164:167], v[84:87]
 s_waitcnt lgkmcnt(2)
 s_add_u32 s30, s30, 128
 v_mfma_f32_16x16x32_bf16 v[88:91], a[144:147], v[168:171], v[88:91]
 ds_read_b128 v[200:203], v19 offset:4096
 s_add_u32 m0, m0, 8192
 v_mfma_f32_16x16x32_bf16 v[92:95], a[148:151], v[168:171], v[92:95]
 s_cmp_lt_u32 m0, s46
 s_cselect_b32 m0, m0, s47
 v_mfma_f32_16x16x32_bf16 v[96:99], a[152:155], v[168:171], v[96:99]
 v_mfma_f32_16x16x32_bf16 v[100:103], a[144:147], v[172:175], v[100:103]
 ds_read_b128 v[204:207], v19 offset:6144
 v_mfma_f32_16x16x32_bf16 v[104:107], a[148:151], v[172:175], v[104:107]
 v_mfma_f32_16x16x32_bf16 v[108:111], a[152:155], v[172:175], v[108:111]
 s_waitcnt vmcnt(8) lgkmcnt(2)
 s_barrier
 v_mfma_f32_16x16x32_bf16 v[64:67], a[156:159], v[192:195], v[64:67]
 ds_read_b128 v[160:163], v18 offset:0
 v_mfma_f32_16x16x32_bf16 v[68:71], a[160:163], v[192:195], v[68:71]
 v_mfma_f32_16x16x32_bf16 v[72:75], a[164:167], v[192:195], v[72:75]
 v_add_u32 v19, s33, v15
 s_add_u32 s33, s33, 8192
 v_mfma_f32_16x16x32_bf16 v[76:79], a[156:159], v[196:199], v[76:79]
 ds_read_b128 v[164:167], v18 offset:2048
 v_mfma_f32_16x16x32_bf16 v[80:83], a[160:163], v[196:199], v[80:83]
 buffer_load_dwordx4 v10, s[8:11], s30 offen offset:0 lds
 v_mfma_f32_16x16x32_bf16 v[84:87], a[164:167], v[196:199], v[84:87]
 s_waitcnt lgkmcnt(2)
 v_mfma_f32_16x16x32_bf16 v[88:91], a[156:159], v[200:203], v[88:91]
 ds_read_b128 v[168:171], v18 offset:4096
 v_mfma_f32_16x16x32_bf16 v[92:95], a[160:163], v[200:203], v[92:95]
 s_cmp_lt_u32 s33, 155648
 s_cselect_b32 s33, s33, 98304
 v_mfma_f32_16x16x32_bf16 v[96:99], a[164:167], v[200:203], v[96:99]
 v_mfma_f32_16x16x32_bf16 v[100:103], a[156:159], v[204:207], v[100:103]
 ds_read_b128 v[172:175], v18 offset:6144
 v_mfma_f32_16x16x32_bf16 v[104:107], a[160:163], v[204:207], v[104:107]
 v_mfma_f32_16x16x32_bf16 v[108:111], a[164:167], v[204:207], v[108:111]
 s_waitcnt lgkmcnt(2)
 v_mfma_f32_16x16x32_bf16 v[64:67], a[168:171], v[160:163], v[64:67]
 ds_read_b128 v[192:195], v19 offset:0
 v_mfma_f32_16x16x32_bf16 v[68:71], a[172:175], v[160:163], v[68:71]
 v_add_u32 v18, s33, v14
 v_mfma_f32_16x16x32_bf16 v[72:75], a[176:179], v[160:163], v[72:75]
 v_mfma_f32_16x16x32_bf16 v[76:79], a[168:171], v[164:167], v[76:79]
 ds_read_b128 v[196:199], v19 offset:2048
 v_mfma_f32_16x16x32_bf16 v[80:83], a[172:175], v[164:167], v[80:83]
 buffer_load_dwordx4 v11, s[8:11], s30 offen offset:1024 lds
 v_mfma_f32_16x16x32_bf16 v[84:87], a[176:179], v[164:167], v[84:87]
 s_waitcnt lgkmcnt(2)
 s_add_u32 s30, s30, 128
 v_mfma_f32_16x16x32_bf16 v[88:91], a[168:171], v[168:171], v[88:91]
 ds_read_b128 v[200:203], v19 offset:4096
 s_add_u32 m0, m0, 8192
 v_mfma_f32_16x16x32_bf16 v[92:95], a[172:175], v[168:171], v[92:95]
 s_cmp_lt_u32 m0, s46
 s_cselect_b32 m0, m0, s47
 v_mfma_f32_16x16x32_bf16 v[96:99], a[176:179], v[168:171], v[96:99]
 v_mfma_f32_16x16x32_bf16 v[100:103], a[168:171], v[172:175], v[100:103]
 ds_read_b128 v[204:207], v19 offset:6144
 v_mfma_f32_16x16x32_bf16 v[104:107], a[172:175], v[172:175], v[104:107]
 v_mfma_f32_16x16x32_bf16 v[108:111], a[176:179], v[172:175], v[108:111]
 s_waitcnt vmcnt(8) lgkmcnt(2)
 s_barrier
 v_mfma_f32_16x16x32_bf16 v[64:67], a[180:183], v[192:195], v[64:67]
 ds_read_b128 v[160:163], v18 offset:0
 v_mfma_f32_16x16x32_bf16 v[68:71], a[184:187], v[192:195], v[68:71]
 v_mfma_f32_16x16x32_bf16 v[72:75], a[188:191], v[192:195], v[72:75]
 v_add_u32 v19, s33, v15
 s_add_u32 s33, s33, 8192
 v_mfma_f32_16x16x32_bf16 v[76:79], a[180:183], v[196:199], v[76:79]
 ds_read_b128 v[164:167], v18 offset:2048
 v_mfma_f32_16x16x32_bf16 v[80:83], a[184:187], v[196:199], v[80:83]
 buffer_load_dwordx4 v10, s[8:11], s30 offen offset:0 lds
 v_mfma_f32_16x16x32_bf16 v[84:87], a[188:191], v[196:199], v[84:87]
 s_waitcnt lgkmcnt(2)
 v_mfma_f32_16x16x32_bf16 v[88:91], a[180:183], v[200:203], v[88:91]
 ds_read_b128 v[168:171], v18 offset:4096
 v_mfma_f32_16x16x32_bf16 v[92:95], a[184:187], v[200:203], v[92:95]
 s_cmp_lt_u32 s33, 155648
 s_cselect_b32 s33, s33, 98304
 v_mfma_f32_16x16x32_bf16 v[96:99], a[188:191], v[200:203], v[96:99]
 v_mfma_f32_16x16x32_bf16 v[100:103], a[180:183], v[204:207], v[100:103]
 ds_read_b128 v[172:175], v18 offset:6144
 v_mfma_f32_16x16x32_bf16 v[104:107], a[184:187], v[204:207], v[104:107]
 v_mfma_f32_16x16x32_bf16 v[108:111], a[188:191], v[204:207], v[108:111]
 s_waitcnt lgkmcnt(2)
 v_mfma_f32_16x16x32_bf16 v[64:67], a[192:195], v[160:163], v[64:67]
 ds_read_b128 v[192:195], v19 offset:0
 v_mfma_f32_16x16x32_bf16 v[68:71], a[196:199], v[160:163], v[68:71]
 v_add_u32 v18, s33, v14
 v_mfma_f32_16x16x32_bf16 v[72:75], a[200:203], v[160:163], v[72:75]
 v_mfma_f32_16x16x32_bf16 v[76:79], a[192:195], v[164:167], v[76:79]
 ds_read_b128 v[196:199], v19 offset:2048
 v_mfma_f32_16x16x32_bf16 v[80:83], a[196:199], v[164:167], v[80:83]
 buffer_load_dwordx4 v11, s[8:11], s30 offen offset:1024 lds
 v_mfma_f32_16x16x32_bf16 v[84:87], a[200:203], v[164:167], v[84:87]
 s_waitcnt lgkmcnt(2)
 s_add_u32 s30, s30, 128
 v_mfma_f32_16x16x32_bf16 v[88:91], a[192:195], v[168:171], v[88:91]
 ds_read_b128 v[200:203], v19 offset:4096
 s_add_u32 m0, m0, 8192
 v_mfma_f32_16x16x32_bf16 v[92:95], a[196:199], v[168:171], v[92:95]
 s_cmp_lt_u32 m0, s46
 s_cselect_b32 m0, m0, s47
 v_mfma_f32_16x16x32_bf16 v[96:99], a[200:203], v[168:171], v[96:99]
 v_mfma_f32_16x16x32_bf16 v[100:103], a[192:195], v[172:175], v[100:103]
 ds_read_b128 v[204:207], v19 offset:6144
 v_mfma_f32_16x16x32_bf16 v[104:107], a[196:199], v[172:175], v[104:107]
 v_mfma_f32_16x16x32_bf16 v[108:111], a[200:203], v[172:175], v[108:111]
 s_waitcnt vmcnt(8) lgkmcnt(2)
 s_barrier
 v_mfma_f32_16x16x32_bf16 v[64:67], a[204:207], v[192:195], v[64:67]
 ds_read_b128 v[160:163], v18 offset:0
 v_mfma_f32_16x16x32_bf16 v[68:71], a[208:211], v[192:195], v[68:71]
 v_mfma_f32_16x16x32_bf16 v[72:75], a[212:215], v[192:195], v[72:75]
 v_add_u32 v19, s33, v15
 s_add_u32 s33, s33, 8192
 v_mfma_f32_16x16x32_bf16 v[76:79], a[204:207], v[196:199], v[76:79]
 ds_read_b128 v[164:167], v18 offset:2048
 v_mfma_f32_16x16x32_bf16 v[80:83], a[208:211], v[196:199], v[80:83]
 buffer_load_dwordx4 v10, s[8:11], s30 offen offset:0 lds
 v_mfma_f32_16x16x32_bf16 v[84:87], a[212:215], v[196:199], v[84:87]
 s_waitcnt lgkmcnt(2)
 v_mfma_f32_16x16x32_bf16 v[88:91], a[204:207], v[200:203], v[88:91]
 ds_read_b128 v[168:171], v18 offset:4096
 v_mfma_f32_16x16x32_bf16 v[92:95], a[208:211], v[200:203], v[92:95]
 s_cmp_lt_u32 s33, 155648
 s_cselect_b32 s33, s33, 98304
 v_mfma_f32_16x16x32_bf16 v[96:99], a[212:215], v[200:203], v[96:99]
 v_mfma_f32_16x16x32_bf16 v[100:103], a[204:207], v[204:207], v[100:103]
 ds_read_b128 v[172:175], v18 offset:6144
 v_mfma_f32_16x16x32_bf16 v[104:107], a[208:211], v[204:207], v[104:107]
 v_mfma_f32_16x16x32_bf16 v[108:111], a[212:215], v[204:207], v[108:111]
 s_waitcnt lgkmcnt(2)
 v_mfma_f32_16x16x32_bf16 v[64:67], a[216:219], v[160:163], v[64:67]
 ds_read_b128 v[192:195], v19 offset:0
 v_mfma_f32_16x16x32_bf16 v[68:71], a[220:223], v[160:163], v[68:71]
 v_add_u32 v18, s33, v14
 v_mfma_f32_16x16x32_bf16 v[72:75], a[224:227], v[160:163], v[72:75]
 v_mfma_f32_16x16x32_bf16 v[76:79], a[216:219], v[164:167], v[76:79]
 ds_read_b128 v[196:199], v19 offset:2048
 v_mfma_f32_16x16x32_bf16 v[80:83], a[220:223], v[164:167], v[80:83]
 buffer_load_dwordx4 v11, s[8:11], s30 offen offset:1024 lds
 v_mfma_f32_16x16x32_bf16 v[84:87], a[224:227], v[164:167], v[84:87]
 s_waitcnt lgkmcnt(2)
 s_add_u32 s30, s30, 128
 v_mfma_f32_16x16x32_bf16 v[88:91], a[216:219], v[168:171], v[88:91]
 ds_read_b128 v[200:203], v19 offset:4096
 s_add_u32 m0, m0, 8192
 v_mfma_f32_16x16x32_bf16 v[92:95], a[220:223], v[168:171], v[92:95]
 s_cmp_lt_u32 m0, s46
 s_cselect_b32 m0, m0, s47
 v_mfma_f32_16x16x32_bf16 v[96:99], a[224:227], v[168:171], v[96:99]
 v_mfma_f32_16x16x32_bf16 v[100:103], a[216:219], v[172:175], v[100:103]
 ds_read_b128 v[204:207], v19 offset:6144
 v_mfma_f32_16x16x32_bf16 v[104:107], a[220:223], v[172:175], v[104:107]
 v_mfma_f32_16x16x32_bf16 v[108:111], a[224:227], v[172:175], v[108:111]
 s_waitcnt vmcnt(8) lgkmcnt(2)
 s_barrier
 v_mfma_f32_16x16x32_bf16 v[64:67], a[228:231], v[192:195], v[64:67]
 ds_read_b128 v[160:163], v18 offset:0
 v_mfma_f32_16x16x32_bf16 v[68:71], a[232:235], v[192:195], v[68:71]
 v_mfma_f32_16x16x32_bf16 v[72:75], a[236:239], v[192:195], v[72:75]
 v_add_u32 v19, s33, v15
 s_add_u32 s33, s33, 8192
 v_mfma_f32_16x16x32_bf16 v[76:79], a[228:231], v[196:199], v[76:79]
 ds_read_b128 v[164:167], v18 offset:2048
 v_cvt_pk_bf16_f32 v224, v64, v65
 v_cvt_pk_bf16_f32 v225, v66, v67
 v_mfma_f32_16x16x32_bf16 v[80:83], a[232:235], v[196:199], v[80:83]
 buffer_load_dwordx4 v10, s[8:11], s30 offen offset:0 lds
 v_cvt_pk_bf16_f32 v226, v68, v69
 v_cvt_pk_bf16_f32 v227, v70, v71
 v_mfma_f32_16x16x32_bf16 v[84:87], a[236:239], v[196:199], v[84:87]
 s_waitcnt lgkmcnt(2)
 v_cvt_pk_bf16_f32 v228, v72, v73
 v_cvt_pk_bf16_f32 v229, v74, v75
 v_mfma_f32_16x16x32_bf16 v[88:91], a[228:231], v[200:203], v[88:91]
 ds_read_b128 v[168:171], v18 offset:4096
 ds_write_b64 v22, v[224:225] offset:0
 v_mfma_f32_16x16x32_bf16 v[92:95], a[232:235], v[200:203], v[92:95]
 s_cmp_lt_u32 s33, 155648
 s_cselect_b32 s33, s33, 98304
 ds_write_b64 v22, v[226:227] offset:8
 v_mfma_f32_16x16x32_bf16 v[96:99], a[236:239], v[200:203], v[96:99]
 ds_write_b64 v16, v[228:229] offset:64
 v_cvt_pk_bf16_f32 v230, v76, v77
 v_cvt_pk_bf16_f32 v231, v78, v79
 v_mfma_f32_16x16x32_bf16 v[100:103], a[228:231], v[204:207], v[100:103]
 ds_read_b128 v[172:175], v18 offset:6144
 v_cvt_pk_bf16_f32 v232, v80, v81
 v_cvt_pk_bf16_f32 v233, v82, v83
 v_cvt_pk_bf16_f32 v234, v84, v85
 v_mfma_f32_16x16x32_bf16 v[104:107], a[232:235], v[204:207], v[104:107]
 v_cvt_pk_bf16_f32 v235, v86, v87
 ds_write_b64 v22, v[230:231] offset:6400
 v_mfma_f32_16x16x32_bf16 v[108:111], a[236:239], v[204:207], v[108:111]
 ds_write_b64 v22, v[232:233] offset:6408
 ds_write_b64 v16, v[234:235] offset:6464
kvm_end_127:
 v_cvt_pk_bf16_f32 v236, v88, v89
 v_cvt_pk_bf16_f32 v237, v90, v91
 v_cvt_pk_bf16_f32 v238, v92, v93
 v_cvt_pk_bf16_f32 v239, v94, v95
 v_cvt_pk_bf16_f32 v240, v96, v97
 v_cvt_pk_bf16_f32 v241, v98, v99
 ds_write_b64 v22, v[236:237] offset:12800
 ds_write_b64 v22, v[238:239] offset:12808
 ds_write_b64 v16, v[240:241] offset:12864
 v_cvt_pk_bf16_f32 v242, v100, v101
 v_cvt_pk_bf16_f32 v243, v102, v103
 v_cvt_pk_bf16_f32 v244, v104, v105
 v_cvt_pk_bf16_f32 v245, v106, v107
 v_cvt_pk_bf16_f32 v246, v108, v109
 v_cvt_pk_bf16_f32 v247, v110, v111
 ds_write_b64 v22, v[242:243] offset:19200
 ds_write_b64 v22, v[244:245] offset:19208
 ds_write_b64 v16, v[246:247] offset:19264
 s_waitcnt lgkmcnt(0)
 s_barrier
 ds_read_b128 v[224:227], v23 offset:0
 ds_read_b128 v[228:231], v23 offset:64
 ds_read_b128 v[232:235], v23 offset:128
 ds_read_b128 v[236:239], v23 offset:192
 ds_read_b128 v[240:243], v23 offset:256
 ds_read_b128 v[244:247], v23 offset:320
 s_waitcnt lgkmcnt(0)
 s_add_u32 s21, s48, 0
 buffer_store_dwordx4 v[224:227], v26, s[16:19], s21 offen offset:0 sc1
 buffer_store_dwordx4 v[228:231], v26, s[16:19], s21 offen offset:1024 sc1
 buffer_store_dwordx4 v[232:235], v26, s[16:19], s21 offen offset:2048 sc1
 buffer_store_dwordx4 v[236:239], v26, s[16:19], s21 offen offset:3072 sc1
 s_add_u32 s21, s48, 4096
 buffer_store_dwordx4 v[240:243], v26, s[16:19], s21 offen offset:0 sc1
 buffer_store_dwordx4 v[244:247], v26, s[16:19], s21 offen offset:1024 sc1
 s_nop 1
 s_cmp_gt_u32 s26, 0
 s_cbranch_scc1 kvm_blk_126
 s_waitcnt vmcnt(6)
 s_barrier
 v_and_b32 v30, 31, v1
 buffer_load_ubyte v29, v30, s[64:67], 0 offen offset:160 sc1
 s_mov_b32 s24, 491520
 s_mov_b32 s25, 163840
 v_lshrrev_b32 v11, 3, v1
 v_and_b32 v12, 7, v1
 v_xor_b32 v12, v12, v11
 v_mul_u32_u24 v11, 1280, v11
 v_lshl_add_u32 v10, v12, 4, v11
 s_mul_i32 s46, s20, 40960
 v_add_u32 v10, s46, v10
 s_lshl_b32 s47, s20, 12
 s_add_u32 s47, s47, 0
 s_add_u32 s46, s47, 98304
 s_mov_b32 s30, s24
 s_add_u32 s32, s47, 32768
 v_add_u32 v11, 9216, v10
 v_add_u32 v12, 18432, v10
 v_add_u32 v13, 27648, v10
 s_mov_b32 m0, s32
 s_nop 0
 buffer_load_dwordx4 v10, s[8:11], s30 offen offset:0 lds
 buffer_load_dwordx4 v11, s[8:11], s30 offen offset:1024 lds
 buffer_load_dwordx4 v12, s[8:11], s30 offen offset:2048 lds
 buffer_load_dwordx4 v13, s[8:11], s30 offen offset:3072 lds
 s_add_u32 s30, s30, 128
 s_add_u32 s32, s32, 16384
 s_cmp_lt_u32 s32, s46
 s_cselect_b32 s32, s32, s47
 s_mov_b32 m0, s32
 s_nop 0
 buffer_load_dwordx4 v10, s[8:11], s30 offen offset:0 lds
 buffer_load_dwordx4 v11, s[8:11], s30 offen offset:1024 lds
 buffer_load_dwordx4 v12, s[8:11], s30 offen offset:2048 lds
 buffer_load_dwordx4 v13, s[8:11], s30 offen offset:3072 lds
 s_add_u32 s30, s30, 128
 s_add_u32 s32, s32, 16384
 s_cmp_lt_u32 s32, s46
 s_cselect_b32 s32, s32, s47
 s_mov_b32 m0, s32
 s_nop 0
 buffer_load_dwordx4 v10, s[8:11], s30 offen offset:0 lds
 buffer_load_dwordx4 v11, s[8:11], s30 offen offset:1024 lds
 buffer_load_dwordx4 v12, s[8:11], s30 offen offset:2048 lds
 buffer_load_dwordx4 v13, s[8:11], s30 offen offset:3072 lds
 s_add_u32 s30, s30, 128
 s_add_u32 s32, s32, 16384
 s_cmp_lt_u32 s32, s46
 s_cselect_b32 s32, s32, s47
 s_mov_b32 m0, s32
 s_nop 0
 buffer_load_dwordx4 v10, s[8:11], s30 offen offset:0 lds
 buffer_load_dwordx4 v11, s[8:11], s30 offen offset:1024 lds
 buffer_load_dwordx4 v12, s[8:11], s30 offen offset:2048 lds
 buffer_load_dwordx4 v13, s[8:11], s30 offen offset:3072 lds
 s_add_u32 s30, s30, 128
 s_add_u32 s32, s32, 16384
 s_cmp_lt_u32 s32, s46
 s_cselect_b32 s32, s32, s47
 s_waitcnt vmcnt(16)
 s_barrier
 s_cmp_lg_u32 s20, 0
 s_cbranch_scc1 af_131
 v_mov_b32 v4, 0
 v_mov_b32 v5, 1
 s_mov_b64 exec, 1
 buffer_atomic_add v5, v4, s[72:75], s61 offen sc1
 s_mov_b64 exec, -1
 s_nop 1
af_131:
 s_mov_b32 s26, 13
 s_mov_b32 s28, 1572864
 s_mov_b32 s101, 0
c0_132:
 v_cmp_eq_u32 vcc, 0, v29
 s_nop 1
 s_cbranch_vccz c0_133
 s_sleep 8
 v_and_b32 v30, 31, v1
 buffer_load_ubyte v29, v30, s[64:67], 0 offen offset:160 sc1
 s_add_u32 s101, s101, 1
 s_cmp_gt_u32 s101, 131072
 s_cbranch_scc1 main_end
 s_waitcnt vmcnt(0)
 s_branch c0_132
c0_133:
 v_cmp_eq_u32 vcc, 2, v29
 s_nop 1
 s_mov_b32 s37, vcc_lo
kv_main:
 v_and_b32 v6, 7, v2
 v_add_u32 v4, 0, v3
 v_xor_b32 v4, v4, v6
 v_lshlrev_b32 v4, 4, v4
 v_lshl_add_u32 v14, v2, 7, v4
 v_add_u32 v4, 4, v3
 v_xor_b32 v4, v4, v6
 v_lshlrev_b32 v4, 4, v4
 v_lshl_add_u32 v15, v2, 7, v4
 v_mul_u32_u24 v22, 400, v2
 v_mul_u32_u24 v4, 16, v3
 s_mul_i32 s21, s20, 96
 s_add_u32 s21, s21, 98304
 v_add3_u32 v22, v22, v4, s21
 v_lshlrev_b32 v4, 3, v3
 v_sub_u32 v16, v22, v4
 v_mov_b32 v9, 2731
 s_mul_i32 s21, s20, 12800
 s_add_u32 s21, s21, 98304
 v_mul_u32_u24 v4, 400, v2
 v_lshlrev_b32 v5, 4, v3
 v_add3_u32 v23, v4, v5, s21
 v_lshlrev_b32 v26, 4, v1
 s_mov_b32 s33, 32768
 s_mov_b32 s48, 0x80000000
 s_mov_b32 m0, s32
 s_nop 0
 buffer_load_dwordx4 v10, s[8:11], s30 offen offset:0 lds
 buffer_load_dwordx4 v11, s[8:11], s30 offen offset:1024 lds
 s_waitcnt vmcnt(14)
 s_barrier
 v_add_u32 v18, s33, v14
 v_add_u32 v19, s33, v15
 s_add_u32 s33, s33, 16384
 s_cmp_lt_u32 s33, 98304
 s_cselect_b32 s33, s33, 0
 ds_read_b128 v[160:163], v18 offset:0
 ds_read_b128 v[164:167], v18 offset:2048
 ds_read_b128 v[168:171], v18 offset:4096
 ds_read_b128 v[172:175], v18 offset:6144
 ds_read_b128 v[176:179], v18 offset:8192
 ds_read_b128 v[180:183], v18 offset:10240
 ds_read_b128 v[184:187], v18 offset:12288
 ds_read_b128 v[188:191], v18 offset:14336
 s_waitcnt lgkmcnt(0)
kv_blk_136:
 v_mfma_f32_16x16x32_bf16 v[64:67], a[0:3], v[160:163], 0
 ds_read_b128 v[192:195], v19 offset:0
 v_mfma_f32_16x16x32_bf16 v[68:71], a[4:7], v[160:163], 0
 v_add_u32 v18, s33, v14
 v_mfma_f32_16x16x32_bf16 v[72:75], a[8:11], v[160:163], 0
 ds_write_b64 v16, v[234:235] offset:6464
 v_mfma_f32_16x16x32_bf16 v[76:79], a[0:3], v[164:167], 0
 ds_read_b128 v[196:199], v19 offset:2048
 v_cvt_pk_bf16_f32 v236, v88, v89
 v_mfma_f32_16x16x32_bf16 v[80:83], a[4:7], v[164:167], 0
 buffer_load_dwordx4 v12, s[8:11], s30 offen offset:2048 lds
 v_mfma_f32_16x16x32_bf16 v[84:87], a[8:11], v[164:167], 0
 v_cvt_pk_bf16_f32 v237, v90, v91
 v_cvt_pk_bf16_f32 v238, v92, v93
 v_mfma_f32_16x16x32_bf16 v[88:91], a[0:3], v[168:171], 0
 ds_read_b128 v[200:203], v19 offset:4096
 v_cvt_pk_bf16_f32 v239, v94, v95
 v_mfma_f32_16x16x32_bf16 v[92:95], a[4:7], v[168:171], 0
 v_cvt_pk_bf16_f32 v240, v96, v97
 v_cvt_pk_bf16_f32 v241, v98, v99
 v_mfma_f32_16x16x32_bf16 v[96:99], a[8:11], v[168:171], 0
 ds_write_b64 v22, v[236:237] offset:12800
 ds_write_b64 v22, v[238:239] offset:12808
 ds_write_b64 v16, v[240:241] offset:12864
 v_cvt_pk_bf16_f32 v242, v100, v101
 v_cvt_pk_bf16_f32 v243, v102, v103
 v_mfma_f32_16x16x32_bf16 v[100:103], a[0:3], v[172:175], 0
 ds_read_b128 v[204:207], v19 offset:6144
 v_cvt_pk_bf16_f32 v244, v104, v105
 v_cvt_pk_bf16_f32 v245, v106, v107
 v_mfma_f32_16x16x32_bf16 v[104:107], a[4:7], v[172:175], 0
 v_cvt_pk_bf16_f32 v246, v108, v109
 v_cvt_pk_bf16_f32 v247, v110, v111
 v_mfma_f32_16x16x32_bf16 v[108:111], a[8:11], v[172:175], 0
 s_waitcnt lgkmcnt(9)
 ds_write_b64 v22, v[242:243] offset:19200
 ds_write_b64 v22, v[244:245] offset:19208
 ds_write_b64 v16, v[246:247] offset:19264
 v_cvt_pk_bf16_f32 v224, v112, v113
 v_cvt_pk_bf16_f32 v225, v114, v115
 v_mfma_f32_16x16x32_bf16 v[112:115], a[0:3], v[176:179], 0
 ds_read_b128 v[208:211], v19 offset:8192
 v_cvt_pk_bf16_f32 v226, v116, v117
 v_cvt_pk_bf16_f32 v227, v118, v119
 v_mfma_f32_16x16x32_bf16 v[116:119], a[4:7], v[176:179], 0
 v_cvt_pk_bf16_f32 v228, v120, v121
 v_cvt_pk_bf16_f32 v229, v122, v123
 v_mfma_f32_16x16x32_bf16 v[120:123], a[8:11], v[176:179], 0
 ds_write_b64 v22, v[224:225] offset:25600
 ds_write_b64 v22, v[226:227] offset:25608
 ds_write_b64 v16, v[228:229] offset:25664
 v_cvt_pk_bf16_f32 v230, v124, v125
 v_cvt_pk_bf16_f32 v231, v126, v127
 v_mfma_f32_16x16x32_bf16 v[124:127], a[0:3], v[180:183], 0
 ds_read_b128 v[212:215], v19 offset:10240
 v_cvt_pk_bf16_f32 v232, v128, v129
 v_cvt_pk_bf16_f32 v233, v130, v131
 v_mfma_f32_16x16x32_bf16 v[128:131], a[4:7], v[180:183], 0
 buffer_load_dwordx4 v13, s[8:11], s30 offen offset:3072 lds
 v_cvt_pk_bf16_f32 v234, v132, v133
 v_cvt_pk_bf16_f32 v235, v134, v135
 v_mfma_f32_16x16x32_bf16 v[132:135], a[8:11], v[180:183], 0
 s_add_u32 s30, s30, 128
 s_add_u32 m0, m0, 16384
 ds_write_b64 v22, v[230:231] offset:32000
 ds_write_b64 v22, v[232:233] offset:32008
 ds_write_b64 v16, v[234:235] offset:32064
 v_cvt_pk_bf16_f32 v236, v136, v137
 v_cvt_pk_bf16_f32 v237, v138, v139
 v_mfma_f32_16x16x32_bf16 v[136:139], a[0:3], v[184:187], 0
 ds_read_b128 v[216:219], v19 offset:12288
 v_cvt_pk_bf16_f32 v238, v140, v141
 v_cvt_pk_bf16_f32 v239, v142, v143
 v_mfma_f32_16x16x32_bf16 v[140:143], a[4:7], v[184:187], 0
 s_cmp_lt_u32 m0, s46
 s_cselect_b32 m0, m0, s47
 v_cvt_pk_bf16_f32 v240, v144, v145
 v_cvt_pk_bf16_f32 v241, v146, v147
 v_mfma_f32_16x16x32_bf16 v[144:147], a[8:11], v[184:187], 0
 ds_write_b64 v22, v[236:237] offset:38400
 ds_write_b64 v22, v[238:239] offset:38408
 ds_write_b64 v16, v[240:241] offset:38464
 v_cvt_pk_bf16_f32 v242, v148, v149
 v_cvt_pk_bf16_f32 v243, v150, v151
 v_mfma_f32_16x16x32_bf16 v[148:151], a[0:3], v[188:191], 0
 ds_read_b128 v[220:223], v19 offset:14336
 v_cvt_pk_bf16_f32 v244, v152, v153
 v_cvt_pk_bf16_f32 v245, v154, v155
 v_mfma_f32_16x16x32_bf16 v[152:155], a[4:7], v[188:191], 0
 v_cvt_pk_bf16_f32 v246, v156, v157
 v_cvt_pk_bf16_f32 v247, v158, v159
 v_mfma_f32_16x16x32_bf16 v[156:159], a[8:11], v[188:191], 0
 s_waitcnt vmcnt(12) lgkmcnt(15)
 s_barrier
 v_mfma_f32_16x16x32_bf16 v[64:67], a[12:15], v[192:195], v[64:67]
 ds_read_b128 v[160:163], v18 offset:0
 v_mfma_f32_16x16x32_bf16 v[68:71], a[16:19], v[192:195], v[68:71]
 ds_write_b64 v22, v[242:243] offset:44800
 v_mfma_f32_16x16x32_bf16 v[72:75], a[20:23], v[192:195], v[72:75]
 v_add_u32 v19, s33, v15
 s_add_u32 s33, s33, 16384
 v_mfma_f32_16x16x32_bf16 v[76:79], a[12:15], v[196:199], v[76:79]
 ds_read_b128 v[164:167], v18 offset:2048
 v_mfma_f32_16x16x32_bf16 v[80:83], a[16:19], v[196:199], v[80:83]
 buffer_load_dwordx4 v10, s[8:11], s30 offen offset:0 lds
 v_mfma_f32_16x16x32_bf16 v[84:87], a[20:23], v[196:199], v[84:87]
 s_cmp_lt_u32 s33, 98304
 s_cselect_b32 s33, s33, 0
 v_mfma_f32_16x16x32_bf16 v[88:91], a[12:15], v[200:203], v[88:91]
 ds_read_b128 v[168:171], v18 offset:4096
 v_mfma_f32_16x16x32_bf16 v[92:95], a[16:19], v[200:203], v[92:95]
 ds_write_b64 v22, v[244:245] offset:44808
 v_mfma_f32_16x16x32_bf16 v[96:99], a[20:23], v[200:203], v[96:99]
 ds_write_b64 v16, v[246:247] offset:44864
 v_mfma_f32_16x16x32_bf16 v[100:103], a[12:15], v[204:207], v[100:103]
 ds_read_b128 v[172:175], v18 offset:6144
 v_mfma_f32_16x16x32_bf16 v[104:107], a[16:19], v[204:207], v[104:107]
 v_mfma_f32_16x16x32_bf16 v[108:111], a[20:23], v[204:207], v[108:111]
 s_waitcnt lgkmcnt(7)
 v_mfma_f32_16x16x32_bf16 v[112:115], a[12:15], v[208:211], v[112:115]
 ds_read_b128 v[176:179], v18 offset:8192
 v_mfma_f32_16x16x32_bf16 v[116:119], a[16:19], v[208:211], v[116:119]
 v_mfma_f32_16x16x32_bf16 v[120:123], a[20:23], v[208:211], v[120:123]
 v_mfma_f32_16x16x32_bf16 v[124:127], a[12:15], v[212:215], v[124:127]
 ds_read_b128 v[180:183], v18 offset:10240
 v_mfma_f32_16x16x32_bf16 v[128:131], a[16:19], v[212:215], v[128:131]
 buffer_load_dwordx4 v11, s[8:11], s30 offen offset:1024 lds
 v_mfma_f32_16x16x32_bf16 v[132:135], a[20:23], v[212:215], v[132:135]
 v_mfma_f32_16x16x32_bf16 v[136:139], a[12:15], v[216:219], v[136:139]
 ds_read_b128 v[184:187], v18 offset:12288
 v_mfma_f32_16x16x32_bf16 v[140:143], a[16:19], v[216:219], v[140:143]
 v_mfma_f32_16x16x32_bf16 v[144:147], a[20:23], v[216:219], v[144:147]
 v_mfma_f32_16x16x32_bf16 v[148:151], a[12:15], v[220:223], v[148:151]
 ds_read_b128 v[188:191], v18 offset:14336
 v_mfma_f32_16x16x32_bf16 v[152:155], a[16:19], v[220:223], v[152:155]
 v_mfma_f32_16x16x32_bf16 v[156:159], a[20:23], v[220:223], v[156:159]
 s_waitcnt lgkmcnt(4)
 v_mfma_f32_16x16x32_bf16 v[64:67], a[24:27], v[160:163], v[64:67]
 ds_read_b128 v[192:195], v19 offset:0
 v_mfma_f32_16x16x32_bf16 v[68:71], a[28:31], v[160:163], v[68:71]
 v_add_u32 v18, s33, v14
 v_mfma_f32_16x16x32_bf16 v[72:75], a[32:35], v[160:163], v[72:75]
 v_mfma_f32_16x16x32_bf16 v[76:79], a[24:27], v[164:167], v[76:79]
 ds_read_b128 v[196:199], v19 offset:2048
 v_mfma_f32_16x16x32_bf16 v[80:83], a[28:31], v[164:167], v[80:83]
 buffer_load_dwordx4 v12, s[8:11], s30 offen offset:2048 lds
 v_mfma_f32_16x16x32_bf16 v[84:87], a[32:35], v[164:167], v[84:87]
 v_mfma_f32_16x16x32_bf16 v[88:91], a[24:27], v[168:171], v[88:91]
 ds_read_b128 v[200:203], v19 offset:4096
 v_mfma_f32_16x16x32_bf16 v[92:95], a[28:31], v[168:171], v[92:95]
 v_mfma_f32_16x16x32_bf16 v[96:99], a[32:35], v[168:171], v[96:99]
 v_mfma_f32_16x16x32_bf16 v[100:103], a[24:27], v[172:175], v[100:103]
 ds_read_b128 v[204:207], v19 offset:6144
 v_mfma_f32_16x16x32_bf16 v[104:107], a[28:31], v[172:175], v[104:107]
 v_mfma_f32_16x16x32_bf16 v[108:111], a[32:35], v[172:175], v[108:111]
 s_waitcnt lgkmcnt(4)
 v_mfma_f32_16x16x32_bf16 v[112:115], a[24:27], v[176:179], v[112:115]
 ds_read_b128 v[208:211], v19 offset:8192
 v_mfma_f32_16x16x32_bf16 v[116:119], a[28:31], v[176:179], v[116:119]
 v_mfma_f32_16x16x32_bf16 v[120:123], a[32:35], v[176:179], v[120:123]
 v_mfma_f32_16x16x32_bf16 v[124:127], a[24:27], v[180:183], v[124:127]
 ds_read_b128 v[212:215], v19 offset:10240
 v_mfma_f32_16x16x32_bf16 v[128:131], a[28:31], v[180:183], v[128:131]
 buffer_load_dwordx4 v13, s[8:11], s30 offen offset:3072 lds
 v_mfma_f32_16x16x32_bf16 v[132:135], a[32:35], v[180:183], v[132:135]
 s_add_u32 s30, s30, 128
 s_add_u32 m0, m0, 16384
 v_mfma_f32_16x16x32_bf16 v[136:139], a[24:27], v[184:187], v[136:139]
 ds_read_b128 v[216:219], v19 offset:12288
 v_mfma_f32_16x16x32_bf16 v[140:143], a[28:31], v[184:187], v[140:143]
 s_cmp_lt_u32 m0, s46
 s_cselect_b32 m0, m0, s47
 v_mfma_f32_16x16x32_bf16 v[144:147], a[32:35], v[184:187], v[144:147]
 v_mfma_f32_16x16x32_bf16 v[148:151], a[24:27], v[188:191], v[148:151]
 ds_read_b128 v[220:223], v19 offset:14336
 v_mfma_f32_16x16x32_bf16 v[152:155], a[28:31], v[188:191], v[152:155]
 v_mfma_f32_16x16x32_bf16 v[156:159], a[32:35], v[188:191], v[156:159]
 s_waitcnt vmcnt(12) lgkmcnt(4)
 s_barrier
 v_mfma_f32_16x16x32_bf16 v[64:67], a[36:39], v[192:195], v[64:67]
 ds_read_b128 v[160:163], v18 offset:0
 v_mfma_f32_16x16x32_bf16 v[68:71], a[40:43], v[192:195], v[68:71]
 v_mfma_f32_16x16x32_bf16 v[72:75], a[44:47], v[192:195], v[72:75]
 v_add_u32 v19, s33, v15
 s_add_u32 s33, s33, 16384
 v_mfma_f32_16x16x32_bf16 v[76:79], a[36:39], v[196:199], v[76:79]
 ds_read_b128 v[164:167], v18 offset:2048
 v_mfma_f32_16x16x32_bf16 v[80:83], a[40:43], v[196:199], v[80:83]
 buffer_load_dwordx4 v10, s[8:11], s30 offen offset:0 lds
 v_mfma_f32_16x16x32_bf16 v[84:87], a[44:47], v[196:199], v[84:87]
 s_cmp_lt_u32 s33, 98304
 s_cselect_b32 s33, s33, 0
 v_mfma_f32_16x16x32_bf16 v[88:91], a[36:39], v[200:203], v[88:91]
 ds_read_b128 v[168:171], v18 offset:4096
 v_mfma_f32_16x16x32_bf16 v[92:95], a[40:43], v[200:203], v[92:95]
 ds_read_b128 v[224:227], v23 offset:0
 v_mfma_f32_16x16x32_bf16 v[96:99], a[44:47], v[200:203], v[96:99]
 v_mfma_f32_16x16x32_bf16 v[100:103], a[36:39], v[204:207], v[100:103]
 ds_read_b128 v[172:175], v18 offset:6144
 v_mfma_f32_16x16x32_bf16 v[104:107], a[40:43], v[204:207], v[104:107]
 v_mfma_f32_16x16x32_bf16 v[108:111], a[44:47], v[204:207], v[108:111]
 s_waitcnt lgkmcnt(5)
 v_mfma_f32_16x16x32_bf16 v[112:115], a[36:39], v[208:211], v[112:115]
 ds_read_b128 v[176:179], v18 offset:8192
 v_mfma_f32_16x16x32_bf16 v[116:119], a[40:43], v[208:211], v[116:119]
 v_mfma_f32_16x16x32_bf16 v[120:123], a[44:47], v[208:211], v[120:123]
 v_mfma_f32_16x16x32_bf16 v[124:127], a[36:39], v[212:215], v[124:127]
 ds_read_b128 v[180:183], v18 offset:10240
 v_mfma_f32_16x16x32_bf16 v[128:131], a[40:43], v[212:215], v[128:131]
 buffer_load_dwordx4 v11, s[8:11], s30 offen offset:1024 lds
 v_mfma_f32_16x16x32_bf16 v[132:135], a[44:47], v[212:215], v[132:135]
 v_mfma_f32_16x16x32_bf16 v[136:139], a[36:39], v[216:219], v[136:139]
 ds_read_b128 v[184:187], v18 offset:12288
 v_mfma_f32_16x16x32_bf16 v[140:143], a[40:43], v[216:219], v[140:143]
 ds_read_b128 v[228:231], v23 offset:64
 v_mfma_f32_16x16x32_bf16 v[144:147], a[44:47], v[216:219], v[144:147]
 v_mfma_f32_16x16x32_bf16 v[148:151], a[36:39], v[220:223], v[148:151]
 ds_read_b128 v[188:191], v18 offset:14336
 v_mfma_f32_16x16x32_bf16 v[152:155], a[40:43], v[220:223], v[152:155]
 v_mfma_f32_16x16x32_bf16 v[156:159], a[44:47], v[220:223], v[156:159]
 s_waitcnt lgkmcnt(5)
 v_mfma_f32_16x16x32_bf16 v[64:67], a[48:51], v[160:163], v[64:67]
 ds_read_b128 v[192:195], v19 offset:0
 v_mfma_f32_16x16x32_bf16 v[68:71], a[52:55], v[160:163], v[68:71]
 v_add_u32 v18, s33, v14
 v_mfma_f32_16x16x32_bf16 v[72:75], a[56:59], v[160:163], v[72:75]
 v_mfma_f32_16x16x32_bf16 v[76:79], a[48:51], v[164:167], v[76:79]
 ds_read_b128 v[196:199], v19 offset:2048
 v_mfma_f32_16x16x32_bf16 v[80:83], a[52:55], v[164:167], v[80:83]
 buffer_load_dwordx4 v12, s[8:11], s30 offen offset:2048 lds
 v_mfma_f32_16x16x32_bf16 v[84:87], a[56:59], v[164:167], v[84:87]
 v_mfma_f32_16x16x32_bf16 v[88:91], a[48:51], v[168:171], v[88:91]
 ds_read_b128 v[200:203], v19 offset:4096
 v_mfma_f32_16x16x32_bf16 v[92:95], a[52:55], v[168:171], v[92:95]
 s_add_u32 s21, s48, 0
 ds_read_b128 v[232:235], v23 offset:128
 v_mfma_f32_16x16x32_bf16 v[96:99], a[56:59], v[168:171], v[96:99]
 v_mfma_f32_16x16x32_bf16 v[100:103], a[48:51], v[172:175], v[100:103]
 ds_read_b128 v[204:207], v19 offset:6144
 v_mfma_f32_16x16x32_bf16 v[104:107], a[52:55], v[172:175], v[104:107]
 buffer_store_dwordx4 v[224:227], v26, s[16:19], s21 offen offset:0 sc1
 v_mfma_f32_16x16x32_bf16 v[108:111], a[56:59], v[172:175], v[108:111]
 s_waitcnt lgkmcnt(5)
 v_mfma_f32_16x16x32_bf16 v[112:115], a[48:51], v[176:179], v[112:115]
 ds_read_b128 v[208:211], v19 offset:8192
 v_mfma_f32_16x16x32_bf16 v[116:119], a[52:55], v[176:179], v[116:119]
 v_mfma_f32_16x16x32_bf16 v[120:123], a[56:59], v[176:179], v[120:123]
 v_mfma_f32_16x16x32_bf16 v[124:127], a[48:51], v[180:183], v[124:127]
 ds_read_b128 v[212:215], v19 offset:10240
 v_mfma_f32_16x16x32_bf16 v[128:131], a[52:55], v[180:183], v[128:131]
 buffer_load_dwordx4 v13, s[8:11], s30 offen offset:3072 lds
 v_mfma_f32_16x16x32_bf16 v[132:135], a[56:59], v[180:183], v[132:135]
 s_add_u32 s30, s30, 128
 s_add_u32 m0, m0, 16384
 v_mfma_f32_16x16x32_bf16 v[136:139], a[48:51], v[184:187], v[136:139]
 ds_read_b128 v[216:219], v19 offset:12288
 v_mfma_f32_16x16x32_bf16 v[140:143], a[52:55], v[184:187], v[140:143]
 s_cmp_lt_u32 m0, s46
 s_cselect_b32 m0, m0, s47
 v_mfma_f32_16x16x32_bf16 v[144:147], a[56:59], v[184:187], v[144:147]
 ds_read_b128 v[236:239], v23 offset:192
 v_mfma_f32_16x16x32_bf16 v[148:151], a[48:51], v[188:191], v[148:151]
 ds_read_b128 v[220:223], v19 offset:14336
 v_mfma_f32_16x16x32_bf16 v[152:155], a[52:55], v[188:191], v[152:155]
 buffer_store_dwordx4 v[228:231], v26, s[16:19], s21 offen offset:1024 sc1
 v_mfma_f32_16x16x32_bf16 v[156:159], a[56:59], v[188:191], v[156:159]
 s_waitcnt vmcnt(14) lgkmcnt(5)
 s_barrier
 v_mfma_f32_16x16x32_bf16 v[64:67], a[60:63], v[192:195], v[64:67]
 ds_read_b128 v[160:163], v18 offset:0
 v_mfma_f32_16x16x32_bf16 v[68:71], a[64:67], v[192:195], v[68:71]
 v_mfma_f32_16x16x32_bf16 v[72:75], a[68:71], v[192:195], v[72:75]
 v_add_u32 v19, s33, v15
 s_add_u32 s33, s33, 16384
 v_mfma_f32_16x16x32_bf16 v[76:79], a[60:63], v[196:199], v[76:79]
 ds_read_b128 v[164:167], v18 offset:2048
 v_mfma_f32_16x16x32_bf16 v[80:83], a[64:67], v[196:199], v[80:83]
 buffer_load_dwordx4 v10, s[8:11], s30 offen offset:0 lds
 v_mfma_f32_16x16x32_bf16 v[84:87], a[68:71], v[196:199], v[84:87]
 s_cmp_lt_u32 s33, 98304
 s_cselect_b32 s33, s33, 0
 v_mfma_f32_16x16x32_bf16 v[88:91], a[60:63], v[200:203], v[88:91]
 ds_read_b128 v[168:171], v18 offset:4096
 v_mfma_f32_16x16x32_bf16 v[92:95], a[64:67], v[200:203], v[92:95]
 ds_read_b128 v[240:243], v23 offset:256
 v_mfma_f32_16x16x32_bf16 v[96:99], a[68:71], v[200:203], v[96:99]
 v_mfma_f32_16x16x32_bf16 v[100:103], a[60:63], v[204:207], v[100:103]
 ds_read_b128 v[172:175], v18 offset:6144
 v_mfma_f32_16x16x32_bf16 v[104:107], a[64:67], v[204:207], v[104:107]
 buffer_store_dwordx4 v[232:235], v26, s[16:19], s21 offen offset:2048 sc1
 v_mfma_f32_16x16x32_bf16 v[108:111], a[68:71], v[204:207], v[108:111]
 s_waitcnt lgkmcnt(5)
 v_mfma_f32_16x16x32_bf16 v[112:115], a[60:63], v[208:211], v[112:115]
 ds_read_b128 v[176:179], v18 offset:8192
 v_mfma_f32_16x16x32_bf16 v[116:119], a[64:67], v[208:211], v[116:119]
 v_mfma_f32_16x16x32_bf16 v[120:123], a[68:71], v[208:211], v[120:123]
 v_mfma_f32_16x16x32_bf16 v[124:127], a[60:63], v[212:215], v[124:127]
 ds_read_b128 v[180:183], v18 offset:10240
 v_mfma_f32_16x16x32_bf16 v[128:131], a[64:67], v[212:215], v[128:131]
 buffer_load_dwordx4 v11, s[8:11], s30 offen offset:1024 lds
 v_mfma_f32_16x16x32_bf16 v[132:135], a[68:71], v[212:215], v[132:135]
 v_mfma_f32_16x16x32_bf16 v[136:139], a[60:63], v[216:219], v[136:139]
 ds_read_b128 v[184:187], v18 offset:12288
 v_mfma_f32_16x16x32_bf16 v[140:143], a[64:67], v[216:219], v[140:143]
 ds_read_b128 v[244:247], v23 offset:320
 v_mfma_f32_16x16x32_bf16 v[144:147], a[68:71], v[216:219], v[144:147]
 v_mfma_f32_16x16x32_bf16 v[148:151], a[60:63], v[220:223], v[148:151]
 ds_read_b128 v[188:191], v18 offset:14336
 v_mfma_f32_16x16x32_bf16 v[152:155], a[64:67], v[220:223], v[152:155]
 buffer_store_dwordx4 v[236:239], v26, s[16:19], s21 offen offset:3072 sc1
 v_mfma_f32_16x16x32_bf16 v[156:159], a[68:71], v[220:223], v[156:159]
 s_waitcnt lgkmcnt(5)
 v_mfma_f32_16x16x32_bf16 v[64:67], a[72:75], v[160:163], v[64:67]
 ds_read_b128 v[192:195], v19 offset:0
 v_mfma_f32_16x16x32_bf16 v[68:71], a[76:79], v[160:163], v[68:71]
 v_add_u32 v18, s33, v14
 v_mfma_f32_16x16x32_bf16 v[72:75], a[80:83], v[160:163], v[72:75]
 v_mfma_f32_16x16x32_bf16 v[76:79], a[72:75], v[164:167], v[76:79]
 ds_read_b128 v[196:199], v19 offset:2048
 v_mfma_f32_16x16x32_bf16 v[80:83], a[76:79], v[164:167], v[80:83]
 buffer_load_dwordx4 v12, s[8:11], s30 offen offset:2048 lds
 v_mfma_f32_16x16x32_bf16 v[84:87], a[80:83], v[164:167], v[84:87]
 v_mfma_f32_16x16x32_bf16 v[88:91], a[72:75], v[168:171], v[88:91]
 ds_read_b128 v[200:203], v19 offset:4096
 v_mfma_f32_16x16x32_bf16 v[92:95], a[76:79], v[168:171], v[92:95]
 s_add_u32 s21, s48, 4096
 ds_read_b128 v[224:227], v23 offset:6400
 v_mfma_f32_16x16x32_bf16 v[96:99], a[80:83], v[168:171], v[96:99]
 v_mfma_f32_16x16x32_bf16 v[100:103], a[72:75], v[172:175], v[100:103]
 ds_read_b128 v[204:207], v19 offset:6144
 v_mfma_f32_16x16x32_bf16 v[104:107], a[76:79], v[172:175], v[104:107]
 buffer_store_dwordx4 v[240:243], v26, s[16:19], s21 offen offset:0 sc1
 v_mfma_f32_16x16x32_bf16 v[108:111], a[80:83], v[172:175], v[108:111]
 s_waitcnt lgkmcnt(5)
 v_mfma_f32_16x16x32_bf16 v[112:115], a[72:75], v[176:179], v[112:115]
 ds_read_b128 v[208:211], v19 offset:8192
 v_mfma_f32_16x16x32_bf16 v[116:119], a[76:79], v[176:179], v[116:119]
 v_mfma_f32_16x16x32_bf16 v[120:123], a[80:83], v[176:179], v[120:123]
 v_mfma_f32_16x16x32_bf16 v[124:127], a[72:75], v[180:183], v[124:127]
 ds_read_b128 v[212:215], v19 offset:10240
 v_mfma_f32_16x16x32_bf16 v[128:131], a[76:79], v[180:183], v[128:131]
 buffer_load_dwordx4 v13, s[8:11], s30 offen offset:3072 lds
 v_mfma_f32_16x16x32_bf16 v[132:135], a[80:83], v[180:183], v[132:135]
 s_add_u32 s30, s30, 128
 s_add_u32 m0, m0, 16384
 v_mfma_f32_16x16x32_bf16 v[136:139], a[72:75], v[184:187], v[136:139]
 ds_read_b128 v[216:219], v19 offset:12288
 v_mfma_f32_16x16x32_bf16 v[140:143], a[76:79], v[184:187], v[140:143]
 s_cmp_lt_u32 m0, s46
 s_cselect_b32 m0, m0, s47
 v_mfma_f32_16x16x32_bf16 v[144:147], a[80:83], v[184:187], v[144:147]
 ds_read_b128 v[228:231], v23 offset:6464
 v_mfma_f32_16x16x32_bf16 v[148:151], a[72:75], v[188:191], v[148:151]
 ds_read_b128 v[220:223], v19 offset:14336
 v_mfma_f32_16x16x32_bf16 v[152:155], a[76:79], v[188:191], v[152:155]
 buffer_store_dwordx4 v[244:247], v26, s[16:19], s21 offen offset:1024 sc1
 v_mfma_f32_16x16x32_bf16 v[156:159], a[80:83], v[188:191], v[156:159]
 s_waitcnt vmcnt(18) lgkmcnt(5)
 s_barrier
 v_mfma_f32_16x16x32_bf16 v[64:67], a[84:87], v[192:195], v[64:67]
 ds_read_b128 v[160:163], v18 offset:0
 v_mfma_f32_16x16x32_bf16 v[68:71], a[88:91], v[192:195], v[68:71]
 v_mfma_f32_16x16x32_bf16 v[72:75], a[92:95], v[192:195], v[72:75]
 v_add_u32 v19, s33, v15
 s_add_u32 s33, s33, 16384
 v_mfma_f32_16x16x32_bf16 v[76:79], a[84:87], v[196:199], v[76:79]
 ds_read_b128 v[164:167], v18 offset:2048
 v_mfma_f32_16x16x32_bf16 v[80:83], a[88:91], v[196:199], v[80:83]
 buffer_load_dwordx4 v10, s[8:11], s30 offen offset:0 lds
 v_mfma_f32_16x16x32_bf16 v[84:87], a[92:95], v[196:199], v[84:87]
 s_cmp_lt_u32 s33, 98304
 s_cselect_b32 s33, s33, 0
 v_mfma_f32_16x16x32_bf16 v[88:91], a[84:87], v[200:203], v[88:91]
 ds_read_b128 v[168:171], v18 offset:4096
 v_mfma_f32_16x16x32_bf16 v[92:95], a[88:91], v[200:203], v[92:95]
 ds_read_b128 v[232:235], v23 offset:6528
 v_mfma_f32_16x16x32_bf16 v[96:99], a[92:95], v[200:203], v[96:99]
 v_mfma_f32_16x16x32_bf16 v[100:103], a[84:87], v[204:207], v[100:103]
 ds_read_b128 v[172:175], v18 offset:6144
 v_mfma_f32_16x16x32_bf16 v[104:107], a[88:91], v[204:207], v[104:107]
 buffer_store_dwordx4 v[224:227], v26, s[16:19], s21 offen offset:2048 sc1
 v_mfma_f32_16x16x32_bf16 v[108:111], a[92:95], v[204:207], v[108:111]
 s_waitcnt lgkmcnt(5)
 v_mfma_f32_16x16x32_bf16 v[112:115], a[84:87], v[208:211], v[112:115]
 ds_read_b128 v[176:179], v18 offset:8192
 v_mfma_f32_16x16x32_bf16 v[116:119], a[88:91], v[208:211], v[116:119]
 v_mfma_f32_16x16x32_bf16 v[120:123], a[92:95], v[208:211], v[120:123]
 v_mfma_f32_16x16x32_bf16 v[124:127], a[84:87], v[212:215], v[124:127]
 ds_read_b128 v[180:183], v18 offset:10240
 v_mfma_f32_16x16x32_bf16 v[128:131], a[88:91], v[212:215], v[128:131]
 buffer_load_dwordx4 v11, s[8:11], s30 offen offset:1024 lds
 v_mfma_f32_16x16x32_bf16 v[132:135], a[92:95], v[212:215], v[132:135]
 v_mfma_f32_16x16x32_bf16 v[136:139], a[84:87], v[216:219], v[136:139]
 ds_read_b128 v[184:187], v18 offset:12288
 v_mfma_f32_16x16x32_bf16 v[140:143], a[88:91], v[216:219], v[140:143]
 ds_read_b128 v[236:239], v23 offset:6592
 v_mfma_f32_16x16x32_bf16 v[144:147], a[92:95], v[216:219], v[144:147]
 v_mfma_f32_16x16x32_bf16 v[148:151], a[84:87], v[220:223], v[148:151]
 ds_read_b128 v[188:191], v18 offset:14336
 v_mfma_f32_16x16x32_bf16 v[152:155], a[88:91], v[220:223], v[152:155]
 buffer_store_dwordx4 v[228:231], v26, s[16:19], s21 offen offset:3072 sc1
 v_mfma_f32_16x16x32_bf16 v[156:159], a[92:95], v[220:223], v[156:159]
 s_waitcnt lgkmcnt(5)
 v_mfma_f32_16x16x32_bf16 v[64:67], a[96:99], v[160:163], v[64:67]
 ds_read_b128 v[192:195], v19 offset:0
 v_mfma_f32_16x16x32_bf16 v[68:71], a[100:103], v[160:163], v[68:71]
 v_add_u32 v18, s33, v14
 v_mfma_f32_16x16x32_bf16 v[72:75], a[104:107], v[160:163], v[72:75]
 v_mfma_f32_16x16x32_bf16 v[76:79], a[96:99], v[164:167], v[76:79]
 ds_read_b128 v[196:199], v19 offset:2048
 v_mfma_f32_16x16x32_bf16 v[80:83], a[100:103], v[164:167], v[80:83]
 buffer_load_dwordx4 v12, s[8:11], s30 offen offset:2048 lds
 v_mfma_f32_16x16x32_bf16 v[84:87], a[104:107], v[164:167], v[84:87]
 v_mfma_f32_16x16x32_bf16 v[88:91], a[96:99], v[168:171], v[88:91]
 ds_read_b128 v[200:203], v19 offset:4096
 v_mfma_f32_16x16x32_bf16 v[92:95], a[100:103], v[168:171], v[92:95]
 s_add_u32 s21, s48, 8192
 ds_read_b128 v[240:243], v23 offset:6656
 v_mfma_f32_16x16x32_bf16 v[96:99], a[104:107], v[168:171], v[96:99]
 v_mfma_f32_16x16x32_bf16 v[100:103], a[96:99], v[172:175], v[100:103]
 ds_read_b128 v[204:207], v19 offset:6144
 v_mfma_f32_16x16x32_bf16 v[104:107], a[100:103], v[172:175], v[104:107]
 buffer_store_dwordx4 v[232:235], v26, s[16:19], s21 offen offset:0 sc1
 v_mfma_f32_16x16x32_bf16 v[108:111], a[104:107], v[172:175], v[108:111]
 s_waitcnt lgkmcnt(5)
 v_mfma_f32_16x16x32_bf16 v[112:115], a[96:99], v[176:179], v[112:115]
 ds_read_b128 v[208:211], v19 offset:8192
 v_mfma_f32_16x16x32_bf16 v[116:119], a[100:103], v[176:179], v[116:119]
 v_mfma_f32_16x16x32_bf16 v[120:123], a[104:107], v[176:179], v[120:123]
 v_mfma_f32_16x16x32_bf16 v[124:127], a[96:99], v[180:183], v[124:127]
 ds_read_b128 v[212:215], v19 offset:10240
 v_mfma_f32_16x16x32_bf16 v[128:131], a[100:103], v[180:183], v[128:131]
 buffer_load_dwordx4 v13, s[8:11], s30 offen offset:3072 lds
 v_mfma_f32_16x16x32_bf16 v[132:135], a[104:107], v[180:183], v[132:135]
 s_add_u32 s30, s30, 128
 s_add_u32 m0, m0, 16384
 v_mfma_f32_16x16x32_bf16 v[136:139], a[96:99], v[184:187], v[136:139]
 ds_read_b128 v[216:219], v19 offset:12288
 v_mfma_f32_16x16x32_bf16 v[140:143], a[100:103], v[184:187], v[140:143]
 s_cmp_lt_u32 m0, s46
 s_cselect_b32 m0, m0, s47
 v_mfma_f32_16x16x32_bf16 v[144:147], a[104:107], v[184:187], v[144:147]
 ds_read_b128 v[244:247], v23 offset:6720
 v_mfma_f32_16x16x32_bf16 v[148:151], a[96:99], v[188:191], v[148:151]
 ds_read_b128 v[220:223], v19 offset:14336
 v_mfma_f32_16x16x32_bf16 v[152:155], a[100:103], v[188:191], v[152:155]
 buffer_store_dwordx4 v[236:239], v26, s[16:19], s21 offen offset:1024 sc1
 v_mfma_f32_16x16x32_bf16 v[156:159], a[104:107], v[188:191], v[156:159]
 s_waitcnt vmcnt(22) lgkmcnt(5)
 s_barrier
 v_mfma_f32_16x16x32_bf16 v[64:67], a[108:111], v[192:195], v[64:67]
 ds_read_b128 v[160:163], v18 offset:0
 v_mfma_f32_16x16x32_bf16 v[68:71], a[112:115], v[192:195], v[68:71]
 v_mfma_f32_16x16x32_bf16 v[72:75], a[116:119], v[192:195], v[72:75]
 v_add_u32 v19, s33, v15
 s_add_u32 s33, s33, 16384
 v_mfma_f32_16x16x32_bf16 v[76:79], a[108:111], v[196:199], v[76:79]
 ds_read_b128 v[164:167], v18 offset:2048
 v_mfma_f32_16x16x32_bf16 v[80:83], a[112:115], v[196:199], v[80:83]
 buffer_load_dwordx4 v10, s[8:11], s30 offen offset:0 lds
 v_mfma_f32_16x16x32_bf16 v[84:87], a[116:119], v[196:199], v[84:87]
 s_cmp_lt_u32 s33, 98304
 s_cselect_b32 s33, s33, 0
 v_mfma_f32_16x16x32_bf16 v[88:91], a[108:111], v[200:203], v[88:91]
 ds_read_b128 v[168:171], v18 offset:4096
 v_mfma_f32_16x16x32_bf16 v[92:95], a[112:115], v[200:203], v[92:95]
 v_mfma_f32_16x16x32_bf16 v[96:99], a[116:119], v[200:203], v[96:99]
 v_mfma_f32_16x16x32_bf16 v[100:103], a[108:111], v[204:207], v[100:103]
 ds_read_b128 v[172:175], v18 offset:6144
 v_mfma_f32_16x16x32_bf16 v[104:107], a[112:115], v[204:207], v[104:107]
 buffer_store_dwordx4 v[240:243], v26, s[16:19], s21 offen offset:2048 sc1
 v_mfma_f32_16x16x32_bf16 v[108:111], a[116:119], v[204:207], v[108:111]
 s_waitcnt lgkmcnt(4)
 v_mfma_f32_16x16x32_bf16 v[112:115], a[108:111], v[208:211], v[112:115]
 ds_read_b128 v[176:179], v18 offset:8192
 v_mfma_f32_16x16x32_bf16 v[116:119], a[112:115], v[208:211], v[116:119]
 v_mfma_f32_16x16x32_bf16 v[120:123], a[116:119], v[208:211], v[120:123]
 v_mfma_f32_16x16x32_bf16 v[124:127], a[108:111], v[212:215], v[124:127]
 ds_read_b128 v[180:183], v18 offset:10240
 v_mfma_f32_16x16x32_bf16 v[128:131], a[112:115], v[212:215], v[128:131]
 buffer_load_dwordx4 v11, s[8:11], s30 offen offset:1024 lds
 v_mfma_f32_16x16x32_bf16 v[132:135], a[116:119], v[212:215], v[132:135]
 v_mfma_f32_16x16x32_bf16 v[136:139], a[108:111], v[216:219], v[136:139]
 ds_read_b128 v[184:187], v18 offset:12288
 v_mfma_f32_16x16x32_bf16 v[140:143], a[112:115], v[216:219], v[140:143]
 v_mfma_f32_16x16x32_bf16 v[144:147], a[116:119], v[216:219], v[144:147]
 v_mfma_f32_16x16x32_bf16 v[148:151], a[108:111], v[220:223], v[148:151]
 ds_read_b128 v[188:191], v18 offset:14336
 v_mfma_f32_16x16x32_bf16 v[152:155], a[112:115], v[220:223], v[152:155]
 buffer_store_dwordx4 v[244:247], v26, s[16:19], s21 offen offset:3072 sc1
 v_mfma_f32_16x16x32_bf16 v[156:159], a[116:119], v[220:223], v[156:159]
 s_waitcnt lgkmcnt(4)
 v_mfma_f32_16x16x32_bf16 v[64:67], a[120:123], v[160:163], v[64:67]
 ds_read_b128 v[192:195], v19 offset:0
 v_mfma_f32_16x16x32_bf16 v[68:71], a[124:127], v[160:163], v[68:71]
 v_add_u32 v18, s33, v14
 v_mfma_f32_16x16x32_bf16 v[72:75], a[128:131], v[160:163], v[72:75]
 v_mfma_f32_16x16x32_bf16 v[76:79], a[120:123], v[164:167], v[76:79]
 ds_read_b128 v[196:199], v19 offset:2048
 v_mfma_f32_16x16x32_bf16 v[80:83], a[124:127], v[164:167], v[80:83]
 buffer_load_dwordx4 v12, s[8:11], s30 offen offset:2048 lds
 v_mfma_f32_16x16x32_bf16 v[84:87], a[128:131], v[164:167], v[84:87]
 v_mfma_f32_16x16x32_bf16 v[88:91], a[120:123], v[168:171], v[88:91]
 ds_read_b128 v[200:203], v19 offset:4096
 v_mfma_f32_16x16x32_bf16 v[92:95], a[124:127], v[168:171], v[92:95]
 v_mfma_f32_16x16x32_bf16 v[96:99], a[128:131], v[168:171], v[96:99]
 v_mfma_f32_16x16x32_bf16 v[100:103], a[120:123], v[172:175], v[100:103]
 ds_read_b128 v[204:207], v19 offset:6144
 v_mfma_f32_16x16x32_bf16 v[104:107], a[124:127], v[172:175], v[104:107]
 v_mfma_f32_16x16x32_bf16 v[108:111], a[128:131], v[172:175], v[108:111]
 s_waitcnt lgkmcnt(4)
 v_mfma_f32_16x16x32_bf16 v[112:115], a[120:123], v[176:179], v[112:115]
 ds_read_b128 v[208:211], v19 offset:8192
 v_mfma_f32_16x16x32_bf16 v[116:119], a[124:127], v[176:179], v[116:119]
 v_mfma_f32_16x16x32_bf16 v[120:123], a[128:131], v[176:179], v[120:123]
 v_mfma_f32_16x16x32_bf16 v[124:127], a[120:123], v[180:183], v[124:127]
 ds_read_b128 v[212:215], v19 offset:10240
 v_mfma_f32_16x16x32_bf16 v[128:131], a[124:127], v[180:183], v[128:131]
 buffer_load_dwordx4 v13, s[8:11], s30 offen offset:3072 lds
 v_mfma_f32_16x16x32_bf16 v[132:135], a[128:131], v[180:183], v[132:135]
 s_add_u32 s30, s30, s25
 s_sub_u32 s30, s30, 1152
 v_mfma_f32_16x16x32_bf16 v[136:139], a[120:123], v[184:187], v[136:139]
 ds_read_b128 v[216:219], v19 offset:12288
 s_add_u32 m0, m0, 16384
 v_mfma_f32_16x16x32_bf16 v[140:143], a[124:127], v[184:187], v[140:143]
 s_cmp_lt_u32 m0, s46
 s_cselect_b32 m0, m0, s47
 v_mfma_f32_16x16x32_bf16 v[144:147], a[128:131], v[184:187], v[144:147]
 v_mfma_f32_16x16x32_bf16 v[148:151], a[120:123], v[188:191], v[148:151]
 ds_read_b128 v[220:223], v19 offset:14336
 v_mfma_f32_16x16x32_bf16 v[152:155], a[124:127], v[188:191], v[152:155]
 v_mfma_f32_16x16x32_bf16 v[156:159], a[128:131], v[188:191], v[156:159]
 s_waitcnt vmcnt(23) lgkmcnt(4)
 s_barrier
 v_mfma_f32_16x16x32_bf16 v[64:67], a[132:135], v[192:195], v[64:67]
 ds_read_b128 v[160:163], v18 offset:0
 v_mfma_f32_16x16x32_bf16 v[68:71], a[136:139], v[192:195], v[68:71]
 v_mfma_f32_16x16x32_bf16 v[72:75], a[140:143], v[192:195], v[72:75]
 v_add_u32 v19, s33, v15
 s_add_u32 s33, s33, 16384
 v_mfma_f32_16x16x32_bf16 v[76:79], a[132:135], v[196:199], v[76:79]
 ds_read_b128 v[164:167], v18 offset:2048
 v_mfma_f32_16x16x32_bf16 v[80:83], a[136:139], v[196:199], v[80:83]
 buffer_load_dwordx4 v10, s[8:11], s30 offen offset:0 lds
 v_mfma_f32_16x16x32_bf16 v[84:87], a[140:143], v[196:199], v[84:87]
 s_cmp_lt_u32 s33, 98304
 s_cselect_b32 s33, s33, 0
 v_mfma_f32_16x16x32_bf16 v[88:91], a[132:135], v[200:203], v[88:91]
 ds_read_b128 v[168:171], v18 offset:4096
 v_mfma_f32_16x16x32_bf16 v[92:95], a[136:139], v[200:203], v[92:95]
 v_mfma_f32_16x16x32_bf16 v[96:99], a[140:143], v[200:203], v[96:99]
 v_mfma_f32_16x16x32_bf16 v[100:103], a[132:135], v[204:207], v[100:103]
 ds_read_b128 v[172:175], v18 offset:6144
 v_mfma_f32_16x16x32_bf16 v[104:107], a[136:139], v[204:207], v[104:107]
 v_mfma_f32_16x16x32_bf16 v[108:111], a[140:143], v[204:207], v[108:111]
 s_waitcnt lgkmcnt(4)
 v_mfma_f32_16x16x32_bf16 v[112:115], a[132:135], v[208:211], v[112:115]
 ds_read_b128 v[176:179], v18 offset:8192
 v_mfma_f32_16x16x32_bf16 v[116:119], a[136:139], v[208:211], v[116:119]
 v_mfma_f32_16x16x32_bf16 v[120:123], a[140:143], v[208:211], v[120:123]
 v_mfma_f32_16x16x32_bf16 v[124:127], a[132:135], v[212:215], v[124:127]
 ds_read_b128 v[180:183], v18 offset:10240
 v_mfma_f32_16x16x32_bf16 v[128:131], a[136:139], v[212:215], v[128:131]
 buffer_load_dwordx4 v11, s[8:11], s30 offen offset:1024 lds
 v_mfma_f32_16x16x32_bf16 v[132:135], a[140:143], v[212:215], v[132:135]
 v_mfma_f32_16x16x32_bf16 v[136:139], a[132:135], v[216:219], v[136:139]
 ds_read_b128 v[184:187], v18 offset:12288
 v_mfma_f32_16x16x32_bf16 v[140:143], a[136:139], v[216:219], v[140:143]
 v_mfma_f32_16x16x32_bf16 v[144:147], a[140:143], v[216:219], v[144:147]
 v_mfma_f32_16x16x32_bf16 v[148:151], a[132:135], v[220:223], v[148:151]
 ds_read_b128 v[188:191], v18 offset:14336
 v_mfma_f32_16x16x32_bf16 v[152:155], a[136:139], v[220:223], v[152:155]
 v_mfma_f32_16x16x32_bf16 v[156:159], a[140:143], v[220:223], v[156:159]
 s_waitcnt lgkmcnt(4)
 v_mfma_f32_16x16x32_bf16 v[64:67], a[144:147], v[160:163], v[64:67]
 ds_read_b128 v[192:195], v19 offset:0
 v_mfma_f32_16x16x32_bf16 v[68:71], a[148:151], v[160:163], v[68:71]
 v_add_u32 v18, s33, v14
 v_mfma_f32_16x16x32_bf16 v[72:75], a[152:155], v[160:163], v[72:75]
 v_mfma_f32_16x16x32_bf16 v[76:79], a[144:147], v[164:167], v[76:79]
 ds_read_b128 v[196:199], v19 offset:2048
 v_mfma_f32_16x16x32_bf16 v[80:83], a[148:151], v[164:167], v[80:83]
 buffer_load_dwordx4 v12, s[8:11], s30 offen offset:2048 lds
 v_mfma_f32_16x16x32_bf16 v[84:87], a[152:155], v[164:167], v[84:87]
 v_mfma_f32_16x16x32_bf16 v[88:91], a[144:147], v[168:171], v[88:91]
 ds_read_b128 v[200:203], v19 offset:4096
 v_mfma_f32_16x16x32_bf16 v[92:95], a[148:151], v[168:171], v[92:95]
 v_mfma_f32_16x16x32_bf16 v[96:99], a[152:155], v[168:171], v[96:99]
 v_mfma_f32_16x16x32_bf16 v[100:103], a[144:147], v[172:175], v[100:103]
 ds_read_b128 v[204:207], v19 offset:6144
 v_mfma_f32_16x16x32_bf16 v[104:107], a[148:151], v[172:175], v[104:107]
 v_mfma_f32_16x16x32_bf16 v[108:111], a[152:155], v[172:175], v[108:111]
 s_waitcnt lgkmcnt(4)
 v_mfma_f32_16x16x32_bf16 v[112:115], a[144:147], v[176:179], v[112:115]
 ds_read_b128 v[208:211], v19 offset:8192
 v_mfma_f32_16x16x32_bf16 v[116:119], a[148:151], v[176:179], v[116:119]
 v_mfma_f32_16x16x32_bf16 v[120:123], a[152:155], v[176:179], v[120:123]
 v_mfma_f32_16x16x32_bf16 v[124:127], a[144:147], v[180:183], v[124:127]
 ds_read_b128 v[212:215], v19 offset:10240
 v_mfma_f32_16x16x32_bf16 v[128:131], a[148:151], v[180:183], v[128:131]
 buffer_load_dwordx4 v13, s[8:11], s30 offen offset:3072 lds
 v_mfma_f32_16x16x32_bf16 v[132:135], a[152:155], v[180:183], v[132:135]
 s_add_u32 s30, s30, 128
 s_add_u32 m0, m0, 16384
 v_mfma_f32_16x16x32_bf16 v[136:139], a[144:147], v[184:187], v[136:139]
 ds_read_b128 v[216:219], v19 offset:12288
 v_mfma_f32_16x16x32_bf16 v[140:143], a[148:151], v[184:187], v[140:143]
 s_cmp_lt_u32 m0, s46
 s_cselect_b32 m0, m0, s47
 v_mfma_f32_16x16x32_bf16 v[144:147], a[152:155], v[184:187], v[144:147]
 v_mfma_f32_16x16x32_bf16 v[148:151], a[144:147], v[188:191], v[148:151]
 ds_read_b128 v[220:223], v19 offset:14336
 v_mfma_f32_16x16x32_bf16 v[152:155], a[148:151], v[188:191], v[152:155]
 v_mfma_f32_16x16x32_bf16 v[156:159], a[152:155], v[188:191], v[156:159]
 s_waitcnt vmcnt(6) lgkmcnt(4)
 s_barrier
 v_mfma_f32_16x16x32_bf16 v[64:67], a[156:159], v[192:195], v[64:67]
 ds_read_b128 v[160:163], v18 offset:0
 v_mfma_f32_16x16x32_bf16 v[68:71], a[160:163], v[192:195], v[68:71]
 s_cmp_eq_u32 s48, 0x80000000
 s_cbranch_scc1 kv_134
 s_cmp_lg_u32 s20, 0
 s_cbranch_scc1 af_135
 v_mov_b32 v4, 0
 v_mov_b32 v5, 1
 s_mov_b64 exec, 1
 buffer_atomic_add v5, v4, s[72:75], s61 offen sc1
 s_mov_b64 exec, -1
 s_nop 1
af_135:
kv_134:
 v_mfma_f32_16x16x32_bf16 v[72:75], a[164:167], v[192:195], v[72:75]
 v_add_u32 v19, s33, v15
 s_add_u32 s33, s33, 16384
 v_mfma_f32_16x16x32_bf16 v[76:79], a[156:159], v[196:199], v[76:79]
 ds_read_b128 v[164:167], v18 offset:2048
 v_mfma_f32_16x16x32_bf16 v[80:83], a[160:163], v[196:199], v[80:83]
 buffer_load_dwordx4 v10, s[8:11], s30 offen offset:0 lds
 v_mfma_f32_16x16x32_bf16 v[84:87], a[164:167], v[196:199], v[84:87]
 s_cmp_lt_u32 s33, 98304
 s_cselect_b32 s33, s33, 0
 v_mfma_f32_16x16x32_bf16 v[88:91], a[156:159], v[200:203], v[88:91]
 ds_read_b128 v[168:171], v18 offset:4096
 v_mfma_f32_16x16x32_bf16 v[92:95], a[160:163], v[200:203], v[92:95]
 v_mfma_f32_16x16x32_bf16 v[96:99], a[164:167], v[200:203], v[96:99]
 v_mfma_f32_16x16x32_bf16 v[100:103], a[156:159], v[204:207], v[100:103]
 ds_read_b128 v[172:175], v18 offset:6144
 v_mfma_f32_16x16x32_bf16 v[104:107], a[160:163], v[204:207], v[104:107]
 v_mfma_f32_16x16x32_bf16 v[108:111], a[164:167], v[204:207], v[108:111]
 s_waitcnt lgkmcnt(4)
 v_mfma_f32_16x16x32_bf16 v[112:115], a[156:159], v[208:211], v[112:115]
 ds_read_b128 v[176:179], v18 offset:8192
 v_mfma_f32_16x16x32_bf16 v[116:119], a[160:163], v[208:211], v[116:119]
 v_mfma_f32_16x16x32_bf16 v[120:123], a[164:167], v[208:211], v[120:123]
 v_mfma_f32_16x16x32_bf16 v[124:127], a[156:159], v[212:215], v[124:127]
 ds_read_b128 v[180:183], v18 offset:10240
 v_mfma_f32_16x16x32_bf16 v[128:131], a[160:163], v[212:215], v[128:131]
 buffer_load_dwordx4 v11, s[8:11], s30 offen offset:1024 lds
 v_mfma_f32_16x16x32_bf16 v[132:135], a[164:167], v[212:215], v[132:135]
 v_mfma_f32_16x16x32_bf16 v[136:139], a[156:159], v[216:219], v[136:139]
 ds_read_b128 v[184:187], v18 offset:12288
 v_mfma_f32_16x16x32_bf16 v[140:143], a[160:163], v[216:219], v[140:143]
 v_mfma_f32_16x16x32_bf16 v[144:147], a[164:167], v[216:219], v[144:147]
 v_mfma_f32_16x16x32_bf16 v[148:151], a[156:159], v[220:223], v[148:151]
 ds_read_b128 v[188:191], v18 offset:14336
 v_mfma_f32_16x16x32_bf16 v[152:155], a[160:163], v[220:223], v[152:155]
 v_mfma_f32_16x16x32_bf16 v[156:159], a[164:167], v[220:223], v[156:159]
 s_waitcnt lgkmcnt(4)
 v_mfma_f32_16x16x32_bf16 v[64:67], a[168:171], v[160:163], v[64:67]
 ds_read_b128 v[192:195], v19 offset:0
 v_mfma_f32_16x16x32_bf16 v[68:71], a[172:175], v[160:163], v[68:71]
 v_add_u32 v18, s33, v14
 s_mov_b32 s61, s60
 v_mfma_f32_16x16x32_bf16 v[72:75], a[176:179], v[160:163], v[72:75]
 s_add_u32 s60, s60, s62
 s_mul_i32 s48, s20, 393216
 v_mfma_f32_16x16x32_bf16 v[76:79], a[168:171], v[164:167], v[76:79]
 ds_read_b128 v[196:199], v19 offset:2048
 s_add_u32 s48, s48, s27
 v_mfma_f32_16x16x32_bf16 v[80:83], a[172:175], v[164:167], v[80:83]
 buffer_load_dwordx4 v12, s[8:11], s30 offen offset:2048 lds
 v_mfma_f32_16x16x32_bf16 v[84:87], a[176:179], v[164:167], v[84:87]
 s_add_u32 s27, s27, s28
 s_sub_u32 s26, s26, 1
 v_mfma_f32_16x16x32_bf16 v[88:91], a[168:171], v[168:171], v[88:91]
 ds_read_b128 v[200:203], v19 offset:4096
 v_mfma_f32_16x16x32_bf16 v[92:95], a[172:175], v[168:171], v[92:95]
 v_mfma_f32_16x16x32_bf16 v[96:99], a[176:179], v[168:171], v[96:99]
 v_mfma_f32_16x16x32_bf16 v[100:103], a[168:171], v[172:175], v[100:103]
 ds_read_b128 v[204:207], v19 offset:6144
 v_mfma_f32_16x16x32_bf16 v[104:107], a[172:175], v[172:175], v[104:107]
 v_mfma_f32_16x16x32_bf16 v[108:111], a[176:179], v[172:175], v[108:111]
 s_waitcnt lgkmcnt(4)
 v_mfma_f32_16x16x32_bf16 v[112:115], a[168:171], v[176:179], v[112:115]
 ds_read_b128 v[208:211], v19 offset:8192
 v_mfma_f32_16x16x32_bf16 v[116:119], a[172:175], v[176:179], v[116:119]
 v_mfma_f32_16x16x32_bf16 v[120:123], a[176:179], v[176:179], v[120:123]
 v_mfma_f32_16x16x32_bf16 v[124:127], a[168:171], v[180:183], v[124:127]
 ds_read_b128 v[212:215], v19 offset:10240
 v_mfma_f32_16x16x32_bf16 v[128:131], a[172:175], v[180:183], v[128:131]
 buffer_load_dwordx4 v13, s[8:11], s30 offen offset:3072 lds
 v_mfma_f32_16x16x32_bf16 v[132:135], a[176:179], v[180:183], v[132:135]
 s_add_u32 s30, s30, 128
 s_add_u32 m0, m0, 16384
 v_mfma_f32_16x16x32_bf16 v[136:139], a[168:171], v[184:187], v[136:139]
 ds_read_b128 v[216:219], v19 offset:12288
 v_mfma_f32_16x16x32_bf16 v[140:143], a[172:175], v[184:187], v[140:143]
 s_cmp_lt_u32 m0, s46
 s_cselect_b32 m0, m0, s47
 v_mfma_f32_16x16x32_bf16 v[144:147], a[176:179], v[184:187], v[144:147]
 v_mfma_f32_16x16x32_bf16 v[148:151], a[168:171], v[188:191], v[148:151]
 ds_read_b128 v[220:223], v19 offset:14336
 v_mfma_f32_16x16x32_bf16 v[152:155], a[172:175], v[188:191], v[152:155]
 v_mfma_f32_16x16x32_bf16 v[156:159], a[176:179], v[188:191], v[156:159]
 s_waitcnt vmcnt(15) lgkmcnt(4)
 s_barrier
 v_mfma_f32_16x16x32_bf16 v[64:67], a[180:183], v[192:195], v[64:67]
 ds_read_b128 v[160:163], v18 offset:0
 v_mfma_f32_16x16x32_bf16 v[68:71], a[184:187], v[192:195], v[68:71]
 v_mfma_f32_16x16x32_bf16 v[72:75], a[188:191], v[192:195], v[72:75]
 v_add_u32 v19, s33, v15
 s_add_u32 s33, s33, 16384
 v_mfma_f32_16x16x32_bf16 v[76:79], a[180:183], v[196:199], v[76:79]
 ds_read_b128 v[164:167], v18 offset:2048
 v_mfma_f32_16x16x32_bf16 v[80:83], a[184:187], v[196:199], v[80:83]
 buffer_load_dwordx4 v10, s[8:11], s30 offen offset:0 lds
 v_mfma_f32_16x16x32_bf16 v[84:87], a[188:191], v[196:199], v[84:87]
 s_cmp_lt_u32 s33, 98304
 s_cselect_b32 s33, s33, 0
 v_mfma_f32_16x16x32_bf16 v[88:91], a[180:183], v[200:203], v[88:91]
 ds_read_b128 v[168:171], v18 offset:4096
 v_mfma_f32_16x16x32_bf16 v[92:95], a[184:187], v[200:203], v[92:95]
 v_mfma_f32_16x16x32_bf16 v[96:99], a[188:191], v[200:203], v[96:99]
 v_mfma_f32_16x16x32_bf16 v[100:103], a[180:183], v[204:207], v[100:103]
 ds_read_b128 v[172:175], v18 offset:6144
 v_mfma_f32_16x16x32_bf16 v[104:107], a[184:187], v[204:207], v[104:107]
 v_mfma_f32_16x16x32_bf16 v[108:111], a[188:191], v[204:207], v[108:111]
 s_waitcnt lgkmcnt(4)
 v_mfma_f32_16x16x32_bf16 v[112:115], a[180:183], v[208:211], v[112:115]
 ds_read_b128 v[176:179], v18 offset:8192
 v_mfma_f32_16x16x32_bf16 v[116:119], a[184:187], v[208:211], v[116:119]
 v_mfma_f32_16x16x32_bf16 v[120:123], a[188:191], v[208:211], v[120:123]
 v_mfma_f32_16x16x32_bf16 v[124:127], a[180:183], v[212:215], v[124:127]
 ds_read_b128 v[180:183], v18 offset:10240
 v_mfma_f32_16x16x32_bf16 v[128:131], a[184:187], v[212:215], v[128:131]
 buffer_load_dwordx4 v11, s[8:11], s30 offen offset:1024 lds
 v_mfma_f32_16x16x32_bf16 v[132:135], a[188:191], v[212:215], v[132:135]
 v_mfma_f32_16x16x32_bf16 v[136:139], a[180:183], v[216:219], v[136:139]
 ds_read_b128 v[184:187], v18 offset:12288
 v_mfma_f32_16x16x32_bf16 v[140:143], a[184:187], v[216:219], v[140:143]
 v_mfma_f32_16x16x32_bf16 v[144:147], a[188:191], v[216:219], v[144:147]
 v_mfma_f32_16x16x32_bf16 v[148:151], a[180:183], v[220:223], v[148:151]
 ds_read_b128 v[188:191], v18 offset:14336
 v_mfma_f32_16x16x32_bf16 v[152:155], a[184:187], v[220:223], v[152:155]
 v_mfma_f32_16x16x32_bf16 v[156:159], a[188:191], v[220:223], v[156:159]
 s_waitcnt lgkmcnt(4)
 v_mfma_f32_16x16x32_bf16 v[64:67], a[192:195], v[160:163], v[64:67]
 ds_read_b128 v[192:195], v19 offset:0
 v_mfma_f32_16x16x32_bf16 v[68:71], a[196:199], v[160:163], v[68:71]
 v_add_u32 v18, s33, v14
 v_mfma_f32_16x16x32_bf16 v[72:75], a[200:203], v[160:163], v[72:75]
 v_mfma_f32_16x16x32_bf16 v[76:79], a[192:195], v[164:167], v[76:79]
 ds_read_b128 v[196:199], v19 offset:2048
 v_mfma_f32_16x16x32_bf16 v[80:83], a[196:199], v[164:167], v[80:83]
 buffer_load_dwordx4 v12, s[8:11], s30 offen offset:2048 lds
 v_mfma_f32_16x16x32_bf16 v[84:87], a[200:203], v[164:167], v[84:87]
 v_mfma_f32_16x16x32_bf16 v[88:91], a[192:195], v[168:171], v[88:91]
 ds_read_b128 v[200:203], v19 offset:4096
 v_mfma_f32_16x16x32_bf16 v[92:95], a[196:199], v[168:171], v[92:95]
 v_mfma_f32_16x16x32_bf16 v[96:99], a[200:203], v[168:171], v[96:99]
 v_mfma_f32_16x16x32_bf16 v[100:103], a[192:195], v[172:175], v[100:103]
 ds_read_b128 v[204:207], v19 offset:6144
 v_mfma_f32_16x16x32_bf16 v[104:107], a[196:199], v[172:175], v[104:107]
 v_mfma_f32_16x16x32_bf16 v[108:111], a[200:203], v[172:175], v[108:111]
 s_waitcnt lgkmcnt(4)
 v_mfma_f32_16x16x32_bf16 v[112:115], a[192:195], v[176:179], v[112:115]
 ds_read_b128 v[208:211], v19 offset:8192
 v_mfma_f32_16x16x32_bf16 v[116:119], a[196:199], v[176:179], v[116:119]
 v_mfma_f32_16x16x32_bf16 v[120:123], a[200:203], v[176:179], v[120:123]
 v_mfma_f32_16x16x32_bf16 v[124:127], a[192:195], v[180:183], v[124:127]
 ds_read_b128 v[212:215], v19 offset:10240
 v_mfma_f32_16x16x32_bf16 v[128:131], a[196:199], v[180:183], v[128:131]
 buffer_load_dwordx4 v13, s[8:11], s30 offen offset:3072 lds
 v_mfma_f32_16x16x32_bf16 v[132:135], a[200:203], v[180:183], v[132:135]
 s_add_u32 s30, s30, 128
 s_add_u32 m0, m0, 16384
 v_mfma_f32_16x16x32_bf16 v[136:139], a[192:195], v[184:187], v[136:139]
 ds_read_b128 v[216:219], v19 offset:12288
 v_mfma_f32_16x16x32_bf16 v[140:143], a[196:199], v[184:187], v[140:143]
 s_cmp_lt_u32 m0, s46
 s_cselect_b32 m0, m0, s47
 v_mfma_f32_16x16x32_bf16 v[144:147], a[200:203], v[184:187], v[144:147]
 v_mfma_f32_16x16x32_bf16 v[148:151], a[192:195], v[188:191], v[148:151]
 ds_read_b128 v[220:223], v19 offset:14336
 v_mfma_f32_16x16x32_bf16 v[152:155], a[196:199], v[188:191], v[152:155]
 v_mfma_f32_16x16x32_bf16 v[156:159], a[200:203], v[188:191], v[156:159]
 s_waitcnt vmcnt(12) lgkmcnt(4)
 s_barrier
 v_mfma_f32_16x16x32_bf16 v[64:67], a[204:207], v[192:195], v[64:67]
 ds_read_b128 v[160:163], v18 offset:0
 v_mfma_f32_16x16x32_bf16 v[68:71], a[208:211], v[192:195], v[68:71]
 v_mfma_f32_16x16x32_bf16 v[72:75], a[212:215], v[192:195], v[72:75]
 v_add_u32 v19, s33, v15
 s_add_u32 s33, s33, 16384
 v_mfma_f32_16x16x32_bf16 v[76:79], a[204:207], v[196:199], v[76:79]
 ds_read_b128 v[164:167], v18 offset:2048
 v_mfma_f32_16x16x32_bf16 v[80:83], a[208:211], v[196:199], v[80:83]
 buffer_load_dwordx4 v10, s[8:11], s30 offen offset:0 lds
 v_mfma_f32_16x16x32_bf16 v[84:87], a[212:215], v[196:199], v[84:87]
 s_cmp_lt_u32 s33, 98304
 s_cselect_b32 s33, s33, 0
 v_mfma_f32_16x16x32_bf16 v[88:91], a[204:207], v[200:203], v[88:91]
 ds_read_b128 v[168:171], v18 offset:4096
 v_mfma_f32_16x16x32_bf16 v[92:95], a[208:211], v[200:203], v[92:95]
 v_mfma_f32_16x16x32_bf16 v[96:99], a[212:215], v[200:203], v[96:99]
 v_mfma_f32_16x16x32_bf16 v[100:103], a[204:207], v[204:207], v[100:103]
 ds_read_b128 v[172:175], v18 offset:6144
 v_mfma_f32_16x16x32_bf16 v[104:107], a[208:211], v[204:207], v[104:107]
 v_mfma_f32_16x16x32_bf16 v[108:111], a[212:215], v[204:207], v[108:111]
 s_waitcnt lgkmcnt(4)
 v_mfma_f32_16x16x32_bf16 v[112:115], a[204:207], v[208:211], v[112:115]
 ds_read_b128 v[176:179], v18 offset:8192
 v_mfma_f32_16x16x32_bf16 v[116:119], a[208:211], v[208:211], v[116:119]
 v_mfma_f32_16x16x32_bf16 v[120:123], a[212:215], v[208:211], v[120:123]
 v_mfma_f32_16x16x32_bf16 v[124:127], a[204:207], v[212:215], v[124:127]
 ds_read_b128 v[180:183], v18 offset:10240
 v_mfma_f32_16x16x32_bf16 v[128:131], a[208:211], v[212:215], v[128:131]
 buffer_load_dwordx4 v11, s[8:11], s30 offen offset:1024 lds
 v_mfma_f32_16x16x32_bf16 v[132:135], a[212:215], v[212:215], v[132:135]
 v_mfma_f32_16x16x32_bf16 v[136:139], a[204:207], v[216:219], v[136:139]
 ds_read_b128 v[184:187], v18 offset:12288
 v_mfma_f32_16x16x32_bf16 v[140:143], a[208:211], v[216:219], v[140:143]
 v_mfma_f32_16x16x32_bf16 v[144:147], a[212:215], v[216:219], v[144:147]
 v_mfma_f32_16x16x32_bf16 v[148:151], a[204:207], v[220:223], v[148:151]
 ds_read_b128 v[188:191], v18 offset:14336
 v_mfma_f32_16x16x32_bf16 v[152:155], a[208:211], v[220:223], v[152:155]
 v_mfma_f32_16x16x32_bf16 v[156:159], a[212:215], v[220:223], v[156:159]
 s_waitcnt lgkmcnt(4)
 v_mfma_f32_16x16x32_bf16 v[64:67], a[216:219], v[160:163], v[64:67]
 ds_read_b128 v[192:195], v19 offset:0
 v_mfma_f32_16x16x32_bf16 v[68:71], a[220:223], v[160:163], v[68:71]
 v_add_u32 v18, s33, v14
 v_mfma_f32_16x16x32_bf16 v[72:75], a[224:227], v[160:163], v[72:75]
 v_mfma_f32_16x16x32_bf16 v[76:79], a[216:219], v[164:167], v[76:79]
 ds_read_b128 v[196:199], v19 offset:2048
 v_mfma_f32_16x16x32_bf16 v[80:83], a[220:223], v[164:167], v[80:83]
 buffer_load_dwordx4 v12, s[8:11], s30 offen offset:2048 lds
 v_mfma_f32_16x16x32_bf16 v[84:87], a[224:227], v[164:167], v[84:87]
 v_mfma_f32_16x16x32_bf16 v[88:91], a[216:219], v[168:171], v[88:91]
 ds_read_b128 v[200:203], v19 offset:4096
 v_mfma_f32_16x16x32_bf16 v[92:95], a[220:223], v[168:171], v[92:95]
 v_mfma_f32_16x16x32_bf16 v[96:99], a[224:227], v[168:171], v[96:99]
 v_mfma_f32_16x16x32_bf16 v[100:103], a[216:219], v[172:175], v[100:103]
 ds_read_b128 v[204:207], v19 offset:6144
 v_mfma_f32_16x16x32_bf16 v[104:107], a[220:223], v[172:175], v[104:107]
 v_mfma_f32_16x16x32_bf16 v[108:111], a[224:227], v[172:175], v[108:111]
 s_waitcnt lgkmcnt(4)
 v_mfma_f32_16x16x32_bf16 v[112:115], a[216:219], v[176:179], v[112:115]
 ds_read_b128 v[208:211], v19 offset:8192
 v_mfma_f32_16x16x32_bf16 v[116:119], a[220:223], v[176:179], v[116:119]
 v_mfma_f32_16x16x32_bf16 v[120:123], a[224:227], v[176:179], v[120:123]
 v_mfma_f32_16x16x32_bf16 v[124:127], a[216:219], v[180:183], v[124:127]
 ds_read_b128 v[212:215], v19 offset:10240
 v_mfma_f32_16x16x32_bf16 v[128:131], a[220:223], v[180:183], v[128:131]
 buffer_load_dwordx4 v13, s[8:11], s30 offen offset:3072 lds
 v_mfma_f32_16x16x32_bf16 v[132:135], a[224:227], v[180:183], v[132:135]
 s_add_u32 s30, s30, 128
 s_add_u32 m0, m0, 16384
 v_mfma_f32_16x16x32_bf16 v[136:139], a[216:219], v[184:187], v[136:139]
 ds_read_b128 v[216:219], v19 offset:12288
 v_mfma_f32_16x16x32_bf16 v[140:143], a[220:223], v[184:187], v[140:143]
 s_cmp_lt_u32 m0, s46
 s_cselect_b32 m0, m0, s47
 v_mfma_f32_16x16x32_bf16 v[144:147], a[224:227], v[184:187], v[144:147]
 v_mfma_f32_16x16x32_bf16 v[148:151], a[216:219], v[188:191], v[148:151]
 ds_read_b128 v[220:223], v19 offset:14336
 v_mfma_f32_16x16x32_bf16 v[152:155], a[220:223], v[188:191], v[152:155]
 v_mfma_f32_16x16x32_bf16 v[156:159], a[224:227], v[188:191], v[156:159]
 s_waitcnt vmcnt(12) lgkmcnt(4)
 s_barrier
 v_mfma_f32_16x16x32_bf16 v[64:67], a[228:231], v[192:195], v[64:67]
 ds_read_b128 v[160:163], v18 offset:0
 v_mfma_f32_16x16x32_bf16 v[68:71], a[232:235], v[192:195], v[68:71]
 v_mfma_f32_16x16x32_bf16 v[72:75], a[236:239], v[192:195], v[72:75]
 v_add_u32 v19, s33, v15
 s_add_u32 s33, s33, 16384
 v_mfma_f32_16x16x32_bf16 v[76:79], a[228:231], v[196:199], v[76:79]
 ds_read_b128 v[164:167], v18 offset:2048
 v_cvt_pk_bf16_f32 v224, v64, v65
 v_mfma_f32_16x16x32_bf16 v[80:83], a[232:235], v[196:199], v[80:83]
 buffer_load_dwordx4 v10, s[8:11], s30 offen offset:0 lds
 v_mfma_f32_16x16x32_bf16 v[84:87], a[236:239], v[196:199], v[84:87]
 s_cmp_lt_u32 s33, 98304
 s_cselect_b32 s33, s33, 0
 v_mfma_f32_16x16x32_bf16 v[88:91], a[228:231], v[200:203], v[88:91]
 ds_read_b128 v[168:171], v18 offset:4096
 v_cvt_pk_bf16_f32 v225, v66, v67
 v_mfma_f32_16x16x32_bf16 v[92:95], a[232:235], v[200:203], v[92:95]
 v_cvt_pk_bf16_f32 v226, v68, v69
 v_cvt_pk_bf16_f32 v227, v70, v71
 v_mfma_f32_16x16x32_bf16 v[96:99], a[236:239], v[200:203], v[96:99]
 v_cvt_pk_bf16_f32 v228, v72, v73
 v_cvt_pk_bf16_f32 v229, v74, v75
 v_mfma_f32_16x16x32_bf16 v[100:103], a[228:231], v[204:207], v[100:103]
 ds_read_b128 v[172:175], v18 offset:6144
 v_mfma_f32_16x16x32_bf16 v[104:107], a[232:235], v[204:207], v[104:107]
 ds_write_b64 v22, v[224:225] offset:0
 v_mfma_f32_16x16x32_bf16 v[108:111], a[236:239], v[204:207], v[108:111]
 s_waitcnt lgkmcnt(5)
 v_mfma_f32_16x16x32_bf16 v[112:115], a[228:231], v[208:211], v[112:115]
 ds_read_b128 v[176:179], v18 offset:8192
 v_mfma_f32_16x16x32_bf16 v[116:119], a[232:235], v[208:211], v[116:119]
 ds_write_b64 v22, v[226:227] offset:8
 v_mfma_f32_16x16x32_bf16 v[120:123], a[236:239], v[208:211], v[120:123]
 ds_write_b64 v16, v[228:229] offset:64
 v_mfma_f32_16x16x32_bf16 v[124:127], a[228:231], v[212:215], v[124:127]
 ds_read_b128 v[180:183], v18 offset:10240
 v_cvt_pk_bf16_f32 v230, v76, v77
 v_mfma_f32_16x16x32_bf16 v[128:131], a[232:235], v[212:215], v[128:131]
 buffer_load_dwordx4 v11, s[8:11], s30 offen offset:1024 lds
 v_mfma_f32_16x16x32_bf16 v[132:135], a[236:239], v[212:215], v[132:135]
 v_cvt_pk_bf16_f32 v231, v78, v79
 v_cvt_pk_bf16_f32 v232, v80, v81
 v_mfma_f32_16x16x32_bf16 v[136:139], a[228:231], v[216:219], v[136:139]
 ds_read_b128 v[184:187], v18 offset:12288
 v_cvt_pk_bf16_f32 v233, v82, v83
 v_mfma_f32_16x16x32_bf16 v[140:143], a[232:235], v[216:219], v[140:143]
 v_cvt_pk_bf16_f32 v234, v84, v85
 v_cvt_pk_bf16_f32 v235, v86, v87
 v_mfma_f32_16x16x32_bf16 v[144:147], a[236:239], v[216:219], v[144:147]
 ds_write_b64 v22, v[230:231] offset:6400
 v_mfma_f32_16x16x32_bf16 v[148:151], a[228:231], v[220:223], v[148:151]
 ds_read_b128 v[188:191], v18 offset:14336
 v_mfma_f32_16x16x32_bf16 v[152:155], a[232:235], v[220:223], v[152:155]
 ds_write_b64 v22, v[232:233] offset:6408
 v_mfma_f32_16x16x32_bf16 v[156:159], a[236:239], v[220:223], v[156:159]
 s_waitcnt lgkmcnt(9)
kv_end_137:
 s_cmp_gt_u32 s26, 0
 s_cbranch_scc1 kv_blk_136
 s_nop 7
 ds_write_b64 v16, v[234:235] offset:6464
 v_cvt_pk_bf16_f32 v236, v88, v89
 v_cvt_pk_bf16_f32 v237, v90, v91
 v_cvt_pk_bf16_f32 v238, v92, v93
 v_cvt_pk_bf16_f32 v239, v94, v95
 v_cvt_pk_bf16_f32 v240, v96, v97
 v_cvt_pk_bf16_f32 v241, v98, v99
 ds_write_b64 v22, v[236:237] offset:12800
 ds_write_b64 v22, v[238:239] offset:12808
 ds_write_b64 v16, v[240:241] offset:12864
 v_cvt_pk_bf16_f32 v242, v100, v101
 v_cvt_pk_bf16_f32 v243, v102, v103
 v_cvt_pk_bf16_f32 v244, v104, v105
 v_cvt_pk_bf16_f32 v245, v106, v107
 v_cvt_pk_bf16_f32 v246, v108, v109
 v_cvt_pk_bf16_f32 v247, v110, v111
 ds_write_b64 v22, v[242:243] offset:19200
 ds_write_b64 v22, v[244:245] offset:19208
 ds_write_b64 v16, v[246:247] offset:19264
 v_cvt_pk_bf16_f32 v224, v112, v113
 v_cvt_pk_bf16_f32 v225, v114, v115
 v_cvt_pk_bf16_f32 v226, v116, v117
 v_cvt_pk_bf16_f32 v227, v118, v119
 v_cvt_pk_bf16_f32 v228, v120, v121
 v_cvt_pk_bf16_f32 v229, v122, v123
 ds_write_b64 v22, v[224:225] offset:25600
 ds_write_b64 v22, v[226:227] offset:25608
 ds_write_b64 v16, v[228:229] offset:25664
 v_cvt_pk_bf16_f32 v230, v124, v125
 v_cvt_pk_bf16_f32 v231, v126, v127
 v_cvt_pk_bf16_f32 v232, v128, v129
 v_cvt_pk_bf16_f32 v233, v130, v131
 v_cvt_pk_bf16_f32 v234, v132, v133
 v_cvt_pk_bf16_f32 v235, v134, v135
 ds_write_b64 v22, v[230:231] offset:32000
 ds_write_b64 v22, v[232:233] offset:32008
 ds_write_b64 v16, v[234:235] offset:32064
 v_cvt_pk_bf16_f32 v236, v136, v137
 v_cvt_pk_bf16_f32 v237, v138, v139
 v_cvt_pk_bf16_f32 v238, v140, v141
 v_cvt_pk_bf16_f32 v239, v142, v143
 v_cvt_pk_bf16_f32 v240, v144, v145
 v_cvt_pk_bf16_f32 v241, v146, v147
 ds_write_b64 v22, v[236:237] offset:38400
 ds_write_b64 v22, v[238:239] offset:38408
 ds_write_b64 v16, v[240:241] offset:38464
 v_cvt_pk_bf16_f32 v242, v148, v149
 v_cvt_pk_bf16_f32 v243, v150, v151
 v_cvt_pk_bf16_f32 v244, v152, v153
 v_cvt_pk_bf16_f32 v245, v154, v155
 v_cvt_pk_bf16_f32 v246, v156, v157
 v_cvt_pk_bf16_f32 v247, v158, v159
 ds_write_b64 v22, v[242:243] offset:44800
 ds_write_b64 v22, v[244:245] offset:44808
 ds_write_b64 v16, v[246:247] offset:44864
 s_waitcnt vmcnt(0) lgkmcnt(0)
 s_barrier
 ds_read_b128 v[224:227], v23 offset:0
 ds_read_b128 v[228:231], v23 offset:64
 ds_read_b128 v[232:235], v23 offset:128
 ds_read_b128 v[236:239], v23 offset:192
 ds_read_b128 v[240:243], v23 offset:256
 ds_read_b128 v[244:247], v23 offset:320
 s_waitcnt lgkmcnt(0)
 s_add_u32 s21, s48, 0
 buffer_store_dwordx4 v[224:227], v26, s[16:19], s21 offen offset:0 sc1
 buffer_store_dwordx4 v[228:231], v26, s[16:19], s21 offen offset:1024 sc1
 buffer_store_dwordx4 v[232:235], v26, s[16:19], s21 offen offset:2048 sc1
 buffer_store_dwordx4 v[236:239], v26, s[16:19], s21 offen offset:3072 sc1
 s_add_u32 s21, s48, 4096
 buffer_store_dwordx4 v[240:243], v26, s[16:19], s21 offen offset:0 sc1
 buffer_store_dwordx4 v[244:247], v26, s[16:19], s21 offen offset:1024 sc1
 s_nop 1
 ds_read_b128 v[224:227], v23 offset:6400
 ds_read_b128 v[228:231], v23 offset:6464
 ds_read_b128 v[232:235], v23 offset:6528
 ds_read_b128 v[236:239], v23 offset:6592
 ds_read_b128 v[240:243], v23 offset:6656
 ds_read_b128 v[244:247], v23 offset:6720
 s_waitcnt lgkmcnt(0)
 buffer_store_dwordx4 v[224:227], v26, s[16:19], s21 offen offset:2048 sc1
 buffer_store_dwordx4 v[228:231], v26, s[16:19], s21 offen offset:3072 sc1
 s_add_u32 s21, s48, 8192
 buffer_store_dwordx4 v[232:235], v26, s[16:19], s21 offen offset:0 sc1
 buffer_store_dwordx4 v[236:239], v26, s[16:19], s21 offen offset:1024 sc1
 buffer_store_dwordx4 v[240:243], v26, s[16:19], s21 offen offset:2048 sc1
 buffer_store_dwordx4 v[244:247], v26, s[16:19], s21 offen offset:3072 sc1
 s_nop 1
 s_waitcnt vmcnt(0)
 s_barrier
 s_cmp_lg_u32 s20, 0
 s_cbranch_scc1 af_138
 v_mov_b32 v4, 0
 v_mov_b32 v5, 1
 s_mov_b64 exec, 1
 buffer_atomic_add v5, v4, s[72:75], s61 offen sc1
 s_mov_b64 exec, -1
 s_nop 1
af_138:
 s_cmp_lg_u32 s43, 0
 s_cbranch_scc1 kv_fin
 s_lshr_b32 s2, s3, 1
 s_branch q_entry
kv_fin:
 s_branch queue
not_kv:
 s_cmp_ge_u32 s3, 96
 s_cbranch_scc1 not_vw
 s_sub_u32 s2, s3, 64
 s_load_dwordx2 s[72:73], s[0:1], 104
 s_waitcnt lgkmcnt(0)
 s_add_u32 s72, s72, 81068032
 s_addc_u32 s73, s73, 0
 s_mov_b32 s74, 129024
 s_mov_b32 s75, 0x00020000
 s_add_u32 s8, s38, 78643200
 s_addc_u32 s9, s39, 0
 s_mov_b32 s10, 2162688
 s_mov_b32 s11, 0x00020000
 s_add_u32 s12, s38, 50331648
 s_addc_u32 s13, s39, 0
 s_mov_b32 s14, 12582912
 s_mov_b32 s15, 0x00020000
 s_add_u32 s16, s38, 181305344
 s_addc_u32 s17, s39, 0
 s_mov_b32 s18, 66158592
 s_mov_b32 s19, 0x00020000
 v_lshlrev_b32 v8, 4, v0
 v_lshlrev_b32 v9, 4, v1
 v_mov_b32 v4, 0
 v_mov_b32 v12, -1
 v_mov_b32 v5, 0
 v_mov_b32 v13, -1
 v_mov_b32 v6, 0
 v_mov_b32 v14, -1
 v_mov_b32 v7, 0
 v_mov_b32 v15, -1
 s_lshl_b32 s21, s2, 12
 buffer_store_dwordx4 v[4:7], v8, s[72:75], s21 offen sc1
 s_lshr_b32 s21, s2, 3
 s_mul_i32 s21, s21, 0x88000
 s_and_b32 s21, s21, 0x108000
 s_bfe_u32 s22, s2, 0x10002
 s_lshl_b32 s22, s22, 13
 s_add_u32 s21, s21, s22
 s_bfe_u32 s22, s2, 0x10001
 s_lshl_b32 s22, s22, 14
 s_add_u32 s21, s21, s22
 s_and_b32 s22, s2, 1
 s_mul_i32 s22, s22, 3
 s_add_u32 s22, s22, s20
 s_lshl_b32 s22, s22, 10
 s_add_u32 s21, s21, s22
 s_cmp_lt_u32 s20, 3
 s_cselect_b32 s21, s21, 0x80000000
 buffer_store_dwordx4 v[4:7], v9, s[16:19], s21 offen sc1
 s_mul_i32 s23, s20, 540672
 s_lshl_b32 s21, s2, 11
 s_add_u32 s21, s21, s23
 s_add_u32 s21, s21, 81920
 buffer_store_dwordx4 v[12:15], v9, s[8:11], s21 offen sc1
 buffer_store_dwordx4 v[12:15], v9, s[8:11], s21 offen offset:1024 sc1
 s_lshl_b32 s21, s2, 9
 s_add_u32 s21, s21, s23
 s_add_u32 s21, s21, 376832
 s_mov_b64 exec, 0xffffffff
 buffer_store_dwordx4 v[12:15], v9, s[8:11], s21 offen sc1
 s_mov_b64 exec, -1
 s_lshl_b32 s21, s2, 1
 s_lshr_b32 s22, s20, 1
 s_add_u32 s21, s21, s22
 s_lshl_b32 s21, s21, 20
 s_and_b32 s22, s20, 1
 s_mul_i32 s22, s22, 49152
 s_add_u32 s21, s21, s22
 s_add_u32 s21, s21, 7168
 v_mul_u32_u24 v9, 16640, v3
 v_bfe_u32 v10, v1, 3, 1
 v_lshl_add_u32 v9, v10, 13, v9
 v_and_b32 v10, 7, v1
 v_lshl_add_u32 v9, v10, 4, v9
 s_mov_b32 exec_hi, 0xffff
 buffer_store_dwordx4 v[4:7], v9, s[16:19], s21 offen sc1
 s_mov_b64 exec, -1
 s_nop 1
 s_load_dwordx2 s[4:5], s[0:1], 0
 s_load_dwordx2 s[6:7], s[0:1], 80
 s_load_dwordx2 s[38:39], s[0:1], 104
 s_lshl_b32 s59, s2, 2
 s_add_u32 s59, s59, s20
 s_lshl_b32 s59, s59, 4
 s_waitcnt lgkmcnt(0)
 s_mov_b32 s8, s4
 s_mov_b32 s9, s5
 s_mov_b32 s10, 2621440
 s_mov_b32 s11, 0x00020000
 s_mov_b32 s12, s6
 s_mov_b32 s13, s7
 s_mov_b32 s14, 1280
 s_mov_b32 s15, 0x00020000
 s_add_u32 s28, s38, 81002496
 s_addc_u32 s29, s39, 0
 s_mov_b32 s30, 8192
 s_mov_b32 s31, 0x00020000
 v_lshlrev_b32 v4, 2, v1
 v_lshlrev_b32 v5, 4, v1
 buffer_load_dwordx4 v[16:19], v5, s[12:15], 0 offen
 buffer_load_dword v20, v4, s[12:15], 0 offen offset:1024
 s_mul_i32 s22, s59, 1280
 buffer_load_dwordx4 v[64:67], v5, s[8:11], s22 offen
 buffer_load_dword v68, v4, s[8:11], s22 offen offset:1024
 s_add_u32 s22, s22, 1280
 buffer_load_dwordx4 v[70:73], v5, s[8:11], s22 offen
 buffer_load_dword v74, v4, s[8:11], s22 offen offset:1024
 s_add_u32 s22, s22, 1280
 buffer_load_dwordx4 v[76:79], v5, s[8:11], s22 offen
 buffer_load_dword v80, v4, s[8:11], s22 offen offset:1024
 s_add_u32 s22, s22, 1280
 buffer_load_dwordx4 v[82:85], v5, s[8:11], s22 offen
 buffer_load_dword v86, v4, s[8:11], s22 offen offset:1024
 s_add_u32 s22, s22, 1280
 buffer_load_dwordx4 v[88:91], v5, s[8:11], s22 offen
 buffer_load_dword v92, v4, s[8:11], s22 offen offset:1024
 s_add_u32 s22, s22, 1280
 buffer_load_dwordx4 v[94:97], v5, s[8:11], s22 offen
 buffer_load_dword v98, v4, s[8:11], s22 offen offset:1024
 s_add_u32 s22, s22, 1280
 buffer_load_dwordx4 v[100:103], v5, s[8:11], s22 offen
 buffer_load_dword v104, v4, s[8:11], s22 offen offset:1024
 s_add_u32 s22, s22, 1280
 buffer_load_dwordx4 v[106:109], v5, s[8:11], s22 offen
 buffer_load_dword v110, v4, s[8:11], s22 offen offset:1024
 s_add_u32 s22, s22, 1280
 buffer_load_dwordx4 v[112:115], v5, s[8:11], s22 offen
 buffer_load_dword v116, v4, s[8:11], s22 offen offset:1024
 s_add_u32 s22, s22, 1280
 buffer_load_dwordx4 v[118:121], v5, s[8:11], s22 offen
 buffer_load_dword v122, v4, s[8:11], s22 offen offset:1024
 s_add_u32 s22, s22, 1280
 buffer_load_dwordx4 v[124:127], v5, s[8:11], s22 offen
 buffer_load_dword v128, v4, s[8:11], s22 offen offset:1024
 s_add_u32 s22, s22, 1280
 buffer_load_dwordx4 v[130:133], v5, s[8:11], s22 offen
 buffer_load_dword v134, v4, s[8:11], s22 offen offset:1024
 s_add_u32 s22, s22, 1280
 buffer_load_dwordx4 v[136:139], v5, s[8:11], s22 offen
 buffer_load_dword v140, v4, s[8:11], s22 offen offset:1024
 s_add_u32 s22, s22, 1280
 buffer_load_dwordx4 v[142:145], v5, s[8:11], s22 offen
 buffer_load_dword v146, v4, s[8:11], s22 offen offset:1024
 s_add_u32 s22, s22, 1280
 buffer_load_dwordx4 v[148:151], v5, s[8:11], s22 offen
 buffer_load_dword v152, v4, s[8:11], s22 offen offset:1024
 s_add_u32 s22, s22, 1280
 buffer_load_dwordx4 v[154:157], v5, s[8:11], s22 offen
 buffer_load_dword v158, v4, s[8:11], s22 offen offset:1024
 s_add_u32 s22, s22, 1280
 s_waitcnt vmcnt(32)
 v_lshlrev_b32 v8, 16, v16
 v_and_b32 v16, 0xffff0000, v16
 v_lshlrev_b32 v9, 16, v17
 v_and_b32 v17, 0xffff0000, v17
 v_lshlrev_b32 v10, 16, v18
 v_and_b32 v18, 0xffff0000, v18
 v_lshlrev_b32 v11, 16, v19
 v_and_b32 v19, 0xffff0000, v19
 v_lshlrev_b32 v12, 16, v20
 v_and_b32 v20, 0xffff0000, v20
 s_waitcnt vmcnt(30)
 v_mov_b32 v160, 0
 v_lshlrev_b32 v25, 16, v64
 v_and_b32 v26, 0xffff0000, v64
 v_mul_f32 v25, v25, v8
 v_mul_f32 v26, v26, v16
 v_cvt_pk_bf16_f32 v25, v25, v26
 v_lshlrev_b32 v26, 16, v25
 v_and_b32 v25, 0xffff0000, v25
 v_add_f32 v160, v160, v26
 v_add_f32 v160, v160, v25
 v_lshlrev_b32 v25, 16, v65
 v_and_b32 v26, 0xffff0000, v65
 v_mul_f32 v25, v25, v9
 v_mul_f32 v26, v26, v17
 v_cvt_pk_bf16_f32 v25, v25, v26
 v_lshlrev_b32 v26, 16, v25
 v_and_b32 v25, 0xffff0000, v25
 v_add_f32 v160, v160, v26
 v_add_f32 v160, v160, v25
 v_lshlrev_b32 v25, 16, v66
 v_and_b32 v26, 0xffff0000, v66
 v_mul_f32 v25, v25, v10
 v_mul_f32 v26, v26, v18
 v_cvt_pk_bf16_f32 v25, v25, v26
 v_lshlrev_b32 v26, 16, v25
 v_and_b32 v25, 0xffff0000, v25
 v_add_f32 v160, v160, v26
 v_add_f32 v160, v160, v25
 v_lshlrev_b32 v25, 16, v67
 v_and_b32 v26, 0xffff0000, v67
 v_mul_f32 v25, v25, v11
 v_mul_f32 v26, v26, v19
 v_cvt_pk_bf16_f32 v25, v25, v26
 v_lshlrev_b32 v26, 16, v25
 v_and_b32 v25, 0xffff0000, v25
 v_add_f32 v160, v160, v26
 v_add_f32 v160, v160, v25
 v_lshlrev_b32 v25, 16, v68
 v_and_b32 v26, 0xffff0000, v68
 v_mul_f32 v25, v25, v12
 v_mul_f32 v26, v26, v20
 v_cvt_pk_bf16_f32 v25, v25, v26
 v_lshlrev_b32 v26, 16, v25
 v_and_b32 v25, 0xffff0000, v25
 v_add_f32 v160, v160, v26
 v_add_f32 v160, v160, v25
 s_waitcnt vmcnt(28)
 v_mov_b32 v161, 0
 v_lshlrev_b32 v25, 16, v70
 v_and_b32 v26, 0xffff0000, v70
 v_mul_f32 v25, v25, v8
 v_mul_f32 v26, v26, v16
 v_cvt_pk_bf16_f32 v25, v25, v26
 v_lshlrev_b32 v26, 16, v25
 v_and_b32 v25, 0xffff0000, v25
 v_add_f32 v161, v161, v26
 v_add_f32 v161, v161, v25
 v_lshlrev_b32 v25, 16, v71
 v_and_b32 v26, 0xffff0000, v71
 v_mul_f32 v25, v25, v9
 v_mul_f32 v26, v26, v17
 v_cvt_pk_bf16_f32 v25, v25, v26
 v_lshlrev_b32 v26, 16, v25
 v_and_b32 v25, 0xffff0000, v25
 v_add_f32 v161, v161, v26
 v_add_f32 v161, v161, v25
 v_lshlrev_b32 v25, 16, v72
 v_and_b32 v26, 0xffff0000, v72
 v_mul_f32 v25, v25, v10
 v_mul_f32 v26, v26, v18
 v_cvt_pk_bf16_f32 v25, v25, v26
 v_lshlrev_b32 v26, 16, v25
 v_and_b32 v25, 0xffff0000, v25
 v_add_f32 v161, v161, v26
 v_add_f32 v161, v161, v25
 v_lshlrev_b32 v25, 16, v73
 v_and_b32 v26, 0xffff0000, v73
 v_mul_f32 v25, v25, v11
 v_mul_f32 v26, v26, v19
 v_cvt_pk_bf16_f32 v25, v25, v26
 v_lshlrev_b32 v26, 16, v25
 v_and_b32 v25, 0xffff0000, v25
 v_add_f32 v161, v161, v26
 v_add_f32 v161, v161, v25
 v_lshlrev_b32 v25, 16, v74
 v_and_b32 v26, 0xffff0000, v74
 v_mul_f32 v25, v25, v12
 v_mul_f32 v26, v26, v20
 v_cvt_pk_bf16_f32 v25, v25, v26
 v_lshlrev_b32 v26, 16, v25
 v_and_b32 v25, 0xffff0000, v25
 v_add_f32 v161, v161, v26
 v_add_f32 v161, v161, v25
 s_waitcnt vmcnt(26)
 v_mov_b32 v162, 0
 v_lshlrev_b32 v25, 16, v76
 v_and_b32 v26, 0xffff0000, v76
 v_mul_f32 v25, v25, v8
 v_mul_f32 v26, v26, v16
 v_cvt_pk_bf16_f32 v25, v25, v26
 v_lshlrev_b32 v26, 16, v25
 v_and_b32 v25, 0xffff0000, v25
 v_add_f32 v162, v162, v26
 v_add_f32 v162, v162, v25
 v_lshlrev_b32 v25, 16, v77
 v_and_b32 v26, 0xffff0000, v77
 v_mul_f32 v25, v25, v9
 v_mul_f32 v26, v26, v17
 v_cvt_pk_bf16_f32 v25, v25, v26
 v_lshlrev_b32 v26, 16, v25
 v_and_b32 v25, 0xffff0000, v25
 v_add_f32 v162, v162, v26
 v_add_f32 v162, v162, v25
 v_lshlrev_b32 v25, 16, v78
 v_and_b32 v26, 0xffff0000, v78
 v_mul_f32 v25, v25, v10
 v_mul_f32 v26, v26, v18
 v_cvt_pk_bf16_f32 v25, v25, v26
 v_lshlrev_b32 v26, 16, v25
 v_and_b32 v25, 0xffff0000, v25
 v_add_f32 v162, v162, v26
 v_add_f32 v162, v162, v25
 v_lshlrev_b32 v25, 16, v79
 v_and_b32 v26, 0xffff0000, v79
 v_mul_f32 v25, v25, v11
 v_mul_f32 v26, v26, v19
 v_cvt_pk_bf16_f32 v25, v25, v26
 v_lshlrev_b32 v26, 16, v25
 v_and_b32 v25, 0xffff0000, v25
 v_add_f32 v162, v162, v26
 v_add_f32 v162, v162, v25
 v_lshlrev_b32 v25, 16, v80
 v_and_b32 v26, 0xffff0000, v80
 v_mul_f32 v25, v25, v12
 v_mul_f32 v26, v26, v20
 v_cvt_pk_bf16_f32 v25, v25, v26
 v_lshlrev_b32 v26, 16, v25
 v_and_b32 v25, 0xffff0000, v25
 v_add_f32 v162, v162, v26
 v_add_f32 v162, v162, v25
 s_waitcnt vmcnt(24)
 v_mov_b32 v163, 0
 v_lshlrev_b32 v25, 16, v82
 v_and_b32 v26, 0xffff0000, v82
 v_mul_f32 v25, v25, v8
 v_mul_f32 v26, v26, v16
 v_cvt_pk_bf16_f32 v25, v25, v26
 v_lshlrev_b32 v26, 16, v25
 v_and_b32 v25, 0xffff0000, v25
 v_add_f32 v163, v163, v26
 v_add_f32 v163, v163, v25
 v_lshlrev_b32 v25, 16, v83
 v_and_b32 v26, 0xffff0000, v83
 v_mul_f32 v25, v25, v9
 v_mul_f32 v26, v26, v17
 v_cvt_pk_bf16_f32 v25, v25, v26
 v_lshlrev_b32 v26, 16, v25
 v_and_b32 v25, 0xffff0000, v25
 v_add_f32 v163, v163, v26
 v_add_f32 v163, v163, v25
 v_lshlrev_b32 v25, 16, v84
 v_and_b32 v26, 0xffff0000, v84
 v_mul_f32 v25, v25, v10
 v_mul_f32 v26, v26, v18
 v_cvt_pk_bf16_f32 v25, v25, v26
 v_lshlrev_b32 v26, 16, v25
 v_and_b32 v25, 0xffff0000, v25
 v_add_f32 v163, v163, v26
 v_add_f32 v163, v163, v25
 v_lshlrev_b32 v25, 16, v85
 v_and_b32 v26, 0xffff0000, v85
 v_mul_f32 v25, v25, v11
 v_mul_f32 v26, v26, v19
 v_cvt_pk_bf16_f32 v25, v25, v26
 v_lshlrev_b32 v26, 16, v25
 v_and_b32 v25, 0xffff0000, v25
 v_add_f32 v163, v163, v26
 v_add_f32 v163, v163, v25
 v_lshlrev_b32 v25, 16, v86
 v_and_b32 v26, 0xffff0000, v86
 v_mul_f32 v25, v25, v12
 v_mul_f32 v26, v26, v20
 v_cvt_pk_bf16_f32 v25, v25, v26
 v_lshlrev_b32 v26, 16, v25
 v_and_b32 v25, 0xffff0000, v25
 v_add_f32 v163, v163, v26
 v_add_f32 v163, v163, v25
 s_waitcnt vmcnt(22)
 v_mov_b32 v164, 0
 v_lshlrev_b32 v25, 16, v88
 v_and_b32 v26, 0xffff0000, v88
 v_mul_f32 v25, v25, v8
 v_mul_f32 v26, v26, v16
 v_cvt_pk_bf16_f32 v25, v25, v26
 v_lshlrev_b32 v26, 16, v25
 v_and_b32 v25, 0xffff0000, v25
 v_add_f32 v164, v164, v26
 v_add_f32 v164, v164, v25
 v_lshlrev_b32 v25, 16, v89
 v_and_b32 v26, 0xffff0000, v89
 v_mul_f32 v25, v25, v9
 v_mul_f32 v26, v26, v17
 v_cvt_pk_bf16_f32 v25, v25, v26
 v_lshlrev_b32 v26, 16, v25
 v_and_b32 v25, 0xffff0000, v25
 v_add_f32 v164, v164, v26
 v_add_f32 v164, v164, v25
 v_lshlrev_b32 v25, 16, v90
 v_and_b32 v26, 0xffff0000, v90
 v_mul_f32 v25, v25, v10
 v_mul_f32 v26, v26, v18
 v_cvt_pk_bf16_f32 v25, v25, v26
 v_lshlrev_b32 v26, 16, v25
 v_and_b32 v25, 0xffff0000, v25
 v_add_f32 v164, v164, v26
 v_add_f32 v164, v164, v25
 v_lshlrev_b32 v25, 16, v91
 v_and_b32 v26, 0xffff0000, v91
 v_mul_f32 v25, v25, v11
 v_mul_f32 v26, v26, v19
 v_cvt_pk_bf16_f32 v25, v25, v26
 v_lshlrev_b32 v26, 16, v25
 v_and_b32 v25, 0xffff0000, v25
 v_add_f32 v164, v164, v26
 v_add_f32 v164, v164, v25
 v_lshlrev_b32 v25, 16, v92
 v_and_b32 v26, 0xffff0000, v92
 v_mul_f32 v25, v25, v12
 v_mul_f32 v26, v26, v20
 v_cvt_pk_bf16_f32 v25, v25, v26
 v_lshlrev_b32 v26, 16, v25
 v_and_b32 v25, 0xffff0000, v25
 v_add_f32 v164, v164, v26
 v_add_f32 v164, v164, v25
 s_waitcnt vmcnt(20)
 v_mov_b32 v165, 0
 v_lshlrev_b32 v25, 16, v94
 v_and_b32 v26, 0xffff0000, v94
 v_mul_f32 v25, v25, v8
 v_mul_f32 v26, v26, v16
 v_cvt_pk_bf16_f32 v25, v25, v26
 v_lshlrev_b32 v26, 16, v25
 v_and_b32 v25, 0xffff0000, v25
 v_add_f32 v165, v165, v26
 v_add_f32 v165, v165, v25
 v_lshlrev_b32 v25, 16, v95
 v_and_b32 v26, 0xffff0000, v95
 v_mul_f32 v25, v25, v9
 v_mul_f32 v26, v26, v17
 v_cvt_pk_bf16_f32 v25, v25, v26
 v_lshlrev_b32 v26, 16, v25
 v_and_b32 v25, 0xffff0000, v25
 v_add_f32 v165, v165, v26
 v_add_f32 v165, v165, v25
 v_lshlrev_b32 v25, 16, v96
 v_and_b32 v26, 0xffff0000, v96
 v_mul_f32 v25, v25, v10
 v_mul_f32 v26, v26, v18
 v_cvt_pk_bf16_f32 v25, v25, v26
 v_lshlrev_b32 v26, 16, v25
 v_and_b32 v25, 0xffff0000, v25
 v_add_f32 v165, v165, v26
 v_add_f32 v165, v165, v25
 v_lshlrev_b32 v25, 16, v97
 v_and_b32 v26, 0xffff0000, v97
 v_mul_f32 v25, v25, v11
 v_mul_f32 v26, v26, v19
 v_cvt_pk_bf16_f32 v25, v25, v26
 v_lshlrev_b32 v26, 16, v25
 v_and_b32 v25, 0xffff0000, v25
 v_add_f32 v165, v165, v26
 v_add_f32 v165, v165, v25
 v_lshlrev_b32 v25, 16, v98
 v_and_b32 v26, 0xffff0000, v98
 v_mul_f32 v25, v25, v12
 v_mul_f32 v26, v26, v20
 v_cvt_pk_bf16_f32 v25, v25, v26
 v_lshlrev_b32 v26, 16, v25
 v_and_b32 v25, 0xffff0000, v25
 v_add_f32 v165, v165, v26
 v_add_f32 v165, v165, v25
 s_waitcnt vmcnt(18)
 v_mov_b32 v166, 0
 v_lshlrev_b32 v25, 16, v100
 v_and_b32 v26, 0xffff0000, v100
 v_mul_f32 v25, v25, v8
 v_mul_f32 v26, v26, v16
 v_cvt_pk_bf16_f32 v25, v25, v26
 v_lshlrev_b32 v26, 16, v25
 v_and_b32 v25, 0xffff0000, v25
 v_add_f32 v166, v166, v26
 v_add_f32 v166, v166, v25
 v_lshlrev_b32 v25, 16, v101
 v_and_b32 v26, 0xffff0000, v101
 v_mul_f32 v25, v25, v9
 v_mul_f32 v26, v26, v17
 v_cvt_pk_bf16_f32 v25, v25, v26
 v_lshlrev_b32 v26, 16, v25
 v_and_b32 v25, 0xffff0000, v25
 v_add_f32 v166, v166, v26
 v_add_f32 v166, v166, v25
 v_lshlrev_b32 v25, 16, v102
 v_and_b32 v26, 0xffff0000, v102
 v_mul_f32 v25, v25, v10
 v_mul_f32 v26, v26, v18
 v_cvt_pk_bf16_f32 v25, v25, v26
 v_lshlrev_b32 v26, 16, v25
 v_and_b32 v25, 0xffff0000, v25
 v_add_f32 v166, v166, v26
 v_add_f32 v166, v166, v25
 v_lshlrev_b32 v25, 16, v103
 v_and_b32 v26, 0xffff0000, v103
 v_mul_f32 v25, v25, v11
 v_mul_f32 v26, v26, v19
 v_cvt_pk_bf16_f32 v25, v25, v26
 v_lshlrev_b32 v26, 16, v25
 v_and_b32 v25, 0xffff0000, v25
 v_add_f32 v166, v166, v26
 v_add_f32 v166, v166, v25
 v_lshlrev_b32 v25, 16, v104
 v_and_b32 v26, 0xffff0000, v104
 v_mul_f32 v25, v25, v12
 v_mul_f32 v26, v26, v20
 v_cvt_pk_bf16_f32 v25, v25, v26
 v_lshlrev_b32 v26, 16, v25
 v_and_b32 v25, 0xffff0000, v25
 v_add_f32 v166, v166, v26
 v_add_f32 v166, v166, v25
 s_waitcnt vmcnt(16)
 v_mov_b32 v167, 0
 v_lshlrev_b32 v25, 16, v106
 v_and_b32 v26, 0xffff0000, v106
 v_mul_f32 v25, v25, v8
 v_mul_f32 v26, v26, v16
 v_cvt_pk_bf16_f32 v25, v25, v26
 v_lshlrev_b32 v26, 16, v25
 v_and_b32 v25, 0xffff0000, v25
 v_add_f32 v167, v167, v26
 v_add_f32 v167, v167, v25
 v_lshlrev_b32 v25, 16, v107
 v_and_b32 v26, 0xffff0000, v107
 v_mul_f32 v25, v25, v9
 v_mul_f32 v26, v26, v17
 v_cvt_pk_bf16_f32 v25, v25, v26
 v_lshlrev_b32 v26, 16, v25
 v_and_b32 v25, 0xffff0000, v25
 v_add_f32 v167, v167, v26
 v_add_f32 v167, v167, v25
 v_lshlrev_b32 v25, 16, v108
 v_and_b32 v26, 0xffff0000, v108
 v_mul_f32 v25, v25, v10
 v_mul_f32 v26, v26, v18
 v_cvt_pk_bf16_f32 v25, v25, v26
 v_lshlrev_b32 v26, 16, v25
 v_and_b32 v25, 0xffff0000, v25
 v_add_f32 v167, v167, v26
 v_add_f32 v167, v167, v25
 v_lshlrev_b32 v25, 16, v109
 v_and_b32 v26, 0xffff0000, v109
 v_mul_f32 v25, v25, v11
 v_mul_f32 v26, v26, v19
 v_cvt_pk_bf16_f32 v25, v25, v26
 v_lshlrev_b32 v26, 16, v25
 v_and_b32 v25, 0xffff0000, v25
 v_add_f32 v167, v167, v26
 v_add_f32 v167, v167, v25
 v_lshlrev_b32 v25, 16, v110
 v_and_b32 v26, 0xffff0000, v110
 v_mul_f32 v25, v25, v12
 v_mul_f32 v26, v26, v20
 v_cvt_pk_bf16_f32 v25, v25, v26
 v_lshlrev_b32 v26, 16, v25
 v_and_b32 v25, 0xffff0000, v25
 v_add_f32 v167, v167, v26
 v_add_f32 v167, v167, v25
 s_waitcnt vmcnt(14)
 v_mov_b32 v168, 0
 v_lshlrev_b32 v25, 16, v112
 v_and_b32 v26, 0xffff0000, v112
 v_mul_f32 v25, v25, v8
 v_mul_f32 v26, v26, v16
 v_cvt_pk_bf16_f32 v25, v25, v26
 v_lshlrev_b32 v26, 16, v25
 v_and_b32 v25, 0xffff0000, v25
 v_add_f32 v168, v168, v26
 v_add_f32 v168, v168, v25
 v_lshlrev_b32 v25, 16, v113
 v_and_b32 v26, 0xffff0000, v113
 v_mul_f32 v25, v25, v9
 v_mul_f32 v26, v26, v17
 v_cvt_pk_bf16_f32 v25, v25, v26
 v_lshlrev_b32 v26, 16, v25
 v_and_b32 v25, 0xffff0000, v25
 v_add_f32 v168, v168, v26
 v_add_f32 v168, v168, v25
 v_lshlrev_b32 v25, 16, v114
 v_and_b32 v26, 0xffff0000, v114
 v_mul_f32 v25, v25, v10
 v_mul_f32 v26, v26, v18
 v_cvt_pk_bf16_f32 v25, v25, v26
 v_lshlrev_b32 v26, 16, v25
 v_and_b32 v25, 0xffff0000, v25
 v_add_f32 v168, v168, v26
 v_add_f32 v168, v168, v25
 v_lshlrev_b32 v25, 16, v115
 v_and_b32 v26, 0xffff0000, v115
 v_mul_f32 v25, v25, v11
 v_mul_f32 v26, v26, v19
 v_cvt_pk_bf16_f32 v25, v25, v26
 v_lshlrev_b32 v26, 16, v25
 v_and_b32 v25, 0xffff0000, v25
 v_add_f32 v168, v168, v26
 v_add_f32 v168, v168, v25
 v_lshlrev_b32 v25, 16, v116
 v_and_b32 v26, 0xffff0000, v116
 v_mul_f32 v25, v25, v12
 v_mul_f32 v26, v26, v20
 v_cvt_pk_bf16_f32 v25, v25, v26
 v_lshlrev_b32 v26, 16, v25
 v_and_b32 v25, 0xffff0000, v25
 v_add_f32 v168, v168, v26
 v_add_f32 v168, v168, v25
 s_waitcnt vmcnt(12)
 v_mov_b32 v169, 0
 v_lshlrev_b32 v25, 16, v118
 v_and_b32 v26, 0xffff0000, v118
 v_mul_f32 v25, v25, v8
 v_mul_f32 v26, v26, v16
 v_cvt_pk_bf16_f32 v25, v25, v26
 v_lshlrev_b32 v26, 16, v25
 v_and_b32 v25, 0xffff0000, v25
 v_add_f32 v169, v169, v26
 v_add_f32 v169, v169, v25
 v_lshlrev_b32 v25, 16, v119
 v_and_b32 v26, 0xffff0000, v119
 v_mul_f32 v25, v25, v9
 v_mul_f32 v26, v26, v17
 v_cvt_pk_bf16_f32 v25, v25, v26
 v_lshlrev_b32 v26, 16, v25
 v_and_b32 v25, 0xffff0000, v25
 v_add_f32 v169, v169, v26
 v_add_f32 v169, v169, v25
 v_lshlrev_b32 v25, 16, v120
 v_and_b32 v26, 0xffff0000, v120
 v_mul_f32 v25, v25, v10
 v_mul_f32 v26, v26, v18
 v_cvt_pk_bf16_f32 v25, v25, v26
 v_lshlrev_b32 v26, 16, v25
 v_and_b32 v25, 0xffff0000, v25
 v_add_f32 v169, v169, v26
 v_add_f32 v169, v169, v25
 v_lshlrev_b32 v25, 16, v121
 v_and_b32 v26, 0xffff0000, v121
 v_mul_f32 v25, v25, v11
 v_mul_f32 v26, v26, v19
 v_cvt_pk_bf16_f32 v25, v25, v26
 v_lshlrev_b32 v26, 16, v25
 v_and_b32 v25, 0xffff0000, v25
 v_add_f32 v169, v169, v26
 v_add_f32 v169, v169, v25
 v_lshlrev_b32 v25, 16, v122
 v_and_b32 v26, 0xffff0000, v122
 v_mul_f32 v25, v25, v12
 v_mul_f32 v26, v26, v20
 v_cvt_pk_bf16_f32 v25, v25, v26
 v_lshlrev_b32 v26, 16, v25
 v_and_b32 v25, 0xffff0000, v25
 v_add_f32 v169, v169, v26
 v_add_f32 v169, v169, v25
 s_waitcnt vmcnt(10)
 v_mov_b32 v170, 0
 v_lshlrev_b32 v25, 16, v124
 v_and_b32 v26, 0xffff0000, v124
 v_mul_f32 v25, v25, v8
 v_mul_f32 v26, v26, v16
 v_cvt_pk_bf16_f32 v25, v25, v26
 v_lshlrev_b32 v26, 16, v25
 v_and_b32 v25, 0xffff0000, v25
 v_add_f32 v170, v170, v26
 v_add_f32 v170, v170, v25
 v_lshlrev_b32 v25, 16, v125
 v_and_b32 v26, 0xffff0000, v125
 v_mul_f32 v25, v25, v9
 v_mul_f32 v26, v26, v17
 v_cvt_pk_bf16_f32 v25, v25, v26
 v_lshlrev_b32 v26, 16, v25
 v_and_b32 v25, 0xffff0000, v25
 v_add_f32 v170, v170, v26
 v_add_f32 v170, v170, v25
 v_lshlrev_b32 v25, 16, v126
 v_and_b32 v26, 0xffff0000, v126
 v_mul_f32 v25, v25, v10
 v_mul_f32 v26, v26, v18
 v_cvt_pk_bf16_f32 v25, v25, v26
 v_lshlrev_b32 v26, 16, v25
 v_and_b32 v25, 0xffff0000, v25
 v_add_f32 v170, v170, v26
 v_add_f32 v170, v170, v25
 v_lshlrev_b32 v25, 16, v127
 v_and_b32 v26, 0xffff0000, v127
 v_mul_f32 v25, v25, v11
 v_mul_f32 v26, v26, v19
 v_cvt_pk_bf16_f32 v25, v25, v26
 v_lshlrev_b32 v26, 16, v25
 v_and_b32 v25, 0xffff0000, v25
 v_add_f32 v170, v170, v26
 v_add_f32 v170, v170, v25
 v_lshlrev_b32 v25, 16, v128
 v_and_b32 v26, 0xffff0000, v128
 v_mul_f32 v25, v25, v12
 v_mul_f32 v26, v26, v20
 v_cvt_pk_bf16_f32 v25, v25, v26
 v_lshlrev_b32 v26, 16, v25
 v_and_b32 v25, 0xffff0000, v25
 v_add_f32 v170, v170, v26
 v_add_f32 v170, v170, v25
 s_waitcnt vmcnt(8)
 v_mov_b32 v171, 0
 v_lshlrev_b32 v25, 16, v130
 v_and_b32 v26, 0xffff0000, v130
 v_mul_f32 v25, v25, v8
 v_mul_f32 v26, v26, v16
 v_cvt_pk_bf16_f32 v25, v25, v26
 v_lshlrev_b32 v26, 16, v25
 v_and_b32 v25, 0xffff0000, v25
 v_add_f32 v171, v171, v26
 v_add_f32 v171, v171, v25
 v_lshlrev_b32 v25, 16, v131
 v_and_b32 v26, 0xffff0000, v131
 v_mul_f32 v25, v25, v9
 v_mul_f32 v26, v26, v17
 v_cvt_pk_bf16_f32 v25, v25, v26
 v_lshlrev_b32 v26, 16, v25
 v_and_b32 v25, 0xffff0000, v25
 v_add_f32 v171, v171, v26
 v_add_f32 v171, v171, v25
 v_lshlrev_b32 v25, 16, v132
 v_and_b32 v26, 0xffff0000, v132
 v_mul_f32 v25, v25, v10
 v_mul_f32 v26, v26, v18
 v_cvt_pk_bf16_f32 v25, v25, v26
 v_lshlrev_b32 v26, 16, v25
 v_and_b32 v25, 0xffff0000, v25
 v_add_f32 v171, v171, v26
 v_add_f32 v171, v171, v25
 v_lshlrev_b32 v25, 16, v133
 v_and_b32 v26, 0xffff0000, v133
 v_mul_f32 v25, v25, v11
 v_mul_f32 v26, v26, v19
 v_cvt_pk_bf16_f32 v25, v25, v26
 v_lshlrev_b32 v26, 16, v25
 v_and_b32 v25, 0xffff0000, v25
 v_add_f32 v171, v171, v26
 v_add_f32 v171, v171, v25
 v_lshlrev_b32 v25, 16, v134
 v_and_b32 v26, 0xffff0000, v134
 v_mul_f32 v25, v25, v12
 v_mul_f32 v26, v26, v20
 v_cvt_pk_bf16_f32 v25, v25, v26
 v_lshlrev_b32 v26, 16, v25
 v_and_b32 v25, 0xffff0000, v25
 v_add_f32 v171, v171, v26
 v_add_f32 v171, v171, v25
 s_waitcnt vmcnt(6)
 v_mov_b32 v172, 0
 v_lshlrev_b32 v25, 16, v136
 v_and_b32 v26, 0xffff0000, v136
 v_mul_f32 v25, v25, v8
 v_mul_f32 v26, v26, v16
 v_cvt_pk_bf16_f32 v25, v25, v26
 v_lshlrev_b32 v26, 16, v25
 v_and_b32 v25, 0xffff0000, v25
 v_add_f32 v172, v172, v26
 v_add_f32 v172, v172, v25
 v_lshlrev_b32 v25, 16, v137
 v_and_b32 v26, 0xffff0000, v137
 v_mul_f32 v25, v25, v9
 v_mul_f32 v26, v26, v17
 v_cvt_pk_bf16_f32 v25, v25, v26
 v_lshlrev_b32 v26, 16, v25
 v_and_b32 v25, 0xffff0000, v25
 v_add_f32 v172, v172, v26
 v_add_f32 v172, v172, v25
 v_lshlrev_b32 v25, 16, v138
 v_and_b32 v26, 0xffff0000, v138
 v_mul_f32 v25, v25, v10
 v_mul_f32 v26, v26, v18
 v_cvt_pk_bf16_f32 v25, v25, v26
 v_lshlrev_b32 v26, 16, v25
 v_and_b32 v25, 0xffff0000, v25
 v_add_f32 v172, v172, v26
 v_add_f32 v172, v172, v25
 v_lshlrev_b32 v25, 16, v139
 v_and_b32 v26, 0xffff0000, v139
 v_mul_f32 v25, v25, v11
 v_mul_f32 v26, v26, v19
 v_cvt_pk_bf16_f32 v25, v25, v26
 v_lshlrev_b32 v26, 16, v25
 v_and_b32 v25, 0xffff0000, v25
 v_add_f32 v172, v172, v26
 v_add_f32 v172, v172, v25
 v_lshlrev_b32 v25, 16, v140
 v_and_b32 v26, 0xffff0000, v140
 v_mul_f32 v25, v25, v12
 v_mul_f32 v26, v26, v20
 v_cvt_pk_bf16_f32 v25, v25, v26
 v_lshlrev_b32 v26, 16, v25
 v_and_b32 v25, 0xffff0000, v25
 v_add_f32 v172, v172, v26
 v_add_f32 v172, v172, v25
 s_waitcnt vmcnt(4)
 v_mov_b32 v173, 0
 v_lshlrev_b32 v25, 16, v142
 v_and_b32 v26, 0xffff0000, v142
 v_mul_f32 v25, v25, v8
 v_mul_f32 v26, v26, v16
 v_cvt_pk_bf16_f32 v25, v25, v26
 v_lshlrev_b32 v26, 16, v25
 v_and_b32 v25, 0xffff0000, v25
 v_add_f32 v173, v173, v26
 v_add_f32 v173, v173, v25
 v_lshlrev_b32 v25, 16, v143
 v_and_b32 v26, 0xffff0000, v143
 v_mul_f32 v25, v25, v9
 v_mul_f32 v26, v26, v17
 v_cvt_pk_bf16_f32 v25, v25, v26
 v_lshlrev_b32 v26, 16, v25
 v_and_b32 v25, 0xffff0000, v25
 v_add_f32 v173, v173, v26
 v_add_f32 v173, v173, v25
 v_lshlrev_b32 v25, 16, v144
 v_and_b32 v26, 0xffff0000, v144
 v_mul_f32 v25, v25, v10
 v_mul_f32 v26, v26, v18
 v_cvt_pk_bf16_f32 v25, v25, v26
 v_lshlrev_b32 v26, 16, v25
 v_and_b32 v25, 0xffff0000, v25
 v_add_f32 v173, v173, v26
 v_add_f32 v173, v173, v25
 v_lshlrev_b32 v25, 16, v145
 v_and_b32 v26, 0xffff0000, v145
 v_mul_f32 v25, v25, v11
 v_mul_f32 v26, v26, v19
 v_cvt_pk_bf16_f32 v25, v25, v26
 v_lshlrev_b32 v26, 16, v25
 v_and_b32 v25, 0xffff0000, v25
 v_add_f32 v173, v173, v26
 v_add_f32 v173, v173, v25
 v_lshlrev_b32 v25, 16, v146
 v_and_b32 v26, 0xffff0000, v146
 v_mul_f32 v25, v25, v12
 v_mul_f32 v26, v26, v20
 v_cvt_pk_bf16_f32 v25, v25, v26
 v_lshlrev_b32 v26, 16, v25
 v_and_b32 v25, 0xffff0000, v25
 v_add_f32 v173, v173, v26
 v_add_f32 v173, v173, v25
 s_waitcnt vmcnt(2)
 v_mov_b32 v174, 0
 v_lshlrev_b32 v25, 16, v148
 v_and_b32 v26, 0xffff0000, v148
 v_mul_f32 v25, v25, v8
 v_mul_f32 v26, v26, v16
 v_cvt_pk_bf16_f32 v25, v25, v26
 v_lshlrev_b32 v26, 16, v25
 v_and_b32 v25, 0xffff0000, v25
 v_add_f32 v174, v174, v26
 v_add_f32 v174, v174, v25
 v_lshlrev_b32 v25, 16, v149
 v_and_b32 v26, 0xffff0000, v149
 v_mul_f32 v25, v25, v9
 v_mul_f32 v26, v26, v17
 v_cvt_pk_bf16_f32 v25, v25, v26
 v_lshlrev_b32 v26, 16, v25
 v_and_b32 v25, 0xffff0000, v25
 v_add_f32 v174, v174, v26
 v_add_f32 v174, v174, v25
 v_lshlrev_b32 v25, 16, v150
 v_and_b32 v26, 0xffff0000, v150
 v_mul_f32 v25, v25, v10
 v_mul_f32 v26, v26, v18
 v_cvt_pk_bf16_f32 v25, v25, v26
 v_lshlrev_b32 v26, 16, v25
 v_and_b32 v25, 0xffff0000, v25
 v_add_f32 v174, v174, v26
 v_add_f32 v174, v174, v25
 v_lshlrev_b32 v25, 16, v151
 v_and_b32 v26, 0xffff0000, v151
 v_mul_f32 v25, v25, v11
 v_mul_f32 v26, v26, v19
 v_cvt_pk_bf16_f32 v25, v25, v26
 v_lshlrev_b32 v26, 16, v25
 v_and_b32 v25, 0xffff0000, v25
 v_add_f32 v174, v174, v26
 v_add_f32 v174, v174, v25
 v_lshlrev_b32 v25, 16, v152
 v_and_b32 v26, 0xffff0000, v152
 v_mul_f32 v25, v25, v12
 v_mul_f32 v26, v26, v20
 v_cvt_pk_bf16_f32 v25, v25, v26
 v_lshlrev_b32 v26, 16, v25
 v_and_b32 v25, 0xffff0000, v25
 v_add_f32 v174, v174, v26
 v_add_f32 v174, v174, v25
 s_waitcnt vmcnt(0)
 v_mov_b32 v175, 0
 v_lshlrev_b32 v25, 16, v154
 v_and_b32 v26, 0xffff0000, v154
 v_mul_f32 v25, v25, v8
 v_mul_f32 v26, v26, v16
 v_cvt_pk_bf16_f32 v25, v25, v26
 v_lshlrev_b32 v26, 16, v25
 v_and_b32 v25, 0xffff0000, v25
 v_add_f32 v175, v175, v26
 v_add_f32 v175, v175, v25
 v_lshlrev_b32 v25, 16, v155
 v_and_b32 v26, 0xffff0000, v155
 v_mul_f32 v25, v25, v9
 v_mul_f32 v26, v26, v17
 v_cvt_pk_bf16_f32 v25, v25, v26
 v_lshlrev_b32 v26, 16, v25
 v_and_b32 v25, 0xffff0000, v25
 v_add_f32 v175, v175, v26
 v_add_f32 v175, v175, v25
 v_lshlrev_b32 v25, 16, v156
 v_and_b32 v26, 0xffff0000, v156
 v_mul_f32 v25, v25, v10
 v_mul_f32 v26, v26, v18
 v_cvt_pk_bf16_f32 v25, v25, v26
 v_lshlrev_b32 v26, 16, v25
 v_and_b32 v25, 0xffff0000, v25
 v_add_f32 v175, v175, v26
 v_add_f32 v175, v175, v25
 v_lshlrev_b32 v25, 16, v157
 v_and_b32 v26, 0xffff0000, v157
 v_mul_f32 v25, v25, v11
 v_mul_f32 v26, v26, v19
 v_cvt_pk_bf16_f32 v25, v25, v26
 v_lshlrev_b32 v26, 16, v25
 v_and_b32 v25, 0xffff0000, v25
 v_add_f32 v175, v175, v26
 v_add_f32 v175, v175, v25
 v_lshlrev_b32 v25, 16, v158
 v_and_b32 v26, 0xffff0000, v158
 v_mul_f32 v25, v25, v12
 v_mul_f32 v26, v26, v20
 v_cvt_pk_bf16_f32 v25, v25, v26
 v_lshlrev_b32 v26, 16, v25
 v_and_b32 v25, 0xffff0000, v25
 v_add_f32 v175, v175, v26
 v_add_f32 v175, v175, v25
 v_add_f32_dpp v160, v160, v160 row_ror:8 row_mask:0xf bank_mask:0xf
 v_add_f32_dpp v161, v161, v161 row_ror:8 row_mask:0xf bank_mask:0xf
 v_add_f32_dpp v162, v162, v162 row_ror:8 row_mask:0xf bank_mask:0xf
 v_add_f32_dpp v163, v163, v163 row_ror:8 row_mask:0xf bank_mask:0xf
 v_add_f32_dpp v164, v164, v164 row_ror:8 row_mask:0xf bank_mask:0xf
 v_add_f32_dpp v165, v165, v165 row_ror:8 row_mask:0xf bank_mask:0xf
 v_add_f32_dpp v166, v166, v166 row_ror:8 row_mask:0xf bank_mask:0xf
 v_add_f32_dpp v167, v167, v167 row_ror:8 row_mask:0xf bank_mask:0xf
 v_add_f32_dpp v168, v168, v168 row_ror:8 row_mask:0xf bank_mask:0xf
 v_add_f32_dpp v169, v169, v169 row_ror:8 row_mask:0xf bank_mask:0xf
 v_add_f32_dpp v170, v170, v170 row_ror:8 row_mask:0xf bank_mask:0xf
 v_add_f32_dpp v171, v171, v171 row_ror:8 row_mask:0xf bank_mask:0xf
 v_add_f32_dpp v172, v172, v172 row_ror:8 row_mask:0xf bank_mask:0xf
 v_add_f32_dpp v173, v173, v173 row_ror:8 row_mask:0xf bank_mask:0xf
 v_add_f32_dpp v174, v174, v174 row_ror:8 row_mask:0xf bank_mask:0xf
 v_add_f32_dpp v175, v175, v175 row_ror:8 row_mask:0xf bank_mask:0xf
 v_add_f32_dpp v160, v160, v160 row_ror:4 row_mask:0xf bank_mask:0xf
 v_add_f32_dpp v161, v161, v161 row_ror:4 row_mask:0xf bank_mask:0xf
 v_add_f32_dpp v162, v162, v162 row_ror:4 row_mask:0xf bank_mask:0xf
 v_add_f32_dpp v163, v163, v163 row_ror:4 row_mask:0xf bank_mask:0xf
 v_add_f32_dpp v164, v164, v164 row_ror:4 row_mask:0xf bank_mask:0xf
 v_add_f32_dpp v165, v165, v165 row_ror:4 row_mask:0xf bank_mask:0xf
 v_add_f32_dpp v166, v166, v166 row_ror:4 row_mask:0xf bank_mask:0xf
 v_add_f32_dpp v167, v167, v167 row_ror:4 row_mask:0xf bank_mask:0xf
 v_add_f32_dpp v168, v168, v168 row_ror:4 row_mask:0xf bank_mask:0xf
 v_add_f32_dpp v169, v169, v169 row_ror:4 row_mask:0xf bank_mask:0xf
 v_add_f32_dpp v170, v170, v170 row_ror:4 row_mask:0xf bank_mask:0xf
 v_add_f32_dpp v171, v171, v171 row_ror:4 row_mask:0xf bank_mask:0xf
 v_add_f32_dpp v172, v172, v172 row_ror:4 row_mask:0xf bank_mask:0xf
 v_add_f32_dpp v173, v173, v173 row_ror:4 row_mask:0xf bank_mask:0xf
 v_add_f32_dpp v174, v174, v174 row_ror:4 row_mask:0xf bank_mask:0xf
 v_add_f32_dpp v175, v175, v175 row_ror:4 row_mask:0xf bank_mask:0xf
 v_add_f32_dpp v160, v160, v160 row_ror:2 row_mask:0xf bank_mask:0xf
 v_add_f32_dpp v161, v161, v161 row_ror:2 row_mask:0xf bank_mask:0xf
 v_add_f32_dpp v162, v162, v162 row_ror:2 row_mask:0xf bank_mask:0xf
 v_add_f32_dpp v163, v163, v163 row_ror:2 row_mask:0xf bank_mask:0xf
 v_add_f32_dpp v164, v164, v164 row_ror:2 row_mask:0xf bank_mask:0xf
 v_add_f32_dpp v165, v165, v165 row_ror:2 row_mask:0xf bank_mask:0xf
 v_add_f32_dpp v166, v166, v166 row_ror:2 row_mask:0xf bank_mask:0xf
 v_add_f32_dpp v167, v167, v167 row_ror:2 row_mask:0xf bank_mask:0xf
 v_add_f32_dpp v168, v168, v168 row_ror:2 row_mask:0xf bank_mask:0xf
 v_add_f32_dpp v169, v169, v169 row_ror:2 row_mask:0xf bank_mask:0xf
 v_add_f32_dpp v170, v170, v170 row_ror:2 row_mask:0xf bank_mask:0xf
 v_add_f32_dpp v171, v171, v171 row_ror:2 row_mask:0xf bank_mask:0xf
 v_add_f32_dpp v172, v172, v172 row_ror:2 row_mask:0xf bank_mask:0xf
 v_add_f32_dpp v173, v173, v173 row_ror:2 row_mask:0xf bank_mask:0xf
 v_add_f32_dpp v174, v174, v174 row_ror:2 row_mask:0xf bank_mask:0xf
 v_add_f32_dpp v175, v175, v175 row_ror:2 row_mask:0xf bank_mask:0xf
 v_add_f32_dpp v160, v160, v160 row_ror:1 row_mask:0xf bank_mask:0xf
 v_add_f32_dpp v161, v161, v161 row_ror:1 row_mask:0xf bank_mask:0xf
 v_add_f32_dpp v162, v162, v162 row_ror:1 row_mask:0xf bank_mask:0xf
 v_add_f32_dpp v163, v163, v163 row_ror:1 row_mask:0xf bank_mask:0xf
 v_add_f32_dpp v164, v164, v164 row_ror:1 row_mask:0xf bank_mask:0xf
 v_add_f32_dpp v165, v165, v165 row_ror:1 row_mask:0xf bank_mask:0xf
 v_add_f32_dpp v166, v166, v166 row_ror:1 row_mask:0xf bank_mask:0xf
 v_add_f32_dpp v167, v167, v167 row_ror:1 row_mask:0xf bank_mask:0xf
 v_add_f32_dpp v168, v168, v168 row_ror:1 row_mask:0xf bank_mask:0xf
 v_add_f32_dpp v169, v169, v169 row_ror:1 row_mask:0xf bank_mask:0xf
 v_add_f32_dpp v170, v170, v170 row_ror:1 row_mask:0xf bank_mask:0xf
 v_add_f32_dpp v171, v171, v171 row_ror:1 row_mask:0xf bank_mask:0xf
 v_add_f32_dpp v172, v172, v172 row_ror:1 row_mask:0xf bank_mask:0xf
 v_add_f32_dpp v173, v173, v173 row_ror:1 row_mask:0xf bank_mask:0xf
 v_add_f32_dpp v174, v174, v174 row_ror:1 row_mask:0xf bank_mask:0xf
 v_add_f32_dpp v175, v175, v175 row_ror:1 row_mask:0xf bank_mask:0xf
 v_mov_b32 v192, v160
 v_mov_b32 v193, v161
 v_mov_b32 v194, v162
 v_mov_b32 v195, v163
 v_mov_b32 v196, v164
 v_mov_b32 v197, v165
 v_mov_b32 v198, v166
 v_mov_b32 v199, v167
 v_mov_b32 v200, v168
 v_mov_b32 v201, v169
 v_mov_b32 v202, v170
 v_mov_b32 v203, v171
 v_mov_b32 v204, v172
 v_mov_b32 v205, v173
 v_mov_b32 v206, v174
 v_mov_b32 v207, v175
 v_permlane32_swap_b32 v160, v192
 v_permlane32_swap_b32 v161, v193
 v_permlane32_swap_b32 v162, v194
 v_permlane32_swap_b32 v163, v195
 v_permlane32_swap_b32 v164, v196
 v_permlane32_swap_b32 v165, v197
 v_permlane32_swap_b32 v166, v198
 v_permlane32_swap_b32 v167, v199
 v_permlane32_swap_b32 v168, v200
 v_permlane32_swap_b32 v169, v201
 v_permlane32_swap_b32 v170, v202
 v_permlane32_swap_b32 v171, v203
 v_permlane32_swap_b32 v172, v204
 v_permlane32_swap_b32 v173, v205
 v_permlane32_swap_b32 v174, v206
 v_permlane32_swap_b32 v175, v207
 v_add_f32 v160, v160, v192
 v_add_f32 v161, v161, v193
 v_add_f32 v162, v162, v194
 v_add_f32 v163, v163, v195
 v_add_f32 v164, v164, v196
 v_add_f32 v165, v165, v197
 v_add_f32 v166, v166, v198
 v_add_f32 v167, v167, v199
 v_add_f32 v168, v168, v200
 v_add_f32 v169, v169, v201
 v_add_f32 v170, v170, v202
 v_add_f32 v171, v171, v203
 v_add_f32 v172, v172, v204
 v_add_f32 v173, v173, v205
 v_add_f32 v174, v174, v206
 v_add_f32 v175, v175, v207
 v_mov_b32 v192, v160
 v_mov_b32 v193, v161
 v_mov_b32 v194, v162
 v_mov_b32 v195, v163
 v_mov_b32 v196, v164
 v_mov_b32 v197, v165
 v_mov_b32 v198, v166
 v_mov_b32 v199, v167
 v_mov_b32 v200, v168
 v_mov_b32 v201, v169
 v_mov_b32 v202, v170
 v_mov_b32 v203, v171
 v_mov_b32 v204, v172
 v_mov_b32 v205, v173
 v_mov_b32 v206, v174
 v_mov_b32 v207, v175
 v_permlane16_swap_b32 v160, v192
 v_permlane16_swap_b32 v161, v193
 v_permlane16_swap_b32 v162, v194
 v_permlane16_swap_b32 v163, v195
 v_permlane16_swap_b32 v164, v196
 v_permlane16_swap_b32 v165, v197
 v_permlane16_swap_b32 v166, v198
 v_permlane16_swap_b32 v167, v199
 v_permlane16_swap_b32 v168, v200
 v_permlane16_swap_b32 v169, v201
 v_permlane16_swap_b32 v170, v202
 v_permlane16_swap_b32 v171, v203
 v_permlane16_swap_b32 v172, v204
 v_permlane16_swap_b32 v173, v205
 v_permlane16_swap_b32 v174, v206
 v_permlane16_swap_b32 v175, v207
 v_add_f32 v160, v160, v192
 v_add_f32 v161, v161, v193
 v_add_f32 v162, v162, v194
 v_add_f32 v163, v163, v195
 v_add_f32 v164, v164, v196
 v_add_f32 v165, v165, v197
 v_add_f32 v166, v166, v198
 v_add_f32 v167, v167, v199
 v_add_f32 v168, v168, v200
 v_add_f32 v169, v169, v201
 v_add_f32 v170, v170, v202
 v_add_f32 v171, v171, v203
 v_add_f32 v172, v172, v204
 v_add_f32 v173, v173, v205
 v_add_f32 v174, v174, v206
 v_add_f32 v175, v175, v207
 v_mov_b32 v24, v160
 v_cmp_eq_u32 vcc, 1, v1
 s_nop 1
 v_cndmask_b32 v24, v24, v161, vcc
 v_cmp_eq_u32 vcc, 2, v1
 s_nop 1
 v_cndmask_b32 v24, v24, v162, vcc
 v_cmp_eq_u32 vcc, 3, v1
 s_nop 1
 v_cndmask_b32 v24, v24, v163, vcc
 v_cmp_eq_u32 vcc, 4, v1
 s_nop 1
 v_cndmask_b32 v24, v24, v164, vcc
 v_cmp_eq_u32 vcc, 5, v1
 s_nop 1
 v_cndmask_b32 v24, v24, v165, vcc
 v_cmp_eq_u32 vcc, 6, v1
 s_nop 1
 v_cndmask_b32 v24, v24, v166, vcc
 v_cmp_eq_u32 vcc, 7, v1
 s_nop 1
 v_cndmask_b32 v24, v24, v167, vcc
 v_cmp_eq_u32 vcc, 8, v1
 s_nop 1
 v_cndmask_b32 v24, v24, v168, vcc
 v_cmp_eq_u32 vcc, 9, v1
 s_nop 1
 v_cndmask_b32 v24, v24, v169, vcc
 v_cmp_eq_u32 vcc, 10, v1
 s_nop 1
 v_cndmask_b32 v24, v24, v170, vcc
 v_cmp_eq_u32 vcc, 11, v1
 s_nop 1
 v_cndmask_b32 v24, v24, v171, vcc
 v_cmp_eq_u32 vcc, 12, v1
 s_nop 1
 v_cndmask_b32 v24, v24, v172, vcc
 v_cmp_eq_u32 vcc, 13, v1
 s_nop 1
 v_cndmask_b32 v24, v24, v173, vcc
 v_cmp_eq_u32 vcc, 14, v1
 s_nop 1
 v_cndmask_b32 v24, v24, v174, vcc
 v_cmp_eq_u32 vcc, 15, v1
 s_nop 1
 v_cndmask_b32 v24, v24, v175, vcc
 v_cvt_pk_bf16_f32 v25, v24, v24
 v_lshlrev_b32 v24, 16, v25
 v_mul_f32 v24, 0xbfb8aa3b, v24
 v_exp_f32 v24, v24
 s_nop 0
 v_add_f32 v24, 1.0, v24
 v_rcp_f32 v24, v24
 s_nop 0
 v_cvt_pk_bf16_f32 v25, v24, v24
 v_lshlrev_b32 v24, 16, v25
 s_lshl_b32 s21, s59, 2
 s_mov_b64 exec, 65535
 buffer_store_dword v24, v4, s[28:31], s21 offen sc1
 s_mov_b64 exec, -1
 s_waitcnt vmcnt(0)
 s_barrier
 s_mov_b32 s21, 76
 s_cmp_lg_u32 s20, 0
 s_cbranch_scc1 af_139
 v_mov_b32 v10, 0
 v_mov_b32 v11, 1
 s_mov_b64 exec, 1
 buffer_atomic_add v11, v10, s[32:35], s21 offen sc1
 s_mov_b64 exec, -1
 s_nop 1
af_139:
 s_load_dwordx2 s[6:7], s[0:1], 40
 s_load_dwordx2 s[38:39], s[0:1], 104
 s_waitcnt lgkmcnt(0)
 s_mov_b32 s12, s6
 s_mov_b32 s13, s7
 s_mov_b32 s14, 7864320
 s_mov_b32 s15, 0x00020000
 s_mov_b32 s16, s38
 s_mov_b32 s17, s39
 s_mov_b32 s18, 50331648
 s_mov_b32 s19, 0x00020000
 s_add_u32 s24, s38, 88080384
 s_addc_u32 s25, s39, 0
 s_mov_b32 s26, 83886080
 s_mov_b32 s27, 0x00020000
 s_load_dwordx2 s[72:73], s[0:1], 104
 s_waitcnt lgkmcnt(0)
 s_add_u32 s72, s72, 81068032
 s_addc_u32 s73, s73, 0
 s_mov_b32 s74, 129024
 s_mov_b32 s75, 0x00020000
 v_mov_b32 v29, 52429
 s_mul_i32 s21, s20, 960
 s_add_u32 s21, s21, 0
 v_add_u32 v21, s21, v1
 v_mul_u32_u24 v22, v21, v29
 v_lshrrev_b32 v22, 22, v22
 v_mul_u32_u24 v23, 80, v22
 v_sub_u32 v21, v21, v23
 v_bfe_u32 v23, v22, 3, 1
 v_and_b32 v24, 3, v22
 v_lshl_add_u32 v23, v23, 2, v24
 v_lshlrev_b32 v23, 1, v23
 v_xor_b32 v21, v21, v23
 v_cmp_gt_u32 vcc, 32, v22
 v_bfe_u32 v26, v22, 3, 2
 v_lshl_add_u32 v25, v26, 2, v24
 v_bfe_u32 v26, v22, 2, 1
 v_lshl_add_u32 v25, v26, 4, v25
 v_cndmask_b32 v25, v22, v25, vcc
 v_mul_u32_u24 v25, 1280, v25
 v_lshl_add_u32 v64, v21, 4, v25
 s_mul_i32 s21, s20, 960
 s_add_u32 s21, s21, 64
 v_add_u32 v21, s21, v1
 v_mul_u32_u24 v22, v21, v29
 v_lshrrev_b32 v22, 22, v22
 v_mul_u32_u24 v23, 80, v22
 v_sub_u32 v21, v21, v23
 v_bfe_u32 v23, v22, 3, 1
 v_and_b32 v24, 3, v22
 v_lshl_add_u32 v23, v23, 2, v24
 v_lshlrev_b32 v23, 1, v23
 v_xor_b32 v21, v21, v23
 v_cmp_gt_u32 vcc, 32, v22
 v_bfe_u32 v26, v22, 3, 2
 v_lshl_add_u32 v25, v26, 2, v24
 v_bfe_u32 v26, v22, 2, 1
 v_lshl_add_u32 v25, v26, 4, v25
 v_cndmask_b32 v25, v22, v25, vcc
 v_mul_u32_u24 v25, 1280, v25
 v_lshl_add_u32 v65, v21, 4, v25
 s_mul_i32 s21, s20, 960
 s_add_u32 s21, s21, 128
 v_add_u32 v21, s21, v1
 v_mul_u32_u24 v22, v21, v29
 v_lshrrev_b32 v22, 22, v22
 v_mul_u32_u24 v23, 80, v22
 v_sub_u32 v21, v21, v23
 v_bfe_u32 v23, v22, 3, 1
 v_and_b32 v24, 3, v22
 v_lshl_add_u32 v23, v23, 2, v24
 v_lshlrev_b32 v23, 1, v23
 v_xor_b32 v21, v21, v23
 v_cmp_gt_u32 vcc, 32, v22
 v_bfe_u32 v26, v22, 3, 2
 v_lshl_add_u32 v25, v26, 2, v24
 v_bfe_u32 v26, v22, 2, 1
 v_lshl_add_u32 v25, v26, 4, v25
 v_cndmask_b32 v25, v22, v25, vcc
 v_mul_u32_u24 v25, 1280, v25
 v_lshl_add_u32 v66, v21, 4, v25
 s_mul_i32 s21, s20, 960
 s_add_u32 s21, s21, 192
 v_add_u32 v21, s21, v1
 v_mul_u32_u24 v22, v21, v29
 v_lshrrev_b32 v22, 22, v22
 v_mul_u32_u24 v23, 80, v22
 v_sub_u32 v21, v21, v23
 v_bfe_u32 v23, v22, 3, 1
 v_and_b32 v24, 3, v22
 v_lshl_add_u32 v23, v23, 2, v24
 v_lshlrev_b32 v23, 1, v23
 v_xor_b32 v21, v21, v23
 v_cmp_gt_u32 vcc, 32, v22
 v_bfe_u32 v26, v22, 3, 2
 v_lshl_add_u32 v25, v26, 2, v24
 v_bfe_u32 v26, v22, 2, 1
 v_lshl_add_u32 v25, v26, 4, v25
 v_cndmask_b32 v25, v22, v25, vcc
 v_mul_u32_u24 v25, 1280, v25
 v_lshl_add_u32 v67, v21, 4, v25
 s_mul_i32 s21, s20, 960
 s_add_u32 s21, s21, 256
 v_add_u32 v21, s21, v1
 v_mul_u32_u24 v22, v21, v29
 v_lshrrev_b32 v22, 22, v22
 v_mul_u32_u24 v23, 80, v22
 v_sub_u32 v21, v21, v23
 v_bfe_u32 v23, v22, 3, 1
 v_and_b32 v24, 3, v22
 v_lshl_add_u32 v23, v23, 2, v24
 v_lshlrev_b32 v23, 1, v23
 v_xor_b32 v21, v21, v23
 v_cmp_gt_u32 vcc, 32, v22
 v_bfe_u32 v26, v22, 3, 2
 v_lshl_add_u32 v25, v26, 2, v24
 v_bfe_u32 v26, v22, 2, 1
 v_lshl_add_u32 v25, v26, 4, v25
 v_cndmask_b32 v25, v22, v25, vcc
 v_mul_u32_u24 v25, 1280, v25
 v_lshl_add_u32 v68, v21, 4, v25
 s_mul_i32 s21, s20, 960
 s_add_u32 s21, s21, 320
 v_add_u32 v21, s21, v1
 v_mul_u32_u24 v22, v21, v29
 v_lshrrev_b32 v22, 22, v22
 v_mul_u32_u24 v23, 80, v22
 v_sub_u32 v21, v21, v23
 v_bfe_u32 v23, v22, 3, 1
 v_and_b32 v24, 3, v22
 v_lshl_add_u32 v23, v23, 2, v24
 v_lshlrev_b32 v23, 1, v23
 v_xor_b32 v21, v21, v23
 v_cmp_gt_u32 vcc, 32, v22
 v_bfe_u32 v26, v22, 3, 2
 v_lshl_add_u32 v25, v26, 2, v24
 v_bfe_u32 v26, v22, 2, 1
 v_lshl_add_u32 v25, v26, 4, v25
 v_cndmask_b32 v25, v22, v25, vcc
 v_mul_u32_u24 v25, 1280, v25
 v_lshl_add_u32 v69, v21, 4, v25
 s_mul_i32 s21, s20, 960
 s_add_u32 s21, s21, 384
 v_add_u32 v21, s21, v1
 v_mul_u32_u24 v22, v21, v29
 v_lshrrev_b32 v22, 22, v22
 v_mul_u32_u24 v23, 80, v22
 v_sub_u32 v21, v21, v23
 v_bfe_u32 v23, v22, 3, 1
 v_and_b32 v24, 3, v22
 v_lshl_add_u32 v23, v23, 2, v24
 v_lshlrev_b32 v23, 1, v23
 v_xor_b32 v21, v21, v23
 v_cmp_gt_u32 vcc, 32, v22
 v_bfe_u32 v26, v22, 3, 2
 v_lshl_add_u32 v25, v26, 2, v24
 v_bfe_u32 v26, v22, 2, 1
 v_lshl_add_u32 v25, v26, 4, v25
 v_cndmask_b32 v25, v22, v25, vcc
 v_mul_u32_u24 v25, 1280, v25
 v_lshl_add_u32 v70, v21, 4, v25
 s_mul_i32 s21, s20, 960
 s_add_u32 s21, s21, 448
 v_add_u32 v21, s21, v1
 v_mul_u32_u24 v22, v21, v29
 v_lshrrev_b32 v22, 22, v22
 v_mul_u32_u24 v23, 80, v22
 v_sub_u32 v21, v21, v23
 v_bfe_u32 v23, v22, 3, 1
 v_and_b32 v24, 3, v22
 v_lshl_add_u32 v23, v23, 2, v24
 v_lshlrev_b32 v23, 1, v23
 v_xor_b32 v21, v21, v23
 v_cmp_gt_u32 vcc, 32, v22
 v_bfe_u32 v26, v22, 3, 2
 v_lshl_add_u32 v25, v26, 2, v24
 v_bfe_u32 v26, v22, 2, 1
 v_lshl_add_u32 v25, v26, 4, v25
 v_cndmask_b32 v25, v22, v25, vcc
 v_mul_u32_u24 v25, 1280, v25
 v_lshl_add_u32 v71, v21, 4, v25
 s_mul_i32 s21, s20, 960
 s_add_u32 s21, s21, 512
 v_add_u32 v21, s21, v1
 v_mul_u32_u24 v22, v21, v29
 v_lshrrev_b32 v22, 22, v22
 v_mul_u32_u24 v23, 80, v22
 v_sub_u32 v21, v21, v23
 v_bfe_u32 v23, v22, 3, 1
 v_and_b32 v24, 3, v22
 v_lshl_add_u32 v23, v23, 2, v24
 v_lshlrev_b32 v23, 1, v23
 v_xor_b32 v21, v21, v23
 v_cmp_gt_u32 vcc, 32, v22
 v_bfe_u32 v26, v22, 3, 2
 v_lshl_add_u32 v25, v26, 2, v24
 v_bfe_u32 v26, v22, 2, 1
 v_lshl_add_u32 v25, v26, 4, v25
 v_cndmask_b32 v25, v22, v25, vcc
 v_mul_u32_u24 v25, 1280, v25
 v_lshl_add_u32 v72, v21, 4, v25
 s_mul_i32 s21, s20, 960
 s_add_u32 s21, s21, 576
 v_add_u32 v21, s21, v1
 v_mul_u32_u24 v22, v21, v29
 v_lshrrev_b32 v22, 22, v22
 v_mul_u32_u24 v23, 80, v22
 v_sub_u32 v21, v21, v23
 v_bfe_u32 v23, v22, 3, 1
 v_and_b32 v24, 3, v22
 v_lshl_add_u32 v23, v23, 2, v24
 v_lshlrev_b32 v23, 1, v23
 v_xor_b32 v21, v21, v23
 v_cmp_gt_u32 vcc, 32, v22
 v_bfe_u32 v26, v22, 3, 2
 v_lshl_add_u32 v25, v26, 2, v24
 v_bfe_u32 v26, v22, 2, 1
 v_lshl_add_u32 v25, v26, 4, v25
 v_cndmask_b32 v25, v22, v25, vcc
 v_mul_u32_u24 v25, 1280, v25
 v_lshl_add_u32 v73, v21, 4, v25
 s_mul_i32 s21, s20, 960
 s_add_u32 s21, s21, 640
 v_add_u32 v21, s21, v1
 v_mul_u32_u24 v22, v21, v29
 v_lshrrev_b32 v22, 22, v22
 v_mul_u32_u24 v23, 80, v22
 v_sub_u32 v21, v21, v23
 v_bfe_u32 v23, v22, 3, 1
 v_and_b32 v24, 3, v22
 v_lshl_add_u32 v23, v23, 2, v24
 v_lshlrev_b32 v23, 1, v23
 v_xor_b32 v21, v21, v23
 v_cmp_gt_u32 vcc, 32, v22
 v_bfe_u32 v26, v22, 3, 2
 v_lshl_add_u32 v25, v26, 2, v24
 v_bfe_u32 v26, v22, 2, 1
 v_lshl_add_u32 v25, v26, 4, v25
 v_cndmask_b32 v25, v22, v25, vcc
 v_mul_u32_u24 v25, 1280, v25
 v_lshl_add_u32 v74, v21, 4, v25
 s_mul_i32 s21, s20, 960
 s_add_u32 s21, s21, 704
 v_add_u32 v21, s21, v1
 v_mul_u32_u24 v22, v21, v29
 v_lshrrev_b32 v22, 22, v22
 v_mul_u32_u24 v23, 80, v22
 v_sub_u32 v21, v21, v23
 v_bfe_u32 v23, v22, 3, 1
 v_and_b32 v24, 3, v22
 v_lshl_add_u32 v23, v23, 2, v24
 v_lshlrev_b32 v23, 1, v23
 v_xor_b32 v21, v21, v23
 v_cmp_gt_u32 vcc, 32, v22
 v_bfe_u32 v26, v22, 3, 2
 v_lshl_add_u32 v25, v26, 2, v24
 v_bfe_u32 v26, v22, 2, 1
 v_lshl_add_u32 v25, v26, 4, v25
 v_cndmask_b32 v25, v22, v25, vcc
 v_mul_u32_u24 v25, 1280, v25
 v_lshl_add_u32 v75, v21, 4, v25
 s_mul_i32 s21, s20, 960
 s_add_u32 s21, s21, 768
 v_add_u32 v21, s21, v1
 v_mul_u32_u24 v22, v21, v29
 v_lshrrev_b32 v22, 22, v22
 v_mul_u32_u24 v23, 80, v22
 v_sub_u32 v21, v21, v23
 v_bfe_u32 v23, v22, 3, 1
 v_and_b32 v24, 3, v22
 v_lshl_add_u32 v23, v23, 2, v24
 v_lshlrev_b32 v23, 1, v23
 v_xor_b32 v21, v21, v23
 v_cmp_gt_u32 vcc, 32, v22
 v_bfe_u32 v26, v22, 3, 2
 v_lshl_add_u32 v25, v26, 2, v24
 v_bfe_u32 v26, v22, 2, 1
 v_lshl_add_u32 v25, v26, 4, v25
 v_cndmask_b32 v25, v22, v25, vcc
 v_mul_u32_u24 v25, 1280, v25
 v_lshl_add_u32 v76, v21, 4, v25
 s_mul_i32 s21, s20, 960
 s_add_u32 s21, s21, 832
 v_add_u32 v21, s21, v1
 v_mul_u32_u24 v22, v21, v29
 v_lshrrev_b32 v22, 22, v22
 v_mul_u32_u24 v23, 80, v22
 v_sub_u32 v21, v21, v23
 v_bfe_u32 v23, v22, 3, 1
 v_and_b32 v24, 3, v22
 v_lshl_add_u32 v23, v23, 2, v24
 v_lshlrev_b32 v23, 1, v23
 v_xor_b32 v21, v21, v23
 v_cmp_gt_u32 vcc, 32, v22
 v_bfe_u32 v26, v22, 3, 2
 v_lshl_add_u32 v25, v26, 2, v24
 v_bfe_u32 v26, v22, 2, 1
 v_lshl_add_u32 v25, v26, 4, v25
 v_cndmask_b32 v25, v22, v25, vcc
 v_mul_u32_u24 v25, 1280, v25
 v_lshl_add_u32 v77, v21, 4, v25
 s_mul_i32 s21, s20, 960
 s_add_u32 s21, s21, 896
 v_add_u32 v21, s21, v1
 v_mul_u32_u24 v22, v21, v29
 v_lshrrev_b32 v22, 22, v22
 v_mul_u32_u24 v23, 80, v22
 v_sub_u32 v21, v21, v23
 v_bfe_u32 v23, v22, 3, 1
 v_and_b32 v24, 3, v22
 v_lshl_add_u32 v23, v23, 2, v24
 v_lshlrev_b32 v23, 1, v23
 v_xor_b32 v21, v21, v23
 v_cmp_gt_u32 vcc, 32, v22
 v_bfe_u32 v26, v22, 3, 2
 v_lshl_add_u32 v25, v26, 2, v24
 v_bfe_u32 v26, v22, 2, 1
 v_lshl_add_u32 v25, v26, 4, v25
 v_cndmask_b32 v25, v22, v25, vcc
 v_mul_u32_u24 v25, 1280, v25
 v_lshl_add_u32 v78, v21, 4, v25
 s_mul_i32 s40, s2, 245760
 s_add_u32 s21, s40, 0
 s_mul_i32 s22, s20, 15360
 s_add_u32 s22, s22, 0
 s_add_u32 m0, s22, 0
 s_nop 0
 buffer_load_dwordx4 v64, s[12:15], s21 offen lds
 s_add_u32 m0, s22, 1024
 s_nop 0
 buffer_load_dwordx4 v65, s[12:15], s21 offen lds
 s_add_u32 m0, s22, 2048
 s_nop 0
 buffer_load_dwordx4 v66, s[12:15], s21 offen lds
 s_add_u32 m0, s22, 3072
 s_nop 0
 buffer_load_dwordx4 v67, s[12:15], s21 offen lds
 s_add_u32 m0, s22, 4096
 s_nop 0
 buffer_load_dwordx4 v68, s[12:15], s21 offen lds
 s_add_u32 m0, s22, 5120
 s_nop 0
 buffer_load_dwordx4 v69, s[12:15], s21 offen lds
 s_add_u32 m0, s22, 6144
 s_nop 0
 buffer_load_dwordx4 v70, s[12:15], s21 offen lds
 s_add_u32 m0, s22, 7168
 s_nop 0
 buffer_load_dwordx4 v71, s[12:15], s21 offen lds
 s_add_u32 m0, s22, 8192
 s_nop 0
 buffer_load_dwordx4 v72, s[12:15], s21 offen lds
 s_add_u32 m0, s22, 9216
 s_nop 0
 buffer_load_dwordx4 v73, s[12:15], s21 offen lds
 s_add_u32 m0, s22, 10240
 s_nop 0
 buffer_load_dwordx4 v74, s[12:15], s21 offen lds
 s_add_u32 m0, s22, 11264
 s_nop 0
 buffer_load_dwordx4 v75, s[12:15], s21 offen lds
 s_add_u32 m0, s22, 12288
 s_nop 0
 buffer_load_dwordx4 v76, s[12:15], s21 offen lds
 s_add_u32 m0, s22, 13312
 s_nop 0
 buffer_load_dwordx4 v77, s[12:15], s21 offen lds
 s_add_u32 m0, s22, 14336
 s_nop 0
 buffer_load_dwordx4 v78, s[12:15], s21 offen lds
 s_add_u32 s21, s40, 61440
 s_mul_i32 s22, s20, 15360
 s_add_u32 s22, s22, 61440
 s_add_u32 m0, s22, 0
 s_nop 0
 buffer_load_dwordx4 v64, s[12:15], s21 offen lds
 s_add_u32 m0, s22, 1024
 s_nop 0
 buffer_load_dwordx4 v65, s[12:15], s21 offen lds
 s_add_u32 m0, s22, 2048
 s_nop 0
 buffer_load_dwordx4 v66, s[12:15], s21 offen lds
 s_add_u32 m0, s22, 3072
 s_nop 0
 buffer_load_dwordx4 v67, s[12:15], s21 offen lds
 s_add_u32 m0, s22, 4096
 s_nop 0
 buffer_load_dwordx4 v68, s[12:15], s21 offen lds
 s_add_u32 m0, s22, 5120
 s_nop 0
 buffer_load_dwordx4 v69, s[12:15], s21 offen lds
 s_add_u32 m0, s22, 6144
 s_nop 0
 buffer_load_dwordx4 v70, s[12:15], s21 offen lds
 s_add_u32 m0, s22, 7168
 s_nop 0
 buffer_load_dwordx4 v71, s[12:15], s21 offen lds
 s_add_u32 m0, s22, 8192
 s_nop 0
 buffer_load_dwordx4 v72, s[12:15], s21 offen lds
 s_add_u32 m0, s22, 9216
 s_nop 0
 buffer_load_dwordx4 v73, s[12:15], s21 offen lds
 s_add_u32 m0, s22, 10240
 s_nop 0
 buffer_load_dwordx4 v74, s[12:15], s21 offen lds
 s_add_u32 m0, s22, 11264
 s_nop 0
 buffer_load_dwordx4 v75, s[12:15], s21 offen lds
 s_add_u32 m0, s22, 12288
 s_nop 0
 buffer_load_dwordx4 v76, s[12:15], s21 offen lds
 s_add_u32 m0, s22, 13312
 s_nop 0
 buffer_load_dwordx4 v77, s[12:15], s21 offen lds
 s_add_u32 m0, s22, 14336
 s_nop 0
 buffer_load_dwordx4 v78, s[12:15], s21 offen lds
 s_add_u32 s21, s40, 122880
 s_mul_i32 s22, s20, 15360
 s_add_u32 s22, s22, 0
 buffer_load_dwordx4 v[80:83], v64, s[12:15], s21 offen
 buffer_load_dwordx4 v[84:87], v65, s[12:15], s21 offen
 buffer_load_dwordx4 v[88:91], v66, s[12:15], s21 offen
 buffer_load_dwordx4 v[92:95], v67, s[12:15], s21 offen
 buffer_load_dwordx4 v[96:99], v68, s[12:15], s21 offen
 buffer_load_dwordx4 v[100:103], v69, s[12:15], s21 offen
 buffer_load_dwordx4 v[104:107], v70, s[12:15], s21 offen
 buffer_load_dwordx4 v[108:111], v71, s[12:15], s21 offen
 buffer_load_dwordx4 v[112:115], v72, s[12:15], s21 offen
 buffer_load_dwordx4 v[116:119], v73, s[12:15], s21 offen
 buffer_load_dwordx4 v[120:123], v74, s[12:15], s21 offen
 buffer_load_dwordx4 v[124:127], v75, s[12:15], s21 offen
 buffer_load_dwordx4 v[128:131], v76, s[12:15], s21 offen
 buffer_load_dwordx4 v[132:135], v77, s[12:15], s21 offen
 buffer_load_dwordx4 v[136:139], v78, s[12:15], s21 offen
 s_add_u32 s21, s40, 184320
 s_mul_i32 s22, s20, 15360
 s_add_u32 s22, s22, 61440
 buffer_load_dwordx4 v[140:143], v64, s[12:15], s21 offen
 buffer_load_dwordx4 v[144:147], v65, s[12:15], s21 offen
 buffer_load_dwordx4 v[148:151], v66, s[12:15], s21 offen
 buffer_load_dwordx4 v[152:155], v67, s[12:15], s21 offen
 buffer_load_dwordx4 v[156:159], v68, s[12:15], s21 offen
 buffer_load_dwordx4 v[160:163], v69, s[12:15], s21 offen
 buffer_load_dwordx4 v[164:167], v70, s[12:15], s21 offen
 buffer_load_dwordx4 v[168:171], v71, s[12:15], s21 offen
 buffer_load_dwordx4 v[172:175], v72, s[12:15], s21 offen
 buffer_load_dwordx4 v[176:179], v73, s[12:15], s21 offen
 buffer_load_dwordx4 v[180:183], v74, s[12:15], s21 offen
 buffer_load_dwordx4 v[184:187], v75, s[12:15], s21 offen
 buffer_load_dwordx4 v[188:191], v76, s[12:15], s21 offen
 buffer_load_dwordx4 v[192:195], v77, s[12:15], s21 offen
 buffer_load_dwordx4 v[196:199], v78, s[12:15], s21 offen
 v_lshrrev_b32 v6, 2, v2
 v_lshl_add_u32 v7, v3, 3, v6
 v_mul_u32_u24 v7, 1280, v7
 v_and_b32 v8, 1, v2
 v_lshl_add_u32 v7, v8, 3, v7
 v_and_b32 v8, 1, v3
 v_lshl_add_u32 v6, v8, 2, v6
 v_lshlrev_b32 v6, 1, v6
 v_bfe_u32 v8, v2, 1, 1
 s_mul_i32 s21, s20, 20
 v_add_u32 v8, s21, v8
 v_add_u32 v5, 0, v8
 v_xor_b32 v5, v5, v6
 v_lshl_add_u32 v200, v5, 4, v7
 v_add_u32 v210, 81920, v200
 v_add_u32 v5, 2, v8
 v_xor_b32 v5, v5, v6
 v_lshl_add_u32 v201, v5, 4, v7
 v_add_u32 v211, 81920, v201
 v_add_u32 v5, 4, v8
 v_xor_b32 v5, v5, v6
 v_lshl_add_u32 v202, v5, 4, v7
 v_add_u32 v212, 81920, v202
 v_add_u32 v5, 6, v8
 v_xor_b32 v5, v5, v6
 v_lshl_add_u32 v203, v5, 4, v7
 v_add_u32 v213, 81920, v203
 v_add_u32 v5, 8, v8
 v_xor_b32 v5, v5, v6
 v_lshl_add_u32 v204, v5, 4, v7
 v_add_u32 v214, 81920, v204
 v_add_u32 v5, 10, v8
 v_xor_b32 v5, v5, v6
 v_lshl_add_u32 v205, v5, 4, v7
 v_add_u32 v215, 81920, v205
 v_add_u32 v5, 12, v8
 v_xor_b32 v5, v5, v6
 v_lshl_add_u32 v206, v5, 4, v7
 v_add_u32 v216, 81920, v206
 v_add_u32 v5, 14, v8
 v_xor_b32 v5, v5, v6
 v_lshl_add_u32 v207, v5, 4, v7
 v_add_u32 v217, 81920, v207
 v_add_u32 v5, 16, v8
 v_xor_b32 v5, v5, v6
 v_lshl_add_u32 v208, v5, 4, v7
 v_add_u32 v218, 81920, v208
 v_add_u32 v5, 18, v8
 v_xor_b32 v5, v5, v6
 v_lshl_add_u32 v209, v5, 4, v7
 v_add_u32 v219, 81920, v209
 s_lshl_b32 s21, s2, 1
 s_lshr_b32 s22, s20, 1
 s_add_u32 s21, s21, s22
 s_lshl_b32 s21, s21, 20
 s_and_b32 s22, s20, 1
 s_mul_i32 s22, s22, 49152
 s_add_u32 s21, s21, s22
 s_add_u32 s21, s21, 7168
 s_add_u32 s21, s21, 181305344
 s_add_u32 s50, s38, s21
 s_addc_u32 s51, s39, 0
 s_mov_b32 s52, -1
 s_mov_b32 s53, -1
 s_mov_b32 s54, 0
cal_141:
 s_memtime s[98:99]
 s_waitcnt lgkmcnt(0)
 s_load_dword s55, s[50:51], 0
 s_waitcnt lgkmcnt(0)
 s_memtime s[100:101]
 s_waitcnt lgkmcnt(0)
 s_sub_u32 s21, s100, s98
 s_min_u32 s52, s52, s21
 s_memtime s[98:99]
 s_waitcnt lgkmcnt(0)
 s_load_dword s55, s[50:51], 8192
 s_waitcnt lgkmcnt(0)
 s_memtime s[100:101]
 s_waitcnt lgkmcnt(0)
 s_sub_u32 s21, s100, s98
 s_min_u32 s53, s53, s21
 s_add_u32 s50, s50, 16640
 s_addc_u32 s51, s51, 0
 s_add_u32 s54, s54, 1
 s_cmp_lt_u32 s54, 3
 s_cbranch_scc1 cal_141
 s_lshl_b32 s21, s20, 2
 s_add_u32 s21, s21, 160000
 v_mov_b32 v28, s21
 v_mov_b32 v24, s52
 v_mov_b32 v25, s53
 ds_write_b32 v28, v24
 ds_write_b32 v28, v25 offset:16
 s_waitcnt lgkmcnt(0)
cal_140:
 s_mul_i32 s22, s20, 15360
 v_lshl_add_u32 v30, v1, 4, s22
 v_add_u32 v31, 61440, v30
 s_waitcnt vmcnt(30)
 s_barrier
 s_cmp_lg_u32 s20, 3
 s_cbranch_scc1 cal_142
 v_mov_b32 v28, 160000
 ds_read_b128 v[20:23], v28
 ds_read_b128 v[24:27], v28 offset:16
 s_waitcnt lgkmcnt(0)
 v_min3_u32 v20, v20, v21, v22
 v_min3_u32 v24, v24, v25, v26
 v_min_u32 v25, v20, v23
 v_min_u32 v26, v24, v27
 v_cmp_lt_u32 vcc, v26, v25
 v_mov_b32 v28, s2
 s_nop 0
 v_cndmask_b32 v24, 1, 2, vcc
 s_mov_b64 exec, 1
 buffer_store_byte v24, v28, s[32:35], 0 offen offset:160 sc1
 s_mov_b64 exec, -1
cal_142:
 ds_read_b64_tr_b16 a[0:1], v200 offset:0
 ds_read_b64_tr_b16 a[2:3], v200 offset:5120
 ds_read_b64_tr_b16 a[24:25], v201 offset:0
 ds_read_b64_tr_b16 a[26:27], v201 offset:5120
 ds_read_b64_tr_b16 a[48:49], v202 offset:0
 ds_read_b64_tr_b16 a[50:51], v202 offset:5120
 ds_read_b64_tr_b16 a[72:73], v203 offset:0
 ds_read_b64_tr_b16 a[74:75], v203 offset:5120
 ds_read_b64_tr_b16 a[96:97], v204 offset:0
 ds_read_b64_tr_b16 a[98:99], v204 offset:5120
 ds_read_b64_tr_b16 a[120:121], v205 offset:0
 ds_read_b64_tr_b16 a[122:123], v205 offset:5120
 ds_read_b64_tr_b16 a[144:145], v206 offset:0
 ds_read_b64_tr_b16 a[146:147], v206 offset:5120
 ds_read_b64_tr_b16 a[168:169], v207 offset:0
 ds_read_b64_tr_b16 a[170:171], v207 offset:5120
 ds_read_b64_tr_b16 a[192:193], v208 offset:0
 ds_read_b64_tr_b16 a[194:195], v208 offset:5120
 ds_read_b64_tr_b16 a[216:217], v209 offset:0
 ds_read_b64_tr_b16 a[218:219], v209 offset:5120
 ds_read_b64_tr_b16 a[4:5], v200 offset:40960
 ds_read_b64_tr_b16 a[6:7], v200 offset:46080
 ds_read_b64_tr_b16 a[28:29], v201 offset:40960
 ds_read_b64_tr_b16 a[30:31], v201 offset:46080
 ds_read_b64_tr_b16 a[52:53], v202 offset:40960
 ds_read_b64_tr_b16 a[54:55], v202 offset:46080
 ds_read_b64_tr_b16 a[76:77], v203 offset:40960
 ds_read_b64_tr_b16 a[78:79], v203 offset:46080
 ds_read_b64_tr_b16 a[100:101], v204 offset:40960
 ds_read_b64_tr_b16 a[102:103], v204 offset:46080
 ds_read_b64_tr_b16 a[124:125], v205 offset:40960
 ds_read_b64_tr_b16 a[126:127], v205 offset:46080
 ds_read_b64_tr_b16 a[148:149], v206 offset:40960
 ds_read_b64_tr_b16 a[150:151], v206 offset:46080
 ds_read_b64_tr_b16 a[172:173], v207 offset:40960
 ds_read_b64_tr_b16 a[174:175], v207 offset:46080
 ds_read_b64_tr_b16 a[196:197], v208 offset:40960
 ds_read_b64_tr_b16 a[198:199], v208 offset:46080
 ds_read_b64_tr_b16 a[220:221], v209 offset:40960
 ds_read_b64_tr_b16 a[222:223], v209 offset:46080
 ds_read_b64_tr_b16 a[8:9], v210 offset:0
 ds_read_b64_tr_b16 a[10:11], v210 offset:5120
 ds_read_b64_tr_b16 a[32:33], v211 offset:0
 ds_read_b64_tr_b16 a[34:35], v211 offset:5120
 ds_read_b64_tr_b16 a[56:57], v212 offset:0
 ds_read_b64_tr_b16 a[58:59], v212 offset:5120
 ds_read_b64_tr_b16 a[80:81], v213 offset:0
 ds_read_b64_tr_b16 a[82:83], v213 offset:5120
 ds_read_b64_tr_b16 a[104:105], v214 offset:0
 ds_read_b64_tr_b16 a[106:107], v214 offset:5120
 ds_read_b64_tr_b16 a[128:129], v215 offset:0
 ds_read_b64_tr_b16 a[130:131], v215 offset:5120
 ds_read_b64_tr_b16 a[152:153], v216 offset:0
 ds_read_b64_tr_b16 a[154:155], v216 offset:5120
 ds_read_b64_tr_b16 a[176:177], v217 offset:0
 ds_read_b64_tr_b16 a[178:179], v217 offset:5120
 ds_read_b64_tr_b16 a[200:201], v218 offset:0
 ds_read_b64_tr_b16 a[202:203], v218 offset:5120
 ds_read_b64_tr_b16 a[224:225], v219 offset:0
 ds_read_b64_tr_b16 a[226:227], v219 offset:5120
 s_waitcnt lgkmcnt(0)
 s_barrier
 s_waitcnt vmcnt(15)
 ds_write_b128 v30, v[80:83] offset:0
 ds_write_b128 v30, v[84:87] offset:1024
 ds_write_b128 v30, v[88:91] offset:2048
 ds_write_b128 v30, v[92:95] offset:3072
 ds_write_b128 v30, v[96:99] offset:4096
 ds_write_b128 v30, v[100:103] offset:5120
 ds_write_b128 v30, v[104:107] offset:6144
 ds_write_b128 v30, v[108:111] offset:7168
 ds_write_b128 v30, v[112:115] offset:8192
 ds_write_b128 v30, v[116:119] offset:9216
 ds_write_b128 v30, v[120:123] offset:10240
 ds_write_b128 v30, v[124:127] offset:11264
 ds_write_b128 v30, v[128:131] offset:12288
 ds_write_b128 v30, v[132:135] offset:13312
 ds_write_b128 v30, v[136:139] offset:14336
 s_waitcnt vmcnt(0)
 ds_write_b128 v31, v[140:143] offset:0
 ds_write_b128 v31, v[144:147] offset:1024
 ds_write_b128 v31, v[148:151] offset:2048
 ds_write_b128 v31, v[152:155] offset:3072
 ds_write_b128 v31, v[156:159] offset:4096
 ds_write_b128 v31, v[160:163] offset:5120
 ds_write_b128 v31, v[164:167] offset:6144
 ds_write_b128 v31, v[168:171] offset:7168
 ds_write_b128 v31, v[172:175] offset:8192
 ds_write_b128 v31, v[176:179] offset:9216
 ds_write_b128 v31, v[180:183] offset:10240
 ds_write_b128 v31, v[184:187] offset:11264
 ds_write_b128 v31, v[188:191] offset:12288
 ds_write_b128 v31, v[192:195] offset:13312
 ds_write_b128 v31, v[196:199] offset:14336
 s_waitcnt lgkmcnt(0)
 s_barrier
 ds_read_b64_tr_b16 a[12:13], v200 offset:0
 ds_read_b64_tr_b16 a[14:15], v200 offset:5120
 ds_read_b64_tr_b16 a[36:37], v201 offset:0
 ds_read_b64_tr_b16 a[38:39], v201 offset:5120
 ds_read_b64_tr_b16 a[60:61], v202 offset:0
 ds_read_b64_tr_b16 a[62:63], v202 offset:5120
 ds_read_b64_tr_b16 a[84:85], v203 offset:0
 ds_read_b64_tr_b16 a[86:87], v203 offset:5120
 ds_read_b64_tr_b16 a[108:109], v204 offset:0
 ds_read_b64_tr_b16 a[110:111], v204 offset:5120
 ds_read_b64_tr_b16 a[132:133], v205 offset:0
 ds_read_b64_tr_b16 a[134:135], v205 offset:5120
 ds_read_b64_tr_b16 a[156:157], v206 offset:0
 ds_read_b64_tr_b16 a[158:159], v206 offset:5120
 ds_read_b64_tr_b16 a[180:181], v207 offset:0
 ds_read_b64_tr_b16 a[182:183], v207 offset:5120
 ds_read_b64_tr_b16 a[204:205], v208 offset:0
 ds_read_b64_tr_b16 a[206:207], v208 offset:5120
 ds_read_b64_tr_b16 a[228:229], v209 offset:0
 ds_read_b64_tr_b16 a[230:231], v209 offset:5120
 ds_read_b64_tr_b16 a[16:17], v200 offset:40960
 ds_read_b64_tr_b16 a[18:19], v200 offset:46080
 ds_read_b64_tr_b16 a[40:41], v201 offset:40960
 ds_read_b64_tr_b16 a[42:43], v201 offset:46080
 ds_read_b64_tr_b16 a[64:65], v202 offset:40960
 ds_read_b64_tr_b16 a[66:67], v202 offset:46080
 ds_read_b64_tr_b16 a[88:89], v203 offset:40960
 ds_read_b64_tr_b16 a[90:91], v203 offset:46080
 ds_read_b64_tr_b16 a[112:113], v204 offset:40960
 ds_read_b64_tr_b16 a[114:115], v204 offset:46080
 ds_read_b64_tr_b16 a[136:137], v205 offset:40960
 ds_read_b64_tr_b16 a[138:139], v205 offset:46080
 ds_read_b64_tr_b16 a[160:161], v206 offset:40960
 ds_read_b64_tr_b16 a[162:163], v206 offset:46080
 ds_read_b64_tr_b16 a[184:185], v207 offset:40960
 ds_read_b64_tr_b16 a[186:187], v207 offset:46080
 ds_read_b64_tr_b16 a[208:209], v208 offset:40960
 ds_read_b64_tr_b16 a[210:211], v208 offset:46080
 ds_read_b64_tr_b16 a[232:233], v209 offset:40960
 ds_read_b64_tr_b16 a[234:235], v209 offset:46080
 ds_read_b64_tr_b16 a[20:21], v210 offset:0
 ds_read_b64_tr_b16 a[22:23], v210 offset:5120
 ds_read_b64_tr_b16 a[44:45], v211 offset:0
 ds_read_b64_tr_b16 a[46:47], v211 offset:5120
 ds_read_b64_tr_b16 a[68:69], v212 offset:0
 ds_read_b64_tr_b16 a[70:71], v212 offset:5120
 ds_read_b64_tr_b16 a[92:93], v213 offset:0
 ds_read_b64_tr_b16 a[94:95], v213 offset:5120
 ds_read_b64_tr_b16 a[116:117], v214 offset:0
 ds_read_b64_tr_b16 a[118:119], v214 offset:5120
 ds_read_b64_tr_b16 a[140:141], v215 offset:0
 ds_read_b64_tr_b16 a[142:143], v215 offset:5120
 ds_read_b64_tr_b16 a[164:165], v216 offset:0
 ds_read_b64_tr_b16 a[166:167], v216 offset:5120
 ds_read_b64_tr_b16 a[188:189], v217 offset:0
 ds_read_b64_tr_b16 a[190:191], v217 offset:5120
 ds_read_b64_tr_b16 a[212:213], v218 offset:0
 ds_read_b64_tr_b16 a[214:215], v218 offset:5120
 ds_read_b64_tr_b16 a[236:237], v219 offset:0
 ds_read_b64_tr_b16 a[238:239], v219 offset:5120
 s_waitcnt lgkmcnt(0)
 s_barrier
 s_load_dwordx2 s[32:33], s[0:1], 96
 s_waitcnt lgkmcnt(0)
 s_mov_b32 s32, s32
 s_mov_b32 s33, s33
 s_mov_b32 s34, 256
 s_mov_b32 s35, 0x00020000
 s_mov_b32 s21, 76
 s_cmp_lg_u32 s20, 0
 s_cbranch_scc1 wf_144
 v_mov_b32 v4, 0
 s_mov_b32 s101, 0
wf_143:
 buffer_load_dword v5, v4, s[32:35], s21 offen sc1
 s_add_u32 s101, s101, 1
 s_cmp_gt_u32 s101, 131072
 s_cbranch_scc1 main_end
 s_waitcnt vmcnt(0)
 v_readfirstlane_b32 s100, v5
 s_cmp_ge_u32 s100, 32
 s_cbranch_scc1 wf_144
 s_sleep 8
 s_branch wf_143
wf_144:
 s_barrier
 s_mul_i32 s41, s2, 12288
 s_add_u32 s47, s41, 25165824
 s_mov_b32 s41, s47
 s_mul_i32 s21, s20, 10
 s_mul_i32 s47, s2, 5
 s_lshr_b32 s22, s21, 3
 s_add_u32 s47, s47, s22
 s_and_b32 s48, s21, 7
 s_mov_b32 s66, 0
 s_mov_b32 s67, 0
 s_lshr_b32 s43, s2, 2
 s_lshl_b32 s43, s43, 7
 s_add_u32 s43, s43, 0
 s_lshl_b32 s44, s2, 7
 s_lshl_b32 s21, s20, 12
 s_add_u32 s44, s44, s21
 s_add_u32 s44, s44, 95232
 s_mov_b32 s45, 0
 s_mov_b32 s49, 1
 s_mov_b32 s50, 0
 v_mov_b32 v10, 0
 v_mov_b32 v11, 1
 v_lshlrev_b32 v4, 4, v1
 s_add_u32 s76, s38, 56623104
 s_addc_u32 s77, s39, 0
 s_mov_b32 s78, 6291456
 s_mov_b32 s79, 0x00020000
 s_add_u32 s80, s38, 101711872
 s_addc_u32 s81, s39, 0
 s_mov_b32 s82, 20971520
 s_mov_b32 s83, 0x00020000
 v_and_b32 v12, 3, v1
 v_lshlrev_b32 v12, 3, v12
 v_add_u32 v12, 4, v12
 v_and_b32 v13, 7, v2
 v_lshlrev_b32 v13, 4, v13
 v_lshl_add_u32 v13, v3, 7, v13
 v_lshrrev_b32 v14, 3, v2
 v_mul_u32_u24 v14, 98304, v14
 v_add_u32 v14, v14, v13
 v_and_b32 v15, 1, v3
 v_lshlrev_b32 v15, 8, v15
 v_lshl_add_u32 v15, v2, 4, v15
 v_lshrrev_b32 v16, 1, v3
 v_mul_u32_u24 v16, 327680, v16
 v_add_u32 v15, v15, v16
 v_lshlrev_b32 v17, 10, v1
 v_mov_b32 v19, 0
 s_lshl_b32 s53, s2, 7
 s_add_u32 s53, s53, 19456
 s_mov_b32 s55, 0
 s_mov_b32 s56, 0
 s_mov_b32 s58, 0
 s_mov_b32 s59, 0
 s_add_u32 s84, s38, 50331648
 s_addc_u32 s85, s39, 0
 s_mov_b32 s86, 12582912
 s_mov_b32 s87, 0x00020000
 s_and_b32 s21, s2, 3
 s_mul_i32 s51, s2, 3072
 s_cmp_eq_u32 s21, s20
 s_cselect_b32 s51, s51, 6291456
 v_mov_b32 v244, -1
 v_mov_b32 v245, -1
 v_mov_b32 v246, -1
 v_mov_b32 v247, -1
 s_add_u32 s88, s38, 180355072
 s_addc_u32 s89, s39, 0
 s_mov_b32 s90, 67108864
 s_mov_b32 s91, 0x00020000
 s_mul_i32 s21, s20, 3072
 s_add_u32 s41, s41, s21
 s_mov_b32 s64, s21
 s_add_u32 s67, s21, 98304
 s_mov_b32 s71, s21
 s_mov_b32 s46, 0
 s_mov_b32 s47, 0
 s_mov_b32 s65, 0
 s_mul_i32 s42, s2, 40960
 s_mul_i32 s21, s20, 10240
 s_add_u32 s42, s42, s21
 s_mov_b32 s68, 0x80000000
 s_mov_b32 s70, 0
 s_mov_b32 s40, 0
 s_mov_b32 s31, 0
 s_mov_b32 s56, s68
 s_mov_b32 s57, s68
 s_lshl_b32 s59, s20, 1
 s_sub_u32 s59, 8, s59
 s_add_u32 s61, s28, 9216
 v_min_u32 v5, 18, v1
 v_lshlrev_b32 v5, 10, v5
 v_mov_b32 v9, 0
 s_lshl_b32 s21, s20, 2
 s_add_u32 s21, s21, 110592
 v_mov_b32 v6, s21
 v_mov_b32 v7, 110592
 s_mul_i32 s51, s2, 3072
 s_lshl_b32 s21, s20, 10
 s_add_u32 s51, s51, s21
 s_cmp_lt_u32 s20, 3
 s_cselect_b32 s51, s51, 6291456
 s_add_u32 s51, s51, 5111808
 s_cmp_lg_u32 s20, 0
 s_cbranch_scc1 wf_146
 v_mov_b32 v20, 0
 s_mov_b32 s101, 0
wf_145:
 buffer_load_dword v21, v20, s[72:75], s43 offen sc1
 s_add_u32 s101, s101, 1
 s_cmp_gt_u32 s101, 131072
 s_cbranch_scc1 main_end
 s_waitcnt vmcnt(0)
 v_readfirstlane_b32 s100, v21
 s_cmp_ge_u32 s100, 8
 s_cbranch_scc1 wf_146
 s_sleep 4
 s_branch wf_145
wf_146:
 s_barrier
 v_writelane_b32 v9, 8, 0
 v_cmp_gt_u32 vcc, 8, v9
 s_nop 0
 s_bitset1_b64 vcc, 19
 s_ff1_i32_b64 s21, vcc
 s_lshl_b32 s22, s21, 1
 s_lshl_b32 s21, s21, 2
 s_sub_i32 s21, s21, 12
 s_max_i32 s47, s21, s22
 s_cmp_gt_u32 s47, s45
 s_cbranch_scc1 va_147
 s_mov_b32 s101, 0
 s_branch va_150
va_148:
 s_sleep 8
va_150:
 buffer_load_dword v9, v5, s[72:75], s43 offen sc1
 s_add_u32 s101, s101, 1
 s_cmp_gt_u32 s101, 131072
 s_cbranch_scc1 main_end
 s_waitcnt vmcnt(0)
 v_cmp_gt_u32 vcc, 8, v9
 s_nop 0
 s_bitset1_b64 vcc, 19
 s_ff1_i32_b64 s21, vcc
 s_lshl_b32 s22, s21, 1
 s_lshl_b32 s21, s21, 2
 s_sub_i32 s21, s21, 12
 s_max_i32 s47, s21, s22
 s_cmp_gt_u32 s47, s45
 s_cbranch_scc0 va_148
va_147:
 s_add_u32 s22, s45, 6
 s_min_u32 s22, s22, s47
va_149:
 s_cmp_ge_u32 s46, s22
 s_cbranch_scc1 va_151
 s_mov_b32 m0, s64
 s_mov_b32 s66, s41
 buffer_load_dwordx4 v4, s[16:19], s66 offen offset:0 sc1 lds
 buffer_load_dwordx4 v4, s[16:19], s66 offen offset:1024 sc1 lds
 buffer_load_dwordx4 v4, s[16:19], s66 offen offset:2048 sc1 lds
 s_add_u32 s46, s46, 1
 s_add_u32 s41, s41, 393216
 s_add_u32 s64, s64, 12288
 s_cmp_lt_u32 s64, s67
 s_cselect_b32 s64, s64, s71
 s_branch va_149
va_151:
 s_mov_b32 s48, s46
 s_mov_b32 s49, s46
 s_mov_b32 s50, s46
 s_waitcnt vmcnt(0)
 s_barrier
 v_mov_b32 v8, v4
 s_add_u32 s65, s65, 12288
 s_cmp_lt_u32 s65, 98304
 s_cselect_b32 s65, s65, 0
 ds_read_b128 v[144:147], v8 offset:0
 ds_read_b128 v[148:151], v8 offset:1024
 ds_read_b128 v[152:155], v8 offset:2048
 ds_read_b128 v[156:159], v8 offset:3072
 ds_read_b128 v[160:163], v8 offset:4096
 ds_read_b128 v[164:167], v8 offset:5120
 ds_read_b128 v[168:171], v8 offset:6144
 ds_read_b128 v[172:175], v8 offset:7168
 ds_read_b128 v[176:179], v8 offset:8192
 ds_read_b128 v[180:183], v8 offset:9216
 ds_read_b128 v[184:187], v8 offset:10240
 ds_read_b128 v[188:191], v8 offset:11264
vwl_152:
 s_waitcnt lgkmcnt(0)
 v_mfma_f32_16x16x32_bf16 v[64:67], v[144:147], a[0:3], 0
 v_cmp_gt_u32 vcc, 8, v9
 s_nop 0
 v_mfma_f32_16x16x32_bf16 v[72:75], v[144:147], a[24:27], 0
 s_bitset1_b64 vcc, 19
 s_ff1_i32_b64 s21, vcc
 v_mfma_f32_16x16x32_bf16 v[80:83], v[144:147], a[48:51], 0
 s_lshl_b32 s22, s21, 1
 s_lshl_b32 s21, s21, 2
 v_mfma_f32_16x16x32_bf16 v[88:91], v[144:147], a[72:75], 0
 s_sub_i32 s21, s21, 12
 s_max_i32 s47, s21, s22
 v_mfma_f32_16x16x32_bf16 v[96:99], v[144:147], a[96:99], 0
 s_add_u32 s22, s45, 7
 s_min_u32 s22, s22, s47
 v_mfma_f32_16x16x32_bf16 v[68:71], v[168:171], a[0:3], 0
 s_cmp_lt_u32 s46, s22
 s_cselect_b32 s66, s41, 0x80000000
 s_cselect_b32 m0, s64, 98304
 s_cselect_b32 s22, 1, 0
 v_mfma_f32_16x16x32_bf16 v[76:79], v[168:171], a[24:27], 0
 buffer_load_dwordx4 v4, s[16:19], s66 offen offset:0 sc1 lds
 v_mfma_f32_16x16x32_bf16 v[84:87], v[168:171], a[48:51], 0
 v_add_u32 v8, s65, v4
 s_add_u32 s65, s65, 12288
 v_mfma_f32_16x16x32_bf16 v[92:95], v[168:171], a[72:75], 0
 buffer_load_dwordx4 v4, s[16:19], s66 offen offset:1024 sc1 lds
 v_mfma_f32_16x16x32_bf16 v[100:103], v[168:171], a[96:99], 0
 s_cmp_lt_u32 s65, 98304
 s_cselect_b32 s65, s65, 0
 v_mfma_f32_16x16x32_bf16 v[64:67], v[148:151], a[4:7], v[64:67]
 buffer_load_dwordx4 v4, s[16:19], s66 offen offset:2048 sc1 lds
 v_mfma_f32_16x16x32_bf16 v[72:75], v[148:151], a[28:31], v[72:75]
 s_add_u32 s46, s46, s22
 s_mul_i32 s21, s22, 393216
 v_mfma_f32_16x16x32_bf16 v[80:83], v[148:151], a[52:55], v[80:83]
 s_add_u32 s41, s41, s21
 s_mul_i32 s21, s22, 12288
 v_mfma_f32_16x16x32_bf16 v[88:91], v[148:151], a[76:79], v[88:91]
 s_add_u32 s64, s64, s21
 v_cvt_pk_bf16_f32 v44, v104, v105
 v_mfma_f32_16x16x32_bf16 v[96:99], v[148:151], a[100:103], v[96:99]
 s_cmp_lt_u32 s64, s67
 s_cselect_b32 s64, s64, s71
 v_mfma_f32_16x16x32_bf16 v[68:71], v[172:175], a[4:7], v[68:71]
 v_cvt_pk_bf16_f32 v45, v106, v107
 v_cvt_pk_bf16_f32 v46, v108, v109
 v_mfma_f32_16x16x32_bf16 v[76:79], v[172:175], a[28:31], v[76:79]
 v_cvt_pk_bf16_f32 v47, v110, v111
 v_mfma_f32_16x16x32_bf16 v[84:87], v[172:175], a[52:55], v[84:87]
 s_add_u32 s69, s68, 4096
 v_mfma_f32_16x16x32_bf16 v[92:95], v[172:175], a[76:79], v[92:95]
 v_mfma_f32_16x16x32_bf16 v[100:103], v[172:175], a[100:103], v[100:103]
 buffer_store_dwordx4 v[44:47], v4, s[24:27], s69 offen offset:1024 sc1
 v_mfma_f32_16x16x32_bf16 v[64:67], v[152:155], a[8:11], v[64:67]
 v_mfma_f32_16x16x32_bf16 v[72:75], v[152:155], a[32:35], v[72:75]
 v_cvt_pk_bf16_f32 v48, v112, v113
 v_mfma_f32_16x16x32_bf16 v[80:83], v[152:155], a[56:59], v[80:83]
 v_cvt_pk_bf16_f32 v49, v114, v115
 v_mfma_f32_16x16x32_bf16 v[88:91], v[152:155], a[80:83], v[88:91]
 v_mfma_f32_16x16x32_bf16 v[96:99], v[152:155], a[104:107], v[96:99]
 v_cvt_pk_bf16_f32 v50, v116, v117
 v_mfma_f32_16x16x32_bf16 v[68:71], v[176:179], a[8:11], v[68:71]
 v_mfma_f32_16x16x32_bf16 v[76:79], v[176:179], a[32:35], v[76:79]
 v_cvt_pk_bf16_f32 v51, v118, v119
 v_mfma_f32_16x16x32_bf16 v[84:87], v[176:179], a[56:59], v[84:87]
 buffer_store_dwordx4 v[48:51], v4, s[24:27], s69 offen offset:2048 sc1
 v_mfma_f32_16x16x32_bf16 v[92:95], v[176:179], a[80:83], v[92:95]
 v_mfma_f32_16x16x32_bf16 v[100:103], v[176:179], a[104:107], v[100:103]
 v_cvt_pk_bf16_f32 v52, v120, v121
 v_mfma_f32_16x16x32_bf16 v[64:67], v[156:159], a[12:15], v[64:67]
 v_mfma_f32_16x16x32_bf16 v[72:75], v[156:159], a[36:39], v[72:75]
 v_cvt_pk_bf16_f32 v53, v122, v123
 v_mfma_f32_16x16x32_bf16 v[80:83], v[156:159], a[60:63], v[80:83]
 v_cvt_pk_bf16_f32 v54, v124, v125
 v_mfma_f32_16x16x32_bf16 v[88:91], v[156:159], a[84:87], v[88:91]
 v_mfma_f32_16x16x32_bf16 v[96:99], v[156:159], a[108:111], v[96:99]
 v_cvt_pk_bf16_f32 v55, v126, v127
 v_mfma_f32_16x16x32_bf16 v[68:71], v[180:183], a[12:15], v[68:71]
 v_mfma_f32_16x16x32_bf16 v[76:79], v[180:183], a[36:39], v[76:79]
 buffer_store_dwordx4 v[52:55], v4, s[24:27], s69 offen offset:3072 sc1
 v_mfma_f32_16x16x32_bf16 v[84:87], v[180:183], a[60:63], v[84:87]
 v_cvt_pk_bf16_f32 v56, v128, v129
 v_mfma_f32_16x16x32_bf16 v[92:95], v[180:183], a[84:87], v[92:95]
 v_mfma_f32_16x16x32_bf16 v[100:103], v[180:183], a[108:111], v[100:103]
 v_cvt_pk_bf16_f32 v57, v130, v131
 v_mfma_f32_16x16x32_bf16 v[64:67], v[160:163], a[16:19], v[64:67]
 v_mfma_f32_16x16x32_bf16 v[72:75], v[160:163], a[40:43], v[72:75]
 v_cvt_pk_bf16_f32 v58, v132, v133
 v_mfma_f32_16x16x32_bf16 v[80:83], v[160:163], a[64:67], v[80:83]
 v_cvt_pk_bf16_f32 v59, v134, v135
 v_mfma_f32_16x16x32_bf16 v[88:91], v[160:163], a[88:91], v[88:91]
 v_mfma_f32_16x16x32_bf16 v[96:99], v[160:163], a[112:115], v[96:99]
 s_add_u32 s69, s68, 8192
 v_mfma_f32_16x16x32_bf16 v[68:71], v[184:187], a[16:19], v[68:71]
 v_mfma_f32_16x16x32_bf16 v[76:79], v[184:187], a[40:43], v[76:79]
 buffer_store_dwordx4 v[56:59], v4, s[24:27], s69 offen offset:0 sc1
 v_mfma_f32_16x16x32_bf16 v[84:87], v[184:187], a[64:67], v[84:87]
 v_cvt_pk_bf16_f32 v60, v136, v137
 v_mfma_f32_16x16x32_bf16 v[92:95], v[184:187], a[88:91], v[92:95]
 v_mfma_f32_16x16x32_bf16 v[100:103], v[184:187], a[112:115], v[100:103]
 v_cvt_pk_bf16_f32 v61, v138, v139
 v_mfma_f32_16x16x32_bf16 v[64:67], v[164:167], a[20:23], v[64:67]
 v_mfma_f32_16x16x32_bf16 v[72:75], v[164:167], a[44:47], v[72:75]
 v_cvt_pk_bf16_f32 v62, v140, v141
 v_mfma_f32_16x16x32_bf16 v[80:83], v[164:167], a[68:71], v[80:83]
 v_cvt_pk_bf16_f32 v63, v142, v143
 v_mfma_f32_16x16x32_bf16 v[88:91], v[164:167], a[92:95], v[88:91]
 v_mfma_f32_16x16x32_bf16 v[96:99], v[164:167], a[116:119], v[96:99]
 buffer_store_dwordx4 v[60:63], v4, s[24:27], s69 offen offset:1024 sc1
 v_mfma_f32_16x16x32_bf16 v[68:71], v[188:191], a[20:23], v[68:71]
 v_mfma_f32_16x16x32_bf16 v[76:79], v[188:191], a[44:47], v[76:79]
 v_mfma_f32_16x16x32_bf16 v[84:87], v[188:191], a[68:71], v[84:87]
 v_mfma_f32_16x16x32_bf16 v[92:95], v[188:191], a[92:95], v[92:95]
 v_mfma_f32_16x16x32_bf16 v[100:103], v[188:191], a[116:119], v[100:103]
 v_mfma_f32_16x16x32_bf16 v[104:107], v[144:147], a[120:123], 0
 buffer_load_dword v9, v5, s[72:75], s43 offen sc1
 v_mfma_f32_16x16x32_bf16 v[112:115], v[144:147], a[144:147], 0
 v_mfma_f32_16x16x32_bf16 v[120:123], v[144:147], a[168:171], 0
 v_mfma_f32_16x16x32_bf16 v[128:131], v[144:147], a[192:195], 0
 v_cvt_pk_bf16_f32 v24, v64, v65
 v_mfma_f32_16x16x32_bf16 v[136:139], v[144:147], a[216:219], 0
 s_add_u32 s63, s45, 1
 s_min_u32 s63, s63, 63
 v_mfma_f32_16x16x32_bf16 v[108:111], v[168:171], a[120:123], 0
 s_cmp_lt_u32 s63, s46
 s_cselect_b32 s53, 1, 0
 v_mfma_f32_16x16x32_bf16 v[116:119], v[168:171], a[144:147], 0
 v_mov_b32 v21, s53
 ds_write_b32 v6, v21 offset:0
 v_mfma_f32_16x16x32_bf16 v[124:127], v[168:171], a[168:171], 0
 v_cvt_pk_bf16_f32 v25, v66, v67
 v_cvt_pk_bf16_f32 v26, v68, v69
 v_mfma_f32_16x16x32_bf16 v[132:135], v[168:171], a[192:195], 0
 v_cvt_pk_bf16_f32 v27, v70, v71
 v_mfma_f32_16x16x32_bf16 v[140:143], v[168:171], a[216:219], 0
 v_mfma_f32_16x16x32_bf16 v[104:107], v[148:151], a[124:127], v[104:107]
 buffer_store_dwordx4 v[24:27], v4, s[24:27], s42 offen offset:0 sc1
 v_mfma_f32_16x16x32_bf16 v[112:115], v[148:151], a[148:151], v[112:115]
 v_cvt_pk_bf16_f32 v28, v72, v73
 v_mfma_f32_16x16x32_bf16 v[120:123], v[148:151], a[172:175], v[120:123]
 s_cmp_eq_u32 s40, 3
 s_cbranch_scc1 vwm_156
vwm_157:
 v_mfma_f32_16x16x32_bf16 v[128:131], v[148:151], a[196:199], v[128:131]
 v_cvt_pk_bf16_f32 v29, v74, v75
 v_mfma_f32_16x16x32_bf16 v[136:139], v[148:151], a[220:223], v[136:139]
 v_mfma_f32_16x16x32_bf16 v[108:111], v[172:175], a[124:127], v[108:111]
 v_cvt_pk_bf16_f32 v30, v76, v77
 v_mfma_f32_16x16x32_bf16 v[116:119], v[172:175], a[148:151], v[116:119]
 v_mfma_f32_16x16x32_bf16 v[124:127], v[172:175], a[172:175], v[124:127]
 v_cvt_pk_bf16_f32 v31, v78, v79
 v_mfma_f32_16x16x32_bf16 v[132:135], v[172:175], a[196:199], v[132:135]
 buffer_store_dwordx4 v[28:31], v4, s[24:27], s42 offen offset:1024 sc1
 v_mfma_f32_16x16x32_bf16 v[140:143], v[172:175], a[220:223], v[140:143]
 s_cmp_lt_u32 s63, s50
 s_cbranch_scc0 vwx_154
vwx_155:
 v_mfma_f32_16x16x32_bf16 v[104:107], v[152:155], a[128:131], v[104:107]
 s_waitcnt lgkmcnt(0)
 s_barrier
 v_mfma_f32_16x16x32_bf16 v[112:115], v[152:155], a[152:155], v[112:115]
 ds_read_b128 v[240:243], v7 offset:0
 v_cvt_pk_bf16_f32 v32, v80, v81
 v_mfma_f32_16x16x32_bf16 v[120:123], v[152:155], a[176:179], v[120:123]
 ds_read_b128 v[192:195], v8 offset:0
 v_cvt_pk_bf16_f32 v33, v82, v83
 v_mfma_f32_16x16x32_bf16 v[128:131], v[152:155], a[200:203], v[128:131]
 v_mfma_f32_16x16x32_bf16 v[136:139], v[152:155], a[224:227], v[136:139]
 ds_read_b128 v[196:199], v8 offset:1024
 v_cvt_pk_bf16_f32 v34, v84, v85
 v_mfma_f32_16x16x32_bf16 v[108:111], v[176:179], a[128:131], v[108:111]
 v_mfma_f32_16x16x32_bf16 v[116:119], v[176:179], a[152:155], v[116:119]
 v_cvt_pk_bf16_f32 v35, v86, v87
 v_mfma_f32_16x16x32_bf16 v[124:127], v[176:179], a[176:179], v[124:127]
 ds_read_b128 v[200:203], v8 offset:2048
 v_mfma_f32_16x16x32_bf16 v[132:135], v[176:179], a[200:203], v[132:135]
 buffer_store_dwordx4 v[32:35], v4, s[24:27], s42 offen offset:2048 sc1
 v_mfma_f32_16x16x32_bf16 v[140:143], v[176:179], a[224:227], v[140:143]
 ds_read_b128 v[204:207], v8 offset:3072
 v_cvt_pk_bf16_f32 v36, v88, v89
 v_mfma_f32_16x16x32_bf16 v[104:107], v[156:159], a[132:135], v[104:107]
 v_mfma_f32_16x16x32_bf16 v[112:115], v[156:159], a[156:159], v[112:115]
 v_cvt_pk_bf16_f32 v37, v90, v91
 v_mfma_f32_16x16x32_bf16 v[120:123], v[156:159], a[180:183], v[120:123]
 ds_read_b128 v[208:211], v8 offset:4096
 v_mfma_f32_16x16x32_bf16 v[128:131], v[156:159], a[204:207], v[128:131]
 v_cvt_pk_bf16_f32 v38, v92, v93
 v_mfma_f32_16x16x32_bf16 v[136:139], v[156:159], a[228:231], v[136:139]
 ds_read_b128 v[212:215], v8 offset:5120
 s_waitcnt lgkmcnt(4)
 v_mfma_f32_16x16x32_bf16 v[108:111], v[180:183], a[132:135], v[108:111]
 v_bitop3_b32 v240, v240, v241, v242 bitop3:0x80
 v_and_b32 v240, v240, v243
 v_mfma_f32_16x16x32_bf16 v[116:119], v[180:183], a[156:159], v[116:119]
 s_nop 0
 v_readfirstlane_b32 s23, v240
 v_mfma_f32_16x16x32_bf16 v[124:127], v[180:183], a[180:183], v[124:127]
 ds_read_b128 v[216:219], v8 offset:6144
 v_cvt_pk_bf16_f32 v39, v94, v95
 v_mfma_f32_16x16x32_bf16 v[132:135], v[180:183], a[204:207], v[132:135]
 buffer_store_dwordx4 v[36:39], v4, s[24:27], s42 offen offset:3072 sc1
 v_mfma_f32_16x16x32_bf16 v[140:143], v[180:183], a[228:231], v[140:143]
 ds_read_b128 v[220:223], v8 offset:7168
 v_cvt_pk_bf16_f32 v40, v96, v97
 v_mfma_f32_16x16x32_bf16 v[104:107], v[160:163], a[136:139], v[104:107]
 v_cvt_pk_bf16_f32 v41, v98, v99
 v_mfma_f32_16x16x32_bf16 v[112:115], v[160:163], a[160:163], v[112:115]
 v_cvt_pk_bf16_f32 v42, v100, v101
 v_mfma_f32_16x16x32_bf16 v[120:123], v[160:163], a[184:187], v[120:123]
 ds_read_b128 v[224:227], v8 offset:8192
 v_mfma_f32_16x16x32_bf16 v[128:131], v[160:163], a[208:211], v[128:131]
 v_cvt_pk_bf16_f32 v43, v102, v103
 v_mfma_f32_16x16x32_bf16 v[136:139], v[160:163], a[232:235], v[136:139]
 ds_read_b128 v[228:231], v8 offset:9216
 v_mfma_f32_16x16x32_bf16 v[108:111], v[184:187], a[136:139], v[108:111]
 s_add_u32 s69, s42, 4096
 v_mfma_f32_16x16x32_bf16 v[116:119], v[184:187], a[160:163], v[116:119]
 v_mfma_f32_16x16x32_bf16 v[124:127], v[184:187], a[184:187], v[124:127]
 ds_read_b128 v[232:235], v8 offset:10240
 v_mfma_f32_16x16x32_bf16 v[132:135], v[184:187], a[208:211], v[132:135]
 buffer_store_dwordx4 v[40:43], v4, s[24:27], s69 offen offset:0 sc1
 v_mfma_f32_16x16x32_bf16 v[140:143], v[184:187], a[232:235], v[140:143]
 ds_read_b128 v[236:239], v8 offset:11264
 v_mfma_f32_16x16x32_bf16 v[104:107], v[164:167], a[140:143], v[104:107]
 v_mfma_f32_16x16x32_bf16 v[112:115], v[164:167], a[164:167], v[112:115]
 v_mfma_f32_16x16x32_bf16 v[120:123], v[164:167], a[188:191], v[120:123]
 s_waitcnt vmcnt(11)
 s_mov_b32 s50, s46
 s_add_u32 s69, s45, s40
 v_mfma_f32_16x16x32_bf16 v[128:131], v[164:167], a[212:215], v[128:131]
 s_mov_b32 s40, 0
 s_sub_i32 s69, s69, 1
 s_max_i32 s69, s69, s70
 v_mfma_f32_16x16x32_bf16 v[136:139], v[164:167], a[236:239], v[136:139]
 s_add_u32 s45, s45, 1
 s_mov_b32 s68, s42
 s_add_u32 s42, s42, 1310720
 v_mfma_f32_16x16x32_bf16 v[108:111], v[188:191], a[140:143], v[108:111]
 v_mfma_f32_16x16x32_bf16 v[116:119], v[188:191], a[164:167], v[116:119]
 v_mfma_f32_16x16x32_bf16 v[124:127], v[188:191], a[188:191], v[124:127]
 v_mfma_f32_16x16x32_bf16 v[132:135], v[188:191], a[212:215], v[132:135]
 v_mfma_f32_16x16x32_bf16 v[140:143], v[188:191], a[236:239], v[140:143]
 s_mov_b64 exec, 1
 v_mov_b32 v20, s69
 buffer_store_dword v20, v10, s[72:75], s44 offen sc1
 s_mov_b64 exec, -1
 s_cmp_le_u32 s45, 16
 s_cbranch_scc1 vwe_160
vwe_161:
 s_cmp_eq_u32 s23, 0
 s_cbranch_scc1 vws_158
vwb_159:
 s_waitcnt lgkmcnt(0)
 v_mfma_f32_16x16x32_bf16 v[64:67], v[192:195], a[0:3], 0
 v_cmp_gt_u32 vcc, 8, v9
 s_nop 0
 v_mfma_f32_16x16x32_bf16 v[72:75], v[192:195], a[24:27], 0
 s_bitset1_b64 vcc, 19
 s_ff1_i32_b64 s21, vcc
 v_mfma_f32_16x16x32_bf16 v[80:83], v[192:195], a[48:51], 0
 s_lshl_b32 s22, s21, 1
 s_lshl_b32 s21, s21, 2
 v_mfma_f32_16x16x32_bf16 v[88:91], v[192:195], a[72:75], 0
 s_sub_i32 s21, s21, 12
 s_max_i32 s47, s21, s22
 v_mfma_f32_16x16x32_bf16 v[96:99], v[192:195], a[96:99], 0
 s_add_u32 s22, s45, 7
 s_min_u32 s22, s22, s47
 v_mfma_f32_16x16x32_bf16 v[68:71], v[216:219], a[0:3], 0
 s_cmp_lt_u32 s46, s22
 s_cselect_b32 s66, s41, 0x80000000
 s_cselect_b32 m0, s64, 98304
 s_cselect_b32 s22, 1, 0
 v_mfma_f32_16x16x32_bf16 v[76:79], v[216:219], a[24:27], 0
 buffer_load_dwordx4 v4, s[16:19], s66 offen offset:0 sc1 lds
 v_mfma_f32_16x16x32_bf16 v[84:87], v[216:219], a[48:51], 0
 v_add_u32 v8, s65, v4
 s_add_u32 s65, s65, 12288
 v_mfma_f32_16x16x32_bf16 v[92:95], v[216:219], a[72:75], 0
 buffer_load_dwordx4 v4, s[16:19], s66 offen offset:1024 sc1 lds
 v_mfma_f32_16x16x32_bf16 v[100:103], v[216:219], a[96:99], 0
 s_cmp_lt_u32 s65, 98304
 s_cselect_b32 s65, s65, 0
 v_mfma_f32_16x16x32_bf16 v[64:67], v[196:199], a[4:7], v[64:67]
 buffer_load_dwordx4 v4, s[16:19], s66 offen offset:2048 sc1 lds
 v_mfma_f32_16x16x32_bf16 v[72:75], v[196:199], a[28:31], v[72:75]
 s_add_u32 s46, s46, s22
 s_mul_i32 s21, s22, 393216
 v_mfma_f32_16x16x32_bf16 v[80:83], v[196:199], a[52:55], v[80:83]
 s_add_u32 s41, s41, s21
 s_mul_i32 s21, s22, 12288
 v_mfma_f32_16x16x32_bf16 v[88:91], v[196:199], a[76:79], v[88:91]
 s_add_u32 s64, s64, s21
 v_cvt_pk_bf16_f32 v44, v104, v105
 v_mfma_f32_16x16x32_bf16 v[96:99], v[196:199], a[100:103], v[96:99]
 s_cmp_lt_u32 s64, s67
 s_cselect_b32 s64, s64, s71
 v_mfma_f32_16x16x32_bf16 v[68:71], v[220:223], a[4:7], v[68:71]
 v_cvt_pk_bf16_f32 v45, v106, v107
 v_cvt_pk_bf16_f32 v46, v108, v109
 v_mfma_f32_16x16x32_bf16 v[76:79], v[220:223], a[28:31], v[76:79]
 v_cvt_pk_bf16_f32 v47, v110, v111
 v_mfma_f32_16x16x32_bf16 v[84:87], v[220:223], a[52:55], v[84:87]
 s_add_u32 s69, s68, 4096
 v_mfma_f32_16x16x32_bf16 v[92:95], v[220:223], a[76:79], v[92:95]
 v_mfma_f32_16x16x32_bf16 v[100:103], v[220:223], a[100:103], v[100:103]
 buffer_store_dwordx4 v[44:47], v4, s[24:27], s69 offen offset:1024 sc1
 v_mfma_f32_16x16x32_bf16 v[64:67], v[200:203], a[8:11], v[64:67]
 v_mfma_f32_16x16x32_bf16 v[72:75], v[200:203], a[32:35], v[72:75]
 v_cvt_pk_bf16_f32 v48, v112, v113
 v_mfma_f32_16x16x32_bf16 v[80:83], v[200:203], a[56:59], v[80:83]
 v_cvt_pk_bf16_f32 v49, v114, v115
 v_mfma_f32_16x16x32_bf16 v[88:91], v[200:203], a[80:83], v[88:91]
 v_mfma_f32_16x16x32_bf16 v[96:99], v[200:203], a[104:107], v[96:99]
 v_cvt_pk_bf16_f32 v50, v116, v117
 v_mfma_f32_16x16x32_bf16 v[68:71], v[224:227], a[8:11], v[68:71]
 v_mfma_f32_16x16x32_bf16 v[76:79], v[224:227], a[32:35], v[76:79]
 v_cvt_pk_bf16_f32 v51, v118, v119
 v_mfma_f32_16x16x32_bf16 v[84:87], v[224:227], a[56:59], v[84:87]
 buffer_store_dwordx4 v[48:51], v4, s[24:27], s69 offen offset:2048 sc1
 v_mfma_f32_16x16x32_bf16 v[92:95], v[224:227], a[80:83], v[92:95]
 v_mfma_f32_16x16x32_bf16 v[100:103], v[224:227], a[104:107], v[100:103]
 v_cvt_pk_bf16_f32 v52, v120, v121
 v_mfma_f32_16x16x32_bf16 v[64:67], v[204:207], a[12:15], v[64:67]
 v_mfma_f32_16x16x32_bf16 v[72:75], v[204:207], a[36:39], v[72:75]
 v_cvt_pk_bf16_f32 v53, v122, v123
 v_mfma_f32_16x16x32_bf16 v[80:83], v[204:207], a[60:63], v[80:83]
 v_cvt_pk_bf16_f32 v54, v124, v125
 v_mfma_f32_16x16x32_bf16 v[88:91], v[204:207], a[84:87], v[88:91]
 v_mfma_f32_16x16x32_bf16 v[96:99], v[204:207], a[108:111], v[96:99]
 v_cvt_pk_bf16_f32 v55, v126, v127
 v_mfma_f32_16x16x32_bf16 v[68:71], v[228:231], a[12:15], v[68:71]
 v_mfma_f32_16x16x32_bf16 v[76:79], v[228:231], a[36:39], v[76:79]
 buffer_store_dwordx4 v[52:55], v4, s[24:27], s69 offen offset:3072 sc1
 v_mfma_f32_16x16x32_bf16 v[84:87], v[228:231], a[60:63], v[84:87]
 v_cvt_pk_bf16_f32 v56, v128, v129
 v_mfma_f32_16x16x32_bf16 v[92:95], v[228:231], a[84:87], v[92:95]
 v_mfma_f32_16x16x32_bf16 v[100:103], v[228:231], a[108:111], v[100:103]
 v_cvt_pk_bf16_f32 v57, v130, v131
 v_mfma_f32_16x16x32_bf16 v[64:67], v[208:211], a[16:19], v[64:67]
 v_mfma_f32_16x16x32_bf16 v[72:75], v[208:211], a[40:43], v[72:75]
 v_cvt_pk_bf16_f32 v58, v132, v133
 v_mfma_f32_16x16x32_bf16 v[80:83], v[208:211], a[64:67], v[80:83]
 v_cvt_pk_bf16_f32 v59, v134, v135
 v_mfma_f32_16x16x32_bf16 v[88:91], v[208:211], a[88:91], v[88:91]
 v_mfma_f32_16x16x32_bf16 v[96:99], v[208:211], a[112:115], v[96:99]
 s_add_u32 s69, s68, 8192
 v_mfma_f32_16x16x32_bf16 v[68:71], v[232:235], a[16:19], v[68:71]
 v_mfma_f32_16x16x32_bf16 v[76:79], v[232:235], a[40:43], v[76:79]
 buffer_store_dwordx4 v[56:59], v4, s[24:27], s69 offen offset:0 sc1
 v_mfma_f32_16x16x32_bf16 v[84:87], v[232:235], a[64:67], v[84:87]
 v_cvt_pk_bf16_f32 v60, v136, v137
 v_mfma_f32_16x16x32_bf16 v[92:95], v[232:235], a[88:91], v[92:95]
 v_mfma_f32_16x16x32_bf16 v[100:103], v[232:235], a[112:115], v[100:103]
 v_cvt_pk_bf16_f32 v61, v138, v139
 v_mfma_f32_16x16x32_bf16 v[64:67], v[212:215], a[20:23], v[64:67]
 v_mfma_f32_16x16x32_bf16 v[72:75], v[212:215], a[44:47], v[72:75]
 v_cvt_pk_bf16_f32 v62, v140, v141
 v_mfma_f32_16x16x32_bf16 v[80:83], v[212:215], a[68:71], v[80:83]
 v_cvt_pk_bf16_f32 v63, v142, v143
 v_mfma_f32_16x16x32_bf16 v[88:91], v[212:215], a[92:95], v[88:91]
 v_mfma_f32_16x16x32_bf16 v[96:99], v[212:215], a[116:119], v[96:99]
 buffer_store_dwordx4 v[60:63], v4, s[24:27], s69 offen offset:1024 sc1
 v_mfma_f32_16x16x32_bf16 v[68:71], v[236:239], a[20:23], v[68:71]
 v_mfma_f32_16x16x32_bf16 v[76:79], v[236:239], a[44:47], v[76:79]
 v_mfma_f32_16x16x32_bf16 v[84:87], v[236:239], a[68:71], v[84:87]
 v_mfma_f32_16x16x32_bf16 v[92:95], v[236:239], a[92:95], v[92:95]
 v_mfma_f32_16x16x32_bf16 v[100:103], v[236:239], a[116:119], v[100:103]
 v_mfma_f32_16x16x32_bf16 v[104:107], v[192:195], a[120:123], 0
 buffer_load_dword v9, v5, s[72:75], s43 offen sc1
 v_mfma_f32_16x16x32_bf16 v[112:115], v[192:195], a[144:147], 0
 v_mfma_f32_16x16x32_bf16 v[120:123], v[192:195], a[168:171], 0
 v_mfma_f32_16x16x32_bf16 v[128:131], v[192:195], a[192:195], 0
 v_cvt_pk_bf16_f32 v24, v64, v65
 v_mfma_f32_16x16x32_bf16 v[136:139], v[192:195], a[216:219], 0
 s_add_u32 s63, s45, 1
 s_min_u32 s63, s63, 63
 v_mfma_f32_16x16x32_bf16 v[108:111], v[216:219], a[120:123], 0
 s_cmp_lt_u32 s63, s46
 s_cselect_b32 s53, 1, 0
 v_mfma_f32_16x16x32_bf16 v[116:119], v[216:219], a[144:147], 0
 v_mov_b32 v21, s53
 ds_write_b32 v6, v21 offset:16
 v_mfma_f32_16x16x32_bf16 v[124:127], v[216:219], a[168:171], 0
 v_cvt_pk_bf16_f32 v25, v66, v67
 v_cvt_pk_bf16_f32 v26, v68, v69
 v_mfma_f32_16x16x32_bf16 v[132:135], v[216:219], a[192:195], 0
 v_cvt_pk_bf16_f32 v27, v70, v71
 v_mfma_f32_16x16x32_bf16 v[140:143], v[216:219], a[216:219], 0
 v_mfma_f32_16x16x32_bf16 v[104:107], v[196:199], a[124:127], v[104:107]
 buffer_store_dwordx4 v[24:27], v4, s[24:27], s42 offen offset:0 sc1
 v_mfma_f32_16x16x32_bf16 v[112:115], v[196:199], a[148:151], v[112:115]
 v_cvt_pk_bf16_f32 v28, v72, v73
 v_mfma_f32_16x16x32_bf16 v[120:123], v[196:199], a[172:175], v[120:123]
 s_cmp_eq_u32 s40, 3
 s_cbranch_scc1 vwm_166
vwm_167:
 v_mfma_f32_16x16x32_bf16 v[128:131], v[196:199], a[196:199], v[128:131]
 v_cvt_pk_bf16_f32 v29, v74, v75
 v_mfma_f32_16x16x32_bf16 v[136:139], v[196:199], a[220:223], v[136:139]
 v_mfma_f32_16x16x32_bf16 v[108:111], v[220:223], a[124:127], v[108:111]
 v_cvt_pk_bf16_f32 v30, v76, v77
 v_mfma_f32_16x16x32_bf16 v[116:119], v[220:223], a[148:151], v[116:119]
 v_mfma_f32_16x16x32_bf16 v[124:127], v[220:223], a[172:175], v[124:127]
 v_cvt_pk_bf16_f32 v31, v78, v79
 v_mfma_f32_16x16x32_bf16 v[132:135], v[220:223], a[196:199], v[132:135]
 buffer_store_dwordx4 v[28:31], v4, s[24:27], s42 offen offset:1024 sc1
 v_mfma_f32_16x16x32_bf16 v[140:143], v[220:223], a[220:223], v[140:143]
 s_cmp_lt_u32 s63, s50
 s_cbranch_scc0 vwx_164
vwx_165:
 v_mfma_f32_16x16x32_bf16 v[104:107], v[200:203], a[128:131], v[104:107]
 s_waitcnt lgkmcnt(0)
 s_barrier
 v_mfma_f32_16x16x32_bf16 v[112:115], v[200:203], a[152:155], v[112:115]
 ds_read_b128 v[240:243], v7 offset:16
 v_cvt_pk_bf16_f32 v32, v80, v81
 v_mfma_f32_16x16x32_bf16 v[120:123], v[200:203], a[176:179], v[120:123]
 ds_read_b128 v[144:147], v8 offset:0
 v_cvt_pk_bf16_f32 v33, v82, v83
 v_mfma_f32_16x16x32_bf16 v[128:131], v[200:203], a[200:203], v[128:131]
 v_mfma_f32_16x16x32_bf16 v[136:139], v[200:203], a[224:227], v[136:139]
 ds_read_b128 v[148:151], v8 offset:1024
 v_cvt_pk_bf16_f32 v34, v84, v85
 v_mfma_f32_16x16x32_bf16 v[108:111], v[224:227], a[128:131], v[108:111]
 v_mfma_f32_16x16x32_bf16 v[116:119], v[224:227], a[152:155], v[116:119]
 v_cvt_pk_bf16_f32 v35, v86, v87
 v_mfma_f32_16x16x32_bf16 v[124:127], v[224:227], a[176:179], v[124:127]
 ds_read_b128 v[152:155], v8 offset:2048
 v_mfma_f32_16x16x32_bf16 v[132:135], v[224:227], a[200:203], v[132:135]
 buffer_store_dwordx4 v[32:35], v4, s[24:27], s42 offen offset:2048 sc1
 v_mfma_f32_16x16x32_bf16 v[140:143], v[224:227], a[224:227], v[140:143]
 ds_read_b128 v[156:159], v8 offset:3072
 v_cvt_pk_bf16_f32 v36, v88, v89
 v_mfma_f32_16x16x32_bf16 v[104:107], v[204:207], a[132:135], v[104:107]
 v_mfma_f32_16x16x32_bf16 v[112:115], v[204:207], a[156:159], v[112:115]
 v_cvt_pk_bf16_f32 v37, v90, v91
 v_mfma_f32_16x16x32_bf16 v[120:123], v[204:207], a[180:183], v[120:123]
 ds_read_b128 v[160:163], v8 offset:4096
 v_mfma_f32_16x16x32_bf16 v[128:131], v[204:207], a[204:207], v[128:131]
 v_cvt_pk_bf16_f32 v38, v92, v93
 v_mfma_f32_16x16x32_bf16 v[136:139], v[204:207], a[228:231], v[136:139]
 ds_read_b128 v[164:167], v8 offset:5120
 s_waitcnt lgkmcnt(4)
 v_mfma_f32_16x16x32_bf16 v[108:111], v[228:231], a[132:135], v[108:111]
 v_bitop3_b32 v240, v240, v241, v242 bitop3:0x80
 v_and_b32 v240, v240, v243
 v_mfma_f32_16x16x32_bf16 v[116:119], v[228:231], a[156:159], v[116:119]
 s_nop 0
 v_readfirstlane_b32 s23, v240
 v_mfma_f32_16x16x32_bf16 v[124:127], v[228:231], a[180:183], v[124:127]
 ds_read_b128 v[168:171], v8 offset:6144
 v_cvt_pk_bf16_f32 v39, v94, v95
 v_mfma_f32_16x16x32_bf16 v[132:135], v[228:231], a[204:207], v[132:135]
 buffer_store_dwordx4 v[36:39], v4, s[24:27], s42 offen offset:3072 sc1
 v_mfma_f32_16x16x32_bf16 v[140:143], v[228:231], a[228:231], v[140:143]
 ds_read_b128 v[172:175], v8 offset:7168
 v_cvt_pk_bf16_f32 v40, v96, v97
 v_mfma_f32_16x16x32_bf16 v[104:107], v[208:211], a[136:139], v[104:107]
 v_cvt_pk_bf16_f32 v41, v98, v99
 v_mfma_f32_16x16x32_bf16 v[112:115], v[208:211], a[160:163], v[112:115]
 v_cvt_pk_bf16_f32 v42, v100, v101
 v_mfma_f32_16x16x32_bf16 v[120:123], v[208:211], a[184:187], v[120:123]
 ds_read_b128 v[176:179], v8 offset:8192
 v_mfma_f32_16x16x32_bf16 v[128:131], v[208:211], a[208:211], v[128:131]
 v_cvt_pk_bf16_f32 v43, v102, v103
 v_mfma_f32_16x16x32_bf16 v[136:139], v[208:211], a[232:235], v[136:139]
 ds_read_b128 v[180:183], v8 offset:9216
 v_mfma_f32_16x16x32_bf16 v[108:111], v[232:235], a[136:139], v[108:111]
 s_add_u32 s69, s42, 4096
 v_mfma_f32_16x16x32_bf16 v[116:119], v[232:235], a[160:163], v[116:119]
 v_mfma_f32_16x16x32_bf16 v[124:127], v[232:235], a[184:187], v[124:127]
 ds_read_b128 v[184:187], v8 offset:10240
 v_mfma_f32_16x16x32_bf16 v[132:135], v[232:235], a[208:211], v[132:135]
 buffer_store_dwordx4 v[40:43], v4, s[24:27], s69 offen offset:0 sc1
 v_mfma_f32_16x16x32_bf16 v[140:143], v[232:235], a[232:235], v[140:143]
 ds_read_b128 v[188:191], v8 offset:11264
 v_mfma_f32_16x16x32_bf16 v[104:107], v[212:215], a[140:143], v[104:107]
 v_mfma_f32_16x16x32_bf16 v[112:115], v[212:215], a[164:167], v[112:115]
 v_mfma_f32_16x16x32_bf16 v[120:123], v[212:215], a[188:191], v[120:123]
 s_waitcnt vmcnt(11)
 s_mov_b32 s50, s46
 s_add_u32 s69, s45, s40
 v_mfma_f32_16x16x32_bf16 v[128:131], v[212:215], a[212:215], v[128:131]
 s_mov_b32 s40, 0
 s_sub_i32 s69, s69, 1
 s_max_i32 s69, s69, s70
 v_mfma_f32_16x16x32_bf16 v[136:139], v[212:215], a[236:239], v[136:139]
 s_add_u32 s45, s45, 1
 s_mov_b32 s68, s42
 s_add_u32 s42, s42, 1310720
 v_mfma_f32_16x16x32_bf16 v[108:111], v[236:239], a[140:143], v[108:111]
 v_mfma_f32_16x16x32_bf16 v[116:119], v[236:239], a[164:167], v[116:119]
 v_mfma_f32_16x16x32_bf16 v[124:127], v[236:239], a[188:191], v[124:127]
 v_mfma_f32_16x16x32_bf16 v[132:135], v[236:239], a[212:215], v[132:135]
 v_mfma_f32_16x16x32_bf16 v[140:143], v[236:239], a[236:239], v[140:143]
 s_mov_b64 exec, 1
 v_mov_b32 v20, s69
 buffer_store_dword v20, v10, s[72:75], s44 offen sc1
 s_mov_b64 exec, -1
 s_cmp_le_u32 s45, 16
 s_cbranch_scc1 vwe_170
vwe_171:
 s_cmp_lg_u32 s45, 44
 s_cbranch_scc1 arm_174
 v_and_b32 v23, 31, v1
 buffer_load_ubyte v22, v23, s[32:35], 0 offen offset:160 sc1
 s_waitcnt vmcnt(0)
 s_mov_b32 s101, 0
c0_176:
 v_cmp_eq_u32 vcc, 0, v22
 s_nop 1
 s_cbranch_vccz c0_177
 s_sleep 8
 v_and_b32 v23, 31, v1
 buffer_load_ubyte v22, v23, s[32:35], 0 offen offset:160 sc1
 s_add_u32 s101, s101, 1
 s_cmp_gt_u32 s101, 131072
 s_cbranch_scc1 main_end
 s_waitcnt vmcnt(0)
 s_branch c0_176
c0_177:
 v_cmp_eq_u32 vcc, 2, v22
 s_nop 1
 s_mov_b32 s37, vcc_lo
 s_lshr_b32 s21, s2, 3
 s_lshl_b32 s21, s21, 14
 s_and_b32 s22, s2, 7
 s_lshl_b32 s22, s22, 10
 s_add_u32 s54, s21, s22
 s_lshr_b32 s21, s2, 2
 s_lshl_b32 s21, s21, 14
 s_and_b32 s22, s2, 3
 s_lshl_b32 s22, s22, 11
 s_add_u32 s21, s21, s22
 s_add_u32 s55, s21, 655360
 s_lshr_b32 s58, s2, 1
 s_lshl_b32 s58, s58, 14
 s_and_b32 s21, s2, 1
 s_mul_i32 s21, s21, 3072
 s_add_u32 s58, s58, s21
 s_add_u32 s58, s58, 655360
 s_add_u32 s56, s20, 52
arm_175:
 s_lshr_b32 s21, s56, 1
 s_bitcmp1_b32 s37, s21
 s_cselect_b32 s21, 8192, 0
 s_lshl_b32 s57, s56, 20
 s_or_b32 s57, s57, s21
 s_cmp_ge_u32 s56, 40
 s_cselect_b32 s21, 8192, 0
 s_xor_b32 s21, s21, s57
 s_add_u32 s21, s21, s54
 buffer_store_dwordx4 v[244:247], v4, s[88:91], s21 offen sc1
 s_add_u32 s21, s21, 65536
 buffer_store_dwordx4 v[244:247], v4, s[88:91], s21 offen sc1
 s_add_u32 s21, s21, 65536
 buffer_store_dwordx4 v[244:247], v4, s[88:91], s21 offen sc1
 s_add_u32 s21, s21, 65536
 buffer_store_dwordx4 v[244:247], v4, s[88:91], s21 offen sc1
 s_add_u32 s21, s21, 65536
 buffer_store_dwordx4 v[244:247], v4, s[88:91], s21 offen sc1
 s_add_u32 s21, s21, 65536
 buffer_store_dwordx4 v[244:247], v4, s[88:91], s21 offen sc1
 s_add_u32 s21, s21, 65536
 buffer_store_dwordx4 v[244:247], v4, s[88:91], s21 offen sc1
 s_add_u32 s21, s21, 65536
 buffer_store_dwordx4 v[244:247], v4, s[88:91], s21 offen sc1
 s_add_u32 s21, s21, 65536
 buffer_store_dwordx4 v[244:247], v4, s[88:91], s21 offen sc1
 s_add_u32 s21, s21, 65536
 buffer_store_dwordx4 v[244:247], v4, s[88:91], s21 offen sc1
 s_add_u32 s21, s21, 65536
 s_add_u32 s21, s57, s55
 buffer_store_dwordx4 v[244:247], v4, s[88:91], s21 offen sc1
 buffer_store_dwordx4 v[244:247], v4, s[88:91], s21 offen offset:1024 sc1
 s_xor_b32 s21, s57, 8192
 s_add_u32 s21, s21, s58
 buffer_store_dwordx4 v[244:247], v4, s[88:91], s21 offen offset:0 sc1
 buffer_store_dwordx4 v[244:247], v4, s[88:91], s21 offen offset:1024 sc1
 buffer_store_dwordx4 v[244:247], v4, s[88:91], s21 offen offset:2048 sc1
 s_add_u32 s56, s56, 4
 s_cmp_lt_u32 s56, 64
 s_cbranch_scc1 arm_175
arm_174:
 s_cmp_ge_u32 s45, 64
 s_cbranch_scc1 vwd_153
 s_cmp_lg_u32 s23, 0
 s_cbranch_scc1 vwl_152
 s_branch vws_168
vws_158:
 v_cmp_gt_u32 vcc, 8, v9
 s_nop 0
 s_bitset1_b64 vcc, 19
 s_ff1_i32_b64 s21, vcc
 s_lshl_b32 s22, s21, 1
 s_lshl_b32 s21, s21, 2
 s_sub_i32 s21, s21, 12
 s_max_i32 s47, s21, s22
 s_cmp_gt_u32 s47, s45
 s_cbranch_scc1 va_178
 s_cmp_eq_u32 s70, s45
 s_cbranch_scc1 va_183
 s_nop 4
 v_cvt_pk_bf16_f32 v44, v104, v105
 v_cvt_pk_bf16_f32 v45, v106, v107
 v_cvt_pk_bf16_f32 v46, v108, v109
 v_cvt_pk_bf16_f32 v47, v110, v111
 s_add_u32 s69, s68, 4096
 buffer_store_dwordx4 v[44:47], v4, s[24:27], s69 offen offset:1024 sc1
 v_cvt_pk_bf16_f32 v48, v112, v113
 v_cvt_pk_bf16_f32 v49, v114, v115
 v_cvt_pk_bf16_f32 v50, v116, v117
 v_cvt_pk_bf16_f32 v51, v118, v119
 buffer_store_dwordx4 v[48:51], v4, s[24:27], s69 offen offset:2048 sc1
 v_cvt_pk_bf16_f32 v52, v120, v121
 v_cvt_pk_bf16_f32 v53, v122, v123
 v_cvt_pk_bf16_f32 v54, v124, v125
 v_cvt_pk_bf16_f32 v55, v126, v127
 buffer_store_dwordx4 v[52:55], v4, s[24:27], s69 offen offset:3072 sc1
 v_cvt_pk_bf16_f32 v56, v128, v129
 v_cvt_pk_bf16_f32 v57, v130, v131
 v_cvt_pk_bf16_f32 v58, v132, v133
 v_cvt_pk_bf16_f32 v59, v134, v135
 s_add_u32 s69, s68, 8192
 buffer_store_dwordx4 v[56:59], v4, s[24:27], s69 offen offset:0 sc1
 v_cvt_pk_bf16_f32 v60, v136, v137
 v_cvt_pk_bf16_f32 v61, v138, v139
 v_cvt_pk_bf16_f32 v62, v140, v141
 v_cvt_pk_bf16_f32 v63, v142, v143
 buffer_store_dwordx4 v[60:63], v4, s[24:27], s69 offen offset:1024 sc1
 s_mov_b32 s68, 0x80000000
 s_mov_b32 s56, s68
 s_mov_b32 s57, s68
 s_waitcnt vmcnt(0)
 s_mov_b64 exec, 1
 v_mov_b32 v20, s45
 buffer_store_dword v20, v10, s[72:75], s44 offen sc1
 s_mov_b64 exec, -1
 s_mov_b32 s70, s45
 s_mov_b32 s40, 0
va_183:
 s_mov_b32 s101, 0
 s_branch va_181
va_179:
 s_sleep 8
va_181:
 buffer_load_dword v9, v5, s[72:75], s43 offen sc1
 s_add_u32 s101, s101, 1
 s_cmp_gt_u32 s101, 131072
 s_cbranch_scc1 main_end
 s_waitcnt vmcnt(0)
 v_cmp_gt_u32 vcc, 8, v9
 s_nop 0
 s_bitset1_b64 vcc, 19
 s_ff1_i32_b64 s21, vcc
 s_lshl_b32 s22, s21, 1
 s_lshl_b32 s21, s21, 2
 s_sub_i32 s21, s21, 12
 s_max_i32 s47, s21, s22
 s_cmp_gt_u32 s47, s45
 s_cbranch_scc0 va_179
va_178:
 s_add_u32 s22, s45, 6
 s_min_u32 s22, s22, s47
va_180:
 s_cmp_ge_u32 s46, s22
 s_cbranch_scc1 va_182
 s_mov_b32 m0, s64
 s_mov_b32 s66, s41
 buffer_load_dwordx4 v4, s[16:19], s66 offen offset:0 sc1 lds
 buffer_load_dwordx4 v4, s[16:19], s66 offen offset:1024 sc1 lds
 buffer_load_dwordx4 v4, s[16:19], s66 offen offset:2048 sc1 lds
 s_add_u32 s46, s46, 1
 s_add_u32 s41, s41, 393216
 s_add_u32 s64, s64, 12288
 s_cmp_lt_u32 s64, s67
 s_cselect_b32 s64, s64, s71
 s_branch va_180
va_182:
 s_mov_b32 s48, s46
 s_mov_b32 s49, s46
 s_mov_b32 s50, s46
 s_waitcnt vmcnt(0)
 s_cmp_eq_u32 s40, 0
 s_cbranch_scc1 va_184
 s_mov_b32 s40, 0
 s_mov_b64 exec, 1
 v_mov_b32 v20, s45
 buffer_store_dword v20, v10, s[72:75], s44 offen sc1
 s_mov_b64 exec, -1
 s_mov_b32 s70, s45
va_184:
 s_barrier
 ds_read_b128 v[192:195], v8 offset:0
 ds_read_b128 v[196:199], v8 offset:1024
 ds_read_b128 v[200:203], v8 offset:2048
 ds_read_b128 v[204:207], v8 offset:3072
 ds_read_b128 v[208:211], v8 offset:4096
 ds_read_b128 v[212:215], v8 offset:5120
 ds_read_b128 v[216:219], v8 offset:6144
 ds_read_b128 v[220:223], v8 offset:7168
 ds_read_b128 v[224:227], v8 offset:8192
 ds_read_b128 v[228:231], v8 offset:9216
 ds_read_b128 v[232:235], v8 offset:10240
 ds_read_b128 v[236:239], v8 offset:11264
 s_branch vwb_159
vws_168:
 v_cmp_gt_u32 vcc, 8, v9
 s_nop 0
 s_bitset1_b64 vcc, 19
 s_ff1_i32_b64 s21, vcc
 s_lshl_b32 s22, s21, 1
 s_lshl_b32 s21, s21, 2
 s_sub_i32 s21, s21, 12
 s_max_i32 s47, s21, s22
 s_cmp_gt_u32 s47, s45
 s_cbranch_scc1 va_185
 s_cmp_eq_u32 s70, s45
 s_cbranch_scc1 va_190
 s_nop 4
 v_cvt_pk_bf16_f32 v44, v104, v105
 v_cvt_pk_bf16_f32 v45, v106, v107
 v_cvt_pk_bf16_f32 v46, v108, v109
 v_cvt_pk_bf16_f32 v47, v110, v111
 s_add_u32 s69, s68, 4096
 buffer_store_dwordx4 v[44:47], v4, s[24:27], s69 offen offset:1024 sc1
 v_cvt_pk_bf16_f32 v48, v112, v113
 v_cvt_pk_bf16_f32 v49, v114, v115
 v_cvt_pk_bf16_f32 v50, v116, v117
 v_cvt_pk_bf16_f32 v51, v118, v119
 buffer_store_dwordx4 v[48:51], v4, s[24:27], s69 offen offset:2048 sc1
 v_cvt_pk_bf16_f32 v52, v120, v121
 v_cvt_pk_bf16_f32 v53, v122, v123
 v_cvt_pk_bf16_f32 v54, v124, v125
 v_cvt_pk_bf16_f32 v55, v126, v127
 buffer_store_dwordx4 v[52:55], v4, s[24:27], s69 offen offset:3072 sc1
 v_cvt_pk_bf16_f32 v56, v128, v129
 v_cvt_pk_bf16_f32 v57, v130, v131
 v_cvt_pk_bf16_f32 v58, v132, v133
 v_cvt_pk_bf16_f32 v59, v134, v135
 s_add_u32 s69, s68, 8192
 buffer_store_dwordx4 v[56:59], v4, s[24:27], s69 offen offset:0 sc1
 v_cvt_pk_bf16_f32 v60, v136, v137
 v_cvt_pk_bf16_f32 v61, v138, v139
 v_cvt_pk_bf16_f32 v62, v140, v141
 v_cvt_pk_bf16_f32 v63, v142, v143
 buffer_store_dwordx4 v[60:63], v4, s[24:27], s69 offen offset:1024 sc1
 s_mov_b32 s68, 0x80000000
 s_mov_b32 s56, s68
 s_mov_b32 s57, s68
 s_waitcnt vmcnt(0)
 s_mov_b64 exec, 1
 v_mov_b32 v20, s45
 buffer_store_dword v20, v10, s[72:75], s44 offen sc1
 s_mov_b64 exec, -1
 s_mov_b32 s70, s45
 s_mov_b32 s40, 0
va_190:
 s_mov_b32 s101, 0
 s_branch va_188
va_186:
 s_sleep 8
va_188:
 buffer_load_dword v9, v5, s[72:75], s43 offen sc1
 s_add_u32 s101, s101, 1
 s_cmp_gt_u32 s101, 131072
 s_cbranch_scc1 main_end
 s_waitcnt vmcnt(0)
 v_cmp_gt_u32 vcc, 8, v9
 s_nop 0
 s_bitset1_b64 vcc, 19
 s_ff1_i32_b64 s21, vcc
 s_lshl_b32 s22, s21, 1
 s_lshl_b32 s21, s21, 2
 s_sub_i32 s21, s21, 12
 s_max_i32 s47, s21, s22
 s_cmp_gt_u32 s47, s45
 s_cbranch_scc0 va_186
va_185:
 s_add_u32 s22, s45, 6
 s_min_u32 s22, s22, s47
va_187:
 s_cmp_ge_u32 s46, s22
 s_cbranch_scc1 va_189
 s_mov_b32 m0, s64
 s_mov_b32 s66, s41
 buffer_load_dwordx4 v4, s[16:19], s66 offen offset:0 sc1 lds
 buffer_load_dwordx4 v4, s[16:19], s66 offen offset:1024 sc1 lds
 buffer_load_dwordx4 v4, s[16:19], s66 offen offset:2048 sc1 lds
 s_add_u32 s46, s46, 1
 s_add_u32 s41, s41, 393216
 s_add_u32 s64, s64, 12288
 s_cmp_lt_u32 s64, s67
 s_cselect_b32 s64, s64, s71
 s_branch va_187
va_189:
 s_mov_b32 s48, s46
 s_mov_b32 s49, s46
 s_mov_b32 s50, s46
 s_waitcnt vmcnt(0)
 s_cmp_eq_u32 s40, 0
 s_cbranch_scc1 va_191
 s_mov_b32 s40, 0
 s_mov_b64 exec, 1
 v_mov_b32 v20, s45
 buffer_store_dword v20, v10, s[72:75], s44 offen sc1
 s_mov_b64 exec, -1
 s_mov_b32 s70, s45
va_191:
 s_barrier
 ds_read_b128 v[144:147], v8 offset:0
 ds_read_b128 v[148:151], v8 offset:1024
 ds_read_b128 v[152:155], v8 offset:2048
 ds_read_b128 v[156:159], v8 offset:3072
 ds_read_b128 v[160:163], v8 offset:4096
 ds_read_b128 v[164:167], v8 offset:5120
 ds_read_b128 v[168:171], v8 offset:6144
 ds_read_b128 v[172:175], v8 offset:7168
 ds_read_b128 v[176:179], v8 offset:8192
 ds_read_b128 v[180:183], v8 offset:9216
 ds_read_b128 v[184:187], v8 offset:10240
 ds_read_b128 v[188:191], v8 offset:11264
 s_branch vwl_152
vwe_160:
 s_nop 4
 v_cvt_pk_bf16_f32 v44, v104, v105
 v_cvt_pk_bf16_f32 v45, v106, v107
 v_cvt_pk_bf16_f32 v46, v108, v109
 v_cvt_pk_bf16_f32 v47, v110, v111
 s_add_u32 s69, s68, 4096
 buffer_store_dwordx4 v[44:47], v4, s[24:27], s69 offen offset:1024 sc1
 v_cvt_pk_bf16_f32 v48, v112, v113
 v_cvt_pk_bf16_f32 v49, v114, v115
 v_cvt_pk_bf16_f32 v50, v116, v117
 v_cvt_pk_bf16_f32 v51, v118, v119
 buffer_store_dwordx4 v[48:51], v4, s[24:27], s69 offen offset:2048 sc1
 v_cvt_pk_bf16_f32 v52, v120, v121
 v_cvt_pk_bf16_f32 v53, v122, v123
 v_cvt_pk_bf16_f32 v54, v124, v125
 v_cvt_pk_bf16_f32 v55, v126, v127
 buffer_store_dwordx4 v[52:55], v4, s[24:27], s69 offen offset:3072 sc1
 v_cvt_pk_bf16_f32 v56, v128, v129
 v_cvt_pk_bf16_f32 v57, v130, v131
 v_cvt_pk_bf16_f32 v58, v132, v133
 v_cvt_pk_bf16_f32 v59, v134, v135
 s_add_u32 s69, s68, 8192
 buffer_store_dwordx4 v[56:59], v4, s[24:27], s69 offen offset:0 sc1
 v_cvt_pk_bf16_f32 v60, v136, v137
 v_cvt_pk_bf16_f32 v61, v138, v139
 v_cvt_pk_bf16_f32 v62, v140, v141
 v_cvt_pk_bf16_f32 v63, v142, v143
 buffer_store_dwordx4 v[60:63], v4, s[24:27], s69 offen offset:1024 sc1
 s_mov_b32 s68, 0x80000000
 s_mov_b32 s56, s68
 s_mov_b32 s57, s68
 s_cmp_le_u32 s45, 4
 s_cselect_b32 s40, 3, 1
 s_branch vwe_161
vwe_170:
 s_nop 4
 v_cvt_pk_bf16_f32 v44, v104, v105
 v_cvt_pk_bf16_f32 v45, v106, v107
 v_cvt_pk_bf16_f32 v46, v108, v109
 v_cvt_pk_bf16_f32 v47, v110, v111
 s_add_u32 s69, s68, 4096
 buffer_store_dwordx4 v[44:47], v4, s[24:27], s69 offen offset:1024 sc1
 v_cvt_pk_bf16_f32 v48, v112, v113
 v_cvt_pk_bf16_f32 v49, v114, v115
 v_cvt_pk_bf16_f32 v50, v116, v117
 v_cvt_pk_bf16_f32 v51, v118, v119
 buffer_store_dwordx4 v[48:51], v4, s[24:27], s69 offen offset:2048 sc1
 v_cvt_pk_bf16_f32 v52, v120, v121
 v_cvt_pk_bf16_f32 v53, v122, v123
 v_cvt_pk_bf16_f32 v54, v124, v125
 v_cvt_pk_bf16_f32 v55, v126, v127
 buffer_store_dwordx4 v[52:55], v4, s[24:27], s69 offen offset:3072 sc1
 v_cvt_pk_bf16_f32 v56, v128, v129
 v_cvt_pk_bf16_f32 v57, v130, v131
 v_cvt_pk_bf16_f32 v58, v132, v133
 v_cvt_pk_bf16_f32 v59, v134, v135
 s_add_u32 s69, s68, 8192
 buffer_store_dwordx4 v[56:59], v4, s[24:27], s69 offen offset:0 sc1
 v_cvt_pk_bf16_f32 v60, v136, v137
 v_cvt_pk_bf16_f32 v61, v138, v139
 v_cvt_pk_bf16_f32 v62, v140, v141
 v_cvt_pk_bf16_f32 v63, v142, v143
 buffer_store_dwordx4 v[60:63], v4, s[24:27], s69 offen offset:1024 sc1
 s_mov_b32 s68, 0x80000000
 s_mov_b32 s56, s68
 s_mov_b32 s57, s68
 s_cmp_le_u32 s45, 4
 s_cselect_b32 s40, 3, 1
 s_branch vwe_171
vwx_154:
 s_waitcnt vmcnt(8)
 s_branch vwx_155
vwx_164:
 s_waitcnt vmcnt(8)
 s_branch vwx_165
vwm_156:
 s_mov_b32 s40, 0
 s_waitcnt vmcnt(10)
 s_mov_b64 exec, 1
 v_mov_b32 v20, s45
 buffer_store_dword v20, v10, s[72:75], s44 offen sc1
 s_mov_b64 exec, -1
 s_mov_b32 s70, s45
 s_branch vwm_157
vwm_166:
 s_mov_b32 s40, 0
 s_waitcnt vmcnt(10)
 s_mov_b64 exec, 1
 v_mov_b32 v20, s45
 buffer_store_dword v20, v10, s[72:75], s44 offen sc1
 s_mov_b64 exec, -1
 s_mov_b32 s70, s45
 s_branch vwm_167
vwd_153:
 s_nop 4
 v_cvt_pk_bf16_f32 v44, v104, v105
 v_cvt_pk_bf16_f32 v45, v106, v107
 v_cvt_pk_bf16_f32 v46, v108, v109
 v_cvt_pk_bf16_f32 v47, v110, v111
 s_add_u32 s69, s68, 4096
 buffer_store_dwordx4 v[44:47], v4, s[24:27], s69 offen offset:1024 sc1
 v_cvt_pk_bf16_f32 v48, v112, v113
 v_cvt_pk_bf16_f32 v49, v114, v115
 v_cvt_pk_bf16_f32 v50, v116, v117
 v_cvt_pk_bf16_f32 v51, v118, v119
 buffer_store_dwordx4 v[48:51], v4, s[24:27], s69 offen offset:2048 sc1
 v_cvt_pk_bf16_f32 v52, v120, v121
 v_cvt_pk_bf16_f32 v53, v122, v123
 v_cvt_pk_bf16_f32 v54, v124, v125
 v_cvt_pk_bf16_f32 v55, v126, v127
 buffer_store_dwordx4 v[52:55], v4, s[24:27], s69 offen offset:3072 sc1
 v_cvt_pk_bf16_f32 v56, v128, v129
 v_cvt_pk_bf16_f32 v57, v130, v131
 v_cvt_pk_bf16_f32 v58, v132, v133
 v_cvt_pk_bf16_f32 v59, v134, v135
 s_add_u32 s69, s68, 8192
 buffer_store_dwordx4 v[56:59], v4, s[24:27], s69 offen offset:0 sc1
 v_cvt_pk_bf16_f32 v60, v136, v137
 v_cvt_pk_bf16_f32 v61, v138, v139
 v_cvt_pk_bf16_f32 v62, v140, v141
 v_cvt_pk_bf16_f32 v63, v142, v143
 buffer_store_dwordx4 v[60:63], v4, s[24:27], s69 offen offset:1024 sc1
 s_waitcnt vmcnt(0)
 s_mov_b64 exec, 1
 v_mov_b32 v20, s45
 buffer_store_dword v20, v10, s[72:75], s44 offen sc1
 s_mov_b64 exec, -1
 s_mov_b32 s84, 0
 s_mov_b32 s85, -1
 s_and_b32 s21, s3, 3
 s_cmp_lt_u32 s21, 2
 s_cbranch_scc1 queue
 s_sub_u32 s22, s21, 2
 s_lshl_b32 s22, s22, 3
 s_bfe_u32 s21, s3, 0x30002
 s_add_u32 s21, s21, s22
 s_add_u32 s87, s21, 284
 s_add_u32 s21, s21, 48
 s_mov_b32 s87, -1
 s_waitcnt vmcnt(0) lgkmcnt(0)
 s_barrier
 s_branch do_opb2
 s_mov_b32 s84, 0
 s_mov_b32 s85, -1
 s_mov_b32 s86, 0
 s_branch queue
not_vw:
 s_sub_u32 s2, s3, 96
armed:
 s_load_dwordx2 s[72:73], s[0:1], 104
 s_waitcnt lgkmcnt(0)
 s_add_u32 s72, s72, 81068032
 s_addc_u32 s73, s73, 0
 s_mov_b32 s74, 129024
 s_mov_b32 s75, 0x00020000
 s_load_dwordx2 s[4:5], s[0:1], 0
 s_load_dwordx2 s[6:7], s[0:1], 64
 s_load_dwordx2 s[38:39], s[0:1], 104
 s_mov_b32 s64, s32
 s_mov_b32 s65, s33
 s_mov_b32 s66, s34
 s_mov_b32 s67, s35
 s_lshr_b32 s41, s2, 1
 s_and_b32 s42, s2, 1
 s_waitcnt lgkmcnt(0)
 s_mov_b32 s8, s4
 s_mov_b32 s9, s5
 s_mov_b32 s10, 2621440
 s_mov_b32 s11, 0x00020000
 s_mov_b32 s12, s6
 s_mov_b32 s13, s7
 s_mov_b32 s14, 2457600
 s_mov_b32 s15, 0x00020000
 s_add_u32 s16, s38, 70713344
 s_addc_u32 s17, s39, 0
 s_mov_b32 s18, 2641920
 s_mov_b32 s19, 0x00020000
 s_add_u32 s72, s38, 81068032
 s_addc_u32 s73, s39, 0
 s_mov_b32 s74, 129024
 s_mov_b32 s75, 0x00020000
 s_lshl_b32 s21, s2, 2
 s_add_u32 s21, s21, s20
 s_mul_i32 s21, s21, 19200
 v_lshlrev_b32 v5, 4, v1
 buffer_load_dwordx4 v[64:67], v5, s[12:15], s21 offen offset:0
 buffer_load_dwordx4 v[64:67], v5, s[12:15], s21 offen offset:1024
 buffer_load_dwordx4 v[64:67], v5, s[12:15], s21 offen offset:2048
 buffer_load_dwordx4 v[64:67], v5, s[12:15], s21 offen offset:3072
 s_add_u32 s21, s21, 4096
 buffer_load_dwordx4 v[64:67], v5, s[12:15], s21 offen offset:0
 buffer_load_dwordx4 v[64:67], v5, s[12:15], s21 offen offset:1024
 buffer_load_dwordx4 v[64:67], v5, s[12:15], s21 offen offset:2048
 buffer_load_dwordx4 v[64:67], v5, s[12:15], s21 offen offset:3072
 s_add_u32 s21, s21, 4096
 buffer_load_dwordx4 v[64:67], v5, s[12:15], s21 offen offset:0
 buffer_load_dwordx4 v[64:67], v5, s[12:15], s21 offen offset:1024
 buffer_load_dwordx4 v[64:67], v5, s[12:15], s21 offen offset:2048
 buffer_load_dwordx4 v[64:67], v5, s[12:15], s21 offen offset:3072
 s_add_u32 s21, s21, 4096
 buffer_load_dwordx4 v[64:67], v5, s[12:15], s21 offen offset:0
 buffer_load_dwordx4 v[64:67], v5, s[12:15], s21 offen offset:1024
 buffer_load_dwordx4 v[64:67], v5, s[12:15], s21 offen offset:2048
 buffer_load_dwordx4 v[64:67], v5, s[12:15], s21 offen offset:3072
 s_add_u32 s21, s21, 4096
 buffer_load_dwordx4 v[64:67], v5, s[12:15], s21 offen offset:0
 buffer_load_dwordx4 v[64:67], v5, s[12:15], s21 offen offset:1024
 buffer_load_dwordx4 v[64:67], v5, s[12:15], s21 offen offset:2048
 s_waitcnt vmcnt(0)
 v_lshlrev_b32 v6, 1, v3
 v_add_u32 v6, 0, v6
 v_xor_b32 v6, v6, v2
 v_min_u32 v6, 14, v6
 v_mul_u32_u24 v7, 52, v6
 v_lshrrev_b32 v7, 8, v7
 v_mul_u32_u24 v7, 1200, v7
 v_lshl_add_u32 v7, v6, 4, v7
 v_mul_u32_u24 v6, 3840, v3
 v_add_u32 v4, v6, v7
 v_lshlrev_b32 v6, 1, v3
 v_add_u32 v6, 8, v6
 v_xor_b32 v6, v6, v2
 v_min_u32 v6, 14, v6
 v_mul_u32_u24 v7, 52, v6
 v_lshrrev_b32 v7, 8, v7
 v_mul_u32_u24 v7, 1200, v7
 v_lshl_add_u32 v7, v6, 4, v7
 v_mul_u32_u24 v6, 3840, v3
 v_add_u32 v5, v6, v7
 s_mul_i32 s21, s41, 80
 s_mul_i32 s22, s20, 15360
 s_add_u32 s21, s21, s22
 s_lshl_b32 s22, s20, 10
 s_cmp_ge_u32 s20, 2
 s_cselect_b64 vcc, -1, 0
 v_cndmask_b32 v4, v4, v5, vcc
 s_add_u32 m0, s22, 0
 s_nop 0
 buffer_load_dwordx4 v4, s[12:15], s21 offen lds
 s_add_u32 s21, s21, 61440
 s_add_u32 m0, s22, 4096
 s_nop 0
 buffer_load_dwordx4 v4, s[12:15], s21 offen lds
 s_add_u32 s21, s21, 61440
 s_add_u32 m0, s22, 8192
 s_nop 0
 buffer_load_dwordx4 v4, s[12:15], s21 offen lds
 s_add_u32 s21, s21, 61440
 s_add_u32 m0, s22, 12288
 s_nop 0
 buffer_load_dwordx4 v4, s[12:15], s21 offen lds
 s_add_u32 s21, s21, 61440
 s_add_u32 m0, s22, 16384
 s_nop 0
 buffer_load_dwordx4 v4, s[12:15], s21 offen lds
 s_add_u32 s21, s21, 61440
 s_add_u32 m0, s22, 20480
 s_nop 0
 buffer_load_dwordx4 v4, s[12:15], s21 offen lds
 s_add_u32 s21, s21, 61440
 s_add_u32 m0, s22, 24576
 s_nop 0
 buffer_load_dwordx4 v4, s[12:15], s21 offen lds
 s_add_u32 s21, s21, 61440
 s_add_u32 m0, s22, 28672
 s_nop 0
 buffer_load_dwordx4 v4, s[12:15], s21 offen lds
 s_add_u32 s21, s21, 61440
 s_add_u32 m0, s22, 32768
 s_nop 0
 buffer_load_dwordx4 v4, s[12:15], s21 offen lds
 s_add_u32 s21, s21, 61440
 s_add_u32 m0, s22, 36864
 s_nop 0
 buffer_load_dwordx4 v4, s[12:15], s21 offen lds
 s_add_u32 s21, s21, 61440
 s_add_u32 m0, s22, 40960
 s_nop 0
 buffer_load_dwordx4 v4, s[12:15], s21 offen lds
 s_add_u32 s21, s21, 61440
 s_add_u32 m0, s22, 45056
 s_nop 0
 buffer_load_dwordx4 v4, s[12:15], s21 offen lds
 s_add_u32 s21, s21, 61440
 s_add_u32 m0, s22, 49152
 s_nop 0
 buffer_load_dwordx4 v4, s[12:15], s21 offen lds
 s_add_u32 s21, s21, 61440
 s_add_u32 m0, s22, 53248
 s_nop 0
 buffer_load_dwordx4 v4, s[12:15], s21 offen lds
 s_add_u32 s21, s21, 61440
 s_add_u32 m0, s22, 57344
 s_nop 0
 buffer_load_dwordx4 v4, s[12:15], s21 offen lds
 s_add_u32 s21, s21, 61440
 s_add_u32 m0, s22, 61440
 s_nop 0
 buffer_load_dwordx4 v4, s[12:15], s21 offen lds
 s_add_u32 s21, s21, 61440
 s_add_u32 m0, s22, 65536
 s_nop 0
 buffer_load_dwordx4 v4, s[12:15], s21 offen lds
 s_add_u32 s21, s21, 61440
 s_add_u32 m0, s22, 69632
 s_nop 0
 buffer_load_dwordx4 v4, s[12:15], s21 offen lds
 s_add_u32 s21, s21, 61440
 s_add_u32 m0, s22, 73728
 s_nop 0
 buffer_load_dwordx4 v4, s[12:15], s21 offen lds
 s_add_u32 s21, s21, 61440
 s_add_u32 m0, s22, 77824
 s_nop 0
 buffer_load_dwordx4 v4, s[12:15], s21 offen lds
 s_add_u32 s21, s21, 61440
 s_add_u32 m0, s22, 81920
 s_nop 0
 buffer_load_dwordx4 v4, s[12:15], s21 offen lds
 s_add_u32 s21, s21, 61440
 s_add_u32 m0, s22, 86016
 s_nop 0
 buffer_load_dwordx4 v4, s[12:15], s21 offen lds
 s_add_u32 s21, s21, 61440
 s_add_u32 m0, s22, 90112
 s_nop 0
 buffer_load_dwordx4 v4, s[12:15], s21 offen lds
 s_add_u32 s21, s21, 61440
 s_add_u32 m0, s22, 94208
 s_nop 0
 buffer_load_dwordx4 v4, s[12:15], s21 offen lds
 s_add_u32 s21, s21, 61440
 s_add_u32 m0, s22, 98304
 s_nop 0
 buffer_load_dwordx4 v4, s[12:15], s21 offen lds
 s_add_u32 s21, s21, 61440
 s_add_u32 m0, s22, 102400
 s_nop 0
 buffer_load_dwordx4 v4, s[12:15], s21 offen lds
 s_add_u32 s21, s21, 61440
 s_add_u32 m0, s22, 106496
 s_nop 0
 buffer_load_dwordx4 v4, s[12:15], s21 offen lds
 s_add_u32 s21, s21, 61440
 s_add_u32 m0, s22, 110592
 s_nop 0
 buffer_load_dwordx4 v4, s[12:15], s21 offen lds
 s_add_u32 s21, s21, 61440
 s_add_u32 m0, s22, 114688
 s_nop 0
 buffer_load_dwordx4 v4, s[12:15], s21 offen lds
 s_add_u32 s21, s21, 61440
 s_add_u32 m0, s22, 118784
 s_nop 0
 buffer_load_dwordx4 v4, s[12:15], s21 offen lds
 s_add_u32 s21, s21, 61440
 s_add_u32 m0, s22, 122880
 s_nop 0
 buffer_load_dwordx4 v4, s[12:15], s21 offen lds
 s_add_u32 s21, s21, 61440
 s_add_u32 m0, s22, 126976
 s_nop 0
 buffer_load_dwordx4 v4, s[12:15], s21 offen lds
 s_add_u32 s21, s21, 61440
 s_add_u32 m0, s22, 131072
 s_nop 0
 buffer_load_dwordx4 v4, s[12:15], s21 offen lds
 s_add_u32 s21, s21, 61440
 s_add_u32 m0, s22, 135168
 s_nop 0
 buffer_load_dwordx4 v4, s[12:15], s21 offen lds
 s_add_u32 s21, s21, 61440
 s_add_u32 m0, s22, 139264
 s_nop 0
 buffer_load_dwordx4 v4, s[12:15], s21 offen lds
 s_add_u32 s21, s21, 61440
 s_add_u32 m0, s22, 143360
 s_nop 0
 buffer_load_dwordx4 v4, s[12:15], s21 offen lds
 s_add_u32 s21, s21, 61440
 s_add_u32 m0, s22, 147456
 s_nop 0
 buffer_load_dwordx4 v4, s[12:15], s21 offen lds
 s_add_u32 s21, s21, 61440
 s_add_u32 m0, s22, 151552
 s_nop 0
 buffer_load_dwordx4 v4, s[12:15], s21 offen lds
 s_add_u32 s21, s21, 61440
 s_add_u32 m0, s22, 155648
 s_nop 0
 buffer_load_dwordx4 v4, s[12:15], s21 offen lds
 s_add_u32 s21, s21, 61440
 s_add_u32 m0, s22, 159744
 s_nop 0
 buffer_load_dwordx4 v4, s[12:15], s21 offen lds
 s_add_u32 s21, s21, 61440
 s_lshl_b32 s21, s2, 2
 s_add_u32 s21, s21, s20
 s_mul_i32 s21, s21, 20480
 v_lshlrev_b32 v5, 4, v1
 buffer_load_dwordx4 v[64:67], v5, s[8:11], s21 offen offset:0
 buffer_load_dwordx4 v[64:67], v5, s[8:11], s21 offen offset:1024
 buffer_load_dwordx4 v[64:67], v5, s[8:11], s21 offen offset:2048
 buffer_load_dwordx4 v[64:67], v5, s[8:11], s21 offen offset:3072
 s_add_u32 s21, s21, 4096
 buffer_load_dwordx4 v[64:67], v5, s[8:11], s21 offen offset:0
 buffer_load_dwordx4 v[64:67], v5, s[8:11], s21 offen offset:1024
 buffer_load_dwordx4 v[64:67], v5, s[8:11], s21 offen offset:2048
 buffer_load_dwordx4 v[64:67], v5, s[8:11], s21 offen offset:3072
 s_add_u32 s21, s21, 4096
 buffer_load_dwordx4 v[64:67], v5, s[8:11], s21 offen offset:0
 buffer_load_dwordx4 v[64:67], v5, s[8:11], s21 offen offset:1024
 buffer_load_dwordx4 v[64:67], v5, s[8:11], s21 offen offset:2048
 buffer_load_dwordx4 v[64:67], v5, s[8:11], s21 offen offset:3072
 s_add_u32 s21, s21, 4096
 buffer_load_dwordx4 v[64:67], v5, s[8:11], s21 offen offset:0
 buffer_load_dwordx4 v[64:67], v5, s[8:11], s21 offen offset:1024
 buffer_load_dwordx4 v[64:67], v5, s[8:11], s21 offen offset:2048
 buffer_load_dwordx4 v[64:67], v5, s[8:11], s21 offen offset:3072
 s_add_u32 s21, s21, 4096
 buffer_load_dwordx4 v[64:67], v5, s[8:11], s21 offen offset:0
 buffer_load_dwordx4 v[64:67], v5, s[8:11], s21 offen offset:1024
 buffer_load_dwordx4 v[64:67], v5, s[8:11], s21 offen offset:2048
 buffer_load_dwordx4 v[64:67], v5, s[8:11], s21 offen offset:3072
 v_lshrrev_b32 v6, 2, v2
 v_lshl_add_u32 v7, v3, 3, v6
 v_and_b32 v8, 1, v3
 v_lshl_add_u32 v6, v8, 2, v6
 v_lshlrev_b32 v6, 1, v6
 v_bfe_u32 v8, v2, 1, 1
 s_lshl_b32 s21, s20, 2
 v_add_u32 v8, s21, v8
 v_and_b32 v9, 1, v2
 v_lshlrev_b32 v9, 3, v9
 v_lshl_add_u32 v9, v7, 8, v9
 v_add_u32 v5, 0, v8
 v_xor_b32 v5, v5, v6
 v_lshl_add_u32 v44, v5, 4, v9
 v_add_u32 v45, 65536, v44
 v_add_u32 v46, 131072, v44
 v_add_u32 v5, 2, v8
 v_xor_b32 v5, v5, v6
 v_lshl_add_u32 v47, v5, 4, v9
 v_add_u32 v48, 65536, v47
 v_add_u32 v49, 131072, v47
 s_waitcnt vmcnt(50) lgkmcnt(0)
 s_barrier
 ds_read_b64_tr_b16 a[0:1], v44 offset:0
 ds_read_b64_tr_b16 a[2:3], v44 offset:1024
 ds_read_b64_tr_b16 a[4:5], v47 offset:0
 ds_read_b64_tr_b16 a[6:7], v47 offset:1024
 ds_read_b64_tr_b16 a[8:9], v44 offset:8192
 ds_read_b64_tr_b16 a[10:11], v44 offset:9216
 ds_read_b64_tr_b16 a[12:13], v47 offset:8192
 ds_read_b64_tr_b16 a[14:15], v47 offset:9216
 ds_read_b64_tr_b16 a[16:17], v44 offset:16384
 ds_read_b64_tr_b16 a[18:19], v44 offset:17408
 ds_read_b64_tr_b16 a[20:21], v47 offset:16384
 ds_read_b64_tr_b16 a[22:23], v47 offset:17408
 ds_read_b64_tr_b16 a[24:25], v44 offset:24576
 ds_read_b64_tr_b16 a[26:27], v44 offset:25600
 ds_read_b64_tr_b16 a[28:29], v47 offset:24576
 ds_read_b64_tr_b16 a[30:31], v47 offset:25600
 ds_read_b64_tr_b16 a[32:33], v44 offset:32768
 ds_read_b64_tr_b16 a[34:35], v44 offset:33792
 ds_read_b64_tr_b16 a[36:37], v47 offset:32768
 ds_read_b64_tr_b16 a[38:39], v47 offset:33792
 s_waitcnt vmcnt(40) lgkmcnt(0)
 s_barrier
 ds_read_b64_tr_b16 a[40:41], v44 offset:40960
 ds_read_b64_tr_b16 a[42:43], v44 offset:41984
 ds_read_b64_tr_b16 a[44:45], v47 offset:40960
 ds_read_b64_tr_b16 a[46:47], v47 offset:41984
 ds_read_b64_tr_b16 a[48:49], v44 offset:49152
 ds_read_b64_tr_b16 a[50:51], v44 offset:50176
 ds_read_b64_tr_b16 a[52:53], v47 offset:49152
 ds_read_b64_tr_b16 a[54:55], v47 offset:50176
 ds_read_b64_tr_b16 a[56:57], v44 offset:57344
 ds_read_b64_tr_b16 a[58:59], v44 offset:58368
 ds_read_b64_tr_b16 a[60:61], v47 offset:57344
 ds_read_b64_tr_b16 a[62:63], v47 offset:58368
 ds_read_b64_tr_b16 a[64:65], v45 offset:0
 ds_read_b64_tr_b16 a[66:67], v45 offset:1024
 ds_read_b64_tr_b16 a[68:69], v48 offset:0
 ds_read_b64_tr_b16 a[70:71], v48 offset:1024
 ds_read_b64_tr_b16 a[72:73], v45 offset:8192
 ds_read_b64_tr_b16 a[74:75], v45 offset:9216
 ds_read_b64_tr_b16 a[76:77], v48 offset:8192
 ds_read_b64_tr_b16 a[78:79], v48 offset:9216
 s_waitcnt vmcnt(30) lgkmcnt(0)
 s_barrier
 s_mul_i32 s24, s42, 1280
 v_lshrrev_b32 v11, 3, v1
 v_and_b32 v12, 7, v1
 v_xor_b32 v12, v12, v11
 v_mul_u32_u24 v11, 2560, v11
 v_lshl_add_u32 v10, v12, 4, v11
 s_mul_i32 s46, s20, 81920
 v_add_u32 v10, s46, v10
 s_lshl_b32 s47, s20, 12
 s_add_u32 s47, s47, 0
 s_add_u32 s46, s47, 114688
 s_mov_b32 s30, s24
 s_add_u32 s32, s47, 0
 v_add_u32 v11, 19456, v10
 v_add_u32 v12, 38912, v10
 v_add_u32 v13, 58368, v10
 s_mov_b32 m0, s32
 s_nop 0
 buffer_load_dwordx4 v10, s[8:11], s30 offen offset:0 lds
 buffer_load_dwordx4 v11, s[8:11], s30 offen offset:1024 lds
 buffer_load_dwordx4 v12, s[8:11], s30 offen offset:2048 lds
 buffer_load_dwordx4 v13, s[8:11], s30 offen offset:3072 lds
 s_add_u32 s30, s30, 128
 s_add_u32 s32, s32, 16384
 s_cmp_lt_u32 s32, s46
 s_cselect_b32 s32, s32, s47
 s_mov_b32 m0, s32
 s_nop 0
 buffer_load_dwordx4 v10, s[8:11], s30 offen offset:0 lds
 buffer_load_dwordx4 v11, s[8:11], s30 offen offset:1024 lds
 buffer_load_dwordx4 v12, s[8:11], s30 offen offset:2048 lds
 buffer_load_dwordx4 v13, s[8:11], s30 offen offset:3072 lds
 s_add_u32 s30, s30, 128
 s_add_u32 s32, s32, 16384
 s_cmp_lt_u32 s32, s46
 s_cselect_b32 s32, s32, s47
 s_mov_b32 m0, s32
 s_nop 0
 buffer_load_dwordx4 v10, s[8:11], s30 offen offset:0 lds
 buffer_load_dwordx4 v11, s[8:11], s30 offen offset:1024 lds
 buffer_load_dwordx4 v12, s[8:11], s30 offen offset:2048 lds
 buffer_load_dwordx4 v13, s[8:11], s30 offen offset:3072 lds
 s_add_u32 s30, s30, 128
 s_add_u32 s32, s32, 16384
 s_cmp_lt_u32 s32, s46
 s_cselect_b32 s32, s32, s47
 s_mov_b32 m0, s32
 s_nop 0
 buffer_load_dwordx4 v10, s[8:11], s30 offen offset:0 lds
 buffer_load_dwordx4 v11, s[8:11], s30 offen offset:1024 lds
 buffer_load_dwordx4 v12, s[8:11], s30 offen offset:2048 lds
 buffer_load_dwordx4 v13, s[8:11], s30 offen offset:3072 lds
 s_add_u32 s30, s30, 128
 s_add_u32 s32, s32, 16384
 s_cmp_lt_u32 s32, s46
 s_cselect_b32 s32, s32, s47
 s_mov_b32 m0, s32
 s_nop 0
 buffer_load_dwordx4 v10, s[8:11], s30 offen offset:0 lds
 buffer_load_dwordx4 v11, s[8:11], s30 offen offset:1024 lds
 buffer_load_dwordx4 v12, s[8:11], s30 offen offset:2048 lds
 buffer_load_dwordx4 v13, s[8:11], s30 offen offset:3072 lds
 s_add_u32 s30, s30, 128
 s_add_u32 s32, s32, 16384
 s_cmp_lt_u32 s32, s46
 s_cselect_b32 s32, s32, s47
 ds_read_b64_tr_b16 a[80:81], v45 offset:16384
 ds_read_b64_tr_b16 a[82:83], v45 offset:17408
 ds_read_b64_tr_b16 a[84:85], v48 offset:16384
 ds_read_b64_tr_b16 a[86:87], v48 offset:17408
 ds_read_b64_tr_b16 a[88:89], v45 offset:24576
 ds_read_b64_tr_b16 a[90:91], v45 offset:25600
 ds_read_b64_tr_b16 a[92:93], v48 offset:24576
 ds_read_b64_tr_b16 a[94:95], v48 offset:25600
 ds_read_b64_tr_b16 a[96:97], v45 offset:32768
 ds_read_b64_tr_b16 a[98:99], v45 offset:33792
 ds_read_b64_tr_b16 a[100:101], v48 offset:32768
 ds_read_b64_tr_b16 a[102:103], v48 offset:33792
 ds_read_b64_tr_b16 a[104:105], v45 offset:40960
 ds_read_b64_tr_b16 a[106:107], v45 offset:41984
 ds_read_b64_tr_b16 a[108:109], v48 offset:40960
 ds_read_b64_tr_b16 a[110:111], v48 offset:41984
 ds_read_b64_tr_b16 a[112:113], v45 offset:49152
 ds_read_b64_tr_b16 a[114:115], v45 offset:50176
 ds_read_b64_tr_b16 a[116:117], v48 offset:49152
 ds_read_b64_tr_b16 a[118:119], v48 offset:50176
 s_waitcnt vmcnt(40) lgkmcnt(0)
 s_barrier
 ds_read_b64_tr_b16 a[120:121], v45 offset:57344
 ds_read_b64_tr_b16 a[122:123], v45 offset:58368
 ds_read_b64_tr_b16 a[124:125], v48 offset:57344
 ds_read_b64_tr_b16 a[126:127], v48 offset:58368
 ds_read_b64_tr_b16 a[128:129], v46 offset:0
 ds_read_b64_tr_b16 a[130:131], v46 offset:1024
 ds_read_b64_tr_b16 a[132:133], v49 offset:0
 ds_read_b64_tr_b16 a[134:135], v49 offset:1024
 ds_read_b64_tr_b16 a[136:137], v46 offset:8192
 ds_read_b64_tr_b16 a[138:139], v46 offset:9216
 ds_read_b64_tr_b16 a[140:141], v49 offset:8192
 ds_read_b64_tr_b16 a[142:143], v49 offset:9216
 ds_read_b64_tr_b16 a[144:145], v46 offset:16384
 ds_read_b64_tr_b16 a[146:147], v46 offset:17408
 ds_read_b64_tr_b16 a[148:149], v49 offset:16384
 ds_read_b64_tr_b16 a[150:151], v49 offset:17408
 ds_read_b64_tr_b16 a[152:153], v46 offset:24576
 ds_read_b64_tr_b16 a[154:155], v46 offset:25600
 ds_read_b64_tr_b16 a[156:157], v49 offset:24576
 ds_read_b64_tr_b16 a[158:159], v49 offset:25600
 s_waitcnt lgkmcnt(0)
 s_barrier
 s_load_dwordx2 s[12:13], s[0:1], 72
 s_lshl_b32 s21, s2, 2
 s_add_u32 s21, s21, s20
 s_mul_i32 s50, s21, 6400
 s_add_u32 s51, s50, 4096
 v_lshlrev_b32 v33, 4, v1
 s_mov_b32 s14, 819200
 v_mov_b32 v32, 76
 s_waitcnt lgkmcnt(0)
 v_and_b32 v4, 31, v1
 s_lshl_b32 s21, s20, 5
 v_add_u32 v36, s21, v4
 v_lshrrev_b32 v5, 5, v1
 v_mul_u32_u24 v6, 264, v36
 v_mul_u32_u24 v7, 40, v5
 s_mov_b32 s21, 114952
 v_add3_u32 v34, v6, v7, s21
 v_lshl_add_u32 v38, v5, 3, v34
 v_lshlrev_b32 v6, 5, v5
 v_sub_u32 v39, v34, v6
 v_lshlrev_b32 v35, 3, v1
 v_add_u32 v35, 114688, v35
 v_mov_b32 v37, 0xf149f2ca
 s_mul_i32 s21, s41, 165120
 s_mul_i32 s22, s42, 16512
 s_add_u32 s21, s21, s22
 v_lshl_add_u32 v7, v36, 4, s21
 v_mul_u32_u24 v6, 99072, v5
 v_add_u32 v29, v6, v7
 v_add_u32 v30, 33024, v29
 v_lshl_add_u32 v31, v5, 3, v7
 v_add_u32 v31, 66048, v31
 v_mov_b32 v8, 0
 v_mov_b32 v9, 0
 ds_write_b64 v35, v[8:9] offset:0
 ds_write_b64 v35, v[8:9] offset:512
 ds_write_b64 v35, v[8:9] offset:1024
 ds_write_b64 v35, v[8:9] offset:1536
 ds_write_b64 v35, v[8:9] offset:2048
 s_mul_i32 s24, s42, 1280
 s_mov_b32 s25, 327680
 s_mov_b32 s26, 8
 s_mov_b32 s27, 0
 s_mov_b32 s60, 0x3e64f92e
 s_mov_b32 s61, 0x3fb8aa3b
 s_mov_b32 s62, 0x05040100
 s_mov_b32 s63, 0x07060302
 v_cmp_le_u32 s[76:77], 0, v36
 v_cmp_le_u32 s[78:79], 1, v36
 v_cmp_le_u32 s[80:81], 2, v36
 v_cmp_le_u32 s[82:83], 3, v36
 v_cmp_le_u32 s[84:85], 4, v36
 v_cmp_le_u32 s[86:87], 5, v36
 v_cmp_le_u32 s[88:89], 6, v36
 v_cmp_le_u32 s[90:91], 7, v36
 v_and_b32 v6, 7, v2
 v_add_u32 v4, 0, v3
 v_xor_b32 v4, v4, v6
 v_lshlrev_b32 v4, 4, v4
 v_lshl_add_u32 v14, v2, 7, v4
 v_add_u32 v4, 4, v3
 v_xor_b32 v4, v4, v6
 v_lshlrev_b32 v4, 4, v4
 v_lshl_add_u32 v15, v2, 7, v4
 v_mul_u32_u24 v22, 264, v2
 v_mul_u32_u24 v4, 8, v3
 s_mul_i32 s21, s20, 64
 s_add_u32 s21, s21, 116800
 v_add3_u32 v22, v22, v4, s21
 v_lshlrev_b32 v4, 3, v3
 v_sub_u32 v16, v22, v4
 v_mov_b32 v9, 2731
 s_mov_b32 s33, 0
 s_mov_b32 s48, 0x80000000
 s_mov_b32 m0, s32
 s_nop 0
 buffer_load_dwordx4 v10, s[8:11], s30 offen offset:0 lds
 buffer_load_dwordx4 v11, s[8:11], s30 offen offset:1024 lds
 s_waitcnt vmcnt(18)
 s_barrier
 v_add_u32 v18, s33, v14
 v_add_u32 v19, s33, v15
 s_add_u32 s33, s33, 16384
 s_cmp_lt_u32 s33, 114688
 s_cselect_b32 s33, s33, 0
 ds_read_b128 v[160:163], v18 offset:0
 ds_read_b128 v[164:167], v18 offset:2048
 ds_read_b128 v[168:171], v18 offset:4096
 ds_read_b128 v[172:175], v18 offset:6144
 ds_read_b128 v[176:179], v18 offset:8192
 ds_read_b128 v[180:183], v18 offset:10240
 ds_read_b128 v[184:187], v18 offset:12288
 ds_read_b128 v[188:191], v18 offset:14336
 s_waitcnt lgkmcnt(0)
bf_blk_192:
 v_mfma_f32_16x16x32_bf16 v[64:67], a[0:3], v[160:163], 0
 ds_read_b128 v[192:195], v19 offset:0
 v_mfma_f32_16x16x32_bf16 v[68:71], a[4:7], v[160:163], 0
 v_add_u32 v18, s33, v14
 v_mfma_f32_16x16x32_bf16 v[72:75], a[0:3], v[164:167], 0
 ds_read_b128 v[196:199], v19 offset:2048
 v_mfma_f32_16x16x32_bf16 v[76:79], a[4:7], v[164:167], 0
 buffer_load_dwordx4 v12, s[8:11], s30 offen offset:2048 lds
 v_mfma_f32_16x16x32_bf16 v[80:83], a[0:3], v[168:171], 0
 ds_read_b128 v[200:203], v19 offset:4096
 v_mfma_f32_16x16x32_bf16 v[84:87], a[4:7], v[168:171], 0
 v_mfma_f32_16x16x32_bf16 v[88:91], a[0:3], v[172:175], 0
 ds_read_b128 v[204:207], v19 offset:6144
 v_mfma_f32_16x16x32_bf16 v[92:95], a[4:7], v[172:175], 0
 s_waitcnt lgkmcnt(14)
 v_mfma_f32_16x16x32_bf16 v[96:99], a[0:3], v[176:179], 0
 ds_read_b128 v[208:211], v19 offset:8192
 v_mfma_f32_16x16x32_bf16 v[100:103], a[4:7], v[176:179], 0
 v_mfma_f32_16x16x32_bf16 v[104:107], a[0:3], v[180:183], 0
 ds_read_b128 v[212:215], v19 offset:10240
 v_mfma_f32_16x16x32_bf16 v[108:111], a[4:7], v[180:183], 0
 buffer_load_dwordx4 v13, s[8:11], s30 offen offset:3072 lds
 v_mfma_f32_16x16x32_bf16 v[112:115], a[0:3], v[184:187], 0
 ds_read_b128 v[216:219], v19 offset:12288
 s_add_u32 s30, s30, 128
 v_mfma_f32_16x16x32_bf16 v[116:119], a[4:7], v[184:187], 0
 s_add_u32 m0, m0, 16384
 v_mfma_f32_16x16x32_bf16 v[120:123], a[0:3], v[188:191], 0
 ds_read_b128 v[220:223], v19 offset:14336
 v_mfma_f32_16x16x32_bf16 v[124:127], a[4:7], v[188:191], 0
 s_waitcnt vmcnt(16) lgkmcnt(4)
 s_barrier
 v_mfma_f32_16x16x32_bf16 v[64:67], a[8:11], v[192:195], v[64:67]
 ds_read_b128 v[160:163], v18 offset:0
 v_mfma_f32_16x16x32_bf16 v[68:71], a[12:15], v[192:195], v[68:71]
 s_cmp_lt_u32 m0, s46
 s_cselect_b32 m0, m0, s47
 v_mfma_f32_16x16x32_bf16 v[72:75], a[8:11], v[196:199], v[72:75]
 ds_read_b128 v[164:167], v18 offset:2048
 v_add_u32 v19, s33, v15
 v_mfma_f32_16x16x32_bf16 v[76:79], a[12:15], v[196:199], v[76:79]
 buffer_load_dwordx4 v10, s[8:11], s30 offen offset:0 lds
 v_mfma_f32_16x16x32_bf16 v[80:83], a[8:11], v[200:203], v[80:83]
 ds_read_b128 v[168:171], v18 offset:4096
 s_add_u32 s33, s33, 16384
 v_mfma_f32_16x16x32_bf16 v[84:87], a[12:15], v[200:203], v[84:87]
 s_cmp_lt_u32 s33, 114688
 s_cselect_b32 s33, s33, 0
 v_mfma_f32_16x16x32_bf16 v[88:91], a[8:11], v[204:207], v[88:91]
 ds_read_b128 v[172:175], v18 offset:6144
 v_mfma_f32_16x16x32_bf16 v[92:95], a[12:15], v[204:207], v[92:95]
 s_waitcnt lgkmcnt(4)
 v_mfma_f32_16x16x32_bf16 v[96:99], a[8:11], v[208:211], v[96:99]
 ds_read_b128 v[176:179], v18 offset:8192
 v_mfma_f32_16x16x32_bf16 v[100:103], a[12:15], v[208:211], v[100:103]
 v_mfma_f32_16x16x32_bf16 v[104:107], a[8:11], v[212:215], v[104:107]
 ds_read_b128 v[180:183], v18 offset:10240
 v_mfma_f32_16x16x32_bf16 v[108:111], a[12:15], v[212:215], v[108:111]
 buffer_load_dwordx4 v11, s[8:11], s30 offen offset:1024 lds
 v_mfma_f32_16x16x32_bf16 v[112:115], a[8:11], v[216:219], v[112:115]
 ds_read_b128 v[184:187], v18 offset:12288
 v_mfma_f32_16x16x32_bf16 v[116:119], a[12:15], v[216:219], v[116:119]
 v_mfma_f32_16x16x32_bf16 v[120:123], a[8:11], v[220:223], v[120:123]
 ds_read_b128 v[188:191], v18 offset:14336
 v_mfma_f32_16x16x32_bf16 v[124:127], a[12:15], v[220:223], v[124:127]
 s_waitcnt lgkmcnt(4)
 v_mfma_f32_16x16x32_bf16 v[64:67], a[16:19], v[160:163], v[64:67]
 ds_read_b128 v[192:195], v19 offset:0
 v_mfma_f32_16x16x32_bf16 v[68:71], a[20:23], v[160:163], v[68:71]
 v_add_u32 v18, s33, v14
 v_mfma_f32_16x16x32_bf16 v[72:75], a[16:19], v[164:167], v[72:75]
 ds_read_b128 v[196:199], v19 offset:2048
 v_mfma_f32_16x16x32_bf16 v[76:79], a[20:23], v[164:167], v[76:79]
 buffer_load_dwordx4 v12, s[8:11], s30 offen offset:2048 lds
 v_mfma_f32_16x16x32_bf16 v[80:83], a[16:19], v[168:171], v[80:83]
 ds_read_b128 v[200:203], v19 offset:4096
 v_mfma_f32_16x16x32_bf16 v[84:87], a[20:23], v[168:171], v[84:87]
 v_mfma_f32_16x16x32_bf16 v[88:91], a[16:19], v[172:175], v[88:91]
 ds_read_b128 v[204:207], v19 offset:6144
 v_mfma_f32_16x16x32_bf16 v[92:95], a[20:23], v[172:175], v[92:95]
 s_waitcnt lgkmcnt(4)
 v_mfma_f32_16x16x32_bf16 v[96:99], a[16:19], v[176:179], v[96:99]
 ds_read_b128 v[208:211], v19 offset:8192
 v_mfma_f32_16x16x32_bf16 v[100:103], a[20:23], v[176:179], v[100:103]
 v_mfma_f32_16x16x32_bf16 v[104:107], a[16:19], v[180:183], v[104:107]
 ds_read_b128 v[212:215], v19 offset:10240
 v_mfma_f32_16x16x32_bf16 v[108:111], a[20:23], v[180:183], v[108:111]
 buffer_load_dwordx4 v13, s[8:11], s30 offen offset:3072 lds
 v_mfma_f32_16x16x32_bf16 v[112:115], a[16:19], v[184:187], v[112:115]
 ds_read_b128 v[216:219], v19 offset:12288
 s_add_u32 s30, s30, 128
 v_mfma_f32_16x16x32_bf16 v[116:119], a[20:23], v[184:187], v[116:119]
 s_add_u32 m0, m0, 16384
 v_mfma_f32_16x16x32_bf16 v[120:123], a[16:19], v[188:191], v[120:123]
 ds_read_b128 v[220:223], v19 offset:14336
 v_mfma_f32_16x16x32_bf16 v[124:127], a[20:23], v[188:191], v[124:127]
 s_waitcnt vmcnt(16) lgkmcnt(4)
 s_barrier
 v_mfma_f32_16x16x32_bf16 v[64:67], a[24:27], v[192:195], v[64:67]
 ds_read_b128 v[160:163], v18 offset:0
 v_mfma_f32_16x16x32_bf16 v[68:71], a[28:31], v[192:195], v[68:71]
 s_cmp_lt_u32 m0, s46
 s_cselect_b32 m0, m0, s47
 v_mfma_f32_16x16x32_bf16 v[72:75], a[24:27], v[196:199], v[72:75]
 ds_read_b128 v[164:167], v18 offset:2048
 v_add_u32 v19, s33, v15
 v_mfma_f32_16x16x32_bf16 v[76:79], a[28:31], v[196:199], v[76:79]
 buffer_load_dwordx4 v10, s[8:11], s30 offen offset:0 lds
 v_mfma_f32_16x16x32_bf16 v[80:83], a[24:27], v[200:203], v[80:83]
 ds_read_b128 v[168:171], v18 offset:4096
 s_add_u32 s33, s33, 16384
 v_mfma_f32_16x16x32_bf16 v[84:87], a[28:31], v[200:203], v[84:87]
 s_cmp_lt_u32 s33, 114688
 s_cselect_b32 s33, s33, 0
 v_mfma_f32_16x16x32_bf16 v[88:91], a[24:27], v[204:207], v[88:91]
 ds_read_b128 v[172:175], v18 offset:6144
 v_mfma_f32_16x16x32_bf16 v[92:95], a[28:31], v[204:207], v[92:95]
 s_waitcnt lgkmcnt(4)
 v_mfma_f32_16x16x32_bf16 v[96:99], a[24:27], v[208:211], v[96:99]
 ds_read_b128 v[176:179], v18 offset:8192
 v_mfma_f32_16x16x32_bf16 v[100:103], a[28:31], v[208:211], v[100:103]
 v_mfma_f32_16x16x32_bf16 v[104:107], a[24:27], v[212:215], v[104:107]
 ds_read_b128 v[180:183], v18 offset:10240
 v_mfma_f32_16x16x32_bf16 v[108:111], a[28:31], v[212:215], v[108:111]
 buffer_load_dwordx4 v11, s[8:11], s30 offen offset:1024 lds
 v_mfma_f32_16x16x32_bf16 v[112:115], a[24:27], v[216:219], v[112:115]
 ds_read_b128 v[184:187], v18 offset:12288
 v_mfma_f32_16x16x32_bf16 v[116:119], a[28:31], v[216:219], v[116:119]
 v_mfma_f32_16x16x32_bf16 v[120:123], a[24:27], v[220:223], v[120:123]
 ds_read_b128 v[188:191], v18 offset:14336
 v_mfma_f32_16x16x32_bf16 v[124:127], a[28:31], v[220:223], v[124:127]
 s_waitcnt lgkmcnt(4)
 v_mfma_f32_16x16x32_bf16 v[64:67], a[32:35], v[160:163], v[64:67]
 ds_read_b128 v[192:195], v19 offset:0
 v_mfma_f32_16x16x32_bf16 v[68:71], a[36:39], v[160:163], v[68:71]
 v_add_u32 v18, s33, v14
 v_mfma_f32_16x16x32_bf16 v[72:75], a[32:35], v[164:167], v[72:75]
 ds_read_b128 v[196:199], v19 offset:2048
 v_mfma_f32_16x16x32_bf16 v[76:79], a[36:39], v[164:167], v[76:79]
 buffer_load_dwordx4 v12, s[8:11], s30 offen offset:2048 lds
 v_mfma_f32_16x16x32_bf16 v[80:83], a[32:35], v[168:171], v[80:83]
 ds_read_b128 v[200:203], v19 offset:4096
 v_mfma_f32_16x16x32_bf16 v[84:87], a[36:39], v[168:171], v[84:87]
 v_mfma_f32_16x16x32_bf16 v[88:91], a[32:35], v[172:175], v[88:91]
 ds_read_b128 v[204:207], v19 offset:6144
 v_mfma_f32_16x16x32_bf16 v[92:95], a[36:39], v[172:175], v[92:95]
 s_waitcnt lgkmcnt(4)
 v_mfma_f32_16x16x32_bf16 v[96:99], a[32:35], v[176:179], v[96:99]
 ds_read_b128 v[208:211], v19 offset:8192
 v_mfma_f32_16x16x32_bf16 v[100:103], a[36:39], v[176:179], v[100:103]
 v_mfma_f32_16x16x32_bf16 v[104:107], a[32:35], v[180:183], v[104:107]
 ds_read_b128 v[212:215], v19 offset:10240
 v_mfma_f32_16x16x32_bf16 v[108:111], a[36:39], v[180:183], v[108:111]
 buffer_load_dwordx4 v13, s[8:11], s30 offen offset:3072 lds
 v_mfma_f32_16x16x32_bf16 v[112:115], a[32:35], v[184:187], v[112:115]
 ds_read_b128 v[216:219], v19 offset:12288
 s_add_u32 s30, s30, 128
 v_mfma_f32_16x16x32_bf16 v[116:119], a[36:39], v[184:187], v[116:119]
 s_add_u32 m0, m0, 16384
 v_mfma_f32_16x16x32_bf16 v[120:123], a[32:35], v[188:191], v[120:123]
 ds_read_b128 v[220:223], v19 offset:14336
 v_mfma_f32_16x16x32_bf16 v[124:127], a[36:39], v[188:191], v[124:127]
 s_waitcnt vmcnt(16) lgkmcnt(4)
 s_barrier
 v_mfma_f32_16x16x32_bf16 v[64:67], a[40:43], v[192:195], v[64:67]
 ds_read_b128 v[160:163], v18 offset:0
 v_mfma_f32_16x16x32_bf16 v[68:71], a[44:47], v[192:195], v[68:71]
 s_cmp_lt_u32 m0, s46
 s_cselect_b32 m0, m0, s47
 v_mfma_f32_16x16x32_bf16 v[72:75], a[40:43], v[196:199], v[72:75]
 ds_read_b128 v[164:167], v18 offset:2048
 v_add_u32 v19, s33, v15
 v_mfma_f32_16x16x32_bf16 v[76:79], a[44:47], v[196:199], v[76:79]
 buffer_load_dwordx4 v10, s[8:11], s30 offen offset:0 lds
 v_mfma_f32_16x16x32_bf16 v[80:83], a[40:43], v[200:203], v[80:83]
 ds_read_b128 v[168:171], v18 offset:4096
 s_add_u32 s33, s33, 16384
 v_mfma_f32_16x16x32_bf16 v[84:87], a[44:47], v[200:203], v[84:87]
 s_cmp_lt_u32 s33, 114688
 s_cselect_b32 s33, s33, 0
 v_mfma_f32_16x16x32_bf16 v[88:91], a[40:43], v[204:207], v[88:91]
 ds_read_b128 v[172:175], v18 offset:6144
 v_mfma_f32_16x16x32_bf16 v[92:95], a[44:47], v[204:207], v[92:95]
 s_waitcnt lgkmcnt(4)
 v_mfma_f32_16x16x32_bf16 v[96:99], a[40:43], v[208:211], v[96:99]
 ds_read_b128 v[176:179], v18 offset:8192
 v_mfma_f32_16x16x32_bf16 v[100:103], a[44:47], v[208:211], v[100:103]
 v_mfma_f32_16x16x32_bf16 v[104:107], a[40:43], v[212:215], v[104:107]
 ds_read_b128 v[180:183], v18 offset:10240
 v_mfma_f32_16x16x32_bf16 v[108:111], a[44:47], v[212:215], v[108:111]
 buffer_load_dwordx4 v11, s[8:11], s30 offen offset:1024 lds
 v_mfma_f32_16x16x32_bf16 v[112:115], a[40:43], v[216:219], v[112:115]
 ds_read_b128 v[184:187], v18 offset:12288
 v_mfma_f32_16x16x32_bf16 v[116:119], a[44:47], v[216:219], v[116:119]
 v_mfma_f32_16x16x32_bf16 v[120:123], a[40:43], v[220:223], v[120:123]
 ds_read_b128 v[188:191], v18 offset:14336
 v_mfma_f32_16x16x32_bf16 v[124:127], a[44:47], v[220:223], v[124:127]
 s_waitcnt lgkmcnt(4)
 v_mfma_f32_16x16x32_bf16 v[64:67], a[48:51], v[160:163], v[64:67]
 ds_read_b128 v[192:195], v19 offset:0
 v_mfma_f32_16x16x32_bf16 v[68:71], a[52:55], v[160:163], v[68:71]
 v_add_u32 v18, s33, v14
 v_mfma_f32_16x16x32_bf16 v[72:75], a[48:51], v[164:167], v[72:75]
 ds_read_b128 v[196:199], v19 offset:2048
 v_mfma_f32_16x16x32_bf16 v[76:79], a[52:55], v[164:167], v[76:79]
 buffer_load_dwordx4 v12, s[8:11], s30 offen offset:2048 lds
 v_mfma_f32_16x16x32_bf16 v[80:83], a[48:51], v[168:171], v[80:83]
 ds_read_b128 v[200:203], v19 offset:4096
 v_mfma_f32_16x16x32_bf16 v[84:87], a[52:55], v[168:171], v[84:87]
 v_mfma_f32_16x16x32_bf16 v[88:91], a[48:51], v[172:175], v[88:91]
 ds_read_b128 v[204:207], v19 offset:6144
 v_mfma_f32_16x16x32_bf16 v[92:95], a[52:55], v[172:175], v[92:95]
 s_waitcnt lgkmcnt(4)
 v_mfma_f32_16x16x32_bf16 v[96:99], a[48:51], v[176:179], v[96:99]
 ds_read_b128 v[208:211], v19 offset:8192
 v_mfma_f32_16x16x32_bf16 v[100:103], a[52:55], v[176:179], v[100:103]
 v_mfma_f32_16x16x32_bf16 v[104:107], a[48:51], v[180:183], v[104:107]
 ds_read_b128 v[212:215], v19 offset:10240
 v_mfma_f32_16x16x32_bf16 v[108:111], a[52:55], v[180:183], v[108:111]
 buffer_load_dwordx4 v13, s[8:11], s30 offen offset:3072 lds
 v_mfma_f32_16x16x32_bf16 v[112:115], a[48:51], v[184:187], v[112:115]
 ds_read_b128 v[216:219], v19 offset:12288
 s_add_u32 s30, s30, 128
 v_mfma_f32_16x16x32_bf16 v[116:119], a[52:55], v[184:187], v[116:119]
 s_add_u32 m0, m0, 16384
 v_mfma_f32_16x16x32_bf16 v[120:123], a[48:51], v[188:191], v[120:123]
 ds_read_b128 v[220:223], v19 offset:14336
 v_mfma_f32_16x16x32_bf16 v[124:127], a[52:55], v[188:191], v[124:127]
 s_waitcnt vmcnt(16) lgkmcnt(4)
 s_barrier
 v_mfma_f32_16x16x32_bf16 v[64:67], a[56:59], v[192:195], v[64:67]
 ds_read_b128 v[160:163], v18 offset:0
 v_mfma_f32_16x16x32_bf16 v[68:71], a[60:63], v[192:195], v[68:71]
 s_cmp_lt_u32 m0, s46
 s_cselect_b32 m0, m0, s47
 v_mfma_f32_16x16x32_bf16 v[72:75], a[56:59], v[196:199], v[72:75]
 ds_read_b128 v[164:167], v18 offset:2048
 v_add_u32 v19, s33, v15
 v_mfma_f32_16x16x32_bf16 v[76:79], a[60:63], v[196:199], v[76:79]
 buffer_load_dwordx4 v10, s[8:11], s30 offen offset:0 lds
 v_mfma_f32_16x16x32_bf16 v[80:83], a[56:59], v[200:203], v[80:83]
 ds_read_b128 v[168:171], v18 offset:4096
 s_add_u32 s33, s33, 16384
 v_mfma_f32_16x16x32_bf16 v[84:87], a[60:63], v[200:203], v[84:87]
 s_cmp_lt_u32 s33, 114688
 s_cselect_b32 s33, s33, 0
 v_mfma_f32_16x16x32_bf16 v[88:91], a[56:59], v[204:207], v[88:91]
 ds_read_b128 v[172:175], v18 offset:6144
 v_mfma_f32_16x16x32_bf16 v[92:95], a[60:63], v[204:207], v[92:95]
 s_waitcnt lgkmcnt(4)
 v_mfma_f32_16x16x32_bf16 v[96:99], a[56:59], v[208:211], v[96:99]
 ds_read_b128 v[176:179], v18 offset:8192
 v_mfma_f32_16x16x32_bf16 v[100:103], a[60:63], v[208:211], v[100:103]
 v_mfma_f32_16x16x32_bf16 v[104:107], a[56:59], v[212:215], v[104:107]
 ds_read_b128 v[180:183], v18 offset:10240
 v_mfma_f32_16x16x32_bf16 v[108:111], a[60:63], v[212:215], v[108:111]
 buffer_load_dwordx4 v11, s[8:11], s30 offen offset:1024 lds
 v_mfma_f32_16x16x32_bf16 v[112:115], a[56:59], v[216:219], v[112:115]
 ds_read_b128 v[184:187], v18 offset:12288
 v_mfma_f32_16x16x32_bf16 v[116:119], a[60:63], v[216:219], v[116:119]
 v_mfma_f32_16x16x32_bf16 v[120:123], a[56:59], v[220:223], v[120:123]
 ds_read_b128 v[188:191], v18 offset:14336
 v_mfma_f32_16x16x32_bf16 v[124:127], a[60:63], v[220:223], v[124:127]
 s_waitcnt lgkmcnt(4)
 v_mfma_f32_16x16x32_bf16 v[64:67], a[64:67], v[160:163], v[64:67]
 ds_read_b128 v[192:195], v19 offset:0
 v_mfma_f32_16x16x32_bf16 v[68:71], a[68:71], v[160:163], v[68:71]
 v_add_u32 v18, s33, v14
 v_mfma_f32_16x16x32_bf16 v[72:75], a[64:67], v[164:167], v[72:75]
 ds_read_b128 v[196:199], v19 offset:2048
 v_mfma_f32_16x16x32_bf16 v[76:79], a[68:71], v[164:167], v[76:79]
 buffer_load_dwordx4 v12, s[8:11], s30 offen offset:2048 lds
 v_mfma_f32_16x16x32_bf16 v[80:83], a[64:67], v[168:171], v[80:83]
 ds_read_b128 v[200:203], v19 offset:4096
 v_mfma_f32_16x16x32_bf16 v[84:87], a[68:71], v[168:171], v[84:87]
 v_mfma_f32_16x16x32_bf16 v[88:91], a[64:67], v[172:175], v[88:91]
 ds_read_b128 v[204:207], v19 offset:6144
 v_mfma_f32_16x16x32_bf16 v[92:95], a[68:71], v[172:175], v[92:95]
 s_waitcnt lgkmcnt(4)
 v_mfma_f32_16x16x32_bf16 v[96:99], a[64:67], v[176:179], v[96:99]
 ds_read_b128 v[208:211], v19 offset:8192
 v_mfma_f32_16x16x32_bf16 v[100:103], a[68:71], v[176:179], v[100:103]
 v_mfma_f32_16x16x32_bf16 v[104:107], a[64:67], v[180:183], v[104:107]
 ds_read_b128 v[212:215], v19 offset:10240
 v_mfma_f32_16x16x32_bf16 v[108:111], a[68:71], v[180:183], v[108:111]
 buffer_load_dwordx4 v13, s[8:11], s30 offen offset:3072 lds
 v_mfma_f32_16x16x32_bf16 v[112:115], a[64:67], v[184:187], v[112:115]
 ds_read_b128 v[216:219], v19 offset:12288
 s_add_u32 s30, s30, s25
 v_mfma_f32_16x16x32_bf16 v[116:119], a[68:71], v[184:187], v[116:119]
 s_sub_u32 s30, s30, 1152
 s_add_u32 m0, m0, 16384
 v_mfma_f32_16x16x32_bf16 v[120:123], a[64:67], v[188:191], v[120:123]
 ds_read_b128 v[220:223], v19 offset:14336
 v_mfma_f32_16x16x32_bf16 v[124:127], a[68:71], v[188:191], v[124:127]
 s_waitcnt vmcnt(16) lgkmcnt(4)
 s_barrier
 v_mfma_f32_16x16x32_bf16 v[64:67], a[72:75], v[192:195], v[64:67]
 ds_read_b128 v[160:163], v18 offset:0
 v_mfma_f32_16x16x32_bf16 v[68:71], a[76:79], v[192:195], v[68:71]
 s_cmp_lt_u32 m0, s46
 s_cselect_b32 m0, m0, s47
 v_mfma_f32_16x16x32_bf16 v[72:75], a[72:75], v[196:199], v[72:75]
 ds_read_b128 v[164:167], v18 offset:2048
 v_add_u32 v19, s33, v15
 v_mfma_f32_16x16x32_bf16 v[76:79], a[76:79], v[196:199], v[76:79]
 buffer_load_dwordx4 v10, s[8:11], s30 offen offset:0 lds
 v_mfma_f32_16x16x32_bf16 v[80:83], a[72:75], v[200:203], v[80:83]
 ds_read_b128 v[168:171], v18 offset:4096
 s_add_u32 s33, s33, 16384
 v_mfma_f32_16x16x32_bf16 v[84:87], a[76:79], v[200:203], v[84:87]
 s_cmp_lt_u32 s33, 114688
 s_cselect_b32 s33, s33, 0
 v_mfma_f32_16x16x32_bf16 v[88:91], a[72:75], v[204:207], v[88:91]
 ds_read_b128 v[172:175], v18 offset:6144
 v_mfma_f32_16x16x32_bf16 v[92:95], a[76:79], v[204:207], v[92:95]
 s_waitcnt lgkmcnt(4)
 v_mfma_f32_16x16x32_bf16 v[96:99], a[72:75], v[208:211], v[96:99]
 ds_read_b128 v[176:179], v18 offset:8192
 v_mfma_f32_16x16x32_bf16 v[100:103], a[76:79], v[208:211], v[100:103]
 v_mfma_f32_16x16x32_bf16 v[104:107], a[72:75], v[212:215], v[104:107]
 ds_read_b128 v[180:183], v18 offset:10240
 v_mfma_f32_16x16x32_bf16 v[108:111], a[76:79], v[212:215], v[108:111]
 buffer_load_dwordx4 v11, s[8:11], s30 offen offset:1024 lds
 v_mfma_f32_16x16x32_bf16 v[112:115], a[72:75], v[216:219], v[112:115]
 ds_read_b128 v[184:187], v18 offset:12288
 v_mfma_f32_16x16x32_bf16 v[116:119], a[76:79], v[216:219], v[116:119]
 v_mfma_f32_16x16x32_bf16 v[120:123], a[72:75], v[220:223], v[120:123]
 ds_read_b128 v[188:191], v18 offset:14336
 v_mfma_f32_16x16x32_bf16 v[124:127], a[76:79], v[220:223], v[124:127]
 s_waitcnt lgkmcnt(4)
 v_mfma_f32_16x16x32_bf16 v[64:67], a[80:83], v[160:163], v[64:67]
 ds_read_b128 v[192:195], v19 offset:0
 v_mfma_f32_16x16x32_bf16 v[68:71], a[84:87], v[160:163], v[68:71]
 v_add_u32 v18, s33, v14
 v_mfma_f32_16x16x32_bf16 v[72:75], a[80:83], v[164:167], v[72:75]
 ds_read_b128 v[196:199], v19 offset:2048
 v_mfma_f32_16x16x32_bf16 v[76:79], a[84:87], v[164:167], v[76:79]
 buffer_load_dwordx4 v12, s[8:11], s30 offen offset:2048 lds
 v_mfma_f32_16x16x32_bf16 v[80:83], a[80:83], v[168:171], v[80:83]
 ds_read_b128 v[200:203], v19 offset:4096
 v_mfma_f32_16x16x32_bf16 v[84:87], a[84:87], v[168:171], v[84:87]
 v_mfma_f32_16x16x32_bf16 v[88:91], a[80:83], v[172:175], v[88:91]
 ds_read_b128 v[204:207], v19 offset:6144
 v_mfma_f32_16x16x32_bf16 v[92:95], a[84:87], v[172:175], v[92:95]
 s_waitcnt lgkmcnt(4)
 v_mfma_f32_16x16x32_bf16 v[96:99], a[80:83], v[176:179], v[96:99]
 ds_read_b128 v[208:211], v19 offset:8192
 v_mfma_f32_16x16x32_bf16 v[100:103], a[84:87], v[176:179], v[100:103]
 v_mfma_f32_16x16x32_bf16 v[104:107], a[80:83], v[180:183], v[104:107]
 ds_read_b128 v[212:215], v19 offset:10240
 v_mfma_f32_16x16x32_bf16 v[108:111], a[84:87], v[180:183], v[108:111]
 buffer_load_dwordx4 v13, s[8:11], s30 offen offset:3072 lds
 v_mfma_f32_16x16x32_bf16 v[112:115], a[80:83], v[184:187], v[112:115]
 ds_read_b128 v[216:219], v19 offset:12288
 s_add_u32 s30, s30, 128
 v_mfma_f32_16x16x32_bf16 v[116:119], a[84:87], v[184:187], v[116:119]
 s_add_u32 m0, m0, 16384
 v_mfma_f32_16x16x32_bf16 v[120:123], a[80:83], v[188:191], v[120:123]
 ds_read_b128 v[220:223], v19 offset:14336
 v_mfma_f32_16x16x32_bf16 v[124:127], a[84:87], v[188:191], v[124:127]
 s_waitcnt vmcnt(16) lgkmcnt(4)
 s_barrier
 v_mfma_f32_16x16x32_bf16 v[64:67], a[88:91], v[192:195], v[64:67]
 ds_read_b128 v[160:163], v18 offset:0
 v_mfma_f32_16x16x32_bf16 v[68:71], a[92:95], v[192:195], v[68:71]
 s_cmp_lt_u32 m0, s46
 s_cselect_b32 m0, m0, s47
 v_mfma_f32_16x16x32_bf16 v[72:75], a[88:91], v[196:199], v[72:75]
 ds_read_b128 v[164:167], v18 offset:2048
 v_add_u32 v19, s33, v15
 v_mfma_f32_16x16x32_bf16 v[76:79], a[92:95], v[196:199], v[76:79]
 buffer_load_dwordx4 v10, s[8:11], s30 offen offset:0 lds
 v_mfma_f32_16x16x32_bf16 v[80:83], a[88:91], v[200:203], v[80:83]
 ds_read_b128 v[168:171], v18 offset:4096
 s_add_u32 s33, s33, 16384
 v_mfma_f32_16x16x32_bf16 v[84:87], a[92:95], v[200:203], v[84:87]
 s_cmp_lt_u32 s33, 114688
 s_cselect_b32 s33, s33, 0
 v_mfma_f32_16x16x32_bf16 v[88:91], a[88:91], v[204:207], v[88:91]
 ds_read_b128 v[172:175], v18 offset:6144
 v_mfma_f32_16x16x32_bf16 v[92:95], a[92:95], v[204:207], v[92:95]
 s_waitcnt lgkmcnt(4)
 v_mfma_f32_16x16x32_bf16 v[96:99], a[88:91], v[208:211], v[96:99]
 ds_read_b128 v[176:179], v18 offset:8192
 v_mfma_f32_16x16x32_bf16 v[100:103], a[92:95], v[208:211], v[100:103]
 v_mfma_f32_16x16x32_bf16 v[104:107], a[88:91], v[212:215], v[104:107]
 ds_read_b128 v[180:183], v18 offset:10240
 v_mfma_f32_16x16x32_bf16 v[108:111], a[92:95], v[212:215], v[108:111]
 buffer_load_dwordx4 v11, s[8:11], s30 offen offset:1024 lds
 v_mfma_f32_16x16x32_bf16 v[112:115], a[88:91], v[216:219], v[112:115]
 ds_read_b128 v[184:187], v18 offset:12288
 v_mfma_f32_16x16x32_bf16 v[116:119], a[92:95], v[216:219], v[116:119]
 v_mfma_f32_16x16x32_bf16 v[120:123], a[88:91], v[220:223], v[120:123]
 ds_read_b128 v[188:191], v18 offset:14336
 v_mfma_f32_16x16x32_bf16 v[124:127], a[92:95], v[220:223], v[124:127]
 s_waitcnt lgkmcnt(4)
 v_mfma_f32_16x16x32_bf16 v[64:67], a[96:99], v[160:163], v[64:67]
 ds_read_b128 v[192:195], v19 offset:0
 v_mfma_f32_16x16x32_bf16 v[68:71], a[100:103], v[160:163], v[68:71]
 v_add_u32 v18, s33, v14
 v_mfma_f32_16x16x32_bf16 v[72:75], a[96:99], v[164:167], v[72:75]
 ds_read_b128 v[196:199], v19 offset:2048
 v_mfma_f32_16x16x32_bf16 v[76:79], a[100:103], v[164:167], v[76:79]
 buffer_load_dwordx4 v12, s[8:11], s30 offen offset:2048 lds
 v_mfma_f32_16x16x32_bf16 v[80:83], a[96:99], v[168:171], v[80:83]
 ds_read_b128 v[200:203], v19 offset:4096
 v_mfma_f32_16x16x32_bf16 v[84:87], a[100:103], v[168:171], v[84:87]
 v_mfma_f32_16x16x32_bf16 v[88:91], a[96:99], v[172:175], v[88:91]
 ds_read_b128 v[204:207], v19 offset:6144
 v_mfma_f32_16x16x32_bf16 v[92:95], a[100:103], v[172:175], v[92:95]
 s_waitcnt lgkmcnt(4)
 v_mfma_f32_16x16x32_bf16 v[96:99], a[96:99], v[176:179], v[96:99]
 ds_read_b128 v[208:211], v19 offset:8192
 v_mfma_f32_16x16x32_bf16 v[100:103], a[100:103], v[176:179], v[100:103]
 v_mfma_f32_16x16x32_bf16 v[104:107], a[96:99], v[180:183], v[104:107]
 ds_read_b128 v[212:215], v19 offset:10240
 v_mfma_f32_16x16x32_bf16 v[108:111], a[100:103], v[180:183], v[108:111]
 buffer_load_dwordx4 v13, s[8:11], s30 offen offset:3072 lds
 v_mfma_f32_16x16x32_bf16 v[112:115], a[96:99], v[184:187], v[112:115]
 ds_read_b128 v[216:219], v19 offset:12288
 s_add_u32 s30, s30, 128
 v_mfma_f32_16x16x32_bf16 v[116:119], a[100:103], v[184:187], v[116:119]
 s_add_u32 m0, m0, 16384
 v_mfma_f32_16x16x32_bf16 v[120:123], a[96:99], v[188:191], v[120:123]
 ds_read_b128 v[220:223], v19 offset:14336
 v_mfma_f32_16x16x32_bf16 v[124:127], a[100:103], v[188:191], v[124:127]
 s_waitcnt vmcnt(16) lgkmcnt(4)
 s_barrier
 v_mfma_f32_16x16x32_bf16 v[64:67], a[104:107], v[192:195], v[64:67]
 ds_read_b128 v[160:163], v18 offset:0
 v_mfma_f32_16x16x32_bf16 v[68:71], a[108:111], v[192:195], v[68:71]
 s_cmp_lt_u32 m0, s46
 s_cselect_b32 m0, m0, s47
 v_mfma_f32_16x16x32_bf16 v[72:75], a[104:107], v[196:199], v[72:75]
 ds_read_b128 v[164:167], v18 offset:2048
 v_add_u32 v19, s33, v15
 v_mfma_f32_16x16x32_bf16 v[76:79], a[108:111], v[196:199], v[76:79]
 buffer_load_dwordx4 v10, s[8:11], s30 offen offset:0 lds
 v_mfma_f32_16x16x32_bf16 v[80:83], a[104:107], v[200:203], v[80:83]
 ds_read_b128 v[168:171], v18 offset:4096
 s_add_u32 s33, s33, 16384
 v_mfma_f32_16x16x32_bf16 v[84:87], a[108:111], v[200:203], v[84:87]
 s_cmp_lt_u32 s33, 114688
 s_cselect_b32 s33, s33, 0
 v_mfma_f32_16x16x32_bf16 v[88:91], a[104:107], v[204:207], v[88:91]
 ds_read_b128 v[172:175], v18 offset:6144
 v_mfma_f32_16x16x32_bf16 v[92:95], a[108:111], v[204:207], v[92:95]
 s_waitcnt lgkmcnt(4)
 v_mfma_f32_16x16x32_bf16 v[96:99], a[104:107], v[208:211], v[96:99]
 ds_read_b128 v[176:179], v18 offset:8192
 v_mfma_f32_16x16x32_bf16 v[100:103], a[108:111], v[208:211], v[100:103]
 v_mfma_f32_16x16x32_bf16 v[104:107], a[104:107], v[212:215], v[104:107]
 ds_read_b128 v[180:183], v18 offset:10240
 v_mfma_f32_16x16x32_bf16 v[108:111], a[108:111], v[212:215], v[108:111]
 buffer_load_dwordx4 v11, s[8:11], s30 offen offset:1024 lds
 v_mfma_f32_16x16x32_bf16 v[112:115], a[104:107], v[216:219], v[112:115]
 ds_read_b128 v[184:187], v18 offset:12288
 v_mfma_f32_16x16x32_bf16 v[116:119], a[108:111], v[216:219], v[116:119]
 v_mfma_f32_16x16x32_bf16 v[120:123], a[104:107], v[220:223], v[120:123]
 ds_read_b128 v[188:191], v18 offset:14336
 v_mfma_f32_16x16x32_bf16 v[124:127], a[108:111], v[220:223], v[124:127]
 s_waitcnt lgkmcnt(4)
 v_mfma_f32_16x16x32_bf16 v[64:67], a[112:115], v[160:163], v[64:67]
 ds_read_b128 v[192:195], v19 offset:0
 v_mfma_f32_16x16x32_bf16 v[68:71], a[116:119], v[160:163], v[68:71]
 v_add_u32 v18, s33, v14
 v_mfma_f32_16x16x32_bf16 v[72:75], a[112:115], v[164:167], v[72:75]
 ds_read_b128 v[196:199], v19 offset:2048
 v_mfma_f32_16x16x32_bf16 v[76:79], a[116:119], v[164:167], v[76:79]
 buffer_load_dwordx4 v12, s[8:11], s30 offen offset:2048 lds
 v_mfma_f32_16x16x32_bf16 v[80:83], a[112:115], v[168:171], v[80:83]
 ds_read_b128 v[200:203], v19 offset:4096
 v_mfma_f32_16x16x32_bf16 v[84:87], a[116:119], v[168:171], v[84:87]
 v_mfma_f32_16x16x32_bf16 v[88:91], a[112:115], v[172:175], v[88:91]
 ds_read_b128 v[204:207], v19 offset:6144
 v_mfma_f32_16x16x32_bf16 v[92:95], a[116:119], v[172:175], v[92:95]
 s_waitcnt lgkmcnt(4)
 v_mfma_f32_16x16x32_bf16 v[96:99], a[112:115], v[176:179], v[96:99]
 ds_read_b128 v[208:211], v19 offset:8192
 v_mfma_f32_16x16x32_bf16 v[100:103], a[116:119], v[176:179], v[100:103]
 v_mfma_f32_16x16x32_bf16 v[104:107], a[112:115], v[180:183], v[104:107]
 ds_read_b128 v[212:215], v19 offset:10240
 v_mfma_f32_16x16x32_bf16 v[108:111], a[116:119], v[180:183], v[108:111]
 buffer_load_dwordx4 v13, s[8:11], s30 offen offset:3072 lds
 v_mfma_f32_16x16x32_bf16 v[112:115], a[112:115], v[184:187], v[112:115]
 ds_read_b128 v[216:219], v19 offset:12288
 s_add_u32 s30, s30, 128
 v_mfma_f32_16x16x32_bf16 v[116:119], a[116:119], v[184:187], v[116:119]
 s_add_u32 m0, m0, 16384
 v_mfma_f32_16x16x32_bf16 v[120:123], a[112:115], v[188:191], v[120:123]
 ds_read_b128 v[220:223], v19 offset:14336
 v_mfma_f32_16x16x32_bf16 v[124:127], a[116:119], v[188:191], v[124:127]
 s_waitcnt vmcnt(16) lgkmcnt(4)
 s_barrier
 v_mfma_f32_16x16x32_bf16 v[64:67], a[120:123], v[192:195], v[64:67]
 ds_read_b128 v[160:163], v18 offset:0
 v_mfma_f32_16x16x32_bf16 v[68:71], a[124:127], v[192:195], v[68:71]
 s_cmp_lt_u32 m0, s46
 s_cselect_b32 m0, m0, s47
 v_mfma_f32_16x16x32_bf16 v[72:75], a[120:123], v[196:199], v[72:75]
 ds_read_b128 v[164:167], v18 offset:2048
 v_add_u32 v19, s33, v15
 v_mfma_f32_16x16x32_bf16 v[76:79], a[124:127], v[196:199], v[76:79]
 buffer_load_dwordx4 v10, s[8:11], s30 offen offset:0 lds
 v_mfma_f32_16x16x32_bf16 v[80:83], a[120:123], v[200:203], v[80:83]
 ds_read_b128 v[168:171], v18 offset:4096
 s_add_u32 s33, s33, 16384
 v_mfma_f32_16x16x32_bf16 v[84:87], a[124:127], v[200:203], v[84:87]
 s_cmp_lt_u32 s33, 114688
 s_cselect_b32 s33, s33, 0
 v_mfma_f32_16x16x32_bf16 v[88:91], a[120:123], v[204:207], v[88:91]
 ds_read_b128 v[172:175], v18 offset:6144
 v_mfma_f32_16x16x32_bf16 v[92:95], a[124:127], v[204:207], v[92:95]
 s_waitcnt lgkmcnt(4)
 v_mfma_f32_16x16x32_bf16 v[96:99], a[120:123], v[208:211], v[96:99]
 ds_read_b128 v[176:179], v18 offset:8192
 v_mfma_f32_16x16x32_bf16 v[100:103], a[124:127], v[208:211], v[100:103]
 v_mfma_f32_16x16x32_bf16 v[104:107], a[120:123], v[212:215], v[104:107]
 ds_read_b128 v[180:183], v18 offset:10240
 v_mfma_f32_16x16x32_bf16 v[108:111], a[124:127], v[212:215], v[108:111]
 buffer_load_dwordx4 v11, s[8:11], s30 offen offset:1024 lds
 v_mfma_f32_16x16x32_bf16 v[112:115], a[120:123], v[216:219], v[112:115]
 ds_read_b128 v[184:187], v18 offset:12288
 v_mfma_f32_16x16x32_bf16 v[116:119], a[124:127], v[216:219], v[116:119]
 v_mfma_f32_16x16x32_bf16 v[120:123], a[120:123], v[220:223], v[120:123]
 ds_read_b128 v[188:191], v18 offset:14336
 v_mfma_f32_16x16x32_bf16 v[124:127], a[124:127], v[220:223], v[124:127]
 s_waitcnt lgkmcnt(4)
 v_mfma_f32_16x16x32_bf16 v[64:67], a[128:131], v[160:163], v[64:67]
 ds_read_b128 v[192:195], v19 offset:0
 v_mfma_f32_16x16x32_bf16 v[68:71], a[132:135], v[160:163], v[68:71]
 v_add_u32 v18, s33, v14
 v_mfma_f32_16x16x32_bf16 v[72:75], a[128:131], v[164:167], v[72:75]
 ds_read_b128 v[196:199], v19 offset:2048
 v_mfma_f32_16x16x32_bf16 v[76:79], a[132:135], v[164:167], v[76:79]
 buffer_load_dwordx4 v12, s[8:11], s30 offen offset:2048 lds
 v_mfma_f32_16x16x32_bf16 v[80:83], a[128:131], v[168:171], v[80:83]
 ds_read_b128 v[200:203], v19 offset:4096
 v_mfma_f32_16x16x32_bf16 v[84:87], a[132:135], v[168:171], v[84:87]
 v_mfma_f32_16x16x32_bf16 v[88:91], a[128:131], v[172:175], v[88:91]
 ds_read_b128 v[204:207], v19 offset:6144
 v_mfma_f32_16x16x32_bf16 v[92:95], a[132:135], v[172:175], v[92:95]
 s_waitcnt lgkmcnt(4)
 v_mfma_f32_16x16x32_bf16 v[96:99], a[128:131], v[176:179], v[96:99]
 ds_read_b128 v[208:211], v19 offset:8192
 v_mfma_f32_16x16x32_bf16 v[100:103], a[132:135], v[176:179], v[100:103]
 v_mfma_f32_16x16x32_bf16 v[104:107], a[128:131], v[180:183], v[104:107]
 ds_read_b128 v[212:215], v19 offset:10240
 v_mfma_f32_16x16x32_bf16 v[108:111], a[132:135], v[180:183], v[108:111]
 buffer_load_dwordx4 v13, s[8:11], s30 offen offset:3072 lds
 v_mfma_f32_16x16x32_bf16 v[112:115], a[128:131], v[184:187], v[112:115]
 ds_read_b128 v[216:219], v19 offset:12288
 s_add_u32 s30, s30, 128
 v_mfma_f32_16x16x32_bf16 v[116:119], a[132:135], v[184:187], v[116:119]
 s_add_u32 m0, m0, 16384
 v_mfma_f32_16x16x32_bf16 v[120:123], a[128:131], v[188:191], v[120:123]
 ds_read_b128 v[220:223], v19 offset:14336
 v_mfma_f32_16x16x32_bf16 v[124:127], a[132:135], v[188:191], v[124:127]
 s_waitcnt vmcnt(16) lgkmcnt(4)
 s_barrier
 v_mfma_f32_16x16x32_bf16 v[64:67], a[136:139], v[192:195], v[64:67]
 ds_read_b128 v[160:163], v18 offset:0
 v_mfma_f32_16x16x32_bf16 v[68:71], a[140:143], v[192:195], v[68:71]
 s_cmp_lt_u32 m0, s46
 s_cselect_b32 m0, m0, s47
 v_mfma_f32_16x16x32_bf16 v[72:75], a[136:139], v[196:199], v[72:75]
 ds_read_b128 v[164:167], v18 offset:2048
 v_add_u32 v19, s33, v15
 v_mfma_f32_16x16x32_bf16 v[76:79], a[140:143], v[196:199], v[76:79]
 buffer_load_dwordx4 v10, s[8:11], s30 offen offset:0 lds
 v_mfma_f32_16x16x32_bf16 v[80:83], a[136:139], v[200:203], v[80:83]
 ds_read_b128 v[168:171], v18 offset:4096
 s_add_u32 s33, s33, 16384
 v_mfma_f32_16x16x32_bf16 v[84:87], a[140:143], v[200:203], v[84:87]
 s_cmp_lt_u32 s33, 114688
 s_cselect_b32 s33, s33, 0
 v_mfma_f32_16x16x32_bf16 v[88:91], a[136:139], v[204:207], v[88:91]
 ds_read_b128 v[172:175], v18 offset:6144
 v_mfma_f32_16x16x32_bf16 v[92:95], a[140:143], v[204:207], v[92:95]
 s_waitcnt lgkmcnt(4)
 v_mfma_f32_16x16x32_bf16 v[96:99], a[136:139], v[208:211], v[96:99]
 ds_read_b128 v[176:179], v18 offset:8192
 v_mfma_f32_16x16x32_bf16 v[100:103], a[140:143], v[208:211], v[100:103]
 v_mfma_f32_16x16x32_bf16 v[104:107], a[136:139], v[212:215], v[104:107]
 ds_read_b128 v[180:183], v18 offset:10240
 v_mfma_f32_16x16x32_bf16 v[108:111], a[140:143], v[212:215], v[108:111]
 buffer_load_dwordx4 v11, s[8:11], s30 offen offset:1024 lds
 v_mfma_f32_16x16x32_bf16 v[112:115], a[136:139], v[216:219], v[112:115]
 ds_read_b128 v[184:187], v18 offset:12288
 v_mfma_f32_16x16x32_bf16 v[116:119], a[140:143], v[216:219], v[116:119]
 v_mfma_f32_16x16x32_bf16 v[120:123], a[136:139], v[220:223], v[120:123]
 ds_read_b128 v[188:191], v18 offset:14336
 v_mfma_f32_16x16x32_bf16 v[124:127], a[140:143], v[220:223], v[124:127]
 s_waitcnt lgkmcnt(4)
 v_mfma_f32_16x16x32_bf16 v[64:67], a[144:147], v[160:163], v[64:67]
 ds_read_b128 v[192:195], v19 offset:0
 v_mfma_f32_16x16x32_bf16 v[68:71], a[148:151], v[160:163], v[68:71]
 v_add_u32 v18, s33, v14
 v_mfma_f32_16x16x32_bf16 v[72:75], a[144:147], v[164:167], v[72:75]
 ds_read_b128 v[196:199], v19 offset:2048
 v_mfma_f32_16x16x32_bf16 v[76:79], a[148:151], v[164:167], v[76:79]
 buffer_load_dwordx4 v12, s[8:11], s30 offen offset:2048 lds
 v_mfma_f32_16x16x32_bf16 v[80:83], a[144:147], v[168:171], v[80:83]
 ds_read_b128 v[200:203], v19 offset:4096
 v_mfma_f32_16x16x32_bf16 v[84:87], a[148:151], v[168:171], v[84:87]
 v_mfma_f32_16x16x32_bf16 v[88:91], a[144:147], v[172:175], v[88:91]
 ds_read_b128 v[204:207], v19 offset:6144
 v_mfma_f32_16x16x32_bf16 v[92:95], a[148:151], v[172:175], v[92:95]
 s_waitcnt lgkmcnt(4)
 v_mfma_f32_16x16x32_bf16 v[96:99], a[144:147], v[176:179], v[96:99]
 ds_read_b128 v[208:211], v19 offset:8192
 v_mfma_f32_16x16x32_bf16 v[100:103], a[148:151], v[176:179], v[100:103]
 v_mfma_f32_16x16x32_bf16 v[104:107], a[144:147], v[180:183], v[104:107]
 ds_read_b128 v[212:215], v19 offset:10240
 v_mfma_f32_16x16x32_bf16 v[108:111], a[148:151], v[180:183], v[108:111]
 buffer_load_dwordx4 v13, s[8:11], s30 offen offset:3072 lds
 v_mfma_f32_16x16x32_bf16 v[112:115], a[144:147], v[184:187], v[112:115]
 ds_read_b128 v[216:219], v19 offset:12288
 s_add_u32 s30, s30, 128
 v_mfma_f32_16x16x32_bf16 v[116:119], a[148:151], v[184:187], v[116:119]
 s_add_u32 m0, m0, 16384
 v_mfma_f32_16x16x32_bf16 v[120:123], a[144:147], v[188:191], v[120:123]
 ds_read_b128 v[220:223], v19 offset:14336
 v_mfma_f32_16x16x32_bf16 v[124:127], a[148:151], v[188:191], v[124:127]
 s_waitcnt vmcnt(16) lgkmcnt(4)
 s_barrier
 v_mfma_f32_16x16x32_bf16 v[64:67], a[152:155], v[192:195], v[64:67]
 ds_read_b128 v[160:163], v18 offset:0
 v_mfma_f32_16x16x32_bf16 v[68:71], a[156:159], v[192:195], v[68:71]
 s_cmp_lt_u32 m0, s46
 s_cselect_b32 m0, m0, s47
 v_mfma_f32_16x16x32_bf16 v[72:75], a[152:155], v[196:199], v[72:75]
 ds_read_b128 v[164:167], v18 offset:2048
 v_add_u32 v19, s33, v15
 v_mfma_f32_16x16x32_bf16 v[76:79], a[156:159], v[196:199], v[76:79]
 buffer_load_dwordx4 v10, s[8:11], s30 offen offset:0 lds
 v_cvt_pk_bf16_f32 v224, v64, v65
 v_cvt_pk_bf16_f32 v225, v66, v67
 v_mfma_f32_16x16x32_bf16 v[80:83], a[152:155], v[200:203], v[80:83]
 ds_read_b128 v[168:171], v18 offset:4096
 s_add_u32 s33, s33, 16384
 v_cvt_pk_bf16_f32 v226, v68, v69
 v_cvt_pk_bf16_f32 v227, v70, v71
 v_mfma_f32_16x16x32_bf16 v[84:87], a[156:159], v[200:203], v[84:87]
 s_cmp_lt_u32 s33, 114688
 s_cselect_b32 s33, s33, 0
 ds_write_b64 v22, v[224:225] offset:0
 v_mfma_f32_16x16x32_bf16 v[88:91], a[152:155], v[204:207], v[88:91]
 ds_read_b128 v[172:175], v18 offset:6144
 ds_write_b64 v22, v[226:227] offset:32
 v_cvt_pk_bf16_f32 v230, v72, v73
 v_mfma_f32_16x16x32_bf16 v[92:95], a[156:159], v[204:207], v[92:95]
 s_waitcnt lgkmcnt(6)
 v_cvt_pk_bf16_f32 v231, v74, v75
 v_cvt_pk_bf16_f32 v232, v76, v77
 v_cvt_pk_bf16_f32 v233, v78, v79
 v_mfma_f32_16x16x32_bf16 v[96:99], a[152:155], v[208:211], v[96:99]
 ds_read_b128 v[176:179], v18 offset:8192
 ds_write_b64 v22, v[230:231] offset:4224
 v_mfma_f32_16x16x32_bf16 v[100:103], a[156:159], v[208:211], v[100:103]
 ds_write_b64 v22, v[232:233] offset:4256
 v_cvt_pk_bf16_f32 v224, v80, v81
 v_cvt_pk_bf16_f32 v225, v82, v83
 v_mfma_f32_16x16x32_bf16 v[104:107], a[152:155], v[212:215], v[104:107]
 ds_read_b128 v[180:183], v18 offset:10240
 v_cvt_pk_bf16_f32 v226, v84, v85
 v_cvt_pk_bf16_f32 v227, v86, v87
 v_mfma_f32_16x16x32_bf16 v[108:111], a[156:159], v[212:215], v[108:111]
 buffer_load_dwordx4 v11, s[8:11], s30 offen offset:1024 lds
 ds_write_b64 v22, v[224:225] offset:8448
 v_mfma_f32_16x16x32_bf16 v[112:115], a[152:155], v[216:219], v[112:115]
 ds_read_b128 v[184:187], v18 offset:12288
 ds_write_b64 v22, v[226:227] offset:8480
 v_cvt_pk_bf16_f32 v230, v88, v89
 v_mfma_f32_16x16x32_bf16 v[116:119], a[156:159], v[216:219], v[116:119]
 v_cvt_pk_bf16_f32 v231, v90, v91
 v_cvt_pk_bf16_f32 v232, v92, v93
 v_cvt_pk_bf16_f32 v233, v94, v95
 v_mfma_f32_16x16x32_bf16 v[120:123], a[152:155], v[220:223], v[120:123]
 ds_read_b128 v[188:191], v18 offset:14336
 ds_write_b64 v22, v[230:231] offset:12672
 v_mfma_f32_16x16x32_bf16 v[124:127], a[156:159], v[220:223], v[124:127]
 ds_write_b64 v22, v[232:233] offset:12704
 v_cvt_pk_bf16_f32 v224, v96, v97
 v_cvt_pk_bf16_f32 v225, v98, v99
bf_end_193:
 v_cvt_pk_bf16_f32 v226, v100, v101
 v_cvt_pk_bf16_f32 v227, v102, v103
 ds_write_b64 v22, v[224:225] offset:16896
 ds_write_b64 v22, v[226:227] offset:16928
 v_cvt_pk_bf16_f32 v230, v104, v105
 v_cvt_pk_bf16_f32 v231, v106, v107
 v_cvt_pk_bf16_f32 v232, v108, v109
 v_cvt_pk_bf16_f32 v233, v110, v111
 ds_write_b64 v22, v[230:231] offset:21120
 ds_write_b64 v22, v[232:233] offset:21152
 v_cvt_pk_bf16_f32 v224, v112, v113
 v_cvt_pk_bf16_f32 v225, v114, v115
 v_cvt_pk_bf16_f32 v226, v116, v117
 v_cvt_pk_bf16_f32 v227, v118, v119
 ds_write_b64 v22, v[224:225] offset:25344
 ds_write_b64 v22, v[226:227] offset:25376
 v_cvt_pk_bf16_f32 v230, v120, v121
 v_cvt_pk_bf16_f32 v231, v122, v123
 v_cvt_pk_bf16_f32 v232, v124, v125
 v_cvt_pk_bf16_f32 v233, v126, v127
 ds_write_b64 v22, v[230:231] offset:29568
 ds_write_b64 v22, v[232:233] offset:29600
 s_cmp_lg_u32 s26, 6
 s_cbranch_scc1 bw_194
 v_and_b32 v51, 31, v1
 buffer_load_ubyte v50, v51, s[64:67], 0 offen offset:160 sc1
 buffer_load_dword v32, v32, s[64:67], 0 offen sc1
 buffer_load_dwordx4 v[40:43], v33, s[12:15], s50 offen offset:0
 buffer_load_dwordx4 v[40:43], v33, s[12:15], s50 offen offset:1024
 buffer_load_dwordx4 v[40:43], v33, s[12:15], s50 offen offset:2048
 buffer_load_dwordx4 v[40:43], v33, s[12:15], s50 offen offset:3072
 buffer_load_dwordx4 v[40:43], v33, s[12:15], s51 offen offset:0
 buffer_load_dwordx4 v[40:43], v33, s[12:15], s51 offen offset:1024
 buffer_load_dwordx4 v[40:43], v33, s[12:15], s51 offen offset:2048
bw_194:
 s_waitcnt lgkmcnt(0)
 s_barrier
 ds_read_b64 v[144:145], v34 offset:1848
 ds_read_b64 v[146:147], v34 offset:1856
 ds_read_b64 v[148:149], v34 offset:1864
 ds_read_b64 v[150:151], v34 offset:1872
 ds_read_b64 v[152:153], v34 offset:1880
 ds_read_b64 v[64:65], v34 offset:1928
 ds_read_b64 v[66:67], v34 offset:1936
 ds_read_b64 v[68:69], v34 offset:1944
 ds_read_b64 v[70:71], v34 offset:1952
 ds_read_b64 v[72:73], v34 offset:1960
 ds_read_b64 v[74:75], v34 offset:1664
 ds_read_b64 v[76:77], v34 offset:1672
 ds_read_b64 v[78:79], v34 offset:1680
 ds_read_b64 v[80:81], v34 offset:1688
 ds_read_b64 v[82:83], v34 offset:1696
 ds_read_b64 v[84:85], v34 offset:1400
 ds_read_b64 v[86:87], v34 offset:1408
 ds_read_b64 v[88:89], v34 offset:1416
 ds_read_b64 v[90:91], v34 offset:1424
 ds_read_b64 v[92:93], v34 offset:1432
 ds_read_b64 v[94:95], v34 offset:1136
 ds_read_b64 v[96:97], v34 offset:1144
 ds_read_b64 v[98:99], v34 offset:1152
 ds_read_b64 v[100:101], v34 offset:1160
 ds_read_b64 v[102:103], v34 offset:1168
 ds_read_b64 v[104:105], v34 offset:872
 ds_read_b64 v[106:107], v34 offset:880
 ds_read_b64 v[108:109], v34 offset:888
 ds_read_b64 v[110:111], v34 offset:896
 ds_read_b64 v[112:113], v34 offset:904
 ds_read_b64 v[114:115], v34 offset:608
 ds_read_b64 v[116:117], v34 offset:616
 ds_read_b64 v[118:119], v34 offset:624
 ds_read_b64 v[120:121], v34 offset:632
 ds_read_b64 v[122:123], v34 offset:640
 ds_read_b64 v[124:125], v34 offset:344
 ds_read_b64 v[126:127], v34 offset:352
 ds_read_b64 v[128:129], v34 offset:360
 ds_read_b64 v[130:131], v34 offset:368
 ds_read_b64 v[132:133], v34 offset:376
 ds_read_b64 v[134:135], v34 offset:80
 ds_read_b64 v[136:137], v34 offset:88
 ds_read_b64 v[138:139], v34 offset:96
 ds_read_b64 v[140:141], v34 offset:104
 ds_read_b64 v[142:143], v34 offset:112
 v_mov_b32 v224, 0
 v_mov_b32 v225, 0
 v_mov_b32 v226, 0
 v_mov_b32 v227, 0
 v_mov_b32 v228, 0
 v_mov_b32 v229, 0
 v_mov_b32 v230, 0
 v_mov_b32 v231, 0
 s_waitcnt lgkmcnt(15)
 v_dot2c_f32_bf16 v224, v64, v144
 v_dot2c_f32_bf16 v225, v74, v144
 v_dot2c_f32_bf16 v226, v84, v144
 v_dot2c_f32_bf16 v227, v94, v144
 v_dot2c_f32_bf16 v224, v65, v145
 v_dot2c_f32_bf16 v225, v75, v145
 v_dot2c_f32_bf16 v226, v85, v145
 v_dot2c_f32_bf16 v227, v95, v145
 v_dot2c_f32_bf16 v224, v66, v146
 v_dot2c_f32_bf16 v225, v76, v146
 v_dot2c_f32_bf16 v226, v86, v146
 v_dot2c_f32_bf16 v227, v96, v146
 v_dot2c_f32_bf16 v224, v67, v147
 v_dot2c_f32_bf16 v225, v77, v147
 v_dot2c_f32_bf16 v226, v87, v147
 v_dot2c_f32_bf16 v227, v97, v147
 v_dot2c_f32_bf16 v224, v68, v148
 v_dot2c_f32_bf16 v225, v78, v148
 v_dot2c_f32_bf16 v226, v88, v148
 v_dot2c_f32_bf16 v227, v98, v148
 v_dot2c_f32_bf16 v224, v69, v149
 v_dot2c_f32_bf16 v225, v79, v149
 v_dot2c_f32_bf16 v226, v89, v149
 v_dot2c_f32_bf16 v227, v99, v149
 v_dot2c_f32_bf16 v224, v70, v150
 v_dot2c_f32_bf16 v225, v80, v150
 v_dot2c_f32_bf16 v226, v90, v150
 v_dot2c_f32_bf16 v227, v100, v150
 v_dot2c_f32_bf16 v224, v71, v151
 v_dot2c_f32_bf16 v225, v81, v151
 v_dot2c_f32_bf16 v226, v91, v151
 v_dot2c_f32_bf16 v227, v101, v151
 v_dot2c_f32_bf16 v224, v72, v152
 v_dot2c_f32_bf16 v225, v82, v152
 v_dot2c_f32_bf16 v226, v92, v152
 v_dot2c_f32_bf16 v227, v102, v152
 v_dot2c_f32_bf16 v224, v73, v153
 v_dot2c_f32_bf16 v225, v83, v153
 v_dot2c_f32_bf16 v226, v93, v153
 v_dot2c_f32_bf16 v227, v103, v153
 s_waitcnt lgkmcnt(0)
 v_dot2c_f32_bf16 v228, v104, v144
 v_dot2c_f32_bf16 v229, v114, v144
 v_dot2c_f32_bf16 v230, v124, v144
 v_dot2c_f32_bf16 v231, v134, v144
 v_dot2c_f32_bf16 v228, v105, v145
 v_dot2c_f32_bf16 v229, v115, v145
 v_dot2c_f32_bf16 v230, v125, v145
 v_dot2c_f32_bf16 v231, v135, v145
 v_dot2c_f32_bf16 v228, v106, v146
 v_dot2c_f32_bf16 v229, v116, v146
 v_dot2c_f32_bf16 v230, v126, v146
 v_dot2c_f32_bf16 v231, v136, v146
 v_dot2c_f32_bf16 v228, v107, v147
 v_dot2c_f32_bf16 v229, v117, v147
 v_dot2c_f32_bf16 v230, v127, v147
 v_dot2c_f32_bf16 v231, v137, v147
 v_dot2c_f32_bf16 v228, v108, v148
 v_dot2c_f32_bf16 v229, v118, v148
 v_dot2c_f32_bf16 v230, v128, v148
 v_dot2c_f32_bf16 v231, v138, v148
 v_dot2c_f32_bf16 v228, v109, v149
 v_dot2c_f32_bf16 v229, v119, v149
 v_dot2c_f32_bf16 v230, v129, v149
 v_dot2c_f32_bf16 v231, v139, v149
 v_dot2c_f32_bf16 v228, v110, v150
 v_dot2c_f32_bf16 v229, v120, v150
 v_dot2c_f32_bf16 v230, v130, v150
 v_dot2c_f32_bf16 v231, v140, v150
 v_dot2c_f32_bf16 v228, v111, v151
 v_dot2c_f32_bf16 v229, v121, v151
 v_dot2c_f32_bf16 v230, v131, v151
 v_dot2c_f32_bf16 v231, v141, v151
 v_dot2c_f32_bf16 v228, v112, v152
 v_dot2c_f32_bf16 v229, v122, v152
 v_dot2c_f32_bf16 v230, v132, v152
 v_dot2c_f32_bf16 v231, v142, v152
 v_dot2c_f32_bf16 v228, v113, v153
 v_dot2c_f32_bf16 v229, v123, v153
 v_dot2c_f32_bf16 v230, v133, v153
 v_dot2c_f32_bf16 v231, v143, v153
 ds_read_b64 v[64:65], v38 offset:2008
 ds_read_b64 v[66:67], v38 offset:2016
 ds_read_b64 v[68:69], v38 offset:2024
 ds_read_b64 v[70:71], v38 offset:2032
 ds_read_b64 v[72:73], v39 offset:2040
 ds_read_b64 v[74:75], v38 offset:1744
 ds_read_b64 v[76:77], v38 offset:1752
 ds_read_b64 v[78:79], v38 offset:1760
 ds_read_b64 v[80:81], v38 offset:1768
 ds_read_b64 v[82:83], v39 offset:1776
 ds_read_b64 v[84:85], v38 offset:1480
 ds_read_b64 v[86:87], v38 offset:1488
 ds_read_b64 v[88:89], v38 offset:1496
 ds_read_b64 v[90:91], v38 offset:1504
 ds_read_b64 v[92:93], v39 offset:1512
 ds_read_b64 v[94:95], v38 offset:1216
 ds_read_b64 v[96:97], v38 offset:1224
 ds_read_b64 v[98:99], v38 offset:1232
 ds_read_b64 v[100:101], v38 offset:1240
 ds_read_b64 v[102:103], v39 offset:1248
 ds_read_b64 v[104:105], v38 offset:952
 ds_read_b64 v[106:107], v38 offset:960
 ds_read_b64 v[108:109], v38 offset:968
 ds_read_b64 v[110:111], v38 offset:976
 ds_read_b64 v[112:113], v39 offset:984
 ds_read_b64 v[114:115], v38 offset:688
 ds_read_b64 v[116:117], v38 offset:696
 ds_read_b64 v[118:119], v38 offset:704
 ds_read_b64 v[120:121], v38 offset:712
 ds_read_b64 v[122:123], v39 offset:720
 ds_read_b64 v[124:125], v38 offset:424
 ds_read_b64 v[126:127], v38 offset:432
 ds_read_b64 v[128:129], v38 offset:440
 ds_read_b64 v[130:131], v38 offset:448
 ds_read_b64 v[132:133], v39 offset:456
 ds_read_b64 v[134:135], v38 offset:160
 ds_read_b64 v[136:137], v38 offset:168
 ds_read_b64 v[138:139], v38 offset:176
 ds_read_b64 v[140:141], v38 offset:184
 ds_read_b64 v[142:143], v39 offset:192
 v_cvt_pk_bf16_f32 v4, v224, v225
 v_lshlrev_b32 v224, 16, v4
 v_and_b32 v225, 0xffff0000, v4
 v_mul_f32 v224, s60, v224
 v_mul_f32 v225, s60, v225
 v_cvt_pk_bf16_f32 v4, v224, v225
 v_lshlrev_b32 v224, 16, v4
 v_and_b32 v225, 0xffff0000, v4
 v_cndmask_b32 v224, v37, v224, s[76:77]
 v_cndmask_b32 v225, v37, v225, s[78:79]
 v_cvt_pk_bf16_f32 v4, v226, v227
 v_lshlrev_b32 v226, 16, v4
 v_and_b32 v227, 0xffff0000, v4
 v_mul_f32 v226, s60, v226
 v_mul_f32 v227, s60, v227
 v_cvt_pk_bf16_f32 v4, v226, v227
 v_lshlrev_b32 v226, 16, v4
 v_and_b32 v227, 0xffff0000, v4
 v_cndmask_b32 v226, v37, v226, s[80:81]
 v_cndmask_b32 v227, v37, v227, s[82:83]
 v_cvt_pk_bf16_f32 v4, v228, v229
 v_lshlrev_b32 v228, 16, v4
 v_and_b32 v229, 0xffff0000, v4
 v_mul_f32 v228, s60, v228
 v_mul_f32 v229, s60, v229
 v_cvt_pk_bf16_f32 v4, v228, v229
 v_lshlrev_b32 v228, 16, v4
 v_and_b32 v229, 0xffff0000, v4
 v_cndmask_b32 v228, v37, v228, s[84:85]
 v_cndmask_b32 v229, v37, v229, s[86:87]
 v_cvt_pk_bf16_f32 v4, v230, v231
 v_lshlrev_b32 v230, 16, v4
 v_and_b32 v231, 0xffff0000, v4
 v_mul_f32 v230, s60, v230
 v_mul_f32 v231, s60, v231
 v_cvt_pk_bf16_f32 v4, v230, v231
 v_lshlrev_b32 v230, 16, v4
 v_and_b32 v231, 0xffff0000, v4
 v_cndmask_b32 v230, v37, v230, s[88:89]
 v_cndmask_b32 v231, v37, v231, s[90:91]
 v_max3_f32 v5, v224, v225, v226
 v_max3_f32 v5, v5, v227, v228
 v_max3_f32 v5, v5, v229, v230
 v_max_f32 v5, v5, v231
 v_sub_f32 v224, v224, v5
 v_mul_f32 v224, s61, v224
 v_exp_f32 v224, v224
 v_sub_f32 v225, v225, v5
 v_mul_f32 v225, s61, v225
 v_exp_f32 v225, v225
 v_sub_f32 v226, v226, v5
 v_mul_f32 v226, s61, v226
 v_exp_f32 v226, v226
 v_sub_f32 v227, v227, v5
 v_mul_f32 v227, s61, v227
 v_exp_f32 v227, v227
 v_sub_f32 v228, v228, v5
 v_mul_f32 v228, s61, v228
 v_exp_f32 v228, v228
 v_sub_f32 v229, v229, v5
 v_mul_f32 v229, s61, v229
 v_exp_f32 v229, v229
 v_sub_f32 v230, v230, v5
 v_mul_f32 v230, s61, v230
 v_exp_f32 v230, v230
 v_sub_f32 v231, v231, v5
 v_mul_f32 v231, s61, v231
 v_exp_f32 v231, v231
 s_nop 0
 v_add_f32 v5, v224, v225
 v_add_f32 v5, v5, v226
 v_add_f32 v5, v5, v227
 v_add_f32 v5, v5, v228
 v_add_f32 v5, v5, v229
 v_add_f32 v5, v5, v230
 v_add_f32 v5, v5, v231
 v_rcp_f32 v5, v5
 s_nop 0
 v_mul_f32 v224, v224, v5
 v_mul_f32 v225, v225, v5
 v_mul_f32 v226, v226, v5
 v_mul_f32 v227, v227, v5
 v_mul_f32 v228, v228, v5
 v_mul_f32 v229, v229, v5
 v_mul_f32 v230, v230, v5
 v_mul_f32 v231, v231, v5
 v_cvt_pk_bf16_f32 v232, v224, v225
 v_cvt_pk_bf16_f32 v233, v226, v227
 v_cvt_pk_bf16_f32 v234, v228, v229
 v_cvt_pk_bf16_f32 v235, v230, v231
 s_waitcnt lgkmcnt(15)
 v_perm_b32 v144, v74, v64, s62
 v_perm_b32 v145, v74, v64, s63
 v_perm_b32 v146, v75, v65, s62
 v_perm_b32 v147, v75, v65, s63
 v_perm_b32 v148, v76, v66, s62
 v_perm_b32 v149, v76, v66, s63
 v_perm_b32 v150, v77, v67, s62
 v_perm_b32 v151, v77, v67, s63
 v_perm_b32 v152, v78, v68, s62
 v_perm_b32 v153, v78, v68, s63
 v_perm_b32 v154, v79, v69, s62
 v_perm_b32 v155, v79, v69, s63
 v_perm_b32 v156, v80, v70, s62
 v_perm_b32 v157, v80, v70, s63
 v_perm_b32 v158, v81, v71, s62
 v_perm_b32 v159, v81, v71, s63
 v_perm_b32 v212, v82, v72, s62
 v_perm_b32 v213, v82, v72, s63
 v_perm_b32 v214, v83, v73, s62
 v_perm_b32 v215, v83, v73, s63
 v_dot2_f32_bf16 v192, v144, v232, 0
 v_dot2_f32_bf16 v193, v145, v232, 0
 v_dot2_f32_bf16 v194, v146, v232, 0
 v_dot2_f32_bf16 v195, v147, v232, 0
 v_dot2_f32_bf16 v196, v148, v232, 0
 v_dot2_f32_bf16 v197, v149, v232, 0
 v_dot2_f32_bf16 v198, v150, v232, 0
 v_dot2_f32_bf16 v199, v151, v232, 0
 v_dot2_f32_bf16 v200, v152, v232, 0
 v_dot2_f32_bf16 v201, v153, v232, 0
 v_dot2_f32_bf16 v202, v154, v232, 0
 v_dot2_f32_bf16 v203, v155, v232, 0
 v_dot2_f32_bf16 v204, v156, v232, 0
 v_dot2_f32_bf16 v205, v157, v232, 0
 v_dot2_f32_bf16 v206, v158, v232, 0
 v_dot2_f32_bf16 v207, v159, v232, 0
 v_dot2_f32_bf16 v208, v212, v232, 0
 v_dot2_f32_bf16 v209, v213, v232, 0
 v_dot2_f32_bf16 v210, v214, v232, 0
 v_dot2_f32_bf16 v211, v215, v232, 0
 s_waitcnt lgkmcnt(15)
 v_perm_b32 v144, v94, v84, s62
 v_perm_b32 v145, v94, v84, s63
 v_perm_b32 v146, v95, v85, s62
 v_perm_b32 v147, v95, v85, s63
 v_perm_b32 v148, v96, v86, s62
 v_perm_b32 v149, v96, v86, s63
 v_perm_b32 v150, v97, v87, s62
 v_perm_b32 v151, v97, v87, s63
 v_perm_b32 v152, v98, v88, s62
 v_perm_b32 v153, v98, v88, s63
 v_perm_b32 v154, v99, v89, s62
 v_perm_b32 v155, v99, v89, s63
 v_perm_b32 v156, v100, v90, s62
 v_perm_b32 v157, v100, v90, s63
 v_perm_b32 v158, v101, v91, s62
 v_perm_b32 v159, v101, v91, s63
 v_perm_b32 v212, v102, v92, s62
 v_perm_b32 v213, v102, v92, s63
 v_perm_b32 v214, v103, v93, s62
 v_perm_b32 v215, v103, v93, s63
 v_dot2c_f32_bf16 v192, v144, v233
 v_dot2c_f32_bf16 v193, v145, v233
 v_dot2c_f32_bf16 v194, v146, v233
 v_dot2c_f32_bf16 v195, v147, v233
 v_dot2c_f32_bf16 v196, v148, v233
 v_dot2c_f32_bf16 v197, v149, v233
 v_dot2c_f32_bf16 v198, v150, v233
 v_dot2c_f32_bf16 v199, v151, v233
 v_dot2c_f32_bf16 v200, v152, v233
 v_dot2c_f32_bf16 v201, v153, v233
 v_dot2c_f32_bf16 v202, v154, v233
 v_dot2c_f32_bf16 v203, v155, v233
 v_dot2c_f32_bf16 v204, v156, v233
 v_dot2c_f32_bf16 v205, v157, v233
 v_dot2c_f32_bf16 v206, v158, v233
 v_dot2c_f32_bf16 v207, v159, v233
 v_dot2c_f32_bf16 v208, v212, v233
 v_dot2c_f32_bf16 v209, v213, v233
 v_dot2c_f32_bf16 v210, v214, v233
 v_dot2c_f32_bf16 v211, v215, v233
 s_waitcnt lgkmcnt(10)
 v_perm_b32 v144, v114, v104, s62
 v_perm_b32 v145, v114, v104, s63
 v_perm_b32 v146, v115, v105, s62
 v_perm_b32 v147, v115, v105, s63
 v_perm_b32 v148, v116, v106, s62
 v_perm_b32 v149, v116, v106, s63
 v_perm_b32 v150, v117, v107, s62
 v_perm_b32 v151, v117, v107, s63
 v_perm_b32 v152, v118, v108, s62
 v_perm_b32 v153, v118, v108, s63
 v_perm_b32 v154, v119, v109, s62
 v_perm_b32 v155, v119, v109, s63
 v_perm_b32 v156, v120, v110, s62
 v_perm_b32 v157, v120, v110, s63
 v_perm_b32 v158, v121, v111, s62
 v_perm_b32 v159, v121, v111, s63
 v_perm_b32 v212, v122, v112, s62
 v_perm_b32 v213, v122, v112, s63
 v_perm_b32 v214, v123, v113, s62
 v_perm_b32 v215, v123, v113, s63
 v_dot2c_f32_bf16 v192, v144, v234
 v_dot2c_f32_bf16 v193, v145, v234
 v_dot2c_f32_bf16 v194, v146, v234
 v_dot2c_f32_bf16 v195, v147, v234
 v_dot2c_f32_bf16 v196, v148, v234
 v_dot2c_f32_bf16 v197, v149, v234
 v_dot2c_f32_bf16 v198, v150, v234
 v_dot2c_f32_bf16 v199, v151, v234
 v_dot2c_f32_bf16 v200, v152, v234
 v_dot2c_f32_bf16 v201, v153, v234
 v_dot2c_f32_bf16 v202, v154, v234
 v_dot2c_f32_bf16 v203, v155, v234
 v_dot2c_f32_bf16 v204, v156, v234
 v_dot2c_f32_bf16 v205, v157, v234
 v_dot2c_f32_bf16 v206, v158, v234
 v_dot2c_f32_bf16 v207, v159, v234
 v_dot2c_f32_bf16 v208, v212, v234
 v_dot2c_f32_bf16 v209, v213, v234
 v_dot2c_f32_bf16 v210, v214, v234
 v_dot2c_f32_bf16 v211, v215, v234
 s_waitcnt lgkmcnt(0)
 v_perm_b32 v144, v134, v124, s62
 v_perm_b32 v145, v134, v124, s63
 v_perm_b32 v146, v135, v125, s62
 v_perm_b32 v147, v135, v125, s63
 v_perm_b32 v148, v136, v126, s62
 v_perm_b32 v149, v136, v126, s63
 v_perm_b32 v150, v137, v127, s62
 v_perm_b32 v151, v137, v127, s63
 v_perm_b32 v152, v138, v128, s62
 v_perm_b32 v153, v138, v128, s63
 v_perm_b32 v154, v139, v129, s62
 v_perm_b32 v155, v139, v129, s63
 v_perm_b32 v156, v140, v130, s62
 v_perm_b32 v157, v140, v130, s63
 v_perm_b32 v158, v141, v131, s62
 v_perm_b32 v159, v141, v131, s63
 v_perm_b32 v212, v142, v132, s62
 v_perm_b32 v213, v142, v132, s63
 v_perm_b32 v214, v143, v133, s62
 v_perm_b32 v215, v143, v133, s63
 v_dot2c_f32_bf16 v192, v144, v235
 v_dot2c_f32_bf16 v193, v145, v235
 v_dot2c_f32_bf16 v194, v146, v235
 v_dot2c_f32_bf16 v195, v147, v235
 v_dot2c_f32_bf16 v196, v148, v235
 v_dot2c_f32_bf16 v197, v149, v235
 v_dot2c_f32_bf16 v198, v150, v235
 v_dot2c_f32_bf16 v199, v151, v235
 v_dot2c_f32_bf16 v200, v152, v235
 v_dot2c_f32_bf16 v201, v153, v235
 v_dot2c_f32_bf16 v202, v154, v235
 v_dot2c_f32_bf16 v203, v155, v235
 v_dot2c_f32_bf16 v204, v156, v235
 v_dot2c_f32_bf16 v205, v157, v235
 v_dot2c_f32_bf16 v206, v158, v235
 v_dot2c_f32_bf16 v207, v159, v235
 v_dot2c_f32_bf16 v208, v212, v235
 v_dot2c_f32_bf16 v209, v213, v235
 v_dot2c_f32_bf16 v210, v214, v235
 v_dot2c_f32_bf16 v211, v215, v235
 s_cmp_lg_u32 s20, 0
 s_cbranch_scc1 bh_195
 ds_read_b64 v[64:65], v35 offset:33792
 ds_read_b64 v[66:67], v35 offset:34304
 ds_read_b64 v[68:69], v35 offset:34816
 ds_read_b64 v[70:71], v35 offset:35328
 ds_read_b64 v[72:73], v35 offset:35840
 s_waitcnt lgkmcnt(0)
 ds_write_b64 v35, v[64:65] offset:0
 ds_write_b64 v35, v[66:67] offset:512
 ds_write_b64 v35, v[68:69] offset:1024
 ds_write_b64 v35, v[70:71] offset:1536
 ds_write_b64 v35, v[72:73] offset:2048
bh_195:
 s_nop 1
 v_cvt_pk_bf16_f32 v244, v192, v193
 v_cvt_pk_bf16_f32 v245, v194, v195
 v_cvt_pk_bf16_f32 v246, v196, v197
 v_cvt_pk_bf16_f32 v247, v198, v199
 v_cvt_pk_bf16_f32 v248, v200, v201
 v_cvt_pk_bf16_f32 v249, v202, v203
 v_cvt_pk_bf16_f32 v250, v204, v205
 v_cvt_pk_bf16_f32 v251, v206, v207
 v_cvt_pk_bf16_f32 v252, v208, v209
 v_cvt_pk_bf16_f32 v253, v210, v211
 buffer_store_dwordx4 v[244:247], v29, s[16:19], s27 offen sc1
 buffer_store_dwordx4 v[248:251], v30, s[16:19], s27 offen sc1
 buffer_store_dwordx2 v[252:253], v31, s[16:19], s27 offen sc1
 s_add_u32 s27, s27, 2048
 s_mov_b64 s[78:79], -1
 s_mov_b64 s[80:81], -1
 s_mov_b64 s[82:83], -1
 s_mov_b64 s[84:85], -1
 s_mov_b64 s[86:87], -1
 s_mov_b64 s[88:89], -1
 s_mov_b64 s[90:91], -1
 s_sub_u32 s26, s26, 1
 s_cmp_gt_u32 s26, 0
 s_waitcnt lgkmcnt(0)
 s_cbranch_scc1 bf_blk_192
 s_waitcnt vmcnt(0) lgkmcnt(0)
 s_barrier
 s_mov_b32 s84, 0
 s_mov_b32 s85, -1
 v_readfirstlane_b32 s21, v32
 s_cmp_ge_u32 s21, 32
 s_cbranch_scc1 bt_196
 s_mov_b32 s21, 76
 v_mov_b32 v4, 0
 s_mov_b32 s101, 0
wf_197:
 buffer_load_dword v5, v4, s[64:67], s21 offen sc1
 s_add_u32 s101, s101, 1
 s_cmp_gt_u32 s101, 131072
 s_cbranch_scc1 main_end
 s_waitcnt vmcnt(0)
 v_readfirstlane_b32 s100, v5
 s_cmp_ge_u32 s100, 32
 s_cbranch_scc1 wf_198
 s_sleep 8
 s_branch wf_197
wf_198:
bt_196:
 s_mov_b32 s21, 91136
 s_cmp_lg_u32 s20, 0
 s_cbranch_scc1 af_199
 v_mov_b32 v4, 0
 v_mov_b32 v5, 1
 s_mov_b64 exec, 1
 buffer_atomic_add v5, v4, s[72:75], s21 offen sc1
 s_mov_b64 exec, -1
 s_nop 1
af_199:
 s_mov_b32 s101, 0
c0_200:
 v_cmp_eq_u32 vcc, 0, v50
 s_nop 1
 s_cbranch_vccz c0_201
 s_sleep 8
 v_and_b32 v51, 31, v1
 buffer_load_ubyte v50, v51, s[64:67], 0 offen offset:160 sc1
 s_add_u32 s101, s101, 1
 s_cmp_gt_u32 s101, 131072
 s_cbranch_scc1 main_end
 s_waitcnt vmcnt(0)
 s_branch c0_200
c0_201:
 v_cmp_eq_u32 vcc, 2, v50
 s_nop 1
 s_mov_b32 s37, vcc_lo
q_entry:
 s_load_dwordx2 s[4:5], s[0:1], 0
 s_load_dwordx2 s[6:7], s[0:1], 16
 s_load_dwordx2 s[38:39], s[0:1], 104
 s_mov_b32 s42, s2
 s_cmp_lt_u32 s3, 64
 s_cselect_b32 s41, 10, 0
 s_cselect_b32 s45, 8, 0
 s_waitcnt lgkmcnt(0)
 s_mov_b32 s8, s4
 s_mov_b32 s9, s5
 s_mov_b32 s10, 2621440
 s_mov_b32 s11, 0x00020000
 s_mov_b32 s12, s6
 s_mov_b32 s13, s7
 s_mov_b32 s14, 7864320
 s_mov_b32 s15, 0x00020000
 s_mov_b32 s16, s38
 s_mov_b32 s17, s39
 s_mov_b32 s18, 50331648
 s_mov_b32 s19, 0x00020000
 s_add_u32 s52, s38, 180355072
 s_addc_u32 s53, s39, 0
 s_mov_b32 s54, 67108864
 s_mov_b32 s55, 0x00020000
 s_add_u32 s56, s38, 180355072
 s_addc_u32 s57, s39, 0
 s_mov_b32 s58, 67108864
 s_mov_b32 s59, 0x00020000
 s_load_dwordx2 s[72:73], s[0:1], 104
 s_waitcnt lgkmcnt(0)
 s_add_u32 s72, s72, 81068032
 s_addc_u32 s73, s73, 0
 s_mov_b32 s74, 129024
 s_mov_b32 s75, 0x00020000
 s_mul_i32 s44, s42, 384
 s_mul_i32 s24, s45, 307200
 v_mov_b32 v9, 2731
 s_and_b32 s22, s20, 1
 s_lshl_b32 s22, s22, 2
 v_add_u32 v8, 0, v1
 v_mul_u32_u24 v7, v8, v9
 v_lshrrev_b32 v7, 16, v7
 v_mul_u32_u24 v4, 24, v7
 v_sub_u32 v8, v8, v4
 v_and_b32 v4, 2, v7
 v_xor_b32 v8, v8, v4
 v_xor_b32 v8, s22, v8
 v_xor_b32 v5, 4, v8
 s_mov_b32 s21, 12288
 v_mul_lo_u32 v7, v7, s21
 v_lshl_add_u32 v40, v8, 4, v7
 v_lshl_add_u32 v43, v5, 4, v7
 v_add_u32 v8, 64, v1
 v_mul_u32_u24 v7, v8, v9
 v_lshrrev_b32 v7, 16, v7
 v_mul_u32_u24 v4, 24, v7
 v_sub_u32 v8, v8, v4
 v_and_b32 v4, 2, v7
 v_xor_b32 v8, v8, v4
 v_xor_b32 v8, s22, v8
 v_xor_b32 v5, 4, v8
 s_mov_b32 s21, 12288
 v_mul_lo_u32 v7, v7, s21
 v_lshl_add_u32 v41, v8, 4, v7
 v_lshl_add_u32 v44, v5, 4, v7
 v_add_u32 v8, 128, v1
 v_mul_u32_u24 v7, v8, v9
 v_lshrrev_b32 v7, 16, v7
 v_mul_u32_u24 v4, 24, v7
 v_sub_u32 v8, v8, v4
 v_and_b32 v4, 2, v7
 v_xor_b32 v8, v8, v4
 v_xor_b32 v8, s22, v8
 v_xor_b32 v5, 4, v8
 s_mov_b32 s21, 12288
 v_mul_lo_u32 v7, v7, s21
 v_lshl_add_u32 v42, v8, 4, v7
 v_lshl_add_u32 v45, v5, 4, v7
 s_mul_i32 s23, s20, 491520
 s_add_u32 s23, s23, s44
 s_mul_i32 s22, s20, 15360
 s_add_u32 s22, s22, 98304
 s_add_u32 s21, s23, 0
 s_add_u32 m0, s22, 0
 s_nop 0
 buffer_load_dwordx4 v40, s[12:15], s21 offen lds
 s_add_u32 m0, s22, 1024
 s_nop 0
 buffer_load_dwordx4 v41, s[12:15], s21 offen lds
 s_add_u32 m0, s22, 2048
 s_nop 0
 buffer_load_dwordx4 v42, s[12:15], s21 offen lds
 s_add_u32 s21, s23, 98304
 s_add_u32 m0, s22, 3072
 s_nop 0
 buffer_load_dwordx4 v43, s[12:15], s21 offen lds
 s_add_u32 m0, s22, 4096
 s_nop 0
 buffer_load_dwordx4 v44, s[12:15], s21 offen lds
 s_add_u32 m0, s22, 5120
 s_nop 0
 buffer_load_dwordx4 v45, s[12:15], s21 offen lds
 s_add_u32 s21, s23, 196608
 s_add_u32 m0, s22, 6144
 s_nop 0
 buffer_load_dwordx4 v40, s[12:15], s21 offen lds
 s_add_u32 m0, s22, 7168
 s_nop 0
 buffer_load_dwordx4 v41, s[12:15], s21 offen lds
 s_add_u32 m0, s22, 8192
 s_nop 0
 buffer_load_dwordx4 v42, s[12:15], s21 offen lds
 s_add_u32 s21, s23, 294912
 s_add_u32 m0, s22, 9216
 s_nop 0
 buffer_load_dwordx4 v43, s[12:15], s21 offen lds
 s_add_u32 m0, s22, 10240
 s_nop 0
 buffer_load_dwordx4 v44, s[12:15], s21 offen lds
 s_add_u32 m0, s22, 11264
 s_nop 0
 buffer_load_dwordx4 v45, s[12:15], s21 offen lds
 s_add_u32 s21, s23, 393216
 s_add_u32 m0, s22, 12288
 s_nop 0
 buffer_load_dwordx4 v40, s[12:15], s21 offen lds
 s_add_u32 m0, s22, 13312
 s_nop 0
 buffer_load_dwordx4 v41, s[12:15], s21 offen lds
 s_add_u32 m0, s22, 14336
 s_nop 0
 buffer_load_dwordx4 v42, s[12:15], s21 offen lds
 s_add_u32 s21, s23, 1966080
 buffer_load_dwordx4 v[64:67], v40, s[12:15], s21 offen
 buffer_load_dwordx4 v[68:71], v41, s[12:15], s21 offen
 buffer_load_dwordx4 v[72:75], v42, s[12:15], s21 offen
 s_add_u32 s21, s23, 2064384
 buffer_load_dwordx4 v[76:79], v43, s[12:15], s21 offen
 buffer_load_dwordx4 v[80:83], v44, s[12:15], s21 offen
 buffer_load_dwordx4 v[84:87], v45, s[12:15], s21 offen
 s_add_u32 s21, s23, 2162688
 buffer_load_dwordx4 v[88:91], v40, s[12:15], s21 offen
 buffer_load_dwordx4 v[92:95], v41, s[12:15], s21 offen
 buffer_load_dwordx4 v[96:99], v42, s[12:15], s21 offen
 s_add_u32 s21, s23, 2260992
 buffer_load_dwordx4 v[100:103], v43, s[12:15], s21 offen
 buffer_load_dwordx4 v[104:107], v44, s[12:15], s21 offen
 buffer_load_dwordx4 v[108:111], v45, s[12:15], s21 offen
 s_add_u32 s21, s23, 2359296
 buffer_load_dwordx4 v[112:115], v40, s[12:15], s21 offen
 buffer_load_dwordx4 v[116:119], v41, s[12:15], s21 offen
 buffer_load_dwordx4 v[120:123], v42, s[12:15], s21 offen
 s_add_u32 s21, s23, 3932160
 buffer_load_dwordx4 v[124:127], v40, s[12:15], s21 offen
 buffer_load_dwordx4 v[128:131], v41, s[12:15], s21 offen
 buffer_load_dwordx4 v[132:135], v42, s[12:15], s21 offen
 s_add_u32 s21, s23, 4030464
 buffer_load_dwordx4 v[136:139], v43, s[12:15], s21 offen
 buffer_load_dwordx4 v[140:143], v44, s[12:15], s21 offen
 buffer_load_dwordx4 v[144:147], v45, s[12:15], s21 offen
 s_add_u32 s21, s23, 4128768
 buffer_load_dwordx4 v[148:151], v40, s[12:15], s21 offen
 buffer_load_dwordx4 v[152:155], v41, s[12:15], s21 offen
 buffer_load_dwordx4 v[156:159], v42, s[12:15], s21 offen
 s_add_u32 s21, s23, 4227072
 buffer_load_dwordx4 v[160:163], v43, s[12:15], s21 offen
 buffer_load_dwordx4 v[164:167], v44, s[12:15], s21 offen
 buffer_load_dwordx4 v[168:171], v45, s[12:15], s21 offen
 s_add_u32 s21, s23, 4325376
 buffer_load_dwordx4 v[172:175], v40, s[12:15], s21 offen
 buffer_load_dwordx4 v[176:179], v41, s[12:15], s21 offen
 buffer_load_dwordx4 v[180:183], v42, s[12:15], s21 offen
 s_add_u32 s21, s23, 5898240
 buffer_load_dwordx4 v[184:187], v40, s[12:15], s21 offen
 buffer_load_dwordx4 v[188:191], v41, s[12:15], s21 offen
 buffer_load_dwordx4 v[192:195], v42, s[12:15], s21 offen
 s_add_u32 s21, s23, 5996544
 buffer_load_dwordx4 v[196:199], v43, s[12:15], s21 offen
 buffer_load_dwordx4 v[200:203], v44, s[12:15], s21 offen
 buffer_load_dwordx4 v[204:207], v45, s[12:15], s21 offen
 s_add_u32 s21, s23, 6094848
 buffer_load_dwordx4 v[208:211], v40, s[12:15], s21 offen
 buffer_load_dwordx4 v[212:215], v41, s[12:15], s21 offen
 buffer_load_dwordx4 v[216:219], v42, s[12:15], s21 offen
 s_add_u32 s21, s23, 6193152
 buffer_load_dwordx4 v[220:223], v43, s[12:15], s21 offen
 buffer_load_dwordx4 v[224:227], v44, s[12:15], s21 offen
 buffer_load_dwordx4 v[228:231], v45, s[12:15], s21 offen
 s_add_u32 s21, s23, 6291456
 buffer_load_dwordx4 v[232:235], v40, s[12:15], s21 offen
 buffer_load_dwordx4 v[236:239], v41, s[12:15], s21 offen
 buffer_load_dwordx4 v[240:243], v42, s[12:15], s21 offen
 v_lshl_add_u32 v49, v1, 4, s22
 v_lshrrev_b32 v7, 2, v2
 v_and_b32 v4, 2, v7
 v_and_b32 v5, 1, v3
 v_lshl_or_b32 v4, v5, 2, v4
 v_lshl_add_u32 v7, v3, 3, v7
 v_mul_u32_u24 v7, 384, v7
 v_and_b32 v5, 1, v2
 v_lshl_add_u32 v7, v5, 3, v7
 v_add_u32 v7, 98304, v7
 v_bfe_u32 v8, v2, 1, 1
 s_mul_i32 s21, s20, 6
 v_add_u32 v8, s21, v8
 v_add_u32 v5, 0, v8
 v_xor_b32 v5, v5, v4
 v_lshl_add_u32 v46, v5, 4, v7
 v_add_u32 v5, 2, v8
 v_xor_b32 v5, v5, v4
 v_lshl_add_u32 v47, v5, 4, v7
 v_add_u32 v5, 4, v8
 v_xor_b32 v5, v5, v4
 v_lshl_add_u32 v48, v5, 4, v7
 s_waitcnt vmcnt(45)
 s_barrier
 ds_read_b64_tr_b16 a[0:1], v46 offset:0
 ds_read_b64_tr_b16 a[2:3], v46 offset:1536
 ds_read_b64_tr_b16 a[4:5], v47 offset:0
 ds_read_b64_tr_b16 a[6:7], v47 offset:1536
 ds_read_b64_tr_b16 a[8:9], v48 offset:0
 ds_read_b64_tr_b16 a[10:11], v48 offset:1536
 ds_read_b64_tr_b16 a[12:13], v46 offset:12288
 ds_read_b64_tr_b16 a[14:15], v46 offset:13824
 ds_read_b64_tr_b16 a[16:17], v47 offset:12288
 ds_read_b64_tr_b16 a[18:19], v47 offset:13824
 ds_read_b64_tr_b16 a[20:21], v48 offset:12288
 ds_read_b64_tr_b16 a[22:23], v48 offset:13824
 ds_read_b64_tr_b16 a[24:25], v46 offset:24576
 ds_read_b64_tr_b16 a[26:27], v46 offset:26112
 ds_read_b64_tr_b16 a[28:29], v47 offset:24576
 ds_read_b64_tr_b16 a[30:31], v47 offset:26112
 ds_read_b64_tr_b16 a[32:33], v48 offset:24576
 ds_read_b64_tr_b16 a[34:35], v48 offset:26112
 ds_read_b64_tr_b16 a[36:37], v46 offset:36864
 ds_read_b64_tr_b16 a[38:39], v46 offset:38400
 ds_read_b64_tr_b16 a[40:41], v47 offset:36864
 ds_read_b64_tr_b16 a[42:43], v47 offset:38400
 ds_read_b64_tr_b16 a[44:45], v48 offset:36864
 ds_read_b64_tr_b16 a[46:47], v48 offset:38400
 ds_read_b64_tr_b16 a[48:49], v46 offset:49152
 ds_read_b64_tr_b16 a[50:51], v46 offset:50688
 ds_read_b64_tr_b16 a[52:53], v47 offset:49152
 ds_read_b64_tr_b16 a[54:55], v47 offset:50688
 ds_read_b64_tr_b16 a[56:57], v48 offset:49152
 ds_read_b64_tr_b16 a[58:59], v48 offset:50688
 v_lshrrev_b32 v11, 3, v1
 v_and_b32 v12, 7, v1
 v_xor_b32 v12, v12, v11
 v_mul_u32_u24 v11, 1280, v11
 v_lshl_add_u32 v10, v12, 4, v11
 s_mul_i32 s46, s20, 40960
 v_add_u32 v10, s46, v10
 s_lshl_b32 s47, s20, 12
 s_add_u32 s47, s47, 0
 s_add_u32 s46, s47, 98304
 s_mov_b32 s30, s24
 s_add_u32 s32, s47, 0
 v_add_u32 v11, 9216, v10
 v_add_u32 v12, 18432, v10
 v_add_u32 v13, 27648, v10
 s_mov_b32 m0, s32
 s_nop 0
 buffer_load_dwordx4 v10, s[8:11], s30 offen offset:0 lds
 buffer_load_dwordx4 v11, s[8:11], s30 offen offset:1024 lds
 buffer_load_dwordx4 v12, s[8:11], s30 offen offset:2048 lds
 buffer_load_dwordx4 v13, s[8:11], s30 offen offset:3072 lds
 s_add_u32 s30, s30, 128
 s_add_u32 s32, s32, 16384
 s_cmp_lt_u32 s32, s46
 s_cselect_b32 s32, s32, s47
 s_mov_b32 m0, s32
 s_nop 0
 buffer_load_dwordx4 v10, s[8:11], s30 offen offset:0 lds
 buffer_load_dwordx4 v11, s[8:11], s30 offen offset:1024 lds
 buffer_load_dwordx4 v12, s[8:11], s30 offen offset:2048 lds
 buffer_load_dwordx4 v13, s[8:11], s30 offen offset:3072 lds
 s_add_u32 s30, s30, 128
 s_add_u32 s32, s32, 16384
 s_cmp_lt_u32 s32, s46
 s_cselect_b32 s32, s32, s47
 s_mov_b32 m0, s32
 s_nop 0
 buffer_load_dwordx4 v10, s[8:11], s30 offen offset:0 lds
 buffer_load_dwordx4 v11, s[8:11], s30 offen offset:1024 lds
 buffer_load_dwordx4 v12, s[8:11], s30 offen offset:2048 lds
 buffer_load_dwordx4 v13, s[8:11], s30 offen offset:3072 lds
 s_add_u32 s30, s30, 128
 s_add_u32 s32, s32, 16384
 s_cmp_lt_u32 s32, s46
 s_cselect_b32 s32, s32, s47
 s_mov_b32 m0, s32
 s_nop 0
 buffer_load_dwordx4 v10, s[8:11], s30 offen offset:0 lds
 buffer_load_dwordx4 v11, s[8:11], s30 offen offset:1024 lds
 buffer_load_dwordx4 v12, s[8:11], s30 offen offset:2048 lds
 buffer_load_dwordx4 v13, s[8:11], s30 offen offset:3072 lds
 s_add_u32 s30, s30, 128
 s_add_u32 s32, s32, 16384
 s_cmp_lt_u32 s32, s46
 s_cselect_b32 s32, s32, s47
 s_waitcnt lgkmcnt(0)
 s_barrier
 s_waitcnt vmcnt(46)
 ds_write_b128 v49, v[64:67] offset:0
 ds_write_b128 v49, v[68:71] offset:1024
 ds_write_b128 v49, v[72:75] offset:2048
 ds_write_b128 v49, v[76:79] offset:3072
 ds_write_b128 v49, v[80:83] offset:4096
 ds_write_b128 v49, v[84:87] offset:5120
 ds_write_b128 v49, v[88:91] offset:6144
 ds_write_b128 v49, v[92:95] offset:7168
 ds_write_b128 v49, v[96:99] offset:8192
 ds_write_b128 v49, v[100:103] offset:9216
 ds_write_b128 v49, v[104:107] offset:10240
 ds_write_b128 v49, v[108:111] offset:11264
 ds_write_b128 v49, v[112:115] offset:12288
 ds_write_b128 v49, v[116:119] offset:13312
 ds_write_b128 v49, v[120:123] offset:14336
 s_waitcnt lgkmcnt(0)
 s_barrier
 ds_read_b64_tr_b16 a[60:61], v46 offset:0
 ds_read_b64_tr_b16 a[62:63], v46 offset:1536
 ds_read_b64_tr_b16 a[64:65], v47 offset:0
 ds_read_b64_tr_b16 a[66:67], v47 offset:1536
 ds_read_b64_tr_b16 a[68:69], v48 offset:0
 ds_read_b64_tr_b16 a[70:71], v48 offset:1536
 ds_read_b64_tr_b16 a[72:73], v46 offset:12288
 ds_read_b64_tr_b16 a[74:75], v46 offset:13824
 ds_read_b64_tr_b16 a[76:77], v47 offset:12288
 ds_read_b64_tr_b16 a[78:79], v47 offset:13824
 ds_read_b64_tr_b16 a[80:81], v48 offset:12288
 ds_read_b64_tr_b16 a[82:83], v48 offset:13824
 ds_read_b64_tr_b16 a[84:85], v46 offset:24576
 ds_read_b64_tr_b16 a[86:87], v46 offset:26112
 ds_read_b64_tr_b16 a[88:89], v47 offset:24576
 ds_read_b64_tr_b16 a[90:91], v47 offset:26112
 ds_read_b64_tr_b16 a[92:93], v48 offset:24576
 ds_read_b64_tr_b16 a[94:95], v48 offset:26112
 ds_read_b64_tr_b16 a[96:97], v46 offset:36864
 ds_read_b64_tr_b16 a[98:99], v46 offset:38400
 ds_read_b64_tr_b16 a[100:101], v47 offset:36864
 ds_read_b64_tr_b16 a[102:103], v47 offset:38400
 ds_read_b64_tr_b16 a[104:105], v48 offset:36864
 ds_read_b64_tr_b16 a[106:107], v48 offset:38400
 ds_read_b64_tr_b16 a[108:109], v46 offset:49152
 ds_read_b64_tr_b16 a[110:111], v46 offset:50688
 ds_read_b64_tr_b16 a[112:113], v47 offset:49152
 ds_read_b64_tr_b16 a[114:115], v47 offset:50688
 ds_read_b64_tr_b16 a[116:117], v48 offset:49152
 ds_read_b64_tr_b16 a[118:119], v48 offset:50688
 s_waitcnt lgkmcnt(0)
 s_barrier
 s_waitcnt vmcnt(31)
 ds_write_b128 v49, v[124:127] offset:0
 ds_write_b128 v49, v[128:131] offset:1024
 ds_write_b128 v49, v[132:135] offset:2048
 ds_write_b128 v49, v[136:139] offset:3072
 ds_write_b128 v49, v[140:143] offset:4096
 ds_write_b128 v49, v[144:147] offset:5120
 ds_write_b128 v49, v[148:151] offset:6144
 ds_write_b128 v49, v[152:155] offset:7168
 ds_write_b128 v49, v[156:159] offset:8192
 ds_write_b128 v49, v[160:163] offset:9216
 ds_write_b128 v49, v[164:167] offset:10240
 ds_write_b128 v49, v[168:171] offset:11264
 ds_write_b128 v49, v[172:175] offset:12288
 ds_write_b128 v49, v[176:179] offset:13312
 ds_write_b128 v49, v[180:183] offset:14336
 s_waitcnt lgkmcnt(0)
 s_barrier
 ds_read_b64_tr_b16 a[120:121], v46 offset:0
 ds_read_b64_tr_b16 a[122:123], v46 offset:1536
 ds_read_b64_tr_b16 a[124:125], v47 offset:0
 ds_read_b64_tr_b16 a[126:127], v47 offset:1536
 ds_read_b64_tr_b16 a[128:129], v48 offset:0
 ds_read_b64_tr_b16 a[130:131], v48 offset:1536
 ds_read_b64_tr_b16 a[132:133], v46 offset:12288
 ds_read_b64_tr_b16 a[134:135], v46 offset:13824
 ds_read_b64_tr_b16 a[136:137], v47 offset:12288
 ds_read_b64_tr_b16 a[138:139], v47 offset:13824
 ds_read_b64_tr_b16 a[140:141], v48 offset:12288
 ds_read_b64_tr_b16 a[142:143], v48 offset:13824
 ds_read_b64_tr_b16 a[144:145], v46 offset:24576
 ds_read_b64_tr_b16 a[146:147], v46 offset:26112
 ds_read_b64_tr_b16 a[148:149], v47 offset:24576
 ds_read_b64_tr_b16 a[150:151], v47 offset:26112
 ds_read_b64_tr_b16 a[152:153], v48 offset:24576
 ds_read_b64_tr_b16 a[154:155], v48 offset:26112
 ds_read_b64_tr_b16 a[156:157], v46 offset:36864
 ds_read_b64_tr_b16 a[158:159], v46 offset:38400
 ds_read_b64_tr_b16 a[160:161], v47 offset:36864
 ds_read_b64_tr_b16 a[162:163], v47 offset:38400
 ds_read_b64_tr_b16 a[164:165], v48 offset:36864
 ds_read_b64_tr_b16 a[166:167], v48 offset:38400
 ds_read_b64_tr_b16 a[168:169], v46 offset:49152
 ds_read_b64_tr_b16 a[170:171], v46 offset:50688
 ds_read_b64_tr_b16 a[172:173], v47 offset:49152
 ds_read_b64_tr_b16 a[174:175], v47 offset:50688
 ds_read_b64_tr_b16 a[176:177], v48 offset:49152
 ds_read_b64_tr_b16 a[178:179], v48 offset:50688
 s_waitcnt lgkmcnt(0)
 s_barrier
 s_waitcnt vmcnt(16)
 ds_write_b128 v49, v[184:187] offset:0
 ds_write_b128 v49, v[188:191] offset:1024
 ds_write_b128 v49, v[192:195] offset:2048
 ds_write_b128 v49, v[196:199] offset:3072
 ds_write_b128 v49, v[200:203] offset:4096
 ds_write_b128 v49, v[204:207] offset:5120
 ds_write_b128 v49, v[208:211] offset:6144
 ds_write_b128 v49, v[212:215] offset:7168
 ds_write_b128 v49, v[216:219] offset:8192
 ds_write_b128 v49, v[220:223] offset:9216
 ds_write_b128 v49, v[224:227] offset:10240
 ds_write_b128 v49, v[228:231] offset:11264
 ds_write_b128 v49, v[232:235] offset:12288
 ds_write_b128 v49, v[236:239] offset:13312
 ds_write_b128 v49, v[240:243] offset:14336
 s_waitcnt lgkmcnt(0)
 s_barrier
 ds_read_b64_tr_b16 a[180:181], v46 offset:0
 ds_read_b64_tr_b16 a[182:183], v46 offset:1536
 ds_read_b64_tr_b16 a[184:185], v47 offset:0
 ds_read_b64_tr_b16 a[186:187], v47 offset:1536
 ds_read_b64_tr_b16 a[188:189], v48 offset:0
 ds_read_b64_tr_b16 a[190:191], v48 offset:1536
 ds_read_b64_tr_b16 a[192:193], v46 offset:12288
 ds_read_b64_tr_b16 a[194:195], v46 offset:13824
 ds_read_b64_tr_b16 a[196:197], v47 offset:12288
 ds_read_b64_tr_b16 a[198:199], v47 offset:13824
 ds_read_b64_tr_b16 a[200:201], v48 offset:12288
 ds_read_b64_tr_b16 a[202:203], v48 offset:13824
 ds_read_b64_tr_b16 a[204:205], v46 offset:24576
 ds_read_b64_tr_b16 a[206:207], v46 offset:26112
 ds_read_b64_tr_b16 a[208:209], v47 offset:24576
 ds_read_b64_tr_b16 a[210:211], v47 offset:26112
 ds_read_b64_tr_b16 a[212:213], v48 offset:24576
 ds_read_b64_tr_b16 a[214:215], v48 offset:26112
 ds_read_b64_tr_b16 a[216:217], v46 offset:36864
 ds_read_b64_tr_b16 a[218:219], v46 offset:38400
 ds_read_b64_tr_b16 a[220:221], v47 offset:36864
 ds_read_b64_tr_b16 a[222:223], v47 offset:38400
 ds_read_b64_tr_b16 a[224:225], v48 offset:36864
 ds_read_b64_tr_b16 a[226:227], v48 offset:38400
 ds_read_b64_tr_b16 a[228:229], v46 offset:49152
 ds_read_b64_tr_b16 a[230:231], v46 offset:50688
 ds_read_b64_tr_b16 a[232:233], v47 offset:49152
 ds_read_b64_tr_b16 a[234:235], v47 offset:50688
 ds_read_b64_tr_b16 a[236:237], v48 offset:49152
 ds_read_b64_tr_b16 a[238:239], v48 offset:50688
 s_waitcnt lgkmcnt(0)
 s_barrier
 s_add_u32 s12, s38, 57671680
 s_addc_u32 s13, s39, 0
 s_mov_b32 s14, 1572864
 s_mov_b32 s15, 0x00020000
 s_mul_i32 s21, s20, 12800
 s_add_u32 s21, s21, 98304
 v_mul_u32_u24 v4, 400, v2
 v_lshlrev_b32 v5, 4, v3
 v_add3_u32 v29, v4, v5, s21
 v_lshlrev_b32 v30, 4, v1
 v_and_b32 v4, 1, v2
 v_bfe_u32 v5, v2, 1, 1
 v_lshl_or_b32 v4, v5, 2, v4
 v_bfe_u32 v5, v2, 2, 1
 v_lshl_or_b32 v4, v5, 1, v4
 v_lshlrev_b32 v4, 4, v4
 v_lshl_add_u32 v31, v3, 7, v4
 v_lshlrev_b32 v32, 3, v1
 v_and_b32 v4, 3, v1
 v_lshlrev_b32 v33, 3, v4
 v_mov_b32 v34, 0xf149f2ca
 v_lshlrev_b32 v4, 2, v3
 v_sub_u32 v35, v2, v4
 v_cmp_gt_u32 s[60:61], 2, v3
 s_mov_b32 s62, 0x3d93cd3a
 s_mov_b32 s63, 0x3fb8aa3b
 s_mov_b32 s83, 0x3dd53b95
 v_cmp_le_i32 s[64:65], 0, v35
 v_cmp_le_i32 s[66:67], 1, v35
 v_cmp_le_i32 s[68:69], 2, v35
 v_cmp_le_i32 s[70:71], 3, v35
 s_mov_b32 s25, 163840
 s_cmp_lg_u32 s45, 0
 s_cselect_b32 s26, 6, 10
 s_cselect_b32 s40, 6, 99
 s_cselect_b32 s25, 4294148096, s25
 s_lshl_b32 s43, s42, 2
 s_add_u32 s43, s43, s20
 s_mul_i32 s43, s43, 12288
 s_lshr_b32 s21, s42, 2
 s_lshl_b32 s21, s21, 14
 s_and_b32 s44, s42, 3
 s_lshl_b32 s44, s44, 11
 s_add_u32 s44, s44, s21
 s_add_u32 s44, s44, 655360
 s_lshr_b32 s36, s42, 1
 s_lshl_b32 s36, s36, 14
 s_and_b32 s21, s42, 1
 s_mul_i32 s21, s21, 3072
 s_add_u32 s36, s36, s21
 s_add_u32 s36, s36, 655360
 s_lshl_b32 s49, s41, 2
 s_add_u32 s49, s49, s20
 s_mov_b32 s29, 4
 s_mov_b32 s78, 0
 s_mov_b32 s81, 0x80000000
 s_mov_b32 s82, 0
 s_mul_i32 s21, s49, 393216
 s_mul_i32 s22, s42, 12288
 s_add_u32 s50, s21, s22
 s_lshr_b32 s21, s49, 1
 s_bitcmp1_b32 s37, s21
 s_cselect_b32 s21, 8192, 0
 s_lshl_b32 s51, s49, 20
 s_or_b32 s51, s51, s21
 s_xor_b32 s51, s51, 8192
 s_add_u32 s51, s51, s36
 s_lshr_b32 s22, s49, 1
 s_lshr_b32 s21, s49, 2
 s_add_u32 s21, s21, 3
 s_cmp_lt_u32 s49, 12
 s_cselect_b32 s21, s22, s21
 s_lshl_b32 s21, s21, 3
 s_lshr_b32 s22, s42, 2
 s_add_u32 s21, s21, s22
 s_lshl_b32 s21, s21, 7
 s_add_u32 s76, s21, 0
 s_lshl_b32 s77, s42, 7
 s_add_u32 s77, s77, 19456
 v_mov_b32 v21, 0
 buffer_load_dword v21, v33, s[72:75], s77 offen sc1
 v_and_b32 v6, 7, v2
 v_add_u32 v4, 0, v3
 v_xor_b32 v4, v4, v6
 v_lshlrev_b32 v4, 4, v4
 v_lshl_add_u32 v14, v2, 7, v4
 v_add_u32 v4, 4, v3
 v_xor_b32 v4, v4, v6
 v_lshlrev_b32 v4, 4, v4
 v_lshl_add_u32 v15, v2, 7, v4
 v_mul_u32_u24 v22, 400, v2
 v_mul_u32_u24 v4, 16, v3
 s_mul_i32 s21, s20, 96
 s_add_u32 s21, s21, 98304
 v_add3_u32 v22, v22, v4, s21
 v_lshlrev_b32 v4, 3, v3
 v_sub_u32 v16, v22, v4
 v_mov_b32 v9, 2731
 s_mov_b32 s33, 0
 s_mov_b32 s48, 0x80000000
 s_mov_b32 m0, s32
 s_nop 0
 buffer_load_dwordx4 v10, s[8:11], s30 offen offset:0 lds
 buffer_load_dwordx4 v11, s[8:11], s30 offen offset:1024 lds
 s_waitcnt vmcnt(14)
 s_barrier
 v_add_u32 v18, s33, v14
 v_add_u32 v19, s33, v15
 s_add_u32 s33, s33, 16384
 s_cmp_lt_u32 s33, 98304
 s_cselect_b32 s33, s33, 0
 ds_read_b128 v[160:163], v18 offset:0
 ds_read_b128 v[164:167], v18 offset:2048
 ds_read_b128 v[168:171], v18 offset:4096
 ds_read_b128 v[172:175], v18 offset:6144
 ds_read_b128 v[176:179], v18 offset:8192
 ds_read_b128 v[180:183], v18 offset:10240
 ds_read_b128 v[184:187], v18 offset:12288
 ds_read_b128 v[188:191], v18 offset:14336
 s_waitcnt lgkmcnt(0)
qa_blk_203:
 v_mfma_f32_16x16x32_bf16 v[64:67], a[0:3], v[160:163], 0
 ds_read_b128 v[192:195], v19 offset:0
 v_mfma_f32_16x16x32_bf16 v[68:71], a[4:7], v[160:163], 0
 v_add_u32 v18, s33, v14
 v_cndmask_b32 v36, v34, v36, s[64:65]
 v_mfma_f32_16x16x32_bf16 v[72:75], a[8:11], v[160:163], 0
 v_cndmask_b32 v48, v34, v48, s[64:65]
 v_cndmask_b32 v37, v34, v37, s[66:67]
 v_mfma_f32_16x16x32_bf16 v[76:79], a[0:3], v[164:167], 0
 ds_read_b128 v[196:199], v19 offset:2048
 v_cndmask_b32 v49, v34, v49, s[66:67]
 v_mfma_f32_16x16x32_bf16 v[80:83], a[4:7], v[164:167], 0
 buffer_load_dwordx4 v12, s[8:11], s30 offen offset:2048 lds
 v_mfma_f32_16x16x32_bf16 v[84:87], a[8:11], v[164:167], 0
 v_cndmask_b32 v38, v34, v38, s[68:69]
 v_cndmask_b32 v50, v34, v50, s[68:69]
 v_mfma_f32_16x16x32_bf16 v[88:91], a[0:3], v[168:171], 0
 ds_read_b128 v[200:203], v19 offset:4096
 v_cndmask_b32 v39, v34, v39, s[70:71]
 v_mfma_f32_16x16x32_bf16 v[92:95], a[4:7], v[168:171], 0
 v_cndmask_b32 v51, v34, v51, s[70:71]
 v_max3_f32 v56, v36, v37, v38
 v_mfma_f32_16x16x32_bf16 v[96:99], a[8:11], v[168:171], 0
 v_max3_f32 v56, v56, v39, v40
 v_max3_f32 v56, v56, v41, v42
 v_mfma_f32_16x16x32_bf16 v[100:103], a[0:3], v[172:175], 0
 ds_read_b128 v[204:207], v19 offset:6144
 v_max_f32 v56, v56, v43
 v_mfma_f32_16x16x32_bf16 v[104:107], a[4:7], v[172:175], 0
 v_mov_b32 v57, v56
 v_mfma_f32_16x16x32_bf16 v[108:111], a[8:11], v[172:175], 0
 s_waitcnt lgkmcnt(15)
 v_mfma_f32_16x16x32_bf16 v[112:115], a[0:3], v[176:179], 0
 ds_read_b128 v[208:211], v19 offset:8192
 v_mfma_f32_16x16x32_bf16 v[116:119], a[4:7], v[176:179], 0
 s_nop 1
 v_mfma_f32_16x16x32_bf16 v[120:123], a[8:11], v[176:179], 0
 v_permlane32_swap_b32 v56, v57
 v_mfma_f32_16x16x32_bf16 v[124:127], a[0:3], v[180:183], 0
 ds_read_b128 v[212:215], v19 offset:10240
 v_max_f32 v56, v56, v57
 v_mfma_f32_16x16x32_bf16 v[128:131], a[4:7], v[180:183], 0
 buffer_load_dwordx4 v13, s[8:11], s30 offen offset:3072 lds
 v_mfma_f32_16x16x32_bf16 v[132:135], a[8:11], v[180:183], 0
 s_add_u32 s30, s30, 128
 s_add_u32 m0, m0, 16384
 v_mfma_f32_16x16x32_bf16 v[136:139], a[0:3], v[184:187], 0
 ds_read_b128 v[216:219], v19 offset:12288
 v_mov_b32 v57, v56
 v_mfma_f32_16x16x32_bf16 v[140:143], a[4:7], v[184:187], 0
 s_cmp_lt_u32 m0, s46
 s_cselect_b32 m0, m0, s47
 v_mfma_f32_16x16x32_bf16 v[144:147], a[8:11], v[184:187], 0
 s_nop 1
 v_mfma_f32_16x16x32_bf16 v[148:151], a[0:3], v[188:191], 0
 ds_read_b128 v[220:223], v19 offset:14336
 v_mfma_f32_16x16x32_bf16 v[152:155], a[4:7], v[188:191], 0
 v_permlane16_swap_b32 v56, v57
 v_mfma_f32_16x16x32_bf16 v[156:159], a[8:11], v[188:191], 0
 s_waitcnt vmcnt(12) lgkmcnt(4)
 s_barrier
 v_mfma_f32_16x16x32_bf16 v[64:67], a[12:15], v[192:195], v[64:67]
 ds_read_b128 v[160:163], v18 offset:0
 v_max_f32 v56, v56, v57
 v_mfma_f32_16x16x32_bf16 v[68:71], a[16:19], v[192:195], v[68:71]
 v_mul_f32 v56, s83, v56
 v_fma_f32 v36, v36, s83, -v56
 v_mfma_f32_16x16x32_bf16 v[72:75], a[20:23], v[192:195], v[72:75]
 v_add_u32 v19, s33, v15
 s_add_u32 s33, s33, 16384
 v_mfma_f32_16x16x32_bf16 v[76:79], a[12:15], v[196:199], v[76:79]
 ds_read_b128 v[164:167], v18 offset:2048
 s_mul_i32 s21, s49, 393216
 v_mfma_f32_16x16x32_bf16 v[80:83], a[16:19], v[196:199], v[80:83]
 buffer_load_dwordx4 v10, s[8:11], s30 offen offset:0 lds
 v_mfma_f32_16x16x32_bf16 v[84:87], a[20:23], v[196:199], v[84:87]
 s_cmp_lt_u32 s33, 98304
 s_cselect_b32 s33, s33, 0
 v_mfma_f32_16x16x32_bf16 v[88:91], a[12:15], v[200:203], v[88:91]
 ds_read_b128 v[168:171], v18 offset:4096
 s_mul_i32 s22, s42, 12288
 v_mfma_f32_16x16x32_bf16 v[92:95], a[16:19], v[200:203], v[92:95]
 s_add_u32 s50, s21, s22
 s_lshr_b32 s21, s49, 1
 v_mfma_f32_16x16x32_bf16 v[96:99], a[20:23], v[200:203], v[96:99]
 s_bitcmp1_b32 s37, s21
 s_cselect_b32 s21, 8192, 0
 v_mfma_f32_16x16x32_bf16 v[100:103], a[12:15], v[204:207], v[100:103]
 ds_read_b128 v[172:175], v18 offset:6144
 s_lshl_b32 s51, s49, 20
 v_mfma_f32_16x16x32_bf16 v[104:107], a[16:19], v[204:207], v[104:107]
 s_or_b32 s51, s51, s21
 s_xor_b32 s51, s51, 8192
 v_mfma_f32_16x16x32_bf16 v[108:111], a[20:23], v[204:207], v[108:111]
 s_waitcnt lgkmcnt(4)
 s_add_u32 s51, s51, s36
 v_mfma_f32_16x16x32_bf16 v[112:115], a[12:15], v[208:211], v[112:115]
 ds_read_b128 v[176:179], v18 offset:8192
 s_add_u32 s23, s49, 1
 v_mfma_f32_16x16x32_bf16 v[116:119], a[16:19], v[208:211], v[116:119]
 v_cmp_gt_u32 vcc, s23, v21
 v_fma_f32 v37, v37, s83, -v56
 v_mfma_f32_16x16x32_bf16 v[120:123], a[20:23], v[208:211], v[120:123]
 s_cmp_eq_u64 vcc, 0
 s_cselect_b32 s80, 1, 0
 s_cselect_b32 s51, s51, 0x80000000
 v_mfma_f32_16x16x32_bf16 v[124:127], a[12:15], v[212:215], v[124:127]
 ds_read_b128 v[180:183], v18 offset:10240
 s_lshl_b32 s79, s80, 3
 v_mfma_f32_16x16x32_bf16 v[128:131], a[16:19], v[212:215], v[128:131]
 buffer_load_dwordx4 v11, s[8:11], s30 offen offset:1024 lds
 v_mfma_f32_16x16x32_bf16 v[132:135], a[20:23], v[212:215], v[132:135]
 s_or_b32 s79, s79, s45
 v_fma_f32 v38, v38, s83, -v56
 v_mfma_f32_16x16x32_bf16 v[136:139], a[12:15], v[216:219], v[136:139]
 ds_read_b128 v[184:187], v18 offset:12288
 v_fma_f32 v39, v39, s83, -v56
 v_mfma_f32_16x16x32_bf16 v[140:143], a[16:19], v[216:219], v[140:143]
 buffer_load_dwordx4 a[240:243], v31, s[52:55], s51 offen offset:0 sc1
 v_mfma_f32_16x16x32_bf16 v[144:147], a[20:23], v[216:219], v[144:147]
 v_fma_f32 v40, v40, s83, -v56
 v_fma_f32 v41, v41, s83, -v56
 v_mfma_f32_16x16x32_bf16 v[148:151], a[12:15], v[220:223], v[148:151]
 ds_read_b128 v[188:191], v18 offset:14336
 v_fma_f32 v42, v42, s83, -v56
 v_mfma_f32_16x16x32_bf16 v[152:155], a[16:19], v[220:223], v[152:155]
 v_fma_f32 v43, v43, s83, -v56
 v_mfma_f32_16x16x32_bf16 v[156:159], a[20:23], v[220:223], v[156:159]
 s_waitcnt lgkmcnt(4)
 v_mfma_f32_16x16x32_bf16 v[64:67], a[24:27], v[160:163], v[64:67]
 ds_read_b128 v[192:195], v19 offset:0
 v_mfma_f32_16x16x32_bf16 v[68:71], a[28:31], v[160:163], v[68:71]
 v_add_u32 v18, s33, v14
 v_mfma_f32_16x16x32_bf16 v[72:75], a[32:35], v[160:163], v[72:75]
 v_exp_f32 v36, v36
 v_mfma_f32_16x16x32_bf16 v[76:79], a[24:27], v[164:167], v[76:79]
 ds_read_b128 v[196:199], v19 offset:2048
 v_mfma_f32_16x16x32_bf16 v[80:83], a[28:31], v[164:167], v[80:83]
 buffer_load_dwordx4 v12, s[8:11], s30 offen offset:2048 lds
 v_mfma_f32_16x16x32_bf16 v[84:87], a[32:35], v[164:167], v[84:87]
 v_exp_f32 v37, v37
 v_mfma_f32_16x16x32_bf16 v[88:91], a[24:27], v[168:171], v[88:91]
 ds_read_b128 v[200:203], v19 offset:4096
 v_mfma_f32_16x16x32_bf16 v[92:95], a[28:31], v[168:171], v[92:95]
 v_exp_f32 v38, v38
 v_mfma_f32_16x16x32_bf16 v[96:99], a[32:35], v[168:171], v[96:99]
 v_exp_f32 v39, v39
 v_mfma_f32_16x16x32_bf16 v[100:103], a[24:27], v[172:175], v[100:103]
 ds_read_b128 v[204:207], v19 offset:6144
 v_mfma_f32_16x16x32_bf16 v[104:107], a[28:31], v[172:175], v[104:107]
 v_exp_f32 v40, v40
 v_mfma_f32_16x16x32_bf16 v[108:111], a[32:35], v[172:175], v[108:111]
 s_waitcnt lgkmcnt(4)
 v_mfma_f32_16x16x32_bf16 v[112:115], a[24:27], v[176:179], v[112:115]
 ds_read_b128 v[208:211], v19 offset:8192
 v_mfma_f32_16x16x32_bf16 v[116:119], a[28:31], v[176:179], v[116:119]
 v_exp_f32 v41, v41
 v_mfma_f32_16x16x32_bf16 v[120:123], a[32:35], v[176:179], v[120:123]
 v_exp_f32 v42, v42
 v_mfma_f32_16x16x32_bf16 v[124:127], a[24:27], v[180:183], v[124:127]
 ds_read_b128 v[212:215], v19 offset:10240
 v_mfma_f32_16x16x32_bf16 v[128:131], a[28:31], v[180:183], v[128:131]
 buffer_load_dwordx4 v13, s[8:11], s30 offen offset:3072 lds
 v_mfma_f32_16x16x32_bf16 v[132:135], a[32:35], v[180:183], v[132:135]
 s_add_u32 s30, s30, 128
 s_add_u32 m0, m0, 16384
 v_mfma_f32_16x16x32_bf16 v[136:139], a[24:27], v[184:187], v[136:139]
 ds_read_b128 v[216:219], v19 offset:12288
 v_mfma_f32_16x16x32_bf16 v[140:143], a[28:31], v[184:187], v[140:143]
 s_cmp_lt_u32 m0, s46
 s_cselect_b32 m0, m0, s47
 v_mfma_f32_16x16x32_bf16 v[144:147], a[32:35], v[184:187], v[144:147]
 buffer_load_dwordx4 a[244:247], v31, s[52:55], s51 offen offset:512 sc1
 v_mfma_f32_16x16x32_bf16 v[148:151], a[24:27], v[188:191], v[148:151]
 ds_read_b128 v[220:223], v19 offset:14336
 v_mfma_f32_16x16x32_bf16 v[152:155], a[28:31], v[188:191], v[152:155]
 v_exp_f32 v43, v43
 v_mfma_f32_16x16x32_bf16 v[156:159], a[32:35], v[188:191], v[156:159]
 s_waitcnt vmcnt(14) lgkmcnt(4)
 s_barrier
 v_mfma_f32_16x16x32_bf16 v[64:67], a[36:39], v[192:195], v[64:67]
 ds_read_b128 v[160:163], v18 offset:0
 s_nop 0
 v_mfma_f32_16x16x32_bf16 v[68:71], a[40:43], v[192:195], v[68:71]
 v_add_f32 v56, v40, v41
 v_add_f32 v56, v56, v42
 v_mfma_f32_16x16x32_bf16 v[72:75], a[44:47], v[192:195], v[72:75]
 v_add_u32 v19, s33, v15
 s_add_u32 s33, s33, 16384
 v_mfma_f32_16x16x32_bf16 v[76:79], a[36:39], v[196:199], v[76:79]
 ds_read_b128 v[164:167], v18 offset:2048
 v_add_f32 v56, v56, v43
 v_mfma_f32_16x16x32_bf16 v[80:83], a[40:43], v[196:199], v[80:83]
 buffer_load_dwordx4 v10, s[8:11], s30 offen offset:0 lds
 v_mfma_f32_16x16x32_bf16 v[84:87], a[44:47], v[196:199], v[84:87]
 s_cmp_lt_u32 s33, 98304
 s_cselect_b32 s33, s33, 0
 v_mfma_f32_16x16x32_bf16 v[88:91], a[36:39], v[200:203], v[88:91]
 ds_read_b128 v[168:171], v18 offset:4096
 v_cndmask_b32 v56, 0, v56, s[60:61]
 v_mfma_f32_16x16x32_bf16 v[92:95], a[40:43], v[200:203], v[92:95]
 v_add_f32 v56, v56, v36
 v_add_f32 v56, v56, v37
 v_mfma_f32_16x16x32_bf16 v[96:99], a[44:47], v[200:203], v[96:99]
 v_add_f32 v56, v56, v38
 v_add_f32 v56, v56, v39
 v_mfma_f32_16x16x32_bf16 v[100:103], a[36:39], v[204:207], v[100:103]
 ds_read_b128 v[172:175], v18 offset:6144
 v_mov_b32 v57, v56
 v_mfma_f32_16x16x32_bf16 v[104:107], a[40:43], v[204:207], v[104:107]
 s_nop 1
 v_mfma_f32_16x16x32_bf16 v[108:111], a[44:47], v[204:207], v[108:111]
 s_waitcnt lgkmcnt(4)
 v_mfma_f32_16x16x32_bf16 v[112:115], a[36:39], v[208:211], v[112:115]
 ds_read_b128 v[176:179], v18 offset:8192
 v_mfma_f32_16x16x32_bf16 v[116:119], a[40:43], v[208:211], v[116:119]
 v_permlane32_swap_b32 v56, v57
 v_mfma_f32_16x16x32_bf16 v[120:123], a[44:47], v[208:211], v[120:123]
 v_add_f32 v56, v56, v57
 v_mov_b32 v57, v56
 v_mfma_f32_16x16x32_bf16 v[124:127], a[36:39], v[212:215], v[124:127]
 ds_read_b128 v[180:183], v18 offset:10240
 v_mfma_f32_16x16x32_bf16 v[128:131], a[40:43], v[212:215], v[128:131]
 buffer_load_dwordx4 v11, s[8:11], s30 offen offset:1024 lds
 v_mfma_f32_16x16x32_bf16 v[132:135], a[44:47], v[212:215], v[132:135]
 buffer_load_dwordx4 a[248:251], v31, s[52:55], s51 offen offset:1024 sc1
 v_mfma_f32_16x16x32_bf16 v[136:139], a[36:39], v[216:219], v[136:139]
 ds_read_b128 v[184:187], v18 offset:12288
 v_mfma_f32_16x16x32_bf16 v[140:143], a[40:43], v[216:219], v[140:143]
 s_nop 1
 v_mfma_f32_16x16x32_bf16 v[144:147], a[44:47], v[216:219], v[144:147]
 v_permlane16_swap_b32 v56, v57
 v_mfma_f32_16x16x32_bf16 v[148:151], a[36:39], v[220:223], v[148:151]
 ds_read_b128 v[188:191], v18 offset:14336
 v_add_f32 v56, v56, v57
 v_mfma_f32_16x16x32_bf16 v[152:155], a[40:43], v[220:223], v[152:155]
 v_rcp_f32 v56, v56
 v_mfma_f32_16x16x32_bf16 v[156:159], a[44:47], v[220:223], v[156:159]
 s_waitcnt lgkmcnt(4)
 s_nop 0
 v_mfma_f32_16x16x32_bf16 v[64:67], a[48:51], v[160:163], v[64:67]
 ds_read_b128 v[192:195], v19 offset:0
 v_mul_f32 v36, v36, v56
 v_mfma_f32_16x16x32_bf16 v[68:71], a[52:55], v[160:163], v[68:71]
 v_add_u32 v18, s33, v14
 v_mul_f32 v37, v37, v56
 v_mfma_f32_16x16x32_bf16 v[72:75], a[56:59], v[160:163], v[72:75]
 v_mul_f32 v38, v38, v56
 v_mul_f32 v39, v39, v56
 v_mfma_f32_16x16x32_bf16 v[76:79], a[48:51], v[164:167], v[76:79]
 ds_read_b128 v[196:199], v19 offset:2048
 v_mul_f32 v40, v40, v56
 v_mfma_f32_16x16x32_bf16 v[80:83], a[52:55], v[164:167], v[80:83]
 buffer_load_dwordx4 v12, s[8:11], s30 offen offset:2048 lds
 v_mfma_f32_16x16x32_bf16 v[84:87], a[56:59], v[164:167], v[84:87]
 v_mul_f32 v41, v41, v56
 v_mul_f32 v42, v42, v56
 v_mfma_f32_16x16x32_bf16 v[88:91], a[48:51], v[168:171], v[88:91]
 ds_read_b128 v[200:203], v19 offset:4096
 v_mul_f32 v43, v43, v56
 v_mfma_f32_16x16x32_bf16 v[92:95], a[52:55], v[168:171], v[92:95]
 v_max3_f32 v56, v44, v45, v46
 v_max3_f32 v56, v56, v47, v48
 v_mfma_f32_16x16x32_bf16 v[96:99], a[56:59], v[168:171], v[96:99]
 v_max3_f32 v56, v56, v49, v50
 v_max3_f32 v56, v56, v51, v52
 v_mfma_f32_16x16x32_bf16 v[100:103], a[48:51], v[172:175], v[100:103]
 ds_read_b128 v[204:207], v19 offset:6144
 v_max3_f32 v56, v56, v53, v54
 v_mfma_f32_16x16x32_bf16 v[104:107], a[52:55], v[172:175], v[104:107]
 v_max_f32 v56, v56, v55
 v_mov_b32 v57, v56
 v_mfma_f32_16x16x32_bf16 v[108:111], a[56:59], v[172:175], v[108:111]
 s_waitcnt lgkmcnt(4)
 v_mfma_f32_16x16x32_bf16 v[112:115], a[48:51], v[176:179], v[112:115]
 ds_read_b128 v[208:211], v19 offset:8192
 v_mfma_f32_16x16x32_bf16 v[116:119], a[52:55], v[176:179], v[116:119]
 buffer_load_dwordx4 a[252:255], v31, s[52:55], s51 offen offset:1536 sc1
 v_mfma_f32_16x16x32_bf16 v[120:123], a[56:59], v[176:179], v[120:123]
 s_nop 1
 v_mfma_f32_16x16x32_bf16 v[124:127], a[48:51], v[180:183], v[124:127]
 ds_read_b128 v[212:215], v19 offset:10240
 v_mfma_f32_16x16x32_bf16 v[128:131], a[52:55], v[180:183], v[128:131]
 buffer_load_dwordx4 v13, s[8:11], s30 offen offset:3072 lds
 v_mfma_f32_16x16x32_bf16 v[132:135], a[56:59], v[180:183], v[132:135]
 s_add_u32 s30, s30, 128
 s_add_u32 m0, m0, 16384
 v_mfma_f32_16x16x32_bf16 v[136:139], a[48:51], v[184:187], v[136:139]
 ds_read_b128 v[216:219], v19 offset:12288
 v_mfma_f32_16x16x32_bf16 v[140:143], a[52:55], v[184:187], v[140:143]
 s_cmp_lt_u32 m0, s46
 s_cselect_b32 m0, m0, s47
 v_mfma_f32_16x16x32_bf16 v[144:147], a[56:59], v[184:187], v[144:147]
 v_permlane32_swap_b32 v56, v57
 v_mfma_f32_16x16x32_bf16 v[148:151], a[48:51], v[188:191], v[148:151]
 ds_read_b128 v[220:223], v19 offset:14336
 v_max_f32 v56, v56, v57
 v_mfma_f32_16x16x32_bf16 v[152:155], a[52:55], v[188:191], v[152:155]
 v_mov_b32 v57, v56
 v_mfma_f32_16x16x32_bf16 v[156:159], a[56:59], v[188:191], v[156:159]
 s_waitcnt vmcnt(16) lgkmcnt(4)
 s_barrier
 v_mfma_f32_16x16x32_bf16 v[64:67], a[60:63], v[192:195], v[64:67]
 ds_read_b128 v[160:163], v18 offset:0
 v_mfma_f32_16x16x32_bf16 v[68:71], a[64:67], v[192:195], v[68:71]
 s_nop 1
 v_mfma_f32_16x16x32_bf16 v[72:75], a[68:71], v[192:195], v[72:75]
 v_add_u32 v19, s33, v15
 s_add_u32 s33, s33, 16384
 v_mfma_f32_16x16x32_bf16 v[76:79], a[60:63], v[196:199], v[76:79]
 ds_read_b128 v[164:167], v18 offset:2048
 v_mfma_f32_16x16x32_bf16 v[80:83], a[64:67], v[196:199], v[80:83]
 buffer_load_dwordx4 v10, s[8:11], s30 offen offset:0 lds
 v_mfma_f32_16x16x32_bf16 v[84:87], a[68:71], v[196:199], v[84:87]
 s_cmp_lt_u32 s33, 98304
 s_cselect_b32 s33, s33, 0
 v_mfma_f32_16x16x32_bf16 v[88:91], a[60:63], v[200:203], v[88:91]
 ds_read_b128 v[168:171], v18 offset:4096
 v_mfma_f32_16x16x32_bf16 v[92:95], a[64:67], v[200:203], v[92:95]
 v_permlane16_swap_b32 v56, v57
 v_mfma_f32_16x16x32_bf16 v[96:99], a[68:71], v[200:203], v[96:99]
 v_max_f32 v56, v56, v57
 v_mul_f32 v56, s83, v56
 v_mfma_f32_16x16x32_bf16 v[100:103], a[60:63], v[204:207], v[100:103]
 ds_read_b128 v[172:175], v18 offset:6144
 v_fma_f32 v44, v44, s83, -v56
 v_mfma_f32_16x16x32_bf16 v[104:107], a[64:67], v[204:207], v[104:107]
 buffer_load_dwordx4 v[24:27], v31, s[52:55], s51 offen offset:2048 sc1
 v_mfma_f32_16x16x32_bf16 v[108:111], a[68:71], v[204:207], v[108:111]
 s_waitcnt lgkmcnt(4)
 v_fma_f32 v45, v45, s83, -v56
 v_mfma_f32_16x16x32_bf16 v[112:115], a[60:63], v[208:211], v[112:115]
 ds_read_b128 v[176:179], v18 offset:8192
 v_fma_f32 v46, v46, s83, -v56
 v_mfma_f32_16x16x32_bf16 v[116:119], a[64:67], v[208:211], v[116:119]
 v_fma_f32 v47, v47, s83, -v56
 v_fma_f32 v48, v48, s83, -v56
 v_mfma_f32_16x16x32_bf16 v[120:123], a[68:71], v[208:211], v[120:123]
 v_fma_f32 v49, v49, s83, -v56
 v_fma_f32 v50, v50, s83, -v56
 v_mfma_f32_16x16x32_bf16 v[124:127], a[60:63], v[212:215], v[124:127]
 ds_read_b128 v[180:183], v18 offset:10240
 v_fma_f32 v51, v51, s83, -v56
 v_mfma_f32_16x16x32_bf16 v[128:131], a[64:67], v[212:215], v[128:131]
 buffer_load_dwordx4 v11, s[8:11], s30 offen offset:1024 lds
 v_mfma_f32_16x16x32_bf16 v[132:135], a[68:71], v[212:215], v[132:135]
 v_fma_f32 v52, v52, s83, -v56
 v_fma_f32 v53, v53, s83, -v56
 v_mfma_f32_16x16x32_bf16 v[136:139], a[60:63], v[216:219], v[136:139]
 ds_read_b128 v[184:187], v18 offset:12288
 v_fma_f32 v54, v54, s83, -v56
 v_mfma_f32_16x16x32_bf16 v[140:143], a[64:67], v[216:219], v[140:143]
 v_fma_f32 v55, v55, s83, -v56
 v_mfma_f32_16x16x32_bf16 v[144:147], a[68:71], v[216:219], v[144:147]
 v_exp_f32 v44, v44
 v_mfma_f32_16x16x32_bf16 v[148:151], a[60:63], v[220:223], v[148:151]
 ds_read_b128 v[188:191], v18 offset:14336
 v_mfma_f32_16x16x32_bf16 v[152:155], a[64:67], v[220:223], v[152:155]
 v_exp_f32 v45, v45
 v_mfma_f32_16x16x32_bf16 v[156:159], a[68:71], v[220:223], v[156:159]
 s_waitcnt lgkmcnt(4)
 v_mfma_f32_16x16x32_bf16 v[64:67], a[72:75], v[160:163], v[64:67]
 ds_read_b128 v[192:195], v19 offset:0
 v_mfma_f32_16x16x32_bf16 v[68:71], a[76:79], v[160:163], v[68:71]
 v_add_u32 v18, s33, v14
 v_mfma_f32_16x16x32_bf16 v[72:75], a[80:83], v[160:163], v[72:75]
 v_exp_f32 v46, v46
 v_mfma_f32_16x16x32_bf16 v[76:79], a[72:75], v[164:167], v[76:79]
 ds_read_b128 v[196:199], v19 offset:2048
 v_mfma_f32_16x16x32_bf16 v[80:83], a[76:79], v[164:167], v[80:83]
 buffer_load_dwordx4 v12, s[8:11], s30 offen offset:2048 lds
 v_mfma_f32_16x16x32_bf16 v[84:87], a[80:83], v[164:167], v[84:87]
 v_exp_f32 v47, v47
 v_mfma_f32_16x16x32_bf16 v[88:91], a[72:75], v[168:171], v[88:91]
 ds_read_b128 v[200:203], v19 offset:4096
 v_mfma_f32_16x16x32_bf16 v[92:95], a[76:79], v[168:171], v[92:95]
 buffer_load_dwordx4 v[6:9], v31, s[52:55], s51 offen offset:2560 sc1
 v_mfma_f32_16x16x32_bf16 v[96:99], a[80:83], v[168:171], v[96:99]
 v_exp_f32 v48, v48
 v_mfma_f32_16x16x32_bf16 v[100:103], a[72:75], v[172:175], v[100:103]
 ds_read_b128 v[204:207], v19 offset:6144
 v_mfma_f32_16x16x32_bf16 v[104:107], a[76:79], v[172:175], v[104:107]
 v_exp_f32 v49, v49
 v_mfma_f32_16x16x32_bf16 v[108:111], a[80:83], v[172:175], v[108:111]
 s_waitcnt lgkmcnt(4)
 v_mfma_f32_16x16x32_bf16 v[112:115], a[72:75], v[176:179], v[112:115]
 ds_read_b128 v[208:211], v19 offset:8192
 v_mfma_f32_16x16x32_bf16 v[116:119], a[76:79], v[176:179], v[116:119]
 v_exp_f32 v50, v50
 v_mfma_f32_16x16x32_bf16 v[120:123], a[80:83], v[176:179], v[120:123]
 v_exp_f32 v51, v51
 v_mfma_f32_16x16x32_bf16 v[124:127], a[72:75], v[180:183], v[124:127]
 ds_read_b128 v[212:215], v19 offset:10240
 v_mfma_f32_16x16x32_bf16 v[128:131], a[76:79], v[180:183], v[128:131]
 buffer_load_dwordx4 v13, s[8:11], s30 offen offset:3072 lds
 v_mfma_f32_16x16x32_bf16 v[132:135], a[80:83], v[180:183], v[132:135]
 s_add_u32 s30, s30, 128
 s_add_u32 m0, m0, 16384
 v_mfma_f32_16x16x32_bf16 v[136:139], a[72:75], v[184:187], v[136:139]
 ds_read_b128 v[216:219], v19 offset:12288
 v_mfma_f32_16x16x32_bf16 v[140:143], a[76:79], v[184:187], v[140:143]
 s_cmp_lt_u32 m0, s46
 s_cselect_b32 m0, m0, s47
 v_mfma_f32_16x16x32_bf16 v[144:147], a[80:83], v[184:187], v[144:147]
 v_exp_f32 v52, v52
 v_mfma_f32_16x16x32_bf16 v[148:151], a[72:75], v[188:191], v[148:151]
 ds_read_b128 v[220:223], v19 offset:14336
 v_mfma_f32_16x16x32_bf16 v[152:155], a[76:79], v[188:191], v[152:155]
 v_exp_f32 v53, v53
 v_mfma_f32_16x16x32_bf16 v[156:159], a[80:83], v[188:191], v[156:159]
 s_waitcnt vmcnt(18) lgkmcnt(4)
 s_barrier
 v_mfma_f32_16x16x32_bf16 v[64:67], a[84:87], v[192:195], v[64:67]
 ds_read_b128 v[160:163], v18 offset:0
 v_mfma_f32_16x16x32_bf16 v[68:71], a[88:91], v[192:195], v[68:71]
 v_exp_f32 v54, v54
 v_mfma_f32_16x16x32_bf16 v[72:75], a[92:95], v[192:195], v[72:75]
 v_add_u32 v19, s33, v15
 s_add_u32 s33, s33, 16384
 v_mfma_f32_16x16x32_bf16 v[76:79], a[84:87], v[196:199], v[76:79]
 ds_read_b128 v[164:167], v18 offset:2048
 s_add_u32 s21, s50, 4096
 v_mfma_f32_16x16x32_bf16 v[80:83], a[88:91], v[196:199], v[80:83]
 buffer_load_dwordx4 v10, s[8:11], s30 offen offset:0 lds
 v_mfma_f32_16x16x32_bf16 v[84:87], a[92:95], v[196:199], v[84:87]
 s_cmp_lt_u32 s33, 98304
 s_cselect_b32 s33, s33, 0
 v_mfma_f32_16x16x32_bf16 v[88:91], a[84:87], v[200:203], v[88:91]
 ds_read_b128 v[168:171], v18 offset:4096
 v_mfma_f32_16x16x32_bf16 v[92:95], a[88:91], v[200:203], v[92:95]
 buffer_load_dwordx4 v[60:63], v30, s[16:19], s21 offen offset:2048 sc1
 v_mfma_f32_16x16x32_bf16 v[96:99], a[92:95], v[200:203], v[96:99]
 v_exp_f32 v55, v55
 v_mfma_f32_16x16x32_bf16 v[100:103], a[84:87], v[204:207], v[100:103]
 ds_read_b128 v[172:175], v18 offset:6144
 s_nop 0
 v_mfma_f32_16x16x32_bf16 v[104:107], a[88:91], v[204:207], v[104:107]
 v_add_f32 v56, v52, v53
 v_add_f32 v56, v56, v54
 v_mfma_f32_16x16x32_bf16 v[108:111], a[92:95], v[204:207], v[108:111]
 s_waitcnt lgkmcnt(4)
 v_add_f32 v56, v56, v55
 v_mfma_f32_16x16x32_bf16 v[112:115], a[84:87], v[208:211], v[112:115]
 ds_read_b128 v[176:179], v18 offset:8192
 v_cndmask_b32 v56, 0, v56, s[60:61]
 v_mfma_f32_16x16x32_bf16 v[116:119], a[88:91], v[208:211], v[116:119]
 v_add_f32 v56, v56, v44
 v_add_f32 v56, v56, v45
 v_mfma_f32_16x16x32_bf16 v[120:123], a[92:95], v[208:211], v[120:123]
 v_add_f32 v56, v56, v46
 v_add_f32 v56, v56, v47
 v_mfma_f32_16x16x32_bf16 v[124:127], a[84:87], v[212:215], v[124:127]
 ds_read_b128 v[180:183], v18 offset:10240
 v_add_f32 v56, v56, v48
 v_mfma_f32_16x16x32_bf16 v[128:131], a[88:91], v[212:215], v[128:131]
 buffer_load_dwordx4 v11, s[8:11], s30 offen offset:1024 lds
 v_mfma_f32_16x16x32_bf16 v[132:135], a[92:95], v[212:215], v[132:135]
 v_add_f32 v56, v56, v49
 v_add_f32 v56, v56, v50
 v_mfma_f32_16x16x32_bf16 v[136:139], a[84:87], v[216:219], v[136:139]
 ds_read_b128 v[184:187], v18 offset:12288
 v_add_f32 v56, v56, v51
 v_mfma_f32_16x16x32_bf16 v[140:143], a[88:91], v[216:219], v[140:143]
 v_mov_b32 v57, v56
 v_mfma_f32_16x16x32_bf16 v[144:147], a[92:95], v[216:219], v[144:147]
 s_nop 1
 v_mfma_f32_16x16x32_bf16 v[148:151], a[84:87], v[220:223], v[148:151]
 ds_read_b128 v[188:191], v18 offset:14336
 v_mfma_f32_16x16x32_bf16 v[152:155], a[88:91], v[220:223], v[152:155]
 v_permlane32_swap_b32 v56, v57
 v_mfma_f32_16x16x32_bf16 v[156:159], a[92:95], v[220:223], v[156:159]
 s_waitcnt lgkmcnt(4)
 v_add_f32 v56, v56, v57
 v_mfma_f32_16x16x32_bf16 v[64:67], a[96:99], v[160:163], v[64:67]
 ds_read_b128 v[192:195], v19 offset:0
 v_mov_b32 v57, v56
 v_mfma_f32_16x16x32_bf16 v[68:71], a[100:103], v[160:163], v[68:71]
 v_add_u32 v18, s33, v14
 v_mfma_f32_16x16x32_bf16 v[72:75], a[104:107], v[160:163], v[72:75]
 s_nop 1
 v_mfma_f32_16x16x32_bf16 v[76:79], a[96:99], v[164:167], v[76:79]
 ds_read_b128 v[196:199], v19 offset:2048
 s_add_u32 s21, s50, 8192
 v_mfma_f32_16x16x32_bf16 v[80:83], a[100:103], v[164:167], v[80:83]
 buffer_load_dwordx4 v12, s[8:11], s30 offen offset:2048 lds
 v_mfma_f32_16x16x32_bf16 v[84:87], a[104:107], v[164:167], v[84:87]
 buffer_load_dwordx4 v[248:251], v30, s[16:19], s21 offen offset:2048 sc1
 v_mfma_f32_16x16x32_bf16 v[88:91], a[96:99], v[168:171], v[88:91]
 ds_read_b128 v[200:203], v19 offset:4096
 v_mfma_f32_16x16x32_bf16 v[92:95], a[100:103], v[168:171], v[92:95]
 v_permlane16_swap_b32 v56, v57
 v_mfma_f32_16x16x32_bf16 v[96:99], a[104:107], v[168:171], v[96:99]
 v_add_f32 v56, v56, v57
 v_mfma_f32_16x16x32_bf16 v[100:103], a[96:99], v[172:175], v[100:103]
 ds_read_b128 v[204:207], v19 offset:6144
 v_mfma_f32_16x16x32_bf16 v[104:107], a[100:103], v[172:175], v[104:107]
 v_rcp_f32 v56, v56
 v_mfma_f32_16x16x32_bf16 v[108:111], a[104:107], v[172:175], v[108:111]
 s_waitcnt lgkmcnt(4)
 s_nop 0
 v_mfma_f32_16x16x32_bf16 v[112:115], a[96:99], v[176:179], v[112:115]
 ds_read_b128 v[208:211], v19 offset:8192
 v_mul_f32 v44, v44, v56
 v_mfma_f32_16x16x32_bf16 v[116:119], a[100:103], v[176:179], v[116:119]
 v_mul_f32 v45, v45, v56
 v_mul_f32 v46, v46, v56
 v_mfma_f32_16x16x32_bf16 v[120:123], a[104:107], v[176:179], v[120:123]
 v_mul_f32 v47, v47, v56
 v_mul_f32 v48, v48, v56
 v_mfma_f32_16x16x32_bf16 v[124:127], a[96:99], v[180:183], v[124:127]
 ds_read_b128 v[212:215], v19 offset:10240
 v_mul_f32 v49, v49, v56
 v_mfma_f32_16x16x32_bf16 v[128:131], a[100:103], v[180:183], v[128:131]
 buffer_load_dwordx4 v13, s[8:11], s30 offen offset:3072 lds
 v_mfma_f32_16x16x32_bf16 v[132:135], a[104:107], v[180:183], v[132:135]
 s_add_u32 s30, s30, 128
 s_add_u32 m0, m0, 16384
 v_mfma_f32_16x16x32_bf16 v[136:139], a[96:99], v[184:187], v[136:139]
 ds_read_b128 v[216:219], v19 offset:12288
 v_mul_f32 v50, v50, v56
 v_mfma_f32_16x16x32_bf16 v[140:143], a[100:103], v[184:187], v[140:143]
 s_cmp_lt_u32 m0, s46
 s_cselect_b32 m0, m0, s47
 v_mfma_f32_16x16x32_bf16 v[144:147], a[104:107], v[184:187], v[144:147]
 v_mul_f32 v51, v51, v56
 v_mul_f32 v52, v52, v56
 v_mfma_f32_16x16x32_bf16 v[148:151], a[96:99], v[188:191], v[148:151]
 ds_read_b128 v[220:223], v19 offset:14336
 v_mul_f32 v53, v53, v56
 v_mfma_f32_16x16x32_bf16 v[152:155], a[100:103], v[188:191], v[152:155]
 v_mul_f32 v54, v54, v56
 v_mul_f32 v55, v55, v56
 v_mfma_f32_16x16x32_bf16 v[156:159], a[104:107], v[188:191], v[156:159]
 s_waitcnt vmcnt(19) lgkmcnt(4)
 s_barrier
 v_mfma_f32_16x16x32_bf16 v[64:67], a[108:111], v[192:195], v[64:67]
 ds_read_b128 v[160:163], v18 offset:0
 v_cvt_pk_bf16_f32 v240, v40, v41
 v_mfma_f32_16x16x32_bf16 v[68:71], a[112:115], v[192:195], v[68:71]
 s_add_u32 s21, s50, 8192
 v_cvt_pk_bf16_f32 v241, v42, v43
 v_mfma_f32_16x16x32_bf16 v[72:75], a[116:119], v[192:195], v[72:75]
 v_add_u32 v19, s33, v15
 s_add_u32 s33, s33, 16384
 v_mfma_f32_16x16x32_bf16 v[76:79], a[108:111], v[196:199], v[76:79]
 ds_read_b128 v[164:167], v18 offset:2048
 v_cvt_pk_bf16_f32 v242, v52, v53
 v_mfma_f32_16x16x32_bf16 v[80:83], a[112:115], v[196:199], v[80:83]
 buffer_load_dwordx4 v10, s[8:11], s30 offen offset:0 lds
 v_mfma_f32_16x16x32_bf16 v[84:87], a[116:119], v[196:199], v[84:87]
 s_cmp_lt_u32 s33, 98304
 s_cselect_b32 s33, s33, 0
 v_mfma_f32_16x16x32_bf16 v[88:91], a[108:111], v[200:203], v[88:91]
 ds_read_b128 v[168:171], v18 offset:4096
 v_cvt_pk_bf16_f32 v243, v54, v55
 v_mfma_f32_16x16x32_bf16 v[92:95], a[112:115], v[200:203], v[92:95]
 buffer_load_dwordx4 v[252:255], v30, s[16:19], s21 offen offset:3072 sc1
 v_mfma_f32_16x16x32_bf16 v[96:99], a[116:119], v[200:203], v[96:99]
 v_cvt_pk_bf16_f32 v236, v44, v45
 v_cvt_pk_bf16_f32 v237, v46, v47
 v_mfma_f32_16x16x32_bf16 v[100:103], a[108:111], v[204:207], v[100:103]
 ds_read_b128 v[172:175], v18 offset:6144
 v_cvt_pk_bf16_f32 v238, v48, v49
 v_mfma_f32_16x16x32_bf16 v[104:107], a[112:115], v[204:207], v[104:107]
 v_cvt_pk_bf16_f32 v239, v50, v51
 v_cvt_pk_bf16_f32 v244, v36, v37
 v_mfma_f32_16x16x32_bf16 v[108:111], a[116:119], v[204:207], v[108:111]
 s_waitcnt lgkmcnt(4)
 v_cvt_pk_bf16_f32 v245, v38, v39
 v_mfma_f32_16x16x32_bf16 v[112:115], a[108:111], v[208:211], v[112:115]
 ds_read_b128 v[176:179], v18 offset:8192
 v_mfma_f32_16x16x32_bf16 v[116:119], a[112:115], v[208:211], v[116:119]
 v_permlane16_swap_b32 v240, v242
 v_mfma_f32_16x16x32_bf16 v[120:123], a[116:119], v[208:211], v[120:123]
 v_permlane16_swap_b32 v241, v243
 v_mfma_f32_16x16x32_bf16 v[124:127], a[108:111], v[212:215], v[124:127]
 ds_read_b128 v[180:183], v18 offset:10240
 v_mfma_f32_16x16x32_bf16 v[128:131], a[112:115], v[212:215], v[128:131]
 buffer_load_dwordx4 v11, s[8:11], s30 offen offset:1024 lds
 v_mfma_f32_16x16x32_bf16 v[132:135], a[116:119], v[212:215], v[132:135]
 v_mfma_f32_16x16x32_bf16 v[136:139], a[108:111], v[216:219], v[136:139]
 ds_read_b128 v[184:187], v18 offset:12288
 v_mfma_f32_16x16x32_bf16 v[140:143], a[112:115], v[216:219], v[140:143]
 v_mfma_f32_16x16x32_bf16 v[144:147], a[116:119], v[216:219], v[144:147]
 v_mfma_f32_16x16x32_bf16 v[148:151], a[108:111], v[220:223], v[148:151]
 ds_read_b128 v[188:191], v18 offset:14336
 v_mfma_f32_16x16x32_bf16 v[152:155], a[112:115], v[220:223], v[152:155]
 v_mfma_f32_16x16x32_bf16 v[156:159], a[116:119], v[220:223], v[156:159]
 s_waitcnt lgkmcnt(4)
 v_mfma_f32_16x16x32_bf16 v[64:67], a[120:123], v[160:163], v[64:67]
 ds_read_b128 v[192:195], v19 offset:0
 v_mfma_f32_16x16x32_bf16 v[68:71], a[124:127], v[160:163], v[68:71]
 v_add_u32 v18, s33, v14
 v_mfma_f32_16x16x32_bf16 v[72:75], a[128:131], v[160:163], v[72:75]
 v_mfma_f32_16x16x32_bf16 v[76:79], a[120:123], v[164:167], v[76:79]
 ds_read_b128 v[196:199], v19 offset:2048
 v_mfma_f32_16x16x32_bf16 v[80:83], a[124:127], v[164:167], v[80:83]
 buffer_load_dwordx4 v12, s[8:11], s30 offen offset:2048 lds
 v_mfma_f32_16x16x32_bf16 v[84:87], a[128:131], v[164:167], v[84:87]
 v_mfma_f32_16x16x32_bf16 v[88:91], a[120:123], v[168:171], v[88:91]
 ds_read_b128 v[200:203], v19 offset:4096
 v_mfma_f32_16x16x32_bf16 v[92:95], a[124:127], v[168:171], v[92:95]
 v_mfma_f32_16x16x32_bf16 v[96:99], a[128:131], v[168:171], v[96:99]
 v_mfma_f32_16x16x32_bf16 v[100:103], a[120:123], v[172:175], v[100:103]
 ds_read_b128 v[204:207], v19 offset:6144
 v_mfma_f32_16x16x32_bf16 v[104:107], a[124:127], v[172:175], v[104:107]
 v_mfma_f32_16x16x32_bf16 v[108:111], a[128:131], v[172:175], v[108:111]
 s_waitcnt lgkmcnt(4)
 v_mfma_f32_16x16x32_bf16 v[112:115], a[120:123], v[176:179], v[112:115]
 ds_read_b128 v[208:211], v19 offset:8192
 v_mfma_f32_16x16x32_bf16 v[116:119], a[124:127], v[176:179], v[116:119]
 v_mfma_f32_16x16x32_bf16 v[120:123], a[128:131], v[176:179], v[120:123]
 v_mfma_f32_16x16x32_bf16 v[124:127], a[120:123], v[180:183], v[124:127]
 ds_read_b128 v[212:215], v19 offset:10240
 v_mfma_f32_16x16x32_bf16 v[128:131], a[124:127], v[180:183], v[128:131]
 buffer_load_dwordx4 v13, s[8:11], s30 offen offset:3072 lds
 v_mfma_f32_16x16x32_bf16 v[132:135], a[128:131], v[180:183], v[132:135]
 s_add_u32 s30, s30, s25
 s_sub_u32 s30, s30, 1152
 v_mfma_f32_16x16x32_bf16 v[136:139], a[120:123], v[184:187], v[136:139]
 ds_read_b128 v[216:219], v19 offset:12288
 s_mov_b32 s25, 163840
 v_mfma_f32_16x16x32_bf16 v[140:143], a[124:127], v[184:187], v[140:143]
 s_add_u32 m0, m0, 16384
 v_mfma_f32_16x16x32_bf16 v[144:147], a[128:131], v[184:187], v[144:147]
 s_cmp_lt_u32 m0, s46
 s_cselect_b32 m0, m0, s47
 v_mfma_f32_16x16x32_bf16 v[148:151], a[120:123], v[188:191], v[148:151]
 ds_read_b128 v[220:223], v19 offset:14336
 v_mfma_f32_16x16x32_bf16 v[152:155], a[124:127], v[188:191], v[152:155]
 v_mfma_f32_16x16x32_bf16 v[156:159], a[128:131], v[188:191], v[156:159]
 s_waitcnt vmcnt(17) lgkmcnt(4)
 s_barrier
 v_mfma_f32_16x16x32_bf16 v[64:67], a[132:135], v[192:195], v[64:67]
 ds_read_b128 v[160:163], v18 offset:0
 v_mfma_f32_16x16x32_bf16 v[68:71], a[136:139], v[192:195], v[68:71]
 v_mfma_f32_16x16x32_bf16 v[72:75], a[140:143], v[192:195], v[72:75]
 v_add_u32 v19, s33, v15
 s_add_u32 s33, s33, 16384
 v_mfma_f32_16x16x32_bf16 v[76:79], a[132:135], v[196:199], v[76:79]
 ds_read_b128 v[164:167], v18 offset:2048
 v_mfma_f32_16x16x32_bf16 v[80:83], a[136:139], v[196:199], v[80:83]
 buffer_load_dwordx4 v10, s[8:11], s30 offen offset:0 lds
 v_mfma_f32_16x16x32_bf16 v[84:87], a[140:143], v[196:199], v[84:87]
 s_cmp_lt_u32 s33, 98304
 s_cselect_b32 s33, s33, 0
 v_mfma_f32_16x16x32_bf16 v[88:91], a[132:135], v[200:203], v[88:91]
 ds_read_b128 v[168:171], v18 offset:4096
 v_mfma_f32_16x16x32_bf16 v[92:95], a[136:139], v[200:203], v[92:95]
 buffer_store_dwordx4 v[236:239], v30, s[56:59], s81 offen sc1
 v_mfma_f32_16x16x32_bf16 v[96:99], a[140:143], v[200:203], v[96:99]
 v_mfma_f32_16x16x32_bf16 v[100:103], a[132:135], v[204:207], v[100:103]
 ds_read_b128 v[172:175], v18 offset:6144
 v_mfma_f32_16x16x32_bf16 v[104:107], a[136:139], v[204:207], v[104:107]
 v_mfma_f32_16x16x32_bf16 v[108:111], a[140:143], v[204:207], v[108:111]
 s_waitcnt lgkmcnt(4)
 v_mfma_f32_16x16x32_bf16 v[112:115], a[132:135], v[208:211], v[112:115]
 ds_read_b128 v[176:179], v18 offset:8192
 v_mfma_f32_16x16x32_bf16 v[116:119], a[136:139], v[208:211], v[116:119]
 s_mov_b64 exec, 0xffffffff
 buffer_store_dwordx4 v[240:243], v30, s[56:59], s81 offen offset:1024 sc1
 s_mov_b64 exec, -1
 v_mfma_f32_16x16x32_bf16 v[120:123], a[140:143], v[208:211], v[120:123]
 v_mfma_f32_16x16x32_bf16 v[124:127], a[132:135], v[212:215], v[124:127]
 ds_read_b128 v[180:183], v18 offset:10240
 v_mfma_f32_16x16x32_bf16 v[128:131], a[136:139], v[212:215], v[128:131]
 buffer_load_dwordx4 v11, s[8:11], s30 offen offset:1024 lds
 v_mfma_f32_16x16x32_bf16 v[132:135], a[140:143], v[212:215], v[132:135]
 v_mfma_f32_16x16x32_bf16 v[136:139], a[132:135], v[216:219], v[136:139]
 ds_read_b128 v[184:187], v18 offset:12288
 v_mfma_f32_16x16x32_bf16 v[140:143], a[136:139], v[216:219], v[140:143]
 buffer_store_dwordx2 v[244:245], v32, s[56:59], s81 offen offset:1536 sc1
 v_mfma_f32_16x16x32_bf16 v[144:147], a[140:143], v[216:219], v[144:147]
 s_mov_b32 s78, s82
 s_mov_b32 s82, 0
 v_mfma_f32_16x16x32_bf16 v[148:151], a[132:135], v[220:223], v[148:151]
 ds_read_b128 v[188:191], v18 offset:14336
 s_mov_b32 s81, 0x80000000
 v_mfma_f32_16x16x32_bf16 v[152:155], a[136:139], v[220:223], v[152:155]
 v_mfma_f32_16x16x32_bf16 v[156:159], a[140:143], v[220:223], v[156:159]
 s_waitcnt lgkmcnt(4)
 s_add_u32 s21, s50, 0
 v_mfma_f32_16x16x32_bf16 v[64:67], a[144:147], v[160:163], v[64:67]
 ds_read_b128 v[192:195], v19 offset:0
 v_mfma_f32_16x16x32_bf16 v[68:71], a[148:151], v[160:163], v[68:71]
 v_add_u32 v18, s33, v14
 v_mfma_f32_16x16x32_bf16 v[72:75], a[152:155], v[160:163], v[72:75]
 buffer_load_dwordx4 v[36:39], v30, s[16:19], s21 offen offset:0 sc1
 v_mfma_f32_16x16x32_bf16 v[76:79], a[144:147], v[164:167], v[76:79]
 ds_read_b128 v[196:199], v19 offset:2048
 v_mfma_f32_16x16x32_bf16 v[80:83], a[148:151], v[164:167], v[80:83]
 buffer_load_dwordx4 v12, s[8:11], s30 offen offset:2048 lds
 v_mfma_f32_16x16x32_bf16 v[84:87], a[152:155], v[164:167], v[84:87]
 v_mfma_f32_16x16x32_bf16 v[88:91], a[144:147], v[168:171], v[88:91]
 ds_read_b128 v[200:203], v19 offset:4096
 v_mfma_f32_16x16x32_bf16 v[92:95], a[148:151], v[168:171], v[92:95]
 v_mfma_f32_16x16x32_bf16 v[96:99], a[152:155], v[168:171], v[96:99]
 v_mfma_f32_16x16x32_bf16 v[100:103], a[144:147], v[172:175], v[100:103]
 ds_read_b128 v[204:207], v19 offset:6144
 v_mfma_f32_16x16x32_bf16 v[104:107], a[148:151], v[172:175], v[104:107]
 v_mfma_f32_16x16x32_bf16 v[108:111], a[152:155], v[172:175], v[108:111]
 s_waitcnt lgkmcnt(4)
 v_mfma_f32_16x16x32_bf16 v[112:115], a[144:147], v[176:179], v[112:115]
 ds_read_b128 v[208:211], v19 offset:8192
 s_add_u32 s21, s50, 0
 v_mfma_f32_16x16x32_bf16 v[116:119], a[148:151], v[176:179], v[116:119]
 buffer_load_dwordx4 v[40:43], v30, s[16:19], s21 offen offset:1024 sc1
 v_mfma_f32_16x16x32_bf16 v[120:123], a[152:155], v[176:179], v[120:123]
 v_mfma_f32_16x16x32_bf16 v[124:127], a[144:147], v[180:183], v[124:127]
 ds_read_b128 v[212:215], v19 offset:10240
 v_mfma_f32_16x16x32_bf16 v[128:131], a[148:151], v[180:183], v[128:131]
 buffer_load_dwordx4 v13, s[8:11], s30 offen offset:3072 lds
 v_mfma_f32_16x16x32_bf16 v[132:135], a[152:155], v[180:183], v[132:135]
 s_add_u32 s30, s30, 128
 s_add_u32 m0, m0, 16384
 v_mfma_f32_16x16x32_bf16 v[136:139], a[144:147], v[184:187], v[136:139]
 ds_read_b128 v[216:219], v19 offset:12288
 v_mfma_f32_16x16x32_bf16 v[140:143], a[148:151], v[184:187], v[140:143]
 s_cmp_lt_u32 m0, s46
 s_cselect_b32 m0, m0, s47
 v_mfma_f32_16x16x32_bf16 v[144:147], a[152:155], v[184:187], v[144:147]
 v_mfma_f32_16x16x32_bf16 v[148:151], a[144:147], v[188:191], v[148:151]
 ds_read_b128 v[220:223], v19 offset:14336
 v_mfma_f32_16x16x32_bf16 v[152:155], a[148:151], v[188:191], v[152:155]
 v_mfma_f32_16x16x32_bf16 v[156:159], a[152:155], v[188:191], v[156:159]
 s_waitcnt vmcnt(20) lgkmcnt(4)
 s_barrier
 v_mfma_f32_16x16x32_bf16 v[64:67], a[156:159], v[192:195], v[64:67]
 ds_read_b128 v[160:163], v18 offset:0
 s_add_u32 s21, s50, 0
 v_mfma_f32_16x16x32_bf16 v[68:71], a[160:163], v[192:195], v[68:71]
 buffer_load_dwordx4 v[44:47], v30, s[16:19], s21 offen offset:2048 sc1
 v_mfma_f32_16x16x32_bf16 v[72:75], a[164:167], v[192:195], v[72:75]
 v_add_u32 v19, s33, v15
 s_add_u32 s33, s33, 16384
 v_mfma_f32_16x16x32_bf16 v[76:79], a[156:159], v[196:199], v[76:79]
 ds_read_b128 v[164:167], v18 offset:2048
 v_mfma_f32_16x16x32_bf16 v[80:83], a[160:163], v[196:199], v[80:83]
 buffer_load_dwordx4 v10, s[8:11], s30 offen offset:0 lds
 v_mfma_f32_16x16x32_bf16 v[84:87], a[164:167], v[196:199], v[84:87]
 s_cmp_lt_u32 s33, 98304
 s_cselect_b32 s33, s33, 0
 v_mfma_f32_16x16x32_bf16 v[88:91], a[156:159], v[200:203], v[88:91]
 ds_read_b128 v[168:171], v18 offset:4096
 v_mfma_f32_16x16x32_bf16 v[92:95], a[160:163], v[200:203], v[92:95]
 v_mfma_f32_16x16x32_bf16 v[96:99], a[164:167], v[200:203], v[96:99]
 v_mfma_f32_16x16x32_bf16 v[100:103], a[156:159], v[204:207], v[100:103]
 ds_read_b128 v[172:175], v18 offset:6144
 v_mfma_f32_16x16x32_bf16 v[104:107], a[160:163], v[204:207], v[104:107]
 v_mfma_f32_16x16x32_bf16 v[108:111], a[164:167], v[204:207], v[108:111]
 s_waitcnt lgkmcnt(4)
 s_add_u32 s21, s50, 0
 v_mfma_f32_16x16x32_bf16 v[112:115], a[156:159], v[208:211], v[112:115]
 ds_read_b128 v[176:179], v18 offset:8192
 v_mfma_f32_16x16x32_bf16 v[116:119], a[160:163], v[208:211], v[116:119]
 buffer_load_dwordx4 v[48:51], v30, s[16:19], s21 offen offset:3072 sc1
 v_mfma_f32_16x16x32_bf16 v[120:123], a[164:167], v[208:211], v[120:123]
 v_mfma_f32_16x16x32_bf16 v[124:127], a[156:159], v[212:215], v[124:127]
 ds_read_b128 v[180:183], v18 offset:10240
 v_mfma_f32_16x16x32_bf16 v[128:131], a[160:163], v[212:215], v[128:131]
 buffer_load_dwordx4 v11, s[8:11], s30 offen offset:1024 lds
 v_mfma_f32_16x16x32_bf16 v[132:135], a[164:167], v[212:215], v[132:135]
 v_mfma_f32_16x16x32_bf16 v[136:139], a[156:159], v[216:219], v[136:139]
 ds_read_b128 v[184:187], v18 offset:12288
 v_mfma_f32_16x16x32_bf16 v[140:143], a[160:163], v[216:219], v[140:143]
 v_mfma_f32_16x16x32_bf16 v[144:147], a[164:167], v[216:219], v[144:147]
 v_mfma_f32_16x16x32_bf16 v[148:151], a[156:159], v[220:223], v[148:151]
 ds_read_b128 v[188:191], v18 offset:14336
 v_mfma_f32_16x16x32_bf16 v[152:155], a[160:163], v[220:223], v[152:155]
 v_mfma_f32_16x16x32_bf16 v[156:159], a[164:167], v[220:223], v[156:159]
 s_waitcnt lgkmcnt(4)
 s_add_u32 s21, s50, 4096
 v_mfma_f32_16x16x32_bf16 v[64:67], a[168:171], v[160:163], v[64:67]
 ds_read_b128 v[192:195], v19 offset:0
 v_mfma_f32_16x16x32_bf16 v[68:71], a[172:175], v[160:163], v[68:71]
 v_add_u32 v18, s33, v14
 v_mfma_f32_16x16x32_bf16 v[72:75], a[176:179], v[160:163], v[72:75]
 buffer_load_dwordx4 v[52:55], v30, s[16:19], s21 offen offset:0 sc1
 v_mfma_f32_16x16x32_bf16 v[76:79], a[168:171], v[164:167], v[76:79]
 ds_read_b128 v[196:199], v19 offset:2048
 v_mfma_f32_16x16x32_bf16 v[80:83], a[172:175], v[164:167], v[80:83]
 buffer_load_dwordx4 v12, s[8:11], s30 offen offset:2048 lds
 v_mfma_f32_16x16x32_bf16 v[84:87], a[176:179], v[164:167], v[84:87]
 v_mfma_f32_16x16x32_bf16 v[88:91], a[168:171], v[168:171], v[88:91]
 ds_read_b128 v[200:203], v19 offset:4096
 v_mfma_f32_16x16x32_bf16 v[92:95], a[172:175], v[168:171], v[92:95]
 v_mfma_f32_16x16x32_bf16 v[96:99], a[176:179], v[168:171], v[96:99]
 v_mfma_f32_16x16x32_bf16 v[100:103], a[168:171], v[172:175], v[100:103]
 ds_read_b128 v[204:207], v19 offset:6144
 v_mfma_f32_16x16x32_bf16 v[104:107], a[172:175], v[172:175], v[104:107]
 v_mfma_f32_16x16x32_bf16 v[108:111], a[176:179], v[172:175], v[108:111]
 s_waitcnt lgkmcnt(4)
 v_mfma_f32_16x16x32_bf16 v[112:115], a[168:171], v[176:179], v[112:115]
 ds_read_b128 v[208:211], v19 offset:8192
 s_add_u32 s21, s50, 4096
 v_mfma_f32_16x16x32_bf16 v[116:119], a[172:175], v[176:179], v[116:119]
 buffer_load_dwordx4 v[56:59], v30, s[16:19], s21 offen offset:1024 sc1
 v_mfma_f32_16x16x32_bf16 v[120:123], a[176:179], v[176:179], v[120:123]
 v_mfma_f32_16x16x32_bf16 v[124:127], a[168:171], v[180:183], v[124:127]
 ds_read_b128 v[212:215], v19 offset:10240
 v_mfma_f32_16x16x32_bf16 v[128:131], a[172:175], v[180:183], v[128:131]
 buffer_load_dwordx4 v13, s[8:11], s30 offen offset:3072 lds
 v_mfma_f32_16x16x32_bf16 v[132:135], a[176:179], v[180:183], v[132:135]
 s_add_u32 s30, s30, 128
 s_add_u32 m0, m0, 16384
 v_mfma_f32_16x16x32_bf16 v[136:139], a[168:171], v[184:187], v[136:139]
 ds_read_b128 v[216:219], v19 offset:12288
 v_mfma_f32_16x16x32_bf16 v[140:143], a[172:175], v[184:187], v[140:143]
 s_cmp_lt_u32 m0, s46
 s_cselect_b32 m0, m0, s47
 v_mfma_f32_16x16x32_bf16 v[144:147], a[176:179], v[184:187], v[144:147]
 v_mfma_f32_16x16x32_bf16 v[148:151], a[168:171], v[188:191], v[148:151]
 ds_read_b128 v[220:223], v19 offset:14336
 v_mfma_f32_16x16x32_bf16 v[152:155], a[172:175], v[188:191], v[152:155]
 v_mfma_f32_16x16x32_bf16 v[156:159], a[176:179], v[188:191], v[156:159]
 s_waitcnt vmcnt(22) lgkmcnt(4)
 s_barrier
 v_mfma_f32_16x16x32_bf16 v[64:67], a[180:183], v[192:195], v[64:67]
 ds_read_b128 v[160:163], v18 offset:0
 s_add_u32 s21, s50, 4096
 v_mfma_f32_16x16x32_bf16 v[68:71], a[184:187], v[192:195], v[68:71]
 buffer_load_dwordx4 v[236:239], v30, s[16:19], s21 offen offset:3072 sc1
 v_mfma_f32_16x16x32_bf16 v[72:75], a[188:191], v[192:195], v[72:75]
 v_add_u32 v19, s33, v15
 s_add_u32 s33, s33, 16384
 v_mfma_f32_16x16x32_bf16 v[76:79], a[180:183], v[196:199], v[76:79]
 ds_read_b128 v[164:167], v18 offset:2048
 v_mfma_f32_16x16x32_bf16 v[80:83], a[184:187], v[196:199], v[80:83]
 buffer_load_dwordx4 v10, s[8:11], s30 offen offset:0 lds
 v_mfma_f32_16x16x32_bf16 v[84:87], a[188:191], v[196:199], v[84:87]
 s_cmp_lt_u32 s33, 98304
 s_cselect_b32 s33, s33, 0
 v_mfma_f32_16x16x32_bf16 v[88:91], a[180:183], v[200:203], v[88:91]
 ds_read_b128 v[168:171], v18 offset:4096
 v_mfma_f32_16x16x32_bf16 v[92:95], a[184:187], v[200:203], v[92:95]
 v_mfma_f32_16x16x32_bf16 v[96:99], a[188:191], v[200:203], v[96:99]
 v_mfma_f32_16x16x32_bf16 v[100:103], a[180:183], v[204:207], v[100:103]
 ds_read_b128 v[172:175], v18 offset:6144
 v_mfma_f32_16x16x32_bf16 v[104:107], a[184:187], v[204:207], v[104:107]
 v_mfma_f32_16x16x32_bf16 v[108:111], a[188:191], v[204:207], v[108:111]
 s_waitcnt lgkmcnt(4)
 s_add_u32 s21, s50, 8192
 v_mfma_f32_16x16x32_bf16 v[112:115], a[180:183], v[208:211], v[112:115]
 ds_read_b128 v[176:179], v18 offset:8192
 v_mfma_f32_16x16x32_bf16 v[116:119], a[184:187], v[208:211], v[116:119]
 buffer_load_dwordx4 v[240:243], v30, s[16:19], s21 offen offset:0 sc1
 v_mfma_f32_16x16x32_bf16 v[120:123], a[188:191], v[208:211], v[120:123]
 v_mfma_f32_16x16x32_bf16 v[124:127], a[180:183], v[212:215], v[124:127]
 ds_read_b128 v[180:183], v18 offset:10240
 v_mfma_f32_16x16x32_bf16 v[128:131], a[184:187], v[212:215], v[128:131]
 buffer_load_dwordx4 v11, s[8:11], s30 offen offset:1024 lds
 v_mfma_f32_16x16x32_bf16 v[132:135], a[188:191], v[212:215], v[132:135]
 v_mfma_f32_16x16x32_bf16 v[136:139], a[180:183], v[216:219], v[136:139]
 ds_read_b128 v[184:187], v18 offset:12288
 v_mfma_f32_16x16x32_bf16 v[140:143], a[184:187], v[216:219], v[140:143]
 v_mfma_f32_16x16x32_bf16 v[144:147], a[188:191], v[216:219], v[144:147]
 v_mfma_f32_16x16x32_bf16 v[148:151], a[180:183], v[220:223], v[148:151]
 ds_read_b128 v[188:191], v18 offset:14336
 v_mfma_f32_16x16x32_bf16 v[152:155], a[184:187], v[220:223], v[152:155]
 v_mfma_f32_16x16x32_bf16 v[156:159], a[188:191], v[220:223], v[156:159]
 s_waitcnt lgkmcnt(4)
 s_add_u32 s21, s50, 8192
 v_mfma_f32_16x16x32_bf16 v[64:67], a[192:195], v[160:163], v[64:67]
 ds_read_b128 v[192:195], v19 offset:0
 v_mfma_f32_16x16x32_bf16 v[68:71], a[196:199], v[160:163], v[68:71]
 v_add_u32 v18, s33, v14
 v_mfma_f32_16x16x32_bf16 v[72:75], a[200:203], v[160:163], v[72:75]
 buffer_load_dwordx4 v[244:247], v30, s[16:19], s21 offen offset:1024 sc1
 v_mfma_f32_16x16x32_bf16 v[76:79], a[192:195], v[164:167], v[76:79]
 ds_read_b128 v[196:199], v19 offset:2048
 v_mfma_f32_16x16x32_bf16 v[80:83], a[196:199], v[164:167], v[80:83]
 buffer_load_dwordx4 v12, s[8:11], s30 offen offset:2048 lds
 v_mfma_f32_16x16x32_bf16 v[84:87], a[200:203], v[164:167], v[84:87]
 v_mfma_f32_16x16x32_bf16 v[88:91], a[192:195], v[168:171], v[88:91]
 ds_read_b128 v[200:203], v19 offset:4096
 v_mfma_f32_16x16x32_bf16 v[92:95], a[196:199], v[168:171], v[92:95]
 v_mfma_f32_16x16x32_bf16 v[96:99], a[200:203], v[168:171], v[96:99]
 v_mfma_f32_16x16x32_bf16 v[100:103], a[192:195], v[172:175], v[100:103]
 ds_read_b128 v[204:207], v19 offset:6144
 v_mfma_f32_16x16x32_bf16 v[104:107], a[196:199], v[172:175], v[104:107]
 v_mfma_f32_16x16x32_bf16 v[108:111], a[200:203], v[172:175], v[108:111]
 s_waitcnt lgkmcnt(4)
 v_mfma_f32_16x16x32_bf16 v[112:115], a[192:195], v[176:179], v[112:115]
 ds_read_b128 v[208:211], v19 offset:8192
 v_mfma_f32_16x16x32_bf16 v[116:119], a[196:199], v[176:179], v[116:119]
 v_mfma_f32_16x16x32_bf16 v[120:123], a[200:203], v[176:179], v[120:123]
 v_mfma_f32_16x16x32_bf16 v[124:127], a[192:195], v[180:183], v[124:127]
 ds_read_b128 v[212:215], v19 offset:10240
 v_mfma_f32_16x16x32_bf16 v[128:131], a[196:199], v[180:183], v[128:131]
 buffer_load_dwordx4 v13, s[8:11], s30 offen offset:3072 lds
 v_mfma_f32_16x16x32_bf16 v[132:135], a[200:203], v[180:183], v[132:135]
 s_add_u32 s30, s30, 128
 s_add_u32 m0, m0, 16384
 v_mfma_f32_16x16x32_bf16 v[136:139], a[192:195], v[184:187], v[136:139]
 ds_read_b128 v[216:219], v19 offset:12288
 v_mfma_f32_16x16x32_bf16 v[140:143], a[196:199], v[184:187], v[140:143]
 s_cmp_lt_u32 m0, s46
 s_cselect_b32 m0, m0, s47
 v_mfma_f32_16x16x32_bf16 v[144:147], a[200:203], v[184:187], v[144:147]
 v_mfma_f32_16x16x32_bf16 v[148:151], a[192:195], v[188:191], v[148:151]
 ds_read_b128 v[220:223], v19 offset:14336
 v_mfma_f32_16x16x32_bf16 v[152:155], a[196:199], v[188:191], v[152:155]
 v_mfma_f32_16x16x32_bf16 v[156:159], a[200:203], v[188:191], v[156:159]
 s_waitcnt vmcnt(24) lgkmcnt(4)
 s_barrier
 v_mfma_f32_16x16x32_bf16 v[64:67], a[204:207], v[192:195], v[64:67]
 ds_read_b128 v[160:163], v18 offset:0
 v_mfma_f32_16x16x32_bf16 v[68:71], a[208:211], v[192:195], v[68:71]
 v_mfma_f32_16x16x32_bf16 v[72:75], a[212:215], v[192:195], v[72:75]
 v_add_u32 v19, s33, v15
 s_add_u32 s33, s33, 16384
 v_mfma_f32_16x16x32_bf16 v[76:79], a[204:207], v[196:199], v[76:79]
 ds_read_b128 v[164:167], v18 offset:2048
 v_mfma_f32_16x16x32_bf16 v[80:83], a[208:211], v[196:199], v[80:83]
 buffer_load_dwordx4 v10, s[8:11], s30 offen offset:0 lds
 v_mfma_f32_16x16x32_bf16 v[84:87], a[212:215], v[196:199], v[84:87]
 s_cmp_lt_u32 s33, 98304
 s_cselect_b32 s33, s33, 0
 v_mfma_f32_16x16x32_bf16 v[88:91], a[204:207], v[200:203], v[88:91]
 ds_read_b128 v[168:171], v18 offset:4096
 v_mfma_f32_16x16x32_bf16 v[92:95], a[208:211], v[200:203], v[92:95]
 v_mfma_f32_16x16x32_bf16 v[96:99], a[212:215], v[200:203], v[96:99]
 v_mfma_f32_16x16x32_bf16 v[100:103], a[204:207], v[204:207], v[100:103]
 ds_read_b128 v[172:175], v18 offset:6144
 v_mfma_f32_16x16x32_bf16 v[104:107], a[208:211], v[204:207], v[104:107]
 v_mfma_f32_16x16x32_bf16 v[108:111], a[212:215], v[204:207], v[108:111]
 s_waitcnt lgkmcnt(4)
 v_mfma_f32_16x16x32_bf16 v[112:115], a[204:207], v[208:211], v[112:115]
 ds_read_b128 v[176:179], v18 offset:8192
 v_mfma_f32_16x16x32_bf16 v[116:119], a[208:211], v[208:211], v[116:119]
 v_mfma_f32_16x16x32_bf16 v[120:123], a[212:215], v[208:211], v[120:123]
 v_mfma_f32_16x16x32_bf16 v[124:127], a[204:207], v[212:215], v[124:127]
 ds_read_b128 v[180:183], v18 offset:10240
 v_mfma_f32_16x16x32_bf16 v[128:131], a[208:211], v[212:215], v[128:131]
 buffer_load_dwordx4 v11, s[8:11], s30 offen offset:1024 lds
 v_mfma_f32_16x16x32_bf16 v[132:135], a[212:215], v[212:215], v[132:135]
 v_mfma_f32_16x16x32_bf16 v[136:139], a[204:207], v[216:219], v[136:139]
 ds_read_b128 v[184:187], v18 offset:12288
 v_mfma_f32_16x16x32_bf16 v[140:143], a[208:211], v[216:219], v[140:143]
 v_mfma_f32_16x16x32_bf16 v[144:147], a[212:215], v[216:219], v[144:147]
 v_mfma_f32_16x16x32_bf16 v[148:151], a[204:207], v[220:223], v[148:151]
 ds_read_b128 v[188:191], v18 offset:14336
 v_mfma_f32_16x16x32_bf16 v[152:155], a[208:211], v[220:223], v[152:155]
 v_mfma_f32_16x16x32_bf16 v[156:159], a[212:215], v[220:223], v[156:159]
 s_waitcnt lgkmcnt(4)
 v_mfma_f32_16x16x32_bf16 v[64:67], a[216:219], v[160:163], v[64:67]
 ds_read_b128 v[192:195], v19 offset:0
 v_mfma_f32_16x16x32_bf16 v[68:71], a[220:223], v[160:163], v[68:71]
 v_add_u32 v18, s33, v14
 v_mfma_f32_16x16x32_bf16 v[72:75], a[224:227], v[160:163], v[72:75]
 v_mfma_f32_16x16x32_bf16 v[76:79], a[216:219], v[164:167], v[76:79]
 ds_read_b128 v[196:199], v19 offset:2048
 v_mfma_f32_16x16x32_bf16 v[80:83], a[220:223], v[164:167], v[80:83]
 buffer_load_dwordx4 v12, s[8:11], s30 offen offset:2048 lds
 v_mfma_f32_16x16x32_bf16 v[84:87], a[224:227], v[164:167], v[84:87]
 v_mfma_f32_16x16x32_bf16 v[88:91], a[216:219], v[168:171], v[88:91]
 ds_read_b128 v[200:203], v19 offset:4096
 v_mfma_f32_16x16x32_bf16 v[92:95], a[220:223], v[168:171], v[92:95]
 v_mfma_f32_16x16x32_bf16 v[96:99], a[224:227], v[168:171], v[96:99]
 v_mfma_f32_16x16x32_bf16 v[100:103], a[216:219], v[172:175], v[100:103]
 ds_read_b128 v[204:207], v19 offset:6144
 v_mfma_f32_16x16x32_bf16 v[104:107], a[220:223], v[172:175], v[104:107]
 v_mfma_f32_16x16x32_bf16 v[108:111], a[224:227], v[172:175], v[108:111]
 s_waitcnt lgkmcnt(4)
 v_mfma_f32_16x16x32_bf16 v[112:115], a[216:219], v[176:179], v[112:115]
 ds_read_b128 v[208:211], v19 offset:8192
 v_mfma_f32_16x16x32_bf16 v[116:119], a[220:223], v[176:179], v[116:119]
 v_mfma_f32_16x16x32_bf16 v[120:123], a[224:227], v[176:179], v[120:123]
 v_mfma_f32_16x16x32_bf16 v[124:127], a[216:219], v[180:183], v[124:127]
 ds_read_b128 v[212:215], v19 offset:10240
 v_mfma_f32_16x16x32_bf16 v[128:131], a[220:223], v[180:183], v[128:131]
 buffer_load_dwordx4 v13, s[8:11], s30 offen offset:3072 lds
 v_mfma_f32_16x16x32_bf16 v[132:135], a[224:227], v[180:183], v[132:135]
 s_add_u32 s30, s30, 128
 s_add_u32 m0, m0, 16384
 v_mfma_f32_16x16x32_bf16 v[136:139], a[216:219], v[184:187], v[136:139]
 ds_read_b128 v[216:219], v19 offset:12288
 v_mfma_f32_16x16x32_bf16 v[140:143], a[220:223], v[184:187], v[140:143]
 s_cmp_lt_u32 m0, s46
 s_cselect_b32 m0, m0, s47
 v_mfma_f32_16x16x32_bf16 v[144:147], a[224:227], v[184:187], v[144:147]
 v_mfma_f32_16x16x32_bf16 v[148:151], a[216:219], v[188:191], v[148:151]
 ds_read_b128 v[220:223], v19 offset:14336
 v_mfma_f32_16x16x32_bf16 v[152:155], a[220:223], v[188:191], v[152:155]
 v_mfma_f32_16x16x32_bf16 v[156:159], a[224:227], v[188:191], v[156:159]
 s_waitcnt vmcnt(19) lgkmcnt(4)
 s_barrier
 v_mfma_f32_16x16x32_bf16 v[64:67], a[228:231], v[192:195], v[64:67]
 ds_read_b128 v[160:163], v18 offset:0
 v_mfma_f32_16x16x32_bf16 v[68:71], a[232:235], v[192:195], v[68:71]
 s_waitcnt vmcnt(22)
 s_cmp_eq_u32 s78, 0
 s_cbranch_scc1 pf_202
 v_mov_b32 v4, 0
 v_mov_b32 v5, 1
 s_mov_b64 exec, 1
 buffer_atomic_add v5, v4, s[72:75], s78 offen sc1
 s_mov_b64 exec, -1
 s_mov_b32 s78, 0
pf_202:
 buffer_load_dword v21, v33, s[72:75], s77 offen sc1
 v_mfma_f32_16x16x32_bf16 v[72:75], a[236:239], v[192:195], v[72:75]
 v_add_u32 v19, s33, v15
 s_add_u32 s33, s33, 16384
 v_mfma_f32_16x16x32_bf16 v[76:79], a[228:231], v[196:199], v[76:79]
 ds_read_b128 v[164:167], v18 offset:2048
 v_cvt_pk_bf16_f32 v224, v64, v65
 v_cvt_pk_bf16_f32 v225, v66, v67
 v_mfma_f32_16x16x32_bf16 v[80:83], a[232:235], v[196:199], v[80:83]
 buffer_load_dwordx4 v10, s[8:11], s30 offen offset:0 lds
 v_cvt_pk_bf16_f32 v226, v68, v69
 v_cvt_pk_bf16_f32 v227, v70, v71
 v_mfma_f32_16x16x32_bf16 v[84:87], a[236:239], v[196:199], v[84:87]
 s_cmp_lt_u32 s33, 98304
 s_cselect_b32 s33, s33, 0
 v_cvt_pk_bf16_f32 v228, v72, v73
 v_cvt_pk_bf16_f32 v229, v74, v75
 v_mfma_f32_16x16x32_bf16 v[88:91], a[228:231], v[200:203], v[88:91]
 ds_read_b128 v[168:171], v18 offset:4096
 ds_write_b64 v22, v[224:225] offset:0
 v_mfma_f32_16x16x32_bf16 v[92:95], a[232:235], v[200:203], v[92:95]
 ds_write_b64 v22, v[226:227] offset:8
 ds_write_b64 v16, v[228:229] offset:64
 v_mfma_f32_16x16x32_bf16 v[96:99], a[236:239], v[200:203], v[96:99]
 v_cvt_pk_bf16_f32 v230, v76, v77
 v_cvt_pk_bf16_f32 v231, v78, v79
 v_cvt_pk_bf16_f32 v232, v80, v81
 v_cvt_pk_bf16_f32 v233, v82, v83
 v_mfma_f32_16x16x32_bf16 v[100:103], a[228:231], v[204:207], v[100:103]
 ds_read_b128 v[172:175], v18 offset:6144
 v_cvt_pk_bf16_f32 v234, v84, v85
 v_cvt_pk_bf16_f32 v235, v86, v87
 v_mfma_f32_16x16x32_bf16 v[104:107], a[232:235], v[204:207], v[104:107]
 ds_write_b64 v22, v[230:231] offset:6400
 ds_write_b64 v22, v[232:233] offset:6408
 v_mfma_f32_16x16x32_bf16 v[108:111], a[236:239], v[204:207], v[108:111]
 s_waitcnt lgkmcnt(9)
 ds_write_b64 v16, v[234:235] offset:6464
 v_cvt_pk_bf16_f32 v224, v88, v89
 v_mfma_f32_16x16x32_bf16 v[112:115], a[228:231], v[208:211], v[112:115]
 ds_read_b128 v[176:179], v18 offset:8192
 v_cvt_pk_bf16_f32 v225, v90, v91
 v_cvt_pk_bf16_f32 v226, v92, v93
 v_cvt_pk_bf16_f32 v227, v94, v95
 v_mfma_f32_16x16x32_bf16 v[116:119], a[232:235], v[208:211], v[116:119]
 v_cvt_pk_bf16_f32 v228, v96, v97
 v_cvt_pk_bf16_f32 v229, v98, v99
 ds_write_b64 v22, v[224:225] offset:12800
 v_mfma_f32_16x16x32_bf16 v[120:123], a[236:239], v[208:211], v[120:123]
 ds_write_b64 v22, v[226:227] offset:12808
 ds_write_b64 v16, v[228:229] offset:12864
 v_mfma_f32_16x16x32_bf16 v[124:127], a[228:231], v[212:215], v[124:127]
 ds_read_b128 v[180:183], v18 offset:10240
 v_cvt_pk_bf16_f32 v230, v100, v101
 v_cvt_pk_bf16_f32 v231, v102, v103
 v_cvt_pk_bf16_f32 v232, v104, v105
 v_mfma_f32_16x16x32_bf16 v[128:131], a[232:235], v[212:215], v[128:131]
 buffer_load_dwordx4 v11, s[8:11], s30 offen offset:1024 lds
 v_cvt_pk_bf16_f32 v233, v106, v107
 v_cvt_pk_bf16_f32 v234, v108, v109
 v_mfma_f32_16x16x32_bf16 v[132:135], a[236:239], v[212:215], v[132:135]
 v_cvt_pk_bf16_f32 v235, v110, v111
 ds_write_b64 v22, v[230:231] offset:19200
 v_mfma_f32_16x16x32_bf16 v[136:139], a[228:231], v[216:219], v[136:139]
 ds_read_b128 v[184:187], v18 offset:12288
 ds_write_b64 v22, v[232:233] offset:19208
 v_mfma_f32_16x16x32_bf16 v[140:143], a[232:235], v[216:219], v[140:143]
 ds_write_b64 v16, v[234:235] offset:19264
 v_cvt_pk_bf16_f32 v224, v112, v113
 v_cvt_pk_bf16_f32 v225, v114, v115
 v_mfma_f32_16x16x32_bf16 v[144:147], a[236:239], v[216:219], v[144:147]
 v_cvt_pk_bf16_f32 v226, v116, v117
 v_cvt_pk_bf16_f32 v227, v118, v119
 v_cvt_pk_bf16_f32 v228, v120, v121
 v_cvt_pk_bf16_f32 v229, v122, v123
 v_mfma_f32_16x16x32_bf16 v[148:151], a[228:231], v[220:223], v[148:151]
 ds_read_b128 v[188:191], v18 offset:14336
 ds_write_b64 v22, v[224:225] offset:25600
 v_mfma_f32_16x16x32_bf16 v[152:155], a[232:235], v[220:223], v[152:155]
 ds_write_b64 v22, v[226:227] offset:25608
 ds_write_b64 v16, v[228:229] offset:25664
 v_mfma_f32_16x16x32_bf16 v[156:159], a[236:239], v[220:223], v[156:159]
 v_cvt_pk_bf16_f32 v230, v124, v125
 v_cvt_pk_bf16_f32 v231, v126, v127
 v_cvt_pk_bf16_f32 v232, v128, v129
 v_cvt_pk_bf16_f32 v233, v130, v131
qa_end_204:
 v_cvt_pk_bf16_f32 v234, v132, v133
 v_cvt_pk_bf16_f32 v235, v134, v135
 ds_write_b64 v22, v[230:231] offset:32000
 ds_write_b64 v22, v[232:233] offset:32008
 ds_write_b64 v16, v[234:235] offset:32064
 v_cvt_pk_bf16_f32 v224, v136, v137
 v_cvt_pk_bf16_f32 v225, v138, v139
 v_cvt_pk_bf16_f32 v226, v140, v141
 v_cvt_pk_bf16_f32 v227, v142, v143
 v_cvt_pk_bf16_f32 v228, v144, v145
 v_cvt_pk_bf16_f32 v229, v146, v147
 ds_write_b64 v22, v[224:225] offset:38400
 ds_write_b64 v22, v[226:227] offset:38408
 ds_write_b64 v16, v[228:229] offset:38464
 v_cvt_pk_bf16_f32 v230, v148, v149
 v_cvt_pk_bf16_f32 v231, v150, v151
 v_cvt_pk_bf16_f32 v232, v152, v153
 v_cvt_pk_bf16_f32 v233, v154, v155
 v_cvt_pk_bf16_f32 v234, v156, v157
 v_cvt_pk_bf16_f32 v235, v158, v159
 ds_write_b64 v22, v[230:231] offset:44800
 ds_write_b64 v22, v[232:233] offset:44808
 ds_write_b64 v16, v[234:235] offset:44864
 s_cmp_lg_u32 s26, s40
 s_cbranch_scc1 qbs_207
 s_waitcnt lgkmcnt(0)
 s_barrier
 ds_read_b128 v[64:67], v29 offset:0
 ds_read_b128 v[68:71], v29 offset:64
 ds_read_b128 v[72:75], v29 offset:128
 ds_read_b128 v[76:79], v29 offset:192
 ds_read_b128 v[80:83], v29 offset:256
 ds_read_b128 v[84:87], v29 offset:320
 ds_read_b128 v[88:91], v29 offset:6400
 ds_read_b128 v[92:95], v29 offset:6464
 ds_read_b128 v[96:99], v29 offset:6528
 ds_read_b128 v[100:103], v29 offset:6592
 ds_read_b128 v[104:107], v29 offset:6656
 ds_read_b128 v[108:111], v29 offset:6720
 s_waitcnt lgkmcnt(0)
 s_add_u32 s21, s43, 0
 buffer_store_dwordx4 v[64:67], v30, s[12:15], s21 offen offset:0 sc1
 buffer_store_dwordx4 v[68:71], v30, s[12:15], s21 offen offset:1024 sc1
 buffer_store_dwordx4 v[72:75], v30, s[12:15], s21 offen offset:2048 sc1
 buffer_store_dwordx4 v[76:79], v30, s[12:15], s21 offen offset:3072 sc1
 s_add_u32 s21, s43, 4096
 buffer_store_dwordx4 v[80:83], v30, s[12:15], s21 offen offset:0 sc1
 buffer_store_dwordx4 v[84:87], v30, s[12:15], s21 offen offset:1024 sc1
 buffer_store_dwordx4 v[88:91], v30, s[12:15], s21 offen offset:2048 sc1
 buffer_store_dwordx4 v[92:95], v30, s[12:15], s21 offen offset:3072 sc1
 s_add_u32 s21, s43, 8192
 buffer_store_dwordx4 v[96:99], v30, s[12:15], s21 offen offset:0 sc1
 buffer_store_dwordx4 v[100:103], v30, s[12:15], s21 offen offset:1024 sc1
 buffer_store_dwordx4 v[104:107], v30, s[12:15], s21 offen offset:2048 sc1
 buffer_store_dwordx4 v[108:111], v30, s[12:15], s21 offen offset:3072 sc1
 s_branch qbe_205
qbs_207:
 s_cmp_eq_u32 s80, 1
 s_cselect_b32 s21, s79, 0
 s_cmp_ge_u32 s21, 8
 s_cbranch_scc0 qx_208
 s_waitcnt lgkmcnt(0) vmcnt(5)
 s_barrier
 ds_read_b128 v[64:67], v29 offset:0
 ds_read_b128 v[88:91], v29 offset:6400
 ds_read_b128 v[68:71], v29 offset:64
 ds_read_b128 v[92:95], v29 offset:6464
 ds_read_b128 v[72:75], v29 offset:128
 ds_read_b128 v[96:99], v29 offset:6528
 ds_read_b128 v[76:79], v29 offset:192
 ds_read_b128 v[100:103], v29 offset:6592
 ds_read_b128 v[80:83], v29 offset:256
 ds_read_b128 v[104:107], v29 offset:6656
 ds_read_b128 v[84:87], v29 offset:320
 ds_read_b128 v[108:111], v29 offset:6720
 s_waitcnt lgkmcnt(10)
 v_mfma_f32_16x16x32_bf16 v[112:115], v[36:39], v[64:67], 0
 v_mfma_f32_16x16x32_bf16 v[116:119], a[240:243], v[64:67], 0
 v_mfma_f32_16x16x32_bf16 v[120:123], v[36:39], v[88:91], 0
 v_mfma_f32_16x16x32_bf16 v[124:127], v[60:63], v[88:91], 0
 v_mfma_f32_16x16x32_bf16 v[128:131], a[240:243], v[88:91], 0
 s_waitcnt lgkmcnt(8)
 v_mfma_f32_16x16x32_bf16 v[112:115], v[40:43], v[68:71], v[112:115]
 v_mfma_f32_16x16x32_bf16 v[116:119], a[244:247], v[68:71], v[116:119]
 v_mfma_f32_16x16x32_bf16 v[120:123], v[40:43], v[92:95], v[120:123]
 v_mfma_f32_16x16x32_bf16 v[124:127], v[236:239], v[92:95], v[124:127]
 v_mfma_f32_16x16x32_bf16 v[128:131], a[244:247], v[92:95], v[128:131]
 s_waitcnt lgkmcnt(6)
 v_mfma_f32_16x16x32_bf16 v[112:115], v[44:47], v[72:75], v[112:115]
 v_mfma_f32_16x16x32_bf16 v[116:119], a[248:251], v[72:75], v[116:119]
 v_mfma_f32_16x16x32_bf16 v[120:123], v[44:47], v[96:99], v[120:123]
 v_mfma_f32_16x16x32_bf16 v[124:127], v[240:243], v[96:99], v[124:127]
 v_mfma_f32_16x16x32_bf16 v[128:131], a[248:251], v[96:99], v[128:131]
 s_waitcnt lgkmcnt(4)
 v_mfma_f32_16x16x32_bf16 v[112:115], v[48:51], v[76:79], v[112:115]
 v_mfma_f32_16x16x32_bf16 v[116:119], a[252:255], v[76:79], v[116:119]
 v_mfma_f32_16x16x32_bf16 v[120:123], v[48:51], v[100:103], v[120:123]
 v_mfma_f32_16x16x32_bf16 v[124:127], v[244:247], v[100:103], v[124:127]
 v_mfma_f32_16x16x32_bf16 v[128:131], a[252:255], v[100:103], v[128:131]
 s_waitcnt lgkmcnt(2)
 v_mfma_f32_16x16x32_bf16 v[112:115], v[52:55], v[80:83], v[112:115]
 v_mfma_f32_16x16x32_bf16 v[116:119], v[24:27], v[80:83], v[116:119]
 v_mfma_f32_16x16x32_bf16 v[120:123], v[52:55], v[104:107], v[120:123]
 v_mfma_f32_16x16x32_bf16 v[124:127], v[248:251], v[104:107], v[124:127]
 v_mfma_f32_16x16x32_bf16 v[128:131], v[24:27], v[104:107], v[128:131]
 s_waitcnt lgkmcnt(0)
 v_mfma_f32_16x16x32_bf16 v[112:115], v[56:59], v[84:87], v[112:115]
 v_mfma_f32_16x16x32_bf16 v[116:119], v[6:9], v[84:87], v[116:119]
 v_mfma_f32_16x16x32_bf16 v[120:123], v[56:59], v[108:111], v[120:123]
 v_mfma_f32_16x16x32_bf16 v[124:127], v[252:255], v[108:111], v[124:127]
 v_mfma_f32_16x16x32_bf16 v[128:131], v[6:9], v[108:111], v[128:131]
 s_branch qx_206
qx_208:
 buffer_load_dword v21, v33, s[72:75], s77 offen sc1
 s_waitcnt vmcnt(0)
 s_mul_i32 s21, s49, 393216
 s_mul_i32 s22, s42, 12288
 s_add_u32 s50, s21, s22
 s_lshr_b32 s21, s49, 1
 s_bitcmp1_b32 s37, s21
 s_cselect_b32 s21, 8192, 0
 s_lshl_b32 s51, s49, 20
 s_or_b32 s51, s51, s21
 s_xor_b32 s51, s51, 8192
 s_add_u32 s51, s51, s36
 s_lshr_b32 s22, s49, 1
 s_lshr_b32 s21, s49, 2
 s_add_u32 s21, s21, 3
 s_cmp_lt_u32 s49, 12
 s_cselect_b32 s21, s22, s21
 s_lshl_b32 s21, s21, 3
 s_lshr_b32 s22, s42, 2
 s_add_u32 s21, s21, s22
 s_lshl_b32 s21, s21, 7
 s_add_u32 s76, s21, 0
 s_lshl_b32 s77, s42, 7
 s_add_u32 s77, s77, 19456
 s_add_u32 s23, s49, 1
 s_waitcnt vmcnt(6)
 v_cmp_gt_u32 vcc, s23, v21
 s_mov_b32 s80, 0
 s_nop 0
 s_cbranch_vccnz qk_210
 s_mov_b32 s80, 1
 buffer_load_dwordx4 v[132:135], v31, s[52:55], s51 offen offset:0 sc1
 buffer_load_dwordx4 v[136:139], v31, s[52:55], s51 offen offset:512 sc1
 buffer_load_dwordx4 v[140:143], v31, s[52:55], s51 offen offset:1024 sc1
 buffer_load_dwordx4 v[144:147], v31, s[52:55], s51 offen offset:1536 sc1
 buffer_load_dwordx4 v[148:151], v31, s[52:55], s51 offen offset:2048 sc1
 buffer_load_dwordx4 v[152:155], v31, s[52:55], s51 offen offset:2560 sc1
qk_210:
 s_cmp_ge_u32 s79, 8
 s_cbranch_scc1 qk_209
 v_mov_b32 v156, 0
 s_mov_b32 s101, 0
wf_211:
 buffer_load_dword v157, v156, s[72:75], s76 offen sc1
 s_add_u32 s101, s101, 1
 s_cmp_gt_u32 s101, 131072
 s_cbranch_scc1 main_end
 s_waitcnt vmcnt(0)
 v_readfirstlane_b32 s100, v157
 s_cmp_ge_u32 s100, 8
 s_cbranch_scc1 wf_212
 s_sleep 2
 s_branch wf_211
wf_212:
 s_add_u32 s21, s50, 0
 buffer_load_dwordx4 v[36:39], v30, s[16:19], s21 offen offset:0 sc1
 buffer_load_dwordx4 v[40:43], v30, s[16:19], s21 offen offset:1024 sc1
 buffer_load_dwordx4 v[44:47], v30, s[16:19], s21 offen offset:2048 sc1
 buffer_load_dwordx4 v[48:51], v30, s[16:19], s21 offen offset:3072 sc1
 s_add_u32 s21, s50, 4096
 buffer_load_dwordx4 v[52:55], v30, s[16:19], s21 offen offset:0 sc1
 buffer_load_dwordx4 v[56:59], v30, s[16:19], s21 offen offset:1024 sc1
 buffer_load_dwordx4 v[60:63], v30, s[16:19], s21 offen offset:2048 sc1
 buffer_load_dwordx4 v[236:239], v30, s[16:19], s21 offen offset:3072 sc1
 s_add_u32 s21, s50, 8192
 buffer_load_dwordx4 v[240:243], v30, s[16:19], s21 offen offset:0 sc1
 buffer_load_dwordx4 v[244:247], v30, s[16:19], s21 offen offset:1024 sc1
 buffer_load_dwordx4 v[248:251], v30, s[16:19], s21 offen offset:2048 sc1
 buffer_load_dwordx4 v[252:255], v30, s[16:19], s21 offen offset:3072 sc1
qk_209:
 s_waitcnt lgkmcnt(0)
 s_barrier
 ds_read_b128 v[64:67], v29 offset:0
 ds_read_b128 v[68:71], v29 offset:64
 ds_read_b128 v[72:75], v29 offset:128
 ds_read_b128 v[76:79], v29 offset:192
 ds_read_b128 v[80:83], v29 offset:256
 ds_read_b128 v[84:87], v29 offset:320
 ds_read_b128 v[88:91], v29 offset:6400
 ds_read_b128 v[92:95], v29 offset:6464
 ds_read_b128 v[96:99], v29 offset:6528
 ds_read_b128 v[100:103], v29 offset:6592
 ds_read_b128 v[104:107], v29 offset:6656
 ds_read_b128 v[108:111], v29 offset:6720
 s_waitcnt lgkmcnt(0)
 s_cmp_eq_u32 s80, 1
 s_cselect_b32 s21, s79, 0
 s_cmp_ge_u32 s21, 8
 s_cbranch_scc1 qw_213
 s_waitcnt vmcnt(0)
qw_213:
 v_mfma_f32_16x16x32_bf16 v[112:115], v[36:39], v[64:67], 0
 v_mfma_f32_16x16x32_bf16 v[120:123], v[36:39], v[88:91], 0
 v_mfma_f32_16x16x32_bf16 v[124:127], v[60:63], v[88:91], 0
 v_mfma_f32_16x16x32_bf16 v[112:115], v[40:43], v[68:71], v[112:115]
 v_mfma_f32_16x16x32_bf16 v[120:123], v[40:43], v[92:95], v[120:123]
 v_mfma_f32_16x16x32_bf16 v[124:127], v[236:239], v[92:95], v[124:127]
 v_mfma_f32_16x16x32_bf16 v[112:115], v[44:47], v[72:75], v[112:115]
 v_mfma_f32_16x16x32_bf16 v[120:123], v[44:47], v[96:99], v[120:123]
 v_mfma_f32_16x16x32_bf16 v[124:127], v[240:243], v[96:99], v[124:127]
 v_mfma_f32_16x16x32_bf16 v[112:115], v[48:51], v[76:79], v[112:115]
 v_mfma_f32_16x16x32_bf16 v[120:123], v[48:51], v[100:103], v[120:123]
 v_mfma_f32_16x16x32_bf16 v[124:127], v[244:247], v[100:103], v[124:127]
 v_mfma_f32_16x16x32_bf16 v[112:115], v[52:55], v[80:83], v[112:115]
 v_mfma_f32_16x16x32_bf16 v[120:123], v[52:55], v[104:107], v[120:123]
 v_mfma_f32_16x16x32_bf16 v[124:127], v[248:251], v[104:107], v[124:127]
 v_mfma_f32_16x16x32_bf16 v[112:115], v[56:59], v[84:87], v[112:115]
 v_mfma_f32_16x16x32_bf16 v[120:123], v[56:59], v[108:111], v[120:123]
 v_mfma_f32_16x16x32_bf16 v[124:127], v[252:255], v[108:111], v[124:127]
 s_cmp_eq_u32 s80, 1
 s_cbranch_scc1 qm_214
 s_add_u32 s23, s49, 1
 s_min_u32 s22, s49, 61
 s_cmp_lt_u32 s49, 52
 s_cselect_b32 s23, s23, s22
 s_mov_b32 s101, 0
wm_215:
 buffer_load_dword v156, v33, s[72:75], s77 offen sc1
 s_add_u32 s101, s101, 1
 s_cmp_gt_u32 s101, 131072
 s_cbranch_scc1 main_end
 s_waitcnt vmcnt(0)
 v_cmp_gt_u32 vcc, s23, v156
 v_readfirstlane_b32 s100, v156
 s_nop 0
 s_cbranch_vccz wm_216
 s_sleep 16
 s_add_u32 s100, s100, 2
 s_cmp_ge_u32 s100, s23
 s_cbranch_scc1 wm_215
 s_sleep 90
 s_branch wm_215
wm_216:
 s_cmp_eq_u32 s49, 63
 s_cselect_b32 s21, s101, 0
 s_cmp_lt_u32 s21, 2
 s_cbranch_scc1 qtz_219
 s_sleep 36
qtz_219:
 s_mov_b32 s101, 0
 s_branch qtp_218
qtp_217:
 s_sleep 3
qtp_218:
 buffer_load_dwordx4 v[132:135], v31, s[52:55], s51 offen offset:0 sc1
 buffer_load_dwordx4 v[136:139], v31, s[52:55], s51 offen offset:512 sc1
 buffer_load_dwordx4 v[140:143], v31, s[52:55], s51 offen offset:1024 sc1
 buffer_load_dwordx4 v[144:147], v31, s[52:55], s51 offen offset:1536 sc1
 buffer_load_dwordx4 v[148:151], v31, s[52:55], s51 offen offset:2048 sc1
 buffer_load_dwordx4 v[152:155], v31, s[52:55], s51 offen offset:2560 sc1
 s_add_u32 s101, s101, 1
 s_cmp_gt_u32 s101, 131072
 s_cbranch_scc1 main_end
 s_waitcnt vmcnt(0)
 v_max3_u32 v156, v132, v134, v136
 v_max3_u32 v156, v156, v138, v140
 v_max3_u32 v156, v156, v142, v144
 v_max3_u32 v156, v156, v146, v148
 v_max3_u32 v156, v156, v150, v152
 v_max3_u32 v156, v156, v154, v154
 v_cmp_eq_u32 vcc, -1, v156
 s_nop 1
 s_cbranch_vccnz qtp_217
qm_214:
 s_waitcnt vmcnt(0)
 v_mfma_f32_16x16x32_bf16 v[116:119], v[132:135], v[64:67], 0
 v_mfma_f32_16x16x32_bf16 v[128:131], v[132:135], v[88:91], 0
 v_mfma_f32_16x16x32_bf16 v[116:119], v[136:139], v[68:71], v[116:119]
 v_mfma_f32_16x16x32_bf16 v[128:131], v[136:139], v[92:95], v[128:131]
 v_mfma_f32_16x16x32_bf16 v[116:119], v[140:143], v[72:75], v[116:119]
 v_mfma_f32_16x16x32_bf16 v[128:131], v[140:143], v[96:99], v[128:131]
 v_mfma_f32_16x16x32_bf16 v[116:119], v[144:147], v[76:79], v[116:119]
 v_mfma_f32_16x16x32_bf16 v[128:131], v[144:147], v[100:103], v[128:131]
 v_mfma_f32_16x16x32_bf16 v[116:119], v[148:151], v[80:83], v[116:119]
 v_mfma_f32_16x16x32_bf16 v[128:131], v[148:151], v[104:107], v[128:131]
 v_mfma_f32_16x16x32_bf16 v[116:119], v[152:155], v[84:87], v[116:119]
 v_mfma_f32_16x16x32_bf16 v[128:131], v[152:155], v[108:111], v[128:131]
qx_206:
 s_lshr_b32 s21, s49, 1
 s_bitcmp1_b32 s37, s21
 s_cselect_b32 s21, 8192, 0
 s_lshl_b32 s81, s49, 20
 s_or_b32 s81, s81, s21
 s_add_u32 s81, s81, s44
 s_lshl_b32 s82, s49, 3
 s_and_b32 s21, s42, 7
 s_add_u32 s82, s82, s21
 s_lshl_b32 s82, s82, 7
 s_add_u32 s82, s82, 23552
 s_cmp_gt_u32 s26, 1
 s_cselect_b32 s21, s80, 0
 s_cmp_eq_u32 s21, 0
 s_cbranch_scc1 qi_221
 v_mov_b32 v36, v112
 v_mov_b32 v37, v113
 v_mov_b32 v38, v114
 v_mov_b32 v39, v115
 v_mov_b32 v40, v116
 v_mov_b32 v41, v117
 v_mov_b32 v42, v118
 v_mov_b32 v43, v119
 v_mov_b32 v44, v120
 v_mov_b32 v45, v121
 v_mov_b32 v46, v122
 v_mov_b32 v47, v123
 v_mov_b32 v48, v124
 v_mov_b32 v49, v125
 v_mov_b32 v50, v126
 v_mov_b32 v51, v127
 v_mov_b32 v52, v128
 v_mov_b32 v53, v129
 v_mov_b32 v54, v130
 v_mov_b32 v55, v131
 s_branch qd_220
qi_221:
 v_cndmask_b32 v112, v34, v112, s[64:65]
 v_cndmask_b32 v124, v34, v124, s[64:65]
 v_cndmask_b32 v113, v34, v113, s[66:67]
 v_cndmask_b32 v125, v34, v125, s[66:67]
 v_cndmask_b32 v114, v34, v114, s[68:69]
 v_cndmask_b32 v126, v34, v126, s[68:69]
 v_cndmask_b32 v115, v34, v115, s[70:71]
 v_cndmask_b32 v127, v34, v127, s[70:71]
 v_max3_f32 v156, v112, v113, v114
 v_max3_f32 v156, v156, v115, v116
 v_max3_f32 v156, v156, v117, v118
 v_max_f32 v156, v156, v119
 v_mov_b32 v157, v156
 s_nop 1
 v_permlane32_swap_b32 v156, v157
 v_max_f32 v156, v156, v157
 v_mov_b32 v157, v156
 s_nop 1
 v_permlane16_swap_b32 v156, v157
 v_max_f32 v156, v156, v157
 v_mul_f32 v156, s83, v156
 v_fma_f32 v112, v112, s83, -v156
 v_fma_f32 v113, v113, s83, -v156
 v_fma_f32 v114, v114, s83, -v156
 v_fma_f32 v115, v115, s83, -v156
 v_fma_f32 v116, v116, s83, -v156
 v_fma_f32 v117, v117, s83, -v156
 v_fma_f32 v118, v118, s83, -v156
 v_fma_f32 v119, v119, s83, -v156
 v_exp_f32 v112, v112
 v_exp_f32 v113, v113
 v_exp_f32 v114, v114
 v_exp_f32 v115, v115
 v_exp_f32 v116, v116
 v_exp_f32 v117, v117
 v_exp_f32 v118, v118
 v_exp_f32 v119, v119
 s_nop 0
 v_add_f32 v156, v116, v117
 v_add_f32 v156, v156, v118
 v_add_f32 v156, v156, v119
 v_cndmask_b32 v156, 0, v156, s[60:61]
 v_add_f32 v156, v156, v112
 v_add_f32 v156, v156, v113
 v_add_f32 v156, v156, v114
 v_add_f32 v156, v156, v115
 v_mov_b32 v157, v156
 s_nop 1
 v_permlane32_swap_b32 v156, v157
 v_add_f32 v156, v156, v157
 v_mov_b32 v157, v156
 s_nop 1
 v_permlane16_swap_b32 v156, v157
 v_add_f32 v156, v156, v157
 v_rcp_f32 v156, v156
 s_nop 0
 v_mul_f32 v112, v112, v156
 v_mul_f32 v113, v113, v156
 v_mul_f32 v114, v114, v156
 v_mul_f32 v115, v115, v156
 v_mul_f32 v116, v116, v156
 v_mul_f32 v117, v117, v156
 v_mul_f32 v118, v118, v156
 v_mul_f32 v119, v119, v156
 v_max3_f32 v156, v120, v121, v122
 v_max3_f32 v156, v156, v123, v124
 v_max3_f32 v156, v156, v125, v126
 v_max3_f32 v156, v156, v127, v128
 v_max3_f32 v156, v156, v129, v130
 v_max_f32 v156, v156, v131
 v_mov_b32 v157, v156
 s_nop 1
 v_permlane32_swap_b32 v156, v157
 v_max_f32 v156, v156, v157
 v_mov_b32 v157, v156
 s_nop 1
 v_permlane16_swap_b32 v156, v157
 v_max_f32 v156, v156, v157
 v_mul_f32 v156, s83, v156
 v_fma_f32 v120, v120, s83, -v156
 v_fma_f32 v121, v121, s83, -v156
 v_fma_f32 v122, v122, s83, -v156
 v_fma_f32 v123, v123, s83, -v156
 v_fma_f32 v124, v124, s83, -v156
 v_fma_f32 v125, v125, s83, -v156
 v_fma_f32 v126, v126, s83, -v156
 v_fma_f32 v127, v127, s83, -v156
 v_fma_f32 v128, v128, s83, -v156
 v_fma_f32 v129, v129, s83, -v156
 v_fma_f32 v130, v130, s83, -v156
 v_fma_f32 v131, v131, s83, -v156
 v_exp_f32 v120, v120
 v_exp_f32 v121, v121
 v_exp_f32 v122, v122
 v_exp_f32 v123, v123
 v_exp_f32 v124, v124
 v_exp_f32 v125, v125
 v_exp_f32 v126, v126
 v_exp_f32 v127, v127
 v_exp_f32 v128, v128
 v_exp_f32 v129, v129
 v_exp_f32 v130, v130
 v_exp_f32 v131, v131
 s_nop 0
 v_add_f32 v156, v128, v129
 v_add_f32 v156, v156, v130
 v_add_f32 v156, v156, v131
 v_cndmask_b32 v156, 0, v156, s[60:61]
 v_add_f32 v156, v156, v120
 v_add_f32 v156, v156, v121
 v_add_f32 v156, v156, v122
 v_add_f32 v156, v156, v123
 v_add_f32 v156, v156, v124
 v_add_f32 v156, v156, v125
 v_add_f32 v156, v156, v126
 v_add_f32 v156, v156, v127
 v_mov_b32 v157, v156
 s_nop 1
 v_permlane32_swap_b32 v156, v157
 v_add_f32 v156, v156, v157
 v_mov_b32 v157, v156
 s_nop 1
 v_permlane16_swap_b32 v156, v157
 v_add_f32 v156, v156, v157
 v_rcp_f32 v156, v156
 s_nop 0
 v_mul_f32 v120, v120, v156
 v_mul_f32 v121, v121, v156
 v_mul_f32 v122, v122, v156
 v_mul_f32 v123, v123, v156
 v_mul_f32 v124, v124, v156
 v_mul_f32 v125, v125, v156
 v_mul_f32 v126, v126, v156
 v_mul_f32 v127, v127, v156
 v_mul_f32 v128, v128, v156
 v_mul_f32 v129, v129, v156
 v_mul_f32 v130, v130, v156
 v_mul_f32 v131, v131, v156
 v_cvt_pk_bf16_f32 v196, v116, v117
 v_cvt_pk_bf16_f32 v197, v118, v119
 v_cvt_pk_bf16_f32 v198, v128, v129
 v_cvt_pk_bf16_f32 v199, v130, v131
 v_cvt_pk_bf16_f32 v192, v120, v121
 v_cvt_pk_bf16_f32 v193, v122, v123
 v_cvt_pk_bf16_f32 v194, v124, v125
 v_cvt_pk_bf16_f32 v195, v126, v127
 v_cvt_pk_bf16_f32 v200, v112, v113
 v_cvt_pk_bf16_f32 v201, v114, v115
 v_permlane16_swap_b32 v196, v198
 v_permlane16_swap_b32 v197, v199
 buffer_store_dwordx4 v[192:195], v30, s[56:59], s81 offen sc1
 s_mov_b64 exec, 0xffffffff
 buffer_store_dwordx4 v[196:199], v30, s[56:59], s81 offen offset:1024 sc1
 s_mov_b64 exec, -1
 buffer_store_dwordx2 v[200:201], v32, s[56:59], s81 offen offset:1536 sc1
 s_mov_b32 s78, s82
 s_mov_b32 s81, 0x80000000
 s_mov_b32 s82, 0
 s_cmp_eq_u32 s80, 1
 s_cbranch_scc1 qd_220
 s_waitcnt vmcnt(0)
 s_cmp_eq_u32 s78, 0
 s_cbranch_scc1 pf_222
 v_mov_b32 v4, 0
 v_mov_b32 v5, 1
 s_mov_b64 exec, 1
 buffer_atomic_add v5, v4, s[72:75], s78 offen sc1
 s_mov_b64 exec, -1
 s_mov_b32 s78, 0
pf_222:
qd_220:
 s_add_u32 s49, s49, s29
qbe_205:
 s_sub_u32 s26, s26, 1
 s_cmp_gt_u32 s26, 0
 s_waitcnt lgkmcnt(0)
 s_cbranch_scc1 qa_blk_203
 s_waitcnt vmcnt(0) lgkmcnt(0)
 s_cmp_eq_u32 s78, 0
 s_cbranch_scc1 pf_223
 v_mov_b32 v4, 0
 v_mov_b32 v5, 1
 s_mov_b64 exec, 1
 buffer_atomic_add v5, v4, s[72:75], s78 offen sc1
 s_mov_b64 exec, -1
 s_mov_b32 s78, 0
pf_223:
 s_cmp_eq_u32 s45, 0
 s_cbranch_scc1 q_done
 s_mul_i32 s21, s49, 393216
 s_mul_i32 s22, s42, 12288
 s_add_u32 s50, s21, s22
 s_lshr_b32 s21, s49, 1
 s_bitcmp1_b32 s37, s21
 s_cselect_b32 s21, 8192, 0
 s_lshl_b32 s51, s49, 20
 s_or_b32 s51, s51, s21
 s_xor_b32 s51, s51, 8192
 s_add_u32 s51, s51, s36
 s_lshr_b32 s22, s49, 1
 s_lshr_b32 s21, s49, 2
 s_add_u32 s21, s21, 3
 s_cmp_lt_u32 s49, 12
 s_cselect_b32 s21, s22, s21
 s_lshl_b32 s21, s21, 3
 s_lshr_b32 s22, s42, 2
 s_add_u32 s21, s21, s22
 s_lshl_b32 s21, s21, 7
 s_add_u32 s76, s21, 0
 s_lshl_b32 s77, s42, 7
 s_add_u32 s77, s77, 19456
 buffer_load_dword v21, v33, s[72:75], s77 offen sc1
 s_add_u32 s21, s50, 0
 buffer_load_dwordx4 v[36:39], v30, s[16:19], s21 offen offset:0 sc1
 buffer_load_dwordx4 v[40:43], v30, s[16:19], s21 offen offset:1024 sc1
 buffer_load_dwordx4 v[44:47], v30, s[16:19], s21 offen offset:2048 sc1
 buffer_load_dwordx4 v[48:51], v30, s[16:19], s21 offen offset:3072 sc1
 s_add_u32 s21, s50, 4096
 buffer_load_dwordx4 v[52:55], v30, s[16:19], s21 offen offset:0 sc1
 buffer_load_dwordx4 v[56:59], v30, s[16:19], s21 offen offset:1024 sc1
 buffer_load_dwordx4 v[60:63], v30, s[16:19], s21 offen offset:2048 sc1
 buffer_load_dwordx4 v[236:239], v30, s[16:19], s21 offen offset:3072 sc1
 s_add_u32 s21, s50, 8192
 buffer_load_dwordx4 v[240:243], v30, s[16:19], s21 offen offset:0 sc1
 buffer_load_dwordx4 v[244:247], v30, s[16:19], s21 offen offset:1024 sc1
 buffer_load_dwordx4 v[248:251], v30, s[16:19], s21 offen offset:2048 sc1
 buffer_load_dwordx4 v[252:255], v30, s[16:19], s21 offen offset:3072 sc1
 s_add_u32 s21, s43, 0
 buffer_load_dwordx4 v[64:67], v30, s[12:15], s21 offen offset:0 sc1
 buffer_load_dwordx4 v[68:71], v30, s[12:15], s21 offen offset:1024 sc1
 buffer_load_dwordx4 v[72:75], v30, s[12:15], s21 offen offset:2048 sc1
 buffer_load_dwordx4 v[76:79], v30, s[12:15], s21 offen offset:3072 sc1
 s_add_u32 s21, s43, 4096
 buffer_load_dwordx4 v[80:83], v30, s[12:15], s21 offen offset:0 sc1
 buffer_load_dwordx4 v[84:87], v30, s[12:15], s21 offen offset:1024 sc1
 buffer_load_dwordx4 v[88:91], v30, s[12:15], s21 offen offset:2048 sc1
 buffer_load_dwordx4 v[92:95], v30, s[12:15], s21 offen offset:3072 sc1
 s_add_u32 s21, s43, 8192
 buffer_load_dwordx4 v[96:99], v30, s[12:15], s21 offen offset:0 sc1
 buffer_load_dwordx4 v[100:103], v30, s[12:15], s21 offen offset:1024 sc1
 buffer_load_dwordx4 v[104:107], v30, s[12:15], s21 offen offset:2048 sc1
 buffer_load_dwordx4 v[108:111], v30, s[12:15], s21 offen offset:3072 sc1
 s_waitcnt vmcnt(24)
 s_cmp_eq_u32 s78, 0
 s_cbranch_scc1 pf_227
 v_mov_b32 v4, 0
 v_mov_b32 v5, 1
 s_mov_b64 exec, 1
 buffer_atomic_add v5, v4, s[72:75], s78 offen sc1
 s_mov_b64 exec, -1
 s_mov_b32 s78, 0
pf_227:
 s_add_u32 s23, s49, 1
 v_cmp_gt_u32 vcc, s23, v21
 s_mov_b32 s80, 0
 s_nop 0
 s_cbranch_vccnz qk_226
 s_mov_b32 s80, 1
 buffer_load_dwordx4 v[132:135], v31, s[52:55], s51 offen offset:0 sc1
 buffer_load_dwordx4 v[136:139], v31, s[52:55], s51 offen offset:512 sc1
 buffer_load_dwordx4 v[140:143], v31, s[52:55], s51 offen offset:1024 sc1
 buffer_load_dwordx4 v[144:147], v31, s[52:55], s51 offen offset:1536 sc1
 buffer_load_dwordx4 v[148:151], v31, s[52:55], s51 offen offset:2048 sc1
 buffer_load_dwordx4 v[152:155], v31, s[52:55], s51 offen offset:2560 sc1
 s_waitcnt vmcnt(6)
 s_branch qk_226x
qk_226:
 s_waitcnt vmcnt(0)
qk_226x:
 v_mfma_f32_16x16x32_bf16 v[112:115], v[36:39], v[64:67], 0
 v_mfma_f32_16x16x32_bf16 v[120:123], v[36:39], v[88:91], 0
 v_mfma_f32_16x16x32_bf16 v[124:127], v[60:63], v[88:91], 0
 v_mfma_f32_16x16x32_bf16 v[112:115], v[40:43], v[68:71], v[112:115]
 v_mfma_f32_16x16x32_bf16 v[120:123], v[40:43], v[92:95], v[120:123]
 v_mfma_f32_16x16x32_bf16 v[124:127], v[236:239], v[92:95], v[124:127]
 v_mfma_f32_16x16x32_bf16 v[112:115], v[44:47], v[72:75], v[112:115]
 v_mfma_f32_16x16x32_bf16 v[120:123], v[44:47], v[96:99], v[120:123]
 v_mfma_f32_16x16x32_bf16 v[124:127], v[240:243], v[96:99], v[124:127]
 v_mfma_f32_16x16x32_bf16 v[112:115], v[48:51], v[76:79], v[112:115]
 v_mfma_f32_16x16x32_bf16 v[120:123], v[48:51], v[100:103], v[120:123]
 v_mfma_f32_16x16x32_bf16 v[124:127], v[244:247], v[100:103], v[124:127]
 v_mfma_f32_16x16x32_bf16 v[112:115], v[52:55], v[80:83], v[112:115]
 v_mfma_f32_16x16x32_bf16 v[120:123], v[52:55], v[104:107], v[120:123]
 v_mfma_f32_16x16x32_bf16 v[124:127], v[248:251], v[104:107], v[124:127]
 v_mfma_f32_16x16x32_bf16 v[112:115], v[56:59], v[84:87], v[112:115]
 v_mfma_f32_16x16x32_bf16 v[120:123], v[56:59], v[108:111], v[120:123]
 v_mfma_f32_16x16x32_bf16 v[124:127], v[252:255], v[108:111], v[124:127]
 s_cmp_eq_u32 s80, 1
 s_cbranch_scc1 qm_228
 s_add_u32 s23, s49, 1
 s_min_u32 s22, s49, 61
 s_cmp_lt_u32 s49, 52
 s_cselect_b32 s23, s23, s22
 s_mov_b32 s101, 0
wm_229:
 buffer_load_dword v156, v33, s[72:75], s77 offen sc1
 s_add_u32 s101, s101, 1
 s_cmp_gt_u32 s101, 131072
 s_cbranch_scc1 main_end
 s_waitcnt vmcnt(0)
 v_cmp_gt_u32 vcc, s23, v156
 v_readfirstlane_b32 s100, v156
 s_nop 0
 s_cbranch_vccz wm_230
 s_sleep 16
 s_add_u32 s100, s100, 2
 s_cmp_ge_u32 s100, s23
 s_cbranch_scc1 wm_229
 s_sleep 90
 s_branch wm_229
wm_230:
 s_cmp_eq_u32 s49, 63
 s_cselect_b32 s21, s101, 0
 s_cmp_lt_u32 s21, 2
 s_cbranch_scc1 qtz_233
 s_sleep 36
qtz_233:
 s_mov_b32 s101, 0
 s_branch qtp_232
qtp_231:
 s_sleep 3
qtp_232:
 buffer_load_dwordx4 v[132:135], v31, s[52:55], s51 offen offset:0 sc1
 buffer_load_dwordx4 v[136:139], v31, s[52:55], s51 offen offset:512 sc1
 buffer_load_dwordx4 v[140:143], v31, s[52:55], s51 offen offset:1024 sc1
 buffer_load_dwordx4 v[144:147], v31, s[52:55], s51 offen offset:1536 sc1
 buffer_load_dwordx4 v[148:151], v31, s[52:55], s51 offen offset:2048 sc1
 buffer_load_dwordx4 v[152:155], v31, s[52:55], s51 offen offset:2560 sc1
 s_add_u32 s101, s101, 1
 s_cmp_gt_u32 s101, 131072
 s_cbranch_scc1 main_end
 s_waitcnt vmcnt(0)
 v_max3_u32 v156, v132, v134, v136
 v_max3_u32 v156, v156, v138, v140
 v_max3_u32 v156, v156, v142, v144
 v_max3_u32 v156, v156, v146, v148
 v_max3_u32 v156, v156, v150, v152
 v_max3_u32 v156, v156, v154, v154
 v_cmp_eq_u32 vcc, -1, v156
 s_nop 1
 s_cbranch_vccnz qtp_231
qm_228:
 s_waitcnt vmcnt(0)
 v_mfma_f32_16x16x32_bf16 v[116:119], v[132:135], v[64:67], 0
 v_mfma_f32_16x16x32_bf16 v[128:131], v[132:135], v[88:91], 0
 v_mfma_f32_16x16x32_bf16 v[116:119], v[136:139], v[68:71], v[116:119]
 v_mfma_f32_16x16x32_bf16 v[128:131], v[136:139], v[92:95], v[128:131]
 v_mfma_f32_16x16x32_bf16 v[116:119], v[140:143], v[72:75], v[116:119]
 v_mfma_f32_16x16x32_bf16 v[128:131], v[140:143], v[96:99], v[128:131]
 v_mfma_f32_16x16x32_bf16 v[116:119], v[144:147], v[76:79], v[116:119]
 v_mfma_f32_16x16x32_bf16 v[128:131], v[144:147], v[100:103], v[128:131]
 v_mfma_f32_16x16x32_bf16 v[116:119], v[148:151], v[80:83], v[116:119]
 v_mfma_f32_16x16x32_bf16 v[128:131], v[148:151], v[104:107], v[128:131]
 v_mfma_f32_16x16x32_bf16 v[116:119], v[152:155], v[84:87], v[116:119]
 v_mfma_f32_16x16x32_bf16 v[128:131], v[152:155], v[108:111], v[128:131]
qx_225:
 s_lshr_b32 s21, s49, 1
 s_bitcmp1_b32 s37, s21
 s_cselect_b32 s21, 8192, 0
 s_lshl_b32 s81, s49, 20
 s_or_b32 s81, s81, s21
 s_add_u32 s81, s81, s44
 s_lshl_b32 s82, s49, 3
 s_and_b32 s21, s42, 7
 s_add_u32 s82, s82, s21
 s_lshl_b32 s82, s82, 7
 s_add_u32 s82, s82, 23552
 v_cndmask_b32 v112, v34, v112, s[64:65]
 v_cndmask_b32 v124, v34, v124, s[64:65]
 v_cndmask_b32 v113, v34, v113, s[66:67]
 v_cndmask_b32 v125, v34, v125, s[66:67]
 v_cndmask_b32 v114, v34, v114, s[68:69]
 v_cndmask_b32 v126, v34, v126, s[68:69]
 v_cndmask_b32 v115, v34, v115, s[70:71]
 v_cndmask_b32 v127, v34, v127, s[70:71]
 v_max3_f32 v156, v112, v113, v114
 v_max3_f32 v156, v156, v115, v116
 v_max3_f32 v156, v156, v117, v118
 v_max_f32 v156, v156, v119
 v_mov_b32 v157, v156
 s_nop 1
 v_permlane32_swap_b32 v156, v157
 v_max_f32 v156, v156, v157
 v_mov_b32 v157, v156
 s_nop 1
 v_permlane16_swap_b32 v156, v157
 v_max_f32 v156, v156, v157
 v_mul_f32 v156, s83, v156
 v_fma_f32 v112, v112, s83, -v156
 v_fma_f32 v113, v113, s83, -v156
 v_fma_f32 v114, v114, s83, -v156
 v_fma_f32 v115, v115, s83, -v156
 v_fma_f32 v116, v116, s83, -v156
 v_fma_f32 v117, v117, s83, -v156
 v_fma_f32 v118, v118, s83, -v156
 v_fma_f32 v119, v119, s83, -v156
 v_exp_f32 v112, v112
 v_exp_f32 v113, v113
 v_exp_f32 v114, v114
 v_exp_f32 v115, v115
 v_exp_f32 v116, v116
 v_exp_f32 v117, v117
 v_exp_f32 v118, v118
 v_exp_f32 v119, v119
 s_nop 0
 v_add_f32 v156, v116, v117
 v_add_f32 v156, v156, v118
 v_add_f32 v156, v156, v119
 v_cndmask_b32 v156, 0, v156, s[60:61]
 v_add_f32 v156, v156, v112
 v_add_f32 v156, v156, v113
 v_add_f32 v156, v156, v114
 v_add_f32 v156, v156, v115
 v_mov_b32 v157, v156
 s_nop 1
 v_permlane32_swap_b32 v156, v157
 v_add_f32 v156, v156, v157
 v_mov_b32 v157, v156
 s_nop 1
 v_permlane16_swap_b32 v156, v157
 v_add_f32 v156, v156, v157
 v_rcp_f32 v156, v156
 s_nop 0
 v_mul_f32 v112, v112, v156
 v_mul_f32 v113, v113, v156
 v_mul_f32 v114, v114, v156
 v_mul_f32 v115, v115, v156
 v_mul_f32 v116, v116, v156
 v_mul_f32 v117, v117, v156
 v_mul_f32 v118, v118, v156
 v_mul_f32 v119, v119, v156
 v_max3_f32 v156, v120, v121, v122
 v_max3_f32 v156, v156, v123, v124
 v_max3_f32 v156, v156, v125, v126
 v_max3_f32 v156, v156, v127, v128
 v_max3_f32 v156, v156, v129, v130
 v_max_f32 v156, v156, v131
 v_mov_b32 v157, v156
 s_nop 1
 v_permlane32_swap_b32 v156, v157
 v_max_f32 v156, v156, v157
 v_mov_b32 v157, v156
 s_nop 1
 v_permlane16_swap_b32 v156, v157
 v_max_f32 v156, v156, v157
 v_mul_f32 v156, s83, v156
 v_fma_f32 v120, v120, s83, -v156
 v_fma_f32 v121, v121, s83, -v156
 v_fma_f32 v122, v122, s83, -v156
 v_fma_f32 v123, v123, s83, -v156
 v_fma_f32 v124, v124, s83, -v156
 v_fma_f32 v125, v125, s83, -v156
 v_fma_f32 v126, v126, s83, -v156
 v_fma_f32 v127, v127, s83, -v156
 v_fma_f32 v128, v128, s83, -v156
 v_fma_f32 v129, v129, s83, -v156
 v_fma_f32 v130, v130, s83, -v156
 v_fma_f32 v131, v131, s83, -v156
 v_exp_f32 v120, v120
 v_exp_f32 v121, v121
 v_exp_f32 v122, v122
 v_exp_f32 v123, v123
 v_exp_f32 v124, v124
 v_exp_f32 v125, v125
 v_exp_f32 v126, v126
 v_exp_f32 v127, v127
 v_exp_f32 v128, v128
 v_exp_f32 v129, v129
 v_exp_f32 v130, v130
 v_exp_f32 v131, v131
 s_nop 0
 v_add_f32 v156, v128, v129
 v_add_f32 v156, v156, v130
 v_add_f32 v156, v156, v131
 v_cndmask_b32 v156, 0, v156, s[60:61]
 v_add_f32 v156, v156, v120
 v_add_f32 v156, v156, v121
 v_add_f32 v156, v156, v122
 v_add_f32 v156, v156, v123
 v_add_f32 v156, v156, v124
 v_add_f32 v156, v156, v125
 v_add_f32 v156, v156, v126
 v_add_f32 v156, v156, v127
 v_mov_b32 v157, v156
 s_nop 1
 v_permlane32_swap_b32 v156, v157
 v_add_f32 v156, v156, v157
 v_mov_b32 v157, v156
 s_nop 1
 v_permlane16_swap_b32 v156, v157
 v_add_f32 v156, v156, v157
 v_rcp_f32 v156, v156
 s_nop 0
 v_mul_f32 v120, v120, v156
 v_mul_f32 v121, v121, v156
 v_mul_f32 v122, v122, v156
 v_mul_f32 v123, v123, v156
 v_mul_f32 v124, v124, v156
 v_mul_f32 v125, v125, v156
 v_mul_f32 v126, v126, v156
 v_mul_f32 v127, v127, v156
 v_mul_f32 v128, v128, v156
 v_mul_f32 v129, v129, v156
 v_mul_f32 v130, v130, v156
 v_mul_f32 v131, v131, v156
 v_cvt_pk_bf16_f32 v196, v116, v117
 v_cvt_pk_bf16_f32 v197, v118, v119
 v_cvt_pk_bf16_f32 v198, v128, v129
 v_cvt_pk_bf16_f32 v199, v130, v131
 v_cvt_pk_bf16_f32 v192, v120, v121
 v_cvt_pk_bf16_f32 v193, v122, v123
 v_cvt_pk_bf16_f32 v194, v124, v125
 v_cvt_pk_bf16_f32 v195, v126, v127
 v_cvt_pk_bf16_f32 v200, v112, v113
 v_cvt_pk_bf16_f32 v201, v114, v115
 v_permlane16_swap_b32 v196, v198
 v_permlane16_swap_b32 v197, v199
 buffer_store_dwordx4 v[192:195], v30, s[56:59], s81 offen sc1
 s_mov_b64 exec, 0xffffffff
 buffer_store_dwordx4 v[196:199], v30, s[56:59], s81 offen offset:1024 sc1
 s_mov_b64 exec, -1
 buffer_store_dwordx2 v[200:201], v32, s[56:59], s81 offen offset:1536 sc1
 s_mov_b32 s78, s82
 s_mov_b32 s81, 0x80000000
 s_mov_b32 s82, 0
 s_cmp_eq_u32 s80, 1
 s_cbranch_scc1 qd_234
 s_waitcnt vmcnt(0)
 s_cmp_eq_u32 s78, 0
 s_cbranch_scc1 pf_235
 v_mov_b32 v4, 0
 v_mov_b32 v5, 1
 s_mov_b64 exec, 1
 buffer_atomic_add v5, v4, s[72:75], s78 offen sc1
 s_mov_b64 exec, -1
 s_mov_b32 s78, 0
pf_235:
qd_234:
 s_add_u32 s49, s49, s29
qbe_224:
 s_waitcnt vmcnt(0)
 s_cmp_eq_u32 s78, 0
 s_cbranch_scc1 pf_236
 v_mov_b32 v4, 0
 v_mov_b32 v5, 1
 s_mov_b64 exec, 1
 buffer_atomic_add v5, v4, s[72:75], s78 offen sc1
 s_mov_b64 exec, -1
 s_mov_b32 s78, 0
pf_236:
 s_branch queue
q_done:
 s_and_b32 s21, s3, 3
 s_sub_u32 s22, s21, 0
 s_lshl_b32 s22, s22, 3
 s_bfe_u32 s87, s3, 0x30002
 s_add_u32 s87, s87, s22
 s_add_u32 s87, s87, 252
 s_cmp_lt_u32 s21, 0
 s_cselect_b32 s87, -1, s87
 s_sub_u32 s21, s3, 96
 s_waitcnt vmcnt(0) lgkmcnt(0)
 s_barrier
 s_branch do_opb2
queue:
 s_load_dwordx2 s[4:5], s[0:1], 96
 s_waitcnt lgkmcnt(0)
 s_mov_b32 s32, s4
 s_mov_b32 s33, s5
 s_mov_b32 s34, 256
 s_mov_b32 s35, 0x00020000
 s_waitcnt vmcnt(0) lgkmcnt(0)
 s_barrier
 s_mov_b32 s2, s85
 s_mov_b32 s85, -1
 s_cmp_lg_u32 s2, -1
 s_cbranch_scc1 queue_c
 v_mov_b32 v21, 0
 s_cmp_lg_u32 s20, 0
 s_cbranch_scc1 q_237
 v_mov_b32 v22, 80
 v_mov_b32 v23, 1
 s_mov_b64 exec, 1
 buffer_atomic_add v23, v22, s[32:35], 0 offen sc0 sc1
 s_waitcnt vmcnt(0)
queue_a:
 ds_write_b32 v21, v23
 s_waitcnt lgkmcnt(0)
 s_mov_b64 exec, -1
q_237:
queue_b:
 s_barrier
 ds_read_b32 v23, v21
 s_waitcnt lgkmcnt(0)
 v_readfirstlane_b32 s2, v23
 s_barrier
queue_c:
 s_add_u32 s21, s2, 0
 s_cmp_lt_u32 s2, 64
 s_cbranch_scc1 do_pv
 s_sub_u32 s2, s2, 64
 s_add_u32 s21, s2, 64
 s_cmp_lt_u32 s2, 20
 s_cbranch_scc1 do_pv
 s_sub_u32 s2, s2, 20
 s_add_u32 s21, s2, 104
 s_cmp_lt_u32 s2, 20
 s_cbranch_scc1 do_pv
 s_sub_u32 s2, s2, 20
 s_add_u32 s21, s2, 84
 s_cmp_lt_u32 s2, 20
 s_cbranch_scc1 do_pv
 s_sub_u32 s2, s2, 20
 s_add_u32 s21, s2, 124
 s_cmp_lt_u32 s2, 20
 s_cbranch_scc1 do_pv
 s_sub_u32 s2, s2, 20
 s_add_u32 s21, s2, 144
 s_cmp_lt_u32 s2, 108
 s_cbranch_scc1 do_pv
 s_sub_u32 s2, s2, 108
 s_branch main_fin
do_opb:
 s_mov_b32 s87, -1
do_opb2:
 s_mov_b32 s2, s21
 s_load_dwordx2 s[4:5], s[0:1], 0
 s_load_dwordx4 s[40:43], s[0:1], 72
 s_load_dwordx2 s[38:39], s[0:1], 104
 s_lshl_b32 s59, s2, 2
 s_add_u32 s59, s59, s20
 s_lshl_b32 s59, s59, 3
 v_lshlrev_b32 v4, 4, v1
 v_lshlrev_b32 v5, 2, v1
 s_waitcnt lgkmcnt(0)
 s_mov_b32 s8, s4
 s_mov_b32 s9, s5
 s_mov_b32 s10, 2621440
 s_mov_b32 s11, 0x00020000
 s_mov_b32 s12, s42
 s_mov_b32 s13, s43
 s_mov_b32 s14, 1280
 s_mov_b32 s15, 0x00020000
 s_mov_b32 s24, s40
 s_mov_b32 s25, s41
 s_mov_b32 s26, 819200
 s_mov_b32 s27, 0x00020000
 s_add_u32 s16, s38, 70713344
 s_addc_u32 s17, s39, 0
 s_mov_b32 s18, 2641920
 s_mov_b32 s19, 0x00020000
 s_add_u32 s28, s38, 81002496
 s_addc_u32 s29, s39, 0
 s_mov_b32 s30, 8192
 s_mov_b32 s31, 0x00020000
 s_add_u32 s72, s38, 81068032
 s_addc_u32 s73, s39, 0
 s_mov_b32 s74, 129024
 s_mov_b32 s75, 0x00020000
 s_mov_b32 s21, 91136
 v_mov_b32 v20, 0
 buffer_load_dword v21, v20, s[72:75], s21 offen sc1
 v_mov_b32 v29, 3277
 s_mul_i32 s21, s20, 320
 s_add_u32 s21, s21, 0
 v_add_u32 v22, s21, v1
 v_mul_u32_u24 v23, v22, v29
 v_lshrrev_b32 v23, 16, v23
 v_mul_u32_u24 v24, 20, v23
 v_sub_u32 v22, v22, v24
 v_bfe_u32 v24, v23, 3, 1
 v_lshlrev_b32 v24, 1, v24
 v_xor_b32 v22, v22, v24
 v_mul_u32_u24 v23, 1280, v23
 v_lshl_add_u32 v8, v22, 4, v23
 s_mul_i32 s21, s20, 320
 s_add_u32 s21, s21, 64
 v_add_u32 v22, s21, v1
 v_mul_u32_u24 v23, v22, v29
 v_lshrrev_b32 v23, 16, v23
 v_mul_u32_u24 v24, 20, v23
 v_sub_u32 v22, v22, v24
 v_bfe_u32 v24, v23, 3, 1
 v_lshlrev_b32 v24, 1, v24
 v_xor_b32 v22, v22, v24
 v_mul_u32_u24 v23, 1280, v23
 v_lshl_add_u32 v9, v22, 4, v23
 s_mul_i32 s21, s20, 320
 s_add_u32 s21, s21, 128
 v_add_u32 v22, s21, v1
 v_mul_u32_u24 v23, v22, v29
 v_lshrrev_b32 v23, 16, v23
 v_mul_u32_u24 v24, 20, v23
 v_sub_u32 v22, v22, v24
 v_bfe_u32 v24, v23, 3, 1
 v_lshlrev_b32 v24, 1, v24
 v_xor_b32 v22, v22, v24
 v_mul_u32_u24 v23, 1280, v23
 v_lshl_add_u32 v10, v22, 4, v23
 s_mul_i32 s21, s20, 320
 s_add_u32 s21, s21, 192
 v_add_u32 v22, s21, v1
 v_mul_u32_u24 v23, v22, v29
 v_lshrrev_b32 v23, 16, v23
 v_mul_u32_u24 v24, 20, v23
 v_sub_u32 v22, v22, v24
 v_bfe_u32 v24, v23, 3, 1
 v_lshlrev_b32 v24, 1, v24
 v_xor_b32 v22, v22, v24
 v_mul_u32_u24 v23, 1280, v23
 v_lshl_add_u32 v11, v22, 4, v23
 s_mul_i32 s21, s20, 320
 s_add_u32 s21, s21, 256
 v_add_u32 v22, s21, v1
 v_mul_u32_u24 v23, v22, v29
 v_lshrrev_b32 v23, 16, v23
 v_mul_u32_u24 v24, 20, v23
 v_sub_u32 v22, v22, v24
 v_bfe_u32 v24, v23, 3, 1
 v_lshlrev_b32 v24, 1, v24
 v_xor_b32 v22, v22, v24
 v_mul_u32_u24 v23, 1280, v23
 v_lshl_add_u32 v12, v22, 4, v23
 s_and_b32 s44, s2, 3
 s_mul_i32 s45, s44, 320
 s_mul_i32 s46, s20, 5120
 v_and_b32 v22, 1, v2
 v_mul_u32_u24 v22, 16512, v22
 v_mul_u32_u24 v23, 33024, v3
 v_lshrrev_b32 v24, 1, v2
 v_lshlrev_b32 v24, 4, v24
 v_add3_u32 v6, v22, v23, v24
 s_lshr_b32 s47, s2, 2
 s_lshl_b32 s47, s47, 2
 s_add_u32 s47, s47, s20
 s_lshl_b32 s47, s47, 1
 s_lshl_b32 s48, s47, 7
 v_lshrrev_b32 v22, 2, v2
 v_lshl_add_u32 v22, v3, 3, v22
 v_mul_u32_u24 v22, 320, v22
 v_and_b32 v23, 3, v2
 v_lshl_add_u32 v22, v23, 3, v22
 v_and_b32 v23, 1, v3
 v_lshlrev_b32 v23, 5, v23
 v_add_u32 v14, v22, v23
 v_sub_u32 v15, v22, v23
 v_add_u32 v16, 61440, v14
 v_add_u32 v17, 61440, v15
 v_add_u32 v18, 122880, v14
 v_add_u32 v19, 122880, v15
 s_add_u32 m0, s46, 0
 s_add_u32 s49, s45, 0
 s_nop 0
 buffer_load_dwordx4 v8, s[24:27], s49 offen lds
 s_add_u32 m0, s46, 1024
 s_nop 0
 buffer_load_dwordx4 v9, s[24:27], s49 offen lds
 s_add_u32 m0, s46, 2048
 s_nop 0
 buffer_load_dwordx4 v10, s[24:27], s49 offen lds
 s_add_u32 m0, s46, 3072
 s_nop 0
 buffer_load_dwordx4 v11, s[24:27], s49 offen lds
 s_add_u32 m0, s46, 4096
 s_nop 0
 buffer_load_dwordx4 v12, s[24:27], s49 offen lds
 s_add_u32 m0, s46, 20480
 s_add_u32 s49, s45, 81920
 s_nop 0
 buffer_load_dwordx4 v8, s[24:27], s49 offen lds
 s_add_u32 m0, s46, 21504
 s_nop 0
 buffer_load_dwordx4 v9, s[24:27], s49 offen lds
 s_add_u32 m0, s46, 22528
 s_nop 0
 buffer_load_dwordx4 v10, s[24:27], s49 offen lds
 s_add_u32 m0, s46, 23552
 s_nop 0
 buffer_load_dwordx4 v11, s[24:27], s49 offen lds
 s_add_u32 m0, s46, 24576
 s_nop 0
 buffer_load_dwordx4 v12, s[24:27], s49 offen lds
 s_waitcnt vmcnt(10)
 v_readfirstlane_b32 s21, v21
 s_cmp_ge_u32 s21, 32
 s_cbranch_scc1 o2_238
 s_mov_b32 s21, 91136
 v_mov_b32 v20, 0
 s_mov_b32 s101, 0
wf_239:
 buffer_load_dword v21, v20, s[72:75], s21 offen sc1
 s_add_u32 s101, s101, 1
 s_cmp_gt_u32 s101, 131072
 s_cbranch_scc1 main_end
 s_waitcnt vmcnt(0)
 v_readfirstlane_b32 s100, v21
 s_cmp_ge_u32 s100, 32
 s_cbranch_scc1 wf_240
 s_sleep 32
 s_branch wf_239
wf_240:
o2_238:
 buffer_load_dwordx4 a[0:3], v6, s[16:19], s48 offen offset:0 sc1
 buffer_load_dwordx4 a[4:7], v6, s[16:19], s48 offen offset:128 sc1
 s_add_u32 s48, s48, 132096
 buffer_load_dwordx4 a[8:11], v6, s[16:19], s48 offen offset:0 sc1
 buffer_load_dwordx4 a[12:15], v6, s[16:19], s48 offen offset:128 sc1
 s_add_u32 s48, s48, 132096
 buffer_load_dwordx4 a[16:19], v6, s[16:19], s48 offen offset:0 sc1
 buffer_load_dwordx4 a[20:23], v6, s[16:19], s48 offen offset:128 sc1
 s_add_u32 s48, s48, 132096
 buffer_load_dwordx4 a[24:27], v6, s[16:19], s48 offen offset:0 sc1
 buffer_load_dwordx4 a[28:31], v6, s[16:19], s48 offen offset:128 sc1
 s_add_u32 s48, s48, 132096
 s_add_u32 m0, s46, 40960
 s_add_u32 s49, s45, 163840
 s_nop 0
 buffer_load_dwordx4 v8, s[24:27], s49 offen lds
 s_add_u32 m0, s46, 41984
 s_nop 0
 buffer_load_dwordx4 v9, s[24:27], s49 offen lds
 s_add_u32 m0, s46, 43008
 s_nop 0
 buffer_load_dwordx4 v10, s[24:27], s49 offen lds
 s_add_u32 m0, s46, 44032
 s_nop 0
 buffer_load_dwordx4 v11, s[24:27], s49 offen lds
 s_add_u32 m0, s46, 45056
 s_nop 0
 buffer_load_dwordx4 v12, s[24:27], s49 offen lds
 buffer_load_dwordx4 a[32:35], v6, s[16:19], s48 offen offset:0 sc1
 buffer_load_dwordx4 a[36:39], v6, s[16:19], s48 offen offset:128 sc1
 s_add_u32 s48, s48, 132096
 buffer_load_dwordx4 a[40:43], v6, s[16:19], s48 offen offset:0 sc1
 buffer_load_dwordx4 a[44:47], v6, s[16:19], s48 offen offset:128 sc1
 s_add_u32 s48, s48, 132096
 s_add_u32 m0, s46, 61440
 s_add_u32 s49, s45, 245760
 s_nop 0
 buffer_load_dwordx4 v8, s[24:27], s49 offen lds
 s_add_u32 m0, s46, 62464
 s_nop 0
 buffer_load_dwordx4 v9, s[24:27], s49 offen lds
 s_add_u32 m0, s46, 63488
 s_nop 0
 buffer_load_dwordx4 v10, s[24:27], s49 offen lds
 s_add_u32 m0, s46, 64512
 s_nop 0
 buffer_load_dwordx4 v11, s[24:27], s49 offen lds
 s_add_u32 m0, s46, 65536
 s_nop 0
 buffer_load_dwordx4 v12, s[24:27], s49 offen lds
 buffer_load_dwordx4 a[48:51], v6, s[16:19], s48 offen offset:0 sc1
 buffer_load_dwordx4 a[52:55], v6, s[16:19], s48 offen offset:128 sc1
 s_add_u32 s48, s48, 132096
 buffer_load_dwordx4 a[56:59], v6, s[16:19], s48 offen offset:0 sc1
 buffer_load_dwordx4 a[60:63], v6, s[16:19], s48 offen offset:128 sc1
 s_add_u32 s48, s48, 132096
 s_add_u32 m0, s46, 81920
 s_add_u32 s49, s45, 327680
 s_nop 0
 buffer_load_dwordx4 v8, s[24:27], s49 offen lds
 s_add_u32 m0, s46, 82944
 s_nop 0
 buffer_load_dwordx4 v9, s[24:27], s49 offen lds
 s_add_u32 m0, s46, 83968
 s_nop 0
 buffer_load_dwordx4 v10, s[24:27], s49 offen lds
 s_add_u32 m0, s46, 84992
 s_nop 0
 buffer_load_dwordx4 v11, s[24:27], s49 offen lds
 s_add_u32 m0, s46, 86016
 s_nop 0
 buffer_load_dwordx4 v12, s[24:27], s49 offen lds
 buffer_load_dwordx4 a[64:67], v6, s[16:19], s48 offen offset:0 sc1
 buffer_load_dwordx4 a[68:71], v6, s[16:19], s48 offen offset:128 sc1
 s_add_u32 s48, s48, 132096
 buffer_load_dwordx4 a[72:75], v6, s[16:19], s48 offen offset:0 sc1
 buffer_load_dwordx4 a[76:79], v6, s[16:19], s48 offen offset:128 sc1
 s_add_u32 s48, s48, 132096
 s_add_u32 m0, s46, 102400
 s_add_u32 s49, s45, 409600
 s_nop 0
 buffer_load_dwordx4 v8, s[24:27], s49 offen lds
 s_add_u32 m0, s46, 103424
 s_nop 0
 buffer_load_dwordx4 v9, s[24:27], s49 offen lds
 s_add_u32 m0, s46, 104448
 s_nop 0
 buffer_load_dwordx4 v10, s[24:27], s49 offen lds
 s_add_u32 m0, s46, 105472
 s_nop 0
 buffer_load_dwordx4 v11, s[24:27], s49 offen lds
 s_add_u32 m0, s46, 106496
 s_nop 0
 buffer_load_dwordx4 v12, s[24:27], s49 offen lds
 s_add_u32 m0, s46, 122880
 s_add_u32 s49, s45, 491520
 s_nop 0
 buffer_load_dwordx4 v8, s[24:27], s49 offen lds
 s_add_u32 m0, s46, 123904
 s_nop 0
 buffer_load_dwordx4 v9, s[24:27], s49 offen lds
 s_add_u32 m0, s46, 124928
 s_nop 0
 buffer_load_dwordx4 v10, s[24:27], s49 offen lds
 s_add_u32 m0, s46, 125952
 s_nop 0
 buffer_load_dwordx4 v11, s[24:27], s49 offen lds
 s_add_u32 m0, s46, 126976
 s_nop 0
 buffer_load_dwordx4 v12, s[24:27], s49 offen lds
 s_waitcnt vmcnt(50)
 s_barrier
 ds_read_b64_tr_b16 v[144:145], v14 offset:0
 ds_read_b64_tr_b16 v[146:147], v14 offset:1280
 ds_read_b64_tr_b16 v[148:149], v15 offset:32
 ds_read_b64_tr_b16 v[150:151], v15 offset:1312
 ds_read_b64_tr_b16 v[152:153], v14 offset:64
 ds_read_b64_tr_b16 v[154:155], v14 offset:1344
 ds_read_b64_tr_b16 v[156:157], v15 offset:96
 ds_read_b64_tr_b16 v[158:159], v15 offset:1376
 ds_read_b64_tr_b16 v[160:161], v14 offset:128
 ds_read_b64_tr_b16 v[162:163], v14 offset:1408
 ds_read_b64_tr_b16 v[164:165], v15 offset:160
 ds_read_b64_tr_b16 v[166:167], v15 offset:1440
 ds_read_b64_tr_b16 v[168:169], v14 offset:192
 ds_read_b64_tr_b16 v[170:171], v14 offset:1472
 ds_read_b64_tr_b16 v[172:173], v15 offset:224
 ds_read_b64_tr_b16 v[174:175], v15 offset:1504
 ds_read_b64_tr_b16 v[176:177], v14 offset:256
 ds_read_b64_tr_b16 v[178:179], v14 offset:1536
 ds_read_b64_tr_b16 v[180:181], v15 offset:288
 ds_read_b64_tr_b16 v[182:183], v15 offset:1568
 s_waitcnt lgkmcnt(0) vmcnt(43)
 v_mfma_f32_16x16x32_bf16 v[64:67], v[144:147], a[0:3], 0
 ds_read_b64_tr_b16 v[184:185], v14 offset:10240
 ds_read_b64_tr_b16 v[186:187], v14 offset:11520
 v_mfma_f32_16x16x32_bf16 v[104:107], v[144:147], a[4:7], 0
 ds_read_b64_tr_b16 v[188:189], v15 offset:10272
 v_mfma_f32_16x16x32_bf16 v[68:71], v[148:151], a[0:3], 0
 ds_read_b64_tr_b16 v[190:191], v15 offset:11552
 v_mfma_f32_16x16x32_bf16 v[108:111], v[148:151], a[4:7], 0
 ds_read_b64_tr_b16 v[192:193], v14 offset:10304
 v_mfma_f32_16x16x32_bf16 v[72:75], v[152:155], a[0:3], 0
 ds_read_b64_tr_b16 v[194:195], v14 offset:11584
 v_mfma_f32_16x16x32_bf16 v[112:115], v[152:155], a[4:7], 0
 ds_read_b64_tr_b16 v[196:197], v15 offset:10336
 ds_read_b64_tr_b16 v[198:199], v15 offset:11616
 v_mfma_f32_16x16x32_bf16 v[76:79], v[156:159], a[0:3], 0
 ds_read_b64_tr_b16 v[200:201], v14 offset:10368
 v_mfma_f32_16x16x32_bf16 v[116:119], v[156:159], a[4:7], 0
 ds_read_b64_tr_b16 v[202:203], v14 offset:11648
 v_mfma_f32_16x16x32_bf16 v[80:83], v[160:163], a[0:3], 0
 ds_read_b64_tr_b16 v[204:205], v15 offset:10400
 v_mfma_f32_16x16x32_bf16 v[120:123], v[160:163], a[4:7], 0
 ds_read_b64_tr_b16 v[206:207], v15 offset:11680
 v_mfma_f32_16x16x32_bf16 v[84:87], v[164:167], a[0:3], 0
 ds_read_b64_tr_b16 v[208:209], v14 offset:10432
 v_mfma_f32_16x16x32_bf16 v[124:127], v[164:167], a[4:7], 0
 ds_read_b64_tr_b16 v[210:211], v14 offset:11712
 ds_read_b64_tr_b16 v[212:213], v15 offset:10464
 v_mfma_f32_16x16x32_bf16 v[88:91], v[168:171], a[0:3], 0
 ds_read_b64_tr_b16 v[214:215], v15 offset:11744
 v_mfma_f32_16x16x32_bf16 v[128:131], v[168:171], a[4:7], 0
 buffer_load_dwordx4 a[80:83], v6, s[16:19], s48 offen offset:0 sc1
 ds_read_b64_tr_b16 v[216:217], v14 offset:10496
 v_mfma_f32_16x16x32_bf16 v[92:95], v[172:175], a[0:3], 0
 ds_read_b64_tr_b16 v[218:219], v14 offset:11776
 v_mfma_f32_16x16x32_bf16 v[132:135], v[172:175], a[4:7], 0
 ds_read_b64_tr_b16 v[220:221], v15 offset:10528
 v_mfma_f32_16x16x32_bf16 v[96:99], v[176:179], a[0:3], 0
 ds_read_b64_tr_b16 v[222:223], v15 offset:11808
 v_mfma_f32_16x16x32_bf16 v[136:139], v[176:179], a[4:7], 0
 buffer_load_dwordx4 a[84:87], v6, s[16:19], s48 offen offset:128 sc1
 v_mfma_f32_16x16x32_bf16 v[100:103], v[180:183], a[0:3], 0
 s_add_u32 s48, s48, 132096
 v_mfma_f32_16x16x32_bf16 v[140:143], v[180:183], a[4:7], 0
 s_waitcnt lgkmcnt(0) vmcnt(43)
 s_barrier
 v_mfma_f32_16x16x32_bf16 v[64:67], v[184:187], a[8:11], v[64:67]
 s_add_u32 m0, s46, 0
 ds_read_b64_tr_b16 v[144:145], v14 offset:20480
 ds_read_b64_tr_b16 v[146:147], v14 offset:21760
 v_mfma_f32_16x16x32_bf16 v[104:107], v[184:187], a[12:15], v[104:107]
 s_add_u32 s49, s45, 573440
 ds_read_b64_tr_b16 v[148:149], v15 offset:20512
 v_mfma_f32_16x16x32_bf16 v[68:71], v[188:191], a[8:11], v[68:71]
 buffer_load_dwordx4 v8, s[24:27], s49 offen lds
 ds_read_b64_tr_b16 v[150:151], v15 offset:21792
 v_mfma_f32_16x16x32_bf16 v[108:111], v[188:191], a[12:15], v[108:111]
 s_add_u32 m0, s46, 1024
 ds_read_b64_tr_b16 v[152:153], v14 offset:20544
 v_mfma_f32_16x16x32_bf16 v[72:75], v[192:195], a[8:11], v[72:75]
 buffer_load_dwordx4 v9, s[24:27], s49 offen lds
 ds_read_b64_tr_b16 v[154:155], v14 offset:21824
 v_mfma_f32_16x16x32_bf16 v[112:115], v[192:195], a[12:15], v[112:115]
 s_add_u32 m0, s46, 2048
 ds_read_b64_tr_b16 v[156:157], v15 offset:20576
 ds_read_b64_tr_b16 v[158:159], v15 offset:21856
 v_mfma_f32_16x16x32_bf16 v[76:79], v[196:199], a[8:11], v[76:79]
 buffer_load_dwordx4 v10, s[24:27], s49 offen lds
 ds_read_b64_tr_b16 v[160:161], v14 offset:20608
 v_mfma_f32_16x16x32_bf16 v[116:119], v[196:199], a[12:15], v[116:119]
 s_add_u32 m0, s46, 3072
 ds_read_b64_tr_b16 v[162:163], v14 offset:21888
 v_mfma_f32_16x16x32_bf16 v[80:83], v[200:203], a[8:11], v[80:83]
 buffer_load_dwordx4 v11, s[24:27], s49 offen lds
 ds_read_b64_tr_b16 v[164:165], v15 offset:20640
 v_mfma_f32_16x16x32_bf16 v[120:123], v[200:203], a[12:15], v[120:123]
 s_add_u32 m0, s46, 4096
 ds_read_b64_tr_b16 v[166:167], v15 offset:21920
 v_mfma_f32_16x16x32_bf16 v[84:87], v[204:207], a[8:11], v[84:87]
 buffer_load_dwordx4 v12, s[24:27], s49 offen lds
 ds_read_b64_tr_b16 v[168:169], v14 offset:20672
 v_mfma_f32_16x16x32_bf16 v[124:127], v[204:207], a[12:15], v[124:127]
 ds_read_b64_tr_b16 v[170:171], v14 offset:21952
 ds_read_b64_tr_b16 v[172:173], v15 offset:20704
 v_mfma_f32_16x16x32_bf16 v[88:91], v[208:211], a[8:11], v[88:91]
 ds_read_b64_tr_b16 v[174:175], v15 offset:21984
 v_mfma_f32_16x16x32_bf16 v[128:131], v[208:211], a[12:15], v[128:131]
 buffer_load_dwordx4 a[88:91], v6, s[16:19], s48 offen offset:0 sc1
 ds_read_b64_tr_b16 v[176:177], v14 offset:20736
 v_mfma_f32_16x16x32_bf16 v[92:95], v[212:215], a[8:11], v[92:95]
 ds_read_b64_tr_b16 v[178:179], v14 offset:22016
 v_mfma_f32_16x16x32_bf16 v[132:135], v[212:215], a[12:15], v[132:135]
 ds_read_b64_tr_b16 v[180:181], v15 offset:20768
 v_mfma_f32_16x16x32_bf16 v[96:99], v[216:219], a[8:11], v[96:99]
 ds_read_b64_tr_b16 v[182:183], v15 offset:22048
 v_mfma_f32_16x16x32_bf16 v[136:139], v[216:219], a[12:15], v[136:139]
 buffer_load_dwordx4 a[92:95], v6, s[16:19], s48 offen offset:128 sc1
 v_mfma_f32_16x16x32_bf16 v[100:103], v[220:223], a[8:11], v[100:103]
 s_add_u32 s48, s48, 132096
 v_mfma_f32_16x16x32_bf16 v[140:143], v[220:223], a[12:15], v[140:143]
 s_waitcnt lgkmcnt(0) vmcnt(48)
 v_mfma_f32_16x16x32_bf16 v[64:67], v[144:147], a[16:19], v[64:67]
 ds_read_b64_tr_b16 v[184:185], v14 offset:30720
 ds_read_b64_tr_b16 v[186:187], v14 offset:32000
 v_mfma_f32_16x16x32_bf16 v[104:107], v[144:147], a[20:23], v[104:107]
 ds_read_b64_tr_b16 v[188:189], v15 offset:30752
 v_mfma_f32_16x16x32_bf16 v[68:71], v[148:151], a[16:19], v[68:71]
 ds_read_b64_tr_b16 v[190:191], v15 offset:32032
 v_mfma_f32_16x16x32_bf16 v[108:111], v[148:151], a[20:23], v[108:111]
 ds_read_b64_tr_b16 v[192:193], v14 offset:30784
 v_mfma_f32_16x16x32_bf16 v[72:75], v[152:155], a[16:19], v[72:75]
 ds_read_b64_tr_b16 v[194:195], v14 offset:32064
 v_mfma_f32_16x16x32_bf16 v[112:115], v[152:155], a[20:23], v[112:115]
 ds_read_b64_tr_b16 v[196:197], v15 offset:30816
 ds_read_b64_tr_b16 v[198:199], v15 offset:32096
 v_mfma_f32_16x16x32_bf16 v[76:79], v[156:159], a[16:19], v[76:79]
 ds_read_b64_tr_b16 v[200:201], v14 offset:30848
 v_mfma_f32_16x16x32_bf16 v[116:119], v[156:159], a[20:23], v[116:119]
 ds_read_b64_tr_b16 v[202:203], v14 offset:32128
 v_mfma_f32_16x16x32_bf16 v[80:83], v[160:163], a[16:19], v[80:83]
 ds_read_b64_tr_b16 v[204:205], v15 offset:30880
 v_mfma_f32_16x16x32_bf16 v[120:123], v[160:163], a[20:23], v[120:123]
 ds_read_b64_tr_b16 v[206:207], v15 offset:32160
 v_mfma_f32_16x16x32_bf16 v[84:87], v[164:167], a[16:19], v[84:87]
 ds_read_b64_tr_b16 v[208:209], v14 offset:30912
 v_mfma_f32_16x16x32_bf16 v[124:127], v[164:167], a[20:23], v[124:127]
 ds_read_b64_tr_b16 v[210:211], v14 offset:32192
 ds_read_b64_tr_b16 v[212:213], v15 offset:30944
 v_mfma_f32_16x16x32_bf16 v[88:91], v[168:171], a[16:19], v[88:91]
 ds_read_b64_tr_b16 v[214:215], v15 offset:32224
 v_mfma_f32_16x16x32_bf16 v[128:131], v[168:171], a[20:23], v[128:131]
 buffer_load_dwordx4 a[96:99], v6, s[16:19], s48 offen offset:0 sc1
 ds_read_b64_tr_b16 v[216:217], v14 offset:30976
 v_mfma_f32_16x16x32_bf16 v[92:95], v[172:175], a[16:19], v[92:95]
 ds_read_b64_tr_b16 v[218:219], v14 offset:32256
 v_mfma_f32_16x16x32_bf16 v[132:135], v[172:175], a[20:23], v[132:135]
 ds_read_b64_tr_b16 v[220:221], v15 offset:31008
 v_mfma_f32_16x16x32_bf16 v[96:99], v[176:179], a[16:19], v[96:99]
 ds_read_b64_tr_b16 v[222:223], v15 offset:32288
 v_mfma_f32_16x16x32_bf16 v[136:139], v[176:179], a[20:23], v[136:139]
 buffer_load_dwordx4 a[100:103], v6, s[16:19], s48 offen offset:128 sc1
 v_mfma_f32_16x16x32_bf16 v[100:103], v[180:183], a[16:19], v[100:103]
 s_add_u32 s48, s48, 132096
 v_mfma_f32_16x16x32_bf16 v[140:143], v[180:183], a[20:23], v[140:143]
 s_waitcnt lgkmcnt(0) vmcnt(43)
 s_barrier
 v_mfma_f32_16x16x32_bf16 v[64:67], v[184:187], a[24:27], v[64:67]
 s_add_u32 m0, s46, 20480
 ds_read_b64_tr_b16 v[144:145], v14 offset:40960
 ds_read_b64_tr_b16 v[146:147], v14 offset:42240
 v_mfma_f32_16x16x32_bf16 v[104:107], v[184:187], a[28:31], v[104:107]
 s_add_u32 s49, s45, 655360
 ds_read_b64_tr_b16 v[148:149], v15 offset:40992
 v_mfma_f32_16x16x32_bf16 v[68:71], v[188:191], a[24:27], v[68:71]
 buffer_load_dwordx4 v8, s[24:27], s49 offen lds
 ds_read_b64_tr_b16 v[150:151], v15 offset:42272
 v_mfma_f32_16x16x32_bf16 v[108:111], v[188:191], a[28:31], v[108:111]
 s_add_u32 m0, s46, 21504
 ds_read_b64_tr_b16 v[152:153], v14 offset:41024
 v_mfma_f32_16x16x32_bf16 v[72:75], v[192:195], a[24:27], v[72:75]
 buffer_load_dwordx4 v9, s[24:27], s49 offen lds
 ds_read_b64_tr_b16 v[154:155], v14 offset:42304
 v_mfma_f32_16x16x32_bf16 v[112:115], v[192:195], a[28:31], v[112:115]
 s_add_u32 m0, s46, 22528
 ds_read_b64_tr_b16 v[156:157], v15 offset:41056
 ds_read_b64_tr_b16 v[158:159], v15 offset:42336
 v_mfma_f32_16x16x32_bf16 v[76:79], v[196:199], a[24:27], v[76:79]
 buffer_load_dwordx4 v10, s[24:27], s49 offen lds
 ds_read_b64_tr_b16 v[160:161], v14 offset:41088
 v_mfma_f32_16x16x32_bf16 v[116:119], v[196:199], a[28:31], v[116:119]
 s_add_u32 m0, s46, 23552
 ds_read_b64_tr_b16 v[162:163], v14 offset:42368
 v_mfma_f32_16x16x32_bf16 v[80:83], v[200:203], a[24:27], v[80:83]
 buffer_load_dwordx4 v11, s[24:27], s49 offen lds
 ds_read_b64_tr_b16 v[164:165], v15 offset:41120
 v_mfma_f32_16x16x32_bf16 v[120:123], v[200:203], a[28:31], v[120:123]
 s_add_u32 m0, s46, 24576
 ds_read_b64_tr_b16 v[166:167], v15 offset:42400
 v_mfma_f32_16x16x32_bf16 v[84:87], v[204:207], a[24:27], v[84:87]
 buffer_load_dwordx4 v12, s[24:27], s49 offen lds
 ds_read_b64_tr_b16 v[168:169], v14 offset:41152
 v_mfma_f32_16x16x32_bf16 v[124:127], v[204:207], a[28:31], v[124:127]
 ds_read_b64_tr_b16 v[170:171], v14 offset:42432
 ds_read_b64_tr_b16 v[172:173], v15 offset:41184
 v_mfma_f32_16x16x32_bf16 v[88:91], v[208:211], a[24:27], v[88:91]
 ds_read_b64_tr_b16 v[174:175], v15 offset:42464
 v_mfma_f32_16x16x32_bf16 v[128:131], v[208:211], a[28:31], v[128:131]
 buffer_load_dwordx4 a[104:107], v6, s[16:19], s48 offen offset:0 sc1
 ds_read_b64_tr_b16 v[176:177], v14 offset:41216
 v_mfma_f32_16x16x32_bf16 v[92:95], v[212:215], a[24:27], v[92:95]
 ds_read_b64_tr_b16 v[178:179], v14 offset:42496
 v_mfma_f32_16x16x32_bf16 v[132:135], v[212:215], a[28:31], v[132:135]
 ds_read_b64_tr_b16 v[180:181], v15 offset:41248
 v_mfma_f32_16x16x32_bf16 v[96:99], v[216:219], a[24:27], v[96:99]
 ds_read_b64_tr_b16 v[182:183], v15 offset:42528
 v_mfma_f32_16x16x32_bf16 v[136:139], v[216:219], a[28:31], v[136:139]
 buffer_load_dwordx4 a[108:111], v6, s[16:19], s48 offen offset:128 sc1
 v_mfma_f32_16x16x32_bf16 v[100:103], v[220:223], a[24:27], v[100:103]
 s_add_u32 s48, s48, 132096
 v_mfma_f32_16x16x32_bf16 v[140:143], v[220:223], a[28:31], v[140:143]
 s_waitcnt lgkmcnt(0) vmcnt(48)
 v_mfma_f32_16x16x32_bf16 v[64:67], v[144:147], a[32:35], v[64:67]
 ds_read_b64_tr_b16 v[184:185], v14 offset:51200
 ds_read_b64_tr_b16 v[186:187], v14 offset:52480
 v_mfma_f32_16x16x32_bf16 v[104:107], v[144:147], a[36:39], v[104:107]
 ds_read_b64_tr_b16 v[188:189], v15 offset:51232
 v_mfma_f32_16x16x32_bf16 v[68:71], v[148:151], a[32:35], v[68:71]
 ds_read_b64_tr_b16 v[190:191], v15 offset:52512
 v_mfma_f32_16x16x32_bf16 v[108:111], v[148:151], a[36:39], v[108:111]
 ds_read_b64_tr_b16 v[192:193], v14 offset:51264
 v_mfma_f32_16x16x32_bf16 v[72:75], v[152:155], a[32:35], v[72:75]
 ds_read_b64_tr_b16 v[194:195], v14 offset:52544
 v_mfma_f32_16x16x32_bf16 v[112:115], v[152:155], a[36:39], v[112:115]
 ds_read_b64_tr_b16 v[196:197], v15 offset:51296
 ds_read_b64_tr_b16 v[198:199], v15 offset:52576
 v_mfma_f32_16x16x32_bf16 v[76:79], v[156:159], a[32:35], v[76:79]
 ds_read_b64_tr_b16 v[200:201], v14 offset:51328
 v_mfma_f32_16x16x32_bf16 v[116:119], v[156:159], a[36:39], v[116:119]
 ds_read_b64_tr_b16 v[202:203], v14 offset:52608
 v_mfma_f32_16x16x32_bf16 v[80:83], v[160:163], a[32:35], v[80:83]
 ds_read_b64_tr_b16 v[204:205], v15 offset:51360
 v_mfma_f32_16x16x32_bf16 v[120:123], v[160:163], a[36:39], v[120:123]
 ds_read_b64_tr_b16 v[206:207], v15 offset:52640
 v_mfma_f32_16x16x32_bf16 v[84:87], v[164:167], a[32:35], v[84:87]
 ds_read_b64_tr_b16 v[208:209], v14 offset:51392
 v_mfma_f32_16x16x32_bf16 v[124:127], v[164:167], a[36:39], v[124:127]
 ds_read_b64_tr_b16 v[210:211], v14 offset:52672
 ds_read_b64_tr_b16 v[212:213], v15 offset:51424
 v_mfma_f32_16x16x32_bf16 v[88:91], v[168:171], a[32:35], v[88:91]
 ds_read_b64_tr_b16 v[214:215], v15 offset:52704
 v_mfma_f32_16x16x32_bf16 v[128:131], v[168:171], a[36:39], v[128:131]
 buffer_load_dwordx4 a[112:115], v6, s[16:19], s48 offen offset:0 sc1
 ds_read_b64_tr_b16 v[216:217], v14 offset:51456
 v_mfma_f32_16x16x32_bf16 v[92:95], v[172:175], a[32:35], v[92:95]
 ds_read_b64_tr_b16 v[218:219], v14 offset:52736
 v_mfma_f32_16x16x32_bf16 v[132:135], v[172:175], a[36:39], v[132:135]
 ds_read_b64_tr_b16 v[220:221], v15 offset:51488
 v_mfma_f32_16x16x32_bf16 v[96:99], v[176:179], a[32:35], v[96:99]
 ds_read_b64_tr_b16 v[222:223], v15 offset:52768
 v_mfma_f32_16x16x32_bf16 v[136:139], v[176:179], a[36:39], v[136:139]
 buffer_load_dwordx4 a[116:119], v6, s[16:19], s48 offen offset:128 sc1
 v_mfma_f32_16x16x32_bf16 v[100:103], v[180:183], a[32:35], v[100:103]
 s_add_u32 s48, s48, 132096
 v_mfma_f32_16x16x32_bf16 v[140:143], v[180:183], a[36:39], v[140:143]
 s_waitcnt lgkmcnt(0) vmcnt(43)
 s_barrier
 v_mfma_f32_16x16x32_bf16 v[64:67], v[184:187], a[40:43], v[64:67]
 s_add_u32 m0, s46, 40960
 ds_read_b64_tr_b16 v[144:145], v16 offset:0
 ds_read_b64_tr_b16 v[146:147], v16 offset:1280
 v_mfma_f32_16x16x32_bf16 v[104:107], v[184:187], a[44:47], v[104:107]
 s_add_u32 s49, s45, 737280
 ds_read_b64_tr_b16 v[148:149], v17 offset:32
 v_mfma_f32_16x16x32_bf16 v[68:71], v[188:191], a[40:43], v[68:71]
 buffer_load_dwordx4 v8, s[24:27], s49 offen lds
 ds_read_b64_tr_b16 v[150:151], v17 offset:1312
 v_mfma_f32_16x16x32_bf16 v[108:111], v[188:191], a[44:47], v[108:111]
 s_add_u32 m0, s46, 41984
 ds_read_b64_tr_b16 v[152:153], v16 offset:64
 v_mfma_f32_16x16x32_bf16 v[72:75], v[192:195], a[40:43], v[72:75]
 buffer_load_dwordx4 v9, s[24:27], s49 offen lds
 ds_read_b64_tr_b16 v[154:155], v16 offset:1344
 v_mfma_f32_16x16x32_bf16 v[112:115], v[192:195], a[44:47], v[112:115]
 s_add_u32 m0, s46, 43008
 ds_read_b64_tr_b16 v[156:157], v17 offset:96
 ds_read_b64_tr_b16 v[158:159], v17 offset:1376
 v_mfma_f32_16x16x32_bf16 v[76:79], v[196:199], a[40:43], v[76:79]
 buffer_load_dwordx4 v10, s[24:27], s49 offen lds
 ds_read_b64_tr_b16 v[160:161], v16 offset:128
 v_mfma_f32_16x16x32_bf16 v[116:119], v[196:199], a[44:47], v[116:119]
 s_add_u32 m0, s46, 44032
 ds_read_b64_tr_b16 v[162:163], v16 offset:1408
 v_mfma_f32_16x16x32_bf16 v[80:83], v[200:203], a[40:43], v[80:83]
 buffer_load_dwordx4 v11, s[24:27], s49 offen lds
 ds_read_b64_tr_b16 v[164:165], v17 offset:160
 v_mfma_f32_16x16x32_bf16 v[120:123], v[200:203], a[44:47], v[120:123]
 s_add_u32 m0, s46, 45056
 ds_read_b64_tr_b16 v[166:167], v17 offset:1440
 v_mfma_f32_16x16x32_bf16 v[84:87], v[204:207], a[40:43], v[84:87]
 buffer_load_dwordx4 v12, s[24:27], s49 offen lds
 ds_read_b64_tr_b16 v[168:169], v16 offset:192
 v_mfma_f32_16x16x32_bf16 v[124:127], v[204:207], a[44:47], v[124:127]
 ds_read_b64_tr_b16 v[170:171], v16 offset:1472
 ds_read_b64_tr_b16 v[172:173], v17 offset:224
 v_mfma_f32_16x16x32_bf16 v[88:91], v[208:211], a[40:43], v[88:91]
 ds_read_b64_tr_b16 v[174:175], v17 offset:1504
 v_mfma_f32_16x16x32_bf16 v[128:131], v[208:211], a[44:47], v[128:131]
 buffer_load_dwordx4 a[120:123], v6, s[16:19], s48 offen offset:0 sc1
 ds_read_b64_tr_b16 v[176:177], v16 offset:256
 v_mfma_f32_16x16x32_bf16 v[92:95], v[212:215], a[40:43], v[92:95]
 ds_read_b64_tr_b16 v[178:179], v16 offset:1536
 v_mfma_f32_16x16x32_bf16 v[132:135], v[212:215], a[44:47], v[132:135]
 ds_read_b64_tr_b16 v[180:181], v17 offset:288
 v_mfma_f32_16x16x32_bf16 v[96:99], v[216:219], a[40:43], v[96:99]
 ds_read_b64_tr_b16 v[182:183], v17 offset:1568
 v_mfma_f32_16x16x32_bf16 v[136:139], v[216:219], a[44:47], v[136:139]
 buffer_load_dwordx4 a[124:127], v6, s[16:19], s48 offen offset:128 sc1
 v_mfma_f32_16x16x32_bf16 v[100:103], v[220:223], a[40:43], v[100:103]
 s_add_u32 s48, s48, 132096
 v_mfma_f32_16x16x32_bf16 v[140:143], v[220:223], a[44:47], v[140:143]
 s_waitcnt lgkmcnt(0) vmcnt(48)
 v_mfma_f32_16x16x32_bf16 v[64:67], v[144:147], a[48:51], v[64:67]
 ds_read_b64_tr_b16 v[184:185], v16 offset:10240
 ds_read_b64_tr_b16 v[186:187], v16 offset:11520
 v_mfma_f32_16x16x32_bf16 v[104:107], v[144:147], a[52:55], v[104:107]
 ds_read_b64_tr_b16 v[188:189], v17 offset:10272
 v_mfma_f32_16x16x32_bf16 v[68:71], v[148:151], a[48:51], v[68:71]
 ds_read_b64_tr_b16 v[190:191], v17 offset:11552
 v_mfma_f32_16x16x32_bf16 v[108:111], v[148:151], a[52:55], v[108:111]
 ds_read_b64_tr_b16 v[192:193], v16 offset:10304
 v_mfma_f32_16x16x32_bf16 v[72:75], v[152:155], a[48:51], v[72:75]
 ds_read_b64_tr_b16 v[194:195], v16 offset:11584
 v_mfma_f32_16x16x32_bf16 v[112:115], v[152:155], a[52:55], v[112:115]
 ds_read_b64_tr_b16 v[196:197], v17 offset:10336
 ds_read_b64_tr_b16 v[198:199], v17 offset:11616
 v_mfma_f32_16x16x32_bf16 v[76:79], v[156:159], a[48:51], v[76:79]
 ds_read_b64_tr_b16 v[200:201], v16 offset:10368
 v_mfma_f32_16x16x32_bf16 v[116:119], v[156:159], a[52:55], v[116:119]
 ds_read_b64_tr_b16 v[202:203], v16 offset:11648
 v_mfma_f32_16x16x32_bf16 v[80:83], v[160:163], a[48:51], v[80:83]
 ds_read_b64_tr_b16 v[204:205], v17 offset:10400
 v_mfma_f32_16x16x32_bf16 v[120:123], v[160:163], a[52:55], v[120:123]
 ds_read_b64_tr_b16 v[206:207], v17 offset:11680
 v_mfma_f32_16x16x32_bf16 v[84:87], v[164:167], a[48:51], v[84:87]
 ds_read_b64_tr_b16 v[208:209], v16 offset:10432
 v_mfma_f32_16x16x32_bf16 v[124:127], v[164:167], a[52:55], v[124:127]
 ds_read_b64_tr_b16 v[210:211], v16 offset:11712
 ds_read_b64_tr_b16 v[212:213], v17 offset:10464
 v_mfma_f32_16x16x32_bf16 v[88:91], v[168:171], a[48:51], v[88:91]
 ds_read_b64_tr_b16 v[214:215], v17 offset:11744
 v_mfma_f32_16x16x32_bf16 v[128:131], v[168:171], a[52:55], v[128:131]
 buffer_load_dwordx4 a[128:131], v6, s[16:19], s48 offen offset:0 sc1
 ds_read_b64_tr_b16 v[216:217], v16 offset:10496
 v_mfma_f32_16x16x32_bf16 v[92:95], v[172:175], a[48:51], v[92:95]
 ds_read_b64_tr_b16 v[218:219], v16 offset:11776
 v_mfma_f32_16x16x32_bf16 v[132:135], v[172:175], a[52:55], v[132:135]
 ds_read_b64_tr_b16 v[220:221], v17 offset:10528
 v_mfma_f32_16x16x32_bf16 v[96:99], v[176:179], a[48:51], v[96:99]
 ds_read_b64_tr_b16 v[222:223], v17 offset:11808
 v_mfma_f32_16x16x32_bf16 v[136:139], v[176:179], a[52:55], v[136:139]
 buffer_load_dwordx4 a[132:135], v6, s[16:19], s48 offen offset:128 sc1
 v_mfma_f32_16x16x32_bf16 v[100:103], v[180:183], a[48:51], v[100:103]
 s_add_u32 s48, s48, 132096
 v_mfma_f32_16x16x32_bf16 v[140:143], v[180:183], a[52:55], v[140:143]
 s_waitcnt lgkmcnt(0) vmcnt(43)
 s_barrier
 v_mfma_f32_16x16x32_bf16 v[64:67], v[184:187], a[56:59], v[64:67]
 ds_read_b64_tr_b16 v[144:145], v16 offset:20480
 ds_read_b64_tr_b16 v[146:147], v16 offset:21760
 v_mfma_f32_16x16x32_bf16 v[104:107], v[184:187], a[60:63], v[104:107]
 ds_read_b64_tr_b16 v[148:149], v17 offset:20512
 v_mfma_f32_16x16x32_bf16 v[68:71], v[188:191], a[56:59], v[68:71]
 ds_read_b64_tr_b16 v[150:151], v17 offset:21792
 v_mfma_f32_16x16x32_bf16 v[108:111], v[188:191], a[60:63], v[108:111]
 ds_read_b64_tr_b16 v[152:153], v16 offset:20544
 v_mfma_f32_16x16x32_bf16 v[72:75], v[192:195], a[56:59], v[72:75]
 ds_read_b64_tr_b16 v[154:155], v16 offset:21824
 v_mfma_f32_16x16x32_bf16 v[112:115], v[192:195], a[60:63], v[112:115]
 ds_read_b64_tr_b16 v[156:157], v17 offset:20576
 ds_read_b64_tr_b16 v[158:159], v17 offset:21856
 v_mfma_f32_16x16x32_bf16 v[76:79], v[196:199], a[56:59], v[76:79]
 ds_read_b64_tr_b16 v[160:161], v16 offset:20608
 v_mfma_f32_16x16x32_bf16 v[116:119], v[196:199], a[60:63], v[116:119]
 ds_read_b64_tr_b16 v[162:163], v16 offset:21888
 v_mfma_f32_16x16x32_bf16 v[80:83], v[200:203], a[56:59], v[80:83]
 ds_read_b64_tr_b16 v[164:165], v17 offset:20640
 v_mfma_f32_16x16x32_bf16 v[120:123], v[200:203], a[60:63], v[120:123]
 ds_read_b64_tr_b16 v[166:167], v17 offset:21920
 v_mfma_f32_16x16x32_bf16 v[84:87], v[204:207], a[56:59], v[84:87]
 ds_read_b64_tr_b16 v[168:169], v16 offset:20672
 v_mfma_f32_16x16x32_bf16 v[124:127], v[204:207], a[60:63], v[124:127]
 ds_read_b64_tr_b16 v[170:171], v16 offset:21952
 ds_read_b64_tr_b16 v[172:173], v17 offset:20704
 v_mfma_f32_16x16x32_bf16 v[88:91], v[208:211], a[56:59], v[88:91]
 ds_read_b64_tr_b16 v[174:175], v17 offset:21984
 v_mfma_f32_16x16x32_bf16 v[128:131], v[208:211], a[60:63], v[128:131]
 buffer_load_dwordx4 a[136:139], v6, s[16:19], s48 offen offset:0 sc1
 ds_read_b64_tr_b16 v[176:177], v16 offset:20736
 v_mfma_f32_16x16x32_bf16 v[92:95], v[212:215], a[56:59], v[92:95]
 ds_read_b64_tr_b16 v[178:179], v16 offset:22016
 v_mfma_f32_16x16x32_bf16 v[132:135], v[212:215], a[60:63], v[132:135]
 ds_read_b64_tr_b16 v[180:181], v17 offset:20768
 v_mfma_f32_16x16x32_bf16 v[96:99], v[216:219], a[56:59], v[96:99]
 ds_read_b64_tr_b16 v[182:183], v17 offset:22048
 v_mfma_f32_16x16x32_bf16 v[136:139], v[216:219], a[60:63], v[136:139]
 buffer_load_dwordx4 a[140:143], v6, s[16:19], s48 offen offset:128 sc1
 v_mfma_f32_16x16x32_bf16 v[100:103], v[220:223], a[56:59], v[100:103]
 s_add_u32 s48, s48, 132096
 v_mfma_f32_16x16x32_bf16 v[140:143], v[220:223], a[60:63], v[140:143]
 s_waitcnt lgkmcnt(0) vmcnt(43)
 v_mfma_f32_16x16x32_bf16 v[64:67], v[144:147], a[64:67], v[64:67]
 ds_read_b64_tr_b16 v[184:185], v16 offset:30720
 ds_read_b64_tr_b16 v[186:187], v16 offset:32000
 v_mfma_f32_16x16x32_bf16 v[104:107], v[144:147], a[68:71], v[104:107]
 ds_read_b64_tr_b16 v[188:189], v17 offset:30752
 v_mfma_f32_16x16x32_bf16 v[68:71], v[148:151], a[64:67], v[68:71]
 ds_read_b64_tr_b16 v[190:191], v17 offset:32032
 v_mfma_f32_16x16x32_bf16 v[108:111], v[148:151], a[68:71], v[108:111]
 ds_read_b64_tr_b16 v[192:193], v16 offset:30784
 v_mfma_f32_16x16x32_bf16 v[72:75], v[152:155], a[64:67], v[72:75]
 ds_read_b64_tr_b16 v[194:195], v16 offset:32064
 v_mfma_f32_16x16x32_bf16 v[112:115], v[152:155], a[68:71], v[112:115]
 ds_read_b64_tr_b16 v[196:197], v17 offset:30816
 ds_read_b64_tr_b16 v[198:199], v17 offset:32096
 v_mfma_f32_16x16x32_bf16 v[76:79], v[156:159], a[64:67], v[76:79]
 ds_read_b64_tr_b16 v[200:201], v16 offset:30848
 v_mfma_f32_16x16x32_bf16 v[116:119], v[156:159], a[68:71], v[116:119]
 ds_read_b64_tr_b16 v[202:203], v16 offset:32128
 v_mfma_f32_16x16x32_bf16 v[80:83], v[160:163], a[64:67], v[80:83]
 ds_read_b64_tr_b16 v[204:205], v17 offset:30880
 v_mfma_f32_16x16x32_bf16 v[120:123], v[160:163], a[68:71], v[120:123]
 ds_read_b64_tr_b16 v[206:207], v17 offset:32160
 v_mfma_f32_16x16x32_bf16 v[84:87], v[164:167], a[64:67], v[84:87]
 ds_read_b64_tr_b16 v[208:209], v16 offset:30912
 v_mfma_f32_16x16x32_bf16 v[124:127], v[164:167], a[68:71], v[124:127]
 ds_read_b64_tr_b16 v[210:211], v16 offset:32192
 ds_read_b64_tr_b16 v[212:213], v17 offset:30944
 v_mfma_f32_16x16x32_bf16 v[88:91], v[168:171], a[64:67], v[88:91]
 ds_read_b64_tr_b16 v[214:215], v17 offset:32224
 v_mfma_f32_16x16x32_bf16 v[128:131], v[168:171], a[68:71], v[128:131]
 buffer_load_dwordx4 a[144:147], v6, s[16:19], s48 offen offset:0 sc1
 ds_read_b64_tr_b16 v[216:217], v16 offset:30976
 v_mfma_f32_16x16x32_bf16 v[92:95], v[172:175], a[64:67], v[92:95]
 ds_read_b64_tr_b16 v[218:219], v16 offset:32256
 v_mfma_f32_16x16x32_bf16 v[132:135], v[172:175], a[68:71], v[132:135]
 ds_read_b64_tr_b16 v[220:221], v17 offset:31008
 v_mfma_f32_16x16x32_bf16 v[96:99], v[176:179], a[64:67], v[96:99]
 ds_read_b64_tr_b16 v[222:223], v17 offset:32288
 v_mfma_f32_16x16x32_bf16 v[136:139], v[176:179], a[68:71], v[136:139]
 buffer_load_dwordx4 a[148:151], v6, s[16:19], s48 offen offset:128 sc1
 v_mfma_f32_16x16x32_bf16 v[100:103], v[180:183], a[64:67], v[100:103]
 s_add_u32 s48, s48, 132096
 v_mfma_f32_16x16x32_bf16 v[140:143], v[180:183], a[68:71], v[140:143]
 s_waitcnt lgkmcnt(0) vmcnt(38)
 s_barrier
 v_mfma_f32_16x16x32_bf16 v[64:67], v[184:187], a[72:75], v[64:67]
 ds_read_b64_tr_b16 v[144:145], v16 offset:40960
 ds_read_b64_tr_b16 v[146:147], v16 offset:42240
 v_mfma_f32_16x16x32_bf16 v[104:107], v[184:187], a[76:79], v[104:107]
 ds_read_b64_tr_b16 v[148:149], v17 offset:40992
 v_mfma_f32_16x16x32_bf16 v[68:71], v[188:191], a[72:75], v[68:71]
 ds_read_b64_tr_b16 v[150:151], v17 offset:42272
 v_mfma_f32_16x16x32_bf16 v[108:111], v[188:191], a[76:79], v[108:111]
 ds_read_b64_tr_b16 v[152:153], v16 offset:41024
 v_mfma_f32_16x16x32_bf16 v[72:75], v[192:195], a[72:75], v[72:75]
 ds_read_b64_tr_b16 v[154:155], v16 offset:42304
 v_mfma_f32_16x16x32_bf16 v[112:115], v[192:195], a[76:79], v[112:115]
 ds_read_b64_tr_b16 v[156:157], v17 offset:41056
 ds_read_b64_tr_b16 v[158:159], v17 offset:42336
 v_mfma_f32_16x16x32_bf16 v[76:79], v[196:199], a[72:75], v[76:79]
 ds_read_b64_tr_b16 v[160:161], v16 offset:41088
 v_mfma_f32_16x16x32_bf16 v[116:119], v[196:199], a[76:79], v[116:119]
 ds_read_b64_tr_b16 v[162:163], v16 offset:42368
 v_mfma_f32_16x16x32_bf16 v[80:83], v[200:203], a[72:75], v[80:83]
 ds_read_b64_tr_b16 v[164:165], v17 offset:41120
 v_mfma_f32_16x16x32_bf16 v[120:123], v[200:203], a[76:79], v[120:123]
 ds_read_b64_tr_b16 v[166:167], v17 offset:42400
 v_mfma_f32_16x16x32_bf16 v[84:87], v[204:207], a[72:75], v[84:87]
 ds_read_b64_tr_b16 v[168:169], v16 offset:41152
 v_mfma_f32_16x16x32_bf16 v[124:127], v[204:207], a[76:79], v[124:127]
 ds_read_b64_tr_b16 v[170:171], v16 offset:42432
 ds_read_b64_tr_b16 v[172:173], v17 offset:41184
 v_mfma_f32_16x16x32_bf16 v[88:91], v[208:211], a[72:75], v[88:91]
 ds_read_b64_tr_b16 v[174:175], v17 offset:42464
 v_mfma_f32_16x16x32_bf16 v[128:131], v[208:211], a[76:79], v[128:131]
 buffer_load_dwordx4 a[152:155], v6, s[16:19], s48 offen offset:0 sc1
 ds_read_b64_tr_b16 v[176:177], v16 offset:41216
 v_mfma_f32_16x16x32_bf16 v[92:95], v[212:215], a[72:75], v[92:95]
 ds_read_b64_tr_b16 v[178:179], v16 offset:42496
 v_mfma_f32_16x16x32_bf16 v[132:135], v[212:215], a[76:79], v[132:135]
 ds_read_b64_tr_b16 v[180:181], v17 offset:41248
 v_mfma_f32_16x16x32_bf16 v[96:99], v[216:219], a[72:75], v[96:99]
 ds_read_b64_tr_b16 v[182:183], v17 offset:42528
 v_mfma_f32_16x16x32_bf16 v[136:139], v[216:219], a[76:79], v[136:139]
 buffer_load_dwordx4 a[156:159], v6, s[16:19], s48 offen offset:128 sc1
 v_mfma_f32_16x16x32_bf16 v[100:103], v[220:223], a[72:75], v[100:103]
 s_add_u32 s48, s48, 132096
 v_mfma_f32_16x16x32_bf16 v[140:143], v[220:223], a[76:79], v[140:143]
 s_waitcnt lgkmcnt(0) vmcnt(33)
 v_mfma_f32_16x16x32_bf16 v[64:67], v[144:147], a[80:83], v[64:67]
 ds_read_b64_tr_b16 v[184:185], v16 offset:51200
 ds_read_b64_tr_b16 v[186:187], v16 offset:52480
 v_mfma_f32_16x16x32_bf16 v[104:107], v[144:147], a[84:87], v[104:107]
 ds_read_b64_tr_b16 v[188:189], v17 offset:51232
 v_mfma_f32_16x16x32_bf16 v[68:71], v[148:151], a[80:83], v[68:71]
 ds_read_b64_tr_b16 v[190:191], v17 offset:52512
 v_mfma_f32_16x16x32_bf16 v[108:111], v[148:151], a[84:87], v[108:111]
 ds_read_b64_tr_b16 v[192:193], v16 offset:51264
 v_mfma_f32_16x16x32_bf16 v[72:75], v[152:155], a[80:83], v[72:75]
 ds_read_b64_tr_b16 v[194:195], v16 offset:52544
 v_mfma_f32_16x16x32_bf16 v[112:115], v[152:155], a[84:87], v[112:115]
 ds_read_b64_tr_b16 v[196:197], v17 offset:51296
 ds_read_b64_tr_b16 v[198:199], v17 offset:52576
 v_mfma_f32_16x16x32_bf16 v[76:79], v[156:159], a[80:83], v[76:79]
 ds_read_b64_tr_b16 v[200:201], v16 offset:51328
 v_mfma_f32_16x16x32_bf16 v[116:119], v[156:159], a[84:87], v[116:119]
 ds_read_b64_tr_b16 v[202:203], v16 offset:52608
 v_mfma_f32_16x16x32_bf16 v[80:83], v[160:163], a[80:83], v[80:83]
 ds_read_b64_tr_b16 v[204:205], v17 offset:51360
 v_mfma_f32_16x16x32_bf16 v[120:123], v[160:163], a[84:87], v[120:123]
 ds_read_b64_tr_b16 v[206:207], v17 offset:52640
 v_mfma_f32_16x16x32_bf16 v[84:87], v[164:167], a[80:83], v[84:87]
 ds_read_b64_tr_b16 v[208:209], v16 offset:51392
 v_mfma_f32_16x16x32_bf16 v[124:127], v[164:167], a[84:87], v[124:127]
 ds_read_b64_tr_b16 v[210:211], v16 offset:52672
 ds_read_b64_tr_b16 v[212:213], v17 offset:51424
 v_mfma_f32_16x16x32_bf16 v[88:91], v[168:171], a[80:83], v[88:91]
 ds_read_b64_tr_b16 v[214:215], v17 offset:52704
 v_mfma_f32_16x16x32_bf16 v[128:131], v[168:171], a[84:87], v[128:131]
 ds_read_b64_tr_b16 v[216:217], v16 offset:51456
 v_mfma_f32_16x16x32_bf16 v[92:95], v[172:175], a[80:83], v[92:95]
 ds_read_b64_tr_b16 v[218:219], v16 offset:52736
 v_mfma_f32_16x16x32_bf16 v[132:135], v[172:175], a[84:87], v[132:135]
 ds_read_b64_tr_b16 v[220:221], v17 offset:51488
 v_mfma_f32_16x16x32_bf16 v[96:99], v[176:179], a[80:83], v[96:99]
 ds_read_b64_tr_b16 v[222:223], v17 offset:52768
 v_mfma_f32_16x16x32_bf16 v[136:139], v[176:179], a[84:87], v[136:139]
 v_mfma_f32_16x16x32_bf16 v[100:103], v[180:183], a[80:83], v[100:103]
 v_mfma_f32_16x16x32_bf16 v[140:143], v[180:183], a[84:87], v[140:143]
 s_waitcnt lgkmcnt(0) vmcnt(26)
 s_barrier
 v_mfma_f32_16x16x32_bf16 v[64:67], v[184:187], a[88:91], v[64:67]
 ds_read_b64_tr_b16 v[144:145], v18 offset:0
 ds_read_b64_tr_b16 v[146:147], v18 offset:1280
 v_mfma_f32_16x16x32_bf16 v[104:107], v[184:187], a[92:95], v[104:107]
 ds_read_b64_tr_b16 v[148:149], v19 offset:32
 v_mfma_f32_16x16x32_bf16 v[68:71], v[188:191], a[88:91], v[68:71]
 ds_read_b64_tr_b16 v[150:151], v19 offset:1312
 v_mfma_f32_16x16x32_bf16 v[108:111], v[188:191], a[92:95], v[108:111]
 ds_read_b64_tr_b16 v[152:153], v18 offset:64
 v_mfma_f32_16x16x32_bf16 v[72:75], v[192:195], a[88:91], v[72:75]
 ds_read_b64_tr_b16 v[154:155], v18 offset:1344
 v_mfma_f32_16x16x32_bf16 v[112:115], v[192:195], a[92:95], v[112:115]
 ds_read_b64_tr_b16 v[156:157], v19 offset:96
 ds_read_b64_tr_b16 v[158:159], v19 offset:1376
 v_mfma_f32_16x16x32_bf16 v[76:79], v[196:199], a[88:91], v[76:79]
 ds_read_b64_tr_b16 v[160:161], v18 offset:128
 v_mfma_f32_16x16x32_bf16 v[116:119], v[196:199], a[92:95], v[116:119]
 ds_read_b64_tr_b16 v[162:163], v18 offset:1408
 v_mfma_f32_16x16x32_bf16 v[80:83], v[200:203], a[88:91], v[80:83]
 ds_read_b64_tr_b16 v[164:165], v19 offset:160
 v_mfma_f32_16x16x32_bf16 v[120:123], v[200:203], a[92:95], v[120:123]
 ds_read_b64_tr_b16 v[166:167], v19 offset:1440
 v_mfma_f32_16x16x32_bf16 v[84:87], v[204:207], a[88:91], v[84:87]
 ds_read_b64_tr_b16 v[168:169], v18 offset:192
 v_mfma_f32_16x16x32_bf16 v[124:127], v[204:207], a[92:95], v[124:127]
 ds_read_b64_tr_b16 v[170:171], v18 offset:1472
 ds_read_b64_tr_b16 v[172:173], v19 offset:224
 v_mfma_f32_16x16x32_bf16 v[88:91], v[208:211], a[88:91], v[88:91]
 ds_read_b64_tr_b16 v[174:175], v19 offset:1504
 v_mfma_f32_16x16x32_bf16 v[128:131], v[208:211], a[92:95], v[128:131]
 ds_read_b64_tr_b16 v[176:177], v18 offset:256
 v_mfma_f32_16x16x32_bf16 v[92:95], v[212:215], a[88:91], v[92:95]
 ds_read_b64_tr_b16 v[178:179], v18 offset:1536
 v_mfma_f32_16x16x32_bf16 v[132:135], v[212:215], a[92:95], v[132:135]
 ds_read_b64_tr_b16 v[180:181], v19 offset:288
 v_mfma_f32_16x16x32_bf16 v[96:99], v[216:219], a[88:91], v[96:99]
 ds_read_b64_tr_b16 v[182:183], v19 offset:1568
 v_mfma_f32_16x16x32_bf16 v[136:139], v[216:219], a[92:95], v[136:139]
 v_mfma_f32_16x16x32_bf16 v[100:103], v[220:223], a[88:91], v[100:103]
 v_mfma_f32_16x16x32_bf16 v[140:143], v[220:223], a[92:95], v[140:143]
 s_waitcnt lgkmcnt(0) vmcnt(24)
 v_mfma_f32_16x16x32_bf16 v[64:67], v[144:147], a[96:99], v[64:67]
 ds_read_b64_tr_b16 v[184:185], v18 offset:10240
 ds_read_b64_tr_b16 v[186:187], v18 offset:11520
 v_mfma_f32_16x16x32_bf16 v[104:107], v[144:147], a[100:103], v[104:107]
 ds_read_b64_tr_b16 v[188:189], v19 offset:10272
 v_mfma_f32_16x16x32_bf16 v[68:71], v[148:151], a[96:99], v[68:71]
 ds_read_b64_tr_b16 v[190:191], v19 offset:11552
 v_mfma_f32_16x16x32_bf16 v[108:111], v[148:151], a[100:103], v[108:111]
 ds_read_b64_tr_b16 v[192:193], v18 offset:10304
 v_mfma_f32_16x16x32_bf16 v[72:75], v[152:155], a[96:99], v[72:75]
 ds_read_b64_tr_b16 v[194:195], v18 offset:11584
 v_mfma_f32_16x16x32_bf16 v[112:115], v[152:155], a[100:103], v[112:115]
 ds_read_b64_tr_b16 v[196:197], v19 offset:10336
 ds_read_b64_tr_b16 v[198:199], v19 offset:11616
 v_mfma_f32_16x16x32_bf16 v[76:79], v[156:159], a[96:99], v[76:79]
 ds_read_b64_tr_b16 v[200:201], v18 offset:10368
 v_mfma_f32_16x16x32_bf16 v[116:119], v[156:159], a[100:103], v[116:119]
 ds_read_b64_tr_b16 v[202:203], v18 offset:11648
 v_mfma_f32_16x16x32_bf16 v[80:83], v[160:163], a[96:99], v[80:83]
 ds_read_b64_tr_b16 v[204:205], v19 offset:10400
 v_mfma_f32_16x16x32_bf16 v[120:123], v[160:163], a[100:103], v[120:123]
 ds_read_b64_tr_b16 v[206:207], v19 offset:11680
 v_mfma_f32_16x16x32_bf16 v[84:87], v[164:167], a[96:99], v[84:87]
 ds_read_b64_tr_b16 v[208:209], v18 offset:10432
 v_mfma_f32_16x16x32_bf16 v[124:127], v[164:167], a[100:103], v[124:127]
 ds_read_b64_tr_b16 v[210:211], v18 offset:11712
 ds_read_b64_tr_b16 v[212:213], v19 offset:10464
 v_mfma_f32_16x16x32_bf16 v[88:91], v[168:171], a[96:99], v[88:91]
 ds_read_b64_tr_b16 v[214:215], v19 offset:11744
 v_mfma_f32_16x16x32_bf16 v[128:131], v[168:171], a[100:103], v[128:131]
 ds_read_b64_tr_b16 v[216:217], v18 offset:10496
 v_mfma_f32_16x16x32_bf16 v[92:95], v[172:175], a[96:99], v[92:95]
 ds_read_b64_tr_b16 v[218:219], v18 offset:11776
 v_mfma_f32_16x16x32_bf16 v[132:135], v[172:175], a[100:103], v[132:135]
 ds_read_b64_tr_b16 v[220:221], v19 offset:10528
 v_mfma_f32_16x16x32_bf16 v[96:99], v[176:179], a[96:99], v[96:99]
 ds_read_b64_tr_b16 v[222:223], v19 offset:11808
 v_mfma_f32_16x16x32_bf16 v[136:139], v[176:179], a[100:103], v[136:139]
 v_mfma_f32_16x16x32_bf16 v[100:103], v[180:183], a[96:99], v[100:103]
 v_mfma_f32_16x16x32_bf16 v[140:143], v[180:183], a[100:103], v[140:143]
 s_waitcnt lgkmcnt(0) vmcnt(17)
 s_barrier
 v_mfma_f32_16x16x32_bf16 v[64:67], v[184:187], a[104:107], v[64:67]
 ds_read_b64_tr_b16 v[144:145], v14 offset:0
 ds_read_b64_tr_b16 v[146:147], v14 offset:1280
 v_mfma_f32_16x16x32_bf16 v[104:107], v[184:187], a[108:111], v[104:107]
 ds_read_b64_tr_b16 v[148:149], v15 offset:32
 v_mfma_f32_16x16x32_bf16 v[68:71], v[188:191], a[104:107], v[68:71]
 ds_read_b64_tr_b16 v[150:151], v15 offset:1312
 v_mfma_f32_16x16x32_bf16 v[108:111], v[188:191], a[108:111], v[108:111]
 ds_read_b64_tr_b16 v[152:153], v14 offset:64
 v_mfma_f32_16x16x32_bf16 v[72:75], v[192:195], a[104:107], v[72:75]
 ds_read_b64_tr_b16 v[154:155], v14 offset:1344
 v_mfma_f32_16x16x32_bf16 v[112:115], v[192:195], a[108:111], v[112:115]
 ds_read_b64_tr_b16 v[156:157], v15 offset:96
 ds_read_b64_tr_b16 v[158:159], v15 offset:1376
 v_mfma_f32_16x16x32_bf16 v[76:79], v[196:199], a[104:107], v[76:79]
 ds_read_b64_tr_b16 v[160:161], v14 offset:128
 v_mfma_f32_16x16x32_bf16 v[116:119], v[196:199], a[108:111], v[116:119]
 ds_read_b64_tr_b16 v[162:163], v14 offset:1408
 v_mfma_f32_16x16x32_bf16 v[80:83], v[200:203], a[104:107], v[80:83]
 ds_read_b64_tr_b16 v[164:165], v15 offset:160
 v_mfma_f32_16x16x32_bf16 v[120:123], v[200:203], a[108:111], v[120:123]
 ds_read_b64_tr_b16 v[166:167], v15 offset:1440
 v_mfma_f32_16x16x32_bf16 v[84:87], v[204:207], a[104:107], v[84:87]
 ds_read_b64_tr_b16 v[168:169], v14 offset:192
 v_mfma_f32_16x16x32_bf16 v[124:127], v[204:207], a[108:111], v[124:127]
 ds_read_b64_tr_b16 v[170:171], v14 offset:1472
 ds_read_b64_tr_b16 v[172:173], v15 offset:224
 v_mfma_f32_16x16x32_bf16 v[88:91], v[208:211], a[104:107], v[88:91]
 ds_read_b64_tr_b16 v[174:175], v15 offset:1504
 v_mfma_f32_16x16x32_bf16 v[128:131], v[208:211], a[108:111], v[128:131]
 ds_read_b64_tr_b16 v[176:177], v14 offset:256
 v_mfma_f32_16x16x32_bf16 v[92:95], v[212:215], a[104:107], v[92:95]
 ds_read_b64_tr_b16 v[178:179], v14 offset:1536
 v_mfma_f32_16x16x32_bf16 v[132:135], v[212:215], a[108:111], v[132:135]
 ds_read_b64_tr_b16 v[180:181], v15 offset:288
 v_mfma_f32_16x16x32_bf16 v[96:99], v[216:219], a[104:107], v[96:99]
 ds_read_b64_tr_b16 v[182:183], v15 offset:1568
 v_mfma_f32_16x16x32_bf16 v[136:139], v[216:219], a[108:111], v[136:139]
 v_mfma_f32_16x16x32_bf16 v[100:103], v[220:223], a[104:107], v[100:103]
 v_mfma_f32_16x16x32_bf16 v[140:143], v[220:223], a[108:111], v[140:143]
 s_waitcnt lgkmcnt(0) vmcnt(15)
 v_mfma_f32_16x16x32_bf16 v[64:67], v[144:147], a[112:115], v[64:67]
 ds_read_b64_tr_b16 v[184:185], v14 offset:10240
 ds_read_b64_tr_b16 v[186:187], v14 offset:11520
 v_mfma_f32_16x16x32_bf16 v[104:107], v[144:147], a[116:119], v[104:107]
 ds_read_b64_tr_b16 v[188:189], v15 offset:10272
 v_mfma_f32_16x16x32_bf16 v[68:71], v[148:151], a[112:115], v[68:71]
 ds_read_b64_tr_b16 v[190:191], v15 offset:11552
 v_mfma_f32_16x16x32_bf16 v[108:111], v[148:151], a[116:119], v[108:111]
 ds_read_b64_tr_b16 v[192:193], v14 offset:10304
 v_mfma_f32_16x16x32_bf16 v[72:75], v[152:155], a[112:115], v[72:75]
 ds_read_b64_tr_b16 v[194:195], v14 offset:11584
 v_mfma_f32_16x16x32_bf16 v[112:115], v[152:155], a[116:119], v[112:115]
 ds_read_b64_tr_b16 v[196:197], v15 offset:10336
 ds_read_b64_tr_b16 v[198:199], v15 offset:11616
 v_mfma_f32_16x16x32_bf16 v[76:79], v[156:159], a[112:115], v[76:79]
 ds_read_b64_tr_b16 v[200:201], v14 offset:10368
 v_mfma_f32_16x16x32_bf16 v[116:119], v[156:159], a[116:119], v[116:119]
 ds_read_b64_tr_b16 v[202:203], v14 offset:11648
 v_mfma_f32_16x16x32_bf16 v[80:83], v[160:163], a[112:115], v[80:83]
 ds_read_b64_tr_b16 v[204:205], v15 offset:10400
 v_mfma_f32_16x16x32_bf16 v[120:123], v[160:163], a[116:119], v[120:123]
 ds_read_b64_tr_b16 v[206:207], v15 offset:11680
 v_mfma_f32_16x16x32_bf16 v[84:87], v[164:167], a[112:115], v[84:87]
 ds_read_b64_tr_b16 v[208:209], v14 offset:10432
 v_mfma_f32_16x16x32_bf16 v[124:127], v[164:167], a[116:119], v[124:127]
 ds_read_b64_tr_b16 v[210:211], v14 offset:11712
 ds_read_b64_tr_b16 v[212:213], v15 offset:10464
 v_mfma_f32_16x16x32_bf16 v[88:91], v[168:171], a[112:115], v[88:91]
 ds_read_b64_tr_b16 v[214:215], v15 offset:11744
 v_mfma_f32_16x16x32_bf16 v[128:131], v[168:171], a[116:119], v[128:131]
 ds_read_b64_tr_b16 v[216:217], v14 offset:10496
 v_mfma_f32_16x16x32_bf16 v[92:95], v[172:175], a[112:115], v[92:95]
 ds_read_b64_tr_b16 v[218:219], v14 offset:11776
 v_mfma_f32_16x16x32_bf16 v[132:135], v[172:175], a[116:119], v[132:135]
 ds_read_b64_tr_b16 v[220:221], v15 offset:10528
 v_mfma_f32_16x16x32_bf16 v[96:99], v[176:179], a[112:115], v[96:99]
 ds_read_b64_tr_b16 v[222:223], v15 offset:11808
 v_mfma_f32_16x16x32_bf16 v[136:139], v[176:179], a[116:119], v[136:139]
 v_mfma_f32_16x16x32_bf16 v[100:103], v[180:183], a[112:115], v[100:103]
 v_mfma_f32_16x16x32_bf16 v[140:143], v[180:183], a[116:119], v[140:143]
 s_waitcnt lgkmcnt(0) vmcnt(8)
 s_barrier
 v_mfma_f32_16x16x32_bf16 v[64:67], v[184:187], a[120:123], v[64:67]
 ds_read_b64_tr_b16 v[144:145], v14 offset:20480
 ds_read_b64_tr_b16 v[146:147], v14 offset:21760
 v_mfma_f32_16x16x32_bf16 v[104:107], v[184:187], a[124:127], v[104:107]
 ds_read_b64_tr_b16 v[148:149], v15 offset:20512
 v_mfma_f32_16x16x32_bf16 v[68:71], v[188:191], a[120:123], v[68:71]
 ds_read_b64_tr_b16 v[150:151], v15 offset:21792
 v_mfma_f32_16x16x32_bf16 v[108:111], v[188:191], a[124:127], v[108:111]
 ds_read_b64_tr_b16 v[152:153], v14 offset:20544
 v_mfma_f32_16x16x32_bf16 v[72:75], v[192:195], a[120:123], v[72:75]
 ds_read_b64_tr_b16 v[154:155], v14 offset:21824
 v_mfma_f32_16x16x32_bf16 v[112:115], v[192:195], a[124:127], v[112:115]
 ds_read_b64_tr_b16 v[156:157], v15 offset:20576
 ds_read_b64_tr_b16 v[158:159], v15 offset:21856
 v_mfma_f32_16x16x32_bf16 v[76:79], v[196:199], a[120:123], v[76:79]
 ds_read_b64_tr_b16 v[160:161], v14 offset:20608
 v_mfma_f32_16x16x32_bf16 v[116:119], v[196:199], a[124:127], v[116:119]
 ds_read_b64_tr_b16 v[162:163], v14 offset:21888
 v_mfma_f32_16x16x32_bf16 v[80:83], v[200:203], a[120:123], v[80:83]
 ds_read_b64_tr_b16 v[164:165], v15 offset:20640
 v_mfma_f32_16x16x32_bf16 v[120:123], v[200:203], a[124:127], v[120:123]
 ds_read_b64_tr_b16 v[166:167], v15 offset:21920
 v_mfma_f32_16x16x32_bf16 v[84:87], v[204:207], a[120:123], v[84:87]
 ds_read_b64_tr_b16 v[168:169], v14 offset:20672
 v_mfma_f32_16x16x32_bf16 v[124:127], v[204:207], a[124:127], v[124:127]
 ds_read_b64_tr_b16 v[170:171], v14 offset:21952
 ds_read_b64_tr_b16 v[172:173], v15 offset:20704
 v_mfma_f32_16x16x32_bf16 v[88:91], v[208:211], a[120:123], v[88:91]
 ds_read_b64_tr_b16 v[174:175], v15 offset:21984
 v_mfma_f32_16x16x32_bf16 v[128:131], v[208:211], a[124:127], v[128:131]
 ds_read_b64_tr_b16 v[176:177], v14 offset:20736
 v_mfma_f32_16x16x32_bf16 v[92:95], v[212:215], a[120:123], v[92:95]
 ds_read_b64_tr_b16 v[178:179], v14 offset:22016
 v_mfma_f32_16x16x32_bf16 v[132:135], v[212:215], a[124:127], v[132:135]
 ds_read_b64_tr_b16 v[180:181], v15 offset:20768
 v_mfma_f32_16x16x32_bf16 v[96:99], v[216:219], a[120:123], v[96:99]
 ds_read_b64_tr_b16 v[182:183], v15 offset:22048
 v_mfma_f32_16x16x32_bf16 v[136:139], v[216:219], a[124:127], v[136:139]
 v_mfma_f32_16x16x32_bf16 v[100:103], v[220:223], a[120:123], v[100:103]
 v_mfma_f32_16x16x32_bf16 v[140:143], v[220:223], a[124:127], v[140:143]
 s_waitcnt lgkmcnt(0) vmcnt(6)
 v_mfma_f32_16x16x32_bf16 v[64:67], v[144:147], a[128:131], v[64:67]
 ds_read_b64_tr_b16 v[184:185], v14 offset:30720
 ds_read_b64_tr_b16 v[186:187], v14 offset:32000
 v_mfma_f32_16x16x32_bf16 v[104:107], v[144:147], a[132:135], v[104:107]
 ds_read_b64_tr_b16 v[188:189], v15 offset:30752
 v_mfma_f32_16x16x32_bf16 v[68:71], v[148:151], a[128:131], v[68:71]
 ds_read_b64_tr_b16 v[190:191], v15 offset:32032
 v_mfma_f32_16x16x32_bf16 v[108:111], v[148:151], a[132:135], v[108:111]
 ds_read_b64_tr_b16 v[192:193], v14 offset:30784
 v_mfma_f32_16x16x32_bf16 v[72:75], v[152:155], a[128:131], v[72:75]
 ds_read_b64_tr_b16 v[194:195], v14 offset:32064
 v_mfma_f32_16x16x32_bf16 v[112:115], v[152:155], a[132:135], v[112:115]
 ds_read_b64_tr_b16 v[196:197], v15 offset:30816
 ds_read_b64_tr_b16 v[198:199], v15 offset:32096
 v_mfma_f32_16x16x32_bf16 v[76:79], v[156:159], a[128:131], v[76:79]
 ds_read_b64_tr_b16 v[200:201], v14 offset:30848
 v_mfma_f32_16x16x32_bf16 v[116:119], v[156:159], a[132:135], v[116:119]
 ds_read_b64_tr_b16 v[202:203], v14 offset:32128
 v_mfma_f32_16x16x32_bf16 v[80:83], v[160:163], a[128:131], v[80:83]
 ds_read_b64_tr_b16 v[204:205], v15 offset:30880
 v_mfma_f32_16x16x32_bf16 v[120:123], v[160:163], a[132:135], v[120:123]
 ds_read_b64_tr_b16 v[206:207], v15 offset:32160
 v_mfma_f32_16x16x32_bf16 v[84:87], v[164:167], a[128:131], v[84:87]
 ds_read_b64_tr_b16 v[208:209], v14 offset:30912
 v_mfma_f32_16x16x32_bf16 v[124:127], v[164:167], a[132:135], v[124:127]
 ds_read_b64_tr_b16 v[210:211], v14 offset:32192
 ds_read_b64_tr_b16 v[212:213], v15 offset:30944
 v_mfma_f32_16x16x32_bf16 v[88:91], v[168:171], a[128:131], v[88:91]
 ds_read_b64_tr_b16 v[214:215], v15 offset:32224
 v_mfma_f32_16x16x32_bf16 v[128:131], v[168:171], a[132:135], v[128:131]
 ds_read_b64_tr_b16 v[216:217], v14 offset:30976
 v_mfma_f32_16x16x32_bf16 v[92:95], v[172:175], a[128:131], v[92:95]
 ds_read_b64_tr_b16 v[218:219], v14 offset:32256
 v_mfma_f32_16x16x32_bf16 v[132:135], v[172:175], a[132:135], v[132:135]
 ds_read_b64_tr_b16 v[220:221], v15 offset:31008
 v_mfma_f32_16x16x32_bf16 v[96:99], v[176:179], a[128:131], v[96:99]
 ds_read_b64_tr_b16 v[222:223], v15 offset:32288
 v_mfma_f32_16x16x32_bf16 v[136:139], v[176:179], a[132:135], v[136:139]
 v_mfma_f32_16x16x32_bf16 v[100:103], v[180:183], a[128:131], v[100:103]
 v_mfma_f32_16x16x32_bf16 v[140:143], v[180:183], a[132:135], v[140:143]
 s_waitcnt lgkmcnt(0) vmcnt(4)
 s_barrier
 v_mfma_f32_16x16x32_bf16 v[64:67], v[184:187], a[136:139], v[64:67]
 ds_read_b64_tr_b16 v[144:145], v14 offset:40960
 ds_read_b64_tr_b16 v[146:147], v14 offset:42240
 v_mfma_f32_16x16x32_bf16 v[104:107], v[184:187], a[140:143], v[104:107]
 ds_read_b64_tr_b16 v[148:149], v15 offset:40992
 v_mfma_f32_16x16x32_bf16 v[68:71], v[188:191], a[136:139], v[68:71]
 ds_read_b64_tr_b16 v[150:151], v15 offset:42272
 v_mfma_f32_16x16x32_bf16 v[108:111], v[188:191], a[140:143], v[108:111]
 ds_read_b64_tr_b16 v[152:153], v14 offset:41024
 v_mfma_f32_16x16x32_bf16 v[72:75], v[192:195], a[136:139], v[72:75]
 ds_read_b64_tr_b16 v[154:155], v14 offset:42304
 v_mfma_f32_16x16x32_bf16 v[112:115], v[192:195], a[140:143], v[112:115]
 ds_read_b64_tr_b16 v[156:157], v15 offset:41056
 ds_read_b64_tr_b16 v[158:159], v15 offset:42336
 v_mfma_f32_16x16x32_bf16 v[76:79], v[196:199], a[136:139], v[76:79]
 ds_read_b64_tr_b16 v[160:161], v14 offset:41088
 v_mfma_f32_16x16x32_bf16 v[116:119], v[196:199], a[140:143], v[116:119]
 ds_read_b64_tr_b16 v[162:163], v14 offset:42368
 v_mfma_f32_16x16x32_bf16 v[80:83], v[200:203], a[136:139], v[80:83]
 ds_read_b64_tr_b16 v[164:165], v15 offset:41120
 v_mfma_f32_16x16x32_bf16 v[120:123], v[200:203], a[140:143], v[120:123]
 ds_read_b64_tr_b16 v[166:167], v15 offset:42400
 v_mfma_f32_16x16x32_bf16 v[84:87], v[204:207], a[136:139], v[84:87]
 ds_read_b64_tr_b16 v[168:169], v14 offset:41152
 v_mfma_f32_16x16x32_bf16 v[124:127], v[204:207], a[140:143], v[124:127]
 ds_read_b64_tr_b16 v[170:171], v14 offset:42432
 ds_read_b64_tr_b16 v[172:173], v15 offset:41184
 v_mfma_f32_16x16x32_bf16 v[88:91], v[208:211], a[136:139], v[88:91]
 ds_read_b64_tr_b16 v[174:175], v15 offset:42464
 v_mfma_f32_16x16x32_bf16 v[128:131], v[208:211], a[140:143], v[128:131]
 ds_read_b64_tr_b16 v[176:177], v14 offset:41216
 v_mfma_f32_16x16x32_bf16 v[92:95], v[212:215], a[136:139], v[92:95]
 ds_read_b64_tr_b16 v[178:179], v14 offset:42496
 v_mfma_f32_16x16x32_bf16 v[132:135], v[212:215], a[140:143], v[132:135]
 ds_read_b64_tr_b16 v[180:181], v15 offset:41248
 v_mfma_f32_16x16x32_bf16 v[96:99], v[216:219], a[136:139], v[96:99]
 ds_read_b64_tr_b16 v[182:183], v15 offset:42528
 v_mfma_f32_16x16x32_bf16 v[136:139], v[216:219], a[140:143], v[136:139]
 v_mfma_f32_16x16x32_bf16 v[100:103], v[220:223], a[136:139], v[100:103]
 v_mfma_f32_16x16x32_bf16 v[140:143], v[220:223], a[140:143], v[140:143]
 s_waitcnt lgkmcnt(0) vmcnt(2)
 v_mfma_f32_16x16x32_bf16 v[64:67], v[144:147], a[144:147], v[64:67]
 ds_read_b64_tr_b16 v[184:185], v14 offset:51200
 ds_read_b64_tr_b16 v[186:187], v14 offset:52480
 v_mfma_f32_16x16x32_bf16 v[104:107], v[144:147], a[148:151], v[104:107]
 ds_read_b64_tr_b16 v[188:189], v15 offset:51232
 v_mfma_f32_16x16x32_bf16 v[68:71], v[148:151], a[144:147], v[68:71]
 ds_read_b64_tr_b16 v[190:191], v15 offset:52512
 v_mfma_f32_16x16x32_bf16 v[108:111], v[148:151], a[148:151], v[108:111]
 ds_read_b64_tr_b16 v[192:193], v14 offset:51264
 v_mfma_f32_16x16x32_bf16 v[72:75], v[152:155], a[144:147], v[72:75]
 ds_read_b64_tr_b16 v[194:195], v14 offset:52544
 v_mfma_f32_16x16x32_bf16 v[112:115], v[152:155], a[148:151], v[112:115]
 ds_read_b64_tr_b16 v[196:197], v15 offset:51296
 ds_read_b64_tr_b16 v[198:199], v15 offset:52576
 v_mfma_f32_16x16x32_bf16 v[76:79], v[156:159], a[144:147], v[76:79]
 ds_read_b64_tr_b16 v[200:201], v14 offset:51328
 v_mfma_f32_16x16x32_bf16 v[116:119], v[156:159], a[148:151], v[116:119]
 ds_read_b64_tr_b16 v[202:203], v14 offset:52608
 v_mfma_f32_16x16x32_bf16 v[80:83], v[160:163], a[144:147], v[80:83]
 ds_read_b64_tr_b16 v[204:205], v15 offset:51360
 v_mfma_f32_16x16x32_bf16 v[120:123], v[160:163], a[148:151], v[120:123]
 ds_read_b64_tr_b16 v[206:207], v15 offset:52640
 v_mfma_f32_16x16x32_bf16 v[84:87], v[164:167], a[144:147], v[84:87]
 ds_read_b64_tr_b16 v[208:209], v14 offset:51392
 v_mfma_f32_16x16x32_bf16 v[124:127], v[164:167], a[148:151], v[124:127]
 ds_read_b64_tr_b16 v[210:211], v14 offset:52672
 ds_read_b64_tr_b16 v[212:213], v15 offset:51424
 v_mfma_f32_16x16x32_bf16 v[88:91], v[168:171], a[144:147], v[88:91]
 ds_read_b64_tr_b16 v[214:215], v15 offset:52704
 v_mfma_f32_16x16x32_bf16 v[128:131], v[168:171], a[148:151], v[128:131]
 ds_read_b64_tr_b16 v[216:217], v14 offset:51456
 v_mfma_f32_16x16x32_bf16 v[92:95], v[172:175], a[144:147], v[92:95]
 ds_read_b64_tr_b16 v[218:219], v14 offset:52736
 v_mfma_f32_16x16x32_bf16 v[132:135], v[172:175], a[148:151], v[132:135]
 ds_read_b64_tr_b16 v[220:221], v15 offset:51488
 v_mfma_f32_16x16x32_bf16 v[96:99], v[176:179], a[144:147], v[96:99]
 ds_read_b64_tr_b16 v[222:223], v15 offset:52768
 v_mfma_f32_16x16x32_bf16 v[136:139], v[176:179], a[148:151], v[136:139]
 v_mfma_f32_16x16x32_bf16 v[100:103], v[180:183], a[144:147], v[100:103]
 v_mfma_f32_16x16x32_bf16 v[140:143], v[180:183], a[148:151], v[140:143]
 s_waitcnt lgkmcnt(0) vmcnt(0)
 v_mfma_f32_16x16x32_bf16 v[64:67], v[184:187], a[152:155], v[64:67]
 v_mfma_f32_16x16x32_bf16 v[104:107], v[184:187], a[156:159], v[104:107]
 v_mfma_f32_16x16x32_bf16 v[68:71], v[188:191], a[152:155], v[68:71]
 v_mfma_f32_16x16x32_bf16 v[108:111], v[188:191], a[156:159], v[108:111]
 v_mfma_f32_16x16x32_bf16 v[72:75], v[192:195], a[152:155], v[72:75]
 v_mfma_f32_16x16x32_bf16 v[112:115], v[192:195], a[156:159], v[112:115]
 v_mfma_f32_16x16x32_bf16 v[76:79], v[196:199], a[152:155], v[76:79]
 v_mfma_f32_16x16x32_bf16 v[116:119], v[196:199], a[156:159], v[116:119]
 v_mfma_f32_16x16x32_bf16 v[80:83], v[200:203], a[152:155], v[80:83]
 v_mfma_f32_16x16x32_bf16 v[120:123], v[200:203], a[156:159], v[120:123]
 v_mfma_f32_16x16x32_bf16 v[84:87], v[204:207], a[152:155], v[84:87]
 v_mfma_f32_16x16x32_bf16 v[124:127], v[204:207], a[156:159], v[124:127]
 v_mfma_f32_16x16x32_bf16 v[88:91], v[208:211], a[152:155], v[88:91]
 v_mfma_f32_16x16x32_bf16 v[128:131], v[208:211], a[156:159], v[128:131]
 v_mfma_f32_16x16x32_bf16 v[92:95], v[212:215], a[152:155], v[92:95]
 v_mfma_f32_16x16x32_bf16 v[132:135], v[212:215], a[156:159], v[132:135]
 v_mfma_f32_16x16x32_bf16 v[96:99], v[216:219], a[152:155], v[96:99]
 v_mfma_f32_16x16x32_bf16 v[136:139], v[216:219], a[156:159], v[136:139]
 v_mfma_f32_16x16x32_bf16 v[100:103], v[220:223], a[152:155], v[100:103]
 v_mfma_f32_16x16x32_bf16 v[140:143], v[220:223], a[156:159], v[140:143]
 s_add_u32 s16, s38, 180355072
 s_addc_u32 s17, s39, 0
 s_mov_b32 s18, 67108864
 s_mov_b32 s19, 0x00020000
 s_nop 3
 s_lshr_b32 s22, s47, 1
 s_lshr_b32 s21, s22, 1
 s_bitcmp1_b32 s37, s21
 s_cselect_b32 s21, 8192, 0
 s_lshl_b32 s51, s22, 20
 s_or_b32 s51, s51, s21
 s_add_u32 s51, s51, 786432
 s_mul_i32 s53, s44, 5
 s_cmp_lt_u32 s2, 48
 s_cbranch_scc1 om_241
 s_add_u32 s21, s53, 0
 s_lshr_b32 s22, s21, 1
 s_lshl_b32 s22, s22, 14
 s_and_b32 s21, s21, 1
 s_lshl_b32 s21, s21, 11
 s_add_u32 s22, s22, s21
 s_add_u32 s22, s22, s51
 buffer_store_dwordx4 v[64:67], v4, s[16:19], s22 offen offset:0 sc1
 buffer_store_dwordx4 v[68:71], v4, s[16:19], s22 offen offset:1024 sc1
 s_add_u32 s21, s53, 1
 s_lshr_b32 s22, s21, 1
 s_lshl_b32 s22, s22, 14
 s_and_b32 s21, s21, 1
 s_lshl_b32 s21, s21, 11
 s_add_u32 s22, s22, s21
 s_add_u32 s22, s22, s51
 buffer_store_dwordx4 v[72:75], v4, s[16:19], s22 offen offset:0 sc1
 buffer_store_dwordx4 v[76:79], v4, s[16:19], s22 offen offset:1024 sc1
 s_add_u32 s21, s53, 2
 s_lshr_b32 s22, s21, 1
 s_lshl_b32 s22, s22, 14
 s_and_b32 s21, s21, 1
 s_lshl_b32 s21, s21, 11
 s_add_u32 s22, s22, s21
 s_add_u32 s22, s22, s51
 buffer_store_dwordx4 v[80:83], v4, s[16:19], s22 offen offset:0 sc1
 buffer_store_dwordx4 v[84:87], v4, s[16:19], s22 offen offset:1024 sc1
 s_add_u32 s21, s53, 3
 s_lshr_b32 s22, s21, 1
 s_lshl_b32 s22, s22, 14
 s_and_b32 s21, s21, 1
 s_lshl_b32 s21, s21, 11
 s_add_u32 s22, s22, s21
 s_add_u32 s22, s22, s51
 buffer_store_dwordx4 v[88:91], v4, s[16:19], s22 offen offset:0 sc1
 buffer_store_dwordx4 v[92:95], v4, s[16:19], s22 offen offset:1024 sc1
 s_add_u32 s21, s53, 4
 s_lshr_b32 s22, s21, 1
 s_lshl_b32 s22, s22, 14
 s_and_b32 s21, s21, 1
 s_lshl_b32 s21, s21, 11
 s_add_u32 s22, s22, s21
 s_add_u32 s22, s22, s51
 buffer_store_dwordx4 v[96:99], v4, s[16:19], s22 offen offset:0 sc1
 buffer_store_dwordx4 v[100:103], v4, s[16:19], s22 offen offset:1024 sc1
 s_add_u32 s21, s53, 0
 s_lshr_b32 s22, s21, 1
 s_lshl_b32 s22, s22, 14
 s_and_b32 s21, s21, 1
 s_lshl_b32 s21, s21, 11
 s_add_u32 s22, s22, s21
 s_add_u32 s22, s22, s51
 s_add_u32 s22, s22, 4096
 buffer_store_dwordx4 v[104:107], v4, s[16:19], s22 offen offset:0 sc1
 buffer_store_dwordx4 v[108:111], v4, s[16:19], s22 offen offset:1024 sc1
 s_add_u32 s21, s53, 1
 s_lshr_b32 s22, s21, 1
 s_lshl_b32 s22, s22, 14
 s_and_b32 s21, s21, 1
 s_lshl_b32 s21, s21, 11
 s_add_u32 s22, s22, s21
 s_add_u32 s22, s22, s51
 s_add_u32 s22, s22, 4096
 buffer_store_dwordx4 v[112:115], v4, s[16:19], s22 offen offset:0 sc1
 buffer_store_dwordx4 v[116:119], v4, s[16:19], s22 offen offset:1024 sc1
 s_add_u32 s21, s53, 2
 s_lshr_b32 s22, s21, 1
 s_lshl_b32 s22, s22, 14
 s_and_b32 s21, s21, 1
 s_lshl_b32 s21, s21, 11
 s_add_u32 s22, s22, s21
 s_add_u32 s22, s22, s51
 s_add_u32 s22, s22, 4096
 buffer_store_dwordx4 v[120:123], v4, s[16:19], s22 offen offset:0 sc1
 buffer_store_dwordx4 v[124:127], v4, s[16:19], s22 offen offset:1024 sc1
 s_add_u32 s21, s53, 3
 s_lshr_b32 s22, s21, 1
 s_lshl_b32 s22, s22, 14
 s_and_b32 s21, s21, 1
 s_lshl_b32 s21, s21, 11
 s_add_u32 s22, s22, s21
 s_add_u32 s22, s22, s51
 s_add_u32 s22, s22, 4096
 buffer_store_dwordx4 v[128:131], v4, s[16:19], s22 offen offset:0 sc1
 buffer_store_dwordx4 v[132:135], v4, s[16:19], s22 offen offset:1024 sc1
 s_add_u32 s21, s53, 4
 s_lshr_b32 s22, s21, 1
 s_lshl_b32 s22, s22, 14
 s_and_b32 s21, s21, 1
 s_lshl_b32 s21, s21, 11
 s_add_u32 s22, s22, s21
 s_add_u32 s22, s22, s51
 s_add_u32 s22, s22, 4096
 buffer_store_dwordx4 v[136:139], v4, s[16:19], s22 offen offset:0 sc1
 buffer_store_dwordx4 v[140:143], v4, s[16:19], s22 offen offset:1024 sc1
 s_waitcnt vmcnt(0)
 s_barrier
 s_lshr_b32 s21, s2, 2
 s_lshl_b32 s21, s21, 7
 s_add_u32 s21, s21, 93184
 s_cmp_lg_u32 s20, 0
 s_cbranch_scc1 af_243
 v_mov_b32 v10, 0
 v_mov_b32 v11, 1
 s_mov_b64 exec, 1
 buffer_atomic_add v11, v10, s[72:75], s21 offen sc1
 s_mov_b64 exec, -1
 s_nop 1
af_243:
 s_branch om_242
om_241:
 s_load_dwordx2 s[8:9], s[0:1], 88
 s_lshr_b32 s52, s2, 2
 s_lshl_b32 s52, s52, 7
 s_and_b32 s21, s52, 511
 s_add_u32 s21, s21, 94720
 s_cmp_lt_u32 s2, 32
 s_cselect_b32 s54, 32, 80
 s_add_u32 s21, s52, 116736
 s_cmp_lg_u32 s20, 0
 s_cbranch_scc1 wf_245
 v_mov_b32 v20, 0
 s_mov_b32 s101, 0
wf_244:
 buffer_load_dword v21, v20, s[72:75], s21 offen sc1
 s_add_u32 s101, s101, 1
 s_cmp_gt_u32 s101, 131072
 s_cbranch_scc1 main_end
 s_waitcnt vmcnt(0)
 v_readfirstlane_b32 s100, v21
 s_cmp_ge_u32 s100, s54
 s_cbranch_scc1 wf_245
 s_sleep 16
 s_branch wf_244
wf_245:
 s_barrier
 v_lshlrev_b32 v6, 2, v2
 s_lshl_b32 s22, s47, 6
 buffer_load_dword v30, v6, s[28:31], s22 offen sc1
 buffer_load_dword v31, v6, s[28:31], s22 offen offset:64 sc1
 s_add_u32 s21, s53, 0
 s_lshr_b32 s22, s21, 1
 s_lshl_b32 s22, s22, 14
 s_and_b32 s21, s21, 1
 s_lshl_b32 s21, s21, 11
 s_add_u32 s22, s22, s21
 s_add_u32 s22, s22, s51
 buffer_load_dwordx4 v[144:147], v4, s[16:19], s22 offen offset:0 sc1
 buffer_load_dwordx4 v[148:151], v4, s[16:19], s22 offen offset:1024 sc1
 s_add_u32 s21, s53, 1
 s_lshr_b32 s22, s21, 1
 s_lshl_b32 s22, s22, 14
 s_and_b32 s21, s21, 1
 s_lshl_b32 s21, s21, 11
 s_add_u32 s22, s22, s21
 s_add_u32 s22, s22, s51
 buffer_load_dwordx4 v[152:155], v4, s[16:19], s22 offen offset:0 sc1
 buffer_load_dwordx4 v[156:159], v4, s[16:19], s22 offen offset:1024 sc1
 s_add_u32 s21, s53, 2
 s_lshr_b32 s22, s21, 1
 s_lshl_b32 s22, s22, 14
 s_and_b32 s21, s21, 1
 s_lshl_b32 s21, s21, 11
 s_add_u32 s22, s22, s21
 s_add_u32 s22, s22, s51
 buffer_load_dwordx4 v[160:163], v4, s[16:19], s22 offen offset:0 sc1
 buffer_load_dwordx4 v[164:167], v4, s[16:19], s22 offen offset:1024 sc1
 s_add_u32 s21, s53, 3
 s_lshr_b32 s22, s21, 1
 s_lshl_b32 s22, s22, 14
 s_and_b32 s21, s21, 1
 s_lshl_b32 s21, s21, 11
 s_add_u32 s22, s22, s21
 s_add_u32 s22, s22, s51
 buffer_load_dwordx4 v[168:171], v4, s[16:19], s22 offen offset:0 sc1
 buffer_load_dwordx4 v[172:175], v4, s[16:19], s22 offen offset:1024 sc1
 s_add_u32 s21, s53, 4
 s_lshr_b32 s22, s21, 1
 s_lshl_b32 s22, s22, 14
 s_and_b32 s21, s21, 1
 s_lshl_b32 s21, s21, 11
 s_add_u32 s22, s22, s21
 s_add_u32 s22, s22, s51
 buffer_load_dwordx4 v[176:179], v4, s[16:19], s22 offen offset:0 sc1
 buffer_load_dwordx4 v[180:183], v4, s[16:19], s22 offen offset:1024 sc1
 s_add_u32 s21, s53, 0
 s_lshr_b32 s22, s21, 1
 s_lshl_b32 s22, s22, 14
 s_and_b32 s21, s21, 1
 s_lshl_b32 s21, s21, 11
 s_add_u32 s22, s22, s21
 s_add_u32 s22, s22, s51
 s_add_u32 s22, s22, 4096
 buffer_load_dwordx4 v[184:187], v4, s[16:19], s22 offen offset:0 sc1
 buffer_load_dwordx4 v[188:191], v4, s[16:19], s22 offen offset:1024 sc1
 s_add_u32 s21, s53, 1
 s_lshr_b32 s22, s21, 1
 s_lshl_b32 s22, s22, 14
 s_and_b32 s21, s21, 1
 s_lshl_b32 s21, s21, 11
 s_add_u32 s22, s22, s21
 s_add_u32 s22, s22, s51
 s_add_u32 s22, s22, 4096
 buffer_load_dwordx4 v[192:195], v4, s[16:19], s22 offen offset:0 sc1
 buffer_load_dwordx4 v[196:199], v4, s[16:19], s22 offen offset:1024 sc1
 s_add_u32 s21, s53, 2
 s_lshr_b32 s22, s21, 1
 s_lshl_b32 s22, s22, 14
 s_and_b32 s21, s21, 1
 s_lshl_b32 s21, s21, 11
 s_add_u32 s22, s22, s21
 s_add_u32 s22, s22, s51
 s_add_u32 s22, s22, 4096
 buffer_load_dwordx4 v[200:203], v4, s[16:19], s22 offen offset:0 sc1
 buffer_load_dwordx4 v[204:207], v4, s[16:19], s22 offen offset:1024 sc1
 s_add_u32 s21, s53, 3
 s_lshr_b32 s22, s21, 1
 s_lshl_b32 s22, s22, 14
 s_and_b32 s21, s21, 1
 s_lshl_b32 s21, s21, 11
 s_add_u32 s22, s22, s21
 s_add_u32 s22, s22, s51
 s_add_u32 s22, s22, 4096
 buffer_load_dwordx4 v[208:211], v4, s[16:19], s22 offen offset:0 sc1
 buffer_load_dwordx4 v[212:215], v4, s[16:19], s22 offen offset:1024 sc1
 s_add_u32 s21, s53, 4
 s_lshr_b32 s22, s21, 1
 s_lshl_b32 s22, s22, 14
 s_and_b32 s21, s21, 1
 s_lshl_b32 s21, s21, 11
 s_add_u32 s22, s22, s21
 s_add_u32 s22, s22, s51
 s_add_u32 s22, s22, 4096
 buffer_load_dwordx4 v[216:219], v4, s[16:19], s22 offen offset:0 sc1
 buffer_load_dwordx4 v[220:223], v4, s[16:19], s22 offen offset:1024 sc1
 v_mul_u32_u24 v9, 1280, v2
 v_lshl_add_u32 v9, v3, 3, v9
 s_mul_i32 s22, s47, 20480
 s_add_u32 s22, s22, s45
 s_add_u32 s23, s22, 20480
 s_waitcnt vmcnt(20) lgkmcnt(0)
 v_sub_f32 v32, 1.0, v30
 v_sub_f32 v33, 1.0, v31
 v_cvt_pk_bf16_f32 v26, v32, v33
 v_lshlrev_b32 v32, 16, v26
 v_and_b32 v33, 0xffff0000, v26
 v_cvt_pk_bf16_f32 v26, v64, v65
 v_lshlrev_b32 v64, 16, v26
 v_and_b32 v65, 0xffff0000, v26
 v_mul_f32 v64, v64, v32
 v_mul_f32 v65, v65, v32
 v_cvt_pk_bf16_f32 v26, v64, v65
 v_lshlrev_b32 v64, 16, v26
 v_and_b32 v65, 0xffff0000, v26
 v_cvt_pk_bf16_f32 v26, v66, v67
 v_lshlrev_b32 v66, 16, v26
 v_and_b32 v67, 0xffff0000, v26
 v_mul_f32 v66, v66, v32
 v_mul_f32 v67, v67, v32
 v_cvt_pk_bf16_f32 v26, v66, v67
 v_lshlrev_b32 v66, 16, v26
 v_and_b32 v67, 0xffff0000, v26
 v_cvt_pk_bf16_f32 v26, v68, v69
 v_lshlrev_b32 v68, 16, v26
 v_and_b32 v69, 0xffff0000, v26
 v_mul_f32 v68, v68, v32
 v_mul_f32 v69, v69, v32
 v_cvt_pk_bf16_f32 v26, v68, v69
 v_lshlrev_b32 v68, 16, v26
 v_and_b32 v69, 0xffff0000, v26
 v_cvt_pk_bf16_f32 v26, v70, v71
 v_lshlrev_b32 v70, 16, v26
 v_and_b32 v71, 0xffff0000, v26
 v_mul_f32 v70, v70, v32
 v_mul_f32 v71, v71, v32
 v_cvt_pk_bf16_f32 v26, v70, v71
 v_lshlrev_b32 v70, 16, v26
 v_and_b32 v71, 0xffff0000, v26
 v_cvt_pk_bf16_f32 v26, v72, v73
 v_lshlrev_b32 v72, 16, v26
 v_and_b32 v73, 0xffff0000, v26
 v_mul_f32 v72, v72, v32
 v_mul_f32 v73, v73, v32
 v_cvt_pk_bf16_f32 v26, v72, v73
 v_lshlrev_b32 v72, 16, v26
 v_and_b32 v73, 0xffff0000, v26
 v_cvt_pk_bf16_f32 v26, v74, v75
 v_lshlrev_b32 v74, 16, v26
 v_and_b32 v75, 0xffff0000, v26
 v_mul_f32 v74, v74, v32
 v_mul_f32 v75, v75, v32
 v_cvt_pk_bf16_f32 v26, v74, v75
 v_lshlrev_b32 v74, 16, v26
 v_and_b32 v75, 0xffff0000, v26
 v_cvt_pk_bf16_f32 v26, v76, v77
 v_lshlrev_b32 v76, 16, v26
 v_and_b32 v77, 0xffff0000, v26
 v_mul_f32 v76, v76, v32
 v_mul_f32 v77, v77, v32
 v_cvt_pk_bf16_f32 v26, v76, v77
 v_lshlrev_b32 v76, 16, v26
 v_and_b32 v77, 0xffff0000, v26
 v_cvt_pk_bf16_f32 v26, v78, v79
 v_lshlrev_b32 v78, 16, v26
 v_and_b32 v79, 0xffff0000, v26
 v_mul_f32 v78, v78, v32
 v_mul_f32 v79, v79, v32
 v_cvt_pk_bf16_f32 v26, v78, v79
 v_lshlrev_b32 v78, 16, v26
 v_and_b32 v79, 0xffff0000, v26
 v_cvt_pk_bf16_f32 v26, v80, v81
 v_lshlrev_b32 v80, 16, v26
 v_and_b32 v81, 0xffff0000, v26
 v_mul_f32 v80, v80, v32
 v_mul_f32 v81, v81, v32
 v_cvt_pk_bf16_f32 v26, v80, v81
 v_lshlrev_b32 v80, 16, v26
 v_and_b32 v81, 0xffff0000, v26
 v_cvt_pk_bf16_f32 v26, v82, v83
 v_lshlrev_b32 v82, 16, v26
 v_and_b32 v83, 0xffff0000, v26
 v_mul_f32 v82, v82, v32
 v_mul_f32 v83, v83, v32
 v_cvt_pk_bf16_f32 v26, v82, v83
 v_lshlrev_b32 v82, 16, v26
 v_and_b32 v83, 0xffff0000, v26
 v_cvt_pk_bf16_f32 v26, v84, v85
 v_lshlrev_b32 v84, 16, v26
 v_and_b32 v85, 0xffff0000, v26
 v_mul_f32 v84, v84, v32
 v_mul_f32 v85, v85, v32
 v_cvt_pk_bf16_f32 v26, v84, v85
 v_lshlrev_b32 v84, 16, v26
 v_and_b32 v85, 0xffff0000, v26
 v_cvt_pk_bf16_f32 v26, v86, v87
 v_lshlrev_b32 v86, 16, v26
 v_and_b32 v87, 0xffff0000, v26
 v_mul_f32 v86, v86, v32
 v_mul_f32 v87, v87, v32
 v_cvt_pk_bf16_f32 v26, v86, v87
 v_lshlrev_b32 v86, 16, v26
 v_and_b32 v87, 0xffff0000, v26
 v_cvt_pk_bf16_f32 v26, v88, v89
 v_lshlrev_b32 v88, 16, v26
 v_and_b32 v89, 0xffff0000, v26
 v_mul_f32 v88, v88, v32
 v_mul_f32 v89, v89, v32
 v_cvt_pk_bf16_f32 v26, v88, v89
 v_lshlrev_b32 v88, 16, v26
 v_and_b32 v89, 0xffff0000, v26
 v_cvt_pk_bf16_f32 v26, v90, v91
 v_lshlrev_b32 v90, 16, v26
 v_and_b32 v91, 0xffff0000, v26
 v_mul_f32 v90, v90, v32
 v_mul_f32 v91, v91, v32
 v_cvt_pk_bf16_f32 v26, v90, v91
 v_lshlrev_b32 v90, 16, v26
 v_and_b32 v91, 0xffff0000, v26
 v_cvt_pk_bf16_f32 v26, v92, v93
 v_lshlrev_b32 v92, 16, v26
 v_and_b32 v93, 0xffff0000, v26
 v_mul_f32 v92, v92, v32
 v_mul_f32 v93, v93, v32
 v_cvt_pk_bf16_f32 v26, v92, v93
 v_lshlrev_b32 v92, 16, v26
 v_and_b32 v93, 0xffff0000, v26
 v_cvt_pk_bf16_f32 v26, v94, v95
 v_lshlrev_b32 v94, 16, v26
 v_and_b32 v95, 0xffff0000, v26
 v_mul_f32 v94, v94, v32
 v_mul_f32 v95, v95, v32
 v_cvt_pk_bf16_f32 v26, v94, v95
 v_lshlrev_b32 v94, 16, v26
 v_and_b32 v95, 0xffff0000, v26
 v_cvt_pk_bf16_f32 v26, v96, v97
 v_lshlrev_b32 v96, 16, v26
 v_and_b32 v97, 0xffff0000, v26
 v_mul_f32 v96, v96, v32
 v_mul_f32 v97, v97, v32
 v_cvt_pk_bf16_f32 v26, v96, v97
 v_lshlrev_b32 v96, 16, v26
 v_and_b32 v97, 0xffff0000, v26
 v_cvt_pk_bf16_f32 v26, v98, v99
 v_lshlrev_b32 v98, 16, v26
 v_and_b32 v99, 0xffff0000, v26
 v_mul_f32 v98, v98, v32
 v_mul_f32 v99, v99, v32
 v_cvt_pk_bf16_f32 v26, v98, v99
 v_lshlrev_b32 v98, 16, v26
 v_and_b32 v99, 0xffff0000, v26
 v_cvt_pk_bf16_f32 v26, v100, v101
 v_lshlrev_b32 v100, 16, v26
 v_and_b32 v101, 0xffff0000, v26
 v_mul_f32 v100, v100, v32
 v_mul_f32 v101, v101, v32
 v_cvt_pk_bf16_f32 v26, v100, v101
 v_lshlrev_b32 v100, 16, v26
 v_and_b32 v101, 0xffff0000, v26
 v_cvt_pk_bf16_f32 v26, v102, v103
 v_lshlrev_b32 v102, 16, v26
 v_and_b32 v103, 0xffff0000, v26
 v_mul_f32 v102, v102, v32
 v_mul_f32 v103, v103, v32
 v_cvt_pk_bf16_f32 v26, v102, v103
 v_lshlrev_b32 v102, 16, v26
 v_and_b32 v103, 0xffff0000, v26
 v_cvt_pk_bf16_f32 v26, v104, v105
 v_lshlrev_b32 v104, 16, v26
 v_and_b32 v105, 0xffff0000, v26
 v_mul_f32 v104, v104, v33
 v_mul_f32 v105, v105, v33
 v_cvt_pk_bf16_f32 v26, v104, v105
 v_lshlrev_b32 v104, 16, v26
 v_and_b32 v105, 0xffff0000, v26
 v_cvt_pk_bf16_f32 v26, v106, v107
 v_lshlrev_b32 v106, 16, v26
 v_and_b32 v107, 0xffff0000, v26
 v_mul_f32 v106, v106, v33
 v_mul_f32 v107, v107, v33
 v_cvt_pk_bf16_f32 v26, v106, v107
 v_lshlrev_b32 v106, 16, v26
 v_and_b32 v107, 0xffff0000, v26
 v_cvt_pk_bf16_f32 v26, v108, v109
 v_lshlrev_b32 v108, 16, v26
 v_and_b32 v109, 0xffff0000, v26
 v_mul_f32 v108, v108, v33
 v_mul_f32 v109, v109, v33
 v_cvt_pk_bf16_f32 v26, v108, v109
 v_lshlrev_b32 v108, 16, v26
 v_and_b32 v109, 0xffff0000, v26
 v_cvt_pk_bf16_f32 v26, v110, v111
 v_lshlrev_b32 v110, 16, v26
 v_and_b32 v111, 0xffff0000, v26
 v_mul_f32 v110, v110, v33
 v_mul_f32 v111, v111, v33
 v_cvt_pk_bf16_f32 v26, v110, v111
 v_lshlrev_b32 v110, 16, v26
 v_and_b32 v111, 0xffff0000, v26
 v_cvt_pk_bf16_f32 v26, v112, v113
 v_lshlrev_b32 v112, 16, v26
 v_and_b32 v113, 0xffff0000, v26
 v_mul_f32 v112, v112, v33
 v_mul_f32 v113, v113, v33
 v_cvt_pk_bf16_f32 v26, v112, v113
 v_lshlrev_b32 v112, 16, v26
 v_and_b32 v113, 0xffff0000, v26
 v_cvt_pk_bf16_f32 v26, v114, v115
 v_lshlrev_b32 v114, 16, v26
 v_and_b32 v115, 0xffff0000, v26
 v_mul_f32 v114, v114, v33
 v_mul_f32 v115, v115, v33
 v_cvt_pk_bf16_f32 v26, v114, v115
 v_lshlrev_b32 v114, 16, v26
 v_and_b32 v115, 0xffff0000, v26
 v_cvt_pk_bf16_f32 v26, v116, v117
 v_lshlrev_b32 v116, 16, v26
 v_and_b32 v117, 0xffff0000, v26
 v_mul_f32 v116, v116, v33
 v_mul_f32 v117, v117, v33
 v_cvt_pk_bf16_f32 v26, v116, v117
 v_lshlrev_b32 v116, 16, v26
 v_and_b32 v117, 0xffff0000, v26
 v_cvt_pk_bf16_f32 v26, v118, v119
 v_lshlrev_b32 v118, 16, v26
 v_and_b32 v119, 0xffff0000, v26
 v_mul_f32 v118, v118, v33
 v_mul_f32 v119, v119, v33
 v_cvt_pk_bf16_f32 v26, v118, v119
 v_lshlrev_b32 v118, 16, v26
 v_and_b32 v119, 0xffff0000, v26
 v_cvt_pk_bf16_f32 v26, v120, v121
 v_lshlrev_b32 v120, 16, v26
 v_and_b32 v121, 0xffff0000, v26
 v_mul_f32 v120, v120, v33
 v_mul_f32 v121, v121, v33
 v_cvt_pk_bf16_f32 v26, v120, v121
 v_lshlrev_b32 v120, 16, v26
 v_and_b32 v121, 0xffff0000, v26
 v_cvt_pk_bf16_f32 v26, v122, v123
 v_lshlrev_b32 v122, 16, v26
 v_and_b32 v123, 0xffff0000, v26
 v_mul_f32 v122, v122, v33
 v_mul_f32 v123, v123, v33
 v_cvt_pk_bf16_f32 v26, v122, v123
 v_lshlrev_b32 v122, 16, v26
 v_and_b32 v123, 0xffff0000, v26
 v_cvt_pk_bf16_f32 v26, v124, v125
 v_lshlrev_b32 v124, 16, v26
 v_and_b32 v125, 0xffff0000, v26
 v_mul_f32 v124, v124, v33
 v_mul_f32 v125, v125, v33
 v_cvt_pk_bf16_f32 v26, v124, v125
 v_lshlrev_b32 v124, 16, v26
 v_and_b32 v125, 0xffff0000, v26
 v_cvt_pk_bf16_f32 v26, v126, v127
 v_lshlrev_b32 v126, 16, v26
 v_and_b32 v127, 0xffff0000, v26
 v_mul_f32 v126, v126, v33
 v_mul_f32 v127, v127, v33
 v_cvt_pk_bf16_f32 v26, v126, v127
 v_lshlrev_b32 v126, 16, v26
 v_and_b32 v127, 0xffff0000, v26
 v_cvt_pk_bf16_f32 v26, v128, v129
 v_lshlrev_b32 v128, 16, v26
 v_and_b32 v129, 0xffff0000, v26
 v_mul_f32 v128, v128, v33
 v_mul_f32 v129, v129, v33
 v_cvt_pk_bf16_f32 v26, v128, v129
 v_lshlrev_b32 v128, 16, v26
 v_and_b32 v129, 0xffff0000, v26
 v_cvt_pk_bf16_f32 v26, v130, v131
 v_lshlrev_b32 v130, 16, v26
 v_and_b32 v131, 0xffff0000, v26
 v_mul_f32 v130, v130, v33
 v_mul_f32 v131, v131, v33
 v_cvt_pk_bf16_f32 v26, v130, v131
 v_lshlrev_b32 v130, 16, v26
 v_and_b32 v131, 0xffff0000, v26
 v_cvt_pk_bf16_f32 v26, v132, v133
 v_lshlrev_b32 v132, 16, v26
 v_and_b32 v133, 0xffff0000, v26
 v_mul_f32 v132, v132, v33
 v_mul_f32 v133, v133, v33
 v_cvt_pk_bf16_f32 v26, v132, v133
 v_lshlrev_b32 v132, 16, v26
 v_and_b32 v133, 0xffff0000, v26
 v_cvt_pk_bf16_f32 v26, v134, v135
 v_lshlrev_b32 v134, 16, v26
 v_and_b32 v135, 0xffff0000, v26
 v_mul_f32 v134, v134, v33
 v_mul_f32 v135, v135, v33
 v_cvt_pk_bf16_f32 v26, v134, v135
 v_lshlrev_b32 v134, 16, v26
 v_and_b32 v135, 0xffff0000, v26
 v_cvt_pk_bf16_f32 v26, v136, v137
 v_lshlrev_b32 v136, 16, v26
 v_and_b32 v137, 0xffff0000, v26
 v_mul_f32 v136, v136, v33
 v_mul_f32 v137, v137, v33
 v_cvt_pk_bf16_f32 v26, v136, v137
 v_lshlrev_b32 v136, 16, v26
 v_and_b32 v137, 0xffff0000, v26
 v_cvt_pk_bf16_f32 v26, v138, v139
 v_lshlrev_b32 v138, 16, v26
 v_and_b32 v139, 0xffff0000, v26
 v_mul_f32 v138, v138, v33
 v_mul_f32 v139, v139, v33
 v_cvt_pk_bf16_f32 v26, v138, v139
 v_lshlrev_b32 v138, 16, v26
 v_and_b32 v139, 0xffff0000, v26
 v_cvt_pk_bf16_f32 v26, v140, v141
 v_lshlrev_b32 v140, 16, v26
 v_and_b32 v141, 0xffff0000, v26
 v_mul_f32 v140, v140, v33
 v_mul_f32 v141, v141, v33
 v_cvt_pk_bf16_f32 v26, v140, v141
 v_lshlrev_b32 v140, 16, v26
 v_and_b32 v141, 0xffff0000, v26
 v_cvt_pk_bf16_f32 v26, v142, v143
 v_lshlrev_b32 v142, 16, v26
 v_and_b32 v143, 0xffff0000, v26
 v_mul_f32 v142, v142, v33
 v_mul_f32 v143, v143, v33
 v_cvt_pk_bf16_f32 v26, v142, v143
 v_lshlrev_b32 v142, 16, v26
 v_and_b32 v143, 0xffff0000, v26
 s_waitcnt vmcnt(19)
 v_cvt_pk_bf16_f32 v26, v144, v145
 v_lshlrev_b32 v144, 16, v26
 v_and_b32 v145, 0xffff0000, v26
 v_mul_f32 v144, v144, v30
 v_mul_f32 v145, v145, v30
 v_cvt_pk_bf16_f32 v26, v144, v145
 v_lshlrev_b32 v144, 16, v26
 v_and_b32 v145, 0xffff0000, v26
 v_add_f32 v144, v144, v64
 v_add_f32 v145, v145, v65
 v_cvt_pk_bf16_f32 v64, v144, v145
 v_cvt_pk_bf16_f32 v26, v146, v147
 v_lshlrev_b32 v146, 16, v26
 v_and_b32 v147, 0xffff0000, v26
 v_mul_f32 v146, v146, v30
 v_mul_f32 v147, v147, v30
 v_cvt_pk_bf16_f32 v26, v146, v147
 v_lshlrev_b32 v146, 16, v26
 v_and_b32 v147, 0xffff0000, v26
 v_add_f32 v146, v146, v66
 v_add_f32 v147, v147, v67
 v_cvt_pk_bf16_f32 v65, v146, v147
 buffer_store_dwordx2 v[64:65], v9, s[8:11], s22 offen offset:0
 s_waitcnt vmcnt(19)
 v_cvt_pk_bf16_f32 v26, v148, v149
 v_lshlrev_b32 v148, 16, v26
 v_and_b32 v149, 0xffff0000, v26
 v_mul_f32 v148, v148, v30
 v_mul_f32 v149, v149, v30
 v_cvt_pk_bf16_f32 v26, v148, v149
 v_lshlrev_b32 v148, 16, v26
 v_and_b32 v149, 0xffff0000, v26
 v_add_f32 v148, v148, v68
 v_add_f32 v149, v149, v69
 v_cvt_pk_bf16_f32 v68, v148, v149
 v_cvt_pk_bf16_f32 v26, v150, v151
 v_lshlrev_b32 v150, 16, v26
 v_and_b32 v151, 0xffff0000, v26
 v_mul_f32 v150, v150, v30
 v_mul_f32 v151, v151, v30
 v_cvt_pk_bf16_f32 v26, v150, v151
 v_lshlrev_b32 v150, 16, v26
 v_and_b32 v151, 0xffff0000, v26
 v_add_f32 v150, v150, v70
 v_add_f32 v151, v151, v71
 v_cvt_pk_bf16_f32 v69, v150, v151
 buffer_store_dwordx2 v[68:69], v9, s[8:11], s22 offen offset:32
 s_waitcnt vmcnt(19)
 v_cvt_pk_bf16_f32 v26, v152, v153
 v_lshlrev_b32 v152, 16, v26
 v_and_b32 v153, 0xffff0000, v26
 v_mul_f32 v152, v152, v30
 v_mul_f32 v153, v153, v30
 v_cvt_pk_bf16_f32 v26, v152, v153
 v_lshlrev_b32 v152, 16, v26
 v_and_b32 v153, 0xffff0000, v26
 v_add_f32 v152, v152, v72
 v_add_f32 v153, v153, v73
 v_cvt_pk_bf16_f32 v72, v152, v153
 v_cvt_pk_bf16_f32 v26, v154, v155
 v_lshlrev_b32 v154, 16, v26
 v_and_b32 v155, 0xffff0000, v26
 v_mul_f32 v154, v154, v30
 v_mul_f32 v155, v155, v30
 v_cvt_pk_bf16_f32 v26, v154, v155
 v_lshlrev_b32 v154, 16, v26
 v_and_b32 v155, 0xffff0000, v26
 v_add_f32 v154, v154, v74
 v_add_f32 v155, v155, v75
 v_cvt_pk_bf16_f32 v73, v154, v155
 buffer_store_dwordx2 v[72:73], v9, s[8:11], s22 offen offset:64
 s_waitcnt vmcnt(19)
 v_cvt_pk_bf16_f32 v26, v156, v157
 v_lshlrev_b32 v156, 16, v26
 v_and_b32 v157, 0xffff0000, v26
 v_mul_f32 v156, v156, v30
 v_mul_f32 v157, v157, v30
 v_cvt_pk_bf16_f32 v26, v156, v157
 v_lshlrev_b32 v156, 16, v26
 v_and_b32 v157, 0xffff0000, v26
 v_add_f32 v156, v156, v76
 v_add_f32 v157, v157, v77
 v_cvt_pk_bf16_f32 v76, v156, v157
 v_cvt_pk_bf16_f32 v26, v158, v159
 v_lshlrev_b32 v158, 16, v26
 v_and_b32 v159, 0xffff0000, v26
 v_mul_f32 v158, v158, v30
 v_mul_f32 v159, v159, v30
 v_cvt_pk_bf16_f32 v26, v158, v159
 v_lshlrev_b32 v158, 16, v26
 v_and_b32 v159, 0xffff0000, v26
 v_add_f32 v158, v158, v78
 v_add_f32 v159, v159, v79
 v_cvt_pk_bf16_f32 v77, v158, v159
 buffer_store_dwordx2 v[76:77], v9, s[8:11], s22 offen offset:96
 s_waitcnt vmcnt(19)
 v_cvt_pk_bf16_f32 v26, v160, v161
 v_lshlrev_b32 v160, 16, v26
 v_and_b32 v161, 0xffff0000, v26
 v_mul_f32 v160, v160, v30
 v_mul_f32 v161, v161, v30
 v_cvt_pk_bf16_f32 v26, v160, v161
 v_lshlrev_b32 v160, 16, v26
 v_and_b32 v161, 0xffff0000, v26
 v_add_f32 v160, v160, v80
 v_add_f32 v161, v161, v81
 v_cvt_pk_bf16_f32 v80, v160, v161
 v_cvt_pk_bf16_f32 v26, v162, v163
 v_lshlrev_b32 v162, 16, v26
 v_and_b32 v163, 0xffff0000, v26
 v_mul_f32 v162, v162, v30
 v_mul_f32 v163, v163, v30
 v_cvt_pk_bf16_f32 v26, v162, v163
 v_lshlrev_b32 v162, 16, v26
 v_and_b32 v163, 0xffff0000, v26
 v_add_f32 v162, v162, v82
 v_add_f32 v163, v163, v83
 v_cvt_pk_bf16_f32 v81, v162, v163
 buffer_store_dwordx2 v[80:81], v9, s[8:11], s22 offen offset:128
 s_waitcnt vmcnt(19)
 v_cvt_pk_bf16_f32 v26, v164, v165
 v_lshlrev_b32 v164, 16, v26
 v_and_b32 v165, 0xffff0000, v26
 v_mul_f32 v164, v164, v30
 v_mul_f32 v165, v165, v30
 v_cvt_pk_bf16_f32 v26, v164, v165
 v_lshlrev_b32 v164, 16, v26
 v_and_b32 v165, 0xffff0000, v26
 v_add_f32 v164, v164, v84
 v_add_f32 v165, v165, v85
 v_cvt_pk_bf16_f32 v84, v164, v165
 v_cvt_pk_bf16_f32 v26, v166, v167
 v_lshlrev_b32 v166, 16, v26
 v_and_b32 v167, 0xffff0000, v26
 v_mul_f32 v166, v166, v30
 v_mul_f32 v167, v167, v30
 v_cvt_pk_bf16_f32 v26, v166, v167
 v_lshlrev_b32 v166, 16, v26
 v_and_b32 v167, 0xffff0000, v26
 v_add_f32 v166, v166, v86
 v_add_f32 v167, v167, v87
 v_cvt_pk_bf16_f32 v85, v166, v167
 buffer_store_dwordx2 v[84:85], v9, s[8:11], s22 offen offset:160
 s_waitcnt vmcnt(19)
 v_cvt_pk_bf16_f32 v26, v168, v169
 v_lshlrev_b32 v168, 16, v26
 v_and_b32 v169, 0xffff0000, v26
 v_mul_f32 v168, v168, v30
 v_mul_f32 v169, v169, v30
 v_cvt_pk_bf16_f32 v26, v168, v169
 v_lshlrev_b32 v168, 16, v26
 v_and_b32 v169, 0xffff0000, v26
 v_add_f32 v168, v168, v88
 v_add_f32 v169, v169, v89
 v_cvt_pk_bf16_f32 v88, v168, v169
 v_cvt_pk_bf16_f32 v26, v170, v171
 v_lshlrev_b32 v170, 16, v26
 v_and_b32 v171, 0xffff0000, v26
 v_mul_f32 v170, v170, v30
 v_mul_f32 v171, v171, v30
 v_cvt_pk_bf16_f32 v26, v170, v171
 v_lshlrev_b32 v170, 16, v26
 v_and_b32 v171, 0xffff0000, v26
 v_add_f32 v170, v170, v90
 v_add_f32 v171, v171, v91
 v_cvt_pk_bf16_f32 v89, v170, v171
 buffer_store_dwordx2 v[88:89], v9, s[8:11], s22 offen offset:192
 s_waitcnt vmcnt(19)
 v_cvt_pk_bf16_f32 v26, v172, v173
 v_lshlrev_b32 v172, 16, v26
 v_and_b32 v173, 0xffff0000, v26
 v_mul_f32 v172, v172, v30
 v_mul_f32 v173, v173, v30
 v_cvt_pk_bf16_f32 v26, v172, v173
 v_lshlrev_b32 v172, 16, v26
 v_and_b32 v173, 0xffff0000, v26
 v_add_f32 v172, v172, v92
 v_add_f32 v173, v173, v93
 v_cvt_pk_bf16_f32 v92, v172, v173
 v_cvt_pk_bf16_f32 v26, v174, v175
 v_lshlrev_b32 v174, 16, v26
 v_and_b32 v175, 0xffff0000, v26
 v_mul_f32 v174, v174, v30
 v_mul_f32 v175, v175, v30
 v_cvt_pk_bf16_f32 v26, v174, v175
 v_lshlrev_b32 v174, 16, v26
 v_and_b32 v175, 0xffff0000, v26
 v_add_f32 v174, v174, v94
 v_add_f32 v175, v175, v95
 v_cvt_pk_bf16_f32 v93, v174, v175
 buffer_store_dwordx2 v[92:93], v9, s[8:11], s22 offen offset:224
 s_waitcnt vmcnt(19)
 v_cvt_pk_bf16_f32 v26, v176, v177
 v_lshlrev_b32 v176, 16, v26
 v_and_b32 v177, 0xffff0000, v26
 v_mul_f32 v176, v176, v30
 v_mul_f32 v177, v177, v30
 v_cvt_pk_bf16_f32 v26, v176, v177
 v_lshlrev_b32 v176, 16, v26
 v_and_b32 v177, 0xffff0000, v26
 v_add_f32 v176, v176, v96
 v_add_f32 v177, v177, v97
 v_cvt_pk_bf16_f32 v96, v176, v177
 v_cvt_pk_bf16_f32 v26, v178, v179
 v_lshlrev_b32 v178, 16, v26
 v_and_b32 v179, 0xffff0000, v26
 v_mul_f32 v178, v178, v30
 v_mul_f32 v179, v179, v30
 v_cvt_pk_bf16_f32 v26, v178, v179
 v_lshlrev_b32 v178, 16, v26
 v_and_b32 v179, 0xffff0000, v26
 v_add_f32 v178, v178, v98
 v_add_f32 v179, v179, v99
 v_cvt_pk_bf16_f32 v97, v178, v179
 buffer_store_dwordx2 v[96:97], v9, s[8:11], s22 offen offset:256
 s_waitcnt vmcnt(19)
 v_cvt_pk_bf16_f32 v26, v180, v181
 v_lshlrev_b32 v180, 16, v26
 v_and_b32 v181, 0xffff0000, v26
 v_mul_f32 v180, v180, v30
 v_mul_f32 v181, v181, v30
 v_cvt_pk_bf16_f32 v26, v180, v181
 v_lshlrev_b32 v180, 16, v26
 v_and_b32 v181, 0xffff0000, v26
 v_add_f32 v180, v180, v100
 v_add_f32 v181, v181, v101
 v_cvt_pk_bf16_f32 v100, v180, v181
 v_cvt_pk_bf16_f32 v26, v182, v183
 v_lshlrev_b32 v182, 16, v26
 v_and_b32 v183, 0xffff0000, v26
 v_mul_f32 v182, v182, v30
 v_mul_f32 v183, v183, v30
 v_cvt_pk_bf16_f32 v26, v182, v183
 v_lshlrev_b32 v182, 16, v26
 v_and_b32 v183, 0xffff0000, v26
 v_add_f32 v182, v182, v102
 v_add_f32 v183, v183, v103
 v_cvt_pk_bf16_f32 v101, v182, v183
 buffer_store_dwordx2 v[100:101], v9, s[8:11], s22 offen offset:288
 s_waitcnt vmcnt(19)
 v_cvt_pk_bf16_f32 v26, v184, v185
 v_lshlrev_b32 v184, 16, v26
 v_and_b32 v185, 0xffff0000, v26
 v_mul_f32 v184, v184, v31
 v_mul_f32 v185, v185, v31
 v_cvt_pk_bf16_f32 v26, v184, v185
 v_lshlrev_b32 v184, 16, v26
 v_and_b32 v185, 0xffff0000, v26
 v_add_f32 v184, v184, v104
 v_add_f32 v185, v185, v105
 v_cvt_pk_bf16_f32 v104, v184, v185
 v_cvt_pk_bf16_f32 v26, v186, v187
 v_lshlrev_b32 v186, 16, v26
 v_and_b32 v187, 0xffff0000, v26
 v_mul_f32 v186, v186, v31
 v_mul_f32 v187, v187, v31
 v_cvt_pk_bf16_f32 v26, v186, v187
 v_lshlrev_b32 v186, 16, v26
 v_and_b32 v187, 0xffff0000, v26
 v_add_f32 v186, v186, v106
 v_add_f32 v187, v187, v107
 v_cvt_pk_bf16_f32 v105, v186, v187
 buffer_store_dwordx2 v[104:105], v9, s[8:11], s23 offen offset:0
 s_waitcnt vmcnt(19)
 v_cvt_pk_bf16_f32 v26, v188, v189
 v_lshlrev_b32 v188, 16, v26
 v_and_b32 v189, 0xffff0000, v26
 v_mul_f32 v188, v188, v31
 v_mul_f32 v189, v189, v31
 v_cvt_pk_bf16_f32 v26, v188, v189
 v_lshlrev_b32 v188, 16, v26
 v_and_b32 v189, 0xffff0000, v26
 v_add_f32 v188, v188, v108
 v_add_f32 v189, v189, v109
 v_cvt_pk_bf16_f32 v108, v188, v189
 v_cvt_pk_bf16_f32 v26, v190, v191
 v_lshlrev_b32 v190, 16, v26
 v_and_b32 v191, 0xffff0000, v26
 v_mul_f32 v190, v190, v31
 v_mul_f32 v191, v191, v31
 v_cvt_pk_bf16_f32 v26, v190, v191
 v_lshlrev_b32 v190, 16, v26
 v_and_b32 v191, 0xffff0000, v26
 v_add_f32 v190, v190, v110
 v_add_f32 v191, v191, v111
 v_cvt_pk_bf16_f32 v109, v190, v191
 buffer_store_dwordx2 v[108:109], v9, s[8:11], s23 offen offset:32
 s_waitcnt vmcnt(19)
 v_cvt_pk_bf16_f32 v26, v192, v193
 v_lshlrev_b32 v192, 16, v26
 v_and_b32 v193, 0xffff0000, v26
 v_mul_f32 v192, v192, v31
 v_mul_f32 v193, v193, v31
 v_cvt_pk_bf16_f32 v26, v192, v193
 v_lshlrev_b32 v192, 16, v26
 v_and_b32 v193, 0xffff0000, v26
 v_add_f32 v192, v192, v112
 v_add_f32 v193, v193, v113
 v_cvt_pk_bf16_f32 v112, v192, v193
 v_cvt_pk_bf16_f32 v26, v194, v195
 v_lshlrev_b32 v194, 16, v26
 v_and_b32 v195, 0xffff0000, v26
 v_mul_f32 v194, v194, v31
 v_mul_f32 v195, v195, v31
 v_cvt_pk_bf16_f32 v26, v194, v195
 v_lshlrev_b32 v194, 16, v26
 v_and_b32 v195, 0xffff0000, v26
 v_add_f32 v194, v194, v114
 v_add_f32 v195, v195, v115
 v_cvt_pk_bf16_f32 v113, v194, v195
 buffer_store_dwordx2 v[112:113], v9, s[8:11], s23 offen offset:64
 s_waitcnt vmcnt(19)
 v_cvt_pk_bf16_f32 v26, v196, v197
 v_lshlrev_b32 v196, 16, v26
 v_and_b32 v197, 0xffff0000, v26
 v_mul_f32 v196, v196, v31
 v_mul_f32 v197, v197, v31
 v_cvt_pk_bf16_f32 v26, v196, v197
 v_lshlrev_b32 v196, 16, v26
 v_and_b32 v197, 0xffff0000, v26
 v_add_f32 v196, v196, v116
 v_add_f32 v197, v197, v117
 v_cvt_pk_bf16_f32 v116, v196, v197
 v_cvt_pk_bf16_f32 v26, v198, v199
 v_lshlrev_b32 v198, 16, v26
 v_and_b32 v199, 0xffff0000, v26
 v_mul_f32 v198, v198, v31
 v_mul_f32 v199, v199, v31
 v_cvt_pk_bf16_f32 v26, v198, v199
 v_lshlrev_b32 v198, 16, v26
 v_and_b32 v199, 0xffff0000, v26
 v_add_f32 v198, v198, v118
 v_add_f32 v199, v199, v119
 v_cvt_pk_bf16_f32 v117, v198, v199
 buffer_store_dwordx2 v[116:117], v9, s[8:11], s23 offen offset:96
 s_waitcnt vmcnt(19)
 v_cvt_pk_bf16_f32 v26, v200, v201
 v_lshlrev_b32 v200, 16, v26
 v_and_b32 v201, 0xffff0000, v26
 v_mul_f32 v200, v200, v31
 v_mul_f32 v201, v201, v31
 v_cvt_pk_bf16_f32 v26, v200, v201
 v_lshlrev_b32 v200, 16, v26
 v_and_b32 v201, 0xffff0000, v26
 v_add_f32 v200, v200, v120
 v_add_f32 v201, v201, v121
 v_cvt_pk_bf16_f32 v120, v200, v201
 v_cvt_pk_bf16_f32 v26, v202, v203
 v_lshlrev_b32 v202, 16, v26
 v_and_b32 v203, 0xffff0000, v26
 v_mul_f32 v202, v202, v31
 v_mul_f32 v203, v203, v31
 v_cvt_pk_bf16_f32 v26, v202, v203
 v_lshlrev_b32 v202, 16, v26
 v_and_b32 v203, 0xffff0000, v26
 v_add_f32 v202, v202, v122
 v_add_f32 v203, v203, v123
 v_cvt_pk_bf16_f32 v121, v202, v203
 buffer_store_dwordx2 v[120:121], v9, s[8:11], s23 offen offset:128
 s_waitcnt vmcnt(19)
 v_cvt_pk_bf16_f32 v26, v204, v205
 v_lshlrev_b32 v204, 16, v26
 v_and_b32 v205, 0xffff0000, v26
 v_mul_f32 v204, v204, v31
 v_mul_f32 v205, v205, v31
 v_cvt_pk_bf16_f32 v26, v204, v205
 v_lshlrev_b32 v204, 16, v26
 v_and_b32 v205, 0xffff0000, v26
 v_add_f32 v204, v204, v124
 v_add_f32 v205, v205, v125
 v_cvt_pk_bf16_f32 v124, v204, v205
 v_cvt_pk_bf16_f32 v26, v206, v207
 v_lshlrev_b32 v206, 16, v26
 v_and_b32 v207, 0xffff0000, v26
 v_mul_f32 v206, v206, v31
 v_mul_f32 v207, v207, v31
 v_cvt_pk_bf16_f32 v26, v206, v207
 v_lshlrev_b32 v206, 16, v26
 v_and_b32 v207, 0xffff0000, v26
 v_add_f32 v206, v206, v126
 v_add_f32 v207, v207, v127
 v_cvt_pk_bf16_f32 v125, v206, v207
 buffer_store_dwordx2 v[124:125], v9, s[8:11], s23 offen offset:160
 s_waitcnt vmcnt(19)
 v_cvt_pk_bf16_f32 v26, v208, v209
 v_lshlrev_b32 v208, 16, v26
 v_and_b32 v209, 0xffff0000, v26
 v_mul_f32 v208, v208, v31
 v_mul_f32 v209, v209, v31
 v_cvt_pk_bf16_f32 v26, v208, v209
 v_lshlrev_b32 v208, 16, v26
 v_and_b32 v209, 0xffff0000, v26
 v_add_f32 v208, v208, v128
 v_add_f32 v209, v209, v129
 v_cvt_pk_bf16_f32 v128, v208, v209
 v_cvt_pk_bf16_f32 v26, v210, v211
 v_lshlrev_b32 v210, 16, v26
 v_and_b32 v211, 0xffff0000, v26
 v_mul_f32 v210, v210, v31
 v_mul_f32 v211, v211, v31
 v_cvt_pk_bf16_f32 v26, v210, v211
 v_lshlrev_b32 v210, 16, v26
 v_and_b32 v211, 0xffff0000, v26
 v_add_f32 v210, v210, v130
 v_add_f32 v211, v211, v131
 v_cvt_pk_bf16_f32 v129, v210, v211
 buffer_store_dwordx2 v[128:129], v9, s[8:11], s23 offen offset:192
 s_waitcnt vmcnt(19)
 v_cvt_pk_bf16_f32 v26, v212, v213
 v_lshlrev_b32 v212, 16, v26
 v_and_b32 v213, 0xffff0000, v26
 v_mul_f32 v212, v212, v31
 v_mul_f32 v213, v213, v31
 v_cvt_pk_bf16_f32 v26, v212, v213
 v_lshlrev_b32 v212, 16, v26
 v_and_b32 v213, 0xffff0000, v26
 v_add_f32 v212, v212, v132
 v_add_f32 v213, v213, v133
 v_cvt_pk_bf16_f32 v132, v212, v213
 v_cvt_pk_bf16_f32 v26, v214, v215
 v_lshlrev_b32 v214, 16, v26
 v_and_b32 v215, 0xffff0000, v26
 v_mul_f32 v214, v214, v31
 v_mul_f32 v215, v215, v31
 v_cvt_pk_bf16_f32 v26, v214, v215
 v_lshlrev_b32 v214, 16, v26
 v_and_b32 v215, 0xffff0000, v26
 v_add_f32 v214, v214, v134
 v_add_f32 v215, v215, v135
 v_cvt_pk_bf16_f32 v133, v214, v215
 buffer_store_dwordx2 v[132:133], v9, s[8:11], s23 offen offset:224
 s_waitcnt vmcnt(19)
 v_cvt_pk_bf16_f32 v26, v216, v217
 v_lshlrev_b32 v216, 16, v26
 v_and_b32 v217, 0xffff0000, v26
 v_mul_f32 v216, v216, v31
 v_mul_f32 v217, v217, v31
 v_cvt_pk_bf16_f32 v26, v216, v217
 v_lshlrev_b32 v216, 16, v26
 v_and_b32 v217, 0xffff0000, v26
 v_add_f32 v216, v216, v136
 v_add_f32 v217, v217, v137
 v_cvt_pk_bf16_f32 v136, v216, v217
 v_cvt_pk_bf16_f32 v26, v218, v219
 v_lshlrev_b32 v218, 16, v26
 v_and_b32 v219, 0xffff0000, v26
 v_mul_f32 v218, v218, v31
 v_mul_f32 v219, v219, v31
 v_cvt_pk_bf16_f32 v26, v218, v219
 v_lshlrev_b32 v218, 16, v26
 v_and_b32 v219, 0xffff0000, v26
 v_add_f32 v218, v218, v138
 v_add_f32 v219, v219, v139
 v_cvt_pk_bf16_f32 v137, v218, v219
 buffer_store_dwordx2 v[136:137], v9, s[8:11], s23 offen offset:256
 s_waitcnt vmcnt(19)
 v_cvt_pk_bf16_f32 v26, v220, v221
 v_lshlrev_b32 v220, 16, v26
 v_and_b32 v221, 0xffff0000, v26
 v_mul_f32 v220, v220, v31
 v_mul_f32 v221, v221, v31
 v_cvt_pk_bf16_f32 v26, v220, v221
 v_lshlrev_b32 v220, 16, v26
 v_and_b32 v221, 0xffff0000, v26
 v_add_f32 v220, v220, v140
 v_add_f32 v221, v221, v141
 v_cvt_pk_bf16_f32 v140, v220, v221
 v_cvt_pk_bf16_f32 v26, v222, v223
 v_lshlrev_b32 v222, 16, v26
 v_and_b32 v223, 0xffff0000, v26
 v_mul_f32 v222, v222, v31
 v_mul_f32 v223, v223, v31
 v_cvt_pk_bf16_f32 v26, v222, v223
 v_lshlrev_b32 v222, 16, v26
 v_and_b32 v223, 0xffff0000, v26
 v_add_f32 v222, v222, v142
 v_add_f32 v223, v223, v143
 v_cvt_pk_bf16_f32 v141, v222, v223
 buffer_store_dwordx2 v[140:141], v9, s[8:11], s23 offen offset:288
om_242:
 s_waitcnt vmcnt(0) lgkmcnt(0)
 s_barrier
 s_sub_u32 s21, s2, 16
 s_cmp_ge_u32 s2, 48
 s_cbranch_scc1 do_opb2
 s_cmp_eq_u32 s87, -1
 s_cbranch_scc1 queue
tail_item:
 s_load_dwordx2 s[4:5], s[0:1], 96
 s_waitcnt lgkmcnt(0)
 s_mov_b32 s32, s4
 s_mov_b32 s33, s5
 s_mov_b32 s34, 256
 s_mov_b32 s35, 0x00020000
 s_waitcnt vmcnt(0)
 s_barrier
 s_mov_b32 s21, s87
do_pv:
 s_mov_b32 s2, s21
 s_load_dwordx2 s[4:5], s[0:1], 88
 s_load_dwordx2 s[38:39], s[0:1], 104
 s_waitcnt lgkmcnt(0)
 s_mov_b32 s8, s4
 s_mov_b32 s9, s5
 s_mov_b32 s10, 2621440
 s_mov_b32 s11, 0x00020000
 s_add_u32 s12, s38, 88080384
 s_addc_u32 s13, s39, 0
 s_mov_b32 s14, 83886080
 s_mov_b32 s15, 0x00020000
 s_mov_b32 s59, 0
 s_mov_b32 s60, 0
 s_add_u32 s16, s38, 180355072
 s_addc_u32 s17, s39, 0
 s_mov_b32 s18, 67108864
 s_mov_b32 s19, 0x00020000
 s_add_u32 s24, s38, 180355072
 s_addc_u32 s25, s39, 0
 s_mov_b32 s26, 67108864
 s_mov_b32 s27, 0x00020000
 s_add_u32 s28, s38, 81002496
 s_addc_u32 s29, s39, 0
 s_mov_b32 s30, 8192
 s_mov_b32 s31, 0x00020000
 s_add_u32 s72, s38, 81068032
 s_addc_u32 s73, s39, 0
 s_mov_b32 s74, 129024
 s_mov_b32 s75, 0x00020000
 v_lshlrev_b32 v4, 4, v1
 v_lshlrev_b32 v5, 3, v1
 v_lshlrev_b32 v6, 2, v2
 v_and_b32 v7, 7, v1
 v_lshlrev_b32 v7, 7, v7
 v_lshrrev_b32 v31, 3, v1
 v_lshl_add_u32 v208, v31, 10, v7
 v_bfe_u32 v31, v1, 3, 2
 v_lshl_add_u32 v31, v31, 12, v7
 s_lshl_b32 s21, s20, 10
 s_add_u32 s21, s21, 95232
 buffer_load_dword v8, v31, s[72:75], s21 offen sc1
 v_lshlrev_b32 v25, 7, v2
 s_mov_b32 s21, 93184
 buffer_load_dword v26, v25, s[72:75], s21 offen sc1
 s_mov_b32 s63, 1
 v_mul_u32_u24 v9, 1280, v2
 v_lshl_add_u32 v9, v3, 3, v9
 s_lshl_b32 s21, s20, 13
 v_add_u32 v10, s21, v4
 s_lshl_b32 s21, s20, 10
 v_add_u32 v11, s21, v4
 v_lshrrev_b32 v20, 5, v1
 v_mul_u32_u24 v21, 2560, v20
 v_add_u32 v21, v21, v4
 v_and_b32 v22, 31, v1
 v_lshlrev_b32 v22, 4, v22
 v_mul_u32_u24 v20, 10240, v20
 v_add_u32 v22, v22, v20
 v_mul_u32_u24 v21, 2048, v3
 v_lshl_add_u32 v21, v2, 4, v21
 v_mul_u32_u24 v22, 1024, v3
 v_lshl_add_u32 v22, v2, 4, v22
 v_mov_b32 v28, 80
 v_mov_b32 v30, 32768
 s_mov_b32 s50, 0
 s_mov_b32 s71, 0
 s_mov_b32 s51, 0
 s_and_b32 s43, s20, 1
 s_lshr_b32 s44, s20, 1
 v_mov_b32 v70, 0
 v_mov_b32 v71, 0
 v_mov_b32 v78, 0
 v_mov_b32 v79, 0
 v_mov_b32 v86, 0
 v_mov_b32 v87, 0
 v_mov_b32 v94, 0
 v_mov_b32 v95, 0
 v_mov_b32 v102, 0
 v_mov_b32 v103, 0
 v_mov_b32 v110, 0
 v_mov_b32 v111, 0
 v_mov_b32 v118, 0
 v_mov_b32 v119, 0
 v_mov_b32 v126, 0
 v_mov_b32 v127, 0
 s_mov_b32 s21, s2
pv_loop:
 s_mul_i32 s2, s21, 2
 s_add_u32 s2, s2, 192
 s_add_u32 s22, s21, 356
 s_cmp_lt_u32 s21, 164
 s_cselect_b32 s2, s2, s22
 s_cselect_b32 s65, 1, 0
 s_mul_i32 s22, s21, 5
 s_cmp_lt_u32 s21, 64
 s_cselect_b32 s2, s22, s2
 s_cselect_b32 s65, 4, s65
 s_mul_hi_u32 s40, s2, 0x1999999a
 s_mul_i32 s21, s40, 10
 s_sub_u32 s41, s2, s21
 s_lshl_b32 s52, s40, 10
 s_add_u32 s52, s52, 23552
 buffer_load_dword v27, v7, s[72:75], s52 offen sc1
 s_cmp_lg_u32 s20, 0
 s_cbranch_scc1 pv_254
 s_sub_u32 s21, s2, 0
 s_cmp_lt_u32 s21, 640
 s_cbranch_scc1 pv_254
 v_mov_b32 v29, 1
 s_mov_b64 exec, 1
 buffer_atomic_add v29, v28, s[32:35], 0 offen sc0 sc1
 s_mov_b64 exec, -1
pv_254:
 s_lshl_b32 s42, s40, 5
 s_lshl_b32 s21, s20, 3
 s_add_u32 s42, s42, s21
 s_lshr_b32 s22, s40, 1
 s_bitcmp1_b32 s37, s22
 s_cselect_b32 s22, 8192, 0
 s_lshl_b32 s62, s40, 20
 s_or_b32 s62, s62, s22
 s_cmp_ge_u32 s40, 40
 s_cselect_b32 s61, 8192, 0
 s_xor_b32 s61, s61, s62
 s_mul_i32 s53, s42, 40960
 s_lshl_b32 s22, s41, 12
 s_add_u32 s53, s53, s22
 s_lshl_b32 s21, s40, 1
 s_add_u32 s21, s21, s43
 s_lshl_b32 s45, s21, 6
 s_mul_i32 s46, s21, 20480
 s_lshl_b32 s21, s41, 4
 s_lshl_b32 s22, s43, 2
 s_add_u32 s21, s21, s22
 s_add_u32 s21, s21, s44
 s_lshl_b32 s54, s21, 10
 s_add_u32 s54, s54, s62
 s_add_u32 s54, s54, 786432
 s_lshl_b32 s22, s41, 2
 s_add_u32 s22, s22, s44
 s_lshl_b32 s22, s22, 5
 s_add_u32 s46, s46, s22
 s_lshl_b32 s47, s20, 15
 s_add_u32 s47, s47, s62
 s_add_u32 s47, s47, 655360
 s_lshl_b32 s48, s41, 16
 s_lshl_b32 s22, s20, 14
 s_add_u32 s48, s48, s22
 s_add_u32 s48, s48, s61
 s_add_u32 s23, s40, 1
 s_cmp_ge_u32 s50, s23
 s_cbranch_scc1 pv_247
 s_cmp_eq_u32 s63, 0
 s_cbranch_scc1 pv_250
 s_mov_b32 s63, 0
 s_waitcnt vmcnt(1)
 v_cmp_le_u32 vcc, 4, v26
 s_mov_b32 s51, vcc_lo
 v_cmp_gt_u32 vcc, s23, v8
 s_nop 1
 s_cbranch_vccz pv_251
pv_250:
 s_lshl_b32 s21, s20, 10
 s_add_u32 s21, s21, 95232
 s_mov_b32 s101, 0
wm_255:
 buffer_load_dword v8, v31, s[72:75], s21 offen sc1
 s_add_u32 s101, s101, 1
 s_cmp_gt_u32 s101, 131072
 s_cbranch_scc1 main_end
 s_waitcnt vmcnt(0)
 v_cmp_gt_u32 vcc, s23, v8
 v_readfirstlane_b32 s100, v8
 s_nop 0
 s_cbranch_vccz wm_256
 s_sleep 8
 s_add_u32 s100, s100, 2
 s_cmp_ge_u32 s100, s23
 s_cbranch_scc1 wm_255
 s_sleep 60
 s_branch wm_255
wm_256:
pv_251:
 v_readlane_b32 s50, v8, 0
 v_readlane_b32 s21, v8, 1
 s_min_u32 s50, s50, s21
 v_readlane_b32 s21, v8, 2
 s_min_u32 s50, s50, s21
 v_readlane_b32 s21, v8, 3
 s_min_u32 s50, s50, s21
 v_readlane_b32 s21, v8, 4
 s_min_u32 s50, s50, s21
 v_readlane_b32 s21, v8, 5
 s_min_u32 s50, s50, s21
 v_readlane_b32 s21, v8, 6
 s_min_u32 s50, s50, s21
 v_readlane_b32 s21, v8, 7
 s_min_u32 s50, s50, s21
 v_readlane_b32 s21, v8, 8
 s_min_u32 s50, s50, s21
 v_readlane_b32 s21, v8, 9
 s_min_u32 s50, s50, s21
 v_readlane_b32 s21, v8, 10
 s_min_u32 s50, s50, s21
 v_readlane_b32 s21, v8, 11
 s_min_u32 s50, s50, s21
 v_readlane_b32 s21, v8, 12
 s_min_u32 s50, s50, s21
 v_readlane_b32 s21, v8, 13
 s_min_u32 s50, s50, s21
 v_readlane_b32 s21, v8, 14
 s_min_u32 s50, s50, s21
 v_readlane_b32 s21, v8, 15
 s_min_u32 s50, s50, s21
 v_readlane_b32 s21, v8, 16
 s_min_u32 s50, s50, s21
 v_readlane_b32 s21, v8, 17
 s_min_u32 s50, s50, s21
 v_readlane_b32 s21, v8, 18
 s_min_u32 s50, s50, s21
 v_readlane_b32 s21, v8, 19
 s_min_u32 s50, s50, s21
 v_readlane_b32 s21, v8, 20
 s_min_u32 s50, s50, s21
 v_readlane_b32 s21, v8, 21
 s_min_u32 s50, s50, s21
 v_readlane_b32 s21, v8, 22
 s_min_u32 s50, s50, s21
 v_readlane_b32 s21, v8, 23
 s_min_u32 s50, s50, s21
 v_readlane_b32 s21, v8, 24
 s_min_u32 s50, s50, s21
 v_readlane_b32 s21, v8, 25
 s_min_u32 s50, s50, s21
 v_readlane_b32 s21, v8, 26
 s_min_u32 s50, s50, s21
 v_readlane_b32 s21, v8, 27
 s_min_u32 s50, s50, s21
 v_readlane_b32 s21, v8, 28
 s_min_u32 s50, s50, s21
 v_readlane_b32 s21, v8, 29
 s_min_u32 s50, s50, s21
 v_readlane_b32 s21, v8, 30
 s_min_u32 s50, s50, s21
 v_readlane_b32 s21, v8, 31
 s_min_u32 s50, s50, s21
pv_247:
 s_lshr_b32 s22, s40, 2
 s_cmp_lt_u32 s40, 48
 s_cbranch_scc1 pv_248
 s_bitcmp1_b32 s51, s22
 s_cbranch_scc1 pv_248
 s_mov_b32 s21, 93184
 v_lshlrev_b32 v25, 7, v2
 s_mov_b32 s101, 0
pv_249:
 buffer_load_dword v26, v25, s[72:75], s21 offen sc1
 s_add_u32 s101, s101, 1
 s_cmp_gt_u32 s101, 131072
 s_cbranch_scc1 main_end
 s_waitcnt vmcnt(0)
 v_cmp_le_u32 vcc, 4, v26
 s_mov_b32 s51, vcc_lo
 s_bitcmp1_b32 s51, s22
 s_cbranch_scc1 pv_248
 s_sleep 8
 s_branch pv_249
pv_248:
 buffer_load_dwordx4 a[0:3], v4, s[12:15], s53 offen offset:0 sc1
 buffer_load_dwordx4 a[4:7], v4, s[12:15], s53 offen offset:1024 sc1
 buffer_load_dwordx4 a[8:11], v4, s[12:15], s53 offen offset:2048 sc1
 buffer_load_dwordx4 a[12:15], v4, s[12:15], s53 offen offset:3072 sc1
 s_add_u32 s53, s53, 40960
 buffer_load_dwordx4 a[16:19], v4, s[12:15], s53 offen offset:0 sc1
 buffer_load_dwordx4 a[20:23], v4, s[12:15], s53 offen offset:1024 sc1
 buffer_load_dwordx4 a[24:27], v4, s[12:15], s53 offen offset:2048 sc1
 buffer_load_dwordx4 a[28:31], v4, s[12:15], s53 offen offset:3072 sc1
 s_add_u32 s53, s53, 40960
 buffer_load_dwordx4 a[32:35], v4, s[12:15], s53 offen offset:0 sc1
 buffer_load_dwordx4 a[36:39], v4, s[12:15], s53 offen offset:1024 sc1
 buffer_load_dwordx4 a[40:43], v4, s[12:15], s53 offen offset:2048 sc1
 buffer_load_dwordx4 a[44:47], v4, s[12:15], s53 offen offset:3072 sc1
 s_add_u32 s53, s53, 40960
 buffer_load_dwordx4 a[48:51], v4, s[12:15], s53 offen offset:0 sc1
 buffer_load_dwordx4 a[52:55], v4, s[12:15], s53 offen offset:1024 sc1
 buffer_load_dwordx4 a[56:59], v4, s[12:15], s53 offen offset:2048 sc1
 buffer_load_dwordx4 a[60:63], v4, s[12:15], s53 offen offset:3072 sc1
 s_add_u32 s53, s53, 40960
 buffer_load_dwordx4 a[64:67], v4, s[12:15], s53 offen offset:0 sc1
 buffer_load_dwordx4 a[68:71], v4, s[12:15], s53 offen offset:1024 sc1
 buffer_load_dwordx4 a[72:75], v4, s[12:15], s53 offen offset:2048 sc1
 buffer_load_dwordx4 a[76:79], v4, s[12:15], s53 offen offset:3072 sc1
 s_add_u32 s53, s53, 40960
 buffer_load_dwordx4 a[80:83], v4, s[12:15], s53 offen offset:0 sc1
 buffer_load_dwordx4 a[84:87], v4, s[12:15], s53 offen offset:1024 sc1
 buffer_load_dwordx4 a[88:91], v4, s[12:15], s53 offen offset:2048 sc1
 buffer_load_dwordx4 a[92:95], v4, s[12:15], s53 offen offset:3072 sc1
 s_add_u32 s53, s53, 40960
 buffer_load_dwordx4 a[96:99], v4, s[12:15], s53 offen offset:0 sc1
 buffer_load_dwordx4 a[100:103], v4, s[12:15], s53 offen offset:1024 sc1
 buffer_load_dwordx4 a[104:107], v4, s[12:15], s53 offen offset:2048 sc1
 buffer_load_dwordx4 a[108:111], v4, s[12:15], s53 offen offset:3072 sc1
 s_add_u32 s53, s53, 40960
 buffer_load_dwordx4 a[112:115], v4, s[12:15], s53 offen offset:0 sc1
 buffer_load_dwordx4 a[116:119], v4, s[12:15], s53 offen offset:1024 sc1
 buffer_load_dwordx4 a[120:123], v4, s[12:15], s53 offen offset:2048 sc1
 buffer_load_dwordx4 a[124:127], v4, s[12:15], s53 offen offset:3072 sc1
 s_cmp_lt_u32 s40, 48
 s_cselect_b32 s70, 0x80000000, s54
 buffer_load_dwordx4 v[12:15], v4, s[24:27], s70 offen sc1
 buffer_load_dwordx4 v[16:19], v4, s[24:27], s70 offen offset:2048 sc1
 buffer_load_dword v24, v6, s[28:31], s45 offen sc1
 s_waitcnt vmcnt(35)
 s_cmp_eq_u32 s71, 0
 s_cbranch_scc1 paf_259
 v_mov_b32 v25, 0
 v_mov_b32 v26, 1
 s_mov_b64 exec, 1
 buffer_atomic_add v26, v25, s[72:75], s71 offen sc1
 s_mov_b64 exec, -1
 s_mov_b32 s71, 0
paf_259:
 v_cmp_le_u32 s[68:69], 4, v27
 s_nop 1
 s_and_b32 s21, s68, 255
 s_cmp_lg_u32 s21, 255
 s_cbranch_scc1 pvw_252
 s_mov_b32 s56, s47
 s_mov_b32 s57, s48
 buffer_load_dwordx4 v[64:67], v4, s[16:19], s56 offen sc1
 buffer_load_dwordx2 v[68:69], v5, s[16:19], s56 offen offset:1536 sc1
 buffer_load_dwordx4 v[128:131], v21, s[16:19], s56 offen offset:1024 sc1
 buffer_load_dwordx4 v[132:135], v21, s[16:19], s56 offen offset:1280 sc1
 s_add_u32 s56, s56, 2048
 buffer_load_dwordx4 v[72:75], v4, s[16:19], s56 offen sc1
 buffer_load_dwordx2 v[76:77], v5, s[16:19], s56 offen offset:1536 sc1
 s_add_u32 s56, s56, 2048
 buffer_load_dwordx4 v[80:83], v4, s[16:19], s56 offen sc1
 buffer_load_dwordx2 v[84:85], v5, s[16:19], s56 offen offset:1536 sc1
 s_add_u32 s56, s56, 2048
 buffer_load_dwordx4 v[88:91], v4, s[16:19], s56 offen sc1
 buffer_load_dwordx2 v[92:93], v5, s[16:19], s56 offen offset:1536 sc1
 s_add_u32 s56, s56, 10240
 buffer_load_dwordx4 v[32:35], v22, s[16:19], s57 offen offset:0 sc1
 buffer_load_dwordx4 v[36:39], v22, s[16:19], s57 offen offset:256 sc1
 buffer_load_dwordx4 v[40:43], v22, s[16:19], s57 offen offset:512 sc1
 buffer_load_dwordx4 v[44:47], v22, s[16:19], s57 offen offset:768 sc1
 s_add_u32 s57, s57, 4096
 buffer_load_dwordx4 v[96:99], v4, s[16:19], s56 offen sc1
 buffer_load_dwordx2 v[100:101], v5, s[16:19], s56 offen offset:1536 sc1
 buffer_load_dwordx4 v[136:139], v21, s[16:19], s56 offen offset:1024 sc1
 buffer_load_dwordx4 v[140:143], v21, s[16:19], s56 offen offset:1280 sc1
 s_add_u32 s56, s56, 2048
 buffer_load_dwordx4 v[104:107], v4, s[16:19], s56 offen sc1
 buffer_load_dwordx2 v[108:109], v5, s[16:19], s56 offen offset:1536 sc1
 s_add_u32 s56, s56, 2048
 buffer_load_dwordx4 v[112:115], v4, s[16:19], s56 offen sc1
 buffer_load_dwordx2 v[116:117], v5, s[16:19], s56 offen offset:1536 sc1
 s_add_u32 s56, s56, 2048
 buffer_load_dwordx4 v[120:123], v4, s[16:19], s56 offen sc1
 buffer_load_dwordx2 v[124:125], v5, s[16:19], s56 offen offset:1536 sc1
 s_add_u32 s56, s56, 10240
 buffer_load_dwordx4 v[48:51], v22, s[16:19], s57 offen offset:0 sc1
 buffer_load_dwordx4 v[52:55], v22, s[16:19], s57 offen offset:256 sc1
 buffer_load_dwordx4 v[56:59], v22, s[16:19], s57 offen offset:512 sc1
 buffer_load_dwordx4 v[60:63], v22, s[16:19], s57 offen offset:768 sc1
 s_add_u32 s57, s57, 4096
 s_barrier
 s_waitcnt vmcnt(28)
 v_sub_f32 v25, 1.0, v24
 v_cvt_pk_bf16_f32 v26, v25, v25
 v_lshlrev_b32 v25, 16, v26
 v_cvt_pk_bf16_f32 v26, v12, v12
 v_lshlrev_b32 v12, 16, v26
 v_cvt_pk_bf16_f32 v26, v13, v13
 v_lshlrev_b32 v13, 16, v26
 v_cvt_pk_bf16_f32 v26, v14, v14
 v_lshlrev_b32 v14, 16, v26
 v_cvt_pk_bf16_f32 v26, v15, v15
 v_lshlrev_b32 v15, 16, v26
 v_cvt_pk_bf16_f32 v26, v16, v16
 v_lshlrev_b32 v16, 16, v26
 v_cvt_pk_bf16_f32 v26, v17, v17
 v_lshlrev_b32 v17, 16, v26
 v_cvt_pk_bf16_f32 v26, v18, v18
 v_lshlrev_b32 v18, 16, v26
 v_cvt_pk_bf16_f32 v26, v19, v19
 v_lshlrev_b32 v19, 16, v26
 v_mul_f32 v12, v12, v25
 v_cvt_pk_bf16_f32 v26, v12, v12
 v_lshlrev_b32 v12, 16, v26
 v_mul_f32 v13, v13, v25
 v_cvt_pk_bf16_f32 v26, v13, v13
 v_lshlrev_b32 v13, 16, v26
 v_mul_f32 v14, v14, v25
 v_cvt_pk_bf16_f32 v26, v14, v14
 v_lshlrev_b32 v14, 16, v26
 v_mul_f32 v15, v15, v25
 v_cvt_pk_bf16_f32 v26, v15, v15
 v_lshlrev_b32 v15, 16, v26
 v_mul_f32 v16, v16, v25
 v_cvt_pk_bf16_f32 v26, v16, v16
 v_lshlrev_b32 v16, 16, v26
 v_mul_f32 v17, v17, v25
 v_cvt_pk_bf16_f32 v26, v17, v17
 v_lshlrev_b32 v17, 16, v26
 v_mul_f32 v18, v18, v25
 v_cvt_pk_bf16_f32 v26, v18, v18
 v_lshlrev_b32 v18, 16, v26
 v_mul_f32 v19, v19, v25
 v_cvt_pk_bf16_f32 v26, v19, v19
 v_lshlrev_b32 v19, 16, v26
 s_cmp_ge_u32 s40, 52
 s_cbranch_scc1 pvc_258
 s_branch pvg_257
pvw_252:
 s_waitcnt vmcnt(0)
 v_sub_f32 v25, 1.0, v24
 v_cvt_pk_bf16_f32 v26, v25, v25
 v_lshlrev_b32 v25, 16, v26
 v_cvt_pk_bf16_f32 v26, v12, v12
 v_lshlrev_b32 v12, 16, v26
 v_cvt_pk_bf16_f32 v26, v13, v13
 v_lshlrev_b32 v13, 16, v26
 v_cvt_pk_bf16_f32 v26, v14, v14
 v_lshlrev_b32 v14, 16, v26
 v_cvt_pk_bf16_f32 v26, v15, v15
 v_lshlrev_b32 v15, 16, v26
 v_cvt_pk_bf16_f32 v26, v16, v16
 v_lshlrev_b32 v16, 16, v26
 v_cvt_pk_bf16_f32 v26, v17, v17
 v_lshlrev_b32 v17, 16, v26
 v_cvt_pk_bf16_f32 v26, v18, v18
 v_lshlrev_b32 v18, 16, v26
 v_cvt_pk_bf16_f32 v26, v19, v19
 v_lshlrev_b32 v19, 16, v26
 v_mul_f32 v12, v12, v25
 v_cvt_pk_bf16_f32 v26, v12, v12
 v_lshlrev_b32 v12, 16, v26
 v_mul_f32 v13, v13, v25
 v_cvt_pk_bf16_f32 v26, v13, v13
 v_lshlrev_b32 v13, 16, v26
 v_mul_f32 v14, v14, v25
 v_cvt_pk_bf16_f32 v26, v14, v14
 v_lshlrev_b32 v14, 16, v26
 v_mul_f32 v15, v15, v25
 v_cvt_pk_bf16_f32 v26, v15, v15
 v_lshlrev_b32 v15, 16, v26
 v_mul_f32 v16, v16, v25
 v_cvt_pk_bf16_f32 v26, v16, v16
 v_lshlrev_b32 v16, 16, v26
 v_mul_f32 v17, v17, v25
 v_cvt_pk_bf16_f32 v26, v17, v17
 v_lshlrev_b32 v17, 16, v26
 v_mul_f32 v18, v18, v25
 v_cvt_pk_bf16_f32 v26, v18, v18
 v_lshlrev_b32 v18, 16, v26
 v_mul_f32 v19, v19, v25
 v_cvt_pk_bf16_f32 v26, v19, v19
 v_lshlrev_b32 v19, 16, v26
 s_cmp_ge_u32 s40, 52
 s_cbranch_scc1 pvt_260
 s_cmp_lg_u32 s20, 0
 s_cbranch_scc1 wm_262
 s_mov_b32 s101, 0
wm_261:
 buffer_load_dword v26, v7, s[72:75], s52 offen sc1
 s_add_u32 s101, s101, 1
 s_cmp_gt_u32 s101, 131072
 s_cbranch_scc1 main_end
 s_waitcnt vmcnt(0)
 v_cmp_gt_u32 vcc, 4, v26
 v_readfirstlane_b32 s100, v26
 s_nop 0
 s_cbranch_vccz wm_262
 s_sleep 2
 s_add_u32 s100, s100, 3
 s_cmp_ge_u32 s100, 4
 s_cbranch_scc1 wm_261
 s_sleep 24
 s_branch wm_261
wm_262:
 s_barrier
 buffer_load_dwordx4 v[64:67], v4, s[16:19], s47 offen sc1
 buffer_load_dwordx2 v[68:69], v5, s[16:19], s47 offen offset:1536 sc1
 buffer_load_dwordx4 v[128:131], v21, s[16:19], s47 offen offset:1024 sc1
 buffer_load_dwordx4 v[132:135], v21, s[16:19], s47 offen offset:1280 sc1
 s_add_u32 s47, s47, 2048
 buffer_load_dwordx4 v[72:75], v4, s[16:19], s47 offen sc1
 buffer_load_dwordx2 v[76:77], v5, s[16:19], s47 offen offset:1536 sc1
 s_add_u32 s47, s47, 2048
 buffer_load_dwordx4 v[80:83], v4, s[16:19], s47 offen sc1
 buffer_load_dwordx2 v[84:85], v5, s[16:19], s47 offen offset:1536 sc1
 s_add_u32 s47, s47, 2048
 buffer_load_dwordx4 v[88:91], v4, s[16:19], s47 offen sc1
 buffer_load_dwordx2 v[92:93], v5, s[16:19], s47 offen offset:1536 sc1
 s_add_u32 s47, s47, 10240
 buffer_load_dwordx4 v[32:35], v22, s[16:19], s48 offen offset:0 sc1
 buffer_load_dwordx4 v[36:39], v22, s[16:19], s48 offen offset:256 sc1
 buffer_load_dwordx4 v[40:43], v22, s[16:19], s48 offen offset:512 sc1
 buffer_load_dwordx4 v[44:47], v22, s[16:19], s48 offen offset:768 sc1
 s_add_u32 s48, s48, 4096
 buffer_load_dwordx4 v[96:99], v4, s[16:19], s47 offen sc1
 buffer_load_dwordx2 v[100:101], v5, s[16:19], s47 offen offset:1536 sc1
 buffer_load_dwordx4 v[136:139], v21, s[16:19], s47 offen offset:1024 sc1
 buffer_load_dwordx4 v[140:143], v21, s[16:19], s47 offen offset:1280 sc1
 s_add_u32 s47, s47, 2048
 buffer_load_dwordx4 v[104:107], v4, s[16:19], s47 offen sc1
 buffer_load_dwordx2 v[108:109], v5, s[16:19], s47 offen offset:1536 sc1
 s_add_u32 s47, s47, 2048
 buffer_load_dwordx4 v[112:115], v4, s[16:19], s47 offen sc1
 buffer_load_dwordx2 v[116:117], v5, s[16:19], s47 offen offset:1536 sc1
 s_add_u32 s47, s47, 2048
 buffer_load_dwordx4 v[120:123], v4, s[16:19], s47 offen sc1
 buffer_load_dwordx2 v[124:125], v5, s[16:19], s47 offen offset:1536 sc1
 s_add_u32 s47, s47, 10240
 buffer_load_dwordx4 v[48:51], v22, s[16:19], s48 offen offset:0 sc1
 buffer_load_dwordx4 v[52:55], v22, s[16:19], s48 offen offset:256 sc1
 buffer_load_dwordx4 v[56:59], v22, s[16:19], s48 offen offset:512 sc1
 buffer_load_dwordx4 v[60:63], v22, s[16:19], s48 offen offset:768 sc1
 s_add_u32 s48, s48, 4096
pvg_257:
 s_add_u32 s41, s41, 1
 s_mul_i32 s53, s42, 40960
 s_lshl_b32 s22, s41, 12
 s_add_u32 s53, s53, s22
 s_lshl_b32 s48, s41, 16
 s_lshl_b32 s22, s20, 14
 s_add_u32 s48, s48, s22
 s_add_u32 s48, s48, s61
 s_waitcnt vmcnt(26)
 v_mfma_f32_16x16x32_bf16 v[148:151], a[0:3], v[64:67], 0
 v_mfma_f32_16x16x32_bf16 v[144:147], a[0:3], v[68:71], 0
 v_mfma_f32_16x16x32_bf16 v[156:159], a[4:7], v[64:67], 0
 v_mfma_f32_16x16x32_bf16 v[152:155], a[4:7], v[68:71], 0
 v_mfma_f32_16x16x32_bf16 v[164:167], a[8:11], v[64:67], 0
 v_mfma_f32_16x16x32_bf16 v[160:163], a[8:11], v[68:71], 0
 v_mfma_f32_16x16x32_bf16 v[172:175], a[12:15], v[64:67], 0
 v_mfma_f32_16x16x32_bf16 v[168:171], a[12:15], v[68:71], 0
 buffer_load_dwordx4 a[0:3], v4, s[12:15], s53 offen offset:0 sc1
 buffer_load_dwordx4 a[4:7], v4, s[12:15], s53 offen offset:1024 sc1
 buffer_load_dwordx4 a[8:11], v4, s[12:15], s53 offen offset:2048 sc1
 buffer_load_dwordx4 a[12:15], v4, s[12:15], s53 offen offset:3072 sc1
 s_waitcnt vmcnt(26)
 v_mfma_f32_16x16x32_bf16 v[148:151], a[16:19], v[72:75], v[148:151]
 v_mfma_f32_16x16x32_bf16 v[144:147], a[16:19], v[76:79], v[144:147]
 v_mfma_f32_16x16x32_bf16 v[156:159], a[20:23], v[72:75], v[156:159]
 v_mfma_f32_16x16x32_bf16 v[152:155], a[20:23], v[76:79], v[152:155]
 v_mfma_f32_16x16x32_bf16 v[164:167], a[24:27], v[72:75], v[164:167]
 v_mfma_f32_16x16x32_bf16 v[160:163], a[24:27], v[76:79], v[160:163]
 v_mfma_f32_16x16x32_bf16 v[172:175], a[28:31], v[72:75], v[172:175]
 v_mfma_f32_16x16x32_bf16 v[168:171], a[28:31], v[76:79], v[168:171]
 s_add_u32 s53, s53, 40960
 buffer_load_dwordx4 a[16:19], v4, s[12:15], s53 offen offset:0 sc1
 buffer_load_dwordx4 a[20:23], v4, s[12:15], s53 offen offset:1024 sc1
 buffer_load_dwordx4 a[24:27], v4, s[12:15], s53 offen offset:2048 sc1
 buffer_load_dwordx4 a[28:31], v4, s[12:15], s53 offen offset:3072 sc1
 s_waitcnt vmcnt(28)
 v_mfma_f32_16x16x32_bf16 v[148:151], a[32:35], v[80:83], v[148:151]
 v_mfma_f32_16x16x32_bf16 v[144:147], a[32:35], v[84:87], v[144:147]
 v_mfma_f32_16x16x32_bf16 v[156:159], a[36:39], v[80:83], v[156:159]
 v_mfma_f32_16x16x32_bf16 v[152:155], a[36:39], v[84:87], v[152:155]
 v_mfma_f32_16x16x32_bf16 v[164:167], a[40:43], v[80:83], v[164:167]
 v_mfma_f32_16x16x32_bf16 v[160:163], a[40:43], v[84:87], v[160:163]
 v_mfma_f32_16x16x32_bf16 v[172:175], a[44:47], v[80:83], v[172:175]
 v_mfma_f32_16x16x32_bf16 v[168:171], a[44:47], v[84:87], v[168:171]
 s_add_u32 s53, s53, 40960
 buffer_load_dwordx4 a[32:35], v4, s[12:15], s53 offen offset:0 sc1
 buffer_load_dwordx4 a[36:39], v4, s[12:15], s53 offen offset:1024 sc1
 buffer_load_dwordx4 a[40:43], v4, s[12:15], s53 offen offset:2048 sc1
 buffer_load_dwordx4 a[44:47], v4, s[12:15], s53 offen offset:3072 sc1
 s_waitcnt vmcnt(30)
 v_mfma_f32_16x16x32_bf16 v[148:151], a[48:51], v[88:91], v[148:151]
 v_mfma_f32_16x16x32_bf16 v[144:147], a[48:51], v[92:95], v[144:147]
 v_mfma_f32_16x16x32_bf16 v[156:159], a[52:55], v[88:91], v[156:159]
 v_mfma_f32_16x16x32_bf16 v[152:155], a[52:55], v[92:95], v[152:155]
 v_mfma_f32_16x16x32_bf16 v[164:167], a[56:59], v[88:91], v[164:167]
 v_mfma_f32_16x16x32_bf16 v[160:163], a[56:59], v[92:95], v[160:163]
 v_mfma_f32_16x16x32_bf16 v[172:175], a[60:63], v[88:91], v[172:175]
 v_mfma_f32_16x16x32_bf16 v[168:171], a[60:63], v[92:95], v[168:171]
 s_add_u32 s53, s53, 40960
 buffer_load_dwordx4 a[48:51], v4, s[12:15], s53 offen offset:0 sc1
 buffer_load_dwordx4 a[52:55], v4, s[12:15], s53 offen offset:1024 sc1
 buffer_load_dwordx4 a[56:59], v4, s[12:15], s53 offen offset:2048 sc1
 buffer_load_dwordx4 a[60:63], v4, s[12:15], s53 offen offset:3072 sc1
 s_waitcnt vmcnt(30)
 v_mfma_f32_16x16x32_bf16 v[144:147], v[32:35], v[128:131], v[144:147]
 v_mfma_f32_16x16x32_bf16 v[148:151], v[32:35], v[132:135], v[148:151]
 v_mfma_f32_16x16x32_bf16 v[152:155], v[36:39], v[128:131], v[152:155]
 v_mfma_f32_16x16x32_bf16 v[156:159], v[36:39], v[132:135], v[156:159]
 v_mfma_f32_16x16x32_bf16 v[160:163], v[40:43], v[128:131], v[160:163]
 v_mfma_f32_16x16x32_bf16 v[164:167], v[40:43], v[132:135], v[164:167]
 v_mfma_f32_16x16x32_bf16 v[168:171], v[44:47], v[128:131], v[168:171]
 v_mfma_f32_16x16x32_bf16 v[172:175], v[44:47], v[132:135], v[172:175]
 buffer_load_dwordx4 v[32:35], v22, s[16:19], s48 offen offset:0 sc1
 buffer_load_dwordx4 v[36:39], v22, s[16:19], s48 offen offset:256 sc1
 buffer_load_dwordx4 v[40:43], v22, s[16:19], s48 offen offset:512 sc1
 buffer_load_dwordx4 v[44:47], v22, s[16:19], s48 offen offset:768 sc1
 s_add_u32 s48, s48, 4096
 s_waitcnt vmcnt(32)
 v_mfma_f32_16x16x32_bf16 v[148:151], a[64:67], v[96:99], v[148:151]
 v_mfma_f32_16x16x32_bf16 v[144:147], a[64:67], v[100:103], v[144:147]
 v_mfma_f32_16x16x32_bf16 v[156:159], a[68:71], v[96:99], v[156:159]
 v_mfma_f32_16x16x32_bf16 v[152:155], a[68:71], v[100:103], v[152:155]
 v_mfma_f32_16x16x32_bf16 v[164:167], a[72:75], v[96:99], v[164:167]
 v_mfma_f32_16x16x32_bf16 v[160:163], a[72:75], v[100:103], v[160:163]
 v_mfma_f32_16x16x32_bf16 v[172:175], a[76:79], v[96:99], v[172:175]
 v_mfma_f32_16x16x32_bf16 v[168:171], a[76:79], v[100:103], v[168:171]
 s_add_u32 s53, s53, 40960
 buffer_load_dwordx4 a[64:67], v4, s[12:15], s53 offen offset:0 sc1
 buffer_load_dwordx4 a[68:71], v4, s[12:15], s53 offen offset:1024 sc1
 buffer_load_dwordx4 a[72:75], v4, s[12:15], s53 offen offset:2048 sc1
 buffer_load_dwordx4 a[76:79], v4, s[12:15], s53 offen offset:3072 sc1
 s_waitcnt vmcnt(32)
 v_mfma_f32_16x16x32_bf16 v[148:151], a[80:83], v[104:107], v[148:151]
 v_mfma_f32_16x16x32_bf16 v[144:147], a[80:83], v[108:111], v[144:147]
 v_mfma_f32_16x16x32_bf16 v[156:159], a[84:87], v[104:107], v[156:159]
 v_mfma_f32_16x16x32_bf16 v[152:155], a[84:87], v[108:111], v[152:155]
 v_mfma_f32_16x16x32_bf16 v[164:167], a[88:91], v[104:107], v[164:167]
 v_mfma_f32_16x16x32_bf16 v[160:163], a[88:91], v[108:111], v[160:163]
 v_mfma_f32_16x16x32_bf16 v[172:175], a[92:95], v[104:107], v[172:175]
 v_mfma_f32_16x16x32_bf16 v[168:171], a[92:95], v[108:111], v[168:171]
 s_add_u32 s53, s53, 40960
 buffer_load_dwordx4 a[80:83], v4, s[12:15], s53 offen offset:0 sc1
 buffer_load_dwordx4 a[84:87], v4, s[12:15], s53 offen offset:1024 sc1
 buffer_load_dwordx4 a[88:91], v4, s[12:15], s53 offen offset:2048 sc1
 buffer_load_dwordx4 a[92:95], v4, s[12:15], s53 offen offset:3072 sc1
 s_waitcnt vmcnt(34)
 v_mfma_f32_16x16x32_bf16 v[148:151], a[96:99], v[112:115], v[148:151]
 v_mfma_f32_16x16x32_bf16 v[144:147], a[96:99], v[116:119], v[144:147]
 v_mfma_f32_16x16x32_bf16 v[156:159], a[100:103], v[112:115], v[156:159]
 v_mfma_f32_16x16x32_bf16 v[152:155], a[100:103], v[116:119], v[152:155]
 v_mfma_f32_16x16x32_bf16 v[164:167], a[104:107], v[112:115], v[164:167]
 v_mfma_f32_16x16x32_bf16 v[160:163], a[104:107], v[116:119], v[160:163]
 v_mfma_f32_16x16x32_bf16 v[172:175], a[108:111], v[112:115], v[172:175]
 v_mfma_f32_16x16x32_bf16 v[168:171], a[108:111], v[116:119], v[168:171]
 s_add_u32 s53, s53, 40960
 buffer_load_dwordx4 a[96:99], v4, s[12:15], s53 offen offset:0 sc1
 buffer_load_dwordx4 a[100:103], v4, s[12:15], s53 offen offset:1024 sc1
 buffer_load_dwordx4 a[104:107], v4, s[12:15], s53 offen offset:2048 sc1
 buffer_load_dwordx4 a[108:111], v4, s[12:15], s53 offen offset:3072 sc1
 s_waitcnt vmcnt(36)
 v_mfma_f32_16x16x32_bf16 v[148:151], a[112:115], v[120:123], v[148:151]
 v_mfma_f32_16x16x32_bf16 v[144:147], a[112:115], v[124:127], v[144:147]
 v_mfma_f32_16x16x32_bf16 v[156:159], a[116:119], v[120:123], v[156:159]
 v_mfma_f32_16x16x32_bf16 v[152:155], a[116:119], v[124:127], v[152:155]
 v_mfma_f32_16x16x32_bf16 v[164:167], a[120:123], v[120:123], v[164:167]
 v_mfma_f32_16x16x32_bf16 v[160:163], a[120:123], v[124:127], v[160:163]
 v_mfma_f32_16x16x32_bf16 v[172:175], a[124:127], v[120:123], v[172:175]
 v_mfma_f32_16x16x32_bf16 v[168:171], a[124:127], v[124:127], v[168:171]
 s_add_u32 s53, s53, 40960
 buffer_load_dwordx4 a[112:115], v4, s[12:15], s53 offen offset:0 sc1
 buffer_load_dwordx4 a[116:119], v4, s[12:15], s53 offen offset:1024 sc1
 buffer_load_dwordx4 a[120:123], v4, s[12:15], s53 offen offset:2048 sc1
 buffer_load_dwordx4 a[124:127], v4, s[12:15], s53 offen offset:3072 sc1
 s_waitcnt vmcnt(36)
 v_mfma_f32_16x16x32_bf16 v[144:147], v[48:51], v[136:139], v[144:147]
 v_mfma_f32_16x16x32_bf16 v[148:151], v[48:51], v[140:143], v[148:151]
 v_mfma_f32_16x16x32_bf16 v[152:155], v[52:55], v[136:139], v[152:155]
 v_mfma_f32_16x16x32_bf16 v[156:159], v[52:55], v[140:143], v[156:159]
 v_mfma_f32_16x16x32_bf16 v[160:163], v[56:59], v[136:139], v[160:163]
 v_mfma_f32_16x16x32_bf16 v[164:167], v[56:59], v[140:143], v[164:167]
 v_mfma_f32_16x16x32_bf16 v[168:171], v[60:63], v[136:139], v[168:171]
 v_mfma_f32_16x16x32_bf16 v[172:175], v[60:63], v[140:143], v[172:175]
 buffer_load_dwordx4 v[48:51], v22, s[16:19], s48 offen offset:0 sc1
 buffer_load_dwordx4 v[52:55], v22, s[16:19], s48 offen offset:256 sc1
 buffer_load_dwordx4 v[56:59], v22, s[16:19], s48 offen offset:512 sc1
 buffer_load_dwordx4 v[60:63], v22, s[16:19], s48 offen offset:768 sc1
 s_add_u32 s48, s48, 4096
 s_branch pve_253
pvt_260:
 s_sub_u32 s55, s52, 2048
 s_cmp_lg_u32 s20, 0
 s_cbranch_scc1 wm_264
 s_mov_b32 s101, 0
wm_263:
 buffer_load_dword v26, v7, s[72:75], s55 offen sc1
 s_add_u32 s101, s101, 1
 s_cmp_gt_u32 s101, 131072
 s_cbranch_scc1 main_end
 s_waitcnt vmcnt(0)
 v_cmp_gt_u32 vcc, 4, v26
 v_readfirstlane_b32 s100, v26
 s_nop 0
 s_cbranch_vccz wm_264
 s_sleep 4
 s_add_u32 s100, s100, 3
 s_cmp_ge_u32 s100, 4
 s_cbranch_scc1 wm_263
 s_sleep 24
 s_branch wm_263
wm_264:
 s_barrier
 s_mov_b32 s56, s47
 s_mov_b32 s57, s48
 buffer_load_dwordx4 v[64:67], v4, s[16:19], s56 offen sc1
 buffer_load_dwordx2 v[68:69], v5, s[16:19], s56 offen offset:1536 sc1
 buffer_load_dwordx4 v[128:131], v21, s[16:19], s56 offen offset:1024 sc1
 buffer_load_dwordx4 v[132:135], v21, s[16:19], s56 offen offset:1280 sc1
 s_add_u32 s56, s56, 2048
 buffer_load_dwordx4 v[72:75], v4, s[16:19], s56 offen sc1
 buffer_load_dwordx2 v[76:77], v5, s[16:19], s56 offen offset:1536 sc1
 s_add_u32 s56, s56, 2048
 buffer_load_dwordx4 v[80:83], v4, s[16:19], s56 offen sc1
 buffer_load_dwordx2 v[84:85], v5, s[16:19], s56 offen offset:1536 sc1
 s_add_u32 s56, s56, 2048
 buffer_load_dwordx4 v[88:91], v4, s[16:19], s56 offen sc1
 buffer_load_dwordx2 v[92:93], v5, s[16:19], s56 offen offset:1536 sc1
 s_add_u32 s56, s56, 10240
 buffer_load_dwordx4 v[32:35], v22, s[16:19], s57 offen offset:0 sc1
 buffer_load_dwordx4 v[36:39], v22, s[16:19], s57 offen offset:256 sc1
 buffer_load_dwordx4 v[40:43], v22, s[16:19], s57 offen offset:512 sc1
 buffer_load_dwordx4 v[44:47], v22, s[16:19], s57 offen offset:768 sc1
 s_add_u32 s57, s57, 4096
 buffer_load_dwordx4 v[96:99], v4, s[16:19], s56 offen sc1
 buffer_load_dwordx2 v[100:101], v5, s[16:19], s56 offen offset:1536 sc1
 buffer_load_dwordx4 v[136:139], v21, s[16:19], s56 offen offset:1024 sc1
 buffer_load_dwordx4 v[140:143], v21, s[16:19], s56 offen offset:1280 sc1
 s_add_u32 s56, s56, 2048
 buffer_load_dwordx4 v[104:107], v4, s[16:19], s56 offen sc1
 buffer_load_dwordx2 v[108:109], v5, s[16:19], s56 offen offset:1536 sc1
 s_add_u32 s56, s56, 2048
 buffer_load_dwordx4 v[112:115], v4, s[16:19], s56 offen sc1
 buffer_load_dwordx2 v[116:117], v5, s[16:19], s56 offen offset:1536 sc1
 s_add_u32 s56, s56, 2048
 buffer_load_dwordx4 v[120:123], v4, s[16:19], s56 offen sc1
 buffer_load_dwordx2 v[124:125], v5, s[16:19], s56 offen offset:1536 sc1
 s_add_u32 s56, s56, 10240
 buffer_load_dwordx4 v[48:51], v22, s[16:19], s57 offen offset:0 sc1
 buffer_load_dwordx4 v[52:55], v22, s[16:19], s57 offen offset:256 sc1
 buffer_load_dwordx4 v[56:59], v22, s[16:19], s57 offen offset:512 sc1
 buffer_load_dwordx4 v[60:63], v22, s[16:19], s57 offen offset:768 sc1
 s_add_u32 s57, s57, 4096
pvc_258:
 s_mov_b32 s101, 0
 s_waitcnt vmcnt(14)
 s_branch pvr_266
pvr_265:
 s_sleep 2
 s_add_u32 s56, s47, 0
 s_add_u32 s57, s48, 0
 buffer_load_dwordx4 v[64:67], v4, s[16:19], s56 offen sc1
 buffer_load_dwordx2 v[68:69], v5, s[16:19], s56 offen offset:1536 sc1
 buffer_load_dwordx4 v[128:131], v21, s[16:19], s56 offen offset:1024 sc1
 buffer_load_dwordx4 v[132:135], v21, s[16:19], s56 offen offset:1280 sc1
 s_add_u32 s56, s56, 2048
 buffer_load_dwordx4 v[72:75], v4, s[16:19], s56 offen sc1
 buffer_load_dwordx2 v[76:77], v5, s[16:19], s56 offen offset:1536 sc1
 s_add_u32 s56, s56, 2048
 buffer_load_dwordx4 v[80:83], v4, s[16:19], s56 offen sc1
 buffer_load_dwordx2 v[84:85], v5, s[16:19], s56 offen offset:1536 sc1
 s_add_u32 s56, s56, 2048
 buffer_load_dwordx4 v[88:91], v4, s[16:19], s56 offen sc1
 buffer_load_dwordx2 v[92:93], v5, s[16:19], s56 offen offset:1536 sc1
 s_add_u32 s56, s56, 10240
 buffer_load_dwordx4 v[32:35], v22, s[16:19], s57 offen offset:0 sc1
 buffer_load_dwordx4 v[36:39], v22, s[16:19], s57 offen offset:256 sc1
 buffer_load_dwordx4 v[40:43], v22, s[16:19], s57 offen offset:512 sc1
 buffer_load_dwordx4 v[44:47], v22, s[16:19], s57 offen offset:768 sc1
 s_add_u32 s57, s57, 4096
 s_add_u32 s101, s101, 1
 s_cmp_gt_u32 s101, 131072
 s_cbranch_scc1 main_end
 s_waitcnt vmcnt(0)
pvr_266:
 v_max3_u32 v26, v64, v68, v72
 v_max3_u32 v26, v26, v76, v80
 v_max3_u32 v26, v26, v84, v88
 v_max3_u32 v26, v26, v92, v128
 v_max3_u32 v26, v26, v132, v32
 v_max3_u32 v26, v26, v36, v40
 v_max3_u32 v26, v26, v44, v44
 v_cmp_eq_u32 vcc, -1, v26
 s_nop 1
 s_cbranch_vccnz pvr_265
 v_mfma_f32_16x16x32_bf16 v[148:151], a[0:3], v[64:67], 0
 v_mfma_f32_16x16x32_bf16 v[144:147], a[0:3], v[68:71], 0
 v_mfma_f32_16x16x32_bf16 v[156:159], a[4:7], v[64:67], 0
 v_mfma_f32_16x16x32_bf16 v[152:155], a[4:7], v[68:71], 0
 v_mfma_f32_16x16x32_bf16 v[164:167], a[8:11], v[64:67], 0
 v_mfma_f32_16x16x32_bf16 v[160:163], a[8:11], v[68:71], 0
 v_mfma_f32_16x16x32_bf16 v[172:175], a[12:15], v[64:67], 0
 v_mfma_f32_16x16x32_bf16 v[168:171], a[12:15], v[68:71], 0
 v_mfma_f32_16x16x32_bf16 v[148:151], a[16:19], v[72:75], v[148:151]
 v_mfma_f32_16x16x32_bf16 v[144:147], a[16:19], v[76:79], v[144:147]
 v_mfma_f32_16x16x32_bf16 v[156:159], a[20:23], v[72:75], v[156:159]
 v_mfma_f32_16x16x32_bf16 v[152:155], a[20:23], v[76:79], v[152:155]
 v_mfma_f32_16x16x32_bf16 v[164:167], a[24:27], v[72:75], v[164:167]
 v_mfma_f32_16x16x32_bf16 v[160:163], a[24:27], v[76:79], v[160:163]
 v_mfma_f32_16x16x32_bf16 v[172:175], a[28:31], v[72:75], v[172:175]
 v_mfma_f32_16x16x32_bf16 v[168:171], a[28:31], v[76:79], v[168:171]
 v_mfma_f32_16x16x32_bf16 v[148:151], a[32:35], v[80:83], v[148:151]
 v_mfma_f32_16x16x32_bf16 v[144:147], a[32:35], v[84:87], v[144:147]
 v_mfma_f32_16x16x32_bf16 v[156:159], a[36:39], v[80:83], v[156:159]
 v_mfma_f32_16x16x32_bf16 v[152:155], a[36:39], v[84:87], v[152:155]
 v_mfma_f32_16x16x32_bf16 v[164:167], a[40:43], v[80:83], v[164:167]
 v_mfma_f32_16x16x32_bf16 v[160:163], a[40:43], v[84:87], v[160:163]
 v_mfma_f32_16x16x32_bf16 v[172:175], a[44:47], v[80:83], v[172:175]
 v_mfma_f32_16x16x32_bf16 v[168:171], a[44:47], v[84:87], v[168:171]
 v_mfma_f32_16x16x32_bf16 v[148:151], a[48:51], v[88:91], v[148:151]
 v_mfma_f32_16x16x32_bf16 v[144:147], a[48:51], v[92:95], v[144:147]
 v_mfma_f32_16x16x32_bf16 v[156:159], a[52:55], v[88:91], v[156:159]
 v_mfma_f32_16x16x32_bf16 v[152:155], a[52:55], v[92:95], v[152:155]
 v_mfma_f32_16x16x32_bf16 v[164:167], a[56:59], v[88:91], v[164:167]
 v_mfma_f32_16x16x32_bf16 v[160:163], a[56:59], v[92:95], v[160:163]
 v_mfma_f32_16x16x32_bf16 v[172:175], a[60:63], v[88:91], v[172:175]
 v_mfma_f32_16x16x32_bf16 v[168:171], a[60:63], v[92:95], v[168:171]
 s_nop 1
 v_mfma_f32_16x16x32_bf16 v[144:147], v[32:35], v[128:131], v[144:147]
 v_mfma_f32_16x16x32_bf16 v[148:151], v[32:35], v[132:135], v[148:151]
 v_mfma_f32_16x16x32_bf16 v[152:155], v[36:39], v[128:131], v[152:155]
 v_mfma_f32_16x16x32_bf16 v[156:159], v[36:39], v[132:135], v[156:159]
 v_mfma_f32_16x16x32_bf16 v[160:163], v[40:43], v[128:131], v[160:163]
 v_mfma_f32_16x16x32_bf16 v[164:167], v[40:43], v[132:135], v[164:167]
 v_mfma_f32_16x16x32_bf16 v[168:171], v[44:47], v[128:131], v[168:171]
 v_mfma_f32_16x16x32_bf16 v[172:175], v[44:47], v[132:135], v[172:175]
 s_mov_b32 s101, 0
 s_waitcnt vmcnt(0)
 s_branch pvr_268
pvr_267:
 s_sleep 2
 s_add_u32 s56, s47, 16384
 s_add_u32 s57, s48, 4096
 buffer_load_dwordx4 v[96:99], v4, s[16:19], s56 offen sc1
 buffer_load_dwordx2 v[100:101], v5, s[16:19], s56 offen offset:1536 sc1
 buffer_load_dwordx4 v[136:139], v21, s[16:19], s56 offen offset:1024 sc1
 buffer_load_dwordx4 v[140:143], v21, s[16:19], s56 offen offset:1280 sc1
 s_add_u32 s56, s56, 2048
 buffer_load_dwordx4 v[104:107], v4, s[16:19], s56 offen sc1
 buffer_load_dwordx2 v[108:109], v5, s[16:19], s56 offen offset:1536 sc1
 s_add_u32 s56, s56, 2048
 buffer_load_dwordx4 v[112:115], v4, s[16:19], s56 offen sc1
 buffer_load_dwordx2 v[116:117], v5, s[16:19], s56 offen offset:1536 sc1
 s_add_u32 s56, s56, 2048
 buffer_load_dwordx4 v[120:123], v4, s[16:19], s56 offen sc1
 buffer_load_dwordx2 v[124:125], v5, s[16:19], s56 offen offset:1536 sc1
 s_add_u32 s56, s56, 10240
 buffer_load_dwordx4 v[48:51], v22, s[16:19], s57 offen offset:0 sc1
 buffer_load_dwordx4 v[52:55], v22, s[16:19], s57 offen offset:256 sc1
 buffer_load_dwordx4 v[56:59], v22, s[16:19], s57 offen offset:512 sc1
 buffer_load_dwordx4 v[60:63], v22, s[16:19], s57 offen offset:768 sc1
 s_add_u32 s57, s57, 4096
 s_add_u32 s101, s101, 1
 s_cmp_gt_u32 s101, 131072
 s_cbranch_scc1 main_end
 s_waitcnt vmcnt(0)
pvr_268:
 v_max3_u32 v26, v96, v100, v104
 v_max3_u32 v26, v26, v108, v112
 v_max3_u32 v26, v26, v116, v120
 v_max3_u32 v26, v26, v124, v136
 v_max3_u32 v26, v26, v140, v48
 v_max3_u32 v26, v26, v52, v56
 v_max3_u32 v26, v26, v60, v60
 v_cmp_eq_u32 vcc, -1, v26
 s_nop 1
 s_cbranch_vccnz pvr_267
 v_mfma_f32_16x16x32_bf16 v[148:151], a[64:67], v[96:99], v[148:151]
 v_mfma_f32_16x16x32_bf16 v[144:147], a[64:67], v[100:103], v[144:147]
 v_mfma_f32_16x16x32_bf16 v[156:159], a[68:71], v[96:99], v[156:159]
 v_mfma_f32_16x16x32_bf16 v[152:155], a[68:71], v[100:103], v[152:155]
 v_mfma_f32_16x16x32_bf16 v[164:167], a[72:75], v[96:99], v[164:167]
 v_mfma_f32_16x16x32_bf16 v[160:163], a[72:75], v[100:103], v[160:163]
 v_mfma_f32_16x16x32_bf16 v[172:175], a[76:79], v[96:99], v[172:175]
 v_mfma_f32_16x16x32_bf16 v[168:171], a[76:79], v[100:103], v[168:171]
 v_mfma_f32_16x16x32_bf16 v[148:151], a[80:83], v[104:107], v[148:151]
 v_mfma_f32_16x16x32_bf16 v[144:147], a[80:83], v[108:111], v[144:147]
 v_mfma_f32_16x16x32_bf16 v[156:159], a[84:87], v[104:107], v[156:159]
 v_mfma_f32_16x16x32_bf16 v[152:155], a[84:87], v[108:111], v[152:155]
 v_mfma_f32_16x16x32_bf16 v[164:167], a[88:91], v[104:107], v[164:167]
 v_mfma_f32_16x16x32_bf16 v[160:163], a[88:91], v[108:111], v[160:163]
 v_mfma_f32_16x16x32_bf16 v[172:175], a[92:95], v[104:107], v[172:175]
 v_mfma_f32_16x16x32_bf16 v[168:171], a[92:95], v[108:111], v[168:171]
 v_mfma_f32_16x16x32_bf16 v[148:151], a[96:99], v[112:115], v[148:151]
 v_mfma_f32_16x16x32_bf16 v[144:147], a[96:99], v[116:119], v[144:147]
 v_mfma_f32_16x16x32_bf16 v[156:159], a[100:103], v[112:115], v[156:159]
 v_mfma_f32_16x16x32_bf16 v[152:155], a[100:103], v[116:119], v[152:155]
 v_mfma_f32_16x16x32_bf16 v[164:167], a[104:107], v[112:115], v[164:167]
 v_mfma_f32_16x16x32_bf16 v[160:163], a[104:107], v[116:119], v[160:163]
 v_mfma_f32_16x16x32_bf16 v[172:175], a[108:111], v[112:115], v[172:175]
 v_mfma_f32_16x16x32_bf16 v[168:171], a[108:111], v[116:119], v[168:171]
 v_mfma_f32_16x16x32_bf16 v[148:151], a[112:115], v[120:123], v[148:151]
 v_mfma_f32_16x16x32_bf16 v[144:147], a[112:115], v[124:127], v[144:147]
 v_mfma_f32_16x16x32_bf16 v[156:159], a[116:119], v[120:123], v[156:159]
 v_mfma_f32_16x16x32_bf16 v[152:155], a[116:119], v[124:127], v[152:155]
 v_mfma_f32_16x16x32_bf16 v[164:167], a[120:123], v[120:123], v[164:167]
 v_mfma_f32_16x16x32_bf16 v[160:163], a[120:123], v[124:127], v[160:163]
 v_mfma_f32_16x16x32_bf16 v[172:175], a[124:127], v[120:123], v[172:175]
 v_mfma_f32_16x16x32_bf16 v[168:171], a[124:127], v[124:127], v[168:171]
 s_nop 1
 v_mfma_f32_16x16x32_bf16 v[144:147], v[48:51], v[136:139], v[144:147]
 v_mfma_f32_16x16x32_bf16 v[148:151], v[48:51], v[140:143], v[148:151]
 v_mfma_f32_16x16x32_bf16 v[152:155], v[52:55], v[136:139], v[152:155]
 v_mfma_f32_16x16x32_bf16 v[156:159], v[52:55], v[140:143], v[156:159]
 v_mfma_f32_16x16x32_bf16 v[160:163], v[56:59], v[136:139], v[160:163]
 v_mfma_f32_16x16x32_bf16 v[164:167], v[56:59], v[140:143], v[164:167]
 v_mfma_f32_16x16x32_bf16 v[168:171], v[60:63], v[136:139], v[168:171]
 v_mfma_f32_16x16x32_bf16 v[172:175], v[60:63], v[140:143], v[172:175]
pve_253:
 s_nop 0
 s_or_b32 s21, s20, s65
 s_cbranch_scc1 lc_269
 s_sub_u32 s21, s2, 0
 s_cmp_ge_u32 s21, 640
 s_cbranch_scc1 lc_269
 v_mov_b32 v29, 1
 s_mov_b64 exec, 1
 buffer_atomic_add v29, v28, s[32:35], 0 offen sc0 sc1
 s_mov_b64 exec, -1
lc_269:
 ds_write_b128 v10, v[144:147] offset:0
 ds_write_b128 v10, v[148:151] offset:1024
 ds_write_b128 v10, v[152:155] offset:2048
 ds_write_b128 v10, v[156:159] offset:3072
 ds_write_b128 v10, v[160:163] offset:4096
 ds_write_b128 v10, v[164:167] offset:5120
 ds_write_b128 v10, v[168:171] offset:6144
 ds_write_b128 v10, v[172:175] offset:7168
 s_cmp_lg_u32 s20, 0
 s_cbranch_scc1 pvq_272
 v_readfirstlane_b32 s21, v29
 s_mov_b32 s23, -1
 v_mov_b32 v213, s23
 s_mov_b64 exec, 1
 ds_write_b32 v30, v29
 ds_write_b32 v30, v213 offset:8
 s_mov_b64 exec, -1
pvq_272:
 s_waitcnt lgkmcnt(0)
 s_barrier
 ds_read_b128 v[176:179], v11 offset:0
 ds_read_b128 v[180:183], v11 offset:8192
 ds_read_b128 v[184:187], v11 offset:16384
 ds_read_b128 v[188:191], v11 offset:24576
 ds_read_b128 v[192:195], v11 offset:4096
 ds_read_b128 v[196:199], v11 offset:12288
 ds_read_b128 v[200:203], v11 offset:20480
 ds_read_b128 v[204:207], v11 offset:28672
 ds_read_b32 v23, v30
 ds_read_b32 v213, v30 offset:8
 s_cmp_ge_u32 s40, 48
 s_cbranch_scc1 pvr_275
 s_waitcnt lgkmcnt(6)
 v_pk_add_f32 v[176:177], v[176:177], v[180:181]
 v_pk_add_f32 v[184:185], v[184:185], v[188:189]
 v_pk_add_f32 v[178:179], v[178:179], v[182:183]
 v_pk_add_f32 v[186:187], v[186:187], v[190:191]
 v_pk_add_f32 v[176:177], v[176:177], v[184:185]
 v_pk_add_f32 v[178:179], v[178:179], v[186:187]
 buffer_store_dwordx4 v[176:179], v4, s[24:27], s54 offen offset:0 sc1
 s_waitcnt lgkmcnt(2)
 v_pk_add_f32 v[192:193], v[192:193], v[196:197]
 v_pk_add_f32 v[200:201], v[200:201], v[204:205]
 v_pk_add_f32 v[194:195], v[194:195], v[198:199]
 v_pk_add_f32 v[202:203], v[202:203], v[206:207]
 v_pk_add_f32 v[192:193], v[192:193], v[200:201]
 v_pk_add_f32 v[194:195], v[194:195], v[202:203]
 buffer_store_dwordx4 v[192:195], v4, s[24:27], s54 offen offset:2048 sc1
 s_lshr_b32 s71, s40, 2
 s_lshl_b32 s71, s71, 7
 s_add_u32 s71, s71, 116736
 s_branch pvr_276
pvr_275:
 s_waitcnt lgkmcnt(6)
 v_pk_add_f32 v[176:177], v[176:177], v[180:181]
 v_pk_add_f32 v[184:185], v[184:185], v[188:189]
 v_pk_add_f32 v[178:179], v[178:179], v[182:183]
 v_pk_add_f32 v[186:187], v[186:187], v[190:191]
 v_pk_add_f32 v[176:177], v[176:177], v[184:185]
 v_pk_add_f32 v[178:179], v[178:179], v[186:187]
 v_cvt_pk_bf16_f32 v26, v176, v177
 v_lshlrev_b32 v176, 16, v26
 v_and_b32 v177, 0xffff0000, v26
 v_mul_f32 v176, v176, v24
 v_mul_f32 v177, v177, v24
 v_cvt_pk_bf16_f32 v26, v176, v177
 v_lshlrev_b32 v176, 16, v26
 v_and_b32 v177, 0xffff0000, v26
 v_add_f32 v176, v176, v12
 v_add_f32 v177, v177, v13
 v_cvt_pk_bf16_f32 v180, v176, v177
 v_cvt_pk_bf16_f32 v26, v178, v179
 v_lshlrev_b32 v178, 16, v26
 v_and_b32 v179, 0xffff0000, v26
 v_mul_f32 v178, v178, v24
 v_mul_f32 v179, v179, v24
 v_cvt_pk_bf16_f32 v26, v178, v179
 v_lshlrev_b32 v178, 16, v26
 v_and_b32 v179, 0xffff0000, v26
 v_add_f32 v178, v178, v14
 v_add_f32 v179, v179, v15
 v_cvt_pk_bf16_f32 v181, v178, v179
 buffer_store_dwordx2 v[180:181], v9, s[8:11], s46 offen offset:0
 s_waitcnt lgkmcnt(2)
 v_pk_add_f32 v[192:193], v[192:193], v[196:197]
 v_pk_add_f32 v[200:201], v[200:201], v[204:205]
 v_pk_add_f32 v[194:195], v[194:195], v[198:199]
 v_pk_add_f32 v[202:203], v[202:203], v[206:207]
 v_pk_add_f32 v[192:193], v[192:193], v[200:201]
 v_pk_add_f32 v[194:195], v[194:195], v[202:203]
 v_cvt_pk_bf16_f32 v26, v192, v193
 v_lshlrev_b32 v192, 16, v26
 v_and_b32 v193, 0xffff0000, v26
 v_mul_f32 v192, v192, v24
 v_mul_f32 v193, v193, v24
 v_cvt_pk_bf16_f32 v26, v192, v193
 v_lshlrev_b32 v192, 16, v26
 v_and_b32 v193, 0xffff0000, v26
 v_add_f32 v192, v192, v16
 v_add_f32 v193, v193, v17
 v_cvt_pk_bf16_f32 v196, v192, v193
 v_cvt_pk_bf16_f32 v26, v194, v195
 v_lshlrev_b32 v194, 16, v26
 v_and_b32 v195, 0xffff0000, v26
 v_mul_f32 v194, v194, v24
 v_mul_f32 v195, v195, v24
 v_cvt_pk_bf16_f32 v26, v194, v195
 v_lshlrev_b32 v194, 16, v26
 v_and_b32 v195, 0xffff0000, v26
 v_add_f32 v194, v194, v18
 v_add_f32 v195, v195, v19
 v_cvt_pk_bf16_f32 v197, v194, v195
 buffer_store_dwordx2 v[196:197], v9, s[8:11], s46 offen offset:64
pvr_276:
pvy_277:
 s_cmp_eq_u32 s65, 0
 s_cbranch_scc1 pvy_278
 s_sub_u32 s65, s65, 1
 s_add_u32 s46, s46, 128
 s_add_u32 s54, s54, 16384
 s_cmp_lt_u32 s40, 48
 s_cselect_b32 s70, 0x80000000, s54
 buffer_load_dwordx4 v[12:15], v4, s[24:27], s70 offen sc1
 buffer_load_dwordx4 v[16:19], v4, s[24:27], s70 offen offset:2048 sc1
 buffer_load_dword v24, v6, s[28:31], s45 offen sc1
 s_waitcnt lgkmcnt(0)
 s_barrier
 s_cmp_eq_u32 s65, 0
 s_cbranch_scc1 pvy_279
 s_add_u32 s41, s41, 1
 s_mul_i32 s53, s42, 40960
 s_lshl_b32 s22, s41, 12
 s_add_u32 s53, s53, s22
 s_lshl_b32 s48, s41, 16
 s_lshl_b32 s22, s20, 14
 s_add_u32 s48, s48, s22
 s_add_u32 s48, s48, s61
 s_waitcnt vmcnt(41)
 v_mfma_f32_16x16x32_bf16 v[148:151], a[0:3], v[64:67], 0
 v_mfma_f32_16x16x32_bf16 v[144:147], a[0:3], v[68:71], 0
 v_mfma_f32_16x16x32_bf16 v[156:159], a[4:7], v[64:67], 0
 v_mfma_f32_16x16x32_bf16 v[152:155], a[4:7], v[68:71], 0
 v_mfma_f32_16x16x32_bf16 v[164:167], a[8:11], v[64:67], 0
 v_mfma_f32_16x16x32_bf16 v[160:163], a[8:11], v[68:71], 0
 v_mfma_f32_16x16x32_bf16 v[172:175], a[12:15], v[64:67], 0
 v_mfma_f32_16x16x32_bf16 v[168:171], a[12:15], v[68:71], 0
 buffer_load_dwordx4 a[0:3], v4, s[12:15], s53 offen offset:0 sc1
 buffer_load_dwordx4 a[4:7], v4, s[12:15], s53 offen offset:1024 sc1
 buffer_load_dwordx4 a[8:11], v4, s[12:15], s53 offen offset:2048 sc1
 buffer_load_dwordx4 a[12:15], v4, s[12:15], s53 offen offset:3072 sc1
 s_waitcnt vmcnt(41)
 v_mfma_f32_16x16x32_bf16 v[148:151], a[16:19], v[72:75], v[148:151]
 v_mfma_f32_16x16x32_bf16 v[144:147], a[16:19], v[76:79], v[144:147]
 v_mfma_f32_16x16x32_bf16 v[156:159], a[20:23], v[72:75], v[156:159]
 v_mfma_f32_16x16x32_bf16 v[152:155], a[20:23], v[76:79], v[152:155]
 v_mfma_f32_16x16x32_bf16 v[164:167], a[24:27], v[72:75], v[164:167]
 v_mfma_f32_16x16x32_bf16 v[160:163], a[24:27], v[76:79], v[160:163]
 v_mfma_f32_16x16x32_bf16 v[172:175], a[28:31], v[72:75], v[172:175]
 v_mfma_f32_16x16x32_bf16 v[168:171], a[28:31], v[76:79], v[168:171]
 s_add_u32 s53, s53, 40960
 buffer_load_dwordx4 a[16:19], v4, s[12:15], s53 offen offset:0 sc1
 buffer_load_dwordx4 a[20:23], v4, s[12:15], s53 offen offset:1024 sc1
 buffer_load_dwordx4 a[24:27], v4, s[12:15], s53 offen offset:2048 sc1
 buffer_load_dwordx4 a[28:31], v4, s[12:15], s53 offen offset:3072 sc1
 s_waitcnt vmcnt(41)
 v_mfma_f32_16x16x32_bf16 v[148:151], a[32:35], v[80:83], v[148:151]
 v_mfma_f32_16x16x32_bf16 v[144:147], a[32:35], v[84:87], v[144:147]
 v_mfma_f32_16x16x32_bf16 v[156:159], a[36:39], v[80:83], v[156:159]
 v_mfma_f32_16x16x32_bf16 v[152:155], a[36:39], v[84:87], v[152:155]
 v_mfma_f32_16x16x32_bf16 v[164:167], a[40:43], v[80:83], v[164:167]
 v_mfma_f32_16x16x32_bf16 v[160:163], a[40:43], v[84:87], v[160:163]
 v_mfma_f32_16x16x32_bf16 v[172:175], a[44:47], v[80:83], v[172:175]
 v_mfma_f32_16x16x32_bf16 v[168:171], a[44:47], v[84:87], v[168:171]
 s_add_u32 s53, s53, 40960
 buffer_load_dwordx4 a[32:35], v4, s[12:15], s53 offen offset:0 sc1
 buffer_load_dwordx4 a[36:39], v4, s[12:15], s53 offen offset:1024 sc1
 buffer_load_dwordx4 a[40:43], v4, s[12:15], s53 offen offset:2048 sc1
 buffer_load_dwordx4 a[44:47], v4, s[12:15], s53 offen offset:3072 sc1
 s_waitcnt vmcnt(41)
 v_mfma_f32_16x16x32_bf16 v[148:151], a[48:51], v[88:91], v[148:151]
 v_mfma_f32_16x16x32_bf16 v[144:147], a[48:51], v[92:95], v[144:147]
 v_mfma_f32_16x16x32_bf16 v[156:159], a[52:55], v[88:91], v[156:159]
 v_mfma_f32_16x16x32_bf16 v[152:155], a[52:55], v[92:95], v[152:155]
 v_mfma_f32_16x16x32_bf16 v[164:167], a[56:59], v[88:91], v[164:167]
 v_mfma_f32_16x16x32_bf16 v[160:163], a[56:59], v[92:95], v[160:163]
 v_mfma_f32_16x16x32_bf16 v[172:175], a[60:63], v[88:91], v[172:175]
 v_mfma_f32_16x16x32_bf16 v[168:171], a[60:63], v[92:95], v[168:171]
 s_add_u32 s53, s53, 40960
 buffer_load_dwordx4 a[48:51], v4, s[12:15], s53 offen offset:0 sc1
 buffer_load_dwordx4 a[52:55], v4, s[12:15], s53 offen offset:1024 sc1
 buffer_load_dwordx4 a[56:59], v4, s[12:15], s53 offen offset:2048 sc1
 buffer_load_dwordx4 a[60:63], v4, s[12:15], s53 offen offset:3072 sc1
 s_waitcnt vmcnt(41)
 v_mfma_f32_16x16x32_bf16 v[144:147], v[32:35], v[128:131], v[144:147]
 v_mfma_f32_16x16x32_bf16 v[148:151], v[32:35], v[132:135], v[148:151]
 v_mfma_f32_16x16x32_bf16 v[152:155], v[36:39], v[128:131], v[152:155]
 v_mfma_f32_16x16x32_bf16 v[156:159], v[36:39], v[132:135], v[156:159]
 v_mfma_f32_16x16x32_bf16 v[160:163], v[40:43], v[128:131], v[160:163]
 v_mfma_f32_16x16x32_bf16 v[164:167], v[40:43], v[132:135], v[164:167]
 v_mfma_f32_16x16x32_bf16 v[168:171], v[44:47], v[128:131], v[168:171]
 v_mfma_f32_16x16x32_bf16 v[172:175], v[44:47], v[132:135], v[172:175]
 buffer_load_dwordx4 v[32:35], v22, s[16:19], s48 offen offset:0 sc1
 buffer_load_dwordx4 v[36:39], v22, s[16:19], s48 offen offset:256 sc1
 buffer_load_dwordx4 v[40:43], v22, s[16:19], s48 offen offset:512 sc1
 buffer_load_dwordx4 v[44:47], v22, s[16:19], s48 offen offset:768 sc1
 s_add_u32 s48, s48, 4096
 s_waitcnt vmcnt(41)
 v_mfma_f32_16x16x32_bf16 v[148:151], a[64:67], v[96:99], v[148:151]
 v_mfma_f32_16x16x32_bf16 v[144:147], a[64:67], v[100:103], v[144:147]
 v_mfma_f32_16x16x32_bf16 v[156:159], a[68:71], v[96:99], v[156:159]
 v_mfma_f32_16x16x32_bf16 v[152:155], a[68:71], v[100:103], v[152:155]
 v_mfma_f32_16x16x32_bf16 v[164:167], a[72:75], v[96:99], v[164:167]
 v_mfma_f32_16x16x32_bf16 v[160:163], a[72:75], v[100:103], v[160:163]
 v_mfma_f32_16x16x32_bf16 v[172:175], a[76:79], v[96:99], v[172:175]
 v_mfma_f32_16x16x32_bf16 v[168:171], a[76:79], v[100:103], v[168:171]
 s_add_u32 s53, s53, 40960
 buffer_load_dwordx4 a[64:67], v4, s[12:15], s53 offen offset:0 sc1
 buffer_load_dwordx4 a[68:71], v4, s[12:15], s53 offen offset:1024 sc1
 buffer_load_dwordx4 a[72:75], v4, s[12:15], s53 offen offset:2048 sc1
 buffer_load_dwordx4 a[76:79], v4, s[12:15], s53 offen offset:3072 sc1
 s_waitcnt vmcnt(41)
 v_mfma_f32_16x16x32_bf16 v[148:151], a[80:83], v[104:107], v[148:151]
 v_mfma_f32_16x16x32_bf16 v[144:147], a[80:83], v[108:111], v[144:147]
 v_mfma_f32_16x16x32_bf16 v[156:159], a[84:87], v[104:107], v[156:159]
 v_mfma_f32_16x16x32_bf16 v[152:155], a[84:87], v[108:111], v[152:155]
 v_mfma_f32_16x16x32_bf16 v[164:167], a[88:91], v[104:107], v[164:167]
 v_mfma_f32_16x16x32_bf16 v[160:163], a[88:91], v[108:111], v[160:163]
 v_mfma_f32_16x16x32_bf16 v[172:175], a[92:95], v[104:107], v[172:175]
 v_mfma_f32_16x16x32_bf16 v[168:171], a[92:95], v[108:111], v[168:171]
 s_add_u32 s53, s53, 40960
 buffer_load_dwordx4 a[80:83], v4, s[12:15], s53 offen offset:0 sc1
 buffer_load_dwordx4 a[84:87], v4, s[12:15], s53 offen offset:1024 sc1
 buffer_load_dwordx4 a[88:91], v4, s[12:15], s53 offen offset:2048 sc1
 buffer_load_dwordx4 a[92:95], v4, s[12:15], s53 offen offset:3072 sc1
 s_waitcnt vmcnt(41)
 v_mfma_f32_16x16x32_bf16 v[148:151], a[96:99], v[112:115], v[148:151]
 v_mfma_f32_16x16x32_bf16 v[144:147], a[96:99], v[116:119], v[144:147]
 v_mfma_f32_16x16x32_bf16 v[156:159], a[100:103], v[112:115], v[156:159]
 v_mfma_f32_16x16x32_bf16 v[152:155], a[100:103], v[116:119], v[152:155]
 v_mfma_f32_16x16x32_bf16 v[164:167], a[104:107], v[112:115], v[164:167]
 v_mfma_f32_16x16x32_bf16 v[160:163], a[104:107], v[116:119], v[160:163]
 v_mfma_f32_16x16x32_bf16 v[172:175], a[108:111], v[112:115], v[172:175]
 v_mfma_f32_16x16x32_bf16 v[168:171], a[108:111], v[116:119], v[168:171]
 s_add_u32 s53, s53, 40960
 buffer_load_dwordx4 a[96:99], v4, s[12:15], s53 offen offset:0 sc1
 buffer_load_dwordx4 a[100:103], v4, s[12:15], s53 offen offset:1024 sc1
 buffer_load_dwordx4 a[104:107], v4, s[12:15], s53 offen offset:2048 sc1
 buffer_load_dwordx4 a[108:111], v4, s[12:15], s53 offen offset:3072 sc1
 s_waitcnt vmcnt(41)
 v_mfma_f32_16x16x32_bf16 v[148:151], a[112:115], v[120:123], v[148:151]
 v_mfma_f32_16x16x32_bf16 v[144:147], a[112:115], v[124:127], v[144:147]
 v_mfma_f32_16x16x32_bf16 v[156:159], a[116:119], v[120:123], v[156:159]
 v_mfma_f32_16x16x32_bf16 v[152:155], a[116:119], v[124:127], v[152:155]
 v_mfma_f32_16x16x32_bf16 v[164:167], a[120:123], v[120:123], v[164:167]
 v_mfma_f32_16x16x32_bf16 v[160:163], a[120:123], v[124:127], v[160:163]
 v_mfma_f32_16x16x32_bf16 v[172:175], a[124:127], v[120:123], v[172:175]
 v_mfma_f32_16x16x32_bf16 v[168:171], a[124:127], v[124:127], v[168:171]
 s_add_u32 s53, s53, 40960
 buffer_load_dwordx4 a[112:115], v4, s[12:15], s53 offen offset:0 sc1
 buffer_load_dwordx4 a[116:119], v4, s[12:15], s53 offen offset:1024 sc1
 buffer_load_dwordx4 a[120:123], v4, s[12:15], s53 offen offset:2048 sc1
 buffer_load_dwordx4 a[124:127], v4, s[12:15], s53 offen offset:3072 sc1
 s_waitcnt vmcnt(41)
 v_mfma_f32_16x16x32_bf16 v[144:147], v[48:51], v[136:139], v[144:147]
 v_mfma_f32_16x16x32_bf16 v[148:151], v[48:51], v[140:143], v[148:151]
 v_mfma_f32_16x16x32_bf16 v[152:155], v[52:55], v[136:139], v[152:155]
 v_mfma_f32_16x16x32_bf16 v[156:159], v[52:55], v[140:143], v[156:159]
 v_mfma_f32_16x16x32_bf16 v[160:163], v[56:59], v[136:139], v[160:163]
 v_mfma_f32_16x16x32_bf16 v[164:167], v[56:59], v[140:143], v[164:167]
 v_mfma_f32_16x16x32_bf16 v[168:171], v[60:63], v[136:139], v[168:171]
 v_mfma_f32_16x16x32_bf16 v[172:175], v[60:63], v[140:143], v[172:175]
 buffer_load_dwordx4 v[48:51], v22, s[16:19], s48 offen offset:0 sc1
 buffer_load_dwordx4 v[52:55], v22, s[16:19], s48 offen offset:256 sc1
 buffer_load_dwordx4 v[56:59], v22, s[16:19], s48 offen offset:512 sc1
 buffer_load_dwordx4 v[60:63], v22, s[16:19], s48 offen offset:768 sc1
 s_add_u32 s48, s48, 4096
 s_waitcnt vmcnt(40)
 s_branch pvy_280
pvy_279:
 s_waitcnt vmcnt(41)
 v_mfma_f32_16x16x32_bf16 v[148:151], a[0:3], v[64:67], 0
 v_mfma_f32_16x16x32_bf16 v[144:147], a[0:3], v[68:71], 0
 v_mfma_f32_16x16x32_bf16 v[156:159], a[4:7], v[64:67], 0
 v_mfma_f32_16x16x32_bf16 v[152:155], a[4:7], v[68:71], 0
 v_mfma_f32_16x16x32_bf16 v[164:167], a[8:11], v[64:67], 0
 v_mfma_f32_16x16x32_bf16 v[160:163], a[8:11], v[68:71], 0
 v_mfma_f32_16x16x32_bf16 v[172:175], a[12:15], v[64:67], 0
 v_mfma_f32_16x16x32_bf16 v[168:171], a[12:15], v[68:71], 0
 s_waitcnt vmcnt(37)
 v_mfma_f32_16x16x32_bf16 v[148:151], a[16:19], v[72:75], v[148:151]
 v_mfma_f32_16x16x32_bf16 v[144:147], a[16:19], v[76:79], v[144:147]
 v_mfma_f32_16x16x32_bf16 v[156:159], a[20:23], v[72:75], v[156:159]
 v_mfma_f32_16x16x32_bf16 v[152:155], a[20:23], v[76:79], v[152:155]
 v_mfma_f32_16x16x32_bf16 v[164:167], a[24:27], v[72:75], v[164:167]
 v_mfma_f32_16x16x32_bf16 v[160:163], a[24:27], v[76:79], v[160:163]
 v_mfma_f32_16x16x32_bf16 v[172:175], a[28:31], v[72:75], v[172:175]
 v_mfma_f32_16x16x32_bf16 v[168:171], a[28:31], v[76:79], v[168:171]
 s_waitcnt vmcnt(33)
 v_mfma_f32_16x16x32_bf16 v[148:151], a[32:35], v[80:83], v[148:151]
 v_mfma_f32_16x16x32_bf16 v[144:147], a[32:35], v[84:87], v[144:147]
 v_mfma_f32_16x16x32_bf16 v[156:159], a[36:39], v[80:83], v[156:159]
 v_mfma_f32_16x16x32_bf16 v[152:155], a[36:39], v[84:87], v[152:155]
 v_mfma_f32_16x16x32_bf16 v[164:167], a[40:43], v[80:83], v[164:167]
 v_mfma_f32_16x16x32_bf16 v[160:163], a[40:43], v[84:87], v[160:163]
 v_mfma_f32_16x16x32_bf16 v[172:175], a[44:47], v[80:83], v[172:175]
 v_mfma_f32_16x16x32_bf16 v[168:171], a[44:47], v[84:87], v[168:171]
 s_waitcnt vmcnt(29)
 v_mfma_f32_16x16x32_bf16 v[148:151], a[48:51], v[88:91], v[148:151]
 v_mfma_f32_16x16x32_bf16 v[144:147], a[48:51], v[92:95], v[144:147]
 v_mfma_f32_16x16x32_bf16 v[156:159], a[52:55], v[88:91], v[156:159]
 v_mfma_f32_16x16x32_bf16 v[152:155], a[52:55], v[92:95], v[152:155]
 v_mfma_f32_16x16x32_bf16 v[164:167], a[56:59], v[88:91], v[164:167]
 v_mfma_f32_16x16x32_bf16 v[160:163], a[56:59], v[92:95], v[160:163]
 v_mfma_f32_16x16x32_bf16 v[172:175], a[60:63], v[88:91], v[172:175]
 v_mfma_f32_16x16x32_bf16 v[168:171], a[60:63], v[92:95], v[168:171]
 s_waitcnt vmcnt(25)
 v_mfma_f32_16x16x32_bf16 v[144:147], v[32:35], v[128:131], v[144:147]
 v_mfma_f32_16x16x32_bf16 v[148:151], v[32:35], v[132:135], v[148:151]
 v_mfma_f32_16x16x32_bf16 v[152:155], v[36:39], v[128:131], v[152:155]
 v_mfma_f32_16x16x32_bf16 v[156:159], v[36:39], v[132:135], v[156:159]
 v_mfma_f32_16x16x32_bf16 v[160:163], v[40:43], v[128:131], v[160:163]
 v_mfma_f32_16x16x32_bf16 v[164:167], v[40:43], v[132:135], v[164:167]
 v_mfma_f32_16x16x32_bf16 v[168:171], v[44:47], v[128:131], v[168:171]
 v_mfma_f32_16x16x32_bf16 v[172:175], v[44:47], v[132:135], v[172:175]
 s_waitcnt vmcnt(21)
 v_mfma_f32_16x16x32_bf16 v[148:151], a[64:67], v[96:99], v[148:151]
 v_mfma_f32_16x16x32_bf16 v[144:147], a[64:67], v[100:103], v[144:147]
 v_mfma_f32_16x16x32_bf16 v[156:159], a[68:71], v[96:99], v[156:159]
 v_mfma_f32_16x16x32_bf16 v[152:155], a[68:71], v[100:103], v[152:155]
 v_mfma_f32_16x16x32_bf16 v[164:167], a[72:75], v[96:99], v[164:167]
 v_mfma_f32_16x16x32_bf16 v[160:163], a[72:75], v[100:103], v[160:163]
 v_mfma_f32_16x16x32_bf16 v[172:175], a[76:79], v[96:99], v[172:175]
 v_mfma_f32_16x16x32_bf16 v[168:171], a[76:79], v[100:103], v[168:171]
 s_waitcnt vmcnt(17)
 v_mfma_f32_16x16x32_bf16 v[148:151], a[80:83], v[104:107], v[148:151]
 v_mfma_f32_16x16x32_bf16 v[144:147], a[80:83], v[108:111], v[144:147]
 v_mfma_f32_16x16x32_bf16 v[156:159], a[84:87], v[104:107], v[156:159]
 v_mfma_f32_16x16x32_bf16 v[152:155], a[84:87], v[108:111], v[152:155]
 v_mfma_f32_16x16x32_bf16 v[164:167], a[88:91], v[104:107], v[164:167]
 v_mfma_f32_16x16x32_bf16 v[160:163], a[88:91], v[108:111], v[160:163]
 v_mfma_f32_16x16x32_bf16 v[172:175], a[92:95], v[104:107], v[172:175]
 v_mfma_f32_16x16x32_bf16 v[168:171], a[92:95], v[108:111], v[168:171]
 s_waitcnt vmcnt(13)
 v_mfma_f32_16x16x32_bf16 v[148:151], a[96:99], v[112:115], v[148:151]
 v_mfma_f32_16x16x32_bf16 v[144:147], a[96:99], v[116:119], v[144:147]
 v_mfma_f32_16x16x32_bf16 v[156:159], a[100:103], v[112:115], v[156:159]
 v_mfma_f32_16x16x32_bf16 v[152:155], a[100:103], v[116:119], v[152:155]
 v_mfma_f32_16x16x32_bf16 v[164:167], a[104:107], v[112:115], v[164:167]
 v_mfma_f32_16x16x32_bf16 v[160:163], a[104:107], v[116:119], v[160:163]
 v_mfma_f32_16x16x32_bf16 v[172:175], a[108:111], v[112:115], v[172:175]
 v_mfma_f32_16x16x32_bf16 v[168:171], a[108:111], v[116:119], v[168:171]
 s_waitcnt vmcnt(9)
 v_mfma_f32_16x16x32_bf16 v[148:151], a[112:115], v[120:123], v[148:151]
 v_mfma_f32_16x16x32_bf16 v[144:147], a[112:115], v[124:127], v[144:147]
 v_mfma_f32_16x16x32_bf16 v[156:159], a[116:119], v[120:123], v[156:159]
 v_mfma_f32_16x16x32_bf16 v[152:155], a[116:119], v[124:127], v[152:155]
 v_mfma_f32_16x16x32_bf16 v[164:167], a[120:123], v[120:123], v[164:167]
 v_mfma_f32_16x16x32_bf16 v[160:163], a[120:123], v[124:127], v[160:163]
 v_mfma_f32_16x16x32_bf16 v[172:175], a[124:127], v[120:123], v[172:175]
 v_mfma_f32_16x16x32_bf16 v[168:171], a[124:127], v[124:127], v[168:171]
 s_waitcnt vmcnt(5)
 v_mfma_f32_16x16x32_bf16 v[144:147], v[48:51], v[136:139], v[144:147]
 v_mfma_f32_16x16x32_bf16 v[148:151], v[48:51], v[140:143], v[148:151]
 v_mfma_f32_16x16x32_bf16 v[152:155], v[52:55], v[136:139], v[152:155]
 v_mfma_f32_16x16x32_bf16 v[156:159], v[52:55], v[140:143], v[156:159]
 v_mfma_f32_16x16x32_bf16 v[160:163], v[56:59], v[136:139], v[160:163]
 v_mfma_f32_16x16x32_bf16 v[164:167], v[56:59], v[140:143], v[164:167]
 v_mfma_f32_16x16x32_bf16 v[168:171], v[60:63], v[136:139], v[168:171]
 v_mfma_f32_16x16x32_bf16 v[172:175], v[60:63], v[140:143], v[172:175]
 s_waitcnt vmcnt(0)
pvy_280:
 s_or_b32 s21, s20, s65
 s_cbranch_scc1 lc_281
 s_sub_u32 s21, s2, 0
 s_cmp_ge_u32 s21, 640
 s_cbranch_scc1 lc_281
 v_mov_b32 v29, 1
 s_mov_b64 exec, 1
 buffer_atomic_add v29, v28, s[32:35], 0 offen sc0 sc1
 s_mov_b64 exec, -1
lc_281:
 v_sub_f32 v25, 1.0, v24
 v_cvt_pk_bf16_f32 v26, v25, v25
 v_lshlrev_b32 v25, 16, v26
 v_cvt_pk_bf16_f32 v26, v12, v12
 v_lshlrev_b32 v12, 16, v26
 v_cvt_pk_bf16_f32 v26, v13, v13
 v_lshlrev_b32 v13, 16, v26
 v_cvt_pk_bf16_f32 v26, v14, v14
 v_lshlrev_b32 v14, 16, v26
 v_cvt_pk_bf16_f32 v26, v15, v15
 v_lshlrev_b32 v15, 16, v26
 v_cvt_pk_bf16_f32 v26, v16, v16
 v_lshlrev_b32 v16, 16, v26
 v_cvt_pk_bf16_f32 v26, v17, v17
 v_lshlrev_b32 v17, 16, v26
 v_cvt_pk_bf16_f32 v26, v18, v18
 v_lshlrev_b32 v18, 16, v26
 v_cvt_pk_bf16_f32 v26, v19, v19
 v_lshlrev_b32 v19, 16, v26
 v_mul_f32 v12, v12, v25
 v_cvt_pk_bf16_f32 v26, v12, v12
 v_lshlrev_b32 v12, 16, v26
 v_mul_f32 v13, v13, v25
 v_cvt_pk_bf16_f32 v26, v13, v13
 v_lshlrev_b32 v13, 16, v26
 v_mul_f32 v14, v14, v25
 v_cvt_pk_bf16_f32 v26, v14, v14
 v_lshlrev_b32 v14, 16, v26
 v_mul_f32 v15, v15, v25
 v_cvt_pk_bf16_f32 v26, v15, v15
 v_lshlrev_b32 v15, 16, v26
 v_mul_f32 v16, v16, v25
 v_cvt_pk_bf16_f32 v26, v16, v16
 v_lshlrev_b32 v16, 16, v26
 v_mul_f32 v17, v17, v25
 v_cvt_pk_bf16_f32 v26, v17, v17
 v_lshlrev_b32 v17, 16, v26
 v_mul_f32 v18, v18, v25
 v_cvt_pk_bf16_f32 v26, v18, v18
 v_lshlrev_b32 v18, 16, v26
 v_mul_f32 v19, v19, v25
 v_cvt_pk_bf16_f32 v26, v19, v19
 v_lshlrev_b32 v19, 16, v26
 ds_write_b128 v10, v[144:147] offset:0
 ds_write_b128 v10, v[148:151] offset:1024
 ds_write_b128 v10, v[152:155] offset:2048
 ds_write_b128 v10, v[156:159] offset:3072
 ds_write_b128 v10, v[160:163] offset:4096
 ds_write_b128 v10, v[164:167] offset:5120
 ds_write_b128 v10, v[168:171] offset:6144
 ds_write_b128 v10, v[172:175] offset:7168
 s_waitcnt lgkmcnt(0)
 s_barrier
 ds_read_b128 v[176:179], v11 offset:0
 ds_read_b128 v[180:183], v11 offset:8192
 ds_read_b128 v[184:187], v11 offset:16384
 ds_read_b128 v[188:191], v11 offset:24576
 ds_read_b128 v[192:195], v11 offset:4096
 ds_read_b128 v[196:199], v11 offset:12288
 ds_read_b128 v[200:203], v11 offset:20480
 ds_read_b128 v[204:207], v11 offset:28672
 s_cmp_ge_u32 s40, 48
 s_cbranch_scc1 pvr_282
 s_waitcnt lgkmcnt(4)
 v_pk_add_f32 v[176:177], v[176:177], v[180:181]
 v_pk_add_f32 v[184:185], v[184:185], v[188:189]
 v_pk_add_f32 v[178:179], v[178:179], v[182:183]
 v_pk_add_f32 v[186:187], v[186:187], v[190:191]
 v_pk_add_f32 v[176:177], v[176:177], v[184:185]
 v_pk_add_f32 v[178:179], v[178:179], v[186:187]
 buffer_store_dwordx4 v[176:179], v4, s[24:27], s54 offen offset:0 sc1
 s_waitcnt lgkmcnt(0)
 v_pk_add_f32 v[192:193], v[192:193], v[196:197]
 v_pk_add_f32 v[200:201], v[200:201], v[204:205]
 v_pk_add_f32 v[194:195], v[194:195], v[198:199]
 v_pk_add_f32 v[202:203], v[202:203], v[206:207]
 v_pk_add_f32 v[192:193], v[192:193], v[200:201]
 v_pk_add_f32 v[194:195], v[194:195], v[202:203]
 buffer_store_dwordx4 v[192:195], v4, s[24:27], s54 offen offset:2048 sc1
 s_lshr_b32 s71, s40, 2
 s_lshl_b32 s71, s71, 7
 s_add_u32 s71, s71, 116736
 s_branch pvr_283
pvr_282:
 s_waitcnt lgkmcnt(4)
 v_pk_add_f32 v[176:177], v[176:177], v[180:181]
 v_pk_add_f32 v[184:185], v[184:185], v[188:189]
 v_pk_add_f32 v[178:179], v[178:179], v[182:183]
 v_pk_add_f32 v[186:187], v[186:187], v[190:191]
 v_pk_add_f32 v[176:177], v[176:177], v[184:185]
 v_pk_add_f32 v[178:179], v[178:179], v[186:187]
 v_cvt_pk_bf16_f32 v26, v176, v177
 v_lshlrev_b32 v176, 16, v26
 v_and_b32 v177, 0xffff0000, v26
 v_mul_f32 v176, v176, v24
 v_mul_f32 v177, v177, v24
 v_cvt_pk_bf16_f32 v26, v176, v177
 v_lshlrev_b32 v176, 16, v26
 v_and_b32 v177, 0xffff0000, v26
 v_add_f32 v176, v176, v12
 v_add_f32 v177, v177, v13
 v_cvt_pk_bf16_f32 v180, v176, v177
 v_cvt_pk_bf16_f32 v26, v178, v179
 v_lshlrev_b32 v178, 16, v26
 v_and_b32 v179, 0xffff0000, v26
 v_mul_f32 v178, v178, v24
 v_mul_f32 v179, v179, v24
 v_cvt_pk_bf16_f32 v26, v178, v179
 v_lshlrev_b32 v178, 16, v26
 v_and_b32 v179, 0xffff0000, v26
 v_add_f32 v178, v178, v14
 v_add_f32 v179, v179, v15
 v_cvt_pk_bf16_f32 v181, v178, v179
 buffer_store_dwordx2 v[180:181], v9, s[8:11], s46 offen offset:0
 s_waitcnt lgkmcnt(0)
 v_pk_add_f32 v[192:193], v[192:193], v[196:197]
 v_pk_add_f32 v[200:201], v[200:201], v[204:205]
 v_pk_add_f32 v[194:195], v[194:195], v[198:199]
 v_pk_add_f32 v[202:203], v[202:203], v[206:207]
 v_pk_add_f32 v[192:193], v[192:193], v[200:201]
 v_pk_add_f32 v[194:195], v[194:195], v[202:203]
 v_cvt_pk_bf16_f32 v26, v192, v193
 v_lshlrev_b32 v192, 16, v26
 v_and_b32 v193, 0xffff0000, v26
 v_mul_f32 v192, v192, v24
 v_mul_f32 v193, v193, v24
 v_cvt_pk_bf16_f32 v26, v192, v193
 v_lshlrev_b32 v192, 16, v26
 v_and_b32 v193, 0xffff0000, v26
 v_add_f32 v192, v192, v16
 v_add_f32 v193, v193, v17
 v_cvt_pk_bf16_f32 v196, v192, v193
 v_cvt_pk_bf16_f32 v26, v194, v195
 v_lshlrev_b32 v194, 16, v26
 v_and_b32 v195, 0xffff0000, v26
 v_mul_f32 v194, v194, v24
 v_mul_f32 v195, v195, v24
 v_cvt_pk_bf16_f32 v26, v194, v195
 v_lshlrev_b32 v194, 16, v26
 v_and_b32 v195, 0xffff0000, v26
 v_add_f32 v194, v194, v18
 v_add_f32 v195, v195, v19
 v_cvt_pk_bf16_f32 v197, v194, v195
 buffer_store_dwordx2 v[196:197], v9, s[8:11], s46 offen offset:64
pvr_283:
 s_branch pvy_277
pvy_278:
 s_sub_u32 s21, s2, 0
 s_cmp_ge_u32 s21, 640
 s_cbranch_scc1 lc_284
 s_cmp_lg_u32 s20, 0
 s_cbranch_scc1 lc_284x
 s_waitcnt vmcnt(2)
 s_mov_b64 exec, 1
 ds_write_b32 v30, v29 offset:12
 s_mov_b64 exec, -1
lc_284x:
 s_waitcnt lgkmcnt(0)
 s_barrier
 ds_read_b32 v23, v30 offset:12
lc_284:
 s_waitcnt lgkmcnt(0)
 v_readfirstlane_b32 s2, v23
 v_readfirstlane_b32 s67, v213
 s_barrier
 s_cmp_lt_u32 s2, 252
 s_cbranch_scc1 pae_285
 s_waitcnt vmcnt(0)
 s_cmp_eq_u32 s71, 0
 s_cbranch_scc1 paf_286
 v_mov_b32 v25, 0
 v_mov_b32 v26, 1
 s_mov_b64 exec, 1
 buffer_atomic_add v26, v25, s[72:75], s71 offen sc1
 s_mov_b64 exec, -1
 s_mov_b32 s71, 0
paf_286:
pae_285:
 s_add_u32 s21, s2, 0
 s_cmp_lt_u32 s2, 64
 s_cbranch_scc1 pv_loop
 s_sub_u32 s2, s2, 64
 s_add_u32 s21, s2, 64
 s_cmp_lt_u32 s2, 20
 s_cbranch_scc1 pv_loop
 s_sub_u32 s2, s2, 20
 s_add_u32 s21, s2, 104
 s_cmp_lt_u32 s2, 20
 s_cbranch_scc1 pv_loop
 s_sub_u32 s2, s2, 20
 s_add_u32 s21, s2, 84
 s_cmp_lt_u32 s2, 20
 s_cbranch_scc1 pv_loop
 s_sub_u32 s2, s2, 20
 s_add_u32 s21, s2, 124
 s_cmp_lt_u32 s2, 20
 s_cbranch_scc1 pv_loop
 s_sub_u32 s2, s2, 20
 s_add_u32 s21, s2, 144
 s_cmp_lt_u32 s2, 108
 s_cbranch_scc1 pv_loop
 s_sub_u32 s2, s2, 108
 s_branch main_fin
 s_branch queue
main_fin:
 s_waitcnt vmcnt(0)
main_end:
 s_endpgm
code_end:
.section .rodata,"a"
.p2align 6
.amdhsa_kernel gated_mix__memory_aug_recurrent_mem_tr__sliding_local_dilated__prompt_kernel
  .amdhsa_next_free_vgpr 512
  .amdhsa_next_free_sgpr 102
  .amdhsa_accum_offset 256
  .amdhsa_group_segment_fixed_size 0
  .amdhsa_kernarg_size 112
  .amdhsa_user_sgpr_count 2
  .amdhsa_user_sgpr_kernarg_segment_ptr 1
  .amdhsa_system_sgpr_workgroup_id_x 1
.end_amdhsa_kernel
.text
```

```asm
; @launch kernel=gated_mix__memory_aug_recurrent_mem_tr__sliding_local_dilated__prompt_kernel grid=(256,1,1) block=(256,1,1) lds=163840
.amdgcn_target "amdgcn-amd-amdhsa--gfx950"
.text
.globl gated_mix__memory_aug_recurrent_mem_tr__sliding_local_dilated__prompt_kernel
.p2align 8
.type gated_mix__memory_aug_recurrent_mem_tr__sliding_local_dilated__prompt_kernel,@function
gated_mix__memory_aug_recurrent_mem_tr__sliding_local_dilated__prompt_kernel:
 s_cmp_ge_u32 s2, 256
 s_cbranch_scc1 end0
 s_load_dwordx2 s[4:5], s[0:1], 96
 s_load_dwordx2 s[38:39], s[0:1], 104
 v_lshrrev_b32 v1, 6, v0
 v_and_b32 v2, 15, v0
 v_readfirstlane_b32 s20, v1
 v_and_b32 v1, 63, v0
 v_lshrrev_b32 v3, 4, v1
 s_getreg_b32 s50, hwreg(HW_REG_XCC_ID)
 s_and_b32 s50, s50, 7
 s_waitcnt lgkmcnt(0)
 s_mov_b32 s32, s4
 s_mov_b32 s33, s5
 s_mov_b32 s34, 256
 s_mov_b32 s35, 0x00020000
 s_getpc_b64 s[6:7]
cpf_pc:
 s_sub_u32 s6, s6, cpf_pc - gated_mix__memory_aug_recurrent_mem_tr__sliding_local_dilated__prompt_kernel
 s_subb_u32 s7, s7, 0
 s_lshr_b32 s21, s2, 3
 s_lshl_b32 s21, s21, 12
 v_lshl_add_u32 v28, v0, 4, s21
 v_min_u32 v28, code_end - gated_mix__memory_aug_recurrent_mem_tr__sliding_local_dilated__prompt_kernel - 16, v28
 global_load_dwordx4 a[252:255], v28, s[6:7]
 v_lshl_add_u32 v28, v0, 4, s21
 v_add_u32 v28, 0x20000, v28
 v_min_u32 v28, code_end - gated_mix__memory_aug_recurrent_mem_tr__sliding_local_dilated__prompt_kernel - 16, v28
 global_load_dwordx4 a[252:255], v28, s[6:7]
 v_mov_b32 v21, 0
 s_cmp_lg_u32 s20, 0
 s_cbranch_scc1 rk_1
 s_and_b32 s21, s50, 1
 s_lshl_b32 s21, s21, 7
 s_lshl_b32 s22, s50, 1
 s_and_b32 s22, s22, 12
 s_add_u32 s21, s21, s22
 v_mov_b32 v22, s21
 v_mov_b32 v23, 1
 s_mov_b64 exec, 1
 buffer_atomic_add v23, v22, s[32:35], 0 offen sc0 sc1
 s_waitcnt vmcnt(0)
 v_readfirstlane_b32 s51, v23
 s_lshl_b32 s22, s50, 5
 s_add_u32 s22, s22, s51
 s_cmp_lt_u32 s51, 32
 s_cbranch_scc1 rk_2
 v_mov_b32 v24, 72
 v_mov_b32 v25, 1
 buffer_atomic_add v25, v24, s[32:35], 0 offen sc0 sc1
 s_waitcnt vmcnt(0)
 v_readfirstlane_b32 s23, v25
 s_mov_b32 s101, 0
 s_mov_b64 exec, -1
 v_lshlrev_b32 v24, 2, v1
rk_3:
 s_sleep 8
 buffer_load_dword v25, v24, s[32:35], 0 offen sc1
 s_add_u32 s101, s101, 1
 s_cmp_gt_u32 s101, 131072
 s_cbranch_scc1 end0
 s_waitcnt vmcnt(0)
 v_readlane_b32 s21, v25, 0
 v_readlane_b32 s22, v25, 32
 s_add_u32 s21, s21, s22
 v_readlane_b32 s22, v25, 1
 s_add_u32 s21, s21, s22
 v_readlane_b32 s22, v25, 33
 s_add_u32 s21, s21, s22
 v_readlane_b32 s22, v25, 2
 s_add_u32 s21, s21, s22
 v_readlane_b32 s22, v25, 34
 s_add_u32 s21, s21, s22
 v_readlane_b32 s22, v25, 3
 s_add_u32 s21, s21, s22
 v_readlane_b32 s22, v25, 35
 s_add_u32 s21, s21, s22
 s_cmp_lt_u32 s21, 256
 s_cbranch_scc1 rk_3
 s_mov_b64 exec, 1
 s_mov_b32 s24, 0
rk_5:
 s_and_b32 s21, s24, 1
 s_lshl_b32 s21, s21, 5
 s_lshr_b32 s22, s24, 1
 s_add_u32 s21, s21, s22
 v_readlane_b32 s21, v25, s21
 s_min_u32 s21, s21, 32
 s_sub_u32 s25, 32, s21
 s_cmp_lt_u32 s23, s25
 s_cbranch_scc1 rk_4
 s_sub_u32 s23, s23, s25
 s_add_u32 s24, s24, 1
 s_cmp_lt_u32 s24, 8
 s_cbranch_scc1 rk_5
 s_branch end0
rk_4:
 s_lshl_b32 s22, s24, 5
 s_add_u32 s22, s22, s21
 s_add_u32 s22, s22, s23
 s_or_b32 s22, s22, 0x100
rk_2:
 v_mov_b32 v23, s22
 ds_write_b32 v21, v23
 s_waitcnt lgkmcnt(0)
 s_mov_b64 exec, -1
rk_1:
 s_barrier
 ds_read_b32 v23, v21
 s_waitcnt lgkmcnt(0)
 v_readfirstlane_b32 s22, v23
 s_barrier
 s_mov_b32 s84, 0
 s_mov_b32 s85, -1
 s_lshr_b32 s53, s22, 8
 s_and_b32 s22, s22, 255
 s_cmp_ge_u32 s22, 128
 s_cbranch_scc1 gemm_side
 s_lshr_b32 s50, s22, 4
 s_and_b32 s51, s22, 15
 s_mov_b32 s86, 0x3dd53b95
 s_load_dwordx2 s[4:5], s[0:1], 8
 s_load_dwordx4 s[36:39], s[0:1], 16
 s_load_dwordx4 s[40:43], s[0:1], 32
 s_load_dwordx2 s[44:45], s[0:1], 104
 s_lshr_b32 s55, s51, 2
 s_and_b32 s56, s51, 3
 s_lshl_b32 s57, s50, 2
 s_add_u32 s58, s57, s55
 s_add_u32 s59, s57, s20
 s_lshr_b32 s21, s51, 1
 s_xor_b32 s21, s21, s55
 s_andn2_b32 s21, 1, s21
 s_xor_b32 s85, s51, s21
 s_mul_i32 s87, s85, 5
 s_lshr_b32 s87, s87, 1
 s_and_b32 s79, s85, 1
 s_waitcnt lgkmcnt(0)
 s_add_u32 s8, s44, 78643200
 s_addc_u32 s9, s45, 0
 s_mov_b32 s10, 2162688
 s_mov_b32 s11, 0x00020000
 s_mov_b32 s16, s44
 s_mov_b32 s17, s45
 s_mov_b32 s18, 50331648
 s_mov_b32 s19, 0x00020000
 s_add_u32 s24, s44, 180355072
 s_addc_u32 s25, s45, 0
 s_mov_b32 s26, 67108864
 s_mov_b32 s27, 0x00020000
 s_mov_b32 s28, s4
 s_mov_b32 s29, s5
 s_mov_b32 s30, 10240
 s_mov_b32 s31, 0x00020000
 s_add_u32 s4, s44, 181305344
 s_addc_u32 s5, s45, 0
 s_mov_b32 s6, 1114112
 s_mov_b32 s7, 0x00020000
 v_mov_b32 v27, 10923
 v_add_u32 v54, 0, v1
 v_mul_u32_u24 v53, v54, v27
 v_lshrrev_b32 v53, 16, v53
 v_mul_u32_u24 v52, 6, v53
 v_sub_u32 v54, v54, v52
 v_mul_u32_u24 v52, 1280, v53
 v_lshl_add_u32 v46, v54, 4, v52
 v_bfe_u32 v52, v53, 1, 1
 v_mul_u32_u24 v52, 20, v52
 v_and_b32 v51, 1, v53
 v_add_u32 v52, v52, v51
 v_lshrrev_b32 v51, 3, v53
 v_mul_u32_u24 v51, 40, v51
 v_bfe_u32 v50, v53, 2, 1
 v_lshl_add_u32 v51, v50, 1, v51
 v_add_u32 v51, v51, v52
 v_mul_u32_u24 v51, 12288, v51
 v_lshl_add_u32 v247, v54, 4, v51
 v_lshrrev_b32 v51, 4, v53
 v_mul_u32_u24 v51, 40, v51
 v_bfe_u32 v50, v53, 2, 2
 v_lshl_add_u32 v51, v50, 1, v51
 v_add_u32 v51, v51, v52
 v_mul_u32_u24 v51, 12288, v51
 v_lshl_add_u32 v244, v54, 4, v51
 v_add_u32 v54, 64, v1
 v_mul_u32_u24 v53, v54, v27
 v_lshrrev_b32 v53, 16, v53
 v_mul_u32_u24 v52, 6, v53
 v_sub_u32 v54, v54, v52
 v_mul_u32_u24 v52, 1280, v53
 v_lshl_add_u32 v47, v54, 4, v52
 v_bfe_u32 v52, v53, 1, 1
 v_mul_u32_u24 v52, 20, v52
 v_and_b32 v51, 1, v53
 v_add_u32 v52, v52, v51
 v_lshrrev_b32 v51, 3, v53
 v_mul_u32_u24 v51, 40, v51
 v_bfe_u32 v50, v53, 2, 1
 v_lshl_add_u32 v51, v50, 1, v51
 v_add_u32 v51, v51, v52
 v_mul_u32_u24 v51, 12288, v51
 v_lshl_add_u32 v248, v54, 4, v51
 v_lshrrev_b32 v51, 4, v53
 v_mul_u32_u24 v51, 40, v51
 v_bfe_u32 v50, v53, 2, 2
 v_lshl_add_u32 v51, v50, 1, v51
 v_add_u32 v51, v51, v52
 v_mul_u32_u24 v51, 12288, v51
 v_lshl_add_u32 v245, v54, 4, v51
 v_add_u32 v54, 128, v1
 v_mul_u32_u24 v53, v54, v27
 v_lshrrev_b32 v53, 16, v53
 v_mul_u32_u24 v52, 6, v53
 v_sub_u32 v54, v54, v52
 v_mul_u32_u24 v52, 1280, v53
 v_lshl_add_u32 v48, v54, 4, v52
 v_bfe_u32 v52, v53, 1, 1
 v_mul_u32_u24 v52, 20, v52
 v_and_b32 v51, 1, v53
 v_add_u32 v52, v52, v51
 v_lshrrev_b32 v51, 3, v53
 v_mul_u32_u24 v51, 40, v51
 v_bfe_u32 v50, v53, 2, 1
 v_lshl_add_u32 v51, v50, 1, v51
 v_add_u32 v51, v51, v52
 v_mul_u32_u24 v51, 12288, v51
 v_lshl_add_u32 v249, v54, 4, v51
 v_lshrrev_b32 v51, 4, v53
 v_mul_u32_u24 v51, 40, v51
 v_bfe_u32 v50, v53, 2, 2
 v_lshl_add_u32 v51, v50, 1, v51
 v_add_u32 v51, v51, v52
 v_mul_u32_u24 v51, 12288, v51
 v_lshl_add_u32 v246, v54, 4, v51
 s_mul_i32 s80, s58, 384
 s_mul_i32 s22, s56, 96
 s_add_u32 s80, s80, s22
 s_mul_i32 s22, s20, 1966080
 s_add_u32 s80, s80, s22
 s_mul_i32 s81, s20, 40448
 s_mul_i32 s82, s59, 245760
 s_lshl_b32 s22, s87, 5
 s_add_u32 s82, s82, s22
 s_mul_i32 s88, s59, 384
 s_mov_b32 s12, s42
 s_mov_b32 s13, s43
 s_mov_b32 s14, 7864320
 s_mov_b32 s15, 0x00020000
 s_add_u32 s21, s82, 0
 s_add_u32 m0, s81, 12288
 s_nop 0
 buffer_load_dwordx4 v46, s[12:15], s21 offen lds
 s_add_u32 m0, s81, 13312
 s_nop 0
 buffer_load_dwordx4 v47, s[12:15], s21 offen lds
 s_add_u32 m0, s81, 14336
 s_nop 0
 buffer_load_dwordx4 v48, s[12:15], s21 offen lds
 s_add_u32 s21, s82, 40960
 s_add_u32 m0, s81, 15360
 s_nop 0
 buffer_load_dwordx4 v46, s[12:15], s21 offen lds
 s_add_u32 m0, s81, 16384
 s_nop 0
 buffer_load_dwordx4 v47, s[12:15], s21 offen lds
 s_add_u32 m0, s81, 17408
 s_nop 0
 buffer_load_dwordx4 v48, s[12:15], s21 offen lds
 s_add_u32 s21, s82, 81920
 s_add_u32 m0, s81, 18432
 s_nop 0
 buffer_load_dwordx4 v46, s[12:15], s21 offen lds
 s_add_u32 m0, s81, 19456
 s_nop 0
 buffer_load_dwordx4 v47, s[12:15], s21 offen lds
 s_add_u32 m0, s81, 20480
 s_nop 0
 buffer_load_dwordx4 v48, s[12:15], s21 offen lds
 s_add_u32 s21, s82, 122880
 s_add_u32 m0, s81, 21504
 s_nop 0
 buffer_load_dwordx4 v46, s[12:15], s21 offen lds
 s_add_u32 m0, s81, 22528
 s_nop 0
 buffer_load_dwordx4 v47, s[12:15], s21 offen lds
 s_add_u32 m0, s81, 23552
 s_nop 0
 buffer_load_dwordx4 v48, s[12:15], s21 offen lds
 s_add_u32 s21, s82, 163840
 s_add_u32 m0, s81, 24576
 s_nop 0
 buffer_load_dwordx4 v46, s[12:15], s21 offen lds
 s_add_u32 m0, s81, 25600
 s_nop 0
 buffer_load_dwordx4 v47, s[12:15], s21 offen lds
 s_add_u32 m0, s81, 26624
 s_nop 0
 buffer_load_dwordx4 v48, s[12:15], s21 offen lds
 s_add_u32 s21, s82, 204800
 s_add_u32 m0, s81, 27648
 s_nop 0
 buffer_load_dwordx4 v46, s[12:15], s21 offen lds
 s_add_u32 m0, s81, 28672
 s_nop 0
 buffer_load_dwordx4 v47, s[12:15], s21 offen lds
 s_add_u32 m0, s81, 29696
 s_nop 0
 buffer_load_dwordx4 v48, s[12:15], s21 offen lds
 s_mov_b32 s12, s40
 s_mov_b32 s13, s41
 s_mov_b32 s14, 7864320
 s_mov_b32 s15, 0x00020000
 s_mov_b32 s40, s38
 s_mov_b32 s41, s39
 s_mov_b32 s38, 7864320
 s_mov_b32 s39, 0x00020000
 s_mov_b32 s42, s38
 s_mov_b32 s43, s39
 v_lshrrev_b32 v250, 2, v2
 v_lshl_add_u32 v250, v3, 3, v250
 v_mul_u32_u24 v250, 96, v250
 v_and_b32 v251, 3, v2
 v_lshlrev_b32 v251, 3, v251
 v_add3_u32 v250, v250, v251, s81
 v_lshlrev_b32 v251, 4, v1
 v_add_u32 v251, s81, v251
 v_lshlrev_b32 v26, 2, v1
 v_mov_b32 v27, 2731
 v_add_u32 v54, 0, v1
 v_mul_u32_u24 v53, v54, v27
 v_lshrrev_b32 v53, 16, v53
 v_mul_u32_u24 v52, 24, v53
 v_sub_u32 v54, v54, v52
 v_bfe_u32 v52, v53, 1, 1
 v_xor_b32 v54, v54, v52
 v_mul_u32_u24 v52, 20, v52
 v_and_b32 v51, 1, v53
 v_add_u32 v52, v52, v51
 v_lshrrev_b32 v51, 2, v53
 v_lshl_add_u32 v52, v51, 1, v52
 v_mul_u32_u24 v52, 12288, v52
 v_subrev_u32 v52, 0, v52
 v_lshl_add_u32 v28, v54, 4, v52
 v_xor_b32 v31, 32, v28
 v_xor_b32 v34, 64, v28
 v_xor_b32 v37, 96, v28
 v_add_u32 v54, 64, v1
 v_mul_u32_u24 v53, v54, v27
 v_lshrrev_b32 v53, 16, v53
 v_mul_u32_u24 v52, 24, v53
 v_sub_u32 v54, v54, v52
 v_bfe_u32 v52, v53, 1, 1
 v_xor_b32 v54, v54, v52
 v_mul_u32_u24 v52, 20, v52
 v_and_b32 v51, 1, v53
 v_add_u32 v52, v52, v51
 v_lshrrev_b32 v51, 2, v53
 v_lshl_add_u32 v52, v51, 1, v52
 v_mul_u32_u24 v52, 12288, v52
 v_subrev_u32 v52, 1024, v52
 v_lshl_add_u32 v29, v54, 4, v52
 v_xor_b32 v32, 32, v29
 v_xor_b32 v35, 64, v29
 v_xor_b32 v38, 96, v29
 v_add_u32 v54, 128, v1
 v_mul_u32_u24 v53, v54, v27
 v_lshrrev_b32 v53, 16, v53
 v_mul_u32_u24 v52, 24, v53
 v_sub_u32 v54, v54, v52
 v_bfe_u32 v52, v53, 1, 1
 v_xor_b32 v54, v54, v52
 v_mul_u32_u24 v52, 20, v52
 v_and_b32 v51, 1, v53
 v_add_u32 v52, v52, v51
 v_lshrrev_b32 v51, 2, v53
 v_lshl_add_u32 v52, v51, 1, v52
 v_mul_u32_u24 v52, 12288, v52
 v_subrev_u32 v52, 2048, v52
 v_lshl_add_u32 v30, v54, 4, v52
 v_xor_b32 v33, 32, v30
 v_xor_b32 v36, 64, v30
 v_xor_b32 v39, 96, v30
 s_add_u32 m0, s81, 0
 s_add_u32 s21, s88, 0
 buffer_load_dwordx4 v28, s[12:15], s21 offen offset:0 lds
 buffer_load_dwordx4 v29, s[12:15], s21 offen offset:1024 lds
 buffer_load_dwordx4 v30, s[12:15], s21 offen offset:2048 lds
 s_add_u32 m0, s81, 3072
 s_add_u32 s21, s88, 49152
 buffer_load_dwordx4 v31, s[12:15], s21 offen offset:0 lds
 buffer_load_dwordx4 v32, s[12:15], s21 offen offset:1024 lds
 buffer_load_dwordx4 v33, s[12:15], s21 offen offset:2048 lds
 s_add_u32 m0, s81, 6144
 s_add_u32 s21, s88, 491520
 buffer_load_dwordx4 v34, s[12:15], s21 offen offset:0 lds
 buffer_load_dwordx4 v35, s[12:15], s21 offen offset:1024 lds
 buffer_load_dwordx4 v36, s[12:15], s21 offen offset:2048 lds
 s_add_u32 m0, s81, 9216
 s_add_u32 s21, s88, 540672
 buffer_load_dwordx4 v37, s[12:15], s21 offen offset:0 lds
 buffer_load_dwordx4 v38, s[12:15], s21 offen offset:1024 lds
 buffer_load_dwordx4 v39, s[12:15], s21 offen offset:2048 lds
 s_add_u32 s22, s80, 0
 buffer_load_dwordx4 v[220:223], v244, s[40:43], s22 offen
 buffer_load_dwordx4 v[224:227], v245, s[40:43], s22 offen
 buffer_load_dwordx4 v[228:231], v246, s[40:43], s22 offen
 s_add_u32 s22, s80, 983040
 buffer_load_dwordx4 v[232:235], v244, s[40:43], s22 offen
 buffer_load_dwordx4 v[236:239], v245, s[40:43], s22 offen
 buffer_load_dwordx4 v[240:243], v246, s[40:43], s22 offen
 v_and_b32 v56, 7, v2
 v_lshrrev_b32 v57, 3, v2
 v_lshlrev_b32 v16, 4, v1
 s_lshr_b32 s21, s20, 1
 s_lshl_b32 s21, s21, 14
 s_and_b32 s22, s20, 1
 s_mul_i32 s22, s22, 3072
 s_add_u32 s21, s21, s22
 v_add_u32 v4, s21, v16
 v_mov_b32 v58, 0x4444
 v_mov_b32 v59, 0xeeee
 v_cmp_eq_u32 vcc, 1, v57
 s_nop 1
 v_cndmask_b32 v25, v58, v59, vcc
 v_mul_u32_u24 v58, 40, v2
 v_lshl_add_u32 v58, v3, 3, v58
 s_mul_i32 s21, s20, 1920
 v_add_u32 v5, s21, v58
 v_lshrrev_b32 v58, 2, v1
 v_mul_u32_u24 v58, 40, v58
 v_and_b32 v59, 3, v1
 v_lshl_add_u32 v6, v59, 3, v58
 v_bfe_u32 v59, v1, 1, 1
 v_mul_u32_u24 v59, 3824, v59
 v_add_u32 v21, v6, v59
 s_lshl_b32 s21, s50, 4
 s_add_u32 s21, s21, s51
 s_lshl_b32 s21, s21, 9
 s_lshl_b32 s22, s20, 7
 s_add_u32 s21, s21, s22
 s_add_u32 s21, s21, 81920
 v_and_b32 v58, 1, v3
 v_lshlrev_b32 v58, 8, v58
 v_lshl_add_u32 v58, v56, 4, v58
 v_lshrrev_b32 v59, 1, v3
 v_lshl_add_u32 v58, v59, 3, v58
 v_add_u32 v7, s21, v58
 s_lshl_b32 s22, s58, 9
 s_lshl_b32 s23, s56, 7
 s_add_u32 s22, s22, s23
 s_add_u32 s22, s22, 376704
 v_lshlrev_b32 v58, 6, v3
 v_lshl_add_u32 v58, v56, 3, v58
 v_add_u32 v58, s22, v58
 s_cmp_eq_u32 s20, 2
 s_cselect_b64 vcc, -1, 0
 v_cndmask_b32 v7, v7, v58, vcc
 s_lshl_b32 s21, s59, 11
 s_add_u32 s21, s21, 81920
 v_add_u32 v8, s21, v16
 s_lshl_b32 s21, s59, 9
 s_add_u32 s21, s21, 376832
 v_lshl_add_u32 v9, v1, 3, s21
 s_mul_i32 s21, s20, 3072
 s_add_u32 s21, s21, 24576
 v_and_b32 v58, 0x39, v1
 v_bfe_u32 v59, v1, 1, 1
 v_lshl_or_b32 v58, v59, 2, v58
 v_bfe_u32 v59, v1, 2, 1
 v_lshl_or_b32 v58, v59, 1, v58
 v_lshl_add_u32 v10, v58, 4, s21
 s_mul_i32 s22, s56, 12
 s_cmp_eq_u32 s20, 2
 s_cselect_b64 vcc, -1, 0
 v_add_u32 v58, s22, v3
 v_add3_u32 v59, 0, v58, v3
 v_lshrrev_b32 v60, 1, v59
 v_and_b32 v59, 1, v59
 v_lshlrev_b32 v59, 3, v59
 v_lshl_add_u32 v61, v60, 7, v59
 v_lshl_add_u32 v61, v56, 4, v61
 s_lshr_b32 s21, s58, 1
 s_lshl_b32 s21, s21, 14
 s_and_b32 s22, s58, 1
 s_mul_i32 s22, s22, 3072
 s_add_u32 s21, s21, s22
 s_add_u32 s21, s21, 655360
 v_add_u32 v62, s21, v61
 v_lshl_add_u32 v61, v60, 8, v59
 v_lshl_add_u32 v61, v2, 4, v61
 s_mul_i32 s21, s58, 12288
 s_and_b32 s22, s20, 1
 s_mul_i32 s22, s22, 6144
 s_add_u32 s21, s21, s22
 v_add_u32 v61, s21, v61
 v_cndmask_b32 v18, v61, v62, vcc
 v_add_u32 v59, 8, v58
 v_lshrrev_b32 v60, 1, v59
 v_and_b32 v59, 1, v59
 v_lshlrev_b32 v59, 3, v59
 v_lshl_add_u32 v61, v60, 7, v59
 v_lshl_add_u32 v61, v56, 4, v61
 s_lshr_b32 s21, s58, 1
 s_lshl_b32 s21, s21, 14
 s_and_b32 s22, s58, 1
 s_mul_i32 s22, s22, 3072
 s_add_u32 s21, s21, s22
 s_add_u32 s21, s21, 655360
 v_add_u32 v62, s21, v61
 v_lshl_add_u32 v61, v60, 8, v59
 v_lshl_add_u32 v61, v2, 4, v61
 s_mul_i32 s21, s58, 12288
 s_and_b32 s22, s20, 1
 s_mul_i32 s22, s22, 6144
 s_add_u32 s21, s21, s22
 v_add_u32 v61, s21, v61
 v_cndmask_b32 v19, v61, v62, vcc
 s_mul_i32 s21, s20, 3072
 s_add_u32 s21, s21, 8192
 v_add_u32 v11, s21, v16
 v_and_b32 v58, 3, v1
 s_lshl_b32 s21, s20, 2
 v_add_u32 v59, s21, v58
 v_cmp_eq_u32 vcc, 10, v59
 s_nop 1
 v_cndmask_b32 v59, v59, 7, vcc
 v_cmp_eq_u32 vcc, 3, v58
 v_lshrrev_b32 v60, 5, v1
 v_mul_u32_u24 v60, 10, v60
 v_cndmask_b32 v59, v59, 3, vcc
 s_lshl_b32 s21, s79, 2
 v_add3_u32 v59, v59, v60, s21
 v_lshrrev_b32 v60, 1, v59
 v_lshlrev_b32 v60, 8, v60
 v_and_b32 v59, 1, v59
 v_lshl_add_u32 v60, v59, 3, v60
 v_bfe_u32 v59, v1, 2, 3
 v_lshl_add_u32 v60, v59, 4, v60
 v_add_u32 v12, 8192, v60
 s_mov_b32 s21, 0x07060100
 s_cmp_eq_u32 s20, 1
 s_cselect_b32 s21, 0x07060302, s21
 s_cmp_eq_u32 s20, 2
 s_cselect_b32 s21, 0x07060c0c, s21
 v_mov_b32 v59, s21
 v_mov_b32 v60, 0x03020100
 v_cndmask_b32 v14, v60, v59, vcc
 s_lshr_b32 s21, s85, 3
 s_lshl_b32 s21, s21, 14
 s_bfe_u32 s22, s85, 0x10002
 s_mul_i32 s22, s22, 3072
 s_add_u32 s21, s21, s22
 s_and_b32 s22, s85, 3
 s_lshl_b32 s22, s22, 8
 s_add_u32 s21, s21, s22
 s_lshl_b32 s22, s20, 10
 s_add_u32 s22, s22, s21
 v_lshl_add_u32 v13, v1, 2, s22
 v_lshlrev_b32 v59, 10, v3
 v_lshl_add_u32 v59, v2, 4, v59
 v_add_u32 v59, s21, v59
 s_cmp_eq_u32 s20, 3
 s_cselect_b64 vcc, -1, 0
 v_cndmask_b32 v13, v13, v59, vcc
 s_mov_b32 s91, 0x3c000000
 v_and_b32 v59, 1, v3
 v_lshrrev_b32 v60, 1, v3
 v_lshl_add_u32 v59, v59, 1, v60
 v_add_u32 v59, s87, v59
 v_lshrrev_b32 v60, 2, v59
 v_and_b32 v59, 3, v59
 v_lshlrev_b32 v59, 8, v59
 v_lshl_add_u32 v59, v60, 16, v59
 v_lshl_add_u32 v59, v2, 4, v59
 s_lshr_b32 s21, s59, 3
 s_lshl_b32 s21, s21, 14
 s_and_b32 s22, s59, 7
 s_lshl_b32 s22, s22, 10
 s_add_u32 s21, s21, s22
 v_add_u32 v15, s21, v59
 s_lshl_b32 s21, s79, 4
 s_lshl_b32 s76, -1, s21
 s_mov_b32 s77, 0xffff
 s_lshl_b32 s21, s79, 7
 v_or_b32 v17, s21, v16
 s_or_b32 s21, s21, 0xffffff7f
 v_and_b32 v20, s21, v16
 v_lshlrev_b32 v24, 3, v1
 v_cmp_gt_u32 s[60:61], 8, v2
 v_cmp_le_u32 s[62:63], 8, v2
 v_cmp_le_u32 s[72:73], 2, v3
 v_cmp_gt_u32 s[70:71], 48, v1
 s_nop 1
 s_and_b64 s[64:65], s[60:61], s[72:73]
 s_cmp_eq_u32 s20, 2
 s_cselect_b64 s[74:75], s[64:65], s[60:61]
 s_waitcnt vmcnt(18)
 ds_read_b64_tr_b16 v[64:65], v250 offset:12288
 ds_read_b64_tr_b16 v[66:67], v250 offset:12672
 ds_read_b64_tr_b16 v[88:89], v250 offset:12320
 ds_read_b64_tr_b16 v[90:91], v250 offset:12704
 ds_read_b64_tr_b16 v[112:113], v250 offset:12352
 ds_read_b64_tr_b16 v[114:115], v250 offset:12736
 ds_read_b64_tr_b16 v[68:69], v250 offset:15360
 ds_read_b64_tr_b16 v[70:71], v250 offset:15744
 ds_read_b64_tr_b16 v[92:93], v250 offset:15392
 ds_read_b64_tr_b16 v[94:95], v250 offset:15776
 ds_read_b64_tr_b16 v[116:117], v250 offset:15424
 ds_read_b64_tr_b16 v[118:119], v250 offset:15808
 ds_read_b64_tr_b16 v[72:73], v250 offset:18432
 ds_read_b64_tr_b16 v[74:75], v250 offset:18816
 ds_read_b64_tr_b16 v[96:97], v250 offset:18464
 ds_read_b64_tr_b16 v[98:99], v250 offset:18848
 ds_read_b64_tr_b16 v[120:121], v250 offset:18496
 ds_read_b64_tr_b16 v[122:123], v250 offset:18880
 ds_read_b64_tr_b16 v[76:77], v250 offset:21504
 ds_read_b64_tr_b16 v[78:79], v250 offset:21888
 ds_read_b64_tr_b16 v[100:101], v250 offset:21536
 ds_read_b64_tr_b16 v[102:103], v250 offset:21920
 ds_read_b64_tr_b16 v[124:125], v250 offset:21568
 ds_read_b64_tr_b16 v[126:127], v250 offset:21952
 ds_read_b64_tr_b16 v[80:81], v250 offset:24576
 ds_read_b64_tr_b16 v[82:83], v250 offset:24960
 ds_read_b64_tr_b16 v[104:105], v250 offset:24608
 ds_read_b64_tr_b16 v[106:107], v250 offset:24992
 ds_read_b64_tr_b16 v[128:129], v250 offset:24640
 ds_read_b64_tr_b16 v[130:131], v250 offset:25024
 ds_read_b64_tr_b16 v[84:85], v250 offset:27648
 ds_read_b64_tr_b16 v[86:87], v250 offset:28032
 ds_read_b64_tr_b16 v[108:109], v250 offset:27680
 ds_read_b64_tr_b16 v[110:111], v250 offset:28064
 ds_read_b64_tr_b16 v[132:133], v250 offset:27712
 ds_read_b64_tr_b16 v[134:135], v250 offset:28096
 s_waitcnt lgkmcnt(0)
 s_add_u32 m0, s81, 12288
 s_add_u32 s21, s88, 983040
 buffer_load_dwordx4 v28, s[12:15], s21 offen offset:0 lds
 buffer_load_dwordx4 v29, s[12:15], s21 offen offset:1024 lds
 buffer_load_dwordx4 v30, s[12:15], s21 offen offset:2048 lds
 s_add_u32 m0, s81, 15360
 s_add_u32 s21, s88, 1032192
 buffer_load_dwordx4 v31, s[12:15], s21 offen offset:0 lds
 buffer_load_dwordx4 v32, s[12:15], s21 offen offset:1024 lds
 buffer_load_dwordx4 v33, s[12:15], s21 offen offset:2048 lds
 s_add_u32 m0, s81, 18432
 s_add_u32 s21, s88, 1474560
 buffer_load_dwordx4 v34, s[12:15], s21 offen offset:0 lds
 buffer_load_dwordx4 v35, s[12:15], s21 offen offset:1024 lds
 buffer_load_dwordx4 v36, s[12:15], s21 offen offset:2048 lds
 s_add_u32 m0, s81, 21504
 s_add_u32 s21, s88, 1523712
 buffer_load_dwordx4 v37, s[12:15], s21 offen offset:0 lds
 buffer_load_dwordx4 v38, s[12:15], s21 offen offset:1024 lds
 buffer_load_dwordx4 v39, s[12:15], s21 offen offset:2048 lds
 s_add_u32 m0, s81, 24576
 s_add_u32 s21, s88, 98304
 buffer_load_dwordx4 v28, s[12:15], s21 offen offset:0 lds
 buffer_load_dwordx4 v29, s[12:15], s21 offen offset:1024 lds
 buffer_load_dwordx4 v30, s[12:15], s21 offen offset:2048 lds
 s_add_u32 m0, s81, 27648
 s_add_u32 s21, s88, 147456
 buffer_load_dwordx4 v31, s[12:15], s21 offen offset:0 lds
 buffer_load_dwordx4 v32, s[12:15], s21 offen offset:1024 lds
 buffer_load_dwordx4 v33, s[12:15], s21 offen offset:2048 lds
 s_add_u32 m0, s81, 30720
 s_add_u32 s21, s88, 589824
 buffer_load_dwordx4 v34, s[12:15], s21 offen offset:0 lds
 buffer_load_dwordx4 v35, s[12:15], s21 offen offset:1024 lds
 buffer_load_dwordx4 v36, s[12:15], s21 offen offset:2048 lds
 s_add_u32 m0, s81, 33792
 s_add_u32 s21, s88, 638976
 buffer_load_dwordx4 v37, s[12:15], s21 offen offset:0 lds
 buffer_load_dwordx4 v38, s[12:15], s21 offen offset:1024 lds
 buffer_load_dwordx4 v39, s[12:15], s21 offen offset:2048 lds
 v_lshrrev_b32 v40, 2, v2
 v_and_b32 v41, 3, v2
 v_lshl_add_u32 v41, v40, 3, v41
 v_mul_u32_u24 v41, 384, v41
 v_add_u32 v41, s81, v41
 v_lshrrev_b32 v40, 1, v2
 v_xor_b32 v40, v40, v3
 v_lshl_add_u32 v22, v40, 4, v41
 v_xor_b32 v40, 4, v40
 v_lshl_add_u32 v23, v40, 4, v41
 s_mul_i32 s64, s59, 40960
 s_lshl_b32 s21, s87, 10
 s_add_u32 s64, s64, s21
 s_add_u32 s64, s64, 1310720
 s_lshl_b32 s79, s59, 7
 s_and_b32 s21, s51, 12
 s_lshl_b32 s21, s21, 10
 s_add_u32 s79, s79, s21
 s_add_u32 s79, s79, 95232
 s_lshl_b32 s90, s58, 7
 s_add_u32 s90, s90, 19456
 s_cmp_eq_u32 s56, 0
 s_cselect_b32 s66, s90, 0x80000000
 s_bfe_u32 s82, s50, 0x10001
 s_lshl_b32 s82, s82, 5
 s_lshr_b32 s21, s50, 2
 s_add_u32 s82, s82, s21
 s_and_b32 s83, s50, 1
 s_lshl_b32 s83, s83, 4
 s_add_u32 s83, s83, 16
 s_waitcnt vmcnt(30)
 ds_read_b128 v[136:139], v22 offset:0
 ds_read_b128 v[140:143], v23 offset:0
 ds_read_b128 v[144:147], v22 offset:128
 s_waitcnt lgkmcnt(2)
 v_mfma_f32_16x16x32_bf16 v[40:43], v[136:139], v[64:67], 0
 ds_read_b128 v[148:151], v23 offset:128
 s_waitcnt vmcnt(27)
 ds_write_b128 v251, v[220:223] offset:36864
 v_mfma_f32_16x16x32_bf16 v[48:51], v[136:139], v[88:91], 0
 ds_write_b128 v251, v[224:227] offset:37888
 ds_write_b128 v251, v[228:231] offset:38912
 ds_read_b64_tr_b16 v[208:209], v250 offset:36864
 v_mfma_f32_16x16x32_bf16 v[56:59], v[136:139], v[112:115], 0
 ds_read_b64_tr_b16 v[210:211], v250 offset:37248
 ds_read_b64_tr_b16 v[212:213], v250 offset:36896
 ds_read_b64_tr_b16 v[214:215], v250 offset:37280
 ds_read_b64_tr_b16 v[216:217], v250 offset:36928
 s_waitcnt lgkmcnt(10)
 v_mfma_f32_16x16x32_bf16 v[40:43], v[140:143], v[68:71], v[40:43]
 ds_read_b128 v[136:139], v22 offset:256
 ds_read_b64_tr_b16 v[218:219], v250 offset:37312
 s_add_u32 s22, s80, 98304
 buffer_load_dwordx4 v[220:223], v244, s[40:43], s22 offen
 v_mfma_f32_16x16x32_bf16 v[48:51], v[140:143], v[92:95], v[48:51]
 buffer_load_dwordx4 v[224:227], v245, s[40:43], s22 offen
 buffer_load_dwordx4 v[228:231], v246, s[40:43], s22 offen
 v_mfma_f32_16x16x32_bf16 v[56:59], v[140:143], v[116:119], v[56:59]
 s_waitcnt lgkmcnt(11)
 v_mfma_f32_16x16x32_bf16 v[40:43], v[144:147], v[72:75], v[40:43]
 ds_read_b128 v[140:143], v23 offset:256
 v_mfma_f32_16x16x32_bf16 v[48:51], v[144:147], v[96:99], v[48:51]
 v_mfma_f32_16x16x32_bf16 v[56:59], v[144:147], v[120:123], v[56:59]
 s_waitcnt lgkmcnt(11)
 v_mfma_f32_16x16x32_bf16 v[40:43], v[148:151], v[76:79], v[40:43]
 ds_read_b128 v[144:147], v22 offset:1536
 v_mfma_f32_16x16x32_bf16 v[48:51], v[148:151], v[100:103], v[48:51]
 s_waitcnt lgkmcnt(2)
 v_lshlrev_b32 v27, 16, v208
 v_and_b32 v208, 0xffff0000, v208
 v_cvt_pk_f16_f32 v208, v27, v208
 v_accvgpr_write_b32 a60, v208
 v_mfma_f32_16x16x32_bf16 v[56:59], v[148:151], v[124:127], v[56:59]
 v_lshlrev_b32 v27, 16, v209
 v_and_b32 v209, 0xffff0000, v209
 v_cvt_pk_f16_f32 v209, v27, v209
 v_accvgpr_write_b32 a61, v209
 s_waitcnt lgkmcnt(3)
 v_mfma_f32_16x16x32_bf16 v[40:43], v[136:139], v[80:83], v[40:43]
 ds_read_b128 v[148:151], v23 offset:1536
 v_lshlrev_b32 v27, 16, v210
 v_and_b32 v210, 0xffff0000, v210
 v_cvt_pk_f16_f32 v210, v27, v210
 v_accvgpr_write_b32 a62, v210
 v_mfma_f32_16x16x32_bf16 v[48:51], v[136:139], v[104:107], v[48:51]
 v_lshlrev_b32 v27, 16, v211
 v_and_b32 v211, 0xffff0000, v211
 v_cvt_pk_f16_f32 v211, v27, v211
 v_accvgpr_write_b32 a63, v211
 v_lshlrev_b32 v27, 16, v212
 v_mfma_f32_16x16x32_bf16 v[56:59], v[136:139], v[128:131], v[56:59]
 v_and_b32 v212, 0xffff0000, v212
 v_cvt_pk_f16_f32 v212, v27, v212
 v_accvgpr_write_b32 a80, v212
 v_lshlrev_b32 v27, 16, v213
 s_waitcnt lgkmcnt(2)
 v_mfma_f32_16x16x32_bf16 v[40:43], v[140:143], v[84:87], v[40:43]
 ds_read_b128 v[136:139], v22 offset:1664
 v_and_b32 v213, 0xffff0000, v213
 v_cvt_pk_f16_f32 v213, v27, v213
 v_accvgpr_write_b32 a81, v213
 v_lshlrev_b32 v27, 16, v214
 v_mfma_f32_16x16x32_bf16 v[48:51], v[140:143], v[108:111], v[48:51]
 v_and_b32 v214, 0xffff0000, v214
 v_cvt_pk_f16_f32 v214, v27, v214
 v_accvgpr_write_b32 a82, v214
 v_lshlrev_b32 v27, 16, v215
 v_and_b32 v215, 0xffff0000, v215
 v_mfma_f32_16x16x32_bf16 v[56:59], v[140:143], v[132:135], v[56:59]
 v_cvt_pk_f16_f32 v215, v27, v215
 v_accvgpr_write_b32 a83, v215
 v_lshlrev_b32 v27, 16, v216
 v_and_b32 v216, 0xffff0000, v216
 s_waitcnt lgkmcnt(2)
 v_mfma_f32_16x16x32_bf16 v[44:47], v[144:147], v[64:67], 0
 ds_read_b128 v[140:143], v23 offset:1664
 v_cvt_pk_f16_f32 v216, v27, v216
 v_accvgpr_write_b32 a100, v216
 v_lshlrev_b32 v27, 16, v217
 v_and_b32 v217, 0xffff0000, v217
 v_mfma_f32_16x16x32_bf16 v[52:55], v[144:147], v[88:91], 0
 v_cvt_pk_f16_f32 v217, v27, v217
 v_accvgpr_write_b32 a101, v217
 v_lshlrev_b32 v27, 16, v218
 v_and_b32 v218, 0xffff0000, v218
 v_cvt_pk_f16_f32 v218, v27, v218
 v_mfma_f32_16x16x32_bf16 v[60:63], v[144:147], v[112:115], 0
 v_accvgpr_write_b32 a102, v218
 v_lshlrev_b32 v27, 16, v219
 v_and_b32 v219, 0xffff0000, v219
 v_cvt_pk_f16_f32 v219, v27, v219
 s_waitcnt lgkmcnt(2)
 v_mfma_f32_16x16x32_bf16 v[44:47], v[148:151], v[68:71], v[44:47]
 ds_read_b128 v[144:147], v22 offset:1792
 v_cvt_pk_f16_f32 v40, v40, v41
 v_accvgpr_write_b32 a103, v219
 v_accvgpr_write_b32 a120, v40
 v_cvt_pk_f16_f32 v42, v42, v43
 v_mfma_f32_16x16x32_bf16 v[52:55], v[148:151], v[92:95], v[52:55]
 v_accvgpr_write_b32 a121, v42
 v_cvt_pk_f16_f32 v48, v48, v49
 v_accvgpr_write_b32 a128, v48
 v_cvt_pk_f16_f32 v50, v50, v51
 v_accvgpr_write_b32 a129, v50
 v_mfma_f32_16x16x32_bf16 v[60:63], v[148:151], v[116:119], v[60:63]
 v_cvt_pk_f16_f32 v56, v56, v57
 v_accvgpr_write_b32 a136, v56
 v_cvt_pk_f16_f32 v58, v58, v59
 v_accvgpr_write_b32 a137, v58
 s_waitcnt lgkmcnt(2)
 v_mfma_f32_16x16x32_bf16 v[44:47], v[136:139], v[72:75], v[44:47]
 ds_read_b128 v[148:151], v23 offset:1792
 v_mfma_f32_16x16x32_bf16 v[52:55], v[136:139], v[96:99], v[52:55]
 v_mfma_f32_16x16x32_bf16 v[60:63], v[136:139], v[120:123], v[60:63]
 s_waitcnt lgkmcnt(2)
 v_mfma_f32_16x16x32_bf16 v[44:47], v[140:143], v[76:79], v[44:47]
 s_waitcnt vmcnt(15)
 ds_read_b128 v[136:139], v22 offset:12288
 v_mfma_f32_16x16x32_bf16 v[52:55], v[140:143], v[100:103], v[52:55]
 v_mfma_f32_16x16x32_bf16 v[60:63], v[140:143], v[124:127], v[60:63]
 s_waitcnt lgkmcnt(2)
 v_mfma_f32_16x16x32_bf16 v[44:47], v[144:147], v[80:83], v[44:47]
 ds_read_b128 v[140:143], v23 offset:12288
 v_mfma_f32_16x16x32_bf16 v[52:55], v[144:147], v[104:107], v[52:55]
 v_mfma_f32_16x16x32_bf16 v[60:63], v[144:147], v[128:131], v[60:63]
 s_waitcnt lgkmcnt(2)
 v_mfma_f32_16x16x32_bf16 v[44:47], v[148:151], v[84:87], v[44:47]
 ds_read_b128 v[144:147], v22 offset:12416
 s_add_u32 m0, s81, 0
 s_add_u32 s21, s88, 1081344
 v_mfma_f32_16x16x32_bf16 v[52:55], v[148:151], v[108:111], v[52:55]
 buffer_load_dwordx4 v28, s[12:15], s21 offen offset:0 lds
 v_mfma_f32_16x16x32_bf16 v[60:63], v[148:151], v[132:135], v[60:63]
 buffer_load_dwordx4 v29, s[12:15], s21 offen offset:1024 lds
 s_waitcnt lgkmcnt(2)
 v_mfma_f32_16x16x32_bf16 v[40:43], v[136:139], v[64:67], 0
 ds_read_b128 v[148:151], v23 offset:12416
 buffer_load_dwordx4 v30, s[12:15], s21 offen offset:2048 lds
 s_waitcnt vmcnt(30)
 v_mfma_f32_16x16x32_bf16 v[48:51], v[136:139], v[88:91], 0
 s_add_u32 m0, s81, 3072
 s_add_u32 s21, s88, 1130496
 ds_write_b128 v251, v[232:235] offset:36864
 v_mfma_f32_16x16x32_bf16 v[56:59], v[136:139], v[112:115], 0
 buffer_load_dwordx4 v31, s[12:15], s21 offen offset:0 lds
 ds_write_b128 v251, v[236:239] offset:37888
 s_waitcnt lgkmcnt(4)
 v_mfma_f32_16x16x32_bf16 v[40:43], v[140:143], v[68:71], v[40:43]
 ds_read_b128 v[136:139], v22 offset:12544
 v_cvt_pk_f16_f32 v44, v44, v45
 buffer_load_dwordx4 v32, s[12:15], s21 offen offset:1024 lds
 v_accvgpr_write_b32 a122, v44
 v_mfma_f32_16x16x32_bf16 v[48:51], v[140:143], v[92:95], v[48:51]
 v_cvt_pk_f16_f32 v46, v46, v47
 buffer_load_dwordx4 v33, s[12:15], s21 offen offset:2048 lds
 ds_write_b128 v251, v[240:243] offset:38912
 v_mfma_f32_16x16x32_bf16 v[56:59], v[140:143], v[116:119], v[56:59]
 v_accvgpr_write_b32 a123, v46
 s_add_u32 m0, s81, 6144
 s_add_u32 s21, s88, 1572864
 ds_read_b64_tr_b16 v[208:209], v250 offset:36864
 s_waitcnt lgkmcnt(6)
 v_mfma_f32_16x16x32_bf16 v[40:43], v[144:147], v[72:75], v[40:43]
 ds_read_b128 v[140:143], v23 offset:12544
 v_cvt_pk_f16_f32 v52, v52, v53
 buffer_load_dwordx4 v34, s[12:15], s21 offen offset:0 lds
 ds_read_b64_tr_b16 v[210:211], v250 offset:37248
 v_mfma_f32_16x16x32_bf16 v[48:51], v[144:147], v[96:99], v[48:51]
 v_accvgpr_write_b32 a130, v52
 buffer_load_dwordx4 v35, s[12:15], s21 offen offset:1024 lds
 ds_read_b64_tr_b16 v[212:213], v250 offset:36896
 ds_read_b64_tr_b16 v[214:215], v250 offset:37280
 v_mfma_f32_16x16x32_bf16 v[56:59], v[144:147], v[120:123], v[56:59]
 v_cvt_pk_f16_f32 v54, v54, v55
 buffer_load_dwordx4 v36, s[12:15], s21 offen offset:2048 lds
 ds_read_b64_tr_b16 v[216:217], v250 offset:36928
 s_waitcnt lgkmcnt(10)
 v_mfma_f32_16x16x32_bf16 v[40:43], v[148:151], v[76:79], v[40:43]
 ds_read_b128 v[144:147], v22 offset:13824
 v_accvgpr_write_b32 a131, v54
 s_add_u32 m0, s81, 9216
 s_add_u32 s21, s88, 1622016
 ds_read_b64_tr_b16 v[218:219], v250 offset:37312
 v_mfma_f32_16x16x32_bf16 v[48:51], v[148:151], v[100:103], v[48:51]
 v_cvt_pk_f16_f32 v60, v60, v61
 buffer_load_dwordx4 v37, s[12:15], s21 offen offset:0 lds
 s_add_u32 s22, s80, 1081344
 v_accvgpr_write_b32 a138, v60
 v_mfma_f32_16x16x32_bf16 v[56:59], v[148:151], v[124:127], v[56:59]
 v_cvt_pk_f16_f32 v62, v62, v63
 buffer_load_dwordx4 v38, s[12:15], s21 offen offset:1024 lds
 v_accvgpr_write_b32 a139, v62
 s_waitcnt lgkmcnt(9)
 v_mfma_f32_16x16x32_bf16 v[40:43], v[136:139], v[80:83], v[40:43]
 ds_read_b128 v[148:151], v23 offset:13824
 buffer_load_dwordx4 v39, s[12:15], s21 offen offset:2048 lds
 buffer_load_dwordx4 v[232:235], v244, s[40:43], s22 offen
 v_mfma_f32_16x16x32_bf16 v[48:51], v[136:139], v[104:107], v[48:51]
 buffer_load_dwordx4 v[236:239], v245, s[40:43], s22 offen
 buffer_load_dwordx4 v[240:243], v246, s[40:43], s22 offen
 v_mfma_f32_16x16x32_bf16 v[56:59], v[136:139], v[128:131], v[56:59]
 s_waitcnt lgkmcnt(7)
 v_mfma_f32_16x16x32_bf16 v[40:43], v[140:143], v[84:87], v[40:43]
 ds_read_b128 v[136:139], v22 offset:13952
 v_mfma_f32_16x16x32_bf16 v[48:51], v[140:143], v[108:111], v[48:51]
 v_mfma_f32_16x16x32_bf16 v[56:59], v[140:143], v[132:135], v[56:59]
 s_waitcnt lgkmcnt(3)
 v_mfma_f32_16x16x32_bf16 v[44:47], v[144:147], v[64:67], 0
 ds_read_b128 v[140:143], v23 offset:13952
 v_mfma_f32_16x16x32_bf16 v[52:55], v[144:147], v[88:91], 0
 s_waitcnt lgkmcnt(3)
 v_lshlrev_b32 v27, 16, v208
 v_and_b32 v208, 0xffff0000, v208
 v_cvt_pk_f16_f32 v208, v27, v208
 v_accvgpr_write_b32 a64, v208
 v_mfma_f32_16x16x32_bf16 v[60:63], v[144:147], v[112:115], 0
 v_lshlrev_b32 v27, 16, v209
 v_and_b32 v209, 0xffff0000, v209
 v_cvt_pk_f16_f32 v209, v27, v209
 v_accvgpr_write_b32 a65, v209
 s_waitcnt lgkmcnt(2)
 v_mfma_f32_16x16x32_bf16 v[44:47], v[148:151], v[68:71], v[44:47]
 ds_read_b128 v[144:147], v22 offset:14080
 v_cvt_pk_f16_f32 v40, v40, v41
 v_lshlrev_b32 v27, 16, v210
 v_and_b32 v210, 0xffff0000, v210
 v_cvt_pk_f16_f32 v210, v27, v210
 v_mfma_f32_16x16x32_bf16 v[52:55], v[148:151], v[92:95], v[52:55]
 v_accvgpr_write_b32 a124, v40
 v_accvgpr_write_b32 a66, v210
 v_lshlrev_b32 v27, 16, v211
 v_and_b32 v211, 0xffff0000, v211
 v_cvt_pk_f16_f32 v211, v27, v211
 v_mfma_f32_16x16x32_bf16 v[60:63], v[148:151], v[116:119], v[60:63]
 v_cvt_pk_f16_f32 v42, v42, v43
 v_accvgpr_write_b32 a67, v211
 v_lshlrev_b32 v27, 16, v212
 v_and_b32 v212, 0xffff0000, v212
 s_waitcnt lgkmcnt(2)
 v_mfma_f32_16x16x32_bf16 v[44:47], v[136:139], v[72:75], v[44:47]
 ds_read_b128 v[148:151], v23 offset:14080
 v_accvgpr_write_b32 a125, v42
 v_cvt_pk_f16_f32 v212, v27, v212
 v_accvgpr_write_b32 a84, v212
 v_lshlrev_b32 v27, 16, v213
 v_mfma_f32_16x16x32_bf16 v[52:55], v[136:139], v[96:99], v[52:55]
 v_cvt_pk_f16_f32 v48, v48, v49
 v_and_b32 v213, 0xffff0000, v213
 v_cvt_pk_f16_f32 v213, v27, v213
 v_accvgpr_write_b32 a85, v213
 v_lshlrev_b32 v27, 16, v214
 v_mfma_f32_16x16x32_bf16 v[60:63], v[136:139], v[120:123], v[60:63]
 v_accvgpr_write_b32 a132, v48
 v_and_b32 v214, 0xffff0000, v214
 v_cvt_pk_f16_f32 v214, v27, v214
 v_accvgpr_write_b32 a86, v214
 s_waitcnt lgkmcnt(2)
 v_mfma_f32_16x16x32_bf16 v[44:47], v[140:143], v[76:79], v[44:47]
 s_waitcnt vmcnt(18)
 ds_read_b128 v[136:139], v22 offset:24576
 v_cvt_pk_f16_f32 v50, v50, v51
 v_lshlrev_b32 v27, 16, v215
 v_and_b32 v215, 0xffff0000, v215
 v_cvt_pk_f16_f32 v215, v27, v215
 v_mfma_f32_16x16x32_bf16 v[52:55], v[140:143], v[100:103], v[52:55]
 v_accvgpr_write_b32 a133, v50
 v_accvgpr_write_b32 a87, v215
 v_lshlrev_b32 v27, 16, v216
 v_and_b32 v216, 0xffff0000, v216
 v_cvt_pk_f16_f32 v216, v27, v216
 v_mfma_f32_16x16x32_bf16 v[60:63], v[140:143], v[124:127], v[60:63]
 v_cvt_pk_f16_f32 v56, v56, v57
 v_accvgpr_write_b32 a104, v216
 v_lshlrev_b32 v27, 16, v217
 v_and_b32 v217, 0xffff0000, v217
 s_waitcnt lgkmcnt(2)
 v_mfma_f32_16x16x32_bf16 v[44:47], v[144:147], v[80:83], v[44:47]
 ds_read_b128 v[140:143], v23 offset:24576
 v_accvgpr_write_b32 a140, v56
 v_cvt_pk_f16_f32 v217, v27, v217
 v_accvgpr_write_b32 a105, v217
 v_lshlrev_b32 v27, 16, v218
 v_mfma_f32_16x16x32_bf16 v[52:55], v[144:147], v[104:107], v[52:55]
 v_cvt_pk_f16_f32 v58, v58, v59
 v_and_b32 v218, 0xffff0000, v218
 v_cvt_pk_f16_f32 v218, v27, v218
 v_accvgpr_write_b32 a106, v218
 v_lshlrev_b32 v27, 16, v219
 v_mfma_f32_16x16x32_bf16 v[60:63], v[144:147], v[128:131], v[60:63]
 v_accvgpr_write_b32 a141, v58
 v_and_b32 v219, 0xffff0000, v219
 v_cvt_pk_f16_f32 v219, v27, v219
 v_accvgpr_write_b32 a107, v219
 s_waitcnt lgkmcnt(2)
 v_mfma_f32_16x16x32_bf16 v[44:47], v[148:151], v[84:87], v[44:47]
 ds_read_b128 v[144:147], v22 offset:24704
 s_add_u32 m0, s81, 12288
 s_add_u32 s21, s88, 1966080
 v_mfma_f32_16x16x32_bf16 v[52:55], v[148:151], v[108:111], v[52:55]
 buffer_load_dwordx4 v28, s[12:15], s21 offen offset:0 lds
 v_mfma_f32_16x16x32_bf16 v[60:63], v[148:151], v[132:135], v[60:63]
 buffer_load_dwordx4 v29, s[12:15], s21 offen offset:1024 lds
 s_waitcnt lgkmcnt(2)
 v_mfma_f32_16x16x32_bf16 v[40:43], v[136:139], v[64:67], 0
 ds_read_b128 v[148:151], v23 offset:24704
 buffer_load_dwordx4 v30, s[12:15], s21 offen offset:2048 lds
 s_waitcnt vmcnt(18)
 v_mfma_f32_16x16x32_bf16 v[48:51], v[136:139], v[88:91], 0
 s_add_u32 m0, s81, 15360
 s_add_u32 s21, s88, 2015232
 ds_write_b128 v251, v[220:223] offset:36864
 v_mfma_f32_16x16x32_bf16 v[56:59], v[136:139], v[112:115], 0
 buffer_load_dwordx4 v31, s[12:15], s21 offen offset:0 lds
 ds_write_b128 v251, v[224:227] offset:37888
 s_waitcnt lgkmcnt(4)
 v_mfma_f32_16x16x32_bf16 v[40:43], v[140:143], v[68:71], v[40:43]
 ds_read_b128 v[136:139], v22 offset:24832
 v_cvt_pk_f16_f32 v44, v44, v45
 buffer_load_dwordx4 v32, s[12:15], s21 offen offset:1024 lds
 v_accvgpr_write_b32 a126, v44
 v_mfma_f32_16x16x32_bf16 v[48:51], v[140:143], v[92:95], v[48:51]
 v_cvt_pk_f16_f32 v46, v46, v47
 buffer_load_dwordx4 v33, s[12:15], s21 offen offset:2048 lds
 ds_write_b128 v251, v[228:231] offset:38912
 v_mfma_f32_16x16x32_bf16 v[56:59], v[140:143], v[116:119], v[56:59]
 v_accvgpr_write_b32 a127, v46
 s_add_u32 m0, s81, 18432
 s_add_u32 s21, s88, 2457600
 ds_read_b64_tr_b16 v[208:209], v250 offset:36864
 s_waitcnt lgkmcnt(6)
 v_mfma_f32_16x16x32_bf16 v[40:43], v[144:147], v[72:75], v[40:43]
 ds_read_b128 v[140:143], v23 offset:24832
 v_cvt_pk_f16_f32 v52, v52, v53
 buffer_load_dwordx4 v34, s[12:15], s21 offen offset:0 lds
 ds_read_b64_tr_b16 v[210:211], v250 offset:37248
 v_mfma_f32_16x16x32_bf16 v[48:51], v[144:147], v[96:99], v[48:51]
 v_accvgpr_write_b32 a134, v52
 buffer_load_dwordx4 v35, s[12:15], s21 offen offset:1024 lds
 ds_read_b64_tr_b16 v[212:213], v250 offset:36896
 ds_read_b64_tr_b16 v[214:215], v250 offset:37280
 v_mfma_f32_16x16x32_bf16 v[56:59], v[144:147], v[120:123], v[56:59]
 v_cvt_pk_f16_f32 v54, v54, v55
 buffer_load_dwordx4 v36, s[12:15], s21 offen offset:2048 lds
 ds_read_b64_tr_b16 v[216:217], v250 offset:36928
 s_waitcnt lgkmcnt(10)
 v_mfma_f32_16x16x32_bf16 v[40:43], v[148:151], v[76:79], v[40:43]
 ds_read_b128 v[144:147], v22 offset:26112
 v_accvgpr_write_b32 a135, v54
 s_add_u32 m0, s81, 21504
 s_add_u32 s21, s88, 2506752
 ds_read_b64_tr_b16 v[218:219], v250 offset:37312
 v_mfma_f32_16x16x32_bf16 v[48:51], v[148:151], v[100:103], v[48:51]
 v_cvt_pk_f16_f32 v60, v60, v61
 buffer_load_dwordx4 v37, s[12:15], s21 offen offset:0 lds
 s_add_u32 s22, s80, 196608
 v_accvgpr_write_b32 a142, v60
 v_mfma_f32_16x16x32_bf16 v[56:59], v[148:151], v[124:127], v[56:59]
 v_cvt_pk_f16_f32 v62, v62, v63
 buffer_load_dwordx4 v38, s[12:15], s21 offen offset:1024 lds
 v_accvgpr_write_b32 a143, v62
 s_waitcnt lgkmcnt(9)
 v_mfma_f32_16x16x32_bf16 v[40:43], v[136:139], v[80:83], v[40:43]
 ds_read_b128 v[148:151], v23 offset:26112
 buffer_load_dwordx4 v39, s[12:15], s21 offen offset:2048 lds
 buffer_load_dwordx4 v[220:223], v247, s[40:43], s22 offen
 v_mfma_f32_16x16x32_bf16 v[48:51], v[136:139], v[104:107], v[48:51]
 buffer_load_dwordx4 v[224:227], v248, s[40:43], s22 offen
 buffer_load_dwordx4 v[228:231], v249, s[40:43], s22 offen
 v_mfma_f32_16x16x32_bf16 v[56:59], v[136:139], v[128:131], v[56:59]
 s_waitcnt lgkmcnt(7)
 v_mfma_f32_16x16x32_bf16 v[40:43], v[140:143], v[84:87], v[40:43]
 ds_read_b128 v[136:139], v22 offset:26240
 v_mfma_f32_16x16x32_bf16 v[48:51], v[140:143], v[108:111], v[48:51]
 v_mfma_f32_16x16x32_bf16 v[56:59], v[140:143], v[132:135], v[56:59]
 s_waitcnt lgkmcnt(3)
 v_mfma_f32_16x16x32_bf16 v[44:47], v[144:147], v[64:67], 0
 ds_read_b128 v[140:143], v23 offset:26240
 v_mfma_f32_16x16x32_bf16 v[52:55], v[144:147], v[88:91], 0
 s_waitcnt lgkmcnt(3)
 v_lshlrev_b32 v27, 16, v208
 v_and_b32 v208, 0xffff0000, v208
 v_cvt_pk_f16_f32 v208, v27, v208
 v_accvgpr_write_b32 a68, v208
 v_mfma_f32_16x16x32_bf16 v[60:63], v[144:147], v[112:115], 0
 v_lshlrev_b32 v27, 16, v209
 v_and_b32 v209, 0xffff0000, v209
 v_cvt_pk_f16_f32 v209, v27, v209
 v_accvgpr_write_b32 a69, v209
 s_waitcnt lgkmcnt(2)
 v_mfma_f32_16x16x32_bf16 v[44:47], v[148:151], v[68:71], v[44:47]
 ds_read_b128 v[144:147], v22 offset:26368
 v_cvt_pk_f16_f32 v40, v40, v41
 v_lshlrev_b32 v27, 16, v210
 v_and_b32 v210, 0xffff0000, v210
 v_cvt_pk_f16_f32 v210, v27, v210
 v_mfma_f32_16x16x32_bf16 v[52:55], v[148:151], v[92:95], v[52:55]
 v_accvgpr_write_b32 a144, v40
 v_accvgpr_write_b32 a70, v210
 v_lshlrev_b32 v27, 16, v211
 v_and_b32 v211, 0xffff0000, v211
 v_cvt_pk_f16_f32 v211, v27, v211
 v_mfma_f32_16x16x32_bf16 v[60:63], v[148:151], v[116:119], v[60:63]
 v_cvt_pk_f16_f32 v42, v42, v43
 v_accvgpr_write_b32 a71, v211
 v_lshlrev_b32 v27, 16, v212
 v_and_b32 v212, 0xffff0000, v212
 s_waitcnt lgkmcnt(2)
 v_mfma_f32_16x16x32_bf16 v[44:47], v[136:139], v[72:75], v[44:47]
 ds_read_b128 v[148:151], v23 offset:26368
 v_accvgpr_write_b32 a145, v42
 v_cvt_pk_f16_f32 v212, v27, v212
 v_accvgpr_write_b32 a88, v212
 v_lshlrev_b32 v27, 16, v213
 v_mfma_f32_16x16x32_bf16 v[52:55], v[136:139], v[96:99], v[52:55]
 v_cvt_pk_f16_f32 v48, v48, v49
 v_and_b32 v213, 0xffff0000, v213
 v_cvt_pk_f16_f32 v213, v27, v213
 v_accvgpr_write_b32 a89, v213
 v_lshlrev_b32 v27, 16, v214
 v_mfma_f32_16x16x32_bf16 v[60:63], v[136:139], v[120:123], v[60:63]
 v_accvgpr_write_b32 a152, v48
 v_and_b32 v214, 0xffff0000, v214
 v_cvt_pk_f16_f32 v214, v27, v214
 v_accvgpr_write_b32 a90, v214
 s_waitcnt lgkmcnt(2)
 v_mfma_f32_16x16x32_bf16 v[44:47], v[140:143], v[76:79], v[44:47]
 s_waitcnt vmcnt(18)
 ds_read_b128 v[136:139], v22 offset:0
 v_cvt_pk_f16_f32 v50, v50, v51
 v_lshlrev_b32 v27, 16, v215
 v_and_b32 v215, 0xffff0000, v215
 v_cvt_pk_f16_f32 v215, v27, v215
 v_mfma_f32_16x16x32_bf16 v[52:55], v[140:143], v[100:103], v[52:55]
 v_accvgpr_write_b32 a153, v50
 v_accvgpr_write_b32 a91, v215
 v_lshlrev_b32 v27, 16, v216
 v_and_b32 v216, 0xffff0000, v216
 v_cvt_pk_f16_f32 v216, v27, v216
 v_mfma_f32_16x16x32_bf16 v[60:63], v[140:143], v[124:127], v[60:63]
 v_cvt_pk_f16_f32 v56, v56, v57
 v_accvgpr_write_b32 a108, v216
 v_lshlrev_b32 v27, 16, v217
 v_and_b32 v217, 0xffff0000, v217
 s_waitcnt lgkmcnt(2)
 v_mfma_f32_16x16x32_bf16 v[44:47], v[144:147], v[80:83], v[44:47]
 ds_read_b128 v[140:143], v23 offset:0
 v_accvgpr_write_b32 a160, v56
 v_cvt_pk_f16_f32 v217, v27, v217
 v_accvgpr_write_b32 a109, v217
 v_lshlrev_b32 v27, 16, v218
 v_mfma_f32_16x16x32_bf16 v[52:55], v[144:147], v[104:107], v[52:55]
 v_cvt_pk_f16_f32 v58, v58, v59
 v_and_b32 v218, 0xffff0000, v218
 v_cvt_pk_f16_f32 v218, v27, v218
 v_accvgpr_write_b32 a110, v218
 v_lshlrev_b32 v27, 16, v219
 v_mfma_f32_16x16x32_bf16 v[60:63], v[144:147], v[128:131], v[60:63]
 v_accvgpr_write_b32 a161, v58
 v_and_b32 v219, 0xffff0000, v219
 v_cvt_pk_f16_f32 v219, v27, v219
 v_accvgpr_write_b32 a111, v219
 s_waitcnt lgkmcnt(2)
 v_mfma_f32_16x16x32_bf16 v[44:47], v[148:151], v[84:87], v[44:47]
 ds_read_b128 v[144:147], v22 offset:128
 s_add_u32 m0, s81, 24576
 s_add_u32 s21, s88, 2949120
 v_mfma_f32_16x16x32_bf16 v[52:55], v[148:151], v[108:111], v[52:55]
 buffer_load_dwordx4 v28, s[12:15], s21 offen offset:0 lds
 v_mfma_f32_16x16x32_bf16 v[60:63], v[148:151], v[132:135], v[60:63]
 buffer_load_dwordx4 v29, s[12:15], s21 offen offset:1024 lds
 s_waitcnt lgkmcnt(2)
 v_mfma_f32_16x16x32_bf16 v[40:43], v[136:139], v[64:67], 0
 ds_read_b128 v[148:151], v23 offset:128
 buffer_load_dwordx4 v30, s[12:15], s21 offen offset:2048 lds
 s_waitcnt vmcnt(18)
 v_mfma_f32_16x16x32_bf16 v[48:51], v[136:139], v[88:91], 0
 s_add_u32 m0, s81, 27648
 s_add_u32 s21, s88, 2998272
 ds_write_b128 v251, v[232:235] offset:36864
 v_mfma_f32_16x16x32_bf16 v[56:59], v[136:139], v[112:115], 0
 buffer_load_dwordx4 v31, s[12:15], s21 offen offset:0 lds
 ds_write_b128 v251, v[236:239] offset:37888
 s_waitcnt lgkmcnt(4)
 v_mfma_f32_16x16x32_bf16 v[40:43], v[140:143], v[68:71], v[40:43]
 ds_read_b128 v[136:139], v22 offset:256
 v_cvt_pk_f16_f32 v44, v44, v45
 buffer_load_dwordx4 v32, s[12:15], s21 offen offset:1024 lds
 v_accvgpr_write_b32 a146, v44
 v_mfma_f32_16x16x32_bf16 v[48:51], v[140:143], v[92:95], v[48:51]
 v_cvt_pk_f16_f32 v46, v46, v47
 buffer_load_dwordx4 v33, s[12:15], s21 offen offset:2048 lds
 ds_write_b128 v251, v[240:243] offset:38912
 v_mfma_f32_16x16x32_bf16 v[56:59], v[140:143], v[116:119], v[56:59]
 v_accvgpr_write_b32 a147, v46
 s_add_u32 m0, s81, 30720
 s_add_u32 s21, s88, 3440640
 ds_read_b64_tr_b16 v[208:209], v250 offset:36864
 s_waitcnt lgkmcnt(6)
 v_mfma_f32_16x16x32_bf16 v[40:43], v[144:147], v[72:75], v[40:43]
 ds_read_b128 v[140:143], v23 offset:256
 v_cvt_pk_f16_f32 v52, v52, v53
 buffer_load_dwordx4 v34, s[12:15], s21 offen offset:0 lds
 ds_read_b64_tr_b16 v[210:211], v250 offset:37248
 v_mfma_f32_16x16x32_bf16 v[48:51], v[144:147], v[96:99], v[48:51]
 v_accvgpr_write_b32 a154, v52
 buffer_load_dwordx4 v35, s[12:15], s21 offen offset:1024 lds
 ds_read_b64_tr_b16 v[212:213], v250 offset:36896
 ds_read_b64_tr_b16 v[214:215], v250 offset:37280
 v_mfma_f32_16x16x32_bf16 v[56:59], v[144:147], v[120:123], v[56:59]
 v_cvt_pk_f16_f32 v54, v54, v55
 buffer_load_dwordx4 v36, s[12:15], s21 offen offset:2048 lds
 ds_read_b64_tr_b16 v[216:217], v250 offset:36928
 s_waitcnt lgkmcnt(10)
 v_mfma_f32_16x16x32_bf16 v[40:43], v[148:151], v[76:79], v[40:43]
 ds_read_b128 v[144:147], v22 offset:1536
 v_accvgpr_write_b32 a155, v54
 s_add_u32 m0, s81, 33792
 s_add_u32 s21, s88, 3489792
 ds_read_b64_tr_b16 v[218:219], v250 offset:37312
 v_mfma_f32_16x16x32_bf16 v[48:51], v[148:151], v[100:103], v[48:51]
 v_cvt_pk_f16_f32 v60, v60, v61
 buffer_load_dwordx4 v37, s[12:15], s21 offen offset:0 lds
 s_add_u32 s22, s80, 0
 v_accvgpr_write_b32 a162, v60
 v_mfma_f32_16x16x32_bf16 v[56:59], v[148:151], v[124:127], v[56:59]
 v_cvt_pk_f16_f32 v62, v62, v63
 buffer_load_dwordx4 v38, s[12:15], s21 offen offset:1024 lds
 v_accvgpr_write_b32 a163, v62
 s_waitcnt lgkmcnt(9)
 v_mfma_f32_16x16x32_bf16 v[40:43], v[136:139], v[80:83], v[40:43]
 ds_read_b128 v[148:151], v23 offset:1536
 buffer_load_dwordx4 v39, s[12:15], s21 offen offset:2048 lds
 buffer_load_dwordx4 v[232:235], v244, s[36:39], s22 offen
 v_mfma_f32_16x16x32_bf16 v[48:51], v[136:139], v[104:107], v[48:51]
 buffer_load_dwordx4 v[236:239], v245, s[36:39], s22 offen
 buffer_load_dwordx4 v[240:243], v246, s[36:39], s22 offen
 v_mfma_f32_16x16x32_bf16 v[56:59], v[136:139], v[128:131], v[56:59]
 s_waitcnt lgkmcnt(7)
 v_mfma_f32_16x16x32_bf16 v[40:43], v[140:143], v[84:87], v[40:43]
 ds_read_b128 v[136:139], v22 offset:1664
 v_mfma_f32_16x16x32_bf16 v[48:51], v[140:143], v[108:111], v[48:51]
 v_mfma_f32_16x16x32_bf16 v[56:59], v[140:143], v[132:135], v[56:59]
 s_waitcnt lgkmcnt(3)
 v_mfma_f32_16x16x32_bf16 v[44:47], v[144:147], v[64:67], 0
 ds_read_b128 v[140:143], v23 offset:1664
 v_mfma_f32_16x16x32_bf16 v[52:55], v[144:147], v[88:91], 0
 s_waitcnt lgkmcnt(3)
 v_lshlrev_b32 v27, 16, v208
 v_and_b32 v208, 0xffff0000, v208
 v_cvt_pk_f16_f32 v208, v27, v208
 v_accvgpr_write_b32 a72, v208
 v_mfma_f32_16x16x32_bf16 v[60:63], v[144:147], v[112:115], 0
 v_lshlrev_b32 v27, 16, v209
 v_and_b32 v209, 0xffff0000, v209
 v_cvt_pk_f16_f32 v209, v27, v209
 v_accvgpr_write_b32 a73, v209
 s_waitcnt lgkmcnt(2)
 v_mfma_f32_16x16x32_bf16 v[44:47], v[148:151], v[68:71], v[44:47]
 ds_read_b128 v[144:147], v22 offset:1792
 v_cvt_pk_f16_f32 v40, v40, v41
 v_lshlrev_b32 v27, 16, v210
 v_and_b32 v210, 0xffff0000, v210
 v_cvt_pk_f16_f32 v210, v27, v210
 v_mfma_f32_16x16x32_bf16 v[52:55], v[148:151], v[92:95], v[52:55]
 v_accvgpr_write_b32 a148, v40
 v_accvgpr_write_b32 a74, v210
 v_lshlrev_b32 v27, 16, v211
 v_and_b32 v211, 0xffff0000, v211
 v_cvt_pk_f16_f32 v211, v27, v211
 v_mfma_f32_16x16x32_bf16 v[60:63], v[148:151], v[116:119], v[60:63]
 v_cvt_pk_f16_f32 v42, v42, v43
 v_accvgpr_write_b32 a75, v211
 v_lshlrev_b32 v27, 16, v212
 v_and_b32 v212, 0xffff0000, v212
 s_waitcnt lgkmcnt(2)
 v_mfma_f32_16x16x32_bf16 v[44:47], v[136:139], v[72:75], v[44:47]
 ds_read_b128 v[148:151], v23 offset:1792
 v_accvgpr_write_b32 a149, v42
 v_cvt_pk_f16_f32 v212, v27, v212
 v_accvgpr_write_b32 a92, v212
 v_lshlrev_b32 v27, 16, v213
 v_mfma_f32_16x16x32_bf16 v[52:55], v[136:139], v[96:99], v[52:55]
 v_cvt_pk_f16_f32 v48, v48, v49
 v_and_b32 v213, 0xffff0000, v213
 v_cvt_pk_f16_f32 v213, v27, v213
 v_accvgpr_write_b32 a93, v213
 v_lshlrev_b32 v27, 16, v214
 v_mfma_f32_16x16x32_bf16 v[60:63], v[136:139], v[120:123], v[60:63]
 v_accvgpr_write_b32 a156, v48
 v_and_b32 v214, 0xffff0000, v214
 v_cvt_pk_f16_f32 v214, v27, v214
 v_accvgpr_write_b32 a94, v214
 s_waitcnt lgkmcnt(2)
 v_mfma_f32_16x16x32_bf16 v[44:47], v[140:143], v[76:79], v[44:47]
 s_waitcnt vmcnt(18)
 ds_read_b128 v[136:139], v22 offset:12288
 v_cvt_pk_f16_f32 v50, v50, v51
 v_lshlrev_b32 v27, 16, v215
 v_and_b32 v215, 0xffff0000, v215
 v_cvt_pk_f16_f32 v215, v27, v215
 v_mfma_f32_16x16x32_bf16 v[52:55], v[140:143], v[100:103], v[52:55]
 v_accvgpr_write_b32 a157, v50
 v_accvgpr_write_b32 a95, v215
 v_lshlrev_b32 v27, 16, v216
 v_and_b32 v216, 0xffff0000, v216
 v_cvt_pk_f16_f32 v216, v27, v216
 v_mfma_f32_16x16x32_bf16 v[60:63], v[140:143], v[124:127], v[60:63]
 v_cvt_pk_f16_f32 v56, v56, v57
 v_accvgpr_write_b32 a112, v216
 v_lshlrev_b32 v27, 16, v217
 v_and_b32 v217, 0xffff0000, v217
 s_waitcnt lgkmcnt(2)
 v_mfma_f32_16x16x32_bf16 v[44:47], v[144:147], v[80:83], v[44:47]
 ds_read_b128 v[140:143], v23 offset:12288
 v_accvgpr_write_b32 a164, v56
 v_cvt_pk_f16_f32 v217, v27, v217
 v_accvgpr_write_b32 a113, v217
 v_lshlrev_b32 v27, 16, v218
 v_mfma_f32_16x16x32_bf16 v[52:55], v[144:147], v[104:107], v[52:55]
 v_cvt_pk_f16_f32 v58, v58, v59
 v_and_b32 v218, 0xffff0000, v218
 v_cvt_pk_f16_f32 v218, v27, v218
 v_accvgpr_write_b32 a114, v218
 v_lshlrev_b32 v27, 16, v219
 v_mfma_f32_16x16x32_bf16 v[60:63], v[144:147], v[128:131], v[60:63]
 v_accvgpr_write_b32 a165, v58
 v_and_b32 v219, 0xffff0000, v219
 v_cvt_pk_f16_f32 v219, v27, v219
 v_accvgpr_write_b32 a115, v219
 s_waitcnt lgkmcnt(2)
 v_mfma_f32_16x16x32_bf16 v[44:47], v[148:151], v[84:87], v[44:47]
 ds_read_b128 v[144:147], v22 offset:12416
 s_add_u32 m0, s81, 0
 s_add_u32 s21, s88, 2064384
 v_mfma_f32_16x16x32_bf16 v[52:55], v[148:151], v[108:111], v[52:55]
 buffer_load_dwordx4 v28, s[12:15], s21 offen offset:0 lds
 v_mfma_f32_16x16x32_bf16 v[60:63], v[148:151], v[132:135], v[60:63]
 buffer_load_dwordx4 v29, s[12:15], s21 offen offset:1024 lds
 s_waitcnt lgkmcnt(2)
 v_mfma_f32_16x16x32_bf16 v[40:43], v[136:139], v[64:67], 0
 ds_read_b128 v[148:151], v23 offset:12416
 buffer_load_dwordx4 v30, s[12:15], s21 offen offset:2048 lds
 s_waitcnt vmcnt(18)
 v_mfma_f32_16x16x32_bf16 v[48:51], v[136:139], v[88:91], 0
 s_add_u32 m0, s81, 3072
 s_add_u32 s21, s88, 2113536
 ds_write_b128 v251, v[220:223] offset:36864
 v_mfma_f32_16x16x32_bf16 v[56:59], v[136:139], v[112:115], 0
 buffer_load_dwordx4 v31, s[12:15], s21 offen offset:0 lds
 ds_write_b128 v251, v[224:227] offset:37888
 s_waitcnt lgkmcnt(4)
 v_mfma_f32_16x16x32_bf16 v[40:43], v[140:143], v[68:71], v[40:43]
 ds_read_b128 v[136:139], v22 offset:12544
 v_cvt_pk_f16_f32 v44, v44, v45
 buffer_load_dwordx4 v32, s[12:15], s21 offen offset:1024 lds
 v_accvgpr_write_b32 a150, v44
 v_mfma_f32_16x16x32_bf16 v[48:51], v[140:143], v[92:95], v[48:51]
 v_cvt_pk_f16_f32 v46, v46, v47
 buffer_load_dwordx4 v33, s[12:15], s21 offen offset:2048 lds
 ds_write_b128 v251, v[228:231] offset:38912
 v_mfma_f32_16x16x32_bf16 v[56:59], v[140:143], v[116:119], v[56:59]
 v_accvgpr_write_b32 a151, v46
 s_add_u32 m0, s81, 6144
 s_add_u32 s21, s88, 2555904
 ds_read_b64_tr_b16 v[208:209], v250 offset:36864
 s_waitcnt lgkmcnt(6)
 v_mfma_f32_16x16x32_bf16 v[40:43], v[144:147], v[72:75], v[40:43]
 ds_read_b128 v[140:143], v23 offset:12544
 v_cvt_pk_f16_f32 v52, v52, v53
 buffer_load_dwordx4 v34, s[12:15], s21 offen offset:0 lds
 ds_read_b64_tr_b16 v[210:211], v250 offset:37248
 v_mfma_f32_16x16x32_bf16 v[48:51], v[144:147], v[96:99], v[48:51]
 v_accvgpr_write_b32 a158, v52
 buffer_load_dwordx4 v35, s[12:15], s21 offen offset:1024 lds
 ds_read_b64_tr_b16 v[212:213], v250 offset:36896
 ds_read_b64_tr_b16 v[214:215], v250 offset:37280
 v_mfma_f32_16x16x32_bf16 v[56:59], v[144:147], v[120:123], v[56:59]
 v_cvt_pk_f16_f32 v54, v54, v55
 buffer_load_dwordx4 v36, s[12:15], s21 offen offset:2048 lds
 ds_read_b64_tr_b16 v[216:217], v250 offset:36928
 s_waitcnt lgkmcnt(10)
 v_mfma_f32_16x16x32_bf16 v[40:43], v[148:151], v[76:79], v[40:43]
 ds_read_b128 v[144:147], v22 offset:13824
 v_accvgpr_write_b32 a159, v54
 s_add_u32 m0, s81, 9216
 s_add_u32 s21, s88, 2605056
 ds_read_b64_tr_b16 v[218:219], v250 offset:37312
 v_mfma_f32_16x16x32_bf16 v[48:51], v[148:151], v[100:103], v[48:51]
 v_cvt_pk_f16_f32 v60, v60, v61
 buffer_load_dwordx4 v37, s[12:15], s21 offen offset:0 lds
 s_add_u32 s22, s80, 983040
 v_accvgpr_write_b32 a166, v60
 v_mfma_f32_16x16x32_bf16 v[56:59], v[148:151], v[124:127], v[56:59]
 v_cvt_pk_f16_f32 v62, v62, v63
 buffer_load_dwordx4 v38, s[12:15], s21 offen offset:1024 lds
 v_accvgpr_write_b32 a167, v62
 s_waitcnt lgkmcnt(9)
 v_mfma_f32_16x16x32_bf16 v[40:43], v[136:139], v[80:83], v[40:43]
 ds_read_b128 v[148:151], v23 offset:13824
 buffer_load_dwordx4 v39, s[12:15], s21 offen offset:2048 lds
 buffer_load_dwordx4 v[220:223], v244, s[36:39], s22 offen
 v_mfma_f32_16x16x32_bf16 v[48:51], v[136:139], v[104:107], v[48:51]
 buffer_load_dwordx4 v[224:227], v245, s[36:39], s22 offen
 buffer_load_dwordx4 v[228:231], v246, s[36:39], s22 offen
 v_mfma_f32_16x16x32_bf16 v[56:59], v[136:139], v[128:131], v[56:59]
 s_waitcnt lgkmcnt(7)
 v_mfma_f32_16x16x32_bf16 v[40:43], v[140:143], v[84:87], v[40:43]
 ds_read_b128 v[136:139], v22 offset:13952
 v_mfma_f32_16x16x32_bf16 v[48:51], v[140:143], v[108:111], v[48:51]
 v_mfma_f32_16x16x32_bf16 v[56:59], v[140:143], v[132:135], v[56:59]
 s_waitcnt lgkmcnt(3)
 v_mfma_f32_16x16x32_bf16 v[44:47], v[144:147], v[64:67], 0
 ds_read_b128 v[140:143], v23 offset:13952
 v_mfma_f32_16x16x32_bf16 v[52:55], v[144:147], v[88:91], 0
 s_waitcnt lgkmcnt(3)
 v_lshlrev_b32 v27, 16, v208
 v_and_b32 v208, 0xffff0000, v208
 v_cvt_pk_f16_f32 v208, v27, v208
 v_accvgpr_write_b32 a76, v208
 v_mfma_f32_16x16x32_bf16 v[60:63], v[144:147], v[112:115], 0
 v_lshlrev_b32 v27, 16, v209
 v_and_b32 v209, 0xffff0000, v209
 v_cvt_pk_f16_f32 v209, v27, v209
 v_accvgpr_write_b32 a77, v209
 s_waitcnt lgkmcnt(2)
 v_mfma_f32_16x16x32_bf16 v[44:47], v[148:151], v[68:71], v[44:47]
 ds_read_b128 v[144:147], v22 offset:14080
 v_cvt_pk_f16_f32 v40, v40, v41
 v_lshlrev_b32 v27, 16, v210
 v_and_b32 v210, 0xffff0000, v210
 v_cvt_pk_f16_f32 v210, v27, v210
 v_mfma_f32_16x16x32_bf16 v[52:55], v[148:151], v[92:95], v[52:55]
 v_accvgpr_write_b32 a168, v40
 v_accvgpr_write_b32 a78, v210
 v_lshlrev_b32 v27, 16, v211
 v_and_b32 v211, 0xffff0000, v211
 v_cvt_pk_f16_f32 v211, v27, v211
 v_mfma_f32_16x16x32_bf16 v[60:63], v[148:151], v[116:119], v[60:63]
 v_cvt_pk_f16_f32 v42, v42, v43
 v_accvgpr_write_b32 a79, v211
 v_lshlrev_b32 v27, 16, v212
 v_and_b32 v212, 0xffff0000, v212
 s_waitcnt lgkmcnt(2)
 v_mfma_f32_16x16x32_bf16 v[44:47], v[136:139], v[72:75], v[44:47]
 ds_read_b128 v[148:151], v23 offset:14080
 v_accvgpr_write_b32 a169, v42
 v_cvt_pk_f16_f32 v212, v27, v212
 v_accvgpr_write_b32 a96, v212
 v_lshlrev_b32 v27, 16, v213
 v_mfma_f32_16x16x32_bf16 v[52:55], v[136:139], v[96:99], v[52:55]
 v_cvt_pk_f16_f32 v48, v48, v49
 v_and_b32 v213, 0xffff0000, v213
 v_cvt_pk_f16_f32 v213, v27, v213
 v_accvgpr_write_b32 a97, v213
 v_lshlrev_b32 v27, 16, v214
 v_mfma_f32_16x16x32_bf16 v[60:63], v[136:139], v[120:123], v[60:63]
 v_accvgpr_write_b32 a176, v48
 v_and_b32 v214, 0xffff0000, v214
 v_cvt_pk_f16_f32 v214, v27, v214
 v_accvgpr_write_b32 a98, v214
 s_waitcnt lgkmcnt(2)
 v_mfma_f32_16x16x32_bf16 v[44:47], v[140:143], v[76:79], v[44:47]
 s_waitcnt vmcnt(18)
 ds_read_b128 v[136:139], v22 offset:24576
 v_cvt_pk_f16_f32 v50, v50, v51
 v_lshlrev_b32 v27, 16, v215
 v_and_b32 v215, 0xffff0000, v215
 v_cvt_pk_f16_f32 v215, v27, v215
 v_mfma_f32_16x16x32_bf16 v[52:55], v[140:143], v[100:103], v[52:55]
 v_accvgpr_write_b32 a177, v50
 v_accvgpr_write_b32 a99, v215
 v_lshlrev_b32 v27, 16, v216
 v_and_b32 v216, 0xffff0000, v216
 v_cvt_pk_f16_f32 v216, v27, v216
 v_mfma_f32_16x16x32_bf16 v[60:63], v[140:143], v[124:127], v[60:63]
 v_cvt_pk_f16_f32 v56, v56, v57
 v_accvgpr_write_b32 a116, v216
 v_lshlrev_b32 v27, 16, v217
 v_and_b32 v217, 0xffff0000, v217
 s_waitcnt lgkmcnt(2)
 v_mfma_f32_16x16x32_bf16 v[44:47], v[144:147], v[80:83], v[44:47]
 ds_read_b128 v[140:143], v23 offset:24576
 v_accvgpr_write_b32 a184, v56
 v_cvt_pk_f16_f32 v217, v27, v217
 v_accvgpr_write_b32 a117, v217
 v_lshlrev_b32 v27, 16, v218
 v_mfma_f32_16x16x32_bf16 v[52:55], v[144:147], v[104:107], v[52:55]
 v_cvt_pk_f16_f32 v58, v58, v59
 v_and_b32 v218, 0xffff0000, v218
 v_cvt_pk_f16_f32 v218, v27, v218
 v_accvgpr_write_b32 a118, v218
 v_lshlrev_b32 v27, 16, v219
 v_mfma_f32_16x16x32_bf16 v[60:63], v[144:147], v[128:131], v[60:63]
 v_accvgpr_write_b32 a185, v58
 v_and_b32 v219, 0xffff0000, v219
 v_cvt_pk_f16_f32 v219, v27, v219
 v_accvgpr_write_b32 a119, v219
 s_waitcnt lgkmcnt(2)
 v_mfma_f32_16x16x32_bf16 v[44:47], v[148:151], v[84:87], v[44:47]
 ds_read_b128 v[144:147], v22 offset:24704
 s_add_u32 m0, s81, 12288
 s_add_u32 s21, s88, 3047424
 v_mfma_f32_16x16x32_bf16 v[52:55], v[148:151], v[108:111], v[52:55]
 buffer_load_dwordx4 v28, s[12:15], s21 offen offset:0 lds
 v_mfma_f32_16x16x32_bf16 v[60:63], v[148:151], v[132:135], v[60:63]
 buffer_load_dwordx4 v29, s[12:15], s21 offen offset:1024 lds
 s_waitcnt lgkmcnt(2)
 v_mfma_f32_16x16x32_bf16 v[40:43], v[136:139], v[64:67], 0
 ds_read_b128 v[148:151], v23 offset:24704
 buffer_load_dwordx4 v30, s[12:15], s21 offen offset:2048 lds
 s_waitcnt vmcnt(18)
 v_mfma_f32_16x16x32_bf16 v[48:51], v[136:139], v[88:91], 0
 s_add_u32 m0, s81, 15360
 s_add_u32 s21, s88, 3096576
 ds_write_b128 v251, v[232:235] offset:36864
 v_mfma_f32_16x16x32_bf16 v[56:59], v[136:139], v[112:115], 0
 buffer_load_dwordx4 v31, s[12:15], s21 offen offset:0 lds
 ds_write_b128 v251, v[236:239] offset:37888
 s_waitcnt lgkmcnt(4)
 v_mfma_f32_16x16x32_bf16 v[40:43], v[140:143], v[68:71], v[40:43]
 ds_read_b128 v[136:139], v22 offset:24832
 v_cvt_pk_f16_f32 v44, v44, v45
 buffer_load_dwordx4 v32, s[12:15], s21 offen offset:1024 lds
 v_accvgpr_write_b32 a170, v44
 v_mfma_f32_16x16x32_bf16 v[48:51], v[140:143], v[92:95], v[48:51]
 v_cvt_pk_f16_f32 v46, v46, v47
 buffer_load_dwordx4 v33, s[12:15], s21 offen offset:2048 lds
 ds_write_b128 v251, v[240:243] offset:38912
 v_mfma_f32_16x16x32_bf16 v[56:59], v[140:143], v[116:119], v[56:59]
 v_accvgpr_write_b32 a171, v46
 s_add_u32 m0, s81, 18432
 s_add_u32 s21, s88, 3538944
 ds_read_b64_tr_b16 v[208:209], v250 offset:36864
 s_waitcnt lgkmcnt(6)
 v_mfma_f32_16x16x32_bf16 v[40:43], v[144:147], v[72:75], v[40:43]
 ds_read_b128 v[140:143], v23 offset:24832
 v_cvt_pk_f16_f32 v52, v52, v53
 buffer_load_dwordx4 v34, s[12:15], s21 offen offset:0 lds
 ds_read_b64_tr_b16 v[210:211], v250 offset:37248
 v_mfma_f32_16x16x32_bf16 v[48:51], v[144:147], v[96:99], v[48:51]
 v_accvgpr_write_b32 a178, v52
 buffer_load_dwordx4 v35, s[12:15], s21 offen offset:1024 lds
 ds_read_b64_tr_b16 v[212:213], v250 offset:36896
 ds_read_b64_tr_b16 v[214:215], v250 offset:37280
 v_mfma_f32_16x16x32_bf16 v[56:59], v[144:147], v[120:123], v[56:59]
 v_cvt_pk_f16_f32 v54, v54, v55
 buffer_load_dwordx4 v36, s[12:15], s21 offen offset:2048 lds
 ds_read_b64_tr_b16 v[216:217], v250 offset:36928
 s_waitcnt lgkmcnt(10)
 v_mfma_f32_16x16x32_bf16 v[40:43], v[148:151], v[76:79], v[40:43]
 ds_read_b128 v[144:147], v22 offset:26112
 v_accvgpr_write_b32 a179, v54
 s_add_u32 m0, s81, 21504
 s_add_u32 s21, s88, 3588096
 ds_read_b64_tr_b16 v[218:219], v250 offset:37312
 v_mfma_f32_16x16x32_bf16 v[48:51], v[148:151], v[100:103], v[48:51]
 v_cvt_pk_f16_f32 v60, v60, v61
 buffer_load_dwordx4 v37, s[12:15], s21 offen offset:0 lds
 s_add_u32 s22, s80, 98304
 v_accvgpr_write_b32 a186, v60
 v_mfma_f32_16x16x32_bf16 v[56:59], v[148:151], v[124:127], v[56:59]
 v_cvt_pk_f16_f32 v62, v62, v63
 buffer_load_dwordx4 v38, s[12:15], s21 offen offset:1024 lds
 v_accvgpr_write_b32 a187, v62
 s_waitcnt lgkmcnt(9)
 v_mfma_f32_16x16x32_bf16 v[40:43], v[136:139], v[80:83], v[40:43]
 ds_read_b128 v[148:151], v23 offset:26112
 buffer_load_dwordx4 v39, s[12:15], s21 offen offset:2048 lds
 buffer_load_dwordx4 v[232:235], v244, s[36:39], s22 offen
 v_mfma_f32_16x16x32_bf16 v[48:51], v[136:139], v[104:107], v[48:51]
 buffer_load_dwordx4 v[236:239], v245, s[36:39], s22 offen
 buffer_load_dwordx4 v[240:243], v246, s[36:39], s22 offen
 v_mfma_f32_16x16x32_bf16 v[56:59], v[136:139], v[128:131], v[56:59]
 s_waitcnt lgkmcnt(7)
 v_mfma_f32_16x16x32_bf16 v[40:43], v[140:143], v[84:87], v[40:43]
 ds_read_b128 v[136:139], v22 offset:26240
 v_mfma_f32_16x16x32_bf16 v[48:51], v[140:143], v[108:111], v[48:51]
 v_mfma_f32_16x16x32_bf16 v[56:59], v[140:143], v[132:135], v[56:59]
 s_waitcnt lgkmcnt(3)
 v_mfma_f32_16x16x32_bf16 v[44:47], v[144:147], v[64:67], 0
 ds_read_b128 v[140:143], v23 offset:26240
 v_mfma_f32_16x16x32_bf16 v[52:55], v[144:147], v[88:91], 0
 s_waitcnt lgkmcnt(3)
 v_lshlrev_b32 v27, 16, v208
 v_and_b32 v208, 0xffff0000, v208
 v_cvt_pk_f16_f32 v208, v27, v208
 v_accvgpr_write_b32 a0, v208
 v_mfma_f32_16x16x32_bf16 v[60:63], v[144:147], v[112:115], 0
 v_lshlrev_b32 v27, 16, v209
 v_and_b32 v209, 0xffff0000, v209
 v_cvt_pk_f16_f32 v209, v27, v209
 v_accvgpr_write_b32 a1, v209
 s_waitcnt lgkmcnt(2)
 v_mfma_f32_16x16x32_bf16 v[44:47], v[148:151], v[68:71], v[44:47]
 ds_read_b128 v[144:147], v22 offset:26368
 v_cvt_pk_f16_f32 v40, v40, v41
 v_lshlrev_b32 v27, 16, v210
 v_and_b32 v210, 0xffff0000, v210
 v_cvt_pk_f16_f32 v210, v27, v210
 v_mfma_f32_16x16x32_bf16 v[52:55], v[148:151], v[92:95], v[52:55]
 v_accvgpr_write_b32 a172, v40
 v_accvgpr_write_b32 a2, v210
 v_lshlrev_b32 v27, 16, v211
 v_and_b32 v211, 0xffff0000, v211
 v_cvt_pk_f16_f32 v211, v27, v211
 v_mfma_f32_16x16x32_bf16 v[60:63], v[148:151], v[116:119], v[60:63]
 v_cvt_pk_f16_f32 v42, v42, v43
 v_accvgpr_write_b32 a3, v211
 v_lshlrev_b32 v27, 16, v212
 v_and_b32 v212, 0xffff0000, v212
 s_waitcnt lgkmcnt(2)
 v_mfma_f32_16x16x32_bf16 v[44:47], v[136:139], v[72:75], v[44:47]
 ds_read_b128 v[148:151], v23 offset:26368
 v_accvgpr_write_b32 a173, v42
 v_cvt_pk_f16_f32 v212, v27, v212
 v_accvgpr_write_b32 a20, v212
 v_lshlrev_b32 v27, 16, v213
 v_mfma_f32_16x16x32_bf16 v[52:55], v[136:139], v[96:99], v[52:55]
 v_cvt_pk_f16_f32 v48, v48, v49
 v_and_b32 v213, 0xffff0000, v213
 v_cvt_pk_f16_f32 v213, v27, v213
 v_accvgpr_write_b32 a21, v213
 v_lshlrev_b32 v27, 16, v214
 v_mfma_f32_16x16x32_bf16 v[60:63], v[136:139], v[120:123], v[60:63]
 v_accvgpr_write_b32 a180, v48
 v_and_b32 v214, 0xffff0000, v214
 v_cvt_pk_f16_f32 v214, v27, v214
 v_accvgpr_write_b32 a22, v214
 s_waitcnt lgkmcnt(2)
 v_mfma_f32_16x16x32_bf16 v[44:47], v[140:143], v[76:79], v[44:47]
 s_waitcnt vmcnt(18)
 ds_read_b128 v[136:139], v22 offset:0
 v_cvt_pk_f16_f32 v50, v50, v51
 v_lshlrev_b32 v27, 16, v215
 v_and_b32 v215, 0xffff0000, v215
 v_cvt_pk_f16_f32 v215, v27, v215
 v_mfma_f32_16x16x32_bf16 v[52:55], v[140:143], v[100:103], v[52:55]
 v_accvgpr_write_b32 a181, v50
 v_accvgpr_write_b32 a23, v215
 v_lshlrev_b32 v27, 16, v216
 v_and_b32 v216, 0xffff0000, v216
 v_cvt_pk_f16_f32 v216, v27, v216
 v_mfma_f32_16x16x32_bf16 v[60:63], v[140:143], v[124:127], v[60:63]
 v_cvt_pk_f16_f32 v56, v56, v57
 v_accvgpr_write_b32 a40, v216
 v_lshlrev_b32 v27, 16, v217
 v_and_b32 v217, 0xffff0000, v217
 s_waitcnt lgkmcnt(2)
 v_mfma_f32_16x16x32_bf16 v[44:47], v[144:147], v[80:83], v[44:47]
 ds_read_b128 v[140:143], v23 offset:0
 v_accvgpr_write_b32 a188, v56
 v_cvt_pk_f16_f32 v217, v27, v217
 v_accvgpr_write_b32 a41, v217
 v_lshlrev_b32 v27, 16, v218
 v_mfma_f32_16x16x32_bf16 v[52:55], v[144:147], v[104:107], v[52:55]
 v_cvt_pk_f16_f32 v58, v58, v59
 v_and_b32 v218, 0xffff0000, v218
 v_cvt_pk_f16_f32 v218, v27, v218
 v_accvgpr_write_b32 a42, v218
 v_lshlrev_b32 v27, 16, v219
 v_mfma_f32_16x16x32_bf16 v[60:63], v[144:147], v[128:131], v[60:63]
 v_accvgpr_write_b32 a189, v58
 v_and_b32 v219, 0xffff0000, v219
 v_cvt_pk_f16_f32 v219, v27, v219
 v_accvgpr_write_b32 a43, v219
 s_waitcnt lgkmcnt(2)
 v_mfma_f32_16x16x32_bf16 v[44:47], v[148:151], v[84:87], v[44:47]
 ds_read_b128 v[144:147], v22 offset:128
 s_add_u32 m0, s81, 24576
 s_add_u32 s21, s88, 3932160
 v_mfma_f32_16x16x32_bf16 v[52:55], v[148:151], v[108:111], v[52:55]
 buffer_load_dwordx4 v28, s[12:15], s21 offen offset:0 lds
 v_mfma_f32_16x16x32_bf16 v[60:63], v[148:151], v[132:135], v[60:63]
 buffer_load_dwordx4 v29, s[12:15], s21 offen offset:1024 lds
 s_waitcnt lgkmcnt(2)
 v_mfma_f32_16x16x32_bf16 v[40:43], v[136:139], v[64:67], 0
 ds_read_b128 v[148:151], v23 offset:128
 buffer_load_dwordx4 v30, s[12:15], s21 offen offset:2048 lds
 s_waitcnt vmcnt(18)
 v_mfma_f32_16x16x32_bf16 v[48:51], v[136:139], v[88:91], 0
 s_add_u32 m0, s81, 27648
 s_add_u32 s21, s88, 3981312
 ds_write_b128 v251, v[220:223] offset:36864
 v_mfma_f32_16x16x32_bf16 v[56:59], v[136:139], v[112:115], 0
 buffer_load_dwordx4 v31, s[12:15], s21 offen offset:0 lds
 ds_write_b128 v251, v[224:227] offset:37888
 s_waitcnt lgkmcnt(4)
 v_mfma_f32_16x16x32_bf16 v[40:43], v[140:143], v[68:71], v[40:43]
 ds_read_b128 v[136:139], v22 offset:256
 v_cvt_pk_f16_f32 v44, v44, v45
 buffer_load_dwordx4 v32, s[12:15], s21 offen offset:1024 lds
 v_accvgpr_write_b32 a174, v44
 v_mfma_f32_16x16x32_bf16 v[48:51], v[140:143], v[92:95], v[48:51]
 v_cvt_pk_f16_f32 v46, v46, v47
 buffer_load_dwordx4 v33, s[12:15], s21 offen offset:2048 lds
 ds_write_b128 v251, v[228:231] offset:38912
 v_mfma_f32_16x16x32_bf16 v[56:59], v[140:143], v[116:119], v[56:59]
 v_accvgpr_write_b32 a175, v46
 s_add_u32 m0, s81, 30720
 s_add_u32 s21, s88, 4423680
 ds_read_b64_tr_b16 v[208:209], v250 offset:36864
 s_waitcnt lgkmcnt(6)
 v_mfma_f32_16x16x32_bf16 v[40:43], v[144:147], v[72:75], v[40:43]
 ds_read_b128 v[140:143], v23 offset:256
 v_cvt_pk_f16_f32 v52, v52, v53
 buffer_load_dwordx4 v34, s[12:15], s21 offen offset:0 lds
 ds_read_b64_tr_b16 v[210:211], v250 offset:37248
 v_mfma_f32_16x16x32_bf16 v[48:51], v[144:147], v[96:99], v[48:51]
 v_accvgpr_write_b32 a182, v52
 buffer_load_dwordx4 v35, s[12:15], s21 offen offset:1024 lds
 ds_read_b64_tr_b16 v[212:213], v250 offset:36896
 ds_read_b64_tr_b16 v[214:215], v250 offset:37280
 v_mfma_f32_16x16x32_bf16 v[56:59], v[144:147], v[120:123], v[56:59]
 v_cvt_pk_f16_f32 v54, v54, v55
 buffer_load_dwordx4 v36, s[12:15], s21 offen offset:2048 lds
 ds_read_b64_tr_b16 v[216:217], v250 offset:36928
 s_waitcnt lgkmcnt(10)
 v_mfma_f32_16x16x32_bf16 v[40:43], v[148:151], v[76:79], v[40:43]
 ds_read_b128 v[144:147], v22 offset:1536
 v_accvgpr_write_b32 a183, v54
 s_add_u32 m0, s81, 33792
 s_add_u32 s21, s88, 4472832
 ds_read_b64_tr_b16 v[218:219], v250 offset:37312
 v_mfma_f32_16x16x32_bf16 v[48:51], v[148:151], v[100:103], v[48:51]
 v_cvt_pk_f16_f32 v60, v60, v61
 buffer_load_dwordx4 v37, s[12:15], s21 offen offset:0 lds
 s_add_u32 s22, s80, 1081344
 v_accvgpr_write_b32 a190, v60
 v_mfma_f32_16x16x32_bf16 v[56:59], v[148:151], v[124:127], v[56:59]
 v_cvt_pk_f16_f32 v62, v62, v63
 buffer_load_dwordx4 v38, s[12:15], s21 offen offset:1024 lds
 v_accvgpr_write_b32 a191, v62
 s_waitcnt lgkmcnt(9)
 v_mfma_f32_16x16x32_bf16 v[40:43], v[136:139], v[80:83], v[40:43]
 ds_read_b128 v[148:151], v23 offset:1536
 buffer_load_dwordx4 v39, s[12:15], s21 offen offset:2048 lds
 buffer_load_dwordx4 v[220:223], v244, s[36:39], s22 offen
 v_mfma_f32_16x16x32_bf16 v[48:51], v[136:139], v[104:107], v[48:51]
 buffer_load_dwordx4 v[224:227], v245, s[36:39], s22 offen
 buffer_load_dwordx4 v[228:231], v246, s[36:39], s22 offen
 v_mfma_f32_16x16x32_bf16 v[56:59], v[136:139], v[128:131], v[56:59]
 s_waitcnt lgkmcnt(7)
 v_mfma_f32_16x16x32_bf16 v[40:43], v[140:143], v[84:87], v[40:43]
 ds_read_b128 v[136:139], v22 offset:1664
 v_mfma_f32_16x16x32_bf16 v[48:51], v[140:143], v[108:111], v[48:51]
 v_mfma_f32_16x16x32_bf16 v[56:59], v[140:143], v[132:135], v[56:59]
 s_waitcnt lgkmcnt(3)
 v_mfma_f32_16x16x32_bf16 v[44:47], v[144:147], v[64:67], 0
 ds_read_b128 v[140:143], v23 offset:1664
 v_mfma_f32_16x16x32_bf16 v[52:55], v[144:147], v[88:91], 0
 s_waitcnt lgkmcnt(3)
 v_lshlrev_b32 v27, 16, v208
 v_and_b32 v208, 0xffff0000, v208
 v_cvt_pk_f16_f32 v208, v27, v208
 v_accvgpr_write_b32 a4, v208
 v_mfma_f32_16x16x32_bf16 v[60:63], v[144:147], v[112:115], 0
 v_lshlrev_b32 v27, 16, v209
 v_and_b32 v209, 0xffff0000, v209
 v_cvt_pk_f16_f32 v209, v27, v209
 v_accvgpr_write_b32 a5, v209
 s_waitcnt lgkmcnt(2)
 v_mfma_f32_16x16x32_bf16 v[44:47], v[148:151], v[68:71], v[44:47]
 ds_read_b128 v[144:147], v22 offset:1792
 v_cvt_pk_f16_f32 v40, v40, v41
 v_lshlrev_b32 v27, 16, v210
 v_and_b32 v210, 0xffff0000, v210
 v_cvt_pk_f16_f32 v210, v27, v210
 v_mfma_f32_16x16x32_bf16 v[52:55], v[148:151], v[92:95], v[52:55]
 v_accvgpr_write_b32 a192, v40
 v_accvgpr_write_b32 a6, v210
 v_lshlrev_b32 v27, 16, v211
 v_and_b32 v211, 0xffff0000, v211
 v_cvt_pk_f16_f32 v211, v27, v211
 v_mfma_f32_16x16x32_bf16 v[60:63], v[148:151], v[116:119], v[60:63]
 v_cvt_pk_f16_f32 v42, v42, v43
 v_accvgpr_write_b32 a7, v211
 v_lshlrev_b32 v27, 16, v212
 v_and_b32 v212, 0xffff0000, v212
 s_waitcnt lgkmcnt(2)
 v_mfma_f32_16x16x32_bf16 v[44:47], v[136:139], v[72:75], v[44:47]
 ds_read_b128 v[148:151], v23 offset:1792
 v_accvgpr_write_b32 a193, v42
 v_cvt_pk_f16_f32 v212, v27, v212
 v_accvgpr_write_b32 a24, v212
 v_lshlrev_b32 v27, 16, v213
 v_mfma_f32_16x16x32_bf16 v[52:55], v[136:139], v[96:99], v[52:55]
 v_cvt_pk_f16_f32 v48, v48, v49
 v_and_b32 v213, 0xffff0000, v213
 v_cvt_pk_f16_f32 v213, v27, v213
 v_accvgpr_write_b32 a25, v213
 v_lshlrev_b32 v27, 16, v214
 v_mfma_f32_16x16x32_bf16 v[60:63], v[136:139], v[120:123], v[60:63]
 v_accvgpr_write_b32 a200, v48
 v_and_b32 v214, 0xffff0000, v214
 v_cvt_pk_f16_f32 v214, v27, v214
 v_accvgpr_write_b32 a26, v214
 s_waitcnt lgkmcnt(2)
 v_mfma_f32_16x16x32_bf16 v[44:47], v[140:143], v[76:79], v[44:47]
 s_waitcnt vmcnt(18)
 ds_read_b128 v[136:139], v22 offset:12288
 v_cvt_pk_f16_f32 v50, v50, v51
 v_lshlrev_b32 v27, 16, v215
 v_and_b32 v215, 0xffff0000, v215
 v_cvt_pk_f16_f32 v215, v27, v215
 v_mfma_f32_16x16x32_bf16 v[52:55], v[140:143], v[100:103], v[52:55]
 v_accvgpr_write_b32 a201, v50
 v_accvgpr_write_b32 a27, v215
 v_lshlrev_b32 v27, 16, v216
 v_and_b32 v216, 0xffff0000, v216
 v_cvt_pk_f16_f32 v216, v27, v216
 v_mfma_f32_16x16x32_bf16 v[60:63], v[140:143], v[124:127], v[60:63]
 v_cvt_pk_f16_f32 v56, v56, v57
 v_accvgpr_write_b32 a44, v216
 v_lshlrev_b32 v27, 16, v217
 v_and_b32 v217, 0xffff0000, v217
 s_waitcnt lgkmcnt(2)
 v_mfma_f32_16x16x32_bf16 v[44:47], v[144:147], v[80:83], v[44:47]
 ds_read_b128 v[140:143], v23 offset:12288
 v_accvgpr_write_b32 a208, v56
 v_cvt_pk_f16_f32 v217, v27, v217
 v_accvgpr_write_b32 a45, v217
 v_lshlrev_b32 v27, 16, v218
 v_mfma_f32_16x16x32_bf16 v[52:55], v[144:147], v[104:107], v[52:55]
 v_cvt_pk_f16_f32 v58, v58, v59
 v_and_b32 v218, 0xffff0000, v218
 v_cvt_pk_f16_f32 v218, v27, v218
 v_accvgpr_write_b32 a46, v218
 v_lshlrev_b32 v27, 16, v219
 v_mfma_f32_16x16x32_bf16 v[60:63], v[144:147], v[128:131], v[60:63]
 v_accvgpr_write_b32 a209, v58
 v_and_b32 v219, 0xffff0000, v219
 v_cvt_pk_f16_f32 v219, v27, v219
 v_accvgpr_write_b32 a47, v219
 s_waitcnt lgkmcnt(2)
 v_mfma_f32_16x16x32_bf16 v[44:47], v[148:151], v[84:87], v[44:47]
 ds_read_b128 v[144:147], v22 offset:12416
 s_add_u32 m0, s81, 0
 s_add_u32 s21, s88, 4915200
 v_mfma_f32_16x16x32_bf16 v[52:55], v[148:151], v[108:111], v[52:55]
 buffer_load_dwordx4 v28, s[12:15], s21 offen offset:0 lds
 v_mfma_f32_16x16x32_bf16 v[60:63], v[148:151], v[132:135], v[60:63]
 buffer_load_dwordx4 v29, s[12:15], s21 offen offset:1024 lds
 s_waitcnt lgkmcnt(2)
 v_mfma_f32_16x16x32_bf16 v[40:43], v[136:139], v[64:67], 0
 ds_read_b128 v[148:151], v23 offset:12416
 buffer_load_dwordx4 v30, s[12:15], s21 offen offset:2048 lds
 s_waitcnt vmcnt(18)
 v_mfma_f32_16x16x32_bf16 v[48:51], v[136:139], v[88:91], 0
 s_add_u32 m0, s81, 3072
 s_add_u32 s21, s88, 4964352
 ds_write_b128 v251, v[232:235] offset:36864
 v_mfma_f32_16x16x32_bf16 v[56:59], v[136:139], v[112:115], 0
 buffer_load_dwordx4 v31, s[12:15], s21 offen offset:0 lds
 ds_write_b128 v251, v[236:239] offset:37888
 s_waitcnt lgkmcnt(4)
 v_mfma_f32_16x16x32_bf16 v[40:43], v[140:143], v[68:71], v[40:43]
 ds_read_b128 v[136:139], v22 offset:12544
 v_cvt_pk_f16_f32 v44, v44, v45
 buffer_load_dwordx4 v32, s[12:15], s21 offen offset:1024 lds
 v_accvgpr_write_b32 a194, v44
 v_mfma_f32_16x16x32_bf16 v[48:51], v[140:143], v[92:95], v[48:51]
 v_cvt_pk_f16_f32 v46, v46, v47
 buffer_load_dwordx4 v33, s[12:15], s21 offen offset:2048 lds
 ds_write_b128 v251, v[240:243] offset:38912
 v_mfma_f32_16x16x32_bf16 v[56:59], v[140:143], v[116:119], v[56:59]
 v_accvgpr_write_b32 a195, v46
 s_add_u32 m0, s81, 6144
 s_add_u32 s21, s88, 5406720
 ds_read_b64_tr_b16 v[208:209], v250 offset:36864
 s_waitcnt lgkmcnt(6)
 v_mfma_f32_16x16x32_bf16 v[40:43], v[144:147], v[72:75], v[40:43]
 ds_read_b128 v[140:143], v23 offset:12544
 v_cvt_pk_f16_f32 v52, v52, v53
 buffer_load_dwordx4 v34, s[12:15], s21 offen offset:0 lds
 ds_read_b64_tr_b16 v[210:211], v250 offset:37248
 v_mfma_f32_16x16x32_bf16 v[48:51], v[144:147], v[96:99], v[48:51]
 v_accvgpr_write_b32 a202, v52
 buffer_load_dwordx4 v35, s[12:15], s21 offen offset:1024 lds
 ds_read_b64_tr_b16 v[212:213], v250 offset:36896
 ds_read_b64_tr_b16 v[214:215], v250 offset:37280
 v_mfma_f32_16x16x32_bf16 v[56:59], v[144:147], v[120:123], v[56:59]
 v_cvt_pk_f16_f32 v54, v54, v55
 buffer_load_dwordx4 v36, s[12:15], s21 offen offset:2048 lds
 ds_read_b64_tr_b16 v[216:217], v250 offset:36928
 s_waitcnt lgkmcnt(10)
 v_mfma_f32_16x16x32_bf16 v[40:43], v[148:151], v[76:79], v[40:43]
 ds_read_b128 v[144:147], v22 offset:13824
 v_accvgpr_write_b32 a203, v54
 s_add_u32 m0, s81, 9216
 s_add_u32 s21, s88, 5455872
 ds_read_b64_tr_b16 v[218:219], v250 offset:37312
 v_mfma_f32_16x16x32_bf16 v[48:51], v[148:151], v[100:103], v[48:51]
 v_cvt_pk_f16_f32 v60, v60, v61
 buffer_load_dwordx4 v37, s[12:15], s21 offen offset:0 lds
 s_add_u32 s22, s80, 196608
 v_accvgpr_write_b32 a210, v60
 v_mfma_f32_16x16x32_bf16 v[56:59], v[148:151], v[124:127], v[56:59]
 v_cvt_pk_f16_f32 v62, v62, v63
 buffer_load_dwordx4 v38, s[12:15], s21 offen offset:1024 lds
 v_accvgpr_write_b32 a211, v62
 s_waitcnt lgkmcnt(9)
 v_mfma_f32_16x16x32_bf16 v[40:43], v[136:139], v[80:83], v[40:43]
 ds_read_b128 v[148:151], v23 offset:13824
 buffer_load_dwordx4 v39, s[12:15], s21 offen offset:2048 lds
 buffer_load_dwordx4 v[232:235], v247, s[36:39], s22 offen
 v_mfma_f32_16x16x32_bf16 v[48:51], v[136:139], v[104:107], v[48:51]
 buffer_load_dwordx4 v[236:239], v248, s[36:39], s22 offen
 buffer_load_dwordx4 v[240:243], v249, s[36:39], s22 offen
 v_mfma_f32_16x16x32_bf16 v[56:59], v[136:139], v[128:131], v[56:59]
 s_waitcnt lgkmcnt(7)
 v_mfma_f32_16x16x32_bf16 v[40:43], v[140:143], v[84:87], v[40:43]
 ds_read_b128 v[136:139], v22 offset:13952
 v_mfma_f32_16x16x32_bf16 v[48:51], v[140:143], v[108:111], v[48:51]
 v_mfma_f32_16x16x32_bf16 v[56:59], v[140:143], v[132:135], v[56:59]
 s_waitcnt lgkmcnt(3)
 v_mfma_f32_16x16x32_bf16 v[44:47], v[144:147], v[64:67], 0
 ds_read_b128 v[140:143], v23 offset:13952
 v_mfma_f32_16x16x32_bf16 v[52:55], v[144:147], v[88:91], 0
 s_waitcnt lgkmcnt(3)
 v_lshlrev_b32 v27, 16, v208
 v_and_b32 v208, 0xffff0000, v208
 v_cvt_pk_f16_f32 v208, v27, v208
 v_accvgpr_write_b32 a8, v208
 v_mfma_f32_16x16x32_bf16 v[60:63], v[144:147], v[112:115], 0
 v_lshlrev_b32 v27, 16, v209
 v_and_b32 v209, 0xffff0000, v209
 v_cvt_pk_f16_f32 v209, v27, v209
 v_accvgpr_write_b32 a9, v209
 s_waitcnt lgkmcnt(2)
 v_mfma_f32_16x16x32_bf16 v[44:47], v[148:151], v[68:71], v[44:47]
 ds_read_b128 v[144:147], v22 offset:14080
 v_cvt_pk_f16_f32 v40, v40, v41
 v_lshlrev_b32 v27, 16, v210
 v_and_b32 v210, 0xffff0000, v210
 v_cvt_pk_f16_f32 v210, v27, v210
 v_mfma_f32_16x16x32_bf16 v[52:55], v[148:151], v[92:95], v[52:55]
 v_accvgpr_write_b32 a196, v40
 v_accvgpr_write_b32 a10, v210
 v_lshlrev_b32 v27, 16, v211
 v_and_b32 v211, 0xffff0000, v211
 v_cvt_pk_f16_f32 v211, v27, v211
 v_mfma_f32_16x16x32_bf16 v[60:63], v[148:151], v[116:119], v[60:63]
 v_cvt_pk_f16_f32 v42, v42, v43
 v_accvgpr_write_b32 a11, v211
 v_lshlrev_b32 v27, 16, v212
 v_and_b32 v212, 0xffff0000, v212
 s_waitcnt lgkmcnt(2)
 v_mfma_f32_16x16x32_bf16 v[44:47], v[136:139], v[72:75], v[44:47]
 ds_read_b128 v[148:151], v23 offset:14080
 v_accvgpr_write_b32 a197, v42
 v_cvt_pk_f16_f32 v212, v27, v212
 v_accvgpr_write_b32 a28, v212
 v_lshlrev_b32 v27, 16, v213
 v_mfma_f32_16x16x32_bf16 v[52:55], v[136:139], v[96:99], v[52:55]
 v_cvt_pk_f16_f32 v48, v48, v49
 v_and_b32 v213, 0xffff0000, v213
 v_cvt_pk_f16_f32 v213, v27, v213
 v_accvgpr_write_b32 a29, v213
 v_lshlrev_b32 v27, 16, v214
 v_mfma_f32_16x16x32_bf16 v[60:63], v[136:139], v[120:123], v[60:63]
 v_accvgpr_write_b32 a204, v48
 v_and_b32 v214, 0xffff0000, v214
 v_cvt_pk_f16_f32 v214, v27, v214
 v_accvgpr_write_b32 a30, v214
 s_waitcnt lgkmcnt(2)
 v_mfma_f32_16x16x32_bf16 v[44:47], v[140:143], v[76:79], v[44:47]
 s_waitcnt vmcnt(18)
 ds_read_b128 v[136:139], v22 offset:24576
 v_cvt_pk_f16_f32 v50, v50, v51
 v_lshlrev_b32 v27, 16, v215
 v_and_b32 v215, 0xffff0000, v215
 v_cvt_pk_f16_f32 v215, v27, v215
 v_mfma_f32_16x16x32_bf16 v[52:55], v[140:143], v[100:103], v[52:55]
 v_accvgpr_write_b32 a205, v50
 v_accvgpr_write_b32 a31, v215
 v_lshlrev_b32 v27, 16, v216
 v_and_b32 v216, 0xffff0000, v216
 v_cvt_pk_f16_f32 v216, v27, v216
 v_mfma_f32_16x16x32_bf16 v[60:63], v[140:143], v[124:127], v[60:63]
 v_cvt_pk_f16_f32 v56, v56, v57
 v_accvgpr_write_b32 a48, v216
 v_lshlrev_b32 v27, 16, v217
 v_and_b32 v217, 0xffff0000, v217
 s_waitcnt lgkmcnt(2)
 v_mfma_f32_16x16x32_bf16 v[44:47], v[144:147], v[80:83], v[44:47]
 ds_read_b128 v[140:143], v23 offset:24576
 v_accvgpr_write_b32 a212, v56
 v_cvt_pk_f16_f32 v217, v27, v217
 v_accvgpr_write_b32 a49, v217
 v_lshlrev_b32 v27, 16, v218
 v_mfma_f32_16x16x32_bf16 v[52:55], v[144:147], v[104:107], v[52:55]
 v_cvt_pk_f16_f32 v58, v58, v59
 v_and_b32 v218, 0xffff0000, v218
 v_cvt_pk_f16_f32 v218, v27, v218
 v_accvgpr_write_b32 a50, v218
 v_lshlrev_b32 v27, 16, v219
 v_mfma_f32_16x16x32_bf16 v[60:63], v[144:147], v[128:131], v[60:63]
 v_accvgpr_write_b32 a213, v58
 v_and_b32 v219, 0xffff0000, v219
 v_cvt_pk_f16_f32 v219, v27, v219
 v_accvgpr_write_b32 a51, v219
 s_waitcnt lgkmcnt(2)
 v_mfma_f32_16x16x32_bf16 v[44:47], v[148:151], v[84:87], v[44:47]
 ds_read_b128 v[144:147], v22 offset:24704
 s_add_u32 m0, s81, 12288
 s_add_u32 s21, s88, 4030464
 v_mfma_f32_16x16x32_bf16 v[52:55], v[148:151], v[108:111], v[52:55]
 buffer_load_dwordx4 v28, s[12:15], s21 offen offset:0 lds
 v_mfma_f32_16x16x32_bf16 v[60:63], v[148:151], v[132:135], v[60:63]
 buffer_load_dwordx4 v29, s[12:15], s21 offen offset:1024 lds
 s_waitcnt lgkmcnt(2)
 v_mfma_f32_16x16x32_bf16 v[40:43], v[136:139], v[64:67], 0
 ds_read_b128 v[148:151], v23 offset:24704
 buffer_load_dwordx4 v30, s[12:15], s21 offen offset:2048 lds
 s_waitcnt vmcnt(18)
 v_mfma_f32_16x16x32_bf16 v[48:51], v[136:139], v[88:91], 0
 s_add_u32 m0, s81, 15360
 s_add_u32 s21, s88, 4079616
 ds_write_b128 v251, v[220:223] offset:36864
 v_mfma_f32_16x16x32_bf16 v[56:59], v[136:139], v[112:115], 0
 buffer_load_dwordx4 v31, s[12:15], s21 offen offset:0 lds
 ds_write_b128 v251, v[224:227] offset:37888
 s_waitcnt lgkmcnt(4)
 v_mfma_f32_16x16x32_bf16 v[40:43], v[140:143], v[68:71], v[40:43]
 ds_read_b128 v[136:139], v22 offset:24832
 v_cvt_pk_f16_f32 v44, v44, v45
 buffer_load_dwordx4 v32, s[12:15], s21 offen offset:1024 lds
 v_accvgpr_write_b32 a198, v44
 v_mfma_f32_16x16x32_bf16 v[48:51], v[140:143], v[92:95], v[48:51]
 v_cvt_pk_f16_f32 v46, v46, v47
 buffer_load_dwordx4 v33, s[12:15], s21 offen offset:2048 lds
 ds_write_b128 v251, v[228:231] offset:38912
 v_mfma_f32_16x16x32_bf16 v[56:59], v[140:143], v[116:119], v[56:59]
 v_accvgpr_write_b32 a199, v46
 s_add_u32 m0, s81, 18432
 s_add_u32 s21, s88, 4521984
 ds_read_b64_tr_b16 v[208:209], v250 offset:36864
 s_waitcnt lgkmcnt(6)
 v_mfma_f32_16x16x32_bf16 v[40:43], v[144:147], v[72:75], v[40:43]
 ds_read_b128 v[140:143], v23 offset:24832
 v_cvt_pk_f16_f32 v52, v52, v53
 buffer_load_dwordx4 v34, s[12:15], s21 offen offset:0 lds
 ds_read_b64_tr_b16 v[210:211], v250 offset:37248
 v_mfma_f32_16x16x32_bf16 v[48:51], v[144:147], v[96:99], v[48:51]
 v_accvgpr_write_b32 a206, v52
 buffer_load_dwordx4 v35, s[12:15], s21 offen offset:1024 lds
 ds_read_b64_tr_b16 v[212:213], v250 offset:36896
 ds_read_b64_tr_b16 v[214:215], v250 offset:37280
 v_mfma_f32_16x16x32_bf16 v[56:59], v[144:147], v[120:123], v[56:59]
 v_cvt_pk_f16_f32 v54, v54, v55
 buffer_load_dwordx4 v36, s[12:15], s21 offen offset:2048 lds
 ds_read_b64_tr_b16 v[216:217], v250 offset:36928
 s_waitcnt lgkmcnt(10)
 v_mfma_f32_16x16x32_bf16 v[40:43], v[148:151], v[76:79], v[40:43]
 ds_read_b128 v[144:147], v22 offset:26112
 v_accvgpr_write_b32 a207, v54
 s_add_u32 m0, s81, 21504
 s_add_u32 s21, s88, 4571136
 ds_read_b64_tr_b16 v[218:219], v250 offset:37312
 v_mfma_f32_16x16x32_bf16 v[48:51], v[148:151], v[100:103], v[48:51]
 v_cvt_pk_f16_f32 v60, v60, v61
 buffer_load_dwordx4 v37, s[12:15], s21 offen offset:0 lds
 v_accvgpr_write_b32 a214, v60
 v_mfma_f32_16x16x32_bf16 v[56:59], v[148:151], v[124:127], v[56:59]
 v_cvt_pk_f16_f32 v62, v62, v63
 buffer_load_dwordx4 v38, s[12:15], s21 offen offset:1024 lds
 v_accvgpr_write_b32 a215, v62
 s_waitcnt lgkmcnt(9)
 v_mfma_f32_16x16x32_bf16 v[40:43], v[136:139], v[80:83], v[40:43]
 ds_read_b128 v[148:151], v23 offset:26112
 buffer_load_dwordx4 v39, s[12:15], s21 offen offset:2048 lds
 v_mfma_f32_16x16x32_bf16 v[48:51], v[136:139], v[104:107], v[48:51]
 v_mfma_f32_16x16x32_bf16 v[56:59], v[136:139], v[128:131], v[56:59]
 s_waitcnt lgkmcnt(7)
 v_mfma_f32_16x16x32_bf16 v[40:43], v[140:143], v[84:87], v[40:43]
 ds_read_b128 v[136:139], v22 offset:26240
 v_mfma_f32_16x16x32_bf16 v[48:51], v[140:143], v[108:111], v[48:51]
 s_waitcnt lgkmcnt(2)
 v_lshlrev_b32 v27, 16, v208
 v_and_b32 v208, 0xffff0000, v208
 v_cvt_pk_f16_f32 v208, v27, v208
 v_accvgpr_write_b32 a12, v208
 v_mfma_f32_16x16x32_bf16 v[56:59], v[140:143], v[132:135], v[56:59]
 v_lshlrev_b32 v27, 16, v209
 v_and_b32 v209, 0xffff0000, v209
 v_cvt_pk_f16_f32 v209, v27, v209
 v_accvgpr_write_b32 a13, v209
 s_waitcnt lgkmcnt(3)
 v_mfma_f32_16x16x32_bf16 v[44:47], v[144:147], v[64:67], 0
 ds_read_b128 v[140:143], v23 offset:26240
 v_lshlrev_b32 v27, 16, v210
 v_and_b32 v210, 0xffff0000, v210
 v_cvt_pk_f16_f32 v210, v27, v210
 v_accvgpr_write_b32 a14, v210
 v_mfma_f32_16x16x32_bf16 v[52:55], v[144:147], v[88:91], 0
 v_lshlrev_b32 v27, 16, v211
 v_and_b32 v211, 0xffff0000, v211
 v_cvt_pk_f16_f32 v211, v27, v211
 v_accvgpr_write_b32 a15, v211
 v_lshlrev_b32 v27, 16, v212
 v_mfma_f32_16x16x32_bf16 v[60:63], v[144:147], v[112:115], 0
 v_and_b32 v212, 0xffff0000, v212
 v_cvt_pk_f16_f32 v212, v27, v212
 v_accvgpr_write_b32 a32, v212
 v_lshlrev_b32 v27, 16, v213
 s_waitcnt lgkmcnt(2)
 v_mfma_f32_16x16x32_bf16 v[44:47], v[148:151], v[68:71], v[44:47]
 ds_read_b128 v[144:147], v22 offset:26368
 v_cvt_pk_f16_f32 v40, v40, v41
 v_and_b32 v213, 0xffff0000, v213
 v_cvt_pk_f16_f32 v213, v27, v213
 v_accvgpr_write_b32 a33, v213
 v_mfma_f32_16x16x32_bf16 v[52:55], v[148:151], v[92:95], v[52:55]
 v_accvgpr_write_b32 a216, v40
 v_lshlrev_b32 v27, 16, v214
 v_and_b32 v214, 0xffff0000, v214
 v_cvt_pk_f16_f32 v214, v27, v214
 v_accvgpr_write_b32 a34, v214
 v_mfma_f32_16x16x32_bf16 v[60:63], v[148:151], v[116:119], v[60:63]
 v_cvt_pk_f16_f32 v42, v42, v43
 v_lshlrev_b32 v27, 16, v215
 v_and_b32 v215, 0xffff0000, v215
 v_cvt_pk_f16_f32 v215, v27, v215
 s_waitcnt lgkmcnt(2)
 v_mfma_f32_16x16x32_bf16 v[44:47], v[136:139], v[72:75], v[44:47]
 ds_read_b128 v[148:151], v23 offset:26368
 v_accvgpr_write_b32 a217, v42
 v_accvgpr_write_b32 a35, v215
 v_lshlrev_b32 v27, 16, v216
 v_and_b32 v216, 0xffff0000, v216
 v_mfma_f32_16x16x32_bf16 v[52:55], v[136:139], v[96:99], v[52:55]
 v_cvt_pk_f16_f32 v48, v48, v49
 v_cvt_pk_f16_f32 v216, v27, v216
 v_accvgpr_write_b32 a52, v216
 v_lshlrev_b32 v27, 16, v217
 v_and_b32 v217, 0xffff0000, v217
 v_mfma_f32_16x16x32_bf16 v[60:63], v[136:139], v[120:123], v[60:63]
 v_accvgpr_write_b32 a224, v48
 v_cvt_pk_f16_f32 v217, v27, v217
 v_accvgpr_write_b32 a53, v217
 v_lshlrev_b32 v27, 16, v218
 s_waitcnt lgkmcnt(2)
 v_mfma_f32_16x16x32_bf16 v[44:47], v[140:143], v[76:79], v[44:47]
 s_waitcnt vmcnt(15)
 ds_read_b128 v[136:139], v22 offset:0
 v_cvt_pk_f16_f32 v50, v50, v51
 v_and_b32 v218, 0xffff0000, v218
 v_cvt_pk_f16_f32 v218, v27, v218
 v_accvgpr_write_b32 a54, v218
 v_mfma_f32_16x16x32_bf16 v[52:55], v[140:143], v[100:103], v[52:55]
 v_accvgpr_write_b32 a225, v50
 v_lshlrev_b32 v27, 16, v219
 v_and_b32 v219, 0xffff0000, v219
 v_cvt_pk_f16_f32 v219, v27, v219
 v_accvgpr_write_b32 a55, v219
 v_mfma_f32_16x16x32_bf16 v[60:63], v[140:143], v[124:127], v[60:63]
 v_cvt_pk_f16_f32 v56, v56, v57
 v_accvgpr_write_b32 a232, v56
 v_cvt_pk_f16_f32 v58, v58, v59
 v_accvgpr_write_b32 a233, v58
 s_waitcnt lgkmcnt(2)
 v_mfma_f32_16x16x32_bf16 v[44:47], v[144:147], v[80:83], v[44:47]
 ds_read_b128 v[140:143], v23 offset:0
 v_mfma_f32_16x16x32_bf16 v[52:55], v[144:147], v[104:107], v[52:55]
 v_mfma_f32_16x16x32_bf16 v[60:63], v[144:147], v[128:131], v[60:63]
 s_waitcnt lgkmcnt(2)
 v_mfma_f32_16x16x32_bf16 v[44:47], v[148:151], v[84:87], v[44:47]
 ds_read_b128 v[144:147], v22 offset:128
 s_add_u32 m0, s81, 24576
 s_add_u32 s21, s88, 5013504
 v_mfma_f32_16x16x32_bf16 v[52:55], v[148:151], v[108:111], v[52:55]
 buffer_load_dwordx4 v28, s[12:15], s21 offen offset:0 lds
 v_mfma_f32_16x16x32_bf16 v[60:63], v[148:151], v[132:135], v[60:63]
 buffer_load_dwordx4 v29, s[12:15], s21 offen offset:1024 lds
 s_waitcnt lgkmcnt(2)
 v_mfma_f32_16x16x32_bf16 v[40:43], v[136:139], v[64:67], 0
 ds_read_b128 v[148:151], v23 offset:128
 buffer_load_dwordx4 v30, s[12:15], s21 offen offset:2048 lds
 s_waitcnt vmcnt(15)
 v_mfma_f32_16x16x32_bf16 v[48:51], v[136:139], v[88:91], 0
 s_add_u32 m0, s81, 27648
 s_add_u32 s21, s88, 5062656
 ds_write_b128 v251, v[232:235] offset:36864
 v_mfma_f32_16x16x32_bf16 v[56:59], v[136:139], v[112:115], 0
 buffer_load_dwordx4 v31, s[12:15], s21 offen offset:0 lds
 ds_write_b128 v251, v[236:239] offset:37888
 s_waitcnt lgkmcnt(4)
 v_mfma_f32_16x16x32_bf16 v[40:43], v[140:143], v[68:71], v[40:43]
 ds_read_b128 v[136:139], v22 offset:256
 v_cvt_pk_f16_f32 v44, v44, v45
 buffer_load_dwordx4 v32, s[12:15], s21 offen offset:1024 lds
 v_accvgpr_write_b32 a218, v44
 v_mfma_f32_16x16x32_bf16 v[48:51], v[140:143], v[92:95], v[48:51]
 v_cvt_pk_f16_f32 v46, v46, v47
 buffer_load_dwordx4 v33, s[12:15], s21 offen offset:2048 lds
 ds_write_b128 v251, v[240:243] offset:38912
 v_mfma_f32_16x16x32_bf16 v[56:59], v[140:143], v[116:119], v[56:59]
 v_accvgpr_write_b32 a219, v46
 s_add_u32 m0, s81, 30720
 s_add_u32 s21, s88, 5505024
 ds_read_b64_tr_b16 v[208:209], v250 offset:36864
 s_waitcnt lgkmcnt(6)
 v_mfma_f32_16x16x32_bf16 v[40:43], v[144:147], v[72:75], v[40:43]
 ds_read_b128 v[140:143], v23 offset:256
 v_cvt_pk_f16_f32 v52, v52, v53
 buffer_load_dwordx4 v34, s[12:15], s21 offen offset:0 lds
 ds_read_b64_tr_b16 v[210:211], v250 offset:37248
 v_mfma_f32_16x16x32_bf16 v[48:51], v[144:147], v[96:99], v[48:51]
 v_accvgpr_write_b32 a226, v52
 buffer_load_dwordx4 v35, s[12:15], s21 offen offset:1024 lds
 ds_read_b64_tr_b16 v[212:213], v250 offset:36896
 ds_read_b64_tr_b16 v[214:215], v250 offset:37280
 v_mfma_f32_16x16x32_bf16 v[56:59], v[144:147], v[120:123], v[56:59]
 v_cvt_pk_f16_f32 v54, v54, v55
 buffer_load_dwordx4 v36, s[12:15], s21 offen offset:2048 lds
 ds_read_b64_tr_b16 v[216:217], v250 offset:36928
 s_waitcnt lgkmcnt(10)
 v_mfma_f32_16x16x32_bf16 v[40:43], v[148:151], v[76:79], v[40:43]
 ds_read_b128 v[144:147], v22 offset:1536
 v_accvgpr_write_b32 a227, v54
 s_add_u32 m0, s81, 33792
 s_add_u32 s21, s88, 5554176
 ds_read_b64_tr_b16 v[218:219], v250 offset:37312
 v_mfma_f32_16x16x32_bf16 v[48:51], v[148:151], v[100:103], v[48:51]
 v_cvt_pk_f16_f32 v60, v60, v61
 buffer_load_dwordx4 v37, s[12:15], s21 offen offset:0 lds
 v_accvgpr_write_b32 a234, v60
 v_mfma_f32_16x16x32_bf16 v[56:59], v[148:151], v[124:127], v[56:59]
 v_cvt_pk_f16_f32 v62, v62, v63
 buffer_load_dwordx4 v38, s[12:15], s21 offen offset:1024 lds
 v_accvgpr_write_b32 a235, v62
 s_waitcnt lgkmcnt(9)
 v_mfma_f32_16x16x32_bf16 v[40:43], v[136:139], v[80:83], v[40:43]
 ds_read_b128 v[148:151], v23 offset:1536
 buffer_load_dwordx4 v39, s[12:15], s21 offen offset:2048 lds
 v_mfma_f32_16x16x32_bf16 v[48:51], v[136:139], v[104:107], v[48:51]
 v_mfma_f32_16x16x32_bf16 v[56:59], v[136:139], v[128:131], v[56:59]
 s_waitcnt lgkmcnt(7)
 v_mfma_f32_16x16x32_bf16 v[40:43], v[140:143], v[84:87], v[40:43]
 ds_read_b128 v[136:139], v22 offset:1664
 v_mfma_f32_16x16x32_bf16 v[48:51], v[140:143], v[108:111], v[48:51]
 s_waitcnt lgkmcnt(2)
 v_lshlrev_b32 v27, 16, v208
 v_and_b32 v208, 0xffff0000, v208
 v_cvt_pk_f16_f32 v208, v27, v208
 v_accvgpr_write_b32 a16, v208
 v_mfma_f32_16x16x32_bf16 v[56:59], v[140:143], v[132:135], v[56:59]
 v_lshlrev_b32 v27, 16, v209
 v_and_b32 v209, 0xffff0000, v209
 v_cvt_pk_f16_f32 v209, v27, v209
 v_accvgpr_write_b32 a17, v209
 s_waitcnt lgkmcnt(3)
 v_mfma_f32_16x16x32_bf16 v[44:47], v[144:147], v[64:67], 0
 ds_read_b128 v[140:143], v23 offset:1664
 v_lshlrev_b32 v27, 16, v210
 v_and_b32 v210, 0xffff0000, v210
 v_cvt_pk_f16_f32 v210, v27, v210
 v_accvgpr_write_b32 a18, v210
 v_mfma_f32_16x16x32_bf16 v[52:55], v[144:147], v[88:91], 0
 v_lshlrev_b32 v27, 16, v211
 v_and_b32 v211, 0xffff0000, v211
 v_cvt_pk_f16_f32 v211, v27, v211
 v_accvgpr_write_b32 a19, v211
 v_lshlrev_b32 v27, 16, v212
 v_mfma_f32_16x16x32_bf16 v[60:63], v[144:147], v[112:115], 0
 v_and_b32 v212, 0xffff0000, v212
 v_cvt_pk_f16_f32 v212, v27, v212
 v_accvgpr_write_b32 a36, v212
 v_lshlrev_b32 v27, 16, v213
 s_waitcnt lgkmcnt(2)
 v_mfma_f32_16x16x32_bf16 v[44:47], v[148:151], v[68:71], v[44:47]
 ds_read_b128 v[144:147], v22 offset:1792
 v_cvt_pk_f16_f32 v40, v40, v41
 v_and_b32 v213, 0xffff0000, v213
 v_cvt_pk_f16_f32 v213, v27, v213
 v_accvgpr_write_b32 a37, v213
 v_mfma_f32_16x16x32_bf16 v[52:55], v[148:151], v[92:95], v[52:55]
 v_accvgpr_write_b32 a220, v40
 v_lshlrev_b32 v27, 16, v214
 v_and_b32 v214, 0xffff0000, v214
 v_cvt_pk_f16_f32 v214, v27, v214
 v_accvgpr_write_b32 a38, v214
 v_mfma_f32_16x16x32_bf16 v[60:63], v[148:151], v[116:119], v[60:63]
 v_cvt_pk_f16_f32 v42, v42, v43
 v_lshlrev_b32 v27, 16, v215
 v_and_b32 v215, 0xffff0000, v215
 v_cvt_pk_f16_f32 v215, v27, v215
 s_waitcnt lgkmcnt(2)
 v_mfma_f32_16x16x32_bf16 v[44:47], v[136:139], v[72:75], v[44:47]
 ds_read_b128 v[148:151], v23 offset:1792
 v_accvgpr_write_b32 a221, v42
 v_accvgpr_write_b32 a39, v215
 v_lshlrev_b32 v27, 16, v216
 v_and_b32 v216, 0xffff0000, v216
 v_mfma_f32_16x16x32_bf16 v[52:55], v[136:139], v[96:99], v[52:55]
 v_cvt_pk_f16_f32 v48, v48, v49
 v_cvt_pk_f16_f32 v216, v27, v216
 v_accvgpr_write_b32 a56, v216
 v_lshlrev_b32 v27, 16, v217
 v_and_b32 v217, 0xffff0000, v217
 v_mfma_f32_16x16x32_bf16 v[60:63], v[136:139], v[120:123], v[60:63]
 v_accvgpr_write_b32 a228, v48
 v_cvt_pk_f16_f32 v217, v27, v217
 v_accvgpr_write_b32 a57, v217
 v_lshlrev_b32 v27, 16, v218
 s_waitcnt lgkmcnt(2)
 v_mfma_f32_16x16x32_bf16 v[44:47], v[140:143], v[76:79], v[44:47]
 s_waitcnt vmcnt(12)
 ds_read_b128 v[136:139], v22 offset:12288
 v_cvt_pk_f16_f32 v50, v50, v51
 v_and_b32 v218, 0xffff0000, v218
 v_cvt_pk_f16_f32 v218, v27, v218
 v_accvgpr_write_b32 a58, v218
 v_mfma_f32_16x16x32_bf16 v[52:55], v[140:143], v[100:103], v[52:55]
 v_accvgpr_write_b32 a229, v50
 v_lshlrev_b32 v27, 16, v219
 v_and_b32 v219, 0xffff0000, v219
 v_cvt_pk_f16_f32 v219, v27, v219
 v_accvgpr_write_b32 a59, v219
 v_mfma_f32_16x16x32_bf16 v[60:63], v[140:143], v[124:127], v[60:63]
 v_cvt_pk_f16_f32 v56, v56, v57
 v_accvgpr_write_b32 a236, v56
 v_cvt_pk_f16_f32 v58, v58, v59
 v_accvgpr_write_b32 a237, v58
 s_waitcnt lgkmcnt(2)
 v_mfma_f32_16x16x32_bf16 v[44:47], v[144:147], v[80:83], v[44:47]
 ds_read_b128 v[140:143], v23 offset:12288
 v_mfma_f32_16x16x32_bf16 v[52:55], v[144:147], v[104:107], v[52:55]
 v_mfma_f32_16x16x32_bf16 v[60:63], v[144:147], v[128:131], v[60:63]
 s_waitcnt lgkmcnt(2)
 v_mfma_f32_16x16x32_bf16 v[44:47], v[148:151], v[84:87], v[44:47]
 ds_read_b128 v[144:147], v22 offset:12416
 s_add_u32 m0, s81, 0
 s_add_u32 s21, s88, 5898240
 v_mfma_f32_16x16x32_bf16 v[52:55], v[148:151], v[108:111], v[52:55]
 buffer_load_dwordx4 v28, s[12:15], s21 offen offset:0 lds
 v_mfma_f32_16x16x32_bf16 v[60:63], v[148:151], v[132:135], v[60:63]
 buffer_load_dwordx4 v29, s[12:15], s21 offen offset:1024 lds
 s_waitcnt lgkmcnt(2)
 v_mfma_f32_16x16x32_bf16 v[40:43], v[136:139], v[64:67], 0
 ds_read_b128 v[148:151], v23 offset:12416
 buffer_load_dwordx4 v30, s[12:15], s21 offen offset:2048 lds
 v_mfma_f32_16x16x32_bf16 v[48:51], v[136:139], v[88:91], 0
 s_add_u32 m0, s81, 3072
 s_add_u32 s21, s88, 5947392
 v_mfma_f32_16x16x32_bf16 v[56:59], v[136:139], v[112:115], 0
 buffer_load_dwordx4 v31, s[12:15], s21 offen offset:0 lds
 s_waitcnt lgkmcnt(2)
 v_mfma_f32_16x16x32_bf16 v[40:43], v[140:143], v[68:71], v[40:43]
 ds_read_b128 v[136:139], v22 offset:12544
 v_cvt_pk_f16_f32 v44, v44, v45
 buffer_load_dwordx4 v32, s[12:15], s21 offen offset:1024 lds
 v_accvgpr_write_b32 a222, v44
 v_mfma_f32_16x16x32_bf16 v[48:51], v[140:143], v[92:95], v[48:51]
 v_cvt_pk_f16_f32 v46, v46, v47
 buffer_load_dwordx4 v33, s[12:15], s21 offen offset:2048 lds
 v_accvgpr_write_b32 a223, v46
 v_cvt_pk_f16_f32 v52, v52, v53
 v_mfma_f32_16x16x32_bf16 v[56:59], v[140:143], v[116:119], v[56:59]
 v_accvgpr_write_b32 a230, v52
 s_add_u32 m0, s81, 6144
 s_add_u32 s21, s88, 6389760
 v_cvt_pk_f16_f32 v54, v54, v55
 s_waitcnt lgkmcnt(2)
 v_mfma_f32_16x16x32_bf16 v[40:43], v[144:147], v[72:75], v[40:43]
 ds_read_b128 v[140:143], v23 offset:12544
 v_accvgpr_write_b32 a231, v54
 buffer_load_dwordx4 v34, s[12:15], s21 offen offset:0 lds
 v_cvt_pk_f16_f32 v60, v60, v61
 v_mfma_f32_16x16x32_bf16 v[48:51], v[144:147], v[96:99], v[48:51]
 v_accvgpr_write_b32 a238, v60
 buffer_load_dwordx4 v35, s[12:15], s21 offen offset:1024 lds
 v_cvt_pk_f16_f32 v62, v62, v63
 v_accvgpr_write_b32 a239, v62
 v_mfma_f32_16x16x32_bf16 v[56:59], v[144:147], v[120:123], v[56:59]
 buffer_load_dwordx4 v36, s[12:15], s21 offen offset:2048 lds
 s_waitcnt lgkmcnt(2)
 v_mfma_f32_16x16x32_bf16 v[40:43], v[148:151], v[76:79], v[40:43]
 ds_read_b128 v[144:147], v22 offset:13824
 s_add_u32 m0, s81, 9216
 s_add_u32 s21, s88, 6438912
 v_mfma_f32_16x16x32_bf16 v[48:51], v[148:151], v[100:103], v[48:51]
 buffer_load_dwordx4 v37, s[12:15], s21 offen offset:0 lds
 v_mfma_f32_16x16x32_bf16 v[56:59], v[148:151], v[124:127], v[56:59]
 buffer_load_dwordx4 v38, s[12:15], s21 offen offset:1024 lds
 s_waitcnt lgkmcnt(2)
 v_mfma_f32_16x16x32_bf16 v[40:43], v[136:139], v[80:83], v[40:43]
 ds_read_b128 v[148:151], v23 offset:13824
 buffer_load_dwordx4 v39, s[12:15], s21 offen offset:2048 lds
 v_mfma_f32_16x16x32_bf16 v[48:51], v[136:139], v[104:107], v[48:51]
 v_mfma_f32_16x16x32_bf16 v[56:59], v[136:139], v[128:131], v[56:59]
 s_waitcnt lgkmcnt(2)
 v_mfma_f32_16x16x32_bf16 v[40:43], v[140:143], v[84:87], v[40:43]
 ds_read_b128 v[136:139], v22 offset:13952
 v_mfma_f32_16x16x32_bf16 v[48:51], v[140:143], v[108:111], v[48:51]
 v_mfma_f32_16x16x32_bf16 v[56:59], v[140:143], v[132:135], v[56:59]
 s_waitcnt lgkmcnt(2)
 v_mfma_f32_16x16x32_bf16 v[44:47], v[144:147], v[64:67], 0
 ds_read_b128 v[140:143], v23 offset:13952
 v_mfma_f32_16x16x32_bf16 v[52:55], v[144:147], v[88:91], 0
 v_mfma_f32_16x16x32_bf16 v[60:63], v[144:147], v[112:115], 0
 s_waitcnt lgkmcnt(2)
 v_mfma_f32_16x16x32_bf16 v[44:47], v[148:151], v[68:71], v[44:47]
 ds_read_b128 v[144:147], v22 offset:14080
 v_cvt_pk_f16_f32 v40, v40, v41
 v_accvgpr_write_b32 a240, v40
 v_cvt_pk_f16_f32 v42, v42, v43
 v_accvgpr_write_b32 a241, v42
 v_mfma_f32_16x16x32_bf16 v[52:55], v[148:151], v[92:95], v[52:55]
 v_cvt_pk_f16_f32 v48, v48, v49
 v_accvgpr_write_b32 a248, v48
 v_cvt_pk_f16_f32 v50, v50, v51
 v_accvgpr_write_b32 a249, v50
 v_cvt_pk_f16_f32 v152, v56, v57
 v_mfma_f32_16x16x32_bf16 v[60:63], v[148:151], v[116:119], v[60:63]
 v_cvt_pk_f16_f32 v153, v58, v59
 s_waitcnt lgkmcnt(2)
 v_mfma_f32_16x16x32_bf16 v[44:47], v[136:139], v[72:75], v[44:47]
 ds_read_b128 v[148:151], v23 offset:14080
 v_mfma_f32_16x16x32_bf16 v[52:55], v[136:139], v[96:99], v[52:55]
 v_mfma_f32_16x16x32_bf16 v[60:63], v[136:139], v[120:123], v[60:63]
 s_waitcnt lgkmcnt(2)
 v_mfma_f32_16x16x32_bf16 v[44:47], v[140:143], v[76:79], v[44:47]
 s_waitcnt vmcnt(12)
 ds_read_b128 v[136:139], v22 offset:24576
 v_mfma_f32_16x16x32_bf16 v[52:55], v[140:143], v[100:103], v[52:55]
 v_mfma_f32_16x16x32_bf16 v[60:63], v[140:143], v[124:127], v[60:63]
 s_waitcnt lgkmcnt(2)
 v_mfma_f32_16x16x32_bf16 v[44:47], v[144:147], v[80:83], v[44:47]
 ds_read_b128 v[140:143], v23 offset:24576
 v_mfma_f32_16x16x32_bf16 v[52:55], v[144:147], v[104:107], v[52:55]
 v_mfma_f32_16x16x32_bf16 v[60:63], v[144:147], v[128:131], v[60:63]
 s_waitcnt lgkmcnt(2)
 v_mfma_f32_16x16x32_bf16 v[44:47], v[148:151], v[84:87], v[44:47]
 ds_read_b128 v[144:147], v22 offset:24704
 s_add_u32 m0, s81, 12288
 s_add_u32 s21, s88, 6881280
 v_mfma_f32_16x16x32_bf16 v[52:55], v[148:151], v[108:111], v[52:55]
 buffer_load_dwordx4 v28, s[12:15], s21 offen offset:0 lds
 v_mfma_f32_16x16x32_bf16 v[60:63], v[148:151], v[132:135], v[60:63]
 buffer_load_dwordx4 v29, s[12:15], s21 offen offset:1024 lds
 s_waitcnt lgkmcnt(2)
 v_mfma_f32_16x16x32_bf16 v[40:43], v[136:139], v[64:67], 0
 ds_read_b128 v[148:151], v23 offset:24704
 buffer_load_dwordx4 v30, s[12:15], s21 offen offset:2048 lds
 v_mfma_f32_16x16x32_bf16 v[48:51], v[136:139], v[88:91], 0
 s_add_u32 m0, s81, 15360
 s_add_u32 s21, s88, 6930432
 v_mfma_f32_16x16x32_bf16 v[56:59], v[136:139], v[112:115], 0
 buffer_load_dwordx4 v31, s[12:15], s21 offen offset:0 lds
 s_waitcnt lgkmcnt(2)
 v_mfma_f32_16x16x32_bf16 v[40:43], v[140:143], v[68:71], v[40:43]
 ds_read_b128 v[136:139], v22 offset:24832
 v_cvt_pk_f16_f32 v44, v44, v45
 buffer_load_dwordx4 v32, s[12:15], s21 offen offset:1024 lds
 v_accvgpr_write_b32 a242, v44
 v_mfma_f32_16x16x32_bf16 v[48:51], v[140:143], v[92:95], v[48:51]
 v_cvt_pk_f16_f32 v46, v46, v47
 buffer_load_dwordx4 v33, s[12:15], s21 offen offset:2048 lds
 v_accvgpr_write_b32 a243, v46
 v_cvt_pk_f16_f32 v52, v52, v53
 v_mfma_f32_16x16x32_bf16 v[56:59], v[140:143], v[116:119], v[56:59]
 v_accvgpr_write_b32 a250, v52
 s_add_u32 m0, s81, 18432
 s_add_u32 s21, s88, 7372800
 v_cvt_pk_f16_f32 v54, v54, v55
 s_waitcnt lgkmcnt(2)
 v_mfma_f32_16x16x32_bf16 v[40:43], v[144:147], v[72:75], v[40:43]
 ds_read_b128 v[140:143], v23 offset:24832
 v_accvgpr_write_b32 a251, v54
 buffer_load_dwordx4 v34, s[12:15], s21 offen offset:0 lds
 v_cvt_pk_f16_f32 v154, v60, v61
 v_mfma_f32_16x16x32_bf16 v[48:51], v[144:147], v[96:99], v[48:51]
 v_cvt_pk_f16_f32 v155, v62, v63
 buffer_load_dwordx4 v35, s[12:15], s21 offen offset:1024 lds
 v_mfma_f32_16x16x32_bf16 v[56:59], v[144:147], v[120:123], v[56:59]
 buffer_load_dwordx4 v36, s[12:15], s21 offen offset:2048 lds
 s_waitcnt lgkmcnt(2)
 v_mfma_f32_16x16x32_bf16 v[40:43], v[148:151], v[76:79], v[40:43]
 ds_read_b128 v[144:147], v22 offset:26112
 s_add_u32 m0, s81, 21504
 s_add_u32 s21, s88, 7421952
 v_mfma_f32_16x16x32_bf16 v[48:51], v[148:151], v[100:103], v[48:51]
 buffer_load_dwordx4 v37, s[12:15], s21 offen offset:0 lds
 v_mfma_f32_16x16x32_bf16 v[56:59], v[148:151], v[124:127], v[56:59]
 buffer_load_dwordx4 v38, s[12:15], s21 offen offset:1024 lds
 s_waitcnt lgkmcnt(2)
 v_mfma_f32_16x16x32_bf16 v[40:43], v[136:139], v[80:83], v[40:43]
 ds_read_b128 v[148:151], v23 offset:26112
 buffer_load_dwordx4 v39, s[12:15], s21 offen offset:2048 lds
 v_mfma_f32_16x16x32_bf16 v[48:51], v[136:139], v[104:107], v[48:51]
 v_mfma_f32_16x16x32_bf16 v[56:59], v[136:139], v[128:131], v[56:59]
 s_waitcnt lgkmcnt(2)
 v_mfma_f32_16x16x32_bf16 v[40:43], v[140:143], v[84:87], v[40:43]
 ds_read_b128 v[136:139], v22 offset:26240
 v_mfma_f32_16x16x32_bf16 v[48:51], v[140:143], v[108:111], v[48:51]
 v_mfma_f32_16x16x32_bf16 v[56:59], v[140:143], v[132:135], v[56:59]
 s_waitcnt lgkmcnt(2)
 v_mfma_f32_16x16x32_bf16 v[44:47], v[144:147], v[64:67], 0
 ds_read_b128 v[140:143], v23 offset:26240
 v_mfma_f32_16x16x32_bf16 v[52:55], v[144:147], v[88:91], 0
 v_mfma_f32_16x16x32_bf16 v[60:63], v[144:147], v[112:115], 0
 s_waitcnt lgkmcnt(2)
 v_mfma_f32_16x16x32_bf16 v[44:47], v[148:151], v[68:71], v[44:47]
 ds_read_b128 v[144:147], v22 offset:26368
 v_cvt_pk_f16_f32 v40, v40, v41
 v_accvgpr_write_b32 a244, v40
 v_cvt_pk_f16_f32 v42, v42, v43
 v_accvgpr_write_b32 a245, v42
 v_mfma_f32_16x16x32_bf16 v[52:55], v[148:151], v[92:95], v[52:55]
 v_cvt_pk_f16_f32 v48, v48, v49
 v_accvgpr_write_b32 a252, v48
 v_cvt_pk_f16_f32 v50, v50, v51
 v_accvgpr_write_b32 a253, v50
 v_cvt_pk_f16_f32 v156, v56, v57
 v_mfma_f32_16x16x32_bf16 v[60:63], v[148:151], v[116:119], v[60:63]
 v_cvt_pk_f16_f32 v157, v58, v59
 s_waitcnt lgkmcnt(2)
 v_mfma_f32_16x16x32_bf16 v[44:47], v[136:139], v[72:75], v[44:47]
 ds_read_b128 v[148:151], v23 offset:26368
 v_mfma_f32_16x16x32_bf16 v[52:55], v[136:139], v[96:99], v[52:55]
 v_mfma_f32_16x16x32_bf16 v[60:63], v[136:139], v[120:123], v[60:63]
 s_waitcnt lgkmcnt(2)
 v_mfma_f32_16x16x32_bf16 v[44:47], v[140:143], v[76:79], v[44:47]
 s_waitcnt vmcnt(12)
 ds_read_b128 v[136:139], v22 offset:0
 v_mfma_f32_16x16x32_bf16 v[52:55], v[140:143], v[100:103], v[52:55]
 v_mfma_f32_16x16x32_bf16 v[60:63], v[140:143], v[124:127], v[60:63]
 s_waitcnt lgkmcnt(2)
 v_mfma_f32_16x16x32_bf16 v[44:47], v[144:147], v[80:83], v[44:47]
 ds_read_b128 v[140:143], v23 offset:0
 v_mfma_f32_16x16x32_bf16 v[52:55], v[144:147], v[104:107], v[52:55]
 v_mfma_f32_16x16x32_bf16 v[60:63], v[144:147], v[128:131], v[60:63]
 s_waitcnt lgkmcnt(2)
 v_mfma_f32_16x16x32_bf16 v[44:47], v[148:151], v[84:87], v[44:47]
 ds_read_b128 v[144:147], v22 offset:128
 s_add_u32 m0, s81, 24576
 s_add_u32 s21, s88, 5996544
 v_mfma_f32_16x16x32_bf16 v[52:55], v[148:151], v[108:111], v[52:55]
 buffer_load_dwordx4 v28, s[12:15], s21 offen offset:0 lds
 v_mfma_f32_16x16x32_bf16 v[60:63], v[148:151], v[132:135], v[60:63]
 buffer_load_dwordx4 v29, s[12:15], s21 offen offset:1024 lds
 s_waitcnt lgkmcnt(2)
 v_mfma_f32_16x16x32_bf16 v[40:43], v[136:139], v[64:67], 0
 ds_read_b128 v[148:151], v23 offset:128
 buffer_load_dwordx4 v30, s[12:15], s21 offen offset:2048 lds
 v_mfma_f32_16x16x32_bf16 v[48:51], v[136:139], v[88:91], 0
 s_add_u32 m0, s81, 27648
 s_add_u32 s21, s88, 6045696
 v_mfma_f32_16x16x32_bf16 v[56:59], v[136:139], v[112:115], 0
 buffer_load_dwordx4 v31, s[12:15], s21 offen offset:0 lds
 s_waitcnt lgkmcnt(2)
 v_mfma_f32_16x16x32_bf16 v[40:43], v[140:143], v[68:71], v[40:43]
 ds_read_b128 v[136:139], v22 offset:256
 v_cvt_pk_f16_f32 v44, v44, v45
 buffer_load_dwordx4 v32, s[12:15], s21 offen offset:1024 lds
 v_accvgpr_write_b32 a246, v44
 v_mfma_f32_16x16x32_bf16 v[48:51], v[140:143], v[92:95], v[48:51]
 v_cvt_pk_f16_f32 v46, v46, v47
 buffer_load_dwordx4 v33, s[12:15], s21 offen offset:2048 lds
 v_accvgpr_write_b32 a247, v46
 v_cvt_pk_f16_f32 v52, v52, v53
 v_mfma_f32_16x16x32_bf16 v[56:59], v[140:143], v[116:119], v[56:59]
 v_accvgpr_write_b32 a254, v52
 s_add_u32 m0, s81, 30720
 s_add_u32 s21, s88, 6488064
 v_cvt_pk_f16_f32 v54, v54, v55
 s_waitcnt lgkmcnt(2)
 v_mfma_f32_16x16x32_bf16 v[40:43], v[144:147], v[72:75], v[40:43]
 ds_read_b128 v[140:143], v23 offset:256
 v_accvgpr_write_b32 a255, v54
 buffer_load_dwordx4 v34, s[12:15], s21 offen offset:0 lds
 v_cvt_pk_f16_f32 v158, v60, v61
 v_mfma_f32_16x16x32_bf16 v[48:51], v[144:147], v[96:99], v[48:51]
 v_cvt_pk_f16_f32 v159, v62, v63
 buffer_load_dwordx4 v35, s[12:15], s21 offen offset:1024 lds
 v_mfma_f32_16x16x32_bf16 v[56:59], v[144:147], v[120:123], v[56:59]
 buffer_load_dwordx4 v36, s[12:15], s21 offen offset:2048 lds
 s_waitcnt lgkmcnt(2)
 v_mfma_f32_16x16x32_bf16 v[40:43], v[148:151], v[76:79], v[40:43]
 ds_read_b128 v[144:147], v22 offset:1536
 s_add_u32 m0, s81, 33792
 s_add_u32 s21, s88, 6537216
 v_mfma_f32_16x16x32_bf16 v[48:51], v[148:151], v[100:103], v[48:51]
 buffer_load_dwordx4 v37, s[12:15], s21 offen offset:0 lds
 v_mfma_f32_16x16x32_bf16 v[56:59], v[148:151], v[124:127], v[56:59]
 buffer_load_dwordx4 v38, s[12:15], s21 offen offset:1024 lds
 s_waitcnt lgkmcnt(2)
 v_mfma_f32_16x16x32_bf16 v[40:43], v[136:139], v[80:83], v[40:43]
 ds_read_b128 v[148:151], v23 offset:1536
 buffer_load_dwordx4 v39, s[12:15], s21 offen offset:2048 lds
 v_mfma_f32_16x16x32_bf16 v[48:51], v[136:139], v[104:107], v[48:51]
 v_mfma_f32_16x16x32_bf16 v[56:59], v[136:139], v[128:131], v[56:59]
 s_waitcnt lgkmcnt(2)
 v_mfma_f32_16x16x32_bf16 v[40:43], v[140:143], v[84:87], v[40:43]
 ds_read_b128 v[136:139], v22 offset:1664
 v_mfma_f32_16x16x32_bf16 v[48:51], v[140:143], v[108:111], v[48:51]
 v_mfma_f32_16x16x32_bf16 v[56:59], v[140:143], v[132:135], v[56:59]
 s_waitcnt lgkmcnt(2)
 v_mfma_f32_16x16x32_bf16 v[44:47], v[144:147], v[64:67], 0
 ds_read_b128 v[140:143], v23 offset:1664
 v_mfma_f32_16x16x32_bf16 v[52:55], v[144:147], v[88:91], 0
 v_mfma_f32_16x16x32_bf16 v[60:63], v[144:147], v[112:115], 0
 s_waitcnt lgkmcnt(2)
 v_mfma_f32_16x16x32_bf16 v[44:47], v[148:151], v[68:71], v[44:47]
 ds_read_b128 v[144:147], v22 offset:1792
 v_cvt_pk_f16_f32 v160, v40, v41
 v_cvt_pk_f16_f32 v161, v42, v43
 v_cvt_pk_f16_f32 v168, v48, v49
 v_cvt_pk_f16_f32 v169, v50, v51
 v_mfma_f32_16x16x32_bf16 v[52:55], v[148:151], v[92:95], v[52:55]
 v_cvt_pk_f16_f32 v176, v56, v57
 v_cvt_pk_f16_f32 v177, v58, v59
 v_mfma_f32_16x16x32_bf16 v[60:63], v[148:151], v[116:119], v[60:63]
 s_waitcnt lgkmcnt(2)
 v_mfma_f32_16x16x32_bf16 v[44:47], v[136:139], v[72:75], v[44:47]
 ds_read_b128 v[148:151], v23 offset:1792
 v_mfma_f32_16x16x32_bf16 v[52:55], v[136:139], v[96:99], v[52:55]
 v_mfma_f32_16x16x32_bf16 v[60:63], v[136:139], v[120:123], v[60:63]
 s_waitcnt lgkmcnt(2)
 v_mfma_f32_16x16x32_bf16 v[44:47], v[140:143], v[76:79], v[44:47]
 s_waitcnt vmcnt(12)
 ds_read_b128 v[136:139], v22 offset:12288
 v_mfma_f32_16x16x32_bf16 v[52:55], v[140:143], v[100:103], v[52:55]
 v_mfma_f32_16x16x32_bf16 v[60:63], v[140:143], v[124:127], v[60:63]
 s_waitcnt lgkmcnt(2)
 v_mfma_f32_16x16x32_bf16 v[44:47], v[144:147], v[80:83], v[44:47]
 ds_read_b128 v[140:143], v23 offset:12288
 v_mfma_f32_16x16x32_bf16 v[52:55], v[144:147], v[104:107], v[52:55]
 v_mfma_f32_16x16x32_bf16 v[60:63], v[144:147], v[128:131], v[60:63]
 s_waitcnt lgkmcnt(2)
 v_mfma_f32_16x16x32_bf16 v[44:47], v[148:151], v[84:87], v[44:47]
 ds_read_b128 v[144:147], v22 offset:12416
 s_add_u32 m0, s81, 0
 s_add_u32 s21, s88, 6979584
 v_mfma_f32_16x16x32_bf16 v[52:55], v[148:151], v[108:111], v[52:55]
 buffer_load_dwordx4 v28, s[12:15], s21 offen offset:0 lds
 v_mfma_f32_16x16x32_bf16 v[60:63], v[148:151], v[132:135], v[60:63]
 buffer_load_dwordx4 v29, s[12:15], s21 offen offset:1024 lds
 s_waitcnt lgkmcnt(2)
 v_mfma_f32_16x16x32_bf16 v[40:43], v[136:139], v[64:67], 0
 ds_read_b128 v[148:151], v23 offset:12416
 buffer_load_dwordx4 v30, s[12:15], s21 offen offset:2048 lds
 v_mfma_f32_16x16x32_bf16 v[48:51], v[136:139], v[88:91], 0
 s_add_u32 m0, s81, 3072
 s_add_u32 s21, s88, 7028736
 v_mfma_f32_16x16x32_bf16 v[56:59], v[136:139], v[112:115], 0
 buffer_load_dwordx4 v31, s[12:15], s21 offen offset:0 lds
 s_waitcnt lgkmcnt(2)
 v_mfma_f32_16x16x32_bf16 v[40:43], v[140:143], v[68:71], v[40:43]
 ds_read_b128 v[136:139], v22 offset:12544
 v_cvt_pk_f16_f32 v162, v44, v45
 buffer_load_dwordx4 v32, s[12:15], s21 offen offset:1024 lds
 v_cvt_pk_f16_f32 v163, v46, v47
 v_mfma_f32_16x16x32_bf16 v[48:51], v[140:143], v[92:95], v[48:51]
 v_cvt_pk_f16_f32 v170, v52, v53
 buffer_load_dwordx4 v33, s[12:15], s21 offen offset:2048 lds
 v_cvt_pk_f16_f32 v171, v54, v55
 v_cvt_pk_f16_f32 v178, v60, v61
 v_mfma_f32_16x16x32_bf16 v[56:59], v[140:143], v[116:119], v[56:59]
 v_cvt_pk_f16_f32 v179, v62, v63
 s_add_u32 m0, s81, 6144
 s_add_u32 s21, s88, 7471104
 s_waitcnt lgkmcnt(2)
 v_mfma_f32_16x16x32_bf16 v[40:43], v[144:147], v[72:75], v[40:43]
 ds_read_b128 v[140:143], v23 offset:12544
 buffer_load_dwordx4 v34, s[12:15], s21 offen offset:0 lds
 v_mfma_f32_16x16x32_bf16 v[48:51], v[144:147], v[96:99], v[48:51]
 buffer_load_dwordx4 v35, s[12:15], s21 offen offset:1024 lds
 v_mfma_f32_16x16x32_bf16 v[56:59], v[144:147], v[120:123], v[56:59]
 buffer_load_dwordx4 v36, s[12:15], s21 offen offset:2048 lds
 s_waitcnt lgkmcnt(2)
 v_mfma_f32_16x16x32_bf16 v[40:43], v[148:151], v[76:79], v[40:43]
 ds_read_b128 v[144:147], v22 offset:13824
 s_add_u32 m0, s81, 9216
 s_add_u32 s21, s88, 7520256
 v_mfma_f32_16x16x32_bf16 v[48:51], v[148:151], v[100:103], v[48:51]
 buffer_load_dwordx4 v37, s[12:15], s21 offen offset:0 lds
 v_mfma_f32_16x16x32_bf16 v[56:59], v[148:151], v[124:127], v[56:59]
 buffer_load_dwordx4 v38, s[12:15], s21 offen offset:1024 lds
 s_waitcnt lgkmcnt(2)
 v_mfma_f32_16x16x32_bf16 v[40:43], v[136:139], v[80:83], v[40:43]
 ds_read_b128 v[148:151], v23 offset:13824
 buffer_load_dwordx4 v39, s[12:15], s21 offen offset:2048 lds
 v_mfma_f32_16x16x32_bf16 v[48:51], v[136:139], v[104:107], v[48:51]
 buffer_load_dword v0, v26, s[32:35], 0 offen sc1
 v_mfma_f32_16x16x32_bf16 v[56:59], v[136:139], v[128:131], v[56:59]
 v_and_b32 v253, 31, v1
 buffer_load_ubyte v252, v253, s[32:35], 0 offen offset:160 sc1
 s_waitcnt lgkmcnt(2)
 v_mfma_f32_16x16x32_bf16 v[40:43], v[140:143], v[84:87], v[40:43]
 ds_read_b128 v[136:139], v22 offset:13952
 v_mfma_f32_16x16x32_bf16 v[48:51], v[140:143], v[108:111], v[48:51]
 v_mfma_f32_16x16x32_bf16 v[56:59], v[140:143], v[132:135], v[56:59]
 s_waitcnt lgkmcnt(2)
 v_mfma_f32_16x16x32_bf16 v[44:47], v[144:147], v[64:67], 0
 ds_read_b128 v[140:143], v23 offset:13952
 v_mfma_f32_16x16x32_bf16 v[52:55], v[144:147], v[88:91], 0
 v_mfma_f32_16x16x32_bf16 v[60:63], v[144:147], v[112:115], 0
 s_waitcnt lgkmcnt(2)
 v_mfma_f32_16x16x32_bf16 v[44:47], v[148:151], v[68:71], v[44:47]
 ds_read_b128 v[144:147], v22 offset:14080
 v_cvt_pk_f16_f32 v164, v40, v41
 v_cvt_pk_f16_f32 v165, v42, v43
 v_cvt_pk_f16_f32 v172, v48, v49
 v_cvt_pk_f16_f32 v173, v50, v51
 v_mfma_f32_16x16x32_bf16 v[52:55], v[148:151], v[92:95], v[52:55]
 v_cvt_pk_f16_f32 v180, v56, v57
 v_cvt_pk_f16_f32 v181, v58, v59
 v_mfma_f32_16x16x32_bf16 v[60:63], v[148:151], v[116:119], v[60:63]
 s_waitcnt lgkmcnt(2)
 v_mfma_f32_16x16x32_bf16 v[44:47], v[136:139], v[72:75], v[44:47]
 ds_read_b128 v[148:151], v23 offset:14080
 v_mfma_f32_16x16x32_bf16 v[52:55], v[136:139], v[96:99], v[52:55]
 v_mfma_f32_16x16x32_bf16 v[60:63], v[136:139], v[120:123], v[60:63]
 s_waitcnt lgkmcnt(2)
 v_mfma_f32_16x16x32_bf16 v[44:47], v[140:143], v[76:79], v[44:47]
 s_waitcnt vmcnt(14)
 ds_read_b128 v[136:139], v22 offset:24576
 v_mfma_f32_16x16x32_bf16 v[52:55], v[140:143], v[100:103], v[52:55]
 v_mfma_f32_16x16x32_bf16 v[60:63], v[140:143], v[124:127], v[60:63]
 s_waitcnt lgkmcnt(2)
 v_mfma_f32_16x16x32_bf16 v[44:47], v[144:147], v[80:83], v[44:47]
 ds_read_b128 v[140:143], v23 offset:24576
 v_mfma_f32_16x16x32_bf16 v[52:55], v[144:147], v[104:107], v[52:55]
 v_mfma_f32_16x16x32_bf16 v[60:63], v[144:147], v[128:131], v[60:63]
 s_waitcnt lgkmcnt(2)
 v_mfma_f32_16x16x32_bf16 v[44:47], v[148:151], v[84:87], v[44:47]
 ds_read_b128 v[144:147], v22 offset:24704
 s_add_u32 m0, s81, 12288
 s_add_u32 s21, s88, 196608
 v_mfma_f32_16x16x32_bf16 v[52:55], v[148:151], v[108:111], v[52:55]
 buffer_load_dwordx4 v28, s[12:15], s21 offen offset:0 lds
 v_mfma_f32_16x16x32_bf16 v[60:63], v[148:151], v[132:135], v[60:63]
 buffer_load_dwordx4 v29, s[12:15], s21 offen offset:1024 lds
 s_waitcnt lgkmcnt(2)
 v_mfma_f32_16x16x32_bf16 v[40:43], v[136:139], v[64:67], 0
 ds_read_b128 v[148:151], v23 offset:24704
 buffer_load_dwordx4 v30, s[12:15], s21 offen offset:2048 lds
 v_mfma_f32_16x16x32_bf16 v[48:51], v[136:139], v[88:91], 0
 s_add_u32 m0, s81, 15360
 s_add_u32 s21, s88, 2162688
 v_mfma_f32_16x16x32_bf16 v[56:59], v[136:139], v[112:115], 0
 buffer_load_dwordx4 v31, s[12:15], s21 offen offset:0 lds
 s_waitcnt lgkmcnt(2)
 v_mfma_f32_16x16x32_bf16 v[40:43], v[140:143], v[68:71], v[40:43]
 ds_read_b128 v[136:139], v22 offset:24832
 v_cvt_pk_f16_f32 v166, v44, v45
 buffer_load_dwordx4 v32, s[12:15], s21 offen offset:1024 lds
 v_cvt_pk_f16_f32 v167, v46, v47
 v_mfma_f32_16x16x32_bf16 v[48:51], v[140:143], v[92:95], v[48:51]
 v_cvt_pk_f16_f32 v174, v52, v53
 buffer_load_dwordx4 v33, s[12:15], s21 offen offset:2048 lds
 v_cvt_pk_f16_f32 v175, v54, v55
 v_cvt_pk_f16_f32 v182, v60, v61
 v_mfma_f32_16x16x32_bf16 v[56:59], v[140:143], v[116:119], v[56:59]
 v_cvt_pk_f16_f32 v183, v62, v63
 s_add_u32 m0, s81, 18432
 s_add_u32 s21, s88, 688128
 s_waitcnt lgkmcnt(2)
 v_mfma_f32_16x16x32_bf16 v[40:43], v[144:147], v[72:75], v[40:43]
 ds_read_b128 v[140:143], v23 offset:24832
 buffer_load_dwordx4 v34, s[12:15], s21 offen offset:0 lds
 v_mfma_f32_16x16x32_bf16 v[48:51], v[144:147], v[96:99], v[48:51]
 buffer_load_dwordx4 v35, s[12:15], s21 offen offset:1024 lds
 v_mfma_f32_16x16x32_bf16 v[56:59], v[144:147], v[120:123], v[56:59]
 buffer_load_dwordx4 v36, s[12:15], s21 offen offset:2048 lds
 s_waitcnt lgkmcnt(2)
 v_mfma_f32_16x16x32_bf16 v[40:43], v[148:151], v[76:79], v[40:43]
 ds_read_b128 v[144:147], v22 offset:26112
 s_add_u32 m0, s81, 21504
 s_add_u32 s21, s88, 2654208
 v_mfma_f32_16x16x32_bf16 v[48:51], v[148:151], v[100:103], v[48:51]
 buffer_load_dwordx4 v37, s[12:15], s21 offen offset:0 lds
 v_mfma_f32_16x16x32_bf16 v[56:59], v[148:151], v[124:127], v[56:59]
 buffer_load_dwordx4 v38, s[12:15], s21 offen offset:1024 lds
 s_waitcnt lgkmcnt(2)
 v_mfma_f32_16x16x32_bf16 v[40:43], v[136:139], v[80:83], v[40:43]
 ds_read_b128 v[148:151], v23 offset:26112
 buffer_load_dwordx4 v39, s[12:15], s21 offen offset:2048 lds
 v_mfma_f32_16x16x32_bf16 v[48:51], v[136:139], v[104:107], v[48:51]
 v_mfma_f32_16x16x32_bf16 v[56:59], v[136:139], v[128:131], v[56:59]
 s_waitcnt lgkmcnt(2)
 v_mfma_f32_16x16x32_bf16 v[40:43], v[140:143], v[84:87], v[40:43]
 ds_read_b128 v[136:139], v22 offset:26240
 v_mfma_f32_16x16x32_bf16 v[48:51], v[140:143], v[108:111], v[48:51]
 v_mfma_f32_16x16x32_bf16 v[56:59], v[140:143], v[132:135], v[56:59]
 s_waitcnt lgkmcnt(2)
 v_mfma_f32_16x16x32_bf16 v[44:47], v[144:147], v[64:67], 0
 ds_read_b128 v[140:143], v23 offset:26240
 v_mfma_f32_16x16x32_bf16 v[52:55], v[144:147], v[88:91], 0
 v_mfma_f32_16x16x32_bf16 v[60:63], v[144:147], v[112:115], 0
 s_waitcnt lgkmcnt(2)
 v_mfma_f32_16x16x32_bf16 v[44:47], v[148:151], v[68:71], v[44:47]
 ds_read_b128 v[144:147], v22 offset:26368
 v_cvt_pk_f16_f32 v184, v40, v41
 v_cvt_pk_f16_f32 v185, v42, v43
 v_cvt_pk_f16_f32 v192, v48, v49
 v_cvt_pk_f16_f32 v193, v50, v51
 v_mfma_f32_16x16x32_bf16 v[52:55], v[148:151], v[92:95], v[52:55]
 v_cvt_pk_f16_f32 v200, v56, v57
 v_cvt_pk_f16_f32 v201, v58, v59
 v_mfma_f32_16x16x32_bf16 v[60:63], v[148:151], v[116:119], v[60:63]
 s_waitcnt lgkmcnt(2)
 v_mfma_f32_16x16x32_bf16 v[44:47], v[136:139], v[72:75], v[44:47]
 ds_read_b128 v[148:151], v23 offset:26368
 v_mfma_f32_16x16x32_bf16 v[52:55], v[136:139], v[96:99], v[52:55]
 v_mfma_f32_16x16x32_bf16 v[60:63], v[136:139], v[120:123], v[60:63]
 s_waitcnt lgkmcnt(2)
 v_mfma_f32_16x16x32_bf16 v[44:47], v[140:143], v[76:79], v[44:47]
 s_waitcnt vmcnt(14)
 ds_read_b128 v[136:139], v22 offset:0
 v_mfma_f32_16x16x32_bf16 v[52:55], v[140:143], v[100:103], v[52:55]
 v_mfma_f32_16x16x32_bf16 v[60:63], v[140:143], v[124:127], v[60:63]
 s_waitcnt lgkmcnt(2)
 v_mfma_f32_16x16x32_bf16 v[44:47], v[144:147], v[80:83], v[44:47]
 ds_read_b128 v[140:143], v23 offset:0
 v_mfma_f32_16x16x32_bf16 v[52:55], v[144:147], v[104:107], v[52:55]
 v_mfma_f32_16x16x32_bf16 v[60:63], v[144:147], v[128:131], v[60:63]
 s_waitcnt lgkmcnt(2)
 v_mfma_f32_16x16x32_bf16 v[44:47], v[148:151], v[84:87], v[44:47]
 ds_read_b128 v[144:147], v22 offset:128
 s_add_u32 m0, s81, 24576
 s_add_u32 s21, s88, 1179648
 v_mfma_f32_16x16x32_bf16 v[52:55], v[148:151], v[108:111], v[52:55]
 buffer_load_dwordx4 v28, s[12:15], s21 offen offset:0 lds
 v_mfma_f32_16x16x32_bf16 v[60:63], v[148:151], v[132:135], v[60:63]
 buffer_load_dwordx4 v29, s[12:15], s21 offen offset:1024 lds
 s_waitcnt lgkmcnt(2)
 v_mfma_f32_16x16x32_bf16 v[40:43], v[136:139], v[64:67], 0
 ds_read_b128 v[148:151], v23 offset:128
 buffer_load_dwordx4 v30, s[12:15], s21 offen offset:2048 lds
 v_mfma_f32_16x16x32_bf16 v[48:51], v[136:139], v[88:91], 0
 s_add_u32 m0, s81, 27648
 s_add_u32 s21, s88, 3145728
 v_mfma_f32_16x16x32_bf16 v[56:59], v[136:139], v[112:115], 0
 buffer_load_dwordx4 v31, s[12:15], s21 offen offset:0 lds
 s_waitcnt lgkmcnt(2)
 v_mfma_f32_16x16x32_bf16 v[40:43], v[140:143], v[68:71], v[40:43]
 ds_read_b128 v[136:139], v22 offset:256
 v_cvt_pk_f16_f32 v186, v44, v45
 buffer_load_dwordx4 v32, s[12:15], s21 offen offset:1024 lds
 v_cvt_pk_f16_f32 v187, v46, v47
 v_mfma_f32_16x16x32_bf16 v[48:51], v[140:143], v[92:95], v[48:51]
 v_cvt_pk_f16_f32 v194, v52, v53
 buffer_load_dwordx4 v33, s[12:15], s21 offen offset:2048 lds
 v_cvt_pk_f16_f32 v195, v54, v55
 v_cvt_pk_f16_f32 v202, v60, v61
 v_mfma_f32_16x16x32_bf16 v[56:59], v[140:143], v[116:119], v[56:59]
 v_cvt_pk_f16_f32 v203, v62, v63
 s_add_u32 m0, s81, 30720
 s_add_u32 s21, s88, 1671168
 s_waitcnt lgkmcnt(2)
 v_mfma_f32_16x16x32_bf16 v[40:43], v[144:147], v[72:75], v[40:43]
 ds_read_b128 v[140:143], v23 offset:256
 buffer_load_dwordx4 v34, s[12:15], s21 offen offset:0 lds
 v_mfma_f32_16x16x32_bf16 v[48:51], v[144:147], v[96:99], v[48:51]
 buffer_load_dwordx4 v35, s[12:15], s21 offen offset:1024 lds
 v_mfma_f32_16x16x32_bf16 v[56:59], v[144:147], v[120:123], v[56:59]
 buffer_load_dwordx4 v36, s[12:15], s21 offen offset:2048 lds
 s_waitcnt lgkmcnt(2)
 v_mfma_f32_16x16x32_bf16 v[40:43], v[148:151], v[76:79], v[40:43]
 ds_read_b128 v[144:147], v22 offset:1536
 s_add_u32 m0, s81, 33792
 s_add_u32 s21, s88, 3637248
 v_mfma_f32_16x16x32_bf16 v[48:51], v[148:151], v[100:103], v[48:51]
 buffer_load_dwordx4 v37, s[12:15], s21 offen offset:0 lds
 v_mfma_f32_16x16x32_bf16 v[56:59], v[148:151], v[124:127], v[56:59]
 buffer_load_dwordx4 v38, s[12:15], s21 offen offset:1024 lds
 s_waitcnt lgkmcnt(2)
 v_mfma_f32_16x16x32_bf16 v[40:43], v[136:139], v[80:83], v[40:43]
 ds_read_b128 v[148:151], v23 offset:1536
 buffer_load_dwordx4 v39, s[12:15], s21 offen offset:2048 lds
 v_mfma_f32_16x16x32_bf16 v[48:51], v[136:139], v[104:107], v[48:51]
 v_mfma_f32_16x16x32_bf16 v[56:59], v[136:139], v[128:131], v[56:59]
 s_waitcnt lgkmcnt(2)
 v_mfma_f32_16x16x32_bf16 v[40:43], v[140:143], v[84:87], v[40:43]
 ds_read_b128 v[136:139], v22 offset:1664
 v_mfma_f32_16x16x32_bf16 v[48:51], v[140:143], v[108:111], v[48:51]
 v_mfma_f32_16x16x32_bf16 v[56:59], v[140:143], v[132:135], v[56:59]
 s_waitcnt lgkmcnt(2)
 v_mfma_f32_16x16x32_bf16 v[44:47], v[144:147], v[64:67], 0
 ds_read_b128 v[140:143], v23 offset:1664
 v_mfma_f32_16x16x32_bf16 v[52:55], v[144:147], v[88:91], 0
 v_mfma_f32_16x16x32_bf16 v[60:63], v[144:147], v[112:115], 0
 s_waitcnt lgkmcnt(2)
 v_mfma_f32_16x16x32_bf16 v[44:47], v[148:151], v[68:71], v[44:47]
 ds_read_b128 v[144:147], v22 offset:1792
 v_cvt_pk_f16_f32 v188, v40, v41
 v_cvt_pk_f16_f32 v189, v42, v43
 v_cvt_pk_f16_f32 v196, v48, v49
 v_cvt_pk_f16_f32 v197, v50, v51
 v_mfma_f32_16x16x32_bf16 v[52:55], v[148:151], v[92:95], v[52:55]
 v_cvt_pk_f16_f32 v204, v56, v57
 v_cvt_pk_f16_f32 v205, v58, v59
 v_mfma_f32_16x16x32_bf16 v[60:63], v[148:151], v[116:119], v[60:63]
 s_waitcnt lgkmcnt(2)
 v_mfma_f32_16x16x32_bf16 v[44:47], v[136:139], v[72:75], v[44:47]
 ds_read_b128 v[148:151], v23 offset:1792
 v_mfma_f32_16x16x32_bf16 v[52:55], v[136:139], v[96:99], v[52:55]
 v_mfma_f32_16x16x32_bf16 v[60:63], v[136:139], v[120:123], v[60:63]
 s_waitcnt lgkmcnt(2)
 v_mfma_f32_16x16x32_bf16 v[44:47], v[140:143], v[76:79], v[44:47]
 s_waitcnt vmcnt(12)
 ds_read_b128 v[136:139], v22 offset:12288
 v_mfma_f32_16x16x32_bf16 v[52:55], v[140:143], v[100:103], v[52:55]
 v_mfma_f32_16x16x32_bf16 v[60:63], v[140:143], v[124:127], v[60:63]
 s_waitcnt lgkmcnt(2)
 v_mfma_f32_16x16x32_bf16 v[44:47], v[144:147], v[80:83], v[44:47]
 ds_read_b128 v[140:143], v23 offset:12288
 v_mfma_f32_16x16x32_bf16 v[52:55], v[144:147], v[104:107], v[52:55]
 v_mfma_f32_16x16x32_bf16 v[60:63], v[144:147], v[128:131], v[60:63]
 s_waitcnt lgkmcnt(2)
 v_mfma_f32_16x16x32_bf16 v[44:47], v[148:151], v[84:87], v[44:47]
 ds_read_b128 v[144:147], v22 offset:12416
 s_add_u32 m0, s81, 0
 s_add_u32 s21, s88, 4128768
 v_mfma_f32_16x16x32_bf16 v[52:55], v[148:151], v[108:111], v[52:55]
 buffer_load_dwordx4 v28, s[12:15], s21 offen offset:0 lds
 v_mfma_f32_16x16x32_bf16 v[60:63], v[148:151], v[132:135], v[60:63]
 buffer_load_dwordx4 v29, s[12:15], s21 offen offset:1024 lds
 s_waitcnt lgkmcnt(2)
 v_mfma_f32_16x16x32_bf16 v[40:43], v[136:139], v[64:67], 0
 ds_read_b128 v[148:151], v23 offset:12416
 buffer_load_dwordx4 v30, s[12:15], s21 offen offset:2048 lds
 v_mfma_f32_16x16x32_bf16 v[48:51], v[136:139], v[88:91], 0
 s_add_u32 m0, s81, 3072
 s_add_u32 s21, s88, 6094848
 v_mfma_f32_16x16x32_bf16 v[56:59], v[136:139], v[112:115], 0
 buffer_load_dwordx4 v31, s[12:15], s21 offen offset:0 lds
 s_waitcnt lgkmcnt(2)
 v_mfma_f32_16x16x32_bf16 v[40:43], v[140:143], v[68:71], v[40:43]
 ds_read_b128 v[136:139], v22 offset:12544
 v_cvt_pk_f16_f32 v190, v44, v45
 buffer_load_dwordx4 v32, s[12:15], s21 offen offset:1024 lds
 v_cvt_pk_f16_f32 v191, v46, v47
 v_mfma_f32_16x16x32_bf16 v[48:51], v[140:143], v[92:95], v[48:51]
 v_cvt_pk_f16_f32 v198, v52, v53
 buffer_load_dwordx4 v33, s[12:15], s21 offen offset:2048 lds
 v_cvt_pk_f16_f32 v199, v54, v55
 v_cvt_pk_f16_f32 v206, v60, v61
 v_mfma_f32_16x16x32_bf16 v[56:59], v[140:143], v[116:119], v[56:59]
 v_cvt_pk_f16_f32 v207, v62, v63
 s_add_u32 m0, s81, 6144
 s_add_u32 s21, s88, 4620288
 s_waitcnt lgkmcnt(2)
 v_mfma_f32_16x16x32_bf16 v[40:43], v[144:147], v[72:75], v[40:43]
 ds_read_b128 v[140:143], v23 offset:12544
 buffer_load_dwordx4 v34, s[12:15], s21 offen offset:0 lds
 v_mfma_f32_16x16x32_bf16 v[48:51], v[144:147], v[96:99], v[48:51]
 buffer_load_dwordx4 v35, s[12:15], s21 offen offset:1024 lds
 v_mfma_f32_16x16x32_bf16 v[56:59], v[144:147], v[120:123], v[56:59]
 buffer_load_dwordx4 v36, s[12:15], s21 offen offset:2048 lds
 s_waitcnt lgkmcnt(2)
 v_mfma_f32_16x16x32_bf16 v[40:43], v[148:151], v[76:79], v[40:43]
 ds_read_b128 v[144:147], v22 offset:13824
 s_add_u32 m0, s81, 9216
 s_add_u32 s21, s88, 6586368
 v_mfma_f32_16x16x32_bf16 v[48:51], v[148:151], v[100:103], v[48:51]
 buffer_load_dwordx4 v37, s[12:15], s21 offen offset:0 lds
 v_mfma_f32_16x16x32_bf16 v[56:59], v[148:151], v[124:127], v[56:59]
 buffer_load_dwordx4 v38, s[12:15], s21 offen offset:1024 lds
 s_waitcnt lgkmcnt(2)
 v_mfma_f32_16x16x32_bf16 v[40:43], v[136:139], v[80:83], v[40:43]
 ds_read_b128 v[148:151], v23 offset:13824
 buffer_load_dwordx4 v39, s[12:15], s21 offen offset:2048 lds
 v_mfma_f32_16x16x32_bf16 v[48:51], v[136:139], v[104:107], v[48:51]
 v_mfma_f32_16x16x32_bf16 v[56:59], v[136:139], v[128:131], v[56:59]
 s_waitcnt lgkmcnt(2)
 v_mfma_f32_16x16x32_bf16 v[40:43], v[140:143], v[84:87], v[40:43]
 ds_read_b128 v[136:139], v22 offset:13952
 v_mfma_f32_16x16x32_bf16 v[48:51], v[140:143], v[108:111], v[48:51]
 v_mfma_f32_16x16x32_bf16 v[56:59], v[140:143], v[132:135], v[56:59]
 s_waitcnt lgkmcnt(2)
 v_mfma_f32_16x16x32_bf16 v[44:47], v[144:147], v[64:67], 0
 ds_read_b128 v[140:143], v23 offset:13952
 v_mfma_f32_16x16x32_bf16 v[52:55], v[144:147], v[88:91], 0
 v_mfma_f32_16x16x32_bf16 v[60:63], v[144:147], v[112:115], 0
 s_waitcnt lgkmcnt(2)
 v_mfma_f32_16x16x32_bf16 v[44:47], v[148:151], v[68:71], v[44:47]
 ds_read_b128 v[144:147], v22 offset:14080
 v_cvt_pk_f16_f32 v208, v40, v41
 v_cvt_pk_f16_f32 v209, v42, v43
 v_cvt_pk_f16_f32 v216, v48, v49
 v_cvt_pk_f16_f32 v217, v50, v51
 v_mfma_f32_16x16x32_bf16 v[52:55], v[148:151], v[92:95], v[52:55]
 v_cvt_pk_f16_f32 v224, v56, v57
 v_cvt_pk_f16_f32 v225, v58, v59
 v_mfma_f32_16x16x32_bf16 v[60:63], v[148:151], v[116:119], v[60:63]
 s_waitcnt lgkmcnt(2)
 v_mfma_f32_16x16x32_bf16 v[44:47], v[136:139], v[72:75], v[44:47]
 ds_read_b128 v[148:151], v23 offset:14080
 v_mfma_f32_16x16x32_bf16 v[52:55], v[136:139], v[96:99], v[52:55]
 v_mfma_f32_16x16x32_bf16 v[60:63], v[136:139], v[120:123], v[60:63]
 s_waitcnt lgkmcnt(2)
 v_mfma_f32_16x16x32_bf16 v[44:47], v[140:143], v[76:79], v[44:47]
 s_waitcnt vmcnt(12)
 ds_read_b128 v[136:139], v22 offset:24576
 v_mfma_f32_16x16x32_bf16 v[52:55], v[140:143], v[100:103], v[52:55]
 v_mfma_f32_16x16x32_bf16 v[60:63], v[140:143], v[124:127], v[60:63]
 s_waitcnt lgkmcnt(2)
 v_mfma_f32_16x16x32_bf16 v[44:47], v[144:147], v[80:83], v[44:47]
 ds_read_b128 v[140:143], v23 offset:24576
 v_mfma_f32_16x16x32_bf16 v[52:55], v[144:147], v[104:107], v[52:55]
 v_mfma_f32_16x16x32_bf16 v[60:63], v[144:147], v[128:131], v[60:63]
 s_waitcnt lgkmcnt(2)
 v_mfma_f32_16x16x32_bf16 v[44:47], v[148:151], v[84:87], v[44:47]
 ds_read_b128 v[144:147], v22 offset:24704
 s_add_u32 m0, s81, 12288
 s_add_u32 s21, s88, 5111808
 v_mfma_f32_16x16x32_bf16 v[52:55], v[148:151], v[108:111], v[52:55]
 buffer_load_dwordx4 v28, s[12:15], s21 offen offset:0 lds
 v_mfma_f32_16x16x32_bf16 v[60:63], v[148:151], v[132:135], v[60:63]
 buffer_load_dwordx4 v29, s[12:15], s21 offen offset:1024 lds
 s_waitcnt lgkmcnt(2)
 v_mfma_f32_16x16x32_bf16 v[40:43], v[136:139], v[64:67], 0
 ds_read_b128 v[148:151], v23 offset:24704
 buffer_load_dwordx4 v30, s[12:15], s21 offen offset:2048 lds
 v_mfma_f32_16x16x32_bf16 v[48:51], v[136:139], v[88:91], 0
 s_add_u32 m0, s81, 15360
 s_add_u32 s21, s88, 7077888
 v_mfma_f32_16x16x32_bf16 v[56:59], v[136:139], v[112:115], 0
 buffer_load_dwordx4 v31, s[12:15], s21 offen offset:0 lds
 s_waitcnt lgkmcnt(2)
 v_mfma_f32_16x16x32_bf16 v[40:43], v[140:143], v[68:71], v[40:43]
 ds_read_b128 v[136:139], v22 offset:24832
 v_cvt_pk_f16_f32 v210, v44, v45
 buffer_load_dwordx4 v32, s[12:15], s21 offen offset:1024 lds
 v_cvt_pk_f16_f32 v211, v46, v47
 v_mfma_f32_16x16x32_bf16 v[48:51], v[140:143], v[92:95], v[48:51]
 v_cvt_pk_f16_f32 v218, v52, v53
 buffer_load_dwordx4 v33, s[12:15], s21 offen offset:2048 lds
 v_cvt_pk_f16_f32 v219, v54, v55
 v_cvt_pk_f16_f32 v226, v60, v61
 v_mfma_f32_16x16x32_bf16 v[56:59], v[140:143], v[116:119], v[56:59]
 v_cvt_pk_f16_f32 v227, v62, v63
 s_add_u32 m0, s81, 18432
 s_add_u32 s21, s88, 5603328
 s_waitcnt lgkmcnt(2)
 v_mfma_f32_16x16x32_bf16 v[40:43], v[144:147], v[72:75], v[40:43]
 ds_read_b128 v[140:143], v23 offset:24832
 buffer_load_dwordx4 v34, s[12:15], s21 offen offset:0 lds
 v_mfma_f32_16x16x32_bf16 v[48:51], v[144:147], v[96:99], v[48:51]
 buffer_load_dwordx4 v35, s[12:15], s21 offen offset:1024 lds
 v_mfma_f32_16x16x32_bf16 v[56:59], v[144:147], v[120:123], v[56:59]
 buffer_load_dwordx4 v36, s[12:15], s21 offen offset:2048 lds
 s_waitcnt lgkmcnt(2)
 v_mfma_f32_16x16x32_bf16 v[40:43], v[148:151], v[76:79], v[40:43]
 ds_read_b128 v[144:147], v22 offset:26112
 s_add_u32 m0, s81, 21504
 s_add_u32 s21, s88, 7569408
 v_mfma_f32_16x16x32_bf16 v[48:51], v[148:151], v[100:103], v[48:51]
 buffer_load_dwordx4 v37, s[12:15], s21 offen offset:0 lds
 v_mfma_f32_16x16x32_bf16 v[56:59], v[148:151], v[124:127], v[56:59]
 buffer_load_dwordx4 v38, s[12:15], s21 offen offset:1024 lds
 s_waitcnt lgkmcnt(2)
 v_mfma_f32_16x16x32_bf16 v[40:43], v[136:139], v[80:83], v[40:43]
 ds_read_b128 v[148:151], v23 offset:26112
 buffer_load_dwordx4 v39, s[12:15], s21 offen offset:2048 lds
 v_mfma_f32_16x16x32_bf16 v[48:51], v[136:139], v[104:107], v[48:51]
 v_mfma_f32_16x16x32_bf16 v[56:59], v[136:139], v[128:131], v[56:59]
 s_waitcnt lgkmcnt(2)
 v_mfma_f32_16x16x32_bf16 v[40:43], v[140:143], v[84:87], v[40:43]
 ds_read_b128 v[136:139], v22 offset:26240
 v_mfma_f32_16x16x32_bf16 v[48:51], v[140:143], v[108:111], v[48:51]
 v_mfma_f32_16x16x32_bf16 v[56:59], v[140:143], v[132:135], v[56:59]
 s_waitcnt lgkmcnt(2)
 v_mfma_f32_16x16x32_bf16 v[44:47], v[144:147], v[64:67], 0
 ds_read_b128 v[140:143], v23 offset:26240
 v_mfma_f32_16x16x32_bf16 v[52:55], v[144:147], v[88:91], 0
 v_mfma_f32_16x16x32_bf16 v[60:63], v[144:147], v[112:115], 0
 s_waitcnt lgkmcnt(2)
 v_mfma_f32_16x16x32_bf16 v[44:47], v[148:151], v[68:71], v[44:47]
 ds_read_b128 v[144:147], v22 offset:26368
 v_cvt_pk_f16_f32 v212, v40, v41
 v_cvt_pk_f16_f32 v213, v42, v43
 v_cvt_pk_f16_f32 v220, v48, v49
 v_cvt_pk_f16_f32 v221, v50, v51
 v_mfma_f32_16x16x32_bf16 v[52:55], v[148:151], v[92:95], v[52:55]
 v_cvt_pk_f16_f32 v228, v56, v57
 v_cvt_pk_f16_f32 v229, v58, v59
 v_mfma_f32_16x16x32_bf16 v[60:63], v[148:151], v[116:119], v[60:63]
 s_waitcnt lgkmcnt(2)
 v_mfma_f32_16x16x32_bf16 v[44:47], v[136:139], v[72:75], v[44:47]
 ds_read_b128 v[148:151], v23 offset:26368
 v_mfma_f32_16x16x32_bf16 v[52:55], v[136:139], v[96:99], v[52:55]
 v_mfma_f32_16x16x32_bf16 v[60:63], v[136:139], v[120:123], v[60:63]
 s_waitcnt lgkmcnt(2)
 v_mfma_f32_16x16x32_bf16 v[44:47], v[140:143], v[76:79], v[44:47]
 s_waitcnt vmcnt(12)
 ds_read_b128 v[136:139], v22 offset:0
 v_mfma_f32_16x16x32_bf16 v[52:55], v[140:143], v[100:103], v[52:55]
 v_mfma_f32_16x16x32_bf16 v[60:63], v[140:143], v[124:127], v[60:63]
 s_waitcnt lgkmcnt(2)
 v_mfma_f32_16x16x32_bf16 v[44:47], v[144:147], v[80:83], v[44:47]
 ds_read_b128 v[140:143], v23 offset:0
 v_mfma_f32_16x16x32_bf16 v[52:55], v[144:147], v[104:107], v[52:55]
 v_mfma_f32_16x16x32_bf16 v[60:63], v[144:147], v[128:131], v[60:63]
 s_waitcnt lgkmcnt(2)
 v_mfma_f32_16x16x32_bf16 v[44:47], v[148:151], v[84:87], v[44:47]
 ds_read_b128 v[144:147], v22 offset:128
 v_mfma_f32_16x16x32_bf16 v[52:55], v[148:151], v[108:111], v[52:55]
 v_mfma_f32_16x16x32_bf16 v[60:63], v[148:151], v[132:135], v[60:63]
 s_mov_b32 s101, 0
 s_branch fm_8
fm_7:
 s_sleep 8
 buffer_load_dword v0, v26, s[32:35], 0 offen sc1
 s_add_u32 s101, s101, 1
 s_cmp_gt_u32 s101, 131072
 s_cbranch_scc1 end0
 s_waitcnt vmcnt(0)
fm_8:
 v_readlane_b32 s22, v0, 0
 v_readlane_b32 s23, v0, 32
 s_add_u32 s22, s22, s23
 v_readlane_b32 s23, v0, 1
 s_add_u32 s22, s22, s23
 v_readlane_b32 s23, v0, 33
 s_add_u32 s22, s22, s23
 v_readlane_b32 s23, v0, 2
 s_add_u32 s22, s22, s23
 v_readlane_b32 s23, v0, 34
 s_add_u32 s22, s22, s23
 v_readlane_b32 s23, v0, 3
 s_add_u32 s22, s22, s23
 v_readlane_b32 s23, v0, 35
 s_add_u32 s22, s22, s23
 v_readlane_b32 s21, v0, 19
 s_cmp_ge_u32 s22, 256
 s_cselect_b32 s21, s21, 0
 s_cmp_lt_u32 s21, 32
 s_cbranch_scc1 fm_7
 v_readlane_b32 s21, v0, s82
 s_cmp_ge_u32 s21, s83
 s_cselect_b32 s21, 1, 0
 s_andn2_b32 s53, s21, s53
 s_mov_b32 s101, 0
c0_9:
 v_cmp_eq_u32 vcc, 0, v252
 s_nop 1
 s_cbranch_vccz c0_10
 s_sleep 8
 v_and_b32 v253, 31, v1
 buffer_load_ubyte v252, v253, s[32:35], 0 offen offset:160 sc1
 s_add_u32 s101, s101, 1
 s_cmp_gt_u32 s101, 131072
 s_cbranch_scc1 end0
 s_waitcnt vmcnt(0)
 s_branch c0_9
c0_10:
 v_cmp_eq_u32 vcc, 2, v252
 s_nop 1
 s_mov_b32 s37, vcc_lo
 s_bitcmp0_b32 s37, 0
 s_cselect_b32 s23, 8192, 0
 v_add_u32 v13, s23, v13
 v_add_u32 v4, s23, v4
 s_add_u32 s12, s44, 81068032
 s_addc_u32 s13, s45, 0
 s_mov_b32 s14, 129024
 s_mov_b32 s15, 0x00020000
 v_and_b32 v27, 7, v2
 v_mul_u32_u24 v27, 1280, v27
 v_lshrrev_b32 v39, 3, v1
 v_mul_u32_u24 v39, 40, v39
 s_mul_i32 s21, s20, 320
 v_add3_u32 v27, v27, v39, s21
 buffer_load_dwordx4 v[28:31], v27, s[28:31], 0 offen offset:0
 buffer_load_dwordx4 v[32:35], v27, s[28:31], 0 offen offset:16
 buffer_load_dwordx2 v[36:37], v27, s[28:31], 0 offen offset:32
 s_and_b32 s21, s51, 3
 s_mul_i32 s21, s21, 540672
 buffer_load_dword v38, v9, s[8:11], s21 offen sc1
 buffer_load_dword v38, v8, s[8:11], s21 offen offset:0 sc1
 buffer_load_dword v38, v8, s[8:11], s21 offen offset:1024 sc1
 s_waitcnt lgkmcnt(2)
 v_mfma_f32_16x16x32_bf16 v[40:43], v[136:139], v[64:67], 0
 ds_read_b128 v[148:151], v23 offset:128
 v_mfma_f32_16x16x32_bf16 v[48:51], v[136:139], v[88:91], 0
 v_mfma_f32_16x16x32_bf16 v[56:59], v[136:139], v[112:115], 0
 s_waitcnt lgkmcnt(2)
 v_mfma_f32_16x16x32_bf16 v[40:43], v[140:143], v[68:71], v[40:43]
 ds_read_b128 v[136:139], v22 offset:256
 v_cvt_pk_f16_f32 v214, v44, v45
 v_cvt_pk_f16_f32 v215, v46, v47
 v_cvt_pk_f16_f32 v222, v52, v53
 v_cvt_pk_f16_f32 v223, v54, v55
 v_mfma_f32_16x16x32_bf16 v[48:51], v[140:143], v[92:95], v[48:51]
 v_cvt_pk_f16_f32 v230, v60, v61
 v_cvt_pk_f16_f32 v231, v62, v63
 v_mfma_f32_16x16x32_bf16 v[56:59], v[140:143], v[116:119], v[56:59]
 s_waitcnt lgkmcnt(2)
 v_mfma_f32_16x16x32_bf16 v[40:43], v[144:147], v[72:75], v[40:43]
 ds_read_b128 v[140:143], v23 offset:256
 v_mfma_f32_16x16x32_bf16 v[48:51], v[144:147], v[96:99], v[48:51]
 v_mfma_f32_16x16x32_bf16 v[56:59], v[144:147], v[120:123], v[56:59]
 s_waitcnt lgkmcnt(2)
 v_mfma_f32_16x16x32_bf16 v[40:43], v[148:151], v[76:79], v[40:43]
 ds_read_b128 v[144:147], v22 offset:1536
 v_mfma_f32_16x16x32_bf16 v[48:51], v[148:151], v[100:103], v[48:51]
 v_mfma_f32_16x16x32_bf16 v[56:59], v[148:151], v[124:127], v[56:59]
 s_waitcnt lgkmcnt(2)
 v_mfma_f32_16x16x32_bf16 v[40:43], v[136:139], v[80:83], v[40:43]
 ds_read_b128 v[148:151], v23 offset:1536
 v_mfma_f32_16x16x32_bf16 v[48:51], v[136:139], v[104:107], v[48:51]
 v_mfma_f32_16x16x32_bf16 v[56:59], v[136:139], v[128:131], v[56:59]
 s_waitcnt lgkmcnt(2)
 v_mfma_f32_16x16x32_bf16 v[40:43], v[140:143], v[84:87], v[40:43]
 ds_read_b128 v[136:139], v22 offset:1664
 v_mfma_f32_16x16x32_bf16 v[48:51], v[140:143], v[108:111], v[48:51]
 v_mfma_f32_16x16x32_bf16 v[56:59], v[140:143], v[132:135], v[56:59]
 s_waitcnt lgkmcnt(2)
 v_mfma_f32_16x16x32_bf16 v[44:47], v[144:147], v[64:67], 0
 ds_read_b128 v[140:143], v23 offset:1664
 v_mfma_f32_16x16x32_bf16 v[52:55], v[144:147], v[88:91], 0
 v_mfma_f32_16x16x32_bf16 v[60:63], v[144:147], v[112:115], 0
 s_waitcnt lgkmcnt(2)
 v_mfma_f32_16x16x32_bf16 v[44:47], v[148:151], v[68:71], v[44:47]
 ds_read_b128 v[144:147], v22 offset:1792
 v_cvt_pk_f16_f32 v232, v40, v41
 v_cvt_pk_f16_f32 v233, v42, v43
 v_cvt_pk_f16_f32 v240, v48, v49
 v_cvt_pk_f16_f32 v241, v50, v51
 v_mfma_f32_16x16x32_bf16 v[52:55], v[148:151], v[92:95], v[52:55]
 v_cvt_pk_f16_f32 v248, v56, v57
 v_cvt_pk_f16_f32 v249, v58, v59
 v_mfma_f32_16x16x32_bf16 v[60:63], v[148:151], v[116:119], v[60:63]
 s_waitcnt lgkmcnt(2)
 v_mfma_f32_16x16x32_bf16 v[44:47], v[136:139], v[72:75], v[44:47]
 ds_read_b128 v[148:151], v23 offset:1792
 v_mfma_f32_16x16x32_bf16 v[52:55], v[136:139], v[96:99], v[52:55]
 v_mfma_f32_16x16x32_bf16 v[60:63], v[136:139], v[120:123], v[60:63]
 s_waitcnt lgkmcnt(2)
 v_mfma_f32_16x16x32_bf16 v[44:47], v[140:143], v[76:79], v[44:47]
 s_waitcnt vmcnt(6)
 ds_read_b128 v[136:139], v22 offset:12288
 v_mfma_f32_16x16x32_bf16 v[52:55], v[140:143], v[100:103], v[52:55]
 v_mfma_f32_16x16x32_bf16 v[60:63], v[140:143], v[124:127], v[60:63]
 s_waitcnt lgkmcnt(2)
 v_mfma_f32_16x16x32_bf16 v[44:47], v[144:147], v[80:83], v[44:47]
 ds_read_b128 v[140:143], v23 offset:12288
 v_mfma_f32_16x16x32_bf16 v[52:55], v[144:147], v[104:107], v[52:55]
 v_mfma_f32_16x16x32_bf16 v[60:63], v[144:147], v[128:131], v[60:63]
 s_waitcnt lgkmcnt(2)
 v_mfma_f32_16x16x32_bf16 v[44:47], v[148:151], v[84:87], v[44:47]
 ds_read_b128 v[144:147], v22 offset:12416
 v_mfma_f32_16x16x32_bf16 v[52:55], v[148:151], v[108:111], v[52:55]
 v_mfma_f32_16x16x32_bf16 v[60:63], v[148:151], v[132:135], v[60:63]
 buffer_load_dword v0, off, s[12:15], s79 sc1
 s_waitcnt lgkmcnt(2)
 v_mfma_f32_16x16x32_bf16 v[40:43], v[136:139], v[64:67], 0
 ds_read_b128 v[148:151], v23 offset:12416
 v_mfma_f32_16x16x32_bf16 v[48:51], v[136:139], v[88:91], 0
 v_mfma_f32_16x16x32_bf16 v[56:59], v[136:139], v[112:115], 0
 s_waitcnt lgkmcnt(2)
 v_mfma_f32_16x16x32_bf16 v[40:43], v[140:143], v[68:71], v[40:43]
 ds_read_b128 v[136:139], v22 offset:12544
 v_cvt_pk_f16_f32 v234, v44, v45
 v_cvt_pk_f16_f32 v235, v46, v47
 v_cvt_pk_f16_f32 v242, v52, v53
 v_cvt_pk_f16_f32 v243, v54, v55
 v_mfma_f32_16x16x32_bf16 v[48:51], v[140:143], v[92:95], v[48:51]
 v_cvt_pk_f16_f32 v250, v60, v61
 v_cvt_pk_f16_f32 v251, v62, v63
 v_mfma_f32_16x16x32_bf16 v[56:59], v[140:143], v[116:119], v[56:59]
 s_waitcnt lgkmcnt(2)
 v_mfma_f32_16x16x32_bf16 v[40:43], v[144:147], v[72:75], v[40:43]
 ds_read_b128 v[140:143], v23 offset:12544
 v_mfma_f32_16x16x32_bf16 v[48:51], v[144:147], v[96:99], v[48:51]
 v_mfma_f32_16x16x32_bf16 v[56:59], v[144:147], v[120:123], v[56:59]
 s_waitcnt lgkmcnt(2)
 v_mfma_f32_16x16x32_bf16 v[40:43], v[148:151], v[76:79], v[40:43]
 ds_read_b128 v[144:147], v22 offset:13824
 v_mfma_f32_16x16x32_bf16 v[48:51], v[148:151], v[100:103], v[48:51]
 v_mfma_f32_16x16x32_bf16 v[56:59], v[148:151], v[124:127], v[56:59]
 s_waitcnt lgkmcnt(2)
 v_mfma_f32_16x16x32_bf16 v[40:43], v[136:139], v[80:83], v[40:43]
 ds_read_b128 v[148:151], v23 offset:13824
 v_mfma_f32_16x16x32_bf16 v[48:51], v[136:139], v[104:107], v[48:51]
 v_mfma_f32_16x16x32_bf16 v[56:59], v[136:139], v[128:131], v[56:59]
 s_waitcnt lgkmcnt(2)
 v_mfma_f32_16x16x32_bf16 v[40:43], v[140:143], v[84:87], v[40:43]
 ds_read_b128 v[136:139], v22 offset:13952
 v_mfma_f32_16x16x32_bf16 v[48:51], v[140:143], v[108:111], v[48:51]
 v_mfma_f32_16x16x32_bf16 v[56:59], v[140:143], v[132:135], v[56:59]
 s_waitcnt lgkmcnt(2)
 v_mfma_f32_16x16x32_bf16 v[44:47], v[144:147], v[64:67], 0
 ds_read_b128 v[140:143], v23 offset:13952
 v_mfma_f32_16x16x32_bf16 v[52:55], v[144:147], v[88:91], 0
 v_mfma_f32_16x16x32_bf16 v[60:63], v[144:147], v[112:115], 0
 s_waitcnt lgkmcnt(2)
 v_mfma_f32_16x16x32_bf16 v[44:47], v[148:151], v[68:71], v[44:47]
 ds_read_b128 v[144:147], v22 offset:14080
 v_cvt_pk_f16_f32 v236, v40, v41
 v_cvt_pk_f16_f32 v237, v42, v43
 v_cvt_pk_f16_f32 v244, v48, v49
 v_cvt_pk_f16_f32 v245, v50, v51
 v_mfma_f32_16x16x32_bf16 v[52:55], v[148:151], v[92:95], v[52:55]
 v_cvt_pk_f16_f32 v252, v56, v57
 v_cvt_pk_f16_f32 v253, v58, v59
 v_mfma_f32_16x16x32_bf16 v[60:63], v[148:151], v[116:119], v[60:63]
 s_waitcnt lgkmcnt(2)
 v_mfma_f32_16x16x32_bf16 v[44:47], v[136:139], v[72:75], v[44:47]
 ds_read_b128 v[148:151], v23 offset:14080
 v_mfma_f32_16x16x32_bf16 v[52:55], v[136:139], v[96:99], v[52:55]
 v_mfma_f32_16x16x32_bf16 v[60:63], v[136:139], v[120:123], v[60:63]
 s_waitcnt lgkmcnt(2)
 v_mfma_f32_16x16x32_bf16 v[44:47], v[140:143], v[76:79], v[44:47]
 v_mfma_f32_16x16x32_bf16 v[52:55], v[140:143], v[100:103], v[52:55]
 v_mfma_f32_16x16x32_bf16 v[60:63], v[140:143], v[124:127], v[60:63]
 s_waitcnt lgkmcnt(1)
 v_mfma_f32_16x16x32_bf16 v[44:47], v[144:147], v[80:83], v[44:47]
 v_mfma_f32_16x16x32_bf16 v[52:55], v[144:147], v[104:107], v[52:55]
 v_mfma_f32_16x16x32_bf16 v[60:63], v[144:147], v[128:131], v[60:63]
 s_waitcnt lgkmcnt(0)
 v_mfma_f32_16x16x32_bf16 v[44:47], v[148:151], v[84:87], v[44:47]
 v_mfma_f32_16x16x32_bf16 v[52:55], v[148:151], v[108:111], v[52:55]
 v_mfma_f32_16x16x32_bf16 v[60:63], v[148:151], v[132:135], v[60:63]
 s_nop 7
 v_cvt_pk_f16_f32 v238, v44, v45
 v_cvt_pk_f16_f32 v239, v46, v47
 v_cvt_pk_f16_f32 v246, v52, v53
 v_cvt_pk_f16_f32 v247, v54, v55
 v_cvt_pk_f16_f32 v254, v60, v61
 v_cvt_pk_f16_f32 v255, v62, v63
 s_add_u32 s28, s44, 88080384
 s_addc_u32 s29, s45, 0
 s_mov_b32 s30, 83886080
 s_mov_b32 s31, 0x00020000
 s_waitcnt vmcnt(0)
 v_readfirstlane_b32 s21, v0
 s_cmp_lg_u32 s21, 0
 s_cbranch_scc1 pf_12
 v_mov_b32 v62, 0
 s_mov_b32 s101, 0
wf_13:
 buffer_load_dword v63, v62, s[12:15], s79 offen sc1
 s_add_u32 s101, s101, 1
 s_cmp_gt_u32 s101, 131072
 s_cbranch_scc1 end0
 s_waitcnt vmcnt(0)
 v_readfirstlane_b32 s100, v63
 s_cmp_ge_u32 s100, 1
 s_cbranch_scc1 wf_14
 s_sleep 4
 s_branch wf_13
wf_14:
 v_mov_b32 v0, s100
pf_12:
 s_mov_b32 s87, 0
 s_sub_u32 s21, s64, 1310720
 s_cmp_ge_u32 s20, 2
 s_cbranch_scc1 pf_11
 buffer_load_dwordx4 v[112:115], v18, s[16:19], 0 offen sc1
 buffer_load_dwordx2 v[116:117], v19, s[16:19], 0 offen sc1
pf_11:
 buffer_load_dwordx4 v[126:129], v16, s[28:31], s21 offen offset:0 sc1
 buffer_load_dwordx4 v[130:133], v16, s[28:31], s21 offen offset:1024 sc1
 buffer_load_dwordx4 v[134:137], v16, s[28:31], s21 offen offset:2048 sc1
 v_lshlrev_b32 v27, 16, v28
 v_and_b32 v28, 0xffff0000, v28
 v_cvt_pk_f16_f32 v28, v27, v28
 v_lshlrev_b32 v27, 16, v29
 v_and_b32 v29, 0xffff0000, v29
 v_cvt_pk_f16_f32 v29, v27, v29
 v_lshlrev_b32 v27, 16, v30
 v_and_b32 v30, 0xffff0000, v30
 v_cvt_pk_f16_f32 v30, v27, v30
 v_lshlrev_b32 v27, 16, v31
 v_and_b32 v31, 0xffff0000, v31
 v_cvt_pk_f16_f32 v31, v27, v31
 v_lshlrev_b32 v27, 16, v32
 v_and_b32 v32, 0xffff0000, v32
 v_cvt_pk_f16_f32 v32, v27, v32
 v_lshlrev_b32 v27, 16, v33
 v_and_b32 v33, 0xffff0000, v33
 v_cvt_pk_f16_f32 v33, v27, v33
 v_lshlrev_b32 v27, 16, v34
 v_and_b32 v34, 0xffff0000, v34
 v_cvt_pk_f16_f32 v34, v27, v34
 v_lshlrev_b32 v27, 16, v35
 v_and_b32 v35, 0xffff0000, v35
 v_cvt_pk_f16_f32 v35, v27, v35
 v_lshlrev_b32 v27, 16, v36
 v_and_b32 v36, 0xffff0000, v36
 v_cvt_pk_f16_f32 v36, v27, v36
 v_lshlrev_b32 v27, 16, v37
 v_and_b32 v37, 0xffff0000, v37
 v_cvt_pk_f16_f32 v37, v27, v37
 s_lshl_b32 s21, s20, 2
 s_add_u32 s21, s21, 20480
 v_add_u32 v22, s21, v16
 v_bfe_u32 v23, v1, 2, 3
 v_lshlrev_b32 v23, 4, v23
 v_add_u32 v23, 20480, v23
 v_cmp_gt_u32 vcc, 2, v3
 s_mov_b32 s52, 0
 s_mov_b32 s89, 0x05040100
 v_cndmask_b32 v26, 0, 1.0, vcc
 v_mov_b32 v124, 0
 v_mov_b32 v125, 0
 v_mov_b32 v144, 0
 v_mov_b32 v145, 0
 v_mov_b32 v40, 0
 v_mov_b32 v41, 0
 v_mov_b32 v42, 0
 v_mov_b32 v43, 0
 v_mov_b32 v44, 0
 v_mov_b32 v45, 0
 v_mov_b32 v46, 0
 v_mov_b32 v47, 0
 v_mov_b32 v48, 0
 v_mov_b32 v49, 0
 v_mov_b32 v50, 0
 v_mov_b32 v51, 0
 v_mov_b32 v52, 0
 v_mov_b32 v53, 0
 v_mov_b32 v54, 0
 v_mov_b32 v55, 0
 v_mov_b32 v56, 0
 v_mov_b32 v57, 0
 v_mov_b32 v58, 0
 v_mov_b32 v59, 0
 v_mov_b32 v60, 0
 v_mov_b32 v61, 0
 v_mov_b32 v62, 0
 v_mov_b32 v63, 0
 v_mov_b32 v100, 0
 v_mov_b32 v101, 0
 v_mov_b32 v102, 0
 v_mov_b32 v103, 0
 v_mov_b32 v104, 0
 v_mov_b32 v105, 0
 v_mov_b32 v106, 0
 v_mov_b32 v107, 0
 v_mov_b32 v108, 0
 v_mov_b32 v109, 0
 v_mov_b32 v110, 0
 v_mov_b32 v111, 0
 s_barrier
 s_mov_b32 s57, 0x80000000
 s_and_b32 s21, s52, 3
 s_mul_i32 s81, s21, 540672
 s_mul_i32 s84, s21, 0x88000
 s_and_b32 s84, s84, 0x108000
 s_add_u32 s21, s52, 3
 s_and_b32 s21, s21, 3
 s_mul_i32 s83, s21, 0x88000
 s_and_b32 s83, s83, 0x108000
 s_add_u32 s21, s52, 1
 s_and_b32 s22, s21, 3
 s_mul_i32 s3, s22, 0x88000
 s_and_b32 s3, s3, 0x108000
 s_mul_i32 s80, s21, 393216
 s_add_u32 s46, s21, 1
 s_min_u32 s46, s46, 64
 s_mov_b32 s47, s57
 s_mov_b32 s78, s85
 s_lshr_b32 s21, s52, 1
 s_bitcmp1_b32 s37, s21
 s_cselect_b32 s21, 8192, 0
 s_lshl_b32 s22, s52, 20
 s_or_b32 s22, s22, s21
 s_cmp_ge_u32 s52, 40
 s_cselect_b32 s57, 8192, 0
 s_xor_b32 s57, s57, s22
 s_xor_b32 s85, s22, 8192
 s_bfe_u32 s88, s52, 0x10002
 s_max_u32 s67, s52, 1
 s_sub_u32 s67, s67, 1
 s_cmp_eq_u32 s53, 0
 s_cbranch_scc1 A1_19
 s_cmp_eq_u32 s20, 0
 s_cbranch_scc1 A1_15
 s_cmp_eq_u32 s20, 1
 s_cbranch_scc1 A1_16
 s_cmp_eq_u32 s20, 2
 s_cbranch_scc1 A1_17
 s_cmp_eq_u32 s20, 3
 s_cbranch_scc1 A1_18
 s_branch A1_19
step_20:
 s_and_b32 s21, s52, 3
 s_mul_i32 s81, s21, 540672
 s_mul_i32 s84, s21, 0x88000
 s_and_b32 s84, s84, 0x108000
 s_add_u32 s21, s52, 3
 s_and_b32 s21, s21, 3
 s_mul_i32 s83, s21, 0x88000
 s_and_b32 s83, s83, 0x108000
 s_add_u32 s21, s52, 1
 s_and_b32 s22, s21, 3
 s_mul_i32 s3, s22, 0x88000
 s_and_b32 s3, s3, 0x108000
 s_mul_i32 s80, s21, 393216
 s_add_u32 s46, s21, 1
 s_min_u32 s46, s46, 64
 s_mov_b32 s47, s57
 s_mov_b32 s78, s85
 s_lshr_b32 s21, s52, 1
 s_bitcmp1_b32 s37, s21
 s_cselect_b32 s21, 8192, 0
 s_lshl_b32 s22, s52, 20
 s_or_b32 s22, s22, s21
 s_cmp_ge_u32 s52, 40
 s_cselect_b32 s57, 8192, 0
 s_xor_b32 s57, s57, s22
 s_xor_b32 s85, s22, 8192
 s_bfe_u32 s88, s52, 0x10002
 s_max_u32 s67, s52, 1
 s_sub_u32 s67, s67, 1
 v_mov_b32 v40, 0
 v_mov_b32 v41, 0
 v_mov_b32 v42, 0
 v_mov_b32 v43, 0
 v_mov_b32 v44, 0
 v_mov_b32 v45, 0
 v_mov_b32 v46, 0
 v_mov_b32 v47, 0
 v_mov_b32 v48, 0
 v_mov_b32 v49, 0
 v_mov_b32 v50, 0
 v_mov_b32 v51, 0
 v_mov_b32 v52, 0
 v_mov_b32 v53, 0
 v_mov_b32 v54, 0
 v_mov_b32 v55, 0
 v_mov_b32 v56, 0
 v_mov_b32 v57, 0
 v_mov_b32 v58, 0
 v_mov_b32 v59, 0
 v_mov_b32 v60, 0
 v_mov_b32 v61, 0
 v_mov_b32 v62, 0
 v_mov_b32 v63, 0
 v_mov_b32 v100, 0
 v_mov_b32 v101, 0
 v_mov_b32 v102, 0
 v_mov_b32 v103, 0
 v_mov_b32 v104, 0
 v_mov_b32 v105, 0
 v_mov_b32 v106, 0
 v_mov_b32 v107, 0
 v_mov_b32 v108, 0
 v_mov_b32 v109, 0
 v_mov_b32 v110, 0
 v_mov_b32 v111, 0
 s_sleep 4
 s_nop 3
 v_readfirstlane_b32 s21, v0
 s_cmp_lt_u32 s21, s46
 s_cselect_b32 s55, s55, 0
 s_cmp_lt_i32 s55, 0
 s_cbranch_scc1 fl_25
fl_26:
 s_mov_b32 s54, 0
 buffer_load_dwordx4 v[36:39], v4, s[4:7], s84 offen offset:2048 sc1
 buffer_load_dwordx4 v[28:31], v4, s[4:7], s84 offen offset:0 sc1
 buffer_load_dwordx4 v[32:35], v4, s[4:7], s84 offen offset:1024 sc1
 s_waitcnt vmcnt(3)
 v_mov_b32 v126, v88
 v_mov_b32 v127, v89
 v_mov_b32 v128, v90
 v_mov_b32 v129, v91
 v_mov_b32 v130, v92
 v_mov_b32 v131, v93
 v_mov_b32 v132, v94
 v_mov_b32 v133, v95
 v_mov_b32 v134, v96
 v_mov_b32 v135, v97
 v_mov_b32 v136, v98
 v_mov_b32 v137, v99
 s_waitcnt vmcnt(2)
 v_smfmac_f32_16x16x32_f16 v[40:43], v[36:37], a[16:19], v25
 v_smfmac_f32_16x16x32_f16 v[52:55], v[36:37], a[76:79], v25
 v_smfmac_f32_16x16x32_f16 v[44:47], v[36:37], a[36:39], v25
 s_waitcnt vmcnt(0)
 v_bitop3_b32 v27, v31, v35, v39 bitop3:0x80
 v_perm_b32 v31, v35, v31, s89
 v_cmp_gt_u32 vcc, 0x48000000, v27
 v_mov_b32 v35, v38
 v_smfmac_f32_16x16x32_f16 v[56:59], v[36:37], a[96:99], v25
 s_cbranch_vccnz pm_23
A2_24:
 v_smfmac_f32_16x16x64_f16 v[40:43], v[28:31], a[0:7], v25
 ds_write_b128 v10, v[28:31]
 v_smfmac_f32_16x16x64_f16 v[40:43], v[32:35], a[8:15], v25
 ds_write_b128 v10, v[32:35] offset:1024
 v_smfmac_f32_16x16x64_f16 v[52:55], v[28:31], a[60:67], v25
 ds_write_b64 v10, v[36:37] offset:2048
 v_smfmac_f32_16x16x64_f16 v[52:55], v[32:35], a[68:75], v25
 v_cvt_pk_f16_f32 v40, v40, v41
 v_cvt_pk_f16_f32 v41, v42, v43
 v_smfmac_f32_16x16x32_f16 v[48:51], v[36:37], a[56:59], v25
 v_smfmac_f32_16x16x32_f16 v[60:63], v[36:37], a[116:119], v25
 v_smfmac_f32_16x16x64_f16 v[44:47], v[28:31], a[20:27], v25
 v_cvt_pk_f16_f32 v52, v52, v53
 v_cvt_pk_f16_f32 v53, v54, v55
 s_nop 0
 v_smfmac_f32_16x16x64_f16 v[44:47], v[32:35], a[28:35], v25
 v_permlane32_swap_b32 v40, v52
 v_smfmac_f32_16x16x64_f16 v[56:59], v[28:31], a[80:87], v25
 v_permlane32_swap_b32 v41, v53
 v_pk_add_f16 v40, v40, v52
 v_smfmac_f32_16x16x64_f16 v[56:59], v[32:35], a[88:95], v25
 v_pk_add_f16 v41, v41, v53
 v_smfmac_f32_16x16x64_f16 v[48:51], v[28:31], a[40:47], v25
 ds_write_b64 v5, v[40:41] offset:0
 v_smfmac_f32_16x16x64_f16 v[48:51], v[32:35], a[48:55], v25
 v_cvt_pk_f16_f32 v44, v44, v45
 v_cvt_pk_f16_f32 v45, v46, v47
 v_cvt_pk_f16_f32 v56, v56, v57
 v_smfmac_f32_16x16x64_f16 v[60:63], v[28:31], a[100:107], v25
 v_cvt_pk_f16_f32 v57, v58, v59
 s_nop 0
 v_smfmac_f32_16x16x64_f16 v[60:63], v[32:35], a[108:115], v25
 v_permlane32_swap_b32 v44, v56
 v_permlane32_swap_b32 v45, v57
 v_pk_add_f16 v44, v44, v56
 v_pk_add_f16 v45, v45, v57
 ds_write_b64 v5, v[44:45] offset:640
 v_cvt_pk_f16_f32 v48, v48, v49
 v_cvt_pk_f16_f32 v49, v50, v51
 v_cvt_pk_f16_f32 v60, v60, v61
 v_cvt_pk_f16_f32 v61, v62, v63
 s_nop 0
 v_permlane32_swap_b32 v48, v60
 v_permlane32_swap_b32 v49, v61
 v_pk_add_f16 v48, v48, v60
 v_pk_add_f16 v49, v49, v61
 ds_write_b64 v5, v[48:49] offset:1280
 s_waitcnt lgkmcnt(0) vmcnt(0)
 s_barrier
 ds_read_b64_tr_b16 v[40:41], v21 offset:0
 ds_read_b64_tr_b16 v[42:43], v21 offset:1920
 ds_read_b64_tr_b16 v[44:45], v21 offset:640
 ds_read_b64_tr_b16 v[46:47], v21 offset:2560
 ds_read_b64_tr_b16 v[48:49], v21 offset:1280
 ds_read_b64_tr_b16 v[50:51], v21 offset:3200
 s_waitcnt lgkmcnt(4)
 v_fma_mix_f32 v52, v40, 1.0, v42 op_sel:[0,0,0] op_sel_hi:[1,0,1]
 v_fma_mix_f32 v53, v40, 1.0, v42 op_sel:[1,0,1] op_sel_hi:[1,0,1]
 v_fma_mix_f32 v54, v41, 1.0, v43 op_sel:[0,0,0] op_sel_hi:[1,0,1]
 v_fma_mix_f32 v55, v41, 1.0, v43 op_sel:[1,0,1] op_sel_hi:[1,0,1]
 v_add_f32_dpp v56, v52, v52 row_ror:8 row_mask:0xf bank_mask:0xf
 v_add_f32_dpp v57, v53, v53 row_ror:8 row_mask:0xf bank_mask:0xf
 v_add_f32_dpp v58, v54, v54 row_ror:8 row_mask:0xf bank_mask:0xf
 v_add_f32_dpp v59, v55, v55 row_ror:8 row_mask:0xf bank_mask:0xf
 v_cvt_pk_bf16_f32 v118, v56, v57
 v_cvt_pk_bf16_f32 v119, v58, v59
 s_waitcnt lgkmcnt(2)
 v_fma_mix_f32 v52, v44, 1.0, v46 op_sel:[0,0,0] op_sel_hi:[1,0,1]
 v_fma_mix_f32 v53, v44, 1.0, v46 op_sel:[1,0,1] op_sel_hi:[1,0,1]
 v_fma_mix_f32 v54, v45, 1.0, v47 op_sel:[0,0,0] op_sel_hi:[1,0,1]
 v_fma_mix_f32 v55, v45, 1.0, v47 op_sel:[1,0,1] op_sel_hi:[1,0,1]
 v_add_f32_dpp v56, v52, v52 row_ror:8 row_mask:0xf bank_mask:0xf
 v_add_f32_dpp v57, v53, v53 row_ror:8 row_mask:0xf bank_mask:0xf
 v_add_f32_dpp v58, v54, v54 row_ror:8 row_mask:0xf bank_mask:0xf
 v_add_f32_dpp v59, v55, v55 row_ror:8 row_mask:0xf bank_mask:0xf
 v_cvt_pk_bf16_f32 v120, v56, v57
 v_cvt_pk_bf16_f32 v121, v58, v59
 s_waitcnt lgkmcnt(0)
 v_fma_mix_f32 v52, v48, 1.0, v50 op_sel:[0,0,0] op_sel_hi:[1,0,1]
 v_fma_mix_f32 v53, v48, 1.0, v50 op_sel:[1,0,1] op_sel_hi:[1,0,1]
 v_fma_mix_f32 v54, v49, 1.0, v51 op_sel:[0,0,0] op_sel_hi:[1,0,1]
 v_fma_mix_f32 v55, v49, 1.0, v51 op_sel:[1,0,1] op_sel_hi:[1,0,1]
 v_mfma_f32_16x16x32_bf16 v[40:43], v[112:115], v[118:121], 0
 v_add_f32_dpp v56, v52, v52 row_ror:8 row_mask:0xf bank_mask:0xf
 v_add_f32_dpp v57, v53, v53 row_ror:8 row_mask:0xf bank_mask:0xf
 v_add_f32_dpp v58, v54, v54 row_ror:8 row_mask:0xf bank_mask:0xf
 v_add_f32_dpp v59, v55, v55 row_ror:8 row_mask:0xf bank_mask:0xf
 v_cvt_pk_bf16_f32 v122, v56, v57
 v_cvt_pk_bf16_f32 v123, v58, v59
 s_nop 1
 v_mfma_f32_16x16x32_bf16 v[40:43], v[116:119], v[122:125], v[40:43]
 ds_read_b128 v[28:31], v16 offset:24576
 ds_read_b128 v[32:35], v16 offset:25600
 ds_read_b128 v[64:67], v16 offset:27648
 ds_read_b128 v[68:71], v16 offset:28672
 ds_read_b128 v[72:75], v16 offset:30720
 ds_read_b128 v[76:79], v16 offset:31744
 s_nop 0
 s_mov_b64 exec, s[74:75]
 v_cvt_pk_f16_f32 v44, v40, v41
 v_cvt_pk_f16_f32 v45, v42, v43
 v_and_or_b32 v44, v44, -2, s88
 buffer_store_dwordx2 v[44:45], v7, s[8:11], s81 offen
 s_mov_b64 exec, -1
 ds_read_b128 v[80:83], v16 offset:33792
 ds_read_b128 v[84:87], v16 offset:34816
 ds_read_b64 v[88:89], v16 offset:26624
 ds_read_b64 v[90:91], v16 offset:29696
 ds_read_b64 v[92:93], v16 offset:32768
 ds_read_b64 v[94:95], v16 offset:35840
 s_cmp_eq_u32 s52, 63
 s_cbranch_scc1 last_21
 s_waitcnt lgkmcnt(10)
 v_smfmac_f32_16x16x64_f16 v[100:103], v[28:31], a[120:127], v25
 v_smfmac_f32_16x16x64_f16 v[104:107], v[28:31], a[128:135], v25
 v_smfmac_f32_16x16x64_f16 v[108:111], v[28:31], a[136:143], v25
 s_mov_b32 s54, 0
 v_smfmac_f32_16x16x64_f16 v[100:103], v[32:35], a[144:151], v25
 v_readfirstlane_b32 s21, v0
 v_smfmac_f32_16x16x64_f16 v[104:107], v[32:35], a[152:159], v25
 s_add_u32 s22, s46, 3
 v_smfmac_f32_16x16x64_f16 v[108:111], v[32:35], a[160:167], v25
 s_min_u32 s22, s22, 64
 s_waitcnt lgkmcnt(7)
 v_smfmac_f32_16x16x64_f16 v[100:103], v[64:67], a[168:175], v25
 s_sub_u32 s55, s21, s22
 v_smfmac_f32_16x16x64_f16 v[104:107], v[64:67], a[176:183], v25
 s_sub_u32 s56, s21, s46
 v_smfmac_f32_16x16x64_f16 v[108:111], v[64:67], a[184:191], v25
 v_smfmac_f32_16x16x64_f16 v[100:103], v[68:71], a[192:199], v25
 v_smfmac_f32_16x16x64_f16 v[104:107], v[68:71], a[200:207], v25
 v_smfmac_f32_16x16x64_f16 v[108:111], v[68:71], a[208:215], v25
 v_smfmac_f32_16x16x64_f16 v[100:103], v[72:75], a[216:223], v25
 v_smfmac_f32_16x16x64_f16 v[104:107], v[72:75], a[224:231], v25
 v_smfmac_f32_16x16x64_f16 v[108:111], v[72:75], a[232:239], v25
 s_waitcnt lgkmcnt(4)
 v_smfmac_f32_16x16x64_f16 v[100:103], v[76:79], a[240:247], v25
 v_smfmac_f32_16x16x64_f16 v[104:107], v[76:79], a[248:255], v25
 v_smfmac_f32_16x16x64_f16 v[108:111], v[76:79], v[152:159], v25
 v_smfmac_f32_16x16x64_f16 v[100:103], v[80:83], v[160:167], v25
 buffer_load_dwordx2 v[58:59], v9, s[8:11], s81 offen sc1
 buffer_load_dwordx4 v[40:43], v8, s[8:11], s81 offen offset:0 sc1
 buffer_load_dwordx4 v[44:47], v8, s[8:11], s81 offen offset:1024 sc1
 v_smfmac_f32_16x16x64_f16 v[104:107], v[80:83], v[168:175], v25
 v_smfmac_f32_16x16x64_f16 v[108:111], v[80:83], v[176:183], v25
 v_smfmac_f32_16x16x64_f16 v[100:103], v[84:87], v[184:191], v25
 v_smfmac_f32_16x16x64_f16 v[104:107], v[84:87], v[192:199], v25
 v_smfmac_f32_16x16x64_f16 v[108:111], v[84:87], v[200:207], v25
 s_waitcnt lgkmcnt(0)
 v_smfmac_f32_16x16x64_f16 v[100:103], v[88:91], v[208:215], v25
 v_smfmac_f32_16x16x64_f16 v[104:107], v[88:91], v[216:223], v25
 v_smfmac_f32_16x16x64_f16 v[108:111], v[88:91], v[224:231], v25
 v_smfmac_f32_16x16x64_f16 v[100:103], v[92:95], v[232:239], v25
 v_smfmac_f32_16x16x64_f16 v[104:107], v[92:95], v[240:247], v25
 v_smfmac_f32_16x16x64_f16 v[108:111], v[92:95], v[248:255], v25
 s_cmp_lt_i32 s56, 0
 s_cbranch_scc1 kvw_29
kvok_30:
 s_waitcnt vmcnt(2)
 v_xor_b32 v76, s88, v58
 s_nop 0
 v_permlane16_swap_b32 v58, v59
 v_fma_mix_f32 v60, v58, 1.0, v59 op_sel:[0,0,0] op_sel_hi:[1,0,1]
 v_fma_mix_f32 v61, v58, 1.0, v59 op_sel:[1,0,1] op_sel_hi:[1,0,1]
 v_mov_b32 v58, v60
 v_mov_b32 v59, v61
 s_nop 0
 v_permlane32_swap_b32 v58, v60
 v_permlane32_swap_b32 v59, v61
 v_add_f32 v52, v58, v60
 v_add_f32 v53, v59, v61
 v_max_f32 v79, v52, v53
 s_waitcnt vmcnt(0)
 v_pk_add_f16 v80, v40, v44
 v_pk_add_f16 v82, v42, v46
 v_pk_add_f16 v81, v41, v45
 v_pk_add_f16 v83, v43, v47
 v_permlane32_swap_b32 v80, v82
 v_bitop3_b32 v77, v40, v42, s88 bitop3:0x7e
 v_permlane32_swap_b32 v81, v83
 v_bitop3_b32 v78, v44, v46, s88 bitop3:0x7e
 v_fma_mix_f32 v48, v80, 1.0, v82 op_sel:[0,0,0] op_sel_hi:[1,0,1]
 v_or3_b32 v27, v76, v77, v78
 v_fma_mix_f32 v49, v80, 1.0, v82 op_sel:[1,0,1] op_sel_hi:[1,0,1]
 v_and_b32 v27, 1, v27
 v_fma_mix_f32 v50, v81, 1.0, v83 op_sel:[0,0,0] op_sel_hi:[1,0,1]
 v_cmp_ne_u32 vcc, 0, v27
 v_fma_mix_f32 v51, v81, 1.0, v83 op_sel:[1,0,1] op_sel_hi:[1,0,1]
 v_max3_f32 v62, v48, v49, v79
 s_cbranch_vccnz psr_27
psj_28:
 v_max3_f32 v62, v62, v50, v51
 v_cvt_pk_bf16_f32 v146, v100, v101
 v_cvt_pk_bf16_f32 v147, v102, v103
 v_max_f32_dpp v62, v62, v62 row_ror:8 row_mask:0xf bank_mask:0xf
 v_mov_b32 v63, v62
 v_cvt_pk_bf16_f32 v148, v104, v105
 v_cvt_pk_bf16_f32 v149, v106, v107
 v_permlane32_swap_b32 v62, v63
 v_max_f32 v62, v62, v63
 v_mov_b32 v63, v62
 v_cvt_pk_bf16_f32 v150, v108, v109
 v_cvt_pk_bf16_f32 v151, v110, v111
 v_permlane16_swap_b32 v62, v63
 v_max_f32 v62, v62, v63
 v_mul_f32 v62, s86, v62
 v_fma_f32 v48, v48, s86, -v62
 v_fma_f32 v49, v49, s86, -v62
 v_fma_f32 v50, v50, s86, -v62
 v_fma_f32 v51, v51, s86, -v62
 v_fma_f32 v52, v52, s86, -v62
 v_fma_f32 v53, v53, s86, -v62
 v_exp_f32 v48, v48
 v_exp_f32 v49, v49
 buffer_load_dwordx4 v[88:91], v17, s[28:31], s64 offen offset:0 sc1
 v_exp_f32 v50, v50
 v_exp_f32 v51, v51
 buffer_load_dwordx4 v[92:95], v16, s[28:31], s64 offen offset:1024 sc1
 v_exp_f32 v52, v52
 v_exp_f32 v53, v53
 buffer_load_dwordx4 v[96:99], v20, s[28:31], s64 offen offset:2048 sc1
 v_cvt_pk_bf16_f32 v138, v48, v49
 v_cvt_pk_bf16_f32 v139, v50, v51
 v_cvt_pk_bf16_f32 v142, v52, v53
 v_mov_b32_dpp v140, v138 row_ror:8 row_mask:0xf bank_mask:0xf
 v_mov_b32_dpp v141, v139 row_ror:8 row_mask:0xf bank_mask:0xf
 v_mov_b32_dpp v143, v142 row_ror:8 row_mask:0xf bank_mask:0xf
 buffer_load_dwordx4 v[112:115], v18, s[16:19], s80 offen sc1
 v_add_f32 v54, v48, v49
 v_mfma_f32_16x16x32_bf16 v[64:67], v[126:129], v[138:141], 0
 v_add_f32 v55, v50, v51
 v_add_f32 v56, v52, v53
 v_mfma_f32_16x16x32_bf16 v[64:67], v[146:149], v[142:145], v[64:67]
 v_add_f32 v62, v54, v55
 v_fmac_f32 v62, v56, v26
 v_mfma_f32_16x16x32_bf16 v[68:71], v[130:133], v[138:141], 0
 buffer_load_dwordx2 v[116:117], v19, s[16:19], s80 offen sc1
 v_add_f32_dpp v62, v62, v62 row_ror:8 row_mask:0xf bank_mask:0xf
 v_mfma_f32_16x16x32_bf16 v[68:71], v[148:151], v[142:145], v[68:71]
 v_mov_b32 v63, v62
 s_cmp_lt_i32 s55, 0
 s_cbranch_scc1 fl_31
fl_32:
 v_mfma_f32_16x16x32_bf16 v[72:75], v[134:137], v[138:141], 0
 v_permlane32_swap_b32 v62, v63
 v_mfma_f32_16x16x32_bf16 v[72:75], v[150:153], v[142:145], v[72:75]
 v_add_f32 v62, v62, v63
 v_mov_b32 v63, v62
 ds_write_b128 v11, v[64:67] offset:0
 s_nop 0
 v_permlane16_swap_b32 v62, v63
 v_add_f32 v62, v62, v63
 v_rcp_f32 v62, v62
 ds_write_b128 v11, v[68:71] offset:1024
 s_mov_b64 exec, 0xff
 ds_write_b32 v22, v62
 s_mov_b64 exec, -1
 ds_write_b128 v11, v[72:75] offset:2048
 s_waitcnt lgkmcnt(0)
 s_barrier
 ds_read_b128 v[72:75], v23
 ds_read_b64 v[64:65], v12 offset:0
 ds_read_b64 v[66:67], v12 offset:3072
 ds_read_b64 v[68:69], v12 offset:6144
 ds_read_b64 v[70:71], v12 offset:9216
 s_waitcnt lgkmcnt(2)
 v_pk_mul_f32 v[64:65], v[64:65], v[72:73] op_sel_hi:[1,0]
 v_pk_fma_f32 v[64:65], v[66:67], v[72:73], v[64:65] op_sel:[0,1,0] op_sel_hi:[1,1,1]
 s_waitcnt lgkmcnt(0)
 v_pk_fma_f32 v[64:65], v[68:69], v[74:75], v[64:65] op_sel_hi:[1,0,1]
 v_pk_fma_f32 v[64:65], v[70:71], v[74:75], v[64:65] op_sel:[0,1,0] op_sel_hi:[1,1,1]
 v_cvt_pk_f16_f32 v68, v64, v65
 v_perm_b32 v68, s91, v68, v14
 buffer_atomic_pk_add_f16 v68, v13, s[4:7], s3 offen
 v_mov_b32 v76, v108
 v_mov_b32 v77, v109
 v_mov_b32 v78, v110
 v_mov_b32 v79, v111
 v_permlane32_swap_b32 v100, v104
 v_permlane32_swap_b32 v101, v105
 v_permlane32_swap_b32 v102, v106
 v_permlane32_swap_b32 v103, v107
 v_permlane32_swap_b32 v108, v76
 v_permlane32_swap_b32 v109, v77
 v_permlane32_swap_b32 v110, v78
 v_permlane32_swap_b32 v111, v79
 v_pk_add_f32 v[100:101], v[100:101], v[104:105]
 v_pk_add_f32 v[102:103], v[102:103], v[106:107]
 v_pk_add_f32 v[108:109], v[108:109], v[76:77]
 v_pk_add_f32 v[110:111], v[110:111], v[78:79]
 v_cvt_pk_bf16_f32 v80, v100, v101
 v_cvt_pk_bf16_f32 v82, v108, v109
 v_cvt_pk_bf16_f32 v81, v102, v103
 v_cvt_pk_bf16_f32 v83, v110, v111
 s_nop 0
 v_permlane16_swap_b32 v80, v82
 v_permlane16_swap_b32 v81, v83
 v_min_u32 v80, -2, v80
 s_mov_b64 exec, s[76:77]
 buffer_store_dwordx4 v[80:83], v15, s[24:27], s57 offen sc1
 s_mov_b64 exec, -1
 s_add_u32 s64, s64, 1310720
 s_add_u32 s52, s52, 1
 s_branch step_20
fl_25:
 buffer_load_dword v0, off, s[12:15], s79 sc1
 s_branch fl_26
A1_15:
 v_smfmac_f32_16x16x32_f16 v[40:43], v[36:37], a[16:19], v25
 v_smfmac_f32_16x16x32_f16 v[52:55], v[36:37], a[76:79], v25
 v_smfmac_f32_16x16x32_f16 v[44:47], v[36:37], a[36:39], v25
 v_smfmac_f32_16x16x32_f16 v[56:59], v[36:37], a[96:99], v25
 s_branch A2_24
pm_23:
 buffer_load_dwordx4 v[36:39], v4, s[4:7], s84 offen offset:2048 sc1
 buffer_load_dwordx4 v[28:31], v4, s[4:7], s84 offen offset:0 sc1
 buffer_load_dwordx4 v[32:35], v4, s[4:7], s84 offen offset:1024 sc1
 s_nop 7
 v_mov_b32 v40, 0
 v_mov_b32 v41, 0
 v_mov_b32 v42, 0
 v_mov_b32 v43, 0
 v_mov_b32 v52, 0
 v_mov_b32 v53, 0
 v_mov_b32 v54, 0
 v_mov_b32 v55, 0
 v_mov_b32 v44, 0
 v_mov_b32 v45, 0
 v_mov_b32 v46, 0
 v_mov_b32 v47, 0
 v_mov_b32 v56, 0
 v_mov_b32 v57, 0
 v_mov_b32 v58, 0
 v_mov_b32 v59, 0
 s_waitcnt vmcnt(0)
 v_bitop3_b32 v27, v31, v35, v39 bitop3:0x80
 v_perm_b32 v31, v35, v31, s89
 v_cmp_gt_u32 vcc, 0x48000000, v27
 v_mov_b32 v35, v38
 s_cbranch_vccz A1_15
pm_22:
 s_cmp_gt_u32 s52, 3
 s_cbranch_scc1 op_33
 v_readfirstlane_b32 s21, v0
 s_cmp_ge_u32 s21, s46
 s_cbranch_scc1 op_33
 buffer_load_dword v0, off, s[12:15], s79 sc1
 s_waitcnt vmcnt(0)
 v_readfirstlane_b32 s21, v0
 s_cmp_gt_u32 s21, s52
 s_cselect_b32 s21, s87, 0
 s_cmp_eq_u32 s21, 0
 s_cbranch_scc1 op_33
 s_mov_b32 s87, 0
 s_sub_u32 s21, s64, 1310720
 buffer_load_dwordx4 v[126:129], v16, s[28:31], s21 offen offset:0 sc1
 buffer_load_dwordx4 v[130:133], v16, s[28:31], s21 offen offset:1024 sc1
 buffer_load_dwordx4 v[134:137], v16, s[28:31], s21 offen offset:2048 sc1
op_33:
 buffer_load_dwordx4 v[36:39], v4, s[4:7], s84 offen offset:2048 sc1
 buffer_load_dwordx4 v[28:31], v4, s[4:7], s84 offen offset:0 sc1
 buffer_load_dwordx4 v[32:35], v4, s[4:7], s84 offen offset:1024 sc1
 s_add_u32 s54, s54, 1
 s_cmp_gt_u32 s54, 131072
 s_cbranch_scc1 end0
 s_waitcnt vmcnt(0)
 v_bitop3_b32 v27, v31, v35, v39 bitop3:0x80
 v_perm_b32 v31, v35, v31, s89
 v_cmp_gt_u32 vcc, 0x48000000, v27
 v_mov_b32 v35, v38
 s_cbranch_vccnz pm_22
 s_branch A1_15
psr_27:
 buffer_load_dwordx2 v[58:59], v9, s[8:11], s81 offen sc1
 buffer_load_dwordx4 v[40:43], v8, s[8:11], s81 offen offset:0 sc1
 buffer_load_dwordx4 v[44:47], v8, s[8:11], s81 offen offset:1024 sc1
 s_add_u32 s54, s54, 1
 s_cmp_gt_u32 s54, 131072
 s_cbranch_scc1 end0
 s_waitcnt vmcnt(2)
 v_xor_b32 v76, s88, v58
 s_nop 0
 v_permlane16_swap_b32 v58, v59
 v_fma_mix_f32 v60, v58, 1.0, v59 op_sel:[0,0,0] op_sel_hi:[1,0,1]
 v_fma_mix_f32 v61, v58, 1.0, v59 op_sel:[1,0,1] op_sel_hi:[1,0,1]
 v_mov_b32 v58, v60
 v_mov_b32 v59, v61
 s_nop 0
 v_permlane32_swap_b32 v58, v60
 v_permlane32_swap_b32 v59, v61
 v_add_f32 v52, v58, v60
 v_add_f32 v53, v59, v61
 v_max_f32 v79, v52, v53
 s_waitcnt vmcnt(0)
 v_pk_add_f16 v80, v40, v44
 v_pk_add_f16 v82, v42, v46
 v_pk_add_f16 v81, v41, v45
 v_pk_add_f16 v83, v43, v47
 v_permlane32_swap_b32 v80, v82
 v_bitop3_b32 v77, v40, v42, s88 bitop3:0x7e
 v_permlane32_swap_b32 v81, v83
 v_bitop3_b32 v78, v44, v46, s88 bitop3:0x7e
 v_fma_mix_f32 v48, v80, 1.0, v82 op_sel:[0,0,0] op_sel_hi:[1,0,1]
 v_or3_b32 v27, v76, v77, v78
 v_fma_mix_f32 v49, v80, 1.0, v82 op_sel:[1,0,1] op_sel_hi:[1,0,1]
 v_and_b32 v27, 1, v27
 v_fma_mix_f32 v50, v81, 1.0, v83 op_sel:[0,0,0] op_sel_hi:[1,0,1]
 v_cmp_ne_u32 vcc, 0, v27
 v_fma_mix_f32 v51, v81, 1.0, v83 op_sel:[1,0,1] op_sel_hi:[1,0,1]
 v_max3_f32 v62, v48, v49, v79
 s_cbranch_vccnz psr_27
 s_branch psj_28
kvw_29:
 s_mov_b32 s22, s87
 s_cmp_eq_u32 s52, 0
 s_cselect_b32 s55, 0, s55
 s_cselect_b32 s87, 1, 0
 s_cbranch_scc1 kvok_30
 v_mov_b32 v62, 0
 s_mov_b32 s101, 0
wf_34:
 buffer_load_dword v63, v62, s[12:15], s79 offen sc1
 s_add_u32 s101, s101, 1
 s_cmp_gt_u32 s101, 131072
 s_cbranch_scc1 end0
 s_waitcnt vmcnt(0)
 v_readfirstlane_b32 s100, v63
 s_cmp_ge_u32 s100, s46
 s_cbranch_scc1 wf_35
 s_sleep 3
 s_branch wf_34
wf_35:
 s_cmp_eq_u32 s22, 0
 s_cbranch_scc1 kvok_30
 s_sub_u32 s21, s64, 1310720
 buffer_load_dwordx4 v[126:129], v16, s[28:31], s21 offen offset:0 sc1
 buffer_load_dwordx4 v[130:133], v16, s[28:31], s21 offen offset:1024 sc1
 buffer_load_dwordx4 v[134:137], v16, s[28:31], s21 offen offset:2048 sc1
 s_waitcnt vmcnt(0)
 s_branch kvok_30
fl_31:
 buffer_load_dword v0, off, s[12:15], s79 sc1
 s_branch fl_32
last_21:
 s_waitcnt lgkmcnt(10)
 v_smfmac_f32_16x16x64_f16 v[100:103], v[28:31], a[120:127], v25
 v_smfmac_f32_16x16x64_f16 v[104:107], v[28:31], a[128:135], v25
 v_smfmac_f32_16x16x64_f16 v[108:111], v[28:31], a[136:143], v25
 v_smfmac_f32_16x16x64_f16 v[100:103], v[32:35], a[144:151], v25
 v_smfmac_f32_16x16x64_f16 v[104:107], v[32:35], a[152:159], v25
 v_smfmac_f32_16x16x64_f16 v[108:111], v[32:35], a[160:167], v25
 s_waitcnt lgkmcnt(7)
 v_smfmac_f32_16x16x64_f16 v[100:103], v[64:67], a[168:175], v25
 v_smfmac_f32_16x16x64_f16 v[104:107], v[64:67], a[176:183], v25
 v_smfmac_f32_16x16x64_f16 v[108:111], v[64:67], a[184:191], v25
 v_smfmac_f32_16x16x64_f16 v[100:103], v[68:71], a[192:199], v25
 v_smfmac_f32_16x16x64_f16 v[104:107], v[68:71], a[200:207], v25
 v_smfmac_f32_16x16x64_f16 v[108:111], v[68:71], a[208:215], v25
 v_smfmac_f32_16x16x64_f16 v[100:103], v[72:75], a[216:223], v25
 v_smfmac_f32_16x16x64_f16 v[104:107], v[72:75], a[224:231], v25
 v_smfmac_f32_16x16x64_f16 v[108:111], v[72:75], a[232:239], v25
 s_waitcnt lgkmcnt(4)
 v_smfmac_f32_16x16x64_f16 v[100:103], v[76:79], a[240:247], v25
 v_smfmac_f32_16x16x64_f16 v[104:107], v[76:79], a[248:255], v25
 v_smfmac_f32_16x16x64_f16 v[108:111], v[76:79], v[152:159], v25
 v_smfmac_f32_16x16x64_f16 v[100:103], v[80:83], v[160:167], v25
 v_smfmac_f32_16x16x64_f16 v[104:107], v[80:83], v[168:175], v25
 v_smfmac_f32_16x16x64_f16 v[108:111], v[80:83], v[176:183], v25
 v_smfmac_f32_16x16x64_f16 v[100:103], v[84:87], v[184:191], v25
 v_smfmac_f32_16x16x64_f16 v[104:107], v[84:87], v[192:199], v25
 v_smfmac_f32_16x16x64_f16 v[108:111], v[84:87], v[200:207], v25
 s_waitcnt lgkmcnt(0)
 v_smfmac_f32_16x16x64_f16 v[100:103], v[88:91], v[208:215], v25
 v_smfmac_f32_16x16x64_f16 v[104:107], v[88:91], v[216:223], v25
 v_smfmac_f32_16x16x64_f16 v[108:111], v[88:91], v[224:231], v25
 v_smfmac_f32_16x16x64_f16 v[100:103], v[92:95], v[232:239], v25
 v_smfmac_f32_16x16x64_f16 v[104:107], v[92:95], v[240:247], v25
 v_smfmac_f32_16x16x64_f16 v[108:111], v[92:95], v[248:255], v25
 s_nop 7
 v_mov_b32 v76, v108
 v_mov_b32 v77, v109
 v_mov_b32 v78, v110
 v_mov_b32 v79, v111
 v_permlane32_swap_b32 v100, v104
 v_permlane32_swap_b32 v101, v105
 v_permlane32_swap_b32 v102, v106
 v_permlane32_swap_b32 v103, v107
 v_permlane32_swap_b32 v108, v76
 v_permlane32_swap_b32 v109, v77
 v_permlane32_swap_b32 v110, v78
 v_permlane32_swap_b32 v111, v79
 v_pk_add_f32 v[100:101], v[100:101], v[104:105]
 v_pk_add_f32 v[102:103], v[102:103], v[106:107]
 v_pk_add_f32 v[108:109], v[108:109], v[76:77]
 v_pk_add_f32 v[110:111], v[110:111], v[78:79]
 v_cvt_pk_bf16_f32 v80, v100, v101
 v_cvt_pk_bf16_f32 v82, v108, v109
 v_cvt_pk_bf16_f32 v81, v102, v103
 v_cvt_pk_bf16_f32 v83, v110, v111
 s_nop 0
 v_permlane16_swap_b32 v80, v82
 v_permlane16_swap_b32 v81, v83
 v_min_u32 v80, -2, v80
 s_mov_b64 exec, s[76:77]
 buffer_store_dwordx4 v[80:83], v15, s[24:27], s57 offen sc1
 s_mov_b64 exec, -1
 v_mov_b32 v246, 80
 v_mov_b32 v247, 1
 s_mov_b64 exec, 1
 buffer_atomic_add v247, v246, s[32:35], 0 offen sc0 sc1
 s_mov_b64 exec, -1
 s_branch chain_done
step_36:
 s_and_b32 s21, s52, 3
 s_mul_i32 s81, s21, 540672
 s_mul_i32 s84, s21, 0x88000
 s_and_b32 s84, s84, 0x108000
 s_add_u32 s21, s52, 3
 s_and_b32 s21, s21, 3
 s_mul_i32 s83, s21, 0x88000
 s_and_b32 s83, s83, 0x108000
 s_add_u32 s21, s52, 1
 s_and_b32 s22, s21, 3
 s_mul_i32 s3, s22, 0x88000
 s_and_b32 s3, s3, 0x108000
 s_mul_i32 s80, s21, 393216
 s_add_u32 s46, s21, 1
 s_min_u32 s46, s46, 64
 s_mov_b32 s47, s57
 s_mov_b32 s78, s85
 s_lshr_b32 s21, s52, 1
 s_bitcmp1_b32 s37, s21
 s_cselect_b32 s21, 8192, 0
 s_lshl_b32 s22, s52, 20
 s_or_b32 s22, s22, s21
 s_cmp_ge_u32 s52, 40
 s_cselect_b32 s57, 8192, 0
 s_xor_b32 s57, s57, s22
 s_xor_b32 s85, s22, 8192
 s_bfe_u32 s88, s52, 0x10002
 s_max_u32 s67, s52, 1
 s_sub_u32 s67, s67, 1
 v_mov_b32 v40, 0
 v_mov_b32 v41, 0
 v_mov_b32 v42, 0
 v_mov_b32 v43, 0
 v_mov_b32 v44, 0
 v_mov_b32 v45, 0
 v_mov_b32 v46, 0
 v_mov_b32 v47, 0
 v_mov_b32 v48, 0
 v_mov_b32 v49, 0
 v_mov_b32 v50, 0
 v_mov_b32 v51, 0
 v_mov_b32 v52, 0
 v_mov_b32 v53, 0
 v_mov_b32 v54, 0
 v_mov_b32 v55, 0
 v_mov_b32 v56, 0
 v_mov_b32 v57, 0
 v_mov_b32 v58, 0
 v_mov_b32 v59, 0
 v_mov_b32 v60, 0
 v_mov_b32 v61, 0
 v_mov_b32 v62, 0
 v_mov_b32 v63, 0
 v_mov_b32 v100, 0
 v_mov_b32 v101, 0
 v_mov_b32 v102, 0
 v_mov_b32 v103, 0
 v_mov_b32 v104, 0
 v_mov_b32 v105, 0
 v_mov_b32 v106, 0
 v_mov_b32 v107, 0
 v_mov_b32 v108, 0
 v_mov_b32 v109, 0
 v_mov_b32 v110, 0
 v_mov_b32 v111, 0
 s_sleep 4
 s_nop 3
 v_readfirstlane_b32 s21, v0
 s_cmp_lt_u32 s21, s46
 s_cselect_b32 s55, s55, 0
 s_cmp_lt_i32 s55, 0
 s_cbranch_scc1 fl_41
fl_42:
 s_mov_b32 s54, 0
 buffer_load_dwordx4 v[36:39], v4, s[4:7], s84 offen offset:2048 sc1
 buffer_load_dwordx4 v[28:31], v4, s[4:7], s84 offen offset:0 sc1
 buffer_load_dwordx4 v[32:35], v4, s[4:7], s84 offen offset:1024 sc1
 s_waitcnt vmcnt(3)
 v_mov_b32 v126, v88
 v_mov_b32 v127, v89
 v_mov_b32 v128, v90
 v_mov_b32 v129, v91
 v_mov_b32 v130, v92
 v_mov_b32 v131, v93
 v_mov_b32 v132, v94
 v_mov_b32 v133, v95
 v_mov_b32 v134, v96
 v_mov_b32 v135, v97
 v_mov_b32 v136, v98
 v_mov_b32 v137, v99
 s_waitcnt vmcnt(2)
 v_smfmac_f32_16x16x32_f16 v[40:43], v[36:37], a[16:19], v25
 v_smfmac_f32_16x16x32_f16 v[52:55], v[36:37], a[76:79], v25
 v_smfmac_f32_16x16x32_f16 v[44:47], v[36:37], a[36:39], v25
 s_waitcnt vmcnt(0)
 v_bitop3_b32 v27, v31, v35, v39 bitop3:0x80
 v_perm_b32 v31, v35, v31, s89
 v_cmp_gt_u32 vcc, 0x48000000, v27
 v_mov_b32 v35, v38
 v_smfmac_f32_16x16x32_f16 v[56:59], v[36:37], a[96:99], v25
 s_cbranch_vccnz pm_39
A2_40:
 v_smfmac_f32_16x16x64_f16 v[40:43], v[28:31], a[0:7], v25
 ds_write_b128 v10, v[28:31]
 v_smfmac_f32_16x16x64_f16 v[40:43], v[32:35], a[8:15], v25
 ds_write_b128 v10, v[32:35] offset:1024
 v_smfmac_f32_16x16x64_f16 v[52:55], v[28:31], a[60:67], v25
 ds_write_b64 v10, v[36:37] offset:2048
 v_smfmac_f32_16x16x64_f16 v[52:55], v[32:35], a[68:75], v25
 v_cvt_pk_f16_f32 v40, v40, v41
 v_cvt_pk_f16_f32 v41, v42, v43
 v_smfmac_f32_16x16x32_f16 v[48:51], v[36:37], a[56:59], v25
 v_smfmac_f32_16x16x32_f16 v[60:63], v[36:37], a[116:119], v25
 v_smfmac_f32_16x16x64_f16 v[44:47], v[28:31], a[20:27], v25
 v_cvt_pk_f16_f32 v52, v52, v53
 v_cvt_pk_f16_f32 v53, v54, v55
 s_nop 0
 v_smfmac_f32_16x16x64_f16 v[44:47], v[32:35], a[28:35], v25
 v_permlane32_swap_b32 v40, v52
 v_smfmac_f32_16x16x64_f16 v[56:59], v[28:31], a[80:87], v25
 v_permlane32_swap_b32 v41, v53
 v_pk_add_f16 v40, v40, v52
 v_smfmac_f32_16x16x64_f16 v[56:59], v[32:35], a[88:95], v25
 v_pk_add_f16 v41, v41, v53
 v_smfmac_f32_16x16x64_f16 v[48:51], v[28:31], a[40:47], v25
 ds_write_b64 v5, v[40:41] offset:0
 v_smfmac_f32_16x16x64_f16 v[48:51], v[32:35], a[48:55], v25
 v_cvt_pk_f16_f32 v44, v44, v45
 v_cvt_pk_f16_f32 v45, v46, v47
 v_cvt_pk_f16_f32 v56, v56, v57
 v_smfmac_f32_16x16x64_f16 v[60:63], v[28:31], a[100:107], v25
 v_cvt_pk_f16_f32 v57, v58, v59
 s_nop 0
 v_smfmac_f32_16x16x64_f16 v[60:63], v[32:35], a[108:115], v25
 v_permlane32_swap_b32 v44, v56
 v_permlane32_swap_b32 v45, v57
 v_pk_add_f16 v44, v44, v56
 v_pk_add_f16 v45, v45, v57
 ds_write_b64 v5, v[44:45] offset:640
 v_cvt_pk_f16_f32 v48, v48, v49
 v_cvt_pk_f16_f32 v49, v50, v51
 v_cvt_pk_f16_f32 v60, v60, v61
 v_cvt_pk_f16_f32 v61, v62, v63
 s_nop 0
 v_permlane32_swap_b32 v48, v60
 v_permlane32_swap_b32 v49, v61
 v_pk_add_f16 v48, v48, v60
 v_pk_add_f16 v49, v49, v61
 ds_write_b64 v5, v[48:49] offset:1280
 s_waitcnt lgkmcnt(0) vmcnt(0)
 s_barrier
 ds_read_b64_tr_b16 v[40:41], v21 offset:0
 ds_read_b64_tr_b16 v[42:43], v21 offset:1920
 ds_read_b64_tr_b16 v[44:45], v21 offset:640
 ds_read_b64_tr_b16 v[46:47], v21 offset:2560
 ds_read_b64_tr_b16 v[48:49], v21 offset:1280
 ds_read_b64_tr_b16 v[50:51], v21 offset:3200
 s_waitcnt lgkmcnt(4)
 v_fma_mix_f32 v52, v40, 1.0, v42 op_sel:[0,0,0] op_sel_hi:[1,0,1]
 v_fma_mix_f32 v53, v40, 1.0, v42 op_sel:[1,0,1] op_sel_hi:[1,0,1]
 v_fma_mix_f32 v54, v41, 1.0, v43 op_sel:[0,0,0] op_sel_hi:[1,0,1]
 v_fma_mix_f32 v55, v41, 1.0, v43 op_sel:[1,0,1] op_sel_hi:[1,0,1]
 v_add_f32_dpp v56, v52, v52 row_ror:8 row_mask:0xf bank_mask:0xf
 v_add_f32_dpp v57, v53, v53 row_ror:8 row_mask:0xf bank_mask:0xf
 v_add_f32_dpp v58, v54, v54 row_ror:8 row_mask:0xf bank_mask:0xf
 v_add_f32_dpp v59, v55, v55 row_ror:8 row_mask:0xf bank_mask:0xf
 v_cvt_pk_bf16_f32 v118, v56, v57
 v_cvt_pk_bf16_f32 v119, v58, v59
 s_waitcnt lgkmcnt(2)
 v_fma_mix_f32 v52, v44, 1.0, v46 op_sel:[0,0,0] op_sel_hi:[1,0,1]
 v_fma_mix_f32 v53, v44, 1.0, v46 op_sel:[1,0,1] op_sel_hi:[1,0,1]
 v_fma_mix_f32 v54, v45, 1.0, v47 op_sel:[0,0,0] op_sel_hi:[1,0,1]
 v_fma_mix_f32 v55, v45, 1.0, v47 op_sel:[1,0,1] op_sel_hi:[1,0,1]
 v_add_f32_dpp v56, v52, v52 row_ror:8 row_mask:0xf bank_mask:0xf
 v_add_f32_dpp v57, v53, v53 row_ror:8 row_mask:0xf bank_mask:0xf
 v_add_f32_dpp v58, v54, v54 row_ror:8 row_mask:0xf bank_mask:0xf
 v_add_f32_dpp v59, v55, v55 row_ror:8 row_mask:0xf bank_mask:0xf
 v_cvt_pk_bf16_f32 v120, v56, v57
 v_cvt_pk_bf16_f32 v121, v58, v59
 s_waitcnt lgkmcnt(0)
 v_fma_mix_f32 v52, v48, 1.0, v50 op_sel:[0,0,0] op_sel_hi:[1,0,1]
 v_fma_mix_f32 v53, v48, 1.0, v50 op_sel:[1,0,1] op_sel_hi:[1,0,1]
 v_fma_mix_f32 v54, v49, 1.0, v51 op_sel:[0,0,0] op_sel_hi:[1,0,1]
 v_fma_mix_f32 v55, v49, 1.0, v51 op_sel:[1,0,1] op_sel_hi:[1,0,1]
 v_mfma_f32_16x16x32_bf16 v[40:43], v[112:115], v[118:121], 0
 v_add_f32_dpp v56, v52, v52 row_ror:8 row_mask:0xf bank_mask:0xf
 v_add_f32_dpp v57, v53, v53 row_ror:8 row_mask:0xf bank_mask:0xf
 v_add_f32_dpp v58, v54, v54 row_ror:8 row_mask:0xf bank_mask:0xf
 v_add_f32_dpp v59, v55, v55 row_ror:8 row_mask:0xf bank_mask:0xf
 v_cvt_pk_bf16_f32 v122, v56, v57
 v_cvt_pk_bf16_f32 v123, v58, v59
 s_nop 1
 v_mfma_f32_16x16x32_bf16 v[40:43], v[116:119], v[122:125], v[40:43]
 ds_read_b128 v[28:31], v16 offset:24576
 ds_read_b128 v[32:35], v16 offset:25600
 ds_read_b128 v[64:67], v16 offset:27648
 ds_read_b128 v[68:71], v16 offset:28672
 ds_read_b128 v[72:75], v16 offset:30720
 ds_read_b128 v[76:79], v16 offset:31744
 s_nop 0
 s_mov_b64 exec, s[74:75]
 v_cvt_pk_f16_f32 v44, v40, v41
 v_cvt_pk_f16_f32 v45, v42, v43
 v_and_or_b32 v44, v44, -2, s88
 buffer_store_dwordx2 v[44:45], v7, s[8:11], s81 offen
 s_mov_b64 exec, -1
 ds_read_b128 v[80:83], v16 offset:33792
 ds_read_b128 v[84:87], v16 offset:34816
 ds_read_b64 v[88:89], v16 offset:26624
 ds_read_b64 v[90:91], v16 offset:29696
 ds_read_b64 v[92:93], v16 offset:32768
 ds_read_b64 v[94:95], v16 offset:35840
 s_cmp_eq_u32 s52, 63
 s_cbranch_scc1 last_37
 s_waitcnt lgkmcnt(10)
 v_smfmac_f32_16x16x64_f16 v[100:103], v[28:31], a[120:127], v25
 v_smfmac_f32_16x16x64_f16 v[104:107], v[28:31], a[128:135], v25
 v_smfmac_f32_16x16x64_f16 v[108:111], v[28:31], a[136:143], v25
 s_mov_b32 s54, 0
 v_smfmac_f32_16x16x64_f16 v[100:103], v[32:35], a[144:151], v25
 v_readfirstlane_b32 s21, v0
 v_smfmac_f32_16x16x64_f16 v[104:107], v[32:35], a[152:159], v25
 s_add_u32 s22, s46, 3
 v_smfmac_f32_16x16x64_f16 v[108:111], v[32:35], a[160:167], v25
 s_min_u32 s22, s22, 64
 s_waitcnt lgkmcnt(7)
 v_smfmac_f32_16x16x64_f16 v[100:103], v[64:67], a[168:175], v25
 s_sub_u32 s55, s21, s22
 v_smfmac_f32_16x16x64_f16 v[104:107], v[64:67], a[176:183], v25
 s_sub_u32 s56, s21, s46
 v_smfmac_f32_16x16x64_f16 v[108:111], v[64:67], a[184:191], v25
 v_smfmac_f32_16x16x64_f16 v[100:103], v[68:71], a[192:199], v25
 v_smfmac_f32_16x16x64_f16 v[104:107], v[68:71], a[200:207], v25
 v_smfmac_f32_16x16x64_f16 v[108:111], v[68:71], a[208:215], v25
 v_smfmac_f32_16x16x64_f16 v[100:103], v[72:75], a[216:223], v25
 v_smfmac_f32_16x16x64_f16 v[104:107], v[72:75], a[224:231], v25
 v_smfmac_f32_16x16x64_f16 v[108:111], v[72:75], a[232:239], v25
 s_waitcnt lgkmcnt(4)
 v_smfmac_f32_16x16x64_f16 v[100:103], v[76:79], a[240:247], v25
 v_smfmac_f32_16x16x64_f16 v[104:107], v[76:79], a[248:255], v25
 v_smfmac_f32_16x16x64_f16 v[108:111], v[76:79], v[152:159], v25
 v_smfmac_f32_16x16x64_f16 v[100:103], v[80:83], v[160:167], v25
 buffer_load_dwordx2 v[58:59], v9, s[8:11], s81 offen sc1
 buffer_load_dwordx4 v[40:43], v8, s[8:11], s81 offen offset:0 sc1
 buffer_load_dwordx4 v[44:47], v8, s[8:11], s81 offen offset:1024 sc1
 v_smfmac_f32_16x16x64_f16 v[104:107], v[80:83], v[168:175], v25
 v_smfmac_f32_16x16x64_f16 v[108:111], v[80:83], v[176:183], v25
 v_smfmac_f32_16x16x64_f16 v[100:103], v[84:87], v[184:191], v25
 v_smfmac_f32_16x16x64_f16 v[104:107], v[84:87], v[192:199], v25
 v_smfmac_f32_16x16x64_f16 v[108:111], v[84:87], v[200:207], v25
 s_waitcnt lgkmcnt(0)
 v_smfmac_f32_16x16x64_f16 v[100:103], v[88:91], v[208:215], v25
 v_smfmac_f32_16x16x64_f16 v[104:107], v[88:91], v[216:223], v25
 v_smfmac_f32_16x16x64_f16 v[108:111], v[88:91], v[224:231], v25
 v_smfmac_f32_16x16x64_f16 v[100:103], v[92:95], v[232:239], v25
 v_smfmac_f32_16x16x64_f16 v[104:107], v[92:95], v[240:247], v25
 v_smfmac_f32_16x16x64_f16 v[108:111], v[92:95], v[248:255], v25
 s_cmp_lt_i32 s56, 0
 s_cbranch_scc1 kvw_45
kvok_46:
 s_waitcnt vmcnt(2)
 v_xor_b32 v76, s88, v58
 s_nop 0
 v_permlane16_swap_b32 v58, v59
 v_fma_mix_f32 v60, v58, 1.0, v59 op_sel:[0,0,0] op_sel_hi:[1,0,1]
 v_fma_mix_f32 v61, v58, 1.0, v59 op_sel:[1,0,1] op_sel_hi:[1,0,1]
 v_mov_b32 v58, v60
 v_mov_b32 v59, v61
 s_nop 0
 v_permlane32_swap_b32 v58, v60
 v_permlane32_swap_b32 v59, v61
 v_add_f32 v52, v58, v60
 v_add_f32 v53, v59, v61
 v_max_f32 v79, v52, v53
 s_waitcnt vmcnt(0)
 v_pk_add_f16 v80, v40, v44
 v_pk_add_f16 v82, v42, v46
 v_pk_add_f16 v81, v41, v45
 v_pk_add_f16 v83, v43, v47
 v_permlane32_swap_b32 v80, v82
 v_bitop3_b32 v77, v40, v42, s88 bitop3:0x7e
 v_permlane32_swap_b32 v81, v83
 v_bitop3_b32 v78, v44, v46, s88 bitop3:0x7e
 v_fma_mix_f32 v48, v80, 1.0, v82 op_sel:[0,0,0] op_sel_hi:[1,0,1]
 v_or3_b32 v27, v76, v77, v78
 v_fma_mix_f32 v49, v80, 1.0, v82 op_sel:[1,0,1] op_sel_hi:[1,0,1]
 v_and_b32 v27, 1, v27
 v_fma_mix_f32 v50, v81, 1.0, v83 op_sel:[0,0,0] op_sel_hi:[1,0,1]
 v_cmp_ne_u32 vcc, 0, v27
 v_fma_mix_f32 v51, v81, 1.0, v83 op_sel:[1,0,1] op_sel_hi:[1,0,1]
 v_max3_f32 v62, v48, v49, v79
 s_cbranch_vccnz psr_43
psj_44:
 v_max3_f32 v62, v62, v50, v51
 v_cvt_pk_bf16_f32 v146, v100, v101
 v_cvt_pk_bf16_f32 v147, v102, v103
 v_max_f32_dpp v62, v62, v62 row_ror:8 row_mask:0xf bank_mask:0xf
 v_mov_b32 v63, v62
 v_cvt_pk_bf16_f32 v148, v104, v105
 v_cvt_pk_bf16_f32 v149, v106, v107
 v_permlane32_swap_b32 v62, v63
 v_max_f32 v62, v62, v63
 v_mov_b32 v63, v62
 v_cvt_pk_bf16_f32 v150, v108, v109
 v_cvt_pk_bf16_f32 v151, v110, v111
 v_permlane16_swap_b32 v62, v63
 v_max_f32 v62, v62, v63
 v_mul_f32 v62, s86, v62
 v_fma_f32 v48, v48, s86, -v62
 v_fma_f32 v49, v49, s86, -v62
 v_fma_f32 v50, v50, s86, -v62
 v_fma_f32 v51, v51, s86, -v62
 v_fma_f32 v52, v52, s86, -v62
 v_fma_f32 v53, v53, s86, -v62
 v_exp_f32 v48, v48
 v_exp_f32 v49, v49
 buffer_load_dwordx4 v[88:91], v17, s[28:31], s64 offen offset:0 sc1
 v_exp_f32 v50, v50
 v_exp_f32 v51, v51
 buffer_load_dwordx4 v[92:95], v16, s[28:31], s64 offen offset:1024 sc1
 v_exp_f32 v52, v52
 v_exp_f32 v53, v53
 buffer_load_dwordx4 v[96:99], v20, s[28:31], s64 offen offset:2048 sc1
 v_cvt_pk_bf16_f32 v138, v48, v49
 v_cvt_pk_bf16_f32 v139, v50, v51
 v_cvt_pk_bf16_f32 v142, v52, v53
 v_mov_b32_dpp v140, v138 row_ror:8 row_mask:0xf bank_mask:0xf
 v_mov_b32_dpp v141, v139 row_ror:8 row_mask:0xf bank_mask:0xf
 v_mov_b32_dpp v143, v142 row_ror:8 row_mask:0xf bank_mask:0xf
 buffer_load_dwordx4 v[112:115], v18, s[16:19], s80 offen sc1
 v_add_f32 v54, v48, v49
 v_mfma_f32_16x16x32_bf16 v[64:67], v[126:129], v[138:141], 0
 v_add_f32 v55, v50, v51
 v_add_f32 v56, v52, v53
 v_mfma_f32_16x16x32_bf16 v[64:67], v[146:149], v[142:145], v[64:67]
 v_add_f32 v62, v54, v55
 v_fmac_f32 v62, v56, v26
 v_mfma_f32_16x16x32_bf16 v[68:71], v[130:133], v[138:141], 0
 buffer_load_dwordx2 v[116:117], v19, s[16:19], s80 offen sc1
 v_add_f32_dpp v62, v62, v62 row_ror:8 row_mask:0xf bank_mask:0xf
 v_mfma_f32_16x16x32_bf16 v[68:71], v[148:151], v[142:145], v[68:71]
 v_mov_b32 v63, v62
 s_cmp_lt_i32 s55, 0
 s_cbranch_scc1 fl_47
fl_48:
 v_mfma_f32_16x16x32_bf16 v[72:75], v[134:137], v[138:141], 0
 v_permlane32_swap_b32 v62, v63
 v_mfma_f32_16x16x32_bf16 v[72:75], v[150:153], v[142:145], v[72:75]
 v_add_f32 v62, v62, v63
 v_mov_b32 v63, v62
 ds_write_b128 v11, v[64:67] offset:0
 s_nop 0
 v_permlane16_swap_b32 v62, v63
 v_add_f32 v62, v62, v63
 v_rcp_f32 v62, v62
 ds_write_b128 v11, v[68:71] offset:1024
 s_mov_b64 exec, 0xff
 ds_write_b32 v22, v62
 s_mov_b64 exec, -1
 ds_write_b128 v11, v[72:75] offset:2048
 s_waitcnt lgkmcnt(0)
 s_barrier
 ds_read_b128 v[72:75], v23
 ds_read_b64 v[64:65], v12 offset:0
 ds_read_b64 v[66:67], v12 offset:3072
 ds_read_b64 v[68:69], v12 offset:6144
 ds_read_b64 v[70:71], v12 offset:9216
 s_waitcnt lgkmcnt(2)
 v_pk_mul_f32 v[64:65], v[64:65], v[72:73] op_sel_hi:[1,0]
 v_pk_fma_f32 v[64:65], v[66:67], v[72:73], v[64:65] op_sel:[0,1,0] op_sel_hi:[1,1,1]
 s_waitcnt lgkmcnt(0)
 v_pk_fma_f32 v[64:65], v[68:69], v[74:75], v[64:65] op_sel_hi:[1,0,1]
 v_pk_fma_f32 v[64:65], v[70:71], v[74:75], v[64:65] op_sel:[0,1,0] op_sel_hi:[1,1,1]
 v_cvt_pk_f16_f32 v68, v64, v65
 v_perm_b32 v68, s91, v68, v14
 buffer_atomic_pk_add_f16 v68, v13, s[4:7], s3 offen
 v_mov_b32 v76, v108
 v_mov_b32 v77, v109
 v_mov_b32 v78, v110
 v_mov_b32 v79, v111
 v_permlane32_swap_b32 v100, v104
 v_permlane32_swap_b32 v101, v105
 v_permlane32_swap_b32 v102, v106
 v_permlane32_swap_b32 v103, v107
 v_permlane32_swap_b32 v108, v76
 v_permlane32_swap_b32 v109, v77
 v_permlane32_swap_b32 v110, v78
 v_permlane32_swap_b32 v111, v79
 v_pk_add_f32 v[100:101], v[100:101], v[104:105]
 v_pk_add_f32 v[102:103], v[102:103], v[106:107]
 v_pk_add_f32 v[108:109], v[108:109], v[76:77]
 v_pk_add_f32 v[110:111], v[110:111], v[78:79]
 v_cvt_pk_bf16_f32 v80, v100, v101
 v_cvt_pk_bf16_f32 v82, v108, v109
 v_cvt_pk_bf16_f32 v81, v102, v103
 v_cvt_pk_bf16_f32 v83, v110, v111
 s_nop 0
 v_permlane16_swap_b32 v80, v82
 v_permlane16_swap_b32 v81, v83
 v_min_u32 v80, -2, v80
 s_mov_b64 exec, s[76:77]
 buffer_store_dwordx4 v[80:83], v15, s[24:27], s57 offen sc1
 s_mov_b64 exec, -1
 s_add_u32 s64, s64, 1310720
 s_add_u32 s52, s52, 1
 s_branch step_36
fl_41:
 buffer_load_dword v0, off, s[12:15], s79 sc1
 s_branch fl_42
A1_16:
 v_smfmac_f32_16x16x32_f16 v[40:43], v[36:37], a[16:19], v25
 v_smfmac_f32_16x16x32_f16 v[52:55], v[36:37], a[76:79], v25
 v_smfmac_f32_16x16x32_f16 v[44:47], v[36:37], a[36:39], v25
 v_smfmac_f32_16x16x32_f16 v[56:59], v[36:37], a[96:99], v25
 s_branch A2_40
pm_39:
 buffer_load_dwordx4 v[36:39], v4, s[4:7], s84 offen offset:2048 sc1
 buffer_load_dwordx4 v[28:31], v4, s[4:7], s84 offen offset:0 sc1
 buffer_load_dwordx4 v[32:35], v4, s[4:7], s84 offen offset:1024 sc1
 s_nop 7
 v_mov_b32 v40, 0
 v_mov_b32 v41, 0
 v_mov_b32 v42, 0
 v_mov_b32 v43, 0
 v_mov_b32 v52, 0
 v_mov_b32 v53, 0
 v_mov_b32 v54, 0
 v_mov_b32 v55, 0
 v_mov_b32 v44, 0
 v_mov_b32 v45, 0
 v_mov_b32 v46, 0
 v_mov_b32 v47, 0
 v_mov_b32 v56, 0
 v_mov_b32 v57, 0
 v_mov_b32 v58, 0
 v_mov_b32 v59, 0
 s_waitcnt vmcnt(0)
 v_bitop3_b32 v27, v31, v35, v39 bitop3:0x80
 v_perm_b32 v31, v35, v31, s89
 v_cmp_gt_u32 vcc, 0x48000000, v27
 v_mov_b32 v35, v38
 s_cbranch_vccz A1_16
pm_38:
 s_cmp_gt_u32 s52, 3
 s_cbranch_scc1 op_49
 v_readfirstlane_b32 s21, v0
 s_cmp_ge_u32 s21, s46
 s_cbranch_scc1 op_49
 buffer_load_dword v0, off, s[12:15], s79 sc1
 s_waitcnt vmcnt(0)
 v_readfirstlane_b32 s21, v0
 s_cmp_gt_u32 s21, s52
 s_cselect_b32 s21, s87, 0
 s_cmp_eq_u32 s21, 0
 s_cbranch_scc1 op_49
 s_mov_b32 s87, 0
 s_sub_u32 s21, s64, 1310720
 buffer_load_dwordx4 v[126:129], v16, s[28:31], s21 offen offset:0 sc1
 buffer_load_dwordx4 v[130:133], v16, s[28:31], s21 offen offset:1024 sc1
 buffer_load_dwordx4 v[134:137], v16, s[28:31], s21 offen offset:2048 sc1
op_49:
 buffer_load_dwordx4 v[36:39], v4, s[4:7], s84 offen offset:2048 sc1
 buffer_load_dwordx4 v[28:31], v4, s[4:7], s84 offen offset:0 sc1
 buffer_load_dwordx4 v[32:35], v4, s[4:7], s84 offen offset:1024 sc1
 s_add_u32 s54, s54, 1
 s_cmp_gt_u32 s54, 131072
 s_cbranch_scc1 end0
 s_waitcnt vmcnt(0)
 v_bitop3_b32 v27, v31, v35, v39 bitop3:0x80
 v_perm_b32 v31, v35, v31, s89
 v_cmp_gt_u32 vcc, 0x48000000, v27
 v_mov_b32 v35, v38
 s_cbranch_vccnz pm_38
 s_branch A1_16
psr_43:
 buffer_load_dwordx2 v[58:59], v9, s[8:11], s81 offen sc1
 buffer_load_dwordx4 v[40:43], v8, s[8:11], s81 offen offset:0 sc1
 buffer_load_dwordx4 v[44:47], v8, s[8:11], s81 offen offset:1024 sc1
 s_add_u32 s54, s54, 1
 s_cmp_gt_u32 s54, 131072
 s_cbranch_scc1 end0
 s_waitcnt vmcnt(2)
 v_xor_b32 v76, s88, v58
 s_nop 0
 v_permlane16_swap_b32 v58, v59
 v_fma_mix_f32 v60, v58, 1.0, v59 op_sel:[0,0,0] op_sel_hi:[1,0,1]
 v_fma_mix_f32 v61, v58, 1.0, v59 op_sel:[1,0,1] op_sel_hi:[1,0,1]
 v_mov_b32 v58, v60
 v_mov_b32 v59, v61
 s_nop 0
 v_permlane32_swap_b32 v58, v60
 v_permlane32_swap_b32 v59, v61
 v_add_f32 v52, v58, v60
 v_add_f32 v53, v59, v61
 v_max_f32 v79, v52, v53
 s_waitcnt vmcnt(0)
 v_pk_add_f16 v80, v40, v44
 v_pk_add_f16 v82, v42, v46
 v_pk_add_f16 v81, v41, v45
 v_pk_add_f16 v83, v43, v47
 v_permlane32_swap_b32 v80, v82
 v_bitop3_b32 v77, v40, v42, s88 bitop3:0x7e
 v_permlane32_swap_b32 v81, v83
 v_bitop3_b32 v78, v44, v46, s88 bitop3:0x7e
 v_fma_mix_f32 v48, v80, 1.0, v82 op_sel:[0,0,0] op_sel_hi:[1,0,1]
 v_or3_b32 v27, v76, v77, v78
 v_fma_mix_f32 v49, v80, 1.0, v82 op_sel:[1,0,1] op_sel_hi:[1,0,1]
 v_and_b32 v27, 1, v27
 v_fma_mix_f32 v50, v81, 1.0, v83 op_sel:[0,0,0] op_sel_hi:[1,0,1]
 v_cmp_ne_u32 vcc, 0, v27
 v_fma_mix_f32 v51, v81, 1.0, v83 op_sel:[1,0,1] op_sel_hi:[1,0,1]
 v_max3_f32 v62, v48, v49, v79
 s_cbranch_vccnz psr_43
 s_branch psj_44
kvw_45:
 s_mov_b32 s22, s87
 s_cmp_eq_u32 s52, 0
 s_cselect_b32 s55, 0, s55
 s_cselect_b32 s87, 1, 0
 s_cbranch_scc1 kvok_46
 v_mov_b32 v62, 0
 s_mov_b32 s101, 0
wf_50:
 buffer_load_dword v63, v62, s[12:15], s79 offen sc1
 s_add_u32 s101, s101, 1
 s_cmp_gt_u32 s101, 131072
 s_cbranch_scc1 end0
 s_waitcnt vmcnt(0)
 v_readfirstlane_b32 s100, v63
 s_cmp_ge_u32 s100, s46
 s_cbranch_scc1 wf_51
 s_sleep 3
 s_branch wf_50
wf_51:
 s_cmp_eq_u32 s22, 0
 s_cbranch_scc1 kvok_46
 s_sub_u32 s21, s64, 1310720
 buffer_load_dwordx4 v[126:129], v16, s[28:31], s21 offen offset:0 sc1
 buffer_load_dwordx4 v[130:133], v16, s[28:31], s21 offen offset:1024 sc1
 buffer_load_dwordx4 v[134:137], v16, s[28:31], s21 offen offset:2048 sc1
 s_waitcnt vmcnt(0)
 s_branch kvok_46
fl_47:
 buffer_load_dword v0, off, s[12:15], s79 sc1
 s_branch fl_48
last_37:
 s_waitcnt lgkmcnt(10)
 v_smfmac_f32_16x16x64_f16 v[100:103], v[28:31], a[120:127], v25
 v_smfmac_f32_16x16x64_f16 v[104:107], v[28:31], a[128:135], v25
 v_smfmac_f32_16x16x64_f16 v[108:111], v[28:31], a[136:143], v25
 v_smfmac_f32_16x16x64_f16 v[100:103], v[32:35], a[144:151], v25
 v_smfmac_f32_16x16x64_f16 v[104:107], v[32:35], a[152:159], v25
 v_smfmac_f32_16x16x64_f16 v[108:111], v[32:35], a[160:167], v25
 s_waitcnt lgkmcnt(7)
 v_smfmac_f32_16x16x64_f16 v[100:103], v[64:67], a[168:175], v25
 v_smfmac_f32_16x16x64_f16 v[104:107], v[64:67], a[176:183], v25
 v_smfmac_f32_16x16x64_f16 v[108:111], v[64:67], a[184:191], v25
 v_smfmac_f32_16x16x64_f16 v[100:103], v[68:71], a[192:199], v25
 v_smfmac_f32_16x16x64_f16 v[104:107], v[68:71], a[200:207], v25
 v_smfmac_f32_16x16x64_f16 v[108:111], v[68:71], a[208:215], v25
 v_smfmac_f32_16x16x64_f16 v[100:103], v[72:75], a[216:223], v25
 v_smfmac_f32_16x16x64_f16 v[104:107], v[72:75], a[224:231], v25
 v_smfmac_f32_16x16x64_f16 v[108:111], v[72:75], a[232:239], v25
 s_waitcnt lgkmcnt(4)
 v_smfmac_f32_16x16x64_f16 v[100:103], v[76:79], a[240:247], v25
 v_smfmac_f32_16x16x64_f16 v[104:107], v[76:79], a[248:255], v25
 v_smfmac_f32_16x16x64_f16 v[108:111], v[76:79], v[152:159], v25
 v_smfmac_f32_16x16x64_f16 v[100:103], v[80:83], v[160:167], v25
 v_smfmac_f32_16x16x64_f16 v[104:107], v[80:83], v[168:175], v25
 v_smfmac_f32_16x16x64_f16 v[108:111], v[80:83], v[176:183], v25
 v_smfmac_f32_16x16x64_f16 v[100:103], v[84:87], v[184:191], v25
 v_smfmac_f32_16x16x64_f16 v[104:107], v[84:87], v[192:199], v25
 v_smfmac_f32_16x16x64_f16 v[108:111], v[84:87], v[200:207], v25
 s_waitcnt lgkmcnt(0)
 v_smfmac_f32_16x16x64_f16 v[100:103], v[88:91], v[208:215], v25
 v_smfmac_f32_16x16x64_f16 v[104:107], v[88:91], v[216:223], v25
 v_smfmac_f32_16x16x64_f16 v[108:111], v[88:91], v[224:231], v25
 v_smfmac_f32_16x16x64_f16 v[100:103], v[92:95], v[232:239], v25
 v_smfmac_f32_16x16x64_f16 v[104:107], v[92:95], v[240:247], v25
 v_smfmac_f32_16x16x64_f16 v[108:111], v[92:95], v[248:255], v25
 s_nop 7
 v_mov_b32 v76, v108
 v_mov_b32 v77, v109
 v_mov_b32 v78, v110
 v_mov_b32 v79, v111
 v_permlane32_swap_b32 v100, v104
 v_permlane32_swap_b32 v101, v105
 v_permlane32_swap_b32 v102, v106
 v_permlane32_swap_b32 v103, v107
 v_permlane32_swap_b32 v108, v76
 v_permlane32_swap_b32 v109, v77
 v_permlane32_swap_b32 v110, v78
 v_permlane32_swap_b32 v111, v79
 v_pk_add_f32 v[100:101], v[100:101], v[104:105]
 v_pk_add_f32 v[102:103], v[102:103], v[106:107]
 v_pk_add_f32 v[108:109], v[108:109], v[76:77]
 v_pk_add_f32 v[110:111], v[110:111], v[78:79]
 v_cvt_pk_bf16_f32 v80, v100, v101
 v_cvt_pk_bf16_f32 v82, v108, v109
 v_cvt_pk_bf16_f32 v81, v102, v103
 v_cvt_pk_bf16_f32 v83, v110, v111
 s_nop 0
 v_permlane16_swap_b32 v80, v82
 v_permlane16_swap_b32 v81, v83
 v_min_u32 v80, -2, v80
 s_mov_b64 exec, s[76:77]
 buffer_store_dwordx4 v[80:83], v15, s[24:27], s57 offen sc1
 s_mov_b64 exec, -1
 s_branch chain_done
step_52:
 s_and_b32 s21, s52, 3
 s_mul_i32 s81, s21, 540672
 s_mul_i32 s84, s21, 0x88000
 s_and_b32 s84, s84, 0x108000
 s_add_u32 s21, s52, 3
 s_and_b32 s21, s21, 3
 s_mul_i32 s83, s21, 0x88000
 s_and_b32 s83, s83, 0x108000
 s_add_u32 s21, s52, 1
 s_and_b32 s22, s21, 3
 s_mul_i32 s3, s22, 0x88000
 s_and_b32 s3, s3, 0x108000
 s_mul_i32 s80, s21, 393216
 s_add_u32 s46, s21, 1
 s_min_u32 s46, s46, 64
 s_mov_b32 s47, s57
 s_mov_b32 s78, s85
 s_lshr_b32 s21, s52, 1
 s_bitcmp1_b32 s37, s21
 s_cselect_b32 s21, 8192, 0
 s_lshl_b32 s22, s52, 20
 s_or_b32 s22, s22, s21
 s_cmp_ge_u32 s52, 40
 s_cselect_b32 s57, 8192, 0
 s_xor_b32 s57, s57, s22
 s_xor_b32 s85, s22, 8192
 s_bfe_u32 s88, s52, 0x10002
 s_max_u32 s67, s52, 1
 s_sub_u32 s67, s67, 1
 v_mov_b32 v40, 0
 v_mov_b32 v41, 0
 v_mov_b32 v42, 0
 v_mov_b32 v43, 0
 v_mov_b32 v44, 0
 v_mov_b32 v45, 0
 v_mov_b32 v46, 0
 v_mov_b32 v47, 0
 v_mov_b32 v48, 0
 v_mov_b32 v49, 0
 v_mov_b32 v50, 0
 v_mov_b32 v51, 0
 v_mov_b32 v52, 0
 v_mov_b32 v53, 0
 v_mov_b32 v54, 0
 v_mov_b32 v55, 0
 v_mov_b32 v56, 0
 v_mov_b32 v57, 0
 v_mov_b32 v58, 0
 v_mov_b32 v59, 0
 v_mov_b32 v60, 0
 v_mov_b32 v61, 0
 v_mov_b32 v62, 0
 v_mov_b32 v63, 0
 v_mov_b32 v100, 0
 v_mov_b32 v101, 0
 v_mov_b32 v102, 0
 v_mov_b32 v103, 0
 v_mov_b32 v104, 0
 v_mov_b32 v105, 0
 v_mov_b32 v106, 0
 v_mov_b32 v107, 0
 v_mov_b32 v108, 0
 v_mov_b32 v109, 0
 v_mov_b32 v110, 0
 v_mov_b32 v111, 0
 s_sleep 3
 s_nop 7
 v_readfirstlane_b32 s21, v0
 s_cmp_lt_u32 s21, s46
 s_cselect_b32 s55, s55, 0
 s_cmp_lt_i32 s55, 0
 s_cbranch_scc1 fl_57
fl_58:
 s_mov_b32 s54, 0
 buffer_load_dwordx4 v[36:39], v4, s[4:7], s84 offen offset:2048 sc1
 buffer_load_dwordx4 v[28:31], v4, s[4:7], s84 offen offset:0 sc1
 buffer_load_dwordx4 v[32:35], v4, s[4:7], s84 offen offset:1024 sc1
 s_waitcnt vmcnt(3)
 v_mov_b32 v126, v88
 v_mov_b32 v127, v89
 v_mov_b32 v128, v90
 v_mov_b32 v129, v91
 v_mov_b32 v130, v92
 v_mov_b32 v131, v93
 v_mov_b32 v132, v94
 v_mov_b32 v133, v95
 v_mov_b32 v134, v96
 v_mov_b32 v135, v97
 v_mov_b32 v136, v98
 v_mov_b32 v137, v99
 s_waitcnt vmcnt(2)
 v_smfmac_f32_16x16x32_f16 v[40:43], v[36:37], a[16:19], v25
 v_smfmac_f32_16x16x32_f16 v[52:55], v[36:37], a[76:79], v25
 v_smfmac_f32_16x16x32_f16 v[44:47], v[36:37], a[36:39], v25
 s_waitcnt vmcnt(0)
 v_bitop3_b32 v27, v31, v35, v39 bitop3:0x80
 v_perm_b32 v31, v35, v31, s89
 v_cmp_gt_u32 vcc, 0x48000000, v27
 v_mov_b32 v35, v38
 v_smfmac_f32_16x16x32_f16 v[56:59], v[36:37], a[96:99], v25
 s_cbranch_vccnz pm_55
A2_56:
 v_smfmac_f32_16x16x64_f16 v[40:43], v[28:31], a[0:7], v25
 ds_write_b128 v10, v[28:31]
 v_smfmac_f32_16x16x64_f16 v[40:43], v[32:35], a[8:15], v25
 ds_write_b128 v10, v[32:35] offset:1024
 v_smfmac_f32_16x16x64_f16 v[52:55], v[28:31], a[60:67], v25
 ds_write_b64 v10, v[36:37] offset:2048
 v_smfmac_f32_16x16x64_f16 v[52:55], v[32:35], a[68:75], v25
 v_cvt_pk_f16_f32 v40, v40, v41
 v_cvt_pk_f16_f32 v41, v42, v43
 v_smfmac_f32_16x16x32_f16 v[48:51], v[36:37], a[56:59], v25
 v_smfmac_f32_16x16x32_f16 v[60:63], v[36:37], a[116:119], v25
 v_smfmac_f32_16x16x64_f16 v[44:47], v[28:31], a[20:27], v25
 v_cvt_pk_f16_f32 v52, v52, v53
 v_cvt_pk_f16_f32 v53, v54, v55
 s_nop 0
 v_smfmac_f32_16x16x64_f16 v[44:47], v[32:35], a[28:35], v25
 v_permlane32_swap_b32 v40, v52
 v_smfmac_f32_16x16x64_f16 v[56:59], v[28:31], a[80:87], v25
 v_permlane32_swap_b32 v41, v53
 v_pk_add_f16 v40, v40, v52
 v_smfmac_f32_16x16x64_f16 v[56:59], v[32:35], a[88:95], v25
 v_pk_add_f16 v41, v41, v53
 v_smfmac_f32_16x16x64_f16 v[48:51], v[28:31], a[40:47], v25
 ds_write_b64 v5, v[40:41] offset:0
 v_smfmac_f32_16x16x64_f16 v[48:51], v[32:35], a[48:55], v25
 v_cvt_pk_f16_f32 v44, v44, v45
 v_cvt_pk_f16_f32 v45, v46, v47
 v_cvt_pk_f16_f32 v56, v56, v57
 v_smfmac_f32_16x16x64_f16 v[60:63], v[28:31], a[100:107], v25
 v_cvt_pk_f16_f32 v57, v58, v59
 s_nop 0
 v_smfmac_f32_16x16x64_f16 v[60:63], v[32:35], a[108:115], v25
 v_permlane32_swap_b32 v44, v56
 v_permlane32_swap_b32 v45, v57
 v_pk_add_f16 v44, v44, v56
 v_pk_add_f16 v45, v45, v57
 ds_write_b64 v5, v[44:45] offset:640
 v_cvt_pk_f16_f32 v48, v48, v49
 v_cvt_pk_f16_f32 v49, v50, v51
 v_cvt_pk_f16_f32 v60, v60, v61
 v_cvt_pk_f16_f32 v61, v62, v63
 s_nop 0
 v_permlane32_swap_b32 v48, v60
 v_permlane32_swap_b32 v49, v61
 v_pk_add_f16 v48, v48, v60
 v_pk_add_f16 v49, v49, v61
 ds_write_b64 v5, v[48:49] offset:1280
 s_waitcnt lgkmcnt(0) vmcnt(0)
 s_barrier
 ds_read_b64_tr_b16 v[40:41], v6 offset:0
 ds_read_b64_tr_b16 v[42:43], v6 offset:1920
 ds_read_b64_tr_b16 v[44:45], v6 offset:3840
 ds_read_b64_tr_b16 v[46:47], v6 offset:5760
 ds_read_b64_tr_b16 v[48:49], v6 offset:640
 ds_read_b64_tr_b16 v[50:51], v6 offset:2560
 ds_read_b64_tr_b16 v[52:53], v6 offset:4480
 ds_read_b64_tr_b16 v[54:55], v6 offset:6400
 ds_read_b64_tr_b16 v[56:57], v6 offset:1280
 ds_read_b64_tr_b16 v[58:59], v6 offset:3200
 ds_read_b64_tr_b16 v[60:61], v6 offset:5120
 ds_read_b64_tr_b16 v[62:63], v6 offset:7040
 s_waitcnt lgkmcnt(8)
 v_pk_add_f16 v40, v40, v42
 v_pk_add_f16 v44, v44, v46
 v_pk_add_f16 v41, v41, v43
 v_pk_add_f16 v45, v45, v47
 v_fma_mix_f32 v146, v40, 1.0, v44 op_sel:[0,0,0] op_sel_hi:[1,0,1]
 v_fma_mix_f32 v147, v40, 1.0, v44 op_sel:[1,0,1] op_sel_hi:[1,0,1]
 v_fma_mix_f32 v148, v41, 1.0, v45 op_sel:[0,0,0] op_sel_hi:[1,0,1]
 v_fma_mix_f32 v149, v41, 1.0, v45 op_sel:[1,0,1] op_sel_hi:[1,0,1]
 v_cvt_pk_bf16_f32 v118, v146, v147
 v_cvt_pk_bf16_f32 v119, v148, v149
 s_waitcnt lgkmcnt(4)
 v_pk_add_f16 v48, v48, v50
 v_pk_add_f16 v52, v52, v54
 v_pk_add_f16 v49, v49, v51
 v_pk_add_f16 v53, v53, v55
 v_fma_mix_f32 v146, v48, 1.0, v52 op_sel:[0,0,0] op_sel_hi:[1,0,1]
 v_fma_mix_f32 v147, v48, 1.0, v52 op_sel:[1,0,1] op_sel_hi:[1,0,1]
 v_fma_mix_f32 v148, v49, 1.0, v53 op_sel:[0,0,0] op_sel_hi:[1,0,1]
 v_fma_mix_f32 v149, v49, 1.0, v53 op_sel:[1,0,1] op_sel_hi:[1,0,1]
 v_cvt_pk_bf16_f32 v120, v146, v147
 v_cvt_pk_bf16_f32 v121, v148, v149
 s_waitcnt lgkmcnt(0)
 v_pk_add_f16 v56, v56, v58
 v_pk_add_f16 v60, v60, v62
 v_pk_add_f16 v57, v57, v59
 v_pk_add_f16 v61, v61, v63
 v_fma_mix_f32 v146, v56, 1.0, v60 op_sel:[0,0,0] op_sel_hi:[1,0,1]
 v_fma_mix_f32 v147, v56, 1.0, v60 op_sel:[1,0,1] op_sel_hi:[1,0,1]
 v_mfma_f32_16x16x32_bf16 v[40:43], v[118:121], v[118:121], 0
 v_fma_mix_f32 v148, v57, 1.0, v61 op_sel:[0,0,0] op_sel_hi:[1,0,1]
 v_fma_mix_f32 v149, v57, 1.0, v61 op_sel:[1,0,1] op_sel_hi:[1,0,1]
 v_cvt_pk_bf16_f32 v122, v146, v147
 v_cvt_pk_bf16_f32 v123, v148, v149
 s_nop 1
 v_mfma_f32_16x16x32_bf16 v[40:43], v[122:125], v[122:125], v[40:43]
 ds_read_b128 v[28:31], v16 offset:24576
 ds_read_b128 v[32:35], v16 offset:25600
 ds_read_b128 v[64:67], v16 offset:27648
 ds_read_b128 v[68:71], v16 offset:28672
 ds_read_b128 v[72:75], v16 offset:30720
 ds_read_b128 v[76:79], v16 offset:31744
 s_nop 0
 s_mov_b64 exec, s[74:75]
 v_cvt_pk_f16_f32 v44, v40, v41
 v_cvt_pk_f16_f32 v45, v42, v43
 v_and_or_b32 v44, v44, -2, s88
 buffer_store_dwordx2 v[44:45], v7, s[8:11], s81 offen
 s_mov_b64 exec, -1
 ds_read_b128 v[80:83], v16 offset:33792
 ds_read_b128 v[84:87], v16 offset:34816
 ds_read_b64 v[88:89], v16 offset:26624
 ds_read_b64 v[90:91], v16 offset:29696
 ds_read_b64 v[92:93], v16 offset:32768
 ds_read_b64 v[94:95], v16 offset:35840
 s_cmp_eq_u32 s52, 63
 s_cbranch_scc1 last_53
 s_waitcnt lgkmcnt(10)
 v_smfmac_f32_16x16x64_f16 v[100:103], v[28:31], a[120:127], v25
 v_smfmac_f32_16x16x64_f16 v[104:107], v[28:31], a[128:135], v25
 v_smfmac_f32_16x16x64_f16 v[108:111], v[28:31], a[136:143], v25
 s_mov_b32 s54, 0
 v_smfmac_f32_16x16x64_f16 v[100:103], v[32:35], a[144:151], v25
 v_readfirstlane_b32 s21, v0
 v_smfmac_f32_16x16x64_f16 v[104:107], v[32:35], a[152:159], v25
 s_add_u32 s22, s46, 3
 v_smfmac_f32_16x16x64_f16 v[108:111], v[32:35], a[160:167], v25
 s_min_u32 s22, s22, 64
 s_waitcnt lgkmcnt(7)
 v_smfmac_f32_16x16x64_f16 v[100:103], v[64:67], a[168:175], v25
 s_sub_u32 s55, s21, s22
 v_smfmac_f32_16x16x64_f16 v[104:107], v[64:67], a[176:183], v25
 s_sub_u32 s56, s21, s46
 v_smfmac_f32_16x16x64_f16 v[108:111], v[64:67], a[184:191], v25
 v_smfmac_f32_16x16x64_f16 v[100:103], v[68:71], a[192:199], v25
 v_smfmac_f32_16x16x64_f16 v[104:107], v[68:71], a[200:207], v25
 v_smfmac_f32_16x16x64_f16 v[108:111], v[68:71], a[208:215], v25
 v_smfmac_f32_16x16x64_f16 v[100:103], v[72:75], a[216:223], v25
 v_smfmac_f32_16x16x64_f16 v[104:107], v[72:75], a[224:231], v25
 v_smfmac_f32_16x16x64_f16 v[108:111], v[72:75], a[232:239], v25
 s_waitcnt lgkmcnt(4)
 v_smfmac_f32_16x16x64_f16 v[100:103], v[76:79], a[240:247], v25
 v_smfmac_f32_16x16x64_f16 v[104:107], v[76:79], a[248:255], v25
 buffer_load_dwordx2 v[58:59], v9, s[8:11], s81 offen sc1
 buffer_load_dwordx4 v[40:43], v8, s[8:11], s81 offen offset:0 sc1
 buffer_load_dwordx4 v[44:47], v8, s[8:11], s81 offen offset:1024 sc1
 v_smfmac_f32_16x16x64_f16 v[108:111], v[76:79], v[152:159], v25
 v_smfmac_f32_16x16x64_f16 v[100:103], v[80:83], v[160:167], v25
 v_smfmac_f32_16x16x64_f16 v[104:107], v[80:83], v[168:175], v25
 v_smfmac_f32_16x16x64_f16 v[108:111], v[80:83], v[176:183], v25
 v_smfmac_f32_16x16x64_f16 v[100:103], v[84:87], v[184:191], v25
 v_smfmac_f32_16x16x64_f16 v[104:107], v[84:87], v[192:199], v25
 v_smfmac_f32_16x16x64_f16 v[108:111], v[84:87], v[200:207], v25
 s_waitcnt lgkmcnt(0)
 v_smfmac_f32_16x16x64_f16 v[100:103], v[88:91], v[208:215], v25
 v_smfmac_f32_16x16x64_f16 v[104:107], v[88:91], v[216:223], v25
 v_smfmac_f32_16x16x64_f16 v[108:111], v[88:91], v[224:231], v25
 v_smfmac_f32_16x16x64_f16 v[100:103], v[92:95], v[232:239], v25
 v_smfmac_f32_16x16x64_f16 v[104:107], v[92:95], v[240:247], v25
 v_smfmac_f32_16x16x64_f16 v[108:111], v[92:95], v[248:255], v25
 s_cmp_lt_i32 s56, 0
 s_cbranch_scc1 kvw_61
kvok_62:
 s_waitcnt vmcnt(2)
 v_xor_b32 v76, s88, v58
 s_nop 0
 v_permlane16_swap_b32 v58, v59
 v_fma_mix_f32 v60, v58, 1.0, v59 op_sel:[0,0,0] op_sel_hi:[1,0,1]
 v_fma_mix_f32 v61, v58, 1.0, v59 op_sel:[1,0,1] op_sel_hi:[1,0,1]
 v_mov_b32 v58, v60
 v_mov_b32 v59, v61
 s_nop 0
 v_permlane32_swap_b32 v58, v60
 v_permlane32_swap_b32 v59, v61
 v_add_f32 v52, v58, v60
 v_add_f32 v53, v59, v61
 v_max_f32 v79, v52, v53
 s_waitcnt vmcnt(0)
 v_pk_add_f16 v80, v40, v44
 v_pk_add_f16 v82, v42, v46
 v_pk_add_f16 v81, v41, v45
 v_pk_add_f16 v83, v43, v47
 v_permlane32_swap_b32 v80, v82
 v_bitop3_b32 v77, v40, v42, s88 bitop3:0x7e
 v_permlane32_swap_b32 v81, v83
 v_bitop3_b32 v78, v44, v46, s88 bitop3:0x7e
 v_fma_mix_f32 v48, v80, 1.0, v82 op_sel:[0,0,0] op_sel_hi:[1,0,1]
 v_or3_b32 v27, v76, v77, v78
 v_fma_mix_f32 v49, v80, 1.0, v82 op_sel:[1,0,1] op_sel_hi:[1,0,1]
 v_and_b32 v27, 1, v27
 v_fma_mix_f32 v50, v81, 1.0, v83 op_sel:[0,0,0] op_sel_hi:[1,0,1]
 v_cmp_ne_u32 vcc, 0, v27
 v_fma_mix_f32 v51, v81, 1.0, v83 op_sel:[1,0,1] op_sel_hi:[1,0,1]
 v_max3_f32 v62, v48, v49, v79
 s_cbranch_vccnz psr_59
psj_60:
 v_max3_f32 v62, v62, v50, v51
 v_cvt_pk_bf16_f32 v146, v100, v101
 v_cvt_pk_bf16_f32 v147, v102, v103
 v_max_f32_dpp v62, v62, v62 row_ror:8 row_mask:0xf bank_mask:0xf
 v_mov_b32 v63, v62
 v_cvt_pk_bf16_f32 v148, v104, v105
 v_cvt_pk_bf16_f32 v149, v106, v107
 v_permlane32_swap_b32 v62, v63
 v_max_f32 v62, v62, v63
 v_mov_b32 v63, v62
 v_cvt_pk_bf16_f32 v150, v108, v109
 v_cvt_pk_bf16_f32 v151, v110, v111
 v_permlane16_swap_b32 v62, v63
 v_max_f32 v62, v62, v63
 v_mul_f32 v62, s86, v62
 v_fma_f32 v48, v48, s86, -v62
 v_fma_f32 v49, v49, s86, -v62
 v_fma_f32 v50, v50, s86, -v62
 v_fma_f32 v51, v51, s86, -v62
 v_fma_f32 v52, v52, s86, -v62
 v_fma_f32 v53, v53, s86, -v62
 v_exp_f32 v48, v48
 v_exp_f32 v49, v49
 buffer_load_dwordx4 v[88:91], v17, s[28:31], s64 offen offset:0 sc1
 v_exp_f32 v50, v50
 v_exp_f32 v51, v51
 buffer_load_dwordx4 v[92:95], v16, s[28:31], s64 offen offset:1024 sc1
 v_exp_f32 v52, v52
 v_exp_f32 v53, v53
 buffer_load_dwordx4 v[96:99], v20, s[28:31], s64 offen offset:2048 sc1
 v_cvt_pk_bf16_f32 v138, v48, v49
 v_cvt_pk_bf16_f32 v139, v50, v51
 v_cvt_pk_bf16_f32 v142, v52, v53
 v_mov_b32_dpp v140, v138 row_ror:8 row_mask:0xf bank_mask:0xf
 v_mov_b32_dpp v141, v139 row_ror:8 row_mask:0xf bank_mask:0xf
 v_mov_b32_dpp v143, v142 row_ror:8 row_mask:0xf bank_mask:0xf
 v_add_f32 v54, v48, v49
 v_mfma_f32_16x16x32_bf16 v[64:67], v[126:129], v[138:141], 0
 v_add_f32 v55, v50, v51
 v_add_f32 v56, v52, v53
 v_mfma_f32_16x16x32_bf16 v[64:67], v[146:149], v[142:145], v[64:67]
 v_add_f32 v62, v54, v55
 v_fmac_f32 v62, v56, v26
 v_mfma_f32_16x16x32_bf16 v[68:71], v[130:133], v[138:141], 0
 s_nop 0
 v_add_f32_dpp v62, v62, v62 row_ror:8 row_mask:0xf bank_mask:0xf
 v_mfma_f32_16x16x32_bf16 v[68:71], v[148:151], v[142:145], v[68:71]
 v_mov_b32 v63, v62
 s_cmp_lt_i32 s55, 0
 s_cbranch_scc1 fl_63
fl_64:
 v_mfma_f32_16x16x32_bf16 v[72:75], v[134:137], v[138:141], 0
 v_permlane32_swap_b32 v62, v63
 v_mfma_f32_16x16x32_bf16 v[72:75], v[150:153], v[142:145], v[72:75]
 v_add_f32 v62, v62, v63
 v_mov_b32 v63, v62
 ds_write_b128 v11, v[64:67] offset:0
 s_nop 0
 v_permlane16_swap_b32 v62, v63
 v_add_f32 v62, v62, v63
 v_rcp_f32 v62, v62
 ds_write_b128 v11, v[68:71] offset:1024
 s_mov_b64 exec, 0xff
 ds_write_b32 v22, v62
 s_mov_b64 exec, -1
 ds_write_b128 v11, v[72:75] offset:2048
 s_waitcnt lgkmcnt(0)
 s_barrier
 ds_read_b128 v[72:75], v23
 ds_read_b64 v[64:65], v12 offset:0
 ds_read_b64 v[66:67], v12 offset:3072
 ds_read_b64 v[68:69], v12 offset:6144
 ds_read_b64 v[70:71], v12 offset:9216
 s_waitcnt lgkmcnt(2)
 v_pk_mul_f32 v[64:65], v[64:65], v[72:73] op_sel_hi:[1,0]
 v_pk_fma_f32 v[64:65], v[66:67], v[72:73], v[64:65] op_sel:[0,1,0] op_sel_hi:[1,1,1]
 s_waitcnt lgkmcnt(0)
 v_pk_fma_f32 v[64:65], v[68:69], v[74:75], v[64:65] op_sel_hi:[1,0,1]
 v_pk_fma_f32 v[64:65], v[70:71], v[74:75], v[64:65] op_sel:[0,1,0] op_sel_hi:[1,1,1]
 v_cvt_pk_f16_f32 v68, v64, v65
 v_perm_b32 v68, s91, v68, v14
 buffer_atomic_pk_add_f16 v68, v13, s[4:7], s3 offen
 s_mov_b64 exec, s[62:63]
 buffer_store_dwordx4 v[118:121], v18, s[24:27], s85 offen sc1
 buffer_store_dwordx2 v[122:123], v19, s[24:27], s85 offen sc1
 s_mov_b64 exec, -1
 v_mov_b32 v76, v108
 v_mov_b32 v77, v109
 v_mov_b32 v78, v110
 v_mov_b32 v79, v111
 v_permlane32_swap_b32 v100, v104
 v_permlane32_swap_b32 v101, v105
 v_permlane32_swap_b32 v102, v106
 v_permlane32_swap_b32 v103, v107
 v_permlane32_swap_b32 v108, v76
 v_permlane32_swap_b32 v109, v77
 v_permlane32_swap_b32 v110, v78
 v_permlane32_swap_b32 v111, v79
 v_pk_add_f32 v[100:101], v[100:101], v[104:105]
 v_pk_add_f32 v[102:103], v[102:103], v[106:107]
 v_pk_add_f32 v[108:109], v[108:109], v[76:77]
 v_pk_add_f32 v[110:111], v[110:111], v[78:79]
 v_cvt_pk_bf16_f32 v80, v100, v101
 v_cvt_pk_bf16_f32 v82, v108, v109
 v_cvt_pk_bf16_f32 v81, v102, v103
 v_cvt_pk_bf16_f32 v83, v110, v111
 s_nop 0
 v_permlane16_swap_b32 v80, v82
 v_permlane16_swap_b32 v81, v83
 v_min_u32 v80, -2, v80
 s_mov_b64 exec, s[76:77]
 buffer_store_dwordx4 v[80:83], v15, s[24:27], s57 offen sc1
 s_mov_b64 exec, -1
 s_add_u32 s64, s64, 1310720
 s_add_u32 s52, s52, 1
 s_branch step_52
fl_57:
 buffer_load_dword v0, off, s[12:15], s79 sc1
 s_branch fl_58
A1_17:
 v_smfmac_f32_16x16x32_f16 v[40:43], v[36:37], a[16:19], v25
 v_smfmac_f32_16x16x32_f16 v[52:55], v[36:37], a[76:79], v25
 v_smfmac_f32_16x16x32_f16 v[44:47], v[36:37], a[36:39], v25
 v_smfmac_f32_16x16x32_f16 v[56:59], v[36:37], a[96:99], v25
 s_branch A2_56
pm_55:
 buffer_load_dwordx4 v[36:39], v4, s[4:7], s84 offen offset:2048 sc1
 buffer_load_dwordx4 v[28:31], v4, s[4:7], s84 offen offset:0 sc1
 buffer_load_dwordx4 v[32:35], v4, s[4:7], s84 offen offset:1024 sc1
 s_nop 7
 v_mov_b32 v40, 0
 v_mov_b32 v41, 0
 v_mov_b32 v42, 0
 v_mov_b32 v43, 0
 v_mov_b32 v52, 0
 v_mov_b32 v53, 0
 v_mov_b32 v54, 0
 v_mov_b32 v55, 0
 v_mov_b32 v44, 0
 v_mov_b32 v45, 0
 v_mov_b32 v46, 0
 v_mov_b32 v47, 0
 v_mov_b32 v56, 0
 v_mov_b32 v57, 0
 v_mov_b32 v58, 0
 v_mov_b32 v59, 0
 s_waitcnt vmcnt(0)
 v_bitop3_b32 v27, v31, v35, v39 bitop3:0x80
 v_perm_b32 v31, v35, v31, s89
 v_cmp_gt_u32 vcc, 0x48000000, v27
 v_mov_b32 v35, v38
 s_cbranch_vccz A1_17
pm_54:
 s_cmp_gt_u32 s52, 3
 s_cbranch_scc1 op_65
 v_readfirstlane_b32 s21, v0
 s_cmp_ge_u32 s21, s46
 s_cbranch_scc1 op_65
 buffer_load_dword v0, off, s[12:15], s79 sc1
 s_waitcnt vmcnt(0)
 v_readfirstlane_b32 s21, v0
 s_cmp_gt_u32 s21, s52
 s_cselect_b32 s21, s87, 0
 s_cmp_eq_u32 s21, 0
 s_cbranch_scc1 op_65
 s_mov_b32 s87, 0
 s_sub_u32 s21, s64, 1310720
 buffer_load_dwordx4 v[126:129], v16, s[28:31], s21 offen offset:0 sc1
 buffer_load_dwordx4 v[130:133], v16, s[28:31], s21 offen offset:1024 sc1
 buffer_load_dwordx4 v[134:137], v16, s[28:31], s21 offen offset:2048 sc1
op_65:
 buffer_load_dwordx4 v[36:39], v4, s[4:7], s84 offen offset:2048 sc1
 buffer_load_dwordx4 v[28:31], v4, s[4:7], s84 offen offset:0 sc1
 buffer_load_dwordx4 v[32:35], v4, s[4:7], s84 offen offset:1024 sc1
 s_add_u32 s54, s54, 1
 s_cmp_gt_u32 s54, 131072
 s_cbranch_scc1 end0
 s_waitcnt vmcnt(0)
 v_bitop3_b32 v27, v31, v35, v39 bitop3:0x80
 v_perm_b32 v31, v35, v31, s89
 v_cmp_gt_u32 vcc, 0x48000000, v27
 v_mov_b32 v35, v38
 s_cbranch_vccnz pm_54
 s_branch A1_17
psr_59:
 buffer_load_dwordx2 v[58:59], v9, s[8:11], s81 offen sc1
 buffer_load_dwordx4 v[40:43], v8, s[8:11], s81 offen offset:0 sc1
 buffer_load_dwordx4 v[44:47], v8, s[8:11], s81 offen offset:1024 sc1
 s_add_u32 s54, s54, 1
 s_cmp_gt_u32 s54, 131072
 s_cbranch_scc1 end0
 s_waitcnt vmcnt(2)
 v_xor_b32 v76, s88, v58
 s_nop 0
 v_permlane16_swap_b32 v58, v59
 v_fma_mix_f32 v60, v58, 1.0, v59 op_sel:[0,0,0] op_sel_hi:[1,0,1]
 v_fma_mix_f32 v61, v58, 1.0, v59 op_sel:[1,0,1] op_sel_hi:[1,0,1]
 v_mov_b32 v58, v60
 v_mov_b32 v59, v61
 s_nop 0
 v_permlane32_swap_b32 v58, v60
 v_permlane32_swap_b32 v59, v61
 v_add_f32 v52, v58, v60
 v_add_f32 v53, v59, v61
 v_max_f32 v79, v52, v53
 s_waitcnt vmcnt(0)
 v_pk_add_f16 v80, v40, v44
 v_pk_add_f16 v82, v42, v46
 v_pk_add_f16 v81, v41, v45
 v_pk_add_f16 v83, v43, v47
 v_permlane32_swap_b32 v80, v82
 v_bitop3_b32 v77, v40, v42, s88 bitop3:0x7e
 v_permlane32_swap_b32 v81, v83
 v_bitop3_b32 v78, v44, v46, s88 bitop3:0x7e
 v_fma_mix_f32 v48, v80, 1.0, v82 op_sel:[0,0,0] op_sel_hi:[1,0,1]
 v_or3_b32 v27, v76, v77, v78
 v_fma_mix_f32 v49, v80, 1.0, v82 op_sel:[1,0,1] op_sel_hi:[1,0,1]
 v_and_b32 v27, 1, v27
 v_fma_mix_f32 v50, v81, 1.0, v83 op_sel:[0,0,0] op_sel_hi:[1,0,1]
 v_cmp_ne_u32 vcc, 0, v27
 v_fma_mix_f32 v51, v81, 1.0, v83 op_sel:[1,0,1] op_sel_hi:[1,0,1]
 v_max3_f32 v62, v48, v49, v79
 s_cbranch_vccnz psr_59
 s_branch psj_60
kvw_61:
 s_mov_b32 s22, s87
 s_cmp_eq_u32 s52, 0
 s_cselect_b32 s55, 0, s55
 s_cselect_b32 s87, 1, 0
 s_cbranch_scc1 kvok_62
 v_mov_b32 v62, 0
 s_mov_b32 s101, 0
wf_66:
 buffer_load_dword v63, v62, s[12:15], s79 offen sc1
 s_add_u32 s101, s101, 1
 s_cmp_gt_u32 s101, 131072
 s_cbranch_scc1 end0
 s_waitcnt vmcnt(0)
 v_readfirstlane_b32 s100, v63
 s_cmp_ge_u32 s100, s46
 s_cbranch_scc1 wf_67
 s_sleep 3
 s_branch wf_66
wf_67:
 s_cmp_eq_u32 s22, 0
 s_cbranch_scc1 kvok_62
 s_sub_u32 s21, s64, 1310720
 buffer_load_dwordx4 v[126:129], v16, s[28:31], s21 offen offset:0 sc1
 buffer_load_dwordx4 v[130:133], v16, s[28:31], s21 offen offset:1024 sc1
 buffer_load_dwordx4 v[134:137], v16, s[28:31], s21 offen offset:2048 sc1
 s_waitcnt vmcnt(0)
 s_branch kvok_62
fl_63:
 buffer_load_dword v0, off, s[12:15], s79 sc1
 s_branch fl_64
last_53:
 s_mov_b64 exec, s[62:63]
 buffer_store_dwordx4 v[118:121], v18, s[24:27], s85 offen sc1
 buffer_store_dwordx2 v[122:123], v19, s[24:27], s85 offen sc1
 s_mov_b64 exec, -1
 s_waitcnt lgkmcnt(10)
 v_smfmac_f32_16x16x64_f16 v[100:103], v[28:31], a[120:127], v25
 v_smfmac_f32_16x16x64_f16 v[104:107], v[28:31], a[128:135], v25
 v_smfmac_f32_16x16x64_f16 v[108:111], v[28:31], a[136:143], v25
 v_smfmac_f32_16x16x64_f16 v[100:103], v[32:35], a[144:151], v25
 v_smfmac_f32_16x16x64_f16 v[104:107], v[32:35], a[152:159], v25
 v_smfmac_f32_16x16x64_f16 v[108:111], v[32:35], a[160:167], v25
 s_waitcnt lgkmcnt(7)
 v_smfmac_f32_16x16x64_f16 v[100:103], v[64:67], a[168:175], v25
 v_smfmac_f32_16x16x64_f16 v[104:107], v[64:67], a[176:183], v25
 v_smfmac_f32_16x16x64_f16 v[108:111], v[64:67], a[184:191], v25
 v_smfmac_f32_16x16x64_f16 v[100:103], v[68:71], a[192:199], v25
 v_smfmac_f32_16x16x64_f16 v[104:107], v[68:71], a[200:207], v25
 v_smfmac_f32_16x16x64_f16 v[108:111], v[68:71], a[208:215], v25
 v_smfmac_f32_16x16x64_f16 v[100:103], v[72:75], a[216:223], v25
 v_smfmac_f32_16x16x64_f16 v[104:107], v[72:75], a[224:231], v25
 v_smfmac_f32_16x16x64_f16 v[108:111], v[72:75], a[232:239], v25
 s_waitcnt lgkmcnt(4)
 v_smfmac_f32_16x16x64_f16 v[100:103], v[76:79], a[240:247], v25
 v_smfmac_f32_16x16x64_f16 v[104:107], v[76:79], a[248:255], v25
 v_smfmac_f32_16x16x64_f16 v[108:111], v[76:79], v[152:159], v25
 v_smfmac_f32_16x16x64_f16 v[100:103], v[80:83], v[160:167], v25
 v_smfmac_f32_16x16x64_f16 v[104:107], v[80:83], v[168:175], v25
 v_smfmac_f32_16x16x64_f16 v[108:111], v[80:83], v[176:183], v25
 v_smfmac_f32_16x16x64_f16 v[100:103], v[84:87], v[184:191], v25
 v_smfmac_f32_16x16x64_f16 v[104:107], v[84:87], v[192:199], v25
 v_smfmac_f32_16x16x64_f16 v[108:111], v[84:87], v[200:207], v25
 s_waitcnt lgkmcnt(0)
 v_smfmac_f32_16x16x64_f16 v[100:103], v[88:91], v[208:215], v25
 v_smfmac_f32_16x16x64_f16 v[104:107], v[88:91], v[216:223], v25
 v_smfmac_f32_16x16x64_f16 v[108:111], v[88:91], v[224:231], v25
 v_smfmac_f32_16x16x64_f16 v[100:103], v[92:95], v[232:239], v25
 v_smfmac_f32_16x16x64_f16 v[104:107], v[92:95], v[240:247], v25
 v_smfmac_f32_16x16x64_f16 v[108:111], v[92:95], v[248:255], v25
 s_nop 7
 v_mov_b32 v76, v108
 v_mov_b32 v77, v109
 v_mov_b32 v78, v110
 v_mov_b32 v79, v111
 v_permlane32_swap_b32 v100, v104
 v_permlane32_swap_b32 v101, v105
 v_permlane32_swap_b32 v102, v106
 v_permlane32_swap_b32 v103, v107
 v_permlane32_swap_b32 v108, v76
 v_permlane32_swap_b32 v109, v77
 v_permlane32_swap_b32 v110, v78
 v_permlane32_swap_b32 v111, v79
 v_pk_add_f32 v[100:101], v[100:101], v[104:105]
 v_pk_add_f32 v[102:103], v[102:103], v[106:107]
 v_pk_add_f32 v[108:109], v[108:109], v[76:77]
 v_pk_add_f32 v[110:111], v[110:111], v[78:79]
 v_cvt_pk_bf16_f32 v80, v100, v101
 v_cvt_pk_bf16_f32 v82, v108, v109
 v_cvt_pk_bf16_f32 v81, v102, v103
 v_cvt_pk_bf16_f32 v83, v110, v111
 s_nop 0
 v_permlane16_swap_b32 v80, v82
 v_permlane16_swap_b32 v81, v83
 v_min_u32 v80, -2, v80
 s_mov_b64 exec, s[76:77]
 buffer_store_dwordx4 v[80:83], v15, s[24:27], s57 offen sc1
 s_mov_b64 exec, -1
 s_branch chain_done
step_68:
 s_and_b32 s21, s52, 3
 s_mul_i32 s81, s21, 540672
 s_mul_i32 s84, s21, 0x88000
 s_and_b32 s84, s84, 0x108000
 s_add_u32 s21, s52, 3
 s_and_b32 s21, s21, 3
 s_mul_i32 s83, s21, 0x88000
 s_and_b32 s83, s83, 0x108000
 s_add_u32 s21, s52, 1
 s_and_b32 s22, s21, 3
 s_mul_i32 s3, s22, 0x88000
 s_and_b32 s3, s3, 0x108000
 s_mul_i32 s80, s21, 393216
 s_add_u32 s46, s21, 1
 s_min_u32 s46, s46, 64
 s_mov_b32 s47, s57
 s_mov_b32 s78, s85
 s_lshr_b32 s21, s52, 1
 s_bitcmp1_b32 s37, s21
 s_cselect_b32 s21, 8192, 0
 s_lshl_b32 s22, s52, 20
 s_or_b32 s22, s22, s21
 s_cmp_ge_u32 s52, 40
 s_cselect_b32 s57, 8192, 0
 s_xor_b32 s57, s57, s22
 s_xor_b32 s85, s22, 8192
 s_bfe_u32 s88, s52, 0x10002
 s_max_u32 s67, s52, 1
 s_sub_u32 s67, s67, 1
 v_mov_b32 v40, 0
 v_mov_b32 v41, 0
 v_mov_b32 v42, 0
 v_mov_b32 v43, 0
 v_mov_b32 v44, 0
 v_mov_b32 v45, 0
 v_mov_b32 v46, 0
 v_mov_b32 v47, 0
 v_mov_b32 v48, 0
 v_mov_b32 v49, 0
 v_mov_b32 v50, 0
 v_mov_b32 v51, 0
 v_mov_b32 v52, 0
 v_mov_b32 v53, 0
 v_mov_b32 v54, 0
 v_mov_b32 v55, 0
 v_mov_b32 v56, 0
 v_mov_b32 v57, 0
 v_mov_b32 v58, 0
 v_mov_b32 v59, 0
 v_mov_b32 v60, 0
 v_mov_b32 v61, 0
 v_mov_b32 v62, 0
 v_mov_b32 v63, 0
 v_mov_b32 v100, 0
 v_mov_b32 v101, 0
 v_mov_b32 v102, 0
 v_mov_b32 v103, 0
 v_mov_b32 v104, 0
 v_mov_b32 v105, 0
 v_mov_b32 v106, 0
 v_mov_b32 v107, 0
 v_mov_b32 v108, 0
 v_mov_b32 v109, 0
 v_mov_b32 v110, 0
 v_mov_b32 v111, 0
 s_sleep 5
 s_nop 3
 v_readfirstlane_b32 s21, v0
 s_cmp_lt_u32 s21, s46
 s_cselect_b32 s55, s55, 0
 s_cmp_lt_i32 s55, 0
 s_cbranch_scc1 fl_73
fl_74:
 s_mov_b32 s54, 0
 buffer_load_dwordx4 v[36:39], v4, s[4:7], s84 offen offset:2048 sc1
 buffer_load_dwordx4 v[28:31], v4, s[4:7], s84 offen offset:0 sc1
 buffer_load_dwordx4 v[32:35], v4, s[4:7], s84 offen offset:1024 sc1
 s_waitcnt vmcnt(3)
 v_mov_b32 v126, v88
 v_mov_b32 v127, v89
 v_mov_b32 v128, v90
 v_mov_b32 v129, v91
 v_mov_b32 v130, v92
 v_mov_b32 v131, v93
 v_mov_b32 v132, v94
 v_mov_b32 v133, v95
 v_mov_b32 v134, v96
 v_mov_b32 v135, v97
 v_mov_b32 v136, v98
 v_mov_b32 v137, v99
 s_waitcnt vmcnt(2)
 v_smfmac_f32_16x16x32_f16 v[40:43], v[36:37], a[16:19], v25
 v_smfmac_f32_16x16x32_f16 v[52:55], v[36:37], a[76:79], v25
 v_smfmac_f32_16x16x32_f16 v[44:47], v[36:37], a[36:39], v25
 s_waitcnt vmcnt(0)
 v_bitop3_b32 v27, v31, v35, v39 bitop3:0x80
 v_perm_b32 v31, v35, v31, s89
 v_cmp_gt_u32 vcc, 0x48000000, v27
 v_mov_b32 v35, v38
 v_smfmac_f32_16x16x32_f16 v[56:59], v[36:37], a[96:99], v25
 s_cbranch_vccnz pm_71
A2_72:
 v_smfmac_f32_16x16x64_f16 v[40:43], v[28:31], a[0:7], v25
 ds_write_b128 v10, v[28:31]
 v_smfmac_f32_16x16x64_f16 v[40:43], v[32:35], a[8:15], v25
 ds_write_b128 v10, v[32:35] offset:1024
 v_smfmac_f32_16x16x64_f16 v[52:55], v[28:31], a[60:67], v25
 ds_write_b64 v10, v[36:37] offset:2048
 v_smfmac_f32_16x16x64_f16 v[52:55], v[32:35], a[68:75], v25
 v_cvt_pk_f16_f32 v40, v40, v41
 v_cvt_pk_f16_f32 v41, v42, v43
 v_smfmac_f32_16x16x32_f16 v[48:51], v[36:37], a[56:59], v25
 v_smfmac_f32_16x16x32_f16 v[60:63], v[36:37], a[116:119], v25
 v_smfmac_f32_16x16x64_f16 v[44:47], v[28:31], a[20:27], v25
 v_cvt_pk_f16_f32 v52, v52, v53
 v_cvt_pk_f16_f32 v53, v54, v55
 s_nop 0
 v_smfmac_f32_16x16x64_f16 v[44:47], v[32:35], a[28:35], v25
 v_permlane32_swap_b32 v40, v52
 v_smfmac_f32_16x16x64_f16 v[56:59], v[28:31], a[80:87], v25
 v_permlane32_swap_b32 v41, v53
 v_pk_add_f16 v40, v40, v52
 v_smfmac_f32_16x16x64_f16 v[56:59], v[32:35], a[88:95], v25
 v_pk_add_f16 v41, v41, v53
 v_smfmac_f32_16x16x64_f16 v[48:51], v[28:31], a[40:47], v25
 ds_write_b64 v5, v[40:41] offset:0
 v_smfmac_f32_16x16x64_f16 v[48:51], v[32:35], a[48:55], v25
 v_cvt_pk_f16_f32 v44, v44, v45
 v_cvt_pk_f16_f32 v45, v46, v47
 v_cvt_pk_f16_f32 v56, v56, v57
 v_smfmac_f32_16x16x64_f16 v[60:63], v[28:31], a[100:107], v25
 v_cvt_pk_f16_f32 v57, v58, v59
 s_nop 0
 v_smfmac_f32_16x16x64_f16 v[60:63], v[32:35], a[108:115], v25
 v_permlane32_swap_b32 v44, v56
 v_permlane32_swap_b32 v45, v57
 v_pk_add_f16 v44, v44, v56
 v_pk_add_f16 v45, v45, v57
 ds_write_b64 v5, v[44:45] offset:640
 v_cvt_pk_f16_f32 v48, v48, v49
 v_cvt_pk_f16_f32 v49, v50, v51
 v_cvt_pk_f16_f32 v60, v60, v61
 v_cvt_pk_f16_f32 v61, v62, v63
 s_nop 0
 v_permlane32_swap_b32 v48, v60
 v_permlane32_swap_b32 v49, v61
 v_pk_add_f16 v48, v48, v60
 v_pk_add_f16 v49, v49, v61
 ds_write_b64 v5, v[48:49] offset:1280
 s_waitcnt lgkmcnt(0) vmcnt(0)
 s_barrier
 ds_read_b128 v[28:31], v16 offset:24576
 ds_read_b128 v[32:35], v16 offset:25600
 ds_read_b128 v[64:67], v16 offset:27648
 ds_read_b128 v[68:71], v16 offset:28672
 ds_read_b128 v[72:75], v16 offset:30720
 ds_read_b128 v[76:79], v16 offset:31744
 ds_read_b128 v[80:83], v16 offset:33792
 ds_read_b128 v[84:87], v16 offset:34816
 ds_read_b64 v[88:89], v16 offset:26624
 ds_read_b64 v[90:91], v16 offset:29696
 ds_read_b64 v[92:93], v16 offset:32768
 ds_read_b64 v[94:95], v16 offset:35840
 s_cmp_eq_u32 s52, 63
 s_cbranch_scc1 last_69
 s_waitcnt lgkmcnt(10)
 v_smfmac_f32_16x16x64_f16 v[100:103], v[28:31], a[120:127], v25
 v_smfmac_f32_16x16x64_f16 v[104:107], v[28:31], a[128:135], v25
 v_smfmac_f32_16x16x64_f16 v[108:111], v[28:31], a[136:143], v25
 s_mov_b32 s54, 0
 v_smfmac_f32_16x16x64_f16 v[100:103], v[32:35], a[144:151], v25
 v_readfirstlane_b32 s21, v0
 v_smfmac_f32_16x16x64_f16 v[104:107], v[32:35], a[152:159], v25
 s_add_u32 s22, s46, 3
 v_smfmac_f32_16x16x64_f16 v[108:111], v[32:35], a[160:167], v25
 s_min_u32 s22, s22, 64
 s_waitcnt lgkmcnt(7)
 v_smfmac_f32_16x16x64_f16 v[100:103], v[64:67], a[168:175], v25
 s_sub_u32 s55, s21, s22
 v_smfmac_f32_16x16x64_f16 v[104:107], v[64:67], a[176:183], v25
 s_sub_u32 s56, s21, s46
 v_smfmac_f32_16x16x64_f16 v[108:111], v[64:67], a[184:191], v25
 v_smfmac_f32_16x16x64_f16 v[100:103], v[68:71], a[192:199], v25
 v_smfmac_f32_16x16x64_f16 v[104:107], v[68:71], a[200:207], v25
 v_smfmac_f32_16x16x64_f16 v[108:111], v[68:71], a[208:215], v25
 v_smfmac_f32_16x16x64_f16 v[100:103], v[72:75], a[216:223], v25
 v_smfmac_f32_16x16x64_f16 v[104:107], v[72:75], a[224:231], v25
 v_smfmac_f32_16x16x64_f16 v[108:111], v[72:75], a[232:239], v25
 s_waitcnt lgkmcnt(4)
 v_smfmac_f32_16x16x64_f16 v[100:103], v[76:79], a[240:247], v25
 v_smfmac_f32_16x16x64_f16 v[104:107], v[76:79], a[248:255], v25
 v_smfmac_f32_16x16x64_f16 v[108:111], v[76:79], v[152:159], v25
 v_smfmac_f32_16x16x64_f16 v[100:103], v[80:83], v[160:167], v25
 v_smfmac_f32_16x16x64_f16 v[104:107], v[80:83], v[168:175], v25
 v_smfmac_f32_16x16x64_f16 v[108:111], v[80:83], v[176:183], v25
 v_smfmac_f32_16x16x64_f16 v[100:103], v[84:87], v[184:191], v25
 v_smfmac_f32_16x16x64_f16 v[104:107], v[84:87], v[192:199], v25
 v_smfmac_f32_16x16x64_f16 v[108:111], v[84:87], v[200:207], v25
 s_waitcnt lgkmcnt(0)
 v_smfmac_f32_16x16x64_f16 v[100:103], v[88:91], v[208:215], v25
 v_smfmac_f32_16x16x64_f16 v[104:107], v[88:91], v[216:223], v25
 v_smfmac_f32_16x16x64_f16 v[108:111], v[88:91], v[224:231], v25
 v_smfmac_f32_16x16x64_f16 v[100:103], v[92:95], v[232:239], v25
 v_smfmac_f32_16x16x64_f16 v[104:107], v[92:95], v[240:247], v25
 v_smfmac_f32_16x16x64_f16 v[108:111], v[92:95], v[248:255], v25
 s_sleep 1
 s_nop 11
 buffer_load_dwordx2 v[58:59], v9, s[8:11], s81 offen sc1
 buffer_load_dwordx4 v[40:43], v8, s[8:11], s81 offen offset:0 sc1
 buffer_load_dwordx4 v[44:47], v8, s[8:11], s81 offen offset:1024 sc1
 s_cmp_lt_i32 s56, 0
 s_cbranch_scc1 kvw_77
kvok_78:
 s_waitcnt vmcnt(2)
 v_xor_b32 v76, s88, v58
 s_nop 0
 v_permlane16_swap_b32 v58, v59
 v_fma_mix_f32 v60, v58, 1.0, v59 op_sel:[0,0,0] op_sel_hi:[1,0,1]
 v_fma_mix_f32 v61, v58, 1.0, v59 op_sel:[1,0,1] op_sel_hi:[1,0,1]
 v_mov_b32 v58, v60
 v_mov_b32 v59, v61
 s_nop 0
 v_permlane32_swap_b32 v58, v60
 v_permlane32_swap_b32 v59, v61
 v_add_f32 v52, v58, v60
 v_add_f32 v53, v59, v61
 v_max_f32 v79, v52, v53
 s_waitcnt vmcnt(0)
 v_pk_add_f16 v80, v40, v44
 v_pk_add_f16 v82, v42, v46
 v_pk_add_f16 v81, v41, v45
 v_pk_add_f16 v83, v43, v47
 v_permlane32_swap_b32 v80, v82
 v_bitop3_b32 v77, v40, v42, s88 bitop3:0x7e
 v_permlane32_swap_b32 v81, v83
 v_bitop3_b32 v78, v44, v46, s88 bitop3:0x7e
 v_fma_mix_f32 v48, v80, 1.0, v82 op_sel:[0,0,0] op_sel_hi:[1,0,1]
 v_or3_b32 v27, v76, v77, v78
 v_fma_mix_f32 v49, v80, 1.0, v82 op_sel:[1,0,1] op_sel_hi:[1,0,1]
 v_and_b32 v27, 1, v27
 v_fma_mix_f32 v50, v81, 1.0, v83 op_sel:[0,0,0] op_sel_hi:[1,0,1]
 v_cmp_ne_u32 vcc, 0, v27
 v_fma_mix_f32 v51, v81, 1.0, v83 op_sel:[1,0,1] op_sel_hi:[1,0,1]
 v_max3_f32 v62, v48, v49, v79
 s_cbranch_vccnz psr_75
psj_76:
 v_max3_f32 v62, v62, v50, v51
 v_cvt_pk_bf16_f32 v146, v100, v101
 v_cvt_pk_bf16_f32 v147, v102, v103
 v_max_f32_dpp v62, v62, v62 row_ror:8 row_mask:0xf bank_mask:0xf
 v_mov_b32 v63, v62
 v_cvt_pk_bf16_f32 v148, v104, v105
 v_cvt_pk_bf16_f32 v149, v106, v107
 v_permlane32_swap_b32 v62, v63
 v_max_f32 v62, v62, v63
 v_mov_b32 v63, v62
 v_cvt_pk_bf16_f32 v150, v108, v109
 v_cvt_pk_bf16_f32 v151, v110, v111
 v_permlane16_swap_b32 v62, v63
 v_max_f32 v62, v62, v63
 v_mul_f32 v62, s86, v62
 v_fma_f32 v48, v48, s86, -v62
 v_fma_f32 v49, v49, s86, -v62
 v_fma_f32 v50, v50, s86, -v62
 v_fma_f32 v51, v51, s86, -v62
 v_fma_f32 v52, v52, s86, -v62
 v_fma_f32 v53, v53, s86, -v62
 v_exp_f32 v48, v48
 v_exp_f32 v49, v49
 buffer_load_dwordx4 v[88:91], v17, s[28:31], s64 offen offset:0 sc1
 v_exp_f32 v50, v50
 v_exp_f32 v51, v51
 buffer_load_dwordx4 v[92:95], v16, s[28:31], s64 offen offset:1024 sc1
 v_exp_f32 v52, v52
 v_exp_f32 v53, v53
 buffer_load_dwordx4 v[96:99], v20, s[28:31], s64 offen offset:2048 sc1
 v_cvt_pk_bf16_f32 v138, v48, v49
 v_cvt_pk_bf16_f32 v139, v50, v51
 v_cvt_pk_bf16_f32 v142, v52, v53
 v_mov_b32_dpp v140, v138 row_ror:8 row_mask:0xf bank_mask:0xf
 v_mov_b32_dpp v141, v139 row_ror:8 row_mask:0xf bank_mask:0xf
 v_mov_b32_dpp v143, v142 row_ror:8 row_mask:0xf bank_mask:0xf
 v_mov_b32 v84, s67
 v_mov_b32 v85, s67
 s_mov_b64 exec, 15
 buffer_store_dwordx2 v[84:85], v24, s[12:15], s66 offen sc1
 s_mov_b64 exec, -1
 v_add_f32 v54, v48, v49
 v_mfma_f32_16x16x32_bf16 v[64:67], v[126:129], v[138:141], 0
 v_add_f32 v55, v50, v51
 v_add_f32 v56, v52, v53
 v_mfma_f32_16x16x32_bf16 v[64:67], v[146:149], v[142:145], v[64:67]
 v_add_f32 v62, v54, v55
 v_fmac_f32 v62, v56, v26
 v_mfma_f32_16x16x32_bf16 v[68:71], v[130:133], v[138:141], 0
 s_nop 0
 v_add_f32_dpp v62, v62, v62 row_ror:8 row_mask:0xf bank_mask:0xf
 v_mfma_f32_16x16x32_bf16 v[68:71], v[148:151], v[142:145], v[68:71]
 v_mov_b32 v63, v62
 s_cmp_lt_i32 s55, 0
 s_cbranch_scc1 fl_79
fl_80:
 v_mfma_f32_16x16x32_bf16 v[72:75], v[134:137], v[138:141], 0
 v_permlane32_swap_b32 v62, v63
 v_mfma_f32_16x16x32_bf16 v[72:75], v[150:153], v[142:145], v[72:75]
 v_add_f32 v62, v62, v63
 v_mov_b32 v63, v62
 ds_write_b128 v11, v[64:67] offset:0
 s_nop 0
 v_permlane16_swap_b32 v62, v63
 v_add_f32 v62, v62, v63
 v_rcp_f32 v62, v62
 ds_write_b128 v11, v[68:71] offset:1024
 s_mov_b64 exec, 0xff
 ds_write_b32 v22, v62
 s_mov_b64 exec, -1
 ds_write_b128 v11, v[72:75] offset:2048
 s_waitcnt lgkmcnt(0)
 s_barrier
 s_and_b32 s21, s52, 7
 s_cmp_lg_u32 s21, s50
 s_cbranch_scc1 zm_81
 v_mov_b32 v64, 0
 v_mov_b32 v65, 0
 v_mov_b32 v66, 0
 v_mov_b32 v67, 0
 s_mov_b64 exec, s[70:71]
 buffer_store_dwordx4 v[64:67], v13, s[4:7], s83 offen sc1
 s_mov_b64 exec, -1
zm_81:
 v_mov_b32 v76, v108
 v_mov_b32 v77, v109
 v_mov_b32 v78, v110
 v_mov_b32 v79, v111
 v_permlane32_swap_b32 v100, v104
 v_permlane32_swap_b32 v101, v105
 v_permlane32_swap_b32 v102, v106
 v_permlane32_swap_b32 v103, v107
 v_permlane32_swap_b32 v108, v76
 v_permlane32_swap_b32 v109, v77
 v_permlane32_swap_b32 v110, v78
 v_permlane32_swap_b32 v111, v79
 v_pk_add_f32 v[100:101], v[100:101], v[104:105]
 v_pk_add_f32 v[102:103], v[102:103], v[106:107]
 v_pk_add_f32 v[108:109], v[108:109], v[76:77]
 v_pk_add_f32 v[110:111], v[110:111], v[78:79]
 v_cvt_pk_bf16_f32 v80, v100, v101
 v_cvt_pk_bf16_f32 v82, v108, v109
 v_cvt_pk_bf16_f32 v81, v102, v103
 v_cvt_pk_bf16_f32 v83, v110, v111
 s_nop 0
 v_permlane16_swap_b32 v80, v82
 v_permlane16_swap_b32 v81, v83
 v_min_u32 v80, -2, v80
 s_mov_b64 exec, s[76:77]
 buffer_store_dwordx4 v[80:83], v15, s[24:27], s57 offen sc1
 s_mov_b64 exec, -1
 s_add_u32 s64, s64, 1310720
 s_add_u32 s52, s52, 1
 s_branch step_68
fl_73:
 buffer_load_dword v0, off, s[12:15], s79 sc1
 s_branch fl_74
A1_18:
 v_smfmac_f32_16x16x32_f16 v[40:43], v[36:37], a[16:19], v25
 v_smfmac_f32_16x16x32_f16 v[52:55], v[36:37], a[76:79], v25
 v_smfmac_f32_16x16x32_f16 v[44:47], v[36:37], a[36:39], v25
 v_smfmac_f32_16x16x32_f16 v[56:59], v[36:37], a[96:99], v25
 s_branch A2_72
pm_71:
 buffer_load_dwordx4 v[36:39], v4, s[4:7], s84 offen offset:2048 sc1
 buffer_load_dwordx4 v[28:31], v4, s[4:7], s84 offen offset:0 sc1
 buffer_load_dwordx4 v[32:35], v4, s[4:7], s84 offen offset:1024 sc1
 s_nop 7
 v_mov_b32 v40, 0
 v_mov_b32 v41, 0
 v_mov_b32 v42, 0
 v_mov_b32 v43, 0
 v_mov_b32 v52, 0
 v_mov_b32 v53, 0
 v_mov_b32 v54, 0
 v_mov_b32 v55, 0
 v_mov_b32 v44, 0
 v_mov_b32 v45, 0
 v_mov_b32 v46, 0
 v_mov_b32 v47, 0
 v_mov_b32 v56, 0
 v_mov_b32 v57, 0
 v_mov_b32 v58, 0
 v_mov_b32 v59, 0
 s_waitcnt vmcnt(0)
 v_bitop3_b32 v27, v31, v35, v39 bitop3:0x80
 v_perm_b32 v31, v35, v31, s89
 v_cmp_gt_u32 vcc, 0x48000000, v27
 v_mov_b32 v35, v38
 s_cbranch_vccz A1_18
pm_70:
 s_cmp_gt_u32 s52, 3
 s_cbranch_scc1 op_82
 v_readfirstlane_b32 s21, v0
 s_cmp_ge_u32 s21, s46
 s_cbranch_scc1 op_82
 buffer_load_dword v0, off, s[12:15], s79 sc1
 s_waitcnt vmcnt(0)
 v_readfirstlane_b32 s21, v0
 s_cmp_gt_u32 s21, s52
 s_cselect_b32 s21, s87, 0
 s_cmp_eq_u32 s21, 0
 s_cbranch_scc1 op_82
 s_mov_b32 s87, 0
 s_sub_u32 s21, s64, 1310720
 buffer_load_dwordx4 v[126:129], v16, s[28:31], s21 offen offset:0 sc1
 buffer_load_dwordx4 v[130:133], v16, s[28:31], s21 offen offset:1024 sc1
 buffer_load_dwordx4 v[134:137], v16, s[28:31], s21 offen offset:2048 sc1
op_82:
 buffer_load_dwordx4 v[36:39], v4, s[4:7], s84 offen offset:2048 sc1
 buffer_load_dwordx4 v[28:31], v4, s[4:7], s84 offen offset:0 sc1
 buffer_load_dwordx4 v[32:35], v4, s[4:7], s84 offen offset:1024 sc1
 s_add_u32 s54, s54, 1
 s_cmp_gt_u32 s54, 131072
 s_cbranch_scc1 end0
 s_waitcnt vmcnt(0)
 v_bitop3_b32 v27, v31, v35, v39 bitop3:0x80
 v_perm_b32 v31, v35, v31, s89
 v_cmp_gt_u32 vcc, 0x48000000, v27
 v_mov_b32 v35, v38
 s_cbranch_vccnz pm_70
 s_branch A1_18
psr_75:
 buffer_load_dwordx2 v[58:59], v9, s[8:11], s81 offen sc1
 buffer_load_dwordx4 v[40:43], v8, s[8:11], s81 offen offset:0 sc1
 buffer_load_dwordx4 v[44:47], v8, s[8:11], s81 offen offset:1024 sc1
 s_add_u32 s54, s54, 1
 s_cmp_gt_u32 s54, 131072
 s_cbranch_scc1 end0
 s_waitcnt vmcnt(2)
 v_xor_b32 v76, s88, v58
 s_nop 0
 v_permlane16_swap_b32 v58, v59
 v_fma_mix_f32 v60, v58, 1.0, v59 op_sel:[0,0,0] op_sel_hi:[1,0,1]
 v_fma_mix_f32 v61, v58, 1.0, v59 op_sel:[1,0,1] op_sel_hi:[1,0,1]
 v_mov_b32 v58, v60
 v_mov_b32 v59, v61
 s_nop 0
 v_permlane32_swap_b32 v58, v60
 v_permlane32_swap_b32 v59, v61
 v_add_f32 v52, v58, v60
 v_add_f32 v53, v59, v61
 v_max_f32 v79, v52, v53
 s_waitcnt vmcnt(0)
 v_pk_add_f16 v80, v40, v44
 v_pk_add_f16 v82, v42, v46
 v_pk_add_f16 v81, v41, v45
 v_pk_add_f16 v83, v43, v47
 v_permlane32_swap_b32 v80, v82
 v_bitop3_b32 v77, v40, v42, s88 bitop3:0x7e
 v_permlane32_swap_b32 v81, v83
 v_bitop3_b32 v78, v44, v46, s88 bitop3:0x7e
 v_fma_mix_f32 v48, v80, 1.0, v82 op_sel:[0,0,0] op_sel_hi:[1,0,1]
 v_or3_b32 v27, v76, v77, v78
 v_fma_mix_f32 v49, v80, 1.0, v82 op_sel:[1,0,1] op_sel_hi:[1,0,1]
 v_and_b32 v27, 1, v27
 v_fma_mix_f32 v50, v81, 1.0, v83 op_sel:[0,0,0] op_sel_hi:[1,0,1]
 v_cmp_ne_u32 vcc, 0, v27
 v_fma_mix_f32 v51, v81, 1.0, v83 op_sel:[1,0,1] op_sel_hi:[1,0,1]
 v_max3_f32 v62, v48, v49, v79
 s_cbranch_vccnz psr_75
 s_branch psj_76
kvw_77:
 s_mov_b32 s22, s87
 s_cmp_eq_u32 s52, 0
 s_cselect_b32 s55, 0, s55
 s_cselect_b32 s87, 1, 0
 s_cbranch_scc1 kvok_78
 v_mov_b32 v62, 0
 s_mov_b32 s101, 0
wf_83:
 buffer_load_dword v63, v62, s[12:15], s79 offen sc1
 s_add_u32 s101, s101, 1
 s_cmp_gt_u32 s101, 131072
 s_cbranch_scc1 end0
 s_waitcnt vmcnt(0)
 v_readfirstlane_b32 s100, v63
 s_cmp_ge_u32 s100, s46
 s_cbranch_scc1 wf_84
 s_sleep 3
 s_branch wf_83
wf_84:
 s_cmp_eq_u32 s22, 0
 s_cbranch_scc1 kvok_78
 s_sub_u32 s21, s64, 1310720
 buffer_load_dwordx4 v[126:129], v16, s[28:31], s21 offen offset:0 sc1
 buffer_load_dwordx4 v[130:133], v16, s[28:31], s21 offen offset:1024 sc1
 buffer_load_dwordx4 v[134:137], v16, s[28:31], s21 offen offset:2048 sc1
 s_waitcnt vmcnt(0)
 s_branch kvok_78
fl_79:
 buffer_load_dword v0, off, s[12:15], s79 sc1
 s_branch fl_80
last_69:
 s_waitcnt lgkmcnt(10)
 v_smfmac_f32_16x16x64_f16 v[100:103], v[28:31], a[120:127], v25
 v_smfmac_f32_16x16x64_f16 v[104:107], v[28:31], a[128:135], v25
 v_smfmac_f32_16x16x64_f16 v[108:111], v[28:31], a[136:143], v25
 v_smfmac_f32_16x16x64_f16 v[100:103], v[32:35], a[144:151], v25
 v_smfmac_f32_16x16x64_f16 v[104:107], v[32:35], a[152:159], v25
 v_smfmac_f32_16x16x64_f16 v[108:111], v[32:35], a[160:167], v25
 s_waitcnt lgkmcnt(7)
 v_smfmac_f32_16x16x64_f16 v[100:103], v[64:67], a[168:175], v25
 v_smfmac_f32_16x16x64_f16 v[104:107], v[64:67], a[176:183], v25
 v_smfmac_f32_16x16x64_f16 v[108:111], v[64:67], a[184:191], v25
 v_smfmac_f32_16x16x64_f16 v[100:103], v[68:71], a[192:199], v25
 v_smfmac_f32_16x16x64_f16 v[104:107], v[68:71], a[200:207], v25
 v_smfmac_f32_16x16x64_f16 v[108:111], v[68:71], a[208:215], v25
 v_smfmac_f32_16x16x64_f16 v[100:103], v[72:75], a[216:223], v25
 v_smfmac_f32_16x16x64_f16 v[104:107], v[72:75], a[224:231], v25
 v_smfmac_f32_16x16x64_f16 v[108:111], v[72:75], a[232:239], v25
 s_waitcnt lgkmcnt(4)
 v_smfmac_f32_16x16x64_f16 v[100:103], v[76:79], a[240:247], v25
 v_smfmac_f32_16x16x64_f16 v[104:107], v[76:79], a[248:255], v25
 v_smfmac_f32_16x16x64_f16 v[108:111], v[76:79], v[152:159], v25
 v_smfmac_f32_16x16x64_f16 v[100:103], v[80:83], v[160:167], v25
 v_smfmac_f32_16x16x64_f16 v[104:107], v[80:83], v[168:175], v25
 v_smfmac_f32_16x16x64_f16 v[108:111], v[80:83], v[176:183], v25
 v_smfmac_f32_16x16x64_f16 v[100:103], v[84:87], v[184:191], v25
 v_smfmac_f32_16x16x64_f16 v[104:107], v[84:87], v[192:199], v25
 v_smfmac_f32_16x16x64_f16 v[108:111], v[84:87], v[200:207], v25
 s_waitcnt lgkmcnt(0)
 v_smfmac_f32_16x16x64_f16 v[100:103], v[88:91], v[208:215], v25
 v_smfmac_f32_16x16x64_f16 v[104:107], v[88:91], v[216:223], v25
 v_smfmac_f32_16x16x64_f16 v[108:111], v[88:91], v[224:231], v25
 v_smfmac_f32_16x16x64_f16 v[100:103], v[92:95], v[232:239], v25
 v_smfmac_f32_16x16x64_f16 v[104:107], v[92:95], v[240:247], v25
 v_smfmac_f32_16x16x64_f16 v[108:111], v[92:95], v[248:255], v25
 s_nop 7
 v_mov_b32 v76, v108
 v_mov_b32 v77, v109
 v_mov_b32 v78, v110
 v_mov_b32 v79, v111
 v_permlane32_swap_b32 v100, v104
 v_permlane32_swap_b32 v101, v105
 v_permlane32_swap_b32 v102, v106
 v_permlane32_swap_b32 v103, v107
 v_permlane32_swap_b32 v108, v76
 v_permlane32_swap_b32 v109, v77
 v_permlane32_swap_b32 v110, v78
 v_permlane32_swap_b32 v111, v79
 v_pk_add_f32 v[100:101], v[100:101], v[104:105]
 v_pk_add_f32 v[102:103], v[102:103], v[106:107]
 v_pk_add_f32 v[108:109], v[108:109], v[76:77]
 v_pk_add_f32 v[110:111], v[110:111], v[78:79]
 v_cvt_pk_bf16_f32 v80, v100, v101
 v_cvt_pk_bf16_f32 v82, v108, v109
 v_cvt_pk_bf16_f32 v81, v102, v103
 v_cvt_pk_bf16_f32 v83, v110, v111
 s_nop 0
 v_permlane16_swap_b32 v80, v82
 v_permlane16_swap_b32 v81, v83
 v_min_u32 v80, -2, v80
 s_mov_b64 exec, s[76:77]
 buffer_store_dwordx4 v[80:83], v15, s[24:27], s57 offen sc1
 s_mov_b64 exec, -1
 s_branch chain_done
step_85:
 s_and_b32 s21, s52, 3
 s_mul_i32 s81, s21, 540672
 s_mul_i32 s84, s21, 0x88000
 s_and_b32 s84, s84, 0x108000
 s_add_u32 s21, s52, 3
 s_and_b32 s21, s21, 3
 s_mul_i32 s83, s21, 0x88000
 s_and_b32 s83, s83, 0x108000
 s_add_u32 s21, s52, 1
 s_and_b32 s22, s21, 3
 s_mul_i32 s3, s22, 0x88000
 s_and_b32 s3, s3, 0x108000
 s_mul_i32 s80, s21, 393216
 s_add_u32 s46, s21, 1
 s_min_u32 s46, s46, 64
 s_mov_b32 s47, s57
 s_mov_b32 s78, s85
 s_lshr_b32 s21, s52, 1
 s_bitcmp1_b32 s37, s21
 s_cselect_b32 s21, 8192, 0
 s_lshl_b32 s22, s52, 20
 s_or_b32 s22, s22, s21
 s_cmp_ge_u32 s52, 40
 s_cselect_b32 s57, 8192, 0
 s_xor_b32 s57, s57, s22
 s_xor_b32 s85, s22, 8192
 s_bfe_u32 s88, s52, 0x10002
 s_max_u32 s67, s52, 1
 s_sub_u32 s67, s67, 1
 v_mov_b32 v40, 0
 v_mov_b32 v41, 0
 v_mov_b32 v42, 0
 v_mov_b32 v43, 0
 v_mov_b32 v44, 0
 v_mov_b32 v45, 0
 v_mov_b32 v46, 0
 v_mov_b32 v47, 0
 v_mov_b32 v48, 0
 v_mov_b32 v49, 0
 v_mov_b32 v50, 0
 v_mov_b32 v51, 0
 v_mov_b32 v52, 0
 v_mov_b32 v53, 0
 v_mov_b32 v54, 0
 v_mov_b32 v55, 0
 v_mov_b32 v56, 0
 v_mov_b32 v57, 0
 v_mov_b32 v58, 0
 v_mov_b32 v59, 0
 v_mov_b32 v60, 0
 v_mov_b32 v61, 0
 v_mov_b32 v62, 0
 v_mov_b32 v63, 0
 v_mov_b32 v100, 0
 v_mov_b32 v101, 0
 v_mov_b32 v102, 0
 v_mov_b32 v103, 0
 v_mov_b32 v104, 0
 v_mov_b32 v105, 0
 v_mov_b32 v106, 0
 v_mov_b32 v107, 0
 v_mov_b32 v108, 0
 v_mov_b32 v109, 0
 v_mov_b32 v110, 0
 v_mov_b32 v111, 0
 s_sleep 8
 v_readfirstlane_b32 s21, v0
 s_cmp_lt_u32 s21, s46
 s_cselect_b32 s55, s55, 0
 s_cmp_lt_i32 s55, 0
 s_cbranch_scc1 fl_90
fl_91:
 s_mov_b32 s54, 0
 buffer_load_dwordx4 v[36:39], v4, s[4:7], s84 offen offset:2048 sc1
 buffer_load_dwordx4 v[28:31], v4, s[4:7], s84 offen offset:0 sc1
 buffer_load_dwordx4 v[32:35], v4, s[4:7], s84 offen offset:1024 sc1
 s_waitcnt vmcnt(3)
 v_mov_b32 v126, v88
 v_mov_b32 v127, v89
 v_mov_b32 v128, v90
 v_mov_b32 v129, v91
 v_mov_b32 v130, v92
 v_mov_b32 v131, v93
 v_mov_b32 v132, v94
 v_mov_b32 v133, v95
 v_mov_b32 v134, v96
 v_mov_b32 v135, v97
 v_mov_b32 v136, v98
 v_mov_b32 v137, v99
 s_waitcnt vmcnt(2)
 v_smfmac_f32_16x16x32_f16 v[40:43], v[36:37], a[16:19], v25
 v_smfmac_f32_16x16x32_f16 v[52:55], v[36:37], a[76:79], v25
 v_smfmac_f32_16x16x32_f16 v[44:47], v[36:37], a[36:39], v25
 s_waitcnt vmcnt(0)
 v_bitop3_b32 v27, v31, v35, v39 bitop3:0x80
 v_perm_b32 v31, v35, v31, s89
 v_cmp_gt_u32 vcc, 0x48000000, v27
 v_mov_b32 v35, v38
 v_smfmac_f32_16x16x32_f16 v[56:59], v[36:37], a[96:99], v25
 s_cbranch_vccnz pm_88
A2_89:
 v_smfmac_f32_16x16x64_f16 v[40:43], v[28:31], a[0:7], v25
 ds_write_b128 v10, v[28:31]
 v_smfmac_f32_16x16x64_f16 v[40:43], v[32:35], a[8:15], v25
 ds_write_b128 v10, v[32:35] offset:1024
 v_smfmac_f32_16x16x64_f16 v[52:55], v[28:31], a[60:67], v25
 ds_write_b64 v10, v[36:37] offset:2048
 v_smfmac_f32_16x16x64_f16 v[52:55], v[32:35], a[68:75], v25
 v_cvt_pk_f16_f32 v40, v40, v41
 v_cvt_pk_f16_f32 v41, v42, v43
 v_smfmac_f32_16x16x32_f16 v[48:51], v[36:37], a[56:59], v25
 v_smfmac_f32_16x16x32_f16 v[60:63], v[36:37], a[116:119], v25
 v_smfmac_f32_16x16x64_f16 v[44:47], v[28:31], a[20:27], v25
 v_cvt_pk_f16_f32 v52, v52, v53
 v_cvt_pk_f16_f32 v53, v54, v55
 s_nop 0
 v_smfmac_f32_16x16x64_f16 v[44:47], v[32:35], a[28:35], v25
 v_permlane32_swap_b32 v40, v52
 v_smfmac_f32_16x16x64_f16 v[56:59], v[28:31], a[80:87], v25
 v_permlane32_swap_b32 v41, v53
 v_pk_add_f16 v40, v40, v52
 v_smfmac_f32_16x16x64_f16 v[56:59], v[32:35], a[88:95], v25
 v_pk_add_f16 v41, v41, v53
 v_smfmac_f32_16x16x64_f16 v[48:51], v[28:31], a[40:47], v25
 ds_write_b64 v5, v[40:41] offset:0
 v_smfmac_f32_16x16x64_f16 v[48:51], v[32:35], a[48:55], v25
 v_cvt_pk_f16_f32 v44, v44, v45
 v_cvt_pk_f16_f32 v45, v46, v47
 v_cvt_pk_f16_f32 v56, v56, v57
 v_smfmac_f32_16x16x64_f16 v[60:63], v[28:31], a[100:107], v25
 v_cvt_pk_f16_f32 v57, v58, v59
 s_nop 0
 v_smfmac_f32_16x16x64_f16 v[60:63], v[32:35], a[108:115], v25
 v_permlane32_swap_b32 v44, v56
 v_permlane32_swap_b32 v45, v57
 v_pk_add_f16 v44, v44, v56
 v_pk_add_f16 v45, v45, v57
 ds_write_b64 v5, v[44:45] offset:640
 v_cvt_pk_f16_f32 v48, v48, v49
 v_cvt_pk_f16_f32 v49, v50, v51
 v_cvt_pk_f16_f32 v60, v60, v61
 v_cvt_pk_f16_f32 v61, v62, v63
 s_nop 0
 v_permlane32_swap_b32 v48, v60
 v_permlane32_swap_b32 v49, v61
 v_pk_add_f16 v48, v48, v60
 v_pk_add_f16 v49, v49, v61
 ds_write_b64 v5, v[48:49] offset:1280
 s_waitcnt lgkmcnt(0) vmcnt(0)
 s_barrier
 s_lshr_b32 s21, 3, s20
 s_bitcmp1_b32 s21, 0
 s_cbranch_scc0 bw_93
 ds_read_b64_tr_b16 v[40:41], v21 offset:0
 ds_read_b64_tr_b16 v[42:43], v21 offset:1920
 ds_read_b64_tr_b16 v[44:45], v21 offset:640
 ds_read_b64_tr_b16 v[46:47], v21 offset:2560
 ds_read_b64_tr_b16 v[48:49], v21 offset:1280
 ds_read_b64_tr_b16 v[50:51], v21 offset:3200
 s_waitcnt lgkmcnt(4)
 v_fma_mix_f32 v52, v40, 1.0, v42 op_sel:[0,0,0] op_sel_hi:[1,0,1]
 v_fma_mix_f32 v53, v40, 1.0, v42 op_sel:[1,0,1] op_sel_hi:[1,0,1]
 v_fma_mix_f32 v54, v41, 1.0, v43 op_sel:[0,0,0] op_sel_hi:[1,0,1]
 v_fma_mix_f32 v55, v41, 1.0, v43 op_sel:[1,0,1] op_sel_hi:[1,0,1]
 v_add_f32_dpp v56, v52, v52 row_ror:8 row_mask:0xf bank_mask:0xf
 v_add_f32_dpp v57, v53, v53 row_ror:8 row_mask:0xf bank_mask:0xf
 v_add_f32_dpp v58, v54, v54 row_ror:8 row_mask:0xf bank_mask:0xf
 v_add_f32_dpp v59, v55, v55 row_ror:8 row_mask:0xf bank_mask:0xf
 v_cvt_pk_bf16_f32 v118, v56, v57
 v_cvt_pk_bf16_f32 v119, v58, v59
 s_waitcnt lgkmcnt(2)
 v_fma_mix_f32 v52, v44, 1.0, v46 op_sel:[0,0,0] op_sel_hi:[1,0,1]
 v_fma_mix_f32 v53, v44, 1.0, v46 op_sel:[1,0,1] op_sel_hi:[1,0,1]
 v_fma_mix_f32 v54, v45, 1.0, v47 op_sel:[0,0,0] op_sel_hi:[1,0,1]
 v_fma_mix_f32 v55, v45, 1.0, v47 op_sel:[1,0,1] op_sel_hi:[1,0,1]
 v_add_f32_dpp v56, v52, v52 row_ror:8 row_mask:0xf bank_mask:0xf
 v_add_f32_dpp v57, v53, v53 row_ror:8 row_mask:0xf bank_mask:0xf
 v_add_f32_dpp v58, v54, v54 row_ror:8 row_mask:0xf bank_mask:0xf
 v_add_f32_dpp v59, v55, v55 row_ror:8 row_mask:0xf bank_mask:0xf
 v_cvt_pk_bf16_f32 v120, v56, v57
 v_cvt_pk_bf16_f32 v121, v58, v59
 s_waitcnt lgkmcnt(0)
 v_fma_mix_f32 v52, v48, 1.0, v50 op_sel:[0,0,0] op_sel_hi:[1,0,1]
 v_fma_mix_f32 v53, v48, 1.0, v50 op_sel:[1,0,1] op_sel_hi:[1,0,1]
 v_fma_mix_f32 v54, v49, 1.0, v51 op_sel:[0,0,0] op_sel_hi:[1,0,1]
 v_fma_mix_f32 v55, v49, 1.0, v51 op_sel:[1,0,1] op_sel_hi:[1,0,1]
 v_mfma_f32_16x16x32_bf16 v[40:43], v[112:115], v[118:121], 0
 v_add_f32_dpp v56, v52, v52 row_ror:8 row_mask:0xf bank_mask:0xf
 v_add_f32_dpp v57, v53, v53 row_ror:8 row_mask:0xf bank_mask:0xf
 v_add_f32_dpp v58, v54, v54 row_ror:8 row_mask:0xf bank_mask:0xf
 v_add_f32_dpp v59, v55, v55 row_ror:8 row_mask:0xf bank_mask:0xf
 v_cvt_pk_bf16_f32 v122, v56, v57
 v_cvt_pk_bf16_f32 v123, v58, v59
 s_nop 1
 v_mfma_f32_16x16x32_bf16 v[40:43], v[116:119], v[122:125], v[40:43]
 ds_read_b128 v[28:31], v16 offset:24576
 ds_read_b128 v[32:35], v16 offset:25600
 ds_read_b128 v[64:67], v16 offset:27648
 ds_read_b128 v[68:71], v16 offset:28672
 ds_read_b128 v[72:75], v16 offset:30720
 ds_read_b128 v[76:79], v16 offset:31744
 s_nop 0
 s_mov_b64 exec, s[74:75]
 v_cvt_pk_f16_f32 v44, v40, v41
 v_cvt_pk_f16_f32 v45, v42, v43
 v_and_or_b32 v44, v44, -2, s88
 s_cmp_eq_u32 s53, 1
 s_cbranch_scc1 si_94
 buffer_store_dwordx2 v[44:45], v7, s[8:11], s81 offen sc1
 s_branch si_95
si_94:
 buffer_store_dwordx2 v[44:45], v7, s[8:11], s81 offen
si_95:
 s_mov_b64 exec, -1
 s_branch bw_92
bw_93:
 s_lshr_b32 s21, 4, s20
 s_bitcmp1_b32 s21, 0
 s_cbranch_scc0 bw_96
 ds_read_b64_tr_b16 v[40:41], v6 offset:0
 ds_read_b64_tr_b16 v[42:43], v6 offset:1920
 ds_read_b64_tr_b16 v[44:45], v6 offset:3840
 ds_read_b64_tr_b16 v[46:47], v6 offset:5760
 ds_read_b64_tr_b16 v[48:49], v6 offset:640
 ds_read_b64_tr_b16 v[50:51], v6 offset:2560
 ds_read_b64_tr_b16 v[52:53], v6 offset:4480
 ds_read_b64_tr_b16 v[54:55], v6 offset:6400
 ds_read_b64_tr_b16 v[56:57], v6 offset:1280
 ds_read_b64_tr_b16 v[58:59], v6 offset:3200
 ds_read_b64_tr_b16 v[60:61], v6 offset:5120
 ds_read_b64_tr_b16 v[62:63], v6 offset:7040
 s_waitcnt lgkmcnt(8)
 v_pk_add_f16 v40, v40, v42
 v_pk_add_f16 v44, v44, v46
 v_pk_add_f16 v41, v41, v43
 v_pk_add_f16 v45, v45, v47
 v_fma_mix_f32 v146, v40, 1.0, v44 op_sel:[0,0,0] op_sel_hi:[1,0,1]
 v_fma_mix_f32 v147, v40, 1.0, v44 op_sel:[1,0,1] op_sel_hi:[1,0,1]
 v_fma_mix_f32 v148, v41, 1.0, v45 op_sel:[0,0,0] op_sel_hi:[1,0,1]
 v_fma_mix_f32 v149, v41, 1.0, v45 op_sel:[1,0,1] op_sel_hi:[1,0,1]
 v_cvt_pk_bf16_f32 v118, v146, v147
 v_cvt_pk_bf16_f32 v119, v148, v149
 s_waitcnt lgkmcnt(4)
 v_pk_add_f16 v48, v48, v50
 v_pk_add_f16 v52, v52, v54
 v_pk_add_f16 v49, v49, v51
 v_pk_add_f16 v53, v53, v55
 v_fma_mix_f32 v146, v48, 1.0, v52 op_sel:[0,0,0] op_sel_hi:[1,0,1]
 v_fma_mix_f32 v147, v48, 1.0, v52 op_sel:[1,0,1] op_sel_hi:[1,0,1]
 v_fma_mix_f32 v148, v49, 1.0, v53 op_sel:[0,0,0] op_sel_hi:[1,0,1]
 v_fma_mix_f32 v149, v49, 1.0, v53 op_sel:[1,0,1] op_sel_hi:[1,0,1]
 v_cvt_pk_bf16_f32 v120, v146, v147
 v_cvt_pk_bf16_f32 v121, v148, v149
 s_waitcnt lgkmcnt(0)
 v_pk_add_f16 v56, v56, v58
 v_pk_add_f16 v60, v60, v62
 v_pk_add_f16 v57, v57, v59
 v_pk_add_f16 v61, v61, v63
 v_fma_mix_f32 v146, v56, 1.0, v60 op_sel:[0,0,0] op_sel_hi:[1,0,1]
 v_fma_mix_f32 v147, v56, 1.0, v60 op_sel:[1,0,1] op_sel_hi:[1,0,1]
 v_mfma_f32_16x16x32_bf16 v[40:43], v[118:121], v[118:121], 0
 v_fma_mix_f32 v148, v57, 1.0, v61 op_sel:[0,0,0] op_sel_hi:[1,0,1]
 v_fma_mix_f32 v149, v57, 1.0, v61 op_sel:[1,0,1] op_sel_hi:[1,0,1]
 v_cvt_pk_bf16_f32 v122, v146, v147
 v_cvt_pk_bf16_f32 v123, v148, v149
 s_nop 1
 v_mfma_f32_16x16x32_bf16 v[40:43], v[122:125], v[122:125], v[40:43]
 ds_read_b128 v[28:31], v16 offset:24576
 ds_read_b128 v[32:35], v16 offset:25600
 ds_read_b128 v[64:67], v16 offset:27648
 ds_read_b128 v[68:71], v16 offset:28672
 ds_read_b128 v[72:75], v16 offset:30720
 ds_read_b128 v[76:79], v16 offset:31744
 s_nop 0
 s_mov_b64 exec, s[74:75]
 v_cvt_pk_f16_f32 v44, v40, v41
 v_cvt_pk_f16_f32 v45, v42, v43
 v_and_or_b32 v44, v44, -2, s88
 s_cmp_eq_u32 s53, 1
 s_cbranch_scc1 si_97
 buffer_store_dwordx2 v[44:45], v7, s[8:11], s81 offen sc1
 s_branch si_98
si_97:
 buffer_store_dwordx2 v[44:45], v7, s[8:11], s81 offen
si_98:
 s_mov_b64 exec, -1
 s_branch bw_92
bw_96:
 s_lshr_b32 s21, 8, s20
 s_bitcmp1_b32 s21, 0
 s_cbranch_scc0 bw_99
 ds_read_b128 v[28:31], v16 offset:24576
 ds_read_b128 v[32:35], v16 offset:25600
 ds_read_b128 v[64:67], v16 offset:27648
 ds_read_b128 v[68:71], v16 offset:28672
 ds_read_b128 v[72:75], v16 offset:30720
 ds_read_b128 v[76:79], v16 offset:31744
 s_branch bw_92
bw_99:
bw_92:
 ds_read_b128 v[80:83], v16 offset:33792
 ds_read_b128 v[84:87], v16 offset:34816
 ds_read_b64 v[88:89], v16 offset:26624
 ds_read_b64 v[90:91], v16 offset:29696
 ds_read_b64 v[92:93], v16 offset:32768
 ds_read_b64 v[94:95], v16 offset:35840
 s_cmp_eq_u32 s52, 63
 s_cbranch_scc1 last_86
 s_waitcnt lgkmcnt(10)
 v_smfmac_f32_16x16x64_f16 v[100:103], v[28:31], a[120:127], v25
 v_smfmac_f32_16x16x64_f16 v[104:107], v[28:31], a[128:135], v25
 v_smfmac_f32_16x16x64_f16 v[108:111], v[28:31], a[136:143], v25
 s_mov_b32 s54, 0
 v_smfmac_f32_16x16x64_f16 v[100:103], v[32:35], a[144:151], v25
 v_readfirstlane_b32 s21, v0
 v_smfmac_f32_16x16x64_f16 v[104:107], v[32:35], a[152:159], v25
 s_add_u32 s22, s46, 3
 v_smfmac_f32_16x16x64_f16 v[108:111], v[32:35], a[160:167], v25
 s_min_u32 s22, s22, 64
 s_waitcnt lgkmcnt(7)
 v_smfmac_f32_16x16x64_f16 v[100:103], v[64:67], a[168:175], v25
 s_sub_u32 s55, s21, s22
 v_smfmac_f32_16x16x64_f16 v[104:107], v[64:67], a[176:183], v25
 s_sub_u32 s56, s21, s46
 v_smfmac_f32_16x16x64_f16 v[108:111], v[64:67], a[184:191], v25
 v_smfmac_f32_16x16x64_f16 v[100:103], v[68:71], a[192:199], v25
 v_smfmac_f32_16x16x64_f16 v[104:107], v[68:71], a[200:207], v25
 v_smfmac_f32_16x16x64_f16 v[108:111], v[68:71], a[208:215], v25
 v_smfmac_f32_16x16x64_f16 v[100:103], v[72:75], a[216:223], v25
 v_smfmac_f32_16x16x64_f16 v[104:107], v[72:75], a[224:231], v25
 v_smfmac_f32_16x16x64_f16 v[108:111], v[72:75], a[232:239], v25
 s_waitcnt lgkmcnt(4)
 v_smfmac_f32_16x16x64_f16 v[100:103], v[76:79], a[240:247], v25
 v_smfmac_f32_16x16x64_f16 v[104:107], v[76:79], a[248:255], v25
 v_smfmac_f32_16x16x64_f16 v[108:111], v[76:79], v[152:159], v25
 v_smfmac_f32_16x16x64_f16 v[100:103], v[80:83], v[160:167], v25
 v_smfmac_f32_16x16x64_f16 v[104:107], v[80:83], v[168:175], v25
 v_smfmac_f32_16x16x64_f16 v[108:111], v[80:83], v[176:183], v25
 v_smfmac_f32_16x16x64_f16 v[100:103], v[84:87], v[184:191], v25
 v_smfmac_f32_16x16x64_f16 v[104:107], v[84:87], v[192:199], v25
 v_smfmac_f32_16x16x64_f16 v[108:111], v[84:87], v[200:207], v25
 s_waitcnt lgkmcnt(0)
 v_smfmac_f32_16x16x64_f16 v[100:103], v[88:91], v[208:215], v25
 v_smfmac_f32_16x16x64_f16 v[104:107], v[88:91], v[216:223], v25
 v_smfmac_f32_16x16x64_f16 v[108:111], v[88:91], v[224:231], v25
 v_smfmac_f32_16x16x64_f16 v[100:103], v[92:95], v[232:239], v25
 v_smfmac_f32_16x16x64_f16 v[104:107], v[92:95], v[240:247], v25
 v_smfmac_f32_16x16x64_f16 v[108:111], v[92:95], v[248:255], v25
 buffer_load_dwordx2 v[58:59], v9, s[8:11], s81 offen sc1
 buffer_load_dwordx4 v[40:43], v8, s[8:11], s81 offen offset:0 sc1
 buffer_load_dwordx4 v[44:47], v8, s[8:11], s81 offen offset:1024 sc1
 s_cmp_lt_i32 s56, 0
 s_cbranch_scc1 kvw_102
kvok_103:
 s_waitcnt vmcnt(2)
 v_xor_b32 v76, s88, v58
 s_nop 0
 v_permlane16_swap_b32 v58, v59
 v_fma_mix_f32 v60, v58, 1.0, v59 op_sel:[0,0,0] op_sel_hi:[1,0,1]
 v_fma_mix_f32 v61, v58, 1.0, v59 op_sel:[1,0,1] op_sel_hi:[1,0,1]
 v_mov_b32 v58, v60
 v_mov_b32 v59, v61
 s_nop 0
 v_permlane32_swap_b32 v58, v60
 v_permlane32_swap_b32 v59, v61
 v_add_f32 v52, v58, v60
 v_add_f32 v53, v59, v61
 v_max_f32 v79, v52, v53
 s_waitcnt vmcnt(0)
 v_pk_add_f16 v80, v40, v44
 v_pk_add_f16 v82, v42, v46
 v_pk_add_f16 v81, v41, v45
 v_pk_add_f16 v83, v43, v47
 v_permlane32_swap_b32 v80, v82
 v_bitop3_b32 v77, v40, v42, s88 bitop3:0x7e
 v_permlane32_swap_b32 v81, v83
 v_bitop3_b32 v78, v44, v46, s88 bitop3:0x7e
 v_fma_mix_f32 v48, v80, 1.0, v82 op_sel:[0,0,0] op_sel_hi:[1,0,1]
 v_or3_b32 v27, v76, v77, v78
 v_fma_mix_f32 v49, v80, 1.0, v82 op_sel:[1,0,1] op_sel_hi:[1,0,1]
 v_and_b32 v27, 1, v27
 v_fma_mix_f32 v50, v81, 1.0, v83 op_sel:[0,0,0] op_sel_hi:[1,0,1]
 v_cmp_ne_u32 vcc, 0, v27
 v_fma_mix_f32 v51, v81, 1.0, v83 op_sel:[1,0,1] op_sel_hi:[1,0,1]
 v_max3_f32 v62, v48, v49, v79
 s_cbranch_vccnz psr_100
psj_101:
 v_max3_f32 v62, v62, v50, v51
 v_cvt_pk_bf16_f32 v146, v100, v101
 v_cvt_pk_bf16_f32 v147, v102, v103
 v_max_f32_dpp v62, v62, v62 row_ror:8 row_mask:0xf bank_mask:0xf
 v_mov_b32 v63, v62
 v_cvt_pk_bf16_f32 v148, v104, v105
 v_cvt_pk_bf16_f32 v149, v106, v107
 v_permlane32_swap_b32 v62, v63
 v_max_f32 v62, v62, v63
 v_mov_b32 v63, v62
 v_cvt_pk_bf16_f32 v150, v108, v109
 v_cvt_pk_bf16_f32 v151, v110, v111
 v_permlane16_swap_b32 v62, v63
 v_max_f32 v62, v62, v63
 v_mul_f32 v62, s86, v62
 v_fma_f32 v48, v48, s86, -v62
 v_fma_f32 v49, v49, s86, -v62
 v_fma_f32 v50, v50, s86, -v62
 v_fma_f32 v51, v51, s86, -v62
 v_fma_f32 v52, v52, s86, -v62
 v_fma_f32 v53, v53, s86, -v62
 v_exp_f32 v48, v48
 v_exp_f32 v49, v49
 buffer_load_dwordx4 v[88:91], v17, s[28:31], s64 offen offset:0 sc1
 v_exp_f32 v50, v50
 v_exp_f32 v51, v51
 buffer_load_dwordx4 v[92:95], v16, s[28:31], s64 offen offset:1024 sc1
 v_exp_f32 v52, v52
 v_exp_f32 v53, v53
 buffer_load_dwordx4 v[96:99], v20, s[28:31], s64 offen offset:2048 sc1
 v_cvt_pk_bf16_f32 v138, v48, v49
 v_cvt_pk_bf16_f32 v139, v50, v51
 v_cvt_pk_bf16_f32 v142, v52, v53
 v_mov_b32_dpp v140, v138 row_ror:8 row_mask:0xf bank_mask:0xf
 v_mov_b32_dpp v141, v139 row_ror:8 row_mask:0xf bank_mask:0xf
 v_mov_b32_dpp v143, v142 row_ror:8 row_mask:0xf bank_mask:0xf
 s_lshr_b32 s21, 3, s20
 s_bitcmp1_b32 s21, 0
 s_cbranch_scc0 bw_105
 buffer_load_dwordx4 v[112:115], v18, s[16:19], s80 offen sc1
 s_branch bw_104
bw_105:
 s_lshr_b32 s21, 8, s20
 s_bitcmp1_b32 s21, 0
 s_cbranch_scc0 bw_106
 v_mov_b32 v84, s67
 v_mov_b32 v85, s67
 s_mov_b64 exec, 15
 buffer_store_dwordx2 v[84:85], v24, s[12:15], s66 offen sc1
 s_mov_b64 exec, -1
 s_branch bw_104
bw_106:
bw_104:
 v_add_f32 v54, v48, v49
 v_mfma_f32_16x16x32_bf16 v[64:67], v[126:129], v[138:141], 0
 v_add_f32 v55, v50, v51
 v_add_f32 v56, v52, v53
 v_mfma_f32_16x16x32_bf16 v[64:67], v[146:149], v[142:145], v[64:67]
 v_add_f32 v62, v54, v55
 v_fmac_f32 v62, v56, v26
 v_mfma_f32_16x16x32_bf16 v[68:71], v[130:133], v[138:141], 0
 s_lshr_b32 s21, 3, s20
 s_bitcmp1_b32 s21, 0
 s_cbranch_scc0 bw_108
 buffer_load_dwordx2 v[116:117], v19, s[16:19], s80 offen sc1
 s_branch bw_107
bw_108:
bw_107:
 v_add_f32_dpp v62, v62, v62 row_ror:8 row_mask:0xf bank_mask:0xf
 v_mfma_f32_16x16x32_bf16 v[68:71], v[148:151], v[142:145], v[68:71]
 v_mov_b32 v63, v62
 s_cmp_lt_i32 s55, 0
 s_cbranch_scc1 fl_109
fl_110:
 v_mfma_f32_16x16x32_bf16 v[72:75], v[134:137], v[138:141], 0
 v_permlane32_swap_b32 v62, v63
 v_mfma_f32_16x16x32_bf16 v[72:75], v[150:153], v[142:145], v[72:75]
 v_add_f32 v62, v62, v63
 v_mov_b32 v63, v62
 ds_write_b128 v11, v[64:67] offset:0
 s_nop 0
 v_permlane16_swap_b32 v62, v63
 v_add_f32 v62, v62, v63
 v_rcp_f32 v62, v62
 ds_write_b128 v11, v[68:71] offset:1024
 s_mov_b64 exec, 0xff
 ds_write_b32 v22, v62
 s_mov_b64 exec, -1
 ds_write_b128 v11, v[72:75] offset:2048
 s_waitcnt lgkmcnt(0)
 s_barrier
 s_lshr_b32 s21, 7, s20
 s_bitcmp1_b32 s21, 0
 s_cbranch_scc0 bw_112
 ds_read_b128 v[72:75], v23
 ds_read_b64 v[64:65], v12 offset:0
 ds_read_b64 v[66:67], v12 offset:3072
 ds_read_b64 v[68:69], v12 offset:6144
 ds_read_b64 v[70:71], v12 offset:9216
 s_waitcnt lgkmcnt(2)
 v_pk_mul_f32 v[64:65], v[64:65], v[72:73] op_sel_hi:[1,0]
 v_pk_fma_f32 v[64:65], v[66:67], v[72:73], v[64:65] op_sel:[0,1,0] op_sel_hi:[1,1,1]
 s_waitcnt lgkmcnt(0)
 v_pk_fma_f32 v[64:65], v[68:69], v[74:75], v[64:65] op_sel_hi:[1,0,1]
 v_pk_fma_f32 v[64:65], v[70:71], v[74:75], v[64:65] op_sel:[0,1,0] op_sel_hi:[1,1,1]
 v_cvt_pk_f16_f32 v68, v64, v65
 v_perm_b32 v68, s91, v68, v14
 buffer_atomic_pk_add_f16 v68, v13, s[4:7], s3 offen
 s_branch bw_111
bw_112:
 s_lshr_b32 s21, 8, s20
 s_bitcmp1_b32 s21, 0
 s_cbranch_scc0 bw_113
 s_and_b32 s21, s52, 7
 s_cmp_lg_u32 s21, s50
 s_cbranch_scc1 zm_114
 v_mov_b32 v64, 0
 v_mov_b32 v65, 0
 v_mov_b32 v66, 0
 v_mov_b32 v67, 0
 s_mov_b64 exec, s[70:71]
 buffer_store_dwordx4 v[64:67], v13, s[4:7], s83 offen sc1
 s_mov_b64 exec, -1
zm_114:
 s_branch bw_111
bw_113:
bw_111:
 s_lshr_b32 s21, 4, s20
 s_bitcmp1_b32 s21, 0
 s_cbranch_scc0 bw_116
 s_mov_b64 exec, s[62:63]
 buffer_store_dwordx4 v[118:121], v18, s[24:27], s85 offen sc1
 buffer_store_dwordx2 v[122:123], v19, s[24:27], s85 offen sc1
 s_mov_b64 exec, -1
 s_branch bw_115
bw_116:
bw_115:
 v_mov_b32 v76, v108
 v_mov_b32 v77, v109
 v_mov_b32 v78, v110
 v_mov_b32 v79, v111
 v_permlane32_swap_b32 v100, v104
 v_permlane32_swap_b32 v101, v105
 v_permlane32_swap_b32 v102, v106
 v_permlane32_swap_b32 v103, v107
 v_permlane32_swap_b32 v108, v76
 v_permlane32_swap_b32 v109, v77
 v_permlane32_swap_b32 v110, v78
 v_permlane32_swap_b32 v111, v79
 v_pk_add_f32 v[100:101], v[100:101], v[104:105]
 v_pk_add_f32 v[102:103], v[102:103], v[106:107]
 v_pk_add_f32 v[108:109], v[108:109], v[76:77]
 v_pk_add_f32 v[110:111], v[110:111], v[78:79]
 v_cvt_pk_bf16_f32 v80, v100, v101
 v_cvt_pk_bf16_f32 v82, v108, v109
 v_cvt_pk_bf16_f32 v81, v102, v103
 v_cvt_pk_bf16_f32 v83, v110, v111
 s_nop 0
 v_permlane16_swap_b32 v80, v82
 v_permlane16_swap_b32 v81, v83
 v_min_u32 v80, -2, v80
 s_mov_b64 exec, s[76:77]
 buffer_store_dwordx4 v[80:83], v15, s[24:27], s57 offen sc1
 s_mov_b64 exec, -1
 s_add_u32 s64, s64, 1310720
 s_add_u32 s52, s52, 1
 s_branch step_85
fl_90:
 buffer_load_dword v0, off, s[12:15], s79 sc1
 s_branch fl_91
A1_19:
 v_smfmac_f32_16x16x32_f16 v[40:43], v[36:37], a[16:19], v25
 v_smfmac_f32_16x16x32_f16 v[52:55], v[36:37], a[76:79], v25
 v_smfmac_f32_16x16x32_f16 v[44:47], v[36:37], a[36:39], v25
 v_smfmac_f32_16x16x32_f16 v[56:59], v[36:37], a[96:99], v25
 s_branch A2_89
pm_88:
 buffer_load_dwordx4 v[36:39], v4, s[4:7], s84 offen offset:2048 sc1
 buffer_load_dwordx4 v[28:31], v4, s[4:7], s84 offen offset:0 sc1
 buffer_load_dwordx4 v[32:35], v4, s[4:7], s84 offen offset:1024 sc1
 s_nop 7
 v_mov_b32 v40, 0
 v_mov_b32 v41, 0
 v_mov_b32 v42, 0
 v_mov_b32 v43, 0
 v_mov_b32 v52, 0
 v_mov_b32 v53, 0
 v_mov_b32 v54, 0
 v_mov_b32 v55, 0
 v_mov_b32 v44, 0
 v_mov_b32 v45, 0
 v_mov_b32 v46, 0
 v_mov_b32 v47, 0
 v_mov_b32 v56, 0
 v_mov_b32 v57, 0
 v_mov_b32 v58, 0
 v_mov_b32 v59, 0
 s_waitcnt vmcnt(0)
 v_bitop3_b32 v27, v31, v35, v39 bitop3:0x80
 v_perm_b32 v31, v35, v31, s89
 v_cmp_gt_u32 vcc, 0x48000000, v27
 v_mov_b32 v35, v38
 s_cbranch_vccz A1_19
pm_87:
 s_cmp_gt_u32 s52, 3
 s_cbranch_scc1 op_117
 v_readfirstlane_b32 s21, v0
 s_cmp_ge_u32 s21, s46
 s_cbranch_scc1 op_117
 buffer_load_dword v0, off, s[12:15], s79 sc1
 s_waitcnt vmcnt(0)
 v_readfirstlane_b32 s21, v0
 s_cmp_gt_u32 s21, s52
 s_cselect_b32 s21, s87, 0
 s_cmp_eq_u32 s21, 0
 s_cbranch_scc1 op_117
 s_mov_b32 s87, 0
 s_sub_u32 s21, s64, 1310720
 buffer_load_dwordx4 v[126:129], v16, s[28:31], s21 offen offset:0 sc1
 buffer_load_dwordx4 v[130:133], v16, s[28:31], s21 offen offset:1024 sc1
 buffer_load_dwordx4 v[134:137], v16, s[28:31], s21 offen offset:2048 sc1
op_117:
 buffer_load_dwordx4 v[36:39], v4, s[4:7], s84 offen offset:2048 sc1
 buffer_load_dwordx4 v[28:31], v4, s[4:7], s84 offen offset:0 sc1
 buffer_load_dwordx4 v[32:35], v4, s[4:7], s84 offen offset:1024 sc1
 s_add_u32 s54, s54, 1
 s_cmp_gt_u32 s54, 131072
 s_cbranch_scc1 end0
 s_waitcnt vmcnt(0)
 v_bitop3_b32 v27, v31, v35, v39 bitop3:0x80
 v_perm_b32 v31, v35, v31, s89
 v_cmp_gt_u32 vcc, 0x48000000, v27
 v_mov_b32 v35, v38
 s_cbranch_vccnz pm_87
 s_branch A1_19
psr_100:
 buffer_load_dwordx2 v[58:59], v9, s[8:11], s81 offen sc1
 buffer_load_dwordx4 v[40:43], v8, s[8:11], s81 offen offset:0 sc1
 buffer_load_dwordx4 v[44:47], v8, s[8:11], s81 offen offset:1024 sc1
 s_add_u32 s54, s54, 1
 s_cmp_gt_u32 s54, 131072
 s_cbranch_scc1 end0
 s_waitcnt vmcnt(2)
 v_xor_b32 v76, s88, v58
 s_nop 0
 v_permlane16_swap_b32 v58, v59
 v_fma_mix_f32 v60, v58, 1.0, v59 op_sel:[0,0,0] op_sel_hi:[1,0,1]
 v_fma_mix_f32 v61, v58, 1.0, v59 op_sel:[1,0,1] op_sel_hi:[1,0,1]
 v_mov_b32 v58, v60
 v_mov_b32 v59, v61
 s_nop 0
 v_permlane32_swap_b32 v58, v60
 v_permlane32_swap_b32 v59, v61
 v_add_f32 v52, v58, v60
 v_add_f32 v53, v59, v61
 v_max_f32 v79, v52, v53
 s_waitcnt vmcnt(0)
 v_pk_add_f16 v80, v40, v44
 v_pk_add_f16 v82, v42, v46
 v_pk_add_f16 v81, v41, v45
 v_pk_add_f16 v83, v43, v47
 v_permlane32_swap_b32 v80, v82
 v_bitop3_b32 v77, v40, v42, s88 bitop3:0x7e
 v_permlane32_swap_b32 v81, v83
 v_bitop3_b32 v78, v44, v46, s88 bitop3:0x7e
 v_fma_mix_f32 v48, v80, 1.0, v82 op_sel:[0,0,0] op_sel_hi:[1,0,1]
 v_or3_b32 v27, v76, v77, v78
 v_fma_mix_f32 v49, v80, 1.0, v82 op_sel:[1,0,1] op_sel_hi:[1,0,1]
 v_and_b32 v27, 1, v27
 v_fma_mix_f32 v50, v81, 1.0, v83 op_sel:[0,0,0] op_sel_hi:[1,0,1]
 v_cmp_ne_u32 vcc, 0, v27
 v_fma_mix_f32 v51, v81, 1.0, v83 op_sel:[1,0,1] op_sel_hi:[1,0,1]
 v_max3_f32 v62, v48, v49, v79
 s_cbranch_vccnz psr_100
 s_branch psj_101
kvw_102:
 s_mov_b32 s22, s87
 s_cmp_eq_u32 s52, 0
 s_cselect_b32 s55, 0, s55
 s_cselect_b32 s87, 1, 0
 s_cbranch_scc1 kvok_103
 v_mov_b32 v62, 0
 s_mov_b32 s101, 0
wf_118:
 buffer_load_dword v63, v62, s[12:15], s79 offen sc1
 s_add_u32 s101, s101, 1
 s_cmp_gt_u32 s101, 131072
 s_cbranch_scc1 end0
 s_waitcnt vmcnt(0)
 v_readfirstlane_b32 s100, v63
 s_cmp_ge_u32 s100, s46
 s_cbranch_scc1 wf_119
 s_sleep 3
 s_branch wf_118
wf_119:
 s_cmp_eq_u32 s22, 0
 s_cbranch_scc1 kvok_103
 s_sub_u32 s21, s64, 1310720
 buffer_load_dwordx4 v[126:129], v16, s[28:31], s21 offen offset:0 sc1
 buffer_load_dwordx4 v[130:133], v16, s[28:31], s21 offen offset:1024 sc1
 buffer_load_dwordx4 v[134:137], v16, s[28:31], s21 offen offset:2048 sc1
 s_waitcnt vmcnt(0)
 s_branch kvok_103
fl_109:
 buffer_load_dword v0, off, s[12:15], s79 sc1
 s_branch fl_110
last_86:
 s_lshr_b32 s21, 4, s20
 s_bitcmp1_b32 s21, 0
 s_cbranch_scc0 bw_121
 s_mov_b64 exec, s[62:63]
 buffer_store_dwordx4 v[118:121], v18, s[24:27], s85 offen sc1
 buffer_store_dwordx2 v[122:123], v19, s[24:27], s85 offen sc1
 s_mov_b64 exec, -1
 s_branch bw_120
bw_121:
bw_120:
 s_waitcnt lgkmcnt(10)
 v_smfmac_f32_16x16x64_f16 v[100:103], v[28:31], a[120:127], v25
 v_smfmac_f32_16x16x64_f16 v[104:107], v[28:31], a[128:135], v25
 v_smfmac_f32_16x16x64_f16 v[108:111], v[28:31], a[136:143], v25
 v_smfmac_f32_16x16x64_f16 v[100:103], v[32:35], a[144:151], v25
 v_smfmac_f32_16x16x64_f16 v[104:107], v[32:35], a[152:159], v25
 v_smfmac_f32_16x16x64_f16 v[108:111], v[32:35], a[160:167], v25
 s_waitcnt lgkmcnt(7)
 v_smfmac_f32_16x16x64_f16 v[100:103], v[64:67], a[168:175], v25
 v_smfmac_f32_16x16x64_f16 v[104:107], v[64:67], a[176:183], v25
 v_smfmac_f32_16x16x64_f16 v[108:111], v[64:67], a[184:191], v25
 v_smfmac_f32_16x16x64_f16 v[100:103], v[68:71], a[192:199], v25
 v_smfmac_f32_16x16x64_f16 v[104:107], v[68:71], a[200:207], v25
 v_smfmac_f32_16x16x64_f16 v[108:111], v[68:71], a[208:215], v25
 v_smfmac_f32_16x16x64_f16 v[100:103], v[72:75], a[216:223], v25
 v_smfmac_f32_16x16x64_f16 v[104:107], v[72:75], a[224:231], v25
 v_smfmac_f32_16x16x64_f16 v[108:111], v[72:75], a[232:239], v25
 s_waitcnt lgkmcnt(4)
 v_smfmac_f32_16x16x64_f16 v[100:103], v[76:79], a[240:247], v25
 v_smfmac_f32_16x16x64_f16 v[104:107], v[76:79], a[248:255], v25
 v_smfmac_f32_16x16x64_f16 v[108:111], v[76:79], v[152:159], v25
 v_smfmac_f32_16x16x64_f16 v[100:103], v[80:83], v[160:167], v25
 v_smfmac_f32_16x16x64_f16 v[104:107], v[80:83], v[168:175], v25
 v_smfmac_f32_16x16x64_f16 v[108:111], v[80:83], v[176:183], v25
 v_smfmac_f32_16x16x64_f16 v[100:103], v[84:87], v[184:191], v25
 v_smfmac_f32_16x16x64_f16 v[104:107], v[84:87], v[192:199], v25
 v_smfmac_f32_16x16x64_f16 v[108:111], v[84:87], v[200:207], v25
 s_waitcnt lgkmcnt(0)
 v_smfmac_f32_16x16x64_f16 v[100:103], v[88:91], v[208:215], v25
 v_smfmac_f32_16x16x64_f16 v[104:107], v[88:91], v[216:223], v25
 v_smfmac_f32_16x16x64_f16 v[108:111], v[88:91], v[224:231], v25
 v_smfmac_f32_16x16x64_f16 v[100:103], v[92:95], v[232:239], v25
 v_smfmac_f32_16x16x64_f16 v[104:107], v[92:95], v[240:247], v25
 v_smfmac_f32_16x16x64_f16 v[108:111], v[92:95], v[248:255], v25
 s_nop 7
 v_mov_b32 v76, v108
 v_mov_b32 v77, v109
 v_mov_b32 v78, v110
 v_mov_b32 v79, v111
 v_permlane32_swap_b32 v100, v104
 v_permlane32_swap_b32 v101, v105
 v_permlane32_swap_b32 v102, v106
 v_permlane32_swap_b32 v103, v107
 v_permlane32_swap_b32 v108, v76
 v_permlane32_swap_b32 v109, v77
 v_permlane32_swap_b32 v110, v78
 v_permlane32_swap_b32 v111, v79
 v_pk_add_f32 v[100:101], v[100:101], v[104:105]
 v_pk_add_f32 v[102:103], v[102:103], v[106:107]
 v_pk_add_f32 v[108:109], v[108:109], v[76:77]
 v_pk_add_f32 v[110:111], v[110:111], v[78:79]
 v_cvt_pk_bf16_f32 v80, v100, v101
 v_cvt_pk_bf16_f32 v82, v108, v109
 v_cvt_pk_bf16_f32 v81, v102, v103
 v_cvt_pk_bf16_f32 v83, v110, v111
 s_nop 0
 v_permlane16_swap_b32 v80, v82
 v_permlane16_swap_b32 v81, v83
 v_min_u32 v80, -2, v80
 s_mov_b64 exec, s[76:77]
 buffer_store_dwordx4 v[80:83], v15, s[24:27], s57 offen sc1
 s_mov_b64 exec, -1
 s_lshr_b32 s21, 1, s20
 s_bitcmp1_b32 s21, 0
 s_cbranch_scc0 bw_123
 v_mov_b32 v246, 80
 v_mov_b32 v247, 1
 s_mov_b64 exec, 1
 buffer_atomic_add v247, v246, s[32:35], 0 offen sc0 sc1
 s_mov_b64 exec, -1
 s_branch bw_122
bw_123:
bw_122:
 s_branch chain_done
chain_done:
 s_waitcnt vmcnt(0) lgkmcnt(0)
 s_barrier
 s_mov_b32 s84, 0
 s_mov_b32 s85, -1
 s_mov_b32 s86, 0
 v_mov_b32 v21, 0
 v_mov_b32 v23, v247
 s_cmp_lg_u32 s20, 0
 s_cbranch_scc1 queue_b
 s_mov_b64 exec, 1
 s_branch queue_a
end0:
 s_endpgm
gemm_side:
 s_bfe_u32 s23, s22, 0x20005
 s_add_u32 s22, s22, 31
 s_and_b32 s22, s22, 31
 s_lshl_b32 s21, s23, 3
 s_add_u32 s2, s21, s22
 s_add_u32 s3, s2, 72
 s_add_u32 s24, s2, 48
 s_add_u32 s2, s2, s21
 s_cmp_lt_u32 s22, 24
 s_cselect_b32 s3, s24, s3
 s_cmp_lt_u32 s22, 16
 s_cselect_b32 s3, s2, s3
 s_mov_b32 s2, s3
gemm_roles:
 s_cmp_ge_u32 s3, 64
 s_cbranch_scc1 not_kv
 s_load_dwordx2 s[4:5], s[0:1], 0
 s_load_dwordx2 s[6:7], s[0:1], 24
 s_load_dwordx2 s[36:37], s[0:1], 32
 s_load_dwordx2 s[38:39], s[0:1], 104
 s_and_b32 s43, s3, 1
 s_bfe_u32 s42, s3, 0x50001
 s_lshr_b32 s40, s42, 2
 s_waitcnt lgkmcnt(0)
 s_cmp_eq_u32 s43, 1
 s_cselect_b32 s6, s36, s6
 s_cselect_b32 s7, s37, s7
 s_mov_b32 s8, s4
 s_mov_b32 s9, s5
 s_mov_b32 s10, 2621440
 s_mov_b32 s11, 0x00020000
 s_mov_b32 s12, s6
 s_mov_b32 s13, s7
 s_mov_b32 s14, 7864320
 s_mov_b32 s15, 0x00020000
 s_mov_b32 s16, s38
 s_mov_b32 s17, s39
 s_mov_b32 s18, 50331648
 s_mov_b32 s19, 0x00020000
 s_mul_i32 s44, s42, 384
 s_mov_b32 s62, 1024
 s_mov_b32 s24, 0
 s_mov_b32 s25, 81920
 s_mov_b32 s64, s32
 s_mov_b32 s65, s33
 s_mov_b32 s66, s34
 s_mov_b32 s67, s35
 s_load_dwordx2 s[72:73], s[0:1], 104
 s_waitcnt lgkmcnt(0)
 s_add_u32 s72, s72, 81068032
 s_addc_u32 s73, s73, 0
 s_mov_b32 s74, 129024
 s_mov_b32 s75, 0x00020000
 v_mov_b32 v9, 2731
 v_add_u32 v8, 0, v1
 v_mul_u32_u24 v7, v8, v9
 v_lshrrev_b32 v7, 16, v7
 v_mul_u32_u24 v4, 24, v7
 v_sub_u32 v8, v8, v4
 v_and_b32 v4, 2, v7
 v_xor_b32 v8, v8, v4
 v_xor_b32 v5, 4, v8
 s_mov_b32 s21, 12288
 v_mul_lo_u32 v7, v7, s21
 v_lshl_add_u32 v40, v8, 4, v7
 v_lshl_add_u32 v43, v5, 4, v7
 v_add_u32 v8, 64, v1
 v_mul_u32_u24 v7, v8, v9
 v_lshrrev_b32 v7, 16, v7
 v_mul_u32_u24 v4, 24, v7
 v_sub_u32 v8, v8, v4
 v_and_b32 v4, 2, v7
 v_xor_b32 v8, v8, v4
 v_xor_b32 v5, 4, v8
 s_mov_b32 s21, 12288
 v_mul_lo_u32 v7, v7, s21
 v_lshl_add_u32 v41, v8, 4, v7
 v_lshl_add_u32 v44, v5, 4, v7
 v_add_u32 v8, 128, v1
 v_mul_u32_u24 v7, v8, v9
 v_lshrrev_b32 v7, 16, v7
 v_mul_u32_u24 v4, 24, v7
 v_sub_u32 v8, v8, v4
 v_and_b32 v4, 2, v7
 v_xor_b32 v8, v8, v4
 v_xor_b32 v5, 4, v8
 s_mov_b32 s21, 12288
 v_mul_lo_u32 v7, v7, s21
 v_lshl_add_u32 v42, v8, 4, v7
 v_lshl_add_u32 v45, v5, 4, v7
 s_mul_i32 s21, s20, 393216
 s_add_u32 s21, s21, 0
 s_add_u32 s21, s21, s44
 s_mul_i32 s22, s20, 12288
 s_add_u32 s22, s22, 0
 s_add_u32 m0, s22, 0
 s_nop 0
 buffer_load_dwordx4 v40, s[12:15], s21 offen lds
 s_add_u32 m0, s22, 1024
 s_nop 0
 buffer_load_dwordx4 v41, s[12:15], s21 offen lds
 s_add_u32 m0, s22, 2048
 s_nop 0
 buffer_load_dwordx4 v42, s[12:15], s21 offen lds
 s_mul_i32 s21, s20, 393216
 s_add_u32 s21, s21, 98304
 s_add_u32 s21, s21, s44
 s_mul_i32 s22, s20, 12288
 s_add_u32 s22, s22, 3072
 s_add_u32 m0, s22, 0
 s_nop 0
 buffer_load_dwordx4 v43, s[12:15], s21 offen lds
 s_add_u32 m0, s22, 1024
 s_nop 0
 buffer_load_dwordx4 v44, s[12:15], s21 offen lds
 s_add_u32 m0, s22, 2048
 s_nop 0
 buffer_load_dwordx4 v45, s[12:15], s21 offen lds
 s_mul_i32 s21, s20, 393216
 s_add_u32 s21, s21, 196608
 s_add_u32 s21, s21, s44
 s_mul_i32 s22, s20, 12288
 s_add_u32 s22, s22, 6144
 s_add_u32 m0, s22, 0
 s_nop 0
 buffer_load_dwordx4 v40, s[12:15], s21 offen lds
 s_add_u32 m0, s22, 1024
 s_nop 0
 buffer_load_dwordx4 v41, s[12:15], s21 offen lds
 s_add_u32 m0, s22, 2048
 s_nop 0
 buffer_load_dwordx4 v42, s[12:15], s21 offen lds
 s_mul_i32 s21, s20, 393216
 s_add_u32 s21, s21, 294912
 s_add_u32 s21, s21, s44
 s_mul_i32 s22, s20, 12288
 s_add_u32 s22, s22, 9216
 s_add_u32 m0, s22, 0
 s_nop 0
 buffer_load_dwordx4 v43, s[12:15], s21 offen lds
 s_add_u32 m0, s22, 1024
 s_nop 0
 buffer_load_dwordx4 v44, s[12:15], s21 offen lds
 s_add_u32 m0, s22, 2048
 s_nop 0
 buffer_load_dwordx4 v45, s[12:15], s21 offen lds
 v_lshrrev_b32 v11, 3, v1
 v_and_b32 v12, 7, v1
 v_xor_b32 v12, v12, v11
 v_mul_u32_u24 v11, 1280, v11
 v_lshl_add_u32 v10, v12, 4, v11
 s_mul_i32 s46, s20, 20480
 v_add_u32 v10, s46, v10
 s_lshl_b32 s47, s20, 11
 s_add_u32 s47, s47, 98304
 s_add_u32 s46, s47, 57344
 s_mov_b32 s30, s24
 s_add_u32 s32, s47, 0
 v_add_u32 v11, 9216, v10
 s_mov_b32 m0, s32
 s_nop 0
 buffer_load_dwordx4 v10, s[8:11], s30 offen offset:0 lds
 buffer_load_dwordx4 v11, s[8:11], s30 offen offset:1024 lds
 s_add_u32 s30, s30, 128
 s_add_u32 s32, s32, 8192
 s_cmp_lt_u32 s32, s46
 s_cselect_b32 s32, s32, s47
 s_mov_b32 m0, s32
 s_nop 0
 buffer_load_dwordx4 v10, s[8:11], s30 offen offset:0 lds
 buffer_load_dwordx4 v11, s[8:11], s30 offen offset:1024 lds
 s_add_u32 s30, s30, 128
 s_add_u32 s32, s32, 8192
 s_cmp_lt_u32 s32, s46
 s_cselect_b32 s32, s32, s47
 s_mov_b32 m0, s32
 s_nop 0
 buffer_load_dwordx4 v10, s[8:11], s30 offen offset:0 lds
 buffer_load_dwordx4 v11, s[8:11], s30 offen offset:1024 lds
 s_add_u32 s30, s30, 128
 s_add_u32 s32, s32, 8192
 s_cmp_lt_u32 s32, s46
 s_cselect_b32 s32, s32, s47
 s_mov_b32 m0, s32
 s_nop 0
 buffer_load_dwordx4 v10, s[8:11], s30 offen offset:0 lds
 buffer_load_dwordx4 v11, s[8:11], s30 offen offset:1024 lds
 s_add_u32 s30, s30, 128
 s_add_u32 s32, s32, 8192
 s_cmp_lt_u32 s32, s46
 s_cselect_b32 s32, s32, s47
 s_mov_b32 m0, s32
 s_nop 0
 buffer_load_dwordx4 v10, s[8:11], s30 offen offset:0 lds
 buffer_load_dwordx4 v11, s[8:11], s30 offen offset:1024 lds
 s_add_u32 s30, s30, 128
 s_add_u32 s32, s32, 8192
 s_cmp_lt_u32 s32, s46
 s_cselect_b32 s32, s32, s47
 s_mul_i32 s21, s20, 393216
 s_add_u32 s21, s21, 1572864
 s_add_u32 s21, s21, s44
 s_mul_i32 s22, s20, 12288
 s_add_u32 s22, s22, 49152
 s_add_u32 m0, s22, 0
 s_nop 0
 buffer_load_dwordx4 v40, s[12:15], s21 offen lds
 s_add_u32 m0, s22, 1024
 s_nop 0
 buffer_load_dwordx4 v41, s[12:15], s21 offen lds
 s_add_u32 m0, s22, 2048
 s_nop 0
 buffer_load_dwordx4 v42, s[12:15], s21 offen lds
 s_mul_i32 s21, s20, 393216
 s_add_u32 s21, s21, 1671168
 s_add_u32 s21, s21, s44
 s_mul_i32 s22, s20, 12288
 s_add_u32 s22, s22, 52224
 s_add_u32 m0, s22, 0
 s_nop 0
 buffer_load_dwordx4 v43, s[12:15], s21 offen lds
 s_add_u32 m0, s22, 1024
 s_nop 0
 buffer_load_dwordx4 v44, s[12:15], s21 offen lds
 s_add_u32 m0, s22, 2048
 s_nop 0
 buffer_load_dwordx4 v45, s[12:15], s21 offen lds
 s_mul_i32 s21, s20, 393216
 s_add_u32 s21, s21, 1769472
 s_add_u32 s21, s21, s44
 s_mul_i32 s22, s20, 12288
 s_add_u32 s22, s22, 55296
 s_add_u32 m0, s22, 0
 s_nop 0
 buffer_load_dwordx4 v40, s[12:15], s21 offen lds
 s_add_u32 m0, s22, 1024
 s_nop 0
 buffer_load_dwordx4 v41, s[12:15], s21 offen lds
 s_add_u32 m0, s22, 2048
 s_nop 0
 buffer_load_dwordx4 v42, s[12:15], s21 offen lds
 s_mul_i32 s21, s20, 393216
 s_add_u32 s21, s21, 1867776
 s_add_u32 s21, s21, s44
 s_mul_i32 s22, s20, 12288
 s_add_u32 s22, s22, 58368
 s_add_u32 m0, s22, 0
 s_nop 0
 buffer_load_dwordx4 v43, s[12:15], s21 offen lds
 s_add_u32 m0, s22, 1024
 s_nop 0
 buffer_load_dwordx4 v44, s[12:15], s21 offen lds
 s_add_u32 m0, s22, 2048
 s_nop 0
 buffer_load_dwordx4 v45, s[12:15], s21 offen lds
 v_lshrrev_b32 v7, 2, v2
 v_and_b32 v4, 2, v7
 v_and_b32 v5, 1, v3
 v_lshl_or_b32 v4, v5, 2, v4
 v_lshl_add_u32 v7, v3, 3, v7
 v_mul_u32_u24 v7, 384, v7
 v_and_b32 v5, 1, v2
 v_lshl_add_u32 v7, v5, 3, v7
 v_bfe_u32 v8, v2, 1, 1
 s_mul_i32 s21, s20, 6
 v_add_u32 v8, s21, v8
 v_add_u32 v5, 0, v8
 v_xor_b32 v5, v5, v4
 v_lshl_add_u32 v46, v5, 4, v7
 v_add_u32 v49, 49152, v46
 v_add_u32 v5, 2, v8
 v_xor_b32 v5, v5, v4
 v_lshl_add_u32 v47, v5, 4, v7
 v_add_u32 v50, 49152, v47
 v_add_u32 v5, 4, v8
 v_xor_b32 v5, v5, v4
 v_lshl_add_u32 v48, v5, 4, v7
 v_add_u32 v51, 49152, v48
 s_mov_b32 s26, 6
 s_mul_i32 s27, s42, 12288
 s_mul_i32 s21, s43, 25165824
 s_add_u32 s27, s27, s21
 s_mov_b32 s28, 786432
 s_lshl_b32 s60, s40, 7
 s_add_u32 s60, s60, 0
 s_mov_b32 s61, 0
 v_and_b32 v6, 7, v2
 v_add_u32 v4, 0, v3
 v_xor_b32 v4, v4, v6
 v_lshlrev_b32 v4, 4, v4
 v_lshl_add_u32 v14, v2, 7, v4
 v_add_u32 v4, 4, v3
 v_xor_b32 v4, v4, v6
 v_lshlrev_b32 v4, 4, v4
 v_lshl_add_u32 v15, v2, 7, v4
 v_mul_u32_u24 v22, 400, v2
 v_mul_u32_u24 v4, 16, v3
 s_mul_i32 s21, s20, 96
 s_add_u32 s21, s21, 0
 v_add3_u32 v22, v22, v4, s21
 v_lshlrev_b32 v4, 3, v3
 v_sub_u32 v16, v22, v4
 v_mov_b32 v9, 2731
 s_mul_i32 s21, s20, 6400
 s_add_u32 s21, s21, 0
 v_mul_u32_u24 v4, 400, v2
 v_lshlrev_b32 v5, 4, v3
 v_add3_u32 v23, v4, v5, s21
 v_lshlrev_b32 v26, 4, v1
 s_mov_b32 s33, 98304
 s_mov_b32 s48, 0x80000000
 s_mov_b32 m0, s32
 s_nop 0
 buffer_load_dwordx4 v10, s[8:11], s30 offen offset:0 lds
 s_waitcnt vmcnt(21)
 s_barrier
 v_add_u32 v18, s33, v14
 v_add_u32 v19, s33, v15
 s_add_u32 s33, s33, 8192
 s_cmp_lt_u32 s33, 155648
 s_cselect_b32 s33, s33, 98304
 ds_read_b128 v[160:163], v18 offset:0
 ds_read_b128 v[164:167], v18 offset:2048
 ds_read_b128 v[168:171], v18 offset:4096
 ds_read_b128 v[172:175], v18 offset:6144
 s_waitcnt lgkmcnt(0)
 s_waitcnt vmcnt(23)
 s_barrier
 ds_read_b64_tr_b16 a[0:1], v46 offset:0
 ds_read_b64_tr_b16 a[2:3], v46 offset:1536
 ds_read_b64_tr_b16 a[4:5], v47 offset:0
 ds_read_b64_tr_b16 a[6:7], v47 offset:1536
 ds_read_b64_tr_b16 a[8:9], v48 offset:0
 ds_read_b64_tr_b16 a[10:11], v48 offset:1536
 ds_read_b64_tr_b16 a[12:13], v46 offset:12288
 ds_read_b64_tr_b16 a[14:15], v46 offset:13824
 ds_read_b64_tr_b16 a[16:17], v47 offset:12288
 ds_read_b64_tr_b16 a[18:19], v47 offset:13824
 ds_read_b64_tr_b16 a[20:21], v48 offset:12288
 ds_read_b64_tr_b16 a[22:23], v48 offset:13824
 ds_read_b64_tr_b16 a[24:25], v46 offset:24576
 ds_read_b64_tr_b16 a[26:27], v46 offset:26112
 ds_read_b64_tr_b16 a[28:29], v47 offset:24576
 ds_read_b64_tr_b16 a[30:31], v47 offset:26112
 ds_read_b64_tr_b16 a[32:33], v48 offset:24576
 ds_read_b64_tr_b16 a[34:35], v48 offset:26112
 ds_read_b64_tr_b16 a[36:37], v46 offset:36864
 ds_read_b64_tr_b16 a[38:39], v46 offset:38400
 ds_read_b64_tr_b16 a[40:41], v47 offset:36864
 ds_read_b64_tr_b16 a[42:43], v47 offset:38400
 ds_read_b64_tr_b16 a[44:45], v48 offset:36864
 ds_read_b64_tr_b16 a[46:47], v48 offset:38400
 s_waitcnt lgkmcnt(0)
 s_barrier
 s_mov_b32 s23, m0
 s_mul_i32 s21, s20, 393216
 s_add_u32 s21, s21, 3145728
 s_add_u32 s21, s21, s44
 s_mul_i32 s22, s20, 12288
 s_add_u32 s22, s22, 0
 s_add_u32 m0, s22, 0
 s_nop 0
 buffer_load_dwordx4 v40, s[12:15], s21 offen lds
 s_add_u32 m0, s22, 1024
 s_nop 0
 buffer_load_dwordx4 v41, s[12:15], s21 offen lds
 s_add_u32 m0, s22, 2048
 s_nop 0
 buffer_load_dwordx4 v42, s[12:15], s21 offen lds
 s_mul_i32 s21, s20, 393216
 s_add_u32 s21, s21, 3244032
 s_add_u32 s21, s21, s44
 s_mul_i32 s22, s20, 12288
 s_add_u32 s22, s22, 3072
 s_add_u32 m0, s22, 0
 s_nop 0
 buffer_load_dwordx4 v43, s[12:15], s21 offen lds
 s_add_u32 m0, s22, 1024
 s_nop 0
 buffer_load_dwordx4 v44, s[12:15], s21 offen lds
 s_add_u32 m0, s22, 2048
 s_nop 0
 buffer_load_dwordx4 v45, s[12:15], s21 offen lds
 s_mul_i32 s21, s20, 393216
 s_add_u32 s21, s21, 3342336
 s_add_u32 s21, s21, s44
 s_mul_i32 s22, s20, 12288
 s_add_u32 s22, s22, 6144
 s_add_u32 m0, s22, 0
 s_nop 0
 buffer_load_dwordx4 v40, s[12:15], s21 offen lds
 s_add_u32 m0, s22, 1024
 s_nop 0
 buffer_load_dwordx4 v41, s[12:15], s21 offen lds
 s_add_u32 m0, s22, 2048
 s_nop 0
 buffer_load_dwordx4 v42, s[12:15], s21 offen lds
 s_mul_i32 s21, s20, 393216
 s_add_u32 s21, s21, 3440640
 s_add_u32 s21, s21, s44
 s_mul_i32 s22, s20, 12288
 s_add_u32 s22, s22, 9216
 s_add_u32 m0, s22, 0
 s_nop 0
 buffer_load_dwordx4 v43, s[12:15], s21 offen lds
 s_add_u32 m0, s22, 1024
 s_nop 0
 buffer_load_dwordx4 v44, s[12:15], s21 offen lds
 s_add_u32 m0, s22, 2048
 s_nop 0
 buffer_load_dwordx4 v45, s[12:15], s21 offen lds
 s_mov_b32 m0, s23
 v_mfma_f32_16x16x32_bf16 v[64:67], a[0:3], v[160:163], 0
 ds_read_b128 v[192:195], v19 offset:0
 v_mfma_f32_16x16x32_bf16 v[68:71], a[4:7], v[160:163], 0
 v_add_u32 v18, s33, v14
 v_mfma_f32_16x16x32_bf16 v[72:75], a[8:11], v[160:163], 0
 v_mfma_f32_16x16x32_bf16 v[76:79], a[0:3], v[164:167], 0
 ds_read_b128 v[196:199], v19 offset:2048
 v_mfma_f32_16x16x32_bf16 v[80:83], a[4:7], v[164:167], 0
 buffer_load_dwordx4 v11, s[8:11], s30 offen offset:1024 lds
 v_mfma_f32_16x16x32_bf16 v[84:87], a[8:11], v[164:167], 0
 s_add_u32 s30, s30, 128
 v_mfma_f32_16x16x32_bf16 v[88:91], a[0:3], v[168:171], 0
 ds_read_b128 v[200:203], v19 offset:4096
 s_add_u32 m0, m0, 8192
 v_mfma_f32_16x16x32_bf16 v[92:95], a[4:7], v[168:171], 0
 s_cmp_lt_u32 m0, s46
 s_cselect_b32 m0, m0, s47
 v_mfma_f32_16x16x32_bf16 v[96:99], a[8:11], v[168:171], 0
 v_mfma_f32_16x16x32_bf16 v[100:103], a[0:3], v[172:175], 0
 ds_read_b128 v[204:207], v19 offset:6144
 v_mfma_f32_16x16x32_bf16 v[104:107], a[4:7], v[172:175], 0
 v_mfma_f32_16x16x32_bf16 v[108:111], a[8:11], v[172:175], 0
 s_waitcnt vmcnt(32) lgkmcnt(2)
 s_barrier
 v_mfma_f32_16x16x32_bf16 v[64:67], a[12:15], v[192:195], v[64:67]
 ds_read_b128 v[160:163], v18 offset:0
 v_mfma_f32_16x16x32_bf16 v[68:71], a[16:19], v[192:195], v[68:71]
 v_mfma_f32_16x16x32_bf16 v[72:75], a[20:23], v[192:195], v[72:75]
 v_add_u32 v19, s33, v15
 s_add_u32 s33, s33, 8192
 v_mfma_f32_16x16x32_bf16 v[76:79], a[12:15], v[196:199], v[76:79]
 ds_read_b128 v[164:167], v18 offset:2048
 v_mfma_f32_16x16x32_bf16 v[80:83], a[16:19], v[196:199], v[80:83]
 buffer_load_dwordx4 v10, s[8:11], s30 offen offset:0 lds
 v_mfma_f32_16x16x32_bf16 v[84:87], a[20:23], v[196:199], v[84:87]
 s_waitcnt lgkmcnt(2)
 v_mfma_f32_16x16x32_bf16 v[88:91], a[12:15], v[200:203], v[88:91]
 ds_read_b128 v[168:171], v18 offset:4096
 v_mfma_f32_16x16x32_bf16 v[92:95], a[16:19], v[200:203], v[92:95]
 s_cmp_lt_u32 s33, 155648
 s_cselect_b32 s33, s33, 98304
 v_mfma_f32_16x16x32_bf16 v[96:99], a[20:23], v[200:203], v[96:99]
 v_mfma_f32_16x16x32_bf16 v[100:103], a[12:15], v[204:207], v[100:103]
 ds_read_b128 v[172:175], v18 offset:6144
 v_mfma_f32_16x16x32_bf16 v[104:107], a[16:19], v[204:207], v[104:107]
 v_mfma_f32_16x16x32_bf16 v[108:111], a[20:23], v[204:207], v[108:111]
 s_waitcnt lgkmcnt(2)
 v_mfma_f32_16x16x32_bf16 v[64:67], a[24:27], v[160:163], v[64:67]
 ds_read_b128 v[192:195], v19 offset:0
 v_mfma_f32_16x16x32_bf16 v[68:71], a[28:31], v[160:163], v[68:71]
 v_add_u32 v18, s33, v14
 v_mfma_f32_16x16x32_bf16 v[72:75], a[32:35], v[160:163], v[72:75]
 v_mfma_f32_16x16x32_bf16 v[76:79], a[24:27], v[164:167], v[76:79]
 ds_read_b128 v[196:199], v19 offset:2048
 v_mfma_f32_16x16x32_bf16 v[80:83], a[28:31], v[164:167], v[80:83]
 buffer_load_dwordx4 v11, s[8:11], s30 offen offset:1024 lds
 v_mfma_f32_16x16x32_bf16 v[84:87], a[32:35], v[164:167], v[84:87]
 s_waitcnt lgkmcnt(2)
 s_add_u32 s30, s30, 128
 v_mfma_f32_16x16x32_bf16 v[88:91], a[24:27], v[168:171], v[88:91]
 ds_read_b128 v[200:203], v19 offset:4096
 s_add_u32 m0, m0, 8192
 v_mfma_f32_16x16x32_bf16 v[92:95], a[28:31], v[168:171], v[92:95]
 s_cmp_lt_u32 m0, s46
 s_cselect_b32 m0, m0, s47
 v_mfma_f32_16x16x32_bf16 v[96:99], a[32:35], v[168:171], v[96:99]
 v_mfma_f32_16x16x32_bf16 v[100:103], a[24:27], v[172:175], v[100:103]
 ds_read_b128 v[204:207], v19 offset:6144
 v_mfma_f32_16x16x32_bf16 v[104:107], a[28:31], v[172:175], v[104:107]
 v_mfma_f32_16x16x32_bf16 v[108:111], a[32:35], v[172:175], v[108:111]
 s_waitcnt vmcnt(32) lgkmcnt(2)
 s_barrier
 v_mfma_f32_16x16x32_bf16 v[64:67], a[36:39], v[192:195], v[64:67]
 ds_read_b128 v[160:163], v18 offset:0
 v_mfma_f32_16x16x32_bf16 v[68:71], a[40:43], v[192:195], v[68:71]
 v_mfma_f32_16x16x32_bf16 v[72:75], a[44:47], v[192:195], v[72:75]
 v_add_u32 v19, s33, v15
 s_add_u32 s33, s33, 8192
 v_mfma_f32_16x16x32_bf16 v[76:79], a[36:39], v[196:199], v[76:79]
 ds_read_b128 v[164:167], v18 offset:2048
 v_mfma_f32_16x16x32_bf16 v[80:83], a[40:43], v[196:199], v[80:83]
 buffer_load_dwordx4 v10, s[8:11], s30 offen offset:0 lds
 v_mfma_f32_16x16x32_bf16 v[84:87], a[44:47], v[196:199], v[84:87]
 s_waitcnt lgkmcnt(2)
 v_mfma_f32_16x16x32_bf16 v[88:91], a[36:39], v[200:203], v[88:91]
 ds_read_b128 v[168:171], v18 offset:4096
 v_mfma_f32_16x16x32_bf16 v[92:95], a[40:43], v[200:203], v[92:95]
 s_cmp_lt_u32 s33, 155648
 s_cselect_b32 s33, s33, 98304
 v_mfma_f32_16x16x32_bf16 v[96:99], a[44:47], v[200:203], v[96:99]
 v_mfma_f32_16x16x32_bf16 v[100:103], a[36:39], v[204:207], v[100:103]
 ds_read_b128 v[172:175], v18 offset:6144
 v_mfma_f32_16x16x32_bf16 v[104:107], a[40:43], v[204:207], v[104:107]
 v_mfma_f32_16x16x32_bf16 v[108:111], a[44:47], v[204:207], v[108:111]
 s_waitcnt lgkmcnt(2)
 s_waitcnt vmcnt(17)
 s_barrier
 ds_read_b64_tr_b16 a[48:49], v49 offset:0
 ds_read_b64_tr_b16 a[50:51], v49 offset:1536
 ds_read_b64_tr_b16 a[52:53], v50 offset:0
 ds_read_b64_tr_b16 a[54:55], v50 offset:1536
 ds_read_b64_tr_b16 a[56:57], v51 offset:0
 ds_read_b64_tr_b16 a[58:59], v51 offset:1536
 ds_read_b64_tr_b16 a[60:61], v49 offset:12288
 ds_read_b64_tr_b16 a[62:63], v49 offset:13824
 ds_read_b64_tr_b16 a[64:65], v50 offset:12288
 ds_read_b64_tr_b16 a[66:67], v50 offset:13824
 ds_read_b64_tr_b16 a[68:69], v51 offset:12288
 ds_read_b64_tr_b16 a[70:71], v51 offset:13824
 ds_read_b64_tr_b16 a[72:73], v49 offset:24576
 ds_read_b64_tr_b16 a[74:75], v49 offset:26112
 ds_read_b64_tr_b16 a[76:77], v50 offset:24576
 ds_read_b64_tr_b16 a[78:79], v50 offset:26112
 ds_read_b64_tr_b16 a[80:81], v51 offset:24576
 ds_read_b64_tr_b16 a[82:83], v51 offset:26112
 ds_read_b64_tr_b16 a[84:85], v49 offset:36864
 ds_read_b64_tr_b16 a[86:87], v49 offset:38400
 ds_read_b64_tr_b16 a[88:89], v50 offset:36864
 ds_read_b64_tr_b16 a[90:91], v50 offset:38400
 ds_read_b64_tr_b16 a[92:93], v51 offset:36864
 ds_read_b64_tr_b16 a[94:95], v51 offset:38400
 s_waitcnt lgkmcnt(0)
 s_barrier
 s_mov_b32 s23, m0
 s_mul_i32 s21, s20, 393216
 s_add_u32 s21, s21, 4718592
 s_add_u32 s21, s21, s44
 s_mul_i32 s22, s20, 12288
 s_add_u32 s22, s22, 49152
 s_add_u32 m0, s22, 0
 s_nop 0
 buffer_load_dwordx4 v40, s[12:15], s21 offen lds
 s_add_u32 m0, s22, 1024
 s_nop 0
 buffer_load_dwordx4 v41, s[12:15], s21 offen lds
 s_add_u32 m0, s22, 2048
 s_nop 0
 buffer_load_dwordx4 v42, s[12:15], s21 offen lds
 s_mul_i32 s21, s20, 393216
 s_add_u32 s21, s21, 4816896
 s_add_u32 s21, s21, s44
 s_mul_i32 s22, s20, 12288
 s_add_u32 s22, s22, 52224
 s_add_u32 m0, s22, 0
 s_nop 0
 buffer_load_dwordx4 v43, s[12:15], s21 offen lds
 s_add_u32 m0, s22, 1024
 s_nop 0
 buffer_load_dwordx4 v44, s[12:15], s21 offen lds
 s_add_u32 m0, s22, 2048
 s_nop 0
 buffer_load_dwordx4 v45, s[12:15], s21 offen lds
 s_mul_i32 s21, s20, 393216
 s_add_u32 s21, s21, 4915200
 s_add_u32 s21, s21, s44
 s_mul_i32 s22, s20, 12288
 s_add_u32 s22, s22, 55296
 s_add_u32 m0, s22, 0
 s_nop 0
 buffer_load_dwordx4 v40, s[12:15], s21 offen lds
 s_add_u32 m0, s22, 1024
 s_nop 0
 buffer_load_dwordx4 v41, s[12:15], s21 offen lds
 s_add_u32 m0, s22, 2048
 s_nop 0
 buffer_load_dwordx4 v42, s[12:15], s21 offen lds
 s_mul_i32 s21, s20, 393216
 s_add_u32 s21, s21, 5013504
 s_add_u32 s21, s21, s44
 s_mul_i32 s22, s20, 12288
 s_add_u32 s22, s22, 58368
 s_add_u32 m0, s22, 0
 s_nop 0
 buffer_load_dwordx4 v43, s[12:15], s21 offen lds
 s_add_u32 m0, s22, 1024
 s_nop 0
 buffer_load_dwordx4 v44, s[12:15], s21 offen lds
 s_add_u32 m0, s22, 2048
 s_nop 0
 buffer_load_dwordx4 v45, s[12:15], s21 offen lds
 s_mov_b32 m0, s23
 v_mfma_f32_16x16x32_bf16 v[64:67], a[48:51], v[160:163], v[64:67]
 ds_read_b128 v[192:195], v19 offset:0
 v_mfma_f32_16x16x32_bf16 v[68:71], a[52:55], v[160:163], v[68:71]
 v_add_u32 v18, s33, v14
 v_mfma_f32_16x16x32_bf16 v[72:75], a[56:59], v[160:163], v[72:75]
 v_mfma_f32_16x16x32_bf16 v[76:79], a[48:51], v[164:167], v[76:79]
 ds_read_b128 v[196:199], v19 offset:2048
 v_mfma_f32_16x16x32_bf16 v[80:83], a[52:55], v[164:167], v[80:83]
 buffer_load_dwordx4 v11, s[8:11], s30 offen offset:1024 lds
 v_mfma_f32_16x16x32_bf16 v[84:87], a[56:59], v[164:167], v[84:87]
 s_add_u32 s30, s30, 128
 v_mfma_f32_16x16x32_bf16 v[88:91], a[48:51], v[168:171], v[88:91]
 ds_read_b128 v[200:203], v19 offset:4096
 s_add_u32 m0, m0, 8192
 v_mfma_f32_16x16x32_bf16 v[92:95], a[52:55], v[168:171], v[92:95]
 s_cmp_lt_u32 m0, s46
 s_cselect_b32 m0, m0, s47
 v_mfma_f32_16x16x32_bf16 v[96:99], a[56:59], v[168:171], v[96:99]
 v_mfma_f32_16x16x32_bf16 v[100:103], a[48:51], v[172:175], v[100:103]
 ds_read_b128 v[204:207], v19 offset:6144
 v_mfma_f32_16x16x32_bf16 v[104:107], a[52:55], v[172:175], v[104:107]
 v_mfma_f32_16x16x32_bf16 v[108:111], a[56:59], v[172:175], v[108:111]
 s_waitcnt vmcnt(44) lgkmcnt(2)
 s_barrier
 v_mfma_f32_16x16x32_bf16 v[64:67], a[60:63], v[192:195], v[64:67]
 ds_read_b128 v[160:163], v18 offset:0
 v_mfma_f32_16x16x32_bf16 v[68:71], a[64:67], v[192:195], v[68:71]
 v_mfma_f32_16x16x32_bf16 v[72:75], a[68:71], v[192:195], v[72:75]
 v_add_u32 v19, s33, v15
 s_add_u32 s33, s33, 8192
 v_mfma_f32_16x16x32_bf16 v[76:79], a[60:63], v[196:199], v[76:79]
 ds_read_b128 v[164:167], v18 offset:2048
 v_mfma_f32_16x16x32_bf16 v[80:83], a[64:67], v[196:199], v[80:83]
 buffer_load_dwordx4 v10, s[8:11], s30 offen offset:0 lds
 v_mfma_f32_16x16x32_bf16 v[84:87], a[68:71], v[196:199], v[84:87]
 s_waitcnt lgkmcnt(2)
 v_mfma_f32_16x16x32_bf16 v[88:91], a[60:63], v[200:203], v[88:91]
 ds_read_b128 v[168:171], v18 offset:4096
 v_mfma_f32_16x16x32_bf16 v[92:95], a[64:67], v[200:203], v[92:95]
 s_cmp_lt_u32 s33, 155648
 s_cselect_b32 s33, s33, 98304
 v_mfma_f32_16x16x32_bf16 v[96:99], a[68:71], v[200:203], v[96:99]
 v_mfma_f32_16x16x32_bf16 v[100:103], a[60:63], v[204:207], v[100:103]
 ds_read_b128 v[172:175], v18 offset:6144
 v_mfma_f32_16x16x32_bf16 v[104:107], a[64:67], v[204:207], v[104:107]
 v_mfma_f32_16x16x32_bf16 v[108:111], a[68:71], v[204:207], v[108:111]
 s_waitcnt lgkmcnt(2)
 v_mfma_f32_16x16x32_bf16 v[64:67], a[72:75], v[160:163], v[64:67]
 ds_read_b128 v[192:195], v19 offset:0
 v_mfma_f32_16x16x32_bf16 v[68:71], a[76:79], v[160:163], v[68:71]
 v_add_u32 v18, s33, v14
 v_mfma_f32_16x16x32_bf16 v[72:75], a[80:83], v[160:163], v[72:75]
 v_mfma_f32_16x16x32_bf16 v[76:79], a[72:75], v[164:167], v[76:79]
 ds_read_b128 v[196:199], v19 offset:2048
 v_mfma_f32_16x16x32_bf16 v[80:83], a[76:79], v[164:167], v[80:83]
 buffer_load_dwordx4 v11, s[8:11], s30 offen offset:1024 lds
 v_mfma_f32_16x16x32_bf16 v[84:87], a[80:83], v[164:167], v[84:87]
 s_waitcnt lgkmcnt(2)
 s_add_u32 s30, s30, 128
 v_mfma_f32_16x16x32_bf16 v[88:91], a[72:75], v[168:171], v[88:91]
 ds_read_b128 v[200:203], v19 offset:4096
 s_add_u32 m0, m0, 8192
 v_mfma_f32_16x16x32_bf16 v[92:95], a[76:79], v[168:171], v[92:95]
 s_cmp_lt_u32 m0, s46
 s_cselect_b32 m0, m0, s47
 v_mfma_f32_16x16x32_bf16 v[96:99], a[80:83], v[168:171], v[96:99]
 v_mfma_f32_16x16x32_bf16 v[100:103], a[72:75], v[172:175], v[100:103]
 ds_read_b128 v[204:207], v19 offset:6144
 v_mfma_f32_16x16x32_bf16 v[104:107], a[76:79], v[172:175], v[104:107]
 v_mfma_f32_16x16x32_bf16 v[108:111], a[80:83], v[172:175], v[108:111]
 s_waitcnt vmcnt(44) lgkmcnt(2)
 s_barrier
 v_mfma_f32_16x16x32_bf16 v[64:67], a[84:87], v[192:195], v[64:67]
 ds_read_b128 v[160:163], v18 offset:0
 v_mfma_f32_16x16x32_bf16 v[68:71], a[88:91], v[192:195], v[68:71]
 v_mfma_f32_16x16x32_bf16 v[72:75], a[92:95], v[192:195], v[72:75]
 v_add_u32 v19, s33, v15
 s_add_u32 s33, s33, 8192
 v_mfma_f32_16x16x32_bf16 v[76:79], a[84:87], v[196:199], v[76:79]
 ds_read_b128 v[164:167], v18 offset:2048
 v_mfma_f32_16x16x32_bf16 v[80:83], a[88:91], v[196:199], v[80:83]
 buffer_load_dwordx4 v10, s[8:11], s30 offen offset:0 lds
 v_mfma_f32_16x16x32_bf16 v[84:87], a[92:95], v[196:199], v[84:87]
 s_waitcnt lgkmcnt(2)
 v_mfma_f32_16x16x32_bf16 v[88:91], a[84:87], v[200:203], v[88:91]
 ds_read_b128 v[168:171], v18 offset:4096
 v_mfma_f32_16x16x32_bf16 v[92:95], a[88:91], v[200:203], v[92:95]
 s_cmp_lt_u32 s33, 155648
 s_cselect_b32 s33, s33, 98304
 v_mfma_f32_16x16x32_bf16 v[96:99], a[92:95], v[200:203], v[96:99]
 v_mfma_f32_16x16x32_bf16 v[100:103], a[84:87], v[204:207], v[100:103]
 ds_read_b128 v[172:175], v18 offset:6144
 v_mfma_f32_16x16x32_bf16 v[104:107], a[88:91], v[204:207], v[104:107]
 v_mfma_f32_16x16x32_bf16 v[108:111], a[92:95], v[204:207], v[108:111]
 s_waitcnt lgkmcnt(2)
 s_waitcnt vmcnt(20)
 s_barrier
 ds_read_b64_tr_b16 a[96:97], v46 offset:0
 ds_read_b64_tr_b16 a[98:99], v46 offset:1536
 ds_read_b64_tr_b16 a[100:101], v47 offset:0
 ds_read_b64_tr_b16 a[102:103], v47 offset:1536
 ds_read_b64_tr_b16 a[104:105], v48 offset:0
 ds_read_b64_tr_b16 a[106:107], v48 offset:1536
 ds_read_b64_tr_b16 a[108:109], v46 offset:12288
 ds_read_b64_tr_b16 a[110:111], v46 offset:13824
 ds_read_b64_tr_b16 a[112:113], v47 offset:12288
 ds_read_b64_tr_b16 a[114:115], v47 offset:13824
 ds_read_b64_tr_b16 a[116:117], v48 offset:12288
 ds_read_b64_tr_b16 a[118:119], v48 offset:13824
 ds_read_b64_tr_b16 a[120:121], v46 offset:24576
 ds_read_b64_tr_b16 a[122:123], v46 offset:26112
 ds_read_b64_tr_b16 a[124:125], v47 offset:24576
 ds_read_b64_tr_b16 a[126:127], v47 offset:26112
 ds_read_b64_tr_b16 a[128:129], v48 offset:24576
 ds_read_b64_tr_b16 a[130:131], v48 offset:26112
 ds_read_b64_tr_b16 a[132:133], v46 offset:36864
 ds_read_b64_tr_b16 a[134:135], v46 offset:38400
 ds_read_b64_tr_b16 a[136:137], v47 offset:36864
 ds_read_b64_tr_b16 a[138:139], v47 offset:38400
 ds_read_b64_tr_b16 a[140:141], v48 offset:36864
 ds_read_b64_tr_b16 a[142:143], v48 offset:38400
 s_waitcnt lgkmcnt(0)
 s_barrier
 s_mov_b32 s23, m0
 s_mul_i32 s21, s20, 393216
 s_add_u32 s21, s21, 6291456
 s_add_u32 s21, s21, s44
 s_mul_i32 s22, s20, 12288
 s_add_u32 s22, s22, 0
 s_add_u32 m0, s22, 0
 s_nop 0
 buffer_load_dwordx4 v40, s[12:15], s21 offen lds
 s_add_u32 m0, s22, 1024
 s_nop 0
 buffer_load_dwordx4 v41, s[12:15], s21 offen lds
 s_add_u32 m0, s22, 2048
 s_nop 0
 buffer_load_dwordx4 v42, s[12:15], s21 offen lds
 s_mul_i32 s21, s20, 393216
 s_add_u32 s21, s21, 6389760
 s_add_u32 s21, s21, s44
 s_mul_i32 s22, s20, 12288
 s_add_u32 s22, s22, 3072
 s_add_u32 m0, s22, 0
 s_nop 0
 buffer_load_dwordx4 v43, s[12:15], s21 offen lds
 s_add_u32 m0, s22, 1024
 s_nop 0
 buffer_load_dwordx4 v44, s[12:15], s21 offen lds
 s_add_u32 m0, s22, 2048
 s_nop 0
 buffer_load_dwordx4 v45, s[12:15], s21 offen lds
 s_mul_i32 s21, s20, 393216
 s_add_u32 s21, s21, 6488064
 s_add_u32 s21, s21, s44
 s_mul_i32 s22, s20, 12288
 s_add_u32 s22, s22, 6144
 s_add_u32 m0, s22, 0
 s_nop 0
 buffer_load_dwordx4 v40, s[12:15], s21 offen lds
 s_add_u32 m0, s22, 1024
 s_nop 0
 buffer_load_dwordx4 v41, s[12:15], s21 offen lds
 s_add_u32 m0, s22, 2048
 s_nop 0
 buffer_load_dwordx4 v42, s[12:15], s21 offen lds
 s_mul_i32 s21, s20, 393216
 s_add_u32 s21, s21, 6586368
 s_add_u32 s21, s21, s44
 s_mul_i32 s22, s20, 12288
 s_add_u32 s22, s22, 9216
 s_add_u32 m0, s22, 0
 s_nop 0
 buffer_load_dwordx4 v43, s[12:15], s21 offen lds
 s_add_u32 m0, s22, 1024
 s_nop 0
 buffer_load_dwordx4 v44, s[12:15], s21 offen lds
 s_add_u32 m0, s22, 2048
 s_nop 0
 buffer_load_dwordx4 v45, s[12:15], s21 offen lds
 s_mov_b32 m0, s23
 v_mov_b32 v29, 76
 buffer_load_dword v29, v29, s[64:67], 0 offen sc1
 v_mfma_f32_16x16x32_bf16 v[64:67], a[96:99], v[160:163], v[64:67]
 ds_read_b128 v[192:195], v19 offset:0
 v_mfma_f32_16x16x32_bf16 v[68:71], a[100:103], v[160:163], v[68:71]
 v_add_u32 v18, s33, v14
 s_mov_b32 s61, s60
 v_mfma_f32_16x16x32_bf16 v[72:75], a[104:107], v[160:163], v[72:75]
 s_add_u32 s60, s60, s62
 s_lshr_b32 s48, s20, 1
 v_mfma_f32_16x16x32_bf16 v[76:79], a[96:99], v[164:167], v[76:79]
 ds_read_b128 v[196:199], v19 offset:2048
 s_mul_i32 s48, s48, 393216
 v_mfma_f32_16x16x32_bf16 v[80:83], a[100:103], v[164:167], v[80:83]
 buffer_load_dwordx4 v11, s[8:11], s30 offen offset:1024 lds
 v_mfma_f32_16x16x32_bf16 v[84:87], a[104:107], v[164:167], v[84:87]
 s_add_u32 s30, s30, s25
 v_mfma_f32_16x16x32_bf16 v[88:91], a[96:99], v[168:171], v[88:91]
 ds_read_b128 v[200:203], v19 offset:4096
 s_sub_u32 s30, s30, 1152
 v_mfma_f32_16x16x32_bf16 v[92:95], a[100:103], v[168:171], v[92:95]
 s_add_u32 m0, m0, 8192
 s_and_b32 s21, s20, 1
 v_mfma_f32_16x16x32_bf16 v[96:99], a[104:107], v[168:171], v[96:99]
 s_cmp_lt_u32 m0, s46
 s_cselect_b32 m0, m0, s47
 v_mfma_f32_16x16x32_bf16 v[100:103], a[96:99], v[172:175], v[100:103]
 ds_read_b128 v[204:207], v19 offset:6144
 s_mul_i32 s21, s21, 6144
 v_mfma_f32_16x16x32_bf16 v[104:107], a[100:103], v[172:175], v[104:107]
 s_add_u32 s48, s48, s21
 s_add_u32 s48, s48, s27
 v_mfma_f32_16x16x32_bf16 v[108:111], a[104:107], v[172:175], v[108:111]
 s_waitcnt vmcnt(33) lgkmcnt(2)
 s_barrier
 v_mfma_f32_16x16x32_bf16 v[64:67], a[108:111], v[192:195], v[64:67]
 ds_read_b128 v[160:163], v18 offset:0
 s_add_u32 s27, s27, s28
 v_mfma_f32_16x16x32_bf16 v[68:71], a[112:115], v[192:195], v[68:71]
 s_sub_u32 s26, s26, 1
 v_mfma_f32_16x16x32_bf16 v[72:75], a[116:119], v[192:195], v[72:75]
 v_add_u32 v19, s33, v15
 s_add_u32 s33, s33, 8192
 v_mfma_f32_16x16x32_bf16 v[76:79], a[108:111], v[196:199], v[76:79]
 ds_read_b128 v[164:167], v18 offset:2048
 v_mfma_f32_16x16x32_bf16 v[80:83], a[112:115], v[196:199], v[80:83]
 buffer_load_dwordx4 v10, s[8:11], s30 offen offset:0 lds
 v_mfma_f32_16x16x32_bf16 v[84:87], a[116:119], v[196:199], v[84:87]
 s_waitcnt lgkmcnt(2)
 v_mfma_f32_16x16x32_bf16 v[88:91], a[108:111], v[200:203], v[88:91]
 ds_read_b128 v[168:171], v18 offset:4096
 v_mfma_f32_16x16x32_bf16 v[92:95], a[112:115], v[200:203], v[92:95]
 s_cmp_lt_u32 s33, 155648
 s_cselect_b32 s33, s33, 98304
 v_mfma_f32_16x16x32_bf16 v[96:99], a[116:119], v[200:203], v[96:99]
 v_mfma_f32_16x16x32_bf16 v[100:103], a[108:111], v[204:207], v[100:103]
 ds_read_b128 v[172:175], v18 offset:6144
 v_mfma_f32_16x16x32_bf16 v[104:107], a[112:115], v[204:207], v[104:107]
 v_mfma_f32_16x16x32_bf16 v[108:111], a[116:119], v[204:207], v[108:111]
 s_waitcnt lgkmcnt(2)
 v_mfma_f32_16x16x32_bf16 v[64:67], a[120:123], v[160:163], v[64:67]
 ds_read_b128 v[192:195], v19 offset:0
 v_mfma_f32_16x16x32_bf16 v[68:71], a[124:127], v[160:163], v[68:71]
 v_add_u32 v18, s33, v14
 v_mfma_f32_16x16x32_bf16 v[72:75], a[128:131], v[160:163], v[72:75]
 v_mfma_f32_16x16x32_bf16 v[76:79], a[120:123], v[164:167], v[76:79]
 ds_read_b128 v[196:199], v19 offset:2048
 v_mfma_f32_16x16x32_bf16 v[80:83], a[124:127], v[164:167], v[80:83]
 buffer_load_dwordx4 v11, s[8:11], s30 offen offset:1024 lds
 v_mfma_f32_16x16x32_bf16 v[84:87], a[128:131], v[164:167], v[84:87]
 s_waitcnt lgkmcnt(2)
 s_add_u32 s30, s30, 128
 v_mfma_f32_16x16x32_bf16 v[88:91], a[120:123], v[168:171], v[88:91]
 ds_read_b128 v[200:203], v19 offset:4096
 s_add_u32 m0, m0, 8192
 v_mfma_f32_16x16x32_bf16 v[92:95], a[124:127], v[168:171], v[92:95]
 s_cmp_lt_u32 m0, s46
 s_cselect_b32 m0, m0, s47
 v_mfma_f32_16x16x32_bf16 v[96:99], a[128:131], v[168:171], v[96:99]
 v_mfma_f32_16x16x32_bf16 v[100:103], a[120:123], v[172:175], v[100:103]
 ds_read_b128 v[204:207], v19 offset:6144
 v_mfma_f32_16x16x32_bf16 v[104:107], a[124:127], v[172:175], v[104:107]
 v_mfma_f32_16x16x32_bf16 v[108:111], a[128:131], v[172:175], v[108:111]
 s_waitcnt vmcnt(33) lgkmcnt(2)
 s_barrier
 v_mfma_f32_16x16x32_bf16 v[64:67], a[132:135], v[192:195], v[64:67]
 ds_read_b128 v[160:163], v18 offset:0
 v_mfma_f32_16x16x32_bf16 v[68:71], a[136:139], v[192:195], v[68:71]
 v_mfma_f32_16x16x32_bf16 v[72:75], a[140:143], v[192:195], v[72:75]
 v_add_u32 v19, s33, v15
 s_add_u32 s33, s33, 8192
 v_mfma_f32_16x16x32_bf16 v[76:79], a[132:135], v[196:199], v[76:79]
 ds_read_b128 v[164:167], v18 offset:2048
 v_mfma_f32_16x16x32_bf16 v[80:83], a[136:139], v[196:199], v[80:83]
 buffer_load_dwordx4 v10, s[8:11], s30 offen offset:0 lds
 v_mfma_f32_16x16x32_bf16 v[84:87], a[140:143], v[196:199], v[84:87]
 s_waitcnt lgkmcnt(2)
 v_mfma_f32_16x16x32_bf16 v[88:91], a[132:135], v[200:203], v[88:91]
 ds_read_b128 v[168:171], v18 offset:4096
 v_mfma_f32_16x16x32_bf16 v[92:95], a[136:139], v[200:203], v[92:95]
 s_cmp_lt_u32 s33, 155648
 s_cselect_b32 s33, s33, 98304
 v_mfma_f32_16x16x32_bf16 v[96:99], a[140:143], v[200:203], v[96:99]
 v_mfma_f32_16x16x32_bf16 v[100:103], a[132:135], v[204:207], v[100:103]
 ds_read_b128 v[172:175], v18 offset:6144
 v_mfma_f32_16x16x32_bf16 v[104:107], a[136:139], v[204:207], v[104:107]
 v_mfma_f32_16x16x32_bf16 v[108:111], a[140:143], v[204:207], v[108:111]
 s_waitcnt lgkmcnt(2)
 s_waitcnt vmcnt(21)
 s_barrier
 ds_read_b64_tr_b16 a[144:145], v49 offset:0
 ds_read_b64_tr_b16 a[146:147], v49 offset:1536
 ds_read_b64_tr_b16 a[148:149], v50 offset:0
 ds_read_b64_tr_b16 a[150:151], v50 offset:1536
 ds_read_b64_tr_b16 a[152:153], v51 offset:0
 ds_read_b64_tr_b16 a[154:155], v51 offset:1536
 ds_read_b64_tr_b16 a[156:157], v49 offset:12288
 ds_read_b64_tr_b16 a[158:159], v49 offset:13824
 ds_read_b64_tr_b16 a[160:161], v50 offset:12288
 ds_read_b64_tr_b16 a[162:163], v50 offset:13824
 ds_read_b64_tr_b16 a[164:165], v51 offset:12288
 ds_read_b64_tr_b16 a[166:167], v51 offset:13824
 ds_read_b64_tr_b16 a[168:169], v49 offset:24576
 ds_read_b64_tr_b16 a[170:171], v49 offset:26112
 ds_read_b64_tr_b16 a[172:173], v50 offset:24576
 ds_read_b64_tr_b16 a[174:175], v50 offset:26112
 ds_read_b64_tr_b16 a[176:177], v51 offset:24576
 ds_read_b64_tr_b16 a[178:179], v51 offset:26112
 ds_read_b64_tr_b16 a[180:181], v49 offset:36864
 ds_read_b64_tr_b16 a[182:183], v49 offset:38400
 ds_read_b64_tr_b16 a[184:185], v50 offset:36864
 ds_read_b64_tr_b16 a[186:187], v50 offset:38400
 ds_read_b64_tr_b16 a[188:189], v51 offset:36864
 ds_read_b64_tr_b16 a[190:191], v51 offset:38400
 s_waitcnt lgkmcnt(0)
 s_barrier
 v_mfma_f32_16x16x32_bf16 v[64:67], a[144:147], v[160:163], v[64:67]
 ds_read_b128 v[192:195], v19 offset:0
 v_mfma_f32_16x16x32_bf16 v[68:71], a[148:151], v[160:163], v[68:71]
 v_add_u32 v18, s33, v14
 v_mfma_f32_16x16x32_bf16 v[72:75], a[152:155], v[160:163], v[72:75]
 v_mfma_f32_16x16x32_bf16 v[76:79], a[144:147], v[164:167], v[76:79]
 ds_read_b128 v[196:199], v19 offset:2048
 v_mfma_f32_16x16x32_bf16 v[80:83], a[148:151], v[164:167], v[80:83]
 buffer_load_dwordx4 v11, s[8:11], s30 offen offset:1024 lds
 v_mfma_f32_16x16x32_bf16 v[84:87], a[152:155], v[164:167], v[84:87]
 s_add_u32 s30, s30, 128
 v_mfma_f32_16x16x32_bf16 v[88:91], a[144:147], v[168:171], v[88:91]
 ds_read_b128 v[200:203], v19 offset:4096
 s_add_u32 m0, m0, 8192
 v_mfma_f32_16x16x32_bf16 v[92:95], a[148:151], v[168:171], v[92:95]
 s_cmp_lt_u32 m0, s46
 s_cselect_b32 m0, m0, s47
 v_mfma_f32_16x16x32_bf16 v[96:99], a[152:155], v[168:171], v[96:99]
 v_mfma_f32_16x16x32_bf16 v[100:103], a[144:147], v[172:175], v[100:103]
 ds_read_b128 v[204:207], v19 offset:6144
 v_mfma_f32_16x16x32_bf16 v[104:107], a[148:151], v[172:175], v[104:107]
 v_mfma_f32_16x16x32_bf16 v[108:111], a[152:155], v[172:175], v[108:111]
 s_waitcnt vmcnt(21) lgkmcnt(2)
 s_barrier
 v_mfma_f32_16x16x32_bf16 v[64:67], a[156:159], v[192:195], v[64:67]
 ds_read_b128 v[160:163], v18 offset:0
 v_mfma_f32_16x16x32_bf16 v[68:71], a[160:163], v[192:195], v[68:71]
 v_mfma_f32_16x16x32_bf16 v[72:75], a[164:167], v[192:195], v[72:75]
 v_add_u32 v19, s33, v15
 s_add_u32 s33, s33, 8192
 v_mfma_f32_16x16x32_bf16 v[76:79], a[156:159], v[196:199], v[76:79]
 ds_read_b128 v[164:167], v18 offset:2048
 v_mfma_f32_16x16x32_bf16 v[80:83], a[160:163], v[196:199], v[80:83]
 buffer_load_dwordx4 v10, s[8:11], s30 offen offset:0 lds
 v_mfma_f32_16x16x32_bf16 v[84:87], a[164:167], v[196:199], v[84:87]
 s_waitcnt lgkmcnt(2)
 v_mfma_f32_16x16x32_bf16 v[88:91], a[156:159], v[200:203], v[88:91]
 ds_read_b128 v[168:171], v18 offset:4096
 v_mfma_f32_16x16x32_bf16 v[92:95], a[160:163], v[200:203], v[92:95]
 s_cmp_lt_u32 s33, 155648
 s_cselect_b32 s33, s33, 98304
 v_mfma_f32_16x16x32_bf16 v[96:99], a[164:167], v[200:203], v[96:99]
 v_mfma_f32_16x16x32_bf16 v[100:103], a[156:159], v[204:207], v[100:103]
 ds_read_b128 v[172:175], v18 offset:6144
 v_mfma_f32_16x16x32_bf16 v[104:107], a[160:163], v[204:207], v[104:107]
 v_mfma_f32_16x16x32_bf16 v[108:111], a[164:167], v[204:207], v[108:111]
 s_waitcnt lgkmcnt(2)
 v_mfma_f32_16x16x32_bf16 v[64:67], a[168:171], v[160:163], v[64:67]
 ds_read_b128 v[192:195], v19 offset:0
 v_mfma_f32_16x16x32_bf16 v[68:71], a[172:175], v[160:163], v[68:71]
 v_add_u32 v18, s33, v14
 v_mfma_f32_16x16x32_bf16 v[72:75], a[176:179], v[160:163], v[72:75]
 v_mfma_f32_16x16x32_bf16 v[76:79], a[168:171], v[164:167], v[76:79]
 ds_read_b128 v[196:199], v19 offset:2048
 v_mfma_f32_16x16x32_bf16 v[80:83], a[172:175], v[164:167], v[80:83]
 buffer_load_dwordx4 v11, s[8:11], s30 offen offset:1024 lds
 v_mfma_f32_16x16x32_bf16 v[84:87], a[176:179], v[164:167], v[84:87]
 s_waitcnt lgkmcnt(2)
 s_add_u32 s30, s30, 128
 v_mfma_f32_16x16x32_bf16 v[88:91], a[168:171], v[168:171], v[88:91]
 ds_read_b128 v[200:203], v19 offset:4096
 s_add_u32 m0, m0, 8192
 v_mfma_f32_16x16x32_bf16 v[92:95], a[172:175], v[168:171], v[92:95]
 s_cmp_lt_u32 m0, s46
 s_cselect_b32 m0, m0, s47
 v_mfma_f32_16x16x32_bf16 v[96:99], a[176:179], v[168:171], v[96:99]
 v_mfma_f32_16x16x32_bf16 v[100:103], a[168:171], v[172:175], v[100:103]
 ds_read_b128 v[204:207], v19 offset:6144
 v_mfma_f32_16x16x32_bf16 v[104:107], a[172:175], v[172:175], v[104:107]
 v_mfma_f32_16x16x32_bf16 v[108:111], a[176:179], v[172:175], v[108:111]
 s_waitcnt vmcnt(21) lgkmcnt(2)
 s_barrier
 v_mfma_f32_16x16x32_bf16 v[64:67], a[180:183], v[192:195], v[64:67]
 ds_read_b128 v[160:163], v18 offset:0
 v_mfma_f32_16x16x32_bf16 v[68:71], a[184:187], v[192:195], v[68:71]
 v_mfma_f32_16x16x32_bf16 v[72:75], a[188:191], v[192:195], v[72:75]
 v_add_u32 v19, s33, v15
 s_add_u32 s33, s33, 8192
 v_mfma_f32_16x16x32_bf16 v[76:79], a[180:183], v[196:199], v[76:79]
 ds_read_b128 v[164:167], v18 offset:2048
 v_mfma_f32_16x16x32_bf16 v[80:83], a[184:187], v[196:199], v[80:83]
 buffer_load_dwordx4 v10, s[8:11], s30 offen offset:0 lds
 v_mfma_f32_16x16x32_bf16 v[84:87], a[188:191], v[196:199], v[84:87]
 s_waitcnt lgkmcnt(2)
 v_mfma_f32_16x16x32_bf16 v[88:91], a[180:183], v[200:203], v[88:91]
 ds_read_b128 v[168:171], v18 offset:4096
 v_mfma_f32_16x16x32_bf16 v[92:95], a[184:187], v[200:203], v[92:95]
 s_cmp_lt_u32 s33, 155648
 s_cselect_b32 s33, s33, 98304
 v_mfma_f32_16x16x32_bf16 v[96:99], a[188:191], v[200:203], v[96:99]
 v_mfma_f32_16x16x32_bf16 v[100:103], a[180:183], v[204:207], v[100:103]
 ds_read_b128 v[172:175], v18 offset:6144
 v_mfma_f32_16x16x32_bf16 v[104:107], a[184:187], v[204:207], v[104:107]
 v_mfma_f32_16x16x32_bf16 v[108:111], a[188:191], v[204:207], v[108:111]
 s_waitcnt lgkmcnt(2)
 s_waitcnt vmcnt(9)
 s_barrier
 ds_read_b64_tr_b16 a[192:193], v46 offset:0
 ds_read_b64_tr_b16 a[194:195], v46 offset:1536
 ds_read_b64_tr_b16 a[196:197], v47 offset:0
 ds_read_b64_tr_b16 a[198:199], v47 offset:1536
 ds_read_b64_tr_b16 a[200:201], v48 offset:0
 ds_read_b64_tr_b16 a[202:203], v48 offset:1536
 ds_read_b64_tr_b16 a[204:205], v46 offset:12288
 ds_read_b64_tr_b16 a[206:207], v46 offset:13824
 ds_read_b64_tr_b16 a[208:209], v47 offset:12288
 ds_read_b64_tr_b16 a[210:211], v47 offset:13824
 ds_read_b64_tr_b16 a[212:213], v48 offset:12288
 ds_read_b64_tr_b16 a[214:215], v48 offset:13824
 ds_read_b64_tr_b16 a[216:217], v46 offset:24576
 ds_read_b64_tr_b16 a[218:219], v46 offset:26112
 ds_read_b64_tr_b16 a[220:221], v47 offset:24576
 ds_read_b64_tr_b16 a[222:223], v47 offset:26112
 ds_read_b64_tr_b16 a[224:225], v48 offset:24576
 ds_read_b64_tr_b16 a[226:227], v48 offset:26112
 ds_read_b64_tr_b16 a[228:229], v46 offset:36864
 ds_read_b64_tr_b16 a[230:231], v46 offset:38400
 ds_read_b64_tr_b16 a[232:233], v47 offset:36864
 ds_read_b64_tr_b16 a[234:235], v47 offset:38400
 ds_read_b64_tr_b16 a[236:237], v48 offset:36864
 ds_read_b64_tr_b16 a[238:239], v48 offset:38400
 s_waitcnt lgkmcnt(0)
 s_barrier
 v_mfma_f32_16x16x32_bf16 v[64:67], a[192:195], v[160:163], v[64:67]
 ds_read_b128 v[192:195], v19 offset:0
 v_mfma_f32_16x16x32_bf16 v[68:71], a[196:199], v[160:163], v[68:71]
 v_add_u32 v18, s33, v14
 v_mfma_f32_16x16x32_bf16 v[72:75], a[200:203], v[160:163], v[72:75]
 v_mfma_f32_16x16x32_bf16 v[76:79], a[192:195], v[164:167], v[76:79]
 ds_read_b128 v[196:199], v19 offset:2048
 v_mfma_f32_16x16x32_bf16 v[80:83], a[196:199], v[164:167], v[80:83]
 buffer_load_dwordx4 v11, s[8:11], s30 offen offset:1024 lds
 v_mfma_f32_16x16x32_bf16 v[84:87], a[200:203], v[164:167], v[84:87]
 s_add_u32 s30, s30, 128
 v_mfma_f32_16x16x32_bf16 v[88:91], a[192:195], v[168:171], v[88:91]
 ds_read_b128 v[200:203], v19 offset:4096
 s_add_u32 m0, m0, 8192
 v_mfma_f32_16x16x32_bf16 v[92:95], a[196:199], v[168:171], v[92:95]
 s_cmp_lt_u32 m0, s46
 s_cselect_b32 m0, m0, s47
 v_mfma_f32_16x16x32_bf16 v[96:99], a[200:203], v[168:171], v[96:99]
 v_mfma_f32_16x16x32_bf16 v[100:103], a[192:195], v[172:175], v[100:103]
 ds_read_b128 v[204:207], v19 offset:6144
 v_mfma_f32_16x16x32_bf16 v[104:107], a[196:199], v[172:175], v[104:107]
 v_mfma_f32_16x16x32_bf16 v[108:111], a[200:203], v[172:175], v[108:111]
 s_waitcnt vmcnt(8) lgkmcnt(2)
 s_barrier
 v_mfma_f32_16x16x32_bf16 v[64:67], a[204:207], v[192:195], v[64:67]
 ds_read_b128 v[160:163], v18 offset:0
 v_mfma_f32_16x16x32_bf16 v[68:71], a[208:211], v[192:195], v[68:71]
 v_mfma_f32_16x16x32_bf16 v[72:75], a[212:215], v[192:195], v[72:75]
 v_add_u32 v19, s33, v15
 s_add_u32 s33, s33, 8192
 v_mfma_f32_16x16x32_bf16 v[76:79], a[204:207], v[196:199], v[76:79]
 ds_read_b128 v[164:167], v18 offset:2048
 v_mfma_f32_16x16x32_bf16 v[80:83], a[208:211], v[196:199], v[80:83]
 buffer_load_dwordx4 v10, s[8:11], s30 offen offset:0 lds
 v_mfma_f32_16x16x32_bf16 v[84:87], a[212:215], v[196:199], v[84:87]
 s_waitcnt lgkmcnt(2)
 v_mfma_f32_16x16x32_bf16 v[88:91], a[204:207], v[200:203], v[88:91]
 ds_read_b128 v[168:171], v18 offset:4096
 v_mfma_f32_16x16x32_bf16 v[92:95], a[208:211], v[200:203], v[92:95]
 s_cmp_lt_u32 s33, 155648
 s_cselect_b32 s33, s33, 98304
 v_mfma_f32_16x16x32_bf16 v[96:99], a[212:215], v[200:203], v[96:99]
 v_mfma_f32_16x16x32_bf16 v[100:103], a[204:207], v[204:207], v[100:103]
 ds_read_b128 v[172:175], v18 offset:6144
 v_mfma_f32_16x16x32_bf16 v[104:107], a[208:211], v[204:207], v[104:107]
 v_mfma_f32_16x16x32_bf16 v[108:111], a[212:215], v[204:207], v[108:111]
 s_waitcnt lgkmcnt(2)
 v_mfma_f32_16x16x32_bf16 v[64:67], a[216:219], v[160:163], v[64:67]
 ds_read_b128 v[192:195], v19 offset:0
 v_mfma_f32_16x16x32_bf16 v[68:71], a[220:223], v[160:163], v[68:71]
 v_add_u32 v18, s33, v14
 v_mfma_f32_16x16x32_bf16 v[72:75], a[224:227], v[160:163], v[72:75]
 v_mfma_f32_16x16x32_bf16 v[76:79], a[216:219], v[164:167], v[76:79]
 ds_read_b128 v[196:199], v19 offset:2048
 v_mfma_f32_16x16x32_bf16 v[80:83], a[220:223], v[164:167], v[80:83]
 buffer_load_dwordx4 v11, s[8:11], s30 offen offset:1024 lds
 v_mfma_f32_16x16x32_bf16 v[84:87], a[224:227], v[164:167], v[84:87]
 s_waitcnt lgkmcnt(2)
 s_add_u32 s30, s30, 128
 v_mfma_f32_16x16x32_bf16 v[88:91], a[216:219], v[168:171], v[88:91]
 ds_read_b128 v[200:203], v19 offset:4096
 s_add_u32 m0, m0, 8192
 v_mfma_f32_16x16x32_bf16 v[92:95], a[220:223], v[168:171], v[92:95]
 s_cmp_lt_u32 m0, s46
 s_cselect_b32 m0, m0, s47
 v_mfma_f32_16x16x32_bf16 v[96:99], a[224:227], v[168:171], v[96:99]
 v_mfma_f32_16x16x32_bf16 v[100:103], a[216:219], v[172:175], v[100:103]
 ds_read_b128 v[204:207], v19 offset:6144
 v_mfma_f32_16x16x32_bf16 v[104:107], a[220:223], v[172:175], v[104:107]
 v_mfma_f32_16x16x32_bf16 v[108:111], a[224:227], v[172:175], v[108:111]
 s_waitcnt vmcnt(8) lgkmcnt(2)
 s_barrier
 v_mfma_f32_16x16x32_bf16 v[64:67], a[228:231], v[192:195], v[64:67]
 ds_read_b128 v[160:163], v18 offset:0
 v_mfma_f32_16x16x32_bf16 v[68:71], a[232:235], v[192:195], v[68:71]
 v_mfma_f32_16x16x32_bf16 v[72:75], a[236:239], v[192:195], v[72:75]
 v_add_u32 v19, s33, v15
 s_add_u32 s33, s33, 8192
 v_mfma_f32_16x16x32_bf16 v[76:79], a[228:231], v[196:199], v[76:79]
 ds_read_b128 v[164:167], v18 offset:2048
 v_cvt_pk_bf16_f32 v224, v64, v65
 v_cvt_pk_bf16_f32 v225, v66, v67
 v_mfma_f32_16x16x32_bf16 v[80:83], a[232:235], v[196:199], v[80:83]
 buffer_load_dwordx4 v10, s[8:11], s30 offen offset:0 lds
 v_cvt_pk_bf16_f32 v226, v68, v69
 v_cvt_pk_bf16_f32 v227, v70, v71
 v_mfma_f32_16x16x32_bf16 v[84:87], a[236:239], v[196:199], v[84:87]
 s_waitcnt lgkmcnt(2)
 v_cvt_pk_bf16_f32 v228, v72, v73
 v_cvt_pk_bf16_f32 v229, v74, v75
 v_mfma_f32_16x16x32_bf16 v[88:91], a[228:231], v[200:203], v[88:91]
 ds_read_b128 v[168:171], v18 offset:4096
 ds_write_b64 v22, v[224:225] offset:0
 v_mfma_f32_16x16x32_bf16 v[92:95], a[232:235], v[200:203], v[92:95]
 s_cmp_lt_u32 s33, 155648
 s_cselect_b32 s33, s33, 98304
 ds_write_b64 v22, v[226:227] offset:8
 v_mfma_f32_16x16x32_bf16 v[96:99], a[236:239], v[200:203], v[96:99]
 ds_write_b64 v16, v[228:229] offset:64
 v_cvt_pk_bf16_f32 v230, v76, v77
 v_cvt_pk_bf16_f32 v231, v78, v79
 v_mfma_f32_16x16x32_bf16 v[100:103], a[228:231], v[204:207], v[100:103]
 ds_read_b128 v[172:175], v18 offset:6144
 v_cvt_pk_bf16_f32 v232, v80, v81
 v_cvt_pk_bf16_f32 v233, v82, v83
 v_cvt_pk_bf16_f32 v234, v84, v85
 v_mfma_f32_16x16x32_bf16 v[104:107], a[232:235], v[204:207], v[104:107]
 v_cvt_pk_bf16_f32 v235, v86, v87
 ds_write_b64 v22, v[230:231] offset:6400
 v_mfma_f32_16x16x32_bf16 v[108:111], a[236:239], v[204:207], v[108:111]
 ds_write_b64 v22, v[232:233] offset:6408
 ds_write_b64 v16, v[234:235] offset:6464
 v_readfirstlane_b32 s21, v29
 s_cmp_ge_u32 s21, 32
 s_cbranch_scc1 kvz_128
 s_mov_b32 s21, 76
 v_mov_b32 v4, 0
 s_mov_b32 s101, 0
wf_129:
 buffer_load_dword v5, v4, s[64:67], s21 offen sc1
 s_add_u32 s101, s101, 1
 s_cmp_gt_u32 s101, 131072
 s_cbranch_scc1 main_end
 s_waitcnt vmcnt(0)
 v_readfirstlane_b32 s100, v5
 s_cmp_ge_u32 s100, 32
 s_cbranch_scc1 wf_130
 s_sleep 8
 s_branch wf_129
wf_130:
kvz_128:
 s_branch kvm_end_127
kvm_blk_126:
 v_mfma_f32_16x16x32_bf16 v[64:67], a[0:3], v[160:163], 0
 ds_read_b128 v[192:195], v19 offset:0
 v_mfma_f32_16x16x32_bf16 v[68:71], a[4:7], v[160:163], 0
 v_add_u32 v18, s33, v14
 v_mfma_f32_16x16x32_bf16 v[72:75], a[8:11], v[160:163], 0
 v_mfma_f32_16x16x32_bf16 v[76:79], a[0:3], v[164:167], 0
 ds_read_b128 v[196:199], v19 offset:2048
 v_mfma_f32_16x16x32_bf16 v[80:83], a[4:7], v[164:167], 0
 buffer_load_dwordx4 v11, s[8:11], s30 offen offset:1024 lds
 v_mfma_f32_16x16x32_bf16 v[84:87], a[8:11], v[164:167], 0
 s_waitcnt lgkmcnt(11)
 s_add_u32 s30, s30, 128
 v_mfma_f32_16x16x32_bf16 v[88:91], a[0:3], v[168:171], 0
 ds_read_b128 v[200:203], v19 offset:4096
 s_add_u32 m0, m0, 8192
 v_mfma_f32_16x16x32_bf16 v[92:95], a[4:7], v[168:171], 0
 s_cmp_lt_u32 m0, s46
 s_cselect_b32 m0, m0, s47
 v_mfma_f32_16x16x32_bf16 v[96:99], a[8:11], v[168:171], 0
 v_mfma_f32_16x16x32_bf16 v[100:103], a[0:3], v[172:175], 0
 ds_read_b128 v[204:207], v19 offset:6144
 v_mfma_f32_16x16x32_bf16 v[104:107], a[4:7], v[172:175], 0
 v_mfma_f32_16x16x32_bf16 v[108:111], a[8:11], v[172:175], 0
 s_waitcnt vmcnt(14) lgkmcnt(2)
 s_barrier
 v_mfma_f32_16x16x32_bf16 v[64:67], a[12:15], v[192:195], v[64:67]
 ds_read_b128 v[160:163], v18 offset:0
 v_mfma_f32_16x16x32_bf16 v[68:71], a[16:19], v[192:195], v[68:71]
 v_mfma_f32_16x16x32_bf16 v[72:75], a[20:23], v[192:195], v[72:75]
 v_add_u32 v19, s33, v15
 s_add_u32 s33, s33, 8192
 v_mfma_f32_16x16x32_bf16 v[76:79], a[12:15], v[196:199], v[76:79]
 ds_read_b128 v[164:167], v18 offset:2048
 v_mfma_f32_16x16x32_bf16 v[80:83], a[16:19], v[196:199], v[80:83]
 buffer_load_dwordx4 v10, s[8:11], s30 offen offset:0 lds
 v_mfma_f32_16x16x32_bf16 v[84:87], a[20:23], v[196:199], v[84:87]
 s_waitcnt lgkmcnt(2)
 v_mfma_f32_16x16x32_bf16 v[88:91], a[12:15], v[200:203], v[88:91]
 ds_read_b128 v[168:171], v18 offset:4096
 v_mfma_f32_16x16x32_bf16 v[92:95], a[16:19], v[200:203], v[92:95]
 s_cmp_lt_u32 s33, 155648
 s_cselect_b32 s33, s33, 98304
 v_mfma_f32_16x16x32_bf16 v[96:99], a[20:23], v[200:203], v[96:99]
 v_mfma_f32_16x16x32_bf16 v[100:103], a[12:15], v[204:207], v[100:103]
 ds_read_b128 v[172:175], v18 offset:6144
 v_mfma_f32_16x16x32_bf16 v[104:107], a[16:19], v[204:207], v[104:107]
 v_mfma_f32_16x16x32_bf16 v[108:111], a[20:23], v[204:207], v[108:111]
 s_waitcnt lgkmcnt(2)
 v_mfma_f32_16x16x32_bf16 v[64:67], a[24:27], v[160:163], v[64:67]
 ds_read_b128 v[192:195], v19 offset:0
 v_mfma_f32_16x16x32_bf16 v[68:71], a[28:31], v[160:163], v[68:71]
 v_add_u32 v18, s33, v14
 v_mfma_f32_16x16x32_bf16 v[72:75], a[32:35], v[160:163], v[72:75]
 v_mfma_f32_16x16x32_bf16 v[76:79], a[24:27], v[164:167], v[76:79]
 ds_read_b128 v[196:199], v19 offset:2048
 v_mfma_f32_16x16x32_bf16 v[80:83], a[28:31], v[164:167], v[80:83]
 buffer_load_dwordx4 v11, s[8:11], s30 offen offset:1024 lds
 v_mfma_f32_16x16x32_bf16 v[84:87], a[32:35], v[164:167], v[84:87]
 s_waitcnt lgkmcnt(2)
 s_add_u32 s30, s30, 128
 v_mfma_f32_16x16x32_bf16 v[88:91], a[24:27], v[168:171], v[88:91]
 ds_read_b128 v[200:203], v19 offset:4096
 s_add_u32 m0, m0, 8192
 v_mfma_f32_16x16x32_bf16 v[92:95], a[28:31], v[168:171], v[92:95]
 s_cmp_lt_u32 m0, s46
 s_cselect_b32 m0, m0, s47
 v_mfma_f32_16x16x32_bf16 v[96:99], a[32:35], v[168:171], v[96:99]
 v_mfma_f32_16x16x32_bf16 v[100:103], a[24:27], v[172:175], v[100:103]
 ds_read_b128 v[204:207], v19 offset:6144
 v_mfma_f32_16x16x32_bf16 v[104:107], a[28:31], v[172:175], v[104:107]
 v_mfma_f32_16x16x32_bf16 v[108:111], a[32:35], v[172:175], v[108:111]
 s_waitcnt vmcnt(14) lgkmcnt(2)
 s_barrier
 v_mfma_f32_16x16x32_bf16 v[64:67], a[36:39], v[192:195], v[64:67]
 ds_read_b128 v[160:163], v18 offset:0
 v_mfma_f32_16x16x32_bf16 v[68:71], a[40:43], v[192:195], v[68:71]
 v_mfma_f32_16x16x32_bf16 v[72:75], a[44:47], v[192:195], v[72:75]
 v_add_u32 v19, s33, v15
 s_add_u32 s33, s33, 8192
 v_mfma_f32_16x16x32_bf16 v[76:79], a[36:39], v[196:199], v[76:79]
 ds_read_b128 v[164:167], v18 offset:2048
 v_mfma_f32_16x16x32_bf16 v[80:83], a[40:43], v[196:199], v[80:83]
 buffer_load_dwordx4 v10, s[8:11], s30 offen offset:0 lds
 v_mfma_f32_16x16x32_bf16 v[84:87], a[44:47], v[196:199], v[84:87]
 s_waitcnt lgkmcnt(2)
 v_mfma_f32_16x16x32_bf16 v[88:91], a[36:39], v[200:203], v[88:91]
 ds_read_b128 v[168:171], v18 offset:4096
 v_mfma_f32_16x16x32_bf16 v[92:95], a[40:43], v[200:203], v[92:95]
 s_cmp_lt_u32 s33, 155648
 s_cselect_b32 s33, s33, 98304
 v_mfma_f32_16x16x32_bf16 v[96:99], a[44:47], v[200:203], v[96:99]
 v_mfma_f32_16x16x32_bf16 v[100:103], a[36:39], v[204:207], v[100:103]
 ds_read_b128 v[172:175], v18 offset:6144
 v_mfma_f32_16x16x32_bf16 v[104:107], a[40:43], v[204:207], v[104:107]
 v_mfma_f32_16x16x32_bf16 v[108:111], a[44:47], v[204:207], v[108:111]
 s_waitcnt lgkmcnt(2)
 v_mfma_f32_16x16x32_bf16 v[64:67], a[48:51], v[160:163], v[64:67]
 ds_read_b128 v[192:195], v19 offset:0
 v_mfma_f32_16x16x32_bf16 v[68:71], a[52:55], v[160:163], v[68:71]
 v_add_u32 v18, s33, v14
 v_mfma_f32_16x16x32_bf16 v[72:75], a[56:59], v[160:163], v[72:75]
 v_mfma_f32_16x16x32_bf16 v[76:79], a[48:51], v[164:167], v[76:79]
 ds_read_b128 v[196:199], v19 offset:2048
 v_mfma_f32_16x16x32_bf16 v[80:83], a[52:55], v[164:167], v[80:83]
 buffer_load_dwordx4 v11, s[8:11], s30 offen offset:1024 lds
 v_mfma_f32_16x16x32_bf16 v[84:87], a[56:59], v[164:167], v[84:87]
 s_waitcnt lgkmcnt(2)
 s_add_u32 s30, s30, 128
 v_mfma_f32_16x16x32_bf16 v[88:91], a[48:51], v[168:171], v[88:91]
 ds_read_b128 v[200:203], v19 offset:4096
 s_add_u32 m0, m0, 8192
 v_mfma_f32_16x16x32_bf16 v[92:95], a[52:55], v[168:171], v[92:95]
 s_cmp_lt_u32 m0, s46
 s_cselect_b32 m0, m0, s47
 v_mfma_f32_16x16x32_bf16 v[96:99], a[56:59], v[168:171], v[96:99]
 v_mfma_f32_16x16x32_bf16 v[100:103], a[48:51], v[172:175], v[100:103]
 ds_read_b128 v[204:207], v19 offset:6144
 v_mfma_f32_16x16x32_bf16 v[104:107], a[52:55], v[172:175], v[104:107]
 v_mfma_f32_16x16x32_bf16 v[108:111], a[56:59], v[172:175], v[108:111]
 s_waitcnt vmcnt(14) lgkmcnt(2)
 s_barrier
 v_mfma_f32_16x16x32_bf16 v[64:67], a[60:63], v[192:195], v[64:67]
 ds_read_b128 v[160:163], v18 offset:0
 v_mfma_f32_16x16x32_bf16 v[68:71], a[64:67], v[192:195], v[68:71]
 v_mfma_f32_16x16x32_bf16 v[72:75], a[68:71], v[192:195], v[72:75]
 v_add_u32 v19, s33, v15
 s_add_u32 s33, s33, 8192
 v_mfma_f32_16x16x32_bf16 v[76:79], a[60:63], v[196:199], v[76:79]
 ds_read_b128 v[164:167], v18 offset:2048
 v_mfma_f32_16x16x32_bf16 v[80:83], a[64:67], v[196:199], v[80:83]
 buffer_load_dwordx4 v10, s[8:11], s30 offen offset:0 lds
 v_mfma_f32_16x16x32_bf16 v[84:87], a[68:71], v[196:199], v[84:87]
 s_waitcnt lgkmcnt(2)
 v_mfma_f32_16x16x32_bf16 v[88:91], a[60:63], v[200:203], v[88:91]
 ds_read_b128 v[168:171], v18 offset:4096
 v_mfma_f32_16x16x32_bf16 v[92:95], a[64:67], v[200:203], v[92:95]
 s_cmp_lt_u32 s33, 155648
 s_cselect_b32 s33, s33, 98304
 v_mfma_f32_16x16x32_bf16 v[96:99], a[68:71], v[200:203], v[96:99]
 v_mfma_f32_16x16x32_bf16 v[100:103], a[60:63], v[204:207], v[100:103]
 ds_read_b128 v[172:175], v18 offset:6144
 v_mfma_f32_16x16x32_bf16 v[104:107], a[64:67], v[204:207], v[104:107]
 v_mfma_f32_16x16x32_bf16 v[108:111], a[68:71], v[204:207], v[108:111]
 s_waitcnt lgkmcnt(2)
 v_mfma_f32_16x16x32_bf16 v[64:67], a[72:75], v[160:163], v[64:67]
 ds_read_b128 v[192:195], v19 offset:0
 v_mfma_f32_16x16x32_bf16 v[68:71], a[76:79], v[160:163], v[68:71]
 v_add_u32 v18, s33, v14
 v_mfma_f32_16x16x32_bf16 v[72:75], a[80:83], v[160:163], v[72:75]
 v_mfma_f32_16x16x32_bf16 v[76:79], a[72:75], v[164:167], v[76:79]
 ds_read_b128 v[196:199], v19 offset:2048
 v_mfma_f32_16x16x32_bf16 v[80:83], a[76:79], v[164:167], v[80:83]
 buffer_load_dwordx4 v11, s[8:11], s30 offen offset:1024 lds
 v_mfma_f32_16x16x32_bf16 v[84:87], a[80:83], v[164:167], v[84:87]
 s_waitcnt lgkmcnt(2)
 s_add_u32 s30, s30, 128
 v_mfma_f32_16x16x32_bf16 v[88:91], a[72:75], v[168:171], v[88:91]
 ds_read_b128 v[200:203], v19 offset:4096
 s_add_u32 m0, m0, 8192
 v_mfma_f32_16x16x32_bf16 v[92:95], a[76:79], v[168:171], v[92:95]
 s_cmp_lt_u32 m0, s46
 s_cselect_b32 m0, m0, s47
 v_mfma_f32_16x16x32_bf16 v[96:99], a[80:83], v[168:171], v[96:99]
 v_mfma_f32_16x16x32_bf16 v[100:103], a[72:75], v[172:175], v[100:103]
 ds_read_b128 v[204:207], v19 offset:6144
 v_mfma_f32_16x16x32_bf16 v[104:107], a[76:79], v[172:175], v[104:107]
 v_mfma_f32_16x16x32_bf16 v[108:111], a[80:83], v[172:175], v[108:111]
 s_waitcnt vmcnt(7) lgkmcnt(2)
 s_barrier
 v_mfma_f32_16x16x32_bf16 v[64:67], a[84:87], v[192:195], v[64:67]
 ds_read_b128 v[160:163], v18 offset:0
 v_mfma_f32_16x16x32_bf16 v[68:71], a[88:91], v[192:195], v[68:71]
 s_cmp_eq_u32 s48, 0x80000000
 s_cbranch_scc1 kvm_124
 s_cmp_lg_u32 s20, 0
 s_cbranch_scc1 af_125
 v_mov_b32 v4, 0
 v_mov_b32 v5, 1
 s_mov_b64 exec, 1
 buffer_atomic_add v5, v4, s[72:75], s61 offen sc1
 s_mov_b64 exec, -1
 s_nop 1
af_125:
kvm_124:
 v_mfma_f32_16x16x32_bf16 v[72:75], a[92:95], v[192:195], v[72:75]
 v_add_u32 v19, s33, v15
 s_add_u32 s33, s33, 8192
 v_mfma_f32_16x16x32_bf16 v[76:79], a[84:87], v[196:199], v[76:79]
 ds_read_b128 v[164:167], v18 offset:2048
 v_mfma_f32_16x16x32_bf16 v[80:83], a[88:91], v[196:199], v[80:83]
 buffer_load_dwordx4 v10, s[8:11], s30 offen offset:0 lds
 v_mfma_f32_16x16x32_bf16 v[84:87], a[92:95], v[196:199], v[84:87]
 s_waitcnt lgkmcnt(2)
 v_mfma_f32_16x16x32_bf16 v[88:91], a[84:87], v[200:203], v[88:91]
 ds_read_b128 v[168:171], v18 offset:4096
 v_mfma_f32_16x16x32_bf16 v[92:95], a[88:91], v[200:203], v[92:95]
 s_cmp_lt_u32 s33, 155648
 s_cselect_b32 s33, s33, 98304
 v_mfma_f32_16x16x32_bf16 v[96:99], a[92:95], v[200:203], v[96:99]
 v_mfma_f32_16x16x32_bf16 v[100:103], a[84:87], v[204:207], v[100:103]
 ds_read_b128 v[172:175], v18 offset:6144
 v_mfma_f32_16x16x32_bf16 v[104:107], a[88:91], v[204:207], v[104:107]
 v_mfma_f32_16x16x32_bf16 v[108:111], a[92:95], v[204:207], v[108:111]
 s_waitcnt lgkmcnt(2)
 v_mfma_f32_16x16x32_bf16 v[64:67], a[96:99], v[160:163], v[64:67]
 ds_read_b128 v[192:195], v19 offset:0
 v_mfma_f32_16x16x32_bf16 v[68:71], a[100:103], v[160:163], v[68:71]
 v_add_u32 v18, s33, v14
 s_mov_b32 s61, s60
 v_mfma_f32_16x16x32_bf16 v[72:75], a[104:107], v[160:163], v[72:75]
 s_add_u32 s60, s60, s62
 s_lshr_b32 s48, s20, 1
 v_mfma_f32_16x16x32_bf16 v[76:79], a[96:99], v[164:167], v[76:79]
 ds_read_b128 v[196:199], v19 offset:2048
 s_mul_i32 s48, s48, 393216
 v_mfma_f32_16x16x32_bf16 v[80:83], a[100:103], v[164:167], v[80:83]
 buffer_load_dwordx4 v11, s[8:11], s30 offen offset:1024 lds
 v_mfma_f32_16x16x32_bf16 v[84:87], a[104:107], v[164:167], v[84:87]
 s_waitcnt lgkmcnt(2)
 s_add_u32 s30, s30, s25
 v_mfma_f32_16x16x32_bf16 v[88:91], a[96:99], v[168:171], v[88:91]
 ds_read_b128 v[200:203], v19 offset:4096
 s_sub_u32 s30, s30, 1152
 v_mfma_f32_16x16x32_bf16 v[92:95], a[100:103], v[168:171], v[92:95]
 s_add_u32 m0, m0, 8192
 s_and_b32 s21, s20, 1
 v_mfma_f32_16x16x32_bf16 v[96:99], a[104:107], v[168:171], v[96:99]
 s_cmp_lt_u32 m0, s46
 s_cselect_b32 m0, m0, s47
 v_mfma_f32_16x16x32_bf16 v[100:103], a[96:99], v[172:175], v[100:103]
 ds_read_b128 v[204:207], v19 offset:6144
 s_mul_i32 s21, s21, 6144
 v_mfma_f32_16x16x32_bf16 v[104:107], a[100:103], v[172:175], v[104:107]
 s_add_u32 s48, s48, s21
 s_add_u32 s48, s48, s27
 v_mfma_f32_16x16x32_bf16 v[108:111], a[104:107], v[172:175], v[108:111]
 s_waitcnt vmcnt(8) lgkmcnt(2)
 s_barrier
 v_mfma_f32_16x16x32_bf16 v[64:67], a[108:111], v[192:195], v[64:67]
 ds_read_b128 v[160:163], v18 offset:0
 s_add_u32 s27, s27, s28
 v_mfma_f32_16x16x32_bf16 v[68:71], a[112:115], v[192:195], v[68:71]
 s_sub_u32 s26, s26, 1
 v_mfma_f32_16x16x32_bf16 v[72:75], a[116:119], v[192:195], v[72:75]
 v_add_u32 v19, s33, v15
 s_add_u32 s33, s33, 8192
 v_mfma_f32_16x16x32_bf16 v[76:79], a[108:111], v[196:199], v[76:79]
 ds_read_b128 v[164:167], v18 offset:2048
 v_mfma_f32_16x16x32_bf16 v[80:83], a[112:115], v[196:199], v[80:83]
 buffer_load_dwordx4 v10, s[8:11], s30 offen offset:0 lds
 v_mfma_f32_16x16x32_bf16 v[84:87], a[116:119], v[196:199], v[84:87]
 s_waitcnt lgkmcnt(2)
 v_mfma_f32_16x16x32_bf16 v[88:91], a[108:111], v[200:203], v[88:91]
 ds_read_b128 v[168:171], v18 offset:4096
 v_mfma_f32_16x16x32_bf16 v[92:95], a[112:115], v[200:203], v[92:95]
 s_cmp_lt_u32 s33, 155648
 s_cselect_b32 s33, s33, 98304
 v_mfma_f32_16x16x32_bf16 v[96:99], a[116:119], v[200:203], v[96:99]
 v_mfma_f32_16x16x32_bf16 v[100:103], a[108:111], v[204:207], v[100:103]
 ds_read_b128 v[172:175], v18 offset:6144
 v_mfma_f32_16x16x32_bf16 v[104:107], a[112:115], v[204:207], v[104:107]
 v_mfma_f32_16x16x32_bf16 v[108:111], a[116:119], v[204:207], v[108:111]
 s_waitcnt lgkmcnt(2)
 v_mfma_f32_16x16x32_bf16 v[64:67], a[120:123], v[160:163], v[64:67]
 ds_read_b128 v[192:195], v19 offset:0
 v_mfma_f32_16x16x32_bf16 v[68:71], a[124:127], v[160:163], v[68:71]
 v_add_u32 v18, s33, v14
 v_mfma_f32_16x16x32_bf16 v[72:75], a[128:131], v[160:163], v[72:75]
 v_mfma_f32_16x16x32_bf16 v[76:79], a[120:123], v[164:167], v[76:79]
 ds_read_b128 v[196:199], v19 offset:2048
 v_mfma_f32_16x16x32_bf16 v[80:83], a[124:127], v[164:167], v[80:83]
 buffer_load_dwordx4 v11, s[8:11], s30 offen offset:1024 lds
 v_mfma_f32_16x16x32_bf16 v[84:87], a[128:131], v[164:167], v[84:87]
 s_waitcnt lgkmcnt(2)
 s_add_u32 s30, s30, 128
 v_mfma_f32_16x16x32_bf16 v[88:91], a[120:123], v[168:171], v[88:91]
 ds_read_b128 v[200:203], v19 offset:4096
 s_add_u32 m0, m0, 8192
 v_mfma_f32_16x16x32_bf16 v[92:95], a[124:127], v[168:171], v[92:95]
 s_cmp_lt_u32 m0, s46
 s_cselect_b32 m0, m0, s47
 v_mfma_f32_16x16x32_bf16 v[96:99], a[128:131], v[168:171], v[96:99]
 v_mfma_f32_16x16x32_bf16 v[100:103], a[120:123], v[172:175], v[100:103]
 ds_read_b128 v[204:207], v19 offset:6144
 v_mfma_f32_16x16x32_bf16 v[104:107], a[124:127], v[172:175], v[104:107]
 v_mfma_f32_16x16x32_bf16 v[108:111], a[128:131], v[172:175], v[108:111]
 s_waitcnt vmcnt(8) lgkmcnt(2)
 s_barrier
 v_mfma_f32_16x16x32_bf16 v[64:67], a[132:135], v[192:195], v[64:67]
 ds_read_b128 v[160:163], v18 offset:0
 v_mfma_f32_16x16x32_bf16 v[68:71], a[136:139], v[192:195], v[68:71]
 v_mfma_f32_16x16x32_bf16 v[72:75], a[140:143], v[192:195], v[72:75]
 v_add_u32 v19, s33, v15
 s_add_u32 s33, s33, 8192
 v_mfma_f32_16x16x32_bf16 v[76:79], a[132:135], v[196:199], v[76:79]
 ds_read_b128 v[164:167], v18 offset:2048
 v_mfma_f32_16x16x32_bf16 v[80:83], a[136:139], v[196:199], v[80:83]
 buffer_load_dwordx4 v10, s[8:11], s30 offen offset:0 lds
 v_mfma_f32_16x16x32_bf16 v[84:87], a[140:143], v[196:199], v[84:87]
 s_waitcnt lgkmcnt(2)
 v_mfma_f32_16x16x32_bf16 v[88:91], a[132:135], v[200:203], v[88:91]
 ds_read_b128 v[168:171], v18 offset:4096
 v_mfma_f32_16x16x32_bf16 v[92:95], a[136:139], v[200:203], v[92:95]
 s_cmp_lt_u32 s33, 155648
 s_cselect_b32 s33, s33, 98304
 v_mfma_f32_16x16x32_bf16 v[96:99], a[140:143], v[200:203], v[96:99]
 v_mfma_f32_16x16x32_bf16 v[100:103], a[132:135], v[204:207], v[100:103]
 ds_read_b128 v[172:175], v18 offset:6144
 v_mfma_f32_16x16x32_bf16 v[104:107], a[136:139], v[204:207], v[104:107]
 v_mfma_f32_16x16x32_bf16 v[108:111], a[140:143], v[204:207], v[108:111]
 s_waitcnt lgkmcnt(2)
 v_mfma_f32_16x16x32_bf16 v[64:67], a[144:147], v[160:163], v[64:67]
 ds_read_b128 v[192:195], v19 offset:0
 v_mfma_f32_16x16x32_bf16 v[68:71], a[148:151], v[160:163], v[68:71]
 v_add_u32 v18, s33, v14
 v_mfma_f32_16x16x32_bf16 v[72:75], a[152:155], v[160:163], v[72:75]
 v_mfma_f32_16x16x32_bf16 v[76:79], a[144:147], v[164:167], v[76:79]
 ds_read_b128 v[196:199], v19 offset:2048
 v_mfma_f32_16x16x32_bf16 v[80:83], a[148:151], v[164:167], v[80:83]
 buffer_load_dwordx4 v11, s[8:11], s30 offen offset:1024 lds
 v_mfma_f32_16x16x32_bf16 v[84:87], a[152:155], v[164:167], v[84:87]
 s_waitcnt lgkmcnt(2)
 s_add_u32 s30, s30, 128
 v_mfma_f32_16x16x32_bf16 v[88:91], a[144:147], v[168:171], v[88:91]
 ds_read_b128 v[200:203], v19 offset:4096
 s_add_u32 m0, m0, 8192
 v_mfma_f32_16x16x32_bf16 v[92:95], a[148:151], v[168:171], v[92:95]
 s_cmp_lt_u32 m0, s46
 s_cselect_b32 m0, m0, s47
 v_mfma_f32_16x16x32_bf16 v[96:99], a[152:155], v[168:171], v[96:99]
 v_mfma_f32_16x16x32_bf16 v[100:103], a[144:147], v[172:175], v[100:103]
 ds_read_b128 v[204:207], v19 offset:6144
 v_mfma_f32_16x16x32_bf16 v[104:107], a[148:151], v[172:175], v[104:107]
 v_mfma_f32_16x16x32_bf16 v[108:111], a[152:155], v[172:175], v[108:111]
 s_waitcnt vmcnt(8) lgkmcnt(2)
 s_barrier
 v_mfma_f32_16x16x32_bf16 v[64:67], a[156:159], v[192:195], v[64:67]
 ds_read_b128 v[160:163], v18 offset:0
 v_mfma_f32_16x16x32_bf16 v[68:71], a[160:163], v[192:195], v[68:71]
 v_mfma_f32_16x16x32_bf16 v[72:75], a[164:167], v[192:195], v[72:75]
 v_add_u32 v19, s33, v15
 s_add_u32 s33, s33, 8192
 v_mfma_f32_16x16x32_bf16 v[76:79], a[156:159], v[196:199], v[76:79]
 ds_read_b128 v[164:167], v18 offset:2048
 v_mfma_f32_16x16x32_bf16 v[80:83], a[160:163], v[196:199], v[80:83]
 buffer_load_dwordx4 v10, s[8:11], s30 offen offset:0 lds
 v_mfma_f32_16x16x32_bf16 v[84:87], a[164:167], v[196:199], v[84:87]
 s_waitcnt lgkmcnt(2)
 v_mfma_f32_16x16x32_bf16 v[88:91], a[156:159], v[200:203], v[88:91]
 ds_read_b128 v[168:171], v18 offset:4096
 v_mfma_f32_16x16x32_bf16 v[92:95], a[160:163], v[200:203], v[92:95]
 s_cmp_lt_u32 s33, 155648
 s_cselect_b32 s33, s33, 98304
 v_mfma_f32_16x16x32_bf16 v[96:99], a[164:167], v[200:203], v[96:99]
 v_mfma_f32_16x16x32_bf16 v[100:103], a[156:159], v[204:207], v[100:103]
 ds_read_b128 v[172:175], v18 offset:6144
 v_mfma_f32_16x16x32_bf16 v[104:107], a[160:163], v[204:207], v[104:107]
 v_mfma_f32_16x16x32_bf16 v[108:111], a[164:167], v[204:207], v[108:111]
 s_waitcnt lgkmcnt(2)
 v_mfma_f32_16x16x32_bf16 v[64:67], a[168:171], v[160:163], v[64:67]
 ds_read_b128 v[192:195], v19 offset:0
 v_mfma_f32_16x16x32_bf16 v[68:71], a[172:175], v[160:163], v[68:71]
 v_add_u32 v18, s33, v14
 v_mfma_f32_16x16x32_bf16 v[72:75], a[176:179], v[160:163], v[72:75]
 v_mfma_f32_16x16x32_bf16 v[76:79], a[168:171], v[164:167], v[76:79]
 ds_read_b128 v[196:199], v19 offset:2048
 v_mfma_f32_16x16x32_bf16 v[80:83], a[172:175], v[164:167], v[80:83]
 buffer_load_dwordx4 v11, s[8:11], s30 offen offset:1024 lds
 v_mfma_f32_16x16x32_bf16 v[84:87], a[176:179], v[164:167], v[84:87]
 s_waitcnt lgkmcnt(2)
 s_add_u32 s30, s30, 128
 v_mfma_f32_16x16x32_bf16 v[88:91], a[168:171], v[168:171], v[88:91]
 ds_read_b128 v[200:203], v19 offset:4096
 s_add_u32 m0, m0, 8192
 v_mfma_f32_16x16x32_bf16 v[92:95], a[172:175], v[168:171], v[92:95]
 s_cmp_lt_u32 m0, s46
 s_cselect_b32 m0, m0, s47
 v_mfma_f32_16x16x32_bf16 v[96:99], a[176:179], v[168:171], v[96:99]
 v_mfma_f32_16x16x32_bf16 v[100:103], a[168:171], v[172:175], v[100:103]
 ds_read_b128 v[204:207], v19 offset:6144
 v_mfma_f32_16x16x32_bf16 v[104:107], a[172:175], v[172:175], v[104:107]
 v_mfma_f32_16x16x32_bf16 v[108:111], a[176:179], v[172:175], v[108:111]
 s_waitcnt vmcnt(8) lgkmcnt(2)
 s_barrier
 v_mfma_f32_16x16x32_bf16 v[64:67], a[180:183], v[192:195], v[64:67]
 ds_read_b128 v[160:163], v18 offset:0
 v_mfma_f32_16x16x32_bf16 v[68:71], a[184:187], v[192:195], v[68:71]
 v_mfma_f32_16x16x32_bf16 v[72:75], a[188:191], v[192:195], v[72:75]
 v_add_u32 v19, s33, v15
 s_add_u32 s33, s33, 8192
 v_mfma_f32_16x16x32_bf16 v[76:79], a[180:183], v[196:199], v[76:79]
 ds_read_b128 v[164:167], v18 offset:2048
 v_mfma_f32_16x16x32_bf16 v[80:83], a[184:187], v[196:199], v[80:83]
 buffer_load_dwordx4 v10, s[8:11], s30 offen offset:0 lds
 v_mfma_f32_16x16x32_bf16 v[84:87], a[188:191], v[196:199], v[84:87]
 s_waitcnt lgkmcnt(2)
 v_mfma_f32_16x16x32_bf16 v[88:91], a[180:183], v[200:203], v[88:91]
 ds_read_b128 v[168:171], v18 offset:4096
 v_mfma_f32_16x16x32_bf16 v[92:95], a[184:187], v[200:203], v[92:95]
 s_cmp_lt_u32 s33, 155648
 s_cselect_b32 s33, s33, 98304
 v_mfma_f32_16x16x32_bf16 v[96:99], a[188:191], v[200:203], v[96:99]
 v_mfma_f32_16x16x32_bf16 v[100:103], a[180:183], v[204:207], v[100:103]
 ds_read_b128 v[172:175], v18 offset:6144
 v_mfma_f32_16x16x32_bf16 v[104:107], a[184:187], v[204:207], v[104:107]
 v_mfma_f32_16x16x32_bf16 v[108:111], a[188:191], v[204:207], v[108:111]
 s_waitcnt lgkmcnt(2)
 v_mfma_f32_16x16x32_bf16 v[64:67], a[192:195], v[160:163], v[64:67]
 ds_read_b128 v[192:195], v19 offset:0
 v_mfma_f32_16x16x32_bf16 v[68:71], a[196:199], v[160:163], v[68:71]
 v_add_u32 v18, s33, v14
 v_mfma_f32_16x16x32_bf16 v[72:75], a[200:203], v[160:163], v[72:75]
 v_mfma_f32_16x16x32_bf16 v[76:79], a[192:195], v[164:167], v[76:79]
 ds_read_b128 v[196:199], v19 offset:2048
 v_mfma_f32_16x16x32_bf16 v[80:83], a[196:199], v[164:167], v[80:83]
 buffer_load_dwordx4 v11, s[8:11], s30 offen offset:1024 lds
 v_mfma_f32_16x16x32_bf16 v[84:87], a[200:203], v[164:167], v[84:87]
 s_waitcnt lgkmcnt(2)
 s_add_u32 s30, s30, 128
 v_mfma_f32_16x16x32_bf16 v[88:91], a[192:195], v[168:171], v[88:91]
 ds_read_b128 v[200:203], v19 offset:4096
 s_add_u32 m0, m0, 8192
 v_mfma_f32_16x16x32_bf16 v[92:95], a[196:199], v[168:171], v[92:95]
 s_cmp_lt_u32 m0, s46
 s_cselect_b32 m0, m0, s47
 v_mfma_f32_16x16x32_bf16 v[96:99], a[200:203], v[168:171], v[96:99]
 v_mfma_f32_16x16x32_bf16 v[100:103], a[192:195], v[172:175], v[100:103]
 ds_read_b128 v[204:207], v19 offset:6144
 v_mfma_f32_16x16x32_bf16 v[104:107], a[196:199], v[172:175], v[104:107]
 v_mfma_f32_16x16x32_bf16 v[108:111], a[200:203], v[172:175], v[108:111]
 s_waitcnt vmcnt(8) lgkmcnt(2)
 s_barrier
 v_mfma_f32_16x16x32_bf16 v[64:67], a[204:207], v[192:195], v[64:67]
 ds_read_b128 v[160:163], v18 offset:0
 v_mfma_f32_16x16x32_bf16 v[68:71], a[208:211], v[192:195], v[68:71]
 v_mfma_f32_16x16x32_bf16 v[72:75], a[212:215], v[192:195], v[72:75]
 v_add_u32 v19, s33, v15
 s_add_u32 s33, s33, 8192
 v_mfma_f32_16x16x32_bf16 v[76:79], a[204:207], v[196:199], v[76:79]
 ds_read_b128 v[164:167], v18 offset:2048
 v_mfma_f32_16x16x32_bf16 v[80:83], a[208:211], v[196:199], v[80:83]
 buffer_load_dwordx4 v10, s[8:11], s30 offen offset:0 lds
 v_mfma_f32_16x16x32_bf16 v[84:87], a[212:215], v[196:199], v[84:87]
 s_waitcnt lgkmcnt(2)
 v_mfma_f32_16x16x32_bf16 v[88:91], a[204:207], v[200:203], v[88:91]
 ds_read_b128 v[168:171], v18 offset:4096
 v_mfma_f32_16x16x32_bf16 v[92:95], a[208:211], v[200:203], v[92:95]
 s_cmp_lt_u32 s33, 155648
 s_cselect_b32 s33, s33, 98304
 v_mfma_f32_16x16x32_bf16 v[96:99], a[212:215], v[200:203], v[96:99]
 v_mfma_f32_16x16x32_bf16 v[100:103], a[204:207], v[204:207], v[100:103]
 ds_read_b128 v[172:175], v18 offset:6144
 v_mfma_f32_16x16x32_bf16 v[104:107], a[208:211], v[204:207], v[104:107]
 v_mfma_f32_16x16x32_bf16 v[108:111], a[212:215], v[204:207], v[108:111]
 s_waitcnt lgkmcnt(2)
 v_mfma_f32_16x16x32_bf16 v[64:67], a[216:219], v[160:163], v[64:67]
 ds_read_b128 v[192:195], v19 offset:0
 v_mfma_f32_16x16x32_bf16 v[68:71], a[220:223], v[160:163], v[68:71]
 v_add_u32 v18, s33, v14
 v_mfma_f32_16x16x32_bf16 v[72:75], a[224:227], v[160:163], v[72:75]
 v_mfma_f32_16x16x32_bf16 v[76:79], a[216:219], v[164:167], v[76:79]
 ds_read_b128 v[196:199], v19 offset:2048
 v_mfma_f32_16x16x32_bf16 v[80:83], a[220:223], v[164:167], v[80:83]
 buffer_load_dwordx4 v11, s[8:11], s30 offen offset:1024 lds
 v_mfma_f32_16x16x32_bf16 v[84:87], a[224:227], v[164:167], v[84:87]
 s_waitcnt lgkmcnt(2)
 s_add_u32 s30, s30, 128
 v_mfma_f32_16x16x32_bf16 v[88:91], a[216:219], v[168:171], v[88:91]
 ds_read_b128 v[200:203], v19 offset:4096
 s_add_u32 m0, m0, 8192
 v_mfma_f32_16x16x32_bf16 v[92:95], a[220:223], v[168:171], v[92:95]
 s_cmp_lt_u32 m0, s46
 s_cselect_b32 m0, m0, s47
 v_mfma_f32_16x16x32_bf16 v[96:99], a[224:227], v[168:171], v[96:99]
 v_mfma_f32_16x16x32_bf16 v[100:103], a[216:219], v[172:175], v[100:103]
 ds_read_b128 v[204:207], v19 offset:6144
 v_mfma_f32_16x16x32_bf16 v[104:107], a[220:223], v[172:175], v[104:107]
 v_mfma_f32_16x16x32_bf16 v[108:111], a[224:227], v[172:175], v[108:111]
 s_waitcnt vmcnt(8) lgkmcnt(2)
 s_barrier
 v_mfma_f32_16x16x32_bf16 v[64:67], a[228:231], v[192:195], v[64:67]
 ds_read_b128 v[160:163], v18 offset:0
 v_mfma_f32_16x16x32_bf16 v[68:71], a[232:235], v[192:195], v[68:71]
 v_mfma_f32_16x16x32_bf16 v[72:75], a[236:239], v[192:195], v[72:75]
 v_add_u32 v19, s33, v15
 s_add_u32 s33, s33, 8192
 v_mfma_f32_16x16x32_bf16 v[76:79], a[228:231], v[196:199], v[76:79]
 ds_read_b128 v[164:167], v18 offset:2048
 v_cvt_pk_bf16_f32 v224, v64, v65
 v_cvt_pk_bf16_f32 v225, v66, v67
 v_mfma_f32_16x16x32_bf16 v[80:83], a[232:235], v[196:199], v[80:83]
 buffer_load_dwordx4 v10, s[8:11], s30 offen offset:0 lds
 v_cvt_pk_bf16_f32 v226, v68, v69
 v_cvt_pk_bf16_f32 v227, v70, v71
 v_mfma_f32_16x16x32_bf16 v[84:87], a[236:239], v[196:199], v[84:87]
 s_waitcnt lgkmcnt(2)
 v_cvt_pk_bf16_f32 v228, v72, v73
 v_cvt_pk_bf16_f32 v229, v74, v75
 v_mfma_f32_16x16x32_bf16 v[88:91], a[228:231], v[200:203], v[88:91]
 ds_read_b128 v[168:171], v18 offset:4096
 ds_write_b64 v22, v[224:225] offset:0
 v_mfma_f32_16x16x32_bf16 v[92:95], a[232:235], v[200:203], v[92:95]
 s_cmp_lt_u32 s33, 155648
 s_cselect_b32 s33, s33, 98304
 ds_write_b64 v22, v[226:227] offset:8
 v_mfma_f32_16x16x32_bf16 v[96:99], a[236:239], v[200:203], v[96:99]
 ds_write_b64 v16, v[228:229] offset:64
 v_cvt_pk_bf16_f32 v230, v76, v77
 v_cvt_pk_bf16_f32 v231, v78, v79
 v_mfma_f32_16x16x32_bf16 v[100:103], a[228:231], v[204:207], v[100:103]
 ds_read_b128 v[172:175], v18 offset:6144
 v_cvt_pk_bf16_f32 v232, v80, v81
 v_cvt_pk_bf16_f32 v233, v82, v83
 v_cvt_pk_bf16_f32 v234, v84, v85
 v_mfma_f32_16x16x32_bf16 v[104:107], a[232:235], v[204:207], v[104:107]
 v_cvt_pk_bf16_f32 v235, v86, v87
 ds_write_b64 v22, v[230:231] offset:6400
 v_mfma_f32_16x16x32_bf16 v[108:111], a[236:239], v[204:207], v[108:111]
 ds_write_b64 v22, v[232:233] offset:6408
 ds_write_b64 v16, v[234:235] offset:6464
kvm_end_127:
 v_cvt_pk_bf16_f32 v236, v88, v89
 v_cvt_pk_bf16_f32 v237, v90, v91
 v_cvt_pk_bf16_f32 v238, v92, v93
 v_cvt_pk_bf16_f32 v239, v94, v95
 v_cvt_pk_bf16_f32 v240, v96, v97
 v_cvt_pk_bf16_f32 v241, v98, v99
 ds_write_b64 v22, v[236:237] offset:12800
 ds_write_b64 v22, v[238:239] offset:12808
 ds_write_b64 v16, v[240:241] offset:12864
 v_cvt_pk_bf16_f32 v242, v100, v101
 v_cvt_pk_bf16_f32 v243, v102, v103
 v_cvt_pk_bf16_f32 v244, v104, v105
 v_cvt_pk_bf16_f32 v245, v106, v107
 v_cvt_pk_bf16_f32 v246, v108, v109
 v_cvt_pk_bf16_f32 v247, v110, v111
 ds_write_b64 v22, v[242:243] offset:19200
 ds_write_b64 v22, v[244:245] offset:19208
 ds_write_b64 v16, v[246:247] offset:19264
 s_waitcnt lgkmcnt(0)
 s_barrier
 ds_read_b128 v[224:227], v23 offset:0
 ds_read_b128 v[228:231], v23 offset:64
 ds_read_b128 v[232:235], v23 offset:128
 ds_read_b128 v[236:239], v23 offset:192
 ds_read_b128 v[240:243], v23 offset:256
 ds_read_b128 v[244:247], v23 offset:320
 s_waitcnt lgkmcnt(0)
 s_add_u32 s21, s48, 0
 buffer_store_dwordx4 v[224:227], v26, s[16:19], s21 offen offset:0 sc1
 buffer_store_dwordx4 v[228:231], v26, s[16:19], s21 offen offset:1024 sc1
 buffer_store_dwordx4 v[232:235], v26, s[16:19], s21 offen offset:2048 sc1
 buffer_store_dwordx4 v[236:239], v26, s[16:19], s21 offen offset:3072 sc1
 s_add_u32 s21, s48, 4096
 buffer_store_dwordx4 v[240:243], v26, s[16:19], s21 offen offset:0 sc1
 buffer_store_dwordx4 v[244:247], v26, s[16:19], s21 offen offset:1024 sc1
 s_nop 1
 s_cmp_gt_u32 s26, 0
 s_cbranch_scc1 kvm_blk_126
 s_waitcnt vmcnt(6)
 s_barrier
 v_and_b32 v30, 31, v1
 buffer_load_ubyte v29, v30, s[64:67], 0 offen offset:160 sc1
 s_mov_b32 s24, 491520
 s_mov_b32 s25, 163840
 v_lshrrev_b32 v11, 3, v1
 v_and_b32 v12, 7, v1
 v_xor_b32 v12, v12, v11
 v_mul_u32_u24 v11, 1280, v11
 v_lshl_add_u32 v10, v12, 4, v11
 s_mul_i32 s46, s20, 40960
 v_add_u32 v10, s46, v10
 s_lshl_b32 s47, s20, 12
 s_add_u32 s47, s47, 0
 s_add_u32 s46, s47, 98304
 s_mov_b32 s30, s24
 s_add_u32 s32, s47, 32768
 v_add_u32 v11, 9216, v10
 v_add_u32 v12, 18432, v10
 v_add_u32 v13, 27648, v10
 s_mov_b32 m0, s32
 s_nop 0
 buffer_load_dwordx4 v10, s[8:11], s30 offen offset:0 lds
 buffer_load_dwordx4 v11, s[8:11], s30 offen offset:1024 lds
 buffer_load_dwordx4 v12, s[8:11], s30 offen offset:2048 lds
 buffer_load_dwordx4 v13, s[8:11], s30 offen offset:3072 lds
 s_add_u32 s30, s30, 128
 s_add_u32 s32, s32, 16384
 s_cmp_lt_u32 s32, s46
 s_cselect_b32 s32, s32, s47
 s_mov_b32 m0, s32
 s_nop 0
 buffer_load_dwordx4 v10, s[8:11], s30 offen offset:0 lds
 buffer_load_dwordx4 v11, s[8:11], s30 offen offset:1024 lds
 buffer_load_dwordx4 v12, s[8:11], s30 offen offset:2048 lds
 buffer_load_dwordx4 v13, s[8:11], s30 offen offset:3072 lds
 s_add_u32 s30, s30, 128
 s_add_u32 s32, s32, 16384
 s_cmp_lt_u32 s32, s46
 s_cselect_b32 s32, s32, s47
 s_mov_b32 m0, s32
 s_nop 0
 buffer_load_dwordx4 v10, s[8:11], s30 offen offset:0 lds
 buffer_load_dwordx4 v11, s[8:11], s30 offen offset:1024 lds
 buffer_load_dwordx4 v12, s[8:11], s30 offen offset:2048 lds
 buffer_load_dwordx4 v13, s[8:11], s30 offen offset:3072 lds
 s_add_u32 s30, s30, 128
 s_add_u32 s32, s32, 16384
 s_cmp_lt_u32 s32, s46
 s_cselect_b32 s32, s32, s47
 s_mov_b32 m0, s32
 s_nop 0
 buffer_load_dwordx4 v10, s[8:11], s30 offen offset:0 lds
 buffer_load_dwordx4 v11, s[8:11], s30 offen offset:1024 lds
 buffer_load_dwordx4 v12, s[8:11], s30 offen offset:2048 lds
 buffer_load_dwordx4 v13, s[8:11], s30 offen offset:3072 lds
 s_add_u32 s30, s30, 128
 s_add_u32 s32, s32, 16384
 s_cmp_lt_u32 s32, s46
 s_cselect_b32 s32, s32, s47
 s_waitcnt vmcnt(16)
 s_barrier
 s_cmp_lg_u32 s20, 0
 s_cbranch_scc1 af_131
 v_mov_b32 v4, 0
 v_mov_b32 v5, 1
 s_mov_b64 exec, 1
 buffer_atomic_add v5, v4, s[72:75], s61 offen sc1
 s_mov_b64 exec, -1
 s_nop 1
af_131:
 s_mov_b32 s26, 13
 s_mov_b32 s28, 1572864
 s_mov_b32 s101, 0
c0_132:
 v_cmp_eq_u32 vcc, 0, v29
 s_nop 1
 s_cbranch_vccz c0_133
 s_sleep 8
 v_and_b32 v30, 31, v1
 buffer_load_ubyte v29, v30, s[64:67], 0 offen offset:160 sc1
 s_add_u32 s101, s101, 1
 s_cmp_gt_u32 s101, 131072
 s_cbranch_scc1 main_end
 s_waitcnt vmcnt(0)
 s_branch c0_132
c0_133:
 v_cmp_eq_u32 vcc, 2, v29
 s_nop 1
 s_mov_b32 s37, vcc_lo
kv_main:
 v_and_b32 v6, 7, v2
 v_add_u32 v4, 0, v3
 v_xor_b32 v4, v4, v6
 v_lshlrev_b32 v4, 4, v4
 v_lshl_add_u32 v14, v2, 7, v4
 v_add_u32 v4, 4, v3
 v_xor_b32 v4, v4, v6
 v_lshlrev_b32 v4, 4, v4
 v_lshl_add_u32 v15, v2, 7, v4
 v_mul_u32_u24 v22, 400, v2
 v_mul_u32_u24 v4, 16, v3
 s_mul_i32 s21, s20, 96
 s_add_u32 s21, s21, 98304
 v_add3_u32 v22, v22, v4, s21
 v_lshlrev_b32 v4, 3, v3
 v_sub_u32 v16, v22, v4
 v_mov_b32 v9, 2731
 s_mul_i32 s21, s20, 12800
 s_add_u32 s21, s21, 98304
 v_mul_u32_u24 v4, 400, v2
 v_lshlrev_b32 v5, 4, v3
 v_add3_u32 v23, v4, v5, s21
 v_lshlrev_b32 v26, 4, v1
 s_mov_b32 s33, 32768
 s_mov_b32 s48, 0x80000000
 s_mov_b32 m0, s32
 s_nop 0
 buffer_load_dwordx4 v10, s[8:11], s30 offen offset:0 lds
 buffer_load_dwordx4 v11, s[8:11], s30 offen offset:1024 lds
 s_waitcnt vmcnt(14)
 s_barrier
 v_add_u32 v18, s33, v14
 v_add_u32 v19, s33, v15
 s_add_u32 s33, s33, 16384
 s_cmp_lt_u32 s33, 98304
 s_cselect_b32 s33, s33, 0
 ds_read_b128 v[160:163], v18 offset:0
 ds_read_b128 v[164:167], v18 offset:2048
 ds_read_b128 v[168:171], v18 offset:4096
 ds_read_b128 v[172:175], v18 offset:6144
 ds_read_b128 v[176:179], v18 offset:8192
 ds_read_b128 v[180:183], v18 offset:10240
 ds_read_b128 v[184:187], v18 offset:12288
 ds_read_b128 v[188:191], v18 offset:14336
 s_waitcnt lgkmcnt(0)
kv_blk_136:
 v_mfma_f32_16x16x32_bf16 v[64:67], a[0:3], v[160:163], 0
 ds_read_b128 v[192:195], v19 offset:0
 v_mfma_f32_16x16x32_bf16 v[68:71], a[4:7], v[160:163], 0
 v_add_u32 v18, s33, v14
 v_mfma_f32_16x16x32_bf16 v[72:75], a[8:11], v[160:163], 0
 ds_write_b64 v16, v[234:235] offset:6464
 v_mfma_f32_16x16x32_bf16 v[76:79], a[0:3], v[164:167], 0
 ds_read_b128 v[196:199], v19 offset:2048
 v_cvt_pk_bf16_f32 v236, v88, v89
 v_mfma_f32_16x16x32_bf16 v[80:83], a[4:7], v[164:167], 0
 buffer_load_dwordx4 v12, s[8:11], s30 offen offset:2048 lds
 v_mfma_f32_16x16x32_bf16 v[84:87], a[8:11], v[164:167], 0
 v_cvt_pk_bf16_f32 v237, v90, v91
 v_cvt_pk_bf16_f32 v238, v92, v93
 v_mfma_f32_16x16x32_bf16 v[88:91], a[0:3], v[168:171], 0
 ds_read_b128 v[200:203], v19 offset:4096
 v_cvt_pk_bf16_f32 v239, v94, v95
 v_mfma_f32_16x16x32_bf16 v[92:95], a[4:7], v[168:171], 0
 v_cvt_pk_bf16_f32 v240, v96, v97
 v_cvt_pk_bf16_f32 v241, v98, v99
 v_mfma_f32_16x16x32_bf16 v[96:99], a[8:11], v[168:171], 0
 ds_write_b64 v22, v[236:237] offset:12800
 ds_write_b64 v22, v[238:239] offset:12808
 ds_write_b64 v16, v[240:241] offset:12864
 v_cvt_pk_bf16_f32 v242, v100, v101
 v_cvt_pk_bf16_f32 v243, v102, v103
 v_mfma_f32_16x16x32_bf16 v[100:103], a[0:3], v[172:175], 0
 ds_read_b128 v[204:207], v19 offset:6144
 v_cvt_pk_bf16_f32 v244, v104, v105
 v_cvt_pk_bf16_f32 v245, v106, v107
 v_mfma_f32_16x16x32_bf16 v[104:107], a[4:7], v[172:175], 0
 v_cvt_pk_bf16_f32 v246, v108, v109
 v_cvt_pk_bf16_f32 v247, v110, v111
 v_mfma_f32_16x16x32_bf16 v[108:111], a[8:11], v[172:175], 0
 s_waitcnt lgkmcnt(9)
 ds_write_b64 v22, v[242:243] offset:19200
 ds_write_b64 v22, v[244:245] offset:19208
 ds_write_b64 v16, v[246:247] offset:19264
 v_cvt_pk_bf16_f32 v224, v112, v113
 v_cvt_pk_bf16_f32 v225, v114, v115
 v_mfma_f32_16x16x32_bf16 v[112:115], a[0:3], v[176:179], 0
 ds_read_b128 v[208:211], v19 offset:8192
 v_cvt_pk_bf16_f32 v226, v116, v117
 v_cvt_pk_bf16_f32 v227, v118, v119
 v_mfma_f32_16x16x32_bf16 v[116:119], a[4:7], v[176:179], 0
 v_cvt_pk_bf16_f32 v228, v120, v121
 v_cvt_pk_bf16_f32 v229, v122, v123
 v_mfma_f32_16x16x32_bf16 v[120:123], a[8:11], v[176:179], 0
 ds_write_b64 v22, v[224:225] offset:25600
 ds_write_b64 v22, v[226:227] offset:25608
 ds_write_b64 v16, v[228:229] offset:25664
 v_cvt_pk_bf16_f32 v230, v124, v125
 v_cvt_pk_bf16_f32 v231, v126, v127
 v_mfma_f32_16x16x32_bf16 v[124:127], a[0:3], v[180:183], 0
 ds_read_b128 v[212:215], v19 offset:10240
 v_cvt_pk_bf16_f32 v232, v128, v129
 v_cvt_pk_bf16_f32 v233, v130, v131
 v_mfma_f32_16x16x32_bf16 v[128:131], a[4:7], v[180:183], 0
 buffer_load_dwordx4 v13, s[8:11], s30 offen offset:3072 lds
 v_cvt_pk_bf16_f32 v234, v132, v133
 v_cvt_pk_bf16_f32 v235, v134, v135
 v_mfma_f32_16x16x32_bf16 v[132:135], a[8:11], v[180:183], 0
 s_add_u32 s30, s30, 128
 s_add_u32 m0, m0, 16384
 ds_write_b64 v22, v[230:231] offset:32000
 ds_write_b64 v22, v[232:233] offset:32008
 ds_write_b64 v16, v[234:235] offset:32064
 v_cvt_pk_bf16_f32 v236, v136, v137
 v_cvt_pk_bf16_f32 v237, v138, v139
 v_mfma_f32_16x16x32_bf16 v[136:139], a[0:3], v[184:187], 0
 ds_read_b128 v[216:219], v19 offset:12288
 v_cvt_pk_bf16_f32 v238, v140, v141
 v_cvt_pk_bf16_f32 v239, v142, v143
 v_mfma_f32_16x16x32_bf16 v[140:143], a[4:7], v[184:187], 0
 s_cmp_lt_u32 m0, s46
 s_cselect_b32 m0, m0, s47
 v_cvt_pk_bf16_f32 v240, v144, v145
 v_cvt_pk_bf16_f32 v241, v146, v147
 v_mfma_f32_16x16x32_bf16 v[144:147], a[8:11], v[184:187], 0
 ds_write_b64 v22, v[236:237] offset:38400
 ds_write_b64 v22, v[238:239] offset:38408
 ds_write_b64 v16, v[240:241] offset:38464
 v_cvt_pk_bf16_f32 v242, v148, v149
 v_cvt_pk_bf16_f32 v243, v150, v151
 v_mfma_f32_16x16x32_bf16 v[148:151], a[0:3], v[188:191], 0
 ds_read_b128 v[220:223], v19 offset:14336
 v_cvt_pk_bf16_f32 v244, v152, v153
 v_cvt_pk_bf16_f32 v245, v154, v155
 v_mfma_f32_16x16x32_bf16 v[152:155], a[4:7], v[188:191], 0
 v_cvt_pk_bf16_f32 v246, v156, v157
 v_cvt_pk_bf16_f32 v247, v158, v159
 v_mfma_f32_16x16x32_bf16 v[156:159], a[8:11], v[188:191], 0
 s_waitcnt vmcnt(12) lgkmcnt(15)
 s_barrier
 v_mfma_f32_16x16x32_bf16 v[64:67], a[12:15], v[192:195], v[64:67]
 ds_read_b128 v[160:163], v18 offset:0
 v_mfma_f32_16x16x32_bf16 v[68:71], a[16:19], v[192:195], v[68:71]
 ds_write_b64 v22, v[242:243] offset:44800
 v_mfma_f32_16x16x32_bf16 v[72:75], a[20:23], v[192:195], v[72:75]
 v_add_u32 v19, s33, v15
 s_add_u32 s33, s33, 16384
 v_mfma_f32_16x16x32_bf16 v[76:79], a[12:15], v[196:199], v[76:79]
 ds_read_b128 v[164:167], v18 offset:2048
 v_mfma_f32_16x16x32_bf16 v[80:83], a[16:19], v[196:199], v[80:83]
 buffer_load_dwordx4 v10, s[8:11], s30 offen offset:0 lds
 v_mfma_f32_16x16x32_bf16 v[84:87], a[20:23], v[196:199], v[84:87]
 s_cmp_lt_u32 s33, 98304
 s_cselect_b32 s33, s33, 0
 v_mfma_f32_16x16x32_bf16 v[88:91], a[12:15], v[200:203], v[88:91]
 ds_read_b128 v[168:171], v18 offset:4096
 v_mfma_f32_16x16x32_bf16 v[92:95], a[16:19], v[200:203], v[92:95]
 ds_write_b64 v22, v[244:245] offset:44808
 v_mfma_f32_16x16x32_bf16 v[96:99], a[20:23], v[200:203], v[96:99]
 ds_write_b64 v16, v[246:247] offset:44864
 v_mfma_f32_16x16x32_bf16 v[100:103], a[12:15], v[204:207], v[100:103]
 ds_read_b128 v[172:175], v18 offset:6144
 v_mfma_f32_16x16x32_bf16 v[104:107], a[16:19], v[204:207], v[104:107]
 v_mfma_f32_16x16x32_bf16 v[108:111], a[20:23], v[204:207], v[108:111]
 s_waitcnt lgkmcnt(7)
 v_mfma_f32_16x16x32_bf16 v[112:115], a[12:15], v[208:211], v[112:115]
 ds_read_b128 v[176:179], v18 offset:8192
 v_mfma_f32_16x16x32_bf16 v[116:119], a[16:19], v[208:211], v[116:119]
 v_mfma_f32_16x16x32_bf16 v[120:123], a[20:23], v[208:211], v[120:123]
 v_mfma_f32_16x16x32_bf16 v[124:127], a[12:15], v[212:215], v[124:127]
 ds_read_b128 v[180:183], v18 offset:10240
 v_mfma_f32_16x16x32_bf16 v[128:131], a[16:19], v[212:215], v[128:131]
 buffer_load_dwordx4 v11, s[8:11], s30 offen offset:1024 lds
 v_mfma_f32_16x16x32_bf16 v[132:135], a[20:23], v[212:215], v[132:135]
 v_mfma_f32_16x16x32_bf16 v[136:139], a[12:15], v[216:219], v[136:139]
 ds_read_b128 v[184:187], v18 offset:12288
 v_mfma_f32_16x16x32_bf16 v[140:143], a[16:19], v[216:219], v[140:143]
 v_mfma_f32_16x16x32_bf16 v[144:147], a[20:23], v[216:219], v[144:147]
 v_mfma_f32_16x16x32_bf16 v[148:151], a[12:15], v[220:223], v[148:151]
 ds_read_b128 v[188:191], v18 offset:14336
 v_mfma_f32_16x16x32_bf16 v[152:155], a[16:19], v[220:223], v[152:155]
 v_mfma_f32_16x16x32_bf16 v[156:159], a[20:23], v[220:223], v[156:159]
 s_waitcnt lgkmcnt(4)
 v_mfma_f32_16x16x32_bf16 v[64:67], a[24:27], v[160:163], v[64:67]
 ds_read_b128 v[192:195], v19 offset:0
 v_mfma_f32_16x16x32_bf16 v[68:71], a[28:31], v[160:163], v[68:71]
 v_add_u32 v18, s33, v14
 v_mfma_f32_16x16x32_bf16 v[72:75], a[32:35], v[160:163], v[72:75]
 v_mfma_f32_16x16x32_bf16 v[76:79], a[24:27], v[164:167], v[76:79]
 ds_read_b128 v[196:199], v19 offset:2048
 v_mfma_f32_16x16x32_bf16 v[80:83], a[28:31], v[164:167], v[80:83]
 buffer_load_dwordx4 v12, s[8:11], s30 offen offset:2048 lds
 v_mfma_f32_16x16x32_bf16 v[84:87], a[32:35], v[164:167], v[84:87]
 v_mfma_f32_16x16x32_bf16 v[88:91], a[24:27], v[168:171], v[88:91]
 ds_read_b128 v[200:203], v19 offset:4096
 v_mfma_f32_16x16x32_bf16 v[92:95], a[28:31], v[168:171], v[92:95]
 v_mfma_f32_16x16x32_bf16 v[96:99], a[32:35], v[168:171], v[96:99]
 v_mfma_f32_16x16x32_bf16 v[100:103], a[24:27], v[172:175], v[100:103]
 ds_read_b128 v[204:207], v19 offset:6144
 v_mfma_f32_16x16x32_bf16 v[104:107], a[28:31], v[172:175], v[104:107]
 v_mfma_f32_16x16x32_bf16 v[108:111], a[32:35], v[172:175], v[108:111]
 s_waitcnt lgkmcnt(4)
 v_mfma_f32_16x16x32_bf16 v[112:115], a[24:27], v[176:179], v[112:115]
 ds_read_b128 v[208:211], v19 offset:8192
 v_mfma_f32_16x16x32_bf16 v[116:119], a[28:31], v[176:179], v[116:119]
 v_mfma_f32_16x16x32_bf16 v[120:123], a[32:35], v[176:179], v[120:123]
 v_mfma_f32_16x16x32_bf16 v[124:127], a[24:27], v[180:183], v[124:127]
 ds_read_b128 v[212:215], v19 offset:10240
 v_mfma_f32_16x16x32_bf16 v[128:131], a[28:31], v[180:183], v[128:131]
 buffer_load_dwordx4 v13, s[8:11], s30 offen offset:3072 lds
 v_mfma_f32_16x16x32_bf16 v[132:135], a[32:35], v[180:183], v[132:135]
 s_add_u32 s30, s30, 128
 s_add_u32 m0, m0, 16384
 v_mfma_f32_16x16x32_bf16 v[136:139], a[24:27], v[184:187], v[136:139]
 ds_read_b128 v[216:219], v19 offset:12288
 v_mfma_f32_16x16x32_bf16 v[140:143], a[28:31], v[184:187], v[140:143]
 s_cmp_lt_u32 m0, s46
 s_cselect_b32 m0, m0, s47
 v_mfma_f32_16x16x32_bf16 v[144:147], a[32:35], v[184:187], v[144:147]
 v_mfma_f32_16x16x32_bf16 v[148:151], a[24:27], v[188:191], v[148:151]
 ds_read_b128 v[220:223], v19 offset:14336
 v_mfma_f32_16x16x32_bf16 v[152:155], a[28:31], v[188:191], v[152:155]
 v_mfma_f32_16x16x32_bf16 v[156:159], a[32:35], v[188:191], v[156:159]
 s_waitcnt vmcnt(12) lgkmcnt(4)
 s_barrier
 v_mfma_f32_16x16x32_bf16 v[64:67], a[36:39], v[192:195], v[64:67]
 ds_read_b128 v[160:163], v18 offset:0
 v_mfma_f32_16x16x32_bf16 v[68:71], a[40:43], v[192:195], v[68:71]
 v_mfma_f32_16x16x32_bf16 v[72:75], a[44:47], v[192:195], v[72:75]
 v_add_u32 v19, s33, v15
 s_add_u32 s33, s33, 16384
 v_mfma_f32_16x16x32_bf16 v[76:79], a[36:39], v[196:199], v[76:79]
 ds_read_b128 v[164:167], v18 offset:2048
 v_mfma_f32_16x16x32_bf16 v[80:83], a[40:43], v[196:199], v[80:83]
 buffer_load_dwordx4 v10, s[8:11], s30 offen offset:0 lds
 v_mfma_f32_16x16x32_bf16 v[84:87], a[44:47], v[196:199], v[84:87]
 s_cmp_lt_u32 s33, 98304
 s_cselect_b32 s33, s33, 0
 v_mfma_f32_16x16x32_bf16 v[88:91], a[36:39], v[200:203], v[88:91]
 ds_read_b128 v[168:171], v18 offset:4096
 v_mfma_f32_16x16x32_bf16 v[92:95], a[40:43], v[200:203], v[92:95]
 ds_read_b128 v[224:227], v23 offset:0
 v_mfma_f32_16x16x32_bf16 v[96:99], a[44:47], v[200:203], v[96:99]
 v_mfma_f32_16x16x32_bf16 v[100:103], a[36:39], v[204:207], v[100:103]
 ds_read_b128 v[172:175], v18 offset:6144
 v_mfma_f32_16x16x32_bf16 v[104:107], a[40:43], v[204:207], v[104:107]
 v_mfma_f32_16x16x32_bf16 v[108:111], a[44:47], v[204:207], v[108:111]
 s_waitcnt lgkmcnt(5)
 v_mfma_f32_16x16x32_bf16 v[112:115], a[36:39], v[208:211], v[112:115]
 ds_read_b128 v[176:179], v18 offset:8192
 v_mfma_f32_16x16x32_bf16 v[116:119], a[40:43], v[208:211], v[116:119]
 v_mfma_f32_16x16x32_bf16 v[120:123], a[44:47], v[208:211], v[120:123]
 v_mfma_f32_16x16x32_bf16 v[124:127], a[36:39], v[212:215], v[124:127]
 ds_read_b128 v[180:183], v18 offset:10240
 v_mfma_f32_16x16x32_bf16 v[128:131], a[40:43], v[212:215], v[128:131]
 buffer_load_dwordx4 v11, s[8:11], s30 offen offset:1024 lds
 v_mfma_f32_16x16x32_bf16 v[132:135], a[44:47], v[212:215], v[132:135]
 v_mfma_f32_16x16x32_bf16 v[136:139], a[36:39], v[216:219], v[136:139]
 ds_read_b128 v[184:187], v18 offset:12288
 v_mfma_f32_16x16x32_bf16 v[140:143], a[40:43], v[216:219], v[140:143]
 ds_read_b128 v[228:231], v23 offset:64
 v_mfma_f32_16x16x32_bf16 v[144:147], a[44:47], v[216:219], v[144:147]
 v_mfma_f32_16x16x32_bf16 v[148:151], a[36:39], v[220:223], v[148:151]
 ds_read_b128 v[188:191], v18 offset:14336
 v_mfma_f32_16x16x32_bf16 v[152:155], a[40:43], v[220:223], v[152:155]
 v_mfma_f32_16x16x32_bf16 v[156:159], a[44:47], v[220:223], v[156:159]
 s_waitcnt lgkmcnt(5)
 v_mfma_f32_16x16x32_bf16 v[64:67], a[48:51], v[160:163], v[64:67]
 ds_read_b128 v[192:195], v19 offset:0
 v_mfma_f32_16x16x32_bf16 v[68:71], a[52:55], v[160:163], v[68:71]
 v_add_u32 v18, s33, v14
 v_mfma_f32_16x16x32_bf16 v[72:75], a[56:59], v[160:163], v[72:75]
 v_mfma_f32_16x16x32_bf16 v[76:79], a[48:51], v[164:167], v[76:79]
 ds_read_b128 v[196:199], v19 offset:2048
 v_mfma_f32_16x16x32_bf16 v[80:83], a[52:55], v[164:167], v[80:83]
 buffer_load_dwordx4 v12, s[8:11], s30 offen offset:2048 lds
 v_mfma_f32_16x16x32_bf16 v[84:87], a[56:59], v[164:167], v[84:87]
 v_mfma_f32_16x16x32_bf16 v[88:91], a[48:51], v[168:171], v[88:91]
 ds_read_b128 v[200:203], v19 offset:4096
 v_mfma_f32_16x16x32_bf16 v[92:95], a[52:55], v[168:171], v[92:95]
 s_add_u32 s21, s48, 0
 ds_read_b128 v[232:235], v23 offset:128
 v_mfma_f32_16x16x32_bf16 v[96:99], a[56:59], v[168:171], v[96:99]
 v_mfma_f32_16x16x32_bf16 v[100:103], a[48:51], v[172:175], v[100:103]
 ds_read_b128 v[204:207], v19 offset:6144
 v_mfma_f32_16x16x32_bf16 v[104:107], a[52:55], v[172:175], v[104:107]
 buffer_store_dwordx4 v[224:227], v26, s[16:19], s21 offen offset:0 sc1
 v_mfma_f32_16x16x32_bf16 v[108:111], a[56:59], v[172:175], v[108:111]
 s_waitcnt lgkmcnt(5)
 v_mfma_f32_16x16x32_bf16 v[112:115], a[48:51], v[176:179], v[112:115]
 ds_read_b128 v[208:211], v19 offset:8192
 v_mfma_f32_16x16x32_bf16 v[116:119], a[52:55], v[176:179], v[116:119]
 v_mfma_f32_16x16x32_bf16 v[120:123], a[56:59], v[176:179], v[120:123]
 v_mfma_f32_16x16x32_bf16 v[124:127], a[48:51], v[180:183], v[124:127]
 ds_read_b128 v[212:215], v19 offset:10240
 v_mfma_f32_16x16x32_bf16 v[128:131], a[52:55], v[180:183], v[128:131]
 buffer_load_dwordx4 v13, s[8:11], s30 offen offset:3072 lds
 v_mfma_f32_16x16x32_bf16 v[132:135], a[56:59], v[180:183], v[132:135]
 s_add_u32 s30, s30, 128
 s_add_u32 m0, m0, 16384
 v_mfma_f32_16x16x32_bf16 v[136:139], a[48:51], v[184:187], v[136:139]
 ds_read_b128 v[216:219], v19 offset:12288
 v_mfma_f32_16x16x32_bf16 v[140:143], a[52:55], v[184:187], v[140:143]
 s_cmp_lt_u32 m0, s46
 s_cselect_b32 m0, m0, s47
 v_mfma_f32_16x16x32_bf16 v[144:147], a[56:59], v[184:187], v[144:147]
 ds_read_b128 v[236:239], v23 offset:192
 v_mfma_f32_16x16x32_bf16 v[148:151], a[48:51], v[188:191], v[148:151]
 ds_read_b128 v[220:223], v19 offset:14336
 v_mfma_f32_16x16x32_bf16 v[152:155], a[52:55], v[188:191], v[152:155]
 buffer_store_dwordx4 v[228:231], v26, s[16:19], s21 offen offset:1024 sc1
 v_mfma_f32_16x16x32_bf16 v[156:159], a[56:59], v[188:191], v[156:159]
 s_waitcnt vmcnt(14) lgkmcnt(5)
 s_barrier
 v_mfma_f32_16x16x32_bf16 v[64:67], a[60:63], v[192:195], v[64:67]
 ds_read_b128 v[160:163], v18 offset:0
 v_mfma_f32_16x16x32_bf16 v[68:71], a[64:67], v[192:195], v[68:71]
 v_mfma_f32_16x16x32_bf16 v[72:75], a[68:71], v[192:195], v[72:75]
 v_add_u32 v19, s33, v15
 s_add_u32 s33, s33, 16384
 v_mfma_f32_16x16x32_bf16 v[76:79], a[60:63], v[196:199], v[76:79]
 ds_read_b128 v[164:167], v18 offset:2048
 v_mfma_f32_16x16x32_bf16 v[80:83], a[64:67], v[196:199], v[80:83]
 buffer_load_dwordx4 v10, s[8:11], s30 offen offset:0 lds
 v_mfma_f32_16x16x32_bf16 v[84:87], a[68:71], v[196:199], v[84:87]
 s_cmp_lt_u32 s33, 98304
 s_cselect_b32 s33, s33, 0
 v_mfma_f32_16x16x32_bf16 v[88:91], a[60:63], v[200:203], v[88:91]
 ds_read_b128 v[168:171], v18 offset:4096
 v_mfma_f32_16x16x32_bf16 v[92:95], a[64:67], v[200:203], v[92:95]
 ds_read_b128 v[240:243], v23 offset:256
 v_mfma_f32_16x16x32_bf16 v[96:99], a[68:71], v[200:203], v[96:99]
 v_mfma_f32_16x16x32_bf16 v[100:103], a[60:63], v[204:207], v[100:103]
 ds_read_b128 v[172:175], v18 offset:6144
 v_mfma_f32_16x16x32_bf16 v[104:107], a[64:67], v[204:207], v[104:107]
 buffer_store_dwordx4 v[232:235], v26, s[16:19], s21 offen offset:2048 sc1
 v_mfma_f32_16x16x32_bf16 v[108:111], a[68:71], v[204:207], v[108:111]
 s_waitcnt lgkmcnt(5)
 v_mfma_f32_16x16x32_bf16 v[112:115], a[60:63], v[208:211], v[112:115]
 ds_read_b128 v[176:179], v18 offset:8192
 v_mfma_f32_16x16x32_bf16 v[116:119], a[64:67], v[208:211], v[116:119]
 v_mfma_f32_16x16x32_bf16 v[120:123], a[68:71], v[208:211], v[120:123]
 v_mfma_f32_16x16x32_bf16 v[124:127], a[60:63], v[212:215], v[124:127]
 ds_read_b128 v[180:183], v18 offset:10240
 v_mfma_f32_16x16x32_bf16 v[128:131], a[64:67], v[212:215], v[128:131]
 buffer_load_dwordx4 v11, s[8:11], s30 offen offset:1024 lds
 v_mfma_f32_16x16x32_bf16 v[132:135], a[68:71], v[212:215], v[132:135]
 v_mfma_f32_16x16x32_bf16 v[136:139], a[60:63], v[216:219], v[136:139]
 ds_read_b128 v[184:187], v18 offset:12288
 v_mfma_f32_16x16x32_bf16 v[140:143], a[64:67], v[216:219], v[140:143]
 ds_read_b128 v[244:247], v23 offset:320
 v_mfma_f32_16x16x32_bf16 v[144:147], a[68:71], v[216:219], v[144:147]
 v_mfma_f32_16x16x32_bf16 v[148:151], a[60:63], v[220:223], v[148:151]
 ds_read_b128 v[188:191], v18 offset:14336
 v_mfma_f32_16x16x32_bf16 v[152:155], a[64:67], v[220:223], v[152:155]
 buffer_store_dwordx4 v[236:239], v26, s[16:19], s21 offen offset:3072 sc1
 v_mfma_f32_16x16x32_bf16 v[156:159], a[68:71], v[220:223], v[156:159]
 s_waitcnt lgkmcnt(5)
 v_mfma_f32_16x16x32_bf16 v[64:67], a[72:75], v[160:163], v[64:67]
 ds_read_b128 v[192:195], v19 offset:0
 v_mfma_f32_16x16x32_bf16 v[68:71], a[76:79], v[160:163], v[68:71]
 v_add_u32 v18, s33, v14
 v_mfma_f32_16x16x32_bf16 v[72:75], a[80:83], v[160:163], v[72:75]
 v_mfma_f32_16x16x32_bf16 v[76:79], a[72:75], v[164:167], v[76:79]
 ds_read_b128 v[196:199], v19 offset:2048
 v_mfma_f32_16x16x32_bf16 v[80:83], a[76:79], v[164:167], v[80:83]
 buffer_load_dwordx4 v12, s[8:11], s30 offen offset:2048 lds
 v_mfma_f32_16x16x32_bf16 v[84:87], a[80:83], v[164:167], v[84:87]
 v_mfma_f32_16x16x32_bf16 v[88:91], a[72:75], v[168:171], v[88:91]
 ds_read_b128 v[200:203], v19 offset:4096
 v_mfma_f32_16x16x32_bf16 v[92:95], a[76:79], v[168:171], v[92:95]
 s_add_u32 s21, s48, 4096
 ds_read_b128 v[224:227], v23 offset:6400
 v_mfma_f32_16x16x32_bf16 v[96:99], a[80:83], v[168:171], v[96:99]
 v_mfma_f32_16x16x32_bf16 v[100:103], a[72:75], v[172:175], v[100:103]
 ds_read_b128 v[204:207], v19 offset:6144
 v_mfma_f32_16x16x32_bf16 v[104:107], a[76:79], v[172:175], v[104:107]
 buffer_store_dwordx4 v[240:243], v26, s[16:19], s21 offen offset:0 sc1
 v_mfma_f32_16x16x32_bf16 v[108:111], a[80:83], v[172:175], v[108:111]
 s_waitcnt lgkmcnt(5)
 v_mfma_f32_16x16x32_bf16 v[112:115], a[72:75], v[176:179], v[112:115]
 ds_read_b128 v[208:211], v19 offset:8192
 v_mfma_f32_16x16x32_bf16 v[116:119], a[76:79], v[176:179], v[116:119]
 v_mfma_f32_16x16x32_bf16 v[120:123], a[80:83], v[176:179], v[120:123]
 v_mfma_f32_16x16x32_bf16 v[124:127], a[72:75], v[180:183], v[124:127]
 ds_read_b128 v[212:215], v19 offset:10240
 v_mfma_f32_16x16x32_bf16 v[128:131], a[76:79], v[180:183], v[128:131]
 buffer_load_dwordx4 v13, s[8:11], s30 offen offset:3072 lds
 v_mfma_f32_16x16x32_bf16 v[132:135], a[80:83], v[180:183], v[132:135]
 s_add_u32 s30, s30, 128
 s_add_u32 m0, m0, 16384
 v_mfma_f32_16x16x32_bf16 v[136:139], a[72:75], v[184:187], v[136:139]
 ds_read_b128 v[216:219], v19 offset:12288
 v_mfma_f32_16x16x32_bf16 v[140:143], a[76:79], v[184:187], v[140:143]
 s_cmp_lt_u32 m0, s46
 s_cselect_b32 m0, m0, s47
 v_mfma_f32_16x16x32_bf16 v[144:147], a[80:83], v[184:187], v[144:147]
 ds_read_b128 v[228:231], v23 offset:6464
 v_mfma_f32_16x16x32_bf16 v[148:151], a[72:75], v[188:191], v[148:151]
 ds_read_b128 v[220:223], v19 offset:14336
 v_mfma_f32_16x16x32_bf16 v[152:155], a[76:79], v[188:191], v[152:155]
 buffer_store_dwordx4 v[244:247], v26, s[16:19], s21 offen offset:1024 sc1
 v_mfma_f32_16x16x32_bf16 v[156:159], a[80:83], v[188:191], v[156:159]
 s_waitcnt vmcnt(18) lgkmcnt(5)
 s_barrier
 v_mfma_f32_16x16x32_bf16 v[64:67], a[84:87], v[192:195], v[64:67]
 ds_read_b128 v[160:163], v18 offset:0
 v_mfma_f32_16x16x32_bf16 v[68:71], a[88:91], v[192:195], v[68:71]
 v_mfma_f32_16x16x32_bf16 v[72:75], a[92:95], v[192:195], v[72:75]
 v_add_u32 v19, s33, v15
 s_add_u32 s33, s33, 16384
 v_mfma_f32_16x16x32_bf16 v[76:79], a[84:87], v[196:199], v[76:79]
 ds_read_b128 v[164:167], v18 offset:2048
 v_mfma_f32_16x16x32_bf16 v[80:83], a[88:91], v[196:199], v[80:83]
 buffer_load_dwordx4 v10, s[8:11], s30 offen offset:0 lds
 v_mfma_f32_16x16x32_bf16 v[84:87], a[92:95], v[196:199], v[84:87]
 s_cmp_lt_u32 s33, 98304
 s_cselect_b32 s33, s33, 0
 v_mfma_f32_16x16x32_bf16 v[88:91], a[84:87], v[200:203], v[88:91]
 ds_read_b128 v[168:171], v18 offset:4096
 v_mfma_f32_16x16x32_bf16 v[92:95], a[88:91], v[200:203], v[92:95]
 ds_read_b128 v[232:235], v23 offset:6528
 v_mfma_f32_16x16x32_bf16 v[96:99], a[92:95], v[200:203], v[96:99]
 v_mfma_f32_16x16x32_bf16 v[100:103], a[84:87], v[204:207], v[100:103]
 ds_read_b128 v[172:175], v18 offset:6144
 v_mfma_f32_16x16x32_bf16 v[104:107], a[88:91], v[204:207], v[104:107]
 buffer_store_dwordx4 v[224:227], v26, s[16:19], s21 offen offset:2048 sc1
 v_mfma_f32_16x16x32_bf16 v[108:111], a[92:95], v[204:207], v[108:111]
 s_waitcnt lgkmcnt(5)
 v_mfma_f32_16x16x32_bf16 v[112:115], a[84:87], v[208:211], v[112:115]
 ds_read_b128 v[176:179], v18 offset:8192
 v_mfma_f32_16x16x32_bf16 v[116:119], a[88:91], v[208:211], v[116:119]
 v_mfma_f32_16x16x32_bf16 v[120:123], a[92:95], v[208:211], v[120:123]
 v_mfma_f32_16x16x32_bf16 v[124:127], a[84:87], v[212:215], v[124:127]
 ds_read_b128 v[180:183], v18 offset:10240
 v_mfma_f32_16x16x32_bf16 v[128:131], a[88:91], v[212:215], v[128:131]
 buffer_load_dwordx4 v11, s[8:11], s30 offen offset:1024 lds
 v_mfma_f32_16x16x32_bf16 v[132:135], a[92:95], v[212:215], v[132:135]
 v_mfma_f32_16x16x32_bf16 v[136:139], a[84:87], v[216:219], v[136:139]
 ds_read_b128 v[184:187], v18 offset:12288
 v_mfma_f32_16x16x32_bf16 v[140:143], a[88:91], v[216:219], v[140:143]
 ds_read_b128 v[236:239], v23 offset:6592
 v_mfma_f32_16x16x32_bf16 v[144:147], a[92:95], v[216:219], v[144:147]
 v_mfma_f32_16x16x32_bf16 v[148:151], a[84:87], v[220:223], v[148:151]
 ds_read_b128 v[188:191], v18 offset:14336
 v_mfma_f32_16x16x32_bf16 v[152:155], a[88:91], v[220:223], v[152:155]
 buffer_store_dwordx4 v[228:231], v26, s[16:19], s21 offen offset:3072 sc1
 v_mfma_f32_16x16x32_bf16 v[156:159], a[92:95], v[220:223], v[156:159]
 s_waitcnt lgkmcnt(5)
 v_mfma_f32_16x16x32_bf16 v[64:67], a[96:99], v[160:163], v[64:67]
 ds_read_b128 v[192:195], v19 offset:0
 v_mfma_f32_16x16x32_bf16 v[68:71], a[100:103], v[160:163], v[68:71]
 v_add_u32 v18, s33, v14
 v_mfma_f32_16x16x32_bf16 v[72:75], a[104:107], v[160:163], v[72:75]
 v_mfma_f32_16x16x32_bf16 v[76:79], a[96:99], v[164:167], v[76:79]
 ds_read_b128 v[196:199], v19 offset:2048
 v_mfma_f32_16x16x32_bf16 v[80:83], a[100:103], v[164:167], v[80:83]
 buffer_load_dwordx4 v12, s[8:11], s30 offen offset:2048 lds
 v_mfma_f32_16x16x32_bf16 v[84:87], a[104:107], v[164:167], v[84:87]
 v_mfma_f32_16x16x32_bf16 v[88:91], a[96:99], v[168:171], v[88:91]
 ds_read_b128 v[200:203], v19 offset:4096
 v_mfma_f32_16x16x32_bf16 v[92:95], a[100:103], v[168:171], v[92:95]
 s_add_u32 s21, s48, 8192
 ds_read_b128 v[240:243], v23 offset:6656
 v_mfma_f32_16x16x32_bf16 v[96:99], a[104:107], v[168:171], v[96:99]
 v_mfma_f32_16x16x32_bf16 v[100:103], a[96:99], v[172:175], v[100:103]
 ds_read_b128 v[204:207], v19 offset:6144
 v_mfma_f32_16x16x32_bf16 v[104:107], a[100:103], v[172:175], v[104:107]
 buffer_store_dwordx4 v[232:235], v26, s[16:19], s21 offen offset:0 sc1
 v_mfma_f32_16x16x32_bf16 v[108:111], a[104:107], v[172:175], v[108:111]
 s_waitcnt lgkmcnt(5)
 v_mfma_f32_16x16x32_bf16 v[112:115], a[96:99], v[176:179], v[112:115]
 ds_read_b128 v[208:211], v19 offset:8192
 v_mfma_f32_16x16x32_bf16 v[116:119], a[100:103], v[176:179], v[116:119]
 v_mfma_f32_16x16x32_bf16 v[120:123], a[104:107], v[176:179], v[120:123]
 v_mfma_f32_16x16x32_bf16 v[124:127], a[96:99], v[180:183], v[124:127]
 ds_read_b128 v[212:215], v19 offset:10240
 v_mfma_f32_16x16x32_bf16 v[128:131], a[100:103], v[180:183], v[128:131]
 buffer_load_dwordx4 v13, s[8:11], s30 offen offset:3072 lds
 v_mfma_f32_16x16x32_bf16 v[132:135], a[104:107], v[180:183], v[132:135]
 s_add_u32 s30, s30, 128
 s_add_u32 m0, m0, 16384
 v_mfma_f32_16x16x32_bf16 v[136:139], a[96:99], v[184:187], v[136:139]
 ds_read_b128 v[216:219], v19 offset:12288
 v_mfma_f32_16x16x32_bf16 v[140:143], a[100:103], v[184:187], v[140:143]
 s_cmp_lt_u32 m0, s46
 s_cselect_b32 m0, m0, s47
 v_mfma_f32_16x16x32_bf16 v[144:147], a[104:107], v[184:187], v[144:147]
 ds_read_b128 v[244:247], v23 offset:6720
 v_mfma_f32_16x16x32_bf16 v[148:151], a[96:99], v[188:191], v[148:151]
 ds_read_b128 v[220:223], v19 offset:14336
 v_mfma_f32_16x16x32_bf16 v[152:155], a[100:103], v[188:191], v[152:155]
 buffer_store_dwordx4 v[236:239], v26, s[16:19], s21 offen offset:1024 sc1
 v_mfma_f32_16x16x32_bf16 v[156:159], a[104:107], v[188:191], v[156:159]
 s_waitcnt vmcnt(22) lgkmcnt(5)
 s_barrier
 v_mfma_f32_16x16x32_bf16 v[64:67], a[108:111], v[192:195], v[64:67]
 ds_read_b128 v[160:163], v18 offset:0
 v_mfma_f32_16x16x32_bf16 v[68:71], a[112:115], v[192:195], v[68:71]
 v_mfma_f32_16x16x32_bf16 v[72:75], a[116:119], v[192:195], v[72:75]
 v_add_u32 v19, s33, v15
 s_add_u32 s33, s33, 16384
 v_mfma_f32_16x16x32_bf16 v[76:79], a[108:111], v[196:199], v[76:79]
 ds_read_b128 v[164:167], v18 offset:2048
 v_mfma_f32_16x16x32_bf16 v[80:83], a[112:115], v[196:199], v[80:83]
 buffer_load_dwordx4 v10, s[8:11], s30 offen offset:0 lds
 v_mfma_f32_16x16x32_bf16 v[84:87], a[116:119], v[196:199], v[84:87]
 s_cmp_lt_u32 s33, 98304
 s_cselect_b32 s33, s33, 0
 v_mfma_f32_16x16x32_bf16 v[88:91], a[108:111], v[200:203], v[88:91]
 ds_read_b128 v[168:171], v18 offset:4096
 v_mfma_f32_16x16x32_bf16 v[92:95], a[112:115], v[200:203], v[92:95]
 v_mfma_f32_16x16x32_bf16 v[96:99], a[116:119], v[200:203], v[96:99]
 v_mfma_f32_16x16x32_bf16 v[100:103], a[108:111], v[204:207], v[100:103]
 ds_read_b128 v[172:175], v18 offset:6144
 v_mfma_f32_16x16x32_bf16 v[104:107], a[112:115], v[204:207], v[104:107]
 buffer_store_dwordx4 v[240:243], v26, s[16:19], s21 offen offset:2048 sc1
 v_mfma_f32_16x16x32_bf16 v[108:111], a[116:119], v[204:207], v[108:111]
 s_waitcnt lgkmcnt(4)
 v_mfma_f32_16x16x32_bf16 v[112:115], a[108:111], v[208:211], v[112:115]
 ds_read_b128 v[176:179], v18 offset:8192
 v_mfma_f32_16x16x32_bf16 v[116:119], a[112:115], v[208:211], v[116:119]
 v_mfma_f32_16x16x32_bf16 v[120:123], a[116:119], v[208:211], v[120:123]
 v_mfma_f32_16x16x32_bf16 v[124:127], a[108:111], v[212:215], v[124:127]
 ds_read_b128 v[180:183], v18 offset:10240
 v_mfma_f32_16x16x32_bf16 v[128:131], a[112:115], v[212:215], v[128:131]
 buffer_load_dwordx4 v11, s[8:11], s30 offen offset:1024 lds
 v_mfma_f32_16x16x32_bf16 v[132:135], a[116:119], v[212:215], v[132:135]
 v_mfma_f32_16x16x32_bf16 v[136:139], a[108:111], v[216:219], v[136:139]
 ds_read_b128 v[184:187], v18 offset:12288
 v_mfma_f32_16x16x32_bf16 v[140:143], a[112:115], v[216:219], v[140:143]
 v_mfma_f32_16x16x32_bf16 v[144:147], a[116:119], v[216:219], v[144:147]
 v_mfma_f32_16x16x32_bf16 v[148:151], a[108:111], v[220:223], v[148:151]
 ds_read_b128 v[188:191], v18 offset:14336
 v_mfma_f32_16x16x32_bf16 v[152:155], a[112:115], v[220:223], v[152:155]
 buffer_store_dwordx4 v[244:247], v26, s[16:19], s21 offen offset:3072 sc1
 v_mfma_f32_16x16x32_bf16 v[156:159], a[116:119], v[220:223], v[156:159]
 s_waitcnt lgkmcnt(4)
 v_mfma_f32_16x16x32_bf16 v[64:67], a[120:123], v[160:163], v[64:67]
 ds_read_b128 v[192:195], v19 offset:0
 v_mfma_f32_16x16x32_bf16 v[68:71], a[124:127], v[160:163], v[68:71]
 v_add_u32 v18, s33, v14
 v_mfma_f32_16x16x32_bf16 v[72:75], a[128:131], v[160:163], v[72:75]
 v_mfma_f32_16x16x32_bf16 v[76:79], a[120:123], v[164:167], v[76:79]
 ds_read_b128 v[196:199], v19 offset:2048
 v_mfma_f32_16x16x32_bf16 v[80:83], a[124:127], v[164:167], v[80:83]
 buffer_load_dwordx4 v12, s[8:11], s30 offen offset:2048 lds
 v_mfma_f32_16x16x32_bf16 v[84:87], a[128:131], v[164:167], v[84:87]
 v_mfma_f32_16x16x32_bf16 v[88:91], a[120:123], v[168:171], v[88:91]
 ds_read_b128 v[200:203], v19 offset:4096
 v_mfma_f32_16x16x32_bf16 v[92:95], a[124:127], v[168:171], v[92:95]
 v_mfma_f32_16x16x32_bf16 v[96:99], a[128:131], v[168:171], v[96:99]
 v_mfma_f32_16x16x32_bf16 v[100:103], a[120:123], v[172:175], v[100:103]
 ds_read_b128 v[204:207], v19 offset:6144
 v_mfma_f32_16x16x32_bf16 v[104:107], a[124:127], v[172:175], v[104:107]
 v_mfma_f32_16x16x32_bf16 v[108:111], a[128:131], v[172:175], v[108:111]
 s_waitcnt lgkmcnt(4)
 v_mfma_f32_16x16x32_bf16 v[112:115], a[120:123], v[176:179], v[112:115]
 ds_read_b128 v[208:211], v19 offset:8192
 v_mfma_f32_16x16x32_bf16 v[116:119], a[124:127], v[176:179], v[116:119]
 v_mfma_f32_16x16x32_bf16 v[120:123], a[128:131], v[176:179], v[120:123]
 v_mfma_f32_16x16x32_bf16 v[124:127], a[120:123], v[180:183], v[124:127]
 ds_read_b128 v[212:215], v19 offset:10240
 v_mfma_f32_16x16x32_bf16 v[128:131], a[124:127], v[180:183], v[128:131]
 buffer_load_dwordx4 v13, s[8:11], s30 offen offset:3072 lds
 v_mfma_f32_16x16x32_bf16 v[132:135], a[128:131], v[180:183], v[132:135]
 s_add_u32 s30, s30, s25
 s_sub_u32 s30, s30, 1152
 v_mfma_f32_16x16x32_bf16 v[136:139], a[120:123], v[184:187], v[136:139]
 ds_read_b128 v[216:219], v19 offset:12288
 s_add_u32 m0, m0, 16384
 v_mfma_f32_16x16x32_bf16 v[140:143], a[124:127], v[184:187], v[140:143]
 s_cmp_lt_u32 m0, s46
 s_cselect_b32 m0, m0, s47
 v_mfma_f32_16x16x32_bf16 v[144:147], a[128:131], v[184:187], v[144:147]
 v_mfma_f32_16x16x32_bf16 v[148:151], a[120:123], v[188:191], v[148:151]
 ds_read_b128 v[220:223], v19 offset:14336
 v_mfma_f32_16x16x32_bf16 v[152:155], a[124:127], v[188:191], v[152:155]
 v_mfma_f32_16x16x32_bf16 v[156:159], a[128:131], v[188:191], v[156:159]
 s_waitcnt vmcnt(23) lgkmcnt(4)
 s_barrier
 v_mfma_f32_16x16x32_bf16 v[64:67], a[132:135], v[192:195], v[64:67]
 ds_read_b128 v[160:163], v18 offset:0
 v_mfma_f32_16x16x32_bf16 v[68:71], a[136:139], v[192:195], v[68:71]
 v_mfma_f32_16x16x32_bf16 v[72:75], a[140:143], v[192:195], v[72:75]
 v_add_u32 v19, s33, v15
 s_add_u32 s33, s33, 16384
 v_mfma_f32_16x16x32_bf16 v[76:79], a[132:135], v[196:199], v[76:79]
 ds_read_b128 v[164:167], v18 offset:2048
 v_mfma_f32_16x16x32_bf16 v[80:83], a[136:139], v[196:199], v[80:83]
 buffer_load_dwordx4 v10, s[8:11], s30 offen offset:0 lds
 v_mfma_f32_16x16x32_bf16 v[84:87], a[140:143], v[196:199], v[84:87]
 s_cmp_lt_u32 s33, 98304
 s_cselect_b32 s33, s33, 0
 v_mfma_f32_16x16x32_bf16 v[88:91], a[132:135], v[200:203], v[88:91]
 ds_read_b128 v[168:171], v18 offset:4096
 v_mfma_f32_16x16x32_bf16 v[92:95], a[136:139], v[200:203], v[92:95]
 v_mfma_f32_16x16x32_bf16 v[96:99], a[140:143], v[200:203], v[96:99]
 v_mfma_f32_16x16x32_bf16 v[100:103], a[132:135], v[204:207], v[100:103]
 ds_read_b128 v[172:175], v18 offset:6144
 v_mfma_f32_16x16x32_bf16 v[104:107], a[136:139], v[204:207], v[104:107]
 v_mfma_f32_16x16x32_bf16 v[108:111], a[140:143], v[204:207], v[108:111]
 s_waitcnt lgkmcnt(4)
 v_mfma_f32_16x16x32_bf16 v[112:115], a[132:135], v[208:211], v[112:115]
 ds_read_b128 v[176:179], v18 offset:8192
 v_mfma_f32_16x16x32_bf16 v[116:119], a[136:139], v[208:211], v[116:119]
 v_mfma_f32_16x16x32_bf16 v[120:123], a[140:143], v[208:211], v[120:123]
 v_mfma_f32_16x16x32_bf16 v[124:127], a[132:135], v[212:215], v[124:127]
 ds_read_b128 v[180:183], v18 offset:10240
 v_mfma_f32_16x16x32_bf16 v[128:131], a[136:139], v[212:215], v[128:131]
 buffer_load_dwordx4 v11, s[8:11], s30 offen offset:1024 lds
 v_mfma_f32_16x16x32_bf16 v[132:135], a[140:143], v[212:215], v[132:135]
 v_mfma_f32_16x16x32_bf16 v[136:139], a[132:135], v[216:219], v[136:139]
 ds_read_b128 v[184:187], v18 offset:12288
 v_mfma_f32_16x16x32_bf16 v[140:143], a[136:139], v[216:219], v[140:143]
 v_mfma_f32_16x16x32_bf16 v[144:147], a[140:143], v[216:219], v[144:147]
 v_mfma_f32_16x16x32_bf16 v[148:151], a[132:135], v[220:223], v[148:151]
 ds_read_b128 v[188:191], v18 offset:14336
 v_mfma_f32_16x16x32_bf16 v[152:155], a[136:139], v[220:223], v[152:155]
 v_mfma_f32_16x16x32_bf16 v[156:159], a[140:143], v[220:223], v[156:159]
 s_waitcnt lgkmcnt(4)
 v_mfma_f32_16x16x32_bf16 v[64:67], a[144:147], v[160:163], v[64:67]
 ds_read_b128 v[192:195], v19 offset:0
 v_mfma_f32_16x16x32_bf16 v[68:71], a[148:151], v[160:163], v[68:71]
 v_add_u32 v18, s33, v14
 v_mfma_f32_16x16x32_bf16 v[72:75], a[152:155], v[160:163], v[72:75]
 v_mfma_f32_16x16x32_bf16 v[76:79], a[144:147], v[164:167], v[76:79]
 ds_read_b128 v[196:199], v19 offset:2048
 v_mfma_f32_16x16x32_bf16 v[80:83], a[148:151], v[164:167], v[80:83]
 buffer_load_dwordx4 v12, s[8:11], s30 offen offset:2048 lds
 v_mfma_f32_16x16x32_bf16 v[84:87], a[152:155], v[164:167], v[84:87]
 v_mfma_f32_16x16x32_bf16 v[88:91], a[144:147], v[168:171], v[88:91]
 ds_read_b128 v[200:203], v19 offset:4096
 v_mfma_f32_16x16x32_bf16 v[92:95], a[148:151], v[168:171], v[92:95]
 v_mfma_f32_16x16x32_bf16 v[96:99], a[152:155], v[168:171], v[96:99]
 v_mfma_f32_16x16x32_bf16 v[100:103], a[144:147], v[172:175], v[100:103]
 ds_read_b128 v[204:207], v19 offset:6144
 v_mfma_f32_16x16x32_bf16 v[104:107], a[148:151], v[172:175], v[104:107]
 v_mfma_f32_16x16x32_bf16 v[108:111], a[152:155], v[172:175], v[108:111]
 s_waitcnt lgkmcnt(4)
 v_mfma_f32_16x16x32_bf16 v[112:115], a[144:147], v[176:179], v[112:115]
 ds_read_b128 v[208:211], v19 offset:8192
 v_mfma_f32_16x16x32_bf16 v[116:119], a[148:151], v[176:179], v[116:119]
 v_mfma_f32_16x16x32_bf16 v[120:123], a[152:155], v[176:179], v[120:123]
 v_mfma_f32_16x16x32_bf16 v[124:127], a[144:147], v[180:183], v[124:127]
 ds_read_b128 v[212:215], v19 offset:10240
 v_mfma_f32_16x16x32_bf16 v[128:131], a[148:151], v[180:183], v[128:131]
 buffer_load_dwordx4 v13, s[8:11], s30 offen offset:3072 lds
 v_mfma_f32_16x16x32_bf16 v[132:135], a[152:155], v[180:183], v[132:135]
 s_add_u32 s30, s30, 128
 s_add_u32 m0, m0, 16384
 v_mfma_f32_16x16x32_bf16 v[136:139], a[144:147], v[184:187], v[136:139]
 ds_read_b128 v[216:219], v19 offset:12288
 v_mfma_f32_16x16x32_bf16 v[140:143], a[148:151], v[184:187], v[140:143]
 s_cmp_lt_u32 m0, s46
 s_cselect_b32 m0, m0, s47
 v_mfma_f32_16x16x32_bf16 v[144:147], a[152:155], v[184:187], v[144:147]
 v_mfma_f32_16x16x32_bf16 v[148:151], a[144:147], v[188:191], v[148:151]
 ds_read_b128 v[220:223], v19 offset:14336
 v_mfma_f32_16x16x32_bf16 v[152:155], a[148:151], v[188:191], v[152:155]
 v_mfma_f32_16x16x32_bf16 v[156:159], a[152:155], v[188:191], v[156:159]
 s_waitcnt vmcnt(6) lgkmcnt(4)
 s_barrier
 v_mfma_f32_16x16x32_bf16 v[64:67], a[156:159], v[192:195], v[64:67]
 ds_read_b128 v[160:163], v18 offset:0
 v_mfma_f32_16x16x32_bf16 v[68:71], a[160:163], v[192:195], v[68:71]
 s_cmp_eq_u32 s48, 0x80000000
 s_cbranch_scc1 kv_134
 s_cmp_lg_u32 s20, 0
 s_cbranch_scc1 af_135
 v_mov_b32 v4, 0
 v_mov_b32 v5, 1
 s_mov_b64 exec, 1
 buffer_atomic_add v5, v4, s[72:75], s61 offen sc1
 s_mov_b64 exec, -1
 s_nop 1
af_135:
kv_134:
 v_mfma_f32_16x16x32_bf16 v[72:75], a[164:167], v[192:195], v[72:75]
 v_add_u32 v19, s33, v15
 s_add_u32 s33, s33, 16384
 v_mfma_f32_16x16x32_bf16 v[76:79], a[156:159], v[196:199], v[76:79]
 ds_read_b128 v[164:167], v18 offset:2048
 v_mfma_f32_16x16x32_bf16 v[80:83], a[160:163], v[196:199], v[80:83]
 buffer_load_dwordx4 v10, s[8:11], s30 offen offset:0 lds
 v_mfma_f32_16x16x32_bf16 v[84:87], a[164:167], v[196:199], v[84:87]
 s_cmp_lt_u32 s33, 98304
 s_cselect_b32 s33, s33, 0
 v_mfma_f32_16x16x32_bf16 v[88:91], a[156:159], v[200:203], v[88:91]
 ds_read_b128 v[168:171], v18 offset:4096
 v_mfma_f32_16x16x32_bf16 v[92:95], a[160:163], v[200:203], v[92:95]
 v_mfma_f32_16x16x32_bf16 v[96:99], a[164:167], v[200:203], v[96:99]
 v_mfma_f32_16x16x32_bf16 v[100:103], a[156:159], v[204:207], v[100:103]
 ds_read_b128 v[172:175], v18 offset:6144
 v_mfma_f32_16x16x32_bf16 v[104:107], a[160:163], v[204:207], v[104:107]
 v_mfma_f32_16x16x32_bf16 v[108:111], a[164:167], v[204:207], v[108:111]
 s_waitcnt lgkmcnt(4)
 v_mfma_f32_16x16x32_bf16 v[112:115], a[156:159], v[208:211], v[112:115]
 ds_read_b128 v[176:179], v18 offset:8192
 v_mfma_f32_16x16x32_bf16 v[116:119], a[160:163], v[208:211], v[116:119]
 v_mfma_f32_16x16x32_bf16 v[120:123], a[164:167], v[208:211], v[120:123]
 v_mfma_f32_16x16x32_bf16 v[124:127], a[156:159], v[212:215], v[124:127]
 ds_read_b128 v[180:183], v18 offset:10240
 v_mfma_f32_16x16x32_bf16 v[128:131], a[160:163], v[212:215], v[128:131]
 buffer_load_dwordx4 v11, s[8:11], s30 offen offset:1024 lds
 v_mfma_f32_16x16x32_bf16 v[132:135], a[164:167], v[212:215], v[132:135]
 v_mfma_f32_16x16x32_bf16 v[136:139], a[156:159], v[216:219], v[136:139]
 ds_read_b128 v[184:187], v18 offset:12288
 v_mfma_f32_16x16x32_bf16 v[140:143], a[160:163], v[216:219], v[140:143]
 v_mfma_f32_16x16x32_bf16 v[144:147], a[164:167], v[216:219], v[144:147]
 v_mfma_f32_16x16x32_bf16 v[148:151], a[156:159], v[220:223], v[148:151]
 ds_read_b128 v[188:191], v18 offset:14336
 v_mfma_f32_16x16x32_bf16 v[152:155], a[160:163], v[220:223], v[152:155]
 v_mfma_f32_16x16x32_bf16 v[156:159], a[164:167], v[220:223], v[156:159]
 s_waitcnt lgkmcnt(4)
 v_mfma_f32_16x16x32_bf16 v[64:67], a[168:171], v[160:163], v[64:67]
 ds_read_b128 v[192:195], v19 offset:0
 v_mfma_f32_16x16x32_bf16 v[68:71], a[172:175], v[160:163], v[68:71]
 v_add_u32 v18, s33, v14
 s_mov_b32 s61, s60
 v_mfma_f32_16x16x32_bf16 v[72:75], a[176:179], v[160:163], v[72:75]
 s_add_u32 s60, s60, s62
 s_mul_i32 s48, s20, 393216
 v_mfma_f32_16x16x32_bf16 v[76:79], a[168:171], v[164:167], v[76:79]
 ds_read_b128 v[196:199], v19 offset:2048
 s_add_u32 s48, s48, s27
 v_mfma_f32_16x16x32_bf16 v[80:83], a[172:175], v[164:167], v[80:83]
 buffer_load_dwordx4 v12, s[8:11], s30 offen offset:2048 lds
 v_mfma_f32_16x16x32_bf16 v[84:87], a[176:179], v[164:167], v[84:87]
 s_add_u32 s27, s27, s28
 s_sub_u32 s26, s26, 1
 v_mfma_f32_16x16x32_bf16 v[88:91], a[168:171], v[168:171], v[88:91]
 ds_read_b128 v[200:203], v19 offset:4096
 v_mfma_f32_16x16x32_bf16 v[92:95], a[172:175], v[168:171], v[92:95]
 v_mfma_f32_16x16x32_bf16 v[96:99], a[176:179], v[168:171], v[96:99]
 v_mfma_f32_16x16x32_bf16 v[100:103], a[168:171], v[172:175], v[100:103]
 ds_read_b128 v[204:207], v19 offset:6144
 v_mfma_f32_16x16x32_bf16 v[104:107], a[172:175], v[172:175], v[104:107]
 v_mfma_f32_16x16x32_bf16 v[108:111], a[176:179], v[172:175], v[108:111]
 s_waitcnt lgkmcnt(4)
 v_mfma_f32_16x16x32_bf16 v[112:115], a[168:171], v[176:179], v[112:115]
 ds_read_b128 v[208:211], v19 offset:8192
 v_mfma_f32_16x16x32_bf16 v[116:119], a[172:175], v[176:179], v[116:119]
 v_mfma_f32_16x16x32_bf16 v[120:123], a[176:179], v[176:179], v[120:123]
 v_mfma_f32_16x16x32_bf16 v[124:127], a[168:171], v[180:183], v[124:127]
 ds_read_b128 v[212:215], v19 offset:10240
 v_mfma_f32_16x16x32_bf16 v[128:131], a[172:175], v[180:183], v[128:131]
 buffer_load_dwordx4 v13, s[8:11], s30 offen offset:3072 lds
 v_mfma_f32_16x16x32_bf16 v[132:135], a[176:179], v[180:183], v[132:135]
 s_add_u32 s30, s30, 128
 s_add_u32 m0, m0, 16384
 v_mfma_f32_16x16x32_bf16 v[136:139], a[168:171], v[184:187], v[136:139]
 ds_read_b128 v[216:219], v19 offset:12288
 v_mfma_f32_16x16x32_bf16 v[140:143], a[172:175], v[184:187], v[140:143]
 s_cmp_lt_u32 m0, s46
 s_cselect_b32 m0, m0, s47
 v_mfma_f32_16x16x32_bf16 v[144:147], a[176:179], v[184:187], v[144:147]
 v_mfma_f32_16x16x32_bf16 v[148:151], a[168:171], v[188:191], v[148:151]
 ds_read_b128 v[220:223], v19 offset:14336
 v_mfma_f32_16x16x32_bf16 v[152:155], a[172:175], v[188:191], v[152:155]
 v_mfma_f32_16x16x32_bf16 v[156:159], a[176:179], v[188:191], v[156:159]
 s_waitcnt vmcnt(15) lgkmcnt(4)
 s_barrier
 v_mfma_f32_16x16x32_bf16 v[64:67], a[180:183], v[192:195], v[64:67]
 ds_read_b128 v[160:163], v18 offset:0
 v_mfma_f32_16x16x32_bf16 v[68:71], a[184:187], v[192:195], v[68:71]
 v_mfma_f32_16x16x32_bf16 v[72:75], a[188:191], v[192:195], v[72:75]
 v_add_u32 v19, s33, v15
 s_add_u32 s33, s33, 16384
 v_mfma_f32_16x16x32_bf16 v[76:79], a[180:183], v[196:199], v[76:79]
 ds_read_b128 v[164:167], v18 offset:2048
 v_mfma_f32_16x16x32_bf16 v[80:83], a[184:187], v[196:199], v[80:83]
 buffer_load_dwordx4 v10, s[8:11], s30 offen offset:0 lds
 v_mfma_f32_16x16x32_bf16 v[84:87], a[188:191], v[196:199], v[84:87]
 s_cmp_lt_u32 s33, 98304
 s_cselect_b32 s33, s33, 0
 v_mfma_f32_16x16x32_bf16 v[88:91], a[180:183], v[200:203], v[88:91]
 ds_read_b128 v[168:171], v18 offset:4096
 v_mfma_f32_16x16x32_bf16 v[92:95], a[184:187], v[200:203], v[92:95]
 v_mfma_f32_16x16x32_bf16 v[96:99], a[188:191], v[200:203], v[96:99]
 v_mfma_f32_16x16x32_bf16 v[100:103], a[180:183], v[204:207], v[100:103]
 ds_read_b128 v[172:175], v18 offset:6144
 v_mfma_f32_16x16x32_bf16 v[104:107], a[184:187], v[204:207], v[104:107]
 v_mfma_f32_16x16x32_bf16 v[108:111], a[188:191], v[204:207], v[108:111]
 s_waitcnt lgkmcnt(4)
 v_mfma_f32_16x16x32_bf16 v[112:115], a[180:183], v[208:211], v[112:115]
 ds_read_b128 v[176:179], v18 offset:8192
 v_mfma_f32_16x16x32_bf16 v[116:119], a[184:187], v[208:211], v[116:119]
 v_mfma_f32_16x16x32_bf16 v[120:123], a[188:191], v[208:211], v[120:123]
 v_mfma_f32_16x16x32_bf16 v[124:127], a[180:183], v[212:215], v[124:127]
 ds_read_b128 v[180:183], v18 offset:10240
 v_mfma_f32_16x16x32_bf16 v[128:131], a[184:187], v[212:215], v[128:131]
 buffer_load_dwordx4 v11, s[8:11], s30 offen offset:1024 lds
 v_mfma_f32_16x16x32_bf16 v[132:135], a[188:191], v[212:215], v[132:135]
 v_mfma_f32_16x16x32_bf16 v[136:139], a[180:183], v[216:219], v[136:139]
 ds_read_b128 v[184:187], v18 offset:12288
 v_mfma_f32_16x16x32_bf16 v[140:143], a[184:187], v[216:219], v[140:143]
 v_mfma_f32_16x16x32_bf16 v[144:147], a[188:191], v[216:219], v[144:147]
 v_mfma_f32_16x16x32_bf16 v[148:151], a[180:183], v[220:223], v[148:151]
 ds_read_b128 v[188:191], v18 offset:14336
 v_mfma_f32_16x16x32_bf16 v[152:155], a[184:187], v[220:223], v[152:155]
 v_mfma_f32_16x16x32_bf16 v[156:159], a[188:191], v[220:223], v[156:159]
 s_waitcnt lgkmcnt(4)
 v_mfma_f32_16x16x32_bf16 v[64:67], a[192:195], v[160:163], v[64:67]
 ds_read_b128 v[192:195], v19 offset:0
 v_mfma_f32_16x16x32_bf16 v[68:71], a[196:199], v[160:163], v[68:71]
 v_add_u32 v18, s33, v14
 v_mfma_f32_16x16x32_bf16 v[72:75], a[200:203], v[160:163], v[72:75]
 v_mfma_f32_16x16x32_bf16 v[76:79], a[192:195], v[164:167], v[76:79]
 ds_read_b128 v[196:199], v19 offset:2048
 v_mfma_f32_16x16x32_bf16 v[80:83], a[196:199], v[164:167], v[80:83]
 buffer_load_dwordx4 v12, s[8:11], s30 offen offset:2048 lds
 v_mfma_f32_16x16x32_bf16 v[84:87], a[200:203], v[164:167], v[84:87]
 v_mfma_f32_16x16x32_bf16 v[88:91], a[192:195], v[168:171], v[88:91]
 ds_read_b128 v[200:203], v19 offset:4096
 v_mfma_f32_16x16x32_bf16 v[92:95], a[196:199], v[168:171], v[92:95]
 v_mfma_f32_16x16x32_bf16 v[96:99], a[200:203], v[168:171], v[96:99]
 v_mfma_f32_16x16x32_bf16 v[100:103], a[192:195], v[172:175], v[100:103]
 ds_read_b128 v[204:207], v19 offset:6144
 v_mfma_f32_16x16x32_bf16 v[104:107], a[196:199], v[172:175], v[104:107]
 v_mfma_f32_16x16x32_bf16 v[108:111], a[200:203], v[172:175], v[108:111]
 s_waitcnt lgkmcnt(4)
 v_mfma_f32_16x16x32_bf16 v[112:115], a[192:195], v[176:179], v[112:115]
 ds_read_b128 v[208:211], v19 offset:8192
 v_mfma_f32_16x16x32_bf16 v[116:119], a[196:199], v[176:179], v[116:119]
 v_mfma_f32_16x16x32_bf16 v[120:123], a[200:203], v[176:179], v[120:123]
 v_mfma_f32_16x16x32_bf16 v[124:127], a[192:195], v[180:183], v[124:127]
 ds_read_b128 v[212:215], v19 offset:10240
 v_mfma_f32_16x16x32_bf16 v[128:131], a[196:199], v[180:183], v[128:131]
 buffer_load_dwordx4 v13, s[8:11], s30 offen offset:3072 lds
 v_mfma_f32_16x16x32_bf16 v[132:135], a[200:203], v[180:183], v[132:135]
 s_add_u32 s30, s30, 128
 s_add_u32 m0, m0, 16384
 v_mfma_f32_16x16x32_bf16 v[136:139], a[192:195], v[184:187], v[136:139]
 ds_read_b128 v[216:219], v19 offset:12288
 v_mfma_f32_16x16x32_bf16 v[140:143], a[196:199], v[184:187], v[140:143]
 s_cmp_lt_u32 m0, s46
 s_cselect_b32 m0, m0, s47
 v_mfma_f32_16x16x32_bf16 v[144:147], a[200:203], v[184:187], v[144:147]
 v_mfma_f32_16x16x32_bf16 v[148:151], a[192:195], v[188:191], v[148:151]
 ds_read_b128 v[220:223], v19 offset:14336
 v_mfma_f32_16x16x32_bf16 v[152:155], a[196:199], v[188:191], v[152:155]
 v_mfma_f32_16x16x32_bf16 v[156:159], a[200:203], v[188:191], v[156:159]
 s_waitcnt vmcnt(12) lgkmcnt(4)
 s_barrier
 v_mfma_f32_16x16x32_bf16 v[64:67], a[204:207], v[192:195], v[64:67]
 ds_read_b128 v[160:163], v18 offset:0
 v_mfma_f32_16x16x32_bf16 v[68:71], a[208:211], v[192:195], v[68:71]
 v_mfma_f32_16x16x32_bf16 v[72:75], a[212:215], v[192:195], v[72:75]
 v_add_u32 v19, s33, v15
 s_add_u32 s33, s33, 16384
 v_mfma_f32_16x16x32_bf16 v[76:79], a[204:207], v[196:199], v[76:79]
 ds_read_b128 v[164:167], v18 offset:2048
 v_mfma_f32_16x16x32_bf16 v[80:83], a[208:211], v[196:199], v[80:83]
 buffer_load_dwordx4 v10, s[8:11], s30 offen offset:0 lds
 v_mfma_f32_16x16x32_bf16 v[84:87], a[212:215], v[196:199], v[84:87]
 s_cmp_lt_u32 s33, 98304
 s_cselect_b32 s33, s33, 0
 v_mfma_f32_16x16x32_bf16 v[88:91], a[204:207], v[200:203], v[88:91]
 ds_read_b128 v[168:171], v18 offset:4096
 v_mfma_f32_16x16x32_bf16 v[92:95], a[208:211], v[200:203], v[92:95]
 v_mfma_f32_16x16x32_bf16 v[96:99], a[212:215], v[200:203], v[96:99]
 v_mfma_f32_16x16x32_bf16 v[100:103], a[204:207], v[204:207], v[100:103]
 ds_read_b128 v[172:175], v18 offset:6144
 v_mfma_f32_16x16x32_bf16 v[104:107], a[208:211], v[204:207], v[104:107]
 v_mfma_f32_16x16x32_bf16 v[108:111], a[212:215], v[204:207], v[108:111]
 s_waitcnt lgkmcnt(4)
 v_mfma_f32_16x16x32_bf16 v[112:115], a[204:207], v[208:211], v[112:115]
 ds_read_b128 v[176:179], v18 offset:8192
 v_mfma_f32_16x16x32_bf16 v[116:119], a[208:211], v[208:211], v[116:119]
 v_mfma_f32_16x16x32_bf16 v[120:123], a[212:215], v[208:211], v[120:123]
 v_mfma_f32_16x16x32_bf16 v[124:127], a[204:207], v[212:215], v[124:127]
 ds_read_b128 v[180:183], v18 offset:10240
 v_mfma_f32_16x16x32_bf16 v[128:131], a[208:211], v[212:215], v[128:131]
 buffer_load_dwordx4 v11, s[8:11], s30 offen offset:1024 lds
 v_mfma_f32_16x16x32_bf16 v[132:135], a[212:215], v[212:215], v[132:135]
 v_mfma_f32_16x16x32_bf16 v[136:139], a[204:207], v[216:219], v[136:139]
 ds_read_b128 v[184:187], v18 offset:12288
 v_mfma_f32_16x16x32_bf16 v[140:143], a[208:211], v[216:219], v[140:143]
 v_mfma_f32_16x16x32_bf16 v[144:147], a[212:215], v[216:219], v[144:147]
 v_mfma_f32_16x16x32_bf16 v[148:151], a[204:207], v[220:223], v[148:151]
 ds_read_b128 v[188:191], v18 offset:14336
 v_mfma_f32_16x16x32_bf16 v[152:155], a[208:211], v[220:223], v[152:155]
 v_mfma_f32_16x16x32_bf16 v[156:159], a[212:215], v[220:223], v[156:159]
 s_waitcnt lgkmcnt(4)
 v_mfma_f32_16x16x32_bf16 v[64:67], a[216:219], v[160:163], v[64:67]
 ds_read_b128 v[192:195], v19 offset:0
 v_mfma_f32_16x16x32_bf16 v[68:71], a[220:223], v[160:163], v[68:71]
 v_add_u32 v18, s33, v14
 v_mfma_f32_16x16x32_bf16 v[72:75], a[224:227], v[160:163], v[72:75]
 v_mfma_f32_16x16x32_bf16 v[76:79], a[216:219], v[164:167], v[76:79]
 ds_read_b128 v[196:199], v19 offset:2048
 v_mfma_f32_16x16x32_bf16 v[80:83], a[220:223], v[164:167], v[80:83]
 buffer_load_dwordx4 v12, s[8:11], s30 offen offset:2048 lds
 v_mfma_f32_16x16x32_bf16 v[84:87], a[224:227], v[164:167], v[84:87]
 v_mfma_f32_16x16x32_bf16 v[88:91], a[216:219], v[168:171], v[88:91]
 ds_read_b128 v[200:203], v19 offset:4096
 v_mfma_f32_16x16x32_bf16 v[92:95], a[220:223], v[168:171], v[92:95]
 v_mfma_f32_16x16x32_bf16 v[96:99], a[224:227], v[168:171], v[96:99]
 v_mfma_f32_16x16x32_bf16 v[100:103], a[216:219], v[172:175], v[100:103]
 ds_read_b128 v[204:207], v19 offset:6144
 v_mfma_f32_16x16x32_bf16 v[104:107], a[220:223], v[172:175], v[104:107]
 v_mfma_f32_16x16x32_bf16 v[108:111], a[224:227], v[172:175], v[108:111]
 s_waitcnt lgkmcnt(4)
 v_mfma_f32_16x16x32_bf16 v[112:115], a[216:219], v[176:179], v[112:115]
 ds_read_b128 v[208:211], v19 offset:8192
 v_mfma_f32_16x16x32_bf16 v[116:119], a[220:223], v[176:179], v[116:119]
 v_mfma_f32_16x16x32_bf16 v[120:123], a[224:227], v[176:179], v[120:123]
 v_mfma_f32_16x16x32_bf16 v[124:127], a[216:219], v[180:183], v[124:127]
 ds_read_b128 v[212:215], v19 offset:10240
 v_mfma_f32_16x16x32_bf16 v[128:131], a[220:223], v[180:183], v[128:131]
 buffer_load_dwordx4 v13, s[8:11], s30 offen offset:3072 lds
 v_mfma_f32_16x16x32_bf16 v[132:135], a[224:227], v[180:183], v[132:135]
 s_add_u32 s30, s30, 128
 s_add_u32 m0, m0, 16384
 v_mfma_f32_16x16x32_bf16 v[136:139], a[216:219], v[184:187], v[136:139]
 ds_read_b128 v[216:219], v19 offset:12288
 v_mfma_f32_16x16x32_bf16 v[140:143], a[220:223], v[184:187], v[140:143]
 s_cmp_lt_u32 m0, s46
 s_cselect_b32 m0, m0, s47
 v_mfma_f32_16x16x32_bf16 v[144:147], a[224:227], v[184:187], v[144:147]
 v_mfma_f32_16x16x32_bf16 v[148:151], a[216:219], v[188:191], v[148:151]
 ds_read_b128 v[220:223], v19 offset:14336
 v_mfma_f32_16x16x32_bf16 v[152:155], a[220:223], v[188:191], v[152:155]
 v_mfma_f32_16x16x32_bf16 v[156:159], a[224:227], v[188:191], v[156:159]
 s_waitcnt vmcnt(12) lgkmcnt(4)
 s_barrier
 v_mfma_f32_16x16x32_bf16 v[64:67], a[228:231], v[192:195], v[64:67]
 ds_read_b128 v[160:163], v18 offset:0
 v_mfma_f32_16x16x32_bf16 v[68:71], a[232:235], v[192:195], v[68:71]
 v_mfma_f32_16x16x32_bf16 v[72:75], a[236:239], v[192:195], v[72:75]
 v_add_u32 v19, s33, v15
 s_add_u32 s33, s33, 16384
 v_mfma_f32_16x16x32_bf16 v[76:79], a[228:231], v[196:199], v[76:79]
 ds_read_b128 v[164:167], v18 offset:2048
 v_cvt_pk_bf16_f32 v224, v64, v65
 v_mfma_f32_16x16x32_bf16 v[80:83], a[232:235], v[196:199], v[80:83]
 buffer_load_dwordx4 v10, s[8:11], s30 offen offset:0 lds
 v_mfma_f32_16x16x32_bf16 v[84:87], a[236:239], v[196:199], v[84:87]
 s_cmp_lt_u32 s33, 98304
 s_cselect_b32 s33, s33, 0
 v_mfma_f32_16x16x32_bf16 v[88:91], a[228:231], v[200:203], v[88:91]
 ds_read_b128 v[168:171], v18 offset:4096
 v_cvt_pk_bf16_f32 v225, v66, v67
 v_mfma_f32_16x16x32_bf16 v[92:95], a[232:235], v[200:203], v[92:95]
 v_cvt_pk_bf16_f32 v226, v68, v69
 v_cvt_pk_bf16_f32 v227, v70, v71
 v_mfma_f32_16x16x32_bf16 v[96:99], a[236:239], v[200:203], v[96:99]
 v_cvt_pk_bf16_f32 v228, v72, v73
 v_cvt_pk_bf16_f32 v229, v74, v75
 v_mfma_f32_16x16x32_bf16 v[100:103], a[228:231], v[204:207], v[100:103]
 ds_read_b128 v[172:175], v18 offset:6144
 v_mfma_f32_16x16x32_bf16 v[104:107], a[232:235], v[204:207], v[104:107]
 ds_write_b64 v22, v[224:225] offset:0
 v_mfma_f32_16x16x32_bf16 v[108:111], a[236:239], v[204:207], v[108:111]
 s_waitcnt lgkmcnt(5)
 v_mfma_f32_16x16x32_bf16 v[112:115], a[228:231], v[208:211], v[112:115]
 ds_read_b128 v[176:179], v18 offset:8192
 v_mfma_f32_16x16x32_bf16 v[116:119], a[232:235], v[208:211], v[116:119]
 ds_write_b64 v22, v[226:227] offset:8
 v_mfma_f32_16x16x32_bf16 v[120:123], a[236:239], v[208:211], v[120:123]
 ds_write_b64 v16, v[228:229] offset:64
 v_mfma_f32_16x16x32_bf16 v[124:127], a[228:231], v[212:215], v[124:127]
 ds_read_b128 v[180:183], v18 offset:10240
 v_cvt_pk_bf16_f32 v230, v76, v77
 v_mfma_f32_16x16x32_bf16 v[128:131], a[232:235], v[212:215], v[128:131]
 buffer_load_dwordx4 v11, s[8:11], s30 offen offset:1024 lds
 v_mfma_f32_16x16x32_bf16 v[132:135], a[236:239], v[212:215], v[132:135]
 v_cvt_pk_bf16_f32 v231, v78, v79
 v_cvt_pk_bf16_f32 v232, v80, v81
 v_mfma_f32_16x16x32_bf16 v[136:139], a[228:231], v[216:219], v[136:139]
 ds_read_b128 v[184:187], v18 offset:12288
 v_cvt_pk_bf16_f32 v233, v82, v83
 v_mfma_f32_16x16x32_bf16 v[140:143], a[232:235], v[216:219], v[140:143]
 v_cvt_pk_bf16_f32 v234, v84, v85
 v_cvt_pk_bf16_f32 v235, v86, v87
 v_mfma_f32_16x16x32_bf16 v[144:147], a[236:239], v[216:219], v[144:147]
 ds_write_b64 v22, v[230:231] offset:6400
 v_mfma_f32_16x16x32_bf16 v[148:151], a[228:231], v[220:223], v[148:151]
 ds_read_b128 v[188:191], v18 offset:14336
 v_mfma_f32_16x16x32_bf16 v[152:155], a[232:235], v[220:223], v[152:155]
 ds_write_b64 v22, v[232:233] offset:6408
 v_mfma_f32_16x16x32_bf16 v[156:159], a[236:239], v[220:223], v[156:159]
 s_waitcnt lgkmcnt(9)
kv_end_137:
 s_cmp_gt_u32 s26, 0
 s_cbranch_scc1 kv_blk_136
 s_nop 7
 ds_write_b64 v16, v[234:235] offset:6464
 v_cvt_pk_bf16_f32 v236, v88, v89
 v_cvt_pk_bf16_f32 v237, v90, v91
 v_cvt_pk_bf16_f32 v238, v92, v93
 v_cvt_pk_bf16_f32 v239, v94, v95
 v_cvt_pk_bf16_f32 v240, v96, v97
 v_cvt_pk_bf16_f32 v241, v98, v99
 ds_write_b64 v22, v[236:237] offset:12800
 ds_write_b64 v22, v[238:239] offset:12808
 ds_write_b64 v16, v[240:241] offset:12864
 v_cvt_pk_bf16_f32 v242, v100, v101
 v_cvt_pk_bf16_f32 v243, v102, v103
 v_cvt_pk_bf16_f32 v244, v104, v105
 v_cvt_pk_bf16_f32 v245, v106, v107
 v_cvt_pk_bf16_f32 v246, v108, v109
 v_cvt_pk_bf16_f32 v247, v110, v111
 ds_write_b64 v22, v[242:243] offset:19200
 ds_write_b64 v22, v[244:245] offset:19208
 ds_write_b64 v16, v[246:247] offset:19264
 v_cvt_pk_bf16_f32 v224, v112, v113
 v_cvt_pk_bf16_f32 v225, v114, v115
 v_cvt_pk_bf16_f32 v226, v116, v117
 v_cvt_pk_bf16_f32 v227, v118, v119
 v_cvt_pk_bf16_f32 v228, v120, v121
 v_cvt_pk_bf16_f32 v229, v122, v123
 ds_write_b64 v22, v[224:225] offset:25600
 ds_write_b64 v22, v[226:227] offset:25608
 ds_write_b64 v16, v[228:229] offset:25664
 v_cvt_pk_bf16_f32 v230, v124, v125
 v_cvt_pk_bf16_f32 v231, v126, v127
 v_cvt_pk_bf16_f32 v232, v128, v129
 v_cvt_pk_bf16_f32 v233, v130, v131
 v_cvt_pk_bf16_f32 v234, v132, v133
 v_cvt_pk_bf16_f32 v235, v134, v135
 ds_write_b64 v22, v[230:231] offset:32000
 ds_write_b64 v22, v[232:233] offset:32008
 ds_write_b64 v16, v[234:235] offset:32064
 v_cvt_pk_bf16_f32 v236, v136, v137
 v_cvt_pk_bf16_f32 v237, v138, v139
 v_cvt_pk_bf16_f32 v238, v140, v141
 v_cvt_pk_bf16_f32 v239, v142, v143
 v_cvt_pk_bf16_f32 v240, v144, v145
 v_cvt_pk_bf16_f32 v241, v146, v147
 ds_write_b64 v22, v[236:237] offset:38400
 ds_write_b64 v22, v[238:239] offset:38408
 ds_write_b64 v16, v[240:241] offset:38464
 v_cvt_pk_bf16_f32 v242, v148, v149
 v_cvt_pk_bf16_f32 v243, v150, v151
 v_cvt_pk_bf16_f32 v244, v152, v153
 v_cvt_pk_bf16_f32 v245, v154, v155
 v_cvt_pk_bf16_f32 v246, v156, v157
 v_cvt_pk_bf16_f32 v247, v158, v159
 ds_write_b64 v22, v[242:243] offset:44800
 ds_write_b64 v22, v[244:245] offset:44808
 ds_write_b64 v16, v[246:247] offset:44864
 s_waitcnt vmcnt(0) lgkmcnt(0)
 s_barrier
 ds_read_b128 v[224:227], v23 offset:0
 ds_read_b128 v[228:231], v23 offset:64
 ds_read_b128 v[232:235], v23 offset:128
 ds_read_b128 v[236:239], v23 offset:192
 ds_read_b128 v[240:243], v23 offset:256
 ds_read_b128 v[244:247], v23 offset:320
 s_waitcnt lgkmcnt(0)
 s_add_u32 s21, s48, 0
 buffer_store_dwordx4 v[224:227], v26, s[16:19], s21 offen offset:0 sc1
 buffer_store_dwordx4 v[228:231], v26, s[16:19], s21 offen offset:1024 sc1
 buffer_store_dwordx4 v[232:235], v26, s[16:19], s21 offen offset:2048 sc1
 buffer_store_dwordx4 v[236:239], v26, s[16:19], s21 offen offset:3072 sc1
 s_add_u32 s21, s48, 4096
 buffer_store_dwordx4 v[240:243], v26, s[16:19], s21 offen offset:0 sc1
 buffer_store_dwordx4 v[244:247], v26, s[16:19], s21 offen offset:1024 sc1
 s_nop 1
 ds_read_b128 v[224:227], v23 offset:6400
 ds_read_b128 v[228:231], v23 offset:6464
 ds_read_b128 v[232:235], v23 offset:6528
 ds_read_b128 v[236:239], v23 offset:6592
 ds_read_b128 v[240:243], v23 offset:6656
 ds_read_b128 v[244:247], v23 offset:6720
 s_waitcnt lgkmcnt(0)
 buffer_store_dwordx4 v[224:227], v26, s[16:19], s21 offen offset:2048 sc1
 buffer_store_dwordx4 v[228:231], v26, s[16:19], s21 offen offset:3072 sc1
 s_add_u32 s21, s48, 8192
 buffer_store_dwordx4 v[232:235], v26, s[16:19], s21 offen offset:0 sc1
 buffer_store_dwordx4 v[236:239], v26, s[16:19], s21 offen offset:1024 sc1
 buffer_store_dwordx4 v[240:243], v26, s[16:19], s21 offen offset:2048 sc1
 buffer_store_dwordx4 v[244:247], v26, s[16:19], s21 offen offset:3072 sc1
 s_nop 1
 s_waitcnt vmcnt(0)
 s_barrier
 s_cmp_lg_u32 s20, 0
 s_cbranch_scc1 af_138
 v_mov_b32 v4, 0
 v_mov_b32 v5, 1
 s_mov_b64 exec, 1
 buffer_atomic_add v5, v4, s[72:75], s61 offen sc1
 s_mov_b64 exec, -1
 s_nop 1
af_138:
 s_cmp_lg_u32 s43, 0
 s_cbranch_scc1 kv_fin
 s_lshr_b32 s2, s3, 1
 s_branch q_entry
kv_fin:
 s_branch queue
not_kv:
 s_cmp_ge_u32 s3, 96
 s_cbranch_scc1 not_vw
 s_sub_u32 s2, s3, 64
 s_load_dwordx2 s[72:73], s[0:1], 104
 s_waitcnt lgkmcnt(0)
 s_add_u32 s72, s72, 81068032
 s_addc_u32 s73, s73, 0
 s_mov_b32 s74, 129024
 s_mov_b32 s75, 0x00020000
 s_add_u32 s8, s38, 78643200
 s_addc_u32 s9, s39, 0
 s_mov_b32 s10, 2162688
 s_mov_b32 s11, 0x00020000
 s_add_u32 s12, s38, 50331648
 s_addc_u32 s13, s39, 0
 s_mov_b32 s14, 12582912
 s_mov_b32 s15, 0x00020000
 s_add_u32 s16, s38, 181305344
 s_addc_u32 s17, s39, 0
 s_mov_b32 s18, 66158592
 s_mov_b32 s19, 0x00020000
 v_lshlrev_b32 v8, 4, v0
 v_lshlrev_b32 v9, 4, v1
 v_mov_b32 v4, 0
 v_mov_b32 v12, -1
 v_mov_b32 v5, 0
 v_mov_b32 v13, -1
 v_mov_b32 v6, 0
 v_mov_b32 v14, -1
 v_mov_b32 v7, 0
 v_mov_b32 v15, -1
 s_lshl_b32 s21, s2, 12
 buffer_store_dwordx4 v[4:7], v8, s[72:75], s21 offen sc1
 s_lshr_b32 s21, s2, 3
 s_mul_i32 s21, s21, 0x88000
 s_and_b32 s21, s21, 0x108000
 s_bfe_u32 s22, s2, 0x10002
 s_lshl_b32 s22, s22, 13
 s_add_u32 s21, s21, s22
 s_bfe_u32 s22, s2, 0x10001
 s_lshl_b32 s22, s22, 14
 s_add_u32 s21, s21, s22
 s_and_b32 s22, s2, 1
 s_mul_i32 s22, s22, 3
 s_add_u32 s22, s22, s20
 s_lshl_b32 s22, s22, 10
 s_add_u32 s21, s21, s22
 s_cmp_lt_u32 s20, 3
 s_cselect_b32 s21, s21, 0x80000000
 buffer_store_dwordx4 v[4:7], v9, s[16:19], s21 offen sc1
 s_mul_i32 s23, s20, 540672
 s_lshl_b32 s21, s2, 11
 s_add_u32 s21, s21, s23
 s_add_u32 s21, s21, 81920
 buffer_store_dwordx4 v[12:15], v9, s[8:11], s21 offen sc1
 buffer_store_dwordx4 v[12:15], v9, s[8:11], s21 offen offset:1024 sc1
 s_lshl_b32 s21, s2, 9
 s_add_u32 s21, s21, s23
 s_add_u32 s21, s21, 376832
 s_mov_b64 exec, 0xffffffff
 buffer_store_dwordx4 v[12:15], v9, s[8:11], s21 offen sc1
 s_mov_b64 exec, -1
 s_lshl_b32 s21, s2, 1
 s_lshr_b32 s22, s20, 1
 s_add_u32 s21, s21, s22
 s_lshl_b32 s21, s21, 20
 s_and_b32 s22, s20, 1
 s_mul_i32 s22, s22, 49152
 s_add_u32 s21, s21, s22
 s_add_u32 s21, s21, 7168
 v_mul_u32_u24 v9, 16640, v3
 v_bfe_u32 v10, v1, 3, 1
 v_lshl_add_u32 v9, v10, 13, v9
 v_and_b32 v10, 7, v1
 v_lshl_add_u32 v9, v10, 4, v9
 s_mov_b32 exec_hi, 0xffff
 buffer_store_dwordx4 v[4:7], v9, s[16:19], s21 offen sc1
 s_mov_b64 exec, -1
 s_waitcnt vmcnt(0)
 s_barrier
 s_mov_b32 s21, 76
 s_cmp_lg_u32 s20, 0
 s_cbranch_scc1 af_139
 v_mov_b32 v10, 0
 v_mov_b32 v11, 1
 s_mov_b64 exec, 1
 buffer_atomic_add v11, v10, s[32:35], s21 offen sc1
 s_mov_b64 exec, -1
 s_nop 1
af_139:
 s_load_dwordx2 s[4:5], s[0:1], 0
 s_load_dwordx2 s[6:7], s[0:1], 80
 s_load_dwordx2 s[38:39], s[0:1], 104
 s_lshl_b32 s59, s2, 2
 s_add_u32 s59, s59, s20
 s_lshl_b32 s59, s59, 4
 s_waitcnt lgkmcnt(0)
 s_mov_b32 s8, s4
 s_mov_b32 s9, s5
 s_mov_b32 s10, 2621440
 s_mov_b32 s11, 0x00020000
 s_mov_b32 s12, s6
 s_mov_b32 s13, s7
 s_mov_b32 s14, 1280
 s_mov_b32 s15, 0x00020000
 s_add_u32 s28, s38, 81002496
 s_addc_u32 s29, s39, 0
 s_mov_b32 s30, 8192
 s_mov_b32 s31, 0x00020000
 v_lshlrev_b32 v4, 2, v1
 v_lshlrev_b32 v5, 4, v1
 buffer_load_dwordx4 v[16:19], v5, s[12:15], 0 offen
 buffer_load_dword v20, v4, s[12:15], 0 offen offset:1024
 s_mul_i32 s22, s59, 1280
 buffer_load_dwordx4 v[64:67], v5, s[8:11], s22 offen
 buffer_load_dword v68, v4, s[8:11], s22 offen offset:1024
 s_add_u32 s22, s22, 1280
 buffer_load_dwordx4 v[70:73], v5, s[8:11], s22 offen
 buffer_load_dword v74, v4, s[8:11], s22 offen offset:1024
 s_add_u32 s22, s22, 1280
 buffer_load_dwordx4 v[76:79], v5, s[8:11], s22 offen
 buffer_load_dword v80, v4, s[8:11], s22 offen offset:1024
 s_add_u32 s22, s22, 1280
 buffer_load_dwordx4 v[82:85], v5, s[8:11], s22 offen
 buffer_load_dword v86, v4, s[8:11], s22 offen offset:1024
 s_add_u32 s22, s22, 1280
 buffer_load_dwordx4 v[88:91], v5, s[8:11], s22 offen
 buffer_load_dword v92, v4, s[8:11], s22 offen offset:1024
 s_add_u32 s22, s22, 1280
 buffer_load_dwordx4 v[94:97], v5, s[8:11], s22 offen
 buffer_load_dword v98, v4, s[8:11], s22 offen offset:1024
 s_add_u32 s22, s22, 1280
 buffer_load_dwordx4 v[100:103], v5, s[8:11], s22 offen
 buffer_load_dword v104, v4, s[8:11], s22 offen offset:1024
 s_add_u32 s22, s22, 1280
 buffer_load_dwordx4 v[106:109], v5, s[8:11], s22 offen
 buffer_load_dword v110, v4, s[8:11], s22 offen offset:1024
 s_add_u32 s22, s22, 1280
 buffer_load_dwordx4 v[112:115], v5, s[8:11], s22 offen
 buffer_load_dword v116, v4, s[8:11], s22 offen offset:1024
 s_add_u32 s22, s22, 1280
 buffer_load_dwordx4 v[118:121], v5, s[8:11], s22 offen
 buffer_load_dword v122, v4, s[8:11], s22 offen offset:1024
 s_add_u32 s22, s22, 1280
 buffer_load_dwordx4 v[124:127], v5, s[8:11], s22 offen
 buffer_load_dword v128, v4, s[8:11], s22 offen offset:1024
 s_add_u32 s22, s22, 1280
 buffer_load_dwordx4 v[130:133], v5, s[8:11], s22 offen
 buffer_load_dword v134, v4, s[8:11], s22 offen offset:1024
 s_add_u32 s22, s22, 1280
 buffer_load_dwordx4 v[136:139], v5, s[8:11], s22 offen
 buffer_load_dword v140, v4, s[8:11], s22 offen offset:1024
 s_add_u32 s22, s22, 1280
 buffer_load_dwordx4 v[142:145], v5, s[8:11], s22 offen
 buffer_load_dword v146, v4, s[8:11], s22 offen offset:1024
 s_add_u32 s22, s22, 1280
 buffer_load_dwordx4 v[148:151], v5, s[8:11], s22 offen
 buffer_load_dword v152, v4, s[8:11], s22 offen offset:1024
 s_add_u32 s22, s22, 1280
 buffer_load_dwordx4 v[154:157], v5, s[8:11], s22 offen
 buffer_load_dword v158, v4, s[8:11], s22 offen offset:1024
 s_add_u32 s22, s22, 1280
 s_waitcnt vmcnt(32)
 v_lshlrev_b32 v8, 16, v16
 v_and_b32 v16, 0xffff0000, v16
 v_lshlrev_b32 v9, 16, v17
 v_and_b32 v17, 0xffff0000, v17
 v_lshlrev_b32 v10, 16, v18
 v_and_b32 v18, 0xffff0000, v18
 v_lshlrev_b32 v11, 16, v19
 v_and_b32 v19, 0xffff0000, v19
 v_lshlrev_b32 v12, 16, v20
 v_and_b32 v20, 0xffff0000, v20
 s_waitcnt vmcnt(30)
 v_mov_b32 v160, 0
 v_lshlrev_b32 v25, 16, v64
 v_and_b32 v26, 0xffff0000, v64
 v_mul_f32 v25, v25, v8
 v_mul_f32 v26, v26, v16
 v_cvt_pk_bf16_f32 v25, v25, v26
 v_lshlrev_b32 v26, 16, v25
 v_and_b32 v25, 0xffff0000, v25
 v_add_f32 v160, v160, v26
 v_add_f32 v160, v160, v25
 v_lshlrev_b32 v25, 16, v65
 v_and_b32 v26, 0xffff0000, v65
 v_mul_f32 v25, v25, v9
 v_mul_f32 v26, v26, v17
 v_cvt_pk_bf16_f32 v25, v25, v26
 v_lshlrev_b32 v26, 16, v25
 v_and_b32 v25, 0xffff0000, v25
 v_add_f32 v160, v160, v26
 v_add_f32 v160, v160, v25
 v_lshlrev_b32 v25, 16, v66
 v_and_b32 v26, 0xffff0000, v66
 v_mul_f32 v25, v25, v10
 v_mul_f32 v26, v26, v18
 v_cvt_pk_bf16_f32 v25, v25, v26
 v_lshlrev_b32 v26, 16, v25
 v_and_b32 v25, 0xffff0000, v25
 v_add_f32 v160, v160, v26
 v_add_f32 v160, v160, v25
 v_lshlrev_b32 v25, 16, v67
 v_and_b32 v26, 0xffff0000, v67
 v_mul_f32 v25, v25, v11
 v_mul_f32 v26, v26, v19
 v_cvt_pk_bf16_f32 v25, v25, v26
 v_lshlrev_b32 v26, 16, v25
 v_and_b32 v25, 0xffff0000, v25
 v_add_f32 v160, v160, v26
 v_add_f32 v160, v160, v25
 v_lshlrev_b32 v25, 16, v68
 v_and_b32 v26, 0xffff0000, v68
 v_mul_f32 v25, v25, v12
 v_mul_f32 v26, v26, v20
 v_cvt_pk_bf16_f32 v25, v25, v26
 v_lshlrev_b32 v26, 16, v25
 v_and_b32 v25, 0xffff0000, v25
 v_add_f32 v160, v160, v26
 v_add_f32 v160, v160, v25
 s_waitcnt vmcnt(28)
 v_mov_b32 v161, 0
 v_lshlrev_b32 v25, 16, v70
 v_and_b32 v26, 0xffff0000, v70
 v_mul_f32 v25, v25, v8
 v_mul_f32 v26, v26, v16
 v_cvt_pk_bf16_f32 v25, v25, v26
 v_lshlrev_b32 v26, 16, v25
 v_and_b32 v25, 0xffff0000, v25
 v_add_f32 v161, v161, v26
 v_add_f32 v161, v161, v25
 v_lshlrev_b32 v25, 16, v71
 v_and_b32 v26, 0xffff0000, v71
 v_mul_f32 v25, v25, v9
 v_mul_f32 v26, v26, v17
 v_cvt_pk_bf16_f32 v25, v25, v26
 v_lshlrev_b32 v26, 16, v25
 v_and_b32 v25, 0xffff0000, v25
 v_add_f32 v161, v161, v26
 v_add_f32 v161, v161, v25
 v_lshlrev_b32 v25, 16, v72
 v_and_b32 v26, 0xffff0000, v72
 v_mul_f32 v25, v25, v10
 v_mul_f32 v26, v26, v18
 v_cvt_pk_bf16_f32 v25, v25, v26
 v_lshlrev_b32 v26, 16, v25
 v_and_b32 v25, 0xffff0000, v25
 v_add_f32 v161, v161, v26
 v_add_f32 v161, v161, v25
 v_lshlrev_b32 v25, 16, v73
 v_and_b32 v26, 0xffff0000, v73
 v_mul_f32 v25, v25, v11
 v_mul_f32 v26, v26, v19
 v_cvt_pk_bf16_f32 v25, v25, v26
 v_lshlrev_b32 v26, 16, v25
 v_and_b32 v25, 0xffff0000, v25
 v_add_f32 v161, v161, v26
 v_add_f32 v161, v161, v25
 v_lshlrev_b32 v25, 16, v74
 v_and_b32 v26, 0xffff0000, v74
 v_mul_f32 v25, v25, v12
 v_mul_f32 v26, v26, v20
 v_cvt_pk_bf16_f32 v25, v25, v26
 v_lshlrev_b32 v26, 16, v25
 v_and_b32 v25, 0xffff0000, v25
 v_add_f32 v161, v161, v26
 v_add_f32 v161, v161, v25
 s_waitcnt vmcnt(26)
 v_mov_b32 v162, 0
 v_lshlrev_b32 v25, 16, v76
 v_and_b32 v26, 0xffff0000, v76
 v_mul_f32 v25, v25, v8
 v_mul_f32 v26, v26, v16
 v_cvt_pk_bf16_f32 v25, v25, v26
 v_lshlrev_b32 v26, 16, v25
 v_and_b32 v25, 0xffff0000, v25
 v_add_f32 v162, v162, v26
 v_add_f32 v162, v162, v25
 v_lshlrev_b32 v25, 16, v77
 v_and_b32 v26, 0xffff0000, v77
 v_mul_f32 v25, v25, v9
 v_mul_f32 v26, v26, v17
 v_cvt_pk_bf16_f32 v25, v25, v26
 v_lshlrev_b32 v26, 16, v25
 v_and_b32 v25, 0xffff0000, v25
 v_add_f32 v162, v162, v26
 v_add_f32 v162, v162, v25
 v_lshlrev_b32 v25, 16, v78
 v_and_b32 v26, 0xffff0000, v78
 v_mul_f32 v25, v25, v10
 v_mul_f32 v26, v26, v18
 v_cvt_pk_bf16_f32 v25, v25, v26
 v_lshlrev_b32 v26, 16, v25
 v_and_b32 v25, 0xffff0000, v25
 v_add_f32 v162, v162, v26
 v_add_f32 v162, v162, v25
 v_lshlrev_b32 v25, 16, v79
 v_and_b32 v26, 0xffff0000, v79
 v_mul_f32 v25, v25, v11
 v_mul_f32 v26, v26, v19
 v_cvt_pk_bf16_f32 v25, v25, v26
 v_lshlrev_b32 v26, 16, v25
 v_and_b32 v25, 0xffff0000, v25
 v_add_f32 v162, v162, v26
 v_add_f32 v162, v162, v25
 v_lshlrev_b32 v25, 16, v80
 v_and_b32 v26, 0xffff0000, v80
 v_mul_f32 v25, v25, v12
 v_mul_f32 v26, v26, v20
 v_cvt_pk_bf16_f32 v25, v25, v26
 v_lshlrev_b32 v26, 16, v25
 v_and_b32 v25, 0xffff0000, v25
 v_add_f32 v162, v162, v26
 v_add_f32 v162, v162, v25
 s_waitcnt vmcnt(24)
 v_mov_b32 v163, 0
 v_lshlrev_b32 v25, 16, v82
 v_and_b32 v26, 0xffff0000, v82
 v_mul_f32 v25, v25, v8
 v_mul_f32 v26, v26, v16
 v_cvt_pk_bf16_f32 v25, v25, v26
 v_lshlrev_b32 v26, 16, v25
 v_and_b32 v25, 0xffff0000, v25
 v_add_f32 v163, v163, v26
 v_add_f32 v163, v163, v25
 v_lshlrev_b32 v25, 16, v83
 v_and_b32 v26, 0xffff0000, v83
 v_mul_f32 v25, v25, v9
 v_mul_f32 v26, v26, v17
 v_cvt_pk_bf16_f32 v25, v25, v26
 v_lshlrev_b32 v26, 16, v25
 v_and_b32 v25, 0xffff0000, v25
 v_add_f32 v163, v163, v26
 v_add_f32 v163, v163, v25
 v_lshlrev_b32 v25, 16, v84
 v_and_b32 v26, 0xffff0000, v84
 v_mul_f32 v25, v25, v10
 v_mul_f32 v26, v26, v18
 v_cvt_pk_bf16_f32 v25, v25, v26
 v_lshlrev_b32 v26, 16, v25
 v_and_b32 v25, 0xffff0000, v25
 v_add_f32 v163, v163, v26
 v_add_f32 v163, v163, v25
 v_lshlrev_b32 v25, 16, v85
 v_and_b32 v26, 0xffff0000, v85
 v_mul_f32 v25, v25, v11
 v_mul_f32 v26, v26, v19
 v_cvt_pk_bf16_f32 v25, v25, v26
 v_lshlrev_b32 v26, 16, v25
 v_and_b32 v25, 0xffff0000, v25
 v_add_f32 v163, v163, v26
 v_add_f32 v163, v163, v25
 v_lshlrev_b32 v25, 16, v86
 v_and_b32 v26, 0xffff0000, v86
 v_mul_f32 v25, v25, v12
 v_mul_f32 v26, v26, v20
 v_cvt_pk_bf16_f32 v25, v25, v26
 v_lshlrev_b32 v26, 16, v25
 v_and_b32 v25, 0xffff0000, v25
 v_add_f32 v163, v163, v26
 v_add_f32 v163, v163, v25
 s_waitcnt vmcnt(22)
 v_mov_b32 v164, 0
 v_lshlrev_b32 v25, 16, v88
 v_and_b32 v26, 0xffff0000, v88
 v_mul_f32 v25, v25, v8
 v_mul_f32 v26, v26, v16
 v_cvt_pk_bf16_f32 v25, v25, v26
 v_lshlrev_b32 v26, 16, v25
 v_and_b32 v25, 0xffff0000, v25
 v_add_f32 v164, v164, v26
 v_add_f32 v164, v164, v25
 v_lshlrev_b32 v25, 16, v89
 v_and_b32 v26, 0xffff0000, v89
 v_mul_f32 v25, v25, v9
 v_mul_f32 v26, v26, v17
 v_cvt_pk_bf16_f32 v25, v25, v26
 v_lshlrev_b32 v26, 16, v25
 v_and_b32 v25, 0xffff0000, v25
 v_add_f32 v164, v164, v26
 v_add_f32 v164, v164, v25
 v_lshlrev_b32 v25, 16, v90
 v_and_b32 v26, 0xffff0000, v90
 v_mul_f32 v25, v25, v10
 v_mul_f32 v26, v26, v18
 v_cvt_pk_bf16_f32 v25, v25, v26
 v_lshlrev_b32 v26, 16, v25
 v_and_b32 v25, 0xffff0000, v25
 v_add_f32 v164, v164, v26
 v_add_f32 v164, v164, v25
 v_lshlrev_b32 v25, 16, v91
 v_and_b32 v26, 0xffff0000, v91
 v_mul_f32 v25, v25, v11
 v_mul_f32 v26, v26, v19
 v_cvt_pk_bf16_f32 v25, v25, v26
 v_lshlrev_b32 v26, 16, v25
 v_and_b32 v25, 0xffff0000, v25
 v_add_f32 v164, v164, v26
 v_add_f32 v164, v164, v25
 v_lshlrev_b32 v25, 16, v92
 v_and_b32 v26, 0xffff0000, v92
 v_mul_f32 v25, v25, v12
 v_mul_f32 v26, v26, v20
 v_cvt_pk_bf16_f32 v25, v25, v26
 v_lshlrev_b32 v26, 16, v25
 v_and_b32 v25, 0xffff0000, v25
 v_add_f32 v164, v164, v26
 v_add_f32 v164, v164, v25
 s_waitcnt vmcnt(20)
 v_mov_b32 v165, 0
 v_lshlrev_b32 v25, 16, v94
 v_and_b32 v26, 0xffff0000, v94
 v_mul_f32 v25, v25, v8
 v_mul_f32 v26, v26, v16
 v_cvt_pk_bf16_f32 v25, v25, v26
 v_lshlrev_b32 v26, 16, v25
 v_and_b32 v25, 0xffff0000, v25
 v_add_f32 v165, v165, v26
 v_add_f32 v165, v165, v25
 v_lshlrev_b32 v25, 16, v95
 v_and_b32 v26, 0xffff0000, v95
 v_mul_f32 v25, v25, v9
 v_mul_f32 v26, v26, v17
 v_cvt_pk_bf16_f32 v25, v25, v26
 v_lshlrev_b32 v26, 16, v25
 v_and_b32 v25, 0xffff0000, v25
 v_add_f32 v165, v165, v26
 v_add_f32 v165, v165, v25
 v_lshlrev_b32 v25, 16, v96
 v_and_b32 v26, 0xffff0000, v96
 v_mul_f32 v25, v25, v10
 v_mul_f32 v26, v26, v18
 v_cvt_pk_bf16_f32 v25, v25, v26
 v_lshlrev_b32 v26, 16, v25
 v_and_b32 v25, 0xffff0000, v25
 v_add_f32 v165, v165, v26
 v_add_f32 v165, v165, v25
 v_lshlrev_b32 v25, 16, v97
 v_and_b32 v26, 0xffff0000, v97
 v_mul_f32 v25, v25, v11
 v_mul_f32 v26, v26, v19
 v_cvt_pk_bf16_f32 v25, v25, v26
 v_lshlrev_b32 v26, 16, v25
 v_and_b32 v25, 0xffff0000, v25
 v_add_f32 v165, v165, v26
 v_add_f32 v165, v165, v25
 v_lshlrev_b32 v25, 16, v98
 v_and_b32 v26, 0xffff0000, v98
 v_mul_f32 v25, v25, v12
 v_mul_f32 v26, v26, v20
 v_cvt_pk_bf16_f32 v25, v25, v26
 v_lshlrev_b32 v26, 16, v25
 v_and_b32 v25, 0xffff0000, v25
 v_add_f32 v165, v165, v26
 v_add_f32 v165, v165, v25
 s_waitcnt vmcnt(18)
 v_mov_b32 v166, 0
 v_lshlrev_b32 v25, 16, v100
 v_and_b32 v26, 0xffff0000, v100
 v_mul_f32 v25, v25, v8
 v_mul_f32 v26, v26, v16
 v_cvt_pk_bf16_f32 v25, v25, v26
 v_lshlrev_b32 v26, 16, v25
 v_and_b32 v25, 0xffff0000, v25
 v_add_f32 v166, v166, v26
 v_add_f32 v166, v166, v25
 v_lshlrev_b32 v25, 16, v101
 v_and_b32 v26, 0xffff0000, v101
 v_mul_f32 v25, v25, v9
 v_mul_f32 v26, v26, v17
 v_cvt_pk_bf16_f32 v25, v25, v26
 v_lshlrev_b32 v26, 16, v25
 v_and_b32 v25, 0xffff0000, v25
 v_add_f32 v166, v166, v26
 v_add_f32 v166, v166, v25
 v_lshlrev_b32 v25, 16, v102
 v_and_b32 v26, 0xffff0000, v102
 v_mul_f32 v25, v25, v10
 v_mul_f32 v26, v26, v18
 v_cvt_pk_bf16_f32 v25, v25, v26
 v_lshlrev_b32 v26, 16, v25
 v_and_b32 v25, 0xffff0000, v25
 v_add_f32 v166, v166, v26
 v_add_f32 v166, v166, v25
 v_lshlrev_b32 v25, 16, v103
 v_and_b32 v26, 0xffff0000, v103
 v_mul_f32 v25, v25, v11
 v_mul_f32 v26, v26, v19
 v_cvt_pk_bf16_f32 v25, v25, v26
 v_lshlrev_b32 v26, 16, v25
 v_and_b32 v25, 0xffff0000, v25
 v_add_f32 v166, v166, v26
 v_add_f32 v166, v166, v25
 v_lshlrev_b32 v25, 16, v104
 v_and_b32 v26, 0xffff0000, v104
 v_mul_f32 v25, v25, v12
 v_mul_f32 v26, v26, v20
 v_cvt_pk_bf16_f32 v25, v25, v26
 v_lshlrev_b32 v26, 16, v25
 v_and_b32 v25, 0xffff0000, v25
 v_add_f32 v166, v166, v26
 v_add_f32 v166, v166, v25
 s_waitcnt vmcnt(16)
 v_mov_b32 v167, 0
 v_lshlrev_b32 v25, 16, v106
 v_and_b32 v26, 0xffff0000, v106
 v_mul_f32 v25, v25, v8
 v_mul_f32 v26, v26, v16
 v_cvt_pk_bf16_f32 v25, v25, v26
 v_lshlrev_b32 v26, 16, v25
 v_and_b32 v25, 0xffff0000, v25
 v_add_f32 v167, v167, v26
 v_add_f32 v167, v167, v25
 v_lshlrev_b32 v25, 16, v107
 v_and_b32 v26, 0xffff0000, v107
 v_mul_f32 v25, v25, v9
 v_mul_f32 v26, v26, v17
 v_cvt_pk_bf16_f32 v25, v25, v26
 v_lshlrev_b32 v26, 16, v25
 v_and_b32 v25, 0xffff0000, v25
 v_add_f32 v167, v167, v26
 v_add_f32 v167, v167, v25
 v_lshlrev_b32 v25, 16, v108
 v_and_b32 v26, 0xffff0000, v108
 v_mul_f32 v25, v25, v10
 v_mul_f32 v26, v26, v18
 v_cvt_pk_bf16_f32 v25, v25, v26
 v_lshlrev_b32 v26, 16, v25
 v_and_b32 v25, 0xffff0000, v25
 v_add_f32 v167, v167, v26
 v_add_f32 v167, v167, v25
 v_lshlrev_b32 v25, 16, v109
 v_and_b32 v26, 0xffff0000, v109
 v_mul_f32 v25, v25, v11
 v_mul_f32 v26, v26, v19
 v_cvt_pk_bf16_f32 v25, v25, v26
 v_lshlrev_b32 v26, 16, v25
 v_and_b32 v25, 0xffff0000, v25
 v_add_f32 v167, v167, v26
 v_add_f32 v167, v167, v25
 v_lshlrev_b32 v25, 16, v110
 v_and_b32 v26, 0xffff0000, v110
 v_mul_f32 v25, v25, v12
 v_mul_f32 v26, v26, v20
 v_cvt_pk_bf16_f32 v25, v25, v26
 v_lshlrev_b32 v26, 16, v25
 v_and_b32 v25, 0xffff0000, v25
 v_add_f32 v167, v167, v26
 v_add_f32 v167, v167, v25
 s_waitcnt vmcnt(14)
 v_mov_b32 v168, 0
 v_lshlrev_b32 v25, 16, v112
 v_and_b32 v26, 0xffff0000, v112
 v_mul_f32 v25, v25, v8
 v_mul_f32 v26, v26, v16
 v_cvt_pk_bf16_f32 v25, v25, v26
 v_lshlrev_b32 v26, 16, v25
 v_and_b32 v25, 0xffff0000, v25
 v_add_f32 v168, v168, v26
 v_add_f32 v168, v168, v25
 v_lshlrev_b32 v25, 16, v113
 v_and_b32 v26, 0xffff0000, v113
 v_mul_f32 v25, v25, v9
 v_mul_f32 v26, v26, v17
 v_cvt_pk_bf16_f32 v25, v25, v26
 v_lshlrev_b32 v26, 16, v25
 v_and_b32 v25, 0xffff0000, v25
 v_add_f32 v168, v168, v26
 v_add_f32 v168, v168, v25
 v_lshlrev_b32 v25, 16, v114
 v_and_b32 v26, 0xffff0000, v114
 v_mul_f32 v25, v25, v10
 v_mul_f32 v26, v26, v18
 v_cvt_pk_bf16_f32 v25, v25, v26
 v_lshlrev_b32 v26, 16, v25
 v_and_b32 v25, 0xffff0000, v25
 v_add_f32 v168, v168, v26
 v_add_f32 v168, v168, v25
 v_lshlrev_b32 v25, 16, v115
 v_and_b32 v26, 0xffff0000, v115
 v_mul_f32 v25, v25, v11
 v_mul_f32 v26, v26, v19
 v_cvt_pk_bf16_f32 v25, v25, v26
 v_lshlrev_b32 v26, 16, v25
 v_and_b32 v25, 0xffff0000, v25
 v_add_f32 v168, v168, v26
 v_add_f32 v168, v168, v25
 v_lshlrev_b32 v25, 16, v116
 v_and_b32 v26, 0xffff0000, v116
 v_mul_f32 v25, v25, v12
 v_mul_f32 v26, v26, v20
 v_cvt_pk_bf16_f32 v25, v25, v26
 v_lshlrev_b32 v26, 16, v25
 v_and_b32 v25, 0xffff0000, v25
 v_add_f32 v168, v168, v26
 v_add_f32 v168, v168, v25
 s_waitcnt vmcnt(12)
 v_mov_b32 v169, 0
 v_lshlrev_b32 v25, 16, v118
 v_and_b32 v26, 0xffff0000, v118
 v_mul_f32 v25, v25, v8
 v_mul_f32 v26, v26, v16
 v_cvt_pk_bf16_f32 v25, v25, v26
 v_lshlrev_b32 v26, 16, v25
 v_and_b32 v25, 0xffff0000, v25
 v_add_f32 v169, v169, v26
 v_add_f32 v169, v169, v25
 v_lshlrev_b32 v25, 16, v119
 v_and_b32 v26, 0xffff0000, v119
 v_mul_f32 v25, v25, v9
 v_mul_f32 v26, v26, v17
 v_cvt_pk_bf16_f32 v25, v25, v26
 v_lshlrev_b32 v26, 16, v25
 v_and_b32 v25, 0xffff0000, v25
 v_add_f32 v169, v169, v26
 v_add_f32 v169, v169, v25
 v_lshlrev_b32 v25, 16, v120
 v_and_b32 v26, 0xffff0000, v120
 v_mul_f32 v25, v25, v10
 v_mul_f32 v26, v26, v18
 v_cvt_pk_bf16_f32 v25, v25, v26
 v_lshlrev_b32 v26, 16, v25
 v_and_b32 v25, 0xffff0000, v25
 v_add_f32 v169, v169, v26
 v_add_f32 v169, v169, v25
 v_lshlrev_b32 v25, 16, v121
 v_and_b32 v26, 0xffff0000, v121
 v_mul_f32 v25, v25, v11
 v_mul_f32 v26, v26, v19
 v_cvt_pk_bf16_f32 v25, v25, v26
 v_lshlrev_b32 v26, 16, v25
 v_and_b32 v25, 0xffff0000, v25
 v_add_f32 v169, v169, v26
 v_add_f32 v169, v169, v25
 v_lshlrev_b32 v25, 16, v122
 v_and_b32 v26, 0xffff0000, v122
 v_mul_f32 v25, v25, v12
 v_mul_f32 v26, v26, v20
 v_cvt_pk_bf16_f32 v25, v25, v26
 v_lshlrev_b32 v26, 16, v25
 v_and_b32 v25, 0xffff0000, v25
 v_add_f32 v169, v169, v26
 v_add_f32 v169, v169, v25
 s_waitcnt vmcnt(10)
 v_mov_b32 v170, 0
 v_lshlrev_b32 v25, 16, v124
 v_and_b32 v26, 0xffff0000, v124
 v_mul_f32 v25, v25, v8
 v_mul_f32 v26, v26, v16
 v_cvt_pk_bf16_f32 v25, v25, v26
 v_lshlrev_b32 v26, 16, v25
 v_and_b32 v25, 0xffff0000, v25
 v_add_f32 v170, v170, v26
 v_add_f32 v170, v170, v25
 v_lshlrev_b32 v25, 16, v125
 v_and_b32 v26, 0xffff0000, v125
 v_mul_f32 v25, v25, v9
 v_mul_f32 v26, v26, v17
 v_cvt_pk_bf16_f32 v25, v25, v26
 v_lshlrev_b32 v26, 16, v25
 v_and_b32 v25, 0xffff0000, v25
 v_add_f32 v170, v170, v26
 v_add_f32 v170, v170, v25
 v_lshlrev_b32 v25, 16, v126
 v_and_b32 v26, 0xffff0000, v126
 v_mul_f32 v25, v25, v10
 v_mul_f32 v26, v26, v18
 v_cvt_pk_bf16_f32 v25, v25, v26
 v_lshlrev_b32 v26, 16, v25
 v_and_b32 v25, 0xffff0000, v25
 v_add_f32 v170, v170, v26
 v_add_f32 v170, v170, v25
 v_lshlrev_b32 v25, 16, v127
 v_and_b32 v26, 0xffff0000, v127
 v_mul_f32 v25, v25, v11
 v_mul_f32 v26, v26, v19
 v_cvt_pk_bf16_f32 v25, v25, v26
 v_lshlrev_b32 v26, 16, v25
 v_and_b32 v25, 0xffff0000, v25
 v_add_f32 v170, v170, v26
 v_add_f32 v170, v170, v25
 v_lshlrev_b32 v25, 16, v128
 v_and_b32 v26, 0xffff0000, v128
 v_mul_f32 v25, v25, v12
 v_mul_f32 v26, v26, v20
 v_cvt_pk_bf16_f32 v25, v25, v26
 v_lshlrev_b32 v26, 16, v25
 v_and_b32 v25, 0xffff0000, v25
 v_add_f32 v170, v170, v26
 v_add_f32 v170, v170, v25
 s_waitcnt vmcnt(8)
 v_mov_b32 v171, 0
 v_lshlrev_b32 v25, 16, v130
 v_and_b32 v26, 0xffff0000, v130
 v_mul_f32 v25, v25, v8
 v_mul_f32 v26, v26, v16
 v_cvt_pk_bf16_f32 v25, v25, v26
 v_lshlrev_b32 v26, 16, v25
 v_and_b32 v25, 0xffff0000, v25
 v_add_f32 v171, v171, v26
 v_add_f32 v171, v171, v25
 v_lshlrev_b32 v25, 16, v131
 v_and_b32 v26, 0xffff0000, v131
 v_mul_f32 v25, v25, v9
 v_mul_f32 v26, v26, v17
 v_cvt_pk_bf16_f32 v25, v25, v26
 v_lshlrev_b32 v26, 16, v25
 v_and_b32 v25, 0xffff0000, v25
 v_add_f32 v171, v171, v26
 v_add_f32 v171, v171, v25
 v_lshlrev_b32 v25, 16, v132
 v_and_b32 v26, 0xffff0000, v132
 v_mul_f32 v25, v25, v10
 v_mul_f32 v26, v26, v18
 v_cvt_pk_bf16_f32 v25, v25, v26
 v_lshlrev_b32 v26, 16, v25
 v_and_b32 v25, 0xffff0000, v25
 v_add_f32 v171, v171, v26
 v_add_f32 v171, v171, v25
 v_lshlrev_b32 v25, 16, v133
 v_and_b32 v26, 0xffff0000, v133
 v_mul_f32 v25, v25, v11
 v_mul_f32 v26, v26, v19
 v_cvt_pk_bf16_f32 v25, v25, v26
 v_lshlrev_b32 v26, 16, v25
 v_and_b32 v25, 0xffff0000, v25
 v_add_f32 v171, v171, v26
 v_add_f32 v171, v171, v25
 v_lshlrev_b32 v25, 16, v134
 v_and_b32 v26, 0xffff0000, v134
 v_mul_f32 v25, v25, v12
 v_mul_f32 v26, v26, v20
 v_cvt_pk_bf16_f32 v25, v25, v26
 v_lshlrev_b32 v26, 16, v25
 v_and_b32 v25, 0xffff0000, v25
 v_add_f32 v171, v171, v26
 v_add_f32 v171, v171, v25
 s_waitcnt vmcnt(6)
 v_mov_b32 v172, 0
 v_lshlrev_b32 v25, 16, v136
 v_and_b32 v26, 0xffff0000, v136
 v_mul_f32 v25, v25, v8
 v_mul_f32 v26, v26, v16
 v_cvt_pk_bf16_f32 v25, v25, v26
 v_lshlrev_b32 v26, 16, v25
 v_and_b32 v25, 0xffff0000, v25
 v_add_f32 v172, v172, v26
 v_add_f32 v172, v172, v25
 v_lshlrev_b32 v25, 16, v137
 v_and_b32 v26, 0xffff0000, v137
 v_mul_f32 v25, v25, v9
 v_mul_f32 v26, v26, v17
 v_cvt_pk_bf16_f32 v25, v25, v26
 v_lshlrev_b32 v26, 16, v25
 v_and_b32 v25, 0xffff0000, v25
 v_add_f32 v172, v172, v26
 v_add_f32 v172, v172, v25
 v_lshlrev_b32 v25, 16, v138
 v_and_b32 v26, 0xffff0000, v138
 v_mul_f32 v25, v25, v10
 v_mul_f32 v26, v26, v18
 v_cvt_pk_bf16_f32 v25, v25, v26
 v_lshlrev_b32 v26, 16, v25
 v_and_b32 v25, 0xffff0000, v25
 v_add_f32 v172, v172, v26
 v_add_f32 v172, v172, v25
 v_lshlrev_b32 v25, 16, v139
 v_and_b32 v26, 0xffff0000, v139
 v_mul_f32 v25, v25, v11
 v_mul_f32 v26, v26, v19
 v_cvt_pk_bf16_f32 v25, v25, v26
 v_lshlrev_b32 v26, 16, v25
 v_and_b32 v25, 0xffff0000, v25
 v_add_f32 v172, v172, v26
 v_add_f32 v172, v172, v25
 v_lshlrev_b32 v25, 16, v140
 v_and_b32 v26, 0xffff0000, v140
 v_mul_f32 v25, v25, v12
 v_mul_f32 v26, v26, v20
 v_cvt_pk_bf16_f32 v25, v25, v26
 v_lshlrev_b32 v26, 16, v25
 v_and_b32 v25, 0xffff0000, v25
 v_add_f32 v172, v172, v26
 v_add_f32 v172, v172, v25
 s_waitcnt vmcnt(4)
 v_mov_b32 v173, 0
 v_lshlrev_b32 v25, 16, v142
 v_and_b32 v26, 0xffff0000, v142
 v_mul_f32 v25, v25, v8
 v_mul_f32 v26, v26, v16
 v_cvt_pk_bf16_f32 v25, v25, v26
 v_lshlrev_b32 v26, 16, v25
 v_and_b32 v25, 0xffff0000, v25
 v_add_f32 v173, v173, v26
 v_add_f32 v173, v173, v25
 v_lshlrev_b32 v25, 16, v143
 v_and_b32 v26, 0xffff0000, v143
 v_mul_f32 v25, v25, v9
 v_mul_f32 v26, v26, v17
 v_cvt_pk_bf16_f32 v25, v25, v26
 v_lshlrev_b32 v26, 16, v25
 v_and_b32 v25, 0xffff0000, v25
 v_add_f32 v173, v173, v26
 v_add_f32 v173, v173, v25
 v_lshlrev_b32 v25, 16, v144
 v_and_b32 v26, 0xffff0000, v144
 v_mul_f32 v25, v25, v10
 v_mul_f32 v26, v26, v18
 v_cvt_pk_bf16_f32 v25, v25, v26
 v_lshlrev_b32 v26, 16, v25
 v_and_b32 v25, 0xffff0000, v25
 v_add_f32 v173, v173, v26
 v_add_f32 v173, v173, v25
 v_lshlrev_b32 v25, 16, v145
 v_and_b32 v26, 0xffff0000, v145
 v_mul_f32 v25, v25, v11
 v_mul_f32 v26, v26, v19
 v_cvt_pk_bf16_f32 v25, v25, v26
 v_lshlrev_b32 v26, 16, v25
 v_and_b32 v25, 0xffff0000, v25
 v_add_f32 v173, v173, v26
 v_add_f32 v173, v173, v25
 v_lshlrev_b32 v25, 16, v146
 v_and_b32 v26, 0xffff0000, v146
 v_mul_f32 v25, v25, v12
 v_mul_f32 v26, v26, v20
 v_cvt_pk_bf16_f32 v25, v25, v26
 v_lshlrev_b32 v26, 16, v25
 v_and_b32 v25, 0xffff0000, v25
 v_add_f32 v173, v173, v26
 v_add_f32 v173, v173, v25
 s_waitcnt vmcnt(2)
 v_mov_b32 v174, 0
 v_lshlrev_b32 v25, 16, v148
 v_and_b32 v26, 0xffff0000, v148
 v_mul_f32 v25, v25, v8
 v_mul_f32 v26, v26, v16
 v_cvt_pk_bf16_f32 v25, v25, v26
 v_lshlrev_b32 v26, 16, v25
 v_and_b32 v25, 0xffff0000, v25
 v_add_f32 v174, v174, v26
 v_add_f32 v174, v174, v25
 v_lshlrev_b32 v25, 16, v149
 v_and_b32 v26, 0xffff0000, v149
 v_mul_f32 v25, v25, v9
 v_mul_f32 v26, v26, v17
 v_cvt_pk_bf16_f32 v25, v25, v26
 v_lshlrev_b32 v26, 16, v25
 v_and_b32 v25, 0xffff0000, v25
 v_add_f32 v174, v174, v26
 v_add_f32 v174, v174, v25
 v_lshlrev_b32 v25, 16, v150
 v_and_b32 v26, 0xffff0000, v150
 v_mul_f32 v25, v25, v10
 v_mul_f32 v26, v26, v18
 v_cvt_pk_bf16_f32 v25, v25, v26
 v_lshlrev_b32 v26, 16, v25
 v_and_b32 v25, 0xffff0000, v25
 v_add_f32 v174, v174, v26
 v_add_f32 v174, v174, v25
 v_lshlrev_b32 v25, 16, v151
 v_and_b32 v26, 0xffff0000, v151
 v_mul_f32 v25, v25, v11
 v_mul_f32 v26, v26, v19
 v_cvt_pk_bf16_f32 v25, v25, v26
 v_lshlrev_b32 v26, 16, v25
 v_and_b32 v25, 0xffff0000, v25
 v_add_f32 v174, v174, v26
 v_add_f32 v174, v174, v25
 v_lshlrev_b32 v25, 16, v152
 v_and_b32 v26, 0xffff0000, v152
 v_mul_f32 v25, v25, v12
 v_mul_f32 v26, v26, v20
 v_cvt_pk_bf16_f32 v25, v25, v26
 v_lshlrev_b32 v26, 16, v25
 v_and_b32 v25, 0xffff0000, v25
 v_add_f32 v174, v174, v26
 v_add_f32 v174, v174, v25
 s_waitcnt vmcnt(0)
 v_mov_b32 v175, 0
 v_lshlrev_b32 v25, 16, v154
 v_and_b32 v26, 0xffff0000, v154
 v_mul_f32 v25, v25, v8
 v_mul_f32 v26, v26, v16
 v_cvt_pk_bf16_f32 v25, v25, v26
 v_lshlrev_b32 v26, 16, v25
 v_and_b32 v25, 0xffff0000, v25
 v_add_f32 v175, v175, v26
 v_add_f32 v175, v175, v25
 v_lshlrev_b32 v25, 16, v155
 v_and_b32 v26, 0xffff0000, v155
 v_mul_f32 v25, v25, v9
 v_mul_f32 v26, v26, v17
 v_cvt_pk_bf16_f32 v25, v25, v26
 v_lshlrev_b32 v26, 16, v25
 v_and_b32 v25, 0xffff0000, v25
 v_add_f32 v175, v175, v26
 v_add_f32 v175, v175, v25
 v_lshlrev_b32 v25, 16, v156
 v_and_b32 v26, 0xffff0000, v156
 v_mul_f32 v25, v25, v10
 v_mul_f32 v26, v26, v18
 v_cvt_pk_bf16_f32 v25, v25, v26
 v_lshlrev_b32 v26, 16, v25
 v_and_b32 v25, 0xffff0000, v25
 v_add_f32 v175, v175, v26
 v_add_f32 v175, v175, v25
 v_lshlrev_b32 v25, 16, v157
 v_and_b32 v26, 0xffff0000, v157
 v_mul_f32 v25, v25, v11
 v_mul_f32 v26, v26, v19
 v_cvt_pk_bf16_f32 v25, v25, v26
 v_lshlrev_b32 v26, 16, v25
 v_and_b32 v25, 0xffff0000, v25
 v_add_f32 v175, v175, v26
 v_add_f32 v175, v175, v25
 v_lshlrev_b32 v25, 16, v158
 v_and_b32 v26, 0xffff0000, v158
 v_mul_f32 v25, v25, v12
 v_mul_f32 v26, v26, v20
 v_cvt_pk_bf16_f32 v25, v25, v26
 v_lshlrev_b32 v26, 16, v25
 v_and_b32 v25, 0xffff0000, v25
 v_add_f32 v175, v175, v26
 v_add_f32 v175, v175, v25
 v_add_f32_dpp v160, v160, v160 row_ror:8 row_mask:0xf bank_mask:0xf
 v_add_f32_dpp v161, v161, v161 row_ror:8 row_mask:0xf bank_mask:0xf
 v_add_f32_dpp v162, v162, v162 row_ror:8 row_mask:0xf bank_mask:0xf
 v_add_f32_dpp v163, v163, v163 row_ror:8 row_mask:0xf bank_mask:0xf
 v_add_f32_dpp v164, v164, v164 row_ror:8 row_mask:0xf bank_mask:0xf
 v_add_f32_dpp v165, v165, v165 row_ror:8 row_mask:0xf bank_mask:0xf
 v_add_f32_dpp v166, v166, v166 row_ror:8 row_mask:0xf bank_mask:0xf
 v_add_f32_dpp v167, v167, v167 row_ror:8 row_mask:0xf bank_mask:0xf
 v_add_f32_dpp v168, v168, v168 row_ror:8 row_mask:0xf bank_mask:0xf
 v_add_f32_dpp v169, v169, v169 row_ror:8 row_mask:0xf bank_mask:0xf
 v_add_f32_dpp v170, v170, v170 row_ror:8 row_mask:0xf bank_mask:0xf
 v_add_f32_dpp v171, v171, v171 row_ror:8 row_mask:0xf bank_mask:0xf
 v_add_f32_dpp v172, v172, v172 row_ror:8 row_mask:0xf bank_mask:0xf
 v_add_f32_dpp v173, v173, v173 row_ror:8 row_mask:0xf bank_mask:0xf
 v_add_f32_dpp v174, v174, v174 row_ror:8 row_mask:0xf bank_mask:0xf
 v_add_f32_dpp v175, v175, v175 row_ror:8 row_mask:0xf bank_mask:0xf
 v_add_f32_dpp v160, v160, v160 row_ror:4 row_mask:0xf bank_mask:0xf
 v_add_f32_dpp v161, v161, v161 row_ror:4 row_mask:0xf bank_mask:0xf
 v_add_f32_dpp v162, v162, v162 row_ror:4 row_mask:0xf bank_mask:0xf
 v_add_f32_dpp v163, v163, v163 row_ror:4 row_mask:0xf bank_mask:0xf
 v_add_f32_dpp v164, v164, v164 row_ror:4 row_mask:0xf bank_mask:0xf
 v_add_f32_dpp v165, v165, v165 row_ror:4 row_mask:0xf bank_mask:0xf
 v_add_f32_dpp v166, v166, v166 row_ror:4 row_mask:0xf bank_mask:0xf
 v_add_f32_dpp v167, v167, v167 row_ror:4 row_mask:0xf bank_mask:0xf
 v_add_f32_dpp v168, v168, v168 row_ror:4 row_mask:0xf bank_mask:0xf
 v_add_f32_dpp v169, v169, v169 row_ror:4 row_mask:0xf bank_mask:0xf
 v_add_f32_dpp v170, v170, v170 row_ror:4 row_mask:0xf bank_mask:0xf
 v_add_f32_dpp v171, v171, v171 row_ror:4 row_mask:0xf bank_mask:0xf
 v_add_f32_dpp v172, v172, v172 row_ror:4 row_mask:0xf bank_mask:0xf
 v_add_f32_dpp v173, v173, v173 row_ror:4 row_mask:0xf bank_mask:0xf
 v_add_f32_dpp v174, v174, v174 row_ror:4 row_mask:0xf bank_mask:0xf
 v_add_f32_dpp v175, v175, v175 row_ror:4 row_mask:0xf bank_mask:0xf
 v_add_f32_dpp v160, v160, v160 row_ror:2 row_mask:0xf bank_mask:0xf
 v_add_f32_dpp v161, v161, v161 row_ror:2 row_mask:0xf bank_mask:0xf
 v_add_f32_dpp v162, v162, v162 row_ror:2 row_mask:0xf bank_mask:0xf
 v_add_f32_dpp v163, v163, v163 row_ror:2 row_mask:0xf bank_mask:0xf
 v_add_f32_dpp v164, v164, v164 row_ror:2 row_mask:0xf bank_mask:0xf
 v_add_f32_dpp v165, v165, v165 row_ror:2 row_mask:0xf bank_mask:0xf
 v_add_f32_dpp v166, v166, v166 row_ror:2 row_mask:0xf bank_mask:0xf
 v_add_f32_dpp v167, v167, v167 row_ror:2 row_mask:0xf bank_mask:0xf
 v_add_f32_dpp v168, v168, v168 row_ror:2 row_mask:0xf bank_mask:0xf
 v_add_f32_dpp v169, v169, v169 row_ror:2 row_mask:0xf bank_mask:0xf
 v_add_f32_dpp v170, v170, v170 row_ror:2 row_mask:0xf bank_mask:0xf
 v_add_f32_dpp v171, v171, v171 row_ror:2 row_mask:0xf bank_mask:0xf
 v_add_f32_dpp v172, v172, v172 row_ror:2 row_mask:0xf bank_mask:0xf
 v_add_f32_dpp v173, v173, v173 row_ror:2 row_mask:0xf bank_mask:0xf
 v_add_f32_dpp v174, v174, v174 row_ror:2 row_mask:0xf bank_mask:0xf
 v_add_f32_dpp v175, v175, v175 row_ror:2 row_mask:0xf bank_mask:0xf
 v_add_f32_dpp v160, v160, v160 row_ror:1 row_mask:0xf bank_mask:0xf
 v_add_f32_dpp v161, v161, v161 row_ror:1 row_mask:0xf bank_mask:0xf
 v_add_f32_dpp v162, v162, v162 row_ror:1 row_mask:0xf bank_mask:0xf
 v_add_f32_dpp v163, v163, v163 row_ror:1 row_mask:0xf bank_mask:0xf
 v_add_f32_dpp v164, v164, v164 row_ror:1 row_mask:0xf bank_mask:0xf
 v_add_f32_dpp v165, v165, v165 row_ror:1 row_mask:0xf bank_mask:0xf
 v_add_f32_dpp v166, v166, v166 row_ror:1 row_mask:0xf bank_mask:0xf
 v_add_f32_dpp v167, v167, v167 row_ror:1 row_mask:0xf bank_mask:0xf
 v_add_f32_dpp v168, v168, v168 row_ror:1 row_mask:0xf bank_mask:0xf
 v_add_f32_dpp v169, v169, v169 row_ror:1 row_mask:0xf bank_mask:0xf
 v_add_f32_dpp v170, v170, v170 row_ror:1 row_mask:0xf bank_mask:0xf
 v_add_f32_dpp v171, v171, v171 row_ror:1 row_mask:0xf bank_mask:0xf
 v_add_f32_dpp v172, v172, v172 row_ror:1 row_mask:0xf bank_mask:0xf
 v_add_f32_dpp v173, v173, v173 row_ror:1 row_mask:0xf bank_mask:0xf
 v_add_f32_dpp v174, v174, v174 row_ror:1 row_mask:0xf bank_mask:0xf
 v_add_f32_dpp v175, v175, v175 row_ror:1 row_mask:0xf bank_mask:0xf
 v_mov_b32 v192, v160
 v_mov_b32 v193, v161
 v_mov_b32 v194, v162
 v_mov_b32 v195, v163
 v_mov_b32 v196, v164
 v_mov_b32 v197, v165
 v_mov_b32 v198, v166
 v_mov_b32 v199, v167
 v_mov_b32 v200, v168
 v_mov_b32 v201, v169
 v_mov_b32 v202, v170
 v_mov_b32 v203, v171
 v_mov_b32 v204, v172
 v_mov_b32 v205, v173
 v_mov_b32 v206, v174
 v_mov_b32 v207, v175
 v_permlane32_swap_b32 v160, v192
 v_permlane32_swap_b32 v161, v193
 v_permlane32_swap_b32 v162, v194
 v_permlane32_swap_b32 v163, v195
 v_permlane32_swap_b32 v164, v196
 v_permlane32_swap_b32 v165, v197
 v_permlane32_swap_b32 v166, v198
 v_permlane32_swap_b32 v167, v199
 v_permlane32_swap_b32 v168, v200
 v_permlane32_swap_b32 v169, v201
 v_permlane32_swap_b32 v170, v202
 v_permlane32_swap_b32 v171, v203
 v_permlane32_swap_b32 v172, v204
 v_permlane32_swap_b32 v173, v205
 v_permlane32_swap_b32 v174, v206
 v_permlane32_swap_b32 v175, v207
 v_add_f32 v160, v160, v192
 v_add_f32 v161, v161, v193
 v_add_f32 v162, v162, v194
 v_add_f32 v163, v163, v195
 v_add_f32 v164, v164, v196
 v_add_f32 v165, v165, v197
 v_add_f32 v166, v166, v198
 v_add_f32 v167, v167, v199
 v_add_f32 v168, v168, v200
 v_add_f32 v169, v169, v201
 v_add_f32 v170, v170, v202
 v_add_f32 v171, v171, v203
 v_add_f32 v172, v172, v204
 v_add_f32 v173, v173, v205
 v_add_f32 v174, v174, v206
 v_add_f32 v175, v175, v207
 v_mov_b32 v192, v160
 v_mov_b32 v193, v161
 v_mov_b32 v194, v162
 v_mov_b32 v195, v163
 v_mov_b32 v196, v164
 v_mov_b32 v197, v165
 v_mov_b32 v198, v166
 v_mov_b32 v199, v167
 v_mov_b32 v200, v168
 v_mov_b32 v201, v169
 v_mov_b32 v202, v170
 v_mov_b32 v203, v171
 v_mov_b32 v204, v172
 v_mov_b32 v205, v173
 v_mov_b32 v206, v174
 v_mov_b32 v207, v175
 v_permlane16_swap_b32 v160, v192
 v_permlane16_swap_b32 v161, v193
 v_permlane16_swap_b32 v162, v194
 v_permlane16_swap_b32 v163, v195
 v_permlane16_swap_b32 v164, v196
 v_permlane16_swap_b32 v165, v197
 v_permlane16_swap_b32 v166, v198
 v_permlane16_swap_b32 v167, v199
 v_permlane16_swap_b32 v168, v200
 v_permlane16_swap_b32 v169, v201
 v_permlane16_swap_b32 v170, v202
 v_permlane16_swap_b32 v171, v203
 v_permlane16_swap_b32 v172, v204
 v_permlane16_swap_b32 v173, v205
 v_permlane16_swap_b32 v174, v206
 v_permlane16_swap_b32 v175, v207
 v_add_f32 v160, v160, v192
 v_add_f32 v161, v161, v193
 v_add_f32 v162, v162, v194
 v_add_f32 v163, v163, v195
 v_add_f32 v164, v164, v196
 v_add_f32 v165, v165, v197
 v_add_f32 v166, v166, v198
 v_add_f32 v167, v167, v199
 v_add_f32 v168, v168, v200
 v_add_f32 v169, v169, v201
 v_add_f32 v170, v170, v202
 v_add_f32 v171, v171, v203
 v_add_f32 v172, v172, v204
 v_add_f32 v173, v173, v205
 v_add_f32 v174, v174, v206
 v_add_f32 v175, v175, v207
 v_mov_b32 v24, v160
 v_cmp_eq_u32 vcc, 1, v1
 s_nop 1
 v_cndmask_b32 v24, v24, v161, vcc
 v_cmp_eq_u32 vcc, 2, v1
 s_nop 1
 v_cndmask_b32 v24, v24, v162, vcc
 v_cmp_eq_u32 vcc, 3, v1
 s_nop 1
 v_cndmask_b32 v24, v24, v163, vcc
 v_cmp_eq_u32 vcc, 4, v1
 s_nop 1
 v_cndmask_b32 v24, v24, v164, vcc
 v_cmp_eq_u32 vcc, 5, v1
 s_nop 1
 v_cndmask_b32 v24, v24, v165, vcc
 v_cmp_eq_u32 vcc, 6, v1
 s_nop 1
 v_cndmask_b32 v24, v24, v166, vcc
 v_cmp_eq_u32 vcc, 7, v1
 s_nop 1
 v_cndmask_b32 v24, v24, v167, vcc
 v_cmp_eq_u32 vcc, 8, v1
 s_nop 1
 v_cndmask_b32 v24, v24, v168, vcc
 v_cmp_eq_u32 vcc, 9, v1
 s_nop 1
 v_cndmask_b32 v24, v24, v169, vcc
 v_cmp_eq_u32 vcc, 10, v1
 s_nop 1
 v_cndmask_b32 v24, v24, v170, vcc
 v_cmp_eq_u32 vcc, 11, v1
 s_nop 1
 v_cndmask_b32 v24, v24, v171, vcc
 v_cmp_eq_u32 vcc, 12, v1
 s_nop 1
 v_cndmask_b32 v24, v24, v172, vcc
 v_cmp_eq_u32 vcc, 13, v1
 s_nop 1
 v_cndmask_b32 v24, v24, v173, vcc
 v_cmp_eq_u32 vcc, 14, v1
 s_nop 1
 v_cndmask_b32 v24, v24, v174, vcc
 v_cmp_eq_u32 vcc, 15, v1
 s_nop 1
 v_cndmask_b32 v24, v24, v175, vcc
 v_cvt_pk_bf16_f32 v25, v24, v24
 v_lshlrev_b32 v24, 16, v25
 v_mul_f32 v24, 0xbfb8aa3b, v24
 v_exp_f32 v24, v24
 s_nop 0
 v_add_f32 v24, 1.0, v24
 v_rcp_f32 v24, v24
 s_nop 0
 v_cvt_pk_bf16_f32 v25, v24, v24
 v_lshlrev_b32 v24, 16, v25
 s_lshl_b32 s21, s59, 2
 s_mov_b64 exec, 65535
 buffer_store_dword v24, v4, s[28:31], s21 offen sc1
 s_mov_b64 exec, -1
 s_load_dwordx2 s[6:7], s[0:1], 40
 s_load_dwordx2 s[38:39], s[0:1], 104
 s_waitcnt lgkmcnt(0)
 s_mov_b32 s12, s6
 s_mov_b32 s13, s7
 s_mov_b32 s14, 7864320
 s_mov_b32 s15, 0x00020000
 s_mov_b32 s16, s38
 s_mov_b32 s17, s39
 s_mov_b32 s18, 50331648
 s_mov_b32 s19, 0x00020000
 s_add_u32 s24, s38, 88080384
 s_addc_u32 s25, s39, 0
 s_mov_b32 s26, 83886080
 s_mov_b32 s27, 0x00020000
 s_load_dwordx2 s[72:73], s[0:1], 104
 s_waitcnt lgkmcnt(0)
 s_add_u32 s72, s72, 81068032
 s_addc_u32 s73, s73, 0
 s_mov_b32 s74, 129024
 s_mov_b32 s75, 0x00020000
 v_mov_b32 v29, 52429
 s_mul_i32 s21, s20, 960
 s_add_u32 s21, s21, 0
 v_add_u32 v21, s21, v1
 v_mul_u32_u24 v22, v21, v29
 v_lshrrev_b32 v22, 22, v22
 v_mul_u32_u24 v23, 80, v22
 v_sub_u32 v21, v21, v23
 v_bfe_u32 v23, v22, 3, 1
 v_and_b32 v24, 3, v22
 v_lshl_add_u32 v23, v23, 2, v24
 v_lshlrev_b32 v23, 1, v23
 v_xor_b32 v21, v21, v23
 v_cmp_gt_u32 vcc, 32, v22
 v_bfe_u32 v26, v22, 3, 2
 v_lshl_add_u32 v25, v26, 2, v24
 v_bfe_u32 v26, v22, 2, 1
 v_lshl_add_u32 v25, v26, 4, v25
 v_cndmask_b32 v25, v22, v25, vcc
 v_mul_u32_u24 v25, 1280, v25
 v_lshl_add_u32 v64, v21, 4, v25
 s_mul_i32 s21, s20, 960
 s_add_u32 s21, s21, 64
 v_add_u32 v21, s21, v1
 v_mul_u32_u24 v22, v21, v29
 v_lshrrev_b32 v22, 22, v22
 v_mul_u32_u24 v23, 80, v22
 v_sub_u32 v21, v21, v23
 v_bfe_u32 v23, v22, 3, 1
 v_and_b32 v24, 3, v22
 v_lshl_add_u32 v23, v23, 2, v24
 v_lshlrev_b32 v23, 1, v23
 v_xor_b32 v21, v21, v23
 v_cmp_gt_u32 vcc, 32, v22
 v_bfe_u32 v26, v22, 3, 2
 v_lshl_add_u32 v25, v26, 2, v24
 v_bfe_u32 v26, v22, 2, 1
 v_lshl_add_u32 v25, v26, 4, v25
 v_cndmask_b32 v25, v22, v25, vcc
 v_mul_u32_u24 v25, 1280, v25
 v_lshl_add_u32 v65, v21, 4, v25
 s_mul_i32 s21, s20, 960
 s_add_u32 s21, s21, 128
 v_add_u32 v21, s21, v1
 v_mul_u32_u24 v22, v21, v29
 v_lshrrev_b32 v22, 22, v22
 v_mul_u32_u24 v23, 80, v22
 v_sub_u32 v21, v21, v23
 v_bfe_u32 v23, v22, 3, 1
 v_and_b32 v24, 3, v22
 v_lshl_add_u32 v23, v23, 2, v24
 v_lshlrev_b32 v23, 1, v23
 v_xor_b32 v21, v21, v23
 v_cmp_gt_u32 vcc, 32, v22
 v_bfe_u32 v26, v22, 3, 2
 v_lshl_add_u32 v25, v26, 2, v24
 v_bfe_u32 v26, v22, 2, 1
 v_lshl_add_u32 v25, v26, 4, v25
 v_cndmask_b32 v25, v22, v25, vcc
 v_mul_u32_u24 v25, 1280, v25
 v_lshl_add_u32 v66, v21, 4, v25
 s_mul_i32 s21, s20, 960
 s_add_u32 s21, s21, 192
 v_add_u32 v21, s21, v1
 v_mul_u32_u24 v22, v21, v29
 v_lshrrev_b32 v22, 22, v22
 v_mul_u32_u24 v23, 80, v22
 v_sub_u32 v21, v21, v23
 v_bfe_u32 v23, v22, 3, 1
 v_and_b32 v24, 3, v22
 v_lshl_add_u32 v23, v23, 2, v24
 v_lshlrev_b32 v23, 1, v23
 v_xor_b32 v21, v21, v23
 v_cmp_gt_u32 vcc, 32, v22
 v_bfe_u32 v26, v22, 3, 2
 v_lshl_add_u32 v25, v26, 2, v24
 v_bfe_u32 v26, v22, 2, 1
 v_lshl_add_u32 v25, v26, 4, v25
 v_cndmask_b32 v25, v22, v25, vcc
 v_mul_u32_u24 v25, 1280, v25
 v_lshl_add_u32 v67, v21, 4, v25
 s_mul_i32 s21, s20, 960
 s_add_u32 s21, s21, 256
 v_add_u32 v21, s21, v1
 v_mul_u32_u24 v22, v21, v29
 v_lshrrev_b32 v22, 22, v22
 v_mul_u32_u24 v23, 80, v22
 v_sub_u32 v21, v21, v23
 v_bfe_u32 v23, v22, 3, 1
 v_and_b32 v24, 3, v22
 v_lshl_add_u32 v23, v23, 2, v24
 v_lshlrev_b32 v23, 1, v23
 v_xor_b32 v21, v21, v23
 v_cmp_gt_u32 vcc, 32, v22
 v_bfe_u32 v26, v22, 3, 2
 v_lshl_add_u32 v25, v26, 2, v24
 v_bfe_u32 v26, v22, 2, 1
 v_lshl_add_u32 v25, v26, 4, v25
 v_cndmask_b32 v25, v22, v25, vcc
 v_mul_u32_u24 v25, 1280, v25
 v_lshl_add_u32 v68, v21, 4, v25
 s_mul_i32 s21, s20, 960
 s_add_u32 s21, s21, 320
 v_add_u32 v21, s21, v1
 v_mul_u32_u24 v22, v21, v29
 v_lshrrev_b32 v22, 22, v22
 v_mul_u32_u24 v23, 80, v22
 v_sub_u32 v21, v21, v23
 v_bfe_u32 v23, v22, 3, 1
 v_and_b32 v24, 3, v22
 v_lshl_add_u32 v23, v23, 2, v24
 v_lshlrev_b32 v23, 1, v23
 v_xor_b32 v21, v21, v23
 v_cmp_gt_u32 vcc, 32, v22
 v_bfe_u32 v26, v22, 3, 2
 v_lshl_add_u32 v25, v26, 2, v24
 v_bfe_u32 v26, v22, 2, 1
 v_lshl_add_u32 v25, v26, 4, v25
 v_cndmask_b32 v25, v22, v25, vcc
 v_mul_u32_u24 v25, 1280, v25
 v_lshl_add_u32 v69, v21, 4, v25
 s_mul_i32 s21, s20, 960
 s_add_u32 s21, s21, 384
 v_add_u32 v21, s21, v1
 v_mul_u32_u24 v22, v21, v29
 v_lshrrev_b32 v22, 22, v22
 v_mul_u32_u24 v23, 80, v22
 v_sub_u32 v21, v21, v23
 v_bfe_u32 v23, v22, 3, 1
 v_and_b32 v24, 3, v22
 v_lshl_add_u32 v23, v23, 2, v24
 v_lshlrev_b32 v23, 1, v23
 v_xor_b32 v21, v21, v23
 v_cmp_gt_u32 vcc, 32, v22
 v_bfe_u32 v26, v22, 3, 2
 v_lshl_add_u32 v25, v26, 2, v24
 v_bfe_u32 v26, v22, 2, 1
 v_lshl_add_u32 v25, v26, 4, v25
 v_cndmask_b32 v25, v22, v25, vcc
 v_mul_u32_u24 v25, 1280, v25
 v_lshl_add_u32 v70, v21, 4, v25
 s_mul_i32 s21, s20, 960
 s_add_u32 s21, s21, 448
 v_add_u32 v21, s21, v1
 v_mul_u32_u24 v22, v21, v29
 v_lshrrev_b32 v22, 22, v22
 v_mul_u32_u24 v23, 80, v22
 v_sub_u32 v21, v21, v23
 v_bfe_u32 v23, v22, 3, 1
 v_and_b32 v24, 3, v22
 v_lshl_add_u32 v23, v23, 2, v24
 v_lshlrev_b32 v23, 1, v23
 v_xor_b32 v21, v21, v23
 v_cmp_gt_u32 vcc, 32, v22
 v_bfe_u32 v26, v22, 3, 2
 v_lshl_add_u32 v25, v26, 2, v24
 v_bfe_u32 v26, v22, 2, 1
 v_lshl_add_u32 v25, v26, 4, v25
 v_cndmask_b32 v25, v22, v25, vcc
 v_mul_u32_u24 v25, 1280, v25
 v_lshl_add_u32 v71, v21, 4, v25
 s_mul_i32 s21, s20, 960
 s_add_u32 s21, s21, 512
 v_add_u32 v21, s21, v1
 v_mul_u32_u24 v22, v21, v29
 v_lshrrev_b32 v22, 22, v22
 v_mul_u32_u24 v23, 80, v22
 v_sub_u32 v21, v21, v23
 v_bfe_u32 v23, v22, 3, 1
 v_and_b32 v24, 3, v22
 v_lshl_add_u32 v23, v23, 2, v24
 v_lshlrev_b32 v23, 1, v23
 v_xor_b32 v21, v21, v23
 v_cmp_gt_u32 vcc, 32, v22
 v_bfe_u32 v26, v22, 3, 2
 v_lshl_add_u32 v25, v26, 2, v24
 v_bfe_u32 v26, v22, 2, 1
 v_lshl_add_u32 v25, v26, 4, v25
 v_cndmask_b32 v25, v22, v25, vcc
 v_mul_u32_u24 v25, 1280, v25
 v_lshl_add_u32 v72, v21, 4, v25
 s_mul_i32 s21, s20, 960
 s_add_u32 s21, s21, 576
 v_add_u32 v21, s21, v1
 v_mul_u32_u24 v22, v21, v29
 v_lshrrev_b32 v22, 22, v22
 v_mul_u32_u24 v23, 80, v22
 v_sub_u32 v21, v21, v23
 v_bfe_u32 v23, v22, 3, 1
 v_and_b32 v24, 3, v22
 v_lshl_add_u32 v23, v23, 2, v24
 v_lshlrev_b32 v23, 1, v23
 v_xor_b32 v21, v21, v23
 v_cmp_gt_u32 vcc, 32, v22
 v_bfe_u32 v26, v22, 3, 2
 v_lshl_add_u32 v25, v26, 2, v24
 v_bfe_u32 v26, v22, 2, 1
 v_lshl_add_u32 v25, v26, 4, v25
 v_cndmask_b32 v25, v22, v25, vcc
 v_mul_u32_u24 v25, 1280, v25
 v_lshl_add_u32 v73, v21, 4, v25
 s_mul_i32 s21, s20, 960
 s_add_u32 s21, s21, 640
 v_add_u32 v21, s21, v1
 v_mul_u32_u24 v22, v21, v29
 v_lshrrev_b32 v22, 22, v22
 v_mul_u32_u24 v23, 80, v22
 v_sub_u32 v21, v21, v23
 v_bfe_u32 v23, v22, 3, 1
 v_and_b32 v24, 3, v22
 v_lshl_add_u32 v23, v23, 2, v24
 v_lshlrev_b32 v23, 1, v23
 v_xor_b32 v21, v21, v23
 v_cmp_gt_u32 vcc, 32, v22
 v_bfe_u32 v26, v22, 3, 2
 v_lshl_add_u32 v25, v26, 2, v24
 v_bfe_u32 v26, v22, 2, 1
 v_lshl_add_u32 v25, v26, 4, v25
 v_cndmask_b32 v25, v22, v25, vcc
 v_mul_u32_u24 v25, 1280, v25
 v_lshl_add_u32 v74, v21, 4, v25
 s_mul_i32 s21, s20, 960
 s_add_u32 s21, s21, 704
 v_add_u32 v21, s21, v1
 v_mul_u32_u24 v22, v21, v29
 v_lshrrev_b32 v22, 22, v22
 v_mul_u32_u24 v23, 80, v22
 v_sub_u32 v21, v21, v23
 v_bfe_u32 v23, v22, 3, 1
 v_and_b32 v24, 3, v22
 v_lshl_add_u32 v23, v23, 2, v24
 v_lshlrev_b32 v23, 1, v23
 v_xor_b32 v21, v21, v23
 v_cmp_gt_u32 vcc, 32, v22
 v_bfe_u32 v26, v22, 3, 2
 v_lshl_add_u32 v25, v26, 2, v24
 v_bfe_u32 v26, v22, 2, 1
 v_lshl_add_u32 v25, v26, 4, v25
 v_cndmask_b32 v25, v22, v25, vcc
 v_mul_u32_u24 v25, 1280, v25
 v_lshl_add_u32 v75, v21, 4, v25
 s_mul_i32 s21, s20, 960
 s_add_u32 s21, s21, 768
 v_add_u32 v21, s21, v1
 v_mul_u32_u24 v22, v21, v29
 v_lshrrev_b32 v22, 22, v22
 v_mul_u32_u24 v23, 80, v22
 v_sub_u32 v21, v21, v23
 v_bfe_u32 v23, v22, 3, 1
 v_and_b32 v24, 3, v22
 v_lshl_add_u32 v23, v23, 2, v24
 v_lshlrev_b32 v23, 1, v23
 v_xor_b32 v21, v21, v23
 v_cmp_gt_u32 vcc, 32, v22
 v_bfe_u32 v26, v22, 3, 2
 v_lshl_add_u32 v25, v26, 2, v24
 v_bfe_u32 v26, v22, 2, 1
 v_lshl_add_u32 v25, v26, 4, v25
 v_cndmask_b32 v25, v22, v25, vcc
 v_mul_u32_u24 v25, 1280, v25
 v_lshl_add_u32 v76, v21, 4, v25
 s_mul_i32 s21, s20, 960
 s_add_u32 s21, s21, 832
 v_add_u32 v21, s21, v1
 v_mul_u32_u24 v22, v21, v29
 v_lshrrev_b32 v22, 22, v22
 v_mul_u32_u24 v23, 80, v22
 v_sub_u32 v21, v21, v23
 v_bfe_u32 v23, v22, 3, 1
 v_and_b32 v24, 3, v22
 v_lshl_add_u32 v23, v23, 2, v24
 v_lshlrev_b32 v23, 1, v23
 v_xor_b32 v21, v21, v23
 v_cmp_gt_u32 vcc, 32, v22
 v_bfe_u32 v26, v22, 3, 2
 v_lshl_add_u32 v25, v26, 2, v24
 v_bfe_u32 v26, v22, 2, 1
 v_lshl_add_u32 v25, v26, 4, v25
 v_cndmask_b32 v25, v22, v25, vcc
 v_mul_u32_u24 v25, 1280, v25
 v_lshl_add_u32 v77, v21, 4, v25
 s_mul_i32 s21, s20, 960
 s_add_u32 s21, s21, 896
 v_add_u32 v21, s21, v1
 v_mul_u32_u24 v22, v21, v29
 v_lshrrev_b32 v22, 22, v22
 v_mul_u32_u24 v23, 80, v22
 v_sub_u32 v21, v21, v23
 v_bfe_u32 v23, v22, 3, 1
 v_and_b32 v24, 3, v22
 v_lshl_add_u32 v23, v23, 2, v24
 v_lshlrev_b32 v23, 1, v23
 v_xor_b32 v21, v21, v23
 v_cmp_gt_u32 vcc, 32, v22
 v_bfe_u32 v26, v22, 3, 2
 v_lshl_add_u32 v25, v26, 2, v24
 v_bfe_u32 v26, v22, 2, 1
 v_lshl_add_u32 v25, v26, 4, v25
 v_cndmask_b32 v25, v22, v25, vcc
 v_mul_u32_u24 v25, 1280, v25
 v_lshl_add_u32 v78, v21, 4, v25
 s_mul_i32 s40, s2, 245760
 s_add_u32 s21, s40, 0
 s_mul_i32 s22, s20, 15360
 s_add_u32 s22, s22, 0
 s_add_u32 m0, s22, 0
 s_nop 0
 buffer_load_dwordx4 v64, s[12:15], s21 offen lds
 s_add_u32 m0, s22, 1024
 s_nop 0
 buffer_load_dwordx4 v65, s[12:15], s21 offen lds
 s_add_u32 m0, s22, 2048
 s_nop 0
 buffer_load_dwordx4 v66, s[12:15], s21 offen lds
 s_add_u32 m0, s22, 3072
 s_nop 0
 buffer_load_dwordx4 v67, s[12:15], s21 offen lds
 s_add_u32 m0, s22, 4096
 s_nop 0
 buffer_load_dwordx4 v68, s[12:15], s21 offen lds
 s_add_u32 m0, s22, 5120
 s_nop 0
 buffer_load_dwordx4 v69, s[12:15], s21 offen lds
 s_add_u32 m0, s22, 6144
 s_nop 0
 buffer_load_dwordx4 v70, s[12:15], s21 offen lds
 s_add_u32 m0, s22, 7168
 s_nop 0
 buffer_load_dwordx4 v71, s[12:15], s21 offen lds
 s_add_u32 m0, s22, 8192
 s_nop 0
 buffer_load_dwordx4 v72, s[12:15], s21 offen lds
 s_add_u32 m0, s22, 9216
 s_nop 0
 buffer_load_dwordx4 v73, s[12:15], s21 offen lds
 s_add_u32 m0, s22, 10240
 s_nop 0
 buffer_load_dwordx4 v74, s[12:15], s21 offen lds
 s_add_u32 m0, s22, 11264
 s_nop 0
 buffer_load_dwordx4 v75, s[12:15], s21 offen lds
 s_add_u32 m0, s22, 12288
 s_nop 0
 buffer_load_dwordx4 v76, s[12:15], s21 offen lds
 s_add_u32 m0, s22, 13312
 s_nop 0
 buffer_load_dwordx4 v77, s[12:15], s21 offen lds
 s_add_u32 m0, s22, 14336
 s_nop 0
 buffer_load_dwordx4 v78, s[12:15], s21 offen lds
 s_add_u32 s21, s40, 61440
 s_mul_i32 s22, s20, 15360
 s_add_u32 s22, s22, 61440
 s_add_u32 m0, s22, 0
 s_nop 0
 buffer_load_dwordx4 v64, s[12:15], s21 offen lds
 s_add_u32 m0, s22, 1024
 s_nop 0
 buffer_load_dwordx4 v65, s[12:15], s21 offen lds
 s_add_u32 m0, s22, 2048
 s_nop 0
 buffer_load_dwordx4 v66, s[12:15], s21 offen lds
 s_add_u32 m0, s22, 3072
 s_nop 0
 buffer_load_dwordx4 v67, s[12:15], s21 offen lds
 s_add_u32 m0, s22, 4096
 s_nop 0
 buffer_load_dwordx4 v68, s[12:15], s21 offen lds
 s_add_u32 m0, s22, 5120
 s_nop 0
 buffer_load_dwordx4 v69, s[12:15], s21 offen lds
 s_add_u32 m0, s22, 6144
 s_nop 0
 buffer_load_dwordx4 v70, s[12:15], s21 offen lds
 s_add_u32 m0, s22, 7168
 s_nop 0
 buffer_load_dwordx4 v71, s[12:15], s21 offen lds
 s_add_u32 m0, s22, 8192
 s_nop 0
 buffer_load_dwordx4 v72, s[12:15], s21 offen lds
 s_add_u32 m0, s22, 9216
 s_nop 0
 buffer_load_dwordx4 v73, s[12:15], s21 offen lds
 s_add_u32 m0, s22, 10240
 s_nop 0
 buffer_load_dwordx4 v74, s[12:15], s21 offen lds
 s_add_u32 m0, s22, 11264
 s_nop 0
 buffer_load_dwordx4 v75, s[12:15], s21 offen lds
 s_add_u32 m0, s22, 12288
 s_nop 0
 buffer_load_dwordx4 v76, s[12:15], s21 offen lds
 s_add_u32 m0, s22, 13312
 s_nop 0
 buffer_load_dwordx4 v77, s[12:15], s21 offen lds
 s_add_u32 m0, s22, 14336
 s_nop 0
 buffer_load_dwordx4 v78, s[12:15], s21 offen lds
 s_add_u32 s21, s40, 122880
 s_mul_i32 s22, s20, 15360
 s_add_u32 s22, s22, 0
 buffer_load_dwordx4 v[80:83], v64, s[12:15], s21 offen
 buffer_load_dwordx4 v[84:87], v65, s[12:15], s21 offen
 buffer_load_dwordx4 v[88:91], v66, s[12:15], s21 offen
 buffer_load_dwordx4 v[92:95], v67, s[12:15], s21 offen
 buffer_load_dwordx4 v[96:99], v68, s[12:15], s21 offen
 buffer_load_dwordx4 v[100:103], v69, s[12:15], s21 offen
 buffer_load_dwordx4 v[104:107], v70, s[12:15], s21 offen
 buffer_load_dwordx4 v[108:111], v71, s[12:15], s21 offen
 buffer_load_dwordx4 v[112:115], v72, s[12:15], s21 offen
 buffer_load_dwordx4 v[116:119], v73, s[12:15], s21 offen
 buffer_load_dwordx4 v[120:123], v74, s[12:15], s21 offen
 buffer_load_dwordx4 v[124:127], v75, s[12:15], s21 offen
 buffer_load_dwordx4 v[128:131], v76, s[12:15], s21 offen
 buffer_load_dwordx4 v[132:135], v77, s[12:15], s21 offen
 buffer_load_dwordx4 v[136:139], v78, s[12:15], s21 offen
 s_add_u32 s21, s40, 184320
 s_mul_i32 s22, s20, 15360
 s_add_u32 s22, s22, 61440
 buffer_load_dwordx4 v[140:143], v64, s[12:15], s21 offen
 buffer_load_dwordx4 v[144:147], v65, s[12:15], s21 offen
 buffer_load_dwordx4 v[148:151], v66, s[12:15], s21 offen
 buffer_load_dwordx4 v[152:155], v67, s[12:15], s21 offen
 buffer_load_dwordx4 v[156:159], v68, s[12:15], s21 offen
 buffer_load_dwordx4 v[160:163], v69, s[12:15], s21 offen
 buffer_load_dwordx4 v[164:167], v70, s[12:15], s21 offen
 buffer_load_dwordx4 v[168:171], v71, s[12:15], s21 offen
 buffer_load_dwordx4 v[172:175], v72, s[12:15], s21 offen
 buffer_load_dwordx4 v[176:179], v73, s[12:15], s21 offen
 buffer_load_dwordx4 v[180:183], v74, s[12:15], s21 offen
 buffer_load_dwordx4 v[184:187], v75, s[12:15], s21 offen
 buffer_load_dwordx4 v[188:191], v76, s[12:15], s21 offen
 buffer_load_dwordx4 v[192:195], v77, s[12:15], s21 offen
 buffer_load_dwordx4 v[196:199], v78, s[12:15], s21 offen
 v_lshrrev_b32 v6, 2, v2
 v_lshl_add_u32 v7, v3, 3, v6
 v_mul_u32_u24 v7, 1280, v7
 v_and_b32 v8, 1, v2
 v_lshl_add_u32 v7, v8, 3, v7
 v_and_b32 v8, 1, v3
 v_lshl_add_u32 v6, v8, 2, v6
 v_lshlrev_b32 v6, 1, v6
 v_bfe_u32 v8, v2, 1, 1
 s_mul_i32 s21, s20, 20
 v_add_u32 v8, s21, v8
 v_add_u32 v5, 0, v8
 v_xor_b32 v5, v5, v6
 v_lshl_add_u32 v200, v5, 4, v7
 v_add_u32 v210, 81920, v200
 v_add_u32 v5, 2, v8
 v_xor_b32 v5, v5, v6
 v_lshl_add_u32 v201, v5, 4, v7
 v_add_u32 v211, 81920, v201
 v_add_u32 v5, 4, v8
 v_xor_b32 v5, v5, v6
 v_lshl_add_u32 v202, v5, 4, v7
 v_add_u32 v212, 81920, v202
 v_add_u32 v5, 6, v8
 v_xor_b32 v5, v5, v6
 v_lshl_add_u32 v203, v5, 4, v7
 v_add_u32 v213, 81920, v203
 v_add_u32 v5, 8, v8
 v_xor_b32 v5, v5, v6
 v_lshl_add_u32 v204, v5, 4, v7
 v_add_u32 v214, 81920, v204
 v_add_u32 v5, 10, v8
 v_xor_b32 v5, v5, v6
 v_lshl_add_u32 v205, v5, 4, v7
 v_add_u32 v215, 81920, v205
 v_add_u32 v5, 12, v8
 v_xor_b32 v5, v5, v6
 v_lshl_add_u32 v206, v5, 4, v7
 v_add_u32 v216, 81920, v206
 v_add_u32 v5, 14, v8
 v_xor_b32 v5, v5, v6
 v_lshl_add_u32 v207, v5, 4, v7
 v_add_u32 v217, 81920, v207
 v_add_u32 v5, 16, v8
 v_xor_b32 v5, v5, v6
 v_lshl_add_u32 v208, v5, 4, v7
 v_add_u32 v218, 81920, v208
 v_add_u32 v5, 18, v8
 v_xor_b32 v5, v5, v6
 v_lshl_add_u32 v209, v5, 4, v7
 v_add_u32 v219, 81920, v209
 s_lshl_b32 s21, s2, 1
 s_lshr_b32 s22, s20, 1
 s_add_u32 s21, s21, s22
 s_lshl_b32 s21, s21, 20
 s_and_b32 s22, s20, 1
 s_mul_i32 s22, s22, 49152
 s_add_u32 s21, s21, s22
 s_add_u32 s21, s21, 7168
 s_add_u32 s21, s21, 181305344
 s_add_u32 s50, s38, s21
 s_addc_u32 s51, s39, 0
 s_mov_b32 s52, -1
 s_mov_b32 s53, -1
 s_mov_b32 s54, 0
cal_141:
 s_memtime s[98:99]
 s_waitcnt lgkmcnt(0)
 s_load_dword s55, s[50:51], 0
 s_waitcnt lgkmcnt(0)
 s_memtime s[100:101]
 s_waitcnt lgkmcnt(0)
 s_sub_u32 s21, s100, s98
 s_min_u32 s52, s52, s21
 s_memtime s[98:99]
 s_waitcnt lgkmcnt(0)
 s_load_dword s55, s[50:51], 8192
 s_waitcnt lgkmcnt(0)
 s_memtime s[100:101]
 s_waitcnt lgkmcnt(0)
 s_sub_u32 s21, s100, s98
 s_min_u32 s53, s53, s21
 s_add_u32 s50, s50, 16640
 s_addc_u32 s51, s51, 0
 s_add_u32 s54, s54, 1
 s_cmp_lt_u32 s54, 3
 s_cbranch_scc1 cal_141
 s_lshl_b32 s21, s20, 2
 s_add_u32 s21, s21, 160000
 v_mov_b32 v28, s21
 v_mov_b32 v24, s52
 v_mov_b32 v25, s53
 ds_write_b32 v28, v24
 ds_write_b32 v28, v25 offset:16
 s_waitcnt lgkmcnt(0)
cal_140:
 s_mul_i32 s22, s20, 15360
 v_lshl_add_u32 v30, v1, 4, s22
 v_add_u32 v31, 61440, v30
 s_waitcnt vmcnt(30)
 s_barrier
 s_cmp_lg_u32 s20, 3
 s_cbranch_scc1 cal_142
 v_mov_b32 v28, 160000
 ds_read_b128 v[20:23], v28
 ds_read_b128 v[24:27], v28 offset:16
 s_waitcnt lgkmcnt(0)
 v_min3_u32 v20, v20, v21, v22
 v_min3_u32 v24, v24, v25, v26
 v_min_u32 v25, v20, v23
 v_min_u32 v26, v24, v27
 v_cmp_lt_u32 vcc, v26, v25
 v_mov_b32 v28, s2
 s_nop 0
 v_cndmask_b32 v24, 1, 2, vcc
 s_mov_b64 exec, 1
 buffer_store_byte v24, v28, s[32:35], 0 offen offset:160 sc1
 s_mov_b64 exec, -1
cal_142:
 ds_read_b64_tr_b16 a[0:1], v200 offset:0
 ds_read_b64_tr_b16 a[2:3], v200 offset:5120
 ds_read_b64_tr_b16 a[24:25], v201 offset:0
 ds_read_b64_tr_b16 a[26:27], v201 offset:5120
 ds_read_b64_tr_b16 a[48:49], v202 offset:0
 ds_read_b64_tr_b16 a[50:51], v202 offset:5120
 ds_read_b64_tr_b16 a[72:73], v203 offset:0
 ds_read_b64_tr_b16 a[74:75], v203 offset:5120
 ds_read_b64_tr_b16 a[96:97], v204 offset:0
 ds_read_b64_tr_b16 a[98:99], v204 offset:5120
 ds_read_b64_tr_b16 a[120:121], v205 offset:0
 ds_read_b64_tr_b16 a[122:123], v205 offset:5120
 ds_read_b64_tr_b16 a[144:145], v206 offset:0
 ds_read_b64_tr_b16 a[146:147], v206 offset:5120
 ds_read_b64_tr_b16 a[168:169], v207 offset:0
 ds_read_b64_tr_b16 a[170:171], v207 offset:5120
 ds_read_b64_tr_b16 a[192:193], v208 offset:0
 ds_read_b64_tr_b16 a[194:195], v208 offset:5120
 ds_read_b64_tr_b16 a[216:217], v209 offset:0
 ds_read_b64_tr_b16 a[218:219], v209 offset:5120
 ds_read_b64_tr_b16 a[4:5], v200 offset:40960
 ds_read_b64_tr_b16 a[6:7], v200 offset:46080
 ds_read_b64_tr_b16 a[28:29], v201 offset:40960
 ds_read_b64_tr_b16 a[30:31], v201 offset:46080
 ds_read_b64_tr_b16 a[52:53], v202 offset:40960
 ds_read_b64_tr_b16 a[54:55], v202 offset:46080
 ds_read_b64_tr_b16 a[76:77], v203 offset:40960
 ds_read_b64_tr_b16 a[78:79], v203 offset:46080
 ds_read_b64_tr_b16 a[100:101], v204 offset:40960
 ds_read_b64_tr_b16 a[102:103], v204 offset:46080
 ds_read_b64_tr_b16 a[124:125], v205 offset:40960
 ds_read_b64_tr_b16 a[126:127], v205 offset:46080
 ds_read_b64_tr_b16 a[148:149], v206 offset:40960
 ds_read_b64_tr_b16 a[150:151], v206 offset:46080
 ds_read_b64_tr_b16 a[172:173], v207 offset:40960
 ds_read_b64_tr_b16 a[174:175], v207 offset:46080
 ds_read_b64_tr_b16 a[196:197], v208 offset:40960
 ds_read_b64_tr_b16 a[198:199], v208 offset:46080
 ds_read_b64_tr_b16 a[220:221], v209 offset:40960
 ds_read_b64_tr_b16 a[222:223], v209 offset:46080
 ds_read_b64_tr_b16 a[8:9], v210 offset:0
 ds_read_b64_tr_b16 a[10:11], v210 offset:5120
 ds_read_b64_tr_b16 a[32:33], v211 offset:0
 ds_read_b64_tr_b16 a[34:35], v211 offset:5120
 ds_read_b64_tr_b16 a[56:57], v212 offset:0
 ds_read_b64_tr_b16 a[58:59], v212 offset:5120
 ds_read_b64_tr_b16 a[80:81], v213 offset:0
 ds_read_b64_tr_b16 a[82:83], v213 offset:5120
 ds_read_b64_tr_b16 a[104:105], v214 offset:0
 ds_read_b64_tr_b16 a[106:107], v214 offset:5120
 ds_read_b64_tr_b16 a[128:129], v215 offset:0
 ds_read_b64_tr_b16 a[130:131], v215 offset:5120
 ds_read_b64_tr_b16 a[152:153], v216 offset:0
 ds_read_b64_tr_b16 a[154:155], v216 offset:5120
 ds_read_b64_tr_b16 a[176:177], v217 offset:0
 ds_read_b64_tr_b16 a[178:179], v217 offset:5120
 ds_read_b64_tr_b16 a[200:201], v218 offset:0
 ds_read_b64_tr_b16 a[202:203], v218 offset:5120
 ds_read_b64_tr_b16 a[224:225], v219 offset:0
 ds_read_b64_tr_b16 a[226:227], v219 offset:5120
 s_waitcnt lgkmcnt(0)
 s_barrier
 s_waitcnt vmcnt(15)
 ds_write_b128 v30, v[80:83] offset:0
 ds_write_b128 v30, v[84:87] offset:1024
 ds_write_b128 v30, v[88:91] offset:2048
 ds_write_b128 v30, v[92:95] offset:3072
 ds_write_b128 v30, v[96:99] offset:4096
 ds_write_b128 v30, v[100:103] offset:5120
 ds_write_b128 v30, v[104:107] offset:6144
 ds_write_b128 v30, v[108:111] offset:7168
 ds_write_b128 v30, v[112:115] offset:8192
 ds_write_b128 v30, v[116:119] offset:9216
 ds_write_b128 v30, v[120:123] offset:10240
 ds_write_b128 v30, v[124:127] offset:11264
 ds_write_b128 v30, v[128:131] offset:12288
 ds_write_b128 v30, v[132:135] offset:13312
 ds_write_b128 v30, v[136:139] offset:14336
 s_waitcnt vmcnt(0)
 ds_write_b128 v31, v[140:143] offset:0
 ds_write_b128 v31, v[144:147] offset:1024
 ds_write_b128 v31, v[148:151] offset:2048
 ds_write_b128 v31, v[152:155] offset:3072
 ds_write_b128 v31, v[156:159] offset:4096
 ds_write_b128 v31, v[160:163] offset:5120
 ds_write_b128 v31, v[164:167] offset:6144
 ds_write_b128 v31, v[168:171] offset:7168
 ds_write_b128 v31, v[172:175] offset:8192
 ds_write_b128 v31, v[176:179] offset:9216
 ds_write_b128 v31, v[180:183] offset:10240
 ds_write_b128 v31, v[184:187] offset:11264
 ds_write_b128 v31, v[188:191] offset:12288
 ds_write_b128 v31, v[192:195] offset:13312
 ds_write_b128 v31, v[196:199] offset:14336
 s_waitcnt lgkmcnt(0)
 s_barrier
 ds_read_b64_tr_b16 a[12:13], v200 offset:0
 ds_read_b64_tr_b16 a[14:15], v200 offset:5120
 ds_read_b64_tr_b16 a[36:37], v201 offset:0
 ds_read_b64_tr_b16 a[38:39], v201 offset:5120
 ds_read_b64_tr_b16 a[60:61], v202 offset:0
 ds_read_b64_tr_b16 a[62:63], v202 offset:5120
 ds_read_b64_tr_b16 a[84:85], v203 offset:0
 ds_read_b64_tr_b16 a[86:87], v203 offset:5120
 ds_read_b64_tr_b16 a[108:109], v204 offset:0
 ds_read_b64_tr_b16 a[110:111], v204 offset:5120
 ds_read_b64_tr_b16 a[132:133], v205 offset:0
 ds_read_b64_tr_b16 a[134:135], v205 offset:5120
 ds_read_b64_tr_b16 a[156:157], v206 offset:0
 ds_read_b64_tr_b16 a[158:159], v206 offset:5120
 ds_read_b64_tr_b16 a[180:181], v207 offset:0
 ds_read_b64_tr_b16 a[182:183], v207 offset:5120
 ds_read_b64_tr_b16 a[204:205], v208 offset:0
 ds_read_b64_tr_b16 a[206:207], v208 offset:5120
 ds_read_b64_tr_b16 a[228:229], v209 offset:0
 ds_read_b64_tr_b16 a[230:231], v209 offset:5120
 ds_read_b64_tr_b16 a[16:17], v200 offset:40960
 ds_read_b64_tr_b16 a[18:19], v200 offset:46080
 ds_read_b64_tr_b16 a[40:41], v201 offset:40960
 ds_read_b64_tr_b16 a[42:43], v201 offset:46080
 ds_read_b64_tr_b16 a[64:65], v202 offset:40960
 ds_read_b64_tr_b16 a[66:67], v202 offset:46080
 ds_read_b64_tr_b16 a[88:89], v203 offset:40960
 ds_read_b64_tr_b16 a[90:91], v203 offset:46080
 ds_read_b64_tr_b16 a[112:113], v204 offset:40960
 ds_read_b64_tr_b16 a[114:115], v204 offset:46080
 ds_read_b64_tr_b16 a[136:137], v205 offset:40960
 ds_read_b64_tr_b16 a[138:139], v205 offset:46080
 ds_read_b64_tr_b16 a[160:161], v206 offset:40960
 ds_read_b64_tr_b16 a[162:163], v206 offset:46080
 ds_read_b64_tr_b16 a[184:185], v207 offset:40960
 ds_read_b64_tr_b16 a[186:187], v207 offset:46080
 ds_read_b64_tr_b16 a[208:209], v208 offset:40960
 ds_read_b64_tr_b16 a[210:211], v208 offset:46080
 ds_read_b64_tr_b16 a[232:233], v209 offset:40960
 ds_read_b64_tr_b16 a[234:235], v209 offset:46080
 ds_read_b64_tr_b16 a[20:21], v210 offset:0
 ds_read_b64_tr_b16 a[22:23], v210 offset:5120
 ds_read_b64_tr_b16 a[44:45], v211 offset:0
 ds_read_b64_tr_b16 a[46:47], v211 offset:5120
 ds_read_b64_tr_b16 a[68:69], v212 offset:0
 ds_read_b64_tr_b16 a[70:71], v212 offset:5120
 ds_read_b64_tr_b16 a[92:93], v213 offset:0
 ds_read_b64_tr_b16 a[94:95], v213 offset:5120
 ds_read_b64_tr_b16 a[116:117], v214 offset:0
 ds_read_b64_tr_b16 a[118:119], v214 offset:5120
 ds_read_b64_tr_b16 a[140:141], v215 offset:0
 ds_read_b64_tr_b16 a[142:143], v215 offset:5120
 ds_read_b64_tr_b16 a[164:165], v216 offset:0
 ds_read_b64_tr_b16 a[166:167], v216 offset:5120
 ds_read_b64_tr_b16 a[188:189], v217 offset:0
 ds_read_b64_tr_b16 a[190:191], v217 offset:5120
 ds_read_b64_tr_b16 a[212:213], v218 offset:0
 ds_read_b64_tr_b16 a[214:215], v218 offset:5120
 ds_read_b64_tr_b16 a[236:237], v219 offset:0
 ds_read_b64_tr_b16 a[238:239], v219 offset:5120
 s_waitcnt lgkmcnt(0)
 s_barrier
 s_load_dwordx2 s[32:33], s[0:1], 96
 s_waitcnt lgkmcnt(0)
 s_mov_b32 s32, s32
 s_mov_b32 s33, s33
 s_mov_b32 s34, 256
 s_mov_b32 s35, 0x00020000
 s_mov_b32 s21, 76
 s_cmp_lg_u32 s20, 0
 s_cbranch_scc1 wf_144
 v_mov_b32 v4, 0
 s_mov_b32 s101, 0
wf_143:
 buffer_load_dword v5, v4, s[32:35], s21 offen sc1
 s_add_u32 s101, s101, 1
 s_cmp_gt_u32 s101, 131072
 s_cbranch_scc1 main_end
 s_waitcnt vmcnt(0)
 v_readfirstlane_b32 s100, v5
 s_cmp_ge_u32 s100, 32
 s_cbranch_scc1 wf_144
 s_sleep 8
 s_branch wf_143
wf_144:
 s_barrier
 s_mov_b32 s21, 91136
 s_cmp_lg_u32 s20, 0
 s_cbranch_scc1 af_145
 v_mov_b32 v4, 0
 v_mov_b32 v5, 1
 s_mov_b64 exec, 1
 buffer_atomic_add v5, v4, s[72:75], s21 offen sc1
 s_mov_b64 exec, -1
 s_nop 1
af_145:
 s_mul_i32 s41, s2, 12288
 s_add_u32 s47, s41, 25165824
 s_mov_b32 s41, s47
 s_mul_i32 s21, s20, 10
 s_mul_i32 s47, s2, 5
 s_lshr_b32 s22, s21, 3
 s_add_u32 s47, s47, s22
 s_and_b32 s48, s21, 7
 s_mov_b32 s66, 0
 s_mov_b32 s67, 0
 s_lshr_b32 s43, s2, 2
 s_lshl_b32 s43, s43, 7
 s_add_u32 s43, s43, 0
 s_lshl_b32 s44, s2, 7
 s_lshl_b32 s21, s20, 12
 s_add_u32 s44, s44, s21
 s_add_u32 s44, s44, 95232
 s_mov_b32 s45, 0
 s_mov_b32 s49, 1
 s_mov_b32 s50, 0
 v_mov_b32 v10, 0
 v_mov_b32 v11, 1
 v_lshlrev_b32 v4, 4, v1
 s_add_u32 s76, s38, 56623104
 s_addc_u32 s77, s39, 0
 s_mov_b32 s78, 6291456
 s_mov_b32 s79, 0x00020000
 s_add_u32 s80, s38, 101711872
 s_addc_u32 s81, s39, 0
 s_mov_b32 s82, 20971520
 s_mov_b32 s83, 0x00020000
 v_and_b32 v12, 3, v1
 v_lshlrev_b32 v12, 3, v12
 v_add_u32 v12, 4, v12
 v_and_b32 v13, 7, v2
 v_lshlrev_b32 v13, 4, v13
 v_lshl_add_u32 v13, v3, 7, v13
 v_lshrrev_b32 v14, 3, v2
 v_mul_u32_u24 v14, 98304, v14
 v_add_u32 v14, v14, v13
 v_and_b32 v15, 1, v3
 v_lshlrev_b32 v15, 8, v15
 v_lshl_add_u32 v15, v2, 4, v15
 v_lshrrev_b32 v16, 1, v3
 v_mul_u32_u24 v16, 327680, v16
 v_add_u32 v15, v15, v16
 v_lshlrev_b32 v17, 10, v1
 v_mov_b32 v19, 0
 s_lshl_b32 s53, s2, 7
 s_add_u32 s53, s53, 19456
 s_mov_b32 s55, 0
 s_mov_b32 s56, 0
 s_mov_b32 s58, 0
 s_mov_b32 s59, 0
 s_add_u32 s84, s38, 50331648
 s_addc_u32 s85, s39, 0
 s_mov_b32 s86, 12582912
 s_mov_b32 s87, 0x00020000
 s_and_b32 s21, s2, 3
 s_mul_i32 s51, s2, 3072
 s_cmp_eq_u32 s21, s20
 s_cselect_b32 s51, s51, 6291456
 v_mov_b32 v244, -1
 v_mov_b32 v245, -1
 v_mov_b32 v246, -1
 v_mov_b32 v247, -1
 s_add_u32 s88, s38, 180355072
 s_addc_u32 s89, s39, 0
 s_mov_b32 s90, 67108864
 s_mov_b32 s91, 0x00020000
 s_mul_i32 s21, s20, 3072
 s_add_u32 s41, s41, s21
 s_mov_b32 s64, s21
 s_add_u32 s67, s21, 98304
 s_mov_b32 s71, s21
 s_mov_b32 s46, 0
 s_mov_b32 s47, 0
 s_mov_b32 s65, 0
 s_mul_i32 s42, s2, 40960
 s_mul_i32 s21, s20, 10240
 s_add_u32 s42, s42, s21
 s_mov_b32 s68, 0x80000000
 s_mov_b32 s70, 0
 s_mov_b32 s40, 0
 s_mov_b32 s31, 0
 s_mov_b32 s56, s68
 s_mov_b32 s57, s68
 s_lshl_b32 s59, s20, 1
 s_sub_u32 s59, 8, s59
 s_add_u32 s61, s28, 9216
 v_min_u32 v5, 18, v1
 v_lshlrev_b32 v5, 10, v5
 v_mov_b32 v9, 0
 s_lshl_b32 s21, s20, 2
 s_add_u32 s21, s21, 110592
 v_mov_b32 v6, s21
 v_mov_b32 v7, 110592
 s_mul_i32 s51, s2, 3072
 s_lshl_b32 s21, s20, 10
 s_add_u32 s51, s51, s21
 s_cmp_lt_u32 s20, 3
 s_cselect_b32 s51, s51, 6291456
 s_add_u32 s51, s51, 5505024
 s_cmp_lg_u32 s20, 0
 s_cbranch_scc1 wf_147
 v_mov_b32 v20, 0
 s_mov_b32 s101, 0
wf_146:
 buffer_load_dword v21, v20, s[72:75], s43 offen sc1
 s_add_u32 s101, s101, 1
 s_cmp_gt_u32 s101, 131072
 s_cbranch_scc1 main_end
 s_waitcnt vmcnt(0)
 v_readfirstlane_b32 s100, v21
 s_cmp_ge_u32 s100, 8
 s_cbranch_scc1 wf_147
 s_sleep 4
 s_branch wf_146
wf_147:
 s_barrier
 v_writelane_b32 v9, 8, 0
 v_cmp_gt_u32 vcc, 8, v9
 s_nop 0
 s_bitset1_b64 vcc, 19
 s_ff1_i32_b64 s21, vcc
 s_lshl_b32 s22, s21, 1
 s_lshl_b32 s21, s21, 2
 s_sub_i32 s21, s21, 12
 s_max_i32 s47, s21, s22
 s_cmp_gt_u32 s47, s45
 s_cbranch_scc1 va_148
 s_mov_b32 s101, 0
 s_branch va_151
va_149:
 s_sleep 8
va_151:
 buffer_load_dword v9, v5, s[72:75], s43 offen sc1
 s_add_u32 s101, s101, 1
 s_cmp_gt_u32 s101, 131072
 s_cbranch_scc1 main_end
 s_waitcnt vmcnt(0)
 v_cmp_gt_u32 vcc, 8, v9
 s_nop 0
 s_bitset1_b64 vcc, 19
 s_ff1_i32_b64 s21, vcc
 s_lshl_b32 s22, s21, 1
 s_lshl_b32 s21, s21, 2
 s_sub_i32 s21, s21, 12
 s_max_i32 s47, s21, s22
 s_cmp_gt_u32 s47, s45
 s_cbranch_scc0 va_149
va_148:
 s_add_u32 s22, s45, 6
 s_min_u32 s22, s22, s47
va_150:
 s_cmp_ge_u32 s46, s22
 s_cbranch_scc1 va_152
 s_mov_b32 m0, s64
 s_mov_b32 s66, s41
 buffer_load_dwordx4 v4, s[16:19], s66 offen offset:0 sc1 lds
 buffer_load_dwordx4 v4, s[16:19], s66 offen offset:1024 sc1 lds
 buffer_load_dwordx4 v4, s[16:19], s66 offen offset:2048 sc1 lds
 s_add_u32 s46, s46, 1
 s_add_u32 s41, s41, 393216
 s_add_u32 s64, s64, 12288
 s_cmp_lt_u32 s64, s67
 s_cselect_b32 s64, s64, s71
 s_branch va_150
va_152:
 s_mov_b32 s48, s46
 s_mov_b32 s49, s46
 s_mov_b32 s50, s46
 s_waitcnt vmcnt(0)
 s_barrier
 v_mov_b32 v8, v4
 s_add_u32 s65, s65, 12288
 s_cmp_lt_u32 s65, 98304
 s_cselect_b32 s65, s65, 0
 ds_read_b128 v[144:147], v8 offset:0
 ds_read_b128 v[148:151], v8 offset:1024
 ds_read_b128 v[152:155], v8 offset:2048
 ds_read_b128 v[156:159], v8 offset:3072
 ds_read_b128 v[160:163], v8 offset:4096
 ds_read_b128 v[164:167], v8 offset:5120
 ds_read_b128 v[168:171], v8 offset:6144
 ds_read_b128 v[172:175], v8 offset:7168
 ds_read_b128 v[176:179], v8 offset:8192
 ds_read_b128 v[180:183], v8 offset:9216
 ds_read_b128 v[184:187], v8 offset:10240
 ds_read_b128 v[188:191], v8 offset:11264
vwl_153:
 s_waitcnt lgkmcnt(0)
 v_mfma_f32_16x16x32_bf16 v[64:67], v[144:147], a[0:3], 0
 v_cmp_gt_u32 vcc, 8, v9
 s_nop 0
 v_mfma_f32_16x16x32_bf16 v[72:75], v[144:147], a[24:27], 0
 s_bitset1_b64 vcc, 19
 s_ff1_i32_b64 s21, vcc
 v_mfma_f32_16x16x32_bf16 v[80:83], v[144:147], a[48:51], 0
 s_lshl_b32 s22, s21, 1
 s_lshl_b32 s21, s21, 2
 v_mfma_f32_16x16x32_bf16 v[88:91], v[144:147], a[72:75], 0
 s_sub_i32 s21, s21, 12
 s_max_i32 s47, s21, s22
 v_mfma_f32_16x16x32_bf16 v[96:99], v[144:147], a[96:99], 0
 s_add_u32 s22, s45, 7
 s_min_u32 s22, s22, s47
 v_mfma_f32_16x16x32_bf16 v[68:71], v[168:171], a[0:3], 0
 s_cmp_lt_u32 s46, s22
 s_cselect_b32 s66, s41, 0x80000000
 s_cselect_b32 m0, s64, 98304
 s_cselect_b32 s22, 1, 0
 v_mfma_f32_16x16x32_bf16 v[76:79], v[168:171], a[24:27], 0
 buffer_load_dwordx4 v4, s[16:19], s66 offen offset:0 sc1 lds
 v_mfma_f32_16x16x32_bf16 v[84:87], v[168:171], a[48:51], 0
 v_add_u32 v8, s65, v4
 s_add_u32 s65, s65, 12288
 v_mfma_f32_16x16x32_bf16 v[92:95], v[168:171], a[72:75], 0
 buffer_load_dwordx4 v4, s[16:19], s66 offen offset:1024 sc1 lds
 v_mfma_f32_16x16x32_bf16 v[100:103], v[168:171], a[96:99], 0
 s_cmp_lt_u32 s65, 98304
 s_cselect_b32 s65, s65, 0
 v_mfma_f32_16x16x32_bf16 v[64:67], v[148:151], a[4:7], v[64:67]
 buffer_load_dwordx4 v4, s[16:19], s66 offen offset:2048 sc1 lds
 v_mfma_f32_16x16x32_bf16 v[72:75], v[148:151], a[28:31], v[72:75]
 s_add_u32 s46, s46, s22
 s_mul_i32 s21, s22, 393216
 v_mfma_f32_16x16x32_bf16 v[80:83], v[148:151], a[52:55], v[80:83]
 s_add_u32 s41, s41, s21
 s_mul_i32 s21, s22, 12288
 v_mfma_f32_16x16x32_bf16 v[88:91], v[148:151], a[76:79], v[88:91]
 s_add_u32 s64, s64, s21
 v_cvt_pk_bf16_f32 v44, v104, v105
 v_mfma_f32_16x16x32_bf16 v[96:99], v[148:151], a[100:103], v[96:99]
 s_cmp_lt_u32 s64, s67
 s_cselect_b32 s64, s64, s71
 v_mfma_f32_16x16x32_bf16 v[68:71], v[172:175], a[4:7], v[68:71]
 v_cvt_pk_bf16_f32 v45, v106, v107
 v_cvt_pk_bf16_f32 v46, v108, v109
 v_mfma_f32_16x16x32_bf16 v[76:79], v[172:175], a[28:31], v[76:79]
 v_cvt_pk_bf16_f32 v47, v110, v111
 v_mfma_f32_16x16x32_bf16 v[84:87], v[172:175], a[52:55], v[84:87]
 s_add_u32 s69, s68, 4096
 v_mfma_f32_16x16x32_bf16 v[92:95], v[172:175], a[76:79], v[92:95]
 v_mfma_f32_16x16x32_bf16 v[100:103], v[172:175], a[100:103], v[100:103]
 buffer_store_dwordx4 v[44:47], v4, s[24:27], s69 offen offset:1024 sc1
 v_mfma_f32_16x16x32_bf16 v[64:67], v[152:155], a[8:11], v[64:67]
 v_mfma_f32_16x16x32_bf16 v[72:75], v[152:155], a[32:35], v[72:75]
 v_cvt_pk_bf16_f32 v48, v112, v113
 v_mfma_f32_16x16x32_bf16 v[80:83], v[152:155], a[56:59], v[80:83]
 v_cvt_pk_bf16_f32 v49, v114, v115
 v_mfma_f32_16x16x32_bf16 v[88:91], v[152:155], a[80:83], v[88:91]
 v_mfma_f32_16x16x32_bf16 v[96:99], v[152:155], a[104:107], v[96:99]
 v_cvt_pk_bf16_f32 v50, v116, v117
 v_mfma_f32_16x16x32_bf16 v[68:71], v[176:179], a[8:11], v[68:71]
 v_mfma_f32_16x16x32_bf16 v[76:79], v[176:179], a[32:35], v[76:79]
 v_cvt_pk_bf16_f32 v51, v118, v119
 v_mfma_f32_16x16x32_bf16 v[84:87], v[176:179], a[56:59], v[84:87]
 buffer_store_dwordx4 v[48:51], v4, s[24:27], s69 offen offset:2048 sc1
 v_mfma_f32_16x16x32_bf16 v[92:95], v[176:179], a[80:83], v[92:95]
 v_mfma_f32_16x16x32_bf16 v[100:103], v[176:179], a[104:107], v[100:103]
 v_cvt_pk_bf16_f32 v52, v120, v121
 v_mfma_f32_16x16x32_bf16 v[64:67], v[156:159], a[12:15], v[64:67]
 v_mfma_f32_16x16x32_bf16 v[72:75], v[156:159], a[36:39], v[72:75]
 v_cvt_pk_bf16_f32 v53, v122, v123
 v_mfma_f32_16x16x32_bf16 v[80:83], v[156:159], a[60:63], v[80:83]
 v_cvt_pk_bf16_f32 v54, v124, v125
 v_mfma_f32_16x16x32_bf16 v[88:91], v[156:159], a[84:87], v[88:91]
 v_mfma_f32_16x16x32_bf16 v[96:99], v[156:159], a[108:111], v[96:99]
 v_cvt_pk_bf16_f32 v55, v126, v127
 v_mfma_f32_16x16x32_bf16 v[68:71], v[180:183], a[12:15], v[68:71]
 v_mfma_f32_16x16x32_bf16 v[76:79], v[180:183], a[36:39], v[76:79]
 buffer_store_dwordx4 v[52:55], v4, s[24:27], s69 offen offset:3072 sc1
 v_mfma_f32_16x16x32_bf16 v[84:87], v[180:183], a[60:63], v[84:87]
 v_cvt_pk_bf16_f32 v56, v128, v129
 v_mfma_f32_16x16x32_bf16 v[92:95], v[180:183], a[84:87], v[92:95]
 v_mfma_f32_16x16x32_bf16 v[100:103], v[180:183], a[108:111], v[100:103]
 v_cvt_pk_bf16_f32 v57, v130, v131
 v_mfma_f32_16x16x32_bf16 v[64:67], v[160:163], a[16:19], v[64:67]
 v_mfma_f32_16x16x32_bf16 v[72:75], v[160:163], a[40:43], v[72:75]
 v_cvt_pk_bf16_f32 v58, v132, v133
 v_mfma_f32_16x16x32_bf16 v[80:83], v[160:163], a[64:67], v[80:83]
 v_cvt_pk_bf16_f32 v59, v134, v135
 v_mfma_f32_16x16x32_bf16 v[88:91], v[160:163], a[88:91], v[88:91]
 v_mfma_f32_16x16x32_bf16 v[96:99], v[160:163], a[112:115], v[96:99]
 s_add_u32 s69, s68, 8192
 v_mfma_f32_16x16x32_bf16 v[68:71], v[184:187], a[16:19], v[68:71]
 v_mfma_f32_16x16x32_bf16 v[76:79], v[184:187], a[40:43], v[76:79]
 buffer_store_dwordx4 v[56:59], v4, s[24:27], s69 offen offset:0 sc1
 v_mfma_f32_16x16x32_bf16 v[84:87], v[184:187], a[64:67], v[84:87]
 v_cvt_pk_bf16_f32 v60, v136, v137
 v_mfma_f32_16x16x32_bf16 v[92:95], v[184:187], a[88:91], v[92:95]
 v_mfma_f32_16x16x32_bf16 v[100:103], v[184:187], a[112:115], v[100:103]
 v_cvt_pk_bf16_f32 v61, v138, v139
 v_mfma_f32_16x16x32_bf16 v[64:67], v[164:167], a[20:23], v[64:67]
 v_mfma_f32_16x16x32_bf16 v[72:75], v[164:167], a[44:47], v[72:75]
 v_cvt_pk_bf16_f32 v62, v140, v141
 v_mfma_f32_16x16x32_bf16 v[80:83], v[164:167], a[68:71], v[80:83]
 v_cvt_pk_bf16_f32 v63, v142, v143
 v_mfma_f32_16x16x32_bf16 v[88:91], v[164:167], a[92:95], v[88:91]
 v_mfma_f32_16x16x32_bf16 v[96:99], v[164:167], a[116:119], v[96:99]
 buffer_store_dwordx4 v[60:63], v4, s[24:27], s69 offen offset:1024 sc1
 v_mfma_f32_16x16x32_bf16 v[68:71], v[188:191], a[20:23], v[68:71]
 v_mfma_f32_16x16x32_bf16 v[76:79], v[188:191], a[44:47], v[76:79]
 v_mfma_f32_16x16x32_bf16 v[84:87], v[188:191], a[68:71], v[84:87]
 v_mfma_f32_16x16x32_bf16 v[92:95], v[188:191], a[92:95], v[92:95]
 v_mfma_f32_16x16x32_bf16 v[100:103], v[188:191], a[116:119], v[100:103]
 v_mfma_f32_16x16x32_bf16 v[104:107], v[144:147], a[120:123], 0
 buffer_load_dword v9, v5, s[72:75], s43 offen sc1
 v_mfma_f32_16x16x32_bf16 v[112:115], v[144:147], a[144:147], 0
 v_mfma_f32_16x16x32_bf16 v[120:123], v[144:147], a[168:171], 0
 v_mfma_f32_16x16x32_bf16 v[128:131], v[144:147], a[192:195], 0
 v_cvt_pk_bf16_f32 v24, v64, v65
 v_mfma_f32_16x16x32_bf16 v[136:139], v[144:147], a[216:219], 0
 s_add_u32 s63, s45, 1
 s_min_u32 s63, s63, 63
 v_mfma_f32_16x16x32_bf16 v[108:111], v[168:171], a[120:123], 0
 s_cmp_lt_u32 s63, s46
 s_cselect_b32 s53, 1, 0
 v_mfma_f32_16x16x32_bf16 v[116:119], v[168:171], a[144:147], 0
 v_mov_b32 v21, s53
 ds_write_b32 v6, v21 offset:0
 v_mfma_f32_16x16x32_bf16 v[124:127], v[168:171], a[168:171], 0
 v_cvt_pk_bf16_f32 v25, v66, v67
 v_cvt_pk_bf16_f32 v26, v68, v69
 v_mfma_f32_16x16x32_bf16 v[132:135], v[168:171], a[192:195], 0
 v_cvt_pk_bf16_f32 v27, v70, v71
 v_mfma_f32_16x16x32_bf16 v[140:143], v[168:171], a[216:219], 0
 v_mfma_f32_16x16x32_bf16 v[104:107], v[148:151], a[124:127], v[104:107]
 buffer_store_dwordx4 v[24:27], v4, s[24:27], s42 offen offset:0 sc1
 v_mfma_f32_16x16x32_bf16 v[112:115], v[148:151], a[148:151], v[112:115]
 v_cvt_pk_bf16_f32 v28, v72, v73
 v_mfma_f32_16x16x32_bf16 v[120:123], v[148:151], a[172:175], v[120:123]
 s_cmp_eq_u32 s40, 3
 s_cbranch_scc1 vwm_157
vwm_158:
 v_mfma_f32_16x16x32_bf16 v[128:131], v[148:151], a[196:199], v[128:131]
 v_cvt_pk_bf16_f32 v29, v74, v75
 v_mfma_f32_16x16x32_bf16 v[136:139], v[148:151], a[220:223], v[136:139]
 v_mfma_f32_16x16x32_bf16 v[108:111], v[172:175], a[124:127], v[108:111]
 v_cvt_pk_bf16_f32 v30, v76, v77
 v_mfma_f32_16x16x32_bf16 v[116:119], v[172:175], a[148:151], v[116:119]
 v_mfma_f32_16x16x32_bf16 v[124:127], v[172:175], a[172:175], v[124:127]
 v_cvt_pk_bf16_f32 v31, v78, v79
 v_mfma_f32_16x16x32_bf16 v[132:135], v[172:175], a[196:199], v[132:135]
 buffer_store_dwordx4 v[28:31], v4, s[24:27], s42 offen offset:1024 sc1
 v_mfma_f32_16x16x32_bf16 v[140:143], v[172:175], a[220:223], v[140:143]
 s_cmp_lt_u32 s63, s50
 s_cbranch_scc0 vwx_155
vwx_156:
 v_mfma_f32_16x16x32_bf16 v[104:107], v[152:155], a[128:131], v[104:107]
 s_waitcnt lgkmcnt(0)
 s_barrier
 v_mfma_f32_16x16x32_bf16 v[112:115], v[152:155], a[152:155], v[112:115]
 ds_read_b128 v[240:243], v7 offset:0
 v_cvt_pk_bf16_f32 v32, v80, v81
 v_mfma_f32_16x16x32_bf16 v[120:123], v[152:155], a[176:179], v[120:123]
 ds_read_b128 v[192:195], v8 offset:0
 v_cvt_pk_bf16_f32 v33, v82, v83
 v_mfma_f32_16x16x32_bf16 v[128:131], v[152:155], a[200:203], v[128:131]
 v_mfma_f32_16x16x32_bf16 v[136:139], v[152:155], a[224:227], v[136:139]
 ds_read_b128 v[196:199], v8 offset:1024
 v_cvt_pk_bf16_f32 v34, v84, v85
 v_mfma_f32_16x16x32_bf16 v[108:111], v[176:179], a[128:131], v[108:111]
 v_mfma_f32_16x16x32_bf16 v[116:119], v[176:179], a[152:155], v[116:119]
 v_cvt_pk_bf16_f32 v35, v86, v87
 v_mfma_f32_16x16x32_bf16 v[124:127], v[176:179], a[176:179], v[124:127]
 ds_read_b128 v[200:203], v8 offset:2048
 v_mfma_f32_16x16x32_bf16 v[132:135], v[176:179], a[200:203], v[132:135]
 buffer_store_dwordx4 v[32:35], v4, s[24:27], s42 offen offset:2048 sc1
 v_mfma_f32_16x16x32_bf16 v[140:143], v[176:179], a[224:227], v[140:143]
 ds_read_b128 v[204:207], v8 offset:3072
 v_cvt_pk_bf16_f32 v36, v88, v89
 v_mfma_f32_16x16x32_bf16 v[104:107], v[156:159], a[132:135], v[104:107]
 v_mfma_f32_16x16x32_bf16 v[112:115], v[156:159], a[156:159], v[112:115]
 v_cvt_pk_bf16_f32 v37, v90, v91
 v_mfma_f32_16x16x32_bf16 v[120:123], v[156:159], a[180:183], v[120:123]
 ds_read_b128 v[208:211], v8 offset:4096
 v_mfma_f32_16x16x32_bf16 v[128:131], v[156:159], a[204:207], v[128:131]
 v_cvt_pk_bf16_f32 v38, v92, v93
 v_mfma_f32_16x16x32_bf16 v[136:139], v[156:159], a[228:231], v[136:139]
 ds_read_b128 v[212:215], v8 offset:5120
 s_waitcnt lgkmcnt(4)
 v_mfma_f32_16x16x32_bf16 v[108:111], v[180:183], a[132:135], v[108:111]
 v_bitop3_b32 v240, v240, v241, v242 bitop3:0x80
 v_and_b32 v240, v240, v243
 v_mfma_f32_16x16x32_bf16 v[116:119], v[180:183], a[156:159], v[116:119]
 s_nop 0
 v_readfirstlane_b32 s23, v240
 v_mfma_f32_16x16x32_bf16 v[124:127], v[180:183], a[180:183], v[124:127]
 ds_read_b128 v[216:219], v8 offset:6144
 v_cvt_pk_bf16_f32 v39, v94, v95
 v_mfma_f32_16x16x32_bf16 v[132:135], v[180:183], a[204:207], v[132:135]
 buffer_store_dwordx4 v[36:39], v4, s[24:27], s42 offen offset:3072 sc1
 v_mfma_f32_16x16x32_bf16 v[140:143], v[180:183], a[228:231], v[140:143]
 ds_read_b128 v[220:223], v8 offset:7168
 v_cvt_pk_bf16_f32 v40, v96, v97
 v_mfma_f32_16x16x32_bf16 v[104:107], v[160:163], a[136:139], v[104:107]
 v_cvt_pk_bf16_f32 v41, v98, v99
 v_mfma_f32_16x16x32_bf16 v[112:115], v[160:163], a[160:163], v[112:115]
 v_cvt_pk_bf16_f32 v42, v100, v101
 v_mfma_f32_16x16x32_bf16 v[120:123], v[160:163], a[184:187], v[120:123]
 ds_read_b128 v[224:227], v8 offset:8192
 v_mfma_f32_16x16x32_bf16 v[128:131], v[160:163], a[208:211], v[128:131]
 v_cvt_pk_bf16_f32 v43, v102, v103
 v_mfma_f32_16x16x32_bf16 v[136:139], v[160:163], a[232:235], v[136:139]
 ds_read_b128 v[228:231], v8 offset:9216
 v_mfma_f32_16x16x32_bf16 v[108:111], v[184:187], a[136:139], v[108:111]
 s_add_u32 s69, s42, 4096
 v_mfma_f32_16x16x32_bf16 v[116:119], v[184:187], a[160:163], v[116:119]
 v_mfma_f32_16x16x32_bf16 v[124:127], v[184:187], a[184:187], v[124:127]
 ds_read_b128 v[232:235], v8 offset:10240
 v_mfma_f32_16x16x32_bf16 v[132:135], v[184:187], a[208:211], v[132:135]
 buffer_store_dwordx4 v[40:43], v4, s[24:27], s69 offen offset:0 sc1
 v_mfma_f32_16x16x32_bf16 v[140:143], v[184:187], a[232:235], v[140:143]
 ds_read_b128 v[236:239], v8 offset:11264
 v_mfma_f32_16x16x32_bf16 v[104:107], v[164:167], a[140:143], v[104:107]
 v_mfma_f32_16x16x32_bf16 v[112:115], v[164:167], a[164:167], v[112:115]
 v_mfma_f32_16x16x32_bf16 v[120:123], v[164:167], a[188:191], v[120:123]
 s_waitcnt vmcnt(11)
 s_mov_b32 s50, s46
 s_add_u32 s69, s45, s40
 v_mfma_f32_16x16x32_bf16 v[128:131], v[164:167], a[212:215], v[128:131]
 s_mov_b32 s40, 0
 s_sub_i32 s69, s69, 1
 s_max_i32 s69, s69, s70
 v_mfma_f32_16x16x32_bf16 v[136:139], v[164:167], a[236:239], v[136:139]
 s_add_u32 s45, s45, 1
 s_mov_b32 s68, s42
 s_add_u32 s42, s42, 1310720
 v_mfma_f32_16x16x32_bf16 v[108:111], v[188:191], a[140:143], v[108:111]
 v_mfma_f32_16x16x32_bf16 v[116:119], v[188:191], a[164:167], v[116:119]
 v_mfma_f32_16x16x32_bf16 v[124:127], v[188:191], a[188:191], v[124:127]
 v_mfma_f32_16x16x32_bf16 v[132:135], v[188:191], a[212:215], v[132:135]
 v_mfma_f32_16x16x32_bf16 v[140:143], v[188:191], a[236:239], v[140:143]
 s_mov_b64 exec, 1
 v_mov_b32 v20, s69
 buffer_store_dword v20, v10, s[72:75], s44 offen sc1
 s_mov_b64 exec, -1
 s_cmp_le_u32 s45, 16
 s_cbranch_scc1 vwe_161
vwe_162:
 s_cmp_eq_u32 s23, 0
 s_cbranch_scc1 vws_159
vwb_160:
 s_waitcnt lgkmcnt(0)
 v_mfma_f32_16x16x32_bf16 v[64:67], v[192:195], a[0:3], 0
 v_cmp_gt_u32 vcc, 8, v9
 s_nop 0
 v_mfma_f32_16x16x32_bf16 v[72:75], v[192:195], a[24:27], 0
 s_bitset1_b64 vcc, 19
 s_ff1_i32_b64 s21, vcc
 v_mfma_f32_16x16x32_bf16 v[80:83], v[192:195], a[48:51], 0
 s_lshl_b32 s22, s21, 1
 s_lshl_b32 s21, s21, 2
 v_mfma_f32_16x16x32_bf16 v[88:91], v[192:195], a[72:75], 0
 s_sub_i32 s21, s21, 12
 s_max_i32 s47, s21, s22
 v_mfma_f32_16x16x32_bf16 v[96:99], v[192:195], a[96:99], 0
 s_add_u32 s22, s45, 7
 s_min_u32 s22, s22, s47
 v_mfma_f32_16x16x32_bf16 v[68:71], v[216:219], a[0:3], 0
 s_cmp_lt_u32 s46, s22
 s_cselect_b32 s66, s41, 0x80000000
 s_cselect_b32 m0, s64, 98304
 s_cselect_b32 s22, 1, 0
 v_mfma_f32_16x16x32_bf16 v[76:79], v[216:219], a[24:27], 0
 buffer_load_dwordx4 v4, s[16:19], s66 offen offset:0 sc1 lds
 v_mfma_f32_16x16x32_bf16 v[84:87], v[216:219], a[48:51], 0
 v_add_u32 v8, s65, v4
 s_add_u32 s65, s65, 12288
 v_mfma_f32_16x16x32_bf16 v[92:95], v[216:219], a[72:75], 0
 buffer_load_dwordx4 v4, s[16:19], s66 offen offset:1024 sc1 lds
 v_mfma_f32_16x16x32_bf16 v[100:103], v[216:219], a[96:99], 0
 s_cmp_lt_u32 s65, 98304
 s_cselect_b32 s65, s65, 0
 v_mfma_f32_16x16x32_bf16 v[64:67], v[196:199], a[4:7], v[64:67]
 buffer_load_dwordx4 v4, s[16:19], s66 offen offset:2048 sc1 lds
 v_mfma_f32_16x16x32_bf16 v[72:75], v[196:199], a[28:31], v[72:75]
 s_add_u32 s46, s46, s22
 s_mul_i32 s21, s22, 393216
 v_mfma_f32_16x16x32_bf16 v[80:83], v[196:199], a[52:55], v[80:83]
 s_add_u32 s41, s41, s21
 s_mul_i32 s21, s22, 12288
 v_mfma_f32_16x16x32_bf16 v[88:91], v[196:199], a[76:79], v[88:91]
 s_add_u32 s64, s64, s21
 v_cvt_pk_bf16_f32 v44, v104, v105
 v_mfma_f32_16x16x32_bf16 v[96:99], v[196:199], a[100:103], v[96:99]
 s_cmp_lt_u32 s64, s67
 s_cselect_b32 s64, s64, s71
 v_mfma_f32_16x16x32_bf16 v[68:71], v[220:223], a[4:7], v[68:71]
 v_cvt_pk_bf16_f32 v45, v106, v107
 v_cvt_pk_bf16_f32 v46, v108, v109
 v_mfma_f32_16x16x32_bf16 v[76:79], v[220:223], a[28:31], v[76:79]
 v_cvt_pk_bf16_f32 v47, v110, v111
 v_mfma_f32_16x16x32_bf16 v[84:87], v[220:223], a[52:55], v[84:87]
 s_add_u32 s69, s68, 4096
 v_mfma_f32_16x16x32_bf16 v[92:95], v[220:223], a[76:79], v[92:95]
 v_mfma_f32_16x16x32_bf16 v[100:103], v[220:223], a[100:103], v[100:103]
 buffer_store_dwordx4 v[44:47], v4, s[24:27], s69 offen offset:1024 sc1
 v_mfma_f32_16x16x32_bf16 v[64:67], v[200:203], a[8:11], v[64:67]
 v_mfma_f32_16x16x32_bf16 v[72:75], v[200:203], a[32:35], v[72:75]
 v_cvt_pk_bf16_f32 v48, v112, v113
 v_mfma_f32_16x16x32_bf16 v[80:83], v[200:203], a[56:59], v[80:83]
 v_cvt_pk_bf16_f32 v49, v114, v115
 v_mfma_f32_16x16x32_bf16 v[88:91], v[200:203], a[80:83], v[88:91]
 v_mfma_f32_16x16x32_bf16 v[96:99], v[200:203], a[104:107], v[96:99]
 v_cvt_pk_bf16_f32 v50, v116, v117
 v_mfma_f32_16x16x32_bf16 v[68:71], v[224:227], a[8:11], v[68:71]
 v_mfma_f32_16x16x32_bf16 v[76:79], v[224:227], a[32:35], v[76:79]
 v_cvt_pk_bf16_f32 v51, v118, v119
 v_mfma_f32_16x16x32_bf16 v[84:87], v[224:227], a[56:59], v[84:87]
 buffer_store_dwordx4 v[48:51], v4, s[24:27], s69 offen offset:2048 sc1
 v_mfma_f32_16x16x32_bf16 v[92:95], v[224:227], a[80:83], v[92:95]
 v_mfma_f32_16x16x32_bf16 v[100:103], v[224:227], a[104:107], v[100:103]
 v_cvt_pk_bf16_f32 v52, v120, v121
 v_mfma_f32_16x16x32_bf16 v[64:67], v[204:207], a[12:15], v[64:67]
 v_mfma_f32_16x16x32_bf16 v[72:75], v[204:207], a[36:39], v[72:75]
 v_cvt_pk_bf16_f32 v53, v122, v123
 v_mfma_f32_16x16x32_bf16 v[80:83], v[204:207], a[60:63], v[80:83]
 v_cvt_pk_bf16_f32 v54, v124, v125
 v_mfma_f32_16x16x32_bf16 v[88:91], v[204:207], a[84:87], v[88:91]
 v_mfma_f32_16x16x32_bf16 v[96:99], v[204:207], a[108:111], v[96:99]
 v_cvt_pk_bf16_f32 v55, v126, v127
 v_mfma_f32_16x16x32_bf16 v[68:71], v[228:231], a[12:15], v[68:71]
 v_mfma_f32_16x16x32_bf16 v[76:79], v[228:231], a[36:39], v[76:79]
 buffer_store_dwordx4 v[52:55], v4, s[24:27], s69 offen offset:3072 sc1
 v_mfma_f32_16x16x32_bf16 v[84:87], v[228:231], a[60:63], v[84:87]
 v_cvt_pk_bf16_f32 v56, v128, v129
 v_mfma_f32_16x16x32_bf16 v[92:95], v[228:231], a[84:87], v[92:95]
 v_mfma_f32_16x16x32_bf16 v[100:103], v[228:231], a[108:111], v[100:103]
 v_cvt_pk_bf16_f32 v57, v130, v131
 v_mfma_f32_16x16x32_bf16 v[64:67], v[208:211], a[16:19], v[64:67]
 v_mfma_f32_16x16x32_bf16 v[72:75], v[208:211], a[40:43], v[72:75]
 v_cvt_pk_bf16_f32 v58, v132, v133
 v_mfma_f32_16x16x32_bf16 v[80:83], v[208:211], a[64:67], v[80:83]
 v_cvt_pk_bf16_f32 v59, v134, v135
 v_mfma_f32_16x16x32_bf16 v[88:91], v[208:211], a[88:91], v[88:91]
 v_mfma_f32_16x16x32_bf16 v[96:99], v[208:211], a[112:115], v[96:99]
 s_add_u32 s69, s68, 8192
 v_mfma_f32_16x16x32_bf16 v[68:71], v[232:235], a[16:19], v[68:71]
 v_mfma_f32_16x16x32_bf16 v[76:79], v[232:235], a[40:43], v[76:79]
 buffer_store_dwordx4 v[56:59], v4, s[24:27], s69 offen offset:0 sc1
 v_mfma_f32_16x16x32_bf16 v[84:87], v[232:235], a[64:67], v[84:87]
 v_cvt_pk_bf16_f32 v60, v136, v137
 v_mfma_f32_16x16x32_bf16 v[92:95], v[232:235], a[88:91], v[92:95]
 v_mfma_f32_16x16x32_bf16 v[100:103], v[232:235], a[112:115], v[100:103]
 v_cvt_pk_bf16_f32 v61, v138, v139
 v_mfma_f32_16x16x32_bf16 v[64:67], v[212:215], a[20:23], v[64:67]
 v_mfma_f32_16x16x32_bf16 v[72:75], v[212:215], a[44:47], v[72:75]
 v_cvt_pk_bf16_f32 v62, v140, v141
 v_mfma_f32_16x16x32_bf16 v[80:83], v[212:215], a[68:71], v[80:83]
 v_cvt_pk_bf16_f32 v63, v142, v143
 v_mfma_f32_16x16x32_bf16 v[88:91], v[212:215], a[92:95], v[88:91]
 v_mfma_f32_16x16x32_bf16 v[96:99], v[212:215], a[116:119], v[96:99]
 buffer_store_dwordx4 v[60:63], v4, s[24:27], s69 offen offset:1024 sc1
 v_mfma_f32_16x16x32_bf16 v[68:71], v[236:239], a[20:23], v[68:71]
 v_mfma_f32_16x16x32_bf16 v[76:79], v[236:239], a[44:47], v[76:79]
 v_mfma_f32_16x16x32_bf16 v[84:87], v[236:239], a[68:71], v[84:87]
 v_mfma_f32_16x16x32_bf16 v[92:95], v[236:239], a[92:95], v[92:95]
 v_mfma_f32_16x16x32_bf16 v[100:103], v[236:239], a[116:119], v[100:103]
 v_mfma_f32_16x16x32_bf16 v[104:107], v[192:195], a[120:123], 0
 buffer_load_dword v9, v5, s[72:75], s43 offen sc1
 v_mfma_f32_16x16x32_bf16 v[112:115], v[192:195], a[144:147], 0
 v_mfma_f32_16x16x32_bf16 v[120:123], v[192:195], a[168:171], 0
 v_mfma_f32_16x16x32_bf16 v[128:131], v[192:195], a[192:195], 0
 v_cvt_pk_bf16_f32 v24, v64, v65
 v_mfma_f32_16x16x32_bf16 v[136:139], v[192:195], a[216:219], 0
 s_add_u32 s63, s45, 1
 s_min_u32 s63, s63, 63
 v_mfma_f32_16x16x32_bf16 v[108:111], v[216:219], a[120:123], 0
 s_cmp_lt_u32 s63, s46
 s_cselect_b32 s53, 1, 0
 v_mfma_f32_16x16x32_bf16 v[116:119], v[216:219], a[144:147], 0
 v_mov_b32 v21, s53
 ds_write_b32 v6, v21 offset:16
 v_mfma_f32_16x16x32_bf16 v[124:127], v[216:219], a[168:171], 0
 v_cvt_pk_bf16_f32 v25, v66, v67
 v_cvt_pk_bf16_f32 v26, v68, v69
 v_mfma_f32_16x16x32_bf16 v[132:135], v[216:219], a[192:195], 0
 v_cvt_pk_bf16_f32 v27, v70, v71
 v_mfma_f32_16x16x32_bf16 v[140:143], v[216:219], a[216:219], 0
 v_mfma_f32_16x16x32_bf16 v[104:107], v[196:199], a[124:127], v[104:107]
 buffer_store_dwordx4 v[24:27], v4, s[24:27], s42 offen offset:0 sc1
 v_mfma_f32_16x16x32_bf16 v[112:115], v[196:199], a[148:151], v[112:115]
 v_cvt_pk_bf16_f32 v28, v72, v73
 v_mfma_f32_16x16x32_bf16 v[120:123], v[196:199], a[172:175], v[120:123]
 s_cmp_eq_u32 s40, 3
 s_cbranch_scc1 vwm_167
vwm_168:
 v_mfma_f32_16x16x32_bf16 v[128:131], v[196:199], a[196:199], v[128:131]
 v_cvt_pk_bf16_f32 v29, v74, v75
 v_mfma_f32_16x16x32_bf16 v[136:139], v[196:199], a[220:223], v[136:139]
 v_mfma_f32_16x16x32_bf16 v[108:111], v[220:223], a[124:127], v[108:111]
 v_cvt_pk_bf16_f32 v30, v76, v77
 v_mfma_f32_16x16x32_bf16 v[116:119], v[220:223], a[148:151], v[116:119]
 v_mfma_f32_16x16x32_bf16 v[124:127], v[220:223], a[172:175], v[124:127]
 v_cvt_pk_bf16_f32 v31, v78, v79
 v_mfma_f32_16x16x32_bf16 v[132:135], v[220:223], a[196:199], v[132:135]
 buffer_store_dwordx4 v[28:31], v4, s[24:27], s42 offen offset:1024 sc1
 v_mfma_f32_16x16x32_bf16 v[140:143], v[220:223], a[220:223], v[140:143]
 s_cmp_lt_u32 s63, s50
 s_cbranch_scc0 vwx_165
vwx_166:
 v_mfma_f32_16x16x32_bf16 v[104:107], v[200:203], a[128:131], v[104:107]
 s_waitcnt lgkmcnt(0)
 s_barrier
 v_mfma_f32_16x16x32_bf16 v[112:115], v[200:203], a[152:155], v[112:115]
 ds_read_b128 v[240:243], v7 offset:16
 v_cvt_pk_bf16_f32 v32, v80, v81
 v_mfma_f32_16x16x32_bf16 v[120:123], v[200:203], a[176:179], v[120:123]
 ds_read_b128 v[144:147], v8 offset:0
 v_cvt_pk_bf16_f32 v33, v82, v83
 v_mfma_f32_16x16x32_bf16 v[128:131], v[200:203], a[200:203], v[128:131]
 v_mfma_f32_16x16x32_bf16 v[136:139], v[200:203], a[224:227], v[136:139]
 ds_read_b128 v[148:151], v8 offset:1024
 v_cvt_pk_bf16_f32 v34, v84, v85
 v_mfma_f32_16x16x32_bf16 v[108:111], v[224:227], a[128:131], v[108:111]
 v_mfma_f32_16x16x32_bf16 v[116:119], v[224:227], a[152:155], v[116:119]
 v_cvt_pk_bf16_f32 v35, v86, v87
 v_mfma_f32_16x16x32_bf16 v[124:127], v[224:227], a[176:179], v[124:127]
 ds_read_b128 v[152:155], v8 offset:2048
 v_mfma_f32_16x16x32_bf16 v[132:135], v[224:227], a[200:203], v[132:135]
 buffer_store_dwordx4 v[32:35], v4, s[24:27], s42 offen offset:2048 sc1
 v_mfma_f32_16x16x32_bf16 v[140:143], v[224:227], a[224:227], v[140:143]
 ds_read_b128 v[156:159], v8 offset:3072
 v_cvt_pk_bf16_f32 v36, v88, v89
 v_mfma_f32_16x16x32_bf16 v[104:107], v[204:207], a[132:135], v[104:107]
 v_mfma_f32_16x16x32_bf16 v[112:115], v[204:207], a[156:159], v[112:115]
 v_cvt_pk_bf16_f32 v37, v90, v91
 v_mfma_f32_16x16x32_bf16 v[120:123], v[204:207], a[180:183], v[120:123]
 ds_read_b128 v[160:163], v8 offset:4096
 v_mfma_f32_16x16x32_bf16 v[128:131], v[204:207], a[204:207], v[128:131]
 v_cvt_pk_bf16_f32 v38, v92, v93
 v_mfma_f32_16x16x32_bf16 v[136:139], v[204:207], a[228:231], v[136:139]
 ds_read_b128 v[164:167], v8 offset:5120
 s_waitcnt lgkmcnt(4)
 v_mfma_f32_16x16x32_bf16 v[108:111], v[228:231], a[132:135], v[108:111]
 v_bitop3_b32 v240, v240, v241, v242 bitop3:0x80
 v_and_b32 v240, v240, v243
 v_mfma_f32_16x16x32_bf16 v[116:119], v[228:231], a[156:159], v[116:119]
 s_nop 0
 v_readfirstlane_b32 s23, v240
 v_mfma_f32_16x16x32_bf16 v[124:127], v[228:231], a[180:183], v[124:127]
 ds_read_b128 v[168:171], v8 offset:6144
 v_cvt_pk_bf16_f32 v39, v94, v95
 v_mfma_f32_16x16x32_bf16 v[132:135], v[228:231], a[204:207], v[132:135]
 buffer_store_dwordx4 v[36:39], v4, s[24:27], s42 offen offset:3072 sc1
 v_mfma_f32_16x16x32_bf16 v[140:143], v[228:231], a[228:231], v[140:143]
 ds_read_b128 v[172:175], v8 offset:7168
 v_cvt_pk_bf16_f32 v40, v96, v97
 v_mfma_f32_16x16x32_bf16 v[104:107], v[208:211], a[136:139], v[104:107]
 v_cvt_pk_bf16_f32 v41, v98, v99
 v_mfma_f32_16x16x32_bf16 v[112:115], v[208:211], a[160:163], v[112:115]
 v_cvt_pk_bf16_f32 v42, v100, v101
 v_mfma_f32_16x16x32_bf16 v[120:123], v[208:211], a[184:187], v[120:123]
 ds_read_b128 v[176:179], v8 offset:8192
 v_mfma_f32_16x16x32_bf16 v[128:131], v[208:211], a[208:211], v[128:131]
 v_cvt_pk_bf16_f32 v43, v102, v103
 v_mfma_f32_16x16x32_bf16 v[136:139], v[208:211], a[232:235], v[136:139]
 ds_read_b128 v[180:183], v8 offset:9216
 v_mfma_f32_16x16x32_bf16 v[108:111], v[232:235], a[136:139], v[108:111]
 s_add_u32 s69, s42, 4096
 v_mfma_f32_16x16x32_bf16 v[116:119], v[232:235], a[160:163], v[116:119]
 v_mfma_f32_16x16x32_bf16 v[124:127], v[232:235], a[184:187], v[124:127]
 ds_read_b128 v[184:187], v8 offset:10240
 v_mfma_f32_16x16x32_bf16 v[132:135], v[232:235], a[208:211], v[132:135]
 buffer_store_dwordx4 v[40:43], v4, s[24:27], s69 offen offset:0 sc1
 v_mfma_f32_16x16x32_bf16 v[140:143], v[232:235], a[232:235], v[140:143]
 ds_read_b128 v[188:191], v8 offset:11264
 v_mfma_f32_16x16x32_bf16 v[104:107], v[212:215], a[140:143], v[104:107]
 v_mfma_f32_16x16x32_bf16 v[112:115], v[212:215], a[164:167], v[112:115]
 v_mfma_f32_16x16x32_bf16 v[120:123], v[212:215], a[188:191], v[120:123]
 s_waitcnt vmcnt(11)
 s_mov_b32 s50, s46
 s_add_u32 s69, s45, s40
 v_mfma_f32_16x16x32_bf16 v[128:131], v[212:215], a[212:215], v[128:131]
 s_mov_b32 s40, 0
 s_sub_i32 s69, s69, 1
 s_max_i32 s69, s69, s70
 v_mfma_f32_16x16x32_bf16 v[136:139], v[212:215], a[236:239], v[136:139]
 s_add_u32 s45, s45, 1
 s_mov_b32 s68, s42
 s_add_u32 s42, s42, 1310720
 v_mfma_f32_16x16x32_bf16 v[108:111], v[236:239], a[140:143], v[108:111]
 v_mfma_f32_16x16x32_bf16 v[116:119], v[236:239], a[164:167], v[116:119]
 v_mfma_f32_16x16x32_bf16 v[124:127], v[236:239], a[188:191], v[124:127]
 v_mfma_f32_16x16x32_bf16 v[132:135], v[236:239], a[212:215], v[132:135]
 v_mfma_f32_16x16x32_bf16 v[140:143], v[236:239], a[236:239], v[140:143]
 s_mov_b64 exec, 1
 v_mov_b32 v20, s69
 buffer_store_dword v20, v10, s[72:75], s44 offen sc1
 s_mov_b64 exec, -1
 s_cmp_le_u32 s45, 16
 s_cbranch_scc1 vwe_171
vwe_172:
 s_cmp_lg_u32 s45, 48
 s_cbranch_scc1 arm_175
 v_and_b32 v23, 31, v1
 buffer_load_ubyte v22, v23, s[32:35], 0 offen offset:160 sc1
 s_waitcnt vmcnt(0)
 s_mov_b32 s101, 0
c0_177:
 v_cmp_eq_u32 vcc, 0, v22
 s_nop 1
 s_cbranch_vccz c0_178
 s_sleep 8
 v_and_b32 v23, 31, v1
 buffer_load_ubyte v22, v23, s[32:35], 0 offen offset:160 sc1
 s_add_u32 s101, s101, 1
 s_cmp_gt_u32 s101, 131072
 s_cbranch_scc1 main_end
 s_waitcnt vmcnt(0)
 s_branch c0_177
c0_178:
 v_cmp_eq_u32 vcc, 2, v22
 s_nop 1
 s_mov_b32 s37, vcc_lo
 s_lshr_b32 s21, s2, 3
 s_lshl_b32 s21, s21, 14
 s_and_b32 s22, s2, 7
 s_lshl_b32 s22, s22, 10
 s_add_u32 s54, s21, s22
 s_lshr_b32 s21, s2, 2
 s_lshl_b32 s21, s21, 14
 s_and_b32 s22, s2, 3
 s_lshl_b32 s22, s22, 11
 s_add_u32 s21, s21, s22
 s_add_u32 s55, s21, 655360
 s_lshr_b32 s58, s2, 1
 s_lshl_b32 s58, s58, 14
 s_and_b32 s21, s2, 1
 s_mul_i32 s21, s21, 3072
 s_add_u32 s58, s58, s21
 s_add_u32 s58, s58, 655360
 s_add_u32 s56, s20, 56
arm_176:
 s_lshr_b32 s21, s56, 1
 s_bitcmp1_b32 s37, s21
 s_cselect_b32 s21, 8192, 0
 s_lshl_b32 s57, s56, 20
 s_or_b32 s57, s57, s21
 s_cmp_ge_u32 s56, 40
 s_cselect_b32 s21, 8192, 0
 s_xor_b32 s21, s21, s57
 s_add_u32 s21, s21, s54
 buffer_store_dwordx4 v[244:247], v4, s[88:91], s21 offen sc1
 s_add_u32 s21, s21, 65536
 buffer_store_dwordx4 v[244:247], v4, s[88:91], s21 offen sc1
 s_add_u32 s21, s21, 65536
 buffer_store_dwordx4 v[244:247], v4, s[88:91], s21 offen sc1
 s_add_u32 s21, s21, 65536
 buffer_store_dwordx4 v[244:247], v4, s[88:91], s21 offen sc1
 s_add_u32 s21, s21, 65536
 buffer_store_dwordx4 v[244:247], v4, s[88:91], s21 offen sc1
 s_add_u32 s21, s21, 65536
 buffer_store_dwordx4 v[244:247], v4, s[88:91], s21 offen sc1
 s_add_u32 s21, s21, 65536
 buffer_store_dwordx4 v[244:247], v4, s[88:91], s21 offen sc1
 s_add_u32 s21, s21, 65536
 buffer_store_dwordx4 v[244:247], v4, s[88:91], s21 offen sc1
 s_add_u32 s21, s21, 65536
 buffer_store_dwordx4 v[244:247], v4, s[88:91], s21 offen sc1
 s_add_u32 s21, s21, 65536
 buffer_store_dwordx4 v[244:247], v4, s[88:91], s21 offen sc1
 s_add_u32 s21, s21, 65536
 s_add_u32 s21, s57, s55
 buffer_store_dwordx4 v[244:247], v4, s[88:91], s21 offen sc1
 buffer_store_dwordx4 v[244:247], v4, s[88:91], s21 offen offset:1024 sc1
 s_xor_b32 s21, s57, 8192
 s_add_u32 s21, s21, s58
 buffer_store_dwordx4 v[244:247], v4, s[88:91], s21 offen offset:0 sc1
 buffer_store_dwordx4 v[244:247], v4, s[88:91], s21 offen offset:1024 sc1
 buffer_store_dwordx4 v[244:247], v4, s[88:91], s21 offen offset:2048 sc1
 s_add_u32 s56, s56, 4
 s_cmp_lt_u32 s56, 64
 s_cbranch_scc1 arm_176
arm_175:
 s_cmp_ge_u32 s45, 64
 s_cbranch_scc1 vwd_154
 s_cmp_lg_u32 s23, 0
 s_cbranch_scc1 vwl_153
 s_branch vws_169
vws_159:
 v_cmp_gt_u32 vcc, 8, v9
 s_nop 0
 s_bitset1_b64 vcc, 19
 s_ff1_i32_b64 s21, vcc
 s_lshl_b32 s22, s21, 1
 s_lshl_b32 s21, s21, 2
 s_sub_i32 s21, s21, 12
 s_max_i32 s47, s21, s22
 s_cmp_gt_u32 s47, s45
 s_cbranch_scc1 va_179
 s_cmp_eq_u32 s70, s45
 s_cbranch_scc1 va_184
 s_nop 4
 v_cvt_pk_bf16_f32 v44, v104, v105
 v_cvt_pk_bf16_f32 v45, v106, v107
 v_cvt_pk_bf16_f32 v46, v108, v109
 v_cvt_pk_bf16_f32 v47, v110, v111
 s_add_u32 s69, s68, 4096
 buffer_store_dwordx4 v[44:47], v4, s[24:27], s69 offen offset:1024 sc1
 v_cvt_pk_bf16_f32 v48, v112, v113
 v_cvt_pk_bf16_f32 v49, v114, v115
 v_cvt_pk_bf16_f32 v50, v116, v117
 v_cvt_pk_bf16_f32 v51, v118, v119
 buffer_store_dwordx4 v[48:51], v4, s[24:27], s69 offen offset:2048 sc1
 v_cvt_pk_bf16_f32 v52, v120, v121
 v_cvt_pk_bf16_f32 v53, v122, v123
 v_cvt_pk_bf16_f32 v54, v124, v125
 v_cvt_pk_bf16_f32 v55, v126, v127
 buffer_store_dwordx4 v[52:55], v4, s[24:27], s69 offen offset:3072 sc1
 v_cvt_pk_bf16_f32 v56, v128, v129
 v_cvt_pk_bf16_f32 v57, v130, v131
 v_cvt_pk_bf16_f32 v58, v132, v133
 v_cvt_pk_bf16_f32 v59, v134, v135
 s_add_u32 s69, s68, 8192
 buffer_store_dwordx4 v[56:59], v4, s[24:27], s69 offen offset:0 sc1
 v_cvt_pk_bf16_f32 v60, v136, v137
 v_cvt_pk_bf16_f32 v61, v138, v139
 v_cvt_pk_bf16_f32 v62, v140, v141
 v_cvt_pk_bf16_f32 v63, v142, v143
 buffer_store_dwordx4 v[60:63], v4, s[24:27], s69 offen offset:1024 sc1
 s_mov_b32 s68, 0x80000000
 s_mov_b32 s56, s68
 s_mov_b32 s57, s68
 s_waitcnt vmcnt(0)
 s_mov_b64 exec, 1
 v_mov_b32 v20, s45
 buffer_store_dword v20, v10, s[72:75], s44 offen sc1
 s_mov_b64 exec, -1
 s_mov_b32 s70, s45
 s_mov_b32 s40, 0
va_184:
 s_mov_b32 s101, 0
 s_branch va_182
va_180:
 s_sleep 8
va_182:
 buffer_load_dword v9, v5, s[72:75], s43 offen sc1
 s_add_u32 s101, s101, 1
 s_cmp_gt_u32 s101, 131072
 s_cbranch_scc1 main_end
 s_waitcnt vmcnt(0)
 v_cmp_gt_u32 vcc, 8, v9
 s_nop 0
 s_bitset1_b64 vcc, 19
 s_ff1_i32_b64 s21, vcc
 s_lshl_b32 s22, s21, 1
 s_lshl_b32 s21, s21, 2
 s_sub_i32 s21, s21, 12
 s_max_i32 s47, s21, s22
 s_cmp_gt_u32 s47, s45
 s_cbranch_scc0 va_180
va_179:
 s_add_u32 s22, s45, 6
 s_min_u32 s22, s22, s47
va_181:
 s_cmp_ge_u32 s46, s22
 s_cbranch_scc1 va_183
 s_mov_b32 m0, s64
 s_mov_b32 s66, s41
 buffer_load_dwordx4 v4, s[16:19], s66 offen offset:0 sc1 lds
 buffer_load_dwordx4 v4, s[16:19], s66 offen offset:1024 sc1 lds
 buffer_load_dwordx4 v4, s[16:19], s66 offen offset:2048 sc1 lds
 s_add_u32 s46, s46, 1
 s_add_u32 s41, s41, 393216
 s_add_u32 s64, s64, 12288
 s_cmp_lt_u32 s64, s67
 s_cselect_b32 s64, s64, s71
 s_branch va_181
va_183:
 s_mov_b32 s48, s46
 s_mov_b32 s49, s46
 s_mov_b32 s50, s46
 s_waitcnt vmcnt(0)
 s_cmp_eq_u32 s40, 0
 s_cbranch_scc1 va_185
 s_mov_b32 s40, 0
 s_mov_b64 exec, 1
 v_mov_b32 v20, s45
 buffer_store_dword v20, v10, s[72:75], s44 offen sc1
 s_mov_b64 exec, -1
 s_mov_b32 s70, s45
va_185:
 s_barrier
 ds_read_b128 v[192:195], v8 offset:0
 ds_read_b128 v[196:199], v8 offset:1024
 ds_read_b128 v[200:203], v8 offset:2048
 ds_read_b128 v[204:207], v8 offset:3072
 ds_read_b128 v[208:211], v8 offset:4096
 ds_read_b128 v[212:215], v8 offset:5120
 ds_read_b128 v[216:219], v8 offset:6144
 ds_read_b128 v[220:223], v8 offset:7168
 ds_read_b128 v[224:227], v8 offset:8192
 ds_read_b128 v[228:231], v8 offset:9216
 ds_read_b128 v[232:235], v8 offset:10240
 ds_read_b128 v[236:239], v8 offset:11264
 s_branch vwb_160
vws_169:
 v_cmp_gt_u32 vcc, 8, v9
 s_nop 0
 s_bitset1_b64 vcc, 19
 s_ff1_i32_b64 s21, vcc
 s_lshl_b32 s22, s21, 1
 s_lshl_b32 s21, s21, 2
 s_sub_i32 s21, s21, 12
 s_max_i32 s47, s21, s22
 s_cmp_gt_u32 s47, s45
 s_cbranch_scc1 va_186
 s_cmp_eq_u32 s70, s45
 s_cbranch_scc1 va_191
 s_nop 4
 v_cvt_pk_bf16_f32 v44, v104, v105
 v_cvt_pk_bf16_f32 v45, v106, v107
 v_cvt_pk_bf16_f32 v46, v108, v109
 v_cvt_pk_bf16_f32 v47, v110, v111
 s_add_u32 s69, s68, 4096
 buffer_store_dwordx4 v[44:47], v4, s[24:27], s69 offen offset:1024 sc1
 v_cvt_pk_bf16_f32 v48, v112, v113
 v_cvt_pk_bf16_f32 v49, v114, v115
 v_cvt_pk_bf16_f32 v50, v116, v117
 v_cvt_pk_bf16_f32 v51, v118, v119
 buffer_store_dwordx4 v[48:51], v4, s[24:27], s69 offen offset:2048 sc1
 v_cvt_pk_bf16_f32 v52, v120, v121
 v_cvt_pk_bf16_f32 v53, v122, v123
 v_cvt_pk_bf16_f32 v54, v124, v125
 v_cvt_pk_bf16_f32 v55, v126, v127
 buffer_store_dwordx4 v[52:55], v4, s[24:27], s69 offen offset:3072 sc1
 v_cvt_pk_bf16_f32 v56, v128, v129
 v_cvt_pk_bf16_f32 v57, v130, v131
 v_cvt_pk_bf16_f32 v58, v132, v133
 v_cvt_pk_bf16_f32 v59, v134, v135
 s_add_u32 s69, s68, 8192
 buffer_store_dwordx4 v[56:59], v4, s[24:27], s69 offen offset:0 sc1
 v_cvt_pk_bf16_f32 v60, v136, v137
 v_cvt_pk_bf16_f32 v61, v138, v139
 v_cvt_pk_bf16_f32 v62, v140, v141
 v_cvt_pk_bf16_f32 v63, v142, v143
 buffer_store_dwordx4 v[60:63], v4, s[24:27], s69 offen offset:1024 sc1
 s_mov_b32 s68, 0x80000000
 s_mov_b32 s56, s68
 s_mov_b32 s57, s68
 s_waitcnt vmcnt(0)
 s_mov_b64 exec, 1
 v_mov_b32 v20, s45
 buffer_store_dword v20, v10, s[72:75], s44 offen sc1
 s_mov_b64 exec, -1
 s_mov_b32 s70, s45
 s_mov_b32 s40, 0
va_191:
 s_mov_b32 s101, 0
 s_branch va_189
va_187:
 s_sleep 8
va_189:
 buffer_load_dword v9, v5, s[72:75], s43 offen sc1
 s_add_u32 s101, s101, 1
 s_cmp_gt_u32 s101, 131072
 s_cbranch_scc1 main_end
 s_waitcnt vmcnt(0)
 v_cmp_gt_u32 vcc, 8, v9
 s_nop 0
 s_bitset1_b64 vcc, 19
 s_ff1_i32_b64 s21, vcc
 s_lshl_b32 s22, s21, 1
 s_lshl_b32 s21, s21, 2
 s_sub_i32 s21, s21, 12
 s_max_i32 s47, s21, s22
 s_cmp_gt_u32 s47, s45
 s_cbranch_scc0 va_187
va_186:
 s_add_u32 s22, s45, 6
 s_min_u32 s22, s22, s47
va_188:
 s_cmp_ge_u32 s46, s22
 s_cbranch_scc1 va_190
 s_mov_b32 m0, s64
 s_mov_b32 s66, s41
 buffer_load_dwordx4 v4, s[16:19], s66 offen offset:0 sc1 lds
 buffer_load_dwordx4 v4, s[16:19], s66 offen offset:1024 sc1 lds
 buffer_load_dwordx4 v4, s[16:19], s66 offen offset:2048 sc1 lds
 s_add_u32 s46, s46, 1
 s_add_u32 s41, s41, 393216
 s_add_u32 s64, s64, 12288
 s_cmp_lt_u32 s64, s67
 s_cselect_b32 s64, s64, s71
 s_branch va_188
va_190:
 s_mov_b32 s48, s46
 s_mov_b32 s49, s46
 s_mov_b32 s50, s46
 s_waitcnt vmcnt(0)
 s_cmp_eq_u32 s40, 0
 s_cbranch_scc1 va_192
 s_mov_b32 s40, 0
 s_mov_b64 exec, 1
 v_mov_b32 v20, s45
 buffer_store_dword v20, v10, s[72:75], s44 offen sc1
 s_mov_b64 exec, -1
 s_mov_b32 s70, s45
va_192:
 s_barrier
 ds_read_b128 v[144:147], v8 offset:0
 ds_read_b128 v[148:151], v8 offset:1024
 ds_read_b128 v[152:155], v8 offset:2048
 ds_read_b128 v[156:159], v8 offset:3072
 ds_read_b128 v[160:163], v8 offset:4096
 ds_read_b128 v[164:167], v8 offset:5120
 ds_read_b128 v[168:171], v8 offset:6144
 ds_read_b128 v[172:175], v8 offset:7168
 ds_read_b128 v[176:179], v8 offset:8192
 ds_read_b128 v[180:183], v8 offset:9216
 ds_read_b128 v[184:187], v8 offset:10240
 ds_read_b128 v[188:191], v8 offset:11264
 s_branch vwl_153
vwe_161:
 s_nop 4
 v_cvt_pk_bf16_f32 v44, v104, v105
 v_cvt_pk_bf16_f32 v45, v106, v107
 v_cvt_pk_bf16_f32 v46, v108, v109
 v_cvt_pk_bf16_f32 v47, v110, v111
 s_add_u32 s69, s68, 4096
 buffer_store_dwordx4 v[44:47], v4, s[24:27], s69 offen offset:1024 sc1
 v_cvt_pk_bf16_f32 v48, v112, v113
 v_cvt_pk_bf16_f32 v49, v114, v115
 v_cvt_pk_bf16_f32 v50, v116, v117
 v_cvt_pk_bf16_f32 v51, v118, v119
 buffer_store_dwordx4 v[48:51], v4, s[24:27], s69 offen offset:2048 sc1
 v_cvt_pk_bf16_f32 v52, v120, v121
 v_cvt_pk_bf16_f32 v53, v122, v123
 v_cvt_pk_bf16_f32 v54, v124, v125
 v_cvt_pk_bf16_f32 v55, v126, v127
 buffer_store_dwordx4 v[52:55], v4, s[24:27], s69 offen offset:3072 sc1
 v_cvt_pk_bf16_f32 v56, v128, v129
 v_cvt_pk_bf16_f32 v57, v130, v131
 v_cvt_pk_bf16_f32 v58, v132, v133
 v_cvt_pk_bf16_f32 v59, v134, v135
 s_add_u32 s69, s68, 8192
 buffer_store_dwordx4 v[56:59], v4, s[24:27], s69 offen offset:0 sc1
 v_cvt_pk_bf16_f32 v60, v136, v137
 v_cvt_pk_bf16_f32 v61, v138, v139
 v_cvt_pk_bf16_f32 v62, v140, v141
 v_cvt_pk_bf16_f32 v63, v142, v143
 buffer_store_dwordx4 v[60:63], v4, s[24:27], s69 offen offset:1024 sc1
 s_mov_b32 s68, 0x80000000
 s_mov_b32 s56, s68
 s_mov_b32 s57, s68
 s_cmp_le_u32 s45, 4
 s_cselect_b32 s40, 3, 1
 s_branch vwe_162
vwe_171:
 s_nop 4
 v_cvt_pk_bf16_f32 v44, v104, v105
 v_cvt_pk_bf16_f32 v45, v106, v107
 v_cvt_pk_bf16_f32 v46, v108, v109
 v_cvt_pk_bf16_f32 v47, v110, v111
 s_add_u32 s69, s68, 4096
 buffer_store_dwordx4 v[44:47], v4, s[24:27], s69 offen offset:1024 sc1
 v_cvt_pk_bf16_f32 v48, v112, v113
 v_cvt_pk_bf16_f32 v49, v114, v115
 v_cvt_pk_bf16_f32 v50, v116, v117
 v_cvt_pk_bf16_f32 v51, v118, v119
 buffer_store_dwordx4 v[48:51], v4, s[24:27], s69 offen offset:2048 sc1
 v_cvt_pk_bf16_f32 v52, v120, v121
 v_cvt_pk_bf16_f32 v53, v122, v123
 v_cvt_pk_bf16_f32 v54, v124, v125
 v_cvt_pk_bf16_f32 v55, v126, v127
 buffer_store_dwordx4 v[52:55], v4, s[24:27], s69 offen offset:3072 sc1
 v_cvt_pk_bf16_f32 v56, v128, v129
 v_cvt_pk_bf16_f32 v57, v130, v131
 v_cvt_pk_bf16_f32 v58, v132, v133
 v_cvt_pk_bf16_f32 v59, v134, v135
 s_add_u32 s69, s68, 8192
 buffer_store_dwordx4 v[56:59], v4, s[24:27], s69 offen offset:0 sc1
 v_cvt_pk_bf16_f32 v60, v136, v137
 v_cvt_pk_bf16_f32 v61, v138, v139
 v_cvt_pk_bf16_f32 v62, v140, v141
 v_cvt_pk_bf16_f32 v63, v142, v143
 buffer_store_dwordx4 v[60:63], v4, s[24:27], s69 offen offset:1024 sc1
 s_mov_b32 s68, 0x80000000
 s_mov_b32 s56, s68
 s_mov_b32 s57, s68
 s_cmp_le_u32 s45, 4
 s_cselect_b32 s40, 3, 1
 s_branch vwe_172
vwx_155:
 s_waitcnt vmcnt(8)
 s_branch vwx_156
vwx_165:
 s_waitcnt vmcnt(8)
 s_branch vwx_166
vwm_157:
 s_mov_b32 s40, 0
 s_waitcnt vmcnt(10)
 s_mov_b64 exec, 1
 v_mov_b32 v20, s45
 buffer_store_dword v20, v10, s[72:75], s44 offen sc1
 s_mov_b64 exec, -1
 s_mov_b32 s70, s45
 s_branch vwm_158
vwm_167:
 s_mov_b32 s40, 0
 s_waitcnt vmcnt(10)
 s_mov_b64 exec, 1
 v_mov_b32 v20, s45
 buffer_store_dword v20, v10, s[72:75], s44 offen sc1
 s_mov_b64 exec, -1
 s_mov_b32 s70, s45
 s_branch vwm_168
vwd_154:
 s_nop 4
 v_cvt_pk_bf16_f32 v44, v104, v105
 v_cvt_pk_bf16_f32 v45, v106, v107
 v_cvt_pk_bf16_f32 v46, v108, v109
 v_cvt_pk_bf16_f32 v47, v110, v111
 s_add_u32 s69, s68, 4096
 buffer_store_dwordx4 v[44:47], v4, s[24:27], s69 offen offset:1024 sc1
 v_cvt_pk_bf16_f32 v48, v112, v113
 v_cvt_pk_bf16_f32 v49, v114, v115
 v_cvt_pk_bf16_f32 v50, v116, v117
 v_cvt_pk_bf16_f32 v51, v118, v119
 buffer_store_dwordx4 v[48:51], v4, s[24:27], s69 offen offset:2048 sc1
 v_cvt_pk_bf16_f32 v52, v120, v121
 v_cvt_pk_bf16_f32 v53, v122, v123
 v_cvt_pk_bf16_f32 v54, v124, v125
 v_cvt_pk_bf16_f32 v55, v126, v127
 buffer_store_dwordx4 v[52:55], v4, s[24:27], s69 offen offset:3072 sc1
 v_cvt_pk_bf16_f32 v56, v128, v129
 v_cvt_pk_bf16_f32 v57, v130, v131
 v_cvt_pk_bf16_f32 v58, v132, v133
 v_cvt_pk_bf16_f32 v59, v134, v135
 s_add_u32 s69, s68, 8192
 buffer_store_dwordx4 v[56:59], v4, s[24:27], s69 offen offset:0 sc1
 v_cvt_pk_bf16_f32 v60, v136, v137
 v_cvt_pk_bf16_f32 v61, v138, v139
 v_cvt_pk_bf16_f32 v62, v140, v141
 v_cvt_pk_bf16_f32 v63, v142, v143
 buffer_store_dwordx4 v[60:63], v4, s[24:27], s69 offen offset:1024 sc1
 s_waitcnt vmcnt(0)
 s_mov_b64 exec, 1
 v_mov_b32 v20, s45
 buffer_store_dword v20, v10, s[72:75], s44 offen sc1
 s_mov_b64 exec, -1
 s_mov_b32 s84, 0
 s_mov_b32 s85, -1
 s_and_b32 s21, s3, 3
 s_cmp_lt_u32 s21, 2
 s_cbranch_scc1 queue
 s_sub_u32 s22, s21, 2
 s_lshl_b32 s22, s22, 3
 s_bfe_u32 s21, s3, 0x30002
 s_add_u32 s21, s21, s22
 s_add_u32 s87, s21, 264
 s_add_u32 s21, s21, 48
 s_mov_b32 s87, -1
 s_waitcnt vmcnt(0) lgkmcnt(0)
 s_barrier
 s_branch do_opb2
 s_mov_b32 s84, 0
 s_mov_b32 s85, -1
 s_mov_b32 s86, 0
 s_branch queue
not_vw:
 s_sub_u32 s2, s3, 96
armed:
 s_load_dwordx2 s[72:73], s[0:1], 104
 s_waitcnt lgkmcnt(0)
 s_add_u32 s72, s72, 81068032
 s_addc_u32 s73, s73, 0
 s_mov_b32 s74, 129024
 s_mov_b32 s75, 0x00020000
 s_load_dwordx2 s[4:5], s[0:1], 0
 s_load_dwordx2 s[6:7], s[0:1], 64
 s_load_dwordx2 s[38:39], s[0:1], 104
 s_mov_b32 s64, s32
 s_mov_b32 s65, s33
 s_mov_b32 s66, s34
 s_mov_b32 s67, s35
 s_lshr_b32 s41, s2, 1
 s_and_b32 s42, s2, 1
 s_waitcnt lgkmcnt(0)
 s_mov_b32 s8, s4
 s_mov_b32 s9, s5
 s_mov_b32 s10, 2621440
 s_mov_b32 s11, 0x00020000
 s_mov_b32 s12, s6
 s_mov_b32 s13, s7
 s_mov_b32 s14, 2457600
 s_mov_b32 s15, 0x00020000
 s_add_u32 s16, s38, 70713344
 s_addc_u32 s17, s39, 0
 s_mov_b32 s18, 2641920
 s_mov_b32 s19, 0x00020000
 s_add_u32 s72, s38, 81068032
 s_addc_u32 s73, s39, 0
 s_mov_b32 s74, 129024
 s_mov_b32 s75, 0x00020000
 s_lshl_b32 s21, s2, 2
 s_add_u32 s21, s21, s20
 s_mul_i32 s21, s21, 19200
 v_lshlrev_b32 v5, 4, v1
 buffer_load_dwordx4 v[64:67], v5, s[12:15], s21 offen offset:0
 buffer_load_dwordx4 v[64:67], v5, s[12:15], s21 offen offset:1024
 buffer_load_dwordx4 v[64:67], v5, s[12:15], s21 offen offset:2048
 buffer_load_dwordx4 v[64:67], v5, s[12:15], s21 offen offset:3072
 s_add_u32 s21, s21, 4096
 buffer_load_dwordx4 v[64:67], v5, s[12:15], s21 offen offset:0
 buffer_load_dwordx4 v[64:67], v5, s[12:15], s21 offen offset:1024
 buffer_load_dwordx4 v[64:67], v5, s[12:15], s21 offen offset:2048
 buffer_load_dwordx4 v[64:67], v5, s[12:15], s21 offen offset:3072
 s_add_u32 s21, s21, 4096
 buffer_load_dwordx4 v[64:67], v5, s[12:15], s21 offen offset:0
 buffer_load_dwordx4 v[64:67], v5, s[12:15], s21 offen offset:1024
 buffer_load_dwordx4 v[64:67], v5, s[12:15], s21 offen offset:2048
 buffer_load_dwordx4 v[64:67], v5, s[12:15], s21 offen offset:3072
 s_add_u32 s21, s21, 4096
 buffer_load_dwordx4 v[64:67], v5, s[12:15], s21 offen offset:0
 buffer_load_dwordx4 v[64:67], v5, s[12:15], s21 offen offset:1024
 buffer_load_dwordx4 v[64:67], v5, s[12:15], s21 offen offset:2048
 buffer_load_dwordx4 v[64:67], v5, s[12:15], s21 offen offset:3072
 s_add_u32 s21, s21, 4096
 buffer_load_dwordx4 v[64:67], v5, s[12:15], s21 offen offset:0
 buffer_load_dwordx4 v[64:67], v5, s[12:15], s21 offen offset:1024
 buffer_load_dwordx4 v[64:67], v5, s[12:15], s21 offen offset:2048
 s_waitcnt vmcnt(0)
 v_lshlrev_b32 v6, 1, v3
 v_add_u32 v6, 0, v6
 v_xor_b32 v6, v6, v2
 v_min_u32 v6, 14, v6
 v_mul_u32_u24 v7, 52, v6
 v_lshrrev_b32 v7, 8, v7
 v_mul_u32_u24 v7, 1200, v7
 v_lshl_add_u32 v7, v6, 4, v7
 v_mul_u32_u24 v6, 3840, v3
 v_add_u32 v4, v6, v7
 v_lshlrev_b32 v6, 1, v3
 v_add_u32 v6, 8, v6
 v_xor_b32 v6, v6, v2
 v_min_u32 v6, 14, v6
 v_mul_u32_u24 v7, 52, v6
 v_lshrrev_b32 v7, 8, v7
 v_mul_u32_u24 v7, 1200, v7
 v_lshl_add_u32 v7, v6, 4, v7
 v_mul_u32_u24 v6, 3840, v3
 v_add_u32 v5, v6, v7
 s_mul_i32 s21, s41, 80
 s_mul_i32 s22, s20, 15360
 s_add_u32 s21, s21, s22
 s_lshl_b32 s22, s20, 10
 s_cmp_ge_u32 s20, 2
 s_cselect_b64 vcc, -1, 0
 v_cndmask_b32 v4, v4, v5, vcc
 s_add_u32 m0, s22, 0
 s_nop 0
 buffer_load_dwordx4 v4, s[12:15], s21 offen lds
 s_add_u32 s21, s21, 61440
 s_add_u32 m0, s22, 4096
 s_nop 0
 buffer_load_dwordx4 v4, s[12:15], s21 offen lds
 s_add_u32 s21, s21, 61440
 s_add_u32 m0, s22, 8192
 s_nop 0
 buffer_load_dwordx4 v4, s[12:15], s21 offen lds
 s_add_u32 s21, s21, 61440
 s_add_u32 m0, s22, 12288
 s_nop 0
 buffer_load_dwordx4 v4, s[12:15], s21 offen lds
 s_add_u32 s21, s21, 61440
 s_add_u32 m0, s22, 16384
 s_nop 0
 buffer_load_dwordx4 v4, s[12:15], s21 offen lds
 s_add_u32 s21, s21, 61440
 s_add_u32 m0, s22, 20480
 s_nop 0
 buffer_load_dwordx4 v4, s[12:15], s21 offen lds
 s_add_u32 s21, s21, 61440
 s_add_u32 m0, s22, 24576
 s_nop 0
 buffer_load_dwordx4 v4, s[12:15], s21 offen lds
 s_add_u32 s21, s21, 61440
 s_add_u32 m0, s22, 28672
 s_nop 0
 buffer_load_dwordx4 v4, s[12:15], s21 offen lds
 s_add_u32 s21, s21, 61440
 s_add_u32 m0, s22, 32768
 s_nop 0
 buffer_load_dwordx4 v4, s[12:15], s21 offen lds
 s_add_u32 s21, s21, 61440
 s_add_u32 m0, s22, 36864
 s_nop 0
 buffer_load_dwordx4 v4, s[12:15], s21 offen lds
 s_add_u32 s21, s21, 61440
 s_add_u32 m0, s22, 40960
 s_nop 0
 buffer_load_dwordx4 v4, s[12:15], s21 offen lds
 s_add_u32 s21, s21, 61440
 s_add_u32 m0, s22, 45056
 s_nop 0
 buffer_load_dwordx4 v4, s[12:15], s21 offen lds
 s_add_u32 s21, s21, 61440
 s_add_u32 m0, s22, 49152
 s_nop 0
 buffer_load_dwordx4 v4, s[12:15], s21 offen lds
 s_add_u32 s21, s21, 61440
 s_add_u32 m0, s22, 53248
 s_nop 0
 buffer_load_dwordx4 v4, s[12:15], s21 offen lds
 s_add_u32 s21, s21, 61440
 s_add_u32 m0, s22, 57344
 s_nop 0
 buffer_load_dwordx4 v4, s[12:15], s21 offen lds
 s_add_u32 s21, s21, 61440
 s_add_u32 m0, s22, 61440
 s_nop 0
 buffer_load_dwordx4 v4, s[12:15], s21 offen lds
 s_add_u32 s21, s21, 61440
 s_add_u32 m0, s22, 65536
 s_nop 0
 buffer_load_dwordx4 v4, s[12:15], s21 offen lds
 s_add_u32 s21, s21, 61440
 s_add_u32 m0, s22, 69632
 s_nop 0
 buffer_load_dwordx4 v4, s[12:15], s21 offen lds
 s_add_u32 s21, s21, 61440
 s_add_u32 m0, s22, 73728
 s_nop 0
 buffer_load_dwordx4 v4, s[12:15], s21 offen lds
 s_add_u32 s21, s21, 61440
 s_add_u32 m0, s22, 77824
 s_nop 0
 buffer_load_dwordx4 v4, s[12:15], s21 offen lds
 s_add_u32 s21, s21, 61440
 s_add_u32 m0, s22, 81920
 s_nop 0
 buffer_load_dwordx4 v4, s[12:15], s21 offen lds
 s_add_u32 s21, s21, 61440
 s_add_u32 m0, s22, 86016
 s_nop 0
 buffer_load_dwordx4 v4, s[12:15], s21 offen lds
 s_add_u32 s21, s21, 61440
 s_add_u32 m0, s22, 90112
 s_nop 0
 buffer_load_dwordx4 v4, s[12:15], s21 offen lds
 s_add_u32 s21, s21, 61440
 s_add_u32 m0, s22, 94208
 s_nop 0
 buffer_load_dwordx4 v4, s[12:15], s21 offen lds
 s_add_u32 s21, s21, 61440
 s_add_u32 m0, s22, 98304
 s_nop 0
 buffer_load_dwordx4 v4, s[12:15], s21 offen lds
 s_add_u32 s21, s21, 61440
 s_add_u32 m0, s22, 102400
 s_nop 0
 buffer_load_dwordx4 v4, s[12:15], s21 offen lds
 s_add_u32 s21, s21, 61440
 s_add_u32 m0, s22, 106496
 s_nop 0
 buffer_load_dwordx4 v4, s[12:15], s21 offen lds
 s_add_u32 s21, s21, 61440
 s_add_u32 m0, s22, 110592
 s_nop 0
 buffer_load_dwordx4 v4, s[12:15], s21 offen lds
 s_add_u32 s21, s21, 61440
 s_add_u32 m0, s22, 114688
 s_nop 0
 buffer_load_dwordx4 v4, s[12:15], s21 offen lds
 s_add_u32 s21, s21, 61440
 s_add_u32 m0, s22, 118784
 s_nop 0
 buffer_load_dwordx4 v4, s[12:15], s21 offen lds
 s_add_u32 s21, s21, 61440
 s_add_u32 m0, s22, 122880
 s_nop 0
 buffer_load_dwordx4 v4, s[12:15], s21 offen lds
 s_add_u32 s21, s21, 61440
 s_add_u32 m0, s22, 126976
 s_nop 0
 buffer_load_dwordx4 v4, s[12:15], s21 offen lds
 s_add_u32 s21, s21, 61440
 s_add_u32 m0, s22, 131072
 s_nop 0
 buffer_load_dwordx4 v4, s[12:15], s21 offen lds
 s_add_u32 s21, s21, 61440
 s_add_u32 m0, s22, 135168
 s_nop 0
 buffer_load_dwordx4 v4, s[12:15], s21 offen lds
 s_add_u32 s21, s21, 61440
 s_add_u32 m0, s22, 139264
 s_nop 0
 buffer_load_dwordx4 v4, s[12:15], s21 offen lds
 s_add_u32 s21, s21, 61440
 s_add_u32 m0, s22, 143360
 s_nop 0
 buffer_load_dwordx4 v4, s[12:15], s21 offen lds
 s_add_u32 s21, s21, 61440
 s_add_u32 m0, s22, 147456
 s_nop 0
 buffer_load_dwordx4 v4, s[12:15], s21 offen lds
 s_add_u32 s21, s21, 61440
 s_add_u32 m0, s22, 151552
 s_nop 0
 buffer_load_dwordx4 v4, s[12:15], s21 offen lds
 s_add_u32 s21, s21, 61440
 s_add_u32 m0, s22, 155648
 s_nop 0
 buffer_load_dwordx4 v4, s[12:15], s21 offen lds
 s_add_u32 s21, s21, 61440
 s_add_u32 m0, s22, 159744
 s_nop 0
 buffer_load_dwordx4 v4, s[12:15], s21 offen lds
 s_add_u32 s21, s21, 61440
 s_lshl_b32 s21, s2, 2
 s_add_u32 s21, s21, s20
 s_mul_i32 s21, s21, 20480
 v_lshlrev_b32 v5, 4, v1
 buffer_load_dwordx4 v[64:67], v5, s[8:11], s21 offen offset:0
 buffer_load_dwordx4 v[64:67], v5, s[8:11], s21 offen offset:1024
 buffer_load_dwordx4 v[64:67], v5, s[8:11], s21 offen offset:2048
 buffer_load_dwordx4 v[64:67], v5, s[8:11], s21 offen offset:3072
 s_add_u32 s21, s21, 4096
 buffer_load_dwordx4 v[64:67], v5, s[8:11], s21 offen offset:0
 buffer_load_dwordx4 v[64:67], v5, s[8:11], s21 offen offset:1024
 buffer_load_dwordx4 v[64:67], v5, s[8:11], s21 offen offset:2048
 buffer_load_dwordx4 v[64:67], v5, s[8:11], s21 offen offset:3072
 s_add_u32 s21, s21, 4096
 buffer_load_dwordx4 v[64:67], v5, s[8:11], s21 offen offset:0
 buffer_load_dwordx4 v[64:67], v5, s[8:11], s21 offen offset:1024
 buffer_load_dwordx4 v[64:67], v5, s[8:11], s21 offen offset:2048
 buffer_load_dwordx4 v[64:67], v5, s[8:11], s21 offen offset:3072
 s_add_u32 s21, s21, 4096
 buffer_load_dwordx4 v[64:67], v5, s[8:11], s21 offen offset:0
 buffer_load_dwordx4 v[64:67], v5, s[8:11], s21 offen offset:1024
 buffer_load_dwordx4 v[64:67], v5, s[8:11], s21 offen offset:2048
 buffer_load_dwordx4 v[64:67], v5, s[8:11], s21 offen offset:3072
 s_add_u32 s21, s21, 4096
 buffer_load_dwordx4 v[64:67], v5, s[8:11], s21 offen offset:0
 buffer_load_dwordx4 v[64:67], v5, s[8:11], s21 offen offset:1024
 buffer_load_dwordx4 v[64:67], v5, s[8:11], s21 offen offset:2048
 buffer_load_dwordx4 v[64:67], v5, s[8:11], s21 offen offset:3072
 v_lshrrev_b32 v6, 2, v2
 v_lshl_add_u32 v7, v3, 3, v6
 v_and_b32 v8, 1, v3
 v_lshl_add_u32 v6, v8, 2, v6
 v_lshlrev_b32 v6, 1, v6
 v_bfe_u32 v8, v2, 1, 1
 s_lshl_b32 s21, s20, 2
 v_add_u32 v8, s21, v8
 v_and_b32 v9, 1, v2
 v_lshlrev_b32 v9, 3, v9
 v_lshl_add_u32 v9, v7, 8, v9
 v_add_u32 v5, 0, v8
 v_xor_b32 v5, v5, v6
 v_lshl_add_u32 v44, v5, 4, v9
 v_add_u32 v45, 65536, v44
 v_add_u32 v46, 131072, v44
 v_add_u32 v5, 2, v8
 v_xor_b32 v5, v5, v6
 v_lshl_add_u32 v47, v5, 4, v9
 v_add_u32 v48, 65536, v47
 v_add_u32 v49, 131072, v47
 s_waitcnt vmcnt(50) lgkmcnt(0)
 s_barrier
 ds_read_b64_tr_b16 a[0:1], v44 offset:0
 ds_read_b64_tr_b16 a[2:3], v44 offset:1024
 ds_read_b64_tr_b16 a[4:5], v47 offset:0
 ds_read_b64_tr_b16 a[6:7], v47 offset:1024
 ds_read_b64_tr_b16 a[8:9], v44 offset:8192
 ds_read_b64_tr_b16 a[10:11], v44 offset:9216
 ds_read_b64_tr_b16 a[12:13], v47 offset:8192
 ds_read_b64_tr_b16 a[14:15], v47 offset:9216
 ds_read_b64_tr_b16 a[16:17], v44 offset:16384
 ds_read_b64_tr_b16 a[18:19], v44 offset:17408
 ds_read_b64_tr_b16 a[20:21], v47 offset:16384
 ds_read_b64_tr_b16 a[22:23], v47 offset:17408
 ds_read_b64_tr_b16 a[24:25], v44 offset:24576
 ds_read_b64_tr_b16 a[26:27], v44 offset:25600
 ds_read_b64_tr_b16 a[28:29], v47 offset:24576
 ds_read_b64_tr_b16 a[30:31], v47 offset:25600
 ds_read_b64_tr_b16 a[32:33], v44 offset:32768
 ds_read_b64_tr_b16 a[34:35], v44 offset:33792
 ds_read_b64_tr_b16 a[36:37], v47 offset:32768
 ds_read_b64_tr_b16 a[38:39], v47 offset:33792
 s_waitcnt vmcnt(40) lgkmcnt(0)
 s_barrier
 ds_read_b64_tr_b16 a[40:41], v44 offset:40960
 ds_read_b64_tr_b16 a[42:43], v44 offset:41984
 ds_read_b64_tr_b16 a[44:45], v47 offset:40960
 ds_read_b64_tr_b16 a[46:47], v47 offset:41984
 ds_read_b64_tr_b16 a[48:49], v44 offset:49152
 ds_read_b64_tr_b16 a[50:51], v44 offset:50176
 ds_read_b64_tr_b16 a[52:53], v47 offset:49152
 ds_read_b64_tr_b16 a[54:55], v47 offset:50176
 ds_read_b64_tr_b16 a[56:57], v44 offset:57344
 ds_read_b64_tr_b16 a[58:59], v44 offset:58368
 ds_read_b64_tr_b16 a[60:61], v47 offset:57344
 ds_read_b64_tr_b16 a[62:63], v47 offset:58368
 ds_read_b64_tr_b16 a[64:65], v45 offset:0
 ds_read_b64_tr_b16 a[66:67], v45 offset:1024
 ds_read_b64_tr_b16 a[68:69], v48 offset:0
 ds_read_b64_tr_b16 a[70:71], v48 offset:1024
 ds_read_b64_tr_b16 a[72:73], v45 offset:8192
 ds_read_b64_tr_b16 a[74:75], v45 offset:9216
 ds_read_b64_tr_b16 a[76:77], v48 offset:8192
 ds_read_b64_tr_b16 a[78:79], v48 offset:9216
 s_waitcnt vmcnt(30) lgkmcnt(0)
 s_barrier
 s_mul_i32 s24, s42, 1280
 v_lshrrev_b32 v11, 3, v1
 v_and_b32 v12, 7, v1
 v_xor_b32 v12, v12, v11
 v_mul_u32_u24 v11, 2560, v11
 v_lshl_add_u32 v10, v12, 4, v11
 s_mul_i32 s46, s20, 81920
 v_add_u32 v10, s46, v10
 s_lshl_b32 s47, s20, 12
 s_add_u32 s47, s47, 0
 s_add_u32 s46, s47, 114688
 s_mov_b32 s30, s24
 s_add_u32 s32, s47, 0
 v_add_u32 v11, 19456, v10
 v_add_u32 v12, 38912, v10
 v_add_u32 v13, 58368, v10
 s_mov_b32 m0, s32
 s_nop 0
 buffer_load_dwordx4 v10, s[8:11], s30 offen offset:0 lds
 buffer_load_dwordx4 v11, s[8:11], s30 offen offset:1024 lds
 buffer_load_dwordx4 v12, s[8:11], s30 offen offset:2048 lds
 buffer_load_dwordx4 v13, s[8:11], s30 offen offset:3072 lds
 s_add_u32 s30, s30, 128
 s_add_u32 s32, s32, 16384
 s_cmp_lt_u32 s32, s46
 s_cselect_b32 s32, s32, s47
 s_mov_b32 m0, s32
 s_nop 0
 buffer_load_dwordx4 v10, s[8:11], s30 offen offset:0 lds
 buffer_load_dwordx4 v11, s[8:11], s30 offen offset:1024 lds
 buffer_load_dwordx4 v12, s[8:11], s30 offen offset:2048 lds
 buffer_load_dwordx4 v13, s[8:11], s30 offen offset:3072 lds
 s_add_u32 s30, s30, 128
 s_add_u32 s32, s32, 16384
 s_cmp_lt_u32 s32, s46
 s_cselect_b32 s32, s32, s47
 s_mov_b32 m0, s32
 s_nop 0
 buffer_load_dwordx4 v10, s[8:11], s30 offen offset:0 lds
 buffer_load_dwordx4 v11, s[8:11], s30 offen offset:1024 lds
 buffer_load_dwordx4 v12, s[8:11], s30 offen offset:2048 lds
 buffer_load_dwordx4 v13, s[8:11], s30 offen offset:3072 lds
 s_add_u32 s30, s30, 128
 s_add_u32 s32, s32, 16384
 s_cmp_lt_u32 s32, s46
 s_cselect_b32 s32, s32, s47
 s_mov_b32 m0, s32
 s_nop 0
 buffer_load_dwordx4 v10, s[8:11], s30 offen offset:0 lds
 buffer_load_dwordx4 v11, s[8:11], s30 offen offset:1024 lds
 buffer_load_dwordx4 v12, s[8:11], s30 offen offset:2048 lds
 buffer_load_dwordx4 v13, s[8:11], s30 offen offset:3072 lds
 s_add_u32 s30, s30, 128
 s_add_u32 s32, s32, 16384
 s_cmp_lt_u32 s32, s46
 s_cselect_b32 s32, s32, s47
 s_mov_b32 m0, s32
 s_nop 0
 buffer_load_dwordx4 v10, s[8:11], s30 offen offset:0 lds
 buffer_load_dwordx4 v11, s[8:11], s30 offen offset:1024 lds
 buffer_load_dwordx4 v12, s[8:11], s30 offen offset:2048 lds
 buffer_load_dwordx4 v13, s[8:11], s30 offen offset:3072 lds
 s_add_u32 s30, s30, 128
 s_add_u32 s32, s32, 16384
 s_cmp_lt_u32 s32, s46
 s_cselect_b32 s32, s32, s47
 ds_read_b64_tr_b16 a[80:81], v45 offset:16384
 ds_read_b64_tr_b16 a[82:83], v45 offset:17408
 ds_read_b64_tr_b16 a[84:85], v48 offset:16384
 ds_read_b64_tr_b16 a[86:87], v48 offset:17408
 ds_read_b64_tr_b16 a[88:89], v45 offset:24576
 ds_read_b64_tr_b16 a[90:91], v45 offset:25600
 ds_read_b64_tr_b16 a[92:93], v48 offset:24576
 ds_read_b64_tr_b16 a[94:95], v48 offset:25600
 ds_read_b64_tr_b16 a[96:97], v45 offset:32768
 ds_read_b64_tr_b16 a[98:99], v45 offset:33792
 ds_read_b64_tr_b16 a[100:101], v48 offset:32768
 ds_read_b64_tr_b16 a[102:103], v48 offset:33792
 ds_read_b64_tr_b16 a[104:105], v45 offset:40960
 ds_read_b64_tr_b16 a[106:107], v45 offset:41984
 ds_read_b64_tr_b16 a[108:109], v48 offset:40960
 ds_read_b64_tr_b16 a[110:111], v48 offset:41984
 ds_read_b64_tr_b16 a[112:113], v45 offset:49152
 ds_read_b64_tr_b16 a[114:115], v45 offset:50176
 ds_read_b64_tr_b16 a[116:117], v48 offset:49152
 ds_read_b64_tr_b16 a[118:119], v48 offset:50176
 s_waitcnt vmcnt(40) lgkmcnt(0)
 s_barrier
 ds_read_b64_tr_b16 a[120:121], v45 offset:57344
 ds_read_b64_tr_b16 a[122:123], v45 offset:58368
 ds_read_b64_tr_b16 a[124:125], v48 offset:57344
 ds_read_b64_tr_b16 a[126:127], v48 offset:58368
 ds_read_b64_tr_b16 a[128:129], v46 offset:0
 ds_read_b64_tr_b16 a[130:131], v46 offset:1024
 ds_read_b64_tr_b16 a[132:133], v49 offset:0
 ds_read_b64_tr_b16 a[134:135], v49 offset:1024
 ds_read_b64_tr_b16 a[136:137], v46 offset:8192
 ds_read_b64_tr_b16 a[138:139], v46 offset:9216
 ds_read_b64_tr_b16 a[140:141], v49 offset:8192
 ds_read_b64_tr_b16 a[142:143], v49 offset:9216
 ds_read_b64_tr_b16 a[144:145], v46 offset:16384
 ds_read_b64_tr_b16 a[146:147], v46 offset:17408
 ds_read_b64_tr_b16 a[148:149], v49 offset:16384
 ds_read_b64_tr_b16 a[150:151], v49 offset:17408
 ds_read_b64_tr_b16 a[152:153], v46 offset:24576
 ds_read_b64_tr_b16 a[154:155], v46 offset:25600
 ds_read_b64_tr_b16 a[156:157], v49 offset:24576
 ds_read_b64_tr_b16 a[158:159], v49 offset:25600
 s_waitcnt lgkmcnt(0)
 s_barrier
 s_load_dwordx2 s[12:13], s[0:1], 72
 s_lshl_b32 s21, s2, 2
 s_add_u32 s21, s21, s20
 s_mul_i32 s50, s21, 6400
 s_add_u32 s51, s50, 4096
 v_lshlrev_b32 v33, 4, v1
 s_mov_b32 s14, 819200
 v_mov_b32 v32, 76
 s_waitcnt lgkmcnt(0)
 v_and_b32 v4, 31, v1
 s_lshl_b32 s21, s20, 5
 v_add_u32 v36, s21, v4
 v_lshrrev_b32 v5, 5, v1
 v_mul_u32_u24 v6, 264, v36
 v_mul_u32_u24 v7, 40, v5
 s_mov_b32 s21, 114952
 v_add3_u32 v34, v6, v7, s21
 v_lshl_add_u32 v38, v5, 3, v34
 v_lshlrev_b32 v6, 5, v5
 v_sub_u32 v39, v34, v6
 v_lshlrev_b32 v35, 3, v1
 v_add_u32 v35, 114688, v35
 v_mov_b32 v37, 0xf149f2ca
 s_mul_i32 s21, s41, 165120
 s_mul_i32 s22, s42, 16512
 s_add_u32 s21, s21, s22
 v_lshl_add_u32 v7, v36, 4, s21
 v_mul_u32_u24 v6, 99072, v5
 v_add_u32 v29, v6, v7
 v_add_u32 v30, 33024, v29
 v_lshl_add_u32 v31, v5, 3, v7
 v_add_u32 v31, 66048, v31
 v_mov_b32 v8, 0
 v_mov_b32 v9, 0
 ds_write_b64 v35, v[8:9] offset:0
 ds_write_b64 v35, v[8:9] offset:512
 ds_write_b64 v35, v[8:9] offset:1024
 ds_write_b64 v35, v[8:9] offset:1536
 ds_write_b64 v35, v[8:9] offset:2048
 s_mul_i32 s24, s42, 1280
 s_mov_b32 s25, 327680
 s_mov_b32 s26, 8
 s_mov_b32 s27, 0
 s_mov_b32 s60, 0x3e64f92e
 s_mov_b32 s61, 0x3fb8aa3b
 s_mov_b32 s62, 0x05040100
 s_mov_b32 s63, 0x07060302
 v_cmp_le_u32 s[76:77], 0, v36
 v_cmp_le_u32 s[78:79], 1, v36
 v_cmp_le_u32 s[80:81], 2, v36
 v_cmp_le_u32 s[82:83], 3, v36
 v_cmp_le_u32 s[84:85], 4, v36
 v_cmp_le_u32 s[86:87], 5, v36
 v_cmp_le_u32 s[88:89], 6, v36
 v_cmp_le_u32 s[90:91], 7, v36
 v_and_b32 v6, 7, v2
 v_add_u32 v4, 0, v3
 v_xor_b32 v4, v4, v6
 v_lshlrev_b32 v4, 4, v4
 v_lshl_add_u32 v14, v2, 7, v4
 v_add_u32 v4, 4, v3
 v_xor_b32 v4, v4, v6
 v_lshlrev_b32 v4, 4, v4
 v_lshl_add_u32 v15, v2, 7, v4
 v_mul_u32_u24 v22, 264, v2
 v_mul_u32_u24 v4, 8, v3
 s_mul_i32 s21, s20, 64
 s_add_u32 s21, s21, 116800
 v_add3_u32 v22, v22, v4, s21
 v_lshlrev_b32 v4, 3, v3
 v_sub_u32 v16, v22, v4
 v_mov_b32 v9, 2731
 s_mov_b32 s33, 0
 s_mov_b32 s48, 0x80000000
 s_mov_b32 m0, s32
 s_nop 0
 buffer_load_dwordx4 v10, s[8:11], s30 offen offset:0 lds
 buffer_load_dwordx4 v11, s[8:11], s30 offen offset:1024 lds
 s_waitcnt vmcnt(18)
 s_barrier
 v_add_u32 v18, s33, v14
 v_add_u32 v19, s33, v15
 s_add_u32 s33, s33, 16384
 s_cmp_lt_u32 s33, 114688
 s_cselect_b32 s33, s33, 0
 ds_read_b128 v[160:163], v18 offset:0
 ds_read_b128 v[164:167], v18 offset:2048
 ds_read_b128 v[168:171], v18 offset:4096
 ds_read_b128 v[172:175], v18 offset:6144
 ds_read_b128 v[176:179], v18 offset:8192
 ds_read_b128 v[180:183], v18 offset:10240
 ds_read_b128 v[184:187], v18 offset:12288
 ds_read_b128 v[188:191], v18 offset:14336
 s_waitcnt lgkmcnt(0)
bf_blk_193:
 v_mfma_f32_16x16x32_bf16 v[64:67], a[0:3], v[160:163], 0
 ds_read_b128 v[192:195], v19 offset:0
 v_mfma_f32_16x16x32_bf16 v[68:71], a[4:7], v[160:163], 0
 v_add_u32 v18, s33, v14
 v_mfma_f32_16x16x32_bf16 v[72:75], a[0:3], v[164:167], 0
 ds_read_b128 v[196:199], v19 offset:2048
 v_mfma_f32_16x16x32_bf16 v[76:79], a[4:7], v[164:167], 0
 buffer_load_dwordx4 v12, s[8:11], s30 offen offset:2048 lds
 v_mfma_f32_16x16x32_bf16 v[80:83], a[0:3], v[168:171], 0
 ds_read_b128 v[200:203], v19 offset:4096
 v_mfma_f32_16x16x32_bf16 v[84:87], a[4:7], v[168:171], 0
 v_mfma_f32_16x16x32_bf16 v[88:91], a[0:3], v[172:175], 0
 ds_read_b128 v[204:207], v19 offset:6144
 v_mfma_f32_16x16x32_bf16 v[92:95], a[4:7], v[172:175], 0
 s_waitcnt lgkmcnt(14)
 v_mfma_f32_16x16x32_bf16 v[96:99], a[0:3], v[176:179], 0
 ds_read_b128 v[208:211], v19 offset:8192
 v_mfma_f32_16x16x32_bf16 v[100:103], a[4:7], v[176:179], 0
 v_mfma_f32_16x16x32_bf16 v[104:107], a[0:3], v[180:183], 0
 ds_read_b128 v[212:215], v19 offset:10240
 v_mfma_f32_16x16x32_bf16 v[108:111], a[4:7], v[180:183], 0
 buffer_load_dwordx4 v13, s[8:11], s30 offen offset:3072 lds
 v_mfma_f32_16x16x32_bf16 v[112:115], a[0:3], v[184:187], 0
 ds_read_b128 v[216:219], v19 offset:12288
 s_add_u32 s30, s30, 128
 v_mfma_f32_16x16x32_bf16 v[116:119], a[4:7], v[184:187], 0
 s_add_u32 m0, m0, 16384
 v_mfma_f32_16x16x32_bf16 v[120:123], a[0:3], v[188:191], 0
 ds_read_b128 v[220:223], v19 offset:14336
 v_mfma_f32_16x16x32_bf16 v[124:127], a[4:7], v[188:191], 0
 s_waitcnt vmcnt(16) lgkmcnt(4)
 s_barrier
 v_mfma_f32_16x16x32_bf16 v[64:67], a[8:11], v[192:195], v[64:67]
 ds_read_b128 v[160:163], v18 offset:0
 v_mfma_f32_16x16x32_bf16 v[68:71], a[12:15], v[192:195], v[68:71]
 s_cmp_lt_u32 m0, s46
 s_cselect_b32 m0, m0, s47
 v_mfma_f32_16x16x32_bf16 v[72:75], a[8:11], v[196:199], v[72:75]
 ds_read_b128 v[164:167], v18 offset:2048
 v_add_u32 v19, s33, v15
 v_mfma_f32_16x16x32_bf16 v[76:79], a[12:15], v[196:199], v[76:79]
 buffer_load_dwordx4 v10, s[8:11], s30 offen offset:0 lds
 v_mfma_f32_16x16x32_bf16 v[80:83], a[8:11], v[200:203], v[80:83]
 ds_read_b128 v[168:171], v18 offset:4096
 s_add_u32 s33, s33, 16384
 v_mfma_f32_16x16x32_bf16 v[84:87], a[12:15], v[200:203], v[84:87]
 s_cmp_lt_u32 s33, 114688
 s_cselect_b32 s33, s33, 0
 v_mfma_f32_16x16x32_bf16 v[88:91], a[8:11], v[204:207], v[88:91]
 ds_read_b128 v[172:175], v18 offset:6144
 v_mfma_f32_16x16x32_bf16 v[92:95], a[12:15], v[204:207], v[92:95]
 s_waitcnt lgkmcnt(4)
 v_mfma_f32_16x16x32_bf16 v[96:99], a[8:11], v[208:211], v[96:99]
 ds_read_b128 v[176:179], v18 offset:8192
 v_mfma_f32_16x16x32_bf16 v[100:103], a[12:15], v[208:211], v[100:103]
 v_mfma_f32_16x16x32_bf16 v[104:107], a[8:11], v[212:215], v[104:107]
 ds_read_b128 v[180:183], v18 offset:10240
 v_mfma_f32_16x16x32_bf16 v[108:111], a[12:15], v[212:215], v[108:111]
 buffer_load_dwordx4 v11, s[8:11], s30 offen offset:1024 lds
 v_mfma_f32_16x16x32_bf16 v[112:115], a[8:11], v[216:219], v[112:115]
 ds_read_b128 v[184:187], v18 offset:12288
 v_mfma_f32_16x16x32_bf16 v[116:119], a[12:15], v[216:219], v[116:119]
 v_mfma_f32_16x16x32_bf16 v[120:123], a[8:11], v[220:223], v[120:123]
 ds_read_b128 v[188:191], v18 offset:14336
 v_mfma_f32_16x16x32_bf16 v[124:127], a[12:15], v[220:223], v[124:127]
 s_waitcnt lgkmcnt(4)
 v_mfma_f32_16x16x32_bf16 v[64:67], a[16:19], v[160:163], v[64:67]
 ds_read_b128 v[192:195], v19 offset:0
 v_mfma_f32_16x16x32_bf16 v[68:71], a[20:23], v[160:163], v[68:71]
 v_add_u32 v18, s33, v14
 v_mfma_f32_16x16x32_bf16 v[72:75], a[16:19], v[164:167], v[72:75]
 ds_read_b128 v[196:199], v19 offset:2048
 v_mfma_f32_16x16x32_bf16 v[76:79], a[20:23], v[164:167], v[76:79]
 buffer_load_dwordx4 v12, s[8:11], s30 offen offset:2048 lds
 v_mfma_f32_16x16x32_bf16 v[80:83], a[16:19], v[168:171], v[80:83]
 ds_read_b128 v[200:203], v19 offset:4096
 v_mfma_f32_16x16x32_bf16 v[84:87], a[20:23], v[168:171], v[84:87]
 v_mfma_f32_16x16x32_bf16 v[88:91], a[16:19], v[172:175], v[88:91]
 ds_read_b128 v[204:207], v19 offset:6144
 v_mfma_f32_16x16x32_bf16 v[92:95], a[20:23], v[172:175], v[92:95]
 s_waitcnt lgkmcnt(4)
 v_mfma_f32_16x16x32_bf16 v[96:99], a[16:19], v[176:179], v[96:99]
 ds_read_b128 v[208:211], v19 offset:8192
 v_mfma_f32_16x16x32_bf16 v[100:103], a[20:23], v[176:179], v[100:103]
 v_mfma_f32_16x16x32_bf16 v[104:107], a[16:19], v[180:183], v[104:107]
 ds_read_b128 v[212:215], v19 offset:10240
 v_mfma_f32_16x16x32_bf16 v[108:111], a[20:23], v[180:183], v[108:111]
 buffer_load_dwordx4 v13, s[8:11], s30 offen offset:3072 lds
 v_mfma_f32_16x16x32_bf16 v[112:115], a[16:19], v[184:187], v[112:115]
 ds_read_b128 v[216:219], v19 offset:12288
 s_add_u32 s30, s30, 128
 v_mfma_f32_16x16x32_bf16 v[116:119], a[20:23], v[184:187], v[116:119]
 s_add_u32 m0, m0, 16384
 v_mfma_f32_16x16x32_bf16 v[120:123], a[16:19], v[188:191], v[120:123]
 ds_read_b128 v[220:223], v19 offset:14336
 v_mfma_f32_16x16x32_bf16 v[124:127], a[20:23], v[188:191], v[124:127]
 s_waitcnt vmcnt(16) lgkmcnt(4)
 s_barrier
 v_mfma_f32_16x16x32_bf16 v[64:67], a[24:27], v[192:195], v[64:67]
 ds_read_b128 v[160:163], v18 offset:0
 v_mfma_f32_16x16x32_bf16 v[68:71], a[28:31], v[192:195], v[68:71]
 s_cmp_lt_u32 m0, s46
 s_cselect_b32 m0, m0, s47
 v_mfma_f32_16x16x32_bf16 v[72:75], a[24:27], v[196:199], v[72:75]
 ds_read_b128 v[164:167], v18 offset:2048
 v_add_u32 v19, s33, v15
 v_mfma_f32_16x16x32_bf16 v[76:79], a[28:31], v[196:199], v[76:79]
 buffer_load_dwordx4 v10, s[8:11], s30 offen offset:0 lds
 v_mfma_f32_16x16x32_bf16 v[80:83], a[24:27], v[200:203], v[80:83]
 ds_read_b128 v[168:171], v18 offset:4096
 s_add_u32 s33, s33, 16384
 v_mfma_f32_16x16x32_bf16 v[84:87], a[28:31], v[200:203], v[84:87]
 s_cmp_lt_u32 s33, 114688
 s_cselect_b32 s33, s33, 0
 v_mfma_f32_16x16x32_bf16 v[88:91], a[24:27], v[204:207], v[88:91]
 ds_read_b128 v[172:175], v18 offset:6144
 v_mfma_f32_16x16x32_bf16 v[92:95], a[28:31], v[204:207], v[92:95]
 s_waitcnt lgkmcnt(4)
 v_mfma_f32_16x16x32_bf16 v[96:99], a[24:27], v[208:211], v[96:99]
 ds_read_b128 v[176:179], v18 offset:8192
 v_mfma_f32_16x16x32_bf16 v[100:103], a[28:31], v[208:211], v[100:103]
 v_mfma_f32_16x16x32_bf16 v[104:107], a[24:27], v[212:215], v[104:107]
 ds_read_b128 v[180:183], v18 offset:10240
 v_mfma_f32_16x16x32_bf16 v[108:111], a[28:31], v[212:215], v[108:111]
 buffer_load_dwordx4 v11, s[8:11], s30 offen offset:1024 lds
 v_mfma_f32_16x16x32_bf16 v[112:115], a[24:27], v[216:219], v[112:115]
 ds_read_b128 v[184:187], v18 offset:12288
 v_mfma_f32_16x16x32_bf16 v[116:119], a[28:31], v[216:219], v[116:119]
 v_mfma_f32_16x16x32_bf16 v[120:123], a[24:27], v[220:223], v[120:123]
 ds_read_b128 v[188:191], v18 offset:14336
 v_mfma_f32_16x16x32_bf16 v[124:127], a[28:31], v[220:223], v[124:127]
 s_waitcnt lgkmcnt(4)
 v_mfma_f32_16x16x32_bf16 v[64:67], a[32:35], v[160:163], v[64:67]
 ds_read_b128 v[192:195], v19 offset:0
 v_mfma_f32_16x16x32_bf16 v[68:71], a[36:39], v[160:163], v[68:71]
 v_add_u32 v18, s33, v14
 v_mfma_f32_16x16x32_bf16 v[72:75], a[32:35], v[164:167], v[72:75]
 ds_read_b128 v[196:199], v19 offset:2048
 v_mfma_f32_16x16x32_bf16 v[76:79], a[36:39], v[164:167], v[76:79]
 buffer_load_dwordx4 v12, s[8:11], s30 offen offset:2048 lds
 v_mfma_f32_16x16x32_bf16 v[80:83], a[32:35], v[168:171], v[80:83]
 ds_read_b128 v[200:203], v19 offset:4096
 v_mfma_f32_16x16x32_bf16 v[84:87], a[36:39], v[168:171], v[84:87]
 v_mfma_f32_16x16x32_bf16 v[88:91], a[32:35], v[172:175], v[88:91]
 ds_read_b128 v[204:207], v19 offset:6144
 v_mfma_f32_16x16x32_bf16 v[92:95], a[36:39], v[172:175], v[92:95]
 s_waitcnt lgkmcnt(4)
 v_mfma_f32_16x16x32_bf16 v[96:99], a[32:35], v[176:179], v[96:99]
 ds_read_b128 v[208:211], v19 offset:8192
 v_mfma_f32_16x16x32_bf16 v[100:103], a[36:39], v[176:179], v[100:103]
 v_mfma_f32_16x16x32_bf16 v[104:107], a[32:35], v[180:183], v[104:107]
 ds_read_b128 v[212:215], v19 offset:10240
 v_mfma_f32_16x16x32_bf16 v[108:111], a[36:39], v[180:183], v[108:111]
 buffer_load_dwordx4 v13, s[8:11], s30 offen offset:3072 lds
 v_mfma_f32_16x16x32_bf16 v[112:115], a[32:35], v[184:187], v[112:115]
 ds_read_b128 v[216:219], v19 offset:12288
 s_add_u32 s30, s30, 128
 v_mfma_f32_16x16x32_bf16 v[116:119], a[36:39], v[184:187], v[116:119]
 s_add_u32 m0, m0, 16384
 v_mfma_f32_16x16x32_bf16 v[120:123], a[32:35], v[188:191], v[120:123]
 ds_read_b128 v[220:223], v19 offset:14336
 v_mfma_f32_16x16x32_bf16 v[124:127], a[36:39], v[188:191], v[124:127]
 s_waitcnt vmcnt(16) lgkmcnt(4)
 s_barrier
 v_mfma_f32_16x16x32_bf16 v[64:67], a[40:43], v[192:195], v[64:67]
 ds_read_b128 v[160:163], v18 offset:0
 v_mfma_f32_16x16x32_bf16 v[68:71], a[44:47], v[192:195], v[68:71]
 s_cmp_lt_u32 m0, s46
 s_cselect_b32 m0, m0, s47
 v_mfma_f32_16x16x32_bf16 v[72:75], a[40:43], v[196:199], v[72:75]
 ds_read_b128 v[164:167], v18 offset:2048
 v_add_u32 v19, s33, v15
 v_mfma_f32_16x16x32_bf16 v[76:79], a[44:47], v[196:199], v[76:79]
 buffer_load_dwordx4 v10, s[8:11], s30 offen offset:0 lds
 v_mfma_f32_16x16x32_bf16 v[80:83], a[40:43], v[200:203], v[80:83]
 ds_read_b128 v[168:171], v18 offset:4096
 s_add_u32 s33, s33, 16384
 v_mfma_f32_16x16x32_bf16 v[84:87], a[44:47], v[200:203], v[84:87]
 s_cmp_lt_u32 s33, 114688
 s_cselect_b32 s33, s33, 0
 v_mfma_f32_16x16x32_bf16 v[88:91], a[40:43], v[204:207], v[88:91]
 ds_read_b128 v[172:175], v18 offset:6144
 v_mfma_f32_16x16x32_bf16 v[92:95], a[44:47], v[204:207], v[92:95]
 s_waitcnt lgkmcnt(4)
 v_mfma_f32_16x16x32_bf16 v[96:99], a[40:43], v[208:211], v[96:99]
 ds_read_b128 v[176:179], v18 offset:8192
 v_mfma_f32_16x16x32_bf16 v[100:103], a[44:47], v[208:211], v[100:103]
 v_mfma_f32_16x16x32_bf16 v[104:107], a[40:43], v[212:215], v[104:107]
 ds_read_b128 v[180:183], v18 offset:10240
 v_mfma_f32_16x16x32_bf16 v[108:111], a[44:47], v[212:215], v[108:111]
 buffer_load_dwordx4 v11, s[8:11], s30 offen offset:1024 lds
 v_mfma_f32_16x16x32_bf16 v[112:115], a[40:43], v[216:219], v[112:115]
 ds_read_b128 v[184:187], v18 offset:12288
 v_mfma_f32_16x16x32_bf16 v[116:119], a[44:47], v[216:219], v[116:119]
 v_mfma_f32_16x16x32_bf16 v[120:123], a[40:43], v[220:223], v[120:123]
 ds_read_b128 v[188:191], v18 offset:14336
 v_mfma_f32_16x16x32_bf16 v[124:127], a[44:47], v[220:223], v[124:127]
 s_waitcnt lgkmcnt(4)
 v_mfma_f32_16x16x32_bf16 v[64:67], a[48:51], v[160:163], v[64:67]
 ds_read_b128 v[192:195], v19 offset:0
 v_mfma_f32_16x16x32_bf16 v[68:71], a[52:55], v[160:163], v[68:71]
 v_add_u32 v18, s33, v14
 v_mfma_f32_16x16x32_bf16 v[72:75], a[48:51], v[164:167], v[72:75]
 ds_read_b128 v[196:199], v19 offset:2048
 v_mfma_f32_16x16x32_bf16 v[76:79], a[52:55], v[164:167], v[76:79]
 buffer_load_dwordx4 v12, s[8:11], s30 offen offset:2048 lds
 v_mfma_f32_16x16x32_bf16 v[80:83], a[48:51], v[168:171], v[80:83]
 ds_read_b128 v[200:203], v19 offset:4096
 v_mfma_f32_16x16x32_bf16 v[84:87], a[52:55], v[168:171], v[84:87]
 v_mfma_f32_16x16x32_bf16 v[88:91], a[48:51], v[172:175], v[88:91]
 ds_read_b128 v[204:207], v19 offset:6144
 v_mfma_f32_16x16x32_bf16 v[92:95], a[52:55], v[172:175], v[92:95]
 s_waitcnt lgkmcnt(4)
 v_mfma_f32_16x16x32_bf16 v[96:99], a[48:51], v[176:179], v[96:99]
 ds_read_b128 v[208:211], v19 offset:8192
 v_mfma_f32_16x16x32_bf16 v[100:103], a[52:55], v[176:179], v[100:103]
 v_mfma_f32_16x16x32_bf16 v[104:107], a[48:51], v[180:183], v[104:107]
 ds_read_b128 v[212:215], v19 offset:10240
 v_mfma_f32_16x16x32_bf16 v[108:111], a[52:55], v[180:183], v[108:111]
 buffer_load_dwordx4 v13, s[8:11], s30 offen offset:3072 lds
 v_mfma_f32_16x16x32_bf16 v[112:115], a[48:51], v[184:187], v[112:115]
 ds_read_b128 v[216:219], v19 offset:12288
 s_add_u32 s30, s30, 128
 v_mfma_f32_16x16x32_bf16 v[116:119], a[52:55], v[184:187], v[116:119]
 s_add_u32 m0, m0, 16384
 v_mfma_f32_16x16x32_bf16 v[120:123], a[48:51], v[188:191], v[120:123]
 ds_read_b128 v[220:223], v19 offset:14336
 v_mfma_f32_16x16x32_bf16 v[124:127], a[52:55], v[188:191], v[124:127]
 s_waitcnt vmcnt(16) lgkmcnt(4)
 s_barrier
 v_mfma_f32_16x16x32_bf16 v[64:67], a[56:59], v[192:195], v[64:67]
 ds_read_b128 v[160:163], v18 offset:0
 v_mfma_f32_16x16x32_bf16 v[68:71], a[60:63], v[192:195], v[68:71]
 s_cmp_lt_u32 m0, s46
 s_cselect_b32 m0, m0, s47
 v_mfma_f32_16x16x32_bf16 v[72:75], a[56:59], v[196:199], v[72:75]
 ds_read_b128 v[164:167], v18 offset:2048
 v_add_u32 v19, s33, v15
 v_mfma_f32_16x16x32_bf16 v[76:79], a[60:63], v[196:199], v[76:79]
 buffer_load_dwordx4 v10, s[8:11], s30 offen offset:0 lds
 v_mfma_f32_16x16x32_bf16 v[80:83], a[56:59], v[200:203], v[80:83]
 ds_read_b128 v[168:171], v18 offset:4096
 s_add_u32 s33, s33, 16384
 v_mfma_f32_16x16x32_bf16 v[84:87], a[60:63], v[200:203], v[84:87]
 s_cmp_lt_u32 s33, 114688
 s_cselect_b32 s33, s33, 0
 v_mfma_f32_16x16x32_bf16 v[88:91], a[56:59], v[204:207], v[88:91]
 ds_read_b128 v[172:175], v18 offset:6144
 v_mfma_f32_16x16x32_bf16 v[92:95], a[60:63], v[204:207], v[92:95]
 s_waitcnt lgkmcnt(4)
 v_mfma_f32_16x16x32_bf16 v[96:99], a[56:59], v[208:211], v[96:99]
 ds_read_b128 v[176:179], v18 offset:8192
 v_mfma_f32_16x16x32_bf16 v[100:103], a[60:63], v[208:211], v[100:103]
 v_mfma_f32_16x16x32_bf16 v[104:107], a[56:59], v[212:215], v[104:107]
 ds_read_b128 v[180:183], v18 offset:10240
 v_mfma_f32_16x16x32_bf16 v[108:111], a[60:63], v[212:215], v[108:111]
 buffer_load_dwordx4 v11, s[8:11], s30 offen offset:1024 lds
 v_mfma_f32_16x16x32_bf16 v[112:115], a[56:59], v[216:219], v[112:115]
 ds_read_b128 v[184:187], v18 offset:12288
 v_mfma_f32_16x16x32_bf16 v[116:119], a[60:63], v[216:219], v[116:119]
 v_mfma_f32_16x16x32_bf16 v[120:123], a[56:59], v[220:223], v[120:123]
 ds_read_b128 v[188:191], v18 offset:14336
 v_mfma_f32_16x16x32_bf16 v[124:127], a[60:63], v[220:223], v[124:127]
 s_waitcnt lgkmcnt(4)
 v_mfma_f32_16x16x32_bf16 v[64:67], a[64:67], v[160:163], v[64:67]
 ds_read_b128 v[192:195], v19 offset:0
 v_mfma_f32_16x16x32_bf16 v[68:71], a[68:71], v[160:163], v[68:71]
 v_add_u32 v18, s33, v14
 v_mfma_f32_16x16x32_bf16 v[72:75], a[64:67], v[164:167], v[72:75]
 ds_read_b128 v[196:199], v19 offset:2048
 v_mfma_f32_16x16x32_bf16 v[76:79], a[68:71], v[164:167], v[76:79]
 buffer_load_dwordx4 v12, s[8:11], s30 offen offset:2048 lds
 v_mfma_f32_16x16x32_bf16 v[80:83], a[64:67], v[168:171], v[80:83]
 ds_read_b128 v[200:203], v19 offset:4096
 v_mfma_f32_16x16x32_bf16 v[84:87], a[68:71], v[168:171], v[84:87]
 v_mfma_f32_16x16x32_bf16 v[88:91], a[64:67], v[172:175], v[88:91]
 ds_read_b128 v[204:207], v19 offset:6144
 v_mfma_f32_16x16x32_bf16 v[92:95], a[68:71], v[172:175], v[92:95]
 s_waitcnt lgkmcnt(4)
 v_mfma_f32_16x16x32_bf16 v[96:99], a[64:67], v[176:179], v[96:99]
 ds_read_b128 v[208:211], v19 offset:8192
 v_mfma_f32_16x16x32_bf16 v[100:103], a[68:71], v[176:179], v[100:103]
 v_mfma_f32_16x16x32_bf16 v[104:107], a[64:67], v[180:183], v[104:107]
 ds_read_b128 v[212:215], v19 offset:10240
 v_mfma_f32_16x16x32_bf16 v[108:111], a[68:71], v[180:183], v[108:111]
 buffer_load_dwordx4 v13, s[8:11], s30 offen offset:3072 lds
 v_mfma_f32_16x16x32_bf16 v[112:115], a[64:67], v[184:187], v[112:115]
 ds_read_b128 v[216:219], v19 offset:12288
 s_add_u32 s30, s30, s25
 v_mfma_f32_16x16x32_bf16 v[116:119], a[68:71], v[184:187], v[116:119]
 s_sub_u32 s30, s30, 1152
 s_add_u32 m0, m0, 16384
 v_mfma_f32_16x16x32_bf16 v[120:123], a[64:67], v[188:191], v[120:123]
 ds_read_b128 v[220:223], v19 offset:14336
 v_mfma_f32_16x16x32_bf16 v[124:127], a[68:71], v[188:191], v[124:127]
 s_waitcnt vmcnt(16) lgkmcnt(4)
 s_barrier
 v_mfma_f32_16x16x32_bf16 v[64:67], a[72:75], v[192:195], v[64:67]
 ds_read_b128 v[160:163], v18 offset:0
 v_mfma_f32_16x16x32_bf16 v[68:71], a[76:79], v[192:195], v[68:71]
 s_cmp_lt_u32 m0, s46
 s_cselect_b32 m0, m0, s47
 v_mfma_f32_16x16x32_bf16 v[72:75], a[72:75], v[196:199], v[72:75]
 ds_read_b128 v[164:167], v18 offset:2048
 v_add_u32 v19, s33, v15
 v_mfma_f32_16x16x32_bf16 v[76:79], a[76:79], v[196:199], v[76:79]
 buffer_load_dwordx4 v10, s[8:11], s30 offen offset:0 lds
 v_mfma_f32_16x16x32_bf16 v[80:83], a[72:75], v[200:203], v[80:83]
 ds_read_b128 v[168:171], v18 offset:4096
 s_add_u32 s33, s33, 16384
 v_mfma_f32_16x16x32_bf16 v[84:87], a[76:79], v[200:203], v[84:87]
 s_cmp_lt_u32 s33, 114688
 s_cselect_b32 s33, s33, 0
 v_mfma_f32_16x16x32_bf16 v[88:91], a[72:75], v[204:207], v[88:91]
 ds_read_b128 v[172:175], v18 offset:6144
 v_mfma_f32_16x16x32_bf16 v[92:95], a[76:79], v[204:207], v[92:95]
 s_waitcnt lgkmcnt(4)
 v_mfma_f32_16x16x32_bf16 v[96:99], a[72:75], v[208:211], v[96:99]
 ds_read_b128 v[176:179], v18 offset:8192
 v_mfma_f32_16x16x32_bf16 v[100:103], a[76:79], v[208:211], v[100:103]
 v_mfma_f32_16x16x32_bf16 v[104:107], a[72:75], v[212:215], v[104:107]
 ds_read_b128 v[180:183], v18 offset:10240
 v_mfma_f32_16x16x32_bf16 v[108:111], a[76:79], v[212:215], v[108:111]
 buffer_load_dwordx4 v11, s[8:11], s30 offen offset:1024 lds
 v_mfma_f32_16x16x32_bf16 v[112:115], a[72:75], v[216:219], v[112:115]
 ds_read_b128 v[184:187], v18 offset:12288
 v_mfma_f32_16x16x32_bf16 v[116:119], a[76:79], v[216:219], v[116:119]
 v_mfma_f32_16x16x32_bf16 v[120:123], a[72:75], v[220:223], v[120:123]
 ds_read_b128 v[188:191], v18 offset:14336
 v_mfma_f32_16x16x32_bf16 v[124:127], a[76:79], v[220:223], v[124:127]
 s_waitcnt lgkmcnt(4)
 v_mfma_f32_16x16x32_bf16 v[64:67], a[80:83], v[160:163], v[64:67]
 ds_read_b128 v[192:195], v19 offset:0
 v_mfma_f32_16x16x32_bf16 v[68:71], a[84:87], v[160:163], v[68:71]
 v_add_u32 v18, s33, v14
 v_mfma_f32_16x16x32_bf16 v[72:75], a[80:83], v[164:167], v[72:75]
 ds_read_b128 v[196:199], v19 offset:2048
 v_mfma_f32_16x16x32_bf16 v[76:79], a[84:87], v[164:167], v[76:79]
 buffer_load_dwordx4 v12, s[8:11], s30 offen offset:2048 lds
 v_mfma_f32_16x16x32_bf16 v[80:83], a[80:83], v[168:171], v[80:83]
 ds_read_b128 v[200:203], v19 offset:4096
 v_mfma_f32_16x16x32_bf16 v[84:87], a[84:87], v[168:171], v[84:87]
 v_mfma_f32_16x16x32_bf16 v[88:91], a[80:83], v[172:175], v[88:91]
 ds_read_b128 v[204:207], v19 offset:6144
 v_mfma_f32_16x16x32_bf16 v[92:95], a[84:87], v[172:175], v[92:95]
 s_waitcnt lgkmcnt(4)
 v_mfma_f32_16x16x32_bf16 v[96:99], a[80:83], v[176:179], v[96:99]
 ds_read_b128 v[208:211], v19 offset:8192
 v_mfma_f32_16x16x32_bf16 v[100:103], a[84:87], v[176:179], v[100:103]
 v_mfma_f32_16x16x32_bf16 v[104:107], a[80:83], v[180:183], v[104:107]
 ds_read_b128 v[212:215], v19 offset:10240
 v_mfma_f32_16x16x32_bf16 v[108:111], a[84:87], v[180:183], v[108:111]
 buffer_load_dwordx4 v13, s[8:11], s30 offen offset:3072 lds
 v_mfma_f32_16x16x32_bf16 v[112:115], a[80:83], v[184:187], v[112:115]
 ds_read_b128 v[216:219], v19 offset:12288
 s_add_u32 s30, s30, 128
 v_mfma_f32_16x16x32_bf16 v[116:119], a[84:87], v[184:187], v[116:119]
 s_add_u32 m0, m0, 16384
 v_mfma_f32_16x16x32_bf16 v[120:123], a[80:83], v[188:191], v[120:123]
 ds_read_b128 v[220:223], v19 offset:14336
 v_mfma_f32_16x16x32_bf16 v[124:127], a[84:87], v[188:191], v[124:127]
 s_waitcnt vmcnt(16) lgkmcnt(4)
 s_barrier
 v_mfma_f32_16x16x32_bf16 v[64:67], a[88:91], v[192:195], v[64:67]
 ds_read_b128 v[160:163], v18 offset:0
 v_mfma_f32_16x16x32_bf16 v[68:71], a[92:95], v[192:195], v[68:71]
 s_cmp_lt_u32 m0, s46
 s_cselect_b32 m0, m0, s47
 v_mfma_f32_16x16x32_bf16 v[72:75], a[88:91], v[196:199], v[72:75]
 ds_read_b128 v[164:167], v18 offset:2048
 v_add_u32 v19, s33, v15
 v_mfma_f32_16x16x32_bf16 v[76:79], a[92:95], v[196:199], v[76:79]
 buffer_load_dwordx4 v10, s[8:11], s30 offen offset:0 lds
 v_mfma_f32_16x16x32_bf16 v[80:83], a[88:91], v[200:203], v[80:83]
 ds_read_b128 v[168:171], v18 offset:4096
 s_add_u32 s33, s33, 16384
 v_mfma_f32_16x16x32_bf16 v[84:87], a[92:95], v[200:203], v[84:87]
 s_cmp_lt_u32 s33, 114688
 s_cselect_b32 s33, s33, 0
 v_mfma_f32_16x16x32_bf16 v[88:91], a[88:91], v[204:207], v[88:91]
 ds_read_b128 v[172:175], v18 offset:6144
 v_mfma_f32_16x16x32_bf16 v[92:95], a[92:95], v[204:207], v[92:95]
 s_waitcnt lgkmcnt(4)
 v_mfma_f32_16x16x32_bf16 v[96:99], a[88:91], v[208:211], v[96:99]
 ds_read_b128 v[176:179], v18 offset:8192
 v_mfma_f32_16x16x32_bf16 v[100:103], a[92:95], v[208:211], v[100:103]
 v_mfma_f32_16x16x32_bf16 v[104:107], a[88:91], v[212:215], v[104:107]
 ds_read_b128 v[180:183], v18 offset:10240
 v_mfma_f32_16x16x32_bf16 v[108:111], a[92:95], v[212:215], v[108:111]
 buffer_load_dwordx4 v11, s[8:11], s30 offen offset:1024 lds
 v_mfma_f32_16x16x32_bf16 v[112:115], a[88:91], v[216:219], v[112:115]
 ds_read_b128 v[184:187], v18 offset:12288
 v_mfma_f32_16x16x32_bf16 v[116:119], a[92:95], v[216:219], v[116:119]
 v_mfma_f32_16x16x32_bf16 v[120:123], a[88:91], v[220:223], v[120:123]
 ds_read_b128 v[188:191], v18 offset:14336
 v_mfma_f32_16x16x32_bf16 v[124:127], a[92:95], v[220:223], v[124:127]
 s_waitcnt lgkmcnt(4)
 v_mfma_f32_16x16x32_bf16 v[64:67], a[96:99], v[160:163], v[64:67]
 ds_read_b128 v[192:195], v19 offset:0
 v_mfma_f32_16x16x32_bf16 v[68:71], a[100:103], v[160:163], v[68:71]
 v_add_u32 v18, s33, v14
 v_mfma_f32_16x16x32_bf16 v[72:75], a[96:99], v[164:167], v[72:75]
 ds_read_b128 v[196:199], v19 offset:2048
 v_mfma_f32_16x16x32_bf16 v[76:79], a[100:103], v[164:167], v[76:79]
 buffer_load_dwordx4 v12, s[8:11], s30 offen offset:2048 lds
 v_mfma_f32_16x16x32_bf16 v[80:83], a[96:99], v[168:171], v[80:83]
 ds_read_b128 v[200:203], v19 offset:4096
 v_mfma_f32_16x16x32_bf16 v[84:87], a[100:103], v[168:171], v[84:87]
 v_mfma_f32_16x16x32_bf16 v[88:91], a[96:99], v[172:175], v[88:91]
 ds_read_b128 v[204:207], v19 offset:6144
 v_mfma_f32_16x16x32_bf16 v[92:95], a[100:103], v[172:175], v[92:95]
 s_waitcnt lgkmcnt(4)
 v_mfma_f32_16x16x32_bf16 v[96:99], a[96:99], v[176:179], v[96:99]
 ds_read_b128 v[208:211], v19 offset:8192
 v_mfma_f32_16x16x32_bf16 v[100:103], a[100:103], v[176:179], v[100:103]
 v_mfma_f32_16x16x32_bf16 v[104:107], a[96:99], v[180:183], v[104:107]
 ds_read_b128 v[212:215], v19 offset:10240
 v_mfma_f32_16x16x32_bf16 v[108:111], a[100:103], v[180:183], v[108:111]
 buffer_load_dwordx4 v13, s[8:11], s30 offen offset:3072 lds
 v_mfma_f32_16x16x32_bf16 v[112:115], a[96:99], v[184:187], v[112:115]
 ds_read_b128 v[216:219], v19 offset:12288
 s_add_u32 s30, s30, 128
 v_mfma_f32_16x16x32_bf16 v[116:119], a[100:103], v[184:187], v[116:119]
 s_add_u32 m0, m0, 16384
 v_mfma_f32_16x16x32_bf16 v[120:123], a[96:99], v[188:191], v[120:123]
 ds_read_b128 v[220:223], v19 offset:14336
 v_mfma_f32_16x16x32_bf16 v[124:127], a[100:103], v[188:191], v[124:127]
 s_waitcnt vmcnt(16) lgkmcnt(4)
 s_barrier
 v_mfma_f32_16x16x32_bf16 v[64:67], a[104:107], v[192:195], v[64:67]
 ds_read_b128 v[160:163], v18 offset:0
 v_mfma_f32_16x16x32_bf16 v[68:71], a[108:111], v[192:195], v[68:71]
 s_cmp_lt_u32 m0, s46
 s_cselect_b32 m0, m0, s47
 v_mfma_f32_16x16x32_bf16 v[72:75], a[104:107], v[196:199], v[72:75]
 ds_read_b128 v[164:167], v18 offset:2048
 v_add_u32 v19, s33, v15
 v_mfma_f32_16x16x32_bf16 v[76:79], a[108:111], v[196:199], v[76:79]
 buffer_load_dwordx4 v10, s[8:11], s30 offen offset:0 lds
 v_mfma_f32_16x16x32_bf16 v[80:83], a[104:107], v[200:203], v[80:83]
 ds_read_b128 v[168:171], v18 offset:4096
 s_add_u32 s33, s33, 16384
 v_mfma_f32_16x16x32_bf16 v[84:87], a[108:111], v[200:203], v[84:87]
 s_cmp_lt_u32 s33, 114688
 s_cselect_b32 s33, s33, 0
 v_mfma_f32_16x16x32_bf16 v[88:91], a[104:107], v[204:207], v[88:91]
 ds_read_b128 v[172:175], v18 offset:6144
 v_mfma_f32_16x16x32_bf16 v[92:95], a[108:111], v[204:207], v[92:95]
 s_waitcnt lgkmcnt(4)
 v_mfma_f32_16x16x32_bf16 v[96:99], a[104:107], v[208:211], v[96:99]
 ds_read_b128 v[176:179], v18 offset:8192
 v_mfma_f32_16x16x32_bf16 v[100:103], a[108:111], v[208:211], v[100:103]
 v_mfma_f32_16x16x32_bf16 v[104:107], a[104:107], v[212:215], v[104:107]
 ds_read_b128 v[180:183], v18 offset:10240
 v_mfma_f32_16x16x32_bf16 v[108:111], a[108:111], v[212:215], v[108:111]
 buffer_load_dwordx4 v11, s[8:11], s30 offen offset:1024 lds
 v_mfma_f32_16x16x32_bf16 v[112:115], a[104:107], v[216:219], v[112:115]
 ds_read_b128 v[184:187], v18 offset:12288
 v_mfma_f32_16x16x32_bf16 v[116:119], a[108:111], v[216:219], v[116:119]
 v_mfma_f32_16x16x32_bf16 v[120:123], a[104:107], v[220:223], v[120:123]
 ds_read_b128 v[188:191], v18 offset:14336
 v_mfma_f32_16x16x32_bf16 v[124:127], a[108:111], v[220:223], v[124:127]
 s_waitcnt lgkmcnt(4)
 v_mfma_f32_16x16x32_bf16 v[64:67], a[112:115], v[160:163], v[64:67]
 ds_read_b128 v[192:195], v19 offset:0
 v_mfma_f32_16x16x32_bf16 v[68:71], a[116:119], v[160:163], v[68:71]
 v_add_u32 v18, s33, v14
 v_mfma_f32_16x16x32_bf16 v[72:75], a[112:115], v[164:167], v[72:75]
 ds_read_b128 v[196:199], v19 offset:2048
 v_mfma_f32_16x16x32_bf16 v[76:79], a[116:119], v[164:167], v[76:79]
 buffer_load_dwordx4 v12, s[8:11], s30 offen offset:2048 lds
 v_mfma_f32_16x16x32_bf16 v[80:83], a[112:115], v[168:171], v[80:83]
 ds_read_b128 v[200:203], v19 offset:4096
 v_mfma_f32_16x16x32_bf16 v[84:87], a[116:119], v[168:171], v[84:87]
 v_mfma_f32_16x16x32_bf16 v[88:91], a[112:115], v[172:175], v[88:91]
 ds_read_b128 v[204:207], v19 offset:6144
 v_mfma_f32_16x16x32_bf16 v[92:95], a[116:119], v[172:175], v[92:95]
 s_waitcnt lgkmcnt(4)
 v_mfma_f32_16x16x32_bf16 v[96:99], a[112:115], v[176:179], v[96:99]
 ds_read_b128 v[208:211], v19 offset:8192
 v_mfma_f32_16x16x32_bf16 v[100:103], a[116:119], v[176:179], v[100:103]
 v_mfma_f32_16x16x32_bf16 v[104:107], a[112:115], v[180:183], v[104:107]
 ds_read_b128 v[212:215], v19 offset:10240
 v_mfma_f32_16x16x32_bf16 v[108:111], a[116:119], v[180:183], v[108:111]
 buffer_load_dwordx4 v13, s[8:11], s30 offen offset:3072 lds
 v_mfma_f32_16x16x32_bf16 v[112:115], a[112:115], v[184:187], v[112:115]
 ds_read_b128 v[216:219], v19 offset:12288
 s_add_u32 s30, s30, 128
 v_mfma_f32_16x16x32_bf16 v[116:119], a[116:119], v[184:187], v[116:119]
 s_add_u32 m0, m0, 16384
 v_mfma_f32_16x16x32_bf16 v[120:123], a[112:115], v[188:191], v[120:123]
 ds_read_b128 v[220:223], v19 offset:14336
 v_mfma_f32_16x16x32_bf16 v[124:127], a[116:119], v[188:191], v[124:127]
 s_waitcnt vmcnt(16) lgkmcnt(4)
 s_barrier
 v_mfma_f32_16x16x32_bf16 v[64:67], a[120:123], v[192:195], v[64:67]
 ds_read_b128 v[160:163], v18 offset:0
 v_mfma_f32_16x16x32_bf16 v[68:71], a[124:127], v[192:195], v[68:71]
 s_cmp_lt_u32 m0, s46
 s_cselect_b32 m0, m0, s47
 v_mfma_f32_16x16x32_bf16 v[72:75], a[120:123], v[196:199], v[72:75]
 ds_read_b128 v[164:167], v18 offset:2048
 v_add_u32 v19, s33, v15
 v_mfma_f32_16x16x32_bf16 v[76:79], a[124:127], v[196:199], v[76:79]
 buffer_load_dwordx4 v10, s[8:11], s30 offen offset:0 lds
 v_mfma_f32_16x16x32_bf16 v[80:83], a[120:123], v[200:203], v[80:83]
 ds_read_b128 v[168:171], v18 offset:4096
 s_add_u32 s33, s33, 16384
 v_mfma_f32_16x16x32_bf16 v[84:87], a[124:127], v[200:203], v[84:87]
 s_cmp_lt_u32 s33, 114688
 s_cselect_b32 s33, s33, 0
 v_mfma_f32_16x16x32_bf16 v[88:91], a[120:123], v[204:207], v[88:91]
 ds_read_b128 v[172:175], v18 offset:6144
 v_mfma_f32_16x16x32_bf16 v[92:95], a[124:127], v[204:207], v[92:95]
 s_waitcnt lgkmcnt(4)
 v_mfma_f32_16x16x32_bf16 v[96:99], a[120:123], v[208:211], v[96:99]
 ds_read_b128 v[176:179], v18 offset:8192
 v_mfma_f32_16x16x32_bf16 v[100:103], a[124:127], v[208:211], v[100:103]
 v_mfma_f32_16x16x32_bf16 v[104:107], a[120:123], v[212:215], v[104:107]
 ds_read_b128 v[180:183], v18 offset:10240
 v_mfma_f32_16x16x32_bf16 v[108:111], a[124:127], v[212:215], v[108:111]
 buffer_load_dwordx4 v11, s[8:11], s30 offen offset:1024 lds
 v_mfma_f32_16x16x32_bf16 v[112:115], a[120:123], v[216:219], v[112:115]
 ds_read_b128 v[184:187], v18 offset:12288
 v_mfma_f32_16x16x32_bf16 v[116:119], a[124:127], v[216:219], v[116:119]
 v_mfma_f32_16x16x32_bf16 v[120:123], a[120:123], v[220:223], v[120:123]
 ds_read_b128 v[188:191], v18 offset:14336
 v_mfma_f32_16x16x32_bf16 v[124:127], a[124:127], v[220:223], v[124:127]
 s_waitcnt lgkmcnt(4)
 v_mfma_f32_16x16x32_bf16 v[64:67], a[128:131], v[160:163], v[64:67]
 ds_read_b128 v[192:195], v19 offset:0
 v_mfma_f32_16x16x32_bf16 v[68:71], a[132:135], v[160:163], v[68:71]
 v_add_u32 v18, s33, v14
 v_mfma_f32_16x16x32_bf16 v[72:75], a[128:131], v[164:167], v[72:75]
 ds_read_b128 v[196:199], v19 offset:2048
 v_mfma_f32_16x16x32_bf16 v[76:79], a[132:135], v[164:167], v[76:79]
 buffer_load_dwordx4 v12, s[8:11], s30 offen offset:2048 lds
 v_mfma_f32_16x16x32_bf16 v[80:83], a[128:131], v[168:171], v[80:83]
 ds_read_b128 v[200:203], v19 offset:4096
 v_mfma_f32_16x16x32_bf16 v[84:87], a[132:135], v[168:171], v[84:87]
 v_mfma_f32_16x16x32_bf16 v[88:91], a[128:131], v[172:175], v[88:91]
 ds_read_b128 v[204:207], v19 offset:6144
 v_mfma_f32_16x16x32_bf16 v[92:95], a[132:135], v[172:175], v[92:95]
 s_waitcnt lgkmcnt(4)
 v_mfma_f32_16x16x32_bf16 v[96:99], a[128:131], v[176:179], v[96:99]
 ds_read_b128 v[208:211], v19 offset:8192
 v_mfma_f32_16x16x32_bf16 v[100:103], a[132:135], v[176:179], v[100:103]
 v_mfma_f32_16x16x32_bf16 v[104:107], a[128:131], v[180:183], v[104:107]
 ds_read_b128 v[212:215], v19 offset:10240
 v_mfma_f32_16x16x32_bf16 v[108:111], a[132:135], v[180:183], v[108:111]
 buffer_load_dwordx4 v13, s[8:11], s30 offen offset:3072 lds
 v_mfma_f32_16x16x32_bf16 v[112:115], a[128:131], v[184:187], v[112:115]
 ds_read_b128 v[216:219], v19 offset:12288
 s_add_u32 s30, s30, 128
 v_mfma_f32_16x16x32_bf16 v[116:119], a[132:135], v[184:187], v[116:119]
 s_add_u32 m0, m0, 16384
 v_mfma_f32_16x16x32_bf16 v[120:123], a[128:131], v[188:191], v[120:123]
 ds_read_b128 v[220:223], v19 offset:14336
 v_mfma_f32_16x16x32_bf16 v[124:127], a[132:135], v[188:191], v[124:127]
 s_waitcnt vmcnt(16) lgkmcnt(4)
 s_barrier
 v_mfma_f32_16x16x32_bf16 v[64:67], a[136:139], v[192:195], v[64:67]
 ds_read_b128 v[160:163], v18 offset:0
 v_mfma_f32_16x16x32_bf16 v[68:71], a[140:143], v[192:195], v[68:71]
 s_cmp_lt_u32 m0, s46
 s_cselect_b32 m0, m0, s47
 v_mfma_f32_16x16x32_bf16 v[72:75], a[136:139], v[196:199], v[72:75]
 ds_read_b128 v[164:167], v18 offset:2048
 v_add_u32 v19, s33, v15
 v_mfma_f32_16x16x32_bf16 v[76:79], a[140:143], v[196:199], v[76:79]
 buffer_load_dwordx4 v10, s[8:11], s30 offen offset:0 lds
 v_mfma_f32_16x16x32_bf16 v[80:83], a[136:139], v[200:203], v[80:83]
 ds_read_b128 v[168:171], v18 offset:4096
 s_add_u32 s33, s33, 16384
 v_mfma_f32_16x16x32_bf16 v[84:87], a[140:143], v[200:203], v[84:87]
 s_cmp_lt_u32 s33, 114688
 s_cselect_b32 s33, s33, 0
 v_mfma_f32_16x16x32_bf16 v[88:91], a[136:139], v[204:207], v[88:91]
 ds_read_b128 v[172:175], v18 offset:6144
 v_mfma_f32_16x16x32_bf16 v[92:95], a[140:143], v[204:207], v[92:95]
 s_waitcnt lgkmcnt(4)
 v_mfma_f32_16x16x32_bf16 v[96:99], a[136:139], v[208:211], v[96:99]
 ds_read_b128 v[176:179], v18 offset:8192
 v_mfma_f32_16x16x32_bf16 v[100:103], a[140:143], v[208:211], v[100:103]
 v_mfma_f32_16x16x32_bf16 v[104:107], a[136:139], v[212:215], v[104:107]
 ds_read_b128 v[180:183], v18 offset:10240
 v_mfma_f32_16x16x32_bf16 v[108:111], a[140:143], v[212:215], v[108:111]
 buffer_load_dwordx4 v11, s[8:11], s30 offen offset:1024 lds
 v_mfma_f32_16x16x32_bf16 v[112:115], a[136:139], v[216:219], v[112:115]
 ds_read_b128 v[184:187], v18 offset:12288
 v_mfma_f32_16x16x32_bf16 v[116:119], a[140:143], v[216:219], v[116:119]
 v_mfma_f32_16x16x32_bf16 v[120:123], a[136:139], v[220:223], v[120:123]
 ds_read_b128 v[188:191], v18 offset:14336
 v_mfma_f32_16x16x32_bf16 v[124:127], a[140:143], v[220:223], v[124:127]
 s_waitcnt lgkmcnt(4)
 v_mfma_f32_16x16x32_bf16 v[64:67], a[144:147], v[160:163], v[64:67]
 ds_read_b128 v[192:195], v19 offset:0
 v_mfma_f32_16x16x32_bf16 v[68:71], a[148:151], v[160:163], v[68:71]
 v_add_u32 v18, s33, v14
 v_mfma_f32_16x16x32_bf16 v[72:75], a[144:147], v[164:167], v[72:75]
 ds_read_b128 v[196:199], v19 offset:2048
 v_mfma_f32_16x16x32_bf16 v[76:79], a[148:151], v[164:167], v[76:79]
 buffer_load_dwordx4 v12, s[8:11], s30 offen offset:2048 lds
 v_mfma_f32_16x16x32_bf16 v[80:83], a[144:147], v[168:171], v[80:83]
 ds_read_b128 v[200:203], v19 offset:4096
 v_mfma_f32_16x16x32_bf16 v[84:87], a[148:151], v[168:171], v[84:87]
 v_mfma_f32_16x16x32_bf16 v[88:91], a[144:147], v[172:175], v[88:91]
 ds_read_b128 v[204:207], v19 offset:6144
 v_mfma_f32_16x16x32_bf16 v[92:95], a[148:151], v[172:175], v[92:95]
 s_waitcnt lgkmcnt(4)
 v_mfma_f32_16x16x32_bf16 v[96:99], a[144:147], v[176:179], v[96:99]
 ds_read_b128 v[208:211], v19 offset:8192
 v_mfma_f32_16x16x32_bf16 v[100:103], a[148:151], v[176:179], v[100:103]
 v_mfma_f32_16x16x32_bf16 v[104:107], a[144:147], v[180:183], v[104:107]
 ds_read_b128 v[212:215], v19 offset:10240
 v_mfma_f32_16x16x32_bf16 v[108:111], a[148:151], v[180:183], v[108:111]
 buffer_load_dwordx4 v13, s[8:11], s30 offen offset:3072 lds
 v_mfma_f32_16x16x32_bf16 v[112:115], a[144:147], v[184:187], v[112:115]
 ds_read_b128 v[216:219], v19 offset:12288
 s_add_u32 s30, s30, 128
 v_mfma_f32_16x16x32_bf16 v[116:119], a[148:151], v[184:187], v[116:119]
 s_add_u32 m0, m0, 16384
 v_mfma_f32_16x16x32_bf16 v[120:123], a[144:147], v[188:191], v[120:123]
 ds_read_b128 v[220:223], v19 offset:14336
 v_mfma_f32_16x16x32_bf16 v[124:127], a[148:151], v[188:191], v[124:127]
 s_waitcnt vmcnt(16) lgkmcnt(4)
 s_barrier
 v_mfma_f32_16x16x32_bf16 v[64:67], a[152:155], v[192:195], v[64:67]
 ds_read_b128 v[160:163], v18 offset:0
 v_mfma_f32_16x16x32_bf16 v[68:71], a[156:159], v[192:195], v[68:71]
 s_cmp_lt_u32 m0, s46
 s_cselect_b32 m0, m0, s47
 v_mfma_f32_16x16x32_bf16 v[72:75], a[152:155], v[196:199], v[72:75]
 ds_read_b128 v[164:167], v18 offset:2048
 v_add_u32 v19, s33, v15
 v_mfma_f32_16x16x32_bf16 v[76:79], a[156:159], v[196:199], v[76:79]
 buffer_load_dwordx4 v10, s[8:11], s30 offen offset:0 lds
 v_cvt_pk_bf16_f32 v224, v64, v65
 v_cvt_pk_bf16_f32 v225, v66, v67
 v_mfma_f32_16x16x32_bf16 v[80:83], a[152:155], v[200:203], v[80:83]
 ds_read_b128 v[168:171], v18 offset:4096
 s_add_u32 s33, s33, 16384
 v_cvt_pk_bf16_f32 v226, v68, v69
 v_cvt_pk_bf16_f32 v227, v70, v71
 v_mfma_f32_16x16x32_bf16 v[84:87], a[156:159], v[200:203], v[84:87]
 s_cmp_lt_u32 s33, 114688
 s_cselect_b32 s33, s33, 0
 ds_write_b64 v22, v[224:225] offset:0
 v_mfma_f32_16x16x32_bf16 v[88:91], a[152:155], v[204:207], v[88:91]
 ds_read_b128 v[172:175], v18 offset:6144
 ds_write_b64 v22, v[226:227] offset:32
 v_cvt_pk_bf16_f32 v230, v72, v73
 v_mfma_f32_16x16x32_bf16 v[92:95], a[156:159], v[204:207], v[92:95]
 s_waitcnt lgkmcnt(6)
 v_cvt_pk_bf16_f32 v231, v74, v75
 v_cvt_pk_bf16_f32 v232, v76, v77
 v_cvt_pk_bf16_f32 v233, v78, v79
 v_mfma_f32_16x16x32_bf16 v[96:99], a[152:155], v[208:211], v[96:99]
 ds_read_b128 v[176:179], v18 offset:8192
 ds_write_b64 v22, v[230:231] offset:4224
 v_mfma_f32_16x16x32_bf16 v[100:103], a[156:159], v[208:211], v[100:103]
 ds_write_b64 v22, v[232:233] offset:4256
 v_cvt_pk_bf16_f32 v224, v80, v81
 v_cvt_pk_bf16_f32 v225, v82, v83
 v_mfma_f32_16x16x32_bf16 v[104:107], a[152:155], v[212:215], v[104:107]
 ds_read_b128 v[180:183], v18 offset:10240
 v_cvt_pk_bf16_f32 v226, v84, v85
 v_cvt_pk_bf16_f32 v227, v86, v87
 v_mfma_f32_16x16x32_bf16 v[108:111], a[156:159], v[212:215], v[108:111]
 buffer_load_dwordx4 v11, s[8:11], s30 offen offset:1024 lds
 ds_write_b64 v22, v[224:225] offset:8448
 v_mfma_f32_16x16x32_bf16 v[112:115], a[152:155], v[216:219], v[112:115]
 ds_read_b128 v[184:187], v18 offset:12288
 ds_write_b64 v22, v[226:227] offset:8480
 v_cvt_pk_bf16_f32 v230, v88, v89
 v_mfma_f32_16x16x32_bf16 v[116:119], a[156:159], v[216:219], v[116:119]
 v_cvt_pk_bf16_f32 v231, v90, v91
 v_cvt_pk_bf16_f32 v232, v92, v93
 v_cvt_pk_bf16_f32 v233, v94, v95
 v_mfma_f32_16x16x32_bf16 v[120:123], a[152:155], v[220:223], v[120:123]
 ds_read_b128 v[188:191], v18 offset:14336
 ds_write_b64 v22, v[230:231] offset:12672
 v_mfma_f32_16x16x32_bf16 v[124:127], a[156:159], v[220:223], v[124:127]
 ds_write_b64 v22, v[232:233] offset:12704
 v_cvt_pk_bf16_f32 v224, v96, v97
 v_cvt_pk_bf16_f32 v225, v98, v99
bf_end_194:
 v_cvt_pk_bf16_f32 v226, v100, v101
 v_cvt_pk_bf16_f32 v227, v102, v103
 ds_write_b64 v22, v[224:225] offset:16896
 ds_write_b64 v22, v[226:227] offset:16928
 v_cvt_pk_bf16_f32 v230, v104, v105
 v_cvt_pk_bf16_f32 v231, v106, v107
 v_cvt_pk_bf16_f32 v232, v108, v109
 v_cvt_pk_bf16_f32 v233, v110, v111
 ds_write_b64 v22, v[230:231] offset:21120
 ds_write_b64 v22, v[232:233] offset:21152
 v_cvt_pk_bf16_f32 v224, v112, v113
 v_cvt_pk_bf16_f32 v225, v114, v115
 v_cvt_pk_bf16_f32 v226, v116, v117
 v_cvt_pk_bf16_f32 v227, v118, v119
 ds_write_b64 v22, v[224:225] offset:25344
 ds_write_b64 v22, v[226:227] offset:25376
 v_cvt_pk_bf16_f32 v230, v120, v121
 v_cvt_pk_bf16_f32 v231, v122, v123
 v_cvt_pk_bf16_f32 v232, v124, v125
 v_cvt_pk_bf16_f32 v233, v126, v127
 ds_write_b64 v22, v[230:231] offset:29568
 ds_write_b64 v22, v[232:233] offset:29600
 s_cmp_lg_u32 s26, 6
 s_cbranch_scc1 bw_195
 v_and_b32 v51, 31, v1
 buffer_load_ubyte v50, v51, s[64:67], 0 offen offset:160 sc1
 buffer_load_dword v32, v32, s[64:67], 0 offen sc1
 buffer_load_dwordx4 v[40:43], v33, s[12:15], s50 offen offset:0
 buffer_load_dwordx4 v[40:43], v33, s[12:15], s50 offen offset:1024
 buffer_load_dwordx4 v[40:43], v33, s[12:15], s50 offen offset:2048
 buffer_load_dwordx4 v[40:43], v33, s[12:15], s50 offen offset:3072
 buffer_load_dwordx4 v[40:43], v33, s[12:15], s51 offen offset:0
 buffer_load_dwordx4 v[40:43], v33, s[12:15], s51 offen offset:1024
 buffer_load_dwordx4 v[40:43], v33, s[12:15], s51 offen offset:2048
bw_195:
 s_waitcnt lgkmcnt(0)
 s_barrier
 ds_read_b64 v[144:145], v34 offset:1848
 ds_read_b64 v[146:147], v34 offset:1856
 ds_read_b64 v[148:149], v34 offset:1864
 ds_read_b64 v[150:151], v34 offset:1872
 ds_read_b64 v[152:153], v34 offset:1880
 ds_read_b64 v[64:65], v34 offset:1928
 ds_read_b64 v[66:67], v34 offset:1936
 ds_read_b64 v[68:69], v34 offset:1944
 ds_read_b64 v[70:71], v34 offset:1952
 ds_read_b64 v[72:73], v34 offset:1960
 ds_read_b64 v[74:75], v34 offset:1664
 ds_read_b64 v[76:77], v34 offset:1672
 ds_read_b64 v[78:79], v34 offset:1680
 ds_read_b64 v[80:81], v34 offset:1688
 ds_read_b64 v[82:83], v34 offset:1696
 ds_read_b64 v[84:85], v34 offset:1400
 ds_read_b64 v[86:87], v34 offset:1408
 ds_read_b64 v[88:89], v34 offset:1416
 ds_read_b64 v[90:91], v34 offset:1424
 ds_read_b64 v[92:93], v34 offset:1432
 ds_read_b64 v[94:95], v34 offset:1136
 ds_read_b64 v[96:97], v34 offset:1144
 ds_read_b64 v[98:99], v34 offset:1152
 ds_read_b64 v[100:101], v34 offset:1160
 ds_read_b64 v[102:103], v34 offset:1168
 ds_read_b64 v[104:105], v34 offset:872
 ds_read_b64 v[106:107], v34 offset:880
 ds_read_b64 v[108:109], v34 offset:888
 ds_read_b64 v[110:111], v34 offset:896
 ds_read_b64 v[112:113], v34 offset:904
 ds_read_b64 v[114:115], v34 offset:608
 ds_read_b64 v[116:117], v34 offset:616
 ds_read_b64 v[118:119], v34 offset:624
 ds_read_b64 v[120:121], v34 offset:632
 ds_read_b64 v[122:123], v34 offset:640
 ds_read_b64 v[124:125], v34 offset:344
 ds_read_b64 v[126:127], v34 offset:352
 ds_read_b64 v[128:129], v34 offset:360
 ds_read_b64 v[130:131], v34 offset:368
 ds_read_b64 v[132:133], v34 offset:376
 ds_read_b64 v[134:135], v34 offset:80
 ds_read_b64 v[136:137], v34 offset:88
 ds_read_b64 v[138:139], v34 offset:96
 ds_read_b64 v[140:141], v34 offset:104
 ds_read_b64 v[142:143], v34 offset:112
 v_mov_b32 v224, 0
 v_mov_b32 v225, 0
 v_mov_b32 v226, 0
 v_mov_b32 v227, 0
 v_mov_b32 v228, 0
 v_mov_b32 v229, 0
 v_mov_b32 v230, 0
 v_mov_b32 v231, 0
 s_waitcnt lgkmcnt(15)
 v_dot2c_f32_bf16 v224, v64, v144
 v_dot2c_f32_bf16 v225, v74, v144
 v_dot2c_f32_bf16 v226, v84, v144
 v_dot2c_f32_bf16 v227, v94, v144
 v_dot2c_f32_bf16 v224, v65, v145
 v_dot2c_f32_bf16 v225, v75, v145
 v_dot2c_f32_bf16 v226, v85, v145
 v_dot2c_f32_bf16 v227, v95, v145
 v_dot2c_f32_bf16 v224, v66, v146
 v_dot2c_f32_bf16 v225, v76, v146
 v_dot2c_f32_bf16 v226, v86, v146
 v_dot2c_f32_bf16 v227, v96, v146
 v_dot2c_f32_bf16 v224, v67, v147
 v_dot2c_f32_bf16 v225, v77, v147
 v_dot2c_f32_bf16 v226, v87, v147
 v_dot2c_f32_bf16 v227, v97, v147
 v_dot2c_f32_bf16 v224, v68, v148
 v_dot2c_f32_bf16 v225, v78, v148
 v_dot2c_f32_bf16 v226, v88, v148
 v_dot2c_f32_bf16 v227, v98, v148
 v_dot2c_f32_bf16 v224, v69, v149
 v_dot2c_f32_bf16 v225, v79, v149
 v_dot2c_f32_bf16 v226, v89, v149
 v_dot2c_f32_bf16 v227, v99, v149
 v_dot2c_f32_bf16 v224, v70, v150
 v_dot2c_f32_bf16 v225, v80, v150
 v_dot2c_f32_bf16 v226, v90, v150
 v_dot2c_f32_bf16 v227, v100, v150
 v_dot2c_f32_bf16 v224, v71, v151
 v_dot2c_f32_bf16 v225, v81, v151
 v_dot2c_f32_bf16 v226, v91, v151
 v_dot2c_f32_bf16 v227, v101, v151
 v_dot2c_f32_bf16 v224, v72, v152
 v_dot2c_f32_bf16 v225, v82, v152
 v_dot2c_f32_bf16 v226, v92, v152
 v_dot2c_f32_bf16 v227, v102, v152
 v_dot2c_f32_bf16 v224, v73, v153
 v_dot2c_f32_bf16 v225, v83, v153
 v_dot2c_f32_bf16 v226, v93, v153
 v_dot2c_f32_bf16 v227, v103, v153
 s_waitcnt lgkmcnt(0)
 v_dot2c_f32_bf16 v228, v104, v144
 v_dot2c_f32_bf16 v229, v114, v144
 v_dot2c_f32_bf16 v230, v124, v144
 v_dot2c_f32_bf16 v231, v134, v144
 v_dot2c_f32_bf16 v228, v105, v145
 v_dot2c_f32_bf16 v229, v115, v145
 v_dot2c_f32_bf16 v230, v125, v145
 v_dot2c_f32_bf16 v231, v135, v145
 v_dot2c_f32_bf16 v228, v106, v146
 v_dot2c_f32_bf16 v229, v116, v146
 v_dot2c_f32_bf16 v230, v126, v146
 v_dot2c_f32_bf16 v231, v136, v146
 v_dot2c_f32_bf16 v228, v107, v147
 v_dot2c_f32_bf16 v229, v117, v147
 v_dot2c_f32_bf16 v230, v127, v147
 v_dot2c_f32_bf16 v231, v137, v147
 v_dot2c_f32_bf16 v228, v108, v148
 v_dot2c_f32_bf16 v229, v118, v148
 v_dot2c_f32_bf16 v230, v128, v148
 v_dot2c_f32_bf16 v231, v138, v148
 v_dot2c_f32_bf16 v228, v109, v149
 v_dot2c_f32_bf16 v229, v119, v149
 v_dot2c_f32_bf16 v230, v129, v149
 v_dot2c_f32_bf16 v231, v139, v149
 v_dot2c_f32_bf16 v228, v110, v150
 v_dot2c_f32_bf16 v229, v120, v150
 v_dot2c_f32_bf16 v230, v130, v150
 v_dot2c_f32_bf16 v231, v140, v150
 v_dot2c_f32_bf16 v228, v111, v151
 v_dot2c_f32_bf16 v229, v121, v151
 v_dot2c_f32_bf16 v230, v131, v151
 v_dot2c_f32_bf16 v231, v141, v151
 v_dot2c_f32_bf16 v228, v112, v152
 v_dot2c_f32_bf16 v229, v122, v152
 v_dot2c_f32_bf16 v230, v132, v152
 v_dot2c_f32_bf16 v231, v142, v152
 v_dot2c_f32_bf16 v228, v113, v153
 v_dot2c_f32_bf16 v229, v123, v153
 v_dot2c_f32_bf16 v230, v133, v153
 v_dot2c_f32_bf16 v231, v143, v153
 ds_read_b64 v[64:65], v38 offset:2008
 ds_read_b64 v[66:67], v38 offset:2016
 ds_read_b64 v[68:69], v38 offset:2024
 ds_read_b64 v[70:71], v38 offset:2032
 ds_read_b64 v[72:73], v39 offset:2040
 ds_read_b64 v[74:75], v38 offset:1744
 ds_read_b64 v[76:77], v38 offset:1752
 ds_read_b64 v[78:79], v38 offset:1760
 ds_read_b64 v[80:81], v38 offset:1768
 ds_read_b64 v[82:83], v39 offset:1776
 ds_read_b64 v[84:85], v38 offset:1480
 ds_read_b64 v[86:87], v38 offset:1488
 ds_read_b64 v[88:89], v38 offset:1496
 ds_read_b64 v[90:91], v38 offset:1504
 ds_read_b64 v[92:93], v39 offset:1512
 ds_read_b64 v[94:95], v38 offset:1216
 ds_read_b64 v[96:97], v38 offset:1224
 ds_read_b64 v[98:99], v38 offset:1232
 ds_read_b64 v[100:101], v38 offset:1240
 ds_read_b64 v[102:103], v39 offset:1248
 ds_read_b64 v[104:105], v38 offset:952
 ds_read_b64 v[106:107], v38 offset:960
 ds_read_b64 v[108:109], v38 offset:968
 ds_read_b64 v[110:111], v38 offset:976
 ds_read_b64 v[112:113], v39 offset:984
 ds_read_b64 v[114:115], v38 offset:688
 ds_read_b64 v[116:117], v38 offset:696
 ds_read_b64 v[118:119], v38 offset:704
 ds_read_b64 v[120:121], v38 offset:712
 ds_read_b64 v[122:123], v39 offset:720
 ds_read_b64 v[124:125], v38 offset:424
 ds_read_b64 v[126:127], v38 offset:432
 ds_read_b64 v[128:129], v38 offset:440
 ds_read_b64 v[130:131], v38 offset:448
 ds_read_b64 v[132:133], v39 offset:456
 ds_read_b64 v[134:135], v38 offset:160
 ds_read_b64 v[136:137], v38 offset:168
 ds_read_b64 v[138:139], v38 offset:176
 ds_read_b64 v[140:141], v38 offset:184
 ds_read_b64 v[142:143], v39 offset:192
 v_cvt_pk_bf16_f32 v4, v224, v225
 v_lshlrev_b32 v224, 16, v4
 v_and_b32 v225, 0xffff0000, v4
 v_mul_f32 v224, s60, v224
 v_mul_f32 v225, s60, v225
 v_cvt_pk_bf16_f32 v4, v224, v225
 v_lshlrev_b32 v224, 16, v4
 v_and_b32 v225, 0xffff0000, v4
 v_cndmask_b32 v224, v37, v224, s[76:77]
 v_cndmask_b32 v225, v37, v225, s[78:79]
 v_cvt_pk_bf16_f32 v4, v226, v227
 v_lshlrev_b32 v226, 16, v4
 v_and_b32 v227, 0xffff0000, v4
 v_mul_f32 v226, s60, v226
 v_mul_f32 v227, s60, v227
 v_cvt_pk_bf16_f32 v4, v226, v227
 v_lshlrev_b32 v226, 16, v4
 v_and_b32 v227, 0xffff0000, v4
 v_cndmask_b32 v226, v37, v226, s[80:81]
 v_cndmask_b32 v227, v37, v227, s[82:83]
 v_cvt_pk_bf16_f32 v4, v228, v229
 v_lshlrev_b32 v228, 16, v4
 v_and_b32 v229, 0xffff0000, v4
 v_mul_f32 v228, s60, v228
 v_mul_f32 v229, s60, v229
 v_cvt_pk_bf16_f32 v4, v228, v229
 v_lshlrev_b32 v228, 16, v4
 v_and_b32 v229, 0xffff0000, v4
 v_cndmask_b32 v228, v37, v228, s[84:85]
 v_cndmask_b32 v229, v37, v229, s[86:87]
 v_cvt_pk_bf16_f32 v4, v230, v231
 v_lshlrev_b32 v230, 16, v4
 v_and_b32 v231, 0xffff0000, v4
 v_mul_f32 v230, s60, v230
 v_mul_f32 v231, s60, v231
 v_cvt_pk_bf16_f32 v4, v230, v231
 v_lshlrev_b32 v230, 16, v4
 v_and_b32 v231, 0xffff0000, v4
 v_cndmask_b32 v230, v37, v230, s[88:89]
 v_cndmask_b32 v231, v37, v231, s[90:91]
 v_max3_f32 v5, v224, v225, v226
 v_max3_f32 v5, v5, v227, v228
 v_max3_f32 v5, v5, v229, v230
 v_max_f32 v5, v5, v231
 v_sub_f32 v224, v224, v5
 v_mul_f32 v224, s61, v224
 v_exp_f32 v224, v224
 v_sub_f32 v225, v225, v5
 v_mul_f32 v225, s61, v225
 v_exp_f32 v225, v225
 v_sub_f32 v226, v226, v5
 v_mul_f32 v226, s61, v226
 v_exp_f32 v226, v226
 v_sub_f32 v227, v227, v5
 v_mul_f32 v227, s61, v227
 v_exp_f32 v227, v227
 v_sub_f32 v228, v228, v5
 v_mul_f32 v228, s61, v228
 v_exp_f32 v228, v228
 v_sub_f32 v229, v229, v5
 v_mul_f32 v229, s61, v229
 v_exp_f32 v229, v229
 v_sub_f32 v230, v230, v5
 v_mul_f32 v230, s61, v230
 v_exp_f32 v230, v230
 v_sub_f32 v231, v231, v5
 v_mul_f32 v231, s61, v231
 v_exp_f32 v231, v231
 s_nop 0
 v_add_f32 v5, v224, v225
 v_add_f32 v5, v5, v226
 v_add_f32 v5, v5, v227
 v_add_f32 v5, v5, v228
 v_add_f32 v5, v5, v229
 v_add_f32 v5, v5, v230
 v_add_f32 v5, v5, v231
 v_rcp_f32 v5, v5
 s_nop 0
 v_mul_f32 v224, v224, v5
 v_mul_f32 v225, v225, v5
 v_mul_f32 v226, v226, v5
 v_mul_f32 v227, v227, v5
 v_mul_f32 v228, v228, v5
 v_mul_f32 v229, v229, v5
 v_mul_f32 v230, v230, v5
 v_mul_f32 v231, v231, v5
 v_cvt_pk_bf16_f32 v232, v224, v225
 v_cvt_pk_bf16_f32 v233, v226, v227
 v_cvt_pk_bf16_f32 v234, v228, v229
 v_cvt_pk_bf16_f32 v235, v230, v231
 s_waitcnt lgkmcnt(15)
 v_perm_b32 v144, v74, v64, s62
 v_perm_b32 v145, v74, v64, s63
 v_perm_b32 v146, v75, v65, s62
 v_perm_b32 v147, v75, v65, s63
 v_perm_b32 v148, v76, v66, s62
 v_perm_b32 v149, v76, v66, s63
 v_perm_b32 v150, v77, v67, s62
 v_perm_b32 v151, v77, v67, s63
 v_perm_b32 v152, v78, v68, s62
 v_perm_b32 v153, v78, v68, s63
 v_perm_b32 v154, v79, v69, s62
 v_perm_b32 v155, v79, v69, s63
 v_perm_b32 v156, v80, v70, s62
 v_perm_b32 v157, v80, v70, s63
 v_perm_b32 v158, v81, v71, s62
 v_perm_b32 v159, v81, v71, s63
 v_perm_b32 v212, v82, v72, s62
 v_perm_b32 v213, v82, v72, s63
 v_perm_b32 v214, v83, v73, s62
 v_perm_b32 v215, v83, v73, s63
 v_dot2_f32_bf16 v192, v144, v232, 0
 v_dot2_f32_bf16 v193, v145, v232, 0
 v_dot2_f32_bf16 v194, v146, v232, 0
 v_dot2_f32_bf16 v195, v147, v232, 0
 v_dot2_f32_bf16 v196, v148, v232, 0
 v_dot2_f32_bf16 v197, v149, v232, 0
 v_dot2_f32_bf16 v198, v150, v232, 0
 v_dot2_f32_bf16 v199, v151, v232, 0
 v_dot2_f32_bf16 v200, v152, v232, 0
 v_dot2_f32_bf16 v201, v153, v232, 0
 v_dot2_f32_bf16 v202, v154, v232, 0
 v_dot2_f32_bf16 v203, v155, v232, 0
 v_dot2_f32_bf16 v204, v156, v232, 0
 v_dot2_f32_bf16 v205, v157, v232, 0
 v_dot2_f32_bf16 v206, v158, v232, 0
 v_dot2_f32_bf16 v207, v159, v232, 0
 v_dot2_f32_bf16 v208, v212, v232, 0
 v_dot2_f32_bf16 v209, v213, v232, 0
 v_dot2_f32_bf16 v210, v214, v232, 0
 v_dot2_f32_bf16 v211, v215, v232, 0
 s_waitcnt lgkmcnt(15)
 v_perm_b32 v144, v94, v84, s62
 v_perm_b32 v145, v94, v84, s63
 v_perm_b32 v146, v95, v85, s62
 v_perm_b32 v147, v95, v85, s63
 v_perm_b32 v148, v96, v86, s62
 v_perm_b32 v149, v96, v86, s63
 v_perm_b32 v150, v97, v87, s62
 v_perm_b32 v151, v97, v87, s63
 v_perm_b32 v152, v98, v88, s62
 v_perm_b32 v153, v98, v88, s63
 v_perm_b32 v154, v99, v89, s62
 v_perm_b32 v155, v99, v89, s63
 v_perm_b32 v156, v100, v90, s62
 v_perm_b32 v157, v100, v90, s63
 v_perm_b32 v158, v101, v91, s62
 v_perm_b32 v159, v101, v91, s63
 v_perm_b32 v212, v102, v92, s62
 v_perm_b32 v213, v102, v92, s63
 v_perm_b32 v214, v103, v93, s62
 v_perm_b32 v215, v103, v93, s63
 v_dot2c_f32_bf16 v192, v144, v233
 v_dot2c_f32_bf16 v193, v145, v233
 v_dot2c_f32_bf16 v194, v146, v233
 v_dot2c_f32_bf16 v195, v147, v233
 v_dot2c_f32_bf16 v196, v148, v233
 v_dot2c_f32_bf16 v197, v149, v233
 v_dot2c_f32_bf16 v198, v150, v233
 v_dot2c_f32_bf16 v199, v151, v233
 v_dot2c_f32_bf16 v200, v152, v233
 v_dot2c_f32_bf16 v201, v153, v233
 v_dot2c_f32_bf16 v202, v154, v233
 v_dot2c_f32_bf16 v203, v155, v233
 v_dot2c_f32_bf16 v204, v156, v233
 v_dot2c_f32_bf16 v205, v157, v233
 v_dot2c_f32_bf16 v206, v158, v233
 v_dot2c_f32_bf16 v207, v159, v233
 v_dot2c_f32_bf16 v208, v212, v233
 v_dot2c_f32_bf16 v209, v213, v233
 v_dot2c_f32_bf16 v210, v214, v233
 v_dot2c_f32_bf16 v211, v215, v233
 s_waitcnt lgkmcnt(10)
 v_perm_b32 v144, v114, v104, s62
 v_perm_b32 v145, v114, v104, s63
 v_perm_b32 v146, v115, v105, s62
 v_perm_b32 v147, v115, v105, s63
 v_perm_b32 v148, v116, v106, s62
 v_perm_b32 v149, v116, v106, s63
 v_perm_b32 v150, v117, v107, s62
 v_perm_b32 v151, v117, v107, s63
 v_perm_b32 v152, v118, v108, s62
 v_perm_b32 v153, v118, v108, s63
 v_perm_b32 v154, v119, v109, s62
 v_perm_b32 v155, v119, v109, s63
 v_perm_b32 v156, v120, v110, s62
 v_perm_b32 v157, v120, v110, s63
 v_perm_b32 v158, v121, v111, s62
 v_perm_b32 v159, v121, v111, s63
 v_perm_b32 v212, v122, v112, s62
 v_perm_b32 v213, v122, v112, s63
 v_perm_b32 v214, v123, v113, s62
 v_perm_b32 v215, v123, v113, s63
 v_dot2c_f32_bf16 v192, v144, v234
 v_dot2c_f32_bf16 v193, v145, v234
 v_dot2c_f32_bf16 v194, v146, v234
 v_dot2c_f32_bf16 v195, v147, v234
 v_dot2c_f32_bf16 v196, v148, v234
 v_dot2c_f32_bf16 v197, v149, v234
 v_dot2c_f32_bf16 v198, v150, v234
 v_dot2c_f32_bf16 v199, v151, v234
 v_dot2c_f32_bf16 v200, v152, v234
 v_dot2c_f32_bf16 v201, v153, v234
 v_dot2c_f32_bf16 v202, v154, v234
 v_dot2c_f32_bf16 v203, v155, v234
 v_dot2c_f32_bf16 v204, v156, v234
 v_dot2c_f32_bf16 v205, v157, v234
 v_dot2c_f32_bf16 v206, v158, v234
 v_dot2c_f32_bf16 v207, v159, v234
 v_dot2c_f32_bf16 v208, v212, v234
 v_dot2c_f32_bf16 v209, v213, v234
 v_dot2c_f32_bf16 v210, v214, v234
 v_dot2c_f32_bf16 v211, v215, v234
 s_waitcnt lgkmcnt(0)
 v_perm_b32 v144, v134, v124, s62
 v_perm_b32 v145, v134, v124, s63
 v_perm_b32 v146, v135, v125, s62
 v_perm_b32 v147, v135, v125, s63
 v_perm_b32 v148, v136, v126, s62
 v_perm_b32 v149, v136, v126, s63
 v_perm_b32 v150, v137, v127, s62
 v_perm_b32 v151, v137, v127, s63
 v_perm_b32 v152, v138, v128, s62
 v_perm_b32 v153, v138, v128, s63
 v_perm_b32 v154, v139, v129, s62
 v_perm_b32 v155, v139, v129, s63
 v_perm_b32 v156, v140, v130, s62
 v_perm_b32 v157, v140, v130, s63
 v_perm_b32 v158, v141, v131, s62
 v_perm_b32 v159, v141, v131, s63
 v_perm_b32 v212, v142, v132, s62
 v_perm_b32 v213, v142, v132, s63
 v_perm_b32 v214, v143, v133, s62
 v_perm_b32 v215, v143, v133, s63
 v_dot2c_f32_bf16 v192, v144, v235
 v_dot2c_f32_bf16 v193, v145, v235
 v_dot2c_f32_bf16 v194, v146, v235
 v_dot2c_f32_bf16 v195, v147, v235
 v_dot2c_f32_bf16 v196, v148, v235
 v_dot2c_f32_bf16 v197, v149, v235
 v_dot2c_f32_bf16 v198, v150, v235
 v_dot2c_f32_bf16 v199, v151, v235
 v_dot2c_f32_bf16 v200, v152, v235
 v_dot2c_f32_bf16 v201, v153, v235
 v_dot2c_f32_bf16 v202, v154, v235
 v_dot2c_f32_bf16 v203, v155, v235
 v_dot2c_f32_bf16 v204, v156, v235
 v_dot2c_f32_bf16 v205, v157, v235
 v_dot2c_f32_bf16 v206, v158, v235
 v_dot2c_f32_bf16 v207, v159, v235
 v_dot2c_f32_bf16 v208, v212, v235
 v_dot2c_f32_bf16 v209, v213, v235
 v_dot2c_f32_bf16 v210, v214, v235
 v_dot2c_f32_bf16 v211, v215, v235
 s_cmp_lg_u32 s20, 0
 s_cbranch_scc1 bh_196
 ds_read_b64 v[64:65], v35 offset:33792
 ds_read_b64 v[66:67], v35 offset:34304
 ds_read_b64 v[68:69], v35 offset:34816
 ds_read_b64 v[70:71], v35 offset:35328
 ds_read_b64 v[72:73], v35 offset:35840
 s_waitcnt lgkmcnt(0)
 ds_write_b64 v35, v[64:65] offset:0
 ds_write_b64 v35, v[66:67] offset:512
 ds_write_b64 v35, v[68:69] offset:1024
 ds_write_b64 v35, v[70:71] offset:1536
 ds_write_b64 v35, v[72:73] offset:2048
bh_196:
 s_nop 1
 v_cvt_pk_bf16_f32 v244, v192, v193
 v_cvt_pk_bf16_f32 v245, v194, v195
 v_cvt_pk_bf16_f32 v246, v196, v197
 v_cvt_pk_bf16_f32 v247, v198, v199
 v_cvt_pk_bf16_f32 v248, v200, v201
 v_cvt_pk_bf16_f32 v249, v202, v203
 v_cvt_pk_bf16_f32 v250, v204, v205
 v_cvt_pk_bf16_f32 v251, v206, v207
 v_cvt_pk_bf16_f32 v252, v208, v209
 v_cvt_pk_bf16_f32 v253, v210, v211
 buffer_store_dwordx4 v[244:247], v29, s[16:19], s27 offen sc1
 buffer_store_dwordx4 v[248:251], v30, s[16:19], s27 offen sc1
 buffer_store_dwordx2 v[252:253], v31, s[16:19], s27 offen sc1
 s_add_u32 s27, s27, 2048
 s_mov_b64 s[78:79], -1
 s_mov_b64 s[80:81], -1
 s_mov_b64 s[82:83], -1
 s_mov_b64 s[84:85], -1
 s_mov_b64 s[86:87], -1
 s_mov_b64 s[88:89], -1
 s_mov_b64 s[90:91], -1
 s_sub_u32 s26, s26, 1
 s_cmp_gt_u32 s26, 0
 s_waitcnt lgkmcnt(0)
 s_cbranch_scc1 bf_blk_193
 s_waitcnt vmcnt(0) lgkmcnt(0)
 s_barrier
 s_mov_b32 s84, 0
 s_mov_b32 s85, -1
 v_readfirstlane_b32 s21, v32
 s_cmp_ge_u32 s21, 32
 s_cbranch_scc1 bt_197
 s_mov_b32 s21, 76
 v_mov_b32 v4, 0
 s_mov_b32 s101, 0
wf_198:
 buffer_load_dword v5, v4, s[64:67], s21 offen sc1
 s_add_u32 s101, s101, 1
 s_cmp_gt_u32 s101, 131072
 s_cbranch_scc1 main_end
 s_waitcnt vmcnt(0)
 v_readfirstlane_b32 s100, v5
 s_cmp_ge_u32 s100, 32
 s_cbranch_scc1 wf_199
 s_sleep 8
 s_branch wf_198
wf_199:
bt_197:
 s_mov_b32 s21, 91136
 s_cmp_lg_u32 s20, 0
 s_cbranch_scc1 af_200
 v_mov_b32 v4, 0
 v_mov_b32 v5, 1
 s_mov_b64 exec, 1
 buffer_atomic_add v5, v4, s[72:75], s21 offen sc1
 s_mov_b64 exec, -1
 s_nop 1
af_200:
 s_mov_b32 s101, 0
c0_201:
 v_cmp_eq_u32 vcc, 0, v50
 s_nop 1
 s_cbranch_vccz c0_202
 s_sleep 8
 v_and_b32 v51, 31, v1
 buffer_load_ubyte v50, v51, s[64:67], 0 offen offset:160 sc1
 s_add_u32 s101, s101, 1
 s_cmp_gt_u32 s101, 131072
 s_cbranch_scc1 main_end
 s_waitcnt vmcnt(0)
 s_branch c0_201
c0_202:
 v_cmp_eq_u32 vcc, 2, v50
 s_nop 1
 s_mov_b32 s37, vcc_lo
q_entry:
 s_load_dwordx2 s[4:5], s[0:1], 0
 s_load_dwordx2 s[6:7], s[0:1], 16
 s_load_dwordx2 s[38:39], s[0:1], 104
 s_mov_b32 s42, s2
 s_cmp_lt_u32 s3, 64
 s_cselect_b32 s41, 10, 0
 s_cselect_b32 s45, 8, 0
 s_waitcnt lgkmcnt(0)
 s_mov_b32 s8, s4
 s_mov_b32 s9, s5
 s_mov_b32 s10, 2621440
 s_mov_b32 s11, 0x00020000
 s_mov_b32 s12, s6
 s_mov_b32 s13, s7
 s_mov_b32 s14, 7864320
 s_mov_b32 s15, 0x00020000
 s_mov_b32 s16, s38
 s_mov_b32 s17, s39
 s_mov_b32 s18, 50331648
 s_mov_b32 s19, 0x00020000
 s_add_u32 s52, s38, 180355072
 s_addc_u32 s53, s39, 0
 s_mov_b32 s54, 67108864
 s_mov_b32 s55, 0x00020000
 s_add_u32 s56, s38, 180355072
 s_addc_u32 s57, s39, 0
 s_mov_b32 s58, 67108864
 s_mov_b32 s59, 0x00020000
 s_load_dwordx2 s[72:73], s[0:1], 104
 s_waitcnt lgkmcnt(0)
 s_add_u32 s72, s72, 81068032
 s_addc_u32 s73, s73, 0
 s_mov_b32 s74, 129024
 s_mov_b32 s75, 0x00020000
 s_mul_i32 s44, s42, 384
 s_mul_i32 s24, s45, 307200
 v_mov_b32 v9, 2731
 s_and_b32 s22, s20, 1
 s_lshl_b32 s22, s22, 2
 v_add_u32 v8, 0, v1
 v_mul_u32_u24 v7, v8, v9
 v_lshrrev_b32 v7, 16, v7
 v_mul_u32_u24 v4, 24, v7
 v_sub_u32 v8, v8, v4
 v_and_b32 v4, 2, v7
 v_xor_b32 v8, v8, v4
 v_xor_b32 v8, s22, v8
 v_xor_b32 v5, 4, v8
 s_mov_b32 s21, 12288
 v_mul_lo_u32 v7, v7, s21
 v_lshl_add_u32 v40, v8, 4, v7
 v_lshl_add_u32 v43, v5, 4, v7
 v_add_u32 v8, 64, v1
 v_mul_u32_u24 v7, v8, v9
 v_lshrrev_b32 v7, 16, v7
 v_mul_u32_u24 v4, 24, v7
 v_sub_u32 v8, v8, v4
 v_and_b32 v4, 2, v7
 v_xor_b32 v8, v8, v4
 v_xor_b32 v8, s22, v8
 v_xor_b32 v5, 4, v8
 s_mov_b32 s21, 12288
 v_mul_lo_u32 v7, v7, s21
 v_lshl_add_u32 v41, v8, 4, v7
 v_lshl_add_u32 v44, v5, 4, v7
 v_add_u32 v8, 128, v1
 v_mul_u32_u24 v7, v8, v9
 v_lshrrev_b32 v7, 16, v7
 v_mul_u32_u24 v4, 24, v7
 v_sub_u32 v8, v8, v4
 v_and_b32 v4, 2, v7
 v_xor_b32 v8, v8, v4
 v_xor_b32 v8, s22, v8
 v_xor_b32 v5, 4, v8
 s_mov_b32 s21, 12288
 v_mul_lo_u32 v7, v7, s21
 v_lshl_add_u32 v42, v8, 4, v7
 v_lshl_add_u32 v45, v5, 4, v7
 s_mul_i32 s23, s20, 491520
 s_add_u32 s23, s23, s44
 s_mul_i32 s22, s20, 15360
 s_add_u32 s22, s22, 98304
 s_add_u32 s21, s23, 0
 s_add_u32 m0, s22, 0
 s_nop 0
 buffer_load_dwordx4 v40, s[12:15], s21 offen lds
 s_add_u32 m0, s22, 1024
 s_nop 0
 buffer_load_dwordx4 v41, s[12:15], s21 offen lds
 s_add_u32 m0, s22, 2048
 s_nop 0
 buffer_load_dwordx4 v42, s[12:15], s21 offen lds
 s_add_u32 s21, s23, 98304
 s_add_u32 m0, s22, 3072
 s_nop 0
 buffer_load_dwordx4 v43, s[12:15], s21 offen lds
 s_add_u32 m0, s22, 4096
 s_nop 0
 buffer_load_dwordx4 v44, s[12:15], s21 offen lds
 s_add_u32 m0, s22, 5120
 s_nop 0
 buffer_load_dwordx4 v45, s[12:15], s21 offen lds
 s_add_u32 s21, s23, 196608
 s_add_u32 m0, s22, 6144
 s_nop 0
 buffer_load_dwordx4 v40, s[12:15], s21 offen lds
 s_add_u32 m0, s22, 7168
 s_nop 0
 buffer_load_dwordx4 v41, s[12:15], s21 offen lds
 s_add_u32 m0, s22, 8192
 s_nop 0
 buffer_load_dwordx4 v42, s[12:15], s21 offen lds
 s_add_u32 s21, s23, 294912
 s_add_u32 m0, s22, 9216
 s_nop 0
 buffer_load_dwordx4 v43, s[12:15], s21 offen lds
 s_add_u32 m0, s22, 10240
 s_nop 0
 buffer_load_dwordx4 v44, s[12:15], s21 offen lds
 s_add_u32 m0, s22, 11264
 s_nop 0
 buffer_load_dwordx4 v45, s[12:15], s21 offen lds
 s_add_u32 s21, s23, 393216
 s_add_u32 m0, s22, 12288
 s_nop 0
 buffer_load_dwordx4 v40, s[12:15], s21 offen lds
 s_add_u32 m0, s22, 13312
 s_nop 0
 buffer_load_dwordx4 v41, s[12:15], s21 offen lds
 s_add_u32 m0, s22, 14336
 s_nop 0
 buffer_load_dwordx4 v42, s[12:15], s21 offen lds
 s_add_u32 s21, s23, 1966080
 buffer_load_dwordx4 v[64:67], v40, s[12:15], s21 offen
 buffer_load_dwordx4 v[68:71], v41, s[12:15], s21 offen
 buffer_load_dwordx4 v[72:75], v42, s[12:15], s21 offen
 s_add_u32 s21, s23, 2064384
 buffer_load_dwordx4 v[76:79], v43, s[12:15], s21 offen
 buffer_load_dwordx4 v[80:83], v44, s[12:15], s21 offen
 buffer_load_dwordx4 v[84:87], v45, s[12:15], s21 offen
 s_add_u32 s21, s23, 2162688
 buffer_load_dwordx4 v[88:91], v40, s[12:15], s21 offen
 buffer_load_dwordx4 v[92:95], v41, s[12:15], s21 offen
 buffer_load_dwordx4 v[96:99], v42, s[12:15], s21 offen
 s_add_u32 s21, s23, 2260992
 buffer_load_dwordx4 v[100:103], v43, s[12:15], s21 offen
 buffer_load_dwordx4 v[104:107], v44, s[12:15], s21 offen
 buffer_load_dwordx4 v[108:111], v45, s[12:15], s21 offen
 s_add_u32 s21, s23, 2359296
 buffer_load_dwordx4 v[112:115], v40, s[12:15], s21 offen
 buffer_load_dwordx4 v[116:119], v41, s[12:15], s21 offen
 buffer_load_dwordx4 v[120:123], v42, s[12:15], s21 offen
 s_add_u32 s21, s23, 3932160
 buffer_load_dwordx4 v[124:127], v40, s[12:15], s21 offen
 buffer_load_dwordx4 v[128:131], v41, s[12:15], s21 offen
 buffer_load_dwordx4 v[132:135], v42, s[12:15], s21 offen
 s_add_u32 s21, s23, 4030464
 buffer_load_dwordx4 v[136:139], v43, s[12:15], s21 offen
 buffer_load_dwordx4 v[140:143], v44, s[12:15], s21 offen
 buffer_load_dwordx4 v[144:147], v45, s[12:15], s21 offen
 s_add_u32 s21, s23, 4128768
 buffer_load_dwordx4 v[148:151], v40, s[12:15], s21 offen
 buffer_load_dwordx4 v[152:155], v41, s[12:15], s21 offen
 buffer_load_dwordx4 v[156:159], v42, s[12:15], s21 offen
 s_add_u32 s21, s23, 4227072
 buffer_load_dwordx4 v[160:163], v43, s[12:15], s21 offen
 buffer_load_dwordx4 v[164:167], v44, s[12:15], s21 offen
 buffer_load_dwordx4 v[168:171], v45, s[12:15], s21 offen
 s_add_u32 s21, s23, 4325376
 buffer_load_dwordx4 v[172:175], v40, s[12:15], s21 offen
 buffer_load_dwordx4 v[176:179], v41, s[12:15], s21 offen
 buffer_load_dwordx4 v[180:183], v42, s[12:15], s21 offen
 s_add_u32 s21, s23, 5898240
 buffer_load_dwordx4 v[184:187], v40, s[12:15], s21 offen
 buffer_load_dwordx4 v[188:191], v41, s[12:15], s21 offen
 buffer_load_dwordx4 v[192:195], v42, s[12:15], s21 offen
 s_add_u32 s21, s23, 5996544
 buffer_load_dwordx4 v[196:199], v43, s[12:15], s21 offen
 buffer_load_dwordx4 v[200:203], v44, s[12:15], s21 offen
 buffer_load_dwordx4 v[204:207], v45, s[12:15], s21 offen
 s_add_u32 s21, s23, 6094848
 buffer_load_dwordx4 v[208:211], v40, s[12:15], s21 offen
 buffer_load_dwordx4 v[212:215], v41, s[12:15], s21 offen
 buffer_load_dwordx4 v[216:219], v42, s[12:15], s21 offen
 s_add_u32 s21, s23, 6193152
 buffer_load_dwordx4 v[220:223], v43, s[12:15], s21 offen
 buffer_load_dwordx4 v[224:227], v44, s[12:15], s21 offen
 buffer_load_dwordx4 v[228:231], v45, s[12:15], s21 offen
 s_add_u32 s21, s23, 6291456
 buffer_load_dwordx4 v[232:235], v40, s[12:15], s21 offen
 buffer_load_dwordx4 v[236:239], v41, s[12:15], s21 offen
 buffer_load_dwordx4 v[240:243], v42, s[12:15], s21 offen
 v_lshl_add_u32 v49, v1, 4, s22
 v_lshrrev_b32 v7, 2, v2
 v_and_b32 v4, 2, v7
 v_and_b32 v5, 1, v3
 v_lshl_or_b32 v4, v5, 2, v4
 v_lshl_add_u32 v7, v3, 3, v7
 v_mul_u32_u24 v7, 384, v7
 v_and_b32 v5, 1, v2
 v_lshl_add_u32 v7, v5, 3, v7
 v_add_u32 v7, 98304, v7
 v_bfe_u32 v8, v2, 1, 1
 s_mul_i32 s21, s20, 6
 v_add_u32 v8, s21, v8
 v_add_u32 v5, 0, v8
 v_xor_b32 v5, v5, v4
 v_lshl_add_u32 v46, v5, 4, v7
 v_add_u32 v5, 2, v8
 v_xor_b32 v5, v5, v4
 v_lshl_add_u32 v47, v5, 4, v7
 v_add_u32 v5, 4, v8
 v_xor_b32 v5, v5, v4
 v_lshl_add_u32 v48, v5, 4, v7
 s_waitcnt vmcnt(45)
 s_barrier
 ds_read_b64_tr_b16 a[0:1], v46 offset:0
 ds_read_b64_tr_b16 a[2:3], v46 offset:1536
 ds_read_b64_tr_b16 a[4:5], v47 offset:0
 ds_read_b64_tr_b16 a[6:7], v47 offset:1536
 ds_read_b64_tr_b16 a[8:9], v48 offset:0
 ds_read_b64_tr_b16 a[10:11], v48 offset:1536
 ds_read_b64_tr_b16 a[12:13], v46 offset:12288
 ds_read_b64_tr_b16 a[14:15], v46 offset:13824
 ds_read_b64_tr_b16 a[16:17], v47 offset:12288
 ds_read_b64_tr_b16 a[18:19], v47 offset:13824
 ds_read_b64_tr_b16 a[20:21], v48 offset:12288
 ds_read_b64_tr_b16 a[22:23], v48 offset:13824
 ds_read_b64_tr_b16 a[24:25], v46 offset:24576
 ds_read_b64_tr_b16 a[26:27], v46 offset:26112
 ds_read_b64_tr_b16 a[28:29], v47 offset:24576
 ds_read_b64_tr_b16 a[30:31], v47 offset:26112
 ds_read_b64_tr_b16 a[32:33], v48 offset:24576
 ds_read_b64_tr_b16 a[34:35], v48 offset:26112
 ds_read_b64_tr_b16 a[36:37], v46 offset:36864
 ds_read_b64_tr_b16 a[38:39], v46 offset:38400
 ds_read_b64_tr_b16 a[40:41], v47 offset:36864
 ds_read_b64_tr_b16 a[42:43], v47 offset:38400
 ds_read_b64_tr_b16 a[44:45], v48 offset:36864
 ds_read_b64_tr_b16 a[46:47], v48 offset:38400
 ds_read_b64_tr_b16 a[48:49], v46 offset:49152
 ds_read_b64_tr_b16 a[50:51], v46 offset:50688
 ds_read_b64_tr_b16 a[52:53], v47 offset:49152
 ds_read_b64_tr_b16 a[54:55], v47 offset:50688
 ds_read_b64_tr_b16 a[56:57], v48 offset:49152
 ds_read_b64_tr_b16 a[58:59], v48 offset:50688
 v_lshrrev_b32 v11, 3, v1
 v_and_b32 v12, 7, v1
 v_xor_b32 v12, v12, v11
 v_mul_u32_u24 v11, 1280, v11
 v_lshl_add_u32 v10, v12, 4, v11
 s_mul_i32 s46, s20, 40960
 v_add_u32 v10, s46, v10
 s_lshl_b32 s47, s20, 12
 s_add_u32 s47, s47, 0
 s_add_u32 s46, s47, 98304
 s_mov_b32 s30, s24
 s_add_u32 s32, s47, 0
 v_add_u32 v11, 9216, v10
 v_add_u32 v12, 18432, v10
 v_add_u32 v13, 27648, v10
 s_mov_b32 m0, s32
 s_nop 0
 buffer_load_dwordx4 v10, s[8:11], s30 offen offset:0 lds
 buffer_load_dwordx4 v11, s[8:11], s30 offen offset:1024 lds
 buffer_load_dwordx4 v12, s[8:11], s30 offen offset:2048 lds
 buffer_load_dwordx4 v13, s[8:11], s30 offen offset:3072 lds
 s_add_u32 s30, s30, 128
 s_add_u32 s32, s32, 16384
 s_cmp_lt_u32 s32, s46
 s_cselect_b32 s32, s32, s47
 s_mov_b32 m0, s32
 s_nop 0
 buffer_load_dwordx4 v10, s[8:11], s30 offen offset:0 lds
 buffer_load_dwordx4 v11, s[8:11], s30 offen offset:1024 lds
 buffer_load_dwordx4 v12, s[8:11], s30 offen offset:2048 lds
 buffer_load_dwordx4 v13, s[8:11], s30 offen offset:3072 lds
 s_add_u32 s30, s30, 128
 s_add_u32 s32, s32, 16384
 s_cmp_lt_u32 s32, s46
 s_cselect_b32 s32, s32, s47
 s_mov_b32 m0, s32
 s_nop 0
 buffer_load_dwordx4 v10, s[8:11], s30 offen offset:0 lds
 buffer_load_dwordx4 v11, s[8:11], s30 offen offset:1024 lds
 buffer_load_dwordx4 v12, s[8:11], s30 offen offset:2048 lds
 buffer_load_dwordx4 v13, s[8:11], s30 offen offset:3072 lds
 s_add_u32 s30, s30, 128
 s_add_u32 s32, s32, 16384
 s_cmp_lt_u32 s32, s46
 s_cselect_b32 s32, s32, s47
 s_mov_b32 m0, s32
 s_nop 0
 buffer_load_dwordx4 v10, s[8:11], s30 offen offset:0 lds
 buffer_load_dwordx4 v11, s[8:11], s30 offen offset:1024 lds
 buffer_load_dwordx4 v12, s[8:11], s30 offen offset:2048 lds
 buffer_load_dwordx4 v13, s[8:11], s30 offen offset:3072 lds
 s_add_u32 s30, s30, 128
 s_add_u32 s32, s32, 16384
 s_cmp_lt_u32 s32, s46
 s_cselect_b32 s32, s32, s47
 s_waitcnt lgkmcnt(0)
 s_barrier
 s_waitcnt vmcnt(46)
 ds_write_b128 v49, v[64:67] offset:0
 ds_write_b128 v49, v[68:71] offset:1024
 ds_write_b128 v49, v[72:75] offset:2048
 ds_write_b128 v49, v[76:79] offset:3072
 ds_write_b128 v49, v[80:83] offset:4096
 ds_write_b128 v49, v[84:87] offset:5120
 ds_write_b128 v49, v[88:91] offset:6144
 ds_write_b128 v49, v[92:95] offset:7168
 ds_write_b128 v49, v[96:99] offset:8192
 ds_write_b128 v49, v[100:103] offset:9216
 ds_write_b128 v49, v[104:107] offset:10240
 ds_write_b128 v49, v[108:111] offset:11264
 ds_write_b128 v49, v[112:115] offset:12288
 ds_write_b128 v49, v[116:119] offset:13312
 ds_write_b128 v49, v[120:123] offset:14336
 s_waitcnt lgkmcnt(0)
 s_barrier
 ds_read_b64_tr_b16 a[60:61], v46 offset:0
 ds_read_b64_tr_b16 a[62:63], v46 offset:1536
 ds_read_b64_tr_b16 a[64:65], v47 offset:0
 ds_read_b64_tr_b16 a[66:67], v47 offset:1536
 ds_read_b64_tr_b16 a[68:69], v48 offset:0
 ds_read_b64_tr_b16 a[70:71], v48 offset:1536
 ds_read_b64_tr_b16 a[72:73], v46 offset:12288
 ds_read_b64_tr_b16 a[74:75], v46 offset:13824
 ds_read_b64_tr_b16 a[76:77], v47 offset:12288
 ds_read_b64_tr_b16 a[78:79], v47 offset:13824
 ds_read_b64_tr_b16 a[80:81], v48 offset:12288
 ds_read_b64_tr_b16 a[82:83], v48 offset:13824
 ds_read_b64_tr_b16 a[84:85], v46 offset:24576
 ds_read_b64_tr_b16 a[86:87], v46 offset:26112
 ds_read_b64_tr_b16 a[88:89], v47 offset:24576
 ds_read_b64_tr_b16 a[90:91], v47 offset:26112
 ds_read_b64_tr_b16 a[92:93], v48 offset:24576
 ds_read_b64_tr_b16 a[94:95], v48 offset:26112
 ds_read_b64_tr_b16 a[96:97], v46 offset:36864
 ds_read_b64_tr_b16 a[98:99], v46 offset:38400
 ds_read_b64_tr_b16 a[100:101], v47 offset:36864
 ds_read_b64_tr_b16 a[102:103], v47 offset:38400
 ds_read_b64_tr_b16 a[104:105], v48 offset:36864
 ds_read_b64_tr_b16 a[106:107], v48 offset:38400
 ds_read_b64_tr_b16 a[108:109], v46 offset:49152
 ds_read_b64_tr_b16 a[110:111], v46 offset:50688
 ds_read_b64_tr_b16 a[112:113], v47 offset:49152
 ds_read_b64_tr_b16 a[114:115], v47 offset:50688
 ds_read_b64_tr_b16 a[116:117], v48 offset:49152
 ds_read_b64_tr_b16 a[118:119], v48 offset:50688
 s_waitcnt lgkmcnt(0)
 s_barrier
 s_waitcnt vmcnt(31)
 ds_write_b128 v49, v[124:127] offset:0
 ds_write_b128 v49, v[128:131] offset:1024
 ds_write_b128 v49, v[132:135] offset:2048
 ds_write_b128 v49, v[136:139] offset:3072
 ds_write_b128 v49, v[140:143] offset:4096
 ds_write_b128 v49, v[144:147] offset:5120
 ds_write_b128 v49, v[148:151] offset:6144
 ds_write_b128 v49, v[152:155] offset:7168
 ds_write_b128 v49, v[156:159] offset:8192
 ds_write_b128 v49, v[160:163] offset:9216
 ds_write_b128 v49, v[164:167] offset:10240
 ds_write_b128 v49, v[168:171] offset:11264
 ds_write_b128 v49, v[172:175] offset:12288
 ds_write_b128 v49, v[176:179] offset:13312
 ds_write_b128 v49, v[180:183] offset:14336
 s_waitcnt lgkmcnt(0)
 s_barrier
 ds_read_b64_tr_b16 a[120:121], v46 offset:0
 ds_read_b64_tr_b16 a[122:123], v46 offset:1536
 ds_read_b64_tr_b16 a[124:125], v47 offset:0
 ds_read_b64_tr_b16 a[126:127], v47 offset:1536
 ds_read_b64_tr_b16 a[128:129], v48 offset:0
 ds_read_b64_tr_b16 a[130:131], v48 offset:1536
 ds_read_b64_tr_b16 a[132:133], v46 offset:12288
 ds_read_b64_tr_b16 a[134:135], v46 offset:13824
 ds_read_b64_tr_b16 a[136:137], v47 offset:12288
 ds_read_b64_tr_b16 a[138:139], v47 offset:13824
 ds_read_b64_tr_b16 a[140:141], v48 offset:12288
 ds_read_b64_tr_b16 a[142:143], v48 offset:13824
 ds_read_b64_tr_b16 a[144:145], v46 offset:24576
 ds_read_b64_tr_b16 a[146:147], v46 offset:26112
 ds_read_b64_tr_b16 a[148:149], v47 offset:24576
 ds_read_b64_tr_b16 a[150:151], v47 offset:26112
 ds_read_b64_tr_b16 a[152:153], v48 offset:24576
 ds_read_b64_tr_b16 a[154:155], v48 offset:26112
 ds_read_b64_tr_b16 a[156:157], v46 offset:36864
 ds_read_b64_tr_b16 a[158:159], v46 offset:38400
 ds_read_b64_tr_b16 a[160:161], v47 offset:36864
 ds_read_b64_tr_b16 a[162:163], v47 offset:38400
 ds_read_b64_tr_b16 a[164:165], v48 offset:36864
 ds_read_b64_tr_b16 a[166:167], v48 offset:38400
 ds_read_b64_tr_b16 a[168:169], v46 offset:49152
 ds_read_b64_tr_b16 a[170:171], v46 offset:50688
 ds_read_b64_tr_b16 a[172:173], v47 offset:49152
 ds_read_b64_tr_b16 a[174:175], v47 offset:50688
 ds_read_b64_tr_b16 a[176:177], v48 offset:49152
 ds_read_b64_tr_b16 a[178:179], v48 offset:50688
 s_waitcnt lgkmcnt(0)
 s_barrier
 s_waitcnt vmcnt(16)
 ds_write_b128 v49, v[184:187] offset:0
 ds_write_b128 v49, v[188:191] offset:1024
 ds_write_b128 v49, v[192:195] offset:2048
 ds_write_b128 v49, v[196:199] offset:3072
 ds_write_b128 v49, v[200:203] offset:4096
 ds_write_b128 v49, v[204:207] offset:5120
 ds_write_b128 v49, v[208:211] offset:6144
 ds_write_b128 v49, v[212:215] offset:7168
 ds_write_b128 v49, v[216:219] offset:8192
 ds_write_b128 v49, v[220:223] offset:9216
 ds_write_b128 v49, v[224:227] offset:10240
 ds_write_b128 v49, v[228:231] offset:11264
 ds_write_b128 v49, v[232:235] offset:12288
 ds_write_b128 v49, v[236:239] offset:13312
 ds_write_b128 v49, v[240:243] offset:14336
 s_waitcnt lgkmcnt(0)
 s_barrier
 ds_read_b64_tr_b16 a[180:181], v46 offset:0
 ds_read_b64_tr_b16 a[182:183], v46 offset:1536
 ds_read_b64_tr_b16 a[184:185], v47 offset:0
 ds_read_b64_tr_b16 a[186:187], v47 offset:1536
 ds_read_b64_tr_b16 a[188:189], v48 offset:0
 ds_read_b64_tr_b16 a[190:191], v48 offset:1536
 ds_read_b64_tr_b16 a[192:193], v46 offset:12288
 ds_read_b64_tr_b16 a[194:195], v46 offset:13824
 ds_read_b64_tr_b16 a[196:197], v47 offset:12288
 ds_read_b64_tr_b16 a[198:199], v47 offset:13824
 ds_read_b64_tr_b16 a[200:201], v48 offset:12288
 ds_read_b64_tr_b16 a[202:203], v48 offset:13824
 ds_read_b64_tr_b16 a[204:205], v46 offset:24576
 ds_read_b64_tr_b16 a[206:207], v46 offset:26112
 ds_read_b64_tr_b16 a[208:209], v47 offset:24576
 ds_read_b64_tr_b16 a[210:211], v47 offset:26112
 ds_read_b64_tr_b16 a[212:213], v48 offset:24576
 ds_read_b64_tr_b16 a[214:215], v48 offset:26112
 ds_read_b64_tr_b16 a[216:217], v46 offset:36864
 ds_read_b64_tr_b16 a[218:219], v46 offset:38400
 ds_read_b64_tr_b16 a[220:221], v47 offset:36864
 ds_read_b64_tr_b16 a[222:223], v47 offset:38400
 ds_read_b64_tr_b16 a[224:225], v48 offset:36864
 ds_read_b64_tr_b16 a[226:227], v48 offset:38400
 ds_read_b64_tr_b16 a[228:229], v46 offset:49152
 ds_read_b64_tr_b16 a[230:231], v46 offset:50688
 ds_read_b64_tr_b16 a[232:233], v47 offset:49152
 ds_read_b64_tr_b16 a[234:235], v47 offset:50688
 ds_read_b64_tr_b16 a[236:237], v48 offset:49152
 ds_read_b64_tr_b16 a[238:239], v48 offset:50688
 s_waitcnt lgkmcnt(0)
 s_barrier
 s_add_u32 s12, s38, 57671680
 s_addc_u32 s13, s39, 0
 s_mov_b32 s14, 1572864
 s_mov_b32 s15, 0x00020000
 s_mul_i32 s21, s20, 12800
 s_add_u32 s21, s21, 98304
 v_mul_u32_u24 v4, 400, v2
 v_lshlrev_b32 v5, 4, v3
 v_add3_u32 v29, v4, v5, s21
 v_lshlrev_b32 v30, 4, v1
 v_and_b32 v4, 1, v2
 v_bfe_u32 v5, v2, 1, 1
 v_lshl_or_b32 v4, v5, 2, v4
 v_bfe_u32 v5, v2, 2, 1
 v_lshl_or_b32 v4, v5, 1, v4
 v_lshlrev_b32 v4, 4, v4
 v_lshl_add_u32 v31, v3, 7, v4
 v_lshlrev_b32 v32, 3, v1
 v_and_b32 v4, 3, v1
 v_lshlrev_b32 v33, 3, v4
 v_mov_b32 v34, 0xf149f2ca
 v_lshlrev_b32 v4, 2, v3
 v_sub_u32 v35, v2, v4
 v_cmp_gt_u32 s[60:61], 2, v3
 s_mov_b32 s62, 0x3d93cd3a
 s_mov_b32 s63, 0x3fb8aa3b
 s_mov_b32 s83, 0x3dd53b95
 v_cmp_le_i32 s[64:65], 0, v35
 v_cmp_le_i32 s[66:67], 1, v35
 v_cmp_le_i32 s[68:69], 2, v35
 v_cmp_le_i32 s[70:71], 3, v35
 s_mov_b32 s25, 163840
 s_cmp_lg_u32 s45, 0
 s_cselect_b32 s26, 6, 10
 s_cselect_b32 s40, 6, 99
 s_cselect_b32 s25, 4294148096, s25
 s_lshl_b32 s43, s42, 2
 s_add_u32 s43, s43, s20
 s_mul_i32 s43, s43, 12288
 s_lshr_b32 s21, s42, 2
 s_lshl_b32 s21, s21, 14
 s_and_b32 s44, s42, 3
 s_lshl_b32 s44, s44, 11
 s_add_u32 s44, s44, s21
 s_add_u32 s44, s44, 655360
 s_lshr_b32 s36, s42, 1
 s_lshl_b32 s36, s36, 14
 s_and_b32 s21, s42, 1
 s_mul_i32 s21, s21, 3072
 s_add_u32 s36, s36, s21
 s_add_u32 s36, s36, 655360
 s_lshl_b32 s49, s41, 2
 s_add_u32 s49, s49, s20
 s_mov_b32 s29, 4
 s_mov_b32 s78, 0
 s_mov_b32 s81, 0x80000000
 s_mov_b32 s82, 0
 s_mul_i32 s21, s49, 393216
 s_mul_i32 s22, s42, 12288
 s_add_u32 s50, s21, s22
 s_lshr_b32 s21, s49, 1
 s_bitcmp1_b32 s37, s21
 s_cselect_b32 s21, 8192, 0
 s_lshl_b32 s51, s49, 20
 s_or_b32 s51, s51, s21
 s_xor_b32 s51, s51, 8192
 s_add_u32 s51, s51, s36
 s_lshr_b32 s22, s49, 1
 s_lshr_b32 s21, s49, 2
 s_add_u32 s21, s21, 3
 s_cmp_lt_u32 s49, 12
 s_cselect_b32 s21, s22, s21
 s_lshl_b32 s21, s21, 3
 s_lshr_b32 s22, s42, 2
 s_add_u32 s21, s21, s22
 s_lshl_b32 s21, s21, 7
 s_add_u32 s76, s21, 0
 s_lshl_b32 s77, s42, 7
 s_add_u32 s77, s77, 19456
 v_mov_b32 v21, 0
 buffer_load_dword v21, v33, s[72:75], s77 offen sc1
 v_and_b32 v6, 7, v2
 v_add_u32 v4, 0, v3
 v_xor_b32 v4, v4, v6
 v_lshlrev_b32 v4, 4, v4
 v_lshl_add_u32 v14, v2, 7, v4
 v_add_u32 v4, 4, v3
 v_xor_b32 v4, v4, v6
 v_lshlrev_b32 v4, 4, v4
 v_lshl_add_u32 v15, v2, 7, v4
 v_mul_u32_u24 v22, 400, v2
 v_mul_u32_u24 v4, 16, v3
 s_mul_i32 s21, s20, 96
 s_add_u32 s21, s21, 98304
 v_add3_u32 v22, v22, v4, s21
 v_lshlrev_b32 v4, 3, v3
 v_sub_u32 v16, v22, v4
 v_mov_b32 v9, 2731
 s_mov_b32 s33, 0
 s_mov_b32 s48, 0x80000000
 s_mov_b32 m0, s32
 s_nop 0
 buffer_load_dwordx4 v10, s[8:11], s30 offen offset:0 lds
 buffer_load_dwordx4 v11, s[8:11], s30 offen offset:1024 lds
 s_waitcnt vmcnt(14)
 s_barrier
 v_add_u32 v18, s33, v14
 v_add_u32 v19, s33, v15
 s_add_u32 s33, s33, 16384
 s_cmp_lt_u32 s33, 98304
 s_cselect_b32 s33, s33, 0
 ds_read_b128 v[160:163], v18 offset:0
 ds_read_b128 v[164:167], v18 offset:2048
 ds_read_b128 v[168:171], v18 offset:4096
 ds_read_b128 v[172:175], v18 offset:6144
 ds_read_b128 v[176:179], v18 offset:8192
 ds_read_b128 v[180:183], v18 offset:10240
 ds_read_b128 v[184:187], v18 offset:12288
 ds_read_b128 v[188:191], v18 offset:14336
 s_waitcnt lgkmcnt(0)
qa_blk_204:
 v_mfma_f32_16x16x32_bf16 v[64:67], a[0:3], v[160:163], 0
 ds_read_b128 v[192:195], v19 offset:0
 v_mfma_f32_16x16x32_bf16 v[68:71], a[4:7], v[160:163], 0
 v_add_u32 v18, s33, v14
 v_cndmask_b32 v36, v34, v36, s[64:65]
 v_mfma_f32_16x16x32_bf16 v[72:75], a[8:11], v[160:163], 0
 v_cndmask_b32 v48, v34, v48, s[64:65]
 v_cndmask_b32 v37, v34, v37, s[66:67]
 v_mfma_f32_16x16x32_bf16 v[76:79], a[0:3], v[164:167], 0
 ds_read_b128 v[196:199], v19 offset:2048
 v_cndmask_b32 v49, v34, v49, s[66:67]
 v_mfma_f32_16x16x32_bf16 v[80:83], a[4:7], v[164:167], 0
 buffer_load_dwordx4 v12, s[8:11], s30 offen offset:2048 lds
 v_mfma_f32_16x16x32_bf16 v[84:87], a[8:11], v[164:167], 0
 v_cndmask_b32 v38, v34, v38, s[68:69]
 v_cndmask_b32 v50, v34, v50, s[68:69]
 v_mfma_f32_16x16x32_bf16 v[88:91], a[0:3], v[168:171], 0
 ds_read_b128 v[200:203], v19 offset:4096
 v_cndmask_b32 v39, v34, v39, s[70:71]
 v_mfma_f32_16x16x32_bf16 v[92:95], a[4:7], v[168:171], 0
 v_cndmask_b32 v51, v34, v51, s[70:71]
 v_max3_f32 v56, v36, v37, v38
 v_mfma_f32_16x16x32_bf16 v[96:99], a[8:11], v[168:171], 0
 v_max3_f32 v56, v56, v39, v40
 v_max3_f32 v56, v56, v41, v42
 v_mfma_f32_16x16x32_bf16 v[100:103], a[0:3], v[172:175], 0
 ds_read_b128 v[204:207], v19 offset:6144
 v_max_f32 v56, v56, v43
 v_mfma_f32_16x16x32_bf16 v[104:107], a[4:7], v[172:175], 0
 v_mov_b32 v57, v56
 v_mfma_f32_16x16x32_bf16 v[108:111], a[8:11], v[172:175], 0
 s_waitcnt lgkmcnt(15)
 v_mfma_f32_16x16x32_bf16 v[112:115], a[0:3], v[176:179], 0
 ds_read_b128 v[208:211], v19 offset:8192
 v_mfma_f32_16x16x32_bf16 v[116:119], a[4:7], v[176:179], 0
 s_nop 1
 v_mfma_f32_16x16x32_bf16 v[120:123], a[8:11], v[176:179], 0
 v_permlane32_swap_b32 v56, v57
 v_mfma_f32_16x16x32_bf16 v[124:127], a[0:3], v[180:183], 0
 ds_read_b128 v[212:215], v19 offset:10240
 v_max_f32 v56, v56, v57
 v_mfma_f32_16x16x32_bf16 v[128:131], a[4:7], v[180:183], 0
 buffer_load_dwordx4 v13, s[8:11], s30 offen offset:3072 lds
 v_mfma_f32_16x16x32_bf16 v[132:135], a[8:11], v[180:183], 0
 s_add_u32 s30, s30, 128
 s_add_u32 m0, m0, 16384
 v_mfma_f32_16x16x32_bf16 v[136:139], a[0:3], v[184:187], 0
 ds_read_b128 v[216:219], v19 offset:12288
 v_mov_b32 v57, v56
 v_mfma_f32_16x16x32_bf16 v[140:143], a[4:7], v[184:187], 0
 s_cmp_lt_u32 m0, s46
 s_cselect_b32 m0, m0, s47
 v_mfma_f32_16x16x32_bf16 v[144:147], a[8:11], v[184:187], 0
 s_nop 1
 v_mfma_f32_16x16x32_bf16 v[148:151], a[0:3], v[188:191], 0
 ds_read_b128 v[220:223], v19 offset:14336
 v_mfma_f32_16x16x32_bf16 v[152:155], a[4:7], v[188:191], 0
 v_permlane16_swap_b32 v56, v57
 v_mfma_f32_16x16x32_bf16 v[156:159], a[8:11], v[188:191], 0
 s_waitcnt vmcnt(12) lgkmcnt(4)
 s_barrier
 v_mfma_f32_16x16x32_bf16 v[64:67], a[12:15], v[192:195], v[64:67]
 ds_read_b128 v[160:163], v18 offset:0
 v_max_f32 v56, v56, v57
 v_mfma_f32_16x16x32_bf16 v[68:71], a[16:19], v[192:195], v[68:71]
 v_mul_f32 v56, s83, v56
 v_fma_f32 v36, v36, s83, -v56
 v_mfma_f32_16x16x32_bf16 v[72:75], a[20:23], v[192:195], v[72:75]
 v_add_u32 v19, s33, v15
 s_add_u32 s33, s33, 16384
 v_mfma_f32_16x16x32_bf16 v[76:79], a[12:15], v[196:199], v[76:79]
 ds_read_b128 v[164:167], v18 offset:2048
 s_mul_i32 s21, s49, 393216
 v_mfma_f32_16x16x32_bf16 v[80:83], a[16:19], v[196:199], v[80:83]
 buffer_load_dwordx4 v10, s[8:11], s30 offen offset:0 lds
 v_mfma_f32_16x16x32_bf16 v[84:87], a[20:23], v[196:199], v[84:87]
 s_cmp_lt_u32 s33, 98304
 s_cselect_b32 s33, s33, 0
 v_mfma_f32_16x16x32_bf16 v[88:91], a[12:15], v[200:203], v[88:91]
 ds_read_b128 v[168:171], v18 offset:4096
 s_mul_i32 s22, s42, 12288
 v_mfma_f32_16x16x32_bf16 v[92:95], a[16:19], v[200:203], v[92:95]
 s_add_u32 s50, s21, s22
 s_lshr_b32 s21, s49, 1
 v_mfma_f32_16x16x32_bf16 v[96:99], a[20:23], v[200:203], v[96:99]
 s_bitcmp1_b32 s37, s21
 s_cselect_b32 s21, 8192, 0
 v_mfma_f32_16x16x32_bf16 v[100:103], a[12:15], v[204:207], v[100:103]
 ds_read_b128 v[172:175], v18 offset:6144
 s_lshl_b32 s51, s49, 20
 v_mfma_f32_16x16x32_bf16 v[104:107], a[16:19], v[204:207], v[104:107]
 s_or_b32 s51, s51, s21
 s_xor_b32 s51, s51, 8192
 v_mfma_f32_16x16x32_bf16 v[108:111], a[20:23], v[204:207], v[108:111]
 s_waitcnt lgkmcnt(4)
 s_add_u32 s51, s51, s36
 v_mfma_f32_16x16x32_bf16 v[112:115], a[12:15], v[208:211], v[112:115]
 ds_read_b128 v[176:179], v18 offset:8192
 s_add_u32 s23, s49, 1
 v_mfma_f32_16x16x32_bf16 v[116:119], a[16:19], v[208:211], v[116:119]
 v_cmp_gt_u32 vcc, s23, v21
 v_fma_f32 v37, v37, s83, -v56
 v_mfma_f32_16x16x32_bf16 v[120:123], a[20:23], v[208:211], v[120:123]
 s_cmp_eq_u64 vcc, 0
 s_cselect_b32 s80, 1, 0
 s_cselect_b32 s51, s51, 0x80000000
 v_mfma_f32_16x16x32_bf16 v[124:127], a[12:15], v[212:215], v[124:127]
 ds_read_b128 v[180:183], v18 offset:10240
 s_lshl_b32 s79, s80, 3
 v_mfma_f32_16x16x32_bf16 v[128:131], a[16:19], v[212:215], v[128:131]
 buffer_load_dwordx4 v11, s[8:11], s30 offen offset:1024 lds
 v_mfma_f32_16x16x32_bf16 v[132:135], a[20:23], v[212:215], v[132:135]
 s_or_b32 s79, s79, s45
 v_fma_f32 v38, v38, s83, -v56
 v_mfma_f32_16x16x32_bf16 v[136:139], a[12:15], v[216:219], v[136:139]
 ds_read_b128 v[184:187], v18 offset:12288
 v_fma_f32 v39, v39, s83, -v56
 v_mfma_f32_16x16x32_bf16 v[140:143], a[16:19], v[216:219], v[140:143]
 buffer_load_dwordx4 a[240:243], v31, s[52:55], s51 offen offset:0 sc1
 v_mfma_f32_16x16x32_bf16 v[144:147], a[20:23], v[216:219], v[144:147]
 v_fma_f32 v40, v40, s83, -v56
 v_fma_f32 v41, v41, s83, -v56
 v_mfma_f32_16x16x32_bf16 v[148:151], a[12:15], v[220:223], v[148:151]
 ds_read_b128 v[188:191], v18 offset:14336
 v_fma_f32 v42, v42, s83, -v56
 v_mfma_f32_16x16x32_bf16 v[152:155], a[16:19], v[220:223], v[152:155]
 v_fma_f32 v43, v43, s83, -v56
 v_mfma_f32_16x16x32_bf16 v[156:159], a[20:23], v[220:223], v[156:159]
 s_waitcnt lgkmcnt(4)
 v_mfma_f32_16x16x32_bf16 v[64:67], a[24:27], v[160:163], v[64:67]
 ds_read_b128 v[192:195], v19 offset:0
 v_mfma_f32_16x16x32_bf16 v[68:71], a[28:31], v[160:163], v[68:71]
 v_add_u32 v18, s33, v14
 v_mfma_f32_16x16x32_bf16 v[72:75], a[32:35], v[160:163], v[72:75]
 v_exp_f32 v36, v36
 v_mfma_f32_16x16x32_bf16 v[76:79], a[24:27], v[164:167], v[76:79]
 ds_read_b128 v[196:199], v19 offset:2048
 v_mfma_f32_16x16x32_bf16 v[80:83], a[28:31], v[164:167], v[80:83]
 buffer_load_dwordx4 v12, s[8:11], s30 offen offset:2048 lds
 v_mfma_f32_16x16x32_bf16 v[84:87], a[32:35], v[164:167], v[84:87]
 v_exp_f32 v37, v37
 v_mfma_f32_16x16x32_bf16 v[88:91], a[24:27], v[168:171], v[88:91]
 ds_read_b128 v[200:203], v19 offset:4096
 v_mfma_f32_16x16x32_bf16 v[92:95], a[28:31], v[168:171], v[92:95]
 v_exp_f32 v38, v38
 v_mfma_f32_16x16x32_bf16 v[96:99], a[32:35], v[168:171], v[96:99]
 v_exp_f32 v39, v39
 v_mfma_f32_16x16x32_bf16 v[100:103], a[24:27], v[172:175], v[100:103]
 ds_read_b128 v[204:207], v19 offset:6144
 v_mfma_f32_16x16x32_bf16 v[104:107], a[28:31], v[172:175], v[104:107]
 v_exp_f32 v40, v40
 v_mfma_f32_16x16x32_bf16 v[108:111], a[32:35], v[172:175], v[108:111]
 s_waitcnt lgkmcnt(4)
 v_mfma_f32_16x16x32_bf16 v[112:115], a[24:27], v[176:179], v[112:115]
 ds_read_b128 v[208:211], v19 offset:8192
 v_mfma_f32_16x16x32_bf16 v[116:119], a[28:31], v[176:179], v[116:119]
 v_exp_f32 v41, v41
 v_mfma_f32_16x16x32_bf16 v[120:123], a[32:35], v[176:179], v[120:123]
 v_exp_f32 v42, v42
 v_mfma_f32_16x16x32_bf16 v[124:127], a[24:27], v[180:183], v[124:127]
 ds_read_b128 v[212:215], v19 offset:10240
 v_mfma_f32_16x16x32_bf16 v[128:131], a[28:31], v[180:183], v[128:131]
 buffer_load_dwordx4 v13, s[8:11], s30 offen offset:3072 lds
 v_mfma_f32_16x16x32_bf16 v[132:135], a[32:35], v[180:183], v[132:135]
 s_add_u32 s30, s30, 128
 s_add_u32 m0, m0, 16384
 v_mfma_f32_16x16x32_bf16 v[136:139], a[24:27], v[184:187], v[136:139]
 ds_read_b128 v[216:219], v19 offset:12288
 v_mfma_f32_16x16x32_bf16 v[140:143], a[28:31], v[184:187], v[140:143]
 s_cmp_lt_u32 m0, s46
 s_cselect_b32 m0, m0, s47
 v_mfma_f32_16x16x32_bf16 v[144:147], a[32:35], v[184:187], v[144:147]
 buffer_load_dwordx4 a[244:247], v31, s[52:55], s51 offen offset:512 sc1
 v_mfma_f32_16x16x32_bf16 v[148:151], a[24:27], v[188:191], v[148:151]
 ds_read_b128 v[220:223], v19 offset:14336
 v_mfma_f32_16x16x32_bf16 v[152:155], a[28:31], v[188:191], v[152:155]
 v_exp_f32 v43, v43
 v_mfma_f32_16x16x32_bf16 v[156:159], a[32:35], v[188:191], v[156:159]
 s_waitcnt vmcnt(14) lgkmcnt(4)
 s_barrier
 v_mfma_f32_16x16x32_bf16 v[64:67], a[36:39], v[192:195], v[64:67]
 ds_read_b128 v[160:163], v18 offset:0
 s_nop 0
 v_mfma_f32_16x16x32_bf16 v[68:71], a[40:43], v[192:195], v[68:71]
 v_add_f32 v56, v40, v41
 v_add_f32 v56, v56, v42
 v_mfma_f32_16x16x32_bf16 v[72:75], a[44:47], v[192:195], v[72:75]
 v_add_u32 v19, s33, v15
 s_add_u32 s33, s33, 16384
 v_mfma_f32_16x16x32_bf16 v[76:79], a[36:39], v[196:199], v[76:79]
 ds_read_b128 v[164:167], v18 offset:2048
 v_add_f32 v56, v56, v43
 v_mfma_f32_16x16x32_bf16 v[80:83], a[40:43], v[196:199], v[80:83]
 buffer_load_dwordx4 v10, s[8:11], s30 offen offset:0 lds
 v_mfma_f32_16x16x32_bf16 v[84:87], a[44:47], v[196:199], v[84:87]
 s_cmp_lt_u32 s33, 98304
 s_cselect_b32 s33, s33, 0
 v_mfma_f32_16x16x32_bf16 v[88:91], a[36:39], v[200:203], v[88:91]
 ds_read_b128 v[168:171], v18 offset:4096
 v_cndmask_b32 v56, 0, v56, s[60:61]
 v_mfma_f32_16x16x32_bf16 v[92:95], a[40:43], v[200:203], v[92:95]
 v_add_f32 v56, v56, v36
 v_add_f32 v56, v56, v37
 v_mfma_f32_16x16x32_bf16 v[96:99], a[44:47], v[200:203], v[96:99]
 v_add_f32 v56, v56, v38
 v_add_f32 v56, v56, v39
 v_mfma_f32_16x16x32_bf16 v[100:103], a[36:39], v[204:207], v[100:103]
 ds_read_b128 v[172:175], v18 offset:6144
 v_mov_b32 v57, v56
 v_mfma_f32_16x16x32_bf16 v[104:107], a[40:43], v[204:207], v[104:107]
 s_nop 1
 v_mfma_f32_16x16x32_bf16 v[108:111], a[44:47], v[204:207], v[108:111]
 s_waitcnt lgkmcnt(4)
 v_mfma_f32_16x16x32_bf16 v[112:115], a[36:39], v[208:211], v[112:115]
 ds_read_b128 v[176:179], v18 offset:8192
 v_mfma_f32_16x16x32_bf16 v[116:119], a[40:43], v[208:211], v[116:119]
 v_permlane32_swap_b32 v56, v57
 v_mfma_f32_16x16x32_bf16 v[120:123], a[44:47], v[208:211], v[120:123]
 v_add_f32 v56, v56, v57
 v_mov_b32 v57, v56
 v_mfma_f32_16x16x32_bf16 v[124:127], a[36:39], v[212:215], v[124:127]
 ds_read_b128 v[180:183], v18 offset:10240
 v_mfma_f32_16x16x32_bf16 v[128:131], a[40:43], v[212:215], v[128:131]
 buffer_load_dwordx4 v11, s[8:11], s30 offen offset:1024 lds
 v_mfma_f32_16x16x32_bf16 v[132:135], a[44:47], v[212:215], v[132:135]
 buffer_load_dwordx4 a[248:251], v31, s[52:55], s51 offen offset:1024 sc1
 v_mfma_f32_16x16x32_bf16 v[136:139], a[36:39], v[216:219], v[136:139]
 ds_read_b128 v[184:187], v18 offset:12288
 v_mfma_f32_16x16x32_bf16 v[140:143], a[40:43], v[216:219], v[140:143]
 s_nop 1
 v_mfma_f32_16x16x32_bf16 v[144:147], a[44:47], v[216:219], v[144:147]
 v_permlane16_swap_b32 v56, v57
 v_mfma_f32_16x16x32_bf16 v[148:151], a[36:39], v[220:223], v[148:151]
 ds_read_b128 v[188:191], v18 offset:14336
 v_add_f32 v56, v56, v57
 v_mfma_f32_16x16x32_bf16 v[152:155], a[40:43], v[220:223], v[152:155]
 v_rcp_f32 v56, v56
 v_mfma_f32_16x16x32_bf16 v[156:159], a[44:47], v[220:223], v[156:159]
 s_waitcnt lgkmcnt(4)
 s_nop 0
 v_mfma_f32_16x16x32_bf16 v[64:67], a[48:51], v[160:163], v[64:67]
 ds_read_b128 v[192:195], v19 offset:0
 v_mul_f32 v36, v36, v56
 v_mfma_f32_16x16x32_bf16 v[68:71], a[52:55], v[160:163], v[68:71]
 v_add_u32 v18, s33, v14
 v_mul_f32 v37, v37, v56
 v_mfma_f32_16x16x32_bf16 v[72:75], a[56:59], v[160:163], v[72:75]
 v_mul_f32 v38, v38, v56
 v_mul_f32 v39, v39, v56
 v_mfma_f32_16x16x32_bf16 v[76:79], a[48:51], v[164:167], v[76:79]
 ds_read_b128 v[196:199], v19 offset:2048
 v_mul_f32 v40, v40, v56
 v_mfma_f32_16x16x32_bf16 v[80:83], a[52:55], v[164:167], v[80:83]
 buffer_load_dwordx4 v12, s[8:11], s30 offen offset:2048 lds
 v_mfma_f32_16x16x32_bf16 v[84:87], a[56:59], v[164:167], v[84:87]
 v_mul_f32 v41, v41, v56
 v_mul_f32 v42, v42, v56
 v_mfma_f32_16x16x32_bf16 v[88:91], a[48:51], v[168:171], v[88:91]
 ds_read_b128 v[200:203], v19 offset:4096
 v_mul_f32 v43, v43, v56
 v_mfma_f32_16x16x32_bf16 v[92:95], a[52:55], v[168:171], v[92:95]
 v_max3_f32 v56, v44, v45, v46
 v_max3_f32 v56, v56, v47, v48
 v_mfma_f32_16x16x32_bf16 v[96:99], a[56:59], v[168:171], v[96:99]
 v_max3_f32 v56, v56, v49, v50
 v_max3_f32 v56, v56, v51, v52
 v_mfma_f32_16x16x32_bf16 v[100:103], a[48:51], v[172:175], v[100:103]
 ds_read_b128 v[204:207], v19 offset:6144
 v_max3_f32 v56, v56, v53, v54
 v_mfma_f32_16x16x32_bf16 v[104:107], a[52:55], v[172:175], v[104:107]
 v_max_f32 v56, v56, v55
 v_mov_b32 v57, v56
 v_mfma_f32_16x16x32_bf16 v[108:111], a[56:59], v[172:175], v[108:111]
 s_waitcnt lgkmcnt(4)
 v_mfma_f32_16x16x32_bf16 v[112:115], a[48:51], v[176:179], v[112:115]
 ds_read_b128 v[208:211], v19 offset:8192
 v_mfma_f32_16x16x32_bf16 v[116:119], a[52:55], v[176:179], v[116:119]
 buffer_load_dwordx4 a[252:255], v31, s[52:55], s51 offen offset:1536 sc1
 v_mfma_f32_16x16x32_bf16 v[120:123], a[56:59], v[176:179], v[120:123]
 s_nop 1
 v_mfma_f32_16x16x32_bf16 v[124:127], a[48:51], v[180:183], v[124:127]
 ds_read_b128 v[212:215], v19 offset:10240
 v_mfma_f32_16x16x32_bf16 v[128:131], a[52:55], v[180:183], v[128:131]
 buffer_load_dwordx4 v13, s[8:11], s30 offen offset:3072 lds
 v_mfma_f32_16x16x32_bf16 v[132:135], a[56:59], v[180:183], v[132:135]
 s_add_u32 s30, s30, 128
 s_add_u32 m0, m0, 16384
 v_mfma_f32_16x16x32_bf16 v[136:139], a[48:51], v[184:187], v[136:139]
 ds_read_b128 v[216:219], v19 offset:12288
 v_mfma_f32_16x16x32_bf16 v[140:143], a[52:55], v[184:187], v[140:143]
 s_cmp_lt_u32 m0, s46
 s_cselect_b32 m0, m0, s47
 v_mfma_f32_16x16x32_bf16 v[144:147], a[56:59], v[184:187], v[144:147]
 v_permlane32_swap_b32 v56, v57
 v_mfma_f32_16x16x32_bf16 v[148:151], a[48:51], v[188:191], v[148:151]
 ds_read_b128 v[220:223], v19 offset:14336
 v_max_f32 v56, v56, v57
 v_mfma_f32_16x16x32_bf16 v[152:155], a[52:55], v[188:191], v[152:155]
 v_mov_b32 v57, v56
 v_mfma_f32_16x16x32_bf16 v[156:159], a[56:59], v[188:191], v[156:159]
 s_waitcnt vmcnt(16) lgkmcnt(4)
 s_barrier
 v_mfma_f32_16x16x32_bf16 v[64:67], a[60:63], v[192:195], v[64:67]
 ds_read_b128 v[160:163], v18 offset:0
 v_mfma_f32_16x16x32_bf16 v[68:71], a[64:67], v[192:195], v[68:71]
 s_nop 1
 v_mfma_f32_16x16x32_bf16 v[72:75], a[68:71], v[192:195], v[72:75]
 v_add_u32 v19, s33, v15
 s_add_u32 s33, s33, 16384
 v_mfma_f32_16x16x32_bf16 v[76:79], a[60:63], v[196:199], v[76:79]
 ds_read_b128 v[164:167], v18 offset:2048
 v_mfma_f32_16x16x32_bf16 v[80:83], a[64:67], v[196:199], v[80:83]
 buffer_load_dwordx4 v10, s[8:11], s30 offen offset:0 lds
 v_mfma_f32_16x16x32_bf16 v[84:87], a[68:71], v[196:199], v[84:87]
 s_cmp_lt_u32 s33, 98304
 s_cselect_b32 s33, s33, 0
 v_mfma_f32_16x16x32_bf16 v[88:91], a[60:63], v[200:203], v[88:91]
 ds_read_b128 v[168:171], v18 offset:4096
 v_mfma_f32_16x16x32_bf16 v[92:95], a[64:67], v[200:203], v[92:95]
 v_permlane16_swap_b32 v56, v57
 v_mfma_f32_16x16x32_bf16 v[96:99], a[68:71], v[200:203], v[96:99]
 v_max_f32 v56, v56, v57
 v_mul_f32 v56, s83, v56
 v_mfma_f32_16x16x32_bf16 v[100:103], a[60:63], v[204:207], v[100:103]
 ds_read_b128 v[172:175], v18 offset:6144
 v_fma_f32 v44, v44, s83, -v56
 v_mfma_f32_16x16x32_bf16 v[104:107], a[64:67], v[204:207], v[104:107]
 buffer_load_dwordx4 v[24:27], v31, s[52:55], s51 offen offset:2048 sc1
 v_mfma_f32_16x16x32_bf16 v[108:111], a[68:71], v[204:207], v[108:111]
 s_waitcnt lgkmcnt(4)
 v_fma_f32 v45, v45, s83, -v56
 v_mfma_f32_16x16x32_bf16 v[112:115], a[60:63], v[208:211], v[112:115]
 ds_read_b128 v[176:179], v18 offset:8192
 v_fma_f32 v46, v46, s83, -v56
 v_mfma_f32_16x16x32_bf16 v[116:119], a[64:67], v[208:211], v[116:119]
 v_fma_f32 v47, v47, s83, -v56
 v_fma_f32 v48, v48, s83, -v56
 v_mfma_f32_16x16x32_bf16 v[120:123], a[68:71], v[208:211], v[120:123]
 v_fma_f32 v49, v49, s83, -v56
 v_fma_f32 v50, v50, s83, -v56
 v_mfma_f32_16x16x32_bf16 v[124:127], a[60:63], v[212:215], v[124:127]
 ds_read_b128 v[180:183], v18 offset:10240
 v_fma_f32 v51, v51, s83, -v56
 v_mfma_f32_16x16x32_bf16 v[128:131], a[64:67], v[212:215], v[128:131]
 buffer_load_dwordx4 v11, s[8:11], s30 offen offset:1024 lds
 v_mfma_f32_16x16x32_bf16 v[132:135], a[68:71], v[212:215], v[132:135]
 v_fma_f32 v52, v52, s83, -v56
 v_fma_f32 v53, v53, s83, -v56
 v_mfma_f32_16x16x32_bf16 v[136:139], a[60:63], v[216:219], v[136:139]
 ds_read_b128 v[184:187], v18 offset:12288
 v_fma_f32 v54, v54, s83, -v56
 v_mfma_f32_16x16x32_bf16 v[140:143], a[64:67], v[216:219], v[140:143]
 v_fma_f32 v55, v55, s83, -v56
 v_mfma_f32_16x16x32_bf16 v[144:147], a[68:71], v[216:219], v[144:147]
 v_exp_f32 v44, v44
 v_mfma_f32_16x16x32_bf16 v[148:151], a[60:63], v[220:223], v[148:151]
 ds_read_b128 v[188:191], v18 offset:14336
 v_mfma_f32_16x16x32_bf16 v[152:155], a[64:67], v[220:223], v[152:155]
 v_exp_f32 v45, v45
 v_mfma_f32_16x16x32_bf16 v[156:159], a[68:71], v[220:223], v[156:159]
 s_waitcnt lgkmcnt(4)
 v_mfma_f32_16x16x32_bf16 v[64:67], a[72:75], v[160:163], v[64:67]
 ds_read_b128 v[192:195], v19 offset:0
 v_mfma_f32_16x16x32_bf16 v[68:71], a[76:79], v[160:163], v[68:71]
 v_add_u32 v18, s33, v14
 v_mfma_f32_16x16x32_bf16 v[72:75], a[80:83], v[160:163], v[72:75]
 v_exp_f32 v46, v46
 v_mfma_f32_16x16x32_bf16 v[76:79], a[72:75], v[164:167], v[76:79]
 ds_read_b128 v[196:199], v19 offset:2048
 v_mfma_f32_16x16x32_bf16 v[80:83], a[76:79], v[164:167], v[80:83]
 buffer_load_dwordx4 v12, s[8:11], s30 offen offset:2048 lds
 v_mfma_f32_16x16x32_bf16 v[84:87], a[80:83], v[164:167], v[84:87]
 v_exp_f32 v47, v47
 v_mfma_f32_16x16x32_bf16 v[88:91], a[72:75], v[168:171], v[88:91]
 ds_read_b128 v[200:203], v19 offset:4096
 v_mfma_f32_16x16x32_bf16 v[92:95], a[76:79], v[168:171], v[92:95]
 buffer_load_dwordx4 v[6:9], v31, s[52:55], s51 offen offset:2560 sc1
 v_mfma_f32_16x16x32_bf16 v[96:99], a[80:83], v[168:171], v[96:99]
 v_exp_f32 v48, v48
 v_mfma_f32_16x16x32_bf16 v[100:103], a[72:75], v[172:175], v[100:103]
 ds_read_b128 v[204:207], v19 offset:6144
 v_mfma_f32_16x16x32_bf16 v[104:107], a[76:79], v[172:175], v[104:107]
 v_exp_f32 v49, v49
 v_mfma_f32_16x16x32_bf16 v[108:111], a[80:83], v[172:175], v[108:111]
 s_waitcnt lgkmcnt(4)
 v_mfma_f32_16x16x32_bf16 v[112:115], a[72:75], v[176:179], v[112:115]
 ds_read_b128 v[208:211], v19 offset:8192
 v_mfma_f32_16x16x32_bf16 v[116:119], a[76:79], v[176:179], v[116:119]
 v_exp_f32 v50, v50
 v_mfma_f32_16x16x32_bf16 v[120:123], a[80:83], v[176:179], v[120:123]
 v_exp_f32 v51, v51
 v_mfma_f32_16x16x32_bf16 v[124:127], a[72:75], v[180:183], v[124:127]
 ds_read_b128 v[212:215], v19 offset:10240
 v_mfma_f32_16x16x32_bf16 v[128:131], a[76:79], v[180:183], v[128:131]
 buffer_load_dwordx4 v13, s[8:11], s30 offen offset:3072 lds
 v_mfma_f32_16x16x32_bf16 v[132:135], a[80:83], v[180:183], v[132:135]
 s_add_u32 s30, s30, 128
 s_add_u32 m0, m0, 16384
 v_mfma_f32_16x16x32_bf16 v[136:139], a[72:75], v[184:187], v[136:139]
 ds_read_b128 v[216:219], v19 offset:12288
 v_mfma_f32_16x16x32_bf16 v[140:143], a[76:79], v[184:187], v[140:143]
 s_cmp_lt_u32 m0, s46
 s_cselect_b32 m0, m0, s47
 v_mfma_f32_16x16x32_bf16 v[144:147], a[80:83], v[184:187], v[144:147]
 v_exp_f32 v52, v52
 v_mfma_f32_16x16x32_bf16 v[148:151], a[72:75], v[188:191], v[148:151]
 ds_read_b128 v[220:223], v19 offset:14336
 v_mfma_f32_16x16x32_bf16 v[152:155], a[76:79], v[188:191], v[152:155]
 v_exp_f32 v53, v53
 v_mfma_f32_16x16x32_bf16 v[156:159], a[80:83], v[188:191], v[156:159]
 s_waitcnt vmcnt(18) lgkmcnt(4)
 s_barrier
 v_mfma_f32_16x16x32_bf16 v[64:67], a[84:87], v[192:195], v[64:67]
 ds_read_b128 v[160:163], v18 offset:0
 v_mfma_f32_16x16x32_bf16 v[68:71], a[88:91], v[192:195], v[68:71]
 v_exp_f32 v54, v54
 v_mfma_f32_16x16x32_bf16 v[72:75], a[92:95], v[192:195], v[72:75]
 v_add_u32 v19, s33, v15
 s_add_u32 s33, s33, 16384
 v_mfma_f32_16x16x32_bf16 v[76:79], a[84:87], v[196:199], v[76:79]
 ds_read_b128 v[164:167], v18 offset:2048
 s_add_u32 s21, s50, 4096
 v_mfma_f32_16x16x32_bf16 v[80:83], a[88:91], v[196:199], v[80:83]
 buffer_load_dwordx4 v10, s[8:11], s30 offen offset:0 lds
 v_mfma_f32_16x16x32_bf16 v[84:87], a[92:95], v[196:199], v[84:87]
 s_cmp_lt_u32 s33, 98304
 s_cselect_b32 s33, s33, 0
 v_mfma_f32_16x16x32_bf16 v[88:91], a[84:87], v[200:203], v[88:91]
 ds_read_b128 v[168:171], v18 offset:4096
 v_mfma_f32_16x16x32_bf16 v[92:95], a[88:91], v[200:203], v[92:95]
 buffer_load_dwordx4 v[60:63], v30, s[16:19], s21 offen offset:2048 sc1
 v_mfma_f32_16x16x32_bf16 v[96:99], a[92:95], v[200:203], v[96:99]
 v_exp_f32 v55, v55
 v_mfma_f32_16x16x32_bf16 v[100:103], a[84:87], v[204:207], v[100:103]
 ds_read_b128 v[172:175], v18 offset:6144
 s_nop 0
 v_mfma_f32_16x16x32_bf16 v[104:107], a[88:91], v[204:207], v[104:107]
 v_add_f32 v56, v52, v53
 v_add_f32 v56, v56, v54
 v_mfma_f32_16x16x32_bf16 v[108:111], a[92:95], v[204:207], v[108:111]
 s_waitcnt lgkmcnt(4)
 v_add_f32 v56, v56, v55
 v_mfma_f32_16x16x32_bf16 v[112:115], a[84:87], v[208:211], v[112:115]
 ds_read_b128 v[176:179], v18 offset:8192
 v_cndmask_b32 v56, 0, v56, s[60:61]
 v_mfma_f32_16x16x32_bf16 v[116:119], a[88:91], v[208:211], v[116:119]
 v_add_f32 v56, v56, v44
 v_add_f32 v56, v56, v45
 v_mfma_f32_16x16x32_bf16 v[120:123], a[92:95], v[208:211], v[120:123]
 v_add_f32 v56, v56, v46
 v_add_f32 v56, v56, v47
 v_mfma_f32_16x16x32_bf16 v[124:127], a[84:87], v[212:215], v[124:127]
 ds_read_b128 v[180:183], v18 offset:10240
 v_add_f32 v56, v56, v48
 v_mfma_f32_16x16x32_bf16 v[128:131], a[88:91], v[212:215], v[128:131]
 buffer_load_dwordx4 v11, s[8:11], s30 offen offset:1024 lds
 v_mfma_f32_16x16x32_bf16 v[132:135], a[92:95], v[212:215], v[132:135]
 v_add_f32 v56, v56, v49
 v_add_f32 v56, v56, v50
 v_mfma_f32_16x16x32_bf16 v[136:139], a[84:87], v[216:219], v[136:139]
 ds_read_b128 v[184:187], v18 offset:12288
 v_add_f32 v56, v56, v51
 v_mfma_f32_16x16x32_bf16 v[140:143], a[88:91], v[216:219], v[140:143]
 v_mov_b32 v57, v56
 v_mfma_f32_16x16x32_bf16 v[144:147], a[92:95], v[216:219], v[144:147]
 s_nop 1
 v_mfma_f32_16x16x32_bf16 v[148:151], a[84:87], v[220:223], v[148:151]
 ds_read_b128 v[188:191], v18 offset:14336
 v_mfma_f32_16x16x32_bf16 v[152:155], a[88:91], v[220:223], v[152:155]
 v_permlane32_swap_b32 v56, v57
 v_mfma_f32_16x16x32_bf16 v[156:159], a[92:95], v[220:223], v[156:159]
 s_waitcnt lgkmcnt(4)
 v_add_f32 v56, v56, v57
 v_mfma_f32_16x16x32_bf16 v[64:67], a[96:99], v[160:163], v[64:67]
 ds_read_b128 v[192:195], v19 offset:0
 v_mov_b32 v57, v56
 v_mfma_f32_16x16x32_bf16 v[68:71], a[100:103], v[160:163], v[68:71]
 v_add_u32 v18, s33, v14
 v_mfma_f32_16x16x32_bf16 v[72:75], a[104:107], v[160:163], v[72:75]
 s_nop 1
 v_mfma_f32_16x16x32_bf16 v[76:79], a[96:99], v[164:167], v[76:79]
 ds_read_b128 v[196:199], v19 offset:2048
 s_add_u32 s21, s50, 8192
 v_mfma_f32_16x16x32_bf16 v[80:83], a[100:103], v[164:167], v[80:83]
 buffer_load_dwordx4 v12, s[8:11], s30 offen offset:2048 lds
 v_mfma_f32_16x16x32_bf16 v[84:87], a[104:107], v[164:167], v[84:87]
 buffer_load_dwordx4 v[248:251], v30, s[16:19], s21 offen offset:2048 sc1
 v_mfma_f32_16x16x32_bf16 v[88:91], a[96:99], v[168:171], v[88:91]
 ds_read_b128 v[200:203], v19 offset:4096
 v_mfma_f32_16x16x32_bf16 v[92:95], a[100:103], v[168:171], v[92:95]
 v_permlane16_swap_b32 v56, v57
 v_mfma_f32_16x16x32_bf16 v[96:99], a[104:107], v[168:171], v[96:99]
 v_add_f32 v56, v56, v57
 v_mfma_f32_16x16x32_bf16 v[100:103], a[96:99], v[172:175], v[100:103]
 ds_read_b128 v[204:207], v19 offset:6144
 v_mfma_f32_16x16x32_bf16 v[104:107], a[100:103], v[172:175], v[104:107]
 v_rcp_f32 v56, v56
 v_mfma_f32_16x16x32_bf16 v[108:111], a[104:107], v[172:175], v[108:111]
 s_waitcnt lgkmcnt(4)
 s_nop 0
 v_mfma_f32_16x16x32_bf16 v[112:115], a[96:99], v[176:179], v[112:115]
 ds_read_b128 v[208:211], v19 offset:8192
 v_mul_f32 v44, v44, v56
 v_mfma_f32_16x16x32_bf16 v[116:119], a[100:103], v[176:179], v[116:119]
 v_mul_f32 v45, v45, v56
 v_mul_f32 v46, v46, v56
 v_mfma_f32_16x16x32_bf16 v[120:123], a[104:107], v[176:179], v[120:123]
 v_mul_f32 v47, v47, v56
 v_mul_f32 v48, v48, v56
 v_mfma_f32_16x16x32_bf16 v[124:127], a[96:99], v[180:183], v[124:127]
 ds_read_b128 v[212:215], v19 offset:10240
 v_mul_f32 v49, v49, v56
 v_mfma_f32_16x16x32_bf16 v[128:131], a[100:103], v[180:183], v[128:131]
 buffer_load_dwordx4 v13, s[8:11], s30 offen offset:3072 lds
 v_mfma_f32_16x16x32_bf16 v[132:135], a[104:107], v[180:183], v[132:135]
 s_add_u32 s30, s30, 128
 s_add_u32 m0, m0, 16384
 v_mfma_f32_16x16x32_bf16 v[136:139], a[96:99], v[184:187], v[136:139]
 ds_read_b128 v[216:219], v19 offset:12288
 v_mul_f32 v50, v50, v56
 v_mfma_f32_16x16x32_bf16 v[140:143], a[100:103], v[184:187], v[140:143]
 s_cmp_lt_u32 m0, s46
 s_cselect_b32 m0, m0, s47
 v_mfma_f32_16x16x32_bf16 v[144:147], a[104:107], v[184:187], v[144:147]
 v_mul_f32 v51, v51, v56
 v_mul_f32 v52, v52, v56
 v_mfma_f32_16x16x32_bf16 v[148:151], a[96:99], v[188:191], v[148:151]
 ds_read_b128 v[220:223], v19 offset:14336
 v_mul_f32 v53, v53, v56
 v_mfma_f32_16x16x32_bf16 v[152:155], a[100:103], v[188:191], v[152:155]
 v_mul_f32 v54, v54, v56
 v_mul_f32 v55, v55, v56
 v_mfma_f32_16x16x32_bf16 v[156:159], a[104:107], v[188:191], v[156:159]
 s_waitcnt vmcnt(19) lgkmcnt(4)
 s_barrier
 v_mfma_f32_16x16x32_bf16 v[64:67], a[108:111], v[192:195], v[64:67]
 ds_read_b128 v[160:163], v18 offset:0
 v_cvt_pk_bf16_f32 v240, v40, v41
 v_mfma_f32_16x16x32_bf16 v[68:71], a[112:115], v[192:195], v[68:71]
 s_add_u32 s21, s50, 8192
 v_cvt_pk_bf16_f32 v241, v42, v43
 v_mfma_f32_16x16x32_bf16 v[72:75], a[116:119], v[192:195], v[72:75]
 v_add_u32 v19, s33, v15
 s_add_u32 s33, s33, 16384
 v_mfma_f32_16x16x32_bf16 v[76:79], a[108:111], v[196:199], v[76:79]
 ds_read_b128 v[164:167], v18 offset:2048
 v_cvt_pk_bf16_f32 v242, v52, v53
 v_mfma_f32_16x16x32_bf16 v[80:83], a[112:115], v[196:199], v[80:83]
 buffer_load_dwordx4 v10, s[8:11], s30 offen offset:0 lds
 v_mfma_f32_16x16x32_bf16 v[84:87], a[116:119], v[196:199], v[84:87]
 s_cmp_lt_u32 s33, 98304
 s_cselect_b32 s33, s33, 0
 v_mfma_f32_16x16x32_bf16 v[88:91], a[108:111], v[200:203], v[88:91]
 ds_read_b128 v[168:171], v18 offset:4096
 v_cvt_pk_bf16_f32 v243, v54, v55
 v_mfma_f32_16x16x32_bf16 v[92:95], a[112:115], v[200:203], v[92:95]
 buffer_load_dwordx4 v[252:255], v30, s[16:19], s21 offen offset:3072 sc1
 v_mfma_f32_16x16x32_bf16 v[96:99], a[116:119], v[200:203], v[96:99]
 v_cvt_pk_bf16_f32 v236, v44, v45
 v_cvt_pk_bf16_f32 v237, v46, v47
 v_mfma_f32_16x16x32_bf16 v[100:103], a[108:111], v[204:207], v[100:103]
 ds_read_b128 v[172:175], v18 offset:6144
 v_cvt_pk_bf16_f32 v238, v48, v49
 v_mfma_f32_16x16x32_bf16 v[104:107], a[112:115], v[204:207], v[104:107]
 v_cvt_pk_bf16_f32 v239, v50, v51
 v_cvt_pk_bf16_f32 v244, v36, v37
 v_mfma_f32_16x16x32_bf16 v[108:111], a[116:119], v[204:207], v[108:111]
 s_waitcnt lgkmcnt(4)
 v_cvt_pk_bf16_f32 v245, v38, v39
 v_mfma_f32_16x16x32_bf16 v[112:115], a[108:111], v[208:211], v[112:115]
 ds_read_b128 v[176:179], v18 offset:8192
 v_mfma_f32_16x16x32_bf16 v[116:119], a[112:115], v[208:211], v[116:119]
 v_permlane16_swap_b32 v240, v242
 v_mfma_f32_16x16x32_bf16 v[120:123], a[116:119], v[208:211], v[120:123]
 v_permlane16_swap_b32 v241, v243
 v_mfma_f32_16x16x32_bf16 v[124:127], a[108:111], v[212:215], v[124:127]
 ds_read_b128 v[180:183], v18 offset:10240
 v_mfma_f32_16x16x32_bf16 v[128:131], a[112:115], v[212:215], v[128:131]
 buffer_load_dwordx4 v11, s[8:11], s30 offen offset:1024 lds
 v_mfma_f32_16x16x32_bf16 v[132:135], a[116:119], v[212:215], v[132:135]
 v_mfma_f32_16x16x32_bf16 v[136:139], a[108:111], v[216:219], v[136:139]
 ds_read_b128 v[184:187], v18 offset:12288
 v_mfma_f32_16x16x32_bf16 v[140:143], a[112:115], v[216:219], v[140:143]
 v_mfma_f32_16x16x32_bf16 v[144:147], a[116:119], v[216:219], v[144:147]
 v_mfma_f32_16x16x32_bf16 v[148:151], a[108:111], v[220:223], v[148:151]
 ds_read_b128 v[188:191], v18 offset:14336
 v_mfma_f32_16x16x32_bf16 v[152:155], a[112:115], v[220:223], v[152:155]
 v_mfma_f32_16x16x32_bf16 v[156:159], a[116:119], v[220:223], v[156:159]
 s_waitcnt lgkmcnt(4)
 v_mfma_f32_16x16x32_bf16 v[64:67], a[120:123], v[160:163], v[64:67]
 ds_read_b128 v[192:195], v19 offset:0
 v_mfma_f32_16x16x32_bf16 v[68:71], a[124:127], v[160:163], v[68:71]
 v_add_u32 v18, s33, v14
 v_mfma_f32_16x16x32_bf16 v[72:75], a[128:131], v[160:163], v[72:75]
 v_mfma_f32_16x16x32_bf16 v[76:79], a[120:123], v[164:167], v[76:79]
 ds_read_b128 v[196:199], v19 offset:2048
 v_mfma_f32_16x16x32_bf16 v[80:83], a[124:127], v[164:167], v[80:83]
 buffer_load_dwordx4 v12, s[8:11], s30 offen offset:2048 lds
 v_mfma_f32_16x16x32_bf16 v[84:87], a[128:131], v[164:167], v[84:87]
 v_mfma_f32_16x16x32_bf16 v[88:91], a[120:123], v[168:171], v[88:91]
 ds_read_b128 v[200:203], v19 offset:4096
 v_mfma_f32_16x16x32_bf16 v[92:95], a[124:127], v[168:171], v[92:95]
 v_mfma_f32_16x16x32_bf16 v[96:99], a[128:131], v[168:171], v[96:99]
 v_mfma_f32_16x16x32_bf16 v[100:103], a[120:123], v[172:175], v[100:103]
 ds_read_b128 v[204:207], v19 offset:6144
 v_mfma_f32_16x16x32_bf16 v[104:107], a[124:127], v[172:175], v[104:107]
 v_mfma_f32_16x16x32_bf16 v[108:111], a[128:131], v[172:175], v[108:111]
 s_waitcnt lgkmcnt(4)
 v_mfma_f32_16x16x32_bf16 v[112:115], a[120:123], v[176:179], v[112:115]
 ds_read_b128 v[208:211], v19 offset:8192
 v_mfma_f32_16x16x32_bf16 v[116:119], a[124:127], v[176:179], v[116:119]
 v_mfma_f32_16x16x32_bf16 v[120:123], a[128:131], v[176:179], v[120:123]
 v_mfma_f32_16x16x32_bf16 v[124:127], a[120:123], v[180:183], v[124:127]
 ds_read_b128 v[212:215], v19 offset:10240
 v_mfma_f32_16x16x32_bf16 v[128:131], a[124:127], v[180:183], v[128:131]
 buffer_load_dwordx4 v13, s[8:11], s30 offen offset:3072 lds
 v_mfma_f32_16x16x32_bf16 v[132:135], a[128:131], v[180:183], v[132:135]
 s_add_u32 s30, s30, s25
 s_sub_u32 s30, s30, 1152
 v_mfma_f32_16x16x32_bf16 v[136:139], a[120:123], v[184:187], v[136:139]
 ds_read_b128 v[216:219], v19 offset:12288
 s_mov_b32 s25, 163840
 v_mfma_f32_16x16x32_bf16 v[140:143], a[124:127], v[184:187], v[140:143]
 s_add_u32 m0, m0, 16384
 v_mfma_f32_16x16x32_bf16 v[144:147], a[128:131], v[184:187], v[144:147]
 s_cmp_lt_u32 m0, s46
 s_cselect_b32 m0, m0, s47
 v_mfma_f32_16x16x32_bf16 v[148:151], a[120:123], v[188:191], v[148:151]
 ds_read_b128 v[220:223], v19 offset:14336
 v_mfma_f32_16x16x32_bf16 v[152:155], a[124:127], v[188:191], v[152:155]
 v_mfma_f32_16x16x32_bf16 v[156:159], a[128:131], v[188:191], v[156:159]
 s_waitcnt vmcnt(17) lgkmcnt(4)
 s_barrier
 v_mfma_f32_16x16x32_bf16 v[64:67], a[132:135], v[192:195], v[64:67]
 ds_read_b128 v[160:163], v18 offset:0
 v_mfma_f32_16x16x32_bf16 v[68:71], a[136:139], v[192:195], v[68:71]
 v_mfma_f32_16x16x32_bf16 v[72:75], a[140:143], v[192:195], v[72:75]
 v_add_u32 v19, s33, v15
 s_add_u32 s33, s33, 16384
 v_mfma_f32_16x16x32_bf16 v[76:79], a[132:135], v[196:199], v[76:79]
 ds_read_b128 v[164:167], v18 offset:2048
 v_mfma_f32_16x16x32_bf16 v[80:83], a[136:139], v[196:199], v[80:83]
 buffer_load_dwordx4 v10, s[8:11], s30 offen offset:0 lds
 v_mfma_f32_16x16x32_bf16 v[84:87], a[140:143], v[196:199], v[84:87]
 s_cmp_lt_u32 s33, 98304
 s_cselect_b32 s33, s33, 0
 v_mfma_f32_16x16x32_bf16 v[88:91], a[132:135], v[200:203], v[88:91]
 ds_read_b128 v[168:171], v18 offset:4096
 v_mfma_f32_16x16x32_bf16 v[92:95], a[136:139], v[200:203], v[92:95]
 buffer_store_dwordx4 v[236:239], v30, s[56:59], s81 offen sc1
 v_mfma_f32_16x16x32_bf16 v[96:99], a[140:143], v[200:203], v[96:99]
 v_mfma_f32_16x16x32_bf16 v[100:103], a[132:135], v[204:207], v[100:103]
 ds_read_b128 v[172:175], v18 offset:6144
 v_mfma_f32_16x16x32_bf16 v[104:107], a[136:139], v[204:207], v[104:107]
 v_mfma_f32_16x16x32_bf16 v[108:111], a[140:143], v[204:207], v[108:111]
 s_waitcnt lgkmcnt(4)
 v_mfma_f32_16x16x32_bf16 v[112:115], a[132:135], v[208:211], v[112:115]
 ds_read_b128 v[176:179], v18 offset:8192
 v_mfma_f32_16x16x32_bf16 v[116:119], a[136:139], v[208:211], v[116:119]
 s_mov_b64 exec, 0xffffffff
 buffer_store_dwordx4 v[240:243], v30, s[56:59], s81 offen offset:1024 sc1
 s_mov_b64 exec, -1
 v_mfma_f32_16x16x32_bf16 v[120:123], a[140:143], v[208:211], v[120:123]
 v_mfma_f32_16x16x32_bf16 v[124:127], a[132:135], v[212:215], v[124:127]
 ds_read_b128 v[180:183], v18 offset:10240
 v_mfma_f32_16x16x32_bf16 v[128:131], a[136:139], v[212:215], v[128:131]
 buffer_load_dwordx4 v11, s[8:11], s30 offen offset:1024 lds
 v_mfma_f32_16x16x32_bf16 v[132:135], a[140:143], v[212:215], v[132:135]
 v_mfma_f32_16x16x32_bf16 v[136:139], a[132:135], v[216:219], v[136:139]
 ds_read_b128 v[184:187], v18 offset:12288
 v_mfma_f32_16x16x32_bf16 v[140:143], a[136:139], v[216:219], v[140:143]
 buffer_store_dwordx2 v[244:245], v32, s[56:59], s81 offen offset:1536 sc1
 v_mfma_f32_16x16x32_bf16 v[144:147], a[140:143], v[216:219], v[144:147]
 s_mov_b32 s78, s82
 s_mov_b32 s82, 0
 v_mfma_f32_16x16x32_bf16 v[148:151], a[132:135], v[220:223], v[148:151]
 ds_read_b128 v[188:191], v18 offset:14336
 s_mov_b32 s81, 0x80000000
 v_mfma_f32_16x16x32_bf16 v[152:155], a[136:139], v[220:223], v[152:155]
 v_mfma_f32_16x16x32_bf16 v[156:159], a[140:143], v[220:223], v[156:159]
 s_waitcnt lgkmcnt(4)
 s_add_u32 s21, s50, 0
 v_mfma_f32_16x16x32_bf16 v[64:67], a[144:147], v[160:163], v[64:67]
 ds_read_b128 v[192:195], v19 offset:0
 v_mfma_f32_16x16x32_bf16 v[68:71], a[148:151], v[160:163], v[68:71]
 v_add_u32 v18, s33, v14
 v_mfma_f32_16x16x32_bf16 v[72:75], a[152:155], v[160:163], v[72:75]
 buffer_load_dwordx4 v[36:39], v30, s[16:19], s21 offen offset:0 sc1
 v_mfma_f32_16x16x32_bf16 v[76:79], a[144:147], v[164:167], v[76:79]
 ds_read_b128 v[196:199], v19 offset:2048
 v_mfma_f32_16x16x32_bf16 v[80:83], a[148:151], v[164:167], v[80:83]
 buffer_load_dwordx4 v12, s[8:11], s30 offen offset:2048 lds
 v_mfma_f32_16x16x32_bf16 v[84:87], a[152:155], v[164:167], v[84:87]
 v_mfma_f32_16x16x32_bf16 v[88:91], a[144:147], v[168:171], v[88:91]
 ds_read_b128 v[200:203], v19 offset:4096
 v_mfma_f32_16x16x32_bf16 v[92:95], a[148:151], v[168:171], v[92:95]
 v_mfma_f32_16x16x32_bf16 v[96:99], a[152:155], v[168:171], v[96:99]
 v_mfma_f32_16x16x32_bf16 v[100:103], a[144:147], v[172:175], v[100:103]
 ds_read_b128 v[204:207], v19 offset:6144
 v_mfma_f32_16x16x32_bf16 v[104:107], a[148:151], v[172:175], v[104:107]
 v_mfma_f32_16x16x32_bf16 v[108:111], a[152:155], v[172:175], v[108:111]
 s_waitcnt lgkmcnt(4)
 v_mfma_f32_16x16x32_bf16 v[112:115], a[144:147], v[176:179], v[112:115]
 ds_read_b128 v[208:211], v19 offset:8192
 s_add_u32 s21, s50, 0
 v_mfma_f32_16x16x32_bf16 v[116:119], a[148:151], v[176:179], v[116:119]
 buffer_load_dwordx4 v[40:43], v30, s[16:19], s21 offen offset:1024 sc1
 v_mfma_f32_16x16x32_bf16 v[120:123], a[152:155], v[176:179], v[120:123]
 v_mfma_f32_16x16x32_bf16 v[124:127], a[144:147], v[180:183], v[124:127]
 ds_read_b128 v[212:215], v19 offset:10240
 v_mfma_f32_16x16x32_bf16 v[128:131], a[148:151], v[180:183], v[128:131]
 buffer_load_dwordx4 v13, s[8:11], s30 offen offset:3072 lds
 v_mfma_f32_16x16x32_bf16 v[132:135], a[152:155], v[180:183], v[132:135]
 s_add_u32 s30, s30, 128
 s_add_u32 m0, m0, 16384
 v_mfma_f32_16x16x32_bf16 v[136:139], a[144:147], v[184:187], v[136:139]
 ds_read_b128 v[216:219], v19 offset:12288
 v_mfma_f32_16x16x32_bf16 v[140:143], a[148:151], v[184:187], v[140:143]
 s_cmp_lt_u32 m0, s46
 s_cselect_b32 m0, m0, s47
 v_mfma_f32_16x16x32_bf16 v[144:147], a[152:155], v[184:187], v[144:147]
 v_mfma_f32_16x16x32_bf16 v[148:151], a[144:147], v[188:191], v[148:151]
 ds_read_b128 v[220:223], v19 offset:14336
 v_mfma_f32_16x16x32_bf16 v[152:155], a[148:151], v[188:191], v[152:155]
 v_mfma_f32_16x16x32_bf16 v[156:159], a[152:155], v[188:191], v[156:159]
 s_waitcnt vmcnt(20) lgkmcnt(4)
 s_barrier
 v_mfma_f32_16x16x32_bf16 v[64:67], a[156:159], v[192:195], v[64:67]
 ds_read_b128 v[160:163], v18 offset:0
 s_add_u32 s21, s50, 0
 v_mfma_f32_16x16x32_bf16 v[68:71], a[160:163], v[192:195], v[68:71]
 buffer_load_dwordx4 v[44:47], v30, s[16:19], s21 offen offset:2048 sc1
 v_mfma_f32_16x16x32_bf16 v[72:75], a[164:167], v[192:195], v[72:75]
 v_add_u32 v19, s33, v15
 s_add_u32 s33, s33, 16384
 v_mfma_f32_16x16x32_bf16 v[76:79], a[156:159], v[196:199], v[76:79]
 ds_read_b128 v[164:167], v18 offset:2048
 v_mfma_f32_16x16x32_bf16 v[80:83], a[160:163], v[196:199], v[80:83]
 buffer_load_dwordx4 v10, s[8:11], s30 offen offset:0 lds
 v_mfma_f32_16x16x32_bf16 v[84:87], a[164:167], v[196:199], v[84:87]
 s_cmp_lt_u32 s33, 98304
 s_cselect_b32 s33, s33, 0
 v_mfma_f32_16x16x32_bf16 v[88:91], a[156:159], v[200:203], v[88:91]
 ds_read_b128 v[168:171], v18 offset:4096
 v_mfma_f32_16x16x32_bf16 v[92:95], a[160:163], v[200:203], v[92:95]
 v_mfma_f32_16x16x32_bf16 v[96:99], a[164:167], v[200:203], v[96:99]
 v_mfma_f32_16x16x32_bf16 v[100:103], a[156:159], v[204:207], v[100:103]
 ds_read_b128 v[172:175], v18 offset:6144
 v_mfma_f32_16x16x32_bf16 v[104:107], a[160:163], v[204:207], v[104:107]
 v_mfma_f32_16x16x32_bf16 v[108:111], a[164:167], v[204:207], v[108:111]
 s_waitcnt lgkmcnt(4)
 s_add_u32 s21, s50, 0
 v_mfma_f32_16x16x32_bf16 v[112:115], a[156:159], v[208:211], v[112:115]
 ds_read_b128 v[176:179], v18 offset:8192
 v_mfma_f32_16x16x32_bf16 v[116:119], a[160:163], v[208:211], v[116:119]
 buffer_load_dwordx4 v[48:51], v30, s[16:19], s21 offen offset:3072 sc1
 v_mfma_f32_16x16x32_bf16 v[120:123], a[164:167], v[208:211], v[120:123]
 v_mfma_f32_16x16x32_bf16 v[124:127], a[156:159], v[212:215], v[124:127]
 ds_read_b128 v[180:183], v18 offset:10240
 v_mfma_f32_16x16x32_bf16 v[128:131], a[160:163], v[212:215], v[128:131]
 buffer_load_dwordx4 v11, s[8:11], s30 offen offset:1024 lds
 v_mfma_f32_16x16x32_bf16 v[132:135], a[164:167], v[212:215], v[132:135]
 v_mfma_f32_16x16x32_bf16 v[136:139], a[156:159], v[216:219], v[136:139]
 ds_read_b128 v[184:187], v18 offset:12288
 v_mfma_f32_16x16x32_bf16 v[140:143], a[160:163], v[216:219], v[140:143]
 v_mfma_f32_16x16x32_bf16 v[144:147], a[164:167], v[216:219], v[144:147]
 v_mfma_f32_16x16x32_bf16 v[148:151], a[156:159], v[220:223], v[148:151]
 ds_read_b128 v[188:191], v18 offset:14336
 v_mfma_f32_16x16x32_bf16 v[152:155], a[160:163], v[220:223], v[152:155]
 v_mfma_f32_16x16x32_bf16 v[156:159], a[164:167], v[220:223], v[156:159]
 s_waitcnt lgkmcnt(4)
 s_add_u32 s21, s50, 4096
 v_mfma_f32_16x16x32_bf16 v[64:67], a[168:171], v[160:163], v[64:67]
 ds_read_b128 v[192:195], v19 offset:0
 v_mfma_f32_16x16x32_bf16 v[68:71], a[172:175], v[160:163], v[68:71]
 v_add_u32 v18, s33, v14
 v_mfma_f32_16x16x32_bf16 v[72:75], a[176:179], v[160:163], v[72:75]
 buffer_load_dwordx4 v[52:55], v30, s[16:19], s21 offen offset:0 sc1
 v_mfma_f32_16x16x32_bf16 v[76:79], a[168:171], v[164:167], v[76:79]
 ds_read_b128 v[196:199], v19 offset:2048
 v_mfma_f32_16x16x32_bf16 v[80:83], a[172:175], v[164:167], v[80:83]
 buffer_load_dwordx4 v12, s[8:11], s30 offen offset:2048 lds
 v_mfma_f32_16x16x32_bf16 v[84:87], a[176:179], v[164:167], v[84:87]
 v_mfma_f32_16x16x32_bf16 v[88:91], a[168:171], v[168:171], v[88:91]
 ds_read_b128 v[200:203], v19 offset:4096
 v_mfma_f32_16x16x32_bf16 v[92:95], a[172:175], v[168:171], v[92:95]
 v_mfma_f32_16x16x32_bf16 v[96:99], a[176:179], v[168:171], v[96:99]
 v_mfma_f32_16x16x32_bf16 v[100:103], a[168:171], v[172:175], v[100:103]
 ds_read_b128 v[204:207], v19 offset:6144
 v_mfma_f32_16x16x32_bf16 v[104:107], a[172:175], v[172:175], v[104:107]
 v_mfma_f32_16x16x32_bf16 v[108:111], a[176:179], v[172:175], v[108:111]
 s_waitcnt lgkmcnt(4)
 v_mfma_f32_16x16x32_bf16 v[112:115], a[168:171], v[176:179], v[112:115]
 ds_read_b128 v[208:211], v19 offset:8192
 s_add_u32 s21, s50, 4096
 v_mfma_f32_16x16x32_bf16 v[116:119], a[172:175], v[176:179], v[116:119]
 buffer_load_dwordx4 v[56:59], v30, s[16:19], s21 offen offset:1024 sc1
 v_mfma_f32_16x16x32_bf16 v[120:123], a[176:179], v[176:179], v[120:123]
 v_mfma_f32_16x16x32_bf16 v[124:127], a[168:171], v[180:183], v[124:127]
 ds_read_b128 v[212:215], v19 offset:10240
 v_mfma_f32_16x16x32_bf16 v[128:131], a[172:175], v[180:183], v[128:131]
 buffer_load_dwordx4 v13, s[8:11], s30 offen offset:3072 lds
 v_mfma_f32_16x16x32_bf16 v[132:135], a[176:179], v[180:183], v[132:135]
 s_add_u32 s30, s30, 128
 s_add_u32 m0, m0, 16384
 v_mfma_f32_16x16x32_bf16 v[136:139], a[168:171], v[184:187], v[136:139]
 ds_read_b128 v[216:219], v19 offset:12288
 v_mfma_f32_16x16x32_bf16 v[140:143], a[172:175], v[184:187], v[140:143]
 s_cmp_lt_u32 m0, s46
 s_cselect_b32 m0, m0, s47
 v_mfma_f32_16x16x32_bf16 v[144:147], a[176:179], v[184:187], v[144:147]
 v_mfma_f32_16x16x32_bf16 v[148:151], a[168:171], v[188:191], v[148:151]
 ds_read_b128 v[220:223], v19 offset:14336
 v_mfma_f32_16x16x32_bf16 v[152:155], a[172:175], v[188:191], v[152:155]
 v_mfma_f32_16x16x32_bf16 v[156:159], a[176:179], v[188:191], v[156:159]
 s_waitcnt vmcnt(22) lgkmcnt(4)
 s_barrier
 v_mfma_f32_16x16x32_bf16 v[64:67], a[180:183], v[192:195], v[64:67]
 ds_read_b128 v[160:163], v18 offset:0
 s_add_u32 s21, s50, 4096
 v_mfma_f32_16x16x32_bf16 v[68:71], a[184:187], v[192:195], v[68:71]
 buffer_load_dwordx4 v[236:239], v30, s[16:19], s21 offen offset:3072 sc1
 s_waitcnt vmcnt(13)
 s_cmp_eq_u32 s78, 0
 s_cbranch_scc1 pf_203
 v_mov_b32 v4, 0
 v_mov_b32 v5, 1
 s_mov_b64 exec, 1
 buffer_atomic_add v5, v4, s[72:75], s78 offen sc1
 s_mov_b64 exec, -1
 s_mov_b32 s78, 0
pf_203:
 v_mfma_f32_16x16x32_bf16 v[72:75], a[188:191], v[192:195], v[72:75]
 v_add_u32 v19, s33, v15
 s_add_u32 s33, s33, 16384
 v_mfma_f32_16x16x32_bf16 v[76:79], a[180:183], v[196:199], v[76:79]
 ds_read_b128 v[164:167], v18 offset:2048
 v_mfma_f32_16x16x32_bf16 v[80:83], a[184:187], v[196:199], v[80:83]
 buffer_load_dwordx4 v10, s[8:11], s30 offen offset:0 lds
 v_mfma_f32_16x16x32_bf16 v[84:87], a[188:191], v[196:199], v[84:87]
 s_cmp_lt_u32 s33, 98304
 s_cselect_b32 s33, s33, 0
 v_mfma_f32_16x16x32_bf16 v[88:91], a[180:183], v[200:203], v[88:91]
 ds_read_b128 v[168:171], v18 offset:4096
 v_mfma_f32_16x16x32_bf16 v[92:95], a[184:187], v[200:203], v[92:95]
 v_mfma_f32_16x16x32_bf16 v[96:99], a[188:191], v[200:203], v[96:99]
 v_mfma_f32_16x16x32_bf16 v[100:103], a[180:183], v[204:207], v[100:103]
 ds_read_b128 v[172:175], v18 offset:6144
 v_mfma_f32_16x16x32_bf16 v[104:107], a[184:187], v[204:207], v[104:107]
 v_mfma_f32_16x16x32_bf16 v[108:111], a[188:191], v[204:207], v[108:111]
 s_waitcnt lgkmcnt(4)
 s_add_u32 s21, s50, 8192
 v_mfma_f32_16x16x32_bf16 v[112:115], a[180:183], v[208:211], v[112:115]
 ds_read_b128 v[176:179], v18 offset:8192
 v_mfma_f32_16x16x32_bf16 v[116:119], a[184:187], v[208:211], v[116:119]
 buffer_load_dwordx4 v[240:243], v30, s[16:19], s21 offen offset:0 sc1
 v_mfma_f32_16x16x32_bf16 v[120:123], a[188:191], v[208:211], v[120:123]
 v_mfma_f32_16x16x32_bf16 v[124:127], a[180:183], v[212:215], v[124:127]
 ds_read_b128 v[180:183], v18 offset:10240
 v_mfma_f32_16x16x32_bf16 v[128:131], a[184:187], v[212:215], v[128:131]
 buffer_load_dwordx4 v11, s[8:11], s30 offen offset:1024 lds
 v_mfma_f32_16x16x32_bf16 v[132:135], a[188:191], v[212:215], v[132:135]
 v_mfma_f32_16x16x32_bf16 v[136:139], a[180:183], v[216:219], v[136:139]
 ds_read_b128 v[184:187], v18 offset:12288
 v_mfma_f32_16x16x32_bf16 v[140:143], a[184:187], v[216:219], v[140:143]
 v_mfma_f32_16x16x32_bf16 v[144:147], a[188:191], v[216:219], v[144:147]
 v_mfma_f32_16x16x32_bf16 v[148:151], a[180:183], v[220:223], v[148:151]
 ds_read_b128 v[188:191], v18 offset:14336
 v_mfma_f32_16x16x32_bf16 v[152:155], a[184:187], v[220:223], v[152:155]
 v_mfma_f32_16x16x32_bf16 v[156:159], a[188:191], v[220:223], v[156:159]
 s_waitcnt lgkmcnt(4)
 s_add_u32 s21, s50, 8192
 v_mfma_f32_16x16x32_bf16 v[64:67], a[192:195], v[160:163], v[64:67]
 ds_read_b128 v[192:195], v19 offset:0
 v_mfma_f32_16x16x32_bf16 v[68:71], a[196:199], v[160:163], v[68:71]
 v_add_u32 v18, s33, v14
 v_mfma_f32_16x16x32_bf16 v[72:75], a[200:203], v[160:163], v[72:75]
 buffer_load_dwordx4 v[244:247], v30, s[16:19], s21 offen offset:1024 sc1
 v_mfma_f32_16x16x32_bf16 v[76:79], a[192:195], v[164:167], v[76:79]
 ds_read_b128 v[196:199], v19 offset:2048
 v_mfma_f32_16x16x32_bf16 v[80:83], a[196:199], v[164:167], v[80:83]
 buffer_load_dwordx4 v12, s[8:11], s30 offen offset:2048 lds
 v_mfma_f32_16x16x32_bf16 v[84:87], a[200:203], v[164:167], v[84:87]
 v_mfma_f32_16x16x32_bf16 v[88:91], a[192:195], v[168:171], v[88:91]
 ds_read_b128 v[200:203], v19 offset:4096
 v_mfma_f32_16x16x32_bf16 v[92:95], a[196:199], v[168:171], v[92:95]
 v_mfma_f32_16x16x32_bf16 v[96:99], a[200:203], v[168:171], v[96:99]
 v_mfma_f32_16x16x32_bf16 v[100:103], a[192:195], v[172:175], v[100:103]
 ds_read_b128 v[204:207], v19 offset:6144
 v_mfma_f32_16x16x32_bf16 v[104:107], a[196:199], v[172:175], v[104:107]
 v_mfma_f32_16x16x32_bf16 v[108:111], a[200:203], v[172:175], v[108:111]
 s_waitcnt lgkmcnt(4)
 v_mfma_f32_16x16x32_bf16 v[112:115], a[192:195], v[176:179], v[112:115]
 ds_read_b128 v[208:211], v19 offset:8192
 v_mfma_f32_16x16x32_bf16 v[116:119], a[196:199], v[176:179], v[116:119]
 v_mfma_f32_16x16x32_bf16 v[120:123], a[200:203], v[176:179], v[120:123]
 v_mfma_f32_16x16x32_bf16 v[124:127], a[192:195], v[180:183], v[124:127]
 ds_read_b128 v[212:215], v19 offset:10240
 v_mfma_f32_16x16x32_bf16 v[128:131], a[196:199], v[180:183], v[128:131]
 buffer_load_dwordx4 v13, s[8:11], s30 offen offset:3072 lds
 v_mfma_f32_16x16x32_bf16 v[132:135], a[200:203], v[180:183], v[132:135]
 s_add_u32 s30, s30, 128
 s_add_u32 m0, m0, 16384
 v_mfma_f32_16x16x32_bf16 v[136:139], a[192:195], v[184:187], v[136:139]
 ds_read_b128 v[216:219], v19 offset:12288
 v_mfma_f32_16x16x32_bf16 v[140:143], a[196:199], v[184:187], v[140:143]
 s_cmp_lt_u32 m0, s46
 s_cselect_b32 m0, m0, s47
 v_mfma_f32_16x16x32_bf16 v[144:147], a[200:203], v[184:187], v[144:147]
 v_mfma_f32_16x16x32_bf16 v[148:151], a[192:195], v[188:191], v[148:151]
 ds_read_b128 v[220:223], v19 offset:14336
 v_mfma_f32_16x16x32_bf16 v[152:155], a[196:199], v[188:191], v[152:155]
 v_mfma_f32_16x16x32_bf16 v[156:159], a[200:203], v[188:191], v[156:159]
 s_waitcnt vmcnt(24) lgkmcnt(4)
 s_barrier
 v_mfma_f32_16x16x32_bf16 v[64:67], a[204:207], v[192:195], v[64:67]
 ds_read_b128 v[160:163], v18 offset:0
 v_mfma_f32_16x16x32_bf16 v[68:71], a[208:211], v[192:195], v[68:71]
 v_mfma_f32_16x16x32_bf16 v[72:75], a[212:215], v[192:195], v[72:75]
 v_add_u32 v19, s33, v15
 s_add_u32 s33, s33, 16384
 v_mfma_f32_16x16x32_bf16 v[76:79], a[204:207], v[196:199], v[76:79]
 ds_read_b128 v[164:167], v18 offset:2048
 v_mfma_f32_16x16x32_bf16 v[80:83], a[208:211], v[196:199], v[80:83]
 buffer_load_dwordx4 v10, s[8:11], s30 offen offset:0 lds
 v_mfma_f32_16x16x32_bf16 v[84:87], a[212:215], v[196:199], v[84:87]
 s_cmp_lt_u32 s33, 98304
 s_cselect_b32 s33, s33, 0
 v_mfma_f32_16x16x32_bf16 v[88:91], a[204:207], v[200:203], v[88:91]
 ds_read_b128 v[168:171], v18 offset:4096
 v_mfma_f32_16x16x32_bf16 v[92:95], a[208:211], v[200:203], v[92:95]
 v_mfma_f32_16x16x32_bf16 v[96:99], a[212:215], v[200:203], v[96:99]
 v_mfma_f32_16x16x32_bf16 v[100:103], a[204:207], v[204:207], v[100:103]
 ds_read_b128 v[172:175], v18 offset:6144
 v_mfma_f32_16x16x32_bf16 v[104:107], a[208:211], v[204:207], v[104:107]
 v_mfma_f32_16x16x32_bf16 v[108:111], a[212:215], v[204:207], v[108:111]
 s_waitcnt lgkmcnt(4)
 v_mfma_f32_16x16x32_bf16 v[112:115], a[204:207], v[208:211], v[112:115]
 ds_read_b128 v[176:179], v18 offset:8192
 v_mfma_f32_16x16x32_bf16 v[116:119], a[208:211], v[208:211], v[116:119]
 v_mfma_f32_16x16x32_bf16 v[120:123], a[212:215], v[208:211], v[120:123]
 v_mfma_f32_16x16x32_bf16 v[124:127], a[204:207], v[212:215], v[124:127]
 ds_read_b128 v[180:183], v18 offset:10240
 v_mfma_f32_16x16x32_bf16 v[128:131], a[208:211], v[212:215], v[128:131]
 buffer_load_dwordx4 v11, s[8:11], s30 offen offset:1024 lds
 v_mfma_f32_16x16x32_bf16 v[132:135], a[212:215], v[212:215], v[132:135]
 v_mfma_f32_16x16x32_bf16 v[136:139], a[204:207], v[216:219], v[136:139]
 ds_read_b128 v[184:187], v18 offset:12288
 v_mfma_f32_16x16x32_bf16 v[140:143], a[208:211], v[216:219], v[140:143]
 v_mfma_f32_16x16x32_bf16 v[144:147], a[212:215], v[216:219], v[144:147]
 v_mfma_f32_16x16x32_bf16 v[148:151], a[204:207], v[220:223], v[148:151]
 ds_read_b128 v[188:191], v18 offset:14336
 v_mfma_f32_16x16x32_bf16 v[152:155], a[208:211], v[220:223], v[152:155]
 v_mfma_f32_16x16x32_bf16 v[156:159], a[212:215], v[220:223], v[156:159]
 s_waitcnt lgkmcnt(4)
 v_mfma_f32_16x16x32_bf16 v[64:67], a[216:219], v[160:163], v[64:67]
 ds_read_b128 v[192:195], v19 offset:0
 v_mfma_f32_16x16x32_bf16 v[68:71], a[220:223], v[160:163], v[68:71]
 v_add_u32 v18, s33, v14
 v_mfma_f32_16x16x32_bf16 v[72:75], a[224:227], v[160:163], v[72:75]
 v_mfma_f32_16x16x32_bf16 v[76:79], a[216:219], v[164:167], v[76:79]
 ds_read_b128 v[196:199], v19 offset:2048
 v_mfma_f32_16x16x32_bf16 v[80:83], a[220:223], v[164:167], v[80:83]
 buffer_load_dwordx4 v12, s[8:11], s30 offen offset:2048 lds
 v_mfma_f32_16x16x32_bf16 v[84:87], a[224:227], v[164:167], v[84:87]
 v_mfma_f32_16x16x32_bf16 v[88:91], a[216:219], v[168:171], v[88:91]
 ds_read_b128 v[200:203], v19 offset:4096
 v_mfma_f32_16x16x32_bf16 v[92:95], a[220:223], v[168:171], v[92:95]
 v_mfma_f32_16x16x32_bf16 v[96:99], a[224:227], v[168:171], v[96:99]
 v_mfma_f32_16x16x32_bf16 v[100:103], a[216:219], v[172:175], v[100:103]
 ds_read_b128 v[204:207], v19 offset:6144
 v_mfma_f32_16x16x32_bf16 v[104:107], a[220:223], v[172:175], v[104:107]
 v_mfma_f32_16x16x32_bf16 v[108:111], a[224:227], v[172:175], v[108:111]
 s_waitcnt lgkmcnt(4)
 v_mfma_f32_16x16x32_bf16 v[112:115], a[216:219], v[176:179], v[112:115]
 ds_read_b128 v[208:211], v19 offset:8192
 v_mfma_f32_16x16x32_bf16 v[116:119], a[220:223], v[176:179], v[116:119]
 v_mfma_f32_16x16x32_bf16 v[120:123], a[224:227], v[176:179], v[120:123]
 v_mfma_f32_16x16x32_bf16 v[124:127], a[216:219], v[180:183], v[124:127]
 ds_read_b128 v[212:215], v19 offset:10240
 v_mfma_f32_16x16x32_bf16 v[128:131], a[220:223], v[180:183], v[128:131]
 buffer_load_dwordx4 v13, s[8:11], s30 offen offset:3072 lds
 v_mfma_f32_16x16x32_bf16 v[132:135], a[224:227], v[180:183], v[132:135]
 s_add_u32 s30, s30, 128
 s_add_u32 m0, m0, 16384
 v_mfma_f32_16x16x32_bf16 v[136:139], a[216:219], v[184:187], v[136:139]
 ds_read_b128 v[216:219], v19 offset:12288
 v_mfma_f32_16x16x32_bf16 v[140:143], a[220:223], v[184:187], v[140:143]
 s_cmp_lt_u32 m0, s46
 s_cselect_b32 m0, m0, s47
 v_mfma_f32_16x16x32_bf16 v[144:147], a[224:227], v[184:187], v[144:147]
 v_mfma_f32_16x16x32_bf16 v[148:151], a[216:219], v[188:191], v[148:151]
 ds_read_b128 v[220:223], v19 offset:14336
 v_mfma_f32_16x16x32_bf16 v[152:155], a[220:223], v[188:191], v[152:155]
 v_mfma_f32_16x16x32_bf16 v[156:159], a[224:227], v[188:191], v[156:159]
 s_waitcnt vmcnt(19) lgkmcnt(4)
 s_barrier
 v_mfma_f32_16x16x32_bf16 v[64:67], a[228:231], v[192:195], v[64:67]
 ds_read_b128 v[160:163], v18 offset:0
 v_mfma_f32_16x16x32_bf16 v[68:71], a[232:235], v[192:195], v[68:71]
 buffer_load_dword v21, v33, s[72:75], s77 offen sc1
 v_mfma_f32_16x16x32_bf16 v[72:75], a[236:239], v[192:195], v[72:75]
 v_add_u32 v19, s33, v15
 s_add_u32 s33, s33, 16384
 v_mfma_f32_16x16x32_bf16 v[76:79], a[228:231], v[196:199], v[76:79]
 ds_read_b128 v[164:167], v18 offset:2048
 v_cvt_pk_bf16_f32 v224, v64, v65
 v_cvt_pk_bf16_f32 v225, v66, v67
 v_mfma_f32_16x16x32_bf16 v[80:83], a[232:235], v[196:199], v[80:83]
 buffer_load_dwordx4 v10, s[8:11], s30 offen offset:0 lds
 v_cvt_pk_bf16_f32 v226, v68, v69
 v_cvt_pk_bf16_f32 v227, v70, v71
 v_mfma_f32_16x16x32_bf16 v[84:87], a[236:239], v[196:199], v[84:87]
 s_cmp_lt_u32 s33, 98304
 s_cselect_b32 s33, s33, 0
 v_cvt_pk_bf16_f32 v228, v72, v73
 v_cvt_pk_bf16_f32 v229, v74, v75
 v_mfma_f32_16x16x32_bf16 v[88:91], a[228:231], v[200:203], v[88:91]
 ds_read_b128 v[168:171], v18 offset:4096
 ds_write_b64 v22, v[224:225] offset:0
 v_mfma_f32_16x16x32_bf16 v[92:95], a[232:235], v[200:203], v[92:95]
 ds_write_b64 v22, v[226:227] offset:8
 ds_write_b64 v16, v[228:229] offset:64
 v_mfma_f32_16x16x32_bf16 v[96:99], a[236:239], v[200:203], v[96:99]
 v_cvt_pk_bf16_f32 v230, v76, v77
 v_cvt_pk_bf16_f32 v231, v78, v79
 v_cvt_pk_bf16_f32 v232, v80, v81
 v_cvt_pk_bf16_f32 v233, v82, v83
 v_mfma_f32_16x16x32_bf16 v[100:103], a[228:231], v[204:207], v[100:103]
 ds_read_b128 v[172:175], v18 offset:6144
 v_cvt_pk_bf16_f32 v234, v84, v85
 v_cvt_pk_bf16_f32 v235, v86, v87
 v_mfma_f32_16x16x32_bf16 v[104:107], a[232:235], v[204:207], v[104:107]
 ds_write_b64 v22, v[230:231] offset:6400
 ds_write_b64 v22, v[232:233] offset:6408
 v_mfma_f32_16x16x32_bf16 v[108:111], a[236:239], v[204:207], v[108:111]
 s_waitcnt lgkmcnt(9)
 ds_write_b64 v16, v[234:235] offset:6464
 v_cvt_pk_bf16_f32 v224, v88, v89
 v_mfma_f32_16x16x32_bf16 v[112:115], a[228:231], v[208:211], v[112:115]
 ds_read_b128 v[176:179], v18 offset:8192
 v_cvt_pk_bf16_f32 v225, v90, v91
 v_cvt_pk_bf16_f32 v226, v92, v93
 v_cvt_pk_bf16_f32 v227, v94, v95
 v_mfma_f32_16x16x32_bf16 v[116:119], a[232:235], v[208:211], v[116:119]
 v_cvt_pk_bf16_f32 v228, v96, v97
 v_cvt_pk_bf16_f32 v229, v98, v99
 ds_write_b64 v22, v[224:225] offset:12800
 v_mfma_f32_16x16x32_bf16 v[120:123], a[236:239], v[208:211], v[120:123]
 ds_write_b64 v22, v[226:227] offset:12808
 ds_write_b64 v16, v[228:229] offset:12864
 v_mfma_f32_16x16x32_bf16 v[124:127], a[228:231], v[212:215], v[124:127]
 ds_read_b128 v[180:183], v18 offset:10240
 v_cvt_pk_bf16_f32 v230, v100, v101
 v_cvt_pk_bf16_f32 v231, v102, v103
 v_cvt_pk_bf16_f32 v232, v104, v105
 v_mfma_f32_16x16x32_bf16 v[128:131], a[232:235], v[212:215], v[128:131]
 buffer_load_dwordx4 v11, s[8:11], s30 offen offset:1024 lds
 v_cvt_pk_bf16_f32 v233, v106, v107
 v_cvt_pk_bf16_f32 v234, v108, v109
 v_mfma_f32_16x16x32_bf16 v[132:135], a[236:239], v[212:215], v[132:135]
 v_cvt_pk_bf16_f32 v235, v110, v111
 ds_write_b64 v22, v[230:231] offset:19200
 v_mfma_f32_16x16x32_bf16 v[136:139], a[228:231], v[216:219], v[136:139]
 ds_read_b128 v[184:187], v18 offset:12288
 ds_write_b64 v22, v[232:233] offset:19208
 v_mfma_f32_16x16x32_bf16 v[140:143], a[232:235], v[216:219], v[140:143]
 ds_write_b64 v16, v[234:235] offset:19264
 v_cvt_pk_bf16_f32 v224, v112, v113
 v_cvt_pk_bf16_f32 v225, v114, v115
 v_mfma_f32_16x16x32_bf16 v[144:147], a[236:239], v[216:219], v[144:147]
 v_cvt_pk_bf16_f32 v226, v116, v117
 v_cvt_pk_bf16_f32 v227, v118, v119
 v_cvt_pk_bf16_f32 v228, v120, v121
 v_cvt_pk_bf16_f32 v229, v122, v123
 v_mfma_f32_16x16x32_bf16 v[148:151], a[228:231], v[220:223], v[148:151]
 ds_read_b128 v[188:191], v18 offset:14336
 ds_write_b64 v22, v[224:225] offset:25600
 v_mfma_f32_16x16x32_bf16 v[152:155], a[232:235], v[220:223], v[152:155]
 ds_write_b64 v22, v[226:227] offset:25608
 ds_write_b64 v16, v[228:229] offset:25664
 v_mfma_f32_16x16x32_bf16 v[156:159], a[236:239], v[220:223], v[156:159]
 v_cvt_pk_bf16_f32 v230, v124, v125
 v_cvt_pk_bf16_f32 v231, v126, v127
 v_cvt_pk_bf16_f32 v232, v128, v129
 v_cvt_pk_bf16_f32 v233, v130, v131
qa_end_205:
 v_cvt_pk_bf16_f32 v234, v132, v133
 v_cvt_pk_bf16_f32 v235, v134, v135
 ds_write_b64 v22, v[230:231] offset:32000
 ds_write_b64 v22, v[232:233] offset:32008
 ds_write_b64 v16, v[234:235] offset:32064
 v_cvt_pk_bf16_f32 v224, v136, v137
 v_cvt_pk_bf16_f32 v225, v138, v139
 v_cvt_pk_bf16_f32 v226, v140, v141
 v_cvt_pk_bf16_f32 v227, v142, v143
 v_cvt_pk_bf16_f32 v228, v144, v145
 v_cvt_pk_bf16_f32 v229, v146, v147
 ds_write_b64 v22, v[224:225] offset:38400
 ds_write_b64 v22, v[226:227] offset:38408
 ds_write_b64 v16, v[228:229] offset:38464
 v_cvt_pk_bf16_f32 v230, v148, v149
 v_cvt_pk_bf16_f32 v231, v150, v151
 v_cvt_pk_bf16_f32 v232, v152, v153
 v_cvt_pk_bf16_f32 v233, v154, v155
 v_cvt_pk_bf16_f32 v234, v156, v157
 v_cvt_pk_bf16_f32 v235, v158, v159
 ds_write_b64 v22, v[230:231] offset:44800
 ds_write_b64 v22, v[232:233] offset:44808
 ds_write_b64 v16, v[234:235] offset:44864
 s_cmp_lg_u32 s26, s40
 s_cbranch_scc1 qbs_208
 s_waitcnt lgkmcnt(0)
 s_barrier
 ds_read_b128 v[64:67], v29 offset:0
 ds_read_b128 v[68:71], v29 offset:64
 ds_read_b128 v[72:75], v29 offset:128
 ds_read_b128 v[76:79], v29 offset:192
 ds_read_b128 v[80:83], v29 offset:256
 ds_read_b128 v[84:87], v29 offset:320
 ds_read_b128 v[88:91], v29 offset:6400
 ds_read_b128 v[92:95], v29 offset:6464
 ds_read_b128 v[96:99], v29 offset:6528
 ds_read_b128 v[100:103], v29 offset:6592
 ds_read_b128 v[104:107], v29 offset:6656
 ds_read_b128 v[108:111], v29 offset:6720
 s_waitcnt lgkmcnt(0)
 s_add_u32 s21, s43, 0
 buffer_store_dwordx4 v[64:67], v30, s[12:15], s21 offen offset:0 sc1
 buffer_store_dwordx4 v[68:71], v30, s[12:15], s21 offen offset:1024 sc1
 buffer_store_dwordx4 v[72:75], v30, s[12:15], s21 offen offset:2048 sc1
 buffer_store_dwordx4 v[76:79], v30, s[12:15], s21 offen offset:3072 sc1
 s_add_u32 s21, s43, 4096
 buffer_store_dwordx4 v[80:83], v30, s[12:15], s21 offen offset:0 sc1
 buffer_store_dwordx4 v[84:87], v30, s[12:15], s21 offen offset:1024 sc1
 buffer_store_dwordx4 v[88:91], v30, s[12:15], s21 offen offset:2048 sc1
 buffer_store_dwordx4 v[92:95], v30, s[12:15], s21 offen offset:3072 sc1
 s_add_u32 s21, s43, 8192
 buffer_store_dwordx4 v[96:99], v30, s[12:15], s21 offen offset:0 sc1
 buffer_store_dwordx4 v[100:103], v30, s[12:15], s21 offen offset:1024 sc1
 buffer_store_dwordx4 v[104:107], v30, s[12:15], s21 offen offset:2048 sc1
 buffer_store_dwordx4 v[108:111], v30, s[12:15], s21 offen offset:3072 sc1
 s_branch qbe_206
qbs_208:
 s_cmp_eq_u32 s80, 1
 s_cselect_b32 s21, s79, 0
 s_cmp_ge_u32 s21, 8
 s_cbranch_scc0 qx_209
 s_waitcnt lgkmcnt(0) vmcnt(5)
 s_barrier
 ds_read_b128 v[64:67], v29 offset:0
 ds_read_b128 v[88:91], v29 offset:6400
 ds_read_b128 v[68:71], v29 offset:64
 ds_read_b128 v[92:95], v29 offset:6464
 ds_read_b128 v[72:75], v29 offset:128
 ds_read_b128 v[96:99], v29 offset:6528
 ds_read_b128 v[76:79], v29 offset:192
 ds_read_b128 v[100:103], v29 offset:6592
 ds_read_b128 v[80:83], v29 offset:256
 ds_read_b128 v[104:107], v29 offset:6656
 ds_read_b128 v[84:87], v29 offset:320
 ds_read_b128 v[108:111], v29 offset:6720
 s_waitcnt lgkmcnt(10)
 v_mfma_f32_16x16x32_bf16 v[112:115], v[36:39], v[64:67], 0
 v_mfma_f32_16x16x32_bf16 v[116:119], a[240:243], v[64:67], 0
 v_mfma_f32_16x16x32_bf16 v[120:123], v[36:39], v[88:91], 0
 v_mfma_f32_16x16x32_bf16 v[124:127], v[60:63], v[88:91], 0
 v_mfma_f32_16x16x32_bf16 v[128:131], a[240:243], v[88:91], 0
 s_waitcnt lgkmcnt(8)
 v_mfma_f32_16x16x32_bf16 v[112:115], v[40:43], v[68:71], v[112:115]
 v_mfma_f32_16x16x32_bf16 v[116:119], a[244:247], v[68:71], v[116:119]
 v_mfma_f32_16x16x32_bf16 v[120:123], v[40:43], v[92:95], v[120:123]
 v_mfma_f32_16x16x32_bf16 v[124:127], v[236:239], v[92:95], v[124:127]
 v_mfma_f32_16x16x32_bf16 v[128:131], a[244:247], v[92:95], v[128:131]
 s_waitcnt lgkmcnt(6)
 v_mfma_f32_16x16x32_bf16 v[112:115], v[44:47], v[72:75], v[112:115]
 v_mfma_f32_16x16x32_bf16 v[116:119], a[248:251], v[72:75], v[116:119]
 v_mfma_f32_16x16x32_bf16 v[120:123], v[44:47], v[96:99], v[120:123]
 v_mfma_f32_16x16x32_bf16 v[124:127], v[240:243], v[96:99], v[124:127]
 v_mfma_f32_16x16x32_bf16 v[128:131], a[248:251], v[96:99], v[128:131]
 s_waitcnt lgkmcnt(4)
 v_mfma_f32_16x16x32_bf16 v[112:115], v[48:51], v[76:79], v[112:115]
 v_mfma_f32_16x16x32_bf16 v[116:119], a[252:255], v[76:79], v[116:119]
 v_mfma_f32_16x16x32_bf16 v[120:123], v[48:51], v[100:103], v[120:123]
 v_mfma_f32_16x16x32_bf16 v[124:127], v[244:247], v[100:103], v[124:127]
 v_mfma_f32_16x16x32_bf16 v[128:131], a[252:255], v[100:103], v[128:131]
 s_waitcnt lgkmcnt(2)
 v_mfma_f32_16x16x32_bf16 v[112:115], v[52:55], v[80:83], v[112:115]
 v_mfma_f32_16x16x32_bf16 v[116:119], v[24:27], v[80:83], v[116:119]
 v_mfma_f32_16x16x32_bf16 v[120:123], v[52:55], v[104:107], v[120:123]
 v_mfma_f32_16x16x32_bf16 v[124:127], v[248:251], v[104:107], v[124:127]
 v_mfma_f32_16x16x32_bf16 v[128:131], v[24:27], v[104:107], v[128:131]
 s_waitcnt lgkmcnt(0)
 v_mfma_f32_16x16x32_bf16 v[112:115], v[56:59], v[84:87], v[112:115]
 v_mfma_f32_16x16x32_bf16 v[116:119], v[6:9], v[84:87], v[116:119]
 v_mfma_f32_16x16x32_bf16 v[120:123], v[56:59], v[108:111], v[120:123]
 v_mfma_f32_16x16x32_bf16 v[124:127], v[252:255], v[108:111], v[124:127]
 v_mfma_f32_16x16x32_bf16 v[128:131], v[6:9], v[108:111], v[128:131]
 s_branch qx_207
qx_209:
 buffer_load_dword v21, v33, s[72:75], s77 offen sc1
 s_waitcnt vmcnt(0)
 s_mul_i32 s21, s49, 393216
 s_mul_i32 s22, s42, 12288
 s_add_u32 s50, s21, s22
 s_lshr_b32 s21, s49, 1
 s_bitcmp1_b32 s37, s21
 s_cselect_b32 s21, 8192, 0
 s_lshl_b32 s51, s49, 20
 s_or_b32 s51, s51, s21
 s_xor_b32 s51, s51, 8192
 s_add_u32 s51, s51, s36
 s_lshr_b32 s22, s49, 1
 s_lshr_b32 s21, s49, 2
 s_add_u32 s21, s21, 3
 s_cmp_lt_u32 s49, 12
 s_cselect_b32 s21, s22, s21
 s_lshl_b32 s21, s21, 3
 s_lshr_b32 s22, s42, 2
 s_add_u32 s21, s21, s22
 s_lshl_b32 s21, s21, 7
 s_add_u32 s76, s21, 0
 s_lshl_b32 s77, s42, 7
 s_add_u32 s77, s77, 19456
 s_add_u32 s23, s49, 1
 s_waitcnt vmcnt(6)
 v_cmp_gt_u32 vcc, s23, v21
 s_mov_b32 s80, 0
 s_nop 0
 s_cbranch_vccnz qk_211
 s_mov_b32 s80, 1
 buffer_load_dwordx4 v[132:135], v31, s[52:55], s51 offen offset:0 sc1
 buffer_load_dwordx4 v[136:139], v31, s[52:55], s51 offen offset:512 sc1
 buffer_load_dwordx4 v[140:143], v31, s[52:55], s51 offen offset:1024 sc1
 buffer_load_dwordx4 v[144:147], v31, s[52:55], s51 offen offset:1536 sc1
 buffer_load_dwordx4 v[148:151], v31, s[52:55], s51 offen offset:2048 sc1
 buffer_load_dwordx4 v[152:155], v31, s[52:55], s51 offen offset:2560 sc1
qk_211:
 s_cmp_ge_u32 s79, 8
 s_cbranch_scc1 qk_210
 v_mov_b32 v156, 0
 s_mov_b32 s101, 0
wf_212:
 buffer_load_dword v157, v156, s[72:75], s76 offen sc1
 s_add_u32 s101, s101, 1
 s_cmp_gt_u32 s101, 131072
 s_cbranch_scc1 main_end
 s_waitcnt vmcnt(0)
 v_readfirstlane_b32 s100, v157
 s_cmp_ge_u32 s100, 8
 s_cbranch_scc1 wf_213
 s_sleep 2
 s_branch wf_212
wf_213:
 s_add_u32 s21, s50, 0
 buffer_load_dwordx4 v[36:39], v30, s[16:19], s21 offen offset:0 sc1
 buffer_load_dwordx4 v[40:43], v30, s[16:19], s21 offen offset:1024 sc1
 buffer_load_dwordx4 v[44:47], v30, s[16:19], s21 offen offset:2048 sc1
 buffer_load_dwordx4 v[48:51], v30, s[16:19], s21 offen offset:3072 sc1
 s_add_u32 s21, s50, 4096
 buffer_load_dwordx4 v[52:55], v30, s[16:19], s21 offen offset:0 sc1
 buffer_load_dwordx4 v[56:59], v30, s[16:19], s21 offen offset:1024 sc1
 buffer_load_dwordx4 v[60:63], v30, s[16:19], s21 offen offset:2048 sc1
 buffer_load_dwordx4 v[236:239], v30, s[16:19], s21 offen offset:3072 sc1
 s_add_u32 s21, s50, 8192
 buffer_load_dwordx4 v[240:243], v30, s[16:19], s21 offen offset:0 sc1
 buffer_load_dwordx4 v[244:247], v30, s[16:19], s21 offen offset:1024 sc1
 buffer_load_dwordx4 v[248:251], v30, s[16:19], s21 offen offset:2048 sc1
 buffer_load_dwordx4 v[252:255], v30, s[16:19], s21 offen offset:3072 sc1
qk_210:
 s_waitcnt lgkmcnt(0)
 s_barrier
 ds_read_b128 v[64:67], v29 offset:0
 ds_read_b128 v[68:71], v29 offset:64
 ds_read_b128 v[72:75], v29 offset:128
 ds_read_b128 v[76:79], v29 offset:192
 ds_read_b128 v[80:83], v29 offset:256
 ds_read_b128 v[84:87], v29 offset:320
 ds_read_b128 v[88:91], v29 offset:6400
 ds_read_b128 v[92:95], v29 offset:6464
 ds_read_b128 v[96:99], v29 offset:6528
 ds_read_b128 v[100:103], v29 offset:6592
 ds_read_b128 v[104:107], v29 offset:6656
 ds_read_b128 v[108:111], v29 offset:6720
 s_waitcnt lgkmcnt(0)
 s_cmp_eq_u32 s80, 1
 s_cselect_b32 s21, s79, 0
 s_cmp_ge_u32 s21, 8
 s_cbranch_scc1 qw_214
 s_waitcnt vmcnt(0)
qw_214:
 v_mfma_f32_16x16x32_bf16 v[112:115], v[36:39], v[64:67], 0
 v_mfma_f32_16x16x32_bf16 v[120:123], v[36:39], v[88:91], 0
 v_mfma_f32_16x16x32_bf16 v[124:127], v[60:63], v[88:91], 0
 v_mfma_f32_16x16x32_bf16 v[112:115], v[40:43], v[68:71], v[112:115]
 v_mfma_f32_16x16x32_bf16 v[120:123], v[40:43], v[92:95], v[120:123]
 v_mfma_f32_16x16x32_bf16 v[124:127], v[236:239], v[92:95], v[124:127]
 v_mfma_f32_16x16x32_bf16 v[112:115], v[44:47], v[72:75], v[112:115]
 v_mfma_f32_16x16x32_bf16 v[120:123], v[44:47], v[96:99], v[120:123]
 v_mfma_f32_16x16x32_bf16 v[124:127], v[240:243], v[96:99], v[124:127]
 v_mfma_f32_16x16x32_bf16 v[112:115], v[48:51], v[76:79], v[112:115]
 v_mfma_f32_16x16x32_bf16 v[120:123], v[48:51], v[100:103], v[120:123]
 v_mfma_f32_16x16x32_bf16 v[124:127], v[244:247], v[100:103], v[124:127]
 v_mfma_f32_16x16x32_bf16 v[112:115], v[52:55], v[80:83], v[112:115]
 v_mfma_f32_16x16x32_bf16 v[120:123], v[52:55], v[104:107], v[120:123]
 v_mfma_f32_16x16x32_bf16 v[124:127], v[248:251], v[104:107], v[124:127]
 v_mfma_f32_16x16x32_bf16 v[112:115], v[56:59], v[84:87], v[112:115]
 v_mfma_f32_16x16x32_bf16 v[120:123], v[56:59], v[108:111], v[120:123]
 v_mfma_f32_16x16x32_bf16 v[124:127], v[252:255], v[108:111], v[124:127]
 s_cmp_eq_u32 s80, 1
 s_cbranch_scc1 qm_215
 s_add_u32 s23, s49, 1
 s_min_u32 s22, s49, 61
 s_cmp_lt_u32 s49, 56
 s_cselect_b32 s23, s23, s22
 s_mov_b32 s101, 0
wm_216:
 buffer_load_dword v156, v33, s[72:75], s77 offen sc1
 s_add_u32 s101, s101, 1
 s_cmp_gt_u32 s101, 131072
 s_cbranch_scc1 main_end
 s_waitcnt vmcnt(0)
 v_cmp_gt_u32 vcc, s23, v156
 v_readfirstlane_b32 s100, v156
 s_nop 0
 s_cbranch_vccz wm_217
 s_sleep 16
 s_add_u32 s100, s100, 2
 s_cmp_ge_u32 s100, s23
 s_cbranch_scc1 wm_216
 s_sleep 90
 s_branch wm_216
wm_217:
 s_cmp_eq_u32 s49, 63
 s_cselect_b32 s21, s101, 0
 s_cmp_lt_u32 s21, 2
 s_cbranch_scc1 qtz_220
 s_sleep 36
qtz_220:
 s_mov_b32 s101, 0
 s_branch qtp_219
qtp_218:
 s_sleep 3
qtp_219:
 buffer_load_dwordx4 v[132:135], v31, s[52:55], s51 offen offset:0 sc1
 buffer_load_dwordx4 v[136:139], v31, s[52:55], s51 offen offset:512 sc1
 buffer_load_dwordx4 v[140:143], v31, s[52:55], s51 offen offset:1024 sc1
 buffer_load_dwordx4 v[144:147], v31, s[52:55], s51 offen offset:1536 sc1
 buffer_load_dwordx4 v[148:151], v31, s[52:55], s51 offen offset:2048 sc1
 buffer_load_dwordx4 v[152:155], v31, s[52:55], s51 offen offset:2560 sc1
 s_add_u32 s101, s101, 1
 s_cmp_gt_u32 s101, 131072
 s_cbranch_scc1 main_end
 s_waitcnt vmcnt(0)
 v_max3_u32 v156, v132, v134, v136
 v_max3_u32 v156, v156, v138, v140
 v_max3_u32 v156, v156, v142, v144
 v_max3_u32 v156, v156, v146, v148
 v_max3_u32 v156, v156, v150, v152
 v_max3_u32 v156, v156, v154, v154
 v_cmp_eq_u32 vcc, -1, v156
 s_nop 1
 s_cbranch_vccnz qtp_218
qm_215:
 s_waitcnt vmcnt(0)
 v_mfma_f32_16x16x32_bf16 v[116:119], v[132:135], v[64:67], 0
 v_mfma_f32_16x16x32_bf16 v[128:131], v[132:135], v[88:91], 0
 v_mfma_f32_16x16x32_bf16 v[116:119], v[136:139], v[68:71], v[116:119]
 v_mfma_f32_16x16x32_bf16 v[128:131], v[136:139], v[92:95], v[128:131]
 v_mfma_f32_16x16x32_bf16 v[116:119], v[140:143], v[72:75], v[116:119]
 v_mfma_f32_16x16x32_bf16 v[128:131], v[140:143], v[96:99], v[128:131]
 v_mfma_f32_16x16x32_bf16 v[116:119], v[144:147], v[76:79], v[116:119]
 v_mfma_f32_16x16x32_bf16 v[128:131], v[144:147], v[100:103], v[128:131]
 v_mfma_f32_16x16x32_bf16 v[116:119], v[148:151], v[80:83], v[116:119]
 v_mfma_f32_16x16x32_bf16 v[128:131], v[148:151], v[104:107], v[128:131]
 v_mfma_f32_16x16x32_bf16 v[116:119], v[152:155], v[84:87], v[116:119]
 v_mfma_f32_16x16x32_bf16 v[128:131], v[152:155], v[108:111], v[128:131]
qx_207:
 s_lshr_b32 s21, s49, 1
 s_bitcmp1_b32 s37, s21
 s_cselect_b32 s21, 8192, 0
 s_lshl_b32 s81, s49, 20
 s_or_b32 s81, s81, s21
 s_add_u32 s81, s81, s44
 s_lshl_b32 s82, s49, 3
 s_and_b32 s21, s42, 7
 s_add_u32 s82, s82, s21
 s_lshl_b32 s82, s82, 7
 s_add_u32 s82, s82, 23552
 s_cmp_gt_u32 s26, 1
 s_cselect_b32 s21, s80, 0
 s_cmp_eq_u32 s21, 0
 s_cbranch_scc1 qi_222
 v_mov_b32 v36, v112
 v_mov_b32 v37, v113
 v_mov_b32 v38, v114
 v_mov_b32 v39, v115
 v_mov_b32 v40, v116
 v_mov_b32 v41, v117
 v_mov_b32 v42, v118
 v_mov_b32 v43, v119
 v_mov_b32 v44, v120
 v_mov_b32 v45, v121
 v_mov_b32 v46, v122
 v_mov_b32 v47, v123
 v_mov_b32 v48, v124
 v_mov_b32 v49, v125
 v_mov_b32 v50, v126
 v_mov_b32 v51, v127
 v_mov_b32 v52, v128
 v_mov_b32 v53, v129
 v_mov_b32 v54, v130
 v_mov_b32 v55, v131
 s_branch qd_221
qi_222:
 v_cndmask_b32 v112, v34, v112, s[64:65]
 v_cndmask_b32 v124, v34, v124, s[64:65]
 v_cndmask_b32 v113, v34, v113, s[66:67]
 v_cndmask_b32 v125, v34, v125, s[66:67]
 v_cndmask_b32 v114, v34, v114, s[68:69]
 v_cndmask_b32 v126, v34, v126, s[68:69]
 v_cndmask_b32 v115, v34, v115, s[70:71]
 v_cndmask_b32 v127, v34, v127, s[70:71]
 v_max3_f32 v156, v112, v113, v114
 v_max3_f32 v156, v156, v115, v116
 v_max3_f32 v156, v156, v117, v118
 v_max_f32 v156, v156, v119
 v_mov_b32 v157, v156
 s_nop 1
 v_permlane32_swap_b32 v156, v157
 v_max_f32 v156, v156, v157
 v_mov_b32 v157, v156
 s_nop 1
 v_permlane16_swap_b32 v156, v157
 v_max_f32 v156, v156, v157
 v_mul_f32 v156, s83, v156
 v_fma_f32 v112, v112, s83, -v156
 v_fma_f32 v113, v113, s83, -v156
 v_fma_f32 v114, v114, s83, -v156
 v_fma_f32 v115, v115, s83, -v156
 v_fma_f32 v116, v116, s83, -v156
 v_fma_f32 v117, v117, s83, -v156
 v_fma_f32 v118, v118, s83, -v156
 v_fma_f32 v119, v119, s83, -v156
 v_exp_f32 v112, v112
 v_exp_f32 v113, v113
 v_exp_f32 v114, v114
 v_exp_f32 v115, v115
 v_exp_f32 v116, v116
 v_exp_f32 v117, v117
 v_exp_f32 v118, v118
 v_exp_f32 v119, v119
 s_nop 0
 v_add_f32 v156, v116, v117
 v_add_f32 v156, v156, v118
 v_add_f32 v156, v156, v119
 v_cndmask_b32 v156, 0, v156, s[60:61]
 v_add_f32 v156, v156, v112
 v_add_f32 v156, v156, v113
 v_add_f32 v156, v156, v114
 v_add_f32 v156, v156, v115
 v_mov_b32 v157, v156
 s_nop 1
 v_permlane32_swap_b32 v156, v157
 v_add_f32 v156, v156, v157
 v_mov_b32 v157, v156
 s_nop 1
 v_permlane16_swap_b32 v156, v157
 v_add_f32 v156, v156, v157
 v_rcp_f32 v156, v156
 s_nop 0
 v_mul_f32 v112, v112, v156
 v_mul_f32 v113, v113, v156
 v_mul_f32 v114, v114, v156
 v_mul_f32 v115, v115, v156
 v_mul_f32 v116, v116, v156
 v_mul_f32 v117, v117, v156
 v_mul_f32 v118, v118, v156
 v_mul_f32 v119, v119, v156
 v_max3_f32 v156, v120, v121, v122
 v_max3_f32 v156, v156, v123, v124
 v_max3_f32 v156, v156, v125, v126
 v_max3_f32 v156, v156, v127, v128
 v_max3_f32 v156, v156, v129, v130
 v_max_f32 v156, v156, v131
 v_mov_b32 v157, v156
 s_nop 1
 v_permlane32_swap_b32 v156, v157
 v_max_f32 v156, v156, v157
 v_mov_b32 v157, v156
 s_nop 1
 v_permlane16_swap_b32 v156, v157
 v_max_f32 v156, v156, v157
 v_mul_f32 v156, s83, v156
 v_fma_f32 v120, v120, s83, -v156
 v_fma_f32 v121, v121, s83, -v156
 v_fma_f32 v122, v122, s83, -v156
 v_fma_f32 v123, v123, s83, -v156
 v_fma_f32 v124, v124, s83, -v156
 v_fma_f32 v125, v125, s83, -v156
 v_fma_f32 v126, v126, s83, -v156
 v_fma_f32 v127, v127, s83, -v156
 v_fma_f32 v128, v128, s83, -v156
 v_fma_f32 v129, v129, s83, -v156
 v_fma_f32 v130, v130, s83, -v156
 v_fma_f32 v131, v131, s83, -v156
 v_exp_f32 v120, v120
 v_exp_f32 v121, v121
 v_exp_f32 v122, v122
 v_exp_f32 v123, v123
 v_exp_f32 v124, v124
 v_exp_f32 v125, v125
 v_exp_f32 v126, v126
 v_exp_f32 v127, v127
 v_exp_f32 v128, v128
 v_exp_f32 v129, v129
 v_exp_f32 v130, v130
 v_exp_f32 v131, v131
 s_nop 0
 v_add_f32 v156, v128, v129
 v_add_f32 v156, v156, v130
 v_add_f32 v156, v156, v131
 v_cndmask_b32 v156, 0, v156, s[60:61]
 v_add_f32 v156, v156, v120
 v_add_f32 v156, v156, v121
 v_add_f32 v156, v156, v122
 v_add_f32 v156, v156, v123
 v_add_f32 v156, v156, v124
 v_add_f32 v156, v156, v125
 v_add_f32 v156, v156, v126
 v_add_f32 v156, v156, v127
 v_mov_b32 v157, v156
 s_nop 1
 v_permlane32_swap_b32 v156, v157
 v_add_f32 v156, v156, v157
 v_mov_b32 v157, v156
 s_nop 1
 v_permlane16_swap_b32 v156, v157
 v_add_f32 v156, v156, v157
 v_rcp_f32 v156, v156
 s_nop 0
 v_mul_f32 v120, v120, v156
 v_mul_f32 v121, v121, v156
 v_mul_f32 v122, v122, v156
 v_mul_f32 v123, v123, v156
 v_mul_f32 v124, v124, v156
 v_mul_f32 v125, v125, v156
 v_mul_f32 v126, v126, v156
 v_mul_f32 v127, v127, v156
 v_mul_f32 v128, v128, v156
 v_mul_f32 v129, v129, v156
 v_mul_f32 v130, v130, v156
 v_mul_f32 v131, v131, v156
 v_cvt_pk_bf16_f32 v196, v116, v117
 v_cvt_pk_bf16_f32 v197, v118, v119
 v_cvt_pk_bf16_f32 v198, v128, v129
 v_cvt_pk_bf16_f32 v199, v130, v131
 v_cvt_pk_bf16_f32 v192, v120, v121
 v_cvt_pk_bf16_f32 v193, v122, v123
 v_cvt_pk_bf16_f32 v194, v124, v125
 v_cvt_pk_bf16_f32 v195, v126, v127
 v_cvt_pk_bf16_f32 v200, v112, v113
 v_cvt_pk_bf16_f32 v201, v114, v115
 v_permlane16_swap_b32 v196, v198
 v_permlane16_swap_b32 v197, v199
 buffer_store_dwordx4 v[192:195], v30, s[56:59], s81 offen sc1
 s_mov_b64 exec, 0xffffffff
 buffer_store_dwordx4 v[196:199], v30, s[56:59], s81 offen offset:1024 sc1
 s_mov_b64 exec, -1
 buffer_store_dwordx2 v[200:201], v32, s[56:59], s81 offen offset:1536 sc1
 s_mov_b32 s78, s82
 s_mov_b32 s81, 0x80000000
 s_mov_b32 s82, 0
 s_cmp_eq_u32 s80, 1
 s_cbranch_scc1 qd_221
 s_waitcnt vmcnt(0)
 s_cmp_eq_u32 s78, 0
 s_cbranch_scc1 pf_223
 v_mov_b32 v4, 0
 v_mov_b32 v5, 1
 s_mov_b64 exec, 1
 buffer_atomic_add v5, v4, s[72:75], s78 offen sc1
 s_mov_b64 exec, -1
 s_mov_b32 s78, 0
pf_223:
qd_221:
 s_add_u32 s49, s49, s29
qbe_206:
 s_sub_u32 s26, s26, 1
 s_cmp_gt_u32 s26, 0
 s_waitcnt lgkmcnt(0)
 s_cbranch_scc1 qa_blk_204
 s_waitcnt vmcnt(0) lgkmcnt(0)
 s_cmp_eq_u32 s78, 0
 s_cbranch_scc1 pf_224
 v_mov_b32 v4, 0
 v_mov_b32 v5, 1
 s_mov_b64 exec, 1
 buffer_atomic_add v5, v4, s[72:75], s78 offen sc1
 s_mov_b64 exec, -1
 s_mov_b32 s78, 0
pf_224:
 s_cmp_eq_u32 s45, 0
 s_cbranch_scc1 q_done
 s_mul_i32 s21, s49, 393216
 s_mul_i32 s22, s42, 12288
 s_add_u32 s50, s21, s22
 s_lshr_b32 s21, s49, 1
 s_bitcmp1_b32 s37, s21
 s_cselect_b32 s21, 8192, 0
 s_lshl_b32 s51, s49, 20
 s_or_b32 s51, s51, s21
 s_xor_b32 s51, s51, 8192
 s_add_u32 s51, s51, s36
 s_lshr_b32 s22, s49, 1
 s_lshr_b32 s21, s49, 2
 s_add_u32 s21, s21, 3
 s_cmp_lt_u32 s49, 12
 s_cselect_b32 s21, s22, s21
 s_lshl_b32 s21, s21, 3
 s_lshr_b32 s22, s42, 2
 s_add_u32 s21, s21, s22
 s_lshl_b32 s21, s21, 7
 s_add_u32 s76, s21, 0
 s_lshl_b32 s77, s42, 7
 s_add_u32 s77, s77, 19456
 buffer_load_dword v21, v33, s[72:75], s77 offen sc1
 s_add_u32 s21, s50, 0
 buffer_load_dwordx4 v[36:39], v30, s[16:19], s21 offen offset:0 sc1
 buffer_load_dwordx4 v[40:43], v30, s[16:19], s21 offen offset:1024 sc1
 buffer_load_dwordx4 v[44:47], v30, s[16:19], s21 offen offset:2048 sc1
 buffer_load_dwordx4 v[48:51], v30, s[16:19], s21 offen offset:3072 sc1
 s_add_u32 s21, s50, 4096
 buffer_load_dwordx4 v[52:55], v30, s[16:19], s21 offen offset:0 sc1
 buffer_load_dwordx4 v[56:59], v30, s[16:19], s21 offen offset:1024 sc1
 buffer_load_dwordx4 v[60:63], v30, s[16:19], s21 offen offset:2048 sc1
 buffer_load_dwordx4 v[236:239], v30, s[16:19], s21 offen offset:3072 sc1
 s_add_u32 s21, s50, 8192
 buffer_load_dwordx4 v[240:243], v30, s[16:19], s21 offen offset:0 sc1
 buffer_load_dwordx4 v[244:247], v30, s[16:19], s21 offen offset:1024 sc1
 buffer_load_dwordx4 v[248:251], v30, s[16:19], s21 offen offset:2048 sc1
 buffer_load_dwordx4 v[252:255], v30, s[16:19], s21 offen offset:3072 sc1
 s_add_u32 s21, s43, 0
 buffer_load_dwordx4 v[64:67], v30, s[12:15], s21 offen offset:0 sc1
 buffer_load_dwordx4 v[68:71], v30, s[12:15], s21 offen offset:1024 sc1
 buffer_load_dwordx4 v[72:75], v30, s[12:15], s21 offen offset:2048 sc1
 buffer_load_dwordx4 v[76:79], v30, s[12:15], s21 offen offset:3072 sc1
 s_add_u32 s21, s43, 4096
 buffer_load_dwordx4 v[80:83], v30, s[12:15], s21 offen offset:0 sc1
 buffer_load_dwordx4 v[84:87], v30, s[12:15], s21 offen offset:1024 sc1
 buffer_load_dwordx4 v[88:91], v30, s[12:15], s21 offen offset:2048 sc1
 buffer_load_dwordx4 v[92:95], v30, s[12:15], s21 offen offset:3072 sc1
 s_add_u32 s21, s43, 8192
 buffer_load_dwordx4 v[96:99], v30, s[12:15], s21 offen offset:0 sc1
 buffer_load_dwordx4 v[100:103], v30, s[12:15], s21 offen offset:1024 sc1
 buffer_load_dwordx4 v[104:107], v30, s[12:15], s21 offen offset:2048 sc1
 buffer_load_dwordx4 v[108:111], v30, s[12:15], s21 offen offset:3072 sc1
 s_waitcnt vmcnt(24)
 s_cmp_eq_u32 s78, 0
 s_cbranch_scc1 pf_228
 v_mov_b32 v4, 0
 v_mov_b32 v5, 1
 s_mov_b64 exec, 1
 buffer_atomic_add v5, v4, s[72:75], s78 offen sc1
 s_mov_b64 exec, -1
 s_mov_b32 s78, 0
pf_228:
 s_add_u32 s23, s49, 1
 v_cmp_gt_u32 vcc, s23, v21
 s_mov_b32 s80, 0
 s_nop 0
 s_cbranch_vccnz qk_227
 s_mov_b32 s80, 1
 buffer_load_dwordx4 v[132:135], v31, s[52:55], s51 offen offset:0 sc1
 buffer_load_dwordx4 v[136:139], v31, s[52:55], s51 offen offset:512 sc1
 buffer_load_dwordx4 v[140:143], v31, s[52:55], s51 offen offset:1024 sc1
 buffer_load_dwordx4 v[144:147], v31, s[52:55], s51 offen offset:1536 sc1
 buffer_load_dwordx4 v[148:151], v31, s[52:55], s51 offen offset:2048 sc1
 buffer_load_dwordx4 v[152:155], v31, s[52:55], s51 offen offset:2560 sc1
 s_waitcnt vmcnt(6)
 s_branch qk_227x
qk_227:
 s_waitcnt vmcnt(0)
qk_227x:
 v_mfma_f32_16x16x32_bf16 v[112:115], v[36:39], v[64:67], 0
 v_mfma_f32_16x16x32_bf16 v[120:123], v[36:39], v[88:91], 0
 v_mfma_f32_16x16x32_bf16 v[124:127], v[60:63], v[88:91], 0
 v_mfma_f32_16x16x32_bf16 v[112:115], v[40:43], v[68:71], v[112:115]
 v_mfma_f32_16x16x32_bf16 v[120:123], v[40:43], v[92:95], v[120:123]
 v_mfma_f32_16x16x32_bf16 v[124:127], v[236:239], v[92:95], v[124:127]
 v_mfma_f32_16x16x32_bf16 v[112:115], v[44:47], v[72:75], v[112:115]
 v_mfma_f32_16x16x32_bf16 v[120:123], v[44:47], v[96:99], v[120:123]
 v_mfma_f32_16x16x32_bf16 v[124:127], v[240:243], v[96:99], v[124:127]
 v_mfma_f32_16x16x32_bf16 v[112:115], v[48:51], v[76:79], v[112:115]
 v_mfma_f32_16x16x32_bf16 v[120:123], v[48:51], v[100:103], v[120:123]
 v_mfma_f32_16x16x32_bf16 v[124:127], v[244:247], v[100:103], v[124:127]
 v_mfma_f32_16x16x32_bf16 v[112:115], v[52:55], v[80:83], v[112:115]
 v_mfma_f32_16x16x32_bf16 v[120:123], v[52:55], v[104:107], v[120:123]
 v_mfma_f32_16x16x32_bf16 v[124:127], v[248:251], v[104:107], v[124:127]
 v_mfma_f32_16x16x32_bf16 v[112:115], v[56:59], v[84:87], v[112:115]
 v_mfma_f32_16x16x32_bf16 v[120:123], v[56:59], v[108:111], v[120:123]
 v_mfma_f32_16x16x32_bf16 v[124:127], v[252:255], v[108:111], v[124:127]
 s_cmp_eq_u32 s80, 1
 s_cbranch_scc1 qm_229
 s_add_u32 s23, s49, 1
 s_min_u32 s22, s49, 61
 s_cmp_lt_u32 s49, 56
 s_cselect_b32 s23, s23, s22
 s_mov_b32 s101, 0
wm_230:
 buffer_load_dword v156, v33, s[72:75], s77 offen sc1
 s_add_u32 s101, s101, 1
 s_cmp_gt_u32 s101, 131072
 s_cbranch_scc1 main_end
 s_waitcnt vmcnt(0)
 v_cmp_gt_u32 vcc, s23, v156
 v_readfirstlane_b32 s100, v156
 s_nop 0
 s_cbranch_vccz wm_231
 s_sleep 16
 s_add_u32 s100, s100, 2
 s_cmp_ge_u32 s100, s23
 s_cbranch_scc1 wm_230
 s_sleep 90
 s_branch wm_230
wm_231:
 s_cmp_eq_u32 s49, 63
 s_cselect_b32 s21, s101, 0
 s_cmp_lt_u32 s21, 2
 s_cbranch_scc1 qtz_234
 s_sleep 36
qtz_234:
 s_mov_b32 s101, 0
 s_branch qtp_233
qtp_232:
 s_sleep 3
qtp_233:
 buffer_load_dwordx4 v[132:135], v31, s[52:55], s51 offen offset:0 sc1
 buffer_load_dwordx4 v[136:139], v31, s[52:55], s51 offen offset:512 sc1
 buffer_load_dwordx4 v[140:143], v31, s[52:55], s51 offen offset:1024 sc1
 buffer_load_dwordx4 v[144:147], v31, s[52:55], s51 offen offset:1536 sc1
 buffer_load_dwordx4 v[148:151], v31, s[52:55], s51 offen offset:2048 sc1
 buffer_load_dwordx4 v[152:155], v31, s[52:55], s51 offen offset:2560 sc1
 s_add_u32 s101, s101, 1
 s_cmp_gt_u32 s101, 131072
 s_cbranch_scc1 main_end
 s_waitcnt vmcnt(0)
 v_max3_u32 v156, v132, v134, v136
 v_max3_u32 v156, v156, v138, v140
 v_max3_u32 v156, v156, v142, v144
 v_max3_u32 v156, v156, v146, v148
 v_max3_u32 v156, v156, v150, v152
 v_max3_u32 v156, v156, v154, v154
 v_cmp_eq_u32 vcc, -1, v156
 s_nop 1
 s_cbranch_vccnz qtp_232
qm_229:
 s_waitcnt vmcnt(0)
 v_mfma_f32_16x16x32_bf16 v[116:119], v[132:135], v[64:67], 0
 v_mfma_f32_16x16x32_bf16 v[128:131], v[132:135], v[88:91], 0
 v_mfma_f32_16x16x32_bf16 v[116:119], v[136:139], v[68:71], v[116:119]
 v_mfma_f32_16x16x32_bf16 v[128:131], v[136:139], v[92:95], v[128:131]
 v_mfma_f32_16x16x32_bf16 v[116:119], v[140:143], v[72:75], v[116:119]
 v_mfma_f32_16x16x32_bf16 v[128:131], v[140:143], v[96:99], v[128:131]
 v_mfma_f32_16x16x32_bf16 v[116:119], v[144:147], v[76:79], v[116:119]
 v_mfma_f32_16x16x32_bf16 v[128:131], v[144:147], v[100:103], v[128:131]
 v_mfma_f32_16x16x32_bf16 v[116:119], v[148:151], v[80:83], v[116:119]
 v_mfma_f32_16x16x32_bf16 v[128:131], v[148:151], v[104:107], v[128:131]
 v_mfma_f32_16x16x32_bf16 v[116:119], v[152:155], v[84:87], v[116:119]
 v_mfma_f32_16x16x32_bf16 v[128:131], v[152:155], v[108:111], v[128:131]
qx_226:
 s_lshr_b32 s21, s49, 1
 s_bitcmp1_b32 s37, s21
 s_cselect_b32 s21, 8192, 0
 s_lshl_b32 s81, s49, 20
 s_or_b32 s81, s81, s21
 s_add_u32 s81, s81, s44
 s_lshl_b32 s82, s49, 3
 s_and_b32 s21, s42, 7
 s_add_u32 s82, s82, s21
 s_lshl_b32 s82, s82, 7
 s_add_u32 s82, s82, 23552
 v_cndmask_b32 v112, v34, v112, s[64:65]
 v_cndmask_b32 v124, v34, v124, s[64:65]
 v_cndmask_b32 v113, v34, v113, s[66:67]
 v_cndmask_b32 v125, v34, v125, s[66:67]
 v_cndmask_b32 v114, v34, v114, s[68:69]
 v_cndmask_b32 v126, v34, v126, s[68:69]
 v_cndmask_b32 v115, v34, v115, s[70:71]
 v_cndmask_b32 v127, v34, v127, s[70:71]
 v_max3_f32 v156, v112, v113, v114
 v_max3_f32 v156, v156, v115, v116
 v_max3_f32 v156, v156, v117, v118
 v_max_f32 v156, v156, v119
 v_mov_b32 v157, v156
 s_nop 1
 v_permlane32_swap_b32 v156, v157
 v_max_f32 v156, v156, v157
 v_mov_b32 v157, v156
 s_nop 1
 v_permlane16_swap_b32 v156, v157
 v_max_f32 v156, v156, v157
 v_mul_f32 v156, s83, v156
 v_fma_f32 v112, v112, s83, -v156
 v_fma_f32 v113, v113, s83, -v156
 v_fma_f32 v114, v114, s83, -v156
 v_fma_f32 v115, v115, s83, -v156
 v_fma_f32 v116, v116, s83, -v156
 v_fma_f32 v117, v117, s83, -v156
 v_fma_f32 v118, v118, s83, -v156
 v_fma_f32 v119, v119, s83, -v156
 v_exp_f32 v112, v112
 v_exp_f32 v113, v113
 v_exp_f32 v114, v114
 v_exp_f32 v115, v115
 v_exp_f32 v116, v116
 v_exp_f32 v117, v117
 v_exp_f32 v118, v118
 v_exp_f32 v119, v119
 s_nop 0
 v_add_f32 v156, v116, v117
 v_add_f32 v156, v156, v118
 v_add_f32 v156, v156, v119
 v_cndmask_b32 v156, 0, v156, s[60:61]
 v_add_f32 v156, v156, v112
 v_add_f32 v156, v156, v113
 v_add_f32 v156, v156, v114
 v_add_f32 v156, v156, v115
 v_mov_b32 v157, v156
 s_nop 1
 v_permlane32_swap_b32 v156, v157
 v_add_f32 v156, v156, v157
 v_mov_b32 v157, v156
 s_nop 1
 v_permlane16_swap_b32 v156, v157
 v_add_f32 v156, v156, v157
 v_rcp_f32 v156, v156
 s_nop 0
 v_mul_f32 v112, v112, v156
 v_mul_f32 v113, v113, v156
 v_mul_f32 v114, v114, v156
 v_mul_f32 v115, v115, v156
 v_mul_f32 v116, v116, v156
 v_mul_f32 v117, v117, v156
 v_mul_f32 v118, v118, v156
 v_mul_f32 v119, v119, v156
 v_max3_f32 v156, v120, v121, v122
 v_max3_f32 v156, v156, v123, v124
 v_max3_f32 v156, v156, v125, v126
 v_max3_f32 v156, v156, v127, v128
 v_max3_f32 v156, v156, v129, v130
 v_max_f32 v156, v156, v131
 v_mov_b32 v157, v156
 s_nop 1
 v_permlane32_swap_b32 v156, v157
 v_max_f32 v156, v156, v157
 v_mov_b32 v157, v156
 s_nop 1
 v_permlane16_swap_b32 v156, v157
 v_max_f32 v156, v156, v157
 v_mul_f32 v156, s83, v156
 v_fma_f32 v120, v120, s83, -v156
 v_fma_f32 v121, v121, s83, -v156
 v_fma_f32 v122, v122, s83, -v156
 v_fma_f32 v123, v123, s83, -v156
 v_fma_f32 v124, v124, s83, -v156
 v_fma_f32 v125, v125, s83, -v156
 v_fma_f32 v126, v126, s83, -v156
 v_fma_f32 v127, v127, s83, -v156
 v_fma_f32 v128, v128, s83, -v156
 v_fma_f32 v129, v129, s83, -v156
 v_fma_f32 v130, v130, s83, -v156
 v_fma_f32 v131, v131, s83, -v156
 v_exp_f32 v120, v120
 v_exp_f32 v121, v121
 v_exp_f32 v122, v122
 v_exp_f32 v123, v123
 v_exp_f32 v124, v124
 v_exp_f32 v125, v125
 v_exp_f32 v126, v126
 v_exp_f32 v127, v127
 v_exp_f32 v128, v128
 v_exp_f32 v129, v129
 v_exp_f32 v130, v130
 v_exp_f32 v131, v131
 s_nop 0
 v_add_f32 v156, v128, v129
 v_add_f32 v156, v156, v130
 v_add_f32 v156, v156, v131
 v_cndmask_b32 v156, 0, v156, s[60:61]
 v_add_f32 v156, v156, v120
 v_add_f32 v156, v156, v121
 v_add_f32 v156, v156, v122
 v_add_f32 v156, v156, v123
 v_add_f32 v156, v156, v124
 v_add_f32 v156, v156, v125
 v_add_f32 v156, v156, v126
 v_add_f32 v156, v156, v127
 v_mov_b32 v157, v156
 s_nop 1
 v_permlane32_swap_b32 v156, v157
 v_add_f32 v156, v156, v157
 v_mov_b32 v157, v156
 s_nop 1
 v_permlane16_swap_b32 v156, v157
 v_add_f32 v156, v156, v157
 v_rcp_f32 v156, v156
 s_nop 0
 v_mul_f32 v120, v120, v156
 v_mul_f32 v121, v121, v156
 v_mul_f32 v122, v122, v156
 v_mul_f32 v123, v123, v156
 v_mul_f32 v124, v124, v156
 v_mul_f32 v125, v125, v156
 v_mul_f32 v126, v126, v156
 v_mul_f32 v127, v127, v156
 v_mul_f32 v128, v128, v156
 v_mul_f32 v129, v129, v156
 v_mul_f32 v130, v130, v156
 v_mul_f32 v131, v131, v156
 v_cvt_pk_bf16_f32 v196, v116, v117
 v_cvt_pk_bf16_f32 v197, v118, v119
 v_cvt_pk_bf16_f32 v198, v128, v129
 v_cvt_pk_bf16_f32 v199, v130, v131
 v_cvt_pk_bf16_f32 v192, v120, v121
 v_cvt_pk_bf16_f32 v193, v122, v123
 v_cvt_pk_bf16_f32 v194, v124, v125
 v_cvt_pk_bf16_f32 v195, v126, v127
 v_cvt_pk_bf16_f32 v200, v112, v113
 v_cvt_pk_bf16_f32 v201, v114, v115
 v_permlane16_swap_b32 v196, v198
 v_permlane16_swap_b32 v197, v199
 buffer_store_dwordx4 v[192:195], v30, s[56:59], s81 offen sc1
 s_mov_b64 exec, 0xffffffff
 buffer_store_dwordx4 v[196:199], v30, s[56:59], s81 offen offset:1024 sc1
 s_mov_b64 exec, -1
 buffer_store_dwordx2 v[200:201], v32, s[56:59], s81 offen offset:1536 sc1
 s_mov_b32 s78, s82
 s_mov_b32 s81, 0x80000000
 s_mov_b32 s82, 0
 s_cmp_eq_u32 s80, 1
 s_cbranch_scc1 qd_235
 s_waitcnt vmcnt(0)
 s_cmp_eq_u32 s78, 0
 s_cbranch_scc1 pf_236
 v_mov_b32 v4, 0
 v_mov_b32 v5, 1
 s_mov_b64 exec, 1
 buffer_atomic_add v5, v4, s[72:75], s78 offen sc1
 s_mov_b64 exec, -1
 s_mov_b32 s78, 0
pf_236:
qd_235:
 s_add_u32 s49, s49, s29
qbe_225:
 s_waitcnt vmcnt(0)
 s_cmp_eq_u32 s78, 0
 s_cbranch_scc1 pf_237
 v_mov_b32 v4, 0
 v_mov_b32 v5, 1
 s_mov_b64 exec, 1
 buffer_atomic_add v5, v4, s[72:75], s78 offen sc1
 s_mov_b64 exec, -1
 s_mov_b32 s78, 0
pf_237:
 s_branch queue
q_done:
 s_and_b32 s21, s3, 3
 s_sub_u32 s22, s21, 2
 s_lshl_b32 s22, s22, 3
 s_bfe_u32 s87, s3, 0x30002
 s_add_u32 s87, s87, s22
 s_add_u32 s87, s87, 248
 s_cmp_lt_u32 s21, 2
 s_cselect_b32 s87, -1, s87
 s_sub_u32 s21, s3, 96
 s_waitcnt vmcnt(0) lgkmcnt(0)
 s_barrier
 s_branch do_opb2
queue:
 s_load_dwordx2 s[4:5], s[0:1], 96
 s_waitcnt lgkmcnt(0)
 s_mov_b32 s32, s4
 s_mov_b32 s33, s5
 s_mov_b32 s34, 256
 s_mov_b32 s35, 0x00020000
 s_waitcnt vmcnt(0) lgkmcnt(0)
 s_barrier
 s_mov_b32 s2, s85
 s_mov_b32 s85, -1
 s_cmp_lg_u32 s2, -1
 s_cbranch_scc1 queue_c
 v_mov_b32 v21, 0
 s_cmp_lg_u32 s20, 0
 s_cbranch_scc1 q_238
 v_mov_b32 v22, 80
 v_mov_b32 v23, 1
 s_mov_b64 exec, 1
 buffer_atomic_add v23, v22, s[32:35], 0 offen sc0 sc1
 s_waitcnt vmcnt(0)
queue_a:
 ds_write_b32 v21, v23
 s_waitcnt lgkmcnt(0)
 s_mov_b64 exec, -1
q_238:
queue_b:
 s_barrier
 ds_read_b32 v23, v21
 s_waitcnt lgkmcnt(0)
 v_readfirstlane_b32 s2, v23
 s_barrier
queue_c:
 s_add_u32 s21, s2, 0
 s_cmp_lt_u32 s2, 64
 s_cbranch_scc1 do_pv
 s_sub_u32 s2, s2, 64
 s_add_u32 s21, s2, 64
 s_cmp_lt_u32 s2, 20
 s_cbranch_scc1 do_pv
 s_sub_u32 s2, s2, 20
 s_add_u32 s21, s2, 104
 s_cmp_lt_u32 s2, 20
 s_cbranch_scc1 do_pv
 s_sub_u32 s2, s2, 20
 s_add_u32 s21, s2, 84
 s_cmp_lt_u32 s2, 20
 s_cbranch_scc1 do_pv
 s_sub_u32 s2, s2, 20
 s_add_u32 s21, s2, 124
 s_cmp_lt_u32 s2, 20
 s_cbranch_scc1 do_pv
 s_sub_u32 s2, s2, 20
 s_add_u32 s21, s2, 144
 s_cmp_lt_u32 s2, 104
 s_cbranch_scc1 do_pv
 s_sub_u32 s2, s2, 104
 s_branch main_fin
do_opb:
 s_mov_b32 s87, -1
do_opb2:
 s_mov_b32 s2, s21
 s_load_dwordx2 s[4:5], s[0:1], 0
 s_load_dwordx4 s[40:43], s[0:1], 72
 s_load_dwordx2 s[38:39], s[0:1], 104
 s_lshl_b32 s59, s2, 2
 s_add_u32 s59, s59, s20
 s_lshl_b32 s59, s59, 3
 v_lshlrev_b32 v4, 4, v1
 v_lshlrev_b32 v5, 2, v1
 s_waitcnt lgkmcnt(0)
 s_mov_b32 s8, s4
 s_mov_b32 s9, s5
 s_mov_b32 s10, 2621440
 s_mov_b32 s11, 0x00020000
 s_mov_b32 s12, s42
 s_mov_b32 s13, s43
 s_mov_b32 s14, 1280
 s_mov_b32 s15, 0x00020000
 s_mov_b32 s24, s40
 s_mov_b32 s25, s41
 s_mov_b32 s26, 819200
 s_mov_b32 s27, 0x00020000
 s_add_u32 s16, s38, 70713344
 s_addc_u32 s17, s39, 0
 s_mov_b32 s18, 2641920
 s_mov_b32 s19, 0x00020000
 s_add_u32 s28, s38, 81002496
 s_addc_u32 s29, s39, 0
 s_mov_b32 s30, 8192
 s_mov_b32 s31, 0x00020000
 s_add_u32 s72, s38, 81068032
 s_addc_u32 s73, s39, 0
 s_mov_b32 s74, 129024
 s_mov_b32 s75, 0x00020000
 s_mov_b32 s21, 91136
 v_mov_b32 v20, 0
 buffer_load_dword v21, v20, s[72:75], s21 offen sc1
 v_mov_b32 v29, 3277
 s_mul_i32 s21, s20, 320
 s_add_u32 s21, s21, 0
 v_add_u32 v22, s21, v1
 v_mul_u32_u24 v23, v22, v29
 v_lshrrev_b32 v23, 16, v23
 v_mul_u32_u24 v24, 20, v23
 v_sub_u32 v22, v22, v24
 v_bfe_u32 v24, v23, 3, 1
 v_lshlrev_b32 v24, 1, v24
 v_xor_b32 v22, v22, v24
 v_mul_u32_u24 v23, 1280, v23
 v_lshl_add_u32 v8, v22, 4, v23
 s_mul_i32 s21, s20, 320
 s_add_u32 s21, s21, 64
 v_add_u32 v22, s21, v1
 v_mul_u32_u24 v23, v22, v29
 v_lshrrev_b32 v23, 16, v23
 v_mul_u32_u24 v24, 20, v23
 v_sub_u32 v22, v22, v24
 v_bfe_u32 v24, v23, 3, 1
 v_lshlrev_b32 v24, 1, v24
 v_xor_b32 v22, v22, v24
 v_mul_u32_u24 v23, 1280, v23
 v_lshl_add_u32 v9, v22, 4, v23
 s_mul_i32 s21, s20, 320
 s_add_u32 s21, s21, 128
 v_add_u32 v22, s21, v1
 v_mul_u32_u24 v23, v22, v29
 v_lshrrev_b32 v23, 16, v23
 v_mul_u32_u24 v24, 20, v23
 v_sub_u32 v22, v22, v24
 v_bfe_u32 v24, v23, 3, 1
 v_lshlrev_b32 v24, 1, v24
 v_xor_b32 v22, v22, v24
 v_mul_u32_u24 v23, 1280, v23
 v_lshl_add_u32 v10, v22, 4, v23
 s_mul_i32 s21, s20, 320
 s_add_u32 s21, s21, 192
 v_add_u32 v22, s21, v1
 v_mul_u32_u24 v23, v22, v29
 v_lshrrev_b32 v23, 16, v23
 v_mul_u32_u24 v24, 20, v23
 v_sub_u32 v22, v22, v24
 v_bfe_u32 v24, v23, 3, 1
 v_lshlrev_b32 v24, 1, v24
 v_xor_b32 v22, v22, v24
 v_mul_u32_u24 v23, 1280, v23
 v_lshl_add_u32 v11, v22, 4, v23
 s_mul_i32 s21, s20, 320
 s_add_u32 s21, s21, 256
 v_add_u32 v22, s21, v1
 v_mul_u32_u24 v23, v22, v29
 v_lshrrev_b32 v23, 16, v23
 v_mul_u32_u24 v24, 20, v23
 v_sub_u32 v22, v22, v24
 v_bfe_u32 v24, v23, 3, 1
 v_lshlrev_b32 v24, 1, v24
 v_xor_b32 v22, v22, v24
 v_mul_u32_u24 v23, 1280, v23
 v_lshl_add_u32 v12, v22, 4, v23
 s_and_b32 s44, s2, 3
 s_mul_i32 s45, s44, 320
 s_mul_i32 s46, s20, 5120
 v_and_b32 v22, 1, v2
 v_mul_u32_u24 v22, 16512, v22
 v_mul_u32_u24 v23, 33024, v3
 v_lshrrev_b32 v24, 1, v2
 v_lshlrev_b32 v24, 4, v24
 v_add3_u32 v6, v22, v23, v24
 s_lshr_b32 s47, s2, 2
 s_lshl_b32 s47, s47, 2
 s_add_u32 s47, s47, s20
 s_lshl_b32 s47, s47, 1
 s_lshl_b32 s48, s47, 7
 v_lshrrev_b32 v22, 2, v2
 v_lshl_add_u32 v22, v3, 3, v22
 v_mul_u32_u24 v22, 320, v22
 v_and_b32 v23, 3, v2
 v_lshl_add_u32 v22, v23, 3, v22
 v_and_b32 v23, 1, v3
 v_lshlrev_b32 v23, 5, v23
 v_add_u32 v14, v22, v23
 v_sub_u32 v15, v22, v23
 v_add_u32 v16, 61440, v14
 v_add_u32 v17, 61440, v15
 v_add_u32 v18, 122880, v14
 v_add_u32 v19, 122880, v15
 s_add_u32 m0, s46, 0
 s_add_u32 s49, s45, 0
 s_nop 0
 buffer_load_dwordx4 v8, s[24:27], s49 offen lds
 s_add_u32 m0, s46, 1024
 s_nop 0
 buffer_load_dwordx4 v9, s[24:27], s49 offen lds
 s_add_u32 m0, s46, 2048
 s_nop 0
 buffer_load_dwordx4 v10, s[24:27], s49 offen lds
 s_add_u32 m0, s46, 3072
 s_nop 0
 buffer_load_dwordx4 v11, s[24:27], s49 offen lds
 s_add_u32 m0, s46, 4096
 s_nop 0
 buffer_load_dwordx4 v12, s[24:27], s49 offen lds
 s_add_u32 m0, s46, 20480
 s_add_u32 s49, s45, 81920
 s_nop 0
 buffer_load_dwordx4 v8, s[24:27], s49 offen lds
 s_add_u32 m0, s46, 21504
 s_nop 0
 buffer_load_dwordx4 v9, s[24:27], s49 offen lds
 s_add_u32 m0, s46, 22528
 s_nop 0
 buffer_load_dwordx4 v10, s[24:27], s49 offen lds
 s_add_u32 m0, s46, 23552
 s_nop 0
 buffer_load_dwordx4 v11, s[24:27], s49 offen lds
 s_add_u32 m0, s46, 24576
 s_nop 0
 buffer_load_dwordx4 v12, s[24:27], s49 offen lds
 s_waitcnt vmcnt(10)
 v_readfirstlane_b32 s21, v21
 s_cmp_ge_u32 s21, 64
 s_cbranch_scc1 o2_239
 s_mov_b32 s21, 91136
 v_mov_b32 v20, 0
 s_mov_b32 s101, 0
wf_240:
 buffer_load_dword v21, v20, s[72:75], s21 offen sc1
 s_add_u32 s101, s101, 1
 s_cmp_gt_u32 s101, 131072
 s_cbranch_scc1 main_end
 s_waitcnt vmcnt(0)
 v_readfirstlane_b32 s100, v21
 s_cmp_ge_u32 s100, 64
 s_cbranch_scc1 wf_241
 s_sleep 32
 s_branch wf_240
wf_241:
o2_239:
 buffer_load_dwordx4 a[0:3], v6, s[16:19], s48 offen offset:0 sc1
 buffer_load_dwordx4 a[4:7], v6, s[16:19], s48 offen offset:128 sc1
 s_add_u32 s48, s48, 132096
 buffer_load_dwordx4 a[8:11], v6, s[16:19], s48 offen offset:0 sc1
 buffer_load_dwordx4 a[12:15], v6, s[16:19], s48 offen offset:128 sc1
 s_add_u32 s48, s48, 132096
 buffer_load_dwordx4 a[16:19], v6, s[16:19], s48 offen offset:0 sc1
 buffer_load_dwordx4 a[20:23], v6, s[16:19], s48 offen offset:128 sc1
 s_add_u32 s48, s48, 132096
 buffer_load_dwordx4 a[24:27], v6, s[16:19], s48 offen offset:0 sc1
 buffer_load_dwordx4 a[28:31], v6, s[16:19], s48 offen offset:128 sc1
 s_add_u32 s48, s48, 132096
 s_add_u32 m0, s46, 40960
 s_add_u32 s49, s45, 163840
 s_nop 0
 buffer_load_dwordx4 v8, s[24:27], s49 offen lds
 s_add_u32 m0, s46, 41984
 s_nop 0
 buffer_load_dwordx4 v9, s[24:27], s49 offen lds
 s_add_u32 m0, s46, 43008
 s_nop 0
 buffer_load_dwordx4 v10, s[24:27], s49 offen lds
 s_add_u32 m0, s46, 44032
 s_nop 0
 buffer_load_dwordx4 v11, s[24:27], s49 offen lds
 s_add_u32 m0, s46, 45056
 s_nop 0
 buffer_load_dwordx4 v12, s[24:27], s49 offen lds
 buffer_load_dwordx4 a[32:35], v6, s[16:19], s48 offen offset:0 sc1
 buffer_load_dwordx4 a[36:39], v6, s[16:19], s48 offen offset:128 sc1
 s_add_u32 s48, s48, 132096
 buffer_load_dwordx4 a[40:43], v6, s[16:19], s48 offen offset:0 sc1
 buffer_load_dwordx4 a[44:47], v6, s[16:19], s48 offen offset:128 sc1
 s_add_u32 s48, s48, 132096
 s_add_u32 m0, s46, 61440
 s_add_u32 s49, s45, 245760
 s_nop 0
 buffer_load_dwordx4 v8, s[24:27], s49 offen lds
 s_add_u32 m0, s46, 62464
 s_nop 0
 buffer_load_dwordx4 v9, s[24:27], s49 offen lds
 s_add_u32 m0, s46, 63488
 s_nop 0
 buffer_load_dwordx4 v10, s[24:27], s49 offen lds
 s_add_u32 m0, s46, 64512
 s_nop 0
 buffer_load_dwordx4 v11, s[24:27], s49 offen lds
 s_add_u32 m0, s46, 65536
 s_nop 0
 buffer_load_dwordx4 v12, s[24:27], s49 offen lds
 buffer_load_dwordx4 a[48:51], v6, s[16:19], s48 offen offset:0 sc1
 buffer_load_dwordx4 a[52:55], v6, s[16:19], s48 offen offset:128 sc1
 s_add_u32 s48, s48, 132096
 buffer_load_dwordx4 a[56:59], v6, s[16:19], s48 offen offset:0 sc1
 buffer_load_dwordx4 a[60:63], v6, s[16:19], s48 offen offset:128 sc1
 s_add_u32 s48, s48, 132096
 s_add_u32 m0, s46, 81920
 s_add_u32 s49, s45, 327680
 s_nop 0
 buffer_load_dwordx4 v8, s[24:27], s49 offen lds
 s_add_u32 m0, s46, 82944
 s_nop 0
 buffer_load_dwordx4 v9, s[24:27], s49 offen lds
 s_add_u32 m0, s46, 83968
 s_nop 0
 buffer_load_dwordx4 v10, s[24:27], s49 offen lds
 s_add_u32 m0, s46, 84992
 s_nop 0
 buffer_load_dwordx4 v11, s[24:27], s49 offen lds
 s_add_u32 m0, s46, 86016
 s_nop 0
 buffer_load_dwordx4 v12, s[24:27], s49 offen lds
 buffer_load_dwordx4 a[64:67], v6, s[16:19], s48 offen offset:0 sc1
 buffer_load_dwordx4 a[68:71], v6, s[16:19], s48 offen offset:128 sc1
 s_add_u32 s48, s48, 132096
 buffer_load_dwordx4 a[72:75], v6, s[16:19], s48 offen offset:0 sc1
 buffer_load_dwordx4 a[76:79], v6, s[16:19], s48 offen offset:128 sc1
 s_add_u32 s48, s48, 132096
 s_add_u32 m0, s46, 102400
 s_add_u32 s49, s45, 409600
 s_nop 0
 buffer_load_dwordx4 v8, s[24:27], s49 offen lds
 s_add_u32 m0, s46, 103424
 s_nop 0
 buffer_load_dwordx4 v9, s[24:27], s49 offen lds
 s_add_u32 m0, s46, 104448
 s_nop 0
 buffer_load_dwordx4 v10, s[24:27], s49 offen lds
 s_add_u32 m0, s46, 105472
 s_nop 0
 buffer_load_dwordx4 v11, s[24:27], s49 offen lds
 s_add_u32 m0, s46, 106496
 s_nop 0
 buffer_load_dwordx4 v12, s[24:27], s49 offen lds
 s_add_u32 m0, s46, 122880
 s_add_u32 s49, s45, 491520
 s_nop 0
 buffer_load_dwordx4 v8, s[24:27], s49 offen lds
 s_add_u32 m0, s46, 123904
 s_nop 0
 buffer_load_dwordx4 v9, s[24:27], s49 offen lds
 s_add_u32 m0, s46, 124928
 s_nop 0
 buffer_load_dwordx4 v10, s[24:27], s49 offen lds
 s_add_u32 m0, s46, 125952
 s_nop 0
 buffer_load_dwordx4 v11, s[24:27], s49 offen lds
 s_add_u32 m0, s46, 126976
 s_nop 0
 buffer_load_dwordx4 v12, s[24:27], s49 offen lds
 s_waitcnt vmcnt(50)
 s_barrier
 ds_read_b64_tr_b16 v[144:145], v14 offset:0
 ds_read_b64_tr_b16 v[146:147], v14 offset:1280
 ds_read_b64_tr_b16 v[148:149], v15 offset:32
 ds_read_b64_tr_b16 v[150:151], v15 offset:1312
 ds_read_b64_tr_b16 v[152:153], v14 offset:64
 ds_read_b64_tr_b16 v[154:155], v14 offset:1344
 ds_read_b64_tr_b16 v[156:157], v15 offset:96
 ds_read_b64_tr_b16 v[158:159], v15 offset:1376
 ds_read_b64_tr_b16 v[160:161], v14 offset:128
 ds_read_b64_tr_b16 v[162:163], v14 offset:1408
 ds_read_b64_tr_b16 v[164:165], v15 offset:160
 ds_read_b64_tr_b16 v[166:167], v15 offset:1440
 ds_read_b64_tr_b16 v[168:169], v14 offset:192
 ds_read_b64_tr_b16 v[170:171], v14 offset:1472
 ds_read_b64_tr_b16 v[172:173], v15 offset:224
 ds_read_b64_tr_b16 v[174:175], v15 offset:1504
 ds_read_b64_tr_b16 v[176:177], v14 offset:256
 ds_read_b64_tr_b16 v[178:179], v14 offset:1536
 ds_read_b64_tr_b16 v[180:181], v15 offset:288
 ds_read_b64_tr_b16 v[182:183], v15 offset:1568
 s_waitcnt lgkmcnt(0) vmcnt(43)
 v_mfma_f32_16x16x32_bf16 v[64:67], v[144:147], a[0:3], 0
 ds_read_b64_tr_b16 v[184:185], v14 offset:10240
 ds_read_b64_tr_b16 v[186:187], v14 offset:11520
 v_mfma_f32_16x16x32_bf16 v[104:107], v[144:147], a[4:7], 0
 ds_read_b64_tr_b16 v[188:189], v15 offset:10272
 v_mfma_f32_16x16x32_bf16 v[68:71], v[148:151], a[0:3], 0
 ds_read_b64_tr_b16 v[190:191], v15 offset:11552
 v_mfma_f32_16x16x32_bf16 v[108:111], v[148:151], a[4:7], 0
 ds_read_b64_tr_b16 v[192:193], v14 offset:10304
 v_mfma_f32_16x16x32_bf16 v[72:75], v[152:155], a[0:3], 0
 ds_read_b64_tr_b16 v[194:195], v14 offset:11584
 v_mfma_f32_16x16x32_bf16 v[112:115], v[152:155], a[4:7], 0
 ds_read_b64_tr_b16 v[196:197], v15 offset:10336
 ds_read_b64_tr_b16 v[198:199], v15 offset:11616
 v_mfma_f32_16x16x32_bf16 v[76:79], v[156:159], a[0:3], 0
 ds_read_b64_tr_b16 v[200:201], v14 offset:10368
 v_mfma_f32_16x16x32_bf16 v[116:119], v[156:159], a[4:7], 0
 ds_read_b64_tr_b16 v[202:203], v14 offset:11648
 v_mfma_f32_16x16x32_bf16 v[80:83], v[160:163], a[0:3], 0
 ds_read_b64_tr_b16 v[204:205], v15 offset:10400
 v_mfma_f32_16x16x32_bf16 v[120:123], v[160:163], a[4:7], 0
 ds_read_b64_tr_b16 v[206:207], v15 offset:11680
 v_mfma_f32_16x16x32_bf16 v[84:87], v[164:167], a[0:3], 0
 ds_read_b64_tr_b16 v[208:209], v14 offset:10432
 v_mfma_f32_16x16x32_bf16 v[124:127], v[164:167], a[4:7], 0
 ds_read_b64_tr_b16 v[210:211], v14 offset:11712
 ds_read_b64_tr_b16 v[212:213], v15 offset:10464
 v_mfma_f32_16x16x32_bf16 v[88:91], v[168:171], a[0:3], 0
 ds_read_b64_tr_b16 v[214:215], v15 offset:11744
 v_mfma_f32_16x16x32_bf16 v[128:131], v[168:171], a[4:7], 0
 buffer_load_dwordx4 a[80:83], v6, s[16:19], s48 offen offset:0 sc1
 ds_read_b64_tr_b16 v[216:217], v14 offset:10496
 v_mfma_f32_16x16x32_bf16 v[92:95], v[172:175], a[0:3], 0
 ds_read_b64_tr_b16 v[218:219], v14 offset:11776
 v_mfma_f32_16x16x32_bf16 v[132:135], v[172:175], a[4:7], 0
 ds_read_b64_tr_b16 v[220:221], v15 offset:10528
 v_mfma_f32_16x16x32_bf16 v[96:99], v[176:179], a[0:3], 0
 ds_read_b64_tr_b16 v[222:223], v15 offset:11808
 v_mfma_f32_16x16x32_bf16 v[136:139], v[176:179], a[4:7], 0
 buffer_load_dwordx4 a[84:87], v6, s[16:19], s48 offen offset:128 sc1
 v_mfma_f32_16x16x32_bf16 v[100:103], v[180:183], a[0:3], 0
 s_add_u32 s48, s48, 132096
 v_mfma_f32_16x16x32_bf16 v[140:143], v[180:183], a[4:7], 0
 s_waitcnt lgkmcnt(0) vmcnt(43)
 s_barrier
 v_mfma_f32_16x16x32_bf16 v[64:67], v[184:187], a[8:11], v[64:67]
 s_add_u32 m0, s46, 0
 ds_read_b64_tr_b16 v[144:145], v14 offset:20480
 ds_read_b64_tr_b16 v[146:147], v14 offset:21760
 v_mfma_f32_16x16x32_bf16 v[104:107], v[184:187], a[12:15], v[104:107]
 s_add_u32 s49, s45, 573440
 ds_read_b64_tr_b16 v[148:149], v15 offset:20512
 v_mfma_f32_16x16x32_bf16 v[68:71], v[188:191], a[8:11], v[68:71]
 buffer_load_dwordx4 v8, s[24:27], s49 offen lds
 ds_read_b64_tr_b16 v[150:151], v15 offset:21792
 v_mfma_f32_16x16x32_bf16 v[108:111], v[188:191], a[12:15], v[108:111]
 s_add_u32 m0, s46, 1024
 ds_read_b64_tr_b16 v[152:153], v14 offset:20544
 v_mfma_f32_16x16x32_bf16 v[72:75], v[192:195], a[8:11], v[72:75]
 buffer_load_dwordx4 v9, s[24:27], s49 offen lds
 ds_read_b64_tr_b16 v[154:155], v14 offset:21824
 v_mfma_f32_16x16x32_bf16 v[112:115], v[192:195], a[12:15], v[112:115]
 s_add_u32 m0, s46, 2048
 ds_read_b64_tr_b16 v[156:157], v15 offset:20576
 ds_read_b64_tr_b16 v[158:159], v15 offset:21856
 v_mfma_f32_16x16x32_bf16 v[76:79], v[196:199], a[8:11], v[76:79]
 buffer_load_dwordx4 v10, s[24:27], s49 offen lds
 ds_read_b64_tr_b16 v[160:161], v14 offset:20608
 v_mfma_f32_16x16x32_bf16 v[116:119], v[196:199], a[12:15], v[116:119]
 s_add_u32 m0, s46, 3072
 ds_read_b64_tr_b16 v[162:163], v14 offset:21888
 v_mfma_f32_16x16x32_bf16 v[80:83], v[200:203], a[8:11], v[80:83]
 buffer_load_dwordx4 v11, s[24:27], s49 offen lds
 ds_read_b64_tr_b16 v[164:165], v15 offset:20640
 v_mfma_f32_16x16x32_bf16 v[120:123], v[200:203], a[12:15], v[120:123]
 s_add_u32 m0, s46, 4096
 ds_read_b64_tr_b16 v[166:167], v15 offset:21920
 v_mfma_f32_16x16x32_bf16 v[84:87], v[204:207], a[8:11], v[84:87]
 buffer_load_dwordx4 v12, s[24:27], s49 offen lds
 ds_read_b64_tr_b16 v[168:169], v14 offset:20672
 v_mfma_f32_16x16x32_bf16 v[124:127], v[204:207], a[12:15], v[124:127]
 ds_read_b64_tr_b16 v[170:171], v14 offset:21952
 ds_read_b64_tr_b16 v[172:173], v15 offset:20704
 v_mfma_f32_16x16x32_bf16 v[88:91], v[208:211], a[8:11], v[88:91]
 ds_read_b64_tr_b16 v[174:175], v15 offset:21984
 v_mfma_f32_16x16x32_bf16 v[128:131], v[208:211], a[12:15], v[128:131]
 buffer_load_dwordx4 a[88:91], v6, s[16:19], s48 offen offset:0 sc1
 ds_read_b64_tr_b16 v[176:177], v14 offset:20736
 v_mfma_f32_16x16x32_bf16 v[92:95], v[212:215], a[8:11], v[92:95]
 ds_read_b64_tr_b16 v[178:179], v14 offset:22016
 v_mfma_f32_16x16x32_bf16 v[132:135], v[212:215], a[12:15], v[132:135]
 ds_read_b64_tr_b16 v[180:181], v15 offset:20768
 v_mfma_f32_16x16x32_bf16 v[96:99], v[216:219], a[8:11], v[96:99]
 ds_read_b64_tr_b16 v[182:183], v15 offset:22048
 v_mfma_f32_16x16x32_bf16 v[136:139], v[216:219], a[12:15], v[136:139]
 buffer_load_dwordx4 a[92:95], v6, s[16:19], s48 offen offset:128 sc1
 v_mfma_f32_16x16x32_bf16 v[100:103], v[220:223], a[8:11], v[100:103]
 s_add_u32 s48, s48, 132096
 v_mfma_f32_16x16x32_bf16 v[140:143], v[220:223], a[12:15], v[140:143]
 s_waitcnt lgkmcnt(0) vmcnt(48)
 v_mfma_f32_16x16x32_bf16 v[64:67], v[144:147], a[16:19], v[64:67]
 ds_read_b64_tr_b16 v[184:185], v14 offset:30720
 ds_read_b64_tr_b16 v[186:187], v14 offset:32000
 v_mfma_f32_16x16x32_bf16 v[104:107], v[144:147], a[20:23], v[104:107]
 ds_read_b64_tr_b16 v[188:189], v15 offset:30752
 v_mfma_f32_16x16x32_bf16 v[68:71], v[148:151], a[16:19], v[68:71]
 ds_read_b64_tr_b16 v[190:191], v15 offset:32032
 v_mfma_f32_16x16x32_bf16 v[108:111], v[148:151], a[20:23], v[108:111]
 ds_read_b64_tr_b16 v[192:193], v14 offset:30784
 v_mfma_f32_16x16x32_bf16 v[72:75], v[152:155], a[16:19], v[72:75]
 ds_read_b64_tr_b16 v[194:195], v14 offset:32064
 v_mfma_f32_16x16x32_bf16 v[112:115], v[152:155], a[20:23], v[112:115]
 ds_read_b64_tr_b16 v[196:197], v15 offset:30816
 ds_read_b64_tr_b16 v[198:199], v15 offset:32096
 v_mfma_f32_16x16x32_bf16 v[76:79], v[156:159], a[16:19], v[76:79]
 ds_read_b64_tr_b16 v[200:201], v14 offset:30848
 v_mfma_f32_16x16x32_bf16 v[116:119], v[156:159], a[20:23], v[116:119]
 ds_read_b64_tr_b16 v[202:203], v14 offset:32128
 v_mfma_f32_16x16x32_bf16 v[80:83], v[160:163], a[16:19], v[80:83]
 ds_read_b64_tr_b16 v[204:205], v15 offset:30880
 v_mfma_f32_16x16x32_bf16 v[120:123], v[160:163], a[20:23], v[120:123]
 ds_read_b64_tr_b16 v[206:207], v15 offset:32160
 v_mfma_f32_16x16x32_bf16 v[84:87], v[164:167], a[16:19], v[84:87]
 ds_read_b64_tr_b16 v[208:209], v14 offset:30912
 v_mfma_f32_16x16x32_bf16 v[124:127], v[164:167], a[20:23], v[124:127]
 ds_read_b64_tr_b16 v[210:211], v14 offset:32192
 ds_read_b64_tr_b16 v[212:213], v15 offset:30944
 v_mfma_f32_16x16x32_bf16 v[88:91], v[168:171], a[16:19], v[88:91]
 ds_read_b64_tr_b16 v[214:215], v15 offset:32224
 v_mfma_f32_16x16x32_bf16 v[128:131], v[168:171], a[20:23], v[128:131]
 buffer_load_dwordx4 a[96:99], v6, s[16:19], s48 offen offset:0 sc1
 ds_read_b64_tr_b16 v[216:217], v14 offset:30976
 v_mfma_f32_16x16x32_bf16 v[92:95], v[172:175], a[16:19], v[92:95]
 ds_read_b64_tr_b16 v[218:219], v14 offset:32256
 v_mfma_f32_16x16x32_bf16 v[132:135], v[172:175], a[20:23], v[132:135]
 ds_read_b64_tr_b16 v[220:221], v15 offset:31008
 v_mfma_f32_16x16x32_bf16 v[96:99], v[176:179], a[16:19], v[96:99]
 ds_read_b64_tr_b16 v[222:223], v15 offset:32288
 v_mfma_f32_16x16x32_bf16 v[136:139], v[176:179], a[20:23], v[136:139]
 buffer_load_dwordx4 a[100:103], v6, s[16:19], s48 offen offset:128 sc1
 v_mfma_f32_16x16x32_bf16 v[100:103], v[180:183], a[16:19], v[100:103]
 s_add_u32 s48, s48, 132096
 v_mfma_f32_16x16x32_bf16 v[140:143], v[180:183], a[20:23], v[140:143]
 s_waitcnt lgkmcnt(0) vmcnt(43)
 s_barrier
 v_mfma_f32_16x16x32_bf16 v[64:67], v[184:187], a[24:27], v[64:67]
 s_add_u32 m0, s46, 20480
 ds_read_b64_tr_b16 v[144:145], v14 offset:40960
 ds_read_b64_tr_b16 v[146:147], v14 offset:42240
 v_mfma_f32_16x16x32_bf16 v[104:107], v[184:187], a[28:31], v[104:107]
 s_add_u32 s49, s45, 655360
 ds_read_b64_tr_b16 v[148:149], v15 offset:40992
 v_mfma_f32_16x16x32_bf16 v[68:71], v[188:191], a[24:27], v[68:71]
 buffer_load_dwordx4 v8, s[24:27], s49 offen lds
 ds_read_b64_tr_b16 v[150:151], v15 offset:42272
 v_mfma_f32_16x16x32_bf16 v[108:111], v[188:191], a[28:31], v[108:111]
 s_add_u32 m0, s46, 21504
 ds_read_b64_tr_b16 v[152:153], v14 offset:41024
 v_mfma_f32_16x16x32_bf16 v[72:75], v[192:195], a[24:27], v[72:75]
 buffer_load_dwordx4 v9, s[24:27], s49 offen lds
 ds_read_b64_tr_b16 v[154:155], v14 offset:42304
 v_mfma_f32_16x16x32_bf16 v[112:115], v[192:195], a[28:31], v[112:115]
 s_add_u32 m0, s46, 22528
 ds_read_b64_tr_b16 v[156:157], v15 offset:41056
 ds_read_b64_tr_b16 v[158:159], v15 offset:42336
 v_mfma_f32_16x16x32_bf16 v[76:79], v[196:199], a[24:27], v[76:79]
 buffer_load_dwordx4 v10, s[24:27], s49 offen lds
 ds_read_b64_tr_b16 v[160:161], v14 offset:41088
 v_mfma_f32_16x16x32_bf16 v[116:119], v[196:199], a[28:31], v[116:119]
 s_add_u32 m0, s46, 23552
 ds_read_b64_tr_b16 v[162:163], v14 offset:42368
 v_mfma_f32_16x16x32_bf16 v[80:83], v[200:203], a[24:27], v[80:83]
 buffer_load_dwordx4 v11, s[24:27], s49 offen lds
 ds_read_b64_tr_b16 v[164:165], v15 offset:41120
 v_mfma_f32_16x16x32_bf16 v[120:123], v[200:203], a[28:31], v[120:123]
 s_add_u32 m0, s46, 24576
 ds_read_b64_tr_b16 v[166:167], v15 offset:42400
 v_mfma_f32_16x16x32_bf16 v[84:87], v[204:207], a[24:27], v[84:87]
 buffer_load_dwordx4 v12, s[24:27], s49 offen lds
 ds_read_b64_tr_b16 v[168:169], v14 offset:41152
 v_mfma_f32_16x16x32_bf16 v[124:127], v[204:207], a[28:31], v[124:127]
 ds_read_b64_tr_b16 v[170:171], v14 offset:42432
 ds_read_b64_tr_b16 v[172:173], v15 offset:41184
 v_mfma_f32_16x16x32_bf16 v[88:91], v[208:211], a[24:27], v[88:91]
 ds_read_b64_tr_b16 v[174:175], v15 offset:42464
 v_mfma_f32_16x16x32_bf16 v[128:131], v[208:211], a[28:31], v[128:131]
 buffer_load_dwordx4 a[104:107], v6, s[16:19], s48 offen offset:0 sc1
 ds_read_b64_tr_b16 v[176:177], v14 offset:41216
 v_mfma_f32_16x16x32_bf16 v[92:95], v[212:215], a[24:27], v[92:95]
 ds_read_b64_tr_b16 v[178:179], v14 offset:42496
 v_mfma_f32_16x16x32_bf16 v[132:135], v[212:215], a[28:31], v[132:135]
 ds_read_b64_tr_b16 v[180:181], v15 offset:41248
 v_mfma_f32_16x16x32_bf16 v[96:99], v[216:219], a[24:27], v[96:99]
 ds_read_b64_tr_b16 v[182:183], v15 offset:42528
 v_mfma_f32_16x16x32_bf16 v[136:139], v[216:219], a[28:31], v[136:139]
 buffer_load_dwordx4 a[108:111], v6, s[16:19], s48 offen offset:128 sc1
 v_mfma_f32_16x16x32_bf16 v[100:103], v[220:223], a[24:27], v[100:103]
 s_add_u32 s48, s48, 132096
 v_mfma_f32_16x16x32_bf16 v[140:143], v[220:223], a[28:31], v[140:143]
 s_waitcnt lgkmcnt(0) vmcnt(48)
 v_mfma_f32_16x16x32_bf16 v[64:67], v[144:147], a[32:35], v[64:67]
 ds_read_b64_tr_b16 v[184:185], v14 offset:51200
 ds_read_b64_tr_b16 v[186:187], v14 offset:52480
 v_mfma_f32_16x16x32_bf16 v[104:107], v[144:147], a[36:39], v[104:107]
 ds_read_b64_tr_b16 v[188:189], v15 offset:51232
 v_mfma_f32_16x16x32_bf16 v[68:71], v[148:151], a[32:35], v[68:71]
 ds_read_b64_tr_b16 v[190:191], v15 offset:52512
 v_mfma_f32_16x16x32_bf16 v[108:111], v[148:151], a[36:39], v[108:111]
 ds_read_b64_tr_b16 v[192:193], v14 offset:51264
 v_mfma_f32_16x16x32_bf16 v[72:75], v[152:155], a[32:35], v[72:75]
 ds_read_b64_tr_b16 v[194:195], v14 offset:52544
 v_mfma_f32_16x16x32_bf16 v[112:115], v[152:155], a[36:39], v[112:115]
 ds_read_b64_tr_b16 v[196:197], v15 offset:51296
 ds_read_b64_tr_b16 v[198:199], v15 offset:52576
 v_mfma_f32_16x16x32_bf16 v[76:79], v[156:159], a[32:35], v[76:79]
 ds_read_b64_tr_b16 v[200:201], v14 offset:51328
 v_mfma_f32_16x16x32_bf16 v[116:119], v[156:159], a[36:39], v[116:119]
 ds_read_b64_tr_b16 v[202:203], v14 offset:52608
 v_mfma_f32_16x16x32_bf16 v[80:83], v[160:163], a[32:35], v[80:83]
 ds_read_b64_tr_b16 v[204:205], v15 offset:51360
 v_mfma_f32_16x16x32_bf16 v[120:123], v[160:163], a[36:39], v[120:123]
 ds_read_b64_tr_b16 v[206:207], v15 offset:52640
 v_mfma_f32_16x16x32_bf16 v[84:87], v[164:167], a[32:35], v[84:87]
 ds_read_b64_tr_b16 v[208:209], v14 offset:51392
 v_mfma_f32_16x16x32_bf16 v[124:127], v[164:167], a[36:39], v[124:127]
 ds_read_b64_tr_b16 v[210:211], v14 offset:52672
 ds_read_b64_tr_b16 v[212:213], v15 offset:51424
 v_mfma_f32_16x16x32_bf16 v[88:91], v[168:171], a[32:35], v[88:91]
 ds_read_b64_tr_b16 v[214:215], v15 offset:52704
 v_mfma_f32_16x16x32_bf16 v[128:131], v[168:171], a[36:39], v[128:131]
 buffer_load_dwordx4 a[112:115], v6, s[16:19], s48 offen offset:0 sc1
 ds_read_b64_tr_b16 v[216:217], v14 offset:51456
 v_mfma_f32_16x16x32_bf16 v[92:95], v[172:175], a[32:35], v[92:95]
 ds_read_b64_tr_b16 v[218:219], v14 offset:52736
 v_mfma_f32_16x16x32_bf16 v[132:135], v[172:175], a[36:39], v[132:135]
 ds_read_b64_tr_b16 v[220:221], v15 offset:51488
 v_mfma_f32_16x16x32_bf16 v[96:99], v[176:179], a[32:35], v[96:99]
 ds_read_b64_tr_b16 v[222:223], v15 offset:52768
 v_mfma_f32_16x16x32_bf16 v[136:139], v[176:179], a[36:39], v[136:139]
 buffer_load_dwordx4 a[116:119], v6, s[16:19], s48 offen offset:128 sc1
 v_mfma_f32_16x16x32_bf16 v[100:103], v[180:183], a[32:35], v[100:103]
 s_add_u32 s48, s48, 132096
 v_mfma_f32_16x16x32_bf16 v[140:143], v[180:183], a[36:39], v[140:143]
 s_waitcnt lgkmcnt(0) vmcnt(43)
 s_barrier
 v_mfma_f32_16x16x32_bf16 v[64:67], v[184:187], a[40:43], v[64:67]
 s_add_u32 m0, s46, 40960
 ds_read_b64_tr_b16 v[144:145], v16 offset:0
 ds_read_b64_tr_b16 v[146:147], v16 offset:1280
 v_mfma_f32_16x16x32_bf16 v[104:107], v[184:187], a[44:47], v[104:107]
 s_add_u32 s49, s45, 737280
 ds_read_b64_tr_b16 v[148:149], v17 offset:32
 v_mfma_f32_16x16x32_bf16 v[68:71], v[188:191], a[40:43], v[68:71]
 buffer_load_dwordx4 v8, s[24:27], s49 offen lds
 ds_read_b64_tr_b16 v[150:151], v17 offset:1312
 v_mfma_f32_16x16x32_bf16 v[108:111], v[188:191], a[44:47], v[108:111]
 s_add_u32 m0, s46, 41984
 ds_read_b64_tr_b16 v[152:153], v16 offset:64
 v_mfma_f32_16x16x32_bf16 v[72:75], v[192:195], a[40:43], v[72:75]
 buffer_load_dwordx4 v9, s[24:27], s49 offen lds
 ds_read_b64_tr_b16 v[154:155], v16 offset:1344
 v_mfma_f32_16x16x32_bf16 v[112:115], v[192:195], a[44:47], v[112:115]
 s_add_u32 m0, s46, 43008
 ds_read_b64_tr_b16 v[156:157], v17 offset:96
 ds_read_b64_tr_b16 v[158:159], v17 offset:1376
 v_mfma_f32_16x16x32_bf16 v[76:79], v[196:199], a[40:43], v[76:79]
 buffer_load_dwordx4 v10, s[24:27], s49 offen lds
 ds_read_b64_tr_b16 v[160:161], v16 offset:128
 v_mfma_f32_16x16x32_bf16 v[116:119], v[196:199], a[44:47], v[116:119]
 s_add_u32 m0, s46, 44032
 ds_read_b64_tr_b16 v[162:163], v16 offset:1408
 v_mfma_f32_16x16x32_bf16 v[80:83], v[200:203], a[40:43], v[80:83]
 buffer_load_dwordx4 v11, s[24:27], s49 offen lds
 ds_read_b64_tr_b16 v[164:165], v17 offset:160
 v_mfma_f32_16x16x32_bf16 v[120:123], v[200:203], a[44:47], v[120:123]
 s_add_u32 m0, s46, 45056
 ds_read_b64_tr_b16 v[166:167], v17 offset:1440
 v_mfma_f32_16x16x32_bf16 v[84:87], v[204:207], a[40:43], v[84:87]
 buffer_load_dwordx4 v12, s[24:27], s49 offen lds
 ds_read_b64_tr_b16 v[168:169], v16 offset:192
 v_mfma_f32_16x16x32_bf16 v[124:127], v[204:207], a[44:47], v[124:127]
 ds_read_b64_tr_b16 v[170:171], v16 offset:1472
 ds_read_b64_tr_b16 v[172:173], v17 offset:224
 v_mfma_f32_16x16x32_bf16 v[88:91], v[208:211], a[40:43], v[88:91]
 ds_read_b64_tr_b16 v[174:175], v17 offset:1504
 v_mfma_f32_16x16x32_bf16 v[128:131], v[208:211], a[44:47], v[128:131]
 buffer_load_dwordx4 a[120:123], v6, s[16:19], s48 offen offset:0 sc1
 ds_read_b64_tr_b16 v[176:177], v16 offset:256
 v_mfma_f32_16x16x32_bf16 v[92:95], v[212:215], a[40:43], v[92:95]
 ds_read_b64_tr_b16 v[178:179], v16 offset:1536
 v_mfma_f32_16x16x32_bf16 v[132:135], v[212:215], a[44:47], v[132:135]
 ds_read_b64_tr_b16 v[180:181], v17 offset:288
 v_mfma_f32_16x16x32_bf16 v[96:99], v[216:219], a[40:43], v[96:99]
 ds_read_b64_tr_b16 v[182:183], v17 offset:1568
 v_mfma_f32_16x16x32_bf16 v[136:139], v[216:219], a[44:47], v[136:139]
 buffer_load_dwordx4 a[124:127], v6, s[16:19], s48 offen offset:128 sc1
 v_mfma_f32_16x16x32_bf16 v[100:103], v[220:223], a[40:43], v[100:103]
 s_add_u32 s48, s48, 132096
 v_mfma_f32_16x16x32_bf16 v[140:143], v[220:223], a[44:47], v[140:143]
 s_waitcnt lgkmcnt(0) vmcnt(48)
 v_mfma_f32_16x16x32_bf16 v[64:67], v[144:147], a[48:51], v[64:67]
 ds_read_b64_tr_b16 v[184:185], v16 offset:10240
 ds_read_b64_tr_b16 v[186:187], v16 offset:11520
 v_mfma_f32_16x16x32_bf16 v[104:107], v[144:147], a[52:55], v[104:107]
 ds_read_b64_tr_b16 v[188:189], v17 offset:10272
 v_mfma_f32_16x16x32_bf16 v[68:71], v[148:151], a[48:51], v[68:71]
 ds_read_b64_tr_b16 v[190:191], v17 offset:11552
 v_mfma_f32_16x16x32_bf16 v[108:111], v[148:151], a[52:55], v[108:111]
 ds_read_b64_tr_b16 v[192:193], v16 offset:10304
 v_mfma_f32_16x16x32_bf16 v[72:75], v[152:155], a[48:51], v[72:75]
 ds_read_b64_tr_b16 v[194:195], v16 offset:11584
 v_mfma_f32_16x16x32_bf16 v[112:115], v[152:155], a[52:55], v[112:115]
 ds_read_b64_tr_b16 v[196:197], v17 offset:10336
 ds_read_b64_tr_b16 v[198:199], v17 offset:11616
 v_mfma_f32_16x16x32_bf16 v[76:79], v[156:159], a[48:51], v[76:79]
 ds_read_b64_tr_b16 v[200:201], v16 offset:10368
 v_mfma_f32_16x16x32_bf16 v[116:119], v[156:159], a[52:55], v[116:119]
 ds_read_b64_tr_b16 v[202:203], v16 offset:11648
 v_mfma_f32_16x16x32_bf16 v[80:83], v[160:163], a[48:51], v[80:83]
 ds_read_b64_tr_b16 v[204:205], v17 offset:10400
 v_mfma_f32_16x16x32_bf16 v[120:123], v[160:163], a[52:55], v[120:123]
 ds_read_b64_tr_b16 v[206:207], v17 offset:11680
 v_mfma_f32_16x16x32_bf16 v[84:87], v[164:167], a[48:51], v[84:87]
 ds_read_b64_tr_b16 v[208:209], v16 offset:10432
 v_mfma_f32_16x16x32_bf16 v[124:127], v[164:167], a[52:55], v[124:127]
 ds_read_b64_tr_b16 v[210:211], v16 offset:11712
 ds_read_b64_tr_b16 v[212:213], v17 offset:10464
 v_mfma_f32_16x16x32_bf16 v[88:91], v[168:171], a[48:51], v[88:91]
 ds_read_b64_tr_b16 v[214:215], v17 offset:11744
 v_mfma_f32_16x16x32_bf16 v[128:131], v[168:171], a[52:55], v[128:131]
 buffer_load_dwordx4 a[128:131], v6, s[16:19], s48 offen offset:0 sc1
 ds_read_b64_tr_b16 v[216:217], v16 offset:10496
 v_mfma_f32_16x16x32_bf16 v[92:95], v[172:175], a[48:51], v[92:95]
 ds_read_b64_tr_b16 v[218:219], v16 offset:11776
 v_mfma_f32_16x16x32_bf16 v[132:135], v[172:175], a[52:55], v[132:135]
 ds_read_b64_tr_b16 v[220:221], v17 offset:10528
 v_mfma_f32_16x16x32_bf16 v[96:99], v[176:179], a[48:51], v[96:99]
 ds_read_b64_tr_b16 v[222:223], v17 offset:11808
 v_mfma_f32_16x16x32_bf16 v[136:139], v[176:179], a[52:55], v[136:139]
 buffer_load_dwordx4 a[132:135], v6, s[16:19], s48 offen offset:128 sc1
 v_mfma_f32_16x16x32_bf16 v[100:103], v[180:183], a[48:51], v[100:103]
 s_add_u32 s48, s48, 132096
 v_mfma_f32_16x16x32_bf16 v[140:143], v[180:183], a[52:55], v[140:143]
 s_waitcnt lgkmcnt(0) vmcnt(43)
 s_barrier
 v_mfma_f32_16x16x32_bf16 v[64:67], v[184:187], a[56:59], v[64:67]
 ds_read_b64_tr_b16 v[144:145], v16 offset:20480
 ds_read_b64_tr_b16 v[146:147], v16 offset:21760
 v_mfma_f32_16x16x32_bf16 v[104:107], v[184:187], a[60:63], v[104:107]
 ds_read_b64_tr_b16 v[148:149], v17 offset:20512
 v_mfma_f32_16x16x32_bf16 v[68:71], v[188:191], a[56:59], v[68:71]
 ds_read_b64_tr_b16 v[150:151], v17 offset:21792
 v_mfma_f32_16x16x32_bf16 v[108:111], v[188:191], a[60:63], v[108:111]
 ds_read_b64_tr_b16 v[152:153], v16 offset:20544
 v_mfma_f32_16x16x32_bf16 v[72:75], v[192:195], a[56:59], v[72:75]
 ds_read_b64_tr_b16 v[154:155], v16 offset:21824
 v_mfma_f32_16x16x32_bf16 v[112:115], v[192:195], a[60:63], v[112:115]
 ds_read_b64_tr_b16 v[156:157], v17 offset:20576
 ds_read_b64_tr_b16 v[158:159], v17 offset:21856
 v_mfma_f32_16x16x32_bf16 v[76:79], v[196:199], a[56:59], v[76:79]
 ds_read_b64_tr_b16 v[160:161], v16 offset:20608
 v_mfma_f32_16x16x32_bf16 v[116:119], v[196:199], a[60:63], v[116:119]
 ds_read_b64_tr_b16 v[162:163], v16 offset:21888
 v_mfma_f32_16x16x32_bf16 v[80:83], v[200:203], a[56:59], v[80:83]
 ds_read_b64_tr_b16 v[164:165], v17 offset:20640
 v_mfma_f32_16x16x32_bf16 v[120:123], v[200:203], a[60:63], v[120:123]
 ds_read_b64_tr_b16 v[166:167], v17 offset:21920
 v_mfma_f32_16x16x32_bf16 v[84:87], v[204:207], a[56:59], v[84:87]
 ds_read_b64_tr_b16 v[168:169], v16 offset:20672
 v_mfma_f32_16x16x32_bf16 v[124:127], v[204:207], a[60:63], v[124:127]
 ds_read_b64_tr_b16 v[170:171], v16 offset:21952
 ds_read_b64_tr_b16 v[172:173], v17 offset:20704
 v_mfma_f32_16x16x32_bf16 v[88:91], v[208:211], a[56:59], v[88:91]
 ds_read_b64_tr_b16 v[174:175], v17 offset:21984
 v_mfma_f32_16x16x32_bf16 v[128:131], v[208:211], a[60:63], v[128:131]
 buffer_load_dwordx4 a[136:139], v6, s[16:19], s48 offen offset:0 sc1
 ds_read_b64_tr_b16 v[176:177], v16 offset:20736
 v_mfma_f32_16x16x32_bf16 v[92:95], v[212:215], a[56:59], v[92:95]
 ds_read_b64_tr_b16 v[178:179], v16 offset:22016
 v_mfma_f32_16x16x32_bf16 v[132:135], v[212:215], a[60:63], v[132:135]
 ds_read_b64_tr_b16 v[180:181], v17 offset:20768
 v_mfma_f32_16x16x32_bf16 v[96:99], v[216:219], a[56:59], v[96:99]
 ds_read_b64_tr_b16 v[182:183], v17 offset:22048
 v_mfma_f32_16x16x32_bf16 v[136:139], v[216:219], a[60:63], v[136:139]
 buffer_load_dwordx4 a[140:143], v6, s[16:19], s48 offen offset:128 sc1
 v_mfma_f32_16x16x32_bf16 v[100:103], v[220:223], a[56:59], v[100:103]
 s_add_u32 s48, s48, 132096
 v_mfma_f32_16x16x32_bf16 v[140:143], v[220:223], a[60:63], v[140:143]
 s_waitcnt lgkmcnt(0) vmcnt(43)
 v_mfma_f32_16x16x32_bf16 v[64:67], v[144:147], a[64:67], v[64:67]
 ds_read_b64_tr_b16 v[184:185], v16 offset:30720
 ds_read_b64_tr_b16 v[186:187], v16 offset:32000
 v_mfma_f32_16x16x32_bf16 v[104:107], v[144:147], a[68:71], v[104:107]
 ds_read_b64_tr_b16 v[188:189], v17 offset:30752
 v_mfma_f32_16x16x32_bf16 v[68:71], v[148:151], a[64:67], v[68:71]
 ds_read_b64_tr_b16 v[190:191], v17 offset:32032
 v_mfma_f32_16x16x32_bf16 v[108:111], v[148:151], a[68:71], v[108:111]
 ds_read_b64_tr_b16 v[192:193], v16 offset:30784
 v_mfma_f32_16x16x32_bf16 v[72:75], v[152:155], a[64:67], v[72:75]
 ds_read_b64_tr_b16 v[194:195], v16 offset:32064
 v_mfma_f32_16x16x32_bf16 v[112:115], v[152:155], a[68:71], v[112:115]
 ds_read_b64_tr_b16 v[196:197], v17 offset:30816
 ds_read_b64_tr_b16 v[198:199], v17 offset:32096
 v_mfma_f32_16x16x32_bf16 v[76:79], v[156:159], a[64:67], v[76:79]
 ds_read_b64_tr_b16 v[200:201], v16 offset:30848
 v_mfma_f32_16x16x32_bf16 v[116:119], v[156:159], a[68:71], v[116:119]
 ds_read_b64_tr_b16 v[202:203], v16 offset:32128
 v_mfma_f32_16x16x32_bf16 v[80:83], v[160:163], a[64:67], v[80:83]
 ds_read_b64_tr_b16 v[204:205], v17 offset:30880
 v_mfma_f32_16x16x32_bf16 v[120:123], v[160:163], a[68:71], v[120:123]
 ds_read_b64_tr_b16 v[206:207], v17 offset:32160
 v_mfma_f32_16x16x32_bf16 v[84:87], v[164:167], a[64:67], v[84:87]
 ds_read_b64_tr_b16 v[208:209], v16 offset:30912
 v_mfma_f32_16x16x32_bf16 v[124:127], v[164:167], a[68:71], v[124:127]
 ds_read_b64_tr_b16 v[210:211], v16 offset:32192
 ds_read_b64_tr_b16 v[212:213], v17 offset:30944
 v_mfma_f32_16x16x32_bf16 v[88:91], v[168:171], a[64:67], v[88:91]
 ds_read_b64_tr_b16 v[214:215], v17 offset:32224
 v_mfma_f32_16x16x32_bf16 v[128:131], v[168:171], a[68:71], v[128:131]
 buffer_load_dwordx4 a[144:147], v6, s[16:19], s48 offen offset:0 sc1
 ds_read_b64_tr_b16 v[216:217], v16 offset:30976
 v_mfma_f32_16x16x32_bf16 v[92:95], v[172:175], a[64:67], v[92:95]
 ds_read_b64_tr_b16 v[218:219], v16 offset:32256
 v_mfma_f32_16x16x32_bf16 v[132:135], v[172:175], a[68:71], v[132:135]
 ds_read_b64_tr_b16 v[220:221], v17 offset:31008
 v_mfma_f32_16x16x32_bf16 v[96:99], v[176:179], a[64:67], v[96:99]
 ds_read_b64_tr_b16 v[222:223], v17 offset:32288
 v_mfma_f32_16x16x32_bf16 v[136:139], v[176:179], a[68:71], v[136:139]
 buffer_load_dwordx4 a[148:151], v6, s[16:19], s48 offen offset:128 sc1
 v_mfma_f32_16x16x32_bf16 v[100:103], v[180:183], a[64:67], v[100:103]
 s_add_u32 s48, s48, 132096
 v_mfma_f32_16x16x32_bf16 v[140:143], v[180:183], a[68:71], v[140:143]
 s_waitcnt lgkmcnt(0) vmcnt(38)
 s_barrier
 v_mfma_f32_16x16x32_bf16 v[64:67], v[184:187], a[72:75], v[64:67]
 ds_read_b64_tr_b16 v[144:145], v16 offset:40960
 ds_read_b64_tr_b16 v[146:147], v16 offset:42240
 v_mfma_f32_16x16x32_bf16 v[104:107], v[184:187], a[76:79], v[104:107]
 ds_read_b64_tr_b16 v[148:149], v17 offset:40992
 v_mfma_f32_16x16x32_bf16 v[68:71], v[188:191], a[72:75], v[68:71]
 ds_read_b64_tr_b16 v[150:151], v17 offset:42272
 v_mfma_f32_16x16x32_bf16 v[108:111], v[188:191], a[76:79], v[108:111]
 ds_read_b64_tr_b16 v[152:153], v16 offset:41024
 v_mfma_f32_16x16x32_bf16 v[72:75], v[192:195], a[72:75], v[72:75]
 ds_read_b64_tr_b16 v[154:155], v16 offset:42304
 v_mfma_f32_16x16x32_bf16 v[112:115], v[192:195], a[76:79], v[112:115]
 ds_read_b64_tr_b16 v[156:157], v17 offset:41056
 ds_read_b64_tr_b16 v[158:159], v17 offset:42336
 v_mfma_f32_16x16x32_bf16 v[76:79], v[196:199], a[72:75], v[76:79]
 ds_read_b64_tr_b16 v[160:161], v16 offset:41088
 v_mfma_f32_16x16x32_bf16 v[116:119], v[196:199], a[76:79], v[116:119]
 ds_read_b64_tr_b16 v[162:163], v16 offset:42368
 v_mfma_f32_16x16x32_bf16 v[80:83], v[200:203], a[72:75], v[80:83]
 ds_read_b64_tr_b16 v[164:165], v17 offset:41120
 v_mfma_f32_16x16x32_bf16 v[120:123], v[200:203], a[76:79], v[120:123]
 ds_read_b64_tr_b16 v[166:167], v17 offset:42400
 v_mfma_f32_16x16x32_bf16 v[84:87], v[204:207], a[72:75], v[84:87]
 ds_read_b64_tr_b16 v[168:169], v16 offset:41152
 v_mfma_f32_16x16x32_bf16 v[124:127], v[204:207], a[76:79], v[124:127]
 ds_read_b64_tr_b16 v[170:171], v16 offset:42432
 ds_read_b64_tr_b16 v[172:173], v17 offset:41184
 v_mfma_f32_16x16x32_bf16 v[88:91], v[208:211], a[72:75], v[88:91]
 ds_read_b64_tr_b16 v[174:175], v17 offset:42464
 v_mfma_f32_16x16x32_bf16 v[128:131], v[208:211], a[76:79], v[128:131]
 buffer_load_dwordx4 a[152:155], v6, s[16:19], s48 offen offset:0 sc1
 ds_read_b64_tr_b16 v[176:177], v16 offset:41216
 v_mfma_f32_16x16x32_bf16 v[92:95], v[212:215], a[72:75], v[92:95]
 ds_read_b64_tr_b16 v[178:179], v16 offset:42496
 v_mfma_f32_16x16x32_bf16 v[132:135], v[212:215], a[76:79], v[132:135]
 ds_read_b64_tr_b16 v[180:181], v17 offset:41248
 v_mfma_f32_16x16x32_bf16 v[96:99], v[216:219], a[72:75], v[96:99]
 ds_read_b64_tr_b16 v[182:183], v17 offset:42528
 v_mfma_f32_16x16x32_bf16 v[136:139], v[216:219], a[76:79], v[136:139]
 buffer_load_dwordx4 a[156:159], v6, s[16:19], s48 offen offset:128 sc1
 v_mfma_f32_16x16x32_bf16 v[100:103], v[220:223], a[72:75], v[100:103]
 s_add_u32 s48, s48, 132096
 v_mfma_f32_16x16x32_bf16 v[140:143], v[220:223], a[76:79], v[140:143]
 s_waitcnt lgkmcnt(0) vmcnt(33)
 v_mfma_f32_16x16x32_bf16 v[64:67], v[144:147], a[80:83], v[64:67]
 ds_read_b64_tr_b16 v[184:185], v16 offset:51200
 ds_read_b64_tr_b16 v[186:187], v16 offset:52480
 v_mfma_f32_16x16x32_bf16 v[104:107], v[144:147], a[84:87], v[104:107]
 ds_read_b64_tr_b16 v[188:189], v17 offset:51232
 v_mfma_f32_16x16x32_bf16 v[68:71], v[148:151], a[80:83], v[68:71]
 ds_read_b64_tr_b16 v[190:191], v17 offset:52512
 v_mfma_f32_16x16x32_bf16 v[108:111], v[148:151], a[84:87], v[108:111]
 ds_read_b64_tr_b16 v[192:193], v16 offset:51264
 v_mfma_f32_16x16x32_bf16 v[72:75], v[152:155], a[80:83], v[72:75]
 ds_read_b64_tr_b16 v[194:195], v16 offset:52544
 v_mfma_f32_16x16x32_bf16 v[112:115], v[152:155], a[84:87], v[112:115]
 ds_read_b64_tr_b16 v[196:197], v17 offset:51296
 ds_read_b64_tr_b16 v[198:199], v17 offset:52576
 v_mfma_f32_16x16x32_bf16 v[76:79], v[156:159], a[80:83], v[76:79]
 ds_read_b64_tr_b16 v[200:201], v16 offset:51328
 v_mfma_f32_16x16x32_bf16 v[116:119], v[156:159], a[84:87], v[116:119]
 ds_read_b64_tr_b16 v[202:203], v16 offset:52608
 v_mfma_f32_16x16x32_bf16 v[80:83], v[160:163], a[80:83], v[80:83]
 ds_read_b64_tr_b16 v[204:205], v17 offset:51360
 v_mfma_f32_16x16x32_bf16 v[120:123], v[160:163], a[84:87], v[120:123]
 ds_read_b64_tr_b16 v[206:207], v17 offset:52640
 v_mfma_f32_16x16x32_bf16 v[84:87], v[164:167], a[80:83], v[84:87]
 ds_read_b64_tr_b16 v[208:209], v16 offset:51392
 v_mfma_f32_16x16x32_bf16 v[124:127], v[164:167], a[84:87], v[124:127]
 ds_read_b64_tr_b16 v[210:211], v16 offset:52672
 ds_read_b64_tr_b16 v[212:213], v17 offset:51424
 v_mfma_f32_16x16x32_bf16 v[88:91], v[168:171], a[80:83], v[88:91]
 ds_read_b64_tr_b16 v[214:215], v17 offset:52704
 v_mfma_f32_16x16x32_bf16 v[128:131], v[168:171], a[84:87], v[128:131]
 ds_read_b64_tr_b16 v[216:217], v16 offset:51456
 v_mfma_f32_16x16x32_bf16 v[92:95], v[172:175], a[80:83], v[92:95]
 ds_read_b64_tr_b16 v[218:219], v16 offset:52736
 v_mfma_f32_16x16x32_bf16 v[132:135], v[172:175], a[84:87], v[132:135]
 ds_read_b64_tr_b16 v[220:221], v17 offset:51488
 v_mfma_f32_16x16x32_bf16 v[96:99], v[176:179], a[80:83], v[96:99]
 ds_read_b64_tr_b16 v[222:223], v17 offset:52768
 v_mfma_f32_16x16x32_bf16 v[136:139], v[176:179], a[84:87], v[136:139]
 v_mfma_f32_16x16x32_bf16 v[100:103], v[180:183], a[80:83], v[100:103]
 v_mfma_f32_16x16x32_bf16 v[140:143], v[180:183], a[84:87], v[140:143]
 s_waitcnt lgkmcnt(0) vmcnt(26)
 s_barrier
 v_mfma_f32_16x16x32_bf16 v[64:67], v[184:187], a[88:91], v[64:67]
 ds_read_b64_tr_b16 v[144:145], v18 offset:0
 ds_read_b64_tr_b16 v[146:147], v18 offset:1280
 v_mfma_f32_16x16x32_bf16 v[104:107], v[184:187], a[92:95], v[104:107]
 ds_read_b64_tr_b16 v[148:149], v19 offset:32
 v_mfma_f32_16x16x32_bf16 v[68:71], v[188:191], a[88:91], v[68:71]
 ds_read_b64_tr_b16 v[150:151], v19 offset:1312
 v_mfma_f32_16x16x32_bf16 v[108:111], v[188:191], a[92:95], v[108:111]
 ds_read_b64_tr_b16 v[152:153], v18 offset:64
 v_mfma_f32_16x16x32_bf16 v[72:75], v[192:195], a[88:91], v[72:75]
 ds_read_b64_tr_b16 v[154:155], v18 offset:1344
 v_mfma_f32_16x16x32_bf16 v[112:115], v[192:195], a[92:95], v[112:115]
 ds_read_b64_tr_b16 v[156:157], v19 offset:96
 ds_read_b64_tr_b16 v[158:159], v19 offset:1376
 v_mfma_f32_16x16x32_bf16 v[76:79], v[196:199], a[88:91], v[76:79]
 ds_read_b64_tr_b16 v[160:161], v18 offset:128
 v_mfma_f32_16x16x32_bf16 v[116:119], v[196:199], a[92:95], v[116:119]
 ds_read_b64_tr_b16 v[162:163], v18 offset:1408
 v_mfma_f32_16x16x32_bf16 v[80:83], v[200:203], a[88:91], v[80:83]
 ds_read_b64_tr_b16 v[164:165], v19 offset:160
 v_mfma_f32_16x16x32_bf16 v[120:123], v[200:203], a[92:95], v[120:123]
 ds_read_b64_tr_b16 v[166:167], v19 offset:1440
 v_mfma_f32_16x16x32_bf16 v[84:87], v[204:207], a[88:91], v[84:87]
 ds_read_b64_tr_b16 v[168:169], v18 offset:192
 v_mfma_f32_16x16x32_bf16 v[124:127], v[204:207], a[92:95], v[124:127]
 ds_read_b64_tr_b16 v[170:171], v18 offset:1472
 ds_read_b64_tr_b16 v[172:173], v19 offset:224
 v_mfma_f32_16x16x32_bf16 v[88:91], v[208:211], a[88:91], v[88:91]
 ds_read_b64_tr_b16 v[174:175], v19 offset:1504
 v_mfma_f32_16x16x32_bf16 v[128:131], v[208:211], a[92:95], v[128:131]
 ds_read_b64_tr_b16 v[176:177], v18 offset:256
 v_mfma_f32_16x16x32_bf16 v[92:95], v[212:215], a[88:91], v[92:95]
 ds_read_b64_tr_b16 v[178:179], v18 offset:1536
 v_mfma_f32_16x16x32_bf16 v[132:135], v[212:215], a[92:95], v[132:135]
 ds_read_b64_tr_b16 v[180:181], v19 offset:288
 v_mfma_f32_16x16x32_bf16 v[96:99], v[216:219], a[88:91], v[96:99]
 ds_read_b64_tr_b16 v[182:183], v19 offset:1568
 v_mfma_f32_16x16x32_bf16 v[136:139], v[216:219], a[92:95], v[136:139]
 v_mfma_f32_16x16x32_bf16 v[100:103], v[220:223], a[88:91], v[100:103]
 v_mfma_f32_16x16x32_bf16 v[140:143], v[220:223], a[92:95], v[140:143]
 s_waitcnt lgkmcnt(0) vmcnt(24)
 v_mfma_f32_16x16x32_bf16 v[64:67], v[144:147], a[96:99], v[64:67]
 ds_read_b64_tr_b16 v[184:185], v18 offset:10240
 ds_read_b64_tr_b16 v[186:187], v18 offset:11520
 v_mfma_f32_16x16x32_bf16 v[104:107], v[144:147], a[100:103], v[104:107]
 ds_read_b64_tr_b16 v[188:189], v19 offset:10272
 v_mfma_f32_16x16x32_bf16 v[68:71], v[148:151], a[96:99], v[68:71]
 ds_read_b64_tr_b16 v[190:191], v19 offset:11552
 v_mfma_f32_16x16x32_bf16 v[108:111], v[148:151], a[100:103], v[108:111]
 ds_read_b64_tr_b16 v[192:193], v18 offset:10304
 v_mfma_f32_16x16x32_bf16 v[72:75], v[152:155], a[96:99], v[72:75]
 ds_read_b64_tr_b16 v[194:195], v18 offset:11584
 v_mfma_f32_16x16x32_bf16 v[112:115], v[152:155], a[100:103], v[112:115]
 ds_read_b64_tr_b16 v[196:197], v19 offset:10336
 ds_read_b64_tr_b16 v[198:199], v19 offset:11616
 v_mfma_f32_16x16x32_bf16 v[76:79], v[156:159], a[96:99], v[76:79]
 ds_read_b64_tr_b16 v[200:201], v18 offset:10368
 v_mfma_f32_16x16x32_bf16 v[116:119], v[156:159], a[100:103], v[116:119]
 ds_read_b64_tr_b16 v[202:203], v18 offset:11648
 v_mfma_f32_16x16x32_bf16 v[80:83], v[160:163], a[96:99], v[80:83]
 ds_read_b64_tr_b16 v[204:205], v19 offset:10400
 v_mfma_f32_16x16x32_bf16 v[120:123], v[160:163], a[100:103], v[120:123]
 ds_read_b64_tr_b16 v[206:207], v19 offset:11680
 v_mfma_f32_16x16x32_bf16 v[84:87], v[164:167], a[96:99], v[84:87]
 ds_read_b64_tr_b16 v[208:209], v18 offset:10432
 v_mfma_f32_16x16x32_bf16 v[124:127], v[164:167], a[100:103], v[124:127]
 ds_read_b64_tr_b16 v[210:211], v18 offset:11712
 ds_read_b64_tr_b16 v[212:213], v19 offset:10464
 v_mfma_f32_16x16x32_bf16 v[88:91], v[168:171], a[96:99], v[88:91]
 ds_read_b64_tr_b16 v[214:215], v19 offset:11744
 v_mfma_f32_16x16x32_bf16 v[128:131], v[168:171], a[100:103], v[128:131]
 ds_read_b64_tr_b16 v[216:217], v18 offset:10496
 v_mfma_f32_16x16x32_bf16 v[92:95], v[172:175], a[96:99], v[92:95]
 ds_read_b64_tr_b16 v[218:219], v18 offset:11776
 v_mfma_f32_16x16x32_bf16 v[132:135], v[172:175], a[100:103], v[132:135]
 ds_read_b64_tr_b16 v[220:221], v19 offset:10528
 v_mfma_f32_16x16x32_bf16 v[96:99], v[176:179], a[96:99], v[96:99]
 ds_read_b64_tr_b16 v[222:223], v19 offset:11808
 v_mfma_f32_16x16x32_bf16 v[136:139], v[176:179], a[100:103], v[136:139]
 v_mfma_f32_16x16x32_bf16 v[100:103], v[180:183], a[96:99], v[100:103]
 v_mfma_f32_16x16x32_bf16 v[140:143], v[180:183], a[100:103], v[140:143]
 s_waitcnt lgkmcnt(0) vmcnt(17)
 s_barrier
 v_mfma_f32_16x16x32_bf16 v[64:67], v[184:187], a[104:107], v[64:67]
 ds_read_b64_tr_b16 v[144:145], v14 offset:0
 ds_read_b64_tr_b16 v[146:147], v14 offset:1280
 v_mfma_f32_16x16x32_bf16 v[104:107], v[184:187], a[108:111], v[104:107]
 ds_read_b64_tr_b16 v[148:149], v15 offset:32
 v_mfma_f32_16x16x32_bf16 v[68:71], v[188:191], a[104:107], v[68:71]
 ds_read_b64_tr_b16 v[150:151], v15 offset:1312
 v_mfma_f32_16x16x32_bf16 v[108:111], v[188:191], a[108:111], v[108:111]
 ds_read_b64_tr_b16 v[152:153], v14 offset:64
 v_mfma_f32_16x16x32_bf16 v[72:75], v[192:195], a[104:107], v[72:75]
 ds_read_b64_tr_b16 v[154:155], v14 offset:1344
 v_mfma_f32_16x16x32_bf16 v[112:115], v[192:195], a[108:111], v[112:115]
 ds_read_b64_tr_b16 v[156:157], v15 offset:96
 ds_read_b64_tr_b16 v[158:159], v15 offset:1376
 v_mfma_f32_16x16x32_bf16 v[76:79], v[196:199], a[104:107], v[76:79]
 ds_read_b64_tr_b16 v[160:161], v14 offset:128
 v_mfma_f32_16x16x32_bf16 v[116:119], v[196:199], a[108:111], v[116:119]
 ds_read_b64_tr_b16 v[162:163], v14 offset:1408
 v_mfma_f32_16x16x32_bf16 v[80:83], v[200:203], a[104:107], v[80:83]
 ds_read_b64_tr_b16 v[164:165], v15 offset:160
 v_mfma_f32_16x16x32_bf16 v[120:123], v[200:203], a[108:111], v[120:123]
 ds_read_b64_tr_b16 v[166:167], v15 offset:1440
 v_mfma_f32_16x16x32_bf16 v[84:87], v[204:207], a[104:107], v[84:87]
 ds_read_b64_tr_b16 v[168:169], v14 offset:192
 v_mfma_f32_16x16x32_bf16 v[124:127], v[204:207], a[108:111], v[124:127]
 ds_read_b64_tr_b16 v[170:171], v14 offset:1472
 ds_read_b64_tr_b16 v[172:173], v15 offset:224
 v_mfma_f32_16x16x32_bf16 v[88:91], v[208:211], a[104:107], v[88:91]
 ds_read_b64_tr_b16 v[174:175], v15 offset:1504
 v_mfma_f32_16x16x32_bf16 v[128:131], v[208:211], a[108:111], v[128:131]
 ds_read_b64_tr_b16 v[176:177], v14 offset:256
 v_mfma_f32_16x16x32_bf16 v[92:95], v[212:215], a[104:107], v[92:95]
 ds_read_b64_tr_b16 v[178:179], v14 offset:1536
 v_mfma_f32_16x16x32_bf16 v[132:135], v[212:215], a[108:111], v[132:135]
 ds_read_b64_tr_b16 v[180:181], v15 offset:288
 v_mfma_f32_16x16x32_bf16 v[96:99], v[216:219], a[104:107], v[96:99]
 ds_read_b64_tr_b16 v[182:183], v15 offset:1568
 v_mfma_f32_16x16x32_bf16 v[136:139], v[216:219], a[108:111], v[136:139]
 v_mfma_f32_16x16x32_bf16 v[100:103], v[220:223], a[104:107], v[100:103]
 v_mfma_f32_16x16x32_bf16 v[140:143], v[220:223], a[108:111], v[140:143]
 s_waitcnt lgkmcnt(0) vmcnt(15)
 v_mfma_f32_16x16x32_bf16 v[64:67], v[144:147], a[112:115], v[64:67]
 ds_read_b64_tr_b16 v[184:185], v14 offset:10240
 ds_read_b64_tr_b16 v[186:187], v14 offset:11520
 v_mfma_f32_16x16x32_bf16 v[104:107], v[144:147], a[116:119], v[104:107]
 ds_read_b64_tr_b16 v[188:189], v15 offset:10272
 v_mfma_f32_16x16x32_bf16 v[68:71], v[148:151], a[112:115], v[68:71]
 ds_read_b64_tr_b16 v[190:191], v15 offset:11552
 v_mfma_f32_16x16x32_bf16 v[108:111], v[148:151], a[116:119], v[108:111]
 ds_read_b64_tr_b16 v[192:193], v14 offset:10304
 v_mfma_f32_16x16x32_bf16 v[72:75], v[152:155], a[112:115], v[72:75]
 ds_read_b64_tr_b16 v[194:195], v14 offset:11584
 v_mfma_f32_16x16x32_bf16 v[112:115], v[152:155], a[116:119], v[112:115]
 ds_read_b64_tr_b16 v[196:197], v15 offset:10336
 ds_read_b64_tr_b16 v[198:199], v15 offset:11616
 v_mfma_f32_16x16x32_bf16 v[76:79], v[156:159], a[112:115], v[76:79]
 ds_read_b64_tr_b16 v[200:201], v14 offset:10368
 v_mfma_f32_16x16x32_bf16 v[116:119], v[156:159], a[116:119], v[116:119]
 ds_read_b64_tr_b16 v[202:203], v14 offset:11648
 v_mfma_f32_16x16x32_bf16 v[80:83], v[160:163], a[112:115], v[80:83]
 ds_read_b64_tr_b16 v[204:205], v15 offset:10400
 v_mfma_f32_16x16x32_bf16 v[120:123], v[160:163], a[116:119], v[120:123]
 ds_read_b64_tr_b16 v[206:207], v15 offset:11680
 v_mfma_f32_16x16x32_bf16 v[84:87], v[164:167], a[112:115], v[84:87]
 ds_read_b64_tr_b16 v[208:209], v14 offset:10432
 v_mfma_f32_16x16x32_bf16 v[124:127], v[164:167], a[116:119], v[124:127]
 ds_read_b64_tr_b16 v[210:211], v14 offset:11712
 ds_read_b64_tr_b16 v[212:213], v15 offset:10464
 v_mfma_f32_16x16x32_bf16 v[88:91], v[168:171], a[112:115], v[88:91]
 ds_read_b64_tr_b16 v[214:215], v15 offset:11744
 v_mfma_f32_16x16x32_bf16 v[128:131], v[168:171], a[116:119], v[128:131]
 ds_read_b64_tr_b16 v[216:217], v14 offset:10496
 v_mfma_f32_16x16x32_bf16 v[92:95], v[172:175], a[112:115], v[92:95]
 ds_read_b64_tr_b16 v[218:219], v14 offset:11776
 v_mfma_f32_16x16x32_bf16 v[132:135], v[172:175], a[116:119], v[132:135]
 ds_read_b64_tr_b16 v[220:221], v15 offset:10528
 v_mfma_f32_16x16x32_bf16 v[96:99], v[176:179], a[112:115], v[96:99]
 ds_read_b64_tr_b16 v[222:223], v15 offset:11808
 v_mfma_f32_16x16x32_bf16 v[136:139], v[176:179], a[116:119], v[136:139]
 v_mfma_f32_16x16x32_bf16 v[100:103], v[180:183], a[112:115], v[100:103]
 v_mfma_f32_16x16x32_bf16 v[140:143], v[180:183], a[116:119], v[140:143]
 s_waitcnt lgkmcnt(0) vmcnt(8)
 s_barrier
 v_mfma_f32_16x16x32_bf16 v[64:67], v[184:187], a[120:123], v[64:67]
 ds_read_b64_tr_b16 v[144:145], v14 offset:20480
 ds_read_b64_tr_b16 v[146:147], v14 offset:21760
 v_mfma_f32_16x16x32_bf16 v[104:107], v[184:187], a[124:127], v[104:107]
 ds_read_b64_tr_b16 v[148:149], v15 offset:20512
 v_mfma_f32_16x16x32_bf16 v[68:71], v[188:191], a[120:123], v[68:71]
 ds_read_b64_tr_b16 v[150:151], v15 offset:21792
 v_mfma_f32_16x16x32_bf16 v[108:111], v[188:191], a[124:127], v[108:111]
 ds_read_b64_tr_b16 v[152:153], v14 offset:20544
 v_mfma_f32_16x16x32_bf16 v[72:75], v[192:195], a[120:123], v[72:75]
 ds_read_b64_tr_b16 v[154:155], v14 offset:21824
 v_mfma_f32_16x16x32_bf16 v[112:115], v[192:195], a[124:127], v[112:115]
 ds_read_b64_tr_b16 v[156:157], v15 offset:20576
 ds_read_b64_tr_b16 v[158:159], v15 offset:21856
 v_mfma_f32_16x16x32_bf16 v[76:79], v[196:199], a[120:123], v[76:79]
 ds_read_b64_tr_b16 v[160:161], v14 offset:20608
 v_mfma_f32_16x16x32_bf16 v[116:119], v[196:199], a[124:127], v[116:119]
 ds_read_b64_tr_b16 v[162:163], v14 offset:21888
 v_mfma_f32_16x16x32_bf16 v[80:83], v[200:203], a[120:123], v[80:83]
 ds_read_b64_tr_b16 v[164:165], v15 offset:20640
 v_mfma_f32_16x16x32_bf16 v[120:123], v[200:203], a[124:127], v[120:123]
 ds_read_b64_tr_b16 v[166:167], v15 offset:21920
 v_mfma_f32_16x16x32_bf16 v[84:87], v[204:207], a[120:123], v[84:87]
 ds_read_b64_tr_b16 v[168:169], v14 offset:20672
 v_mfma_f32_16x16x32_bf16 v[124:127], v[204:207], a[124:127], v[124:127]
 ds_read_b64_tr_b16 v[170:171], v14 offset:21952
 ds_read_b64_tr_b16 v[172:173], v15 offset:20704
 v_mfma_f32_16x16x32_bf16 v[88:91], v[208:211], a[120:123], v[88:91]
 ds_read_b64_tr_b16 v[174:175], v15 offset:21984
 v_mfma_f32_16x16x32_bf16 v[128:131], v[208:211], a[124:127], v[128:131]
 ds_read_b64_tr_b16 v[176:177], v14 offset:20736
 v_mfma_f32_16x16x32_bf16 v[92:95], v[212:215], a[120:123], v[92:95]
 ds_read_b64_tr_b16 v[178:179], v14 offset:22016
 v_mfma_f32_16x16x32_bf16 v[132:135], v[212:215], a[124:127], v[132:135]
 ds_read_b64_tr_b16 v[180:181], v15 offset:20768
 v_mfma_f32_16x16x32_bf16 v[96:99], v[216:219], a[120:123], v[96:99]
 ds_read_b64_tr_b16 v[182:183], v15 offset:22048
 v_mfma_f32_16x16x32_bf16 v[136:139], v[216:219], a[124:127], v[136:139]
 v_mfma_f32_16x16x32_bf16 v[100:103], v[220:223], a[120:123], v[100:103]
 v_mfma_f32_16x16x32_bf16 v[140:143], v[220:223], a[124:127], v[140:143]
 s_waitcnt lgkmcnt(0) vmcnt(6)
 v_mfma_f32_16x16x32_bf16 v[64:67], v[144:147], a[128:131], v[64:67]
 ds_read_b64_tr_b16 v[184:185], v14 offset:30720
 ds_read_b64_tr_b16 v[186:187], v14 offset:32000
 v_mfma_f32_16x16x32_bf16 v[104:107], v[144:147], a[132:135], v[104:107]
 ds_read_b64_tr_b16 v[188:189], v15 offset:30752
 v_mfma_f32_16x16x32_bf16 v[68:71], v[148:151], a[128:131], v[68:71]
 ds_read_b64_tr_b16 v[190:191], v15 offset:32032
 v_mfma_f32_16x16x32_bf16 v[108:111], v[148:151], a[132:135], v[108:111]
 ds_read_b64_tr_b16 v[192:193], v14 offset:30784
 v_mfma_f32_16x16x32_bf16 v[72:75], v[152:155], a[128:131], v[72:75]
 ds_read_b64_tr_b16 v[194:195], v14 offset:32064
 v_mfma_f32_16x16x32_bf16 v[112:115], v[152:155], a[132:135], v[112:115]
 ds_read_b64_tr_b16 v[196:197], v15 offset:30816
 ds_read_b64_tr_b16 v[198:199], v15 offset:32096
 v_mfma_f32_16x16x32_bf16 v[76:79], v[156:159], a[128:131], v[76:79]
 ds_read_b64_tr_b16 v[200:201], v14 offset:30848
 v_mfma_f32_16x16x32_bf16 v[116:119], v[156:159], a[132:135], v[116:119]
 ds_read_b64_tr_b16 v[202:203], v14 offset:32128
 v_mfma_f32_16x16x32_bf16 v[80:83], v[160:163], a[128:131], v[80:83]
 ds_read_b64_tr_b16 v[204:205], v15 offset:30880
 v_mfma_f32_16x16x32_bf16 v[120:123], v[160:163], a[132:135], v[120:123]
 ds_read_b64_tr_b16 v[206:207], v15 offset:32160
 v_mfma_f32_16x16x32_bf16 v[84:87], v[164:167], a[128:131], v[84:87]
 ds_read_b64_tr_b16 v[208:209], v14 offset:30912
 v_mfma_f32_16x16x32_bf16 v[124:127], v[164:167], a[132:135], v[124:127]
 ds_read_b64_tr_b16 v[210:211], v14 offset:32192
 ds_read_b64_tr_b16 v[212:213], v15 offset:30944
 v_mfma_f32_16x16x32_bf16 v[88:91], v[168:171], a[128:131], v[88:91]
 ds_read_b64_tr_b16 v[214:215], v15 offset:32224
 v_mfma_f32_16x16x32_bf16 v[128:131], v[168:171], a[132:135], v[128:131]
 ds_read_b64_tr_b16 v[216:217], v14 offset:30976
 v_mfma_f32_16x16x32_bf16 v[92:95], v[172:175], a[128:131], v[92:95]
 ds_read_b64_tr_b16 v[218:219], v14 offset:32256
 v_mfma_f32_16x16x32_bf16 v[132:135], v[172:175], a[132:135], v[132:135]
 ds_read_b64_tr_b16 v[220:221], v15 offset:31008
 v_mfma_f32_16x16x32_bf16 v[96:99], v[176:179], a[128:131], v[96:99]
 ds_read_b64_tr_b16 v[222:223], v15 offset:32288
 v_mfma_f32_16x16x32_bf16 v[136:139], v[176:179], a[132:135], v[136:139]
 v_mfma_f32_16x16x32_bf16 v[100:103], v[180:183], a[128:131], v[100:103]
 v_mfma_f32_16x16x32_bf16 v[140:143], v[180:183], a[132:135], v[140:143]
 s_waitcnt lgkmcnt(0) vmcnt(4)
 s_barrier
 v_mfma_f32_16x16x32_bf16 v[64:67], v[184:187], a[136:139], v[64:67]
 ds_read_b64_tr_b16 v[144:145], v14 offset:40960
 ds_read_b64_tr_b16 v[146:147], v14 offset:42240
 v_mfma_f32_16x16x32_bf16 v[104:107], v[184:187], a[140:143], v[104:107]
 ds_read_b64_tr_b16 v[148:149], v15 offset:40992
 v_mfma_f32_16x16x32_bf16 v[68:71], v[188:191], a[136:139], v[68:71]
 ds_read_b64_tr_b16 v[150:151], v15 offset:42272
 v_mfma_f32_16x16x32_bf16 v[108:111], v[188:191], a[140:143], v[108:111]
 ds_read_b64_tr_b16 v[152:153], v14 offset:41024
 v_mfma_f32_16x16x32_bf16 v[72:75], v[192:195], a[136:139], v[72:75]
 ds_read_b64_tr_b16 v[154:155], v14 offset:42304
 v_mfma_f32_16x16x32_bf16 v[112:115], v[192:195], a[140:143], v[112:115]
 ds_read_b64_tr_b16 v[156:157], v15 offset:41056
 ds_read_b64_tr_b16 v[158:159], v15 offset:42336
 v_mfma_f32_16x16x32_bf16 v[76:79], v[196:199], a[136:139], v[76:79]
 ds_read_b64_tr_b16 v[160:161], v14 offset:41088
 v_mfma_f32_16x16x32_bf16 v[116:119], v[196:199], a[140:143], v[116:119]
 ds_read_b64_tr_b16 v[162:163], v14 offset:42368
 v_mfma_f32_16x16x32_bf16 v[80:83], v[200:203], a[136:139], v[80:83]
 ds_read_b64_tr_b16 v[164:165], v15 offset:41120
 v_mfma_f32_16x16x32_bf16 v[120:123], v[200:203], a[140:143], v[120:123]
 ds_read_b64_tr_b16 v[166:167], v15 offset:42400
 v_mfma_f32_16x16x32_bf16 v[84:87], v[204:207], a[136:139], v[84:87]
 ds_read_b64_tr_b16 v[168:169], v14 offset:41152
 v_mfma_f32_16x16x32_bf16 v[124:127], v[204:207], a[140:143], v[124:127]
 ds_read_b64_tr_b16 v[170:171], v14 offset:42432
 ds_read_b64_tr_b16 v[172:173], v15 offset:41184
 v_mfma_f32_16x16x32_bf16 v[88:91], v[208:211], a[136:139], v[88:91]
 ds_read_b64_tr_b16 v[174:175], v15 offset:42464
 v_mfma_f32_16x16x32_bf16 v[128:131], v[208:211], a[140:143], v[128:131]
 ds_read_b64_tr_b16 v[176:177], v14 offset:41216
 v_mfma_f32_16x16x32_bf16 v[92:95], v[212:215], a[136:139], v[92:95]
 ds_read_b64_tr_b16 v[178:179], v14 offset:42496
 v_mfma_f32_16x16x32_bf16 v[132:135], v[212:215], a[140:143], v[132:135]
 ds_read_b64_tr_b16 v[180:181], v15 offset:41248
 v_mfma_f32_16x16x32_bf16 v[96:99], v[216:219], a[136:139], v[96:99]
 ds_read_b64_tr_b16 v[182:183], v15 offset:42528
 v_mfma_f32_16x16x32_bf16 v[136:139], v[216:219], a[140:143], v[136:139]
 v_mfma_f32_16x16x32_bf16 v[100:103], v[220:223], a[136:139], v[100:103]
 v_mfma_f32_16x16x32_bf16 v[140:143], v[220:223], a[140:143], v[140:143]
 s_waitcnt lgkmcnt(0) vmcnt(2)
 v_mfma_f32_16x16x32_bf16 v[64:67], v[144:147], a[144:147], v[64:67]
 ds_read_b64_tr_b16 v[184:185], v14 offset:51200
 ds_read_b64_tr_b16 v[186:187], v14 offset:52480
 v_mfma_f32_16x16x32_bf16 v[104:107], v[144:147], a[148:151], v[104:107]
 ds_read_b64_tr_b16 v[188:189], v15 offset:51232
 v_mfma_f32_16x16x32_bf16 v[68:71], v[148:151], a[144:147], v[68:71]
 ds_read_b64_tr_b16 v[190:191], v15 offset:52512
 v_mfma_f32_16x16x32_bf16 v[108:111], v[148:151], a[148:151], v[108:111]
 ds_read_b64_tr_b16 v[192:193], v14 offset:51264
 v_mfma_f32_16x16x32_bf16 v[72:75], v[152:155], a[144:147], v[72:75]
 ds_read_b64_tr_b16 v[194:195], v14 offset:52544
 v_mfma_f32_16x16x32_bf16 v[112:115], v[152:155], a[148:151], v[112:115]
 ds_read_b64_tr_b16 v[196:197], v15 offset:51296
 ds_read_b64_tr_b16 v[198:199], v15 offset:52576
 v_mfma_f32_16x16x32_bf16 v[76:79], v[156:159], a[144:147], v[76:79]
 ds_read_b64_tr_b16 v[200:201], v14 offset:51328
 v_mfma_f32_16x16x32_bf16 v[116:119], v[156:159], a[148:151], v[116:119]
 ds_read_b64_tr_b16 v[202:203], v14 offset:52608
 v_mfma_f32_16x16x32_bf16 v[80:83], v[160:163], a[144:147], v[80:83]
 ds_read_b64_tr_b16 v[204:205], v15 offset:51360
 v_mfma_f32_16x16x32_bf16 v[120:123], v[160:163], a[148:151], v[120:123]
 ds_read_b64_tr_b16 v[206:207], v15 offset:52640
 v_mfma_f32_16x16x32_bf16 v[84:87], v[164:167], a[144:147], v[84:87]
 ds_read_b64_tr_b16 v[208:209], v14 offset:51392
 v_mfma_f32_16x16x32_bf16 v[124:127], v[164:167], a[148:151], v[124:127]
 ds_read_b64_tr_b16 v[210:211], v14 offset:52672
 ds_read_b64_tr_b16 v[212:213], v15 offset:51424
 v_mfma_f32_16x16x32_bf16 v[88:91], v[168:171], a[144:147], v[88:91]
 ds_read_b64_tr_b16 v[214:215], v15 offset:52704
 v_mfma_f32_16x16x32_bf16 v[128:131], v[168:171], a[148:151], v[128:131]
 ds_read_b64_tr_b16 v[216:217], v14 offset:51456
 v_mfma_f32_16x16x32_bf16 v[92:95], v[172:175], a[144:147], v[92:95]
 ds_read_b64_tr_b16 v[218:219], v14 offset:52736
 v_mfma_f32_16x16x32_bf16 v[132:135], v[172:175], a[148:151], v[132:135]
 ds_read_b64_tr_b16 v[220:221], v15 offset:51488
 v_mfma_f32_16x16x32_bf16 v[96:99], v[176:179], a[144:147], v[96:99]
 ds_read_b64_tr_b16 v[222:223], v15 offset:52768
 v_mfma_f32_16x16x32_bf16 v[136:139], v[176:179], a[148:151], v[136:139]
 v_mfma_f32_16x16x32_bf16 v[100:103], v[180:183], a[144:147], v[100:103]
 v_mfma_f32_16x16x32_bf16 v[140:143], v[180:183], a[148:151], v[140:143]
 s_waitcnt lgkmcnt(0) vmcnt(0)
 v_mfma_f32_16x16x32_bf16 v[64:67], v[184:187], a[152:155], v[64:67]
 v_mfma_f32_16x16x32_bf16 v[104:107], v[184:187], a[156:159], v[104:107]
 v_mfma_f32_16x16x32_bf16 v[68:71], v[188:191], a[152:155], v[68:71]
 v_mfma_f32_16x16x32_bf16 v[108:111], v[188:191], a[156:159], v[108:111]
 v_mfma_f32_16x16x32_bf16 v[72:75], v[192:195], a[152:155], v[72:75]
 v_mfma_f32_16x16x32_bf16 v[112:115], v[192:195], a[156:159], v[112:115]
 v_mfma_f32_16x16x32_bf16 v[76:79], v[196:199], a[152:155], v[76:79]
 v_mfma_f32_16x16x32_bf16 v[116:119], v[196:199], a[156:159], v[116:119]
 v_mfma_f32_16x16x32_bf16 v[80:83], v[200:203], a[152:155], v[80:83]
 v_mfma_f32_16x16x32_bf16 v[120:123], v[200:203], a[156:159], v[120:123]
 v_mfma_f32_16x16x32_bf16 v[84:87], v[204:207], a[152:155], v[84:87]
 v_mfma_f32_16x16x32_bf16 v[124:127], v[204:207], a[156:159], v[124:127]
 v_mfma_f32_16x16x32_bf16 v[88:91], v[208:211], a[152:155], v[88:91]
 v_mfma_f32_16x16x32_bf16 v[128:131], v[208:211], a[156:159], v[128:131]
 v_mfma_f32_16x16x32_bf16 v[92:95], v[212:215], a[152:155], v[92:95]
 v_mfma_f32_16x16x32_bf16 v[132:135], v[212:215], a[156:159], v[132:135]
 v_mfma_f32_16x16x32_bf16 v[96:99], v[216:219], a[152:155], v[96:99]
 v_mfma_f32_16x16x32_bf16 v[136:139], v[216:219], a[156:159], v[136:139]
 v_mfma_f32_16x16x32_bf16 v[100:103], v[220:223], a[152:155], v[100:103]
 v_mfma_f32_16x16x32_bf16 v[140:143], v[220:223], a[156:159], v[140:143]
 s_add_u32 s16, s38, 180355072
 s_addc_u32 s17, s39, 0
 s_mov_b32 s18, 67108864
 s_mov_b32 s19, 0x00020000
 s_nop 3
 s_lshr_b32 s22, s47, 1
 s_lshr_b32 s21, s22, 1
 s_bitcmp1_b32 s37, s21
 s_cselect_b32 s21, 8192, 0
 s_lshl_b32 s51, s22, 20
 s_or_b32 s51, s51, s21
 s_add_u32 s51, s51, 786432
 s_mul_i32 s53, s44, 5
 s_cmp_lt_u32 s2, 48
 s_cbranch_scc1 om_242
 s_add_u32 s21, s53, 0
 s_lshr_b32 s22, s21, 1
 s_lshl_b32 s22, s22, 14
 s_and_b32 s21, s21, 1
 s_lshl_b32 s21, s21, 11
 s_add_u32 s22, s22, s21
 s_add_u32 s22, s22, s51
 buffer_store_dwordx4 v[64:67], v4, s[16:19], s22 offen offset:0 sc1
 buffer_store_dwordx4 v[68:71], v4, s[16:19], s22 offen offset:1024 sc1
 s_add_u32 s21, s53, 1
 s_lshr_b32 s22, s21, 1
 s_lshl_b32 s22, s22, 14
 s_and_b32 s21, s21, 1
 s_lshl_b32 s21, s21, 11
 s_add_u32 s22, s22, s21
 s_add_u32 s22, s22, s51
 buffer_store_dwordx4 v[72:75], v4, s[16:19], s22 offen offset:0 sc1
 buffer_store_dwordx4 v[76:79], v4, s[16:19], s22 offen offset:1024 sc1
 s_add_u32 s21, s53, 2
 s_lshr_b32 s22, s21, 1
 s_lshl_b32 s22, s22, 14
 s_and_b32 s21, s21, 1
 s_lshl_b32 s21, s21, 11
 s_add_u32 s22, s22, s21
 s_add_u32 s22, s22, s51
 buffer_store_dwordx4 v[80:83], v4, s[16:19], s22 offen offset:0 sc1
 buffer_store_dwordx4 v[84:87], v4, s[16:19], s22 offen offset:1024 sc1
 s_add_u32 s21, s53, 3
 s_lshr_b32 s22, s21, 1
 s_lshl_b32 s22, s22, 14
 s_and_b32 s21, s21, 1
 s_lshl_b32 s21, s21, 11
 s_add_u32 s22, s22, s21
 s_add_u32 s22, s22, s51
 buffer_store_dwordx4 v[88:91], v4, s[16:19], s22 offen offset:0 sc1
 buffer_store_dwordx4 v[92:95], v4, s[16:19], s22 offen offset:1024 sc1
 s_add_u32 s21, s53, 4
 s_lshr_b32 s22, s21, 1
 s_lshl_b32 s22, s22, 14
 s_and_b32 s21, s21, 1
 s_lshl_b32 s21, s21, 11
 s_add_u32 s22, s22, s21
 s_add_u32 s22, s22, s51
 buffer_store_dwordx4 v[96:99], v4, s[16:19], s22 offen offset:0 sc1
 buffer_store_dwordx4 v[100:103], v4, s[16:19], s22 offen offset:1024 sc1
 s_add_u32 s21, s53, 0
 s_lshr_b32 s22, s21, 1
 s_lshl_b32 s22, s22, 14
 s_and_b32 s21, s21, 1
 s_lshl_b32 s21, s21, 11
 s_add_u32 s22, s22, s21
 s_add_u32 s22, s22, s51
 s_add_u32 s22, s22, 4096
 buffer_store_dwordx4 v[104:107], v4, s[16:19], s22 offen offset:0 sc1
 buffer_store_dwordx4 v[108:111], v4, s[16:19], s22 offen offset:1024 sc1
 s_add_u32 s21, s53, 1
 s_lshr_b32 s22, s21, 1
 s_lshl_b32 s22, s22, 14
 s_and_b32 s21, s21, 1
 s_lshl_b32 s21, s21, 11
 s_add_u32 s22, s22, s21
 s_add_u32 s22, s22, s51
 s_add_u32 s22, s22, 4096
 buffer_store_dwordx4 v[112:115], v4, s[16:19], s22 offen offset:0 sc1
 buffer_store_dwordx4 v[116:119], v4, s[16:19], s22 offen offset:1024 sc1
 s_add_u32 s21, s53, 2
 s_lshr_b32 s22, s21, 1
 s_lshl_b32 s22, s22, 14
 s_and_b32 s21, s21, 1
 s_lshl_b32 s21, s21, 11
 s_add_u32 s22, s22, s21
 s_add_u32 s22, s22, s51
 s_add_u32 s22, s22, 4096
 buffer_store_dwordx4 v[120:123], v4, s[16:19], s22 offen offset:0 sc1
 buffer_store_dwordx4 v[124:127], v4, s[16:19], s22 offen offset:1024 sc1
 s_add_u32 s21, s53, 3
 s_lshr_b32 s22, s21, 1
 s_lshl_b32 s22, s22, 14
 s_and_b32 s21, s21, 1
 s_lshl_b32 s21, s21, 11
 s_add_u32 s22, s22, s21
 s_add_u32 s22, s22, s51
 s_add_u32 s22, s22, 4096
 buffer_store_dwordx4 v[128:131], v4, s[16:19], s22 offen offset:0 sc1
 buffer_store_dwordx4 v[132:135], v4, s[16:19], s22 offen offset:1024 sc1
 s_add_u32 s21, s53, 4
 s_lshr_b32 s22, s21, 1
 s_lshl_b32 s22, s22, 14
 s_and_b32 s21, s21, 1
 s_lshl_b32 s21, s21, 11
 s_add_u32 s22, s22, s21
 s_add_u32 s22, s22, s51
 s_add_u32 s22, s22, 4096
 buffer_store_dwordx4 v[136:139], v4, s[16:19], s22 offen offset:0 sc1
 buffer_store_dwordx4 v[140:143], v4, s[16:19], s22 offen offset:1024 sc1
 s_waitcnt vmcnt(0)
 s_barrier
 s_lshr_b32 s21, s2, 2
 s_lshl_b32 s21, s21, 7
 s_add_u32 s21, s21, 93184
 s_cmp_lg_u32 s20, 0
 s_cbranch_scc1 af_244
 v_mov_b32 v10, 0
 v_mov_b32 v11, 1
 s_mov_b64 exec, 1
 buffer_atomic_add v11, v10, s[72:75], s21 offen sc1
 s_mov_b64 exec, -1
 s_nop 1
af_244:
 s_branch om_243
om_242:
 s_load_dwordx2 s[8:9], s[0:1], 88
 s_lshr_b32 s52, s2, 2
 s_lshl_b32 s52, s52, 7
 s_and_b32 s21, s52, 511
 s_add_u32 s21, s21, 94720
 s_cmp_lt_u32 s2, 32
 s_cselect_b32 s54, 32, 80
 s_add_u32 s21, s52, 116736
 s_cmp_lg_u32 s20, 0
 s_cbranch_scc1 wf_246
 v_mov_b32 v20, 0
 s_mov_b32 s101, 0
wf_245:
 buffer_load_dword v21, v20, s[72:75], s21 offen sc1
 s_add_u32 s101, s101, 1
 s_cmp_gt_u32 s101, 131072
 s_cbranch_scc1 main_end
 s_waitcnt vmcnt(0)
 v_readfirstlane_b32 s100, v21
 s_cmp_ge_u32 s100, s54
 s_cbranch_scc1 wf_246
 s_sleep 16
 s_branch wf_245
wf_246:
 s_barrier
 v_lshlrev_b32 v6, 2, v2
 s_lshl_b32 s22, s47, 6
 buffer_load_dword v30, v6, s[28:31], s22 offen sc1
 buffer_load_dword v31, v6, s[28:31], s22 offen offset:64 sc1
 s_add_u32 s21, s53, 0
 s_lshr_b32 s22, s21, 1
 s_lshl_b32 s22, s22, 14
 s_and_b32 s21, s21, 1
 s_lshl_b32 s21, s21, 11
 s_add_u32 s22, s22, s21
 s_add_u32 s22, s22, s51
 buffer_load_dwordx4 v[144:147], v4, s[16:19], s22 offen offset:0 sc1
 buffer_load_dwordx4 v[148:151], v4, s[16:19], s22 offen offset:1024 sc1
 s_add_u32 s21, s53, 1
 s_lshr_b32 s22, s21, 1
 s_lshl_b32 s22, s22, 14
 s_and_b32 s21, s21, 1
 s_lshl_b32 s21, s21, 11
 s_add_u32 s22, s22, s21
 s_add_u32 s22, s22, s51
 buffer_load_dwordx4 v[152:155], v4, s[16:19], s22 offen offset:0 sc1
 buffer_load_dwordx4 v[156:159], v4, s[16:19], s22 offen offset:1024 sc1
 s_add_u32 s21, s53, 2
 s_lshr_b32 s22, s21, 1
 s_lshl_b32 s22, s22, 14
 s_and_b32 s21, s21, 1
 s_lshl_b32 s21, s21, 11
 s_add_u32 s22, s22, s21
 s_add_u32 s22, s22, s51
 buffer_load_dwordx4 v[160:163], v4, s[16:19], s22 offen offset:0 sc1
 buffer_load_dwordx4 v[164:167], v4, s[16:19], s22 offen offset:1024 sc1
 s_add_u32 s21, s53, 3
 s_lshr_b32 s22, s21, 1
 s_lshl_b32 s22, s22, 14
 s_and_b32 s21, s21, 1
 s_lshl_b32 s21, s21, 11
 s_add_u32 s22, s22, s21
 s_add_u32 s22, s22, s51
 buffer_load_dwordx4 v[168:171], v4, s[16:19], s22 offen offset:0 sc1
 buffer_load_dwordx4 v[172:175], v4, s[16:19], s22 offen offset:1024 sc1
 s_add_u32 s21, s53, 4
 s_lshr_b32 s22, s21, 1
 s_lshl_b32 s22, s22, 14
 s_and_b32 s21, s21, 1
 s_lshl_b32 s21, s21, 11
 s_add_u32 s22, s22, s21
 s_add_u32 s22, s22, s51
 buffer_load_dwordx4 v[176:179], v4, s[16:19], s22 offen offset:0 sc1
 buffer_load_dwordx4 v[180:183], v4, s[16:19], s22 offen offset:1024 sc1
 s_add_u32 s21, s53, 0
 s_lshr_b32 s22, s21, 1
 s_lshl_b32 s22, s22, 14
 s_and_b32 s21, s21, 1
 s_lshl_b32 s21, s21, 11
 s_add_u32 s22, s22, s21
 s_add_u32 s22, s22, s51
 s_add_u32 s22, s22, 4096
 buffer_load_dwordx4 v[184:187], v4, s[16:19], s22 offen offset:0 sc1
 buffer_load_dwordx4 v[188:191], v4, s[16:19], s22 offen offset:1024 sc1
 s_add_u32 s21, s53, 1
 s_lshr_b32 s22, s21, 1
 s_lshl_b32 s22, s22, 14
 s_and_b32 s21, s21, 1
 s_lshl_b32 s21, s21, 11
 s_add_u32 s22, s22, s21
 s_add_u32 s22, s22, s51
 s_add_u32 s22, s22, 4096
 buffer_load_dwordx4 v[192:195], v4, s[16:19], s22 offen offset:0 sc1
 buffer_load_dwordx4 v[196:199], v4, s[16:19], s22 offen offset:1024 sc1
 s_add_u32 s21, s53, 2
 s_lshr_b32 s22, s21, 1
 s_lshl_b32 s22, s22, 14
 s_and_b32 s21, s21, 1
 s_lshl_b32 s21, s21, 11
 s_add_u32 s22, s22, s21
 s_add_u32 s22, s22, s51
 s_add_u32 s22, s22, 4096
 buffer_load_dwordx4 v[200:203], v4, s[16:19], s22 offen offset:0 sc1
 buffer_load_dwordx4 v[204:207], v4, s[16:19], s22 offen offset:1024 sc1
 s_add_u32 s21, s53, 3
 s_lshr_b32 s22, s21, 1
 s_lshl_b32 s22, s22, 14
 s_and_b32 s21, s21, 1
 s_lshl_b32 s21, s21, 11
 s_add_u32 s22, s22, s21
 s_add_u32 s22, s22, s51
 s_add_u32 s22, s22, 4096
 buffer_load_dwordx4 v[208:211], v4, s[16:19], s22 offen offset:0 sc1
 buffer_load_dwordx4 v[212:215], v4, s[16:19], s22 offen offset:1024 sc1
 s_add_u32 s21, s53, 4
 s_lshr_b32 s22, s21, 1
 s_lshl_b32 s22, s22, 14
 s_and_b32 s21, s21, 1
 s_lshl_b32 s21, s21, 11
 s_add_u32 s22, s22, s21
 s_add_u32 s22, s22, s51
 s_add_u32 s22, s22, 4096
 buffer_load_dwordx4 v[216:219], v4, s[16:19], s22 offen offset:0 sc1
 buffer_load_dwordx4 v[220:223], v4, s[16:19], s22 offen offset:1024 sc1
 v_mul_u32_u24 v9, 1280, v2
 v_lshl_add_u32 v9, v3, 3, v9
 s_mul_i32 s22, s47, 20480
 s_add_u32 s22, s22, s45
 s_add_u32 s23, s22, 20480
 s_waitcnt vmcnt(20) lgkmcnt(0)
 v_sub_f32 v32, 1.0, v30
 v_sub_f32 v33, 1.0, v31
 v_cvt_pk_bf16_f32 v26, v32, v33
 v_lshlrev_b32 v32, 16, v26
 v_and_b32 v33, 0xffff0000, v26
 v_cvt_pk_bf16_f32 v26, v64, v65
 v_lshlrev_b32 v64, 16, v26
 v_and_b32 v65, 0xffff0000, v26
 v_mul_f32 v64, v64, v32
 v_mul_f32 v65, v65, v32
 v_cvt_pk_bf16_f32 v26, v64, v65
 v_lshlrev_b32 v64, 16, v26
 v_and_b32 v65, 0xffff0000, v26
 v_cvt_pk_bf16_f32 v26, v66, v67
 v_lshlrev_b32 v66, 16, v26
 v_and_b32 v67, 0xffff0000, v26
 v_mul_f32 v66, v66, v32
 v_mul_f32 v67, v67, v32
 v_cvt_pk_bf16_f32 v26, v66, v67
 v_lshlrev_b32 v66, 16, v26
 v_and_b32 v67, 0xffff0000, v26
 v_cvt_pk_bf16_f32 v26, v68, v69
 v_lshlrev_b32 v68, 16, v26
 v_and_b32 v69, 0xffff0000, v26
 v_mul_f32 v68, v68, v32
 v_mul_f32 v69, v69, v32
 v_cvt_pk_bf16_f32 v26, v68, v69
 v_lshlrev_b32 v68, 16, v26
 v_and_b32 v69, 0xffff0000, v26
 v_cvt_pk_bf16_f32 v26, v70, v71
 v_lshlrev_b32 v70, 16, v26
 v_and_b32 v71, 0xffff0000, v26
 v_mul_f32 v70, v70, v32
 v_mul_f32 v71, v71, v32
 v_cvt_pk_bf16_f32 v26, v70, v71
 v_lshlrev_b32 v70, 16, v26
 v_and_b32 v71, 0xffff0000, v26
 v_cvt_pk_bf16_f32 v26, v72, v73
 v_lshlrev_b32 v72, 16, v26
 v_and_b32 v73, 0xffff0000, v26
 v_mul_f32 v72, v72, v32
 v_mul_f32 v73, v73, v32
 v_cvt_pk_bf16_f32 v26, v72, v73
 v_lshlrev_b32 v72, 16, v26
 v_and_b32 v73, 0xffff0000, v26
 v_cvt_pk_bf16_f32 v26, v74, v75
 v_lshlrev_b32 v74, 16, v26
 v_and_b32 v75, 0xffff0000, v26
 v_mul_f32 v74, v74, v32
 v_mul_f32 v75, v75, v32
 v_cvt_pk_bf16_f32 v26, v74, v75
 v_lshlrev_b32 v74, 16, v26
 v_and_b32 v75, 0xffff0000, v26
 v_cvt_pk_bf16_f32 v26, v76, v77
 v_lshlrev_b32 v76, 16, v26
 v_and_b32 v77, 0xffff0000, v26
 v_mul_f32 v76, v76, v32
 v_mul_f32 v77, v77, v32
 v_cvt_pk_bf16_f32 v26, v76, v77
 v_lshlrev_b32 v76, 16, v26
 v_and_b32 v77, 0xffff0000, v26
 v_cvt_pk_bf16_f32 v26, v78, v79
 v_lshlrev_b32 v78, 16, v26
 v_and_b32 v79, 0xffff0000, v26
 v_mul_f32 v78, v78, v32
 v_mul_f32 v79, v79, v32
 v_cvt_pk_bf16_f32 v26, v78, v79
 v_lshlrev_b32 v78, 16, v26
 v_and_b32 v79, 0xffff0000, v26
 v_cvt_pk_bf16_f32 v26, v80, v81
 v_lshlrev_b32 v80, 16, v26
 v_and_b32 v81, 0xffff0000, v26
 v_mul_f32 v80, v80, v32
 v_mul_f32 v81, v81, v32
 v_cvt_pk_bf16_f32 v26, v80, v81
 v_lshlrev_b32 v80, 16, v26
 v_and_b32 v81, 0xffff0000, v26
 v_cvt_pk_bf16_f32 v26, v82, v83
 v_lshlrev_b32 v82, 16, v26
 v_and_b32 v83, 0xffff0000, v26
 v_mul_f32 v82, v82, v32
 v_mul_f32 v83, v83, v32
 v_cvt_pk_bf16_f32 v26, v82, v83
 v_lshlrev_b32 v82, 16, v26
 v_and_b32 v83, 0xffff0000, v26
 v_cvt_pk_bf16_f32 v26, v84, v85
 v_lshlrev_b32 v84, 16, v26
 v_and_b32 v85, 0xffff0000, v26
 v_mul_f32 v84, v84, v32
 v_mul_f32 v85, v85, v32
 v_cvt_pk_bf16_f32 v26, v84, v85
 v_lshlrev_b32 v84, 16, v26
 v_and_b32 v85, 0xffff0000, v26
 v_cvt_pk_bf16_f32 v26, v86, v87
 v_lshlrev_b32 v86, 16, v26
 v_and_b32 v87, 0xffff0000, v26
 v_mul_f32 v86, v86, v32
 v_mul_f32 v87, v87, v32
 v_cvt_pk_bf16_f32 v26, v86, v87
 v_lshlrev_b32 v86, 16, v26
 v_and_b32 v87, 0xffff0000, v26
 v_cvt_pk_bf16_f32 v26, v88, v89
 v_lshlrev_b32 v88, 16, v26
 v_and_b32 v89, 0xffff0000, v26
 v_mul_f32 v88, v88, v32
 v_mul_f32 v89, v89, v32
 v_cvt_pk_bf16_f32 v26, v88, v89
 v_lshlrev_b32 v88, 16, v26
 v_and_b32 v89, 0xffff0000, v26
 v_cvt_pk_bf16_f32 v26, v90, v91
 v_lshlrev_b32 v90, 16, v26
 v_and_b32 v91, 0xffff0000, v26
 v_mul_f32 v90, v90, v32
 v_mul_f32 v91, v91, v32
 v_cvt_pk_bf16_f32 v26, v90, v91
 v_lshlrev_b32 v90, 16, v26
 v_and_b32 v91, 0xffff0000, v26
 v_cvt_pk_bf16_f32 v26, v92, v93
 v_lshlrev_b32 v92, 16, v26
 v_and_b32 v93, 0xffff0000, v26
 v_mul_f32 v92, v92, v32
 v_mul_f32 v93, v93, v32
 v_cvt_pk_bf16_f32 v26, v92, v93
 v_lshlrev_b32 v92, 16, v26
 v_and_b32 v93, 0xffff0000, v26
 v_cvt_pk_bf16_f32 v26, v94, v95
 v_lshlrev_b32 v94, 16, v26
 v_and_b32 v95, 0xffff0000, v26
 v_mul_f32 v94, v94, v32
 v_mul_f32 v95, v95, v32
 v_cvt_pk_bf16_f32 v26, v94, v95
 v_lshlrev_b32 v94, 16, v26
 v_and_b32 v95, 0xffff0000, v26
 v_cvt_pk_bf16_f32 v26, v96, v97
 v_lshlrev_b32 v96, 16, v26
 v_and_b32 v97, 0xffff0000, v26
 v_mul_f32 v96, v96, v32
 v_mul_f32 v97, v97, v32
 v_cvt_pk_bf16_f32 v26, v96, v97
 v_lshlrev_b32 v96, 16, v26
 v_and_b32 v97, 0xffff0000, v26
 v_cvt_pk_bf16_f32 v26, v98, v99
 v_lshlrev_b32 v98, 16, v26
 v_and_b32 v99, 0xffff0000, v26
 v_mul_f32 v98, v98, v32
 v_mul_f32 v99, v99, v32
 v_cvt_pk_bf16_f32 v26, v98, v99
 v_lshlrev_b32 v98, 16, v26
 v_and_b32 v99, 0xffff0000, v26
 v_cvt_pk_bf16_f32 v26, v100, v101
 v_lshlrev_b32 v100, 16, v26
 v_and_b32 v101, 0xffff0000, v26
 v_mul_f32 v100, v100, v32
 v_mul_f32 v101, v101, v32
 v_cvt_pk_bf16_f32 v26, v100, v101
 v_lshlrev_b32 v100, 16, v26
 v_and_b32 v101, 0xffff0000, v26
 v_cvt_pk_bf16_f32 v26, v102, v103
 v_lshlrev_b32 v102, 16, v26
 v_and_b32 v103, 0xffff0000, v26
 v_mul_f32 v102, v102, v32
 v_mul_f32 v103, v103, v32
 v_cvt_pk_bf16_f32 v26, v102, v103
 v_lshlrev_b32 v102, 16, v26
 v_and_b32 v103, 0xffff0000, v26
 v_cvt_pk_bf16_f32 v26, v104, v105
 v_lshlrev_b32 v104, 16, v26
 v_and_b32 v105, 0xffff0000, v26
 v_mul_f32 v104, v104, v33
 v_mul_f32 v105, v105, v33
 v_cvt_pk_bf16_f32 v26, v104, v105
 v_lshlrev_b32 v104, 16, v26
 v_and_b32 v105, 0xffff0000, v26
 v_cvt_pk_bf16_f32 v26, v106, v107
 v_lshlrev_b32 v106, 16, v26
 v_and_b32 v107, 0xffff0000, v26
 v_mul_f32 v106, v106, v33
 v_mul_f32 v107, v107, v33
 v_cvt_pk_bf16_f32 v26, v106, v107
 v_lshlrev_b32 v106, 16, v26
 v_and_b32 v107, 0xffff0000, v26
 v_cvt_pk_bf16_f32 v26, v108, v109
 v_lshlrev_b32 v108, 16, v26
 v_and_b32 v109, 0xffff0000, v26
 v_mul_f32 v108, v108, v33
 v_mul_f32 v109, v109, v33
 v_cvt_pk_bf16_f32 v26, v108, v109
 v_lshlrev_b32 v108, 16, v26
 v_and_b32 v109, 0xffff0000, v26
 v_cvt_pk_bf16_f32 v26, v110, v111
 v_lshlrev_b32 v110, 16, v26
 v_and_b32 v111, 0xffff0000, v26
 v_mul_f32 v110, v110, v33
 v_mul_f32 v111, v111, v33
 v_cvt_pk_bf16_f32 v26, v110, v111
 v_lshlrev_b32 v110, 16, v26
 v_and_b32 v111, 0xffff0000, v26
 v_cvt_pk_bf16_f32 v26, v112, v113
 v_lshlrev_b32 v112, 16, v26
 v_and_b32 v113, 0xffff0000, v26
 v_mul_f32 v112, v112, v33
 v_mul_f32 v113, v113, v33
 v_cvt_pk_bf16_f32 v26, v112, v113
 v_lshlrev_b32 v112, 16, v26
 v_and_b32 v113, 0xffff0000, v26
 v_cvt_pk_bf16_f32 v26, v114, v115
 v_lshlrev_b32 v114, 16, v26
 v_and_b32 v115, 0xffff0000, v26
 v_mul_f32 v114, v114, v33
 v_mul_f32 v115, v115, v33
 v_cvt_pk_bf16_f32 v26, v114, v115
 v_lshlrev_b32 v114, 16, v26
 v_and_b32 v115, 0xffff0000, v26
 v_cvt_pk_bf16_f32 v26, v116, v117
 v_lshlrev_b32 v116, 16, v26
 v_and_b32 v117, 0xffff0000, v26
 v_mul_f32 v116, v116, v33
 v_mul_f32 v117, v117, v33
 v_cvt_pk_bf16_f32 v26, v116, v117
 v_lshlrev_b32 v116, 16, v26
 v_and_b32 v117, 0xffff0000, v26
 v_cvt_pk_bf16_f32 v26, v118, v119
 v_lshlrev_b32 v118, 16, v26
 v_and_b32 v119, 0xffff0000, v26
 v_mul_f32 v118, v118, v33
 v_mul_f32 v119, v119, v33
 v_cvt_pk_bf16_f32 v26, v118, v119
 v_lshlrev_b32 v118, 16, v26
 v_and_b32 v119, 0xffff0000, v26
 v_cvt_pk_bf16_f32 v26, v120, v121
 v_lshlrev_b32 v120, 16, v26
 v_and_b32 v121, 0xffff0000, v26
 v_mul_f32 v120, v120, v33
 v_mul_f32 v121, v121, v33
 v_cvt_pk_bf16_f32 v26, v120, v121
 v_lshlrev_b32 v120, 16, v26
 v_and_b32 v121, 0xffff0000, v26
 v_cvt_pk_bf16_f32 v26, v122, v123
 v_lshlrev_b32 v122, 16, v26
 v_and_b32 v123, 0xffff0000, v26
 v_mul_f32 v122, v122, v33
 v_mul_f32 v123, v123, v33
 v_cvt_pk_bf16_f32 v26, v122, v123
 v_lshlrev_b32 v122, 16, v26
 v_and_b32 v123, 0xffff0000, v26
 v_cvt_pk_bf16_f32 v26, v124, v125
 v_lshlrev_b32 v124, 16, v26
 v_and_b32 v125, 0xffff0000, v26
 v_mul_f32 v124, v124, v33
 v_mul_f32 v125, v125, v33
 v_cvt_pk_bf16_f32 v26, v124, v125
 v_lshlrev_b32 v124, 16, v26
 v_and_b32 v125, 0xffff0000, v26
 v_cvt_pk_bf16_f32 v26, v126, v127
 v_lshlrev_b32 v126, 16, v26
 v_and_b32 v127, 0xffff0000, v26
 v_mul_f32 v126, v126, v33
 v_mul_f32 v127, v127, v33
 v_cvt_pk_bf16_f32 v26, v126, v127
 v_lshlrev_b32 v126, 16, v26
 v_and_b32 v127, 0xffff0000, v26
 v_cvt_pk_bf16_f32 v26, v128, v129
 v_lshlrev_b32 v128, 16, v26
 v_and_b32 v129, 0xffff0000, v26
 v_mul_f32 v128, v128, v33
 v_mul_f32 v129, v129, v33
 v_cvt_pk_bf16_f32 v26, v128, v129
 v_lshlrev_b32 v128, 16, v26
 v_and_b32 v129, 0xffff0000, v26
 v_cvt_pk_bf16_f32 v26, v130, v131
 v_lshlrev_b32 v130, 16, v26
 v_and_b32 v131, 0xffff0000, v26
 v_mul_f32 v130, v130, v33
 v_mul_f32 v131, v131, v33
 v_cvt_pk_bf16_f32 v26, v130, v131
 v_lshlrev_b32 v130, 16, v26
 v_and_b32 v131, 0xffff0000, v26
 v_cvt_pk_bf16_f32 v26, v132, v133
 v_lshlrev_b32 v132, 16, v26
 v_and_b32 v133, 0xffff0000, v26
 v_mul_f32 v132, v132, v33
 v_mul_f32 v133, v133, v33
 v_cvt_pk_bf16_f32 v26, v132, v133
 v_lshlrev_b32 v132, 16, v26
 v_and_b32 v133, 0xffff0000, v26
 v_cvt_pk_bf16_f32 v26, v134, v135
 v_lshlrev_b32 v134, 16, v26
 v_and_b32 v135, 0xffff0000, v26
 v_mul_f32 v134, v134, v33
 v_mul_f32 v135, v135, v33
 v_cvt_pk_bf16_f32 v26, v134, v135
 v_lshlrev_b32 v134, 16, v26
 v_and_b32 v135, 0xffff0000, v26
 v_cvt_pk_bf16_f32 v26, v136, v137
 v_lshlrev_b32 v136, 16, v26
 v_and_b32 v137, 0xffff0000, v26
 v_mul_f32 v136, v136, v33
 v_mul_f32 v137, v137, v33
 v_cvt_pk_bf16_f32 v26, v136, v137
 v_lshlrev_b32 v136, 16, v26
 v_and_b32 v137, 0xffff0000, v26
 v_cvt_pk_bf16_f32 v26, v138, v139
 v_lshlrev_b32 v138, 16, v26
 v_and_b32 v139, 0xffff0000, v26
 v_mul_f32 v138, v138, v33
 v_mul_f32 v139, v139, v33
 v_cvt_pk_bf16_f32 v26, v138, v139
 v_lshlrev_b32 v138, 16, v26
 v_and_b32 v139, 0xffff0000, v26
 v_cvt_pk_bf16_f32 v26, v140, v141
 v_lshlrev_b32 v140, 16, v26
 v_and_b32 v141, 0xffff0000, v26
 v_mul_f32 v140, v140, v33
 v_mul_f32 v141, v141, v33
 v_cvt_pk_bf16_f32 v26, v140, v141
 v_lshlrev_b32 v140, 16, v26
 v_and_b32 v141, 0xffff0000, v26
 v_cvt_pk_bf16_f32 v26, v142, v143
 v_lshlrev_b32 v142, 16, v26
 v_and_b32 v143, 0xffff0000, v26
 v_mul_f32 v142, v142, v33
 v_mul_f32 v143, v143, v33
 v_cvt_pk_bf16_f32 v26, v142, v143
 v_lshlrev_b32 v142, 16, v26
 v_and_b32 v143, 0xffff0000, v26
 s_waitcnt vmcnt(19)
 v_cvt_pk_bf16_f32 v26, v144, v145
 v_lshlrev_b32 v144, 16, v26
 v_and_b32 v145, 0xffff0000, v26
 v_mul_f32 v144, v144, v30
 v_mul_f32 v145, v145, v30
 v_cvt_pk_bf16_f32 v26, v144, v145
 v_lshlrev_b32 v144, 16, v26
 v_and_b32 v145, 0xffff0000, v26
 v_add_f32 v144, v144, v64
 v_add_f32 v145, v145, v65
 v_cvt_pk_bf16_f32 v64, v144, v145
 v_cvt_pk_bf16_f32 v26, v146, v147
 v_lshlrev_b32 v146, 16, v26
 v_and_b32 v147, 0xffff0000, v26
 v_mul_f32 v146, v146, v30
 v_mul_f32 v147, v147, v30
 v_cvt_pk_bf16_f32 v26, v146, v147
 v_lshlrev_b32 v146, 16, v26
 v_and_b32 v147, 0xffff0000, v26
 v_add_f32 v146, v146, v66
 v_add_f32 v147, v147, v67
 v_cvt_pk_bf16_f32 v65, v146, v147
 buffer_store_dwordx2 v[64:65], v9, s[8:11], s22 offen offset:0
 s_waitcnt vmcnt(19)
 v_cvt_pk_bf16_f32 v26, v148, v149
 v_lshlrev_b32 v148, 16, v26
 v_and_b32 v149, 0xffff0000, v26
 v_mul_f32 v148, v148, v30
 v_mul_f32 v149, v149, v30
 v_cvt_pk_bf16_f32 v26, v148, v149
 v_lshlrev_b32 v148, 16, v26
 v_and_b32 v149, 0xffff0000, v26
 v_add_f32 v148, v148, v68
 v_add_f32 v149, v149, v69
 v_cvt_pk_bf16_f32 v68, v148, v149
 v_cvt_pk_bf16_f32 v26, v150, v151
 v_lshlrev_b32 v150, 16, v26
 v_and_b32 v151, 0xffff0000, v26
 v_mul_f32 v150, v150, v30
 v_mul_f32 v151, v151, v30
 v_cvt_pk_bf16_f32 v26, v150, v151
 v_lshlrev_b32 v150, 16, v26
 v_and_b32 v151, 0xffff0000, v26
 v_add_f32 v150, v150, v70
 v_add_f32 v151, v151, v71
 v_cvt_pk_bf16_f32 v69, v150, v151
 buffer_store_dwordx2 v[68:69], v9, s[8:11], s22 offen offset:32
 s_waitcnt vmcnt(19)
 v_cvt_pk_bf16_f32 v26, v152, v153
 v_lshlrev_b32 v152, 16, v26
 v_and_b32 v153, 0xffff0000, v26
 v_mul_f32 v152, v152, v30
 v_mul_f32 v153, v153, v30
 v_cvt_pk_bf16_f32 v26, v152, v153
 v_lshlrev_b32 v152, 16, v26
 v_and_b32 v153, 0xffff0000, v26
 v_add_f32 v152, v152, v72
 v_add_f32 v153, v153, v73
 v_cvt_pk_bf16_f32 v72, v152, v153
 v_cvt_pk_bf16_f32 v26, v154, v155
 v_lshlrev_b32 v154, 16, v26
 v_and_b32 v155, 0xffff0000, v26
 v_mul_f32 v154, v154, v30
 v_mul_f32 v155, v155, v30
 v_cvt_pk_bf16_f32 v26, v154, v155
 v_lshlrev_b32 v154, 16, v26
 v_and_b32 v155, 0xffff0000, v26
 v_add_f32 v154, v154, v74
 v_add_f32 v155, v155, v75
 v_cvt_pk_bf16_f32 v73, v154, v155
 buffer_store_dwordx2 v[72:73], v9, s[8:11], s22 offen offset:64
 s_waitcnt vmcnt(19)
 v_cvt_pk_bf16_f32 v26, v156, v157
 v_lshlrev_b32 v156, 16, v26
 v_and_b32 v157, 0xffff0000, v26
 v_mul_f32 v156, v156, v30
 v_mul_f32 v157, v157, v30
 v_cvt_pk_bf16_f32 v26, v156, v157
 v_lshlrev_b32 v156, 16, v26
 v_and_b32 v157, 0xffff0000, v26
 v_add_f32 v156, v156, v76
 v_add_f32 v157, v157, v77
 v_cvt_pk_bf16_f32 v76, v156, v157
 v_cvt_pk_bf16_f32 v26, v158, v159
 v_lshlrev_b32 v158, 16, v26
 v_and_b32 v159, 0xffff0000, v26
 v_mul_f32 v158, v158, v30
 v_mul_f32 v159, v159, v30
 v_cvt_pk_bf16_f32 v26, v158, v159
 v_lshlrev_b32 v158, 16, v26
 v_and_b32 v159, 0xffff0000, v26
 v_add_f32 v158, v158, v78
 v_add_f32 v159, v159, v79
 v_cvt_pk_bf16_f32 v77, v158, v159
 buffer_store_dwordx2 v[76:77], v9, s[8:11], s22 offen offset:96
 s_waitcnt vmcnt(19)
 v_cvt_pk_bf16_f32 v26, v160, v161
 v_lshlrev_b32 v160, 16, v26
 v_and_b32 v161, 0xffff0000, v26
 v_mul_f32 v160, v160, v30
 v_mul_f32 v161, v161, v30
 v_cvt_pk_bf16_f32 v26, v160, v161
 v_lshlrev_b32 v160, 16, v26
 v_and_b32 v161, 0xffff0000, v26
 v_add_f32 v160, v160, v80
 v_add_f32 v161, v161, v81
 v_cvt_pk_bf16_f32 v80, v160, v161
 v_cvt_pk_bf16_f32 v26, v162, v163
 v_lshlrev_b32 v162, 16, v26
 v_and_b32 v163, 0xffff0000, v26
 v_mul_f32 v162, v162, v30
 v_mul_f32 v163, v163, v30
 v_cvt_pk_bf16_f32 v26, v162, v163
 v_lshlrev_b32 v162, 16, v26
 v_and_b32 v163, 0xffff0000, v26
 v_add_f32 v162, v162, v82
 v_add_f32 v163, v163, v83
 v_cvt_pk_bf16_f32 v81, v162, v163
 buffer_store_dwordx2 v[80:81], v9, s[8:11], s22 offen offset:128
 s_waitcnt vmcnt(19)
 v_cvt_pk_bf16_f32 v26, v164, v165
 v_lshlrev_b32 v164, 16, v26
 v_and_b32 v165, 0xffff0000, v26
 v_mul_f32 v164, v164, v30
 v_mul_f32 v165, v165, v30
 v_cvt_pk_bf16_f32 v26, v164, v165
 v_lshlrev_b32 v164, 16, v26
 v_and_b32 v165, 0xffff0000, v26
 v_add_f32 v164, v164, v84
 v_add_f32 v165, v165, v85
 v_cvt_pk_bf16_f32 v84, v164, v165
 v_cvt_pk_bf16_f32 v26, v166, v167
 v_lshlrev_b32 v166, 16, v26
 v_and_b32 v167, 0xffff0000, v26
 v_mul_f32 v166, v166, v30
 v_mul_f32 v167, v167, v30
 v_cvt_pk_bf16_f32 v26, v166, v167
 v_lshlrev_b32 v166, 16, v26
 v_and_b32 v167, 0xffff0000, v26
 v_add_f32 v166, v166, v86
 v_add_f32 v167, v167, v87
 v_cvt_pk_bf16_f32 v85, v166, v167
 buffer_store_dwordx2 v[84:85], v9, s[8:11], s22 offen offset:160
 s_waitcnt vmcnt(19)
 v_cvt_pk_bf16_f32 v26, v168, v169
 v_lshlrev_b32 v168, 16, v26
 v_and_b32 v169, 0xffff0000, v26
 v_mul_f32 v168, v168, v30
 v_mul_f32 v169, v169, v30
 v_cvt_pk_bf16_f32 v26, v168, v169
 v_lshlrev_b32 v168, 16, v26
 v_and_b32 v169, 0xffff0000, v26
 v_add_f32 v168, v168, v88
 v_add_f32 v169, v169, v89
 v_cvt_pk_bf16_f32 v88, v168, v169
 v_cvt_pk_bf16_f32 v26, v170, v171
 v_lshlrev_b32 v170, 16, v26
 v_and_b32 v171, 0xffff0000, v26
 v_mul_f32 v170, v170, v30
 v_mul_f32 v171, v171, v30
 v_cvt_pk_bf16_f32 v26, v170, v171
 v_lshlrev_b32 v170, 16, v26
 v_and_b32 v171, 0xffff0000, v26
 v_add_f32 v170, v170, v90
 v_add_f32 v171, v171, v91
 v_cvt_pk_bf16_f32 v89, v170, v171
 buffer_store_dwordx2 v[88:89], v9, s[8:11], s22 offen offset:192
 s_waitcnt vmcnt(19)
 v_cvt_pk_bf16_f32 v26, v172, v173
 v_lshlrev_b32 v172, 16, v26
 v_and_b32 v173, 0xffff0000, v26
 v_mul_f32 v172, v172, v30
 v_mul_f32 v173, v173, v30
 v_cvt_pk_bf16_f32 v26, v172, v173
 v_lshlrev_b32 v172, 16, v26
 v_and_b32 v173, 0xffff0000, v26
 v_add_f32 v172, v172, v92
 v_add_f32 v173, v173, v93
 v_cvt_pk_bf16_f32 v92, v172, v173
 v_cvt_pk_bf16_f32 v26, v174, v175
 v_lshlrev_b32 v174, 16, v26
 v_and_b32 v175, 0xffff0000, v26
 v_mul_f32 v174, v174, v30
 v_mul_f32 v175, v175, v30
 v_cvt_pk_bf16_f32 v26, v174, v175
 v_lshlrev_b32 v174, 16, v26
 v_and_b32 v175, 0xffff0000, v26
 v_add_f32 v174, v174, v94
 v_add_f32 v175, v175, v95
 v_cvt_pk_bf16_f32 v93, v174, v175
 buffer_store_dwordx2 v[92:93], v9, s[8:11], s22 offen offset:224
 s_waitcnt vmcnt(19)
 v_cvt_pk_bf16_f32 v26, v176, v177
 v_lshlrev_b32 v176, 16, v26
 v_and_b32 v177, 0xffff0000, v26
 v_mul_f32 v176, v176, v30
 v_mul_f32 v177, v177, v30
 v_cvt_pk_bf16_f32 v26, v176, v177
 v_lshlrev_b32 v176, 16, v26
 v_and_b32 v177, 0xffff0000, v26
 v_add_f32 v176, v176, v96
 v_add_f32 v177, v177, v97
 v_cvt_pk_bf16_f32 v96, v176, v177
 v_cvt_pk_bf16_f32 v26, v178, v179
 v_lshlrev_b32 v178, 16, v26
 v_and_b32 v179, 0xffff0000, v26
 v_mul_f32 v178, v178, v30
 v_mul_f32 v179, v179, v30
 v_cvt_pk_bf16_f32 v26, v178, v179
 v_lshlrev_b32 v178, 16, v26
 v_and_b32 v179, 0xffff0000, v26
 v_add_f32 v178, v178, v98
 v_add_f32 v179, v179, v99
 v_cvt_pk_bf16_f32 v97, v178, v179
 buffer_store_dwordx2 v[96:97], v9, s[8:11], s22 offen offset:256
 s_waitcnt vmcnt(19)
 v_cvt_pk_bf16_f32 v26, v180, v181
 v_lshlrev_b32 v180, 16, v26
 v_and_b32 v181, 0xffff0000, v26
 v_mul_f32 v180, v180, v30
 v_mul_f32 v181, v181, v30
 v_cvt_pk_bf16_f32 v26, v180, v181
 v_lshlrev_b32 v180, 16, v26
 v_and_b32 v181, 0xffff0000, v26
 v_add_f32 v180, v180, v100
 v_add_f32 v181, v181, v101
 v_cvt_pk_bf16_f32 v100, v180, v181
 v_cvt_pk_bf16_f32 v26, v182, v183
 v_lshlrev_b32 v182, 16, v26
 v_and_b32 v183, 0xffff0000, v26
 v_mul_f32 v182, v182, v30
 v_mul_f32 v183, v183, v30
 v_cvt_pk_bf16_f32 v26, v182, v183
 v_lshlrev_b32 v182, 16, v26
 v_and_b32 v183, 0xffff0000, v26
 v_add_f32 v182, v182, v102
 v_add_f32 v183, v183, v103
 v_cvt_pk_bf16_f32 v101, v182, v183
 buffer_store_dwordx2 v[100:101], v9, s[8:11], s22 offen offset:288
 s_waitcnt vmcnt(19)
 v_cvt_pk_bf16_f32 v26, v184, v185
 v_lshlrev_b32 v184, 16, v26
 v_and_b32 v185, 0xffff0000, v26
 v_mul_f32 v184, v184, v31
 v_mul_f32 v185, v185, v31
 v_cvt_pk_bf16_f32 v26, v184, v185
 v_lshlrev_b32 v184, 16, v26
 v_and_b32 v185, 0xffff0000, v26
 v_add_f32 v184, v184, v104
 v_add_f32 v185, v185, v105
 v_cvt_pk_bf16_f32 v104, v184, v185
 v_cvt_pk_bf16_f32 v26, v186, v187
 v_lshlrev_b32 v186, 16, v26
 v_and_b32 v187, 0xffff0000, v26
 v_mul_f32 v186, v186, v31
 v_mul_f32 v187, v187, v31
 v_cvt_pk_bf16_f32 v26, v186, v187
 v_lshlrev_b32 v186, 16, v26
 v_and_b32 v187, 0xffff0000, v26
 v_add_f32 v186, v186, v106
 v_add_f32 v187, v187, v107
 v_cvt_pk_bf16_f32 v105, v186, v187
 buffer_store_dwordx2 v[104:105], v9, s[8:11], s23 offen offset:0
 s_waitcnt vmcnt(19)
 v_cvt_pk_bf16_f32 v26, v188, v189
 v_lshlrev_b32 v188, 16, v26
 v_and_b32 v189, 0xffff0000, v26
 v_mul_f32 v188, v188, v31
 v_mul_f32 v189, v189, v31
 v_cvt_pk_bf16_f32 v26, v188, v189
 v_lshlrev_b32 v188, 16, v26
 v_and_b32 v189, 0xffff0000, v26
 v_add_f32 v188, v188, v108
 v_add_f32 v189, v189, v109
 v_cvt_pk_bf16_f32 v108, v188, v189
 v_cvt_pk_bf16_f32 v26, v190, v191
 v_lshlrev_b32 v190, 16, v26
 v_and_b32 v191, 0xffff0000, v26
 v_mul_f32 v190, v190, v31
 v_mul_f32 v191, v191, v31
 v_cvt_pk_bf16_f32 v26, v190, v191
 v_lshlrev_b32 v190, 16, v26
 v_and_b32 v191, 0xffff0000, v26
 v_add_f32 v190, v190, v110
 v_add_f32 v191, v191, v111
 v_cvt_pk_bf16_f32 v109, v190, v191
 buffer_store_dwordx2 v[108:109], v9, s[8:11], s23 offen offset:32
 s_waitcnt vmcnt(19)
 v_cvt_pk_bf16_f32 v26, v192, v193
 v_lshlrev_b32 v192, 16, v26
 v_and_b32 v193, 0xffff0000, v26
 v_mul_f32 v192, v192, v31
 v_mul_f32 v193, v193, v31
 v_cvt_pk_bf16_f32 v26, v192, v193
 v_lshlrev_b32 v192, 16, v26
 v_and_b32 v193, 0xffff0000, v26
 v_add_f32 v192, v192, v112
 v_add_f32 v193, v193, v113
 v_cvt_pk_bf16_f32 v112, v192, v193
 v_cvt_pk_bf16_f32 v26, v194, v195
 v_lshlrev_b32 v194, 16, v26
 v_and_b32 v195, 0xffff0000, v26
 v_mul_f32 v194, v194, v31
 v_mul_f32 v195, v195, v31
 v_cvt_pk_bf16_f32 v26, v194, v195
 v_lshlrev_b32 v194, 16, v26
 v_and_b32 v195, 0xffff0000, v26
 v_add_f32 v194, v194, v114
 v_add_f32 v195, v195, v115
 v_cvt_pk_bf16_f32 v113, v194, v195
 buffer_store_dwordx2 v[112:113], v9, s[8:11], s23 offen offset:64
 s_waitcnt vmcnt(19)
 v_cvt_pk_bf16_f32 v26, v196, v197
 v_lshlrev_b32 v196, 16, v26
 v_and_b32 v197, 0xffff0000, v26
 v_mul_f32 v196, v196, v31
 v_mul_f32 v197, v197, v31
 v_cvt_pk_bf16_f32 v26, v196, v197
 v_lshlrev_b32 v196, 16, v26
 v_and_b32 v197, 0xffff0000, v26
 v_add_f32 v196, v196, v116
 v_add_f32 v197, v197, v117
 v_cvt_pk_bf16_f32 v116, v196, v197
 v_cvt_pk_bf16_f32 v26, v198, v199
 v_lshlrev_b32 v198, 16, v26
 v_and_b32 v199, 0xffff0000, v26
 v_mul_f32 v198, v198, v31
 v_mul_f32 v199, v199, v31
 v_cvt_pk_bf16_f32 v26, v198, v199
 v_lshlrev_b32 v198, 16, v26
 v_and_b32 v199, 0xffff0000, v26
 v_add_f32 v198, v198, v118
 v_add_f32 v199, v199, v119
 v_cvt_pk_bf16_f32 v117, v198, v199
 buffer_store_dwordx2 v[116:117], v9, s[8:11], s23 offen offset:96
 s_waitcnt vmcnt(19)
 v_cvt_pk_bf16_f32 v26, v200, v201
 v_lshlrev_b32 v200, 16, v26
 v_and_b32 v201, 0xffff0000, v26
 v_mul_f32 v200, v200, v31
 v_mul_f32 v201, v201, v31
 v_cvt_pk_bf16_f32 v26, v200, v201
 v_lshlrev_b32 v200, 16, v26
 v_and_b32 v201, 0xffff0000, v26
 v_add_f32 v200, v200, v120
 v_add_f32 v201, v201, v121
 v_cvt_pk_bf16_f32 v120, v200, v201
 v_cvt_pk_bf16_f32 v26, v202, v203
 v_lshlrev_b32 v202, 16, v26
 v_and_b32 v203, 0xffff0000, v26
 v_mul_f32 v202, v202, v31
 v_mul_f32 v203, v203, v31
 v_cvt_pk_bf16_f32 v26, v202, v203
 v_lshlrev_b32 v202, 16, v26
 v_and_b32 v203, 0xffff0000, v26
 v_add_f32 v202, v202, v122
 v_add_f32 v203, v203, v123
 v_cvt_pk_bf16_f32 v121, v202, v203
 buffer_store_dwordx2 v[120:121], v9, s[8:11], s23 offen offset:128
 s_waitcnt vmcnt(19)
 v_cvt_pk_bf16_f32 v26, v204, v205
 v_lshlrev_b32 v204, 16, v26
 v_and_b32 v205, 0xffff0000, v26
 v_mul_f32 v204, v204, v31
 v_mul_f32 v205, v205, v31
 v_cvt_pk_bf16_f32 v26, v204, v205
 v_lshlrev_b32 v204, 16, v26
 v_and_b32 v205, 0xffff0000, v26
 v_add_f32 v204, v204, v124
 v_add_f32 v205, v205, v125
 v_cvt_pk_bf16_f32 v124, v204, v205
 v_cvt_pk_bf16_f32 v26, v206, v207
 v_lshlrev_b32 v206, 16, v26
 v_and_b32 v207, 0xffff0000, v26
 v_mul_f32 v206, v206, v31
 v_mul_f32 v207, v207, v31
 v_cvt_pk_bf16_f32 v26, v206, v207
 v_lshlrev_b32 v206, 16, v26
 v_and_b32 v207, 0xffff0000, v26
 v_add_f32 v206, v206, v126
 v_add_f32 v207, v207, v127
 v_cvt_pk_bf16_f32 v125, v206, v207
 buffer_store_dwordx2 v[124:125], v9, s[8:11], s23 offen offset:160
 s_waitcnt vmcnt(19)
 v_cvt_pk_bf16_f32 v26, v208, v209
 v_lshlrev_b32 v208, 16, v26
 v_and_b32 v209, 0xffff0000, v26
 v_mul_f32 v208, v208, v31
 v_mul_f32 v209, v209, v31
 v_cvt_pk_bf16_f32 v26, v208, v209
 v_lshlrev_b32 v208, 16, v26
 v_and_b32 v209, 0xffff0000, v26
 v_add_f32 v208, v208, v128
 v_add_f32 v209, v209, v129
 v_cvt_pk_bf16_f32 v128, v208, v209
 v_cvt_pk_bf16_f32 v26, v210, v211
 v_lshlrev_b32 v210, 16, v26
 v_and_b32 v211, 0xffff0000, v26
 v_mul_f32 v210, v210, v31
 v_mul_f32 v211, v211, v31
 v_cvt_pk_bf16_f32 v26, v210, v211
 v_lshlrev_b32 v210, 16, v26
 v_and_b32 v211, 0xffff0000, v26
 v_add_f32 v210, v210, v130
 v_add_f32 v211, v211, v131
 v_cvt_pk_bf16_f32 v129, v210, v211
 buffer_store_dwordx2 v[128:129], v9, s[8:11], s23 offen offset:192
 s_waitcnt vmcnt(19)
 v_cvt_pk_bf16_f32 v26, v212, v213
 v_lshlrev_b32 v212, 16, v26
 v_and_b32 v213, 0xffff0000, v26
 v_mul_f32 v212, v212, v31
 v_mul_f32 v213, v213, v31
 v_cvt_pk_bf16_f32 v26, v212, v213
 v_lshlrev_b32 v212, 16, v26
 v_and_b32 v213, 0xffff0000, v26
 v_add_f32 v212, v212, v132
 v_add_f32 v213, v213, v133
 v_cvt_pk_bf16_f32 v132, v212, v213
 v_cvt_pk_bf16_f32 v26, v214, v215
 v_lshlrev_b32 v214, 16, v26
 v_and_b32 v215, 0xffff0000, v26
 v_mul_f32 v214, v214, v31
 v_mul_f32 v215, v215, v31
 v_cvt_pk_bf16_f32 v26, v214, v215
 v_lshlrev_b32 v214, 16, v26
 v_and_b32 v215, 0xffff0000, v26
 v_add_f32 v214, v214, v134
 v_add_f32 v215, v215, v135
 v_cvt_pk_bf16_f32 v133, v214, v215
 buffer_store_dwordx2 v[132:133], v9, s[8:11], s23 offen offset:224
 s_waitcnt vmcnt(19)
 v_cvt_pk_bf16_f32 v26, v216, v217
 v_lshlrev_b32 v216, 16, v26
 v_and_b32 v217, 0xffff0000, v26
 v_mul_f32 v216, v216, v31
 v_mul_f32 v217, v217, v31
 v_cvt_pk_bf16_f32 v26, v216, v217
 v_lshlrev_b32 v216, 16, v26
 v_and_b32 v217, 0xffff0000, v26
 v_add_f32 v216, v216, v136
 v_add_f32 v217, v217, v137
 v_cvt_pk_bf16_f32 v136, v216, v217
 v_cvt_pk_bf16_f32 v26, v218, v219
 v_lshlrev_b32 v218, 16, v26
 v_and_b32 v219, 0xffff0000, v26
 v_mul_f32 v218, v218, v31
 v_mul_f32 v219, v219, v31
 v_cvt_pk_bf16_f32 v26, v218, v219
 v_lshlrev_b32 v218, 16, v26
 v_and_b32 v219, 0xffff0000, v26
 v_add_f32 v218, v218, v138
 v_add_f32 v219, v219, v139
 v_cvt_pk_bf16_f32 v137, v218, v219
 buffer_store_dwordx2 v[136:137], v9, s[8:11], s23 offen offset:256
 s_waitcnt vmcnt(19)
 v_cvt_pk_bf16_f32 v26, v220, v221
 v_lshlrev_b32 v220, 16, v26
 v_and_b32 v221, 0xffff0000, v26
 v_mul_f32 v220, v220, v31
 v_mul_f32 v221, v221, v31
 v_cvt_pk_bf16_f32 v26, v220, v221
 v_lshlrev_b32 v220, 16, v26
 v_and_b32 v221, 0xffff0000, v26
 v_add_f32 v220, v220, v140
 v_add_f32 v221, v221, v141
 v_cvt_pk_bf16_f32 v140, v220, v221
 v_cvt_pk_bf16_f32 v26, v222, v223
 v_lshlrev_b32 v222, 16, v26
 v_and_b32 v223, 0xffff0000, v26
 v_mul_f32 v222, v222, v31
 v_mul_f32 v223, v223, v31
 v_cvt_pk_bf16_f32 v26, v222, v223
 v_lshlrev_b32 v222, 16, v26
 v_and_b32 v223, 0xffff0000, v26
 v_add_f32 v222, v222, v142
 v_add_f32 v223, v223, v143
 v_cvt_pk_bf16_f32 v141, v222, v223
 buffer_store_dwordx2 v[140:141], v9, s[8:11], s23 offen offset:288
om_243:
 s_waitcnt vmcnt(0) lgkmcnt(0)
 s_barrier
 s_sub_u32 s21, s2, 16
 s_cmp_ge_u32 s2, 48
 s_cbranch_scc1 do_opb2
 s_cmp_eq_u32 s87, -1
 s_cbranch_scc1 queue
tail_item:
 s_load_dwordx2 s[4:5], s[0:1], 96
 s_waitcnt lgkmcnt(0)
 s_mov_b32 s32, s4
 s_mov_b32 s33, s5
 s_mov_b32 s34, 256
 s_mov_b32 s35, 0x00020000
 s_waitcnt vmcnt(0)
 s_barrier
 s_mov_b32 s21, s87
do_pv:
 s_mov_b32 s2, s21
 s_load_dwordx2 s[4:5], s[0:1], 88
 s_load_dwordx2 s[38:39], s[0:1], 104
 s_waitcnt lgkmcnt(0)
 s_mov_b32 s8, s4
 s_mov_b32 s9, s5
 s_mov_b32 s10, 2621440
 s_mov_b32 s11, 0x00020000
 s_add_u32 s12, s38, 88080384
 s_addc_u32 s13, s39, 0
 s_mov_b32 s14, 83886080
 s_mov_b32 s15, 0x00020000
 s_mov_b32 s59, 0
 s_mov_b32 s60, 0
 s_add_u32 s16, s38, 180355072
 s_addc_u32 s17, s39, 0
 s_mov_b32 s18, 67108864
 s_mov_b32 s19, 0x00020000
 s_add_u32 s24, s38, 180355072
 s_addc_u32 s25, s39, 0
 s_mov_b32 s26, 67108864
 s_mov_b32 s27, 0x00020000
 s_add_u32 s28, s38, 81002496
 s_addc_u32 s29, s39, 0
 s_mov_b32 s30, 8192
 s_mov_b32 s31, 0x00020000
 s_add_u32 s72, s38, 81068032
 s_addc_u32 s73, s39, 0
 s_mov_b32 s74, 129024
 s_mov_b32 s75, 0x00020000
 v_lshlrev_b32 v4, 4, v1
 v_lshlrev_b32 v5, 3, v1
 v_lshlrev_b32 v6, 2, v2
 v_and_b32 v7, 7, v1
 v_lshlrev_b32 v7, 7, v7
 v_lshrrev_b32 v31, 3, v1
 v_lshl_add_u32 v208, v31, 10, v7
 v_bfe_u32 v31, v1, 3, 2
 v_lshl_add_u32 v31, v31, 12, v7
 s_lshl_b32 s21, s20, 10
 s_add_u32 s21, s21, 95232
 buffer_load_dword v8, v31, s[72:75], s21 offen sc1
 v_lshlrev_b32 v25, 7, v2
 s_mov_b32 s21, 93184
 buffer_load_dword v26, v25, s[72:75], s21 offen sc1
 s_mov_b32 s63, 1
 v_mul_u32_u24 v9, 1280, v2
 v_lshl_add_u32 v9, v3, 3, v9
 s_lshl_b32 s21, s20, 13
 v_add_u32 v10, s21, v4
 s_lshl_b32 s21, s20, 10
 v_add_u32 v11, s21, v4
 v_lshrrev_b32 v20, 5, v1
 v_mul_u32_u24 v21, 2560, v20
 v_add_u32 v21, v21, v4
 v_and_b32 v22, 31, v1
 v_lshlrev_b32 v22, 4, v22
 v_mul_u32_u24 v20, 10240, v20
 v_add_u32 v22, v22, v20
 v_mul_u32_u24 v21, 2048, v3
 v_lshl_add_u32 v21, v2, 4, v21
 v_mul_u32_u24 v22, 1024, v3
 v_lshl_add_u32 v22, v2, 4, v22
 v_mov_b32 v28, 80
 v_mov_b32 v30, 32768
 s_mov_b32 s50, 0
 s_mov_b32 s71, 0
 s_mov_b32 s51, 0
 s_and_b32 s43, s20, 1
 s_lshr_b32 s44, s20, 1
 v_mov_b32 v70, 0
 v_mov_b32 v71, 0
 v_mov_b32 v78, 0
 v_mov_b32 v79, 0
 v_mov_b32 v86, 0
 v_mov_b32 v87, 0
 v_mov_b32 v94, 0
 v_mov_b32 v95, 0
 v_mov_b32 v102, 0
 v_mov_b32 v103, 0
 v_mov_b32 v110, 0
 v_mov_b32 v111, 0
 v_mov_b32 v118, 0
 v_mov_b32 v119, 0
 v_mov_b32 v126, 0
 v_mov_b32 v127, 0
 s_mov_b32 s21, s2
pv_loop:
 s_mul_i32 s2, s21, 2
 s_add_u32 s2, s2, 192
 s_add_u32 s22, s21, 376
 s_cmp_lt_u32 s21, 184
 s_cselect_b32 s2, s2, s22
 s_cselect_b32 s65, 1, 0
 s_mul_i32 s22, s21, 5
 s_cmp_lt_u32 s21, 64
 s_cselect_b32 s2, s22, s2
 s_cselect_b32 s65, 4, s65
 s_mul_hi_u32 s40, s2, 0x1999999a
 s_mul_i32 s21, s40, 10
 s_sub_u32 s41, s2, s21
 s_lshl_b32 s52, s40, 10
 s_add_u32 s52, s52, 23552
 buffer_load_dword v27, v7, s[72:75], s52 offen sc1
 s_cmp_lg_u32 s20, 0
 s_cbranch_scc1 pv_255
 s_sub_u32 s21, s2, 0
 s_cmp_lt_u32 s21, 640
 s_cbranch_scc1 pv_255
 v_mov_b32 v29, 1
 s_mov_b64 exec, 1
 buffer_atomic_add v29, v28, s[32:35], 0 offen sc0 sc1
 s_mov_b64 exec, -1
pv_255:
 s_lshl_b32 s42, s40, 5
 s_lshl_b32 s21, s20, 3
 s_add_u32 s42, s42, s21
 s_lshr_b32 s22, s40, 1
 s_bitcmp1_b32 s37, s22
 s_cselect_b32 s22, 8192, 0
 s_lshl_b32 s62, s40, 20
 s_or_b32 s62, s62, s22
 s_cmp_ge_u32 s40, 40
 s_cselect_b32 s61, 8192, 0
 s_xor_b32 s61, s61, s62
 s_mul_i32 s53, s42, 40960
 s_lshl_b32 s22, s41, 12
 s_add_u32 s53, s53, s22
 s_lshl_b32 s21, s40, 1
 s_add_u32 s21, s21, s43
 s_lshl_b32 s45, s21, 6
 s_mul_i32 s46, s21, 20480
 s_lshl_b32 s21, s41, 4
 s_lshl_b32 s22, s43, 2
 s_add_u32 s21, s21, s22
 s_add_u32 s21, s21, s44
 s_lshl_b32 s54, s21, 10
 s_add_u32 s54, s54, s62
 s_add_u32 s54, s54, 786432
 s_lshl_b32 s22, s41, 2
 s_add_u32 s22, s22, s44
 s_lshl_b32 s22, s22, 5
 s_add_u32 s46, s46, s22
 s_lshl_b32 s47, s20, 15
 s_add_u32 s47, s47, s62
 s_add_u32 s47, s47, 655360
 s_lshl_b32 s48, s41, 16
 s_lshl_b32 s22, s20, 14
 s_add_u32 s48, s48, s22
 s_add_u32 s48, s48, s61
 s_add_u32 s23, s40, 1
 s_cmp_ge_u32 s50, s23
 s_cbranch_scc1 pv_248
 s_cmp_eq_u32 s63, 0
 s_cbranch_scc1 pv_251
 s_mov_b32 s63, 0
 s_waitcnt vmcnt(1)
 v_cmp_le_u32 vcc, 4, v26
 s_mov_b32 s51, vcc_lo
 v_cmp_gt_u32 vcc, s23, v8
 s_nop 1
 s_cbranch_vccz pv_252
pv_251:
 s_lshl_b32 s21, s20, 10
 s_add_u32 s21, s21, 95232
 s_mov_b32 s101, 0
wm_256:
 buffer_load_dword v8, v31, s[72:75], s21 offen sc1
 s_add_u32 s101, s101, 1
 s_cmp_gt_u32 s101, 131072
 s_cbranch_scc1 main_end
 s_waitcnt vmcnt(0)
 v_cmp_gt_u32 vcc, s23, v8
 v_readfirstlane_b32 s100, v8
 s_nop 0
 s_cbranch_vccz wm_257
 s_sleep 8
 s_add_u32 s100, s100, 2
 s_cmp_ge_u32 s100, s23
 s_cbranch_scc1 wm_256
 s_sleep 60
 s_branch wm_256
wm_257:
pv_252:
 v_readlane_b32 s50, v8, 0
 v_readlane_b32 s21, v8, 1
 s_min_u32 s50, s50, s21
 v_readlane_b32 s21, v8, 2
 s_min_u32 s50, s50, s21
 v_readlane_b32 s21, v8, 3
 s_min_u32 s50, s50, s21
 v_readlane_b32 s21, v8, 4
 s_min_u32 s50, s50, s21
 v_readlane_b32 s21, v8, 5
 s_min_u32 s50, s50, s21
 v_readlane_b32 s21, v8, 6
 s_min_u32 s50, s50, s21
 v_readlane_b32 s21, v8, 7
 s_min_u32 s50, s50, s21
 v_readlane_b32 s21, v8, 8
 s_min_u32 s50, s50, s21
 v_readlane_b32 s21, v8, 9
 s_min_u32 s50, s50, s21
 v_readlane_b32 s21, v8, 10
 s_min_u32 s50, s50, s21
 v_readlane_b32 s21, v8, 11
 s_min_u32 s50, s50, s21
 v_readlane_b32 s21, v8, 12
 s_min_u32 s50, s50, s21
 v_readlane_b32 s21, v8, 13
 s_min_u32 s50, s50, s21
 v_readlane_b32 s21, v8, 14
 s_min_u32 s50, s50, s21
 v_readlane_b32 s21, v8, 15
 s_min_u32 s50, s50, s21
 v_readlane_b32 s21, v8, 16
 s_min_u32 s50, s50, s21
 v_readlane_b32 s21, v8, 17
 s_min_u32 s50, s50, s21
 v_readlane_b32 s21, v8, 18
 s_min_u32 s50, s50, s21
 v_readlane_b32 s21, v8, 19
 s_min_u32 s50, s50, s21
 v_readlane_b32 s21, v8, 20
 s_min_u32 s50, s50, s21
 v_readlane_b32 s21, v8, 21
 s_min_u32 s50, s50, s21
 v_readlane_b32 s21, v8, 22
 s_min_u32 s50, s50, s21
 v_readlane_b32 s21, v8, 23
 s_min_u32 s50, s50, s21
 v_readlane_b32 s21, v8, 24
 s_min_u32 s50, s50, s21
 v_readlane_b32 s21, v8, 25
 s_min_u32 s50, s50, s21
 v_readlane_b32 s21, v8, 26
 s_min_u32 s50, s50, s21
 v_readlane_b32 s21, v8, 27
 s_min_u32 s50, s50, s21
 v_readlane_b32 s21, v8, 28
 s_min_u32 s50, s50, s21
 v_readlane_b32 s21, v8, 29
 s_min_u32 s50, s50, s21
 v_readlane_b32 s21, v8, 30
 s_min_u32 s50, s50, s21
 v_readlane_b32 s21, v8, 31
 s_min_u32 s50, s50, s21
pv_248:
 s_lshr_b32 s22, s40, 2
 s_cmp_lt_u32 s40, 48
 s_cbranch_scc1 pv_249
 s_bitcmp1_b32 s51, s22
 s_cbranch_scc1 pv_249
 s_mov_b32 s21, 93184
 v_lshlrev_b32 v25, 7, v2
 s_mov_b32 s101, 0
pv_250:
 buffer_load_dword v26, v25, s[72:75], s21 offen sc1
 s_add_u32 s101, s101, 1
 s_cmp_gt_u32 s101, 131072
 s_cbranch_scc1 main_end
 s_waitcnt vmcnt(0)
 v_cmp_le_u32 vcc, 4, v26
 s_mov_b32 s51, vcc_lo
 s_bitcmp1_b32 s51, s22
 s_cbranch_scc1 pv_249
 s_sleep 8
 s_branch pv_250
pv_249:
 buffer_load_dwordx4 a[0:3], v4, s[12:15], s53 offen offset:0 sc1
 buffer_load_dwordx4 a[4:7], v4, s[12:15], s53 offen offset:1024 sc1
 buffer_load_dwordx4 a[8:11], v4, s[12:15], s53 offen offset:2048 sc1
 buffer_load_dwordx4 a[12:15], v4, s[12:15], s53 offen offset:3072 sc1
 s_add_u32 s53, s53, 40960
 buffer_load_dwordx4 a[16:19], v4, s[12:15], s53 offen offset:0 sc1
 buffer_load_dwordx4 a[20:23], v4, s[12:15], s53 offen offset:1024 sc1
 buffer_load_dwordx4 a[24:27], v4, s[12:15], s53 offen offset:2048 sc1
 buffer_load_dwordx4 a[28:31], v4, s[12:15], s53 offen offset:3072 sc1
 s_add_u32 s53, s53, 40960
 buffer_load_dwordx4 a[32:35], v4, s[12:15], s53 offen offset:0 sc1
 buffer_load_dwordx4 a[36:39], v4, s[12:15], s53 offen offset:1024 sc1
 buffer_load_dwordx4 a[40:43], v4, s[12:15], s53 offen offset:2048 sc1
 buffer_load_dwordx4 a[44:47], v4, s[12:15], s53 offen offset:3072 sc1
 s_add_u32 s53, s53, 40960
 buffer_load_dwordx4 a[48:51], v4, s[12:15], s53 offen offset:0 sc1
 buffer_load_dwordx4 a[52:55], v4, s[12:15], s53 offen offset:1024 sc1
 buffer_load_dwordx4 a[56:59], v4, s[12:15], s53 offen offset:2048 sc1
 buffer_load_dwordx4 a[60:63], v4, s[12:15], s53 offen offset:3072 sc1
 s_add_u32 s53, s53, 40960
 buffer_load_dwordx4 a[64:67], v4, s[12:15], s53 offen offset:0 sc1
 buffer_load_dwordx4 a[68:71], v4, s[12:15], s53 offen offset:1024 sc1
 buffer_load_dwordx4 a[72:75], v4, s[12:15], s53 offen offset:2048 sc1
 buffer_load_dwordx4 a[76:79], v4, s[12:15], s53 offen offset:3072 sc1
 s_add_u32 s53, s53, 40960
 buffer_load_dwordx4 a[80:83], v4, s[12:15], s53 offen offset:0 sc1
 buffer_load_dwordx4 a[84:87], v4, s[12:15], s53 offen offset:1024 sc1
 buffer_load_dwordx4 a[88:91], v4, s[12:15], s53 offen offset:2048 sc1
 buffer_load_dwordx4 a[92:95], v4, s[12:15], s53 offen offset:3072 sc1
 s_add_u32 s53, s53, 40960
 buffer_load_dwordx4 a[96:99], v4, s[12:15], s53 offen offset:0 sc1
 buffer_load_dwordx4 a[100:103], v4, s[12:15], s53 offen offset:1024 sc1
 buffer_load_dwordx4 a[104:107], v4, s[12:15], s53 offen offset:2048 sc1
 buffer_load_dwordx4 a[108:111], v4, s[12:15], s53 offen offset:3072 sc1
 s_add_u32 s53, s53, 40960
 buffer_load_dwordx4 a[112:115], v4, s[12:15], s53 offen offset:0 sc1
 buffer_load_dwordx4 a[116:119], v4, s[12:15], s53 offen offset:1024 sc1
 buffer_load_dwordx4 a[120:123], v4, s[12:15], s53 offen offset:2048 sc1
 buffer_load_dwordx4 a[124:127], v4, s[12:15], s53 offen offset:3072 sc1
 s_cmp_lt_u32 s40, 48
 s_cselect_b32 s70, 0x80000000, s54
 buffer_load_dwordx4 v[12:15], v4, s[24:27], s70 offen sc1
 buffer_load_dwordx4 v[16:19], v4, s[24:27], s70 offen offset:2048 sc1
 buffer_load_dword v24, v6, s[28:31], s45 offen sc1
 s_waitcnt vmcnt(35)
 s_cmp_eq_u32 s71, 0
 s_cbranch_scc1 paf_260
 v_mov_b32 v25, 0
 v_mov_b32 v26, 1
 s_mov_b64 exec, 1
 buffer_atomic_add v26, v25, s[72:75], s71 offen sc1
 s_mov_b64 exec, -1
 s_mov_b32 s71, 0
paf_260:
 v_cmp_le_u32 s[68:69], 4, v27
 s_nop 1
 s_and_b32 s21, s68, 255
 s_cmp_lg_u32 s21, 255
 s_cbranch_scc1 pvw_253
 s_mov_b32 s56, s47
 s_mov_b32 s57, s48
 buffer_load_dwordx4 v[64:67], v4, s[16:19], s56 offen sc1
 buffer_load_dwordx2 v[68:69], v5, s[16:19], s56 offen offset:1536 sc1
 buffer_load_dwordx4 v[128:131], v21, s[16:19], s56 offen offset:1024 sc1
 buffer_load_dwordx4 v[132:135], v21, s[16:19], s56 offen offset:1280 sc1
 s_add_u32 s56, s56, 2048
 buffer_load_dwordx4 v[72:75], v4, s[16:19], s56 offen sc1
 buffer_load_dwordx2 v[76:77], v5, s[16:19], s56 offen offset:1536 sc1
 s_add_u32 s56, s56, 2048
 buffer_load_dwordx4 v[80:83], v4, s[16:19], s56 offen sc1
 buffer_load_dwordx2 v[84:85], v5, s[16:19], s56 offen offset:1536 sc1
 s_add_u32 s56, s56, 2048
 buffer_load_dwordx4 v[88:91], v4, s[16:19], s56 offen sc1
 buffer_load_dwordx2 v[92:93], v5, s[16:19], s56 offen offset:1536 sc1
 s_add_u32 s56, s56, 10240
 buffer_load_dwordx4 v[32:35], v22, s[16:19], s57 offen offset:0 sc1
 buffer_load_dwordx4 v[36:39], v22, s[16:19], s57 offen offset:256 sc1
 buffer_load_dwordx4 v[40:43], v22, s[16:19], s57 offen offset:512 sc1
 buffer_load_dwordx4 v[44:47], v22, s[16:19], s57 offen offset:768 sc1
 s_add_u32 s57, s57, 4096
 buffer_load_dwordx4 v[96:99], v4, s[16:19], s56 offen sc1
 buffer_load_dwordx2 v[100:101], v5, s[16:19], s56 offen offset:1536 sc1
 buffer_load_dwordx4 v[136:139], v21, s[16:19], s56 offen offset:1024 sc1
 buffer_load_dwordx4 v[140:143], v21, s[16:19], s56 offen offset:1280 sc1
 s_add_u32 s56, s56, 2048
 buffer_load_dwordx4 v[104:107], v4, s[16:19], s56 offen sc1
 buffer_load_dwordx2 v[108:109], v5, s[16:19], s56 offen offset:1536 sc1
 s_add_u32 s56, s56, 2048
 buffer_load_dwordx4 v[112:115], v4, s[16:19], s56 offen sc1
 buffer_load_dwordx2 v[116:117], v5, s[16:19], s56 offen offset:1536 sc1
 s_add_u32 s56, s56, 2048
 buffer_load_dwordx4 v[120:123], v4, s[16:19], s56 offen sc1
 buffer_load_dwordx2 v[124:125], v5, s[16:19], s56 offen offset:1536 sc1
 s_add_u32 s56, s56, 10240
 buffer_load_dwordx4 v[48:51], v22, s[16:19], s57 offen offset:0 sc1
 buffer_load_dwordx4 v[52:55], v22, s[16:19], s57 offen offset:256 sc1
 buffer_load_dwordx4 v[56:59], v22, s[16:19], s57 offen offset:512 sc1
 buffer_load_dwordx4 v[60:63], v22, s[16:19], s57 offen offset:768 sc1
 s_add_u32 s57, s57, 4096
 s_barrier
 s_waitcnt vmcnt(28)
 v_sub_f32 v25, 1.0, v24
 v_cvt_pk_bf16_f32 v26, v25, v25
 v_lshlrev_b32 v25, 16, v26
 v_cvt_pk_bf16_f32 v26, v12, v12
 v_lshlrev_b32 v12, 16, v26
 v_cvt_pk_bf16_f32 v26, v13, v13
 v_lshlrev_b32 v13, 16, v26
 v_cvt_pk_bf16_f32 v26, v14, v14
 v_lshlrev_b32 v14, 16, v26
 v_cvt_pk_bf16_f32 v26, v15, v15
 v_lshlrev_b32 v15, 16, v26
 v_cvt_pk_bf16_f32 v26, v16, v16
 v_lshlrev_b32 v16, 16, v26
 v_cvt_pk_bf16_f32 v26, v17, v17
 v_lshlrev_b32 v17, 16, v26
 v_cvt_pk_bf16_f32 v26, v18, v18
 v_lshlrev_b32 v18, 16, v26
 v_cvt_pk_bf16_f32 v26, v19, v19
 v_lshlrev_b32 v19, 16, v26
 v_mul_f32 v12, v12, v25
 v_cvt_pk_bf16_f32 v26, v12, v12
 v_lshlrev_b32 v12, 16, v26
 v_mul_f32 v13, v13, v25
 v_cvt_pk_bf16_f32 v26, v13, v13
 v_lshlrev_b32 v13, 16, v26
 v_mul_f32 v14, v14, v25
 v_cvt_pk_bf16_f32 v26, v14, v14
 v_lshlrev_b32 v14, 16, v26
 v_mul_f32 v15, v15, v25
 v_cvt_pk_bf16_f32 v26, v15, v15
 v_lshlrev_b32 v15, 16, v26
 v_mul_f32 v16, v16, v25
 v_cvt_pk_bf16_f32 v26, v16, v16
 v_lshlrev_b32 v16, 16, v26
 v_mul_f32 v17, v17, v25
 v_cvt_pk_bf16_f32 v26, v17, v17
 v_lshlrev_b32 v17, 16, v26
 v_mul_f32 v18, v18, v25
 v_cvt_pk_bf16_f32 v26, v18, v18
 v_lshlrev_b32 v18, 16, v26
 v_mul_f32 v19, v19, v25
 v_cvt_pk_bf16_f32 v26, v19, v19
 v_lshlrev_b32 v19, 16, v26
 s_cmp_ge_u32 s40, 56
 s_cbranch_scc1 pvc_259
 s_branch pvg_258
pvw_253:
 s_waitcnt vmcnt(0)
 v_sub_f32 v25, 1.0, v24
 v_cvt_pk_bf16_f32 v26, v25, v25
 v_lshlrev_b32 v25, 16, v26
 v_cvt_pk_bf16_f32 v26, v12, v12
 v_lshlrev_b32 v12, 16, v26
 v_cvt_pk_bf16_f32 v26, v13, v13
 v_lshlrev_b32 v13, 16, v26
 v_cvt_pk_bf16_f32 v26, v14, v14
 v_lshlrev_b32 v14, 16, v26
 v_cvt_pk_bf16_f32 v26, v15, v15
 v_lshlrev_b32 v15, 16, v26
 v_cvt_pk_bf16_f32 v26, v16, v16
 v_lshlrev_b32 v16, 16, v26
 v_cvt_pk_bf16_f32 v26, v17, v17
 v_lshlrev_b32 v17, 16, v26
 v_cvt_pk_bf16_f32 v26, v18, v18
 v_lshlrev_b32 v18, 16, v26
 v_cvt_pk_bf16_f32 v26, v19, v19
 v_lshlrev_b32 v19, 16, v26
 v_mul_f32 v12, v12, v25
 v_cvt_pk_bf16_f32 v26, v12, v12
 v_lshlrev_b32 v12, 16, v26
 v_mul_f32 v13, v13, v25
 v_cvt_pk_bf16_f32 v26, v13, v13
 v_lshlrev_b32 v13, 16, v26
 v_mul_f32 v14, v14, v25
 v_cvt_pk_bf16_f32 v26, v14, v14
 v_lshlrev_b32 v14, 16, v26
 v_mul_f32 v15, v15, v25
 v_cvt_pk_bf16_f32 v26, v15, v15
 v_lshlrev_b32 v15, 16, v26
 v_mul_f32 v16, v16, v25
 v_cvt_pk_bf16_f32 v26, v16, v16
 v_lshlrev_b32 v16, 16, v26
 v_mul_f32 v17, v17, v25
 v_cvt_pk_bf16_f32 v26, v17, v17
 v_lshlrev_b32 v17, 16, v26
 v_mul_f32 v18, v18, v25
 v_cvt_pk_bf16_f32 v26, v18, v18
 v_lshlrev_b32 v18, 16, v26
 v_mul_f32 v19, v19, v25
 v_cvt_pk_bf16_f32 v26, v19, v19
 v_lshlrev_b32 v19, 16, v26
 s_cmp_ge_u32 s40, 56
 s_cbranch_scc1 pvt_261
 s_cmp_lg_u32 s20, 0
 s_cbranch_scc1 wm_263
 s_mov_b32 s101, 0
wm_262:
 buffer_load_dword v26, v7, s[72:75], s52 offen sc1
 s_add_u32 s101, s101, 1
 s_cmp_gt_u32 s101, 131072
 s_cbranch_scc1 main_end
 s_waitcnt vmcnt(0)
 v_cmp_gt_u32 vcc, 4, v26
 v_readfirstlane_b32 s100, v26
 s_nop 0
 s_cbranch_vccz wm_263
 s_sleep 2
 s_add_u32 s100, s100, 3
 s_cmp_ge_u32 s100, 4
 s_cbranch_scc1 wm_262
 s_sleep 24
 s_branch wm_262
wm_263:
 s_barrier
 buffer_load_dwordx4 v[64:67], v4, s[16:19], s47 offen sc1
 buffer_load_dwordx2 v[68:69], v5, s[16:19], s47 offen offset:1536 sc1
 buffer_load_dwordx4 v[128:131], v21, s[16:19], s47 offen offset:1024 sc1
 buffer_load_dwordx4 v[132:135], v21, s[16:19], s47 offen offset:1280 sc1
 s_add_u32 s47, s47, 2048
 buffer_load_dwordx4 v[72:75], v4, s[16:19], s47 offen sc1
 buffer_load_dwordx2 v[76:77], v5, s[16:19], s47 offen offset:1536 sc1
 s_add_u32 s47, s47, 2048
 buffer_load_dwordx4 v[80:83], v4, s[16:19], s47 offen sc1
 buffer_load_dwordx2 v[84:85], v5, s[16:19], s47 offen offset:1536 sc1
 s_add_u32 s47, s47, 2048
 buffer_load_dwordx4 v[88:91], v4, s[16:19], s47 offen sc1
 buffer_load_dwordx2 v[92:93], v5, s[16:19], s47 offen offset:1536 sc1
 s_add_u32 s47, s47, 10240
 buffer_load_dwordx4 v[32:35], v22, s[16:19], s48 offen offset:0 sc1
 buffer_load_dwordx4 v[36:39], v22, s[16:19], s48 offen offset:256 sc1
 buffer_load_dwordx4 v[40:43], v22, s[16:19], s48 offen offset:512 sc1
 buffer_load_dwordx4 v[44:47], v22, s[16:19], s48 offen offset:768 sc1
 s_add_u32 s48, s48, 4096
 buffer_load_dwordx4 v[96:99], v4, s[16:19], s47 offen sc1
 buffer_load_dwordx2 v[100:101], v5, s[16:19], s47 offen offset:1536 sc1
 buffer_load_dwordx4 v[136:139], v21, s[16:19], s47 offen offset:1024 sc1
 buffer_load_dwordx4 v[140:143], v21, s[16:19], s47 offen offset:1280 sc1
 s_add_u32 s47, s47, 2048
 buffer_load_dwordx4 v[104:107], v4, s[16:19], s47 offen sc1
 buffer_load_dwordx2 v[108:109], v5, s[16:19], s47 offen offset:1536 sc1
 s_add_u32 s47, s47, 2048
 buffer_load_dwordx4 v[112:115], v4, s[16:19], s47 offen sc1
 buffer_load_dwordx2 v[116:117], v5, s[16:19], s47 offen offset:1536 sc1
 s_add_u32 s47, s47, 2048
 buffer_load_dwordx4 v[120:123], v4, s[16:19], s47 offen sc1
 buffer_load_dwordx2 v[124:125], v5, s[16:19], s47 offen offset:1536 sc1
 s_add_u32 s47, s47, 10240
 buffer_load_dwordx4 v[48:51], v22, s[16:19], s48 offen offset:0 sc1
 buffer_load_dwordx4 v[52:55], v22, s[16:19], s48 offen offset:256 sc1
 buffer_load_dwordx4 v[56:59], v22, s[16:19], s48 offen offset:512 sc1
 buffer_load_dwordx4 v[60:63], v22, s[16:19], s48 offen offset:768 sc1
 s_add_u32 s48, s48, 4096
pvg_258:
 s_add_u32 s41, s41, 1
 s_mul_i32 s53, s42, 40960
 s_lshl_b32 s22, s41, 12
 s_add_u32 s53, s53, s22
 s_lshl_b32 s48, s41, 16
 s_lshl_b32 s22, s20, 14
 s_add_u32 s48, s48, s22
 s_add_u32 s48, s48, s61
 s_waitcnt vmcnt(26)
 v_mfma_f32_16x16x32_bf16 v[148:151], a[0:3], v[64:67], 0
 v_mfma_f32_16x16x32_bf16 v[144:147], a[0:3], v[68:71], 0
 v_mfma_f32_16x16x32_bf16 v[156:159], a[4:7], v[64:67], 0
 v_mfma_f32_16x16x32_bf16 v[152:155], a[4:7], v[68:71], 0
 v_mfma_f32_16x16x32_bf16 v[164:167], a[8:11], v[64:67], 0
 v_mfma_f32_16x16x32_bf16 v[160:163], a[8:11], v[68:71], 0
 v_mfma_f32_16x16x32_bf16 v[172:175], a[12:15], v[64:67], 0
 v_mfma_f32_16x16x32_bf16 v[168:171], a[12:15], v[68:71], 0
 buffer_load_dwordx4 a[0:3], v4, s[12:15], s53 offen offset:0 sc1
 buffer_load_dwordx4 a[4:7], v4, s[12:15], s53 offen offset:1024 sc1
 buffer_load_dwordx4 a[8:11], v4, s[12:15], s53 offen offset:2048 sc1
 buffer_load_dwordx4 a[12:15], v4, s[12:15], s53 offen offset:3072 sc1
 s_waitcnt vmcnt(26)
 v_mfma_f32_16x16x32_bf16 v[148:151], a[16:19], v[72:75], v[148:151]
 v_mfma_f32_16x16x32_bf16 v[144:147], a[16:19], v[76:79], v[144:147]
 v_mfma_f32_16x16x32_bf16 v[156:159], a[20:23], v[72:75], v[156:159]
 v_mfma_f32_16x16x32_bf16 v[152:155], a[20:23], v[76:79], v[152:155]
 v_mfma_f32_16x16x32_bf16 v[164:167], a[24:27], v[72:75], v[164:167]
 v_mfma_f32_16x16x32_bf16 v[160:163], a[24:27], v[76:79], v[160:163]
 v_mfma_f32_16x16x32_bf16 v[172:175], a[28:31], v[72:75], v[172:175]
 v_mfma_f32_16x16x32_bf16 v[168:171], a[28:31], v[76:79], v[168:171]
 s_add_u32 s53, s53, 40960
 buffer_load_dwordx4 a[16:19], v4, s[12:15], s53 offen offset:0 sc1
 buffer_load_dwordx4 a[20:23], v4, s[12:15], s53 offen offset:1024 sc1
 buffer_load_dwordx4 a[24:27], v4, s[12:15], s53 offen offset:2048 sc1
 buffer_load_dwordx4 a[28:31], v4, s[12:15], s53 offen offset:3072 sc1
 s_waitcnt vmcnt(28)
 v_mfma_f32_16x16x32_bf16 v[148:151], a[32:35], v[80:83], v[148:151]
 v_mfma_f32_16x16x32_bf16 v[144:147], a[32:35], v[84:87], v[144:147]
 v_mfma_f32_16x16x32_bf16 v[156:159], a[36:39], v[80:83], v[156:159]
 v_mfma_f32_16x16x32_bf16 v[152:155], a[36:39], v[84:87], v[152:155]
 v_mfma_f32_16x16x32_bf16 v[164:167], a[40:43], v[80:83], v[164:167]
 v_mfma_f32_16x16x32_bf16 v[160:163], a[40:43], v[84:87], v[160:163]
 v_mfma_f32_16x16x32_bf16 v[172:175], a[44:47], v[80:83], v[172:175]
 v_mfma_f32_16x16x32_bf16 v[168:171], a[44:47], v[84:87], v[168:171]
 s_add_u32 s53, s53, 40960
 buffer_load_dwordx4 a[32:35], v4, s[12:15], s53 offen offset:0 sc1
 buffer_load_dwordx4 a[36:39], v4, s[12:15], s53 offen offset:1024 sc1
 buffer_load_dwordx4 a[40:43], v4, s[12:15], s53 offen offset:2048 sc1
 buffer_load_dwordx4 a[44:47], v4, s[12:15], s53 offen offset:3072 sc1
 s_waitcnt vmcnt(30)
 v_mfma_f32_16x16x32_bf16 v[148:151], a[48:51], v[88:91], v[148:151]
 v_mfma_f32_16x16x32_bf16 v[144:147], a[48:51], v[92:95], v[144:147]
 v_mfma_f32_16x16x32_bf16 v[156:159], a[52:55], v[88:91], v[156:159]
 v_mfma_f32_16x16x32_bf16 v[152:155], a[52:55], v[92:95], v[152:155]
 v_mfma_f32_16x16x32_bf16 v[164:167], a[56:59], v[88:91], v[164:167]
 v_mfma_f32_16x16x32_bf16 v[160:163], a[56:59], v[92:95], v[160:163]
 v_mfma_f32_16x16x32_bf16 v[172:175], a[60:63], v[88:91], v[172:175]
 v_mfma_f32_16x16x32_bf16 v[168:171], a[60:63], v[92:95], v[168:171]
 s_add_u32 s53, s53, 40960
 buffer_load_dwordx4 a[48:51], v4, s[12:15], s53 offen offset:0 sc1
 buffer_load_dwordx4 a[52:55], v4, s[12:15], s53 offen offset:1024 sc1
 buffer_load_dwordx4 a[56:59], v4, s[12:15], s53 offen offset:2048 sc1
 buffer_load_dwordx4 a[60:63], v4, s[12:15], s53 offen offset:3072 sc1
 s_waitcnt vmcnt(30)
 v_mfma_f32_16x16x32_bf16 v[144:147], v[32:35], v[128:131], v[144:147]
 v_mfma_f32_16x16x32_bf16 v[148:151], v[32:35], v[132:135], v[148:151]
 v_mfma_f32_16x16x32_bf16 v[152:155], v[36:39], v[128:131], v[152:155]
 v_mfma_f32_16x16x32_bf16 v[156:159], v[36:39], v[132:135], v[156:159]
 v_mfma_f32_16x16x32_bf16 v[160:163], v[40:43], v[128:131], v[160:163]
 v_mfma_f32_16x16x32_bf16 v[164:167], v[40:43], v[132:135], v[164:167]
 v_mfma_f32_16x16x32_bf16 v[168:171], v[44:47], v[128:131], v[168:171]
 v_mfma_f32_16x16x32_bf16 v[172:175], v[44:47], v[132:135], v[172:175]
 buffer_load_dwordx4 v[32:35], v22, s[16:19], s48 offen offset:0 sc1
 buffer_load_dwordx4 v[36:39], v22, s[16:19], s48 offen offset:256 sc1
 buffer_load_dwordx4 v[40:43], v22, s[16:19], s48 offen offset:512 sc1
 buffer_load_dwordx4 v[44:47], v22, s[16:19], s48 offen offset:768 sc1
 s_add_u32 s48, s48, 4096
 s_waitcnt vmcnt(32)
 v_mfma_f32_16x16x32_bf16 v[148:151], a[64:67], v[96:99], v[148:151]
 v_mfma_f32_16x16x32_bf16 v[144:147], a[64:67], v[100:103], v[144:147]
 v_mfma_f32_16x16x32_bf16 v[156:159], a[68:71], v[96:99], v[156:159]
 v_mfma_f32_16x16x32_bf16 v[152:155], a[68:71], v[100:103], v[152:155]
 v_mfma_f32_16x16x32_bf16 v[164:167], a[72:75], v[96:99], v[164:167]
 v_mfma_f32_16x16x32_bf16 v[160:163], a[72:75], v[100:103], v[160:163]
 v_mfma_f32_16x16x32_bf16 v[172:175], a[76:79], v[96:99], v[172:175]
 v_mfma_f32_16x16x32_bf16 v[168:171], a[76:79], v[100:103], v[168:171]
 s_add_u32 s53, s53, 40960
 buffer_load_dwordx4 a[64:67], v4, s[12:15], s53 offen offset:0 sc1
 buffer_load_dwordx4 a[68:71], v4, s[12:15], s53 offen offset:1024 sc1
 buffer_load_dwordx4 a[72:75], v4, s[12:15], s53 offen offset:2048 sc1
 buffer_load_dwordx4 a[76:79], v4, s[12:15], s53 offen offset:3072 sc1
 s_waitcnt vmcnt(32)
 v_mfma_f32_16x16x32_bf16 v[148:151], a[80:83], v[104:107], v[148:151]
 v_mfma_f32_16x16x32_bf16 v[144:147], a[80:83], v[108:111], v[144:147]
 v_mfma_f32_16x16x32_bf16 v[156:159], a[84:87], v[104:107], v[156:159]
 v_mfma_f32_16x16x32_bf16 v[152:155], a[84:87], v[108:111], v[152:155]
 v_mfma_f32_16x16x32_bf16 v[164:167], a[88:91], v[104:107], v[164:167]
 v_mfma_f32_16x16x32_bf16 v[160:163], a[88:91], v[108:111], v[160:163]
 v_mfma_f32_16x16x32_bf16 v[172:175], a[92:95], v[104:107], v[172:175]
 v_mfma_f32_16x16x32_bf16 v[168:171], a[92:95], v[108:111], v[168:171]
 s_add_u32 s53, s53, 40960
 buffer_load_dwordx4 a[80:83], v4, s[12:15], s53 offen offset:0 sc1
 buffer_load_dwordx4 a[84:87], v4, s[12:15], s53 offen offset:1024 sc1
 buffer_load_dwordx4 a[88:91], v4, s[12:15], s53 offen offset:2048 sc1
 buffer_load_dwordx4 a[92:95], v4, s[12:15], s53 offen offset:3072 sc1
 s_waitcnt vmcnt(34)
 v_mfma_f32_16x16x32_bf16 v[148:151], a[96:99], v[112:115], v[148:151]
 v_mfma_f32_16x16x32_bf16 v[144:147], a[96:99], v[116:119], v[144:147]
 v_mfma_f32_16x16x32_bf16 v[156:159], a[100:103], v[112:115], v[156:159]
 v_mfma_f32_16x16x32_bf16 v[152:155], a[100:103], v[116:119], v[152:155]
 v_mfma_f32_16x16x32_bf16 v[164:167], a[104:107], v[112:115], v[164:167]
 v_mfma_f32_16x16x32_bf16 v[160:163], a[104:107], v[116:119], v[160:163]
 v_mfma_f32_16x16x32_bf16 v[172:175], a[108:111], v[112:115], v[172:175]
 v_mfma_f32_16x16x32_bf16 v[168:171], a[108:111], v[116:119], v[168:171]
 s_add_u32 s53, s53, 40960
 buffer_load_dwordx4 a[96:99], v4, s[12:15], s53 offen offset:0 sc1
 buffer_load_dwordx4 a[100:103], v4, s[12:15], s53 offen offset:1024 sc1
 buffer_load_dwordx4 a[104:107], v4, s[12:15], s53 offen offset:2048 sc1
 buffer_load_dwordx4 a[108:111], v4, s[12:15], s53 offen offset:3072 sc1
 s_waitcnt vmcnt(36)
 v_mfma_f32_16x16x32_bf16 v[148:151], a[112:115], v[120:123], v[148:151]
 v_mfma_f32_16x16x32_bf16 v[144:147], a[112:115], v[124:127], v[144:147]
 v_mfma_f32_16x16x32_bf16 v[156:159], a[116:119], v[120:123], v[156:159]
 v_mfma_f32_16x16x32_bf16 v[152:155], a[116:119], v[124:127], v[152:155]
 v_mfma_f32_16x16x32_bf16 v[164:167], a[120:123], v[120:123], v[164:167]
 v_mfma_f32_16x16x32_bf16 v[160:163], a[120:123], v[124:127], v[160:163]
 v_mfma_f32_16x16x32_bf16 v[172:175], a[124:127], v[120:123], v[172:175]
 v_mfma_f32_16x16x32_bf16 v[168:171], a[124:127], v[124:127], v[168:171]
 s_add_u32 s53, s53, 40960
 buffer_load_dwordx4 a[112:115], v4, s[12:15], s53 offen offset:0 sc1
 buffer_load_dwordx4 a[116:119], v4, s[12:15], s53 offen offset:1024 sc1
 buffer_load_dwordx4 a[120:123], v4, s[12:15], s53 offen offset:2048 sc1
 buffer_load_dwordx4 a[124:127], v4, s[12:15], s53 offen offset:3072 sc1
 s_waitcnt vmcnt(36)
 v_mfma_f32_16x16x32_bf16 v[144:147], v[48:51], v[136:139], v[144:147]
 v_mfma_f32_16x16x32_bf16 v[148:151], v[48:51], v[140:143], v[148:151]
 v_mfma_f32_16x16x32_bf16 v[152:155], v[52:55], v[136:139], v[152:155]
 v_mfma_f32_16x16x32_bf16 v[156:159], v[52:55], v[140:143], v[156:159]
 v_mfma_f32_16x16x32_bf16 v[160:163], v[56:59], v[136:139], v[160:163]
 v_mfma_f32_16x16x32_bf16 v[164:167], v[56:59], v[140:143], v[164:167]
 v_mfma_f32_16x16x32_bf16 v[168:171], v[60:63], v[136:139], v[168:171]
 v_mfma_f32_16x16x32_bf16 v[172:175], v[60:63], v[140:143], v[172:175]
 buffer_load_dwordx4 v[48:51], v22, s[16:19], s48 offen offset:0 sc1
 buffer_load_dwordx4 v[52:55], v22, s[16:19], s48 offen offset:256 sc1
 buffer_load_dwordx4 v[56:59], v22, s[16:19], s48 offen offset:512 sc1
 buffer_load_dwordx4 v[60:63], v22, s[16:19], s48 offen offset:768 sc1
 s_add_u32 s48, s48, 4096
 s_branch pve_254
pvt_261:
 s_sub_u32 s55, s52, 2048
 s_cmp_lg_u32 s20, 0
 s_cbranch_scc1 wm_265
 s_mov_b32 s101, 0
wm_264:
 buffer_load_dword v26, v7, s[72:75], s55 offen sc1
 s_add_u32 s101, s101, 1
 s_cmp_gt_u32 s101, 131072
 s_cbranch_scc1 main_end
 s_waitcnt vmcnt(0)
 v_cmp_gt_u32 vcc, 4, v26
 v_readfirstlane_b32 s100, v26
 s_nop 0
 s_cbranch_vccz wm_265
 s_sleep 4
 s_add_u32 s100, s100, 3
 s_cmp_ge_u32 s100, 4
 s_cbranch_scc1 wm_264
 s_sleep 24
 s_branch wm_264
wm_265:
 s_barrier
 s_mov_b32 s56, s47
 s_mov_b32 s57, s48
 buffer_load_dwordx4 v[64:67], v4, s[16:19], s56 offen sc1
 buffer_load_dwordx2 v[68:69], v5, s[16:19], s56 offen offset:1536 sc1
 buffer_load_dwordx4 v[128:131], v21, s[16:19], s56 offen offset:1024 sc1
 buffer_load_dwordx4 v[132:135], v21, s[16:19], s56 offen offset:1280 sc1
 s_add_u32 s56, s56, 2048
 buffer_load_dwordx4 v[72:75], v4, s[16:19], s56 offen sc1
 buffer_load_dwordx2 v[76:77], v5, s[16:19], s56 offen offset:1536 sc1
 s_add_u32 s56, s56, 2048
 buffer_load_dwordx4 v[80:83], v4, s[16:19], s56 offen sc1
 buffer_load_dwordx2 v[84:85], v5, s[16:19], s56 offen offset:1536 sc1
 s_add_u32 s56, s56, 2048
 buffer_load_dwordx4 v[88:91], v4, s[16:19], s56 offen sc1
 buffer_load_dwordx2 v[92:93], v5, s[16:19], s56 offen offset:1536 sc1
 s_add_u32 s56, s56, 10240
 buffer_load_dwordx4 v[32:35], v22, s[16:19], s57 offen offset:0 sc1
 buffer_load_dwordx4 v[36:39], v22, s[16:19], s57 offen offset:256 sc1
 buffer_load_dwordx4 v[40:43], v22, s[16:19], s57 offen offset:512 sc1
 buffer_load_dwordx4 v[44:47], v22, s[16:19], s57 offen offset:768 sc1
 s_add_u32 s57, s57, 4096
 buffer_load_dwordx4 v[96:99], v4, s[16:19], s56 offen sc1
 buffer_load_dwordx2 v[100:101], v5, s[16:19], s56 offen offset:1536 sc1
 buffer_load_dwordx4 v[136:139], v21, s[16:19], s56 offen offset:1024 sc1
 buffer_load_dwordx4 v[140:143], v21, s[16:19], s56 offen offset:1280 sc1
 s_add_u32 s56, s56, 2048
 buffer_load_dwordx4 v[104:107], v4, s[16:19], s56 offen sc1
 buffer_load_dwordx2 v[108:109], v5, s[16:19], s56 offen offset:1536 sc1
 s_add_u32 s56, s56, 2048
 buffer_load_dwordx4 v[112:115], v4, s[16:19], s56 offen sc1
 buffer_load_dwordx2 v[116:117], v5, s[16:19], s56 offen offset:1536 sc1
 s_add_u32 s56, s56, 2048
 buffer_load_dwordx4 v[120:123], v4, s[16:19], s56 offen sc1
 buffer_load_dwordx2 v[124:125], v5, s[16:19], s56 offen offset:1536 sc1
 s_add_u32 s56, s56, 10240
 buffer_load_dwordx4 v[48:51], v22, s[16:19], s57 offen offset:0 sc1
 buffer_load_dwordx4 v[52:55], v22, s[16:19], s57 offen offset:256 sc1
 buffer_load_dwordx4 v[56:59], v22, s[16:19], s57 offen offset:512 sc1
 buffer_load_dwordx4 v[60:63], v22, s[16:19], s57 offen offset:768 sc1
 s_add_u32 s57, s57, 4096
pvc_259:
 s_mov_b32 s101, 0
 s_waitcnt vmcnt(14)
 s_branch pvr_267
pvr_266:
 s_sleep 2
 s_add_u32 s56, s47, 0
 s_add_u32 s57, s48, 0
 buffer_load_dwordx4 v[64:67], v4, s[16:19], s56 offen sc1
 buffer_load_dwordx2 v[68:69], v5, s[16:19], s56 offen offset:1536 sc1
 buffer_load_dwordx4 v[128:131], v21, s[16:19], s56 offen offset:1024 sc1
 buffer_load_dwordx4 v[132:135], v21, s[16:19], s56 offen offset:1280 sc1
 s_add_u32 s56, s56, 2048
 buffer_load_dwordx4 v[72:75], v4, s[16:19], s56 offen sc1
 buffer_load_dwordx2 v[76:77], v5, s[16:19], s56 offen offset:1536 sc1
 s_add_u32 s56, s56, 2048
 buffer_load_dwordx4 v[80:83], v4, s[16:19], s56 offen sc1
 buffer_load_dwordx2 v[84:85], v5, s[16:19], s56 offen offset:1536 sc1
 s_add_u32 s56, s56, 2048
 buffer_load_dwordx4 v[88:91], v4, s[16:19], s56 offen sc1
 buffer_load_dwordx2 v[92:93], v5, s[16:19], s56 offen offset:1536 sc1
 s_add_u32 s56, s56, 10240
 buffer_load_dwordx4 v[32:35], v22, s[16:19], s57 offen offset:0 sc1
 buffer_load_dwordx4 v[36:39], v22, s[16:19], s57 offen offset:256 sc1
 buffer_load_dwordx4 v[40:43], v22, s[16:19], s57 offen offset:512 sc1
 buffer_load_dwordx4 v[44:47], v22, s[16:19], s57 offen offset:768 sc1
 s_add_u32 s57, s57, 4096
 s_add_u32 s101, s101, 1
 s_cmp_gt_u32 s101, 131072
 s_cbranch_scc1 main_end
 s_waitcnt vmcnt(0)
pvr_267:
 v_max3_u32 v26, v64, v68, v72
 v_max3_u32 v26, v26, v76, v80
 v_max3_u32 v26, v26, v84, v88
 v_max3_u32 v26, v26, v92, v128
 v_max3_u32 v26, v26, v132, v32
 v_max3_u32 v26, v26, v36, v40
 v_max3_u32 v26, v26, v44, v44
 v_cmp_eq_u32 vcc, -1, v26
 s_nop 1
 s_cbranch_vccnz pvr_266
 v_mfma_f32_16x16x32_bf16 v[148:151], a[0:3], v[64:67], 0
 v_mfma_f32_16x16x32_bf16 v[144:147], a[0:3], v[68:71], 0
 v_mfma_f32_16x16x32_bf16 v[156:159], a[4:7], v[64:67], 0
 v_mfma_f32_16x16x32_bf16 v[152:155], a[4:7], v[68:71], 0
 v_mfma_f32_16x16x32_bf16 v[164:167], a[8:11], v[64:67], 0
 v_mfma_f32_16x16x32_bf16 v[160:163], a[8:11], v[68:71], 0
 v_mfma_f32_16x16x32_bf16 v[172:175], a[12:15], v[64:67], 0
 v_mfma_f32_16x16x32_bf16 v[168:171], a[12:15], v[68:71], 0
 v_mfma_f32_16x16x32_bf16 v[148:151], a[16:19], v[72:75], v[148:151]
 v_mfma_f32_16x16x32_bf16 v[144:147], a[16:19], v[76:79], v[144:147]
 v_mfma_f32_16x16x32_bf16 v[156:159], a[20:23], v[72:75], v[156:159]
 v_mfma_f32_16x16x32_bf16 v[152:155], a[20:23], v[76:79], v[152:155]
 v_mfma_f32_16x16x32_bf16 v[164:167], a[24:27], v[72:75], v[164:167]
 v_mfma_f32_16x16x32_bf16 v[160:163], a[24:27], v[76:79], v[160:163]
 v_mfma_f32_16x16x32_bf16 v[172:175], a[28:31], v[72:75], v[172:175]
 v_mfma_f32_16x16x32_bf16 v[168:171], a[28:31], v[76:79], v[168:171]
 v_mfma_f32_16x16x32_bf16 v[148:151], a[32:35], v[80:83], v[148:151]
 v_mfma_f32_16x16x32_bf16 v[144:147], a[32:35], v[84:87], v[144:147]
 v_mfma_f32_16x16x32_bf16 v[156:159], a[36:39], v[80:83], v[156:159]
 v_mfma_f32_16x16x32_bf16 v[152:155], a[36:39], v[84:87], v[152:155]
 v_mfma_f32_16x16x32_bf16 v[164:167], a[40:43], v[80:83], v[164:167]
 v_mfma_f32_16x16x32_bf16 v[160:163], a[40:43], v[84:87], v[160:163]
 v_mfma_f32_16x16x32_bf16 v[172:175], a[44:47], v[80:83], v[172:175]
 v_mfma_f32_16x16x32_bf16 v[168:171], a[44:47], v[84:87], v[168:171]
 v_mfma_f32_16x16x32_bf16 v[148:151], a[48:51], v[88:91], v[148:151]
 v_mfma_f32_16x16x32_bf16 v[144:147], a[48:51], v[92:95], v[144:147]
 v_mfma_f32_16x16x32_bf16 v[156:159], a[52:55], v[88:91], v[156:159]
 v_mfma_f32_16x16x32_bf16 v[152:155], a[52:55], v[92:95], v[152:155]
 v_mfma_f32_16x16x32_bf16 v[164:167], a[56:59], v[88:91], v[164:167]
 v_mfma_f32_16x16x32_bf16 v[160:163], a[56:59], v[92:95], v[160:163]
 v_mfma_f32_16x16x32_bf16 v[172:175], a[60:63], v[88:91], v[172:175]
 v_mfma_f32_16x16x32_bf16 v[168:171], a[60:63], v[92:95], v[168:171]
 s_nop 1
 v_mfma_f32_16x16x32_bf16 v[144:147], v[32:35], v[128:131], v[144:147]
 v_mfma_f32_16x16x32_bf16 v[148:151], v[32:35], v[132:135], v[148:151]
 v_mfma_f32_16x16x32_bf16 v[152:155], v[36:39], v[128:131], v[152:155]
 v_mfma_f32_16x16x32_bf16 v[156:159], v[36:39], v[132:135], v[156:159]
 v_mfma_f32_16x16x32_bf16 v[160:163], v[40:43], v[128:131], v[160:163]
 v_mfma_f32_16x16x32_bf16 v[164:167], v[40:43], v[132:135], v[164:167]
 v_mfma_f32_16x16x32_bf16 v[168:171], v[44:47], v[128:131], v[168:171]
 v_mfma_f32_16x16x32_bf16 v[172:175], v[44:47], v[132:135], v[172:175]
 s_mov_b32 s101, 0
 s_waitcnt vmcnt(0)
 s_branch pvr_269
pvr_268:
 s_sleep 2
 s_add_u32 s56, s47, 16384
 s_add_u32 s57, s48, 4096
 buffer_load_dwordx4 v[96:99], v4, s[16:19], s56 offen sc1
 buffer_load_dwordx2 v[100:101], v5, s[16:19], s56 offen offset:1536 sc1
 buffer_load_dwordx4 v[136:139], v21, s[16:19], s56 offen offset:1024 sc1
 buffer_load_dwordx4 v[140:143], v21, s[16:19], s56 offen offset:1280 sc1
 s_add_u32 s56, s56, 2048
 buffer_load_dwordx4 v[104:107], v4, s[16:19], s56 offen sc1
 buffer_load_dwordx2 v[108:109], v5, s[16:19], s56 offen offset:1536 sc1
 s_add_u32 s56, s56, 2048
 buffer_load_dwordx4 v[112:115], v4, s[16:19], s56 offen sc1
 buffer_load_dwordx2 v[116:117], v5, s[16:19], s56 offen offset:1536 sc1
 s_add_u32 s56, s56, 2048
 buffer_load_dwordx4 v[120:123], v4, s[16:19], s56 offen sc1
 buffer_load_dwordx2 v[124:125], v5, s[16:19], s56 offen offset:1536 sc1
 s_add_u32 s56, s56, 10240
 buffer_load_dwordx4 v[48:51], v22, s[16:19], s57 offen offset:0 sc1
 buffer_load_dwordx4 v[52:55], v22, s[16:19], s57 offen offset:256 sc1
 buffer_load_dwordx4 v[56:59], v22, s[16:19], s57 offen offset:512 sc1
 buffer_load_dwordx4 v[60:63], v22, s[16:19], s57 offen offset:768 sc1
 s_add_u32 s57, s57, 4096
 s_add_u32 s101, s101, 1
 s_cmp_gt_u32 s101, 131072
 s_cbranch_scc1 main_end
 s_waitcnt vmcnt(0)
pvr_269:
 v_max3_u32 v26, v96, v100, v104
 v_max3_u32 v26, v26, v108, v112
 v_max3_u32 v26, v26, v116, v120
 v_max3_u32 v26, v26, v124, v136
 v_max3_u32 v26, v26, v140, v48
 v_max3_u32 v26, v26, v52, v56
 v_max3_u32 v26, v26, v60, v60
 v_cmp_eq_u32 vcc, -1, v26
 s_nop 1
 s_cbranch_vccnz pvr_268
 v_mfma_f32_16x16x32_bf16 v[148:151], a[64:67], v[96:99], v[148:151]
 v_mfma_f32_16x16x32_bf16 v[144:147], a[64:67], v[100:103], v[144:147]
 v_mfma_f32_16x16x32_bf16 v[156:159], a[68:71], v[96:99], v[156:159]
 v_mfma_f32_16x16x32_bf16 v[152:155], a[68:71], v[100:103], v[152:155]
 v_mfma_f32_16x16x32_bf16 v[164:167], a[72:75], v[96:99], v[164:167]
 v_mfma_f32_16x16x32_bf16 v[160:163], a[72:75], v[100:103], v[160:163]
 v_mfma_f32_16x16x32_bf16 v[172:175], a[76:79], v[96:99], v[172:175]
 v_mfma_f32_16x16x32_bf16 v[168:171], a[76:79], v[100:103], v[168:171]
 v_mfma_f32_16x16x32_bf16 v[148:151], a[80:83], v[104:107], v[148:151]
 v_mfma_f32_16x16x32_bf16 v[144:147], a[80:83], v[108:111], v[144:147]
 v_mfma_f32_16x16x32_bf16 v[156:159], a[84:87], v[104:107], v[156:159]
 v_mfma_f32_16x16x32_bf16 v[152:155], a[84:87], v[108:111], v[152:155]
 v_mfma_f32_16x16x32_bf16 v[164:167], a[88:91], v[104:107], v[164:167]
 v_mfma_f32_16x16x32_bf16 v[160:163], a[88:91], v[108:111], v[160:163]
 v_mfma_f32_16x16x32_bf16 v[172:175], a[92:95], v[104:107], v[172:175]
 v_mfma_f32_16x16x32_bf16 v[168:171], a[92:95], v[108:111], v[168:171]
 v_mfma_f32_16x16x32_bf16 v[148:151], a[96:99], v[112:115], v[148:151]
 v_mfma_f32_16x16x32_bf16 v[144:147], a[96:99], v[116:119], v[144:147]
 v_mfma_f32_16x16x32_bf16 v[156:159], a[100:103], v[112:115], v[156:159]
 v_mfma_f32_16x16x32_bf16 v[152:155], a[100:103], v[116:119], v[152:155]
 v_mfma_f32_16x16x32_bf16 v[164:167], a[104:107], v[112:115], v[164:167]
 v_mfma_f32_16x16x32_bf16 v[160:163], a[104:107], v[116:119], v[160:163]
 v_mfma_f32_16x16x32_bf16 v[172:175], a[108:111], v[112:115], v[172:175]
 v_mfma_f32_16x16x32_bf16 v[168:171], a[108:111], v[116:119], v[168:171]
 v_mfma_f32_16x16x32_bf16 v[148:151], a[112:115], v[120:123], v[148:151]
 v_mfma_f32_16x16x32_bf16 v[144:147], a[112:115], v[124:127], v[144:147]
 v_mfma_f32_16x16x32_bf16 v[156:159], a[116:119], v[120:123], v[156:159]
 v_mfma_f32_16x16x32_bf16 v[152:155], a[116:119], v[124:127], v[152:155]
 v_mfma_f32_16x16x32_bf16 v[164:167], a[120:123], v[120:123], v[164:167]
 v_mfma_f32_16x16x32_bf16 v[160:163], a[120:123], v[124:127], v[160:163]
 v_mfma_f32_16x16x32_bf16 v[172:175], a[124:127], v[120:123], v[172:175]
 v_mfma_f32_16x16x32_bf16 v[168:171], a[124:127], v[124:127], v[168:171]
 s_nop 1
 v_mfma_f32_16x16x32_bf16 v[144:147], v[48:51], v[136:139], v[144:147]
 v_mfma_f32_16x16x32_bf16 v[148:151], v[48:51], v[140:143], v[148:151]
 v_mfma_f32_16x16x32_bf16 v[152:155], v[52:55], v[136:139], v[152:155]
 v_mfma_f32_16x16x32_bf16 v[156:159], v[52:55], v[140:143], v[156:159]
 v_mfma_f32_16x16x32_bf16 v[160:163], v[56:59], v[136:139], v[160:163]
 v_mfma_f32_16x16x32_bf16 v[164:167], v[56:59], v[140:143], v[164:167]
 v_mfma_f32_16x16x32_bf16 v[168:171], v[60:63], v[136:139], v[168:171]
 v_mfma_f32_16x16x32_bf16 v[172:175], v[60:63], v[140:143], v[172:175]
pve_254:
 s_nop 0
 s_or_b32 s21, s20, s65
 s_cbranch_scc1 lc_270
 s_sub_u32 s21, s2, 0
 s_cmp_ge_u32 s21, 640
 s_cbranch_scc1 lc_270
 v_mov_b32 v29, 1
 s_mov_b64 exec, 1
 buffer_atomic_add v29, v28, s[32:35], 0 offen sc0 sc1
 s_mov_b64 exec, -1
lc_270:
 ds_write_b128 v10, v[144:147] offset:0
 ds_write_b128 v10, v[148:151] offset:1024
 ds_write_b128 v10, v[152:155] offset:2048
 ds_write_b128 v10, v[156:159] offset:3072
 ds_write_b128 v10, v[160:163] offset:4096
 ds_write_b128 v10, v[164:167] offset:5120
 ds_write_b128 v10, v[168:171] offset:6144
 ds_write_b128 v10, v[172:175] offset:7168
 s_cmp_lg_u32 s20, 0
 s_cbranch_scc1 pvq_273
 v_readfirstlane_b32 s21, v29
 s_mov_b32 s23, -1
 v_mov_b32 v213, s23
 s_mov_b64 exec, 1
 ds_write_b32 v30, v29
 ds_write_b32 v30, v213 offset:8
 s_mov_b64 exec, -1
pvq_273:
 s_waitcnt lgkmcnt(0)
 s_barrier
 ds_read_b128 v[176:179], v11 offset:0
 ds_read_b128 v[180:183], v11 offset:8192
 ds_read_b128 v[184:187], v11 offset:16384
 ds_read_b128 v[188:191], v11 offset:24576
 ds_read_b128 v[192:195], v11 offset:4096
 ds_read_b128 v[196:199], v11 offset:12288
 ds_read_b128 v[200:203], v11 offset:20480
 ds_read_b128 v[204:207], v11 offset:28672
 ds_read_b32 v23, v30
 ds_read_b32 v213, v30 offset:8
 s_cmp_ge_u32 s40, 48
 s_cbranch_scc1 pvr_276
 s_waitcnt lgkmcnt(6)
 v_pk_add_f32 v[176:177], v[176:177], v[180:181]
 v_pk_add_f32 v[184:185], v[184:185], v[188:189]
 v_pk_add_f32 v[178:179], v[178:179], v[182:183]
 v_pk_add_f32 v[186:187], v[186:187], v[190:191]
 v_pk_add_f32 v[176:177], v[176:177], v[184:185]
 v_pk_add_f32 v[178:179], v[178:179], v[186:187]
 buffer_store_dwordx4 v[176:179], v4, s[24:27], s54 offen offset:0 sc1
 s_waitcnt lgkmcnt(2)
 v_pk_add_f32 v[192:193], v[192:193], v[196:197]
 v_pk_add_f32 v[200:201], v[200:201], v[204:205]
 v_pk_add_f32 v[194:195], v[194:195], v[198:199]
 v_pk_add_f32 v[202:203], v[202:203], v[206:207]
 v_pk_add_f32 v[192:193], v[192:193], v[200:201]
 v_pk_add_f32 v[194:195], v[194:195], v[202:203]
 buffer_store_dwordx4 v[192:195], v4, s[24:27], s54 offen offset:2048 sc1
 s_lshr_b32 s71, s40, 2
 s_lshl_b32 s71, s71, 7
 s_add_u32 s71, s71, 116736
 s_branch pvr_277
pvr_276:
 s_waitcnt lgkmcnt(6)
 v_pk_add_f32 v[176:177], v[176:177], v[180:181]
 v_pk_add_f32 v[184:185], v[184:185], v[188:189]
 v_pk_add_f32 v[178:179], v[178:179], v[182:183]
 v_pk_add_f32 v[186:187], v[186:187], v[190:191]
 v_pk_add_f32 v[176:177], v[176:177], v[184:185]
 v_pk_add_f32 v[178:179], v[178:179], v[186:187]
 v_cvt_pk_bf16_f32 v26, v176, v177
 v_lshlrev_b32 v176, 16, v26
 v_and_b32 v177, 0xffff0000, v26
 v_mul_f32 v176, v176, v24
 v_mul_f32 v177, v177, v24
 v_cvt_pk_bf16_f32 v26, v176, v177
 v_lshlrev_b32 v176, 16, v26
 v_and_b32 v177, 0xffff0000, v26
 v_add_f32 v176, v176, v12
 v_add_f32 v177, v177, v13
 v_cvt_pk_bf16_f32 v180, v176, v177
 v_cvt_pk_bf16_f32 v26, v178, v179
 v_lshlrev_b32 v178, 16, v26
 v_and_b32 v179, 0xffff0000, v26
 v_mul_f32 v178, v178, v24
 v_mul_f32 v179, v179, v24
 v_cvt_pk_bf16_f32 v26, v178, v179
 v_lshlrev_b32 v178, 16, v26
 v_and_b32 v179, 0xffff0000, v26
 v_add_f32 v178, v178, v14
 v_add_f32 v179, v179, v15
 v_cvt_pk_bf16_f32 v181, v178, v179
 buffer_store_dwordx2 v[180:181], v9, s[8:11], s46 offen offset:0
 s_waitcnt lgkmcnt(2)
 v_pk_add_f32 v[192:193], v[192:193], v[196:197]
 v_pk_add_f32 v[200:201], v[200:201], v[204:205]
 v_pk_add_f32 v[194:195], v[194:195], v[198:199]
 v_pk_add_f32 v[202:203], v[202:203], v[206:207]
 v_pk_add_f32 v[192:193], v[192:193], v[200:201]
 v_pk_add_f32 v[194:195], v[194:195], v[202:203]
 v_cvt_pk_bf16_f32 v26, v192, v193
 v_lshlrev_b32 v192, 16, v26
 v_and_b32 v193, 0xffff0000, v26
 v_mul_f32 v192, v192, v24
 v_mul_f32 v193, v193, v24
 v_cvt_pk_bf16_f32 v26, v192, v193
 v_lshlrev_b32 v192, 16, v26
 v_and_b32 v193, 0xffff0000, v26
 v_add_f32 v192, v192, v16
 v_add_f32 v193, v193, v17
 v_cvt_pk_bf16_f32 v196, v192, v193
 v_cvt_pk_bf16_f32 v26, v194, v195
 v_lshlrev_b32 v194, 16, v26
 v_and_b32 v195, 0xffff0000, v26
 v_mul_f32 v194, v194, v24
 v_mul_f32 v195, v195, v24
 v_cvt_pk_bf16_f32 v26, v194, v195
 v_lshlrev_b32 v194, 16, v26
 v_and_b32 v195, 0xffff0000, v26
 v_add_f32 v194, v194, v18
 v_add_f32 v195, v195, v19
 v_cvt_pk_bf16_f32 v197, v194, v195
 buffer_store_dwordx2 v[196:197], v9, s[8:11], s46 offen offset:64
pvr_277:
pvy_278:
 s_cmp_eq_u32 s65, 0
 s_cbranch_scc1 pvy_279
 s_sub_u32 s65, s65, 1
 s_add_u32 s46, s46, 128
 s_add_u32 s54, s54, 16384
 s_cmp_lt_u32 s40, 48
 s_cselect_b32 s70, 0x80000000, s54
 buffer_load_dwordx4 v[12:15], v4, s[24:27], s70 offen sc1
 buffer_load_dwordx4 v[16:19], v4, s[24:27], s70 offen offset:2048 sc1
 buffer_load_dword v24, v6, s[28:31], s45 offen sc1
 s_waitcnt lgkmcnt(0)
 s_barrier
 s_cmp_eq_u32 s65, 0
 s_cbranch_scc1 pvy_280
 s_add_u32 s41, s41, 1
 s_mul_i32 s53, s42, 40960
 s_lshl_b32 s22, s41, 12
 s_add_u32 s53, s53, s22
 s_lshl_b32 s48, s41, 16
 s_lshl_b32 s22, s20, 14
 s_add_u32 s48, s48, s22
 s_add_u32 s48, s48, s61
 s_waitcnt vmcnt(41)
 v_mfma_f32_16x16x32_bf16 v[148:151], a[0:3], v[64:67], 0
 v_mfma_f32_16x16x32_bf16 v[144:147], a[0:3], v[68:71], 0
 v_mfma_f32_16x16x32_bf16 v[156:159], a[4:7], v[64:67], 0
 v_mfma_f32_16x16x32_bf16 v[152:155], a[4:7], v[68:71], 0
 v_mfma_f32_16x16x32_bf16 v[164:167], a[8:11], v[64:67], 0
 v_mfma_f32_16x16x32_bf16 v[160:163], a[8:11], v[68:71], 0
 v_mfma_f32_16x16x32_bf16 v[172:175], a[12:15], v[64:67], 0
 v_mfma_f32_16x16x32_bf16 v[168:171], a[12:15], v[68:71], 0
 buffer_load_dwordx4 a[0:3], v4, s[12:15], s53 offen offset:0 sc1
 buffer_load_dwordx4 a[4:7], v4, s[12:15], s53 offen offset:1024 sc1
 buffer_load_dwordx4 a[8:11], v4, s[12:15], s53 offen offset:2048 sc1
 buffer_load_dwordx4 a[12:15], v4, s[12:15], s53 offen offset:3072 sc1
 s_waitcnt vmcnt(41)
 v_mfma_f32_16x16x32_bf16 v[148:151], a[16:19], v[72:75], v[148:151]
 v_mfma_f32_16x16x32_bf16 v[144:147], a[16:19], v[76:79], v[144:147]
 v_mfma_f32_16x16x32_bf16 v[156:159], a[20:23], v[72:75], v[156:159]
 v_mfma_f32_16x16x32_bf16 v[152:155], a[20:23], v[76:79], v[152:155]
 v_mfma_f32_16x16x32_bf16 v[164:167], a[24:27], v[72:75], v[164:167]
 v_mfma_f32_16x16x32_bf16 v[160:163], a[24:27], v[76:79], v[160:163]
 v_mfma_f32_16x16x32_bf16 v[172:175], a[28:31], v[72:75], v[172:175]
 v_mfma_f32_16x16x32_bf16 v[168:171], a[28:31], v[76:79], v[168:171]
 s_add_u32 s53, s53, 40960
 buffer_load_dwordx4 a[16:19], v4, s[12:15], s53 offen offset:0 sc1
 buffer_load_dwordx4 a[20:23], v4, s[12:15], s53 offen offset:1024 sc1
 buffer_load_dwordx4 a[24:27], v4, s[12:15], s53 offen offset:2048 sc1
 buffer_load_dwordx4 a[28:31], v4, s[12:15], s53 offen offset:3072 sc1
 s_waitcnt vmcnt(41)
 v_mfma_f32_16x16x32_bf16 v[148:151], a[32:35], v[80:83], v[148:151]
 v_mfma_f32_16x16x32_bf16 v[144:147], a[32:35], v[84:87], v[144:147]
 v_mfma_f32_16x16x32_bf16 v[156:159], a[36:39], v[80:83], v[156:159]
 v_mfma_f32_16x16x32_bf16 v[152:155], a[36:39], v[84:87], v[152:155]
 v_mfma_f32_16x16x32_bf16 v[164:167], a[40:43], v[80:83], v[164:167]
 v_mfma_f32_16x16x32_bf16 v[160:163], a[40:43], v[84:87], v[160:163]
 v_mfma_f32_16x16x32_bf16 v[172:175], a[44:47], v[80:83], v[172:175]
 v_mfma_f32_16x16x32_bf16 v[168:171], a[44:47], v[84:87], v[168:171]
 s_add_u32 s53, s53, 40960
 buffer_load_dwordx4 a[32:35], v4, s[12:15], s53 offen offset:0 sc1
 buffer_load_dwordx4 a[36:39], v4, s[12:15], s53 offen offset:1024 sc1
 buffer_load_dwordx4 a[40:43], v4, s[12:15], s53 offen offset:2048 sc1
 buffer_load_dwordx4 a[44:47], v4, s[12:15], s53 offen offset:3072 sc1
 s_waitcnt vmcnt(41)
 v_mfma_f32_16x16x32_bf16 v[148:151], a[48:51], v[88:91], v[148:151]
 v_mfma_f32_16x16x32_bf16 v[144:147], a[48:51], v[92:95], v[144:147]
 v_mfma_f32_16x16x32_bf16 v[156:159], a[52:55], v[88:91], v[156:159]
 v_mfma_f32_16x16x32_bf16 v[152:155], a[52:55], v[92:95], v[152:155]
 v_mfma_f32_16x16x32_bf16 v[164:167], a[56:59], v[88:91], v[164:167]
 v_mfma_f32_16x16x32_bf16 v[160:163], a[56:59], v[92:95], v[160:163]
 v_mfma_f32_16x16x32_bf16 v[172:175], a[60:63], v[88:91], v[172:175]
 v_mfma_f32_16x16x32_bf16 v[168:171], a[60:63], v[92:95], v[168:171]
 s_add_u32 s53, s53, 40960
 buffer_load_dwordx4 a[48:51], v4, s[12:15], s53 offen offset:0 sc1
 buffer_load_dwordx4 a[52:55], v4, s[12:15], s53 offen offset:1024 sc1
 buffer_load_dwordx4 a[56:59], v4, s[12:15], s53 offen offset:2048 sc1
 buffer_load_dwordx4 a[60:63], v4, s[12:15], s53 offen offset:3072 sc1
 s_waitcnt vmcnt(41)
 v_mfma_f32_16x16x32_bf16 v[144:147], v[32:35], v[128:131], v[144:147]
 v_mfma_f32_16x16x32_bf16 v[148:151], v[32:35], v[132:135], v[148:151]
 v_mfma_f32_16x16x32_bf16 v[152:155], v[36:39], v[128:131], v[152:155]
 v_mfma_f32_16x16x32_bf16 v[156:159], v[36:39], v[132:135], v[156:159]
 v_mfma_f32_16x16x32_bf16 v[160:163], v[40:43], v[128:131], v[160:163]
 v_mfma_f32_16x16x32_bf16 v[164:167], v[40:43], v[132:135], v[164:167]
 v_mfma_f32_16x16x32_bf16 v[168:171], v[44:47], v[128:131], v[168:171]
 v_mfma_f32_16x16x32_bf16 v[172:175], v[44:47], v[132:135], v[172:175]
 buffer_load_dwordx4 v[32:35], v22, s[16:19], s48 offen offset:0 sc1
 buffer_load_dwordx4 v[36:39], v22, s[16:19], s48 offen offset:256 sc1
 buffer_load_dwordx4 v[40:43], v22, s[16:19], s48 offen offset:512 sc1
 buffer_load_dwordx4 v[44:47], v22, s[16:19], s48 offen offset:768 sc1
 s_add_u32 s48, s48, 4096
 s_waitcnt vmcnt(41)
 v_mfma_f32_16x16x32_bf16 v[148:151], a[64:67], v[96:99], v[148:151]
 v_mfma_f32_16x16x32_bf16 v[144:147], a[64:67], v[100:103], v[144:147]
 v_mfma_f32_16x16x32_bf16 v[156:159], a[68:71], v[96:99], v[156:159]
 v_mfma_f32_16x16x32_bf16 v[152:155], a[68:71], v[100:103], v[152:155]
 v_mfma_f32_16x16x32_bf16 v[164:167], a[72:75], v[96:99], v[164:167]
 v_mfma_f32_16x16x32_bf16 v[160:163], a[72:75], v[100:103], v[160:163]
 v_mfma_f32_16x16x32_bf16 v[172:175], a[76:79], v[96:99], v[172:175]
 v_mfma_f32_16x16x32_bf16 v[168:171], a[76:79], v[100:103], v[168:171]
 s_add_u32 s53, s53, 40960
 buffer_load_dwordx4 a[64:67], v4, s[12:15], s53 offen offset:0 sc1
 buffer_load_dwordx4 a[68:71], v4, s[12:15], s53 offen offset:1024 sc1
 buffer_load_dwordx4 a[72:75], v4, s[12:15], s53 offen offset:2048 sc1
 buffer_load_dwordx4 a[76:79], v4, s[12:15], s53 offen offset:3072 sc1
 s_waitcnt vmcnt(41)
 v_mfma_f32_16x16x32_bf16 v[148:151], a[80:83], v[104:107], v[148:151]
 v_mfma_f32_16x16x32_bf16 v[144:147], a[80:83], v[108:111], v[144:147]
 v_mfma_f32_16x16x32_bf16 v[156:159], a[84:87], v[104:107], v[156:159]
 v_mfma_f32_16x16x32_bf16 v[152:155], a[84:87], v[108:111], v[152:155]
 v_mfma_f32_16x16x32_bf16 v[164:167], a[88:91], v[104:107], v[164:167]
 v_mfma_f32_16x16x32_bf16 v[160:163], a[88:91], v[108:111], v[160:163]
 v_mfma_f32_16x16x32_bf16 v[172:175], a[92:95], v[104:107], v[172:175]
 v_mfma_f32_16x16x32_bf16 v[168:171], a[92:95], v[108:111], v[168:171]
 s_add_u32 s53, s53, 40960
 buffer_load_dwordx4 a[80:83], v4, s[12:15], s53 offen offset:0 sc1
 buffer_load_dwordx4 a[84:87], v4, s[12:15], s53 offen offset:1024 sc1
 buffer_load_dwordx4 a[88:91], v4, s[12:15], s53 offen offset:2048 sc1
 buffer_load_dwordx4 a[92:95], v4, s[12:15], s53 offen offset:3072 sc1
 s_waitcnt vmcnt(41)
 v_mfma_f32_16x16x32_bf16 v[148:151], a[96:99], v[112:115], v[148:151]
 v_mfma_f32_16x16x32_bf16 v[144:147], a[96:99], v[116:119], v[144:147]
 v_mfma_f32_16x16x32_bf16 v[156:159], a[100:103], v[112:115], v[156:159]
 v_mfma_f32_16x16x32_bf16 v[152:155], a[100:103], v[116:119], v[152:155]
 v_mfma_f32_16x16x32_bf16 v[164:167], a[104:107], v[112:115], v[164:167]
 v_mfma_f32_16x16x32_bf16 v[160:163], a[104:107], v[116:119], v[160:163]
 v_mfma_f32_16x16x32_bf16 v[172:175], a[108:111], v[112:115], v[172:175]
 v_mfma_f32_16x16x32_bf16 v[168:171], a[108:111], v[116:119], v[168:171]
 s_add_u32 s53, s53, 40960
 buffer_load_dwordx4 a[96:99], v4, s[12:15], s53 offen offset:0 sc1
 buffer_load_dwordx4 a[100:103], v4, s[12:15], s53 offen offset:1024 sc1
 buffer_load_dwordx4 a[104:107], v4, s[12:15], s53 offen offset:2048 sc1
 buffer_load_dwordx4 a[108:111], v4, s[12:15], s53 offen offset:3072 sc1
 s_waitcnt vmcnt(41)
 v_mfma_f32_16x16x32_bf16 v[148:151], a[112:115], v[120:123], v[148:151]
 v_mfma_f32_16x16x32_bf16 v[144:147], a[112:115], v[124:127], v[144:147]
 v_mfma_f32_16x16x32_bf16 v[156:159], a[116:119], v[120:123], v[156:159]
 v_mfma_f32_16x16x32_bf16 v[152:155], a[116:119], v[124:127], v[152:155]
 v_mfma_f32_16x16x32_bf16 v[164:167], a[120:123], v[120:123], v[164:167]
 v_mfma_f32_16x16x32_bf16 v[160:163], a[120:123], v[124:127], v[160:163]
 v_mfma_f32_16x16x32_bf16 v[172:175], a[124:127], v[120:123], v[172:175]
 v_mfma_f32_16x16x32_bf16 v[168:171], a[124:127], v[124:127], v[168:171]
 s_add_u32 s53, s53, 40960
 buffer_load_dwordx4 a[112:115], v4, s[12:15], s53 offen offset:0 sc1
 buffer_load_dwordx4 a[116:119], v4, s[12:15], s53 offen offset:1024 sc1
 buffer_load_dwordx4 a[120:123], v4, s[12:15], s53 offen offset:2048 sc1
 buffer_load_dwordx4 a[124:127], v4, s[12:15], s53 offen offset:3072 sc1
 s_waitcnt vmcnt(41)
 v_mfma_f32_16x16x32_bf16 v[144:147], v[48:51], v[136:139], v[144:147]
 v_mfma_f32_16x16x32_bf16 v[148:151], v[48:51], v[140:143], v[148:151]
 v_mfma_f32_16x16x32_bf16 v[152:155], v[52:55], v[136:139], v[152:155]
 v_mfma_f32_16x16x32_bf16 v[156:159], v[52:55], v[140:143], v[156:159]
 v_mfma_f32_16x16x32_bf16 v[160:163], v[56:59], v[136:139], v[160:163]
 v_mfma_f32_16x16x32_bf16 v[164:167], v[56:59], v[140:143], v[164:167]
 v_mfma_f32_16x16x32_bf16 v[168:171], v[60:63], v[136:139], v[168:171]
 v_mfma_f32_16x16x32_bf16 v[172:175], v[60:63], v[140:143], v[172:175]
 buffer_load_dwordx4 v[48:51], v22, s[16:19], s48 offen offset:0 sc1
 buffer_load_dwordx4 v[52:55], v22, s[16:19], s48 offen offset:256 sc1
 buffer_load_dwordx4 v[56:59], v22, s[16:19], s48 offen offset:512 sc1
 buffer_load_dwordx4 v[60:63], v22, s[16:19], s48 offen offset:768 sc1
 s_add_u32 s48, s48, 4096
 s_waitcnt vmcnt(40)
 s_branch pvy_281
pvy_280:
 s_waitcnt vmcnt(41)
 v_mfma_f32_16x16x32_bf16 v[148:151], a[0:3], v[64:67], 0
 v_mfma_f32_16x16x32_bf16 v[144:147], a[0:3], v[68:71], 0
 v_mfma_f32_16x16x32_bf16 v[156:159], a[4:7], v[64:67], 0
 v_mfma_f32_16x16x32_bf16 v[152:155], a[4:7], v[68:71], 0
 v_mfma_f32_16x16x32_bf16 v[164:167], a[8:11], v[64:67], 0
 v_mfma_f32_16x16x32_bf16 v[160:163], a[8:11], v[68:71], 0
 v_mfma_f32_16x16x32_bf16 v[172:175], a[12:15], v[64:67], 0
 v_mfma_f32_16x16x32_bf16 v[168:171], a[12:15], v[68:71], 0
 s_waitcnt vmcnt(37)
 v_mfma_f32_16x16x32_bf16 v[148:151], a[16:19], v[72:75], v[148:151]
 v_mfma_f32_16x16x32_bf16 v[144:147], a[16:19], v[76:79], v[144:147]
 v_mfma_f32_16x16x32_bf16 v[156:159], a[20:23], v[72:75], v[156:159]
 v_mfma_f32_16x16x32_bf16 v[152:155], a[20:23], v[76:79], v[152:155]
 v_mfma_f32_16x16x32_bf16 v[164:167], a[24:27], v[72:75], v[164:167]
 v_mfma_f32_16x16x32_bf16 v[160:163], a[24:27], v[76:79], v[160:163]
 v_mfma_f32_16x16x32_bf16 v[172:175], a[28:31], v[72:75], v[172:175]
 v_mfma_f32_16x16x32_bf16 v[168:171], a[28:31], v[76:79], v[168:171]
 s_waitcnt vmcnt(33)
 v_mfma_f32_16x16x32_bf16 v[148:151], a[32:35], v[80:83], v[148:151]
 v_mfma_f32_16x16x32_bf16 v[144:147], a[32:35], v[84:87], v[144:147]
 v_mfma_f32_16x16x32_bf16 v[156:159], a[36:39], v[80:83], v[156:159]
 v_mfma_f32_16x16x32_bf16 v[152:155], a[36:39], v[84:87], v[152:155]
 v_mfma_f32_16x16x32_bf16 v[164:167], a[40:43], v[80:83], v[164:167]
 v_mfma_f32_16x16x32_bf16 v[160:163], a[40:43], v[84:87], v[160:163]
 v_mfma_f32_16x16x32_bf16 v[172:175], a[44:47], v[80:83], v[172:175]
 v_mfma_f32_16x16x32_bf16 v[168:171], a[44:47], v[84:87], v[168:171]
 s_waitcnt vmcnt(29)
 v_mfma_f32_16x16x32_bf16 v[148:151], a[48:51], v[88:91], v[148:151]
 v_mfma_f32_16x16x32_bf16 v[144:147], a[48:51], v[92:95], v[144:147]
 v_mfma_f32_16x16x32_bf16 v[156:159], a[52:55], v[88:91], v[156:159]
 v_mfma_f32_16x16x32_bf16 v[152:155], a[52:55], v[92:95], v[152:155]
 v_mfma_f32_16x16x32_bf16 v[164:167], a[56:59], v[88:91], v[164:167]
 v_mfma_f32_16x16x32_bf16 v[160:163], a[56:59], v[92:95], v[160:163]
 v_mfma_f32_16x16x32_bf16 v[172:175], a[60:63], v[88:91], v[172:175]
 v_mfma_f32_16x16x32_bf16 v[168:171], a[60:63], v[92:95], v[168:171]
 s_waitcnt vmcnt(25)
 v_mfma_f32_16x16x32_bf16 v[144:147], v[32:35], v[128:131], v[144:147]
 v_mfma_f32_16x16x32_bf16 v[148:151], v[32:35], v[132:135], v[148:151]
 v_mfma_f32_16x16x32_bf16 v[152:155], v[36:39], v[128:131], v[152:155]
 v_mfma_f32_16x16x32_bf16 v[156:159], v[36:39], v[132:135], v[156:159]
 v_mfma_f32_16x16x32_bf16 v[160:163], v[40:43], v[128:131], v[160:163]
 v_mfma_f32_16x16x32_bf16 v[164:167], v[40:43], v[132:135], v[164:167]
 v_mfma_f32_16x16x32_bf16 v[168:171], v[44:47], v[128:131], v[168:171]
 v_mfma_f32_16x16x32_bf16 v[172:175], v[44:47], v[132:135], v[172:175]
 s_waitcnt vmcnt(21)
 v_mfma_f32_16x16x32_bf16 v[148:151], a[64:67], v[96:99], v[148:151]
 v_mfma_f32_16x16x32_bf16 v[144:147], a[64:67], v[100:103], v[144:147]
 v_mfma_f32_16x16x32_bf16 v[156:159], a[68:71], v[96:99], v[156:159]
 v_mfma_f32_16x16x32_bf16 v[152:155], a[68:71], v[100:103], v[152:155]
 v_mfma_f32_16x16x32_bf16 v[164:167], a[72:75], v[96:99], v[164:167]
 v_mfma_f32_16x16x32_bf16 v[160:163], a[72:75], v[100:103], v[160:163]
 v_mfma_f32_16x16x32_bf16 v[172:175], a[76:79], v[96:99], v[172:175]
 v_mfma_f32_16x16x32_bf16 v[168:171], a[76:79], v[100:103], v[168:171]
 s_waitcnt vmcnt(17)
 v_mfma_f32_16x16x32_bf16 v[148:151], a[80:83], v[104:107], v[148:151]
 v_mfma_f32_16x16x32_bf16 v[144:147], a[80:83], v[108:111], v[144:147]
 v_mfma_f32_16x16x32_bf16 v[156:159], a[84:87], v[104:107], v[156:159]
 v_mfma_f32_16x16x32_bf16 v[152:155], a[84:87], v[108:111], v[152:155]
 v_mfma_f32_16x16x32_bf16 v[164:167], a[88:91], v[104:107], v[164:167]
 v_mfma_f32_16x16x32_bf16 v[160:163], a[88:91], v[108:111], v[160:163]
 v_mfma_f32_16x16x32_bf16 v[172:175], a[92:95], v[104:107], v[172:175]
 v_mfma_f32_16x16x32_bf16 v[168:171], a[92:95], v[108:111], v[168:171]
 s_waitcnt vmcnt(13)
 v_mfma_f32_16x16x32_bf16 v[148:151], a[96:99], v[112:115], v[148:151]
 v_mfma_f32_16x16x32_bf16 v[144:147], a[96:99], v[116:119], v[144:147]
 v_mfma_f32_16x16x32_bf16 v[156:159], a[100:103], v[112:115], v[156:159]
 v_mfma_f32_16x16x32_bf16 v[152:155], a[100:103], v[116:119], v[152:155]
 v_mfma_f32_16x16x32_bf16 v[164:167], a[104:107], v[112:115], v[164:167]
 v_mfma_f32_16x16x32_bf16 v[160:163], a[104:107], v[116:119], v[160:163]
 v_mfma_f32_16x16x32_bf16 v[172:175], a[108:111], v[112:115], v[172:175]
 v_mfma_f32_16x16x32_bf16 v[168:171], a[108:111], v[116:119], v[168:171]
 s_waitcnt vmcnt(9)
 v_mfma_f32_16x16x32_bf16 v[148:151], a[112:115], v[120:123], v[148:151]
 v_mfma_f32_16x16x32_bf16 v[144:147], a[112:115], v[124:127], v[144:147]
 v_mfma_f32_16x16x32_bf16 v[156:159], a[116:119], v[120:123], v[156:159]
 v_mfma_f32_16x16x32_bf16 v[152:155], a[116:119], v[124:127], v[152:155]
 v_mfma_f32_16x16x32_bf16 v[164:167], a[120:123], v[120:123], v[164:167]
 v_mfma_f32_16x16x32_bf16 v[160:163], a[120:123], v[124:127], v[160:163]
 v_mfma_f32_16x16x32_bf16 v[172:175], a[124:127], v[120:123], v[172:175]
 v_mfma_f32_16x16x32_bf16 v[168:171], a[124:127], v[124:127], v[168:171]
 s_waitcnt vmcnt(5)
 v_mfma_f32_16x16x32_bf16 v[144:147], v[48:51], v[136:139], v[144:147]
 v_mfma_f32_16x16x32_bf16 v[148:151], v[48:51], v[140:143], v[148:151]
 v_mfma_f32_16x16x32_bf16 v[152:155], v[52:55], v[136:139], v[152:155]
 v_mfma_f32_16x16x32_bf16 v[156:159], v[52:55], v[140:143], v[156:159]
 v_mfma_f32_16x16x32_bf16 v[160:163], v[56:59], v[136:139], v[160:163]
 v_mfma_f32_16x16x32_bf16 v[164:167], v[56:59], v[140:143], v[164:167]
 v_mfma_f32_16x16x32_bf16 v[168:171], v[60:63], v[136:139], v[168:171]
 v_mfma_f32_16x16x32_bf16 v[172:175], v[60:63], v[140:143], v[172:175]
 s_waitcnt vmcnt(0)
pvy_281:
 s_or_b32 s21, s20, s65
 s_cbranch_scc1 lc_282
 s_sub_u32 s21, s2, 0
 s_cmp_ge_u32 s21, 640
 s_cbranch_scc1 lc_282
 v_mov_b32 v29, 1
 s_mov_b64 exec, 1
 buffer_atomic_add v29, v28, s[32:35], 0 offen sc0 sc1
 s_mov_b64 exec, -1
lc_282:
 v_sub_f32 v25, 1.0, v24
 v_cvt_pk_bf16_f32 v26, v25, v25
 v_lshlrev_b32 v25, 16, v26
 v_cvt_pk_bf16_f32 v26, v12, v12
 v_lshlrev_b32 v12, 16, v26
 v_cvt_pk_bf16_f32 v26, v13, v13
 v_lshlrev_b32 v13, 16, v26
 v_cvt_pk_bf16_f32 v26, v14, v14
 v_lshlrev_b32 v14, 16, v26
 v_cvt_pk_bf16_f32 v26, v15, v15
 v_lshlrev_b32 v15, 16, v26
 v_cvt_pk_bf16_f32 v26, v16, v16
 v_lshlrev_b32 v16, 16, v26
 v_cvt_pk_bf16_f32 v26, v17, v17
 v_lshlrev_b32 v17, 16, v26
 v_cvt_pk_bf16_f32 v26, v18, v18
 v_lshlrev_b32 v18, 16, v26
 v_cvt_pk_bf16_f32 v26, v19, v19
 v_lshlrev_b32 v19, 16, v26
 v_mul_f32 v12, v12, v25
 v_cvt_pk_bf16_f32 v26, v12, v12
 v_lshlrev_b32 v12, 16, v26
 v_mul_f32 v13, v13, v25
 v_cvt_pk_bf16_f32 v26, v13, v13
 v_lshlrev_b32 v13, 16, v26
 v_mul_f32 v14, v14, v25
 v_cvt_pk_bf16_f32 v26, v14, v14
 v_lshlrev_b32 v14, 16, v26
 v_mul_f32 v15, v15, v25
 v_cvt_pk_bf16_f32 v26, v15, v15
 v_lshlrev_b32 v15, 16, v26
 v_mul_f32 v16, v16, v25
 v_cvt_pk_bf16_f32 v26, v16, v16
 v_lshlrev_b32 v16, 16, v26
 v_mul_f32 v17, v17, v25
 v_cvt_pk_bf16_f32 v26, v17, v17
 v_lshlrev_b32 v17, 16, v26
 v_mul_f32 v18, v18, v25
 v_cvt_pk_bf16_f32 v26, v18, v18
 v_lshlrev_b32 v18, 16, v26
 v_mul_f32 v19, v19, v25
 v_cvt_pk_bf16_f32 v26, v19, v19
 v_lshlrev_b32 v19, 16, v26
 ds_write_b128 v10, v[144:147] offset:0
 ds_write_b128 v10, v[148:151] offset:1024
 ds_write_b128 v10, v[152:155] offset:2048
 ds_write_b128 v10, v[156:159] offset:3072
 ds_write_b128 v10, v[160:163] offset:4096
 ds_write_b128 v10, v[164:167] offset:5120
 ds_write_b128 v10, v[168:171] offset:6144
 ds_write_b128 v10, v[172:175] offset:7168
 s_waitcnt lgkmcnt(0)
 s_barrier
 ds_read_b128 v[176:179], v11 offset:0
 ds_read_b128 v[180:183], v11 offset:8192
 ds_read_b128 v[184:187], v11 offset:16384
 ds_read_b128 v[188:191], v11 offset:24576
 ds_read_b128 v[192:195], v11 offset:4096
 ds_read_b128 v[196:199], v11 offset:12288
 ds_read_b128 v[200:203], v11 offset:20480
 ds_read_b128 v[204:207], v11 offset:28672
 s_cmp_ge_u32 s40, 48
 s_cbranch_scc1 pvr_283
 s_waitcnt lgkmcnt(4)
 v_pk_add_f32 v[176:177], v[176:177], v[180:181]
 v_pk_add_f32 v[184:185], v[184:185], v[188:189]
 v_pk_add_f32 v[178:179], v[178:179], v[182:183]
 v_pk_add_f32 v[186:187], v[186:187], v[190:191]
 v_pk_add_f32 v[176:177], v[176:177], v[184:185]
 v_pk_add_f32 v[178:179], v[178:179], v[186:187]
 buffer_store_dwordx4 v[176:179], v4, s[24:27], s54 offen offset:0 sc1
 s_waitcnt lgkmcnt(0)
 v_pk_add_f32 v[192:193], v[192:193], v[196:197]
 v_pk_add_f32 v[200:201], v[200:201], v[204:205]
 v_pk_add_f32 v[194:195], v[194:195], v[198:199]
 v_pk_add_f32 v[202:203], v[202:203], v[206:207]
 v_pk_add_f32 v[192:193], v[192:193], v[200:201]
 v_pk_add_f32 v[194:195], v[194:195], v[202:203]
 buffer_store_dwordx4 v[192:195], v4, s[24:27], s54 offen offset:2048 sc1
 s_lshr_b32 s71, s40, 2
 s_lshl_b32 s71, s71, 7
 s_add_u32 s71, s71, 116736
 s_branch pvr_284
pvr_283:
 s_waitcnt lgkmcnt(4)
 v_pk_add_f32 v[176:177], v[176:177], v[180:181]
 v_pk_add_f32 v[184:185], v[184:185], v[188:189]
 v_pk_add_f32 v[178:179], v[178:179], v[182:183]
 v_pk_add_f32 v[186:187], v[186:187], v[190:191]
 v_pk_add_f32 v[176:177], v[176:177], v[184:185]
 v_pk_add_f32 v[178:179], v[178:179], v[186:187]
 v_cvt_pk_bf16_f32 v26, v176, v177
 v_lshlrev_b32 v176, 16, v26
 v_and_b32 v177, 0xffff0000, v26
 v_mul_f32 v176, v176, v24
 v_mul_f32 v177, v177, v24
 v_cvt_pk_bf16_f32 v26, v176, v177
 v_lshlrev_b32 v176, 16, v26
 v_and_b32 v177, 0xffff0000, v26
 v_add_f32 v176, v176, v12
 v_add_f32 v177, v177, v13
 v_cvt_pk_bf16_f32 v180, v176, v177
 v_cvt_pk_bf16_f32 v26, v178, v179
 v_lshlrev_b32 v178, 16, v26
 v_and_b32 v179, 0xffff0000, v26
 v_mul_f32 v178, v178, v24
 v_mul_f32 v179, v179, v24
 v_cvt_pk_bf16_f32 v26, v178, v179
 v_lshlrev_b32 v178, 16, v26
 v_and_b32 v179, 0xffff0000, v26
 v_add_f32 v178, v178, v14
 v_add_f32 v179, v179, v15
 v_cvt_pk_bf16_f32 v181, v178, v179
 buffer_store_dwordx2 v[180:181], v9, s[8:11], s46 offen offset:0
 s_waitcnt lgkmcnt(0)
 v_pk_add_f32 v[192:193], v[192:193], v[196:197]
 v_pk_add_f32 v[200:201], v[200:201], v[204:205]
 v_pk_add_f32 v[194:195], v[194:195], v[198:199]
 v_pk_add_f32 v[202:203], v[202:203], v[206:207]
 v_pk_add_f32 v[192:193], v[192:193], v[200:201]
 v_pk_add_f32 v[194:195], v[194:195], v[202:203]
 v_cvt_pk_bf16_f32 v26, v192, v193
 v_lshlrev_b32 v192, 16, v26
 v_and_b32 v193, 0xffff0000, v26
 v_mul_f32 v192, v192, v24
 v_mul_f32 v193, v193, v24
 v_cvt_pk_bf16_f32 v26, v192, v193
 v_lshlrev_b32 v192, 16, v26
 v_and_b32 v193, 0xffff0000, v26
 v_add_f32 v192, v192, v16
 v_add_f32 v193, v193, v17
 v_cvt_pk_bf16_f32 v196, v192, v193
 v_cvt_pk_bf16_f32 v26, v194, v195
 v_lshlrev_b32 v194, 16, v26
 v_and_b32 v195, 0xffff0000, v26
 v_mul_f32 v194, v194, v24
 v_mul_f32 v195, v195, v24
 v_cvt_pk_bf16_f32 v26, v194, v195
 v_lshlrev_b32 v194, 16, v26
 v_and_b32 v195, 0xffff0000, v26
 v_add_f32 v194, v194, v18
 v_add_f32 v195, v195, v19
 v_cvt_pk_bf16_f32 v197, v194, v195
 buffer_store_dwordx2 v[196:197], v9, s[8:11], s46 offen offset:64
pvr_284:
 s_branch pvy_278
pvy_279:
 s_sub_u32 s21, s2, 0
 s_cmp_ge_u32 s21, 640
 s_cbranch_scc1 lc_285
 s_cmp_lg_u32 s20, 0
 s_cbranch_scc1 lc_285x
 s_waitcnt vmcnt(2)
 s_mov_b64 exec, 1
 ds_write_b32 v30, v29 offset:12
 s_mov_b64 exec, -1
lc_285x:
 s_waitcnt lgkmcnt(0)
 s_barrier
 ds_read_b32 v23, v30 offset:12
lc_285:
 s_waitcnt lgkmcnt(0)
 v_readfirstlane_b32 s2, v23
 v_readfirstlane_b32 s67, v213
 s_barrier
 s_cmp_ge_u32 s40, 40
 s_cselect_b32 s21, s71, 0
 s_cmp_lg_u32 s21, 0
 s_cselect_b32 s21, 9999, s2
 s_cmp_lt_u32 s21, 248
 s_cbranch_scc1 pae_286
 s_waitcnt vmcnt(0)
 s_cmp_eq_u32 s71, 0
 s_cbranch_scc1 paf_287
 v_mov_b32 v25, 0
 v_mov_b32 v26, 1
 s_mov_b64 exec, 1
 buffer_atomic_add v26, v25, s[72:75], s71 offen sc1
 s_mov_b64 exec, -1
 s_mov_b32 s71, 0
paf_287:
pae_286:
 s_add_u32 s21, s2, 0
 s_cmp_lt_u32 s2, 64
 s_cbranch_scc1 pv_loop
 s_sub_u32 s2, s2, 64
 s_add_u32 s21, s2, 64
 s_cmp_lt_u32 s2, 20
 s_cbranch_scc1 pv_loop
 s_sub_u32 s2, s2, 20
 s_add_u32 s21, s2, 104
 s_cmp_lt_u32 s2, 20
 s_cbranch_scc1 pv_loop
 s_sub_u32 s2, s2, 20
 s_add_u32 s21, s2, 84
 s_cmp_lt_u32 s2, 20
 s_cbranch_scc1 pv_loop
 s_sub_u32 s2, s2, 20
 s_add_u32 s21, s2, 124
 s_cmp_lt_u32 s2, 20
 s_cbranch_scc1 pv_loop
 s_sub_u32 s2, s2, 20
 s_add_u32 s21, s2, 144
 s_cmp_lt_u32 s2, 104
 s_cbranch_scc1 pv_loop
 s_sub_u32 s2, s2, 104
 s_branch main_fin
 s_branch queue
main_fin:
 s_waitcnt vmcnt(0)
main_end:
 s_endpgm
code_end:
.section .rodata,"a"
.p2align 6
.amdhsa_kernel gated_mix__memory_aug_recurrent_mem_tr__sliding_local_dilated__prompt_kernel
  .amdhsa_next_free_vgpr 512
  .amdhsa_next_free_sgpr 102
  .amdhsa_accum_offset 256
  .amdhsa_group_segment_fixed_size 0
  .amdhsa_kernarg_size 112
  .amdhsa_user_sgpr_count 2
  .amdhsa_user_sgpr_kernarg_segment_ptr 1
  .amdhsa_system_sgpr_workgroup_id_x 1
.end_amdhsa_kernel
.text
```

```asm
; @launch kernel=gated_mix__memory_aug_recurrent_mem_tr__sliding_local_dilated__prompt_kernel grid=(256,1,1) block=(256,1,1) lds=163840
.amdgcn_target "amdgcn-amd-amdhsa--gfx950"
.text
.globl gated_mix__memory_aug_recurrent_mem_tr__sliding_local_dilated__prompt_kernel
.p2align 8
.type gated_mix__memory_aug_recurrent_mem_tr__sliding_local_dilated__prompt_kernel,@function
gated_mix__memory_aug_recurrent_mem_tr__sliding_local_dilated__prompt_kernel:
 s_cmp_ge_u32 s2, 256
 s_cbranch_scc1 end0
 s_load_dwordx2 s[4:5], s[0:1], 96
 s_load_dwordx2 s[38:39], s[0:1], 104
 v_lshrrev_b32 v1, 6, v0
 v_and_b32 v2, 15, v0
 v_readfirstlane_b32 s20, v1
 v_and_b32 v1, 63, v0
 v_lshrrev_b32 v3, 4, v1
 s_getreg_b32 s50, hwreg(HW_REG_XCC_ID)
 s_and_b32 s50, s50, 7
 s_waitcnt lgkmcnt(0)
 s_mov_b32 s32, s4
 s_mov_b32 s33, s5
 s_mov_b32 s34, 256
 s_mov_b32 s35, 0x00020000
 s_getpc_b64 s[6:7]
cpf_pc:
 s_sub_u32 s6, s6, cpf_pc - gated_mix__memory_aug_recurrent_mem_tr__sliding_local_dilated__prompt_kernel
 s_subb_u32 s7, s7, 0
 s_lshr_b32 s21, s2, 3
 s_lshl_b32 s21, s21, 12
 v_lshl_add_u32 v28, v0, 4, s21
 v_min_u32 v28, code_end - gated_mix__memory_aug_recurrent_mem_tr__sliding_local_dilated__prompt_kernel - 16, v28
 global_load_dwordx4 a[252:255], v28, s[6:7]
 v_lshl_add_u32 v28, v0, 4, s21
 v_add_u32 v28, 0x20000, v28
 v_min_u32 v28, code_end - gated_mix__memory_aug_recurrent_mem_tr__sliding_local_dilated__prompt_kernel - 16, v28
 global_load_dwordx4 a[252:255], v28, s[6:7]
 v_mov_b32 v21, 0
 s_cmp_lg_u32 s20, 0
 s_cbranch_scc1 rk_1
 s_and_b32 s21, s50, 1
 s_lshl_b32 s21, s21, 7
 s_lshl_b32 s22, s50, 1
 s_and_b32 s22, s22, 12
 s_add_u32 s21, s21, s22
 v_mov_b32 v22, s21
 v_mov_b32 v23, 1
 s_mov_b64 exec, 1
 buffer_atomic_add v23, v22, s[32:35], 0 offen sc0 sc1
 s_waitcnt vmcnt(0)
 v_readfirstlane_b32 s51, v23
 s_lshl_b32 s22, s50, 5
 s_add_u32 s22, s22, s51
 s_cmp_lt_u32 s51, 32
 s_cbranch_scc1 rk_2
 v_mov_b32 v24, 72
 v_mov_b32 v25, 1
 buffer_atomic_add v25, v24, s[32:35], 0 offen sc0 sc1
 s_waitcnt vmcnt(0)
 v_readfirstlane_b32 s23, v25
 s_mov_b32 s101, 0
 s_mov_b64 exec, -1
 v_lshlrev_b32 v24, 2, v1
rk_3:
 s_sleep 8
 buffer_load_dword v25, v24, s[32:35], 0 offen sc1
 s_add_u32 s101, s101, 1
 s_cmp_gt_u32 s101, 131072
 s_cbranch_scc1 end0
 s_waitcnt vmcnt(0)
 v_readlane_b32 s21, v25, 0
 v_readlane_b32 s22, v25, 32
 s_add_u32 s21, s21, s22
 v_readlane_b32 s22, v25, 1
 s_add_u32 s21, s21, s22
 v_readlane_b32 s22, v25, 33
 s_add_u32 s21, s21, s22
 v_readlane_b32 s22, v25, 2
 s_add_u32 s21, s21, s22
 v_readlane_b32 s22, v25, 34
 s_add_u32 s21, s21, s22
 v_readlane_b32 s22, v25, 3
 s_add_u32 s21, s21, s22
 v_readlane_b32 s22, v25, 35
 s_add_u32 s21, s21, s22
 s_cmp_lt_u32 s21, 256
 s_cbranch_scc1 rk_3
 s_mov_b64 exec, 1
 s_mov_b32 s24, 0
rk_5:
 s_and_b32 s21, s24, 1
 s_lshl_b32 s21, s21, 5
 s_lshr_b32 s22, s24, 1
 s_add_u32 s21, s21, s22
 v_readlane_b32 s21, v25, s21
 s_min_u32 s21, s21, 32
 s_sub_u32 s25, 32, s21
 s_cmp_lt_u32 s23, s25
 s_cbranch_scc1 rk_4
 s_sub_u32 s23, s23, s25
 s_add_u32 s24, s24, 1
 s_cmp_lt_u32 s24, 8
 s_cbranch_scc1 rk_5
 s_branch end0
rk_4:
 s_lshl_b32 s22, s24, 5
 s_add_u32 s22, s22, s21
 s_add_u32 s22, s22, s23
 s_or_b32 s22, s22, 0x100
rk_2:
 v_mov_b32 v23, s22
 ds_write_b32 v21, v23
 s_waitcnt lgkmcnt(0)
 s_mov_b64 exec, -1
rk_1:
 s_barrier
 ds_read_b32 v23, v21
 s_waitcnt lgkmcnt(0)
 v_readfirstlane_b32 s22, v23
 s_barrier
 s_mov_b32 s84, 0
 s_mov_b32 s85, -1
 s_lshr_b32 s53, s22, 8
 s_and_b32 s22, s22, 255
 s_cmp_ge_u32 s22, 128
 s_cbranch_scc1 gemm_side
 s_lshr_b32 s50, s22, 4
 s_and_b32 s51, s22, 15
 s_mov_b32 s86, 0x3dd53b95
 s_load_dwordx2 s[4:5], s[0:1], 8
 s_load_dwordx4 s[36:39], s[0:1], 16
 s_load_dwordx4 s[40:43], s[0:1], 32
 s_load_dwordx2 s[44:45], s[0:1], 104
 s_lshr_b32 s55, s51, 2
 s_and_b32 s56, s51, 3
 s_lshl_b32 s57, s50, 2
 s_add_u32 s58, s57, s55
 s_add_u32 s59, s57, s20
 s_lshr_b32 s21, s51, 1
 s_xor_b32 s21, s21, s55
 s_andn2_b32 s21, 1, s21
 s_xor_b32 s85, s51, s21
 s_mul_i32 s87, s85, 5
 s_lshr_b32 s87, s87, 1
 s_and_b32 s79, s85, 1
 s_waitcnt lgkmcnt(0)
 s_add_u32 s8, s44, 78643200
 s_addc_u32 s9, s45, 0
 s_mov_b32 s10, 2162688
 s_mov_b32 s11, 0x00020000
 s_mov_b32 s16, s44
 s_mov_b32 s17, s45
 s_mov_b32 s18, 50331648
 s_mov_b32 s19, 0x00020000
 s_add_u32 s24, s44, 180355072
 s_addc_u32 s25, s45, 0
 s_mov_b32 s26, 67108864
 s_mov_b32 s27, 0x00020000
 s_mov_b32 s28, s4
 s_mov_b32 s29, s5
 s_mov_b32 s30, 10240
 s_mov_b32 s31, 0x00020000
 s_add_u32 s4, s44, 181305344
 s_addc_u32 s5, s45, 0
 s_mov_b32 s6, 1114112
 s_mov_b32 s7, 0x00020000
 v_mov_b32 v27, 10923
 v_add_u32 v54, 0, v1
 v_mul_u32_u24 v53, v54, v27
 v_lshrrev_b32 v53, 16, v53
 v_mul_u32_u24 v52, 6, v53
 v_sub_u32 v54, v54, v52
 v_mul_u32_u24 v52, 1280, v53
 v_lshl_add_u32 v46, v54, 4, v52
 v_bfe_u32 v52, v53, 1, 1
 v_mul_u32_u24 v52, 20, v52
 v_and_b32 v51, 1, v53
 v_add_u32 v52, v52, v51
 v_lshrrev_b32 v51, 3, v53
 v_mul_u32_u24 v51, 40, v51
 v_bfe_u32 v50, v53, 2, 1
 v_lshl_add_u32 v51, v50, 1, v51
 v_add_u32 v51, v51, v52
 v_mul_u32_u24 v51, 12288, v51
 v_lshl_add_u32 v247, v54, 4, v51
 v_lshrrev_b32 v51, 4, v53
 v_mul_u32_u24 v51, 40, v51
 v_bfe_u32 v50, v53, 2, 2
 v_lshl_add_u32 v51, v50, 1, v51
 v_add_u32 v51, v51, v52
 v_mul_u32_u24 v51, 12288, v51
 v_lshl_add_u32 v244, v54, 4, v51
 v_add_u32 v54, 64, v1
 v_mul_u32_u24 v53, v54, v27
 v_lshrrev_b32 v53, 16, v53
 v_mul_u32_u24 v52, 6, v53
 v_sub_u32 v54, v54, v52
 v_mul_u32_u24 v52, 1280, v53
 v_lshl_add_u32 v47, v54, 4, v52
 v_bfe_u32 v52, v53, 1, 1
 v_mul_u32_u24 v52, 20, v52
 v_and_b32 v51, 1, v53
 v_add_u32 v52, v52, v51
 v_lshrrev_b32 v51, 3, v53
 v_mul_u32_u24 v51, 40, v51
 v_bfe_u32 v50, v53, 2, 1
 v_lshl_add_u32 v51, v50, 1, v51
 v_add_u32 v51, v51, v52
 v_mul_u32_u24 v51, 12288, v51
 v_lshl_add_u32 v248, v54, 4, v51
 v_lshrrev_b32 v51, 4, v53
 v_mul_u32_u24 v51, 40, v51
 v_bfe_u32 v50, v53, 2, 2
 v_lshl_add_u32 v51, v50, 1, v51
 v_add_u32 v51, v51, v52
 v_mul_u32_u24 v51, 12288, v51
 v_lshl_add_u32 v245, v54, 4, v51
 v_add_u32 v54, 128, v1
 v_mul_u32_u24 v53, v54, v27
 v_lshrrev_b32 v53, 16, v53
 v_mul_u32_u24 v52, 6, v53
 v_sub_u32 v54, v54, v52
 v_mul_u32_u24 v52, 1280, v53
 v_lshl_add_u32 v48, v54, 4, v52
 v_bfe_u32 v52, v53, 1, 1
 v_mul_u32_u24 v52, 20, v52
 v_and_b32 v51, 1, v53
 v_add_u32 v52, v52, v51
 v_lshrrev_b32 v51, 3, v53
 v_mul_u32_u24 v51, 40, v51
 v_bfe_u32 v50, v53, 2, 1
 v_lshl_add_u32 v51, v50, 1, v51
 v_add_u32 v51, v51, v52
 v_mul_u32_u24 v51, 12288, v51
 v_lshl_add_u32 v249, v54, 4, v51
 v_lshrrev_b32 v51, 4, v53
 v_mul_u32_u24 v51, 40, v51
 v_bfe_u32 v50, v53, 2, 2
 v_lshl_add_u32 v51, v50, 1, v51
 v_add_u32 v51, v51, v52
 v_mul_u32_u24 v51, 12288, v51
 v_lshl_add_u32 v246, v54, 4, v51
 s_mul_i32 s80, s58, 384
 s_mul_i32 s22, s56, 96
 s_add_u32 s80, s80, s22
 s_mul_i32 s22, s20, 1966080
 s_add_u32 s80, s80, s22
 s_mul_i32 s81, s20, 40448
 s_mul_i32 s82, s59, 245760
 s_lshl_b32 s22, s87, 5
 s_add_u32 s82, s82, s22
 s_mul_i32 s88, s59, 384
 s_mov_b32 s12, s42
 s_mov_b32 s13, s43
 s_mov_b32 s14, 7864320
 s_mov_b32 s15, 0x00020000
 s_add_u32 s21, s82, 0
 s_add_u32 m0, s81, 12288
 s_nop 0
 buffer_load_dwordx4 v46, s[12:15], s21 offen lds
 s_add_u32 m0, s81, 13312
 s_nop 0
 buffer_load_dwordx4 v47, s[12:15], s21 offen lds
 s_add_u32 m0, s81, 14336
 s_nop 0
 buffer_load_dwordx4 v48, s[12:15], s21 offen lds
 s_add_u32 s21, s82, 40960
 s_add_u32 m0, s81, 15360
 s_nop 0
 buffer_load_dwordx4 v46, s[12:15], s21 offen lds
 s_add_u32 m0, s81, 16384
 s_nop 0
 buffer_load_dwordx4 v47, s[12:15], s21 offen lds
 s_add_u32 m0, s81, 17408
 s_nop 0
 buffer_load_dwordx4 v48, s[12:15], s21 offen lds
 s_add_u32 s21, s82, 81920
 s_add_u32 m0, s81, 18432
 s_nop 0
 buffer_load_dwordx4 v46, s[12:15], s21 offen lds
 s_add_u32 m0, s81, 19456
 s_nop 0
 buffer_load_dwordx4 v47, s[12:15], s21 offen lds
 s_add_u32 m0, s81, 20480
 s_nop 0
 buffer_load_dwordx4 v48, s[12:15], s21 offen lds
 s_add_u32 s21, s82, 122880
 s_add_u32 m0, s81, 21504
 s_nop 0
 buffer_load_dwordx4 v46, s[12:15], s21 offen lds
 s_add_u32 m0, s81, 22528
 s_nop 0
 buffer_load_dwordx4 v47, s[12:15], s21 offen lds
 s_add_u32 m0, s81, 23552
 s_nop 0
 buffer_load_dwordx4 v48, s[12:15], s21 offen lds
 s_add_u32 s21, s82, 163840
 s_add_u32 m0, s81, 24576
 s_nop 0
 buffer_load_dwordx4 v46, s[12:15], s21 offen lds
 s_add_u32 m0, s81, 25600
 s_nop 0
 buffer_load_dwordx4 v47, s[12:15], s21 offen lds
 s_add_u32 m0, s81, 26624
 s_nop 0
 buffer_load_dwordx4 v48, s[12:15], s21 offen lds
 s_add_u32 s21, s82, 204800
 s_add_u32 m0, s81, 27648
 s_nop 0
 buffer_load_dwordx4 v46, s[12:15], s21 offen lds
 s_add_u32 m0, s81, 28672
 s_nop 0
 buffer_load_dwordx4 v47, s[12:15], s21 offen lds
 s_add_u32 m0, s81, 29696
 s_nop 0
 buffer_load_dwordx4 v48, s[12:15], s21 offen lds
 s_mov_b32 s12, s40
 s_mov_b32 s13, s41
 s_mov_b32 s14, 7864320
 s_mov_b32 s15, 0x00020000
 s_mov_b32 s40, s38
 s_mov_b32 s41, s39
 s_mov_b32 s38, 7864320
 s_mov_b32 s39, 0x00020000
 s_mov_b32 s42, s38
 s_mov_b32 s43, s39
 v_lshrrev_b32 v250, 2, v2
 v_lshl_add_u32 v250, v3, 3, v250
 v_mul_u32_u24 v250, 96, v250
 v_and_b32 v251, 3, v2
 v_lshlrev_b32 v251, 3, v251
 v_add3_u32 v250, v250, v251, s81
 v_lshlrev_b32 v251, 4, v1
 v_add_u32 v251, s81, v251
 v_lshlrev_b32 v26, 2, v1
 v_mov_b32 v27, 2731
 v_add_u32 v54, 0, v1
 v_mul_u32_u24 v53, v54, v27
 v_lshrrev_b32 v53, 16, v53
 v_mul_u32_u24 v52, 24, v53
 v_sub_u32 v54, v54, v52
 v_bfe_u32 v52, v53, 1, 1
 v_xor_b32 v54, v54, v52
 v_mul_u32_u24 v52, 20, v52
 v_and_b32 v51, 1, v53
 v_add_u32 v52, v52, v51
 v_lshrrev_b32 v51, 2, v53
 v_lshl_add_u32 v52, v51, 1, v52
 v_mul_u32_u24 v52, 12288, v52
 v_subrev_u32 v52, 0, v52
 v_lshl_add_u32 v28, v54, 4, v52
 v_xor_b32 v31, 32, v28
 v_xor_b32 v34, 64, v28
 v_xor_b32 v37, 96, v28
 v_add_u32 v54, 64, v1
 v_mul_u32_u24 v53, v54, v27
 v_lshrrev_b32 v53, 16, v53
 v_mul_u32_u24 v52, 24, v53
 v_sub_u32 v54, v54, v52
 v_bfe_u32 v52, v53, 1, 1
 v_xor_b32 v54, v54, v52
 v_mul_u32_u24 v52, 20, v52
 v_and_b32 v51, 1, v53
 v_add_u32 v52, v52, v51
 v_lshrrev_b32 v51, 2, v53
 v_lshl_add_u32 v52, v51, 1, v52
 v_mul_u32_u24 v52, 12288, v52
 v_subrev_u32 v52, 1024, v52
 v_lshl_add_u32 v29, v54, 4, v52
 v_xor_b32 v32, 32, v29
 v_xor_b32 v35, 64, v29
 v_xor_b32 v38, 96, v29
 v_add_u32 v54, 128, v1
 v_mul_u32_u24 v53, v54, v27
 v_lshrrev_b32 v53, 16, v53
 v_mul_u32_u24 v52, 24, v53
 v_sub_u32 v54, v54, v52
 v_bfe_u32 v52, v53, 1, 1
 v_xor_b32 v54, v54, v52
 v_mul_u32_u24 v52, 20, v52
 v_and_b32 v51, 1, v53
 v_add_u32 v52, v52, v51
 v_lshrrev_b32 v51, 2, v53
 v_lshl_add_u32 v52, v51, 1, v52
 v_mul_u32_u24 v52, 12288, v52
 v_subrev_u32 v52, 2048, v52
 v_lshl_add_u32 v30, v54, 4, v52
 v_xor_b32 v33, 32, v30
 v_xor_b32 v36, 64, v30
 v_xor_b32 v39, 96, v30
 s_add_u32 m0, s81, 0
 s_add_u32 s21, s88, 0
 buffer_load_dwordx4 v28, s[12:15], s21 offen offset:0 lds
 buffer_load_dwordx4 v29, s[12:15], s21 offen offset:1024 lds
 buffer_load_dwordx4 v30, s[12:15], s21 offen offset:2048 lds
 s_add_u32 m0, s81, 3072
 s_add_u32 s21, s88, 49152
 buffer_load_dwordx4 v31, s[12:15], s21 offen offset:0 lds
 buffer_load_dwordx4 v32, s[12:15], s21 offen offset:1024 lds
 buffer_load_dwordx4 v33, s[12:15], s21 offen offset:2048 lds
 s_add_u32 m0, s81, 6144
 s_add_u32 s21, s88, 491520
 buffer_load_dwordx4 v34, s[12:15], s21 offen offset:0 lds
 buffer_load_dwordx4 v35, s[12:15], s21 offen offset:1024 lds
 buffer_load_dwordx4 v36, s[12:15], s21 offen offset:2048 lds
 s_add_u32 m0, s81, 9216
 s_add_u32 s21, s88, 540672
 buffer_load_dwordx4 v37, s[12:15], s21 offen offset:0 lds
 buffer_load_dwordx4 v38, s[12:15], s21 offen offset:1024 lds
 buffer_load_dwordx4 v39, s[12:15], s21 offen offset:2048 lds
 s_add_u32 s22, s80, 0
 buffer_load_dwordx4 v[220:223], v244, s[40:43], s22 offen
 buffer_load_dwordx4 v[224:227], v245, s[40:43], s22 offen
 buffer_load_dwordx4 v[228:231], v246, s[40:43], s22 offen
 s_add_u32 s22, s80, 983040
 buffer_load_dwordx4 v[232:235], v244, s[40:43], s22 offen
 buffer_load_dwordx4 v[236:239], v245, s[40:43], s22 offen
 buffer_load_dwordx4 v[240:243], v246, s[40:43], s22 offen
 s_mul_i32 s23, s51, 491520
 s_add_u32 s23, s23, s88
 buffer_load_dwordx4 a[252:255], v28, s[36:39], s23 offen offset:0
 buffer_load_dwordx4 a[252:255], v29, s[36:39], s23 offen offset:1024
 buffer_load_dwordx4 a[252:255], v30, s[36:39], s23 offen offset:2048
 s_add_u32 s23, s23, 49152
 buffer_load_dwordx4 a[252:255], v28, s[36:39], s23 offen offset:0
 buffer_load_dwordx4 a[252:255], v29, s[36:39], s23 offen offset:1024
 buffer_load_dwordx4 a[252:255], v30, s[36:39], s23 offen offset:2048
 s_add_u32 s23, s23, 49152
 buffer_load_dwordx4 a[252:255], v28, s[36:39], s23 offen offset:0
 buffer_load_dwordx4 a[252:255], v29, s[36:39], s23 offen offset:1024
 buffer_load_dwordx4 a[252:255], v30, s[36:39], s23 offen offset:2048
 s_add_u32 s23, s23, 49152
 buffer_load_dwordx4 a[252:255], v28, s[36:39], s23 offen offset:0
 buffer_load_dwordx4 a[252:255], v29, s[36:39], s23 offen offset:1024
 buffer_load_dwordx4 a[252:255], v30, s[36:39], s23 offen offset:2048
 s_add_u32 s23, s23, 49152
 buffer_load_dwordx4 a[252:255], v28, s[36:39], s23 offen offset:0
 buffer_load_dwordx4 a[252:255], v29, s[36:39], s23 offen offset:1024
 buffer_load_dwordx4 a[252:255], v30, s[36:39], s23 offen offset:2048
 s_add_u32 s23, s23, 49152
 v_and_b32 v56, 7, v2
 v_lshrrev_b32 v57, 3, v2
 v_lshlrev_b32 v16, 4, v1
 s_lshr_b32 s21, s20, 1
 s_lshl_b32 s21, s21, 14
 s_and_b32 s22, s20, 1
 s_mul_i32 s22, s22, 3072
 s_add_u32 s21, s21, s22
 v_add_u32 v4, s21, v16
 v_mov_b32 v58, 0x4444
 v_mov_b32 v59, 0xeeee
 v_cmp_eq_u32 vcc, 1, v57
 s_nop 1
 v_cndmask_b32 v25, v58, v59, vcc
 v_mul_u32_u24 v58, 40, v2
 v_lshl_add_u32 v58, v3, 3, v58
 s_mul_i32 s21, s20, 1920
 v_add_u32 v5, s21, v58
 v_lshrrev_b32 v58, 2, v1
 v_mul_u32_u24 v58, 40, v58
 v_and_b32 v59, 3, v1
 v_lshl_add_u32 v6, v59, 3, v58
 v_bfe_u32 v59, v1, 1, 1
 v_mul_u32_u24 v59, 3824, v59
 v_add_u32 v21, v6, v59
 s_lshl_b32 s21, s50, 4
 s_add_u32 s21, s21, s51
 s_lshl_b32 s21, s21, 9
 s_lshl_b32 s22, s20, 7
 s_add_u32 s21, s21, s22
 s_add_u32 s21, s21, 81920
 v_and_b32 v58, 1, v3
 v_lshlrev_b32 v58, 8, v58
 v_lshl_add_u32 v58, v56, 4, v58
 v_lshrrev_b32 v59, 1, v3
 v_lshl_add_u32 v58, v59, 3, v58
 v_add_u32 v7, s21, v58
 s_lshl_b32 s22, s58, 9
 s_lshl_b32 s23, s56, 7
 s_add_u32 s22, s22, s23
 s_add_u32 s22, s22, 376704
 v_lshlrev_b32 v58, 6, v3
 v_lshl_add_u32 v58, v56, 3, v58
 v_add_u32 v58, s22, v58
 s_cmp_eq_u32 s20, 2
 s_cselect_b64 vcc, -1, 0
 v_cndmask_b32 v7, v7, v58, vcc
 s_lshl_b32 s21, s59, 11
 s_add_u32 s21, s21, 81920
 v_add_u32 v8, s21, v16
 s_lshl_b32 s21, s59, 9
 s_add_u32 s21, s21, 376832
 v_lshl_add_u32 v9, v1, 3, s21
 s_mul_i32 s21, s20, 3072
 s_add_u32 s21, s21, 24576
 v_and_b32 v58, 0x39, v1
 v_bfe_u32 v59, v1, 1, 1
 v_lshl_or_b32 v58, v59, 2, v58
 v_bfe_u32 v59, v1, 2, 1
 v_lshl_or_b32 v58, v59, 1, v58
 v_lshl_add_u32 v10, v58, 4, s21
 s_mul_i32 s22, s56, 12
 s_cmp_eq_u32 s20, 2
 s_cselect_b64 vcc, -1, 0
 v_add_u32 v58, s22, v3
 v_add3_u32 v59, 0, v58, v3
 v_lshrrev_b32 v60, 1, v59
 v_and_b32 v59, 1, v59
 v_lshlrev_b32 v59, 3, v59
 v_lshl_add_u32 v61, v60, 7, v59
 v_lshl_add_u32 v61, v56, 4, v61
 s_lshr_b32 s21, s58, 1
 s_lshl_b32 s21, s21, 14
 s_and_b32 s22, s58, 1
 s_mul_i32 s22, s22, 3072
 s_add_u32 s21, s21, s22
 s_add_u32 s21, s21, 655360
 v_add_u32 v62, s21, v61
 v_lshl_add_u32 v61, v60, 8, v59
 v_lshl_add_u32 v61, v2, 4, v61
 s_mul_i32 s21, s58, 12288
 s_and_b32 s22, s20, 1
 s_mul_i32 s22, s22, 6144
 s_add_u32 s21, s21, s22
 v_add_u32 v61, s21, v61
 v_cndmask_b32 v18, v61, v62, vcc
 v_add_u32 v59, 8, v58
 v_lshrrev_b32 v60, 1, v59
 v_and_b32 v59, 1, v59
 v_lshlrev_b32 v59, 3, v59
 v_lshl_add_u32 v61, v60, 7, v59
 v_lshl_add_u32 v61, v56, 4, v61
 s_lshr_b32 s21, s58, 1
 s_lshl_b32 s21, s21, 14
 s_and_b32 s22, s58, 1
 s_mul_i32 s22, s22, 3072
 s_add_u32 s21, s21, s22
 s_add_u32 s21, s21, 655360
 v_add_u32 v62, s21, v61
 v_lshl_add_u32 v61, v60, 8, v59
 v_lshl_add_u32 v61, v2, 4, v61
 s_mul_i32 s21, s58, 12288
 s_and_b32 s22, s20, 1
 s_mul_i32 s22, s22, 6144
 s_add_u32 s21, s21, s22
 v_add_u32 v61, s21, v61
 v_cndmask_b32 v19, v61, v62, vcc
 s_mul_i32 s21, s20, 3072
 s_add_u32 s21, s21, 8192
 v_add_u32 v11, s21, v16
 v_and_b32 v58, 3, v1
 s_lshl_b32 s21, s20, 2
 v_add_u32 v59, s21, v58
 v_cmp_eq_u32 vcc, 10, v59
 s_nop 1
 v_cndmask_b32 v59, v59, 7, vcc
 v_cmp_eq_u32 vcc, 3, v58
 v_lshrrev_b32 v60, 5, v1
 v_mul_u32_u24 v60, 10, v60
 v_cndmask_b32 v59, v59, 3, vcc
 s_lshl_b32 s21, s79, 2
 v_add3_u32 v59, v59, v60, s21
 v_lshrrev_b32 v60, 1, v59
 v_lshlrev_b32 v60, 8, v60
 v_and_b32 v59, 1, v59
 v_lshl_add_u32 v60, v59, 3, v60
 v_bfe_u32 v59, v1, 2, 3
 v_lshl_add_u32 v60, v59, 4, v60
 v_add_u32 v12, 8192, v60
 s_mov_b32 s21, 0x07060100
 s_cmp_eq_u32 s20, 1
 s_cselect_b32 s21, 0x07060302, s21
 s_cmp_eq_u32 s20, 2
 s_cselect_b32 s21, 0x07060c0c, s21
 v_mov_b32 v59, s21
 v_mov_b32 v60, 0x03020100
 v_cndmask_b32 v14, v60, v59, vcc
 s_lshr_b32 s21, s85, 3
 s_lshl_b32 s21, s21, 14
 s_bfe_u32 s22, s85, 0x10002
 s_mul_i32 s22, s22, 3072
 s_add_u32 s21, s21, s22
 s_and_b32 s22, s85, 3
 s_lshl_b32 s22, s22, 8
 s_add_u32 s21, s21, s22
 s_lshl_b32 s22, s20, 10
 s_add_u32 s22, s22, s21
 v_lshl_add_u32 v13, v1, 2, s22
 v_lshlrev_b32 v59, 10, v3
 v_lshl_add_u32 v59, v2, 4, v59
 v_add_u32 v59, s21, v59
 s_cmp_eq_u32 s20, 3
 s_cselect_b64 vcc, -1, 0
 v_cndmask_b32 v13, v13, v59, vcc
 s_mov_b32 s91, 0x3c000000
 v_and_b32 v59, 1, v3
 v_lshrrev_b32 v60, 1, v3
 v_lshl_add_u32 v59, v59, 1, v60
 v_add_u32 v59, s87, v59
 v_lshrrev_b32 v60, 2, v59
 v_and_b32 v59, 3, v59
 v_lshlrev_b32 v59, 8, v59
 v_lshl_add_u32 v59, v60, 16, v59
 v_lshl_add_u32 v59, v2, 4, v59
 s_lshr_b32 s21, s59, 3
 s_lshl_b32 s21, s21, 14
 s_and_b32 s22, s59, 7
 s_lshl_b32 s22, s22, 10
 s_add_u32 s21, s21, s22
 v_add_u32 v15, s21, v59
 s_lshl_b32 s21, s79, 4
 s_lshl_b32 s76, -1, s21
 s_mov_b32 s77, 0xffff
 s_lshl_b32 s21, s79, 7
 v_or_b32 v17, s21, v16
 s_or_b32 s21, s21, 0xffffff7f
 v_and_b32 v20, s21, v16
 v_lshlrev_b32 v24, 3, v1
 v_cmp_gt_u32 s[60:61], 8, v2
 v_cmp_le_u32 s[62:63], 8, v2
 v_cmp_le_u32 s[72:73], 2, v3
 v_cmp_gt_u32 s[70:71], 48, v1
 s_nop 1
 s_and_b64 s[64:65], s[60:61], s[72:73]
 s_cmp_eq_u32 s20, 2
 s_cselect_b64 s[74:75], s[64:65], s[60:61]
 s_waitcnt vmcnt(33)
 ds_read_b64_tr_b16 v[64:65], v250 offset:12288
 ds_read_b64_tr_b16 v[66:67], v250 offset:12672
 ds_read_b64_tr_b16 v[88:89], v250 offset:12320
 ds_read_b64_tr_b16 v[90:91], v250 offset:12704
 ds_read_b64_tr_b16 v[112:113], v250 offset:12352
 ds_read_b64_tr_b16 v[114:115], v250 offset:12736
 ds_read_b64_tr_b16 v[68:69], v250 offset:15360
 ds_read_b64_tr_b16 v[70:71], v250 offset:15744
 ds_read_b64_tr_b16 v[92:93], v250 offset:15392
 ds_read_b64_tr_b16 v[94:95], v250 offset:15776
 ds_read_b64_tr_b16 v[116:117], v250 offset:15424
 ds_read_b64_tr_b16 v[118:119], v250 offset:15808
 ds_read_b64_tr_b16 v[72:73], v250 offset:18432
 ds_read_b64_tr_b16 v[74:75], v250 offset:18816
 ds_read_b64_tr_b16 v[96:97], v250 offset:18464
 ds_read_b64_tr_b16 v[98:99], v250 offset:18848
 ds_read_b64_tr_b16 v[120:121], v250 offset:18496
 ds_read_b64_tr_b16 v[122:123], v250 offset:18880
 ds_read_b64_tr_b16 v[76:77], v250 offset:21504
 ds_read_b64_tr_b16 v[78:79], v250 offset:21888
 ds_read_b64_tr_b16 v[100:101], v250 offset:21536
 ds_read_b64_tr_b16 v[102:103], v250 offset:21920
 ds_read_b64_tr_b16 v[124:125], v250 offset:21568
 ds_read_b64_tr_b16 v[126:127], v250 offset:21952
 ds_read_b64_tr_b16 v[80:81], v250 offset:24576
 ds_read_b64_tr_b16 v[82:83], v250 offset:24960
 ds_read_b64_tr_b16 v[104:105], v250 offset:24608
 ds_read_b64_tr_b16 v[106:107], v250 offset:24992
 ds_read_b64_tr_b16 v[128:129], v250 offset:24640
 ds_read_b64_tr_b16 v[130:131], v250 offset:25024
 ds_read_b64_tr_b16 v[84:85], v250 offset:27648
 ds_read_b64_tr_b16 v[86:87], v250 offset:28032
 ds_read_b64_tr_b16 v[108:109], v250 offset:27680
 ds_read_b64_tr_b16 v[110:111], v250 offset:28064
 ds_read_b64_tr_b16 v[132:133], v250 offset:27712
 ds_read_b64_tr_b16 v[134:135], v250 offset:28096
 s_waitcnt lgkmcnt(0)
 s_add_u32 m0, s81, 12288
 s_add_u32 s21, s88, 983040
 buffer_load_dwordx4 v28, s[12:15], s21 offen offset:0 lds
 buffer_load_dwordx4 v29, s[12:15], s21 offen offset:1024 lds
 buffer_load_dwordx4 v30, s[12:15], s21 offen offset:2048 lds
 s_add_u32 m0, s81, 15360
 s_add_u32 s21, s88, 1032192
 buffer_load_dwordx4 v31, s[12:15], s21 offen offset:0 lds
 buffer_load_dwordx4 v32, s[12:15], s21 offen offset:1024 lds
 buffer_load_dwordx4 v33, s[12:15], s21 offen offset:2048 lds
 s_add_u32 m0, s81, 18432
 s_add_u32 s21, s88, 1474560
 buffer_load_dwordx4 v34, s[12:15], s21 offen offset:0 lds
 buffer_load_dwordx4 v35, s[12:15], s21 offen offset:1024 lds
 buffer_load_dwordx4 v36, s[12:15], s21 offen offset:2048 lds
 s_add_u32 m0, s81, 21504
 s_add_u32 s21, s88, 1523712
 buffer_load_dwordx4 v37, s[12:15], s21 offen offset:0 lds
 buffer_load_dwordx4 v38, s[12:15], s21 offen offset:1024 lds
 buffer_load_dwordx4 v39, s[12:15], s21 offen offset:2048 lds
 s_add_u32 m0, s81, 24576
 s_add_u32 s21, s88, 98304
 buffer_load_dwordx4 v28, s[12:15], s21 offen offset:0 lds
 buffer_load_dwordx4 v29, s[12:15], s21 offen offset:1024 lds
 buffer_load_dwordx4 v30, s[12:15], s21 offen offset:2048 lds
 s_add_u32 m0, s81, 27648
 s_add_u32 s21, s88, 147456
 buffer_load_dwordx4 v31, s[12:15], s21 offen offset:0 lds
 buffer_load_dwordx4 v32, s[12:15], s21 offen offset:1024 lds
 buffer_load_dwordx4 v33, s[12:15], s21 offen offset:2048 lds
 s_add_u32 m0, s81, 30720
 s_add_u32 s21, s88, 589824
 buffer_load_dwordx4 v34, s[12:15], s21 offen offset:0 lds
 buffer_load_dwordx4 v35, s[12:15], s21 offen offset:1024 lds
 buffer_load_dwordx4 v36, s[12:15], s21 offen offset:2048 lds
 s_add_u32 m0, s81, 33792
 s_add_u32 s21, s88, 638976
 buffer_load_dwordx4 v37, s[12:15], s21 offen offset:0 lds
 buffer_load_dwordx4 v38, s[12:15], s21 offen offset:1024 lds
 buffer_load_dwordx4 v39, s[12:15], s21 offen offset:2048 lds
 v_lshrrev_b32 v40, 2, v2
 v_and_b32 v41, 3, v2
 v_lshl_add_u32 v41, v40, 3, v41
 v_mul_u32_u24 v41, 384, v41
 v_add_u32 v41, s81, v41
 v_lshrrev_b32 v40, 1, v2
 v_xor_b32 v40, v40, v3
 v_lshl_add_u32 v22, v40, 4, v41
 v_xor_b32 v40, 4, v40
 v_lshl_add_u32 v23, v40, 4, v41
 s_mul_i32 s64, s59, 40960
 s_lshl_b32 s21, s87, 10
 s_add_u32 s64, s64, s21
 s_add_u32 s64, s64, 1310720
 s_lshl_b32 s79, s59, 7
 s_and_b32 s21, s51, 12
 s_lshl_b32 s21, s21, 10
 s_add_u32 s79, s79, s21
 s_add_u32 s79, s79, 95232
 s_lshl_b32 s90, s58, 7
 s_add_u32 s90, s90, 19456
 s_cmp_eq_u32 s56, 0
 s_cselect_b32 s66, s90, 0x80000000
 s_bfe_u32 s82, s50, 0x10001
 s_lshl_b32 s82, s82, 5
 s_lshr_b32 s21, s50, 2
 s_add_u32 s82, s82, s21
 s_and_b32 s83, s50, 1
 s_lshl_b32 s83, s83, 4
 s_add_u32 s83, s83, 16
 s_waitcnt vmcnt(45)
 ds_read_b128 v[136:139], v22 offset:0
 ds_read_b128 v[140:143], v23 offset:0
 ds_read_b128 v[144:147], v22 offset:128
 s_waitcnt lgkmcnt(2)
 v_mfma_f32_16x16x32_bf16 v[40:43], v[136:139], v[64:67], 0
 ds_read_b128 v[148:151], v23 offset:128
 s_waitcnt vmcnt(42)
 ds_write_b128 v251, v[220:223] offset:36864
 v_mfma_f32_16x16x32_bf16 v[48:51], v[136:139], v[88:91], 0
 ds_write_b128 v251, v[224:227] offset:37888
 ds_write_b128 v251, v[228:231] offset:38912
 ds_read_b64_tr_b16 v[208:209], v250 offset:36864
 v_mfma_f32_16x16x32_bf16 v[56:59], v[136:139], v[112:115], 0
 ds_read_b64_tr_b16 v[210:211], v250 offset:37248
 ds_read_b64_tr_b16 v[212:213], v250 offset:36896
 ds_read_b64_tr_b16 v[214:215], v250 offset:37280
 ds_read_b64_tr_b16 v[216:217], v250 offset:36928
 s_waitcnt lgkmcnt(10)
 v_mfma_f32_16x16x32_bf16 v[40:43], v[140:143], v[68:71], v[40:43]
 ds_read_b128 v[136:139], v22 offset:256
 ds_read_b64_tr_b16 v[218:219], v250 offset:37312
 s_add_u32 s22, s80, 98304
 buffer_load_dwordx4 v[220:223], v244, s[40:43], s22 offen
 v_mfma_f32_16x16x32_bf16 v[48:51], v[140:143], v[92:95], v[48:51]
 buffer_load_dwordx4 v[224:227], v245, s[40:43], s22 offen
 buffer_load_dwordx4 v[228:231], v246, s[40:43], s22 offen
 v_mfma_f32_16x16x32_bf16 v[56:59], v[140:143], v[116:119], v[56:59]
 s_waitcnt lgkmcnt(11)
 v_mfma_f32_16x16x32_bf16 v[40:43], v[144:147], v[72:75], v[40:43]
 ds_read_b128 v[140:143], v23 offset:256
 v_mfma_f32_16x16x32_bf16 v[48:51], v[144:147], v[96:99], v[48:51]
 v_mfma_f32_16x16x32_bf16 v[56:59], v[144:147], v[120:123], v[56:59]
 s_waitcnt lgkmcnt(11)
 v_mfma_f32_16x16x32_bf16 v[40:43], v[148:151], v[76:79], v[40:43]
 ds_read_b128 v[144:147], v22 offset:1536
 v_mfma_f32_16x16x32_bf16 v[48:51], v[148:151], v[100:103], v[48:51]
 s_waitcnt lgkmcnt(2)
 v_lshlrev_b32 v27, 16, v208
 v_and_b32 v208, 0xffff0000, v208
 v_cvt_pk_f16_f32 v208, v27, v208
 v_accvgpr_write_b32 a60, v208
 v_mfma_f32_16x16x32_bf16 v[56:59], v[148:151], v[124:127], v[56:59]
 v_lshlrev_b32 v27, 16, v209
 v_and_b32 v209, 0xffff0000, v209
 v_cvt_pk_f16_f32 v209, v27, v209
 v_accvgpr_write_b32 a61, v209
 s_waitcnt lgkmcnt(3)
 v_mfma_f32_16x16x32_bf16 v[40:43], v[136:139], v[80:83], v[40:43]
 ds_read_b128 v[148:151], v23 offset:1536
 v_lshlrev_b32 v27, 16, v210
 v_and_b32 v210, 0xffff0000, v210
 v_cvt_pk_f16_f32 v210, v27, v210
 v_accvgpr_write_b32 a62, v210
 v_mfma_f32_16x16x32_bf16 v[48:51], v[136:139], v[104:107], v[48:51]
 v_lshlrev_b32 v27, 16, v211
 v_and_b32 v211, 0xffff0000, v211
 v_cvt_pk_f16_f32 v211, v27, v211
 v_accvgpr_write_b32 a63, v211
 v_lshlrev_b32 v27, 16, v212
 v_mfma_f32_16x16x32_bf16 v[56:59], v[136:139], v[128:131], v[56:59]
 v_and_b32 v212, 0xffff0000, v212
 v_cvt_pk_f16_f32 v212, v27, v212
 v_accvgpr_write_b32 a80, v212
 v_lshlrev_b32 v27, 16, v213
 s_waitcnt lgkmcnt(2)
 v_mfma_f32_16x16x32_bf16 v[40:43], v[140:143], v[84:87], v[40:43]
 ds_read_b128 v[136:139], v22 offset:1664
 v_and_b32 v213, 0xffff0000, v213
 v_cvt_pk_f16_f32 v213, v27, v213
 v_accvgpr_write_b32 a81, v213
 v_lshlrev_b32 v27, 16, v214
 v_mfma_f32_16x16x32_bf16 v[48:51], v[140:143], v[108:111], v[48:51]
 v_and_b32 v214, 0xffff0000, v214
 v_cvt_pk_f16_f32 v214, v27, v214
 v_accvgpr_write_b32 a82, v214
 v_lshlrev_b32 v27, 16, v215
 v_and_b32 v215, 0xffff0000, v215
 v_mfma_f32_16x16x32_bf16 v[56:59], v[140:143], v[132:135], v[56:59]
 v_cvt_pk_f16_f32 v215, v27, v215
 v_accvgpr_write_b32 a83, v215
 v_lshlrev_b32 v27, 16, v216
 v_and_b32 v216, 0xffff0000, v216
 s_waitcnt lgkmcnt(2)
 v_mfma_f32_16x16x32_bf16 v[44:47], v[144:147], v[64:67], 0
 ds_read_b128 v[140:143], v23 offset:1664
 v_cvt_pk_f16_f32 v216, v27, v216
 v_accvgpr_write_b32 a100, v216
 v_lshlrev_b32 v27, 16, v217
 v_and_b32 v217, 0xffff0000, v217
 v_mfma_f32_16x16x32_bf16 v[52:55], v[144:147], v[88:91], 0
 v_cvt_pk_f16_f32 v217, v27, v217
 v_accvgpr_write_b32 a101, v217
 v_lshlrev_b32 v27, 16, v218
 v_and_b32 v218, 0xffff0000, v218
 v_cvt_pk_f16_f32 v218, v27, v218
 v_mfma_f32_16x16x32_bf16 v[60:63], v[144:147], v[112:115], 0
 v_accvgpr_write_b32 a102, v218
 v_lshlrev_b32 v27, 16, v219
 v_and_b32 v219, 0xffff0000, v219
 v_cvt_pk_f16_f32 v219, v27, v219
 s_waitcnt lgkmcnt(2)
 v_mfma_f32_16x16x32_bf16 v[44:47], v[148:151], v[68:71], v[44:47]
 ds_read_b128 v[144:147], v22 offset:1792
 v_cvt_pk_f16_f32 v40, v40, v41
 v_accvgpr_write_b32 a103, v219
 v_accvgpr_write_b32 a120, v40
 v_cvt_pk_f16_f32 v42, v42, v43
 v_mfma_f32_16x16x32_bf16 v[52:55], v[148:151], v[92:95], v[52:55]
 v_accvgpr_write_b32 a121, v42
 v_cvt_pk_f16_f32 v48, v48, v49
 v_accvgpr_write_b32 a128, v48
 v_cvt_pk_f16_f32 v50, v50, v51
 v_accvgpr_write_b32 a129, v50
 v_mfma_f32_16x16x32_bf16 v[60:63], v[148:151], v[116:119], v[60:63]
 v_cvt_pk_f16_f32 v56, v56, v57
 v_accvgpr_write_b32 a136, v56
 v_cvt_pk_f16_f32 v58, v58, v59
 v_accvgpr_write_b32 a137, v58
 s_waitcnt lgkmcnt(2)
 v_mfma_f32_16x16x32_bf16 v[44:47], v[136:139], v[72:75], v[44:47]
 ds_read_b128 v[148:151], v23 offset:1792
 v_mfma_f32_16x16x32_bf16 v[52:55], v[136:139], v[96:99], v[52:55]
 v_mfma_f32_16x16x32_bf16 v[60:63], v[136:139], v[120:123], v[60:63]
 s_waitcnt lgkmcnt(2)
 v_mfma_f32_16x16x32_bf16 v[44:47], v[140:143], v[76:79], v[44:47]
 s_waitcnt vmcnt(15)
 ds_read_b128 v[136:139], v22 offset:12288
 v_mfma_f32_16x16x32_bf16 v[52:55], v[140:143], v[100:103], v[52:55]
 v_mfma_f32_16x16x32_bf16 v[60:63], v[140:143], v[124:127], v[60:63]
 s_waitcnt lgkmcnt(2)
 v_mfma_f32_16x16x32_bf16 v[44:47], v[144:147], v[80:83], v[44:47]
 ds_read_b128 v[140:143], v23 offset:12288
 v_mfma_f32_16x16x32_bf16 v[52:55], v[144:147], v[104:107], v[52:55]
 v_mfma_f32_16x16x32_bf16 v[60:63], v[144:147], v[128:131], v[60:63]
 s_waitcnt lgkmcnt(2)
 v_mfma_f32_16x16x32_bf16 v[44:47], v[148:151], v[84:87], v[44:47]
 ds_read_b128 v[144:147], v22 offset:12416
 s_add_u32 m0, s81, 0
 s_add_u32 s21, s88, 1081344
 v_mfma_f32_16x16x32_bf16 v[52:55], v[148:151], v[108:111], v[52:55]
 buffer_load_dwordx4 v28, s[12:15], s21 offen offset:0 lds
 v_mfma_f32_16x16x32_bf16 v[60:63], v[148:151], v[132:135], v[60:63]
 buffer_load_dwordx4 v29, s[12:15], s21 offen offset:1024 lds
 s_waitcnt lgkmcnt(2)
 v_mfma_f32_16x16x32_bf16 v[40:43], v[136:139], v[64:67], 0
 ds_read_b128 v[148:151], v23 offset:12416
 buffer_load_dwordx4 v30, s[12:15], s21 offen offset:2048 lds
 s_waitcnt vmcnt(45)
 v_mfma_f32_16x16x32_bf16 v[48:51], v[136:139], v[88:91], 0
 s_add_u32 m0, s81, 3072
 s_add_u32 s21, s88, 1130496
 ds_write_b128 v251, v[232:235] offset:36864
 v_mfma_f32_16x16x32_bf16 v[56:59], v[136:139], v[112:115], 0
 buffer_load_dwordx4 v31, s[12:15], s21 offen offset:0 lds
 ds_write_b128 v251, v[236:239] offset:37888
 s_waitcnt lgkmcnt(4)
 v_mfma_f32_16x16x32_bf16 v[40:43], v[140:143], v[68:71], v[40:43]
 ds_read_b128 v[136:139], v22 offset:12544
 v_cvt_pk_f16_f32 v44, v44, v45
 buffer_load_dwordx4 v32, s[12:15], s21 offen offset:1024 lds
 v_accvgpr_write_b32 a122, v44
 v_mfma_f32_16x16x32_bf16 v[48:51], v[140:143], v[92:95], v[48:51]
 v_cvt_pk_f16_f32 v46, v46, v47
 buffer_load_dwordx4 v33, s[12:15], s21 offen offset:2048 lds
 ds_write_b128 v251, v[240:243] offset:38912
 v_mfma_f32_16x16x32_bf16 v[56:59], v[140:143], v[116:119], v[56:59]
 v_accvgpr_write_b32 a123, v46
 s_add_u32 m0, s81, 6144
 s_add_u32 s21, s88, 1572864
 ds_read_b64_tr_b16 v[208:209], v250 offset:36864
 s_waitcnt lgkmcnt(6)
 v_mfma_f32_16x16x32_bf16 v[40:43], v[144:147], v[72:75], v[40:43]
 ds_read_b128 v[140:143], v23 offset:12544
 v_cvt_pk_f16_f32 v52, v52, v53
 buffer_load_dwordx4 v34, s[12:15], s21 offen offset:0 lds
 ds_read_b64_tr_b16 v[210:211], v250 offset:37248
 v_mfma_f32_16x16x32_bf16 v[48:51], v[144:147], v[96:99], v[48:51]
 v_accvgpr_write_b32 a130, v52
 buffer_load_dwordx4 v35, s[12:15], s21 offen offset:1024 lds
 ds_read_b64_tr_b16 v[212:213], v250 offset:36896
 ds_read_b64_tr_b16 v[214:215], v250 offset:37280
 v_mfma_f32_16x16x32_bf16 v[56:59], v[144:147], v[120:123], v[56:59]
 v_cvt_pk_f16_f32 v54, v54, v55
 buffer_load_dwordx4 v36, s[12:15], s21 offen offset:2048 lds
 ds_read_b64_tr_b16 v[216:217], v250 offset:36928
 s_waitcnt lgkmcnt(10)
 v_mfma_f32_16x16x32_bf16 v[40:43], v[148:151], v[76:79], v[40:43]
 ds_read_b128 v[144:147], v22 offset:13824
 v_accvgpr_write_b32 a131, v54
 s_add_u32 m0, s81, 9216
 s_add_u32 s21, s88, 1622016
 ds_read_b64_tr_b16 v[218:219], v250 offset:37312
 v_mfma_f32_16x16x32_bf16 v[48:51], v[148:151], v[100:103], v[48:51]
 v_cvt_pk_f16_f32 v60, v60, v61
 buffer_load_dwordx4 v37, s[12:15], s21 offen offset:0 lds
 s_add_u32 s22, s80, 1081344
 v_accvgpr_write_b32 a138, v60
 v_mfma_f32_16x16x32_bf16 v[56:59], v[148:151], v[124:127], v[56:59]
 v_cvt_pk_f16_f32 v62, v62, v63
 buffer_load_dwordx4 v38, s[12:15], s21 offen offset:1024 lds
 v_accvgpr_write_b32 a139, v62
 s_waitcnt lgkmcnt(9)
 v_mfma_f32_16x16x32_bf16 v[40:43], v[136:139], v[80:83], v[40:43]
 ds_read_b128 v[148:151], v23 offset:13824
 buffer_load_dwordx4 v39, s[12:15], s21 offen offset:2048 lds
 buffer_load_dwordx4 v[232:235], v244, s[40:43], s22 offen
 v_mfma_f32_16x16x32_bf16 v[48:51], v[136:139], v[104:107], v[48:51]
 buffer_load_dwordx4 v[236:239], v245, s[40:43], s22 offen
 buffer_load_dwordx4 v[240:243], v246, s[40:43], s22 offen
 v_mfma_f32_16x16x32_bf16 v[56:59], v[136:139], v[128:131], v[56:59]
 s_waitcnt lgkmcnt(7)
 v_mfma_f32_16x16x32_bf16 v[40:43], v[140:143], v[84:87], v[40:43]
 ds_read_b128 v[136:139], v22 offset:13952
 v_mfma_f32_16x16x32_bf16 v[48:51], v[140:143], v[108:111], v[48:51]
 v_mfma_f32_16x16x32_bf16 v[56:59], v[140:143], v[132:135], v[56:59]
 s_waitcnt lgkmcnt(3)
 v_mfma_f32_16x16x32_bf16 v[44:47], v[144:147], v[64:67], 0
 ds_read_b128 v[140:143], v23 offset:13952
 v_mfma_f32_16x16x32_bf16 v[52:55], v[144:147], v[88:91], 0
 s_waitcnt lgkmcnt(3)
 v_lshlrev_b32 v27, 16, v208
 v_and_b32 v208, 0xffff0000, v208
 v_cvt_pk_f16_f32 v208, v27, v208
 v_accvgpr_write_b32 a64, v208
 v_mfma_f32_16x16x32_bf16 v[60:63], v[144:147], v[112:115], 0
 v_lshlrev_b32 v27, 16, v209
 v_and_b32 v209, 0xffff0000, v209
 v_cvt_pk_f16_f32 v209, v27, v209
 v_accvgpr_write_b32 a65, v209
 s_waitcnt lgkmcnt(2)
 v_mfma_f32_16x16x32_bf16 v[44:47], v[148:151], v[68:71], v[44:47]
 ds_read_b128 v[144:147], v22 offset:14080
 v_cvt_pk_f16_f32 v40, v40, v41
 v_lshlrev_b32 v27, 16, v210
 v_and_b32 v210, 0xffff0000, v210
 v_cvt_pk_f16_f32 v210, v27, v210
 v_mfma_f32_16x16x32_bf16 v[52:55], v[148:151], v[92:95], v[52:55]
 v_accvgpr_write_b32 a124, v40
 v_accvgpr_write_b32 a66, v210
 v_lshlrev_b32 v27, 16, v211
 v_and_b32 v211, 0xffff0000, v211
 v_cvt_pk_f16_f32 v211, v27, v211
 v_mfma_f32_16x16x32_bf16 v[60:63], v[148:151], v[116:119], v[60:63]
 v_cvt_pk_f16_f32 v42, v42, v43
 v_accvgpr_write_b32 a67, v211
 v_lshlrev_b32 v27, 16, v212
 v_and_b32 v212, 0xffff0000, v212
 s_waitcnt lgkmcnt(2)
 v_mfma_f32_16x16x32_bf16 v[44:47], v[136:139], v[72:75], v[44:47]
 ds_read_b128 v[148:151], v23 offset:14080
 v_accvgpr_write_b32 a125, v42
 v_cvt_pk_f16_f32 v212, v27, v212
 v_accvgpr_write_b32 a84, v212
 v_lshlrev_b32 v27, 16, v213
 v_mfma_f32_16x16x32_bf16 v[52:55], v[136:139], v[96:99], v[52:55]
 v_cvt_pk_f16_f32 v48, v48, v49
 v_and_b32 v213, 0xffff0000, v213
 v_cvt_pk_f16_f32 v213, v27, v213
 v_accvgpr_write_b32 a85, v213
 v_lshlrev_b32 v27, 16, v214
 v_mfma_f32_16x16x32_bf16 v[60:63], v[136:139], v[120:123], v[60:63]
 v_accvgpr_write_b32 a132, v48
 v_and_b32 v214, 0xffff0000, v214
 v_cvt_pk_f16_f32 v214, v27, v214
 v_accvgpr_write_b32 a86, v214
 s_waitcnt lgkmcnt(2)
 v_mfma_f32_16x16x32_bf16 v[44:47], v[140:143], v[76:79], v[44:47]
 s_waitcnt vmcnt(18)
 ds_read_b128 v[136:139], v22 offset:24576
 v_cvt_pk_f16_f32 v50, v50, v51
 v_lshlrev_b32 v27, 16, v215
 v_and_b32 v215, 0xffff0000, v215
 v_cvt_pk_f16_f32 v215, v27, v215
 v_mfma_f32_16x16x32_bf16 v[52:55], v[140:143], v[100:103], v[52:55]
 v_accvgpr_write_b32 a133, v50
 v_accvgpr_write_b32 a87, v215
 v_lshlrev_b32 v27, 16, v216
 v_and_b32 v216, 0xffff0000, v216
 v_cvt_pk_f16_f32 v216, v27, v216
 v_mfma_f32_16x16x32_bf16 v[60:63], v[140:143], v[124:127], v[60:63]
 v_cvt_pk_f16_f32 v56, v56, v57
 v_accvgpr_write_b32 a104, v216
 v_lshlrev_b32 v27, 16, v217
 v_and_b32 v217, 0xffff0000, v217
 s_waitcnt lgkmcnt(2)
 v_mfma_f32_16x16x32_bf16 v[44:47], v[144:147], v[80:83], v[44:47]
 ds_read_b128 v[140:143], v23 offset:24576
 v_accvgpr_write_b32 a140, v56
 v_cvt_pk_f16_f32 v217, v27, v217
 v_accvgpr_write_b32 a105, v217
 v_lshlrev_b32 v27, 16, v218
 v_mfma_f32_16x16x32_bf16 v[52:55], v[144:147], v[104:107], v[52:55]
 v_cvt_pk_f16_f32 v58, v58, v59
 v_and_b32 v218, 0xffff0000, v218
 v_cvt_pk_f16_f32 v218, v27, v218
 v_accvgpr_write_b32 a106, v218
 v_lshlrev_b32 v27, 16, v219
 v_mfma_f32_16x16x32_bf16 v[60:63], v[144:147], v[128:131], v[60:63]
 v_accvgpr_write_b32 a141, v58
 v_and_b32 v219, 0xffff0000, v219
 v_cvt_pk_f16_f32 v219, v27, v219
 v_accvgpr_write_b32 a107, v219
 s_waitcnt lgkmcnt(2)
 v_mfma_f32_16x16x32_bf16 v[44:47], v[148:151], v[84:87], v[44:47]
 ds_read_b128 v[144:147], v22 offset:24704
 s_add_u32 m0, s81, 12288
 s_add_u32 s21, s88, 1966080
 v_mfma_f32_16x16x32_bf16 v[52:55], v[148:151], v[108:111], v[52:55]
 buffer_load_dwordx4 v28, s[12:15], s21 offen offset:0 lds
 v_mfma_f32_16x16x32_bf16 v[60:63], v[148:151], v[132:135], v[60:63]
 buffer_load_dwordx4 v29, s[12:15], s21 offen offset:1024 lds
 s_waitcnt lgkmcnt(2)
 v_mfma_f32_16x16x32_bf16 v[40:43], v[136:139], v[64:67], 0
 ds_read_b128 v[148:151], v23 offset:24704
 buffer_load_dwordx4 v30, s[12:15], s21 offen offset:2048 lds
 s_waitcnt vmcnt(18)
 v_mfma_f32_16x16x32_bf16 v[48:51], v[136:139], v[88:91], 0
 s_add_u32 m0, s81, 15360
 s_add_u32 s21, s88, 2015232
 ds_write_b128 v251, v[220:223] offset:36864
 v_mfma_f32_16x16x32_bf16 v[56:59], v[136:139], v[112:115], 0
 buffer_load_dwordx4 v31, s[12:15], s21 offen offset:0 lds
 ds_write_b128 v251, v[224:227] offset:37888
 s_waitcnt lgkmcnt(4)
 v_mfma_f32_16x16x32_bf16 v[40:43], v[140:143], v[68:71], v[40:43]
 ds_read_b128 v[136:139], v22 offset:24832
 v_cvt_pk_f16_f32 v44, v44, v45
 buffer_load_dwordx4 v32, s[12:15], s21 offen offset:1024 lds
 v_accvgpr_write_b32 a126, v44
 v_mfma_f32_16x16x32_bf16 v[48:51], v[140:143], v[92:95], v[48:51]
 v_cvt_pk_f16_f32 v46, v46, v47
 buffer_load_dwordx4 v33, s[12:15], s21 offen offset:2048 lds
 ds_write_b128 v251, v[228:231] offset:38912
 v_mfma_f32_16x16x32_bf16 v[56:59], v[140:143], v[116:119], v[56:59]
 v_accvgpr_write_b32 a127, v46
 s_add_u32 m0, s81, 18432
 s_add_u32 s21, s88, 2457600
 ds_read_b64_tr_b16 v[208:209], v250 offset:36864
 s_waitcnt lgkmcnt(6)
 v_mfma_f32_16x16x32_bf16 v[40:43], v[144:147], v[72:75], v[40:43]
 ds_read_b128 v[140:143], v23 offset:24832
 v_cvt_pk_f16_f32 v52, v52, v53
 buffer_load_dwordx4 v34, s[12:15], s21 offen offset:0 lds
 ds_read_b64_tr_b16 v[210:211], v250 offset:37248
 v_mfma_f32_16x16x32_bf16 v[48:51], v[144:147], v[96:99], v[48:51]
 v_accvgpr_write_b32 a134, v52
 buffer_load_dwordx4 v35, s[12:15], s21 offen offset:1024 lds
 ds_read_b64_tr_b16 v[212:213], v250 offset:36896
 ds_read_b64_tr_b16 v[214:215], v250 offset:37280
 v_mfma_f32_16x16x32_bf16 v[56:59], v[144:147], v[120:123], v[56:59]
 v_cvt_pk_f16_f32 v54, v54, v55
 buffer_load_dwordx4 v36, s[12:15], s21 offen offset:2048 lds
 ds_read_b64_tr_b16 v[216:217], v250 offset:36928
 s_waitcnt lgkmcnt(10)
 v_mfma_f32_16x16x32_bf16 v[40:43], v[148:151], v[76:79], v[40:43]
 ds_read_b128 v[144:147], v22 offset:26112
 v_accvgpr_write_b32 a135, v54
 s_add_u32 m0, s81, 21504
 s_add_u32 s21, s88, 2506752
 ds_read_b64_tr_b16 v[218:219], v250 offset:37312
 v_mfma_f32_16x16x32_bf16 v[48:51], v[148:151], v[100:103], v[48:51]
 v_cvt_pk_f16_f32 v60, v60, v61
 buffer_load_dwordx4 v37, s[12:15], s21 offen offset:0 lds
 s_add_u32 s22, s80, 196608
 v_accvgpr_write_b32 a142, v60
 v_mfma_f32_16x16x32_bf16 v[56:59], v[148:151], v[124:127], v[56:59]
 v_cvt_pk_f16_f32 v62, v62, v63
 buffer_load_dwordx4 v38, s[12:15], s21 offen offset:1024 lds
 v_accvgpr_write_b32 a143, v62
 s_waitcnt lgkmcnt(9)
 v_mfma_f32_16x16x32_bf16 v[40:43], v[136:139], v[80:83], v[40:43]
 ds_read_b128 v[148:151], v23 offset:26112
 buffer_load_dwordx4 v39, s[12:15], s21 offen offset:2048 lds
 buffer_load_dwordx4 v[220:223], v247, s[40:43], s22 offen
 v_mfma_f32_16x16x32_bf16 v[48:51], v[136:139], v[104:107], v[48:51]
 buffer_load_dwordx4 v[224:227], v248, s[40:43], s22 offen
 buffer_load_dwordx4 v[228:231], v249, s[40:43], s22 offen
 v_mfma_f32_16x16x32_bf16 v[56:59], v[136:139], v[128:131], v[56:59]
 s_waitcnt lgkmcnt(7)
 v_mfma_f32_16x16x32_bf16 v[40:43], v[140:143], v[84:87], v[40:43]
 ds_read_b128 v[136:139], v22 offset:26240
 v_mfma_f32_16x16x32_bf16 v[48:51], v[140:143], v[108:111], v[48:51]
 v_mfma_f32_16x16x32_bf16 v[56:59], v[140:143], v[132:135], v[56:59]
 s_waitcnt lgkmcnt(3)
 v_mfma_f32_16x16x32_bf16 v[44:47], v[144:147], v[64:67], 0
 ds_read_b128 v[140:143], v23 offset:26240
 v_mfma_f32_16x16x32_bf16 v[52:55], v[144:147], v[88:91], 0
 s_waitcnt lgkmcnt(3)
 v_lshlrev_b32 v27, 16, v208
 v_and_b32 v208, 0xffff0000, v208
 v_cvt_pk_f16_f32 v208, v27, v208
 v_accvgpr_write_b32 a68, v208
 v_mfma_f32_16x16x32_bf16 v[60:63], v[144:147], v[112:115], 0
 v_lshlrev_b32 v27, 16, v209
 v_and_b32 v209, 0xffff0000, v209
 v_cvt_pk_f16_f32 v209, v27, v209
 v_accvgpr_write_b32 a69, v209
 s_waitcnt lgkmcnt(2)
 v_mfma_f32_16x16x32_bf16 v[44:47], v[148:151], v[68:71], v[44:47]
 ds_read_b128 v[144:147], v22 offset:26368
 v_cvt_pk_f16_f32 v40, v40, v41
 v_lshlrev_b32 v27, 16, v210
 v_and_b32 v210, 0xffff0000, v210
 v_cvt_pk_f16_f32 v210, v27, v210
 v_mfma_f32_16x16x32_bf16 v[52:55], v[148:151], v[92:95], v[52:55]
 v_accvgpr_write_b32 a144, v40
 v_accvgpr_write_b32 a70, v210
 v_lshlrev_b32 v27, 16, v211
 v_and_b32 v211, 0xffff0000, v211
 v_cvt_pk_f16_f32 v211, v27, v211
 v_mfma_f32_16x16x32_bf16 v[60:63], v[148:151], v[116:119], v[60:63]
 v_cvt_pk_f16_f32 v42, v42, v43
 v_accvgpr_write_b32 a71, v211
 v_lshlrev_b32 v27, 16, v212
 v_and_b32 v212, 0xffff0000, v212
 s_waitcnt lgkmcnt(2)
 v_mfma_f32_16x16x32_bf16 v[44:47], v[136:139], v[72:75], v[44:47]
 ds_read_b128 v[148:151], v23 offset:26368
 v_accvgpr_write_b32 a145, v42
 v_cvt_pk_f16_f32 v212, v27, v212
 v_accvgpr_write_b32 a88, v212
 v_lshlrev_b32 v27, 16, v213
 v_mfma_f32_16x16x32_bf16 v[52:55], v[136:139], v[96:99], v[52:55]
 v_cvt_pk_f16_f32 v48, v48, v49
 v_and_b32 v213, 0xffff0000, v213
 v_cvt_pk_f16_f32 v213, v27, v213
 v_accvgpr_write_b32 a89, v213
 v_lshlrev_b32 v27, 16, v214
 v_mfma_f32_16x16x32_bf16 v[60:63], v[136:139], v[120:123], v[60:63]
 v_accvgpr_write_b32 a152, v48
 v_and_b32 v214, 0xffff0000, v214
 v_cvt_pk_f16_f32 v214, v27, v214
 v_accvgpr_write_b32 a90, v214
 s_waitcnt lgkmcnt(2)
 v_mfma_f32_16x16x32_bf16 v[44:47], v[140:143], v[76:79], v[44:47]
 s_waitcnt vmcnt(18)
 ds_read_b128 v[136:139], v22 offset:0
 v_cvt_pk_f16_f32 v50, v50, v51
 v_lshlrev_b32 v27, 16, v215
 v_and_b32 v215, 0xffff0000, v215
 v_cvt_pk_f16_f32 v215, v27, v215
 v_mfma_f32_16x16x32_bf16 v[52:55], v[140:143], v[100:103], v[52:55]
 v_accvgpr_write_b32 a153, v50
 v_accvgpr_write_b32 a91, v215
 v_lshlrev_b32 v27, 16, v216
 v_and_b32 v216, 0xffff0000, v216
 v_cvt_pk_f16_f32 v216, v27, v216
 v_mfma_f32_16x16x32_bf16 v[60:63], v[140:143], v[124:127], v[60:63]
 v_cvt_pk_f16_f32 v56, v56, v57
 v_accvgpr_write_b32 a108, v216
 v_lshlrev_b32 v27, 16, v217
 v_and_b32 v217, 0xffff0000, v217
 s_waitcnt lgkmcnt(2)
 v_mfma_f32_16x16x32_bf16 v[44:47], v[144:147], v[80:83], v[44:47]
 ds_read_b128 v[140:143], v23 offset:0
 v_accvgpr_write_b32 a160, v56
 v_cvt_pk_f16_f32 v217, v27, v217
 v_accvgpr_write_b32 a109, v217
 v_lshlrev_b32 v27, 16, v218
 v_mfma_f32_16x16x32_bf16 v[52:55], v[144:147], v[104:107], v[52:55]
 v_cvt_pk_f16_f32 v58, v58, v59
 v_and_b32 v218, 0xffff0000, v218
 v_cvt_pk_f16_f32 v218, v27, v218
 v_accvgpr_write_b32 a110, v218
 v_lshlrev_b32 v27, 16, v219
 v_mfma_f32_16x16x32_bf16 v[60:63], v[144:147], v[128:131], v[60:63]
 v_accvgpr_write_b32 a161, v58
 v_and_b32 v219, 0xffff0000, v219
 v_cvt_pk_f16_f32 v219, v27, v219
 v_accvgpr_write_b32 a111, v219
 s_waitcnt lgkmcnt(2)
 v_mfma_f32_16x16x32_bf16 v[44:47], v[148:151], v[84:87], v[44:47]
 ds_read_b128 v[144:147], v22 offset:128
 s_add_u32 m0, s81, 24576
 s_add_u32 s21, s88, 2949120
 v_mfma_f32_16x16x32_bf16 v[52:55], v[148:151], v[108:111], v[52:55]
 buffer_load_dwordx4 v28, s[12:15], s21 offen offset:0 lds
 v_mfma_f32_16x16x32_bf16 v[60:63], v[148:151], v[132:135], v[60:63]
 buffer_load_dwordx4 v29, s[12:15], s21 offen offset:1024 lds
 s_waitcnt lgkmcnt(2)
 v_mfma_f32_16x16x32_bf16 v[40:43], v[136:139], v[64:67], 0
 ds_read_b128 v[148:151], v23 offset:128
 buffer_load_dwordx4 v30, s[12:15], s21 offen offset:2048 lds
 s_waitcnt vmcnt(18)
 v_mfma_f32_16x16x32_bf16 v[48:51], v[136:139], v[88:91], 0
 s_add_u32 m0, s81, 27648
 s_add_u32 s21, s88, 2998272
 ds_write_b128 v251, v[232:235] offset:36864
 v_mfma_f32_16x16x32_bf16 v[56:59], v[136:139], v[112:115], 0
 buffer_load_dwordx4 v31, s[12:15], s21 offen offset:0 lds
 ds_write_b128 v251, v[236:239] offset:37888
 s_waitcnt lgkmcnt(4)
 v_mfma_f32_16x16x32_bf16 v[40:43], v[140:143], v[68:71], v[40:43]
 ds_read_b128 v[136:139], v22 offset:256
 v_cvt_pk_f16_f32 v44, v44, v45
 buffer_load_dwordx4 v32, s[12:15], s21 offen offset:1024 lds
 v_accvgpr_write_b32 a146, v44
 v_mfma_f32_16x16x32_bf16 v[48:51], v[140:143], v[92:95], v[48:51]
 v_cvt_pk_f16_f32 v46, v46, v47
 buffer_load_dwordx4 v33, s[12:15], s21 offen offset:2048 lds
 ds_write_b128 v251, v[240:243] offset:38912
 v_mfma_f32_16x16x32_bf16 v[56:59], v[140:143], v[116:119], v[56:59]
 v_accvgpr_write_b32 a147, v46
 s_add_u32 m0, s81, 30720
 s_add_u32 s21, s88, 3440640
 ds_read_b64_tr_b16 v[208:209], v250 offset:36864
 s_waitcnt lgkmcnt(6)
 v_mfma_f32_16x16x32_bf16 v[40:43], v[144:147], v[72:75], v[40:43]
 ds_read_b128 v[140:143], v23 offset:256
 v_cvt_pk_f16_f32 v52, v52, v53
 buffer_load_dwordx4 v34, s[12:15], s21 offen offset:0 lds
 ds_read_b64_tr_b16 v[210:211], v250 offset:37248
 v_mfma_f32_16x16x32_bf16 v[48:51], v[144:147], v[96:99], v[48:51]
 v_accvgpr_write_b32 a154, v52
 buffer_load_dwordx4 v35, s[12:15], s21 offen offset:1024 lds
 ds_read_b64_tr_b16 v[212:213], v250 offset:36896
 ds_read_b64_tr_b16 v[214:215], v250 offset:37280
 v_mfma_f32_16x16x32_bf16 v[56:59], v[144:147], v[120:123], v[56:59]
 v_cvt_pk_f16_f32 v54, v54, v55
 buffer_load_dwordx4 v36, s[12:15], s21 offen offset:2048 lds
 ds_read_b64_tr_b16 v[216:217], v250 offset:36928
 s_waitcnt lgkmcnt(10)
 v_mfma_f32_16x16x32_bf16 v[40:43], v[148:151], v[76:79], v[40:43]
 ds_read_b128 v[144:147], v22 offset:1536
 v_accvgpr_write_b32 a155, v54
 s_add_u32 m0, s81, 33792
 s_add_u32 s21, s88, 3489792
 ds_read_b64_tr_b16 v[218:219], v250 offset:37312
 v_mfma_f32_16x16x32_bf16 v[48:51], v[148:151], v[100:103], v[48:51]
 v_cvt_pk_f16_f32 v60, v60, v61
 buffer_load_dwordx4 v37, s[12:15], s21 offen offset:0 lds
 s_add_u32 s22, s80, 0
 v_accvgpr_write_b32 a162, v60
 v_mfma_f32_16x16x32_bf16 v[56:59], v[148:151], v[124:127], v[56:59]
 v_cvt_pk_f16_f32 v62, v62, v63
 buffer_load_dwordx4 v38, s[12:15], s21 offen offset:1024 lds
 v_accvgpr_write_b32 a163, v62
 s_waitcnt lgkmcnt(9)
 v_mfma_f32_16x16x32_bf16 v[40:43], v[136:139], v[80:83], v[40:43]
 ds_read_b128 v[148:151], v23 offset:1536
 buffer_load_dwordx4 v39, s[12:15], s21 offen offset:2048 lds
 buffer_load_dwordx4 v[232:235], v244, s[36:39], s22 offen
 v_mfma_f32_16x16x32_bf16 v[48:51], v[136:139], v[104:107], v[48:51]
 buffer_load_dwordx4 v[236:239], v245, s[36:39], s22 offen
 buffer_load_dwordx4 v[240:243], v246, s[36:39], s22 offen
 v_mfma_f32_16x16x32_bf16 v[56:59], v[136:139], v[128:131], v[56:59]
 s_waitcnt lgkmcnt(7)
 v_mfma_f32_16x16x32_bf16 v[40:43], v[140:143], v[84:87], v[40:43]
 ds_read_b128 v[136:139], v22 offset:1664
 v_mfma_f32_16x16x32_bf16 v[48:51], v[140:143], v[108:111], v[48:51]
 v_mfma_f32_16x16x32_bf16 v[56:59], v[140:143], v[132:135], v[56:59]
 s_waitcnt lgkmcnt(3)
 v_mfma_f32_16x16x32_bf16 v[44:47], v[144:147], v[64:67], 0
 ds_read_b128 v[140:143], v23 offset:1664
 v_mfma_f32_16x16x32_bf16 v[52:55], v[144:147], v[88:91], 0
 s_waitcnt lgkmcnt(3)
 v_lshlrev_b32 v27, 16, v208
 v_and_b32 v208, 0xffff0000, v208
 v_cvt_pk_f16_f32 v208, v27, v208
 v_accvgpr_write_b32 a72, v208
 v_mfma_f32_16x16x32_bf16 v[60:63], v[144:147], v[112:115], 0
 v_lshlrev_b32 v27, 16, v209
 v_and_b32 v209, 0xffff0000, v209
 v_cvt_pk_f16_f32 v209, v27, v209
 v_accvgpr_write_b32 a73, v209
 s_waitcnt lgkmcnt(2)
 v_mfma_f32_16x16x32_bf16 v[44:47], v[148:151], v[68:71], v[44:47]
 ds_read_b128 v[144:147], v22 offset:1792
 v_cvt_pk_f16_f32 v40, v40, v41
 v_lshlrev_b32 v27, 16, v210
 v_and_b32 v210, 0xffff0000, v210
 v_cvt_pk_f16_f32 v210, v27, v210
 v_mfma_f32_16x16x32_bf16 v[52:55], v[148:151], v[92:95], v[52:55]
 v_accvgpr_write_b32 a148, v40
 v_accvgpr_write_b32 a74, v210
 v_lshlrev_b32 v27, 16, v211
 v_and_b32 v211, 0xffff0000, v211
 v_cvt_pk_f16_f32 v211, v27, v211
 v_mfma_f32_16x16x32_bf16 v[60:63], v[148:151], v[116:119], v[60:63]
 v_cvt_pk_f16_f32 v42, v42, v43
 v_accvgpr_write_b32 a75, v211
 v_lshlrev_b32 v27, 16, v212
 v_and_b32 v212, 0xffff0000, v212
 s_waitcnt lgkmcnt(2)
 v_mfma_f32_16x16x32_bf16 v[44:47], v[136:139], v[72:75], v[44:47]
 ds_read_b128 v[148:151], v23 offset:1792
 v_accvgpr_write_b32 a149, v42
 v_cvt_pk_f16_f32 v212, v27, v212
 v_accvgpr_write_b32 a92, v212
 v_lshlrev_b32 v27, 16, v213
 v_mfma_f32_16x16x32_bf16 v[52:55], v[136:139], v[96:99], v[52:55]
 v_cvt_pk_f16_f32 v48, v48, v49
 v_and_b32 v213, 0xffff0000, v213
 v_cvt_pk_f16_f32 v213, v27, v213
 v_accvgpr_write_b32 a93, v213
 v_lshlrev_b32 v27, 16, v214
 v_mfma_f32_16x16x32_bf16 v[60:63], v[136:139], v[120:123], v[60:63]
 v_accvgpr_write_b32 a156, v48
 v_and_b32 v214, 0xffff0000, v214
 v_cvt_pk_f16_f32 v214, v27, v214
 v_accvgpr_write_b32 a94, v214
 s_waitcnt lgkmcnt(2)
 v_mfma_f32_16x16x32_bf16 v[44:47], v[140:143], v[76:79], v[44:47]
 s_waitcnt vmcnt(18)
 ds_read_b128 v[136:139], v22 offset:12288
 v_cvt_pk_f16_f32 v50, v50, v51
 v_lshlrev_b32 v27, 16, v215
 v_and_b32 v215, 0xffff0000, v215
 v_cvt_pk_f16_f32 v215, v27, v215
 v_mfma_f32_16x16x32_bf16 v[52:55], v[140:143], v[100:103], v[52:55]
 v_accvgpr_write_b32 a157, v50
 v_accvgpr_write_b32 a95, v215
 v_lshlrev_b32 v27, 16, v216
 v_and_b32 v216, 0xffff0000, v216
 v_cvt_pk_f16_f32 v216, v27, v216
 v_mfma_f32_16x16x32_bf16 v[60:63], v[140:143], v[124:127], v[60:63]
 v_cvt_pk_f16_f32 v56, v56, v57
 v_accvgpr_write_b32 a112, v216
 v_lshlrev_b32 v27, 16, v217
 v_and_b32 v217, 0xffff0000, v217
 s_waitcnt lgkmcnt(2)
 v_mfma_f32_16x16x32_bf16 v[44:47], v[144:147], v[80:83], v[44:47]
 ds_read_b128 v[140:143], v23 offset:12288
 v_accvgpr_write_b32 a164, v56
 v_cvt_pk_f16_f32 v217, v27, v217
 v_accvgpr_write_b32 a113, v217
 v_lshlrev_b32 v27, 16, v218
 v_mfma_f32_16x16x32_bf16 v[52:55], v[144:147], v[104:107], v[52:55]
 v_cvt_pk_f16_f32 v58, v58, v59
 v_and_b32 v218, 0xffff0000, v218
 v_cvt_pk_f16_f32 v218, v27, v218
 v_accvgpr_write_b32 a114, v218
 v_lshlrev_b32 v27, 16, v219
 v_mfma_f32_16x16x32_bf16 v[60:63], v[144:147], v[128:131], v[60:63]
 v_accvgpr_write_b32 a165, v58
 v_and_b32 v219, 0xffff0000, v219
 v_cvt_pk_f16_f32 v219, v27, v219
 v_accvgpr_write_b32 a115, v219
 s_waitcnt lgkmcnt(2)
 v_mfma_f32_16x16x32_bf16 v[44:47], v[148:151], v[84:87], v[44:47]
 ds_read_b128 v[144:147], v22 offset:12416
 s_add_u32 m0, s81, 0
 s_add_u32 s21, s88, 2064384
 v_mfma_f32_16x16x32_bf16 v[52:55], v[148:151], v[108:111], v[52:55]
 buffer_load_dwordx4 v28, s[12:15], s21 offen offset:0 lds
 v_mfma_f32_16x16x32_bf16 v[60:63], v[148:151], v[132:135], v[60:63]
 buffer_load_dwordx4 v29, s[12:15], s21 offen offset:1024 lds
 s_waitcnt lgkmcnt(2)
 v_mfma_f32_16x16x32_bf16 v[40:43], v[136:139], v[64:67], 0
 ds_read_b128 v[148:151], v23 offset:12416
 buffer_load_dwordx4 v30, s[12:15], s21 offen offset:2048 lds
 s_waitcnt vmcnt(18)
 v_mfma_f32_16x16x32_bf16 v[48:51], v[136:139], v[88:91], 0
 s_add_u32 m0, s81, 3072
 s_add_u32 s21, s88, 2113536
 ds_write_b128 v251, v[220:223] offset:36864
 v_mfma_f32_16x16x32_bf16 v[56:59], v[136:139], v[112:115], 0
 buffer_load_dwordx4 v31, s[12:15], s21 offen offset:0 lds
 ds_write_b128 v251, v[224:227] offset:37888
 s_waitcnt lgkmcnt(4)
 v_mfma_f32_16x16x32_bf16 v[40:43], v[140:143], v[68:71], v[40:43]
 ds_read_b128 v[136:139], v22 offset:12544
 v_cvt_pk_f16_f32 v44, v44, v45
 buffer_load_dwordx4 v32, s[12:15], s21 offen offset:1024 lds
 v_accvgpr_write_b32 a150, v44
 v_mfma_f32_16x16x32_bf16 v[48:51], v[140:143], v[92:95], v[48:51]
 v_cvt_pk_f16_f32 v46, v46, v47
 buffer_load_dwordx4 v33, s[12:15], s21 offen offset:2048 lds
 ds_write_b128 v251, v[228:231] offset:38912
 v_mfma_f32_16x16x32_bf16 v[56:59], v[140:143], v[116:119], v[56:59]
 v_accvgpr_write_b32 a151, v46
 s_add_u32 m0, s81, 6144
 s_add_u32 s21, s88, 2555904
 ds_read_b64_tr_b16 v[208:209], v250 offset:36864
 s_waitcnt lgkmcnt(6)
 v_mfma_f32_16x16x32_bf16 v[40:43], v[144:147], v[72:75], v[40:43]
 ds_read_b128 v[140:143], v23 offset:12544
 v_cvt_pk_f16_f32 v52, v52, v53
 buffer_load_dwordx4 v34, s[12:15], s21 offen offset:0 lds
 ds_read_b64_tr_b16 v[210:211], v250 offset:37248
 v_mfma_f32_16x16x32_bf16 v[48:51], v[144:147], v[96:99], v[48:51]
 v_accvgpr_write_b32 a158, v52
 buffer_load_dwordx4 v35, s[12:15], s21 offen offset:1024 lds
 ds_read_b64_tr_b16 v[212:213], v250 offset:36896
 ds_read_b64_tr_b16 v[214:215], v250 offset:37280
 v_mfma_f32_16x16x32_bf16 v[56:59], v[144:147], v[120:123], v[56:59]
 v_cvt_pk_f16_f32 v54, v54, v55
 buffer_load_dwordx4 v36, s[12:15], s21 offen offset:2048 lds
 ds_read_b64_tr_b16 v[216:217], v250 offset:36928
 s_waitcnt lgkmcnt(10)
 v_mfma_f32_16x16x32_bf16 v[40:43], v[148:151], v[76:79], v[40:43]
 ds_read_b128 v[144:147], v22 offset:13824
 v_accvgpr_write_b32 a159, v54
 s_add_u32 m0, s81, 9216
 s_add_u32 s21, s88, 2605056
 ds_read_b64_tr_b16 v[218:219], v250 offset:37312
 v_mfma_f32_16x16x32_bf16 v[48:51], v[148:151], v[100:103], v[48:51]
 v_cvt_pk_f16_f32 v60, v60, v61
 buffer_load_dwordx4 v37, s[12:15], s21 offen offset:0 lds
 s_add_u32 s22, s80, 983040
 v_accvgpr_write_b32 a166, v60
 v_mfma_f32_16x16x32_bf16 v[56:59], v[148:151], v[124:127], v[56:59]
 v_cvt_pk_f16_f32 v62, v62, v63
 buffer_load_dwordx4 v38, s[12:15], s21 offen offset:1024 lds
 v_accvgpr_write_b32 a167, v62
 s_waitcnt lgkmcnt(9)
 v_mfma_f32_16x16x32_bf16 v[40:43], v[136:139], v[80:83], v[40:43]
 ds_read_b128 v[148:151], v23 offset:13824
 buffer_load_dwordx4 v39, s[12:15], s21 offen offset:2048 lds
 buffer_load_dwordx4 v[220:223], v244, s[36:39], s22 offen
 v_mfma_f32_16x16x32_bf16 v[48:51], v[136:139], v[104:107], v[48:51]
 buffer_load_dwordx4 v[224:227], v245, s[36:39], s22 offen
 buffer_load_dwordx4 v[228:231], v246, s[36:39], s22 offen
 v_mfma_f32_16x16x32_bf16 v[56:59], v[136:139], v[128:131], v[56:59]
 s_waitcnt lgkmcnt(7)
 v_mfma_f32_16x16x32_bf16 v[40:43], v[140:143], v[84:87], v[40:43]
 ds_read_b128 v[136:139], v22 offset:13952
 v_mfma_f32_16x16x32_bf16 v[48:51], v[140:143], v[108:111], v[48:51]
 v_mfma_f32_16x16x32_bf16 v[56:59], v[140:143], v[132:135], v[56:59]
 s_waitcnt lgkmcnt(3)
 v_mfma_f32_16x16x32_bf16 v[44:47], v[144:147], v[64:67], 0
 ds_read_b128 v[140:143], v23 offset:13952
 v_mfma_f32_16x16x32_bf16 v[52:55], v[144:147], v[88:91], 0
 s_waitcnt lgkmcnt(3)
 v_lshlrev_b32 v27, 16, v208
 v_and_b32 v208, 0xffff0000, v208
 v_cvt_pk_f16_f32 v208, v27, v208
 v_accvgpr_write_b32 a76, v208
 v_mfma_f32_16x16x32_bf16 v[60:63], v[144:147], v[112:115], 0
 v_lshlrev_b32 v27, 16, v209
 v_and_b32 v209, 0xffff0000, v209
 v_cvt_pk_f16_f32 v209, v27, v209
 v_accvgpr_write_b32 a77, v209
 s_waitcnt lgkmcnt(2)
 v_mfma_f32_16x16x32_bf16 v[44:47], v[148:151], v[68:71], v[44:47]
 ds_read_b128 v[144:147], v22 offset:14080
 v_cvt_pk_f16_f32 v40, v40, v41
 v_lshlrev_b32 v27, 16, v210
 v_and_b32 v210, 0xffff0000, v210
 v_cvt_pk_f16_f32 v210, v27, v210
 v_mfma_f32_16x16x32_bf16 v[52:55], v[148:151], v[92:95], v[52:55]
 v_accvgpr_write_b32 a168, v40
 v_accvgpr_write_b32 a78, v210
 v_lshlrev_b32 v27, 16, v211
 v_and_b32 v211, 0xffff0000, v211
 v_cvt_pk_f16_f32 v211, v27, v211
 v_mfma_f32_16x16x32_bf16 v[60:63], v[148:151], v[116:119], v[60:63]
 v_cvt_pk_f16_f32 v42, v42, v43
 v_accvgpr_write_b32 a79, v211
 v_lshlrev_b32 v27, 16, v212
 v_and_b32 v212, 0xffff0000, v212
 s_waitcnt lgkmcnt(2)
 v_mfma_f32_16x16x32_bf16 v[44:47], v[136:139], v[72:75], v[44:47]
 ds_read_b128 v[148:151], v23 offset:14080
 v_accvgpr_write_b32 a169, v42
 v_cvt_pk_f16_f32 v212, v27, v212
 v_accvgpr_write_b32 a96, v212
 v_lshlrev_b32 v27, 16, v213
 v_mfma_f32_16x16x32_bf16 v[52:55], v[136:139], v[96:99], v[52:55]
 v_cvt_pk_f16_f32 v48, v48, v49
 v_and_b32 v213, 0xffff0000, v213
 v_cvt_pk_f16_f32 v213, v27, v213
 v_accvgpr_write_b32 a97, v213
 v_lshlrev_b32 v27, 16, v214
 v_mfma_f32_16x16x32_bf16 v[60:63], v[136:139], v[120:123], v[60:63]
 v_accvgpr_write_b32 a176, v48
 v_and_b32 v214, 0xffff0000, v214
 v_cvt_pk_f16_f32 v214, v27, v214
 v_accvgpr_write_b32 a98, v214
 s_waitcnt lgkmcnt(2)
 v_mfma_f32_16x16x32_bf16 v[44:47], v[140:143], v[76:79], v[44:47]
 s_waitcnt vmcnt(18)
 ds_read_b128 v[136:139], v22 offset:24576
 v_cvt_pk_f16_f32 v50, v50, v51
 v_lshlrev_b32 v27, 16, v215
 v_and_b32 v215, 0xffff0000, v215
 v_cvt_pk_f16_f32 v215, v27, v215
 v_mfma_f32_16x16x32_bf16 v[52:55], v[140:143], v[100:103], v[52:55]
 v_accvgpr_write_b32 a177, v50
 v_accvgpr_write_b32 a99, v215
 v_lshlrev_b32 v27, 16, v216
 v_and_b32 v216, 0xffff0000, v216
 v_cvt_pk_f16_f32 v216, v27, v216
 v_mfma_f32_16x16x32_bf16 v[60:63], v[140:143], v[124:127], v[60:63]
 v_cvt_pk_f16_f32 v56, v56, v57
 v_accvgpr_write_b32 a116, v216
 v_lshlrev_b32 v27, 16, v217
 v_and_b32 v217, 0xffff0000, v217
 s_waitcnt lgkmcnt(2)
 v_mfma_f32_16x16x32_bf16 v[44:47], v[144:147], v[80:83], v[44:47]
 ds_read_b128 v[140:143], v23 offset:24576
 v_accvgpr_write_b32 a184, v56
 v_cvt_pk_f16_f32 v217, v27, v217
 v_accvgpr_write_b32 a117, v217
 v_lshlrev_b32 v27, 16, v218
 v_mfma_f32_16x16x32_bf16 v[52:55], v[144:147], v[104:107], v[52:55]
 v_cvt_pk_f16_f32 v58, v58, v59
 v_and_b32 v218, 0xffff0000, v218
 v_cvt_pk_f16_f32 v218, v27, v218
 v_accvgpr_write_b32 a118, v218
 v_lshlrev_b32 v27, 16, v219
 v_mfma_f32_16x16x32_bf16 v[60:63], v[144:147], v[128:131], v[60:63]
 v_accvgpr_write_b32 a185, v58
 v_and_b32 v219, 0xffff0000, v219
 v_cvt_pk_f16_f32 v219, v27, v219
 v_accvgpr_write_b32 a119, v219
 s_waitcnt lgkmcnt(2)
 v_mfma_f32_16x16x32_bf16 v[44:47], v[148:151], v[84:87], v[44:47]
 ds_read_b128 v[144:147], v22 offset:24704
 s_add_u32 m0, s81, 12288
 s_add_u32 s21, s88, 3047424
 v_mfma_f32_16x16x32_bf16 v[52:55], v[148:151], v[108:111], v[52:55]
 buffer_load_dwordx4 v28, s[12:15], s21 offen offset:0 lds
 v_mfma_f32_16x16x32_bf16 v[60:63], v[148:151], v[132:135], v[60:63]
 buffer_load_dwordx4 v29, s[12:15], s21 offen offset:1024 lds
 s_waitcnt lgkmcnt(2)
 v_mfma_f32_16x16x32_bf16 v[40:43], v[136:139], v[64:67], 0
 ds_read_b128 v[148:151], v23 offset:24704
 buffer_load_dwordx4 v30, s[12:15], s21 offen offset:2048 lds
 s_waitcnt vmcnt(18)
 v_mfma_f32_16x16x32_bf16 v[48:51], v[136:139], v[88:91], 0
 s_add_u32 m0, s81, 15360
 s_add_u32 s21, s88, 3096576
 ds_write_b128 v251, v[232:235] offset:36864
 v_mfma_f32_16x16x32_bf16 v[56:59], v[136:139], v[112:115], 0
 buffer_load_dwordx4 v31, s[12:15], s21 offen offset:0 lds
 ds_write_b128 v251, v[236:239] offset:37888
 s_waitcnt lgkmcnt(4)
 v_mfma_f32_16x16x32_bf16 v[40:43], v[140:143], v[68:71], v[40:43]
 ds_read_b128 v[136:139], v22 offset:24832
 v_cvt_pk_f16_f32 v44, v44, v45
 buffer_load_dwordx4 v32, s[12:15], s21 offen offset:1024 lds
 v_accvgpr_write_b32 a170, v44
 v_mfma_f32_16x16x32_bf16 v[48:51], v[140:143], v[92:95], v[48:51]
 v_cvt_pk_f16_f32 v46, v46, v47
 buffer_load_dwordx4 v33, s[12:15], s21 offen offset:2048 lds
 ds_write_b128 v251, v[240:243] offset:38912
 v_mfma_f32_16x16x32_bf16 v[56:59], v[140:143], v[116:119], v[56:59]
 v_accvgpr_write_b32 a171, v46
 s_add_u32 m0, s81, 18432
 s_add_u32 s21, s88, 3538944
 ds_read_b64_tr_b16 v[208:209], v250 offset:36864
 s_waitcnt lgkmcnt(6)
 v_mfma_f32_16x16x32_bf16 v[40:43], v[144:147], v[72:75], v[40:43]
 ds_read_b128 v[140:143], v23 offset:24832
 v_cvt_pk_f16_f32 v52, v52, v53
 buffer_load_dwordx4 v34, s[12:15], s21 offen offset:0 lds
 ds_read_b64_tr_b16 v[210:211], v250 offset:37248
 v_mfma_f32_16x16x32_bf16 v[48:51], v[144:147], v[96:99], v[48:51]
 v_accvgpr_write_b32 a178, v52
 buffer_load_dwordx4 v35, s[12:15], s21 offen offset:1024 lds
 ds_read_b64_tr_b16 v[212:213], v250 offset:36896
 ds_read_b64_tr_b16 v[214:215], v250 offset:37280
 v_mfma_f32_16x16x32_bf16 v[56:59], v[144:147], v[120:123], v[56:59]
 v_cvt_pk_f16_f32 v54, v54, v55
 buffer_load_dwordx4 v36, s[12:15], s21 offen offset:2048 lds
 ds_read_b64_tr_b16 v[216:217], v250 offset:36928
 s_waitcnt lgkmcnt(10)
 v_mfma_f32_16x16x32_bf16 v[40:43], v[148:151], v[76:79], v[40:43]
 ds_read_b128 v[144:147], v22 offset:26112
 v_accvgpr_write_b32 a179, v54
 s_add_u32 m0, s81, 21504
 s_add_u32 s21, s88, 3588096
 ds_read_b64_tr_b16 v[218:219], v250 offset:37312
 v_mfma_f32_16x16x32_bf16 v[48:51], v[148:151], v[100:103], v[48:51]
 v_cvt_pk_f16_f32 v60, v60, v61
 buffer_load_dwordx4 v37, s[12:15], s21 offen offset:0 lds
 s_add_u32 s22, s80, 98304
 v_accvgpr_write_b32 a186, v60
 v_mfma_f32_16x16x32_bf16 v[56:59], v[148:151], v[124:127], v[56:59]
 v_cvt_pk_f16_f32 v62, v62, v63
 buffer_load_dwordx4 v38, s[12:15], s21 offen offset:1024 lds
 v_accvgpr_write_b32 a187, v62
 s_waitcnt lgkmcnt(9)
 v_mfma_f32_16x16x32_bf16 v[40:43], v[136:139], v[80:83], v[40:43]
 ds_read_b128 v[148:151], v23 offset:26112
 buffer_load_dwordx4 v39, s[12:15], s21 offen offset:2048 lds
 buffer_load_dwordx4 v[232:235], v244, s[36:39], s22 offen
 v_mfma_f32_16x16x32_bf16 v[48:51], v[136:139], v[104:107], v[48:51]
 buffer_load_dwordx4 v[236:239], v245, s[36:39], s22 offen
 buffer_load_dwordx4 v[240:243], v246, s[36:39], s22 offen
 v_mfma_f32_16x16x32_bf16 v[56:59], v[136:139], v[128:131], v[56:59]
 s_waitcnt lgkmcnt(7)
 v_mfma_f32_16x16x32_bf16 v[40:43], v[140:143], v[84:87], v[40:43]
 ds_read_b128 v[136:139], v22 offset:26240
 v_mfma_f32_16x16x32_bf16 v[48:51], v[140:143], v[108:111], v[48:51]
 v_mfma_f32_16x16x32_bf16 v[56:59], v[140:143], v[132:135], v[56:59]
 s_waitcnt lgkmcnt(3)
 v_mfma_f32_16x16x32_bf16 v[44:47], v[144:147], v[64:67], 0
 ds_read_b128 v[140:143], v23 offset:26240
 v_mfma_f32_16x16x32_bf16 v[52:55], v[144:147], v[88:91], 0
 s_waitcnt lgkmcnt(3)
 v_lshlrev_b32 v27, 16, v208
 v_and_b32 v208, 0xffff0000, v208
 v_cvt_pk_f16_f32 v208, v27, v208
 v_accvgpr_write_b32 a0, v208
 v_mfma_f32_16x16x32_bf16 v[60:63], v[144:147], v[112:115], 0
 v_lshlrev_b32 v27, 16, v209
 v_and_b32 v209, 0xffff0000, v209
 v_cvt_pk_f16_f32 v209, v27, v209
 v_accvgpr_write_b32 a1, v209
 s_waitcnt lgkmcnt(2)
 v_mfma_f32_16x16x32_bf16 v[44:47], v[148:151], v[68:71], v[44:47]
 ds_read_b128 v[144:147], v22 offset:26368
 v_cvt_pk_f16_f32 v40, v40, v41
 v_lshlrev_b32 v27, 16, v210
 v_and_b32 v210, 0xffff0000, v210
 v_cvt_pk_f16_f32 v210, v27, v210
 v_mfma_f32_16x16x32_bf16 v[52:55], v[148:151], v[92:95], v[52:55]
 v_accvgpr_write_b32 a172, v40
 v_accvgpr_write_b32 a2, v210
 v_lshlrev_b32 v27, 16, v211
 v_and_b32 v211, 0xffff0000, v211
 v_cvt_pk_f16_f32 v211, v27, v211
 v_mfma_f32_16x16x32_bf16 v[60:63], v[148:151], v[116:119], v[60:63]
 v_cvt_pk_f16_f32 v42, v42, v43
 v_accvgpr_write_b32 a3, v211
 v_lshlrev_b32 v27, 16, v212
 v_and_b32 v212, 0xffff0000, v212
 s_waitcnt lgkmcnt(2)
 v_mfma_f32_16x16x32_bf16 v[44:47], v[136:139], v[72:75], v[44:47]
 ds_read_b128 v[148:151], v23 offset:26368
 v_accvgpr_write_b32 a173, v42
 v_cvt_pk_f16_f32 v212, v27, v212
 v_accvgpr_write_b32 a20, v212
 v_lshlrev_b32 v27, 16, v213
 v_mfma_f32_16x16x32_bf16 v[52:55], v[136:139], v[96:99], v[52:55]
 v_cvt_pk_f16_f32 v48, v48, v49
 v_and_b32 v213, 0xffff0000, v213
 v_cvt_pk_f16_f32 v213, v27, v213
 v_accvgpr_write_b32 a21, v213
 v_lshlrev_b32 v27, 16, v214
 v_mfma_f32_16x16x32_bf16 v[60:63], v[136:139], v[120:123], v[60:63]
 v_accvgpr_write_b32 a180, v48
 v_and_b32 v214, 0xffff0000, v214
 v_cvt_pk_f16_f32 v214, v27, v214
 v_accvgpr_write_b32 a22, v214
 s_waitcnt lgkmcnt(2)
 v_mfma_f32_16x16x32_bf16 v[44:47], v[140:143], v[76:79], v[44:47]
 s_waitcnt vmcnt(18)
 ds_read_b128 v[136:139], v22 offset:0
 v_cvt_pk_f16_f32 v50, v50, v51
 v_lshlrev_b32 v27, 16, v215
 v_and_b32 v215, 0xffff0000, v215
 v_cvt_pk_f16_f32 v215, v27, v215
 v_mfma_f32_16x16x32_bf16 v[52:55], v[140:143], v[100:103], v[52:55]
 v_accvgpr_write_b32 a181, v50
 v_accvgpr_write_b32 a23, v215
 v_lshlrev_b32 v27, 16, v216
 v_and_b32 v216, 0xffff0000, v216
 v_cvt_pk_f16_f32 v216, v27, v216
 v_mfma_f32_16x16x32_bf16 v[60:63], v[140:143], v[124:127], v[60:63]
 v_cvt_pk_f16_f32 v56, v56, v57
 v_accvgpr_write_b32 a40, v216
 v_lshlrev_b32 v27, 16, v217
 v_and_b32 v217, 0xffff0000, v217
 s_waitcnt lgkmcnt(2)
 v_mfma_f32_16x16x32_bf16 v[44:47], v[144:147], v[80:83], v[44:47]
 ds_read_b128 v[140:143], v23 offset:0
 v_accvgpr_write_b32 a188, v56
 v_cvt_pk_f16_f32 v217, v27, v217
 v_accvgpr_write_b32 a41, v217
 v_lshlrev_b32 v27, 16, v218
 v_mfma_f32_16x16x32_bf16 v[52:55], v[144:147], v[104:107], v[52:55]
 v_cvt_pk_f16_f32 v58, v58, v59
 v_and_b32 v218, 0xffff0000, v218
 v_cvt_pk_f16_f32 v218, v27, v218
 v_accvgpr_write_b32 a42, v218
 v_lshlrev_b32 v27, 16, v219
 v_mfma_f32_16x16x32_bf16 v[60:63], v[144:147], v[128:131], v[60:63]
 v_accvgpr_write_b32 a189, v58
 v_and_b32 v219, 0xffff0000, v219
 v_cvt_pk_f16_f32 v219, v27, v219
 v_accvgpr_write_b32 a43, v219
 s_waitcnt lgkmcnt(2)
 v_mfma_f32_16x16x32_bf16 v[44:47], v[148:151], v[84:87], v[44:47]
 ds_read_b128 v[144:147], v22 offset:128
 s_add_u32 m0, s81, 24576
 s_add_u32 s21, s88, 3932160
 v_mfma_f32_16x16x32_bf16 v[52:55], v[148:151], v[108:111], v[52:55]
 buffer_load_dwordx4 v28, s[12:15], s21 offen offset:0 lds
 v_mfma_f32_16x16x32_bf16 v[60:63], v[148:151], v[132:135], v[60:63]
 buffer_load_dwordx4 v29, s[12:15], s21 offen offset:1024 lds
 s_waitcnt lgkmcnt(2)
 v_mfma_f32_16x16x32_bf16 v[40:43], v[136:139], v[64:67], 0
 ds_read_b128 v[148:151], v23 offset:128
 buffer_load_dwordx4 v30, s[12:15], s21 offen offset:2048 lds
 s_waitcnt vmcnt(18)
 v_mfma_f32_16x16x32_bf16 v[48:51], v[136:139], v[88:91], 0
 s_add_u32 m0, s81, 27648
 s_add_u32 s21, s88, 3981312
 ds_write_b128 v251, v[220:223] offset:36864
 v_mfma_f32_16x16x32_bf16 v[56:59], v[136:139], v[112:115], 0
 buffer_load_dwordx4 v31, s[12:15], s21 offen offset:0 lds
 ds_write_b128 v251, v[224:227] offset:37888
 s_waitcnt lgkmcnt(4)
 v_mfma_f32_16x16x32_bf16 v[40:43], v[140:143], v[68:71], v[40:43]
 ds_read_b128 v[136:139], v22 offset:256
 v_cvt_pk_f16_f32 v44, v44, v45
 buffer_load_dwordx4 v32, s[12:15], s21 offen offset:1024 lds
 v_accvgpr_write_b32 a174, v44
 v_mfma_f32_16x16x32_bf16 v[48:51], v[140:143], v[92:95], v[48:51]
 v_cvt_pk_f16_f32 v46, v46, v47
 buffer_load_dwordx4 v33, s[12:15], s21 offen offset:2048 lds
 ds_write_b128 v251, v[228:231] offset:38912
 v_mfma_f32_16x16x32_bf16 v[56:59], v[140:143], v[116:119], v[56:59]
 v_accvgpr_write_b32 a175, v46
 s_add_u32 m0, s81, 30720
 s_add_u32 s21, s88, 4423680
 ds_read_b64_tr_b16 v[208:209], v250 offset:36864
 s_waitcnt lgkmcnt(6)
 v_mfma_f32_16x16x32_bf16 v[40:43], v[144:147], v[72:75], v[40:43]
 ds_read_b128 v[140:143], v23 offset:256
 v_cvt_pk_f16_f32 v52, v52, v53
 buffer_load_dwordx4 v34, s[12:15], s21 offen offset:0 lds
 ds_read_b64_tr_b16 v[210:211], v250 offset:37248
 v_mfma_f32_16x16x32_bf16 v[48:51], v[144:147], v[96:99], v[48:51]
 v_accvgpr_write_b32 a182, v52
 buffer_load_dwordx4 v35, s[12:15], s21 offen offset:1024 lds
 ds_read_b64_tr_b16 v[212:213], v250 offset:36896
 ds_read_b64_tr_b16 v[214:215], v250 offset:37280
 v_mfma_f32_16x16x32_bf16 v[56:59], v[144:147], v[120:123], v[56:59]
 v_cvt_pk_f16_f32 v54, v54, v55
 buffer_load_dwordx4 v36, s[12:15], s21 offen offset:2048 lds
 ds_read_b64_tr_b16 v[216:217], v250 offset:36928
 s_waitcnt lgkmcnt(10)
 v_mfma_f32_16x16x32_bf16 v[40:43], v[148:151], v[76:79], v[40:43]
 ds_read_b128 v[144:147], v22 offset:1536
 v_accvgpr_write_b32 a183, v54
 s_add_u32 m0, s81, 33792
 s_add_u32 s21, s88, 4472832
 ds_read_b64_tr_b16 v[218:219], v250 offset:37312
 v_mfma_f32_16x16x32_bf16 v[48:51], v[148:151], v[100:103], v[48:51]
 v_cvt_pk_f16_f32 v60, v60, v61
 buffer_load_dwordx4 v37, s[12:15], s21 offen offset:0 lds
 s_add_u32 s22, s80, 1081344
 v_accvgpr_write_b32 a190, v60
 v_mfma_f32_16x16x32_bf16 v[56:59], v[148:151], v[124:127], v[56:59]
 v_cvt_pk_f16_f32 v62, v62, v63
 buffer_load_dwordx4 v38, s[12:15], s21 offen offset:1024 lds
 v_accvgpr_write_b32 a191, v62
 s_waitcnt lgkmcnt(9)
 v_mfma_f32_16x16x32_bf16 v[40:43], v[136:139], v[80:83], v[40:43]
 ds_read_b128 v[148:151], v23 offset:1536
 buffer_load_dwordx4 v39, s[12:15], s21 offen offset:2048 lds
 buffer_load_dwordx4 v[220:223], v244, s[36:39], s22 offen
 v_mfma_f32_16x16x32_bf16 v[48:51], v[136:139], v[104:107], v[48:51]
 buffer_load_dwordx4 v[224:227], v245, s[36:39], s22 offen
 buffer_load_dwordx4 v[228:231], v246, s[36:39], s22 offen
 v_mfma_f32_16x16x32_bf16 v[56:59], v[136:139], v[128:131], v[56:59]
 s_waitcnt lgkmcnt(7)
 v_mfma_f32_16x16x32_bf16 v[40:43], v[140:143], v[84:87], v[40:43]
 ds_read_b128 v[136:139], v22 offset:1664
 v_mfma_f32_16x16x32_bf16 v[48:51], v[140:143], v[108:111], v[48:51]
 v_mfma_f32_16x16x32_bf16 v[56:59], v[140:143], v[132:135], v[56:59]
 s_waitcnt lgkmcnt(3)
 v_mfma_f32_16x16x32_bf16 v[44:47], v[144:147], v[64:67], 0
 ds_read_b128 v[140:143], v23 offset:1664
 v_mfma_f32_16x16x32_bf16 v[52:55], v[144:147], v[88:91], 0
 s_waitcnt lgkmcnt(3)
 v_lshlrev_b32 v27, 16, v208
 v_and_b32 v208, 0xffff0000, v208
 v_cvt_pk_f16_f32 v208, v27, v208
 v_accvgpr_write_b32 a4, v208
 v_mfma_f32_16x16x32_bf16 v[60:63], v[144:147], v[112:115], 0
 v_lshlrev_b32 v27, 16, v209
 v_and_b32 v209, 0xffff0000, v209
 v_cvt_pk_f16_f32 v209, v27, v209
 v_accvgpr_write_b32 a5, v209
 s_waitcnt lgkmcnt(2)
 v_mfma_f32_16x16x32_bf16 v[44:47], v[148:151], v[68:71], v[44:47]
 ds_read_b128 v[144:147], v22 offset:1792
 v_cvt_pk_f16_f32 v40, v40, v41
 v_lshlrev_b32 v27, 16, v210
 v_and_b32 v210, 0xffff0000, v210
 v_cvt_pk_f16_f32 v210, v27, v210
 v_mfma_f32_16x16x32_bf16 v[52:55], v[148:151], v[92:95], v[52:55]
 v_accvgpr_write_b32 a192, v40
 v_accvgpr_write_b32 a6, v210
 v_lshlrev_b32 v27, 16, v211
 v_and_b32 v211, 0xffff0000, v211
 v_cvt_pk_f16_f32 v211, v27, v211
 v_mfma_f32_16x16x32_bf16 v[60:63], v[148:151], v[116:119], v[60:63]
 v_cvt_pk_f16_f32 v42, v42, v43
 v_accvgpr_write_b32 a7, v211
 v_lshlrev_b32 v27, 16, v212
 v_and_b32 v212, 0xffff0000, v212
 s_waitcnt lgkmcnt(2)
 v_mfma_f32_16x16x32_bf16 v[44:47], v[136:139], v[72:75], v[44:47]
 ds_read_b128 v[148:151], v23 offset:1792
 v_accvgpr_write_b32 a193, v42
 v_cvt_pk_f16_f32 v212, v27, v212
 v_accvgpr_write_b32 a24, v212
 v_lshlrev_b32 v27, 16, v213
 v_mfma_f32_16x16x32_bf16 v[52:55], v[136:139], v[96:99], v[52:55]
 v_cvt_pk_f16_f32 v48, v48, v49
 v_and_b32 v213, 0xffff0000, v213
 v_cvt_pk_f16_f32 v213, v27, v213
 v_accvgpr_write_b32 a25, v213
 v_lshlrev_b32 v27, 16, v214
 v_mfma_f32_16x16x32_bf16 v[60:63], v[136:139], v[120:123], v[60:63]
 v_accvgpr_write_b32 a200, v48
 v_and_b32 v214, 0xffff0000, v214
 v_cvt_pk_f16_f32 v214, v27, v214
 v_accvgpr_write_b32 a26, v214
 s_waitcnt lgkmcnt(2)
 v_mfma_f32_16x16x32_bf16 v[44:47], v[140:143], v[76:79], v[44:47]
 s_waitcnt vmcnt(18)
 ds_read_b128 v[136:139], v22 offset:12288
 v_cvt_pk_f16_f32 v50, v50, v51
 v_lshlrev_b32 v27, 16, v215
 v_and_b32 v215, 0xffff0000, v215
 v_cvt_pk_f16_f32 v215, v27, v215
 v_mfma_f32_16x16x32_bf16 v[52:55], v[140:143], v[100:103], v[52:55]
 v_accvgpr_write_b32 a201, v50
 v_accvgpr_write_b32 a27, v215
 v_lshlrev_b32 v27, 16, v216
 v_and_b32 v216, 0xffff0000, v216
 v_cvt_pk_f16_f32 v216, v27, v216
 v_mfma_f32_16x16x32_bf16 v[60:63], v[140:143], v[124:127], v[60:63]
 v_cvt_pk_f16_f32 v56, v56, v57
 v_accvgpr_write_b32 a44, v216
 v_lshlrev_b32 v27, 16, v217
 v_and_b32 v217, 0xffff0000, v217
 s_waitcnt lgkmcnt(2)
 v_mfma_f32_16x16x32_bf16 v[44:47], v[144:147], v[80:83], v[44:47]
 ds_read_b128 v[140:143], v23 offset:12288
 v_accvgpr_write_b32 a208, v56
 v_cvt_pk_f16_f32 v217, v27, v217
 v_accvgpr_write_b32 a45, v217
 v_lshlrev_b32 v27, 16, v218
 v_mfma_f32_16x16x32_bf16 v[52:55], v[144:147], v[104:107], v[52:55]
 v_cvt_pk_f16_f32 v58, v58, v59
 v_and_b32 v218, 0xffff0000, v218
 v_cvt_pk_f16_f32 v218, v27, v218
 v_accvgpr_write_b32 a46, v218
 v_lshlrev_b32 v27, 16, v219
 v_mfma_f32_16x16x32_bf16 v[60:63], v[144:147], v[128:131], v[60:63]
 v_accvgpr_write_b32 a209, v58
 v_and_b32 v219, 0xffff0000, v219
 v_cvt_pk_f16_f32 v219, v27, v219
 v_accvgpr_write_b32 a47, v219
 s_waitcnt lgkmcnt(2)
 v_mfma_f32_16x16x32_bf16 v[44:47], v[148:151], v[84:87], v[44:47]
 ds_read_b128 v[144:147], v22 offset:12416
 s_add_u32 m0, s81, 0
 s_add_u32 s21, s88, 4915200
 v_mfma_f32_16x16x32_bf16 v[52:55], v[148:151], v[108:111], v[52:55]
 buffer_load_dwordx4 v28, s[12:15], s21 offen offset:0 lds
 v_mfma_f32_16x16x32_bf16 v[60:63], v[148:151], v[132:135], v[60:63]
 buffer_load_dwordx4 v29, s[12:15], s21 offen offset:1024 lds
 s_waitcnt lgkmcnt(2)
 v_mfma_f32_16x16x32_bf16 v[40:43], v[136:139], v[64:67], 0
 ds_read_b128 v[148:151], v23 offset:12416
 buffer_load_dwordx4 v30, s[12:15], s21 offen offset:2048 lds
 s_waitcnt vmcnt(18)
 v_mfma_f32_16x16x32_bf16 v[48:51], v[136:139], v[88:91], 0
 s_add_u32 m0, s81, 3072
 s_add_u32 s21, s88, 4964352
 ds_write_b128 v251, v[232:235] offset:36864
 v_mfma_f32_16x16x32_bf16 v[56:59], v[136:139], v[112:115], 0
 buffer_load_dwordx4 v31, s[12:15], s21 offen offset:0 lds
 ds_write_b128 v251, v[236:239] offset:37888
 s_waitcnt lgkmcnt(4)
 v_mfma_f32_16x16x32_bf16 v[40:43], v[140:143], v[68:71], v[40:43]
 ds_read_b128 v[136:139], v22 offset:12544
 v_cvt_pk_f16_f32 v44, v44, v45
 buffer_load_dwordx4 v32, s[12:15], s21 offen offset:1024 lds
 v_accvgpr_write_b32 a194, v44
 v_mfma_f32_16x16x32_bf16 v[48:51], v[140:143], v[92:95], v[48:51]
 v_cvt_pk_f16_f32 v46, v46, v47
 buffer_load_dwordx4 v33, s[12:15], s21 offen offset:2048 lds
 ds_write_b128 v251, v[240:243] offset:38912
 v_mfma_f32_16x16x32_bf16 v[56:59], v[140:143], v[116:119], v[56:59]
 v_accvgpr_write_b32 a195, v46
 s_add_u32 m0, s81, 6144
 s_add_u32 s21, s88, 5406720
 ds_read_b64_tr_b16 v[208:209], v250 offset:36864
 s_waitcnt lgkmcnt(6)
 v_mfma_f32_16x16x32_bf16 v[40:43], v[144:147], v[72:75], v[40:43]
 ds_read_b128 v[140:143], v23 offset:12544
 v_cvt_pk_f16_f32 v52, v52, v53
 buffer_load_dwordx4 v34, s[12:15], s21 offen offset:0 lds
 ds_read_b64_tr_b16 v[210:211], v250 offset:37248
 v_mfma_f32_16x16x32_bf16 v[48:51], v[144:147], v[96:99], v[48:51]
 v_accvgpr_write_b32 a202, v52
 buffer_load_dwordx4 v35, s[12:15], s21 offen offset:1024 lds
 ds_read_b64_tr_b16 v[212:213], v250 offset:36896
 ds_read_b64_tr_b16 v[214:215], v250 offset:37280
 v_mfma_f32_16x16x32_bf16 v[56:59], v[144:147], v[120:123], v[56:59]
 v_cvt_pk_f16_f32 v54, v54, v55
 buffer_load_dwordx4 v36, s[12:15], s21 offen offset:2048 lds
 ds_read_b64_tr_b16 v[216:217], v250 offset:36928
 s_waitcnt lgkmcnt(10)
 v_mfma_f32_16x16x32_bf16 v[40:43], v[148:151], v[76:79], v[40:43]
 ds_read_b128 v[144:147], v22 offset:13824
 v_accvgpr_write_b32 a203, v54
 s_add_u32 m0, s81, 9216
 s_add_u32 s21, s88, 5455872
 ds_read_b64_tr_b16 v[218:219], v250 offset:37312
 v_mfma_f32_16x16x32_bf16 v[48:51], v[148:151], v[100:103], v[48:51]
 v_cvt_pk_f16_f32 v60, v60, v61
 buffer_load_dwordx4 v37, s[12:15], s21 offen offset:0 lds
 s_add_u32 s22, s80, 196608
 v_accvgpr_write_b32 a210, v60
 v_mfma_f32_16x16x32_bf16 v[56:59], v[148:151], v[124:127], v[56:59]
 v_cvt_pk_f16_f32 v62, v62, v63
 buffer_load_dwordx4 v38, s[12:15], s21 offen offset:1024 lds
 v_accvgpr_write_b32 a211, v62
 s_waitcnt lgkmcnt(9)
 v_mfma_f32_16x16x32_bf16 v[40:43], v[136:139], v[80:83], v[40:43]
 ds_read_b128 v[148:151], v23 offset:13824
 buffer_load_dwordx4 v39, s[12:15], s21 offen offset:2048 lds
 buffer_load_dwordx4 v[232:235], v247, s[36:39], s22 offen
 v_mfma_f32_16x16x32_bf16 v[48:51], v[136:139], v[104:107], v[48:51]
 buffer_load_dwordx4 v[236:239], v248, s[36:39], s22 offen
 buffer_load_dwordx4 v[240:243], v249, s[36:39], s22 offen
 v_mfma_f32_16x16x32_bf16 v[56:59], v[136:139], v[128:131], v[56:59]
 s_waitcnt lgkmcnt(7)
 v_mfma_f32_16x16x32_bf16 v[40:43], v[140:143], v[84:87], v[40:43]
 ds_read_b128 v[136:139], v22 offset:13952
 v_mfma_f32_16x16x32_bf16 v[48:51], v[140:143], v[108:111], v[48:51]
 v_mfma_f32_16x16x32_bf16 v[56:59], v[140:143], v[132:135], v[56:59]
 s_waitcnt lgkmcnt(3)
 v_mfma_f32_16x16x32_bf16 v[44:47], v[144:147], v[64:67], 0
 ds_read_b128 v[140:143], v23 offset:13952
 v_mfma_f32_16x16x32_bf16 v[52:55], v[144:147], v[88:91], 0
 s_waitcnt lgkmcnt(3)
 v_lshlrev_b32 v27, 16, v208
 v_and_b32 v208, 0xffff0000, v208
 v_cvt_pk_f16_f32 v208, v27, v208
 v_accvgpr_write_b32 a8, v208
 v_mfma_f32_16x16x32_bf16 v[60:63], v[144:147], v[112:115], 0
 v_lshlrev_b32 v27, 16, v209
 v_and_b32 v209, 0xffff0000, v209
 v_cvt_pk_f16_f32 v209, v27, v209
 v_accvgpr_write_b32 a9, v209
 s_waitcnt lgkmcnt(2)
 v_mfma_f32_16x16x32_bf16 v[44:47], v[148:151], v[68:71], v[44:47]
 ds_read_b128 v[144:147], v22 offset:14080
 v_cvt_pk_f16_f32 v40, v40, v41
 v_lshlrev_b32 v27, 16, v210
 v_and_b32 v210, 0xffff0000, v210
 v_cvt_pk_f16_f32 v210, v27, v210
 v_mfma_f32_16x16x32_bf16 v[52:55], v[148:151], v[92:95], v[52:55]
 v_accvgpr_write_b32 a196, v40
 v_accvgpr_write_b32 a10, v210
 v_lshlrev_b32 v27, 16, v211
 v_and_b32 v211, 0xffff0000, v211
 v_cvt_pk_f16_f32 v211, v27, v211
 v_mfma_f32_16x16x32_bf16 v[60:63], v[148:151], v[116:119], v[60:63]
 v_cvt_pk_f16_f32 v42, v42, v43
 v_accvgpr_write_b32 a11, v211
 v_lshlrev_b32 v27, 16, v212
 v_and_b32 v212, 0xffff0000, v212
 s_waitcnt lgkmcnt(2)
 v_mfma_f32_16x16x32_bf16 v[44:47], v[136:139], v[72:75], v[44:47]
 ds_read_b128 v[148:151], v23 offset:14080
 v_accvgpr_write_b32 a197, v42
 v_cvt_pk_f16_f32 v212, v27, v212
 v_accvgpr_write_b32 a28, v212
 v_lshlrev_b32 v27, 16, v213
 v_mfma_f32_16x16x32_bf16 v[52:55], v[136:139], v[96:99], v[52:55]
 v_cvt_pk_f16_f32 v48, v48, v49
 v_and_b32 v213, 0xffff0000, v213
 v_cvt_pk_f16_f32 v213, v27, v213
 v_accvgpr_write_b32 a29, v213
 v_lshlrev_b32 v27, 16, v214
 v_mfma_f32_16x16x32_bf16 v[60:63], v[136:139], v[120:123], v[60:63]
 v_accvgpr_write_b32 a204, v48
 v_and_b32 v214, 0xffff0000, v214
 v_cvt_pk_f16_f32 v214, v27, v214
 v_accvgpr_write_b32 a30, v214
 s_waitcnt lgkmcnt(2)
 v_mfma_f32_16x16x32_bf16 v[44:47], v[140:143], v[76:79], v[44:47]
 s_waitcnt vmcnt(18)
 ds_read_b128 v[136:139], v22 offset:24576
 v_cvt_pk_f16_f32 v50, v50, v51
 v_lshlrev_b32 v27, 16, v215
 v_and_b32 v215, 0xffff0000, v215
 v_cvt_pk_f16_f32 v215, v27, v215
 v_mfma_f32_16x16x32_bf16 v[52:55], v[140:143], v[100:103], v[52:55]
 v_accvgpr_write_b32 a205, v50
 v_accvgpr_write_b32 a31, v215
 v_lshlrev_b32 v27, 16, v216
 v_and_b32 v216, 0xffff0000, v216
 v_cvt_pk_f16_f32 v216, v27, v216
 v_mfma_f32_16x16x32_bf16 v[60:63], v[140:143], v[124:127], v[60:63]
 v_cvt_pk_f16_f32 v56, v56, v57
 v_accvgpr_write_b32 a48, v216
 v_lshlrev_b32 v27, 16, v217
 v_and_b32 v217, 0xffff0000, v217
 s_waitcnt lgkmcnt(2)
 v_mfma_f32_16x16x32_bf16 v[44:47], v[144:147], v[80:83], v[44:47]
 ds_read_b128 v[140:143], v23 offset:24576
 v_accvgpr_write_b32 a212, v56
 v_cvt_pk_f16_f32 v217, v27, v217
 v_accvgpr_write_b32 a49, v217
 v_lshlrev_b32 v27, 16, v218
 v_mfma_f32_16x16x32_bf16 v[52:55], v[144:147], v[104:107], v[52:55]
 v_cvt_pk_f16_f32 v58, v58, v59
 v_and_b32 v218, 0xffff0000, v218
 v_cvt_pk_f16_f32 v218, v27, v218
 v_accvgpr_write_b32 a50, v218
 v_lshlrev_b32 v27, 16, v219
 v_mfma_f32_16x16x32_bf16 v[60:63], v[144:147], v[128:131], v[60:63]
 v_accvgpr_write_b32 a213, v58
 v_and_b32 v219, 0xffff0000, v219
 v_cvt_pk_f16_f32 v219, v27, v219
 v_accvgpr_write_b32 a51, v219
 s_waitcnt lgkmcnt(2)
 v_mfma_f32_16x16x32_bf16 v[44:47], v[148:151], v[84:87], v[44:47]
 ds_read_b128 v[144:147], v22 offset:24704
 s_add_u32 m0, s81, 12288
 s_add_u32 s21, s88, 4030464
 v_mfma_f32_16x16x32_bf16 v[52:55], v[148:151], v[108:111], v[52:55]
 buffer_load_dwordx4 v28, s[12:15], s21 offen offset:0 lds
 v_mfma_f32_16x16x32_bf16 v[60:63], v[148:151], v[132:135], v[60:63]
 buffer_load_dwordx4 v29, s[12:15], s21 offen offset:1024 lds
 s_waitcnt lgkmcnt(2)
 v_mfma_f32_16x16x32_bf16 v[40:43], v[136:139], v[64:67], 0
 ds_read_b128 v[148:151], v23 offset:24704
 buffer_load_dwordx4 v30, s[12:15], s21 offen offset:2048 lds
 s_waitcnt vmcnt(18)
 v_mfma_f32_16x16x32_bf16 v[48:51], v[136:139], v[88:91], 0
 s_add_u32 m0, s81, 15360
 s_add_u32 s21, s88, 4079616
 ds_write_b128 v251, v[220:223] offset:36864
 v_mfma_f32_16x16x32_bf16 v[56:59], v[136:139], v[112:115], 0
 buffer_load_dwordx4 v31, s[12:15], s21 offen offset:0 lds
 ds_write_b128 v251, v[224:227] offset:37888
 s_waitcnt lgkmcnt(4)
 v_mfma_f32_16x16x32_bf16 v[40:43], v[140:143], v[68:71], v[40:43]
 ds_read_b128 v[136:139], v22 offset:24832
 v_cvt_pk_f16_f32 v44, v44, v45
 buffer_load_dwordx4 v32, s[12:15], s21 offen offset:1024 lds
 v_accvgpr_write_b32 a198, v44
 v_mfma_f32_16x16x32_bf16 v[48:51], v[140:143], v[92:95], v[48:51]
 v_cvt_pk_f16_f32 v46, v46, v47
 buffer_load_dwordx4 v33, s[12:15], s21 offen offset:2048 lds
 ds_write_b128 v251, v[228:231] offset:38912
 v_mfma_f32_16x16x32_bf16 v[56:59], v[140:143], v[116:119], v[56:59]
 v_accvgpr_write_b32 a199, v46
 s_add_u32 m0, s81, 18432
 s_add_u32 s21, s88, 4521984
 ds_read_b64_tr_b16 v[208:209], v250 offset:36864
 s_waitcnt lgkmcnt(6)
 v_mfma_f32_16x16x32_bf16 v[40:43], v[144:147], v[72:75], v[40:43]
 ds_read_b128 v[140:143], v23 offset:24832
 v_cvt_pk_f16_f32 v52, v52, v53
 buffer_load_dwordx4 v34, s[12:15], s21 offen offset:0 lds
 ds_read_b64_tr_b16 v[210:211], v250 offset:37248
 v_mfma_f32_16x16x32_bf16 v[48:51], v[144:147], v[96:99], v[48:51]
 v_accvgpr_write_b32 a206, v52
 buffer_load_dwordx4 v35, s[12:15], s21 offen offset:1024 lds
 ds_read_b64_tr_b16 v[212:213], v250 offset:36896
 ds_read_b64_tr_b16 v[214:215], v250 offset:37280
 v_mfma_f32_16x16x32_bf16 v[56:59], v[144:147], v[120:123], v[56:59]
 v_cvt_pk_f16_f32 v54, v54, v55
 buffer_load_dwordx4 v36, s[12:15], s21 offen offset:2048 lds
 ds_read_b64_tr_b16 v[216:217], v250 offset:36928
 s_waitcnt lgkmcnt(10)
 v_mfma_f32_16x16x32_bf16 v[40:43], v[148:151], v[76:79], v[40:43]
 ds_read_b128 v[144:147], v22 offset:26112
 v_accvgpr_write_b32 a207, v54
 s_add_u32 m0, s81, 21504
 s_add_u32 s21, s88, 4571136
 ds_read_b64_tr_b16 v[218:219], v250 offset:37312
 v_mfma_f32_16x16x32_bf16 v[48:51], v[148:151], v[100:103], v[48:51]
 v_cvt_pk_f16_f32 v60, v60, v61
 buffer_load_dwordx4 v37, s[12:15], s21 offen offset:0 lds
 v_accvgpr_write_b32 a214, v60
 v_mfma_f32_16x16x32_bf16 v[56:59], v[148:151], v[124:127], v[56:59]
 v_cvt_pk_f16_f32 v62, v62, v63
 buffer_load_dwordx4 v38, s[12:15], s21 offen offset:1024 lds
 v_accvgpr_write_b32 a215, v62
 s_waitcnt lgkmcnt(9)
 v_mfma_f32_16x16x32_bf16 v[40:43], v[136:139], v[80:83], v[40:43]
 ds_read_b128 v[148:151], v23 offset:26112
 buffer_load_dwordx4 v39, s[12:15], s21 offen offset:2048 lds
 v_mfma_f32_16x16x32_bf16 v[48:51], v[136:139], v[104:107], v[48:51]
 v_mfma_f32_16x16x32_bf16 v[56:59], v[136:139], v[128:131], v[56:59]
 s_waitcnt lgkmcnt(7)
 v_mfma_f32_16x16x32_bf16 v[40:43], v[140:143], v[84:87], v[40:43]
 ds_read_b128 v[136:139], v22 offset:26240
 v_mfma_f32_16x16x32_bf16 v[48:51], v[140:143], v[108:111], v[48:51]
 s_waitcnt lgkmcnt(2)
 v_lshlrev_b32 v27, 16, v208
 v_and_b32 v208, 0xffff0000, v208
 v_cvt_pk_f16_f32 v208, v27, v208
 v_accvgpr_write_b32 a12, v208
 v_mfma_f32_16x16x32_bf16 v[56:59], v[140:143], v[132:135], v[56:59]
 v_lshlrev_b32 v27, 16, v209
 v_and_b32 v209, 0xffff0000, v209
 v_cvt_pk_f16_f32 v209, v27, v209
 v_accvgpr_write_b32 a13, v209
 s_waitcnt lgkmcnt(3)
 v_mfma_f32_16x16x32_bf16 v[44:47], v[144:147], v[64:67], 0
 ds_read_b128 v[140:143], v23 offset:26240
 v_lshlrev_b32 v27, 16, v210
 v_and_b32 v210, 0xffff0000, v210
 v_cvt_pk_f16_f32 v210, v27, v210
 v_accvgpr_write_b32 a14, v210
 v_mfma_f32_16x16x32_bf16 v[52:55], v[144:147], v[88:91], 0
 v_lshlrev_b32 v27, 16, v211
 v_and_b32 v211, 0xffff0000, v211
 v_cvt_pk_f16_f32 v211, v27, v211
 v_accvgpr_write_b32 a15, v211
 v_lshlrev_b32 v27, 16, v212
 v_mfma_f32_16x16x32_bf16 v[60:63], v[144:147], v[112:115], 0
 v_and_b32 v212, 0xffff0000, v212
 v_cvt_pk_f16_f32 v212, v27, v212
 v_accvgpr_write_b32 a32, v212
 v_lshlrev_b32 v27, 16, v213
 s_waitcnt lgkmcnt(2)
 v_mfma_f32_16x16x32_bf16 v[44:47], v[148:151], v[68:71], v[44:47]
 ds_read_b128 v[144:147], v22 offset:26368
 v_cvt_pk_f16_f32 v40, v40, v41
 v_and_b32 v213, 0xffff0000, v213
 v_cvt_pk_f16_f32 v213, v27, v213
 v_accvgpr_write_b32 a33, v213
 v_mfma_f32_16x16x32_bf16 v[52:55], v[148:151], v[92:95], v[52:55]
 v_accvgpr_write_b32 a216, v40
 v_lshlrev_b32 v27, 16, v214
 v_and_b32 v214, 0xffff0000, v214
 v_cvt_pk_f16_f32 v214, v27, v214
 v_accvgpr_write_b32 a34, v214
 v_mfma_f32_16x16x32_bf16 v[60:63], v[148:151], v[116:119], v[60:63]
 v_cvt_pk_f16_f32 v42, v42, v43
 v_lshlrev_b32 v27, 16, v215
 v_and_b32 v215, 0xffff0000, v215
 v_cvt_pk_f16_f32 v215, v27, v215
 s_waitcnt lgkmcnt(2)
 v_mfma_f32_16x16x32_bf16 v[44:47], v[136:139], v[72:75], v[44:47]
 ds_read_b128 v[148:151], v23 offset:26368
 v_accvgpr_write_b32 a217, v42
 v_accvgpr_write_b32 a35, v215
 v_lshlrev_b32 v27, 16, v216
 v_and_b32 v216, 0xffff0000, v216
 v_mfma_f32_16x16x32_bf16 v[52:55], v[136:139], v[96:99], v[52:55]
 v_cvt_pk_f16_f32 v48, v48, v49
 v_cvt_pk_f16_f32 v216, v27, v216
 v_accvgpr_write_b32 a52, v216
 v_lshlrev_b32 v27, 16, v217
 v_and_b32 v217, 0xffff0000, v217
 v_mfma_f32_16x16x32_bf16 v[60:63], v[136:139], v[120:123], v[60:63]
 v_accvgpr_write_b32 a224, v48
 v_cvt_pk_f16_f32 v217, v27, v217
 v_accvgpr_write_b32 a53, v217
 v_lshlrev_b32 v27, 16, v218
 s_waitcnt lgkmcnt(2)
 v_mfma_f32_16x16x32_bf16 v[44:47], v[140:143], v[76:79], v[44:47]
 s_waitcnt vmcnt(15)
 ds_read_b128 v[136:139], v22 offset:0
 v_cvt_pk_f16_f32 v50, v50, v51
 v_and_b32 v218, 0xffff0000, v218
 v_cvt_pk_f16_f32 v218, v27, v218
 v_accvgpr_write_b32 a54, v218
 v_mfma_f32_16x16x32_bf16 v[52:55], v[140:143], v[100:103], v[52:55]
 v_accvgpr_write_b32 a225, v50
 v_lshlrev_b32 v27, 16, v219
 v_and_b32 v219, 0xffff0000, v219
 v_cvt_pk_f16_f32 v219, v27, v219
 v_accvgpr_write_b32 a55, v219
 v_mfma_f32_16x16x32_bf16 v[60:63], v[140:143], v[124:127], v[60:63]
 v_cvt_pk_f16_f32 v56, v56, v57
 v_accvgpr_write_b32 a232, v56
 v_cvt_pk_f16_f32 v58, v58, v59
 v_accvgpr_write_b32 a233, v58
 s_waitcnt lgkmcnt(2)
 v_mfma_f32_16x16x32_bf16 v[44:47], v[144:147], v[80:83], v[44:47]
 ds_read_b128 v[140:143], v23 offset:0
 v_mfma_f32_16x16x32_bf16 v[52:55], v[144:147], v[104:107], v[52:55]
 v_mfma_f32_16x16x32_bf16 v[60:63], v[144:147], v[128:131], v[60:63]
 s_waitcnt lgkmcnt(2)
 v_mfma_f32_16x16x32_bf16 v[44:47], v[148:151], v[84:87], v[44:47]
 ds_read_b128 v[144:147], v22 offset:128
 s_add_u32 m0, s81, 24576
 s_add_u32 s21, s88, 5013504
 v_mfma_f32_16x16x32_bf16 v[52:55], v[148:151], v[108:111], v[52:55]
 buffer_load_dwordx4 v28, s[12:15], s21 offen offset:0 lds
 v_mfma_f32_16x16x32_bf16 v[60:63], v[148:151], v[132:135], v[60:63]
 buffer_load_dwordx4 v29, s[12:15], s21 offen offset:1024 lds
 s_waitcnt lgkmcnt(2)
 v_mfma_f32_16x16x32_bf16 v[40:43], v[136:139], v[64:67], 0
 ds_read_b128 v[148:151], v23 offset:128
 buffer_load_dwordx4 v30, s[12:15], s21 offen offset:2048 lds
 s_waitcnt vmcnt(15)
 v_mfma_f32_16x16x32_bf16 v[48:51], v[136:139], v[88:91], 0
 s_add_u32 m0, s81, 27648
 s_add_u32 s21, s88, 5062656
 ds_write_b128 v251, v[232:235] offset:36864
 v_mfma_f32_16x16x32_bf16 v[56:59], v[136:139], v[112:115], 0
 buffer_load_dwordx4 v31, s[12:15], s21 offen offset:0 lds
 ds_write_b128 v251, v[236:239] offset:37888
 s_waitcnt lgkmcnt(4)
 v_mfma_f32_16x16x32_bf16 v[40:43], v[140:143], v[68:71], v[40:43]
 ds_read_b128 v[136:139], v22 offset:256
 v_cvt_pk_f16_f32 v44, v44, v45
 buffer_load_dwordx4 v32, s[12:15], s21 offen offset:1024 lds
 v_accvgpr_write_b32 a218, v44
 v_mfma_f32_16x16x32_bf16 v[48:51], v[140:143], v[92:95], v[48:51]
 v_cvt_pk_f16_f32 v46, v46, v47
 buffer_load_dwordx4 v33, s[12:15], s21 offen offset:2048 lds
 ds_write_b128 v251, v[240:243] offset:38912
 v_mfma_f32_16x16x32_bf16 v[56:59], v[140:143], v[116:119], v[56:59]
 v_accvgpr_write_b32 a219, v46
 s_add_u32 m0, s81, 30720
 s_add_u32 s21, s88, 5505024
 ds_read_b64_tr_b16 v[208:209], v250 offset:36864
 s_waitcnt lgkmcnt(6)
 v_mfma_f32_16x16x32_bf16 v[40:43], v[144:147], v[72:75], v[40:43]
 ds_read_b128 v[140:143], v23 offset:256
 v_cvt_pk_f16_f32 v52, v52, v53
 buffer_load_dwordx4 v34, s[12:15], s21 offen offset:0 lds
 ds_read_b64_tr_b16 v[210:211], v250 offset:37248
 v_mfma_f32_16x16x32_bf16 v[48:51], v[144:147], v[96:99], v[48:51]
 v_accvgpr_write_b32 a226, v52
 buffer_load_dwordx4 v35, s[12:15], s21 offen offset:1024 lds
 ds_read_b64_tr_b16 v[212:213], v250 offset:36896
 ds_read_b64_tr_b16 v[214:215], v250 offset:37280
 v_mfma_f32_16x16x32_bf16 v[56:59], v[144:147], v[120:123], v[56:59]
 v_cvt_pk_f16_f32 v54, v54, v55
 buffer_load_dwordx4 v36, s[12:15], s21 offen offset:2048 lds
 ds_read_b64_tr_b16 v[216:217], v250 offset:36928
 s_waitcnt lgkmcnt(10)
 v_mfma_f32_16x16x32_bf16 v[40:43], v[148:151], v[76:79], v[40:43]
 ds_read_b128 v[144:147], v22 offset:1536
 v_accvgpr_write_b32 a227, v54
 s_add_u32 m0, s81, 33792
 s_add_u32 s21, s88, 5554176
 ds_read_b64_tr_b16 v[218:219], v250 offset:37312
 v_mfma_f32_16x16x32_bf16 v[48:51], v[148:151], v[100:103], v[48:51]
 v_cvt_pk_f16_f32 v60, v60, v61
 buffer_load_dwordx4 v37, s[12:15], s21 offen offset:0 lds
 v_accvgpr_write_b32 a234, v60
 v_mfma_f32_16x16x32_bf16 v[56:59], v[148:151], v[124:127], v[56:59]
 v_cvt_pk_f16_f32 v62, v62, v63
 buffer_load_dwordx4 v38, s[12:15], s21 offen offset:1024 lds
 v_accvgpr_write_b32 a235, v62
 s_waitcnt lgkmcnt(9)
 v_mfma_f32_16x16x32_bf16 v[40:43], v[136:139], v[80:83], v[40:43]
 ds_read_b128 v[148:151], v23 offset:1536
 buffer_load_dwordx4 v39, s[12:15], s21 offen offset:2048 lds
 v_mfma_f32_16x16x32_bf16 v[48:51], v[136:139], v[104:107], v[48:51]
 v_mfma_f32_16x16x32_bf16 v[56:59], v[136:139], v[128:131], v[56:59]
 s_waitcnt lgkmcnt(7)
 v_mfma_f32_16x16x32_bf16 v[40:43], v[140:143], v[84:87], v[40:43]
 ds_read_b128 v[136:139], v22 offset:1664
 v_mfma_f32_16x16x32_bf16 v[48:51], v[140:143], v[108:111], v[48:51]
 s_waitcnt lgkmcnt(2)
 v_lshlrev_b32 v27, 16, v208
 v_and_b32 v208, 0xffff0000, v208
 v_cvt_pk_f16_f32 v208, v27, v208
 v_accvgpr_write_b32 a16, v208
 v_mfma_f32_16x16x32_bf16 v[56:59], v[140:143], v[132:135], v[56:59]
 v_lshlrev_b32 v27, 16, v209
 v_and_b32 v209, 0xffff0000, v209
 v_cvt_pk_f16_f32 v209, v27, v209
 v_accvgpr_write_b32 a17, v209
 s_waitcnt lgkmcnt(3)
 v_mfma_f32_16x16x32_bf16 v[44:47], v[144:147], v[64:67], 0
 ds_read_b128 v[140:143], v23 offset:1664
 v_lshlrev_b32 v27, 16, v210
 v_and_b32 v210, 0xffff0000, v210
 v_cvt_pk_f16_f32 v210, v27, v210
 v_accvgpr_write_b32 a18, v210
 v_mfma_f32_16x16x32_bf16 v[52:55], v[144:147], v[88:91], 0
 v_lshlrev_b32 v27, 16, v211
 v_and_b32 v211, 0xffff0000, v211
 v_cvt_pk_f16_f32 v211, v27, v211
 v_accvgpr_write_b32 a19, v211
 v_lshlrev_b32 v27, 16, v212
 v_mfma_f32_16x16x32_bf16 v[60:63], v[144:147], v[112:115], 0
 v_and_b32 v212, 0xffff0000, v212
 v_cvt_pk_f16_f32 v212, v27, v212
 v_accvgpr_write_b32 a36, v212
 v_lshlrev_b32 v27, 16, v213
 s_waitcnt lgkmcnt(2)
 v_mfma_f32_16x16x32_bf16 v[44:47], v[148:151], v[68:71], v[44:47]
 ds_read_b128 v[144:147], v22 offset:1792
 v_cvt_pk_f16_f32 v40, v40, v41
 v_and_b32 v213, 0xffff0000, v213
 v_cvt_pk_f16_f32 v213, v27, v213
 v_accvgpr_write_b32 a37, v213
 v_mfma_f32_16x16x32_bf16 v[52:55], v[148:151], v[92:95], v[52:55]
 v_accvgpr_write_b32 a220, v40
 v_lshlrev_b32 v27, 16, v214
 v_and_b32 v214, 0xffff0000, v214
 v_cvt_pk_f16_f32 v214, v27, v214
 v_accvgpr_write_b32 a38, v214
 v_mfma_f32_16x16x32_bf16 v[60:63], v[148:151], v[116:119], v[60:63]
 v_cvt_pk_f16_f32 v42, v42, v43
 v_lshlrev_b32 v27, 16, v215
 v_and_b32 v215, 0xffff0000, v215
 v_cvt_pk_f16_f32 v215, v27, v215
 s_waitcnt lgkmcnt(2)
 v_mfma_f32_16x16x32_bf16 v[44:47], v[136:139], v[72:75], v[44:47]
 ds_read_b128 v[148:151], v23 offset:1792
 v_accvgpr_write_b32 a221, v42
 v_accvgpr_write_b32 a39, v215
 v_lshlrev_b32 v27, 16, v216
 v_and_b32 v216, 0xffff0000, v216
 v_mfma_f32_16x16x32_bf16 v[52:55], v[136:139], v[96:99], v[52:55]
 v_cvt_pk_f16_f32 v48, v48, v49
 v_cvt_pk_f16_f32 v216, v27, v216
 v_accvgpr_write_b32 a56, v216
 v_lshlrev_b32 v27, 16, v217
 v_and_b32 v217, 0xffff0000, v217
 v_mfma_f32_16x16x32_bf16 v[60:63], v[136:139], v[120:123], v[60:63]
 v_accvgpr_write_b32 a228, v48
 v_cvt_pk_f16_f32 v217, v27, v217
 v_accvgpr_write_b32 a57, v217
 v_lshlrev_b32 v27, 16, v218
 s_waitcnt lgkmcnt(2)
 v_mfma_f32_16x16x32_bf16 v[44:47], v[140:143], v[76:79], v[44:47]
 s_waitcnt vmcnt(12)
 ds_read_b128 v[136:139], v22 offset:12288
 v_cvt_pk_f16_f32 v50, v50, v51
 v_and_b32 v218, 0xffff0000, v218
 v_cvt_pk_f16_f32 v218, v27, v218
 v_accvgpr_write_b32 a58, v218
 v_mfma_f32_16x16x32_bf16 v[52:55], v[140:143], v[100:103], v[52:55]
 v_accvgpr_write_b32 a229, v50
 v_lshlrev_b32 v27, 16, v219
 v_and_b32 v219, 0xffff0000, v219
 v_cvt_pk_f16_f32 v219, v27, v219
 v_accvgpr_write_b32 a59, v219
 v_mfma_f32_16x16x32_bf16 v[60:63], v[140:143], v[124:127], v[60:63]
 v_cvt_pk_f16_f32 v56, v56, v57
 v_accvgpr_write_b32 a236, v56
 v_cvt_pk_f16_f32 v58, v58, v59
 v_accvgpr_write_b32 a237, v58
 s_waitcnt lgkmcnt(2)
 v_mfma_f32_16x16x32_bf16 v[44:47], v[144:147], v[80:83], v[44:47]
 ds_read_b128 v[140:143], v23 offset:12288
 v_mfma_f32_16x16x32_bf16 v[52:55], v[144:147], v[104:107], v[52:55]
 v_mfma_f32_16x16x32_bf16 v[60:63], v[144:147], v[128:131], v[60:63]
 s_waitcnt lgkmcnt(2)
 v_mfma_f32_16x16x32_bf16 v[44:47], v[148:151], v[84:87], v[44:47]
 ds_read_b128 v[144:147], v22 offset:12416
 s_add_u32 m0, s81, 0
 s_add_u32 s21, s88, 5898240
 v_mfma_f32_16x16x32_bf16 v[52:55], v[148:151], v[108:111], v[52:55]
 buffer_load_dwordx4 v28, s[12:15], s21 offen offset:0 lds
 v_mfma_f32_16x16x32_bf16 v[60:63], v[148:151], v[132:135], v[60:63]
 buffer_load_dwordx4 v29, s[12:15], s21 offen offset:1024 lds
 s_waitcnt lgkmcnt(2)
 v_mfma_f32_16x16x32_bf16 v[40:43], v[136:139], v[64:67], 0
 ds_read_b128 v[148:151], v23 offset:12416
 buffer_load_dwordx4 v30, s[12:15], s21 offen offset:2048 lds
 v_mfma_f32_16x16x32_bf16 v[48:51], v[136:139], v[88:91], 0
 s_add_u32 m0, s81, 3072
 s_add_u32 s21, s88, 5947392
 v_mfma_f32_16x16x32_bf16 v[56:59], v[136:139], v[112:115], 0
 buffer_load_dwordx4 v31, s[12:15], s21 offen offset:0 lds
 s_waitcnt lgkmcnt(2)
 v_mfma_f32_16x16x32_bf16 v[40:43], v[140:143], v[68:71], v[40:43]
 ds_read_b128 v[136:139], v22 offset:12544
 v_cvt_pk_f16_f32 v44, v44, v45
 buffer_load_dwordx4 v32, s[12:15], s21 offen offset:1024 lds
 v_accvgpr_write_b32 a222, v44
 v_mfma_f32_16x16x32_bf16 v[48:51], v[140:143], v[92:95], v[48:51]
 v_cvt_pk_f16_f32 v46, v46, v47
 buffer_load_dwordx4 v33, s[12:15], s21 offen offset:2048 lds
 v_accvgpr_write_b32 a223, v46
 v_cvt_pk_f16_f32 v52, v52, v53
 v_mfma_f32_16x16x32_bf16 v[56:59], v[140:143], v[116:119], v[56:59]
 v_accvgpr_write_b32 a230, v52
 s_add_u32 m0, s81, 6144
 s_add_u32 s21, s88, 6389760
 v_cvt_pk_f16_f32 v54, v54, v55
 s_waitcnt lgkmcnt(2)
 v_mfma_f32_16x16x32_bf16 v[40:43], v[144:147], v[72:75], v[40:43]
 ds_read_b128 v[140:143], v23 offset:12544
 v_accvgpr_write_b32 a231, v54
 buffer_load_dwordx4 v34, s[12:15], s21 offen offset:0 lds
 v_cvt_pk_f16_f32 v60, v60, v61
 v_mfma_f32_16x16x32_bf16 v[48:51], v[144:147], v[96:99], v[48:51]
 v_accvgpr_write_b32 a238, v60
 buffer_load_dwordx4 v35, s[12:15], s21 offen offset:1024 lds
 v_cvt_pk_f16_f32 v62, v62, v63
 v_accvgpr_write_b32 a239, v62
 v_mfma_f32_16x16x32_bf16 v[56:59], v[144:147], v[120:123], v[56:59]
 buffer_load_dwordx4 v36, s[12:15], s21 offen offset:2048 lds
 s_waitcnt lgkmcnt(2)
 v_mfma_f32_16x16x32_bf16 v[40:43], v[148:151], v[76:79], v[40:43]
 ds_read_b128 v[144:147], v22 offset:13824
 s_add_u32 m0, s81, 9216
 s_add_u32 s21, s88, 6438912
 v_mfma_f32_16x16x32_bf16 v[48:51], v[148:151], v[100:103], v[48:51]
 buffer_load_dwordx4 v37, s[12:15], s21 offen offset:0 lds
 v_mfma_f32_16x16x32_bf16 v[56:59], v[148:151], v[124:127], v[56:59]
 buffer_load_dwordx4 v38, s[12:15], s21 offen offset:1024 lds
 s_waitcnt lgkmcnt(2)
 v_mfma_f32_16x16x32_bf16 v[40:43], v[136:139], v[80:83], v[40:43]
 ds_read_b128 v[148:151], v23 offset:13824
 buffer_load_dwordx4 v39, s[12:15], s21 offen offset:2048 lds
 v_mfma_f32_16x16x32_bf16 v[48:51], v[136:139], v[104:107], v[48:51]
 v_mfma_f32_16x16x32_bf16 v[56:59], v[136:139], v[128:131], v[56:59]
 s_waitcnt lgkmcnt(2)
 v_mfma_f32_16x16x32_bf16 v[40:43], v[140:143], v[84:87], v[40:43]
 ds_read_b128 v[136:139], v22 offset:13952
 v_mfma_f32_16x16x32_bf16 v[48:51], v[140:143], v[108:111], v[48:51]
 v_mfma_f32_16x16x32_bf16 v[56:59], v[140:143], v[132:135], v[56:59]
 s_waitcnt lgkmcnt(2)
 v_mfma_f32_16x16x32_bf16 v[44:47], v[144:147], v[64:67], 0
 ds_read_b128 v[140:143], v23 offset:13952
 v_mfma_f32_16x16x32_bf16 v[52:55], v[144:147], v[88:91], 0
 v_mfma_f32_16x16x32_bf16 v[60:63], v[144:147], v[112:115], 0
 s_waitcnt lgkmcnt(2)
 v_mfma_f32_16x16x32_bf16 v[44:47], v[148:151], v[68:71], v[44:47]
 ds_read_b128 v[144:147], v22 offset:14080
 v_cvt_pk_f16_f32 v40, v40, v41
 v_accvgpr_write_b32 a240, v40
 v_cvt_pk_f16_f32 v42, v42, v43
 v_accvgpr_write_b32 a241, v42
 v_mfma_f32_16x16x32_bf16 v[52:55], v[148:151], v[92:95], v[52:55]
 v_cvt_pk_f16_f32 v48, v48, v49
 v_accvgpr_write_b32 a248, v48
 v_cvt_pk_f16_f32 v50, v50, v51
 v_accvgpr_write_b32 a249, v50
 v_cvt_pk_f16_f32 v152, v56, v57
 v_mfma_f32_16x16x32_bf16 v[60:63], v[148:151], v[116:119], v[60:63]
 v_cvt_pk_f16_f32 v153, v58, v59
 s_waitcnt lgkmcnt(2)
 v_mfma_f32_16x16x32_bf16 v[44:47], v[136:139], v[72:75], v[44:47]
 ds_read_b128 v[148:151], v23 offset:14080
 v_mfma_f32_16x16x32_bf16 v[52:55], v[136:139], v[96:99], v[52:55]
 v_mfma_f32_16x16x32_bf16 v[60:63], v[136:139], v[120:123], v[60:63]
 s_waitcnt lgkmcnt(2)
 v_mfma_f32_16x16x32_bf16 v[44:47], v[140:143], v[76:79], v[44:47]
 s_waitcnt vmcnt(12)
 ds_read_b128 v[136:139], v22 offset:24576
 v_mfma_f32_16x16x32_bf16 v[52:55], v[140:143], v[100:103], v[52:55]
 v_mfma_f32_16x16x32_bf16 v[60:63], v[140:143], v[124:127], v[60:63]
 s_waitcnt lgkmcnt(2)
 v_mfma_f32_16x16x32_bf16 v[44:47], v[144:147], v[80:83], v[44:47]
 ds_read_b128 v[140:143], v23 offset:24576
 v_mfma_f32_16x16x32_bf16 v[52:55], v[144:147], v[104:107], v[52:55]
 v_mfma_f32_16x16x32_bf16 v[60:63], v[144:147], v[128:131], v[60:63]
 s_waitcnt lgkmcnt(2)
 v_mfma_f32_16x16x32_bf16 v[44:47], v[148:151], v[84:87], v[44:47]
 ds_read_b128 v[144:147], v22 offset:24704
 s_add_u32 m0, s81, 12288
 s_add_u32 s21, s88, 6881280
 v_mfma_f32_16x16x32_bf16 v[52:55], v[148:151], v[108:111], v[52:55]
 buffer_load_dwordx4 v28, s[12:15], s21 offen offset:0 lds
 v_mfma_f32_16x16x32_bf16 v[60:63], v[148:151], v[132:135], v[60:63]
 buffer_load_dwordx4 v29, s[12:15], s21 offen offset:1024 lds
 s_waitcnt lgkmcnt(2)
 v_mfma_f32_16x16x32_bf16 v[40:43], v[136:139], v[64:67], 0
 ds_read_b128 v[148:151], v23 offset:24704
 buffer_load_dwordx4 v30, s[12:15], s21 offen offset:2048 lds
 v_mfma_f32_16x16x32_bf16 v[48:51], v[136:139], v[88:91], 0
 s_add_u32 m0, s81, 15360
 s_add_u32 s21, s88, 6930432
 v_mfma_f32_16x16x32_bf16 v[56:59], v[136:139], v[112:115], 0
 buffer_load_dwordx4 v31, s[12:15], s21 offen offset:0 lds
 s_waitcnt lgkmcnt(2)
 v_mfma_f32_16x16x32_bf16 v[40:43], v[140:143], v[68:71], v[40:43]
 ds_read_b128 v[136:139], v22 offset:24832
 v_cvt_pk_f16_f32 v44, v44, v45
 buffer_load_dwordx4 v32, s[12:15], s21 offen offset:1024 lds
 v_accvgpr_write_b32 a242, v44
 v_mfma_f32_16x16x32_bf16 v[48:51], v[140:143], v[92:95], v[48:51]
 v_cvt_pk_f16_f32 v46, v46, v47
 buffer_load_dwordx4 v33, s[12:15], s21 offen offset:2048 lds
 v_accvgpr_write_b32 a243, v46
 v_cvt_pk_f16_f32 v52, v52, v53
 v_mfma_f32_16x16x32_bf16 v[56:59], v[140:143], v[116:119], v[56:59]
 v_accvgpr_write_b32 a250, v52
 s_add_u32 m0, s81, 18432
 s_add_u32 s21, s88, 7372800
 v_cvt_pk_f16_f32 v54, v54, v55
 s_waitcnt lgkmcnt(2)
 v_mfma_f32_16x16x32_bf16 v[40:43], v[144:147], v[72:75], v[40:43]
 ds_read_b128 v[140:143], v23 offset:24832
 v_accvgpr_write_b32 a251, v54
 buffer_load_dwordx4 v34, s[12:15], s21 offen offset:0 lds
 v_cvt_pk_f16_f32 v154, v60, v61
 v_mfma_f32_16x16x32_bf16 v[48:51], v[144:147], v[96:99], v[48:51]
 v_cvt_pk_f16_f32 v155, v62, v63
 buffer_load_dwordx4 v35, s[12:15], s21 offen offset:1024 lds
 v_mfma_f32_16x16x32_bf16 v[56:59], v[144:147], v[120:123], v[56:59]
 buffer_load_dwordx4 v36, s[12:15], s21 offen offset:2048 lds
 s_waitcnt lgkmcnt(2)
 v_mfma_f32_16x16x32_bf16 v[40:43], v[148:151], v[76:79], v[40:43]
 ds_read_b128 v[144:147], v22 offset:26112
 s_add_u32 m0, s81, 21504
 s_add_u32 s21, s88, 7421952
 v_mfma_f32_16x16x32_bf16 v[48:51], v[148:151], v[100:103], v[48:51]
 buffer_load_dwordx4 v37, s[12:15], s21 offen offset:0 lds
 v_mfma_f32_16x16x32_bf16 v[56:59], v[148:151], v[124:127], v[56:59]
 buffer_load_dwordx4 v38, s[12:15], s21 offen offset:1024 lds
 s_waitcnt lgkmcnt(2)
 v_mfma_f32_16x16x32_bf16 v[40:43], v[136:139], v[80:83], v[40:43]
 ds_read_b128 v[148:151], v23 offset:26112
 buffer_load_dwordx4 v39, s[12:15], s21 offen offset:2048 lds
 v_mfma_f32_16x16x32_bf16 v[48:51], v[136:139], v[104:107], v[48:51]
 v_mfma_f32_16x16x32_bf16 v[56:59], v[136:139], v[128:131], v[56:59]
 s_waitcnt lgkmcnt(2)
 v_mfma_f32_16x16x32_bf16 v[40:43], v[140:143], v[84:87], v[40:43]
 ds_read_b128 v[136:139], v22 offset:26240
 v_mfma_f32_16x16x32_bf16 v[48:51], v[140:143], v[108:111], v[48:51]
 v_mfma_f32_16x16x32_bf16 v[56:59], v[140:143], v[132:135], v[56:59]
 s_waitcnt lgkmcnt(2)
 v_mfma_f32_16x16x32_bf16 v[44:47], v[144:147], v[64:67], 0
 ds_read_b128 v[140:143], v23 offset:26240
 v_mfma_f32_16x16x32_bf16 v[52:55], v[144:147], v[88:91], 0
 v_mfma_f32_16x16x32_bf16 v[60:63], v[144:147], v[112:115], 0
 s_waitcnt lgkmcnt(2)
 v_mfma_f32_16x16x32_bf16 v[44:47], v[148:151], v[68:71], v[44:47]
 ds_read_b128 v[144:147], v22 offset:26368
 v_cvt_pk_f16_f32 v40, v40, v41
 v_accvgpr_write_b32 a244, v40
 v_cvt_pk_f16_f32 v42, v42, v43
 v_accvgpr_write_b32 a245, v42
 v_mfma_f32_16x16x32_bf16 v[52:55], v[148:151], v[92:95], v[52:55]
 v_cvt_pk_f16_f32 v48, v48, v49
 v_accvgpr_write_b32 a252, v48
 v_cvt_pk_f16_f32 v50, v50, v51
 v_accvgpr_write_b32 a253, v50
 v_cvt_pk_f16_f32 v156, v56, v57
 v_mfma_f32_16x16x32_bf16 v[60:63], v[148:151], v[116:119], v[60:63]
 v_cvt_pk_f16_f32 v157, v58, v59
 s_waitcnt lgkmcnt(2)
 v_mfma_f32_16x16x32_bf16 v[44:47], v[136:139], v[72:75], v[44:47]
 ds_read_b128 v[148:151], v23 offset:26368
 v_mfma_f32_16x16x32_bf16 v[52:55], v[136:139], v[96:99], v[52:55]
 v_mfma_f32_16x16x32_bf16 v[60:63], v[136:139], v[120:123], v[60:63]
 s_waitcnt lgkmcnt(2)
 v_mfma_f32_16x16x32_bf16 v[44:47], v[140:143], v[76:79], v[44:47]
 s_waitcnt vmcnt(12)
 ds_read_b128 v[136:139], v22 offset:0
 v_mfma_f32_16x16x32_bf16 v[52:55], v[140:143], v[100:103], v[52:55]
 v_mfma_f32_16x16x32_bf16 v[60:63], v[140:143], v[124:127], v[60:63]
 s_waitcnt lgkmcnt(2)
 v_mfma_f32_16x16x32_bf16 v[44:47], v[144:147], v[80:83], v[44:47]
 ds_read_b128 v[140:143], v23 offset:0
 v_mfma_f32_16x16x32_bf16 v[52:55], v[144:147], v[104:107], v[52:55]
 v_mfma_f32_16x16x32_bf16 v[60:63], v[144:147], v[128:131], v[60:63]
 s_waitcnt lgkmcnt(2)
 v_mfma_f32_16x16x32_bf16 v[44:47], v[148:151], v[84:87], v[44:47]
 ds_read_b128 v[144:147], v22 offset:128
 s_add_u32 m0, s81, 24576
 s_add_u32 s21, s88, 5996544
 v_mfma_f32_16x16x32_bf16 v[52:55], v[148:151], v[108:111], v[52:55]
 buffer_load_dwordx4 v28, s[12:15], s21 offen offset:0 lds
 v_mfma_f32_16x16x32_bf16 v[60:63], v[148:151], v[132:135], v[60:63]
 buffer_load_dwordx4 v29, s[12:15], s21 offen offset:1024 lds
 s_waitcnt lgkmcnt(2)
 v_mfma_f32_16x16x32_bf16 v[40:43], v[136:139], v[64:67], 0
 ds_read_b128 v[148:151], v23 offset:128
 buffer_load_dwordx4 v30, s[12:15], s21 offen offset:2048 lds
 v_mfma_f32_16x16x32_bf16 v[48:51], v[136:139], v[88:91], 0
 s_add_u32 m0, s81, 27648
 s_add_u32 s21, s88, 6045696
 v_mfma_f32_16x16x32_bf16 v[56:59], v[136:139], v[112:115], 0
 buffer_load_dwordx4 v31, s[12:15], s21 offen offset:0 lds
 s_waitcnt lgkmcnt(2)
 v_mfma_f32_16x16x32_bf16 v[40:43], v[140:143], v[68:71], v[40:43]
 ds_read_b128 v[136:139], v22 offset:256
 v_cvt_pk_f16_f32 v44, v44, v45
 buffer_load_dwordx4 v32, s[12:15], s21 offen offset:1024 lds
 v_accvgpr_write_b32 a246, v44
 v_mfma_f32_16x16x32_bf16 v[48:51], v[140:143], v[92:95], v[48:51]
 v_cvt_pk_f16_f32 v46, v46, v47
 buffer_load_dwordx4 v33, s[12:15], s21 offen offset:2048 lds
 v_accvgpr_write_b32 a247, v46
 v_cvt_pk_f16_f32 v52, v52, v53
 v_mfma_f32_16x16x32_bf16 v[56:59], v[140:143], v[116:119], v[56:59]
 v_accvgpr_write_b32 a254, v52
 s_add_u32 m0, s81, 30720
 s_add_u32 s21, s88, 6488064
 v_cvt_pk_f16_f32 v54, v54, v55
 s_waitcnt lgkmcnt(2)
 v_mfma_f32_16x16x32_bf16 v[40:43], v[144:147], v[72:75], v[40:43]
 ds_read_b128 v[140:143], v23 offset:256
 v_accvgpr_write_b32 a255, v54
 buffer_load_dwordx4 v34, s[12:15], s21 offen offset:0 lds
 v_cvt_pk_f16_f32 v158, v60, v61
 v_mfma_f32_16x16x32_bf16 v[48:51], v[144:147], v[96:99], v[48:51]
 v_cvt_pk_f16_f32 v159, v62, v63
 buffer_load_dwordx4 v35, s[12:15], s21 offen offset:1024 lds
 v_mfma_f32_16x16x32_bf16 v[56:59], v[144:147], v[120:123], v[56:59]
 buffer_load_dwordx4 v36, s[12:15], s21 offen offset:2048 lds
 s_waitcnt lgkmcnt(2)
 v_mfma_f32_16x16x32_bf16 v[40:43], v[148:151], v[76:79], v[40:43]
 ds_read_b128 v[144:147], v22 offset:1536
 s_add_u32 m0, s81, 33792
 s_add_u32 s21, s88, 6537216
 v_mfma_f32_16x16x32_bf16 v[48:51], v[148:151], v[100:103], v[48:51]
 buffer_load_dwordx4 v37, s[12:15], s21 offen offset:0 lds
 v_mfma_f32_16x16x32_bf16 v[56:59], v[148:151], v[124:127], v[56:59]
 buffer_load_dwordx4 v38, s[12:15], s21 offen offset:1024 lds
 s_waitcnt lgkmcnt(2)
 v_mfma_f32_16x16x32_bf16 v[40:43], v[136:139], v[80:83], v[40:43]
 ds_read_b128 v[148:151], v23 offset:1536
 buffer_load_dwordx4 v39, s[12:15], s21 offen offset:2048 lds
 v_mfma_f32_16x16x32_bf16 v[48:51], v[136:139], v[104:107], v[48:51]
 v_mfma_f32_16x16x32_bf16 v[56:59], v[136:139], v[128:131], v[56:59]
 s_waitcnt lgkmcnt(2)
 v_mfma_f32_16x16x32_bf16 v[40:43], v[140:143], v[84:87], v[40:43]
 ds_read_b128 v[136:139], v22 offset:1664
 v_mfma_f32_16x16x32_bf16 v[48:51], v[140:143], v[108:111], v[48:51]
 v_mfma_f32_16x16x32_bf16 v[56:59], v[140:143], v[132:135], v[56:59]
 s_waitcnt lgkmcnt(2)
 v_mfma_f32_16x16x32_bf16 v[44:47], v[144:147], v[64:67], 0
 ds_read_b128 v[140:143], v23 offset:1664
 v_mfma_f32_16x16x32_bf16 v[52:55], v[144:147], v[88:91], 0
 v_mfma_f32_16x16x32_bf16 v[60:63], v[144:147], v[112:115], 0
 s_waitcnt lgkmcnt(2)
 v_mfma_f32_16x16x32_bf16 v[44:47], v[148:151], v[68:71], v[44:47]
 ds_read_b128 v[144:147], v22 offset:1792
 v_cvt_pk_f16_f32 v160, v40, v41
 v_cvt_pk_f16_f32 v161, v42, v43
 v_cvt_pk_f16_f32 v168, v48, v49
 v_cvt_pk_f16_f32 v169, v50, v51
 v_mfma_f32_16x16x32_bf16 v[52:55], v[148:151], v[92:95], v[52:55]
 v_cvt_pk_f16_f32 v176, v56, v57
 v_cvt_pk_f16_f32 v177, v58, v59
 v_mfma_f32_16x16x32_bf16 v[60:63], v[148:151], v[116:119], v[60:63]
 s_waitcnt lgkmcnt(2)
 v_mfma_f32_16x16x32_bf16 v[44:47], v[136:139], v[72:75], v[44:47]
 ds_read_b128 v[148:151], v23 offset:1792
 v_mfma_f32_16x16x32_bf16 v[52:55], v[136:139], v[96:99], v[52:55]
 v_mfma_f32_16x16x32_bf16 v[60:63], v[136:139], v[120:123], v[60:63]
 s_waitcnt lgkmcnt(2)
 v_mfma_f32_16x16x32_bf16 v[44:47], v[140:143], v[76:79], v[44:47]
 s_waitcnt vmcnt(12)
 ds_read_b128 v[136:139], v22 offset:12288
 v_mfma_f32_16x16x32_bf16 v[52:55], v[140:143], v[100:103], v[52:55]
 v_mfma_f32_16x16x32_bf16 v[60:63], v[140:143], v[124:127], v[60:63]
 s_waitcnt lgkmcnt(2)
 v_mfma_f32_16x16x32_bf16 v[44:47], v[144:147], v[80:83], v[44:47]
 ds_read_b128 v[140:143], v23 offset:12288
 v_mfma_f32_16x16x32_bf16 v[52:55], v[144:147], v[104:107], v[52:55]
 v_mfma_f32_16x16x32_bf16 v[60:63], v[144:147], v[128:131], v[60:63]
 s_waitcnt lgkmcnt(2)
 v_mfma_f32_16x16x32_bf16 v[44:47], v[148:151], v[84:87], v[44:47]
 ds_read_b128 v[144:147], v22 offset:12416
 s_add_u32 m0, s81, 0
 s_add_u32 s21, s88, 6979584
 v_mfma_f32_16x16x32_bf16 v[52:55], v[148:151], v[108:111], v[52:55]
 buffer_load_dwordx4 v28, s[12:15], s21 offen offset:0 lds
 v_mfma_f32_16x16x32_bf16 v[60:63], v[148:151], v[132:135], v[60:63]
 buffer_load_dwordx4 v29, s[12:15], s21 offen offset:1024 lds
 s_waitcnt lgkmcnt(2)
 v_mfma_f32_16x16x32_bf16 v[40:43], v[136:139], v[64:67], 0
 ds_read_b128 v[148:151], v23 offset:12416
 buffer_load_dwordx4 v30, s[12:15], s21 offen offset:2048 lds
 v_mfma_f32_16x16x32_bf16 v[48:51], v[136:139], v[88:91], 0
 s_add_u32 m0, s81, 3072
 s_add_u32 s21, s88, 7028736
 v_mfma_f32_16x16x32_bf16 v[56:59], v[136:139], v[112:115], 0
 buffer_load_dwordx4 v31, s[12:15], s21 offen offset:0 lds
 s_waitcnt lgkmcnt(2)
 v_mfma_f32_16x16x32_bf16 v[40:43], v[140:143], v[68:71], v[40:43]
 ds_read_b128 v[136:139], v22 offset:12544
 v_cvt_pk_f16_f32 v162, v44, v45
 buffer_load_dwordx4 v32, s[12:15], s21 offen offset:1024 lds
 v_cvt_pk_f16_f32 v163, v46, v47
 v_mfma_f32_16x16x32_bf16 v[48:51], v[140:143], v[92:95], v[48:51]
 v_cvt_pk_f16_f32 v170, v52, v53
 buffer_load_dwordx4 v33, s[12:15], s21 offen offset:2048 lds
 v_cvt_pk_f16_f32 v171, v54, v55
 v_cvt_pk_f16_f32 v178, v60, v61
 v_mfma_f32_16x16x32_bf16 v[56:59], v[140:143], v[116:119], v[56:59]
 v_cvt_pk_f16_f32 v179, v62, v63
 s_add_u32 m0, s81, 6144
 s_add_u32 s21, s88, 7471104
 s_waitcnt lgkmcnt(2)
 v_mfma_f32_16x16x32_bf16 v[40:43], v[144:147], v[72:75], v[40:43]
 ds_read_b128 v[140:143], v23 offset:12544
 buffer_load_dwordx4 v34, s[12:15], s21 offen offset:0 lds
 v_mfma_f32_16x16x32_bf16 v[48:51], v[144:147], v[96:99], v[48:51]
 buffer_load_dwordx4 v35, s[12:15], s21 offen offset:1024 lds
 v_mfma_f32_16x16x32_bf16 v[56:59], v[144:147], v[120:123], v[56:59]
 buffer_load_dwordx4 v36, s[12:15], s21 offen offset:2048 lds
 s_waitcnt lgkmcnt(2)
 v_mfma_f32_16x16x32_bf16 v[40:43], v[148:151], v[76:79], v[40:43]
 ds_read_b128 v[144:147], v22 offset:13824
 s_add_u32 m0, s81, 9216
 s_add_u32 s21, s88, 7520256
 v_mfma_f32_16x16x32_bf16 v[48:51], v[148:151], v[100:103], v[48:51]
 buffer_load_dwordx4 v37, s[12:15], s21 offen offset:0 lds
 v_mfma_f32_16x16x32_bf16 v[56:59], v[148:151], v[124:127], v[56:59]
 buffer_load_dwordx4 v38, s[12:15], s21 offen offset:1024 lds
 s_waitcnt lgkmcnt(2)
 v_mfma_f32_16x16x32_bf16 v[40:43], v[136:139], v[80:83], v[40:43]
 ds_read_b128 v[148:151], v23 offset:13824
 buffer_load_dwordx4 v39, s[12:15], s21 offen offset:2048 lds
 v_mfma_f32_16x16x32_bf16 v[48:51], v[136:139], v[104:107], v[48:51]
 buffer_load_dword v0, v26, s[32:35], 0 offen sc1
 v_mfma_f32_16x16x32_bf16 v[56:59], v[136:139], v[128:131], v[56:59]
 v_and_b32 v253, 31, v1
 buffer_load_ubyte v252, v253, s[32:35], 0 offen offset:160 sc1
 s_waitcnt lgkmcnt(2)
 v_mfma_f32_16x16x32_bf16 v[40:43], v[140:143], v[84:87], v[40:43]
 ds_read_b128 v[136:139], v22 offset:13952
 v_mfma_f32_16x16x32_bf16 v[48:51], v[140:143], v[108:111], v[48:51]
 v_mfma_f32_16x16x32_bf16 v[56:59], v[140:143], v[132:135], v[56:59]
 s_waitcnt lgkmcnt(2)
 v_mfma_f32_16x16x32_bf16 v[44:47], v[144:147], v[64:67], 0
 ds_read_b128 v[140:143], v23 offset:13952
 v_mfma_f32_16x16x32_bf16 v[52:55], v[144:147], v[88:91], 0
 v_mfma_f32_16x16x32_bf16 v[60:63], v[144:147], v[112:115], 0
 s_waitcnt lgkmcnt(2)
 v_mfma_f32_16x16x32_bf16 v[44:47], v[148:151], v[68:71], v[44:47]
 ds_read_b128 v[144:147], v22 offset:14080
 v_cvt_pk_f16_f32 v164, v40, v41
 v_cvt_pk_f16_f32 v165, v42, v43
 v_cvt_pk_f16_f32 v172, v48, v49
 v_cvt_pk_f16_f32 v173, v50, v51
 v_mfma_f32_16x16x32_bf16 v[52:55], v[148:151], v[92:95], v[52:55]
 v_cvt_pk_f16_f32 v180, v56, v57
 v_cvt_pk_f16_f32 v181, v58, v59
 v_mfma_f32_16x16x32_bf16 v[60:63], v[148:151], v[116:119], v[60:63]
 s_waitcnt lgkmcnt(2)
 v_mfma_f32_16x16x32_bf16 v[44:47], v[136:139], v[72:75], v[44:47]
 ds_read_b128 v[148:151], v23 offset:14080
 v_mfma_f32_16x16x32_bf16 v[52:55], v[136:139], v[96:99], v[52:55]
 v_mfma_f32_16x16x32_bf16 v[60:63], v[136:139], v[120:123], v[60:63]
 s_waitcnt lgkmcnt(2)
 v_mfma_f32_16x16x32_bf16 v[44:47], v[140:143], v[76:79], v[44:47]
 s_waitcnt vmcnt(14)
 ds_read_b128 v[136:139], v22 offset:24576
 v_mfma_f32_16x16x32_bf16 v[52:55], v[140:143], v[100:103], v[52:55]
 v_mfma_f32_16x16x32_bf16 v[60:63], v[140:143], v[124:127], v[60:63]
 s_waitcnt lgkmcnt(2)
 v_mfma_f32_16x16x32_bf16 v[44:47], v[144:147], v[80:83], v[44:47]
 ds_read_b128 v[140:143], v23 offset:24576
 v_mfma_f32_16x16x32_bf16 v[52:55], v[144:147], v[104:107], v[52:55]
 v_mfma_f32_16x16x32_bf16 v[60:63], v[144:147], v[128:131], v[60:63]
 s_waitcnt lgkmcnt(2)
 v_mfma_f32_16x16x32_bf16 v[44:47], v[148:151], v[84:87], v[44:47]
 ds_read_b128 v[144:147], v22 offset:24704
 s_add_u32 m0, s81, 12288
 s_add_u32 s21, s88, 196608
 v_mfma_f32_16x16x32_bf16 v[52:55], v[148:151], v[108:111], v[52:55]
 buffer_load_dwordx4 v28, s[12:15], s21 offen offset:0 lds
 v_mfma_f32_16x16x32_bf16 v[60:63], v[148:151], v[132:135], v[60:63]
 buffer_load_dwordx4 v29, s[12:15], s21 offen offset:1024 lds
 s_waitcnt lgkmcnt(2)
 v_mfma_f32_16x16x32_bf16 v[40:43], v[136:139], v[64:67], 0
 ds_read_b128 v[148:151], v23 offset:24704
 buffer_load_dwordx4 v30, s[12:15], s21 offen offset:2048 lds
 v_mfma_f32_16x16x32_bf16 v[48:51], v[136:139], v[88:91], 0
 s_add_u32 m0, s81, 15360
 s_add_u32 s21, s88, 2162688
 v_mfma_f32_16x16x32_bf16 v[56:59], v[136:139], v[112:115], 0
 buffer_load_dwordx4 v31, s[12:15], s21 offen offset:0 lds
 s_waitcnt lgkmcnt(2)
 v_mfma_f32_16x16x32_bf16 v[40:43], v[140:143], v[68:71], v[40:43]
 ds_read_b128 v[136:139], v22 offset:24832
 v_cvt_pk_f16_f32 v166, v44, v45
 buffer_load_dwordx4 v32, s[12:15], s21 offen offset:1024 lds
 v_cvt_pk_f16_f32 v167, v46, v47
 v_mfma_f32_16x16x32_bf16 v[48:51], v[140:143], v[92:95], v[48:51]
 v_cvt_pk_f16_f32 v174, v52, v53
 buffer_load_dwordx4 v33, s[12:15], s21 offen offset:2048 lds
 v_cvt_pk_f16_f32 v175, v54, v55
 v_cvt_pk_f16_f32 v182, v60, v61
 v_mfma_f32_16x16x32_bf16 v[56:59], v[140:143], v[116:119], v[56:59]
 v_cvt_pk_f16_f32 v183, v62, v63
 s_add_u32 m0, s81, 18432
 s_add_u32 s21, s88, 688128
 s_waitcnt lgkmcnt(2)
 v_mfma_f32_16x16x32_bf16 v[40:43], v[144:147], v[72:75], v[40:43]
 ds_read_b128 v[140:143], v23 offset:24832
 buffer_load_dwordx4 v34, s[12:15], s21 offen offset:0 lds
 v_mfma_f32_16x16x32_bf16 v[48:51], v[144:147], v[96:99], v[48:51]
 buffer_load_dwordx4 v35, s[12:15], s21 offen offset:1024 lds
 v_mfma_f32_16x16x32_bf16 v[56:59], v[144:147], v[120:123], v[56:59]
 buffer_load_dwordx4 v36, s[12:15], s21 offen offset:2048 lds
 s_waitcnt lgkmcnt(2)
 v_mfma_f32_16x16x32_bf16 v[40:43], v[148:151], v[76:79], v[40:43]
 ds_read_b128 v[144:147], v22 offset:26112
 s_add_u32 m0, s81, 21504
 s_add_u32 s21, s88, 2654208
 v_mfma_f32_16x16x32_bf16 v[48:51], v[148:151], v[100:103], v[48:51]
 buffer_load_dwordx4 v37, s[12:15], s21 offen offset:0 lds
 v_mfma_f32_16x16x32_bf16 v[56:59], v[148:151], v[124:127], v[56:59]
 buffer_load_dwordx4 v38, s[12:15], s21 offen offset:1024 lds
 s_waitcnt lgkmcnt(2)
 v_mfma_f32_16x16x32_bf16 v[40:43], v[136:139], v[80:83], v[40:43]
 ds_read_b128 v[148:151], v23 offset:26112
 buffer_load_dwordx4 v39, s[12:15], s21 offen offset:2048 lds
 v_mfma_f32_16x16x32_bf16 v[48:51], v[136:139], v[104:107], v[48:51]
 v_mfma_f32_16x16x32_bf16 v[56:59], v[136:139], v[128:131], v[56:59]
 s_waitcnt lgkmcnt(2)
 v_mfma_f32_16x16x32_bf16 v[40:43], v[140:143], v[84:87], v[40:43]
 ds_read_b128 v[136:139], v22 offset:26240
 v_mfma_f32_16x16x32_bf16 v[48:51], v[140:143], v[108:111], v[48:51]
 v_mfma_f32_16x16x32_bf16 v[56:59], v[140:143], v[132:135], v[56:59]
 s_waitcnt lgkmcnt(2)
 v_mfma_f32_16x16x32_bf16 v[44:47], v[144:147], v[64:67], 0
 ds_read_b128 v[140:143], v23 offset:26240
 v_mfma_f32_16x16x32_bf16 v[52:55], v[144:147], v[88:91], 0
 v_mfma_f32_16x16x32_bf16 v[60:63], v[144:147], v[112:115], 0
 s_waitcnt lgkmcnt(2)
 v_mfma_f32_16x16x32_bf16 v[44:47], v[148:151], v[68:71], v[44:47]
 ds_read_b128 v[144:147], v22 offset:26368
 v_cvt_pk_f16_f32 v184, v40, v41
 v_cvt_pk_f16_f32 v185, v42, v43
 v_cvt_pk_f16_f32 v192, v48, v49
 v_cvt_pk_f16_f32 v193, v50, v51
 v_mfma_f32_16x16x32_bf16 v[52:55], v[148:151], v[92:95], v[52:55]
 v_cvt_pk_f16_f32 v200, v56, v57
 v_cvt_pk_f16_f32 v201, v58, v59
 v_mfma_f32_16x16x32_bf16 v[60:63], v[148:151], v[116:119], v[60:63]
 s_waitcnt lgkmcnt(2)
 v_mfma_f32_16x16x32_bf16 v[44:47], v[136:139], v[72:75], v[44:47]
 ds_read_b128 v[148:151], v23 offset:26368
 v_mfma_f32_16x16x32_bf16 v[52:55], v[136:139], v[96:99], v[52:55]
 v_mfma_f32_16x16x32_bf16 v[60:63], v[136:139], v[120:123], v[60:63]
 s_waitcnt lgkmcnt(2)
 v_mfma_f32_16x16x32_bf16 v[44:47], v[140:143], v[76:79], v[44:47]
 s_waitcnt vmcnt(14)
 ds_read_b128 v[136:139], v22 offset:0
 v_mfma_f32_16x16x32_bf16 v[52:55], v[140:143], v[100:103], v[52:55]
 v_mfma_f32_16x16x32_bf16 v[60:63], v[140:143], v[124:127], v[60:63]
 s_waitcnt lgkmcnt(2)
 v_mfma_f32_16x16x32_bf16 v[44:47], v[144:147], v[80:83], v[44:47]
 ds_read_b128 v[140:143], v23 offset:0
 v_mfma_f32_16x16x32_bf16 v[52:55], v[144:147], v[104:107], v[52:55]
 v_mfma_f32_16x16x32_bf16 v[60:63], v[144:147], v[128:131], v[60:63]
 s_waitcnt lgkmcnt(2)
 v_mfma_f32_16x16x32_bf16 v[44:47], v[148:151], v[84:87], v[44:47]
 ds_read_b128 v[144:147], v22 offset:128
 s_add_u32 m0, s81, 24576
 s_add_u32 s21, s88, 1179648
 v_mfma_f32_16x16x32_bf16 v[52:55], v[148:151], v[108:111], v[52:55]
 buffer_load_dwordx4 v28, s[12:15], s21 offen offset:0 lds
 v_mfma_f32_16x16x32_bf16 v[60:63], v[148:151], v[132:135], v[60:63]
 buffer_load_dwordx4 v29, s[12:15], s21 offen offset:1024 lds
 s_waitcnt lgkmcnt(2)
 v_mfma_f32_16x16x32_bf16 v[40:43], v[136:139], v[64:67], 0
 ds_read_b128 v[148:151], v23 offset:128
 buffer_load_dwordx4 v30, s[12:15], s21 offen offset:2048 lds
 v_mfma_f32_16x16x32_bf16 v[48:51], v[136:139], v[88:91], 0
 s_add_u32 m0, s81, 27648
 s_add_u32 s21, s88, 3145728
 v_mfma_f32_16x16x32_bf16 v[56:59], v[136:139], v[112:115], 0
 buffer_load_dwordx4 v31, s[12:15], s21 offen offset:0 lds
 s_waitcnt lgkmcnt(2)
 v_mfma_f32_16x16x32_bf16 v[40:43], v[140:143], v[68:71], v[40:43]
 ds_read_b128 v[136:139], v22 offset:256
 v_cvt_pk_f16_f32 v186, v44, v45
 buffer_load_dwordx4 v32, s[12:15], s21 offen offset:1024 lds
 v_cvt_pk_f16_f32 v187, v46, v47
 v_mfma_f32_16x16x32_bf16 v[48:51], v[140:143], v[92:95], v[48:51]
 v_cvt_pk_f16_f32 v194, v52, v53
 buffer_load_dwordx4 v33, s[12:15], s21 offen offset:2048 lds
 v_cvt_pk_f16_f32 v195, v54, v55
 v_cvt_pk_f16_f32 v202, v60, v61
 v_mfma_f32_16x16x32_bf16 v[56:59], v[140:143], v[116:119], v[56:59]
 v_cvt_pk_f16_f32 v203, v62, v63
 s_add_u32 m0, s81, 30720
 s_add_u32 s21, s88, 1671168
 s_waitcnt lgkmcnt(2)
 v_mfma_f32_16x16x32_bf16 v[40:43], v[144:147], v[72:75], v[40:43]
 ds_read_b128 v[140:143], v23 offset:256
 buffer_load_dwordx4 v34, s[12:15], s21 offen offset:0 lds
 v_mfma_f32_16x16x32_bf16 v[48:51], v[144:147], v[96:99], v[48:51]
 buffer_load_dwordx4 v35, s[12:15], s21 offen offset:1024 lds
 v_mfma_f32_16x16x32_bf16 v[56:59], v[144:147], v[120:123], v[56:59]
 buffer_load_dwordx4 v36, s[12:15], s21 offen offset:2048 lds
 s_waitcnt lgkmcnt(2)
 v_mfma_f32_16x16x32_bf16 v[40:43], v[148:151], v[76:79], v[40:43]
 ds_read_b128 v[144:147], v22 offset:1536
 s_add_u32 m0, s81, 33792
 s_add_u32 s21, s88, 3637248
 v_mfma_f32_16x16x32_bf16 v[48:51], v[148:151], v[100:103], v[48:51]
 buffer_load_dwordx4 v37, s[12:15], s21 offen offset:0 lds
 v_mfma_f32_16x16x32_bf16 v[56:59], v[148:151], v[124:127], v[56:59]
 buffer_load_dwordx4 v38, s[12:15], s21 offen offset:1024 lds
 s_waitcnt lgkmcnt(2)
 v_mfma_f32_16x16x32_bf16 v[40:43], v[136:139], v[80:83], v[40:43]
 ds_read_b128 v[148:151], v23 offset:1536
 buffer_load_dwordx4 v39, s[12:15], s21 offen offset:2048 lds
 v_mfma_f32_16x16x32_bf16 v[48:51], v[136:139], v[104:107], v[48:51]
 v_mfma_f32_16x16x32_bf16 v[56:59], v[136:139], v[128:131], v[56:59]
 s_waitcnt lgkmcnt(2)
 v_mfma_f32_16x16x32_bf16 v[40:43], v[140:143], v[84:87], v[40:43]
 ds_read_b128 v[136:139], v22 offset:1664
 v_mfma_f32_16x16x32_bf16 v[48:51], v[140:143], v[108:111], v[48:51]
 v_mfma_f32_16x16x32_bf16 v[56:59], v[140:143], v[132:135], v[56:59]
 s_waitcnt lgkmcnt(2)
 v_mfma_f32_16x16x32_bf16 v[44:47], v[144:147], v[64:67], 0
 ds_read_b128 v[140:143], v23 offset:1664
 v_mfma_f32_16x16x32_bf16 v[52:55], v[144:147], v[88:91], 0
 v_mfma_f32_16x16x32_bf16 v[60:63], v[144:147], v[112:115], 0
 s_waitcnt lgkmcnt(2)
 v_mfma_f32_16x16x32_bf16 v[44:47], v[148:151], v[68:71], v[44:47]
 ds_read_b128 v[144:147], v22 offset:1792
 v_cvt_pk_f16_f32 v188, v40, v41
 v_cvt_pk_f16_f32 v189, v42, v43
 v_cvt_pk_f16_f32 v196, v48, v49
 v_cvt_pk_f16_f32 v197, v50, v51
 v_mfma_f32_16x16x32_bf16 v[52:55], v[148:151], v[92:95], v[52:55]
 v_cvt_pk_f16_f32 v204, v56, v57
 v_cvt_pk_f16_f32 v205, v58, v59
 v_mfma_f32_16x16x32_bf16 v[60:63], v[148:151], v[116:119], v[60:63]
 s_waitcnt lgkmcnt(2)
 v_mfma_f32_16x16x32_bf16 v[44:47], v[136:139], v[72:75], v[44:47]
 ds_read_b128 v[148:151], v23 offset:1792
 v_mfma_f32_16x16x32_bf16 v[52:55], v[136:139], v[96:99], v[52:55]
 v_mfma_f32_16x16x32_bf16 v[60:63], v[136:139], v[120:123], v[60:63]
 s_waitcnt lgkmcnt(2)
 v_mfma_f32_16x16x32_bf16 v[44:47], v[140:143], v[76:79], v[44:47]
 s_waitcnt vmcnt(12)
 ds_read_b128 v[136:139], v22 offset:12288
 v_mfma_f32_16x16x32_bf16 v[52:55], v[140:143], v[100:103], v[52:55]
 v_mfma_f32_16x16x32_bf16 v[60:63], v[140:143], v[124:127], v[60:63]
 s_waitcnt lgkmcnt(2)
 v_mfma_f32_16x16x32_bf16 v[44:47], v[144:147], v[80:83], v[44:47]
 ds_read_b128 v[140:143], v23 offset:12288
 v_mfma_f32_16x16x32_bf16 v[52:55], v[144:147], v[104:107], v[52:55]
 v_mfma_f32_16x16x32_bf16 v[60:63], v[144:147], v[128:131], v[60:63]
 s_waitcnt lgkmcnt(2)
 v_mfma_f32_16x16x32_bf16 v[44:47], v[148:151], v[84:87], v[44:47]
 ds_read_b128 v[144:147], v22 offset:12416
 s_add_u32 m0, s81, 0
 s_add_u32 s21, s88, 4128768
 v_mfma_f32_16x16x32_bf16 v[52:55], v[148:151], v[108:111], v[52:55]
 buffer_load_dwordx4 v28, s[12:15], s21 offen offset:0 lds
 v_mfma_f32_16x16x32_bf16 v[60:63], v[148:151], v[132:135], v[60:63]
 buffer_load_dwordx4 v29, s[12:15], s21 offen offset:1024 lds
 s_waitcnt lgkmcnt(2)
 v_mfma_f32_16x16x32_bf16 v[40:43], v[136:139], v[64:67], 0
 ds_read_b128 v[148:151], v23 offset:12416
 buffer_load_dwordx4 v30, s[12:15], s21 offen offset:2048 lds
 v_mfma_f32_16x16x32_bf16 v[48:51], v[136:139], v[88:91], 0
 s_add_u32 m0, s81, 3072
 s_add_u32 s21, s88, 6094848
 v_mfma_f32_16x16x32_bf16 v[56:59], v[136:139], v[112:115], 0
 buffer_load_dwordx4 v31, s[12:15], s21 offen offset:0 lds
 s_waitcnt lgkmcnt(2)
 v_mfma_f32_16x16x32_bf16 v[40:43], v[140:143], v[68:71], v[40:43]
 ds_read_b128 v[136:139], v22 offset:12544
 v_cvt_pk_f16_f32 v190, v44, v45
 buffer_load_dwordx4 v32, s[12:15], s21 offen offset:1024 lds
 v_cvt_pk_f16_f32 v191, v46, v47
 v_mfma_f32_16x16x32_bf16 v[48:51], v[140:143], v[92:95], v[48:51]
 v_cvt_pk_f16_f32 v198, v52, v53
 buffer_load_dwordx4 v33, s[12:15], s21 offen offset:2048 lds
 v_cvt_pk_f16_f32 v199, v54, v55
 v_cvt_pk_f16_f32 v206, v60, v61
 v_mfma_f32_16x16x32_bf16 v[56:59], v[140:143], v[116:119], v[56:59]
 v_cvt_pk_f16_f32 v207, v62, v63
 s_add_u32 m0, s81, 6144
 s_add_u32 s21, s88, 4620288
 s_waitcnt lgkmcnt(2)
 v_mfma_f32_16x16x32_bf16 v[40:43], v[144:147], v[72:75], v[40:43]
 ds_read_b128 v[140:143], v23 offset:12544
 buffer_load_dwordx4 v34, s[12:15], s21 offen offset:0 lds
 v_mfma_f32_16x16x32_bf16 v[48:51], v[144:147], v[96:99], v[48:51]
 buffer_load_dwordx4 v35, s[12:15], s21 offen offset:1024 lds
 v_mfma_f32_16x16x32_bf16 v[56:59], v[144:147], v[120:123], v[56:59]
 buffer_load_dwordx4 v36, s[12:15], s21 offen offset:2048 lds
 s_waitcnt lgkmcnt(2)
 v_mfma_f32_16x16x32_bf16 v[40:43], v[148:151], v[76:79], v[40:43]
 ds_read_b128 v[144:147], v22 offset:13824
 s_add_u32 m0, s81, 9216
 s_add_u32 s21, s88, 6586368
 v_mfma_f32_16x16x32_bf16 v[48:51], v[148:151], v[100:103], v[48:51]
 buffer_load_dwordx4 v37, s[12:15], s21 offen offset:0 lds
 v_mfma_f32_16x16x32_bf16 v[56:59], v[148:151], v[124:127], v[56:59]
 buffer_load_dwordx4 v38, s[12:15], s21 offen offset:1024 lds
 s_waitcnt lgkmcnt(2)
 v_mfma_f32_16x16x32_bf16 v[40:43], v[136:139], v[80:83], v[40:43]
 ds_read_b128 v[148:151], v23 offset:13824
 buffer_load_dwordx4 v39, s[12:15], s21 offen offset:2048 lds
 v_mfma_f32_16x16x32_bf16 v[48:51], v[136:139], v[104:107], v[48:51]
 v_mfma_f32_16x16x32_bf16 v[56:59], v[136:139], v[128:131], v[56:59]
 s_waitcnt lgkmcnt(2)
 v_mfma_f32_16x16x32_bf16 v[40:43], v[140:143], v[84:87], v[40:43]
 ds_read_b128 v[136:139], v22 offset:13952
 v_mfma_f32_16x16x32_bf16 v[48:51], v[140:143], v[108:111], v[48:51]
 v_mfma_f32_16x16x32_bf16 v[56:59], v[140:143], v[132:135], v[56:59]
 s_waitcnt lgkmcnt(2)
 v_mfma_f32_16x16x32_bf16 v[44:47], v[144:147], v[64:67], 0
 ds_read_b128 v[140:143], v23 offset:13952
 v_mfma_f32_16x16x32_bf16 v[52:55], v[144:147], v[88:91], 0
 v_mfma_f32_16x16x32_bf16 v[60:63], v[144:147], v[112:115], 0
 s_waitcnt lgkmcnt(2)
 v_mfma_f32_16x16x32_bf16 v[44:47], v[148:151], v[68:71], v[44:47]
 ds_read_b128 v[144:147], v22 offset:14080
 v_cvt_pk_f16_f32 v208, v40, v41
 v_cvt_pk_f16_f32 v209, v42, v43
 v_cvt_pk_f16_f32 v216, v48, v49
 v_cvt_pk_f16_f32 v217, v50, v51
 v_mfma_f32_16x16x32_bf16 v[52:55], v[148:151], v[92:95], v[52:55]
 v_cvt_pk_f16_f32 v224, v56, v57
 v_cvt_pk_f16_f32 v225, v58, v59
 v_mfma_f32_16x16x32_bf16 v[60:63], v[148:151], v[116:119], v[60:63]
 s_waitcnt lgkmcnt(2)
 v_mfma_f32_16x16x32_bf16 v[44:47], v[136:139], v[72:75], v[44:47]
 ds_read_b128 v[148:151], v23 offset:14080
 v_mfma_f32_16x16x32_bf16 v[52:55], v[136:139], v[96:99], v[52:55]
 v_mfma_f32_16x16x32_bf16 v[60:63], v[136:139], v[120:123], v[60:63]
 s_waitcnt lgkmcnt(2)
 v_mfma_f32_16x16x32_bf16 v[44:47], v[140:143], v[76:79], v[44:47]
 s_waitcnt vmcnt(12)
 ds_read_b128 v[136:139], v22 offset:24576
 v_mfma_f32_16x16x32_bf16 v[52:55], v[140:143], v[100:103], v[52:55]
 v_mfma_f32_16x16x32_bf16 v[60:63], v[140:143], v[124:127], v[60:63]
 s_waitcnt lgkmcnt(2)
 v_mfma_f32_16x16x32_bf16 v[44:47], v[144:147], v[80:83], v[44:47]
 ds_read_b128 v[140:143], v23 offset:24576
 v_mfma_f32_16x16x32_bf16 v[52:55], v[144:147], v[104:107], v[52:55]
 v_mfma_f32_16x16x32_bf16 v[60:63], v[144:147], v[128:131], v[60:63]
 s_waitcnt lgkmcnt(2)
 v_mfma_f32_16x16x32_bf16 v[44:47], v[148:151], v[84:87], v[44:47]
 ds_read_b128 v[144:147], v22 offset:24704
 s_add_u32 m0, s81, 12288
 s_add_u32 s21, s88, 5111808
 v_mfma_f32_16x16x32_bf16 v[52:55], v[148:151], v[108:111], v[52:55]
 buffer_load_dwordx4 v28, s[12:15], s21 offen offset:0 lds
 v_mfma_f32_16x16x32_bf16 v[60:63], v[148:151], v[132:135], v[60:63]
 buffer_load_dwordx4 v29, s[12:15], s21 offen offset:1024 lds
 s_waitcnt lgkmcnt(2)
 v_mfma_f32_16x16x32_bf16 v[40:43], v[136:139], v[64:67], 0
 ds_read_b128 v[148:151], v23 offset:24704
 buffer_load_dwordx4 v30, s[12:15], s21 offen offset:2048 lds
 v_mfma_f32_16x16x32_bf16 v[48:51], v[136:139], v[88:91], 0
 s_add_u32 m0, s81, 15360
 s_add_u32 s21, s88, 7077888
 v_mfma_f32_16x16x32_bf16 v[56:59], v[136:139], v[112:115], 0
 buffer_load_dwordx4 v31, s[12:15], s21 offen offset:0 lds
 s_waitcnt lgkmcnt(2)
 v_mfma_f32_16x16x32_bf16 v[40:43], v[140:143], v[68:71], v[40:43]
 ds_read_b128 v[136:139], v22 offset:24832
 v_cvt_pk_f16_f32 v210, v44, v45
 buffer_load_dwordx4 v32, s[12:15], s21 offen offset:1024 lds
 v_cvt_pk_f16_f32 v211, v46, v47
 v_mfma_f32_16x16x32_bf16 v[48:51], v[140:143], v[92:95], v[48:51]
 v_cvt_pk_f16_f32 v218, v52, v53
 buffer_load_dwordx4 v33, s[12:15], s21 offen offset:2048 lds
 v_cvt_pk_f16_f32 v219, v54, v55
 v_cvt_pk_f16_f32 v226, v60, v61
 v_mfma_f32_16x16x32_bf16 v[56:59], v[140:143], v[116:119], v[56:59]
 v_cvt_pk_f16_f32 v227, v62, v63
 s_add_u32 m0, s81, 18432
 s_add_u32 s21, s88, 5603328
 s_waitcnt lgkmcnt(2)
 v_mfma_f32_16x16x32_bf16 v[40:43], v[144:147], v[72:75], v[40:43]
 ds_read_b128 v[140:143], v23 offset:24832
 buffer_load_dwordx4 v34, s[12:15], s21 offen offset:0 lds
 v_mfma_f32_16x16x32_bf16 v[48:51], v[144:147], v[96:99], v[48:51]
 buffer_load_dwordx4 v35, s[12:15], s21 offen offset:1024 lds
 v_mfma_f32_16x16x32_bf16 v[56:59], v[144:147], v[120:123], v[56:59]
 buffer_load_dwordx4 v36, s[12:15], s21 offen offset:2048 lds
 s_waitcnt lgkmcnt(2)
 v_mfma_f32_16x16x32_bf16 v[40:43], v[148:151], v[76:79], v[40:43]
 ds_read_b128 v[144:147], v22 offset:26112
 s_add_u32 m0, s81, 21504
 s_add_u32 s21, s88, 7569408
 v_mfma_f32_16x16x32_bf16 v[48:51], v[148:151], v[100:103], v[48:51]
 buffer_load_dwordx4 v37, s[12:15], s21 offen offset:0 lds
 v_mfma_f32_16x16x32_bf16 v[56:59], v[148:151], v[124:127], v[56:59]
 buffer_load_dwordx4 v38, s[12:15], s21 offen offset:1024 lds
 s_waitcnt lgkmcnt(2)
 v_mfma_f32_16x16x32_bf16 v[40:43], v[136:139], v[80:83], v[40:43]
 ds_read_b128 v[148:151], v23 offset:26112
 buffer_load_dwordx4 v39, s[12:15], s21 offen offset:2048 lds
 v_mfma_f32_16x16x32_bf16 v[48:51], v[136:139], v[104:107], v[48:51]
 v_mfma_f32_16x16x32_bf16 v[56:59], v[136:139], v[128:131], v[56:59]
 s_waitcnt lgkmcnt(2)
 v_mfma_f32_16x16x32_bf16 v[40:43], v[140:143], v[84:87], v[40:43]
 ds_read_b128 v[136:139], v22 offset:26240
 v_mfma_f32_16x16x32_bf16 v[48:51], v[140:143], v[108:111], v[48:51]
 v_mfma_f32_16x16x32_bf16 v[56:59], v[140:143], v[132:135], v[56:59]
 s_waitcnt lgkmcnt(2)
 v_mfma_f32_16x16x32_bf16 v[44:47], v[144:147], v[64:67], 0
 ds_read_b128 v[140:143], v23 offset:26240
 v_mfma_f32_16x16x32_bf16 v[52:55], v[144:147], v[88:91], 0
 v_mfma_f32_16x16x32_bf16 v[60:63], v[144:147], v[112:115], 0
 s_waitcnt lgkmcnt(2)
 v_mfma_f32_16x16x32_bf16 v[44:47], v[148:151], v[68:71], v[44:47]
 ds_read_b128 v[144:147], v22 offset:26368
 v_cvt_pk_f16_f32 v212, v40, v41
 v_cvt_pk_f16_f32 v213, v42, v43
 v_cvt_pk_f16_f32 v220, v48, v49
 v_cvt_pk_f16_f32 v221, v50, v51
 v_mfma_f32_16x16x32_bf16 v[52:55], v[148:151], v[92:95], v[52:55]
 v_cvt_pk_f16_f32 v228, v56, v57
 v_cvt_pk_f16_f32 v229, v58, v59
 v_mfma_f32_16x16x32_bf16 v[60:63], v[148:151], v[116:119], v[60:63]
 s_waitcnt lgkmcnt(2)
 v_mfma_f32_16x16x32_bf16 v[44:47], v[136:139], v[72:75], v[44:47]
 ds_read_b128 v[148:151], v23 offset:26368
 v_mfma_f32_16x16x32_bf16 v[52:55], v[136:139], v[96:99], v[52:55]
 v_mfma_f32_16x16x32_bf16 v[60:63], v[136:139], v[120:123], v[60:63]
 s_waitcnt lgkmcnt(2)
 v_mfma_f32_16x16x32_bf16 v[44:47], v[140:143], v[76:79], v[44:47]
 s_waitcnt vmcnt(12)
 ds_read_b128 v[136:139], v22 offset:0
 v_mfma_f32_16x16x32_bf16 v[52:55], v[140:143], v[100:103], v[52:55]
 v_mfma_f32_16x16x32_bf16 v[60:63], v[140:143], v[124:127], v[60:63]
 s_waitcnt lgkmcnt(2)
 v_mfma_f32_16x16x32_bf16 v[44:47], v[144:147], v[80:83], v[44:47]
 ds_read_b128 v[140:143], v23 offset:0
 v_mfma_f32_16x16x32_bf16 v[52:55], v[144:147], v[104:107], v[52:55]
 v_mfma_f32_16x16x32_bf16 v[60:63], v[144:147], v[128:131], v[60:63]
 s_waitcnt lgkmcnt(2)
 v_mfma_f32_16x16x32_bf16 v[44:47], v[148:151], v[84:87], v[44:47]
 ds_read_b128 v[144:147], v22 offset:128
 v_mfma_f32_16x16x32_bf16 v[52:55], v[148:151], v[108:111], v[52:55]
 v_mfma_f32_16x16x32_bf16 v[60:63], v[148:151], v[132:135], v[60:63]
 s_mov_b32 s101, 0
 s_branch fm_8
fm_7:
 s_sleep 8
 buffer_load_dword v0, v26, s[32:35], 0 offen sc1
 s_add_u32 s101, s101, 1
 s_cmp_gt_u32 s101, 131072
 s_cbranch_scc1 end0
 s_waitcnt vmcnt(0)
fm_8:
 v_readlane_b32 s22, v0, 0
 v_readlane_b32 s23, v0, 32
 s_add_u32 s22, s22, s23
 v_readlane_b32 s23, v0, 1
 s_add_u32 s22, s22, s23
 v_readlane_b32 s23, v0, 33
 s_add_u32 s22, s22, s23
 v_readlane_b32 s23, v0, 2
 s_add_u32 s22, s22, s23
 v_readlane_b32 s23, v0, 34
 s_add_u32 s22, s22, s23
 v_readlane_b32 s23, v0, 3
 s_add_u32 s22, s22, s23
 v_readlane_b32 s23, v0, 35
 s_add_u32 s22, s22, s23
 v_readlane_b32 s21, v0, 19
 s_cmp_ge_u32 s22, 256
 s_cselect_b32 s21, s21, 0
 s_cmp_lt_u32 s21, 32
 s_cbranch_scc1 fm_7
 v_readlane_b32 s21, v0, s82
 s_cmp_ge_u32 s21, s83
 s_cselect_b32 s21, 1, 0
 s_andn2_b32 s53, s21, s53
 s_mov_b32 s101, 0
c0_9:
 v_cmp_eq_u32 vcc, 0, v252
 s_nop 1
 s_cbranch_vccz c0_10
 s_sleep 8
 v_and_b32 v253, 31, v1
 buffer_load_ubyte v252, v253, s[32:35], 0 offen offset:160 sc1
 s_add_u32 s101, s101, 1
 s_cmp_gt_u32 s101, 131072
 s_cbranch_scc1 end0
 s_waitcnt vmcnt(0)
 s_branch c0_9
c0_10:
 v_cmp_eq_u32 vcc, 2, v252
 s_nop 1
 s_mov_b32 s37, vcc_lo
 s_bitcmp0_b32 s37, 0
 s_cselect_b32 s23, 8192, 0
 v_add_u32 v13, s23, v13
 v_add_u32 v4, s23, v4
 s_add_u32 s12, s44, 81068032
 s_addc_u32 s13, s45, 0
 s_mov_b32 s14, 129024
 s_mov_b32 s15, 0x00020000
 v_and_b32 v27, 7, v2
 v_mul_u32_u24 v27, 1280, v27
 v_lshrrev_b32 v39, 3, v1
 v_mul_u32_u24 v39, 40, v39
 s_mul_i32 s21, s20, 320
 v_add3_u32 v27, v27, v39, s21
 buffer_load_dwordx4 v[28:31], v27, s[28:31], 0 offen offset:0
 buffer_load_dwordx4 v[32:35], v27, s[28:31], 0 offen offset:16
 buffer_load_dwordx2 v[36:37], v27, s[28:31], 0 offen offset:32
 s_and_b32 s21, s51, 3
 s_mul_i32 s21, s21, 540672
 buffer_load_dword v38, v9, s[8:11], s21 offen sc1
 buffer_load_dword v38, v8, s[8:11], s21 offen offset:0 sc1
 buffer_load_dword v38, v8, s[8:11], s21 offen offset:1024 sc1
 s_waitcnt lgkmcnt(2)
 v_mfma_f32_16x16x32_bf16 v[40:43], v[136:139], v[64:67], 0
 ds_read_b128 v[148:151], v23 offset:128
 v_mfma_f32_16x16x32_bf16 v[48:51], v[136:139], v[88:91], 0
 v_mfma_f32_16x16x32_bf16 v[56:59], v[136:139], v[112:115], 0
 s_waitcnt lgkmcnt(2)
 v_mfma_f32_16x16x32_bf16 v[40:43], v[140:143], v[68:71], v[40:43]
 ds_read_b128 v[136:139], v22 offset:256
 v_cvt_pk_f16_f32 v214, v44, v45
 v_cvt_pk_f16_f32 v215, v46, v47
 v_cvt_pk_f16_f32 v222, v52, v53
 v_cvt_pk_f16_f32 v223, v54, v55
 v_mfma_f32_16x16x32_bf16 v[48:51], v[140:143], v[92:95], v[48:51]
 v_cvt_pk_f16_f32 v230, v60, v61
 v_cvt_pk_f16_f32 v231, v62, v63
 v_mfma_f32_16x16x32_bf16 v[56:59], v[140:143], v[116:119], v[56:59]
 s_waitcnt lgkmcnt(2)
 v_mfma_f32_16x16x32_bf16 v[40:43], v[144:147], v[72:75], v[40:43]
 ds_read_b128 v[140:143], v23 offset:256
 v_mfma_f32_16x16x32_bf16 v[48:51], v[144:147], v[96:99], v[48:51]
 v_mfma_f32_16x16x32_bf16 v[56:59], v[144:147], v[120:123], v[56:59]
 s_waitcnt lgkmcnt(2)
 v_mfma_f32_16x16x32_bf16 v[40:43], v[148:151], v[76:79], v[40:43]
 ds_read_b128 v[144:147], v22 offset:1536
 v_mfma_f32_16x16x32_bf16 v[48:51], v[148:151], v[100:103], v[48:51]
 v_mfma_f32_16x16x32_bf16 v[56:59], v[148:151], v[124:127], v[56:59]
 s_waitcnt lgkmcnt(2)
 v_mfma_f32_16x16x32_bf16 v[40:43], v[136:139], v[80:83], v[40:43]
 ds_read_b128 v[148:151], v23 offset:1536
 v_mfma_f32_16x16x32_bf16 v[48:51], v[136:139], v[104:107], v[48:51]
 v_mfma_f32_16x16x32_bf16 v[56:59], v[136:139], v[128:131], v[56:59]
 s_waitcnt lgkmcnt(2)
 v_mfma_f32_16x16x32_bf16 v[40:43], v[140:143], v[84:87], v[40:43]
 ds_read_b128 v[136:139], v22 offset:1664
 v_mfma_f32_16x16x32_bf16 v[48:51], v[140:143], v[108:111], v[48:51]
 v_mfma_f32_16x16x32_bf16 v[56:59], v[140:143], v[132:135], v[56:59]
 s_waitcnt lgkmcnt(2)
 v_mfma_f32_16x16x32_bf16 v[44:47], v[144:147], v[64:67], 0
 ds_read_b128 v[140:143], v23 offset:1664
 v_mfma_f32_16x16x32_bf16 v[52:55], v[144:147], v[88:91], 0
 v_mfma_f32_16x16x32_bf16 v[60:63], v[144:147], v[112:115], 0
 s_waitcnt lgkmcnt(2)
 v_mfma_f32_16x16x32_bf16 v[44:47], v[148:151], v[68:71], v[44:47]
 ds_read_b128 v[144:147], v22 offset:1792
 v_cvt_pk_f16_f32 v232, v40, v41
 v_cvt_pk_f16_f32 v233, v42, v43
 v_cvt_pk_f16_f32 v240, v48, v49
 v_cvt_pk_f16_f32 v241, v50, v51
 v_mfma_f32_16x16x32_bf16 v[52:55], v[148:151], v[92:95], v[52:55]
 v_cvt_pk_f16_f32 v248, v56, v57
 v_cvt_pk_f16_f32 v249, v58, v59
 v_mfma_f32_16x16x32_bf16 v[60:63], v[148:151], v[116:119], v[60:63]
 s_waitcnt lgkmcnt(2)
 v_mfma_f32_16x16x32_bf16 v[44:47], v[136:139], v[72:75], v[44:47]
 ds_read_b128 v[148:151], v23 offset:1792
 v_mfma_f32_16x16x32_bf16 v[52:55], v[136:139], v[96:99], v[52:55]
 v_mfma_f32_16x16x32_bf16 v[60:63], v[136:139], v[120:123], v[60:63]
 s_waitcnt lgkmcnt(2)
 v_mfma_f32_16x16x32_bf16 v[44:47], v[140:143], v[76:79], v[44:47]
 s_waitcnt vmcnt(6)
 ds_read_b128 v[136:139], v22 offset:12288
 v_mfma_f32_16x16x32_bf16 v[52:55], v[140:143], v[100:103], v[52:55]
 v_mfma_f32_16x16x32_bf16 v[60:63], v[140:143], v[124:127], v[60:63]
 s_waitcnt lgkmcnt(2)
 v_mfma_f32_16x16x32_bf16 v[44:47], v[144:147], v[80:83], v[44:47]
 ds_read_b128 v[140:143], v23 offset:12288
 v_mfma_f32_16x16x32_bf16 v[52:55], v[144:147], v[104:107], v[52:55]
 v_mfma_f32_16x16x32_bf16 v[60:63], v[144:147], v[128:131], v[60:63]
 s_waitcnt lgkmcnt(2)
 v_mfma_f32_16x16x32_bf16 v[44:47], v[148:151], v[84:87], v[44:47]
 ds_read_b128 v[144:147], v22 offset:12416
 v_mfma_f32_16x16x32_bf16 v[52:55], v[148:151], v[108:111], v[52:55]
 v_mfma_f32_16x16x32_bf16 v[60:63], v[148:151], v[132:135], v[60:63]
 buffer_load_dword v0, off, s[12:15], s79 sc1
 s_waitcnt lgkmcnt(2)
 v_mfma_f32_16x16x32_bf16 v[40:43], v[136:139], v[64:67], 0
 ds_read_b128 v[148:151], v23 offset:12416
 v_mfma_f32_16x16x32_bf16 v[48:51], v[136:139], v[88:91], 0
 v_mfma_f32_16x16x32_bf16 v[56:59], v[136:139], v[112:115], 0
 s_waitcnt lgkmcnt(2)
 v_mfma_f32_16x16x32_bf16 v[40:43], v[140:143], v[68:71], v[40:43]
 ds_read_b128 v[136:139], v22 offset:12544
 v_cvt_pk_f16_f32 v234, v44, v45
 v_cvt_pk_f16_f32 v235, v46, v47
 v_cvt_pk_f16_f32 v242, v52, v53
 v_cvt_pk_f16_f32 v243, v54, v55
 v_mfma_f32_16x16x32_bf16 v[48:51], v[140:143], v[92:95], v[48:51]
 v_cvt_pk_f16_f32 v250, v60, v61
 v_cvt_pk_f16_f32 v251, v62, v63
 v_mfma_f32_16x16x32_bf16 v[56:59], v[140:143], v[116:119], v[56:59]
 s_waitcnt lgkmcnt(2)
 v_mfma_f32_16x16x32_bf16 v[40:43], v[144:147], v[72:75], v[40:43]
 ds_read_b128 v[140:143], v23 offset:12544
 v_mfma_f32_16x16x32_bf16 v[48:51], v[144:147], v[96:99], v[48:51]
 v_mfma_f32_16x16x32_bf16 v[56:59], v[144:147], v[120:123], v[56:59]
 s_waitcnt lgkmcnt(2)
 v_mfma_f32_16x16x32_bf16 v[40:43], v[148:151], v[76:79], v[40:43]
 ds_read_b128 v[144:147], v22 offset:13824
 v_mfma_f32_16x16x32_bf16 v[48:51], v[148:151], v[100:103], v[48:51]
 v_mfma_f32_16x16x32_bf16 v[56:59], v[148:151], v[124:127], v[56:59]
 s_waitcnt lgkmcnt(2)
 v_mfma_f32_16x16x32_bf16 v[40:43], v[136:139], v[80:83], v[40:43]
 ds_read_b128 v[148:151], v23 offset:13824
 v_mfma_f32_16x16x32_bf16 v[48:51], v[136:139], v[104:107], v[48:51]
 v_mfma_f32_16x16x32_bf16 v[56:59], v[136:139], v[128:131], v[56:59]
 s_waitcnt lgkmcnt(2)
 v_mfma_f32_16x16x32_bf16 v[40:43], v[140:143], v[84:87], v[40:43]
 ds_read_b128 v[136:139], v22 offset:13952
 v_mfma_f32_16x16x32_bf16 v[48:51], v[140:143], v[108:111], v[48:51]
 v_mfma_f32_16x16x32_bf16 v[56:59], v[140:143], v[132:135], v[56:59]
 s_waitcnt lgkmcnt(2)
 v_mfma_f32_16x16x32_bf16 v[44:47], v[144:147], v[64:67], 0
 ds_read_b128 v[140:143], v23 offset:13952
 v_mfma_f32_16x16x32_bf16 v[52:55], v[144:147], v[88:91], 0
 v_mfma_f32_16x16x32_bf16 v[60:63], v[144:147], v[112:115], 0
 s_waitcnt lgkmcnt(2)
 v_mfma_f32_16x16x32_bf16 v[44:47], v[148:151], v[68:71], v[44:47]
 ds_read_b128 v[144:147], v22 offset:14080
 v_cvt_pk_f16_f32 v236, v40, v41
 v_cvt_pk_f16_f32 v237, v42, v43
 v_cvt_pk_f16_f32 v244, v48, v49
 v_cvt_pk_f16_f32 v245, v50, v51
 v_mfma_f32_16x16x32_bf16 v[52:55], v[148:151], v[92:95], v[52:55]
 v_cvt_pk_f16_f32 v252, v56, v57
 v_cvt_pk_f16_f32 v253, v58, v59
 v_mfma_f32_16x16x32_bf16 v[60:63], v[148:151], v[116:119], v[60:63]
 s_waitcnt lgkmcnt(2)
 v_mfma_f32_16x16x32_bf16 v[44:47], v[136:139], v[72:75], v[44:47]
 ds_read_b128 v[148:151], v23 offset:14080
 v_mfma_f32_16x16x32_bf16 v[52:55], v[136:139], v[96:99], v[52:55]
 v_mfma_f32_16x16x32_bf16 v[60:63], v[136:139], v[120:123], v[60:63]
 s_waitcnt lgkmcnt(2)
 v_mfma_f32_16x16x32_bf16 v[44:47], v[140:143], v[76:79], v[44:47]
 v_mfma_f32_16x16x32_bf16 v[52:55], v[140:143], v[100:103], v[52:55]
 v_mfma_f32_16x16x32_bf16 v[60:63], v[140:143], v[124:127], v[60:63]
 s_waitcnt lgkmcnt(1)
 v_mfma_f32_16x16x32_bf16 v[44:47], v[144:147], v[80:83], v[44:47]
 v_mfma_f32_16x16x32_bf16 v[52:55], v[144:147], v[104:107], v[52:55]
 v_mfma_f32_16x16x32_bf16 v[60:63], v[144:147], v[128:131], v[60:63]
 s_waitcnt lgkmcnt(0)
 v_mfma_f32_16x16x32_bf16 v[44:47], v[148:151], v[84:87], v[44:47]
 v_mfma_f32_16x16x32_bf16 v[52:55], v[148:151], v[108:111], v[52:55]
 v_mfma_f32_16x16x32_bf16 v[60:63], v[148:151], v[132:135], v[60:63]
 s_nop 7
 v_cvt_pk_f16_f32 v238, v44, v45
 v_cvt_pk_f16_f32 v239, v46, v47
 v_cvt_pk_f16_f32 v246, v52, v53
 v_cvt_pk_f16_f32 v247, v54, v55
 v_cvt_pk_f16_f32 v254, v60, v61
 v_cvt_pk_f16_f32 v255, v62, v63
 s_add_u32 s28, s44, 88080384
 s_addc_u32 s29, s45, 0
 s_mov_b32 s30, 83886080
 s_mov_b32 s31, 0x00020000
 s_waitcnt vmcnt(0)
 v_readfirstlane_b32 s21, v0
 s_cmp_lg_u32 s21, 0
 s_cbranch_scc1 pf_12
 v_mov_b32 v62, 0
 s_mov_b32 s101, 0
wf_13:
 buffer_load_dword v63, v62, s[12:15], s79 offen sc1
 s_add_u32 s101, s101, 1
 s_cmp_gt_u32 s101, 131072
 s_cbranch_scc1 end0
 s_waitcnt vmcnt(0)
 v_readfirstlane_b32 s100, v63
 s_cmp_ge_u32 s100, 1
 s_cbranch_scc1 wf_14
 s_sleep 4
 s_branch wf_13
wf_14:
 v_mov_b32 v0, s100
pf_12:
 s_mov_b32 s87, 0
 s_sub_u32 s21, s64, 1310720
 s_cmp_ge_u32 s20, 2
 s_cbranch_scc1 pf_11
 buffer_load_dwordx4 v[112:115], v18, s[16:19], 0 offen sc1
 buffer_load_dwordx2 v[116:117], v19, s[16:19], 0 offen sc1
pf_11:
 buffer_load_dwordx4 v[126:129], v16, s[28:31], s21 offen offset:0 sc1
 buffer_load_dwordx4 v[130:133], v16, s[28:31], s21 offen offset:1024 sc1
 buffer_load_dwordx4 v[134:137], v16, s[28:31], s21 offen offset:2048 sc1
 v_lshlrev_b32 v27, 16, v28
 v_and_b32 v28, 0xffff0000, v28
 v_cvt_pk_f16_f32 v28, v27, v28
 v_lshlrev_b32 v27, 16, v29
 v_and_b32 v29, 0xffff0000, v29
 v_cvt_pk_f16_f32 v29, v27, v29
 v_lshlrev_b32 v27, 16, v30
 v_and_b32 v30, 0xffff0000, v30
 v_cvt_pk_f16_f32 v30, v27, v30
 v_lshlrev_b32 v27, 16, v31
 v_and_b32 v31, 0xffff0000, v31
 v_cvt_pk_f16_f32 v31, v27, v31
 v_lshlrev_b32 v27, 16, v32
 v_and_b32 v32, 0xffff0000, v32
 v_cvt_pk_f16_f32 v32, v27, v32
 v_lshlrev_b32 v27, 16, v33
 v_and_b32 v33, 0xffff0000, v33
 v_cvt_pk_f16_f32 v33, v27, v33
 v_lshlrev_b32 v27, 16, v34
 v_and_b32 v34, 0xffff0000, v34
 v_cvt_pk_f16_f32 v34, v27, v34
 v_lshlrev_b32 v27, 16, v35
 v_and_b32 v35, 0xffff0000, v35
 v_cvt_pk_f16_f32 v35, v27, v35
 v_lshlrev_b32 v27, 16, v36
 v_and_b32 v36, 0xffff0000, v36
 v_cvt_pk_f16_f32 v36, v27, v36
 v_lshlrev_b32 v27, 16, v37
 v_and_b32 v37, 0xffff0000, v37
 v_cvt_pk_f16_f32 v37, v27, v37
 s_lshl_b32 s21, s20, 2
 s_add_u32 s21, s21, 20480
 v_add_u32 v22, s21, v16
 v_bfe_u32 v23, v1, 2, 3
 v_lshlrev_b32 v23, 4, v23
 v_add_u32 v23, 20480, v23
 v_cmp_gt_u32 vcc, 2, v3
 s_mov_b32 s52, 0
 s_mov_b32 s89, 0x05040100
 v_cndmask_b32 v26, 0, 1.0, vcc
 v_mov_b32 v124, 0
 v_mov_b32 v125, 0
 v_mov_b32 v144, 0
 v_mov_b32 v145, 0
 v_mov_b32 v40, 0
 v_mov_b32 v41, 0
 v_mov_b32 v42, 0
 v_mov_b32 v43, 0
 v_mov_b32 v44, 0
 v_mov_b32 v45, 0
 v_mov_b32 v46, 0
 v_mov_b32 v47, 0
 v_mov_b32 v48, 0
 v_mov_b32 v49, 0
 v_mov_b32 v50, 0
 v_mov_b32 v51, 0
 v_mov_b32 v52, 0
 v_mov_b32 v53, 0
 v_mov_b32 v54, 0
 v_mov_b32 v55, 0
 v_mov_b32 v56, 0
 v_mov_b32 v57, 0
 v_mov_b32 v58, 0
 v_mov_b32 v59, 0
 v_mov_b32 v60, 0
 v_mov_b32 v61, 0
 v_mov_b32 v62, 0
 v_mov_b32 v63, 0
 v_mov_b32 v100, 0
 v_mov_b32 v101, 0
 v_mov_b32 v102, 0
 v_mov_b32 v103, 0
 v_mov_b32 v104, 0
 v_mov_b32 v105, 0
 v_mov_b32 v106, 0
 v_mov_b32 v107, 0
 v_mov_b32 v108, 0
 v_mov_b32 v109, 0
 v_mov_b32 v110, 0
 v_mov_b32 v111, 0
 s_barrier
 s_mov_b32 s57, 0x80000000
 s_and_b32 s21, s52, 3
 s_mul_i32 s81, s21, 540672
 s_mul_i32 s84, s21, 0x88000
 s_and_b32 s84, s84, 0x108000
 s_add_u32 s21, s52, 3
 s_and_b32 s21, s21, 3
 s_mul_i32 s83, s21, 0x88000
 s_and_b32 s83, s83, 0x108000
 s_add_u32 s21, s52, 1
 s_and_b32 s22, s21, 3
 s_mul_i32 s3, s22, 0x88000
 s_and_b32 s3, s3, 0x108000
 s_mul_i32 s80, s21, 393216
 s_add_u32 s46, s21, 1
 s_min_u32 s46, s46, 64
 s_mov_b32 s47, s57
 s_mov_b32 s78, s85
 s_lshr_b32 s21, s52, 1
 s_bitcmp1_b32 s37, s21
 s_cselect_b32 s21, 8192, 0
 s_lshl_b32 s22, s52, 20
 s_or_b32 s22, s22, s21
 s_cmp_ge_u32 s52, 40
 s_cselect_b32 s57, 8192, 0
 s_xor_b32 s57, s57, s22
 s_xor_b32 s85, s22, 8192
 s_bfe_u32 s88, s52, 0x10002
 s_max_u32 s67, s52, 1
 s_sub_u32 s67, s67, 1
 s_cmp_eq_u32 s53, 0
 s_cbranch_scc1 A1_19
 s_cmp_eq_u32 s20, 0
 s_cbranch_scc1 A1_15
 s_cmp_eq_u32 s20, 1
 s_cbranch_scc1 A1_16
 s_cmp_eq_u32 s20, 2
 s_cbranch_scc1 A1_17
 s_cmp_eq_u32 s20, 3
 s_cbranch_scc1 A1_18
 s_branch A1_19
step_20:
 s_and_b32 s21, s52, 3
 s_mul_i32 s81, s21, 540672
 s_mul_i32 s84, s21, 0x88000
 s_and_b32 s84, s84, 0x108000
 s_add_u32 s21, s52, 3
 s_and_b32 s21, s21, 3
 s_mul_i32 s83, s21, 0x88000
 s_and_b32 s83, s83, 0x108000
 s_add_u32 s21, s52, 1
 s_and_b32 s22, s21, 3
 s_mul_i32 s3, s22, 0x88000
 s_and_b32 s3, s3, 0x108000
 s_mul_i32 s80, s21, 393216
 s_add_u32 s46, s21, 1
 s_min_u32 s46, s46, 64
 s_mov_b32 s47, s57
 s_mov_b32 s78, s85
 s_lshr_b32 s21, s52, 1
 s_bitcmp1_b32 s37, s21
 s_cselect_b32 s21, 8192, 0
 s_lshl_b32 s22, s52, 20
 s_or_b32 s22, s22, s21
 s_cmp_ge_u32 s52, 40
 s_cselect_b32 s57, 8192, 0
 s_xor_b32 s57, s57, s22
 s_xor_b32 s85, s22, 8192
 s_bfe_u32 s88, s52, 0x10002
 s_max_u32 s67, s52, 1
 s_sub_u32 s67, s67, 1
 v_mov_b32 v40, 0
 v_mov_b32 v41, 0
 v_mov_b32 v42, 0
 v_mov_b32 v43, 0
 v_mov_b32 v44, 0
 v_mov_b32 v45, 0
 v_mov_b32 v46, 0
 v_mov_b32 v47, 0
 v_mov_b32 v48, 0
 v_mov_b32 v49, 0
 v_mov_b32 v50, 0
 v_mov_b32 v51, 0
 v_mov_b32 v52, 0
 v_mov_b32 v53, 0
 v_mov_b32 v54, 0
 v_mov_b32 v55, 0
 v_mov_b32 v56, 0
 v_mov_b32 v57, 0
 v_mov_b32 v58, 0
 v_mov_b32 v59, 0
 v_mov_b32 v60, 0
 v_mov_b32 v61, 0
 v_mov_b32 v62, 0
 v_mov_b32 v63, 0
 v_mov_b32 v100, 0
 v_mov_b32 v101, 0
 v_mov_b32 v102, 0
 v_mov_b32 v103, 0
 v_mov_b32 v104, 0
 v_mov_b32 v105, 0
 v_mov_b32 v106, 0
 v_mov_b32 v107, 0
 v_mov_b32 v108, 0
 v_mov_b32 v109, 0
 v_mov_b32 v110, 0
 v_mov_b32 v111, 0
 s_sleep 4
 s_nop 3
 v_readfirstlane_b32 s21, v0
 s_cmp_lt_u32 s21, s46
 s_cselect_b32 s55, s55, 0
 s_cmp_lt_i32 s55, 0
 s_cbranch_scc1 fl_25
fl_26:
 s_mov_b32 s54, 0
 buffer_load_dwordx4 v[36:39], v4, s[4:7], s84 offen offset:2048 sc1
 buffer_load_dwordx4 v[28:31], v4, s[4:7], s84 offen offset:0 sc1
 buffer_load_dwordx4 v[32:35], v4, s[4:7], s84 offen offset:1024 sc1
 s_waitcnt vmcnt(3)
 v_mov_b32 v126, v88
 v_mov_b32 v127, v89
 v_mov_b32 v128, v90
 v_mov_b32 v129, v91
 v_mov_b32 v130, v92
 v_mov_b32 v131, v93
 v_mov_b32 v132, v94
 v_mov_b32 v133, v95
 v_mov_b32 v134, v96
 v_mov_b32 v135, v97
 v_mov_b32 v136, v98
 v_mov_b32 v137, v99
 s_waitcnt vmcnt(2)
 v_smfmac_f32_16x16x32_f16 v[40:43], v[36:37], a[16:19], v25
 v_smfmac_f32_16x16x32_f16 v[52:55], v[36:37], a[76:79], v25
 v_smfmac_f32_16x16x32_f16 v[44:47], v[36:37], a[36:39], v25
 s_waitcnt vmcnt(0)
 v_bitop3_b32 v27, v31, v35, v39 bitop3:0x80
 v_perm_b32 v31, v35, v31, s89
 v_cmp_gt_u32 vcc, 0x48000000, v27
 v_mov_b32 v35, v38
 v_smfmac_f32_16x16x32_f16 v[56:59], v[36:37], a[96:99], v25
 s_cbranch_vccnz pm_23
A2_24:
 v_smfmac_f32_16x16x64_f16 v[40:43], v[28:31], a[0:7], v25
 ds_write_b128 v10, v[28:31]
 v_smfmac_f32_16x16x64_f16 v[40:43], v[32:35], a[8:15], v25
 ds_write_b128 v10, v[32:35] offset:1024
 v_smfmac_f32_16x16x64_f16 v[52:55], v[28:31], a[60:67], v25
 ds_write_b64 v10, v[36:37] offset:2048
 v_smfmac_f32_16x16x64_f16 v[52:55], v[32:35], a[68:75], v25
 v_cvt_pk_f16_f32 v40, v40, v41
 v_cvt_pk_f16_f32 v41, v42, v43
 v_smfmac_f32_16x16x32_f16 v[48:51], v[36:37], a[56:59], v25
 v_smfmac_f32_16x16x32_f16 v[60:63], v[36:37], a[116:119], v25
 v_smfmac_f32_16x16x64_f16 v[44:47], v[28:31], a[20:27], v25
 v_cvt_pk_f16_f32 v52, v52, v53
 v_cvt_pk_f16_f32 v53, v54, v55
 s_nop 0
 v_smfmac_f32_16x16x64_f16 v[44:47], v[32:35], a[28:35], v25
 v_permlane32_swap_b32 v40, v52
 v_smfmac_f32_16x16x64_f16 v[56:59], v[28:31], a[80:87], v25
 v_permlane32_swap_b32 v41, v53
 v_pk_add_f16 v40, v40, v52
 v_smfmac_f32_16x16x64_f16 v[56:59], v[32:35], a[88:95], v25
 v_pk_add_f16 v41, v41, v53
 v_smfmac_f32_16x16x64_f16 v[48:51], v[28:31], a[40:47], v25
 ds_write_b64 v5, v[40:41] offset:0
 v_smfmac_f32_16x16x64_f16 v[48:51], v[32:35], a[48:55], v25
 v_cvt_pk_f16_f32 v44, v44, v45
 v_cvt_pk_f16_f32 v45, v46, v47
 v_cvt_pk_f16_f32 v56, v56, v57
 v_smfmac_f32_16x16x64_f16 v[60:63], v[28:31], a[100:107], v25
 v_cvt_pk_f16_f32 v57, v58, v59
 s_nop 0
 v_smfmac_f32_16x16x64_f16 v[60:63], v[32:35], a[108:115], v25
 v_permlane32_swap_b32 v44, v56
 v_permlane32_swap_b32 v45, v57
 v_pk_add_f16 v44, v44, v56
 v_pk_add_f16 v45, v45, v57
 ds_write_b64 v5, v[44:45] offset:640
 v_cvt_pk_f16_f32 v48, v48, v49
 v_cvt_pk_f16_f32 v49, v50, v51
 v_cvt_pk_f16_f32 v60, v60, v61
 v_cvt_pk_f16_f32 v61, v62, v63
 s_nop 0
 v_permlane32_swap_b32 v48, v60
 v_permlane32_swap_b32 v49, v61
 v_pk_add_f16 v48, v48, v60
 v_pk_add_f16 v49, v49, v61
 ds_write_b64 v5, v[48:49] offset:1280
 s_waitcnt lgkmcnt(0) vmcnt(0)
 s_barrier
 ds_read_b64_tr_b16 v[40:41], v21 offset:0
 ds_read_b64_tr_b16 v[42:43], v21 offset:1920
 ds_read_b64_tr_b16 v[44:45], v21 offset:640
 ds_read_b64_tr_b16 v[46:47], v21 offset:2560
 ds_read_b64_tr_b16 v[48:49], v21 offset:1280
 ds_read_b64_tr_b16 v[50:51], v21 offset:3200
 s_waitcnt lgkmcnt(4)
 v_fma_mix_f32 v52, v40, 1.0, v42 op_sel:[0,0,0] op_sel_hi:[1,0,1]
 v_fma_mix_f32 v53, v40, 1.0, v42 op_sel:[1,0,1] op_sel_hi:[1,0,1]
 v_fma_mix_f32 v54, v41, 1.0, v43 op_sel:[0,0,0] op_sel_hi:[1,0,1]
 v_fma_mix_f32 v55, v41, 1.0, v43 op_sel:[1,0,1] op_sel_hi:[1,0,1]
 v_add_f32_dpp v56, v52, v52 row_ror:8 row_mask:0xf bank_mask:0xf
 v_add_f32_dpp v57, v53, v53 row_ror:8 row_mask:0xf bank_mask:0xf
 v_add_f32_dpp v58, v54, v54 row_ror:8 row_mask:0xf bank_mask:0xf
 v_add_f32_dpp v59, v55, v55 row_ror:8 row_mask:0xf bank_mask:0xf
 v_cvt_pk_bf16_f32 v118, v56, v57
 v_cvt_pk_bf16_f32 v119, v58, v59
 s_waitcnt lgkmcnt(2)
 v_fma_mix_f32 v52, v44, 1.0, v46 op_sel:[0,0,0] op_sel_hi:[1,0,1]
 v_fma_mix_f32 v53, v44, 1.0, v46 op_sel:[1,0,1] op_sel_hi:[1,0,1]
 v_fma_mix_f32 v54, v45, 1.0, v47 op_sel:[0,0,0] op_sel_hi:[1,0,1]
 v_fma_mix_f32 v55, v45, 1.0, v47 op_sel:[1,0,1] op_sel_hi:[1,0,1]
 v_add_f32_dpp v56, v52, v52 row_ror:8 row_mask:0xf bank_mask:0xf
 v_add_f32_dpp v57, v53, v53 row_ror:8 row_mask:0xf bank_mask:0xf
 v_add_f32_dpp v58, v54, v54 row_ror:8 row_mask:0xf bank_mask:0xf
 v_add_f32_dpp v59, v55, v55 row_ror:8 row_mask:0xf bank_mask:0xf
 v_cvt_pk_bf16_f32 v120, v56, v57
 v_cvt_pk_bf16_f32 v121, v58, v59
 s_waitcnt lgkmcnt(0)
 v_fma_mix_f32 v52, v48, 1.0, v50 op_sel:[0,0,0] op_sel_hi:[1,0,1]
 v_fma_mix_f32 v53, v48, 1.0, v50 op_sel:[1,0,1] op_sel_hi:[1,0,1]
 v_fma_mix_f32 v54, v49, 1.0, v51 op_sel:[0,0,0] op_sel_hi:[1,0,1]
 v_fma_mix_f32 v55, v49, 1.0, v51 op_sel:[1,0,1] op_sel_hi:[1,0,1]
 v_mfma_f32_16x16x32_bf16 v[40:43], v[112:115], v[118:121], 0
 v_add_f32_dpp v56, v52, v52 row_ror:8 row_mask:0xf bank_mask:0xf
 v_add_f32_dpp v57, v53, v53 row_ror:8 row_mask:0xf bank_mask:0xf
 v_add_f32_dpp v58, v54, v54 row_ror:8 row_mask:0xf bank_mask:0xf
 v_add_f32_dpp v59, v55, v55 row_ror:8 row_mask:0xf bank_mask:0xf
 v_cvt_pk_bf16_f32 v122, v56, v57
 v_cvt_pk_bf16_f32 v123, v58, v59
 s_nop 1
 v_mfma_f32_16x16x32_bf16 v[40:43], v[116:119], v[122:125], v[40:43]
 ds_read_b128 v[28:31], v16 offset:24576
 ds_read_b128 v[32:35], v16 offset:25600
 ds_read_b128 v[64:67], v16 offset:27648
 ds_read_b128 v[68:71], v16 offset:28672
 ds_read_b128 v[72:75], v16 offset:30720
 ds_read_b128 v[76:79], v16 offset:31744
 s_nop 0
 s_mov_b64 exec, s[74:75]
 v_cvt_pk_f16_f32 v44, v40, v41
 v_cvt_pk_f16_f32 v45, v42, v43
 v_and_or_b32 v44, v44, -2, s88
 buffer_store_dwordx2 v[44:45], v7, s[8:11], s81 offen
 s_mov_b64 exec, -1
 ds_read_b128 v[80:83], v16 offset:33792
 ds_read_b128 v[84:87], v16 offset:34816
 ds_read_b64 v[88:89], v16 offset:26624
 ds_read_b64 v[90:91], v16 offset:29696
 ds_read_b64 v[92:93], v16 offset:32768
 ds_read_b64 v[94:95], v16 offset:35840
 s_cmp_eq_u32 s52, 63
 s_cbranch_scc1 last_21
 s_waitcnt lgkmcnt(10)
 v_smfmac_f32_16x16x64_f16 v[100:103], v[28:31], a[120:127], v25
 v_smfmac_f32_16x16x64_f16 v[104:107], v[28:31], a[128:135], v25
 v_smfmac_f32_16x16x64_f16 v[108:111], v[28:31], a[136:143], v25
 s_mov_b32 s54, 0
 v_smfmac_f32_16x16x64_f16 v[100:103], v[32:35], a[144:151], v25
 v_readfirstlane_b32 s21, v0
 v_smfmac_f32_16x16x64_f16 v[104:107], v[32:35], a[152:159], v25
 s_add_u32 s22, s46, 3
 v_smfmac_f32_16x16x64_f16 v[108:111], v[32:35], a[160:167], v25
 s_min_u32 s22, s22, 64
 s_waitcnt lgkmcnt(7)
 v_smfmac_f32_16x16x64_f16 v[100:103], v[64:67], a[168:175], v25
 s_sub_u32 s55, s21, s22
 v_smfmac_f32_16x16x64_f16 v[104:107], v[64:67], a[176:183], v25
 s_sub_u32 s56, s21, s46
 v_smfmac_f32_16x16x64_f16 v[108:111], v[64:67], a[184:191], v25
 v_smfmac_f32_16x16x64_f16 v[100:103], v[68:71], a[192:199], v25
 v_smfmac_f32_16x16x64_f16 v[104:107], v[68:71], a[200:207], v25
 v_smfmac_f32_16x16x64_f16 v[108:111], v[68:71], a[208:215], v25
 v_smfmac_f32_16x16x64_f16 v[100:103], v[72:75], a[216:223], v25
 v_smfmac_f32_16x16x64_f16 v[104:107], v[72:75], a[224:231], v25
 v_smfmac_f32_16x16x64_f16 v[108:111], v[72:75], a[232:239], v25
 s_waitcnt lgkmcnt(4)
 v_smfmac_f32_16x16x64_f16 v[100:103], v[76:79], a[240:247], v25
 v_smfmac_f32_16x16x64_f16 v[104:107], v[76:79], a[248:255], v25
 v_smfmac_f32_16x16x64_f16 v[108:111], v[76:79], v[152:159], v25
 v_smfmac_f32_16x16x64_f16 v[100:103], v[80:83], v[160:167], v25
 buffer_load_dwordx2 v[58:59], v9, s[8:11], s81 offen sc1
 buffer_load_dwordx4 v[40:43], v8, s[8:11], s81 offen offset:0 sc1
 buffer_load_dwordx4 v[44:47], v8, s[8:11], s81 offen offset:1024 sc1
 v_smfmac_f32_16x16x64_f16 v[104:107], v[80:83], v[168:175], v25
 v_smfmac_f32_16x16x64_f16 v[108:111], v[80:83], v[176:183], v25
 v_smfmac_f32_16x16x64_f16 v[100:103], v[84:87], v[184:191], v25
 v_smfmac_f32_16x16x64_f16 v[104:107], v[84:87], v[192:199], v25
 v_smfmac_f32_16x16x64_f16 v[108:111], v[84:87], v[200:207], v25
 s_waitcnt lgkmcnt(0)
 v_smfmac_f32_16x16x64_f16 v[100:103], v[88:91], v[208:215], v25
 v_smfmac_f32_16x16x64_f16 v[104:107], v[88:91], v[216:223], v25
 v_smfmac_f32_16x16x64_f16 v[108:111], v[88:91], v[224:231], v25
 v_smfmac_f32_16x16x64_f16 v[100:103], v[92:95], v[232:239], v25
 v_smfmac_f32_16x16x64_f16 v[104:107], v[92:95], v[240:247], v25
 v_smfmac_f32_16x16x64_f16 v[108:111], v[92:95], v[248:255], v25
 s_cmp_lt_i32 s56, 0
 s_cbranch_scc1 kvw_29
kvok_30:
 s_waitcnt vmcnt(2)
 v_xor_b32 v76, s88, v58
 s_nop 0
 v_permlane16_swap_b32 v58, v59
 v_fma_mix_f32 v60, v58, 1.0, v59 op_sel:[0,0,0] op_sel_hi:[1,0,1]
 v_fma_mix_f32 v61, v58, 1.0, v59 op_sel:[1,0,1] op_sel_hi:[1,0,1]
 v_mov_b32 v58, v60
 v_mov_b32 v59, v61
 s_nop 0
 v_permlane32_swap_b32 v58, v60
 v_permlane32_swap_b32 v59, v61
 v_add_f32 v52, v58, v60
 v_add_f32 v53, v59, v61
 v_max_f32 v79, v52, v53
 s_waitcnt vmcnt(0)
 v_pk_add_f16 v80, v40, v44
 v_pk_add_f16 v82, v42, v46
 v_pk_add_f16 v81, v41, v45
 v_pk_add_f16 v83, v43, v47
 v_permlane32_swap_b32 v80, v82
 v_bitop3_b32 v77, v40, v42, s88 bitop3:0x7e
 v_permlane32_swap_b32 v81, v83
 v_bitop3_b32 v78, v44, v46, s88 bitop3:0x7e
 v_fma_mix_f32 v48, v80, 1.0, v82 op_sel:[0,0,0] op_sel_hi:[1,0,1]
 v_or3_b32 v27, v76, v77, v78
 v_fma_mix_f32 v49, v80, 1.0, v82 op_sel:[1,0,1] op_sel_hi:[1,0,1]
 v_and_b32 v27, 1, v27
 v_fma_mix_f32 v50, v81, 1.0, v83 op_sel:[0,0,0] op_sel_hi:[1,0,1]
 v_cmp_ne_u32 vcc, 0, v27
 v_fma_mix_f32 v51, v81, 1.0, v83 op_sel:[1,0,1] op_sel_hi:[1,0,1]
 v_max3_f32 v62, v48, v49, v79
 s_cbranch_vccnz psr_27
psj_28:
 v_max3_f32 v62, v62, v50, v51
 v_cvt_pk_bf16_f32 v146, v100, v101
 v_cvt_pk_bf16_f32 v147, v102, v103
 v_max_f32_dpp v62, v62, v62 row_ror:8 row_mask:0xf bank_mask:0xf
 v_mov_b32 v63, v62
 v_cvt_pk_bf16_f32 v148, v104, v105
 v_cvt_pk_bf16_f32 v149, v106, v107
 v_permlane32_swap_b32 v62, v63
 v_max_f32 v62, v62, v63
 v_mov_b32 v63, v62
 v_cvt_pk_bf16_f32 v150, v108, v109
 v_cvt_pk_bf16_f32 v151, v110, v111
 v_permlane16_swap_b32 v62, v63
 v_max_f32 v62, v62, v63
 v_mul_f32 v62, s86, v62
 v_fma_f32 v48, v48, s86, -v62
 v_fma_f32 v49, v49, s86, -v62
 v_fma_f32 v50, v50, s86, -v62
 v_fma_f32 v51, v51, s86, -v62
 v_fma_f32 v52, v52, s86, -v62
 v_fma_f32 v53, v53, s86, -v62
 v_exp_f32 v48, v48
 v_exp_f32 v49, v49
 buffer_load_dwordx4 v[88:91], v17, s[28:31], s64 offen offset:0 sc1
 v_exp_f32 v50, v50
 v_exp_f32 v51, v51
 buffer_load_dwordx4 v[92:95], v16, s[28:31], s64 offen offset:1024 sc1
 v_exp_f32 v52, v52
 v_exp_f32 v53, v53
 buffer_load_dwordx4 v[96:99], v20, s[28:31], s64 offen offset:2048 sc1
 v_cvt_pk_bf16_f32 v138, v48, v49
 v_cvt_pk_bf16_f32 v139, v50, v51
 v_cvt_pk_bf16_f32 v142, v52, v53
 v_mov_b32_dpp v140, v138 row_ror:8 row_mask:0xf bank_mask:0xf
 v_mov_b32_dpp v141, v139 row_ror:8 row_mask:0xf bank_mask:0xf
 v_mov_b32_dpp v143, v142 row_ror:8 row_mask:0xf bank_mask:0xf
 buffer_load_dwordx4 v[112:115], v18, s[16:19], s80 offen sc1
 v_add_f32 v54, v48, v49
 v_mfma_f32_16x16x32_bf16 v[64:67], v[126:129], v[138:141], 0
 v_add_f32 v55, v50, v51
 v_add_f32 v56, v52, v53
 v_mfma_f32_16x16x32_bf16 v[64:67], v[146:149], v[142:145], v[64:67]
 v_add_f32 v62, v54, v55
 v_fmac_f32 v62, v56, v26
 v_mfma_f32_16x16x32_bf16 v[68:71], v[130:133], v[138:141], 0
 buffer_load_dwordx2 v[116:117], v19, s[16:19], s80 offen sc1
 v_add_f32_dpp v62, v62, v62 row_ror:8 row_mask:0xf bank_mask:0xf
 v_mfma_f32_16x16x32_bf16 v[68:71], v[148:151], v[142:145], v[68:71]
 v_mov_b32 v63, v62
 s_cmp_lt_i32 s55, 0
 s_cbranch_scc1 fl_31
fl_32:
 v_mfma_f32_16x16x32_bf16 v[72:75], v[134:137], v[138:141], 0
 v_permlane32_swap_b32 v62, v63
 v_mfma_f32_16x16x32_bf16 v[72:75], v[150:153], v[142:145], v[72:75]
 v_add_f32 v62, v62, v63
 v_mov_b32 v63, v62
 ds_write_b128 v11, v[64:67] offset:0
 s_nop 0
 v_permlane16_swap_b32 v62, v63
 v_add_f32 v62, v62, v63
 v_rcp_f32 v62, v62
 ds_write_b128 v11, v[68:71] offset:1024
 s_mov_b64 exec, 0xff
 ds_write_b32 v22, v62
 s_mov_b64 exec, -1
 ds_write_b128 v11, v[72:75] offset:2048
 s_waitcnt lgkmcnt(0)
 s_barrier
 ds_read_b128 v[72:75], v23
 ds_read_b64 v[64:65], v12 offset:0
 ds_read_b64 v[66:67], v12 offset:3072
 ds_read_b64 v[68:69], v12 offset:6144
 ds_read_b64 v[70:71], v12 offset:9216
 s_waitcnt lgkmcnt(2)
 v_pk_mul_f32 v[64:65], v[64:65], v[72:73] op_sel_hi:[1,0]
 v_pk_fma_f32 v[64:65], v[66:67], v[72:73], v[64:65] op_sel:[0,1,0] op_sel_hi:[1,1,1]
 s_waitcnt lgkmcnt(0)
 v_pk_fma_f32 v[64:65], v[68:69], v[74:75], v[64:65] op_sel_hi:[1,0,1]
 v_pk_fma_f32 v[64:65], v[70:71], v[74:75], v[64:65] op_sel:[0,1,0] op_sel_hi:[1,1,1]
 v_cvt_pk_f16_f32 v68, v64, v65
 v_perm_b32 v68, s91, v68, v14
 buffer_atomic_pk_add_f16 v68, v13, s[4:7], s3 offen
 v_mov_b32 v76, v108
 v_mov_b32 v77, v109
 v_mov_b32 v78, v110
 v_mov_b32 v79, v111
 v_permlane32_swap_b32 v100, v104
 v_permlane32_swap_b32 v101, v105
 v_permlane32_swap_b32 v102, v106
 v_permlane32_swap_b32 v103, v107
 v_permlane32_swap_b32 v108, v76
 v_permlane32_swap_b32 v109, v77
 v_permlane32_swap_b32 v110, v78
 v_permlane32_swap_b32 v111, v79
 v_pk_add_f32 v[100:101], v[100:101], v[104:105]
 v_pk_add_f32 v[102:103], v[102:103], v[106:107]
 v_pk_add_f32 v[108:109], v[108:109], v[76:77]
 v_pk_add_f32 v[110:111], v[110:111], v[78:79]
 v_cvt_pk_bf16_f32 v80, v100, v101
 v_cvt_pk_bf16_f32 v82, v108, v109
 v_cvt_pk_bf16_f32 v81, v102, v103
 v_cvt_pk_bf16_f32 v83, v110, v111
 s_nop 0
 v_permlane16_swap_b32 v80, v82
 v_permlane16_swap_b32 v81, v83
 v_min_u32 v80, -2, v80
 s_mov_b64 exec, s[76:77]
 buffer_store_dwordx4 v[80:83], v15, s[24:27], s57 offen sc1
 s_mov_b64 exec, -1
 s_add_u32 s64, s64, 1310720
 s_add_u32 s52, s52, 1
 s_branch step_20
fl_25:
 buffer_load_dword v0, off, s[12:15], s79 sc1
 s_branch fl_26
A1_15:
 v_smfmac_f32_16x16x32_f16 v[40:43], v[36:37], a[16:19], v25
 v_smfmac_f32_16x16x32_f16 v[52:55], v[36:37], a[76:79], v25
 v_smfmac_f32_16x16x32_f16 v[44:47], v[36:37], a[36:39], v25
 v_smfmac_f32_16x16x32_f16 v[56:59], v[36:37], a[96:99], v25
 s_branch A2_24
pm_23:
 buffer_load_dwordx4 v[36:39], v4, s[4:7], s84 offen offset:2048 sc1
 buffer_load_dwordx4 v[28:31], v4, s[4:7], s84 offen offset:0 sc1
 buffer_load_dwordx4 v[32:35], v4, s[4:7], s84 offen offset:1024 sc1
 s_nop 7
 v_mov_b32 v40, 0
 v_mov_b32 v41, 0
 v_mov_b32 v42, 0
 v_mov_b32 v43, 0
 v_mov_b32 v52, 0
 v_mov_b32 v53, 0
 v_mov_b32 v54, 0
 v_mov_b32 v55, 0
 v_mov_b32 v44, 0
 v_mov_b32 v45, 0
 v_mov_b32 v46, 0
 v_mov_b32 v47, 0
 v_mov_b32 v56, 0
 v_mov_b32 v57, 0
 v_mov_b32 v58, 0
 v_mov_b32 v59, 0
 s_waitcnt vmcnt(0)
 v_bitop3_b32 v27, v31, v35, v39 bitop3:0x80
 v_perm_b32 v31, v35, v31, s89
 v_cmp_gt_u32 vcc, 0x48000000, v27
 v_mov_b32 v35, v38
 s_cbranch_vccz A1_15
pm_22:
 s_cmp_gt_u32 s52, 3
 s_cbranch_scc1 op_33
 v_readfirstlane_b32 s21, v0
 s_cmp_ge_u32 s21, s46
 s_cbranch_scc1 op_33
 buffer_load_dword v0, off, s[12:15], s79 sc1
 s_waitcnt vmcnt(0)
 v_readfirstlane_b32 s21, v0
 s_cmp_gt_u32 s21, s52
 s_cselect_b32 s21, s87, 0
 s_cmp_eq_u32 s21, 0
 s_cbranch_scc1 op_33
 s_mov_b32 s87, 0
 s_sub_u32 s21, s64, 1310720
 buffer_load_dwordx4 v[126:129], v16, s[28:31], s21 offen offset:0 sc1
 buffer_load_dwordx4 v[130:133], v16, s[28:31], s21 offen offset:1024 sc1
 buffer_load_dwordx4 v[134:137], v16, s[28:31], s21 offen offset:2048 sc1
op_33:
 buffer_load_dwordx4 v[36:39], v4, s[4:7], s84 offen offset:2048 sc1
 buffer_load_dwordx4 v[28:31], v4, s[4:7], s84 offen offset:0 sc1
 buffer_load_dwordx4 v[32:35], v4, s[4:7], s84 offen offset:1024 sc1
 s_add_u32 s54, s54, 1
 s_cmp_gt_u32 s54, 131072
 s_cbranch_scc1 end0
 s_waitcnt vmcnt(0)
 v_bitop3_b32 v27, v31, v35, v39 bitop3:0x80
 v_perm_b32 v31, v35, v31, s89
 v_cmp_gt_u32 vcc, 0x48000000, v27
 v_mov_b32 v35, v38
 s_cbranch_vccnz pm_22
 s_branch A1_15
psr_27:
 buffer_load_dwordx2 v[58:59], v9, s[8:11], s81 offen sc1
 buffer_load_dwordx4 v[40:43], v8, s[8:11], s81 offen offset:0 sc1
 buffer_load_dwordx4 v[44:47], v8, s[8:11], s81 offen offset:1024 sc1
 s_add_u32 s54, s54, 1
 s_cmp_gt_u32 s54, 131072
 s_cbranch_scc1 end0
 s_waitcnt vmcnt(2)
 v_xor_b32 v76, s88, v58
 s_nop 0
 v_permlane16_swap_b32 v58, v59
 v_fma_mix_f32 v60, v58, 1.0, v59 op_sel:[0,0,0] op_sel_hi:[1,0,1]
 v_fma_mix_f32 v61, v58, 1.0, v59 op_sel:[1,0,1] op_sel_hi:[1,0,1]
 v_mov_b32 v58, v60
 v_mov_b32 v59, v61
 s_nop 0
 v_permlane32_swap_b32 v58, v60
 v_permlane32_swap_b32 v59, v61
 v_add_f32 v52, v58, v60
 v_add_f32 v53, v59, v61
 v_max_f32 v79, v52, v53
 s_waitcnt vmcnt(0)
 v_pk_add_f16 v80, v40, v44
 v_pk_add_f16 v82, v42, v46
 v_pk_add_f16 v81, v41, v45
 v_pk_add_f16 v83, v43, v47
 v_permlane32_swap_b32 v80, v82
 v_bitop3_b32 v77, v40, v42, s88 bitop3:0x7e
 v_permlane32_swap_b32 v81, v83
 v_bitop3_b32 v78, v44, v46, s88 bitop3:0x7e
 v_fma_mix_f32 v48, v80, 1.0, v82 op_sel:[0,0,0] op_sel_hi:[1,0,1]
 v_or3_b32 v27, v76, v77, v78
 v_fma_mix_f32 v49, v80, 1.0, v82 op_sel:[1,0,1] op_sel_hi:[1,0,1]
 v_and_b32 v27, 1, v27
 v_fma_mix_f32 v50, v81, 1.0, v83 op_sel:[0,0,0] op_sel_hi:[1,0,1]
 v_cmp_ne_u32 vcc, 0, v27
 v_fma_mix_f32 v51, v81, 1.0, v83 op_sel:[1,0,1] op_sel_hi:[1,0,1]
 v_max3_f32 v62, v48, v49, v79
 s_cbranch_vccnz psr_27
 s_branch psj_28
kvw_29:
 s_mov_b32 s22, s87
 s_cmp_eq_u32 s52, 0
 s_cselect_b32 s55, 0, s55
 s_cselect_b32 s87, 1, 0
 s_cbranch_scc1 kvok_30
 v_mov_b32 v62, 0
 s_mov_b32 s101, 0
wf_34:
 buffer_load_dword v63, v62, s[12:15], s79 offen sc1
 s_add_u32 s101, s101, 1
 s_cmp_gt_u32 s101, 131072
 s_cbranch_scc1 end0
 s_waitcnt vmcnt(0)
 v_readfirstlane_b32 s100, v63
 s_cmp_ge_u32 s100, s46
 s_cbranch_scc1 wf_35
 s_sleep 3
 s_branch wf_34
wf_35:
 s_cmp_eq_u32 s22, 0
 s_cbranch_scc1 kvok_30
 s_sub_u32 s21, s64, 1310720
 buffer_load_dwordx4 v[126:129], v16, s[28:31], s21 offen offset:0 sc1
 buffer_load_dwordx4 v[130:133], v16, s[28:31], s21 offen offset:1024 sc1
 buffer_load_dwordx4 v[134:137], v16, s[28:31], s21 offen offset:2048 sc1
 s_waitcnt vmcnt(0)
 s_branch kvok_30
fl_31:
 buffer_load_dword v0, off, s[12:15], s79 sc1
 s_branch fl_32
last_21:
 s_waitcnt lgkmcnt(10)
 v_smfmac_f32_16x16x64_f16 v[100:103], v[28:31], a[120:127], v25
 v_smfmac_f32_16x16x64_f16 v[104:107], v[28:31], a[128:135], v25
 v_smfmac_f32_16x16x64_f16 v[108:111], v[28:31], a[136:143], v25
 v_smfmac_f32_16x16x64_f16 v[100:103], v[32:35], a[144:151], v25
 v_smfmac_f32_16x16x64_f16 v[104:107], v[32:35], a[152:159], v25
 v_smfmac_f32_16x16x64_f16 v[108:111], v[32:35], a[160:167], v25
 s_waitcnt lgkmcnt(7)
 v_smfmac_f32_16x16x64_f16 v[100:103], v[64:67], a[168:175], v25
 v_smfmac_f32_16x16x64_f16 v[104:107], v[64:67], a[176:183], v25
 v_smfmac_f32_16x16x64_f16 v[108:111], v[64:67], a[184:191], v25
 v_smfmac_f32_16x16x64_f16 v[100:103], v[68:71], a[192:199], v25
 v_smfmac_f32_16x16x64_f16 v[104:107], v[68:71], a[200:207], v25
 v_smfmac_f32_16x16x64_f16 v[108:111], v[68:71], a[208:215], v25
 v_smfmac_f32_16x16x64_f16 v[100:103], v[72:75], a[216:223], v25
 v_smfmac_f32_16x16x64_f16 v[104:107], v[72:75], a[224:231], v25
 v_smfmac_f32_16x16x64_f16 v[108:111], v[72:75], a[232:239], v25
 s_waitcnt lgkmcnt(4)
 v_smfmac_f32_16x16x64_f16 v[100:103], v[76:79], a[240:247], v25
 v_smfmac_f32_16x16x64_f16 v[104:107], v[76:79], a[248:255], v25
 v_smfmac_f32_16x16x64_f16 v[108:111], v[76:79], v[152:159], v25
 v_smfmac_f32_16x16x64_f16 v[100:103], v[80:83], v[160:167], v25
 v_smfmac_f32_16x16x64_f16 v[104:107], v[80:83], v[168:175], v25
 v_smfmac_f32_16x16x64_f16 v[108:111], v[80:83], v[176:183], v25
 v_smfmac_f32_16x16x64_f16 v[100:103], v[84:87], v[184:191], v25
 v_smfmac_f32_16x16x64_f16 v[104:107], v[84:87], v[192:199], v25
 v_smfmac_f32_16x16x64_f16 v[108:111], v[84:87], v[200:207], v25
 s_waitcnt lgkmcnt(0)
 v_smfmac_f32_16x16x64_f16 v[100:103], v[88:91], v[208:215], v25
 v_smfmac_f32_16x16x64_f16 v[104:107], v[88:91], v[216:223], v25
 v_smfmac_f32_16x16x64_f16 v[108:111], v[88:91], v[224:231], v25
 v_smfmac_f32_16x16x64_f16 v[100:103], v[92:95], v[232:239], v25
 v_smfmac_f32_16x16x64_f16 v[104:107], v[92:95], v[240:247], v25
 v_smfmac_f32_16x16x64_f16 v[108:111], v[92:95], v[248:255], v25
 s_nop 7
 v_mov_b32 v76, v108
 v_mov_b32 v77, v109
 v_mov_b32 v78, v110
 v_mov_b32 v79, v111
 v_permlane32_swap_b32 v100, v104
 v_permlane32_swap_b32 v101, v105
 v_permlane32_swap_b32 v102, v106
 v_permlane32_swap_b32 v103, v107
 v_permlane32_swap_b32 v108, v76
 v_permlane32_swap_b32 v109, v77
 v_permlane32_swap_b32 v110, v78
 v_permlane32_swap_b32 v111, v79
 v_pk_add_f32 v[100:101], v[100:101], v[104:105]
 v_pk_add_f32 v[102:103], v[102:103], v[106:107]
 v_pk_add_f32 v[108:109], v[108:109], v[76:77]
 v_pk_add_f32 v[110:111], v[110:111], v[78:79]
 v_cvt_pk_bf16_f32 v80, v100, v101
 v_cvt_pk_bf16_f32 v82, v108, v109
 v_cvt_pk_bf16_f32 v81, v102, v103
 v_cvt_pk_bf16_f32 v83, v110, v111
 s_nop 0
 v_permlane16_swap_b32 v80, v82
 v_permlane16_swap_b32 v81, v83
 v_min_u32 v80, -2, v80
 s_mov_b64 exec, s[76:77]
 buffer_store_dwordx4 v[80:83], v15, s[24:27], s57 offen sc1
 s_mov_b64 exec, -1
 v_mov_b32 v246, 80
 v_mov_b32 v247, 1
 s_mov_b64 exec, 1
 buffer_atomic_add v247, v246, s[32:35], 0 offen sc0 sc1
 s_mov_b64 exec, -1
 s_branch chain_done
step_36:
 s_and_b32 s21, s52, 3
 s_mul_i32 s81, s21, 540672
 s_mul_i32 s84, s21, 0x88000
 s_and_b32 s84, s84, 0x108000
 s_add_u32 s21, s52, 3
 s_and_b32 s21, s21, 3
 s_mul_i32 s83, s21, 0x88000
 s_and_b32 s83, s83, 0x108000
 s_add_u32 s21, s52, 1
 s_and_b32 s22, s21, 3
 s_mul_i32 s3, s22, 0x88000
 s_and_b32 s3, s3, 0x108000
 s_mul_i32 s80, s21, 393216
 s_add_u32 s46, s21, 1
 s_min_u32 s46, s46, 64
 s_mov_b32 s47, s57
 s_mov_b32 s78, s85
 s_lshr_b32 s21, s52, 1
 s_bitcmp1_b32 s37, s21
 s_cselect_b32 s21, 8192, 0
 s_lshl_b32 s22, s52, 20
 s_or_b32 s22, s22, s21
 s_cmp_ge_u32 s52, 40
 s_cselect_b32 s57, 8192, 0
 s_xor_b32 s57, s57, s22
 s_xor_b32 s85, s22, 8192
 s_bfe_u32 s88, s52, 0x10002
 s_max_u32 s67, s52, 1
 s_sub_u32 s67, s67, 1
 v_mov_b32 v40, 0
 v_mov_b32 v41, 0
 v_mov_b32 v42, 0
 v_mov_b32 v43, 0
 v_mov_b32 v44, 0
 v_mov_b32 v45, 0
 v_mov_b32 v46, 0
 v_mov_b32 v47, 0
 v_mov_b32 v48, 0
 v_mov_b32 v49, 0
 v_mov_b32 v50, 0
 v_mov_b32 v51, 0
 v_mov_b32 v52, 0
 v_mov_b32 v53, 0
 v_mov_b32 v54, 0
 v_mov_b32 v55, 0
 v_mov_b32 v56, 0
 v_mov_b32 v57, 0
 v_mov_b32 v58, 0
 v_mov_b32 v59, 0
 v_mov_b32 v60, 0
 v_mov_b32 v61, 0
 v_mov_b32 v62, 0
 v_mov_b32 v63, 0
 v_mov_b32 v100, 0
 v_mov_b32 v101, 0
 v_mov_b32 v102, 0
 v_mov_b32 v103, 0
 v_mov_b32 v104, 0
 v_mov_b32 v105, 0
 v_mov_b32 v106, 0
 v_mov_b32 v107, 0
 v_mov_b32 v108, 0
 v_mov_b32 v109, 0
 v_mov_b32 v110, 0
 v_mov_b32 v111, 0
 s_sleep 4
 s_nop 3
 v_readfirstlane_b32 s21, v0
 s_cmp_lt_u32 s21, s46
 s_cselect_b32 s55, s55, 0
 s_cmp_lt_i32 s55, 0
 s_cbranch_scc1 fl_41
fl_42:
 s_mov_b32 s54, 0
 buffer_load_dwordx4 v[36:39], v4, s[4:7], s84 offen offset:2048 sc1
 buffer_load_dwordx4 v[28:31], v4, s[4:7], s84 offen offset:0 sc1
 buffer_load_dwordx4 v[32:35], v4, s[4:7], s84 offen offset:1024 sc1
 s_waitcnt vmcnt(3)
 v_mov_b32 v126, v88
 v_mov_b32 v127, v89
 v_mov_b32 v128, v90
 v_mov_b32 v129, v91
 v_mov_b32 v130, v92
 v_mov_b32 v131, v93
 v_mov_b32 v132, v94
 v_mov_b32 v133, v95
 v_mov_b32 v134, v96
 v_mov_b32 v135, v97
 v_mov_b32 v136, v98
 v_mov_b32 v137, v99
 s_waitcnt vmcnt(2)
 v_smfmac_f32_16x16x32_f16 v[40:43], v[36:37], a[16:19], v25
 v_smfmac_f32_16x16x32_f16 v[52:55], v[36:37], a[76:79], v25
 v_smfmac_f32_16x16x32_f16 v[44:47], v[36:37], a[36:39], v25
 s_waitcnt vmcnt(0)
 v_bitop3_b32 v27, v31, v35, v39 bitop3:0x80
 v_perm_b32 v31, v35, v31, s89
 v_cmp_gt_u32 vcc, 0x48000000, v27
 v_mov_b32 v35, v38
 v_smfmac_f32_16x16x32_f16 v[56:59], v[36:37], a[96:99], v25
 s_cbranch_vccnz pm_39
A2_40:
 v_smfmac_f32_16x16x64_f16 v[40:43], v[28:31], a[0:7], v25
 ds_write_b128 v10, v[28:31]
 v_smfmac_f32_16x16x64_f16 v[40:43], v[32:35], a[8:15], v25
 ds_write_b128 v10, v[32:35] offset:1024
 v_smfmac_f32_16x16x64_f16 v[52:55], v[28:31], a[60:67], v25
 ds_write_b64 v10, v[36:37] offset:2048
 v_smfmac_f32_16x16x64_f16 v[52:55], v[32:35], a[68:75], v25
 v_cvt_pk_f16_f32 v40, v40, v41
 v_cvt_pk_f16_f32 v41, v42, v43
 v_smfmac_f32_16x16x32_f16 v[48:51], v[36:37], a[56:59], v25
 v_smfmac_f32_16x16x32_f16 v[60:63], v[36:37], a[116:119], v25
 v_smfmac_f32_16x16x64_f16 v[44:47], v[28:31], a[20:27], v25
 v_cvt_pk_f16_f32 v52, v52, v53
 v_cvt_pk_f16_f32 v53, v54, v55
 s_nop 0
 v_smfmac_f32_16x16x64_f16 v[44:47], v[32:35], a[28:35], v25
 v_permlane32_swap_b32 v40, v52
 v_smfmac_f32_16x16x64_f16 v[56:59], v[28:31], a[80:87], v25
 v_permlane32_swap_b32 v41, v53
 v_pk_add_f16 v40, v40, v52
 v_smfmac_f32_16x16x64_f16 v[56:59], v[32:35], a[88:95], v25
 v_pk_add_f16 v41, v41, v53
 v_smfmac_f32_16x16x64_f16 v[48:51], v[28:31], a[40:47], v25
 ds_write_b64 v5, v[40:41] offset:0
 v_smfmac_f32_16x16x64_f16 v[48:51], v[32:35], a[48:55], v25
 v_cvt_pk_f16_f32 v44, v44, v45
 v_cvt_pk_f16_f32 v45, v46, v47
 v_cvt_pk_f16_f32 v56, v56, v57
 v_smfmac_f32_16x16x64_f16 v[60:63], v[28:31], a[100:107], v25
 v_cvt_pk_f16_f32 v57, v58, v59
 s_nop 0
 v_smfmac_f32_16x16x64_f16 v[60:63], v[32:35], a[108:115], v25
 v_permlane32_swap_b32 v44, v56
 v_permlane32_swap_b32 v45, v57
 v_pk_add_f16 v44, v44, v56
 v_pk_add_f16 v45, v45, v57
 ds_write_b64 v5, v[44:45] offset:640
 v_cvt_pk_f16_f32 v48, v48, v49
 v_cvt_pk_f16_f32 v49, v50, v51
 v_cvt_pk_f16_f32 v60, v60, v61
 v_cvt_pk_f16_f32 v61, v62, v63
 s_nop 0
 v_permlane32_swap_b32 v48, v60
 v_permlane32_swap_b32 v49, v61
 v_pk_add_f16 v48, v48, v60
 v_pk_add_f16 v49, v49, v61
 ds_write_b64 v5, v[48:49] offset:1280
 s_waitcnt lgkmcnt(0) vmcnt(0)
 s_barrier
 ds_read_b64_tr_b16 v[40:41], v21 offset:0
 ds_read_b64_tr_b16 v[42:43], v21 offset:1920
 ds_read_b64_tr_b16 v[44:45], v21 offset:640
 ds_read_b64_tr_b16 v[46:47], v21 offset:2560
 ds_read_b64_tr_b16 v[48:49], v21 offset:1280
 ds_read_b64_tr_b16 v[50:51], v21 offset:3200
 s_waitcnt lgkmcnt(4)
 v_fma_mix_f32 v52, v40, 1.0, v42 op_sel:[0,0,0] op_sel_hi:[1,0,1]
 v_fma_mix_f32 v53, v40, 1.0, v42 op_sel:[1,0,1] op_sel_hi:[1,0,1]
 v_fma_mix_f32 v54, v41, 1.0, v43 op_sel:[0,0,0] op_sel_hi:[1,0,1]
 v_fma_mix_f32 v55, v41, 1.0, v43 op_sel:[1,0,1] op_sel_hi:[1,0,1]
 v_add_f32_dpp v56, v52, v52 row_ror:8 row_mask:0xf bank_mask:0xf
 v_add_f32_dpp v57, v53, v53 row_ror:8 row_mask:0xf bank_mask:0xf
 v_add_f32_dpp v58, v54, v54 row_ror:8 row_mask:0xf bank_mask:0xf
 v_add_f32_dpp v59, v55, v55 row_ror:8 row_mask:0xf bank_mask:0xf
 v_cvt_pk_bf16_f32 v118, v56, v57
 v_cvt_pk_bf16_f32 v119, v58, v59
 s_waitcnt lgkmcnt(2)
 v_fma_mix_f32 v52, v44, 1.0, v46 op_sel:[0,0,0] op_sel_hi:[1,0,1]
 v_fma_mix_f32 v53, v44, 1.0, v46 op_sel:[1,0,1] op_sel_hi:[1,0,1]
 v_fma_mix_f32 v54, v45, 1.0, v47 op_sel:[0,0,0] op_sel_hi:[1,0,1]
 v_fma_mix_f32 v55, v45, 1.0, v47 op_sel:[1,0,1] op_sel_hi:[1,0,1]
 v_add_f32_dpp v56, v52, v52 row_ror:8 row_mask:0xf bank_mask:0xf
 v_add_f32_dpp v57, v53, v53 row_ror:8 row_mask:0xf bank_mask:0xf
 v_add_f32_dpp v58, v54, v54 row_ror:8 row_mask:0xf bank_mask:0xf
 v_add_f32_dpp v59, v55, v55 row_ror:8 row_mask:0xf bank_mask:0xf
 v_cvt_pk_bf16_f32 v120, v56, v57
 v_cvt_pk_bf16_f32 v121, v58, v59
 s_waitcnt lgkmcnt(0)
 v_fma_mix_f32 v52, v48, 1.0, v50 op_sel:[0,0,0] op_sel_hi:[1,0,1]
 v_fma_mix_f32 v53, v48, 1.0, v50 op_sel:[1,0,1] op_sel_hi:[1,0,1]
 v_fma_mix_f32 v54, v49, 1.0, v51 op_sel:[0,0,0] op_sel_hi:[1,0,1]
 v_fma_mix_f32 v55, v49, 1.0, v51 op_sel:[1,0,1] op_sel_hi:[1,0,1]
 v_mfma_f32_16x16x32_bf16 v[40:43], v[112:115], v[118:121], 0
 v_add_f32_dpp v56, v52, v52 row_ror:8 row_mask:0xf bank_mask:0xf
 v_add_f32_dpp v57, v53, v53 row_ror:8 row_mask:0xf bank_mask:0xf
 v_add_f32_dpp v58, v54, v54 row_ror:8 row_mask:0xf bank_mask:0xf
 v_add_f32_dpp v59, v55, v55 row_ror:8 row_mask:0xf bank_mask:0xf
 v_cvt_pk_bf16_f32 v122, v56, v57
 v_cvt_pk_bf16_f32 v123, v58, v59
 s_nop 1
 v_mfma_f32_16x16x32_bf16 v[40:43], v[116:119], v[122:125], v[40:43]
 ds_read_b128 v[28:31], v16 offset:24576
 ds_read_b128 v[32:35], v16 offset:25600
 ds_read_b128 v[64:67], v16 offset:27648
 ds_read_b128 v[68:71], v16 offset:28672
 ds_read_b128 v[72:75], v16 offset:30720
 ds_read_b128 v[76:79], v16 offset:31744
 s_nop 0
 s_mov_b64 exec, s[74:75]
 v_cvt_pk_f16_f32 v44, v40, v41
 v_cvt_pk_f16_f32 v45, v42, v43
 v_and_or_b32 v44, v44, -2, s88
 buffer_store_dwordx2 v[44:45], v7, s[8:11], s81 offen
 s_mov_b64 exec, -1
 ds_read_b128 v[80:83], v16 offset:33792
 ds_read_b128 v[84:87], v16 offset:34816
 ds_read_b64 v[88:89], v16 offset:26624
 ds_read_b64 v[90:91], v16 offset:29696
 ds_read_b64 v[92:93], v16 offset:32768
 ds_read_b64 v[94:95], v16 offset:35840
 s_cmp_eq_u32 s52, 63
 s_cbranch_scc1 last_37
 s_waitcnt lgkmcnt(10)
 v_smfmac_f32_16x16x64_f16 v[100:103], v[28:31], a[120:127], v25
 v_smfmac_f32_16x16x64_f16 v[104:107], v[28:31], a[128:135], v25
 v_smfmac_f32_16x16x64_f16 v[108:111], v[28:31], a[136:143], v25
 s_mov_b32 s54, 0
 v_smfmac_f32_16x16x64_f16 v[100:103], v[32:35], a[144:151], v25
 v_readfirstlane_b32 s21, v0
 v_smfmac_f32_16x16x64_f16 v[104:107], v[32:35], a[152:159], v25
 s_add_u32 s22, s46, 3
 v_smfmac_f32_16x16x64_f16 v[108:111], v[32:35], a[160:167], v25
 s_min_u32 s22, s22, 64
 s_waitcnt lgkmcnt(7)
 v_smfmac_f32_16x16x64_f16 v[100:103], v[64:67], a[168:175], v25
 s_sub_u32 s55, s21, s22
 v_smfmac_f32_16x16x64_f16 v[104:107], v[64:67], a[176:183], v25
 s_sub_u32 s56, s21, s46
 v_smfmac_f32_16x16x64_f16 v[108:111], v[64:67], a[184:191], v25
 v_smfmac_f32_16x16x64_f16 v[100:103], v[68:71], a[192:199], v25
 v_smfmac_f32_16x16x64_f16 v[104:107], v[68:71], a[200:207], v25
 v_smfmac_f32_16x16x64_f16 v[108:111], v[68:71], a[208:215], v25
 v_smfmac_f32_16x16x64_f16 v[100:103], v[72:75], a[216:223], v25
 v_smfmac_f32_16x16x64_f16 v[104:107], v[72:75], a[224:231], v25
 v_smfmac_f32_16x16x64_f16 v[108:111], v[72:75], a[232:239], v25
 s_waitcnt lgkmcnt(4)
 v_smfmac_f32_16x16x64_f16 v[100:103], v[76:79], a[240:247], v25
 v_smfmac_f32_16x16x64_f16 v[104:107], v[76:79], a[248:255], v25
 v_smfmac_f32_16x16x64_f16 v[108:111], v[76:79], v[152:159], v25
 v_smfmac_f32_16x16x64_f16 v[100:103], v[80:83], v[160:167], v25
 buffer_load_dwordx2 v[58:59], v9, s[8:11], s81 offen sc1
 buffer_load_dwordx4 v[40:43], v8, s[8:11], s81 offen offset:0 sc1
 buffer_load_dwordx4 v[44:47], v8, s[8:11], s81 offen offset:1024 sc1
 v_smfmac_f32_16x16x64_f16 v[104:107], v[80:83], v[168:175], v25
 v_smfmac_f32_16x16x64_f16 v[108:111], v[80:83], v[176:183], v25
 v_smfmac_f32_16x16x64_f16 v[100:103], v[84:87], v[184:191], v25
 v_smfmac_f32_16x16x64_f16 v[104:107], v[84:87], v[192:199], v25
 v_smfmac_f32_16x16x64_f16 v[108:111], v[84:87], v[200:207], v25
 s_waitcnt lgkmcnt(0)
 v_smfmac_f32_16x16x64_f16 v[100:103], v[88:91], v[208:215], v25
 v_smfmac_f32_16x16x64_f16 v[104:107], v[88:91], v[216:223], v25
 v_smfmac_f32_16x16x64_f16 v[108:111], v[88:91], v[224:231], v25
 v_smfmac_f32_16x16x64_f16 v[100:103], v[92:95], v[232:239], v25
 v_smfmac_f32_16x16x64_f16 v[104:107], v[92:95], v[240:247], v25
 v_smfmac_f32_16x16x64_f16 v[108:111], v[92:95], v[248:255], v25
 s_cmp_lt_i32 s56, 0
 s_cbranch_scc1 kvw_45
kvok_46:
 s_waitcnt vmcnt(2)
 v_xor_b32 v76, s88, v58
 s_nop 0
 v_permlane16_swap_b32 v58, v59
 v_fma_mix_f32 v60, v58, 1.0, v59 op_sel:[0,0,0] op_sel_hi:[1,0,1]
 v_fma_mix_f32 v61, v58, 1.0, v59 op_sel:[1,0,1] op_sel_hi:[1,0,1]
 v_mov_b32 v58, v60
 v_mov_b32 v59, v61
 s_nop 0
 v_permlane32_swap_b32 v58, v60
 v_permlane32_swap_b32 v59, v61
 v_add_f32 v52, v58, v60
 v_add_f32 v53, v59, v61
 v_max_f32 v79, v52, v53
 s_waitcnt vmcnt(0)
 v_pk_add_f16 v80, v40, v44
 v_pk_add_f16 v82, v42, v46
 v_pk_add_f16 v81, v41, v45
 v_pk_add_f16 v83, v43, v47
 v_permlane32_swap_b32 v80, v82
 v_bitop3_b32 v77, v40, v42, s88 bitop3:0x7e
 v_permlane32_swap_b32 v81, v83
 v_bitop3_b32 v78, v44, v46, s88 bitop3:0x7e
 v_fma_mix_f32 v48, v80, 1.0, v82 op_sel:[0,0,0] op_sel_hi:[1,0,1]
 v_or3_b32 v27, v76, v77, v78
 v_fma_mix_f32 v49, v80, 1.0, v82 op_sel:[1,0,1] op_sel_hi:[1,0,1]
 v_and_b32 v27, 1, v27
 v_fma_mix_f32 v50, v81, 1.0, v83 op_sel:[0,0,0] op_sel_hi:[1,0,1]
 v_cmp_ne_u32 vcc, 0, v27
 v_fma_mix_f32 v51, v81, 1.0, v83 op_sel:[1,0,1] op_sel_hi:[1,0,1]
 v_max3_f32 v62, v48, v49, v79
 s_cbranch_vccnz psr_43
psj_44:
 v_max3_f32 v62, v62, v50, v51
 v_cvt_pk_bf16_f32 v146, v100, v101
 v_cvt_pk_bf16_f32 v147, v102, v103
 v_max_f32_dpp v62, v62, v62 row_ror:8 row_mask:0xf bank_mask:0xf
 v_mov_b32 v63, v62
 v_cvt_pk_bf16_f32 v148, v104, v105
 v_cvt_pk_bf16_f32 v149, v106, v107
 v_permlane32_swap_b32 v62, v63
 v_max_f32 v62, v62, v63
 v_mov_b32 v63, v62
 v_cvt_pk_bf16_f32 v150, v108, v109
 v_cvt_pk_bf16_f32 v151, v110, v111
 v_permlane16_swap_b32 v62, v63
 v_max_f32 v62, v62, v63
 v_mul_f32 v62, s86, v62
 v_fma_f32 v48, v48, s86, -v62
 v_fma_f32 v49, v49, s86, -v62
 v_fma_f32 v50, v50, s86, -v62
 v_fma_f32 v51, v51, s86, -v62
 v_fma_f32 v52, v52, s86, -v62
 v_fma_f32 v53, v53, s86, -v62
 v_exp_f32 v48, v48
 v_exp_f32 v49, v49
 buffer_load_dwordx4 v[88:91], v17, s[28:31], s64 offen offset:0 sc1
 v_exp_f32 v50, v50
 v_exp_f32 v51, v51
 buffer_load_dwordx4 v[92:95], v16, s[28:31], s64 offen offset:1024 sc1
 v_exp_f32 v52, v52
 v_exp_f32 v53, v53
 buffer_load_dwordx4 v[96:99], v20, s[28:31], s64 offen offset:2048 sc1
 v_cvt_pk_bf16_f32 v138, v48, v49
 v_cvt_pk_bf16_f32 v139, v50, v51
 v_cvt_pk_bf16_f32 v142, v52, v53
 v_mov_b32_dpp v140, v138 row_ror:8 row_mask:0xf bank_mask:0xf
 v_mov_b32_dpp v141, v139 row_ror:8 row_mask:0xf bank_mask:0xf
 v_mov_b32_dpp v143, v142 row_ror:8 row_mask:0xf bank_mask:0xf
 buffer_load_dwordx4 v[112:115], v18, s[16:19], s80 offen sc1
 v_add_f32 v54, v48, v49
 v_mfma_f32_16x16x32_bf16 v[64:67], v[126:129], v[138:141], 0
 v_add_f32 v55, v50, v51
 v_add_f32 v56, v52, v53
 v_mfma_f32_16x16x32_bf16 v[64:67], v[146:149], v[142:145], v[64:67]
 v_add_f32 v62, v54, v55
 v_fmac_f32 v62, v56, v26
 v_mfma_f32_16x16x32_bf16 v[68:71], v[130:133], v[138:141], 0
 buffer_load_dwordx2 v[116:117], v19, s[16:19], s80 offen sc1
 v_add_f32_dpp v62, v62, v62 row_ror:8 row_mask:0xf bank_mask:0xf
 v_mfma_f32_16x16x32_bf16 v[68:71], v[148:151], v[142:145], v[68:71]
 v_mov_b32 v63, v62
 s_cmp_lt_i32 s55, 0
 s_cbranch_scc1 fl_47
fl_48:
 v_mfma_f32_16x16x32_bf16 v[72:75], v[134:137], v[138:141], 0
 v_permlane32_swap_b32 v62, v63
 v_mfma_f32_16x16x32_bf16 v[72:75], v[150:153], v[142:145], v[72:75]
 v_add_f32 v62, v62, v63
 v_mov_b32 v63, v62
 ds_write_b128 v11, v[64:67] offset:0
 s_nop 0
 v_permlane16_swap_b32 v62, v63
 v_add_f32 v62, v62, v63
 v_rcp_f32 v62, v62
 ds_write_b128 v11, v[68:71] offset:1024
 s_mov_b64 exec, 0xff
 ds_write_b32 v22, v62
 s_mov_b64 exec, -1
 ds_write_b128 v11, v[72:75] offset:2048
 s_waitcnt lgkmcnt(0)
 s_barrier
 ds_read_b128 v[72:75], v23
 ds_read_b64 v[64:65], v12 offset:0
 ds_read_b64 v[66:67], v12 offset:3072
 ds_read_b64 v[68:69], v12 offset:6144
 ds_read_b64 v[70:71], v12 offset:9216
 s_waitcnt lgkmcnt(2)
 v_pk_mul_f32 v[64:65], v[64:65], v[72:73] op_sel_hi:[1,0]
 v_pk_fma_f32 v[64:65], v[66:67], v[72:73], v[64:65] op_sel:[0,1,0] op_sel_hi:[1,1,1]
 s_waitcnt lgkmcnt(0)
 v_pk_fma_f32 v[64:65], v[68:69], v[74:75], v[64:65] op_sel_hi:[1,0,1]
 v_pk_fma_f32 v[64:65], v[70:71], v[74:75], v[64:65] op_sel:[0,1,0] op_sel_hi:[1,1,1]
 v_cvt_pk_f16_f32 v68, v64, v65
 v_perm_b32 v68, s91, v68, v14
 buffer_atomic_pk_add_f16 v68, v13, s[4:7], s3 offen
 v_mov_b32 v76, v108
 v_mov_b32 v77, v109
 v_mov_b32 v78, v110
 v_mov_b32 v79, v111
 v_permlane32_swap_b32 v100, v104
 v_permlane32_swap_b32 v101, v105
 v_permlane32_swap_b32 v102, v106
 v_permlane32_swap_b32 v103, v107
 v_permlane32_swap_b32 v108, v76
 v_permlane32_swap_b32 v109, v77
 v_permlane32_swap_b32 v110, v78
 v_permlane32_swap_b32 v111, v79
 v_pk_add_f32 v[100:101], v[100:101], v[104:105]
 v_pk_add_f32 v[102:103], v[102:103], v[106:107]
 v_pk_add_f32 v[108:109], v[108:109], v[76:77]
 v_pk_add_f32 v[110:111], v[110:111], v[78:79]
 v_cvt_pk_bf16_f32 v80, v100, v101
 v_cvt_pk_bf16_f32 v82, v108, v109
 v_cvt_pk_bf16_f32 v81, v102, v103
 v_cvt_pk_bf16_f32 v83, v110, v111
 s_nop 0
 v_permlane16_swap_b32 v80, v82
 v_permlane16_swap_b32 v81, v83
 v_min_u32 v80, -2, v80
 s_mov_b64 exec, s[76:77]
 buffer_store_dwordx4 v[80:83], v15, s[24:27], s57 offen sc1
 s_mov_b64 exec, -1
 s_add_u32 s64, s64, 1310720
 s_add_u32 s52, s52, 1
 s_branch step_36
fl_41:
 buffer_load_dword v0, off, s[12:15], s79 sc1
 s_branch fl_42
A1_16:
 v_smfmac_f32_16x16x32_f16 v[40:43], v[36:37], a[16:19], v25
 v_smfmac_f32_16x16x32_f16 v[52:55], v[36:37], a[76:79], v25
 v_smfmac_f32_16x16x32_f16 v[44:47], v[36:37], a[36:39], v25
 v_smfmac_f32_16x16x32_f16 v[56:59], v[36:37], a[96:99], v25
 s_branch A2_40
pm_39:
 buffer_load_dwordx4 v[36:39], v4, s[4:7], s84 offen offset:2048 sc1
 buffer_load_dwordx4 v[28:31], v4, s[4:7], s84 offen offset:0 sc1
 buffer_load_dwordx4 v[32:35], v4, s[4:7], s84 offen offset:1024 sc1
 s_nop 7
 v_mov_b32 v40, 0
 v_mov_b32 v41, 0
 v_mov_b32 v42, 0
 v_mov_b32 v43, 0
 v_mov_b32 v52, 0
 v_mov_b32 v53, 0
 v_mov_b32 v54, 0
 v_mov_b32 v55, 0
 v_mov_b32 v44, 0
 v_mov_b32 v45, 0
 v_mov_b32 v46, 0
 v_mov_b32 v47, 0
 v_mov_b32 v56, 0
 v_mov_b32 v57, 0
 v_mov_b32 v58, 0
 v_mov_b32 v59, 0
 s_waitcnt vmcnt(0)
 v_bitop3_b32 v27, v31, v35, v39 bitop3:0x80
 v_perm_b32 v31, v35, v31, s89
 v_cmp_gt_u32 vcc, 0x48000000, v27
 v_mov_b32 v35, v38
 s_cbranch_vccz A1_16
pm_38:
 s_cmp_gt_u32 s52, 3
 s_cbranch_scc1 op_49
 v_readfirstlane_b32 s21, v0
 s_cmp_ge_u32 s21, s46
 s_cbranch_scc1 op_49
 buffer_load_dword v0, off, s[12:15], s79 sc1
 s_waitcnt vmcnt(0)
 v_readfirstlane_b32 s21, v0
 s_cmp_gt_u32 s21, s52
 s_cselect_b32 s21, s87, 0
 s_cmp_eq_u32 s21, 0
 s_cbranch_scc1 op_49
 s_mov_b32 s87, 0
 s_sub_u32 s21, s64, 1310720
 buffer_load_dwordx4 v[126:129], v16, s[28:31], s21 offen offset:0 sc1
 buffer_load_dwordx4 v[130:133], v16, s[28:31], s21 offen offset:1024 sc1
 buffer_load_dwordx4 v[134:137], v16, s[28:31], s21 offen offset:2048 sc1
op_49:
 buffer_load_dwordx4 v[36:39], v4, s[4:7], s84 offen offset:2048 sc1
 buffer_load_dwordx4 v[28:31], v4, s[4:7], s84 offen offset:0 sc1
 buffer_load_dwordx4 v[32:35], v4, s[4:7], s84 offen offset:1024 sc1
 s_add_u32 s54, s54, 1
 s_cmp_gt_u32 s54, 131072
 s_cbranch_scc1 end0
 s_waitcnt vmcnt(0)
 v_bitop3_b32 v27, v31, v35, v39 bitop3:0x80
 v_perm_b32 v31, v35, v31, s89
 v_cmp_gt_u32 vcc, 0x48000000, v27
 v_mov_b32 v35, v38
 s_cbranch_vccnz pm_38
 s_branch A1_16
psr_43:
 buffer_load_dwordx2 v[58:59], v9, s[8:11], s81 offen sc1
 buffer_load_dwordx4 v[40:43], v8, s[8:11], s81 offen offset:0 sc1
 buffer_load_dwordx4 v[44:47], v8, s[8:11], s81 offen offset:1024 sc1
 s_add_u32 s54, s54, 1
 s_cmp_gt_u32 s54, 131072
 s_cbranch_scc1 end0
 s_waitcnt vmcnt(2)
 v_xor_b32 v76, s88, v58
 s_nop 0
 v_permlane16_swap_b32 v58, v59
 v_fma_mix_f32 v60, v58, 1.0, v59 op_sel:[0,0,0] op_sel_hi:[1,0,1]
 v_fma_mix_f32 v61, v58, 1.0, v59 op_sel:[1,0,1] op_sel_hi:[1,0,1]
 v_mov_b32 v58, v60
 v_mov_b32 v59, v61
 s_nop 0
 v_permlane32_swap_b32 v58, v60
 v_permlane32_swap_b32 v59, v61
 v_add_f32 v52, v58, v60
 v_add_f32 v53, v59, v61
 v_max_f32 v79, v52, v53
 s_waitcnt vmcnt(0)
 v_pk_add_f16 v80, v40, v44
 v_pk_add_f16 v82, v42, v46
 v_pk_add_f16 v81, v41, v45
 v_pk_add_f16 v83, v43, v47
 v_permlane32_swap_b32 v80, v82
 v_bitop3_b32 v77, v40, v42, s88 bitop3:0x7e
 v_permlane32_swap_b32 v81, v83
 v_bitop3_b32 v78, v44, v46, s88 bitop3:0x7e
 v_fma_mix_f32 v48, v80, 1.0, v82 op_sel:[0,0,0] op_sel_hi:[1,0,1]
 v_or3_b32 v27, v76, v77, v78
 v_fma_mix_f32 v49, v80, 1.0, v82 op_sel:[1,0,1] op_sel_hi:[1,0,1]
 v_and_b32 v27, 1, v27
 v_fma_mix_f32 v50, v81, 1.0, v83 op_sel:[0,0,0] op_sel_hi:[1,0,1]
 v_cmp_ne_u32 vcc, 0, v27
 v_fma_mix_f32 v51, v81, 1.0, v83 op_sel:[1,0,1] op_sel_hi:[1,0,1]
 v_max3_f32 v62, v48, v49, v79
 s_cbranch_vccnz psr_43
 s_branch psj_44
kvw_45:
 s_mov_b32 s22, s87
 s_cmp_eq_u32 s52, 0
 s_cselect_b32 s55, 0, s55
 s_cselect_b32 s87, 1, 0
 s_cbranch_scc1 kvok_46
 v_mov_b32 v62, 0
 s_mov_b32 s101, 0
wf_50:
 buffer_load_dword v63, v62, s[12:15], s79 offen sc1
 s_add_u32 s101, s101, 1
 s_cmp_gt_u32 s101, 131072
 s_cbranch_scc1 end0
 s_waitcnt vmcnt(0)
 v_readfirstlane_b32 s100, v63
 s_cmp_ge_u32 s100, s46
 s_cbranch_scc1 wf_51
 s_sleep 3
 s_branch wf_50
wf_51:
 s_cmp_eq_u32 s22, 0
 s_cbranch_scc1 kvok_46
 s_sub_u32 s21, s64, 1310720
 buffer_load_dwordx4 v[126:129], v16, s[28:31], s21 offen offset:0 sc1
 buffer_load_dwordx4 v[130:133], v16, s[28:31], s21 offen offset:1024 sc1
 buffer_load_dwordx4 v[134:137], v16, s[28:31], s21 offen offset:2048 sc1
 s_waitcnt vmcnt(0)
 s_branch kvok_46
fl_47:
 buffer_load_dword v0, off, s[12:15], s79 sc1
 s_branch fl_48
last_37:
 s_waitcnt lgkmcnt(10)
 v_smfmac_f32_16x16x64_f16 v[100:103], v[28:31], a[120:127], v25
 v_smfmac_f32_16x16x64_f16 v[104:107], v[28:31], a[128:135], v25
 v_smfmac_f32_16x16x64_f16 v[108:111], v[28:31], a[136:143], v25
 v_smfmac_f32_16x16x64_f16 v[100:103], v[32:35], a[144:151], v25
 v_smfmac_f32_16x16x64_f16 v[104:107], v[32:35], a[152:159], v25
 v_smfmac_f32_16x16x64_f16 v[108:111], v[32:35], a[160:167], v25
 s_waitcnt lgkmcnt(7)
 v_smfmac_f32_16x16x64_f16 v[100:103], v[64:67], a[168:175], v25
 v_smfmac_f32_16x16x64_f16 v[104:107], v[64:67], a[176:183], v25
 v_smfmac_f32_16x16x64_f16 v[108:111], v[64:67], a[184:191], v25
 v_smfmac_f32_16x16x64_f16 v[100:103], v[68:71], a[192:199], v25
 v_smfmac_f32_16x16x64_f16 v[104:107], v[68:71], a[200:207], v25
 v_smfmac_f32_16x16x64_f16 v[108:111], v[68:71], a[208:215], v25
 v_smfmac_f32_16x16x64_f16 v[100:103], v[72:75], a[216:223], v25
 v_smfmac_f32_16x16x64_f16 v[104:107], v[72:75], a[224:231], v25
 v_smfmac_f32_16x16x64_f16 v[108:111], v[72:75], a[232:239], v25
 s_waitcnt lgkmcnt(4)
 v_smfmac_f32_16x16x64_f16 v[100:103], v[76:79], a[240:247], v25
 v_smfmac_f32_16x16x64_f16 v[104:107], v[76:79], a[248:255], v25
 v_smfmac_f32_16x16x64_f16 v[108:111], v[76:79], v[152:159], v25
 v_smfmac_f32_16x16x64_f16 v[100:103], v[80:83], v[160:167], v25
 v_smfmac_f32_16x16x64_f16 v[104:107], v[80:83], v[168:175], v25
 v_smfmac_f32_16x16x64_f16 v[108:111], v[80:83], v[176:183], v25
 v_smfmac_f32_16x16x64_f16 v[100:103], v[84:87], v[184:191], v25
 v_smfmac_f32_16x16x64_f16 v[104:107], v[84:87], v[192:199], v25
 v_smfmac_f32_16x16x64_f16 v[108:111], v[84:87], v[200:207], v25
 s_waitcnt lgkmcnt(0)
 v_smfmac_f32_16x16x64_f16 v[100:103], v[88:91], v[208:215], v25
 v_smfmac_f32_16x16x64_f16 v[104:107], v[88:91], v[216:223], v25
 v_smfmac_f32_16x16x64_f16 v[108:111], v[88:91], v[224:231], v25
 v_smfmac_f32_16x16x64_f16 v[100:103], v[92:95], v[232:239], v25
 v_smfmac_f32_16x16x64_f16 v[104:107], v[92:95], v[240:247], v25
 v_smfmac_f32_16x16x64_f16 v[108:111], v[92:95], v[248:255], v25
 s_nop 7
 v_mov_b32 v76, v108
 v_mov_b32 v77, v109
 v_mov_b32 v78, v110
 v_mov_b32 v79, v111
 v_permlane32_swap_b32 v100, v104
 v_permlane32_swap_b32 v101, v105
 v_permlane32_swap_b32 v102, v106
 v_permlane32_swap_b32 v103, v107
 v_permlane32_swap_b32 v108, v76
 v_permlane32_swap_b32 v109, v77
 v_permlane32_swap_b32 v110, v78
 v_permlane32_swap_b32 v111, v79
 v_pk_add_f32 v[100:101], v[100:101], v[104:105]
 v_pk_add_f32 v[102:103], v[102:103], v[106:107]
 v_pk_add_f32 v[108:109], v[108:109], v[76:77]
 v_pk_add_f32 v[110:111], v[110:111], v[78:79]
 v_cvt_pk_bf16_f32 v80, v100, v101
 v_cvt_pk_bf16_f32 v82, v108, v109
 v_cvt_pk_bf16_f32 v81, v102, v103
 v_cvt_pk_bf16_f32 v83, v110, v111
 s_nop 0
 v_permlane16_swap_b32 v80, v82
 v_permlane16_swap_b32 v81, v83
 v_min_u32 v80, -2, v80
 s_mov_b64 exec, s[76:77]
 buffer_store_dwordx4 v[80:83], v15, s[24:27], s57 offen sc1
 s_mov_b64 exec, -1
 s_branch chain_done
step_52:
 s_and_b32 s21, s52, 3
 s_mul_i32 s81, s21, 540672
 s_mul_i32 s84, s21, 0x88000
 s_and_b32 s84, s84, 0x108000
 s_add_u32 s21, s52, 3
 s_and_b32 s21, s21, 3
 s_mul_i32 s83, s21, 0x88000
 s_and_b32 s83, s83, 0x108000
 s_add_u32 s21, s52, 1
 s_and_b32 s22, s21, 3
 s_mul_i32 s3, s22, 0x88000
 s_and_b32 s3, s3, 0x108000
 s_mul_i32 s80, s21, 393216
 s_add_u32 s46, s21, 1
 s_min_u32 s46, s46, 64
 s_mov_b32 s47, s57
 s_mov_b32 s78, s85
 s_lshr_b32 s21, s52, 1
 s_bitcmp1_b32 s37, s21
 s_cselect_b32 s21, 8192, 0
 s_lshl_b32 s22, s52, 20
 s_or_b32 s22, s22, s21
 s_cmp_ge_u32 s52, 40
 s_cselect_b32 s57, 8192, 0
 s_xor_b32 s57, s57, s22
 s_xor_b32 s85, s22, 8192
 s_bfe_u32 s88, s52, 0x10002
 s_max_u32 s67, s52, 1
 s_sub_u32 s67, s67, 1
 v_mov_b32 v40, 0
 v_mov_b32 v41, 0
 v_mov_b32 v42, 0
 v_mov_b32 v43, 0
 v_mov_b32 v44, 0
 v_mov_b32 v45, 0
 v_mov_b32 v46, 0
 v_mov_b32 v47, 0
 v_mov_b32 v48, 0
 v_mov_b32 v49, 0
 v_mov_b32 v50, 0
 v_mov_b32 v51, 0
 v_mov_b32 v52, 0
 v_mov_b32 v53, 0
 v_mov_b32 v54, 0
 v_mov_b32 v55, 0
 v_mov_b32 v56, 0
 v_mov_b32 v57, 0
 v_mov_b32 v58, 0
 v_mov_b32 v59, 0
 v_mov_b32 v60, 0
 v_mov_b32 v61, 0
 v_mov_b32 v62, 0
 v_mov_b32 v63, 0
 v_mov_b32 v100, 0
 v_mov_b32 v101, 0
 v_mov_b32 v102, 0
 v_mov_b32 v103, 0
 v_mov_b32 v104, 0
 v_mov_b32 v105, 0
 v_mov_b32 v106, 0
 v_mov_b32 v107, 0
 v_mov_b32 v108, 0
 v_mov_b32 v109, 0
 v_mov_b32 v110, 0
 v_mov_b32 v111, 0
 s_sleep 3
 s_nop 7
 v_readfirstlane_b32 s21, v0
 s_cmp_lt_u32 s21, s46
 s_cselect_b32 s55, s55, 0
 s_cmp_lt_i32 s55, 0
 s_cbranch_scc1 fl_57
fl_58:
 s_mov_b32 s54, 0
 buffer_load_dwordx4 v[36:39], v4, s[4:7], s84 offen offset:2048 sc1
 buffer_load_dwordx4 v[28:31], v4, s[4:7], s84 offen offset:0 sc1
 buffer_load_dwordx4 v[32:35], v4, s[4:7], s84 offen offset:1024 sc1
 s_waitcnt vmcnt(3)
 v_mov_b32 v126, v88
 v_mov_b32 v127, v89
 v_mov_b32 v128, v90
 v_mov_b32 v129, v91
 v_mov_b32 v130, v92
 v_mov_b32 v131, v93
 v_mov_b32 v132, v94
 v_mov_b32 v133, v95
 v_mov_b32 v134, v96
 v_mov_b32 v135, v97
 v_mov_b32 v136, v98
 v_mov_b32 v137, v99
 s_waitcnt vmcnt(2)
 v_smfmac_f32_16x16x32_f16 v[40:43], v[36:37], a[16:19], v25
 v_smfmac_f32_16x16x32_f16 v[52:55], v[36:37], a[76:79], v25
 v_smfmac_f32_16x16x32_f16 v[44:47], v[36:37], a[36:39], v25
 s_waitcnt vmcnt(0)
 v_bitop3_b32 v27, v31, v35, v39 bitop3:0x80
 v_perm_b32 v31, v35, v31, s89
 v_cmp_gt_u32 vcc, 0x48000000, v27
 v_mov_b32 v35, v38
 v_smfmac_f32_16x16x32_f16 v[56:59], v[36:37], a[96:99], v25
 s_cbranch_vccnz pm_55
A2_56:
 v_smfmac_f32_16x16x64_f16 v[40:43], v[28:31], a[0:7], v25
 ds_write_b128 v10, v[28:31]
 v_smfmac_f32_16x16x64_f16 v[40:43], v[32:35], a[8:15], v25
 ds_write_b128 v10, v[32:35] offset:1024
 v_smfmac_f32_16x16x64_f16 v[52:55], v[28:31], a[60:67], v25
 ds_write_b64 v10, v[36:37] offset:2048
 v_smfmac_f32_16x16x64_f16 v[52:55], v[32:35], a[68:75], v25
 v_cvt_pk_f16_f32 v40, v40, v41
 v_cvt_pk_f16_f32 v41, v42, v43
 v_smfmac_f32_16x16x32_f16 v[48:51], v[36:37], a[56:59], v25
 v_smfmac_f32_16x16x32_f16 v[60:63], v[36:37], a[116:119], v25
 v_smfmac_f32_16x16x64_f16 v[44:47], v[28:31], a[20:27], v25
 v_cvt_pk_f16_f32 v52, v52, v53
 v_cvt_pk_f16_f32 v53, v54, v55
 s_nop 0
 v_smfmac_f32_16x16x64_f16 v[44:47], v[32:35], a[28:35], v25
 v_permlane32_swap_b32 v40, v52
 v_smfmac_f32_16x16x64_f16 v[56:59], v[28:31], a[80:87], v25
 v_permlane32_swap_b32 v41, v53
 v_pk_add_f16 v40, v40, v52
 v_smfmac_f32_16x16x64_f16 v[56:59], v[32:35], a[88:95], v25
 v_pk_add_f16 v41, v41, v53
 v_smfmac_f32_16x16x64_f16 v[48:51], v[28:31], a[40:47], v25
 ds_write_b64 v5, v[40:41] offset:0
 v_smfmac_f32_16x16x64_f16 v[48:51], v[32:35], a[48:55], v25
 v_cvt_pk_f16_f32 v44, v44, v45
 v_cvt_pk_f16_f32 v45, v46, v47
 v_cvt_pk_f16_f32 v56, v56, v57
 v_smfmac_f32_16x16x64_f16 v[60:63], v[28:31], a[100:107], v25
 v_cvt_pk_f16_f32 v57, v58, v59
 s_nop 0
 v_smfmac_f32_16x16x64_f16 v[60:63], v[32:35], a[108:115], v25
 v_permlane32_swap_b32 v44, v56
 v_permlane32_swap_b32 v45, v57
 v_pk_add_f16 v44, v44, v56
 v_pk_add_f16 v45, v45, v57
 ds_write_b64 v5, v[44:45] offset:640
 v_cvt_pk_f16_f32 v48, v48, v49
 v_cvt_pk_f16_f32 v49, v50, v51
 v_cvt_pk_f16_f32 v60, v60, v61
 v_cvt_pk_f16_f32 v61, v62, v63
 s_nop 0
 v_permlane32_swap_b32 v48, v60
 v_permlane32_swap_b32 v49, v61
 v_pk_add_f16 v48, v48, v60
 v_pk_add_f16 v49, v49, v61
 ds_write_b64 v5, v[48:49] offset:1280
 s_waitcnt lgkmcnt(0) vmcnt(0)
 s_barrier
 ds_read_b64_tr_b16 v[40:41], v6 offset:0
 ds_read_b64_tr_b16 v[42:43], v6 offset:1920
 ds_read_b64_tr_b16 v[44:45], v6 offset:3840
 ds_read_b64_tr_b16 v[46:47], v6 offset:5760
 ds_read_b64_tr_b16 v[48:49], v6 offset:640
 ds_read_b64_tr_b16 v[50:51], v6 offset:2560
 ds_read_b64_tr_b16 v[52:53], v6 offset:4480
 ds_read_b64_tr_b16 v[54:55], v6 offset:6400
 ds_read_b64_tr_b16 v[56:57], v6 offset:1280
 ds_read_b64_tr_b16 v[58:59], v6 offset:3200
 ds_read_b64_tr_b16 v[60:61], v6 offset:5120
 ds_read_b64_tr_b16 v[62:63], v6 offset:7040
 s_waitcnt lgkmcnt(8)
 v_pk_add_f16 v40, v40, v42
 v_pk_add_f16 v44, v44, v46
 v_pk_add_f16 v41, v41, v43
 v_pk_add_f16 v45, v45, v47
 v_fma_mix_f32 v146, v40, 1.0, v44 op_sel:[0,0,0] op_sel_hi:[1,0,1]
 v_fma_mix_f32 v147, v40, 1.0, v44 op_sel:[1,0,1] op_sel_hi:[1,0,1]
 v_fma_mix_f32 v148, v41, 1.0, v45 op_sel:[0,0,0] op_sel_hi:[1,0,1]
 v_fma_mix_f32 v149, v41, 1.0, v45 op_sel:[1,0,1] op_sel_hi:[1,0,1]
 v_cvt_pk_bf16_f32 v118, v146, v147
 v_cvt_pk_bf16_f32 v119, v148, v149
 s_waitcnt lgkmcnt(4)
 v_pk_add_f16 v48, v48, v50
 v_pk_add_f16 v52, v52, v54
 v_pk_add_f16 v49, v49, v51
 v_pk_add_f16 v53, v53, v55
 v_fma_mix_f32 v146, v48, 1.0, v52 op_sel:[0,0,0] op_sel_hi:[1,0,1]
 v_fma_mix_f32 v147, v48, 1.0, v52 op_sel:[1,0,1] op_sel_hi:[1,0,1]
 v_fma_mix_f32 v148, v49, 1.0, v53 op_sel:[0,0,0] op_sel_hi:[1,0,1]
 v_fma_mix_f32 v149, v49, 1.0, v53 op_sel:[1,0,1] op_sel_hi:[1,0,1]
 v_cvt_pk_bf16_f32 v120, v146, v147
 v_cvt_pk_bf16_f32 v121, v148, v149
 s_waitcnt lgkmcnt(0)
 v_pk_add_f16 v56, v56, v58
 v_pk_add_f16 v60, v60, v62
 v_pk_add_f16 v57, v57, v59
 v_pk_add_f16 v61, v61, v63
 v_fma_mix_f32 v146, v56, 1.0, v60 op_sel:[0,0,0] op_sel_hi:[1,0,1]
 v_fma_mix_f32 v147, v56, 1.0, v60 op_sel:[1,0,1] op_sel_hi:[1,0,1]
 v_mfma_f32_16x16x32_bf16 v[40:43], v[118:121], v[118:121], 0
 v_fma_mix_f32 v148, v57, 1.0, v61 op_sel:[0,0,0] op_sel_hi:[1,0,1]
 v_fma_mix_f32 v149, v57, 1.0, v61 op_sel:[1,0,1] op_sel_hi:[1,0,1]
 v_cvt_pk_bf16_f32 v122, v146, v147
 v_cvt_pk_bf16_f32 v123, v148, v149
 s_nop 1
 v_mfma_f32_16x16x32_bf16 v[40:43], v[122:125], v[122:125], v[40:43]
 ds_read_b128 v[28:31], v16 offset:24576
 ds_read_b128 v[32:35], v16 offset:25600
 ds_read_b128 v[64:67], v16 offset:27648
 ds_read_b128 v[68:71], v16 offset:28672
 ds_read_b128 v[72:75], v16 offset:30720
 ds_read_b128 v[76:79], v16 offset:31744
 s_nop 0
 s_mov_b64 exec, s[74:75]
 v_cvt_pk_f16_f32 v44, v40, v41
 v_cvt_pk_f16_f32 v45, v42, v43
 v_and_or_b32 v44, v44, -2, s88
 buffer_store_dwordx2 v[44:45], v7, s[8:11], s81 offen
 s_mov_b64 exec, -1
 ds_read_b128 v[80:83], v16 offset:33792
 ds_read_b128 v[84:87], v16 offset:34816
 ds_read_b64 v[88:89], v16 offset:26624
 ds_read_b64 v[90:91], v16 offset:29696
 ds_read_b64 v[92:93], v16 offset:32768
 ds_read_b64 v[94:95], v16 offset:35840
 s_cmp_eq_u32 s52, 63
 s_cbranch_scc1 last_53
 s_waitcnt lgkmcnt(10)
 v_smfmac_f32_16x16x64_f16 v[100:103], v[28:31], a[120:127], v25
 v_smfmac_f32_16x16x64_f16 v[104:107], v[28:31], a[128:135], v25
 v_smfmac_f32_16x16x64_f16 v[108:111], v[28:31], a[136:143], v25
 s_mov_b32 s54, 0
 v_smfmac_f32_16x16x64_f16 v[100:103], v[32:35], a[144:151], v25
 v_readfirstlane_b32 s21, v0
 v_smfmac_f32_16x16x64_f16 v[104:107], v[32:35], a[152:159], v25
 s_add_u32 s22, s46, 3
 v_smfmac_f32_16x16x64_f16 v[108:111], v[32:35], a[160:167], v25
 s_min_u32 s22, s22, 64
 s_waitcnt lgkmcnt(7)
 v_smfmac_f32_16x16x64_f16 v[100:103], v[64:67], a[168:175], v25
 s_sub_u32 s55, s21, s22
 v_smfmac_f32_16x16x64_f16 v[104:107], v[64:67], a[176:183], v25
 s_sub_u32 s56, s21, s46
 v_smfmac_f32_16x16x64_f16 v[108:111], v[64:67], a[184:191], v25
 v_smfmac_f32_16x16x64_f16 v[100:103], v[68:71], a[192:199], v25
 v_smfmac_f32_16x16x64_f16 v[104:107], v[68:71], a[200:207], v25
 v_smfmac_f32_16x16x64_f16 v[108:111], v[68:71], a[208:215], v25
 v_smfmac_f32_16x16x64_f16 v[100:103], v[72:75], a[216:223], v25
 v_smfmac_f32_16x16x64_f16 v[104:107], v[72:75], a[224:231], v25
 v_smfmac_f32_16x16x64_f16 v[108:111], v[72:75], a[232:239], v25
 s_waitcnt lgkmcnt(4)
 v_smfmac_f32_16x16x64_f16 v[100:103], v[76:79], a[240:247], v25
 v_smfmac_f32_16x16x64_f16 v[104:107], v[76:79], a[248:255], v25
 buffer_load_dwordx2 v[58:59], v9, s[8:11], s81 offen sc1
 buffer_load_dwordx4 v[40:43], v8, s[8:11], s81 offen offset:0 sc1
 buffer_load_dwordx4 v[44:47], v8, s[8:11], s81 offen offset:1024 sc1
 v_smfmac_f32_16x16x64_f16 v[108:111], v[76:79], v[152:159], v25
 v_smfmac_f32_16x16x64_f16 v[100:103], v[80:83], v[160:167], v25
 v_smfmac_f32_16x16x64_f16 v[104:107], v[80:83], v[168:175], v25
 v_smfmac_f32_16x16x64_f16 v[108:111], v[80:83], v[176:183], v25
 v_smfmac_f32_16x16x64_f16 v[100:103], v[84:87], v[184:191], v25
 v_smfmac_f32_16x16x64_f16 v[104:107], v[84:87], v[192:199], v25
 v_smfmac_f32_16x16x64_f16 v[108:111], v[84:87], v[200:207], v25
 s_waitcnt lgkmcnt(0)
 v_smfmac_f32_16x16x64_f16 v[100:103], v[88:91], v[208:215], v25
 v_smfmac_f32_16x16x64_f16 v[104:107], v[88:91], v[216:223], v25
 v_smfmac_f32_16x16x64_f16 v[108:111], v[88:91], v[224:231], v25
 v_smfmac_f32_16x16x64_f16 v[100:103], v[92:95], v[232:239], v25
 v_smfmac_f32_16x16x64_f16 v[104:107], v[92:95], v[240:247], v25
 v_smfmac_f32_16x16x64_f16 v[108:111], v[92:95], v[248:255], v25
 s_cmp_lt_i32 s56, 0
 s_cbranch_scc1 kvw_61
kvok_62:
 s_waitcnt vmcnt(2)
 v_xor_b32 v76, s88, v58
 s_nop 0
 v_permlane16_swap_b32 v58, v59
 v_fma_mix_f32 v60, v58, 1.0, v59 op_sel:[0,0,0] op_sel_hi:[1,0,1]
 v_fma_mix_f32 v61, v58, 1.0, v59 op_sel:[1,0,1] op_sel_hi:[1,0,1]
 v_mov_b32 v58, v60
 v_mov_b32 v59, v61
 s_nop 0
 v_permlane32_swap_b32 v58, v60
 v_permlane32_swap_b32 v59, v61
 v_add_f32 v52, v58, v60
 v_add_f32 v53, v59, v61
 v_max_f32 v79, v52, v53
 s_waitcnt vmcnt(0)
 v_pk_add_f16 v80, v40, v44
 v_pk_add_f16 v82, v42, v46
 v_pk_add_f16 v81, v41, v45
 v_pk_add_f16 v83, v43, v47
 v_permlane32_swap_b32 v80, v82
 v_bitop3_b32 v77, v40, v42, s88 bitop3:0x7e
 v_permlane32_swap_b32 v81, v83
 v_bitop3_b32 v78, v44, v46, s88 bitop3:0x7e
 v_fma_mix_f32 v48, v80, 1.0, v82 op_sel:[0,0,0] op_sel_hi:[1,0,1]
 v_or3_b32 v27, v76, v77, v78
 v_fma_mix_f32 v49, v80, 1.0, v82 op_sel:[1,0,1] op_sel_hi:[1,0,1]
 v_and_b32 v27, 1, v27
 v_fma_mix_f32 v50, v81, 1.0, v83 op_sel:[0,0,0] op_sel_hi:[1,0,1]
 v_cmp_ne_u32 vcc, 0, v27
 v_fma_mix_f32 v51, v81, 1.0, v83 op_sel:[1,0,1] op_sel_hi:[1,0,1]
 v_max3_f32 v62, v48, v49, v79
 s_cbranch_vccnz psr_59
psj_60:
 v_max3_f32 v62, v62, v50, v51
 v_cvt_pk_bf16_f32 v146, v100, v101
 v_cvt_pk_bf16_f32 v147, v102, v103
 v_max_f32_dpp v62, v62, v62 row_ror:8 row_mask:0xf bank_mask:0xf
 v_mov_b32 v63, v62
 v_cvt_pk_bf16_f32 v148, v104, v105
 v_cvt_pk_bf16_f32 v149, v106, v107
 v_permlane32_swap_b32 v62, v63
 v_max_f32 v62, v62, v63
 v_mov_b32 v63, v62
 v_cvt_pk_bf16_f32 v150, v108, v109
 v_cvt_pk_bf16_f32 v151, v110, v111
 v_permlane16_swap_b32 v62, v63
 v_max_f32 v62, v62, v63
 v_mul_f32 v62, s86, v62
 v_fma_f32 v48, v48, s86, -v62
 v_fma_f32 v49, v49, s86, -v62
 v_fma_f32 v50, v50, s86, -v62
 v_fma_f32 v51, v51, s86, -v62
 v_fma_f32 v52, v52, s86, -v62
 v_fma_f32 v53, v53, s86, -v62
 v_exp_f32 v48, v48
 v_exp_f32 v49, v49
 buffer_load_dwordx4 v[88:91], v17, s[28:31], s64 offen offset:0 sc1
 v_exp_f32 v50, v50
 v_exp_f32 v51, v51
 buffer_load_dwordx4 v[92:95], v16, s[28:31], s64 offen offset:1024 sc1
 v_exp_f32 v52, v52
 v_exp_f32 v53, v53
 buffer_load_dwordx4 v[96:99], v20, s[28:31], s64 offen offset:2048 sc1
 v_cvt_pk_bf16_f32 v138, v48, v49
 v_cvt_pk_bf16_f32 v139, v50, v51
 v_cvt_pk_bf16_f32 v142, v52, v53
 v_mov_b32_dpp v140, v138 row_ror:8 row_mask:0xf bank_mask:0xf
 v_mov_b32_dpp v141, v139 row_ror:8 row_mask:0xf bank_mask:0xf
 v_mov_b32_dpp v143, v142 row_ror:8 row_mask:0xf bank_mask:0xf
 v_add_f32 v54, v48, v49
 v_mfma_f32_16x16x32_bf16 v[64:67], v[126:129], v[138:141], 0
 v_add_f32 v55, v50, v51
 v_add_f32 v56, v52, v53
 v_mfma_f32_16x16x32_bf16 v[64:67], v[146:149], v[142:145], v[64:67]
 v_add_f32 v62, v54, v55
 v_fmac_f32 v62, v56, v26
 v_mfma_f32_16x16x32_bf16 v[68:71], v[130:133], v[138:141], 0
 s_nop 0
 v_add_f32_dpp v62, v62, v62 row_ror:8 row_mask:0xf bank_mask:0xf
 v_mfma_f32_16x16x32_bf16 v[68:71], v[148:151], v[142:145], v[68:71]
 v_mov_b32 v63, v62
 s_cmp_lt_i32 s55, 0
 s_cbranch_scc1 fl_63
fl_64:
 v_mfma_f32_16x16x32_bf16 v[72:75], v[134:137], v[138:141], 0
 v_permlane32_swap_b32 v62, v63
 v_mfma_f32_16x16x32_bf16 v[72:75], v[150:153], v[142:145], v[72:75]
 v_add_f32 v62, v62, v63
 v_mov_b32 v63, v62
 ds_write_b128 v11, v[64:67] offset:0
 s_nop 0
 v_permlane16_swap_b32 v62, v63
 v_add_f32 v62, v62, v63
 v_rcp_f32 v62, v62
 ds_write_b128 v11, v[68:71] offset:1024
 s_mov_b64 exec, 0xff
 ds_write_b32 v22, v62
 s_mov_b64 exec, -1
 ds_write_b128 v11, v[72:75] offset:2048
 s_waitcnt lgkmcnt(0)
 s_barrier
 ds_read_b128 v[72:75], v23
 ds_read_b64 v[64:65], v12 offset:0
 ds_read_b64 v[66:67], v12 offset:3072
 ds_read_b64 v[68:69], v12 offset:6144
 ds_read_b64 v[70:71], v12 offset:9216
 s_waitcnt lgkmcnt(2)
 v_pk_mul_f32 v[64:65], v[64:65], v[72:73] op_sel_hi:[1,0]
 v_pk_fma_f32 v[64:65], v[66:67], v[72:73], v[64:65] op_sel:[0,1,0] op_sel_hi:[1,1,1]
 s_waitcnt lgkmcnt(0)
 v_pk_fma_f32 v[64:65], v[68:69], v[74:75], v[64:65] op_sel_hi:[1,0,1]
 v_pk_fma_f32 v[64:65], v[70:71], v[74:75], v[64:65] op_sel:[0,1,0] op_sel_hi:[1,1,1]
 v_cvt_pk_f16_f32 v68, v64, v65
 v_perm_b32 v68, s91, v68, v14
 buffer_atomic_pk_add_f16 v68, v13, s[4:7], s3 offen
 s_mov_b64 exec, s[62:63]
 buffer_store_dwordx4 v[118:121], v18, s[24:27], s85 offen sc1
 buffer_store_dwordx2 v[122:123], v19, s[24:27], s85 offen sc1
 s_mov_b64 exec, -1
 v_mov_b32 v76, v108
 v_mov_b32 v77, v109
 v_mov_b32 v78, v110
 v_mov_b32 v79, v111
 v_permlane32_swap_b32 v100, v104
 v_permlane32_swap_b32 v101, v105
 v_permlane32_swap_b32 v102, v106
 v_permlane32_swap_b32 v103, v107
 v_permlane32_swap_b32 v108, v76
 v_permlane32_swap_b32 v109, v77
 v_permlane32_swap_b32 v110, v78
 v_permlane32_swap_b32 v111, v79
 v_pk_add_f32 v[100:101], v[100:101], v[104:105]
 v_pk_add_f32 v[102:103], v[102:103], v[106:107]
 v_pk_add_f32 v[108:109], v[108:109], v[76:77]
 v_pk_add_f32 v[110:111], v[110:111], v[78:79]
 v_cvt_pk_bf16_f32 v80, v100, v101
 v_cvt_pk_bf16_f32 v82, v108, v109
 v_cvt_pk_bf16_f32 v81, v102, v103
 v_cvt_pk_bf16_f32 v83, v110, v111
 s_nop 0
 v_permlane16_swap_b32 v80, v82
 v_permlane16_swap_b32 v81, v83
 v_min_u32 v80, -2, v80
 s_mov_b64 exec, s[76:77]
 buffer_store_dwordx4 v[80:83], v15, s[24:27], s57 offen sc1
 s_mov_b64 exec, -1
 s_add_u32 s64, s64, 1310720
 s_add_u32 s52, s52, 1
 s_branch step_52
fl_57:
 buffer_load_dword v0, off, s[12:15], s79 sc1
 s_branch fl_58
A1_17:
 v_smfmac_f32_16x16x32_f16 v[40:43], v[36:37], a[16:19], v25
 v_smfmac_f32_16x16x32_f16 v[52:55], v[36:37], a[76:79], v25
 v_smfmac_f32_16x16x32_f16 v[44:47], v[36:37], a[36:39], v25
 v_smfmac_f32_16x16x32_f16 v[56:59], v[36:37], a[96:99], v25
 s_branch A2_56
pm_55:
 buffer_load_dwordx4 v[36:39], v4, s[4:7], s84 offen offset:2048 sc1
 buffer_load_dwordx4 v[28:31], v4, s[4:7], s84 offen offset:0 sc1
 buffer_load_dwordx4 v[32:35], v4, s[4:7], s84 offen offset:1024 sc1
 s_nop 7
 v_mov_b32 v40, 0
 v_mov_b32 v41, 0
 v_mov_b32 v42, 0
 v_mov_b32 v43, 0
 v_mov_b32 v52, 0
 v_mov_b32 v53, 0
 v_mov_b32 v54, 0
 v_mov_b32 v55, 0
 v_mov_b32 v44, 0
 v_mov_b32 v45, 0
 v_mov_b32 v46, 0
 v_mov_b32 v47, 0
 v_mov_b32 v56, 0
 v_mov_b32 v57, 0
 v_mov_b32 v58, 0
 v_mov_b32 v59, 0
 s_waitcnt vmcnt(0)
 v_bitop3_b32 v27, v31, v35, v39 bitop3:0x80
 v_perm_b32 v31, v35, v31, s89
 v_cmp_gt_u32 vcc, 0x48000000, v27
 v_mov_b32 v35, v38
 s_cbranch_vccz A1_17
pm_54:
 s_cmp_gt_u32 s52, 3
 s_cbranch_scc1 op_65
 v_readfirstlane_b32 s21, v0
 s_cmp_ge_u32 s21, s46
 s_cbranch_scc1 op_65
 buffer_load_dword v0, off, s[12:15], s79 sc1
 s_waitcnt vmcnt(0)
 v_readfirstlane_b32 s21, v0
 s_cmp_gt_u32 s21, s52
 s_cselect_b32 s21, s87, 0
 s_cmp_eq_u32 s21, 0
 s_cbranch_scc1 op_65
 s_mov_b32 s87, 0
 s_sub_u32 s21, s64, 1310720
 buffer_load_dwordx4 v[126:129], v16, s[28:31], s21 offen offset:0 sc1
 buffer_load_dwordx4 v[130:133], v16, s[28:31], s21 offen offset:1024 sc1
 buffer_load_dwordx4 v[134:137], v16, s[28:31], s21 offen offset:2048 sc1
op_65:
 buffer_load_dwordx4 v[36:39], v4, s[4:7], s84 offen offset:2048 sc1
 buffer_load_dwordx4 v[28:31], v4, s[4:7], s84 offen offset:0 sc1
 buffer_load_dwordx4 v[32:35], v4, s[4:7], s84 offen offset:1024 sc1
 s_add_u32 s54, s54, 1
 s_cmp_gt_u32 s54, 131072
 s_cbranch_scc1 end0
 s_waitcnt vmcnt(0)
 v_bitop3_b32 v27, v31, v35, v39 bitop3:0x80
 v_perm_b32 v31, v35, v31, s89
 v_cmp_gt_u32 vcc, 0x48000000, v27
 v_mov_b32 v35, v38
 s_cbranch_vccnz pm_54
 s_branch A1_17
psr_59:
 buffer_load_dwordx2 v[58:59], v9, s[8:11], s81 offen sc1
 buffer_load_dwordx4 v[40:43], v8, s[8:11], s81 offen offset:0 sc1
 buffer_load_dwordx4 v[44:47], v8, s[8:11], s81 offen offset:1024 sc1
 s_add_u32 s54, s54, 1
 s_cmp_gt_u32 s54, 131072
 s_cbranch_scc1 end0
 s_waitcnt vmcnt(2)
 v_xor_b32 v76, s88, v58
 s_nop 0
 v_permlane16_swap_b32 v58, v59
 v_fma_mix_f32 v60, v58, 1.0, v59 op_sel:[0,0,0] op_sel_hi:[1,0,1]
 v_fma_mix_f32 v61, v58, 1.0, v59 op_sel:[1,0,1] op_sel_hi:[1,0,1]
 v_mov_b32 v58, v60
 v_mov_b32 v59, v61
 s_nop 0
 v_permlane32_swap_b32 v58, v60
 v_permlane32_swap_b32 v59, v61
 v_add_f32 v52, v58, v60
 v_add_f32 v53, v59, v61
 v_max_f32 v79, v52, v53
 s_waitcnt vmcnt(0)
 v_pk_add_f16 v80, v40, v44
 v_pk_add_f16 v82, v42, v46
 v_pk_add_f16 v81, v41, v45
 v_pk_add_f16 v83, v43, v47
 v_permlane32_swap_b32 v80, v82
 v_bitop3_b32 v77, v40, v42, s88 bitop3:0x7e
 v_permlane32_swap_b32 v81, v83
 v_bitop3_b32 v78, v44, v46, s88 bitop3:0x7e
 v_fma_mix_f32 v48, v80, 1.0, v82 op_sel:[0,0,0] op_sel_hi:[1,0,1]
 v_or3_b32 v27, v76, v77, v78
 v_fma_mix_f32 v49, v80, 1.0, v82 op_sel:[1,0,1] op_sel_hi:[1,0,1]
 v_and_b32 v27, 1, v27
 v_fma_mix_f32 v50, v81, 1.0, v83 op_sel:[0,0,0] op_sel_hi:[1,0,1]
 v_cmp_ne_u32 vcc, 0, v27
 v_fma_mix_f32 v51, v81, 1.0, v83 op_sel:[1,0,1] op_sel_hi:[1,0,1]
 v_max3_f32 v62, v48, v49, v79
 s_cbranch_vccnz psr_59
 s_branch psj_60
kvw_61:
 s_mov_b32 s22, s87
 s_cmp_eq_u32 s52, 0
 s_cselect_b32 s55, 0, s55
 s_cselect_b32 s87, 1, 0
 s_cbranch_scc1 kvok_62
 v_mov_b32 v62, 0
 s_mov_b32 s101, 0
wf_66:
 buffer_load_dword v63, v62, s[12:15], s79 offen sc1
 s_add_u32 s101, s101, 1
 s_cmp_gt_u32 s101, 131072
 s_cbranch_scc1 end0
 s_waitcnt vmcnt(0)
 v_readfirstlane_b32 s100, v63
 s_cmp_ge_u32 s100, s46
 s_cbranch_scc1 wf_67
 s_sleep 3
 s_branch wf_66
wf_67:
 s_cmp_eq_u32 s22, 0
 s_cbranch_scc1 kvok_62
 s_sub_u32 s21, s64, 1310720
 buffer_load_dwordx4 v[126:129], v16, s[28:31], s21 offen offset:0 sc1
 buffer_load_dwordx4 v[130:133], v16, s[28:31], s21 offen offset:1024 sc1
 buffer_load_dwordx4 v[134:137], v16, s[28:31], s21 offen offset:2048 sc1
 s_waitcnt vmcnt(0)
 s_branch kvok_62
fl_63:
 buffer_load_dword v0, off, s[12:15], s79 sc1
 s_branch fl_64
last_53:
 s_mov_b64 exec, s[62:63]
 buffer_store_dwordx4 v[118:121], v18, s[24:27], s85 offen sc1
 buffer_store_dwordx2 v[122:123], v19, s[24:27], s85 offen sc1
 s_mov_b64 exec, -1
 s_waitcnt lgkmcnt(10)
 v_smfmac_f32_16x16x64_f16 v[100:103], v[28:31], a[120:127], v25
 v_smfmac_f32_16x16x64_f16 v[104:107], v[28:31], a[128:135], v25
 v_smfmac_f32_16x16x64_f16 v[108:111], v[28:31], a[136:143], v25
 v_smfmac_f32_16x16x64_f16 v[100:103], v[32:35], a[144:151], v25
 v_smfmac_f32_16x16x64_f16 v[104:107], v[32:35], a[152:159], v25
 v_smfmac_f32_16x16x64_f16 v[108:111], v[32:35], a[160:167], v25
 s_waitcnt lgkmcnt(7)
 v_smfmac_f32_16x16x64_f16 v[100:103], v[64:67], a[168:175], v25
 v_smfmac_f32_16x16x64_f16 v[104:107], v[64:67], a[176:183], v25
 v_smfmac_f32_16x16x64_f16 v[108:111], v[64:67], a[184:191], v25
 v_smfmac_f32_16x16x64_f16 v[100:103], v[68:71], a[192:199], v25
 v_smfmac_f32_16x16x64_f16 v[104:107], v[68:71], a[200:207], v25
 v_smfmac_f32_16x16x64_f16 v[108:111], v[68:71], a[208:215], v25
 v_smfmac_f32_16x16x64_f16 v[100:103], v[72:75], a[216:223], v25
 v_smfmac_f32_16x16x64_f16 v[104:107], v[72:75], a[224:231], v25
 v_smfmac_f32_16x16x64_f16 v[108:111], v[72:75], a[232:239], v25
 s_waitcnt lgkmcnt(4)
 v_smfmac_f32_16x16x64_f16 v[100:103], v[76:79], a[240:247], v25
 v_smfmac_f32_16x16x64_f16 v[104:107], v[76:79], a[248:255], v25
 v_smfmac_f32_16x16x64_f16 v[108:111], v[76:79], v[152:159], v25
 v_smfmac_f32_16x16x64_f16 v[100:103], v[80:83], v[160:167], v25
 v_smfmac_f32_16x16x64_f16 v[104:107], v[80:83], v[168:175], v25
 v_smfmac_f32_16x16x64_f16 v[108:111], v[80:83], v[176:183], v25
 v_smfmac_f32_16x16x64_f16 v[100:103], v[84:87], v[184:191], v25
 v_smfmac_f32_16x16x64_f16 v[104:107], v[84:87], v[192:199], v25
 v_smfmac_f32_16x16x64_f16 v[108:111], v[84:87], v[200:207], v25
 s_waitcnt lgkmcnt(0)
 v_smfmac_f32_16x16x64_f16 v[100:103], v[88:91], v[208:215], v25
 v_smfmac_f32_16x16x64_f16 v[104:107], v[88:91], v[216:223], v25
 v_smfmac_f32_16x16x64_f16 v[108:111], v[88:91], v[224:231], v25
 v_smfmac_f32_16x16x64_f16 v[100:103], v[92:95], v[232:239], v25
 v_smfmac_f32_16x16x64_f16 v[104:107], v[92:95], v[240:247], v25
 v_smfmac_f32_16x16x64_f16 v[108:111], v[92:95], v[248:255], v25
 s_nop 7
 v_mov_b32 v76, v108
 v_mov_b32 v77, v109
 v_mov_b32 v78, v110
 v_mov_b32 v79, v111
 v_permlane32_swap_b32 v100, v104
 v_permlane32_swap_b32 v101, v105
 v_permlane32_swap_b32 v102, v106
 v_permlane32_swap_b32 v103, v107
 v_permlane32_swap_b32 v108, v76
 v_permlane32_swap_b32 v109, v77
 v_permlane32_swap_b32 v110, v78
 v_permlane32_swap_b32 v111, v79
 v_pk_add_f32 v[100:101], v[100:101], v[104:105]
 v_pk_add_f32 v[102:103], v[102:103], v[106:107]
 v_pk_add_f32 v[108:109], v[108:109], v[76:77]
 v_pk_add_f32 v[110:111], v[110:111], v[78:79]
 v_cvt_pk_bf16_f32 v80, v100, v101
 v_cvt_pk_bf16_f32 v82, v108, v109
 v_cvt_pk_bf16_f32 v81, v102, v103
 v_cvt_pk_bf16_f32 v83, v110, v111
 s_nop 0
 v_permlane16_swap_b32 v80, v82
 v_permlane16_swap_b32 v81, v83
 v_min_u32 v80, -2, v80
 s_mov_b64 exec, s[76:77]
 buffer_store_dwordx4 v[80:83], v15, s[24:27], s57 offen sc1
 s_mov_b64 exec, -1
 s_branch chain_done
step_68:
 s_and_b32 s21, s52, 3
 s_mul_i32 s81, s21, 540672
 s_mul_i32 s84, s21, 0x88000
 s_and_b32 s84, s84, 0x108000
 s_add_u32 s21, s52, 3
 s_and_b32 s21, s21, 3
 s_mul_i32 s83, s21, 0x88000
 s_and_b32 s83, s83, 0x108000
 s_add_u32 s21, s52, 1
 s_and_b32 s22, s21, 3
 s_mul_i32 s3, s22, 0x88000
 s_and_b32 s3, s3, 0x108000
 s_mul_i32 s80, s21, 393216
 s_add_u32 s46, s21, 1
 s_min_u32 s46, s46, 64
 s_mov_b32 s47, s57
 s_mov_b32 s78, s85
 s_lshr_b32 s21, s52, 1
 s_bitcmp1_b32 s37, s21
 s_cselect_b32 s21, 8192, 0
 s_lshl_b32 s22, s52, 20
 s_or_b32 s22, s22, s21
 s_cmp_ge_u32 s52, 40
 s_cselect_b32 s57, 8192, 0
 s_xor_b32 s57, s57, s22
 s_xor_b32 s85, s22, 8192
 s_bfe_u32 s88, s52, 0x10002
 s_max_u32 s67, s52, 1
 s_sub_u32 s67, s67, 1
 v_mov_b32 v40, 0
 v_mov_b32 v41, 0
 v_mov_b32 v42, 0
 v_mov_b32 v43, 0
 v_mov_b32 v44, 0
 v_mov_b32 v45, 0
 v_mov_b32 v46, 0
 v_mov_b32 v47, 0
 v_mov_b32 v48, 0
 v_mov_b32 v49, 0
 v_mov_b32 v50, 0
 v_mov_b32 v51, 0
 v_mov_b32 v52, 0
 v_mov_b32 v53, 0
 v_mov_b32 v54, 0
 v_mov_b32 v55, 0
 v_mov_b32 v56, 0
 v_mov_b32 v57, 0
 v_mov_b32 v58, 0
 v_mov_b32 v59, 0
 v_mov_b32 v60, 0
 v_mov_b32 v61, 0
 v_mov_b32 v62, 0
 v_mov_b32 v63, 0
 v_mov_b32 v100, 0
 v_mov_b32 v101, 0
 v_mov_b32 v102, 0
 v_mov_b32 v103, 0
 v_mov_b32 v104, 0
 v_mov_b32 v105, 0
 v_mov_b32 v106, 0
 v_mov_b32 v107, 0
 v_mov_b32 v108, 0
 v_mov_b32 v109, 0
 v_mov_b32 v110, 0
 v_mov_b32 v111, 0
 s_sleep 5
 s_nop 3
 v_readfirstlane_b32 s21, v0
 s_cmp_lt_u32 s21, s46
 s_cselect_b32 s55, s55, 0
 s_cmp_lt_i32 s55, 0
 s_cbranch_scc1 fl_73
fl_74:
 s_mov_b32 s54, 0
 buffer_load_dwordx4 v[36:39], v4, s[4:7], s84 offen offset:2048 sc1
 buffer_load_dwordx4 v[28:31], v4, s[4:7], s84 offen offset:0 sc1
 buffer_load_dwordx4 v[32:35], v4, s[4:7], s84 offen offset:1024 sc1
 s_waitcnt vmcnt(3)
 v_mov_b32 v126, v88
 v_mov_b32 v127, v89
 v_mov_b32 v128, v90
 v_mov_b32 v129, v91
 v_mov_b32 v130, v92
 v_mov_b32 v131, v93
 v_mov_b32 v132, v94
 v_mov_b32 v133, v95
 v_mov_b32 v134, v96
 v_mov_b32 v135, v97
 v_mov_b32 v136, v98
 v_mov_b32 v137, v99
 s_waitcnt vmcnt(2)
 v_smfmac_f32_16x16x32_f16 v[40:43], v[36:37], a[16:19], v25
 v_smfmac_f32_16x16x32_f16 v[52:55], v[36:37], a[76:79], v25
 v_smfmac_f32_16x16x32_f16 v[44:47], v[36:37], a[36:39], v25
 s_waitcnt vmcnt(0)
 v_bitop3_b32 v27, v31, v35, v39 bitop3:0x80
 v_perm_b32 v31, v35, v31, s89
 v_cmp_gt_u32 vcc, 0x48000000, v27
 v_mov_b32 v35, v38
 v_smfmac_f32_16x16x32_f16 v[56:59], v[36:37], a[96:99], v25
 s_cbranch_vccnz pm_71
A2_72:
 v_smfmac_f32_16x16x64_f16 v[40:43], v[28:31], a[0:7], v25
 ds_write_b128 v10, v[28:31]
 v_smfmac_f32_16x16x64_f16 v[40:43], v[32:35], a[8:15], v25
 ds_write_b128 v10, v[32:35] offset:1024
 v_smfmac_f32_16x16x64_f16 v[52:55], v[28:31], a[60:67], v25
 ds_write_b64 v10, v[36:37] offset:2048
 v_smfmac_f32_16x16x64_f16 v[52:55], v[32:35], a[68:75], v25
 v_cvt_pk_f16_f32 v40, v40, v41
 v_cvt_pk_f16_f32 v41, v42, v43
 v_smfmac_f32_16x16x32_f16 v[48:51], v[36:37], a[56:59], v25
 v_smfmac_f32_16x16x32_f16 v[60:63], v[36:37], a[116:119], v25
 v_smfmac_f32_16x16x64_f16 v[44:47], v[28:31], a[20:27], v25
 v_cvt_pk_f16_f32 v52, v52, v53
 v_cvt_pk_f16_f32 v53, v54, v55
 s_nop 0
 v_smfmac_f32_16x16x64_f16 v[44:47], v[32:35], a[28:35], v25
 v_permlane32_swap_b32 v40, v52
 v_smfmac_f32_16x16x64_f16 v[56:59], v[28:31], a[80:87], v25
 v_permlane32_swap_b32 v41, v53
 v_pk_add_f16 v40, v40, v52
 v_smfmac_f32_16x16x64_f16 v[56:59], v[32:35], a[88:95], v25
 v_pk_add_f16 v41, v41, v53
 v_smfmac_f32_16x16x64_f16 v[48:51], v[28:31], a[40:47], v25
 ds_write_b64 v5, v[40:41] offset:0
 v_smfmac_f32_16x16x64_f16 v[48:51], v[32:35], a[48:55], v25
 v_cvt_pk_f16_f32 v44, v44, v45
 v_cvt_pk_f16_f32 v45, v46, v47
 v_cvt_pk_f16_f32 v56, v56, v57
 v_smfmac_f32_16x16x64_f16 v[60:63], v[28:31], a[100:107], v25
 v_cvt_pk_f16_f32 v57, v58, v59
 s_nop 0
 v_smfmac_f32_16x16x64_f16 v[60:63], v[32:35], a[108:115], v25
 v_permlane32_swap_b32 v44, v56
 v_permlane32_swap_b32 v45, v57
 v_pk_add_f16 v44, v44, v56
 v_pk_add_f16 v45, v45, v57
 ds_write_b64 v5, v[44:45] offset:640
 v_cvt_pk_f16_f32 v48, v48, v49
 v_cvt_pk_f16_f32 v49, v50, v51
 v_cvt_pk_f16_f32 v60, v60, v61
 v_cvt_pk_f16_f32 v61, v62, v63
 s_nop 0
 v_permlane32_swap_b32 v48, v60
 v_permlane32_swap_b32 v49, v61
 v_pk_add_f16 v48, v48, v60
 v_pk_add_f16 v49, v49, v61
 ds_write_b64 v5, v[48:49] offset:1280
 s_waitcnt lgkmcnt(0) vmcnt(0)
 s_barrier
 ds_read_b128 v[28:31], v16 offset:24576
 ds_read_b128 v[32:35], v16 offset:25600
 ds_read_b128 v[64:67], v16 offset:27648
 ds_read_b128 v[68:71], v16 offset:28672
 ds_read_b128 v[72:75], v16 offset:30720
 ds_read_b128 v[76:79], v16 offset:31744
 ds_read_b128 v[80:83], v16 offset:33792
 ds_read_b128 v[84:87], v16 offset:34816
 ds_read_b64 v[88:89], v16 offset:26624
 ds_read_b64 v[90:91], v16 offset:29696
 ds_read_b64 v[92:93], v16 offset:32768
 ds_read_b64 v[94:95], v16 offset:35840
 s_cmp_eq_u32 s52, 63
 s_cbranch_scc1 last_69
 s_waitcnt lgkmcnt(10)
 v_smfmac_f32_16x16x64_f16 v[100:103], v[28:31], a[120:127], v25
 v_smfmac_f32_16x16x64_f16 v[104:107], v[28:31], a[128:135], v25
 v_smfmac_f32_16x16x64_f16 v[108:111], v[28:31], a[136:143], v25
 s_mov_b32 s54, 0
 v_smfmac_f32_16x16x64_f16 v[100:103], v[32:35], a[144:151], v25
 v_readfirstlane_b32 s21, v0
 v_smfmac_f32_16x16x64_f16 v[104:107], v[32:35], a[152:159], v25
 s_add_u32 s22, s46, 3
 v_smfmac_f32_16x16x64_f16 v[108:111], v[32:35], a[160:167], v25
 s_min_u32 s22, s22, 64
 s_waitcnt lgkmcnt(7)
 v_smfmac_f32_16x16x64_f16 v[100:103], v[64:67], a[168:175], v25
 s_sub_u32 s55, s21, s22
 v_smfmac_f32_16x16x64_f16 v[104:107], v[64:67], a[176:183], v25
 s_sub_u32 s56, s21, s46
 v_smfmac_f32_16x16x64_f16 v[108:111], v[64:67], a[184:191], v25
 v_smfmac_f32_16x16x64_f16 v[100:103], v[68:71], a[192:199], v25
 v_smfmac_f32_16x16x64_f16 v[104:107], v[68:71], a[200:207], v25
 v_smfmac_f32_16x16x64_f16 v[108:111], v[68:71], a[208:215], v25
 v_smfmac_f32_16x16x64_f16 v[100:103], v[72:75], a[216:223], v25
 v_smfmac_f32_16x16x64_f16 v[104:107], v[72:75], a[224:231], v25
 v_smfmac_f32_16x16x64_f16 v[108:111], v[72:75], a[232:239], v25
 s_waitcnt lgkmcnt(4)
 v_smfmac_f32_16x16x64_f16 v[100:103], v[76:79], a[240:247], v25
 v_smfmac_f32_16x16x64_f16 v[104:107], v[76:79], a[248:255], v25
 v_smfmac_f32_16x16x64_f16 v[108:111], v[76:79], v[152:159], v25
 v_smfmac_f32_16x16x64_f16 v[100:103], v[80:83], v[160:167], v25
 v_smfmac_f32_16x16x64_f16 v[104:107], v[80:83], v[168:175], v25
 v_smfmac_f32_16x16x64_f16 v[108:111], v[80:83], v[176:183], v25
 v_smfmac_f32_16x16x64_f16 v[100:103], v[84:87], v[184:191], v25
 v_smfmac_f32_16x16x64_f16 v[104:107], v[84:87], v[192:199], v25
 v_smfmac_f32_16x16x64_f16 v[108:111], v[84:87], v[200:207], v25
 s_waitcnt lgkmcnt(0)
 v_smfmac_f32_16x16x64_f16 v[100:103], v[88:91], v[208:215], v25
 v_smfmac_f32_16x16x64_f16 v[104:107], v[88:91], v[216:223], v25
 v_smfmac_f32_16x16x64_f16 v[108:111], v[88:91], v[224:231], v25
 v_smfmac_f32_16x16x64_f16 v[100:103], v[92:95], v[232:239], v25
 v_smfmac_f32_16x16x64_f16 v[104:107], v[92:95], v[240:247], v25
 v_smfmac_f32_16x16x64_f16 v[108:111], v[92:95], v[248:255], v25
 s_sleep 1
 s_nop 11
 buffer_load_dwordx2 v[58:59], v9, s[8:11], s81 offen sc1
 buffer_load_dwordx4 v[40:43], v8, s[8:11], s81 offen offset:0 sc1
 buffer_load_dwordx4 v[44:47], v8, s[8:11], s81 offen offset:1024 sc1
 s_cmp_lt_i32 s56, 0
 s_cbranch_scc1 kvw_77
kvok_78:
 s_waitcnt vmcnt(2)
 v_xor_b32 v76, s88, v58
 s_nop 0
 v_permlane16_swap_b32 v58, v59
 v_fma_mix_f32 v60, v58, 1.0, v59 op_sel:[0,0,0] op_sel_hi:[1,0,1]
 v_fma_mix_f32 v61, v58, 1.0, v59 op_sel:[1,0,1] op_sel_hi:[1,0,1]
 v_mov_b32 v58, v60
 v_mov_b32 v59, v61
 s_nop 0
 v_permlane32_swap_b32 v58, v60
 v_permlane32_swap_b32 v59, v61
 v_add_f32 v52, v58, v60
 v_add_f32 v53, v59, v61
 v_max_f32 v79, v52, v53
 s_waitcnt vmcnt(0)
 v_pk_add_f16 v80, v40, v44
 v_pk_add_f16 v82, v42, v46
 v_pk_add_f16 v81, v41, v45
 v_pk_add_f16 v83, v43, v47
 v_permlane32_swap_b32 v80, v82
 v_bitop3_b32 v77, v40, v42, s88 bitop3:0x7e
 v_permlane32_swap_b32 v81, v83
 v_bitop3_b32 v78, v44, v46, s88 bitop3:0x7e
 v_fma_mix_f32 v48, v80, 1.0, v82 op_sel:[0,0,0] op_sel_hi:[1,0,1]
 v_or3_b32 v27, v76, v77, v78
 v_fma_mix_f32 v49, v80, 1.0, v82 op_sel:[1,0,1] op_sel_hi:[1,0,1]
 v_and_b32 v27, 1, v27
 v_fma_mix_f32 v50, v81, 1.0, v83 op_sel:[0,0,0] op_sel_hi:[1,0,1]
 v_cmp_ne_u32 vcc, 0, v27
 v_fma_mix_f32 v51, v81, 1.0, v83 op_sel:[1,0,1] op_sel_hi:[1,0,1]
 v_max3_f32 v62, v48, v49, v79
 s_cbranch_vccnz psr_75
psj_76:
 v_max3_f32 v62, v62, v50, v51
 v_cvt_pk_bf16_f32 v146, v100, v101
 v_cvt_pk_bf16_f32 v147, v102, v103
 v_max_f32_dpp v62, v62, v62 row_ror:8 row_mask:0xf bank_mask:0xf
 v_mov_b32 v63, v62
 v_cvt_pk_bf16_f32 v148, v104, v105
 v_cvt_pk_bf16_f32 v149, v106, v107
 v_permlane32_swap_b32 v62, v63
 v_max_f32 v62, v62, v63
 v_mov_b32 v63, v62
 v_cvt_pk_bf16_f32 v150, v108, v109
 v_cvt_pk_bf16_f32 v151, v110, v111
 v_permlane16_swap_b32 v62, v63
 v_max_f32 v62, v62, v63
 v_mul_f32 v62, s86, v62
 v_fma_f32 v48, v48, s86, -v62
 v_fma_f32 v49, v49, s86, -v62
 v_fma_f32 v50, v50, s86, -v62
 v_fma_f32 v51, v51, s86, -v62
 v_fma_f32 v52, v52, s86, -v62
 v_fma_f32 v53, v53, s86, -v62
 v_exp_f32 v48, v48
 v_exp_f32 v49, v49
 buffer_load_dwordx4 v[88:91], v17, s[28:31], s64 offen offset:0 sc1
 v_exp_f32 v50, v50
 v_exp_f32 v51, v51
 buffer_load_dwordx4 v[92:95], v16, s[28:31], s64 offen offset:1024 sc1
 v_exp_f32 v52, v52
 v_exp_f32 v53, v53
 buffer_load_dwordx4 v[96:99], v20, s[28:31], s64 offen offset:2048 sc1
 v_cvt_pk_bf16_f32 v138, v48, v49
 v_cvt_pk_bf16_f32 v139, v50, v51
 v_cvt_pk_bf16_f32 v142, v52, v53
 v_mov_b32_dpp v140, v138 row_ror:8 row_mask:0xf bank_mask:0xf
 v_mov_b32_dpp v141, v139 row_ror:8 row_mask:0xf bank_mask:0xf
 v_mov_b32_dpp v143, v142 row_ror:8 row_mask:0xf bank_mask:0xf
 v_mov_b32 v84, s67
 v_mov_b32 v85, s67
 s_mov_b64 exec, 15
 buffer_store_dwordx2 v[84:85], v24, s[12:15], s66 offen sc1
 s_mov_b64 exec, -1
 v_add_f32 v54, v48, v49
 v_mfma_f32_16x16x32_bf16 v[64:67], v[126:129], v[138:141], 0
 v_add_f32 v55, v50, v51
 v_add_f32 v56, v52, v53
 v_mfma_f32_16x16x32_bf16 v[64:67], v[146:149], v[142:145], v[64:67]
 v_add_f32 v62, v54, v55
 v_fmac_f32 v62, v56, v26
 v_mfma_f32_16x16x32_bf16 v[68:71], v[130:133], v[138:141], 0
 s_nop 0
 v_add_f32_dpp v62, v62, v62 row_ror:8 row_mask:0xf bank_mask:0xf
 v_mfma_f32_16x16x32_bf16 v[68:71], v[148:151], v[142:145], v[68:71]
 v_mov_b32 v63, v62
 s_cmp_lt_i32 s55, 0
 s_cbranch_scc1 fl_79
fl_80:
 v_mfma_f32_16x16x32_bf16 v[72:75], v[134:137], v[138:141], 0
 v_permlane32_swap_b32 v62, v63
 v_mfma_f32_16x16x32_bf16 v[72:75], v[150:153], v[142:145], v[72:75]
 v_add_f32 v62, v62, v63
 v_mov_b32 v63, v62
 ds_write_b128 v11, v[64:67] offset:0
 s_nop 0
 v_permlane16_swap_b32 v62, v63
 v_add_f32 v62, v62, v63
 v_rcp_f32 v62, v62
 ds_write_b128 v11, v[68:71] offset:1024
 s_mov_b64 exec, 0xff
 ds_write_b32 v22, v62
 s_mov_b64 exec, -1
 ds_write_b128 v11, v[72:75] offset:2048
 s_waitcnt lgkmcnt(0)
 s_barrier
 s_and_b32 s21, s52, 7
 s_cmp_lg_u32 s21, s50
 s_cbranch_scc1 zm_81
 v_mov_b32 v64, 0
 v_mov_b32 v65, 0
 v_mov_b32 v66, 0
 v_mov_b32 v67, 0
 s_mov_b64 exec, s[70:71]
 buffer_store_dwordx4 v[64:67], v13, s[4:7], s83 offen sc1
 s_mov_b64 exec, -1
zm_81:
 v_mov_b32 v76, v108
 v_mov_b32 v77, v109
 v_mov_b32 v78, v110
 v_mov_b32 v79, v111
 v_permlane32_swap_b32 v100, v104
 v_permlane32_swap_b32 v101, v105
 v_permlane32_swap_b32 v102, v106
 v_permlane32_swap_b32 v103, v107
 v_permlane32_swap_b32 v108, v76
 v_permlane32_swap_b32 v109, v77
 v_permlane32_swap_b32 v110, v78
 v_permlane32_swap_b32 v111, v79
 v_pk_add_f32 v[100:101], v[100:101], v[104:105]
 v_pk_add_f32 v[102:103], v[102:103], v[106:107]
 v_pk_add_f32 v[108:109], v[108:109], v[76:77]
 v_pk_add_f32 v[110:111], v[110:111], v[78:79]
 v_cvt_pk_bf16_f32 v80, v100, v101
 v_cvt_pk_bf16_f32 v82, v108, v109
 v_cvt_pk_bf16_f32 v81, v102, v103
 v_cvt_pk_bf16_f32 v83, v110, v111
 s_nop 0
 v_permlane16_swap_b32 v80, v82
 v_permlane16_swap_b32 v81, v83
 v_min_u32 v80, -2, v80
 s_mov_b64 exec, s[76:77]
 buffer_store_dwordx4 v[80:83], v15, s[24:27], s57 offen sc1
 s_mov_b64 exec, -1
 s_add_u32 s64, s64, 1310720
 s_add_u32 s52, s52, 1
 s_branch step_68
fl_73:
 buffer_load_dword v0, off, s[12:15], s79 sc1
 s_branch fl_74
A1_18:
 v_smfmac_f32_16x16x32_f16 v[40:43], v[36:37], a[16:19], v25
 v_smfmac_f32_16x16x32_f16 v[52:55], v[36:37], a[76:79], v25
 v_smfmac_f32_16x16x32_f16 v[44:47], v[36:37], a[36:39], v25
 v_smfmac_f32_16x16x32_f16 v[56:59], v[36:37], a[96:99], v25
 s_branch A2_72
pm_71:
 buffer_load_dwordx4 v[36:39], v4, s[4:7], s84 offen offset:2048 sc1
 buffer_load_dwordx4 v[28:31], v4, s[4:7], s84 offen offset:0 sc1
 buffer_load_dwordx4 v[32:35], v4, s[4:7], s84 offen offset:1024 sc1
 s_nop 7
 v_mov_b32 v40, 0
 v_mov_b32 v41, 0
 v_mov_b32 v42, 0
 v_mov_b32 v43, 0
 v_mov_b32 v52, 0
 v_mov_b32 v53, 0
 v_mov_b32 v54, 0
 v_mov_b32 v55, 0
 v_mov_b32 v44, 0
 v_mov_b32 v45, 0
 v_mov_b32 v46, 0
 v_mov_b32 v47, 0
 v_mov_b32 v56, 0
 v_mov_b32 v57, 0
 v_mov_b32 v58, 0
 v_mov_b32 v59, 0
 s_waitcnt vmcnt(0)
 v_bitop3_b32 v27, v31, v35, v39 bitop3:0x80
 v_perm_b32 v31, v35, v31, s89
 v_cmp_gt_u32 vcc, 0x48000000, v27
 v_mov_b32 v35, v38
 s_cbranch_vccz A1_18
pm_70:
 s_cmp_gt_u32 s52, 3
 s_cbranch_scc1 op_82
 v_readfirstlane_b32 s21, v0
 s_cmp_ge_u32 s21, s46
 s_cbranch_scc1 op_82
 buffer_load_dword v0, off, s[12:15], s79 sc1
 s_waitcnt vmcnt(0)
 v_readfirstlane_b32 s21, v0
 s_cmp_gt_u32 s21, s52
 s_cselect_b32 s21, s87, 0
 s_cmp_eq_u32 s21, 0
 s_cbranch_scc1 op_82
 s_mov_b32 s87, 0
 s_sub_u32 s21, s64, 1310720
 buffer_load_dwordx4 v[126:129], v16, s[28:31], s21 offen offset:0 sc1
 buffer_load_dwordx4 v[130:133], v16, s[28:31], s21 offen offset:1024 sc1
 buffer_load_dwordx4 v[134:137], v16, s[28:31], s21 offen offset:2048 sc1
op_82:
 buffer_load_dwordx4 v[36:39], v4, s[4:7], s84 offen offset:2048 sc1
 buffer_load_dwordx4 v[28:31], v4, s[4:7], s84 offen offset:0 sc1
 buffer_load_dwordx4 v[32:35], v4, s[4:7], s84 offen offset:1024 sc1
 s_add_u32 s54, s54, 1
 s_cmp_gt_u32 s54, 131072
 s_cbranch_scc1 end0
 s_waitcnt vmcnt(0)
 v_bitop3_b32 v27, v31, v35, v39 bitop3:0x80
 v_perm_b32 v31, v35, v31, s89
 v_cmp_gt_u32 vcc, 0x48000000, v27
 v_mov_b32 v35, v38
 s_cbranch_vccnz pm_70
 s_branch A1_18
psr_75:
 buffer_load_dwordx2 v[58:59], v9, s[8:11], s81 offen sc1
 buffer_load_dwordx4 v[40:43], v8, s[8:11], s81 offen offset:0 sc1
 buffer_load_dwordx4 v[44:47], v8, s[8:11], s81 offen offset:1024 sc1
 s_add_u32 s54, s54, 1
 s_cmp_gt_u32 s54, 131072
 s_cbranch_scc1 end0
 s_waitcnt vmcnt(2)
 v_xor_b32 v76, s88, v58
 s_nop 0
 v_permlane16_swap_b32 v58, v59
 v_fma_mix_f32 v60, v58, 1.0, v59 op_sel:[0,0,0] op_sel_hi:[1,0,1]
 v_fma_mix_f32 v61, v58, 1.0, v59 op_sel:[1,0,1] op_sel_hi:[1,0,1]
 v_mov_b32 v58, v60
 v_mov_b32 v59, v61
 s_nop 0
 v_permlane32_swap_b32 v58, v60
 v_permlane32_swap_b32 v59, v61
 v_add_f32 v52, v58, v60
 v_add_f32 v53, v59, v61
 v_max_f32 v79, v52, v53
 s_waitcnt vmcnt(0)
 v_pk_add_f16 v80, v40, v44
 v_pk_add_f16 v82, v42, v46
 v_pk_add_f16 v81, v41, v45
 v_pk_add_f16 v83, v43, v47
 v_permlane32_swap_b32 v80, v82
 v_bitop3_b32 v77, v40, v42, s88 bitop3:0x7e
 v_permlane32_swap_b32 v81, v83
 v_bitop3_b32 v78, v44, v46, s88 bitop3:0x7e
 v_fma_mix_f32 v48, v80, 1.0, v82 op_sel:[0,0,0] op_sel_hi:[1,0,1]
 v_or3_b32 v27, v76, v77, v78
 v_fma_mix_f32 v49, v80, 1.0, v82 op_sel:[1,0,1] op_sel_hi:[1,0,1]
 v_and_b32 v27, 1, v27
 v_fma_mix_f32 v50, v81, 1.0, v83 op_sel:[0,0,0] op_sel_hi:[1,0,1]
 v_cmp_ne_u32 vcc, 0, v27
 v_fma_mix_f32 v51, v81, 1.0, v83 op_sel:[1,0,1] op_sel_hi:[1,0,1]
 v_max3_f32 v62, v48, v49, v79
 s_cbranch_vccnz psr_75
 s_branch psj_76
kvw_77:
 s_mov_b32 s22, s87
 s_cmp_eq_u32 s52, 0
 s_cselect_b32 s55, 0, s55
 s_cselect_b32 s87, 1, 0
 s_cbranch_scc1 kvok_78
 v_mov_b32 v62, 0
 s_mov_b32 s101, 0
wf_83:
 buffer_load_dword v63, v62, s[12:15], s79 offen sc1
 s_add_u32 s101, s101, 1
 s_cmp_gt_u32 s101, 131072
 s_cbranch_scc1 end0
 s_waitcnt vmcnt(0)
 v_readfirstlane_b32 s100, v63
 s_cmp_ge_u32 s100, s46
 s_cbranch_scc1 wf_84
 s_sleep 3
 s_branch wf_83
wf_84:
 s_cmp_eq_u32 s22, 0
 s_cbranch_scc1 kvok_78
 s_sub_u32 s21, s64, 1310720
 buffer_load_dwordx4 v[126:129], v16, s[28:31], s21 offen offset:0 sc1
 buffer_load_dwordx4 v[130:133], v16, s[28:31], s21 offen offset:1024 sc1
 buffer_load_dwordx4 v[134:137], v16, s[28:31], s21 offen offset:2048 sc1
 s_waitcnt vmcnt(0)
 s_branch kvok_78
fl_79:
 buffer_load_dword v0, off, s[12:15], s79 sc1
 s_branch fl_80
last_69:
 s_waitcnt lgkmcnt(10)
 v_smfmac_f32_16x16x64_f16 v[100:103], v[28:31], a[120:127], v25
 v_smfmac_f32_16x16x64_f16 v[104:107], v[28:31], a[128:135], v25
 v_smfmac_f32_16x16x64_f16 v[108:111], v[28:31], a[136:143], v25
 v_smfmac_f32_16x16x64_f16 v[100:103], v[32:35], a[144:151], v25
 v_smfmac_f32_16x16x64_f16 v[104:107], v[32:35], a[152:159], v25
 v_smfmac_f32_16x16x64_f16 v[108:111], v[32:35], a[160:167], v25
 s_waitcnt lgkmcnt(7)
 v_smfmac_f32_16x16x64_f16 v[100:103], v[64:67], a[168:175], v25
 v_smfmac_f32_16x16x64_f16 v[104:107], v[64:67], a[176:183], v25
 v_smfmac_f32_16x16x64_f16 v[108:111], v[64:67], a[184:191], v25
 v_smfmac_f32_16x16x64_f16 v[100:103], v[68:71], a[192:199], v25
 v_smfmac_f32_16x16x64_f16 v[104:107], v[68:71], a[200:207], v25
 v_smfmac_f32_16x16x64_f16 v[108:111], v[68:71], a[208:215], v25
 v_smfmac_f32_16x16x64_f16 v[100:103], v[72:75], a[216:223], v25
 v_smfmac_f32_16x16x64_f16 v[104:107], v[72:75], a[224:231], v25
 v_smfmac_f32_16x16x64_f16 v[108:111], v[72:75], a[232:239], v25
 s_waitcnt lgkmcnt(4)
 v_smfmac_f32_16x16x64_f16 v[100:103], v[76:79], a[240:247], v25
 v_smfmac_f32_16x16x64_f16 v[104:107], v[76:79], a[248:255], v25
 v_smfmac_f32_16x16x64_f16 v[108:111], v[76:79], v[152:159], v25
 v_smfmac_f32_16x16x64_f16 v[100:103], v[80:83], v[160:167], v25
 v_smfmac_f32_16x16x64_f16 v[104:107], v[80:83], v[168:175], v25
 v_smfmac_f32_16x16x64_f16 v[108:111], v[80:83], v[176:183], v25
 v_smfmac_f32_16x16x64_f16 v[100:103], v[84:87], v[184:191], v25
 v_smfmac_f32_16x16x64_f16 v[104:107], v[84:87], v[192:199], v25
 v_smfmac_f32_16x16x64_f16 v[108:111], v[84:87], v[200:207], v25
 s_waitcnt lgkmcnt(0)
 v_smfmac_f32_16x16x64_f16 v[100:103], v[88:91], v[208:215], v25
 v_smfmac_f32_16x16x64_f16 v[104:107], v[88:91], v[216:223], v25
 v_smfmac_f32_16x16x64_f16 v[108:111], v[88:91], v[224:231], v25
 v_smfmac_f32_16x16x64_f16 v[100:103], v[92:95], v[232:239], v25
 v_smfmac_f32_16x16x64_f16 v[104:107], v[92:95], v[240:247], v25
 v_smfmac_f32_16x16x64_f16 v[108:111], v[92:95], v[248:255], v25
 s_nop 7
 v_mov_b32 v76, v108
 v_mov_b32 v77, v109
 v_mov_b32 v78, v110
 v_mov_b32 v79, v111
 v_permlane32_swap_b32 v100, v104
 v_permlane32_swap_b32 v101, v105
 v_permlane32_swap_b32 v102, v106
 v_permlane32_swap_b32 v103, v107
 v_permlane32_swap_b32 v108, v76
 v_permlane32_swap_b32 v109, v77
 v_permlane32_swap_b32 v110, v78
 v_permlane32_swap_b32 v111, v79
 v_pk_add_f32 v[100:101], v[100:101], v[104:105]
 v_pk_add_f32 v[102:103], v[102:103], v[106:107]
 v_pk_add_f32 v[108:109], v[108:109], v[76:77]
 v_pk_add_f32 v[110:111], v[110:111], v[78:79]
 v_cvt_pk_bf16_f32 v80, v100, v101
 v_cvt_pk_bf16_f32 v82, v108, v109
 v_cvt_pk_bf16_f32 v81, v102, v103
 v_cvt_pk_bf16_f32 v83, v110, v111
 s_nop 0
 v_permlane16_swap_b32 v80, v82
 v_permlane16_swap_b32 v81, v83
 v_min_u32 v80, -2, v80
 s_mov_b64 exec, s[76:77]
 buffer_store_dwordx4 v[80:83], v15, s[24:27], s57 offen sc1
 s_mov_b64 exec, -1
 s_branch chain_done
step_85:
 s_and_b32 s21, s52, 3
 s_mul_i32 s81, s21, 540672
 s_mul_i32 s84, s21, 0x88000
 s_and_b32 s84, s84, 0x108000
 s_add_u32 s21, s52, 3
 s_and_b32 s21, s21, 3
 s_mul_i32 s83, s21, 0x88000
 s_and_b32 s83, s83, 0x108000
 s_add_u32 s21, s52, 1
 s_and_b32 s22, s21, 3
 s_mul_i32 s3, s22, 0x88000
 s_and_b32 s3, s3, 0x108000
 s_mul_i32 s80, s21, 393216
 s_add_u32 s46, s21, 1
 s_min_u32 s46, s46, 64
 s_mov_b32 s47, s57
 s_mov_b32 s78, s85
 s_lshr_b32 s21, s52, 1
 s_bitcmp1_b32 s37, s21
 s_cselect_b32 s21, 8192, 0
 s_lshl_b32 s22, s52, 20
 s_or_b32 s22, s22, s21
 s_cmp_ge_u32 s52, 40
 s_cselect_b32 s57, 8192, 0
 s_xor_b32 s57, s57, s22
 s_xor_b32 s85, s22, 8192
 s_bfe_u32 s88, s52, 0x10002
 s_max_u32 s67, s52, 1
 s_sub_u32 s67, s67, 1
 v_mov_b32 v40, 0
 v_mov_b32 v41, 0
 v_mov_b32 v42, 0
 v_mov_b32 v43, 0
 v_mov_b32 v44, 0
 v_mov_b32 v45, 0
 v_mov_b32 v46, 0
 v_mov_b32 v47, 0
 v_mov_b32 v48, 0
 v_mov_b32 v49, 0
 v_mov_b32 v50, 0
 v_mov_b32 v51, 0
 v_mov_b32 v52, 0
 v_mov_b32 v53, 0
 v_mov_b32 v54, 0
 v_mov_b32 v55, 0
 v_mov_b32 v56, 0
 v_mov_b32 v57, 0
 v_mov_b32 v58, 0
 v_mov_b32 v59, 0
 v_mov_b32 v60, 0
 v_mov_b32 v61, 0
 v_mov_b32 v62, 0
 v_mov_b32 v63, 0
 v_mov_b32 v100, 0
 v_mov_b32 v101, 0
 v_mov_b32 v102, 0
 v_mov_b32 v103, 0
 v_mov_b32 v104, 0
 v_mov_b32 v105, 0
 v_mov_b32 v106, 0
 v_mov_b32 v107, 0
 v_mov_b32 v108, 0
 v_mov_b32 v109, 0
 v_mov_b32 v110, 0
 v_mov_b32 v111, 0
 s_sleep 8
 v_readfirstlane_b32 s21, v0
 s_cmp_lt_u32 s21, s46
 s_cselect_b32 s55, s55, 0
 s_cmp_lt_i32 s55, 0
 s_cbranch_scc1 fl_90
fl_91:
 s_mov_b32 s54, 0
 buffer_load_dwordx4 v[36:39], v4, s[4:7], s84 offen offset:2048 sc1
 buffer_load_dwordx4 v[28:31], v4, s[4:7], s84 offen offset:0 sc1
 buffer_load_dwordx4 v[32:35], v4, s[4:7], s84 offen offset:1024 sc1
 s_waitcnt vmcnt(3)
 v_mov_b32 v126, v88
 v_mov_b32 v127, v89
 v_mov_b32 v128, v90
 v_mov_b32 v129, v91
 v_mov_b32 v130, v92
 v_mov_b32 v131, v93
 v_mov_b32 v132, v94
 v_mov_b32 v133, v95
 v_mov_b32 v134, v96
 v_mov_b32 v135, v97
 v_mov_b32 v136, v98
 v_mov_b32 v137, v99
 s_waitcnt vmcnt(2)
 v_smfmac_f32_16x16x32_f16 v[40:43], v[36:37], a[16:19], v25
 v_smfmac_f32_16x16x32_f16 v[52:55], v[36:37], a[76:79], v25
 v_smfmac_f32_16x16x32_f16 v[44:47], v[36:37], a[36:39], v25
 s_waitcnt vmcnt(0)
 v_bitop3_b32 v27, v31, v35, v39 bitop3:0x80
 v_perm_b32 v31, v35, v31, s89
 v_cmp_gt_u32 vcc, 0x48000000, v27
 v_mov_b32 v35, v38
 v_smfmac_f32_16x16x32_f16 v[56:59], v[36:37], a[96:99], v25
 s_cbranch_vccnz pm_88
A2_89:
 v_smfmac_f32_16x16x64_f16 v[40:43], v[28:31], a[0:7], v25
 ds_write_b128 v10, v[28:31]
 v_smfmac_f32_16x16x64_f16 v[40:43], v[32:35], a[8:15], v25
 ds_write_b128 v10, v[32:35] offset:1024
 v_smfmac_f32_16x16x64_f16 v[52:55], v[28:31], a[60:67], v25
 ds_write_b64 v10, v[36:37] offset:2048
 v_smfmac_f32_16x16x64_f16 v[52:55], v[32:35], a[68:75], v25
 v_cvt_pk_f16_f32 v40, v40, v41
 v_cvt_pk_f16_f32 v41, v42, v43
 v_smfmac_f32_16x16x32_f16 v[48:51], v[36:37], a[56:59], v25
 v_smfmac_f32_16x16x32_f16 v[60:63], v[36:37], a[116:119], v25
 v_smfmac_f32_16x16x64_f16 v[44:47], v[28:31], a[20:27], v25
 v_cvt_pk_f16_f32 v52, v52, v53
 v_cvt_pk_f16_f32 v53, v54, v55
 s_nop 0
 v_smfmac_f32_16x16x64_f16 v[44:47], v[32:35], a[28:35], v25
 v_permlane32_swap_b32 v40, v52
 v_smfmac_f32_16x16x64_f16 v[56:59], v[28:31], a[80:87], v25
 v_permlane32_swap_b32 v41, v53
 v_pk_add_f16 v40, v40, v52
 v_smfmac_f32_16x16x64_f16 v[56:59], v[32:35], a[88:95], v25
 v_pk_add_f16 v41, v41, v53
 v_smfmac_f32_16x16x64_f16 v[48:51], v[28:31], a[40:47], v25
 ds_write_b64 v5, v[40:41] offset:0
 v_smfmac_f32_16x16x64_f16 v[48:51], v[32:35], a[48:55], v25
 v_cvt_pk_f16_f32 v44, v44, v45
 v_cvt_pk_f16_f32 v45, v46, v47
 v_cvt_pk_f16_f32 v56, v56, v57
 v_smfmac_f32_16x16x64_f16 v[60:63], v[28:31], a[100:107], v25
 v_cvt_pk_f16_f32 v57, v58, v59
 s_nop 0
 v_smfmac_f32_16x16x64_f16 v[60:63], v[32:35], a[108:115], v25
 v_permlane32_swap_b32 v44, v56
 v_permlane32_swap_b32 v45, v57
 v_pk_add_f16 v44, v44, v56
 v_pk_add_f16 v45, v45, v57
 ds_write_b64 v5, v[44:45] offset:640
 v_cvt_pk_f16_f32 v48, v48, v49
 v_cvt_pk_f16_f32 v49, v50, v51
 v_cvt_pk_f16_f32 v60, v60, v61
 v_cvt_pk_f16_f32 v61, v62, v63
 s_nop 0
 v_permlane32_swap_b32 v48, v60
 v_permlane32_swap_b32 v49, v61
 v_pk_add_f16 v48, v48, v60
 v_pk_add_f16 v49, v49, v61
 ds_write_b64 v5, v[48:49] offset:1280
 s_waitcnt lgkmcnt(0) vmcnt(0)
 s_barrier
 s_lshr_b32 s21, 3, s20
 s_bitcmp1_b32 s21, 0
 s_cbranch_scc0 bw_93
 ds_read_b64_tr_b16 v[40:41], v21 offset:0
 ds_read_b64_tr_b16 v[42:43], v21 offset:1920
 ds_read_b64_tr_b16 v[44:45], v21 offset:640
 ds_read_b64_tr_b16 v[46:47], v21 offset:2560
 ds_read_b64_tr_b16 v[48:49], v21 offset:1280
 ds_read_b64_tr_b16 v[50:51], v21 offset:3200
 s_waitcnt lgkmcnt(4)
 v_fma_mix_f32 v52, v40, 1.0, v42 op_sel:[0,0,0] op_sel_hi:[1,0,1]
 v_fma_mix_f32 v53, v40, 1.0, v42 op_sel:[1,0,1] op_sel_hi:[1,0,1]
 v_fma_mix_f32 v54, v41, 1.0, v43 op_sel:[0,0,0] op_sel_hi:[1,0,1]
 v_fma_mix_f32 v55, v41, 1.0, v43 op_sel:[1,0,1] op_sel_hi:[1,0,1]
 v_add_f32_dpp v56, v52, v52 row_ror:8 row_mask:0xf bank_mask:0xf
 v_add_f32_dpp v57, v53, v53 row_ror:8 row_mask:0xf bank_mask:0xf
 v_add_f32_dpp v58, v54, v54 row_ror:8 row_mask:0xf bank_mask:0xf
 v_add_f32_dpp v59, v55, v55 row_ror:8 row_mask:0xf bank_mask:0xf
 v_cvt_pk_bf16_f32 v118, v56, v57
 v_cvt_pk_bf16_f32 v119, v58, v59
 s_waitcnt lgkmcnt(2)
 v_fma_mix_f32 v52, v44, 1.0, v46 op_sel:[0,0,0] op_sel_hi:[1,0,1]
 v_fma_mix_f32 v53, v44, 1.0, v46 op_sel:[1,0,1] op_sel_hi:[1,0,1]
 v_fma_mix_f32 v54, v45, 1.0, v47 op_sel:[0,0,0] op_sel_hi:[1,0,1]
 v_fma_mix_f32 v55, v45, 1.0, v47 op_sel:[1,0,1] op_sel_hi:[1,0,1]
 v_add_f32_dpp v56, v52, v52 row_ror:8 row_mask:0xf bank_mask:0xf
 v_add_f32_dpp v57, v53, v53 row_ror:8 row_mask:0xf bank_mask:0xf
 v_add_f32_dpp v58, v54, v54 row_ror:8 row_mask:0xf bank_mask:0xf
 v_add_f32_dpp v59, v55, v55 row_ror:8 row_mask:0xf bank_mask:0xf
 v_cvt_pk_bf16_f32 v120, v56, v57
 v_cvt_pk_bf16_f32 v121, v58, v59
 s_waitcnt lgkmcnt(0)
 v_fma_mix_f32 v52, v48, 1.0, v50 op_sel:[0,0,0] op_sel_hi:[1,0,1]
 v_fma_mix_f32 v53, v48, 1.0, v50 op_sel:[1,0,1] op_sel_hi:[1,0,1]
 v_fma_mix_f32 v54, v49, 1.0, v51 op_sel:[0,0,0] op_sel_hi:[1,0,1]
 v_fma_mix_f32 v55, v49, 1.0, v51 op_sel:[1,0,1] op_sel_hi:[1,0,1]
 v_mfma_f32_16x16x32_bf16 v[40:43], v[112:115], v[118:121], 0
 v_add_f32_dpp v56, v52, v52 row_ror:8 row_mask:0xf bank_mask:0xf
 v_add_f32_dpp v57, v53, v53 row_ror:8 row_mask:0xf bank_mask:0xf
 v_add_f32_dpp v58, v54, v54 row_ror:8 row_mask:0xf bank_mask:0xf
 v_add_f32_dpp v59, v55, v55 row_ror:8 row_mask:0xf bank_mask:0xf
 v_cvt_pk_bf16_f32 v122, v56, v57
 v_cvt_pk_bf16_f32 v123, v58, v59
 s_nop 1
 v_mfma_f32_16x16x32_bf16 v[40:43], v[116:119], v[122:125], v[40:43]
 ds_read_b128 v[28:31], v16 offset:24576
 ds_read_b128 v[32:35], v16 offset:25600
 ds_read_b128 v[64:67], v16 offset:27648
 ds_read_b128 v[68:71], v16 offset:28672
 ds_read_b128 v[72:75], v16 offset:30720
 ds_read_b128 v[76:79], v16 offset:31744
 s_nop 0
 s_mov_b64 exec, s[74:75]
 v_cvt_pk_f16_f32 v44, v40, v41
 v_cvt_pk_f16_f32 v45, v42, v43
 v_and_or_b32 v44, v44, -2, s88
 s_cmp_eq_u32 s53, 1
 s_cbranch_scc1 si_94
 buffer_store_dwordx2 v[44:45], v7, s[8:11], s81 offen sc1
 s_branch si_95
si_94:
 buffer_store_dwordx2 v[44:45], v7, s[8:11], s81 offen
si_95:
 s_mov_b64 exec, -1
 s_branch bw_92
bw_93:
 s_lshr_b32 s21, 4, s20
 s_bitcmp1_b32 s21, 0
 s_cbranch_scc0 bw_96
 ds_read_b64_tr_b16 v[40:41], v6 offset:0
 ds_read_b64_tr_b16 v[42:43], v6 offset:1920
 ds_read_b64_tr_b16 v[44:45], v6 offset:3840
 ds_read_b64_tr_b16 v[46:47], v6 offset:5760
 ds_read_b64_tr_b16 v[48:49], v6 offset:640
 ds_read_b64_tr_b16 v[50:51], v6 offset:2560
 ds_read_b64_tr_b16 v[52:53], v6 offset:4480
 ds_read_b64_tr_b16 v[54:55], v6 offset:6400
 ds_read_b64_tr_b16 v[56:57], v6 offset:1280
 ds_read_b64_tr_b16 v[58:59], v6 offset:3200
 ds_read_b64_tr_b16 v[60:61], v6 offset:5120
 ds_read_b64_tr_b16 v[62:63], v6 offset:7040
 s_waitcnt lgkmcnt(8)
 v_pk_add_f16 v40, v40, v42
 v_pk_add_f16 v44, v44, v46
 v_pk_add_f16 v41, v41, v43
 v_pk_add_f16 v45, v45, v47
 v_fma_mix_f32 v146, v40, 1.0, v44 op_sel:[0,0,0] op_sel_hi:[1,0,1]
 v_fma_mix_f32 v147, v40, 1.0, v44 op_sel:[1,0,1] op_sel_hi:[1,0,1]
 v_fma_mix_f32 v148, v41, 1.0, v45 op_sel:[0,0,0] op_sel_hi:[1,0,1]
 v_fma_mix_f32 v149, v41, 1.0, v45 op_sel:[1,0,1] op_sel_hi:[1,0,1]
 v_cvt_pk_bf16_f32 v118, v146, v147
 v_cvt_pk_bf16_f32 v119, v148, v149
 s_waitcnt lgkmcnt(4)
 v_pk_add_f16 v48, v48, v50
 v_pk_add_f16 v52, v52, v54
 v_pk_add_f16 v49, v49, v51
 v_pk_add_f16 v53, v53, v55
 v_fma_mix_f32 v146, v48, 1.0, v52 op_sel:[0,0,0] op_sel_hi:[1,0,1]
 v_fma_mix_f32 v147, v48, 1.0, v52 op_sel:[1,0,1] op_sel_hi:[1,0,1]
 v_fma_mix_f32 v148, v49, 1.0, v53 op_sel:[0,0,0] op_sel_hi:[1,0,1]
 v_fma_mix_f32 v149, v49, 1.0, v53 op_sel:[1,0,1] op_sel_hi:[1,0,1]
 v_cvt_pk_bf16_f32 v120, v146, v147
 v_cvt_pk_bf16_f32 v121, v148, v149
 s_waitcnt lgkmcnt(0)
 v_pk_add_f16 v56, v56, v58
 v_pk_add_f16 v60, v60, v62
 v_pk_add_f16 v57, v57, v59
 v_pk_add_f16 v61, v61, v63
 v_fma_mix_f32 v146, v56, 1.0, v60 op_sel:[0,0,0] op_sel_hi:[1,0,1]
 v_fma_mix_f32 v147, v56, 1.0, v60 op_sel:[1,0,1] op_sel_hi:[1,0,1]
 v_mfma_f32_16x16x32_bf16 v[40:43], v[118:121], v[118:121], 0
 v_fma_mix_f32 v148, v57, 1.0, v61 op_sel:[0,0,0] op_sel_hi:[1,0,1]
 v_fma_mix_f32 v149, v57, 1.0, v61 op_sel:[1,0,1] op_sel_hi:[1,0,1]
 v_cvt_pk_bf16_f32 v122, v146, v147
 v_cvt_pk_bf16_f32 v123, v148, v149
 s_nop 1
 v_mfma_f32_16x16x32_bf16 v[40:43], v[122:125], v[122:125], v[40:43]
 ds_read_b128 v[28:31], v16 offset:24576
 ds_read_b128 v[32:35], v16 offset:25600
 ds_read_b128 v[64:67], v16 offset:27648
 ds_read_b128 v[68:71], v16 offset:28672
 ds_read_b128 v[72:75], v16 offset:30720
 ds_read_b128 v[76:79], v16 offset:31744
 s_nop 0
 s_mov_b64 exec, s[74:75]
 v_cvt_pk_f16_f32 v44, v40, v41
 v_cvt_pk_f16_f32 v45, v42, v43
 v_and_or_b32 v44, v44, -2, s88
 s_cmp_eq_u32 s53, 1
 s_cbranch_scc1 si_97
 buffer_store_dwordx2 v[44:45], v7, s[8:11], s81 offen sc1
 s_branch si_98
si_97:
 buffer_store_dwordx2 v[44:45], v7, s[8:11], s81 offen
si_98:
 s_mov_b64 exec, -1
 s_branch bw_92
bw_96:
 s_lshr_b32 s21, 8, s20
 s_bitcmp1_b32 s21, 0
 s_cbranch_scc0 bw_99
 ds_read_b128 v[28:31], v16 offset:24576
 ds_read_b128 v[32:35], v16 offset:25600
 ds_read_b128 v[64:67], v16 offset:27648
 ds_read_b128 v[68:71], v16 offset:28672
 ds_read_b128 v[72:75], v16 offset:30720
 ds_read_b128 v[76:79], v16 offset:31744
 s_branch bw_92
bw_99:
bw_92:
 ds_read_b128 v[80:83], v16 offset:33792
 ds_read_b128 v[84:87], v16 offset:34816
 ds_read_b64 v[88:89], v16 offset:26624
 ds_read_b64 v[90:91], v16 offset:29696
 ds_read_b64 v[92:93], v16 offset:32768
 ds_read_b64 v[94:95], v16 offset:35840
 s_cmp_eq_u32 s52, 63
 s_cbranch_scc1 last_86
 s_waitcnt lgkmcnt(10)
 v_smfmac_f32_16x16x64_f16 v[100:103], v[28:31], a[120:127], v25
 v_smfmac_f32_16x16x64_f16 v[104:107], v[28:31], a[128:135], v25
 v_smfmac_f32_16x16x64_f16 v[108:111], v[28:31], a[136:143], v25
 s_mov_b32 s54, 0
 v_smfmac_f32_16x16x64_f16 v[100:103], v[32:35], a[144:151], v25
 v_readfirstlane_b32 s21, v0
 v_smfmac_f32_16x16x64_f16 v[104:107], v[32:35], a[152:159], v25
 s_add_u32 s22, s46, 3
 v_smfmac_f32_16x16x64_f16 v[108:111], v[32:35], a[160:167], v25
 s_min_u32 s22, s22, 64
 s_waitcnt lgkmcnt(7)
 v_smfmac_f32_16x16x64_f16 v[100:103], v[64:67], a[168:175], v25
 s_sub_u32 s55, s21, s22
 v_smfmac_f32_16x16x64_f16 v[104:107], v[64:67], a[176:183], v25
 s_sub_u32 s56, s21, s46
 v_smfmac_f32_16x16x64_f16 v[108:111], v[64:67], a[184:191], v25
 v_smfmac_f32_16x16x64_f16 v[100:103], v[68:71], a[192:199], v25
 v_smfmac_f32_16x16x64_f16 v[104:107], v[68:71], a[200:207], v25
 v_smfmac_f32_16x16x64_f16 v[108:111], v[68:71], a[208:215], v25
 v_smfmac_f32_16x16x64_f16 v[100:103], v[72:75], a[216:223], v25
 v_smfmac_f32_16x16x64_f16 v[104:107], v[72:75], a[224:231], v25
 v_smfmac_f32_16x16x64_f16 v[108:111], v[72:75], a[232:239], v25
 s_waitcnt lgkmcnt(4)
 v_smfmac_f32_16x16x64_f16 v[100:103], v[76:79], a[240:247], v25
 v_smfmac_f32_16x16x64_f16 v[104:107], v[76:79], a[248:255], v25
 v_smfmac_f32_16x16x64_f16 v[108:111], v[76:79], v[152:159], v25
 v_smfmac_f32_16x16x64_f16 v[100:103], v[80:83], v[160:167], v25
 v_smfmac_f32_16x16x64_f16 v[104:107], v[80:83], v[168:175], v25
 v_smfmac_f32_16x16x64_f16 v[108:111], v[80:83], v[176:183], v25
 v_smfmac_f32_16x16x64_f16 v[100:103], v[84:87], v[184:191], v25
 v_smfmac_f32_16x16x64_f16 v[104:107], v[84:87], v[192:199], v25
 v_smfmac_f32_16x16x64_f16 v[108:111], v[84:87], v[200:207], v25
 s_waitcnt lgkmcnt(0)
 v_smfmac_f32_16x16x64_f16 v[100:103], v[88:91], v[208:215], v25
 v_smfmac_f32_16x16x64_f16 v[104:107], v[88:91], v[216:223], v25
 v_smfmac_f32_16x16x64_f16 v[108:111], v[88:91], v[224:231], v25
 v_smfmac_f32_16x16x64_f16 v[100:103], v[92:95], v[232:239], v25
 v_smfmac_f32_16x16x64_f16 v[104:107], v[92:95], v[240:247], v25
 v_smfmac_f32_16x16x64_f16 v[108:111], v[92:95], v[248:255], v25
 buffer_load_dwordx2 v[58:59], v9, s[8:11], s81 offen sc1
 buffer_load_dwordx4 v[40:43], v8, s[8:11], s81 offen offset:0 sc1
 buffer_load_dwordx4 v[44:47], v8, s[8:11], s81 offen offset:1024 sc1
 s_cmp_lt_i32 s56, 0
 s_cbranch_scc1 kvw_102
kvok_103:
 s_waitcnt vmcnt(2)
 v_xor_b32 v76, s88, v58
 s_nop 0
 v_permlane16_swap_b32 v58, v59
 v_fma_mix_f32 v60, v58, 1.0, v59 op_sel:[0,0,0] op_sel_hi:[1,0,1]
 v_fma_mix_f32 v61, v58, 1.0, v59 op_sel:[1,0,1] op_sel_hi:[1,0,1]
 v_mov_b32 v58, v60
 v_mov_b32 v59, v61
 s_nop 0
 v_permlane32_swap_b32 v58, v60
 v_permlane32_swap_b32 v59, v61
 v_add_f32 v52, v58, v60
 v_add_f32 v53, v59, v61
 v_max_f32 v79, v52, v53
 s_waitcnt vmcnt(0)
 v_pk_add_f16 v80, v40, v44
 v_pk_add_f16 v82, v42, v46
 v_pk_add_f16 v81, v41, v45
 v_pk_add_f16 v83, v43, v47
 v_permlane32_swap_b32 v80, v82
 v_bitop3_b32 v77, v40, v42, s88 bitop3:0x7e
 v_permlane32_swap_b32 v81, v83
 v_bitop3_b32 v78, v44, v46, s88 bitop3:0x7e
 v_fma_mix_f32 v48, v80, 1.0, v82 op_sel:[0,0,0] op_sel_hi:[1,0,1]
 v_or3_b32 v27, v76, v77, v78
 v_fma_mix_f32 v49, v80, 1.0, v82 op_sel:[1,0,1] op_sel_hi:[1,0,1]
 v_and_b32 v27, 1, v27
 v_fma_mix_f32 v50, v81, 1.0, v83 op_sel:[0,0,0] op_sel_hi:[1,0,1]
 v_cmp_ne_u32 vcc, 0, v27
 v_fma_mix_f32 v51, v81, 1.0, v83 op_sel:[1,0,1] op_sel_hi:[1,0,1]
 v_max3_f32 v62, v48, v49, v79
 s_cbranch_vccnz psr_100
psj_101:
 v_max3_f32 v62, v62, v50, v51
 v_cvt_pk_bf16_f32 v146, v100, v101
 v_cvt_pk_bf16_f32 v147, v102, v103
 v_max_f32_dpp v62, v62, v62 row_ror:8 row_mask:0xf bank_mask:0xf
 v_mov_b32 v63, v62
 v_cvt_pk_bf16_f32 v148, v104, v105
 v_cvt_pk_bf16_f32 v149, v106, v107
 v_permlane32_swap_b32 v62, v63
 v_max_f32 v62, v62, v63
 v_mov_b32 v63, v62
 v_cvt_pk_bf16_f32 v150, v108, v109
 v_cvt_pk_bf16_f32 v151, v110, v111
 v_permlane16_swap_b32 v62, v63
 v_max_f32 v62, v62, v63
 v_mul_f32 v62, s86, v62
 v_fma_f32 v48, v48, s86, -v62
 v_fma_f32 v49, v49, s86, -v62
 v_fma_f32 v50, v50, s86, -v62
 v_fma_f32 v51, v51, s86, -v62
 v_fma_f32 v52, v52, s86, -v62
 v_fma_f32 v53, v53, s86, -v62
 v_exp_f32 v48, v48
 v_exp_f32 v49, v49
 buffer_load_dwordx4 v[88:91], v17, s[28:31], s64 offen offset:0 sc1
 v_exp_f32 v50, v50
 v_exp_f32 v51, v51
 buffer_load_dwordx4 v[92:95], v16, s[28:31], s64 offen offset:1024 sc1
 v_exp_f32 v52, v52
 v_exp_f32 v53, v53
 buffer_load_dwordx4 v[96:99], v20, s[28:31], s64 offen offset:2048 sc1
 v_cvt_pk_bf16_f32 v138, v48, v49
 v_cvt_pk_bf16_f32 v139, v50, v51
 v_cvt_pk_bf16_f32 v142, v52, v53
 v_mov_b32_dpp v140, v138 row_ror:8 row_mask:0xf bank_mask:0xf
 v_mov_b32_dpp v141, v139 row_ror:8 row_mask:0xf bank_mask:0xf
 v_mov_b32_dpp v143, v142 row_ror:8 row_mask:0xf bank_mask:0xf
 s_lshr_b32 s21, 3, s20
 s_bitcmp1_b32 s21, 0
 s_cbranch_scc0 bw_105
 buffer_load_dwordx4 v[112:115], v18, s[16:19], s80 offen sc1
 s_branch bw_104
bw_105:
 s_lshr_b32 s21, 8, s20
 s_bitcmp1_b32 s21, 0
 s_cbranch_scc0 bw_106
 v_mov_b32 v84, s67
 v_mov_b32 v85, s67
 s_mov_b64 exec, 15
 buffer_store_dwordx2 v[84:85], v24, s[12:15], s66 offen sc1
 s_mov_b64 exec, -1
 s_branch bw_104
bw_106:
bw_104:
 v_add_f32 v54, v48, v49
 v_mfma_f32_16x16x32_bf16 v[64:67], v[126:129], v[138:141], 0
 v_add_f32 v55, v50, v51
 v_add_f32 v56, v52, v53
 v_mfma_f32_16x16x32_bf16 v[64:67], v[146:149], v[142:145], v[64:67]
 v_add_f32 v62, v54, v55
 v_fmac_f32 v62, v56, v26
 v_mfma_f32_16x16x32_bf16 v[68:71], v[130:133], v[138:141], 0
 s_lshr_b32 s21, 3, s20
 s_bitcmp1_b32 s21, 0
 s_cbranch_scc0 bw_108
 buffer_load_dwordx2 v[116:117], v19, s[16:19], s80 offen sc1
 s_branch bw_107
bw_108:
bw_107:
 v_add_f32_dpp v62, v62, v62 row_ror:8 row_mask:0xf bank_mask:0xf
 v_mfma_f32_16x16x32_bf16 v[68:71], v[148:151], v[142:145], v[68:71]
 v_mov_b32 v63, v62
 s_cmp_lt_i32 s55, 0
 s_cbranch_scc1 fl_109
fl_110:
 v_mfma_f32_16x16x32_bf16 v[72:75], v[134:137], v[138:141], 0
 v_permlane32_swap_b32 v62, v63
 v_mfma_f32_16x16x32_bf16 v[72:75], v[150:153], v[142:145], v[72:75]
 v_add_f32 v62, v62, v63
 v_mov_b32 v63, v62
 ds_write_b128 v11, v[64:67] offset:0
 s_nop 0
 v_permlane16_swap_b32 v62, v63
 v_add_f32 v62, v62, v63
 v_rcp_f32 v62, v62
 ds_write_b128 v11, v[68:71] offset:1024
 s_mov_b64 exec, 0xff
 ds_write_b32 v22, v62
 s_mov_b64 exec, -1
 ds_write_b128 v11, v[72:75] offset:2048
 s_waitcnt lgkmcnt(0)
 s_barrier
 s_lshr_b32 s21, 7, s20
 s_bitcmp1_b32 s21, 0
 s_cbranch_scc0 bw_112
 ds_read_b128 v[72:75], v23
 ds_read_b64 v[64:65], v12 offset:0
 ds_read_b64 v[66:67], v12 offset:3072
 ds_read_b64 v[68:69], v12 offset:6144
 ds_read_b64 v[70:71], v12 offset:9216
 s_waitcnt lgkmcnt(2)
 v_pk_mul_f32 v[64:65], v[64:65], v[72:73] op_sel_hi:[1,0]
 v_pk_fma_f32 v[64:65], v[66:67], v[72:73], v[64:65] op_sel:[0,1,0] op_sel_hi:[1,1,1]
 s_waitcnt lgkmcnt(0)
 v_pk_fma_f32 v[64:65], v[68:69], v[74:75], v[64:65] op_sel_hi:[1,0,1]
 v_pk_fma_f32 v[64:65], v[70:71], v[74:75], v[64:65] op_sel:[0,1,0] op_sel_hi:[1,1,1]
 v_cvt_pk_f16_f32 v68, v64, v65
 v_perm_b32 v68, s91, v68, v14
 buffer_atomic_pk_add_f16 v68, v13, s[4:7], s3 offen
 s_branch bw_111
bw_112:
 s_lshr_b32 s21, 8, s20
 s_bitcmp1_b32 s21, 0
 s_cbranch_scc0 bw_113
 s_and_b32 s21, s52, 7
 s_cmp_lg_u32 s21, s50
 s_cbranch_scc1 zm_114
 v_mov_b32 v64, 0
 v_mov_b32 v65, 0
 v_mov_b32 v66, 0
 v_mov_b32 v67, 0
 s_mov_b64 exec, s[70:71]
 buffer_store_dwordx4 v[64:67], v13, s[4:7], s83 offen sc1
 s_mov_b64 exec, -1
zm_114:
 s_branch bw_111
bw_113:
bw_111:
 s_lshr_b32 s21, 4, s20
 s_bitcmp1_b32 s21, 0
 s_cbranch_scc0 bw_116
 s_mov_b64 exec, s[62:63]
 buffer_store_dwordx4 v[118:121], v18, s[24:27], s85 offen sc1
 buffer_store_dwordx2 v[122:123], v19, s[24:27], s85 offen sc1
 s_mov_b64 exec, -1
 s_branch bw_115
bw_116:
bw_115:
 v_mov_b32 v76, v108
 v_mov_b32 v77, v109
 v_mov_b32 v78, v110
 v_mov_b32 v79, v111
 v_permlane32_swap_b32 v100, v104
 v_permlane32_swap_b32 v101, v105
 v_permlane32_swap_b32 v102, v106
 v_permlane32_swap_b32 v103, v107
 v_permlane32_swap_b32 v108, v76
 v_permlane32_swap_b32 v109, v77
 v_permlane32_swap_b32 v110, v78
 v_permlane32_swap_b32 v111, v79
 v_pk_add_f32 v[100:101], v[100:101], v[104:105]
 v_pk_add_f32 v[102:103], v[102:103], v[106:107]
 v_pk_add_f32 v[108:109], v[108:109], v[76:77]
 v_pk_add_f32 v[110:111], v[110:111], v[78:79]
 v_cvt_pk_bf16_f32 v80, v100, v101
 v_cvt_pk_bf16_f32 v82, v108, v109
 v_cvt_pk_bf16_f32 v81, v102, v103
 v_cvt_pk_bf16_f32 v83, v110, v111
 s_nop 0
 v_permlane16_swap_b32 v80, v82
 v_permlane16_swap_b32 v81, v83
 v_min_u32 v80, -2, v80
 s_mov_b64 exec, s[76:77]
 buffer_store_dwordx4 v[80:83], v15, s[24:27], s57 offen sc1
 s_mov_b64 exec, -1
 s_add_u32 s64, s64, 1310720
 s_add_u32 s52, s52, 1
 s_branch step_85
fl_90:
 buffer_load_dword v0, off, s[12:15], s79 sc1
 s_branch fl_91
A1_19:
 v_smfmac_f32_16x16x32_f16 v[40:43], v[36:37], a[16:19], v25
 v_smfmac_f32_16x16x32_f16 v[52:55], v[36:37], a[76:79], v25
 v_smfmac_f32_16x16x32_f16 v[44:47], v[36:37], a[36:39], v25
 v_smfmac_f32_16x16x32_f16 v[56:59], v[36:37], a[96:99], v25
 s_branch A2_89
pm_88:
 buffer_load_dwordx4 v[36:39], v4, s[4:7], s84 offen offset:2048 sc1
 buffer_load_dwordx4 v[28:31], v4, s[4:7], s84 offen offset:0 sc1
 buffer_load_dwordx4 v[32:35], v4, s[4:7], s84 offen offset:1024 sc1
 s_nop 7
 v_mov_b32 v40, 0
 v_mov_b32 v41, 0
 v_mov_b32 v42, 0
 v_mov_b32 v43, 0
 v_mov_b32 v52, 0
 v_mov_b32 v53, 0
 v_mov_b32 v54, 0
 v_mov_b32 v55, 0
 v_mov_b32 v44, 0
 v_mov_b32 v45, 0
 v_mov_b32 v46, 0
 v_mov_b32 v47, 0
 v_mov_b32 v56, 0
 v_mov_b32 v57, 0
 v_mov_b32 v58, 0
 v_mov_b32 v59, 0
 s_waitcnt vmcnt(0)
 v_bitop3_b32 v27, v31, v35, v39 bitop3:0x80
 v_perm_b32 v31, v35, v31, s89
 v_cmp_gt_u32 vcc, 0x48000000, v27
 v_mov_b32 v35, v38
 s_cbranch_vccz A1_19
pm_87:
 s_cmp_gt_u32 s52, 3
 s_cbranch_scc1 op_117
 v_readfirstlane_b32 s21, v0
 s_cmp_ge_u32 s21, s46
 s_cbranch_scc1 op_117
 buffer_load_dword v0, off, s[12:15], s79 sc1
 s_waitcnt vmcnt(0)
 v_readfirstlane_b32 s21, v0
 s_cmp_gt_u32 s21, s52
 s_cselect_b32 s21, s87, 0
 s_cmp_eq_u32 s21, 0
 s_cbranch_scc1 op_117
 s_mov_b32 s87, 0
 s_sub_u32 s21, s64, 1310720
 buffer_load_dwordx4 v[126:129], v16, s[28:31], s21 offen offset:0 sc1
 buffer_load_dwordx4 v[130:133], v16, s[28:31], s21 offen offset:1024 sc1
 buffer_load_dwordx4 v[134:137], v16, s[28:31], s21 offen offset:2048 sc1
op_117:
 buffer_load_dwordx4 v[36:39], v4, s[4:7], s84 offen offset:2048 sc1
 buffer_load_dwordx4 v[28:31], v4, s[4:7], s84 offen offset:0 sc1
 buffer_load_dwordx4 v[32:35], v4, s[4:7], s84 offen offset:1024 sc1
 s_add_u32 s54, s54, 1
 s_cmp_gt_u32 s54, 131072
 s_cbranch_scc1 end0
 s_waitcnt vmcnt(0)
 v_bitop3_b32 v27, v31, v35, v39 bitop3:0x80
 v_perm_b32 v31, v35, v31, s89
 v_cmp_gt_u32 vcc, 0x48000000, v27
 v_mov_b32 v35, v38
 s_cbranch_vccnz pm_87
 s_branch A1_19
psr_100:
 buffer_load_dwordx2 v[58:59], v9, s[8:11], s81 offen sc1
 buffer_load_dwordx4 v[40:43], v8, s[8:11], s81 offen offset:0 sc1
 buffer_load_dwordx4 v[44:47], v8, s[8:11], s81 offen offset:1024 sc1
 s_add_u32 s54, s54, 1
 s_cmp_gt_u32 s54, 131072
 s_cbranch_scc1 end0
 s_waitcnt vmcnt(2)
 v_xor_b32 v76, s88, v58
 s_nop 0
 v_permlane16_swap_b32 v58, v59
 v_fma_mix_f32 v60, v58, 1.0, v59 op_sel:[0,0,0] op_sel_hi:[1,0,1]
 v_fma_mix_f32 v61, v58, 1.0, v59 op_sel:[1,0,1] op_sel_hi:[1,0,1]
 v_mov_b32 v58, v60
 v_mov_b32 v59, v61
 s_nop 0
 v_permlane32_swap_b32 v58, v60
 v_permlane32_swap_b32 v59, v61
 v_add_f32 v52, v58, v60
 v_add_f32 v53, v59, v61
 v_max_f32 v79, v52, v53
 s_waitcnt vmcnt(0)
 v_pk_add_f16 v80, v40, v44
 v_pk_add_f16 v82, v42, v46
 v_pk_add_f16 v81, v41, v45
 v_pk_add_f16 v83, v43, v47
 v_permlane32_swap_b32 v80, v82
 v_bitop3_b32 v77, v40, v42, s88 bitop3:0x7e
 v_permlane32_swap_b32 v81, v83
 v_bitop3_b32 v78, v44, v46, s88 bitop3:0x7e
 v_fma_mix_f32 v48, v80, 1.0, v82 op_sel:[0,0,0] op_sel_hi:[1,0,1]
 v_or3_b32 v27, v76, v77, v78
 v_fma_mix_f32 v49, v80, 1.0, v82 op_sel:[1,0,1] op_sel_hi:[1,0,1]
 v_and_b32 v27, 1, v27
 v_fma_mix_f32 v50, v81, 1.0, v83 op_sel:[0,0,0] op_sel_hi:[1,0,1]
 v_cmp_ne_u32 vcc, 0, v27
 v_fma_mix_f32 v51, v81, 1.0, v83 op_sel:[1,0,1] op_sel_hi:[1,0,1]
 v_max3_f32 v62, v48, v49, v79
 s_cbranch_vccnz psr_100
 s_branch psj_101
kvw_102:
 s_mov_b32 s22, s87
 s_cmp_eq_u32 s52, 0
 s_cselect_b32 s55, 0, s55
 s_cselect_b32 s87, 1, 0
 s_cbranch_scc1 kvok_103
 v_mov_b32 v62, 0
 s_mov_b32 s101, 0
wf_118:
 buffer_load_dword v63, v62, s[12:15], s79 offen sc1
 s_add_u32 s101, s101, 1
 s_cmp_gt_u32 s101, 131072
 s_cbranch_scc1 end0
 s_waitcnt vmcnt(0)
 v_readfirstlane_b32 s100, v63
 s_cmp_ge_u32 s100, s46
 s_cbranch_scc1 wf_119
 s_sleep 3
 s_branch wf_118
wf_119:
 s_cmp_eq_u32 s22, 0
 s_cbranch_scc1 kvok_103
 s_sub_u32 s21, s64, 1310720
 buffer_load_dwordx4 v[126:129], v16, s[28:31], s21 offen offset:0 sc1
 buffer_load_dwordx4 v[130:133], v16, s[28:31], s21 offen offset:1024 sc1
 buffer_load_dwordx4 v[134:137], v16, s[28:31], s21 offen offset:2048 sc1
 s_waitcnt vmcnt(0)
 s_branch kvok_103
fl_109:
 buffer_load_dword v0, off, s[12:15], s79 sc1
 s_branch fl_110
last_86:
 s_lshr_b32 s21, 4, s20
 s_bitcmp1_b32 s21, 0
 s_cbranch_scc0 bw_121
 s_mov_b64 exec, s[62:63]
 buffer_store_dwordx4 v[118:121], v18, s[24:27], s85 offen sc1
 buffer_store_dwordx2 v[122:123], v19, s[24:27], s85 offen sc1
 s_mov_b64 exec, -1
 s_branch bw_120
bw_121:
bw_120:
 s_waitcnt lgkmcnt(10)
 v_smfmac_f32_16x16x64_f16 v[100:103], v[28:31], a[120:127], v25
 v_smfmac_f32_16x16x64_f16 v[104:107], v[28:31], a[128:135], v25
 v_smfmac_f32_16x16x64_f16 v[108:111], v[28:31], a[136:143], v25
 v_smfmac_f32_16x16x64_f16 v[100:103], v[32:35], a[144:151], v25
 v_smfmac_f32_16x16x64_f16 v[104:107], v[32:35], a[152:159], v25
 v_smfmac_f32_16x16x64_f16 v[108:111], v[32:35], a[160:167], v25
 s_waitcnt lgkmcnt(7)
 v_smfmac_f32_16x16x64_f16 v[100:103], v[64:67], a[168:175], v25
 v_smfmac_f32_16x16x64_f16 v[104:107], v[64:67], a[176:183], v25
 v_smfmac_f32_16x16x64_f16 v[108:111], v[64:67], a[184:191], v25
 v_smfmac_f32_16x16x64_f16 v[100:103], v[68:71], a[192:199], v25
 v_smfmac_f32_16x16x64_f16 v[104:107], v[68:71], a[200:207], v25
 v_smfmac_f32_16x16x64_f16 v[108:111], v[68:71], a[208:215], v25
 v_smfmac_f32_16x16x64_f16 v[100:103], v[72:75], a[216:223], v25
 v_smfmac_f32_16x16x64_f16 v[104:107], v[72:75], a[224:231], v25
 v_smfmac_f32_16x16x64_f16 v[108:111], v[72:75], a[232:239], v25
 s_waitcnt lgkmcnt(4)
 v_smfmac_f32_16x16x64_f16 v[100:103], v[76:79], a[240:247], v25
 v_smfmac_f32_16x16x64_f16 v[104:107], v[76:79], a[248:255], v25
 v_smfmac_f32_16x16x64_f16 v[108:111], v[76:79], v[152:159], v25
 v_smfmac_f32_16x16x64_f16 v[100:103], v[80:83], v[160:167], v25
 v_smfmac_f32_16x16x64_f16 v[104:107], v[80:83], v[168:175], v25
 v_smfmac_f32_16x16x64_f16 v[108:111], v[80:83], v[176:183], v25
 v_smfmac_f32_16x16x64_f16 v[100:103], v[84:87], v[184:191], v25
 v_smfmac_f32_16x16x64_f16 v[104:107], v[84:87], v[192:199], v25
 v_smfmac_f32_16x16x64_f16 v[108:111], v[84:87], v[200:207], v25
 s_waitcnt lgkmcnt(0)
 v_smfmac_f32_16x16x64_f16 v[100:103], v[88:91], v[208:215], v25
 v_smfmac_f32_16x16x64_f16 v[104:107], v[88:91], v[216:223], v25
 v_smfmac_f32_16x16x64_f16 v[108:111], v[88:91], v[224:231], v25
 v_smfmac_f32_16x16x64_f16 v[100:103], v[92:95], v[232:239], v25
 v_smfmac_f32_16x16x64_f16 v[104:107], v[92:95], v[240:247], v25
 v_smfmac_f32_16x16x64_f16 v[108:111], v[92:95], v[248:255], v25
 s_nop 7
 v_mov_b32 v76, v108
 v_mov_b32 v77, v109
 v_mov_b32 v78, v110
 v_mov_b32 v79, v111
 v_permlane32_swap_b32 v100, v104
 v_permlane32_swap_b32 v101, v105
 v_permlane32_swap_b32 v102, v106
 v_permlane32_swap_b32 v103, v107
 v_permlane32_swap_b32 v108, v76
 v_permlane32_swap_b32 v109, v77
 v_permlane32_swap_b32 v110, v78
 v_permlane32_swap_b32 v111, v79
 v_pk_add_f32 v[100:101], v[100:101], v[104:105]
 v_pk_add_f32 v[102:103], v[102:103], v[106:107]
 v_pk_add_f32 v[108:109], v[108:109], v[76:77]
 v_pk_add_f32 v[110:111], v[110:111], v[78:79]
 v_cvt_pk_bf16_f32 v80, v100, v101
 v_cvt_pk_bf16_f32 v82, v108, v109
 v_cvt_pk_bf16_f32 v81, v102, v103
 v_cvt_pk_bf16_f32 v83, v110, v111
 s_nop 0
 v_permlane16_swap_b32 v80, v82
 v_permlane16_swap_b32 v81, v83
 v_min_u32 v80, -2, v80
 s_mov_b64 exec, s[76:77]
 buffer_store_dwordx4 v[80:83], v15, s[24:27], s57 offen sc1
 s_mov_b64 exec, -1
 s_lshr_b32 s21, 1, s20
 s_bitcmp1_b32 s21, 0
 s_cbranch_scc0 bw_123
 v_mov_b32 v246, 80
 v_mov_b32 v247, 1
 s_mov_b64 exec, 1
 buffer_atomic_add v247, v246, s[32:35], 0 offen sc0 sc1
 s_mov_b64 exec, -1
 s_branch bw_122
bw_123:
bw_122:
 s_branch chain_done
chain_done:
 s_waitcnt vmcnt(0) lgkmcnt(0)
 s_barrier
 s_mov_b32 s84, 0
 s_mov_b32 s85, -1
 s_mov_b32 s86, 0
 v_mov_b32 v21, 0
 v_mov_b32 v23, v247
 s_cmp_lg_u32 s20, 0
 s_cbranch_scc1 queue_b
 s_mov_b64 exec, 1
 s_branch queue_a
end0:
 s_endpgm
gemm_side:
 s_bfe_u32 s23, s22, 0x20005
 s_add_u32 s22, s22, 31
 s_and_b32 s22, s22, 31
 s_lshl_b32 s21, s23, 3
 s_add_u32 s2, s21, s22
 s_add_u32 s3, s2, 72
 s_add_u32 s24, s2, 48
 s_add_u32 s2, s2, s21
 s_cmp_lt_u32 s22, 24
 s_cselect_b32 s3, s24, s3
 s_cmp_lt_u32 s22, 16
 s_cselect_b32 s3, s2, s3
 s_mov_b32 s2, s3
gemm_roles:
 s_cmp_ge_u32 s3, 64
 s_cbranch_scc1 not_kv
 s_load_dwordx2 s[4:5], s[0:1], 0
 s_load_dwordx2 s[6:7], s[0:1], 24
 s_load_dwordx2 s[36:37], s[0:1], 32
 s_load_dwordx2 s[38:39], s[0:1], 104
 s_and_b32 s43, s3, 1
 s_bfe_u32 s42, s3, 0x50001
 s_lshr_b32 s40, s42, 2
 s_waitcnt lgkmcnt(0)
 s_cmp_eq_u32 s43, 1
 s_cselect_b32 s6, s36, s6
 s_cselect_b32 s7, s37, s7
 s_mov_b32 s8, s4
 s_mov_b32 s9, s5
 s_mov_b32 s10, 2621440
 s_mov_b32 s11, 0x00020000
 s_mov_b32 s12, s6
 s_mov_b32 s13, s7
 s_mov_b32 s14, 7864320
 s_mov_b32 s15, 0x00020000
 s_mov_b32 s16, s38
 s_mov_b32 s17, s39
 s_mov_b32 s18, 50331648
 s_mov_b32 s19, 0x00020000
 s_mul_i32 s44, s42, 384
 s_mov_b32 s62, 1024
 s_mov_b32 s24, 0
 s_mov_b32 s25, 81920
 s_mov_b32 s64, s32
 s_mov_b32 s65, s33
 s_mov_b32 s66, s34
 s_mov_b32 s67, s35
 s_load_dwordx2 s[72:73], s[0:1], 104
 s_waitcnt lgkmcnt(0)
 s_add_u32 s72, s72, 81068032
 s_addc_u32 s73, s73, 0
 s_mov_b32 s74, 129024
 s_mov_b32 s75, 0x00020000
 v_mov_b32 v9, 2731
 v_add_u32 v8, 0, v1
 v_mul_u32_u24 v7, v8, v9
 v_lshrrev_b32 v7, 16, v7
 v_mul_u32_u24 v4, 24, v7
 v_sub_u32 v8, v8, v4
 v_and_b32 v4, 2, v7
 v_xor_b32 v8, v8, v4
 v_xor_b32 v5, 4, v8
 s_mov_b32 s21, 12288
 v_mul_lo_u32 v7, v7, s21
 v_lshl_add_u32 v40, v8, 4, v7
 v_lshl_add_u32 v43, v5, 4, v7
 v_add_u32 v8, 64, v1
 v_mul_u32_u24 v7, v8, v9
 v_lshrrev_b32 v7, 16, v7
 v_mul_u32_u24 v4, 24, v7
 v_sub_u32 v8, v8, v4
 v_and_b32 v4, 2, v7
 v_xor_b32 v8, v8, v4
 v_xor_b32 v5, 4, v8
 s_mov_b32 s21, 12288
 v_mul_lo_u32 v7, v7, s21
 v_lshl_add_u32 v41, v8, 4, v7
 v_lshl_add_u32 v44, v5, 4, v7
 v_add_u32 v8, 128, v1
 v_mul_u32_u24 v7, v8, v9
 v_lshrrev_b32 v7, 16, v7
 v_mul_u32_u24 v4, 24, v7
 v_sub_u32 v8, v8, v4
 v_and_b32 v4, 2, v7
 v_xor_b32 v8, v8, v4
 v_xor_b32 v5, 4, v8
 s_mov_b32 s21, 12288
 v_mul_lo_u32 v7, v7, s21
 v_lshl_add_u32 v42, v8, 4, v7
 v_lshl_add_u32 v45, v5, 4, v7
 s_mul_i32 s21, s20, 393216
 s_add_u32 s21, s21, 0
 s_add_u32 s21, s21, s44
 s_mul_i32 s22, s20, 12288
 s_add_u32 s22, s22, 0
 s_add_u32 m0, s22, 0
 s_nop 0
 buffer_load_dwordx4 v40, s[12:15], s21 offen lds
 s_add_u32 m0, s22, 1024
 s_nop 0
 buffer_load_dwordx4 v41, s[12:15], s21 offen lds
 s_add_u32 m0, s22, 2048
 s_nop 0
 buffer_load_dwordx4 v42, s[12:15], s21 offen lds
 s_mul_i32 s21, s20, 393216
 s_add_u32 s21, s21, 98304
 s_add_u32 s21, s21, s44
 s_mul_i32 s22, s20, 12288
 s_add_u32 s22, s22, 3072
 s_add_u32 m0, s22, 0
 s_nop 0
 buffer_load_dwordx4 v43, s[12:15], s21 offen lds
 s_add_u32 m0, s22, 1024
 s_nop 0
 buffer_load_dwordx4 v44, s[12:15], s21 offen lds
 s_add_u32 m0, s22, 2048
 s_nop 0
 buffer_load_dwordx4 v45, s[12:15], s21 offen lds
 s_mul_i32 s21, s20, 393216
 s_add_u32 s21, s21, 196608
 s_add_u32 s21, s21, s44
 s_mul_i32 s22, s20, 12288
 s_add_u32 s22, s22, 6144
 s_add_u32 m0, s22, 0
 s_nop 0
 buffer_load_dwordx4 v40, s[12:15], s21 offen lds
 s_add_u32 m0, s22, 1024
 s_nop 0
 buffer_load_dwordx4 v41, s[12:15], s21 offen lds
 s_add_u32 m0, s22, 2048
 s_nop 0
 buffer_load_dwordx4 v42, s[12:15], s21 offen lds
 s_mul_i32 s21, s20, 393216
 s_add_u32 s21, s21, 294912
 s_add_u32 s21, s21, s44
 s_mul_i32 s22, s20, 12288
 s_add_u32 s22, s22, 9216
 s_add_u32 m0, s22, 0
 s_nop 0
 buffer_load_dwordx4 v43, s[12:15], s21 offen lds
 s_add_u32 m0, s22, 1024
 s_nop 0
 buffer_load_dwordx4 v44, s[12:15], s21 offen lds
 s_add_u32 m0, s22, 2048
 s_nop 0
 buffer_load_dwordx4 v45, s[12:15], s21 offen lds
 v_lshrrev_b32 v11, 3, v1
 v_and_b32 v12, 7, v1
 v_xor_b32 v12, v12, v11
 v_mul_u32_u24 v11, 1280, v11
 v_lshl_add_u32 v10, v12, 4, v11
 s_mul_i32 s46, s20, 20480
 v_add_u32 v10, s46, v10
 s_lshl_b32 s47, s20, 11
 s_add_u32 s47, s47, 98304
 s_add_u32 s46, s47, 57344
 s_mov_b32 s30, s24
 s_add_u32 s32, s47, 0
 v_add_u32 v11, 9216, v10
 s_mov_b32 m0, s32
 s_nop 0
 buffer_load_dwordx4 v10, s[8:11], s30 offen offset:0 lds
 buffer_load_dwordx4 v11, s[8:11], s30 offen offset:1024 lds
 s_add_u32 s30, s30, 128
 s_add_u32 s32, s32, 8192
 s_cmp_lt_u32 s32, s46
 s_cselect_b32 s32, s32, s47
 s_mov_b32 m0, s32
 s_nop 0
 buffer_load_dwordx4 v10, s[8:11], s30 offen offset:0 lds
 buffer_load_dwordx4 v11, s[8:11], s30 offen offset:1024 lds
 s_add_u32 s30, s30, 128
 s_add_u32 s32, s32, 8192
 s_cmp_lt_u32 s32, s46
 s_cselect_b32 s32, s32, s47
 s_mov_b32 m0, s32
 s_nop 0
 buffer_load_dwordx4 v10, s[8:11], s30 offen offset:0 lds
 buffer_load_dwordx4 v11, s[8:11], s30 offen offset:1024 lds
 s_add_u32 s30, s30, 128
 s_add_u32 s32, s32, 8192
 s_cmp_lt_u32 s32, s46
 s_cselect_b32 s32, s32, s47
 s_mov_b32 m0, s32
 s_nop 0
 buffer_load_dwordx4 v10, s[8:11], s30 offen offset:0 lds
 buffer_load_dwordx4 v11, s[8:11], s30 offen offset:1024 lds
 s_add_u32 s30, s30, 128
 s_add_u32 s32, s32, 8192
 s_cmp_lt_u32 s32, s46
 s_cselect_b32 s32, s32, s47
 s_mov_b32 m0, s32
 s_nop 0
 buffer_load_dwordx4 v10, s[8:11], s30 offen offset:0 lds
 buffer_load_dwordx4 v11, s[8:11], s30 offen offset:1024 lds
 s_add_u32 s30, s30, 128
 s_add_u32 s32, s32, 8192
 s_cmp_lt_u32 s32, s46
 s_cselect_b32 s32, s32, s47
 s_mul_i32 s21, s20, 393216
 s_add_u32 s21, s21, 1572864
 s_add_u32 s21, s21, s44
 s_mul_i32 s22, s20, 12288
 s_add_u32 s22, s22, 49152
 s_add_u32 m0, s22, 0
 s_nop 0
 buffer_load_dwordx4 v40, s[12:15], s21 offen lds
 s_add_u32 m0, s22, 1024
 s_nop 0
 buffer_load_dwordx4 v41, s[12:15], s21 offen lds
 s_add_u32 m0, s22, 2048
 s_nop 0
 buffer_load_dwordx4 v42, s[12:15], s21 offen lds
 s_mul_i32 s21, s20, 393216
 s_add_u32 s21, s21, 1671168
 s_add_u32 s21, s21, s44
 s_mul_i32 s22, s20, 12288
 s_add_u32 s22, s22, 52224
 s_add_u32 m0, s22, 0
 s_nop 0
 buffer_load_dwordx4 v43, s[12:15], s21 offen lds
 s_add_u32 m0, s22, 1024
 s_nop 0
 buffer_load_dwordx4 v44, s[12:15], s21 offen lds
 s_add_u32 m0, s22, 2048
 s_nop 0
 buffer_load_dwordx4 v45, s[12:15], s21 offen lds
 s_mul_i32 s21, s20, 393216
 s_add_u32 s21, s21, 1769472
 s_add_u32 s21, s21, s44
 s_mul_i32 s22, s20, 12288
 s_add_u32 s22, s22, 55296
 s_add_u32 m0, s22, 0
 s_nop 0
 buffer_load_dwordx4 v40, s[12:15], s21 offen lds
 s_add_u32 m0, s22, 1024
 s_nop 0
 buffer_load_dwordx4 v41, s[12:15], s21 offen lds
 s_add_u32 m0, s22, 2048
 s_nop 0
 buffer_load_dwordx4 v42, s[12:15], s21 offen lds
 s_mul_i32 s21, s20, 393216
 s_add_u32 s21, s21, 1867776
 s_add_u32 s21, s21, s44
 s_mul_i32 s22, s20, 12288
 s_add_u32 s22, s22, 58368
 s_add_u32 m0, s22, 0
 s_nop 0
 buffer_load_dwordx4 v43, s[12:15], s21 offen lds
 s_add_u32 m0, s22, 1024
 s_nop 0
 buffer_load_dwordx4 v44, s[12:15], s21 offen lds
 s_add_u32 m0, s22, 2048
 s_nop 0
 buffer_load_dwordx4 v45, s[12:15], s21 offen lds
 v_lshrrev_b32 v7, 2, v2
 v_and_b32 v4, 2, v7
 v_and_b32 v5, 1, v3
 v_lshl_or_b32 v4, v5, 2, v4
 v_lshl_add_u32 v7, v3, 3, v7
 v_mul_u32_u24 v7, 384, v7
 v_and_b32 v5, 1, v2
 v_lshl_add_u32 v7, v5, 3, v7
 v_bfe_u32 v8, v2, 1, 1
 s_mul_i32 s21, s20, 6
 v_add_u32 v8, s21, v8
 v_add_u32 v5, 0, v8
 v_xor_b32 v5, v5, v4
 v_lshl_add_u32 v46, v5, 4, v7
 v_add_u32 v49, 49152, v46
 v_add_u32 v5, 2, v8
 v_xor_b32 v5, v5, v4
 v_lshl_add_u32 v47, v5, 4, v7
 v_add_u32 v50, 49152, v47
 v_add_u32 v5, 4, v8
 v_xor_b32 v5, v5, v4
 v_lshl_add_u32 v48, v5, 4, v7
 v_add_u32 v51, 49152, v48
 s_mov_b32 s26, 6
 s_mul_i32 s27, s42, 12288
 s_mul_i32 s21, s43, 25165824
 s_add_u32 s27, s27, s21
 s_mov_b32 s28, 786432
 s_lshl_b32 s60, s40, 7
 s_add_u32 s60, s60, 0
 s_mov_b32 s61, 0
 v_and_b32 v6, 7, v2
 v_add_u32 v4, 0, v3
 v_xor_b32 v4, v4, v6
 v_lshlrev_b32 v4, 4, v4
 v_lshl_add_u32 v14, v2, 7, v4
 v_add_u32 v4, 4, v3
 v_xor_b32 v4, v4, v6
 v_lshlrev_b32 v4, 4, v4
 v_lshl_add_u32 v15, v2, 7, v4
 v_mul_u32_u24 v22, 400, v2
 v_mul_u32_u24 v4, 16, v3
 s_mul_i32 s21, s20, 96
 s_add_u32 s21, s21, 0
 v_add3_u32 v22, v22, v4, s21
 v_lshlrev_b32 v4, 3, v3
 v_sub_u32 v16, v22, v4
 v_mov_b32 v9, 2731
 s_mul_i32 s21, s20, 6400
 s_add_u32 s21, s21, 0
 v_mul_u32_u24 v4, 400, v2
 v_lshlrev_b32 v5, 4, v3
 v_add3_u32 v23, v4, v5, s21
 v_lshlrev_b32 v26, 4, v1
 s_mov_b32 s33, 98304
 s_mov_b32 s48, 0x80000000
 s_mov_b32 m0, s32
 s_nop 0
 buffer_load_dwordx4 v10, s[8:11], s30 offen offset:0 lds
 s_waitcnt vmcnt(21)
 s_barrier
 v_add_u32 v18, s33, v14
 v_add_u32 v19, s33, v15
 s_add_u32 s33, s33, 8192
 s_cmp_lt_u32 s33, 155648
 s_cselect_b32 s33, s33, 98304
 ds_read_b128 v[160:163], v18 offset:0
 ds_read_b128 v[164:167], v18 offset:2048
 ds_read_b128 v[168:171], v18 offset:4096
 ds_read_b128 v[172:175], v18 offset:6144
 s_waitcnt lgkmcnt(0)
 s_waitcnt vmcnt(23)
 s_barrier
 ds_read_b64_tr_b16 a[0:1], v46 offset:0
 ds_read_b64_tr_b16 a[2:3], v46 offset:1536
 ds_read_b64_tr_b16 a[4:5], v47 offset:0
 ds_read_b64_tr_b16 a[6:7], v47 offset:1536
 ds_read_b64_tr_b16 a[8:9], v48 offset:0
 ds_read_b64_tr_b16 a[10:11], v48 offset:1536
 ds_read_b64_tr_b16 a[12:13], v46 offset:12288
 ds_read_b64_tr_b16 a[14:15], v46 offset:13824
 ds_read_b64_tr_b16 a[16:17], v47 offset:12288
 ds_read_b64_tr_b16 a[18:19], v47 offset:13824
 ds_read_b64_tr_b16 a[20:21], v48 offset:12288
 ds_read_b64_tr_b16 a[22:23], v48 offset:13824
 ds_read_b64_tr_b16 a[24:25], v46 offset:24576
 ds_read_b64_tr_b16 a[26:27], v46 offset:26112
 ds_read_b64_tr_b16 a[28:29], v47 offset:24576
 ds_read_b64_tr_b16 a[30:31], v47 offset:26112
 ds_read_b64_tr_b16 a[32:33], v48 offset:24576
 ds_read_b64_tr_b16 a[34:35], v48 offset:26112
 ds_read_b64_tr_b16 a[36:37], v46 offset:36864
 ds_read_b64_tr_b16 a[38:39], v46 offset:38400
 ds_read_b64_tr_b16 a[40:41], v47 offset:36864
 ds_read_b64_tr_b16 a[42:43], v47 offset:38400
 ds_read_b64_tr_b16 a[44:45], v48 offset:36864
 ds_read_b64_tr_b16 a[46:47], v48 offset:38400
 s_waitcnt lgkmcnt(0)
 s_barrier
 s_mov_b32 s23, m0
 s_mul_i32 s21, s20, 393216
 s_add_u32 s21, s21, 3145728
 s_add_u32 s21, s21, s44
 s_mul_i32 s22, s20, 12288
 s_add_u32 s22, s22, 0
 s_add_u32 m0, s22, 0
 s_nop 0
 buffer_load_dwordx4 v40, s[12:15], s21 offen lds
 s_add_u32 m0, s22, 1024
 s_nop 0
 buffer_load_dwordx4 v41, s[12:15], s21 offen lds
 s_add_u32 m0, s22, 2048
 s_nop 0
 buffer_load_dwordx4 v42, s[12:15], s21 offen lds
 s_mul_i32 s21, s20, 393216
 s_add_u32 s21, s21, 3244032
 s_add_u32 s21, s21, s44
 s_mul_i32 s22, s20, 12288
 s_add_u32 s22, s22, 3072
 s_add_u32 m0, s22, 0
 s_nop 0
 buffer_load_dwordx4 v43, s[12:15], s21 offen lds
 s_add_u32 m0, s22, 1024
 s_nop 0
 buffer_load_dwordx4 v44, s[12:15], s21 offen lds
 s_add_u32 m0, s22, 2048
 s_nop 0
 buffer_load_dwordx4 v45, s[12:15], s21 offen lds
 s_mul_i32 s21, s20, 393216
 s_add_u32 s21, s21, 3342336
 s_add_u32 s21, s21, s44
 s_mul_i32 s22, s20, 12288
 s_add_u32 s22, s22, 6144
 s_add_u32 m0, s22, 0
 s_nop 0
 buffer_load_dwordx4 v40, s[12:15], s21 offen lds
 s_add_u32 m0, s22, 1024
 s_nop 0
 buffer_load_dwordx4 v41, s[12:15], s21 offen lds
 s_add_u32 m0, s22, 2048
 s_nop 0
 buffer_load_dwordx4 v42, s[12:15], s21 offen lds
 s_mul_i32 s21, s20, 393216
 s_add_u32 s21, s21, 3440640
 s_add_u32 s21, s21, s44
 s_mul_i32 s22, s20, 12288
 s_add_u32 s22, s22, 9216
 s_add_u32 m0, s22, 0
 s_nop 0
 buffer_load_dwordx4 v43, s[12:15], s21 offen lds
 s_add_u32 m0, s22, 1024
 s_nop 0
 buffer_load_dwordx4 v44, s[12:15], s21 offen lds
 s_add_u32 m0, s22, 2048
 s_nop 0
 buffer_load_dwordx4 v45, s[12:15], s21 offen lds
 s_mov_b32 m0, s23
 v_mfma_f32_16x16x32_bf16 v[64:67], a[0:3], v[160:163], 0
 ds_read_b128 v[192:195], v19 offset:0
 v_mfma_f32_16x16x32_bf16 v[68:71], a[4:7], v[160:163], 0
 v_add_u32 v18, s33, v14
 v_mfma_f32_16x16x32_bf16 v[72:75], a[8:11], v[160:163], 0
 v_mfma_f32_16x16x32_bf16 v[76:79], a[0:3], v[164:167], 0
 ds_read_b128 v[196:199], v19 offset:2048
 v_mfma_f32_16x16x32_bf16 v[80:83], a[4:7], v[164:167], 0
 buffer_load_dwordx4 v11, s[8:11], s30 offen offset:1024 lds
 v_mfma_f32_16x16x32_bf16 v[84:87], a[8:11], v[164:167], 0
 s_add_u32 s30, s30, 128
 v_mfma_f32_16x16x32_bf16 v[88:91], a[0:3], v[168:171], 0
 ds_read_b128 v[200:203], v19 offset:4096
 s_add_u32 m0, m0, 8192
 v_mfma_f32_16x16x32_bf16 v[92:95], a[4:7], v[168:171], 0
 s_cmp_lt_u32 m0, s46
 s_cselect_b32 m0, m0, s47
 v_mfma_f32_16x16x32_bf16 v[96:99], a[8:11], v[168:171], 0
 v_mfma_f32_16x16x32_bf16 v[100:103], a[0:3], v[172:175], 0
 ds_read_b128 v[204:207], v19 offset:6144
 v_mfma_f32_16x16x32_bf16 v[104:107], a[4:7], v[172:175], 0
 v_mfma_f32_16x16x32_bf16 v[108:111], a[8:11], v[172:175], 0
 s_waitcnt vmcnt(32) lgkmcnt(2)
 s_barrier
 v_mfma_f32_16x16x32_bf16 v[64:67], a[12:15], v[192:195], v[64:67]
 ds_read_b128 v[160:163], v18 offset:0
 v_mfma_f32_16x16x32_bf16 v[68:71], a[16:19], v[192:195], v[68:71]
 v_mfma_f32_16x16x32_bf16 v[72:75], a[20:23], v[192:195], v[72:75]
 v_add_u32 v19, s33, v15
 s_add_u32 s33, s33, 8192
 v_mfma_f32_16x16x32_bf16 v[76:79], a[12:15], v[196:199], v[76:79]
 ds_read_b128 v[164:167], v18 offset:2048
 v_mfma_f32_16x16x32_bf16 v[80:83], a[16:19], v[196:199], v[80:83]
 buffer_load_dwordx4 v10, s[8:11], s30 offen offset:0 lds
 v_mfma_f32_16x16x32_bf16 v[84:87], a[20:23], v[196:199], v[84:87]
 s_waitcnt lgkmcnt(2)
 v_mfma_f32_16x16x32_bf16 v[88:91], a[12:15], v[200:203], v[88:91]
 ds_read_b128 v[168:171], v18 offset:4096
 v_mfma_f32_16x16x32_bf16 v[92:95], a[16:19], v[200:203], v[92:95]
 s_cmp_lt_u32 s33, 155648
 s_cselect_b32 s33, s33, 98304
 v_mfma_f32_16x16x32_bf16 v[96:99], a[20:23], v[200:203], v[96:99]
 v_mfma_f32_16x16x32_bf16 v[100:103], a[12:15], v[204:207], v[100:103]
 ds_read_b128 v[172:175], v18 offset:6144
 v_mfma_f32_16x16x32_bf16 v[104:107], a[16:19], v[204:207], v[104:107]
 v_mfma_f32_16x16x32_bf16 v[108:111], a[20:23], v[204:207], v[108:111]
 s_waitcnt lgkmcnt(2)
 v_mfma_f32_16x16x32_bf16 v[64:67], a[24:27], v[160:163], v[64:67]
 ds_read_b128 v[192:195], v19 offset:0
 v_mfma_f32_16x16x32_bf16 v[68:71], a[28:31], v[160:163], v[68:71]
 v_add_u32 v18, s33, v14
 v_mfma_f32_16x16x32_bf16 v[72:75], a[32:35], v[160:163], v[72:75]
 v_mfma_f32_16x16x32_bf16 v[76:79], a[24:27], v[164:167], v[76:79]
 ds_read_b128 v[196:199], v19 offset:2048
 v_mfma_f32_16x16x32_bf16 v[80:83], a[28:31], v[164:167], v[80:83]
 buffer_load_dwordx4 v11, s[8:11], s30 offen offset:1024 lds
 v_mfma_f32_16x16x32_bf16 v[84:87], a[32:35], v[164:167], v[84:87]
 s_waitcnt lgkmcnt(2)
 s_add_u32 s30, s30, 128
 v_mfma_f32_16x16x32_bf16 v[88:91], a[24:27], v[168:171], v[88:91]
 ds_read_b128 v[200:203], v19 offset:4096
 s_add_u32 m0, m0, 8192
 v_mfma_f32_16x16x32_bf16 v[92:95], a[28:31], v[168:171], v[92:95]
 s_cmp_lt_u32 m0, s46
 s_cselect_b32 m0, m0, s47
 v_mfma_f32_16x16x32_bf16 v[96:99], a[32:35], v[168:171], v[96:99]
 v_mfma_f32_16x16x32_bf16 v[100:103], a[24:27], v[172:175], v[100:103]
 ds_read_b128 v[204:207], v19 offset:6144
 v_mfma_f32_16x16x32_bf16 v[104:107], a[28:31], v[172:175], v[104:107]
 v_mfma_f32_16x16x32_bf16 v[108:111], a[32:35], v[172:175], v[108:111]
 s_waitcnt vmcnt(32) lgkmcnt(2)
 s_barrier
 v_mfma_f32_16x16x32_bf16 v[64:67], a[36:39], v[192:195], v[64:67]
 ds_read_b128 v[160:163], v18 offset:0
 v_mfma_f32_16x16x32_bf16 v[68:71], a[40:43], v[192:195], v[68:71]
 v_mfma_f32_16x16x32_bf16 v[72:75], a[44:47], v[192:195], v[72:75]
 v_add_u32 v19, s33, v15
 s_add_u32 s33, s33, 8192
 v_mfma_f32_16x16x32_bf16 v[76:79], a[36:39], v[196:199], v[76:79]
 ds_read_b128 v[164:167], v18 offset:2048
 v_mfma_f32_16x16x32_bf16 v[80:83], a[40:43], v[196:199], v[80:83]
 buffer_load_dwordx4 v10, s[8:11], s30 offen offset:0 lds
 v_mfma_f32_16x16x32_bf16 v[84:87], a[44:47], v[196:199], v[84:87]
 s_waitcnt lgkmcnt(2)
 v_mfma_f32_16x16x32_bf16 v[88:91], a[36:39], v[200:203], v[88:91]
 ds_read_b128 v[168:171], v18 offset:4096
 v_mfma_f32_16x16x32_bf16 v[92:95], a[40:43], v[200:203], v[92:95]
 s_cmp_lt_u32 s33, 155648
 s_cselect_b32 s33, s33, 98304
 v_mfma_f32_16x16x32_bf16 v[96:99], a[44:47], v[200:203], v[96:99]
 v_mfma_f32_16x16x32_bf16 v[100:103], a[36:39], v[204:207], v[100:103]
 ds_read_b128 v[172:175], v18 offset:6144
 v_mfma_f32_16x16x32_bf16 v[104:107], a[40:43], v[204:207], v[104:107]
 v_mfma_f32_16x16x32_bf16 v[108:111], a[44:47], v[204:207], v[108:111]
 s_waitcnt lgkmcnt(2)
 s_waitcnt vmcnt(17)
 s_barrier
 ds_read_b64_tr_b16 a[48:49], v49 offset:0
 ds_read_b64_tr_b16 a[50:51], v49 offset:1536
 ds_read_b64_tr_b16 a[52:53], v50 offset:0
 ds_read_b64_tr_b16 a[54:55], v50 offset:1536
 ds_read_b64_tr_b16 a[56:57], v51 offset:0
 ds_read_b64_tr_b16 a[58:59], v51 offset:1536
 ds_read_b64_tr_b16 a[60:61], v49 offset:12288
 ds_read_b64_tr_b16 a[62:63], v49 offset:13824
 ds_read_b64_tr_b16 a[64:65], v50 offset:12288
 ds_read_b64_tr_b16 a[66:67], v50 offset:13824
 ds_read_b64_tr_b16 a[68:69], v51 offset:12288
 ds_read_b64_tr_b16 a[70:71], v51 offset:13824
 ds_read_b64_tr_b16 a[72:73], v49 offset:24576
 ds_read_b64_tr_b16 a[74:75], v49 offset:26112
 ds_read_b64_tr_b16 a[76:77], v50 offset:24576
 ds_read_b64_tr_b16 a[78:79], v50 offset:26112
 ds_read_b64_tr_b16 a[80:81], v51 offset:24576
 ds_read_b64_tr_b16 a[82:83], v51 offset:26112
 ds_read_b64_tr_b16 a[84:85], v49 offset:36864
 ds_read_b64_tr_b16 a[86:87], v49 offset:38400
 ds_read_b64_tr_b16 a[88:89], v50 offset:36864
 ds_read_b64_tr_b16 a[90:91], v50 offset:38400
 ds_read_b64_tr_b16 a[92:93], v51 offset:36864
 ds_read_b64_tr_b16 a[94:95], v51 offset:38400
 s_waitcnt lgkmcnt(0)
 s_barrier
 s_mov_b32 s23, m0
 s_mul_i32 s21, s20, 393216
 s_add_u32 s21, s21, 4718592
 s_add_u32 s21, s21, s44
 s_mul_i32 s22, s20, 12288
 s_add_u32 s22, s22, 49152
 s_add_u32 m0, s22, 0
 s_nop 0
 buffer_load_dwordx4 v40, s[12:15], s21 offen lds
 s_add_u32 m0, s22, 1024
 s_nop 0
 buffer_load_dwordx4 v41, s[12:15], s21 offen lds
 s_add_u32 m0, s22, 2048
 s_nop 0
 buffer_load_dwordx4 v42, s[12:15], s21 offen lds
 s_mul_i32 s21, s20, 393216
 s_add_u32 s21, s21, 4816896
 s_add_u32 s21, s21, s44
 s_mul_i32 s22, s20, 12288
 s_add_u32 s22, s22, 52224
 s_add_u32 m0, s22, 0
 s_nop 0
 buffer_load_dwordx4 v43, s[12:15], s21 offen lds
 s_add_u32 m0, s22, 1024
 s_nop 0
 buffer_load_dwordx4 v44, s[12:15], s21 offen lds
 s_add_u32 m0, s22, 2048
 s_nop 0
 buffer_load_dwordx4 v45, s[12:15], s21 offen lds
 s_mul_i32 s21, s20, 393216
 s_add_u32 s21, s21, 4915200
 s_add_u32 s21, s21, s44
 s_mul_i32 s22, s20, 12288
 s_add_u32 s22, s22, 55296
 s_add_u32 m0, s22, 0
 s_nop 0
 buffer_load_dwordx4 v40, s[12:15], s21 offen lds
 s_add_u32 m0, s22, 1024
 s_nop 0
 buffer_load_dwordx4 v41, s[12:15], s21 offen lds
 s_add_u32 m0, s22, 2048
 s_nop 0
 buffer_load_dwordx4 v42, s[12:15], s21 offen lds
 s_mul_i32 s21, s20, 393216
 s_add_u32 s21, s21, 5013504
 s_add_u32 s21, s21, s44
 s_mul_i32 s22, s20, 12288
 s_add_u32 s22, s22, 58368
 s_add_u32 m0, s22, 0
 s_nop 0
 buffer_load_dwordx4 v43, s[12:15], s21 offen lds
 s_add_u32 m0, s22, 1024
 s_nop 0
 buffer_load_dwordx4 v44, s[12:15], s21 offen lds
 s_add_u32 m0, s22, 2048
 s_nop 0
 buffer_load_dwordx4 v45, s[12:15], s21 offen lds
 s_mov_b32 m0, s23
 v_mfma_f32_16x16x32_bf16 v[64:67], a[48:51], v[160:163], v[64:67]
 ds_read_b128 v[192:195], v19 offset:0
 v_mfma_f32_16x16x32_bf16 v[68:71], a[52:55], v[160:163], v[68:71]
 v_add_u32 v18, s33, v14
 v_mfma_f32_16x16x32_bf16 v[72:75], a[56:59], v[160:163], v[72:75]
 v_mfma_f32_16x16x32_bf16 v[76:79], a[48:51], v[164:167], v[76:79]
 ds_read_b128 v[196:199], v19 offset:2048
 v_mfma_f32_16x16x32_bf16 v[80:83], a[52:55], v[164:167], v[80:83]
 buffer_load_dwordx4 v11, s[8:11], s30 offen offset:1024 lds
 v_mfma_f32_16x16x32_bf16 v[84:87], a[56:59], v[164:167], v[84:87]
 s_add_u32 s30, s30, 128
 v_mfma_f32_16x16x32_bf16 v[88:91], a[48:51], v[168:171], v[88:91]
 ds_read_b128 v[200:203], v19 offset:4096
 s_add_u32 m0, m0, 8192
 v_mfma_f32_16x16x32_bf16 v[92:95], a[52:55], v[168:171], v[92:95]
 s_cmp_lt_u32 m0, s46
 s_cselect_b32 m0, m0, s47
 v_mfma_f32_16x16x32_bf16 v[96:99], a[56:59], v[168:171], v[96:99]
 v_mfma_f32_16x16x32_bf16 v[100:103], a[48:51], v[172:175], v[100:103]
 ds_read_b128 v[204:207], v19 offset:6144
 v_mfma_f32_16x16x32_bf16 v[104:107], a[52:55], v[172:175], v[104:107]
 v_mfma_f32_16x16x32_bf16 v[108:111], a[56:59], v[172:175], v[108:111]
 s_waitcnt vmcnt(44) lgkmcnt(2)
 s_barrier
 v_mfma_f32_16x16x32_bf16 v[64:67], a[60:63], v[192:195], v[64:67]
 ds_read_b128 v[160:163], v18 offset:0
 v_mfma_f32_16x16x32_bf16 v[68:71], a[64:67], v[192:195], v[68:71]
 v_mfma_f32_16x16x32_bf16 v[72:75], a[68:71], v[192:195], v[72:75]
 v_add_u32 v19, s33, v15
 s_add_u32 s33, s33, 8192
 v_mfma_f32_16x16x32_bf16 v[76:79], a[60:63], v[196:199], v[76:79]
 ds_read_b128 v[164:167], v18 offset:2048
 v_mfma_f32_16x16x32_bf16 v[80:83], a[64:67], v[196:199], v[80:83]
 buffer_load_dwordx4 v10, s[8:11], s30 offen offset:0 lds
 v_mfma_f32_16x16x32_bf16 v[84:87], a[68:71], v[196:199], v[84:87]
 s_waitcnt lgkmcnt(2)
 v_mfma_f32_16x16x32_bf16 v[88:91], a[60:63], v[200:203], v[88:91]
 ds_read_b128 v[168:171], v18 offset:4096
 v_mfma_f32_16x16x32_bf16 v[92:95], a[64:67], v[200:203], v[92:95]
 s_cmp_lt_u32 s33, 155648
 s_cselect_b32 s33, s33, 98304
 v_mfma_f32_16x16x32_bf16 v[96:99], a[68:71], v[200:203], v[96:99]
 v_mfma_f32_16x16x32_bf16 v[100:103], a[60:63], v[204:207], v[100:103]
 ds_read_b128 v[172:175], v18 offset:6144
 v_mfma_f32_16x16x32_bf16 v[104:107], a[64:67], v[204:207], v[104:107]
 v_mfma_f32_16x16x32_bf16 v[108:111], a[68:71], v[204:207], v[108:111]
 s_waitcnt lgkmcnt(2)
 v_mfma_f32_16x16x32_bf16 v[64:67], a[72:75], v[160:163], v[64:67]
 ds_read_b128 v[192:195], v19 offset:0
 v_mfma_f32_16x16x32_bf16 v[68:71], a[76:79], v[160:163], v[68:71]
 v_add_u32 v18, s33, v14
 v_mfma_f32_16x16x32_bf16 v[72:75], a[80:83], v[160:163], v[72:75]
 v_mfma_f32_16x16x32_bf16 v[76:79], a[72:75], v[164:167], v[76:79]
 ds_read_b128 v[196:199], v19 offset:2048
 v_mfma_f32_16x16x32_bf16 v[80:83], a[76:79], v[164:167], v[80:83]
 buffer_load_dwordx4 v11, s[8:11], s30 offen offset:1024 lds
 v_mfma_f32_16x16x32_bf16 v[84:87], a[80:83], v[164:167], v[84:87]
 s_waitcnt lgkmcnt(2)
 s_add_u32 s30, s30, 128
 v_mfma_f32_16x16x32_bf16 v[88:91], a[72:75], v[168:171], v[88:91]
 ds_read_b128 v[200:203], v19 offset:4096
 s_add_u32 m0, m0, 8192
 v_mfma_f32_16x16x32_bf16 v[92:95], a[76:79], v[168:171], v[92:95]
 s_cmp_lt_u32 m0, s46
 s_cselect_b32 m0, m0, s47
 v_mfma_f32_16x16x32_bf16 v[96:99], a[80:83], v[168:171], v[96:99]
 v_mfma_f32_16x16x32_bf16 v[100:103], a[72:75], v[172:175], v[100:103]
 ds_read_b128 v[204:207], v19 offset:6144
 v_mfma_f32_16x16x32_bf16 v[104:107], a[76:79], v[172:175], v[104:107]
 v_mfma_f32_16x16x32_bf16 v[108:111], a[80:83], v[172:175], v[108:111]
 s_waitcnt vmcnt(44) lgkmcnt(2)
 s_barrier
 v_mfma_f32_16x16x32_bf16 v[64:67], a[84:87], v[192:195], v[64:67]
 ds_read_b128 v[160:163], v18 offset:0
 v_mfma_f32_16x16x32_bf16 v[68:71], a[88:91], v[192:195], v[68:71]
 v_mfma_f32_16x16x32_bf16 v[72:75], a[92:95], v[192:195], v[72:75]
 v_add_u32 v19, s33, v15
 s_add_u32 s33, s33, 8192
 v_mfma_f32_16x16x32_bf16 v[76:79], a[84:87], v[196:199], v[76:79]
 ds_read_b128 v[164:167], v18 offset:2048
 v_mfma_f32_16x16x32_bf16 v[80:83], a[88:91], v[196:199], v[80:83]
 buffer_load_dwordx4 v10, s[8:11], s30 offen offset:0 lds
 v_mfma_f32_16x16x32_bf16 v[84:87], a[92:95], v[196:199], v[84:87]
 s_waitcnt lgkmcnt(2)
 v_mfma_f32_16x16x32_bf16 v[88:91], a[84:87], v[200:203], v[88:91]
 ds_read_b128 v[168:171], v18 offset:4096
 v_mfma_f32_16x16x32_bf16 v[92:95], a[88:91], v[200:203], v[92:95]
 s_cmp_lt_u32 s33, 155648
 s_cselect_b32 s33, s33, 98304
 v_mfma_f32_16x16x32_bf16 v[96:99], a[92:95], v[200:203], v[96:99]
 v_mfma_f32_16x16x32_bf16 v[100:103], a[84:87], v[204:207], v[100:103]
 ds_read_b128 v[172:175], v18 offset:6144
 v_mfma_f32_16x16x32_bf16 v[104:107], a[88:91], v[204:207], v[104:107]
 v_mfma_f32_16x16x32_bf16 v[108:111], a[92:95], v[204:207], v[108:111]
 s_waitcnt lgkmcnt(2)
 s_waitcnt vmcnt(20)
 s_barrier
 ds_read_b64_tr_b16 a[96:97], v46 offset:0
 ds_read_b64_tr_b16 a[98:99], v46 offset:1536
 ds_read_b64_tr_b16 a[100:101], v47 offset:0
 ds_read_b64_tr_b16 a[102:103], v47 offset:1536
 ds_read_b64_tr_b16 a[104:105], v48 offset:0
 ds_read_b64_tr_b16 a[106:107], v48 offset:1536
 ds_read_b64_tr_b16 a[108:109], v46 offset:12288
 ds_read_b64_tr_b16 a[110:111], v46 offset:13824
 ds_read_b64_tr_b16 a[112:113], v47 offset:12288
 ds_read_b64_tr_b16 a[114:115], v47 offset:13824
 ds_read_b64_tr_b16 a[116:117], v48 offset:12288
 ds_read_b64_tr_b16 a[118:119], v48 offset:13824
 ds_read_b64_tr_b16 a[120:121], v46 offset:24576
 ds_read_b64_tr_b16 a[122:123], v46 offset:26112
 ds_read_b64_tr_b16 a[124:125], v47 offset:24576
 ds_read_b64_tr_b16 a[126:127], v47 offset:26112
 ds_read_b64_tr_b16 a[128:129], v48 offset:24576
 ds_read_b64_tr_b16 a[130:131], v48 offset:26112
 ds_read_b64_tr_b16 a[132:133], v46 offset:36864
 ds_read_b64_tr_b16 a[134:135], v46 offset:38400
 ds_read_b64_tr_b16 a[136:137], v47 offset:36864
 ds_read_b64_tr_b16 a[138:139], v47 offset:38400
 ds_read_b64_tr_b16 a[140:141], v48 offset:36864
 ds_read_b64_tr_b16 a[142:143], v48 offset:38400
 s_waitcnt lgkmcnt(0)
 s_barrier
 s_mov_b32 s23, m0
 s_mul_i32 s21, s20, 393216
 s_add_u32 s21, s21, 6291456
 s_add_u32 s21, s21, s44
 s_mul_i32 s22, s20, 12288
 s_add_u32 s22, s22, 0
 s_add_u32 m0, s22, 0
 s_nop 0
 buffer_load_dwordx4 v40, s[12:15], s21 offen lds
 s_add_u32 m0, s22, 1024
 s_nop 0
 buffer_load_dwordx4 v41, s[12:15], s21 offen lds
 s_add_u32 m0, s22, 2048
 s_nop 0
 buffer_load_dwordx4 v42, s[12:15], s21 offen lds
 s_mul_i32 s21, s20, 393216
 s_add_u32 s21, s21, 6389760
 s_add_u32 s21, s21, s44
 s_mul_i32 s22, s20, 12288
 s_add_u32 s22, s22, 3072
 s_add_u32 m0, s22, 0
 s_nop 0
 buffer_load_dwordx4 v43, s[12:15], s21 offen lds
 s_add_u32 m0, s22, 1024
 s_nop 0
 buffer_load_dwordx4 v44, s[12:15], s21 offen lds
 s_add_u32 m0, s22, 2048
 s_nop 0
 buffer_load_dwordx4 v45, s[12:15], s21 offen lds
 s_mul_i32 s21, s20, 393216
 s_add_u32 s21, s21, 6488064
 s_add_u32 s21, s21, s44
 s_mul_i32 s22, s20, 12288
 s_add_u32 s22, s22, 6144
 s_add_u32 m0, s22, 0
 s_nop 0
 buffer_load_dwordx4 v40, s[12:15], s21 offen lds
 s_add_u32 m0, s22, 1024
 s_nop 0
 buffer_load_dwordx4 v41, s[12:15], s21 offen lds
 s_add_u32 m0, s22, 2048
 s_nop 0
 buffer_load_dwordx4 v42, s[12:15], s21 offen lds
 s_mul_i32 s21, s20, 393216
 s_add_u32 s21, s21, 6586368
 s_add_u32 s21, s21, s44
 s_mul_i32 s22, s20, 12288
 s_add_u32 s22, s22, 9216
 s_add_u32 m0, s22, 0
 s_nop 0
 buffer_load_dwordx4 v43, s[12:15], s21 offen lds
 s_add_u32 m0, s22, 1024
 s_nop 0
 buffer_load_dwordx4 v44, s[12:15], s21 offen lds
 s_add_u32 m0, s22, 2048
 s_nop 0
 buffer_load_dwordx4 v45, s[12:15], s21 offen lds
 s_mov_b32 m0, s23
 v_mov_b32 v29, 76
 buffer_load_dword v29, v29, s[64:67], 0 offen sc1
 v_mfma_f32_16x16x32_bf16 v[64:67], a[96:99], v[160:163], v[64:67]
 ds_read_b128 v[192:195], v19 offset:0
 v_mfma_f32_16x16x32_bf16 v[68:71], a[100:103], v[160:163], v[68:71]
 v_add_u32 v18, s33, v14
 s_mov_b32 s61, s60
 v_mfma_f32_16x16x32_bf16 v[72:75], a[104:107], v[160:163], v[72:75]
 s_add_u32 s60, s60, s62
 s_lshr_b32 s48, s20, 1
 v_mfma_f32_16x16x32_bf16 v[76:79], a[96:99], v[164:167], v[76:79]
 ds_read_b128 v[196:199], v19 offset:2048
 s_mul_i32 s48, s48, 393216
 v_mfma_f32_16x16x32_bf16 v[80:83], a[100:103], v[164:167], v[80:83]
 buffer_load_dwordx4 v11, s[8:11], s30 offen offset:1024 lds
 v_mfma_f32_16x16x32_bf16 v[84:87], a[104:107], v[164:167], v[84:87]
 s_add_u32 s30, s30, s25
 v_mfma_f32_16x16x32_bf16 v[88:91], a[96:99], v[168:171], v[88:91]
 ds_read_b128 v[200:203], v19 offset:4096
 s_sub_u32 s30, s30, 1152
 v_mfma_f32_16x16x32_bf16 v[92:95], a[100:103], v[168:171], v[92:95]
 s_add_u32 m0, m0, 8192
 s_and_b32 s21, s20, 1
 v_mfma_f32_16x16x32_bf16 v[96:99], a[104:107], v[168:171], v[96:99]
 s_cmp_lt_u32 m0, s46
 s_cselect_b32 m0, m0, s47
 v_mfma_f32_16x16x32_bf16 v[100:103], a[96:99], v[172:175], v[100:103]
 ds_read_b128 v[204:207], v19 offset:6144
 s_mul_i32 s21, s21, 6144
 v_mfma_f32_16x16x32_bf16 v[104:107], a[100:103], v[172:175], v[104:107]
 s_add_u32 s48, s48, s21
 s_add_u32 s48, s48, s27
 v_mfma_f32_16x16x32_bf16 v[108:111], a[104:107], v[172:175], v[108:111]
 s_waitcnt vmcnt(33) lgkmcnt(2)
 s_barrier
 v_mfma_f32_16x16x32_bf16 v[64:67], a[108:111], v[192:195], v[64:67]
 ds_read_b128 v[160:163], v18 offset:0
 s_add_u32 s27, s27, s28
 v_mfma_f32_16x16x32_bf16 v[68:71], a[112:115], v[192:195], v[68:71]
 s_sub_u32 s26, s26, 1
 v_mfma_f32_16x16x32_bf16 v[72:75], a[116:119], v[192:195], v[72:75]
 v_add_u32 v19, s33, v15
 s_add_u32 s33, s33, 8192
 v_mfma_f32_16x16x32_bf16 v[76:79], a[108:111], v[196:199], v[76:79]
 ds_read_b128 v[164:167], v18 offset:2048
 v_mfma_f32_16x16x32_bf16 v[80:83], a[112:115], v[196:199], v[80:83]
 buffer_load_dwordx4 v10, s[8:11], s30 offen offset:0 lds
 v_mfma_f32_16x16x32_bf16 v[84:87], a[116:119], v[196:199], v[84:87]
 s_waitcnt lgkmcnt(2)
 v_mfma_f32_16x16x32_bf16 v[88:91], a[108:111], v[200:203], v[88:91]
 ds_read_b128 v[168:171], v18 offset:4096
 v_mfma_f32_16x16x32_bf16 v[92:95], a[112:115], v[200:203], v[92:95]
 s_cmp_lt_u32 s33, 155648
 s_cselect_b32 s33, s33, 98304
 v_mfma_f32_16x16x32_bf16 v[96:99], a[116:119], v[200:203], v[96:99]
 v_mfma_f32_16x16x32_bf16 v[100:103], a[108:111], v[204:207], v[100:103]
 ds_read_b128 v[172:175], v18 offset:6144
 v_mfma_f32_16x16x32_bf16 v[104:107], a[112:115], v[204:207], v[104:107]
 v_mfma_f32_16x16x32_bf16 v[108:111], a[116:119], v[204:207], v[108:111]
 s_waitcnt lgkmcnt(2)
 v_mfma_f32_16x16x32_bf16 v[64:67], a[120:123], v[160:163], v[64:67]
 ds_read_b128 v[192:195], v19 offset:0
 v_mfma_f32_16x16x32_bf16 v[68:71], a[124:127], v[160:163], v[68:71]
 v_add_u32 v18, s33, v14
 v_mfma_f32_16x16x32_bf16 v[72:75], a[128:131], v[160:163], v[72:75]
 v_mfma_f32_16x16x32_bf16 v[76:79], a[120:123], v[164:167], v[76:79]
 ds_read_b128 v[196:199], v19 offset:2048
 v_mfma_f32_16x16x32_bf16 v[80:83], a[124:127], v[164:167], v[80:83]
 buffer_load_dwordx4 v11, s[8:11], s30 offen offset:1024 lds
 v_mfma_f32_16x16x32_bf16 v[84:87], a[128:131], v[164:167], v[84:87]
 s_waitcnt lgkmcnt(2)
 s_add_u32 s30, s30, 128
 v_mfma_f32_16x16x32_bf16 v[88:91], a[120:123], v[168:171], v[88:91]
 ds_read_b128 v[200:203], v19 offset:4096
 s_add_u32 m0, m0, 8192
 v_mfma_f32_16x16x32_bf16 v[92:95], a[124:127], v[168:171], v[92:95]
 s_cmp_lt_u32 m0, s46
 s_cselect_b32 m0, m0, s47
 v_mfma_f32_16x16x32_bf16 v[96:99], a[128:131], v[168:171], v[96:99]
 v_mfma_f32_16x16x32_bf16 v[100:103], a[120:123], v[172:175], v[100:103]
 ds_read_b128 v[204:207], v19 offset:6144
 v_mfma_f32_16x16x32_bf16 v[104:107], a[124:127], v[172:175], v[104:107]
 v_mfma_f32_16x16x32_bf16 v[108:111], a[128:131], v[172:175], v[108:111]
 s_waitcnt vmcnt(33) lgkmcnt(2)
 s_barrier
 v_mfma_f32_16x16x32_bf16 v[64:67], a[132:135], v[192:195], v[64:67]
 ds_read_b128 v[160:163], v18 offset:0
 v_mfma_f32_16x16x32_bf16 v[68:71], a[136:139], v[192:195], v[68:71]
 v_mfma_f32_16x16x32_bf16 v[72:75], a[140:143], v[192:195], v[72:75]
 v_add_u32 v19, s33, v15
 s_add_u32 s33, s33, 8192
 v_mfma_f32_16x16x32_bf16 v[76:79], a[132:135], v[196:199], v[76:79]
 ds_read_b128 v[164:167], v18 offset:2048
 v_mfma_f32_16x16x32_bf16 v[80:83], a[136:139], v[196:199], v[80:83]
 buffer_load_dwordx4 v10, s[8:11], s30 offen offset:0 lds
 v_mfma_f32_16x16x32_bf16 v[84:87], a[140:143], v[196:199], v[84:87]
 s_waitcnt lgkmcnt(2)
 v_mfma_f32_16x16x32_bf16 v[88:91], a[132:135], v[200:203], v[88:91]
 ds_read_b128 v[168:171], v18 offset:4096
 v_mfma_f32_16x16x32_bf16 v[92:95], a[136:139], v[200:203], v[92:95]
 s_cmp_lt_u32 s33, 155648
 s_cselect_b32 s33, s33, 98304
 v_mfma_f32_16x16x32_bf16 v[96:99], a[140:143], v[200:203], v[96:99]
 v_mfma_f32_16x16x32_bf16 v[100:103], a[132:135], v[204:207], v[100:103]
 ds_read_b128 v[172:175], v18 offset:6144
 v_mfma_f32_16x16x32_bf16 v[104:107], a[136:139], v[204:207], v[104:107]
 v_mfma_f32_16x16x32_bf16 v[108:111], a[140:143], v[204:207], v[108:111]
 s_waitcnt lgkmcnt(2)
 s_waitcnt vmcnt(21)
 s_barrier
 ds_read_b64_tr_b16 a[144:145], v49 offset:0
 ds_read_b64_tr_b16 a[146:147], v49 offset:1536
 ds_read_b64_tr_b16 a[148:149], v50 offset:0
 ds_read_b64_tr_b16 a[150:151], v50 offset:1536
 ds_read_b64_tr_b16 a[152:153], v51 offset:0
 ds_read_b64_tr_b16 a[154:155], v51 offset:1536
 ds_read_b64_tr_b16 a[156:157], v49 offset:12288
 ds_read_b64_tr_b16 a[158:159], v49 offset:13824
 ds_read_b64_tr_b16 a[160:161], v50 offset:12288
 ds_read_b64_tr_b16 a[162:163], v50 offset:13824
 ds_read_b64_tr_b16 a[164:165], v51 offset:12288
 ds_read_b64_tr_b16 a[166:167], v51 offset:13824
 ds_read_b64_tr_b16 a[168:169], v49 offset:24576
 ds_read_b64_tr_b16 a[170:171], v49 offset:26112
 ds_read_b64_tr_b16 a[172:173], v50 offset:24576
 ds_read_b64_tr_b16 a[174:175], v50 offset:26112
 ds_read_b64_tr_b16 a[176:177], v51 offset:24576
 ds_read_b64_tr_b16 a[178:179], v51 offset:26112
 ds_read_b64_tr_b16 a[180:181], v49 offset:36864
 ds_read_b64_tr_b16 a[182:183], v49 offset:38400
 ds_read_b64_tr_b16 a[184:185], v50 offset:36864
 ds_read_b64_tr_b16 a[186:187], v50 offset:38400
 ds_read_b64_tr_b16 a[188:189], v51 offset:36864
 ds_read_b64_tr_b16 a[190:191], v51 offset:38400
 s_waitcnt lgkmcnt(0)
 s_barrier
 v_mfma_f32_16x16x32_bf16 v[64:67], a[144:147], v[160:163], v[64:67]
 ds_read_b128 v[192:195], v19 offset:0
 v_mfma_f32_16x16x32_bf16 v[68:71], a[148:151], v[160:163], v[68:71]
 v_add_u32 v18, s33, v14
 v_mfma_f32_16x16x32_bf16 v[72:75], a[152:155], v[160:163], v[72:75]
 v_mfma_f32_16x16x32_bf16 v[76:79], a[144:147], v[164:167], v[76:79]
 ds_read_b128 v[196:199], v19 offset:2048
 v_mfma_f32_16x16x32_bf16 v[80:83], a[148:151], v[164:167], v[80:83]
 buffer_load_dwordx4 v11, s[8:11], s30 offen offset:1024 lds
 v_mfma_f32_16x16x32_bf16 v[84:87], a[152:155], v[164:167], v[84:87]
 s_add_u32 s30, s30, 128
 v_mfma_f32_16x16x32_bf16 v[88:91], a[144:147], v[168:171], v[88:91]
 ds_read_b128 v[200:203], v19 offset:4096
 s_add_u32 m0, m0, 8192
 v_mfma_f32_16x16x32_bf16 v[92:95], a[148:151], v[168:171], v[92:95]
 s_cmp_lt_u32 m0, s46
 s_cselect_b32 m0, m0, s47
 v_mfma_f32_16x16x32_bf16 v[96:99], a[152:155], v[168:171], v[96:99]
 v_mfma_f32_16x16x32_bf16 v[100:103], a[144:147], v[172:175], v[100:103]
 ds_read_b128 v[204:207], v19 offset:6144
 v_mfma_f32_16x16x32_bf16 v[104:107], a[148:151], v[172:175], v[104:107]
 v_mfma_f32_16x16x32_bf16 v[108:111], a[152:155], v[172:175], v[108:111]
 s_waitcnt vmcnt(21) lgkmcnt(2)
 s_barrier
 v_mfma_f32_16x16x32_bf16 v[64:67], a[156:159], v[192:195], v[64:67]
 ds_read_b128 v[160:163], v18 offset:0
 v_mfma_f32_16x16x32_bf16 v[68:71], a[160:163], v[192:195], v[68:71]
 v_mfma_f32_16x16x32_bf16 v[72:75], a[164:167], v[192:195], v[72:75]
 v_add_u32 v19, s33, v15
 s_add_u32 s33, s33, 8192
 v_mfma_f32_16x16x32_bf16 v[76:79], a[156:159], v[196:199], v[76:79]
 ds_read_b128 v[164:167], v18 offset:2048
 v_mfma_f32_16x16x32_bf16 v[80:83], a[160:163], v[196:199], v[80:83]
 buffer_load_dwordx4 v10, s[8:11], s30 offen offset:0 lds
 v_mfma_f32_16x16x32_bf16 v[84:87], a[164:167], v[196:199], v[84:87]
 s_waitcnt lgkmcnt(2)
 v_mfma_f32_16x16x32_bf16 v[88:91], a[156:159], v[200:203], v[88:91]
 ds_read_b128 v[168:171], v18 offset:4096
 v_mfma_f32_16x16x32_bf16 v[92:95], a[160:163], v[200:203], v[92:95]
 s_cmp_lt_u32 s33, 155648
 s_cselect_b32 s33, s33, 98304
 v_mfma_f32_16x16x32_bf16 v[96:99], a[164:167], v[200:203], v[96:99]
 v_mfma_f32_16x16x32_bf16 v[100:103], a[156:159], v[204:207], v[100:103]
 ds_read_b128 v[172:175], v18 offset:6144
 v_mfma_f32_16x16x32_bf16 v[104:107], a[160:163], v[204:207], v[104:107]
 v_mfma_f32_16x16x32_bf16 v[108:111], a[164:167], v[204:207], v[108:111]
 s_waitcnt lgkmcnt(2)
 v_mfma_f32_16x16x32_bf16 v[64:67], a[168:171], v[160:163], v[64:67]
 ds_read_b128 v[192:195], v19 offset:0
 v_mfma_f32_16x16x32_bf16 v[68:71], a[172:175], v[160:163], v[68:71]
 v_add_u32 v18, s33, v14
 v_mfma_f32_16x16x32_bf16 v[72:75], a[176:179], v[160:163], v[72:75]
 v_mfma_f32_16x16x32_bf16 v[76:79], a[168:171], v[164:167], v[76:79]
 ds_read_b128 v[196:199], v19 offset:2048
 v_mfma_f32_16x16x32_bf16 v[80:83], a[172:175], v[164:167], v[80:83]
 buffer_load_dwordx4 v11, s[8:11], s30 offen offset:1024 lds
 v_mfma_f32_16x16x32_bf16 v[84:87], a[176:179], v[164:167], v[84:87]
 s_waitcnt lgkmcnt(2)
 s_add_u32 s30, s30, 128
 v_mfma_f32_16x16x32_bf16 v[88:91], a[168:171], v[168:171], v[88:91]
 ds_read_b128 v[200:203], v19 offset:4096
 s_add_u32 m0, m0, 8192
 v_mfma_f32_16x16x32_bf16 v[92:95], a[172:175], v[168:171], v[92:95]
 s_cmp_lt_u32 m0, s46
 s_cselect_b32 m0, m0, s47
 v_mfma_f32_16x16x32_bf16 v[96:99], a[176:179], v[168:171], v[96:99]
 v_mfma_f32_16x16x32_bf16 v[100:103], a[168:171], v[172:175], v[100:103]
 ds_read_b128 v[204:207], v19 offset:6144
 v_mfma_f32_16x16x32_bf16 v[104:107], a[172:175], v[172:175], v[104:107]
 v_mfma_f32_16x16x32_bf16 v[108:111], a[176:179], v[172:175], v[108:111]
 s_waitcnt vmcnt(21) lgkmcnt(2)
 s_barrier
 v_mfma_f32_16x16x32_bf16 v[64:67], a[180:183], v[192:195], v[64:67]
 ds_read_b128 v[160:163], v18 offset:0
 v_mfma_f32_16x16x32_bf16 v[68:71], a[184:187], v[192:195], v[68:71]
 v_mfma_f32_16x16x32_bf16 v[72:75], a[188:191], v[192:195], v[72:75]
 v_add_u32 v19, s33, v15
 s_add_u32 s33, s33, 8192
 v_mfma_f32_16x16x32_bf16 v[76:79], a[180:183], v[196:199], v[76:79]
 ds_read_b128 v[164:167], v18 offset:2048
 v_mfma_f32_16x16x32_bf16 v[80:83], a[184:187], v[196:199], v[80:83]
 buffer_load_dwordx4 v10, s[8:11], s30 offen offset:0 lds
 v_mfma_f32_16x16x32_bf16 v[84:87], a[188:191], v[196:199], v[84:87]
 s_waitcnt lgkmcnt(2)
 v_mfma_f32_16x16x32_bf16 v[88:91], a[180:183], v[200:203], v[88:91]
 ds_read_b128 v[168:171], v18 offset:4096
 v_mfma_f32_16x16x32_bf16 v[92:95], a[184:187], v[200:203], v[92:95]
 s_cmp_lt_u32 s33, 155648
 s_cselect_b32 s33, s33, 98304
 v_mfma_f32_16x16x32_bf16 v[96:99], a[188:191], v[200:203], v[96:99]
 v_mfma_f32_16x16x32_bf16 v[100:103], a[180:183], v[204:207], v[100:103]
 ds_read_b128 v[172:175], v18 offset:6144
 v_mfma_f32_16x16x32_bf16 v[104:107], a[184:187], v[204:207], v[104:107]
 v_mfma_f32_16x16x32_bf16 v[108:111], a[188:191], v[204:207], v[108:111]
 s_waitcnt lgkmcnt(2)
 s_waitcnt vmcnt(9)
 s_barrier
 ds_read_b64_tr_b16 a[192:193], v46 offset:0
 ds_read_b64_tr_b16 a[194:195], v46 offset:1536
 ds_read_b64_tr_b16 a[196:197], v47 offset:0
 ds_read_b64_tr_b16 a[198:199], v47 offset:1536
 ds_read_b64_tr_b16 a[200:201], v48 offset:0
 ds_read_b64_tr_b16 a[202:203], v48 offset:1536
 ds_read_b64_tr_b16 a[204:205], v46 offset:12288
 ds_read_b64_tr_b16 a[206:207], v46 offset:13824
 ds_read_b64_tr_b16 a[208:209], v47 offset:12288
 ds_read_b64_tr_b16 a[210:211], v47 offset:13824
 ds_read_b64_tr_b16 a[212:213], v48 offset:12288
 ds_read_b64_tr_b16 a[214:215], v48 offset:13824
 ds_read_b64_tr_b16 a[216:217], v46 offset:24576
 ds_read_b64_tr_b16 a[218:219], v46 offset:26112
 ds_read_b64_tr_b16 a[220:221], v47 offset:24576
 ds_read_b64_tr_b16 a[222:223], v47 offset:26112
 ds_read_b64_tr_b16 a[224:225], v48 offset:24576
 ds_read_b64_tr_b16 a[226:227], v48 offset:26112
 ds_read_b64_tr_b16 a[228:229], v46 offset:36864
 ds_read_b64_tr_b16 a[230:231], v46 offset:38400
 ds_read_b64_tr_b16 a[232:233], v47 offset:36864
 ds_read_b64_tr_b16 a[234:235], v47 offset:38400
 ds_read_b64_tr_b16 a[236:237], v48 offset:36864
 ds_read_b64_tr_b16 a[238:239], v48 offset:38400
 s_waitcnt lgkmcnt(0)
 s_barrier
 v_mfma_f32_16x16x32_bf16 v[64:67], a[192:195], v[160:163], v[64:67]
 ds_read_b128 v[192:195], v19 offset:0
 v_mfma_f32_16x16x32_bf16 v[68:71], a[196:199], v[160:163], v[68:71]
 v_add_u32 v18, s33, v14
 v_mfma_f32_16x16x32_bf16 v[72:75], a[200:203], v[160:163], v[72:75]
 v_mfma_f32_16x16x32_bf16 v[76:79], a[192:195], v[164:167], v[76:79]
 ds_read_b128 v[196:199], v19 offset:2048
 v_mfma_f32_16x16x32_bf16 v[80:83], a[196:199], v[164:167], v[80:83]
 buffer_load_dwordx4 v11, s[8:11], s30 offen offset:1024 lds
 v_mfma_f32_16x16x32_bf16 v[84:87], a[200:203], v[164:167], v[84:87]
 s_add_u32 s30, s30, 128
 v_mfma_f32_16x16x32_bf16 v[88:91], a[192:195], v[168:171], v[88:91]
 ds_read_b128 v[200:203], v19 offset:4096
 s_add_u32 m0, m0, 8192
 v_mfma_f32_16x16x32_bf16 v[92:95], a[196:199], v[168:171], v[92:95]
 s_cmp_lt_u32 m0, s46
 s_cselect_b32 m0, m0, s47
 v_mfma_f32_16x16x32_bf16 v[96:99], a[200:203], v[168:171], v[96:99]
 v_mfma_f32_16x16x32_bf16 v[100:103], a[192:195], v[172:175], v[100:103]
 ds_read_b128 v[204:207], v19 offset:6144
 v_mfma_f32_16x16x32_bf16 v[104:107], a[196:199], v[172:175], v[104:107]
 v_mfma_f32_16x16x32_bf16 v[108:111], a[200:203], v[172:175], v[108:111]
 s_waitcnt vmcnt(8) lgkmcnt(2)
 s_barrier
 v_mfma_f32_16x16x32_bf16 v[64:67], a[204:207], v[192:195], v[64:67]
 ds_read_b128 v[160:163], v18 offset:0
 v_mfma_f32_16x16x32_bf16 v[68:71], a[208:211], v[192:195], v[68:71]
 v_mfma_f32_16x16x32_bf16 v[72:75], a[212:215], v[192:195], v[72:75]
 v_add_u32 v19, s33, v15
 s_add_u32 s33, s33, 8192
 v_mfma_f32_16x16x32_bf16 v[76:79], a[204:207], v[196:199], v[76:79]
 ds_read_b128 v[164:167], v18 offset:2048
 v_mfma_f32_16x16x32_bf16 v[80:83], a[208:211], v[196:199], v[80:83]
 buffer_load_dwordx4 v10, s[8:11], s30 offen offset:0 lds
 v_mfma_f32_16x16x32_bf16 v[84:87], a[212:215], v[196:199], v[84:87]
 s_waitcnt lgkmcnt(2)
 v_mfma_f32_16x16x32_bf16 v[88:91], a[204:207], v[200:203], v[88:91]
 ds_read_b128 v[168:171], v18 offset:4096
 v_mfma_f32_16x16x32_bf16 v[92:95], a[208:211], v[200:203], v[92:95]
 s_cmp_lt_u32 s33, 155648
 s_cselect_b32 s33, s33, 98304
 v_mfma_f32_16x16x32_bf16 v[96:99], a[212:215], v[200:203], v[96:99]
 v_mfma_f32_16x16x32_bf16 v[100:103], a[204:207], v[204:207], v[100:103]
 ds_read_b128 v[172:175], v18 offset:6144
 v_mfma_f32_16x16x32_bf16 v[104:107], a[208:211], v[204:207], v[104:107]
 v_mfma_f32_16x16x32_bf16 v[108:111], a[212:215], v[204:207], v[108:111]
 s_waitcnt lgkmcnt(2)
 v_mfma_f32_16x16x32_bf16 v[64:67], a[216:219], v[160:163], v[64:67]
 ds_read_b128 v[192:195], v19 offset:0
 v_mfma_f32_16x16x32_bf16 v[68:71], a[220:223], v[160:163], v[68:71]
 v_add_u32 v18, s33, v14
 v_mfma_f32_16x16x32_bf16 v[72:75], a[224:227], v[160:163], v[72:75]
 v_mfma_f32_16x16x32_bf16 v[76:79], a[216:219], v[164:167], v[76:79]
 ds_read_b128 v[196:199], v19 offset:2048
 v_mfma_f32_16x16x32_bf16 v[80:83], a[220:223], v[164:167], v[80:83]
 buffer_load_dwordx4 v11, s[8:11], s30 offen offset:1024 lds
 v_mfma_f32_16x16x32_bf16 v[84:87], a[224:227], v[164:167], v[84:87]
 s_waitcnt lgkmcnt(2)
 s_add_u32 s30, s30, 128
 v_mfma_f32_16x16x32_bf16 v[88:91], a[216:219], v[168:171], v[88:91]
 ds_read_b128 v[200:203], v19 offset:4096
 s_add_u32 m0, m0, 8192
 v_mfma_f32_16x16x32_bf16 v[92:95], a[220:223], v[168:171], v[92:95]
 s_cmp_lt_u32 m0, s46
 s_cselect_b32 m0, m0, s47
 v_mfma_f32_16x16x32_bf16 v[96:99], a[224:227], v[168:171], v[96:99]
 v_mfma_f32_16x16x32_bf16 v[100:103], a[216:219], v[172:175], v[100:103]
 ds_read_b128 v[204:207], v19 offset:6144
 v_mfma_f32_16x16x32_bf16 v[104:107], a[220:223], v[172:175], v[104:107]
 v_mfma_f32_16x16x32_bf16 v[108:111], a[224:227], v[172:175], v[108:111]
 s_waitcnt vmcnt(8) lgkmcnt(2)
 s_barrier
 v_mfma_f32_16x16x32_bf16 v[64:67], a[228:231], v[192:195], v[64:67]
 ds_read_b128 v[160:163], v18 offset:0
 v_mfma_f32_16x16x32_bf16 v[68:71], a[232:235], v[192:195], v[68:71]
 v_mfma_f32_16x16x32_bf16 v[72:75], a[236:239], v[192:195], v[72:75]
 v_add_u32 v19, s33, v15
 s_add_u32 s33, s33, 8192
 v_mfma_f32_16x16x32_bf16 v[76:79], a[228:231], v[196:199], v[76:79]
 ds_read_b128 v[164:167], v18 offset:2048
 v_cvt_pk_bf16_f32 v224, v64, v65
 v_cvt_pk_bf16_f32 v225, v66, v67
 v_mfma_f32_16x16x32_bf16 v[80:83], a[232:235], v[196:199], v[80:83]
 buffer_load_dwordx4 v10, s[8:11], s30 offen offset:0 lds
 v_cvt_pk_bf16_f32 v226, v68, v69
 v_cvt_pk_bf16_f32 v227, v70, v71
 v_mfma_f32_16x16x32_bf16 v[84:87], a[236:239], v[196:199], v[84:87]
 s_waitcnt lgkmcnt(2)
 v_cvt_pk_bf16_f32 v228, v72, v73
 v_cvt_pk_bf16_f32 v229, v74, v75
 v_mfma_f32_16x16x32_bf16 v[88:91], a[228:231], v[200:203], v[88:91]
 ds_read_b128 v[168:171], v18 offset:4096
 ds_write_b64 v22, v[224:225] offset:0
 v_mfma_f32_16x16x32_bf16 v[92:95], a[232:235], v[200:203], v[92:95]
 s_cmp_lt_u32 s33, 155648
 s_cselect_b32 s33, s33, 98304
 ds_write_b64 v22, v[226:227] offset:8
 v_mfma_f32_16x16x32_bf16 v[96:99], a[236:239], v[200:203], v[96:99]
 ds_write_b64 v16, v[228:229] offset:64
 v_cvt_pk_bf16_f32 v230, v76, v77
 v_cvt_pk_bf16_f32 v231, v78, v79
 v_mfma_f32_16x16x32_bf16 v[100:103], a[228:231], v[204:207], v[100:103]
 ds_read_b128 v[172:175], v18 offset:6144
 v_cvt_pk_bf16_f32 v232, v80, v81
 v_cvt_pk_bf16_f32 v233, v82, v83
 v_cvt_pk_bf16_f32 v234, v84, v85
 v_mfma_f32_16x16x32_bf16 v[104:107], a[232:235], v[204:207], v[104:107]
 v_cvt_pk_bf16_f32 v235, v86, v87
 ds_write_b64 v22, v[230:231] offset:6400
 v_mfma_f32_16x16x32_bf16 v[108:111], a[236:239], v[204:207], v[108:111]
 ds_write_b64 v22, v[232:233] offset:6408
 ds_write_b64 v16, v[234:235] offset:6464
 v_readfirstlane_b32 s21, v29
 s_cmp_ge_u32 s21, 32
 s_cbranch_scc1 kvz_128
 s_mov_b32 s21, 76
 v_mov_b32 v4, 0
 s_mov_b32 s101, 0
wf_129:
 buffer_load_dword v5, v4, s[64:67], s21 offen sc1
 s_add_u32 s101, s101, 1
 s_cmp_gt_u32 s101, 131072
 s_cbranch_scc1 main_end
 s_waitcnt vmcnt(0)
 v_readfirstlane_b32 s100, v5
 s_cmp_ge_u32 s100, 32
 s_cbranch_scc1 wf_130
 s_sleep 8
 s_branch wf_129
wf_130:
kvz_128:
 s_branch kvm_end_127
kvm_blk_126:
 v_mfma_f32_16x16x32_bf16 v[64:67], a[0:3], v[160:163], 0
 ds_read_b128 v[192:195], v19 offset:0
 v_mfma_f32_16x16x32_bf16 v[68:71], a[4:7], v[160:163], 0
 v_add_u32 v18, s33, v14
 v_mfma_f32_16x16x32_bf16 v[72:75], a[8:11], v[160:163], 0
 v_mfma_f32_16x16x32_bf16 v[76:79], a[0:3], v[164:167], 0
 ds_read_b128 v[196:199], v19 offset:2048
 v_mfma_f32_16x16x32_bf16 v[80:83], a[4:7], v[164:167], 0
 buffer_load_dwordx4 v11, s[8:11], s30 offen offset:1024 lds
 v_mfma_f32_16x16x32_bf16 v[84:87], a[8:11], v[164:167], 0
 s_waitcnt lgkmcnt(11)
 s_add_u32 s30, s30, 128
 v_mfma_f32_16x16x32_bf16 v[88:91], a[0:3], v[168:171], 0
 ds_read_b128 v[200:203], v19 offset:4096
 s_add_u32 m0, m0, 8192
 v_mfma_f32_16x16x32_bf16 v[92:95], a[4:7], v[168:171], 0
 s_cmp_lt_u32 m0, s46
 s_cselect_b32 m0, m0, s47
 v_mfma_f32_16x16x32_bf16 v[96:99], a[8:11], v[168:171], 0
 v_mfma_f32_16x16x32_bf16 v[100:103], a[0:3], v[172:175], 0
 ds_read_b128 v[204:207], v19 offset:6144
 v_mfma_f32_16x16x32_bf16 v[104:107], a[4:7], v[172:175], 0
 v_mfma_f32_16x16x32_bf16 v[108:111], a[8:11], v[172:175], 0
 s_waitcnt vmcnt(14) lgkmcnt(2)
 s_barrier
 v_mfma_f32_16x16x32_bf16 v[64:67], a[12:15], v[192:195], v[64:67]
 ds_read_b128 v[160:163], v18 offset:0
 v_mfma_f32_16x16x32_bf16 v[68:71], a[16:19], v[192:195], v[68:71]
 v_mfma_f32_16x16x32_bf16 v[72:75], a[20:23], v[192:195], v[72:75]
 v_add_u32 v19, s33, v15
 s_add_u32 s33, s33, 8192
 v_mfma_f32_16x16x32_bf16 v[76:79], a[12:15], v[196:199], v[76:79]
 ds_read_b128 v[164:167], v18 offset:2048
 v_mfma_f32_16x16x32_bf16 v[80:83], a[16:19], v[196:199], v[80:83]
 buffer_load_dwordx4 v10, s[8:11], s30 offen offset:0 lds
 v_mfma_f32_16x16x32_bf16 v[84:87], a[20:23], v[196:199], v[84:87]
 s_waitcnt lgkmcnt(2)
 v_mfma_f32_16x16x32_bf16 v[88:91], a[12:15], v[200:203], v[88:91]
 ds_read_b128 v[168:171], v18 offset:4096
 v_mfma_f32_16x16x32_bf16 v[92:95], a[16:19], v[200:203], v[92:95]
 s_cmp_lt_u32 s33, 155648
 s_cselect_b32 s33, s33, 98304
 v_mfma_f32_16x16x32_bf16 v[96:99], a[20:23], v[200:203], v[96:99]
 v_mfma_f32_16x16x32_bf16 v[100:103], a[12:15], v[204:207], v[100:103]
 ds_read_b128 v[172:175], v18 offset:6144
 v_mfma_f32_16x16x32_bf16 v[104:107], a[16:19], v[204:207], v[104:107]
 v_mfma_f32_16x16x32_bf16 v[108:111], a[20:23], v[204:207], v[108:111]
 s_waitcnt lgkmcnt(2)
 v_mfma_f32_16x16x32_bf16 v[64:67], a[24:27], v[160:163], v[64:67]
 ds_read_b128 v[192:195], v19 offset:0
 v_mfma_f32_16x16x32_bf16 v[68:71], a[28:31], v[160:163], v[68:71]
 v_add_u32 v18, s33, v14
 v_mfma_f32_16x16x32_bf16 v[72:75], a[32:35], v[160:163], v[72:75]
 v_mfma_f32_16x16x32_bf16 v[76:79], a[24:27], v[164:167], v[76:79]
 ds_read_b128 v[196:199], v19 offset:2048
 v_mfma_f32_16x16x32_bf16 v[80:83], a[28:31], v[164:167], v[80:83]
 buffer_load_dwordx4 v11, s[8:11], s30 offen offset:1024 lds
 v_mfma_f32_16x16x32_bf16 v[84:87], a[32:35], v[164:167], v[84:87]
 s_waitcnt lgkmcnt(2)
 s_add_u32 s30, s30, 128
 v_mfma_f32_16x16x32_bf16 v[88:91], a[24:27], v[168:171], v[88:91]
 ds_read_b128 v[200:203], v19 offset:4096
 s_add_u32 m0, m0, 8192
 v_mfma_f32_16x16x32_bf16 v[92:95], a[28:31], v[168:171], v[92:95]
 s_cmp_lt_u32 m0, s46
 s_cselect_b32 m0, m0, s47
 v_mfma_f32_16x16x32_bf16 v[96:99], a[32:35], v[168:171], v[96:99]
 v_mfma_f32_16x16x32_bf16 v[100:103], a[24:27], v[172:175], v[100:103]
 ds_read_b128 v[204:207], v19 offset:6144
 v_mfma_f32_16x16x32_bf16 v[104:107], a[28:31], v[172:175], v[104:107]
 v_mfma_f32_16x16x32_bf16 v[108:111], a[32:35], v[172:175], v[108:111]
 s_waitcnt vmcnt(14) lgkmcnt(2)
 s_barrier
 v_mfma_f32_16x16x32_bf16 v[64:67], a[36:39], v[192:195], v[64:67]
 ds_read_b128 v[160:163], v18 offset:0
 v_mfma_f32_16x16x32_bf16 v[68:71], a[40:43], v[192:195], v[68:71]
 v_mfma_f32_16x16x32_bf16 v[72:75], a[44:47], v[192:195], v[72:75]
 v_add_u32 v19, s33, v15
 s_add_u32 s33, s33, 8192
 v_mfma_f32_16x16x32_bf16 v[76:79], a[36:39], v[196:199], v[76:79]
 ds_read_b128 v[164:167], v18 offset:2048
 v_mfma_f32_16x16x32_bf16 v[80:83], a[40:43], v[196:199], v[80:83]
 buffer_load_dwordx4 v10, s[8:11], s30 offen offset:0 lds
 v_mfma_f32_16x16x32_bf16 v[84:87], a[44:47], v[196:199], v[84:87]
 s_waitcnt lgkmcnt(2)
 v_mfma_f32_16x16x32_bf16 v[88:91], a[36:39], v[200:203], v[88:91]
 ds_read_b128 v[168:171], v18 offset:4096
 v_mfma_f32_16x16x32_bf16 v[92:95], a[40:43], v[200:203], v[92:95]
 s_cmp_lt_u32 s33, 155648
 s_cselect_b32 s33, s33, 98304
 v_mfma_f32_16x16x32_bf16 v[96:99], a[44:47], v[200:203], v[96:99]
 v_mfma_f32_16x16x32_bf16 v[100:103], a[36:39], v[204:207], v[100:103]
 ds_read_b128 v[172:175], v18 offset:6144
 v_mfma_f32_16x16x32_bf16 v[104:107], a[40:43], v[204:207], v[104:107]
 v_mfma_f32_16x16x32_bf16 v[108:111], a[44:47], v[204:207], v[108:111]
 s_waitcnt lgkmcnt(2)
 v_mfma_f32_16x16x32_bf16 v[64:67], a[48:51], v[160:163], v[64:67]
 ds_read_b128 v[192:195], v19 offset:0
 v_mfma_f32_16x16x32_bf16 v[68:71], a[52:55], v[160:163], v[68:71]
 v_add_u32 v18, s33, v14
 v_mfma_f32_16x16x32_bf16 v[72:75], a[56:59], v[160:163], v[72:75]
 v_mfma_f32_16x16x32_bf16 v[76:79], a[48:51], v[164:167], v[76:79]
 ds_read_b128 v[196:199], v19 offset:2048
 v_mfma_f32_16x16x32_bf16 v[80:83], a[52:55], v[164:167], v[80:83]
 buffer_load_dwordx4 v11, s[8:11], s30 offen offset:1024 lds
 v_mfma_f32_16x16x32_bf16 v[84:87], a[56:59], v[164:167], v[84:87]
 s_waitcnt lgkmcnt(2)
 s_add_u32 s30, s30, 128
 v_mfma_f32_16x16x32_bf16 v[88:91], a[48:51], v[168:171], v[88:91]
 ds_read_b128 v[200:203], v19 offset:4096
 s_add_u32 m0, m0, 8192
 v_mfma_f32_16x16x32_bf16 v[92:95], a[52:55], v[168:171], v[92:95]
 s_cmp_lt_u32 m0, s46
 s_cselect_b32 m0, m0, s47
 v_mfma_f32_16x16x32_bf16 v[96:99], a[56:59], v[168:171], v[96:99]
 v_mfma_f32_16x16x32_bf16 v[100:103], a[48:51], v[172:175], v[100:103]
 ds_read_b128 v[204:207], v19 offset:6144
 v_mfma_f32_16x16x32_bf16 v[104:107], a[52:55], v[172:175], v[104:107]
 v_mfma_f32_16x16x32_bf16 v[108:111], a[56:59], v[172:175], v[108:111]
 s_waitcnt vmcnt(14) lgkmcnt(2)
 s_barrier
 v_mfma_f32_16x16x32_bf16 v[64:67], a[60:63], v[192:195], v[64:67]
 ds_read_b128 v[160:163], v18 offset:0
 v_mfma_f32_16x16x32_bf16 v[68:71], a[64:67], v[192:195], v[68:71]
 v_mfma_f32_16x16x32_bf16 v[72:75], a[68:71], v[192:195], v[72:75]
 v_add_u32 v19, s33, v15
 s_add_u32 s33, s33, 8192
 v_mfma_f32_16x16x32_bf16 v[76:79], a[60:63], v[196:199], v[76:79]
 ds_read_b128 v[164:167], v18 offset:2048
 v_mfma_f32_16x16x32_bf16 v[80:83], a[64:67], v[196:199], v[80:83]
 buffer_load_dwordx4 v10, s[8:11], s30 offen offset:0 lds
 v_mfma_f32_16x16x32_bf16 v[84:87], a[68:71], v[196:199], v[84:87]
 s_waitcnt lgkmcnt(2)
 v_mfma_f32_16x16x32_bf16 v[88:91], a[60:63], v[200:203], v[88:91]
 ds_read_b128 v[168:171], v18 offset:4096
 v_mfma_f32_16x16x32_bf16 v[92:95], a[64:67], v[200:203], v[92:95]
 s_cmp_lt_u32 s33, 155648
 s_cselect_b32 s33, s33, 98304
 v_mfma_f32_16x16x32_bf16 v[96:99], a[68:71], v[200:203], v[96:99]
 v_mfma_f32_16x16x32_bf16 v[100:103], a[60:63], v[204:207], v[100:103]
 ds_read_b128 v[172:175], v18 offset:6144
 v_mfma_f32_16x16x32_bf16 v[104:107], a[64:67], v[204:207], v[104:107]
 v_mfma_f32_16x16x32_bf16 v[108:111], a[68:71], v[204:207], v[108:111]
 s_waitcnt lgkmcnt(2)
 v_mfma_f32_16x16x32_bf16 v[64:67], a[72:75], v[160:163], v[64:67]
 ds_read_b128 v[192:195], v19 offset:0
 v_mfma_f32_16x16x32_bf16 v[68:71], a[76:79], v[160:163], v[68:71]
 v_add_u32 v18, s33, v14
 v_mfma_f32_16x16x32_bf16 v[72:75], a[80:83], v[160:163], v[72:75]
 v_mfma_f32_16x16x32_bf16 v[76:79], a[72:75], v[164:167], v[76:79]
 ds_read_b128 v[196:199], v19 offset:2048
 v_mfma_f32_16x16x32_bf16 v[80:83], a[76:79], v[164:167], v[80:83]
 buffer_load_dwordx4 v11, s[8:11], s30 offen offset:1024 lds
 v_mfma_f32_16x16x32_bf16 v[84:87], a[80:83], v[164:167], v[84:87]
 s_waitcnt lgkmcnt(2)
 s_add_u32 s30, s30, 128
 v_mfma_f32_16x16x32_bf16 v[88:91], a[72:75], v[168:171], v[88:91]
 ds_read_b128 v[200:203], v19 offset:4096
 s_add_u32 m0, m0, 8192
 v_mfma_f32_16x16x32_bf16 v[92:95], a[76:79], v[168:171], v[92:95]
 s_cmp_lt_u32 m0, s46
 s_cselect_b32 m0, m0, s47
 v_mfma_f32_16x16x32_bf16 v[96:99], a[80:83], v[168:171], v[96:99]
 v_mfma_f32_16x16x32_bf16 v[100:103], a[72:75], v[172:175], v[100:103]
 ds_read_b128 v[204:207], v19 offset:6144
 v_mfma_f32_16x16x32_bf16 v[104:107], a[76:79], v[172:175], v[104:107]
 v_mfma_f32_16x16x32_bf16 v[108:111], a[80:83], v[172:175], v[108:111]
 s_waitcnt vmcnt(7) lgkmcnt(2)
 s_barrier
 v_mfma_f32_16x16x32_bf16 v[64:67], a[84:87], v[192:195], v[64:67]
 ds_read_b128 v[160:163], v18 offset:0
 v_mfma_f32_16x16x32_bf16 v[68:71], a[88:91], v[192:195], v[68:71]
 s_cmp_eq_u32 s48, 0x80000000
 s_cbranch_scc1 kvm_124
 s_cmp_lg_u32 s20, 0
 s_cbranch_scc1 af_125
 v_mov_b32 v4, 0
 v_mov_b32 v5, 1
 s_mov_b64 exec, 1
 buffer_atomic_add v5, v4, s[72:75], s61 offen sc1
 s_mov_b64 exec, -1
 s_nop 1
af_125:
kvm_124:
 v_mfma_f32_16x16x32_bf16 v[72:75], a[92:95], v[192:195], v[72:75]
 v_add_u32 v19, s33, v15
 s_add_u32 s33, s33, 8192
 v_mfma_f32_16x16x32_bf16 v[76:79], a[84:87], v[196:199], v[76:79]
 ds_read_b128 v[164:167], v18 offset:2048
 v_mfma_f32_16x16x32_bf16 v[80:83], a[88:91], v[196:199], v[80:83]
 buffer_load_dwordx4 v10, s[8:11], s30 offen offset:0 lds
 v_mfma_f32_16x16x32_bf16 v[84:87], a[92:95], v[196:199], v[84:87]
 s_waitcnt lgkmcnt(2)
 v_mfma_f32_16x16x32_bf16 v[88:91], a[84:87], v[200:203], v[88:91]
 ds_read_b128 v[168:171], v18 offset:4096
 v_mfma_f32_16x16x32_bf16 v[92:95], a[88:91], v[200:203], v[92:95]
 s_cmp_lt_u32 s33, 155648
 s_cselect_b32 s33, s33, 98304
 v_mfma_f32_16x16x32_bf16 v[96:99], a[92:95], v[200:203], v[96:99]
 v_mfma_f32_16x16x32_bf16 v[100:103], a[84:87], v[204:207], v[100:103]
 ds_read_b128 v[172:175], v18 offset:6144
 v_mfma_f32_16x16x32_bf16 v[104:107], a[88:91], v[204:207], v[104:107]
 v_mfma_f32_16x16x32_bf16 v[108:111], a[92:95], v[204:207], v[108:111]
 s_waitcnt lgkmcnt(2)
 v_mfma_f32_16x16x32_bf16 v[64:67], a[96:99], v[160:163], v[64:67]
 ds_read_b128 v[192:195], v19 offset:0
 v_mfma_f32_16x16x32_bf16 v[68:71], a[100:103], v[160:163], v[68:71]
 v_add_u32 v18, s33, v14
 s_mov_b32 s61, s60
 v_mfma_f32_16x16x32_bf16 v[72:75], a[104:107], v[160:163], v[72:75]
 s_add_u32 s60, s60, s62
 s_lshr_b32 s48, s20, 1
 v_mfma_f32_16x16x32_bf16 v[76:79], a[96:99], v[164:167], v[76:79]
 ds_read_b128 v[196:199], v19 offset:2048
 s_mul_i32 s48, s48, 393216
 v_mfma_f32_16x16x32_bf16 v[80:83], a[100:103], v[164:167], v[80:83]
 buffer_load_dwordx4 v11, s[8:11], s30 offen offset:1024 lds
 v_mfma_f32_16x16x32_bf16 v[84:87], a[104:107], v[164:167], v[84:87]
 s_waitcnt lgkmcnt(2)
 s_add_u32 s30, s30, s25
 v_mfma_f32_16x16x32_bf16 v[88:91], a[96:99], v[168:171], v[88:91]
 ds_read_b128 v[200:203], v19 offset:4096
 s_sub_u32 s30, s30, 1152
 v_mfma_f32_16x16x32_bf16 v[92:95], a[100:103], v[168:171], v[92:95]
 s_add_u32 m0, m0, 8192
 s_and_b32 s21, s20, 1
 v_mfma_f32_16x16x32_bf16 v[96:99], a[104:107], v[168:171], v[96:99]
 s_cmp_lt_u32 m0, s46
 s_cselect_b32 m0, m0, s47
 v_mfma_f32_16x16x32_bf16 v[100:103], a[96:99], v[172:175], v[100:103]
 ds_read_b128 v[204:207], v19 offset:6144
 s_mul_i32 s21, s21, 6144
 v_mfma_f32_16x16x32_bf16 v[104:107], a[100:103], v[172:175], v[104:107]
 s_add_u32 s48, s48, s21
 s_add_u32 s48, s48, s27
 v_mfma_f32_16x16x32_bf16 v[108:111], a[104:107], v[172:175], v[108:111]
 s_waitcnt vmcnt(8) lgkmcnt(2)
 s_barrier
 v_mfma_f32_16x16x32_bf16 v[64:67], a[108:111], v[192:195], v[64:67]
 ds_read_b128 v[160:163], v18 offset:0
 s_add_u32 s27, s27, s28
 v_mfma_f32_16x16x32_bf16 v[68:71], a[112:115], v[192:195], v[68:71]
 s_sub_u32 s26, s26, 1
 v_mfma_f32_16x16x32_bf16 v[72:75], a[116:119], v[192:195], v[72:75]
 v_add_u32 v19, s33, v15
 s_add_u32 s33, s33, 8192
 v_mfma_f32_16x16x32_bf16 v[76:79], a[108:111], v[196:199], v[76:79]
 ds_read_b128 v[164:167], v18 offset:2048
 v_mfma_f32_16x16x32_bf16 v[80:83], a[112:115], v[196:199], v[80:83]
 buffer_load_dwordx4 v10, s[8:11], s30 offen offset:0 lds
 v_mfma_f32_16x16x32_bf16 v[84:87], a[116:119], v[196:199], v[84:87]
 s_waitcnt lgkmcnt(2)
 v_mfma_f32_16x16x32_bf16 v[88:91], a[108:111], v[200:203], v[88:91]
 ds_read_b128 v[168:171], v18 offset:4096
 v_mfma_f32_16x16x32_bf16 v[92:95], a[112:115], v[200:203], v[92:95]
 s_cmp_lt_u32 s33, 155648
 s_cselect_b32 s33, s33, 98304
 v_mfma_f32_16x16x32_bf16 v[96:99], a[116:119], v[200:203], v[96:99]
 v_mfma_f32_16x16x32_bf16 v[100:103], a[108:111], v[204:207], v[100:103]
 ds_read_b128 v[172:175], v18 offset:6144
 v_mfma_f32_16x16x32_bf16 v[104:107], a[112:115], v[204:207], v[104:107]
 v_mfma_f32_16x16x32_bf16 v[108:111], a[116:119], v[204:207], v[108:111]
 s_waitcnt lgkmcnt(2)
 v_mfma_f32_16x16x32_bf16 v[64:67], a[120:123], v[160:163], v[64:67]
 ds_read_b128 v[192:195], v19 offset:0
 v_mfma_f32_16x16x32_bf16 v[68:71], a[124:127], v[160:163], v[68:71]
 v_add_u32 v18, s33, v14
 v_mfma_f32_16x16x32_bf16 v[72:75], a[128:131], v[160:163], v[72:75]
 v_mfma_f32_16x16x32_bf16 v[76:79], a[120:123], v[164:167], v[76:79]
 ds_read_b128 v[196:199], v19 offset:2048
 v_mfma_f32_16x16x32_bf16 v[80:83], a[124:127], v[164:167], v[80:83]
 buffer_load_dwordx4 v11, s[8:11], s30 offen offset:1024 lds
 v_mfma_f32_16x16x32_bf16 v[84:87], a[128:131], v[164:167], v[84:87]
 s_waitcnt lgkmcnt(2)
 s_add_u32 s30, s30, 128
 v_mfma_f32_16x16x32_bf16 v[88:91], a[120:123], v[168:171], v[88:91]
 ds_read_b128 v[200:203], v19 offset:4096
 s_add_u32 m0, m0, 8192
 v_mfma_f32_16x16x32_bf16 v[92:95], a[124:127], v[168:171], v[92:95]
 s_cmp_lt_u32 m0, s46
 s_cselect_b32 m0, m0, s47
 v_mfma_f32_16x16x32_bf16 v[96:99], a[128:131], v[168:171], v[96:99]
 v_mfma_f32_16x16x32_bf16 v[100:103], a[120:123], v[172:175], v[100:103]
 ds_read_b128 v[204:207], v19 offset:6144
 v_mfma_f32_16x16x32_bf16 v[104:107], a[124:127], v[172:175], v[104:107]
 v_mfma_f32_16x16x32_bf16 v[108:111], a[128:131], v[172:175], v[108:111]
 s_waitcnt vmcnt(8) lgkmcnt(2)
 s_barrier
 v_mfma_f32_16x16x32_bf16 v[64:67], a[132:135], v[192:195], v[64:67]
 ds_read_b128 v[160:163], v18 offset:0
 v_mfma_f32_16x16x32_bf16 v[68:71], a[136:139], v[192:195], v[68:71]
 v_mfma_f32_16x16x32_bf16 v[72:75], a[140:143], v[192:195], v[72:75]
 v_add_u32 v19, s33, v15
 s_add_u32 s33, s33, 8192
 v_mfma_f32_16x16x32_bf16 v[76:79], a[132:135], v[196:199], v[76:79]
 ds_read_b128 v[164:167], v18 offset:2048
 v_mfma_f32_16x16x32_bf16 v[80:83], a[136:139], v[196:199], v[80:83]
 buffer_load_dwordx4 v10, s[8:11], s30 offen offset:0 lds
 v_mfma_f32_16x16x32_bf16 v[84:87], a[140:143], v[196:199], v[84:87]
 s_waitcnt lgkmcnt(2)
 v_mfma_f32_16x16x32_bf16 v[88:91], a[132:135], v[200:203], v[88:91]
 ds_read_b128 v[168:171], v18 offset:4096
 v_mfma_f32_16x16x32_bf16 v[92:95], a[136:139], v[200:203], v[92:95]
 s_cmp_lt_u32 s33, 155648
 s_cselect_b32 s33, s33, 98304
 v_mfma_f32_16x16x32_bf16 v[96:99], a[140:143], v[200:203], v[96:99]
 v_mfma_f32_16x16x32_bf16 v[100:103], a[132:135], v[204:207], v[100:103]
 ds_read_b128 v[172:175], v18 offset:6144
 v_mfma_f32_16x16x32_bf16 v[104:107], a[136:139], v[204:207], v[104:107]
 v_mfma_f32_16x16x32_bf16 v[108:111], a[140:143], v[204:207], v[108:111]
 s_waitcnt lgkmcnt(2)
 v_mfma_f32_16x16x32_bf16 v[64:67], a[144:147], v[160:163], v[64:67]
 ds_read_b128 v[192:195], v19 offset:0
 v_mfma_f32_16x16x32_bf16 v[68:71], a[148:151], v[160:163], v[68:71]
 v_add_u32 v18, s33, v14
 v_mfma_f32_16x16x32_bf16 v[72:75], a[152:155], v[160:163], v[72:75]
 v_mfma_f32_16x16x32_bf16 v[76:79], a[144:147], v[164:167], v[76:79]
 ds_read_b128 v[196:199], v19 offset:2048
 v_mfma_f32_16x16x32_bf16 v[80:83], a[148:151], v[164:167], v[80:83]
 buffer_load_dwordx4 v11, s[8:11], s30 offen offset:1024 lds
 v_mfma_f32_16x16x32_bf16 v[84:87], a[152:155], v[164:167], v[84:87]
 s_waitcnt lgkmcnt(2)
 s_add_u32 s30, s30, 128
 v_mfma_f32_16x16x32_bf16 v[88:91], a[144:147], v[168:171], v[88:91]
 ds_read_b128 v[200:203], v19 offset:4096
 s_add_u32 m0, m0, 8192
 v_mfma_f32_16x16x32_bf16 v[92:95], a[148:151], v[168:171], v[92:95]
 s_cmp_lt_u32 m0, s46
 s_cselect_b32 m0, m0, s47
 v_mfma_f32_16x16x32_bf16 v[96:99], a[152:155], v[168:171], v[96:99]
 v_mfma_f32_16x16x32_bf16 v[100:103], a[144:147], v[172:175], v[100:103]
 ds_read_b128 v[204:207], v19 offset:6144
 v_mfma_f32_16x16x32_bf16 v[104:107], a[148:151], v[172:175], v[104:107]
 v_mfma_f32_16x16x32_bf16 v[108:111], a[152:155], v[172:175], v[108:111]
 s_waitcnt vmcnt(8) lgkmcnt(2)
 s_barrier
 v_mfma_f32_16x16x32_bf16 v[64:67], a[156:159], v[192:195], v[64:67]
 ds_read_b128 v[160:163], v18 offset:0
 v_mfma_f32_16x16x32_bf16 v[68:71], a[160:163], v[192:195], v[68:71]
 v_mfma_f32_16x16x32_bf16 v[72:75], a[164:167], v[192:195], v[72:75]
 v_add_u32 v19, s33, v15
 s_add_u32 s33, s33, 8192
 v_mfma_f32_16x16x32_bf16 v[76:79], a[156:159], v[196:199], v[76:79]
 ds_read_b128 v[164:167], v18 offset:2048
 v_mfma_f32_16x16x32_bf16 v[80:83], a[160:163], v[196:199], v[80:83]
 buffer_load_dwordx4 v10, s[8:11], s30 offen offset:0 lds
 v_mfma_f32_16x16x32_bf16 v[84:87], a[164:167], v[196:199], v[84:87]
 s_waitcnt lgkmcnt(2)
 v_mfma_f32_16x16x32_bf16 v[88:91], a[156:159], v[200:203], v[88:91]
 ds_read_b128 v[168:171], v18 offset:4096
 v_mfma_f32_16x16x32_bf16 v[92:95], a[160:163], v[200:203], v[92:95]
 s_cmp_lt_u32 s33, 155648
 s_cselect_b32 s33, s33, 98304
 v_mfma_f32_16x16x32_bf16 v[96:99], a[164:167], v[200:203], v[96:99]
 v_mfma_f32_16x16x32_bf16 v[100:103], a[156:159], v[204:207], v[100:103]
 ds_read_b128 v[172:175], v18 offset:6144
 v_mfma_f32_16x16x32_bf16 v[104:107], a[160:163], v[204:207], v[104:107]
 v_mfma_f32_16x16x32_bf16 v[108:111], a[164:167], v[204:207], v[108:111]
 s_waitcnt lgkmcnt(2)
 v_mfma_f32_16x16x32_bf16 v[64:67], a[168:171], v[160:163], v[64:67]
 ds_read_b128 v[192:195], v19 offset:0
 v_mfma_f32_16x16x32_bf16 v[68:71], a[172:175], v[160:163], v[68:71]
 v_add_u32 v18, s33, v14
 v_mfma_f32_16x16x32_bf16 v[72:75], a[176:179], v[160:163], v[72:75]
 v_mfma_f32_16x16x32_bf16 v[76:79], a[168:171], v[164:167], v[76:79]
 ds_read_b128 v[196:199], v19 offset:2048
 v_mfma_f32_16x16x32_bf16 v[80:83], a[172:175], v[164:167], v[80:83]
 buffer_load_dwordx4 v11, s[8:11], s30 offen offset:1024 lds
 v_mfma_f32_16x16x32_bf16 v[84:87], a[176:179], v[164:167], v[84:87]
 s_waitcnt lgkmcnt(2)
 s_add_u32 s30, s30, 128
 v_mfma_f32_16x16x32_bf16 v[88:91], a[168:171], v[168:171], v[88:91]
 ds_read_b128 v[200:203], v19 offset:4096
 s_add_u32 m0, m0, 8192
 v_mfma_f32_16x16x32_bf16 v[92:95], a[172:175], v[168:171], v[92:95]
 s_cmp_lt_u32 m0, s46
 s_cselect_b32 m0, m0, s47
 v_mfma_f32_16x16x32_bf16 v[96:99], a[176:179], v[168:171], v[96:99]
 v_mfma_f32_16x16x32_bf16 v[100:103], a[168:171], v[172:175], v[100:103]
 ds_read_b128 v[204:207], v19 offset:6144
 v_mfma_f32_16x16x32_bf16 v[104:107], a[172:175], v[172:175], v[104:107]
 v_mfma_f32_16x16x32_bf16 v[108:111], a[176:179], v[172:175], v[108:111]
 s_waitcnt vmcnt(8) lgkmcnt(2)
 s_barrier
 v_mfma_f32_16x16x32_bf16 v[64:67], a[180:183], v[192:195], v[64:67]
 ds_read_b128 v[160:163], v18 offset:0
 v_mfma_f32_16x16x32_bf16 v[68:71], a[184:187], v[192:195], v[68:71]
 v_mfma_f32_16x16x32_bf16 v[72:75], a[188:191], v[192:195], v[72:75]
 v_add_u32 v19, s33, v15
 s_add_u32 s33, s33, 8192
 v_mfma_f32_16x16x32_bf16 v[76:79], a[180:183], v[196:199], v[76:79]
 ds_read_b128 v[164:167], v18 offset:2048
 v_mfma_f32_16x16x32_bf16 v[80:83], a[184:187], v[196:199], v[80:83]
 buffer_load_dwordx4 v10, s[8:11], s30 offen offset:0 lds
 v_mfma_f32_16x16x32_bf16 v[84:87], a[188:191], v[196:199], v[84:87]
 s_waitcnt lgkmcnt(2)
 v_mfma_f32_16x16x32_bf16 v[88:91], a[180:183], v[200:203], v[88:91]
 ds_read_b128 v[168:171], v18 offset:4096
 v_mfma_f32_16x16x32_bf16 v[92:95], a[184:187], v[200:203], v[92:95]
 s_cmp_lt_u32 s33, 155648
 s_cselect_b32 s33, s33, 98304
 v_mfma_f32_16x16x32_bf16 v[96:99], a[188:191], v[200:203], v[96:99]
 v_mfma_f32_16x16x32_bf16 v[100:103], a[180:183], v[204:207], v[100:103]
 ds_read_b128 v[172:175], v18 offset:6144
 v_mfma_f32_16x16x32_bf16 v[104:107], a[184:187], v[204:207], v[104:107]
 v_mfma_f32_16x16x32_bf16 v[108:111], a[188:191], v[204:207], v[108:111]
 s_waitcnt lgkmcnt(2)
 v_mfma_f32_16x16x32_bf16 v[64:67], a[192:195], v[160:163], v[64:67]
 ds_read_b128 v[192:195], v19 offset:0
 v_mfma_f32_16x16x32_bf16 v[68:71], a[196:199], v[160:163], v[68:71]
 v_add_u32 v18, s33, v14
 v_mfma_f32_16x16x32_bf16 v[72:75], a[200:203], v[160:163], v[72:75]
 v_mfma_f32_16x16x32_bf16 v[76:79], a[192:195], v[164:167], v[76:79]
 ds_read_b128 v[196:199], v19 offset:2048
 v_mfma_f32_16x16x32_bf16 v[80:83], a[196:199], v[164:167], v[80:83]
 buffer_load_dwordx4 v11, s[8:11], s30 offen offset:1024 lds
 v_mfma_f32_16x16x32_bf16 v[84:87], a[200:203], v[164:167], v[84:87]
 s_waitcnt lgkmcnt(2)
 s_add_u32 s30, s30, 128
 v_mfma_f32_16x16x32_bf16 v[88:91], a[192:195], v[168:171], v[88:91]
 ds_read_b128 v[200:203], v19 offset:4096
 s_add_u32 m0, m0, 8192
 v_mfma_f32_16x16x32_bf16 v[92:95], a[196:199], v[168:171], v[92:95]
 s_cmp_lt_u32 m0, s46
 s_cselect_b32 m0, m0, s47
 v_mfma_f32_16x16x32_bf16 v[96:99], a[200:203], v[168:171], v[96:99]
 v_mfma_f32_16x16x32_bf16 v[100:103], a[192:195], v[172:175], v[100:103]
 ds_read_b128 v[204:207], v19 offset:6144
 v_mfma_f32_16x16x32_bf16 v[104:107], a[196:199], v[172:175], v[104:107]
 v_mfma_f32_16x16x32_bf16 v[108:111], a[200:203], v[172:175], v[108:111]
 s_waitcnt vmcnt(8) lgkmcnt(2)
 s_barrier
 v_mfma_f32_16x16x32_bf16 v[64:67], a[204:207], v[192:195], v[64:67]
 ds_read_b128 v[160:163], v18 offset:0
 v_mfma_f32_16x16x32_bf16 v[68:71], a[208:211], v[192:195], v[68:71]
 v_mfma_f32_16x16x32_bf16 v[72:75], a[212:215], v[192:195], v[72:75]
 v_add_u32 v19, s33, v15
 s_add_u32 s33, s33, 8192
 v_mfma_f32_16x16x32_bf16 v[76:79], a[204:207], v[196:199], v[76:79]
 ds_read_b128 v[164:167], v18 offset:2048
 v_mfma_f32_16x16x32_bf16 v[80:83], a[208:211], v[196:199], v[80:83]
 buffer_load_dwordx4 v10, s[8:11], s30 offen offset:0 lds
 v_mfma_f32_16x16x32_bf16 v[84:87], a[212:215], v[196:199], v[84:87]
 s_waitcnt lgkmcnt(2)
 v_mfma_f32_16x16x32_bf16 v[88:91], a[204:207], v[200:203], v[88:91]
 ds_read_b128 v[168:171], v18 offset:4096
 v_mfma_f32_16x16x32_bf16 v[92:95], a[208:211], v[200:203], v[92:95]
 s_cmp_lt_u32 s33, 155648
 s_cselect_b32 s33, s33, 98304
 v_mfma_f32_16x16x32_bf16 v[96:99], a[212:215], v[200:203], v[96:99]
 v_mfma_f32_16x16x32_bf16 v[100:103], a[204:207], v[204:207], v[100:103]
 ds_read_b128 v[172:175], v18 offset:6144
 v_mfma_f32_16x16x32_bf16 v[104:107], a[208:211], v[204:207], v[104:107]
 v_mfma_f32_16x16x32_bf16 v[108:111], a[212:215], v[204:207], v[108:111]
 s_waitcnt lgkmcnt(2)
 v_mfma_f32_16x16x32_bf16 v[64:67], a[216:219], v[160:163], v[64:67]
 ds_read_b128 v[192:195], v19 offset:0
 v_mfma_f32_16x16x32_bf16 v[68:71], a[220:223], v[160:163], v[68:71]
 v_add_u32 v18, s33, v14
 v_mfma_f32_16x16x32_bf16 v[72:75], a[224:227], v[160:163], v[72:75]
 v_mfma_f32_16x16x32_bf16 v[76:79], a[216:219], v[164:167], v[76:79]
 ds_read_b128 v[196:199], v19 offset:2048
 v_mfma_f32_16x16x32_bf16 v[80:83], a[220:223], v[164:167], v[80:83]
 buffer_load_dwordx4 v11, s[8:11], s30 offen offset:1024 lds
 v_mfma_f32_16x16x32_bf16 v[84:87], a[224:227], v[164:167], v[84:87]
 s_waitcnt lgkmcnt(2)
 s_add_u32 s30, s30, 128
 v_mfma_f32_16x16x32_bf16 v[88:91], a[216:219], v[168:171], v[88:91]
 ds_read_b128 v[200:203], v19 offset:4096
 s_add_u32 m0, m0, 8192
 v_mfma_f32_16x16x32_bf16 v[92:95], a[220:223], v[168:171], v[92:95]
 s_cmp_lt_u32 m0, s46
 s_cselect_b32 m0, m0, s47
 v_mfma_f32_16x16x32_bf16 v[96:99], a[224:227], v[168:171], v[96:99]
 v_mfma_f32_16x16x32_bf16 v[100:103], a[216:219], v[172:175], v[100:103]
 ds_read_b128 v[204:207], v19 offset:6144
 v_mfma_f32_16x16x32_bf16 v[104:107], a[220:223], v[172:175], v[104:107]
 v_mfma_f32_16x16x32_bf16 v[108:111], a[224:227], v[172:175], v[108:111]
 s_waitcnt vmcnt(8) lgkmcnt(2)
 s_barrier
 v_mfma_f32_16x16x32_bf16 v[64:67], a[228:231], v[192:195], v[64:67]
 ds_read_b128 v[160:163], v18 offset:0
 v_mfma_f32_16x16x32_bf16 v[68:71], a[232:235], v[192:195], v[68:71]
 v_mfma_f32_16x16x32_bf16 v[72:75], a[236:239], v[192:195], v[72:75]
 v_add_u32 v19, s33, v15
 s_add_u32 s33, s33, 8192
 v_mfma_f32_16x16x32_bf16 v[76:79], a[228:231], v[196:199], v[76:79]
 ds_read_b128 v[164:167], v18 offset:2048
 v_cvt_pk_bf16_f32 v224, v64, v65
 v_cvt_pk_bf16_f32 v225, v66, v67
 v_mfma_f32_16x16x32_bf16 v[80:83], a[232:235], v[196:199], v[80:83]
 buffer_load_dwordx4 v10, s[8:11], s30 offen offset:0 lds
 v_cvt_pk_bf16_f32 v226, v68, v69
 v_cvt_pk_bf16_f32 v227, v70, v71
 v_mfma_f32_16x16x32_bf16 v[84:87], a[236:239], v[196:199], v[84:87]
 s_waitcnt lgkmcnt(2)
 v_cvt_pk_bf16_f32 v228, v72, v73
 v_cvt_pk_bf16_f32 v229, v74, v75
 v_mfma_f32_16x16x32_bf16 v[88:91], a[228:231], v[200:203], v[88:91]
 ds_read_b128 v[168:171], v18 offset:4096
 ds_write_b64 v22, v[224:225] offset:0
 v_mfma_f32_16x16x32_bf16 v[92:95], a[232:235], v[200:203], v[92:95]
 s_cmp_lt_u32 s33, 155648
 s_cselect_b32 s33, s33, 98304
 ds_write_b64 v22, v[226:227] offset:8
 v_mfma_f32_16x16x32_bf16 v[96:99], a[236:239], v[200:203], v[96:99]
 ds_write_b64 v16, v[228:229] offset:64
 v_cvt_pk_bf16_f32 v230, v76, v77
 v_cvt_pk_bf16_f32 v231, v78, v79
 v_mfma_f32_16x16x32_bf16 v[100:103], a[228:231], v[204:207], v[100:103]
 ds_read_b128 v[172:175], v18 offset:6144
 v_cvt_pk_bf16_f32 v232, v80, v81
 v_cvt_pk_bf16_f32 v233, v82, v83
 v_cvt_pk_bf16_f32 v234, v84, v85
 v_mfma_f32_16x16x32_bf16 v[104:107], a[232:235], v[204:207], v[104:107]
 v_cvt_pk_bf16_f32 v235, v86, v87
 ds_write_b64 v22, v[230:231] offset:6400
 v_mfma_f32_16x16x32_bf16 v[108:111], a[236:239], v[204:207], v[108:111]
 ds_write_b64 v22, v[232:233] offset:6408
 ds_write_b64 v16, v[234:235] offset:6464
kvm_end_127:
 v_cvt_pk_bf16_f32 v236, v88, v89
 v_cvt_pk_bf16_f32 v237, v90, v91
 v_cvt_pk_bf16_f32 v238, v92, v93
 v_cvt_pk_bf16_f32 v239, v94, v95
 v_cvt_pk_bf16_f32 v240, v96, v97
 v_cvt_pk_bf16_f32 v241, v98, v99
 ds_write_b64 v22, v[236:237] offset:12800
 ds_write_b64 v22, v[238:239] offset:12808
 ds_write_b64 v16, v[240:241] offset:12864
 v_cvt_pk_bf16_f32 v242, v100, v101
 v_cvt_pk_bf16_f32 v243, v102, v103
 v_cvt_pk_bf16_f32 v244, v104, v105
 v_cvt_pk_bf16_f32 v245, v106, v107
 v_cvt_pk_bf16_f32 v246, v108, v109
 v_cvt_pk_bf16_f32 v247, v110, v111
 ds_write_b64 v22, v[242:243] offset:19200
 ds_write_b64 v22, v[244:245] offset:19208
 ds_write_b64 v16, v[246:247] offset:19264
 s_waitcnt lgkmcnt(0)
 s_barrier
 ds_read_b128 v[224:227], v23 offset:0
 ds_read_b128 v[228:231], v23 offset:64
 ds_read_b128 v[232:235], v23 offset:128
 ds_read_b128 v[236:239], v23 offset:192
 ds_read_b128 v[240:243], v23 offset:256
 ds_read_b128 v[244:247], v23 offset:320
 s_waitcnt lgkmcnt(0)
 s_add_u32 s21, s48, 0
 buffer_store_dwordx4 v[224:227], v26, s[16:19], s21 offen offset:0 sc1
 buffer_store_dwordx4 v[228:231], v26, s[16:19], s21 offen offset:1024 sc1
 buffer_store_dwordx4 v[232:235], v26, s[16:19], s21 offen offset:2048 sc1
 buffer_store_dwordx4 v[236:239], v26, s[16:19], s21 offen offset:3072 sc1
 s_add_u32 s21, s48, 4096
 buffer_store_dwordx4 v[240:243], v26, s[16:19], s21 offen offset:0 sc1
 buffer_store_dwordx4 v[244:247], v26, s[16:19], s21 offen offset:1024 sc1
 s_nop 1
 s_cmp_gt_u32 s26, 0
 s_cbranch_scc1 kvm_blk_126
 s_waitcnt vmcnt(6)
 s_barrier
 v_and_b32 v30, 31, v1
 buffer_load_ubyte v29, v30, s[64:67], 0 offen offset:160 sc1
 s_mov_b32 s24, 491520
 s_mov_b32 s25, 163840
 v_lshrrev_b32 v11, 3, v1
 v_and_b32 v12, 7, v1
 v_xor_b32 v12, v12, v11
 v_mul_u32_u24 v11, 1280, v11
 v_lshl_add_u32 v10, v12, 4, v11
 s_mul_i32 s46, s20, 40960
 v_add_u32 v10, s46, v10
 s_lshl_b32 s47, s20, 12
 s_add_u32 s47, s47, 0
 s_add_u32 s46, s47, 98304
 s_mov_b32 s30, s24
 s_add_u32 s32, s47, 32768
 v_add_u32 v11, 9216, v10
 v_add_u32 v12, 18432, v10
 v_add_u32 v13, 27648, v10
 s_mov_b32 m0, s32
 s_nop 0
 buffer_load_dwordx4 v10, s[8:11], s30 offen offset:0 lds
 buffer_load_dwordx4 v11, s[8:11], s30 offen offset:1024 lds
 buffer_load_dwordx4 v12, s[8:11], s30 offen offset:2048 lds
 buffer_load_dwordx4 v13, s[8:11], s30 offen offset:3072 lds
 s_add_u32 s30, s30, 128
 s_add_u32 s32, s32, 16384
 s_cmp_lt_u32 s32, s46
 s_cselect_b32 s32, s32, s47
 s_mov_b32 m0, s32
 s_nop 0
 buffer_load_dwordx4 v10, s[8:11], s30 offen offset:0 lds
 buffer_load_dwordx4 v11, s[8:11], s30 offen offset:1024 lds
 buffer_load_dwordx4 v12, s[8:11], s30 offen offset:2048 lds
 buffer_load_dwordx4 v13, s[8:11], s30 offen offset:3072 lds
 s_add_u32 s30, s30, 128
 s_add_u32 s32, s32, 16384
 s_cmp_lt_u32 s32, s46
 s_cselect_b32 s32, s32, s47
 s_mov_b32 m0, s32
 s_nop 0
 buffer_load_dwordx4 v10, s[8:11], s30 offen offset:0 lds
 buffer_load_dwordx4 v11, s[8:11], s30 offen offset:1024 lds
 buffer_load_dwordx4 v12, s[8:11], s30 offen offset:2048 lds
 buffer_load_dwordx4 v13, s[8:11], s30 offen offset:3072 lds
 s_add_u32 s30, s30, 128
 s_add_u32 s32, s32, 16384
 s_cmp_lt_u32 s32, s46
 s_cselect_b32 s32, s32, s47
 s_mov_b32 m0, s32
 s_nop 0
 buffer_load_dwordx4 v10, s[8:11], s30 offen offset:0 lds
 buffer_load_dwordx4 v11, s[8:11], s30 offen offset:1024 lds
 buffer_load_dwordx4 v12, s[8:11], s30 offen offset:2048 lds
 buffer_load_dwordx4 v13, s[8:11], s30 offen offset:3072 lds
 s_add_u32 s30, s30, 128
 s_add_u32 s32, s32, 16384
 s_cmp_lt_u32 s32, s46
 s_cselect_b32 s32, s32, s47
 s_waitcnt vmcnt(16)
 s_barrier
 s_cmp_lg_u32 s20, 0
 s_cbranch_scc1 af_131
 v_mov_b32 v4, 0
 v_mov_b32 v5, 1
 s_mov_b64 exec, 1
 buffer_atomic_add v5, v4, s[72:75], s61 offen sc1
 s_mov_b64 exec, -1
 s_nop 1
af_131:
 s_mov_b32 s26, 13
 s_mov_b32 s28, 1572864
 s_mov_b32 s101, 0
c0_132:
 v_cmp_eq_u32 vcc, 0, v29
 s_nop 1
 s_cbranch_vccz c0_133
 s_sleep 8
 v_and_b32 v30, 31, v1
 buffer_load_ubyte v29, v30, s[64:67], 0 offen offset:160 sc1
 s_add_u32 s101, s101, 1
 s_cmp_gt_u32 s101, 131072
 s_cbranch_scc1 main_end
 s_waitcnt vmcnt(0)
 s_branch c0_132
c0_133:
 v_cmp_eq_u32 vcc, 2, v29
 s_nop 1
 s_mov_b32 s37, vcc_lo
kv_main:
 v_and_b32 v6, 7, v2
 v_add_u32 v4, 0, v3
 v_xor_b32 v4, v4, v6
 v_lshlrev_b32 v4, 4, v4
 v_lshl_add_u32 v14, v2, 7, v4
 v_add_u32 v4, 4, v3
 v_xor_b32 v4, v4, v6
 v_lshlrev_b32 v4, 4, v4
 v_lshl_add_u32 v15, v2, 7, v4
 v_mul_u32_u24 v22, 400, v2
 v_mul_u32_u24 v4, 16, v3
 s_mul_i32 s21, s20, 96
 s_add_u32 s21, s21, 98304
 v_add3_u32 v22, v22, v4, s21
 v_lshlrev_b32 v4, 3, v3
 v_sub_u32 v16, v22, v4
 v_mov_b32 v9, 2731
 s_mul_i32 s21, s20, 12800
 s_add_u32 s21, s21, 98304
 v_mul_u32_u24 v4, 400, v2
 v_lshlrev_b32 v5, 4, v3
 v_add3_u32 v23, v4, v5, s21
 v_lshlrev_b32 v26, 4, v1
 s_mov_b32 s33, 32768
 s_mov_b32 s48, 0x80000000
 s_mov_b32 m0, s32
 s_nop 0
 buffer_load_dwordx4 v10, s[8:11], s30 offen offset:0 lds
 buffer_load_dwordx4 v11, s[8:11], s30 offen offset:1024 lds
 s_waitcnt vmcnt(14)
 s_barrier
 v_add_u32 v18, s33, v14
 v_add_u32 v19, s33, v15
 s_add_u32 s33, s33, 16384
 s_cmp_lt_u32 s33, 98304
 s_cselect_b32 s33, s33, 0
 ds_read_b128 v[160:163], v18 offset:0
 ds_read_b128 v[164:167], v18 offset:2048
 ds_read_b128 v[168:171], v18 offset:4096
 ds_read_b128 v[172:175], v18 offset:6144
 ds_read_b128 v[176:179], v18 offset:8192
 ds_read_b128 v[180:183], v18 offset:10240
 ds_read_b128 v[184:187], v18 offset:12288
 ds_read_b128 v[188:191], v18 offset:14336
 s_waitcnt lgkmcnt(0)
kv_blk_136:
 v_mfma_f32_16x16x32_bf16 v[64:67], a[0:3], v[160:163], 0
 ds_read_b128 v[192:195], v19 offset:0
 v_mfma_f32_16x16x32_bf16 v[68:71], a[4:7], v[160:163], 0
 v_add_u32 v18, s33, v14
 v_mfma_f32_16x16x32_bf16 v[72:75], a[8:11], v[160:163], 0
 ds_write_b64 v16, v[234:235] offset:6464
 v_mfma_f32_16x16x32_bf16 v[76:79], a[0:3], v[164:167], 0
 ds_read_b128 v[196:199], v19 offset:2048
 v_cvt_pk_bf16_f32 v236, v88, v89
 v_mfma_f32_16x16x32_bf16 v[80:83], a[4:7], v[164:167], 0
 buffer_load_dwordx4 v12, s[8:11], s30 offen offset:2048 lds
 v_mfma_f32_16x16x32_bf16 v[84:87], a[8:11], v[164:167], 0
 v_cvt_pk_bf16_f32 v237, v90, v91
 v_cvt_pk_bf16_f32 v238, v92, v93
 v_mfma_f32_16x16x32_bf16 v[88:91], a[0:3], v[168:171], 0
 ds_read_b128 v[200:203], v19 offset:4096
 v_cvt_pk_bf16_f32 v239, v94, v95
 v_mfma_f32_16x16x32_bf16 v[92:95], a[4:7], v[168:171], 0
 v_cvt_pk_bf16_f32 v240, v96, v97
 v_cvt_pk_bf16_f32 v241, v98, v99
 v_mfma_f32_16x16x32_bf16 v[96:99], a[8:11], v[168:171], 0
 ds_write_b64 v22, v[236:237] offset:12800
 ds_write_b64 v22, v[238:239] offset:12808
 ds_write_b64 v16, v[240:241] offset:12864
 v_cvt_pk_bf16_f32 v242, v100, v101
 v_cvt_pk_bf16_f32 v243, v102, v103
 v_mfma_f32_16x16x32_bf16 v[100:103], a[0:3], v[172:175], 0
 ds_read_b128 v[204:207], v19 offset:6144
 v_cvt_pk_bf16_f32 v244, v104, v105
 v_cvt_pk_bf16_f32 v245, v106, v107
 v_mfma_f32_16x16x32_bf16 v[104:107], a[4:7], v[172:175], 0
 v_cvt_pk_bf16_f32 v246, v108, v109
 v_cvt_pk_bf16_f32 v247, v110, v111
 v_mfma_f32_16x16x32_bf16 v[108:111], a[8:11], v[172:175], 0
 s_waitcnt lgkmcnt(9)
 ds_write_b64 v22, v[242:243] offset:19200
 ds_write_b64 v22, v[244:245] offset:19208
 ds_write_b64 v16, v[246:247] offset:19264
 v_cvt_pk_bf16_f32 v224, v112, v113
 v_cvt_pk_bf16_f32 v225, v114, v115
 v_mfma_f32_16x16x32_bf16 v[112:115], a[0:3], v[176:179], 0
 ds_read_b128 v[208:211], v19 offset:8192
 v_cvt_pk_bf16_f32 v226, v116, v117
 v_cvt_pk_bf16_f32 v227, v118, v119
 v_mfma_f32_16x16x32_bf16 v[116:119], a[4:7], v[176:179], 0
 v_cvt_pk_bf16_f32 v228, v120, v121
 v_cvt_pk_bf16_f32 v229, v122, v123
 v_mfma_f32_16x16x32_bf16 v[120:123], a[8:11], v[176:179], 0
 ds_write_b64 v22, v[224:225] offset:25600
 ds_write_b64 v22, v[226:227] offset:25608
 ds_write_b64 v16, v[228:229] offset:25664
 v_cvt_pk_bf16_f32 v230, v124, v125
 v_cvt_pk_bf16_f32 v231, v126, v127
 v_mfma_f32_16x16x32_bf16 v[124:127], a[0:3], v[180:183], 0
 ds_read_b128 v[212:215], v19 offset:10240
 v_cvt_pk_bf16_f32 v232, v128, v129
 v_cvt_pk_bf16_f32 v233, v130, v131
 v_mfma_f32_16x16x32_bf16 v[128:131], a[4:7], v[180:183], 0
 buffer_load_dwordx4 v13, s[8:11], s30 offen offset:3072 lds
 v_cvt_pk_bf16_f32 v234, v132, v133
 v_cvt_pk_bf16_f32 v235, v134, v135
 v_mfma_f32_16x16x32_bf16 v[132:135], a[8:11], v[180:183], 0
 s_add_u32 s30, s30, 128
 s_add_u32 m0, m0, 16384
 ds_write_b64 v22, v[230:231] offset:32000
 ds_write_b64 v22, v[232:233] offset:32008
 ds_write_b64 v16, v[234:235] offset:32064
 v_cvt_pk_bf16_f32 v236, v136, v137
 v_cvt_pk_bf16_f32 v237, v138, v139
 v_mfma_f32_16x16x32_bf16 v[136:139], a[0:3], v[184:187], 0
 ds_read_b128 v[216:219], v19 offset:12288
 v_cvt_pk_bf16_f32 v238, v140, v141
 v_cvt_pk_bf16_f32 v239, v142, v143
 v_mfma_f32_16x16x32_bf16 v[140:143], a[4:7], v[184:187], 0
 s_cmp_lt_u32 m0, s46
 s_cselect_b32 m0, m0, s47
 v_cvt_pk_bf16_f32 v240, v144, v145
 v_cvt_pk_bf16_f32 v241, v146, v147
 v_mfma_f32_16x16x32_bf16 v[144:147], a[8:11], v[184:187], 0
 ds_write_b64 v22, v[236:237] offset:38400
 ds_write_b64 v22, v[238:239] offset:38408
 ds_write_b64 v16, v[240:241] offset:38464
 v_cvt_pk_bf16_f32 v242, v148, v149
 v_cvt_pk_bf16_f32 v243, v150, v151
 v_mfma_f32_16x16x32_bf16 v[148:151], a[0:3], v[188:191], 0
 ds_read_b128 v[220:223], v19 offset:14336
 v_cvt_pk_bf16_f32 v244, v152, v153
 v_cvt_pk_bf16_f32 v245, v154, v155
 v_mfma_f32_16x16x32_bf16 v[152:155], a[4:7], v[188:191], 0
 v_cvt_pk_bf16_f32 v246, v156, v157
 v_cvt_pk_bf16_f32 v247, v158, v159
 v_mfma_f32_16x16x32_bf16 v[156:159], a[8:11], v[188:191], 0
 s_waitcnt vmcnt(12) lgkmcnt(15)
 s_barrier
 v_mfma_f32_16x16x32_bf16 v[64:67], a[12:15], v[192:195], v[64:67]
 ds_read_b128 v[160:163], v18 offset:0
 v_mfma_f32_16x16x32_bf16 v[68:71], a[16:19], v[192:195], v[68:71]
 ds_write_b64 v22, v[242:243] offset:44800
 v_mfma_f32_16x16x32_bf16 v[72:75], a[20:23], v[192:195], v[72:75]
 v_add_u32 v19, s33, v15
 s_add_u32 s33, s33, 16384
 v_mfma_f32_16x16x32_bf16 v[76:79], a[12:15], v[196:199], v[76:79]
 ds_read_b128 v[164:167], v18 offset:2048
 v_mfma_f32_16x16x32_bf16 v[80:83], a[16:19], v[196:199], v[80:83]
 buffer_load_dwordx4 v10, s[8:11], s30 offen offset:0 lds
 v_mfma_f32_16x16x32_bf16 v[84:87], a[20:23], v[196:199], v[84:87]
 s_cmp_lt_u32 s33, 98304
 s_cselect_b32 s33, s33, 0
 v_mfma_f32_16x16x32_bf16 v[88:91], a[12:15], v[200:203], v[88:91]
 ds_read_b128 v[168:171], v18 offset:4096
 v_mfma_f32_16x16x32_bf16 v[92:95], a[16:19], v[200:203], v[92:95]
 ds_write_b64 v22, v[244:245] offset:44808
 v_mfma_f32_16x16x32_bf16 v[96:99], a[20:23], v[200:203], v[96:99]
 ds_write_b64 v16, v[246:247] offset:44864
 v_mfma_f32_16x16x32_bf16 v[100:103], a[12:15], v[204:207], v[100:103]
 ds_read_b128 v[172:175], v18 offset:6144
 v_mfma_f32_16x16x32_bf16 v[104:107], a[16:19], v[204:207], v[104:107]
 v_mfma_f32_16x16x32_bf16 v[108:111], a[20:23], v[204:207], v[108:111]
 s_waitcnt lgkmcnt(7)
 v_mfma_f32_16x16x32_bf16 v[112:115], a[12:15], v[208:211], v[112:115]
 ds_read_b128 v[176:179], v18 offset:8192
 v_mfma_f32_16x16x32_bf16 v[116:119], a[16:19], v[208:211], v[116:119]
 v_mfma_f32_16x16x32_bf16 v[120:123], a[20:23], v[208:211], v[120:123]
 v_mfma_f32_16x16x32_bf16 v[124:127], a[12:15], v[212:215], v[124:127]
 ds_read_b128 v[180:183], v18 offset:10240
 v_mfma_f32_16x16x32_bf16 v[128:131], a[16:19], v[212:215], v[128:131]
 buffer_load_dwordx4 v11, s[8:11], s30 offen offset:1024 lds
 v_mfma_f32_16x16x32_bf16 v[132:135], a[20:23], v[212:215], v[132:135]
 v_mfma_f32_16x16x32_bf16 v[136:139], a[12:15], v[216:219], v[136:139]
 ds_read_b128 v[184:187], v18 offset:12288
 v_mfma_f32_16x16x32_bf16 v[140:143], a[16:19], v[216:219], v[140:143]
 v_mfma_f32_16x16x32_bf16 v[144:147], a[20:23], v[216:219], v[144:147]
 v_mfma_f32_16x16x32_bf16 v[148:151], a[12:15], v[220:223], v[148:151]
 ds_read_b128 v[188:191], v18 offset:14336
 v_mfma_f32_16x16x32_bf16 v[152:155], a[16:19], v[220:223], v[152:155]
 v_mfma_f32_16x16x32_bf16 v[156:159], a[20:23], v[220:223], v[156:159]
 s_waitcnt lgkmcnt(4)
 v_mfma_f32_16x16x32_bf16 v[64:67], a[24:27], v[160:163], v[64:67]
 ds_read_b128 v[192:195], v19 offset:0
 v_mfma_f32_16x16x32_bf16 v[68:71], a[28:31], v[160:163], v[68:71]
 v_add_u32 v18, s33, v14
 v_mfma_f32_16x16x32_bf16 v[72:75], a[32:35], v[160:163], v[72:75]
 v_mfma_f32_16x16x32_bf16 v[76:79], a[24:27], v[164:167], v[76:79]
 ds_read_b128 v[196:199], v19 offset:2048
 v_mfma_f32_16x16x32_bf16 v[80:83], a[28:31], v[164:167], v[80:83]
 buffer_load_dwordx4 v12, s[8:11], s30 offen offset:2048 lds
 v_mfma_f32_16x16x32_bf16 v[84:87], a[32:35], v[164:167], v[84:87]
 v_mfma_f32_16x16x32_bf16 v[88:91], a[24:27], v[168:171], v[88:91]
 ds_read_b128 v[200:203], v19 offset:4096
 v_mfma_f32_16x16x32_bf16 v[92:95], a[28:31], v[168:171], v[92:95]
 v_mfma_f32_16x16x32_bf16 v[96:99], a[32:35], v[168:171], v[96:99]
 v_mfma_f32_16x16x32_bf16 v[100:103], a[24:27], v[172:175], v[100:103]
 ds_read_b128 v[204:207], v19 offset:6144
 v_mfma_f32_16x16x32_bf16 v[104:107], a[28:31], v[172:175], v[104:107]
 v_mfma_f32_16x16x32_bf16 v[108:111], a[32:35], v[172:175], v[108:111]
 s_waitcnt lgkmcnt(4)
 v_mfma_f32_16x16x32_bf16 v[112:115], a[24:27], v[176:179], v[112:115]
 ds_read_b128 v[208:211], v19 offset:8192
 v_mfma_f32_16x16x32_bf16 v[116:119], a[28:31], v[176:179], v[116:119]
 v_mfma_f32_16x16x32_bf16 v[120:123], a[32:35], v[176:179], v[120:123]
 v_mfma_f32_16x16x32_bf16 v[124:127], a[24:27], v[180:183], v[124:127]
 ds_read_b128 v[212:215], v19 offset:10240
 v_mfma_f32_16x16x32_bf16 v[128:131], a[28:31], v[180:183], v[128:131]
 buffer_load_dwordx4 v13, s[8:11], s30 offen offset:3072 lds
 v_mfma_f32_16x16x32_bf16 v[132:135], a[32:35], v[180:183], v[132:135]
 s_add_u32 s30, s30, 128
 s_add_u32 m0, m0, 16384
 v_mfma_f32_16x16x32_bf16 v[136:139], a[24:27], v[184:187], v[136:139]
 ds_read_b128 v[216:219], v19 offset:12288
 v_mfma_f32_16x16x32_bf16 v[140:143], a[28:31], v[184:187], v[140:143]
 s_cmp_lt_u32 m0, s46
 s_cselect_b32 m0, m0, s47
 v_mfma_f32_16x16x32_bf16 v[144:147], a[32:35], v[184:187], v[144:147]
 v_mfma_f32_16x16x32_bf16 v[148:151], a[24:27], v[188:191], v[148:151]
 ds_read_b128 v[220:223], v19 offset:14336
 v_mfma_f32_16x16x32_bf16 v[152:155], a[28:31], v[188:191], v[152:155]
 v_mfma_f32_16x16x32_bf16 v[156:159], a[32:35], v[188:191], v[156:159]
 s_waitcnt vmcnt(12) lgkmcnt(4)
 s_barrier
 v_mfma_f32_16x16x32_bf16 v[64:67], a[36:39], v[192:195], v[64:67]
 ds_read_b128 v[160:163], v18 offset:0
 v_mfma_f32_16x16x32_bf16 v[68:71], a[40:43], v[192:195], v[68:71]
 v_mfma_f32_16x16x32_bf16 v[72:75], a[44:47], v[192:195], v[72:75]
 v_add_u32 v19, s33, v15
 s_add_u32 s33, s33, 16384
 v_mfma_f32_16x16x32_bf16 v[76:79], a[36:39], v[196:199], v[76:79]
 ds_read_b128 v[164:167], v18 offset:2048
 v_mfma_f32_16x16x32_bf16 v[80:83], a[40:43], v[196:199], v[80:83]
 buffer_load_dwordx4 v10, s[8:11], s30 offen offset:0 lds
 v_mfma_f32_16x16x32_bf16 v[84:87], a[44:47], v[196:199], v[84:87]
 s_cmp_lt_u32 s33, 98304
 s_cselect_b32 s33, s33, 0
 v_mfma_f32_16x16x32_bf16 v[88:91], a[36:39], v[200:203], v[88:91]
 ds_read_b128 v[168:171], v18 offset:4096
 v_mfma_f32_16x16x32_bf16 v[92:95], a[40:43], v[200:203], v[92:95]
 ds_read_b128 v[224:227], v23 offset:0
 v_mfma_f32_16x16x32_bf16 v[96:99], a[44:47], v[200:203], v[96:99]
 v_mfma_f32_16x16x32_bf16 v[100:103], a[36:39], v[204:207], v[100:103]
 ds_read_b128 v[172:175], v18 offset:6144
 v_mfma_f32_16x16x32_bf16 v[104:107], a[40:43], v[204:207], v[104:107]
 v_mfma_f32_16x16x32_bf16 v[108:111], a[44:47], v[204:207], v[108:111]
 s_waitcnt lgkmcnt(5)
 v_mfma_f32_16x16x32_bf16 v[112:115], a[36:39], v[208:211], v[112:115]
 ds_read_b128 v[176:179], v18 offset:8192
 v_mfma_f32_16x16x32_bf16 v[116:119], a[40:43], v[208:211], v[116:119]
 v_mfma_f32_16x16x32_bf16 v[120:123], a[44:47], v[208:211], v[120:123]
 v_mfma_f32_16x16x32_bf16 v[124:127], a[36:39], v[212:215], v[124:127]
 ds_read_b128 v[180:183], v18 offset:10240
 v_mfma_f32_16x16x32_bf16 v[128:131], a[40:43], v[212:215], v[128:131]
 buffer_load_dwordx4 v11, s[8:11], s30 offen offset:1024 lds
 v_mfma_f32_16x16x32_bf16 v[132:135], a[44:47], v[212:215], v[132:135]
 v_mfma_f32_16x16x32_bf16 v[136:139], a[36:39], v[216:219], v[136:139]
 ds_read_b128 v[184:187], v18 offset:12288
 v_mfma_f32_16x16x32_bf16 v[140:143], a[40:43], v[216:219], v[140:143]
 ds_read_b128 v[228:231], v23 offset:64
 v_mfma_f32_16x16x32_bf16 v[144:147], a[44:47], v[216:219], v[144:147]
 v_mfma_f32_16x16x32_bf16 v[148:151], a[36:39], v[220:223], v[148:151]
 ds_read_b128 v[188:191], v18 offset:14336
 v_mfma_f32_16x16x32_bf16 v[152:155], a[40:43], v[220:223], v[152:155]
 v_mfma_f32_16x16x32_bf16 v[156:159], a[44:47], v[220:223], v[156:159]
 s_waitcnt lgkmcnt(5)
 v_mfma_f32_16x16x32_bf16 v[64:67], a[48:51], v[160:163], v[64:67]
 ds_read_b128 v[192:195], v19 offset:0
 v_mfma_f32_16x16x32_bf16 v[68:71], a[52:55], v[160:163], v[68:71]
 v_add_u32 v18, s33, v14
 v_mfma_f32_16x16x32_bf16 v[72:75], a[56:59], v[160:163], v[72:75]
 v_mfma_f32_16x16x32_bf16 v[76:79], a[48:51], v[164:167], v[76:79]
 ds_read_b128 v[196:199], v19 offset:2048
 v_mfma_f32_16x16x32_bf16 v[80:83], a[52:55], v[164:167], v[80:83]
 buffer_load_dwordx4 v12, s[8:11], s30 offen offset:2048 lds
 v_mfma_f32_16x16x32_bf16 v[84:87], a[56:59], v[164:167], v[84:87]
 v_mfma_f32_16x16x32_bf16 v[88:91], a[48:51], v[168:171], v[88:91]
 ds_read_b128 v[200:203], v19 offset:4096
 v_mfma_f32_16x16x32_bf16 v[92:95], a[52:55], v[168:171], v[92:95]
 s_add_u32 s21, s48, 0
 ds_read_b128 v[232:235], v23 offset:128
 v_mfma_f32_16x16x32_bf16 v[96:99], a[56:59], v[168:171], v[96:99]
 v_mfma_f32_16x16x32_bf16 v[100:103], a[48:51], v[172:175], v[100:103]
 ds_read_b128 v[204:207], v19 offset:6144
 v_mfma_f32_16x16x32_bf16 v[104:107], a[52:55], v[172:175], v[104:107]
 buffer_store_dwordx4 v[224:227], v26, s[16:19], s21 offen offset:0 sc1
 v_mfma_f32_16x16x32_bf16 v[108:111], a[56:59], v[172:175], v[108:111]
 s_waitcnt lgkmcnt(5)
 v_mfma_f32_16x16x32_bf16 v[112:115], a[48:51], v[176:179], v[112:115]
 ds_read_b128 v[208:211], v19 offset:8192
 v_mfma_f32_16x16x32_bf16 v[116:119], a[52:55], v[176:179], v[116:119]
 v_mfma_f32_16x16x32_bf16 v[120:123], a[56:59], v[176:179], v[120:123]
 v_mfma_f32_16x16x32_bf16 v[124:127], a[48:51], v[180:183], v[124:127]
 ds_read_b128 v[212:215], v19 offset:10240
 v_mfma_f32_16x16x32_bf16 v[128:131], a[52:55], v[180:183], v[128:131]
 buffer_load_dwordx4 v13, s[8:11], s30 offen offset:3072 lds
 v_mfma_f32_16x16x32_bf16 v[132:135], a[56:59], v[180:183], v[132:135]
 s_add_u32 s30, s30, 128
 s_add_u32 m0, m0, 16384
 v_mfma_f32_16x16x32_bf16 v[136:139], a[48:51], v[184:187], v[136:139]
 ds_read_b128 v[216:219], v19 offset:12288
 v_mfma_f32_16x16x32_bf16 v[140:143], a[52:55], v[184:187], v[140:143]
 s_cmp_lt_u32 m0, s46
 s_cselect_b32 m0, m0, s47
 v_mfma_f32_16x16x32_bf16 v[144:147], a[56:59], v[184:187], v[144:147]
 ds_read_b128 v[236:239], v23 offset:192
 v_mfma_f32_16x16x32_bf16 v[148:151], a[48:51], v[188:191], v[148:151]
 ds_read_b128 v[220:223], v19 offset:14336
 v_mfma_f32_16x16x32_bf16 v[152:155], a[52:55], v[188:191], v[152:155]
 buffer_store_dwordx4 v[228:231], v26, s[16:19], s21 offen offset:1024 sc1
 v_mfma_f32_16x16x32_bf16 v[156:159], a[56:59], v[188:191], v[156:159]
 s_waitcnt vmcnt(14) lgkmcnt(5)
 s_barrier
 v_mfma_f32_16x16x32_bf16 v[64:67], a[60:63], v[192:195], v[64:67]
 ds_read_b128 v[160:163], v18 offset:0
 v_mfma_f32_16x16x32_bf16 v[68:71], a[64:67], v[192:195], v[68:71]
 v_mfma_f32_16x16x32_bf16 v[72:75], a[68:71], v[192:195], v[72:75]
 v_add_u32 v19, s33, v15
 s_add_u32 s33, s33, 16384
 v_mfma_f32_16x16x32_bf16 v[76:79], a[60:63], v[196:199], v[76:79]
 ds_read_b128 v[164:167], v18 offset:2048
 v_mfma_f32_16x16x32_bf16 v[80:83], a[64:67], v[196:199], v[80:83]
 buffer_load_dwordx4 v10, s[8:11], s30 offen offset:0 lds
 v_mfma_f32_16x16x32_bf16 v[84:87], a[68:71], v[196:199], v[84:87]
 s_cmp_lt_u32 s33, 98304
 s_cselect_b32 s33, s33, 0
 v_mfma_f32_16x16x32_bf16 v[88:91], a[60:63], v[200:203], v[88:91]
 ds_read_b128 v[168:171], v18 offset:4096
 v_mfma_f32_16x16x32_bf16 v[92:95], a[64:67], v[200:203], v[92:95]
 ds_read_b128 v[240:243], v23 offset:256
 v_mfma_f32_16x16x32_bf16 v[96:99], a[68:71], v[200:203], v[96:99]
 v_mfma_f32_16x16x32_bf16 v[100:103], a[60:63], v[204:207], v[100:103]
 ds_read_b128 v[172:175], v18 offset:6144
 v_mfma_f32_16x16x32_bf16 v[104:107], a[64:67], v[204:207], v[104:107]
 buffer_store_dwordx4 v[232:235], v26, s[16:19], s21 offen offset:2048 sc1
 v_mfma_f32_16x16x32_bf16 v[108:111], a[68:71], v[204:207], v[108:111]
 s_waitcnt lgkmcnt(5)
 v_mfma_f32_16x16x32_bf16 v[112:115], a[60:63], v[208:211], v[112:115]
 ds_read_b128 v[176:179], v18 offset:8192
 v_mfma_f32_16x16x32_bf16 v[116:119], a[64:67], v[208:211], v[116:119]
 v_mfma_f32_16x16x32_bf16 v[120:123], a[68:71], v[208:211], v[120:123]
 v_mfma_f32_16x16x32_bf16 v[124:127], a[60:63], v[212:215], v[124:127]
 ds_read_b128 v[180:183], v18 offset:10240
 v_mfma_f32_16x16x32_bf16 v[128:131], a[64:67], v[212:215], v[128:131]
 buffer_load_dwordx4 v11, s[8:11], s30 offen offset:1024 lds
 v_mfma_f32_16x16x32_bf16 v[132:135], a[68:71], v[212:215], v[132:135]
 v_mfma_f32_16x16x32_bf16 v[136:139], a[60:63], v[216:219], v[136:139]
 ds_read_b128 v[184:187], v18 offset:12288
 v_mfma_f32_16x16x32_bf16 v[140:143], a[64:67], v[216:219], v[140:143]
 ds_read_b128 v[244:247], v23 offset:320
 v_mfma_f32_16x16x32_bf16 v[144:147], a[68:71], v[216:219], v[144:147]
 v_mfma_f32_16x16x32_bf16 v[148:151], a[60:63], v[220:223], v[148:151]
 ds_read_b128 v[188:191], v18 offset:14336
 v_mfma_f32_16x16x32_bf16 v[152:155], a[64:67], v[220:223], v[152:155]
 buffer_store_dwordx4 v[236:239], v26, s[16:19], s21 offen offset:3072 sc1
 v_mfma_f32_16x16x32_bf16 v[156:159], a[68:71], v[220:223], v[156:159]
 s_waitcnt lgkmcnt(5)
 v_mfma_f32_16x16x32_bf16 v[64:67], a[72:75], v[160:163], v[64:67]
 ds_read_b128 v[192:195], v19 offset:0
 v_mfma_f32_16x16x32_bf16 v[68:71], a[76:79], v[160:163], v[68:71]
 v_add_u32 v18, s33, v14
 v_mfma_f32_16x16x32_bf16 v[72:75], a[80:83], v[160:163], v[72:75]
 v_mfma_f32_16x16x32_bf16 v[76:79], a[72:75], v[164:167], v[76:79]
 ds_read_b128 v[196:199], v19 offset:2048
 v_mfma_f32_16x16x32_bf16 v[80:83], a[76:79], v[164:167], v[80:83]
 buffer_load_dwordx4 v12, s[8:11], s30 offen offset:2048 lds
 v_mfma_f32_16x16x32_bf16 v[84:87], a[80:83], v[164:167], v[84:87]
 v_mfma_f32_16x16x32_bf16 v[88:91], a[72:75], v[168:171], v[88:91]
 ds_read_b128 v[200:203], v19 offset:4096
 v_mfma_f32_16x16x32_bf16 v[92:95], a[76:79], v[168:171], v[92:95]
 s_add_u32 s21, s48, 4096
 ds_read_b128 v[224:227], v23 offset:6400
 v_mfma_f32_16x16x32_bf16 v[96:99], a[80:83], v[168:171], v[96:99]
 v_mfma_f32_16x16x32_bf16 v[100:103], a[72:75], v[172:175], v[100:103]
 ds_read_b128 v[204:207], v19 offset:6144
 v_mfma_f32_16x16x32_bf16 v[104:107], a[76:79], v[172:175], v[104:107]
 buffer_store_dwordx4 v[240:243], v26, s[16:19], s21 offen offset:0 sc1
 v_mfma_f32_16x16x32_bf16 v[108:111], a[80:83], v[172:175], v[108:111]
 s_waitcnt lgkmcnt(5)
 v_mfma_f32_16x16x32_bf16 v[112:115], a[72:75], v[176:179], v[112:115]
 ds_read_b128 v[208:211], v19 offset:8192
 v_mfma_f32_16x16x32_bf16 v[116:119], a[76:79], v[176:179], v[116:119]
 v_mfma_f32_16x16x32_bf16 v[120:123], a[80:83], v[176:179], v[120:123]
 v_mfma_f32_16x16x32_bf16 v[124:127], a[72:75], v[180:183], v[124:127]
 ds_read_b128 v[212:215], v19 offset:10240
 v_mfma_f32_16x16x32_bf16 v[128:131], a[76:79], v[180:183], v[128:131]
 buffer_load_dwordx4 v13, s[8:11], s30 offen offset:3072 lds
 v_mfma_f32_16x16x32_bf16 v[132:135], a[80:83], v[180:183], v[132:135]
 s_add_u32 s30, s30, 128
 s_add_u32 m0, m0, 16384
 v_mfma_f32_16x16x32_bf16 v[136:139], a[72:75], v[184:187], v[136:139]
 ds_read_b128 v[216:219], v19 offset:12288
 v_mfma_f32_16x16x32_bf16 v[140:143], a[76:79], v[184:187], v[140:143]
 s_cmp_lt_u32 m0, s46
 s_cselect_b32 m0, m0, s47
 v_mfma_f32_16x16x32_bf16 v[144:147], a[80:83], v[184:187], v[144:147]
 ds_read_b128 v[228:231], v23 offset:6464
 v_mfma_f32_16x16x32_bf16 v[148:151], a[72:75], v[188:191], v[148:151]
 ds_read_b128 v[220:223], v19 offset:14336
 v_mfma_f32_16x16x32_bf16 v[152:155], a[76:79], v[188:191], v[152:155]
 buffer_store_dwordx4 v[244:247], v26, s[16:19], s21 offen offset:1024 sc1
 v_mfma_f32_16x16x32_bf16 v[156:159], a[80:83], v[188:191], v[156:159]
 s_waitcnt vmcnt(18) lgkmcnt(5)
 s_barrier
 v_mfma_f32_16x16x32_bf16 v[64:67], a[84:87], v[192:195], v[64:67]
 ds_read_b128 v[160:163], v18 offset:0
 v_mfma_f32_16x16x32_bf16 v[68:71], a[88:91], v[192:195], v[68:71]
 v_mfma_f32_16x16x32_bf16 v[72:75], a[92:95], v[192:195], v[72:75]
 v_add_u32 v19, s33, v15
 s_add_u32 s33, s33, 16384
 v_mfma_f32_16x16x32_bf16 v[76:79], a[84:87], v[196:199], v[76:79]
 ds_read_b128 v[164:167], v18 offset:2048
 v_mfma_f32_16x16x32_bf16 v[80:83], a[88:91], v[196:199], v[80:83]
 buffer_load_dwordx4 v10, s[8:11], s30 offen offset:0 lds
 v_mfma_f32_16x16x32_bf16 v[84:87], a[92:95], v[196:199], v[84:87]
 s_cmp_lt_u32 s33, 98304
 s_cselect_b32 s33, s33, 0
 v_mfma_f32_16x16x32_bf16 v[88:91], a[84:87], v[200:203], v[88:91]
 ds_read_b128 v[168:171], v18 offset:4096
 v_mfma_f32_16x16x32_bf16 v[92:95], a[88:91], v[200:203], v[92:95]
 ds_read_b128 v[232:235], v23 offset:6528
 v_mfma_f32_16x16x32_bf16 v[96:99], a[92:95], v[200:203], v[96:99]
 v_mfma_f32_16x16x32_bf16 v[100:103], a[84:87], v[204:207], v[100:103]
 ds_read_b128 v[172:175], v18 offset:6144
 v_mfma_f32_16x16x32_bf16 v[104:107], a[88:91], v[204:207], v[104:107]
 buffer_store_dwordx4 v[224:227], v26, s[16:19], s21 offen offset:2048 sc1
 v_mfma_f32_16x16x32_bf16 v[108:111], a[92:95], v[204:207], v[108:111]
 s_waitcnt lgkmcnt(5)
 v_mfma_f32_16x16x32_bf16 v[112:115], a[84:87], v[208:211], v[112:115]
 ds_read_b128 v[176:179], v18 offset:8192
 v_mfma_f32_16x16x32_bf16 v[116:119], a[88:91], v[208:211], v[116:119]
 v_mfma_f32_16x16x32_bf16 v[120:123], a[92:95], v[208:211], v[120:123]
 v_mfma_f32_16x16x32_bf16 v[124:127], a[84:87], v[212:215], v[124:127]
 ds_read_b128 v[180:183], v18 offset:10240
 v_mfma_f32_16x16x32_bf16 v[128:131], a[88:91], v[212:215], v[128:131]
 buffer_load_dwordx4 v11, s[8:11], s30 offen offset:1024 lds
 v_mfma_f32_16x16x32_bf16 v[132:135], a[92:95], v[212:215], v[132:135]
 v_mfma_f32_16x16x32_bf16 v[136:139], a[84:87], v[216:219], v[136:139]
 ds_read_b128 v[184:187], v18 offset:12288
 v_mfma_f32_16x16x32_bf16 v[140:143], a[88:91], v[216:219], v[140:143]
 ds_read_b128 v[236:239], v23 offset:6592
 v_mfma_f32_16x16x32_bf16 v[144:147], a[92:95], v[216:219], v[144:147]
 v_mfma_f32_16x16x32_bf16 v[148:151], a[84:87], v[220:223], v[148:151]
 ds_read_b128 v[188:191], v18 offset:14336
 v_mfma_f32_16x16x32_bf16 v[152:155], a[88:91], v[220:223], v[152:155]
 buffer_store_dwordx4 v[228:231], v26, s[16:19], s21 offen offset:3072 sc1
 v_mfma_f32_16x16x32_bf16 v[156:159], a[92:95], v[220:223], v[156:159]
 s_waitcnt lgkmcnt(5)
 v_mfma_f32_16x16x32_bf16 v[64:67], a[96:99], v[160:163], v[64:67]
 ds_read_b128 v[192:195], v19 offset:0
 v_mfma_f32_16x16x32_bf16 v[68:71], a[100:103], v[160:163], v[68:71]
 v_add_u32 v18, s33, v14
 v_mfma_f32_16x16x32_bf16 v[72:75], a[104:107], v[160:163], v[72:75]
 v_mfma_f32_16x16x32_bf16 v[76:79], a[96:99], v[164:167], v[76:79]
 ds_read_b128 v[196:199], v19 offset:2048
 v_mfma_f32_16x16x32_bf16 v[80:83], a[100:103], v[164:167], v[80:83]
 buffer_load_dwordx4 v12, s[8:11], s30 offen offset:2048 lds
 v_mfma_f32_16x16x32_bf16 v[84:87], a[104:107], v[164:167], v[84:87]
 v_mfma_f32_16x16x32_bf16 v[88:91], a[96:99], v[168:171], v[88:91]
 ds_read_b128 v[200:203], v19 offset:4096
 v_mfma_f32_16x16x32_bf16 v[92:95], a[100:103], v[168:171], v[92:95]
 s_add_u32 s21, s48, 8192
 ds_read_b128 v[240:243], v23 offset:6656
 v_mfma_f32_16x16x32_bf16 v[96:99], a[104:107], v[168:171], v[96:99]
 v_mfma_f32_16x16x32_bf16 v[100:103], a[96:99], v[172:175], v[100:103]
 ds_read_b128 v[204:207], v19 offset:6144
 v_mfma_f32_16x16x32_bf16 v[104:107], a[100:103], v[172:175], v[104:107]
 buffer_store_dwordx4 v[232:235], v26, s[16:19], s21 offen offset:0 sc1
 v_mfma_f32_16x16x32_bf16 v[108:111], a[104:107], v[172:175], v[108:111]
 s_waitcnt lgkmcnt(5)
 v_mfma_f32_16x16x32_bf16 v[112:115], a[96:99], v[176:179], v[112:115]
 ds_read_b128 v[208:211], v19 offset:8192
 v_mfma_f32_16x16x32_bf16 v[116:119], a[100:103], v[176:179], v[116:119]
 v_mfma_f32_16x16x32_bf16 v[120:123], a[104:107], v[176:179], v[120:123]
 v_mfma_f32_16x16x32_bf16 v[124:127], a[96:99], v[180:183], v[124:127]
 ds_read_b128 v[212:215], v19 offset:10240
 v_mfma_f32_16x16x32_bf16 v[128:131], a[100:103], v[180:183], v[128:131]
 buffer_load_dwordx4 v13, s[8:11], s30 offen offset:3072 lds
 v_mfma_f32_16x16x32_bf16 v[132:135], a[104:107], v[180:183], v[132:135]
 s_add_u32 s30, s30, 128
 s_add_u32 m0, m0, 16384
 v_mfma_f32_16x16x32_bf16 v[136:139], a[96:99], v[184:187], v[136:139]
 ds_read_b128 v[216:219], v19 offset:12288
 v_mfma_f32_16x16x32_bf16 v[140:143], a[100:103], v[184:187], v[140:143]
 s_cmp_lt_u32 m0, s46
 s_cselect_b32 m0, m0, s47
 v_mfma_f32_16x16x32_bf16 v[144:147], a[104:107], v[184:187], v[144:147]
 ds_read_b128 v[244:247], v23 offset:6720
 v_mfma_f32_16x16x32_bf16 v[148:151], a[96:99], v[188:191], v[148:151]
 ds_read_b128 v[220:223], v19 offset:14336
 v_mfma_f32_16x16x32_bf16 v[152:155], a[100:103], v[188:191], v[152:155]
 buffer_store_dwordx4 v[236:239], v26, s[16:19], s21 offen offset:1024 sc1
 v_mfma_f32_16x16x32_bf16 v[156:159], a[104:107], v[188:191], v[156:159]
 s_waitcnt vmcnt(22) lgkmcnt(5)
 s_barrier
 v_mfma_f32_16x16x32_bf16 v[64:67], a[108:111], v[192:195], v[64:67]
 ds_read_b128 v[160:163], v18 offset:0
 v_mfma_f32_16x16x32_bf16 v[68:71], a[112:115], v[192:195], v[68:71]
 v_mfma_f32_16x16x32_bf16 v[72:75], a[116:119], v[192:195], v[72:75]
 v_add_u32 v19, s33, v15
 s_add_u32 s33, s33, 16384
 v_mfma_f32_16x16x32_bf16 v[76:79], a[108:111], v[196:199], v[76:79]
 ds_read_b128 v[164:167], v18 offset:2048
 v_mfma_f32_16x16x32_bf16 v[80:83], a[112:115], v[196:199], v[80:83]
 buffer_load_dwordx4 v10, s[8:11], s30 offen offset:0 lds
 v_mfma_f32_16x16x32_bf16 v[84:87], a[116:119], v[196:199], v[84:87]
 s_cmp_lt_u32 s33, 98304
 s_cselect_b32 s33, s33, 0
 v_mfma_f32_16x16x32_bf16 v[88:91], a[108:111], v[200:203], v[88:91]
 ds_read_b128 v[168:171], v18 offset:4096
 v_mfma_f32_16x16x32_bf16 v[92:95], a[112:115], v[200:203], v[92:95]
 v_mfma_f32_16x16x32_bf16 v[96:99], a[116:119], v[200:203], v[96:99]
 v_mfma_f32_16x16x32_bf16 v[100:103], a[108:111], v[204:207], v[100:103]
 ds_read_b128 v[172:175], v18 offset:6144
 v_mfma_f32_16x16x32_bf16 v[104:107], a[112:115], v[204:207], v[104:107]
 buffer_store_dwordx4 v[240:243], v26, s[16:19], s21 offen offset:2048 sc1
 v_mfma_f32_16x16x32_bf16 v[108:111], a[116:119], v[204:207], v[108:111]
 s_waitcnt lgkmcnt(4)
 v_mfma_f32_16x16x32_bf16 v[112:115], a[108:111], v[208:211], v[112:115]
 ds_read_b128 v[176:179], v18 offset:8192
 v_mfma_f32_16x16x32_bf16 v[116:119], a[112:115], v[208:211], v[116:119]
 v_mfma_f32_16x16x32_bf16 v[120:123], a[116:119], v[208:211], v[120:123]
 v_mfma_f32_16x16x32_bf16 v[124:127], a[108:111], v[212:215], v[124:127]
 ds_read_b128 v[180:183], v18 offset:10240
 v_mfma_f32_16x16x32_bf16 v[128:131], a[112:115], v[212:215], v[128:131]
 buffer_load_dwordx4 v11, s[8:11], s30 offen offset:1024 lds
 v_mfma_f32_16x16x32_bf16 v[132:135], a[116:119], v[212:215], v[132:135]
 v_mfma_f32_16x16x32_bf16 v[136:139], a[108:111], v[216:219], v[136:139]
 ds_read_b128 v[184:187], v18 offset:12288
 v_mfma_f32_16x16x32_bf16 v[140:143], a[112:115], v[216:219], v[140:143]
 v_mfma_f32_16x16x32_bf16 v[144:147], a[116:119], v[216:219], v[144:147]
 v_mfma_f32_16x16x32_bf16 v[148:151], a[108:111], v[220:223], v[148:151]
 ds_read_b128 v[188:191], v18 offset:14336
 v_mfma_f32_16x16x32_bf16 v[152:155], a[112:115], v[220:223], v[152:155]
 buffer_store_dwordx4 v[244:247], v26, s[16:19], s21 offen offset:3072 sc1
 v_mfma_f32_16x16x32_bf16 v[156:159], a[116:119], v[220:223], v[156:159]
 s_waitcnt lgkmcnt(4)
 v_mfma_f32_16x16x32_bf16 v[64:67], a[120:123], v[160:163], v[64:67]
 ds_read_b128 v[192:195], v19 offset:0
 v_mfma_f32_16x16x32_bf16 v[68:71], a[124:127], v[160:163], v[68:71]
 v_add_u32 v18, s33, v14
 v_mfma_f32_16x16x32_bf16 v[72:75], a[128:131], v[160:163], v[72:75]
 v_mfma_f32_16x16x32_bf16 v[76:79], a[120:123], v[164:167], v[76:79]
 ds_read_b128 v[196:199], v19 offset:2048
 v_mfma_f32_16x16x32_bf16 v[80:83], a[124:127], v[164:167], v[80:83]
 buffer_load_dwordx4 v12, s[8:11], s30 offen offset:2048 lds
 v_mfma_f32_16x16x32_bf16 v[84:87], a[128:131], v[164:167], v[84:87]
 v_mfma_f32_16x16x32_bf16 v[88:91], a[120:123], v[168:171], v[88:91]
 ds_read_b128 v[200:203], v19 offset:4096
 v_mfma_f32_16x16x32_bf16 v[92:95], a[124:127], v[168:171], v[92:95]
 v_mfma_f32_16x16x32_bf16 v[96:99], a[128:131], v[168:171], v[96:99]
 v_mfma_f32_16x16x32_bf16 v[100:103], a[120:123], v[172:175], v[100:103]
 ds_read_b128 v[204:207], v19 offset:6144
 v_mfma_f32_16x16x32_bf16 v[104:107], a[124:127], v[172:175], v[104:107]
 v_mfma_f32_16x16x32_bf16 v[108:111], a[128:131], v[172:175], v[108:111]
 s_waitcnt lgkmcnt(4)
 v_mfma_f32_16x16x32_bf16 v[112:115], a[120:123], v[176:179], v[112:115]
 ds_read_b128 v[208:211], v19 offset:8192
 v_mfma_f32_16x16x32_bf16 v[116:119], a[124:127], v[176:179], v[116:119]
 v_mfma_f32_16x16x32_bf16 v[120:123], a[128:131], v[176:179], v[120:123]
 v_mfma_f32_16x16x32_bf16 v[124:127], a[120:123], v[180:183], v[124:127]
 ds_read_b128 v[212:215], v19 offset:10240
 v_mfma_f32_16x16x32_bf16 v[128:131], a[124:127], v[180:183], v[128:131]
 buffer_load_dwordx4 v13, s[8:11], s30 offen offset:3072 lds
 v_mfma_f32_16x16x32_bf16 v[132:135], a[128:131], v[180:183], v[132:135]
 s_add_u32 s30, s30, s25
 s_sub_u32 s30, s30, 1152
 v_mfma_f32_16x16x32_bf16 v[136:139], a[120:123], v[184:187], v[136:139]
 ds_read_b128 v[216:219], v19 offset:12288
 s_add_u32 m0, m0, 16384
 v_mfma_f32_16x16x32_bf16 v[140:143], a[124:127], v[184:187], v[140:143]
 s_cmp_lt_u32 m0, s46
 s_cselect_b32 m0, m0, s47
 v_mfma_f32_16x16x32_bf16 v[144:147], a[128:131], v[184:187], v[144:147]
 v_mfma_f32_16x16x32_bf16 v[148:151], a[120:123], v[188:191], v[148:151]
 ds_read_b128 v[220:223], v19 offset:14336
 v_mfma_f32_16x16x32_bf16 v[152:155], a[124:127], v[188:191], v[152:155]
 v_mfma_f32_16x16x32_bf16 v[156:159], a[128:131], v[188:191], v[156:159]
 s_waitcnt vmcnt(23) lgkmcnt(4)
 s_barrier
 v_mfma_f32_16x16x32_bf16 v[64:67], a[132:135], v[192:195], v[64:67]
 ds_read_b128 v[160:163], v18 offset:0
 v_mfma_f32_16x16x32_bf16 v[68:71], a[136:139], v[192:195], v[68:71]
 v_mfma_f32_16x16x32_bf16 v[72:75], a[140:143], v[192:195], v[72:75]
 v_add_u32 v19, s33, v15
 s_add_u32 s33, s33, 16384
 v_mfma_f32_16x16x32_bf16 v[76:79], a[132:135], v[196:199], v[76:79]
 ds_read_b128 v[164:167], v18 offset:2048
 v_mfma_f32_16x16x32_bf16 v[80:83], a[136:139], v[196:199], v[80:83]
 buffer_load_dwordx4 v10, s[8:11], s30 offen offset:0 lds
 v_mfma_f32_16x16x32_bf16 v[84:87], a[140:143], v[196:199], v[84:87]
 s_cmp_lt_u32 s33, 98304
 s_cselect_b32 s33, s33, 0
 v_mfma_f32_16x16x32_bf16 v[88:91], a[132:135], v[200:203], v[88:91]
 ds_read_b128 v[168:171], v18 offset:4096
 v_mfma_f32_16x16x32_bf16 v[92:95], a[136:139], v[200:203], v[92:95]
 v_mfma_f32_16x16x32_bf16 v[96:99], a[140:143], v[200:203], v[96:99]
 v_mfma_f32_16x16x32_bf16 v[100:103], a[132:135], v[204:207], v[100:103]
 ds_read_b128 v[172:175], v18 offset:6144
 v_mfma_f32_16x16x32_bf16 v[104:107], a[136:139], v[204:207], v[104:107]
 v_mfma_f32_16x16x32_bf16 v[108:111], a[140:143], v[204:207], v[108:111]
 s_waitcnt lgkmcnt(4)
 v_mfma_f32_16x16x32_bf16 v[112:115], a[132:135], v[208:211], v[112:115]
 ds_read_b128 v[176:179], v18 offset:8192
 v_mfma_f32_16x16x32_bf16 v[116:119], a[136:139], v[208:211], v[116:119]
 v_mfma_f32_16x16x32_bf16 v[120:123], a[140:143], v[208:211], v[120:123]
 v_mfma_f32_16x16x32_bf16 v[124:127], a[132:135], v[212:215], v[124:127]
 ds_read_b128 v[180:183], v18 offset:10240
 v_mfma_f32_16x16x32_bf16 v[128:131], a[136:139], v[212:215], v[128:131]
 buffer_load_dwordx4 v11, s[8:11], s30 offen offset:1024 lds
 v_mfma_f32_16x16x32_bf16 v[132:135], a[140:143], v[212:215], v[132:135]
 v_mfma_f32_16x16x32_bf16 v[136:139], a[132:135], v[216:219], v[136:139]
 ds_read_b128 v[184:187], v18 offset:12288
 v_mfma_f32_16x16x32_bf16 v[140:143], a[136:139], v[216:219], v[140:143]
 v_mfma_f32_16x16x32_bf16 v[144:147], a[140:143], v[216:219], v[144:147]
 v_mfma_f32_16x16x32_bf16 v[148:151], a[132:135], v[220:223], v[148:151]
 ds_read_b128 v[188:191], v18 offset:14336
 v_mfma_f32_16x16x32_bf16 v[152:155], a[136:139], v[220:223], v[152:155]
 v_mfma_f32_16x16x32_bf16 v[156:159], a[140:143], v[220:223], v[156:159]
 s_waitcnt lgkmcnt(4)
 v_mfma_f32_16x16x32_bf16 v[64:67], a[144:147], v[160:163], v[64:67]
 ds_read_b128 v[192:195], v19 offset:0
 v_mfma_f32_16x16x32_bf16 v[68:71], a[148:151], v[160:163], v[68:71]
 v_add_u32 v18, s33, v14
 v_mfma_f32_16x16x32_bf16 v[72:75], a[152:155], v[160:163], v[72:75]
 v_mfma_f32_16x16x32_bf16 v[76:79], a[144:147], v[164:167], v[76:79]
 ds_read_b128 v[196:199], v19 offset:2048
 v_mfma_f32_16x16x32_bf16 v[80:83], a[148:151], v[164:167], v[80:83]
 buffer_load_dwordx4 v12, s[8:11], s30 offen offset:2048 lds
 v_mfma_f32_16x16x32_bf16 v[84:87], a[152:155], v[164:167], v[84:87]
 v_mfma_f32_16x16x32_bf16 v[88:91], a[144:147], v[168:171], v[88:91]
 ds_read_b128 v[200:203], v19 offset:4096
 v_mfma_f32_16x16x32_bf16 v[92:95], a[148:151], v[168:171], v[92:95]
 v_mfma_f32_16x16x32_bf16 v[96:99], a[152:155], v[168:171], v[96:99]
 v_mfma_f32_16x16x32_bf16 v[100:103], a[144:147], v[172:175], v[100:103]
 ds_read_b128 v[204:207], v19 offset:6144
 v_mfma_f32_16x16x32_bf16 v[104:107], a[148:151], v[172:175], v[104:107]
 v_mfma_f32_16x16x32_bf16 v[108:111], a[152:155], v[172:175], v[108:111]
 s_waitcnt lgkmcnt(4)
 v_mfma_f32_16x16x32_bf16 v[112:115], a[144:147], v[176:179], v[112:115]
 ds_read_b128 v[208:211], v19 offset:8192
 v_mfma_f32_16x16x32_bf16 v[116:119], a[148:151], v[176:179], v[116:119]
 v_mfma_f32_16x16x32_bf16 v[120:123], a[152:155], v[176:179], v[120:123]
 v_mfma_f32_16x16x32_bf16 v[124:127], a[144:147], v[180:183], v[124:127]
 ds_read_b128 v[212:215], v19 offset:10240
 v_mfma_f32_16x16x32_bf16 v[128:131], a[148:151], v[180:183], v[128:131]
 buffer_load_dwordx4 v13, s[8:11], s30 offen offset:3072 lds
 v_mfma_f32_16x16x32_bf16 v[132:135], a[152:155], v[180:183], v[132:135]
 s_add_u32 s30, s30, 128
 s_add_u32 m0, m0, 16384
 v_mfma_f32_16x16x32_bf16 v[136:139], a[144:147], v[184:187], v[136:139]
 ds_read_b128 v[216:219], v19 offset:12288
 v_mfma_f32_16x16x32_bf16 v[140:143], a[148:151], v[184:187], v[140:143]
 s_cmp_lt_u32 m0, s46
 s_cselect_b32 m0, m0, s47
 v_mfma_f32_16x16x32_bf16 v[144:147], a[152:155], v[184:187], v[144:147]
 v_mfma_f32_16x16x32_bf16 v[148:151], a[144:147], v[188:191], v[148:151]
 ds_read_b128 v[220:223], v19 offset:14336
 v_mfma_f32_16x16x32_bf16 v[152:155], a[148:151], v[188:191], v[152:155]
 v_mfma_f32_16x16x32_bf16 v[156:159], a[152:155], v[188:191], v[156:159]
 s_waitcnt vmcnt(6) lgkmcnt(4)
 s_barrier
 v_mfma_f32_16x16x32_bf16 v[64:67], a[156:159], v[192:195], v[64:67]
 ds_read_b128 v[160:163], v18 offset:0
 v_mfma_f32_16x16x32_bf16 v[68:71], a[160:163], v[192:195], v[68:71]
 s_cmp_eq_u32 s48, 0x80000000
 s_cbranch_scc1 kv_134
 s_cmp_lg_u32 s20, 0
 s_cbranch_scc1 af_135
 v_mov_b32 v4, 0
 v_mov_b32 v5, 1
 s_mov_b64 exec, 1
 buffer_atomic_add v5, v4, s[72:75], s61 offen sc1
 s_mov_b64 exec, -1
 s_nop 1
af_135:
kv_134:
 v_mfma_f32_16x16x32_bf16 v[72:75], a[164:167], v[192:195], v[72:75]
 v_add_u32 v19, s33, v15
 s_add_u32 s33, s33, 16384
 v_mfma_f32_16x16x32_bf16 v[76:79], a[156:159], v[196:199], v[76:79]
 ds_read_b128 v[164:167], v18 offset:2048
 v_mfma_f32_16x16x32_bf16 v[80:83], a[160:163], v[196:199], v[80:83]
 buffer_load_dwordx4 v10, s[8:11], s30 offen offset:0 lds
 v_mfma_f32_16x16x32_bf16 v[84:87], a[164:167], v[196:199], v[84:87]
 s_cmp_lt_u32 s33, 98304
 s_cselect_b32 s33, s33, 0
 v_mfma_f32_16x16x32_bf16 v[88:91], a[156:159], v[200:203], v[88:91]
 ds_read_b128 v[168:171], v18 offset:4096
 v_mfma_f32_16x16x32_bf16 v[92:95], a[160:163], v[200:203], v[92:95]
 v_mfma_f32_16x16x32_bf16 v[96:99], a[164:167], v[200:203], v[96:99]
 v_mfma_f32_16x16x32_bf16 v[100:103], a[156:159], v[204:207], v[100:103]
 ds_read_b128 v[172:175], v18 offset:6144
 v_mfma_f32_16x16x32_bf16 v[104:107], a[160:163], v[204:207], v[104:107]
 v_mfma_f32_16x16x32_bf16 v[108:111], a[164:167], v[204:207], v[108:111]
 s_waitcnt lgkmcnt(4)
 v_mfma_f32_16x16x32_bf16 v[112:115], a[156:159], v[208:211], v[112:115]
 ds_read_b128 v[176:179], v18 offset:8192
 v_mfma_f32_16x16x32_bf16 v[116:119], a[160:163], v[208:211], v[116:119]
 v_mfma_f32_16x16x32_bf16 v[120:123], a[164:167], v[208:211], v[120:123]
 v_mfma_f32_16x16x32_bf16 v[124:127], a[156:159], v[212:215], v[124:127]
 ds_read_b128 v[180:183], v18 offset:10240
 v_mfma_f32_16x16x32_bf16 v[128:131], a[160:163], v[212:215], v[128:131]
 buffer_load_dwordx4 v11, s[8:11], s30 offen offset:1024 lds
 v_mfma_f32_16x16x32_bf16 v[132:135], a[164:167], v[212:215], v[132:135]
 v_mfma_f32_16x16x32_bf16 v[136:139], a[156:159], v[216:219], v[136:139]
 ds_read_b128 v[184:187], v18 offset:12288
 v_mfma_f32_16x16x32_bf16 v[140:143], a[160:163], v[216:219], v[140:143]
 v_mfma_f32_16x16x32_bf16 v[144:147], a[164:167], v[216:219], v[144:147]
 v_mfma_f32_16x16x32_bf16 v[148:151], a[156:159], v[220:223], v[148:151]
 ds_read_b128 v[188:191], v18 offset:14336
 v_mfma_f32_16x16x32_bf16 v[152:155], a[160:163], v[220:223], v[152:155]
 v_mfma_f32_16x16x32_bf16 v[156:159], a[164:167], v[220:223], v[156:159]
 s_waitcnt lgkmcnt(4)
 v_mfma_f32_16x16x32_bf16 v[64:67], a[168:171], v[160:163], v[64:67]
 ds_read_b128 v[192:195], v19 offset:0
 v_mfma_f32_16x16x32_bf16 v[68:71], a[172:175], v[160:163], v[68:71]
 v_add_u32 v18, s33, v14
 s_mov_b32 s61, s60
 v_mfma_f32_16x16x32_bf16 v[72:75], a[176:179], v[160:163], v[72:75]
 s_add_u32 s60, s60, s62
 s_mul_i32 s48, s20, 393216
 v_mfma_f32_16x16x32_bf16 v[76:79], a[168:171], v[164:167], v[76:79]
 ds_read_b128 v[196:199], v19 offset:2048
 s_add_u32 s48, s48, s27
 v_mfma_f32_16x16x32_bf16 v[80:83], a[172:175], v[164:167], v[80:83]
 buffer_load_dwordx4 v12, s[8:11], s30 offen offset:2048 lds
 v_mfma_f32_16x16x32_bf16 v[84:87], a[176:179], v[164:167], v[84:87]
 s_add_u32 s27, s27, s28
 s_sub_u32 s26, s26, 1
 v_mfma_f32_16x16x32_bf16 v[88:91], a[168:171], v[168:171], v[88:91]
 ds_read_b128 v[200:203], v19 offset:4096
 v_mfma_f32_16x16x32_bf16 v[92:95], a[172:175], v[168:171], v[92:95]
 v_mfma_f32_16x16x32_bf16 v[96:99], a[176:179], v[168:171], v[96:99]
 v_mfma_f32_16x16x32_bf16 v[100:103], a[168:171], v[172:175], v[100:103]
 ds_read_b128 v[204:207], v19 offset:6144
 v_mfma_f32_16x16x32_bf16 v[104:107], a[172:175], v[172:175], v[104:107]
 v_mfma_f32_16x16x32_bf16 v[108:111], a[176:179], v[172:175], v[108:111]
 s_waitcnt lgkmcnt(4)
 v_mfma_f32_16x16x32_bf16 v[112:115], a[168:171], v[176:179], v[112:115]
 ds_read_b128 v[208:211], v19 offset:8192
 v_mfma_f32_16x16x32_bf16 v[116:119], a[172:175], v[176:179], v[116:119]
 v_mfma_f32_16x16x32_bf16 v[120:123], a[176:179], v[176:179], v[120:123]
 v_mfma_f32_16x16x32_bf16 v[124:127], a[168:171], v[180:183], v[124:127]
 ds_read_b128 v[212:215], v19 offset:10240
 v_mfma_f32_16x16x32_bf16 v[128:131], a[172:175], v[180:183], v[128:131]
 buffer_load_dwordx4 v13, s[8:11], s30 offen offset:3072 lds
 v_mfma_f32_16x16x32_bf16 v[132:135], a[176:179], v[180:183], v[132:135]
 s_add_u32 s30, s30, 128
 s_add_u32 m0, m0, 16384
 v_mfma_f32_16x16x32_bf16 v[136:139], a[168:171], v[184:187], v[136:139]
 ds_read_b128 v[216:219], v19 offset:12288
 v_mfma_f32_16x16x32_bf16 v[140:143], a[172:175], v[184:187], v[140:143]
 s_cmp_lt_u32 m0, s46
 s_cselect_b32 m0, m0, s47
 v_mfma_f32_16x16x32_bf16 v[144:147], a[176:179], v[184:187], v[144:147]
 v_mfma_f32_16x16x32_bf16 v[148:151], a[168:171], v[188:191], v[148:151]
 ds_read_b128 v[220:223], v19 offset:14336
 v_mfma_f32_16x16x32_bf16 v[152:155], a[172:175], v[188:191], v[152:155]
 v_mfma_f32_16x16x32_bf16 v[156:159], a[176:179], v[188:191], v[156:159]
 s_waitcnt vmcnt(15) lgkmcnt(4)
 s_barrier
 v_mfma_f32_16x16x32_bf16 v[64:67], a[180:183], v[192:195], v[64:67]
 ds_read_b128 v[160:163], v18 offset:0
 v_mfma_f32_16x16x32_bf16 v[68:71], a[184:187], v[192:195], v[68:71]
 v_mfma_f32_16x16x32_bf16 v[72:75], a[188:191], v[192:195], v[72:75]
 v_add_u32 v19, s33, v15
 s_add_u32 s33, s33, 16384
 v_mfma_f32_16x16x32_bf16 v[76:79], a[180:183], v[196:199], v[76:79]
 ds_read_b128 v[164:167], v18 offset:2048
 v_mfma_f32_16x16x32_bf16 v[80:83], a[184:187], v[196:199], v[80:83]
 buffer_load_dwordx4 v10, s[8:11], s30 offen offset:0 lds
 v_mfma_f32_16x16x32_bf16 v[84:87], a[188:191], v[196:199], v[84:87]
 s_cmp_lt_u32 s33, 98304
 s_cselect_b32 s33, s33, 0
 v_mfma_f32_16x16x32_bf16 v[88:91], a[180:183], v[200:203], v[88:91]
 ds_read_b128 v[168:171], v18 offset:4096
 v_mfma_f32_16x16x32_bf16 v[92:95], a[184:187], v[200:203], v[92:95]
 v_mfma_f32_16x16x32_bf16 v[96:99], a[188:191], v[200:203], v[96:99]
 v_mfma_f32_16x16x32_bf16 v[100:103], a[180:183], v[204:207], v[100:103]
 ds_read_b128 v[172:175], v18 offset:6144
 v_mfma_f32_16x16x32_bf16 v[104:107], a[184:187], v[204:207], v[104:107]
 v_mfma_f32_16x16x32_bf16 v[108:111], a[188:191], v[204:207], v[108:111]
 s_waitcnt lgkmcnt(4)
 v_mfma_f32_16x16x32_bf16 v[112:115], a[180:183], v[208:211], v[112:115]
 ds_read_b128 v[176:179], v18 offset:8192
 v_mfma_f32_16x16x32_bf16 v[116:119], a[184:187], v[208:211], v[116:119]
 v_mfma_f32_16x16x32_bf16 v[120:123], a[188:191], v[208:211], v[120:123]
 v_mfma_f32_16x16x32_bf16 v[124:127], a[180:183], v[212:215], v[124:127]
 ds_read_b128 v[180:183], v18 offset:10240
 v_mfma_f32_16x16x32_bf16 v[128:131], a[184:187], v[212:215], v[128:131]
 buffer_load_dwordx4 v11, s[8:11], s30 offen offset:1024 lds
 v_mfma_f32_16x16x32_bf16 v[132:135], a[188:191], v[212:215], v[132:135]
 v_mfma_f32_16x16x32_bf16 v[136:139], a[180:183], v[216:219], v[136:139]
 ds_read_b128 v[184:187], v18 offset:12288
 v_mfma_f32_16x16x32_bf16 v[140:143], a[184:187], v[216:219], v[140:143]
 v_mfma_f32_16x16x32_bf16 v[144:147], a[188:191], v[216:219], v[144:147]
 v_mfma_f32_16x16x32_bf16 v[148:151], a[180:183], v[220:223], v[148:151]
 ds_read_b128 v[188:191], v18 offset:14336
 v_mfma_f32_16x16x32_bf16 v[152:155], a[184:187], v[220:223], v[152:155]
 v_mfma_f32_16x16x32_bf16 v[156:159], a[188:191], v[220:223], v[156:159]
 s_waitcnt lgkmcnt(4)
 v_mfma_f32_16x16x32_bf16 v[64:67], a[192:195], v[160:163], v[64:67]
 ds_read_b128 v[192:195], v19 offset:0
 v_mfma_f32_16x16x32_bf16 v[68:71], a[196:199], v[160:163], v[68:71]
 v_add_u32 v18, s33, v14
 v_mfma_f32_16x16x32_bf16 v[72:75], a[200:203], v[160:163], v[72:75]
 v_mfma_f32_16x16x32_bf16 v[76:79], a[192:195], v[164:167], v[76:79]
 ds_read_b128 v[196:199], v19 offset:2048
 v_mfma_f32_16x16x32_bf16 v[80:83], a[196:199], v[164:167], v[80:83]
 buffer_load_dwordx4 v12, s[8:11], s30 offen offset:2048 lds
 v_mfma_f32_16x16x32_bf16 v[84:87], a[200:203], v[164:167], v[84:87]
 v_mfma_f32_16x16x32_bf16 v[88:91], a[192:195], v[168:171], v[88:91]
 ds_read_b128 v[200:203], v19 offset:4096
 v_mfma_f32_16x16x32_bf16 v[92:95], a[196:199], v[168:171], v[92:95]
 v_mfma_f32_16x16x32_bf16 v[96:99], a[200:203], v[168:171], v[96:99]
 v_mfma_f32_16x16x32_bf16 v[100:103], a[192:195], v[172:175], v[100:103]
 ds_read_b128 v[204:207], v19 offset:6144
 v_mfma_f32_16x16x32_bf16 v[104:107], a[196:199], v[172:175], v[104:107]
 v_mfma_f32_16x16x32_bf16 v[108:111], a[200:203], v[172:175], v[108:111]
 s_waitcnt lgkmcnt(4)
 v_mfma_f32_16x16x32_bf16 v[112:115], a[192:195], v[176:179], v[112:115]
 ds_read_b128 v[208:211], v19 offset:8192
 v_mfma_f32_16x16x32_bf16 v[116:119], a[196:199], v[176:179], v[116:119]
 v_mfma_f32_16x16x32_bf16 v[120:123], a[200:203], v[176:179], v[120:123]
 v_mfma_f32_16x16x32_bf16 v[124:127], a[192:195], v[180:183], v[124:127]
 ds_read_b128 v[212:215], v19 offset:10240
 v_mfma_f32_16x16x32_bf16 v[128:131], a[196:199], v[180:183], v[128:131]
 buffer_load_dwordx4 v13, s[8:11], s30 offen offset:3072 lds
 v_mfma_f32_16x16x32_bf16 v[132:135], a[200:203], v[180:183], v[132:135]
 s_add_u32 s30, s30, 128
 s_add_u32 m0, m0, 16384
 v_mfma_f32_16x16x32_bf16 v[136:139], a[192:195], v[184:187], v[136:139]
 ds_read_b128 v[216:219], v19 offset:12288
 v_mfma_f32_16x16x32_bf16 v[140:143], a[196:199], v[184:187], v[140:143]
 s_cmp_lt_u32 m0, s46
 s_cselect_b32 m0, m0, s47
 v_mfma_f32_16x16x32_bf16 v[144:147], a[200:203], v[184:187], v[144:147]
 v_mfma_f32_16x16x32_bf16 v[148:151], a[192:195], v[188:191], v[148:151]
 ds_read_b128 v[220:223], v19 offset:14336
 v_mfma_f32_16x16x32_bf16 v[152:155], a[196:199], v[188:191], v[152:155]
 v_mfma_f32_16x16x32_bf16 v[156:159], a[200:203], v[188:191], v[156:159]
 s_waitcnt vmcnt(12) lgkmcnt(4)
 s_barrier
 v_mfma_f32_16x16x32_bf16 v[64:67], a[204:207], v[192:195], v[64:67]
 ds_read_b128 v[160:163], v18 offset:0
 v_mfma_f32_16x16x32_bf16 v[68:71], a[208:211], v[192:195], v[68:71]
 v_mfma_f32_16x16x32_bf16 v[72:75], a[212:215], v[192:195], v[72:75]
 v_add_u32 v19, s33, v15
 s_add_u32 s33, s33, 16384
 v_mfma_f32_16x16x32_bf16 v[76:79], a[204:207], v[196:199], v[76:79]
 ds_read_b128 v[164:167], v18 offset:2048
 v_mfma_f32_16x16x32_bf16 v[80:83], a[208:211], v[196:199], v[80:83]
 buffer_load_dwordx4 v10, s[8:11], s30 offen offset:0 lds
 v_mfma_f32_16x16x32_bf16 v[84:87], a[212:215], v[196:199], v[84:87]
 s_cmp_lt_u32 s33, 98304
 s_cselect_b32 s33, s33, 0
 v_mfma_f32_16x16x32_bf16 v[88:91], a[204:207], v[200:203], v[88:91]
 ds_read_b128 v[168:171], v18 offset:4096
 v_mfma_f32_16x16x32_bf16 v[92:95], a[208:211], v[200:203], v[92:95]
 v_mfma_f32_16x16x32_bf16 v[96:99], a[212:215], v[200:203], v[96:99]
 v_mfma_f32_16x16x32_bf16 v[100:103], a[204:207], v[204:207], v[100:103]
 ds_read_b128 v[172:175], v18 offset:6144
 v_mfma_f32_16x16x32_bf16 v[104:107], a[208:211], v[204:207], v[104:107]
 v_mfma_f32_16x16x32_bf16 v[108:111], a[212:215], v[204:207], v[108:111]
 s_waitcnt lgkmcnt(4)
 v_mfma_f32_16x16x32_bf16 v[112:115], a[204:207], v[208:211], v[112:115]
 ds_read_b128 v[176:179], v18 offset:8192
 v_mfma_f32_16x16x32_bf16 v[116:119], a[208:211], v[208:211], v[116:119]
 v_mfma_f32_16x16x32_bf16 v[120:123], a[212:215], v[208:211], v[120:123]
 v_mfma_f32_16x16x32_bf16 v[124:127], a[204:207], v[212:215], v[124:127]
 ds_read_b128 v[180:183], v18 offset:10240
 v_mfma_f32_16x16x32_bf16 v[128:131], a[208:211], v[212:215], v[128:131]
 buffer_load_dwordx4 v11, s[8:11], s30 offen offset:1024 lds
 v_mfma_f32_16x16x32_bf16 v[132:135], a[212:215], v[212:215], v[132:135]
 v_mfma_f32_16x16x32_bf16 v[136:139], a[204:207], v[216:219], v[136:139]
 ds_read_b128 v[184:187], v18 offset:12288
 v_mfma_f32_16x16x32_bf16 v[140:143], a[208:211], v[216:219], v[140:143]
 v_mfma_f32_16x16x32_bf16 v[144:147], a[212:215], v[216:219], v[144:147]
 v_mfma_f32_16x16x32_bf16 v[148:151], a[204:207], v[220:223], v[148:151]
 ds_read_b128 v[188:191], v18 offset:14336
 v_mfma_f32_16x16x32_bf16 v[152:155], a[208:211], v[220:223], v[152:155]
 v_mfma_f32_16x16x32_bf16 v[156:159], a[212:215], v[220:223], v[156:159]
 s_waitcnt lgkmcnt(4)
 v_mfma_f32_16x16x32_bf16 v[64:67], a[216:219], v[160:163], v[64:67]
 ds_read_b128 v[192:195], v19 offset:0
 v_mfma_f32_16x16x32_bf16 v[68:71], a[220:223], v[160:163], v[68:71]
 v_add_u32 v18, s33, v14
 v_mfma_f32_16x16x32_bf16 v[72:75], a[224:227], v[160:163], v[72:75]
 v_mfma_f32_16x16x32_bf16 v[76:79], a[216:219], v[164:167], v[76:79]
 ds_read_b128 v[196:199], v19 offset:2048
 v_mfma_f32_16x16x32_bf16 v[80:83], a[220:223], v[164:167], v[80:83]
 buffer_load_dwordx4 v12, s[8:11], s30 offen offset:2048 lds
 v_mfma_f32_16x16x32_bf16 v[84:87], a[224:227], v[164:167], v[84:87]
 v_mfma_f32_16x16x32_bf16 v[88:91], a[216:219], v[168:171], v[88:91]
 ds_read_b128 v[200:203], v19 offset:4096
 v_mfma_f32_16x16x32_bf16 v[92:95], a[220:223], v[168:171], v[92:95]
 v_mfma_f32_16x16x32_bf16 v[96:99], a[224:227], v[168:171], v[96:99]
 v_mfma_f32_16x16x32_bf16 v[100:103], a[216:219], v[172:175], v[100:103]
 ds_read_b128 v[204:207], v19 offset:6144
 v_mfma_f32_16x16x32_bf16 v[104:107], a[220:223], v[172:175], v[104:107]
 v_mfma_f32_16x16x32_bf16 v[108:111], a[224:227], v[172:175], v[108:111]
 s_waitcnt lgkmcnt(4)
 v_mfma_f32_16x16x32_bf16 v[112:115], a[216:219], v[176:179], v[112:115]
 ds_read_b128 v[208:211], v19 offset:8192
 v_mfma_f32_16x16x32_bf16 v[116:119], a[220:223], v[176:179], v[116:119]
 v_mfma_f32_16x16x32_bf16 v[120:123], a[224:227], v[176:179], v[120:123]
 v_mfma_f32_16x16x32_bf16 v[124:127], a[216:219], v[180:183], v[124:127]
 ds_read_b128 v[212:215], v19 offset:10240
 v_mfma_f32_16x16x32_bf16 v[128:131], a[220:223], v[180:183], v[128:131]
 buffer_load_dwordx4 v13, s[8:11], s30 offen offset:3072 lds
 v_mfma_f32_16x16x32_bf16 v[132:135], a[224:227], v[180:183], v[132:135]
 s_add_u32 s30, s30, 128
 s_add_u32 m0, m0, 16384
 v_mfma_f32_16x16x32_bf16 v[136:139], a[216:219], v[184:187], v[136:139]
 ds_read_b128 v[216:219], v19 offset:12288
 v_mfma_f32_16x16x32_bf16 v[140:143], a[220:223], v[184:187], v[140:143]
 s_cmp_lt_u32 m0, s46
 s_cselect_b32 m0, m0, s47
 v_mfma_f32_16x16x32_bf16 v[144:147], a[224:227], v[184:187], v[144:147]
 v_mfma_f32_16x16x32_bf16 v[148:151], a[216:219], v[188:191], v[148:151]
 ds_read_b128 v[220:223], v19 offset:14336
 v_mfma_f32_16x16x32_bf16 v[152:155], a[220:223], v[188:191], v[152:155]
 v_mfma_f32_16x16x32_bf16 v[156:159], a[224:227], v[188:191], v[156:159]
 s_waitcnt vmcnt(12) lgkmcnt(4)
 s_barrier
 v_mfma_f32_16x16x32_bf16 v[64:67], a[228:231], v[192:195], v[64:67]
 ds_read_b128 v[160:163], v18 offset:0
 v_mfma_f32_16x16x32_bf16 v[68:71], a[232:235], v[192:195], v[68:71]
 v_mfma_f32_16x16x32_bf16 v[72:75], a[236:239], v[192:195], v[72:75]
 v_add_u32 v19, s33, v15
 s_add_u32 s33, s33, 16384
 v_mfma_f32_16x16x32_bf16 v[76:79], a[228:231], v[196:199], v[76:79]
 ds_read_b128 v[164:167], v18 offset:2048
 v_cvt_pk_bf16_f32 v224, v64, v65
 v_mfma_f32_16x16x32_bf16 v[80:83], a[232:235], v[196:199], v[80:83]
 buffer_load_dwordx4 v10, s[8:11], s30 offen offset:0 lds
 v_mfma_f32_16x16x32_bf16 v[84:87], a[236:239], v[196:199], v[84:87]
 s_cmp_lt_u32 s33, 98304
 s_cselect_b32 s33, s33, 0
 v_mfma_f32_16x16x32_bf16 v[88:91], a[228:231], v[200:203], v[88:91]
 ds_read_b128 v[168:171], v18 offset:4096
 v_cvt_pk_bf16_f32 v225, v66, v67
 v_mfma_f32_16x16x32_bf16 v[92:95], a[232:235], v[200:203], v[92:95]
 v_cvt_pk_bf16_f32 v226, v68, v69
 v_cvt_pk_bf16_f32 v227, v70, v71
 v_mfma_f32_16x16x32_bf16 v[96:99], a[236:239], v[200:203], v[96:99]
 v_cvt_pk_bf16_f32 v228, v72, v73
 v_cvt_pk_bf16_f32 v229, v74, v75
 v_mfma_f32_16x16x32_bf16 v[100:103], a[228:231], v[204:207], v[100:103]
 ds_read_b128 v[172:175], v18 offset:6144
 v_mfma_f32_16x16x32_bf16 v[104:107], a[232:235], v[204:207], v[104:107]
 ds_write_b64 v22, v[224:225] offset:0
 v_mfma_f32_16x16x32_bf16 v[108:111], a[236:239], v[204:207], v[108:111]
 s_waitcnt lgkmcnt(5)
 v_mfma_f32_16x16x32_bf16 v[112:115], a[228:231], v[208:211], v[112:115]
 ds_read_b128 v[176:179], v18 offset:8192
 v_mfma_f32_16x16x32_bf16 v[116:119], a[232:235], v[208:211], v[116:119]
 ds_write_b64 v22, v[226:227] offset:8
 v_mfma_f32_16x16x32_bf16 v[120:123], a[236:239], v[208:211], v[120:123]
 ds_write_b64 v16, v[228:229] offset:64
 v_mfma_f32_16x16x32_bf16 v[124:127], a[228:231], v[212:215], v[124:127]
 ds_read_b128 v[180:183], v18 offset:10240
 v_cvt_pk_bf16_f32 v230, v76, v77
 v_mfma_f32_16x16x32_bf16 v[128:131], a[232:235], v[212:215], v[128:131]
 buffer_load_dwordx4 v11, s[8:11], s30 offen offset:1024 lds
 v_mfma_f32_16x16x32_bf16 v[132:135], a[236:239], v[212:215], v[132:135]
 v_cvt_pk_bf16_f32 v231, v78, v79
 v_cvt_pk_bf16_f32 v232, v80, v81
 v_mfma_f32_16x16x32_bf16 v[136:139], a[228:231], v[216:219], v[136:139]
 ds_read_b128 v[184:187], v18 offset:12288
 v_cvt_pk_bf16_f32 v233, v82, v83
 v_mfma_f32_16x16x32_bf16 v[140:143], a[232:235], v[216:219], v[140:143]
 v_cvt_pk_bf16_f32 v234, v84, v85
 v_cvt_pk_bf16_f32 v235, v86, v87
 v_mfma_f32_16x16x32_bf16 v[144:147], a[236:239], v[216:219], v[144:147]
 ds_write_b64 v22, v[230:231] offset:6400
 v_mfma_f32_16x16x32_bf16 v[148:151], a[228:231], v[220:223], v[148:151]
 ds_read_b128 v[188:191], v18 offset:14336
 v_mfma_f32_16x16x32_bf16 v[152:155], a[232:235], v[220:223], v[152:155]
 ds_write_b64 v22, v[232:233] offset:6408
 v_mfma_f32_16x16x32_bf16 v[156:159], a[236:239], v[220:223], v[156:159]
 s_waitcnt lgkmcnt(9)
kv_end_137:
 s_cmp_gt_u32 s26, 0
 s_cbranch_scc1 kv_blk_136
 s_nop 7
 ds_write_b64 v16, v[234:235] offset:6464
 v_cvt_pk_bf16_f32 v236, v88, v89
 v_cvt_pk_bf16_f32 v237, v90, v91
 v_cvt_pk_bf16_f32 v238, v92, v93
 v_cvt_pk_bf16_f32 v239, v94, v95
 v_cvt_pk_bf16_f32 v240, v96, v97
 v_cvt_pk_bf16_f32 v241, v98, v99
 ds_write_b64 v22, v[236:237] offset:12800
 ds_write_b64 v22, v[238:239] offset:12808
 ds_write_b64 v16, v[240:241] offset:12864
 v_cvt_pk_bf16_f32 v242, v100, v101
 v_cvt_pk_bf16_f32 v243, v102, v103
 v_cvt_pk_bf16_f32 v244, v104, v105
 v_cvt_pk_bf16_f32 v245, v106, v107
 v_cvt_pk_bf16_f32 v246, v108, v109
 v_cvt_pk_bf16_f32 v247, v110, v111
 ds_write_b64 v22, v[242:243] offset:19200
 ds_write_b64 v22, v[244:245] offset:19208
 ds_write_b64 v16, v[246:247] offset:19264
 v_cvt_pk_bf16_f32 v224, v112, v113
 v_cvt_pk_bf16_f32 v225, v114, v115
 v_cvt_pk_bf16_f32 v226, v116, v117
 v_cvt_pk_bf16_f32 v227, v118, v119
 v_cvt_pk_bf16_f32 v228, v120, v121
 v_cvt_pk_bf16_f32 v229, v122, v123
 ds_write_b64 v22, v[224:225] offset:25600
 ds_write_b64 v22, v[226:227] offset:25608
 ds_write_b64 v16, v[228:229] offset:25664
 v_cvt_pk_bf16_f32 v230, v124, v125
 v_cvt_pk_bf16_f32 v231, v126, v127
 v_cvt_pk_bf16_f32 v232, v128, v129
 v_cvt_pk_bf16_f32 v233, v130, v131
 v_cvt_pk_bf16_f32 v234, v132, v133
 v_cvt_pk_bf16_f32 v235, v134, v135
 ds_write_b64 v22, v[230:231] offset:32000
 ds_write_b64 v22, v[232:233] offset:32008
 ds_write_b64 v16, v[234:235] offset:32064
 v_cvt_pk_bf16_f32 v236, v136, v137
 v_cvt_pk_bf16_f32 v237, v138, v139
 v_cvt_pk_bf16_f32 v238, v140, v141
 v_cvt_pk_bf16_f32 v239, v142, v143
 v_cvt_pk_bf16_f32 v240, v144, v145
 v_cvt_pk_bf16_f32 v241, v146, v147
 ds_write_b64 v22, v[236:237] offset:38400
 ds_write_b64 v22, v[238:239] offset:38408
 ds_write_b64 v16, v[240:241] offset:38464
 v_cvt_pk_bf16_f32 v242, v148, v149
 v_cvt_pk_bf16_f32 v243, v150, v151
 v_cvt_pk_bf16_f32 v244, v152, v153
 v_cvt_pk_bf16_f32 v245, v154, v155
 v_cvt_pk_bf16_f32 v246, v156, v157
 v_cvt_pk_bf16_f32 v247, v158, v159
 ds_write_b64 v22, v[242:243] offset:44800
 ds_write_b64 v22, v[244:245] offset:44808
 ds_write_b64 v16, v[246:247] offset:44864
 s_waitcnt vmcnt(0) lgkmcnt(0)
 s_barrier
 ds_read_b128 v[224:227], v23 offset:0
 ds_read_b128 v[228:231], v23 offset:64
 ds_read_b128 v[232:235], v23 offset:128
 ds_read_b128 v[236:239], v23 offset:192
 ds_read_b128 v[240:243], v23 offset:256
 ds_read_b128 v[244:247], v23 offset:320
 s_waitcnt lgkmcnt(0)
 s_add_u32 s21, s48, 0
 buffer_store_dwordx4 v[224:227], v26, s[16:19], s21 offen offset:0 sc1
 buffer_store_dwordx4 v[228:231], v26, s[16:19], s21 offen offset:1024 sc1
 buffer_store_dwordx4 v[232:235], v26, s[16:19], s21 offen offset:2048 sc1
 buffer_store_dwordx4 v[236:239], v26, s[16:19], s21 offen offset:3072 sc1
 s_add_u32 s21, s48, 4096
 buffer_store_dwordx4 v[240:243], v26, s[16:19], s21 offen offset:0 sc1
 buffer_store_dwordx4 v[244:247], v26, s[16:19], s21 offen offset:1024 sc1
 s_nop 1
 ds_read_b128 v[224:227], v23 offset:6400
 ds_read_b128 v[228:231], v23 offset:6464
 ds_read_b128 v[232:235], v23 offset:6528
 ds_read_b128 v[236:239], v23 offset:6592
 ds_read_b128 v[240:243], v23 offset:6656
 ds_read_b128 v[244:247], v23 offset:6720
 s_waitcnt lgkmcnt(0)
 buffer_store_dwordx4 v[224:227], v26, s[16:19], s21 offen offset:2048 sc1
 buffer_store_dwordx4 v[228:231], v26, s[16:19], s21 offen offset:3072 sc1
 s_add_u32 s21, s48, 8192
 buffer_store_dwordx4 v[232:235], v26, s[16:19], s21 offen offset:0 sc1
 buffer_store_dwordx4 v[236:239], v26, s[16:19], s21 offen offset:1024 sc1
 buffer_store_dwordx4 v[240:243], v26, s[16:19], s21 offen offset:2048 sc1
 buffer_store_dwordx4 v[244:247], v26, s[16:19], s21 offen offset:3072 sc1
 s_nop 1
 s_waitcnt vmcnt(0)
 s_barrier
 s_cmp_lg_u32 s20, 0
 s_cbranch_scc1 af_138
 v_mov_b32 v4, 0
 v_mov_b32 v5, 1
 s_mov_b64 exec, 1
 buffer_atomic_add v5, v4, s[72:75], s61 offen sc1
 s_mov_b64 exec, -1
 s_nop 1
af_138:
 s_cmp_lg_u32 s43, 0
 s_cbranch_scc1 kv_fin
 s_lshr_b32 s2, s3, 1
 s_branch q_entry
kv_fin:
 s_branch queue
not_kv:
 s_cmp_ge_u32 s3, 96
 s_cbranch_scc1 not_vw
 s_sub_u32 s2, s3, 64
 s_load_dwordx2 s[72:73], s[0:1], 104
 s_waitcnt lgkmcnt(0)
 s_add_u32 s72, s72, 81068032
 s_addc_u32 s73, s73, 0
 s_mov_b32 s74, 129024
 s_mov_b32 s75, 0x00020000
 s_add_u32 s8, s38, 78643200
 s_addc_u32 s9, s39, 0
 s_mov_b32 s10, 2162688
 s_mov_b32 s11, 0x00020000
 s_add_u32 s12, s38, 50331648
 s_addc_u32 s13, s39, 0
 s_mov_b32 s14, 12582912
 s_mov_b32 s15, 0x00020000
 s_add_u32 s16, s38, 181305344
 s_addc_u32 s17, s39, 0
 s_mov_b32 s18, 66158592
 s_mov_b32 s19, 0x00020000
 v_lshlrev_b32 v8, 4, v0
 v_lshlrev_b32 v9, 4, v1
 v_mov_b32 v4, 0
 v_mov_b32 v12, -1
 v_mov_b32 v5, 0
 v_mov_b32 v13, -1
 v_mov_b32 v6, 0
 v_mov_b32 v14, -1
 v_mov_b32 v7, 0
 v_mov_b32 v15, -1
 s_lshl_b32 s21, s2, 12
 buffer_store_dwordx4 v[4:7], v8, s[72:75], s21 offen sc1
 s_lshr_b32 s21, s2, 3
 s_mul_i32 s21, s21, 0x88000
 s_and_b32 s21, s21, 0x108000
 s_bfe_u32 s22, s2, 0x10002
 s_lshl_b32 s22, s22, 13
 s_add_u32 s21, s21, s22
 s_bfe_u32 s22, s2, 0x10001
 s_lshl_b32 s22, s22, 14
 s_add_u32 s21, s21, s22
 s_and_b32 s22, s2, 1
 s_mul_i32 s22, s22, 3
 s_add_u32 s22, s22, s20
 s_lshl_b32 s22, s22, 10
 s_add_u32 s21, s21, s22
 s_cmp_lt_u32 s20, 3
 s_cselect_b32 s21, s21, 0x80000000
 buffer_store_dwordx4 v[4:7], v9, s[16:19], s21 offen sc1
 s_mul_i32 s23, s20, 540672
 s_lshl_b32 s21, s2, 11
 s_add_u32 s21, s21, s23
 s_add_u32 s21, s21, 81920
 buffer_store_dwordx4 v[12:15], v9, s[8:11], s21 offen sc1
 buffer_store_dwordx4 v[12:15], v9, s[8:11], s21 offen offset:1024 sc1
 s_lshl_b32 s21, s2, 9
 s_add_u32 s21, s21, s23
 s_add_u32 s21, s21, 376832
 s_mov_b64 exec, 0xffffffff
 buffer_store_dwordx4 v[12:15], v9, s[8:11], s21 offen sc1
 s_mov_b64 exec, -1
 s_lshl_b32 s21, s2, 1
 s_lshr_b32 s22, s20, 1
 s_add_u32 s21, s21, s22
 s_lshl_b32 s21, s21, 20
 s_and_b32 s22, s20, 1
 s_mul_i32 s22, s22, 49152
 s_add_u32 s21, s21, s22
 s_add_u32 s21, s21, 7168
 v_mul_u32_u24 v9, 16640, v3
 v_bfe_u32 v10, v1, 3, 1
 v_lshl_add_u32 v9, v10, 13, v9
 v_and_b32 v10, 7, v1
 v_lshl_add_u32 v9, v10, 4, v9
 s_mov_b32 exec_hi, 0xffff
 buffer_store_dwordx4 v[4:7], v9, s[16:19], s21 offen sc1
 s_mov_b64 exec, -1
 s_waitcnt vmcnt(0)
 s_barrier
 s_mov_b32 s21, 76
 s_cmp_lg_u32 s20, 0
 s_cbranch_scc1 af_139
 v_mov_b32 v10, 0
 v_mov_b32 v11, 1
 s_mov_b64 exec, 1
 buffer_atomic_add v11, v10, s[32:35], s21 offen sc1
 s_mov_b64 exec, -1
 s_nop 1
af_139:
 s_load_dwordx2 s[4:5], s[0:1], 0
 s_load_dwordx2 s[6:7], s[0:1], 80
 s_load_dwordx2 s[38:39], s[0:1], 104
 s_lshl_b32 s59, s2, 2
 s_add_u32 s59, s59, s20
 s_lshl_b32 s59, s59, 4
 s_waitcnt lgkmcnt(0)
 s_mov_b32 s8, s4
 s_mov_b32 s9, s5
 s_mov_b32 s10, 2621440
 s_mov_b32 s11, 0x00020000
 s_mov_b32 s12, s6
 s_mov_b32 s13, s7
 s_mov_b32 s14, 1280
 s_mov_b32 s15, 0x00020000
 s_add_u32 s28, s38, 81002496
 s_addc_u32 s29, s39, 0
 s_mov_b32 s30, 8192
 s_mov_b32 s31, 0x00020000
 v_lshlrev_b32 v4, 2, v1
 v_lshlrev_b32 v5, 4, v1
 buffer_load_dwordx4 v[16:19], v5, s[12:15], 0 offen
 buffer_load_dword v20, v4, s[12:15], 0 offen offset:1024
 s_mul_i32 s22, s59, 1280
 buffer_load_dwordx4 v[64:67], v5, s[8:11], s22 offen
 buffer_load_dword v68, v4, s[8:11], s22 offen offset:1024
 s_add_u32 s22, s22, 1280
 buffer_load_dwordx4 v[70:73], v5, s[8:11], s22 offen
 buffer_load_dword v74, v4, s[8:11], s22 offen offset:1024
 s_add_u32 s22, s22, 1280
 buffer_load_dwordx4 v[76:79], v5, s[8:11], s22 offen
 buffer_load_dword v80, v4, s[8:11], s22 offen offset:1024
 s_add_u32 s22, s22, 1280
 buffer_load_dwordx4 v[82:85], v5, s[8:11], s22 offen
 buffer_load_dword v86, v4, s[8:11], s22 offen offset:1024
 s_add_u32 s22, s22, 1280
 buffer_load_dwordx4 v[88:91], v5, s[8:11], s22 offen
 buffer_load_dword v92, v4, s[8:11], s22 offen offset:1024
 s_add_u32 s22, s22, 1280
 buffer_load_dwordx4 v[94:97], v5, s[8:11], s22 offen
 buffer_load_dword v98, v4, s[8:11], s22 offen offset:1024
 s_add_u32 s22, s22, 1280
 buffer_load_dwordx4 v[100:103], v5, s[8:11], s22 offen
 buffer_load_dword v104, v4, s[8:11], s22 offen offset:1024
 s_add_u32 s22, s22, 1280
 buffer_load_dwordx4 v[106:109], v5, s[8:11], s22 offen
 buffer_load_dword v110, v4, s[8:11], s22 offen offset:1024
 s_add_u32 s22, s22, 1280
 buffer_load_dwordx4 v[112:115], v5, s[8:11], s22 offen
 buffer_load_dword v116, v4, s[8:11], s22 offen offset:1024
 s_add_u32 s22, s22, 1280
 buffer_load_dwordx4 v[118:121], v5, s[8:11], s22 offen
 buffer_load_dword v122, v4, s[8:11], s22 offen offset:1024
 s_add_u32 s22, s22, 1280
 buffer_load_dwordx4 v[124:127], v5, s[8:11], s22 offen
 buffer_load_dword v128, v4, s[8:11], s22 offen offset:1024
 s_add_u32 s22, s22, 1280
 buffer_load_dwordx4 v[130:133], v5, s[8:11], s22 offen
 buffer_load_dword v134, v4, s[8:11], s22 offen offset:1024
 s_add_u32 s22, s22, 1280
 buffer_load_dwordx4 v[136:139], v5, s[8:11], s22 offen
 buffer_load_dword v140, v4, s[8:11], s22 offen offset:1024
 s_add_u32 s22, s22, 1280
 buffer_load_dwordx4 v[142:145], v5, s[8:11], s22 offen
 buffer_load_dword v146, v4, s[8:11], s22 offen offset:1024
 s_add_u32 s22, s22, 1280
 buffer_load_dwordx4 v[148:151], v5, s[8:11], s22 offen
 buffer_load_dword v152, v4, s[8:11], s22 offen offset:1024
 s_add_u32 s22, s22, 1280
 buffer_load_dwordx4 v[154:157], v5, s[8:11], s22 offen
 buffer_load_dword v158, v4, s[8:11], s22 offen offset:1024
 s_add_u32 s22, s22, 1280
 s_waitcnt vmcnt(32)
 v_lshlrev_b32 v8, 16, v16
 v_and_b32 v16, 0xffff0000, v16
 v_lshlrev_b32 v9, 16, v17
 v_and_b32 v17, 0xffff0000, v17
 v_lshlrev_b32 v10, 16, v18
 v_and_b32 v18, 0xffff0000, v18
 v_lshlrev_b32 v11, 16, v19
 v_and_b32 v19, 0xffff0000, v19
 v_lshlrev_b32 v12, 16, v20
 v_and_b32 v20, 0xffff0000, v20
 s_waitcnt vmcnt(30)
 v_mov_b32 v160, 0
 v_lshlrev_b32 v25, 16, v64
 v_and_b32 v26, 0xffff0000, v64
 v_mul_f32 v25, v25, v8
 v_mul_f32 v26, v26, v16
 v_cvt_pk_bf16_f32 v25, v25, v26
 v_lshlrev_b32 v26, 16, v25
 v_and_b32 v25, 0xffff0000, v25
 v_add_f32 v160, v160, v26
 v_add_f32 v160, v160, v25
 v_lshlrev_b32 v25, 16, v65
 v_and_b32 v26, 0xffff0000, v65
 v_mul_f32 v25, v25, v9
 v_mul_f32 v26, v26, v17
 v_cvt_pk_bf16_f32 v25, v25, v26
 v_lshlrev_b32 v26, 16, v25
 v_and_b32 v25, 0xffff0000, v25
 v_add_f32 v160, v160, v26
 v_add_f32 v160, v160, v25
 v_lshlrev_b32 v25, 16, v66
 v_and_b32 v26, 0xffff0000, v66
 v_mul_f32 v25, v25, v10
 v_mul_f32 v26, v26, v18
 v_cvt_pk_bf16_f32 v25, v25, v26
 v_lshlrev_b32 v26, 16, v25
 v_and_b32 v25, 0xffff0000, v25
 v_add_f32 v160, v160, v26
 v_add_f32 v160, v160, v25
 v_lshlrev_b32 v25, 16, v67
 v_and_b32 v26, 0xffff0000, v67
 v_mul_f32 v25, v25, v11
 v_mul_f32 v26, v26, v19
 v_cvt_pk_bf16_f32 v25, v25, v26
 v_lshlrev_b32 v26, 16, v25
 v_and_b32 v25, 0xffff0000, v25
 v_add_f32 v160, v160, v26
 v_add_f32 v160, v160, v25
 v_lshlrev_b32 v25, 16, v68
 v_and_b32 v26, 0xffff0000, v68
 v_mul_f32 v25, v25, v12
 v_mul_f32 v26, v26, v20
 v_cvt_pk_bf16_f32 v25, v25, v26
 v_lshlrev_b32 v26, 16, v25
 v_and_b32 v25, 0xffff0000, v25
 v_add_f32 v160, v160, v26
 v_add_f32 v160, v160, v25
 s_waitcnt vmcnt(28)
 v_mov_b32 v161, 0
 v_lshlrev_b32 v25, 16, v70
 v_and_b32 v26, 0xffff0000, v70
 v_mul_f32 v25, v25, v8
 v_mul_f32 v26, v26, v16
 v_cvt_pk_bf16_f32 v25, v25, v26
 v_lshlrev_b32 v26, 16, v25
 v_and_b32 v25, 0xffff0000, v25
 v_add_f32 v161, v161, v26
 v_add_f32 v161, v161, v25
 v_lshlrev_b32 v25, 16, v71
 v_and_b32 v26, 0xffff0000, v71
 v_mul_f32 v25, v25, v9
 v_mul_f32 v26, v26, v17
 v_cvt_pk_bf16_f32 v25, v25, v26
 v_lshlrev_b32 v26, 16, v25
 v_and_b32 v25, 0xffff0000, v25
 v_add_f32 v161, v161, v26
 v_add_f32 v161, v161, v25
 v_lshlrev_b32 v25, 16, v72
 v_and_b32 v26, 0xffff0000, v72
 v_mul_f32 v25, v25, v10
 v_mul_f32 v26, v26, v18
 v_cvt_pk_bf16_f32 v25, v25, v26
 v_lshlrev_b32 v26, 16, v25
 v_and_b32 v25, 0xffff0000, v25
 v_add_f32 v161, v161, v26
 v_add_f32 v161, v161, v25
 v_lshlrev_b32 v25, 16, v73
 v_and_b32 v26, 0xffff0000, v73
 v_mul_f32 v25, v25, v11
 v_mul_f32 v26, v26, v19
 v_cvt_pk_bf16_f32 v25, v25, v26
 v_lshlrev_b32 v26, 16, v25
 v_and_b32 v25, 0xffff0000, v25
 v_add_f32 v161, v161, v26
 v_add_f32 v161, v161, v25
 v_lshlrev_b32 v25, 16, v74
 v_and_b32 v26, 0xffff0000, v74
 v_mul_f32 v25, v25, v12
 v_mul_f32 v26, v26, v20
 v_cvt_pk_bf16_f32 v25, v25, v26
 v_lshlrev_b32 v26, 16, v25
 v_and_b32 v25, 0xffff0000, v25
 v_add_f32 v161, v161, v26
 v_add_f32 v161, v161, v25
 s_waitcnt vmcnt(26)
 v_mov_b32 v162, 0
 v_lshlrev_b32 v25, 16, v76
 v_and_b32 v26, 0xffff0000, v76
 v_mul_f32 v25, v25, v8
 v_mul_f32 v26, v26, v16
 v_cvt_pk_bf16_f32 v25, v25, v26
 v_lshlrev_b32 v26, 16, v25
 v_and_b32 v25, 0xffff0000, v25
 v_add_f32 v162, v162, v26
 v_add_f32 v162, v162, v25
 v_lshlrev_b32 v25, 16, v77
 v_and_b32 v26, 0xffff0000, v77
 v_mul_f32 v25, v25, v9
 v_mul_f32 v26, v26, v17
 v_cvt_pk_bf16_f32 v25, v25, v26
 v_lshlrev_b32 v26, 16, v25
 v_and_b32 v25, 0xffff0000, v25
 v_add_f32 v162, v162, v26
 v_add_f32 v162, v162, v25
 v_lshlrev_b32 v25, 16, v78
 v_and_b32 v26, 0xffff0000, v78
 v_mul_f32 v25, v25, v10
 v_mul_f32 v26, v26, v18
 v_cvt_pk_bf16_f32 v25, v25, v26
 v_lshlrev_b32 v26, 16, v25
 v_and_b32 v25, 0xffff0000, v25
 v_add_f32 v162, v162, v26
 v_add_f32 v162, v162, v25
 v_lshlrev_b32 v25, 16, v79
 v_and_b32 v26, 0xffff0000, v79
 v_mul_f32 v25, v25, v11
 v_mul_f32 v26, v26, v19
 v_cvt_pk_bf16_f32 v25, v25, v26
 v_lshlrev_b32 v26, 16, v25
 v_and_b32 v25, 0xffff0000, v25
 v_add_f32 v162, v162, v26
 v_add_f32 v162, v162, v25
 v_lshlrev_b32 v25, 16, v80
 v_and_b32 v26, 0xffff0000, v80
 v_mul_f32 v25, v25, v12
 v_mul_f32 v26, v26, v20
 v_cvt_pk_bf16_f32 v25, v25, v26
 v_lshlrev_b32 v26, 16, v25
 v_and_b32 v25, 0xffff0000, v25
 v_add_f32 v162, v162, v26
 v_add_f32 v162, v162, v25
 s_waitcnt vmcnt(24)
 v_mov_b32 v163, 0
 v_lshlrev_b32 v25, 16, v82
 v_and_b32 v26, 0xffff0000, v82
 v_mul_f32 v25, v25, v8
 v_mul_f32 v26, v26, v16
 v_cvt_pk_bf16_f32 v25, v25, v26
 v_lshlrev_b32 v26, 16, v25
 v_and_b32 v25, 0xffff0000, v25
 v_add_f32 v163, v163, v26
 v_add_f32 v163, v163, v25
 v_lshlrev_b32 v25, 16, v83
 v_and_b32 v26, 0xffff0000, v83
 v_mul_f32 v25, v25, v9
 v_mul_f32 v26, v26, v17
 v_cvt_pk_bf16_f32 v25, v25, v26
 v_lshlrev_b32 v26, 16, v25
 v_and_b32 v25, 0xffff0000, v25
 v_add_f32 v163, v163, v26
 v_add_f32 v163, v163, v25
 v_lshlrev_b32 v25, 16, v84
 v_and_b32 v26, 0xffff0000, v84
 v_mul_f32 v25, v25, v10
 v_mul_f32 v26, v26, v18
 v_cvt_pk_bf16_f32 v25, v25, v26
 v_lshlrev_b32 v26, 16, v25
 v_and_b32 v25, 0xffff0000, v25
 v_add_f32 v163, v163, v26
 v_add_f32 v163, v163, v25
 v_lshlrev_b32 v25, 16, v85
 v_and_b32 v26, 0xffff0000, v85
 v_mul_f32 v25, v25, v11
 v_mul_f32 v26, v26, v19
 v_cvt_pk_bf16_f32 v25, v25, v26
 v_lshlrev_b32 v26, 16, v25
 v_and_b32 v25, 0xffff0000, v25
 v_add_f32 v163, v163, v26
 v_add_f32 v163, v163, v25
 v_lshlrev_b32 v25, 16, v86
 v_and_b32 v26, 0xffff0000, v86
 v_mul_f32 v25, v25, v12
 v_mul_f32 v26, v26, v20
 v_cvt_pk_bf16_f32 v25, v25, v26
 v_lshlrev_b32 v26, 16, v25
 v_and_b32 v25, 0xffff0000, v25
 v_add_f32 v163, v163, v26
 v_add_f32 v163, v163, v25
 s_waitcnt vmcnt(22)
 v_mov_b32 v164, 0
 v_lshlrev_b32 v25, 16, v88
 v_and_b32 v26, 0xffff0000, v88
 v_mul_f32 v25, v25, v8
 v_mul_f32 v26, v26, v16
 v_cvt_pk_bf16_f32 v25, v25, v26
 v_lshlrev_b32 v26, 16, v25
 v_and_b32 v25, 0xffff0000, v25
 v_add_f32 v164, v164, v26
 v_add_f32 v164, v164, v25
 v_lshlrev_b32 v25, 16, v89
 v_and_b32 v26, 0xffff0000, v89
 v_mul_f32 v25, v25, v9
 v_mul_f32 v26, v26, v17
 v_cvt_pk_bf16_f32 v25, v25, v26
 v_lshlrev_b32 v26, 16, v25
 v_and_b32 v25, 0xffff0000, v25
 v_add_f32 v164, v164, v26
 v_add_f32 v164, v164, v25
 v_lshlrev_b32 v25, 16, v90
 v_and_b32 v26, 0xffff0000, v90
 v_mul_f32 v25, v25, v10
 v_mul_f32 v26, v26, v18
 v_cvt_pk_bf16_f32 v25, v25, v26
 v_lshlrev_b32 v26, 16, v25
 v_and_b32 v25, 0xffff0000, v25
 v_add_f32 v164, v164, v26
 v_add_f32 v164, v164, v25
 v_lshlrev_b32 v25, 16, v91
 v_and_b32 v26, 0xffff0000, v91
 v_mul_f32 v25, v25, v11
 v_mul_f32 v26, v26, v19
 v_cvt_pk_bf16_f32 v25, v25, v26
 v_lshlrev_b32 v26, 16, v25
 v_and_b32 v25, 0xffff0000, v25
 v_add_f32 v164, v164, v26
 v_add_f32 v164, v164, v25
 v_lshlrev_b32 v25, 16, v92
 v_and_b32 v26, 0xffff0000, v92
 v_mul_f32 v25, v25, v12
 v_mul_f32 v26, v26, v20
 v_cvt_pk_bf16_f32 v25, v25, v26
 v_lshlrev_b32 v26, 16, v25
 v_and_b32 v25, 0xffff0000, v25
 v_add_f32 v164, v164, v26
 v_add_f32 v164, v164, v25
 s_waitcnt vmcnt(20)
 v_mov_b32 v165, 0
 v_lshlrev_b32 v25, 16, v94
 v_and_b32 v26, 0xffff0000, v94
 v_mul_f32 v25, v25, v8
 v_mul_f32 v26, v26, v16
 v_cvt_pk_bf16_f32 v25, v25, v26
 v_lshlrev_b32 v26, 16, v25
 v_and_b32 v25, 0xffff0000, v25
 v_add_f32 v165, v165, v26
 v_add_f32 v165, v165, v25
 v_lshlrev_b32 v25, 16, v95
 v_and_b32 v26, 0xffff0000, v95
 v_mul_f32 v25, v25, v9
 v_mul_f32 v26, v26, v17
 v_cvt_pk_bf16_f32 v25, v25, v26
 v_lshlrev_b32 v26, 16, v25
 v_and_b32 v25, 0xffff0000, v25
 v_add_f32 v165, v165, v26
 v_add_f32 v165, v165, v25
 v_lshlrev_b32 v25, 16, v96
 v_and_b32 v26, 0xffff0000, v96
 v_mul_f32 v25, v25, v10
 v_mul_f32 v26, v26, v18
 v_cvt_pk_bf16_f32 v25, v25, v26
 v_lshlrev_b32 v26, 16, v25
 v_and_b32 v25, 0xffff0000, v25
 v_add_f32 v165, v165, v26
 v_add_f32 v165, v165, v25
 v_lshlrev_b32 v25, 16, v97
 v_and_b32 v26, 0xffff0000, v97
 v_mul_f32 v25, v25, v11
 v_mul_f32 v26, v26, v19
 v_cvt_pk_bf16_f32 v25, v25, v26
 v_lshlrev_b32 v26, 16, v25
 v_and_b32 v25, 0xffff0000, v25
 v_add_f32 v165, v165, v26
 v_add_f32 v165, v165, v25
 v_lshlrev_b32 v25, 16, v98
 v_and_b32 v26, 0xffff0000, v98
 v_mul_f32 v25, v25, v12
 v_mul_f32 v26, v26, v20
 v_cvt_pk_bf16_f32 v25, v25, v26
 v_lshlrev_b32 v26, 16, v25
 v_and_b32 v25, 0xffff0000, v25
 v_add_f32 v165, v165, v26
 v_add_f32 v165, v165, v25
 s_waitcnt vmcnt(18)
 v_mov_b32 v166, 0
 v_lshlrev_b32 v25, 16, v100
 v_and_b32 v26, 0xffff0000, v100
 v_mul_f32 v25, v25, v8
 v_mul_f32 v26, v26, v16
 v_cvt_pk_bf16_f32 v25, v25, v26
 v_lshlrev_b32 v26, 16, v25
 v_and_b32 v25, 0xffff0000, v25
 v_add_f32 v166, v166, v26
 v_add_f32 v166, v166, v25
 v_lshlrev_b32 v25, 16, v101
 v_and_b32 v26, 0xffff0000, v101
 v_mul_f32 v25, v25, v9
 v_mul_f32 v26, v26, v17
 v_cvt_pk_bf16_f32 v25, v25, v26
 v_lshlrev_b32 v26, 16, v25
 v_and_b32 v25, 0xffff0000, v25
 v_add_f32 v166, v166, v26
 v_add_f32 v166, v166, v25
 v_lshlrev_b32 v25, 16, v102
 v_and_b32 v26, 0xffff0000, v102
 v_mul_f32 v25, v25, v10
 v_mul_f32 v26, v26, v18
 v_cvt_pk_bf16_f32 v25, v25, v26
 v_lshlrev_b32 v26, 16, v25
 v_and_b32 v25, 0xffff0000, v25
 v_add_f32 v166, v166, v26
 v_add_f32 v166, v166, v25
 v_lshlrev_b32 v25, 16, v103
 v_and_b32 v26, 0xffff0000, v103
 v_mul_f32 v25, v25, v11
 v_mul_f32 v26, v26, v19
 v_cvt_pk_bf16_f32 v25, v25, v26
 v_lshlrev_b32 v26, 16, v25
 v_and_b32 v25, 0xffff0000, v25
 v_add_f32 v166, v166, v26
 v_add_f32 v166, v166, v25
 v_lshlrev_b32 v25, 16, v104
 v_and_b32 v26, 0xffff0000, v104
 v_mul_f32 v25, v25, v12
 v_mul_f32 v26, v26, v20
 v_cvt_pk_bf16_f32 v25, v25, v26
 v_lshlrev_b32 v26, 16, v25
 v_and_b32 v25, 0xffff0000, v25
 v_add_f32 v166, v166, v26
 v_add_f32 v166, v166, v25
 s_waitcnt vmcnt(16)
 v_mov_b32 v167, 0
 v_lshlrev_b32 v25, 16, v106
 v_and_b32 v26, 0xffff0000, v106
 v_mul_f32 v25, v25, v8
 v_mul_f32 v26, v26, v16
 v_cvt_pk_bf16_f32 v25, v25, v26
 v_lshlrev_b32 v26, 16, v25
 v_and_b32 v25, 0xffff0000, v25
 v_add_f32 v167, v167, v26
 v_add_f32 v167, v167, v25
 v_lshlrev_b32 v25, 16, v107
 v_and_b32 v26, 0xffff0000, v107
 v_mul_f32 v25, v25, v9
 v_mul_f32 v26, v26, v17
 v_cvt_pk_bf16_f32 v25, v25, v26
 v_lshlrev_b32 v26, 16, v25
 v_and_b32 v25, 0xffff0000, v25
 v_add_f32 v167, v167, v26
 v_add_f32 v167, v167, v25
 v_lshlrev_b32 v25, 16, v108
 v_and_b32 v26, 0xffff0000, v108
 v_mul_f32 v25, v25, v10
 v_mul_f32 v26, v26, v18
 v_cvt_pk_bf16_f32 v25, v25, v26
 v_lshlrev_b32 v26, 16, v25
 v_and_b32 v25, 0xffff0000, v25
 v_add_f32 v167, v167, v26
 v_add_f32 v167, v167, v25
 v_lshlrev_b32 v25, 16, v109
 v_and_b32 v26, 0xffff0000, v109
 v_mul_f32 v25, v25, v11
 v_mul_f32 v26, v26, v19
 v_cvt_pk_bf16_f32 v25, v25, v26
 v_lshlrev_b32 v26, 16, v25
 v_and_b32 v25, 0xffff0000, v25
 v_add_f32 v167, v167, v26
 v_add_f32 v167, v167, v25
 v_lshlrev_b32 v25, 16, v110
 v_and_b32 v26, 0xffff0000, v110
 v_mul_f32 v25, v25, v12
 v_mul_f32 v26, v26, v20
 v_cvt_pk_bf16_f32 v25, v25, v26
 v_lshlrev_b32 v26, 16, v25
 v_and_b32 v25, 0xffff0000, v25
 v_add_f32 v167, v167, v26
 v_add_f32 v167, v167, v25
 s_waitcnt vmcnt(14)
 v_mov_b32 v168, 0
 v_lshlrev_b32 v25, 16, v112
 v_and_b32 v26, 0xffff0000, v112
 v_mul_f32 v25, v25, v8
 v_mul_f32 v26, v26, v16
 v_cvt_pk_bf16_f32 v25, v25, v26
 v_lshlrev_b32 v26, 16, v25
 v_and_b32 v25, 0xffff0000, v25
 v_add_f32 v168, v168, v26
 v_add_f32 v168, v168, v25
 v_lshlrev_b32 v25, 16, v113
 v_and_b32 v26, 0xffff0000, v113
 v_mul_f32 v25, v25, v9
 v_mul_f32 v26, v26, v17
 v_cvt_pk_bf16_f32 v25, v25, v26
 v_lshlrev_b32 v26, 16, v25
 v_and_b32 v25, 0xffff0000, v25
 v_add_f32 v168, v168, v26
 v_add_f32 v168, v168, v25
 v_lshlrev_b32 v25, 16, v114
 v_and_b32 v26, 0xffff0000, v114
 v_mul_f32 v25, v25, v10
 v_mul_f32 v26, v26, v18
 v_cvt_pk_bf16_f32 v25, v25, v26
 v_lshlrev_b32 v26, 16, v25
 v_and_b32 v25, 0xffff0000, v25
 v_add_f32 v168, v168, v26
 v_add_f32 v168, v168, v25
 v_lshlrev_b32 v25, 16, v115
 v_and_b32 v26, 0xffff0000, v115
 v_mul_f32 v25, v25, v11
 v_mul_f32 v26, v26, v19
 v_cvt_pk_bf16_f32 v25, v25, v26
 v_lshlrev_b32 v26, 16, v25
 v_and_b32 v25, 0xffff0000, v25
 v_add_f32 v168, v168, v26
 v_add_f32 v168, v168, v25
 v_lshlrev_b32 v25, 16, v116
 v_and_b32 v26, 0xffff0000, v116
 v_mul_f32 v25, v25, v12
 v_mul_f32 v26, v26, v20
 v_cvt_pk_bf16_f32 v25, v25, v26
 v_lshlrev_b32 v26, 16, v25
 v_and_b32 v25, 0xffff0000, v25
 v_add_f32 v168, v168, v26
 v_add_f32 v168, v168, v25
 s_waitcnt vmcnt(12)
 v_mov_b32 v169, 0
 v_lshlrev_b32 v25, 16, v118
 v_and_b32 v26, 0xffff0000, v118
 v_mul_f32 v25, v25, v8
 v_mul_f32 v26, v26, v16
 v_cvt_pk_bf16_f32 v25, v25, v26
 v_lshlrev_b32 v26, 16, v25
 v_and_b32 v25, 0xffff0000, v25
 v_add_f32 v169, v169, v26
 v_add_f32 v169, v169, v25
 v_lshlrev_b32 v25, 16, v119
 v_and_b32 v26, 0xffff0000, v119
 v_mul_f32 v25, v25, v9
 v_mul_f32 v26, v26, v17
 v_cvt_pk_bf16_f32 v25, v25, v26
 v_lshlrev_b32 v26, 16, v25
 v_and_b32 v25, 0xffff0000, v25
 v_add_f32 v169, v169, v26
 v_add_f32 v169, v169, v25
 v_lshlrev_b32 v25, 16, v120
 v_and_b32 v26, 0xffff0000, v120
 v_mul_f32 v25, v25, v10
 v_mul_f32 v26, v26, v18
 v_cvt_pk_bf16_f32 v25, v25, v26
 v_lshlrev_b32 v26, 16, v25
 v_and_b32 v25, 0xffff0000, v25
 v_add_f32 v169, v169, v26
 v_add_f32 v169, v169, v25
 v_lshlrev_b32 v25, 16, v121
 v_and_b32 v26, 0xffff0000, v121
 v_mul_f32 v25, v25, v11
 v_mul_f32 v26, v26, v19
 v_cvt_pk_bf16_f32 v25, v25, v26
 v_lshlrev_b32 v26, 16, v25
 v_and_b32 v25, 0xffff0000, v25
 v_add_f32 v169, v169, v26
 v_add_f32 v169, v169, v25
 v_lshlrev_b32 v25, 16, v122
 v_and_b32 v26, 0xffff0000, v122
 v_mul_f32 v25, v25, v12
 v_mul_f32 v26, v26, v20
 v_cvt_pk_bf16_f32 v25, v25, v26
 v_lshlrev_b32 v26, 16, v25
 v_and_b32 v25, 0xffff0000, v25
 v_add_f32 v169, v169, v26
 v_add_f32 v169, v169, v25
 s_waitcnt vmcnt(10)
 v_mov_b32 v170, 0
 v_lshlrev_b32 v25, 16, v124
 v_and_b32 v26, 0xffff0000, v124
 v_mul_f32 v25, v25, v8
 v_mul_f32 v26, v26, v16
 v_cvt_pk_bf16_f32 v25, v25, v26
 v_lshlrev_b32 v26, 16, v25
 v_and_b32 v25, 0xffff0000, v25
 v_add_f32 v170, v170, v26
 v_add_f32 v170, v170, v25
 v_lshlrev_b32 v25, 16, v125
 v_and_b32 v26, 0xffff0000, v125
 v_mul_f32 v25, v25, v9
 v_mul_f32 v26, v26, v17
 v_cvt_pk_bf16_f32 v25, v25, v26
 v_lshlrev_b32 v26, 16, v25
 v_and_b32 v25, 0xffff0000, v25
 v_add_f32 v170, v170, v26
 v_add_f32 v170, v170, v25
 v_lshlrev_b32 v25, 16, v126
 v_and_b32 v26, 0xffff0000, v126
 v_mul_f32 v25, v25, v10
 v_mul_f32 v26, v26, v18
 v_cvt_pk_bf16_f32 v25, v25, v26
 v_lshlrev_b32 v26, 16, v25
 v_and_b32 v25, 0xffff0000, v25
 v_add_f32 v170, v170, v26
 v_add_f32 v170, v170, v25
 v_lshlrev_b32 v25, 16, v127
 v_and_b32 v26, 0xffff0000, v127
 v_mul_f32 v25, v25, v11
 v_mul_f32 v26, v26, v19
 v_cvt_pk_bf16_f32 v25, v25, v26
 v_lshlrev_b32 v26, 16, v25
 v_and_b32 v25, 0xffff0000, v25
 v_add_f32 v170, v170, v26
 v_add_f32 v170, v170, v25
 v_lshlrev_b32 v25, 16, v128
 v_and_b32 v26, 0xffff0000, v128
 v_mul_f32 v25, v25, v12
 v_mul_f32 v26, v26, v20
 v_cvt_pk_bf16_f32 v25, v25, v26
 v_lshlrev_b32 v26, 16, v25
 v_and_b32 v25, 0xffff0000, v25
 v_add_f32 v170, v170, v26
 v_add_f32 v170, v170, v25
 s_waitcnt vmcnt(8)
 v_mov_b32 v171, 0
 v_lshlrev_b32 v25, 16, v130
 v_and_b32 v26, 0xffff0000, v130
 v_mul_f32 v25, v25, v8
 v_mul_f32 v26, v26, v16
 v_cvt_pk_bf16_f32 v25, v25, v26
 v_lshlrev_b32 v26, 16, v25
 v_and_b32 v25, 0xffff0000, v25
 v_add_f32 v171, v171, v26
 v_add_f32 v171, v171, v25
 v_lshlrev_b32 v25, 16, v131
 v_and_b32 v26, 0xffff0000, v131
 v_mul_f32 v25, v25, v9
 v_mul_f32 v26, v26, v17
 v_cvt_pk_bf16_f32 v25, v25, v26
 v_lshlrev_b32 v26, 16, v25
 v_and_b32 v25, 0xffff0000, v25
 v_add_f32 v171, v171, v26
 v_add_f32 v171, v171, v25
 v_lshlrev_b32 v25, 16, v132
 v_and_b32 v26, 0xffff0000, v132
 v_mul_f32 v25, v25, v10
 v_mul_f32 v26, v26, v18
 v_cvt_pk_bf16_f32 v25, v25, v26
 v_lshlrev_b32 v26, 16, v25
 v_and_b32 v25, 0xffff0000, v25
 v_add_f32 v171, v171, v26
 v_add_f32 v171, v171, v25
 v_lshlrev_b32 v25, 16, v133
 v_and_b32 v26, 0xffff0000, v133
 v_mul_f32 v25, v25, v11
 v_mul_f32 v26, v26, v19
 v_cvt_pk_bf16_f32 v25, v25, v26
 v_lshlrev_b32 v26, 16, v25
 v_and_b32 v25, 0xffff0000, v25
 v_add_f32 v171, v171, v26
 v_add_f32 v171, v171, v25
 v_lshlrev_b32 v25, 16, v134
 v_and_b32 v26, 0xffff0000, v134
 v_mul_f32 v25, v25, v12
 v_mul_f32 v26, v26, v20
 v_cvt_pk_bf16_f32 v25, v25, v26
 v_lshlrev_b32 v26, 16, v25
 v_and_b32 v25, 0xffff0000, v25
 v_add_f32 v171, v171, v26
 v_add_f32 v171, v171, v25
 s_waitcnt vmcnt(6)
 v_mov_b32 v172, 0
 v_lshlrev_b32 v25, 16, v136
 v_and_b32 v26, 0xffff0000, v136
 v_mul_f32 v25, v25, v8
 v_mul_f32 v26, v26, v16
 v_cvt_pk_bf16_f32 v25, v25, v26
 v_lshlrev_b32 v26, 16, v25
 v_and_b32 v25, 0xffff0000, v25
 v_add_f32 v172, v172, v26
 v_add_f32 v172, v172, v25
 v_lshlrev_b32 v25, 16, v137
 v_and_b32 v26, 0xffff0000, v137
 v_mul_f32 v25, v25, v9
 v_mul_f32 v26, v26, v17
 v_cvt_pk_bf16_f32 v25, v25, v26
 v_lshlrev_b32 v26, 16, v25
 v_and_b32 v25, 0xffff0000, v25
 v_add_f32 v172, v172, v26
 v_add_f32 v172, v172, v25
 v_lshlrev_b32 v25, 16, v138
 v_and_b32 v26, 0xffff0000, v138
 v_mul_f32 v25, v25, v10
 v_mul_f32 v26, v26, v18
 v_cvt_pk_bf16_f32 v25, v25, v26
 v_lshlrev_b32 v26, 16, v25
 v_and_b32 v25, 0xffff0000, v25
 v_add_f32 v172, v172, v26
 v_add_f32 v172, v172, v25
 v_lshlrev_b32 v25, 16, v139
 v_and_b32 v26, 0xffff0000, v139
 v_mul_f32 v25, v25, v11
 v_mul_f32 v26, v26, v19
 v_cvt_pk_bf16_f32 v25, v25, v26
 v_lshlrev_b32 v26, 16, v25
 v_and_b32 v25, 0xffff0000, v25
 v_add_f32 v172, v172, v26
 v_add_f32 v172, v172, v25
 v_lshlrev_b32 v25, 16, v140
 v_and_b32 v26, 0xffff0000, v140
 v_mul_f32 v25, v25, v12
 v_mul_f32 v26, v26, v20
 v_cvt_pk_bf16_f32 v25, v25, v26
 v_lshlrev_b32 v26, 16, v25
 v_and_b32 v25, 0xffff0000, v25
 v_add_f32 v172, v172, v26
 v_add_f32 v172, v172, v25
 s_waitcnt vmcnt(4)
 v_mov_b32 v173, 0
 v_lshlrev_b32 v25, 16, v142
 v_and_b32 v26, 0xffff0000, v142
 v_mul_f32 v25, v25, v8
 v_mul_f32 v26, v26, v16
 v_cvt_pk_bf16_f32 v25, v25, v26
 v_lshlrev_b32 v26, 16, v25
 v_and_b32 v25, 0xffff0000, v25
 v_add_f32 v173, v173, v26
 v_add_f32 v173, v173, v25
 v_lshlrev_b32 v25, 16, v143
 v_and_b32 v26, 0xffff0000, v143
 v_mul_f32 v25, v25, v9
 v_mul_f32 v26, v26, v17
 v_cvt_pk_bf16_f32 v25, v25, v26
 v_lshlrev_b32 v26, 16, v25
 v_and_b32 v25, 0xffff0000, v25
 v_add_f32 v173, v173, v26
 v_add_f32 v173, v173, v25
 v_lshlrev_b32 v25, 16, v144
 v_and_b32 v26, 0xffff0000, v144
 v_mul_f32 v25, v25, v10
 v_mul_f32 v26, v26, v18
 v_cvt_pk_bf16_f32 v25, v25, v26
 v_lshlrev_b32 v26, 16, v25
 v_and_b32 v25, 0xffff0000, v25
 v_add_f32 v173, v173, v26
 v_add_f32 v173, v173, v25
 v_lshlrev_b32 v25, 16, v145
 v_and_b32 v26, 0xffff0000, v145
 v_mul_f32 v25, v25, v11
 v_mul_f32 v26, v26, v19
 v_cvt_pk_bf16_f32 v25, v25, v26
 v_lshlrev_b32 v26, 16, v25
 v_and_b32 v25, 0xffff0000, v25
 v_add_f32 v173, v173, v26
 v_add_f32 v173, v173, v25
 v_lshlrev_b32 v25, 16, v146
 v_and_b32 v26, 0xffff0000, v146
 v_mul_f32 v25, v25, v12
 v_mul_f32 v26, v26, v20
 v_cvt_pk_bf16_f32 v25, v25, v26
 v_lshlrev_b32 v26, 16, v25
 v_and_b32 v25, 0xffff0000, v25
 v_add_f32 v173, v173, v26
 v_add_f32 v173, v173, v25
 s_waitcnt vmcnt(2)
 v_mov_b32 v174, 0
 v_lshlrev_b32 v25, 16, v148
 v_and_b32 v26, 0xffff0000, v148
 v_mul_f32 v25, v25, v8
 v_mul_f32 v26, v26, v16
 v_cvt_pk_bf16_f32 v25, v25, v26
 v_lshlrev_b32 v26, 16, v25
 v_and_b32 v25, 0xffff0000, v25
 v_add_f32 v174, v174, v26
 v_add_f32 v174, v174, v25
 v_lshlrev_b32 v25, 16, v149
 v_and_b32 v26, 0xffff0000, v149
 v_mul_f32 v25, v25, v9
 v_mul_f32 v26, v26, v17
 v_cvt_pk_bf16_f32 v25, v25, v26
 v_lshlrev_b32 v26, 16, v25
 v_and_b32 v25, 0xffff0000, v25
 v_add_f32 v174, v174, v26
 v_add_f32 v174, v174, v25
 v_lshlrev_b32 v25, 16, v150
 v_and_b32 v26, 0xffff0000, v150
 v_mul_f32 v25, v25, v10
 v_mul_f32 v26, v26, v18
 v_cvt_pk_bf16_f32 v25, v25, v26
 v_lshlrev_b32 v26, 16, v25
 v_and_b32 v25, 0xffff0000, v25
 v_add_f32 v174, v174, v26
 v_add_f32 v174, v174, v25
 v_lshlrev_b32 v25, 16, v151
 v_and_b32 v26, 0xffff0000, v151
 v_mul_f32 v25, v25, v11
 v_mul_f32 v26, v26, v19
 v_cvt_pk_bf16_f32 v25, v25, v26
 v_lshlrev_b32 v26, 16, v25
 v_and_b32 v25, 0xffff0000, v25
 v_add_f32 v174, v174, v26
 v_add_f32 v174, v174, v25
 v_lshlrev_b32 v25, 16, v152
 v_and_b32 v26, 0xffff0000, v152
 v_mul_f32 v25, v25, v12
 v_mul_f32 v26, v26, v20
 v_cvt_pk_bf16_f32 v25, v25, v26
 v_lshlrev_b32 v26, 16, v25
 v_and_b32 v25, 0xffff0000, v25
 v_add_f32 v174, v174, v26
 v_add_f32 v174, v174, v25
 s_waitcnt vmcnt(0)
 v_mov_b32 v175, 0
 v_lshlrev_b32 v25, 16, v154
 v_and_b32 v26, 0xffff0000, v154
 v_mul_f32 v25, v25, v8
 v_mul_f32 v26, v26, v16
 v_cvt_pk_bf16_f32 v25, v25, v26
 v_lshlrev_b32 v26, 16, v25
 v_and_b32 v25, 0xffff0000, v25
 v_add_f32 v175, v175, v26
 v_add_f32 v175, v175, v25
 v_lshlrev_b32 v25, 16, v155
 v_and_b32 v26, 0xffff0000, v155
 v_mul_f32 v25, v25, v9
 v_mul_f32 v26, v26, v17
 v_cvt_pk_bf16_f32 v25, v25, v26
 v_lshlrev_b32 v26, 16, v25
 v_and_b32 v25, 0xffff0000, v25
 v_add_f32 v175, v175, v26
 v_add_f32 v175, v175, v25
 v_lshlrev_b32 v25, 16, v156
 v_and_b32 v26, 0xffff0000, v156
 v_mul_f32 v25, v25, v10
 v_mul_f32 v26, v26, v18
 v_cvt_pk_bf16_f32 v25, v25, v26
 v_lshlrev_b32 v26, 16, v25
 v_and_b32 v25, 0xffff0000, v25
 v_add_f32 v175, v175, v26
 v_add_f32 v175, v175, v25
 v_lshlrev_b32 v25, 16, v157
 v_and_b32 v26, 0xffff0000, v157
 v_mul_f32 v25, v25, v11
 v_mul_f32 v26, v26, v19
 v_cvt_pk_bf16_f32 v25, v25, v26
 v_lshlrev_b32 v26, 16, v25
 v_and_b32 v25, 0xffff0000, v25
 v_add_f32 v175, v175, v26
 v_add_f32 v175, v175, v25
 v_lshlrev_b32 v25, 16, v158
 v_and_b32 v26, 0xffff0000, v158
 v_mul_f32 v25, v25, v12
 v_mul_f32 v26, v26, v20
 v_cvt_pk_bf16_f32 v25, v25, v26
 v_lshlrev_b32 v26, 16, v25
 v_and_b32 v25, 0xffff0000, v25
 v_add_f32 v175, v175, v26
 v_add_f32 v175, v175, v25
 v_add_f32_dpp v160, v160, v160 row_ror:8 row_mask:0xf bank_mask:0xf
 v_add_f32_dpp v161, v161, v161 row_ror:8 row_mask:0xf bank_mask:0xf
 v_add_f32_dpp v162, v162, v162 row_ror:8 row_mask:0xf bank_mask:0xf
 v_add_f32_dpp v163, v163, v163 row_ror:8 row_mask:0xf bank_mask:0xf
 v_add_f32_dpp v164, v164, v164 row_ror:8 row_mask:0xf bank_mask:0xf
 v_add_f32_dpp v165, v165, v165 row_ror:8 row_mask:0xf bank_mask:0xf
 v_add_f32_dpp v166, v166, v166 row_ror:8 row_mask:0xf bank_mask:0xf
 v_add_f32_dpp v167, v167, v167 row_ror:8 row_mask:0xf bank_mask:0xf
 v_add_f32_dpp v168, v168, v168 row_ror:8 row_mask:0xf bank_mask:0xf
 v_add_f32_dpp v169, v169, v169 row_ror:8 row_mask:0xf bank_mask:0xf
 v_add_f32_dpp v170, v170, v170 row_ror:8 row_mask:0xf bank_mask:0xf
 v_add_f32_dpp v171, v171, v171 row_ror:8 row_mask:0xf bank_mask:0xf
 v_add_f32_dpp v172, v172, v172 row_ror:8 row_mask:0xf bank_mask:0xf
 v_add_f32_dpp v173, v173, v173 row_ror:8 row_mask:0xf bank_mask:0xf
 v_add_f32_dpp v174, v174, v174 row_ror:8 row_mask:0xf bank_mask:0xf
 v_add_f32_dpp v175, v175, v175 row_ror:8 row_mask:0xf bank_mask:0xf
 v_add_f32_dpp v160, v160, v160 row_ror:4 row_mask:0xf bank_mask:0xf
 v_add_f32_dpp v161, v161, v161 row_ror:4 row_mask:0xf bank_mask:0xf
 v_add_f32_dpp v162, v162, v162 row_ror:4 row_mask:0xf bank_mask:0xf
 v_add_f32_dpp v163, v163, v163 row_ror:4 row_mask:0xf bank_mask:0xf
 v_add_f32_dpp v164, v164, v164 row_ror:4 row_mask:0xf bank_mask:0xf
 v_add_f32_dpp v165, v165, v165 row_ror:4 row_mask:0xf bank_mask:0xf
 v_add_f32_dpp v166, v166, v166 row_ror:4 row_mask:0xf bank_mask:0xf
 v_add_f32_dpp v167, v167, v167 row_ror:4 row_mask:0xf bank_mask:0xf
 v_add_f32_dpp v168, v168, v168 row_ror:4 row_mask:0xf bank_mask:0xf
 v_add_f32_dpp v169, v169, v169 row_ror:4 row_mask:0xf bank_mask:0xf
 v_add_f32_dpp v170, v170, v170 row_ror:4 row_mask:0xf bank_mask:0xf
 v_add_f32_dpp v171, v171, v171 row_ror:4 row_mask:0xf bank_mask:0xf
 v_add_f32_dpp v172, v172, v172 row_ror:4 row_mask:0xf bank_mask:0xf
 v_add_f32_dpp v173, v173, v173 row_ror:4 row_mask:0xf bank_mask:0xf
 v_add_f32_dpp v174, v174, v174 row_ror:4 row_mask:0xf bank_mask:0xf
 v_add_f32_dpp v175, v175, v175 row_ror:4 row_mask:0xf bank_mask:0xf
 v_add_f32_dpp v160, v160, v160 row_ror:2 row_mask:0xf bank_mask:0xf
 v_add_f32_dpp v161, v161, v161 row_ror:2 row_mask:0xf bank_mask:0xf
 v_add_f32_dpp v162, v162, v162 row_ror:2 row_mask:0xf bank_mask:0xf
 v_add_f32_dpp v163, v163, v163 row_ror:2 row_mask:0xf bank_mask:0xf
 v_add_f32_dpp v164, v164, v164 row_ror:2 row_mask:0xf bank_mask:0xf
 v_add_f32_dpp v165, v165, v165 row_ror:2 row_mask:0xf bank_mask:0xf
 v_add_f32_dpp v166, v166, v166 row_ror:2 row_mask:0xf bank_mask:0xf
 v_add_f32_dpp v167, v167, v167 row_ror:2 row_mask:0xf bank_mask:0xf
 v_add_f32_dpp v168, v168, v168 row_ror:2 row_mask:0xf bank_mask:0xf
 v_add_f32_dpp v169, v169, v169 row_ror:2 row_mask:0xf bank_mask:0xf
 v_add_f32_dpp v170, v170, v170 row_ror:2 row_mask:0xf bank_mask:0xf
 v_add_f32_dpp v171, v171, v171 row_ror:2 row_mask:0xf bank_mask:0xf
 v_add_f32_dpp v172, v172, v172 row_ror:2 row_mask:0xf bank_mask:0xf
 v_add_f32_dpp v173, v173, v173 row_ror:2 row_mask:0xf bank_mask:0xf
 v_add_f32_dpp v174, v174, v174 row_ror:2 row_mask:0xf bank_mask:0xf
 v_add_f32_dpp v175, v175, v175 row_ror:2 row_mask:0xf bank_mask:0xf
 v_add_f32_dpp v160, v160, v160 row_ror:1 row_mask:0xf bank_mask:0xf
 v_add_f32_dpp v161, v161, v161 row_ror:1 row_mask:0xf bank_mask:0xf
 v_add_f32_dpp v162, v162, v162 row_ror:1 row_mask:0xf bank_mask:0xf
 v_add_f32_dpp v163, v163, v163 row_ror:1 row_mask:0xf bank_mask:0xf
 v_add_f32_dpp v164, v164, v164 row_ror:1 row_mask:0xf bank_mask:0xf
 v_add_f32_dpp v165, v165, v165 row_ror:1 row_mask:0xf bank_mask:0xf
 v_add_f32_dpp v166, v166, v166 row_ror:1 row_mask:0xf bank_mask:0xf
 v_add_f32_dpp v167, v167, v167 row_ror:1 row_mask:0xf bank_mask:0xf
 v_add_f32_dpp v168, v168, v168 row_ror:1 row_mask:0xf bank_mask:0xf
 v_add_f32_dpp v169, v169, v169 row_ror:1 row_mask:0xf bank_mask:0xf
 v_add_f32_dpp v170, v170, v170 row_ror:1 row_mask:0xf bank_mask:0xf
 v_add_f32_dpp v171, v171, v171 row_ror:1 row_mask:0xf bank_mask:0xf
 v_add_f32_dpp v172, v172, v172 row_ror:1 row_mask:0xf bank_mask:0xf
 v_add_f32_dpp v173, v173, v173 row_ror:1 row_mask:0xf bank_mask:0xf
 v_add_f32_dpp v174, v174, v174 row_ror:1 row_mask:0xf bank_mask:0xf
 v_add_f32_dpp v175, v175, v175 row_ror:1 row_mask:0xf bank_mask:0xf
 v_mov_b32 v192, v160
 v_mov_b32 v193, v161
 v_mov_b32 v194, v162
 v_mov_b32 v195, v163
 v_mov_b32 v196, v164
 v_mov_b32 v197, v165
 v_mov_b32 v198, v166
 v_mov_b32 v199, v167
 v_mov_b32 v200, v168
 v_mov_b32 v201, v169
 v_mov_b32 v202, v170
 v_mov_b32 v203, v171
 v_mov_b32 v204, v172
 v_mov_b32 v205, v173
 v_mov_b32 v206, v174
 v_mov_b32 v207, v175
 v_permlane32_swap_b32 v160, v192
 v_permlane32_swap_b32 v161, v193
 v_permlane32_swap_b32 v162, v194
 v_permlane32_swap_b32 v163, v195
 v_permlane32_swap_b32 v164, v196
 v_permlane32_swap_b32 v165, v197
 v_permlane32_swap_b32 v166, v198
 v_permlane32_swap_b32 v167, v199
 v_permlane32_swap_b32 v168, v200
 v_permlane32_swap_b32 v169, v201
 v_permlane32_swap_b32 v170, v202
 v_permlane32_swap_b32 v171, v203
 v_permlane32_swap_b32 v172, v204
 v_permlane32_swap_b32 v173, v205
 v_permlane32_swap_b32 v174, v206
 v_permlane32_swap_b32 v175, v207
 v_add_f32 v160, v160, v192
 v_add_f32 v161, v161, v193
 v_add_f32 v162, v162, v194
 v_add_f32 v163, v163, v195
 v_add_f32 v164, v164, v196
 v_add_f32 v165, v165, v197
 v_add_f32 v166, v166, v198
 v_add_f32 v167, v167, v199
 v_add_f32 v168, v168, v200
 v_add_f32 v169, v169, v201
 v_add_f32 v170, v170, v202
 v_add_f32 v171, v171, v203
 v_add_f32 v172, v172, v204
 v_add_f32 v173, v173, v205
 v_add_f32 v174, v174, v206
 v_add_f32 v175, v175, v207
 v_mov_b32 v192, v160
 v_mov_b32 v193, v161
 v_mov_b32 v194, v162
 v_mov_b32 v195, v163
 v_mov_b32 v196, v164
 v_mov_b32 v197, v165
 v_mov_b32 v198, v166
 v_mov_b32 v199, v167
 v_mov_b32 v200, v168
 v_mov_b32 v201, v169
 v_mov_b32 v202, v170
 v_mov_b32 v203, v171
 v_mov_b32 v204, v172
 v_mov_b32 v205, v173
 v_mov_b32 v206, v174
 v_mov_b32 v207, v175
 v_permlane16_swap_b32 v160, v192
 v_permlane16_swap_b32 v161, v193
 v_permlane16_swap_b32 v162, v194
 v_permlane16_swap_b32 v163, v195
 v_permlane16_swap_b32 v164, v196
 v_permlane16_swap_b32 v165, v197
 v_permlane16_swap_b32 v166, v198
 v_permlane16_swap_b32 v167, v199
 v_permlane16_swap_b32 v168, v200
 v_permlane16_swap_b32 v169, v201
 v_permlane16_swap_b32 v170, v202
 v_permlane16_swap_b32 v171, v203
 v_permlane16_swap_b32 v172, v204
 v_permlane16_swap_b32 v173, v205
 v_permlane16_swap_b32 v174, v206
 v_permlane16_swap_b32 v175, v207
 v_add_f32 v160, v160, v192
 v_add_f32 v161, v161, v193
 v_add_f32 v162, v162, v194
 v_add_f32 v163, v163, v195
 v_add_f32 v164, v164, v196
 v_add_f32 v165, v165, v197
 v_add_f32 v166, v166, v198
 v_add_f32 v167, v167, v199
 v_add_f32 v168, v168, v200
 v_add_f32 v169, v169, v201
 v_add_f32 v170, v170, v202
 v_add_f32 v171, v171, v203
 v_add_f32 v172, v172, v204
 v_add_f32 v173, v173, v205
 v_add_f32 v174, v174, v206
 v_add_f32 v175, v175, v207
 v_mov_b32 v24, v160
 v_cmp_eq_u32 vcc, 1, v1
 s_nop 1
 v_cndmask_b32 v24, v24, v161, vcc
 v_cmp_eq_u32 vcc, 2, v1
 s_nop 1
 v_cndmask_b32 v24, v24, v162, vcc
 v_cmp_eq_u32 vcc, 3, v1
 s_nop 1
 v_cndmask_b32 v24, v24, v163, vcc
 v_cmp_eq_u32 vcc, 4, v1
 s_nop 1
 v_cndmask_b32 v24, v24, v164, vcc
 v_cmp_eq_u32 vcc, 5, v1
 s_nop 1
 v_cndmask_b32 v24, v24, v165, vcc
 v_cmp_eq_u32 vcc, 6, v1
 s_nop 1
 v_cndmask_b32 v24, v24, v166, vcc
 v_cmp_eq_u32 vcc, 7, v1
 s_nop 1
 v_cndmask_b32 v24, v24, v167, vcc
 v_cmp_eq_u32 vcc, 8, v1
 s_nop 1
 v_cndmask_b32 v24, v24, v168, vcc
 v_cmp_eq_u32 vcc, 9, v1
 s_nop 1
 v_cndmask_b32 v24, v24, v169, vcc
 v_cmp_eq_u32 vcc, 10, v1
 s_nop 1
 v_cndmask_b32 v24, v24, v170, vcc
 v_cmp_eq_u32 vcc, 11, v1
 s_nop 1
 v_cndmask_b32 v24, v24, v171, vcc
 v_cmp_eq_u32 vcc, 12, v1
 s_nop 1
 v_cndmask_b32 v24, v24, v172, vcc
 v_cmp_eq_u32 vcc, 13, v1
 s_nop 1
 v_cndmask_b32 v24, v24, v173, vcc
 v_cmp_eq_u32 vcc, 14, v1
 s_nop 1
 v_cndmask_b32 v24, v24, v174, vcc
 v_cmp_eq_u32 vcc, 15, v1
 s_nop 1
 v_cndmask_b32 v24, v24, v175, vcc
 v_cvt_pk_bf16_f32 v25, v24, v24
 v_lshlrev_b32 v24, 16, v25
 v_mul_f32 v24, 0xbfb8aa3b, v24
 v_exp_f32 v24, v24
 s_nop 0
 v_add_f32 v24, 1.0, v24
 v_rcp_f32 v24, v24
 s_nop 0
 v_cvt_pk_bf16_f32 v25, v24, v24
 v_lshlrev_b32 v24, 16, v25
 s_lshl_b32 s21, s59, 2
 s_mov_b64 exec, 65535
 buffer_store_dword v24, v4, s[28:31], s21 offen sc1
 s_mov_b64 exec, -1
 s_load_dwordx2 s[6:7], s[0:1], 40
 s_load_dwordx2 s[38:39], s[0:1], 104
 s_waitcnt lgkmcnt(0)
 s_mov_b32 s12, s6
 s_mov_b32 s13, s7
 s_mov_b32 s14, 7864320
 s_mov_b32 s15, 0x00020000
 s_mov_b32 s16, s38
 s_mov_b32 s17, s39
 s_mov_b32 s18, 50331648
 s_mov_b32 s19, 0x00020000
 s_add_u32 s24, s38, 88080384
 s_addc_u32 s25, s39, 0
 s_mov_b32 s26, 83886080
 s_mov_b32 s27, 0x00020000
 s_load_dwordx2 s[72:73], s[0:1], 104
 s_waitcnt lgkmcnt(0)
 s_add_u32 s72, s72, 81068032
 s_addc_u32 s73, s73, 0
 s_mov_b32 s74, 129024
 s_mov_b32 s75, 0x00020000
 v_mov_b32 v29, 52429
 s_mul_i32 s21, s20, 960
 s_add_u32 s21, s21, 0
 v_add_u32 v21, s21, v1
 v_mul_u32_u24 v22, v21, v29
 v_lshrrev_b32 v22, 22, v22
 v_mul_u32_u24 v23, 80, v22
 v_sub_u32 v21, v21, v23
 v_bfe_u32 v23, v22, 3, 1
 v_and_b32 v24, 3, v22
 v_lshl_add_u32 v23, v23, 2, v24
 v_lshlrev_b32 v23, 1, v23
 v_xor_b32 v21, v21, v23
 v_cmp_gt_u32 vcc, 32, v22
 v_bfe_u32 v26, v22, 3, 2
 v_lshl_add_u32 v25, v26, 2, v24
 v_bfe_u32 v26, v22, 2, 1
 v_lshl_add_u32 v25, v26, 4, v25
 v_cndmask_b32 v25, v22, v25, vcc
 v_mul_u32_u24 v25, 1280, v25
 v_lshl_add_u32 v64, v21, 4, v25
 s_mul_i32 s21, s20, 960
 s_add_u32 s21, s21, 64
 v_add_u32 v21, s21, v1
 v_mul_u32_u24 v22, v21, v29
 v_lshrrev_b32 v22, 22, v22
 v_mul_u32_u24 v23, 80, v22
 v_sub_u32 v21, v21, v23
 v_bfe_u32 v23, v22, 3, 1
 v_and_b32 v24, 3, v22
 v_lshl_add_u32 v23, v23, 2, v24
 v_lshlrev_b32 v23, 1, v23
 v_xor_b32 v21, v21, v23
 v_cmp_gt_u32 vcc, 32, v22
 v_bfe_u32 v26, v22, 3, 2
 v_lshl_add_u32 v25, v26, 2, v24
 v_bfe_u32 v26, v22, 2, 1
 v_lshl_add_u32 v25, v26, 4, v25
 v_cndmask_b32 v25, v22, v25, vcc
 v_mul_u32_u24 v25, 1280, v25
 v_lshl_add_u32 v65, v21, 4, v25
 s_mul_i32 s21, s20, 960
 s_add_u32 s21, s21, 128
 v_add_u32 v21, s21, v1
 v_mul_u32_u24 v22, v21, v29
 v_lshrrev_b32 v22, 22, v22
 v_mul_u32_u24 v23, 80, v22
 v_sub_u32 v21, v21, v23
 v_bfe_u32 v23, v22, 3, 1
 v_and_b32 v24, 3, v22
 v_lshl_add_u32 v23, v23, 2, v24
 v_lshlrev_b32 v23, 1, v23
 v_xor_b32 v21, v21, v23
 v_cmp_gt_u32 vcc, 32, v22
 v_bfe_u32 v26, v22, 3, 2
 v_lshl_add_u32 v25, v26, 2, v24
 v_bfe_u32 v26, v22, 2, 1
 v_lshl_add_u32 v25, v26, 4, v25
 v_cndmask_b32 v25, v22, v25, vcc
 v_mul_u32_u24 v25, 1280, v25
 v_lshl_add_u32 v66, v21, 4, v25
 s_mul_i32 s21, s20, 960
 s_add_u32 s21, s21, 192
 v_add_u32 v21, s21, v1
 v_mul_u32_u24 v22, v21, v29
 v_lshrrev_b32 v22, 22, v22
 v_mul_u32_u24 v23, 80, v22
 v_sub_u32 v21, v21, v23
 v_bfe_u32 v23, v22, 3, 1
 v_and_b32 v24, 3, v22
 v_lshl_add_u32 v23, v23, 2, v24
 v_lshlrev_b32 v23, 1, v23
 v_xor_b32 v21, v21, v23
 v_cmp_gt_u32 vcc, 32, v22
 v_bfe_u32 v26, v22, 3, 2
 v_lshl_add_u32 v25, v26, 2, v24
 v_bfe_u32 v26, v22, 2, 1
 v_lshl_add_u32 v25, v26, 4, v25
 v_cndmask_b32 v25, v22, v25, vcc
 v_mul_u32_u24 v25, 1280, v25
 v_lshl_add_u32 v67, v21, 4, v25
 s_mul_i32 s21, s20, 960
 s_add_u32 s21, s21, 256
 v_add_u32 v21, s21, v1
 v_mul_u32_u24 v22, v21, v29
 v_lshrrev_b32 v22, 22, v22
 v_mul_u32_u24 v23, 80, v22
 v_sub_u32 v21, v21, v23
 v_bfe_u32 v23, v22, 3, 1
 v_and_b32 v24, 3, v22
 v_lshl_add_u32 v23, v23, 2, v24
 v_lshlrev_b32 v23, 1, v23
 v_xor_b32 v21, v21, v23
 v_cmp_gt_u32 vcc, 32, v22
 v_bfe_u32 v26, v22, 3, 2
 v_lshl_add_u32 v25, v26, 2, v24
 v_bfe_u32 v26, v22, 2, 1
 v_lshl_add_u32 v25, v26, 4, v25
 v_cndmask_b32 v25, v22, v25, vcc
 v_mul_u32_u24 v25, 1280, v25
 v_lshl_add_u32 v68, v21, 4, v25
 s_mul_i32 s21, s20, 960
 s_add_u32 s21, s21, 320
 v_add_u32 v21, s21, v1
 v_mul_u32_u24 v22, v21, v29
 v_lshrrev_b32 v22, 22, v22
 v_mul_u32_u24 v23, 80, v22
 v_sub_u32 v21, v21, v23
 v_bfe_u32 v23, v22, 3, 1
 v_and_b32 v24, 3, v22
 v_lshl_add_u32 v23, v23, 2, v24
 v_lshlrev_b32 v23, 1, v23
 v_xor_b32 v21, v21, v23
 v_cmp_gt_u32 vcc, 32, v22
 v_bfe_u32 v26, v22, 3, 2
 v_lshl_add_u32 v25, v26, 2, v24
 v_bfe_u32 v26, v22, 2, 1
 v_lshl_add_u32 v25, v26, 4, v25
 v_cndmask_b32 v25, v22, v25, vcc
 v_mul_u32_u24 v25, 1280, v25
 v_lshl_add_u32 v69, v21, 4, v25
 s_mul_i32 s21, s20, 960
 s_add_u32 s21, s21, 384
 v_add_u32 v21, s21, v1
 v_mul_u32_u24 v22, v21, v29
 v_lshrrev_b32 v22, 22, v22
 v_mul_u32_u24 v23, 80, v22
 v_sub_u32 v21, v21, v23
 v_bfe_u32 v23, v22, 3, 1
 v_and_b32 v24, 3, v22
 v_lshl_add_u32 v23, v23, 2, v24
 v_lshlrev_b32 v23, 1, v23
 v_xor_b32 v21, v21, v23
 v_cmp_gt_u32 vcc, 32, v22
 v_bfe_u32 v26, v22, 3, 2
 v_lshl_add_u32 v25, v26, 2, v24
 v_bfe_u32 v26, v22, 2, 1
 v_lshl_add_u32 v25, v26, 4, v25
 v_cndmask_b32 v25, v22, v25, vcc
 v_mul_u32_u24 v25, 1280, v25
 v_lshl_add_u32 v70, v21, 4, v25
 s_mul_i32 s21, s20, 960
 s_add_u32 s21, s21, 448
 v_add_u32 v21, s21, v1
 v_mul_u32_u24 v22, v21, v29
 v_lshrrev_b32 v22, 22, v22
 v_mul_u32_u24 v23, 80, v22
 v_sub_u32 v21, v21, v23
 v_bfe_u32 v23, v22, 3, 1
 v_and_b32 v24, 3, v22
 v_lshl_add_u32 v23, v23, 2, v24
 v_lshlrev_b32 v23, 1, v23
 v_xor_b32 v21, v21, v23
 v_cmp_gt_u32 vcc, 32, v22
 v_bfe_u32 v26, v22, 3, 2
 v_lshl_add_u32 v25, v26, 2, v24
 v_bfe_u32 v26, v22, 2, 1
 v_lshl_add_u32 v25, v26, 4, v25
 v_cndmask_b32 v25, v22, v25, vcc
 v_mul_u32_u24 v25, 1280, v25
 v_lshl_add_u32 v71, v21, 4, v25
 s_mul_i32 s21, s20, 960
 s_add_u32 s21, s21, 512
 v_add_u32 v21, s21, v1
 v_mul_u32_u24 v22, v21, v29
 v_lshrrev_b32 v22, 22, v22
 v_mul_u32_u24 v23, 80, v22
 v_sub_u32 v21, v21, v23
 v_bfe_u32 v23, v22, 3, 1
 v_and_b32 v24, 3, v22
 v_lshl_add_u32 v23, v23, 2, v24
 v_lshlrev_b32 v23, 1, v23
 v_xor_b32 v21, v21, v23
 v_cmp_gt_u32 vcc, 32, v22
 v_bfe_u32 v26, v22, 3, 2
 v_lshl_add_u32 v25, v26, 2, v24
 v_bfe_u32 v26, v22, 2, 1
 v_lshl_add_u32 v25, v26, 4, v25
 v_cndmask_b32 v25, v22, v25, vcc
 v_mul_u32_u24 v25, 1280, v25
 v_lshl_add_u32 v72, v21, 4, v25
 s_mul_i32 s21, s20, 960
 s_add_u32 s21, s21, 576
 v_add_u32 v21, s21, v1
 v_mul_u32_u24 v22, v21, v29
 v_lshrrev_b32 v22, 22, v22
 v_mul_u32_u24 v23, 80, v22
 v_sub_u32 v21, v21, v23
 v_bfe_u32 v23, v22, 3, 1
 v_and_b32 v24, 3, v22
 v_lshl_add_u32 v23, v23, 2, v24
 v_lshlrev_b32 v23, 1, v23
 v_xor_b32 v21, v21, v23
 v_cmp_gt_u32 vcc, 32, v22
 v_bfe_u32 v26, v22, 3, 2
 v_lshl_add_u32 v25, v26, 2, v24
 v_bfe_u32 v26, v22, 2, 1
 v_lshl_add_u32 v25, v26, 4, v25
 v_cndmask_b32 v25, v22, v25, vcc
 v_mul_u32_u24 v25, 1280, v25
 v_lshl_add_u32 v73, v21, 4, v25
 s_mul_i32 s21, s20, 960
 s_add_u32 s21, s21, 640
 v_add_u32 v21, s21, v1
 v_mul_u32_u24 v22, v21, v29
 v_lshrrev_b32 v22, 22, v22
 v_mul_u32_u24 v23, 80, v22
 v_sub_u32 v21, v21, v23
 v_bfe_u32 v23, v22, 3, 1
 v_and_b32 v24, 3, v22
 v_lshl_add_u32 v23, v23, 2, v24
 v_lshlrev_b32 v23, 1, v23
 v_xor_b32 v21, v21, v23
 v_cmp_gt_u32 vcc, 32, v22
 v_bfe_u32 v26, v22, 3, 2
 v_lshl_add_u32 v25, v26, 2, v24
 v_bfe_u32 v26, v22, 2, 1
 v_lshl_add_u32 v25, v26, 4, v25
 v_cndmask_b32 v25, v22, v25, vcc
 v_mul_u32_u24 v25, 1280, v25
 v_lshl_add_u32 v74, v21, 4, v25
 s_mul_i32 s21, s20, 960
 s_add_u32 s21, s21, 704
 v_add_u32 v21, s21, v1
 v_mul_u32_u24 v22, v21, v29
 v_lshrrev_b32 v22, 22, v22
 v_mul_u32_u24 v23, 80, v22
 v_sub_u32 v21, v21, v23
 v_bfe_u32 v23, v22, 3, 1
 v_and_b32 v24, 3, v22
 v_lshl_add_u32 v23, v23, 2, v24
 v_lshlrev_b32 v23, 1, v23
 v_xor_b32 v21, v21, v23
 v_cmp_gt_u32 vcc, 32, v22
 v_bfe_u32 v26, v22, 3, 2
 v_lshl_add_u32 v25, v26, 2, v24
 v_bfe_u32 v26, v22, 2, 1
 v_lshl_add_u32 v25, v26, 4, v25
 v_cndmask_b32 v25, v22, v25, vcc
 v_mul_u32_u24 v25, 1280, v25
 v_lshl_add_u32 v75, v21, 4, v25
 s_mul_i32 s21, s20, 960
 s_add_u32 s21, s21, 768
 v_add_u32 v21, s21, v1
 v_mul_u32_u24 v22, v21, v29
 v_lshrrev_b32 v22, 22, v22
 v_mul_u32_u24 v23, 80, v22
 v_sub_u32 v21, v21, v23
 v_bfe_u32 v23, v22, 3, 1
 v_and_b32 v24, 3, v22
 v_lshl_add_u32 v23, v23, 2, v24
 v_lshlrev_b32 v23, 1, v23
 v_xor_b32 v21, v21, v23
 v_cmp_gt_u32 vcc, 32, v22
 v_bfe_u32 v26, v22, 3, 2
 v_lshl_add_u32 v25, v26, 2, v24
 v_bfe_u32 v26, v22, 2, 1
 v_lshl_add_u32 v25, v26, 4, v25
 v_cndmask_b32 v25, v22, v25, vcc
 v_mul_u32_u24 v25, 1280, v25
 v_lshl_add_u32 v76, v21, 4, v25
 s_mul_i32 s21, s20, 960
 s_add_u32 s21, s21, 832
 v_add_u32 v21, s21, v1
 v_mul_u32_u24 v22, v21, v29
 v_lshrrev_b32 v22, 22, v22
 v_mul_u32_u24 v23, 80, v22
 v_sub_u32 v21, v21, v23
 v_bfe_u32 v23, v22, 3, 1
 v_and_b32 v24, 3, v22
 v_lshl_add_u32 v23, v23, 2, v24
 v_lshlrev_b32 v23, 1, v23
 v_xor_b32 v21, v21, v23
 v_cmp_gt_u32 vcc, 32, v22
 v_bfe_u32 v26, v22, 3, 2
 v_lshl_add_u32 v25, v26, 2, v24
 v_bfe_u32 v26, v22, 2, 1
 v_lshl_add_u32 v25, v26, 4, v25
 v_cndmask_b32 v25, v22, v25, vcc
 v_mul_u32_u24 v25, 1280, v25
 v_lshl_add_u32 v77, v21, 4, v25
 s_mul_i32 s21, s20, 960
 s_add_u32 s21, s21, 896
 v_add_u32 v21, s21, v1
 v_mul_u32_u24 v22, v21, v29
 v_lshrrev_b32 v22, 22, v22
 v_mul_u32_u24 v23, 80, v22
 v_sub_u32 v21, v21, v23
 v_bfe_u32 v23, v22, 3, 1
 v_and_b32 v24, 3, v22
 v_lshl_add_u32 v23, v23, 2, v24
 v_lshlrev_b32 v23, 1, v23
 v_xor_b32 v21, v21, v23
 v_cmp_gt_u32 vcc, 32, v22
 v_bfe_u32 v26, v22, 3, 2
 v_lshl_add_u32 v25, v26, 2, v24
 v_bfe_u32 v26, v22, 2, 1
 v_lshl_add_u32 v25, v26, 4, v25
 v_cndmask_b32 v25, v22, v25, vcc
 v_mul_u32_u24 v25, 1280, v25
 v_lshl_add_u32 v78, v21, 4, v25
 s_mul_i32 s40, s2, 245760
 s_add_u32 s21, s40, 0
 s_mul_i32 s22, s20, 15360
 s_add_u32 s22, s22, 0
 s_add_u32 m0, s22, 0
 s_nop 0
 buffer_load_dwordx4 v64, s[12:15], s21 offen lds
 s_add_u32 m0, s22, 1024
 s_nop 0
 buffer_load_dwordx4 v65, s[12:15], s21 offen lds
 s_add_u32 m0, s22, 2048
 s_nop 0
 buffer_load_dwordx4 v66, s[12:15], s21 offen lds
 s_add_u32 m0, s22, 3072
 s_nop 0
 buffer_load_dwordx4 v67, s[12:15], s21 offen lds
 s_add_u32 m0, s22, 4096
 s_nop 0
 buffer_load_dwordx4 v68, s[12:15], s21 offen lds
 s_add_u32 m0, s22, 5120
 s_nop 0
 buffer_load_dwordx4 v69, s[12:15], s21 offen lds
 s_add_u32 m0, s22, 6144
 s_nop 0
 buffer_load_dwordx4 v70, s[12:15], s21 offen lds
 s_add_u32 m0, s22, 7168
 s_nop 0
 buffer_load_dwordx4 v71, s[12:15], s21 offen lds
 s_add_u32 m0, s22, 8192
 s_nop 0
 buffer_load_dwordx4 v72, s[12:15], s21 offen lds
 s_add_u32 m0, s22, 9216
 s_nop 0
 buffer_load_dwordx4 v73, s[12:15], s21 offen lds
 s_add_u32 m0, s22, 10240
 s_nop 0
 buffer_load_dwordx4 v74, s[12:15], s21 offen lds
 s_add_u32 m0, s22, 11264
 s_nop 0
 buffer_load_dwordx4 v75, s[12:15], s21 offen lds
 s_add_u32 m0, s22, 12288
 s_nop 0
 buffer_load_dwordx4 v76, s[12:15], s21 offen lds
 s_add_u32 m0, s22, 13312
 s_nop 0
 buffer_load_dwordx4 v77, s[12:15], s21 offen lds
 s_add_u32 m0, s22, 14336
 s_nop 0
 buffer_load_dwordx4 v78, s[12:15], s21 offen lds
 s_add_u32 s21, s40, 61440
 s_mul_i32 s22, s20, 15360
 s_add_u32 s22, s22, 61440
 s_add_u32 m0, s22, 0
 s_nop 0
 buffer_load_dwordx4 v64, s[12:15], s21 offen lds
 s_add_u32 m0, s22, 1024
 s_nop 0
 buffer_load_dwordx4 v65, s[12:15], s21 offen lds
 s_add_u32 m0, s22, 2048
 s_nop 0
 buffer_load_dwordx4 v66, s[12:15], s21 offen lds
 s_add_u32 m0, s22, 3072
 s_nop 0
 buffer_load_dwordx4 v67, s[12:15], s21 offen lds
 s_add_u32 m0, s22, 4096
 s_nop 0
 buffer_load_dwordx4 v68, s[12:15], s21 offen lds
 s_add_u32 m0, s22, 5120
 s_nop 0
 buffer_load_dwordx4 v69, s[12:15], s21 offen lds
 s_add_u32 m0, s22, 6144
 s_nop 0
 buffer_load_dwordx4 v70, s[12:15], s21 offen lds
 s_add_u32 m0, s22, 7168
 s_nop 0
 buffer_load_dwordx4 v71, s[12:15], s21 offen lds
 s_add_u32 m0, s22, 8192
 s_nop 0
 buffer_load_dwordx4 v72, s[12:15], s21 offen lds
 s_add_u32 m0, s22, 9216
 s_nop 0
 buffer_load_dwordx4 v73, s[12:15], s21 offen lds
 s_add_u32 m0, s22, 10240
 s_nop 0
 buffer_load_dwordx4 v74, s[12:15], s21 offen lds
 s_add_u32 m0, s22, 11264
 s_nop 0
 buffer_load_dwordx4 v75, s[12:15], s21 offen lds
 s_add_u32 m0, s22, 12288
 s_nop 0
 buffer_load_dwordx4 v76, s[12:15], s21 offen lds
 s_add_u32 m0, s22, 13312
 s_nop 0
 buffer_load_dwordx4 v77, s[12:15], s21 offen lds
 s_add_u32 m0, s22, 14336
 s_nop 0
 buffer_load_dwordx4 v78, s[12:15], s21 offen lds
 s_add_u32 s21, s40, 122880
 s_mul_i32 s22, s20, 15360
 s_add_u32 s22, s22, 0
 buffer_load_dwordx4 v[80:83], v64, s[12:15], s21 offen
 buffer_load_dwordx4 v[84:87], v65, s[12:15], s21 offen
 buffer_load_dwordx4 v[88:91], v66, s[12:15], s21 offen
 buffer_load_dwordx4 v[92:95], v67, s[12:15], s21 offen
 buffer_load_dwordx4 v[96:99], v68, s[12:15], s21 offen
 buffer_load_dwordx4 v[100:103], v69, s[12:15], s21 offen
 buffer_load_dwordx4 v[104:107], v70, s[12:15], s21 offen
 buffer_load_dwordx4 v[108:111], v71, s[12:15], s21 offen
 buffer_load_dwordx4 v[112:115], v72, s[12:15], s21 offen
 buffer_load_dwordx4 v[116:119], v73, s[12:15], s21 offen
 buffer_load_dwordx4 v[120:123], v74, s[12:15], s21 offen
 buffer_load_dwordx4 v[124:127], v75, s[12:15], s21 offen
 buffer_load_dwordx4 v[128:131], v76, s[12:15], s21 offen
 buffer_load_dwordx4 v[132:135], v77, s[12:15], s21 offen
 buffer_load_dwordx4 v[136:139], v78, s[12:15], s21 offen
 s_add_u32 s21, s40, 184320
 s_mul_i32 s22, s20, 15360
 s_add_u32 s22, s22, 61440
 buffer_load_dwordx4 v[140:143], v64, s[12:15], s21 offen
 buffer_load_dwordx4 v[144:147], v65, s[12:15], s21 offen
 buffer_load_dwordx4 v[148:151], v66, s[12:15], s21 offen
 buffer_load_dwordx4 v[152:155], v67, s[12:15], s21 offen
 buffer_load_dwordx4 v[156:159], v68, s[12:15], s21 offen
 buffer_load_dwordx4 v[160:163], v69, s[12:15], s21 offen
 buffer_load_dwordx4 v[164:167], v70, s[12:15], s21 offen
 buffer_load_dwordx4 v[168:171], v71, s[12:15], s21 offen
 buffer_load_dwordx4 v[172:175], v72, s[12:15], s21 offen
 buffer_load_dwordx4 v[176:179], v73, s[12:15], s21 offen
 buffer_load_dwordx4 v[180:183], v74, s[12:15], s21 offen
 buffer_load_dwordx4 v[184:187], v75, s[12:15], s21 offen
 buffer_load_dwordx4 v[188:191], v76, s[12:15], s21 offen
 buffer_load_dwordx4 v[192:195], v77, s[12:15], s21 offen
 buffer_load_dwordx4 v[196:199], v78, s[12:15], s21 offen
 v_lshrrev_b32 v6, 2, v2
 v_lshl_add_u32 v7, v3, 3, v6
 v_mul_u32_u24 v7, 1280, v7
 v_and_b32 v8, 1, v2
 v_lshl_add_u32 v7, v8, 3, v7
 v_and_b32 v8, 1, v3
 v_lshl_add_u32 v6, v8, 2, v6
 v_lshlrev_b32 v6, 1, v6
 v_bfe_u32 v8, v2, 1, 1
 s_mul_i32 s21, s20, 20
 v_add_u32 v8, s21, v8
 v_add_u32 v5, 0, v8
 v_xor_b32 v5, v5, v6
 v_lshl_add_u32 v200, v5, 4, v7
 v_add_u32 v210, 81920, v200
 v_add_u32 v5, 2, v8
 v_xor_b32 v5, v5, v6
 v_lshl_add_u32 v201, v5, 4, v7
 v_add_u32 v211, 81920, v201
 v_add_u32 v5, 4, v8
 v_xor_b32 v5, v5, v6
 v_lshl_add_u32 v202, v5, 4, v7
 v_add_u32 v212, 81920, v202
 v_add_u32 v5, 6, v8
 v_xor_b32 v5, v5, v6
 v_lshl_add_u32 v203, v5, 4, v7
 v_add_u32 v213, 81920, v203
 v_add_u32 v5, 8, v8
 v_xor_b32 v5, v5, v6
 v_lshl_add_u32 v204, v5, 4, v7
 v_add_u32 v214, 81920, v204
 v_add_u32 v5, 10, v8
 v_xor_b32 v5, v5, v6
 v_lshl_add_u32 v205, v5, 4, v7
 v_add_u32 v215, 81920, v205
 v_add_u32 v5, 12, v8
 v_xor_b32 v5, v5, v6
 v_lshl_add_u32 v206, v5, 4, v7
 v_add_u32 v216, 81920, v206
 v_add_u32 v5, 14, v8
 v_xor_b32 v5, v5, v6
 v_lshl_add_u32 v207, v5, 4, v7
 v_add_u32 v217, 81920, v207
 v_add_u32 v5, 16, v8
 v_xor_b32 v5, v5, v6
 v_lshl_add_u32 v208, v5, 4, v7
 v_add_u32 v218, 81920, v208
 v_add_u32 v5, 18, v8
 v_xor_b32 v5, v5, v6
 v_lshl_add_u32 v209, v5, 4, v7
 v_add_u32 v219, 81920, v209
 s_lshl_b32 s21, s2, 1
 s_lshr_b32 s22, s20, 1
 s_add_u32 s21, s21, s22
 s_lshl_b32 s21, s21, 20
 s_and_b32 s22, s20, 1
 s_mul_i32 s22, s22, 49152
 s_add_u32 s21, s21, s22
 s_add_u32 s21, s21, 7168
 s_add_u32 s21, s21, 181305344
 s_add_u32 s50, s38, s21
 s_addc_u32 s51, s39, 0
 s_mov_b32 s52, -1
 s_mov_b32 s53, -1
 s_mov_b32 s54, 0
cal_141:
 s_memtime s[98:99]
 s_waitcnt lgkmcnt(0)
 s_load_dword s55, s[50:51], 0
 s_waitcnt lgkmcnt(0)
 s_memtime s[100:101]
 s_waitcnt lgkmcnt(0)
 s_sub_u32 s21, s100, s98
 s_min_u32 s52, s52, s21
 s_memtime s[98:99]
 s_waitcnt lgkmcnt(0)
 s_load_dword s55, s[50:51], 8192
 s_waitcnt lgkmcnt(0)
 s_memtime s[100:101]
 s_waitcnt lgkmcnt(0)
 s_sub_u32 s21, s100, s98
 s_min_u32 s53, s53, s21
 s_add_u32 s50, s50, 16640
 s_addc_u32 s51, s51, 0
 s_add_u32 s54, s54, 1
 s_cmp_lt_u32 s54, 3
 s_cbranch_scc1 cal_141
 s_lshl_b32 s21, s20, 2
 s_add_u32 s21, s21, 160000
 v_mov_b32 v28, s21
 v_mov_b32 v24, s52
 v_mov_b32 v25, s53
 ds_write_b32 v28, v24
 ds_write_b32 v28, v25 offset:16
 s_waitcnt lgkmcnt(0)
cal_140:
 s_mul_i32 s22, s20, 15360
 v_lshl_add_u32 v30, v1, 4, s22
 v_add_u32 v31, 61440, v30
 s_waitcnt vmcnt(30)
 s_barrier
 s_cmp_lg_u32 s20, 3
 s_cbranch_scc1 cal_142
 v_mov_b32 v28, 160000
 ds_read_b128 v[20:23], v28
 ds_read_b128 v[24:27], v28 offset:16
 s_waitcnt lgkmcnt(0)
 v_min3_u32 v20, v20, v21, v22
 v_min3_u32 v24, v24, v25, v26
 v_min_u32 v25, v20, v23
 v_min_u32 v26, v24, v27
 v_cmp_lt_u32 vcc, v26, v25
 v_mov_b32 v28, s2
 s_nop 0
 v_cndmask_b32 v24, 1, 2, vcc
 s_mov_b64 exec, 1
 buffer_store_byte v24, v28, s[32:35], 0 offen offset:160 sc1
 s_mov_b64 exec, -1
cal_142:
 ds_read_b64_tr_b16 a[0:1], v200 offset:0
 ds_read_b64_tr_b16 a[2:3], v200 offset:5120
 ds_read_b64_tr_b16 a[24:25], v201 offset:0
 ds_read_b64_tr_b16 a[26:27], v201 offset:5120
 ds_read_b64_tr_b16 a[48:49], v202 offset:0
 ds_read_b64_tr_b16 a[50:51], v202 offset:5120
 ds_read_b64_tr_b16 a[72:73], v203 offset:0
 ds_read_b64_tr_b16 a[74:75], v203 offset:5120
 ds_read_b64_tr_b16 a[96:97], v204 offset:0
 ds_read_b64_tr_b16 a[98:99], v204 offset:5120
 ds_read_b64_tr_b16 a[120:121], v205 offset:0
 ds_read_b64_tr_b16 a[122:123], v205 offset:5120
 ds_read_b64_tr_b16 a[144:145], v206 offset:0
 ds_read_b64_tr_b16 a[146:147], v206 offset:5120
 ds_read_b64_tr_b16 a[168:169], v207 offset:0
 ds_read_b64_tr_b16 a[170:171], v207 offset:5120
 ds_read_b64_tr_b16 a[192:193], v208 offset:0
 ds_read_b64_tr_b16 a[194:195], v208 offset:5120
 ds_read_b64_tr_b16 a[216:217], v209 offset:0
 ds_read_b64_tr_b16 a[218:219], v209 offset:5120
 ds_read_b64_tr_b16 a[4:5], v200 offset:40960
 ds_read_b64_tr_b16 a[6:7], v200 offset:46080
 ds_read_b64_tr_b16 a[28:29], v201 offset:40960
 ds_read_b64_tr_b16 a[30:31], v201 offset:46080
 ds_read_b64_tr_b16 a[52:53], v202 offset:40960
 ds_read_b64_tr_b16 a[54:55], v202 offset:46080
 ds_read_b64_tr_b16 a[76:77], v203 offset:40960
 ds_read_b64_tr_b16 a[78:79], v203 offset:46080
 ds_read_b64_tr_b16 a[100:101], v204 offset:40960
 ds_read_b64_tr_b16 a[102:103], v204 offset:46080
 ds_read_b64_tr_b16 a[124:125], v205 offset:40960
 ds_read_b64_tr_b16 a[126:127], v205 offset:46080
 ds_read_b64_tr_b16 a[148:149], v206 offset:40960
 ds_read_b64_tr_b16 a[150:151], v206 offset:46080
 ds_read_b64_tr_b16 a[172:173], v207 offset:40960
 ds_read_b64_tr_b16 a[174:175], v207 offset:46080
 ds_read_b64_tr_b16 a[196:197], v208 offset:40960
 ds_read_b64_tr_b16 a[198:199], v208 offset:46080
 ds_read_b64_tr_b16 a[220:221], v209 offset:40960
 ds_read_b64_tr_b16 a[222:223], v209 offset:46080
 ds_read_b64_tr_b16 a[8:9], v210 offset:0
 ds_read_b64_tr_b16 a[10:11], v210 offset:5120
 ds_read_b64_tr_b16 a[32:33], v211 offset:0
 ds_read_b64_tr_b16 a[34:35], v211 offset:5120
 ds_read_b64_tr_b16 a[56:57], v212 offset:0
 ds_read_b64_tr_b16 a[58:59], v212 offset:5120
 ds_read_b64_tr_b16 a[80:81], v213 offset:0
 ds_read_b64_tr_b16 a[82:83], v213 offset:5120
 ds_read_b64_tr_b16 a[104:105], v214 offset:0
 ds_read_b64_tr_b16 a[106:107], v214 offset:5120
 ds_read_b64_tr_b16 a[128:129], v215 offset:0
 ds_read_b64_tr_b16 a[130:131], v215 offset:5120
 ds_read_b64_tr_b16 a[152:153], v216 offset:0
 ds_read_b64_tr_b16 a[154:155], v216 offset:5120
 ds_read_b64_tr_b16 a[176:177], v217 offset:0
 ds_read_b64_tr_b16 a[178:179], v217 offset:5120
 ds_read_b64_tr_b16 a[200:201], v218 offset:0
 ds_read_b64_tr_b16 a[202:203], v218 offset:5120
 ds_read_b64_tr_b16 a[224:225], v219 offset:0
 ds_read_b64_tr_b16 a[226:227], v219 offset:5120
 s_waitcnt lgkmcnt(0)
 s_barrier
 s_waitcnt vmcnt(15)
 ds_write_b128 v30, v[80:83] offset:0
 ds_write_b128 v30, v[84:87] offset:1024
 ds_write_b128 v30, v[88:91] offset:2048
 ds_write_b128 v30, v[92:95] offset:3072
 ds_write_b128 v30, v[96:99] offset:4096
 ds_write_b128 v30, v[100:103] offset:5120
 ds_write_b128 v30, v[104:107] offset:6144
 ds_write_b128 v30, v[108:111] offset:7168
 ds_write_b128 v30, v[112:115] offset:8192
 ds_write_b128 v30, v[116:119] offset:9216
 ds_write_b128 v30, v[120:123] offset:10240
 ds_write_b128 v30, v[124:127] offset:11264
 ds_write_b128 v30, v[128:131] offset:12288
 ds_write_b128 v30, v[132:135] offset:13312
 ds_write_b128 v30, v[136:139] offset:14336
 s_waitcnt vmcnt(0)
 ds_write_b128 v31, v[140:143] offset:0
 ds_write_b128 v31, v[144:147] offset:1024
 ds_write_b128 v31, v[148:151] offset:2048
 ds_write_b128 v31, v[152:155] offset:3072
 ds_write_b128 v31, v[156:159] offset:4096
 ds_write_b128 v31, v[160:163] offset:5120
 ds_write_b128 v31, v[164:167] offset:6144
 ds_write_b128 v31, v[168:171] offset:7168
 ds_write_b128 v31, v[172:175] offset:8192
 ds_write_b128 v31, v[176:179] offset:9216
 ds_write_b128 v31, v[180:183] offset:10240
 ds_write_b128 v31, v[184:187] offset:11264
 ds_write_b128 v31, v[188:191] offset:12288
 ds_write_b128 v31, v[192:195] offset:13312
 ds_write_b128 v31, v[196:199] offset:14336
 s_waitcnt lgkmcnt(0)
 s_barrier
 ds_read_b64_tr_b16 a[12:13], v200 offset:0
 ds_read_b64_tr_b16 a[14:15], v200 offset:5120
 ds_read_b64_tr_b16 a[36:37], v201 offset:0
 ds_read_b64_tr_b16 a[38:39], v201 offset:5120
 ds_read_b64_tr_b16 a[60:61], v202 offset:0
 ds_read_b64_tr_b16 a[62:63], v202 offset:5120
 ds_read_b64_tr_b16 a[84:85], v203 offset:0
 ds_read_b64_tr_b16 a[86:87], v203 offset:5120
 ds_read_b64_tr_b16 a[108:109], v204 offset:0
 ds_read_b64_tr_b16 a[110:111], v204 offset:5120
 ds_read_b64_tr_b16 a[132:133], v205 offset:0
 ds_read_b64_tr_b16 a[134:135], v205 offset:5120
 ds_read_b64_tr_b16 a[156:157], v206 offset:0
 ds_read_b64_tr_b16 a[158:159], v206 offset:5120
 ds_read_b64_tr_b16 a[180:181], v207 offset:0
 ds_read_b64_tr_b16 a[182:183], v207 offset:5120
 ds_read_b64_tr_b16 a[204:205], v208 offset:0
 ds_read_b64_tr_b16 a[206:207], v208 offset:5120
 ds_read_b64_tr_b16 a[228:229], v209 offset:0
 ds_read_b64_tr_b16 a[230:231], v209 offset:5120
 ds_read_b64_tr_b16 a[16:17], v200 offset:40960
 ds_read_b64_tr_b16 a[18:19], v200 offset:46080
 ds_read_b64_tr_b16 a[40:41], v201 offset:40960
 ds_read_b64_tr_b16 a[42:43], v201 offset:46080
 ds_read_b64_tr_b16 a[64:65], v202 offset:40960
 ds_read_b64_tr_b16 a[66:67], v202 offset:46080
 ds_read_b64_tr_b16 a[88:89], v203 offset:40960
 ds_read_b64_tr_b16 a[90:91], v203 offset:46080
 ds_read_b64_tr_b16 a[112:113], v204 offset:40960
 ds_read_b64_tr_b16 a[114:115], v204 offset:46080
 ds_read_b64_tr_b16 a[136:137], v205 offset:40960
 ds_read_b64_tr_b16 a[138:139], v205 offset:46080
 ds_read_b64_tr_b16 a[160:161], v206 offset:40960
 ds_read_b64_tr_b16 a[162:163], v206 offset:46080
 ds_read_b64_tr_b16 a[184:185], v207 offset:40960
 ds_read_b64_tr_b16 a[186:187], v207 offset:46080
 ds_read_b64_tr_b16 a[208:209], v208 offset:40960
 ds_read_b64_tr_b16 a[210:211], v208 offset:46080
 ds_read_b64_tr_b16 a[232:233], v209 offset:40960
 ds_read_b64_tr_b16 a[234:235], v209 offset:46080
 ds_read_b64_tr_b16 a[20:21], v210 offset:0
 ds_read_b64_tr_b16 a[22:23], v210 offset:5120
 ds_read_b64_tr_b16 a[44:45], v211 offset:0
 ds_read_b64_tr_b16 a[46:47], v211 offset:5120
 ds_read_b64_tr_b16 a[68:69], v212 offset:0
 ds_read_b64_tr_b16 a[70:71], v212 offset:5120
 ds_read_b64_tr_b16 a[92:93], v213 offset:0
 ds_read_b64_tr_b16 a[94:95], v213 offset:5120
 ds_read_b64_tr_b16 a[116:117], v214 offset:0
 ds_read_b64_tr_b16 a[118:119], v214 offset:5120
 ds_read_b64_tr_b16 a[140:141], v215 offset:0
 ds_read_b64_tr_b16 a[142:143], v215 offset:5120
 ds_read_b64_tr_b16 a[164:165], v216 offset:0
 ds_read_b64_tr_b16 a[166:167], v216 offset:5120
 ds_read_b64_tr_b16 a[188:189], v217 offset:0
 ds_read_b64_tr_b16 a[190:191], v217 offset:5120
 ds_read_b64_tr_b16 a[212:213], v218 offset:0
 ds_read_b64_tr_b16 a[214:215], v218 offset:5120
 ds_read_b64_tr_b16 a[236:237], v219 offset:0
 ds_read_b64_tr_b16 a[238:239], v219 offset:5120
 s_waitcnt lgkmcnt(0)
 s_barrier
 s_load_dwordx2 s[32:33], s[0:1], 96
 s_waitcnt lgkmcnt(0)
 s_mov_b32 s32, s32
 s_mov_b32 s33, s33
 s_mov_b32 s34, 256
 s_mov_b32 s35, 0x00020000
 s_mov_b32 s21, 76
 s_cmp_lg_u32 s20, 0
 s_cbranch_scc1 wf_144
 v_mov_b32 v4, 0
 s_mov_b32 s101, 0
wf_143:
 buffer_load_dword v5, v4, s[32:35], s21 offen sc1
 s_add_u32 s101, s101, 1
 s_cmp_gt_u32 s101, 131072
 s_cbranch_scc1 main_end
 s_waitcnt vmcnt(0)
 v_readfirstlane_b32 s100, v5
 s_cmp_ge_u32 s100, 32
 s_cbranch_scc1 wf_144
 s_sleep 8
 s_branch wf_143
wf_144:
 s_barrier
 s_mov_b32 s21, 91136
 s_cmp_lg_u32 s20, 0
 s_cbranch_scc1 af_145
 v_mov_b32 v4, 0
 v_mov_b32 v5, 1
 s_mov_b64 exec, 1
 buffer_atomic_add v5, v4, s[72:75], s21 offen sc1
 s_mov_b64 exec, -1
 s_nop 1
af_145:
 s_mul_i32 s41, s2, 12288
 s_add_u32 s47, s41, 25165824
 s_mov_b32 s41, s47
 s_mul_i32 s21, s20, 10
 s_mul_i32 s47, s2, 5
 s_lshr_b32 s22, s21, 3
 s_add_u32 s47, s47, s22
 s_and_b32 s48, s21, 7
 s_mov_b32 s66, 0
 s_mov_b32 s67, 0
 s_lshr_b32 s43, s2, 2
 s_lshl_b32 s43, s43, 7
 s_add_u32 s43, s43, 0
 s_lshl_b32 s44, s2, 7
 s_lshl_b32 s21, s20, 12
 s_add_u32 s44, s44, s21
 s_add_u32 s44, s44, 95232
 s_mov_b32 s45, 0
 s_mov_b32 s49, 1
 s_mov_b32 s50, 0
 v_mov_b32 v10, 0
 v_mov_b32 v11, 1
 v_lshlrev_b32 v4, 4, v1
 s_add_u32 s76, s38, 56623104
 s_addc_u32 s77, s39, 0
 s_mov_b32 s78, 6291456
 s_mov_b32 s79, 0x00020000
 s_add_u32 s80, s38, 101711872
 s_addc_u32 s81, s39, 0
 s_mov_b32 s82, 20971520
 s_mov_b32 s83, 0x00020000
 v_and_b32 v12, 3, v1
 v_lshlrev_b32 v12, 3, v12
 v_add_u32 v12, 4, v12
 v_and_b32 v13, 7, v2
 v_lshlrev_b32 v13, 4, v13
 v_lshl_add_u32 v13, v3, 7, v13
 v_lshrrev_b32 v14, 3, v2
 v_mul_u32_u24 v14, 98304, v14
 v_add_u32 v14, v14, v13
 v_and_b32 v15, 1, v3
 v_lshlrev_b32 v15, 8, v15
 v_lshl_add_u32 v15, v2, 4, v15
 v_lshrrev_b32 v16, 1, v3
 v_mul_u32_u24 v16, 327680, v16
 v_add_u32 v15, v15, v16
 v_lshlrev_b32 v17, 10, v1
 v_mov_b32 v19, 0
 s_lshl_b32 s53, s2, 7
 s_add_u32 s53, s53, 19456
 s_mov_b32 s55, 0
 s_mov_b32 s56, 0
 s_mov_b32 s58, 0
 s_mov_b32 s59, 0
 s_add_u32 s84, s38, 50331648
 s_addc_u32 s85, s39, 0
 s_mov_b32 s86, 12582912
 s_mov_b32 s87, 0x00020000
 s_and_b32 s21, s2, 3
 s_mul_i32 s51, s2, 3072
 s_cmp_eq_u32 s21, s20
 s_cselect_b32 s51, s51, 6291456
 v_mov_b32 v244, -1
 v_mov_b32 v245, -1
 v_mov_b32 v246, -1
 v_mov_b32 v247, -1
 s_add_u32 s88, s38, 180355072
 s_addc_u32 s89, s39, 0
 s_mov_b32 s90, 67108864
 s_mov_b32 s91, 0x00020000
 s_mul_i32 s21, s20, 3072
 s_add_u32 s41, s41, s21
 s_mov_b32 s64, s21
 s_add_u32 s67, s21, 98304
 s_mov_b32 s71, s21
 s_mov_b32 s46, 0
 s_mov_b32 s47, 0
 s_mov_b32 s65, 0
 s_mul_i32 s42, s2, 40960
 s_mul_i32 s21, s20, 10240
 s_add_u32 s42, s42, s21
 s_mov_b32 s68, 0x80000000
 s_mov_b32 s70, 0
 s_mov_b32 s40, 0
 s_mov_b32 s31, 0
 s_mov_b32 s56, s68
 s_mov_b32 s57, s68
 s_lshl_b32 s59, s20, 1
 s_sub_u32 s59, 8, s59
 s_add_u32 s61, s28, 9216
 v_min_u32 v5, 18, v1
 v_lshlrev_b32 v5, 10, v5
 v_mov_b32 v9, 0
 s_lshl_b32 s21, s20, 2
 s_add_u32 s21, s21, 110592
 v_mov_b32 v6, s21
 v_mov_b32 v7, 110592
 s_mul_i32 s51, s2, 3072
 s_lshl_b32 s21, s20, 10
 s_add_u32 s51, s51, s21
 s_cmp_lt_u32 s20, 3
 s_cselect_b32 s51, s51, 6291456
 s_add_u32 s51, s51, 5505024
 s_cmp_lg_u32 s20, 0
 s_cbranch_scc1 wf_147
 v_mov_b32 v20, 0
 s_mov_b32 s101, 0
wf_146:
 buffer_load_dword v21, v20, s[72:75], s43 offen sc1
 s_add_u32 s101, s101, 1
 s_cmp_gt_u32 s101, 131072
 s_cbranch_scc1 main_end
 s_waitcnt vmcnt(0)
 v_readfirstlane_b32 s100, v21
 s_cmp_ge_u32 s100, 8
 s_cbranch_scc1 wf_147
 s_sleep 4
 s_branch wf_146
wf_147:
 s_barrier
 v_writelane_b32 v9, 8, 0
 v_cmp_gt_u32 vcc, 8, v9
 s_nop 0
 s_bitset1_b64 vcc, 19
 s_ff1_i32_b64 s21, vcc
 s_lshl_b32 s22, s21, 1
 s_lshl_b32 s21, s21, 2
 s_sub_i32 s21, s21, 12
 s_max_i32 s47, s21, s22
 s_cmp_gt_u32 s47, s45
 s_cbranch_scc1 va_148
 s_mov_b32 s101, 0
 s_branch va_151
va_149:
 s_sleep 8
va_151:
 buffer_load_dword v9, v5, s[72:75], s43 offen sc1
 s_add_u32 s101, s101, 1
 s_cmp_gt_u32 s101, 131072
 s_cbranch_scc1 main_end
 s_waitcnt vmcnt(0)
 v_cmp_gt_u32 vcc, 8, v9
 s_nop 0
 s_bitset1_b64 vcc, 19
 s_ff1_i32_b64 s21, vcc
 s_lshl_b32 s22, s21, 1
 s_lshl_b32 s21, s21, 2
 s_sub_i32 s21, s21, 12
 s_max_i32 s47, s21, s22
 s_cmp_gt_u32 s47, s45
 s_cbranch_scc0 va_149
va_148:
 s_add_u32 s22, s45, 6
 s_min_u32 s22, s22, s47
va_150:
 s_cmp_ge_u32 s46, s22
 s_cbranch_scc1 va_152
 s_mov_b32 m0, s64
 s_mov_b32 s66, s41
 buffer_load_dwordx4 v4, s[16:19], s66 offen offset:0 sc1 lds
 buffer_load_dwordx4 v4, s[16:19], s66 offen offset:1024 sc1 lds
 buffer_load_dwordx4 v4, s[16:19], s66 offen offset:2048 sc1 lds
 s_add_u32 s46, s46, 1
 s_add_u32 s41, s41, 393216
 s_add_u32 s64, s64, 12288
 s_cmp_lt_u32 s64, s67
 s_cselect_b32 s64, s64, s71
 s_branch va_150
va_152:
 s_mov_b32 s48, s46
 s_mov_b32 s49, s46
 s_mov_b32 s50, s46
 s_waitcnt vmcnt(0)
 s_barrier
 v_mov_b32 v8, v4
 s_add_u32 s65, s65, 12288
 s_cmp_lt_u32 s65, 98304
 s_cselect_b32 s65, s65, 0
 ds_read_b128 v[144:147], v8 offset:0
 ds_read_b128 v[148:151], v8 offset:1024
 ds_read_b128 v[152:155], v8 offset:2048
 ds_read_b128 v[156:159], v8 offset:3072
 ds_read_b128 v[160:163], v8 offset:4096
 ds_read_b128 v[164:167], v8 offset:5120
 ds_read_b128 v[168:171], v8 offset:6144
 ds_read_b128 v[172:175], v8 offset:7168
 ds_read_b128 v[176:179], v8 offset:8192
 ds_read_b128 v[180:183], v8 offset:9216
 ds_read_b128 v[184:187], v8 offset:10240
 ds_read_b128 v[188:191], v8 offset:11264
vwl_153:
 s_waitcnt lgkmcnt(0)
 v_mfma_f32_16x16x32_bf16 v[64:67], v[144:147], a[0:3], 0
 v_cmp_gt_u32 vcc, 8, v9
 s_nop 0
 v_mfma_f32_16x16x32_bf16 v[72:75], v[144:147], a[24:27], 0
 s_bitset1_b64 vcc, 19
 s_ff1_i32_b64 s21, vcc
 v_mfma_f32_16x16x32_bf16 v[80:83], v[144:147], a[48:51], 0
 s_lshl_b32 s22, s21, 1
 s_lshl_b32 s21, s21, 2
 v_mfma_f32_16x16x32_bf16 v[88:91], v[144:147], a[72:75], 0
 s_sub_i32 s21, s21, 12
 s_max_i32 s47, s21, s22
 v_mfma_f32_16x16x32_bf16 v[96:99], v[144:147], a[96:99], 0
 s_add_u32 s22, s45, 7
 s_min_u32 s22, s22, s47
 v_mfma_f32_16x16x32_bf16 v[68:71], v[168:171], a[0:3], 0
 s_cmp_lt_u32 s46, s22
 s_cselect_b32 s66, s41, 0x80000000
 s_cselect_b32 m0, s64, 98304
 s_cselect_b32 s22, 1, 0
 v_mfma_f32_16x16x32_bf16 v[76:79], v[168:171], a[24:27], 0
 buffer_load_dwordx4 v4, s[16:19], s66 offen offset:0 sc1 lds
 v_mfma_f32_16x16x32_bf16 v[84:87], v[168:171], a[48:51], 0
 v_add_u32 v8, s65, v4
 s_add_u32 s65, s65, 12288
 v_mfma_f32_16x16x32_bf16 v[92:95], v[168:171], a[72:75], 0
 buffer_load_dwordx4 v4, s[16:19], s66 offen offset:1024 sc1 lds
 v_mfma_f32_16x16x32_bf16 v[100:103], v[168:171], a[96:99], 0
 s_cmp_lt_u32 s65, 98304
 s_cselect_b32 s65, s65, 0
 v_mfma_f32_16x16x32_bf16 v[64:67], v[148:151], a[4:7], v[64:67]
 buffer_load_dwordx4 v4, s[16:19], s66 offen offset:2048 sc1 lds
 v_mfma_f32_16x16x32_bf16 v[72:75], v[148:151], a[28:31], v[72:75]
 s_add_u32 s46, s46, s22
 s_mul_i32 s21, s22, 393216
 v_mfma_f32_16x16x32_bf16 v[80:83], v[148:151], a[52:55], v[80:83]
 s_add_u32 s41, s41, s21
 s_mul_i32 s21, s22, 12288
 v_mfma_f32_16x16x32_bf16 v[88:91], v[148:151], a[76:79], v[88:91]
 s_add_u32 s64, s64, s21
 v_cvt_pk_bf16_f32 v44, v104, v105
 v_mfma_f32_16x16x32_bf16 v[96:99], v[148:151], a[100:103], v[96:99]
 s_cmp_lt_u32 s64, s67
 s_cselect_b32 s64, s64, s71
 v_mfma_f32_16x16x32_bf16 v[68:71], v[172:175], a[4:7], v[68:71]
 v_cvt_pk_bf16_f32 v45, v106, v107
 v_cvt_pk_bf16_f32 v46, v108, v109
 v_mfma_f32_16x16x32_bf16 v[76:79], v[172:175], a[28:31], v[76:79]
 v_cvt_pk_bf16_f32 v47, v110, v111
 v_mfma_f32_16x16x32_bf16 v[84:87], v[172:175], a[52:55], v[84:87]
 s_add_u32 s69, s68, 4096
 v_mfma_f32_16x16x32_bf16 v[92:95], v[172:175], a[76:79], v[92:95]
 v_mfma_f32_16x16x32_bf16 v[100:103], v[172:175], a[100:103], v[100:103]
 buffer_store_dwordx4 v[44:47], v4, s[24:27], s69 offen offset:1024 sc1
 v_mfma_f32_16x16x32_bf16 v[64:67], v[152:155], a[8:11], v[64:67]
 v_mfma_f32_16x16x32_bf16 v[72:75], v[152:155], a[32:35], v[72:75]
 v_cvt_pk_bf16_f32 v48, v112, v113
 v_mfma_f32_16x16x32_bf16 v[80:83], v[152:155], a[56:59], v[80:83]
 v_cvt_pk_bf16_f32 v49, v114, v115
 v_mfma_f32_16x16x32_bf16 v[88:91], v[152:155], a[80:83], v[88:91]
 v_mfma_f32_16x16x32_bf16 v[96:99], v[152:155], a[104:107], v[96:99]
 v_cvt_pk_bf16_f32 v50, v116, v117
 v_mfma_f32_16x16x32_bf16 v[68:71], v[176:179], a[8:11], v[68:71]
 v_mfma_f32_16x16x32_bf16 v[76:79], v[176:179], a[32:35], v[76:79]
 v_cvt_pk_bf16_f32 v51, v118, v119
 v_mfma_f32_16x16x32_bf16 v[84:87], v[176:179], a[56:59], v[84:87]
 buffer_store_dwordx4 v[48:51], v4, s[24:27], s69 offen offset:2048 sc1
 v_mfma_f32_16x16x32_bf16 v[92:95], v[176:179], a[80:83], v[92:95]
 v_mfma_f32_16x16x32_bf16 v[100:103], v[176:179], a[104:107], v[100:103]
 v_cvt_pk_bf16_f32 v52, v120, v121
 v_mfma_f32_16x16x32_bf16 v[64:67], v[156:159], a[12:15], v[64:67]
 v_mfma_f32_16x16x32_bf16 v[72:75], v[156:159], a[36:39], v[72:75]
 v_cvt_pk_bf16_f32 v53, v122, v123
 v_mfma_f32_16x16x32_bf16 v[80:83], v[156:159], a[60:63], v[80:83]
 v_cvt_pk_bf16_f32 v54, v124, v125
 v_mfma_f32_16x16x32_bf16 v[88:91], v[156:159], a[84:87], v[88:91]
 v_mfma_f32_16x16x32_bf16 v[96:99], v[156:159], a[108:111], v[96:99]
 v_cvt_pk_bf16_f32 v55, v126, v127
 v_mfma_f32_16x16x32_bf16 v[68:71], v[180:183], a[12:15], v[68:71]
 v_mfma_f32_16x16x32_bf16 v[76:79], v[180:183], a[36:39], v[76:79]
 buffer_store_dwordx4 v[52:55], v4, s[24:27], s69 offen offset:3072 sc1
 v_mfma_f32_16x16x32_bf16 v[84:87], v[180:183], a[60:63], v[84:87]
 v_cvt_pk_bf16_f32 v56, v128, v129
 v_mfma_f32_16x16x32_bf16 v[92:95], v[180:183], a[84:87], v[92:95]
 v_mfma_f32_16x16x32_bf16 v[100:103], v[180:183], a[108:111], v[100:103]
 v_cvt_pk_bf16_f32 v57, v130, v131
 v_mfma_f32_16x16x32_bf16 v[64:67], v[160:163], a[16:19], v[64:67]
 v_mfma_f32_16x16x32_bf16 v[72:75], v[160:163], a[40:43], v[72:75]
 v_cvt_pk_bf16_f32 v58, v132, v133
 v_mfma_f32_16x16x32_bf16 v[80:83], v[160:163], a[64:67], v[80:83]
 v_cvt_pk_bf16_f32 v59, v134, v135
 v_mfma_f32_16x16x32_bf16 v[88:91], v[160:163], a[88:91], v[88:91]
 v_mfma_f32_16x16x32_bf16 v[96:99], v[160:163], a[112:115], v[96:99]
 s_add_u32 s69, s68, 8192
 v_mfma_f32_16x16x32_bf16 v[68:71], v[184:187], a[16:19], v[68:71]
 v_mfma_f32_16x16x32_bf16 v[76:79], v[184:187], a[40:43], v[76:79]
 buffer_store_dwordx4 v[56:59], v4, s[24:27], s69 offen offset:0 sc1
 v_mfma_f32_16x16x32_bf16 v[84:87], v[184:187], a[64:67], v[84:87]
 v_cvt_pk_bf16_f32 v60, v136, v137
 v_mfma_f32_16x16x32_bf16 v[92:95], v[184:187], a[88:91], v[92:95]
 v_mfma_f32_16x16x32_bf16 v[100:103], v[184:187], a[112:115], v[100:103]
 v_cvt_pk_bf16_f32 v61, v138, v139
 v_mfma_f32_16x16x32_bf16 v[64:67], v[164:167], a[20:23], v[64:67]
 v_mfma_f32_16x16x32_bf16 v[72:75], v[164:167], a[44:47], v[72:75]
 v_cvt_pk_bf16_f32 v62, v140, v141
 v_mfma_f32_16x16x32_bf16 v[80:83], v[164:167], a[68:71], v[80:83]
 v_cvt_pk_bf16_f32 v63, v142, v143
 v_mfma_f32_16x16x32_bf16 v[88:91], v[164:167], a[92:95], v[88:91]
 v_mfma_f32_16x16x32_bf16 v[96:99], v[164:167], a[116:119], v[96:99]
 buffer_store_dwordx4 v[60:63], v4, s[24:27], s69 offen offset:1024 sc1
 v_mfma_f32_16x16x32_bf16 v[68:71], v[188:191], a[20:23], v[68:71]
 v_mfma_f32_16x16x32_bf16 v[76:79], v[188:191], a[44:47], v[76:79]
 v_mfma_f32_16x16x32_bf16 v[84:87], v[188:191], a[68:71], v[84:87]
 v_mfma_f32_16x16x32_bf16 v[92:95], v[188:191], a[92:95], v[92:95]
 v_mfma_f32_16x16x32_bf16 v[100:103], v[188:191], a[116:119], v[100:103]
 v_mfma_f32_16x16x32_bf16 v[104:107], v[144:147], a[120:123], 0
 buffer_load_dword v9, v5, s[72:75], s43 offen sc1
 v_mfma_f32_16x16x32_bf16 v[112:115], v[144:147], a[144:147], 0
 v_mfma_f32_16x16x32_bf16 v[120:123], v[144:147], a[168:171], 0
 v_mfma_f32_16x16x32_bf16 v[128:131], v[144:147], a[192:195], 0
 v_cvt_pk_bf16_f32 v24, v64, v65
 v_mfma_f32_16x16x32_bf16 v[136:139], v[144:147], a[216:219], 0
 s_add_u32 s63, s45, 1
 s_min_u32 s63, s63, 63
 v_mfma_f32_16x16x32_bf16 v[108:111], v[168:171], a[120:123], 0
 s_cmp_lt_u32 s63, s46
 s_cselect_b32 s53, 1, 0
 v_mfma_f32_16x16x32_bf16 v[116:119], v[168:171], a[144:147], 0
 v_mov_b32 v21, s53
 ds_write_b32 v6, v21 offset:0
 v_mfma_f32_16x16x32_bf16 v[124:127], v[168:171], a[168:171], 0
 v_cvt_pk_bf16_f32 v25, v66, v67
 v_cvt_pk_bf16_f32 v26, v68, v69
 v_mfma_f32_16x16x32_bf16 v[132:135], v[168:171], a[192:195], 0
 v_cvt_pk_bf16_f32 v27, v70, v71
 v_mfma_f32_16x16x32_bf16 v[140:143], v[168:171], a[216:219], 0
 v_mfma_f32_16x16x32_bf16 v[104:107], v[148:151], a[124:127], v[104:107]
 buffer_store_dwordx4 v[24:27], v4, s[24:27], s42 offen offset:0 sc1
 v_mfma_f32_16x16x32_bf16 v[112:115], v[148:151], a[148:151], v[112:115]
 v_cvt_pk_bf16_f32 v28, v72, v73
 v_mfma_f32_16x16x32_bf16 v[120:123], v[148:151], a[172:175], v[120:123]
 s_cmp_eq_u32 s40, 3
 s_cbranch_scc1 vwm_157
vwm_158:
 v_mfma_f32_16x16x32_bf16 v[128:131], v[148:151], a[196:199], v[128:131]
 v_cvt_pk_bf16_f32 v29, v74, v75
 v_mfma_f32_16x16x32_bf16 v[136:139], v[148:151], a[220:223], v[136:139]
 v_mfma_f32_16x16x32_bf16 v[108:111], v[172:175], a[124:127], v[108:111]
 v_cvt_pk_bf16_f32 v30, v76, v77
 v_mfma_f32_16x16x32_bf16 v[116:119], v[172:175], a[148:151], v[116:119]
 v_mfma_f32_16x16x32_bf16 v[124:127], v[172:175], a[172:175], v[124:127]
 v_cvt_pk_bf16_f32 v31, v78, v79
 v_mfma_f32_16x16x32_bf16 v[132:135], v[172:175], a[196:199], v[132:135]
 buffer_store_dwordx4 v[28:31], v4, s[24:27], s42 offen offset:1024 sc1
 v_mfma_f32_16x16x32_bf16 v[140:143], v[172:175], a[220:223], v[140:143]
 s_cmp_lt_u32 s63, s50
 s_cbranch_scc0 vwx_155
vwx_156:
 v_mfma_f32_16x16x32_bf16 v[104:107], v[152:155], a[128:131], v[104:107]
 s_waitcnt lgkmcnt(0)
 s_barrier
 v_mfma_f32_16x16x32_bf16 v[112:115], v[152:155], a[152:155], v[112:115]
 ds_read_b128 v[240:243], v7 offset:0
 v_cvt_pk_bf16_f32 v32, v80, v81
 v_mfma_f32_16x16x32_bf16 v[120:123], v[152:155], a[176:179], v[120:123]
 ds_read_b128 v[192:195], v8 offset:0
 v_cvt_pk_bf16_f32 v33, v82, v83
 v_mfma_f32_16x16x32_bf16 v[128:131], v[152:155], a[200:203], v[128:131]
 v_mfma_f32_16x16x32_bf16 v[136:139], v[152:155], a[224:227], v[136:139]
 ds_read_b128 v[196:199], v8 offset:1024
 v_cvt_pk_bf16_f32 v34, v84, v85
 v_mfma_f32_16x16x32_bf16 v[108:111], v[176:179], a[128:131], v[108:111]
 v_mfma_f32_16x16x32_bf16 v[116:119], v[176:179], a[152:155], v[116:119]
 v_cvt_pk_bf16_f32 v35, v86, v87
 v_mfma_f32_16x16x32_bf16 v[124:127], v[176:179], a[176:179], v[124:127]
 ds_read_b128 v[200:203], v8 offset:2048
 v_mfma_f32_16x16x32_bf16 v[132:135], v[176:179], a[200:203], v[132:135]
 buffer_store_dwordx4 v[32:35], v4, s[24:27], s42 offen offset:2048 sc1
 v_mfma_f32_16x16x32_bf16 v[140:143], v[176:179], a[224:227], v[140:143]
 ds_read_b128 v[204:207], v8 offset:3072
 v_cvt_pk_bf16_f32 v36, v88, v89
 v_mfma_f32_16x16x32_bf16 v[104:107], v[156:159], a[132:135], v[104:107]
 v_mfma_f32_16x16x32_bf16 v[112:115], v[156:159], a[156:159], v[112:115]
 v_cvt_pk_bf16_f32 v37, v90, v91
 v_mfma_f32_16x16x32_bf16 v[120:123], v[156:159], a[180:183], v[120:123]
 ds_read_b128 v[208:211], v8 offset:4096
 v_mfma_f32_16x16x32_bf16 v[128:131], v[156:159], a[204:207], v[128:131]
 v_cvt_pk_bf16_f32 v38, v92, v93
 v_mfma_f32_16x16x32_bf16 v[136:139], v[156:159], a[228:231], v[136:139]
 ds_read_b128 v[212:215], v8 offset:5120
 s_waitcnt lgkmcnt(4)
 v_mfma_f32_16x16x32_bf16 v[108:111], v[180:183], a[132:135], v[108:111]
 v_bitop3_b32 v240, v240, v241, v242 bitop3:0x80
 v_and_b32 v240, v240, v243
 v_mfma_f32_16x16x32_bf16 v[116:119], v[180:183], a[156:159], v[116:119]
 s_nop 0
 v_readfirstlane_b32 s23, v240
 v_mfma_f32_16x16x32_bf16 v[124:127], v[180:183], a[180:183], v[124:127]
 ds_read_b128 v[216:219], v8 offset:6144
 v_cvt_pk_bf16_f32 v39, v94, v95
 v_mfma_f32_16x16x32_bf16 v[132:135], v[180:183], a[204:207], v[132:135]
 buffer_store_dwordx4 v[36:39], v4, s[24:27], s42 offen offset:3072 sc1
 v_mfma_f32_16x16x32_bf16 v[140:143], v[180:183], a[228:231], v[140:143]
 ds_read_b128 v[220:223], v8 offset:7168
 v_cvt_pk_bf16_f32 v40, v96, v97
 v_mfma_f32_16x16x32_bf16 v[104:107], v[160:163], a[136:139], v[104:107]
 v_cvt_pk_bf16_f32 v41, v98, v99
 v_mfma_f32_16x16x32_bf16 v[112:115], v[160:163], a[160:163], v[112:115]
 v_cvt_pk_bf16_f32 v42, v100, v101
 v_mfma_f32_16x16x32_bf16 v[120:123], v[160:163], a[184:187], v[120:123]
 ds_read_b128 v[224:227], v8 offset:8192
 v_mfma_f32_16x16x32_bf16 v[128:131], v[160:163], a[208:211], v[128:131]
 v_cvt_pk_bf16_f32 v43, v102, v103
 v_mfma_f32_16x16x32_bf16 v[136:139], v[160:163], a[232:235], v[136:139]
 ds_read_b128 v[228:231], v8 offset:9216
 v_mfma_f32_16x16x32_bf16 v[108:111], v[184:187], a[136:139], v[108:111]
 s_add_u32 s69, s42, 4096
 v_mfma_f32_16x16x32_bf16 v[116:119], v[184:187], a[160:163], v[116:119]
 v_mfma_f32_16x16x32_bf16 v[124:127], v[184:187], a[184:187], v[124:127]
 ds_read_b128 v[232:235], v8 offset:10240
 v_mfma_f32_16x16x32_bf16 v[132:135], v[184:187], a[208:211], v[132:135]
 buffer_store_dwordx4 v[40:43], v4, s[24:27], s69 offen offset:0 sc1
 v_mfma_f32_16x16x32_bf16 v[140:143], v[184:187], a[232:235], v[140:143]
 ds_read_b128 v[236:239], v8 offset:11264
 v_mfma_f32_16x16x32_bf16 v[104:107], v[164:167], a[140:143], v[104:107]
 v_mfma_f32_16x16x32_bf16 v[112:115], v[164:167], a[164:167], v[112:115]
 v_mfma_f32_16x16x32_bf16 v[120:123], v[164:167], a[188:191], v[120:123]
 s_waitcnt vmcnt(11)
 s_mov_b32 s50, s46
 s_add_u32 s69, s45, s40
 v_mfma_f32_16x16x32_bf16 v[128:131], v[164:167], a[212:215], v[128:131]
 s_mov_b32 s40, 0
 s_sub_i32 s69, s69, 1
 s_max_i32 s69, s69, s70
 v_mfma_f32_16x16x32_bf16 v[136:139], v[164:167], a[236:239], v[136:139]
 s_add_u32 s45, s45, 1
 s_mov_b32 s68, s42
 s_add_u32 s42, s42, 1310720
 v_mfma_f32_16x16x32_bf16 v[108:111], v[188:191], a[140:143], v[108:111]
 v_mfma_f32_16x16x32_bf16 v[116:119], v[188:191], a[164:167], v[116:119]
 v_mfma_f32_16x16x32_bf16 v[124:127], v[188:191], a[188:191], v[124:127]
 v_mfma_f32_16x16x32_bf16 v[132:135], v[188:191], a[212:215], v[132:135]
 v_mfma_f32_16x16x32_bf16 v[140:143], v[188:191], a[236:239], v[140:143]
 s_mov_b64 exec, 1
 v_mov_b32 v20, s69
 buffer_store_dword v20, v10, s[72:75], s44 offen sc1
 s_mov_b64 exec, -1
 s_cmp_le_u32 s45, 16
 s_cbranch_scc1 vwe_161
vwe_162:
 s_cmp_eq_u32 s23, 0
 s_cbranch_scc1 vws_159
vwb_160:
 s_waitcnt lgkmcnt(0)
 v_mfma_f32_16x16x32_bf16 v[64:67], v[192:195], a[0:3], 0
 v_cmp_gt_u32 vcc, 8, v9
 s_nop 0
 v_mfma_f32_16x16x32_bf16 v[72:75], v[192:195], a[24:27], 0
 s_bitset1_b64 vcc, 19
 s_ff1_i32_b64 s21, vcc
 v_mfma_f32_16x16x32_bf16 v[80:83], v[192:195], a[48:51], 0
 s_lshl_b32 s22, s21, 1
 s_lshl_b32 s21, s21, 2
 v_mfma_f32_16x16x32_bf16 v[88:91], v[192:195], a[72:75], 0
 s_sub_i32 s21, s21, 12
 s_max_i32 s47, s21, s22
 v_mfma_f32_16x16x32_bf16 v[96:99], v[192:195], a[96:99], 0
 s_add_u32 s22, s45, 7
 s_min_u32 s22, s22, s47
 v_mfma_f32_16x16x32_bf16 v[68:71], v[216:219], a[0:3], 0
 s_cmp_lt_u32 s46, s22
 s_cselect_b32 s66, s41, 0x80000000
 s_cselect_b32 m0, s64, 98304
 s_cselect_b32 s22, 1, 0
 v_mfma_f32_16x16x32_bf16 v[76:79], v[216:219], a[24:27], 0
 buffer_load_dwordx4 v4, s[16:19], s66 offen offset:0 sc1 lds
 v_mfma_f32_16x16x32_bf16 v[84:87], v[216:219], a[48:51], 0
 v_add_u32 v8, s65, v4
 s_add_u32 s65, s65, 12288
 v_mfma_f32_16x16x32_bf16 v[92:95], v[216:219], a[72:75], 0
 buffer_load_dwordx4 v4, s[16:19], s66 offen offset:1024 sc1 lds
 v_mfma_f32_16x16x32_bf16 v[100:103], v[216:219], a[96:99], 0
 s_cmp_lt_u32 s65, 98304
 s_cselect_b32 s65, s65, 0
 v_mfma_f32_16x16x32_bf16 v[64:67], v[196:199], a[4:7], v[64:67]
 buffer_load_dwordx4 v4, s[16:19], s66 offen offset:2048 sc1 lds
 v_mfma_f32_16x16x32_bf16 v[72:75], v[196:199], a[28:31], v[72:75]
 s_add_u32 s46, s46, s22
 s_mul_i32 s21, s22, 393216
 v_mfma_f32_16x16x32_bf16 v[80:83], v[196:199], a[52:55], v[80:83]
 s_add_u32 s41, s41, s21
 s_mul_i32 s21, s22, 12288
 v_mfma_f32_16x16x32_bf16 v[88:91], v[196:199], a[76:79], v[88:91]
 s_add_u32 s64, s64, s21
 v_cvt_pk_bf16_f32 v44, v104, v105
 v_mfma_f32_16x16x32_bf16 v[96:99], v[196:199], a[100:103], v[96:99]
 s_cmp_lt_u32 s64, s67
 s_cselect_b32 s64, s64, s71
 v_mfma_f32_16x16x32_bf16 v[68:71], v[220:223], a[4:7], v[68:71]
 v_cvt_pk_bf16_f32 v45, v106, v107
 v_cvt_pk_bf16_f32 v46, v108, v109
 v_mfma_f32_16x16x32_bf16 v[76:79], v[220:223], a[28:31], v[76:79]
 v_cvt_pk_bf16_f32 v47, v110, v111
 v_mfma_f32_16x16x32_bf16 v[84:87], v[220:223], a[52:55], v[84:87]
 s_add_u32 s69, s68, 4096
 v_mfma_f32_16x16x32_bf16 v[92:95], v[220:223], a[76:79], v[92:95]
 v_mfma_f32_16x16x32_bf16 v[100:103], v[220:223], a[100:103], v[100:103]
 buffer_store_dwordx4 v[44:47], v4, s[24:27], s69 offen offset:1024 sc1
 v_mfma_f32_16x16x32_bf16 v[64:67], v[200:203], a[8:11], v[64:67]
 v_mfma_f32_16x16x32_bf16 v[72:75], v[200:203], a[32:35], v[72:75]
 v_cvt_pk_bf16_f32 v48, v112, v113
 v_mfma_f32_16x16x32_bf16 v[80:83], v[200:203], a[56:59], v[80:83]
 v_cvt_pk_bf16_f32 v49, v114, v115
 v_mfma_f32_16x16x32_bf16 v[88:91], v[200:203], a[80:83], v[88:91]
 v_mfma_f32_16x16x32_bf16 v[96:99], v[200:203], a[104:107], v[96:99]
 v_cvt_pk_bf16_f32 v50, v116, v117
 v_mfma_f32_16x16x32_bf16 v[68:71], v[224:227], a[8:11], v[68:71]
 v_mfma_f32_16x16x32_bf16 v[76:79], v[224:227], a[32:35], v[76:79]
 v_cvt_pk_bf16_f32 v51, v118, v119
 v_mfma_f32_16x16x32_bf16 v[84:87], v[224:227], a[56:59], v[84:87]
 buffer_store_dwordx4 v[48:51], v4, s[24:27], s69 offen offset:2048 sc1
 v_mfma_f32_16x16x32_bf16 v[92:95], v[224:227], a[80:83], v[92:95]
 v_mfma_f32_16x16x32_bf16 v[100:103], v[224:227], a[104:107], v[100:103]
 v_cvt_pk_bf16_f32 v52, v120, v121
 v_mfma_f32_16x16x32_bf16 v[64:67], v[204:207], a[12:15], v[64:67]
 v_mfma_f32_16x16x32_bf16 v[72:75], v[204:207], a[36:39], v[72:75]
 v_cvt_pk_bf16_f32 v53, v122, v123
 v_mfma_f32_16x16x32_bf16 v[80:83], v[204:207], a[60:63], v[80:83]
 v_cvt_pk_bf16_f32 v54, v124, v125
 v_mfma_f32_16x16x32_bf16 v[88:91], v[204:207], a[84:87], v[88:91]
 v_mfma_f32_16x16x32_bf16 v[96:99], v[204:207], a[108:111], v[96:99]
 v_cvt_pk_bf16_f32 v55, v126, v127
 v_mfma_f32_16x16x32_bf16 v[68:71], v[228:231], a[12:15], v[68:71]
 v_mfma_f32_16x16x32_bf16 v[76:79], v[228:231], a[36:39], v[76:79]
 buffer_store_dwordx4 v[52:55], v4, s[24:27], s69 offen offset:3072 sc1
 v_mfma_f32_16x16x32_bf16 v[84:87], v[228:231], a[60:63], v[84:87]
 v_cvt_pk_bf16_f32 v56, v128, v129
 v_mfma_f32_16x16x32_bf16 v[92:95], v[228:231], a[84:87], v[92:95]
 v_mfma_f32_16x16x32_bf16 v[100:103], v[228:231], a[108:111], v[100:103]
 v_cvt_pk_bf16_f32 v57, v130, v131
 v_mfma_f32_16x16x32_bf16 v[64:67], v[208:211], a[16:19], v[64:67]
 v_mfma_f32_16x16x32_bf16 v[72:75], v[208:211], a[40:43], v[72:75]
 v_cvt_pk_bf16_f32 v58, v132, v133
 v_mfma_f32_16x16x32_bf16 v[80:83], v[208:211], a[64:67], v[80:83]
 v_cvt_pk_bf16_f32 v59, v134, v135
 v_mfma_f32_16x16x32_bf16 v[88:91], v[208:211], a[88:91], v[88:91]
 v_mfma_f32_16x16x32_bf16 v[96:99], v[208:211], a[112:115], v[96:99]
 s_add_u32 s69, s68, 8192
 v_mfma_f32_16x16x32_bf16 v[68:71], v[232:235], a[16:19], v[68:71]
 v_mfma_f32_16x16x32_bf16 v[76:79], v[232:235], a[40:43], v[76:79]
 buffer_store_dwordx4 v[56:59], v4, s[24:27], s69 offen offset:0 sc1
 v_mfma_f32_16x16x32_bf16 v[84:87], v[232:235], a[64:67], v[84:87]
 v_cvt_pk_bf16_f32 v60, v136, v137
 v_mfma_f32_16x16x32_bf16 v[92:95], v[232:235], a[88:91], v[92:95]
 v_mfma_f32_16x16x32_bf16 v[100:103], v[232:235], a[112:115], v[100:103]
 v_cvt_pk_bf16_f32 v61, v138, v139
 v_mfma_f32_16x16x32_bf16 v[64:67], v[212:215], a[20:23], v[64:67]
 v_mfma_f32_16x16x32_bf16 v[72:75], v[212:215], a[44:47], v[72:75]
 v_cvt_pk_bf16_f32 v62, v140, v141
 v_mfma_f32_16x16x32_bf16 v[80:83], v[212:215], a[68:71], v[80:83]
 v_cvt_pk_bf16_f32 v63, v142, v143
 v_mfma_f32_16x16x32_bf16 v[88:91], v[212:215], a[92:95], v[88:91]
 v_mfma_f32_16x16x32_bf16 v[96:99], v[212:215], a[116:119], v[96:99]
 buffer_store_dwordx4 v[60:63], v4, s[24:27], s69 offen offset:1024 sc1
 v_mfma_f32_16x16x32_bf16 v[68:71], v[236:239], a[20:23], v[68:71]
 v_mfma_f32_16x16x32_bf16 v[76:79], v[236:239], a[44:47], v[76:79]
 v_mfma_f32_16x16x32_bf16 v[84:87], v[236:239], a[68:71], v[84:87]
 v_mfma_f32_16x16x32_bf16 v[92:95], v[236:239], a[92:95], v[92:95]
 v_mfma_f32_16x16x32_bf16 v[100:103], v[236:239], a[116:119], v[100:103]
 v_mfma_f32_16x16x32_bf16 v[104:107], v[192:195], a[120:123], 0
 buffer_load_dword v9, v5, s[72:75], s43 offen sc1
 v_mfma_f32_16x16x32_bf16 v[112:115], v[192:195], a[144:147], 0
 v_mfma_f32_16x16x32_bf16 v[120:123], v[192:195], a[168:171], 0
 v_mfma_f32_16x16x32_bf16 v[128:131], v[192:195], a[192:195], 0
 v_cvt_pk_bf16_f32 v24, v64, v65
 v_mfma_f32_16x16x32_bf16 v[136:139], v[192:195], a[216:219], 0
 s_add_u32 s63, s45, 1
 s_min_u32 s63, s63, 63
 v_mfma_f32_16x16x32_bf16 v[108:111], v[216:219], a[120:123], 0
 s_cmp_lt_u32 s63, s46
 s_cselect_b32 s53, 1, 0
 v_mfma_f32_16x16x32_bf16 v[116:119], v[216:219], a[144:147], 0
 v_mov_b32 v21, s53
 ds_write_b32 v6, v21 offset:16
 v_mfma_f32_16x16x32_bf16 v[124:127], v[216:219], a[168:171], 0
 v_cvt_pk_bf16_f32 v25, v66, v67
 v_cvt_pk_bf16_f32 v26, v68, v69
 v_mfma_f32_16x16x32_bf16 v[132:135], v[216:219], a[192:195], 0
 v_cvt_pk_bf16_f32 v27, v70, v71
 v_mfma_f32_16x16x32_bf16 v[140:143], v[216:219], a[216:219], 0
 v_mfma_f32_16x16x32_bf16 v[104:107], v[196:199], a[124:127], v[104:107]
 buffer_store_dwordx4 v[24:27], v4, s[24:27], s42 offen offset:0 sc1
 v_mfma_f32_16x16x32_bf16 v[112:115], v[196:199], a[148:151], v[112:115]
 v_cvt_pk_bf16_f32 v28, v72, v73
 v_mfma_f32_16x16x32_bf16 v[120:123], v[196:199], a[172:175], v[120:123]
 s_cmp_eq_u32 s40, 3
 s_cbranch_scc1 vwm_167
vwm_168:
 v_mfma_f32_16x16x32_bf16 v[128:131], v[196:199], a[196:199], v[128:131]
 v_cvt_pk_bf16_f32 v29, v74, v75
 v_mfma_f32_16x16x32_bf16 v[136:139], v[196:199], a[220:223], v[136:139]
 v_mfma_f32_16x16x32_bf16 v[108:111], v[220:223], a[124:127], v[108:111]
 v_cvt_pk_bf16_f32 v30, v76, v77
 v_mfma_f32_16x16x32_bf16 v[116:119], v[220:223], a[148:151], v[116:119]
 v_mfma_f32_16x16x32_bf16 v[124:127], v[220:223], a[172:175], v[124:127]
 v_cvt_pk_bf16_f32 v31, v78, v79
 v_mfma_f32_16x16x32_bf16 v[132:135], v[220:223], a[196:199], v[132:135]
 buffer_store_dwordx4 v[28:31], v4, s[24:27], s42 offen offset:1024 sc1
 v_mfma_f32_16x16x32_bf16 v[140:143], v[220:223], a[220:223], v[140:143]
 s_cmp_lt_u32 s63, s50
 s_cbranch_scc0 vwx_165
vwx_166:
 v_mfma_f32_16x16x32_bf16 v[104:107], v[200:203], a[128:131], v[104:107]
 s_waitcnt lgkmcnt(0)
 s_barrier
 v_mfma_f32_16x16x32_bf16 v[112:115], v[200:203], a[152:155], v[112:115]
 ds_read_b128 v[240:243], v7 offset:16
 v_cvt_pk_bf16_f32 v32, v80, v81
 v_mfma_f32_16x16x32_bf16 v[120:123], v[200:203], a[176:179], v[120:123]
 ds_read_b128 v[144:147], v8 offset:0
 v_cvt_pk_bf16_f32 v33, v82, v83
 v_mfma_f32_16x16x32_bf16 v[128:131], v[200:203], a[200:203], v[128:131]
 v_mfma_f32_16x16x32_bf16 v[136:139], v[200:203], a[224:227], v[136:139]
 ds_read_b128 v[148:151], v8 offset:1024
 v_cvt_pk_bf16_f32 v34, v84, v85
 v_mfma_f32_16x16x32_bf16 v[108:111], v[224:227], a[128:131], v[108:111]
 v_mfma_f32_16x16x32_bf16 v[116:119], v[224:227], a[152:155], v[116:119]
 v_cvt_pk_bf16_f32 v35, v86, v87
 v_mfma_f32_16x16x32_bf16 v[124:127], v[224:227], a[176:179], v[124:127]
 ds_read_b128 v[152:155], v8 offset:2048
 v_mfma_f32_16x16x32_bf16 v[132:135], v[224:227], a[200:203], v[132:135]
 buffer_store_dwordx4 v[32:35], v4, s[24:27], s42 offen offset:2048 sc1
 v_mfma_f32_16x16x32_bf16 v[140:143], v[224:227], a[224:227], v[140:143]
 ds_read_b128 v[156:159], v8 offset:3072
 v_cvt_pk_bf16_f32 v36, v88, v89
 v_mfma_f32_16x16x32_bf16 v[104:107], v[204:207], a[132:135], v[104:107]
 v_mfma_f32_16x16x32_bf16 v[112:115], v[204:207], a[156:159], v[112:115]
 v_cvt_pk_bf16_f32 v37, v90, v91
 v_mfma_f32_16x16x32_bf16 v[120:123], v[204:207], a[180:183], v[120:123]
 ds_read_b128 v[160:163], v8 offset:4096
 v_mfma_f32_16x16x32_bf16 v[128:131], v[204:207], a[204:207], v[128:131]
 v_cvt_pk_bf16_f32 v38, v92, v93
 v_mfma_f32_16x16x32_bf16 v[136:139], v[204:207], a[228:231], v[136:139]
 ds_read_b128 v[164:167], v8 offset:5120
 s_waitcnt lgkmcnt(4)
 v_mfma_f32_16x16x32_bf16 v[108:111], v[228:231], a[132:135], v[108:111]
 v_bitop3_b32 v240, v240, v241, v242 bitop3:0x80
 v_and_b32 v240, v240, v243
 v_mfma_f32_16x16x32_bf16 v[116:119], v[228:231], a[156:159], v[116:119]
 s_nop 0
 v_readfirstlane_b32 s23, v240
 v_mfma_f32_16x16x32_bf16 v[124:127], v[228:231], a[180:183], v[124:127]
 ds_read_b128 v[168:171], v8 offset:6144
 v_cvt_pk_bf16_f32 v39, v94, v95
 v_mfma_f32_16x16x32_bf16 v[132:135], v[228:231], a[204:207], v[132:135]
 buffer_store_dwordx4 v[36:39], v4, s[24:27], s42 offen offset:3072 sc1
 v_mfma_f32_16x16x32_bf16 v[140:143], v[228:231], a[228:231], v[140:143]
 ds_read_b128 v[172:175], v8 offset:7168
 v_cvt_pk_bf16_f32 v40, v96, v97
 v_mfma_f32_16x16x32_bf16 v[104:107], v[208:211], a[136:139], v[104:107]
 v_cvt_pk_bf16_f32 v41, v98, v99
 v_mfma_f32_16x16x32_bf16 v[112:115], v[208:211], a[160:163], v[112:115]
 v_cvt_pk_bf16_f32 v42, v100, v101
 v_mfma_f32_16x16x32_bf16 v[120:123], v[208:211], a[184:187], v[120:123]
 ds_read_b128 v[176:179], v8 offset:8192
 v_mfma_f32_16x16x32_bf16 v[128:131], v[208:211], a[208:211], v[128:131]
 v_cvt_pk_bf16_f32 v43, v102, v103
 v_mfma_f32_16x16x32_bf16 v[136:139], v[208:211], a[232:235], v[136:139]
 ds_read_b128 v[180:183], v8 offset:9216
 v_mfma_f32_16x16x32_bf16 v[108:111], v[232:235], a[136:139], v[108:111]
 s_add_u32 s69, s42, 4096
 v_mfma_f32_16x16x32_bf16 v[116:119], v[232:235], a[160:163], v[116:119]
 v_mfma_f32_16x16x32_bf16 v[124:127], v[232:235], a[184:187], v[124:127]
 ds_read_b128 v[184:187], v8 offset:10240
 v_mfma_f32_16x16x32_bf16 v[132:135], v[232:235], a[208:211], v[132:135]
 buffer_store_dwordx4 v[40:43], v4, s[24:27], s69 offen offset:0 sc1
 v_mfma_f32_16x16x32_bf16 v[140:143], v[232:235], a[232:235], v[140:143]
 ds_read_b128 v[188:191], v8 offset:11264
 v_mfma_f32_16x16x32_bf16 v[104:107], v[212:215], a[140:143], v[104:107]
 v_mfma_f32_16x16x32_bf16 v[112:115], v[212:215], a[164:167], v[112:115]
 v_mfma_f32_16x16x32_bf16 v[120:123], v[212:215], a[188:191], v[120:123]
 s_waitcnt vmcnt(11)
 s_mov_b32 s50, s46
 s_add_u32 s69, s45, s40
 v_mfma_f32_16x16x32_bf16 v[128:131], v[212:215], a[212:215], v[128:131]
 s_mov_b32 s40, 0
 s_sub_i32 s69, s69, 1
 s_max_i32 s69, s69, s70
 v_mfma_f32_16x16x32_bf16 v[136:139], v[212:215], a[236:239], v[136:139]
 s_add_u32 s45, s45, 1
 s_mov_b32 s68, s42
 s_add_u32 s42, s42, 1310720
 v_mfma_f32_16x16x32_bf16 v[108:111], v[236:239], a[140:143], v[108:111]
 v_mfma_f32_16x16x32_bf16 v[116:119], v[236:239], a[164:167], v[116:119]
 v_mfma_f32_16x16x32_bf16 v[124:127], v[236:239], a[188:191], v[124:127]
 v_mfma_f32_16x16x32_bf16 v[132:135], v[236:239], a[212:215], v[132:135]
 v_mfma_f32_16x16x32_bf16 v[140:143], v[236:239], a[236:239], v[140:143]
 s_mov_b64 exec, 1
 v_mov_b32 v20, s69
 buffer_store_dword v20, v10, s[72:75], s44 offen sc1
 s_mov_b64 exec, -1
 s_cmp_le_u32 s45, 16
 s_cbranch_scc1 vwe_171
vwe_172:
 s_cmp_lg_u32 s45, 48
 s_cbranch_scc1 arm_175
 v_and_b32 v23, 31, v1
 buffer_load_ubyte v22, v23, s[32:35], 0 offen offset:160 sc1
 s_waitcnt vmcnt(0)
 s_mov_b32 s101, 0
c0_177:
 v_cmp_eq_u32 vcc, 0, v22
 s_nop 1
 s_cbranch_vccz c0_178
 s_sleep 8
 v_and_b32 v23, 31, v1
 buffer_load_ubyte v22, v23, s[32:35], 0 offen offset:160 sc1
 s_add_u32 s101, s101, 1
 s_cmp_gt_u32 s101, 131072
 s_cbranch_scc1 main_end
 s_waitcnt vmcnt(0)
 s_branch c0_177
c0_178:
 v_cmp_eq_u32 vcc, 2, v22
 s_nop 1
 s_mov_b32 s37, vcc_lo
 s_lshr_b32 s21, s2, 3
 s_lshl_b32 s21, s21, 14
 s_and_b32 s22, s2, 7
 s_lshl_b32 s22, s22, 10
 s_add_u32 s54, s21, s22
 s_lshr_b32 s21, s2, 2
 s_lshl_b32 s21, s21, 14
 s_and_b32 s22, s2, 3
 s_lshl_b32 s22, s22, 11
 s_add_u32 s21, s21, s22
 s_add_u32 s55, s21, 655360
 s_lshr_b32 s58, s2, 1
 s_lshl_b32 s58, s58, 14
 s_and_b32 s21, s2, 1
 s_mul_i32 s21, s21, 3072
 s_add_u32 s58, s58, s21
 s_add_u32 s58, s58, 655360
 s_add_u32 s56, s20, 56
arm_176:
 s_lshr_b32 s21, s56, 1
 s_bitcmp1_b32 s37, s21
 s_cselect_b32 s21, 8192, 0
 s_lshl_b32 s57, s56, 20
 s_or_b32 s57, s57, s21
 s_cmp_ge_u32 s56, 40
 s_cselect_b32 s21, 8192, 0
 s_xor_b32 s21, s21, s57
 s_add_u32 s21, s21, s54
 buffer_store_dwordx4 v[244:247], v4, s[88:91], s21 offen sc1
 s_add_u32 s21, s21, 65536
 buffer_store_dwordx4 v[244:247], v4, s[88:91], s21 offen sc1
 s_add_u32 s21, s21, 65536
 buffer_store_dwordx4 v[244:247], v4, s[88:91], s21 offen sc1
 s_add_u32 s21, s21, 65536
 buffer_store_dwordx4 v[244:247], v4, s[88:91], s21 offen sc1
 s_add_u32 s21, s21, 65536
 buffer_store_dwordx4 v[244:247], v4, s[88:91], s21 offen sc1
 s_add_u32 s21, s21, 65536
 buffer_store_dwordx4 v[244:247], v4, s[88:91], s21 offen sc1
 s_add_u32 s21, s21, 65536
 buffer_store_dwordx4 v[244:247], v4, s[88:91], s21 offen sc1
 s_add_u32 s21, s21, 65536
 buffer_store_dwordx4 v[244:247], v4, s[88:91], s21 offen sc1
 s_add_u32 s21, s21, 65536
 buffer_store_dwordx4 v[244:247], v4, s[88:91], s21 offen sc1
 s_add_u32 s21, s21, 65536
 buffer_store_dwordx4 v[244:247], v4, s[88:91], s21 offen sc1
 s_add_u32 s21, s21, 65536
 s_add_u32 s21, s57, s55
 buffer_store_dwordx4 v[244:247], v4, s[88:91], s21 offen sc1
 buffer_store_dwordx4 v[244:247], v4, s[88:91], s21 offen offset:1024 sc1
 s_xor_b32 s21, s57, 8192
 s_add_u32 s21, s21, s58
 buffer_store_dwordx4 v[244:247], v4, s[88:91], s21 offen offset:0 sc1
 buffer_store_dwordx4 v[244:247], v4, s[88:91], s21 offen offset:1024 sc1
 buffer_store_dwordx4 v[244:247], v4, s[88:91], s21 offen offset:2048 sc1
 s_add_u32 s56, s56, 4
 s_cmp_lt_u32 s56, 64
 s_cbranch_scc1 arm_176
arm_175:
 s_cmp_ge_u32 s45, 64
 s_cbranch_scc1 vwd_154
 s_cmp_lg_u32 s23, 0
 s_cbranch_scc1 vwl_153
 s_branch vws_169
vws_159:
 v_cmp_gt_u32 vcc, 8, v9
 s_nop 0
 s_bitset1_b64 vcc, 19
 s_ff1_i32_b64 s21, vcc
 s_lshl_b32 s22, s21, 1
 s_lshl_b32 s21, s21, 2
 s_sub_i32 s21, s21, 12
 s_max_i32 s47, s21, s22
 s_cmp_gt_u32 s47, s45
 s_cbranch_scc1 va_179
 s_cmp_eq_u32 s70, s45
 s_cbranch_scc1 va_184
 s_nop 4
 v_cvt_pk_bf16_f32 v44, v104, v105
 v_cvt_pk_bf16_f32 v45, v106, v107
 v_cvt_pk_bf16_f32 v46, v108, v109
 v_cvt_pk_bf16_f32 v47, v110, v111
 s_add_u32 s69, s68, 4096
 buffer_store_dwordx4 v[44:47], v4, s[24:27], s69 offen offset:1024 sc1
 v_cvt_pk_bf16_f32 v48, v112, v113
 v_cvt_pk_bf16_f32 v49, v114, v115
 v_cvt_pk_bf16_f32 v50, v116, v117
 v_cvt_pk_bf16_f32 v51, v118, v119
 buffer_store_dwordx4 v[48:51], v4, s[24:27], s69 offen offset:2048 sc1
 v_cvt_pk_bf16_f32 v52, v120, v121
 v_cvt_pk_bf16_f32 v53, v122, v123
 v_cvt_pk_bf16_f32 v54, v124, v125
 v_cvt_pk_bf16_f32 v55, v126, v127
 buffer_store_dwordx4 v[52:55], v4, s[24:27], s69 offen offset:3072 sc1
 v_cvt_pk_bf16_f32 v56, v128, v129
 v_cvt_pk_bf16_f32 v57, v130, v131
 v_cvt_pk_bf16_f32 v58, v132, v133
 v_cvt_pk_bf16_f32 v59, v134, v135
 s_add_u32 s69, s68, 8192
 buffer_store_dwordx4 v[56:59], v4, s[24:27], s69 offen offset:0 sc1
 v_cvt_pk_bf16_f32 v60, v136, v137
 v_cvt_pk_bf16_f32 v61, v138, v139
 v_cvt_pk_bf16_f32 v62, v140, v141
 v_cvt_pk_bf16_f32 v63, v142, v143
 buffer_store_dwordx4 v[60:63], v4, s[24:27], s69 offen offset:1024 sc1
 s_mov_b32 s68, 0x80000000
 s_mov_b32 s56, s68
 s_mov_b32 s57, s68
 s_waitcnt vmcnt(0)
 s_mov_b64 exec, 1
 v_mov_b32 v20, s45
 buffer_store_dword v20, v10, s[72:75], s44 offen sc1
 s_mov_b64 exec, -1
 s_mov_b32 s70, s45
 s_mov_b32 s40, 0
va_184:
 s_mov_b32 s101, 0
 s_branch va_182
va_180:
 s_sleep 8
va_182:
 buffer_load_dword v9, v5, s[72:75], s43 offen sc1
 s_add_u32 s101, s101, 1
 s_cmp_gt_u32 s101, 131072
 s_cbranch_scc1 main_end
 s_waitcnt vmcnt(0)
 v_cmp_gt_u32 vcc, 8, v9
 s_nop 0
 s_bitset1_b64 vcc, 19
 s_ff1_i32_b64 s21, vcc
 s_lshl_b32 s22, s21, 1
 s_lshl_b32 s21, s21, 2
 s_sub_i32 s21, s21, 12
 s_max_i32 s47, s21, s22
 s_cmp_gt_u32 s47, s45
 s_cbranch_scc0 va_180
va_179:
 s_add_u32 s22, s45, 6
 s_min_u32 s22, s22, s47
va_181:
 s_cmp_ge_u32 s46, s22
 s_cbranch_scc1 va_183
 s_mov_b32 m0, s64
 s_mov_b32 s66, s41
 buffer_load_dwordx4 v4, s[16:19], s66 offen offset:0 sc1 lds
 buffer_load_dwordx4 v4, s[16:19], s66 offen offset:1024 sc1 lds
 buffer_load_dwordx4 v4, s[16:19], s66 offen offset:2048 sc1 lds
 s_add_u32 s46, s46, 1
 s_add_u32 s41, s41, 393216
 s_add_u32 s64, s64, 12288
 s_cmp_lt_u32 s64, s67
 s_cselect_b32 s64, s64, s71
 s_branch va_181
va_183:
 s_mov_b32 s48, s46
 s_mov_b32 s49, s46
 s_mov_b32 s50, s46
 s_waitcnt vmcnt(0)
 s_cmp_eq_u32 s40, 0
 s_cbranch_scc1 va_185
 s_mov_b32 s40, 0
 s_mov_b64 exec, 1
 v_mov_b32 v20, s45
 buffer_store_dword v20, v10, s[72:75], s44 offen sc1
 s_mov_b64 exec, -1
 s_mov_b32 s70, s45
va_185:
 s_barrier
 ds_read_b128 v[192:195], v8 offset:0
 ds_read_b128 v[196:199], v8 offset:1024
 ds_read_b128 v[200:203], v8 offset:2048
 ds_read_b128 v[204:207], v8 offset:3072
 ds_read_b128 v[208:211], v8 offset:4096
 ds_read_b128 v[212:215], v8 offset:5120
 ds_read_b128 v[216:219], v8 offset:6144
 ds_read_b128 v[220:223], v8 offset:7168
 ds_read_b128 v[224:227], v8 offset:8192
 ds_read_b128 v[228:231], v8 offset:9216
 ds_read_b128 v[232:235], v8 offset:10240
 ds_read_b128 v[236:239], v8 offset:11264
 s_branch vwb_160
vws_169:
 v_cmp_gt_u32 vcc, 8, v9
 s_nop 0
 s_bitset1_b64 vcc, 19
 s_ff1_i32_b64 s21, vcc
 s_lshl_b32 s22, s21, 1
 s_lshl_b32 s21, s21, 2
 s_sub_i32 s21, s21, 12
 s_max_i32 s47, s21, s22
 s_cmp_gt_u32 s47, s45
 s_cbranch_scc1 va_186
 s_cmp_eq_u32 s70, s45
 s_cbranch_scc1 va_191
 s_nop 4
 v_cvt_pk_bf16_f32 v44, v104, v105
 v_cvt_pk_bf16_f32 v45, v106, v107
 v_cvt_pk_bf16_f32 v46, v108, v109
 v_cvt_pk_bf16_f32 v47, v110, v111
 s_add_u32 s69, s68, 4096
 buffer_store_dwordx4 v[44:47], v4, s[24:27], s69 offen offset:1024 sc1
 v_cvt_pk_bf16_f32 v48, v112, v113
 v_cvt_pk_bf16_f32 v49, v114, v115
 v_cvt_pk_bf16_f32 v50, v116, v117
 v_cvt_pk_bf16_f32 v51, v118, v119
 buffer_store_dwordx4 v[48:51], v4, s[24:27], s69 offen offset:2048 sc1
 v_cvt_pk_bf16_f32 v52, v120, v121
 v_cvt_pk_bf16_f32 v53, v122, v123
 v_cvt_pk_bf16_f32 v54, v124, v125
 v_cvt_pk_bf16_f32 v55, v126, v127
 buffer_store_dwordx4 v[52:55], v4, s[24:27], s69 offen offset:3072 sc1
 v_cvt_pk_bf16_f32 v56, v128, v129
 v_cvt_pk_bf16_f32 v57, v130, v131
 v_cvt_pk_bf16_f32 v58, v132, v133
 v_cvt_pk_bf16_f32 v59, v134, v135
 s_add_u32 s69, s68, 8192
 buffer_store_dwordx4 v[56:59], v4, s[24:27], s69 offen offset:0 sc1
 v_cvt_pk_bf16_f32 v60, v136, v137
 v_cvt_pk_bf16_f32 v61, v138, v139
 v_cvt_pk_bf16_f32 v62, v140, v141
 v_cvt_pk_bf16_f32 v63, v142, v143
 buffer_store_dwordx4 v[60:63], v4, s[24:27], s69 offen offset:1024 sc1
 s_mov_b32 s68, 0x80000000
 s_mov_b32 s56, s68
 s_mov_b32 s57, s68
 s_waitcnt vmcnt(0)
 s_mov_b64 exec, 1
 v_mov_b32 v20, s45
 buffer_store_dword v20, v10, s[72:75], s44 offen sc1
 s_mov_b64 exec, -1
 s_mov_b32 s70, s45
 s_mov_b32 s40, 0
va_191:
 s_mov_b32 s101, 0
 s_branch va_189
va_187:
 s_sleep 8
va_189:
 buffer_load_dword v9, v5, s[72:75], s43 offen sc1
 s_add_u32 s101, s101, 1
 s_cmp_gt_u32 s101, 131072
 s_cbranch_scc1 main_end
 s_waitcnt vmcnt(0)
 v_cmp_gt_u32 vcc, 8, v9
 s_nop 0
 s_bitset1_b64 vcc, 19
 s_ff1_i32_b64 s21, vcc
 s_lshl_b32 s22, s21, 1
 s_lshl_b32 s21, s21, 2
 s_sub_i32 s21, s21, 12
 s_max_i32 s47, s21, s22
 s_cmp_gt_u32 s47, s45
 s_cbranch_scc0 va_187
va_186:
 s_add_u32 s22, s45, 6
 s_min_u32 s22, s22, s47
va_188:
 s_cmp_ge_u32 s46, s22
 s_cbranch_scc1 va_190
 s_mov_b32 m0, s64
 s_mov_b32 s66, s41
 buffer_load_dwordx4 v4, s[16:19], s66 offen offset:0 sc1 lds
 buffer_load_dwordx4 v4, s[16:19], s66 offen offset:1024 sc1 lds
 buffer_load_dwordx4 v4, s[16:19], s66 offen offset:2048 sc1 lds
 s_add_u32 s46, s46, 1
 s_add_u32 s41, s41, 393216
 s_add_u32 s64, s64, 12288
 s_cmp_lt_u32 s64, s67
 s_cselect_b32 s64, s64, s71
 s_branch va_188
va_190:
 s_mov_b32 s48, s46
 s_mov_b32 s49, s46
 s_mov_b32 s50, s46
 s_waitcnt vmcnt(0)
 s_cmp_eq_u32 s40, 0
 s_cbranch_scc1 va_192
 s_mov_b32 s40, 0
 s_mov_b64 exec, 1
 v_mov_b32 v20, s45
 buffer_store_dword v20, v10, s[72:75], s44 offen sc1
 s_mov_b64 exec, -1
 s_mov_b32 s70, s45
va_192:
 s_barrier
 ds_read_b128 v[144:147], v8 offset:0
 ds_read_b128 v[148:151], v8 offset:1024
 ds_read_b128 v[152:155], v8 offset:2048
 ds_read_b128 v[156:159], v8 offset:3072
 ds_read_b128 v[160:163], v8 offset:4096
 ds_read_b128 v[164:167], v8 offset:5120
 ds_read_b128 v[168:171], v8 offset:6144
 ds_read_b128 v[172:175], v8 offset:7168
 ds_read_b128 v[176:179], v8 offset:8192
 ds_read_b128 v[180:183], v8 offset:9216
 ds_read_b128 v[184:187], v8 offset:10240
 ds_read_b128 v[188:191], v8 offset:11264
 s_branch vwl_153
vwe_161:
 s_nop 4
 v_cvt_pk_bf16_f32 v44, v104, v105
 v_cvt_pk_bf16_f32 v45, v106, v107
 v_cvt_pk_bf16_f32 v46, v108, v109
 v_cvt_pk_bf16_f32 v47, v110, v111
 s_add_u32 s69, s68, 4096
 buffer_store_dwordx4 v[44:47], v4, s[24:27], s69 offen offset:1024 sc1
 v_cvt_pk_bf16_f32 v48, v112, v113
 v_cvt_pk_bf16_f32 v49, v114, v115
 v_cvt_pk_bf16_f32 v50, v116, v117
 v_cvt_pk_bf16_f32 v51, v118, v119
 buffer_store_dwordx4 v[48:51], v4, s[24:27], s69 offen offset:2048 sc1
 v_cvt_pk_bf16_f32 v52, v120, v121
 v_cvt_pk_bf16_f32 v53, v122, v123
 v_cvt_pk_bf16_f32 v54, v124, v125
 v_cvt_pk_bf16_f32 v55, v126, v127
 buffer_store_dwordx4 v[52:55], v4, s[24:27], s69 offen offset:3072 sc1
 v_cvt_pk_bf16_f32 v56, v128, v129
 v_cvt_pk_bf16_f32 v57, v130, v131
 v_cvt_pk_bf16_f32 v58, v132, v133
 v_cvt_pk_bf16_f32 v59, v134, v135
 s_add_u32 s69, s68, 8192
 buffer_store_dwordx4 v[56:59], v4, s[24:27], s69 offen offset:0 sc1
 v_cvt_pk_bf16_f32 v60, v136, v137
 v_cvt_pk_bf16_f32 v61, v138, v139
 v_cvt_pk_bf16_f32 v62, v140, v141
 v_cvt_pk_bf16_f32 v63, v142, v143
 buffer_store_dwordx4 v[60:63], v4, s[24:27], s69 offen offset:1024 sc1
 s_mov_b32 s68, 0x80000000
 s_mov_b32 s56, s68
 s_mov_b32 s57, s68
 s_cmp_le_u32 s45, 4
 s_cselect_b32 s40, 3, 1
 s_branch vwe_162
vwe_171:
 s_nop 4
 v_cvt_pk_bf16_f32 v44, v104, v105
 v_cvt_pk_bf16_f32 v45, v106, v107
 v_cvt_pk_bf16_f32 v46, v108, v109
 v_cvt_pk_bf16_f32 v47, v110, v111
 s_add_u32 s69, s68, 4096
 buffer_store_dwordx4 v[44:47], v4, s[24:27], s69 offen offset:1024 sc1
 v_cvt_pk_bf16_f32 v48, v112, v113
 v_cvt_pk_bf16_f32 v49, v114, v115
 v_cvt_pk_bf16_f32 v50, v116, v117
 v_cvt_pk_bf16_f32 v51, v118, v119
 buffer_store_dwordx4 v[48:51], v4, s[24:27], s69 offen offset:2048 sc1
 v_cvt_pk_bf16_f32 v52, v120, v121
 v_cvt_pk_bf16_f32 v53, v122, v123
 v_cvt_pk_bf16_f32 v54, v124, v125
 v_cvt_pk_bf16_f32 v55, v126, v127
 buffer_store_dwordx4 v[52:55], v4, s[24:27], s69 offen offset:3072 sc1
 v_cvt_pk_bf16_f32 v56, v128, v129
 v_cvt_pk_bf16_f32 v57, v130, v131
 v_cvt_pk_bf16_f32 v58, v132, v133
 v_cvt_pk_bf16_f32 v59, v134, v135
 s_add_u32 s69, s68, 8192
 buffer_store_dwordx4 v[56:59], v4, s[24:27], s69 offen offset:0 sc1
 v_cvt_pk_bf16_f32 v60, v136, v137
 v_cvt_pk_bf16_f32 v61, v138, v139
 v_cvt_pk_bf16_f32 v62, v140, v141
 v_cvt_pk_bf16_f32 v63, v142, v143
 buffer_store_dwordx4 v[60:63], v4, s[24:27], s69 offen offset:1024 sc1
 s_mov_b32 s68, 0x80000000
 s_mov_b32 s56, s68
 s_mov_b32 s57, s68
 s_cmp_le_u32 s45, 4
 s_cselect_b32 s40, 3, 1
 s_branch vwe_172
vwx_155:
 s_waitcnt vmcnt(8)
 s_branch vwx_156
vwx_165:
 s_waitcnt vmcnt(8)
 s_branch vwx_166
vwm_157:
 s_mov_b32 s40, 0
 s_waitcnt vmcnt(10)
 s_mov_b64 exec, 1
 v_mov_b32 v20, s45
 buffer_store_dword v20, v10, s[72:75], s44 offen sc1
 s_mov_b64 exec, -1
 s_mov_b32 s70, s45
 s_branch vwm_158
vwm_167:
 s_mov_b32 s40, 0
 s_waitcnt vmcnt(10)
 s_mov_b64 exec, 1
 v_mov_b32 v20, s45
 buffer_store_dword v20, v10, s[72:75], s44 offen sc1
 s_mov_b64 exec, -1
 s_mov_b32 s70, s45
 s_branch vwm_168
vwd_154:
 s_nop 4
 v_cvt_pk_bf16_f32 v44, v104, v105
 v_cvt_pk_bf16_f32 v45, v106, v107
 v_cvt_pk_bf16_f32 v46, v108, v109
 v_cvt_pk_bf16_f32 v47, v110, v111
 s_add_u32 s69, s68, 4096
 buffer_store_dwordx4 v[44:47], v4, s[24:27], s69 offen offset:1024 sc1
 v_cvt_pk_bf16_f32 v48, v112, v113
 v_cvt_pk_bf16_f32 v49, v114, v115
 v_cvt_pk_bf16_f32 v50, v116, v117
 v_cvt_pk_bf16_f32 v51, v118, v119
 buffer_store_dwordx4 v[48:51], v4, s[24:27], s69 offen offset:2048 sc1
 v_cvt_pk_bf16_f32 v52, v120, v121
 v_cvt_pk_bf16_f32 v53, v122, v123
 v_cvt_pk_bf16_f32 v54, v124, v125
 v_cvt_pk_bf16_f32 v55, v126, v127
 buffer_store_dwordx4 v[52:55], v4, s[24:27], s69 offen offset:3072 sc1
 v_cvt_pk_bf16_f32 v56, v128, v129
 v_cvt_pk_bf16_f32 v57, v130, v131
 v_cvt_pk_bf16_f32 v58, v132, v133
 v_cvt_pk_bf16_f32 v59, v134, v135
 s_add_u32 s69, s68, 8192
 buffer_store_dwordx4 v[56:59], v4, s[24:27], s69 offen offset:0 sc1
 v_cvt_pk_bf16_f32 v60, v136, v137
 v_cvt_pk_bf16_f32 v61, v138, v139
 v_cvt_pk_bf16_f32 v62, v140, v141
 v_cvt_pk_bf16_f32 v63, v142, v143
 buffer_store_dwordx4 v[60:63], v4, s[24:27], s69 offen offset:1024 sc1
 s_waitcnt vmcnt(0)
 s_mov_b64 exec, 1
 v_mov_b32 v20, s45
 buffer_store_dword v20, v10, s[72:75], s44 offen sc1
 s_mov_b64 exec, -1
 s_mov_b32 s84, 0
 s_mov_b32 s85, -1
 s_and_b32 s21, s3, 3
 s_cmp_lt_u32 s21, 2
 s_cbranch_scc1 queue
 s_sub_u32 s22, s21, 2
 s_lshl_b32 s22, s22, 3
 s_bfe_u32 s21, s3, 0x30002
 s_add_u32 s21, s21, s22
 s_add_u32 s87, s21, 264
 s_add_u32 s21, s21, 48
 s_mov_b32 s87, -1
 s_waitcnt vmcnt(0) lgkmcnt(0)
 s_barrier
 s_branch do_opb2
 s_mov_b32 s84, 0
 s_mov_b32 s85, -1
 s_mov_b32 s86, 0
 s_branch queue
not_vw:
 s_sub_u32 s2, s3, 96
armed:
 s_load_dwordx2 s[72:73], s[0:1], 104
 s_waitcnt lgkmcnt(0)
 s_add_u32 s72, s72, 81068032
 s_addc_u32 s73, s73, 0
 s_mov_b32 s74, 129024
 s_mov_b32 s75, 0x00020000
 s_load_dwordx2 s[4:5], s[0:1], 0
 s_load_dwordx2 s[6:7], s[0:1], 64
 s_load_dwordx2 s[38:39], s[0:1], 104
 s_mov_b32 s64, s32
 s_mov_b32 s65, s33
 s_mov_b32 s66, s34
 s_mov_b32 s67, s35
 s_lshr_b32 s41, s2, 1
 s_and_b32 s42, s2, 1
 s_waitcnt lgkmcnt(0)
 s_mov_b32 s8, s4
 s_mov_b32 s9, s5
 s_mov_b32 s10, 2621440
 s_mov_b32 s11, 0x00020000
 s_mov_b32 s12, s6
 s_mov_b32 s13, s7
 s_mov_b32 s14, 2457600
 s_mov_b32 s15, 0x00020000
 s_add_u32 s16, s38, 70713344
 s_addc_u32 s17, s39, 0
 s_mov_b32 s18, 2641920
 s_mov_b32 s19, 0x00020000
 s_add_u32 s72, s38, 81068032
 s_addc_u32 s73, s39, 0
 s_mov_b32 s74, 129024
 s_mov_b32 s75, 0x00020000
 s_lshl_b32 s21, s2, 2
 s_add_u32 s21, s21, s20
 s_mul_i32 s21, s21, 19200
 v_lshlrev_b32 v5, 4, v1
 buffer_load_dwordx4 v[64:67], v5, s[12:15], s21 offen offset:0
 buffer_load_dwordx4 v[64:67], v5, s[12:15], s21 offen offset:1024
 buffer_load_dwordx4 v[64:67], v5, s[12:15], s21 offen offset:2048
 buffer_load_dwordx4 v[64:67], v5, s[12:15], s21 offen offset:3072
 s_add_u32 s21, s21, 4096
 buffer_load_dwordx4 v[64:67], v5, s[12:15], s21 offen offset:0
 buffer_load_dwordx4 v[64:67], v5, s[12:15], s21 offen offset:1024
 buffer_load_dwordx4 v[64:67], v5, s[12:15], s21 offen offset:2048
 buffer_load_dwordx4 v[64:67], v5, s[12:15], s21 offen offset:3072
 s_add_u32 s21, s21, 4096
 buffer_load_dwordx4 v[64:67], v5, s[12:15], s21 offen offset:0
 buffer_load_dwordx4 v[64:67], v5, s[12:15], s21 offen offset:1024
 buffer_load_dwordx4 v[64:67], v5, s[12:15], s21 offen offset:2048
 buffer_load_dwordx4 v[64:67], v5, s[12:15], s21 offen offset:3072
 s_add_u32 s21, s21, 4096
 buffer_load_dwordx4 v[64:67], v5, s[12:15], s21 offen offset:0
 buffer_load_dwordx4 v[64:67], v5, s[12:15], s21 offen offset:1024
 buffer_load_dwordx4 v[64:67], v5, s[12:15], s21 offen offset:2048
 buffer_load_dwordx4 v[64:67], v5, s[12:15], s21 offen offset:3072
 s_add_u32 s21, s21, 4096
 buffer_load_dwordx4 v[64:67], v5, s[12:15], s21 offen offset:0
 buffer_load_dwordx4 v[64:67], v5, s[12:15], s21 offen offset:1024
 buffer_load_dwordx4 v[64:67], v5, s[12:15], s21 offen offset:2048
 s_waitcnt vmcnt(0)
 v_lshlrev_b32 v6, 1, v3
 v_add_u32 v6, 0, v6
 v_xor_b32 v6, v6, v2
 v_min_u32 v6, 14, v6
 v_mul_u32_u24 v7, 52, v6
 v_lshrrev_b32 v7, 8, v7
 v_mul_u32_u24 v7, 1200, v7
 v_lshl_add_u32 v7, v6, 4, v7
 v_mul_u32_u24 v6, 3840, v3
 v_add_u32 v4, v6, v7
 v_lshlrev_b32 v6, 1, v3
 v_add_u32 v6, 8, v6
 v_xor_b32 v6, v6, v2
 v_min_u32 v6, 14, v6
 v_mul_u32_u24 v7, 52, v6
 v_lshrrev_b32 v7, 8, v7
 v_mul_u32_u24 v7, 1200, v7
 v_lshl_add_u32 v7, v6, 4, v7
 v_mul_u32_u24 v6, 3840, v3
 v_add_u32 v5, v6, v7
 s_mul_i32 s21, s41, 80
 s_mul_i32 s22, s20, 15360
 s_add_u32 s21, s21, s22
 s_lshl_b32 s22, s20, 10
 s_cmp_ge_u32 s20, 2
 s_cselect_b64 vcc, -1, 0
 v_cndmask_b32 v4, v4, v5, vcc
 s_add_u32 m0, s22, 0
 s_nop 0
 buffer_load_dwordx4 v4, s[12:15], s21 offen lds
 s_add_u32 s21, s21, 61440
 s_add_u32 m0, s22, 4096
 s_nop 0
 buffer_load_dwordx4 v4, s[12:15], s21 offen lds
 s_add_u32 s21, s21, 61440
 s_add_u32 m0, s22, 8192
 s_nop 0
 buffer_load_dwordx4 v4, s[12:15], s21 offen lds
 s_add_u32 s21, s21, 61440
 s_add_u32 m0, s22, 12288
 s_nop 0
 buffer_load_dwordx4 v4, s[12:15], s21 offen lds
 s_add_u32 s21, s21, 61440
 s_add_u32 m0, s22, 16384
 s_nop 0
 buffer_load_dwordx4 v4, s[12:15], s21 offen lds
 s_add_u32 s21, s21, 61440
 s_add_u32 m0, s22, 20480
 s_nop 0
 buffer_load_dwordx4 v4, s[12:15], s21 offen lds
 s_add_u32 s21, s21, 61440
 s_add_u32 m0, s22, 24576
 s_nop 0
 buffer_load_dwordx4 v4, s[12:15], s21 offen lds
 s_add_u32 s21, s21, 61440
 s_add_u32 m0, s22, 28672
 s_nop 0
 buffer_load_dwordx4 v4, s[12:15], s21 offen lds
 s_add_u32 s21, s21, 61440
 s_add_u32 m0, s22, 32768
 s_nop 0
 buffer_load_dwordx4 v4, s[12:15], s21 offen lds
 s_add_u32 s21, s21, 61440
 s_add_u32 m0, s22, 36864
 s_nop 0
 buffer_load_dwordx4 v4, s[12:15], s21 offen lds
 s_add_u32 s21, s21, 61440
 s_add_u32 m0, s22, 40960
 s_nop 0
 buffer_load_dwordx4 v4, s[12:15], s21 offen lds
 s_add_u32 s21, s21, 61440
 s_add_u32 m0, s22, 45056
 s_nop 0
 buffer_load_dwordx4 v4, s[12:15], s21 offen lds
 s_add_u32 s21, s21, 61440
 s_add_u32 m0, s22, 49152
 s_nop 0
 buffer_load_dwordx4 v4, s[12:15], s21 offen lds
 s_add_u32 s21, s21, 61440
 s_add_u32 m0, s22, 53248
 s_nop 0
 buffer_load_dwordx4 v4, s[12:15], s21 offen lds
 s_add_u32 s21, s21, 61440
 s_add_u32 m0, s22, 57344
 s_nop 0
 buffer_load_dwordx4 v4, s[12:15], s21 offen lds
 s_add_u32 s21, s21, 61440
 s_add_u32 m0, s22, 61440
 s_nop 0
 buffer_load_dwordx4 v4, s[12:15], s21 offen lds
 s_add_u32 s21, s21, 61440
 s_add_u32 m0, s22, 65536
 s_nop 0
 buffer_load_dwordx4 v4, s[12:15], s21 offen lds
 s_add_u32 s21, s21, 61440
 s_add_u32 m0, s22, 69632
 s_nop 0
 buffer_load_dwordx4 v4, s[12:15], s21 offen lds
 s_add_u32 s21, s21, 61440
 s_add_u32 m0, s22, 73728
 s_nop 0
 buffer_load_dwordx4 v4, s[12:15], s21 offen lds
 s_add_u32 s21, s21, 61440
 s_add_u32 m0, s22, 77824
 s_nop 0
 buffer_load_dwordx4 v4, s[12:15], s21 offen lds
 s_add_u32 s21, s21, 61440
 s_add_u32 m0, s22, 81920
 s_nop 0
 buffer_load_dwordx4 v4, s[12:15], s21 offen lds
 s_add_u32 s21, s21, 61440
 s_add_u32 m0, s22, 86016
 s_nop 0
 buffer_load_dwordx4 v4, s[12:15], s21 offen lds
 s_add_u32 s21, s21, 61440
 s_add_u32 m0, s22, 90112
 s_nop 0
 buffer_load_dwordx4 v4, s[12:15], s21 offen lds
 s_add_u32 s21, s21, 61440
 s_add_u32 m0, s22, 94208
 s_nop 0
 buffer_load_dwordx4 v4, s[12:15], s21 offen lds
 s_add_u32 s21, s21, 61440
 s_add_u32 m0, s22, 98304
 s_nop 0
 buffer_load_dwordx4 v4, s[12:15], s21 offen lds
 s_add_u32 s21, s21, 61440
 s_add_u32 m0, s22, 102400
 s_nop 0
 buffer_load_dwordx4 v4, s[12:15], s21 offen lds
 s_add_u32 s21, s21, 61440
 s_add_u32 m0, s22, 106496
 s_nop 0
 buffer_load_dwordx4 v4, s[12:15], s21 offen lds
 s_add_u32 s21, s21, 61440
 s_add_u32 m0, s22, 110592
 s_nop 0
 buffer_load_dwordx4 v4, s[12:15], s21 offen lds
 s_add_u32 s21, s21, 61440
 s_add_u32 m0, s22, 114688
 s_nop 0
 buffer_load_dwordx4 v4, s[12:15], s21 offen lds
 s_add_u32 s21, s21, 61440
 s_add_u32 m0, s22, 118784
 s_nop 0
 buffer_load_dwordx4 v4, s[12:15], s21 offen lds
 s_add_u32 s21, s21, 61440
 s_add_u32 m0, s22, 122880
 s_nop 0
 buffer_load_dwordx4 v4, s[12:15], s21 offen lds
 s_add_u32 s21, s21, 61440
 s_add_u32 m0, s22, 126976
 s_nop 0
 buffer_load_dwordx4 v4, s[12:15], s21 offen lds
 s_add_u32 s21, s21, 61440
 s_add_u32 m0, s22, 131072
 s_nop 0
 buffer_load_dwordx4 v4, s[12:15], s21 offen lds
 s_add_u32 s21, s21, 61440
 s_add_u32 m0, s22, 135168
 s_nop 0
 buffer_load_dwordx4 v4, s[12:15], s21 offen lds
 s_add_u32 s21, s21, 61440
 s_add_u32 m0, s22, 139264
 s_nop 0
 buffer_load_dwordx4 v4, s[12:15], s21 offen lds
 s_add_u32 s21, s21, 61440
 s_add_u32 m0, s22, 143360
 s_nop 0
 buffer_load_dwordx4 v4, s[12:15], s21 offen lds
 s_add_u32 s21, s21, 61440
 s_add_u32 m0, s22, 147456
 s_nop 0
 buffer_load_dwordx4 v4, s[12:15], s21 offen lds
 s_add_u32 s21, s21, 61440
 s_add_u32 m0, s22, 151552
 s_nop 0
 buffer_load_dwordx4 v4, s[12:15], s21 offen lds
 s_add_u32 s21, s21, 61440
 s_add_u32 m0, s22, 155648
 s_nop 0
 buffer_load_dwordx4 v4, s[12:15], s21 offen lds
 s_add_u32 s21, s21, 61440
 s_add_u32 m0, s22, 159744
 s_nop 0
 buffer_load_dwordx4 v4, s[12:15], s21 offen lds
 s_add_u32 s21, s21, 61440
 s_lshl_b32 s21, s2, 2
 s_add_u32 s21, s21, s20
 s_mul_i32 s21, s21, 20480
 v_lshlrev_b32 v5, 4, v1
 buffer_load_dwordx4 v[64:67], v5, s[8:11], s21 offen offset:0
 buffer_load_dwordx4 v[64:67], v5, s[8:11], s21 offen offset:1024
 buffer_load_dwordx4 v[64:67], v5, s[8:11], s21 offen offset:2048
 buffer_load_dwordx4 v[64:67], v5, s[8:11], s21 offen offset:3072
 s_add_u32 s21, s21, 4096
 buffer_load_dwordx4 v[64:67], v5, s[8:11], s21 offen offset:0
 buffer_load_dwordx4 v[64:67], v5, s[8:11], s21 offen offset:1024
 buffer_load_dwordx4 v[64:67], v5, s[8:11], s21 offen offset:2048
 buffer_load_dwordx4 v[64:67], v5, s[8:11], s21 offen offset:3072
 s_add_u32 s21, s21, 4096
 buffer_load_dwordx4 v[64:67], v5, s[8:11], s21 offen offset:0
 buffer_load_dwordx4 v[64:67], v5, s[8:11], s21 offen offset:1024
 buffer_load_dwordx4 v[64:67], v5, s[8:11], s21 offen offset:2048
 buffer_load_dwordx4 v[64:67], v5, s[8:11], s21 offen offset:3072
 s_add_u32 s21, s21, 4096
 buffer_load_dwordx4 v[64:67], v5, s[8:11], s21 offen offset:0
 buffer_load_dwordx4 v[64:67], v5, s[8:11], s21 offen offset:1024
 buffer_load_dwordx4 v[64:67], v5, s[8:11], s21 offen offset:2048
 buffer_load_dwordx4 v[64:67], v5, s[8:11], s21 offen offset:3072
 s_add_u32 s21, s21, 4096
 buffer_load_dwordx4 v[64:67], v5, s[8:11], s21 offen offset:0
 buffer_load_dwordx4 v[64:67], v5, s[8:11], s21 offen offset:1024
 buffer_load_dwordx4 v[64:67], v5, s[8:11], s21 offen offset:2048
 buffer_load_dwordx4 v[64:67], v5, s[8:11], s21 offen offset:3072
 v_lshrrev_b32 v6, 2, v2
 v_lshl_add_u32 v7, v3, 3, v6
 v_and_b32 v8, 1, v3
 v_lshl_add_u32 v6, v8, 2, v6
 v_lshlrev_b32 v6, 1, v6
 v_bfe_u32 v8, v2, 1, 1
 s_lshl_b32 s21, s20, 2
 v_add_u32 v8, s21, v8
 v_and_b32 v9, 1, v2
 v_lshlrev_b32 v9, 3, v9
 v_lshl_add_u32 v9, v7, 8, v9
 v_add_u32 v5, 0, v8
 v_xor_b32 v5, v5, v6
 v_lshl_add_u32 v44, v5, 4, v9
 v_add_u32 v45, 65536, v44
 v_add_u32 v46, 131072, v44
 v_add_u32 v5, 2, v8
 v_xor_b32 v5, v5, v6
 v_lshl_add_u32 v47, v5, 4, v9
 v_add_u32 v48, 65536, v47
 v_add_u32 v49, 131072, v47
 s_waitcnt vmcnt(50) lgkmcnt(0)
 s_barrier
 ds_read_b64_tr_b16 a[0:1], v44 offset:0
 ds_read_b64_tr_b16 a[2:3], v44 offset:1024
 ds_read_b64_tr_b16 a[4:5], v47 offset:0
 ds_read_b64_tr_b16 a[6:7], v47 offset:1024
 ds_read_b64_tr_b16 a[8:9], v44 offset:8192
 ds_read_b64_tr_b16 a[10:11], v44 offset:9216
 ds_read_b64_tr_b16 a[12:13], v47 offset:8192
 ds_read_b64_tr_b16 a[14:15], v47 offset:9216
 ds_read_b64_tr_b16 a[16:17], v44 offset:16384
 ds_read_b64_tr_b16 a[18:19], v44 offset:17408
 ds_read_b64_tr_b16 a[20:21], v47 offset:16384
 ds_read_b64_tr_b16 a[22:23], v47 offset:17408
 ds_read_b64_tr_b16 a[24:25], v44 offset:24576
 ds_read_b64_tr_b16 a[26:27], v44 offset:25600
 ds_read_b64_tr_b16 a[28:29], v47 offset:24576
 ds_read_b64_tr_b16 a[30:31], v47 offset:25600
 ds_read_b64_tr_b16 a[32:33], v44 offset:32768
 ds_read_b64_tr_b16 a[34:35], v44 offset:33792
 ds_read_b64_tr_b16 a[36:37], v47 offset:32768
 ds_read_b64_tr_b16 a[38:39], v47 offset:33792
 s_waitcnt vmcnt(40) lgkmcnt(0)
 s_barrier
 ds_read_b64_tr_b16 a[40:41], v44 offset:40960
 ds_read_b64_tr_b16 a[42:43], v44 offset:41984
 ds_read_b64_tr_b16 a[44:45], v47 offset:40960
 ds_read_b64_tr_b16 a[46:47], v47 offset:41984
 ds_read_b64_tr_b16 a[48:49], v44 offset:49152
 ds_read_b64_tr_b16 a[50:51], v44 offset:50176
 ds_read_b64_tr_b16 a[52:53], v47 offset:49152
 ds_read_b64_tr_b16 a[54:55], v47 offset:50176
 ds_read_b64_tr_b16 a[56:57], v44 offset:57344
 ds_read_b64_tr_b16 a[58:59], v44 offset:58368
 ds_read_b64_tr_b16 a[60:61], v47 offset:57344
 ds_read_b64_tr_b16 a[62:63], v47 offset:58368
 ds_read_b64_tr_b16 a[64:65], v45 offset:0
 ds_read_b64_tr_b16 a[66:67], v45 offset:1024
 ds_read_b64_tr_b16 a[68:69], v48 offset:0
 ds_read_b64_tr_b16 a[70:71], v48 offset:1024
 ds_read_b64_tr_b16 a[72:73], v45 offset:8192
 ds_read_b64_tr_b16 a[74:75], v45 offset:9216
 ds_read_b64_tr_b16 a[76:77], v48 offset:8192
 ds_read_b64_tr_b16 a[78:79], v48 offset:9216
 s_waitcnt vmcnt(30) lgkmcnt(0)
 s_barrier
 s_mul_i32 s24, s42, 1280
 v_lshrrev_b32 v11, 3, v1
 v_and_b32 v12, 7, v1
 v_xor_b32 v12, v12, v11
 v_mul_u32_u24 v11, 2560, v11
 v_lshl_add_u32 v10, v12, 4, v11
 s_mul_i32 s46, s20, 81920
 v_add_u32 v10, s46, v10
 s_lshl_b32 s47, s20, 12
 s_add_u32 s47, s47, 0
 s_add_u32 s46, s47, 114688
 s_mov_b32 s30, s24
 s_add_u32 s32, s47, 0
 v_add_u32 v11, 19456, v10
 v_add_u32 v12, 38912, v10
 v_add_u32 v13, 58368, v10
 s_mov_b32 m0, s32
 s_nop 0
 buffer_load_dwordx4 v10, s[8:11], s30 offen offset:0 lds
 buffer_load_dwordx4 v11, s[8:11], s30 offen offset:1024 lds
 buffer_load_dwordx4 v12, s[8:11], s30 offen offset:2048 lds
 buffer_load_dwordx4 v13, s[8:11], s30 offen offset:3072 lds
 s_add_u32 s30, s30, 128
 s_add_u32 s32, s32, 16384
 s_cmp_lt_u32 s32, s46
 s_cselect_b32 s32, s32, s47
 s_mov_b32 m0, s32
 s_nop 0
 buffer_load_dwordx4 v10, s[8:11], s30 offen offset:0 lds
 buffer_load_dwordx4 v11, s[8:11], s30 offen offset:1024 lds
 buffer_load_dwordx4 v12, s[8:11], s30 offen offset:2048 lds
 buffer_load_dwordx4 v13, s[8:11], s30 offen offset:3072 lds
 s_add_u32 s30, s30, 128
 s_add_u32 s32, s32, 16384
 s_cmp_lt_u32 s32, s46
 s_cselect_b32 s32, s32, s47
 s_mov_b32 m0, s32
 s_nop 0
 buffer_load_dwordx4 v10, s[8:11], s30 offen offset:0 lds
 buffer_load_dwordx4 v11, s[8:11], s30 offen offset:1024 lds
 buffer_load_dwordx4 v12, s[8:11], s30 offen offset:2048 lds
 buffer_load_dwordx4 v13, s[8:11], s30 offen offset:3072 lds
 s_add_u32 s30, s30, 128
 s_add_u32 s32, s32, 16384
 s_cmp_lt_u32 s32, s46
 s_cselect_b32 s32, s32, s47
 s_mov_b32 m0, s32
 s_nop 0
 buffer_load_dwordx4 v10, s[8:11], s30 offen offset:0 lds
 buffer_load_dwordx4 v11, s[8:11], s30 offen offset:1024 lds
 buffer_load_dwordx4 v12, s[8:11], s30 offen offset:2048 lds
 buffer_load_dwordx4 v13, s[8:11], s30 offen offset:3072 lds
 s_add_u32 s30, s30, 128
 s_add_u32 s32, s32, 16384
 s_cmp_lt_u32 s32, s46
 s_cselect_b32 s32, s32, s47
 s_mov_b32 m0, s32
 s_nop 0
 buffer_load_dwordx4 v10, s[8:11], s30 offen offset:0 lds
 buffer_load_dwordx4 v11, s[8:11], s30 offen offset:1024 lds
 buffer_load_dwordx4 v12, s[8:11], s30 offen offset:2048 lds
 buffer_load_dwordx4 v13, s[8:11], s30 offen offset:3072 lds
 s_add_u32 s30, s30, 128
 s_add_u32 s32, s32, 16384
 s_cmp_lt_u32 s32, s46
 s_cselect_b32 s32, s32, s47
 ds_read_b64_tr_b16 a[80:81], v45 offset:16384
 ds_read_b64_tr_b16 a[82:83], v45 offset:17408
 ds_read_b64_tr_b16 a[84:85], v48 offset:16384
 ds_read_b64_tr_b16 a[86:87], v48 offset:17408
 ds_read_b64_tr_b16 a[88:89], v45 offset:24576
 ds_read_b64_tr_b16 a[90:91], v45 offset:25600
 ds_read_b64_tr_b16 a[92:93], v48 offset:24576
 ds_read_b64_tr_b16 a[94:95], v48 offset:25600
 ds_read_b64_tr_b16 a[96:97], v45 offset:32768
 ds_read_b64_tr_b16 a[98:99], v45 offset:33792
 ds_read_b64_tr_b16 a[100:101], v48 offset:32768
 ds_read_b64_tr_b16 a[102:103], v48 offset:33792
 ds_read_b64_tr_b16 a[104:105], v45 offset:40960
 ds_read_b64_tr_b16 a[106:107], v45 offset:41984
 ds_read_b64_tr_b16 a[108:109], v48 offset:40960
 ds_read_b64_tr_b16 a[110:111], v48 offset:41984
 ds_read_b64_tr_b16 a[112:113], v45 offset:49152
 ds_read_b64_tr_b16 a[114:115], v45 offset:50176
 ds_read_b64_tr_b16 a[116:117], v48 offset:49152
 ds_read_b64_tr_b16 a[118:119], v48 offset:50176
 s_waitcnt vmcnt(40) lgkmcnt(0)
 s_barrier
 ds_read_b64_tr_b16 a[120:121], v45 offset:57344
 ds_read_b64_tr_b16 a[122:123], v45 offset:58368
 ds_read_b64_tr_b16 a[124:125], v48 offset:57344
 ds_read_b64_tr_b16 a[126:127], v48 offset:58368
 ds_read_b64_tr_b16 a[128:129], v46 offset:0
 ds_read_b64_tr_b16 a[130:131], v46 offset:1024
 ds_read_b64_tr_b16 a[132:133], v49 offset:0
 ds_read_b64_tr_b16 a[134:135], v49 offset:1024
 ds_read_b64_tr_b16 a[136:137], v46 offset:8192
 ds_read_b64_tr_b16 a[138:139], v46 offset:9216
 ds_read_b64_tr_b16 a[140:141], v49 offset:8192
 ds_read_b64_tr_b16 a[142:143], v49 offset:9216
 ds_read_b64_tr_b16 a[144:145], v46 offset:16384
 ds_read_b64_tr_b16 a[146:147], v46 offset:17408
 ds_read_b64_tr_b16 a[148:149], v49 offset:16384
 ds_read_b64_tr_b16 a[150:151], v49 offset:17408
 ds_read_b64_tr_b16 a[152:153], v46 offset:24576
 ds_read_b64_tr_b16 a[154:155], v46 offset:25600
 ds_read_b64_tr_b16 a[156:157], v49 offset:24576
 ds_read_b64_tr_b16 a[158:159], v49 offset:25600
 s_waitcnt lgkmcnt(0)
 s_barrier
 s_load_dwordx2 s[12:13], s[0:1], 72
 s_lshl_b32 s21, s2, 2
 s_add_u32 s21, s21, s20
 s_mul_i32 s50, s21, 6400
 s_add_u32 s51, s50, 4096
 v_lshlrev_b32 v33, 4, v1
 s_mov_b32 s14, 819200
 v_mov_b32 v32, 76
 s_waitcnt lgkmcnt(0)
 v_and_b32 v4, 31, v1
 s_lshl_b32 s21, s20, 5
 v_add_u32 v36, s21, v4
 v_lshrrev_b32 v5, 5, v1
 v_mul_u32_u24 v6, 264, v36
 v_mul_u32_u24 v7, 40, v5
 s_mov_b32 s21, 114952
 v_add3_u32 v34, v6, v7, s21
 v_lshl_add_u32 v38, v5, 3, v34
 v_lshlrev_b32 v6, 5, v5
 v_sub_u32 v39, v34, v6
 v_lshlrev_b32 v35, 3, v1
 v_add_u32 v35, 114688, v35
 v_mov_b32 v37, 0xf149f2ca
 s_mul_i32 s21, s41, 165120
 s_mul_i32 s22, s42, 16512
 s_add_u32 s21, s21, s22
 v_lshl_add_u32 v7, v36, 4, s21
 v_mul_u32_u24 v6, 99072, v5
 v_add_u32 v29, v6, v7
 v_add_u32 v30, 33024, v29
 v_lshl_add_u32 v31, v5, 3, v7
 v_add_u32 v31, 66048, v31
 v_mov_b32 v8, 0
 v_mov_b32 v9, 0
 ds_write_b64 v35, v[8:9] offset:0
 ds_write_b64 v35, v[8:9] offset:512
 ds_write_b64 v35, v[8:9] offset:1024
 ds_write_b64 v35, v[8:9] offset:1536
 ds_write_b64 v35, v[8:9] offset:2048
 s_mul_i32 s24, s42, 1280
 s_mov_b32 s25, 327680
 s_mov_b32 s26, 8
 s_mov_b32 s27, 0
 s_mov_b32 s60, 0x3e64f92e
 s_mov_b32 s61, 0x3fb8aa3b
 s_mov_b32 s62, 0x05040100
 s_mov_b32 s63, 0x07060302
 v_cmp_le_u32 s[76:77], 0, v36
 v_cmp_le_u32 s[78:79], 1, v36
 v_cmp_le_u32 s[80:81], 2, v36
 v_cmp_le_u32 s[82:83], 3, v36
 v_cmp_le_u32 s[84:85], 4, v36
 v_cmp_le_u32 s[86:87], 5, v36
 v_cmp_le_u32 s[88:89], 6, v36
 v_cmp_le_u32 s[90:91], 7, v36
 v_and_b32 v6, 7, v2
 v_add_u32 v4, 0, v3
 v_xor_b32 v4, v4, v6
 v_lshlrev_b32 v4, 4, v4
 v_lshl_add_u32 v14, v2, 7, v4
 v_add_u32 v4, 4, v3
 v_xor_b32 v4, v4, v6
 v_lshlrev_b32 v4, 4, v4
 v_lshl_add_u32 v15, v2, 7, v4
 v_mul_u32_u24 v22, 264, v2
 v_mul_u32_u24 v4, 8, v3
 s_mul_i32 s21, s20, 64
 s_add_u32 s21, s21, 116800
 v_add3_u32 v22, v22, v4, s21
 v_lshlrev_b32 v4, 3, v3
 v_sub_u32 v16, v22, v4
 v_mov_b32 v9, 2731
 s_mov_b32 s33, 0
 s_mov_b32 s48, 0x80000000
 s_mov_b32 m0, s32
 s_nop 0
 buffer_load_dwordx4 v10, s[8:11], s30 offen offset:0 lds
 buffer_load_dwordx4 v11, s[8:11], s30 offen offset:1024 lds
 s_waitcnt vmcnt(18)
 s_barrier
 v_add_u32 v18, s33, v14
 v_add_u32 v19, s33, v15
 s_add_u32 s33, s33, 16384
 s_cmp_lt_u32 s33, 114688
 s_cselect_b32 s33, s33, 0
 ds_read_b128 v[160:163], v18 offset:0
 ds_read_b128 v[164:167], v18 offset:2048
 ds_read_b128 v[168:171], v18 offset:4096
 ds_read_b128 v[172:175], v18 offset:6144
 ds_read_b128 v[176:179], v18 offset:8192
 ds_read_b128 v[180:183], v18 offset:10240
 ds_read_b128 v[184:187], v18 offset:12288
 ds_read_b128 v[188:191], v18 offset:14336
 s_waitcnt lgkmcnt(0)
bf_blk_193:
 v_mfma_f32_16x16x32_bf16 v[64:67], a[0:3], v[160:163], 0
 ds_read_b128 v[192:195], v19 offset:0
 v_mfma_f32_16x16x32_bf16 v[68:71], a[4:7], v[160:163], 0
 v_add_u32 v18, s33, v14
 v_mfma_f32_16x16x32_bf16 v[72:75], a[0:3], v[164:167], 0
 ds_read_b128 v[196:199], v19 offset:2048
 v_mfma_f32_16x16x32_bf16 v[76:79], a[4:7], v[164:167], 0
 buffer_load_dwordx4 v12, s[8:11], s30 offen offset:2048 lds
 v_mfma_f32_16x16x32_bf16 v[80:83], a[0:3], v[168:171], 0
 ds_read_b128 v[200:203], v19 offset:4096
 v_mfma_f32_16x16x32_bf16 v[84:87], a[4:7], v[168:171], 0
 v_mfma_f32_16x16x32_bf16 v[88:91], a[0:3], v[172:175], 0
 ds_read_b128 v[204:207], v19 offset:6144
 v_mfma_f32_16x16x32_bf16 v[92:95], a[4:7], v[172:175], 0
 s_waitcnt lgkmcnt(14)
 v_mfma_f32_16x16x32_bf16 v[96:99], a[0:3], v[176:179], 0
 ds_read_b128 v[208:211], v19 offset:8192
 v_mfma_f32_16x16x32_bf16 v[100:103], a[4:7], v[176:179], 0
 v_mfma_f32_16x16x32_bf16 v[104:107], a[0:3], v[180:183], 0
 ds_read_b128 v[212:215], v19 offset:10240
 v_mfma_f32_16x16x32_bf16 v[108:111], a[4:7], v[180:183], 0
 buffer_load_dwordx4 v13, s[8:11], s30 offen offset:3072 lds
 v_mfma_f32_16x16x32_bf16 v[112:115], a[0:3], v[184:187], 0
 ds_read_b128 v[216:219], v19 offset:12288
 s_add_u32 s30, s30, 128
 v_mfma_f32_16x16x32_bf16 v[116:119], a[4:7], v[184:187], 0
 s_add_u32 m0, m0, 16384
 v_mfma_f32_16x16x32_bf16 v[120:123], a[0:3], v[188:191], 0
 ds_read_b128 v[220:223], v19 offset:14336
 v_mfma_f32_16x16x32_bf16 v[124:127], a[4:7], v[188:191], 0
 s_waitcnt vmcnt(16) lgkmcnt(4)
 s_barrier
 v_mfma_f32_16x16x32_bf16 v[64:67], a[8:11], v[192:195], v[64:67]
 ds_read_b128 v[160:163], v18 offset:0
 v_mfma_f32_16x16x32_bf16 v[68:71], a[12:15], v[192:195], v[68:71]
 s_cmp_lt_u32 m0, s46
 s_cselect_b32 m0, m0, s47
 v_mfma_f32_16x16x32_bf16 v[72:75], a[8:11], v[196:199], v[72:75]
 ds_read_b128 v[164:167], v18 offset:2048
 v_add_u32 v19, s33, v15
 v_mfma_f32_16x16x32_bf16 v[76:79], a[12:15], v[196:199], v[76:79]
 buffer_load_dwordx4 v10, s[8:11], s30 offen offset:0 lds
 v_mfma_f32_16x16x32_bf16 v[80:83], a[8:11], v[200:203], v[80:83]
 ds_read_b128 v[168:171], v18 offset:4096
 s_add_u32 s33, s33, 16384
 v_mfma_f32_16x16x32_bf16 v[84:87], a[12:15], v[200:203], v[84:87]
 s_cmp_lt_u32 s33, 114688
 s_cselect_b32 s33, s33, 0
 v_mfma_f32_16x16x32_bf16 v[88:91], a[8:11], v[204:207], v[88:91]
 ds_read_b128 v[172:175], v18 offset:6144
 v_mfma_f32_16x16x32_bf16 v[92:95], a[12:15], v[204:207], v[92:95]
 s_waitcnt lgkmcnt(4)
 v_mfma_f32_16x16x32_bf16 v[96:99], a[8:11], v[208:211], v[96:99]
 ds_read_b128 v[176:179], v18 offset:8192
 v_mfma_f32_16x16x32_bf16 v[100:103], a[12:15], v[208:211], v[100:103]
 v_mfma_f32_16x16x32_bf16 v[104:107], a[8:11], v[212:215], v[104:107]
 ds_read_b128 v[180:183], v18 offset:10240
 v_mfma_f32_16x16x32_bf16 v[108:111], a[12:15], v[212:215], v[108:111]
 buffer_load_dwordx4 v11, s[8:11], s30 offen offset:1024 lds
 v_mfma_f32_16x16x32_bf16 v[112:115], a[8:11], v[216:219], v[112:115]
 ds_read_b128 v[184:187], v18 offset:12288
 v_mfma_f32_16x16x32_bf16 v[116:119], a[12:15], v[216:219], v[116:119]
 v_mfma_f32_16x16x32_bf16 v[120:123], a[8:11], v[220:223], v[120:123]
 ds_read_b128 v[188:191], v18 offset:14336
 v_mfma_f32_16x16x32_bf16 v[124:127], a[12:15], v[220:223], v[124:127]
 s_waitcnt lgkmcnt(4)
 v_mfma_f32_16x16x32_bf16 v[64:67], a[16:19], v[160:163], v[64:67]
 ds_read_b128 v[192:195], v19 offset:0
 v_mfma_f32_16x16x32_bf16 v[68:71], a[20:23], v[160:163], v[68:71]
 v_add_u32 v18, s33, v14
 v_mfma_f32_16x16x32_bf16 v[72:75], a[16:19], v[164:167], v[72:75]
 ds_read_b128 v[196:199], v19 offset:2048
 v_mfma_f32_16x16x32_bf16 v[76:79], a[20:23], v[164:167], v[76:79]
 buffer_load_dwordx4 v12, s[8:11], s30 offen offset:2048 lds
 v_mfma_f32_16x16x32_bf16 v[80:83], a[16:19], v[168:171], v[80:83]
 ds_read_b128 v[200:203], v19 offset:4096
 v_mfma_f32_16x16x32_bf16 v[84:87], a[20:23], v[168:171], v[84:87]
 v_mfma_f32_16x16x32_bf16 v[88:91], a[16:19], v[172:175], v[88:91]
 ds_read_b128 v[204:207], v19 offset:6144
 v_mfma_f32_16x16x32_bf16 v[92:95], a[20:23], v[172:175], v[92:95]
 s_waitcnt lgkmcnt(4)
 v_mfma_f32_16x16x32_bf16 v[96:99], a[16:19], v[176:179], v[96:99]
 ds_read_b128 v[208:211], v19 offset:8192
 v_mfma_f32_16x16x32_bf16 v[100:103], a[20:23], v[176:179], v[100:103]
 v_mfma_f32_16x16x32_bf16 v[104:107], a[16:19], v[180:183], v[104:107]
 ds_read_b128 v[212:215], v19 offset:10240
 v_mfma_f32_16x16x32_bf16 v[108:111], a[20:23], v[180:183], v[108:111]
 buffer_load_dwordx4 v13, s[8:11], s30 offen offset:3072 lds
 v_mfma_f32_16x16x32_bf16 v[112:115], a[16:19], v[184:187], v[112:115]
 ds_read_b128 v[216:219], v19 offset:12288
 s_add_u32 s30, s30, 128
 v_mfma_f32_16x16x32_bf16 v[116:119], a[20:23], v[184:187], v[116:119]
 s_add_u32 m0, m0, 16384
 v_mfma_f32_16x16x32_bf16 v[120:123], a[16:19], v[188:191], v[120:123]
 ds_read_b128 v[220:223], v19 offset:14336
 v_mfma_f32_16x16x32_bf16 v[124:127], a[20:23], v[188:191], v[124:127]
 s_waitcnt vmcnt(16) lgkmcnt(4)
 s_barrier
 v_mfma_f32_16x16x32_bf16 v[64:67], a[24:27], v[192:195], v[64:67]
 ds_read_b128 v[160:163], v18 offset:0
 v_mfma_f32_16x16x32_bf16 v[68:71], a[28:31], v[192:195], v[68:71]
 s_cmp_lt_u32 m0, s46
 s_cselect_b32 m0, m0, s47
 v_mfma_f32_16x16x32_bf16 v[72:75], a[24:27], v[196:199], v[72:75]
 ds_read_b128 v[164:167], v18 offset:2048
 v_add_u32 v19, s33, v15
 v_mfma_f32_16x16x32_bf16 v[76:79], a[28:31], v[196:199], v[76:79]
 buffer_load_dwordx4 v10, s[8:11], s30 offen offset:0 lds
 v_mfma_f32_16x16x32_bf16 v[80:83], a[24:27], v[200:203], v[80:83]
 ds_read_b128 v[168:171], v18 offset:4096
 s_add_u32 s33, s33, 16384
 v_mfma_f32_16x16x32_bf16 v[84:87], a[28:31], v[200:203], v[84:87]
 s_cmp_lt_u32 s33, 114688
 s_cselect_b32 s33, s33, 0
 v_mfma_f32_16x16x32_bf16 v[88:91], a[24:27], v[204:207], v[88:91]
 ds_read_b128 v[172:175], v18 offset:6144
 v_mfma_f32_16x16x32_bf16 v[92:95], a[28:31], v[204:207], v[92:95]
 s_waitcnt lgkmcnt(4)
 v_mfma_f32_16x16x32_bf16 v[96:99], a[24:27], v[208:211], v[96:99]
 ds_read_b128 v[176:179], v18 offset:8192
 v_mfma_f32_16x16x32_bf16 v[100:103], a[28:31], v[208:211], v[100:103]
 v_mfma_f32_16x16x32_bf16 v[104:107], a[24:27], v[212:215], v[104:107]
 ds_read_b128 v[180:183], v18 offset:10240
 v_mfma_f32_16x16x32_bf16 v[108:111], a[28:31], v[212:215], v[108:111]
 buffer_load_dwordx4 v11, s[8:11], s30 offen offset:1024 lds
 v_mfma_f32_16x16x32_bf16 v[112:115], a[24:27], v[216:219], v[112:115]
 ds_read_b128 v[184:187], v18 offset:12288
 v_mfma_f32_16x16x32_bf16 v[116:119], a[28:31], v[216:219], v[116:119]
 v_mfma_f32_16x16x32_bf16 v[120:123], a[24:27], v[220:223], v[120:123]
 ds_read_b128 v[188:191], v18 offset:14336
 v_mfma_f32_16x16x32_bf16 v[124:127], a[28:31], v[220:223], v[124:127]
 s_waitcnt lgkmcnt(4)
 v_mfma_f32_16x16x32_bf16 v[64:67], a[32:35], v[160:163], v[64:67]
 ds_read_b128 v[192:195], v19 offset:0
 v_mfma_f32_16x16x32_bf16 v[68:71], a[36:39], v[160:163], v[68:71]
 v_add_u32 v18, s33, v14
 v_mfma_f32_16x16x32_bf16 v[72:75], a[32:35], v[164:167], v[72:75]
 ds_read_b128 v[196:199], v19 offset:2048
 v_mfma_f32_16x16x32_bf16 v[76:79], a[36:39], v[164:167], v[76:79]
 buffer_load_dwordx4 v12, s[8:11], s30 offen offset:2048 lds
 v_mfma_f32_16x16x32_bf16 v[80:83], a[32:35], v[168:171], v[80:83]
 ds_read_b128 v[200:203], v19 offset:4096
 v_mfma_f32_16x16x32_bf16 v[84:87], a[36:39], v[168:171], v[84:87]
 v_mfma_f32_16x16x32_bf16 v[88:91], a[32:35], v[172:175], v[88:91]
 ds_read_b128 v[204:207], v19 offset:6144
 v_mfma_f32_16x16x32_bf16 v[92:95], a[36:39], v[172:175], v[92:95]
 s_waitcnt lgkmcnt(4)
 v_mfma_f32_16x16x32_bf16 v[96:99], a[32:35], v[176:179], v[96:99]
 ds_read_b128 v[208:211], v19 offset:8192
 v_mfma_f32_16x16x32_bf16 v[100:103], a[36:39], v[176:179], v[100:103]
 v_mfma_f32_16x16x32_bf16 v[104:107], a[32:35], v[180:183], v[104:107]
 ds_read_b128 v[212:215], v19 offset:10240
 v_mfma_f32_16x16x32_bf16 v[108:111], a[36:39], v[180:183], v[108:111]
 buffer_load_dwordx4 v13, s[8:11], s30 offen offset:3072 lds
 v_mfma_f32_16x16x32_bf16 v[112:115], a[32:35], v[184:187], v[112:115]
 ds_read_b128 v[216:219], v19 offset:12288
 s_add_u32 s30, s30, 128
 v_mfma_f32_16x16x32_bf16 v[116:119], a[36:39], v[184:187], v[116:119]
 s_add_u32 m0, m0, 16384
 v_mfma_f32_16x16x32_bf16 v[120:123], a[32:35], v[188:191], v[120:123]
 ds_read_b128 v[220:223], v19 offset:14336
 v_mfma_f32_16x16x32_bf16 v[124:127], a[36:39], v[188:191], v[124:127]
 s_waitcnt vmcnt(16) lgkmcnt(4)
 s_barrier
 v_mfma_f32_16x16x32_bf16 v[64:67], a[40:43], v[192:195], v[64:67]
 ds_read_b128 v[160:163], v18 offset:0
 v_mfma_f32_16x16x32_bf16 v[68:71], a[44:47], v[192:195], v[68:71]
 s_cmp_lt_u32 m0, s46
 s_cselect_b32 m0, m0, s47
 v_mfma_f32_16x16x32_bf16 v[72:75], a[40:43], v[196:199], v[72:75]
 ds_read_b128 v[164:167], v18 offset:2048
 v_add_u32 v19, s33, v15
 v_mfma_f32_16x16x32_bf16 v[76:79], a[44:47], v[196:199], v[76:79]
 buffer_load_dwordx4 v10, s[8:11], s30 offen offset:0 lds
 v_mfma_f32_16x16x32_bf16 v[80:83], a[40:43], v[200:203], v[80:83]
 ds_read_b128 v[168:171], v18 offset:4096
 s_add_u32 s33, s33, 16384
 v_mfma_f32_16x16x32_bf16 v[84:87], a[44:47], v[200:203], v[84:87]
 s_cmp_lt_u32 s33, 114688
 s_cselect_b32 s33, s33, 0
 v_mfma_f32_16x16x32_bf16 v[88:91], a[40:43], v[204:207], v[88:91]
 ds_read_b128 v[172:175], v18 offset:6144
 v_mfma_f32_16x16x32_bf16 v[92:95], a[44:47], v[204:207], v[92:95]
 s_waitcnt lgkmcnt(4)
 v_mfma_f32_16x16x32_bf16 v[96:99], a[40:43], v[208:211], v[96:99]
 ds_read_b128 v[176:179], v18 offset:8192
 v_mfma_f32_16x16x32_bf16 v[100:103], a[44:47], v[208:211], v[100:103]
 v_mfma_f32_16x16x32_bf16 v[104:107], a[40:43], v[212:215], v[104:107]
 ds_read_b128 v[180:183], v18 offset:10240
 v_mfma_f32_16x16x32_bf16 v[108:111], a[44:47], v[212:215], v[108:111]
 buffer_load_dwordx4 v11, s[8:11], s30 offen offset:1024 lds
 v_mfma_f32_16x16x32_bf16 v[112:115], a[40:43], v[216:219], v[112:115]
 ds_read_b128 v[184:187], v18 offset:12288
 v_mfma_f32_16x16x32_bf16 v[116:119], a[44:47], v[216:219], v[116:119]
 v_mfma_f32_16x16x32_bf16 v[120:123], a[40:43], v[220:223], v[120:123]
 ds_read_b128 v[188:191], v18 offset:14336
 v_mfma_f32_16x16x32_bf16 v[124:127], a[44:47], v[220:223], v[124:127]
 s_waitcnt lgkmcnt(4)
 v_mfma_f32_16x16x32_bf16 v[64:67], a[48:51], v[160:163], v[64:67]
 ds_read_b128 v[192:195], v19 offset:0
 v_mfma_f32_16x16x32_bf16 v[68:71], a[52:55], v[160:163], v[68:71]
 v_add_u32 v18, s33, v14
 v_mfma_f32_16x16x32_bf16 v[72:75], a[48:51], v[164:167], v[72:75]
 ds_read_b128 v[196:199], v19 offset:2048
 v_mfma_f32_16x16x32_bf16 v[76:79], a[52:55], v[164:167], v[76:79]
 buffer_load_dwordx4 v12, s[8:11], s30 offen offset:2048 lds
 v_mfma_f32_16x16x32_bf16 v[80:83], a[48:51], v[168:171], v[80:83]
 ds_read_b128 v[200:203], v19 offset:4096
 v_mfma_f32_16x16x32_bf16 v[84:87], a[52:55], v[168:171], v[84:87]
 v_mfma_f32_16x16x32_bf16 v[88:91], a[48:51], v[172:175], v[88:91]
 ds_read_b128 v[204:207], v19 offset:6144
 v_mfma_f32_16x16x32_bf16 v[92:95], a[52:55], v[172:175], v[92:95]
 s_waitcnt lgkmcnt(4)
 v_mfma_f32_16x16x32_bf16 v[96:99], a[48:51], v[176:179], v[96:99]
 ds_read_b128 v[208:211], v19 offset:8192
 v_mfma_f32_16x16x32_bf16 v[100:103], a[52:55], v[176:179], v[100:103]
 v_mfma_f32_16x16x32_bf16 v[104:107], a[48:51], v[180:183], v[104:107]
 ds_read_b128 v[212:215], v19 offset:10240
 v_mfma_f32_16x16x32_bf16 v[108:111], a[52:55], v[180:183], v[108:111]
 buffer_load_dwordx4 v13, s[8:11], s30 offen offset:3072 lds
 v_mfma_f32_16x16x32_bf16 v[112:115], a[48:51], v[184:187], v[112:115]
 ds_read_b128 v[216:219], v19 offset:12288
 s_add_u32 s30, s30, 128
 v_mfma_f32_16x16x32_bf16 v[116:119], a[52:55], v[184:187], v[116:119]
 s_add_u32 m0, m0, 16384
 v_mfma_f32_16x16x32_bf16 v[120:123], a[48:51], v[188:191], v[120:123]
 ds_read_b128 v[220:223], v19 offset:14336
 v_mfma_f32_16x16x32_bf16 v[124:127], a[52:55], v[188:191], v[124:127]
 s_waitcnt vmcnt(16) lgkmcnt(4)
 s_barrier
 v_mfma_f32_16x16x32_bf16 v[64:67], a[56:59], v[192:195], v[64:67]
 ds_read_b128 v[160:163], v18 offset:0
 v_mfma_f32_16x16x32_bf16 v[68:71], a[60:63], v[192:195], v[68:71]
 s_cmp_lt_u32 m0, s46
 s_cselect_b32 m0, m0, s47
 v_mfma_f32_16x16x32_bf16 v[72:75], a[56:59], v[196:199], v[72:75]
 ds_read_b128 v[164:167], v18 offset:2048
 v_add_u32 v19, s33, v15
 v_mfma_f32_16x16x32_bf16 v[76:79], a[60:63], v[196:199], v[76:79]
 buffer_load_dwordx4 v10, s[8:11], s30 offen offset:0 lds
 v_mfma_f32_16x16x32_bf16 v[80:83], a[56:59], v[200:203], v[80:83]
 ds_read_b128 v[168:171], v18 offset:4096
 s_add_u32 s33, s33, 16384
 v_mfma_f32_16x16x32_bf16 v[84:87], a[60:63], v[200:203], v[84:87]
 s_cmp_lt_u32 s33, 114688
 s_cselect_b32 s33, s33, 0
 v_mfma_f32_16x16x32_bf16 v[88:91], a[56:59], v[204:207], v[88:91]
 ds_read_b128 v[172:175], v18 offset:6144
 v_mfma_f32_16x16x32_bf16 v[92:95], a[60:63], v[204:207], v[92:95]
 s_waitcnt lgkmcnt(4)
 v_mfma_f32_16x16x32_bf16 v[96:99], a[56:59], v[208:211], v[96:99]
 ds_read_b128 v[176:179], v18 offset:8192
 v_mfma_f32_16x16x32_bf16 v[100:103], a[60:63], v[208:211], v[100:103]
 v_mfma_f32_16x16x32_bf16 v[104:107], a[56:59], v[212:215], v[104:107]
 ds_read_b128 v[180:183], v18 offset:10240
 v_mfma_f32_16x16x32_bf16 v[108:111], a[60:63], v[212:215], v[108:111]
 buffer_load_dwordx4 v11, s[8:11], s30 offen offset:1024 lds
 v_mfma_f32_16x16x32_bf16 v[112:115], a[56:59], v[216:219], v[112:115]
 ds_read_b128 v[184:187], v18 offset:12288
 v_mfma_f32_16x16x32_bf16 v[116:119], a[60:63], v[216:219], v[116:119]
 v_mfma_f32_16x16x32_bf16 v[120:123], a[56:59], v[220:223], v[120:123]
 ds_read_b128 v[188:191], v18 offset:14336
 v_mfma_f32_16x16x32_bf16 v[124:127], a[60:63], v[220:223], v[124:127]
 s_waitcnt lgkmcnt(4)
 v_mfma_f32_16x16x32_bf16 v[64:67], a[64:67], v[160:163], v[64:67]
 ds_read_b128 v[192:195], v19 offset:0
 v_mfma_f32_16x16x32_bf16 v[68:71], a[68:71], v[160:163], v[68:71]
 v_add_u32 v18, s33, v14
 v_mfma_f32_16x16x32_bf16 v[72:75], a[64:67], v[164:167], v[72:75]
 ds_read_b128 v[196:199], v19 offset:2048
 v_mfma_f32_16x16x32_bf16 v[76:79], a[68:71], v[164:167], v[76:79]
 buffer_load_dwordx4 v12, s[8:11], s30 offen offset:2048 lds
 v_mfma_f32_16x16x32_bf16 v[80:83], a[64:67], v[168:171], v[80:83]
 ds_read_b128 v[200:203], v19 offset:4096
 v_mfma_f32_16x16x32_bf16 v[84:87], a[68:71], v[168:171], v[84:87]
 v_mfma_f32_16x16x32_bf16 v[88:91], a[64:67], v[172:175], v[88:91]
 ds_read_b128 v[204:207], v19 offset:6144
 v_mfma_f32_16x16x32_bf16 v[92:95], a[68:71], v[172:175], v[92:95]
 s_waitcnt lgkmcnt(4)
 v_mfma_f32_16x16x32_bf16 v[96:99], a[64:67], v[176:179], v[96:99]
 ds_read_b128 v[208:211], v19 offset:8192
 v_mfma_f32_16x16x32_bf16 v[100:103], a[68:71], v[176:179], v[100:103]
 v_mfma_f32_16x16x32_bf16 v[104:107], a[64:67], v[180:183], v[104:107]
 ds_read_b128 v[212:215], v19 offset:10240
 v_mfma_f32_16x16x32_bf16 v[108:111], a[68:71], v[180:183], v[108:111]
 buffer_load_dwordx4 v13, s[8:11], s30 offen offset:3072 lds
 v_mfma_f32_16x16x32_bf16 v[112:115], a[64:67], v[184:187], v[112:115]
 ds_read_b128 v[216:219], v19 offset:12288
 s_add_u32 s30, s30, s25
 v_mfma_f32_16x16x32_bf16 v[116:119], a[68:71], v[184:187], v[116:119]
 s_sub_u32 s30, s30, 1152
 s_add_u32 m0, m0, 16384
 v_mfma_f32_16x16x32_bf16 v[120:123], a[64:67], v[188:191], v[120:123]
 ds_read_b128 v[220:223], v19 offset:14336
 v_mfma_f32_16x16x32_bf16 v[124:127], a[68:71], v[188:191], v[124:127]
 s_waitcnt vmcnt(16) lgkmcnt(4)
 s_barrier
 v_mfma_f32_16x16x32_bf16 v[64:67], a[72:75], v[192:195], v[64:67]
 ds_read_b128 v[160:163], v18 offset:0
 v_mfma_f32_16x16x32_bf16 v[68:71], a[76:79], v[192:195], v[68:71]
 s_cmp_lt_u32 m0, s46
 s_cselect_b32 m0, m0, s47
 v_mfma_f32_16x16x32_bf16 v[72:75], a[72:75], v[196:199], v[72:75]
 ds_read_b128 v[164:167], v18 offset:2048
 v_add_u32 v19, s33, v15
 v_mfma_f32_16x16x32_bf16 v[76:79], a[76:79], v[196:199], v[76:79]
 buffer_load_dwordx4 v10, s[8:11], s30 offen offset:0 lds
 v_mfma_f32_16x16x32_bf16 v[80:83], a[72:75], v[200:203], v[80:83]
 ds_read_b128 v[168:171], v18 offset:4096
 s_add_u32 s33, s33, 16384
 v_mfma_f32_16x16x32_bf16 v[84:87], a[76:79], v[200:203], v[84:87]
 s_cmp_lt_u32 s33, 114688
 s_cselect_b32 s33, s33, 0
 v_mfma_f32_16x16x32_bf16 v[88:91], a[72:75], v[204:207], v[88:91]
 ds_read_b128 v[172:175], v18 offset:6144
 v_mfma_f32_16x16x32_bf16 v[92:95], a[76:79], v[204:207], v[92:95]
 s_waitcnt lgkmcnt(4)
 v_mfma_f32_16x16x32_bf16 v[96:99], a[72:75], v[208:211], v[96:99]
 ds_read_b128 v[176:179], v18 offset:8192
 v_mfma_f32_16x16x32_bf16 v[100:103], a[76:79], v[208:211], v[100:103]
 v_mfma_f32_16x16x32_bf16 v[104:107], a[72:75], v[212:215], v[104:107]
 ds_read_b128 v[180:183], v18 offset:10240
 v_mfma_f32_16x16x32_bf16 v[108:111], a[76:79], v[212:215], v[108:111]
 buffer_load_dwordx4 v11, s[8:11], s30 offen offset:1024 lds
 v_mfma_f32_16x16x32_bf16 v[112:115], a[72:75], v[216:219], v[112:115]
 ds_read_b128 v[184:187], v18 offset:12288
 v_mfma_f32_16x16x32_bf16 v[116:119], a[76:79], v[216:219], v[116:119]
 v_mfma_f32_16x16x32_bf16 v[120:123], a[72:75], v[220:223], v[120:123]
 ds_read_b128 v[188:191], v18 offset:14336
 v_mfma_f32_16x16x32_bf16 v[124:127], a[76:79], v[220:223], v[124:127]
 s_waitcnt lgkmcnt(4)
 v_mfma_f32_16x16x32_bf16 v[64:67], a[80:83], v[160:163], v[64:67]
 ds_read_b128 v[192:195], v19 offset:0
 v_mfma_f32_16x16x32_bf16 v[68:71], a[84:87], v[160:163], v[68:71]
 v_add_u32 v18, s33, v14
 v_mfma_f32_16x16x32_bf16 v[72:75], a[80:83], v[164:167], v[72:75]
 ds_read_b128 v[196:199], v19 offset:2048
 v_mfma_f32_16x16x32_bf16 v[76:79], a[84:87], v[164:167], v[76:79]
 buffer_load_dwordx4 v12, s[8:11], s30 offen offset:2048 lds
 v_mfma_f32_16x16x32_bf16 v[80:83], a[80:83], v[168:171], v[80:83]
 ds_read_b128 v[200:203], v19 offset:4096
 v_mfma_f32_16x16x32_bf16 v[84:87], a[84:87], v[168:171], v[84:87]
 v_mfma_f32_16x16x32_bf16 v[88:91], a[80:83], v[172:175], v[88:91]
 ds_read_b128 v[204:207], v19 offset:6144
 v_mfma_f32_16x16x32_bf16 v[92:95], a[84:87], v[172:175], v[92:95]
 s_waitcnt lgkmcnt(4)
 v_mfma_f32_16x16x32_bf16 v[96:99], a[80:83], v[176:179], v[96:99]
 ds_read_b128 v[208:211], v19 offset:8192
 v_mfma_f32_16x16x32_bf16 v[100:103], a[84:87], v[176:179], v[100:103]
 v_mfma_f32_16x16x32_bf16 v[104:107], a[80:83], v[180:183], v[104:107]
 ds_read_b128 v[212:215], v19 offset:10240
 v_mfma_f32_16x16x32_bf16 v[108:111], a[84:87], v[180:183], v[108:111]
 buffer_load_dwordx4 v13, s[8:11], s30 offen offset:3072 lds
 v_mfma_f32_16x16x32_bf16 v[112:115], a[80:83], v[184:187], v[112:115]
 ds_read_b128 v[216:219], v19 offset:12288
 s_add_u32 s30, s30, 128
 v_mfma_f32_16x16x32_bf16 v[116:119], a[84:87], v[184:187], v[116:119]
 s_add_u32 m0, m0, 16384
 v_mfma_f32_16x16x32_bf16 v[120:123], a[80:83], v[188:191], v[120:123]
 ds_read_b128 v[220:223], v19 offset:14336
 v_mfma_f32_16x16x32_bf16 v[124:127], a[84:87], v[188:191], v[124:127]
 s_waitcnt vmcnt(16) lgkmcnt(4)
 s_barrier
 v_mfma_f32_16x16x32_bf16 v[64:67], a[88:91], v[192:195], v[64:67]
 ds_read_b128 v[160:163], v18 offset:0
 v_mfma_f32_16x16x32_bf16 v[68:71], a[92:95], v[192:195], v[68:71]
 s_cmp_lt_u32 m0, s46
 s_cselect_b32 m0, m0, s47
 v_mfma_f32_16x16x32_bf16 v[72:75], a[88:91], v[196:199], v[72:75]
 ds_read_b128 v[164:167], v18 offset:2048
 v_add_u32 v19, s33, v15
 v_mfma_f32_16x16x32_bf16 v[76:79], a[92:95], v[196:199], v[76:79]
 buffer_load_dwordx4 v10, s[8:11], s30 offen offset:0 lds
 v_mfma_f32_16x16x32_bf16 v[80:83], a[88:91], v[200:203], v[80:83]
 ds_read_b128 v[168:171], v18 offset:4096
 s_add_u32 s33, s33, 16384
 v_mfma_f32_16x16x32_bf16 v[84:87], a[92:95], v[200:203], v[84:87]
 s_cmp_lt_u32 s33, 114688
 s_cselect_b32 s33, s33, 0
 v_mfma_f32_16x16x32_bf16 v[88:91], a[88:91], v[204:207], v[88:91]
 ds_read_b128 v[172:175], v18 offset:6144
 v_mfma_f32_16x16x32_bf16 v[92:95], a[92:95], v[204:207], v[92:95]
 s_waitcnt lgkmcnt(4)
 v_mfma_f32_16x16x32_bf16 v[96:99], a[88:91], v[208:211], v[96:99]
 ds_read_b128 v[176:179], v18 offset:8192
 v_mfma_f32_16x16x32_bf16 v[100:103], a[92:95], v[208:211], v[100:103]
 v_mfma_f32_16x16x32_bf16 v[104:107], a[88:91], v[212:215], v[104:107]
 ds_read_b128 v[180:183], v18 offset:10240
 v_mfma_f32_16x16x32_bf16 v[108:111], a[92:95], v[212:215], v[108:111]
 buffer_load_dwordx4 v11, s[8:11], s30 offen offset:1024 lds
 v_mfma_f32_16x16x32_bf16 v[112:115], a[88:91], v[216:219], v[112:115]
 ds_read_b128 v[184:187], v18 offset:12288
 v_mfma_f32_16x16x32_bf16 v[116:119], a[92:95], v[216:219], v[116:119]
 v_mfma_f32_16x16x32_bf16 v[120:123], a[88:91], v[220:223], v[120:123]
 ds_read_b128 v[188:191], v18 offset:14336
 v_mfma_f32_16x16x32_bf16 v[124:127], a[92:95], v[220:223], v[124:127]
 s_waitcnt lgkmcnt(4)
 v_mfma_f32_16x16x32_bf16 v[64:67], a[96:99], v[160:163], v[64:67]
 ds_read_b128 v[192:195], v19 offset:0
 v_mfma_f32_16x16x32_bf16 v[68:71], a[100:103], v[160:163], v[68:71]
 v_add_u32 v18, s33, v14
 v_mfma_f32_16x16x32_bf16 v[72:75], a[96:99], v[164:167], v[72:75]
 ds_read_b128 v[196:199], v19 offset:2048
 v_mfma_f32_16x16x32_bf16 v[76:79], a[100:103], v[164:167], v[76:79]
 buffer_load_dwordx4 v12, s[8:11], s30 offen offset:2048 lds
 v_mfma_f32_16x16x32_bf16 v[80:83], a[96:99], v[168:171], v[80:83]
 ds_read_b128 v[200:203], v19 offset:4096
 v_mfma_f32_16x16x32_bf16 v[84:87], a[100:103], v[168:171], v[84:87]
 v_mfma_f32_16x16x32_bf16 v[88:91], a[96:99], v[172:175], v[88:91]
 ds_read_b128 v[204:207], v19 offset:6144
 v_mfma_f32_16x16x32_bf16 v[92:95], a[100:103], v[172:175], v[92:95]
 s_waitcnt lgkmcnt(4)
 v_mfma_f32_16x16x32_bf16 v[96:99], a[96:99], v[176:179], v[96:99]
 ds_read_b128 v[208:211], v19 offset:8192
 v_mfma_f32_16x16x32_bf16 v[100:103], a[100:103], v[176:179], v[100:103]
 v_mfma_f32_16x16x32_bf16 v[104:107], a[96:99], v[180:183], v[104:107]
 ds_read_b128 v[212:215], v19 offset:10240
 v_mfma_f32_16x16x32_bf16 v[108:111], a[100:103], v[180:183], v[108:111]
 buffer_load_dwordx4 v13, s[8:11], s30 offen offset:3072 lds
 v_mfma_f32_16x16x32_bf16 v[112:115], a[96:99], v[184:187], v[112:115]
 ds_read_b128 v[216:219], v19 offset:12288
 s_add_u32 s30, s30, 128
 v_mfma_f32_16x16x32_bf16 v[116:119], a[100:103], v[184:187], v[116:119]
 s_add_u32 m0, m0, 16384
 v_mfma_f32_16x16x32_bf16 v[120:123], a[96:99], v[188:191], v[120:123]
 ds_read_b128 v[220:223], v19 offset:14336
 v_mfma_f32_16x16x32_bf16 v[124:127], a[100:103], v[188:191], v[124:127]
 s_waitcnt vmcnt(16) lgkmcnt(4)
 s_barrier
 v_mfma_f32_16x16x32_bf16 v[64:67], a[104:107], v[192:195], v[64:67]
 ds_read_b128 v[160:163], v18 offset:0
 v_mfma_f32_16x16x32_bf16 v[68:71], a[108:111], v[192:195], v[68:71]
 s_cmp_lt_u32 m0, s46
 s_cselect_b32 m0, m0, s47
 v_mfma_f32_16x16x32_bf16 v[72:75], a[104:107], v[196:199], v[72:75]
 ds_read_b128 v[164:167], v18 offset:2048
 v_add_u32 v19, s33, v15
 v_mfma_f32_16x16x32_bf16 v[76:79], a[108:111], v[196:199], v[76:79]
 buffer_load_dwordx4 v10, s[8:11], s30 offen offset:0 lds
 v_mfma_f32_16x16x32_bf16 v[80:83], a[104:107], v[200:203], v[80:83]
 ds_read_b128 v[168:171], v18 offset:4096
 s_add_u32 s33, s33, 16384
 v_mfma_f32_16x16x32_bf16 v[84:87], a[108:111], v[200:203], v[84:87]
 s_cmp_lt_u32 s33, 114688
 s_cselect_b32 s33, s33, 0
 v_mfma_f32_16x16x32_bf16 v[88:91], a[104:107], v[204:207], v[88:91]
 ds_read_b128 v[172:175], v18 offset:6144
 v_mfma_f32_16x16x32_bf16 v[92:95], a[108:111], v[204:207], v[92:95]
 s_waitcnt lgkmcnt(4)
 v_mfma_f32_16x16x32_bf16 v[96:99], a[104:107], v[208:211], v[96:99]
 ds_read_b128 v[176:179], v18 offset:8192
 v_mfma_f32_16x16x32_bf16 v[100:103], a[108:111], v[208:211], v[100:103]
 v_mfma_f32_16x16x32_bf16 v[104:107], a[104:107], v[212:215], v[104:107]
 ds_read_b128 v[180:183], v18 offset:10240
 v_mfma_f32_16x16x32_bf16 v[108:111], a[108:111], v[212:215], v[108:111]
 buffer_load_dwordx4 v11, s[8:11], s30 offen offset:1024 lds
 v_mfma_f32_16x16x32_bf16 v[112:115], a[104:107], v[216:219], v[112:115]
 ds_read_b128 v[184:187], v18 offset:12288
 v_mfma_f32_16x16x32_bf16 v[116:119], a[108:111], v[216:219], v[116:119]
 v_mfma_f32_16x16x32_bf16 v[120:123], a[104:107], v[220:223], v[120:123]
 ds_read_b128 v[188:191], v18 offset:14336
 v_mfma_f32_16x16x32_bf16 v[124:127], a[108:111], v[220:223], v[124:127]
 s_waitcnt lgkmcnt(4)
 v_mfma_f32_16x16x32_bf16 v[64:67], a[112:115], v[160:163], v[64:67]
 ds_read_b128 v[192:195], v19 offset:0
 v_mfma_f32_16x16x32_bf16 v[68:71], a[116:119], v[160:163], v[68:71]
 v_add_u32 v18, s33, v14
 v_mfma_f32_16x16x32_bf16 v[72:75], a[112:115], v[164:167], v[72:75]
 ds_read_b128 v[196:199], v19 offset:2048
 v_mfma_f32_16x16x32_bf16 v[76:79], a[116:119], v[164:167], v[76:79]
 buffer_load_dwordx4 v12, s[8:11], s30 offen offset:2048 lds
 v_mfma_f32_16x16x32_bf16 v[80:83], a[112:115], v[168:171], v[80:83]
 ds_read_b128 v[200:203], v19 offset:4096
 v_mfma_f32_16x16x32_bf16 v[84:87], a[116:119], v[168:171], v[84:87]
 v_mfma_f32_16x16x32_bf16 v[88:91], a[112:115], v[172:175], v[88:91]
 ds_read_b128 v[204:207], v19 offset:6144
 v_mfma_f32_16x16x32_bf16 v[92:95], a[116:119], v[172:175], v[92:95]
 s_waitcnt lgkmcnt(4)
 v_mfma_f32_16x16x32_bf16 v[96:99], a[112:115], v[176:179], v[96:99]
 ds_read_b128 v[208:211], v19 offset:8192
 v_mfma_f32_16x16x32_bf16 v[100:103], a[116:119], v[176:179], v[100:103]
 v_mfma_f32_16x16x32_bf16 v[104:107], a[112:115], v[180:183], v[104:107]
 ds_read_b128 v[212:215], v19 offset:10240
 v_mfma_f32_16x16x32_bf16 v[108:111], a[116:119], v[180:183], v[108:111]
 buffer_load_dwordx4 v13, s[8:11], s30 offen offset:3072 lds
 v_mfma_f32_16x16x32_bf16 v[112:115], a[112:115], v[184:187], v[112:115]
 ds_read_b128 v[216:219], v19 offset:12288
 s_add_u32 s30, s30, 128
 v_mfma_f32_16x16x32_bf16 v[116:119], a[116:119], v[184:187], v[116:119]
 s_add_u32 m0, m0, 16384
 v_mfma_f32_16x16x32_bf16 v[120:123], a[112:115], v[188:191], v[120:123]
 ds_read_b128 v[220:223], v19 offset:14336
 v_mfma_f32_16x16x32_bf16 v[124:127], a[116:119], v[188:191], v[124:127]
 s_waitcnt vmcnt(16) lgkmcnt(4)
 s_barrier
 v_mfma_f32_16x16x32_bf16 v[64:67], a[120:123], v[192:195], v[64:67]
 ds_read_b128 v[160:163], v18 offset:0
 v_mfma_f32_16x16x32_bf16 v[68:71], a[124:127], v[192:195], v[68:71]
 s_cmp_lt_u32 m0, s46
 s_cselect_b32 m0, m0, s47
 v_mfma_f32_16x16x32_bf16 v[72:75], a[120:123], v[196:199], v[72:75]
 ds_read_b128 v[164:167], v18 offset:2048
 v_add_u32 v19, s33, v15
 v_mfma_f32_16x16x32_bf16 v[76:79], a[124:127], v[196:199], v[76:79]
 buffer_load_dwordx4 v10, s[8:11], s30 offen offset:0 lds
 v_mfma_f32_16x16x32_bf16 v[80:83], a[120:123], v[200:203], v[80:83]
 ds_read_b128 v[168:171], v18 offset:4096
 s_add_u32 s33, s33, 16384
 v_mfma_f32_16x16x32_bf16 v[84:87], a[124:127], v[200:203], v[84:87]
 s_cmp_lt_u32 s33, 114688
 s_cselect_b32 s33, s33, 0
 v_mfma_f32_16x16x32_bf16 v[88:91], a[120:123], v[204:207], v[88:91]
 ds_read_b128 v[172:175], v18 offset:6144
 v_mfma_f32_16x16x32_bf16 v[92:95], a[124:127], v[204:207], v[92:95]
 s_waitcnt lgkmcnt(4)
 v_mfma_f32_16x16x32_bf16 v[96:99], a[120:123], v[208:211], v[96:99]
 ds_read_b128 v[176:179], v18 offset:8192
 v_mfma_f32_16x16x32_bf16 v[100:103], a[124:127], v[208:211], v[100:103]
 v_mfma_f32_16x16x32_bf16 v[104:107], a[120:123], v[212:215], v[104:107]
 ds_read_b128 v[180:183], v18 offset:10240
 v_mfma_f32_16x16x32_bf16 v[108:111], a[124:127], v[212:215], v[108:111]
 buffer_load_dwordx4 v11, s[8:11], s30 offen offset:1024 lds
 v_mfma_f32_16x16x32_bf16 v[112:115], a[120:123], v[216:219], v[112:115]
 ds_read_b128 v[184:187], v18 offset:12288
 v_mfma_f32_16x16x32_bf16 v[116:119], a[124:127], v[216:219], v[116:119]
 v_mfma_f32_16x16x32_bf16 v[120:123], a[120:123], v[220:223], v[120:123]
 ds_read_b128 v[188:191], v18 offset:14336
 v_mfma_f32_16x16x32_bf16 v[124:127], a[124:127], v[220:223], v[124:127]
 s_waitcnt lgkmcnt(4)
 v_mfma_f32_16x16x32_bf16 v[64:67], a[128:131], v[160:163], v[64:67]
 ds_read_b128 v[192:195], v19 offset:0
 v_mfma_f32_16x16x32_bf16 v[68:71], a[132:135], v[160:163], v[68:71]
 v_add_u32 v18, s33, v14
 v_mfma_f32_16x16x32_bf16 v[72:75], a[128:131], v[164:167], v[72:75]
 ds_read_b128 v[196:199], v19 offset:2048
 v_mfma_f32_16x16x32_bf16 v[76:79], a[132:135], v[164:167], v[76:79]
 buffer_load_dwordx4 v12, s[8:11], s30 offen offset:2048 lds
 v_mfma_f32_16x16x32_bf16 v[80:83], a[128:131], v[168:171], v[80:83]
 ds_read_b128 v[200:203], v19 offset:4096
 v_mfma_f32_16x16x32_bf16 v[84:87], a[132:135], v[168:171], v[84:87]
 v_mfma_f32_16x16x32_bf16 v[88:91], a[128:131], v[172:175], v[88:91]
 ds_read_b128 v[204:207], v19 offset:6144
 v_mfma_f32_16x16x32_bf16 v[92:95], a[132:135], v[172:175], v[92:95]
 s_waitcnt lgkmcnt(4)
 v_mfma_f32_16x16x32_bf16 v[96:99], a[128:131], v[176:179], v[96:99]
 ds_read_b128 v[208:211], v19 offset:8192
 v_mfma_f32_16x16x32_bf16 v[100:103], a[132:135], v[176:179], v[100:103]
 v_mfma_f32_16x16x32_bf16 v[104:107], a[128:131], v[180:183], v[104:107]
 ds_read_b128 v[212:215], v19 offset:10240
 v_mfma_f32_16x16x32_bf16 v[108:111], a[132:135], v[180:183], v[108:111]
 buffer_load_dwordx4 v13, s[8:11], s30 offen offset:3072 lds
 v_mfma_f32_16x16x32_bf16 v[112:115], a[128:131], v[184:187], v[112:115]
 ds_read_b128 v[216:219], v19 offset:12288
 s_add_u32 s30, s30, 128
 v_mfma_f32_16x16x32_bf16 v[116:119], a[132:135], v[184:187], v[116:119]
 s_add_u32 m0, m0, 16384
 v_mfma_f32_16x16x32_bf16 v[120:123], a[128:131], v[188:191], v[120:123]
 ds_read_b128 v[220:223], v19 offset:14336
 v_mfma_f32_16x16x32_bf16 v[124:127], a[132:135], v[188:191], v[124:127]
 s_waitcnt vmcnt(16) lgkmcnt(4)
 s_barrier
 v_mfma_f32_16x16x32_bf16 v[64:67], a[136:139], v[192:195], v[64:67]
 ds_read_b128 v[160:163], v18 offset:0
 v_mfma_f32_16x16x32_bf16 v[68:71], a[140:143], v[192:195], v[68:71]
 s_cmp_lt_u32 m0, s46
 s_cselect_b32 m0, m0, s47
 v_mfma_f32_16x16x32_bf16 v[72:75], a[136:139], v[196:199], v[72:75]
 ds_read_b128 v[164:167], v18 offset:2048
 v_add_u32 v19, s33, v15
 v_mfma_f32_16x16x32_bf16 v[76:79], a[140:143], v[196:199], v[76:79]
 buffer_load_dwordx4 v10, s[8:11], s30 offen offset:0 lds
 v_mfma_f32_16x16x32_bf16 v[80:83], a[136:139], v[200:203], v[80:83]
 ds_read_b128 v[168:171], v18 offset:4096
 s_add_u32 s33, s33, 16384
 v_mfma_f32_16x16x32_bf16 v[84:87], a[140:143], v[200:203], v[84:87]
 s_cmp_lt_u32 s33, 114688
 s_cselect_b32 s33, s33, 0
 v_mfma_f32_16x16x32_bf16 v[88:91], a[136:139], v[204:207], v[88:91]
 ds_read_b128 v[172:175], v18 offset:6144
 v_mfma_f32_16x16x32_bf16 v[92:95], a[140:143], v[204:207], v[92:95]
 s_waitcnt lgkmcnt(4)
 v_mfma_f32_16x16x32_bf16 v[96:99], a[136:139], v[208:211], v[96:99]
 ds_read_b128 v[176:179], v18 offset:8192
 v_mfma_f32_16x16x32_bf16 v[100:103], a[140:143], v[208:211], v[100:103]
 v_mfma_f32_16x16x32_bf16 v[104:107], a[136:139], v[212:215], v[104:107]
 ds_read_b128 v[180:183], v18 offset:10240
 v_mfma_f32_16x16x32_bf16 v[108:111], a[140:143], v[212:215], v[108:111]
 buffer_load_dwordx4 v11, s[8:11], s30 offen offset:1024 lds
 v_mfma_f32_16x16x32_bf16 v[112:115], a[136:139], v[216:219], v[112:115]
 ds_read_b128 v[184:187], v18 offset:12288
 v_mfma_f32_16x16x32_bf16 v[116:119], a[140:143], v[216:219], v[116:119]
 v_mfma_f32_16x16x32_bf16 v[120:123], a[136:139], v[220:223], v[120:123]
 ds_read_b128 v[188:191], v18 offset:14336
 v_mfma_f32_16x16x32_bf16 v[124:127], a[140:143], v[220:223], v[124:127]
 s_waitcnt lgkmcnt(4)
 v_mfma_f32_16x16x32_bf16 v[64:67], a[144:147], v[160:163], v[64:67]
 ds_read_b128 v[192:195], v19 offset:0
 v_mfma_f32_16x16x32_bf16 v[68:71], a[148:151], v[160:163], v[68:71]
 v_add_u32 v18, s33, v14
 v_mfma_f32_16x16x32_bf16 v[72:75], a[144:147], v[164:167], v[72:75]
 ds_read_b128 v[196:199], v19 offset:2048
 v_mfma_f32_16x16x32_bf16 v[76:79], a[148:151], v[164:167], v[76:79]
 buffer_load_dwordx4 v12, s[8:11], s30 offen offset:2048 lds
 v_mfma_f32_16x16x32_bf16 v[80:83], a[144:147], v[168:171], v[80:83]
 ds_read_b128 v[200:203], v19 offset:4096
 v_mfma_f32_16x16x32_bf16 v[84:87], a[148:151], v[168:171], v[84:87]
 v_mfma_f32_16x16x32_bf16 v[88:91], a[144:147], v[172:175], v[88:91]
 ds_read_b128 v[204:207], v19 offset:6144
 v_mfma_f32_16x16x32_bf16 v[92:95], a[148:151], v[172:175], v[92:95]
 s_waitcnt lgkmcnt(4)
 v_mfma_f32_16x16x32_bf16 v[96:99], a[144:147], v[176:179], v[96:99]
 ds_read_b128 v[208:211], v19 offset:8192
 v_mfma_f32_16x16x32_bf16 v[100:103], a[148:151], v[176:179], v[100:103]
 v_mfma_f32_16x16x32_bf16 v[104:107], a[144:147], v[180:183], v[104:107]
 ds_read_b128 v[212:215], v19 offset:10240
 v_mfma_f32_16x16x32_bf16 v[108:111], a[148:151], v[180:183], v[108:111]
 buffer_load_dwordx4 v13, s[8:11], s30 offen offset:3072 lds
 v_mfma_f32_16x16x32_bf16 v[112:115], a[144:147], v[184:187], v[112:115]
 ds_read_b128 v[216:219], v19 offset:12288
 s_add_u32 s30, s30, 128
 v_mfma_f32_16x16x32_bf16 v[116:119], a[148:151], v[184:187], v[116:119]
 s_add_u32 m0, m0, 16384
 v_mfma_f32_16x16x32_bf16 v[120:123], a[144:147], v[188:191], v[120:123]
 ds_read_b128 v[220:223], v19 offset:14336
 v_mfma_f32_16x16x32_bf16 v[124:127], a[148:151], v[188:191], v[124:127]
 s_waitcnt vmcnt(16) lgkmcnt(4)
 s_barrier
 v_mfma_f32_16x16x32_bf16 v[64:67], a[152:155], v[192:195], v[64:67]
 ds_read_b128 v[160:163], v18 offset:0
 v_mfma_f32_16x16x32_bf16 v[68:71], a[156:159], v[192:195], v[68:71]
 s_cmp_lt_u32 m0, s46
 s_cselect_b32 m0, m0, s47
 v_mfma_f32_16x16x32_bf16 v[72:75], a[152:155], v[196:199], v[72:75]
 ds_read_b128 v[164:167], v18 offset:2048
 v_add_u32 v19, s33, v15
 v_mfma_f32_16x16x32_bf16 v[76:79], a[156:159], v[196:199], v[76:79]
 buffer_load_dwordx4 v10, s[8:11], s30 offen offset:0 lds
 v_cvt_pk_bf16_f32 v224, v64, v65
 v_cvt_pk_bf16_f32 v225, v66, v67
 v_mfma_f32_16x16x32_bf16 v[80:83], a[152:155], v[200:203], v[80:83]
 ds_read_b128 v[168:171], v18 offset:4096
 s_add_u32 s33, s33, 16384
 v_cvt_pk_bf16_f32 v226, v68, v69
 v_cvt_pk_bf16_f32 v227, v70, v71
 v_mfma_f32_16x16x32_bf16 v[84:87], a[156:159], v[200:203], v[84:87]
 s_cmp_lt_u32 s33, 114688
 s_cselect_b32 s33, s33, 0
 ds_write_b64 v22, v[224:225] offset:0
 v_mfma_f32_16x16x32_bf16 v[88:91], a[152:155], v[204:207], v[88:91]
 ds_read_b128 v[172:175], v18 offset:6144
 ds_write_b64 v22, v[226:227] offset:32
 v_cvt_pk_bf16_f32 v230, v72, v73
 v_mfma_f32_16x16x32_bf16 v[92:95], a[156:159], v[204:207], v[92:95]
 s_waitcnt lgkmcnt(6)
 v_cvt_pk_bf16_f32 v231, v74, v75
 v_cvt_pk_bf16_f32 v232, v76, v77
 v_cvt_pk_bf16_f32 v233, v78, v79
 v_mfma_f32_16x16x32_bf16 v[96:99], a[152:155], v[208:211], v[96:99]
 ds_read_b128 v[176:179], v18 offset:8192
 ds_write_b64 v22, v[230:231] offset:4224
 v_mfma_f32_16x16x32_bf16 v[100:103], a[156:159], v[208:211], v[100:103]
 ds_write_b64 v22, v[232:233] offset:4256
 v_cvt_pk_bf16_f32 v224, v80, v81
 v_cvt_pk_bf16_f32 v225, v82, v83
 v_mfma_f32_16x16x32_bf16 v[104:107], a[152:155], v[212:215], v[104:107]
 ds_read_b128 v[180:183], v18 offset:10240
 v_cvt_pk_bf16_f32 v226, v84, v85
 v_cvt_pk_bf16_f32 v227, v86, v87
 v_mfma_f32_16x16x32_bf16 v[108:111], a[156:159], v[212:215], v[108:111]
 buffer_load_dwordx4 v11, s[8:11], s30 offen offset:1024 lds
 ds_write_b64 v22, v[224:225] offset:8448
 v_mfma_f32_16x16x32_bf16 v[112:115], a[152:155], v[216:219], v[112:115]
 ds_read_b128 v[184:187], v18 offset:12288
 ds_write_b64 v22, v[226:227] offset:8480
 v_cvt_pk_bf16_f32 v230, v88, v89
 v_mfma_f32_16x16x32_bf16 v[116:119], a[156:159], v[216:219], v[116:119]
 v_cvt_pk_bf16_f32 v231, v90, v91
 v_cvt_pk_bf16_f32 v232, v92, v93
 v_cvt_pk_bf16_f32 v233, v94, v95
 v_mfma_f32_16x16x32_bf16 v[120:123], a[152:155], v[220:223], v[120:123]
 ds_read_b128 v[188:191], v18 offset:14336
 ds_write_b64 v22, v[230:231] offset:12672
 v_mfma_f32_16x16x32_bf16 v[124:127], a[156:159], v[220:223], v[124:127]
 ds_write_b64 v22, v[232:233] offset:12704
 v_cvt_pk_bf16_f32 v224, v96, v97
 v_cvt_pk_bf16_f32 v225, v98, v99
bf_end_194:
 v_cvt_pk_bf16_f32 v226, v100, v101
 v_cvt_pk_bf16_f32 v227, v102, v103
 ds_write_b64 v22, v[224:225] offset:16896
 ds_write_b64 v22, v[226:227] offset:16928
 v_cvt_pk_bf16_f32 v230, v104, v105
 v_cvt_pk_bf16_f32 v231, v106, v107
 v_cvt_pk_bf16_f32 v232, v108, v109
 v_cvt_pk_bf16_f32 v233, v110, v111
 ds_write_b64 v22, v[230:231] offset:21120
 ds_write_b64 v22, v[232:233] offset:21152
 v_cvt_pk_bf16_f32 v224, v112, v113
 v_cvt_pk_bf16_f32 v225, v114, v115
 v_cvt_pk_bf16_f32 v226, v116, v117
 v_cvt_pk_bf16_f32 v227, v118, v119
 ds_write_b64 v22, v[224:225] offset:25344
 ds_write_b64 v22, v[226:227] offset:25376
 v_cvt_pk_bf16_f32 v230, v120, v121
 v_cvt_pk_bf16_f32 v231, v122, v123
 v_cvt_pk_bf16_f32 v232, v124, v125
 v_cvt_pk_bf16_f32 v233, v126, v127
 ds_write_b64 v22, v[230:231] offset:29568
 ds_write_b64 v22, v[232:233] offset:29600
 s_cmp_lg_u32 s26, 6
 s_cbranch_scc1 bw_195
 v_and_b32 v51, 31, v1
 buffer_load_ubyte v50, v51, s[64:67], 0 offen offset:160 sc1
 buffer_load_dword v32, v32, s[64:67], 0 offen sc1
 buffer_load_dwordx4 v[40:43], v33, s[12:15], s50 offen offset:0
 buffer_load_dwordx4 v[40:43], v33, s[12:15], s50 offen offset:1024
 buffer_load_dwordx4 v[40:43], v33, s[12:15], s50 offen offset:2048
 buffer_load_dwordx4 v[40:43], v33, s[12:15], s50 offen offset:3072
 buffer_load_dwordx4 v[40:43], v33, s[12:15], s51 offen offset:0
 buffer_load_dwordx4 v[40:43], v33, s[12:15], s51 offen offset:1024
 buffer_load_dwordx4 v[40:43], v33, s[12:15], s51 offen offset:2048
bw_195:
 s_waitcnt lgkmcnt(0)
 s_barrier
 ds_read_b64 v[144:145], v34 offset:1848
 ds_read_b64 v[146:147], v34 offset:1856
 ds_read_b64 v[148:149], v34 offset:1864
 ds_read_b64 v[150:151], v34 offset:1872
 ds_read_b64 v[152:153], v34 offset:1880
 ds_read_b64 v[64:65], v34 offset:1928
 ds_read_b64 v[66:67], v34 offset:1936
 ds_read_b64 v[68:69], v34 offset:1944
 ds_read_b64 v[70:71], v34 offset:1952
 ds_read_b64 v[72:73], v34 offset:1960
 ds_read_b64 v[74:75], v34 offset:1664
 ds_read_b64 v[76:77], v34 offset:1672
 ds_read_b64 v[78:79], v34 offset:1680
 ds_read_b64 v[80:81], v34 offset:1688
 ds_read_b64 v[82:83], v34 offset:1696
 ds_read_b64 v[84:85], v34 offset:1400
 ds_read_b64 v[86:87], v34 offset:1408
 ds_read_b64 v[88:89], v34 offset:1416
 ds_read_b64 v[90:91], v34 offset:1424
 ds_read_b64 v[92:93], v34 offset:1432
 ds_read_b64 v[94:95], v34 offset:1136
 ds_read_b64 v[96:97], v34 offset:1144
 ds_read_b64 v[98:99], v34 offset:1152
 ds_read_b64 v[100:101], v34 offset:1160
 ds_read_b64 v[102:103], v34 offset:1168
 ds_read_b64 v[104:105], v34 offset:872
 ds_read_b64 v[106:107], v34 offset:880
 ds_read_b64 v[108:109], v34 offset:888
 ds_read_b64 v[110:111], v34 offset:896
 ds_read_b64 v[112:113], v34 offset:904
 ds_read_b64 v[114:115], v34 offset:608
 ds_read_b64 v[116:117], v34 offset:616
 ds_read_b64 v[118:119], v34 offset:624
 ds_read_b64 v[120:121], v34 offset:632
 ds_read_b64 v[122:123], v34 offset:640
 ds_read_b64 v[124:125], v34 offset:344
 ds_read_b64 v[126:127], v34 offset:352
 ds_read_b64 v[128:129], v34 offset:360
 ds_read_b64 v[130:131], v34 offset:368
 ds_read_b64 v[132:133], v34 offset:376
 ds_read_b64 v[134:135], v34 offset:80
 ds_read_b64 v[136:137], v34 offset:88
 ds_read_b64 v[138:139], v34 offset:96
 ds_read_b64 v[140:141], v34 offset:104
 ds_read_b64 v[142:143], v34 offset:112
 v_mov_b32 v224, 0
 v_mov_b32 v225, 0
 v_mov_b32 v226, 0
 v_mov_b32 v227, 0
 v_mov_b32 v228, 0
 v_mov_b32 v229, 0
 v_mov_b32 v230, 0
 v_mov_b32 v231, 0
 s_waitcnt lgkmcnt(15)
 v_dot2c_f32_bf16 v224, v64, v144
 v_dot2c_f32_bf16 v225, v74, v144
 v_dot2c_f32_bf16 v226, v84, v144
 v_dot2c_f32_bf16 v227, v94, v144
 v_dot2c_f32_bf16 v224, v65, v145
 v_dot2c_f32_bf16 v225, v75, v145
 v_dot2c_f32_bf16 v226, v85, v145
 v_dot2c_f32_bf16 v227, v95, v145
 v_dot2c_f32_bf16 v224, v66, v146
 v_dot2c_f32_bf16 v225, v76, v146
 v_dot2c_f32_bf16 v226, v86, v146
 v_dot2c_f32_bf16 v227, v96, v146
 v_dot2c_f32_bf16 v224, v67, v147
 v_dot2c_f32_bf16 v225, v77, v147
 v_dot2c_f32_bf16 v226, v87, v147
 v_dot2c_f32_bf16 v227, v97, v147
 v_dot2c_f32_bf16 v224, v68, v148
 v_dot2c_f32_bf16 v225, v78, v148
 v_dot2c_f32_bf16 v226, v88, v148
 v_dot2c_f32_bf16 v227, v98, v148
 v_dot2c_f32_bf16 v224, v69, v149
 v_dot2c_f32_bf16 v225, v79, v149
 v_dot2c_f32_bf16 v226, v89, v149
 v_dot2c_f32_bf16 v227, v99, v149
 v_dot2c_f32_bf16 v224, v70, v150
 v_dot2c_f32_bf16 v225, v80, v150
 v_dot2c_f32_bf16 v226, v90, v150
 v_dot2c_f32_bf16 v227, v100, v150
 v_dot2c_f32_bf16 v224, v71, v151
 v_dot2c_f32_bf16 v225, v81, v151
 v_dot2c_f32_bf16 v226, v91, v151
 v_dot2c_f32_bf16 v227, v101, v151
 v_dot2c_f32_bf16 v224, v72, v152
 v_dot2c_f32_bf16 v225, v82, v152
 v_dot2c_f32_bf16 v226, v92, v152
 v_dot2c_f32_bf16 v227, v102, v152
 v_dot2c_f32_bf16 v224, v73, v153
 v_dot2c_f32_bf16 v225, v83, v153
 v_dot2c_f32_bf16 v226, v93, v153
 v_dot2c_f32_bf16 v227, v103, v153
 s_waitcnt lgkmcnt(0)
 v_dot2c_f32_bf16 v228, v104, v144
 v_dot2c_f32_bf16 v229, v114, v144
 v_dot2c_f32_bf16 v230, v124, v144
 v_dot2c_f32_bf16 v231, v134, v144
 v_dot2c_f32_bf16 v228, v105, v145
 v_dot2c_f32_bf16 v229, v115, v145
 v_dot2c_f32_bf16 v230, v125, v145
 v_dot2c_f32_bf16 v231, v135, v145
 v_dot2c_f32_bf16 v228, v106, v146
 v_dot2c_f32_bf16 v229, v116, v146
 v_dot2c_f32_bf16 v230, v126, v146
 v_dot2c_f32_bf16 v231, v136, v146
 v_dot2c_f32_bf16 v228, v107, v147
 v_dot2c_f32_bf16 v229, v117, v147
 v_dot2c_f32_bf16 v230, v127, v147
 v_dot2c_f32_bf16 v231, v137, v147
 v_dot2c_f32_bf16 v228, v108, v148
 v_dot2c_f32_bf16 v229, v118, v148
 v_dot2c_f32_bf16 v230, v128, v148
 v_dot2c_f32_bf16 v231, v138, v148
 v_dot2c_f32_bf16 v228, v109, v149
 v_dot2c_f32_bf16 v229, v119, v149
 v_dot2c_f32_bf16 v230, v129, v149
 v_dot2c_f32_bf16 v231, v139, v149
 v_dot2c_f32_bf16 v228, v110, v150
 v_dot2c_f32_bf16 v229, v120, v150
 v_dot2c_f32_bf16 v230, v130, v150
 v_dot2c_f32_bf16 v231, v140, v150
 v_dot2c_f32_bf16 v228, v111, v151
 v_dot2c_f32_bf16 v229, v121, v151
 v_dot2c_f32_bf16 v230, v131, v151
 v_dot2c_f32_bf16 v231, v141, v151
 v_dot2c_f32_bf16 v228, v112, v152
 v_dot2c_f32_bf16 v229, v122, v152
 v_dot2c_f32_bf16 v230, v132, v152
 v_dot2c_f32_bf16 v231, v142, v152
 v_dot2c_f32_bf16 v228, v113, v153
 v_dot2c_f32_bf16 v229, v123, v153
 v_dot2c_f32_bf16 v230, v133, v153
 v_dot2c_f32_bf16 v231, v143, v153
 ds_read_b64 v[64:65], v38 offset:2008
 ds_read_b64 v[66:67], v38 offset:2016
 ds_read_b64 v[68:69], v38 offset:2024
 ds_read_b64 v[70:71], v38 offset:2032
 ds_read_b64 v[72:73], v39 offset:2040
 ds_read_b64 v[74:75], v38 offset:1744
 ds_read_b64 v[76:77], v38 offset:1752
 ds_read_b64 v[78:79], v38 offset:1760
 ds_read_b64 v[80:81], v38 offset:1768
 ds_read_b64 v[82:83], v39 offset:1776
 ds_read_b64 v[84:85], v38 offset:1480
 ds_read_b64 v[86:87], v38 offset:1488
 ds_read_b64 v[88:89], v38 offset:1496
 ds_read_b64 v[90:91], v38 offset:1504
 ds_read_b64 v[92:93], v39 offset:1512
 ds_read_b64 v[94:95], v38 offset:1216
 ds_read_b64 v[96:97], v38 offset:1224
 ds_read_b64 v[98:99], v38 offset:1232
 ds_read_b64 v[100:101], v38 offset:1240
 ds_read_b64 v[102:103], v39 offset:1248
 ds_read_b64 v[104:105], v38 offset:952
 ds_read_b64 v[106:107], v38 offset:960
 ds_read_b64 v[108:109], v38 offset:968
 ds_read_b64 v[110:111], v38 offset:976
 ds_read_b64 v[112:113], v39 offset:984
 ds_read_b64 v[114:115], v38 offset:688
 ds_read_b64 v[116:117], v38 offset:696
 ds_read_b64 v[118:119], v38 offset:704
 ds_read_b64 v[120:121], v38 offset:712
 ds_read_b64 v[122:123], v39 offset:720
 ds_read_b64 v[124:125], v38 offset:424
 ds_read_b64 v[126:127], v38 offset:432
 ds_read_b64 v[128:129], v38 offset:440
 ds_read_b64 v[130:131], v38 offset:448
 ds_read_b64 v[132:133], v39 offset:456
 ds_read_b64 v[134:135], v38 offset:160
 ds_read_b64 v[136:137], v38 offset:168
 ds_read_b64 v[138:139], v38 offset:176
 ds_read_b64 v[140:141], v38 offset:184
 ds_read_b64 v[142:143], v39 offset:192
 v_cvt_pk_bf16_f32 v4, v224, v225
 v_lshlrev_b32 v224, 16, v4
 v_and_b32 v225, 0xffff0000, v4
 v_mul_f32 v224, s60, v224
 v_mul_f32 v225, s60, v225
 v_cvt_pk_bf16_f32 v4, v224, v225
 v_lshlrev_b32 v224, 16, v4
 v_and_b32 v225, 0xffff0000, v4
 v_cndmask_b32 v224, v37, v224, s[76:77]
 v_cndmask_b32 v225, v37, v225, s[78:79]
 v_cvt_pk_bf16_f32 v4, v226, v227
 v_lshlrev_b32 v226, 16, v4
 v_and_b32 v227, 0xffff0000, v4
 v_mul_f32 v226, s60, v226
 v_mul_f32 v227, s60, v227
 v_cvt_pk_bf16_f32 v4, v226, v227
 v_lshlrev_b32 v226, 16, v4
 v_and_b32 v227, 0xffff0000, v4
 v_cndmask_b32 v226, v37, v226, s[80:81]
 v_cndmask_b32 v227, v37, v227, s[82:83]
 v_cvt_pk_bf16_f32 v4, v228, v229
 v_lshlrev_b32 v228, 16, v4
 v_and_b32 v229, 0xffff0000, v4
 v_mul_f32 v228, s60, v228
 v_mul_f32 v229, s60, v229
 v_cvt_pk_bf16_f32 v4, v228, v229
 v_lshlrev_b32 v228, 16, v4
 v_and_b32 v229, 0xffff0000, v4
 v_cndmask_b32 v228, v37, v228, s[84:85]
 v_cndmask_b32 v229, v37, v229, s[86:87]
 v_cvt_pk_bf16_f32 v4, v230, v231
 v_lshlrev_b32 v230, 16, v4
 v_and_b32 v231, 0xffff0000, v4
 v_mul_f32 v230, s60, v230
 v_mul_f32 v231, s60, v231
 v_cvt_pk_bf16_f32 v4, v230, v231
 v_lshlrev_b32 v230, 16, v4
 v_and_b32 v231, 0xffff0000, v4
 v_cndmask_b32 v230, v37, v230, s[88:89]
 v_cndmask_b32 v231, v37, v231, s[90:91]
 v_max3_f32 v5, v224, v225, v226
 v_max3_f32 v5, v5, v227, v228
 v_max3_f32 v5, v5, v229, v230
 v_max_f32 v5, v5, v231
 v_sub_f32 v224, v224, v5
 v_mul_f32 v224, s61, v224
 v_exp_f32 v224, v224
 v_sub_f32 v225, v225, v5
 v_mul_f32 v225, s61, v225
 v_exp_f32 v225, v225
 v_sub_f32 v226, v226, v5
 v_mul_f32 v226, s61, v226
 v_exp_f32 v226, v226
 v_sub_f32 v227, v227, v5
 v_mul_f32 v227, s61, v227
 v_exp_f32 v227, v227
 v_sub_f32 v228, v228, v5
 v_mul_f32 v228, s61, v228
 v_exp_f32 v228, v228
 v_sub_f32 v229, v229, v5
 v_mul_f32 v229, s61, v229
 v_exp_f32 v229, v229
 v_sub_f32 v230, v230, v5
 v_mul_f32 v230, s61, v230
 v_exp_f32 v230, v230
 v_sub_f32 v231, v231, v5
 v_mul_f32 v231, s61, v231
 v_exp_f32 v231, v231
 s_nop 0
 v_add_f32 v5, v224, v225
 v_add_f32 v5, v5, v226
 v_add_f32 v5, v5, v227
 v_add_f32 v5, v5, v228
 v_add_f32 v5, v5, v229
 v_add_f32 v5, v5, v230
 v_add_f32 v5, v5, v231
 v_rcp_f32 v5, v5
 s_nop 0
 v_mul_f32 v224, v224, v5
 v_mul_f32 v225, v225, v5
 v_mul_f32 v226, v226, v5
 v_mul_f32 v227, v227, v5
 v_mul_f32 v228, v228, v5
 v_mul_f32 v229, v229, v5
 v_mul_f32 v230, v230, v5
 v_mul_f32 v231, v231, v5
 v_cvt_pk_bf16_f32 v232, v224, v225
 v_cvt_pk_bf16_f32 v233, v226, v227
 v_cvt_pk_bf16_f32 v234, v228, v229
 v_cvt_pk_bf16_f32 v235, v230, v231
 s_waitcnt lgkmcnt(15)
 v_perm_b32 v144, v74, v64, s62
 v_perm_b32 v145, v74, v64, s63
 v_perm_b32 v146, v75, v65, s62
 v_perm_b32 v147, v75, v65, s63
 v_perm_b32 v148, v76, v66, s62
 v_perm_b32 v149, v76, v66, s63
 v_perm_b32 v150, v77, v67, s62
 v_perm_b32 v151, v77, v67, s63
 v_perm_b32 v152, v78, v68, s62
 v_perm_b32 v153, v78, v68, s63
 v_perm_b32 v154, v79, v69, s62
 v_perm_b32 v155, v79, v69, s63
 v_perm_b32 v156, v80, v70, s62
 v_perm_b32 v157, v80, v70, s63
 v_perm_b32 v158, v81, v71, s62
 v_perm_b32 v159, v81, v71, s63
 v_perm_b32 v212, v82, v72, s62
 v_perm_b32 v213, v82, v72, s63
 v_perm_b32 v214, v83, v73, s62
 v_perm_b32 v215, v83, v73, s63
 v_dot2_f32_bf16 v192, v144, v232, 0
 v_dot2_f32_bf16 v193, v145, v232, 0
 v_dot2_f32_bf16 v194, v146, v232, 0
 v_dot2_f32_bf16 v195, v147, v232, 0
 v_dot2_f32_bf16 v196, v148, v232, 0
 v_dot2_f32_bf16 v197, v149, v232, 0
 v_dot2_f32_bf16 v198, v150, v232, 0
 v_dot2_f32_bf16 v199, v151, v232, 0
 v_dot2_f32_bf16 v200, v152, v232, 0
 v_dot2_f32_bf16 v201, v153, v232, 0
 v_dot2_f32_bf16 v202, v154, v232, 0
 v_dot2_f32_bf16 v203, v155, v232, 0
 v_dot2_f32_bf16 v204, v156, v232, 0
 v_dot2_f32_bf16 v205, v157, v232, 0
 v_dot2_f32_bf16 v206, v158, v232, 0
 v_dot2_f32_bf16 v207, v159, v232, 0
 v_dot2_f32_bf16 v208, v212, v232, 0
 v_dot2_f32_bf16 v209, v213, v232, 0
 v_dot2_f32_bf16 v210, v214, v232, 0
 v_dot2_f32_bf16 v211, v215, v232, 0
 s_waitcnt lgkmcnt(15)
 v_perm_b32 v144, v94, v84, s62
 v_perm_b32 v145, v94, v84, s63
 v_perm_b32 v146, v95, v85, s62
 v_perm_b32 v147, v95, v85, s63
 v_perm_b32 v148, v96, v86, s62
 v_perm_b32 v149, v96, v86, s63
 v_perm_b32 v150, v97, v87, s62
 v_perm_b32 v151, v97, v87, s63
 v_perm_b32 v152, v98, v88, s62
 v_perm_b32 v153, v98, v88, s63
 v_perm_b32 v154, v99, v89, s62
 v_perm_b32 v155, v99, v89, s63
 v_perm_b32 v156, v100, v90, s62
 v_perm_b32 v157, v100, v90, s63
 v_perm_b32 v158, v101, v91, s62
 v_perm_b32 v159, v101, v91, s63
 v_perm_b32 v212, v102, v92, s62
 v_perm_b32 v213, v102, v92, s63
 v_perm_b32 v214, v103, v93, s62
 v_perm_b32 v215, v103, v93, s63
 v_dot2c_f32_bf16 v192, v144, v233
 v_dot2c_f32_bf16 v193, v145, v233
 v_dot2c_f32_bf16 v194, v146, v233
 v_dot2c_f32_bf16 v195, v147, v233
 v_dot2c_f32_bf16 v196, v148, v233
 v_dot2c_f32_bf16 v197, v149, v233
 v_dot2c_f32_bf16 v198, v150, v233
 v_dot2c_f32_bf16 v199, v151, v233
 v_dot2c_f32_bf16 v200, v152, v233
 v_dot2c_f32_bf16 v201, v153, v233
 v_dot2c_f32_bf16 v202, v154, v233
 v_dot2c_f32_bf16 v203, v155, v233
 v_dot2c_f32_bf16 v204, v156, v233
 v_dot2c_f32_bf16 v205, v157, v233
 v_dot2c_f32_bf16 v206, v158, v233
 v_dot2c_f32_bf16 v207, v159, v233
 v_dot2c_f32_bf16 v208, v212, v233
 v_dot2c_f32_bf16 v209, v213, v233
 v_dot2c_f32_bf16 v210, v214, v233
 v_dot2c_f32_bf16 v211, v215, v233
 s_waitcnt lgkmcnt(10)
 v_perm_b32 v144, v114, v104, s62
 v_perm_b32 v145, v114, v104, s63
 v_perm_b32 v146, v115, v105, s62
 v_perm_b32 v147, v115, v105, s63
 v_perm_b32 v148, v116, v106, s62
 v_perm_b32 v149, v116, v106, s63
 v_perm_b32 v150, v117, v107, s62
 v_perm_b32 v151, v117, v107, s63
 v_perm_b32 v152, v118, v108, s62
 v_perm_b32 v153, v118, v108, s63
 v_perm_b32 v154, v119, v109, s62
 v_perm_b32 v155, v119, v109, s63
 v_perm_b32 v156, v120, v110, s62
 v_perm_b32 v157, v120, v110, s63
 v_perm_b32 v158, v121, v111, s62
 v_perm_b32 v159, v121, v111, s63
 v_perm_b32 v212, v122, v112, s62
 v_perm_b32 v213, v122, v112, s63
 v_perm_b32 v214, v123, v113, s62
 v_perm_b32 v215, v123, v113, s63
 v_dot2c_f32_bf16 v192, v144, v234
 v_dot2c_f32_bf16 v193, v145, v234
 v_dot2c_f32_bf16 v194, v146, v234
 v_dot2c_f32_bf16 v195, v147, v234
 v_dot2c_f32_bf16 v196, v148, v234
 v_dot2c_f32_bf16 v197, v149, v234
 v_dot2c_f32_bf16 v198, v150, v234
 v_dot2c_f32_bf16 v199, v151, v234
 v_dot2c_f32_bf16 v200, v152, v234
 v_dot2c_f32_bf16 v201, v153, v234
 v_dot2c_f32_bf16 v202, v154, v234
 v_dot2c_f32_bf16 v203, v155, v234
 v_dot2c_f32_bf16 v204, v156, v234
 v_dot2c_f32_bf16 v205, v157, v234
 v_dot2c_f32_bf16 v206, v158, v234
 v_dot2c_f32_bf16 v207, v159, v234
 v_dot2c_f32_bf16 v208, v212, v234
 v_dot2c_f32_bf16 v209, v213, v234
 v_dot2c_f32_bf16 v210, v214, v234
 v_dot2c_f32_bf16 v211, v215, v234
 s_waitcnt lgkmcnt(0)
 v_perm_b32 v144, v134, v124, s62
 v_perm_b32 v145, v134, v124, s63
 v_perm_b32 v146, v135, v125, s62
 v_perm_b32 v147, v135, v125, s63
 v_perm_b32 v148, v136, v126, s62
 v_perm_b32 v149, v136, v126, s63
 v_perm_b32 v150, v137, v127, s62
 v_perm_b32 v151, v137, v127, s63
 v_perm_b32 v152, v138, v128, s62
 v_perm_b32 v153, v138, v128, s63
 v_perm_b32 v154, v139, v129, s62
 v_perm_b32 v155, v139, v129, s63
 v_perm_b32 v156, v140, v130, s62
 v_perm_b32 v157, v140, v130, s63
 v_perm_b32 v158, v141, v131, s62
 v_perm_b32 v159, v141, v131, s63
 v_perm_b32 v212, v142, v132, s62
 v_perm_b32 v213, v142, v132, s63
 v_perm_b32 v214, v143, v133, s62
 v_perm_b32 v215, v143, v133, s63
 v_dot2c_f32_bf16 v192, v144, v235
 v_dot2c_f32_bf16 v193, v145, v235
 v_dot2c_f32_bf16 v194, v146, v235
 v_dot2c_f32_bf16 v195, v147, v235
 v_dot2c_f32_bf16 v196, v148, v235
 v_dot2c_f32_bf16 v197, v149, v235
 v_dot2c_f32_bf16 v198, v150, v235
 v_dot2c_f32_bf16 v199, v151, v235
 v_dot2c_f32_bf16 v200, v152, v235
 v_dot2c_f32_bf16 v201, v153, v235
 v_dot2c_f32_bf16 v202, v154, v235
 v_dot2c_f32_bf16 v203, v155, v235
 v_dot2c_f32_bf16 v204, v156, v235
 v_dot2c_f32_bf16 v205, v157, v235
 v_dot2c_f32_bf16 v206, v158, v235
 v_dot2c_f32_bf16 v207, v159, v235
 v_dot2c_f32_bf16 v208, v212, v235
 v_dot2c_f32_bf16 v209, v213, v235
 v_dot2c_f32_bf16 v210, v214, v235
 v_dot2c_f32_bf16 v211, v215, v235
 s_cmp_lg_u32 s20, 0
 s_cbranch_scc1 bh_196
 ds_read_b64 v[64:65], v35 offset:33792
 ds_read_b64 v[66:67], v35 offset:34304
 ds_read_b64 v[68:69], v35 offset:34816
 ds_read_b64 v[70:71], v35 offset:35328
 ds_read_b64 v[72:73], v35 offset:35840
 s_waitcnt lgkmcnt(0)
 ds_write_b64 v35, v[64:65] offset:0
 ds_write_b64 v35, v[66:67] offset:512
 ds_write_b64 v35, v[68:69] offset:1024
 ds_write_b64 v35, v[70:71] offset:1536
 ds_write_b64 v35, v[72:73] offset:2048
bh_196:
 s_nop 1
 v_cvt_pk_bf16_f32 v244, v192, v193
 v_cvt_pk_bf16_f32 v245, v194, v195
 v_cvt_pk_bf16_f32 v246, v196, v197
 v_cvt_pk_bf16_f32 v247, v198, v199
 v_cvt_pk_bf16_f32 v248, v200, v201
 v_cvt_pk_bf16_f32 v249, v202, v203
 v_cvt_pk_bf16_f32 v250, v204, v205
 v_cvt_pk_bf16_f32 v251, v206, v207
 v_cvt_pk_bf16_f32 v252, v208, v209
 v_cvt_pk_bf16_f32 v253, v210, v211
 buffer_store_dwordx4 v[244:247], v29, s[16:19], s27 offen sc1
 buffer_store_dwordx4 v[248:251], v30, s[16:19], s27 offen sc1
 buffer_store_dwordx2 v[252:253], v31, s[16:19], s27 offen sc1
 s_add_u32 s27, s27, 2048
 s_mov_b64 s[78:79], -1
 s_mov_b64 s[80:81], -1
 s_mov_b64 s[82:83], -1
 s_mov_b64 s[84:85], -1
 s_mov_b64 s[86:87], -1
 s_mov_b64 s[88:89], -1
 s_mov_b64 s[90:91], -1
 s_sub_u32 s26, s26, 1
 s_cmp_gt_u32 s26, 0
 s_waitcnt lgkmcnt(0)
 s_cbranch_scc1 bf_blk_193
 s_waitcnt vmcnt(0) lgkmcnt(0)
 s_barrier
 s_mov_b32 s84, 0
 s_mov_b32 s85, -1
 v_readfirstlane_b32 s21, v32
 s_cmp_ge_u32 s21, 32
 s_cbranch_scc1 bt_197
 s_mov_b32 s21, 76
 v_mov_b32 v4, 0
 s_mov_b32 s101, 0
wf_198:
 buffer_load_dword v5, v4, s[64:67], s21 offen sc1
 s_add_u32 s101, s101, 1
 s_cmp_gt_u32 s101, 131072
 s_cbranch_scc1 main_end
 s_waitcnt vmcnt(0)
 v_readfirstlane_b32 s100, v5
 s_cmp_ge_u32 s100, 32
 s_cbranch_scc1 wf_199
 s_sleep 8
 s_branch wf_198
wf_199:
bt_197:
 s_mov_b32 s21, 91136
 s_cmp_lg_u32 s20, 0
 s_cbranch_scc1 af_200
 v_mov_b32 v4, 0
 v_mov_b32 v5, 1
 s_mov_b64 exec, 1
 buffer_atomic_add v5, v4, s[72:75], s21 offen sc1
 s_mov_b64 exec, -1
 s_nop 1
af_200:
 s_mov_b32 s101, 0
c0_201:
 v_cmp_eq_u32 vcc, 0, v50
 s_nop 1
 s_cbranch_vccz c0_202
 s_sleep 8
 v_and_b32 v51, 31, v1
 buffer_load_ubyte v50, v51, s[64:67], 0 offen offset:160 sc1
 s_add_u32 s101, s101, 1
 s_cmp_gt_u32 s101, 131072
 s_cbranch_scc1 main_end
 s_waitcnt vmcnt(0)
 s_branch c0_201
c0_202:
 v_cmp_eq_u32 vcc, 2, v50
 s_nop 1
 s_mov_b32 s37, vcc_lo
q_entry:
 s_load_dwordx2 s[4:5], s[0:1], 0
 s_load_dwordx2 s[6:7], s[0:1], 16
 s_load_dwordx2 s[38:39], s[0:1], 104
 s_mov_b32 s42, s2
 s_cmp_lt_u32 s3, 64
 s_cselect_b32 s41, 11, 0
 s_cselect_b32 s45, 8, 0
 s_waitcnt lgkmcnt(0)
 s_mov_b32 s8, s4
 s_mov_b32 s9, s5
 s_mov_b32 s10, 2621440
 s_mov_b32 s11, 0x00020000
 s_mov_b32 s12, s6
 s_mov_b32 s13, s7
 s_mov_b32 s14, 7864320
 s_mov_b32 s15, 0x00020000
 s_mov_b32 s16, s38
 s_mov_b32 s17, s39
 s_mov_b32 s18, 50331648
 s_mov_b32 s19, 0x00020000
 s_add_u32 s52, s38, 180355072
 s_addc_u32 s53, s39, 0
 s_mov_b32 s54, 67108864
 s_mov_b32 s55, 0x00020000
 s_add_u32 s56, s38, 180355072
 s_addc_u32 s57, s39, 0
 s_mov_b32 s58, 67108864
 s_mov_b32 s59, 0x00020000
 s_load_dwordx2 s[72:73], s[0:1], 104
 s_waitcnt lgkmcnt(0)
 s_add_u32 s72, s72, 81068032
 s_addc_u32 s73, s73, 0
 s_mov_b32 s74, 129024
 s_mov_b32 s75, 0x00020000
 s_mul_i32 s44, s42, 384
 s_mul_i32 s24, s45, 307200
 v_mov_b32 v9, 2731
 s_and_b32 s22, s20, 1
 s_lshl_b32 s22, s22, 2
 v_add_u32 v8, 0, v1
 v_mul_u32_u24 v7, v8, v9
 v_lshrrev_b32 v7, 16, v7
 v_mul_u32_u24 v4, 24, v7
 v_sub_u32 v8, v8, v4
 v_and_b32 v4, 2, v7
 v_xor_b32 v8, v8, v4
 v_xor_b32 v8, s22, v8
 v_xor_b32 v5, 4, v8
 s_mov_b32 s21, 12288
 v_mul_lo_u32 v7, v7, s21
 v_lshl_add_u32 v40, v8, 4, v7
 v_lshl_add_u32 v43, v5, 4, v7
 v_add_u32 v8, 64, v1
 v_mul_u32_u24 v7, v8, v9
 v_lshrrev_b32 v7, 16, v7
 v_mul_u32_u24 v4, 24, v7
 v_sub_u32 v8, v8, v4
 v_and_b32 v4, 2, v7
 v_xor_b32 v8, v8, v4
 v_xor_b32 v8, s22, v8
 v_xor_b32 v5, 4, v8
 s_mov_b32 s21, 12288
 v_mul_lo_u32 v7, v7, s21
 v_lshl_add_u32 v41, v8, 4, v7
 v_lshl_add_u32 v44, v5, 4, v7
 v_add_u32 v8, 128, v1
 v_mul_u32_u24 v7, v8, v9
 v_lshrrev_b32 v7, 16, v7
 v_mul_u32_u24 v4, 24, v7
 v_sub_u32 v8, v8, v4
 v_and_b32 v4, 2, v7
 v_xor_b32 v8, v8, v4
 v_xor_b32 v8, s22, v8
 v_xor_b32 v5, 4, v8
 s_mov_b32 s21, 12288
 v_mul_lo_u32 v7, v7, s21
 v_lshl_add_u32 v42, v8, 4, v7
 v_lshl_add_u32 v45, v5, 4, v7
 s_mul_i32 s23, s20, 491520
 s_add_u32 s23, s23, s44
 s_mul_i32 s22, s20, 15360
 s_add_u32 s22, s22, 98304
 s_add_u32 s21, s23, 0
 s_add_u32 m0, s22, 0
 s_nop 0
 buffer_load_dwordx4 v40, s[12:15], s21 offen lds
 s_add_u32 m0, s22, 1024
 s_nop 0
 buffer_load_dwordx4 v41, s[12:15], s21 offen lds
 s_add_u32 m0, s22, 2048
 s_nop 0
 buffer_load_dwordx4 v42, s[12:15], s21 offen lds
 s_add_u32 s21, s23, 98304
 s_add_u32 m0, s22, 3072
 s_nop 0
 buffer_load_dwordx4 v43, s[12:15], s21 offen lds
 s_add_u32 m0, s22, 4096
 s_nop 0
 buffer_load_dwordx4 v44, s[12:15], s21 offen lds
 s_add_u32 m0, s22, 5120
 s_nop 0
 buffer_load_dwordx4 v45, s[12:15], s21 offen lds
 s_add_u32 s21, s23, 196608
 s_add_u32 m0, s22, 6144
 s_nop 0
 buffer_load_dwordx4 v40, s[12:15], s21 offen lds
 s_add_u32 m0, s22, 7168
 s_nop 0
 buffer_load_dwordx4 v41, s[12:15], s21 offen lds
 s_add_u32 m0, s22, 8192
 s_nop 0
 buffer_load_dwordx4 v42, s[12:15], s21 offen lds
 s_add_u32 s21, s23, 294912
 s_add_u32 m0, s22, 9216
 s_nop 0
 buffer_load_dwordx4 v43, s[12:15], s21 offen lds
 s_add_u32 m0, s22, 10240
 s_nop 0
 buffer_load_dwordx4 v44, s[12:15], s21 offen lds
 s_add_u32 m0, s22, 11264
 s_nop 0
 buffer_load_dwordx4 v45, s[12:15], s21 offen lds
 s_add_u32 s21, s23, 393216
 s_add_u32 m0, s22, 12288
 s_nop 0
 buffer_load_dwordx4 v40, s[12:15], s21 offen lds
 s_add_u32 m0, s22, 13312
 s_nop 0
 buffer_load_dwordx4 v41, s[12:15], s21 offen lds
 s_add_u32 m0, s22, 14336
 s_nop 0
 buffer_load_dwordx4 v42, s[12:15], s21 offen lds
 s_add_u32 s21, s23, 1966080
 buffer_load_dwordx4 v[64:67], v40, s[12:15], s21 offen
 buffer_load_dwordx4 v[68:71], v41, s[12:15], s21 offen
 buffer_load_dwordx4 v[72:75], v42, s[12:15], s21 offen
 s_add_u32 s21, s23, 2064384
 buffer_load_dwordx4 v[76:79], v43, s[12:15], s21 offen
 buffer_load_dwordx4 v[80:83], v44, s[12:15], s21 offen
 buffer_load_dwordx4 v[84:87], v45, s[12:15], s21 offen
 s_add_u32 s21, s23, 2162688
 buffer_load_dwordx4 v[88:91], v40, s[12:15], s21 offen
 buffer_load_dwordx4 v[92:95], v41, s[12:15], s21 offen
 buffer_load_dwordx4 v[96:99], v42, s[12:15], s21 offen
 s_add_u32 s21, s23, 2260992
 buffer_load_dwordx4 v[100:103], v43, s[12:15], s21 offen
 buffer_load_dwordx4 v[104:107], v44, s[12:15], s21 offen
 buffer_load_dwordx4 v[108:111], v45, s[12:15], s21 offen
 s_add_u32 s21, s23, 2359296
 buffer_load_dwordx4 v[112:115], v40, s[12:15], s21 offen
 buffer_load_dwordx4 v[116:119], v41, s[12:15], s21 offen
 buffer_load_dwordx4 v[120:123], v42, s[12:15], s21 offen
 s_add_u32 s21, s23, 3932160
 buffer_load_dwordx4 v[124:127], v40, s[12:15], s21 offen
 buffer_load_dwordx4 v[128:131], v41, s[12:15], s21 offen
 buffer_load_dwordx4 v[132:135], v42, s[12:15], s21 offen
 s_add_u32 s21, s23, 4030464
 buffer_load_dwordx4 v[136:139], v43, s[12:15], s21 offen
 buffer_load_dwordx4 v[140:143], v44, s[12:15], s21 offen
 buffer_load_dwordx4 v[144:147], v45, s[12:15], s21 offen
 s_add_u32 s21, s23, 4128768
 buffer_load_dwordx4 v[148:151], v40, s[12:15], s21 offen
 buffer_load_dwordx4 v[152:155], v41, s[12:15], s21 offen
 buffer_load_dwordx4 v[156:159], v42, s[12:15], s21 offen
 s_add_u32 s21, s23, 4227072
 buffer_load_dwordx4 v[160:163], v43, s[12:15], s21 offen
 buffer_load_dwordx4 v[164:167], v44, s[12:15], s21 offen
 buffer_load_dwordx4 v[168:171], v45, s[12:15], s21 offen
 s_add_u32 s21, s23, 4325376
 buffer_load_dwordx4 v[172:175], v40, s[12:15], s21 offen
 buffer_load_dwordx4 v[176:179], v41, s[12:15], s21 offen
 buffer_load_dwordx4 v[180:183], v42, s[12:15], s21 offen
 s_add_u32 s21, s23, 5898240
 buffer_load_dwordx4 v[184:187], v40, s[12:15], s21 offen
 buffer_load_dwordx4 v[188:191], v41, s[12:15], s21 offen
 buffer_load_dwordx4 v[192:195], v42, s[12:15], s21 offen
 s_add_u32 s21, s23, 5996544
 buffer_load_dwordx4 v[196:199], v43, s[12:15], s21 offen
 buffer_load_dwordx4 v[200:203], v44, s[12:15], s21 offen
 buffer_load_dwordx4 v[204:207], v45, s[12:15], s21 offen
 s_add_u32 s21, s23, 6094848
 buffer_load_dwordx4 v[208:211], v40, s[12:15], s21 offen
 buffer_load_dwordx4 v[212:215], v41, s[12:15], s21 offen
 buffer_load_dwordx4 v[216:219], v42, s[12:15], s21 offen
 s_add_u32 s21, s23, 6193152
 buffer_load_dwordx4 v[220:223], v43, s[12:15], s21 offen
 buffer_load_dwordx4 v[224:227], v44, s[12:15], s21 offen
 buffer_load_dwordx4 v[228:231], v45, s[12:15], s21 offen
 s_add_u32 s21, s23, 6291456
 buffer_load_dwordx4 v[232:235], v40, s[12:15], s21 offen
 buffer_load_dwordx4 v[236:239], v41, s[12:15], s21 offen
 buffer_load_dwordx4 v[240:243], v42, s[12:15], s21 offen
 v_lshl_add_u32 v49, v1, 4, s22
 v_lshrrev_b32 v7, 2, v2
 v_and_b32 v4, 2, v7
 v_and_b32 v5, 1, v3
 v_lshl_or_b32 v4, v5, 2, v4
 v_lshl_add_u32 v7, v3, 3, v7
 v_mul_u32_u24 v7, 384, v7
 v_and_b32 v5, 1, v2
 v_lshl_add_u32 v7, v5, 3, v7
 v_add_u32 v7, 98304, v7
 v_bfe_u32 v8, v2, 1, 1
 s_mul_i32 s21, s20, 6
 v_add_u32 v8, s21, v8
 v_add_u32 v5, 0, v8
 v_xor_b32 v5, v5, v4
 v_lshl_add_u32 v46, v5, 4, v7
 v_add_u32 v5, 2, v8
 v_xor_b32 v5, v5, v4
 v_lshl_add_u32 v47, v5, 4, v7
 v_add_u32 v5, 4, v8
 v_xor_b32 v5, v5, v4
 v_lshl_add_u32 v48, v5, 4, v7
 s_waitcnt vmcnt(45)
 s_barrier
 ds_read_b64_tr_b16 a[0:1], v46 offset:0
 ds_read_b64_tr_b16 a[2:3], v46 offset:1536
 ds_read_b64_tr_b16 a[4:5], v47 offset:0
 ds_read_b64_tr_b16 a[6:7], v47 offset:1536
 ds_read_b64_tr_b16 a[8:9], v48 offset:0
 ds_read_b64_tr_b16 a[10:11], v48 offset:1536
 ds_read_b64_tr_b16 a[12:13], v46 offset:12288
 ds_read_b64_tr_b16 a[14:15], v46 offset:13824
 ds_read_b64_tr_b16 a[16:17], v47 offset:12288
 ds_read_b64_tr_b16 a[18:19], v47 offset:13824
 ds_read_b64_tr_b16 a[20:21], v48 offset:12288
 ds_read_b64_tr_b16 a[22:23], v48 offset:13824
 ds_read_b64_tr_b16 a[24:25], v46 offset:24576
 ds_read_b64_tr_b16 a[26:27], v46 offset:26112
 ds_read_b64_tr_b16 a[28:29], v47 offset:24576
 ds_read_b64_tr_b16 a[30:31], v47 offset:26112
 ds_read_b64_tr_b16 a[32:33], v48 offset:24576
 ds_read_b64_tr_b16 a[34:35], v48 offset:26112
 ds_read_b64_tr_b16 a[36:37], v46 offset:36864
 ds_read_b64_tr_b16 a[38:39], v46 offset:38400
 ds_read_b64_tr_b16 a[40:41], v47 offset:36864
 ds_read_b64_tr_b16 a[42:43], v47 offset:38400
 ds_read_b64_tr_b16 a[44:45], v48 offset:36864
 ds_read_b64_tr_b16 a[46:47], v48 offset:38400
 ds_read_b64_tr_b16 a[48:49], v46 offset:49152
 ds_read_b64_tr_b16 a[50:51], v46 offset:50688
 ds_read_b64_tr_b16 a[52:53], v47 offset:49152
 ds_read_b64_tr_b16 a[54:55], v47 offset:50688
 ds_read_b64_tr_b16 a[56:57], v48 offset:49152
 ds_read_b64_tr_b16 a[58:59], v48 offset:50688
 v_lshrrev_b32 v11, 3, v1
 v_and_b32 v12, 7, v1
 v_xor_b32 v12, v12, v11
 v_mul_u32_u24 v11, 1280, v11
 v_lshl_add_u32 v10, v12, 4, v11
 s_mul_i32 s46, s20, 40960
 v_add_u32 v10, s46, v10
 s_lshl_b32 s47, s20, 12
 s_add_u32 s47, s47, 0
 s_add_u32 s46, s47, 98304
 s_mov_b32 s30, s24
 s_add_u32 s32, s47, 0
 v_add_u32 v11, 9216, v10
 v_add_u32 v12, 18432, v10
 v_add_u32 v13, 27648, v10
 s_mov_b32 m0, s32
 s_nop 0
 buffer_load_dwordx4 v10, s[8:11], s30 offen offset:0 lds
 buffer_load_dwordx4 v11, s[8:11], s30 offen offset:1024 lds
 buffer_load_dwordx4 v12, s[8:11], s30 offen offset:2048 lds
 buffer_load_dwordx4 v13, s[8:11], s30 offen offset:3072 lds
 s_add_u32 s30, s30, 128
 s_add_u32 s32, s32, 16384
 s_cmp_lt_u32 s32, s46
 s_cselect_b32 s32, s32, s47
 s_mov_b32 m0, s32
 s_nop 0
 buffer_load_dwordx4 v10, s[8:11], s30 offen offset:0 lds
 buffer_load_dwordx4 v11, s[8:11], s30 offen offset:1024 lds
 buffer_load_dwordx4 v12, s[8:11], s30 offen offset:2048 lds
 buffer_load_dwordx4 v13, s[8:11], s30 offen offset:3072 lds
 s_add_u32 s30, s30, 128
 s_add_u32 s32, s32, 16384
 s_cmp_lt_u32 s32, s46
 s_cselect_b32 s32, s32, s47
 s_mov_b32 m0, s32
 s_nop 0
 buffer_load_dwordx4 v10, s[8:11], s30 offen offset:0 lds
 buffer_load_dwordx4 v11, s[8:11], s30 offen offset:1024 lds
 buffer_load_dwordx4 v12, s[8:11], s30 offen offset:2048 lds
 buffer_load_dwordx4 v13, s[8:11], s30 offen offset:3072 lds
 s_add_u32 s30, s30, 128
 s_add_u32 s32, s32, 16384
 s_cmp_lt_u32 s32, s46
 s_cselect_b32 s32, s32, s47
 s_mov_b32 m0, s32
 s_nop 0
 buffer_load_dwordx4 v10, s[8:11], s30 offen offset:0 lds
 buffer_load_dwordx4 v11, s[8:11], s30 offen offset:1024 lds
 buffer_load_dwordx4 v12, s[8:11], s30 offen offset:2048 lds
 buffer_load_dwordx4 v13, s[8:11], s30 offen offset:3072 lds
 s_add_u32 s30, s30, 128
 s_add_u32 s32, s32, 16384
 s_cmp_lt_u32 s32, s46
 s_cselect_b32 s32, s32, s47
 s_waitcnt lgkmcnt(0)
 s_barrier
 s_waitcnt vmcnt(46)
 ds_write_b128 v49, v[64:67] offset:0
 ds_write_b128 v49, v[68:71] offset:1024
 ds_write_b128 v49, v[72:75] offset:2048
 ds_write_b128 v49, v[76:79] offset:3072
 ds_write_b128 v49, v[80:83] offset:4096
 ds_write_b128 v49, v[84:87] offset:5120
 ds_write_b128 v49, v[88:91] offset:6144
 ds_write_b128 v49, v[92:95] offset:7168
 ds_write_b128 v49, v[96:99] offset:8192
 ds_write_b128 v49, v[100:103] offset:9216
 ds_write_b128 v49, v[104:107] offset:10240
 ds_write_b128 v49, v[108:111] offset:11264
 ds_write_b128 v49, v[112:115] offset:12288
 ds_write_b128 v49, v[116:119] offset:13312
 ds_write_b128 v49, v[120:123] offset:14336
 s_waitcnt lgkmcnt(0)
 s_barrier
 ds_read_b64_tr_b16 a[60:61], v46 offset:0
 ds_read_b64_tr_b16 a[62:63], v46 offset:1536
 ds_read_b64_tr_b16 a[64:65], v47 offset:0
 ds_read_b64_tr_b16 a[66:67], v47 offset:1536
 ds_read_b64_tr_b16 a[68:69], v48 offset:0
 ds_read_b64_tr_b16 a[70:71], v48 offset:1536
 ds_read_b64_tr_b16 a[72:73], v46 offset:12288
 ds_read_b64_tr_b16 a[74:75], v46 offset:13824
 ds_read_b64_tr_b16 a[76:77], v47 offset:12288
 ds_read_b64_tr_b16 a[78:79], v47 offset:13824
 ds_read_b64_tr_b16 a[80:81], v48 offset:12288
 ds_read_b64_tr_b16 a[82:83], v48 offset:13824
 ds_read_b64_tr_b16 a[84:85], v46 offset:24576
 ds_read_b64_tr_b16 a[86:87], v46 offset:26112
 ds_read_b64_tr_b16 a[88:89], v47 offset:24576
 ds_read_b64_tr_b16 a[90:91], v47 offset:26112
 ds_read_b64_tr_b16 a[92:93], v48 offset:24576
 ds_read_b64_tr_b16 a[94:95], v48 offset:26112
 ds_read_b64_tr_b16 a[96:97], v46 offset:36864
 ds_read_b64_tr_b16 a[98:99], v46 offset:38400
 ds_read_b64_tr_b16 a[100:101], v47 offset:36864
 ds_read_b64_tr_b16 a[102:103], v47 offset:38400
 ds_read_b64_tr_b16 a[104:105], v48 offset:36864
 ds_read_b64_tr_b16 a[106:107], v48 offset:38400
 ds_read_b64_tr_b16 a[108:109], v46 offset:49152
 ds_read_b64_tr_b16 a[110:111], v46 offset:50688
 ds_read_b64_tr_b16 a[112:113], v47 offset:49152
 ds_read_b64_tr_b16 a[114:115], v47 offset:50688
 ds_read_b64_tr_b16 a[116:117], v48 offset:49152
 ds_read_b64_tr_b16 a[118:119], v48 offset:50688
 s_waitcnt lgkmcnt(0)
 s_barrier
 s_waitcnt vmcnt(31)
 ds_write_b128 v49, v[124:127] offset:0
 ds_write_b128 v49, v[128:131] offset:1024
 ds_write_b128 v49, v[132:135] offset:2048
 ds_write_b128 v49, v[136:139] offset:3072
 ds_write_b128 v49, v[140:143] offset:4096
 ds_write_b128 v49, v[144:147] offset:5120
 ds_write_b128 v49, v[148:151] offset:6144
 ds_write_b128 v49, v[152:155] offset:7168
 ds_write_b128 v49, v[156:159] offset:8192
 ds_write_b128 v49, v[160:163] offset:9216
 ds_write_b128 v49, v[164:167] offset:10240
 ds_write_b128 v49, v[168:171] offset:11264
 ds_write_b128 v49, v[172:175] offset:12288
 ds_write_b128 v49, v[176:179] offset:13312
 ds_write_b128 v49, v[180:183] offset:14336
 s_waitcnt lgkmcnt(0)
 s_barrier
 ds_read_b64_tr_b16 a[120:121], v46 offset:0
 ds_read_b64_tr_b16 a[122:123], v46 offset:1536
 ds_read_b64_tr_b16 a[124:125], v47 offset:0
 ds_read_b64_tr_b16 a[126:127], v47 offset:1536
 ds_read_b64_tr_b16 a[128:129], v48 offset:0
 ds_read_b64_tr_b16 a[130:131], v48 offset:1536
 ds_read_b64_tr_b16 a[132:133], v46 offset:12288
 ds_read_b64_tr_b16 a[134:135], v46 offset:13824
 ds_read_b64_tr_b16 a[136:137], v47 offset:12288
 ds_read_b64_tr_b16 a[138:139], v47 offset:13824
 ds_read_b64_tr_b16 a[140:141], v48 offset:12288
 ds_read_b64_tr_b16 a[142:143], v48 offset:13824
 ds_read_b64_tr_b16 a[144:145], v46 offset:24576
 ds_read_b64_tr_b16 a[146:147], v46 offset:26112
 ds_read_b64_tr_b16 a[148:149], v47 offset:24576
 ds_read_b64_tr_b16 a[150:151], v47 offset:26112
 ds_read_b64_tr_b16 a[152:153], v48 offset:24576
 ds_read_b64_tr_b16 a[154:155], v48 offset:26112
 ds_read_b64_tr_b16 a[156:157], v46 offset:36864
 ds_read_b64_tr_b16 a[158:159], v46 offset:38400
 ds_read_b64_tr_b16 a[160:161], v47 offset:36864
 ds_read_b64_tr_b16 a[162:163], v47 offset:38400
 ds_read_b64_tr_b16 a[164:165], v48 offset:36864
 ds_read_b64_tr_b16 a[166:167], v48 offset:38400
 ds_read_b64_tr_b16 a[168:169], v46 offset:49152
 ds_read_b64_tr_b16 a[170:171], v46 offset:50688
 ds_read_b64_tr_b16 a[172:173], v47 offset:49152
 ds_read_b64_tr_b16 a[174:175], v47 offset:50688
 ds_read_b64_tr_b16 a[176:177], v48 offset:49152
 ds_read_b64_tr_b16 a[178:179], v48 offset:50688
 s_waitcnt lgkmcnt(0)
 s_barrier
 s_waitcnt vmcnt(16)
 ds_write_b128 v49, v[184:187] offset:0
 ds_write_b128 v49, v[188:191] offset:1024
 ds_write_b128 v49, v[192:195] offset:2048
 ds_write_b128 v49, v[196:199] offset:3072
 ds_write_b128 v49, v[200:203] offset:4096
 ds_write_b128 v49, v[204:207] offset:5120
 ds_write_b128 v49, v[208:211] offset:6144
 ds_write_b128 v49, v[212:215] offset:7168
 ds_write_b128 v49, v[216:219] offset:8192
 ds_write_b128 v49, v[220:223] offset:9216
 ds_write_b128 v49, v[224:227] offset:10240
 ds_write_b128 v49, v[228:231] offset:11264
 ds_write_b128 v49, v[232:235] offset:12288
 ds_write_b128 v49, v[236:239] offset:13312
 ds_write_b128 v49, v[240:243] offset:14336
 s_waitcnt lgkmcnt(0)
 s_barrier
 ds_read_b64_tr_b16 a[180:181], v46 offset:0
 ds_read_b64_tr_b16 a[182:183], v46 offset:1536
 ds_read_b64_tr_b16 a[184:185], v47 offset:0
 ds_read_b64_tr_b16 a[186:187], v47 offset:1536
 ds_read_b64_tr_b16 a[188:189], v48 offset:0
 ds_read_b64_tr_b16 a[190:191], v48 offset:1536
 ds_read_b64_tr_b16 a[192:193], v46 offset:12288
 ds_read_b64_tr_b16 a[194:195], v46 offset:13824
 ds_read_b64_tr_b16 a[196:197], v47 offset:12288
 ds_read_b64_tr_b16 a[198:199], v47 offset:13824
 ds_read_b64_tr_b16 a[200:201], v48 offset:12288
 ds_read_b64_tr_b16 a[202:203], v48 offset:13824
 ds_read_b64_tr_b16 a[204:205], v46 offset:24576
 ds_read_b64_tr_b16 a[206:207], v46 offset:26112
 ds_read_b64_tr_b16 a[208:209], v47 offset:24576
 ds_read_b64_tr_b16 a[210:211], v47 offset:26112
 ds_read_b64_tr_b16 a[212:213], v48 offset:24576
 ds_read_b64_tr_b16 a[214:215], v48 offset:26112
 ds_read_b64_tr_b16 a[216:217], v46 offset:36864
 ds_read_b64_tr_b16 a[218:219], v46 offset:38400
 ds_read_b64_tr_b16 a[220:221], v47 offset:36864
 ds_read_b64_tr_b16 a[222:223], v47 offset:38400
 ds_read_b64_tr_b16 a[224:225], v48 offset:36864
 ds_read_b64_tr_b16 a[226:227], v48 offset:38400
 ds_read_b64_tr_b16 a[228:229], v46 offset:49152
 ds_read_b64_tr_b16 a[230:231], v46 offset:50688
 ds_read_b64_tr_b16 a[232:233], v47 offset:49152
 ds_read_b64_tr_b16 a[234:235], v47 offset:50688
 ds_read_b64_tr_b16 a[236:237], v48 offset:49152
 ds_read_b64_tr_b16 a[238:239], v48 offset:50688
 s_waitcnt lgkmcnt(0)
 s_barrier
 s_add_u32 s12, s38, 57671680
 s_addc_u32 s13, s39, 0
 s_mov_b32 s14, 1572864
 s_mov_b32 s15, 0x00020000
 s_mul_i32 s21, s20, 12800
 s_add_u32 s21, s21, 98304
 v_mul_u32_u24 v4, 400, v2
 v_lshlrev_b32 v5, 4, v3
 v_add3_u32 v29, v4, v5, s21
 v_lshlrev_b32 v30, 4, v1
 v_and_b32 v4, 1, v2
 v_bfe_u32 v5, v2, 1, 1
 v_lshl_or_b32 v4, v5, 2, v4
 v_bfe_u32 v5, v2, 2, 1
 v_lshl_or_b32 v4, v5, 1, v4
 v_lshlrev_b32 v4, 4, v4
 v_lshl_add_u32 v31, v3, 7, v4
 v_lshlrev_b32 v32, 3, v1
 v_and_b32 v4, 3, v1
 v_lshlrev_b32 v33, 3, v4
 v_mov_b32 v34, 0xf149f2ca
 v_lshlrev_b32 v4, 2, v3
 v_sub_u32 v35, v2, v4
 v_cmp_gt_u32 s[60:61], 2, v3
 s_mov_b32 s62, 0x3d93cd3a
 s_mov_b32 s63, 0x3fb8aa3b
 s_mov_b32 s83, 0x3dd53b95
 v_cmp_le_i32 s[64:65], 0, v35
 v_cmp_le_i32 s[66:67], 1, v35
 v_cmp_le_i32 s[68:69], 2, v35
 v_cmp_le_i32 s[70:71], 3, v35
 s_mov_b32 s25, 163840
 s_cmp_lg_u32 s45, 0
 s_cselect_b32 s26, 5, 11
 s_cselect_b32 s40, 5, 99
 s_cselect_b32 s25, 4294311936, s25
 s_lshl_b32 s43, s42, 2
 s_add_u32 s43, s43, s20
 s_mul_i32 s43, s43, 12288
 s_lshr_b32 s21, s42, 2
 s_lshl_b32 s21, s21, 14
 s_and_b32 s44, s42, 3
 s_lshl_b32 s44, s44, 11
 s_add_u32 s44, s44, s21
 s_add_u32 s44, s44, 655360
 s_lshr_b32 s36, s42, 1
 s_lshl_b32 s36, s36, 14
 s_and_b32 s21, s42, 1
 s_mul_i32 s21, s21, 3072
 s_add_u32 s36, s36, s21
 s_add_u32 s36, s36, 655360
 s_lshl_b32 s49, s41, 2
 s_add_u32 s49, s49, s20
 s_mov_b32 s29, 4
 s_mov_b32 s78, 0
 s_mov_b32 s81, 0x80000000
 s_mov_b32 s82, 0
 s_mul_i32 s21, s49, 393216
 s_mul_i32 s22, s42, 12288
 s_add_u32 s50, s21, s22
 s_lshr_b32 s21, s49, 1
 s_bitcmp1_b32 s37, s21
 s_cselect_b32 s21, 8192, 0
 s_lshl_b32 s51, s49, 20
 s_or_b32 s51, s51, s21
 s_xor_b32 s51, s51, 8192
 s_add_u32 s51, s51, s36
 s_lshr_b32 s22, s49, 1
 s_lshr_b32 s21, s49, 2
 s_add_u32 s21, s21, 3
 s_cmp_lt_u32 s49, 12
 s_cselect_b32 s21, s22, s21
 s_lshl_b32 s21, s21, 3
 s_lshr_b32 s22, s42, 2
 s_add_u32 s21, s21, s22
 s_lshl_b32 s21, s21, 7
 s_add_u32 s76, s21, 0
 s_lshl_b32 s77, s42, 7
 s_add_u32 s77, s77, 19456
 v_mov_b32 v21, 0
 buffer_load_dword v21, v33, s[72:75], s77 offen sc1
 v_and_b32 v6, 7, v2
 v_add_u32 v4, 0, v3
 v_xor_b32 v4, v4, v6
 v_lshlrev_b32 v4, 4, v4
 v_lshl_add_u32 v14, v2, 7, v4
 v_add_u32 v4, 4, v3
 v_xor_b32 v4, v4, v6
 v_lshlrev_b32 v4, 4, v4
 v_lshl_add_u32 v15, v2, 7, v4
 v_mul_u32_u24 v22, 400, v2
 v_mul_u32_u24 v4, 16, v3
 s_mul_i32 s21, s20, 96
 s_add_u32 s21, s21, 98304
 v_add3_u32 v22, v22, v4, s21
 v_lshlrev_b32 v4, 3, v3
 v_sub_u32 v16, v22, v4
 v_mov_b32 v9, 2731
 s_mov_b32 s33, 0
 s_mov_b32 s48, 0x80000000
 s_mov_b32 m0, s32
 s_nop 0
 buffer_load_dwordx4 v10, s[8:11], s30 offen offset:0 lds
 buffer_load_dwordx4 v11, s[8:11], s30 offen offset:1024 lds
 s_waitcnt vmcnt(14)
 s_barrier
 v_add_u32 v18, s33, v14
 v_add_u32 v19, s33, v15
 s_add_u32 s33, s33, 16384
 s_cmp_lt_u32 s33, 98304
 s_cselect_b32 s33, s33, 0
 ds_read_b128 v[160:163], v18 offset:0
 ds_read_b128 v[164:167], v18 offset:2048
 ds_read_b128 v[168:171], v18 offset:4096
 ds_read_b128 v[172:175], v18 offset:6144
 ds_read_b128 v[176:179], v18 offset:8192
 ds_read_b128 v[180:183], v18 offset:10240
 ds_read_b128 v[184:187], v18 offset:12288
 ds_read_b128 v[188:191], v18 offset:14336
 s_waitcnt lgkmcnt(0)
qa_blk_204:
 v_mfma_f32_16x16x32_bf16 v[64:67], a[0:3], v[160:163], 0
 ds_read_b128 v[192:195], v19 offset:0
 v_mfma_f32_16x16x32_bf16 v[68:71], a[4:7], v[160:163], 0
 v_add_u32 v18, s33, v14
 v_cndmask_b32 v36, v34, v36, s[64:65]
 v_mfma_f32_16x16x32_bf16 v[72:75], a[8:11], v[160:163], 0
 v_cndmask_b32 v48, v34, v48, s[64:65]
 v_cndmask_b32 v37, v34, v37, s[66:67]
 v_mfma_f32_16x16x32_bf16 v[76:79], a[0:3], v[164:167], 0
 ds_read_b128 v[196:199], v19 offset:2048
 v_cndmask_b32 v49, v34, v49, s[66:67]
 v_mfma_f32_16x16x32_bf16 v[80:83], a[4:7], v[164:167], 0
 buffer_load_dwordx4 v12, s[8:11], s30 offen offset:2048 lds
 v_mfma_f32_16x16x32_bf16 v[84:87], a[8:11], v[164:167], 0
 v_cndmask_b32 v38, v34, v38, s[68:69]
 v_cndmask_b32 v50, v34, v50, s[68:69]
 v_mfma_f32_16x16x32_bf16 v[88:91], a[0:3], v[168:171], 0
 ds_read_b128 v[200:203], v19 offset:4096
 v_cndmask_b32 v39, v34, v39, s[70:71]
 v_mfma_f32_16x16x32_bf16 v[92:95], a[4:7], v[168:171], 0
 v_cndmask_b32 v51, v34, v51, s[70:71]
 v_max3_f32 v56, v36, v37, v38
 v_mfma_f32_16x16x32_bf16 v[96:99], a[8:11], v[168:171], 0
 v_max3_f32 v56, v56, v39, v40
 v_max3_f32 v56, v56, v41, v42
 v_mfma_f32_16x16x32_bf16 v[100:103], a[0:3], v[172:175], 0
 ds_read_b128 v[204:207], v19 offset:6144
 v_max_f32 v56, v56, v43
 v_mfma_f32_16x16x32_bf16 v[104:107], a[4:7], v[172:175], 0
 v_mov_b32 v57, v56
 v_mfma_f32_16x16x32_bf16 v[108:111], a[8:11], v[172:175], 0
 s_waitcnt lgkmcnt(15)
 v_mfma_f32_16x16x32_bf16 v[112:115], a[0:3], v[176:179], 0
 ds_read_b128 v[208:211], v19 offset:8192
 v_mfma_f32_16x16x32_bf16 v[116:119], a[4:7], v[176:179], 0
 s_nop 1
 v_mfma_f32_16x16x32_bf16 v[120:123], a[8:11], v[176:179], 0
 v_permlane32_swap_b32 v56, v57
 v_mfma_f32_16x16x32_bf16 v[124:127], a[0:3], v[180:183], 0
 ds_read_b128 v[212:215], v19 offset:10240
 v_max_f32 v56, v56, v57
 v_mfma_f32_16x16x32_bf16 v[128:131], a[4:7], v[180:183], 0
 buffer_load_dwordx4 v13, s[8:11], s30 offen offset:3072 lds
 v_mfma_f32_16x16x32_bf16 v[132:135], a[8:11], v[180:183], 0
 s_add_u32 s30, s30, 128
 s_add_u32 m0, m0, 16384
 v_mfma_f32_16x16x32_bf16 v[136:139], a[0:3], v[184:187], 0
 ds_read_b128 v[216:219], v19 offset:12288
 v_mov_b32 v57, v56
 v_mfma_f32_16x16x32_bf16 v[140:143], a[4:7], v[184:187], 0
 s_cmp_lt_u32 m0, s46
 s_cselect_b32 m0, m0, s47
 v_mfma_f32_16x16x32_bf16 v[144:147], a[8:11], v[184:187], 0
 s_nop 1
 v_mfma_f32_16x16x32_bf16 v[148:151], a[0:3], v[188:191], 0
 ds_read_b128 v[220:223], v19 offset:14336
 v_mfma_f32_16x16x32_bf16 v[152:155], a[4:7], v[188:191], 0
 v_permlane16_swap_b32 v56, v57
 v_mfma_f32_16x16x32_bf16 v[156:159], a[8:11], v[188:191], 0
 s_waitcnt vmcnt(12) lgkmcnt(4)
 s_barrier
 v_mfma_f32_16x16x32_bf16 v[64:67], a[12:15], v[192:195], v[64:67]
 ds_read_b128 v[160:163], v18 offset:0
 v_max_f32 v56, v56, v57
 v_mfma_f32_16x16x32_bf16 v[68:71], a[16:19], v[192:195], v[68:71]
 v_mul_f32 v56, s83, v56
 v_fma_f32 v36, v36, s83, -v56
 v_mfma_f32_16x16x32_bf16 v[72:75], a[20:23], v[192:195], v[72:75]
 v_add_u32 v19, s33, v15
 s_add_u32 s33, s33, 16384
 v_mfma_f32_16x16x32_bf16 v[76:79], a[12:15], v[196:199], v[76:79]
 ds_read_b128 v[164:167], v18 offset:2048
 s_mul_i32 s21, s49, 393216
 v_mfma_f32_16x16x32_bf16 v[80:83], a[16:19], v[196:199], v[80:83]
 buffer_load_dwordx4 v10, s[8:11], s30 offen offset:0 lds
 v_mfma_f32_16x16x32_bf16 v[84:87], a[20:23], v[196:199], v[84:87]
 s_cmp_lt_u32 s33, 98304
 s_cselect_b32 s33, s33, 0
 v_mfma_f32_16x16x32_bf16 v[88:91], a[12:15], v[200:203], v[88:91]
 ds_read_b128 v[168:171], v18 offset:4096
 s_mul_i32 s22, s42, 12288
 v_mfma_f32_16x16x32_bf16 v[92:95], a[16:19], v[200:203], v[92:95]
 s_add_u32 s50, s21, s22
 s_lshr_b32 s21, s49, 1
 v_mfma_f32_16x16x32_bf16 v[96:99], a[20:23], v[200:203], v[96:99]
 s_bitcmp1_b32 s37, s21
 s_cselect_b32 s21, 8192, 0
 v_mfma_f32_16x16x32_bf16 v[100:103], a[12:15], v[204:207], v[100:103]
 ds_read_b128 v[172:175], v18 offset:6144
 s_lshl_b32 s51, s49, 20
 v_mfma_f32_16x16x32_bf16 v[104:107], a[16:19], v[204:207], v[104:107]
 s_or_b32 s51, s51, s21
 s_xor_b32 s51, s51, 8192
 v_mfma_f32_16x16x32_bf16 v[108:111], a[20:23], v[204:207], v[108:111]
 s_waitcnt lgkmcnt(4)
 s_add_u32 s51, s51, s36
 v_mfma_f32_16x16x32_bf16 v[112:115], a[12:15], v[208:211], v[112:115]
 ds_read_b128 v[176:179], v18 offset:8192
 s_add_u32 s23, s49, 1
 v_mfma_f32_16x16x32_bf16 v[116:119], a[16:19], v[208:211], v[116:119]
 v_cmp_gt_u32 vcc, s23, v21
 v_fma_f32 v37, v37, s83, -v56
 v_mfma_f32_16x16x32_bf16 v[120:123], a[20:23], v[208:211], v[120:123]
 s_cmp_eq_u64 vcc, 0
 s_cselect_b32 s80, 1, 0
 s_cselect_b32 s51, s51, 0x80000000
 v_mfma_f32_16x16x32_bf16 v[124:127], a[12:15], v[212:215], v[124:127]
 ds_read_b128 v[180:183], v18 offset:10240
 s_lshl_b32 s79, s80, 3
 v_mfma_f32_16x16x32_bf16 v[128:131], a[16:19], v[212:215], v[128:131]
 buffer_load_dwordx4 v11, s[8:11], s30 offen offset:1024 lds
 v_mfma_f32_16x16x32_bf16 v[132:135], a[20:23], v[212:215], v[132:135]
 s_or_b32 s79, s79, s45
 v_fma_f32 v38, v38, s83, -v56
 v_mfma_f32_16x16x32_bf16 v[136:139], a[12:15], v[216:219], v[136:139]
 ds_read_b128 v[184:187], v18 offset:12288
 v_fma_f32 v39, v39, s83, -v56
 v_mfma_f32_16x16x32_bf16 v[140:143], a[16:19], v[216:219], v[140:143]
 buffer_load_dwordx4 a[240:243], v31, s[52:55], s51 offen offset:0 sc1
 v_mfma_f32_16x16x32_bf16 v[144:147], a[20:23], v[216:219], v[144:147]
 v_fma_f32 v40, v40, s83, -v56
 v_fma_f32 v41, v41, s83, -v56
 v_mfma_f32_16x16x32_bf16 v[148:151], a[12:15], v[220:223], v[148:151]
 ds_read_b128 v[188:191], v18 offset:14336
 v_fma_f32 v42, v42, s83, -v56
 v_mfma_f32_16x16x32_bf16 v[152:155], a[16:19], v[220:223], v[152:155]
 v_fma_f32 v43, v43, s83, -v56
 v_mfma_f32_16x16x32_bf16 v[156:159], a[20:23], v[220:223], v[156:159]
 s_waitcnt lgkmcnt(4)
 v_mfma_f32_16x16x32_bf16 v[64:67], a[24:27], v[160:163], v[64:67]
 ds_read_b128 v[192:195], v19 offset:0
 v_mfma_f32_16x16x32_bf16 v[68:71], a[28:31], v[160:163], v[68:71]
 v_add_u32 v18, s33, v14
 v_mfma_f32_16x16x32_bf16 v[72:75], a[32:35], v[160:163], v[72:75]
 v_exp_f32 v36, v36
 v_mfma_f32_16x16x32_bf16 v[76:79], a[24:27], v[164:167], v[76:79]
 ds_read_b128 v[196:199], v19 offset:2048
 v_mfma_f32_16x16x32_bf16 v[80:83], a[28:31], v[164:167], v[80:83]
 buffer_load_dwordx4 v12, s[8:11], s30 offen offset:2048 lds
 v_mfma_f32_16x16x32_bf16 v[84:87], a[32:35], v[164:167], v[84:87]
 v_exp_f32 v37, v37
 v_mfma_f32_16x16x32_bf16 v[88:91], a[24:27], v[168:171], v[88:91]
 ds_read_b128 v[200:203], v19 offset:4096
 v_mfma_f32_16x16x32_bf16 v[92:95], a[28:31], v[168:171], v[92:95]
 v_exp_f32 v38, v38
 v_mfma_f32_16x16x32_bf16 v[96:99], a[32:35], v[168:171], v[96:99]
 v_exp_f32 v39, v39
 v_mfma_f32_16x16x32_bf16 v[100:103], a[24:27], v[172:175], v[100:103]
 ds_read_b128 v[204:207], v19 offset:6144
 v_mfma_f32_16x16x32_bf16 v[104:107], a[28:31], v[172:175], v[104:107]
 v_exp_f32 v40, v40
 v_mfma_f32_16x16x32_bf16 v[108:111], a[32:35], v[172:175], v[108:111]
 s_waitcnt lgkmcnt(4)
 v_mfma_f32_16x16x32_bf16 v[112:115], a[24:27], v[176:179], v[112:115]
 ds_read_b128 v[208:211], v19 offset:8192
 v_mfma_f32_16x16x32_bf16 v[116:119], a[28:31], v[176:179], v[116:119]
 v_exp_f32 v41, v41
 v_mfma_f32_16x16x32_bf16 v[120:123], a[32:35], v[176:179], v[120:123]
 v_exp_f32 v42, v42
 v_mfma_f32_16x16x32_bf16 v[124:127], a[24:27], v[180:183], v[124:127]
 ds_read_b128 v[212:215], v19 offset:10240
 v_mfma_f32_16x16x32_bf16 v[128:131], a[28:31], v[180:183], v[128:131]
 buffer_load_dwordx4 v13, s[8:11], s30 offen offset:3072 lds
 v_mfma_f32_16x16x32_bf16 v[132:135], a[32:35], v[180:183], v[132:135]
 s_add_u32 s30, s30, 128
 s_add_u32 m0, m0, 16384
 v_mfma_f32_16x16x32_bf16 v[136:139], a[24:27], v[184:187], v[136:139]
 ds_read_b128 v[216:219], v19 offset:12288
 v_mfma_f32_16x16x32_bf16 v[140:143], a[28:31], v[184:187], v[140:143]
 s_cmp_lt_u32 m0, s46
 s_cselect_b32 m0, m0, s47
 v_mfma_f32_16x16x32_bf16 v[144:147], a[32:35], v[184:187], v[144:147]
 buffer_load_dwordx4 a[244:247], v31, s[52:55], s51 offen offset:512 sc1
 v_mfma_f32_16x16x32_bf16 v[148:151], a[24:27], v[188:191], v[148:151]
 ds_read_b128 v[220:223], v19 offset:14336
 v_mfma_f32_16x16x32_bf16 v[152:155], a[28:31], v[188:191], v[152:155]
 v_exp_f32 v43, v43
 v_mfma_f32_16x16x32_bf16 v[156:159], a[32:35], v[188:191], v[156:159]
 s_waitcnt vmcnt(14) lgkmcnt(4)
 s_barrier
 v_mfma_f32_16x16x32_bf16 v[64:67], a[36:39], v[192:195], v[64:67]
 ds_read_b128 v[160:163], v18 offset:0
 s_nop 0
 v_mfma_f32_16x16x32_bf16 v[68:71], a[40:43], v[192:195], v[68:71]
 v_add_f32 v56, v40, v41
 v_add_f32 v56, v56, v42
 v_mfma_f32_16x16x32_bf16 v[72:75], a[44:47], v[192:195], v[72:75]
 v_add_u32 v19, s33, v15
 s_add_u32 s33, s33, 16384
 v_mfma_f32_16x16x32_bf16 v[76:79], a[36:39], v[196:199], v[76:79]
 ds_read_b128 v[164:167], v18 offset:2048
 v_add_f32 v56, v56, v43
 v_mfma_f32_16x16x32_bf16 v[80:83], a[40:43], v[196:199], v[80:83]
 buffer_load_dwordx4 v10, s[8:11], s30 offen offset:0 lds
 v_mfma_f32_16x16x32_bf16 v[84:87], a[44:47], v[196:199], v[84:87]
 s_cmp_lt_u32 s33, 98304
 s_cselect_b32 s33, s33, 0
 v_mfma_f32_16x16x32_bf16 v[88:91], a[36:39], v[200:203], v[88:91]
 ds_read_b128 v[168:171], v18 offset:4096
 v_cndmask_b32 v56, 0, v56, s[60:61]
 v_mfma_f32_16x16x32_bf16 v[92:95], a[40:43], v[200:203], v[92:95]
 v_add_f32 v56, v56, v36
 v_add_f32 v56, v56, v37
 v_mfma_f32_16x16x32_bf16 v[96:99], a[44:47], v[200:203], v[96:99]
 v_add_f32 v56, v56, v38
 v_add_f32 v56, v56, v39
 v_mfma_f32_16x16x32_bf16 v[100:103], a[36:39], v[204:207], v[100:103]
 ds_read_b128 v[172:175], v18 offset:6144
 v_mov_b32 v57, v56
 v_mfma_f32_16x16x32_bf16 v[104:107], a[40:43], v[204:207], v[104:107]
 s_nop 1
 v_mfma_f32_16x16x32_bf16 v[108:111], a[44:47], v[204:207], v[108:111]
 s_waitcnt lgkmcnt(4)
 v_mfma_f32_16x16x32_bf16 v[112:115], a[36:39], v[208:211], v[112:115]
 ds_read_b128 v[176:179], v18 offset:8192
 v_mfma_f32_16x16x32_bf16 v[116:119], a[40:43], v[208:211], v[116:119]
 v_permlane32_swap_b32 v56, v57
 v_mfma_f32_16x16x32_bf16 v[120:123], a[44:47], v[208:211], v[120:123]
 v_add_f32 v56, v56, v57
 v_mov_b32 v57, v56
 v_mfma_f32_16x16x32_bf16 v[124:127], a[36:39], v[212:215], v[124:127]
 ds_read_b128 v[180:183], v18 offset:10240
 v_mfma_f32_16x16x32_bf16 v[128:131], a[40:43], v[212:215], v[128:131]
 buffer_load_dwordx4 v11, s[8:11], s30 offen offset:1024 lds
 v_mfma_f32_16x16x32_bf16 v[132:135], a[44:47], v[212:215], v[132:135]
 buffer_load_dwordx4 a[248:251], v31, s[52:55], s51 offen offset:1024 sc1
 v_mfma_f32_16x16x32_bf16 v[136:139], a[36:39], v[216:219], v[136:139]
 ds_read_b128 v[184:187], v18 offset:12288
 v_mfma_f32_16x16x32_bf16 v[140:143], a[40:43], v[216:219], v[140:143]
 s_nop 1
 v_mfma_f32_16x16x32_bf16 v[144:147], a[44:47], v[216:219], v[144:147]
 v_permlane16_swap_b32 v56, v57
 v_mfma_f32_16x16x32_bf16 v[148:151], a[36:39], v[220:223], v[148:151]
 ds_read_b128 v[188:191], v18 offset:14336
 v_add_f32 v56, v56, v57
 v_mfma_f32_16x16x32_bf16 v[152:155], a[40:43], v[220:223], v[152:155]
 v_rcp_f32 v56, v56
 v_mfma_f32_16x16x32_bf16 v[156:159], a[44:47], v[220:223], v[156:159]
 s_waitcnt lgkmcnt(4)
 s_nop 0
 v_mfma_f32_16x16x32_bf16 v[64:67], a[48:51], v[160:163], v[64:67]
 ds_read_b128 v[192:195], v19 offset:0
 v_mul_f32 v36, v36, v56
 v_mfma_f32_16x16x32_bf16 v[68:71], a[52:55], v[160:163], v[68:71]
 v_add_u32 v18, s33, v14
 v_mul_f32 v37, v37, v56
 v_mfma_f32_16x16x32_bf16 v[72:75], a[56:59], v[160:163], v[72:75]
 v_mul_f32 v38, v38, v56
 v_mul_f32 v39, v39, v56
 v_mfma_f32_16x16x32_bf16 v[76:79], a[48:51], v[164:167], v[76:79]
 ds_read_b128 v[196:199], v19 offset:2048
 v_mul_f32 v40, v40, v56
 v_mfma_f32_16x16x32_bf16 v[80:83], a[52:55], v[164:167], v[80:83]
 buffer_load_dwordx4 v12, s[8:11], s30 offen offset:2048 lds
 v_mfma_f32_16x16x32_bf16 v[84:87], a[56:59], v[164:167], v[84:87]
 v_mul_f32 v41, v41, v56
 v_mul_f32 v42, v42, v56
 v_mfma_f32_16x16x32_bf16 v[88:91], a[48:51], v[168:171], v[88:91]
 ds_read_b128 v[200:203], v19 offset:4096
 v_mul_f32 v43, v43, v56
 v_mfma_f32_16x16x32_bf16 v[92:95], a[52:55], v[168:171], v[92:95]
 v_max3_f32 v56, v44, v45, v46
 v_max3_f32 v56, v56, v47, v48
 v_mfma_f32_16x16x32_bf16 v[96:99], a[56:59], v[168:171], v[96:99]
 v_max3_f32 v56, v56, v49, v50
 v_max3_f32 v56, v56, v51, v52
 v_mfma_f32_16x16x32_bf16 v[100:103], a[48:51], v[172:175], v[100:103]
 ds_read_b128 v[204:207], v19 offset:6144
 v_max3_f32 v56, v56, v53, v54
 v_mfma_f32_16x16x32_bf16 v[104:107], a[52:55], v[172:175], v[104:107]
 v_max_f32 v56, v56, v55
 v_mov_b32 v57, v56
 v_mfma_f32_16x16x32_bf16 v[108:111], a[56:59], v[172:175], v[108:111]
 s_waitcnt lgkmcnt(4)
 v_mfma_f32_16x16x32_bf16 v[112:115], a[48:51], v[176:179], v[112:115]
 ds_read_b128 v[208:211], v19 offset:8192
 v_mfma_f32_16x16x32_bf16 v[116:119], a[52:55], v[176:179], v[116:119]
 buffer_load_dwordx4 a[252:255], v31, s[52:55], s51 offen offset:1536 sc1
 v_mfma_f32_16x16x32_bf16 v[120:123], a[56:59], v[176:179], v[120:123]
 s_nop 1
 v_mfma_f32_16x16x32_bf16 v[124:127], a[48:51], v[180:183], v[124:127]
 ds_read_b128 v[212:215], v19 offset:10240
 v_mfma_f32_16x16x32_bf16 v[128:131], a[52:55], v[180:183], v[128:131]
 buffer_load_dwordx4 v13, s[8:11], s30 offen offset:3072 lds
 v_mfma_f32_16x16x32_bf16 v[132:135], a[56:59], v[180:183], v[132:135]
 s_add_u32 s30, s30, 128
 s_add_u32 m0, m0, 16384
 v_mfma_f32_16x16x32_bf16 v[136:139], a[48:51], v[184:187], v[136:139]
 ds_read_b128 v[216:219], v19 offset:12288
 v_mfma_f32_16x16x32_bf16 v[140:143], a[52:55], v[184:187], v[140:143]
 s_cmp_lt_u32 m0, s46
 s_cselect_b32 m0, m0, s47
 v_mfma_f32_16x16x32_bf16 v[144:147], a[56:59], v[184:187], v[144:147]
 v_permlane32_swap_b32 v56, v57
 v_mfma_f32_16x16x32_bf16 v[148:151], a[48:51], v[188:191], v[148:151]
 ds_read_b128 v[220:223], v19 offset:14336
 v_max_f32 v56, v56, v57
 v_mfma_f32_16x16x32_bf16 v[152:155], a[52:55], v[188:191], v[152:155]
 v_mov_b32 v57, v56
 v_mfma_f32_16x16x32_bf16 v[156:159], a[56:59], v[188:191], v[156:159]
 s_waitcnt vmcnt(16) lgkmcnt(4)
 s_barrier
 v_mfma_f32_16x16x32_bf16 v[64:67], a[60:63], v[192:195], v[64:67]
 ds_read_b128 v[160:163], v18 offset:0
 v_mfma_f32_16x16x32_bf16 v[68:71], a[64:67], v[192:195], v[68:71]
 s_nop 1
 v_mfma_f32_16x16x32_bf16 v[72:75], a[68:71], v[192:195], v[72:75]
 v_add_u32 v19, s33, v15
 s_add_u32 s33, s33, 16384
 v_mfma_f32_16x16x32_bf16 v[76:79], a[60:63], v[196:199], v[76:79]
 ds_read_b128 v[164:167], v18 offset:2048
 v_mfma_f32_16x16x32_bf16 v[80:83], a[64:67], v[196:199], v[80:83]
 buffer_load_dwordx4 v10, s[8:11], s30 offen offset:0 lds
 v_mfma_f32_16x16x32_bf16 v[84:87], a[68:71], v[196:199], v[84:87]
 s_cmp_lt_u32 s33, 98304
 s_cselect_b32 s33, s33, 0
 v_mfma_f32_16x16x32_bf16 v[88:91], a[60:63], v[200:203], v[88:91]
 ds_read_b128 v[168:171], v18 offset:4096
 v_mfma_f32_16x16x32_bf16 v[92:95], a[64:67], v[200:203], v[92:95]
 v_permlane16_swap_b32 v56, v57
 v_mfma_f32_16x16x32_bf16 v[96:99], a[68:71], v[200:203], v[96:99]
 v_max_f32 v56, v56, v57
 v_mul_f32 v56, s83, v56
 v_mfma_f32_16x16x32_bf16 v[100:103], a[60:63], v[204:207], v[100:103]
 ds_read_b128 v[172:175], v18 offset:6144
 v_fma_f32 v44, v44, s83, -v56
 v_mfma_f32_16x16x32_bf16 v[104:107], a[64:67], v[204:207], v[104:107]
 buffer_load_dwordx4 v[24:27], v31, s[52:55], s51 offen offset:2048 sc1
 v_mfma_f32_16x16x32_bf16 v[108:111], a[68:71], v[204:207], v[108:111]
 s_waitcnt lgkmcnt(4)
 v_fma_f32 v45, v45, s83, -v56
 v_mfma_f32_16x16x32_bf16 v[112:115], a[60:63], v[208:211], v[112:115]
 ds_read_b128 v[176:179], v18 offset:8192
 v_fma_f32 v46, v46, s83, -v56
 v_mfma_f32_16x16x32_bf16 v[116:119], a[64:67], v[208:211], v[116:119]
 v_fma_f32 v47, v47, s83, -v56
 v_fma_f32 v48, v48, s83, -v56
 v_mfma_f32_16x16x32_bf16 v[120:123], a[68:71], v[208:211], v[120:123]
 v_fma_f32 v49, v49, s83, -v56
 v_fma_f32 v50, v50, s83, -v56
 v_mfma_f32_16x16x32_bf16 v[124:127], a[60:63], v[212:215], v[124:127]
 ds_read_b128 v[180:183], v18 offset:10240
 v_fma_f32 v51, v51, s83, -v56
 v_mfma_f32_16x16x32_bf16 v[128:131], a[64:67], v[212:215], v[128:131]
 buffer_load_dwordx4 v11, s[8:11], s30 offen offset:1024 lds
 v_mfma_f32_16x16x32_bf16 v[132:135], a[68:71], v[212:215], v[132:135]
 v_fma_f32 v52, v52, s83, -v56
 v_fma_f32 v53, v53, s83, -v56
 v_mfma_f32_16x16x32_bf16 v[136:139], a[60:63], v[216:219], v[136:139]
 ds_read_b128 v[184:187], v18 offset:12288
 v_fma_f32 v54, v54, s83, -v56
 v_mfma_f32_16x16x32_bf16 v[140:143], a[64:67], v[216:219], v[140:143]
 v_fma_f32 v55, v55, s83, -v56
 v_mfma_f32_16x16x32_bf16 v[144:147], a[68:71], v[216:219], v[144:147]
 v_exp_f32 v44, v44
 v_mfma_f32_16x16x32_bf16 v[148:151], a[60:63], v[220:223], v[148:151]
 ds_read_b128 v[188:191], v18 offset:14336
 v_mfma_f32_16x16x32_bf16 v[152:155], a[64:67], v[220:223], v[152:155]
 v_exp_f32 v45, v45
 v_mfma_f32_16x16x32_bf16 v[156:159], a[68:71], v[220:223], v[156:159]
 s_waitcnt lgkmcnt(4)
 v_mfma_f32_16x16x32_bf16 v[64:67], a[72:75], v[160:163], v[64:67]
 ds_read_b128 v[192:195], v19 offset:0
 v_mfma_f32_16x16x32_bf16 v[68:71], a[76:79], v[160:163], v[68:71]
 v_add_u32 v18, s33, v14
 v_mfma_f32_16x16x32_bf16 v[72:75], a[80:83], v[160:163], v[72:75]
 v_exp_f32 v46, v46
 v_mfma_f32_16x16x32_bf16 v[76:79], a[72:75], v[164:167], v[76:79]
 ds_read_b128 v[196:199], v19 offset:2048
 v_mfma_f32_16x16x32_bf16 v[80:83], a[76:79], v[164:167], v[80:83]
 buffer_load_dwordx4 v12, s[8:11], s30 offen offset:2048 lds
 v_mfma_f32_16x16x32_bf16 v[84:87], a[80:83], v[164:167], v[84:87]
 v_exp_f32 v47, v47
 v_mfma_f32_16x16x32_bf16 v[88:91], a[72:75], v[168:171], v[88:91]
 ds_read_b128 v[200:203], v19 offset:4096
 v_mfma_f32_16x16x32_bf16 v[92:95], a[76:79], v[168:171], v[92:95]
 buffer_load_dwordx4 v[6:9], v31, s[52:55], s51 offen offset:2560 sc1
 v_mfma_f32_16x16x32_bf16 v[96:99], a[80:83], v[168:171], v[96:99]
 v_exp_f32 v48, v48
 v_mfma_f32_16x16x32_bf16 v[100:103], a[72:75], v[172:175], v[100:103]
 ds_read_b128 v[204:207], v19 offset:6144
 v_mfma_f32_16x16x32_bf16 v[104:107], a[76:79], v[172:175], v[104:107]
 v_exp_f32 v49, v49
 v_mfma_f32_16x16x32_bf16 v[108:111], a[80:83], v[172:175], v[108:111]
 s_waitcnt lgkmcnt(4)
 v_mfma_f32_16x16x32_bf16 v[112:115], a[72:75], v[176:179], v[112:115]
 ds_read_b128 v[208:211], v19 offset:8192
 v_mfma_f32_16x16x32_bf16 v[116:119], a[76:79], v[176:179], v[116:119]
 v_exp_f32 v50, v50
 v_mfma_f32_16x16x32_bf16 v[120:123], a[80:83], v[176:179], v[120:123]
 v_exp_f32 v51, v51
 v_mfma_f32_16x16x32_bf16 v[124:127], a[72:75], v[180:183], v[124:127]
 ds_read_b128 v[212:215], v19 offset:10240
 v_mfma_f32_16x16x32_bf16 v[128:131], a[76:79], v[180:183], v[128:131]
 buffer_load_dwordx4 v13, s[8:11], s30 offen offset:3072 lds
 v_mfma_f32_16x16x32_bf16 v[132:135], a[80:83], v[180:183], v[132:135]
 s_add_u32 s30, s30, 128
 s_add_u32 m0, m0, 16384
 v_mfma_f32_16x16x32_bf16 v[136:139], a[72:75], v[184:187], v[136:139]
 ds_read_b128 v[216:219], v19 offset:12288
 v_mfma_f32_16x16x32_bf16 v[140:143], a[76:79], v[184:187], v[140:143]
 s_cmp_lt_u32 m0, s46
 s_cselect_b32 m0, m0, s47
 v_mfma_f32_16x16x32_bf16 v[144:147], a[80:83], v[184:187], v[144:147]
 v_exp_f32 v52, v52
 v_mfma_f32_16x16x32_bf16 v[148:151], a[72:75], v[188:191], v[148:151]
 ds_read_b128 v[220:223], v19 offset:14336
 v_mfma_f32_16x16x32_bf16 v[152:155], a[76:79], v[188:191], v[152:155]
 v_exp_f32 v53, v53
 v_mfma_f32_16x16x32_bf16 v[156:159], a[80:83], v[188:191], v[156:159]
 s_waitcnt vmcnt(18) lgkmcnt(4)
 s_barrier
 v_mfma_f32_16x16x32_bf16 v[64:67], a[84:87], v[192:195], v[64:67]
 ds_read_b128 v[160:163], v18 offset:0
 v_mfma_f32_16x16x32_bf16 v[68:71], a[88:91], v[192:195], v[68:71]
 v_exp_f32 v54, v54
 v_mfma_f32_16x16x32_bf16 v[72:75], a[92:95], v[192:195], v[72:75]
 v_add_u32 v19, s33, v15
 s_add_u32 s33, s33, 16384
 v_mfma_f32_16x16x32_bf16 v[76:79], a[84:87], v[196:199], v[76:79]
 ds_read_b128 v[164:167], v18 offset:2048
 s_add_u32 s21, s50, 4096
 v_mfma_f32_16x16x32_bf16 v[80:83], a[88:91], v[196:199], v[80:83]
 buffer_load_dwordx4 v10, s[8:11], s30 offen offset:0 lds
 v_mfma_f32_16x16x32_bf16 v[84:87], a[92:95], v[196:199], v[84:87]
 s_cmp_lt_u32 s33, 98304
 s_cselect_b32 s33, s33, 0
 v_mfma_f32_16x16x32_bf16 v[88:91], a[84:87], v[200:203], v[88:91]
 ds_read_b128 v[168:171], v18 offset:4096
 v_mfma_f32_16x16x32_bf16 v[92:95], a[88:91], v[200:203], v[92:95]
 buffer_load_dwordx4 v[60:63], v30, s[16:19], s21 offen offset:2048 sc1
 v_mfma_f32_16x16x32_bf16 v[96:99], a[92:95], v[200:203], v[96:99]
 v_exp_f32 v55, v55
 v_mfma_f32_16x16x32_bf16 v[100:103], a[84:87], v[204:207], v[100:103]
 ds_read_b128 v[172:175], v18 offset:6144
 s_nop 0
 v_mfma_f32_16x16x32_bf16 v[104:107], a[88:91], v[204:207], v[104:107]
 v_add_f32 v56, v52, v53
 v_add_f32 v56, v56, v54
 v_mfma_f32_16x16x32_bf16 v[108:111], a[92:95], v[204:207], v[108:111]
 s_waitcnt lgkmcnt(4)
 v_add_f32 v56, v56, v55
 v_mfma_f32_16x16x32_bf16 v[112:115], a[84:87], v[208:211], v[112:115]
 ds_read_b128 v[176:179], v18 offset:8192
 v_cndmask_b32 v56, 0, v56, s[60:61]
 v_mfma_f32_16x16x32_bf16 v[116:119], a[88:91], v[208:211], v[116:119]
 v_add_f32 v56, v56, v44
 v_add_f32 v56, v56, v45
 v_mfma_f32_16x16x32_bf16 v[120:123], a[92:95], v[208:211], v[120:123]
 v_add_f32 v56, v56, v46
 v_add_f32 v56, v56, v47
 v_mfma_f32_16x16x32_bf16 v[124:127], a[84:87], v[212:215], v[124:127]
 ds_read_b128 v[180:183], v18 offset:10240
 v_add_f32 v56, v56, v48
 v_mfma_f32_16x16x32_bf16 v[128:131], a[88:91], v[212:215], v[128:131]
 buffer_load_dwordx4 v11, s[8:11], s30 offen offset:1024 lds
 v_mfma_f32_16x16x32_bf16 v[132:135], a[92:95], v[212:215], v[132:135]
 v_add_f32 v56, v56, v49
 v_add_f32 v56, v56, v50
 v_mfma_f32_16x16x32_bf16 v[136:139], a[84:87], v[216:219], v[136:139]
 ds_read_b128 v[184:187], v18 offset:12288
 v_add_f32 v56, v56, v51
 v_mfma_f32_16x16x32_bf16 v[140:143], a[88:91], v[216:219], v[140:143]
 v_mov_b32 v57, v56
 v_mfma_f32_16x16x32_bf16 v[144:147], a[92:95], v[216:219], v[144:147]
 s_nop 1
 v_mfma_f32_16x16x32_bf16 v[148:151], a[84:87], v[220:223], v[148:151]
 ds_read_b128 v[188:191], v18 offset:14336
 v_mfma_f32_16x16x32_bf16 v[152:155], a[88:91], v[220:223], v[152:155]
 v_permlane32_swap_b32 v56, v57
 v_mfma_f32_16x16x32_bf16 v[156:159], a[92:95], v[220:223], v[156:159]
 s_waitcnt lgkmcnt(4)
 v_add_f32 v56, v56, v57
 v_mfma_f32_16x16x32_bf16 v[64:67], a[96:99], v[160:163], v[64:67]
 ds_read_b128 v[192:195], v19 offset:0
 v_mov_b32 v57, v56
 v_mfma_f32_16x16x32_bf16 v[68:71], a[100:103], v[160:163], v[68:71]
 v_add_u32 v18, s33, v14
 v_mfma_f32_16x16x32_bf16 v[72:75], a[104:107], v[160:163], v[72:75]
 s_nop 1
 v_mfma_f32_16x16x32_bf16 v[76:79], a[96:99], v[164:167], v[76:79]
 ds_read_b128 v[196:199], v19 offset:2048
 s_add_u32 s21, s50, 8192
 v_mfma_f32_16x16x32_bf16 v[80:83], a[100:103], v[164:167], v[80:83]
 buffer_load_dwordx4 v12, s[8:11], s30 offen offset:2048 lds
 v_mfma_f32_16x16x32_bf16 v[84:87], a[104:107], v[164:167], v[84:87]
 buffer_load_dwordx4 v[248:251], v30, s[16:19], s21 offen offset:2048 sc1
 v_mfma_f32_16x16x32_bf16 v[88:91], a[96:99], v[168:171], v[88:91]
 ds_read_b128 v[200:203], v19 offset:4096
 v_mfma_f32_16x16x32_bf16 v[92:95], a[100:103], v[168:171], v[92:95]
 v_permlane16_swap_b32 v56, v57
 v_mfma_f32_16x16x32_bf16 v[96:99], a[104:107], v[168:171], v[96:99]
 v_add_f32 v56, v56, v57
 v_mfma_f32_16x16x32_bf16 v[100:103], a[96:99], v[172:175], v[100:103]
 ds_read_b128 v[204:207], v19 offset:6144
 v_mfma_f32_16x16x32_bf16 v[104:107], a[100:103], v[172:175], v[104:107]
 v_rcp_f32 v56, v56
 v_mfma_f32_16x16x32_bf16 v[108:111], a[104:107], v[172:175], v[108:111]
 s_waitcnt lgkmcnt(4)
 s_nop 0
 v_mfma_f32_16x16x32_bf16 v[112:115], a[96:99], v[176:179], v[112:115]
 ds_read_b128 v[208:211], v19 offset:8192
 v_mul_f32 v44, v44, v56
 v_mfma_f32_16x16x32_bf16 v[116:119], a[100:103], v[176:179], v[116:119]
 v_mul_f32 v45, v45, v56
 v_mul_f32 v46, v46, v56
 v_mfma_f32_16x16x32_bf16 v[120:123], a[104:107], v[176:179], v[120:123]
 v_mul_f32 v47, v47, v56
 v_mul_f32 v48, v48, v56
 v_mfma_f32_16x16x32_bf16 v[124:127], a[96:99], v[180:183], v[124:127]
 ds_read_b128 v[212:215], v19 offset:10240
 v_mul_f32 v49, v49, v56
 v_mfma_f32_16x16x32_bf16 v[128:131], a[100:103], v[180:183], v[128:131]
 buffer_load_dwordx4 v13, s[8:11], s30 offen offset:3072 lds
 v_mfma_f32_16x16x32_bf16 v[132:135], a[104:107], v[180:183], v[132:135]
 s_add_u32 s30, s30, 128
 s_add_u32 m0, m0, 16384
 v_mfma_f32_16x16x32_bf16 v[136:139], a[96:99], v[184:187], v[136:139]
 ds_read_b128 v[216:219], v19 offset:12288
 v_mul_f32 v50, v50, v56
 v_mfma_f32_16x16x32_bf16 v[140:143], a[100:103], v[184:187], v[140:143]
 s_cmp_lt_u32 m0, s46
 s_cselect_b32 m0, m0, s47
 v_mfma_f32_16x16x32_bf16 v[144:147], a[104:107], v[184:187], v[144:147]
 v_mul_f32 v51, v51, v56
 v_mul_f32 v52, v52, v56
 v_mfma_f32_16x16x32_bf16 v[148:151], a[96:99], v[188:191], v[148:151]
 ds_read_b128 v[220:223], v19 offset:14336
 v_mul_f32 v53, v53, v56
 v_mfma_f32_16x16x32_bf16 v[152:155], a[100:103], v[188:191], v[152:155]
 v_mul_f32 v54, v54, v56
 v_mul_f32 v55, v55, v56
 v_mfma_f32_16x16x32_bf16 v[156:159], a[104:107], v[188:191], v[156:159]
 s_waitcnt vmcnt(19) lgkmcnt(4)
 s_barrier
 v_mfma_f32_16x16x32_bf16 v[64:67], a[108:111], v[192:195], v[64:67]
 ds_read_b128 v[160:163], v18 offset:0
 v_cvt_pk_bf16_f32 v240, v40, v41
 v_mfma_f32_16x16x32_bf16 v[68:71], a[112:115], v[192:195], v[68:71]
 s_add_u32 s21, s50, 8192
 v_cvt_pk_bf16_f32 v241, v42, v43
 v_mfma_f32_16x16x32_bf16 v[72:75], a[116:119], v[192:195], v[72:75]
 v_add_u32 v19, s33, v15
 s_add_u32 s33, s33, 16384
 v_mfma_f32_16x16x32_bf16 v[76:79], a[108:111], v[196:199], v[76:79]
 ds_read_b128 v[164:167], v18 offset:2048
 v_cvt_pk_bf16_f32 v242, v52, v53
 v_mfma_f32_16x16x32_bf16 v[80:83], a[112:115], v[196:199], v[80:83]
 buffer_load_dwordx4 v10, s[8:11], s30 offen offset:0 lds
 v_mfma_f32_16x16x32_bf16 v[84:87], a[116:119], v[196:199], v[84:87]
 s_cmp_lt_u32 s33, 98304
 s_cselect_b32 s33, s33, 0
 v_mfma_f32_16x16x32_bf16 v[88:91], a[108:111], v[200:203], v[88:91]
 ds_read_b128 v[168:171], v18 offset:4096
 v_cvt_pk_bf16_f32 v243, v54, v55
 v_mfma_f32_16x16x32_bf16 v[92:95], a[112:115], v[200:203], v[92:95]
 buffer_load_dwordx4 v[252:255], v30, s[16:19], s21 offen offset:3072 sc1
 v_mfma_f32_16x16x32_bf16 v[96:99], a[116:119], v[200:203], v[96:99]
 v_cvt_pk_bf16_f32 v236, v44, v45
 v_cvt_pk_bf16_f32 v237, v46, v47
 v_mfma_f32_16x16x32_bf16 v[100:103], a[108:111], v[204:207], v[100:103]
 ds_read_b128 v[172:175], v18 offset:6144
 v_cvt_pk_bf16_f32 v238, v48, v49
 v_mfma_f32_16x16x32_bf16 v[104:107], a[112:115], v[204:207], v[104:107]
 v_cvt_pk_bf16_f32 v239, v50, v51
 v_cvt_pk_bf16_f32 v244, v36, v37
 v_mfma_f32_16x16x32_bf16 v[108:111], a[116:119], v[204:207], v[108:111]
 s_waitcnt lgkmcnt(4)
 v_cvt_pk_bf16_f32 v245, v38, v39
 v_mfma_f32_16x16x32_bf16 v[112:115], a[108:111], v[208:211], v[112:115]
 ds_read_b128 v[176:179], v18 offset:8192
 v_mfma_f32_16x16x32_bf16 v[116:119], a[112:115], v[208:211], v[116:119]
 v_permlane16_swap_b32 v240, v242
 v_mfma_f32_16x16x32_bf16 v[120:123], a[116:119], v[208:211], v[120:123]
 v_permlane16_swap_b32 v241, v243
 v_mfma_f32_16x16x32_bf16 v[124:127], a[108:111], v[212:215], v[124:127]
 ds_read_b128 v[180:183], v18 offset:10240
 v_mfma_f32_16x16x32_bf16 v[128:131], a[112:115], v[212:215], v[128:131]
 buffer_load_dwordx4 v11, s[8:11], s30 offen offset:1024 lds
 v_mfma_f32_16x16x32_bf16 v[132:135], a[116:119], v[212:215], v[132:135]
 v_mfma_f32_16x16x32_bf16 v[136:139], a[108:111], v[216:219], v[136:139]
 ds_read_b128 v[184:187], v18 offset:12288
 v_mfma_f32_16x16x32_bf16 v[140:143], a[112:115], v[216:219], v[140:143]
 v_mfma_f32_16x16x32_bf16 v[144:147], a[116:119], v[216:219], v[144:147]
 v_mfma_f32_16x16x32_bf16 v[148:151], a[108:111], v[220:223], v[148:151]
 ds_read_b128 v[188:191], v18 offset:14336
 v_mfma_f32_16x16x32_bf16 v[152:155], a[112:115], v[220:223], v[152:155]
 v_mfma_f32_16x16x32_bf16 v[156:159], a[116:119], v[220:223], v[156:159]
 s_waitcnt lgkmcnt(4)
 v_mfma_f32_16x16x32_bf16 v[64:67], a[120:123], v[160:163], v[64:67]
 ds_read_b128 v[192:195], v19 offset:0
 v_mfma_f32_16x16x32_bf16 v[68:71], a[124:127], v[160:163], v[68:71]
 v_add_u32 v18, s33, v14
 v_mfma_f32_16x16x32_bf16 v[72:75], a[128:131], v[160:163], v[72:75]
 v_mfma_f32_16x16x32_bf16 v[76:79], a[120:123], v[164:167], v[76:79]
 ds_read_b128 v[196:199], v19 offset:2048
 v_mfma_f32_16x16x32_bf16 v[80:83], a[124:127], v[164:167], v[80:83]
 buffer_load_dwordx4 v12, s[8:11], s30 offen offset:2048 lds
 v_mfma_f32_16x16x32_bf16 v[84:87], a[128:131], v[164:167], v[84:87]
 v_mfma_f32_16x16x32_bf16 v[88:91], a[120:123], v[168:171], v[88:91]
 ds_read_b128 v[200:203], v19 offset:4096
 v_mfma_f32_16x16x32_bf16 v[92:95], a[124:127], v[168:171], v[92:95]
 v_mfma_f32_16x16x32_bf16 v[96:99], a[128:131], v[168:171], v[96:99]
 v_mfma_f32_16x16x32_bf16 v[100:103], a[120:123], v[172:175], v[100:103]
 ds_read_b128 v[204:207], v19 offset:6144
 v_mfma_f32_16x16x32_bf16 v[104:107], a[124:127], v[172:175], v[104:107]
 v_mfma_f32_16x16x32_bf16 v[108:111], a[128:131], v[172:175], v[108:111]
 s_waitcnt lgkmcnt(4)
 v_mfma_f32_16x16x32_bf16 v[112:115], a[120:123], v[176:179], v[112:115]
 ds_read_b128 v[208:211], v19 offset:8192
 v_mfma_f32_16x16x32_bf16 v[116:119], a[124:127], v[176:179], v[116:119]
 v_mfma_f32_16x16x32_bf16 v[120:123], a[128:131], v[176:179], v[120:123]
 v_mfma_f32_16x16x32_bf16 v[124:127], a[120:123], v[180:183], v[124:127]
 ds_read_b128 v[212:215], v19 offset:10240
 v_mfma_f32_16x16x32_bf16 v[128:131], a[124:127], v[180:183], v[128:131]
 buffer_load_dwordx4 v13, s[8:11], s30 offen offset:3072 lds
 v_mfma_f32_16x16x32_bf16 v[132:135], a[128:131], v[180:183], v[132:135]
 s_add_u32 s30, s30, s25
 s_sub_u32 s30, s30, 1152
 v_mfma_f32_16x16x32_bf16 v[136:139], a[120:123], v[184:187], v[136:139]
 ds_read_b128 v[216:219], v19 offset:12288
 s_mov_b32 s25, 163840
 v_mfma_f32_16x16x32_bf16 v[140:143], a[124:127], v[184:187], v[140:143]
 s_add_u32 m0, m0, 16384
 v_mfma_f32_16x16x32_bf16 v[144:147], a[128:131], v[184:187], v[144:147]
 s_cmp_lt_u32 m0, s46
 s_cselect_b32 m0, m0, s47
 v_mfma_f32_16x16x32_bf16 v[148:151], a[120:123], v[188:191], v[148:151]
 ds_read_b128 v[220:223], v19 offset:14336
 v_mfma_f32_16x16x32_bf16 v[152:155], a[124:127], v[188:191], v[152:155]
 v_mfma_f32_16x16x32_bf16 v[156:159], a[128:131], v[188:191], v[156:159]
 s_waitcnt vmcnt(17) lgkmcnt(4)
 s_barrier
 v_mfma_f32_16x16x32_bf16 v[64:67], a[132:135], v[192:195], v[64:67]
 ds_read_b128 v[160:163], v18 offset:0
 v_mfma_f32_16x16x32_bf16 v[68:71], a[136:139], v[192:195], v[68:71]
 v_mfma_f32_16x16x32_bf16 v[72:75], a[140:143], v[192:195], v[72:75]
 v_add_u32 v19, s33, v15
 s_add_u32 s33, s33, 16384
 v_mfma_f32_16x16x32_bf16 v[76:79], a[132:135], v[196:199], v[76:79]
 ds_read_b128 v[164:167], v18 offset:2048
 v_mfma_f32_16x16x32_bf16 v[80:83], a[136:139], v[196:199], v[80:83]
 buffer_load_dwordx4 v10, s[8:11], s30 offen offset:0 lds
 v_mfma_f32_16x16x32_bf16 v[84:87], a[140:143], v[196:199], v[84:87]
 s_cmp_lt_u32 s33, 98304
 s_cselect_b32 s33, s33, 0
 v_mfma_f32_16x16x32_bf16 v[88:91], a[132:135], v[200:203], v[88:91]
 ds_read_b128 v[168:171], v18 offset:4096
 v_mfma_f32_16x16x32_bf16 v[92:95], a[136:139], v[200:203], v[92:95]
 buffer_store_dwordx4 v[236:239], v30, s[56:59], s81 offen sc1
 v_mfma_f32_16x16x32_bf16 v[96:99], a[140:143], v[200:203], v[96:99]
 v_mfma_f32_16x16x32_bf16 v[100:103], a[132:135], v[204:207], v[100:103]
 ds_read_b128 v[172:175], v18 offset:6144
 v_mfma_f32_16x16x32_bf16 v[104:107], a[136:139], v[204:207], v[104:107]
 v_mfma_f32_16x16x32_bf16 v[108:111], a[140:143], v[204:207], v[108:111]
 s_waitcnt lgkmcnt(4)
 v_mfma_f32_16x16x32_bf16 v[112:115], a[132:135], v[208:211], v[112:115]
 ds_read_b128 v[176:179], v18 offset:8192
 v_mfma_f32_16x16x32_bf16 v[116:119], a[136:139], v[208:211], v[116:119]
 s_mov_b64 exec, 0xffffffff
 buffer_store_dwordx4 v[240:243], v30, s[56:59], s81 offen offset:1024 sc1
 s_mov_b64 exec, -1
 v_mfma_f32_16x16x32_bf16 v[120:123], a[140:143], v[208:211], v[120:123]
 v_mfma_f32_16x16x32_bf16 v[124:127], a[132:135], v[212:215], v[124:127]
 ds_read_b128 v[180:183], v18 offset:10240
 v_mfma_f32_16x16x32_bf16 v[128:131], a[136:139], v[212:215], v[128:131]
 buffer_load_dwordx4 v11, s[8:11], s30 offen offset:1024 lds
 v_mfma_f32_16x16x32_bf16 v[132:135], a[140:143], v[212:215], v[132:135]
 v_mfma_f32_16x16x32_bf16 v[136:139], a[132:135], v[216:219], v[136:139]
 ds_read_b128 v[184:187], v18 offset:12288
 v_mfma_f32_16x16x32_bf16 v[140:143], a[136:139], v[216:219], v[140:143]
 buffer_store_dwordx2 v[244:245], v32, s[56:59], s81 offen offset:1536 sc1
 v_mfma_f32_16x16x32_bf16 v[144:147], a[140:143], v[216:219], v[144:147]
 s_mov_b32 s78, s82
 s_mov_b32 s82, 0
 v_mfma_f32_16x16x32_bf16 v[148:151], a[132:135], v[220:223], v[148:151]
 ds_read_b128 v[188:191], v18 offset:14336
 s_mov_b32 s81, 0x80000000
 v_mfma_f32_16x16x32_bf16 v[152:155], a[136:139], v[220:223], v[152:155]
 v_mfma_f32_16x16x32_bf16 v[156:159], a[140:143], v[220:223], v[156:159]
 s_waitcnt lgkmcnt(4)
 s_add_u32 s21, s50, 0
 v_mfma_f32_16x16x32_bf16 v[64:67], a[144:147], v[160:163], v[64:67]
 ds_read_b128 v[192:195], v19 offset:0
 v_mfma_f32_16x16x32_bf16 v[68:71], a[148:151], v[160:163], v[68:71]
 v_add_u32 v18, s33, v14
 v_mfma_f32_16x16x32_bf16 v[72:75], a[152:155], v[160:163], v[72:75]
 buffer_load_dwordx4 v[36:39], v30, s[16:19], s21 offen offset:0 sc1
 v_mfma_f32_16x16x32_bf16 v[76:79], a[144:147], v[164:167], v[76:79]
 ds_read_b128 v[196:199], v19 offset:2048
 v_mfma_f32_16x16x32_bf16 v[80:83], a[148:151], v[164:167], v[80:83]
 buffer_load_dwordx4 v12, s[8:11], s30 offen offset:2048 lds
 v_mfma_f32_16x16x32_bf16 v[84:87], a[152:155], v[164:167], v[84:87]
 v_mfma_f32_16x16x32_bf16 v[88:91], a[144:147], v[168:171], v[88:91]
 ds_read_b128 v[200:203], v19 offset:4096
 v_mfma_f32_16x16x32_bf16 v[92:95], a[148:151], v[168:171], v[92:95]
 v_mfma_f32_16x16x32_bf16 v[96:99], a[152:155], v[168:171], v[96:99]
 v_mfma_f32_16x16x32_bf16 v[100:103], a[144:147], v[172:175], v[100:103]
 ds_read_b128 v[204:207], v19 offset:6144
 v_mfma_f32_16x16x32_bf16 v[104:107], a[148:151], v[172:175], v[104:107]
 v_mfma_f32_16x16x32_bf16 v[108:111], a[152:155], v[172:175], v[108:111]
 s_waitcnt lgkmcnt(4)
 v_mfma_f32_16x16x32_bf16 v[112:115], a[144:147], v[176:179], v[112:115]
 ds_read_b128 v[208:211], v19 offset:8192
 s_add_u32 s21, s50, 0
 v_mfma_f32_16x16x32_bf16 v[116:119], a[148:151], v[176:179], v[116:119]
 buffer_load_dwordx4 v[40:43], v30, s[16:19], s21 offen offset:1024 sc1
 v_mfma_f32_16x16x32_bf16 v[120:123], a[152:155], v[176:179], v[120:123]
 v_mfma_f32_16x16x32_bf16 v[124:127], a[144:147], v[180:183], v[124:127]
 ds_read_b128 v[212:215], v19 offset:10240
 v_mfma_f32_16x16x32_bf16 v[128:131], a[148:151], v[180:183], v[128:131]
 buffer_load_dwordx4 v13, s[8:11], s30 offen offset:3072 lds
 v_mfma_f32_16x16x32_bf16 v[132:135], a[152:155], v[180:183], v[132:135]
 s_add_u32 s30, s30, 128
 s_add_u32 m0, m0, 16384
 v_mfma_f32_16x16x32_bf16 v[136:139], a[144:147], v[184:187], v[136:139]
 ds_read_b128 v[216:219], v19 offset:12288
 v_mfma_f32_16x16x32_bf16 v[140:143], a[148:151], v[184:187], v[140:143]
 s_cmp_lt_u32 m0, s46
 s_cselect_b32 m0, m0, s47
 v_mfma_f32_16x16x32_bf16 v[144:147], a[152:155], v[184:187], v[144:147]
 v_mfma_f32_16x16x32_bf16 v[148:151], a[144:147], v[188:191], v[148:151]
 ds_read_b128 v[220:223], v19 offset:14336
 v_mfma_f32_16x16x32_bf16 v[152:155], a[148:151], v[188:191], v[152:155]
 v_mfma_f32_16x16x32_bf16 v[156:159], a[152:155], v[188:191], v[156:159]
 s_waitcnt vmcnt(20) lgkmcnt(4)
 s_barrier
 v_mfma_f32_16x16x32_bf16 v[64:67], a[156:159], v[192:195], v[64:67]
 ds_read_b128 v[160:163], v18 offset:0
 s_add_u32 s21, s50, 0
 v_mfma_f32_16x16x32_bf16 v[68:71], a[160:163], v[192:195], v[68:71]
 buffer_load_dwordx4 v[44:47], v30, s[16:19], s21 offen offset:2048 sc1
 v_mfma_f32_16x16x32_bf16 v[72:75], a[164:167], v[192:195], v[72:75]
 v_add_u32 v19, s33, v15
 s_add_u32 s33, s33, 16384
 v_mfma_f32_16x16x32_bf16 v[76:79], a[156:159], v[196:199], v[76:79]
 ds_read_b128 v[164:167], v18 offset:2048
 v_mfma_f32_16x16x32_bf16 v[80:83], a[160:163], v[196:199], v[80:83]
 buffer_load_dwordx4 v10, s[8:11], s30 offen offset:0 lds
 v_mfma_f32_16x16x32_bf16 v[84:87], a[164:167], v[196:199], v[84:87]
 s_cmp_lt_u32 s33, 98304
 s_cselect_b32 s33, s33, 0
 v_mfma_f32_16x16x32_bf16 v[88:91], a[156:159], v[200:203], v[88:91]
 ds_read_b128 v[168:171], v18 offset:4096
 v_mfma_f32_16x16x32_bf16 v[92:95], a[160:163], v[200:203], v[92:95]
 v_mfma_f32_16x16x32_bf16 v[96:99], a[164:167], v[200:203], v[96:99]
 v_mfma_f32_16x16x32_bf16 v[100:103], a[156:159], v[204:207], v[100:103]
 ds_read_b128 v[172:175], v18 offset:6144
 v_mfma_f32_16x16x32_bf16 v[104:107], a[160:163], v[204:207], v[104:107]
 v_mfma_f32_16x16x32_bf16 v[108:111], a[164:167], v[204:207], v[108:111]
 s_waitcnt lgkmcnt(4)
 s_add_u32 s21, s50, 0
 v_mfma_f32_16x16x32_bf16 v[112:115], a[156:159], v[208:211], v[112:115]
 ds_read_b128 v[176:179], v18 offset:8192
 v_mfma_f32_16x16x32_bf16 v[116:119], a[160:163], v[208:211], v[116:119]
 buffer_load_dwordx4 v[48:51], v30, s[16:19], s21 offen offset:3072 sc1
 v_mfma_f32_16x16x32_bf16 v[120:123], a[164:167], v[208:211], v[120:123]
 v_mfma_f32_16x16x32_bf16 v[124:127], a[156:159], v[212:215], v[124:127]
 ds_read_b128 v[180:183], v18 offset:10240
 v_mfma_f32_16x16x32_bf16 v[128:131], a[160:163], v[212:215], v[128:131]
 buffer_load_dwordx4 v11, s[8:11], s30 offen offset:1024 lds
 v_mfma_f32_16x16x32_bf16 v[132:135], a[164:167], v[212:215], v[132:135]
 v_mfma_f32_16x16x32_bf16 v[136:139], a[156:159], v[216:219], v[136:139]
 ds_read_b128 v[184:187], v18 offset:12288
 v_mfma_f32_16x16x32_bf16 v[140:143], a[160:163], v[216:219], v[140:143]
 v_mfma_f32_16x16x32_bf16 v[144:147], a[164:167], v[216:219], v[144:147]
 v_mfma_f32_16x16x32_bf16 v[148:151], a[156:159], v[220:223], v[148:151]
 ds_read_b128 v[188:191], v18 offset:14336
 v_mfma_f32_16x16x32_bf16 v[152:155], a[160:163], v[220:223], v[152:155]
 v_mfma_f32_16x16x32_bf16 v[156:159], a[164:167], v[220:223], v[156:159]
 s_waitcnt lgkmcnt(4)
 s_add_u32 s21, s50, 4096
 v_mfma_f32_16x16x32_bf16 v[64:67], a[168:171], v[160:163], v[64:67]
 ds_read_b128 v[192:195], v19 offset:0
 v_mfma_f32_16x16x32_bf16 v[68:71], a[172:175], v[160:163], v[68:71]
 v_add_u32 v18, s33, v14
 v_mfma_f32_16x16x32_bf16 v[72:75], a[176:179], v[160:163], v[72:75]
 buffer_load_dwordx4 v[52:55], v30, s[16:19], s21 offen offset:0 sc1
 v_mfma_f32_16x16x32_bf16 v[76:79], a[168:171], v[164:167], v[76:79]
 ds_read_b128 v[196:199], v19 offset:2048
 v_mfma_f32_16x16x32_bf16 v[80:83], a[172:175], v[164:167], v[80:83]
 buffer_load_dwordx4 v12, s[8:11], s30 offen offset:2048 lds
 v_mfma_f32_16x16x32_bf16 v[84:87], a[176:179], v[164:167], v[84:87]
 v_mfma_f32_16x16x32_bf16 v[88:91], a[168:171], v[168:171], v[88:91]
 ds_read_b128 v[200:203], v19 offset:4096
 v_mfma_f32_16x16x32_bf16 v[92:95], a[172:175], v[168:171], v[92:95]
 v_mfma_f32_16x16x32_bf16 v[96:99], a[176:179], v[168:171], v[96:99]
 v_mfma_f32_16x16x32_bf16 v[100:103], a[168:171], v[172:175], v[100:103]
 ds_read_b128 v[204:207], v19 offset:6144
 v_mfma_f32_16x16x32_bf16 v[104:107], a[172:175], v[172:175], v[104:107]
 v_mfma_f32_16x16x32_bf16 v[108:111], a[176:179], v[172:175], v[108:111]
 s_waitcnt lgkmcnt(4)
 v_mfma_f32_16x16x32_bf16 v[112:115], a[168:171], v[176:179], v[112:115]
 ds_read_b128 v[208:211], v19 offset:8192
 s_add_u32 s21, s50, 4096
 v_mfma_f32_16x16x32_bf16 v[116:119], a[172:175], v[176:179], v[116:119]
 buffer_load_dwordx4 v[56:59], v30, s[16:19], s21 offen offset:1024 sc1
 v_mfma_f32_16x16x32_bf16 v[120:123], a[176:179], v[176:179], v[120:123]
 v_mfma_f32_16x16x32_bf16 v[124:127], a[168:171], v[180:183], v[124:127]
 ds_read_b128 v[212:215], v19 offset:10240
 v_mfma_f32_16x16x32_bf16 v[128:131], a[172:175], v[180:183], v[128:131]
 buffer_load_dwordx4 v13, s[8:11], s30 offen offset:3072 lds
 v_mfma_f32_16x16x32_bf16 v[132:135], a[176:179], v[180:183], v[132:135]
 s_add_u32 s30, s30, 128
 s_add_u32 m0, m0, 16384
 v_mfma_f32_16x16x32_bf16 v[136:139], a[168:171], v[184:187], v[136:139]
 ds_read_b128 v[216:219], v19 offset:12288
 v_mfma_f32_16x16x32_bf16 v[140:143], a[172:175], v[184:187], v[140:143]
 s_cmp_lt_u32 m0, s46
 s_cselect_b32 m0, m0, s47
 v_mfma_f32_16x16x32_bf16 v[144:147], a[176:179], v[184:187], v[144:147]
 v_mfma_f32_16x16x32_bf16 v[148:151], a[168:171], v[188:191], v[148:151]
 ds_read_b128 v[220:223], v19 offset:14336
 v_mfma_f32_16x16x32_bf16 v[152:155], a[172:175], v[188:191], v[152:155]
 v_mfma_f32_16x16x32_bf16 v[156:159], a[176:179], v[188:191], v[156:159]
 s_waitcnt vmcnt(22) lgkmcnt(4)
 s_barrier
 v_mfma_f32_16x16x32_bf16 v[64:67], a[180:183], v[192:195], v[64:67]
 ds_read_b128 v[160:163], v18 offset:0
 s_add_u32 s21, s50, 4096
 v_mfma_f32_16x16x32_bf16 v[68:71], a[184:187], v[192:195], v[68:71]
 buffer_load_dwordx4 v[236:239], v30, s[16:19], s21 offen offset:3072 sc1
 s_waitcnt vmcnt(13)
 s_cmp_eq_u32 s78, 0
 s_cbranch_scc1 pf_203
 v_mov_b32 v4, 0
 v_mov_b32 v5, 1
 s_mov_b64 exec, 1
 buffer_atomic_add v5, v4, s[72:75], s78 offen sc1
 s_mov_b64 exec, -1
 s_mov_b32 s78, 0
pf_203:
 v_mfma_f32_16x16x32_bf16 v[72:75], a[188:191], v[192:195], v[72:75]
 v_add_u32 v19, s33, v15
 s_add_u32 s33, s33, 16384
 v_mfma_f32_16x16x32_bf16 v[76:79], a[180:183], v[196:199], v[76:79]
 ds_read_b128 v[164:167], v18 offset:2048
 v_mfma_f32_16x16x32_bf16 v[80:83], a[184:187], v[196:199], v[80:83]
 buffer_load_dwordx4 v10, s[8:11], s30 offen offset:0 lds
 v_mfma_f32_16x16x32_bf16 v[84:87], a[188:191], v[196:199], v[84:87]
 s_cmp_lt_u32 s33, 98304
 s_cselect_b32 s33, s33, 0
 v_mfma_f32_16x16x32_bf16 v[88:91], a[180:183], v[200:203], v[88:91]
 ds_read_b128 v[168:171], v18 offset:4096
 v_mfma_f32_16x16x32_bf16 v[92:95], a[184:187], v[200:203], v[92:95]
 v_mfma_f32_16x16x32_bf16 v[96:99], a[188:191], v[200:203], v[96:99]
 v_mfma_f32_16x16x32_bf16 v[100:103], a[180:183], v[204:207], v[100:103]
 ds_read_b128 v[172:175], v18 offset:6144
 v_mfma_f32_16x16x32_bf16 v[104:107], a[184:187], v[204:207], v[104:107]
 v_mfma_f32_16x16x32_bf16 v[108:111], a[188:191], v[204:207], v[108:111]
 s_waitcnt lgkmcnt(4)
 s_add_u32 s21, s50, 8192
 v_mfma_f32_16x16x32_bf16 v[112:115], a[180:183], v[208:211], v[112:115]
 ds_read_b128 v[176:179], v18 offset:8192
 v_mfma_f32_16x16x32_bf16 v[116:119], a[184:187], v[208:211], v[116:119]
 buffer_load_dwordx4 v[240:243], v30, s[16:19], s21 offen offset:0 sc1
 v_mfma_f32_16x16x32_bf16 v[120:123], a[188:191], v[208:211], v[120:123]
 v_mfma_f32_16x16x32_bf16 v[124:127], a[180:183], v[212:215], v[124:127]
 ds_read_b128 v[180:183], v18 offset:10240
 v_mfma_f32_16x16x32_bf16 v[128:131], a[184:187], v[212:215], v[128:131]
 buffer_load_dwordx4 v11, s[8:11], s30 offen offset:1024 lds
 v_mfma_f32_16x16x32_bf16 v[132:135], a[188:191], v[212:215], v[132:135]
 v_mfma_f32_16x16x32_bf16 v[136:139], a[180:183], v[216:219], v[136:139]
 ds_read_b128 v[184:187], v18 offset:12288
 v_mfma_f32_16x16x32_bf16 v[140:143], a[184:187], v[216:219], v[140:143]
 v_mfma_f32_16x16x32_bf16 v[144:147], a[188:191], v[216:219], v[144:147]
 v_mfma_f32_16x16x32_bf16 v[148:151], a[180:183], v[220:223], v[148:151]
 ds_read_b128 v[188:191], v18 offset:14336
 v_mfma_f32_16x16x32_bf16 v[152:155], a[184:187], v[220:223], v[152:155]
 v_mfma_f32_16x16x32_bf16 v[156:159], a[188:191], v[220:223], v[156:159]
 s_waitcnt lgkmcnt(4)
 s_add_u32 s21, s50, 8192
 v_mfma_f32_16x16x32_bf16 v[64:67], a[192:195], v[160:163], v[64:67]
 ds_read_b128 v[192:195], v19 offset:0
 v_mfma_f32_16x16x32_bf16 v[68:71], a[196:199], v[160:163], v[68:71]
 v_add_u32 v18, s33, v14
 v_mfma_f32_16x16x32_bf16 v[72:75], a[200:203], v[160:163], v[72:75]
 buffer_load_dwordx4 v[244:247], v30, s[16:19], s21 offen offset:1024 sc1
 v_mfma_f32_16x16x32_bf16 v[76:79], a[192:195], v[164:167], v[76:79]
 ds_read_b128 v[196:199], v19 offset:2048
 v_mfma_f32_16x16x32_bf16 v[80:83], a[196:199], v[164:167], v[80:83]
 buffer_load_dwordx4 v12, s[8:11], s30 offen offset:2048 lds
 v_mfma_f32_16x16x32_bf16 v[84:87], a[200:203], v[164:167], v[84:87]
 v_mfma_f32_16x16x32_bf16 v[88:91], a[192:195], v[168:171], v[88:91]
 ds_read_b128 v[200:203], v19 offset:4096
 v_mfma_f32_16x16x32_bf16 v[92:95], a[196:199], v[168:171], v[92:95]
 v_mfma_f32_16x16x32_bf16 v[96:99], a[200:203], v[168:171], v[96:99]
 v_mfma_f32_16x16x32_bf16 v[100:103], a[192:195], v[172:175], v[100:103]
 ds_read_b128 v[204:207], v19 offset:6144
 v_mfma_f32_16x16x32_bf16 v[104:107], a[196:199], v[172:175], v[104:107]
 v_mfma_f32_16x16x32_bf16 v[108:111], a[200:203], v[172:175], v[108:111]
 s_waitcnt lgkmcnt(4)
 v_mfma_f32_16x16x32_bf16 v[112:115], a[192:195], v[176:179], v[112:115]
 ds_read_b128 v[208:211], v19 offset:8192
 v_mfma_f32_16x16x32_bf16 v[116:119], a[196:199], v[176:179], v[116:119]
 v_mfma_f32_16x16x32_bf16 v[120:123], a[200:203], v[176:179], v[120:123]
 v_mfma_f32_16x16x32_bf16 v[124:127], a[192:195], v[180:183], v[124:127]
 ds_read_b128 v[212:215], v19 offset:10240
 v_mfma_f32_16x16x32_bf16 v[128:131], a[196:199], v[180:183], v[128:131]
 buffer_load_dwordx4 v13, s[8:11], s30 offen offset:3072 lds
 v_mfma_f32_16x16x32_bf16 v[132:135], a[200:203], v[180:183], v[132:135]
 s_add_u32 s30, s30, 128
 s_add_u32 m0, m0, 16384
 v_mfma_f32_16x16x32_bf16 v[136:139], a[192:195], v[184:187], v[136:139]
 ds_read_b128 v[216:219], v19 offset:12288
 v_mfma_f32_16x16x32_bf16 v[140:143], a[196:199], v[184:187], v[140:143]
 s_cmp_lt_u32 m0, s46
 s_cselect_b32 m0, m0, s47
 v_mfma_f32_16x16x32_bf16 v[144:147], a[200:203], v[184:187], v[144:147]
 v_mfma_f32_16x16x32_bf16 v[148:151], a[192:195], v[188:191], v[148:151]
 ds_read_b128 v[220:223], v19 offset:14336
 v_mfma_f32_16x16x32_bf16 v[152:155], a[196:199], v[188:191], v[152:155]
 v_mfma_f32_16x16x32_bf16 v[156:159], a[200:203], v[188:191], v[156:159]
 s_waitcnt vmcnt(24) lgkmcnt(4)
 s_barrier
 v_mfma_f32_16x16x32_bf16 v[64:67], a[204:207], v[192:195], v[64:67]
 ds_read_b128 v[160:163], v18 offset:0
 v_mfma_f32_16x16x32_bf16 v[68:71], a[208:211], v[192:195], v[68:71]
 v_mfma_f32_16x16x32_bf16 v[72:75], a[212:215], v[192:195], v[72:75]
 v_add_u32 v19, s33, v15
 s_add_u32 s33, s33, 16384
 v_mfma_f32_16x16x32_bf16 v[76:79], a[204:207], v[196:199], v[76:79]
 ds_read_b128 v[164:167], v18 offset:2048
 v_mfma_f32_16x16x32_bf16 v[80:83], a[208:211], v[196:199], v[80:83]
 buffer_load_dwordx4 v10, s[8:11], s30 offen offset:0 lds
 v_mfma_f32_16x16x32_bf16 v[84:87], a[212:215], v[196:199], v[84:87]
 s_cmp_lt_u32 s33, 98304
 s_cselect_b32 s33, s33, 0
 v_mfma_f32_16x16x32_bf16 v[88:91], a[204:207], v[200:203], v[88:91]
 ds_read_b128 v[168:171], v18 offset:4096
 v_mfma_f32_16x16x32_bf16 v[92:95], a[208:211], v[200:203], v[92:95]
 v_mfma_f32_16x16x32_bf16 v[96:99], a[212:215], v[200:203], v[96:99]
 v_mfma_f32_16x16x32_bf16 v[100:103], a[204:207], v[204:207], v[100:103]
 ds_read_b128 v[172:175], v18 offset:6144
 v_mfma_f32_16x16x32_bf16 v[104:107], a[208:211], v[204:207], v[104:107]
 v_mfma_f32_16x16x32_bf16 v[108:111], a[212:215], v[204:207], v[108:111]
 s_waitcnt lgkmcnt(4)
 v_mfma_f32_16x16x32_bf16 v[112:115], a[204:207], v[208:211], v[112:115]
 ds_read_b128 v[176:179], v18 offset:8192
 v_mfma_f32_16x16x32_bf16 v[116:119], a[208:211], v[208:211], v[116:119]
 v_mfma_f32_16x16x32_bf16 v[120:123], a[212:215], v[208:211], v[120:123]
 v_mfma_f32_16x16x32_bf16 v[124:127], a[204:207], v[212:215], v[124:127]
 ds_read_b128 v[180:183], v18 offset:10240
 v_mfma_f32_16x16x32_bf16 v[128:131], a[208:211], v[212:215], v[128:131]
 buffer_load_dwordx4 v11, s[8:11], s30 offen offset:1024 lds
 v_mfma_f32_16x16x32_bf16 v[132:135], a[212:215], v[212:215], v[132:135]
 v_mfma_f32_16x16x32_bf16 v[136:139], a[204:207], v[216:219], v[136:139]
 ds_read_b128 v[184:187], v18 offset:12288
 v_mfma_f32_16x16x32_bf16 v[140:143], a[208:211], v[216:219], v[140:143]
 v_mfma_f32_16x16x32_bf16 v[144:147], a[212:215], v[216:219], v[144:147]
 v_mfma_f32_16x16x32_bf16 v[148:151], a[204:207], v[220:223], v[148:151]
 ds_read_b128 v[188:191], v18 offset:14336
 v_mfma_f32_16x16x32_bf16 v[152:155], a[208:211], v[220:223], v[152:155]
 v_mfma_f32_16x16x32_bf16 v[156:159], a[212:215], v[220:223], v[156:159]
 s_waitcnt lgkmcnt(4)
 v_mfma_f32_16x16x32_bf16 v[64:67], a[216:219], v[160:163], v[64:67]
 ds_read_b128 v[192:195], v19 offset:0
 v_mfma_f32_16x16x32_bf16 v[68:71], a[220:223], v[160:163], v[68:71]
 v_add_u32 v18, s33, v14
 v_mfma_f32_16x16x32_bf16 v[72:75], a[224:227], v[160:163], v[72:75]
 v_mfma_f32_16x16x32_bf16 v[76:79], a[216:219], v[164:167], v[76:79]
 ds_read_b128 v[196:199], v19 offset:2048
 v_mfma_f32_16x16x32_bf16 v[80:83], a[220:223], v[164:167], v[80:83]
 buffer_load_dwordx4 v12, s[8:11], s30 offen offset:2048 lds
 v_mfma_f32_16x16x32_bf16 v[84:87], a[224:227], v[164:167], v[84:87]
 v_mfma_f32_16x16x32_bf16 v[88:91], a[216:219], v[168:171], v[88:91]
 ds_read_b128 v[200:203], v19 offset:4096
 v_mfma_f32_16x16x32_bf16 v[92:95], a[220:223], v[168:171], v[92:95]
 v_mfma_f32_16x16x32_bf16 v[96:99], a[224:227], v[168:171], v[96:99]
 v_mfma_f32_16x16x32_bf16 v[100:103], a[216:219], v[172:175], v[100:103]
 ds_read_b128 v[204:207], v19 offset:6144
 v_mfma_f32_16x16x32_bf16 v[104:107], a[220:223], v[172:175], v[104:107]
 v_mfma_f32_16x16x32_bf16 v[108:111], a[224:227], v[172:175], v[108:111]
 s_waitcnt lgkmcnt(4)
 v_mfma_f32_16x16x32_bf16 v[112:115], a[216:219], v[176:179], v[112:115]
 ds_read_b128 v[208:211], v19 offset:8192
 v_mfma_f32_16x16x32_bf16 v[116:119], a[220:223], v[176:179], v[116:119]
 v_mfma_f32_16x16x32_bf16 v[120:123], a[224:227], v[176:179], v[120:123]
 v_mfma_f32_16x16x32_bf16 v[124:127], a[216:219], v[180:183], v[124:127]
 ds_read_b128 v[212:215], v19 offset:10240
 v_mfma_f32_16x16x32_bf16 v[128:131], a[220:223], v[180:183], v[128:131]
 buffer_load_dwordx4 v13, s[8:11], s30 offen offset:3072 lds
 v_mfma_f32_16x16x32_bf16 v[132:135], a[224:227], v[180:183], v[132:135]
 s_add_u32 s30, s30, 128
 s_add_u32 m0, m0, 16384
 v_mfma_f32_16x16x32_bf16 v[136:139], a[216:219], v[184:187], v[136:139]
 ds_read_b128 v[216:219], v19 offset:12288
 v_mfma_f32_16x16x32_bf16 v[140:143], a[220:223], v[184:187], v[140:143]
 s_cmp_lt_u32 m0, s46
 s_cselect_b32 m0, m0, s47
 v_mfma_f32_16x16x32_bf16 v[144:147], a[224:227], v[184:187], v[144:147]
 v_mfma_f32_16x16x32_bf16 v[148:151], a[216:219], v[188:191], v[148:151]
 ds_read_b128 v[220:223], v19 offset:14336
 v_mfma_f32_16x16x32_bf16 v[152:155], a[220:223], v[188:191], v[152:155]
 v_mfma_f32_16x16x32_bf16 v[156:159], a[224:227], v[188:191], v[156:159]
 s_waitcnt vmcnt(19) lgkmcnt(4)
 s_barrier
 v_mfma_f32_16x16x32_bf16 v[64:67], a[228:231], v[192:195], v[64:67]
 ds_read_b128 v[160:163], v18 offset:0
 v_mfma_f32_16x16x32_bf16 v[68:71], a[232:235], v[192:195], v[68:71]
 buffer_load_dword v21, v33, s[72:75], s77 offen sc1
 v_mfma_f32_16x16x32_bf16 v[72:75], a[236:239], v[192:195], v[72:75]
 v_add_u32 v19, s33, v15
 s_add_u32 s33, s33, 16384
 v_mfma_f32_16x16x32_bf16 v[76:79], a[228:231], v[196:199], v[76:79]
 ds_read_b128 v[164:167], v18 offset:2048
 v_cvt_pk_bf16_f32 v224, v64, v65
 v_cvt_pk_bf16_f32 v225, v66, v67
 v_mfma_f32_16x16x32_bf16 v[80:83], a[232:235], v[196:199], v[80:83]
 buffer_load_dwordx4 v10, s[8:11], s30 offen offset:0 lds
 v_cvt_pk_bf16_f32 v226, v68, v69
 v_cvt_pk_bf16_f32 v227, v70, v71
 v_mfma_f32_16x16x32_bf16 v[84:87], a[236:239], v[196:199], v[84:87]
 s_cmp_lt_u32 s33, 98304
 s_cselect_b32 s33, s33, 0
 v_cvt_pk_bf16_f32 v228, v72, v73
 v_cvt_pk_bf16_f32 v229, v74, v75
 v_mfma_f32_16x16x32_bf16 v[88:91], a[228:231], v[200:203], v[88:91]
 ds_read_b128 v[168:171], v18 offset:4096
 ds_write_b64 v22, v[224:225] offset:0
 v_mfma_f32_16x16x32_bf16 v[92:95], a[232:235], v[200:203], v[92:95]
 ds_write_b64 v22, v[226:227] offset:8
 ds_write_b64 v16, v[228:229] offset:64
 v_mfma_f32_16x16x32_bf16 v[96:99], a[236:239], v[200:203], v[96:99]
 v_cvt_pk_bf16_f32 v230, v76, v77
 v_cvt_pk_bf16_f32 v231, v78, v79
 v_cvt_pk_bf16_f32 v232, v80, v81
 v_cvt_pk_bf16_f32 v233, v82, v83
 v_mfma_f32_16x16x32_bf16 v[100:103], a[228:231], v[204:207], v[100:103]
 ds_read_b128 v[172:175], v18 offset:6144
 v_cvt_pk_bf16_f32 v234, v84, v85
 v_cvt_pk_bf16_f32 v235, v86, v87
 v_mfma_f32_16x16x32_bf16 v[104:107], a[232:235], v[204:207], v[104:107]
 ds_write_b64 v22, v[230:231] offset:6400
 ds_write_b64 v22, v[232:233] offset:6408
 v_mfma_f32_16x16x32_bf16 v[108:111], a[236:239], v[204:207], v[108:111]
 s_waitcnt lgkmcnt(9)
 ds_write_b64 v16, v[234:235] offset:6464
 v_cvt_pk_bf16_f32 v224, v88, v89
 v_mfma_f32_16x16x32_bf16 v[112:115], a[228:231], v[208:211], v[112:115]
 ds_read_b128 v[176:179], v18 offset:8192
 v_cvt_pk_bf16_f32 v225, v90, v91
 v_cvt_pk_bf16_f32 v226, v92, v93
 v_cvt_pk_bf16_f32 v227, v94, v95
 v_mfma_f32_16x16x32_bf16 v[116:119], a[232:235], v[208:211], v[116:119]
 v_cvt_pk_bf16_f32 v228, v96, v97
 v_cvt_pk_bf16_f32 v229, v98, v99
 ds_write_b64 v22, v[224:225] offset:12800
 v_mfma_f32_16x16x32_bf16 v[120:123], a[236:239], v[208:211], v[120:123]
 ds_write_b64 v22, v[226:227] offset:12808
 ds_write_b64 v16, v[228:229] offset:12864
 v_mfma_f32_16x16x32_bf16 v[124:127], a[228:231], v[212:215], v[124:127]
 ds_read_b128 v[180:183], v18 offset:10240
 v_cvt_pk_bf16_f32 v230, v100, v101
 v_cvt_pk_bf16_f32 v231, v102, v103
 v_cvt_pk_bf16_f32 v232, v104, v105
 v_mfma_f32_16x16x32_bf16 v[128:131], a[232:235], v[212:215], v[128:131]
 buffer_load_dwordx4 v11, s[8:11], s30 offen offset:1024 lds
 v_cvt_pk_bf16_f32 v233, v106, v107
 v_cvt_pk_bf16_f32 v234, v108, v109
 v_mfma_f32_16x16x32_bf16 v[132:135], a[236:239], v[212:215], v[132:135]
 v_cvt_pk_bf16_f32 v235, v110, v111
 ds_write_b64 v22, v[230:231] offset:19200
 v_mfma_f32_16x16x32_bf16 v[136:139], a[228:231], v[216:219], v[136:139]
 ds_read_b128 v[184:187], v18 offset:12288
 ds_write_b64 v22, v[232:233] offset:19208
 v_mfma_f32_16x16x32_bf16 v[140:143], a[232:235], v[216:219], v[140:143]
 ds_write_b64 v16, v[234:235] offset:19264
 v_cvt_pk_bf16_f32 v224, v112, v113
 v_cvt_pk_bf16_f32 v225, v114, v115
 v_mfma_f32_16x16x32_bf16 v[144:147], a[236:239], v[216:219], v[144:147]
 v_cvt_pk_bf16_f32 v226, v116, v117
 v_cvt_pk_bf16_f32 v227, v118, v119
 v_cvt_pk_bf16_f32 v228, v120, v121
 v_cvt_pk_bf16_f32 v229, v122, v123
 v_mfma_f32_16x16x32_bf16 v[148:151], a[228:231], v[220:223], v[148:151]
 ds_read_b128 v[188:191], v18 offset:14336
 ds_write_b64 v22, v[224:225] offset:25600
 v_mfma_f32_16x16x32_bf16 v[152:155], a[232:235], v[220:223], v[152:155]
 ds_write_b64 v22, v[226:227] offset:25608
 ds_write_b64 v16, v[228:229] offset:25664
 v_mfma_f32_16x16x32_bf16 v[156:159], a[236:239], v[220:223], v[156:159]
 v_cvt_pk_bf16_f32 v230, v124, v125
 v_cvt_pk_bf16_f32 v231, v126, v127
 v_cvt_pk_bf16_f32 v232, v128, v129
 v_cvt_pk_bf16_f32 v233, v130, v131
qa_end_205:
 v_cvt_pk_bf16_f32 v234, v132, v133
 v_cvt_pk_bf16_f32 v235, v134, v135
 ds_write_b64 v22, v[230:231] offset:32000
 ds_write_b64 v22, v[232:233] offset:32008
 ds_write_b64 v16, v[234:235] offset:32064
 v_cvt_pk_bf16_f32 v224, v136, v137
 v_cvt_pk_bf16_f32 v225, v138, v139
 v_cvt_pk_bf16_f32 v226, v140, v141
 v_cvt_pk_bf16_f32 v227, v142, v143
 v_cvt_pk_bf16_f32 v228, v144, v145
 v_cvt_pk_bf16_f32 v229, v146, v147
 ds_write_b64 v22, v[224:225] offset:38400
 ds_write_b64 v22, v[226:227] offset:38408
 ds_write_b64 v16, v[228:229] offset:38464
 v_cvt_pk_bf16_f32 v230, v148, v149
 v_cvt_pk_bf16_f32 v231, v150, v151
 v_cvt_pk_bf16_f32 v232, v152, v153
 v_cvt_pk_bf16_f32 v233, v154, v155
 v_cvt_pk_bf16_f32 v234, v156, v157
 v_cvt_pk_bf16_f32 v235, v158, v159
 ds_write_b64 v22, v[230:231] offset:44800
 ds_write_b64 v22, v[232:233] offset:44808
 ds_write_b64 v16, v[234:235] offset:44864
 s_cmp_lg_u32 s26, s40
 s_cbranch_scc1 qbs_208
 s_waitcnt lgkmcnt(0)
 s_barrier
 ds_read_b128 v[64:67], v29 offset:0
 ds_read_b128 v[68:71], v29 offset:64
 ds_read_b128 v[72:75], v29 offset:128
 ds_read_b128 v[76:79], v29 offset:192
 ds_read_b128 v[80:83], v29 offset:256
 ds_read_b128 v[84:87], v29 offset:320
 ds_read_b128 v[88:91], v29 offset:6400
 ds_read_b128 v[92:95], v29 offset:6464
 ds_read_b128 v[96:99], v29 offset:6528
 ds_read_b128 v[100:103], v29 offset:6592
 ds_read_b128 v[104:107], v29 offset:6656
 ds_read_b128 v[108:111], v29 offset:6720
 s_waitcnt lgkmcnt(0)
 s_add_u32 s21, s43, 0
 buffer_store_dwordx4 v[64:67], v30, s[12:15], s21 offen offset:0 sc1
 buffer_store_dwordx4 v[68:71], v30, s[12:15], s21 offen offset:1024 sc1
 buffer_store_dwordx4 v[72:75], v30, s[12:15], s21 offen offset:2048 sc1
 buffer_store_dwordx4 v[76:79], v30, s[12:15], s21 offen offset:3072 sc1
 s_add_u32 s21, s43, 4096
 buffer_store_dwordx4 v[80:83], v30, s[12:15], s21 offen offset:0 sc1
 buffer_store_dwordx4 v[84:87], v30, s[12:15], s21 offen offset:1024 sc1
 buffer_store_dwordx4 v[88:91], v30, s[12:15], s21 offen offset:2048 sc1
 buffer_store_dwordx4 v[92:95], v30, s[12:15], s21 offen offset:3072 sc1
 s_add_u32 s21, s43, 8192
 buffer_store_dwordx4 v[96:99], v30, s[12:15], s21 offen offset:0 sc1
 buffer_store_dwordx4 v[100:103], v30, s[12:15], s21 offen offset:1024 sc1
 buffer_store_dwordx4 v[104:107], v30, s[12:15], s21 offen offset:2048 sc1
 buffer_store_dwordx4 v[108:111], v30, s[12:15], s21 offen offset:3072 sc1
 s_branch qbe_206
qbs_208:
 s_cmp_eq_u32 s80, 1
 s_cselect_b32 s21, s79, 0
 s_cmp_ge_u32 s21, 8
 s_cbranch_scc0 qx_209
 s_waitcnt lgkmcnt(0) vmcnt(5)
 s_barrier
 ds_read_b128 v[64:67], v29 offset:0
 ds_read_b128 v[88:91], v29 offset:6400
 ds_read_b128 v[68:71], v29 offset:64
 ds_read_b128 v[92:95], v29 offset:6464
 ds_read_b128 v[72:75], v29 offset:128
 ds_read_b128 v[96:99], v29 offset:6528
 ds_read_b128 v[76:79], v29 offset:192
 ds_read_b128 v[100:103], v29 offset:6592
 ds_read_b128 v[80:83], v29 offset:256
 ds_read_b128 v[104:107], v29 offset:6656
 ds_read_b128 v[84:87], v29 offset:320
 ds_read_b128 v[108:111], v29 offset:6720
 s_waitcnt lgkmcnt(10)
 v_mfma_f32_16x16x32_bf16 v[112:115], v[36:39], v[64:67], 0
 v_mfma_f32_16x16x32_bf16 v[116:119], a[240:243], v[64:67], 0
 v_mfma_f32_16x16x32_bf16 v[120:123], v[36:39], v[88:91], 0
 v_mfma_f32_16x16x32_bf16 v[124:127], v[60:63], v[88:91], 0
 v_mfma_f32_16x16x32_bf16 v[128:131], a[240:243], v[88:91], 0
 s_waitcnt lgkmcnt(8)
 v_mfma_f32_16x16x32_bf16 v[112:115], v[40:43], v[68:71], v[112:115]
 v_mfma_f32_16x16x32_bf16 v[116:119], a[244:247], v[68:71], v[116:119]
 v_mfma_f32_16x16x32_bf16 v[120:123], v[40:43], v[92:95], v[120:123]
 v_mfma_f32_16x16x32_bf16 v[124:127], v[236:239], v[92:95], v[124:127]
 v_mfma_f32_16x16x32_bf16 v[128:131], a[244:247], v[92:95], v[128:131]
 s_waitcnt lgkmcnt(6)
 v_mfma_f32_16x16x32_bf16 v[112:115], v[44:47], v[72:75], v[112:115]
 v_mfma_f32_16x16x32_bf16 v[116:119], a[248:251], v[72:75], v[116:119]
 v_mfma_f32_16x16x32_bf16 v[120:123], v[44:47], v[96:99], v[120:123]
 v_mfma_f32_16x16x32_bf16 v[124:127], v[240:243], v[96:99], v[124:127]
 v_mfma_f32_16x16x32_bf16 v[128:131], a[248:251], v[96:99], v[128:131]
 s_waitcnt lgkmcnt(4)
 v_mfma_f32_16x16x32_bf16 v[112:115], v[48:51], v[76:79], v[112:115]
 v_mfma_f32_16x16x32_bf16 v[116:119], a[252:255], v[76:79], v[116:119]
 v_mfma_f32_16x16x32_bf16 v[120:123], v[48:51], v[100:103], v[120:123]
 v_mfma_f32_16x16x32_bf16 v[124:127], v[244:247], v[100:103], v[124:127]
 v_mfma_f32_16x16x32_bf16 v[128:131], a[252:255], v[100:103], v[128:131]
 s_waitcnt lgkmcnt(2)
 v_mfma_f32_16x16x32_bf16 v[112:115], v[52:55], v[80:83], v[112:115]
 v_mfma_f32_16x16x32_bf16 v[116:119], v[24:27], v[80:83], v[116:119]
 v_mfma_f32_16x16x32_bf16 v[120:123], v[52:55], v[104:107], v[120:123]
 v_mfma_f32_16x16x32_bf16 v[124:127], v[248:251], v[104:107], v[124:127]
 v_mfma_f32_16x16x32_bf16 v[128:131], v[24:27], v[104:107], v[128:131]
 s_waitcnt lgkmcnt(0)
 v_mfma_f32_16x16x32_bf16 v[112:115], v[56:59], v[84:87], v[112:115]
 v_mfma_f32_16x16x32_bf16 v[116:119], v[6:9], v[84:87], v[116:119]
 v_mfma_f32_16x16x32_bf16 v[120:123], v[56:59], v[108:111], v[120:123]
 v_mfma_f32_16x16x32_bf16 v[124:127], v[252:255], v[108:111], v[124:127]
 v_mfma_f32_16x16x32_bf16 v[128:131], v[6:9], v[108:111], v[128:131]
 s_branch qx_207
qx_209:
 buffer_load_dword v21, v33, s[72:75], s77 offen sc1
 s_waitcnt vmcnt(0)
 s_mul_i32 s21, s49, 393216
 s_mul_i32 s22, s42, 12288
 s_add_u32 s50, s21, s22
 s_lshr_b32 s21, s49, 1
 s_bitcmp1_b32 s37, s21
 s_cselect_b32 s21, 8192, 0
 s_lshl_b32 s51, s49, 20
 s_or_b32 s51, s51, s21
 s_xor_b32 s51, s51, 8192
 s_add_u32 s51, s51, s36
 s_lshr_b32 s22, s49, 1
 s_lshr_b32 s21, s49, 2
 s_add_u32 s21, s21, 3
 s_cmp_lt_u32 s49, 12
 s_cselect_b32 s21, s22, s21
 s_lshl_b32 s21, s21, 3
 s_lshr_b32 s22, s42, 2
 s_add_u32 s21, s21, s22
 s_lshl_b32 s21, s21, 7
 s_add_u32 s76, s21, 0
 s_lshl_b32 s77, s42, 7
 s_add_u32 s77, s77, 19456
 s_add_u32 s23, s49, 1
 s_waitcnt vmcnt(6)
 v_cmp_gt_u32 vcc, s23, v21
 s_mov_b32 s80, 0
 s_nop 0
 s_cbranch_vccnz qk_211
 s_mov_b32 s80, 1
 buffer_load_dwordx4 v[132:135], v31, s[52:55], s51 offen offset:0 sc1
 buffer_load_dwordx4 v[136:139], v31, s[52:55], s51 offen offset:512 sc1
 buffer_load_dwordx4 v[140:143], v31, s[52:55], s51 offen offset:1024 sc1
 buffer_load_dwordx4 v[144:147], v31, s[52:55], s51 offen offset:1536 sc1
 buffer_load_dwordx4 v[148:151], v31, s[52:55], s51 offen offset:2048 sc1
 buffer_load_dwordx4 v[152:155], v31, s[52:55], s51 offen offset:2560 sc1
qk_211:
 s_cmp_ge_u32 s79, 8
 s_cbranch_scc1 qk_210
 v_mov_b32 v156, 0
 s_mov_b32 s101, 0
wf_212:
 buffer_load_dword v157, v156, s[72:75], s76 offen sc1
 s_add_u32 s101, s101, 1
 s_cmp_gt_u32 s101, 131072
 s_cbranch_scc1 main_end
 s_waitcnt vmcnt(0)
 v_readfirstlane_b32 s100, v157
 s_cmp_ge_u32 s100, 8
 s_cbranch_scc1 wf_213
 s_sleep 2
 s_branch wf_212
wf_213:
 s_add_u32 s21, s50, 0
 buffer_load_dwordx4 v[36:39], v30, s[16:19], s21 offen offset:0 sc1
 buffer_load_dwordx4 v[40:43], v30, s[16:19], s21 offen offset:1024 sc1
 buffer_load_dwordx4 v[44:47], v30, s[16:19], s21 offen offset:2048 sc1
 buffer_load_dwordx4 v[48:51], v30, s[16:19], s21 offen offset:3072 sc1
 s_add_u32 s21, s50, 4096
 buffer_load_dwordx4 v[52:55], v30, s[16:19], s21 offen offset:0 sc1
 buffer_load_dwordx4 v[56:59], v30, s[16:19], s21 offen offset:1024 sc1
 buffer_load_dwordx4 v[60:63], v30, s[16:19], s21 offen offset:2048 sc1
 buffer_load_dwordx4 v[236:239], v30, s[16:19], s21 offen offset:3072 sc1
 s_add_u32 s21, s50, 8192
 buffer_load_dwordx4 v[240:243], v30, s[16:19], s21 offen offset:0 sc1
 buffer_load_dwordx4 v[244:247], v30, s[16:19], s21 offen offset:1024 sc1
 buffer_load_dwordx4 v[248:251], v30, s[16:19], s21 offen offset:2048 sc1
 buffer_load_dwordx4 v[252:255], v30, s[16:19], s21 offen offset:3072 sc1
qk_210:
 s_waitcnt lgkmcnt(0)
 s_barrier
 ds_read_b128 v[64:67], v29 offset:0
 ds_read_b128 v[68:71], v29 offset:64
 ds_read_b128 v[72:75], v29 offset:128
 ds_read_b128 v[76:79], v29 offset:192
 ds_read_b128 v[80:83], v29 offset:256
 ds_read_b128 v[84:87], v29 offset:320
 ds_read_b128 v[88:91], v29 offset:6400
 ds_read_b128 v[92:95], v29 offset:6464
 ds_read_b128 v[96:99], v29 offset:6528
 ds_read_b128 v[100:103], v29 offset:6592
 ds_read_b128 v[104:107], v29 offset:6656
 ds_read_b128 v[108:111], v29 offset:6720
 s_waitcnt lgkmcnt(0)
 s_cmp_eq_u32 s80, 1
 s_cselect_b32 s21, s79, 0
 s_cmp_ge_u32 s21, 8
 s_cbranch_scc1 qw_214
 s_waitcnt vmcnt(0)
qw_214:
 v_mfma_f32_16x16x32_bf16 v[112:115], v[36:39], v[64:67], 0
 v_mfma_f32_16x16x32_bf16 v[120:123], v[36:39], v[88:91], 0
 v_mfma_f32_16x16x32_bf16 v[124:127], v[60:63], v[88:91], 0
 v_mfma_f32_16x16x32_bf16 v[112:115], v[40:43], v[68:71], v[112:115]
 v_mfma_f32_16x16x32_bf16 v[120:123], v[40:43], v[92:95], v[120:123]
 v_mfma_f32_16x16x32_bf16 v[124:127], v[236:239], v[92:95], v[124:127]
 v_mfma_f32_16x16x32_bf16 v[112:115], v[44:47], v[72:75], v[112:115]
 v_mfma_f32_16x16x32_bf16 v[120:123], v[44:47], v[96:99], v[120:123]
 v_mfma_f32_16x16x32_bf16 v[124:127], v[240:243], v[96:99], v[124:127]
 v_mfma_f32_16x16x32_bf16 v[112:115], v[48:51], v[76:79], v[112:115]
 v_mfma_f32_16x16x32_bf16 v[120:123], v[48:51], v[100:103], v[120:123]
 v_mfma_f32_16x16x32_bf16 v[124:127], v[244:247], v[100:103], v[124:127]
 v_mfma_f32_16x16x32_bf16 v[112:115], v[52:55], v[80:83], v[112:115]
 v_mfma_f32_16x16x32_bf16 v[120:123], v[52:55], v[104:107], v[120:123]
 v_mfma_f32_16x16x32_bf16 v[124:127], v[248:251], v[104:107], v[124:127]
 v_mfma_f32_16x16x32_bf16 v[112:115], v[56:59], v[84:87], v[112:115]
 v_mfma_f32_16x16x32_bf16 v[120:123], v[56:59], v[108:111], v[120:123]
 v_mfma_f32_16x16x32_bf16 v[124:127], v[252:255], v[108:111], v[124:127]
 s_cmp_eq_u32 s80, 1
 s_cbranch_scc1 qm_215
 s_add_u32 s23, s49, 1
 s_min_u32 s22, s49, 61
 s_cmp_lt_u32 s49, 56
 s_cselect_b32 s23, s23, s22
 s_mov_b32 s101, 0
wm_216:
 buffer_load_dword v156, v33, s[72:75], s77 offen sc1
 s_add_u32 s101, s101, 1
 s_cmp_gt_u32 s101, 131072
 s_cbranch_scc1 main_end
 s_waitcnt vmcnt(0)
 v_cmp_gt_u32 vcc, s23, v156
 v_readfirstlane_b32 s100, v156
 s_nop 0
 s_cbranch_vccz wm_217
 s_sleep 16
 s_add_u32 s100, s100, 2
 s_cmp_ge_u32 s100, s23
 s_cbranch_scc1 wm_216
 s_sleep 90
 s_branch wm_216
wm_217:
 s_cmp_eq_u32 s49, 63
 s_cselect_b32 s21, s101, 0
 s_cmp_lt_u32 s21, 2
 s_cbranch_scc1 qtz_220
 s_sleep 36
qtz_220:
 s_mov_b32 s101, 0
 s_branch qtp_219
qtp_218:
 s_sleep 3
qtp_219:
 buffer_load_dwordx4 v[132:135], v31, s[52:55], s51 offen offset:0 sc1
 buffer_load_dwordx4 v[136:139], v31, s[52:55], s51 offen offset:512 sc1
 buffer_load_dwordx4 v[140:143], v31, s[52:55], s51 offen offset:1024 sc1
 buffer_load_dwordx4 v[144:147], v31, s[52:55], s51 offen offset:1536 sc1
 buffer_load_dwordx4 v[148:151], v31, s[52:55], s51 offen offset:2048 sc1
 buffer_load_dwordx4 v[152:155], v31, s[52:55], s51 offen offset:2560 sc1
 s_add_u32 s101, s101, 1
 s_cmp_gt_u32 s101, 131072
 s_cbranch_scc1 main_end
 s_waitcnt vmcnt(0)
 v_max3_u32 v156, v132, v134, v136
 v_max3_u32 v156, v156, v138, v140
 v_max3_u32 v156, v156, v142, v144
 v_max3_u32 v156, v156, v146, v148
 v_max3_u32 v156, v156, v150, v152
 v_max3_u32 v156, v156, v154, v154
 v_cmp_eq_u32 vcc, -1, v156
 s_nop 1
 s_cbranch_vccnz qtp_218
qm_215:
 s_waitcnt vmcnt(0)
 v_mfma_f32_16x16x32_bf16 v[116:119], v[132:135], v[64:67], 0
 v_mfma_f32_16x16x32_bf16 v[128:131], v[132:135], v[88:91], 0
 v_mfma_f32_16x16x32_bf16 v[116:119], v[136:139], v[68:71], v[116:119]
 v_mfma_f32_16x16x32_bf16 v[128:131], v[136:139], v[92:95], v[128:131]
 v_mfma_f32_16x16x32_bf16 v[116:119], v[140:143], v[72:75], v[116:119]
 v_mfma_f32_16x16x32_bf16 v[128:131], v[140:143], v[96:99], v[128:131]
 v_mfma_f32_16x16x32_bf16 v[116:119], v[144:147], v[76:79], v[116:119]
 v_mfma_f32_16x16x32_bf16 v[128:131], v[144:147], v[100:103], v[128:131]
 v_mfma_f32_16x16x32_bf16 v[116:119], v[148:151], v[80:83], v[116:119]
 v_mfma_f32_16x16x32_bf16 v[128:131], v[148:151], v[104:107], v[128:131]
 v_mfma_f32_16x16x32_bf16 v[116:119], v[152:155], v[84:87], v[116:119]
 v_mfma_f32_16x16x32_bf16 v[128:131], v[152:155], v[108:111], v[128:131]
qx_207:
 s_lshr_b32 s21, s49, 1
 s_bitcmp1_b32 s37, s21
 s_cselect_b32 s21, 8192, 0
 s_lshl_b32 s81, s49, 20
 s_or_b32 s81, s81, s21
 s_add_u32 s81, s81, s44
 s_lshl_b32 s82, s49, 3
 s_and_b32 s21, s42, 7
 s_add_u32 s82, s82, s21
 s_lshl_b32 s82, s82, 7
 s_add_u32 s82, s82, 23552
 s_cmp_gt_u32 s26, 1
 s_cselect_b32 s21, s80, 0
 s_cmp_eq_u32 s21, 0
 s_cbranch_scc1 qi_222
 v_mov_b32 v36, v112
 v_mov_b32 v37, v113
 v_mov_b32 v38, v114
 v_mov_b32 v39, v115
 v_mov_b32 v40, v116
 v_mov_b32 v41, v117
 v_mov_b32 v42, v118
 v_mov_b32 v43, v119
 v_mov_b32 v44, v120
 v_mov_b32 v45, v121
 v_mov_b32 v46, v122
 v_mov_b32 v47, v123
 v_mov_b32 v48, v124
 v_mov_b32 v49, v125
 v_mov_b32 v50, v126
 v_mov_b32 v51, v127
 v_mov_b32 v52, v128
 v_mov_b32 v53, v129
 v_mov_b32 v54, v130
 v_mov_b32 v55, v131
 s_branch qd_221
qi_222:
 v_cndmask_b32 v112, v34, v112, s[64:65]
 v_cndmask_b32 v124, v34, v124, s[64:65]
 v_cndmask_b32 v113, v34, v113, s[66:67]
 v_cndmask_b32 v125, v34, v125, s[66:67]
 v_cndmask_b32 v114, v34, v114, s[68:69]
 v_cndmask_b32 v126, v34, v126, s[68:69]
 v_cndmask_b32 v115, v34, v115, s[70:71]
 v_cndmask_b32 v127, v34, v127, s[70:71]
 v_max3_f32 v156, v112, v113, v114
 v_max3_f32 v156, v156, v115, v116
 v_max3_f32 v156, v156, v117, v118
 v_max_f32 v156, v156, v119
 v_mov_b32 v157, v156
 s_nop 1
 v_permlane32_swap_b32 v156, v157
 v_max_f32 v156, v156, v157
 v_mov_b32 v157, v156
 s_nop 1
 v_permlane16_swap_b32 v156, v157
 v_max_f32 v156, v156, v157
 v_mul_f32 v156, s83, v156
 v_fma_f32 v112, v112, s83, -v156
 v_fma_f32 v113, v113, s83, -v156
 v_fma_f32 v114, v114, s83, -v156
 v_fma_f32 v115, v115, s83, -v156
 v_fma_f32 v116, v116, s83, -v156
 v_fma_f32 v117, v117, s83, -v156
 v_fma_f32 v118, v118, s83, -v156
 v_fma_f32 v119, v119, s83, -v156
 v_exp_f32 v112, v112
 v_exp_f32 v113, v113
 v_exp_f32 v114, v114
 v_exp_f32 v115, v115
 v_exp_f32 v116, v116
 v_exp_f32 v117, v117
 v_exp_f32 v118, v118
 v_exp_f32 v119, v119
 s_nop 0
 v_add_f32 v156, v116, v117
 v_add_f32 v156, v156, v118
 v_add_f32 v156, v156, v119
 v_cndmask_b32 v156, 0, v156, s[60:61]
 v_add_f32 v156, v156, v112
 v_add_f32 v156, v156, v113
 v_add_f32 v156, v156, v114
 v_add_f32 v156, v156, v115
 v_mov_b32 v157, v156
 s_nop 1
 v_permlane32_swap_b32 v156, v157
 v_add_f32 v156, v156, v157
 v_mov_b32 v157, v156
 s_nop 1
 v_permlane16_swap_b32 v156, v157
 v_add_f32 v156, v156, v157
 v_rcp_f32 v156, v156
 s_nop 0
 v_mul_f32 v112, v112, v156
 v_mul_f32 v113, v113, v156
 v_mul_f32 v114, v114, v156
 v_mul_f32 v115, v115, v156
 v_mul_f32 v116, v116, v156
 v_mul_f32 v117, v117, v156
 v_mul_f32 v118, v118, v156
 v_mul_f32 v119, v119, v156
 v_max3_f32 v156, v120, v121, v122
 v_max3_f32 v156, v156, v123, v124
 v_max3_f32 v156, v156, v125, v126
 v_max3_f32 v156, v156, v127, v128
 v_max3_f32 v156, v156, v129, v130
 v_max_f32 v156, v156, v131
 v_mov_b32 v157, v156
 s_nop 1
 v_permlane32_swap_b32 v156, v157
 v_max_f32 v156, v156, v157
 v_mov_b32 v157, v156
 s_nop 1
 v_permlane16_swap_b32 v156, v157
 v_max_f32 v156, v156, v157
 v_mul_f32 v156, s83, v156
 v_fma_f32 v120, v120, s83, -v156
 v_fma_f32 v121, v121, s83, -v156
 v_fma_f32 v122, v122, s83, -v156
 v_fma_f32 v123, v123, s83, -v156
 v_fma_f32 v124, v124, s83, -v156
 v_fma_f32 v125, v125, s83, -v156
 v_fma_f32 v126, v126, s83, -v156
 v_fma_f32 v127, v127, s83, -v156
 v_fma_f32 v128, v128, s83, -v156
 v_fma_f32 v129, v129, s83, -v156
 v_fma_f32 v130, v130, s83, -v156
 v_fma_f32 v131, v131, s83, -v156
 v_exp_f32 v120, v120
 v_exp_f32 v121, v121
 v_exp_f32 v122, v122
 v_exp_f32 v123, v123
 v_exp_f32 v124, v124
 v_exp_f32 v125, v125
 v_exp_f32 v126, v126
 v_exp_f32 v127, v127
 v_exp_f32 v128, v128
 v_exp_f32 v129, v129
 v_exp_f32 v130, v130
 v_exp_f32 v131, v131
 s_nop 0
 v_add_f32 v156, v128, v129
 v_add_f32 v156, v156, v130
 v_add_f32 v156, v156, v131
 v_cndmask_b32 v156, 0, v156, s[60:61]
 v_add_f32 v156, v156, v120
 v_add_f32 v156, v156, v121
 v_add_f32 v156, v156, v122
 v_add_f32 v156, v156, v123
 v_add_f32 v156, v156, v124
 v_add_f32 v156, v156, v125
 v_add_f32 v156, v156, v126
 v_add_f32 v156, v156, v127
 v_mov_b32 v157, v156
 s_nop 1
 v_permlane32_swap_b32 v156, v157
 v_add_f32 v156, v156, v157
 v_mov_b32 v157, v156
 s_nop 1
 v_permlane16_swap_b32 v156, v157
 v_add_f32 v156, v156, v157
 v_rcp_f32 v156, v156
 s_nop 0
 v_mul_f32 v120, v120, v156
 v_mul_f32 v121, v121, v156
 v_mul_f32 v122, v122, v156
 v_mul_f32 v123, v123, v156
 v_mul_f32 v124, v124, v156
 v_mul_f32 v125, v125, v156
 v_mul_f32 v126, v126, v156
 v_mul_f32 v127, v127, v156
 v_mul_f32 v128, v128, v156
 v_mul_f32 v129, v129, v156
 v_mul_f32 v130, v130, v156
 v_mul_f32 v131, v131, v156
 v_cvt_pk_bf16_f32 v196, v116, v117
 v_cvt_pk_bf16_f32 v197, v118, v119
 v_cvt_pk_bf16_f32 v198, v128, v129
 v_cvt_pk_bf16_f32 v199, v130, v131
 v_cvt_pk_bf16_f32 v192, v120, v121
 v_cvt_pk_bf16_f32 v193, v122, v123
 v_cvt_pk_bf16_f32 v194, v124, v125
 v_cvt_pk_bf16_f32 v195, v126, v127
 v_cvt_pk_bf16_f32 v200, v112, v113
 v_cvt_pk_bf16_f32 v201, v114, v115
 v_permlane16_swap_b32 v196, v198
 v_permlane16_swap_b32 v197, v199
 buffer_store_dwordx4 v[192:195], v30, s[56:59], s81 offen sc1
 s_mov_b64 exec, 0xffffffff
 buffer_store_dwordx4 v[196:199], v30, s[56:59], s81 offen offset:1024 sc1
 s_mov_b64 exec, -1
 buffer_store_dwordx2 v[200:201], v32, s[56:59], s81 offen offset:1536 sc1
 s_mov_b32 s78, s82
 s_mov_b32 s81, 0x80000000
 s_mov_b32 s82, 0
 s_cmp_eq_u32 s80, 1
 s_cbranch_scc1 qd_221
 s_waitcnt vmcnt(0)
 s_cmp_eq_u32 s78, 0
 s_cbranch_scc1 pf_223
 v_mov_b32 v4, 0
 v_mov_b32 v5, 1
 s_mov_b64 exec, 1
 buffer_atomic_add v5, v4, s[72:75], s78 offen sc1
 s_mov_b64 exec, -1
 s_mov_b32 s78, 0
pf_223:
qd_221:
 s_add_u32 s49, s49, s29
qbe_206:
 s_sub_u32 s26, s26, 1
 s_cmp_gt_u32 s26, 0
 s_waitcnt lgkmcnt(0)
 s_cbranch_scc1 qa_blk_204
 s_waitcnt vmcnt(0) lgkmcnt(0)
 s_cmp_eq_u32 s78, 0
 s_cbranch_scc1 pf_224
 v_mov_b32 v4, 0
 v_mov_b32 v5, 1
 s_mov_b64 exec, 1
 buffer_atomic_add v5, v4, s[72:75], s78 offen sc1
 s_mov_b64 exec, -1
 s_mov_b32 s78, 0
pf_224:
 s_cmp_eq_u32 s45, 0
 s_cbranch_scc1 q_done
 s_mul_i32 s21, s49, 393216
 s_mul_i32 s22, s42, 12288
 s_add_u32 s50, s21, s22
 s_lshr_b32 s21, s49, 1
 s_bitcmp1_b32 s37, s21
 s_cselect_b32 s21, 8192, 0
 s_lshl_b32 s51, s49, 20
 s_or_b32 s51, s51, s21
 s_xor_b32 s51, s51, 8192
 s_add_u32 s51, s51, s36
 s_lshr_b32 s22, s49, 1
 s_lshr_b32 s21, s49, 2
 s_add_u32 s21, s21, 3
 s_cmp_lt_u32 s49, 12
 s_cselect_b32 s21, s22, s21
 s_lshl_b32 s21, s21, 3
 s_lshr_b32 s22, s42, 2
 s_add_u32 s21, s21, s22
 s_lshl_b32 s21, s21, 7
 s_add_u32 s76, s21, 0
 s_lshl_b32 s77, s42, 7
 s_add_u32 s77, s77, 19456
 buffer_load_dword v21, v33, s[72:75], s77 offen sc1
 s_add_u32 s21, s50, 0
 buffer_load_dwordx4 v[36:39], v30, s[16:19], s21 offen offset:0 sc1
 buffer_load_dwordx4 v[40:43], v30, s[16:19], s21 offen offset:1024 sc1
 buffer_load_dwordx4 v[44:47], v30, s[16:19], s21 offen offset:2048 sc1
 buffer_load_dwordx4 v[48:51], v30, s[16:19], s21 offen offset:3072 sc1
 s_add_u32 s21, s50, 4096
 buffer_load_dwordx4 v[52:55], v30, s[16:19], s21 offen offset:0 sc1
 buffer_load_dwordx4 v[56:59], v30, s[16:19], s21 offen offset:1024 sc1
 buffer_load_dwordx4 v[60:63], v30, s[16:19], s21 offen offset:2048 sc1
 buffer_load_dwordx4 v[236:239], v30, s[16:19], s21 offen offset:3072 sc1
 s_add_u32 s21, s50, 8192
 buffer_load_dwordx4 v[240:243], v30, s[16:19], s21 offen offset:0 sc1
 buffer_load_dwordx4 v[244:247], v30, s[16:19], s21 offen offset:1024 sc1
 buffer_load_dwordx4 v[248:251], v30, s[16:19], s21 offen offset:2048 sc1
 buffer_load_dwordx4 v[252:255], v30, s[16:19], s21 offen offset:3072 sc1
 s_add_u32 s21, s43, 0
 buffer_load_dwordx4 v[64:67], v30, s[12:15], s21 offen offset:0 sc1
 buffer_load_dwordx4 v[68:71], v30, s[12:15], s21 offen offset:1024 sc1
 buffer_load_dwordx4 v[72:75], v30, s[12:15], s21 offen offset:2048 sc1
 buffer_load_dwordx4 v[76:79], v30, s[12:15], s21 offen offset:3072 sc1
 s_add_u32 s21, s43, 4096
 buffer_load_dwordx4 v[80:83], v30, s[12:15], s21 offen offset:0 sc1
 buffer_load_dwordx4 v[84:87], v30, s[12:15], s21 offen offset:1024 sc1
 buffer_load_dwordx4 v[88:91], v30, s[12:15], s21 offen offset:2048 sc1
 buffer_load_dwordx4 v[92:95], v30, s[12:15], s21 offen offset:3072 sc1
 s_add_u32 s21, s43, 8192
 buffer_load_dwordx4 v[96:99], v30, s[12:15], s21 offen offset:0 sc1
 buffer_load_dwordx4 v[100:103], v30, s[12:15], s21 offen offset:1024 sc1
 buffer_load_dwordx4 v[104:107], v30, s[12:15], s21 offen offset:2048 sc1
 buffer_load_dwordx4 v[108:111], v30, s[12:15], s21 offen offset:3072 sc1
 s_waitcnt vmcnt(24)
 s_cmp_eq_u32 s78, 0
 s_cbranch_scc1 pf_228
 v_mov_b32 v4, 0
 v_mov_b32 v5, 1
 s_mov_b64 exec, 1
 buffer_atomic_add v5, v4, s[72:75], s78 offen sc1
 s_mov_b64 exec, -1
 s_mov_b32 s78, 0
pf_228:
 s_add_u32 s23, s49, 1
 v_cmp_gt_u32 vcc, s23, v21
 s_mov_b32 s80, 0
 s_nop 0
 s_cbranch_vccnz qk_227
 s_mov_b32 s80, 1
 buffer_load_dwordx4 v[132:135], v31, s[52:55], s51 offen offset:0 sc1
 buffer_load_dwordx4 v[136:139], v31, s[52:55], s51 offen offset:512 sc1
 buffer_load_dwordx4 v[140:143], v31, s[52:55], s51 offen offset:1024 sc1
 buffer_load_dwordx4 v[144:147], v31, s[52:55], s51 offen offset:1536 sc1
 buffer_load_dwordx4 v[148:151], v31, s[52:55], s51 offen offset:2048 sc1
 buffer_load_dwordx4 v[152:155], v31, s[52:55], s51 offen offset:2560 sc1
 s_waitcnt vmcnt(6)
 s_branch qk_227x
qk_227:
 s_waitcnt vmcnt(0)
qk_227x:
 v_mfma_f32_16x16x32_bf16 v[112:115], v[36:39], v[64:67], 0
 v_mfma_f32_16x16x32_bf16 v[120:123], v[36:39], v[88:91], 0
 v_mfma_f32_16x16x32_bf16 v[124:127], v[60:63], v[88:91], 0
 v_mfma_f32_16x16x32_bf16 v[112:115], v[40:43], v[68:71], v[112:115]
 v_mfma_f32_16x16x32_bf16 v[120:123], v[40:43], v[92:95], v[120:123]
 v_mfma_f32_16x16x32_bf16 v[124:127], v[236:239], v[92:95], v[124:127]
 v_mfma_f32_16x16x32_bf16 v[112:115], v[44:47], v[72:75], v[112:115]
 v_mfma_f32_16x16x32_bf16 v[120:123], v[44:47], v[96:99], v[120:123]
 v_mfma_f32_16x16x32_bf16 v[124:127], v[240:243], v[96:99], v[124:127]
 v_mfma_f32_16x16x32_bf16 v[112:115], v[48:51], v[76:79], v[112:115]
 v_mfma_f32_16x16x32_bf16 v[120:123], v[48:51], v[100:103], v[120:123]
 v_mfma_f32_16x16x32_bf16 v[124:127], v[244:247], v[100:103], v[124:127]
 v_mfma_f32_16x16x32_bf16 v[112:115], v[52:55], v[80:83], v[112:115]
 v_mfma_f32_16x16x32_bf16 v[120:123], v[52:55], v[104:107], v[120:123]
 v_mfma_f32_16x16x32_bf16 v[124:127], v[248:251], v[104:107], v[124:127]
 v_mfma_f32_16x16x32_bf16 v[112:115], v[56:59], v[84:87], v[112:115]
 v_mfma_f32_16x16x32_bf16 v[120:123], v[56:59], v[108:111], v[120:123]
 v_mfma_f32_16x16x32_bf16 v[124:127], v[252:255], v[108:111], v[124:127]
 s_cmp_eq_u32 s80, 1
 s_cbranch_scc1 qm_229
 s_add_u32 s23, s49, 1
 s_min_u32 s22, s49, 61
 s_cmp_lt_u32 s49, 56
 s_cselect_b32 s23, s23, s22
 s_mov_b32 s101, 0
wm_230:
 buffer_load_dword v156, v33, s[72:75], s77 offen sc1
 s_add_u32 s101, s101, 1
 s_cmp_gt_u32 s101, 131072
 s_cbranch_scc1 main_end
 s_waitcnt vmcnt(0)
 v_cmp_gt_u32 vcc, s23, v156
 v_readfirstlane_b32 s100, v156
 s_nop 0
 s_cbranch_vccz wm_231
 s_sleep 16
 s_add_u32 s100, s100, 2
 s_cmp_ge_u32 s100, s23
 s_cbranch_scc1 wm_230
 s_sleep 90
 s_branch wm_230
wm_231:
 s_cmp_eq_u32 s49, 63
 s_cselect_b32 s21, s101, 0
 s_cmp_lt_u32 s21, 2
 s_cbranch_scc1 qtz_234
 s_sleep 36
qtz_234:
 s_mov_b32 s101, 0
 s_branch qtp_233
qtp_232:
 s_sleep 3
qtp_233:
 buffer_load_dwordx4 v[132:135], v31, s[52:55], s51 offen offset:0 sc1
 buffer_load_dwordx4 v[136:139], v31, s[52:55], s51 offen offset:512 sc1
 buffer_load_dwordx4 v[140:143], v31, s[52:55], s51 offen offset:1024 sc1
 buffer_load_dwordx4 v[144:147], v31, s[52:55], s51 offen offset:1536 sc1
 buffer_load_dwordx4 v[148:151], v31, s[52:55], s51 offen offset:2048 sc1
 buffer_load_dwordx4 v[152:155], v31, s[52:55], s51 offen offset:2560 sc1
 s_add_u32 s101, s101, 1
 s_cmp_gt_u32 s101, 131072
 s_cbranch_scc1 main_end
 s_waitcnt vmcnt(0)
 v_max3_u32 v156, v132, v134, v136
 v_max3_u32 v156, v156, v138, v140
 v_max3_u32 v156, v156, v142, v144
 v_max3_u32 v156, v156, v146, v148
 v_max3_u32 v156, v156, v150, v152
 v_max3_u32 v156, v156, v154, v154
 v_cmp_eq_u32 vcc, -1, v156
 s_nop 1
 s_cbranch_vccnz qtp_232
qm_229:
 s_waitcnt vmcnt(0)
 v_mfma_f32_16x16x32_bf16 v[116:119], v[132:135], v[64:67], 0
 v_mfma_f32_16x16x32_bf16 v[128:131], v[132:135], v[88:91], 0
 v_mfma_f32_16x16x32_bf16 v[116:119], v[136:139], v[68:71], v[116:119]
 v_mfma_f32_16x16x32_bf16 v[128:131], v[136:139], v[92:95], v[128:131]
 v_mfma_f32_16x16x32_bf16 v[116:119], v[140:143], v[72:75], v[116:119]
 v_mfma_f32_16x16x32_bf16 v[128:131], v[140:143], v[96:99], v[128:131]
 v_mfma_f32_16x16x32_bf16 v[116:119], v[144:147], v[76:79], v[116:119]
 v_mfma_f32_16x16x32_bf16 v[128:131], v[144:147], v[100:103], v[128:131]
 v_mfma_f32_16x16x32_bf16 v[116:119], v[148:151], v[80:83], v[116:119]
 v_mfma_f32_16x16x32_bf16 v[128:131], v[148:151], v[104:107], v[128:131]
 v_mfma_f32_16x16x32_bf16 v[116:119], v[152:155], v[84:87], v[116:119]
 v_mfma_f32_16x16x32_bf16 v[128:131], v[152:155], v[108:111], v[128:131]
qx_226:
 s_lshr_b32 s21, s49, 1
 s_bitcmp1_b32 s37, s21
 s_cselect_b32 s21, 8192, 0
 s_lshl_b32 s81, s49, 20
 s_or_b32 s81, s81, s21
 s_add_u32 s81, s81, s44
 s_lshl_b32 s82, s49, 3
 s_and_b32 s21, s42, 7
 s_add_u32 s82, s82, s21
 s_lshl_b32 s82, s82, 7
 s_add_u32 s82, s82, 23552
 v_cndmask_b32 v112, v34, v112, s[64:65]
 v_cndmask_b32 v124, v34, v124, s[64:65]
 v_cndmask_b32 v113, v34, v113, s[66:67]
 v_cndmask_b32 v125, v34, v125, s[66:67]
 v_cndmask_b32 v114, v34, v114, s[68:69]
 v_cndmask_b32 v126, v34, v126, s[68:69]
 v_cndmask_b32 v115, v34, v115, s[70:71]
 v_cndmask_b32 v127, v34, v127, s[70:71]
 v_max3_f32 v156, v112, v113, v114
 v_max3_f32 v156, v156, v115, v116
 v_max3_f32 v156, v156, v117, v118
 v_max_f32 v156, v156, v119
 v_mov_b32 v157, v156
 s_nop 1
 v_permlane32_swap_b32 v156, v157
 v_max_f32 v156, v156, v157
 v_mov_b32 v157, v156
 s_nop 1
 v_permlane16_swap_b32 v156, v157
 v_max_f32 v156, v156, v157
 v_mul_f32 v156, s83, v156
 v_fma_f32 v112, v112, s83, -v156
 v_fma_f32 v113, v113, s83, -v156
 v_fma_f32 v114, v114, s83, -v156
 v_fma_f32 v115, v115, s83, -v156
 v_fma_f32 v116, v116, s83, -v156
 v_fma_f32 v117, v117, s83, -v156
 v_fma_f32 v118, v118, s83, -v156
 v_fma_f32 v119, v119, s83, -v156
 v_exp_f32 v112, v112
 v_exp_f32 v113, v113
 v_exp_f32 v114, v114
 v_exp_f32 v115, v115
 v_exp_f32 v116, v116
 v_exp_f32 v117, v117
 v_exp_f32 v118, v118
 v_exp_f32 v119, v119
 s_nop 0
 v_add_f32 v156, v116, v117
 v_add_f32 v156, v156, v118
 v_add_f32 v156, v156, v119
 v_cndmask_b32 v156, 0, v156, s[60:61]
 v_add_f32 v156, v156, v112
 v_add_f32 v156, v156, v113
 v_add_f32 v156, v156, v114
 v_add_f32 v156, v156, v115
 v_mov_b32 v157, v156
 s_nop 1
 v_permlane32_swap_b32 v156, v157
 v_add_f32 v156, v156, v157
 v_mov_b32 v157, v156
 s_nop 1
 v_permlane16_swap_b32 v156, v157
 v_add_f32 v156, v156, v157
 v_rcp_f32 v156, v156
 s_nop 0
 v_mul_f32 v112, v112, v156
 v_mul_f32 v113, v113, v156
 v_mul_f32 v114, v114, v156
 v_mul_f32 v115, v115, v156
 v_mul_f32 v116, v116, v156
 v_mul_f32 v117, v117, v156
 v_mul_f32 v118, v118, v156
 v_mul_f32 v119, v119, v156
 v_max3_f32 v156, v120, v121, v122
 v_max3_f32 v156, v156, v123, v124
 v_max3_f32 v156, v156, v125, v126
 v_max3_f32 v156, v156, v127, v128
 v_max3_f32 v156, v156, v129, v130
 v_max_f32 v156, v156, v131
 v_mov_b32 v157, v156
 s_nop 1
 v_permlane32_swap_b32 v156, v157
 v_max_f32 v156, v156, v157
 v_mov_b32 v157, v156
 s_nop 1
 v_permlane16_swap_b32 v156, v157
 v_max_f32 v156, v156, v157
 v_mul_f32 v156, s83, v156
 v_fma_f32 v120, v120, s83, -v156
 v_fma_f32 v121, v121, s83, -v156
 v_fma_f32 v122, v122, s83, -v156
 v_fma_f32 v123, v123, s83, -v156
 v_fma_f32 v124, v124, s83, -v156
 v_fma_f32 v125, v125, s83, -v156
 v_fma_f32 v126, v126, s83, -v156
 v_fma_f32 v127, v127, s83, -v156
 v_fma_f32 v128, v128, s83, -v156
 v_fma_f32 v129, v129, s83, -v156
 v_fma_f32 v130, v130, s83, -v156
 v_fma_f32 v131, v131, s83, -v156
 v_exp_f32 v120, v120
 v_exp_f32 v121, v121
 v_exp_f32 v122, v122
 v_exp_f32 v123, v123
 v_exp_f32 v124, v124
 v_exp_f32 v125, v125
 v_exp_f32 v126, v126
 v_exp_f32 v127, v127
 v_exp_f32 v128, v128
 v_exp_f32 v129, v129
 v_exp_f32 v130, v130
 v_exp_f32 v131, v131
 s_nop 0
 v_add_f32 v156, v128, v129
 v_add_f32 v156, v156, v130
 v_add_f32 v156, v156, v131
 v_cndmask_b32 v156, 0, v156, s[60:61]
 v_add_f32 v156, v156, v120
 v_add_f32 v156, v156, v121
 v_add_f32 v156, v156, v122
 v_add_f32 v156, v156, v123
 v_add_f32 v156, v156, v124
 v_add_f32 v156, v156, v125
 v_add_f32 v156, v156, v126
 v_add_f32 v156, v156, v127
 v_mov_b32 v157, v156
 s_nop 1
 v_permlane32_swap_b32 v156, v157
 v_add_f32 v156, v156, v157
 v_mov_b32 v157, v156
 s_nop 1
 v_permlane16_swap_b32 v156, v157
 v_add_f32 v156, v156, v157
 v_rcp_f32 v156, v156
 s_nop 0
 v_mul_f32 v120, v120, v156
 v_mul_f32 v121, v121, v156
 v_mul_f32 v122, v122, v156
 v_mul_f32 v123, v123, v156
 v_mul_f32 v124, v124, v156
 v_mul_f32 v125, v125, v156
 v_mul_f32 v126, v126, v156
 v_mul_f32 v127, v127, v156
 v_mul_f32 v128, v128, v156
 v_mul_f32 v129, v129, v156
 v_mul_f32 v130, v130, v156
 v_mul_f32 v131, v131, v156
 v_cvt_pk_bf16_f32 v196, v116, v117
 v_cvt_pk_bf16_f32 v197, v118, v119
 v_cvt_pk_bf16_f32 v198, v128, v129
 v_cvt_pk_bf16_f32 v199, v130, v131
 v_cvt_pk_bf16_f32 v192, v120, v121
 v_cvt_pk_bf16_f32 v193, v122, v123
 v_cvt_pk_bf16_f32 v194, v124, v125
 v_cvt_pk_bf16_f32 v195, v126, v127
 v_cvt_pk_bf16_f32 v200, v112, v113
 v_cvt_pk_bf16_f32 v201, v114, v115
 v_permlane16_swap_b32 v196, v198
 v_permlane16_swap_b32 v197, v199
 buffer_store_dwordx4 v[192:195], v30, s[56:59], s81 offen sc1
 s_mov_b64 exec, 0xffffffff
 buffer_store_dwordx4 v[196:199], v30, s[56:59], s81 offen offset:1024 sc1
 s_mov_b64 exec, -1
 buffer_store_dwordx2 v[200:201], v32, s[56:59], s81 offen offset:1536 sc1
 s_mov_b32 s78, s82
 s_mov_b32 s81, 0x80000000
 s_mov_b32 s82, 0
 s_cmp_eq_u32 s80, 1
 s_cbranch_scc1 qd_235
 s_waitcnt vmcnt(0)
 s_cmp_eq_u32 s78, 0
 s_cbranch_scc1 pf_236
 v_mov_b32 v4, 0
 v_mov_b32 v5, 1
 s_mov_b64 exec, 1
 buffer_atomic_add v5, v4, s[72:75], s78 offen sc1
 s_mov_b64 exec, -1
 s_mov_b32 s78, 0
pf_236:
qd_235:
 s_add_u32 s49, s49, s29
qbe_225:
 s_waitcnt vmcnt(0)
 s_cmp_eq_u32 s78, 0
 s_cbranch_scc1 pf_237
 v_mov_b32 v4, 0
 v_mov_b32 v5, 1
 s_mov_b64 exec, 1
 buffer_atomic_add v5, v4, s[72:75], s78 offen sc1
 s_mov_b64 exec, -1
 s_mov_b32 s78, 0
pf_237:
 s_branch queue
q_done:
 s_and_b32 s21, s3, 3
 s_sub_u32 s22, s21, 2
 s_lshl_b32 s22, s22, 3
 s_bfe_u32 s87, s3, 0x30002
 s_add_u32 s87, s87, s22
 s_add_u32 s87, s87, 248
 s_cmp_lt_u32 s21, 2
 s_cselect_b32 s87, -1, s87
 s_sub_u32 s21, s3, 96
 s_waitcnt vmcnt(0) lgkmcnt(0)
 s_barrier
 s_branch do_opb2
queue:
 s_load_dwordx2 s[4:5], s[0:1], 96
 s_waitcnt lgkmcnt(0)
 s_mov_b32 s32, s4
 s_mov_b32 s33, s5
 s_mov_b32 s34, 256
 s_mov_b32 s35, 0x00020000
 s_waitcnt vmcnt(0) lgkmcnt(0)
 s_barrier
 s_mov_b32 s2, s85
 s_mov_b32 s85, -1
 s_cmp_lg_u32 s2, -1
 s_cbranch_scc1 queue_c
 v_mov_b32 v21, 0
 s_cmp_lg_u32 s20, 0
 s_cbranch_scc1 q_238
 v_mov_b32 v22, 80
 v_mov_b32 v23, 1
 s_mov_b64 exec, 1
 buffer_atomic_add v23, v22, s[32:35], 0 offen sc0 sc1
 s_waitcnt vmcnt(0)
queue_a:
 ds_write_b32 v21, v23
 s_waitcnt lgkmcnt(0)
 s_mov_b64 exec, -1
q_238:
queue_b:
 s_barrier
 ds_read_b32 v23, v21
 s_waitcnt lgkmcnt(0)
 v_readfirstlane_b32 s2, v23
 s_barrier
queue_c:
 s_add_u32 s21, s2, 0
 s_cmp_lt_u32 s2, 64
 s_cbranch_scc1 do_pv
 s_sub_u32 s2, s2, 64
 s_add_u32 s21, s2, 64
 s_cmp_lt_u32 s2, 20
 s_cbranch_scc1 do_pv
 s_sub_u32 s2, s2, 20
 s_add_u32 s21, s2, 84
 s_cmp_lt_u32 s2, 20
 s_cbranch_scc1 do_pv
 s_sub_u32 s2, s2, 20
 s_add_u32 s21, s2, 124
 s_cmp_lt_u32 s2, 20
 s_cbranch_scc1 do_pv
 s_sub_u32 s2, s2, 20
 s_add_u32 s21, s2, 104
 s_cmp_lt_u32 s2, 20
 s_cbranch_scc1 do_pv
 s_sub_u32 s2, s2, 20
 s_add_u32 s21, s2, 144
 s_cmp_lt_u32 s2, 104
 s_cbranch_scc1 do_pv
 s_sub_u32 s2, s2, 104
 s_branch main_fin
do_opb:
 s_mov_b32 s87, -1
do_opb2:
 s_mov_b32 s2, s21
 s_load_dwordx2 s[4:5], s[0:1], 0
 s_load_dwordx4 s[40:43], s[0:1], 72
 s_load_dwordx2 s[38:39], s[0:1], 104
 s_lshl_b32 s59, s2, 2
 s_add_u32 s59, s59, s20
 s_lshl_b32 s59, s59, 3
 v_lshlrev_b32 v4, 4, v1
 v_lshlrev_b32 v5, 2, v1
 s_waitcnt lgkmcnt(0)
 s_mov_b32 s8, s4
 s_mov_b32 s9, s5
 s_mov_b32 s10, 2621440
 s_mov_b32 s11, 0x00020000
 s_mov_b32 s12, s42
 s_mov_b32 s13, s43
 s_mov_b32 s14, 1280
 s_mov_b32 s15, 0x00020000
 s_mov_b32 s24, s40
 s_mov_b32 s25, s41
 s_mov_b32 s26, 819200
 s_mov_b32 s27, 0x00020000
 s_add_u32 s16, s38, 70713344
 s_addc_u32 s17, s39, 0
 s_mov_b32 s18, 2641920
 s_mov_b32 s19, 0x00020000
 s_add_u32 s28, s38, 81002496
 s_addc_u32 s29, s39, 0
 s_mov_b32 s30, 8192
 s_mov_b32 s31, 0x00020000
 s_add_u32 s72, s38, 81068032
 s_addc_u32 s73, s39, 0
 s_mov_b32 s74, 129024
 s_mov_b32 s75, 0x00020000
 s_mov_b32 s21, 91136
 v_mov_b32 v20, 0
 buffer_load_dword v21, v20, s[72:75], s21 offen sc1
 v_mov_b32 v29, 3277
 s_mul_i32 s21, s20, 320
 s_add_u32 s21, s21, 0
 v_add_u32 v22, s21, v1
 v_mul_u32_u24 v23, v22, v29
 v_lshrrev_b32 v23, 16, v23
 v_mul_u32_u24 v24, 20, v23
 v_sub_u32 v22, v22, v24
 v_bfe_u32 v24, v23, 3, 1
 v_lshlrev_b32 v24, 1, v24
 v_xor_b32 v22, v22, v24
 v_mul_u32_u24 v23, 1280, v23
 v_lshl_add_u32 v8, v22, 4, v23
 s_mul_i32 s21, s20, 320
 s_add_u32 s21, s21, 64
 v_add_u32 v22, s21, v1
 v_mul_u32_u24 v23, v22, v29
 v_lshrrev_b32 v23, 16, v23
 v_mul_u32_u24 v24, 20, v23
 v_sub_u32 v22, v22, v24
 v_bfe_u32 v24, v23, 3, 1
 v_lshlrev_b32 v24, 1, v24
 v_xor_b32 v22, v22, v24
 v_mul_u32_u24 v23, 1280, v23
 v_lshl_add_u32 v9, v22, 4, v23
 s_mul_i32 s21, s20, 320
 s_add_u32 s21, s21, 128
 v_add_u32 v22, s21, v1
 v_mul_u32_u24 v23, v22, v29
 v_lshrrev_b32 v23, 16, v23
 v_mul_u32_u24 v24, 20, v23
 v_sub_u32 v22, v22, v24
 v_bfe_u32 v24, v23, 3, 1
 v_lshlrev_b32 v24, 1, v24
 v_xor_b32 v22, v22, v24
 v_mul_u32_u24 v23, 1280, v23
 v_lshl_add_u32 v10, v22, 4, v23
 s_mul_i32 s21, s20, 320
 s_add_u32 s21, s21, 192
 v_add_u32 v22, s21, v1
 v_mul_u32_u24 v23, v22, v29
 v_lshrrev_b32 v23, 16, v23
 v_mul_u32_u24 v24, 20, v23
 v_sub_u32 v22, v22, v24
 v_bfe_u32 v24, v23, 3, 1
 v_lshlrev_b32 v24, 1, v24
 v_xor_b32 v22, v22, v24
 v_mul_u32_u24 v23, 1280, v23
 v_lshl_add_u32 v11, v22, 4, v23
 s_mul_i32 s21, s20, 320
 s_add_u32 s21, s21, 256
 v_add_u32 v22, s21, v1
 v_mul_u32_u24 v23, v22, v29
 v_lshrrev_b32 v23, 16, v23
 v_mul_u32_u24 v24, 20, v23
 v_sub_u32 v22, v22, v24
 v_bfe_u32 v24, v23, 3, 1
 v_lshlrev_b32 v24, 1, v24
 v_xor_b32 v22, v22, v24
 v_mul_u32_u24 v23, 1280, v23
 v_lshl_add_u32 v12, v22, 4, v23
 s_and_b32 s44, s2, 3
 s_mul_i32 s45, s44, 320
 s_mul_i32 s46, s20, 5120
 v_and_b32 v22, 1, v2
 v_mul_u32_u24 v22, 16512, v22
 v_mul_u32_u24 v23, 33024, v3
 v_lshrrev_b32 v24, 1, v2
 v_lshlrev_b32 v24, 4, v24
 v_add3_u32 v6, v22, v23, v24
 s_lshr_b32 s47, s2, 2
 s_lshl_b32 s47, s47, 2
 s_add_u32 s47, s47, s20
 s_lshl_b32 s47, s47, 1
 s_lshl_b32 s48, s47, 7
 v_lshrrev_b32 v22, 2, v2
 v_lshl_add_u32 v22, v3, 3, v22
 v_mul_u32_u24 v22, 320, v22
 v_and_b32 v23, 3, v2
 v_lshl_add_u32 v22, v23, 3, v22
 v_and_b32 v23, 1, v3
 v_lshlrev_b32 v23, 5, v23
 v_add_u32 v14, v22, v23
 v_sub_u32 v15, v22, v23
 v_add_u32 v16, 61440, v14
 v_add_u32 v17, 61440, v15
 v_add_u32 v18, 122880, v14
 v_add_u32 v19, 122880, v15
 s_add_u32 m0, s46, 0
 s_add_u32 s49, s45, 0
 s_nop 0
 buffer_load_dwordx4 v8, s[24:27], s49 offen lds
 s_add_u32 m0, s46, 1024
 s_nop 0
 buffer_load_dwordx4 v9, s[24:27], s49 offen lds
 s_add_u32 m0, s46, 2048
 s_nop 0
 buffer_load_dwordx4 v10, s[24:27], s49 offen lds
 s_add_u32 m0, s46, 3072
 s_nop 0
 buffer_load_dwordx4 v11, s[24:27], s49 offen lds
 s_add_u32 m0, s46, 4096
 s_nop 0
 buffer_load_dwordx4 v12, s[24:27], s49 offen lds
 s_add_u32 m0, s46, 20480
 s_add_u32 s49, s45, 81920
 s_nop 0
 buffer_load_dwordx4 v8, s[24:27], s49 offen lds
 s_add_u32 m0, s46, 21504
 s_nop 0
 buffer_load_dwordx4 v9, s[24:27], s49 offen lds
 s_add_u32 m0, s46, 22528
 s_nop 0
 buffer_load_dwordx4 v10, s[24:27], s49 offen lds
 s_add_u32 m0, s46, 23552
 s_nop 0
 buffer_load_dwordx4 v11, s[24:27], s49 offen lds
 s_add_u32 m0, s46, 24576
 s_nop 0
 buffer_load_dwordx4 v12, s[24:27], s49 offen lds
 s_waitcnt vmcnt(10)
 v_readfirstlane_b32 s21, v21
 s_cmp_ge_u32 s21, 64
 s_cbranch_scc1 o2_239
 s_mov_b32 s21, 91136
 v_mov_b32 v20, 0
 s_mov_b32 s101, 0
wf_240:
 buffer_load_dword v21, v20, s[72:75], s21 offen sc1
 s_add_u32 s101, s101, 1
 s_cmp_gt_u32 s101, 131072
 s_cbranch_scc1 main_end
 s_waitcnt vmcnt(0)
 v_readfirstlane_b32 s100, v21
 s_cmp_ge_u32 s100, 64
 s_cbranch_scc1 wf_241
 s_sleep 32
 s_branch wf_240
wf_241:
o2_239:
 buffer_load_dwordx4 a[0:3], v6, s[16:19], s48 offen offset:0 sc1
 buffer_load_dwordx4 a[4:7], v6, s[16:19], s48 offen offset:128 sc1
 s_add_u32 s48, s48, 132096
 buffer_load_dwordx4 a[8:11], v6, s[16:19], s48 offen offset:0 sc1
 buffer_load_dwordx4 a[12:15], v6, s[16:19], s48 offen offset:128 sc1
 s_add_u32 s48, s48, 132096
 buffer_load_dwordx4 a[16:19], v6, s[16:19], s48 offen offset:0 sc1
 buffer_load_dwordx4 a[20:23], v6, s[16:19], s48 offen offset:128 sc1
 s_add_u32 s48, s48, 132096
 buffer_load_dwordx4 a[24:27], v6, s[16:19], s48 offen offset:0 sc1
 buffer_load_dwordx4 a[28:31], v6, s[16:19], s48 offen offset:128 sc1
 s_add_u32 s48, s48, 132096
 s_add_u32 m0, s46, 40960
 s_add_u32 s49, s45, 163840
 s_nop 0
 buffer_load_dwordx4 v8, s[24:27], s49 offen lds
 s_add_u32 m0, s46, 41984
 s_nop 0
 buffer_load_dwordx4 v9, s[24:27], s49 offen lds
 s_add_u32 m0, s46, 43008
 s_nop 0
 buffer_load_dwordx4 v10, s[24:27], s49 offen lds
 s_add_u32 m0, s46, 44032
 s_nop 0
 buffer_load_dwordx4 v11, s[24:27], s49 offen lds
 s_add_u32 m0, s46, 45056
 s_nop 0
 buffer_load_dwordx4 v12, s[24:27], s49 offen lds
 buffer_load_dwordx4 a[32:35], v6, s[16:19], s48 offen offset:0 sc1
 buffer_load_dwordx4 a[36:39], v6, s[16:19], s48 offen offset:128 sc1
 s_add_u32 s48, s48, 132096
 buffer_load_dwordx4 a[40:43], v6, s[16:19], s48 offen offset:0 sc1
 buffer_load_dwordx4 a[44:47], v6, s[16:19], s48 offen offset:128 sc1
 s_add_u32 s48, s48, 132096
 s_add_u32 m0, s46, 61440
 s_add_u32 s49, s45, 245760
 s_nop 0
 buffer_load_dwordx4 v8, s[24:27], s49 offen lds
 s_add_u32 m0, s46, 62464
 s_nop 0
 buffer_load_dwordx4 v9, s[24:27], s49 offen lds
 s_add_u32 m0, s46, 63488
 s_nop 0
 buffer_load_dwordx4 v10, s[24:27], s49 offen lds
 s_add_u32 m0, s46, 64512
 s_nop 0
 buffer_load_dwordx4 v11, s[24:27], s49 offen lds
 s_add_u32 m0, s46, 65536
 s_nop 0
 buffer_load_dwordx4 v12, s[24:27], s49 offen lds
 buffer_load_dwordx4 a[48:51], v6, s[16:19], s48 offen offset:0 sc1
 buffer_load_dwordx4 a[52:55], v6, s[16:19], s48 offen offset:128 sc1
 s_add_u32 s48, s48, 132096
 buffer_load_dwordx4 a[56:59], v6, s[16:19], s48 offen offset:0 sc1
 buffer_load_dwordx4 a[60:63], v6, s[16:19], s48 offen offset:128 sc1
 s_add_u32 s48, s48, 132096
 s_add_u32 m0, s46, 81920
 s_add_u32 s49, s45, 327680
 s_nop 0
 buffer_load_dwordx4 v8, s[24:27], s49 offen lds
 s_add_u32 m0, s46, 82944
 s_nop 0
 buffer_load_dwordx4 v9, s[24:27], s49 offen lds
 s_add_u32 m0, s46, 83968
 s_nop 0
 buffer_load_dwordx4 v10, s[24:27], s49 offen lds
 s_add_u32 m0, s46, 84992
 s_nop 0
 buffer_load_dwordx4 v11, s[24:27], s49 offen lds
 s_add_u32 m0, s46, 86016
 s_nop 0
 buffer_load_dwordx4 v12, s[24:27], s49 offen lds
 buffer_load_dwordx4 a[64:67], v6, s[16:19], s48 offen offset:0 sc1
 buffer_load_dwordx4 a[68:71], v6, s[16:19], s48 offen offset:128 sc1
 s_add_u32 s48, s48, 132096
 buffer_load_dwordx4 a[72:75], v6, s[16:19], s48 offen offset:0 sc1
 buffer_load_dwordx4 a[76:79], v6, s[16:19], s48 offen offset:128 sc1
 s_add_u32 s48, s48, 132096
 s_add_u32 m0, s46, 102400
 s_add_u32 s49, s45, 409600
 s_nop 0
 buffer_load_dwordx4 v8, s[24:27], s49 offen lds
 s_add_u32 m0, s46, 103424
 s_nop 0
 buffer_load_dwordx4 v9, s[24:27], s49 offen lds
 s_add_u32 m0, s46, 104448
 s_nop 0
 buffer_load_dwordx4 v10, s[24:27], s49 offen lds
 s_add_u32 m0, s46, 105472
 s_nop 0
 buffer_load_dwordx4 v11, s[24:27], s49 offen lds
 s_add_u32 m0, s46, 106496
 s_nop 0
 buffer_load_dwordx4 v12, s[24:27], s49 offen lds
 s_add_u32 m0, s46, 122880
 s_add_u32 s49, s45, 491520
 s_nop 0
 buffer_load_dwordx4 v8, s[24:27], s49 offen lds
 s_add_u32 m0, s46, 123904
 s_nop 0
 buffer_load_dwordx4 v9, s[24:27], s49 offen lds
 s_add_u32 m0, s46, 124928
 s_nop 0
 buffer_load_dwordx4 v10, s[24:27], s49 offen lds
 s_add_u32 m0, s46, 125952
 s_nop 0
 buffer_load_dwordx4 v11, s[24:27], s49 offen lds
 s_add_u32 m0, s46, 126976
 s_nop 0
 buffer_load_dwordx4 v12, s[24:27], s49 offen lds
 s_waitcnt vmcnt(50)
 s_barrier
 ds_read_b64_tr_b16 v[144:145], v14 offset:0
 ds_read_b64_tr_b16 v[146:147], v14 offset:1280
 ds_read_b64_tr_b16 v[148:149], v15 offset:32
 ds_read_b64_tr_b16 v[150:151], v15 offset:1312
 ds_read_b64_tr_b16 v[152:153], v14 offset:64
 ds_read_b64_tr_b16 v[154:155], v14 offset:1344
 ds_read_b64_tr_b16 v[156:157], v15 offset:96
 ds_read_b64_tr_b16 v[158:159], v15 offset:1376
 ds_read_b64_tr_b16 v[160:161], v14 offset:128
 ds_read_b64_tr_b16 v[162:163], v14 offset:1408
 ds_read_b64_tr_b16 v[164:165], v15 offset:160
 ds_read_b64_tr_b16 v[166:167], v15 offset:1440
 ds_read_b64_tr_b16 v[168:169], v14 offset:192
 ds_read_b64_tr_b16 v[170:171], v14 offset:1472
 ds_read_b64_tr_b16 v[172:173], v15 offset:224
 ds_read_b64_tr_b16 v[174:175], v15 offset:1504
 ds_read_b64_tr_b16 v[176:177], v14 offset:256
 ds_read_b64_tr_b16 v[178:179], v14 offset:1536
 ds_read_b64_tr_b16 v[180:181], v15 offset:288
 ds_read_b64_tr_b16 v[182:183], v15 offset:1568
 s_waitcnt lgkmcnt(0) vmcnt(43)
 v_mfma_f32_16x16x32_bf16 v[64:67], v[144:147], a[0:3], 0
 ds_read_b64_tr_b16 v[184:185], v14 offset:10240
 ds_read_b64_tr_b16 v[186:187], v14 offset:11520
 v_mfma_f32_16x16x32_bf16 v[104:107], v[144:147], a[4:7], 0
 ds_read_b64_tr_b16 v[188:189], v15 offset:10272
 v_mfma_f32_16x16x32_bf16 v[68:71], v[148:151], a[0:3], 0
 ds_read_b64_tr_b16 v[190:191], v15 offset:11552
 v_mfma_f32_16x16x32_bf16 v[108:111], v[148:151], a[4:7], 0
 ds_read_b64_tr_b16 v[192:193], v14 offset:10304
 v_mfma_f32_16x16x32_bf16 v[72:75], v[152:155], a[0:3], 0
 ds_read_b64_tr_b16 v[194:195], v14 offset:11584
 v_mfma_f32_16x16x32_bf16 v[112:115], v[152:155], a[4:7], 0
 ds_read_b64_tr_b16 v[196:197], v15 offset:10336
 ds_read_b64_tr_b16 v[198:199], v15 offset:11616
 v_mfma_f32_16x16x32_bf16 v[76:79], v[156:159], a[0:3], 0
 ds_read_b64_tr_b16 v[200:201], v14 offset:10368
 v_mfma_f32_16x16x32_bf16 v[116:119], v[156:159], a[4:7], 0
 ds_read_b64_tr_b16 v[202:203], v14 offset:11648
 v_mfma_f32_16x16x32_bf16 v[80:83], v[160:163], a[0:3], 0
 ds_read_b64_tr_b16 v[204:205], v15 offset:10400
 v_mfma_f32_16x16x32_bf16 v[120:123], v[160:163], a[4:7], 0
 ds_read_b64_tr_b16 v[206:207], v15 offset:11680
 v_mfma_f32_16x16x32_bf16 v[84:87], v[164:167], a[0:3], 0
 ds_read_b64_tr_b16 v[208:209], v14 offset:10432
 v_mfma_f32_16x16x32_bf16 v[124:127], v[164:167], a[4:7], 0
 ds_read_b64_tr_b16 v[210:211], v14 offset:11712
 ds_read_b64_tr_b16 v[212:213], v15 offset:10464
 v_mfma_f32_16x16x32_bf16 v[88:91], v[168:171], a[0:3], 0
 ds_read_b64_tr_b16 v[214:215], v15 offset:11744
 v_mfma_f32_16x16x32_bf16 v[128:131], v[168:171], a[4:7], 0
 buffer_load_dwordx4 a[80:83], v6, s[16:19], s48 offen offset:0 sc1
 ds_read_b64_tr_b16 v[216:217], v14 offset:10496
 v_mfma_f32_16x16x32_bf16 v[92:95], v[172:175], a[0:3], 0
 ds_read_b64_tr_b16 v[218:219], v14 offset:11776
 v_mfma_f32_16x16x32_bf16 v[132:135], v[172:175], a[4:7], 0
 ds_read_b64_tr_b16 v[220:221], v15 offset:10528
 v_mfma_f32_16x16x32_bf16 v[96:99], v[176:179], a[0:3], 0
 ds_read_b64_tr_b16 v[222:223], v15 offset:11808
 v_mfma_f32_16x16x32_bf16 v[136:139], v[176:179], a[4:7], 0
 buffer_load_dwordx4 a[84:87], v6, s[16:19], s48 offen offset:128 sc1
 v_mfma_f32_16x16x32_bf16 v[100:103], v[180:183], a[0:3], 0
 s_add_u32 s48, s48, 132096
 v_mfma_f32_16x16x32_bf16 v[140:143], v[180:183], a[4:7], 0
 s_waitcnt lgkmcnt(0) vmcnt(43)
 s_barrier
 v_mfma_f32_16x16x32_bf16 v[64:67], v[184:187], a[8:11], v[64:67]
 s_add_u32 m0, s46, 0
 ds_read_b64_tr_b16 v[144:145], v14 offset:20480
 ds_read_b64_tr_b16 v[146:147], v14 offset:21760
 v_mfma_f32_16x16x32_bf16 v[104:107], v[184:187], a[12:15], v[104:107]
 s_add_u32 s49, s45, 573440
 ds_read_b64_tr_b16 v[148:149], v15 offset:20512
 v_mfma_f32_16x16x32_bf16 v[68:71], v[188:191], a[8:11], v[68:71]
 buffer_load_dwordx4 v8, s[24:27], s49 offen lds
 ds_read_b64_tr_b16 v[150:151], v15 offset:21792
 v_mfma_f32_16x16x32_bf16 v[108:111], v[188:191], a[12:15], v[108:111]
 s_add_u32 m0, s46, 1024
 ds_read_b64_tr_b16 v[152:153], v14 offset:20544
 v_mfma_f32_16x16x32_bf16 v[72:75], v[192:195], a[8:11], v[72:75]
 buffer_load_dwordx4 v9, s[24:27], s49 offen lds
 ds_read_b64_tr_b16 v[154:155], v14 offset:21824
 v_mfma_f32_16x16x32_bf16 v[112:115], v[192:195], a[12:15], v[112:115]
 s_add_u32 m0, s46, 2048
 ds_read_b64_tr_b16 v[156:157], v15 offset:20576
 ds_read_b64_tr_b16 v[158:159], v15 offset:21856
 v_mfma_f32_16x16x32_bf16 v[76:79], v[196:199], a[8:11], v[76:79]
 buffer_load_dwordx4 v10, s[24:27], s49 offen lds
 ds_read_b64_tr_b16 v[160:161], v14 offset:20608
 v_mfma_f32_16x16x32_bf16 v[116:119], v[196:199], a[12:15], v[116:119]
 s_add_u32 m0, s46, 3072
 ds_read_b64_tr_b16 v[162:163], v14 offset:21888
 v_mfma_f32_16x16x32_bf16 v[80:83], v[200:203], a[8:11], v[80:83]
 buffer_load_dwordx4 v11, s[24:27], s49 offen lds
 ds_read_b64_tr_b16 v[164:165], v15 offset:20640
 v_mfma_f32_16x16x32_bf16 v[120:123], v[200:203], a[12:15], v[120:123]
 s_add_u32 m0, s46, 4096
 ds_read_b64_tr_b16 v[166:167], v15 offset:21920
 v_mfma_f32_16x16x32_bf16 v[84:87], v[204:207], a[8:11], v[84:87]
 buffer_load_dwordx4 v12, s[24:27], s49 offen lds
 ds_read_b64_tr_b16 v[168:169], v14 offset:20672
 v_mfma_f32_16x16x32_bf16 v[124:127], v[204:207], a[12:15], v[124:127]
 ds_read_b64_tr_b16 v[170:171], v14 offset:21952
 ds_read_b64_tr_b16 v[172:173], v15 offset:20704
 v_mfma_f32_16x16x32_bf16 v[88:91], v[208:211], a[8:11], v[88:91]
 ds_read_b64_tr_b16 v[174:175], v15 offset:21984
 v_mfma_f32_16x16x32_bf16 v[128:131], v[208:211], a[12:15], v[128:131]
 buffer_load_dwordx4 a[88:91], v6, s[16:19], s48 offen offset:0 sc1
 ds_read_b64_tr_b16 v[176:177], v14 offset:20736
 v_mfma_f32_16x16x32_bf16 v[92:95], v[212:215], a[8:11], v[92:95]
 ds_read_b64_tr_b16 v[178:179], v14 offset:22016
 v_mfma_f32_16x16x32_bf16 v[132:135], v[212:215], a[12:15], v[132:135]
 ds_read_b64_tr_b16 v[180:181], v15 offset:20768
 v_mfma_f32_16x16x32_bf16 v[96:99], v[216:219], a[8:11], v[96:99]
 ds_read_b64_tr_b16 v[182:183], v15 offset:22048
 v_mfma_f32_16x16x32_bf16 v[136:139], v[216:219], a[12:15], v[136:139]
 buffer_load_dwordx4 a[92:95], v6, s[16:19], s48 offen offset:128 sc1
 v_mfma_f32_16x16x32_bf16 v[100:103], v[220:223], a[8:11], v[100:103]
 s_add_u32 s48, s48, 132096
 v_mfma_f32_16x16x32_bf16 v[140:143], v[220:223], a[12:15], v[140:143]
 s_waitcnt lgkmcnt(0) vmcnt(48)
 v_mfma_f32_16x16x32_bf16 v[64:67], v[144:147], a[16:19], v[64:67]
 ds_read_b64_tr_b16 v[184:185], v14 offset:30720
 ds_read_b64_tr_b16 v[186:187], v14 offset:32000
 v_mfma_f32_16x16x32_bf16 v[104:107], v[144:147], a[20:23], v[104:107]
 ds_read_b64_tr_b16 v[188:189], v15 offset:30752
 v_mfma_f32_16x16x32_bf16 v[68:71], v[148:151], a[16:19], v[68:71]
 ds_read_b64_tr_b16 v[190:191], v15 offset:32032
 v_mfma_f32_16x16x32_bf16 v[108:111], v[148:151], a[20:23], v[108:111]
 ds_read_b64_tr_b16 v[192:193], v14 offset:30784
 v_mfma_f32_16x16x32_bf16 v[72:75], v[152:155], a[16:19], v[72:75]
 ds_read_b64_tr_b16 v[194:195], v14 offset:32064
 v_mfma_f32_16x16x32_bf16 v[112:115], v[152:155], a[20:23], v[112:115]
 ds_read_b64_tr_b16 v[196:197], v15 offset:30816
 ds_read_b64_tr_b16 v[198:199], v15 offset:32096
 v_mfma_f32_16x16x32_bf16 v[76:79], v[156:159], a[16:19], v[76:79]
 ds_read_b64_tr_b16 v[200:201], v14 offset:30848
 v_mfma_f32_16x16x32_bf16 v[116:119], v[156:159], a[20:23], v[116:119]
 ds_read_b64_tr_b16 v[202:203], v14 offset:32128
 v_mfma_f32_16x16x32_bf16 v[80:83], v[160:163], a[16:19], v[80:83]
 ds_read_b64_tr_b16 v[204:205], v15 offset:30880
 v_mfma_f32_16x16x32_bf16 v[120:123], v[160:163], a[20:23], v[120:123]
 ds_read_b64_tr_b16 v[206:207], v15 offset:32160
 v_mfma_f32_16x16x32_bf16 v[84:87], v[164:167], a[16:19], v[84:87]
 ds_read_b64_tr_b16 v[208:209], v14 offset:30912
 v_mfma_f32_16x16x32_bf16 v[124:127], v[164:167], a[20:23], v[124:127]
 ds_read_b64_tr_b16 v[210:211], v14 offset:32192
 ds_read_b64_tr_b16 v[212:213], v15 offset:30944
 v_mfma_f32_16x16x32_bf16 v[88:91], v[168:171], a[16:19], v[88:91]
 ds_read_b64_tr_b16 v[214:215], v15 offset:32224
 v_mfma_f32_16x16x32_bf16 v[128:131], v[168:171], a[20:23], v[128:131]
 buffer_load_dwordx4 a[96:99], v6, s[16:19], s48 offen offset:0 sc1
 ds_read_b64_tr_b16 v[216:217], v14 offset:30976
 v_mfma_f32_16x16x32_bf16 v[92:95], v[172:175], a[16:19], v[92:95]
 ds_read_b64_tr_b16 v[218:219], v14 offset:32256
 v_mfma_f32_16x16x32_bf16 v[132:135], v[172:175], a[20:23], v[132:135]
 ds_read_b64_tr_b16 v[220:221], v15 offset:31008
 v_mfma_f32_16x16x32_bf16 v[96:99], v[176:179], a[16:19], v[96:99]
 ds_read_b64_tr_b16 v[222:223], v15 offset:32288
 v_mfma_f32_16x16x32_bf16 v[136:139], v[176:179], a[20:23], v[136:139]
 buffer_load_dwordx4 a[100:103], v6, s[16:19], s48 offen offset:128 sc1
 v_mfma_f32_16x16x32_bf16 v[100:103], v[180:183], a[16:19], v[100:103]
 s_add_u32 s48, s48, 132096
 v_mfma_f32_16x16x32_bf16 v[140:143], v[180:183], a[20:23], v[140:143]
 s_waitcnt lgkmcnt(0) vmcnt(43)
 s_barrier
 v_mfma_f32_16x16x32_bf16 v[64:67], v[184:187], a[24:27], v[64:67]
 s_add_u32 m0, s46, 20480
 ds_read_b64_tr_b16 v[144:145], v14 offset:40960
 ds_read_b64_tr_b16 v[146:147], v14 offset:42240
 v_mfma_f32_16x16x32_bf16 v[104:107], v[184:187], a[28:31], v[104:107]
 s_add_u32 s49, s45, 655360
 ds_read_b64_tr_b16 v[148:149], v15 offset:40992
 v_mfma_f32_16x16x32_bf16 v[68:71], v[188:191], a[24:27], v[68:71]
 buffer_load_dwordx4 v8, s[24:27], s49 offen lds
 ds_read_b64_tr_b16 v[150:151], v15 offset:42272
 v_mfma_f32_16x16x32_bf16 v[108:111], v[188:191], a[28:31], v[108:111]
 s_add_u32 m0, s46, 21504
 ds_read_b64_tr_b16 v[152:153], v14 offset:41024
 v_mfma_f32_16x16x32_bf16 v[72:75], v[192:195], a[24:27], v[72:75]
 buffer_load_dwordx4 v9, s[24:27], s49 offen lds
 ds_read_b64_tr_b16 v[154:155], v14 offset:42304
 v_mfma_f32_16x16x32_bf16 v[112:115], v[192:195], a[28:31], v[112:115]
 s_add_u32 m0, s46, 22528
 ds_read_b64_tr_b16 v[156:157], v15 offset:41056
 ds_read_b64_tr_b16 v[158:159], v15 offset:42336
 v_mfma_f32_16x16x32_bf16 v[76:79], v[196:199], a[24:27], v[76:79]
 buffer_load_dwordx4 v10, s[24:27], s49 offen lds
 ds_read_b64_tr_b16 v[160:161], v14 offset:41088
 v_mfma_f32_16x16x32_bf16 v[116:119], v[196:199], a[28:31], v[116:119]
 s_add_u32 m0, s46, 23552
 ds_read_b64_tr_b16 v[162:163], v14 offset:42368
 v_mfma_f32_16x16x32_bf16 v[80:83], v[200:203], a[24:27], v[80:83]
 buffer_load_dwordx4 v11, s[24:27], s49 offen lds
 ds_read_b64_tr_b16 v[164:165], v15 offset:41120
 v_mfma_f32_16x16x32_bf16 v[120:123], v[200:203], a[28:31], v[120:123]
 s_add_u32 m0, s46, 24576
 ds_read_b64_tr_b16 v[166:167], v15 offset:42400
 v_mfma_f32_16x16x32_bf16 v[84:87], v[204:207], a[24:27], v[84:87]
 buffer_load_dwordx4 v12, s[24:27], s49 offen lds
 ds_read_b64_tr_b16 v[168:169], v14 offset:41152
 v_mfma_f32_16x16x32_bf16 v[124:127], v[204:207], a[28:31], v[124:127]
 ds_read_b64_tr_b16 v[170:171], v14 offset:42432
 ds_read_b64_tr_b16 v[172:173], v15 offset:41184
 v_mfma_f32_16x16x32_bf16 v[88:91], v[208:211], a[24:27], v[88:91]
 ds_read_b64_tr_b16 v[174:175], v15 offset:42464
 v_mfma_f32_16x16x32_bf16 v[128:131], v[208:211], a[28:31], v[128:131]
 buffer_load_dwordx4 a[104:107], v6, s[16:19], s48 offen offset:0 sc1
 ds_read_b64_tr_b16 v[176:177], v14 offset:41216
 v_mfma_f32_16x16x32_bf16 v[92:95], v[212:215], a[24:27], v[92:95]
 ds_read_b64_tr_b16 v[178:179], v14 offset:42496
 v_mfma_f32_16x16x32_bf16 v[132:135], v[212:215], a[28:31], v[132:135]
 ds_read_b64_tr_b16 v[180:181], v15 offset:41248
 v_mfma_f32_16x16x32_bf16 v[96:99], v[216:219], a[24:27], v[96:99]
 ds_read_b64_tr_b16 v[182:183], v15 offset:42528
 v_mfma_f32_16x16x32_bf16 v[136:139], v[216:219], a[28:31], v[136:139]
 buffer_load_dwordx4 a[108:111], v6, s[16:19], s48 offen offset:128 sc1
 v_mfma_f32_16x16x32_bf16 v[100:103], v[220:223], a[24:27], v[100:103]
 s_add_u32 s48, s48, 132096
 v_mfma_f32_16x16x32_bf16 v[140:143], v[220:223], a[28:31], v[140:143]
 s_waitcnt lgkmcnt(0) vmcnt(48)
 v_mfma_f32_16x16x32_bf16 v[64:67], v[144:147], a[32:35], v[64:67]
 ds_read_b64_tr_b16 v[184:185], v14 offset:51200
 ds_read_b64_tr_b16 v[186:187], v14 offset:52480
 v_mfma_f32_16x16x32_bf16 v[104:107], v[144:147], a[36:39], v[104:107]
 ds_read_b64_tr_b16 v[188:189], v15 offset:51232
 v_mfma_f32_16x16x32_bf16 v[68:71], v[148:151], a[32:35], v[68:71]
 ds_read_b64_tr_b16 v[190:191], v15 offset:52512
 v_mfma_f32_16x16x32_bf16 v[108:111], v[148:151], a[36:39], v[108:111]
 ds_read_b64_tr_b16 v[192:193], v14 offset:51264
 v_mfma_f32_16x16x32_bf16 v[72:75], v[152:155], a[32:35], v[72:75]
 ds_read_b64_tr_b16 v[194:195], v14 offset:52544
 v_mfma_f32_16x16x32_bf16 v[112:115], v[152:155], a[36:39], v[112:115]
 ds_read_b64_tr_b16 v[196:197], v15 offset:51296
 ds_read_b64_tr_b16 v[198:199], v15 offset:52576
 v_mfma_f32_16x16x32_bf16 v[76:79], v[156:159], a[32:35], v[76:79]
 ds_read_b64_tr_b16 v[200:201], v14 offset:51328
 v_mfma_f32_16x16x32_bf16 v[116:119], v[156:159], a[36:39], v[116:119]
 ds_read_b64_tr_b16 v[202:203], v14 offset:52608
 v_mfma_f32_16x16x32_bf16 v[80:83], v[160:163], a[32:35], v[80:83]
 ds_read_b64_tr_b16 v[204:205], v15 offset:51360
 v_mfma_f32_16x16x32_bf16 v[120:123], v[160:163], a[36:39], v[120:123]
 ds_read_b64_tr_b16 v[206:207], v15 offset:52640
 v_mfma_f32_16x16x32_bf16 v[84:87], v[164:167], a[32:35], v[84:87]
 ds_read_b64_tr_b16 v[208:209], v14 offset:51392
 v_mfma_f32_16x16x32_bf16 v[124:127], v[164:167], a[36:39], v[124:127]
 ds_read_b64_tr_b16 v[210:211], v14 offset:52672
 ds_read_b64_tr_b16 v[212:213], v15 offset:51424
 v_mfma_f32_16x16x32_bf16 v[88:91], v[168:171], a[32:35], v[88:91]
 ds_read_b64_tr_b16 v[214:215], v15 offset:52704
 v_mfma_f32_16x16x32_bf16 v[128:131], v[168:171], a[36:39], v[128:131]
 buffer_load_dwordx4 a[112:115], v6, s[16:19], s48 offen offset:0 sc1
 ds_read_b64_tr_b16 v[216:217], v14 offset:51456
 v_mfma_f32_16x16x32_bf16 v[92:95], v[172:175], a[32:35], v[92:95]
 ds_read_b64_tr_b16 v[218:219], v14 offset:52736
 v_mfma_f32_16x16x32_bf16 v[132:135], v[172:175], a[36:39], v[132:135]
 ds_read_b64_tr_b16 v[220:221], v15 offset:51488
 v_mfma_f32_16x16x32_bf16 v[96:99], v[176:179], a[32:35], v[96:99]
 ds_read_b64_tr_b16 v[222:223], v15 offset:52768
 v_mfma_f32_16x16x32_bf16 v[136:139], v[176:179], a[36:39], v[136:139]
 buffer_load_dwordx4 a[116:119], v6, s[16:19], s48 offen offset:128 sc1
 v_mfma_f32_16x16x32_bf16 v[100:103], v[180:183], a[32:35], v[100:103]
 s_add_u32 s48, s48, 132096
 v_mfma_f32_16x16x32_bf16 v[140:143], v[180:183], a[36:39], v[140:143]
 s_waitcnt lgkmcnt(0) vmcnt(43)
 s_barrier
 v_mfma_f32_16x16x32_bf16 v[64:67], v[184:187], a[40:43], v[64:67]
 s_add_u32 m0, s46, 40960
 ds_read_b64_tr_b16 v[144:145], v16 offset:0
 ds_read_b64_tr_b16 v[146:147], v16 offset:1280
 v_mfma_f32_16x16x32_bf16 v[104:107], v[184:187], a[44:47], v[104:107]
 s_add_u32 s49, s45, 737280
 ds_read_b64_tr_b16 v[148:149], v17 offset:32
 v_mfma_f32_16x16x32_bf16 v[68:71], v[188:191], a[40:43], v[68:71]
 buffer_load_dwordx4 v8, s[24:27], s49 offen lds
 ds_read_b64_tr_b16 v[150:151], v17 offset:1312
 v_mfma_f32_16x16x32_bf16 v[108:111], v[188:191], a[44:47], v[108:111]
 s_add_u32 m0, s46, 41984
 ds_read_b64_tr_b16 v[152:153], v16 offset:64
 v_mfma_f32_16x16x32_bf16 v[72:75], v[192:195], a[40:43], v[72:75]
 buffer_load_dwordx4 v9, s[24:27], s49 offen lds
 ds_read_b64_tr_b16 v[154:155], v16 offset:1344
 v_mfma_f32_16x16x32_bf16 v[112:115], v[192:195], a[44:47], v[112:115]
 s_add_u32 m0, s46, 43008
 ds_read_b64_tr_b16 v[156:157], v17 offset:96
 ds_read_b64_tr_b16 v[158:159], v17 offset:1376
 v_mfma_f32_16x16x32_bf16 v[76:79], v[196:199], a[40:43], v[76:79]
 buffer_load_dwordx4 v10, s[24:27], s49 offen lds
 ds_read_b64_tr_b16 v[160:161], v16 offset:128
 v_mfma_f32_16x16x32_bf16 v[116:119], v[196:199], a[44:47], v[116:119]
 s_add_u32 m0, s46, 44032
 ds_read_b64_tr_b16 v[162:163], v16 offset:1408
 v_mfma_f32_16x16x32_bf16 v[80:83], v[200:203], a[40:43], v[80:83]
 buffer_load_dwordx4 v11, s[24:27], s49 offen lds
 ds_read_b64_tr_b16 v[164:165], v17 offset:160
 v_mfma_f32_16x16x32_bf16 v[120:123], v[200:203], a[44:47], v[120:123]
 s_add_u32 m0, s46, 45056
 ds_read_b64_tr_b16 v[166:167], v17 offset:1440
 v_mfma_f32_16x16x32_bf16 v[84:87], v[204:207], a[40:43], v[84:87]
 buffer_load_dwordx4 v12, s[24:27], s49 offen lds
 ds_read_b64_tr_b16 v[168:169], v16 offset:192
 v_mfma_f32_16x16x32_bf16 v[124:127], v[204:207], a[44:47], v[124:127]
 ds_read_b64_tr_b16 v[170:171], v16 offset:1472
 ds_read_b64_tr_b16 v[172:173], v17 offset:224
 v_mfma_f32_16x16x32_bf16 v[88:91], v[208:211], a[40:43], v[88:91]
 ds_read_b64_tr_b16 v[174:175], v17 offset:1504
 v_mfma_f32_16x16x32_bf16 v[128:131], v[208:211], a[44:47], v[128:131]
 buffer_load_dwordx4 a[120:123], v6, s[16:19], s48 offen offset:0 sc1
 ds_read_b64_tr_b16 v[176:177], v16 offset:256
 v_mfma_f32_16x16x32_bf16 v[92:95], v[212:215], a[40:43], v[92:95]
 ds_read_b64_tr_b16 v[178:179], v16 offset:1536
 v_mfma_f32_16x16x32_bf16 v[132:135], v[212:215], a[44:47], v[132:135]
 ds_read_b64_tr_b16 v[180:181], v17 offset:288
 v_mfma_f32_16x16x32_bf16 v[96:99], v[216:219], a[40:43], v[96:99]
 ds_read_b64_tr_b16 v[182:183], v17 offset:1568
 v_mfma_f32_16x16x32_bf16 v[136:139], v[216:219], a[44:47], v[136:139]
 buffer_load_dwordx4 a[124:127], v6, s[16:19], s48 offen offset:128 sc1
 v_mfma_f32_16x16x32_bf16 v[100:103], v[220:223], a[40:43], v[100:103]
 s_add_u32 s48, s48, 132096
 v_mfma_f32_16x16x32_bf16 v[140:143], v[220:223], a[44:47], v[140:143]
 s_waitcnt lgkmcnt(0) vmcnt(48)
 v_mfma_f32_16x16x32_bf16 v[64:67], v[144:147], a[48:51], v[64:67]
 ds_read_b64_tr_b16 v[184:185], v16 offset:10240
 ds_read_b64_tr_b16 v[186:187], v16 offset:11520
 v_mfma_f32_16x16x32_bf16 v[104:107], v[144:147], a[52:55], v[104:107]
 ds_read_b64_tr_b16 v[188:189], v17 offset:10272
 v_mfma_f32_16x16x32_bf16 v[68:71], v[148:151], a[48:51], v[68:71]
 ds_read_b64_tr_b16 v[190:191], v17 offset:11552
 v_mfma_f32_16x16x32_bf16 v[108:111], v[148:151], a[52:55], v[108:111]
 ds_read_b64_tr_b16 v[192:193], v16 offset:10304
 v_mfma_f32_16x16x32_bf16 v[72:75], v[152:155], a[48:51], v[72:75]
 ds_read_b64_tr_b16 v[194:195], v16 offset:11584
 v_mfma_f32_16x16x32_bf16 v[112:115], v[152:155], a[52:55], v[112:115]
 ds_read_b64_tr_b16 v[196:197], v17 offset:10336
 ds_read_b64_tr_b16 v[198:199], v17 offset:11616
 v_mfma_f32_16x16x32_bf16 v[76:79], v[156:159], a[48:51], v[76:79]
 ds_read_b64_tr_b16 v[200:201], v16 offset:10368
 v_mfma_f32_16x16x32_bf16 v[116:119], v[156:159], a[52:55], v[116:119]
 ds_read_b64_tr_b16 v[202:203], v16 offset:11648
 v_mfma_f32_16x16x32_bf16 v[80:83], v[160:163], a[48:51], v[80:83]
 ds_read_b64_tr_b16 v[204:205], v17 offset:10400
 v_mfma_f32_16x16x32_bf16 v[120:123], v[160:163], a[52:55], v[120:123]
 ds_read_b64_tr_b16 v[206:207], v17 offset:11680
 v_mfma_f32_16x16x32_bf16 v[84:87], v[164:167], a[48:51], v[84:87]
 ds_read_b64_tr_b16 v[208:209], v16 offset:10432
 v_mfma_f32_16x16x32_bf16 v[124:127], v[164:167], a[52:55], v[124:127]
 ds_read_b64_tr_b16 v[210:211], v16 offset:11712
 ds_read_b64_tr_b16 v[212:213], v17 offset:10464
 v_mfma_f32_16x16x32_bf16 v[88:91], v[168:171], a[48:51], v[88:91]
 ds_read_b64_tr_b16 v[214:215], v17 offset:11744
 v_mfma_f32_16x16x32_bf16 v[128:131], v[168:171], a[52:55], v[128:131]
 buffer_load_dwordx4 a[128:131], v6, s[16:19], s48 offen offset:0 sc1
 ds_read_b64_tr_b16 v[216:217], v16 offset:10496
 v_mfma_f32_16x16x32_bf16 v[92:95], v[172:175], a[48:51], v[92:95]
 ds_read_b64_tr_b16 v[218:219], v16 offset:11776
 v_mfma_f32_16x16x32_bf16 v[132:135], v[172:175], a[52:55], v[132:135]
 ds_read_b64_tr_b16 v[220:221], v17 offset:10528
 v_mfma_f32_16x16x32_bf16 v[96:99], v[176:179], a[48:51], v[96:99]
 ds_read_b64_tr_b16 v[222:223], v17 offset:11808
 v_mfma_f32_16x16x32_bf16 v[136:139], v[176:179], a[52:55], v[136:139]
 buffer_load_dwordx4 a[132:135], v6, s[16:19], s48 offen offset:128 sc1
 v_mfma_f32_16x16x32_bf16 v[100:103], v[180:183], a[48:51], v[100:103]
 s_add_u32 s48, s48, 132096
 v_mfma_f32_16x16x32_bf16 v[140:143], v[180:183], a[52:55], v[140:143]
 s_waitcnt lgkmcnt(0) vmcnt(43)
 s_barrier
 v_mfma_f32_16x16x32_bf16 v[64:67], v[184:187], a[56:59], v[64:67]
 ds_read_b64_tr_b16 v[144:145], v16 offset:20480
 ds_read_b64_tr_b16 v[146:147], v16 offset:21760
 v_mfma_f32_16x16x32_bf16 v[104:107], v[184:187], a[60:63], v[104:107]
 ds_read_b64_tr_b16 v[148:149], v17 offset:20512
 v_mfma_f32_16x16x32_bf16 v[68:71], v[188:191], a[56:59], v[68:71]
 ds_read_b64_tr_b16 v[150:151], v17 offset:21792
 v_mfma_f32_16x16x32_bf16 v[108:111], v[188:191], a[60:63], v[108:111]
 ds_read_b64_tr_b16 v[152:153], v16 offset:20544
 v_mfma_f32_16x16x32_bf16 v[72:75], v[192:195], a[56:59], v[72:75]
 ds_read_b64_tr_b16 v[154:155], v16 offset:21824
 v_mfma_f32_16x16x32_bf16 v[112:115], v[192:195], a[60:63], v[112:115]
 ds_read_b64_tr_b16 v[156:157], v17 offset:20576
 ds_read_b64_tr_b16 v[158:159], v17 offset:21856
 v_mfma_f32_16x16x32_bf16 v[76:79], v[196:199], a[56:59], v[76:79]
 ds_read_b64_tr_b16 v[160:161], v16 offset:20608
 v_mfma_f32_16x16x32_bf16 v[116:119], v[196:199], a[60:63], v[116:119]
 ds_read_b64_tr_b16 v[162:163], v16 offset:21888
 v_mfma_f32_16x16x32_bf16 v[80:83], v[200:203], a[56:59], v[80:83]
 ds_read_b64_tr_b16 v[164:165], v17 offset:20640
 v_mfma_f32_16x16x32_bf16 v[120:123], v[200:203], a[60:63], v[120:123]
 ds_read_b64_tr_b16 v[166:167], v17 offset:21920
 v_mfma_f32_16x16x32_bf16 v[84:87], v[204:207], a[56:59], v[84:87]
 ds_read_b64_tr_b16 v[168:169], v16 offset:20672
 v_mfma_f32_16x16x32_bf16 v[124:127], v[204:207], a[60:63], v[124:127]
 ds_read_b64_tr_b16 v[170:171], v16 offset:21952
 ds_read_b64_tr_b16 v[172:173], v17 offset:20704
 v_mfma_f32_16x16x32_bf16 v[88:91], v[208:211], a[56:59], v[88:91]
 ds_read_b64_tr_b16 v[174:175], v17 offset:21984
 v_mfma_f32_16x16x32_bf16 v[128:131], v[208:211], a[60:63], v[128:131]
 buffer_load_dwordx4 a[136:139], v6, s[16:19], s48 offen offset:0 sc1
 ds_read_b64_tr_b16 v[176:177], v16 offset:20736
 v_mfma_f32_16x16x32_bf16 v[92:95], v[212:215], a[56:59], v[92:95]
 ds_read_b64_tr_b16 v[178:179], v16 offset:22016
 v_mfma_f32_16x16x32_bf16 v[132:135], v[212:215], a[60:63], v[132:135]
 ds_read_b64_tr_b16 v[180:181], v17 offset:20768
 v_mfma_f32_16x16x32_bf16 v[96:99], v[216:219], a[56:59], v[96:99]
 ds_read_b64_tr_b16 v[182:183], v17 offset:22048
 v_mfma_f32_16x16x32_bf16 v[136:139], v[216:219], a[60:63], v[136:139]
 buffer_load_dwordx4 a[140:143], v6, s[16:19], s48 offen offset:128 sc1
 v_mfma_f32_16x16x32_bf16 v[100:103], v[220:223], a[56:59], v[100:103]
 s_add_u32 s48, s48, 132096
 v_mfma_f32_16x16x32_bf16 v[140:143], v[220:223], a[60:63], v[140:143]
 s_waitcnt lgkmcnt(0) vmcnt(43)
 v_mfma_f32_16x16x32_bf16 v[64:67], v[144:147], a[64:67], v[64:67]
 ds_read_b64_tr_b16 v[184:185], v16 offset:30720
 ds_read_b64_tr_b16 v[186:187], v16 offset:32000
 v_mfma_f32_16x16x32_bf16 v[104:107], v[144:147], a[68:71], v[104:107]
 ds_read_b64_tr_b16 v[188:189], v17 offset:30752
 v_mfma_f32_16x16x32_bf16 v[68:71], v[148:151], a[64:67], v[68:71]
 ds_read_b64_tr_b16 v[190:191], v17 offset:32032
 v_mfma_f32_16x16x32_bf16 v[108:111], v[148:151], a[68:71], v[108:111]
 ds_read_b64_tr_b16 v[192:193], v16 offset:30784
 v_mfma_f32_16x16x32_bf16 v[72:75], v[152:155], a[64:67], v[72:75]
 ds_read_b64_tr_b16 v[194:195], v16 offset:32064
 v_mfma_f32_16x16x32_bf16 v[112:115], v[152:155], a[68:71], v[112:115]
 ds_read_b64_tr_b16 v[196:197], v17 offset:30816
 ds_read_b64_tr_b16 v[198:199], v17 offset:32096
 v_mfma_f32_16x16x32_bf16 v[76:79], v[156:159], a[64:67], v[76:79]
 ds_read_b64_tr_b16 v[200:201], v16 offset:30848
 v_mfma_f32_16x16x32_bf16 v[116:119], v[156:159], a[68:71], v[116:119]
 ds_read_b64_tr_b16 v[202:203], v16 offset:32128
 v_mfma_f32_16x16x32_bf16 v[80:83], v[160:163], a[64:67], v[80:83]
 ds_read_b64_tr_b16 v[204:205], v17 offset:30880
 v_mfma_f32_16x16x32_bf16 v[120:123], v[160:163], a[68:71], v[120:123]
 ds_read_b64_tr_b16 v[206:207], v17 offset:32160
 v_mfma_f32_16x16x32_bf16 v[84:87], v[164:167], a[64:67], v[84:87]
 ds_read_b64_tr_b16 v[208:209], v16 offset:30912
 v_mfma_f32_16x16x32_bf16 v[124:127], v[164:167], a[68:71], v[124:127]
 ds_read_b64_tr_b16 v[210:211], v16 offset:32192
 ds_read_b64_tr_b16 v[212:213], v17 offset:30944
 v_mfma_f32_16x16x32_bf16 v[88:91], v[168:171], a[64:67], v[88:91]
 ds_read_b64_tr_b16 v[214:215], v17 offset:32224
 v_mfma_f32_16x16x32_bf16 v[128:131], v[168:171], a[68:71], v[128:131]
 buffer_load_dwordx4 a[144:147], v6, s[16:19], s48 offen offset:0 sc1
 ds_read_b64_tr_b16 v[216:217], v16 offset:30976
 v_mfma_f32_16x16x32_bf16 v[92:95], v[172:175], a[64:67], v[92:95]
 ds_read_b64_tr_b16 v[218:219], v16 offset:32256
 v_mfma_f32_16x16x32_bf16 v[132:135], v[172:175], a[68:71], v[132:135]
 ds_read_b64_tr_b16 v[220:221], v17 offset:31008
 v_mfma_f32_16x16x32_bf16 v[96:99], v[176:179], a[64:67], v[96:99]
 ds_read_b64_tr_b16 v[222:223], v17 offset:32288
 v_mfma_f32_16x16x32_bf16 v[136:139], v[176:179], a[68:71], v[136:139]
 buffer_load_dwordx4 a[148:151], v6, s[16:19], s48 offen offset:128 sc1
 v_mfma_f32_16x16x32_bf16 v[100:103], v[180:183], a[64:67], v[100:103]
 s_add_u32 s48, s48, 132096
 v_mfma_f32_16x16x32_bf16 v[140:143], v[180:183], a[68:71], v[140:143]
 s_waitcnt lgkmcnt(0) vmcnt(38)
 s_barrier
 v_mfma_f32_16x16x32_bf16 v[64:67], v[184:187], a[72:75], v[64:67]
 ds_read_b64_tr_b16 v[144:145], v16 offset:40960
 ds_read_b64_tr_b16 v[146:147], v16 offset:42240
 v_mfma_f32_16x16x32_bf16 v[104:107], v[184:187], a[76:79], v[104:107]
 ds_read_b64_tr_b16 v[148:149], v17 offset:40992
 v_mfma_f32_16x16x32_bf16 v[68:71], v[188:191], a[72:75], v[68:71]
 ds_read_b64_tr_b16 v[150:151], v17 offset:42272
 v_mfma_f32_16x16x32_bf16 v[108:111], v[188:191], a[76:79], v[108:111]
 ds_read_b64_tr_b16 v[152:153], v16 offset:41024
 v_mfma_f32_16x16x32_bf16 v[72:75], v[192:195], a[72:75], v[72:75]
 ds_read_b64_tr_b16 v[154:155], v16 offset:42304
 v_mfma_f32_16x16x32_bf16 v[112:115], v[192:195], a[76:79], v[112:115]
 ds_read_b64_tr_b16 v[156:157], v17 offset:41056
 ds_read_b64_tr_b16 v[158:159], v17 offset:42336
 v_mfma_f32_16x16x32_bf16 v[76:79], v[196:199], a[72:75], v[76:79]
 ds_read_b64_tr_b16 v[160:161], v16 offset:41088
 v_mfma_f32_16x16x32_bf16 v[116:119], v[196:199], a[76:79], v[116:119]
 ds_read_b64_tr_b16 v[162:163], v16 offset:42368
 v_mfma_f32_16x16x32_bf16 v[80:83], v[200:203], a[72:75], v[80:83]
 ds_read_b64_tr_b16 v[164:165], v17 offset:41120
 v_mfma_f32_16x16x32_bf16 v[120:123], v[200:203], a[76:79], v[120:123]
 ds_read_b64_tr_b16 v[166:167], v17 offset:42400
 v_mfma_f32_16x16x32_bf16 v[84:87], v[204:207], a[72:75], v[84:87]
 ds_read_b64_tr_b16 v[168:169], v16 offset:41152
 v_mfma_f32_16x16x32_bf16 v[124:127], v[204:207], a[76:79], v[124:127]
 ds_read_b64_tr_b16 v[170:171], v16 offset:42432
 ds_read_b64_tr_b16 v[172:173], v17 offset:41184
 v_mfma_f32_16x16x32_bf16 v[88:91], v[208:211], a[72:75], v[88:91]
 ds_read_b64_tr_b16 v[174:175], v17 offset:42464
 v_mfma_f32_16x16x32_bf16 v[128:131], v[208:211], a[76:79], v[128:131]
 buffer_load_dwordx4 a[152:155], v6, s[16:19], s48 offen offset:0 sc1
 ds_read_b64_tr_b16 v[176:177], v16 offset:41216
 v_mfma_f32_16x16x32_bf16 v[92:95], v[212:215], a[72:75], v[92:95]
 ds_read_b64_tr_b16 v[178:179], v16 offset:42496
 v_mfma_f32_16x16x32_bf16 v[132:135], v[212:215], a[76:79], v[132:135]
 ds_read_b64_tr_b16 v[180:181], v17 offset:41248
 v_mfma_f32_16x16x32_bf16 v[96:99], v[216:219], a[72:75], v[96:99]
 ds_read_b64_tr_b16 v[182:183], v17 offset:42528
 v_mfma_f32_16x16x32_bf16 v[136:139], v[216:219], a[76:79], v[136:139]
 buffer_load_dwordx4 a[156:159], v6, s[16:19], s48 offen offset:128 sc1
 v_mfma_f32_16x16x32_bf16 v[100:103], v[220:223], a[72:75], v[100:103]
 s_add_u32 s48, s48, 132096
 v_mfma_f32_16x16x32_bf16 v[140:143], v[220:223], a[76:79], v[140:143]
 s_waitcnt lgkmcnt(0) vmcnt(33)
 v_mfma_f32_16x16x32_bf16 v[64:67], v[144:147], a[80:83], v[64:67]
 ds_read_b64_tr_b16 v[184:185], v16 offset:51200
 ds_read_b64_tr_b16 v[186:187], v16 offset:52480
 v_mfma_f32_16x16x32_bf16 v[104:107], v[144:147], a[84:87], v[104:107]
 ds_read_b64_tr_b16 v[188:189], v17 offset:51232
 v_mfma_f32_16x16x32_bf16 v[68:71], v[148:151], a[80:83], v[68:71]
 ds_read_b64_tr_b16 v[190:191], v17 offset:52512
 v_mfma_f32_16x16x32_bf16 v[108:111], v[148:151], a[84:87], v[108:111]
 ds_read_b64_tr_b16 v[192:193], v16 offset:51264
 v_mfma_f32_16x16x32_bf16 v[72:75], v[152:155], a[80:83], v[72:75]
 ds_read_b64_tr_b16 v[194:195], v16 offset:52544
 v_mfma_f32_16x16x32_bf16 v[112:115], v[152:155], a[84:87], v[112:115]
 ds_read_b64_tr_b16 v[196:197], v17 offset:51296
 ds_read_b64_tr_b16 v[198:199], v17 offset:52576
 v_mfma_f32_16x16x32_bf16 v[76:79], v[156:159], a[80:83], v[76:79]
 ds_read_b64_tr_b16 v[200:201], v16 offset:51328
 v_mfma_f32_16x16x32_bf16 v[116:119], v[156:159], a[84:87], v[116:119]
 ds_read_b64_tr_b16 v[202:203], v16 offset:52608
 v_mfma_f32_16x16x32_bf16 v[80:83], v[160:163], a[80:83], v[80:83]
 ds_read_b64_tr_b16 v[204:205], v17 offset:51360
 v_mfma_f32_16x16x32_bf16 v[120:123], v[160:163], a[84:87], v[120:123]
 ds_read_b64_tr_b16 v[206:207], v17 offset:52640
 v_mfma_f32_16x16x32_bf16 v[84:87], v[164:167], a[80:83], v[84:87]
 ds_read_b64_tr_b16 v[208:209], v16 offset:51392
 v_mfma_f32_16x16x32_bf16 v[124:127], v[164:167], a[84:87], v[124:127]
 ds_read_b64_tr_b16 v[210:211], v16 offset:52672
 ds_read_b64_tr_b16 v[212:213], v17 offset:51424
 v_mfma_f32_16x16x32_bf16 v[88:91], v[168:171], a[80:83], v[88:91]
 ds_read_b64_tr_b16 v[214:215], v17 offset:52704
 v_mfma_f32_16x16x32_bf16 v[128:131], v[168:171], a[84:87], v[128:131]
 ds_read_b64_tr_b16 v[216:217], v16 offset:51456
 v_mfma_f32_16x16x32_bf16 v[92:95], v[172:175], a[80:83], v[92:95]
 ds_read_b64_tr_b16 v[218:219], v16 offset:52736
 v_mfma_f32_16x16x32_bf16 v[132:135], v[172:175], a[84:87], v[132:135]
 ds_read_b64_tr_b16 v[220:221], v17 offset:51488
 v_mfma_f32_16x16x32_bf16 v[96:99], v[176:179], a[80:83], v[96:99]
 ds_read_b64_tr_b16 v[222:223], v17 offset:52768
 v_mfma_f32_16x16x32_bf16 v[136:139], v[176:179], a[84:87], v[136:139]
 v_mfma_f32_16x16x32_bf16 v[100:103], v[180:183], a[80:83], v[100:103]
 v_mfma_f32_16x16x32_bf16 v[140:143], v[180:183], a[84:87], v[140:143]
 s_waitcnt lgkmcnt(0) vmcnt(26)
 s_barrier
 v_mfma_f32_16x16x32_bf16 v[64:67], v[184:187], a[88:91], v[64:67]
 ds_read_b64_tr_b16 v[144:145], v18 offset:0
 ds_read_b64_tr_b16 v[146:147], v18 offset:1280
 v_mfma_f32_16x16x32_bf16 v[104:107], v[184:187], a[92:95], v[104:107]
 ds_read_b64_tr_b16 v[148:149], v19 offset:32
 v_mfma_f32_16x16x32_bf16 v[68:71], v[188:191], a[88:91], v[68:71]
 ds_read_b64_tr_b16 v[150:151], v19 offset:1312
 v_mfma_f32_16x16x32_bf16 v[108:111], v[188:191], a[92:95], v[108:111]
 ds_read_b64_tr_b16 v[152:153], v18 offset:64
 v_mfma_f32_16x16x32_bf16 v[72:75], v[192:195], a[88:91], v[72:75]
 ds_read_b64_tr_b16 v[154:155], v18 offset:1344
 v_mfma_f32_16x16x32_bf16 v[112:115], v[192:195], a[92:95], v[112:115]
 ds_read_b64_tr_b16 v[156:157], v19 offset:96
 ds_read_b64_tr_b16 v[158:159], v19 offset:1376
 v_mfma_f32_16x16x32_bf16 v[76:79], v[196:199], a[88:91], v[76:79]
 ds_read_b64_tr_b16 v[160:161], v18 offset:128
 v_mfma_f32_16x16x32_bf16 v[116:119], v[196:199], a[92:95], v[116:119]
 ds_read_b64_tr_b16 v[162:163], v18 offset:1408
 v_mfma_f32_16x16x32_bf16 v[80:83], v[200:203], a[88:91], v[80:83]
 ds_read_b64_tr_b16 v[164:165], v19 offset:160
 v_mfma_f32_16x16x32_bf16 v[120:123], v[200:203], a[92:95], v[120:123]
 ds_read_b64_tr_b16 v[166:167], v19 offset:1440
 v_mfma_f32_16x16x32_bf16 v[84:87], v[204:207], a[88:91], v[84:87]
 ds_read_b64_tr_b16 v[168:169], v18 offset:192
 v_mfma_f32_16x16x32_bf16 v[124:127], v[204:207], a[92:95], v[124:127]
 ds_read_b64_tr_b16 v[170:171], v18 offset:1472
 ds_read_b64_tr_b16 v[172:173], v19 offset:224
 v_mfma_f32_16x16x32_bf16 v[88:91], v[208:211], a[88:91], v[88:91]
 ds_read_b64_tr_b16 v[174:175], v19 offset:1504
 v_mfma_f32_16x16x32_bf16 v[128:131], v[208:211], a[92:95], v[128:131]
 ds_read_b64_tr_b16 v[176:177], v18 offset:256
 v_mfma_f32_16x16x32_bf16 v[92:95], v[212:215], a[88:91], v[92:95]
 ds_read_b64_tr_b16 v[178:179], v18 offset:1536
 v_mfma_f32_16x16x32_bf16 v[132:135], v[212:215], a[92:95], v[132:135]
 ds_read_b64_tr_b16 v[180:181], v19 offset:288
 v_mfma_f32_16x16x32_bf16 v[96:99], v[216:219], a[88:91], v[96:99]
 ds_read_b64_tr_b16 v[182:183], v19 offset:1568
 v_mfma_f32_16x16x32_bf16 v[136:139], v[216:219], a[92:95], v[136:139]
 v_mfma_f32_16x16x32_bf16 v[100:103], v[220:223], a[88:91], v[100:103]
 v_mfma_f32_16x16x32_bf16 v[140:143], v[220:223], a[92:95], v[140:143]
 s_waitcnt lgkmcnt(0) vmcnt(24)
 v_mfma_f32_16x16x32_bf16 v[64:67], v[144:147], a[96:99], v[64:67]
 ds_read_b64_tr_b16 v[184:185], v18 offset:10240
 ds_read_b64_tr_b16 v[186:187], v18 offset:11520
 v_mfma_f32_16x16x32_bf16 v[104:107], v[144:147], a[100:103], v[104:107]
 ds_read_b64_tr_b16 v[188:189], v19 offset:10272
 v_mfma_f32_16x16x32_bf16 v[68:71], v[148:151], a[96:99], v[68:71]
 ds_read_b64_tr_b16 v[190:191], v19 offset:11552
 v_mfma_f32_16x16x32_bf16 v[108:111], v[148:151], a[100:103], v[108:111]
 ds_read_b64_tr_b16 v[192:193], v18 offset:10304
 v_mfma_f32_16x16x32_bf16 v[72:75], v[152:155], a[96:99], v[72:75]
 ds_read_b64_tr_b16 v[194:195], v18 offset:11584
 v_mfma_f32_16x16x32_bf16 v[112:115], v[152:155], a[100:103], v[112:115]
 ds_read_b64_tr_b16 v[196:197], v19 offset:10336
 ds_read_b64_tr_b16 v[198:199], v19 offset:11616
 v_mfma_f32_16x16x32_bf16 v[76:79], v[156:159], a[96:99], v[76:79]
 ds_read_b64_tr_b16 v[200:201], v18 offset:10368
 v_mfma_f32_16x16x32_bf16 v[116:119], v[156:159], a[100:103], v[116:119]
 ds_read_b64_tr_b16 v[202:203], v18 offset:11648
 v_mfma_f32_16x16x32_bf16 v[80:83], v[160:163], a[96:99], v[80:83]
 ds_read_b64_tr_b16 v[204:205], v19 offset:10400
 v_mfma_f32_16x16x32_bf16 v[120:123], v[160:163], a[100:103], v[120:123]
 ds_read_b64_tr_b16 v[206:207], v19 offset:11680
 v_mfma_f32_16x16x32_bf16 v[84:87], v[164:167], a[96:99], v[84:87]
 ds_read_b64_tr_b16 v[208:209], v18 offset:10432
 v_mfma_f32_16x16x32_bf16 v[124:127], v[164:167], a[100:103], v[124:127]
 ds_read_b64_tr_b16 v[210:211], v18 offset:11712
 ds_read_b64_tr_b16 v[212:213], v19 offset:10464
 v_mfma_f32_16x16x32_bf16 v[88:91], v[168:171], a[96:99], v[88:91]
 ds_read_b64_tr_b16 v[214:215], v19 offset:11744
 v_mfma_f32_16x16x32_bf16 v[128:131], v[168:171], a[100:103], v[128:131]
 ds_read_b64_tr_b16 v[216:217], v18 offset:10496
 v_mfma_f32_16x16x32_bf16 v[92:95], v[172:175], a[96:99], v[92:95]
 ds_read_b64_tr_b16 v[218:219], v18 offset:11776
 v_mfma_f32_16x16x32_bf16 v[132:135], v[172:175], a[100:103], v[132:135]
 ds_read_b64_tr_b16 v[220:221], v19 offset:10528
 v_mfma_f32_16x16x32_bf16 v[96:99], v[176:179], a[96:99], v[96:99]
 ds_read_b64_tr_b16 v[222:223], v19 offset:11808
 v_mfma_f32_16x16x32_bf16 v[136:139], v[176:179], a[100:103], v[136:139]
 v_mfma_f32_16x16x32_bf16 v[100:103], v[180:183], a[96:99], v[100:103]
 v_mfma_f32_16x16x32_bf16 v[140:143], v[180:183], a[100:103], v[140:143]
 s_waitcnt lgkmcnt(0) vmcnt(17)
 s_barrier
 v_mfma_f32_16x16x32_bf16 v[64:67], v[184:187], a[104:107], v[64:67]
 ds_read_b64_tr_b16 v[144:145], v14 offset:0
 ds_read_b64_tr_b16 v[146:147], v14 offset:1280
 v_mfma_f32_16x16x32_bf16 v[104:107], v[184:187], a[108:111], v[104:107]
 ds_read_b64_tr_b16 v[148:149], v15 offset:32
 v_mfma_f32_16x16x32_bf16 v[68:71], v[188:191], a[104:107], v[68:71]
 ds_read_b64_tr_b16 v[150:151], v15 offset:1312
 v_mfma_f32_16x16x32_bf16 v[108:111], v[188:191], a[108:111], v[108:111]
 ds_read_b64_tr_b16 v[152:153], v14 offset:64
 v_mfma_f32_16x16x32_bf16 v[72:75], v[192:195], a[104:107], v[72:75]
 ds_read_b64_tr_b16 v[154:155], v14 offset:1344
 v_mfma_f32_16x16x32_bf16 v[112:115], v[192:195], a[108:111], v[112:115]
 ds_read_b64_tr_b16 v[156:157], v15 offset:96
 ds_read_b64_tr_b16 v[158:159], v15 offset:1376
 v_mfma_f32_16x16x32_bf16 v[76:79], v[196:199], a[104:107], v[76:79]
 ds_read_b64_tr_b16 v[160:161], v14 offset:128
 v_mfma_f32_16x16x32_bf16 v[116:119], v[196:199], a[108:111], v[116:119]
 ds_read_b64_tr_b16 v[162:163], v14 offset:1408
 v_mfma_f32_16x16x32_bf16 v[80:83], v[200:203], a[104:107], v[80:83]
 ds_read_b64_tr_b16 v[164:165], v15 offset:160
 v_mfma_f32_16x16x32_bf16 v[120:123], v[200:203], a[108:111], v[120:123]
 ds_read_b64_tr_b16 v[166:167], v15 offset:1440
 v_mfma_f32_16x16x32_bf16 v[84:87], v[204:207], a[104:107], v[84:87]
 ds_read_b64_tr_b16 v[168:169], v14 offset:192
 v_mfma_f32_16x16x32_bf16 v[124:127], v[204:207], a[108:111], v[124:127]
 ds_read_b64_tr_b16 v[170:171], v14 offset:1472
 ds_read_b64_tr_b16 v[172:173], v15 offset:224
 v_mfma_f32_16x16x32_bf16 v[88:91], v[208:211], a[104:107], v[88:91]
 ds_read_b64_tr_b16 v[174:175], v15 offset:1504
 v_mfma_f32_16x16x32_bf16 v[128:131], v[208:211], a[108:111], v[128:131]
 ds_read_b64_tr_b16 v[176:177], v14 offset:256
 v_mfma_f32_16x16x32_bf16 v[92:95], v[212:215], a[104:107], v[92:95]
 ds_read_b64_tr_b16 v[178:179], v14 offset:1536
 v_mfma_f32_16x16x32_bf16 v[132:135], v[212:215], a[108:111], v[132:135]
 ds_read_b64_tr_b16 v[180:181], v15 offset:288
 v_mfma_f32_16x16x32_bf16 v[96:99], v[216:219], a[104:107], v[96:99]
 ds_read_b64_tr_b16 v[182:183], v15 offset:1568
 v_mfma_f32_16x16x32_bf16 v[136:139], v[216:219], a[108:111], v[136:139]
 v_mfma_f32_16x16x32_bf16 v[100:103], v[220:223], a[104:107], v[100:103]
 v_mfma_f32_16x16x32_bf16 v[140:143], v[220:223], a[108:111], v[140:143]
 s_waitcnt lgkmcnt(0) vmcnt(15)
 v_mfma_f32_16x16x32_bf16 v[64:67], v[144:147], a[112:115], v[64:67]
 ds_read_b64_tr_b16 v[184:185], v14 offset:10240
 ds_read_b64_tr_b16 v[186:187], v14 offset:11520
 v_mfma_f32_16x16x32_bf16 v[104:107], v[144:147], a[116:119], v[104:107]
 ds_read_b64_tr_b16 v[188:189], v15 offset:10272
 v_mfma_f32_16x16x32_bf16 v[68:71], v[148:151], a[112:115], v[68:71]
 ds_read_b64_tr_b16 v[190:191], v15 offset:11552
 v_mfma_f32_16x16x32_bf16 v[108:111], v[148:151], a[116:119], v[108:111]
 ds_read_b64_tr_b16 v[192:193], v14 offset:10304
 v_mfma_f32_16x16x32_bf16 v[72:75], v[152:155], a[112:115], v[72:75]
 ds_read_b64_tr_b16 v[194:195], v14 offset:11584
 v_mfma_f32_16x16x32_bf16 v[112:115], v[152:155], a[116:119], v[112:115]
 ds_read_b64_tr_b16 v[196:197], v15 offset:10336
 ds_read_b64_tr_b16 v[198:199], v15 offset:11616
 v_mfma_f32_16x16x32_bf16 v[76:79], v[156:159], a[112:115], v[76:79]
 ds_read_b64_tr_b16 v[200:201], v14 offset:10368
 v_mfma_f32_16x16x32_bf16 v[116:119], v[156:159], a[116:119], v[116:119]
 ds_read_b64_tr_b16 v[202:203], v14 offset:11648
 v_mfma_f32_16x16x32_bf16 v[80:83], v[160:163], a[112:115], v[80:83]
 ds_read_b64_tr_b16 v[204:205], v15 offset:10400
 v_mfma_f32_16x16x32_bf16 v[120:123], v[160:163], a[116:119], v[120:123]
 ds_read_b64_tr_b16 v[206:207], v15 offset:11680
 v_mfma_f32_16x16x32_bf16 v[84:87], v[164:167], a[112:115], v[84:87]
 ds_read_b64_tr_b16 v[208:209], v14 offset:10432
 v_mfma_f32_16x16x32_bf16 v[124:127], v[164:167], a[116:119], v[124:127]
 ds_read_b64_tr_b16 v[210:211], v14 offset:11712
 ds_read_b64_tr_b16 v[212:213], v15 offset:10464
 v_mfma_f32_16x16x32_bf16 v[88:91], v[168:171], a[112:115], v[88:91]
 ds_read_b64_tr_b16 v[214:215], v15 offset:11744
 v_mfma_f32_16x16x32_bf16 v[128:131], v[168:171], a[116:119], v[128:131]
 ds_read_b64_tr_b16 v[216:217], v14 offset:10496
 v_mfma_f32_16x16x32_bf16 v[92:95], v[172:175], a[112:115], v[92:95]
 ds_read_b64_tr_b16 v[218:219], v14 offset:11776
 v_mfma_f32_16x16x32_bf16 v[132:135], v[172:175], a[116:119], v[132:135]
 ds_read_b64_tr_b16 v[220:221], v15 offset:10528
 v_mfma_f32_16x16x32_bf16 v[96:99], v[176:179], a[112:115], v[96:99]
 ds_read_b64_tr_b16 v[222:223], v15 offset:11808
 v_mfma_f32_16x16x32_bf16 v[136:139], v[176:179], a[116:119], v[136:139]
 v_mfma_f32_16x16x32_bf16 v[100:103], v[180:183], a[112:115], v[100:103]
 v_mfma_f32_16x16x32_bf16 v[140:143], v[180:183], a[116:119], v[140:143]
 s_waitcnt lgkmcnt(0) vmcnt(8)
 s_barrier
 v_mfma_f32_16x16x32_bf16 v[64:67], v[184:187], a[120:123], v[64:67]
 ds_read_b64_tr_b16 v[144:145], v14 offset:20480
 ds_read_b64_tr_b16 v[146:147], v14 offset:21760
 v_mfma_f32_16x16x32_bf16 v[104:107], v[184:187], a[124:127], v[104:107]
 ds_read_b64_tr_b16 v[148:149], v15 offset:20512
 v_mfma_f32_16x16x32_bf16 v[68:71], v[188:191], a[120:123], v[68:71]
 ds_read_b64_tr_b16 v[150:151], v15 offset:21792
 v_mfma_f32_16x16x32_bf16 v[108:111], v[188:191], a[124:127], v[108:111]
 ds_read_b64_tr_b16 v[152:153], v14 offset:20544
 v_mfma_f32_16x16x32_bf16 v[72:75], v[192:195], a[120:123], v[72:75]
 ds_read_b64_tr_b16 v[154:155], v14 offset:21824
 v_mfma_f32_16x16x32_bf16 v[112:115], v[192:195], a[124:127], v[112:115]
 ds_read_b64_tr_b16 v[156:157], v15 offset:20576
 ds_read_b64_tr_b16 v[158:159], v15 offset:21856
 v_mfma_f32_16x16x32_bf16 v[76:79], v[196:199], a[120:123], v[76:79]
 ds_read_b64_tr_b16 v[160:161], v14 offset:20608
 v_mfma_f32_16x16x32_bf16 v[116:119], v[196:199], a[124:127], v[116:119]
 ds_read_b64_tr_b16 v[162:163], v14 offset:21888
 v_mfma_f32_16x16x32_bf16 v[80:83], v[200:203], a[120:123], v[80:83]
 ds_read_b64_tr_b16 v[164:165], v15 offset:20640
 v_mfma_f32_16x16x32_bf16 v[120:123], v[200:203], a[124:127], v[120:123]
 ds_read_b64_tr_b16 v[166:167], v15 offset:21920
 v_mfma_f32_16x16x32_bf16 v[84:87], v[204:207], a[120:123], v[84:87]
 ds_read_b64_tr_b16 v[168:169], v14 offset:20672
 v_mfma_f32_16x16x32_bf16 v[124:127], v[204:207], a[124:127], v[124:127]
 ds_read_b64_tr_b16 v[170:171], v14 offset:21952
 ds_read_b64_tr_b16 v[172:173], v15 offset:20704
 v_mfma_f32_16x16x32_bf16 v[88:91], v[208:211], a[120:123], v[88:91]
 ds_read_b64_tr_b16 v[174:175], v15 offset:21984
 v_mfma_f32_16x16x32_bf16 v[128:131], v[208:211], a[124:127], v[128:131]
 ds_read_b64_tr_b16 v[176:177], v14 offset:20736
 v_mfma_f32_16x16x32_bf16 v[92:95], v[212:215], a[120:123], v[92:95]
 ds_read_b64_tr_b16 v[178:179], v14 offset:22016
 v_mfma_f32_16x16x32_bf16 v[132:135], v[212:215], a[124:127], v[132:135]
 ds_read_b64_tr_b16 v[180:181], v15 offset:20768
 v_mfma_f32_16x16x32_bf16 v[96:99], v[216:219], a[120:123], v[96:99]
 ds_read_b64_tr_b16 v[182:183], v15 offset:22048
 v_mfma_f32_16x16x32_bf16 v[136:139], v[216:219], a[124:127], v[136:139]
 v_mfma_f32_16x16x32_bf16 v[100:103], v[220:223], a[120:123], v[100:103]
 v_mfma_f32_16x16x32_bf16 v[140:143], v[220:223], a[124:127], v[140:143]
 s_waitcnt lgkmcnt(0) vmcnt(6)
 v_mfma_f32_16x16x32_bf16 v[64:67], v[144:147], a[128:131], v[64:67]
 ds_read_b64_tr_b16 v[184:185], v14 offset:30720
 ds_read_b64_tr_b16 v[186:187], v14 offset:32000
 v_mfma_f32_16x16x32_bf16 v[104:107], v[144:147], a[132:135], v[104:107]
 ds_read_b64_tr_b16 v[188:189], v15 offset:30752
 v_mfma_f32_16x16x32_bf16 v[68:71], v[148:151], a[128:131], v[68:71]
 ds_read_b64_tr_b16 v[190:191], v15 offset:32032
 v_mfma_f32_16x16x32_bf16 v[108:111], v[148:151], a[132:135], v[108:111]
 ds_read_b64_tr_b16 v[192:193], v14 offset:30784
 v_mfma_f32_16x16x32_bf16 v[72:75], v[152:155], a[128:131], v[72:75]
 ds_read_b64_tr_b16 v[194:195], v14 offset:32064
 v_mfma_f32_16x16x32_bf16 v[112:115], v[152:155], a[132:135], v[112:115]
 ds_read_b64_tr_b16 v[196:197], v15 offset:30816
 ds_read_b64_tr_b16 v[198:199], v15 offset:32096
 v_mfma_f32_16x16x32_bf16 v[76:79], v[156:159], a[128:131], v[76:79]
 ds_read_b64_tr_b16 v[200:201], v14 offset:30848
 v_mfma_f32_16x16x32_bf16 v[116:119], v[156:159], a[132:135], v[116:119]
 ds_read_b64_tr_b16 v[202:203], v14 offset:32128
 v_mfma_f32_16x16x32_bf16 v[80:83], v[160:163], a[128:131], v[80:83]
 ds_read_b64_tr_b16 v[204:205], v15 offset:30880
 v_mfma_f32_16x16x32_bf16 v[120:123], v[160:163], a[132:135], v[120:123]
 ds_read_b64_tr_b16 v[206:207], v15 offset:32160
 v_mfma_f32_16x16x32_bf16 v[84:87], v[164:167], a[128:131], v[84:87]
 ds_read_b64_tr_b16 v[208:209], v14 offset:30912
 v_mfma_f32_16x16x32_bf16 v[124:127], v[164:167], a[132:135], v[124:127]
 ds_read_b64_tr_b16 v[210:211], v14 offset:32192
 ds_read_b64_tr_b16 v[212:213], v15 offset:30944
 v_mfma_f32_16x16x32_bf16 v[88:91], v[168:171], a[128:131], v[88:91]
 ds_read_b64_tr_b16 v[214:215], v15 offset:32224
 v_mfma_f32_16x16x32_bf16 v[128:131], v[168:171], a[132:135], v[128:131]
 ds_read_b64_tr_b16 v[216:217], v14 offset:30976
 v_mfma_f32_16x16x32_bf16 v[92:95], v[172:175], a[128:131], v[92:95]
 ds_read_b64_tr_b16 v[218:219], v14 offset:32256
 v_mfma_f32_16x16x32_bf16 v[132:135], v[172:175], a[132:135], v[132:135]
 ds_read_b64_tr_b16 v[220:221], v15 offset:31008
 v_mfma_f32_16x16x32_bf16 v[96:99], v[176:179], a[128:131], v[96:99]
 ds_read_b64_tr_b16 v[222:223], v15 offset:32288
 v_mfma_f32_16x16x32_bf16 v[136:139], v[176:179], a[132:135], v[136:139]
 v_mfma_f32_16x16x32_bf16 v[100:103], v[180:183], a[128:131], v[100:103]
 v_mfma_f32_16x16x32_bf16 v[140:143], v[180:183], a[132:135], v[140:143]
 s_waitcnt lgkmcnt(0) vmcnt(4)
 s_barrier
 v_mfma_f32_16x16x32_bf16 v[64:67], v[184:187], a[136:139], v[64:67]
 ds_read_b64_tr_b16 v[144:145], v14 offset:40960
 ds_read_b64_tr_b16 v[146:147], v14 offset:42240
 v_mfma_f32_16x16x32_bf16 v[104:107], v[184:187], a[140:143], v[104:107]
 ds_read_b64_tr_b16 v[148:149], v15 offset:40992
 v_mfma_f32_16x16x32_bf16 v[68:71], v[188:191], a[136:139], v[68:71]
 ds_read_b64_tr_b16 v[150:151], v15 offset:42272
 v_mfma_f32_16x16x32_bf16 v[108:111], v[188:191], a[140:143], v[108:111]
 ds_read_b64_tr_b16 v[152:153], v14 offset:41024
 v_mfma_f32_16x16x32_bf16 v[72:75], v[192:195], a[136:139], v[72:75]
 ds_read_b64_tr_b16 v[154:155], v14 offset:42304
 v_mfma_f32_16x16x32_bf16 v[112:115], v[192:195], a[140:143], v[112:115]
 ds_read_b64_tr_b16 v[156:157], v15 offset:41056
 ds_read_b64_tr_b16 v[158:159], v15 offset:42336
 v_mfma_f32_16x16x32_bf16 v[76:79], v[196:199], a[136:139], v[76:79]
 ds_read_b64_tr_b16 v[160:161], v14 offset:41088
 v_mfma_f32_16x16x32_bf16 v[116:119], v[196:199], a[140:143], v[116:119]
 ds_read_b64_tr_b16 v[162:163], v14 offset:42368
 v_mfma_f32_16x16x32_bf16 v[80:83], v[200:203], a[136:139], v[80:83]
 ds_read_b64_tr_b16 v[164:165], v15 offset:41120
 v_mfma_f32_16x16x32_bf16 v[120:123], v[200:203], a[140:143], v[120:123]
 ds_read_b64_tr_b16 v[166:167], v15 offset:42400
 v_mfma_f32_16x16x32_bf16 v[84:87], v[204:207], a[136:139], v[84:87]
 ds_read_b64_tr_b16 v[168:169], v14 offset:41152
 v_mfma_f32_16x16x32_bf16 v[124:127], v[204:207], a[140:143], v[124:127]
 ds_read_b64_tr_b16 v[170:171], v14 offset:42432
 ds_read_b64_tr_b16 v[172:173], v15 offset:41184
 v_mfma_f32_16x16x32_bf16 v[88:91], v[208:211], a[136:139], v[88:91]
 ds_read_b64_tr_b16 v[174:175], v15 offset:42464
 v_mfma_f32_16x16x32_bf16 v[128:131], v[208:211], a[140:143], v[128:131]
 ds_read_b64_tr_b16 v[176:177], v14 offset:41216
 v_mfma_f32_16x16x32_bf16 v[92:95], v[212:215], a[136:139], v[92:95]
 ds_read_b64_tr_b16 v[178:179], v14 offset:42496
 v_mfma_f32_16x16x32_bf16 v[132:135], v[212:215], a[140:143], v[132:135]
 ds_read_b64_tr_b16 v[180:181], v15 offset:41248
 v_mfma_f32_16x16x32_bf16 v[96:99], v[216:219], a[136:139], v[96:99]
 ds_read_b64_tr_b16 v[182:183], v15 offset:42528
 v_mfma_f32_16x16x32_bf16 v[136:139], v[216:219], a[140:143], v[136:139]
 v_mfma_f32_16x16x32_bf16 v[100:103], v[220:223], a[136:139], v[100:103]
 v_mfma_f32_16x16x32_bf16 v[140:143], v[220:223], a[140:143], v[140:143]
 s_waitcnt lgkmcnt(0) vmcnt(2)
 v_mfma_f32_16x16x32_bf16 v[64:67], v[144:147], a[144:147], v[64:67]
 ds_read_b64_tr_b16 v[184:185], v14 offset:51200
 ds_read_b64_tr_b16 v[186:187], v14 offset:52480
 v_mfma_f32_16x16x32_bf16 v[104:107], v[144:147], a[148:151], v[104:107]
 ds_read_b64_tr_b16 v[188:189], v15 offset:51232
 v_mfma_f32_16x16x32_bf16 v[68:71], v[148:151], a[144:147], v[68:71]
 ds_read_b64_tr_b16 v[190:191], v15 offset:52512
 v_mfma_f32_16x16x32_bf16 v[108:111], v[148:151], a[148:151], v[108:111]
 ds_read_b64_tr_b16 v[192:193], v14 offset:51264
 v_mfma_f32_16x16x32_bf16 v[72:75], v[152:155], a[144:147], v[72:75]
 ds_read_b64_tr_b16 v[194:195], v14 offset:52544
 v_mfma_f32_16x16x32_bf16 v[112:115], v[152:155], a[148:151], v[112:115]
 ds_read_b64_tr_b16 v[196:197], v15 offset:51296
 ds_read_b64_tr_b16 v[198:199], v15 offset:52576
 v_mfma_f32_16x16x32_bf16 v[76:79], v[156:159], a[144:147], v[76:79]
 ds_read_b64_tr_b16 v[200:201], v14 offset:51328
 v_mfma_f32_16x16x32_bf16 v[116:119], v[156:159], a[148:151], v[116:119]
 ds_read_b64_tr_b16 v[202:203], v14 offset:52608
 v_mfma_f32_16x16x32_bf16 v[80:83], v[160:163], a[144:147], v[80:83]
 ds_read_b64_tr_b16 v[204:205], v15 offset:51360
 v_mfma_f32_16x16x32_bf16 v[120:123], v[160:163], a[148:151], v[120:123]
 ds_read_b64_tr_b16 v[206:207], v15 offset:52640
 v_mfma_f32_16x16x32_bf16 v[84:87], v[164:167], a[144:147], v[84:87]
 ds_read_b64_tr_b16 v[208:209], v14 offset:51392
 v_mfma_f32_16x16x32_bf16 v[124:127], v[164:167], a[148:151], v[124:127]
 ds_read_b64_tr_b16 v[210:211], v14 offset:52672
 ds_read_b64_tr_b16 v[212:213], v15 offset:51424
 v_mfma_f32_16x16x32_bf16 v[88:91], v[168:171], a[144:147], v[88:91]
 ds_read_b64_tr_b16 v[214:215], v15 offset:52704
 v_mfma_f32_16x16x32_bf16 v[128:131], v[168:171], a[148:151], v[128:131]
 ds_read_b64_tr_b16 v[216:217], v14 offset:51456
 v_mfma_f32_16x16x32_bf16 v[92:95], v[172:175], a[144:147], v[92:95]
 ds_read_b64_tr_b16 v[218:219], v14 offset:52736
 v_mfma_f32_16x16x32_bf16 v[132:135], v[172:175], a[148:151], v[132:135]
 ds_read_b64_tr_b16 v[220:221], v15 offset:51488
 v_mfma_f32_16x16x32_bf16 v[96:99], v[176:179], a[144:147], v[96:99]
 ds_read_b64_tr_b16 v[222:223], v15 offset:52768
 v_mfma_f32_16x16x32_bf16 v[136:139], v[176:179], a[148:151], v[136:139]
 v_mfma_f32_16x16x32_bf16 v[100:103], v[180:183], a[144:147], v[100:103]
 v_mfma_f32_16x16x32_bf16 v[140:143], v[180:183], a[148:151], v[140:143]
 s_waitcnt lgkmcnt(0) vmcnt(0)
 v_mfma_f32_16x16x32_bf16 v[64:67], v[184:187], a[152:155], v[64:67]
 v_mfma_f32_16x16x32_bf16 v[104:107], v[184:187], a[156:159], v[104:107]
 v_mfma_f32_16x16x32_bf16 v[68:71], v[188:191], a[152:155], v[68:71]
 v_mfma_f32_16x16x32_bf16 v[108:111], v[188:191], a[156:159], v[108:111]
 v_mfma_f32_16x16x32_bf16 v[72:75], v[192:195], a[152:155], v[72:75]
 v_mfma_f32_16x16x32_bf16 v[112:115], v[192:195], a[156:159], v[112:115]
 v_mfma_f32_16x16x32_bf16 v[76:79], v[196:199], a[152:155], v[76:79]
 v_mfma_f32_16x16x32_bf16 v[116:119], v[196:199], a[156:159], v[116:119]
 v_mfma_f32_16x16x32_bf16 v[80:83], v[200:203], a[152:155], v[80:83]
 v_mfma_f32_16x16x32_bf16 v[120:123], v[200:203], a[156:159], v[120:123]
 v_mfma_f32_16x16x32_bf16 v[84:87], v[204:207], a[152:155], v[84:87]
 v_mfma_f32_16x16x32_bf16 v[124:127], v[204:207], a[156:159], v[124:127]
 v_mfma_f32_16x16x32_bf16 v[88:91], v[208:211], a[152:155], v[88:91]
 v_mfma_f32_16x16x32_bf16 v[128:131], v[208:211], a[156:159], v[128:131]
 v_mfma_f32_16x16x32_bf16 v[92:95], v[212:215], a[152:155], v[92:95]
 v_mfma_f32_16x16x32_bf16 v[132:135], v[212:215], a[156:159], v[132:135]
 v_mfma_f32_16x16x32_bf16 v[96:99], v[216:219], a[152:155], v[96:99]
 v_mfma_f32_16x16x32_bf16 v[136:139], v[216:219], a[156:159], v[136:139]
 v_mfma_f32_16x16x32_bf16 v[100:103], v[220:223], a[152:155], v[100:103]
 v_mfma_f32_16x16x32_bf16 v[140:143], v[220:223], a[156:159], v[140:143]
 s_add_u32 s16, s38, 180355072
 s_addc_u32 s17, s39, 0
 s_mov_b32 s18, 67108864
 s_mov_b32 s19, 0x00020000
 s_nop 3
 s_lshr_b32 s22, s47, 1
 s_lshr_b32 s21, s22, 1
 s_bitcmp1_b32 s37, s21
 s_cselect_b32 s21, 8192, 0
 s_lshl_b32 s51, s22, 20
 s_or_b32 s51, s51, s21
 s_add_u32 s51, s51, 786432
 s_mul_i32 s53, s44, 5
 s_cmp_lt_u32 s2, 48
 s_cbranch_scc1 om_242
 s_add_u32 s21, s53, 0
 s_lshr_b32 s22, s21, 1
 s_lshl_b32 s22, s22, 14
 s_and_b32 s21, s21, 1
 s_lshl_b32 s21, s21, 11
 s_add_u32 s22, s22, s21
 s_add_u32 s22, s22, s51
 buffer_store_dwordx4 v[64:67], v4, s[16:19], s22 offen offset:0 sc1
 buffer_store_dwordx4 v[68:71], v4, s[16:19], s22 offen offset:1024 sc1
 s_add_u32 s21, s53, 1
 s_lshr_b32 s22, s21, 1
 s_lshl_b32 s22, s22, 14
 s_and_b32 s21, s21, 1
 s_lshl_b32 s21, s21, 11
 s_add_u32 s22, s22, s21
 s_add_u32 s22, s22, s51
 buffer_store_dwordx4 v[72:75], v4, s[16:19], s22 offen offset:0 sc1
 buffer_store_dwordx4 v[76:79], v4, s[16:19], s22 offen offset:1024 sc1
 s_add_u32 s21, s53, 2
 s_lshr_b32 s22, s21, 1
 s_lshl_b32 s22, s22, 14
 s_and_b32 s21, s21, 1
 s_lshl_b32 s21, s21, 11
 s_add_u32 s22, s22, s21
 s_add_u32 s22, s22, s51
 buffer_store_dwordx4 v[80:83], v4, s[16:19], s22 offen offset:0 sc1
 buffer_store_dwordx4 v[84:87], v4, s[16:19], s22 offen offset:1024 sc1
 s_add_u32 s21, s53, 3
 s_lshr_b32 s22, s21, 1
 s_lshl_b32 s22, s22, 14
 s_and_b32 s21, s21, 1
 s_lshl_b32 s21, s21, 11
 s_add_u32 s22, s22, s21
 s_add_u32 s22, s22, s51
 buffer_store_dwordx4 v[88:91], v4, s[16:19], s22 offen offset:0 sc1
 buffer_store_dwordx4 v[92:95], v4, s[16:19], s22 offen offset:1024 sc1
 s_add_u32 s21, s53, 4
 s_lshr_b32 s22, s21, 1
 s_lshl_b32 s22, s22, 14
 s_and_b32 s21, s21, 1
 s_lshl_b32 s21, s21, 11
 s_add_u32 s22, s22, s21
 s_add_u32 s22, s22, s51
 buffer_store_dwordx4 v[96:99], v4, s[16:19], s22 offen offset:0 sc1
 buffer_store_dwordx4 v[100:103], v4, s[16:19], s22 offen offset:1024 sc1
 s_add_u32 s21, s53, 0
 s_lshr_b32 s22, s21, 1
 s_lshl_b32 s22, s22, 14
 s_and_b32 s21, s21, 1
 s_lshl_b32 s21, s21, 11
 s_add_u32 s22, s22, s21
 s_add_u32 s22, s22, s51
 s_add_u32 s22, s22, 4096
 buffer_store_dwordx4 v[104:107], v4, s[16:19], s22 offen offset:0 sc1
 buffer_store_dwordx4 v[108:111], v4, s[16:19], s22 offen offset:1024 sc1
 s_add_u32 s21, s53, 1
 s_lshr_b32 s22, s21, 1
 s_lshl_b32 s22, s22, 14
 s_and_b32 s21, s21, 1
 s_lshl_b32 s21, s21, 11
 s_add_u32 s22, s22, s21
 s_add_u32 s22, s22, s51
 s_add_u32 s22, s22, 4096
 buffer_store_dwordx4 v[112:115], v4, s[16:19], s22 offen offset:0 sc1
 buffer_store_dwordx4 v[116:119], v4, s[16:19], s22 offen offset:1024 sc1
 s_add_u32 s21, s53, 2
 s_lshr_b32 s22, s21, 1
 s_lshl_b32 s22, s22, 14
 s_and_b32 s21, s21, 1
 s_lshl_b32 s21, s21, 11
 s_add_u32 s22, s22, s21
 s_add_u32 s22, s22, s51
 s_add_u32 s22, s22, 4096
 buffer_store_dwordx4 v[120:123], v4, s[16:19], s22 offen offset:0 sc1
 buffer_store_dwordx4 v[124:127], v4, s[16:19], s22 offen offset:1024 sc1
 s_add_u32 s21, s53, 3
 s_lshr_b32 s22, s21, 1
 s_lshl_b32 s22, s22, 14
 s_and_b32 s21, s21, 1
 s_lshl_b32 s21, s21, 11
 s_add_u32 s22, s22, s21
 s_add_u32 s22, s22, s51
 s_add_u32 s22, s22, 4096
 buffer_store_dwordx4 v[128:131], v4, s[16:19], s22 offen offset:0 sc1
 buffer_store_dwordx4 v[132:135], v4, s[16:19], s22 offen offset:1024 sc1
 s_add_u32 s21, s53, 4
 s_lshr_b32 s22, s21, 1
 s_lshl_b32 s22, s22, 14
 s_and_b32 s21, s21, 1
 s_lshl_b32 s21, s21, 11
 s_add_u32 s22, s22, s21
 s_add_u32 s22, s22, s51
 s_add_u32 s22, s22, 4096
 buffer_store_dwordx4 v[136:139], v4, s[16:19], s22 offen offset:0 sc1
 buffer_store_dwordx4 v[140:143], v4, s[16:19], s22 offen offset:1024 sc1
 s_waitcnt vmcnt(0)
 s_barrier
 s_lshr_b32 s21, s2, 2
 s_lshl_b32 s21, s21, 7
 s_add_u32 s21, s21, 93184
 s_cmp_lg_u32 s20, 0
 s_cbranch_scc1 af_244
 v_mov_b32 v10, 0
 v_mov_b32 v11, 1
 s_mov_b64 exec, 1
 buffer_atomic_add v11, v10, s[72:75], s21 offen sc1
 s_mov_b64 exec, -1
 s_nop 1
af_244:
 s_branch om_243
om_242:
 s_load_dwordx2 s[8:9], s[0:1], 88
 s_lshr_b32 s52, s2, 2
 s_lshl_b32 s52, s52, 7
 s_and_b32 s21, s52, 511
 s_add_u32 s21, s21, 94720
 s_cmp_lt_u32 s2, 32
 s_cselect_b32 s54, 32, 80
 s_add_u32 s21, s52, 116736
 s_cmp_lg_u32 s20, 0
 s_cbranch_scc1 wf_246
 v_mov_b32 v20, 0
 s_mov_b32 s101, 0
wf_245:
 buffer_load_dword v21, v20, s[72:75], s21 offen sc1
 s_add_u32 s101, s101, 1
 s_cmp_gt_u32 s101, 131072
 s_cbranch_scc1 main_end
 s_waitcnt vmcnt(0)
 v_readfirstlane_b32 s100, v21
 s_cmp_ge_u32 s100, s54
 s_cbranch_scc1 wf_246
 s_sleep 16
 s_branch wf_245
wf_246:
 s_barrier
 v_lshlrev_b32 v6, 2, v2
 s_lshl_b32 s22, s47, 6
 buffer_load_dword v30, v6, s[28:31], s22 offen sc1
 buffer_load_dword v31, v6, s[28:31], s22 offen offset:64 sc1
 s_add_u32 s21, s53, 0
 s_lshr_b32 s22, s21, 1
 s_lshl_b32 s22, s22, 14
 s_and_b32 s21, s21, 1
 s_lshl_b32 s21, s21, 11
 s_add_u32 s22, s22, s21
 s_add_u32 s22, s22, s51
 buffer_load_dwordx4 v[144:147], v4, s[16:19], s22 offen offset:0 sc1
 buffer_load_dwordx4 v[148:151], v4, s[16:19], s22 offen offset:1024 sc1
 s_add_u32 s21, s53, 1
 s_lshr_b32 s22, s21, 1
 s_lshl_b32 s22, s22, 14
 s_and_b32 s21, s21, 1
 s_lshl_b32 s21, s21, 11
 s_add_u32 s22, s22, s21
 s_add_u32 s22, s22, s51
 buffer_load_dwordx4 v[152:155], v4, s[16:19], s22 offen offset:0 sc1
 buffer_load_dwordx4 v[156:159], v4, s[16:19], s22 offen offset:1024 sc1
 s_add_u32 s21, s53, 2
 s_lshr_b32 s22, s21, 1
 s_lshl_b32 s22, s22, 14
 s_and_b32 s21, s21, 1
 s_lshl_b32 s21, s21, 11
 s_add_u32 s22, s22, s21
 s_add_u32 s22, s22, s51
 buffer_load_dwordx4 v[160:163], v4, s[16:19], s22 offen offset:0 sc1
 buffer_load_dwordx4 v[164:167], v4, s[16:19], s22 offen offset:1024 sc1
 s_add_u32 s21, s53, 3
 s_lshr_b32 s22, s21, 1
 s_lshl_b32 s22, s22, 14
 s_and_b32 s21, s21, 1
 s_lshl_b32 s21, s21, 11
 s_add_u32 s22, s22, s21
 s_add_u32 s22, s22, s51
 buffer_load_dwordx4 v[168:171], v4, s[16:19], s22 offen offset:0 sc1
 buffer_load_dwordx4 v[172:175], v4, s[16:19], s22 offen offset:1024 sc1
 s_add_u32 s21, s53, 4
 s_lshr_b32 s22, s21, 1
 s_lshl_b32 s22, s22, 14
 s_and_b32 s21, s21, 1
 s_lshl_b32 s21, s21, 11
 s_add_u32 s22, s22, s21
 s_add_u32 s22, s22, s51
 buffer_load_dwordx4 v[176:179], v4, s[16:19], s22 offen offset:0 sc1
 buffer_load_dwordx4 v[180:183], v4, s[16:19], s22 offen offset:1024 sc1
 s_add_u32 s21, s53, 0
 s_lshr_b32 s22, s21, 1
 s_lshl_b32 s22, s22, 14
 s_and_b32 s21, s21, 1
 s_lshl_b32 s21, s21, 11
 s_add_u32 s22, s22, s21
 s_add_u32 s22, s22, s51
 s_add_u32 s22, s22, 4096
 buffer_load_dwordx4 v[184:187], v4, s[16:19], s22 offen offset:0 sc1
 buffer_load_dwordx4 v[188:191], v4, s[16:19], s22 offen offset:1024 sc1
 s_add_u32 s21, s53, 1
 s_lshr_b32 s22, s21, 1
 s_lshl_b32 s22, s22, 14
 s_and_b32 s21, s21, 1
 s_lshl_b32 s21, s21, 11
 s_add_u32 s22, s22, s21
 s_add_u32 s22, s22, s51
 s_add_u32 s22, s22, 4096
 buffer_load_dwordx4 v[192:195], v4, s[16:19], s22 offen offset:0 sc1
 buffer_load_dwordx4 v[196:199], v4, s[16:19], s22 offen offset:1024 sc1
 s_add_u32 s21, s53, 2
 s_lshr_b32 s22, s21, 1
 s_lshl_b32 s22, s22, 14
 s_and_b32 s21, s21, 1
 s_lshl_b32 s21, s21, 11
 s_add_u32 s22, s22, s21
 s_add_u32 s22, s22, s51
 s_add_u32 s22, s22, 4096
 buffer_load_dwordx4 v[200:203], v4, s[16:19], s22 offen offset:0 sc1
 buffer_load_dwordx4 v[204:207], v4, s[16:19], s22 offen offset:1024 sc1
 s_add_u32 s21, s53, 3
 s_lshr_b32 s22, s21, 1
 s_lshl_b32 s22, s22, 14
 s_and_b32 s21, s21, 1
 s_lshl_b32 s21, s21, 11
 s_add_u32 s22, s22, s21
 s_add_u32 s22, s22, s51
 s_add_u32 s22, s22, 4096
 buffer_load_dwordx4 v[208:211], v4, s[16:19], s22 offen offset:0 sc1
 buffer_load_dwordx4 v[212:215], v4, s[16:19], s22 offen offset:1024 sc1
 s_add_u32 s21, s53, 4
 s_lshr_b32 s22, s21, 1
 s_lshl_b32 s22, s22, 14
 s_and_b32 s21, s21, 1
 s_lshl_b32 s21, s21, 11
 s_add_u32 s22, s22, s21
 s_add_u32 s22, s22, s51
 s_add_u32 s22, s22, 4096
 buffer_load_dwordx4 v[216:219], v4, s[16:19], s22 offen offset:0 sc1
 buffer_load_dwordx4 v[220:223], v4, s[16:19], s22 offen offset:1024 sc1
 v_mul_u32_u24 v9, 1280, v2
 v_lshl_add_u32 v9, v3, 3, v9
 s_mul_i32 s22, s47, 20480
 s_add_u32 s22, s22, s45
 s_add_u32 s23, s22, 20480
 s_waitcnt vmcnt(20) lgkmcnt(0)
 v_sub_f32 v32, 1.0, v30
 v_sub_f32 v33, 1.0, v31
 v_cvt_pk_bf16_f32 v26, v32, v33
 v_lshlrev_b32 v32, 16, v26
 v_and_b32 v33, 0xffff0000, v26
 v_cvt_pk_bf16_f32 v26, v64, v65
 v_lshlrev_b32 v64, 16, v26
 v_and_b32 v65, 0xffff0000, v26
 v_mul_f32 v64, v64, v32
 v_mul_f32 v65, v65, v32
 v_cvt_pk_bf16_f32 v26, v64, v65
 v_lshlrev_b32 v64, 16, v26
 v_and_b32 v65, 0xffff0000, v26
 v_cvt_pk_bf16_f32 v26, v66, v67
 v_lshlrev_b32 v66, 16, v26
 v_and_b32 v67, 0xffff0000, v26
 v_mul_f32 v66, v66, v32
 v_mul_f32 v67, v67, v32
 v_cvt_pk_bf16_f32 v26, v66, v67
 v_lshlrev_b32 v66, 16, v26
 v_and_b32 v67, 0xffff0000, v26
 v_cvt_pk_bf16_f32 v26, v68, v69
 v_lshlrev_b32 v68, 16, v26
 v_and_b32 v69, 0xffff0000, v26
 v_mul_f32 v68, v68, v32
 v_mul_f32 v69, v69, v32
 v_cvt_pk_bf16_f32 v26, v68, v69
 v_lshlrev_b32 v68, 16, v26
 v_and_b32 v69, 0xffff0000, v26
 v_cvt_pk_bf16_f32 v26, v70, v71
 v_lshlrev_b32 v70, 16, v26
 v_and_b32 v71, 0xffff0000, v26
 v_mul_f32 v70, v70, v32
 v_mul_f32 v71, v71, v32
 v_cvt_pk_bf16_f32 v26, v70, v71
 v_lshlrev_b32 v70, 16, v26
 v_and_b32 v71, 0xffff0000, v26
 v_cvt_pk_bf16_f32 v26, v72, v73
 v_lshlrev_b32 v72, 16, v26
 v_and_b32 v73, 0xffff0000, v26
 v_mul_f32 v72, v72, v32
 v_mul_f32 v73, v73, v32
 v_cvt_pk_bf16_f32 v26, v72, v73
 v_lshlrev_b32 v72, 16, v26
 v_and_b32 v73, 0xffff0000, v26
 v_cvt_pk_bf16_f32 v26, v74, v75
 v_lshlrev_b32 v74, 16, v26
 v_and_b32 v75, 0xffff0000, v26
 v_mul_f32 v74, v74, v32
 v_mul_f32 v75, v75, v32
 v_cvt_pk_bf16_f32 v26, v74, v75
 v_lshlrev_b32 v74, 16, v26
 v_and_b32 v75, 0xffff0000, v26
 v_cvt_pk_bf16_f32 v26, v76, v77
 v_lshlrev_b32 v76, 16, v26
 v_and_b32 v77, 0xffff0000, v26
 v_mul_f32 v76, v76, v32
 v_mul_f32 v77, v77, v32
 v_cvt_pk_bf16_f32 v26, v76, v77
 v_lshlrev_b32 v76, 16, v26
 v_and_b32 v77, 0xffff0000, v26
 v_cvt_pk_bf16_f32 v26, v78, v79
 v_lshlrev_b32 v78, 16, v26
 v_and_b32 v79, 0xffff0000, v26
 v_mul_f32 v78, v78, v32
 v_mul_f32 v79, v79, v32
 v_cvt_pk_bf16_f32 v26, v78, v79
 v_lshlrev_b32 v78, 16, v26
 v_and_b32 v79, 0xffff0000, v26
 v_cvt_pk_bf16_f32 v26, v80, v81
 v_lshlrev_b32 v80, 16, v26
 v_and_b32 v81, 0xffff0000, v26
 v_mul_f32 v80, v80, v32
 v_mul_f32 v81, v81, v32
 v_cvt_pk_bf16_f32 v26, v80, v81
 v_lshlrev_b32 v80, 16, v26
 v_and_b32 v81, 0xffff0000, v26
 v_cvt_pk_bf16_f32 v26, v82, v83
 v_lshlrev_b32 v82, 16, v26
 v_and_b32 v83, 0xffff0000, v26
 v_mul_f32 v82, v82, v32
 v_mul_f32 v83, v83, v32
 v_cvt_pk_bf16_f32 v26, v82, v83
 v_lshlrev_b32 v82, 16, v26
 v_and_b32 v83, 0xffff0000, v26
 v_cvt_pk_bf16_f32 v26, v84, v85
 v_lshlrev_b32 v84, 16, v26
 v_and_b32 v85, 0xffff0000, v26
 v_mul_f32 v84, v84, v32
 v_mul_f32 v85, v85, v32
 v_cvt_pk_bf16_f32 v26, v84, v85
 v_lshlrev_b32 v84, 16, v26
 v_and_b32 v85, 0xffff0000, v26
 v_cvt_pk_bf16_f32 v26, v86, v87
 v_lshlrev_b32 v86, 16, v26
 v_and_b32 v87, 0xffff0000, v26
 v_mul_f32 v86, v86, v32
 v_mul_f32 v87, v87, v32
 v_cvt_pk_bf16_f32 v26, v86, v87
 v_lshlrev_b32 v86, 16, v26
 v_and_b32 v87, 0xffff0000, v26
 v_cvt_pk_bf16_f32 v26, v88, v89
 v_lshlrev_b32 v88, 16, v26
 v_and_b32 v89, 0xffff0000, v26
 v_mul_f32 v88, v88, v32
 v_mul_f32 v89, v89, v32
 v_cvt_pk_bf16_f32 v26, v88, v89
 v_lshlrev_b32 v88, 16, v26
 v_and_b32 v89, 0xffff0000, v26
 v_cvt_pk_bf16_f32 v26, v90, v91
 v_lshlrev_b32 v90, 16, v26
 v_and_b32 v91, 0xffff0000, v26
 v_mul_f32 v90, v90, v32
 v_mul_f32 v91, v91, v32
 v_cvt_pk_bf16_f32 v26, v90, v91
 v_lshlrev_b32 v90, 16, v26
 v_and_b32 v91, 0xffff0000, v26
 v_cvt_pk_bf16_f32 v26, v92, v93
 v_lshlrev_b32 v92, 16, v26
 v_and_b32 v93, 0xffff0000, v26
 v_mul_f32 v92, v92, v32
 v_mul_f32 v93, v93, v32
 v_cvt_pk_bf16_f32 v26, v92, v93
 v_lshlrev_b32 v92, 16, v26
 v_and_b32 v93, 0xffff0000, v26
 v_cvt_pk_bf16_f32 v26, v94, v95
 v_lshlrev_b32 v94, 16, v26
 v_and_b32 v95, 0xffff0000, v26
 v_mul_f32 v94, v94, v32
 v_mul_f32 v95, v95, v32
 v_cvt_pk_bf16_f32 v26, v94, v95
 v_lshlrev_b32 v94, 16, v26
 v_and_b32 v95, 0xffff0000, v26
 v_cvt_pk_bf16_f32 v26, v96, v97
 v_lshlrev_b32 v96, 16, v26
 v_and_b32 v97, 0xffff0000, v26
 v_mul_f32 v96, v96, v32
 v_mul_f32 v97, v97, v32
 v_cvt_pk_bf16_f32 v26, v96, v97
 v_lshlrev_b32 v96, 16, v26
 v_and_b32 v97, 0xffff0000, v26
 v_cvt_pk_bf16_f32 v26, v98, v99
 v_lshlrev_b32 v98, 16, v26
 v_and_b32 v99, 0xffff0000, v26
 v_mul_f32 v98, v98, v32
 v_mul_f32 v99, v99, v32
 v_cvt_pk_bf16_f32 v26, v98, v99
 v_lshlrev_b32 v98, 16, v26
 v_and_b32 v99, 0xffff0000, v26
 v_cvt_pk_bf16_f32 v26, v100, v101
 v_lshlrev_b32 v100, 16, v26
 v_and_b32 v101, 0xffff0000, v26
 v_mul_f32 v100, v100, v32
 v_mul_f32 v101, v101, v32
 v_cvt_pk_bf16_f32 v26, v100, v101
 v_lshlrev_b32 v100, 16, v26
 v_and_b32 v101, 0xffff0000, v26
 v_cvt_pk_bf16_f32 v26, v102, v103
 v_lshlrev_b32 v102, 16, v26
 v_and_b32 v103, 0xffff0000, v26
 v_mul_f32 v102, v102, v32
 v_mul_f32 v103, v103, v32
 v_cvt_pk_bf16_f32 v26, v102, v103
 v_lshlrev_b32 v102, 16, v26
 v_and_b32 v103, 0xffff0000, v26
 v_cvt_pk_bf16_f32 v26, v104, v105
 v_lshlrev_b32 v104, 16, v26
 v_and_b32 v105, 0xffff0000, v26
 v_mul_f32 v104, v104, v33
 v_mul_f32 v105, v105, v33
 v_cvt_pk_bf16_f32 v26, v104, v105
 v_lshlrev_b32 v104, 16, v26
 v_and_b32 v105, 0xffff0000, v26
 v_cvt_pk_bf16_f32 v26, v106, v107
 v_lshlrev_b32 v106, 16, v26
 v_and_b32 v107, 0xffff0000, v26
 v_mul_f32 v106, v106, v33
 v_mul_f32 v107, v107, v33
 v_cvt_pk_bf16_f32 v26, v106, v107
 v_lshlrev_b32 v106, 16, v26
 v_and_b32 v107, 0xffff0000, v26
 v_cvt_pk_bf16_f32 v26, v108, v109
 v_lshlrev_b32 v108, 16, v26
 v_and_b32 v109, 0xffff0000, v26
 v_mul_f32 v108, v108, v33
 v_mul_f32 v109, v109, v33
 v_cvt_pk_bf16_f32 v26, v108, v109
 v_lshlrev_b32 v108, 16, v26
 v_and_b32 v109, 0xffff0000, v26
 v_cvt_pk_bf16_f32 v26, v110, v111
 v_lshlrev_b32 v110, 16, v26
 v_and_b32 v111, 0xffff0000, v26
 v_mul_f32 v110, v110, v33
 v_mul_f32 v111, v111, v33
 v_cvt_pk_bf16_f32 v26, v110, v111
 v_lshlrev_b32 v110, 16, v26
 v_and_b32 v111, 0xffff0000, v26
 v_cvt_pk_bf16_f32 v26, v112, v113
 v_lshlrev_b32 v112, 16, v26
 v_and_b32 v113, 0xffff0000, v26
 v_mul_f32 v112, v112, v33
 v_mul_f32 v113, v113, v33
 v_cvt_pk_bf16_f32 v26, v112, v113
 v_lshlrev_b32 v112, 16, v26
 v_and_b32 v113, 0xffff0000, v26
 v_cvt_pk_bf16_f32 v26, v114, v115
 v_lshlrev_b32 v114, 16, v26
 v_and_b32 v115, 0xffff0000, v26
 v_mul_f32 v114, v114, v33
 v_mul_f32 v115, v115, v33
 v_cvt_pk_bf16_f32 v26, v114, v115
 v_lshlrev_b32 v114, 16, v26
 v_and_b32 v115, 0xffff0000, v26
 v_cvt_pk_bf16_f32 v26, v116, v117
 v_lshlrev_b32 v116, 16, v26
 v_and_b32 v117, 0xffff0000, v26
 v_mul_f32 v116, v116, v33
 v_mul_f32 v117, v117, v33
 v_cvt_pk_bf16_f32 v26, v116, v117
 v_lshlrev_b32 v116, 16, v26
 v_and_b32 v117, 0xffff0000, v26
 v_cvt_pk_bf16_f32 v26, v118, v119
 v_lshlrev_b32 v118, 16, v26
 v_and_b32 v119, 0xffff0000, v26
 v_mul_f32 v118, v118, v33
 v_mul_f32 v119, v119, v33
 v_cvt_pk_bf16_f32 v26, v118, v119
 v_lshlrev_b32 v118, 16, v26
 v_and_b32 v119, 0xffff0000, v26
 v_cvt_pk_bf16_f32 v26, v120, v121
 v_lshlrev_b32 v120, 16, v26
 v_and_b32 v121, 0xffff0000, v26
 v_mul_f32 v120, v120, v33
 v_mul_f32 v121, v121, v33
 v_cvt_pk_bf16_f32 v26, v120, v121
 v_lshlrev_b32 v120, 16, v26
 v_and_b32 v121, 0xffff0000, v26
 v_cvt_pk_bf16_f32 v26, v122, v123
 v_lshlrev_b32 v122, 16, v26
 v_and_b32 v123, 0xffff0000, v26
 v_mul_f32 v122, v122, v33
 v_mul_f32 v123, v123, v33
 v_cvt_pk_bf16_f32 v26, v122, v123
 v_lshlrev_b32 v122, 16, v26
 v_and_b32 v123, 0xffff0000, v26
 v_cvt_pk_bf16_f32 v26, v124, v125
 v_lshlrev_b32 v124, 16, v26
 v_and_b32 v125, 0xffff0000, v26
 v_mul_f32 v124, v124, v33
 v_mul_f32 v125, v125, v33
 v_cvt_pk_bf16_f32 v26, v124, v125
 v_lshlrev_b32 v124, 16, v26
 v_and_b32 v125, 0xffff0000, v26
 v_cvt_pk_bf16_f32 v26, v126, v127
 v_lshlrev_b32 v126, 16, v26
 v_and_b32 v127, 0xffff0000, v26
 v_mul_f32 v126, v126, v33
 v_mul_f32 v127, v127, v33
 v_cvt_pk_bf16_f32 v26, v126, v127
 v_lshlrev_b32 v126, 16, v26
 v_and_b32 v127, 0xffff0000, v26
 v_cvt_pk_bf16_f32 v26, v128, v129
 v_lshlrev_b32 v128, 16, v26
 v_and_b32 v129, 0xffff0000, v26
 v_mul_f32 v128, v128, v33
 v_mul_f32 v129, v129, v33
 v_cvt_pk_bf16_f32 v26, v128, v129
 v_lshlrev_b32 v128, 16, v26
 v_and_b32 v129, 0xffff0000, v26
 v_cvt_pk_bf16_f32 v26, v130, v131
 v_lshlrev_b32 v130, 16, v26
 v_and_b32 v131, 0xffff0000, v26
 v_mul_f32 v130, v130, v33
 v_mul_f32 v131, v131, v33
 v_cvt_pk_bf16_f32 v26, v130, v131
 v_lshlrev_b32 v130, 16, v26
 v_and_b32 v131, 0xffff0000, v26
 v_cvt_pk_bf16_f32 v26, v132, v133
 v_lshlrev_b32 v132, 16, v26
 v_and_b32 v133, 0xffff0000, v26
 v_mul_f32 v132, v132, v33
 v_mul_f32 v133, v133, v33
 v_cvt_pk_bf16_f32 v26, v132, v133
 v_lshlrev_b32 v132, 16, v26
 v_and_b32 v133, 0xffff0000, v26
 v_cvt_pk_bf16_f32 v26, v134, v135
 v_lshlrev_b32 v134, 16, v26
 v_and_b32 v135, 0xffff0000, v26
 v_mul_f32 v134, v134, v33
 v_mul_f32 v135, v135, v33
 v_cvt_pk_bf16_f32 v26, v134, v135
 v_lshlrev_b32 v134, 16, v26
 v_and_b32 v135, 0xffff0000, v26
 v_cvt_pk_bf16_f32 v26, v136, v137
 v_lshlrev_b32 v136, 16, v26
 v_and_b32 v137, 0xffff0000, v26
 v_mul_f32 v136, v136, v33
 v_mul_f32 v137, v137, v33
 v_cvt_pk_bf16_f32 v26, v136, v137
 v_lshlrev_b32 v136, 16, v26
 v_and_b32 v137, 0xffff0000, v26
 v_cvt_pk_bf16_f32 v26, v138, v139
 v_lshlrev_b32 v138, 16, v26
 v_and_b32 v139, 0xffff0000, v26
 v_mul_f32 v138, v138, v33
 v_mul_f32 v139, v139, v33
 v_cvt_pk_bf16_f32 v26, v138, v139
 v_lshlrev_b32 v138, 16, v26
 v_and_b32 v139, 0xffff0000, v26
 v_cvt_pk_bf16_f32 v26, v140, v141
 v_lshlrev_b32 v140, 16, v26
 v_and_b32 v141, 0xffff0000, v26
 v_mul_f32 v140, v140, v33
 v_mul_f32 v141, v141, v33
 v_cvt_pk_bf16_f32 v26, v140, v141
 v_lshlrev_b32 v140, 16, v26
 v_and_b32 v141, 0xffff0000, v26
 v_cvt_pk_bf16_f32 v26, v142, v143
 v_lshlrev_b32 v142, 16, v26
 v_and_b32 v143, 0xffff0000, v26
 v_mul_f32 v142, v142, v33
 v_mul_f32 v143, v143, v33
 v_cvt_pk_bf16_f32 v26, v142, v143
 v_lshlrev_b32 v142, 16, v26
 v_and_b32 v143, 0xffff0000, v26
 s_waitcnt vmcnt(19)
 v_cvt_pk_bf16_f32 v26, v144, v145
 v_lshlrev_b32 v144, 16, v26
 v_and_b32 v145, 0xffff0000, v26
 v_mul_f32 v144, v144, v30
 v_mul_f32 v145, v145, v30
 v_cvt_pk_bf16_f32 v26, v144, v145
 v_lshlrev_b32 v144, 16, v26
 v_and_b32 v145, 0xffff0000, v26
 v_add_f32 v144, v144, v64
 v_add_f32 v145, v145, v65
 v_cvt_pk_bf16_f32 v64, v144, v145
 v_cvt_pk_bf16_f32 v26, v146, v147
 v_lshlrev_b32 v146, 16, v26
 v_and_b32 v147, 0xffff0000, v26
 v_mul_f32 v146, v146, v30
 v_mul_f32 v147, v147, v30
 v_cvt_pk_bf16_f32 v26, v146, v147
 v_lshlrev_b32 v146, 16, v26
 v_and_b32 v147, 0xffff0000, v26
 v_add_f32 v146, v146, v66
 v_add_f32 v147, v147, v67
 v_cvt_pk_bf16_f32 v65, v146, v147
 buffer_store_dwordx2 v[64:65], v9, s[8:11], s22 offen offset:0
 s_waitcnt vmcnt(19)
 v_cvt_pk_bf16_f32 v26, v148, v149
 v_lshlrev_b32 v148, 16, v26
 v_and_b32 v149, 0xffff0000, v26
 v_mul_f32 v148, v148, v30
 v_mul_f32 v149, v149, v30
 v_cvt_pk_bf16_f32 v26, v148, v149
 v_lshlrev_b32 v148, 16, v26
 v_and_b32 v149, 0xffff0000, v26
 v_add_f32 v148, v148, v68
 v_add_f32 v149, v149, v69
 v_cvt_pk_bf16_f32 v68, v148, v149
 v_cvt_pk_bf16_f32 v26, v150, v151
 v_lshlrev_b32 v150, 16, v26
 v_and_b32 v151, 0xffff0000, v26
 v_mul_f32 v150, v150, v30
 v_mul_f32 v151, v151, v30
 v_cvt_pk_bf16_f32 v26, v150, v151
 v_lshlrev_b32 v150, 16, v26
 v_and_b32 v151, 0xffff0000, v26
 v_add_f32 v150, v150, v70
 v_add_f32 v151, v151, v71
 v_cvt_pk_bf16_f32 v69, v150, v151
 buffer_store_dwordx2 v[68:69], v9, s[8:11], s22 offen offset:32
 s_waitcnt vmcnt(19)
 v_cvt_pk_bf16_f32 v26, v152, v153
 v_lshlrev_b32 v152, 16, v26
 v_and_b32 v153, 0xffff0000, v26
 v_mul_f32 v152, v152, v30
 v_mul_f32 v153, v153, v30
 v_cvt_pk_bf16_f32 v26, v152, v153
 v_lshlrev_b32 v152, 16, v26
 v_and_b32 v153, 0xffff0000, v26
 v_add_f32 v152, v152, v72
 v_add_f32 v153, v153, v73
 v_cvt_pk_bf16_f32 v72, v152, v153
 v_cvt_pk_bf16_f32 v26, v154, v155
 v_lshlrev_b32 v154, 16, v26
 v_and_b32 v155, 0xffff0000, v26
 v_mul_f32 v154, v154, v30
 v_mul_f32 v155, v155, v30
 v_cvt_pk_bf16_f32 v26, v154, v155
 v_lshlrev_b32 v154, 16, v26
 v_and_b32 v155, 0xffff0000, v26
 v_add_f32 v154, v154, v74
 v_add_f32 v155, v155, v75
 v_cvt_pk_bf16_f32 v73, v154, v155
 buffer_store_dwordx2 v[72:73], v9, s[8:11], s22 offen offset:64
 s_waitcnt vmcnt(19)
 v_cvt_pk_bf16_f32 v26, v156, v157
 v_lshlrev_b32 v156, 16, v26
 v_and_b32 v157, 0xffff0000, v26
 v_mul_f32 v156, v156, v30
 v_mul_f32 v157, v157, v30
 v_cvt_pk_bf16_f32 v26, v156, v157
 v_lshlrev_b32 v156, 16, v26
 v_and_b32 v157, 0xffff0000, v26
 v_add_f32 v156, v156, v76
 v_add_f32 v157, v157, v77
 v_cvt_pk_bf16_f32 v76, v156, v157
 v_cvt_pk_bf16_f32 v26, v158, v159
 v_lshlrev_b32 v158, 16, v26
 v_and_b32 v159, 0xffff0000, v26
 v_mul_f32 v158, v158, v30
 v_mul_f32 v159, v159, v30
 v_cvt_pk_bf16_f32 v26, v158, v159
 v_lshlrev_b32 v158, 16, v26
 v_and_b32 v159, 0xffff0000, v26
 v_add_f32 v158, v158, v78
 v_add_f32 v159, v159, v79
 v_cvt_pk_bf16_f32 v77, v158, v159
 buffer_store_dwordx2 v[76:77], v9, s[8:11], s22 offen offset:96
 s_waitcnt vmcnt(19)
 v_cvt_pk_bf16_f32 v26, v160, v161
 v_lshlrev_b32 v160, 16, v26
 v_and_b32 v161, 0xffff0000, v26
 v_mul_f32 v160, v160, v30
 v_mul_f32 v161, v161, v30
 v_cvt_pk_bf16_f32 v26, v160, v161
 v_lshlrev_b32 v160, 16, v26
 v_and_b32 v161, 0xffff0000, v26
 v_add_f32 v160, v160, v80
 v_add_f32 v161, v161, v81
 v_cvt_pk_bf16_f32 v80, v160, v161
 v_cvt_pk_bf16_f32 v26, v162, v163
 v_lshlrev_b32 v162, 16, v26
 v_and_b32 v163, 0xffff0000, v26
 v_mul_f32 v162, v162, v30
 v_mul_f32 v163, v163, v30
 v_cvt_pk_bf16_f32 v26, v162, v163
 v_lshlrev_b32 v162, 16, v26
 v_and_b32 v163, 0xffff0000, v26
 v_add_f32 v162, v162, v82
 v_add_f32 v163, v163, v83
 v_cvt_pk_bf16_f32 v81, v162, v163
 buffer_store_dwordx2 v[80:81], v9, s[8:11], s22 offen offset:128
 s_waitcnt vmcnt(19)
 v_cvt_pk_bf16_f32 v26, v164, v165
 v_lshlrev_b32 v164, 16, v26
 v_and_b32 v165, 0xffff0000, v26
 v_mul_f32 v164, v164, v30
 v_mul_f32 v165, v165, v30
 v_cvt_pk_bf16_f32 v26, v164, v165
 v_lshlrev_b32 v164, 16, v26
 v_and_b32 v165, 0xffff0000, v26
 v_add_f32 v164, v164, v84
 v_add_f32 v165, v165, v85
 v_cvt_pk_bf16_f32 v84, v164, v165
 v_cvt_pk_bf16_f32 v26, v166, v167
 v_lshlrev_b32 v166, 16, v26
 v_and_b32 v167, 0xffff0000, v26
 v_mul_f32 v166, v166, v30
 v_mul_f32 v167, v167, v30
 v_cvt_pk_bf16_f32 v26, v166, v167
 v_lshlrev_b32 v166, 16, v26
 v_and_b32 v167, 0xffff0000, v26
 v_add_f32 v166, v166, v86
 v_add_f32 v167, v167, v87
 v_cvt_pk_bf16_f32 v85, v166, v167
 buffer_store_dwordx2 v[84:85], v9, s[8:11], s22 offen offset:160
 s_waitcnt vmcnt(19)
 v_cvt_pk_bf16_f32 v26, v168, v169
 v_lshlrev_b32 v168, 16, v26
 v_and_b32 v169, 0xffff0000, v26
 v_mul_f32 v168, v168, v30
 v_mul_f32 v169, v169, v30
 v_cvt_pk_bf16_f32 v26, v168, v169
 v_lshlrev_b32 v168, 16, v26
 v_and_b32 v169, 0xffff0000, v26
 v_add_f32 v168, v168, v88
 v_add_f32 v169, v169, v89
 v_cvt_pk_bf16_f32 v88, v168, v169
 v_cvt_pk_bf16_f32 v26, v170, v171
 v_lshlrev_b32 v170, 16, v26
 v_and_b32 v171, 0xffff0000, v26
 v_mul_f32 v170, v170, v30
 v_mul_f32 v171, v171, v30
 v_cvt_pk_bf16_f32 v26, v170, v171
 v_lshlrev_b32 v170, 16, v26
 v_and_b32 v171, 0xffff0000, v26
 v_add_f32 v170, v170, v90
 v_add_f32 v171, v171, v91
 v_cvt_pk_bf16_f32 v89, v170, v171
 buffer_store_dwordx2 v[88:89], v9, s[8:11], s22 offen offset:192
 s_waitcnt vmcnt(19)
 v_cvt_pk_bf16_f32 v26, v172, v173
 v_lshlrev_b32 v172, 16, v26
 v_and_b32 v173, 0xffff0000, v26
 v_mul_f32 v172, v172, v30
 v_mul_f32 v173, v173, v30
 v_cvt_pk_bf16_f32 v26, v172, v173
 v_lshlrev_b32 v172, 16, v26
 v_and_b32 v173, 0xffff0000, v26
 v_add_f32 v172, v172, v92
 v_add_f32 v173, v173, v93
 v_cvt_pk_bf16_f32 v92, v172, v173
 v_cvt_pk_bf16_f32 v26, v174, v175
 v_lshlrev_b32 v174, 16, v26
 v_and_b32 v175, 0xffff0000, v26
 v_mul_f32 v174, v174, v30
 v_mul_f32 v175, v175, v30
 v_cvt_pk_bf16_f32 v26, v174, v175
 v_lshlrev_b32 v174, 16, v26
 v_and_b32 v175, 0xffff0000, v26
 v_add_f32 v174, v174, v94
 v_add_f32 v175, v175, v95
 v_cvt_pk_bf16_f32 v93, v174, v175
 buffer_store_dwordx2 v[92:93], v9, s[8:11], s22 offen offset:224
 s_waitcnt vmcnt(19)
 v_cvt_pk_bf16_f32 v26, v176, v177
 v_lshlrev_b32 v176, 16, v26
 v_and_b32 v177, 0xffff0000, v26
 v_mul_f32 v176, v176, v30
 v_mul_f32 v177, v177, v30
 v_cvt_pk_bf16_f32 v26, v176, v177
 v_lshlrev_b32 v176, 16, v26
 v_and_b32 v177, 0xffff0000, v26
 v_add_f32 v176, v176, v96
 v_add_f32 v177, v177, v97
 v_cvt_pk_bf16_f32 v96, v176, v177
 v_cvt_pk_bf16_f32 v26, v178, v179
 v_lshlrev_b32 v178, 16, v26
 v_and_b32 v179, 0xffff0000, v26
 v_mul_f32 v178, v178, v30
 v_mul_f32 v179, v179, v30
 v_cvt_pk_bf16_f32 v26, v178, v179
 v_lshlrev_b32 v178, 16, v26
 v_and_b32 v179, 0xffff0000, v26
 v_add_f32 v178, v178, v98
 v_add_f32 v179, v179, v99
 v_cvt_pk_bf16_f32 v97, v178, v179
 buffer_store_dwordx2 v[96:97], v9, s[8:11], s22 offen offset:256
 s_waitcnt vmcnt(19)
 v_cvt_pk_bf16_f32 v26, v180, v181
 v_lshlrev_b32 v180, 16, v26
 v_and_b32 v181, 0xffff0000, v26
 v_mul_f32 v180, v180, v30
 v_mul_f32 v181, v181, v30
 v_cvt_pk_bf16_f32 v26, v180, v181
 v_lshlrev_b32 v180, 16, v26
 v_and_b32 v181, 0xffff0000, v26
 v_add_f32 v180, v180, v100
 v_add_f32 v181, v181, v101
 v_cvt_pk_bf16_f32 v100, v180, v181
 v_cvt_pk_bf16_f32 v26, v182, v183
 v_lshlrev_b32 v182, 16, v26
 v_and_b32 v183, 0xffff0000, v26
 v_mul_f32 v182, v182, v30
 v_mul_f32 v183, v183, v30
 v_cvt_pk_bf16_f32 v26, v182, v183
 v_lshlrev_b32 v182, 16, v26
 v_and_b32 v183, 0xffff0000, v26
 v_add_f32 v182, v182, v102
 v_add_f32 v183, v183, v103
 v_cvt_pk_bf16_f32 v101, v182, v183
 buffer_store_dwordx2 v[100:101], v9, s[8:11], s22 offen offset:288
 s_waitcnt vmcnt(19)
 v_cvt_pk_bf16_f32 v26, v184, v185
 v_lshlrev_b32 v184, 16, v26
 v_and_b32 v185, 0xffff0000, v26
 v_mul_f32 v184, v184, v31
 v_mul_f32 v185, v185, v31
 v_cvt_pk_bf16_f32 v26, v184, v185
 v_lshlrev_b32 v184, 16, v26
 v_and_b32 v185, 0xffff0000, v26
 v_add_f32 v184, v184, v104
 v_add_f32 v185, v185, v105
 v_cvt_pk_bf16_f32 v104, v184, v185
 v_cvt_pk_bf16_f32 v26, v186, v187
 v_lshlrev_b32 v186, 16, v26
 v_and_b32 v187, 0xffff0000, v26
 v_mul_f32 v186, v186, v31
 v_mul_f32 v187, v187, v31
 v_cvt_pk_bf16_f32 v26, v186, v187
 v_lshlrev_b32 v186, 16, v26
 v_and_b32 v187, 0xffff0000, v26
 v_add_f32 v186, v186, v106
 v_add_f32 v187, v187, v107
 v_cvt_pk_bf16_f32 v105, v186, v187
 buffer_store_dwordx2 v[104:105], v9, s[8:11], s23 offen offset:0
 s_waitcnt vmcnt(19)
 v_cvt_pk_bf16_f32 v26, v188, v189
 v_lshlrev_b32 v188, 16, v26
 v_and_b32 v189, 0xffff0000, v26
 v_mul_f32 v188, v188, v31
 v_mul_f32 v189, v189, v31
 v_cvt_pk_bf16_f32 v26, v188, v189
 v_lshlrev_b32 v188, 16, v26
 v_and_b32 v189, 0xffff0000, v26
 v_add_f32 v188, v188, v108
 v_add_f32 v189, v189, v109
 v_cvt_pk_bf16_f32 v108, v188, v189
 v_cvt_pk_bf16_f32 v26, v190, v191
 v_lshlrev_b32 v190, 16, v26
 v_and_b32 v191, 0xffff0000, v26
 v_mul_f32 v190, v190, v31
 v_mul_f32 v191, v191, v31
 v_cvt_pk_bf16_f32 v26, v190, v191
 v_lshlrev_b32 v190, 16, v26
 v_and_b32 v191, 0xffff0000, v26
 v_add_f32 v190, v190, v110
 v_add_f32 v191, v191, v111
 v_cvt_pk_bf16_f32 v109, v190, v191
 buffer_store_dwordx2 v[108:109], v9, s[8:11], s23 offen offset:32
 s_waitcnt vmcnt(19)
 v_cvt_pk_bf16_f32 v26, v192, v193
 v_lshlrev_b32 v192, 16, v26
 v_and_b32 v193, 0xffff0000, v26
 v_mul_f32 v192, v192, v31
 v_mul_f32 v193, v193, v31
 v_cvt_pk_bf16_f32 v26, v192, v193
 v_lshlrev_b32 v192, 16, v26
 v_and_b32 v193, 0xffff0000, v26
 v_add_f32 v192, v192, v112
 v_add_f32 v193, v193, v113
 v_cvt_pk_bf16_f32 v112, v192, v193
 v_cvt_pk_bf16_f32 v26, v194, v195
 v_lshlrev_b32 v194, 16, v26
 v_and_b32 v195, 0xffff0000, v26
 v_mul_f32 v194, v194, v31
 v_mul_f32 v195, v195, v31
 v_cvt_pk_bf16_f32 v26, v194, v195
 v_lshlrev_b32 v194, 16, v26
 v_and_b32 v195, 0xffff0000, v26
 v_add_f32 v194, v194, v114
 v_add_f32 v195, v195, v115
 v_cvt_pk_bf16_f32 v113, v194, v195
 buffer_store_dwordx2 v[112:113], v9, s[8:11], s23 offen offset:64
 s_waitcnt vmcnt(19)
 v_cvt_pk_bf16_f32 v26, v196, v197
 v_lshlrev_b32 v196, 16, v26
 v_and_b32 v197, 0xffff0000, v26
 v_mul_f32 v196, v196, v31
 v_mul_f32 v197, v197, v31
 v_cvt_pk_bf16_f32 v26, v196, v197
 v_lshlrev_b32 v196, 16, v26
 v_and_b32 v197, 0xffff0000, v26
 v_add_f32 v196, v196, v116
 v_add_f32 v197, v197, v117
 v_cvt_pk_bf16_f32 v116, v196, v197
 v_cvt_pk_bf16_f32 v26, v198, v199
 v_lshlrev_b32 v198, 16, v26
 v_and_b32 v199, 0xffff0000, v26
 v_mul_f32 v198, v198, v31
 v_mul_f32 v199, v199, v31
 v_cvt_pk_bf16_f32 v26, v198, v199
 v_lshlrev_b32 v198, 16, v26
 v_and_b32 v199, 0xffff0000, v26
 v_add_f32 v198, v198, v118
 v_add_f32 v199, v199, v119
 v_cvt_pk_bf16_f32 v117, v198, v199
 buffer_store_dwordx2 v[116:117], v9, s[8:11], s23 offen offset:96
 s_waitcnt vmcnt(19)
 v_cvt_pk_bf16_f32 v26, v200, v201
 v_lshlrev_b32 v200, 16, v26
 v_and_b32 v201, 0xffff0000, v26
 v_mul_f32 v200, v200, v31
 v_mul_f32 v201, v201, v31
 v_cvt_pk_bf16_f32 v26, v200, v201
 v_lshlrev_b32 v200, 16, v26
 v_and_b32 v201, 0xffff0000, v26
 v_add_f32 v200, v200, v120
 v_add_f32 v201, v201, v121
 v_cvt_pk_bf16_f32 v120, v200, v201
 v_cvt_pk_bf16_f32 v26, v202, v203
 v_lshlrev_b32 v202, 16, v26
 v_and_b32 v203, 0xffff0000, v26
 v_mul_f32 v202, v202, v31
 v_mul_f32 v203, v203, v31
 v_cvt_pk_bf16_f32 v26, v202, v203
 v_lshlrev_b32 v202, 16, v26
 v_and_b32 v203, 0xffff0000, v26
 v_add_f32 v202, v202, v122
 v_add_f32 v203, v203, v123
 v_cvt_pk_bf16_f32 v121, v202, v203
 buffer_store_dwordx2 v[120:121], v9, s[8:11], s23 offen offset:128
 s_waitcnt vmcnt(19)
 v_cvt_pk_bf16_f32 v26, v204, v205
 v_lshlrev_b32 v204, 16, v26
 v_and_b32 v205, 0xffff0000, v26
 v_mul_f32 v204, v204, v31
 v_mul_f32 v205, v205, v31
 v_cvt_pk_bf16_f32 v26, v204, v205
 v_lshlrev_b32 v204, 16, v26
 v_and_b32 v205, 0xffff0000, v26
 v_add_f32 v204, v204, v124
 v_add_f32 v205, v205, v125
 v_cvt_pk_bf16_f32 v124, v204, v205
 v_cvt_pk_bf16_f32 v26, v206, v207
 v_lshlrev_b32 v206, 16, v26
 v_and_b32 v207, 0xffff0000, v26
 v_mul_f32 v206, v206, v31
 v_mul_f32 v207, v207, v31
 v_cvt_pk_bf16_f32 v26, v206, v207
 v_lshlrev_b32 v206, 16, v26
 v_and_b32 v207, 0xffff0000, v26
 v_add_f32 v206, v206, v126
 v_add_f32 v207, v207, v127
 v_cvt_pk_bf16_f32 v125, v206, v207
 buffer_store_dwordx2 v[124:125], v9, s[8:11], s23 offen offset:160
 s_waitcnt vmcnt(19)
 v_cvt_pk_bf16_f32 v26, v208, v209
 v_lshlrev_b32 v208, 16, v26
 v_and_b32 v209, 0xffff0000, v26
 v_mul_f32 v208, v208, v31
 v_mul_f32 v209, v209, v31
 v_cvt_pk_bf16_f32 v26, v208, v209
 v_lshlrev_b32 v208, 16, v26
 v_and_b32 v209, 0xffff0000, v26
 v_add_f32 v208, v208, v128
 v_add_f32 v209, v209, v129
 v_cvt_pk_bf16_f32 v128, v208, v209
 v_cvt_pk_bf16_f32 v26, v210, v211
 v_lshlrev_b32 v210, 16, v26
 v_and_b32 v211, 0xffff0000, v26
 v_mul_f32 v210, v210, v31
 v_mul_f32 v211, v211, v31
 v_cvt_pk_bf16_f32 v26, v210, v211
 v_lshlrev_b32 v210, 16, v26
 v_and_b32 v211, 0xffff0000, v26
 v_add_f32 v210, v210, v130
 v_add_f32 v211, v211, v131
 v_cvt_pk_bf16_f32 v129, v210, v211
 buffer_store_dwordx2 v[128:129], v9, s[8:11], s23 offen offset:192
 s_waitcnt vmcnt(19)
 v_cvt_pk_bf16_f32 v26, v212, v213
 v_lshlrev_b32 v212, 16, v26
 v_and_b32 v213, 0xffff0000, v26
 v_mul_f32 v212, v212, v31
 v_mul_f32 v213, v213, v31
 v_cvt_pk_bf16_f32 v26, v212, v213
 v_lshlrev_b32 v212, 16, v26
 v_and_b32 v213, 0xffff0000, v26
 v_add_f32 v212, v212, v132
 v_add_f32 v213, v213, v133
 v_cvt_pk_bf16_f32 v132, v212, v213
 v_cvt_pk_bf16_f32 v26, v214, v215
 v_lshlrev_b32 v214, 16, v26
 v_and_b32 v215, 0xffff0000, v26
 v_mul_f32 v214, v214, v31
 v_mul_f32 v215, v215, v31
 v_cvt_pk_bf16_f32 v26, v214, v215
 v_lshlrev_b32 v214, 16, v26
 v_and_b32 v215, 0xffff0000, v26
 v_add_f32 v214, v214, v134
 v_add_f32 v215, v215, v135
 v_cvt_pk_bf16_f32 v133, v214, v215
 buffer_store_dwordx2 v[132:133], v9, s[8:11], s23 offen offset:224
 s_waitcnt vmcnt(19)
 v_cvt_pk_bf16_f32 v26, v216, v217
 v_lshlrev_b32 v216, 16, v26
 v_and_b32 v217, 0xffff0000, v26
 v_mul_f32 v216, v216, v31
 v_mul_f32 v217, v217, v31
 v_cvt_pk_bf16_f32 v26, v216, v217
 v_lshlrev_b32 v216, 16, v26
 v_and_b32 v217, 0xffff0000, v26
 v_add_f32 v216, v216, v136
 v_add_f32 v217, v217, v137
 v_cvt_pk_bf16_f32 v136, v216, v217
 v_cvt_pk_bf16_f32 v26, v218, v219
 v_lshlrev_b32 v218, 16, v26
 v_and_b32 v219, 0xffff0000, v26
 v_mul_f32 v218, v218, v31
 v_mul_f32 v219, v219, v31
 v_cvt_pk_bf16_f32 v26, v218, v219
 v_lshlrev_b32 v218, 16, v26
 v_and_b32 v219, 0xffff0000, v26
 v_add_f32 v218, v218, v138
 v_add_f32 v219, v219, v139
 v_cvt_pk_bf16_f32 v137, v218, v219
 buffer_store_dwordx2 v[136:137], v9, s[8:11], s23 offen offset:256
 s_waitcnt vmcnt(19)
 v_cvt_pk_bf16_f32 v26, v220, v221
 v_lshlrev_b32 v220, 16, v26
 v_and_b32 v221, 0xffff0000, v26
 v_mul_f32 v220, v220, v31
 v_mul_f32 v221, v221, v31
 v_cvt_pk_bf16_f32 v26, v220, v221
 v_lshlrev_b32 v220, 16, v26
 v_and_b32 v221, 0xffff0000, v26
 v_add_f32 v220, v220, v140
 v_add_f32 v221, v221, v141
 v_cvt_pk_bf16_f32 v140, v220, v221
 v_cvt_pk_bf16_f32 v26, v222, v223
 v_lshlrev_b32 v222, 16, v26
 v_and_b32 v223, 0xffff0000, v26
 v_mul_f32 v222, v222, v31
 v_mul_f32 v223, v223, v31
 v_cvt_pk_bf16_f32 v26, v222, v223
 v_lshlrev_b32 v222, 16, v26
 v_and_b32 v223, 0xffff0000, v26
 v_add_f32 v222, v222, v142
 v_add_f32 v223, v223, v143
 v_cvt_pk_bf16_f32 v141, v222, v223
 buffer_store_dwordx2 v[140:141], v9, s[8:11], s23 offen offset:288
om_243:
 s_waitcnt vmcnt(0) lgkmcnt(0)
 s_barrier
 s_sub_u32 s21, s2, 16
 s_cmp_ge_u32 s2, 48
 s_cbranch_scc1 do_opb2
 s_cmp_eq_u32 s87, -1
 s_cbranch_scc1 queue
tail_item:
 s_load_dwordx2 s[4:5], s[0:1], 96
 s_waitcnt lgkmcnt(0)
 s_mov_b32 s32, s4
 s_mov_b32 s33, s5
 s_mov_b32 s34, 256
 s_mov_b32 s35, 0x00020000
 s_waitcnt vmcnt(0)
 s_barrier
 s_mov_b32 s21, s87
do_pv:
 s_mov_b32 s2, s21
 s_load_dwordx2 s[4:5], s[0:1], 88
 s_load_dwordx2 s[38:39], s[0:1], 104
 s_waitcnt lgkmcnt(0)
 s_mov_b32 s8, s4
 s_mov_b32 s9, s5
 s_mov_b32 s10, 2621440
 s_mov_b32 s11, 0x00020000
 s_add_u32 s12, s38, 88080384
 s_addc_u32 s13, s39, 0
 s_mov_b32 s14, 83886080
 s_mov_b32 s15, 0x00020000
 s_mov_b32 s59, 0
 s_mov_b32 s60, 0
 s_add_u32 s16, s38, 180355072
 s_addc_u32 s17, s39, 0
 s_mov_b32 s18, 67108864
 s_mov_b32 s19, 0x00020000
 s_add_u32 s24, s38, 180355072
 s_addc_u32 s25, s39, 0
 s_mov_b32 s26, 67108864
 s_mov_b32 s27, 0x00020000
 s_add_u32 s28, s38, 81002496
 s_addc_u32 s29, s39, 0
 s_mov_b32 s30, 8192
 s_mov_b32 s31, 0x00020000
 s_add_u32 s72, s38, 81068032
 s_addc_u32 s73, s39, 0
 s_mov_b32 s74, 129024
 s_mov_b32 s75, 0x00020000
 v_lshlrev_b32 v4, 4, v1
 v_lshlrev_b32 v5, 3, v1
 v_lshlrev_b32 v6, 2, v2
 v_and_b32 v7, 7, v1
 v_lshlrev_b32 v7, 7, v7
 v_lshrrev_b32 v31, 3, v1
 v_lshl_add_u32 v208, v31, 10, v7
 v_bfe_u32 v31, v1, 3, 2
 v_lshl_add_u32 v31, v31, 12, v7
 s_lshl_b32 s21, s20, 10
 s_add_u32 s21, s21, 95232
 buffer_load_dword v8, v31, s[72:75], s21 offen sc1
 v_lshlrev_b32 v25, 7, v2
 s_mov_b32 s21, 93184
 buffer_load_dword v26, v25, s[72:75], s21 offen sc1
 s_mov_b32 s63, 1
 v_mul_u32_u24 v9, 1280, v2
 v_lshl_add_u32 v9, v3, 3, v9
 s_lshl_b32 s21, s20, 13
 v_add_u32 v10, s21, v4
 s_lshl_b32 s21, s20, 10
 v_add_u32 v11, s21, v4
 v_lshrrev_b32 v20, 5, v1
 v_mul_u32_u24 v21, 2560, v20
 v_add_u32 v21, v21, v4
 v_and_b32 v22, 31, v1
 v_lshlrev_b32 v22, 4, v22
 v_mul_u32_u24 v20, 10240, v20
 v_add_u32 v22, v22, v20
 v_mul_u32_u24 v21, 2048, v3
 v_lshl_add_u32 v21, v2, 4, v21
 v_mul_u32_u24 v22, 1024, v3
 v_lshl_add_u32 v22, v2, 4, v22
 v_mov_b32 v28, 80
 v_mov_b32 v30, 32768
 s_mov_b32 s50, 0
 s_mov_b32 s71, 0
 s_mov_b32 s51, 0
 s_and_b32 s43, s20, 1
 s_lshr_b32 s44, s20, 1
 v_mov_b32 v70, 0
 v_mov_b32 v71, 0
 v_mov_b32 v78, 0
 v_mov_b32 v79, 0
 v_mov_b32 v86, 0
 v_mov_b32 v87, 0
 v_mov_b32 v94, 0
 v_mov_b32 v95, 0
 v_mov_b32 v102, 0
 v_mov_b32 v103, 0
 v_mov_b32 v110, 0
 v_mov_b32 v111, 0
 v_mov_b32 v118, 0
 v_mov_b32 v119, 0
 v_mov_b32 v126, 0
 v_mov_b32 v127, 0
 s_mov_b32 s21, s2
pv_loop:
 s_mul_i32 s2, s21, 2
 s_add_u32 s2, s2, 192
 s_add_u32 s22, s21, 376
 s_cmp_lt_u32 s21, 184
 s_cselect_b32 s2, s2, s22
 s_cselect_b32 s65, 1, 0
 s_mul_i32 s22, s21, 5
 s_cmp_lt_u32 s21, 64
 s_cselect_b32 s2, s22, s2
 s_cselect_b32 s65, 4, s65
 s_mul_hi_u32 s40, s2, 0x1999999a
 s_mul_i32 s21, s40, 10
 s_sub_u32 s41, s2, s21
 s_lshl_b32 s52, s40, 10
 s_add_u32 s52, s52, 23552
 buffer_load_dword v27, v7, s[72:75], s52 offen sc1
 s_cmp_lg_u32 s20, 0
 s_cbranch_scc1 pv_255
 s_sub_u32 s21, s2, 0
 s_cmp_lt_u32 s21, 640
 s_cbranch_scc1 pv_255
 v_mov_b32 v29, 1
 s_mov_b64 exec, 1
 buffer_atomic_add v29, v28, s[32:35], 0 offen sc0 sc1
 s_mov_b64 exec, -1
pv_255:
 s_lshl_b32 s42, s40, 5
 s_lshl_b32 s21, s20, 3
 s_add_u32 s42, s42, s21
 s_lshr_b32 s22, s40, 1
 s_bitcmp1_b32 s37, s22
 s_cselect_b32 s22, 8192, 0
 s_lshl_b32 s62, s40, 20
 s_or_b32 s62, s62, s22
 s_cmp_ge_u32 s40, 40
 s_cselect_b32 s61, 8192, 0
 s_xor_b32 s61, s61, s62
 s_mul_i32 s53, s42, 40960
 s_lshl_b32 s22, s41, 12
 s_add_u32 s53, s53, s22
 s_lshl_b32 s21, s40, 1
 s_add_u32 s21, s21, s43
 s_lshl_b32 s45, s21, 6
 s_mul_i32 s46, s21, 20480
 s_lshl_b32 s21, s41, 4
 s_lshl_b32 s22, s43, 2
 s_add_u32 s21, s21, s22
 s_add_u32 s21, s21, s44
 s_lshl_b32 s54, s21, 10
 s_add_u32 s54, s54, s62
 s_add_u32 s54, s54, 786432
 s_lshl_b32 s22, s41, 2
 s_add_u32 s22, s22, s44
 s_lshl_b32 s22, s22, 5
 s_add_u32 s46, s46, s22
 s_lshl_b32 s47, s20, 15
 s_add_u32 s47, s47, s62
 s_add_u32 s47, s47, 655360
 s_lshl_b32 s48, s41, 16
 s_lshl_b32 s22, s20, 14
 s_add_u32 s48, s48, s22
 s_add_u32 s48, s48, s61
 s_add_u32 s23, s40, 1
 s_cmp_ge_u32 s50, s23
 s_cbranch_scc1 pv_248
 s_cmp_eq_u32 s63, 0
 s_cbranch_scc1 pv_251
 s_mov_b32 s63, 0
 s_waitcnt vmcnt(1)
 v_cmp_le_u32 vcc, 4, v26
 s_mov_b32 s51, vcc_lo
 v_cmp_gt_u32 vcc, s23, v8
 s_nop 1
 s_cbranch_vccz pv_252
pv_251:
 s_lshl_b32 s21, s20, 10
 s_add_u32 s21, s21, 95232
 s_mov_b32 s101, 0
wm_256:
 buffer_load_dword v8, v31, s[72:75], s21 offen sc1
 s_add_u32 s101, s101, 1
 s_cmp_gt_u32 s101, 131072
 s_cbranch_scc1 main_end
 s_waitcnt vmcnt(0)
 v_cmp_gt_u32 vcc, s23, v8
 v_readfirstlane_b32 s100, v8
 s_nop 0
 s_cbranch_vccz wm_257
 s_sleep 8
 s_add_u32 s100, s100, 2
 s_cmp_ge_u32 s100, s23
 s_cbranch_scc1 wm_256
 s_sleep 60
 s_branch wm_256
wm_257:
pv_252:
 v_readlane_b32 s50, v8, 0
 v_readlane_b32 s21, v8, 1
 s_min_u32 s50, s50, s21
 v_readlane_b32 s21, v8, 2
 s_min_u32 s50, s50, s21
 v_readlane_b32 s21, v8, 3
 s_min_u32 s50, s50, s21
 v_readlane_b32 s21, v8, 4
 s_min_u32 s50, s50, s21
 v_readlane_b32 s21, v8, 5
 s_min_u32 s50, s50, s21
 v_readlane_b32 s21, v8, 6
 s_min_u32 s50, s50, s21
 v_readlane_b32 s21, v8, 7
 s_min_u32 s50, s50, s21
 v_readlane_b32 s21, v8, 8
 s_min_u32 s50, s50, s21
 v_readlane_b32 s21, v8, 9
 s_min_u32 s50, s50, s21
 v_readlane_b32 s21, v8, 10
 s_min_u32 s50, s50, s21
 v_readlane_b32 s21, v8, 11
 s_min_u32 s50, s50, s21
 v_readlane_b32 s21, v8, 12
 s_min_u32 s50, s50, s21
 v_readlane_b32 s21, v8, 13
 s_min_u32 s50, s50, s21
 v_readlane_b32 s21, v8, 14
 s_min_u32 s50, s50, s21
 v_readlane_b32 s21, v8, 15
 s_min_u32 s50, s50, s21
 v_readlane_b32 s21, v8, 16
 s_min_u32 s50, s50, s21
 v_readlane_b32 s21, v8, 17
 s_min_u32 s50, s50, s21
 v_readlane_b32 s21, v8, 18
 s_min_u32 s50, s50, s21
 v_readlane_b32 s21, v8, 19
 s_min_u32 s50, s50, s21
 v_readlane_b32 s21, v8, 20
 s_min_u32 s50, s50, s21
 v_readlane_b32 s21, v8, 21
 s_min_u32 s50, s50, s21
 v_readlane_b32 s21, v8, 22
 s_min_u32 s50, s50, s21
 v_readlane_b32 s21, v8, 23
 s_min_u32 s50, s50, s21
 v_readlane_b32 s21, v8, 24
 s_min_u32 s50, s50, s21
 v_readlane_b32 s21, v8, 25
 s_min_u32 s50, s50, s21
 v_readlane_b32 s21, v8, 26
 s_min_u32 s50, s50, s21
 v_readlane_b32 s21, v8, 27
 s_min_u32 s50, s50, s21
 v_readlane_b32 s21, v8, 28
 s_min_u32 s50, s50, s21
 v_readlane_b32 s21, v8, 29
 s_min_u32 s50, s50, s21
 v_readlane_b32 s21, v8, 30
 s_min_u32 s50, s50, s21
 v_readlane_b32 s21, v8, 31
 s_min_u32 s50, s50, s21
pv_248:
 s_lshr_b32 s22, s40, 2
 s_cmp_lt_u32 s40, 48
 s_cbranch_scc1 pv_249
 s_bitcmp1_b32 s51, s22
 s_cbranch_scc1 pv_249
 s_mov_b32 s21, 93184
 v_lshlrev_b32 v25, 7, v2
 s_mov_b32 s101, 0
pv_250:
 buffer_load_dword v26, v25, s[72:75], s21 offen sc1
 s_add_u32 s101, s101, 1
 s_cmp_gt_u32 s101, 131072
 s_cbranch_scc1 main_end
 s_waitcnt vmcnt(0)
 v_cmp_le_u32 vcc, 4, v26
 s_mov_b32 s51, vcc_lo
 s_bitcmp1_b32 s51, s22
 s_cbranch_scc1 pv_249
 s_sleep 8
 s_branch pv_250
pv_249:
 buffer_load_dwordx4 a[0:3], v4, s[12:15], s53 offen offset:0 sc1
 buffer_load_dwordx4 a[4:7], v4, s[12:15], s53 offen offset:1024 sc1
 buffer_load_dwordx4 a[8:11], v4, s[12:15], s53 offen offset:2048 sc1
 buffer_load_dwordx4 a[12:15], v4, s[12:15], s53 offen offset:3072 sc1
 s_add_u32 s53, s53, 40960
 buffer_load_dwordx4 a[16:19], v4, s[12:15], s53 offen offset:0 sc1
 buffer_load_dwordx4 a[20:23], v4, s[12:15], s53 offen offset:1024 sc1
 buffer_load_dwordx4 a[24:27], v4, s[12:15], s53 offen offset:2048 sc1
 buffer_load_dwordx4 a[28:31], v4, s[12:15], s53 offen offset:3072 sc1
 s_add_u32 s53, s53, 40960
 buffer_load_dwordx4 a[32:35], v4, s[12:15], s53 offen offset:0 sc1
 buffer_load_dwordx4 a[36:39], v4, s[12:15], s53 offen offset:1024 sc1
 buffer_load_dwordx4 a[40:43], v4, s[12:15], s53 offen offset:2048 sc1
 buffer_load_dwordx4 a[44:47], v4, s[12:15], s53 offen offset:3072 sc1
 s_add_u32 s53, s53, 40960
 buffer_load_dwordx4 a[48:51], v4, s[12:15], s53 offen offset:0 sc1
 buffer_load_dwordx4 a[52:55], v4, s[12:15], s53 offen offset:1024 sc1
 buffer_load_dwordx4 a[56:59], v4, s[12:15], s53 offen offset:2048 sc1
 buffer_load_dwordx4 a[60:63], v4, s[12:15], s53 offen offset:3072 sc1
 s_add_u32 s53, s53, 40960
 buffer_load_dwordx4 a[64:67], v4, s[12:15], s53 offen offset:0 sc1
 buffer_load_dwordx4 a[68:71], v4, s[12:15], s53 offen offset:1024 sc1
 buffer_load_dwordx4 a[72:75], v4, s[12:15], s53 offen offset:2048 sc1
 buffer_load_dwordx4 a[76:79], v4, s[12:15], s53 offen offset:3072 sc1
 s_add_u32 s53, s53, 40960
 buffer_load_dwordx4 a[80:83], v4, s[12:15], s53 offen offset:0 sc1
 buffer_load_dwordx4 a[84:87], v4, s[12:15], s53 offen offset:1024 sc1
 buffer_load_dwordx4 a[88:91], v4, s[12:15], s53 offen offset:2048 sc1
 buffer_load_dwordx4 a[92:95], v4, s[12:15], s53 offen offset:3072 sc1
 s_add_u32 s53, s53, 40960
 buffer_load_dwordx4 a[96:99], v4, s[12:15], s53 offen offset:0 sc1
 buffer_load_dwordx4 a[100:103], v4, s[12:15], s53 offen offset:1024 sc1
 buffer_load_dwordx4 a[104:107], v4, s[12:15], s53 offen offset:2048 sc1
 buffer_load_dwordx4 a[108:111], v4, s[12:15], s53 offen offset:3072 sc1
 s_add_u32 s53, s53, 40960
 buffer_load_dwordx4 a[112:115], v4, s[12:15], s53 offen offset:0 sc1
 buffer_load_dwordx4 a[116:119], v4, s[12:15], s53 offen offset:1024 sc1
 buffer_load_dwordx4 a[120:123], v4, s[12:15], s53 offen offset:2048 sc1
 buffer_load_dwordx4 a[124:127], v4, s[12:15], s53 offen offset:3072 sc1
 s_cmp_lt_u32 s40, 48
 s_cselect_b32 s70, 0x80000000, s54
 buffer_load_dwordx4 v[12:15], v4, s[24:27], s70 offen sc1
 buffer_load_dwordx4 v[16:19], v4, s[24:27], s70 offen offset:2048 sc1
 buffer_load_dword v24, v6, s[28:31], s45 offen sc1
 s_waitcnt vmcnt(35)
 s_cmp_eq_u32 s71, 0
 s_cbranch_scc1 paf_260
 v_mov_b32 v25, 0
 v_mov_b32 v26, 1
 s_mov_b64 exec, 1
 buffer_atomic_add v26, v25, s[72:75], s71 offen sc1
 s_mov_b64 exec, -1
 s_mov_b32 s71, 0
paf_260:
 v_cmp_le_u32 s[68:69], 4, v27
 s_nop 1
 s_and_b32 s21, s68, 255
 s_cmp_lg_u32 s21, 255
 s_cbranch_scc1 pvw_253
 s_mov_b32 s56, s47
 s_mov_b32 s57, s48
 buffer_load_dwordx4 v[64:67], v4, s[16:19], s56 offen sc1
 buffer_load_dwordx2 v[68:69], v5, s[16:19], s56 offen offset:1536 sc1
 buffer_load_dwordx4 v[128:131], v21, s[16:19], s56 offen offset:1024 sc1
 buffer_load_dwordx4 v[132:135], v21, s[16:19], s56 offen offset:1280 sc1
 s_add_u32 s56, s56, 2048
 buffer_load_dwordx4 v[72:75], v4, s[16:19], s56 offen sc1
 buffer_load_dwordx2 v[76:77], v5, s[16:19], s56 offen offset:1536 sc1
 s_add_u32 s56, s56, 2048
 buffer_load_dwordx4 v[80:83], v4, s[16:19], s56 offen sc1
 buffer_load_dwordx2 v[84:85], v5, s[16:19], s56 offen offset:1536 sc1
 s_add_u32 s56, s56, 2048
 buffer_load_dwordx4 v[88:91], v4, s[16:19], s56 offen sc1
 buffer_load_dwordx2 v[92:93], v5, s[16:19], s56 offen offset:1536 sc1
 s_add_u32 s56, s56, 10240
 buffer_load_dwordx4 v[32:35], v22, s[16:19], s57 offen offset:0 sc1
 buffer_load_dwordx4 v[36:39], v22, s[16:19], s57 offen offset:256 sc1
 buffer_load_dwordx4 v[40:43], v22, s[16:19], s57 offen offset:512 sc1
 buffer_load_dwordx4 v[44:47], v22, s[16:19], s57 offen offset:768 sc1
 s_add_u32 s57, s57, 4096
 buffer_load_dwordx4 v[96:99], v4, s[16:19], s56 offen sc1
 buffer_load_dwordx2 v[100:101], v5, s[16:19], s56 offen offset:1536 sc1
 buffer_load_dwordx4 v[136:139], v21, s[16:19], s56 offen offset:1024 sc1
 buffer_load_dwordx4 v[140:143], v21, s[16:19], s56 offen offset:1280 sc1
 s_add_u32 s56, s56, 2048
 buffer_load_dwordx4 v[104:107], v4, s[16:19], s56 offen sc1
 buffer_load_dwordx2 v[108:109], v5, s[16:19], s56 offen offset:1536 sc1
 s_add_u32 s56, s56, 2048
 buffer_load_dwordx4 v[112:115], v4, s[16:19], s56 offen sc1
 buffer_load_dwordx2 v[116:117], v5, s[16:19], s56 offen offset:1536 sc1
 s_add_u32 s56, s56, 2048
 buffer_load_dwordx4 v[120:123], v4, s[16:19], s56 offen sc1
 buffer_load_dwordx2 v[124:125], v5, s[16:19], s56 offen offset:1536 sc1
 s_add_u32 s56, s56, 10240
 buffer_load_dwordx4 v[48:51], v22, s[16:19], s57 offen offset:0 sc1
 buffer_load_dwordx4 v[52:55], v22, s[16:19], s57 offen offset:256 sc1
 buffer_load_dwordx4 v[56:59], v22, s[16:19], s57 offen offset:512 sc1
 buffer_load_dwordx4 v[60:63], v22, s[16:19], s57 offen offset:768 sc1
 s_add_u32 s57, s57, 4096
 s_barrier
 s_waitcnt vmcnt(28)
 v_sub_f32 v25, 1.0, v24
 v_cvt_pk_bf16_f32 v26, v25, v25
 v_lshlrev_b32 v25, 16, v26
 v_cvt_pk_bf16_f32 v26, v12, v12
 v_lshlrev_b32 v12, 16, v26
 v_cvt_pk_bf16_f32 v26, v13, v13
 v_lshlrev_b32 v13, 16, v26
 v_cvt_pk_bf16_f32 v26, v14, v14
 v_lshlrev_b32 v14, 16, v26
 v_cvt_pk_bf16_f32 v26, v15, v15
 v_lshlrev_b32 v15, 16, v26
 v_cvt_pk_bf16_f32 v26, v16, v16
 v_lshlrev_b32 v16, 16, v26
 v_cvt_pk_bf16_f32 v26, v17, v17
 v_lshlrev_b32 v17, 16, v26
 v_cvt_pk_bf16_f32 v26, v18, v18
 v_lshlrev_b32 v18, 16, v26
 v_cvt_pk_bf16_f32 v26, v19, v19
 v_lshlrev_b32 v19, 16, v26
 v_mul_f32 v12, v12, v25
 v_cvt_pk_bf16_f32 v26, v12, v12
 v_lshlrev_b32 v12, 16, v26
 v_mul_f32 v13, v13, v25
 v_cvt_pk_bf16_f32 v26, v13, v13
 v_lshlrev_b32 v13, 16, v26
 v_mul_f32 v14, v14, v25
 v_cvt_pk_bf16_f32 v26, v14, v14
 v_lshlrev_b32 v14, 16, v26
 v_mul_f32 v15, v15, v25
 v_cvt_pk_bf16_f32 v26, v15, v15
 v_lshlrev_b32 v15, 16, v26
 v_mul_f32 v16, v16, v25
 v_cvt_pk_bf16_f32 v26, v16, v16
 v_lshlrev_b32 v16, 16, v26
 v_mul_f32 v17, v17, v25
 v_cvt_pk_bf16_f32 v26, v17, v17
 v_lshlrev_b32 v17, 16, v26
 v_mul_f32 v18, v18, v25
 v_cvt_pk_bf16_f32 v26, v18, v18
 v_lshlrev_b32 v18, 16, v26
 v_mul_f32 v19, v19, v25
 v_cvt_pk_bf16_f32 v26, v19, v19
 v_lshlrev_b32 v19, 16, v26
 s_cmp_ge_u32 s40, 56
 s_cbranch_scc1 pvc_259
 s_branch pvg_258
pvw_253:
 s_waitcnt vmcnt(0)
 v_sub_f32 v25, 1.0, v24
 v_cvt_pk_bf16_f32 v26, v25, v25
 v_lshlrev_b32 v25, 16, v26
 v_cvt_pk_bf16_f32 v26, v12, v12
 v_lshlrev_b32 v12, 16, v26
 v_cvt_pk_bf16_f32 v26, v13, v13
 v_lshlrev_b32 v13, 16, v26
 v_cvt_pk_bf16_f32 v26, v14, v14
 v_lshlrev_b32 v14, 16, v26
 v_cvt_pk_bf16_f32 v26, v15, v15
 v_lshlrev_b32 v15, 16, v26
 v_cvt_pk_bf16_f32 v26, v16, v16
 v_lshlrev_b32 v16, 16, v26
 v_cvt_pk_bf16_f32 v26, v17, v17
 v_lshlrev_b32 v17, 16, v26
 v_cvt_pk_bf16_f32 v26, v18, v18
 v_lshlrev_b32 v18, 16, v26
 v_cvt_pk_bf16_f32 v26, v19, v19
 v_lshlrev_b32 v19, 16, v26
 v_mul_f32 v12, v12, v25
 v_cvt_pk_bf16_f32 v26, v12, v12
 v_lshlrev_b32 v12, 16, v26
 v_mul_f32 v13, v13, v25
 v_cvt_pk_bf16_f32 v26, v13, v13
 v_lshlrev_b32 v13, 16, v26
 v_mul_f32 v14, v14, v25
 v_cvt_pk_bf16_f32 v26, v14, v14
 v_lshlrev_b32 v14, 16, v26
 v_mul_f32 v15, v15, v25
 v_cvt_pk_bf16_f32 v26, v15, v15
 v_lshlrev_b32 v15, 16, v26
 v_mul_f32 v16, v16, v25
 v_cvt_pk_bf16_f32 v26, v16, v16
 v_lshlrev_b32 v16, 16, v26
 v_mul_f32 v17, v17, v25
 v_cvt_pk_bf16_f32 v26, v17, v17
 v_lshlrev_b32 v17, 16, v26
 v_mul_f32 v18, v18, v25
 v_cvt_pk_bf16_f32 v26, v18, v18
 v_lshlrev_b32 v18, 16, v26
 v_mul_f32 v19, v19, v25
 v_cvt_pk_bf16_f32 v26, v19, v19
 v_lshlrev_b32 v19, 16, v26
 s_cmp_ge_u32 s40, 56
 s_cbranch_scc1 pvt_261
 s_cmp_lg_u32 s20, 0
 s_cbranch_scc1 wm_263
 s_mov_b32 s101, 0
wm_262:
 buffer_load_dword v26, v7, s[72:75], s52 offen sc1
 s_add_u32 s101, s101, 1
 s_cmp_gt_u32 s101, 131072
 s_cbranch_scc1 main_end
 s_waitcnt vmcnt(0)
 v_cmp_gt_u32 vcc, 4, v26
 v_readfirstlane_b32 s100, v26
 s_nop 0
 s_cbranch_vccz wm_263
 s_sleep 2
 s_add_u32 s100, s100, 3
 s_cmp_ge_u32 s100, 4
 s_cbranch_scc1 wm_262
 s_sleep 24
 s_branch wm_262
wm_263:
 s_barrier
 buffer_load_dwordx4 v[64:67], v4, s[16:19], s47 offen sc1
 buffer_load_dwordx2 v[68:69], v5, s[16:19], s47 offen offset:1536 sc1
 buffer_load_dwordx4 v[128:131], v21, s[16:19], s47 offen offset:1024 sc1
 buffer_load_dwordx4 v[132:135], v21, s[16:19], s47 offen offset:1280 sc1
 s_add_u32 s47, s47, 2048
 buffer_load_dwordx4 v[72:75], v4, s[16:19], s47 offen sc1
 buffer_load_dwordx2 v[76:77], v5, s[16:19], s47 offen offset:1536 sc1
 s_add_u32 s47, s47, 2048
 buffer_load_dwordx4 v[80:83], v4, s[16:19], s47 offen sc1
 buffer_load_dwordx2 v[84:85], v5, s[16:19], s47 offen offset:1536 sc1
 s_add_u32 s47, s47, 2048
 buffer_load_dwordx4 v[88:91], v4, s[16:19], s47 offen sc1
 buffer_load_dwordx2 v[92:93], v5, s[16:19], s47 offen offset:1536 sc1
 s_add_u32 s47, s47, 10240
 buffer_load_dwordx4 v[32:35], v22, s[16:19], s48 offen offset:0 sc1
 buffer_load_dwordx4 v[36:39], v22, s[16:19], s48 offen offset:256 sc1
 buffer_load_dwordx4 v[40:43], v22, s[16:19], s48 offen offset:512 sc1
 buffer_load_dwordx4 v[44:47], v22, s[16:19], s48 offen offset:768 sc1
 s_add_u32 s48, s48, 4096
 buffer_load_dwordx4 v[96:99], v4, s[16:19], s47 offen sc1
 buffer_load_dwordx2 v[100:101], v5, s[16:19], s47 offen offset:1536 sc1
 buffer_load_dwordx4 v[136:139], v21, s[16:19], s47 offen offset:1024 sc1
 buffer_load_dwordx4 v[140:143], v21, s[16:19], s47 offen offset:1280 sc1
 s_add_u32 s47, s47, 2048
 buffer_load_dwordx4 v[104:107], v4, s[16:19], s47 offen sc1
 buffer_load_dwordx2 v[108:109], v5, s[16:19], s47 offen offset:1536 sc1
 s_add_u32 s47, s47, 2048
 buffer_load_dwordx4 v[112:115], v4, s[16:19], s47 offen sc1
 buffer_load_dwordx2 v[116:117], v5, s[16:19], s47 offen offset:1536 sc1
 s_add_u32 s47, s47, 2048
 buffer_load_dwordx4 v[120:123], v4, s[16:19], s47 offen sc1
 buffer_load_dwordx2 v[124:125], v5, s[16:19], s47 offen offset:1536 sc1
 s_add_u32 s47, s47, 10240
 buffer_load_dwordx4 v[48:51], v22, s[16:19], s48 offen offset:0 sc1
 buffer_load_dwordx4 v[52:55], v22, s[16:19], s48 offen offset:256 sc1
 buffer_load_dwordx4 v[56:59], v22, s[16:19], s48 offen offset:512 sc1
 buffer_load_dwordx4 v[60:63], v22, s[16:19], s48 offen offset:768 sc1
 s_add_u32 s48, s48, 4096
pvg_258:
 s_add_u32 s41, s41, 1
 s_mul_i32 s53, s42, 40960
 s_lshl_b32 s22, s41, 12
 s_add_u32 s53, s53, s22
 s_lshl_b32 s48, s41, 16
 s_lshl_b32 s22, s20, 14
 s_add_u32 s48, s48, s22
 s_add_u32 s48, s48, s61
 s_waitcnt vmcnt(26)
 v_mfma_f32_16x16x32_bf16 v[148:151], a[0:3], v[64:67], 0
 v_mfma_f32_16x16x32_bf16 v[144:147], a[0:3], v[68:71], 0
 v_mfma_f32_16x16x32_bf16 v[156:159], a[4:7], v[64:67], 0
 v_mfma_f32_16x16x32_bf16 v[152:155], a[4:7], v[68:71], 0
 v_mfma_f32_16x16x32_bf16 v[164:167], a[8:11], v[64:67], 0
 v_mfma_f32_16x16x32_bf16 v[160:163], a[8:11], v[68:71], 0
 v_mfma_f32_16x16x32_bf16 v[172:175], a[12:15], v[64:67], 0
 v_mfma_f32_16x16x32_bf16 v[168:171], a[12:15], v[68:71], 0
 buffer_load_dwordx4 a[0:3], v4, s[12:15], s53 offen offset:0 sc1
 buffer_load_dwordx4 a[4:7], v4, s[12:15], s53 offen offset:1024 sc1
 buffer_load_dwordx4 a[8:11], v4, s[12:15], s53 offen offset:2048 sc1
 buffer_load_dwordx4 a[12:15], v4, s[12:15], s53 offen offset:3072 sc1
 s_waitcnt vmcnt(26)
 v_mfma_f32_16x16x32_bf16 v[148:151], a[16:19], v[72:75], v[148:151]
 v_mfma_f32_16x16x32_bf16 v[144:147], a[16:19], v[76:79], v[144:147]
 v_mfma_f32_16x16x32_bf16 v[156:159], a[20:23], v[72:75], v[156:159]
 v_mfma_f32_16x16x32_bf16 v[152:155], a[20:23], v[76:79], v[152:155]
 v_mfma_f32_16x16x32_bf16 v[164:167], a[24:27], v[72:75], v[164:167]
 v_mfma_f32_16x16x32_bf16 v[160:163], a[24:27], v[76:79], v[160:163]
 v_mfma_f32_16x16x32_bf16 v[172:175], a[28:31], v[72:75], v[172:175]
 v_mfma_f32_16x16x32_bf16 v[168:171], a[28:31], v[76:79], v[168:171]
 s_add_u32 s53, s53, 40960
 buffer_load_dwordx4 a[16:19], v4, s[12:15], s53 offen offset:0 sc1
 buffer_load_dwordx4 a[20:23], v4, s[12:15], s53 offen offset:1024 sc1
 buffer_load_dwordx4 a[24:27], v4, s[12:15], s53 offen offset:2048 sc1
 buffer_load_dwordx4 a[28:31], v4, s[12:15], s53 offen offset:3072 sc1
 s_waitcnt vmcnt(28)
 v_mfma_f32_16x16x32_bf16 v[148:151], a[32:35], v[80:83], v[148:151]
 v_mfma_f32_16x16x32_bf16 v[144:147], a[32:35], v[84:87], v[144:147]
 v_mfma_f32_16x16x32_bf16 v[156:159], a[36:39], v[80:83], v[156:159]
 v_mfma_f32_16x16x32_bf16 v[152:155], a[36:39], v[84:87], v[152:155]
 v_mfma_f32_16x16x32_bf16 v[164:167], a[40:43], v[80:83], v[164:167]
 v_mfma_f32_16x16x32_bf16 v[160:163], a[40:43], v[84:87], v[160:163]
 v_mfma_f32_16x16x32_bf16 v[172:175], a[44:47], v[80:83], v[172:175]
 v_mfma_f32_16x16x32_bf16 v[168:171], a[44:47], v[84:87], v[168:171]
 s_add_u32 s53, s53, 40960
 buffer_load_dwordx4 a[32:35], v4, s[12:15], s53 offen offset:0 sc1
 buffer_load_dwordx4 a[36:39], v4, s[12:15], s53 offen offset:1024 sc1
 buffer_load_dwordx4 a[40:43], v4, s[12:15], s53 offen offset:2048 sc1
 buffer_load_dwordx4 a[44:47], v4, s[12:15], s53 offen offset:3072 sc1
 s_waitcnt vmcnt(30)
 v_mfma_f32_16x16x32_bf16 v[148:151], a[48:51], v[88:91], v[148:151]
 v_mfma_f32_16x16x32_bf16 v[144:147], a[48:51], v[92:95], v[144:147]
 v_mfma_f32_16x16x32_bf16 v[156:159], a[52:55], v[88:91], v[156:159]
 v_mfma_f32_16x16x32_bf16 v[152:155], a[52:55], v[92:95], v[152:155]
 v_mfma_f32_16x16x32_bf16 v[164:167], a[56:59], v[88:91], v[164:167]
 v_mfma_f32_16x16x32_bf16 v[160:163], a[56:59], v[92:95], v[160:163]
 v_mfma_f32_16x16x32_bf16 v[172:175], a[60:63], v[88:91], v[172:175]
 v_mfma_f32_16x16x32_bf16 v[168:171], a[60:63], v[92:95], v[168:171]
 s_add_u32 s53, s53, 40960
 buffer_load_dwordx4 a[48:51], v4, s[12:15], s53 offen offset:0 sc1
 buffer_load_dwordx4 a[52:55], v4, s[12:15], s53 offen offset:1024 sc1
 buffer_load_dwordx4 a[56:59], v4, s[12:15], s53 offen offset:2048 sc1
 buffer_load_dwordx4 a[60:63], v4, s[12:15], s53 offen offset:3072 sc1
 s_waitcnt vmcnt(30)
 v_mfma_f32_16x16x32_bf16 v[144:147], v[32:35], v[128:131], v[144:147]
 v_mfma_f32_16x16x32_bf16 v[148:151], v[32:35], v[132:135], v[148:151]
 v_mfma_f32_16x16x32_bf16 v[152:155], v[36:39], v[128:131], v[152:155]
 v_mfma_f32_16x16x32_bf16 v[156:159], v[36:39], v[132:135], v[156:159]
 v_mfma_f32_16x16x32_bf16 v[160:163], v[40:43], v[128:131], v[160:163]
 v_mfma_f32_16x16x32_bf16 v[164:167], v[40:43], v[132:135], v[164:167]
 v_mfma_f32_16x16x32_bf16 v[168:171], v[44:47], v[128:131], v[168:171]
 v_mfma_f32_16x16x32_bf16 v[172:175], v[44:47], v[132:135], v[172:175]
 buffer_load_dwordx4 v[32:35], v22, s[16:19], s48 offen offset:0 sc1
 buffer_load_dwordx4 v[36:39], v22, s[16:19], s48 offen offset:256 sc1
 buffer_load_dwordx4 v[40:43], v22, s[16:19], s48 offen offset:512 sc1
 buffer_load_dwordx4 v[44:47], v22, s[16:19], s48 offen offset:768 sc1
 s_add_u32 s48, s48, 4096
 s_waitcnt vmcnt(32)
 v_mfma_f32_16x16x32_bf16 v[148:151], a[64:67], v[96:99], v[148:151]
 v_mfma_f32_16x16x32_bf16 v[144:147], a[64:67], v[100:103], v[144:147]
 v_mfma_f32_16x16x32_bf16 v[156:159], a[68:71], v[96:99], v[156:159]
 v_mfma_f32_16x16x32_bf16 v[152:155], a[68:71], v[100:103], v[152:155]
 v_mfma_f32_16x16x32_bf16 v[164:167], a[72:75], v[96:99], v[164:167]
 v_mfma_f32_16x16x32_bf16 v[160:163], a[72:75], v[100:103], v[160:163]
 v_mfma_f32_16x16x32_bf16 v[172:175], a[76:79], v[96:99], v[172:175]
 v_mfma_f32_16x16x32_bf16 v[168:171], a[76:79], v[100:103], v[168:171]
 s_add_u32 s53, s53, 40960
 buffer_load_dwordx4 a[64:67], v4, s[12:15], s53 offen offset:0 sc1
 buffer_load_dwordx4 a[68:71], v4, s[12:15], s53 offen offset:1024 sc1
 buffer_load_dwordx4 a[72:75], v4, s[12:15], s53 offen offset:2048 sc1
 buffer_load_dwordx4 a[76:79], v4, s[12:15], s53 offen offset:3072 sc1
 s_waitcnt vmcnt(32)
 v_mfma_f32_16x16x32_bf16 v[148:151], a[80:83], v[104:107], v[148:151]
 v_mfma_f32_16x16x32_bf16 v[144:147], a[80:83], v[108:111], v[144:147]
 v_mfma_f32_16x16x32_bf16 v[156:159], a[84:87], v[104:107], v[156:159]
 v_mfma_f32_16x16x32_bf16 v[152:155], a[84:87], v[108:111], v[152:155]
 v_mfma_f32_16x16x32_bf16 v[164:167], a[88:91], v[104:107], v[164:167]
 v_mfma_f32_16x16x32_bf16 v[160:163], a[88:91], v[108:111], v[160:163]
 v_mfma_f32_16x16x32_bf16 v[172:175], a[92:95], v[104:107], v[172:175]
 v_mfma_f32_16x16x32_bf16 v[168:171], a[92:95], v[108:111], v[168:171]
 s_add_u32 s53, s53, 40960
 buffer_load_dwordx4 a[80:83], v4, s[12:15], s53 offen offset:0 sc1
 buffer_load_dwordx4 a[84:87], v4, s[12:15], s53 offen offset:1024 sc1
 buffer_load_dwordx4 a[88:91], v4, s[12:15], s53 offen offset:2048 sc1
 buffer_load_dwordx4 a[92:95], v4, s[12:15], s53 offen offset:3072 sc1
 s_waitcnt vmcnt(34)
 v_mfma_f32_16x16x32_bf16 v[148:151], a[96:99], v[112:115], v[148:151]
 v_mfma_f32_16x16x32_bf16 v[144:147], a[96:99], v[116:119], v[144:147]
 v_mfma_f32_16x16x32_bf16 v[156:159], a[100:103], v[112:115], v[156:159]
 v_mfma_f32_16x16x32_bf16 v[152:155], a[100:103], v[116:119], v[152:155]
 v_mfma_f32_16x16x32_bf16 v[164:167], a[104:107], v[112:115], v[164:167]
 v_mfma_f32_16x16x32_bf16 v[160:163], a[104:107], v[116:119], v[160:163]
 v_mfma_f32_16x16x32_bf16 v[172:175], a[108:111], v[112:115], v[172:175]
 v_mfma_f32_16x16x32_bf16 v[168:171], a[108:111], v[116:119], v[168:171]
 s_add_u32 s53, s53, 40960
 buffer_load_dwordx4 a[96:99], v4, s[12:15], s53 offen offset:0 sc1
 buffer_load_dwordx4 a[100:103], v4, s[12:15], s53 offen offset:1024 sc1
 buffer_load_dwordx4 a[104:107], v4, s[12:15], s53 offen offset:2048 sc1
 buffer_load_dwordx4 a[108:111], v4, s[12:15], s53 offen offset:3072 sc1
 s_waitcnt vmcnt(36)
 v_mfma_f32_16x16x32_bf16 v[148:151], a[112:115], v[120:123], v[148:151]
 v_mfma_f32_16x16x32_bf16 v[144:147], a[112:115], v[124:127], v[144:147]
 v_mfma_f32_16x16x32_bf16 v[156:159], a[116:119], v[120:123], v[156:159]
 v_mfma_f32_16x16x32_bf16 v[152:155], a[116:119], v[124:127], v[152:155]
 v_mfma_f32_16x16x32_bf16 v[164:167], a[120:123], v[120:123], v[164:167]
 v_mfma_f32_16x16x32_bf16 v[160:163], a[120:123], v[124:127], v[160:163]
 v_mfma_f32_16x16x32_bf16 v[172:175], a[124:127], v[120:123], v[172:175]
 v_mfma_f32_16x16x32_bf16 v[168:171], a[124:127], v[124:127], v[168:171]
 s_add_u32 s53, s53, 40960
 buffer_load_dwordx4 a[112:115], v4, s[12:15], s53 offen offset:0 sc1
 buffer_load_dwordx4 a[116:119], v4, s[12:15], s53 offen offset:1024 sc1
 buffer_load_dwordx4 a[120:123], v4, s[12:15], s53 offen offset:2048 sc1
 buffer_load_dwordx4 a[124:127], v4, s[12:15], s53 offen offset:3072 sc1
 s_waitcnt vmcnt(36)
 v_mfma_f32_16x16x32_bf16 v[144:147], v[48:51], v[136:139], v[144:147]
 v_mfma_f32_16x16x32_bf16 v[148:151], v[48:51], v[140:143], v[148:151]
 v_mfma_f32_16x16x32_bf16 v[152:155], v[52:55], v[136:139], v[152:155]
 v_mfma_f32_16x16x32_bf16 v[156:159], v[52:55], v[140:143], v[156:159]
 v_mfma_f32_16x16x32_bf16 v[160:163], v[56:59], v[136:139], v[160:163]
 v_mfma_f32_16x16x32_bf16 v[164:167], v[56:59], v[140:143], v[164:167]
 v_mfma_f32_16x16x32_bf16 v[168:171], v[60:63], v[136:139], v[168:171]
 v_mfma_f32_16x16x32_bf16 v[172:175], v[60:63], v[140:143], v[172:175]
 buffer_load_dwordx4 v[48:51], v22, s[16:19], s48 offen offset:0 sc1
 buffer_load_dwordx4 v[52:55], v22, s[16:19], s48 offen offset:256 sc1
 buffer_load_dwordx4 v[56:59], v22, s[16:19], s48 offen offset:512 sc1
 buffer_load_dwordx4 v[60:63], v22, s[16:19], s48 offen offset:768 sc1
 s_add_u32 s48, s48, 4096
 s_branch pve_254
pvt_261:
 s_sub_u32 s55, s52, 2048
 s_cmp_lg_u32 s20, 0
 s_cbranch_scc1 wm_265
 s_mov_b32 s101, 0
wm_264:
 buffer_load_dword v26, v7, s[72:75], s55 offen sc1
 s_add_u32 s101, s101, 1
 s_cmp_gt_u32 s101, 131072
 s_cbranch_scc1 main_end
 s_waitcnt vmcnt(0)
 v_cmp_gt_u32 vcc, 4, v26
 v_readfirstlane_b32 s100, v26
 s_nop 0
 s_cbranch_vccz wm_265
 s_sleep 4
 s_add_u32 s100, s100, 3
 s_cmp_ge_u32 s100, 4
 s_cbranch_scc1 wm_264
 s_sleep 24
 s_branch wm_264
wm_265:
 s_barrier
 s_mov_b32 s56, s47
 s_mov_b32 s57, s48
 buffer_load_dwordx4 v[64:67], v4, s[16:19], s56 offen sc1
 buffer_load_dwordx2 v[68:69], v5, s[16:19], s56 offen offset:1536 sc1
 buffer_load_dwordx4 v[128:131], v21, s[16:19], s56 offen offset:1024 sc1
 buffer_load_dwordx4 v[132:135], v21, s[16:19], s56 offen offset:1280 sc1
 s_add_u32 s56, s56, 2048
 buffer_load_dwordx4 v[72:75], v4, s[16:19], s56 offen sc1
 buffer_load_dwordx2 v[76:77], v5, s[16:19], s56 offen offset:1536 sc1
 s_add_u32 s56, s56, 2048
 buffer_load_dwordx4 v[80:83], v4, s[16:19], s56 offen sc1
 buffer_load_dwordx2 v[84:85], v5, s[16:19], s56 offen offset:1536 sc1
 s_add_u32 s56, s56, 2048
 buffer_load_dwordx4 v[88:91], v4, s[16:19], s56 offen sc1
 buffer_load_dwordx2 v[92:93], v5, s[16:19], s56 offen offset:1536 sc1
 s_add_u32 s56, s56, 10240
 buffer_load_dwordx4 v[32:35], v22, s[16:19], s57 offen offset:0 sc1
 buffer_load_dwordx4 v[36:39], v22, s[16:19], s57 offen offset:256 sc1
 buffer_load_dwordx4 v[40:43], v22, s[16:19], s57 offen offset:512 sc1
 buffer_load_dwordx4 v[44:47], v22, s[16:19], s57 offen offset:768 sc1
 s_add_u32 s57, s57, 4096
 buffer_load_dwordx4 v[96:99], v4, s[16:19], s56 offen sc1
 buffer_load_dwordx2 v[100:101], v5, s[16:19], s56 offen offset:1536 sc1
 buffer_load_dwordx4 v[136:139], v21, s[16:19], s56 offen offset:1024 sc1
 buffer_load_dwordx4 v[140:143], v21, s[16:19], s56 offen offset:1280 sc1
 s_add_u32 s56, s56, 2048
 buffer_load_dwordx4 v[104:107], v4, s[16:19], s56 offen sc1
 buffer_load_dwordx2 v[108:109], v5, s[16:19], s56 offen offset:1536 sc1
 s_add_u32 s56, s56, 2048
 buffer_load_dwordx4 v[112:115], v4, s[16:19], s56 offen sc1
 buffer_load_dwordx2 v[116:117], v5, s[16:19], s56 offen offset:1536 sc1
 s_add_u32 s56, s56, 2048
 buffer_load_dwordx4 v[120:123], v4, s[16:19], s56 offen sc1
 buffer_load_dwordx2 v[124:125], v5, s[16:19], s56 offen offset:1536 sc1
 s_add_u32 s56, s56, 10240
 buffer_load_dwordx4 v[48:51], v22, s[16:19], s57 offen offset:0 sc1
 buffer_load_dwordx4 v[52:55], v22, s[16:19], s57 offen offset:256 sc1
 buffer_load_dwordx4 v[56:59], v22, s[16:19], s57 offen offset:512 sc1
 buffer_load_dwordx4 v[60:63], v22, s[16:19], s57 offen offset:768 sc1
 s_add_u32 s57, s57, 4096
pvc_259:
 s_mov_b32 s101, 0
 s_waitcnt vmcnt(14)
 s_branch pvr_267
pvr_266:
 s_sleep 2
 s_add_u32 s56, s47, 0
 s_add_u32 s57, s48, 0
 buffer_load_dwordx4 v[64:67], v4, s[16:19], s56 offen sc1
 buffer_load_dwordx2 v[68:69], v5, s[16:19], s56 offen offset:1536 sc1
 buffer_load_dwordx4 v[128:131], v21, s[16:19], s56 offen offset:1024 sc1
 buffer_load_dwordx4 v[132:135], v21, s[16:19], s56 offen offset:1280 sc1
 s_add_u32 s56, s56, 2048
 buffer_load_dwordx4 v[72:75], v4, s[16:19], s56 offen sc1
 buffer_load_dwordx2 v[76:77], v5, s[16:19], s56 offen offset:1536 sc1
 s_add_u32 s56, s56, 2048
 buffer_load_dwordx4 v[80:83], v4, s[16:19], s56 offen sc1
 buffer_load_dwordx2 v[84:85], v5, s[16:19], s56 offen offset:1536 sc1
 s_add_u32 s56, s56, 2048
 buffer_load_dwordx4 v[88:91], v4, s[16:19], s56 offen sc1
 buffer_load_dwordx2 v[92:93], v5, s[16:19], s56 offen offset:1536 sc1
 s_add_u32 s56, s56, 10240
 buffer_load_dwordx4 v[32:35], v22, s[16:19], s57 offen offset:0 sc1
 buffer_load_dwordx4 v[36:39], v22, s[16:19], s57 offen offset:256 sc1
 buffer_load_dwordx4 v[40:43], v22, s[16:19], s57 offen offset:512 sc1
 buffer_load_dwordx4 v[44:47], v22, s[16:19], s57 offen offset:768 sc1
 s_add_u32 s57, s57, 4096
 s_add_u32 s101, s101, 1
 s_cmp_gt_u32 s101, 131072
 s_cbranch_scc1 main_end
 s_waitcnt vmcnt(0)
pvr_267:
 v_max3_u32 v26, v64, v68, v72
 v_max3_u32 v26, v26, v76, v80
 v_max3_u32 v26, v26, v84, v88
 v_max3_u32 v26, v26, v92, v128
 v_max3_u32 v26, v26, v132, v32
 v_max3_u32 v26, v26, v36, v40
 v_max3_u32 v26, v26, v44, v44
 v_cmp_eq_u32 vcc, -1, v26
 s_nop 1
 s_cbranch_vccnz pvr_266
 v_mfma_f32_16x16x32_bf16 v[148:151], a[0:3], v[64:67], 0
 v_mfma_f32_16x16x32_bf16 v[144:147], a[0:3], v[68:71], 0
 v_mfma_f32_16x16x32_bf16 v[156:159], a[4:7], v[64:67], 0
 v_mfma_f32_16x16x32_bf16 v[152:155], a[4:7], v[68:71], 0
 v_mfma_f32_16x16x32_bf16 v[164:167], a[8:11], v[64:67], 0
 v_mfma_f32_16x16x32_bf16 v[160:163], a[8:11], v[68:71], 0
 v_mfma_f32_16x16x32_bf16 v[172:175], a[12:15], v[64:67], 0
 v_mfma_f32_16x16x32_bf16 v[168:171], a[12:15], v[68:71], 0
 v_mfma_f32_16x16x32_bf16 v[148:151], a[16:19], v[72:75], v[148:151]
 v_mfma_f32_16x16x32_bf16 v[144:147], a[16:19], v[76:79], v[144:147]
 v_mfma_f32_16x16x32_bf16 v[156:159], a[20:23], v[72:75], v[156:159]
 v_mfma_f32_16x16x32_bf16 v[152:155], a[20:23], v[76:79], v[152:155]
 v_mfma_f32_16x16x32_bf16 v[164:167], a[24:27], v[72:75], v[164:167]
 v_mfma_f32_16x16x32_bf16 v[160:163], a[24:27], v[76:79], v[160:163]
 v_mfma_f32_16x16x32_bf16 v[172:175], a[28:31], v[72:75], v[172:175]
 v_mfma_f32_16x16x32_bf16 v[168:171], a[28:31], v[76:79], v[168:171]
 v_mfma_f32_16x16x32_bf16 v[148:151], a[32:35], v[80:83], v[148:151]
 v_mfma_f32_16x16x32_bf16 v[144:147], a[32:35], v[84:87], v[144:147]
 v_mfma_f32_16x16x32_bf16 v[156:159], a[36:39], v[80:83], v[156:159]
 v_mfma_f32_16x16x32_bf16 v[152:155], a[36:39], v[84:87], v[152:155]
 v_mfma_f32_16x16x32_bf16 v[164:167], a[40:43], v[80:83], v[164:167]
 v_mfma_f32_16x16x32_bf16 v[160:163], a[40:43], v[84:87], v[160:163]
 v_mfma_f32_16x16x32_bf16 v[172:175], a[44:47], v[80:83], v[172:175]
 v_mfma_f32_16x16x32_bf16 v[168:171], a[44:47], v[84:87], v[168:171]
 v_mfma_f32_16x16x32_bf16 v[148:151], a[48:51], v[88:91], v[148:151]
 v_mfma_f32_16x16x32_bf16 v[144:147], a[48:51], v[92:95], v[144:147]
 v_mfma_f32_16x16x32_bf16 v[156:159], a[52:55], v[88:91], v[156:159]
 v_mfma_f32_16x16x32_bf16 v[152:155], a[52:55], v[92:95], v[152:155]
 v_mfma_f32_16x16x32_bf16 v[164:167], a[56:59], v[88:91], v[164:167]
 v_mfma_f32_16x16x32_bf16 v[160:163], a[56:59], v[92:95], v[160:163]
 v_mfma_f32_16x16x32_bf16 v[172:175], a[60:63], v[88:91], v[172:175]
 v_mfma_f32_16x16x32_bf16 v[168:171], a[60:63], v[92:95], v[168:171]
 s_nop 1
 v_mfma_f32_16x16x32_bf16 v[144:147], v[32:35], v[128:131], v[144:147]
 v_mfma_f32_16x16x32_bf16 v[148:151], v[32:35], v[132:135], v[148:151]
 v_mfma_f32_16x16x32_bf16 v[152:155], v[36:39], v[128:131], v[152:155]
 v_mfma_f32_16x16x32_bf16 v[156:159], v[36:39], v[132:135], v[156:159]
 v_mfma_f32_16x16x32_bf16 v[160:163], v[40:43], v[128:131], v[160:163]
 v_mfma_f32_16x16x32_bf16 v[164:167], v[40:43], v[132:135], v[164:167]
 v_mfma_f32_16x16x32_bf16 v[168:171], v[44:47], v[128:131], v[168:171]
 v_mfma_f32_16x16x32_bf16 v[172:175], v[44:47], v[132:135], v[172:175]
 s_mov_b32 s101, 0
 s_waitcnt vmcnt(0)
 s_branch pvr_269
pvr_268:
 s_sleep 2
 s_add_u32 s56, s47, 16384
 s_add_u32 s57, s48, 4096
 buffer_load_dwordx4 v[96:99], v4, s[16:19], s56 offen sc1
 buffer_load_dwordx2 v[100:101], v5, s[16:19], s56 offen offset:1536 sc1
 buffer_load_dwordx4 v[136:139], v21, s[16:19], s56 offen offset:1024 sc1
 buffer_load_dwordx4 v[140:143], v21, s[16:19], s56 offen offset:1280 sc1
 s_add_u32 s56, s56, 2048
 buffer_load_dwordx4 v[104:107], v4, s[16:19], s56 offen sc1
 buffer_load_dwordx2 v[108:109], v5, s[16:19], s56 offen offset:1536 sc1
 s_add_u32 s56, s56, 2048
 buffer_load_dwordx4 v[112:115], v4, s[16:19], s56 offen sc1
 buffer_load_dwordx2 v[116:117], v5, s[16:19], s56 offen offset:1536 sc1
 s_add_u32 s56, s56, 2048
 buffer_load_dwordx4 v[120:123], v4, s[16:19], s56 offen sc1
 buffer_load_dwordx2 v[124:125], v5, s[16:19], s56 offen offset:1536 sc1
 s_add_u32 s56, s56, 10240
 buffer_load_dwordx4 v[48:51], v22, s[16:19], s57 offen offset:0 sc1
 buffer_load_dwordx4 v[52:55], v22, s[16:19], s57 offen offset:256 sc1
 buffer_load_dwordx4 v[56:59], v22, s[16:19], s57 offen offset:512 sc1
 buffer_load_dwordx4 v[60:63], v22, s[16:19], s57 offen offset:768 sc1
 s_add_u32 s57, s57, 4096
 s_add_u32 s101, s101, 1
 s_cmp_gt_u32 s101, 131072
 s_cbranch_scc1 main_end
 s_waitcnt vmcnt(0)
pvr_269:
 v_max3_u32 v26, v96, v100, v104
 v_max3_u32 v26, v26, v108, v112
 v_max3_u32 v26, v26, v116, v120
 v_max3_u32 v26, v26, v124, v136
 v_max3_u32 v26, v26, v140, v48
 v_max3_u32 v26, v26, v52, v56
 v_max3_u32 v26, v26, v60, v60
 v_cmp_eq_u32 vcc, -1, v26
 s_nop 1
 s_cbranch_vccnz pvr_268
 v_mfma_f32_16x16x32_bf16 v[148:151], a[64:67], v[96:99], v[148:151]
 v_mfma_f32_16x16x32_bf16 v[144:147], a[64:67], v[100:103], v[144:147]
 v_mfma_f32_16x16x32_bf16 v[156:159], a[68:71], v[96:99], v[156:159]
 v_mfma_f32_16x16x32_bf16 v[152:155], a[68:71], v[100:103], v[152:155]
 v_mfma_f32_16x16x32_bf16 v[164:167], a[72:75], v[96:99], v[164:167]
 v_mfma_f32_16x16x32_bf16 v[160:163], a[72:75], v[100:103], v[160:163]
 v_mfma_f32_16x16x32_bf16 v[172:175], a[76:79], v[96:99], v[172:175]
 v_mfma_f32_16x16x32_bf16 v[168:171], a[76:79], v[100:103], v[168:171]
 v_mfma_f32_16x16x32_bf16 v[148:151], a[80:83], v[104:107], v[148:151]
 v_mfma_f32_16x16x32_bf16 v[144:147], a[80:83], v[108:111], v[144:147]
 v_mfma_f32_16x16x32_bf16 v[156:159], a[84:87], v[104:107], v[156:159]
 v_mfma_f32_16x16x32_bf16 v[152:155], a[84:87], v[108:111], v[152:155]
 v_mfma_f32_16x16x32_bf16 v[164:167], a[88:91], v[104:107], v[164:167]
 v_mfma_f32_16x16x32_bf16 v[160:163], a[88:91], v[108:111], v[160:163]
 v_mfma_f32_16x16x32_bf16 v[172:175], a[92:95], v[104:107], v[172:175]
 v_mfma_f32_16x16x32_bf16 v[168:171], a[92:95], v[108:111], v[168:171]
 v_mfma_f32_16x16x32_bf16 v[148:151], a[96:99], v[112:115], v[148:151]
 v_mfma_f32_16x16x32_bf16 v[144:147], a[96:99], v[116:119], v[144:147]
 v_mfma_f32_16x16x32_bf16 v[156:159], a[100:103], v[112:115], v[156:159]
 v_mfma_f32_16x16x32_bf16 v[152:155], a[100:103], v[116:119], v[152:155]
 v_mfma_f32_16x16x32_bf16 v[164:167], a[104:107], v[112:115], v[164:167]
 v_mfma_f32_16x16x32_bf16 v[160:163], a[104:107], v[116:119], v[160:163]
 v_mfma_f32_16x16x32_bf16 v[172:175], a[108:111], v[112:115], v[172:175]
 v_mfma_f32_16x16x32_bf16 v[168:171], a[108:111], v[116:119], v[168:171]
 v_mfma_f32_16x16x32_bf16 v[148:151], a[112:115], v[120:123], v[148:151]
 v_mfma_f32_16x16x32_bf16 v[144:147], a[112:115], v[124:127], v[144:147]
 v_mfma_f32_16x16x32_bf16 v[156:159], a[116:119], v[120:123], v[156:159]
 v_mfma_f32_16x16x32_bf16 v[152:155], a[116:119], v[124:127], v[152:155]
 v_mfma_f32_16x16x32_bf16 v[164:167], a[120:123], v[120:123], v[164:167]
 v_mfma_f32_16x16x32_bf16 v[160:163], a[120:123], v[124:127], v[160:163]
 v_mfma_f32_16x16x32_bf16 v[172:175], a[124:127], v[120:123], v[172:175]
 v_mfma_f32_16x16x32_bf16 v[168:171], a[124:127], v[124:127], v[168:171]
 s_nop 1
 v_mfma_f32_16x16x32_bf16 v[144:147], v[48:51], v[136:139], v[144:147]
 v_mfma_f32_16x16x32_bf16 v[148:151], v[48:51], v[140:143], v[148:151]
 v_mfma_f32_16x16x32_bf16 v[152:155], v[52:55], v[136:139], v[152:155]
 v_mfma_f32_16x16x32_bf16 v[156:159], v[52:55], v[140:143], v[156:159]
 v_mfma_f32_16x16x32_bf16 v[160:163], v[56:59], v[136:139], v[160:163]
 v_mfma_f32_16x16x32_bf16 v[164:167], v[56:59], v[140:143], v[164:167]
 v_mfma_f32_16x16x32_bf16 v[168:171], v[60:63], v[136:139], v[168:171]
 v_mfma_f32_16x16x32_bf16 v[172:175], v[60:63], v[140:143], v[172:175]
pve_254:
 s_nop 0
 s_or_b32 s21, s20, s65
 s_cbranch_scc1 lc_270
 s_sub_u32 s21, s2, 0
 s_cmp_ge_u32 s21, 640
 s_cbranch_scc1 lc_270
 v_mov_b32 v29, 1
 s_mov_b64 exec, 1
 buffer_atomic_add v29, v28, s[32:35], 0 offen sc0 sc1
 s_mov_b64 exec, -1
lc_270:
 ds_write_b128 v10, v[144:147] offset:0
 ds_write_b128 v10, v[148:151] offset:1024
 ds_write_b128 v10, v[152:155] offset:2048
 ds_write_b128 v10, v[156:159] offset:3072
 ds_write_b128 v10, v[160:163] offset:4096
 ds_write_b128 v10, v[164:167] offset:5120
 ds_write_b128 v10, v[168:171] offset:6144
 ds_write_b128 v10, v[172:175] offset:7168
 s_cmp_lg_u32 s20, 0
 s_cbranch_scc1 pvq_273
 v_readfirstlane_b32 s21, v29
 s_mov_b32 s23, -1
 v_mov_b32 v213, s23
 s_mov_b64 exec, 1
 ds_write_b32 v30, v29
 ds_write_b32 v30, v213 offset:8
 s_mov_b64 exec, -1
pvq_273:
 s_waitcnt lgkmcnt(0)
 s_barrier
 ds_read_b128 v[176:179], v11 offset:0
 ds_read_b128 v[180:183], v11 offset:8192
 ds_read_b128 v[184:187], v11 offset:16384
 ds_read_b128 v[188:191], v11 offset:24576
 ds_read_b128 v[192:195], v11 offset:4096
 ds_read_b128 v[196:199], v11 offset:12288
 ds_read_b128 v[200:203], v11 offset:20480
 ds_read_b128 v[204:207], v11 offset:28672
 ds_read_b32 v23, v30
 ds_read_b32 v213, v30 offset:8
 s_cmp_ge_u32 s40, 48
 s_cbranch_scc1 pvr_276
 s_waitcnt lgkmcnt(6)
 v_pk_add_f32 v[176:177], v[176:177], v[180:181]
 v_pk_add_f32 v[184:185], v[184:185], v[188:189]
 v_pk_add_f32 v[178:179], v[178:179], v[182:183]
 v_pk_add_f32 v[186:187], v[186:187], v[190:191]
 v_pk_add_f32 v[176:177], v[176:177], v[184:185]
 v_pk_add_f32 v[178:179], v[178:179], v[186:187]
 buffer_store_dwordx4 v[176:179], v4, s[24:27], s54 offen offset:0 sc1
 s_waitcnt lgkmcnt(2)
 v_pk_add_f32 v[192:193], v[192:193], v[196:197]
 v_pk_add_f32 v[200:201], v[200:201], v[204:205]
 v_pk_add_f32 v[194:195], v[194:195], v[198:199]
 v_pk_add_f32 v[202:203], v[202:203], v[206:207]
 v_pk_add_f32 v[192:193], v[192:193], v[200:201]
 v_pk_add_f32 v[194:195], v[194:195], v[202:203]
 buffer_store_dwordx4 v[192:195], v4, s[24:27], s54 offen offset:2048 sc1
 s_lshr_b32 s71, s40, 2
 s_lshl_b32 s71, s71, 7
 s_add_u32 s71, s71, 116736
 s_branch pvr_277
pvr_276:
 s_waitcnt lgkmcnt(6)
 v_pk_add_f32 v[176:177], v[176:177], v[180:181]
 v_pk_add_f32 v[184:185], v[184:185], v[188:189]
 v_pk_add_f32 v[178:179], v[178:179], v[182:183]
 v_pk_add_f32 v[186:187], v[186:187], v[190:191]
 v_pk_add_f32 v[176:177], v[176:177], v[184:185]
 v_pk_add_f32 v[178:179], v[178:179], v[186:187]
 v_cvt_pk_bf16_f32 v26, v176, v177
 v_lshlrev_b32 v176, 16, v26
 v_and_b32 v177, 0xffff0000, v26
 v_mul_f32 v176, v176, v24
 v_mul_f32 v177, v177, v24
 v_cvt_pk_bf16_f32 v26, v176, v177
 v_lshlrev_b32 v176, 16, v26
 v_and_b32 v177, 0xffff0000, v26
 v_add_f32 v176, v176, v12
 v_add_f32 v177, v177, v13
 v_cvt_pk_bf16_f32 v180, v176, v177
 v_cvt_pk_bf16_f32 v26, v178, v179
 v_lshlrev_b32 v178, 16, v26
 v_and_b32 v179, 0xffff0000, v26
 v_mul_f32 v178, v178, v24
 v_mul_f32 v179, v179, v24
 v_cvt_pk_bf16_f32 v26, v178, v179
 v_lshlrev_b32 v178, 16, v26
 v_and_b32 v179, 0xffff0000, v26
 v_add_f32 v178, v178, v14
 v_add_f32 v179, v179, v15
 v_cvt_pk_bf16_f32 v181, v178, v179
 buffer_store_dwordx2 v[180:181], v9, s[8:11], s46 offen offset:0
 s_waitcnt lgkmcnt(2)
 v_pk_add_f32 v[192:193], v[192:193], v[196:197]
 v_pk_add_f32 v[200:201], v[200:201], v[204:205]
 v_pk_add_f32 v[194:195], v[194:195], v[198:199]
 v_pk_add_f32 v[202:203], v[202:203], v[206:207]
 v_pk_add_f32 v[192:193], v[192:193], v[200:201]
 v_pk_add_f32 v[194:195], v[194:195], v[202:203]
 v_cvt_pk_bf16_f32 v26, v192, v193
 v_lshlrev_b32 v192, 16, v26
 v_and_b32 v193, 0xffff0000, v26
 v_mul_f32 v192, v192, v24
 v_mul_f32 v193, v193, v24
 v_cvt_pk_bf16_f32 v26, v192, v193
 v_lshlrev_b32 v192, 16, v26
 v_and_b32 v193, 0xffff0000, v26
 v_add_f32 v192, v192, v16
 v_add_f32 v193, v193, v17
 v_cvt_pk_bf16_f32 v196, v192, v193
 v_cvt_pk_bf16_f32 v26, v194, v195
 v_lshlrev_b32 v194, 16, v26
 v_and_b32 v195, 0xffff0000, v26
 v_mul_f32 v194, v194, v24
 v_mul_f32 v195, v195, v24
 v_cvt_pk_bf16_f32 v26, v194, v195
 v_lshlrev_b32 v194, 16, v26
 v_and_b32 v195, 0xffff0000, v26
 v_add_f32 v194, v194, v18
 v_add_f32 v195, v195, v19
 v_cvt_pk_bf16_f32 v197, v194, v195
 buffer_store_dwordx2 v[196:197], v9, s[8:11], s46 offen offset:64
pvr_277:
pvy_278:
 s_cmp_eq_u32 s65, 0
 s_cbranch_scc1 pvy_279
 s_sub_u32 s65, s65, 1
 s_add_u32 s46, s46, 128
 s_add_u32 s54, s54, 16384
 s_cmp_lt_u32 s40, 48
 s_cselect_b32 s70, 0x80000000, s54
 buffer_load_dwordx4 v[12:15], v4, s[24:27], s70 offen sc1
 buffer_load_dwordx4 v[16:19], v4, s[24:27], s70 offen offset:2048 sc1
 buffer_load_dword v24, v6, s[28:31], s45 offen sc1
 s_waitcnt lgkmcnt(0)
 s_barrier
 s_cmp_eq_u32 s65, 0
 s_cbranch_scc1 pvy_280
 s_add_u32 s41, s41, 1
 s_mul_i32 s53, s42, 40960
 s_lshl_b32 s22, s41, 12
 s_add_u32 s53, s53, s22
 s_lshl_b32 s48, s41, 16
 s_lshl_b32 s22, s20, 14
 s_add_u32 s48, s48, s22
 s_add_u32 s48, s48, s61
 s_waitcnt vmcnt(41)
 v_mfma_f32_16x16x32_bf16 v[148:151], a[0:3], v[64:67], 0
 v_mfma_f32_16x16x32_bf16 v[144:147], a[0:3], v[68:71], 0
 v_mfma_f32_16x16x32_bf16 v[156:159], a[4:7], v[64:67], 0
 v_mfma_f32_16x16x32_bf16 v[152:155], a[4:7], v[68:71], 0
 v_mfma_f32_16x16x32_bf16 v[164:167], a[8:11], v[64:67], 0
 v_mfma_f32_16x16x32_bf16 v[160:163], a[8:11], v[68:71], 0
 v_mfma_f32_16x16x32_bf16 v[172:175], a[12:15], v[64:67], 0
 v_mfma_f32_16x16x32_bf16 v[168:171], a[12:15], v[68:71], 0
 buffer_load_dwordx4 a[0:3], v4, s[12:15], s53 offen offset:0 sc1
 buffer_load_dwordx4 a[4:7], v4, s[12:15], s53 offen offset:1024 sc1
 buffer_load_dwordx4 a[8:11], v4, s[12:15], s53 offen offset:2048 sc1
 buffer_load_dwordx4 a[12:15], v4, s[12:15], s53 offen offset:3072 sc1
 s_waitcnt vmcnt(41)
 v_mfma_f32_16x16x32_bf16 v[148:151], a[16:19], v[72:75], v[148:151]
 v_mfma_f32_16x16x32_bf16 v[144:147], a[16:19], v[76:79], v[144:147]
 v_mfma_f32_16x16x32_bf16 v[156:159], a[20:23], v[72:75], v[156:159]
 v_mfma_f32_16x16x32_bf16 v[152:155], a[20:23], v[76:79], v[152:155]
 v_mfma_f32_16x16x32_bf16 v[164:167], a[24:27], v[72:75], v[164:167]
 v_mfma_f32_16x16x32_bf16 v[160:163], a[24:27], v[76:79], v[160:163]
 v_mfma_f32_16x16x32_bf16 v[172:175], a[28:31], v[72:75], v[172:175]
 v_mfma_f32_16x16x32_bf16 v[168:171], a[28:31], v[76:79], v[168:171]
 s_add_u32 s53, s53, 40960
 buffer_load_dwordx4 a[16:19], v4, s[12:15], s53 offen offset:0 sc1
 buffer_load_dwordx4 a[20:23], v4, s[12:15], s53 offen offset:1024 sc1
 buffer_load_dwordx4 a[24:27], v4, s[12:15], s53 offen offset:2048 sc1
 buffer_load_dwordx4 a[28:31], v4, s[12:15], s53 offen offset:3072 sc1
 s_waitcnt vmcnt(41)
 v_mfma_f32_16x16x32_bf16 v[148:151], a[32:35], v[80:83], v[148:151]
 v_mfma_f32_16x16x32_bf16 v[144:147], a[32:35], v[84:87], v[144:147]
 v_mfma_f32_16x16x32_bf16 v[156:159], a[36:39], v[80:83], v[156:159]
 v_mfma_f32_16x16x32_bf16 v[152:155], a[36:39], v[84:87], v[152:155]
 v_mfma_f32_16x16x32_bf16 v[164:167], a[40:43], v[80:83], v[164:167]
 v_mfma_f32_16x16x32_bf16 v[160:163], a[40:43], v[84:87], v[160:163]
 v_mfma_f32_16x16x32_bf16 v[172:175], a[44:47], v[80:83], v[172:175]
 v_mfma_f32_16x16x32_bf16 v[168:171], a[44:47], v[84:87], v[168:171]
 s_add_u32 s53, s53, 40960
 buffer_load_dwordx4 a[32:35], v4, s[12:15], s53 offen offset:0 sc1
 buffer_load_dwordx4 a[36:39], v4, s[12:15], s53 offen offset:1024 sc1
 buffer_load_dwordx4 a[40:43], v4, s[12:15], s53 offen offset:2048 sc1
 buffer_load_dwordx4 a[44:47], v4, s[12:15], s53 offen offset:3072 sc1
 s_waitcnt vmcnt(41)
 v_mfma_f32_16x16x32_bf16 v[148:151], a[48:51], v[88:91], v[148:151]
 v_mfma_f32_16x16x32_bf16 v[144:147], a[48:51], v[92:95], v[144:147]
 v_mfma_f32_16x16x32_bf16 v[156:159], a[52:55], v[88:91], v[156:159]
 v_mfma_f32_16x16x32_bf16 v[152:155], a[52:55], v[92:95], v[152:155]
 v_mfma_f32_16x16x32_bf16 v[164:167], a[56:59], v[88:91], v[164:167]
 v_mfma_f32_16x16x32_bf16 v[160:163], a[56:59], v[92:95], v[160:163]
 v_mfma_f32_16x16x32_bf16 v[172:175], a[60:63], v[88:91], v[172:175]
 v_mfma_f32_16x16x32_bf16 v[168:171], a[60:63], v[92:95], v[168:171]
 s_add_u32 s53, s53, 40960
 buffer_load_dwordx4 a[48:51], v4, s[12:15], s53 offen offset:0 sc1
 buffer_load_dwordx4 a[52:55], v4, s[12:15], s53 offen offset:1024 sc1
 buffer_load_dwordx4 a[56:59], v4, s[12:15], s53 offen offset:2048 sc1
 buffer_load_dwordx4 a[60:63], v4, s[12:15], s53 offen offset:3072 sc1
 s_waitcnt vmcnt(41)
 v_mfma_f32_16x16x32_bf16 v[144:147], v[32:35], v[128:131], v[144:147]
 v_mfma_f32_16x16x32_bf16 v[148:151], v[32:35], v[132:135], v[148:151]
 v_mfma_f32_16x16x32_bf16 v[152:155], v[36:39], v[128:131], v[152:155]
 v_mfma_f32_16x16x32_bf16 v[156:159], v[36:39], v[132:135], v[156:159]
 v_mfma_f32_16x16x32_bf16 v[160:163], v[40:43], v[128:131], v[160:163]
 v_mfma_f32_16x16x32_bf16 v[164:167], v[40:43], v[132:135], v[164:167]
 v_mfma_f32_16x16x32_bf16 v[168:171], v[44:47], v[128:131], v[168:171]
 v_mfma_f32_16x16x32_bf16 v[172:175], v[44:47], v[132:135], v[172:175]
 buffer_load_dwordx4 v[32:35], v22, s[16:19], s48 offen offset:0 sc1
 buffer_load_dwordx4 v[36:39], v22, s[16:19], s48 offen offset:256 sc1
 buffer_load_dwordx4 v[40:43], v22, s[16:19], s48 offen offset:512 sc1
 buffer_load_dwordx4 v[44:47], v22, s[16:19], s48 offen offset:768 sc1
 s_add_u32 s48, s48, 4096
 s_waitcnt vmcnt(41)
 v_mfma_f32_16x16x32_bf16 v[148:151], a[64:67], v[96:99], v[148:151]
 v_mfma_f32_16x16x32_bf16 v[144:147], a[64:67], v[100:103], v[144:147]
 v_mfma_f32_16x16x32_bf16 v[156:159], a[68:71], v[96:99], v[156:159]
 v_mfma_f32_16x16x32_bf16 v[152:155], a[68:71], v[100:103], v[152:155]
 v_mfma_f32_16x16x32_bf16 v[164:167], a[72:75], v[96:99], v[164:167]
 v_mfma_f32_16x16x32_bf16 v[160:163], a[72:75], v[100:103], v[160:163]
 v_mfma_f32_16x16x32_bf16 v[172:175], a[76:79], v[96:99], v[172:175]
 v_mfma_f32_16x16x32_bf16 v[168:171], a[76:79], v[100:103], v[168:171]
 s_add_u32 s53, s53, 40960
 buffer_load_dwordx4 a[64:67], v4, s[12:15], s53 offen offset:0 sc1
 buffer_load_dwordx4 a[68:71], v4, s[12:15], s53 offen offset:1024 sc1
 buffer_load_dwordx4 a[72:75], v4, s[12:15], s53 offen offset:2048 sc1
 buffer_load_dwordx4 a[76:79], v4, s[12:15], s53 offen offset:3072 sc1
 s_waitcnt vmcnt(41)
 v_mfma_f32_16x16x32_bf16 v[148:151], a[80:83], v[104:107], v[148:151]
 v_mfma_f32_16x16x32_bf16 v[144:147], a[80:83], v[108:111], v[144:147]
 v_mfma_f32_16x16x32_bf16 v[156:159], a[84:87], v[104:107], v[156:159]
 v_mfma_f32_16x16x32_bf16 v[152:155], a[84:87], v[108:111], v[152:155]
 v_mfma_f32_16x16x32_bf16 v[164:167], a[88:91], v[104:107], v[164:167]
 v_mfma_f32_16x16x32_bf16 v[160:163], a[88:91], v[108:111], v[160:163]
 v_mfma_f32_16x16x32_bf16 v[172:175], a[92:95], v[104:107], v[172:175]
 v_mfma_f32_16x16x32_bf16 v[168:171], a[92:95], v[108:111], v[168:171]
 s_add_u32 s53, s53, 40960
 buffer_load_dwordx4 a[80:83], v4, s[12:15], s53 offen offset:0 sc1
 buffer_load_dwordx4 a[84:87], v4, s[12:15], s53 offen offset:1024 sc1
 buffer_load_dwordx4 a[88:91], v4, s[12:15], s53 offen offset:2048 sc1
 buffer_load_dwordx4 a[92:95], v4, s[12:15], s53 offen offset:3072 sc1
 s_waitcnt vmcnt(41)
 v_mfma_f32_16x16x32_bf16 v[148:151], a[96:99], v[112:115], v[148:151]
 v_mfma_f32_16x16x32_bf16 v[144:147], a[96:99], v[116:119], v[144:147]
 v_mfma_f32_16x16x32_bf16 v[156:159], a[100:103], v[112:115], v[156:159]
 v_mfma_f32_16x16x32_bf16 v[152:155], a[100:103], v[116:119], v[152:155]
 v_mfma_f32_16x16x32_bf16 v[164:167], a[104:107], v[112:115], v[164:167]
 v_mfma_f32_16x16x32_bf16 v[160:163], a[104:107], v[116:119], v[160:163]
 v_mfma_f32_16x16x32_bf16 v[172:175], a[108:111], v[112:115], v[172:175]
 v_mfma_f32_16x16x32_bf16 v[168:171], a[108:111], v[116:119], v[168:171]
 s_add_u32 s53, s53, 40960
 buffer_load_dwordx4 a[96:99], v4, s[12:15], s53 offen offset:0 sc1
 buffer_load_dwordx4 a[100:103], v4, s[12:15], s53 offen offset:1024 sc1
 buffer_load_dwordx4 a[104:107], v4, s[12:15], s53 offen offset:2048 sc1
 buffer_load_dwordx4 a[108:111], v4, s[12:15], s53 offen offset:3072 sc1
 s_waitcnt vmcnt(41)
 v_mfma_f32_16x16x32_bf16 v[148:151], a[112:115], v[120:123], v[148:151]
 v_mfma_f32_16x16x32_bf16 v[144:147], a[112:115], v[124:127], v[144:147]
 v_mfma_f32_16x16x32_bf16 v[156:159], a[116:119], v[120:123], v[156:159]
 v_mfma_f32_16x16x32_bf16 v[152:155], a[116:119], v[124:127], v[152:155]
 v_mfma_f32_16x16x32_bf16 v[164:167], a[120:123], v[120:123], v[164:167]
 v_mfma_f32_16x16x32_bf16 v[160:163], a[120:123], v[124:127], v[160:163]
 v_mfma_f32_16x16x32_bf16 v[172:175], a[124:127], v[120:123], v[172:175]
 v_mfma_f32_16x16x32_bf16 v[168:171], a[124:127], v[124:127], v[168:171]
 s_add_u32 s53, s53, 40960
 buffer_load_dwordx4 a[112:115], v4, s[12:15], s53 offen offset:0 sc1
 buffer_load_dwordx4 a[116:119], v4, s[12:15], s53 offen offset:1024 sc1
 buffer_load_dwordx4 a[120:123], v4, s[12:15], s53 offen offset:2048 sc1
 buffer_load_dwordx4 a[124:127], v4, s[12:15], s53 offen offset:3072 sc1
 s_waitcnt vmcnt(41)
 v_mfma_f32_16x16x32_bf16 v[144:147], v[48:51], v[136:139], v[144:147]
 v_mfma_f32_16x16x32_bf16 v[148:151], v[48:51], v[140:143], v[148:151]
 v_mfma_f32_16x16x32_bf16 v[152:155], v[52:55], v[136:139], v[152:155]
 v_mfma_f32_16x16x32_bf16 v[156:159], v[52:55], v[140:143], v[156:159]
 v_mfma_f32_16x16x32_bf16 v[160:163], v[56:59], v[136:139], v[160:163]
 v_mfma_f32_16x16x32_bf16 v[164:167], v[56:59], v[140:143], v[164:167]
 v_mfma_f32_16x16x32_bf16 v[168:171], v[60:63], v[136:139], v[168:171]
 v_mfma_f32_16x16x32_bf16 v[172:175], v[60:63], v[140:143], v[172:175]
 buffer_load_dwordx4 v[48:51], v22, s[16:19], s48 offen offset:0 sc1
 buffer_load_dwordx4 v[52:55], v22, s[16:19], s48 offen offset:256 sc1
 buffer_load_dwordx4 v[56:59], v22, s[16:19], s48 offen offset:512 sc1
 buffer_load_dwordx4 v[60:63], v22, s[16:19], s48 offen offset:768 sc1
 s_add_u32 s48, s48, 4096
 s_waitcnt vmcnt(40)
 s_branch pvy_281
pvy_280:
 s_waitcnt vmcnt(41)
 v_mfma_f32_16x16x32_bf16 v[148:151], a[0:3], v[64:67], 0
 v_mfma_f32_16x16x32_bf16 v[144:147], a[0:3], v[68:71], 0
 v_mfma_f32_16x16x32_bf16 v[156:159], a[4:7], v[64:67], 0
 v_mfma_f32_16x16x32_bf16 v[152:155], a[4:7], v[68:71], 0
 v_mfma_f32_16x16x32_bf16 v[164:167], a[8:11], v[64:67], 0
 v_mfma_f32_16x16x32_bf16 v[160:163], a[8:11], v[68:71], 0
 v_mfma_f32_16x16x32_bf16 v[172:175], a[12:15], v[64:67], 0
 v_mfma_f32_16x16x32_bf16 v[168:171], a[12:15], v[68:71], 0
 s_waitcnt vmcnt(37)
 v_mfma_f32_16x16x32_bf16 v[148:151], a[16:19], v[72:75], v[148:151]
 v_mfma_f32_16x16x32_bf16 v[144:147], a[16:19], v[76:79], v[144:147]
 v_mfma_f32_16x16x32_bf16 v[156:159], a[20:23], v[72:75], v[156:159]
 v_mfma_f32_16x16x32_bf16 v[152:155], a[20:23], v[76:79], v[152:155]
 v_mfma_f32_16x16x32_bf16 v[164:167], a[24:27], v[72:75], v[164:167]
 v_mfma_f32_16x16x32_bf16 v[160:163], a[24:27], v[76:79], v[160:163]
 v_mfma_f32_16x16x32_bf16 v[172:175], a[28:31], v[72:75], v[172:175]
 v_mfma_f32_16x16x32_bf16 v[168:171], a[28:31], v[76:79], v[168:171]
 s_waitcnt vmcnt(33)
 v_mfma_f32_16x16x32_bf16 v[148:151], a[32:35], v[80:83], v[148:151]
 v_mfma_f32_16x16x32_bf16 v[144:147], a[32:35], v[84:87], v[144:147]
 v_mfma_f32_16x16x32_bf16 v[156:159], a[36:39], v[80:83], v[156:159]
 v_mfma_f32_16x16x32_bf16 v[152:155], a[36:39], v[84:87], v[152:155]
 v_mfma_f32_16x16x32_bf16 v[164:167], a[40:43], v[80:83], v[164:167]
 v_mfma_f32_16x16x32_bf16 v[160:163], a[40:43], v[84:87], v[160:163]
 v_mfma_f32_16x16x32_bf16 v[172:175], a[44:47], v[80:83], v[172:175]
 v_mfma_f32_16x16x32_bf16 v[168:171], a[44:47], v[84:87], v[168:171]
 s_waitcnt vmcnt(29)
 v_mfma_f32_16x16x32_bf16 v[148:151], a[48:51], v[88:91], v[148:151]
 v_mfma_f32_16x16x32_bf16 v[144:147], a[48:51], v[92:95], v[144:147]
 v_mfma_f32_16x16x32_bf16 v[156:159], a[52:55], v[88:91], v[156:159]
 v_mfma_f32_16x16x32_bf16 v[152:155], a[52:55], v[92:95], v[152:155]
 v_mfma_f32_16x16x32_bf16 v[164:167], a[56:59], v[88:91], v[164:167]
 v_mfma_f32_16x16x32_bf16 v[160:163], a[56:59], v[92:95], v[160:163]
 v_mfma_f32_16x16x32_bf16 v[172:175], a[60:63], v[88:91], v[172:175]
 v_mfma_f32_16x16x32_bf16 v[168:171], a[60:63], v[92:95], v[168:171]
 s_waitcnt vmcnt(25)
 v_mfma_f32_16x16x32_bf16 v[144:147], v[32:35], v[128:131], v[144:147]
 v_mfma_f32_16x16x32_bf16 v[148:151], v[32:35], v[132:135], v[148:151]
 v_mfma_f32_16x16x32_bf16 v[152:155], v[36:39], v[128:131], v[152:155]
 v_mfma_f32_16x16x32_bf16 v[156:159], v[36:39], v[132:135], v[156:159]
 v_mfma_f32_16x16x32_bf16 v[160:163], v[40:43], v[128:131], v[160:163]
 v_mfma_f32_16x16x32_bf16 v[164:167], v[40:43], v[132:135], v[164:167]
 v_mfma_f32_16x16x32_bf16 v[168:171], v[44:47], v[128:131], v[168:171]
 v_mfma_f32_16x16x32_bf16 v[172:175], v[44:47], v[132:135], v[172:175]
 s_waitcnt vmcnt(21)
 v_mfma_f32_16x16x32_bf16 v[148:151], a[64:67], v[96:99], v[148:151]
 v_mfma_f32_16x16x32_bf16 v[144:147], a[64:67], v[100:103], v[144:147]
 v_mfma_f32_16x16x32_bf16 v[156:159], a[68:71], v[96:99], v[156:159]
 v_mfma_f32_16x16x32_bf16 v[152:155], a[68:71], v[100:103], v[152:155]
 v_mfma_f32_16x16x32_bf16 v[164:167], a[72:75], v[96:99], v[164:167]
 v_mfma_f32_16x16x32_bf16 v[160:163], a[72:75], v[100:103], v[160:163]
 v_mfma_f32_16x16x32_bf16 v[172:175], a[76:79], v[96:99], v[172:175]
 v_mfma_f32_16x16x32_bf16 v[168:171], a[76:79], v[100:103], v[168:171]
 s_waitcnt vmcnt(17)
 v_mfma_f32_16x16x32_bf16 v[148:151], a[80:83], v[104:107], v[148:151]
 v_mfma_f32_16x16x32_bf16 v[144:147], a[80:83], v[108:111], v[144:147]
 v_mfma_f32_16x16x32_bf16 v[156:159], a[84:87], v[104:107], v[156:159]
 v_mfma_f32_16x16x32_bf16 v[152:155], a[84:87], v[108:111], v[152:155]
 v_mfma_f32_16x16x32_bf16 v[164:167], a[88:91], v[104:107], v[164:167]
 v_mfma_f32_16x16x32_bf16 v[160:163], a[88:91], v[108:111], v[160:163]
 v_mfma_f32_16x16x32_bf16 v[172:175], a[92:95], v[104:107], v[172:175]
 v_mfma_f32_16x16x32_bf16 v[168:171], a[92:95], v[108:111], v[168:171]
 s_waitcnt vmcnt(13)
 v_mfma_f32_16x16x32_bf16 v[148:151], a[96:99], v[112:115], v[148:151]
 v_mfma_f32_16x16x32_bf16 v[144:147], a[96:99], v[116:119], v[144:147]
 v_mfma_f32_16x16x32_bf16 v[156:159], a[100:103], v[112:115], v[156:159]
 v_mfma_f32_16x16x32_bf16 v[152:155], a[100:103], v[116:119], v[152:155]
 v_mfma_f32_16x16x32_bf16 v[164:167], a[104:107], v[112:115], v[164:167]
 v_mfma_f32_16x16x32_bf16 v[160:163], a[104:107], v[116:119], v[160:163]
 v_mfma_f32_16x16x32_bf16 v[172:175], a[108:111], v[112:115], v[172:175]
 v_mfma_f32_16x16x32_bf16 v[168:171], a[108:111], v[116:119], v[168:171]
 s_waitcnt vmcnt(9)
 v_mfma_f32_16x16x32_bf16 v[148:151], a[112:115], v[120:123], v[148:151]
 v_mfma_f32_16x16x32_bf16 v[144:147], a[112:115], v[124:127], v[144:147]
 v_mfma_f32_16x16x32_bf16 v[156:159], a[116:119], v[120:123], v[156:159]
 v_mfma_f32_16x16x32_bf16 v[152:155], a[116:119], v[124:127], v[152:155]
 v_mfma_f32_16x16x32_bf16 v[164:167], a[120:123], v[120:123], v[164:167]
 v_mfma_f32_16x16x32_bf16 v[160:163], a[120:123], v[124:127], v[160:163]
 v_mfma_f32_16x16x32_bf16 v[172:175], a[124:127], v[120:123], v[172:175]
 v_mfma_f32_16x16x32_bf16 v[168:171], a[124:127], v[124:127], v[168:171]
 s_waitcnt vmcnt(5)
 v_mfma_f32_16x16x32_bf16 v[144:147], v[48:51], v[136:139], v[144:147]
 v_mfma_f32_16x16x32_bf16 v[148:151], v[48:51], v[140:143], v[148:151]
 v_mfma_f32_16x16x32_bf16 v[152:155], v[52:55], v[136:139], v[152:155]
 v_mfma_f32_16x16x32_bf16 v[156:159], v[52:55], v[140:143], v[156:159]
 v_mfma_f32_16x16x32_bf16 v[160:163], v[56:59], v[136:139], v[160:163]
 v_mfma_f32_16x16x32_bf16 v[164:167], v[56:59], v[140:143], v[164:167]
 v_mfma_f32_16x16x32_bf16 v[168:171], v[60:63], v[136:139], v[168:171]
 v_mfma_f32_16x16x32_bf16 v[172:175], v[60:63], v[140:143], v[172:175]
 s_waitcnt vmcnt(0)
pvy_281:
 s_or_b32 s21, s20, s65
 s_cbranch_scc1 lc_282
 s_sub_u32 s21, s2, 0
 s_cmp_ge_u32 s21, 640
 s_cbranch_scc1 lc_282
 v_mov_b32 v29, 1
 s_mov_b64 exec, 1
 buffer_atomic_add v29, v28, s[32:35], 0 offen sc0 sc1
 s_mov_b64 exec, -1
lc_282:
 v_sub_f32 v25, 1.0, v24
 v_cvt_pk_bf16_f32 v26, v25, v25
 v_lshlrev_b32 v25, 16, v26
 v_cvt_pk_bf16_f32 v26, v12, v12
 v_lshlrev_b32 v12, 16, v26
 v_cvt_pk_bf16_f32 v26, v13, v13
 v_lshlrev_b32 v13, 16, v26
 v_cvt_pk_bf16_f32 v26, v14, v14
 v_lshlrev_b32 v14, 16, v26
 v_cvt_pk_bf16_f32 v26, v15, v15
 v_lshlrev_b32 v15, 16, v26
 v_cvt_pk_bf16_f32 v26, v16, v16
 v_lshlrev_b32 v16, 16, v26
 v_cvt_pk_bf16_f32 v26, v17, v17
 v_lshlrev_b32 v17, 16, v26
 v_cvt_pk_bf16_f32 v26, v18, v18
 v_lshlrev_b32 v18, 16, v26
 v_cvt_pk_bf16_f32 v26, v19, v19
 v_lshlrev_b32 v19, 16, v26
 v_mul_f32 v12, v12, v25
 v_cvt_pk_bf16_f32 v26, v12, v12
 v_lshlrev_b32 v12, 16, v26
 v_mul_f32 v13, v13, v25
 v_cvt_pk_bf16_f32 v26, v13, v13
 v_lshlrev_b32 v13, 16, v26
 v_mul_f32 v14, v14, v25
 v_cvt_pk_bf16_f32 v26, v14, v14
 v_lshlrev_b32 v14, 16, v26
 v_mul_f32 v15, v15, v25
 v_cvt_pk_bf16_f32 v26, v15, v15
 v_lshlrev_b32 v15, 16, v26
 v_mul_f32 v16, v16, v25
 v_cvt_pk_bf16_f32 v26, v16, v16
 v_lshlrev_b32 v16, 16, v26
 v_mul_f32 v17, v17, v25
 v_cvt_pk_bf16_f32 v26, v17, v17
 v_lshlrev_b32 v17, 16, v26
 v_mul_f32 v18, v18, v25
 v_cvt_pk_bf16_f32 v26, v18, v18
 v_lshlrev_b32 v18, 16, v26
 v_mul_f32 v19, v19, v25
 v_cvt_pk_bf16_f32 v26, v19, v19
 v_lshlrev_b32 v19, 16, v26
 ds_write_b128 v10, v[144:147] offset:0
 ds_write_b128 v10, v[148:151] offset:1024
 ds_write_b128 v10, v[152:155] offset:2048
 ds_write_b128 v10, v[156:159] offset:3072
 ds_write_b128 v10, v[160:163] offset:4096
 ds_write_b128 v10, v[164:167] offset:5120
 ds_write_b128 v10, v[168:171] offset:6144
 ds_write_b128 v10, v[172:175] offset:7168
 s_waitcnt lgkmcnt(0)
 s_barrier
 ds_read_b128 v[176:179], v11 offset:0
 ds_read_b128 v[180:183], v11 offset:8192
 ds_read_b128 v[184:187], v11 offset:16384
 ds_read_b128 v[188:191], v11 offset:24576
 ds_read_b128 v[192:195], v11 offset:4096
 ds_read_b128 v[196:199], v11 offset:12288
 ds_read_b128 v[200:203], v11 offset:20480
 ds_read_b128 v[204:207], v11 offset:28672
 s_cmp_ge_u32 s40, 48
 s_cbranch_scc1 pvr_283
 s_waitcnt lgkmcnt(4)
 v_pk_add_f32 v[176:177], v[176:177], v[180:181]
 v_pk_add_f32 v[184:185], v[184:185], v[188:189]
 v_pk_add_f32 v[178:179], v[178:179], v[182:183]
 v_pk_add_f32 v[186:187], v[186:187], v[190:191]
 v_pk_add_f32 v[176:177], v[176:177], v[184:185]
 v_pk_add_f32 v[178:179], v[178:179], v[186:187]
 buffer_store_dwordx4 v[176:179], v4, s[24:27], s54 offen offset:0 sc1
 s_waitcnt lgkmcnt(0)
 v_pk_add_f32 v[192:193], v[192:193], v[196:197]
 v_pk_add_f32 v[200:201], v[200:201], v[204:205]
 v_pk_add_f32 v[194:195], v[194:195], v[198:199]
 v_pk_add_f32 v[202:203], v[202:203], v[206:207]
 v_pk_add_f32 v[192:193], v[192:193], v[200:201]
 v_pk_add_f32 v[194:195], v[194:195], v[202:203]
 buffer_store_dwordx4 v[192:195], v4, s[24:27], s54 offen offset:2048 sc1
 s_lshr_b32 s71, s40, 2
 s_lshl_b32 s71, s71, 7
 s_add_u32 s71, s71, 116736
 s_branch pvr_284
pvr_283:
 s_waitcnt lgkmcnt(4)
 v_pk_add_f32 v[176:177], v[176:177], v[180:181]
 v_pk_add_f32 v[184:185], v[184:185], v[188:189]
 v_pk_add_f32 v[178:179], v[178:179], v[182:183]
 v_pk_add_f32 v[186:187], v[186:187], v[190:191]
 v_pk_add_f32 v[176:177], v[176:177], v[184:185]
 v_pk_add_f32 v[178:179], v[178:179], v[186:187]
 v_cvt_pk_bf16_f32 v26, v176, v177
 v_lshlrev_b32 v176, 16, v26
 v_and_b32 v177, 0xffff0000, v26
 v_mul_f32 v176, v176, v24
 v_mul_f32 v177, v177, v24
 v_cvt_pk_bf16_f32 v26, v176, v177
 v_lshlrev_b32 v176, 16, v26
 v_and_b32 v177, 0xffff0000, v26
 v_add_f32 v176, v176, v12
 v_add_f32 v177, v177, v13
 v_cvt_pk_bf16_f32 v180, v176, v177
 v_cvt_pk_bf16_f32 v26, v178, v179
 v_lshlrev_b32 v178, 16, v26
 v_and_b32 v179, 0xffff0000, v26
 v_mul_f32 v178, v178, v24
 v_mul_f32 v179, v179, v24
 v_cvt_pk_bf16_f32 v26, v178, v179
 v_lshlrev_b32 v178, 16, v26
 v_and_b32 v179, 0xffff0000, v26
 v_add_f32 v178, v178, v14
 v_add_f32 v179, v179, v15
 v_cvt_pk_bf16_f32 v181, v178, v179
 buffer_store_dwordx2 v[180:181], v9, s[8:11], s46 offen offset:0
 s_waitcnt lgkmcnt(0)
 v_pk_add_f32 v[192:193], v[192:193], v[196:197]
 v_pk_add_f32 v[200:201], v[200:201], v[204:205]
 v_pk_add_f32 v[194:195], v[194:195], v[198:199]
 v_pk_add_f32 v[202:203], v[202:203], v[206:207]
 v_pk_add_f32 v[192:193], v[192:193], v[200:201]
 v_pk_add_f32 v[194:195], v[194:195], v[202:203]
 v_cvt_pk_bf16_f32 v26, v192, v193
 v_lshlrev_b32 v192, 16, v26
 v_and_b32 v193, 0xffff0000, v26
 v_mul_f32 v192, v192, v24
 v_mul_f32 v193, v193, v24
 v_cvt_pk_bf16_f32 v26, v192, v193
 v_lshlrev_b32 v192, 16, v26
 v_and_b32 v193, 0xffff0000, v26
 v_add_f32 v192, v192, v16
 v_add_f32 v193, v193, v17
 v_cvt_pk_bf16_f32 v196, v192, v193
 v_cvt_pk_bf16_f32 v26, v194, v195
 v_lshlrev_b32 v194, 16, v26
 v_and_b32 v195, 0xffff0000, v26
 v_mul_f32 v194, v194, v24
 v_mul_f32 v195, v195, v24
 v_cvt_pk_bf16_f32 v26, v194, v195
 v_lshlrev_b32 v194, 16, v26
 v_and_b32 v195, 0xffff0000, v26
 v_add_f32 v194, v194, v18
 v_add_f32 v195, v195, v19
 v_cvt_pk_bf16_f32 v197, v194, v195
 buffer_store_dwordx2 v[196:197], v9, s[8:11], s46 offen offset:64
pvr_284:
 s_branch pvy_278
pvy_279:
 s_sub_u32 s21, s2, 0
 s_cmp_ge_u32 s21, 640
 s_cbranch_scc1 lc_285
 s_cmp_lg_u32 s20, 0
 s_cbranch_scc1 lc_285x
 s_waitcnt vmcnt(2)
 s_mov_b64 exec, 1
 ds_write_b32 v30, v29 offset:12
 s_mov_b64 exec, -1
lc_285x:
 s_waitcnt lgkmcnt(0)
 s_barrier
 ds_read_b32 v23, v30 offset:12
lc_285:
 s_waitcnt lgkmcnt(0)
 v_readfirstlane_b32 s2, v23
 v_readfirstlane_b32 s67, v213
 s_barrier
 s_cmp_ge_u32 s40, 40
 s_cselect_b32 s21, s71, 0
 s_cmp_lg_u32 s21, 0
 s_cselect_b32 s21, 9999, s2
 s_cmp_lt_u32 s21, 248
 s_cbranch_scc1 pae_286
 s_waitcnt vmcnt(0)
 s_cmp_eq_u32 s71, 0
 s_cbranch_scc1 paf_287
 v_mov_b32 v25, 0
 v_mov_b32 v26, 1
 s_mov_b64 exec, 1
 buffer_atomic_add v26, v25, s[72:75], s71 offen sc1
 s_mov_b64 exec, -1
 s_mov_b32 s71, 0
paf_287:
pae_286:
 s_add_u32 s21, s2, 0
 s_cmp_lt_u32 s2, 64
 s_cbranch_scc1 pv_loop
 s_sub_u32 s2, s2, 64
 s_add_u32 s21, s2, 64
 s_cmp_lt_u32 s2, 20
 s_cbranch_scc1 pv_loop
 s_sub_u32 s2, s2, 20
 s_add_u32 s21, s2, 84
 s_cmp_lt_u32 s2, 20
 s_cbranch_scc1 pv_loop
 s_sub_u32 s2, s2, 20
 s_add_u32 s21, s2, 124
 s_cmp_lt_u32 s2, 20
 s_cbranch_scc1 pv_loop
 s_sub_u32 s2, s2, 20
 s_add_u32 s21, s2, 104
 s_cmp_lt_u32 s2, 20
 s_cbranch_scc1 pv_loop
 s_sub_u32 s2, s2, 20
 s_add_u32 s21, s2, 144
 s_cmp_lt_u32 s2, 104
 s_cbranch_scc1 pv_loop
 s_sub_u32 s2, s2, 104
 s_branch main_fin
 s_branch queue
main_fin:
 s_waitcnt vmcnt(0)
main_end:
 s_endpgm
code_end:
.section .rodata,"a"
.p2align 6
.amdhsa_kernel gated_mix__memory_aug_recurrent_mem_tr__sliding_local_dilated__prompt_kernel
  .amdhsa_next_free_vgpr 512
  .amdhsa_next_free_sgpr 102
  .amdhsa_accum_offset 256
  .amdhsa_group_segment_fixed_size 0
  .amdhsa_kernarg_size 112
  .amdhsa_user_sgpr_count 2
  .amdhsa_user_sgpr_kernarg_segment_ptr 1
  .amdhsa_system_sgpr_workgroup_id_x 1
.end_amdhsa_kernel
.text
```
